```python
import torch

def _softmax(x, axis=-1):
    return torch.softmax(x, dim=axis)
def _gelu(x):
    return torch.nn.functional.gelu(x, approximate="tanh")
def _silu(x):
    return torch.nn.functional.silu(x)
def _sigmoid(x):
    return torch.sigmoid(x)
def _layernorm(x, axis=-1, eps=1e-5):
    m = x.mean(dim=axis, keepdim=True)
    v = x.var(dim=axis, keepdim=True, unbiased=False)
    return (x - m) / torch.sqrt(v + eps)
def _scatter_add(tgt, idx, src, axis=0):
    return tgt.clone().index_add_(axis, idx, src)
def _segment_sum(src, seg, n):
    out = torch.zeros((n,) + src.shape[1:], dtype=src.dtype)
    return out.index_add_(0, seg, src)
def _pad(x, pw):
    flat = tuple(v for pair in reversed(pw) for v in pair)
    return torch.nn.functional.pad(x, flat)

kernel_name = 'sequential_preLN__compressed_kv_cla__moe_arch_mod__prompt'

def setup_inputs():

    _w = (lambda a: (lambda t: t.to(torch.bfloat16) if t.is_floating_point() else t)(torch.as_tensor(a)))
    def _A_setup():
        B, H, Sq, Sk, D, M = 1, 32, 2048, 2048, 128, 1024
        Dc = 4 * D
        return {
            "x": _w((lambda *s: torch.randn(*s, dtype=torch.bfloat16) * 0.1)(B, Sq, M)),
            "c_kv": _w((lambda *s: torch.randn(*s, dtype=torch.bfloat16) * 1.6)(B, Sk, Dc)),
            "w_q": _w((lambda *s: torch.randn(*s, dtype=torch.bfloat16) * 0.8)(M, H, D) * (M ** -0.5)),
            "w_uk": _w((lambda *s: torch.randn(*s, dtype=torch.bfloat16) * 0.8)(Dc, H, D) * (Dc ** -0.5)),
            "w_uv": _w((lambda *s: torch.randn(*s, dtype=torch.bfloat16) * 1.6)(Dc, H, D) * (Dc ** -0.5)),
            "w_o": _w((lambda *s: torch.randn(*s, dtype=torch.bfloat16) * 1.6)(H, D, M) * ((H * D) ** -0.5)),
        }
    _A_in = _A_setup()

    def _B_setup():
        B, S, D, F, C = 1, 2048, 1024, 3584, 2
        return {
            "x": _w((lambda *s: torch.randn(*s, dtype=torch.bfloat16) * 0.1)(B, S, D)),
            "w_r": _w((lambda *s: torch.randn(*s, dtype=torch.bfloat16) * 0.2)(D)),
            "w_gate": _w((lambda *s: torch.randn(*s, dtype=torch.bfloat16) * 0.2)(D, F)),
            "w_up": _w((lambda *s: torch.randn(*s, dtype=torch.bfloat16) * 0.2)(D, F)),
            "w_down": _w((lambda *s: torch.randn(*s, dtype=torch.bfloat16) * 0.2)(F, D)),
        }
    _B_in = _B_setup()

    return {
        "A_x": _A_in["x"],
        "A_c_kv": _A_in["c_kv"],
        "A_w_q": _A_in["w_q"],
        "A_w_uk": _A_in["w_uk"],
        "A_w_uv": _A_in["w_uv"],
        "A_w_o": _A_in["w_o"],
        "B_x": _B_in["x"],
        "B_w_r": _B_in["w_r"],
        "B_w_gate": _B_in["w_gate"],
        "B_w_up": _B_in["w_up"],
        "B_w_down": _B_in["w_down"],
    }

def reference(A_x, A_c_kv, A_w_q, A_w_uk, A_w_uv, A_w_o, B_x, B_w_r, B_w_gate, B_w_up, B_w_down):
    def _A_ref(x, c_kv, w_q, w_uk, w_uv, w_o):
        B, Sq, M = x.shape[0], x.shape[1], x.shape[2]
        Sk = c_kv.shape[1]
        H, D = w_q.shape[1], w_q.shape[2]
        q = torch.einsum("bqm,mhd->bhqd", x, w_q)
        k = torch.einsum("bkc,chd->bhkd", c_kv, w_uk)
        v = torch.einsum("bkc,chd->bhkd", c_kv, w_uv)
        scores = torch.einsum("bhqd,bhkd->bhqk", q, k) * (D ** -0.5)
        off = Sk - Sq
        qi = torch.arange(Sq)[:, None]
        kj = torch.arange(Sk)[None, :]
        cmask = kj <= (qi + off)
        scores = torch.where(cmask[None, None], scores, -1e9)
        p = _softmax(scores, axis=-1)
        ctx = torch.einsum("bhqk,bhkd->bhqd", p, v)
        return torch.einsum("bhqd,hdm->bqm", ctx, w_o)

    def _B_ref(x, w_r, w_gate, w_up, w_down):
        B, S, D = x.shape
        C = 2
        r = x @ w_r
        idx = torch.argsort(-r, axis=-1)[:, :C]
        idx_e = (lambda x, n, axis: torch.repeat_interleave(x, n, dim=axis))(idx.reshape(B, C, 1), D, axis=2)
        x_sel = (lambda x, i, axis: torch.take_along_dim(x, i, dim=axis))(x, idx_e, axis=1)
        g = _silu(x_sel @ w_gate)
        u = x_sel @ w_up
        y = (g * u) @ w_down
        r_sel = _sigmoid((lambda x, i, axis: torch.take_along_dim(x, i, dim=axis))(r, idx, axis=1))
        y = y * r_sel.reshape(B, C, 1)
        b_off = (torch.arange(B) * S).reshape(B, 1)
        flat_idx = (idx + b_off).reshape(B * C)
        zero = (x * 0.0).reshape(B * S, D)
        upd = _scatter_add(zero, flat_idx, y.reshape(B * C, D), axis=0)
        return x + upd.reshape(B, S, D)

    x = A_x
    h = x + _A_ref(_layernorm(x, axis=-1), A_c_kv, A_w_q, A_w_uk, A_w_uv, A_w_o)
    h2 = h + _B_ref(_layernorm(h, axis=-1), B_w_r, B_w_gate, B_w_up, B_w_down)
    return h2
```

```asm
; @launch kernel=k1_kernel grid=(256,1,1) block=(256,1,1) lds=131072
; @launch kernel=k2_kernel grid=(256,1,1) block=(256,1,1) lds=131072
; @launch kernel=k3_kernel grid=(256,1,1) block=(256,1,1) lds=65536
; @launch kernel=k4_kernel grid=(256,1,1) block=(256,1,1) lds=90176
; @launch kernel=k5_kernel grid=(64,1,1) block=(256,1,1) lds=512
.amdgcn_target "amdgcn-amd-amdhsa--gfx950"
.text
.globl k1_kernel
.p2align 8
.type k1_kernel,@function
k1_kernel:
    s_cmp_ge_u32 s2, 256
    s_cbranch_scc1 k1_end_1
    s_load_dwordx4 s[4:7], s[0:1], 0
    s_load_dwordx4 s[8:11], s[0:1], 24
    s_load_dwordx2 s[12:13], s[0:1], 104
    s_and_b32 s40, s2, 7
    s_lshr_b32 s41, s2, 3
    s_and_b32 s42, s41, 7
    s_lshr_b32 s43, s41, 3
    s_and_b32 s44, s43, 1
    s_lshl_b32 s45, s40, 1
    s_add_u32 s44, s44, s45
    s_lshr_b32 s43, s43, 1
    v_lshrrev_b32 v1, 6, v0
    v_and_b32 v2, 63, v0
    v_readfirstlane_b32 s46, v1
    s_waitcnt lgkmcnt(0)
    s_mov_b32 s16, s6
    s_and_b32 s17, s7, 0xffff
    s_mov_b32 s18, 0x200000
    s_mov_b32 s19, 0x00020000
    s_cmp_eq_u32 s43, 0
    s_cselect_b32 s20, s8, s10
    s_cselect_b32 s21, s9, s11
    s_and_b32 s21, s21, 0xffff
    s_mov_b32 s22, 0x400000
    s_mov_b32 s23, 0x00020000
    s_mov_b32 s24, s4
    s_and_b32 s25, s5, 0xffff
    s_mov_b32 s26, 0x400000
    s_mov_b32 s27, 0x00020000
    s_add_u32 s28, s12, 0x0
    s_addc_u32 s29, s13, 0
    s_and_b32 s29, s29, 0xffff
    s_mov_b32 s30, 0x400000
    s_mov_b32 s31, 0x00020000
    s_add_u32 s32, s12, 0x1000000
    s_addc_u32 s33, s13, 0
    s_and_b32 s33, s33, 0xffff
    s_mov_b32 s34, 0x2000000
    s_mov_b32 s35, 0x00020000
    s_add_u32 s36, s12, 0x4800000
    s_addc_u32 s37, s13, 0
    s_and_b32 s37, s37, 0xffff
    s_mov_b32 s38, 0x6000
    s_mov_b32 s39, 0x00020000
    v_lshrrev_b32 v3, 3, v2
    v_and_b32 v4, 7, v2
    v_lshrrev_b32 v5, 1, v3
    v_xor_b32 v6, v4, v5
    v_xor_b32 v7, 4, v6
    v_lshl_add_u32 v8, v1, 6, v3
    v_lshlrev_b32 v8, 10, v8
    s_lshl_b32 s47, s42, 18
    v_add_u32 v8, s47, v8
    v_lshl_add_u32 v10, v6, 4, v8
    v_lshl_add_u32 v11, v7, 4, v8
    v_add_u32 v17, 54272, v11
    v_add_u32 v16, 47104, v10
    v_add_u32 v15, 39936, v11
    v_add_u32 v14, 32768, v10
    v_add_u32 v13, 21504, v11
    v_add_u32 v12, 14336, v10
    v_add_u32 v11, 7168, v11
    v_add_u32 v10, 0, v10
    v_lshrrev_b32 v3, 5, v2
    v_bfe_u32 v4, v2, 1, 4
    v_and_b32 v5, 1, v2
    v_lshl_add_u32 v8, v1, 4, v3
    v_lshlrev_b32 v8, 13, v8
    v_lshl_add_u32 v8, v5, 4, v8
    s_lshl_b32 s47, s44, 9
    v_add_u32 v8, s47, v8
    v_xor_b32 v4, v4, v3
    v_xor_b32 v6, 0, v4
    v_lshl_add_u32 v6, v6, 5, v8
    v_add_u32 v18, 0, v6
    v_xor_b32 v6, 2, v4
    v_lshl_add_u32 v6, v6, 5, v8
    v_add_u32 v19, 15360, v6
    v_xor_b32 v6, 0, v4
    v_lshl_add_u32 v6, v6, 5, v8
    v_add_u32 v20, 30720, v6
    v_xor_b32 v6, 2, v4
    v_lshl_add_u32 v6, v6, 5, v8
    v_add_u32 v21, 46080, v6
    v_xor_b32 v6, 4, v4
    v_lshl_add_u32 v6, v6, 5, v8
    v_add_u32 v22, 65536, v6
    v_xor_b32 v6, 6, v4
    v_lshl_add_u32 v6, v6, 5, v8
    v_add_u32 v23, 80896, v6
    v_xor_b32 v6, 4, v4
    v_lshl_add_u32 v6, v6, 5, v8
    v_add_u32 v24, 96256, v6
    v_xor_b32 v6, 6, v4
    v_lshl_add_u32 v6, v6, 5, v8
    v_add_u32 v25, 111616, v6
    s_lshl_b32 s48, s46, 13
    s_mov_b32 s49, 0
    s_mov_b32 s50, 0
    s_add_u32 m0, s48, 0
    s_nop 0
    buffer_load_dwordx4 v10, s[16:19], s49 offen offset:0 lds
    buffer_load_dwordx4 v11, s[16:19], s49 offen offset:1024 lds
    buffer_load_dwordx4 v12, s[16:19], s49 offen offset:2048 lds
    buffer_load_dwordx4 v13, s[16:19], s49 offen offset:3072 lds
    s_add_u32 m0, s48, 4096
    s_nop 0
    buffer_load_dwordx4 v14, s[16:19], s49 offen offset:0 lds
    buffer_load_dwordx4 v15, s[16:19], s49 offen offset:1024 lds
    buffer_load_dwordx4 v16, s[16:19], s49 offen offset:2048 lds
    buffer_load_dwordx4 v17, s[16:19], s49 offen offset:3072 lds
    s_add_u32 m0, s48, 65536
    s_nop 0
    buffer_load_dwordx4 v18, s[20:23], s50 offen offset:0 lds
    buffer_load_dwordx4 v19, s[20:23], s50 offen offset:1024 lds
    buffer_load_dwordx4 v20, s[20:23], s50 offen offset:2048 lds
    buffer_load_dwordx4 v21, s[20:23], s50 offen offset:3072 lds
    s_add_u32 m0, s48, 69632
    s_nop 0
    buffer_load_dwordx4 v22, s[20:23], s50 offen offset:0 lds
    buffer_load_dwordx4 v23, s[20:23], s50 offen offset:1024 lds
    buffer_load_dwordx4 v24, s[20:23], s50 offen offset:2048 lds
    buffer_load_dwordx4 v25, s[20:23], s50 offen offset:3072 lds
    s_add_u32 s49, s49, 128
    s_add_u32 s50, s50, 0x80000
    s_add_u32 m0, s48, 32768
    s_nop 0
    buffer_load_dwordx4 v10, s[16:19], s49 offen offset:0 lds
    buffer_load_dwordx4 v11, s[16:19], s49 offen offset:1024 lds
    buffer_load_dwordx4 v12, s[16:19], s49 offen offset:2048 lds
    buffer_load_dwordx4 v13, s[16:19], s49 offen offset:3072 lds
    s_add_u32 m0, s48, 36864
    s_nop 0
    buffer_load_dwordx4 v14, s[16:19], s49 offen offset:0 lds
    buffer_load_dwordx4 v15, s[16:19], s49 offen offset:1024 lds
    buffer_load_dwordx4 v16, s[16:19], s49 offen offset:2048 lds
    buffer_load_dwordx4 v17, s[16:19], s49 offen offset:3072 lds
    s_add_u32 m0, s48, 98304
    s_nop 0
    buffer_load_dwordx4 v18, s[20:23], s50 offen offset:0 lds
    buffer_load_dwordx4 v19, s[20:23], s50 offen offset:1024 lds
    buffer_load_dwordx4 v20, s[20:23], s50 offen offset:2048 lds
    buffer_load_dwordx4 v21, s[20:23], s50 offen offset:3072 lds
    s_add_u32 m0, s48, 102400
    s_nop 0
    buffer_load_dwordx4 v22, s[20:23], s50 offen offset:0 lds
    buffer_load_dwordx4 v23, s[20:23], s50 offen offset:1024 lds
    buffer_load_dwordx4 v24, s[20:23], s50 offen offset:2048 lds
    buffer_load_dwordx4 v25, s[20:23], s50 offen offset:3072 lds
    s_add_u32 s49, s49, 128
    s_add_u32 s50, s50, 0x80000
    v_lshrrev_b32 v3, 5, v2
    v_lshl_add_u32 v3, v1, 1, v3
    s_lshl_b32 s47, s2, 3
    v_add_u32 v3, s47, v3
    v_and_b32 v4, 31, v2
    v_lshlrev_b32 v5, 11, v3
    v_lshl_add_u32 v5, v4, 4, v5
    buffer_load_dwordx4 v[40:43], v5, s[24:27], 0 offen offset:0
    buffer_load_dwordx4 v[44:47], v5, s[24:27], 0 offen offset:512
    buffer_load_dwordx4 v[48:51], v5, s[24:27], 0 offen offset:1024
    buffer_load_dwordx4 v[52:55], v5, s[24:27], 0 offen offset:1536
    v_lshrrev_b32 v5, 4, v3
    v_lshlrev_b32 v5, 10, v5
    v_and_b32 v6, 15, v3
    v_lshl_add_u32 v5, v6, 4, v5
    v_and_b32 v6, 3, v4
    v_lshl_add_u32 v5, v6, 8, v5
    v_lshrrev_b32 v6, 2, v4
    v_lshl_add_u32 v26, v6, 17, v5
    v_and_b32 v3, 15, v2
    v_lshrrev_b32 v4, 4, v2
    v_lshrrev_b32 v5, 1, v3
    v_xor_b32 v5, v5, v4
    v_and_b32 v6, 1, v1
    v_lshl_add_u32 v6, v6, 7, v3
    v_lshlrev_b32 v6, 7, v6
    v_lshl_add_u32 v28, v5, 4, v6
    v_xor_b32 v29, 64, v28
    v_lshrrev_b32 v5, 2, v3
    v_and_b32 v6, 1, v4
    v_lshl_add_u32 v6, v6, 2, v5
    v_lshl_add_u32 v7, v4, 3, v5
    v_lshlrev_b32 v7, 9, v7
    v_lshrrev_b32 v8, 1, v1
    v_lshl_add_u32 v7, v8, 8, v7
    v_and_b32 v8, 3, v2
    v_lshl_add_u32 v7, v8, 3, v7
    v_add_u32 v7, 65536, v7
    v_xor_b32 v8, 0, v6
    v_lshl_add_u32 v30, v8, 5, v7
    v_xor_b32 v8, 1, v6
    v_lshl_add_u32 v31, v8, 5, v7
    v_xor_b32 v8, 2, v6
    v_lshl_add_u32 v32, v8, 5, v7
    v_xor_b32 v8, 3, v6
    v_lshl_add_u32 v33, v8, 5, v7
    v_xor_b32 v8, 4, v6
    v_lshl_add_u32 v34, v8, 5, v7
    v_xor_b32 v8, 5, v6
    v_lshl_add_u32 v35, v8, 5, v7
    v_xor_b32 v8, 6, v6
    v_lshl_add_u32 v36, v8, 5, v7
    v_xor_b32 v8, 7, v6
    v_lshl_add_u32 v37, v8, 5, v7
    v_accvgpr_write_b32 a0, 0
    v_accvgpr_write_b32 a1, 0
    v_accvgpr_write_b32 a2, 0
    v_accvgpr_write_b32 a3, 0
    v_accvgpr_write_b32 a4, 0
    v_accvgpr_write_b32 a5, 0
    v_accvgpr_write_b32 a6, 0
    v_accvgpr_write_b32 a7, 0
    v_accvgpr_write_b32 a8, 0
    v_accvgpr_write_b32 a9, 0
    v_accvgpr_write_b32 a10, 0
    v_accvgpr_write_b32 a11, 0
    v_accvgpr_write_b32 a12, 0
    v_accvgpr_write_b32 a13, 0
    v_accvgpr_write_b32 a14, 0
    v_accvgpr_write_b32 a15, 0
    v_accvgpr_write_b32 a16, 0
    v_accvgpr_write_b32 a17, 0
    v_accvgpr_write_b32 a18, 0
    v_accvgpr_write_b32 a19, 0
    v_accvgpr_write_b32 a20, 0
    v_accvgpr_write_b32 a21, 0
    v_accvgpr_write_b32 a22, 0
    v_accvgpr_write_b32 a23, 0
    v_accvgpr_write_b32 a24, 0
    v_accvgpr_write_b32 a25, 0
    v_accvgpr_write_b32 a26, 0
    v_accvgpr_write_b32 a27, 0
    v_accvgpr_write_b32 a28, 0
    v_accvgpr_write_b32 a29, 0
    v_accvgpr_write_b32 a30, 0
    v_accvgpr_write_b32 a31, 0
    v_accvgpr_write_b32 a32, 0
    v_accvgpr_write_b32 a33, 0
    v_accvgpr_write_b32 a34, 0
    v_accvgpr_write_b32 a35, 0
    v_accvgpr_write_b32 a36, 0
    v_accvgpr_write_b32 a37, 0
    v_accvgpr_write_b32 a38, 0
    v_accvgpr_write_b32 a39, 0
    v_accvgpr_write_b32 a40, 0
    v_accvgpr_write_b32 a41, 0
    v_accvgpr_write_b32 a42, 0
    v_accvgpr_write_b32 a43, 0
    v_accvgpr_write_b32 a44, 0
    v_accvgpr_write_b32 a45, 0
    v_accvgpr_write_b32 a46, 0
    v_accvgpr_write_b32 a47, 0
    v_accvgpr_write_b32 a48, 0
    v_accvgpr_write_b32 a49, 0
    v_accvgpr_write_b32 a50, 0
    v_accvgpr_write_b32 a51, 0
    v_accvgpr_write_b32 a52, 0
    v_accvgpr_write_b32 a53, 0
    v_accvgpr_write_b32 a54, 0
    v_accvgpr_write_b32 a55, 0
    v_accvgpr_write_b32 a56, 0
    v_accvgpr_write_b32 a57, 0
    v_accvgpr_write_b32 a58, 0
    v_accvgpr_write_b32 a59, 0
    v_accvgpr_write_b32 a60, 0
    v_accvgpr_write_b32 a61, 0
    v_accvgpr_write_b32 a62, 0
    v_accvgpr_write_b32 a63, 0
    v_accvgpr_write_b32 a64, 0
    v_accvgpr_write_b32 a65, 0
    v_accvgpr_write_b32 a66, 0
    v_accvgpr_write_b32 a67, 0
    v_accvgpr_write_b32 a68, 0
    v_accvgpr_write_b32 a69, 0
    v_accvgpr_write_b32 a70, 0
    v_accvgpr_write_b32 a71, 0
    v_accvgpr_write_b32 a72, 0
    v_accvgpr_write_b32 a73, 0
    v_accvgpr_write_b32 a74, 0
    v_accvgpr_write_b32 a75, 0
    v_accvgpr_write_b32 a76, 0
    v_accvgpr_write_b32 a77, 0
    v_accvgpr_write_b32 a78, 0
    v_accvgpr_write_b32 a79, 0
    v_accvgpr_write_b32 a80, 0
    v_accvgpr_write_b32 a81, 0
    v_accvgpr_write_b32 a82, 0
    v_accvgpr_write_b32 a83, 0
    v_accvgpr_write_b32 a84, 0
    v_accvgpr_write_b32 a85, 0
    v_accvgpr_write_b32 a86, 0
    v_accvgpr_write_b32 a87, 0
    v_accvgpr_write_b32 a88, 0
    v_accvgpr_write_b32 a89, 0
    v_accvgpr_write_b32 a90, 0
    v_accvgpr_write_b32 a91, 0
    v_accvgpr_write_b32 a92, 0
    v_accvgpr_write_b32 a93, 0
    v_accvgpr_write_b32 a94, 0
    v_accvgpr_write_b32 a95, 0
    v_accvgpr_write_b32 a96, 0
    v_accvgpr_write_b32 a97, 0
    v_accvgpr_write_b32 a98, 0
    v_accvgpr_write_b32 a99, 0
    v_accvgpr_write_b32 a100, 0
    v_accvgpr_write_b32 a101, 0
    v_accvgpr_write_b32 a102, 0
    v_accvgpr_write_b32 a103, 0
    v_accvgpr_write_b32 a104, 0
    v_accvgpr_write_b32 a105, 0
    v_accvgpr_write_b32 a106, 0
    v_accvgpr_write_b32 a107, 0
    v_accvgpr_write_b32 a108, 0
    v_accvgpr_write_b32 a109, 0
    v_accvgpr_write_b32 a110, 0
    v_accvgpr_write_b32 a111, 0
    v_accvgpr_write_b32 a112, 0
    v_accvgpr_write_b32 a113, 0
    v_accvgpr_write_b32 a114, 0
    v_accvgpr_write_b32 a115, 0
    v_accvgpr_write_b32 a116, 0
    v_accvgpr_write_b32 a117, 0
    v_accvgpr_write_b32 a118, 0
    v_accvgpr_write_b32 a119, 0
    v_accvgpr_write_b32 a120, 0
    v_accvgpr_write_b32 a121, 0
    v_accvgpr_write_b32 a122, 0
    v_accvgpr_write_b32 a123, 0
    v_accvgpr_write_b32 a124, 0
    v_accvgpr_write_b32 a125, 0
    v_accvgpr_write_b32 a126, 0
    v_accvgpr_write_b32 a127, 0
    v_accvgpr_write_b32 a128, 0
    v_accvgpr_write_b32 a129, 0
    v_accvgpr_write_b32 a130, 0
    v_accvgpr_write_b32 a131, 0
    v_accvgpr_write_b32 a132, 0
    v_accvgpr_write_b32 a133, 0
    v_accvgpr_write_b32 a134, 0
    v_accvgpr_write_b32 a135, 0
    v_accvgpr_write_b32 a136, 0
    v_accvgpr_write_b32 a137, 0
    v_accvgpr_write_b32 a138, 0
    v_accvgpr_write_b32 a139, 0
    v_accvgpr_write_b32 a140, 0
    v_accvgpr_write_b32 a141, 0
    v_accvgpr_write_b32 a142, 0
    v_accvgpr_write_b32 a143, 0
    v_accvgpr_write_b32 a144, 0
    v_accvgpr_write_b32 a145, 0
    v_accvgpr_write_b32 a146, 0
    v_accvgpr_write_b32 a147, 0
    v_accvgpr_write_b32 a148, 0
    v_accvgpr_write_b32 a149, 0
    v_accvgpr_write_b32 a150, 0
    v_accvgpr_write_b32 a151, 0
    v_accvgpr_write_b32 a152, 0
    v_accvgpr_write_b32 a153, 0
    v_accvgpr_write_b32 a154, 0
    v_accvgpr_write_b32 a155, 0
    v_accvgpr_write_b32 a156, 0
    v_accvgpr_write_b32 a157, 0
    v_accvgpr_write_b32 a158, 0
    v_accvgpr_write_b32 a159, 0
    v_accvgpr_write_b32 a160, 0
    v_accvgpr_write_b32 a161, 0
    v_accvgpr_write_b32 a162, 0
    v_accvgpr_write_b32 a163, 0
    v_accvgpr_write_b32 a164, 0
    v_accvgpr_write_b32 a165, 0
    v_accvgpr_write_b32 a166, 0
    v_accvgpr_write_b32 a167, 0
    v_accvgpr_write_b32 a168, 0
    v_accvgpr_write_b32 a169, 0
    v_accvgpr_write_b32 a170, 0
    v_accvgpr_write_b32 a171, 0
    v_accvgpr_write_b32 a172, 0
    v_accvgpr_write_b32 a173, 0
    v_accvgpr_write_b32 a174, 0
    v_accvgpr_write_b32 a175, 0
    v_accvgpr_write_b32 a176, 0
    v_accvgpr_write_b32 a177, 0
    v_accvgpr_write_b32 a178, 0
    v_accvgpr_write_b32 a179, 0
    v_accvgpr_write_b32 a180, 0
    v_accvgpr_write_b32 a181, 0
    v_accvgpr_write_b32 a182, 0
    v_accvgpr_write_b32 a183, 0
    v_accvgpr_write_b32 a184, 0
    v_accvgpr_write_b32 a185, 0
    v_accvgpr_write_b32 a186, 0
    v_accvgpr_write_b32 a187, 0
    v_accvgpr_write_b32 a188, 0
    v_accvgpr_write_b32 a189, 0
    v_accvgpr_write_b32 a190, 0
    v_accvgpr_write_b32 a191, 0
    v_accvgpr_write_b32 a192, 0
    v_accvgpr_write_b32 a193, 0
    v_accvgpr_write_b32 a194, 0
    v_accvgpr_write_b32 a195, 0
    v_accvgpr_write_b32 a196, 0
    v_accvgpr_write_b32 a197, 0
    v_accvgpr_write_b32 a198, 0
    v_accvgpr_write_b32 a199, 0
    v_accvgpr_write_b32 a200, 0
    v_accvgpr_write_b32 a201, 0
    v_accvgpr_write_b32 a202, 0
    v_accvgpr_write_b32 a203, 0
    v_accvgpr_write_b32 a204, 0
    v_accvgpr_write_b32 a205, 0
    v_accvgpr_write_b32 a206, 0
    v_accvgpr_write_b32 a207, 0
    v_accvgpr_write_b32 a208, 0
    v_accvgpr_write_b32 a209, 0
    v_accvgpr_write_b32 a210, 0
    v_accvgpr_write_b32 a211, 0
    v_accvgpr_write_b32 a212, 0
    v_accvgpr_write_b32 a213, 0
    v_accvgpr_write_b32 a214, 0
    v_accvgpr_write_b32 a215, 0
    v_accvgpr_write_b32 a216, 0
    v_accvgpr_write_b32 a217, 0
    v_accvgpr_write_b32 a218, 0
    v_accvgpr_write_b32 a219, 0
    v_accvgpr_write_b32 a220, 0
    v_accvgpr_write_b32 a221, 0
    v_accvgpr_write_b32 a222, 0
    v_accvgpr_write_b32 a223, 0
    v_accvgpr_write_b32 a224, 0
    v_accvgpr_write_b32 a225, 0
    v_accvgpr_write_b32 a226, 0
    v_accvgpr_write_b32 a227, 0
    v_accvgpr_write_b32 a228, 0
    v_accvgpr_write_b32 a229, 0
    v_accvgpr_write_b32 a230, 0
    v_accvgpr_write_b32 a231, 0
    v_accvgpr_write_b32 a232, 0
    v_accvgpr_write_b32 a233, 0
    v_accvgpr_write_b32 a234, 0
    v_accvgpr_write_b32 a235, 0
    v_accvgpr_write_b32 a236, 0
    v_accvgpr_write_b32 a237, 0
    v_accvgpr_write_b32 a238, 0
    v_accvgpr_write_b32 a239, 0
    v_accvgpr_write_b32 a240, 0
    v_accvgpr_write_b32 a241, 0
    v_accvgpr_write_b32 a242, 0
    v_accvgpr_write_b32 a243, 0
    v_accvgpr_write_b32 a244, 0
    v_accvgpr_write_b32 a245, 0
    v_accvgpr_write_b32 a246, 0
    v_accvgpr_write_b32 a247, 0
    v_accvgpr_write_b32 a248, 0
    v_accvgpr_write_b32 a249, 0
    v_accvgpr_write_b32 a250, 0
    v_accvgpr_write_b32 a251, 0
    v_accvgpr_write_b32 a252, 0
    v_accvgpr_write_b32 a253, 0
    v_accvgpr_write_b32 a254, 0
    v_accvgpr_write_b32 a255, 0
    s_cmp_ge_u32 s2, 6
    s_cbranch_scc1 k1_nostat_2
    v_mov_b32 v124, 0
    v_mov_b32 v125, 0
    v_mov_b32 v126, 0
    v_mov_b32 v127, 0
    s_lshl_b32 s47, s2, 12
    v_lshlrev_b32 v3, 4, v0
    buffer_store_dwordx4 v[124:127], v3, s[36:39], s47 offen
k1_nostat_2:
    s_waitcnt vmcnt(0)
    v_lshlrev_b32 v56, 16, v40
    v_and_b32 v57, 0xffff0000, v40
    v_lshlrev_b32 v58, 16, v41
    v_and_b32 v59, 0xffff0000, v41
    v_lshlrev_b32 v60, 16, v42
    v_and_b32 v61, 0xffff0000, v42
    v_lshlrev_b32 v62, 16, v43
    v_and_b32 v63, 0xffff0000, v43
    v_lshlrev_b32 v64, 16, v44
    v_and_b32 v65, 0xffff0000, v44
    v_lshlrev_b32 v66, 16, v45
    v_and_b32 v67, 0xffff0000, v45
    v_lshlrev_b32 v68, 16, v46
    v_and_b32 v69, 0xffff0000, v46
    v_lshlrev_b32 v70, 16, v47
    v_and_b32 v71, 0xffff0000, v47
    v_lshlrev_b32 v72, 16, v48
    v_and_b32 v73, 0xffff0000, v48
    v_lshlrev_b32 v74, 16, v49
    v_and_b32 v75, 0xffff0000, v49
    v_lshlrev_b32 v76, 16, v50
    v_and_b32 v77, 0xffff0000, v50
    v_lshlrev_b32 v78, 16, v51
    v_and_b32 v79, 0xffff0000, v51
    v_lshlrev_b32 v80, 16, v52
    v_and_b32 v81, 0xffff0000, v52
    v_lshlrev_b32 v82, 16, v53
    v_and_b32 v83, 0xffff0000, v53
    v_lshlrev_b32 v84, 16, v54
    v_and_b32 v85, 0xffff0000, v54
    v_lshlrev_b32 v86, 16, v55
    v_and_b32 v87, 0xffff0000, v55
    v_pk_add_f32 v[88:89], v[56:57], v[58:59]
    v_pk_add_f32 v[90:91], v[60:61], v[62:63]
    v_pk_add_f32 v[88:89], v[88:89], v[64:65]
    v_pk_add_f32 v[90:91], v[90:91], v[66:67]
    v_pk_add_f32 v[88:89], v[88:89], v[68:69]
    v_pk_add_f32 v[90:91], v[90:91], v[70:71]
    v_pk_add_f32 v[88:89], v[88:89], v[72:73]
    v_pk_add_f32 v[90:91], v[90:91], v[74:75]
    v_pk_add_f32 v[88:89], v[88:89], v[76:77]
    v_pk_add_f32 v[90:91], v[90:91], v[78:79]
    v_pk_add_f32 v[88:89], v[88:89], v[80:81]
    v_pk_add_f32 v[90:91], v[90:91], v[82:83]
    v_pk_add_f32 v[88:89], v[88:89], v[84:85]
    v_pk_add_f32 v[90:91], v[90:91], v[86:87]
    v_pk_add_f32 v[88:89], v[88:89], v[90:91]
    v_add_f32 v88, v88, v89
    s_nop 1
    v_add_f32_dpp v88, v88, v88 quad_perm:[1,0,3,2] row_mask:0xf bank_mask:0xf
    s_nop 1
    v_add_f32_dpp v88, v88, v88 quad_perm:[2,3,0,1] row_mask:0xf bank_mask:0xf
    s_nop 1
    v_add_f32_dpp v88, v88, v88 row_half_mirror row_mask:0xf bank_mask:0xf
    s_nop 1
    v_add_f32_dpp v88, v88, v88 row_mirror row_mask:0xf bank_mask:0xf
    v_mov_b32 v90, v88
    s_nop 1
    v_permlane16_swap_b32 v88, v90
    s_nop 1
    v_add_f32 v88, v88, v90
    v_mul_f32 v88, 0xba800000, v88
    v_mov_b32 v89, v88
    v_pk_add_f32 v[90:91], v[56:57], v[88:89]
    v_pk_add_f32 v[94:95], v[58:59], v[88:89]
    v_pk_mul_f32 v[92:93], v[90:91], v[90:91]
    v_pk_fma_f32 v[92:93], v[94:95], v[94:95], v[92:93]
    v_pk_add_f32 v[90:91], v[60:61], v[88:89]
    v_pk_add_f32 v[94:95], v[62:63], v[88:89]
    v_pk_fma_f32 v[92:93], v[90:91], v[90:91], v[92:93]
    v_pk_fma_f32 v[92:93], v[94:95], v[94:95], v[92:93]
    v_pk_add_f32 v[90:91], v[64:65], v[88:89]
    v_pk_add_f32 v[94:95], v[66:67], v[88:89]
    v_pk_fma_f32 v[92:93], v[90:91], v[90:91], v[92:93]
    v_pk_fma_f32 v[92:93], v[94:95], v[94:95], v[92:93]
    v_pk_add_f32 v[90:91], v[68:69], v[88:89]
    v_pk_add_f32 v[94:95], v[70:71], v[88:89]
    v_pk_fma_f32 v[92:93], v[90:91], v[90:91], v[92:93]
    v_pk_fma_f32 v[92:93], v[94:95], v[94:95], v[92:93]
    v_pk_add_f32 v[90:91], v[72:73], v[88:89]
    v_pk_add_f32 v[94:95], v[74:75], v[88:89]
    v_pk_fma_f32 v[92:93], v[90:91], v[90:91], v[92:93]
    v_pk_fma_f32 v[92:93], v[94:95], v[94:95], v[92:93]
    v_pk_add_f32 v[90:91], v[76:77], v[88:89]
    v_pk_add_f32 v[94:95], v[78:79], v[88:89]
    v_pk_fma_f32 v[92:93], v[90:91], v[90:91], v[92:93]
    v_pk_fma_f32 v[92:93], v[94:95], v[94:95], v[92:93]
    v_pk_add_f32 v[90:91], v[80:81], v[88:89]
    v_pk_add_f32 v[94:95], v[82:83], v[88:89]
    v_pk_fma_f32 v[92:93], v[90:91], v[90:91], v[92:93]
    v_pk_fma_f32 v[92:93], v[94:95], v[94:95], v[92:93]
    v_pk_add_f32 v[90:91], v[84:85], v[88:89]
    v_pk_add_f32 v[94:95], v[86:87], v[88:89]
    v_pk_fma_f32 v[92:93], v[90:91], v[90:91], v[92:93]
    v_pk_fma_f32 v[92:93], v[94:95], v[94:95], v[92:93]
    v_add_f32 v92, v92, v93
    s_nop 1
    v_add_f32_dpp v92, v92, v92 quad_perm:[1,0,3,2] row_mask:0xf bank_mask:0xf
    s_nop 1
    v_add_f32_dpp v92, v92, v92 quad_perm:[2,3,0,1] row_mask:0xf bank_mask:0xf
    s_nop 1
    v_add_f32_dpp v92, v92, v92 row_half_mirror row_mask:0xf bank_mask:0xf
    s_nop 1
    v_add_f32_dpp v92, v92, v92 row_mirror row_mask:0xf bank_mask:0xf
    v_mov_b32 v90, v92
    s_nop 1
    v_permlane16_swap_b32 v92, v90
    s_nop 1
    v_add_f32 v92, v92, v90
    v_mul_f32 v92, 0x3a800000, v92
    v_cvt_pk_bf16_f32 v94, v88, v92
    v_and_b32 v92, 0xffff0000, v94
    v_lshlrev_b32 v94, 16, v94
    v_add_f32 v92, 0x3727c5ac, v92
    v_mov_b32 v95, v94
    v_cvt_pk_bf16_f32 v92, v92, v92
    v_and_b32 v92, 0xffff0000, v92
    v_sqrt_f32 v92, v92
    v_pk_add_f32 v[56:57], v[56:57], v[94:95]
    v_pk_add_f32 v[58:59], v[58:59], v[94:95]
    v_pk_add_f32 v[60:61], v[60:61], v[94:95]
    v_pk_add_f32 v[62:63], v[62:63], v[94:95]
    v_pk_add_f32 v[64:65], v[64:65], v[94:95]
    v_pk_add_f32 v[66:67], v[66:67], v[94:95]
    v_pk_add_f32 v[68:69], v[68:69], v[94:95]
    v_pk_add_f32 v[70:71], v[70:71], v[94:95]
    v_pk_add_f32 v[72:73], v[72:73], v[94:95]
    v_pk_add_f32 v[74:75], v[74:75], v[94:95]
    v_pk_add_f32 v[76:77], v[76:77], v[94:95]
    v_pk_add_f32 v[78:79], v[78:79], v[94:95]
    v_pk_add_f32 v[80:81], v[80:81], v[94:95]
    v_pk_add_f32 v[82:83], v[82:83], v[94:95]
    v_pk_add_f32 v[84:85], v[84:85], v[94:95]
    v_pk_add_f32 v[86:87], v[86:87], v[94:95]
    v_cvt_pk_bf16_f32 v92, v92, v92
    v_and_b32 v92, 0xffff0000, v92
    v_rcp_f32 v92, v92
    v_cvt_pk_bf16_f32 v40, v56, v57
    v_cvt_pk_bf16_f32 v41, v58, v59
    v_cvt_pk_bf16_f32 v42, v60, v61
    v_cvt_pk_bf16_f32 v43, v62, v63
    v_cvt_pk_bf16_f32 v44, v64, v65
    v_cvt_pk_bf16_f32 v45, v66, v67
    v_cvt_pk_bf16_f32 v46, v68, v69
    v_cvt_pk_bf16_f32 v47, v70, v71
    v_cvt_pk_bf16_f32 v48, v72, v73
    v_cvt_pk_bf16_f32 v49, v74, v75
    v_cvt_pk_bf16_f32 v50, v76, v77
    v_cvt_pk_bf16_f32 v51, v78, v79
    v_cvt_pk_bf16_f32 v52, v80, v81
    v_cvt_pk_bf16_f32 v53, v82, v83
    v_cvt_pk_bf16_f32 v54, v84, v85
    v_cvt_pk_bf16_f32 v55, v86, v87
    v_mov_b32 v93, v92
    v_lshlrev_b32 v56, 16, v40
    v_and_b32 v57, 0xffff0000, v40
    v_lshlrev_b32 v58, 16, v41
    v_and_b32 v59, 0xffff0000, v41
    v_lshlrev_b32 v60, 16, v42
    v_and_b32 v61, 0xffff0000, v42
    v_lshlrev_b32 v62, 16, v43
    v_and_b32 v63, 0xffff0000, v43
    v_lshlrev_b32 v64, 16, v44
    v_and_b32 v65, 0xffff0000, v44
    v_lshlrev_b32 v66, 16, v45
    v_and_b32 v67, 0xffff0000, v45
    v_lshlrev_b32 v68, 16, v46
    v_and_b32 v69, 0xffff0000, v46
    v_lshlrev_b32 v70, 16, v47
    v_and_b32 v71, 0xffff0000, v47
    v_lshlrev_b32 v72, 16, v48
    v_and_b32 v73, 0xffff0000, v48
    v_lshlrev_b32 v74, 16, v49
    v_and_b32 v75, 0xffff0000, v49
    v_lshlrev_b32 v76, 16, v50
    v_and_b32 v77, 0xffff0000, v50
    v_lshlrev_b32 v78, 16, v51
    v_and_b32 v79, 0xffff0000, v51
    v_lshlrev_b32 v80, 16, v52
    v_and_b32 v81, 0xffff0000, v52
    v_lshlrev_b32 v82, 16, v53
    v_and_b32 v83, 0xffff0000, v53
    v_lshlrev_b32 v84, 16, v54
    v_and_b32 v85, 0xffff0000, v54
    v_lshlrev_b32 v86, 16, v55
    v_and_b32 v87, 0xffff0000, v55
    v_pk_mul_f32 v[56:57], v[56:57], v[92:93]
    v_pk_mul_f32 v[58:59], v[58:59], v[92:93]
    v_pk_mul_f32 v[60:61], v[60:61], v[92:93]
    v_pk_mul_f32 v[62:63], v[62:63], v[92:93]
    v_pk_mul_f32 v[64:65], v[64:65], v[92:93]
    v_pk_mul_f32 v[66:67], v[66:67], v[92:93]
    v_pk_mul_f32 v[68:69], v[68:69], v[92:93]
    v_pk_mul_f32 v[70:71], v[70:71], v[92:93]
    v_pk_mul_f32 v[72:73], v[72:73], v[92:93]
    v_pk_mul_f32 v[74:75], v[74:75], v[92:93]
    v_pk_mul_f32 v[76:77], v[76:77], v[92:93]
    v_pk_mul_f32 v[78:79], v[78:79], v[92:93]
    v_pk_mul_f32 v[80:81], v[80:81], v[92:93]
    v_pk_mul_f32 v[82:83], v[82:83], v[92:93]
    v_pk_mul_f32 v[84:85], v[84:85], v[92:93]
    v_pk_mul_f32 v[86:87], v[86:87], v[92:93]
    v_cvt_pk_bf16_f32 v40, v56, v57
    v_cvt_pk_bf16_f32 v41, v58, v59
    v_cvt_pk_bf16_f32 v42, v60, v61
    v_cvt_pk_bf16_f32 v43, v62, v63
    v_cvt_pk_bf16_f32 v44, v64, v65
    v_cvt_pk_bf16_f32 v45, v66, v67
    v_cvt_pk_bf16_f32 v46, v68, v69
    v_cvt_pk_bf16_f32 v47, v70, v71
    v_cvt_pk_bf16_f32 v48, v72, v73
    v_cvt_pk_bf16_f32 v49, v74, v75
    v_cvt_pk_bf16_f32 v50, v76, v77
    v_cvt_pk_bf16_f32 v51, v78, v79
    v_cvt_pk_bf16_f32 v52, v80, v81
    v_cvt_pk_bf16_f32 v53, v82, v83
    v_cvt_pk_bf16_f32 v54, v84, v85
    v_cvt_pk_bf16_f32 v55, v86, v87
    v_add_u32 v27, 0, v26
    buffer_store_dwordx4 v[40:43], v27, s[28:31], 0 offen
    v_add_u32 v27, 1048576, v26
    buffer_store_dwordx4 v[44:47], v27, s[28:31], 0 offen
    v_add_u32 v27, 2097152, v26
    buffer_store_dwordx4 v[48:51], v27, s[28:31], 0 offen
    v_add_u32 v27, 3145728, v26
    buffer_store_dwordx4 v[52:55], v27, s[28:31], 0 offen
    s_barrier
    ds_read_b128 v[128:131], v28 offset:0
    ds_read_b64_tr_b16 v[160:161], v30 offset:0
    ds_read_b64_tr_b16 v[162:163], v30 offset:2048
    ds_read_b128 v[132:135], v28 offset:2048
    ds_read_b64_tr_b16 v[164:165], v31 offset:0
    ds_read_b64_tr_b16 v[166:167], v31 offset:2048
    ds_read_b128 v[136:139], v28 offset:4096
    ds_read_b64_tr_b16 v[168:169], v32 offset:0
    ds_read_b64_tr_b16 v[170:171], v32 offset:2048
    ds_read_b128 v[140:143], v28 offset:6144
    ds_read_b64_tr_b16 v[172:173], v33 offset:0
    ds_read_b64_tr_b16 v[174:175], v33 offset:2048
    ds_read_b128 v[144:147], v28 offset:8192
    ds_read_b64_tr_b16 v[176:177], v34 offset:0
    ds_read_b64_tr_b16 v[178:179], v34 offset:2048
    ds_read_b128 v[148:151], v28 offset:10240
    ds_read_b64_tr_b16 v[180:181], v35 offset:0
    ds_read_b64_tr_b16 v[182:183], v35 offset:2048
    ds_read_b128 v[152:155], v28 offset:12288
    ds_read_b64_tr_b16 v[184:185], v36 offset:0
    ds_read_b64_tr_b16 v[186:187], v36 offset:2048
    ds_read_b128 v[156:159], v28 offset:14336
    ds_read_b64_tr_b16 v[188:189], v37 offset:0
    ds_read_b64_tr_b16 v[190:191], v37 offset:2048
    s_mov_b32 s51, 0
    s_cmp_lg_u32 s43, 0
    s_cbranch_scc1 k1_v_3
k1_loop_4:
    s_waitcnt lgkmcnt(0)
    v_mfma_f32_16x16x32_bf16 a[0:3], v[160:163], v[128:131], a[0:3]
    ds_read_b128 v[192:195], v29 offset:0
    v_mfma_f32_16x16x32_bf16 a[4:7], v[160:163], v[132:135], a[4:7]
    ds_read_b64_tr_b16 v[224:225], v30 offset:16384
    v_mfma_f32_16x16x32_bf16 a[8:11], v[160:163], v[136:139], a[8:11]
    v_mfma_f32_16x16x32_bf16 a[12:15], v[160:163], v[140:143], a[12:15]
    ds_read_b64_tr_b16 v[226:227], v30 offset:18432
    v_mfma_f32_16x16x32_bf16 a[16:19], v[160:163], v[144:147], a[16:19]
    v_mfma_f32_16x16x32_bf16 a[20:23], v[160:163], v[148:151], a[20:23]
    ds_read_b128 v[196:199], v29 offset:2048
    v_mfma_f32_16x16x32_bf16 a[24:27], v[160:163], v[152:155], a[24:27]
    ds_read_b64_tr_b16 v[228:229], v31 offset:16384
    v_mfma_f32_16x16x32_bf16 a[28:31], v[160:163], v[156:159], a[28:31]
    v_mfma_f32_16x16x32_bf16 a[32:35], v[164:167], v[128:131], a[32:35]
    ds_read_b64_tr_b16 v[230:231], v31 offset:18432
    v_mfma_f32_16x16x32_bf16 a[36:39], v[164:167], v[132:135], a[36:39]
    v_mfma_f32_16x16x32_bf16 a[40:43], v[164:167], v[136:139], a[40:43]
    ds_read_b128 v[200:203], v29 offset:4096
    v_mfma_f32_16x16x32_bf16 a[44:47], v[164:167], v[140:143], a[44:47]
    ds_read_b64_tr_b16 v[232:233], v32 offset:16384
    v_mfma_f32_16x16x32_bf16 a[48:51], v[164:167], v[144:147], a[48:51]
    v_mfma_f32_16x16x32_bf16 a[52:55], v[164:167], v[148:151], a[52:55]
    ds_read_b64_tr_b16 v[234:235], v32 offset:18432
    v_mfma_f32_16x16x32_bf16 a[56:59], v[164:167], v[152:155], a[56:59]
    v_mfma_f32_16x16x32_bf16 a[60:63], v[164:167], v[156:159], a[60:63]
    ds_read_b128 v[204:207], v29 offset:6144
    v_mfma_f32_16x16x32_bf16 a[64:67], v[168:171], v[128:131], a[64:67]
    ds_read_b64_tr_b16 v[236:237], v33 offset:16384
    v_mfma_f32_16x16x32_bf16 a[68:71], v[168:171], v[132:135], a[68:71]
    v_mfma_f32_16x16x32_bf16 a[72:75], v[168:171], v[136:139], a[72:75]
    ds_read_b64_tr_b16 v[238:239], v33 offset:18432
    v_mfma_f32_16x16x32_bf16 a[76:79], v[168:171], v[140:143], a[76:79]
    v_mfma_f32_16x16x32_bf16 a[80:83], v[168:171], v[144:147], a[80:83]
    ds_read_b128 v[208:211], v29 offset:8192
    v_mfma_f32_16x16x32_bf16 a[84:87], v[168:171], v[148:151], a[84:87]
    ds_read_b64_tr_b16 v[240:241], v34 offset:16384
    v_mfma_f32_16x16x32_bf16 a[88:91], v[168:171], v[152:155], a[88:91]
    v_mfma_f32_16x16x32_bf16 a[92:95], v[168:171], v[156:159], a[92:95]
    ds_read_b64_tr_b16 v[242:243], v34 offset:18432
    v_mfma_f32_16x16x32_bf16 a[96:99], v[172:175], v[128:131], a[96:99]
    v_mfma_f32_16x16x32_bf16 a[100:103], v[172:175], v[132:135], a[100:103]
    ds_read_b128 v[212:215], v29 offset:10240
    v_mfma_f32_16x16x32_bf16 a[104:107], v[172:175], v[136:139], a[104:107]
    ds_read_b64_tr_b16 v[244:245], v35 offset:16384
    v_mfma_f32_16x16x32_bf16 a[108:111], v[172:175], v[140:143], a[108:111]
    v_mfma_f32_16x16x32_bf16 a[112:115], v[172:175], v[144:147], a[112:115]
    ds_read_b64_tr_b16 v[246:247], v35 offset:18432
    v_mfma_f32_16x16x32_bf16 a[116:119], v[172:175], v[148:151], a[116:119]
    v_mfma_f32_16x16x32_bf16 a[120:123], v[172:175], v[152:155], a[120:123]
    ds_read_b128 v[216:219], v29 offset:12288
    v_mfma_f32_16x16x32_bf16 a[124:127], v[172:175], v[156:159], a[124:127]
    ds_read_b64_tr_b16 v[248:249], v36 offset:16384
    v_mfma_f32_16x16x32_bf16 a[128:131], v[176:179], v[128:131], a[128:131]
    v_mfma_f32_16x16x32_bf16 a[132:135], v[176:179], v[132:135], a[132:135]
    ds_read_b64_tr_b16 v[250:251], v36 offset:18432
    v_mfma_f32_16x16x32_bf16 a[136:139], v[176:179], v[136:139], a[136:139]
    v_mfma_f32_16x16x32_bf16 a[140:143], v[176:179], v[140:143], a[140:143]
    ds_read_b128 v[220:223], v29 offset:14336
    v_mfma_f32_16x16x32_bf16 a[144:147], v[176:179], v[144:147], a[144:147]
    ds_read_b64_tr_b16 v[252:253], v37 offset:16384
    v_mfma_f32_16x16x32_bf16 a[148:151], v[176:179], v[148:151], a[148:151]
    v_mfma_f32_16x16x32_bf16 a[152:155], v[176:179], v[152:155], a[152:155]
    ds_read_b64_tr_b16 v[254:255], v37 offset:18432
    v_mfma_f32_16x16x32_bf16 a[156:159], v[176:179], v[156:159], a[156:159]
    v_mfma_f32_16x16x32_bf16 a[160:163], v[180:183], v[128:131], a[160:163]
    v_mfma_f32_16x16x32_bf16 a[164:167], v[180:183], v[132:135], a[164:167]
    v_mfma_f32_16x16x32_bf16 a[168:171], v[180:183], v[136:139], a[168:171]
    v_mfma_f32_16x16x32_bf16 a[172:175], v[180:183], v[140:143], a[172:175]
    v_mfma_f32_16x16x32_bf16 a[176:179], v[180:183], v[144:147], a[176:179]
    v_mfma_f32_16x16x32_bf16 a[180:183], v[180:183], v[148:151], a[180:183]
    v_mfma_f32_16x16x32_bf16 a[184:187], v[180:183], v[152:155], a[184:187]
    v_mfma_f32_16x16x32_bf16 a[188:191], v[180:183], v[156:159], a[188:191]
    v_mfma_f32_16x16x32_bf16 a[192:195], v[184:187], v[128:131], a[192:195]
    v_mfma_f32_16x16x32_bf16 a[196:199], v[184:187], v[132:135], a[196:199]
    v_mfma_f32_16x16x32_bf16 a[200:203], v[184:187], v[136:139], a[200:203]
    v_mfma_f32_16x16x32_bf16 a[204:207], v[184:187], v[140:143], a[204:207]
    v_mfma_f32_16x16x32_bf16 a[208:211], v[184:187], v[144:147], a[208:211]
    v_mfma_f32_16x16x32_bf16 a[212:215], v[184:187], v[148:151], a[212:215]
    v_mfma_f32_16x16x32_bf16 a[216:219], v[184:187], v[152:155], a[216:219]
    v_mfma_f32_16x16x32_bf16 a[220:223], v[184:187], v[156:159], a[220:223]
    v_mfma_f32_16x16x32_bf16 a[224:227], v[188:191], v[128:131], a[224:227]
    v_mfma_f32_16x16x32_bf16 a[228:231], v[188:191], v[132:135], a[228:231]
    v_mfma_f32_16x16x32_bf16 a[232:235], v[188:191], v[136:139], a[232:235]
    v_mfma_f32_16x16x32_bf16 a[236:239], v[188:191], v[140:143], a[236:239]
    v_mfma_f32_16x16x32_bf16 a[240:243], v[188:191], v[144:147], a[240:243]
    v_mfma_f32_16x16x32_bf16 a[244:247], v[188:191], v[148:151], a[244:247]
    v_mfma_f32_16x16x32_bf16 a[248:251], v[188:191], v[152:155], a[248:251]
    v_mfma_f32_16x16x32_bf16 a[252:255], v[188:191], v[156:159], a[252:255]
    s_waitcnt vmcnt(0) lgkmcnt(0)
    s_barrier
    s_cmp_ge_u32 s49, 1024
    s_cselect_b32 s18, 0, s18
    s_cselect_b32 s22, 0, s22
    v_mfma_f32_16x16x32_bf16 a[0:3], v[224:227], v[192:195], a[0:3]
    ds_read_b128 v[128:131], v28 offset:32768
    v_mfma_f32_16x16x32_bf16 a[4:7], v[224:227], v[196:199], a[4:7]
    ds_read_b64_tr_b16 v[160:161], v30 offset:32768
    v_mfma_f32_16x16x32_bf16 a[8:11], v[224:227], v[200:203], a[8:11]
    s_add_u32 m0, s48, 0
    s_nop 0
    buffer_load_dwordx4 v10, s[16:19], s49 offen offset:0 lds
    v_mfma_f32_16x16x32_bf16 a[12:15], v[224:227], v[204:207], a[12:15]
    ds_read_b64_tr_b16 v[162:163], v30 offset:34816
    v_mfma_f32_16x16x32_bf16 a[16:19], v[224:227], v[208:211], a[16:19]
    buffer_load_dwordx4 v11, s[16:19], s49 offen offset:1024 lds
    v_mfma_f32_16x16x32_bf16 a[20:23], v[224:227], v[212:215], a[20:23]
    ds_read_b128 v[132:135], v28 offset:34816
    v_mfma_f32_16x16x32_bf16 a[24:27], v[224:227], v[216:219], a[24:27]
    ds_read_b64_tr_b16 v[164:165], v31 offset:32768
    v_mfma_f32_16x16x32_bf16 a[28:31], v[224:227], v[220:223], a[28:31]
    buffer_load_dwordx4 v12, s[16:19], s49 offen offset:2048 lds
    v_mfma_f32_16x16x32_bf16 a[32:35], v[228:231], v[192:195], a[32:35]
    ds_read_b64_tr_b16 v[166:167], v31 offset:34816
    v_mfma_f32_16x16x32_bf16 a[36:39], v[228:231], v[196:199], a[36:39]
    v_mfma_f32_16x16x32_bf16 a[40:43], v[228:231], v[200:203], a[40:43]
    ds_read_b128 v[136:139], v28 offset:36864
    buffer_load_dwordx4 v13, s[16:19], s49 offen offset:3072 lds
    v_mfma_f32_16x16x32_bf16 a[44:47], v[228:231], v[204:207], a[44:47]
    ds_read_b64_tr_b16 v[168:169], v32 offset:32768
    v_mfma_f32_16x16x32_bf16 a[48:51], v[228:231], v[208:211], a[48:51]
    v_mfma_f32_16x16x32_bf16 a[52:55], v[228:231], v[212:215], a[52:55]
    ds_read_b64_tr_b16 v[170:171], v32 offset:34816
    s_add_u32 m0, s48, 4096
    s_nop 0
    buffer_load_dwordx4 v14, s[16:19], s49 offen offset:0 lds
    v_mfma_f32_16x16x32_bf16 a[56:59], v[228:231], v[216:219], a[56:59]
    v_mfma_f32_16x16x32_bf16 a[60:63], v[228:231], v[220:223], a[60:63]
    ds_read_b128 v[140:143], v28 offset:38912
    v_mfma_f32_16x16x32_bf16 a[64:67], v[232:235], v[192:195], a[64:67]
    ds_read_b64_tr_b16 v[172:173], v33 offset:32768
    buffer_load_dwordx4 v15, s[16:19], s49 offen offset:1024 lds
    v_mfma_f32_16x16x32_bf16 a[68:71], v[232:235], v[196:199], a[68:71]
    v_mfma_f32_16x16x32_bf16 a[72:75], v[232:235], v[200:203], a[72:75]
    ds_read_b64_tr_b16 v[174:175], v33 offset:34816
    buffer_load_dwordx4 v16, s[16:19], s49 offen offset:2048 lds
    v_mfma_f32_16x16x32_bf16 a[76:79], v[232:235], v[204:207], a[76:79]
    v_mfma_f32_16x16x32_bf16 a[80:83], v[232:235], v[208:211], a[80:83]
    ds_read_b128 v[144:147], v28 offset:40960
    v_mfma_f32_16x16x32_bf16 a[84:87], v[232:235], v[212:215], a[84:87]
    ds_read_b64_tr_b16 v[176:177], v34 offset:32768
    buffer_load_dwordx4 v17, s[16:19], s49 offen offset:3072 lds
    v_mfma_f32_16x16x32_bf16 a[88:91], v[232:235], v[216:219], a[88:91]
    v_mfma_f32_16x16x32_bf16 a[92:95], v[232:235], v[220:223], a[92:95]
    ds_read_b64_tr_b16 v[178:179], v34 offset:34816
    v_mfma_f32_16x16x32_bf16 a[96:99], v[236:239], v[192:195], a[96:99]
    s_add_u32 m0, s48, 65536
    s_nop 0
    buffer_load_dwordx4 v18, s[20:23], s50 offen offset:0 lds
    v_mfma_f32_16x16x32_bf16 a[100:103], v[236:239], v[196:199], a[100:103]
    ds_read_b128 v[148:151], v28 offset:43008
    v_mfma_f32_16x16x32_bf16 a[104:107], v[236:239], v[200:203], a[104:107]
    ds_read_b64_tr_b16 v[180:181], v35 offset:32768
    v_mfma_f32_16x16x32_bf16 a[108:111], v[236:239], v[204:207], a[108:111]
    buffer_load_dwordx4 v19, s[20:23], s50 offen offset:1024 lds
    v_mfma_f32_16x16x32_bf16 a[112:115], v[236:239], v[208:211], a[112:115]
    ds_read_b64_tr_b16 v[182:183], v35 offset:34816
    v_mfma_f32_16x16x32_bf16 a[116:119], v[236:239], v[212:215], a[116:119]
    v_mfma_f32_16x16x32_bf16 a[120:123], v[236:239], v[216:219], a[120:123]
    ds_read_b128 v[152:155], v28 offset:45056
    buffer_load_dwordx4 v20, s[20:23], s50 offen offset:2048 lds
    v_mfma_f32_16x16x32_bf16 a[124:127], v[236:239], v[220:223], a[124:127]
    ds_read_b64_tr_b16 v[184:185], v36 offset:32768
    v_mfma_f32_16x16x32_bf16 a[128:131], v[240:243], v[192:195], a[128:131]
    v_mfma_f32_16x16x32_bf16 a[132:135], v[240:243], v[196:199], a[132:135]
    ds_read_b64_tr_b16 v[186:187], v36 offset:34816
    buffer_load_dwordx4 v21, s[20:23], s50 offen offset:3072 lds
    v_mfma_f32_16x16x32_bf16 a[136:139], v[240:243], v[200:203], a[136:139]
    v_mfma_f32_16x16x32_bf16 a[140:143], v[240:243], v[204:207], a[140:143]
    ds_read_b128 v[156:159], v28 offset:47104
    s_add_u32 m0, s48, 69632
    s_nop 0
    buffer_load_dwordx4 v22, s[20:23], s50 offen offset:0 lds
    v_mfma_f32_16x16x32_bf16 a[144:147], v[240:243], v[208:211], a[144:147]
    ds_read_b64_tr_b16 v[188:189], v37 offset:32768
    v_mfma_f32_16x16x32_bf16 a[148:151], v[240:243], v[212:215], a[148:151]
    v_mfma_f32_16x16x32_bf16 a[152:155], v[240:243], v[216:219], a[152:155]
    ds_read_b64_tr_b16 v[190:191], v37 offset:34816
    buffer_load_dwordx4 v23, s[20:23], s50 offen offset:1024 lds
    v_mfma_f32_16x16x32_bf16 a[156:159], v[240:243], v[220:223], a[156:159]
    v_mfma_f32_16x16x32_bf16 a[160:163], v[244:247], v[192:195], a[160:163]
    v_mfma_f32_16x16x32_bf16 a[164:167], v[244:247], v[196:199], a[164:167]
    buffer_load_dwordx4 v24, s[20:23], s50 offen offset:2048 lds
    v_mfma_f32_16x16x32_bf16 a[168:171], v[244:247], v[200:203], a[168:171]
    v_mfma_f32_16x16x32_bf16 a[172:175], v[244:247], v[204:207], a[172:175]
    v_mfma_f32_16x16x32_bf16 a[176:179], v[244:247], v[208:211], a[176:179]
    buffer_load_dwordx4 v25, s[20:23], s50 offen offset:3072 lds
    v_mfma_f32_16x16x32_bf16 a[180:183], v[244:247], v[212:215], a[180:183]
    v_mfma_f32_16x16x32_bf16 a[184:187], v[244:247], v[216:219], a[184:187]
    v_mfma_f32_16x16x32_bf16 a[188:191], v[244:247], v[220:223], a[188:191]
    s_add_u32 s49, s49, 128
    s_add_u32 s50, s50, 0x80000
    v_mfma_f32_16x16x32_bf16 a[192:195], v[248:251], v[192:195], a[192:195]
    v_mfma_f32_16x16x32_bf16 a[196:199], v[248:251], v[196:199], a[196:199]
    v_mfma_f32_16x16x32_bf16 a[200:203], v[248:251], v[200:203], a[200:203]
    v_mfma_f32_16x16x32_bf16 a[204:207], v[248:251], v[204:207], a[204:207]
    v_mfma_f32_16x16x32_bf16 a[208:211], v[248:251], v[208:211], a[208:211]
    v_mfma_f32_16x16x32_bf16 a[212:215], v[248:251], v[212:215], a[212:215]
    v_mfma_f32_16x16x32_bf16 a[216:219], v[248:251], v[216:219], a[216:219]
    v_mfma_f32_16x16x32_bf16 a[220:223], v[248:251], v[220:223], a[220:223]
    v_mfma_f32_16x16x32_bf16 a[224:227], v[252:255], v[192:195], a[224:227]
    v_mfma_f32_16x16x32_bf16 a[228:231], v[252:255], v[196:199], a[228:231]
    v_mfma_f32_16x16x32_bf16 a[232:235], v[252:255], v[200:203], a[232:235]
    v_mfma_f32_16x16x32_bf16 a[236:239], v[252:255], v[204:207], a[236:239]
    v_mfma_f32_16x16x32_bf16 a[240:243], v[252:255], v[208:211], a[240:243]
    v_mfma_f32_16x16x32_bf16 a[244:247], v[252:255], v[212:215], a[244:247]
    v_mfma_f32_16x16x32_bf16 a[248:251], v[252:255], v[216:219], a[248:251]
    v_mfma_f32_16x16x32_bf16 a[252:255], v[252:255], v[220:223], a[252:255]
    s_waitcnt lgkmcnt(0)
    v_mfma_f32_16x16x32_bf16 a[0:3], v[160:163], v[128:131], a[0:3]
    ds_read_b128 v[192:195], v29 offset:32768
    v_mfma_f32_16x16x32_bf16 a[4:7], v[160:163], v[132:135], a[4:7]
    ds_read_b64_tr_b16 v[224:225], v30 offset:49152
    v_mfma_f32_16x16x32_bf16 a[8:11], v[160:163], v[136:139], a[8:11]
    v_mfma_f32_16x16x32_bf16 a[12:15], v[160:163], v[140:143], a[12:15]
    ds_read_b64_tr_b16 v[226:227], v30 offset:51200
    v_mfma_f32_16x16x32_bf16 a[16:19], v[160:163], v[144:147], a[16:19]
    v_mfma_f32_16x16x32_bf16 a[20:23], v[160:163], v[148:151], a[20:23]
    ds_read_b128 v[196:199], v29 offset:34816
    v_mfma_f32_16x16x32_bf16 a[24:27], v[160:163], v[152:155], a[24:27]
    ds_read_b64_tr_b16 v[228:229], v31 offset:49152
    v_mfma_f32_16x16x32_bf16 a[28:31], v[160:163], v[156:159], a[28:31]
    v_mfma_f32_16x16x32_bf16 a[32:35], v[164:167], v[128:131], a[32:35]
    ds_read_b64_tr_b16 v[230:231], v31 offset:51200
    v_mfma_f32_16x16x32_bf16 a[36:39], v[164:167], v[132:135], a[36:39]
    v_mfma_f32_16x16x32_bf16 a[40:43], v[164:167], v[136:139], a[40:43]
    ds_read_b128 v[200:203], v29 offset:36864
    v_mfma_f32_16x16x32_bf16 a[44:47], v[164:167], v[140:143], a[44:47]
    ds_read_b64_tr_b16 v[232:233], v32 offset:49152
    v_mfma_f32_16x16x32_bf16 a[48:51], v[164:167], v[144:147], a[48:51]
    v_mfma_f32_16x16x32_bf16 a[52:55], v[164:167], v[148:151], a[52:55]
    ds_read_b64_tr_b16 v[234:235], v32 offset:51200
    v_mfma_f32_16x16x32_bf16 a[56:59], v[164:167], v[152:155], a[56:59]
    v_mfma_f32_16x16x32_bf16 a[60:63], v[164:167], v[156:159], a[60:63]
    ds_read_b128 v[204:207], v29 offset:38912
    v_mfma_f32_16x16x32_bf16 a[64:67], v[168:171], v[128:131], a[64:67]
    ds_read_b64_tr_b16 v[236:237], v33 offset:49152
    v_mfma_f32_16x16x32_bf16 a[68:71], v[168:171], v[132:135], a[68:71]
    v_mfma_f32_16x16x32_bf16 a[72:75], v[168:171], v[136:139], a[72:75]
    ds_read_b64_tr_b16 v[238:239], v33 offset:51200
    v_mfma_f32_16x16x32_bf16 a[76:79], v[168:171], v[140:143], a[76:79]
    v_mfma_f32_16x16x32_bf16 a[80:83], v[168:171], v[144:147], a[80:83]
    ds_read_b128 v[208:211], v29 offset:40960
    v_mfma_f32_16x16x32_bf16 a[84:87], v[168:171], v[148:151], a[84:87]
    ds_read_b64_tr_b16 v[240:241], v34 offset:49152
    v_mfma_f32_16x16x32_bf16 a[88:91], v[168:171], v[152:155], a[88:91]
    v_mfma_f32_16x16x32_bf16 a[92:95], v[168:171], v[156:159], a[92:95]
    ds_read_b64_tr_b16 v[242:243], v34 offset:51200
    v_mfma_f32_16x16x32_bf16 a[96:99], v[172:175], v[128:131], a[96:99]
    v_mfma_f32_16x16x32_bf16 a[100:103], v[172:175], v[132:135], a[100:103]
    ds_read_b128 v[212:215], v29 offset:43008
    v_mfma_f32_16x16x32_bf16 a[104:107], v[172:175], v[136:139], a[104:107]
    ds_read_b64_tr_b16 v[244:245], v35 offset:49152
    v_mfma_f32_16x16x32_bf16 a[108:111], v[172:175], v[140:143], a[108:111]
    v_mfma_f32_16x16x32_bf16 a[112:115], v[172:175], v[144:147], a[112:115]
    ds_read_b64_tr_b16 v[246:247], v35 offset:51200
    v_mfma_f32_16x16x32_bf16 a[116:119], v[172:175], v[148:151], a[116:119]
    v_mfma_f32_16x16x32_bf16 a[120:123], v[172:175], v[152:155], a[120:123]
    ds_read_b128 v[216:219], v29 offset:45056
    v_mfma_f32_16x16x32_bf16 a[124:127], v[172:175], v[156:159], a[124:127]
    ds_read_b64_tr_b16 v[248:249], v36 offset:49152
    v_mfma_f32_16x16x32_bf16 a[128:131], v[176:179], v[128:131], a[128:131]
    v_mfma_f32_16x16x32_bf16 a[132:135], v[176:179], v[132:135], a[132:135]
    ds_read_b64_tr_b16 v[250:251], v36 offset:51200
    v_mfma_f32_16x16x32_bf16 a[136:139], v[176:179], v[136:139], a[136:139]
    v_mfma_f32_16x16x32_bf16 a[140:143], v[176:179], v[140:143], a[140:143]
    ds_read_b128 v[220:223], v29 offset:47104
    v_mfma_f32_16x16x32_bf16 a[144:147], v[176:179], v[144:147], a[144:147]
    ds_read_b64_tr_b16 v[252:253], v37 offset:49152
    v_mfma_f32_16x16x32_bf16 a[148:151], v[176:179], v[148:151], a[148:151]
    v_mfma_f32_16x16x32_bf16 a[152:155], v[176:179], v[152:155], a[152:155]
    ds_read_b64_tr_b16 v[254:255], v37 offset:51200
    v_mfma_f32_16x16x32_bf16 a[156:159], v[176:179], v[156:159], a[156:159]
    v_mfma_f32_16x16x32_bf16 a[160:163], v[180:183], v[128:131], a[160:163]
    v_mfma_f32_16x16x32_bf16 a[164:167], v[180:183], v[132:135], a[164:167]
    v_mfma_f32_16x16x32_bf16 a[168:171], v[180:183], v[136:139], a[168:171]
    v_mfma_f32_16x16x32_bf16 a[172:175], v[180:183], v[140:143], a[172:175]
    v_mfma_f32_16x16x32_bf16 a[176:179], v[180:183], v[144:147], a[176:179]
    v_mfma_f32_16x16x32_bf16 a[180:183], v[180:183], v[148:151], a[180:183]
    v_mfma_f32_16x16x32_bf16 a[184:187], v[180:183], v[152:155], a[184:187]
    v_mfma_f32_16x16x32_bf16 a[188:191], v[180:183], v[156:159], a[188:191]
    v_mfma_f32_16x16x32_bf16 a[192:195], v[184:187], v[128:131], a[192:195]
    v_mfma_f32_16x16x32_bf16 a[196:199], v[184:187], v[132:135], a[196:199]
    v_mfma_f32_16x16x32_bf16 a[200:203], v[184:187], v[136:139], a[200:203]
    v_mfma_f32_16x16x32_bf16 a[204:207], v[184:187], v[140:143], a[204:207]
    v_mfma_f32_16x16x32_bf16 a[208:211], v[184:187], v[144:147], a[208:211]
    v_mfma_f32_16x16x32_bf16 a[212:215], v[184:187], v[148:151], a[212:215]
    v_mfma_f32_16x16x32_bf16 a[216:219], v[184:187], v[152:155], a[216:219]
    v_mfma_f32_16x16x32_bf16 a[220:223], v[184:187], v[156:159], a[220:223]
    v_mfma_f32_16x16x32_bf16 a[224:227], v[188:191], v[128:131], a[224:227]
    v_mfma_f32_16x16x32_bf16 a[228:231], v[188:191], v[132:135], a[228:231]
    v_mfma_f32_16x16x32_bf16 a[232:235], v[188:191], v[136:139], a[232:235]
    v_mfma_f32_16x16x32_bf16 a[236:239], v[188:191], v[140:143], a[236:239]
    v_mfma_f32_16x16x32_bf16 a[240:243], v[188:191], v[144:147], a[240:243]
    v_mfma_f32_16x16x32_bf16 a[244:247], v[188:191], v[148:151], a[244:247]
    v_mfma_f32_16x16x32_bf16 a[248:251], v[188:191], v[152:155], a[248:251]
    v_mfma_f32_16x16x32_bf16 a[252:255], v[188:191], v[156:159], a[252:255]
    s_waitcnt vmcnt(0) lgkmcnt(0)
    s_barrier
    v_mfma_f32_16x16x32_bf16 a[0:3], v[224:227], v[192:195], a[0:3]
    ds_read_b128 v[128:131], v28 offset:0
    v_mfma_f32_16x16x32_bf16 a[4:7], v[224:227], v[196:199], a[4:7]
    ds_read_b64_tr_b16 v[160:161], v30 offset:0
    v_mfma_f32_16x16x32_bf16 a[8:11], v[224:227], v[200:203], a[8:11]
    s_add_u32 m0, s48, 32768
    s_nop 0
    buffer_load_dwordx4 v10, s[16:19], s49 offen offset:0 lds
    v_mfma_f32_16x16x32_bf16 a[12:15], v[224:227], v[204:207], a[12:15]
    ds_read_b64_tr_b16 v[162:163], v30 offset:2048
    v_mfma_f32_16x16x32_bf16 a[16:19], v[224:227], v[208:211], a[16:19]
    buffer_load_dwordx4 v11, s[16:19], s49 offen offset:1024 lds
    v_mfma_f32_16x16x32_bf16 a[20:23], v[224:227], v[212:215], a[20:23]
    ds_read_b128 v[132:135], v28 offset:2048
    v_mfma_f32_16x16x32_bf16 a[24:27], v[224:227], v[216:219], a[24:27]
    ds_read_b64_tr_b16 v[164:165], v31 offset:0
    v_mfma_f32_16x16x32_bf16 a[28:31], v[224:227], v[220:223], a[28:31]
    buffer_load_dwordx4 v12, s[16:19], s49 offen offset:2048 lds
    v_mfma_f32_16x16x32_bf16 a[32:35], v[228:231], v[192:195], a[32:35]
    ds_read_b64_tr_b16 v[166:167], v31 offset:2048
    v_mfma_f32_16x16x32_bf16 a[36:39], v[228:231], v[196:199], a[36:39]
    v_mfma_f32_16x16x32_bf16 a[40:43], v[228:231], v[200:203], a[40:43]
    ds_read_b128 v[136:139], v28 offset:4096
    buffer_load_dwordx4 v13, s[16:19], s49 offen offset:3072 lds
    v_mfma_f32_16x16x32_bf16 a[44:47], v[228:231], v[204:207], a[44:47]
    ds_read_b64_tr_b16 v[168:169], v32 offset:0
    v_mfma_f32_16x16x32_bf16 a[48:51], v[228:231], v[208:211], a[48:51]
    v_mfma_f32_16x16x32_bf16 a[52:55], v[228:231], v[212:215], a[52:55]
    ds_read_b64_tr_b16 v[170:171], v32 offset:2048
    s_add_u32 m0, s48, 36864
    s_nop 0
    buffer_load_dwordx4 v14, s[16:19], s49 offen offset:0 lds
    v_mfma_f32_16x16x32_bf16 a[56:59], v[228:231], v[216:219], a[56:59]
    v_mfma_f32_16x16x32_bf16 a[60:63], v[228:231], v[220:223], a[60:63]
    ds_read_b128 v[140:143], v28 offset:6144
    v_mfma_f32_16x16x32_bf16 a[64:67], v[232:235], v[192:195], a[64:67]
    ds_read_b64_tr_b16 v[172:173], v33 offset:0
    buffer_load_dwordx4 v15, s[16:19], s49 offen offset:1024 lds
    v_mfma_f32_16x16x32_bf16 a[68:71], v[232:235], v[196:199], a[68:71]
    v_mfma_f32_16x16x32_bf16 a[72:75], v[232:235], v[200:203], a[72:75]
    ds_read_b64_tr_b16 v[174:175], v33 offset:2048
    buffer_load_dwordx4 v16, s[16:19], s49 offen offset:2048 lds
    v_mfma_f32_16x16x32_bf16 a[76:79], v[232:235], v[204:207], a[76:79]
    v_mfma_f32_16x16x32_bf16 a[80:83], v[232:235], v[208:211], a[80:83]
    ds_read_b128 v[144:147], v28 offset:8192
    v_mfma_f32_16x16x32_bf16 a[84:87], v[232:235], v[212:215], a[84:87]
    ds_read_b64_tr_b16 v[176:177], v34 offset:0
    buffer_load_dwordx4 v17, s[16:19], s49 offen offset:3072 lds
    v_mfma_f32_16x16x32_bf16 a[88:91], v[232:235], v[216:219], a[88:91]
    v_mfma_f32_16x16x32_bf16 a[92:95], v[232:235], v[220:223], a[92:95]
    ds_read_b64_tr_b16 v[178:179], v34 offset:2048
    v_mfma_f32_16x16x32_bf16 a[96:99], v[236:239], v[192:195], a[96:99]
    s_add_u32 m0, s48, 98304
    s_nop 0
    buffer_load_dwordx4 v18, s[20:23], s50 offen offset:0 lds
    v_mfma_f32_16x16x32_bf16 a[100:103], v[236:239], v[196:199], a[100:103]
    ds_read_b128 v[148:151], v28 offset:10240
    v_mfma_f32_16x16x32_bf16 a[104:107], v[236:239], v[200:203], a[104:107]
    ds_read_b64_tr_b16 v[180:181], v35 offset:0
    v_mfma_f32_16x16x32_bf16 a[108:111], v[236:239], v[204:207], a[108:111]
    buffer_load_dwordx4 v19, s[20:23], s50 offen offset:1024 lds
    v_mfma_f32_16x16x32_bf16 a[112:115], v[236:239], v[208:211], a[112:115]
    ds_read_b64_tr_b16 v[182:183], v35 offset:2048
    v_mfma_f32_16x16x32_bf16 a[116:119], v[236:239], v[212:215], a[116:119]
    v_mfma_f32_16x16x32_bf16 a[120:123], v[236:239], v[216:219], a[120:123]
    ds_read_b128 v[152:155], v28 offset:12288
    buffer_load_dwordx4 v20, s[20:23], s50 offen offset:2048 lds
    v_mfma_f32_16x16x32_bf16 a[124:127], v[236:239], v[220:223], a[124:127]
    ds_read_b64_tr_b16 v[184:185], v36 offset:0
    v_mfma_f32_16x16x32_bf16 a[128:131], v[240:243], v[192:195], a[128:131]
    v_mfma_f32_16x16x32_bf16 a[132:135], v[240:243], v[196:199], a[132:135]
    ds_read_b64_tr_b16 v[186:187], v36 offset:2048
    buffer_load_dwordx4 v21, s[20:23], s50 offen offset:3072 lds
    v_mfma_f32_16x16x32_bf16 a[136:139], v[240:243], v[200:203], a[136:139]
    v_mfma_f32_16x16x32_bf16 a[140:143], v[240:243], v[204:207], a[140:143]
    ds_read_b128 v[156:159], v28 offset:14336
    s_add_u32 m0, s48, 102400
    s_nop 0
    buffer_load_dwordx4 v22, s[20:23], s50 offen offset:0 lds
    v_mfma_f32_16x16x32_bf16 a[144:147], v[240:243], v[208:211], a[144:147]
    ds_read_b64_tr_b16 v[188:189], v37 offset:0
    v_mfma_f32_16x16x32_bf16 a[148:151], v[240:243], v[212:215], a[148:151]
    v_mfma_f32_16x16x32_bf16 a[152:155], v[240:243], v[216:219], a[152:155]
    ds_read_b64_tr_b16 v[190:191], v37 offset:2048
    buffer_load_dwordx4 v23, s[20:23], s50 offen offset:1024 lds
    v_mfma_f32_16x16x32_bf16 a[156:159], v[240:243], v[220:223], a[156:159]
    v_mfma_f32_16x16x32_bf16 a[160:163], v[244:247], v[192:195], a[160:163]
    v_mfma_f32_16x16x32_bf16 a[164:167], v[244:247], v[196:199], a[164:167]
    buffer_load_dwordx4 v24, s[20:23], s50 offen offset:2048 lds
    v_mfma_f32_16x16x32_bf16 a[168:171], v[244:247], v[200:203], a[168:171]
    v_mfma_f32_16x16x32_bf16 a[172:175], v[244:247], v[204:207], a[172:175]
    v_mfma_f32_16x16x32_bf16 a[176:179], v[244:247], v[208:211], a[176:179]
    buffer_load_dwordx4 v25, s[20:23], s50 offen offset:3072 lds
    v_mfma_f32_16x16x32_bf16 a[180:183], v[244:247], v[212:215], a[180:183]
    v_mfma_f32_16x16x32_bf16 a[184:187], v[244:247], v[216:219], a[184:187]
    v_mfma_f32_16x16x32_bf16 a[188:191], v[244:247], v[220:223], a[188:191]
    s_add_u32 s49, s49, 128
    s_add_u32 s50, s50, 0x80000
    v_mfma_f32_16x16x32_bf16 a[192:195], v[248:251], v[192:195], a[192:195]
    v_mfma_f32_16x16x32_bf16 a[196:199], v[248:251], v[196:199], a[196:199]
    v_mfma_f32_16x16x32_bf16 a[200:203], v[248:251], v[200:203], a[200:203]
    v_mfma_f32_16x16x32_bf16 a[204:207], v[248:251], v[204:207], a[204:207]
    v_mfma_f32_16x16x32_bf16 a[208:211], v[248:251], v[208:211], a[208:211]
    v_mfma_f32_16x16x32_bf16 a[212:215], v[248:251], v[212:215], a[212:215]
    v_mfma_f32_16x16x32_bf16 a[216:219], v[248:251], v[216:219], a[216:219]
    v_mfma_f32_16x16x32_bf16 a[220:223], v[248:251], v[220:223], a[220:223]
    v_mfma_f32_16x16x32_bf16 a[224:227], v[252:255], v[192:195], a[224:227]
    v_mfma_f32_16x16x32_bf16 a[228:231], v[252:255], v[196:199], a[228:231]
    v_mfma_f32_16x16x32_bf16 a[232:235], v[252:255], v[200:203], a[232:235]
    v_mfma_f32_16x16x32_bf16 a[236:239], v[252:255], v[204:207], a[236:239]
    v_mfma_f32_16x16x32_bf16 a[240:243], v[252:255], v[208:211], a[240:243]
    v_mfma_f32_16x16x32_bf16 a[244:247], v[252:255], v[212:215], a[244:247]
    v_mfma_f32_16x16x32_bf16 a[248:251], v[252:255], v[216:219], a[248:251]
    v_mfma_f32_16x16x32_bf16 a[252:255], v[252:255], v[220:223], a[252:255]
    s_add_u32 s51, s51, 1
    s_cmp_lt_u32 s51, 4
    s_cbranch_scc1 k1_loop_4
    s_lshl_b32 s47, s44, 1
    s_lshr_b32 s52, s46, 1
    s_add_u32 s47, s47, s52
    s_lshl_b32 s47, s47, 14
    s_lshl_b32 s52, s42, 1
    s_and_b32 s53, s46, 1
    s_add_u32 s52, s52, s53
    s_lshl_b32 s52, s52, 20
    s_add_u32 s47, s47, s52
    v_lshlrev_b32 v3, 4, v2
    s_nop 7
    v_accvgpr_read_b32 v44, a0
    v_accvgpr_read_b32 v45, a1
    v_accvgpr_read_b32 v46, a2
    v_accvgpr_read_b32 v47, a3
    v_accvgpr_read_b32 v48, a32
    v_accvgpr_read_b32 v49, a33
    v_accvgpr_read_b32 v50, a34
    v_accvgpr_read_b32 v51, a35
    v_cvt_pk_bf16_f32 v40, v44, v45
    v_cvt_pk_bf16_f32 v41, v46, v47
    v_cvt_pk_bf16_f32 v42, v48, v49
    v_cvt_pk_bf16_f32 v43, v50, v51
    s_add_u32 s52, s47, 0
    buffer_store_dwordx4 v[40:43], v3, s[32:35], s52 offen offset:0
    v_accvgpr_read_b32 v56, a4
    v_accvgpr_read_b32 v57, a5
    v_accvgpr_read_b32 v58, a6
    v_accvgpr_read_b32 v59, a7
    v_accvgpr_read_b32 v60, a36
    v_accvgpr_read_b32 v61, a37
    v_accvgpr_read_b32 v62, a38
    v_accvgpr_read_b32 v63, a39
    v_cvt_pk_bf16_f32 v52, v56, v57
    v_cvt_pk_bf16_f32 v53, v58, v59
    v_cvt_pk_bf16_f32 v54, v60, v61
    v_cvt_pk_bf16_f32 v55, v62, v63
    s_add_u32 s52, s47, 4096
    buffer_store_dwordx4 v[52:55], v3, s[32:35], s52 offen offset:0
    v_accvgpr_read_b32 v68, a8
    v_accvgpr_read_b32 v69, a9
    v_accvgpr_read_b32 v70, a10
    v_accvgpr_read_b32 v71, a11
    v_accvgpr_read_b32 v72, a40
    v_accvgpr_read_b32 v73, a41
    v_accvgpr_read_b32 v74, a42
    v_accvgpr_read_b32 v75, a43
    v_cvt_pk_bf16_f32 v64, v68, v69
    v_cvt_pk_bf16_f32 v65, v70, v71
    v_cvt_pk_bf16_f32 v66, v72, v73
    v_cvt_pk_bf16_f32 v67, v74, v75
    s_add_u32 s52, s47, 8192
    buffer_store_dwordx4 v[64:67], v3, s[32:35], s52 offen offset:0
    v_accvgpr_read_b32 v80, a12
    v_accvgpr_read_b32 v81, a13
    v_accvgpr_read_b32 v82, a14
    v_accvgpr_read_b32 v83, a15
    v_accvgpr_read_b32 v84, a44
    v_accvgpr_read_b32 v85, a45
    v_accvgpr_read_b32 v86, a46
    v_accvgpr_read_b32 v87, a47
    v_cvt_pk_bf16_f32 v76, v80, v81
    v_cvt_pk_bf16_f32 v77, v82, v83
    v_cvt_pk_bf16_f32 v78, v84, v85
    v_cvt_pk_bf16_f32 v79, v86, v87
    s_add_u32 s52, s47, 12288
    buffer_store_dwordx4 v[76:79], v3, s[32:35], s52 offen offset:0
    v_accvgpr_read_b32 v44, a16
    v_accvgpr_read_b32 v45, a17
    v_accvgpr_read_b32 v46, a18
    v_accvgpr_read_b32 v47, a19
    v_accvgpr_read_b32 v48, a48
    v_accvgpr_read_b32 v49, a49
    v_accvgpr_read_b32 v50, a50
    v_accvgpr_read_b32 v51, a51
    v_cvt_pk_bf16_f32 v40, v44, v45
    v_cvt_pk_bf16_f32 v41, v46, v47
    v_cvt_pk_bf16_f32 v42, v48, v49
    v_cvt_pk_bf16_f32 v43, v50, v51
    s_add_u32 s52, s47, 524288
    buffer_store_dwordx4 v[40:43], v3, s[32:35], s52 offen offset:0
    v_accvgpr_read_b32 v56, a20
    v_accvgpr_read_b32 v57, a21
    v_accvgpr_read_b32 v58, a22
    v_accvgpr_read_b32 v59, a23
    v_accvgpr_read_b32 v60, a52
    v_accvgpr_read_b32 v61, a53
    v_accvgpr_read_b32 v62, a54
    v_accvgpr_read_b32 v63, a55
    v_cvt_pk_bf16_f32 v52, v56, v57
    v_cvt_pk_bf16_f32 v53, v58, v59
    v_cvt_pk_bf16_f32 v54, v60, v61
    v_cvt_pk_bf16_f32 v55, v62, v63
    s_add_u32 s52, s47, 528384
    buffer_store_dwordx4 v[52:55], v3, s[32:35], s52 offen offset:0
    v_accvgpr_read_b32 v68, a24
    v_accvgpr_read_b32 v69, a25
    v_accvgpr_read_b32 v70, a26
    v_accvgpr_read_b32 v71, a27
    v_accvgpr_read_b32 v72, a56
    v_accvgpr_read_b32 v73, a57
    v_accvgpr_read_b32 v74, a58
    v_accvgpr_read_b32 v75, a59
    v_cvt_pk_bf16_f32 v64, v68, v69
    v_cvt_pk_bf16_f32 v65, v70, v71
    v_cvt_pk_bf16_f32 v66, v72, v73
    v_cvt_pk_bf16_f32 v67, v74, v75
    s_add_u32 s52, s47, 532480
    buffer_store_dwordx4 v[64:67], v3, s[32:35], s52 offen offset:0
    v_accvgpr_read_b32 v80, a28
    v_accvgpr_read_b32 v81, a29
    v_accvgpr_read_b32 v82, a30
    v_accvgpr_read_b32 v83, a31
    v_accvgpr_read_b32 v84, a60
    v_accvgpr_read_b32 v85, a61
    v_accvgpr_read_b32 v86, a62
    v_accvgpr_read_b32 v87, a63
    v_cvt_pk_bf16_f32 v76, v80, v81
    v_cvt_pk_bf16_f32 v77, v82, v83
    v_cvt_pk_bf16_f32 v78, v84, v85
    v_cvt_pk_bf16_f32 v79, v86, v87
    s_add_u32 s52, s47, 536576
    buffer_store_dwordx4 v[76:79], v3, s[32:35], s52 offen offset:0
    v_accvgpr_read_b32 v44, a64
    v_accvgpr_read_b32 v45, a65
    v_accvgpr_read_b32 v46, a66
    v_accvgpr_read_b32 v47, a67
    v_accvgpr_read_b32 v48, a96
    v_accvgpr_read_b32 v49, a97
    v_accvgpr_read_b32 v50, a98
    v_accvgpr_read_b32 v51, a99
    v_cvt_pk_bf16_f32 v40, v44, v45
    v_cvt_pk_bf16_f32 v41, v46, v47
    v_cvt_pk_bf16_f32 v42, v48, v49
    v_cvt_pk_bf16_f32 v43, v50, v51
    s_add_u32 s52, s47, 0
    buffer_store_dwordx4 v[40:43], v3, s[32:35], s52 offen offset:1024
    v_accvgpr_read_b32 v56, a68
    v_accvgpr_read_b32 v57, a69
    v_accvgpr_read_b32 v58, a70
    v_accvgpr_read_b32 v59, a71
    v_accvgpr_read_b32 v60, a100
    v_accvgpr_read_b32 v61, a101
    v_accvgpr_read_b32 v62, a102
    v_accvgpr_read_b32 v63, a103
    v_cvt_pk_bf16_f32 v52, v56, v57
    v_cvt_pk_bf16_f32 v53, v58, v59
    v_cvt_pk_bf16_f32 v54, v60, v61
    v_cvt_pk_bf16_f32 v55, v62, v63
    s_add_u32 s52, s47, 4096
    buffer_store_dwordx4 v[52:55], v3, s[32:35], s52 offen offset:1024
    v_accvgpr_read_b32 v68, a72
    v_accvgpr_read_b32 v69, a73
    v_accvgpr_read_b32 v70, a74
    v_accvgpr_read_b32 v71, a75
    v_accvgpr_read_b32 v72, a104
    v_accvgpr_read_b32 v73, a105
    v_accvgpr_read_b32 v74, a106
    v_accvgpr_read_b32 v75, a107
    v_cvt_pk_bf16_f32 v64, v68, v69
    v_cvt_pk_bf16_f32 v65, v70, v71
    v_cvt_pk_bf16_f32 v66, v72, v73
    v_cvt_pk_bf16_f32 v67, v74, v75
    s_add_u32 s52, s47, 8192
    buffer_store_dwordx4 v[64:67], v3, s[32:35], s52 offen offset:1024
    v_accvgpr_read_b32 v80, a76
    v_accvgpr_read_b32 v81, a77
    v_accvgpr_read_b32 v82, a78
    v_accvgpr_read_b32 v83, a79
    v_accvgpr_read_b32 v84, a108
    v_accvgpr_read_b32 v85, a109
    v_accvgpr_read_b32 v86, a110
    v_accvgpr_read_b32 v87, a111
    v_cvt_pk_bf16_f32 v76, v80, v81
    v_cvt_pk_bf16_f32 v77, v82, v83
    v_cvt_pk_bf16_f32 v78, v84, v85
    v_cvt_pk_bf16_f32 v79, v86, v87
    s_add_u32 s52, s47, 12288
    buffer_store_dwordx4 v[76:79], v3, s[32:35], s52 offen offset:1024
    v_accvgpr_read_b32 v44, a80
    v_accvgpr_read_b32 v45, a81
    v_accvgpr_read_b32 v46, a82
    v_accvgpr_read_b32 v47, a83
    v_accvgpr_read_b32 v48, a112
    v_accvgpr_read_b32 v49, a113
    v_accvgpr_read_b32 v50, a114
    v_accvgpr_read_b32 v51, a115
    v_cvt_pk_bf16_f32 v40, v44, v45
    v_cvt_pk_bf16_f32 v41, v46, v47
    v_cvt_pk_bf16_f32 v42, v48, v49
    v_cvt_pk_bf16_f32 v43, v50, v51
    s_add_u32 s52, s47, 524288
    buffer_store_dwordx4 v[40:43], v3, s[32:35], s52 offen offset:1024
    v_accvgpr_read_b32 v56, a84
    v_accvgpr_read_b32 v57, a85
    v_accvgpr_read_b32 v58, a86
    v_accvgpr_read_b32 v59, a87
    v_accvgpr_read_b32 v60, a116
    v_accvgpr_read_b32 v61, a117
    v_accvgpr_read_b32 v62, a118
    v_accvgpr_read_b32 v63, a119
    v_cvt_pk_bf16_f32 v52, v56, v57
    v_cvt_pk_bf16_f32 v53, v58, v59
    v_cvt_pk_bf16_f32 v54, v60, v61
    v_cvt_pk_bf16_f32 v55, v62, v63
    s_add_u32 s52, s47, 528384
    buffer_store_dwordx4 v[52:55], v3, s[32:35], s52 offen offset:1024
    v_accvgpr_read_b32 v68, a88
    v_accvgpr_read_b32 v69, a89
    v_accvgpr_read_b32 v70, a90
    v_accvgpr_read_b32 v71, a91
    v_accvgpr_read_b32 v72, a120
    v_accvgpr_read_b32 v73, a121
    v_accvgpr_read_b32 v74, a122
    v_accvgpr_read_b32 v75, a123
    v_cvt_pk_bf16_f32 v64, v68, v69
    v_cvt_pk_bf16_f32 v65, v70, v71
    v_cvt_pk_bf16_f32 v66, v72, v73
    v_cvt_pk_bf16_f32 v67, v74, v75
    s_add_u32 s52, s47, 532480
    buffer_store_dwordx4 v[64:67], v3, s[32:35], s52 offen offset:1024
    v_accvgpr_read_b32 v80, a92
    v_accvgpr_read_b32 v81, a93
    v_accvgpr_read_b32 v82, a94
    v_accvgpr_read_b32 v83, a95
    v_accvgpr_read_b32 v84, a124
    v_accvgpr_read_b32 v85, a125
    v_accvgpr_read_b32 v86, a126
    v_accvgpr_read_b32 v87, a127
    v_cvt_pk_bf16_f32 v76, v80, v81
    v_cvt_pk_bf16_f32 v77, v82, v83
    v_cvt_pk_bf16_f32 v78, v84, v85
    v_cvt_pk_bf16_f32 v79, v86, v87
    s_add_u32 s52, s47, 536576
    buffer_store_dwordx4 v[76:79], v3, s[32:35], s52 offen offset:1024
    v_accvgpr_read_b32 v44, a128
    v_accvgpr_read_b32 v45, a129
    v_accvgpr_read_b32 v46, a130
    v_accvgpr_read_b32 v47, a131
    v_accvgpr_read_b32 v48, a160
    v_accvgpr_read_b32 v49, a161
    v_accvgpr_read_b32 v50, a162
    v_accvgpr_read_b32 v51, a163
    v_cvt_pk_bf16_f32 v40, v44, v45
    v_cvt_pk_bf16_f32 v41, v46, v47
    v_cvt_pk_bf16_f32 v42, v48, v49
    v_cvt_pk_bf16_f32 v43, v50, v51
    s_add_u32 s52, s47, 0
    buffer_store_dwordx4 v[40:43], v3, s[32:35], s52 offen offset:2048
    v_accvgpr_read_b32 v56, a132
    v_accvgpr_read_b32 v57, a133
    v_accvgpr_read_b32 v58, a134
    v_accvgpr_read_b32 v59, a135
    v_accvgpr_read_b32 v60, a164
    v_accvgpr_read_b32 v61, a165
    v_accvgpr_read_b32 v62, a166
    v_accvgpr_read_b32 v63, a167
    v_cvt_pk_bf16_f32 v52, v56, v57
    v_cvt_pk_bf16_f32 v53, v58, v59
    v_cvt_pk_bf16_f32 v54, v60, v61
    v_cvt_pk_bf16_f32 v55, v62, v63
    s_add_u32 s52, s47, 4096
    buffer_store_dwordx4 v[52:55], v3, s[32:35], s52 offen offset:2048
    v_accvgpr_read_b32 v68, a136
    v_accvgpr_read_b32 v69, a137
    v_accvgpr_read_b32 v70, a138
    v_accvgpr_read_b32 v71, a139
    v_accvgpr_read_b32 v72, a168
    v_accvgpr_read_b32 v73, a169
    v_accvgpr_read_b32 v74, a170
    v_accvgpr_read_b32 v75, a171
    v_cvt_pk_bf16_f32 v64, v68, v69
    v_cvt_pk_bf16_f32 v65, v70, v71
    v_cvt_pk_bf16_f32 v66, v72, v73
    v_cvt_pk_bf16_f32 v67, v74, v75
    s_add_u32 s52, s47, 8192
    buffer_store_dwordx4 v[64:67], v3, s[32:35], s52 offen offset:2048
    v_accvgpr_read_b32 v80, a140
    v_accvgpr_read_b32 v81, a141
    v_accvgpr_read_b32 v82, a142
    v_accvgpr_read_b32 v83, a143
    v_accvgpr_read_b32 v84, a172
    v_accvgpr_read_b32 v85, a173
    v_accvgpr_read_b32 v86, a174
    v_accvgpr_read_b32 v87, a175
    v_cvt_pk_bf16_f32 v76, v80, v81
    v_cvt_pk_bf16_f32 v77, v82, v83
    v_cvt_pk_bf16_f32 v78, v84, v85
    v_cvt_pk_bf16_f32 v79, v86, v87
    s_add_u32 s52, s47, 12288
    buffer_store_dwordx4 v[76:79], v3, s[32:35], s52 offen offset:2048
    v_accvgpr_read_b32 v44, a144
    v_accvgpr_read_b32 v45, a145
    v_accvgpr_read_b32 v46, a146
    v_accvgpr_read_b32 v47, a147
    v_accvgpr_read_b32 v48, a176
    v_accvgpr_read_b32 v49, a177
    v_accvgpr_read_b32 v50, a178
    v_accvgpr_read_b32 v51, a179
    v_cvt_pk_bf16_f32 v40, v44, v45
    v_cvt_pk_bf16_f32 v41, v46, v47
    v_cvt_pk_bf16_f32 v42, v48, v49
    v_cvt_pk_bf16_f32 v43, v50, v51
    s_add_u32 s52, s47, 524288
    buffer_store_dwordx4 v[40:43], v3, s[32:35], s52 offen offset:2048
    v_accvgpr_read_b32 v56, a148
    v_accvgpr_read_b32 v57, a149
    v_accvgpr_read_b32 v58, a150
    v_accvgpr_read_b32 v59, a151
    v_accvgpr_read_b32 v60, a180
    v_accvgpr_read_b32 v61, a181
    v_accvgpr_read_b32 v62, a182
    v_accvgpr_read_b32 v63, a183
    v_cvt_pk_bf16_f32 v52, v56, v57
    v_cvt_pk_bf16_f32 v53, v58, v59
    v_cvt_pk_bf16_f32 v54, v60, v61
    v_cvt_pk_bf16_f32 v55, v62, v63
    s_add_u32 s52, s47, 528384
    buffer_store_dwordx4 v[52:55], v3, s[32:35], s52 offen offset:2048
    v_accvgpr_read_b32 v68, a152
    v_accvgpr_read_b32 v69, a153
    v_accvgpr_read_b32 v70, a154
    v_accvgpr_read_b32 v71, a155
    v_accvgpr_read_b32 v72, a184
    v_accvgpr_read_b32 v73, a185
    v_accvgpr_read_b32 v74, a186
    v_accvgpr_read_b32 v75, a187
    v_cvt_pk_bf16_f32 v64, v68, v69
    v_cvt_pk_bf16_f32 v65, v70, v71
    v_cvt_pk_bf16_f32 v66, v72, v73
    v_cvt_pk_bf16_f32 v67, v74, v75
    s_add_u32 s52, s47, 532480
    buffer_store_dwordx4 v[64:67], v3, s[32:35], s52 offen offset:2048
    v_accvgpr_read_b32 v80, a156
    v_accvgpr_read_b32 v81, a157
    v_accvgpr_read_b32 v82, a158
    v_accvgpr_read_b32 v83, a159
    v_accvgpr_read_b32 v84, a188
    v_accvgpr_read_b32 v85, a189
    v_accvgpr_read_b32 v86, a190
    v_accvgpr_read_b32 v87, a191
    v_cvt_pk_bf16_f32 v76, v80, v81
    v_cvt_pk_bf16_f32 v77, v82, v83
    v_cvt_pk_bf16_f32 v78, v84, v85
    v_cvt_pk_bf16_f32 v79, v86, v87
    s_add_u32 s52, s47, 536576
    buffer_store_dwordx4 v[76:79], v3, s[32:35], s52 offen offset:2048
    v_accvgpr_read_b32 v44, a192
    v_accvgpr_read_b32 v45, a193
    v_accvgpr_read_b32 v46, a194
    v_accvgpr_read_b32 v47, a195
    v_accvgpr_read_b32 v48, a224
    v_accvgpr_read_b32 v49, a225
    v_accvgpr_read_b32 v50, a226
    v_accvgpr_read_b32 v51, a227
    v_cvt_pk_bf16_f32 v40, v44, v45
    v_cvt_pk_bf16_f32 v41, v46, v47
    v_cvt_pk_bf16_f32 v42, v48, v49
    v_cvt_pk_bf16_f32 v43, v50, v51
    s_add_u32 s52, s47, 0
    buffer_store_dwordx4 v[40:43], v3, s[32:35], s52 offen offset:3072
    v_accvgpr_read_b32 v56, a196
    v_accvgpr_read_b32 v57, a197
    v_accvgpr_read_b32 v58, a198
    v_accvgpr_read_b32 v59, a199
    v_accvgpr_read_b32 v60, a228
    v_accvgpr_read_b32 v61, a229
    v_accvgpr_read_b32 v62, a230
    v_accvgpr_read_b32 v63, a231
    v_cvt_pk_bf16_f32 v52, v56, v57
    v_cvt_pk_bf16_f32 v53, v58, v59
    v_cvt_pk_bf16_f32 v54, v60, v61
    v_cvt_pk_bf16_f32 v55, v62, v63
    s_add_u32 s52, s47, 4096
    buffer_store_dwordx4 v[52:55], v3, s[32:35], s52 offen offset:3072
    v_accvgpr_read_b32 v68, a200
    v_accvgpr_read_b32 v69, a201
    v_accvgpr_read_b32 v70, a202
    v_accvgpr_read_b32 v71, a203
    v_accvgpr_read_b32 v72, a232
    v_accvgpr_read_b32 v73, a233
    v_accvgpr_read_b32 v74, a234
    v_accvgpr_read_b32 v75, a235
    v_cvt_pk_bf16_f32 v64, v68, v69
    v_cvt_pk_bf16_f32 v65, v70, v71
    v_cvt_pk_bf16_f32 v66, v72, v73
    v_cvt_pk_bf16_f32 v67, v74, v75
    s_add_u32 s52, s47, 8192
    buffer_store_dwordx4 v[64:67], v3, s[32:35], s52 offen offset:3072
    v_accvgpr_read_b32 v80, a204
    v_accvgpr_read_b32 v81, a205
    v_accvgpr_read_b32 v82, a206
    v_accvgpr_read_b32 v83, a207
    v_accvgpr_read_b32 v84, a236
    v_accvgpr_read_b32 v85, a237
    v_accvgpr_read_b32 v86, a238
    v_accvgpr_read_b32 v87, a239
    v_cvt_pk_bf16_f32 v76, v80, v81
    v_cvt_pk_bf16_f32 v77, v82, v83
    v_cvt_pk_bf16_f32 v78, v84, v85
    v_cvt_pk_bf16_f32 v79, v86, v87
    s_add_u32 s52, s47, 12288
    buffer_store_dwordx4 v[76:79], v3, s[32:35], s52 offen offset:3072
    v_accvgpr_read_b32 v44, a208
    v_accvgpr_read_b32 v45, a209
    v_accvgpr_read_b32 v46, a210
    v_accvgpr_read_b32 v47, a211
    v_accvgpr_read_b32 v48, a240
    v_accvgpr_read_b32 v49, a241
    v_accvgpr_read_b32 v50, a242
    v_accvgpr_read_b32 v51, a243
    v_cvt_pk_bf16_f32 v40, v44, v45
    v_cvt_pk_bf16_f32 v41, v46, v47
    v_cvt_pk_bf16_f32 v42, v48, v49
    v_cvt_pk_bf16_f32 v43, v50, v51
    s_add_u32 s52, s47, 524288
    buffer_store_dwordx4 v[40:43], v3, s[32:35], s52 offen offset:3072
    v_accvgpr_read_b32 v56, a212
    v_accvgpr_read_b32 v57, a213
    v_accvgpr_read_b32 v58, a214
    v_accvgpr_read_b32 v59, a215
    v_accvgpr_read_b32 v60, a244
    v_accvgpr_read_b32 v61, a245
    v_accvgpr_read_b32 v62, a246
    v_accvgpr_read_b32 v63, a247
    v_cvt_pk_bf16_f32 v52, v56, v57
    v_cvt_pk_bf16_f32 v53, v58, v59
    v_cvt_pk_bf16_f32 v54, v60, v61
    v_cvt_pk_bf16_f32 v55, v62, v63
    s_add_u32 s52, s47, 528384
    buffer_store_dwordx4 v[52:55], v3, s[32:35], s52 offen offset:3072
    v_accvgpr_read_b32 v68, a216
    v_accvgpr_read_b32 v69, a217
    v_accvgpr_read_b32 v70, a218
    v_accvgpr_read_b32 v71, a219
    v_accvgpr_read_b32 v72, a248
    v_accvgpr_read_b32 v73, a249
    v_accvgpr_read_b32 v74, a250
    v_accvgpr_read_b32 v75, a251
    v_cvt_pk_bf16_f32 v64, v68, v69
    v_cvt_pk_bf16_f32 v65, v70, v71
    v_cvt_pk_bf16_f32 v66, v72, v73
    v_cvt_pk_bf16_f32 v67, v74, v75
    s_add_u32 s52, s47, 532480
    buffer_store_dwordx4 v[64:67], v3, s[32:35], s52 offen offset:3072
    v_accvgpr_read_b32 v80, a220
    v_accvgpr_read_b32 v81, a221
    v_accvgpr_read_b32 v82, a222
    v_accvgpr_read_b32 v83, a223
    v_accvgpr_read_b32 v84, a252
    v_accvgpr_read_b32 v85, a253
    v_accvgpr_read_b32 v86, a254
    v_accvgpr_read_b32 v87, a255
    v_cvt_pk_bf16_f32 v76, v80, v81
    v_cvt_pk_bf16_f32 v77, v82, v83
    v_cvt_pk_bf16_f32 v78, v84, v85
    v_cvt_pk_bf16_f32 v79, v86, v87
    s_add_u32 s52, s47, 536576
    buffer_store_dwordx4 v[76:79], v3, s[32:35], s52 offen offset:3072
    s_endpgm
k1_v_3:
k1_loop_5:
    s_waitcnt lgkmcnt(0)
    v_mfma_f32_16x16x32_bf16 a[0:3], v[128:131], v[160:163], a[0:3]
    ds_read_b128 v[192:195], v29 offset:0
    v_mfma_f32_16x16x32_bf16 a[4:7], v[128:131], v[164:167], a[4:7]
    ds_read_b64_tr_b16 v[224:225], v30 offset:16384
    v_mfma_f32_16x16x32_bf16 a[8:11], v[128:131], v[168:171], a[8:11]
    v_mfma_f32_16x16x32_bf16 a[12:15], v[128:131], v[172:175], a[12:15]
    ds_read_b64_tr_b16 v[226:227], v30 offset:18432
    v_mfma_f32_16x16x32_bf16 a[16:19], v[128:131], v[176:179], a[16:19]
    v_mfma_f32_16x16x32_bf16 a[20:23], v[128:131], v[180:183], a[20:23]
    ds_read_b128 v[196:199], v29 offset:2048
    v_mfma_f32_16x16x32_bf16 a[24:27], v[128:131], v[184:187], a[24:27]
    ds_read_b64_tr_b16 v[228:229], v31 offset:16384
    v_mfma_f32_16x16x32_bf16 a[28:31], v[128:131], v[188:191], a[28:31]
    v_mfma_f32_16x16x32_bf16 a[32:35], v[132:135], v[160:163], a[32:35]
    ds_read_b64_tr_b16 v[230:231], v31 offset:18432
    v_mfma_f32_16x16x32_bf16 a[36:39], v[132:135], v[164:167], a[36:39]
    v_mfma_f32_16x16x32_bf16 a[40:43], v[132:135], v[168:171], a[40:43]
    ds_read_b128 v[200:203], v29 offset:4096
    v_mfma_f32_16x16x32_bf16 a[44:47], v[132:135], v[172:175], a[44:47]
    ds_read_b64_tr_b16 v[232:233], v32 offset:16384
    v_mfma_f32_16x16x32_bf16 a[48:51], v[132:135], v[176:179], a[48:51]
    v_mfma_f32_16x16x32_bf16 a[52:55], v[132:135], v[180:183], a[52:55]
    ds_read_b64_tr_b16 v[234:235], v32 offset:18432
    v_mfma_f32_16x16x32_bf16 a[56:59], v[132:135], v[184:187], a[56:59]
    v_mfma_f32_16x16x32_bf16 a[60:63], v[132:135], v[188:191], a[60:63]
    ds_read_b128 v[204:207], v29 offset:6144
    v_mfma_f32_16x16x32_bf16 a[64:67], v[136:139], v[160:163], a[64:67]
    ds_read_b64_tr_b16 v[236:237], v33 offset:16384
    v_mfma_f32_16x16x32_bf16 a[68:71], v[136:139], v[164:167], a[68:71]
    v_mfma_f32_16x16x32_bf16 a[72:75], v[136:139], v[168:171], a[72:75]
    ds_read_b64_tr_b16 v[238:239], v33 offset:18432
    v_mfma_f32_16x16x32_bf16 a[76:79], v[136:139], v[172:175], a[76:79]
    v_mfma_f32_16x16x32_bf16 a[80:83], v[136:139], v[176:179], a[80:83]
    ds_read_b128 v[208:211], v29 offset:8192
    v_mfma_f32_16x16x32_bf16 a[84:87], v[136:139], v[180:183], a[84:87]
    ds_read_b64_tr_b16 v[240:241], v34 offset:16384
    v_mfma_f32_16x16x32_bf16 a[88:91], v[136:139], v[184:187], a[88:91]
    v_mfma_f32_16x16x32_bf16 a[92:95], v[136:139], v[188:191], a[92:95]
    ds_read_b64_tr_b16 v[242:243], v34 offset:18432
    v_mfma_f32_16x16x32_bf16 a[96:99], v[140:143], v[160:163], a[96:99]
    v_mfma_f32_16x16x32_bf16 a[100:103], v[140:143], v[164:167], a[100:103]
    ds_read_b128 v[212:215], v29 offset:10240
    v_mfma_f32_16x16x32_bf16 a[104:107], v[140:143], v[168:171], a[104:107]
    ds_read_b64_tr_b16 v[244:245], v35 offset:16384
    v_mfma_f32_16x16x32_bf16 a[108:111], v[140:143], v[172:175], a[108:111]
    v_mfma_f32_16x16x32_bf16 a[112:115], v[140:143], v[176:179], a[112:115]
    ds_read_b64_tr_b16 v[246:247], v35 offset:18432
    v_mfma_f32_16x16x32_bf16 a[116:119], v[140:143], v[180:183], a[116:119]
    v_mfma_f32_16x16x32_bf16 a[120:123], v[140:143], v[184:187], a[120:123]
    ds_read_b128 v[216:219], v29 offset:12288
    v_mfma_f32_16x16x32_bf16 a[124:127], v[140:143], v[188:191], a[124:127]
    ds_read_b64_tr_b16 v[248:249], v36 offset:16384
    v_mfma_f32_16x16x32_bf16 a[128:131], v[144:147], v[160:163], a[128:131]
    v_mfma_f32_16x16x32_bf16 a[132:135], v[144:147], v[164:167], a[132:135]
    ds_read_b64_tr_b16 v[250:251], v36 offset:18432
    v_mfma_f32_16x16x32_bf16 a[136:139], v[144:147], v[168:171], a[136:139]
    v_mfma_f32_16x16x32_bf16 a[140:143], v[144:147], v[172:175], a[140:143]
    ds_read_b128 v[220:223], v29 offset:14336
    v_mfma_f32_16x16x32_bf16 a[144:147], v[144:147], v[176:179], a[144:147]
    ds_read_b64_tr_b16 v[252:253], v37 offset:16384
    v_mfma_f32_16x16x32_bf16 a[148:151], v[144:147], v[180:183], a[148:151]
    v_mfma_f32_16x16x32_bf16 a[152:155], v[144:147], v[184:187], a[152:155]
    ds_read_b64_tr_b16 v[254:255], v37 offset:18432
    v_mfma_f32_16x16x32_bf16 a[156:159], v[144:147], v[188:191], a[156:159]
    v_mfma_f32_16x16x32_bf16 a[160:163], v[148:151], v[160:163], a[160:163]
    v_mfma_f32_16x16x32_bf16 a[164:167], v[148:151], v[164:167], a[164:167]
    v_mfma_f32_16x16x32_bf16 a[168:171], v[148:151], v[168:171], a[168:171]
    v_mfma_f32_16x16x32_bf16 a[172:175], v[148:151], v[172:175], a[172:175]
    v_mfma_f32_16x16x32_bf16 a[176:179], v[148:151], v[176:179], a[176:179]
    v_mfma_f32_16x16x32_bf16 a[180:183], v[148:151], v[180:183], a[180:183]
    v_mfma_f32_16x16x32_bf16 a[184:187], v[148:151], v[184:187], a[184:187]
    v_mfma_f32_16x16x32_bf16 a[188:191], v[148:151], v[188:191], a[188:191]
    v_mfma_f32_16x16x32_bf16 a[192:195], v[152:155], v[160:163], a[192:195]
    v_mfma_f32_16x16x32_bf16 a[196:199], v[152:155], v[164:167], a[196:199]
    v_mfma_f32_16x16x32_bf16 a[200:203], v[152:155], v[168:171], a[200:203]
    v_mfma_f32_16x16x32_bf16 a[204:207], v[152:155], v[172:175], a[204:207]
    v_mfma_f32_16x16x32_bf16 a[208:211], v[152:155], v[176:179], a[208:211]
    v_mfma_f32_16x16x32_bf16 a[212:215], v[152:155], v[180:183], a[212:215]
    v_mfma_f32_16x16x32_bf16 a[216:219], v[152:155], v[184:187], a[216:219]
    v_mfma_f32_16x16x32_bf16 a[220:223], v[152:155], v[188:191], a[220:223]
    v_mfma_f32_16x16x32_bf16 a[224:227], v[156:159], v[160:163], a[224:227]
    v_mfma_f32_16x16x32_bf16 a[228:231], v[156:159], v[164:167], a[228:231]
    v_mfma_f32_16x16x32_bf16 a[232:235], v[156:159], v[168:171], a[232:235]
    v_mfma_f32_16x16x32_bf16 a[236:239], v[156:159], v[172:175], a[236:239]
    v_mfma_f32_16x16x32_bf16 a[240:243], v[156:159], v[176:179], a[240:243]
    v_mfma_f32_16x16x32_bf16 a[244:247], v[156:159], v[180:183], a[244:247]
    v_mfma_f32_16x16x32_bf16 a[248:251], v[156:159], v[184:187], a[248:251]
    v_mfma_f32_16x16x32_bf16 a[252:255], v[156:159], v[188:191], a[252:255]
    s_waitcnt vmcnt(0) lgkmcnt(0)
    s_barrier
    s_cmp_ge_u32 s49, 1024
    s_cselect_b32 s18, 0, s18
    s_cselect_b32 s22, 0, s22
    v_mfma_f32_16x16x32_bf16 a[0:3], v[192:195], v[224:227], a[0:3]
    ds_read_b128 v[128:131], v28 offset:32768
    v_mfma_f32_16x16x32_bf16 a[4:7], v[192:195], v[228:231], a[4:7]
    ds_read_b64_tr_b16 v[160:161], v30 offset:32768
    v_mfma_f32_16x16x32_bf16 a[8:11], v[192:195], v[232:235], a[8:11]
    s_add_u32 m0, s48, 0
    s_nop 0
    buffer_load_dwordx4 v10, s[16:19], s49 offen offset:0 lds
    v_mfma_f32_16x16x32_bf16 a[12:15], v[192:195], v[236:239], a[12:15]
    ds_read_b64_tr_b16 v[162:163], v30 offset:34816
    v_mfma_f32_16x16x32_bf16 a[16:19], v[192:195], v[240:243], a[16:19]
    buffer_load_dwordx4 v11, s[16:19], s49 offen offset:1024 lds
    v_mfma_f32_16x16x32_bf16 a[20:23], v[192:195], v[244:247], a[20:23]
    ds_read_b128 v[132:135], v28 offset:34816
    v_mfma_f32_16x16x32_bf16 a[24:27], v[192:195], v[248:251], a[24:27]
    ds_read_b64_tr_b16 v[164:165], v31 offset:32768
    v_mfma_f32_16x16x32_bf16 a[28:31], v[192:195], v[252:255], a[28:31]
    buffer_load_dwordx4 v12, s[16:19], s49 offen offset:2048 lds
    v_mfma_f32_16x16x32_bf16 a[32:35], v[196:199], v[224:227], a[32:35]
    ds_read_b64_tr_b16 v[166:167], v31 offset:34816
    v_mfma_f32_16x16x32_bf16 a[36:39], v[196:199], v[228:231], a[36:39]
    v_mfma_f32_16x16x32_bf16 a[40:43], v[196:199], v[232:235], a[40:43]
    ds_read_b128 v[136:139], v28 offset:36864
    buffer_load_dwordx4 v13, s[16:19], s49 offen offset:3072 lds
    v_mfma_f32_16x16x32_bf16 a[44:47], v[196:199], v[236:239], a[44:47]
    ds_read_b64_tr_b16 v[168:169], v32 offset:32768
    v_mfma_f32_16x16x32_bf16 a[48:51], v[196:199], v[240:243], a[48:51]
    v_mfma_f32_16x16x32_bf16 a[52:55], v[196:199], v[244:247], a[52:55]
    ds_read_b64_tr_b16 v[170:171], v32 offset:34816
    s_add_u32 m0, s48, 4096
    s_nop 0
    buffer_load_dwordx4 v14, s[16:19], s49 offen offset:0 lds
    v_mfma_f32_16x16x32_bf16 a[56:59], v[196:199], v[248:251], a[56:59]
    v_mfma_f32_16x16x32_bf16 a[60:63], v[196:199], v[252:255], a[60:63]
    ds_read_b128 v[140:143], v28 offset:38912
    v_mfma_f32_16x16x32_bf16 a[64:67], v[200:203], v[224:227], a[64:67]
    ds_read_b64_tr_b16 v[172:173], v33 offset:32768
    buffer_load_dwordx4 v15, s[16:19], s49 offen offset:1024 lds
    v_mfma_f32_16x16x32_bf16 a[68:71], v[200:203], v[228:231], a[68:71]
    v_mfma_f32_16x16x32_bf16 a[72:75], v[200:203], v[232:235], a[72:75]
    ds_read_b64_tr_b16 v[174:175], v33 offset:34816
    buffer_load_dwordx4 v16, s[16:19], s49 offen offset:2048 lds
    v_mfma_f32_16x16x32_bf16 a[76:79], v[200:203], v[236:239], a[76:79]
    v_mfma_f32_16x16x32_bf16 a[80:83], v[200:203], v[240:243], a[80:83]
    ds_read_b128 v[144:147], v28 offset:40960
    v_mfma_f32_16x16x32_bf16 a[84:87], v[200:203], v[244:247], a[84:87]
    ds_read_b64_tr_b16 v[176:177], v34 offset:32768
    buffer_load_dwordx4 v17, s[16:19], s49 offen offset:3072 lds
    v_mfma_f32_16x16x32_bf16 a[88:91], v[200:203], v[248:251], a[88:91]
    v_mfma_f32_16x16x32_bf16 a[92:95], v[200:203], v[252:255], a[92:95]
    ds_read_b64_tr_b16 v[178:179], v34 offset:34816
    v_mfma_f32_16x16x32_bf16 a[96:99], v[204:207], v[224:227], a[96:99]
    s_add_u32 m0, s48, 65536
    s_nop 0
    buffer_load_dwordx4 v18, s[20:23], s50 offen offset:0 lds
    v_mfma_f32_16x16x32_bf16 a[100:103], v[204:207], v[228:231], a[100:103]
    ds_read_b128 v[148:151], v28 offset:43008
    v_mfma_f32_16x16x32_bf16 a[104:107], v[204:207], v[232:235], a[104:107]
    ds_read_b64_tr_b16 v[180:181], v35 offset:32768
    v_mfma_f32_16x16x32_bf16 a[108:111], v[204:207], v[236:239], a[108:111]
    buffer_load_dwordx4 v19, s[20:23], s50 offen offset:1024 lds
    v_mfma_f32_16x16x32_bf16 a[112:115], v[204:207], v[240:243], a[112:115]
    ds_read_b64_tr_b16 v[182:183], v35 offset:34816
    v_mfma_f32_16x16x32_bf16 a[116:119], v[204:207], v[244:247], a[116:119]
    v_mfma_f32_16x16x32_bf16 a[120:123], v[204:207], v[248:251], a[120:123]
    ds_read_b128 v[152:155], v28 offset:45056
    buffer_load_dwordx4 v20, s[20:23], s50 offen offset:2048 lds
    v_mfma_f32_16x16x32_bf16 a[124:127], v[204:207], v[252:255], a[124:127]
    ds_read_b64_tr_b16 v[184:185], v36 offset:32768
    v_mfma_f32_16x16x32_bf16 a[128:131], v[208:211], v[224:227], a[128:131]
    v_mfma_f32_16x16x32_bf16 a[132:135], v[208:211], v[228:231], a[132:135]
    ds_read_b64_tr_b16 v[186:187], v36 offset:34816
    buffer_load_dwordx4 v21, s[20:23], s50 offen offset:3072 lds
    v_mfma_f32_16x16x32_bf16 a[136:139], v[208:211], v[232:235], a[136:139]
    v_mfma_f32_16x16x32_bf16 a[140:143], v[208:211], v[236:239], a[140:143]
    ds_read_b128 v[156:159], v28 offset:47104
    s_add_u32 m0, s48, 69632
    s_nop 0
    buffer_load_dwordx4 v22, s[20:23], s50 offen offset:0 lds
    v_mfma_f32_16x16x32_bf16 a[144:147], v[208:211], v[240:243], a[144:147]
    ds_read_b64_tr_b16 v[188:189], v37 offset:32768
    v_mfma_f32_16x16x32_bf16 a[148:151], v[208:211], v[244:247], a[148:151]
    v_mfma_f32_16x16x32_bf16 a[152:155], v[208:211], v[248:251], a[152:155]
    ds_read_b64_tr_b16 v[190:191], v37 offset:34816
    buffer_load_dwordx4 v23, s[20:23], s50 offen offset:1024 lds
    v_mfma_f32_16x16x32_bf16 a[156:159], v[208:211], v[252:255], a[156:159]
    v_mfma_f32_16x16x32_bf16 a[160:163], v[212:215], v[224:227], a[160:163]
    v_mfma_f32_16x16x32_bf16 a[164:167], v[212:215], v[228:231], a[164:167]
    buffer_load_dwordx4 v24, s[20:23], s50 offen offset:2048 lds
    v_mfma_f32_16x16x32_bf16 a[168:171], v[212:215], v[232:235], a[168:171]
    v_mfma_f32_16x16x32_bf16 a[172:175], v[212:215], v[236:239], a[172:175]
    v_mfma_f32_16x16x32_bf16 a[176:179], v[212:215], v[240:243], a[176:179]
    buffer_load_dwordx4 v25, s[20:23], s50 offen offset:3072 lds
    v_mfma_f32_16x16x32_bf16 a[180:183], v[212:215], v[244:247], a[180:183]
    v_mfma_f32_16x16x32_bf16 a[184:187], v[212:215], v[248:251], a[184:187]
    v_mfma_f32_16x16x32_bf16 a[188:191], v[212:215], v[252:255], a[188:191]
    s_add_u32 s49, s49, 128
    s_add_u32 s50, s50, 0x80000
    v_mfma_f32_16x16x32_bf16 a[192:195], v[216:219], v[224:227], a[192:195]
    v_mfma_f32_16x16x32_bf16 a[196:199], v[216:219], v[228:231], a[196:199]
    v_mfma_f32_16x16x32_bf16 a[200:203], v[216:219], v[232:235], a[200:203]
    v_mfma_f32_16x16x32_bf16 a[204:207], v[216:219], v[236:239], a[204:207]
    v_mfma_f32_16x16x32_bf16 a[208:211], v[216:219], v[240:243], a[208:211]
    v_mfma_f32_16x16x32_bf16 a[212:215], v[216:219], v[244:247], a[212:215]
    v_mfma_f32_16x16x32_bf16 a[216:219], v[216:219], v[248:251], a[216:219]
    v_mfma_f32_16x16x32_bf16 a[220:223], v[216:219], v[252:255], a[220:223]
    v_mfma_f32_16x16x32_bf16 a[224:227], v[220:223], v[224:227], a[224:227]
    v_mfma_f32_16x16x32_bf16 a[228:231], v[220:223], v[228:231], a[228:231]
    v_mfma_f32_16x16x32_bf16 a[232:235], v[220:223], v[232:235], a[232:235]
    v_mfma_f32_16x16x32_bf16 a[236:239], v[220:223], v[236:239], a[236:239]
    v_mfma_f32_16x16x32_bf16 a[240:243], v[220:223], v[240:243], a[240:243]
    v_mfma_f32_16x16x32_bf16 a[244:247], v[220:223], v[244:247], a[244:247]
    v_mfma_f32_16x16x32_bf16 a[248:251], v[220:223], v[248:251], a[248:251]
    v_mfma_f32_16x16x32_bf16 a[252:255], v[220:223], v[252:255], a[252:255]
    s_waitcnt lgkmcnt(0)
    v_mfma_f32_16x16x32_bf16 a[0:3], v[128:131], v[160:163], a[0:3]
    ds_read_b128 v[192:195], v29 offset:32768
    v_mfma_f32_16x16x32_bf16 a[4:7], v[128:131], v[164:167], a[4:7]
    ds_read_b64_tr_b16 v[224:225], v30 offset:49152
    v_mfma_f32_16x16x32_bf16 a[8:11], v[128:131], v[168:171], a[8:11]
    v_mfma_f32_16x16x32_bf16 a[12:15], v[128:131], v[172:175], a[12:15]
    ds_read_b64_tr_b16 v[226:227], v30 offset:51200
    v_mfma_f32_16x16x32_bf16 a[16:19], v[128:131], v[176:179], a[16:19]
    v_mfma_f32_16x16x32_bf16 a[20:23], v[128:131], v[180:183], a[20:23]
    ds_read_b128 v[196:199], v29 offset:34816
    v_mfma_f32_16x16x32_bf16 a[24:27], v[128:131], v[184:187], a[24:27]
    ds_read_b64_tr_b16 v[228:229], v31 offset:49152
    v_mfma_f32_16x16x32_bf16 a[28:31], v[128:131], v[188:191], a[28:31]
    v_mfma_f32_16x16x32_bf16 a[32:35], v[132:135], v[160:163], a[32:35]
    ds_read_b64_tr_b16 v[230:231], v31 offset:51200
    v_mfma_f32_16x16x32_bf16 a[36:39], v[132:135], v[164:167], a[36:39]
    v_mfma_f32_16x16x32_bf16 a[40:43], v[132:135], v[168:171], a[40:43]
    ds_read_b128 v[200:203], v29 offset:36864
    v_mfma_f32_16x16x32_bf16 a[44:47], v[132:135], v[172:175], a[44:47]
    ds_read_b64_tr_b16 v[232:233], v32 offset:49152
    v_mfma_f32_16x16x32_bf16 a[48:51], v[132:135], v[176:179], a[48:51]
    v_mfma_f32_16x16x32_bf16 a[52:55], v[132:135], v[180:183], a[52:55]
    ds_read_b64_tr_b16 v[234:235], v32 offset:51200
    v_mfma_f32_16x16x32_bf16 a[56:59], v[132:135], v[184:187], a[56:59]
    v_mfma_f32_16x16x32_bf16 a[60:63], v[132:135], v[188:191], a[60:63]
    ds_read_b128 v[204:207], v29 offset:38912
    v_mfma_f32_16x16x32_bf16 a[64:67], v[136:139], v[160:163], a[64:67]
    ds_read_b64_tr_b16 v[236:237], v33 offset:49152
    v_mfma_f32_16x16x32_bf16 a[68:71], v[136:139], v[164:167], a[68:71]
    v_mfma_f32_16x16x32_bf16 a[72:75], v[136:139], v[168:171], a[72:75]
    ds_read_b64_tr_b16 v[238:239], v33 offset:51200
    v_mfma_f32_16x16x32_bf16 a[76:79], v[136:139], v[172:175], a[76:79]
    v_mfma_f32_16x16x32_bf16 a[80:83], v[136:139], v[176:179], a[80:83]
    ds_read_b128 v[208:211], v29 offset:40960
    v_mfma_f32_16x16x32_bf16 a[84:87], v[136:139], v[180:183], a[84:87]
    ds_read_b64_tr_b16 v[240:241], v34 offset:49152
    v_mfma_f32_16x16x32_bf16 a[88:91], v[136:139], v[184:187], a[88:91]
    v_mfma_f32_16x16x32_bf16 a[92:95], v[136:139], v[188:191], a[92:95]
    ds_read_b64_tr_b16 v[242:243], v34 offset:51200
    v_mfma_f32_16x16x32_bf16 a[96:99], v[140:143], v[160:163], a[96:99]
    v_mfma_f32_16x16x32_bf16 a[100:103], v[140:143], v[164:167], a[100:103]
    ds_read_b128 v[212:215], v29 offset:43008
    v_mfma_f32_16x16x32_bf16 a[104:107], v[140:143], v[168:171], a[104:107]
    ds_read_b64_tr_b16 v[244:245], v35 offset:49152
    v_mfma_f32_16x16x32_bf16 a[108:111], v[140:143], v[172:175], a[108:111]
    v_mfma_f32_16x16x32_bf16 a[112:115], v[140:143], v[176:179], a[112:115]
    ds_read_b64_tr_b16 v[246:247], v35 offset:51200
    v_mfma_f32_16x16x32_bf16 a[116:119], v[140:143], v[180:183], a[116:119]
    v_mfma_f32_16x16x32_bf16 a[120:123], v[140:143], v[184:187], a[120:123]
    ds_read_b128 v[216:219], v29 offset:45056
    v_mfma_f32_16x16x32_bf16 a[124:127], v[140:143], v[188:191], a[124:127]
    ds_read_b64_tr_b16 v[248:249], v36 offset:49152
    v_mfma_f32_16x16x32_bf16 a[128:131], v[144:147], v[160:163], a[128:131]
    v_mfma_f32_16x16x32_bf16 a[132:135], v[144:147], v[164:167], a[132:135]
    ds_read_b64_tr_b16 v[250:251], v36 offset:51200
    v_mfma_f32_16x16x32_bf16 a[136:139], v[144:147], v[168:171], a[136:139]
    v_mfma_f32_16x16x32_bf16 a[140:143], v[144:147], v[172:175], a[140:143]
    ds_read_b128 v[220:223], v29 offset:47104
    v_mfma_f32_16x16x32_bf16 a[144:147], v[144:147], v[176:179], a[144:147]
    ds_read_b64_tr_b16 v[252:253], v37 offset:49152
    v_mfma_f32_16x16x32_bf16 a[148:151], v[144:147], v[180:183], a[148:151]
    v_mfma_f32_16x16x32_bf16 a[152:155], v[144:147], v[184:187], a[152:155]
    ds_read_b64_tr_b16 v[254:255], v37 offset:51200
    v_mfma_f32_16x16x32_bf16 a[156:159], v[144:147], v[188:191], a[156:159]
    v_mfma_f32_16x16x32_bf16 a[160:163], v[148:151], v[160:163], a[160:163]
    v_mfma_f32_16x16x32_bf16 a[164:167], v[148:151], v[164:167], a[164:167]
    v_mfma_f32_16x16x32_bf16 a[168:171], v[148:151], v[168:171], a[168:171]
    v_mfma_f32_16x16x32_bf16 a[172:175], v[148:151], v[172:175], a[172:175]
    v_mfma_f32_16x16x32_bf16 a[176:179], v[148:151], v[176:179], a[176:179]
    v_mfma_f32_16x16x32_bf16 a[180:183], v[148:151], v[180:183], a[180:183]
    v_mfma_f32_16x16x32_bf16 a[184:187], v[148:151], v[184:187], a[184:187]
    v_mfma_f32_16x16x32_bf16 a[188:191], v[148:151], v[188:191], a[188:191]
    v_mfma_f32_16x16x32_bf16 a[192:195], v[152:155], v[160:163], a[192:195]
    v_mfma_f32_16x16x32_bf16 a[196:199], v[152:155], v[164:167], a[196:199]
    v_mfma_f32_16x16x32_bf16 a[200:203], v[152:155], v[168:171], a[200:203]
    v_mfma_f32_16x16x32_bf16 a[204:207], v[152:155], v[172:175], a[204:207]
    v_mfma_f32_16x16x32_bf16 a[208:211], v[152:155], v[176:179], a[208:211]
    v_mfma_f32_16x16x32_bf16 a[212:215], v[152:155], v[180:183], a[212:215]
    v_mfma_f32_16x16x32_bf16 a[216:219], v[152:155], v[184:187], a[216:219]
    v_mfma_f32_16x16x32_bf16 a[220:223], v[152:155], v[188:191], a[220:223]
    v_mfma_f32_16x16x32_bf16 a[224:227], v[156:159], v[160:163], a[224:227]
    v_mfma_f32_16x16x32_bf16 a[228:231], v[156:159], v[164:167], a[228:231]
    v_mfma_f32_16x16x32_bf16 a[232:235], v[156:159], v[168:171], a[232:235]
    v_mfma_f32_16x16x32_bf16 a[236:239], v[156:159], v[172:175], a[236:239]
    v_mfma_f32_16x16x32_bf16 a[240:243], v[156:159], v[176:179], a[240:243]
    v_mfma_f32_16x16x32_bf16 a[244:247], v[156:159], v[180:183], a[244:247]
    v_mfma_f32_16x16x32_bf16 a[248:251], v[156:159], v[184:187], a[248:251]
    v_mfma_f32_16x16x32_bf16 a[252:255], v[156:159], v[188:191], a[252:255]
    s_waitcnt vmcnt(0) lgkmcnt(0)
    s_barrier
    v_mfma_f32_16x16x32_bf16 a[0:3], v[192:195], v[224:227], a[0:3]
    ds_read_b128 v[128:131], v28 offset:0
    v_mfma_f32_16x16x32_bf16 a[4:7], v[192:195], v[228:231], a[4:7]
    ds_read_b64_tr_b16 v[160:161], v30 offset:0
    v_mfma_f32_16x16x32_bf16 a[8:11], v[192:195], v[232:235], a[8:11]
    s_add_u32 m0, s48, 32768
    s_nop 0
    buffer_load_dwordx4 v10, s[16:19], s49 offen offset:0 lds
    v_mfma_f32_16x16x32_bf16 a[12:15], v[192:195], v[236:239], a[12:15]
    ds_read_b64_tr_b16 v[162:163], v30 offset:2048
    v_mfma_f32_16x16x32_bf16 a[16:19], v[192:195], v[240:243], a[16:19]
    buffer_load_dwordx4 v11, s[16:19], s49 offen offset:1024 lds
    v_mfma_f32_16x16x32_bf16 a[20:23], v[192:195], v[244:247], a[20:23]
    ds_read_b128 v[132:135], v28 offset:2048
    v_mfma_f32_16x16x32_bf16 a[24:27], v[192:195], v[248:251], a[24:27]
    ds_read_b64_tr_b16 v[164:165], v31 offset:0
    v_mfma_f32_16x16x32_bf16 a[28:31], v[192:195], v[252:255], a[28:31]
    buffer_load_dwordx4 v12, s[16:19], s49 offen offset:2048 lds
    v_mfma_f32_16x16x32_bf16 a[32:35], v[196:199], v[224:227], a[32:35]
    ds_read_b64_tr_b16 v[166:167], v31 offset:2048
    v_mfma_f32_16x16x32_bf16 a[36:39], v[196:199], v[228:231], a[36:39]
    v_mfma_f32_16x16x32_bf16 a[40:43], v[196:199], v[232:235], a[40:43]
    ds_read_b128 v[136:139], v28 offset:4096
    buffer_load_dwordx4 v13, s[16:19], s49 offen offset:3072 lds
    v_mfma_f32_16x16x32_bf16 a[44:47], v[196:199], v[236:239], a[44:47]
    ds_read_b64_tr_b16 v[168:169], v32 offset:0
    v_mfma_f32_16x16x32_bf16 a[48:51], v[196:199], v[240:243], a[48:51]
    v_mfma_f32_16x16x32_bf16 a[52:55], v[196:199], v[244:247], a[52:55]
    ds_read_b64_tr_b16 v[170:171], v32 offset:2048
    s_add_u32 m0, s48, 36864
    s_nop 0
    buffer_load_dwordx4 v14, s[16:19], s49 offen offset:0 lds
    v_mfma_f32_16x16x32_bf16 a[56:59], v[196:199], v[248:251], a[56:59]
    v_mfma_f32_16x16x32_bf16 a[60:63], v[196:199], v[252:255], a[60:63]
    ds_read_b128 v[140:143], v28 offset:6144
    v_mfma_f32_16x16x32_bf16 a[64:67], v[200:203], v[224:227], a[64:67]
    ds_read_b64_tr_b16 v[172:173], v33 offset:0
    buffer_load_dwordx4 v15, s[16:19], s49 offen offset:1024 lds
    v_mfma_f32_16x16x32_bf16 a[68:71], v[200:203], v[228:231], a[68:71]
    v_mfma_f32_16x16x32_bf16 a[72:75], v[200:203], v[232:235], a[72:75]
    ds_read_b64_tr_b16 v[174:175], v33 offset:2048
    buffer_load_dwordx4 v16, s[16:19], s49 offen offset:2048 lds
    v_mfma_f32_16x16x32_bf16 a[76:79], v[200:203], v[236:239], a[76:79]
    v_mfma_f32_16x16x32_bf16 a[80:83], v[200:203], v[240:243], a[80:83]
    ds_read_b128 v[144:147], v28 offset:8192
    v_mfma_f32_16x16x32_bf16 a[84:87], v[200:203], v[244:247], a[84:87]
    ds_read_b64_tr_b16 v[176:177], v34 offset:0
    buffer_load_dwordx4 v17, s[16:19], s49 offen offset:3072 lds
    v_mfma_f32_16x16x32_bf16 a[88:91], v[200:203], v[248:251], a[88:91]
    v_mfma_f32_16x16x32_bf16 a[92:95], v[200:203], v[252:255], a[92:95]
    ds_read_b64_tr_b16 v[178:179], v34 offset:2048
    v_mfma_f32_16x16x32_bf16 a[96:99], v[204:207], v[224:227], a[96:99]
    s_add_u32 m0, s48, 98304
    s_nop 0
    buffer_load_dwordx4 v18, s[20:23], s50 offen offset:0 lds
    v_mfma_f32_16x16x32_bf16 a[100:103], v[204:207], v[228:231], a[100:103]
    ds_read_b128 v[148:151], v28 offset:10240
    v_mfma_f32_16x16x32_bf16 a[104:107], v[204:207], v[232:235], a[104:107]
    ds_read_b64_tr_b16 v[180:181], v35 offset:0
    v_mfma_f32_16x16x32_bf16 a[108:111], v[204:207], v[236:239], a[108:111]
    buffer_load_dwordx4 v19, s[20:23], s50 offen offset:1024 lds
    v_mfma_f32_16x16x32_bf16 a[112:115], v[204:207], v[240:243], a[112:115]
    ds_read_b64_tr_b16 v[182:183], v35 offset:2048
    v_mfma_f32_16x16x32_bf16 a[116:119], v[204:207], v[244:247], a[116:119]
    v_mfma_f32_16x16x32_bf16 a[120:123], v[204:207], v[248:251], a[120:123]
    ds_read_b128 v[152:155], v28 offset:12288
    buffer_load_dwordx4 v20, s[20:23], s50 offen offset:2048 lds
    v_mfma_f32_16x16x32_bf16 a[124:127], v[204:207], v[252:255], a[124:127]
    ds_read_b64_tr_b16 v[184:185], v36 offset:0
    v_mfma_f32_16x16x32_bf16 a[128:131], v[208:211], v[224:227], a[128:131]
    v_mfma_f32_16x16x32_bf16 a[132:135], v[208:211], v[228:231], a[132:135]
    ds_read_b64_tr_b16 v[186:187], v36 offset:2048
    buffer_load_dwordx4 v21, s[20:23], s50 offen offset:3072 lds
    v_mfma_f32_16x16x32_bf16 a[136:139], v[208:211], v[232:235], a[136:139]
    v_mfma_f32_16x16x32_bf16 a[140:143], v[208:211], v[236:239], a[140:143]
    ds_read_b128 v[156:159], v28 offset:14336
    s_add_u32 m0, s48, 102400
    s_nop 0
    buffer_load_dwordx4 v22, s[20:23], s50 offen offset:0 lds
    v_mfma_f32_16x16x32_bf16 a[144:147], v[208:211], v[240:243], a[144:147]
    ds_read_b64_tr_b16 v[188:189], v37 offset:0
    v_mfma_f32_16x16x32_bf16 a[148:151], v[208:211], v[244:247], a[148:151]
    v_mfma_f32_16x16x32_bf16 a[152:155], v[208:211], v[248:251], a[152:155]
    ds_read_b64_tr_b16 v[190:191], v37 offset:2048
    buffer_load_dwordx4 v23, s[20:23], s50 offen offset:1024 lds
    v_mfma_f32_16x16x32_bf16 a[156:159], v[208:211], v[252:255], a[156:159]
    v_mfma_f32_16x16x32_bf16 a[160:163], v[212:215], v[224:227], a[160:163]
    v_mfma_f32_16x16x32_bf16 a[164:167], v[212:215], v[228:231], a[164:167]
    buffer_load_dwordx4 v24, s[20:23], s50 offen offset:2048 lds
    v_mfma_f32_16x16x32_bf16 a[168:171], v[212:215], v[232:235], a[168:171]
    v_mfma_f32_16x16x32_bf16 a[172:175], v[212:215], v[236:239], a[172:175]
    v_mfma_f32_16x16x32_bf16 a[176:179], v[212:215], v[240:243], a[176:179]
    buffer_load_dwordx4 v25, s[20:23], s50 offen offset:3072 lds
    v_mfma_f32_16x16x32_bf16 a[180:183], v[212:215], v[244:247], a[180:183]
    v_mfma_f32_16x16x32_bf16 a[184:187], v[212:215], v[248:251], a[184:187]
    v_mfma_f32_16x16x32_bf16 a[188:191], v[212:215], v[252:255], a[188:191]
    s_add_u32 s49, s49, 128
    s_add_u32 s50, s50, 0x80000
    v_mfma_f32_16x16x32_bf16 a[192:195], v[216:219], v[224:227], a[192:195]
    v_mfma_f32_16x16x32_bf16 a[196:199], v[216:219], v[228:231], a[196:199]
    v_mfma_f32_16x16x32_bf16 a[200:203], v[216:219], v[232:235], a[200:203]
    v_mfma_f32_16x16x32_bf16 a[204:207], v[216:219], v[236:239], a[204:207]
    v_mfma_f32_16x16x32_bf16 a[208:211], v[216:219], v[240:243], a[208:211]
    v_mfma_f32_16x16x32_bf16 a[212:215], v[216:219], v[244:247], a[212:215]
    v_mfma_f32_16x16x32_bf16 a[216:219], v[216:219], v[248:251], a[216:219]
    v_mfma_f32_16x16x32_bf16 a[220:223], v[216:219], v[252:255], a[220:223]
    v_mfma_f32_16x16x32_bf16 a[224:227], v[220:223], v[224:227], a[224:227]
    v_mfma_f32_16x16x32_bf16 a[228:231], v[220:223], v[228:231], a[228:231]
    v_mfma_f32_16x16x32_bf16 a[232:235], v[220:223], v[232:235], a[232:235]
    v_mfma_f32_16x16x32_bf16 a[236:239], v[220:223], v[236:239], a[236:239]
    v_mfma_f32_16x16x32_bf16 a[240:243], v[220:223], v[240:243], a[240:243]
    v_mfma_f32_16x16x32_bf16 a[244:247], v[220:223], v[244:247], a[244:247]
    v_mfma_f32_16x16x32_bf16 a[248:251], v[220:223], v[248:251], a[248:251]
    v_mfma_f32_16x16x32_bf16 a[252:255], v[220:223], v[252:255], a[252:255]
    s_add_u32 s51, s51, 1
    s_cmp_lt_u32 s51, 4
    s_cbranch_scc1 k1_loop_5
    s_lshl_b32 s47, s44, 1
    s_lshr_b32 s52, s46, 1
    s_add_u32 s47, s47, s52
    s_lshl_b32 s47, s47, 14
    s_lshl_b32 s52, s42, 1
    s_and_b32 s53, s46, 1
    s_add_u32 s52, s52, s53
    s_lshl_b32 s52, s52, 20
    s_add_u32 s47, s47, s52
    s_add_u32 s47, s47, 0x1000000
    v_lshlrev_b32 v3, 4, v2
    s_nop 7
    v_accvgpr_read_b32 v44, a0
    v_accvgpr_read_b32 v45, a1
    v_accvgpr_read_b32 v46, a2
    v_accvgpr_read_b32 v47, a3
    v_accvgpr_read_b32 v48, a32
    v_accvgpr_read_b32 v49, a33
    v_accvgpr_read_b32 v50, a34
    v_accvgpr_read_b32 v51, a35
    v_cvt_pk_bf16_f32 v40, v44, v45
    v_cvt_pk_bf16_f32 v41, v46, v47
    v_cvt_pk_bf16_f32 v42, v48, v49
    v_cvt_pk_bf16_f32 v43, v50, v51
    s_add_u32 s52, s47, 0
    buffer_store_dwordx4 v[40:43], v3, s[32:35], s52 offen offset:0
    v_accvgpr_read_b32 v56, a4
    v_accvgpr_read_b32 v57, a5
    v_accvgpr_read_b32 v58, a6
    v_accvgpr_read_b32 v59, a7
    v_accvgpr_read_b32 v60, a36
    v_accvgpr_read_b32 v61, a37
    v_accvgpr_read_b32 v62, a38
    v_accvgpr_read_b32 v63, a39
    v_cvt_pk_bf16_f32 v52, v56, v57
    v_cvt_pk_bf16_f32 v53, v58, v59
    v_cvt_pk_bf16_f32 v54, v60, v61
    v_cvt_pk_bf16_f32 v55, v62, v63
    s_add_u32 s52, s47, 0
    buffer_store_dwordx4 v[52:55], v3, s[32:35], s52 offen offset:1024
    v_accvgpr_read_b32 v68, a8
    v_accvgpr_read_b32 v69, a9
    v_accvgpr_read_b32 v70, a10
    v_accvgpr_read_b32 v71, a11
    v_accvgpr_read_b32 v72, a40
    v_accvgpr_read_b32 v73, a41
    v_accvgpr_read_b32 v74, a42
    v_accvgpr_read_b32 v75, a43
    v_cvt_pk_bf16_f32 v64, v68, v69
    v_cvt_pk_bf16_f32 v65, v70, v71
    v_cvt_pk_bf16_f32 v66, v72, v73
    v_cvt_pk_bf16_f32 v67, v74, v75
    s_add_u32 s52, s47, 0
    buffer_store_dwordx4 v[64:67], v3, s[32:35], s52 offen offset:2048
    v_accvgpr_read_b32 v80, a12
    v_accvgpr_read_b32 v81, a13
    v_accvgpr_read_b32 v82, a14
    v_accvgpr_read_b32 v83, a15
    v_accvgpr_read_b32 v84, a44
    v_accvgpr_read_b32 v85, a45
    v_accvgpr_read_b32 v86, a46
    v_accvgpr_read_b32 v87, a47
    v_cvt_pk_bf16_f32 v76, v80, v81
    v_cvt_pk_bf16_f32 v77, v82, v83
    v_cvt_pk_bf16_f32 v78, v84, v85
    v_cvt_pk_bf16_f32 v79, v86, v87
    s_add_u32 s52, s47, 0
    buffer_store_dwordx4 v[76:79], v3, s[32:35], s52 offen offset:3072
    v_accvgpr_read_b32 v44, a16
    v_accvgpr_read_b32 v45, a17
    v_accvgpr_read_b32 v46, a18
    v_accvgpr_read_b32 v47, a19
    v_accvgpr_read_b32 v48, a48
    v_accvgpr_read_b32 v49, a49
    v_accvgpr_read_b32 v50, a50
    v_accvgpr_read_b32 v51, a51
    v_cvt_pk_bf16_f32 v40, v44, v45
    v_cvt_pk_bf16_f32 v41, v46, v47
    v_cvt_pk_bf16_f32 v42, v48, v49
    v_cvt_pk_bf16_f32 v43, v50, v51
    s_add_u32 s52, s47, 4096
    buffer_store_dwordx4 v[40:43], v3, s[32:35], s52 offen offset:0
    v_accvgpr_read_b32 v56, a20
    v_accvgpr_read_b32 v57, a21
    v_accvgpr_read_b32 v58, a22
    v_accvgpr_read_b32 v59, a23
    v_accvgpr_read_b32 v60, a52
    v_accvgpr_read_b32 v61, a53
    v_accvgpr_read_b32 v62, a54
    v_accvgpr_read_b32 v63, a55
    v_cvt_pk_bf16_f32 v52, v56, v57
    v_cvt_pk_bf16_f32 v53, v58, v59
    v_cvt_pk_bf16_f32 v54, v60, v61
    v_cvt_pk_bf16_f32 v55, v62, v63
    s_add_u32 s52, s47, 4096
    buffer_store_dwordx4 v[52:55], v3, s[32:35], s52 offen offset:1024
    v_accvgpr_read_b32 v68, a24
    v_accvgpr_read_b32 v69, a25
    v_accvgpr_read_b32 v70, a26
    v_accvgpr_read_b32 v71, a27
    v_accvgpr_read_b32 v72, a56
    v_accvgpr_read_b32 v73, a57
    v_accvgpr_read_b32 v74, a58
    v_accvgpr_read_b32 v75, a59
    v_cvt_pk_bf16_f32 v64, v68, v69
    v_cvt_pk_bf16_f32 v65, v70, v71
    v_cvt_pk_bf16_f32 v66, v72, v73
    v_cvt_pk_bf16_f32 v67, v74, v75
    s_add_u32 s52, s47, 4096
    buffer_store_dwordx4 v[64:67], v3, s[32:35], s52 offen offset:2048
    v_accvgpr_read_b32 v80, a28
    v_accvgpr_read_b32 v81, a29
    v_accvgpr_read_b32 v82, a30
    v_accvgpr_read_b32 v83, a31
    v_accvgpr_read_b32 v84, a60
    v_accvgpr_read_b32 v85, a61
    v_accvgpr_read_b32 v86, a62
    v_accvgpr_read_b32 v87, a63
    v_cvt_pk_bf16_f32 v76, v80, v81
    v_cvt_pk_bf16_f32 v77, v82, v83
    v_cvt_pk_bf16_f32 v78, v84, v85
    v_cvt_pk_bf16_f32 v79, v86, v87
    s_add_u32 s52, s47, 4096
    buffer_store_dwordx4 v[76:79], v3, s[32:35], s52 offen offset:3072
    v_accvgpr_read_b32 v44, a64
    v_accvgpr_read_b32 v45, a65
    v_accvgpr_read_b32 v46, a66
    v_accvgpr_read_b32 v47, a67
    v_accvgpr_read_b32 v48, a96
    v_accvgpr_read_b32 v49, a97
    v_accvgpr_read_b32 v50, a98
    v_accvgpr_read_b32 v51, a99
    v_cvt_pk_bf16_f32 v40, v44, v45
    v_cvt_pk_bf16_f32 v41, v46, v47
    v_cvt_pk_bf16_f32 v42, v48, v49
    v_cvt_pk_bf16_f32 v43, v50, v51
    s_add_u32 s52, s47, 8192
    buffer_store_dwordx4 v[40:43], v3, s[32:35], s52 offen offset:0
    v_accvgpr_read_b32 v56, a68
    v_accvgpr_read_b32 v57, a69
    v_accvgpr_read_b32 v58, a70
    v_accvgpr_read_b32 v59, a71
    v_accvgpr_read_b32 v60, a100
    v_accvgpr_read_b32 v61, a101
    v_accvgpr_read_b32 v62, a102
    v_accvgpr_read_b32 v63, a103
    v_cvt_pk_bf16_f32 v52, v56, v57
    v_cvt_pk_bf16_f32 v53, v58, v59
    v_cvt_pk_bf16_f32 v54, v60, v61
    v_cvt_pk_bf16_f32 v55, v62, v63
    s_add_u32 s52, s47, 8192
    buffer_store_dwordx4 v[52:55], v3, s[32:35], s52 offen offset:1024
    v_accvgpr_read_b32 v68, a72
    v_accvgpr_read_b32 v69, a73
    v_accvgpr_read_b32 v70, a74
    v_accvgpr_read_b32 v71, a75
    v_accvgpr_read_b32 v72, a104
    v_accvgpr_read_b32 v73, a105
    v_accvgpr_read_b32 v74, a106
    v_accvgpr_read_b32 v75, a107
    v_cvt_pk_bf16_f32 v64, v68, v69
    v_cvt_pk_bf16_f32 v65, v70, v71
    v_cvt_pk_bf16_f32 v66, v72, v73
    v_cvt_pk_bf16_f32 v67, v74, v75
    s_add_u32 s52, s47, 8192
    buffer_store_dwordx4 v[64:67], v3, s[32:35], s52 offen offset:2048
    v_accvgpr_read_b32 v80, a76
    v_accvgpr_read_b32 v81, a77
    v_accvgpr_read_b32 v82, a78
    v_accvgpr_read_b32 v83, a79
    v_accvgpr_read_b32 v84, a108
    v_accvgpr_read_b32 v85, a109
    v_accvgpr_read_b32 v86, a110
    v_accvgpr_read_b32 v87, a111
    v_cvt_pk_bf16_f32 v76, v80, v81
    v_cvt_pk_bf16_f32 v77, v82, v83
    v_cvt_pk_bf16_f32 v78, v84, v85
    v_cvt_pk_bf16_f32 v79, v86, v87
    s_add_u32 s52, s47, 8192
    buffer_store_dwordx4 v[76:79], v3, s[32:35], s52 offen offset:3072
    v_accvgpr_read_b32 v44, a80
    v_accvgpr_read_b32 v45, a81
    v_accvgpr_read_b32 v46, a82
    v_accvgpr_read_b32 v47, a83
    v_accvgpr_read_b32 v48, a112
    v_accvgpr_read_b32 v49, a113
    v_accvgpr_read_b32 v50, a114
    v_accvgpr_read_b32 v51, a115
    v_cvt_pk_bf16_f32 v40, v44, v45
    v_cvt_pk_bf16_f32 v41, v46, v47
    v_cvt_pk_bf16_f32 v42, v48, v49
    v_cvt_pk_bf16_f32 v43, v50, v51
    s_add_u32 s52, s47, 12288
    buffer_store_dwordx4 v[40:43], v3, s[32:35], s52 offen offset:0
    v_accvgpr_read_b32 v56, a84
    v_accvgpr_read_b32 v57, a85
    v_accvgpr_read_b32 v58, a86
    v_accvgpr_read_b32 v59, a87
    v_accvgpr_read_b32 v60, a116
    v_accvgpr_read_b32 v61, a117
    v_accvgpr_read_b32 v62, a118
    v_accvgpr_read_b32 v63, a119
    v_cvt_pk_bf16_f32 v52, v56, v57
    v_cvt_pk_bf16_f32 v53, v58, v59
    v_cvt_pk_bf16_f32 v54, v60, v61
    v_cvt_pk_bf16_f32 v55, v62, v63
    s_add_u32 s52, s47, 12288
    buffer_store_dwordx4 v[52:55], v3, s[32:35], s52 offen offset:1024
    v_accvgpr_read_b32 v68, a88
    v_accvgpr_read_b32 v69, a89
    v_accvgpr_read_b32 v70, a90
    v_accvgpr_read_b32 v71, a91
    v_accvgpr_read_b32 v72, a120
    v_accvgpr_read_b32 v73, a121
    v_accvgpr_read_b32 v74, a122
    v_accvgpr_read_b32 v75, a123
    v_cvt_pk_bf16_f32 v64, v68, v69
    v_cvt_pk_bf16_f32 v65, v70, v71
    v_cvt_pk_bf16_f32 v66, v72, v73
    v_cvt_pk_bf16_f32 v67, v74, v75
    s_add_u32 s52, s47, 12288
    buffer_store_dwordx4 v[64:67], v3, s[32:35], s52 offen offset:2048
    v_accvgpr_read_b32 v80, a92
    v_accvgpr_read_b32 v81, a93
    v_accvgpr_read_b32 v82, a94
    v_accvgpr_read_b32 v83, a95
    v_accvgpr_read_b32 v84, a124
    v_accvgpr_read_b32 v85, a125
    v_accvgpr_read_b32 v86, a126
    v_accvgpr_read_b32 v87, a127
    v_cvt_pk_bf16_f32 v76, v80, v81
    v_cvt_pk_bf16_f32 v77, v82, v83
    v_cvt_pk_bf16_f32 v78, v84, v85
    v_cvt_pk_bf16_f32 v79, v86, v87
    s_add_u32 s52, s47, 12288
    buffer_store_dwordx4 v[76:79], v3, s[32:35], s52 offen offset:3072
    v_accvgpr_read_b32 v44, a128
    v_accvgpr_read_b32 v45, a129
    v_accvgpr_read_b32 v46, a130
    v_accvgpr_read_b32 v47, a131
    v_accvgpr_read_b32 v48, a160
    v_accvgpr_read_b32 v49, a161
    v_accvgpr_read_b32 v50, a162
    v_accvgpr_read_b32 v51, a163
    v_cvt_pk_bf16_f32 v40, v44, v45
    v_cvt_pk_bf16_f32 v41, v46, v47
    v_cvt_pk_bf16_f32 v42, v48, v49
    v_cvt_pk_bf16_f32 v43, v50, v51
    s_add_u32 s52, s47, 524288
    buffer_store_dwordx4 v[40:43], v3, s[32:35], s52 offen offset:0
    v_accvgpr_read_b32 v56, a132
    v_accvgpr_read_b32 v57, a133
    v_accvgpr_read_b32 v58, a134
    v_accvgpr_read_b32 v59, a135
    v_accvgpr_read_b32 v60, a164
    v_accvgpr_read_b32 v61, a165
    v_accvgpr_read_b32 v62, a166
    v_accvgpr_read_b32 v63, a167
    v_cvt_pk_bf16_f32 v52, v56, v57
    v_cvt_pk_bf16_f32 v53, v58, v59
    v_cvt_pk_bf16_f32 v54, v60, v61
    v_cvt_pk_bf16_f32 v55, v62, v63
    s_add_u32 s52, s47, 524288
    buffer_store_dwordx4 v[52:55], v3, s[32:35], s52 offen offset:1024
    v_accvgpr_read_b32 v68, a136
    v_accvgpr_read_b32 v69, a137
    v_accvgpr_read_b32 v70, a138
    v_accvgpr_read_b32 v71, a139
    v_accvgpr_read_b32 v72, a168
    v_accvgpr_read_b32 v73, a169
    v_accvgpr_read_b32 v74, a170
    v_accvgpr_read_b32 v75, a171
    v_cvt_pk_bf16_f32 v64, v68, v69
    v_cvt_pk_bf16_f32 v65, v70, v71
    v_cvt_pk_bf16_f32 v66, v72, v73
    v_cvt_pk_bf16_f32 v67, v74, v75
    s_add_u32 s52, s47, 524288
    buffer_store_dwordx4 v[64:67], v3, s[32:35], s52 offen offset:2048
    v_accvgpr_read_b32 v80, a140
    v_accvgpr_read_b32 v81, a141
    v_accvgpr_read_b32 v82, a142
    v_accvgpr_read_b32 v83, a143
    v_accvgpr_read_b32 v84, a172
    v_accvgpr_read_b32 v85, a173
    v_accvgpr_read_b32 v86, a174
    v_accvgpr_read_b32 v87, a175
    v_cvt_pk_bf16_f32 v76, v80, v81
    v_cvt_pk_bf16_f32 v77, v82, v83
    v_cvt_pk_bf16_f32 v78, v84, v85
    v_cvt_pk_bf16_f32 v79, v86, v87
    s_add_u32 s52, s47, 524288
    buffer_store_dwordx4 v[76:79], v3, s[32:35], s52 offen offset:3072
    v_accvgpr_read_b32 v44, a144
    v_accvgpr_read_b32 v45, a145
    v_accvgpr_read_b32 v46, a146
    v_accvgpr_read_b32 v47, a147
    v_accvgpr_read_b32 v48, a176
    v_accvgpr_read_b32 v49, a177
    v_accvgpr_read_b32 v50, a178
    v_accvgpr_read_b32 v51, a179
    v_cvt_pk_bf16_f32 v40, v44, v45
    v_cvt_pk_bf16_f32 v41, v46, v47
    v_cvt_pk_bf16_f32 v42, v48, v49
    v_cvt_pk_bf16_f32 v43, v50, v51
    s_add_u32 s52, s47, 528384
    buffer_store_dwordx4 v[40:43], v3, s[32:35], s52 offen offset:0
    v_accvgpr_read_b32 v56, a148
    v_accvgpr_read_b32 v57, a149
    v_accvgpr_read_b32 v58, a150
    v_accvgpr_read_b32 v59, a151
    v_accvgpr_read_b32 v60, a180
    v_accvgpr_read_b32 v61, a181
    v_accvgpr_read_b32 v62, a182
    v_accvgpr_read_b32 v63, a183
    v_cvt_pk_bf16_f32 v52, v56, v57
    v_cvt_pk_bf16_f32 v53, v58, v59
    v_cvt_pk_bf16_f32 v54, v60, v61
    v_cvt_pk_bf16_f32 v55, v62, v63
    s_add_u32 s52, s47, 528384
    buffer_store_dwordx4 v[52:55], v3, s[32:35], s52 offen offset:1024
    v_accvgpr_read_b32 v68, a152
    v_accvgpr_read_b32 v69, a153
    v_accvgpr_read_b32 v70, a154
    v_accvgpr_read_b32 v71, a155
    v_accvgpr_read_b32 v72, a184
    v_accvgpr_read_b32 v73, a185
    v_accvgpr_read_b32 v74, a186
    v_accvgpr_read_b32 v75, a187
    v_cvt_pk_bf16_f32 v64, v68, v69
    v_cvt_pk_bf16_f32 v65, v70, v71
    v_cvt_pk_bf16_f32 v66, v72, v73
    v_cvt_pk_bf16_f32 v67, v74, v75
    s_add_u32 s52, s47, 528384
    buffer_store_dwordx4 v[64:67], v3, s[32:35], s52 offen offset:2048
    v_accvgpr_read_b32 v80, a156
    v_accvgpr_read_b32 v81, a157
    v_accvgpr_read_b32 v82, a158
    v_accvgpr_read_b32 v83, a159
    v_accvgpr_read_b32 v84, a188
    v_accvgpr_read_b32 v85, a189
    v_accvgpr_read_b32 v86, a190
    v_accvgpr_read_b32 v87, a191
    v_cvt_pk_bf16_f32 v76, v80, v81
    v_cvt_pk_bf16_f32 v77, v82, v83
    v_cvt_pk_bf16_f32 v78, v84, v85
    v_cvt_pk_bf16_f32 v79, v86, v87
    s_add_u32 s52, s47, 528384
    buffer_store_dwordx4 v[76:79], v3, s[32:35], s52 offen offset:3072
    v_accvgpr_read_b32 v44, a192
    v_accvgpr_read_b32 v45, a193
    v_accvgpr_read_b32 v46, a194
    v_accvgpr_read_b32 v47, a195
    v_accvgpr_read_b32 v48, a224
    v_accvgpr_read_b32 v49, a225
    v_accvgpr_read_b32 v50, a226
    v_accvgpr_read_b32 v51, a227
    v_cvt_pk_bf16_f32 v40, v44, v45
    v_cvt_pk_bf16_f32 v41, v46, v47
    v_cvt_pk_bf16_f32 v42, v48, v49
    v_cvt_pk_bf16_f32 v43, v50, v51
    s_add_u32 s52, s47, 532480
    buffer_store_dwordx4 v[40:43], v3, s[32:35], s52 offen offset:0
    v_accvgpr_read_b32 v56, a196
    v_accvgpr_read_b32 v57, a197
    v_accvgpr_read_b32 v58, a198
    v_accvgpr_read_b32 v59, a199
    v_accvgpr_read_b32 v60, a228
    v_accvgpr_read_b32 v61, a229
    v_accvgpr_read_b32 v62, a230
    v_accvgpr_read_b32 v63, a231
    v_cvt_pk_bf16_f32 v52, v56, v57
    v_cvt_pk_bf16_f32 v53, v58, v59
    v_cvt_pk_bf16_f32 v54, v60, v61
    v_cvt_pk_bf16_f32 v55, v62, v63
    s_add_u32 s52, s47, 532480
    buffer_store_dwordx4 v[52:55], v3, s[32:35], s52 offen offset:1024
    v_accvgpr_read_b32 v68, a200
    v_accvgpr_read_b32 v69, a201
    v_accvgpr_read_b32 v70, a202
    v_accvgpr_read_b32 v71, a203
    v_accvgpr_read_b32 v72, a232
    v_accvgpr_read_b32 v73, a233
    v_accvgpr_read_b32 v74, a234
    v_accvgpr_read_b32 v75, a235
    v_cvt_pk_bf16_f32 v64, v68, v69
    v_cvt_pk_bf16_f32 v65, v70, v71
    v_cvt_pk_bf16_f32 v66, v72, v73
    v_cvt_pk_bf16_f32 v67, v74, v75
    s_add_u32 s52, s47, 532480
    buffer_store_dwordx4 v[64:67], v3, s[32:35], s52 offen offset:2048
    v_accvgpr_read_b32 v80, a204
    v_accvgpr_read_b32 v81, a205
    v_accvgpr_read_b32 v82, a206
    v_accvgpr_read_b32 v83, a207
    v_accvgpr_read_b32 v84, a236
    v_accvgpr_read_b32 v85, a237
    v_accvgpr_read_b32 v86, a238
    v_accvgpr_read_b32 v87, a239
    v_cvt_pk_bf16_f32 v76, v80, v81
    v_cvt_pk_bf16_f32 v77, v82, v83
    v_cvt_pk_bf16_f32 v78, v84, v85
    v_cvt_pk_bf16_f32 v79, v86, v87
    s_add_u32 s52, s47, 532480
    buffer_store_dwordx4 v[76:79], v3, s[32:35], s52 offen offset:3072
    v_accvgpr_read_b32 v44, a208
    v_accvgpr_read_b32 v45, a209
    v_accvgpr_read_b32 v46, a210
    v_accvgpr_read_b32 v47, a211
    v_accvgpr_read_b32 v48, a240
    v_accvgpr_read_b32 v49, a241
    v_accvgpr_read_b32 v50, a242
    v_accvgpr_read_b32 v51, a243
    v_cvt_pk_bf16_f32 v40, v44, v45
    v_cvt_pk_bf16_f32 v41, v46, v47
    v_cvt_pk_bf16_f32 v42, v48, v49
    v_cvt_pk_bf16_f32 v43, v50, v51
    s_add_u32 s52, s47, 536576
    buffer_store_dwordx4 v[40:43], v3, s[32:35], s52 offen offset:0
    v_accvgpr_read_b32 v56, a212
    v_accvgpr_read_b32 v57, a213
    v_accvgpr_read_b32 v58, a214
    v_accvgpr_read_b32 v59, a215
    v_accvgpr_read_b32 v60, a244
    v_accvgpr_read_b32 v61, a245
    v_accvgpr_read_b32 v62, a246
    v_accvgpr_read_b32 v63, a247
    v_cvt_pk_bf16_f32 v52, v56, v57
    v_cvt_pk_bf16_f32 v53, v58, v59
    v_cvt_pk_bf16_f32 v54, v60, v61
    v_cvt_pk_bf16_f32 v55, v62, v63
    s_add_u32 s52, s47, 536576
    buffer_store_dwordx4 v[52:55], v3, s[32:35], s52 offen offset:1024
    v_accvgpr_read_b32 v68, a216
    v_accvgpr_read_b32 v69, a217
    v_accvgpr_read_b32 v70, a218
    v_accvgpr_read_b32 v71, a219
    v_accvgpr_read_b32 v72, a248
    v_accvgpr_read_b32 v73, a249
    v_accvgpr_read_b32 v74, a250
    v_accvgpr_read_b32 v75, a251
    v_cvt_pk_bf16_f32 v64, v68, v69
    v_cvt_pk_bf16_f32 v65, v70, v71
    v_cvt_pk_bf16_f32 v66, v72, v73
    v_cvt_pk_bf16_f32 v67, v74, v75
    s_add_u32 s52, s47, 536576
    buffer_store_dwordx4 v[64:67], v3, s[32:35], s52 offen offset:2048
    v_accvgpr_read_b32 v80, a220
    v_accvgpr_read_b32 v81, a221
    v_accvgpr_read_b32 v82, a222
    v_accvgpr_read_b32 v83, a223
    v_accvgpr_read_b32 v84, a252
    v_accvgpr_read_b32 v85, a253
    v_accvgpr_read_b32 v86, a254
    v_accvgpr_read_b32 v87, a255
    v_cvt_pk_bf16_f32 v76, v80, v81
    v_cvt_pk_bf16_f32 v77, v82, v83
    v_cvt_pk_bf16_f32 v78, v84, v85
    v_cvt_pk_bf16_f32 v79, v86, v87
    s_add_u32 s52, s47, 536576
    buffer_store_dwordx4 v[76:79], v3, s[32:35], s52 offen offset:3072
    s_endpgm
k1_end_1:
    s_endpgm
.globl k2_kernel
.p2align 8
.type k2_kernel,@function
k2_kernel:
    s_cmp_ge_u32 s2, 256
    s_cbranch_scc1 k2_end_6
    s_load_dwordx2 s[4:5], s[0:1], 16
    s_load_dwordx2 s[6:7], s[0:1], 104
    s_and_b32 s28, s2, 7
    s_lshl_b32 s28, s28, 2
    s_lshr_b32 s29, s2, 3
    s_and_b32 s31, s29, 3
    s_add_u32 s28, s28, s31
    s_lshr_b32 s29, s29, 2
    v_lshrrev_b32 v10, 6, v0
    v_and_b32 v11, 63, v0
    v_readfirstlane_b32 s30, v10
    v_lshlrev_b32 v1, 4, v11
    s_lshl_b32 s38, s29, 7
    s_sub_u32 s39, 1920, s38
    s_lshl_b32 s31, s30, 5
    s_mov_b32 s42, s38
    s_mov_b32 s43, s39
    s_add_u32 s38, s38, s31
    s_add_u32 s39, s39, s31
    s_lshl_b32 s31, s38, 6
    v_add_u32 v12, s31, v1
    s_lshl_b32 s31, s39, 6
    v_add_u32 v13, s31, v1
    v_lshrrev_b32 v20, 4, v11
    v_bfe_u32 v21, v11, 1, 3
    v_and_b32 v22, 1, v11
    v_lshl_add_u32 v23, v10, 4, v20
    v_lshlrev_b32 v23, 13, v23
    v_lshl_add_u32 v23, v22, 4, v23
    s_lshl_b32 s31, s28, 8
    v_add_u32 v23, s31, v23
    v_xor_b32 v21, v21, v20
    v_xor_b32 v22, 0, v21
    v_lshl_add_u32 v22, v22, 5, v23
    v_add_u32 v16, 0, v22
    v_xor_b32 v22, 0, v21
    v_lshl_add_u32 v22, v22, 5, v23
    v_add_u32 v17, 31744, v22
    v_xor_b32 v22, 4, v21
    v_lshl_add_u32 v22, v22, 5, v23
    v_add_u32 v18, 63488, v22
    v_xor_b32 v22, 4, v21
    v_lshl_add_u32 v22, v22, 5, v23
    v_add_u32 v19, 95232, v22
    s_waitcnt lgkmcnt(0)
    s_add_u32 s8, s6, 0x0
    s_addc_u32 s9, s7, 0
    s_and_b32 s9, s9, 0xffff
    s_mov_b32 s10, 0x400000
    s_mov_b32 s11, 0x00020000
    s_mov_b32 s12, s4
    s_and_b32 s13, s5, 0xffff
    s_mov_b32 s14, 0x800000
    s_mov_b32 s15, 0x00020000
    s_lshl_b32 s60, s30, 12
    s_mov_b32 s61, 0
    s_mov_b32 s62, 0
    s_add_u32 m0, s60, 0
    s_nop 0
    buffer_load_dwordx4 v16, s[12:15], s61 offen offset:0 lds
    buffer_load_dwordx4 v17, s[12:15], s61 offen offset:1024 lds
    buffer_load_dwordx4 v18, s[12:15], s61 offen offset:2048 lds
    buffer_load_dwordx4 v19, s[12:15], s61 offen offset:3072 lds
    s_add_u32 s61, s61, 0x80000
    buffer_load_dwordx4 a[128:131], v12, s[8:11], s62 offen offset:0
    buffer_load_dwordx4 a[132:135], v12, s[8:11], s62 offen offset:1024
    buffer_load_dwordx4 a[136:139], v13, s[8:11], s62 offen offset:0
    buffer_load_dwordx4 a[140:143], v13, s[8:11], s62 offen offset:1024
    s_add_u32 s62, s62, 0x20000
    s_add_u32 m0, s60, 16384
    s_nop 0
    buffer_load_dwordx4 v16, s[12:15], s61 offen offset:0 lds
    buffer_load_dwordx4 v17, s[12:15], s61 offen offset:1024 lds
    buffer_load_dwordx4 v18, s[12:15], s61 offen offset:2048 lds
    buffer_load_dwordx4 v19, s[12:15], s61 offen offset:3072 lds
    s_add_u32 s61, s61, 0x80000
    buffer_load_dwordx4 a[144:147], v12, s[8:11], s62 offen offset:0
    buffer_load_dwordx4 a[148:151], v12, s[8:11], s62 offen offset:1024
    buffer_load_dwordx4 a[152:155], v13, s[8:11], s62 offen offset:0
    buffer_load_dwordx4 a[156:159], v13, s[8:11], s62 offen offset:1024
    s_add_u32 s62, s62, 0x20000
    buffer_load_dwordx4 a[160:163], v12, s[8:11], s62 offen offset:0
    buffer_load_dwordx4 a[164:167], v12, s[8:11], s62 offen offset:1024
    buffer_load_dwordx4 a[168:171], v13, s[8:11], s62 offen offset:0
    buffer_load_dwordx4 a[172:175], v13, s[8:11], s62 offen offset:1024
    s_add_u32 s62, s62, 0x20000
    s_add_u32 m0, s60, 32768
    s_nop 0
    buffer_load_dwordx4 v16, s[12:15], s61 offen offset:0 lds
    buffer_load_dwordx4 v17, s[12:15], s61 offen offset:1024 lds
    buffer_load_dwordx4 v18, s[12:15], s61 offen offset:2048 lds
    buffer_load_dwordx4 v19, s[12:15], s61 offen offset:3072 lds
    s_add_u32 s61, s61, 0x80000
    buffer_load_dwordx4 a[176:179], v12, s[8:11], s62 offen offset:0
    buffer_load_dwordx4 a[180:183], v12, s[8:11], s62 offen offset:1024
    buffer_load_dwordx4 a[184:187], v13, s[8:11], s62 offen offset:0
    buffer_load_dwordx4 a[188:191], v13, s[8:11], s62 offen offset:1024
    s_add_u32 s62, s62, 0x20000
    buffer_load_dwordx4 a[192:195], v12, s[8:11], s62 offen offset:0
    buffer_load_dwordx4 a[196:199], v12, s[8:11], s62 offen offset:1024
    buffer_load_dwordx4 a[200:203], v13, s[8:11], s62 offen offset:0
    buffer_load_dwordx4 a[204:207], v13, s[8:11], s62 offen offset:1024
    s_add_u32 s62, s62, 0x20000
    s_add_u32 m0, s60, 49152
    s_nop 0
    buffer_load_dwordx4 v16, s[12:15], s61 offen offset:0 lds
    buffer_load_dwordx4 v17, s[12:15], s61 offen offset:1024 lds
    buffer_load_dwordx4 v18, s[12:15], s61 offen offset:2048 lds
    buffer_load_dwordx4 v19, s[12:15], s61 offen offset:3072 lds
    s_add_u32 s61, s61, 0x80000
    buffer_load_dwordx4 a[208:211], v12, s[8:11], s62 offen offset:0
    buffer_load_dwordx4 a[212:215], v12, s[8:11], s62 offen offset:1024
    buffer_load_dwordx4 a[216:219], v13, s[8:11], s62 offen offset:0
    buffer_load_dwordx4 a[220:223], v13, s[8:11], s62 offen offset:1024
    s_add_u32 s62, s62, 0x20000
    buffer_load_dwordx4 a[224:227], v12, s[8:11], s62 offen offset:0
    buffer_load_dwordx4 a[228:231], v12, s[8:11], s62 offen offset:1024
    buffer_load_dwordx4 a[232:235], v13, s[8:11], s62 offen offset:0
    buffer_load_dwordx4 a[236:239], v13, s[8:11], s62 offen offset:1024
    s_add_u32 s62, s62, 0x20000
    s_lshl_b32 s31, s28, 14
    s_add_u32 s16, s6, s31
    s_addc_u32 s17, s7, 0
    s_add_u32 s20, s16, 0x2000000
    s_addc_u32 s21, s17, 0
    s_add_u32 s16, s16, 0x1000000
    s_addc_u32 s17, s17, 0
    s_and_b32 s17, s17, 0xffff
    s_and_b32 s21, s21, 0xffff
    s_lshl_b32 s31, s29, 20
    s_sub_u32 s18, 0xf84000, s31
    s_mov_b32 s22, s18
    s_mov_b32 s19, 0x00020000
    s_mov_b32 s23, 0x00020000
    s_add_u32 s24, s6, 0x3000000
    s_addc_u32 s25, s7, 0
    s_and_b32 s25, s25, 0xffff
    s_mov_b32 s26, 0x1000000
    s_mov_b32 s27, 0x00020000
    v_and_b32 v21, 15, v11
    v_lshrrev_b32 v22, 2, v21
    v_and_b32 v23, 1, v20
    v_lshl_add_u32 v23, v23, 2, v22
    v_lshl_add_u32 v22, v20, 3, v22
    v_lshlrev_b32 v22, 8, v22
    v_and_b32 v32, 3, v11
    v_lshl_add_u32 v22, v32, 3, v22
    v_xor_b32 v32, 0, v23
    v_lshl_add_u32 v24, v32, 5, v22
    v_xor_b32 v32, 1, v23
    v_lshl_add_u32 v25, v32, 5, v22
    v_xor_b32 v32, 2, v23
    v_lshl_add_u32 v26, v32, 5, v22
    v_xor_b32 v32, 3, v23
    v_lshl_add_u32 v27, v32, 5, v22
    v_xor_b32 v32, 4, v23
    v_lshl_add_u32 v28, v32, 5, v22
    v_xor_b32 v32, 5, v23
    v_lshl_add_u32 v29, v32, 5, v22
    v_xor_b32 v32, 6, v23
    v_lshl_add_u32 v30, v32, 5, v22
    v_xor_b32 v32, 7, v23
    v_lshl_add_u32 v31, v32, 5, v22
    v_lshlrev_b32 v32, 2, v20
    v_sub_u32 v4, v21, v32
    v_mov_b32 v5, 0xff800000
    v_accvgpr_write_b32 a0, 0
    v_accvgpr_write_b32 a1, 0
    v_accvgpr_write_b32 a2, 0
    v_accvgpr_write_b32 a3, 0
    v_accvgpr_write_b32 a4, 0
    v_accvgpr_write_b32 a5, 0
    v_accvgpr_write_b32 a6, 0
    v_accvgpr_write_b32 a7, 0
    v_accvgpr_write_b32 a8, 0
    v_accvgpr_write_b32 a9, 0
    v_accvgpr_write_b32 a10, 0
    v_accvgpr_write_b32 a11, 0
    v_accvgpr_write_b32 a12, 0
    v_accvgpr_write_b32 a13, 0
    v_accvgpr_write_b32 a14, 0
    v_accvgpr_write_b32 a15, 0
    v_accvgpr_write_b32 a16, 0
    v_accvgpr_write_b32 a17, 0
    v_accvgpr_write_b32 a18, 0
    v_accvgpr_write_b32 a19, 0
    v_accvgpr_write_b32 a20, 0
    v_accvgpr_write_b32 a21, 0
    v_accvgpr_write_b32 a22, 0
    v_accvgpr_write_b32 a23, 0
    v_accvgpr_write_b32 a24, 0
    v_accvgpr_write_b32 a25, 0
    v_accvgpr_write_b32 a26, 0
    v_accvgpr_write_b32 a27, 0
    v_accvgpr_write_b32 a28, 0
    v_accvgpr_write_b32 a29, 0
    v_accvgpr_write_b32 a30, 0
    v_accvgpr_write_b32 a31, 0
    v_accvgpr_write_b32 a32, 0
    v_accvgpr_write_b32 a33, 0
    v_accvgpr_write_b32 a34, 0
    v_accvgpr_write_b32 a35, 0
    v_accvgpr_write_b32 a36, 0
    v_accvgpr_write_b32 a37, 0
    v_accvgpr_write_b32 a38, 0
    v_accvgpr_write_b32 a39, 0
    v_accvgpr_write_b32 a40, 0
    v_accvgpr_write_b32 a41, 0
    v_accvgpr_write_b32 a42, 0
    v_accvgpr_write_b32 a43, 0
    v_accvgpr_write_b32 a44, 0
    v_accvgpr_write_b32 a45, 0
    v_accvgpr_write_b32 a46, 0
    v_accvgpr_write_b32 a47, 0
    v_accvgpr_write_b32 a48, 0
    v_accvgpr_write_b32 a49, 0
    v_accvgpr_write_b32 a50, 0
    v_accvgpr_write_b32 a51, 0
    v_accvgpr_write_b32 a52, 0
    v_accvgpr_write_b32 a53, 0
    v_accvgpr_write_b32 a54, 0
    v_accvgpr_write_b32 a55, 0
    v_accvgpr_write_b32 a56, 0
    v_accvgpr_write_b32 a57, 0
    v_accvgpr_write_b32 a58, 0
    v_accvgpr_write_b32 a59, 0
    v_accvgpr_write_b32 a60, 0
    v_accvgpr_write_b32 a61, 0
    v_accvgpr_write_b32 a62, 0
    v_accvgpr_write_b32 a63, 0
    v_accvgpr_write_b32 a64, 0
    v_accvgpr_write_b32 a65, 0
    v_accvgpr_write_b32 a66, 0
    v_accvgpr_write_b32 a67, 0
    v_accvgpr_write_b32 a68, 0
    v_accvgpr_write_b32 a69, 0
    v_accvgpr_write_b32 a70, 0
    v_accvgpr_write_b32 a71, 0
    v_accvgpr_write_b32 a72, 0
    v_accvgpr_write_b32 a73, 0
    v_accvgpr_write_b32 a74, 0
    v_accvgpr_write_b32 a75, 0
    v_accvgpr_write_b32 a76, 0
    v_accvgpr_write_b32 a77, 0
    v_accvgpr_write_b32 a78, 0
    v_accvgpr_write_b32 a79, 0
    v_accvgpr_write_b32 a80, 0
    v_accvgpr_write_b32 a81, 0
    v_accvgpr_write_b32 a82, 0
    v_accvgpr_write_b32 a83, 0
    v_accvgpr_write_b32 a84, 0
    v_accvgpr_write_b32 a85, 0
    v_accvgpr_write_b32 a86, 0
    v_accvgpr_write_b32 a87, 0
    v_accvgpr_write_b32 a88, 0
    v_accvgpr_write_b32 a89, 0
    v_accvgpr_write_b32 a90, 0
    v_accvgpr_write_b32 a91, 0
    v_accvgpr_write_b32 a92, 0
    v_accvgpr_write_b32 a93, 0
    v_accvgpr_write_b32 a94, 0
    v_accvgpr_write_b32 a95, 0
    v_accvgpr_write_b32 a96, 0
    v_accvgpr_write_b32 a97, 0
    v_accvgpr_write_b32 a98, 0
    v_accvgpr_write_b32 a99, 0
    v_accvgpr_write_b32 a100, 0
    v_accvgpr_write_b32 a101, 0
    v_accvgpr_write_b32 a102, 0
    v_accvgpr_write_b32 a103, 0
    v_accvgpr_write_b32 a104, 0
    v_accvgpr_write_b32 a105, 0
    v_accvgpr_write_b32 a106, 0
    v_accvgpr_write_b32 a107, 0
    v_accvgpr_write_b32 a108, 0
    v_accvgpr_write_b32 a109, 0
    v_accvgpr_write_b32 a110, 0
    v_accvgpr_write_b32 a111, 0
    v_accvgpr_write_b32 a112, 0
    v_accvgpr_write_b32 a113, 0
    v_accvgpr_write_b32 a114, 0
    v_accvgpr_write_b32 a115, 0
    v_accvgpr_write_b32 a116, 0
    v_accvgpr_write_b32 a117, 0
    v_accvgpr_write_b32 a118, 0
    v_accvgpr_write_b32 a119, 0
    v_accvgpr_write_b32 a120, 0
    v_accvgpr_write_b32 a121, 0
    v_accvgpr_write_b32 a122, 0
    v_accvgpr_write_b32 a123, 0
    v_accvgpr_write_b32 a124, 0
    v_accvgpr_write_b32 a125, 0
    v_accvgpr_write_b32 a126, 0
    v_accvgpr_write_b32 a127, 0
    v_mov_b32 v128, 0
    v_mov_b32 v129, 0
    v_mov_b32 v130, 0
    v_mov_b32 v131, 0
    v_mov_b32 v132, 0
    v_mov_b32 v133, 0
    v_mov_b32 v134, 0
    v_mov_b32 v135, 0
    v_mov_b32 v136, 0
    v_mov_b32 v137, 0
    v_mov_b32 v138, 0
    v_mov_b32 v139, 0
    v_mov_b32 v140, 0
    v_mov_b32 v141, 0
    v_mov_b32 v142, 0
    v_mov_b32 v143, 0
    v_mov_b32 v144, 0
    v_mov_b32 v145, 0
    v_mov_b32 v146, 0
    v_mov_b32 v147, 0
    v_mov_b32 v148, 0
    v_mov_b32 v149, 0
    v_mov_b32 v150, 0
    v_mov_b32 v151, 0
    v_mov_b32 v152, 0
    v_mov_b32 v153, 0
    v_mov_b32 v154, 0
    v_mov_b32 v155, 0
    v_mov_b32 v156, 0
    v_mov_b32 v157, 0
    v_mov_b32 v158, 0
    v_mov_b32 v159, 0
    v_mov_b32 v160, 0
    v_mov_b32 v161, 0
    v_mov_b32 v162, 0
    v_mov_b32 v163, 0
    v_mov_b32 v164, 0
    v_mov_b32 v165, 0
    v_mov_b32 v166, 0
    v_mov_b32 v167, 0
    v_mov_b32 v168, 0
    v_mov_b32 v169, 0
    v_mov_b32 v170, 0
    v_mov_b32 v171, 0
    v_mov_b32 v172, 0
    v_mov_b32 v173, 0
    v_mov_b32 v174, 0
    v_mov_b32 v175, 0
    v_mov_b32 v176, 0
    v_mov_b32 v177, 0
    v_mov_b32 v178, 0
    v_mov_b32 v179, 0
    v_mov_b32 v180, 0
    v_mov_b32 v181, 0
    v_mov_b32 v182, 0
    v_mov_b32 v183, 0
    v_mov_b32 v184, 0
    v_mov_b32 v185, 0
    v_mov_b32 v186, 0
    v_mov_b32 v187, 0
    v_mov_b32 v188, 0
    v_mov_b32 v189, 0
    v_mov_b32 v190, 0
    v_mov_b32 v191, 0
    v_mov_b32 v192, 0
    v_mov_b32 v193, 0
    v_mov_b32 v194, 0
    v_mov_b32 v195, 0
    v_mov_b32 v196, 0
    v_mov_b32 v197, 0
    v_mov_b32 v198, 0
    v_mov_b32 v199, 0
    v_mov_b32 v200, 0
    v_mov_b32 v201, 0
    v_mov_b32 v202, 0
    v_mov_b32 v203, 0
    v_mov_b32 v204, 0
    v_mov_b32 v205, 0
    v_mov_b32 v206, 0
    v_mov_b32 v207, 0
    v_mov_b32 v208, 0
    v_mov_b32 v209, 0
    v_mov_b32 v210, 0
    v_mov_b32 v211, 0
    v_mov_b32 v212, 0
    v_mov_b32 v213, 0
    v_mov_b32 v214, 0
    v_mov_b32 v215, 0
    v_mov_b32 v216, 0
    v_mov_b32 v217, 0
    v_mov_b32 v218, 0
    v_mov_b32 v219, 0
    v_mov_b32 v220, 0
    v_mov_b32 v221, 0
    v_mov_b32 v222, 0
    v_mov_b32 v223, 0
    v_mov_b32 v224, 0
    v_mov_b32 v225, 0
    v_mov_b32 v226, 0
    v_mov_b32 v227, 0
    v_mov_b32 v228, 0
    v_mov_b32 v229, 0
    v_mov_b32 v230, 0
    v_mov_b32 v231, 0
    v_mov_b32 v232, 0
    v_mov_b32 v233, 0
    v_mov_b32 v234, 0
    v_mov_b32 v235, 0
    v_mov_b32 v236, 0
    v_mov_b32 v237, 0
    v_mov_b32 v238, 0
    v_mov_b32 v239, 0
    v_mov_b32 v240, 0
    v_mov_b32 v241, 0
    v_mov_b32 v242, 0
    v_mov_b32 v243, 0
    v_mov_b32 v244, 0
    v_mov_b32 v245, 0
    v_mov_b32 v246, 0
    v_mov_b32 v247, 0
    v_mov_b32 v248, 0
    v_mov_b32 v249, 0
    v_mov_b32 v250, 0
    v_mov_b32 v251, 0
    v_mov_b32 v252, 0
    v_mov_b32 v253, 0
    v_mov_b32 v254, 0
    v_mov_b32 v255, 0
    s_waitcnt vmcnt(40)
    s_barrier
    ds_read_b64_tr_b16 v[64:65], v24 offset:0
    ds_read_b64_tr_b16 v[66:67], v24 offset:1024
    ds_read_b64_tr_b16 v[68:69], v25 offset:0
    ds_read_b64_tr_b16 v[70:71], v25 offset:1024
    ds_read_b64_tr_b16 v[72:73], v26 offset:0
    ds_read_b64_tr_b16 v[74:75], v26 offset:1024
    ds_read_b64_tr_b16 v[76:77], v27 offset:0
    ds_read_b64_tr_b16 v[78:79], v27 offset:1024
    ds_read_b64_tr_b16 v[80:81], v28 offset:0
    ds_read_b64_tr_b16 v[82:83], v28 offset:1024
    ds_read_b64_tr_b16 v[84:85], v29 offset:0
    ds_read_b64_tr_b16 v[86:87], v29 offset:1024
    ds_read_b64_tr_b16 v[88:89], v30 offset:0
    ds_read_b64_tr_b16 v[90:91], v30 offset:1024
    ds_read_b64_tr_b16 v[92:93], v31 offset:0
    ds_read_b64_tr_b16 v[94:95], v31 offset:1024
    s_mov_b32 s63, 0
k2_qloop_7:
    s_waitcnt vmcnt(36) lgkmcnt(0)
    v_mfma_f32_16x16x32_bf16 v[128:131], v[64:67], a[128:131], v[128:131]
    ds_read_b64_tr_b16 v[96:97], v24 offset:8192
    v_mfma_f32_16x16x32_bf16 v[132:135], v[64:67], a[132:135], v[132:135]
    ds_read_b64_tr_b16 v[98:99], v24 offset:9216
    v_mfma_f32_16x16x32_bf16 v[136:139], v[64:67], a[136:139], v[136:139]
    ds_read_b64_tr_b16 v[100:101], v25 offset:8192
    v_mfma_f32_16x16x32_bf16 v[140:143], v[64:67], a[140:143], v[140:143]
    ds_read_b64_tr_b16 v[102:103], v25 offset:9216
    v_mfma_f32_16x16x32_bf16 v[144:147], v[68:71], a[128:131], v[144:147]
    buffer_load_dwordx4 a[240:243], v12, s[8:11], s62 offen offset:0
    v_mfma_f32_16x16x32_bf16 v[148:151], v[68:71], a[132:135], v[148:151]
    ds_read_b64_tr_b16 v[104:105], v26 offset:8192
    v_mfma_f32_16x16x32_bf16 v[152:155], v[68:71], a[136:139], v[152:155]
    ds_read_b64_tr_b16 v[106:107], v26 offset:9216
    v_mfma_f32_16x16x32_bf16 v[156:159], v[68:71], a[140:143], v[156:159]
    ds_read_b64_tr_b16 v[108:109], v27 offset:8192
    v_mfma_f32_16x16x32_bf16 v[160:163], v[72:75], a[128:131], v[160:163]
    ds_read_b64_tr_b16 v[110:111], v27 offset:9216
    buffer_load_dwordx4 a[244:247], v12, s[8:11], s62 offen offset:1024
    v_mfma_f32_16x16x32_bf16 v[164:167], v[72:75], a[132:135], v[164:167]
    v_mfma_f32_16x16x32_bf16 v[168:171], v[72:75], a[136:139], v[168:171]
    ds_read_b64_tr_b16 v[112:113], v28 offset:8192
    v_mfma_f32_16x16x32_bf16 v[172:175], v[72:75], a[140:143], v[172:175]
    ds_read_b64_tr_b16 v[114:115], v28 offset:9216
    v_mfma_f32_16x16x32_bf16 v[176:179], v[76:79], a[128:131], v[176:179]
    ds_read_b64_tr_b16 v[116:117], v29 offset:8192
    v_mfma_f32_16x16x32_bf16 v[180:183], v[76:79], a[132:135], v[180:183]
    ds_read_b64_tr_b16 v[118:119], v29 offset:9216
    buffer_load_dwordx4 a[248:251], v13, s[8:11], s62 offen offset:0
    v_mfma_f32_16x16x32_bf16 v[184:187], v[76:79], a[136:139], v[184:187]
    v_mfma_f32_16x16x32_bf16 v[188:191], v[76:79], a[140:143], v[188:191]
    ds_read_b64_tr_b16 v[120:121], v30 offset:8192
    v_mfma_f32_16x16x32_bf16 v[192:195], v[80:83], a[128:131], v[192:195]
    ds_read_b64_tr_b16 v[122:123], v30 offset:9216
    v_mfma_f32_16x16x32_bf16 v[196:199], v[80:83], a[132:135], v[196:199]
    ds_read_b64_tr_b16 v[124:125], v31 offset:8192
    v_mfma_f32_16x16x32_bf16 v[200:203], v[80:83], a[136:139], v[200:203]
    ds_read_b64_tr_b16 v[126:127], v31 offset:9216
    buffer_load_dwordx4 a[252:255], v13, s[8:11], s62 offen offset:1024
    v_mfma_f32_16x16x32_bf16 v[204:207], v[80:83], a[140:143], v[204:207]
    v_mfma_f32_16x16x32_bf16 v[208:211], v[84:87], a[128:131], v[208:211]
    v_mfma_f32_16x16x32_bf16 v[212:215], v[84:87], a[132:135], v[212:215]
    v_mfma_f32_16x16x32_bf16 v[216:219], v[84:87], a[136:139], v[216:219]
    v_mfma_f32_16x16x32_bf16 v[220:223], v[84:87], a[140:143], v[220:223]
    s_add_u32 s62, s62, 0x20000
    v_mfma_f32_16x16x32_bf16 v[224:227], v[88:91], a[128:131], v[224:227]
    v_mfma_f32_16x16x32_bf16 v[228:231], v[88:91], a[132:135], v[228:231]
    v_mfma_f32_16x16x32_bf16 v[232:235], v[88:91], a[136:139], v[232:235]
    v_mfma_f32_16x16x32_bf16 v[236:239], v[88:91], a[140:143], v[236:239]
    v_mfma_f32_16x16x32_bf16 v[240:243], v[92:95], a[128:131], v[240:243]
    v_mfma_f32_16x16x32_bf16 v[244:247], v[92:95], a[132:135], v[244:247]
    v_mfma_f32_16x16x32_bf16 v[248:251], v[92:95], a[136:139], v[248:251]
    v_mfma_f32_16x16x32_bf16 v[252:255], v[92:95], a[140:143], v[252:255]
    s_waitcnt vmcnt(32) lgkmcnt(0)
    s_barrier
    v_mfma_f32_16x16x32_bf16 v[128:131], v[96:99], a[144:147], v[128:131]
    ds_read_b64_tr_b16 v[64:65], v24 offset:16384
    v_mfma_f32_16x16x32_bf16 v[132:135], v[96:99], a[148:151], v[132:135]
    ds_read_b64_tr_b16 v[66:67], v24 offset:17408
    v_mfma_f32_16x16x32_bf16 v[136:139], v[96:99], a[152:155], v[136:139]
    ds_read_b64_tr_b16 v[68:69], v25 offset:16384
    s_add_u32 m0, s60, 0
    s_nop 0
    buffer_load_dwordx4 v16, s[12:15], s61 offen offset:0 lds
    v_mfma_f32_16x16x32_bf16 v[140:143], v[96:99], a[156:159], v[140:143]
    ds_read_b64_tr_b16 v[70:71], v25 offset:17408
    v_mfma_f32_16x16x32_bf16 v[144:147], v[100:103], a[144:147], v[144:147]
    buffer_load_dwordx4 v17, s[12:15], s61 offen offset:1024 lds
    v_mfma_f32_16x16x32_bf16 v[148:151], v[100:103], a[148:151], v[148:151]
    ds_read_b64_tr_b16 v[72:73], v26 offset:16384
    v_mfma_f32_16x16x32_bf16 v[152:155], v[100:103], a[152:155], v[152:155]
    ds_read_b64_tr_b16 v[74:75], v26 offset:17408
    v_mfma_f32_16x16x32_bf16 v[156:159], v[100:103], a[156:159], v[156:159]
    ds_read_b64_tr_b16 v[76:77], v27 offset:16384
    buffer_load_dwordx4 v18, s[12:15], s61 offen offset:2048 lds
    v_mfma_f32_16x16x32_bf16 v[160:163], v[104:107], a[144:147], v[160:163]
    ds_read_b64_tr_b16 v[78:79], v27 offset:17408
    v_mfma_f32_16x16x32_bf16 v[164:167], v[104:107], a[148:151], v[164:167]
    v_mfma_f32_16x16x32_bf16 v[168:171], v[104:107], a[152:155], v[168:171]
    ds_read_b64_tr_b16 v[80:81], v28 offset:16384
    buffer_load_dwordx4 v19, s[12:15], s61 offen offset:3072 lds
    v_mfma_f32_16x16x32_bf16 v[172:175], v[104:107], a[156:159], v[172:175]
    ds_read_b64_tr_b16 v[82:83], v28 offset:17408
    v_mfma_f32_16x16x32_bf16 v[176:179], v[108:111], a[144:147], v[176:179]
    ds_read_b64_tr_b16 v[84:85], v29 offset:16384
    v_mfma_f32_16x16x32_bf16 v[180:183], v[108:111], a[148:151], v[180:183]
    ds_read_b64_tr_b16 v[86:87], v29 offset:17408
    s_add_u32 s61, s61, 0x80000
    v_mfma_f32_16x16x32_bf16 v[184:187], v[108:111], a[152:155], v[184:187]
    v_mfma_f32_16x16x32_bf16 v[188:191], v[108:111], a[156:159], v[188:191]
    ds_read_b64_tr_b16 v[88:89], v30 offset:16384
    v_mfma_f32_16x16x32_bf16 v[192:195], v[112:115], a[144:147], v[192:195]
    ds_read_b64_tr_b16 v[90:91], v30 offset:17408
    buffer_load_dwordx4 a[128:131], v12, s[8:11], s62 offen offset:0
    v_mfma_f32_16x16x32_bf16 v[196:199], v[112:115], a[148:151], v[196:199]
    ds_read_b64_tr_b16 v[92:93], v31 offset:16384
    v_mfma_f32_16x16x32_bf16 v[200:203], v[112:115], a[152:155], v[200:203]
    ds_read_b64_tr_b16 v[94:95], v31 offset:17408
    buffer_load_dwordx4 a[132:135], v12, s[8:11], s62 offen offset:1024
    v_mfma_f32_16x16x32_bf16 v[204:207], v[112:115], a[156:159], v[204:207]
    v_mfma_f32_16x16x32_bf16 v[208:211], v[116:119], a[144:147], v[208:211]
    v_mfma_f32_16x16x32_bf16 v[212:215], v[116:119], a[148:151], v[212:215]
    buffer_load_dwordx4 a[136:139], v13, s[8:11], s62 offen offset:0
    v_mfma_f32_16x16x32_bf16 v[216:219], v[116:119], a[152:155], v[216:219]
    v_mfma_f32_16x16x32_bf16 v[220:223], v[116:119], a[156:159], v[220:223]
    v_mfma_f32_16x16x32_bf16 v[224:227], v[120:123], a[144:147], v[224:227]
    buffer_load_dwordx4 a[140:143], v13, s[8:11], s62 offen offset:1024
    v_mfma_f32_16x16x32_bf16 v[228:231], v[120:123], a[148:151], v[228:231]
    v_mfma_f32_16x16x32_bf16 v[232:235], v[120:123], a[152:155], v[232:235]
    v_mfma_f32_16x16x32_bf16 v[236:239], v[120:123], a[156:159], v[236:239]
    s_add_u32 s62, s62, 0x20000
    v_mfma_f32_16x16x32_bf16 v[240:243], v[124:127], a[144:147], v[240:243]
    v_mfma_f32_16x16x32_bf16 v[244:247], v[124:127], a[148:151], v[244:247]
    v_mfma_f32_16x16x32_bf16 v[248:251], v[124:127], a[152:155], v[248:251]
    v_mfma_f32_16x16x32_bf16 v[252:255], v[124:127], a[156:159], v[252:255]
    s_waitcnt vmcnt(36) lgkmcnt(0)
    v_mfma_f32_16x16x32_bf16 v[128:131], v[64:67], a[160:163], v[128:131]
    ds_read_b64_tr_b16 v[96:97], v24 offset:24576
    v_mfma_f32_16x16x32_bf16 v[132:135], v[64:67], a[164:167], v[132:135]
    ds_read_b64_tr_b16 v[98:99], v24 offset:25600
    v_mfma_f32_16x16x32_bf16 v[136:139], v[64:67], a[168:171], v[136:139]
    ds_read_b64_tr_b16 v[100:101], v25 offset:24576
    v_mfma_f32_16x16x32_bf16 v[140:143], v[64:67], a[172:175], v[140:143]
    ds_read_b64_tr_b16 v[102:103], v25 offset:25600
    v_mfma_f32_16x16x32_bf16 v[144:147], v[68:71], a[160:163], v[144:147]
    buffer_load_dwordx4 a[144:147], v12, s[8:11], s62 offen offset:0
    v_mfma_f32_16x16x32_bf16 v[148:151], v[68:71], a[164:167], v[148:151]
    ds_read_b64_tr_b16 v[104:105], v26 offset:24576
    v_mfma_f32_16x16x32_bf16 v[152:155], v[68:71], a[168:171], v[152:155]
    ds_read_b64_tr_b16 v[106:107], v26 offset:25600
    v_mfma_f32_16x16x32_bf16 v[156:159], v[68:71], a[172:175], v[156:159]
    ds_read_b64_tr_b16 v[108:109], v27 offset:24576
    v_mfma_f32_16x16x32_bf16 v[160:163], v[72:75], a[160:163], v[160:163]
    ds_read_b64_tr_b16 v[110:111], v27 offset:25600
    buffer_load_dwordx4 a[148:151], v12, s[8:11], s62 offen offset:1024
    v_mfma_f32_16x16x32_bf16 v[164:167], v[72:75], a[164:167], v[164:167]
    v_mfma_f32_16x16x32_bf16 v[168:171], v[72:75], a[168:171], v[168:171]
    ds_read_b64_tr_b16 v[112:113], v28 offset:24576
    v_mfma_f32_16x16x32_bf16 v[172:175], v[72:75], a[172:175], v[172:175]
    ds_read_b64_tr_b16 v[114:115], v28 offset:25600
    v_mfma_f32_16x16x32_bf16 v[176:179], v[76:79], a[160:163], v[176:179]
    ds_read_b64_tr_b16 v[116:117], v29 offset:24576
    v_mfma_f32_16x16x32_bf16 v[180:183], v[76:79], a[164:167], v[180:183]
    ds_read_b64_tr_b16 v[118:119], v29 offset:25600
    buffer_load_dwordx4 a[152:155], v13, s[8:11], s62 offen offset:0
    v_mfma_f32_16x16x32_bf16 v[184:187], v[76:79], a[168:171], v[184:187]
    v_mfma_f32_16x16x32_bf16 v[188:191], v[76:79], a[172:175], v[188:191]
    ds_read_b64_tr_b16 v[120:121], v30 offset:24576
    v_mfma_f32_16x16x32_bf16 v[192:195], v[80:83], a[160:163], v[192:195]
    ds_read_b64_tr_b16 v[122:123], v30 offset:25600
    v_mfma_f32_16x16x32_bf16 v[196:199], v[80:83], a[164:167], v[196:199]
    ds_read_b64_tr_b16 v[124:125], v31 offset:24576
    v_mfma_f32_16x16x32_bf16 v[200:203], v[80:83], a[168:171], v[200:203]
    ds_read_b64_tr_b16 v[126:127], v31 offset:25600
    buffer_load_dwordx4 a[156:159], v13, s[8:11], s62 offen offset:1024
    v_mfma_f32_16x16x32_bf16 v[204:207], v[80:83], a[172:175], v[204:207]
    v_mfma_f32_16x16x32_bf16 v[208:211], v[84:87], a[160:163], v[208:211]
    v_mfma_f32_16x16x32_bf16 v[212:215], v[84:87], a[164:167], v[212:215]
    v_mfma_f32_16x16x32_bf16 v[216:219], v[84:87], a[168:171], v[216:219]
    v_mfma_f32_16x16x32_bf16 v[220:223], v[84:87], a[172:175], v[220:223]
    s_add_u32 s62, s62, 0x20000
    v_mfma_f32_16x16x32_bf16 v[224:227], v[88:91], a[160:163], v[224:227]
    v_mfma_f32_16x16x32_bf16 v[228:231], v[88:91], a[164:167], v[228:231]
    v_mfma_f32_16x16x32_bf16 v[232:235], v[88:91], a[168:171], v[232:235]
    v_mfma_f32_16x16x32_bf16 v[236:239], v[88:91], a[172:175], v[236:239]
    v_mfma_f32_16x16x32_bf16 v[240:243], v[92:95], a[160:163], v[240:243]
    v_mfma_f32_16x16x32_bf16 v[244:247], v[92:95], a[164:167], v[244:247]
    v_mfma_f32_16x16x32_bf16 v[248:251], v[92:95], a[168:171], v[248:251]
    v_mfma_f32_16x16x32_bf16 v[252:255], v[92:95], a[172:175], v[252:255]
    s_waitcnt vmcnt(32) lgkmcnt(0)
    s_barrier
    v_mfma_f32_16x16x32_bf16 v[128:131], v[96:99], a[176:179], v[128:131]
    ds_read_b64_tr_b16 v[64:65], v24 offset:32768
    v_mfma_f32_16x16x32_bf16 v[132:135], v[96:99], a[180:183], v[132:135]
    ds_read_b64_tr_b16 v[66:67], v24 offset:33792
    v_mfma_f32_16x16x32_bf16 v[136:139], v[96:99], a[184:187], v[136:139]
    ds_read_b64_tr_b16 v[68:69], v25 offset:32768
    s_add_u32 m0, s60, 16384
    s_nop 0
    buffer_load_dwordx4 v16, s[12:15], s61 offen offset:0 lds
    v_mfma_f32_16x16x32_bf16 v[140:143], v[96:99], a[188:191], v[140:143]
    ds_read_b64_tr_b16 v[70:71], v25 offset:33792
    v_mfma_f32_16x16x32_bf16 v[144:147], v[100:103], a[176:179], v[144:147]
    buffer_load_dwordx4 v17, s[12:15], s61 offen offset:1024 lds
    v_mfma_f32_16x16x32_bf16 v[148:151], v[100:103], a[180:183], v[148:151]
    ds_read_b64_tr_b16 v[72:73], v26 offset:32768
    v_mfma_f32_16x16x32_bf16 v[152:155], v[100:103], a[184:187], v[152:155]
    ds_read_b64_tr_b16 v[74:75], v26 offset:33792
    v_mfma_f32_16x16x32_bf16 v[156:159], v[100:103], a[188:191], v[156:159]
    ds_read_b64_tr_b16 v[76:77], v27 offset:32768
    buffer_load_dwordx4 v18, s[12:15], s61 offen offset:2048 lds
    v_mfma_f32_16x16x32_bf16 v[160:163], v[104:107], a[176:179], v[160:163]
    ds_read_b64_tr_b16 v[78:79], v27 offset:33792
    v_mfma_f32_16x16x32_bf16 v[164:167], v[104:107], a[180:183], v[164:167]
    v_mfma_f32_16x16x32_bf16 v[168:171], v[104:107], a[184:187], v[168:171]
    ds_read_b64_tr_b16 v[80:81], v28 offset:32768
    buffer_load_dwordx4 v19, s[12:15], s61 offen offset:3072 lds
    v_mfma_f32_16x16x32_bf16 v[172:175], v[104:107], a[188:191], v[172:175]
    ds_read_b64_tr_b16 v[82:83], v28 offset:33792
    v_mfma_f32_16x16x32_bf16 v[176:179], v[108:111], a[176:179], v[176:179]
    ds_read_b64_tr_b16 v[84:85], v29 offset:32768
    v_mfma_f32_16x16x32_bf16 v[180:183], v[108:111], a[180:183], v[180:183]
    ds_read_b64_tr_b16 v[86:87], v29 offset:33792
    s_add_u32 s61, s61, 0x80000
    v_mfma_f32_16x16x32_bf16 v[184:187], v[108:111], a[184:187], v[184:187]
    v_mfma_f32_16x16x32_bf16 v[188:191], v[108:111], a[188:191], v[188:191]
    ds_read_b64_tr_b16 v[88:89], v30 offset:32768
    v_mfma_f32_16x16x32_bf16 v[192:195], v[112:115], a[176:179], v[192:195]
    ds_read_b64_tr_b16 v[90:91], v30 offset:33792
    buffer_load_dwordx4 a[160:163], v12, s[8:11], s62 offen offset:0
    v_mfma_f32_16x16x32_bf16 v[196:199], v[112:115], a[180:183], v[196:199]
    ds_read_b64_tr_b16 v[92:93], v31 offset:32768
    v_mfma_f32_16x16x32_bf16 v[200:203], v[112:115], a[184:187], v[200:203]
    ds_read_b64_tr_b16 v[94:95], v31 offset:33792
    buffer_load_dwordx4 a[164:167], v12, s[8:11], s62 offen offset:1024
    v_mfma_f32_16x16x32_bf16 v[204:207], v[112:115], a[188:191], v[204:207]
    v_mfma_f32_16x16x32_bf16 v[208:211], v[116:119], a[176:179], v[208:211]
    v_mfma_f32_16x16x32_bf16 v[212:215], v[116:119], a[180:183], v[212:215]
    buffer_load_dwordx4 a[168:171], v13, s[8:11], s62 offen offset:0
    v_mfma_f32_16x16x32_bf16 v[216:219], v[116:119], a[184:187], v[216:219]
    v_mfma_f32_16x16x32_bf16 v[220:223], v[116:119], a[188:191], v[220:223]
    v_mfma_f32_16x16x32_bf16 v[224:227], v[120:123], a[176:179], v[224:227]
    buffer_load_dwordx4 a[172:175], v13, s[8:11], s62 offen offset:1024
    v_mfma_f32_16x16x32_bf16 v[228:231], v[120:123], a[180:183], v[228:231]
    v_mfma_f32_16x16x32_bf16 v[232:235], v[120:123], a[184:187], v[232:235]
    v_mfma_f32_16x16x32_bf16 v[236:239], v[120:123], a[188:191], v[236:239]
    s_add_u32 s62, s62, 0x20000
    v_mfma_f32_16x16x32_bf16 v[240:243], v[124:127], a[176:179], v[240:243]
    v_mfma_f32_16x16x32_bf16 v[244:247], v[124:127], a[180:183], v[244:247]
    v_mfma_f32_16x16x32_bf16 v[248:251], v[124:127], a[184:187], v[248:251]
    v_mfma_f32_16x16x32_bf16 v[252:255], v[124:127], a[188:191], v[252:255]
    s_waitcnt vmcnt(36) lgkmcnt(0)
    v_mfma_f32_16x16x32_bf16 v[128:131], v[64:67], a[192:195], v[128:131]
    ds_read_b64_tr_b16 v[96:97], v24 offset:40960
    v_mfma_f32_16x16x32_bf16 v[132:135], v[64:67], a[196:199], v[132:135]
    ds_read_b64_tr_b16 v[98:99], v24 offset:41984
    v_mfma_f32_16x16x32_bf16 v[136:139], v[64:67], a[200:203], v[136:139]
    ds_read_b64_tr_b16 v[100:101], v25 offset:40960
    v_mfma_f32_16x16x32_bf16 v[140:143], v[64:67], a[204:207], v[140:143]
    ds_read_b64_tr_b16 v[102:103], v25 offset:41984
    v_mfma_f32_16x16x32_bf16 v[144:147], v[68:71], a[192:195], v[144:147]
    buffer_load_dwordx4 a[176:179], v12, s[8:11], s62 offen offset:0
    v_mfma_f32_16x16x32_bf16 v[148:151], v[68:71], a[196:199], v[148:151]
    ds_read_b64_tr_b16 v[104:105], v26 offset:40960
    v_mfma_f32_16x16x32_bf16 v[152:155], v[68:71], a[200:203], v[152:155]
    ds_read_b64_tr_b16 v[106:107], v26 offset:41984
    v_mfma_f32_16x16x32_bf16 v[156:159], v[68:71], a[204:207], v[156:159]
    ds_read_b64_tr_b16 v[108:109], v27 offset:40960
    v_mfma_f32_16x16x32_bf16 v[160:163], v[72:75], a[192:195], v[160:163]
    ds_read_b64_tr_b16 v[110:111], v27 offset:41984
    buffer_load_dwordx4 a[180:183], v12, s[8:11], s62 offen offset:1024
    v_mfma_f32_16x16x32_bf16 v[164:167], v[72:75], a[196:199], v[164:167]
    v_mfma_f32_16x16x32_bf16 v[168:171], v[72:75], a[200:203], v[168:171]
    ds_read_b64_tr_b16 v[112:113], v28 offset:40960
    v_mfma_f32_16x16x32_bf16 v[172:175], v[72:75], a[204:207], v[172:175]
    ds_read_b64_tr_b16 v[114:115], v28 offset:41984
    v_mfma_f32_16x16x32_bf16 v[176:179], v[76:79], a[192:195], v[176:179]
    ds_read_b64_tr_b16 v[116:117], v29 offset:40960
    v_mfma_f32_16x16x32_bf16 v[180:183], v[76:79], a[196:199], v[180:183]
    ds_read_b64_tr_b16 v[118:119], v29 offset:41984
    buffer_load_dwordx4 a[184:187], v13, s[8:11], s62 offen offset:0
    v_mfma_f32_16x16x32_bf16 v[184:187], v[76:79], a[200:203], v[184:187]
    v_mfma_f32_16x16x32_bf16 v[188:191], v[76:79], a[204:207], v[188:191]
    ds_read_b64_tr_b16 v[120:121], v30 offset:40960
    v_mfma_f32_16x16x32_bf16 v[192:195], v[80:83], a[192:195], v[192:195]
    ds_read_b64_tr_b16 v[122:123], v30 offset:41984
    v_mfma_f32_16x16x32_bf16 v[196:199], v[80:83], a[196:199], v[196:199]
    ds_read_b64_tr_b16 v[124:125], v31 offset:40960
    v_mfma_f32_16x16x32_bf16 v[200:203], v[80:83], a[200:203], v[200:203]
    ds_read_b64_tr_b16 v[126:127], v31 offset:41984
    buffer_load_dwordx4 a[188:191], v13, s[8:11], s62 offen offset:1024
    v_mfma_f32_16x16x32_bf16 v[204:207], v[80:83], a[204:207], v[204:207]
    v_mfma_f32_16x16x32_bf16 v[208:211], v[84:87], a[192:195], v[208:211]
    v_mfma_f32_16x16x32_bf16 v[212:215], v[84:87], a[196:199], v[212:215]
    v_mfma_f32_16x16x32_bf16 v[216:219], v[84:87], a[200:203], v[216:219]
    v_mfma_f32_16x16x32_bf16 v[220:223], v[84:87], a[204:207], v[220:223]
    s_add_u32 s62, s62, 0x20000
    v_mfma_f32_16x16x32_bf16 v[224:227], v[88:91], a[192:195], v[224:227]
    v_mfma_f32_16x16x32_bf16 v[228:231], v[88:91], a[196:199], v[228:231]
    v_mfma_f32_16x16x32_bf16 v[232:235], v[88:91], a[200:203], v[232:235]
    v_mfma_f32_16x16x32_bf16 v[236:239], v[88:91], a[204:207], v[236:239]
    v_mfma_f32_16x16x32_bf16 v[240:243], v[92:95], a[192:195], v[240:243]
    v_mfma_f32_16x16x32_bf16 v[244:247], v[92:95], a[196:199], v[244:247]
    v_mfma_f32_16x16x32_bf16 v[248:251], v[92:95], a[200:203], v[248:251]
    v_mfma_f32_16x16x32_bf16 v[252:255], v[92:95], a[204:207], v[252:255]
    s_waitcnt vmcnt(32) lgkmcnt(0)
    s_barrier
    v_mfma_f32_16x16x32_bf16 v[128:131], v[96:99], a[208:211], v[128:131]
    ds_read_b64_tr_b16 v[64:65], v24 offset:49152
    v_mfma_f32_16x16x32_bf16 v[132:135], v[96:99], a[212:215], v[132:135]
    ds_read_b64_tr_b16 v[66:67], v24 offset:50176
    v_mfma_f32_16x16x32_bf16 v[136:139], v[96:99], a[216:219], v[136:139]
    ds_read_b64_tr_b16 v[68:69], v25 offset:49152
    s_add_u32 m0, s60, 32768
    s_nop 0
    buffer_load_dwordx4 v16, s[12:15], s61 offen offset:0 lds
    v_mfma_f32_16x16x32_bf16 v[140:143], v[96:99], a[220:223], v[140:143]
    ds_read_b64_tr_b16 v[70:71], v25 offset:50176
    v_mfma_f32_16x16x32_bf16 v[144:147], v[100:103], a[208:211], v[144:147]
    buffer_load_dwordx4 v17, s[12:15], s61 offen offset:1024 lds
    v_mfma_f32_16x16x32_bf16 v[148:151], v[100:103], a[212:215], v[148:151]
    ds_read_b64_tr_b16 v[72:73], v26 offset:49152
    v_mfma_f32_16x16x32_bf16 v[152:155], v[100:103], a[216:219], v[152:155]
    ds_read_b64_tr_b16 v[74:75], v26 offset:50176
    v_mfma_f32_16x16x32_bf16 v[156:159], v[100:103], a[220:223], v[156:159]
    ds_read_b64_tr_b16 v[76:77], v27 offset:49152
    buffer_load_dwordx4 v18, s[12:15], s61 offen offset:2048 lds
    v_mfma_f32_16x16x32_bf16 v[160:163], v[104:107], a[208:211], v[160:163]
    ds_read_b64_tr_b16 v[78:79], v27 offset:50176
    v_mfma_f32_16x16x32_bf16 v[164:167], v[104:107], a[212:215], v[164:167]
    v_mfma_f32_16x16x32_bf16 v[168:171], v[104:107], a[216:219], v[168:171]
    ds_read_b64_tr_b16 v[80:81], v28 offset:49152
    buffer_load_dwordx4 v19, s[12:15], s61 offen offset:3072 lds
    v_mfma_f32_16x16x32_bf16 v[172:175], v[104:107], a[220:223], v[172:175]
    ds_read_b64_tr_b16 v[82:83], v28 offset:50176
    v_mfma_f32_16x16x32_bf16 v[176:179], v[108:111], a[208:211], v[176:179]
    ds_read_b64_tr_b16 v[84:85], v29 offset:49152
    v_mfma_f32_16x16x32_bf16 v[180:183], v[108:111], a[212:215], v[180:183]
    ds_read_b64_tr_b16 v[86:87], v29 offset:50176
    s_add_u32 s61, s61, 0x80000
    v_mfma_f32_16x16x32_bf16 v[184:187], v[108:111], a[216:219], v[184:187]
    v_mfma_f32_16x16x32_bf16 v[188:191], v[108:111], a[220:223], v[188:191]
    ds_read_b64_tr_b16 v[88:89], v30 offset:49152
    v_mfma_f32_16x16x32_bf16 v[192:195], v[112:115], a[208:211], v[192:195]
    ds_read_b64_tr_b16 v[90:91], v30 offset:50176
    buffer_load_dwordx4 a[192:195], v12, s[8:11], s62 offen offset:0
    v_mfma_f32_16x16x32_bf16 v[196:199], v[112:115], a[212:215], v[196:199]
    ds_read_b64_tr_b16 v[92:93], v31 offset:49152
    v_mfma_f32_16x16x32_bf16 v[200:203], v[112:115], a[216:219], v[200:203]
    ds_read_b64_tr_b16 v[94:95], v31 offset:50176
    buffer_load_dwordx4 a[196:199], v12, s[8:11], s62 offen offset:1024
    v_mfma_f32_16x16x32_bf16 v[204:207], v[112:115], a[220:223], v[204:207]
    v_mfma_f32_16x16x32_bf16 v[208:211], v[116:119], a[208:211], v[208:211]
    v_mfma_f32_16x16x32_bf16 v[212:215], v[116:119], a[212:215], v[212:215]
    buffer_load_dwordx4 a[200:203], v13, s[8:11], s62 offen offset:0
    v_mfma_f32_16x16x32_bf16 v[216:219], v[116:119], a[216:219], v[216:219]
    v_mfma_f32_16x16x32_bf16 v[220:223], v[116:119], a[220:223], v[220:223]
    v_mfma_f32_16x16x32_bf16 v[224:227], v[120:123], a[208:211], v[224:227]
    buffer_load_dwordx4 a[204:207], v13, s[8:11], s62 offen offset:1024
    v_mfma_f32_16x16x32_bf16 v[228:231], v[120:123], a[212:215], v[228:231]
    v_mfma_f32_16x16x32_bf16 v[232:235], v[120:123], a[216:219], v[232:235]
    v_mfma_f32_16x16x32_bf16 v[236:239], v[120:123], a[220:223], v[236:239]
    s_add_u32 s62, s62, 0x20000
    v_mfma_f32_16x16x32_bf16 v[240:243], v[124:127], a[208:211], v[240:243]
    v_mfma_f32_16x16x32_bf16 v[244:247], v[124:127], a[212:215], v[244:247]
    v_mfma_f32_16x16x32_bf16 v[248:251], v[124:127], a[216:219], v[248:251]
    v_mfma_f32_16x16x32_bf16 v[252:255], v[124:127], a[220:223], v[252:255]
    s_waitcnt vmcnt(36) lgkmcnt(0)
    v_mfma_f32_16x16x32_bf16 v[128:131], v[64:67], a[224:227], v[128:131]
    ds_read_b64_tr_b16 v[96:97], v24 offset:57344
    v_mfma_f32_16x16x32_bf16 v[132:135], v[64:67], a[228:231], v[132:135]
    ds_read_b64_tr_b16 v[98:99], v24 offset:58368
    v_mfma_f32_16x16x32_bf16 v[136:139], v[64:67], a[232:235], v[136:139]
    ds_read_b64_tr_b16 v[100:101], v25 offset:57344
    v_mfma_f32_16x16x32_bf16 v[140:143], v[64:67], a[236:239], v[140:143]
    ds_read_b64_tr_b16 v[102:103], v25 offset:58368
    v_mfma_f32_16x16x32_bf16 v[144:147], v[68:71], a[224:227], v[144:147]
    buffer_load_dwordx4 a[208:211], v12, s[8:11], s62 offen offset:0
    v_mfma_f32_16x16x32_bf16 v[148:151], v[68:71], a[228:231], v[148:151]
    ds_read_b64_tr_b16 v[104:105], v26 offset:57344
    v_mfma_f32_16x16x32_bf16 v[152:155], v[68:71], a[232:235], v[152:155]
    ds_read_b64_tr_b16 v[106:107], v26 offset:58368
    v_mfma_f32_16x16x32_bf16 v[156:159], v[68:71], a[236:239], v[156:159]
    ds_read_b64_tr_b16 v[108:109], v27 offset:57344
    v_mfma_f32_16x16x32_bf16 v[160:163], v[72:75], a[224:227], v[160:163]
    ds_read_b64_tr_b16 v[110:111], v27 offset:58368
    buffer_load_dwordx4 a[212:215], v12, s[8:11], s62 offen offset:1024
    v_mfma_f32_16x16x32_bf16 v[164:167], v[72:75], a[228:231], v[164:167]
    v_mfma_f32_16x16x32_bf16 v[168:171], v[72:75], a[232:235], v[168:171]
    ds_read_b64_tr_b16 v[112:113], v28 offset:57344
    v_mfma_f32_16x16x32_bf16 v[172:175], v[72:75], a[236:239], v[172:175]
    ds_read_b64_tr_b16 v[114:115], v28 offset:58368
    v_mfma_f32_16x16x32_bf16 v[176:179], v[76:79], a[224:227], v[176:179]
    ds_read_b64_tr_b16 v[116:117], v29 offset:57344
    v_mfma_f32_16x16x32_bf16 v[180:183], v[76:79], a[228:231], v[180:183]
    ds_read_b64_tr_b16 v[118:119], v29 offset:58368
    buffer_load_dwordx4 a[216:219], v13, s[8:11], s62 offen offset:0
    v_mfma_f32_16x16x32_bf16 v[184:187], v[76:79], a[232:235], v[184:187]
    v_mfma_f32_16x16x32_bf16 v[188:191], v[76:79], a[236:239], v[188:191]
    ds_read_b64_tr_b16 v[120:121], v30 offset:57344
    v_mfma_f32_16x16x32_bf16 v[192:195], v[80:83], a[224:227], v[192:195]
    ds_read_b64_tr_b16 v[122:123], v30 offset:58368
    v_mfma_f32_16x16x32_bf16 v[196:199], v[80:83], a[228:231], v[196:199]
    ds_read_b64_tr_b16 v[124:125], v31 offset:57344
    v_mfma_f32_16x16x32_bf16 v[200:203], v[80:83], a[232:235], v[200:203]
    ds_read_b64_tr_b16 v[126:127], v31 offset:58368
    buffer_load_dwordx4 a[220:223], v13, s[8:11], s62 offen offset:1024
    v_mfma_f32_16x16x32_bf16 v[204:207], v[80:83], a[236:239], v[204:207]
    v_mfma_f32_16x16x32_bf16 v[208:211], v[84:87], a[224:227], v[208:211]
    v_mfma_f32_16x16x32_bf16 v[212:215], v[84:87], a[228:231], v[212:215]
    v_mfma_f32_16x16x32_bf16 v[216:219], v[84:87], a[232:235], v[216:219]
    v_mfma_f32_16x16x32_bf16 v[220:223], v[84:87], a[236:239], v[220:223]
    s_add_u32 s62, s62, 0x20000
    v_mfma_f32_16x16x32_bf16 v[224:227], v[88:91], a[224:227], v[224:227]
    v_mfma_f32_16x16x32_bf16 v[228:231], v[88:91], a[228:231], v[228:231]
    v_mfma_f32_16x16x32_bf16 v[232:235], v[88:91], a[232:235], v[232:235]
    v_mfma_f32_16x16x32_bf16 v[236:239], v[88:91], a[236:239], v[236:239]
    v_mfma_f32_16x16x32_bf16 v[240:243], v[92:95], a[224:227], v[240:243]
    v_mfma_f32_16x16x32_bf16 v[244:247], v[92:95], a[228:231], v[244:247]
    v_mfma_f32_16x16x32_bf16 v[248:251], v[92:95], a[232:235], v[248:251]
    v_mfma_f32_16x16x32_bf16 v[252:255], v[92:95], a[236:239], v[252:255]
    s_waitcnt vmcnt(32) lgkmcnt(0)
    s_barrier
    v_mfma_f32_16x16x32_bf16 v[128:131], v[96:99], a[240:243], v[128:131]
    ds_read_b64_tr_b16 v[64:65], v24 offset:0
    v_mfma_f32_16x16x32_bf16 v[132:135], v[96:99], a[244:247], v[132:135]
    ds_read_b64_tr_b16 v[66:67], v24 offset:1024
    v_mfma_f32_16x16x32_bf16 v[136:139], v[96:99], a[248:251], v[136:139]
    ds_read_b64_tr_b16 v[68:69], v25 offset:0
    s_add_u32 m0, s60, 49152
    s_nop 0
    buffer_load_dwordx4 v16, s[12:15], s61 offen offset:0 lds
    v_mfma_f32_16x16x32_bf16 v[140:143], v[96:99], a[252:255], v[140:143]
    ds_read_b64_tr_b16 v[70:71], v25 offset:1024
    v_mfma_f32_16x16x32_bf16 v[144:147], v[100:103], a[240:243], v[144:147]
    buffer_load_dwordx4 v17, s[12:15], s61 offen offset:1024 lds
    v_mfma_f32_16x16x32_bf16 v[148:151], v[100:103], a[244:247], v[148:151]
    ds_read_b64_tr_b16 v[72:73], v26 offset:0
    v_mfma_f32_16x16x32_bf16 v[152:155], v[100:103], a[248:251], v[152:155]
    ds_read_b64_tr_b16 v[74:75], v26 offset:1024
    v_mfma_f32_16x16x32_bf16 v[156:159], v[100:103], a[252:255], v[156:159]
    ds_read_b64_tr_b16 v[76:77], v27 offset:0
    buffer_load_dwordx4 v18, s[12:15], s61 offen offset:2048 lds
    v_mfma_f32_16x16x32_bf16 v[160:163], v[104:107], a[240:243], v[160:163]
    ds_read_b64_tr_b16 v[78:79], v27 offset:1024
    v_mfma_f32_16x16x32_bf16 v[164:167], v[104:107], a[244:247], v[164:167]
    v_mfma_f32_16x16x32_bf16 v[168:171], v[104:107], a[248:251], v[168:171]
    ds_read_b64_tr_b16 v[80:81], v28 offset:0
    buffer_load_dwordx4 v19, s[12:15], s61 offen offset:3072 lds
    v_mfma_f32_16x16x32_bf16 v[172:175], v[104:107], a[252:255], v[172:175]
    ds_read_b64_tr_b16 v[82:83], v28 offset:1024
    v_mfma_f32_16x16x32_bf16 v[176:179], v[108:111], a[240:243], v[176:179]
    ds_read_b64_tr_b16 v[84:85], v29 offset:0
    v_mfma_f32_16x16x32_bf16 v[180:183], v[108:111], a[244:247], v[180:183]
    ds_read_b64_tr_b16 v[86:87], v29 offset:1024
    s_add_u32 s61, s61, 0x80000
    v_mfma_f32_16x16x32_bf16 v[184:187], v[108:111], a[248:251], v[184:187]
    v_mfma_f32_16x16x32_bf16 v[188:191], v[108:111], a[252:255], v[188:191]
    ds_read_b64_tr_b16 v[88:89], v30 offset:0
    v_mfma_f32_16x16x32_bf16 v[192:195], v[112:115], a[240:243], v[192:195]
    ds_read_b64_tr_b16 v[90:91], v30 offset:1024
    buffer_load_dwordx4 a[224:227], v12, s[8:11], s62 offen offset:0
    v_mfma_f32_16x16x32_bf16 v[196:199], v[112:115], a[244:247], v[196:199]
    ds_read_b64_tr_b16 v[92:93], v31 offset:0
    v_mfma_f32_16x16x32_bf16 v[200:203], v[112:115], a[248:251], v[200:203]
    ds_read_b64_tr_b16 v[94:95], v31 offset:1024
    buffer_load_dwordx4 a[228:231], v12, s[8:11], s62 offen offset:1024
    v_mfma_f32_16x16x32_bf16 v[204:207], v[112:115], a[252:255], v[204:207]
    v_mfma_f32_16x16x32_bf16 v[208:211], v[116:119], a[240:243], v[208:211]
    v_mfma_f32_16x16x32_bf16 v[212:215], v[116:119], a[244:247], v[212:215]
    buffer_load_dwordx4 a[232:235], v13, s[8:11], s62 offen offset:0
    v_mfma_f32_16x16x32_bf16 v[216:219], v[116:119], a[248:251], v[216:219]
    v_mfma_f32_16x16x32_bf16 v[220:223], v[116:119], a[252:255], v[220:223]
    v_mfma_f32_16x16x32_bf16 v[224:227], v[120:123], a[240:243], v[224:227]
    buffer_load_dwordx4 a[236:239], v13, s[8:11], s62 offen offset:1024
    v_mfma_f32_16x16x32_bf16 v[228:231], v[120:123], a[244:247], v[228:231]
    v_mfma_f32_16x16x32_bf16 v[232:235], v[120:123], a[248:251], v[232:235]
    v_mfma_f32_16x16x32_bf16 v[236:239], v[120:123], a[252:255], v[236:239]
    s_add_u32 s62, s62, 0x20000
    v_mfma_f32_16x16x32_bf16 v[240:243], v[124:127], a[240:243], v[240:243]
    v_mfma_f32_16x16x32_bf16 v[244:247], v[124:127], a[244:247], v[244:247]
    v_mfma_f32_16x16x32_bf16 v[248:251], v[124:127], a[248:251], v[248:251]
    v_mfma_f32_16x16x32_bf16 v[252:255], v[124:127], a[252:255], v[252:255]
    s_add_u32 s63, s63, 1
    s_cmp_lt_u32 s63, 4
    s_cbranch_scc1 k2_qloop_7
    s_waitcnt vmcnt(0) lgkmcnt(0)
    s_barrier
    s_mov_b32 s32, s60
    s_mov_b32 s34, s60
    s_mov_b32 m0, s34
    s_nop 0
    buffer_load_dwordx4 v1, s[16:19], s32 offen offset:0 lds
    buffer_load_dwordx4 v1, s[16:19], s32 offen offset:1024 lds
    buffer_load_dwordx4 v1, s[16:19], s32 offen offset:2048 lds
    buffer_load_dwordx4 v1, s[16:19], s32 offen offset:3072 lds
    s_add_u32 s32, s32, 0x80000
    s_add_u32 s34, s34, 0x4000
    s_mov_b32 s33, s60
    s_add_u32 s35, s60, 0x10000
    s_mov_b32 m0, s34
    s_nop 0
    buffer_load_dwordx4 v1, s[16:19], s32 offen offset:0 lds
    buffer_load_dwordx4 v1, s[16:19], s32 offen offset:1024 lds
    buffer_load_dwordx4 v1, s[16:19], s32 offen offset:2048 lds
    buffer_load_dwordx4 v1, s[16:19], s32 offen offset:3072 lds
    s_mov_b32 m0, s35
    s_nop 0
    buffer_load_dwordx4 v1, s[20:23], s33 offen offset:0 lds
    buffer_load_dwordx4 v1, s[20:23], s33 offen offset:1024 lds
    buffer_load_dwordx4 v1, s[20:23], s33 offen offset:2048 lds
    buffer_load_dwordx4 v1, s[20:23], s33 offen offset:3072 lds
    s_add_u32 s32, s32, 0x80000
    s_add_u32 s33, s33, 0x80000
    s_add_u32 s34, s34, 0x4000
    s_and_b32 s34, s34, 0xffff
    s_add_u32 s35, s35, 0x4000
    s_and_b32 s35, s35, 0xffff
    s_or_b32 s35, s35, 0x10000
    s_mov_b32 m0, s34
    s_nop 0
    buffer_load_dwordx4 v1, s[16:19], s32 offen offset:0 lds
    buffer_load_dwordx4 v1, s[16:19], s32 offen offset:1024 lds
    buffer_load_dwordx4 v1, s[16:19], s32 offen offset:2048 lds
    buffer_load_dwordx4 v1, s[16:19], s32 offen offset:3072 lds
    s_mov_b32 m0, s35
    s_nop 0
    buffer_load_dwordx4 v1, s[20:23], s33 offen offset:0 lds
    buffer_load_dwordx4 v1, s[20:23], s33 offen offset:1024 lds
    buffer_load_dwordx4 v1, s[20:23], s33 offen offset:2048 lds
    buffer_load_dwordx4 v1, s[20:23], s33 offen offset:3072 lds
    s_add_u32 s32, s32, 0x80000
    s_add_u32 s33, s33, 0x80000
    s_add_u32 s34, s34, 0x4000
    s_and_b32 s34, s34, 0xffff
    s_add_u32 s35, s35, 0x4000
    s_and_b32 s35, s35, 0xffff
    s_or_b32 s35, s35, 0x10000
    s_mov_b32 m0, s34
    s_nop 0
    buffer_load_dwordx4 v1, s[16:19], s32 offen offset:0 lds
    buffer_load_dwordx4 v1, s[16:19], s32 offen offset:1024 lds
    buffer_load_dwordx4 v1, s[16:19], s32 offen offset:2048 lds
    buffer_load_dwordx4 v1, s[16:19], s32 offen offset:3072 lds
    s_mov_b32 m0, s35
    s_nop 0
    buffer_load_dwordx4 v1, s[20:23], s33 offen offset:0 lds
    buffer_load_dwordx4 v1, s[20:23], s33 offen offset:1024 lds
    buffer_load_dwordx4 v1, s[20:23], s33 offen offset:2048 lds
    buffer_load_dwordx4 v1, s[20:23], s33 offen offset:3072 lds
    s_add_u32 s32, s32, 0x80000
    s_add_u32 s33, s33, 0x80000
    s_add_u32 s34, s34, 0x4000
    s_and_b32 s34, s34, 0xffff
    s_add_u32 s35, s35, 0x4000
    s_and_b32 s35, s35, 0xffff
    s_or_b32 s35, s35, 0x10000
    s_mov_b32 s40, 0x3e0293ee
    s_mov_b32 s41, 0x3e0293ee
    v_pk_mul_f32 v[128:129], v[128:129], s[40:41]
    v_pk_mul_f32 v[130:131], v[130:131], s[40:41]
    v_cvt_pk_bf16_f32 v64, v128, v129
    v_cvt_pk_bf16_f32 v65, v130, v131
    v_pk_mul_f32 v[144:145], v[144:145], s[40:41]
    v_pk_mul_f32 v[146:147], v[146:147], s[40:41]
    v_cvt_pk_bf16_f32 v66, v144, v145
    v_cvt_pk_bf16_f32 v67, v146, v147
    v_pk_mul_f32 v[160:161], v[160:161], s[40:41]
    v_pk_mul_f32 v[162:163], v[162:163], s[40:41]
    v_cvt_pk_bf16_f32 v68, v160, v161
    v_cvt_pk_bf16_f32 v69, v162, v163
    v_pk_mul_f32 v[176:177], v[176:177], s[40:41]
    v_pk_mul_f32 v[178:179], v[178:179], s[40:41]
    v_cvt_pk_bf16_f32 v70, v176, v177
    v_cvt_pk_bf16_f32 v71, v178, v179
    v_pk_mul_f32 v[192:193], v[192:193], s[40:41]
    v_pk_mul_f32 v[194:195], v[194:195], s[40:41]
    v_cvt_pk_bf16_f32 v72, v192, v193
    v_cvt_pk_bf16_f32 v73, v194, v195
    v_pk_mul_f32 v[208:209], v[208:209], s[40:41]
    v_pk_mul_f32 v[210:211], v[210:211], s[40:41]
    v_cvt_pk_bf16_f32 v74, v208, v209
    v_cvt_pk_bf16_f32 v75, v210, v211
    v_pk_mul_f32 v[224:225], v[224:225], s[40:41]
    v_pk_mul_f32 v[226:227], v[226:227], s[40:41]
    v_cvt_pk_bf16_f32 v76, v224, v225
    v_cvt_pk_bf16_f32 v77, v226, v227
    v_pk_mul_f32 v[240:241], v[240:241], s[40:41]
    v_pk_mul_f32 v[242:243], v[242:243], s[40:41]
    v_cvt_pk_bf16_f32 v78, v240, v241
    v_cvt_pk_bf16_f32 v79, v242, v243
    v_pk_mul_f32 v[132:133], v[132:133], s[40:41]
    v_pk_mul_f32 v[134:135], v[134:135], s[40:41]
    v_cvt_pk_bf16_f32 v80, v132, v133
    v_cvt_pk_bf16_f32 v81, v134, v135
    v_pk_mul_f32 v[148:149], v[148:149], s[40:41]
    v_pk_mul_f32 v[150:151], v[150:151], s[40:41]
    v_cvt_pk_bf16_f32 v82, v148, v149
    v_cvt_pk_bf16_f32 v83, v150, v151
    v_pk_mul_f32 v[164:165], v[164:165], s[40:41]
    v_pk_mul_f32 v[166:167], v[166:167], s[40:41]
    v_cvt_pk_bf16_f32 v84, v164, v165
    v_cvt_pk_bf16_f32 v85, v166, v167
    v_pk_mul_f32 v[180:181], v[180:181], s[40:41]
    v_pk_mul_f32 v[182:183], v[182:183], s[40:41]
    v_cvt_pk_bf16_f32 v86, v180, v181
    v_cvt_pk_bf16_f32 v87, v182, v183
    v_pk_mul_f32 v[196:197], v[196:197], s[40:41]
    v_pk_mul_f32 v[198:199], v[198:199], s[40:41]
    v_cvt_pk_bf16_f32 v88, v196, v197
    v_cvt_pk_bf16_f32 v89, v198, v199
    v_pk_mul_f32 v[212:213], v[212:213], s[40:41]
    v_pk_mul_f32 v[214:215], v[214:215], s[40:41]
    v_cvt_pk_bf16_f32 v90, v212, v213
    v_cvt_pk_bf16_f32 v91, v214, v215
    v_pk_mul_f32 v[228:229], v[228:229], s[40:41]
    v_pk_mul_f32 v[230:231], v[230:231], s[40:41]
    v_cvt_pk_bf16_f32 v92, v228, v229
    v_cvt_pk_bf16_f32 v93, v230, v231
    v_pk_mul_f32 v[244:245], v[244:245], s[40:41]
    v_pk_mul_f32 v[246:247], v[246:247], s[40:41]
    v_cvt_pk_bf16_f32 v94, v244, v245
    v_cvt_pk_bf16_f32 v95, v246, v247
    v_pk_mul_f32 v[136:137], v[136:137], s[40:41]
    v_pk_mul_f32 v[138:139], v[138:139], s[40:41]
    v_cvt_pk_bf16_f32 v96, v136, v137
    v_cvt_pk_bf16_f32 v97, v138, v139
    v_pk_mul_f32 v[152:153], v[152:153], s[40:41]
    v_pk_mul_f32 v[154:155], v[154:155], s[40:41]
    v_cvt_pk_bf16_f32 v98, v152, v153
    v_cvt_pk_bf16_f32 v99, v154, v155
    v_pk_mul_f32 v[168:169], v[168:169], s[40:41]
    v_pk_mul_f32 v[170:171], v[170:171], s[40:41]
    v_cvt_pk_bf16_f32 v100, v168, v169
    v_cvt_pk_bf16_f32 v101, v170, v171
    v_pk_mul_f32 v[184:185], v[184:185], s[40:41]
    v_pk_mul_f32 v[186:187], v[186:187], s[40:41]
    v_cvt_pk_bf16_f32 v102, v184, v185
    v_cvt_pk_bf16_f32 v103, v186, v187
    v_pk_mul_f32 v[200:201], v[200:201], s[40:41]
    v_pk_mul_f32 v[202:203], v[202:203], s[40:41]
    v_cvt_pk_bf16_f32 v104, v200, v201
    v_cvt_pk_bf16_f32 v105, v202, v203
    v_pk_mul_f32 v[216:217], v[216:217], s[40:41]
    v_pk_mul_f32 v[218:219], v[218:219], s[40:41]
    v_cvt_pk_bf16_f32 v106, v216, v217
    v_cvt_pk_bf16_f32 v107, v218, v219
    v_pk_mul_f32 v[232:233], v[232:233], s[40:41]
    v_pk_mul_f32 v[234:235], v[234:235], s[40:41]
    v_cvt_pk_bf16_f32 v108, v232, v233
    v_cvt_pk_bf16_f32 v109, v234, v235
    v_pk_mul_f32 v[248:249], v[248:249], s[40:41]
    v_pk_mul_f32 v[250:251], v[250:251], s[40:41]
    v_cvt_pk_bf16_f32 v110, v248, v249
    v_cvt_pk_bf16_f32 v111, v250, v251
    v_pk_mul_f32 v[140:141], v[140:141], s[40:41]
    v_pk_mul_f32 v[142:143], v[142:143], s[40:41]
    v_cvt_pk_bf16_f32 v112, v140, v141
    v_cvt_pk_bf16_f32 v113, v142, v143
    v_pk_mul_f32 v[156:157], v[156:157], s[40:41]
    v_pk_mul_f32 v[158:159], v[158:159], s[40:41]
    v_cvt_pk_bf16_f32 v114, v156, v157
    v_cvt_pk_bf16_f32 v115, v158, v159
    v_pk_mul_f32 v[172:173], v[172:173], s[40:41]
    v_pk_mul_f32 v[174:175], v[174:175], s[40:41]
    v_cvt_pk_bf16_f32 v116, v172, v173
    v_cvt_pk_bf16_f32 v117, v174, v175
    v_pk_mul_f32 v[188:189], v[188:189], s[40:41]
    v_pk_mul_f32 v[190:191], v[190:191], s[40:41]
    v_cvt_pk_bf16_f32 v118, v188, v189
    v_cvt_pk_bf16_f32 v119, v190, v191
    v_pk_mul_f32 v[204:205], v[204:205], s[40:41]
    v_pk_mul_f32 v[206:207], v[206:207], s[40:41]
    v_cvt_pk_bf16_f32 v120, v204, v205
    v_cvt_pk_bf16_f32 v121, v206, v207
    v_pk_mul_f32 v[220:221], v[220:221], s[40:41]
    v_pk_mul_f32 v[222:223], v[222:223], s[40:41]
    v_cvt_pk_bf16_f32 v122, v220, v221
    v_cvt_pk_bf16_f32 v123, v222, v223
    v_pk_mul_f32 v[236:237], v[236:237], s[40:41]
    v_pk_mul_f32 v[238:239], v[238:239], s[40:41]
    v_cvt_pk_bf16_f32 v124, v236, v237
    v_cvt_pk_bf16_f32 v125, v238, v239
    v_pk_mul_f32 v[252:253], v[252:253], s[40:41]
    v_pk_mul_f32 v[254:255], v[254:255], s[40:41]
    v_cvt_pk_bf16_f32 v126, v252, v253
    v_cvt_pk_bf16_f32 v127, v254, v255
    v_mov_b32 v2, v1
    v_or_b32 v3, 0x10000, v1
    v_mov_b32 v8, 0
    v_mov_b32 v12, 0
    v_mov_b32 v9, 0
    v_mov_b32 v13, 0
    v_mov_b32 v10, 0
    v_mov_b32 v14, 0
    v_mov_b32 v11, 0
    v_mov_b32 v15, 0
    v_mov_b32 v16, 0
    v_mov_b32 v17, 0
    v_mov_b32 v18, 0
    v_mov_b32 v19, 0
    v_mov_b32 v20, 0
    v_mov_b32 v21, 0
    v_mov_b32 v22, 0
    v_mov_b32 v23, 0
    v_mov_b32 v24, 0
    v_mov_b32 v25, 0
    v_mov_b32 v26, 0
    v_mov_b32 v27, 0
    v_mov_b32 v28, 0
    v_mov_b32 v29, 0
    v_mov_b32 v30, 0
    v_mov_b32 v31, 0
    v_mov_b32 v32, 0
    v_mov_b32 v33, 0
    v_mov_b32 v34, 0
    v_mov_b32 v35, 0
    v_mov_b32 v36, 0
    v_mov_b32 v37, 0
    v_mov_b32 v38, 0
    v_mov_b32 v39, 0
    v_mov_b32 v40, 0
    v_mov_b32 v41, 0
    v_mov_b32 v42, 0
    v_mov_b32 v43, 0
    v_mov_b32 v44, 0
    v_mov_b32 v45, 0
    v_mov_b32 v46, 0
    v_mov_b32 v47, 0
    s_mov_b32 s36, 0
    s_mov_b32 s37, 0x46800000
    s_waitcnt vmcnt(24)
    s_barrier
    s_waitcnt lgkmcnt(0)
    ds_read_b128 a[128:131], v2 offset:0
    ds_read_b128 a[132:135], v2 offset:1024
    ds_read_b128 a[136:139], v2 offset:2048
    ds_read_b128 a[140:143], v2 offset:3072
    ds_read_b128 a[144:147], v2 offset:4096
    ds_read_b128 a[148:151], v2 offset:5120
    ds_read_b128 a[152:155], v2 offset:6144
    ds_read_b128 a[156:159], v2 offset:7168
    v_add_u32 v2, 8192, v2
    v_and_b32 v2, 0xffff, v2
    s_waitcnt lgkmcnt(0)
    s_cmp_lt_u32 s36, s42
    s_cbranch_scc1 k2_noprep_8
    s_sub_u32 s40, s36, s38
    v_subrev_u32 v6, s40, v4
    v_cmp_gt_i32 s[44:45], -16, v6
    v_cmp_gt_i32 s[46:47], -15, v6
    v_cmp_gt_i32 s[48:49], -14, v6
    v_cmp_gt_i32 s[50:51], -13, v6
    s_nop 1
    v_cndmask_b32 v20, v9, v5, s[44:45]
    v_cndmask_b32 v21, v9, v5, s[46:47]
    v_cndmask_b32 v22, v9, v5, s[48:49]
    v_cndmask_b32 v23, v9, v5, s[50:51]
    v_cmp_gt_i32 s[52:53], 0, v6
    v_cmp_gt_i32 s[54:55], 1, v6
    v_cmp_gt_i32 s[56:57], 2, v6
    v_cmp_gt_i32 s[58:59], 3, v6
    s_nop 1
    v_cndmask_b32 v16, v8, v5, s[52:53]
    v_cndmask_b32 v17, v8, v5, s[54:55]
    v_cndmask_b32 v18, v8, v5, s[56:57]
    v_cndmask_b32 v19, v8, v5, s[58:59]
    v_cndmask_b32 v36, v9, v5, s[52:53]
    v_cndmask_b32 v37, v9, v5, s[54:55]
    v_cndmask_b32 v38, v9, v5, s[56:57]
    v_cndmask_b32 v39, v9, v5, s[58:59]
    v_cmp_gt_i32 s[44:45], 16, v6
    v_cmp_gt_i32 s[46:47], 17, v6
    v_cmp_gt_i32 s[48:49], 18, v6
    v_cmp_gt_i32 s[50:51], 19, v6
    s_nop 1
    v_cndmask_b32 v32, v8, v5, s[44:45]
    v_cndmask_b32 v33, v8, v5, s[46:47]
    v_cndmask_b32 v34, v8, v5, s[48:49]
    v_cndmask_b32 v35, v8, v5, s[50:51]
    s_nop 1
k2_noprep_8:
    v_mfma_f32_16x16x32_bf16 v[128:131], a[128:131], v[64:67], v[16:19]
    v_mfma_f32_16x16x32_bf16 v[132:135], a[128:131], v[80:83], v[20:23]
    v_mfma_f32_16x16x32_bf16 v[136:139], a[128:131], v[96:99], v[24:27]
    v_mfma_f32_16x16x32_bf16 v[140:143], a[128:131], v[112:115], v[28:31]
    v_mfma_f32_16x16x32_bf16 v[128:131], a[132:135], v[68:71], v[128:131]
    v_mfma_f32_16x16x32_bf16 v[132:135], a[132:135], v[84:87], v[132:135]
    v_mfma_f32_16x16x32_bf16 v[136:139], a[132:135], v[100:103], v[136:139]
    v_mfma_f32_16x16x32_bf16 v[140:143], a[132:135], v[116:119], v[140:143]
    v_mfma_f32_16x16x32_bf16 v[128:131], a[136:139], v[72:75], v[128:131]
    v_mfma_f32_16x16x32_bf16 v[132:135], a[136:139], v[88:91], v[132:135]
    v_mfma_f32_16x16x32_bf16 v[136:139], a[136:139], v[104:107], v[136:139]
    v_mfma_f32_16x16x32_bf16 v[140:143], a[136:139], v[120:123], v[140:143]
    v_mfma_f32_16x16x32_bf16 v[128:131], a[140:143], v[76:79], v[128:131]
    v_mfma_f32_16x16x32_bf16 v[132:135], a[140:143], v[92:95], v[132:135]
    v_mfma_f32_16x16x32_bf16 v[136:139], a[140:143], v[108:111], v[136:139]
    v_mfma_f32_16x16x32_bf16 v[140:143], a[140:143], v[124:127], v[140:143]
    v_mfma_f32_16x16x32_bf16 v[144:147], a[144:147], v[64:67], v[32:35]
    v_mfma_f32_16x16x32_bf16 v[148:151], a[144:147], v[80:83], v[36:39]
    v_mfma_f32_16x16x32_bf16 v[152:155], a[144:147], v[96:99], v[40:43]
    v_mfma_f32_16x16x32_bf16 v[156:159], a[144:147], v[112:115], v[44:47]
    v_mfma_f32_16x16x32_bf16 v[144:147], a[148:151], v[68:71], v[144:147]
    v_mfma_f32_16x16x32_bf16 v[148:151], a[148:151], v[84:87], v[148:151]
    v_mfma_f32_16x16x32_bf16 v[152:155], a[148:151], v[100:103], v[152:155]
    v_mfma_f32_16x16x32_bf16 v[156:159], a[148:151], v[116:119], v[156:159]
    v_mfma_f32_16x16x32_bf16 v[144:147], a[152:155], v[72:75], v[144:147]
    v_mfma_f32_16x16x32_bf16 v[148:151], a[152:155], v[88:91], v[148:151]
    v_mfma_f32_16x16x32_bf16 v[152:155], a[152:155], v[104:107], v[152:155]
    v_mfma_f32_16x16x32_bf16 v[156:159], a[152:155], v[120:123], v[156:159]
    v_mfma_f32_16x16x32_bf16 v[144:147], a[156:159], v[76:79], v[144:147]
    v_mfma_f32_16x16x32_bf16 v[148:151], a[156:159], v[92:95], v[148:151]
    v_mfma_f32_16x16x32_bf16 v[152:155], a[156:159], v[108:111], v[152:155]
    v_mfma_f32_16x16x32_bf16 v[156:159], a[156:159], v[124:127], v[156:159]
    s_add_u32 s36, s36, 32
    s_nop 7
    v_max_f32 v52, v128, v129
    v_max3_f32 v52, v52, v130, v131
    v_max3_f32 v52, v52, v144, v145
    v_max3_f32 v52, v52, v146, v147
    v_mov_b32 v6, v52
    s_nop 1
    v_permlane16_swap_b32 v52, v6
    s_nop 1
    v_max_f32 v52, v52, v6
    v_mov_b32 v6, v52
    s_nop 1
    v_permlane32_swap_b32 v52, v6
    s_nop 1
    v_max_f32 v52, v52, v6
    v_max_f32 v53, v132, v133
    v_max3_f32 v53, v53, v134, v135
    v_max3_f32 v53, v53, v148, v149
    v_max3_f32 v53, v53, v150, v151
    v_mov_b32 v6, v53
    s_nop 1
    v_permlane16_swap_b32 v53, v6
    s_nop 1
    v_max_f32 v53, v53, v6
    v_mov_b32 v6, v53
    s_nop 1
    v_permlane32_swap_b32 v53, v6
    s_nop 1
    v_max_f32 v53, v53, v6
    v_max_f32 v54, v136, v137
    v_max3_f32 v54, v54, v138, v139
    v_max3_f32 v54, v54, v152, v153
    v_max3_f32 v54, v54, v154, v155
    v_mov_b32 v6, v54
    s_nop 1
    v_permlane16_swap_b32 v54, v6
    s_nop 1
    v_max_f32 v54, v54, v6
    v_mov_b32 v6, v54
    s_nop 1
    v_permlane32_swap_b32 v54, v6
    s_nop 1
    v_max_f32 v54, v54, v6
    v_max_f32 v55, v140, v141
    v_max3_f32 v55, v55, v142, v143
    v_max3_f32 v55, v55, v156, v157
    v_max3_f32 v55, v55, v158, v159
    v_mov_b32 v6, v55
    s_nop 1
    v_permlane16_swap_b32 v55, v6
    s_nop 1
    v_max_f32 v55, v55, v6
    v_mov_b32 v6, v55
    s_nop 1
    v_permlane32_swap_b32 v55, v6
    s_nop 1
    v_max_f32 v55, v55, v6
    v_sub_f32 v128, v128, v52
    v_sub_f32 v16, 0, v52
    v_sub_f32 v129, v129, v52
    v_sub_f32 v17, 0, v52
    v_sub_f32 v130, v130, v52
    v_sub_f32 v18, 0, v52
    v_sub_f32 v131, v131, v52
    v_sub_f32 v19, 0, v52
    v_sub_f32 v132, v132, v53
    v_sub_f32 v20, 0, v53
    v_sub_f32 v133, v133, v53
    v_sub_f32 v21, 0, v53
    v_sub_f32 v134, v134, v53
    v_sub_f32 v22, 0, v53
    v_sub_f32 v135, v135, v53
    v_sub_f32 v23, 0, v53
    v_sub_f32 v136, v136, v54
    v_sub_f32 v24, 0, v54
    v_sub_f32 v137, v137, v54
    v_sub_f32 v25, 0, v54
    v_sub_f32 v138, v138, v54
    v_sub_f32 v26, 0, v54
    v_sub_f32 v139, v139, v54
    v_sub_f32 v27, 0, v54
    v_sub_f32 v140, v140, v55
    v_sub_f32 v28, 0, v55
    v_sub_f32 v141, v141, v55
    v_sub_f32 v29, 0, v55
    v_sub_f32 v142, v142, v55
    v_sub_f32 v30, 0, v55
    v_sub_f32 v143, v143, v55
    v_sub_f32 v31, 0, v55
    v_sub_f32 v144, v144, v52
    v_sub_f32 v32, 0, v52
    v_sub_f32 v145, v145, v52
    v_sub_f32 v33, 0, v52
    v_sub_f32 v146, v146, v52
    v_sub_f32 v34, 0, v52
    v_sub_f32 v147, v147, v52
    v_sub_f32 v35, 0, v52
    v_sub_f32 v148, v148, v53
    v_sub_f32 v36, 0, v53
    v_sub_f32 v149, v149, v53
    v_sub_f32 v37, 0, v53
    v_sub_f32 v150, v150, v53
    v_sub_f32 v38, 0, v53
    v_sub_f32 v151, v151, v53
    v_sub_f32 v39, 0, v53
    v_sub_f32 v152, v152, v54
    v_sub_f32 v40, 0, v54
    v_sub_f32 v153, v153, v54
    v_sub_f32 v41, 0, v54
    v_sub_f32 v154, v154, v54
    v_sub_f32 v42, 0, v54
    v_sub_f32 v155, v155, v54
    v_sub_f32 v43, 0, v54
    v_sub_f32 v156, v156, v55
    v_sub_f32 v44, 0, v55
    v_sub_f32 v157, v157, v55
    v_sub_f32 v45, 0, v55
    v_sub_f32 v158, v158, v55
    v_sub_f32 v46, 0, v55
    v_sub_f32 v159, v159, v55
    v_sub_f32 v47, 0, v55
    v_sub_f32 v8, 0, v52
    v_sub_f32 v9, 0, v53
    v_sub_f32 v10, 0, v54
    v_sub_f32 v11, 0, v55
    s_waitcnt lgkmcnt(0)
    ds_read_b128 a[128:131], v2 offset:0
    ds_read_b128 a[132:135], v2 offset:1024
    ds_read_b128 a[136:139], v2 offset:2048
    ds_read_b128 a[140:143], v2 offset:3072
    ds_read_b128 a[144:147], v2 offset:4096
    ds_read_b128 a[148:151], v2 offset:5120
    ds_read_b128 a[152:155], v2 offset:6144
    ds_read_b128 a[156:159], v2 offset:7168
    v_add_u32 v2, 8192, v2
    v_and_b32 v2, 0xffff, v2
    s_waitcnt vmcnt(16) lgkmcnt(0)
    s_barrier
    s_cmp_lt_u32 s36, s42
    s_cbranch_scc1 k2_noprep_9
    s_sub_u32 s40, s36, s38
    v_subrev_u32 v6, s40, v4
    v_cmp_gt_i32 s[44:45], -16, v6
    v_cmp_gt_i32 s[46:47], -15, v6
    v_cmp_gt_i32 s[48:49], -14, v6
    v_cmp_gt_i32 s[50:51], -13, v6
    s_nop 1
    v_cndmask_b32 v20, v9, v5, s[44:45]
    v_cndmask_b32 v21, v9, v5, s[46:47]
    v_cndmask_b32 v22, v9, v5, s[48:49]
    v_cndmask_b32 v23, v9, v5, s[50:51]
    v_cmp_gt_i32 s[52:53], 0, v6
    v_cmp_gt_i32 s[54:55], 1, v6
    v_cmp_gt_i32 s[56:57], 2, v6
    v_cmp_gt_i32 s[58:59], 3, v6
    s_nop 1
    v_cndmask_b32 v16, v8, v5, s[52:53]
    v_cndmask_b32 v17, v8, v5, s[54:55]
    v_cndmask_b32 v18, v8, v5, s[56:57]
    v_cndmask_b32 v19, v8, v5, s[58:59]
    v_cndmask_b32 v36, v9, v5, s[52:53]
    v_cndmask_b32 v37, v9, v5, s[54:55]
    v_cndmask_b32 v38, v9, v5, s[56:57]
    v_cndmask_b32 v39, v9, v5, s[58:59]
    v_cmp_gt_i32 s[44:45], 16, v6
    v_cmp_gt_i32 s[46:47], 17, v6
    v_cmp_gt_i32 s[48:49], 18, v6
    v_cmp_gt_i32 s[50:51], 19, v6
    s_nop 1
    v_cndmask_b32 v32, v8, v5, s[44:45]
    v_cndmask_b32 v33, v8, v5, s[46:47]
    v_cndmask_b32 v34, v8, v5, s[48:49]
    v_cndmask_b32 v35, v8, v5, s[50:51]
    s_nop 1
k2_noprep_9:
    v_mfma_f32_16x16x32_bf16 v[160:163], a[128:131], v[64:67], v[16:19]
    ds_read_b128 a[192:195], v3 offset:0
    v_exp_f32 v56, v128
    v_exp_f32 v57, v129
    v_exp_f32 v58, v130
    v_mfma_f32_16x16x32_bf16 v[164:167], a[128:131], v[80:83], v[20:23]
    v_exp_f32 v59, v131
    v_add_f32 v48, v56, v57
    v_cvt_pk_bf16_f32 v192, v56, v57
    v_mfma_f32_16x16x32_bf16 v[168:171], a[128:131], v[96:99], v[24:27]
    ds_read_b128 a[196:199], v3 offset:1024
    v_exp_f32 v60, v144
    v_exp_f32 v61, v145
    v_add_f32 v48, v48, v58
    v_mfma_f32_16x16x32_bf16 v[172:175], a[128:131], v[112:115], v[28:31]
    v_add_f32 v48, v48, v59
    v_cvt_pk_bf16_f32 v193, v58, v59
    v_mfma_f32_16x16x32_bf16 v[160:163], a[132:135], v[68:71], v[160:163]
    ds_read_b128 a[200:203], v3 offset:2048
    v_exp_f32 v62, v146
    v_exp_f32 v63, v147
    v_add_f32 v48, v48, v60
    s_mov_b32 m0, s34
    s_nop 0
    buffer_load_dwordx4 v1, s[16:19], s32 offen offset:0 lds
    v_mfma_f32_16x16x32_bf16 v[164:167], a[132:135], v[84:87], v[164:167]
    v_add_f32 v48, v48, v61
    v_cvt_pk_bf16_f32 v194, v60, v61
    v_exp_f32 v56, v132
    v_mfma_f32_16x16x32_bf16 v[168:171], a[132:135], v[100:103], v[168:171]
    ds_read_b128 a[204:207], v3 offset:3072
    v_exp_f32 v57, v133
    v_add_f32 v48, v48, v62
    v_add_f32 v48, v48, v63
    buffer_load_dwordx4 v1, s[16:19], s32 offen offset:1024 lds
    v_mfma_f32_16x16x32_bf16 v[172:175], a[132:135], v[116:119], v[172:175]
    v_cvt_pk_bf16_f32 v195, v62, v63
    v_exp_f32 v58, v134
    v_mfma_f32_16x16x32_bf16 v[160:163], a[136:139], v[72:75], v[160:163]
    ds_read_b128 a[208:211], v3 offset:4096
    v_exp_f32 v59, v135
    v_add_f32 v49, v56, v57
    v_cvt_pk_bf16_f32 v196, v56, v57
    v_mfma_f32_16x16x32_bf16 v[164:167], a[136:139], v[88:91], v[164:167]
    v_exp_f32 v60, v148
    v_exp_f32 v61, v149
    v_add_f32 v49, v49, v58
    buffer_load_dwordx4 v1, s[16:19], s32 offen offset:2048 lds
    v_mfma_f32_16x16x32_bf16 v[168:171], a[136:139], v[104:107], v[168:171]
    v_add_f32 v49, v49, v59
    v_cvt_pk_bf16_f32 v197, v58, v59
    v_exp_f32 v62, v150
    v_mfma_f32_16x16x32_bf16 v[172:175], a[136:139], v[120:123], v[172:175]
    ds_read_b128 a[212:215], v3 offset:5120
    v_exp_f32 v63, v151
    v_add_f32 v49, v49, v60
    v_mfma_f32_16x16x32_bf16 v[160:163], a[140:143], v[76:79], v[160:163]
    v_add_f32 v49, v49, v61
    v_cvt_pk_bf16_f32 v198, v60, v61
    v_exp_f32 v56, v136
    buffer_load_dwordx4 v1, s[16:19], s32 offen offset:3072 lds
    v_mfma_f32_16x16x32_bf16 v[164:167], a[140:143], v[92:95], v[164:167]
    ds_read_b128 a[216:219], v3 offset:6144
    v_exp_f32 v57, v137
    v_add_f32 v49, v49, v62
    v_add_f32 v49, v49, v63
    v_mfma_f32_16x16x32_bf16 v[168:171], a[140:143], v[108:111], v[168:171]
    v_cvt_pk_bf16_f32 v199, v62, v63
    v_exp_f32 v58, v138
    v_exp_f32 v59, v139
    v_mfma_f32_16x16x32_bf16 v[172:175], a[140:143], v[124:127], v[172:175]
    ds_read_b128 a[220:223], v3 offset:7168
    v_add_f32 v50, v56, v57
    v_cvt_pk_bf16_f32 v200, v56, v57
    s_mov_b32 m0, s35
    s_nop 0
    buffer_load_dwordx4 v1, s[20:23], s33 offen offset:0 lds
    v_mfma_f32_16x16x32_bf16 v[176:179], a[144:147], v[64:67], v[32:35]
    v_exp_f32 v60, v152
    v_exp_f32 v61, v153
    v_add_f32 v50, v50, v58
    v_mfma_f32_16x16x32_bf16 v[180:183], a[144:147], v[80:83], v[36:39]
    v_add_u32 v3, 8192, v3
    v_and_b32 v3, 0xffff, v3
    v_or_b32 v3, 0x10000, v3
    v_add_f32 v50, v50, v59
    v_cvt_pk_bf16_f32 v201, v58, v59
    v_exp_f32 v62, v154
    v_mfma_f32_16x16x32_bf16 v[184:187], a[144:147], v[96:99], v[40:43]
    v_exp_f32 v63, v155
    v_add_f32 v50, v50, v60
    v_add_f32 v50, v50, v61
    buffer_load_dwordx4 v1, s[20:23], s33 offen offset:1024 lds
    v_mfma_f32_16x16x32_bf16 v[188:191], a[144:147], v[112:115], v[44:47]
    v_cvt_pk_bf16_f32 v202, v60, v61
    v_exp_f32 v56, v140
    v_mfma_f32_16x16x32_bf16 v[176:179], a[148:151], v[68:71], v[176:179]
    v_exp_f32 v57, v141
    v_add_f32 v50, v50, v62
    v_add_f32 v50, v50, v63
    v_mfma_f32_16x16x32_bf16 v[180:183], a[148:151], v[84:87], v[180:183]
    v_cvt_pk_bf16_f32 v203, v62, v63
    v_exp_f32 v58, v142
    v_exp_f32 v59, v143
    buffer_load_dwordx4 v1, s[20:23], s33 offen offset:2048 lds
    v_mfma_f32_16x16x32_bf16 v[184:187], a[148:151], v[100:103], v[184:187]
    v_add_f32 v51, v56, v57
    v_cvt_pk_bf16_f32 v204, v56, v57
    v_exp_f32 v60, v156
    v_mfma_f32_16x16x32_bf16 v[188:191], a[148:151], v[116:119], v[188:191]
    v_exp_f32 v61, v157
    v_add_f32 v51, v51, v58
    v_mfma_f32_16x16x32_bf16 v[176:179], a[152:155], v[72:75], v[176:179]
    v_add_f32 v51, v51, v59
    v_cvt_pk_bf16_f32 v205, v58, v59
    v_exp_f32 v62, v158
    buffer_load_dwordx4 v1, s[20:23], s33 offen offset:3072 lds
    v_mfma_f32_16x16x32_bf16 v[180:183], a[152:155], v[88:91], v[180:183]
    v_exp_f32 v63, v159
    v_add_f32 v51, v51, v60
    v_add_f32 v51, v51, v61
    v_mfma_f32_16x16x32_bf16 v[184:187], a[152:155], v[104:107], v[184:187]
    v_cvt_pk_bf16_f32 v206, v60, v61
    s_nop 0
    v_add_f32 v51, v51, v62
    v_mfma_f32_16x16x32_bf16 v[188:191], a[152:155], v[120:123], v[188:191]
    v_add_f32 v51, v51, v63
    v_cvt_pk_bf16_f32 v207, v62, v63
    s_add_u32 s32, s32, 0x80000
    s_add_u32 s33, s33, 0x80000
    s_add_u32 s34, s34, 0x4000
    s_and_b32 s34, s34, 0xffff
    s_add_u32 s35, s35, 0x4000
    s_and_b32 s35, s35, 0xffff
    s_or_b32 s35, s35, 0x10000
    v_mfma_f32_16x16x32_bf16 v[176:179], a[156:159], v[76:79], v[176:179]
    v_mfma_f32_16x16x32_bf16 v[180:183], a[156:159], v[92:95], v[180:183]
    v_mfma_f32_16x16x32_bf16 v[184:187], a[156:159], v[108:111], v[184:187]
    v_mfma_f32_16x16x32_bf16 v[188:191], a[156:159], v[124:127], v[188:191]
    s_add_u32 s36, s36, 32
    v_max3_f32 v6, v48, v49, v50
    v_max_f32 v6, v6, v51
    v_cmp_nge_f32 vcc, s37, v6
    s_cbranch_vccnz k2_rare_10
k2_ret_11:
    v_add_f32 v12, v12, v48
    v_add_f32 v13, v13, v49
    v_add_f32 v14, v14, v50
    v_add_f32 v15, v15, v51
    s_lshl_b32 s63, s29, 1
    s_add_u32 s63, s63, 1
k2_dloop_12:
    s_waitcnt lgkmcnt(0)
    v_mfma_f32_16x16x32_bf16 a[0:3], a[192:195], v[192:195], a[0:3]
    ds_read_b128 a[128:131], v2 offset:0
    v_exp_f32 v56, v160
    v_exp_f32 v57, v161
    v_mfma_f32_16x16x32_bf16 a[4:7], a[192:195], v[196:199], a[4:7]
    v_exp_f32 v58, v162
    v_mfma_f32_16x16x32_bf16 a[8:11], a[192:195], v[200:203], a[8:11]
    ds_read_b128 a[132:135], v2 offset:1024
    v_exp_f32 v59, v163
    v_mfma_f32_16x16x32_bf16 a[12:15], a[192:195], v[204:207], a[12:15]
    v_add_f32 v48, v56, v57
    v_mfma_f32_16x16x32_bf16 a[16:19], a[196:199], v[192:195], a[16:19]
    ds_read_b128 a[136:139], v2 offset:2048
    v_cvt_pk_bf16_f32 v208, v56, v57
    v_mfma_f32_16x16x32_bf16 a[20:23], a[196:199], v[196:199], a[20:23]
    v_exp_f32 v60, v176
    v_exp_f32 v61, v177
    v_mfma_f32_16x16x32_bf16 a[24:27], a[196:199], v[200:203], a[24:27]
    ds_read_b128 a[140:143], v2 offset:3072
    v_add_f32 v48, v48, v58
    v_mfma_f32_16x16x32_bf16 a[28:31], a[196:199], v[204:207], a[28:31]
    v_add_f32 v48, v48, v59
    v_mfma_f32_16x16x32_bf16 a[32:35], a[200:203], v[192:195], a[32:35]
    ds_read_b128 a[144:147], v2 offset:4096
    v_cvt_pk_bf16_f32 v209, v58, v59
    v_mfma_f32_16x16x32_bf16 a[36:39], a[200:203], v[196:199], a[36:39]
    v_exp_f32 v62, v178
    v_mfma_f32_16x16x32_bf16 a[40:43], a[200:203], v[200:203], a[40:43]
    v_exp_f32 v63, v179
    v_add_f32 v48, v48, v60
    v_mfma_f32_16x16x32_bf16 a[44:47], a[200:203], v[204:207], a[44:47]
    ds_read_b128 a[148:151], v2 offset:5120
    v_add_f32 v48, v48, v61
    v_mfma_f32_16x16x32_bf16 a[48:51], a[204:207], v[192:195], a[48:51]
    v_cvt_pk_bf16_f32 v210, v60, v61
    v_mfma_f32_16x16x32_bf16 a[52:55], a[204:207], v[196:199], a[52:55]
    ds_read_b128 a[152:155], v2 offset:6144
    v_exp_f32 v56, v164
    v_mfma_f32_16x16x32_bf16 a[56:59], a[204:207], v[200:203], a[56:59]
    v_exp_f32 v57, v165
    v_mfma_f32_16x16x32_bf16 a[60:63], a[204:207], v[204:207], a[60:63]
    ds_read_b128 a[156:159], v2 offset:7168
    v_add_f32 v48, v48, v62
    v_mfma_f32_16x16x32_bf16 a[64:67], a[208:211], v[192:195], a[64:67]
    v_add_f32 v48, v48, v63
    v_cvt_pk_bf16_f32 v211, v62, v63
    v_mfma_f32_16x16x32_bf16 a[68:71], a[208:211], v[196:199], a[68:71]
    v_add_u32 v2, 8192, v2
    v_and_b32 v2, 0xffff, v2
    v_exp_f32 v58, v166
    v_mfma_f32_16x16x32_bf16 a[72:75], a[208:211], v[200:203], a[72:75]
    v_exp_f32 v59, v167
    v_mfma_f32_16x16x32_bf16 a[76:79], a[208:211], v[204:207], a[76:79]
    v_add_f32 v49, v56, v57
    v_mfma_f32_16x16x32_bf16 a[80:83], a[212:215], v[192:195], a[80:83]
    v_cvt_pk_bf16_f32 v212, v56, v57
    v_mfma_f32_16x16x32_bf16 a[84:87], a[212:215], v[196:199], a[84:87]
    v_exp_f32 v60, v180
    v_exp_f32 v61, v181
    v_mfma_f32_16x16x32_bf16 a[88:91], a[212:215], v[200:203], a[88:91]
    v_add_f32 v49, v49, v58
    v_mfma_f32_16x16x32_bf16 a[92:95], a[212:215], v[204:207], a[92:95]
    v_add_f32 v49, v49, v59
    v_mfma_f32_16x16x32_bf16 a[96:99], a[216:219], v[192:195], a[96:99]
    v_cvt_pk_bf16_f32 v213, v58, v59
    v_mfma_f32_16x16x32_bf16 a[100:103], a[216:219], v[196:199], a[100:103]
    v_exp_f32 v62, v182
    v_mfma_f32_16x16x32_bf16 a[104:107], a[216:219], v[200:203], a[104:107]
    v_exp_f32 v63, v183
    v_add_f32 v49, v49, v60
    v_mfma_f32_16x16x32_bf16 a[108:111], a[216:219], v[204:207], a[108:111]
    v_add_f32 v49, v49, v61
    v_mfma_f32_16x16x32_bf16 a[112:115], a[220:223], v[192:195], a[112:115]
    v_cvt_pk_bf16_f32 v214, v60, v61
    v_mfma_f32_16x16x32_bf16 a[116:119], a[220:223], v[196:199], a[116:119]
    v_exp_f32 v56, v168
    v_mfma_f32_16x16x32_bf16 a[120:123], a[220:223], v[200:203], a[120:123]
    v_exp_f32 v57, v169
    v_mfma_f32_16x16x32_bf16 a[124:127], a[220:223], v[204:207], a[124:127]
    v_add_f32 v49, v49, v62
    s_waitcnt lgkmcnt(0)
    s_cmp_lt_u32 s36, s42
    s_cbranch_scc1 k2_noprep_13
    s_sub_u32 s40, s36, s38
    v_subrev_u32 v6, s40, v4
    v_cmp_gt_i32 s[44:45], -16, v6
    v_cmp_gt_i32 s[46:47], -15, v6
    v_cmp_gt_i32 s[48:49], -14, v6
    v_cmp_gt_i32 s[50:51], -13, v6
    s_nop 1
    v_cndmask_b32 v20, v9, v5, s[44:45]
    v_cndmask_b32 v21, v9, v5, s[46:47]
    v_cndmask_b32 v22, v9, v5, s[48:49]
    v_cndmask_b32 v23, v9, v5, s[50:51]
    v_cmp_gt_i32 s[52:53], 0, v6
    v_cmp_gt_i32 s[54:55], 1, v6
    v_cmp_gt_i32 s[56:57], 2, v6
    v_cmp_gt_i32 s[58:59], 3, v6
    s_nop 1
    v_cndmask_b32 v16, v8, v5, s[52:53]
    v_cndmask_b32 v17, v8, v5, s[54:55]
    v_cndmask_b32 v18, v8, v5, s[56:57]
    v_cndmask_b32 v19, v8, v5, s[58:59]
    v_cndmask_b32 v36, v9, v5, s[52:53]
    v_cndmask_b32 v37, v9, v5, s[54:55]
    v_cndmask_b32 v38, v9, v5, s[56:57]
    v_cndmask_b32 v39, v9, v5, s[58:59]
    v_cmp_gt_i32 s[44:45], 16, v6
    v_cmp_gt_i32 s[46:47], 17, v6
    v_cmp_gt_i32 s[48:49], 18, v6
    v_cmp_gt_i32 s[50:51], 19, v6
    s_nop 1
    v_cndmask_b32 v32, v8, v5, s[44:45]
    v_cndmask_b32 v33, v8, v5, s[46:47]
    v_cndmask_b32 v34, v8, v5, s[48:49]
    v_cndmask_b32 v35, v8, v5, s[50:51]
    s_nop 1
k2_noprep_13:
    v_mfma_f32_16x16x32_bf16 v[128:131], a[128:131], v[64:67], v[16:19]
    ds_read_b128 a[192:195], v3 offset:0
    v_add_f32 v49, v49, v63
    v_cvt_pk_bf16_f32 v215, v62, v63
    v_mfma_f32_16x16x32_bf16 v[132:135], a[128:131], v[80:83], v[20:23]
    v_exp_f32 v58, v170
    v_mfma_f32_16x16x32_bf16 v[136:139], a[128:131], v[96:99], v[24:27]
    ds_read_b128 a[196:199], v3 offset:1024
    v_exp_f32 v59, v171
    v_add_f32 v50, v56, v57
    v_mfma_f32_16x16x32_bf16 v[140:143], a[128:131], v[112:115], v[28:31]
    v_cvt_pk_bf16_f32 v216, v56, v57
    v_mfma_f32_16x16x32_bf16 v[128:131], a[132:135], v[68:71], v[128:131]
    ds_read_b128 a[200:203], v3 offset:2048
    v_exp_f32 v60, v184
    v_mfma_f32_16x16x32_bf16 v[132:135], a[132:135], v[84:87], v[132:135]
    v_exp_f32 v61, v185
    v_add_f32 v50, v50, v58
    v_mfma_f32_16x16x32_bf16 v[136:139], a[132:135], v[100:103], v[136:139]
    ds_read_b128 a[204:207], v3 offset:3072
    v_add_f32 v50, v50, v59
    v_mfma_f32_16x16x32_bf16 v[140:143], a[132:135], v[116:119], v[140:143]
    v_cvt_pk_bf16_f32 v217, v58, v59
    v_exp_f32 v62, v186
    v_mfma_f32_16x16x32_bf16 v[128:131], a[136:139], v[72:75], v[128:131]
    ds_read_b128 a[208:211], v3 offset:4096
    v_exp_f32 v63, v187
    v_mfma_f32_16x16x32_bf16 v[132:135], a[136:139], v[88:91], v[132:135]
    v_add_f32 v50, v50, v60
    v_mfma_f32_16x16x32_bf16 v[136:139], a[136:139], v[104:107], v[136:139]
    v_add_f32 v50, v50, v61
    v_cvt_pk_bf16_f32 v218, v60, v61
    v_mfma_f32_16x16x32_bf16 v[140:143], a[136:139], v[120:123], v[140:143]
    ds_read_b128 a[212:215], v3 offset:5120
    v_exp_f32 v56, v172
    v_mfma_f32_16x16x32_bf16 v[128:131], a[140:143], v[76:79], v[128:131]
    v_exp_f32 v57, v173
    v_add_f32 v50, v50, v62
    v_mfma_f32_16x16x32_bf16 v[132:135], a[140:143], v[92:95], v[132:135]
    ds_read_b128 a[216:219], v3 offset:6144
    v_add_f32 v50, v50, v63
    v_mfma_f32_16x16x32_bf16 v[136:139], a[140:143], v[108:111], v[136:139]
    v_cvt_pk_bf16_f32 v219, v62, v63
    v_mfma_f32_16x16x32_bf16 v[140:143], a[140:143], v[124:127], v[140:143]
    ds_read_b128 a[220:223], v3 offset:7168
    v_exp_f32 v58, v174
    v_exp_f32 v59, v175
    v_mfma_f32_16x16x32_bf16 v[144:147], a[144:147], v[64:67], v[32:35]
    v_add_f32 v51, v56, v57
    v_mfma_f32_16x16x32_bf16 v[148:151], a[144:147], v[80:83], v[36:39]
    v_add_u32 v3, 8192, v3
    v_and_b32 v3, 0xffff, v3
    v_or_b32 v3, 0x10000, v3
    v_cvt_pk_bf16_f32 v220, v56, v57
    v_exp_f32 v60, v188
    v_mfma_f32_16x16x32_bf16 v[152:155], a[144:147], v[96:99], v[40:43]
    v_exp_f32 v61, v189
    v_mfma_f32_16x16x32_bf16 v[156:159], a[144:147], v[112:115], v[44:47]
    v_add_f32 v51, v51, v58
    v_mfma_f32_16x16x32_bf16 v[144:147], a[148:151], v[68:71], v[144:147]
    v_add_f32 v51, v51, v59
    v_cvt_pk_bf16_f32 v221, v58, v59
    v_mfma_f32_16x16x32_bf16 v[148:151], a[148:151], v[84:87], v[148:151]
    v_exp_f32 v62, v190
    v_mfma_f32_16x16x32_bf16 v[152:155], a[148:151], v[100:103], v[152:155]
    v_exp_f32 v63, v191
    v_add_f32 v51, v51, v60
    v_mfma_f32_16x16x32_bf16 v[156:159], a[148:151], v[116:119], v[156:159]
    v_add_f32 v51, v51, v61
    v_mfma_f32_16x16x32_bf16 v[144:147], a[152:155], v[72:75], v[144:147]
    v_cvt_pk_bf16_f32 v222, v60, v61
    v_mfma_f32_16x16x32_bf16 v[148:151], a[152:155], v[88:91], v[148:151]
    s_nop 0
    v_add_f32 v51, v51, v62
    v_mfma_f32_16x16x32_bf16 v[152:155], a[152:155], v[104:107], v[152:155]
    v_add_f32 v51, v51, v63
    v_mfma_f32_16x16x32_bf16 v[156:159], a[152:155], v[120:123], v[156:159]
    v_cvt_pk_bf16_f32 v223, v62, v63
    v_mfma_f32_16x16x32_bf16 v[144:147], a[156:159], v[76:79], v[144:147]
    v_mfma_f32_16x16x32_bf16 v[148:151], a[156:159], v[92:95], v[148:151]
    v_mfma_f32_16x16x32_bf16 v[152:155], a[156:159], v[108:111], v[152:155]
    v_mfma_f32_16x16x32_bf16 v[156:159], a[156:159], v[124:127], v[156:159]
    s_add_u32 s36, s36, 32
    v_max3_f32 v6, v48, v49, v50
    v_max_f32 v6, v6, v51
    v_cmp_nge_f32 vcc, s37, v6
    s_cbranch_vccnz k2_rare_14
k2_ret_15:
    v_add_f32 v12, v12, v48
    v_add_f32 v13, v13, v49
    v_add_f32 v14, v14, v50
    v_add_f32 v15, v15, v51
    s_waitcnt lgkmcnt(0)
    v_mfma_f32_16x16x32_bf16 a[0:3], a[192:195], v[208:211], a[0:3]
    ds_read_b128 a[128:131], v2 offset:0
    v_exp_f32 v56, v128
    v_exp_f32 v57, v129
    v_mfma_f32_16x16x32_bf16 a[4:7], a[192:195], v[212:215], a[4:7]
    v_exp_f32 v58, v130
    v_mfma_f32_16x16x32_bf16 a[8:11], a[192:195], v[216:219], a[8:11]
    ds_read_b128 a[132:135], v2 offset:1024
    v_exp_f32 v59, v131
    v_mfma_f32_16x16x32_bf16 a[12:15], a[192:195], v[220:223], a[12:15]
    v_add_f32 v48, v56, v57
    v_mfma_f32_16x16x32_bf16 a[16:19], a[196:199], v[208:211], a[16:19]
    ds_read_b128 a[136:139], v2 offset:2048
    v_cvt_pk_bf16_f32 v192, v56, v57
    v_mfma_f32_16x16x32_bf16 a[20:23], a[196:199], v[212:215], a[20:23]
    v_exp_f32 v60, v144
    v_exp_f32 v61, v145
    v_mfma_f32_16x16x32_bf16 a[24:27], a[196:199], v[216:219], a[24:27]
    ds_read_b128 a[140:143], v2 offset:3072
    v_add_f32 v48, v48, v58
    v_mfma_f32_16x16x32_bf16 a[28:31], a[196:199], v[220:223], a[28:31]
    v_add_f32 v48, v48, v59
    v_mfma_f32_16x16x32_bf16 a[32:35], a[200:203], v[208:211], a[32:35]
    ds_read_b128 a[144:147], v2 offset:4096
    v_cvt_pk_bf16_f32 v193, v58, v59
    v_mfma_f32_16x16x32_bf16 a[36:39], a[200:203], v[212:215], a[36:39]
    v_exp_f32 v62, v146
    v_mfma_f32_16x16x32_bf16 a[40:43], a[200:203], v[216:219], a[40:43]
    v_exp_f32 v63, v147
    v_add_f32 v48, v48, v60
    v_mfma_f32_16x16x32_bf16 a[44:47], a[200:203], v[220:223], a[44:47]
    ds_read_b128 a[148:151], v2 offset:5120
    v_add_f32 v48, v48, v61
    v_mfma_f32_16x16x32_bf16 a[48:51], a[204:207], v[208:211], a[48:51]
    v_cvt_pk_bf16_f32 v194, v60, v61
    v_mfma_f32_16x16x32_bf16 a[52:55], a[204:207], v[212:215], a[52:55]
    ds_read_b128 a[152:155], v2 offset:6144
    v_exp_f32 v56, v132
    v_mfma_f32_16x16x32_bf16 a[56:59], a[204:207], v[216:219], a[56:59]
    v_exp_f32 v57, v133
    v_mfma_f32_16x16x32_bf16 a[60:63], a[204:207], v[220:223], a[60:63]
    ds_read_b128 a[156:159], v2 offset:7168
    v_add_f32 v48, v48, v62
    v_mfma_f32_16x16x32_bf16 a[64:67], a[208:211], v[208:211], a[64:67]
    v_add_f32 v48, v48, v63
    v_cvt_pk_bf16_f32 v195, v62, v63
    v_mfma_f32_16x16x32_bf16 a[68:71], a[208:211], v[212:215], a[68:71]
    v_add_u32 v2, 8192, v2
    v_and_b32 v2, 0xffff, v2
    v_exp_f32 v58, v134
    v_mfma_f32_16x16x32_bf16 a[72:75], a[208:211], v[216:219], a[72:75]
    v_exp_f32 v59, v135
    v_mfma_f32_16x16x32_bf16 a[76:79], a[208:211], v[220:223], a[76:79]
    v_add_f32 v49, v56, v57
    v_mfma_f32_16x16x32_bf16 a[80:83], a[212:215], v[208:211], a[80:83]
    v_cvt_pk_bf16_f32 v196, v56, v57
    v_mfma_f32_16x16x32_bf16 a[84:87], a[212:215], v[212:215], a[84:87]
    v_exp_f32 v60, v148
    v_exp_f32 v61, v149
    v_mfma_f32_16x16x32_bf16 a[88:91], a[212:215], v[216:219], a[88:91]
    v_add_f32 v49, v49, v58
    v_mfma_f32_16x16x32_bf16 a[92:95], a[212:215], v[220:223], a[92:95]
    v_add_f32 v49, v49, v59
    v_mfma_f32_16x16x32_bf16 a[96:99], a[216:219], v[208:211], a[96:99]
    v_cvt_pk_bf16_f32 v197, v58, v59
    v_mfma_f32_16x16x32_bf16 a[100:103], a[216:219], v[212:215], a[100:103]
    v_exp_f32 v62, v150
    v_mfma_f32_16x16x32_bf16 a[104:107], a[216:219], v[216:219], a[104:107]
    v_exp_f32 v63, v151
    v_add_f32 v49, v49, v60
    v_mfma_f32_16x16x32_bf16 a[108:111], a[216:219], v[220:223], a[108:111]
    v_add_f32 v49, v49, v61
    v_mfma_f32_16x16x32_bf16 a[112:115], a[220:223], v[208:211], a[112:115]
    v_cvt_pk_bf16_f32 v198, v60, v61
    v_mfma_f32_16x16x32_bf16 a[116:119], a[220:223], v[212:215], a[116:119]
    v_exp_f32 v56, v136
    v_mfma_f32_16x16x32_bf16 a[120:123], a[220:223], v[216:219], a[120:123]
    v_exp_f32 v57, v137
    v_mfma_f32_16x16x32_bf16 a[124:127], a[220:223], v[220:223], a[124:127]
    v_add_f32 v49, v49, v62
    s_waitcnt vmcnt(16) lgkmcnt(0)
    s_barrier
    s_cmp_lt_u32 s36, s42
    s_cbranch_scc1 k2_noprep_16
    s_sub_u32 s40, s36, s38
    v_subrev_u32 v6, s40, v4
    v_cmp_gt_i32 s[44:45], -16, v6
    v_cmp_gt_i32 s[46:47], -15, v6
    v_cmp_gt_i32 s[48:49], -14, v6
    v_cmp_gt_i32 s[50:51], -13, v6
    s_nop 1
    v_cndmask_b32 v20, v9, v5, s[44:45]
    v_cndmask_b32 v21, v9, v5, s[46:47]
    v_cndmask_b32 v22, v9, v5, s[48:49]
    v_cndmask_b32 v23, v9, v5, s[50:51]
    v_cmp_gt_i32 s[52:53], 0, v6
    v_cmp_gt_i32 s[54:55], 1, v6
    v_cmp_gt_i32 s[56:57], 2, v6
    v_cmp_gt_i32 s[58:59], 3, v6
    s_nop 1
    v_cndmask_b32 v16, v8, v5, s[52:53]
    v_cndmask_b32 v17, v8, v5, s[54:55]
    v_cndmask_b32 v18, v8, v5, s[56:57]
    v_cndmask_b32 v19, v8, v5, s[58:59]
    v_cndmask_b32 v36, v9, v5, s[52:53]
    v_cndmask_b32 v37, v9, v5, s[54:55]
    v_cndmask_b32 v38, v9, v5, s[56:57]
    v_cndmask_b32 v39, v9, v5, s[58:59]
    v_cmp_gt_i32 s[44:45], 16, v6
    v_cmp_gt_i32 s[46:47], 17, v6
    v_cmp_gt_i32 s[48:49], 18, v6
    v_cmp_gt_i32 s[50:51], 19, v6
    s_nop 1
    v_cndmask_b32 v32, v8, v5, s[44:45]
    v_cndmask_b32 v33, v8, v5, s[46:47]
    v_cndmask_b32 v34, v8, v5, s[48:49]
    v_cndmask_b32 v35, v8, v5, s[50:51]
    s_nop 1
k2_noprep_16:
    v_mfma_f32_16x16x32_bf16 v[160:163], a[128:131], v[64:67], v[16:19]
    ds_read_b128 a[192:195], v3 offset:0
    v_add_f32 v49, v49, v63
    v_cvt_pk_bf16_f32 v199, v62, v63
    v_mfma_f32_16x16x32_bf16 v[164:167], a[128:131], v[80:83], v[20:23]
    v_exp_f32 v58, v138
    v_mfma_f32_16x16x32_bf16 v[168:171], a[128:131], v[96:99], v[24:27]
    ds_read_b128 a[196:199], v3 offset:1024
    v_exp_f32 v59, v139
    v_add_f32 v50, v56, v57
    v_mfma_f32_16x16x32_bf16 v[172:175], a[128:131], v[112:115], v[28:31]
    v_cvt_pk_bf16_f32 v200, v56, v57
    v_mfma_f32_16x16x32_bf16 v[160:163], a[132:135], v[68:71], v[160:163]
    ds_read_b128 a[200:203], v3 offset:2048
    v_exp_f32 v60, v152
    s_mov_b32 m0, s34
    s_nop 0
    buffer_load_dwordx4 v1, s[16:19], s32 offen offset:0 lds
    v_mfma_f32_16x16x32_bf16 v[164:167], a[132:135], v[84:87], v[164:167]
    v_exp_f32 v61, v153
    v_add_f32 v50, v50, v58
    v_mfma_f32_16x16x32_bf16 v[168:171], a[132:135], v[100:103], v[168:171]
    ds_read_b128 a[204:207], v3 offset:3072
    v_add_f32 v50, v50, v59
    buffer_load_dwordx4 v1, s[16:19], s32 offen offset:1024 lds
    v_mfma_f32_16x16x32_bf16 v[172:175], a[132:135], v[116:119], v[172:175]
    v_cvt_pk_bf16_f32 v201, v58, v59
    v_exp_f32 v62, v154
    v_mfma_f32_16x16x32_bf16 v[160:163], a[136:139], v[72:75], v[160:163]
    ds_read_b128 a[208:211], v3 offset:4096
    v_exp_f32 v63, v155
    v_mfma_f32_16x16x32_bf16 v[164:167], a[136:139], v[88:91], v[164:167]
    v_add_f32 v50, v50, v60
    buffer_load_dwordx4 v1, s[16:19], s32 offen offset:2048 lds
    v_mfma_f32_16x16x32_bf16 v[168:171], a[136:139], v[104:107], v[168:171]
    v_add_f32 v50, v50, v61
    v_cvt_pk_bf16_f32 v202, v60, v61
    v_mfma_f32_16x16x32_bf16 v[172:175], a[136:139], v[120:123], v[172:175]
    ds_read_b128 a[212:215], v3 offset:5120
    v_exp_f32 v56, v140
    v_mfma_f32_16x16x32_bf16 v[160:163], a[140:143], v[76:79], v[160:163]
    v_exp_f32 v57, v141
    v_add_f32 v50, v50, v62
    buffer_load_dwordx4 v1, s[16:19], s32 offen offset:3072 lds
    v_mfma_f32_16x16x32_bf16 v[164:167], a[140:143], v[92:95], v[164:167]
    ds_read_b128 a[216:219], v3 offset:6144
    v_add_f32 v50, v50, v63
    v_mfma_f32_16x16x32_bf16 v[168:171], a[140:143], v[108:111], v[168:171]
    v_cvt_pk_bf16_f32 v203, v62, v63
    v_mfma_f32_16x16x32_bf16 v[172:175], a[140:143], v[124:127], v[172:175]
    ds_read_b128 a[220:223], v3 offset:7168
    v_exp_f32 v58, v142
    v_exp_f32 v59, v143
    s_mov_b32 m0, s35
    s_nop 0
    buffer_load_dwordx4 v1, s[20:23], s33 offen offset:0 lds
    v_mfma_f32_16x16x32_bf16 v[176:179], a[144:147], v[64:67], v[32:35]
    v_add_f32 v51, v56, v57
    v_mfma_f32_16x16x32_bf16 v[180:183], a[144:147], v[80:83], v[36:39]
    v_add_u32 v3, 8192, v3
    v_and_b32 v3, 0xffff, v3
    v_or_b32 v3, 0x10000, v3
    v_cvt_pk_bf16_f32 v204, v56, v57
    v_exp_f32 v60, v156
    v_mfma_f32_16x16x32_bf16 v[184:187], a[144:147], v[96:99], v[40:43]
    v_exp_f32 v61, v157
    buffer_load_dwordx4 v1, s[20:23], s33 offen offset:1024 lds
    v_mfma_f32_16x16x32_bf16 v[188:191], a[144:147], v[112:115], v[44:47]
    v_add_f32 v51, v51, v58
    v_mfma_f32_16x16x32_bf16 v[176:179], a[148:151], v[68:71], v[176:179]
    v_add_f32 v51, v51, v59
    v_cvt_pk_bf16_f32 v205, v58, v59
    v_mfma_f32_16x16x32_bf16 v[180:183], a[148:151], v[84:87], v[180:183]
    v_exp_f32 v62, v158
    buffer_load_dwordx4 v1, s[20:23], s33 offen offset:2048 lds
    v_mfma_f32_16x16x32_bf16 v[184:187], a[148:151], v[100:103], v[184:187]
    v_exp_f32 v63, v159
    v_add_f32 v51, v51, v60
    v_mfma_f32_16x16x32_bf16 v[188:191], a[148:151], v[116:119], v[188:191]
    v_add_f32 v51, v51, v61
    v_mfma_f32_16x16x32_bf16 v[176:179], a[152:155], v[72:75], v[176:179]
    v_cvt_pk_bf16_f32 v206, v60, v61
    buffer_load_dwordx4 v1, s[20:23], s33 offen offset:3072 lds
    v_mfma_f32_16x16x32_bf16 v[180:183], a[152:155], v[88:91], v[180:183]
    s_nop 0
    v_add_f32 v51, v51, v62
    v_mfma_f32_16x16x32_bf16 v[184:187], a[152:155], v[104:107], v[184:187]
    v_add_f32 v51, v51, v63
    v_mfma_f32_16x16x32_bf16 v[188:191], a[152:155], v[120:123], v[188:191]
    v_cvt_pk_bf16_f32 v207, v62, v63
    s_add_u32 s32, s32, 0x80000
    s_add_u32 s33, s33, 0x80000
    s_add_u32 s34, s34, 0x4000
    s_and_b32 s34, s34, 0xffff
    s_add_u32 s35, s35, 0x4000
    s_and_b32 s35, s35, 0xffff
    s_or_b32 s35, s35, 0x10000
    v_mfma_f32_16x16x32_bf16 v[176:179], a[156:159], v[76:79], v[176:179]
    v_mfma_f32_16x16x32_bf16 v[180:183], a[156:159], v[92:95], v[180:183]
    v_mfma_f32_16x16x32_bf16 v[184:187], a[156:159], v[108:111], v[184:187]
    v_mfma_f32_16x16x32_bf16 v[188:191], a[156:159], v[124:127], v[188:191]
    s_add_u32 s36, s36, 32
    v_max3_f32 v6, v48, v49, v50
    v_max_f32 v6, v6, v51
    v_cmp_nge_f32 vcc, s37, v6
    s_cbranch_vccnz k2_rare_17
k2_ret_18:
    v_add_f32 v12, v12, v48
    v_add_f32 v13, v13, v49
    v_add_f32 v14, v14, v50
    v_add_f32 v15, v15, v51
    s_sub_u32 s63, s63, 1
    s_cmp_lg_u32 s63, 0
    s_cbranch_scc1 k2_dloop_12
    s_waitcnt lgkmcnt(0)
    v_mfma_f32_16x16x32_bf16 a[0:3], a[192:195], v[192:195], a[0:3]
    ds_read_b128 a[128:131], v2 offset:0
    v_exp_f32 v56, v160
    v_exp_f32 v57, v161
    v_mfma_f32_16x16x32_bf16 a[4:7], a[192:195], v[196:199], a[4:7]
    ds_read_b128 a[132:135], v2 offset:1024
    v_exp_f32 v58, v162
    v_mfma_f32_16x16x32_bf16 a[8:11], a[192:195], v[200:203], a[8:11]
    ds_read_b128 a[136:139], v2 offset:2048
    v_exp_f32 v59, v163
    v_mfma_f32_16x16x32_bf16 a[12:15], a[192:195], v[204:207], a[12:15]
    ds_read_b128 a[140:143], v2 offset:3072
    v_add_f32 v48, v56, v57
    v_mfma_f32_16x16x32_bf16 a[16:19], a[196:199], v[192:195], a[16:19]
    ds_read_b128 a[144:147], v2 offset:4096
    v_cvt_pk_bf16_f32 v208, v56, v57
    v_mfma_f32_16x16x32_bf16 a[20:23], a[196:199], v[196:199], a[20:23]
    ds_read_b128 a[148:151], v2 offset:5120
    v_exp_f32 v60, v176
    v_exp_f32 v61, v177
    v_mfma_f32_16x16x32_bf16 a[24:27], a[196:199], v[200:203], a[24:27]
    v_add_f32 v48, v48, v58
    v_mfma_f32_16x16x32_bf16 a[28:31], a[196:199], v[204:207], a[28:31]
    ds_read_b128 a[152:155], v2 offset:6144
    v_add_f32 v48, v48, v59
    v_mfma_f32_16x16x32_bf16 a[32:35], a[200:203], v[192:195], a[32:35]
    ds_read_b128 a[156:159], v2 offset:7168
    v_cvt_pk_bf16_f32 v209, v58, v59
    v_mfma_f32_16x16x32_bf16 a[36:39], a[200:203], v[196:199], a[36:39]
    ds_read_b128 a[160:163], v2 offset:8192
    v_exp_f32 v62, v178
    v_mfma_f32_16x16x32_bf16 a[40:43], a[200:203], v[200:203], a[40:43]
    ds_read_b128 a[164:167], v2 offset:9216
    v_exp_f32 v63, v179
    v_add_f32 v48, v48, v60
    v_mfma_f32_16x16x32_bf16 a[44:47], a[200:203], v[204:207], a[44:47]
    ds_read_b128 a[168:171], v2 offset:10240
    v_add_f32 v48, v48, v61
    v_mfma_f32_16x16x32_bf16 a[48:51], a[204:207], v[192:195], a[48:51]
    ds_read_b128 a[172:175], v2 offset:11264
    v_cvt_pk_bf16_f32 v210, v60, v61
    v_mfma_f32_16x16x32_bf16 a[52:55], a[204:207], v[196:199], a[52:55]
    v_exp_f32 v56, v164
    v_mfma_f32_16x16x32_bf16 a[56:59], a[204:207], v[200:203], a[56:59]
    ds_read_b128 a[176:179], v2 offset:12288
    v_exp_f32 v57, v165
    v_mfma_f32_16x16x32_bf16 a[60:63], a[204:207], v[204:207], a[60:63]
    ds_read_b128 a[180:183], v2 offset:13312
    v_add_f32 v48, v48, v62
    v_mfma_f32_16x16x32_bf16 a[64:67], a[208:211], v[192:195], a[64:67]
    ds_read_b128 a[184:187], v2 offset:14336
    v_add_f32 v48, v48, v63
    v_cvt_pk_bf16_f32 v211, v62, v63
    v_mfma_f32_16x16x32_bf16 a[68:71], a[208:211], v[196:199], a[68:71]
    ds_read_b128 a[188:191], v2 offset:15360
    v_exp_f32 v58, v166
    v_mfma_f32_16x16x32_bf16 a[72:75], a[208:211], v[200:203], a[72:75]
    v_add_u32 v2, 16384, v2
    v_and_b32 v2, 0xffff, v2
    v_exp_f32 v59, v167
    v_mfma_f32_16x16x32_bf16 a[76:79], a[208:211], v[204:207], a[76:79]
    v_add_f32 v49, v56, v57
    v_mfma_f32_16x16x32_bf16 a[80:83], a[212:215], v[192:195], a[80:83]
    v_cvt_pk_bf16_f32 v212, v56, v57
    v_mfma_f32_16x16x32_bf16 a[84:87], a[212:215], v[196:199], a[84:87]
    v_exp_f32 v60, v180
    v_exp_f32 v61, v181
    v_mfma_f32_16x16x32_bf16 a[88:91], a[212:215], v[200:203], a[88:91]
    v_add_f32 v49, v49, v58
    v_mfma_f32_16x16x32_bf16 a[92:95], a[212:215], v[204:207], a[92:95]
    v_add_f32 v49, v49, v59
    v_mfma_f32_16x16x32_bf16 a[96:99], a[216:219], v[192:195], a[96:99]
    v_cvt_pk_bf16_f32 v213, v58, v59
    v_mfma_f32_16x16x32_bf16 a[100:103], a[216:219], v[196:199], a[100:103]
    v_exp_f32 v62, v182
    v_mfma_f32_16x16x32_bf16 a[104:107], a[216:219], v[200:203], a[104:107]
    v_exp_f32 v63, v183
    v_add_f32 v49, v49, v60
    v_mfma_f32_16x16x32_bf16 a[108:111], a[216:219], v[204:207], a[108:111]
    v_add_f32 v49, v49, v61
    v_mfma_f32_16x16x32_bf16 a[112:115], a[220:223], v[192:195], a[112:115]
    v_cvt_pk_bf16_f32 v214, v60, v61
    v_mfma_f32_16x16x32_bf16 a[116:119], a[220:223], v[196:199], a[116:119]
    v_exp_f32 v56, v168
    v_mfma_f32_16x16x32_bf16 a[120:123], a[220:223], v[200:203], a[120:123]
    v_exp_f32 v57, v169
    v_mfma_f32_16x16x32_bf16 a[124:127], a[220:223], v[204:207], a[124:127]
    v_add_f32 v49, v49, v62
    s_waitcnt lgkmcnt(0)
    s_sub_u32 s40, s36, s39
    v_subrev_u32 v6, s40, v4
    v_cmp_gt_i32 s[44:45], -16, v6
    v_cmp_gt_i32 s[46:47], -15, v6
    v_cmp_gt_i32 s[48:49], -14, v6
    v_cmp_gt_i32 s[50:51], -13, v6
    s_nop 1
    v_cndmask_b32 v20, v11, v5, s[44:45]
    v_cndmask_b32 v21, v11, v5, s[46:47]
    v_cndmask_b32 v22, v11, v5, s[48:49]
    v_cndmask_b32 v23, v11, v5, s[50:51]
    v_cmp_gt_i32 s[52:53], 0, v6
    v_cmp_gt_i32 s[54:55], 1, v6
    v_cmp_gt_i32 s[56:57], 2, v6
    v_cmp_gt_i32 s[58:59], 3, v6
    s_nop 1
    v_cndmask_b32 v16, v10, v5, s[52:53]
    v_cndmask_b32 v17, v10, v5, s[54:55]
    v_cndmask_b32 v18, v10, v5, s[56:57]
    v_cndmask_b32 v19, v10, v5, s[58:59]
    v_cndmask_b32 v36, v11, v5, s[52:53]
    v_cndmask_b32 v37, v11, v5, s[54:55]
    v_cndmask_b32 v38, v11, v5, s[56:57]
    v_cndmask_b32 v39, v11, v5, s[58:59]
    v_cmp_gt_i32 s[44:45], 16, v6
    v_cmp_gt_i32 s[46:47], 17, v6
    v_cmp_gt_i32 s[48:49], 18, v6
    v_cmp_gt_i32 s[50:51], 19, v6
    s_nop 1
    v_cndmask_b32 v32, v10, v5, s[44:45]
    v_cndmask_b32 v33, v10, v5, s[46:47]
    v_cndmask_b32 v34, v10, v5, s[48:49]
    v_cndmask_b32 v35, v10, v5, s[50:51]
    v_cndmask_b32 v28, v11, v5, s[44:45]
    v_cndmask_b32 v29, v11, v5, s[46:47]
    v_cndmask_b32 v30, v11, v5, s[48:49]
    v_cndmask_b32 v31, v11, v5, s[50:51]
    v_cmp_gt_i32 s[52:53], 32, v6
    v_cmp_gt_i32 s[54:55], 33, v6
    v_cmp_gt_i32 s[56:57], 34, v6
    v_cmp_gt_i32 s[58:59], 35, v6
    s_nop 1
    v_cndmask_b32 v24, v10, v5, s[52:53]
    v_cndmask_b32 v25, v10, v5, s[54:55]
    v_cndmask_b32 v26, v10, v5, s[56:57]
    v_cndmask_b32 v27, v10, v5, s[58:59]
    v_cndmask_b32 v44, v11, v5, s[52:53]
    v_cndmask_b32 v45, v11, v5, s[54:55]
    v_cndmask_b32 v46, v11, v5, s[56:57]
    v_cndmask_b32 v47, v11, v5, s[58:59]
    v_cmp_gt_i32 s[44:45], 48, v6
    v_cmp_gt_i32 s[46:47], 49, v6
    v_cmp_gt_i32 s[48:49], 50, v6
    v_cmp_gt_i32 s[50:51], 51, v6
    s_nop 1
    v_cndmask_b32 v40, v10, v5, s[44:45]
    v_cndmask_b32 v41, v10, v5, s[46:47]
    v_cndmask_b32 v42, v10, v5, s[48:49]
    v_cndmask_b32 v43, v10, v5, s[50:51]
    s_nop 1
    v_mfma_f32_16x16x32_bf16 v[128:131], a[128:131], v[96:99], v[16:19]
    ds_read_b128 a[192:195], v3 offset:0
    v_add_f32 v49, v49, v63
    v_cvt_pk_bf16_f32 v215, v62, v63
    v_mfma_f32_16x16x32_bf16 v[132:135], a[128:131], v[112:115], v[20:23]
    v_exp_f32 v58, v170
    v_mfma_f32_16x16x32_bf16 v[128:131], a[132:135], v[100:103], v[128:131]
    ds_read_b128 a[196:199], v3 offset:1024
    v_exp_f32 v59, v171
    v_add_f32 v50, v56, v57
    v_mfma_f32_16x16x32_bf16 v[132:135], a[132:135], v[116:119], v[132:135]
    v_cvt_pk_bf16_f32 v216, v56, v57
    v_mfma_f32_16x16x32_bf16 v[128:131], a[136:139], v[104:107], v[128:131]
    ds_read_b128 a[200:203], v3 offset:2048
    v_exp_f32 v60, v184
    v_mfma_f32_16x16x32_bf16 v[132:135], a[136:139], v[120:123], v[132:135]
    v_exp_f32 v61, v185
    v_add_f32 v50, v50, v58
    v_mfma_f32_16x16x32_bf16 v[128:131], a[140:143], v[108:111], v[128:131]
    ds_read_b128 a[204:207], v3 offset:3072
    v_add_f32 v50, v50, v59
    v_mfma_f32_16x16x32_bf16 v[132:135], a[140:143], v[124:127], v[132:135]
    v_cvt_pk_bf16_f32 v217, v58, v59
    v_exp_f32 v62, v186
    v_mfma_f32_16x16x32_bf16 v[144:147], a[144:147], v[96:99], v[32:35]
    ds_read_b128 a[208:211], v3 offset:4096
    v_exp_f32 v63, v187
    v_mfma_f32_16x16x32_bf16 v[148:151], a[144:147], v[112:115], v[36:39]
    v_add_f32 v50, v50, v60
    v_mfma_f32_16x16x32_bf16 v[144:147], a[148:151], v[100:103], v[144:147]
    v_add_f32 v50, v50, v61
    v_cvt_pk_bf16_f32 v218, v60, v61
    v_mfma_f32_16x16x32_bf16 v[148:151], a[148:151], v[116:119], v[148:151]
    ds_read_b128 a[212:215], v3 offset:5120
    v_exp_f32 v56, v172
    v_mfma_f32_16x16x32_bf16 v[144:147], a[152:155], v[104:107], v[144:147]
    v_exp_f32 v57, v173
    v_add_f32 v50, v50, v62
    v_mfma_f32_16x16x32_bf16 v[148:151], a[152:155], v[120:123], v[148:151]
    ds_read_b128 a[216:219], v3 offset:6144
    v_add_f32 v50, v50, v63
    v_mfma_f32_16x16x32_bf16 v[144:147], a[156:159], v[108:111], v[144:147]
    v_cvt_pk_bf16_f32 v219, v62, v63
    v_mfma_f32_16x16x32_bf16 v[148:151], a[156:159], v[124:127], v[148:151]
    ds_read_b128 a[220:223], v3 offset:7168
    v_exp_f32 v58, v174
    v_exp_f32 v59, v175
    v_mfma_f32_16x16x32_bf16 v[136:139], a[160:163], v[96:99], v[24:27]
    v_add_f32 v51, v56, v57
    v_mfma_f32_16x16x32_bf16 v[140:143], a[160:163], v[112:115], v[28:31]
    v_add_u32 v3, 8192, v3
    v_and_b32 v3, 0xffff, v3
    v_or_b32 v3, 0x10000, v3
    v_cvt_pk_bf16_f32 v220, v56, v57
    v_exp_f32 v60, v188
    v_mfma_f32_16x16x32_bf16 v[136:139], a[164:167], v[100:103], v[136:139]
    v_exp_f32 v61, v189
    v_mfma_f32_16x16x32_bf16 v[140:143], a[164:167], v[116:119], v[140:143]
    v_add_f32 v51, v51, v58
    v_mfma_f32_16x16x32_bf16 v[136:139], a[168:171], v[104:107], v[136:139]
    v_add_f32 v51, v51, v59
    v_cvt_pk_bf16_f32 v221, v58, v59
    v_mfma_f32_16x16x32_bf16 v[140:143], a[168:171], v[120:123], v[140:143]
    v_exp_f32 v62, v190
    v_mfma_f32_16x16x32_bf16 v[136:139], a[172:175], v[108:111], v[136:139]
    v_exp_f32 v63, v191
    v_add_f32 v51, v51, v60
    v_mfma_f32_16x16x32_bf16 v[140:143], a[172:175], v[124:127], v[140:143]
    v_add_f32 v51, v51, v61
    v_mfma_f32_16x16x32_bf16 v[152:155], a[176:179], v[96:99], v[40:43]
    v_cvt_pk_bf16_f32 v222, v60, v61
    v_mfma_f32_16x16x32_bf16 v[156:159], a[176:179], v[112:115], v[44:47]
    s_nop 0
    v_add_f32 v51, v51, v62
    v_mfma_f32_16x16x32_bf16 v[152:155], a[180:183], v[100:103], v[152:155]
    v_add_f32 v51, v51, v63
    v_mfma_f32_16x16x32_bf16 v[156:159], a[180:183], v[116:119], v[156:159]
    v_cvt_pk_bf16_f32 v223, v62, v63
    v_mfma_f32_16x16x32_bf16 v[152:155], a[184:187], v[104:107], v[152:155]
    v_mfma_f32_16x16x32_bf16 v[156:159], a[184:187], v[120:123], v[156:159]
    v_mfma_f32_16x16x32_bf16 v[152:155], a[188:191], v[108:111], v[152:155]
    v_mfma_f32_16x16x32_bf16 v[156:159], a[188:191], v[124:127], v[156:159]
    s_add_u32 s36, s36, 64
    v_max3_f32 v6, v48, v49, v50
    v_max_f32 v6, v6, v51
    v_cmp_nge_f32 vcc, s37, v6
    s_cbranch_vccnz k2_rare_19
k2_ret_20:
    v_add_f32 v12, v12, v48
    v_add_f32 v13, v13, v49
    v_add_f32 v14, v14, v50
    v_add_f32 v15, v15, v51
    s_waitcnt vmcnt(16) lgkmcnt(0)
    s_barrier
    v_mfma_f32_16x16x32_bf16 a[0:3], a[192:195], v[208:211], a[0:3]
    ds_read_b128 a[128:131], v2 offset:0
    v_exp_f32 v56, v128
    v_exp_f32 v57, v129
    v_mfma_f32_16x16x32_bf16 a[4:7], a[192:195], v[212:215], a[4:7]
    ds_read_b128 a[132:135], v2 offset:1024
    v_exp_f32 v58, v130
    v_mfma_f32_16x16x32_bf16 a[8:11], a[192:195], v[216:219], a[8:11]
    ds_read_b128 a[136:139], v2 offset:2048
    v_exp_f32 v59, v131
    v_mfma_f32_16x16x32_bf16 a[12:15], a[192:195], v[220:223], a[12:15]
    ds_read_b128 a[140:143], v2 offset:3072
    v_add_f32 v48, v56, v57
    v_mfma_f32_16x16x32_bf16 a[16:19], a[196:199], v[208:211], a[16:19]
    ds_read_b128 a[144:147], v2 offset:4096
    v_cvt_pk_bf16_f32 v192, v56, v57
    s_mov_b32 m0, s34
    s_nop 0
    buffer_load_dwordx4 v1, s[16:19], s32 offen offset:0 lds
    v_mfma_f32_16x16x32_bf16 a[20:23], a[196:199], v[212:215], a[20:23]
    ds_read_b128 a[148:151], v2 offset:5120
    v_exp_f32 v60, v144
    v_exp_f32 v61, v145
    v_mfma_f32_16x16x32_bf16 a[24:27], a[196:199], v[216:219], a[24:27]
    v_add_f32 v48, v48, v58
    buffer_load_dwordx4 v1, s[16:19], s32 offen offset:1024 lds
    v_mfma_f32_16x16x32_bf16 a[28:31], a[196:199], v[220:223], a[28:31]
    ds_read_b128 a[152:155], v2 offset:6144
    v_add_f32 v48, v48, v59
    v_mfma_f32_16x16x32_bf16 a[32:35], a[200:203], v[208:211], a[32:35]
    ds_read_b128 a[156:159], v2 offset:7168
    v_cvt_pk_bf16_f32 v193, v58, v59
    v_mfma_f32_16x16x32_bf16 a[36:39], a[200:203], v[212:215], a[36:39]
    ds_read_b128 a[160:163], v2 offset:8192
    v_exp_f32 v62, v146
    buffer_load_dwordx4 v1, s[16:19], s32 offen offset:2048 lds
    v_mfma_f32_16x16x32_bf16 a[40:43], a[200:203], v[216:219], a[40:43]
    ds_read_b128 a[164:167], v2 offset:9216
    v_exp_f32 v63, v147
    v_add_f32 v48, v48, v60
    v_mfma_f32_16x16x32_bf16 a[44:47], a[200:203], v[220:223], a[44:47]
    ds_read_b128 a[168:171], v2 offset:10240
    v_add_f32 v48, v48, v61
    v_mfma_f32_16x16x32_bf16 a[48:51], a[204:207], v[208:211], a[48:51]
    ds_read_b128 a[172:175], v2 offset:11264
    v_cvt_pk_bf16_f32 v194, v60, v61
    buffer_load_dwordx4 v1, s[16:19], s32 offen offset:3072 lds
    v_mfma_f32_16x16x32_bf16 a[52:55], a[204:207], v[212:215], a[52:55]
    v_exp_f32 v56, v132
    v_mfma_f32_16x16x32_bf16 a[56:59], a[204:207], v[216:219], a[56:59]
    ds_read_b128 a[176:179], v2 offset:12288
    v_exp_f32 v57, v133
    v_mfma_f32_16x16x32_bf16 a[60:63], a[204:207], v[220:223], a[60:63]
    ds_read_b128 a[180:183], v2 offset:13312
    v_add_f32 v48, v48, v62
    s_mov_b32 m0, s35
    s_nop 0
    buffer_load_dwordx4 v1, s[20:23], s33 offen offset:0 lds
    v_mfma_f32_16x16x32_bf16 a[64:67], a[208:211], v[208:211], a[64:67]
    ds_read_b128 a[184:187], v2 offset:14336
    v_add_f32 v48, v48, v63
    v_cvt_pk_bf16_f32 v195, v62, v63
    v_mfma_f32_16x16x32_bf16 a[68:71], a[208:211], v[212:215], a[68:71]
    ds_read_b128 a[188:191], v2 offset:15360
    v_exp_f32 v58, v134
    v_mfma_f32_16x16x32_bf16 a[72:75], a[208:211], v[216:219], a[72:75]
    v_add_u32 v2, 16384, v2
    v_and_b32 v2, 0xffff, v2
    v_exp_f32 v59, v135
    buffer_load_dwordx4 v1, s[20:23], s33 offen offset:1024 lds
    v_mfma_f32_16x16x32_bf16 a[76:79], a[208:211], v[220:223], a[76:79]
    v_add_f32 v49, v56, v57
    v_mfma_f32_16x16x32_bf16 a[80:83], a[212:215], v[208:211], a[80:83]
    v_cvt_pk_bf16_f32 v196, v56, v57
    v_mfma_f32_16x16x32_bf16 a[84:87], a[212:215], v[212:215], a[84:87]
    v_exp_f32 v60, v148
    v_exp_f32 v61, v149
    buffer_load_dwordx4 v1, s[20:23], s33 offen offset:2048 lds
    v_mfma_f32_16x16x32_bf16 a[88:91], a[212:215], v[216:219], a[88:91]
    v_add_f32 v49, v49, v58
    v_mfma_f32_16x16x32_bf16 a[92:95], a[212:215], v[220:223], a[92:95]
    v_add_f32 v49, v49, v59
    v_mfma_f32_16x16x32_bf16 a[96:99], a[216:219], v[208:211], a[96:99]
    v_cvt_pk_bf16_f32 v197, v58, v59
    buffer_load_dwordx4 v1, s[20:23], s33 offen offset:3072 lds
    v_mfma_f32_16x16x32_bf16 a[100:103], a[216:219], v[212:215], a[100:103]
    v_exp_f32 v62, v150
    v_mfma_f32_16x16x32_bf16 a[104:107], a[216:219], v[216:219], a[104:107]
    v_exp_f32 v63, v151
    v_add_f32 v49, v49, v60
    v_mfma_f32_16x16x32_bf16 a[108:111], a[216:219], v[220:223], a[108:111]
    v_add_f32 v49, v49, v61
    s_add_u32 s32, s32, 0x80000
    s_add_u32 s33, s33, 0x80000
    s_add_u32 s34, s34, 0x4000
    s_and_b32 s34, s34, 0xffff
    s_add_u32 s35, s35, 0x4000
    s_and_b32 s35, s35, 0xffff
    s_or_b32 s35, s35, 0x10000
    v_mfma_f32_16x16x32_bf16 a[112:115], a[220:223], v[208:211], a[112:115]
    v_cvt_pk_bf16_f32 v198, v60, v61
    v_mfma_f32_16x16x32_bf16 a[116:119], a[220:223], v[212:215], a[116:119]
    v_exp_f32 v56, v136
    v_mfma_f32_16x16x32_bf16 a[120:123], a[220:223], v[216:219], a[120:123]
    v_exp_f32 v57, v137
    v_mfma_f32_16x16x32_bf16 a[124:127], a[220:223], v[220:223], a[124:127]
    v_add_f32 v49, v49, v62
    s_waitcnt lgkmcnt(0)
    s_cmp_lt_u32 s36, s43
    s_cbranch_scc1 k2_noprep_21
    s_sub_u32 s40, s36, s39
    v_subrev_u32 v6, s40, v4
    v_cmp_gt_i32 s[44:45], -16, v6
    v_cmp_gt_i32 s[46:47], -15, v6
    v_cmp_gt_i32 s[48:49], -14, v6
    v_cmp_gt_i32 s[50:51], -13, v6
    s_nop 1
    v_cndmask_b32 v20, v11, v5, s[44:45]
    v_cndmask_b32 v21, v11, v5, s[46:47]
    v_cndmask_b32 v22, v11, v5, s[48:49]
    v_cndmask_b32 v23, v11, v5, s[50:51]
    v_cmp_gt_i32 s[52:53], 0, v6
    v_cmp_gt_i32 s[54:55], 1, v6
    v_cmp_gt_i32 s[56:57], 2, v6
    v_cmp_gt_i32 s[58:59], 3, v6
    s_nop 1
    v_cndmask_b32 v16, v10, v5, s[52:53]
    v_cndmask_b32 v17, v10, v5, s[54:55]
    v_cndmask_b32 v18, v10, v5, s[56:57]
    v_cndmask_b32 v19, v10, v5, s[58:59]
    v_cndmask_b32 v36, v11, v5, s[52:53]
    v_cndmask_b32 v37, v11, v5, s[54:55]
    v_cndmask_b32 v38, v11, v5, s[56:57]
    v_cndmask_b32 v39, v11, v5, s[58:59]
    v_cmp_gt_i32 s[44:45], 16, v6
    v_cmp_gt_i32 s[46:47], 17, v6
    v_cmp_gt_i32 s[48:49], 18, v6
    v_cmp_gt_i32 s[50:51], 19, v6
    s_nop 1
    v_cndmask_b32 v32, v10, v5, s[44:45]
    v_cndmask_b32 v33, v10, v5, s[46:47]
    v_cndmask_b32 v34, v10, v5, s[48:49]
    v_cndmask_b32 v35, v10, v5, s[50:51]
    v_cndmask_b32 v28, v11, v5, s[44:45]
    v_cndmask_b32 v29, v11, v5, s[46:47]
    v_cndmask_b32 v30, v11, v5, s[48:49]
    v_cndmask_b32 v31, v11, v5, s[50:51]
    v_cmp_gt_i32 s[52:53], 32, v6
    v_cmp_gt_i32 s[54:55], 33, v6
    v_cmp_gt_i32 s[56:57], 34, v6
    v_cmp_gt_i32 s[58:59], 35, v6
    s_nop 1
    v_cndmask_b32 v24, v10, v5, s[52:53]
    v_cndmask_b32 v25, v10, v5, s[54:55]
    v_cndmask_b32 v26, v10, v5, s[56:57]
    v_cndmask_b32 v27, v10, v5, s[58:59]
    v_cndmask_b32 v44, v11, v5, s[52:53]
    v_cndmask_b32 v45, v11, v5, s[54:55]
    v_cndmask_b32 v46, v11, v5, s[56:57]
    v_cndmask_b32 v47, v11, v5, s[58:59]
    v_cmp_gt_i32 s[44:45], 48, v6
    v_cmp_gt_i32 s[46:47], 49, v6
    v_cmp_gt_i32 s[48:49], 50, v6
    v_cmp_gt_i32 s[50:51], 51, v6
    s_nop 1
    v_cndmask_b32 v40, v10, v5, s[44:45]
    v_cndmask_b32 v41, v10, v5, s[46:47]
    v_cndmask_b32 v42, v10, v5, s[48:49]
    v_cndmask_b32 v43, v10, v5, s[50:51]
    s_nop 1
k2_noprep_21:
    v_mfma_f32_16x16x32_bf16 v[160:163], a[128:131], v[96:99], v[16:19]
    ds_read_b128 a[192:195], v3 offset:0
    v_add_f32 v49, v49, v63
    v_cvt_pk_bf16_f32 v199, v62, v63
    v_mfma_f32_16x16x32_bf16 v[164:167], a[128:131], v[112:115], v[20:23]
    ds_read_b128 a[196:199], v3 offset:1024
    v_exp_f32 v58, v138
    v_mfma_f32_16x16x32_bf16 v[160:163], a[132:135], v[100:103], v[160:163]
    ds_read_b128 a[200:203], v3 offset:2048
    v_exp_f32 v59, v139
    v_add_f32 v50, v56, v57
    v_mfma_f32_16x16x32_bf16 v[164:167], a[132:135], v[116:119], v[164:167]
    ds_read_b128 a[204:207], v3 offset:3072
    v_cvt_pk_bf16_f32 v200, v56, v57
    v_mfma_f32_16x16x32_bf16 v[160:163], a[136:139], v[104:107], v[160:163]
    ds_read_b128 a[208:211], v3 offset:4096
    v_exp_f32 v60, v152
    v_mfma_f32_16x16x32_bf16 v[164:167], a[136:139], v[120:123], v[164:167]
    ds_read_b128 a[212:215], v3 offset:5120
    v_exp_f32 v61, v153
    v_add_f32 v50, v50, v58
    v_mfma_f32_16x16x32_bf16 v[160:163], a[140:143], v[108:111], v[160:163]
    v_add_f32 v50, v50, v59
    v_mfma_f32_16x16x32_bf16 v[164:167], a[140:143], v[124:127], v[164:167]
    ds_read_b128 a[216:219], v3 offset:6144
    v_cvt_pk_bf16_f32 v201, v58, v59
    v_exp_f32 v62, v154
    v_mfma_f32_16x16x32_bf16 v[176:179], a[144:147], v[96:99], v[32:35]
    ds_read_b128 a[220:223], v3 offset:7168
    v_exp_f32 v63, v155
    v_mfma_f32_16x16x32_bf16 v[180:183], a[144:147], v[112:115], v[36:39]
    ds_read_b128 a[224:227], v3 offset:8192
    v_add_f32 v50, v50, v60
    v_mfma_f32_16x16x32_bf16 v[176:179], a[148:151], v[100:103], v[176:179]
    ds_read_b128 a[228:231], v3 offset:9216
    v_add_f32 v50, v50, v61
    v_cvt_pk_bf16_f32 v202, v60, v61
    v_mfma_f32_16x16x32_bf16 v[180:183], a[148:151], v[116:119], v[180:183]
    ds_read_b128 a[232:235], v3 offset:10240
    v_exp_f32 v56, v140
    v_mfma_f32_16x16x32_bf16 v[176:179], a[152:155], v[104:107], v[176:179]
    ds_read_b128 a[236:239], v3 offset:11264
    v_exp_f32 v57, v141
    v_add_f32 v50, v50, v62
    v_mfma_f32_16x16x32_bf16 v[180:183], a[152:155], v[120:123], v[180:183]
    v_add_f32 v50, v50, v63
    v_mfma_f32_16x16x32_bf16 v[176:179], a[156:159], v[108:111], v[176:179]
    ds_read_b128 a[240:243], v3 offset:12288
    v_cvt_pk_bf16_f32 v203, v62, v63
    v_mfma_f32_16x16x32_bf16 v[180:183], a[156:159], v[124:127], v[180:183]
    ds_read_b128 a[244:247], v3 offset:13312
    v_exp_f32 v58, v142
    v_exp_f32 v59, v143
    v_mfma_f32_16x16x32_bf16 v[168:171], a[160:163], v[96:99], v[24:27]
    ds_read_b128 a[248:251], v3 offset:14336
    v_add_f32 v51, v56, v57
    v_mfma_f32_16x16x32_bf16 v[172:175], a[160:163], v[112:115], v[28:31]
    ds_read_b128 a[252:255], v3 offset:15360
    v_cvt_pk_bf16_f32 v204, v56, v57
    v_exp_f32 v60, v156
    v_mfma_f32_16x16x32_bf16 v[168:171], a[164:167], v[100:103], v[168:171]
    v_add_u32 v3, 16384, v3
    v_and_b32 v3, 0xffff, v3
    v_or_b32 v3, 0x10000, v3
    v_exp_f32 v61, v157
    v_mfma_f32_16x16x32_bf16 v[172:175], a[164:167], v[116:119], v[172:175]
    v_add_f32 v51, v51, v58
    v_mfma_f32_16x16x32_bf16 v[168:171], a[168:171], v[104:107], v[168:171]
    v_add_f32 v51, v51, v59
    v_cvt_pk_bf16_f32 v205, v58, v59
    v_mfma_f32_16x16x32_bf16 v[172:175], a[168:171], v[120:123], v[172:175]
    v_exp_f32 v62, v158
    v_mfma_f32_16x16x32_bf16 v[168:171], a[172:175], v[108:111], v[168:171]
    v_exp_f32 v63, v159
    v_add_f32 v51, v51, v60
    v_mfma_f32_16x16x32_bf16 v[172:175], a[172:175], v[124:127], v[172:175]
    v_add_f32 v51, v51, v61
    v_mfma_f32_16x16x32_bf16 v[184:187], a[176:179], v[96:99], v[40:43]
    v_cvt_pk_bf16_f32 v206, v60, v61
    v_mfma_f32_16x16x32_bf16 v[188:191], a[176:179], v[112:115], v[44:47]
    s_nop 0
    v_add_f32 v51, v51, v62
    v_mfma_f32_16x16x32_bf16 v[184:187], a[180:183], v[100:103], v[184:187]
    v_add_f32 v51, v51, v63
    v_mfma_f32_16x16x32_bf16 v[188:191], a[180:183], v[116:119], v[188:191]
    v_cvt_pk_bf16_f32 v207, v62, v63
    v_mfma_f32_16x16x32_bf16 v[184:187], a[184:187], v[104:107], v[184:187]
    v_mfma_f32_16x16x32_bf16 v[188:191], a[184:187], v[120:123], v[188:191]
    v_mfma_f32_16x16x32_bf16 v[184:187], a[188:191], v[108:111], v[184:187]
    v_mfma_f32_16x16x32_bf16 v[188:191], a[188:191], v[124:127], v[188:191]
    s_add_u32 s36, s36, 64
    v_max3_f32 v6, v48, v49, v50
    v_max_f32 v6, v6, v51
    v_cmp_nge_f32 vcc, s37, v6
    s_cbranch_vccnz k2_rare_22
k2_ret_23:
    v_add_f32 v14, v14, v48
    v_add_f32 v15, v15, v49
    v_add_f32 v14, v14, v50
    v_add_f32 v15, v15, v51
    s_lshl_b32 s63, s29, 1
    s_sub_u32 s63, 14, s63
    s_cmp_eq_u32 s63, 0
    s_cbranch_scc1 k2_sdone_25
k2_sloop_24:
    s_waitcnt vmcnt(16) lgkmcnt(0)
    s_barrier
    v_mfma_f32_16x16x32_bf16 a[8:11], a[192:195], v[192:195], a[8:11]
    ds_read_b128 a[128:131], v2 offset:0
    v_exp_f32 v56, v160
    v_exp_f32 v57, v161
    v_mfma_f32_16x16x32_bf16 a[12:15], a[192:195], v[196:199], a[12:15]
    ds_read_b128 a[132:135], v2 offset:1024
    v_exp_f32 v58, v162
    v_mfma_f32_16x16x32_bf16 a[24:27], a[196:199], v[192:195], a[24:27]
    ds_read_b128 a[136:139], v2 offset:2048
    v_exp_f32 v59, v163
    v_mfma_f32_16x16x32_bf16 a[28:31], a[196:199], v[196:199], a[28:31]
    ds_read_b128 a[140:143], v2 offset:3072
    v_add_f32 v48, v56, v57
    v_mfma_f32_16x16x32_bf16 a[40:43], a[200:203], v[192:195], a[40:43]
    ds_read_b128 a[144:147], v2 offset:4096
    v_cvt_pk_bf16_f32 v208, v56, v57
    s_mov_b32 m0, s34
    s_nop 0
    buffer_load_dwordx4 v1, s[16:19], s32 offen offset:0 lds
    v_mfma_f32_16x16x32_bf16 a[44:47], a[200:203], v[196:199], a[44:47]
    ds_read_b128 a[148:151], v2 offset:5120
    v_exp_f32 v60, v176
    v_exp_f32 v61, v177
    v_mfma_f32_16x16x32_bf16 a[56:59], a[204:207], v[192:195], a[56:59]
    v_add_f32 v48, v48, v58
    buffer_load_dwordx4 v1, s[16:19], s32 offen offset:1024 lds
    v_mfma_f32_16x16x32_bf16 a[60:63], a[204:207], v[196:199], a[60:63]
    ds_read_b128 a[152:155], v2 offset:6144
    v_add_f32 v48, v48, v59
    v_mfma_f32_16x16x32_bf16 a[72:75], a[208:211], v[192:195], a[72:75]
    ds_read_b128 a[156:159], v2 offset:7168
    v_cvt_pk_bf16_f32 v209, v58, v59
    v_mfma_f32_16x16x32_bf16 a[76:79], a[208:211], v[196:199], a[76:79]
    ds_read_b128 a[160:163], v2 offset:8192
    v_exp_f32 v62, v178
    buffer_load_dwordx4 v1, s[16:19], s32 offen offset:2048 lds
    v_mfma_f32_16x16x32_bf16 a[88:91], a[212:215], v[192:195], a[88:91]
    ds_read_b128 a[164:167], v2 offset:9216
    v_exp_f32 v63, v179
    v_add_f32 v48, v48, v60
    v_mfma_f32_16x16x32_bf16 a[92:95], a[212:215], v[196:199], a[92:95]
    ds_read_b128 a[168:171], v2 offset:10240
    v_add_f32 v48, v48, v61
    v_mfma_f32_16x16x32_bf16 a[104:107], a[216:219], v[192:195], a[104:107]
    ds_read_b128 a[172:175], v2 offset:11264
    v_cvt_pk_bf16_f32 v210, v60, v61
    buffer_load_dwordx4 v1, s[16:19], s32 offen offset:3072 lds
    v_mfma_f32_16x16x32_bf16 a[108:111], a[216:219], v[196:199], a[108:111]
    v_exp_f32 v56, v164
    v_mfma_f32_16x16x32_bf16 a[120:123], a[220:223], v[192:195], a[120:123]
    ds_read_b128 a[176:179], v2 offset:12288
    v_exp_f32 v57, v165
    v_mfma_f32_16x16x32_bf16 a[124:127], a[220:223], v[196:199], a[124:127]
    ds_read_b128 a[180:183], v2 offset:13312
    v_add_f32 v48, v48, v62
    s_mov_b32 m0, s35
    s_nop 0
    buffer_load_dwordx4 v1, s[20:23], s33 offen offset:0 lds
    v_mfma_f32_16x16x32_bf16 a[8:11], a[224:227], v[200:203], a[8:11]
    ds_read_b128 a[184:187], v2 offset:14336
    v_add_f32 v48, v48, v63
    v_cvt_pk_bf16_f32 v211, v62, v63
    v_mfma_f32_16x16x32_bf16 a[12:15], a[224:227], v[204:207], a[12:15]
    ds_read_b128 a[188:191], v2 offset:15360
    v_exp_f32 v58, v166
    v_mfma_f32_16x16x32_bf16 a[24:27], a[228:231], v[200:203], a[24:27]
    v_add_u32 v2, 16384, v2
    v_and_b32 v2, 0xffff, v2
    v_exp_f32 v59, v167
    buffer_load_dwordx4 v1, s[20:23], s33 offen offset:1024 lds
    v_mfma_f32_16x16x32_bf16 a[28:31], a[228:231], v[204:207], a[28:31]
    v_add_f32 v49, v56, v57
    v_mfma_f32_16x16x32_bf16 a[40:43], a[232:235], v[200:203], a[40:43]
    v_cvt_pk_bf16_f32 v212, v56, v57
    v_mfma_f32_16x16x32_bf16 a[44:47], a[232:235], v[204:207], a[44:47]
    v_exp_f32 v60, v180
    v_exp_f32 v61, v181
    buffer_load_dwordx4 v1, s[20:23], s33 offen offset:2048 lds
    v_mfma_f32_16x16x32_bf16 a[56:59], a[236:239], v[200:203], a[56:59]
    v_add_f32 v49, v49, v58
    v_mfma_f32_16x16x32_bf16 a[60:63], a[236:239], v[204:207], a[60:63]
    v_add_f32 v49, v49, v59
    v_mfma_f32_16x16x32_bf16 a[72:75], a[240:243], v[200:203], a[72:75]
    v_cvt_pk_bf16_f32 v213, v58, v59
    buffer_load_dwordx4 v1, s[20:23], s33 offen offset:3072 lds
    v_mfma_f32_16x16x32_bf16 a[76:79], a[240:243], v[204:207], a[76:79]
    v_exp_f32 v62, v182
    v_mfma_f32_16x16x32_bf16 a[88:91], a[244:247], v[200:203], a[88:91]
    v_exp_f32 v63, v183
    v_add_f32 v49, v49, v60
    v_mfma_f32_16x16x32_bf16 a[92:95], a[244:247], v[204:207], a[92:95]
    v_add_f32 v49, v49, v61
    s_add_u32 s32, s32, 0x80000
    s_add_u32 s33, s33, 0x80000
    s_add_u32 s34, s34, 0x4000
    s_and_b32 s34, s34, 0xffff
    s_add_u32 s35, s35, 0x4000
    s_and_b32 s35, s35, 0xffff
    s_or_b32 s35, s35, 0x10000
    v_mfma_f32_16x16x32_bf16 a[104:107], a[248:251], v[200:203], a[104:107]
    v_cvt_pk_bf16_f32 v214, v60, v61
    v_mfma_f32_16x16x32_bf16 a[108:111], a[248:251], v[204:207], a[108:111]
    v_exp_f32 v56, v168
    v_mfma_f32_16x16x32_bf16 a[120:123], a[252:255], v[200:203], a[120:123]
    v_exp_f32 v57, v169
    v_mfma_f32_16x16x32_bf16 a[124:127], a[252:255], v[204:207], a[124:127]
    v_add_f32 v49, v49, v62
    s_waitcnt lgkmcnt(0)
    s_cmp_lt_u32 s36, s43
    s_cbranch_scc1 k2_noprep_26
    s_sub_u32 s40, s36, s39
    v_subrev_u32 v6, s40, v4
    v_cmp_gt_i32 s[44:45], -16, v6
    v_cmp_gt_i32 s[46:47], -15, v6
    v_cmp_gt_i32 s[48:49], -14, v6
    v_cmp_gt_i32 s[50:51], -13, v6
    s_nop 1
    v_cndmask_b32 v20, v11, v5, s[44:45]
    v_cndmask_b32 v21, v11, v5, s[46:47]
    v_cndmask_b32 v22, v11, v5, s[48:49]
    v_cndmask_b32 v23, v11, v5, s[50:51]
    v_cmp_gt_i32 s[52:53], 0, v6
    v_cmp_gt_i32 s[54:55], 1, v6
    v_cmp_gt_i32 s[56:57], 2, v6
    v_cmp_gt_i32 s[58:59], 3, v6
    s_nop 1
    v_cndmask_b32 v16, v10, v5, s[52:53]
    v_cndmask_b32 v17, v10, v5, s[54:55]
    v_cndmask_b32 v18, v10, v5, s[56:57]
    v_cndmask_b32 v19, v10, v5, s[58:59]
    v_cndmask_b32 v36, v11, v5, s[52:53]
    v_cndmask_b32 v37, v11, v5, s[54:55]
    v_cndmask_b32 v38, v11, v5, s[56:57]
    v_cndmask_b32 v39, v11, v5, s[58:59]
    v_cmp_gt_i32 s[44:45], 16, v6
    v_cmp_gt_i32 s[46:47], 17, v6
    v_cmp_gt_i32 s[48:49], 18, v6
    v_cmp_gt_i32 s[50:51], 19, v6
    s_nop 1
    v_cndmask_b32 v32, v10, v5, s[44:45]
    v_cndmask_b32 v33, v10, v5, s[46:47]
    v_cndmask_b32 v34, v10, v5, s[48:49]
    v_cndmask_b32 v35, v10, v5, s[50:51]
    v_cndmask_b32 v28, v11, v5, s[44:45]
    v_cndmask_b32 v29, v11, v5, s[46:47]
    v_cndmask_b32 v30, v11, v5, s[48:49]
    v_cndmask_b32 v31, v11, v5, s[50:51]
    v_cmp_gt_i32 s[52:53], 32, v6
    v_cmp_gt_i32 s[54:55], 33, v6
    v_cmp_gt_i32 s[56:57], 34, v6
    v_cmp_gt_i32 s[58:59], 35, v6
    s_nop 1
    v_cndmask_b32 v24, v10, v5, s[52:53]
    v_cndmask_b32 v25, v10, v5, s[54:55]
    v_cndmask_b32 v26, v10, v5, s[56:57]
    v_cndmask_b32 v27, v10, v5, s[58:59]
    v_cndmask_b32 v44, v11, v5, s[52:53]
    v_cndmask_b32 v45, v11, v5, s[54:55]
    v_cndmask_b32 v46, v11, v5, s[56:57]
    v_cndmask_b32 v47, v11, v5, s[58:59]
    v_cmp_gt_i32 s[44:45], 48, v6
    v_cmp_gt_i32 s[46:47], 49, v6
    v_cmp_gt_i32 s[48:49], 50, v6
    v_cmp_gt_i32 s[50:51], 51, v6
    s_nop 1
    v_cndmask_b32 v40, v10, v5, s[44:45]
    v_cndmask_b32 v41, v10, v5, s[46:47]
    v_cndmask_b32 v42, v10, v5, s[48:49]
    v_cndmask_b32 v43, v10, v5, s[50:51]
    s_nop 1
k2_noprep_26:
    v_mfma_f32_16x16x32_bf16 v[128:131], a[128:131], v[96:99], v[16:19]
    ds_read_b128 a[192:195], v3 offset:0
    v_add_f32 v49, v49, v63
    v_cvt_pk_bf16_f32 v215, v62, v63
    v_mfma_f32_16x16x32_bf16 v[132:135], a[128:131], v[112:115], v[20:23]
    ds_read_b128 a[196:199], v3 offset:1024
    v_exp_f32 v58, v170
    v_mfma_f32_16x16x32_bf16 v[128:131], a[132:135], v[100:103], v[128:131]
    ds_read_b128 a[200:203], v3 offset:2048
    v_exp_f32 v59, v171
    v_add_f32 v50, v56, v57
    v_mfma_f32_16x16x32_bf16 v[132:135], a[132:135], v[116:119], v[132:135]
    ds_read_b128 a[204:207], v3 offset:3072
    v_cvt_pk_bf16_f32 v216, v56, v57
    v_mfma_f32_16x16x32_bf16 v[128:131], a[136:139], v[104:107], v[128:131]
    ds_read_b128 a[208:211], v3 offset:4096
    v_exp_f32 v60, v184
    v_mfma_f32_16x16x32_bf16 v[132:135], a[136:139], v[120:123], v[132:135]
    ds_read_b128 a[212:215], v3 offset:5120
    v_exp_f32 v61, v185
    v_add_f32 v50, v50, v58
    v_mfma_f32_16x16x32_bf16 v[128:131], a[140:143], v[108:111], v[128:131]
    v_add_f32 v50, v50, v59
    v_mfma_f32_16x16x32_bf16 v[132:135], a[140:143], v[124:127], v[132:135]
    ds_read_b128 a[216:219], v3 offset:6144
    v_cvt_pk_bf16_f32 v217, v58, v59
    v_exp_f32 v62, v186
    v_mfma_f32_16x16x32_bf16 v[144:147], a[144:147], v[96:99], v[32:35]
    ds_read_b128 a[220:223], v3 offset:7168
    v_exp_f32 v63, v187
    v_mfma_f32_16x16x32_bf16 v[148:151], a[144:147], v[112:115], v[36:39]
    ds_read_b128 a[224:227], v3 offset:8192
    v_add_f32 v50, v50, v60
    v_mfma_f32_16x16x32_bf16 v[144:147], a[148:151], v[100:103], v[144:147]
    ds_read_b128 a[228:231], v3 offset:9216
    v_add_f32 v50, v50, v61
    v_cvt_pk_bf16_f32 v218, v60, v61
    v_mfma_f32_16x16x32_bf16 v[148:151], a[148:151], v[116:119], v[148:151]
    ds_read_b128 a[232:235], v3 offset:10240
    v_exp_f32 v56, v172
    v_mfma_f32_16x16x32_bf16 v[144:147], a[152:155], v[104:107], v[144:147]
    ds_read_b128 a[236:239], v3 offset:11264
    v_exp_f32 v57, v173
    v_add_f32 v50, v50, v62
    v_mfma_f32_16x16x32_bf16 v[148:151], a[152:155], v[120:123], v[148:151]
    v_add_f32 v50, v50, v63
    v_mfma_f32_16x16x32_bf16 v[144:147], a[156:159], v[108:111], v[144:147]
    ds_read_b128 a[240:243], v3 offset:12288
    v_cvt_pk_bf16_f32 v219, v62, v63
    v_mfma_f32_16x16x32_bf16 v[148:151], a[156:159], v[124:127], v[148:151]
    ds_read_b128 a[244:247], v3 offset:13312
    v_exp_f32 v58, v174
    v_exp_f32 v59, v175
    v_mfma_f32_16x16x32_bf16 v[136:139], a[160:163], v[96:99], v[24:27]
    ds_read_b128 a[248:251], v3 offset:14336
    v_add_f32 v51, v56, v57
    v_mfma_f32_16x16x32_bf16 v[140:143], a[160:163], v[112:115], v[28:31]
    ds_read_b128 a[252:255], v3 offset:15360
    v_cvt_pk_bf16_f32 v220, v56, v57
    v_exp_f32 v60, v188
    v_mfma_f32_16x16x32_bf16 v[136:139], a[164:167], v[100:103], v[136:139]
    v_add_u32 v3, 16384, v3
    v_and_b32 v3, 0xffff, v3
    v_or_b32 v3, 0x10000, v3
    v_exp_f32 v61, v189
    v_mfma_f32_16x16x32_bf16 v[140:143], a[164:167], v[116:119], v[140:143]
    v_add_f32 v51, v51, v58
    v_mfma_f32_16x16x32_bf16 v[136:139], a[168:171], v[104:107], v[136:139]
    v_add_f32 v51, v51, v59
    v_cvt_pk_bf16_f32 v221, v58, v59
    v_mfma_f32_16x16x32_bf16 v[140:143], a[168:171], v[120:123], v[140:143]
    v_exp_f32 v62, v190
    v_mfma_f32_16x16x32_bf16 v[136:139], a[172:175], v[108:111], v[136:139]
    v_exp_f32 v63, v191
    v_add_f32 v51, v51, v60
    v_mfma_f32_16x16x32_bf16 v[140:143], a[172:175], v[124:127], v[140:143]
    v_add_f32 v51, v51, v61
    v_mfma_f32_16x16x32_bf16 v[152:155], a[176:179], v[96:99], v[40:43]
    v_cvt_pk_bf16_f32 v222, v60, v61
    v_mfma_f32_16x16x32_bf16 v[156:159], a[176:179], v[112:115], v[44:47]
    s_nop 0
    v_add_f32 v51, v51, v62
    v_mfma_f32_16x16x32_bf16 v[152:155], a[180:183], v[100:103], v[152:155]
    v_add_f32 v51, v51, v63
    v_mfma_f32_16x16x32_bf16 v[156:159], a[180:183], v[116:119], v[156:159]
    v_cvt_pk_bf16_f32 v223, v62, v63
    v_mfma_f32_16x16x32_bf16 v[152:155], a[184:187], v[104:107], v[152:155]
    v_mfma_f32_16x16x32_bf16 v[156:159], a[184:187], v[120:123], v[156:159]
    v_mfma_f32_16x16x32_bf16 v[152:155], a[188:191], v[108:111], v[152:155]
    v_mfma_f32_16x16x32_bf16 v[156:159], a[188:191], v[124:127], v[156:159]
    s_add_u32 s36, s36, 64
    v_max3_f32 v6, v48, v49, v50
    v_max_f32 v6, v6, v51
    v_cmp_nge_f32 vcc, s37, v6
    s_cbranch_vccnz k2_rare_27
k2_ret_28:
    v_add_f32 v14, v14, v48
    v_add_f32 v15, v15, v49
    v_add_f32 v14, v14, v50
    v_add_f32 v15, v15, v51
    s_waitcnt vmcnt(16) lgkmcnt(0)
    s_barrier
    v_mfma_f32_16x16x32_bf16 a[8:11], a[192:195], v[208:211], a[8:11]
    ds_read_b128 a[128:131], v2 offset:0
    v_exp_f32 v56, v128
    v_exp_f32 v57, v129
    v_mfma_f32_16x16x32_bf16 a[12:15], a[192:195], v[212:215], a[12:15]
    ds_read_b128 a[132:135], v2 offset:1024
    v_exp_f32 v58, v130
    v_mfma_f32_16x16x32_bf16 a[24:27], a[196:199], v[208:211], a[24:27]
    ds_read_b128 a[136:139], v2 offset:2048
    v_exp_f32 v59, v131
    v_mfma_f32_16x16x32_bf16 a[28:31], a[196:199], v[212:215], a[28:31]
    ds_read_b128 a[140:143], v2 offset:3072
    v_add_f32 v48, v56, v57
    v_mfma_f32_16x16x32_bf16 a[40:43], a[200:203], v[208:211], a[40:43]
    ds_read_b128 a[144:147], v2 offset:4096
    v_cvt_pk_bf16_f32 v192, v56, v57
    s_mov_b32 m0, s34
    s_nop 0
    buffer_load_dwordx4 v1, s[16:19], s32 offen offset:0 lds
    v_mfma_f32_16x16x32_bf16 a[44:47], a[200:203], v[212:215], a[44:47]
    ds_read_b128 a[148:151], v2 offset:5120
    v_exp_f32 v60, v144
    v_exp_f32 v61, v145
    v_mfma_f32_16x16x32_bf16 a[56:59], a[204:207], v[208:211], a[56:59]
    v_add_f32 v48, v48, v58
    buffer_load_dwordx4 v1, s[16:19], s32 offen offset:1024 lds
    v_mfma_f32_16x16x32_bf16 a[60:63], a[204:207], v[212:215], a[60:63]
    ds_read_b128 a[152:155], v2 offset:6144
    v_add_f32 v48, v48, v59
    v_mfma_f32_16x16x32_bf16 a[72:75], a[208:211], v[208:211], a[72:75]
    ds_read_b128 a[156:159], v2 offset:7168
    v_cvt_pk_bf16_f32 v193, v58, v59
    v_mfma_f32_16x16x32_bf16 a[76:79], a[208:211], v[212:215], a[76:79]
    ds_read_b128 a[160:163], v2 offset:8192
    v_exp_f32 v62, v146
    buffer_load_dwordx4 v1, s[16:19], s32 offen offset:2048 lds
    v_mfma_f32_16x16x32_bf16 a[88:91], a[212:215], v[208:211], a[88:91]
    ds_read_b128 a[164:167], v2 offset:9216
    v_exp_f32 v63, v147
    v_add_f32 v48, v48, v60
    v_mfma_f32_16x16x32_bf16 a[92:95], a[212:215], v[212:215], a[92:95]
    ds_read_b128 a[168:171], v2 offset:10240
    v_add_f32 v48, v48, v61
    v_mfma_f32_16x16x32_bf16 a[104:107], a[216:219], v[208:211], a[104:107]
    ds_read_b128 a[172:175], v2 offset:11264
    v_cvt_pk_bf16_f32 v194, v60, v61
    buffer_load_dwordx4 v1, s[16:19], s32 offen offset:3072 lds
    v_mfma_f32_16x16x32_bf16 a[108:111], a[216:219], v[212:215], a[108:111]
    v_exp_f32 v56, v132
    v_mfma_f32_16x16x32_bf16 a[120:123], a[220:223], v[208:211], a[120:123]
    ds_read_b128 a[176:179], v2 offset:12288
    v_exp_f32 v57, v133
    v_mfma_f32_16x16x32_bf16 a[124:127], a[220:223], v[212:215], a[124:127]
    ds_read_b128 a[180:183], v2 offset:13312
    v_add_f32 v48, v48, v62
    s_mov_b32 m0, s35
    s_nop 0
    buffer_load_dwordx4 v1, s[20:23], s33 offen offset:0 lds
    v_mfma_f32_16x16x32_bf16 a[8:11], a[224:227], v[216:219], a[8:11]
    ds_read_b128 a[184:187], v2 offset:14336
    v_add_f32 v48, v48, v63
    v_cvt_pk_bf16_f32 v195, v62, v63
    v_mfma_f32_16x16x32_bf16 a[12:15], a[224:227], v[220:223], a[12:15]
    ds_read_b128 a[188:191], v2 offset:15360
    v_exp_f32 v58, v134
    v_mfma_f32_16x16x32_bf16 a[24:27], a[228:231], v[216:219], a[24:27]
    v_add_u32 v2, 16384, v2
    v_and_b32 v2, 0xffff, v2
    v_exp_f32 v59, v135
    buffer_load_dwordx4 v1, s[20:23], s33 offen offset:1024 lds
    v_mfma_f32_16x16x32_bf16 a[28:31], a[228:231], v[220:223], a[28:31]
    v_add_f32 v49, v56, v57
    v_mfma_f32_16x16x32_bf16 a[40:43], a[232:235], v[216:219], a[40:43]
    v_cvt_pk_bf16_f32 v196, v56, v57
    v_mfma_f32_16x16x32_bf16 a[44:47], a[232:235], v[220:223], a[44:47]
    v_exp_f32 v60, v148
    v_exp_f32 v61, v149
    buffer_load_dwordx4 v1, s[20:23], s33 offen offset:2048 lds
    v_mfma_f32_16x16x32_bf16 a[56:59], a[236:239], v[216:219], a[56:59]
    v_add_f32 v49, v49, v58
    v_mfma_f32_16x16x32_bf16 a[60:63], a[236:239], v[220:223], a[60:63]
    v_add_f32 v49, v49, v59
    v_mfma_f32_16x16x32_bf16 a[72:75], a[240:243], v[216:219], a[72:75]
    v_cvt_pk_bf16_f32 v197, v58, v59
    buffer_load_dwordx4 v1, s[20:23], s33 offen offset:3072 lds
    v_mfma_f32_16x16x32_bf16 a[76:79], a[240:243], v[220:223], a[76:79]
    v_exp_f32 v62, v150
    v_mfma_f32_16x16x32_bf16 a[88:91], a[244:247], v[216:219], a[88:91]
    v_exp_f32 v63, v151
    v_add_f32 v49, v49, v60
    v_mfma_f32_16x16x32_bf16 a[92:95], a[244:247], v[220:223], a[92:95]
    v_add_f32 v49, v49, v61
    s_add_u32 s32, s32, 0x80000
    s_add_u32 s33, s33, 0x80000
    s_add_u32 s34, s34, 0x4000
    s_and_b32 s34, s34, 0xffff
    s_add_u32 s35, s35, 0x4000
    s_and_b32 s35, s35, 0xffff
    s_or_b32 s35, s35, 0x10000
    v_mfma_f32_16x16x32_bf16 a[104:107], a[248:251], v[216:219], a[104:107]
    v_cvt_pk_bf16_f32 v198, v60, v61
    v_mfma_f32_16x16x32_bf16 a[108:111], a[248:251], v[220:223], a[108:111]
    v_exp_f32 v56, v136
    v_mfma_f32_16x16x32_bf16 a[120:123], a[252:255], v[216:219], a[120:123]
    v_exp_f32 v57, v137
    v_mfma_f32_16x16x32_bf16 a[124:127], a[252:255], v[220:223], a[124:127]
    v_add_f32 v49, v49, v62
    s_waitcnt lgkmcnt(0)
    s_cmp_lt_u32 s36, s43
    s_cbranch_scc1 k2_noprep_29
    s_sub_u32 s40, s36, s39
    v_subrev_u32 v6, s40, v4
    v_cmp_gt_i32 s[44:45], -16, v6
    v_cmp_gt_i32 s[46:47], -15, v6
    v_cmp_gt_i32 s[48:49], -14, v6
    v_cmp_gt_i32 s[50:51], -13, v6
    s_nop 1
    v_cndmask_b32 v20, v11, v5, s[44:45]
    v_cndmask_b32 v21, v11, v5, s[46:47]
    v_cndmask_b32 v22, v11, v5, s[48:49]
    v_cndmask_b32 v23, v11, v5, s[50:51]
    v_cmp_gt_i32 s[52:53], 0, v6
    v_cmp_gt_i32 s[54:55], 1, v6
    v_cmp_gt_i32 s[56:57], 2, v6
    v_cmp_gt_i32 s[58:59], 3, v6
    s_nop 1
    v_cndmask_b32 v16, v10, v5, s[52:53]
    v_cndmask_b32 v17, v10, v5, s[54:55]
    v_cndmask_b32 v18, v10, v5, s[56:57]
    v_cndmask_b32 v19, v10, v5, s[58:59]
    v_cndmask_b32 v36, v11, v5, s[52:53]
    v_cndmask_b32 v37, v11, v5, s[54:55]
    v_cndmask_b32 v38, v11, v5, s[56:57]
    v_cndmask_b32 v39, v11, v5, s[58:59]
    v_cmp_gt_i32 s[44:45], 16, v6
    v_cmp_gt_i32 s[46:47], 17, v6
    v_cmp_gt_i32 s[48:49], 18, v6
    v_cmp_gt_i32 s[50:51], 19, v6
    s_nop 1
    v_cndmask_b32 v32, v10, v5, s[44:45]
    v_cndmask_b32 v33, v10, v5, s[46:47]
    v_cndmask_b32 v34, v10, v5, s[48:49]
    v_cndmask_b32 v35, v10, v5, s[50:51]
    v_cndmask_b32 v28, v11, v5, s[44:45]
    v_cndmask_b32 v29, v11, v5, s[46:47]
    v_cndmask_b32 v30, v11, v5, s[48:49]
    v_cndmask_b32 v31, v11, v5, s[50:51]
    v_cmp_gt_i32 s[52:53], 32, v6
    v_cmp_gt_i32 s[54:55], 33, v6
    v_cmp_gt_i32 s[56:57], 34, v6
    v_cmp_gt_i32 s[58:59], 35, v6
    s_nop 1
    v_cndmask_b32 v24, v10, v5, s[52:53]
    v_cndmask_b32 v25, v10, v5, s[54:55]
    v_cndmask_b32 v26, v10, v5, s[56:57]
    v_cndmask_b32 v27, v10, v5, s[58:59]
    v_cndmask_b32 v44, v11, v5, s[52:53]
    v_cndmask_b32 v45, v11, v5, s[54:55]
    v_cndmask_b32 v46, v11, v5, s[56:57]
    v_cndmask_b32 v47, v11, v5, s[58:59]
    v_cmp_gt_i32 s[44:45], 48, v6
    v_cmp_gt_i32 s[46:47], 49, v6
    v_cmp_gt_i32 s[48:49], 50, v6
    v_cmp_gt_i32 s[50:51], 51, v6
    s_nop 1
    v_cndmask_b32 v40, v10, v5, s[44:45]
    v_cndmask_b32 v41, v10, v5, s[46:47]
    v_cndmask_b32 v42, v10, v5, s[48:49]
    v_cndmask_b32 v43, v10, v5, s[50:51]
    s_nop 1
k2_noprep_29:
    v_mfma_f32_16x16x32_bf16 v[160:163], a[128:131], v[96:99], v[16:19]
    ds_read_b128 a[192:195], v3 offset:0
    v_add_f32 v49, v49, v63
    v_cvt_pk_bf16_f32 v199, v62, v63
    v_mfma_f32_16x16x32_bf16 v[164:167], a[128:131], v[112:115], v[20:23]
    ds_read_b128 a[196:199], v3 offset:1024
    v_exp_f32 v58, v138
    v_mfma_f32_16x16x32_bf16 v[160:163], a[132:135], v[100:103], v[160:163]
    ds_read_b128 a[200:203], v3 offset:2048
    v_exp_f32 v59, v139
    v_add_f32 v50, v56, v57
    v_mfma_f32_16x16x32_bf16 v[164:167], a[132:135], v[116:119], v[164:167]
    ds_read_b128 a[204:207], v3 offset:3072
    v_cvt_pk_bf16_f32 v200, v56, v57
    v_mfma_f32_16x16x32_bf16 v[160:163], a[136:139], v[104:107], v[160:163]
    ds_read_b128 a[208:211], v3 offset:4096
    v_exp_f32 v60, v152
    v_mfma_f32_16x16x32_bf16 v[164:167], a[136:139], v[120:123], v[164:167]
    ds_read_b128 a[212:215], v3 offset:5120
    v_exp_f32 v61, v153
    v_add_f32 v50, v50, v58
    v_mfma_f32_16x16x32_bf16 v[160:163], a[140:143], v[108:111], v[160:163]
    v_add_f32 v50, v50, v59
    v_mfma_f32_16x16x32_bf16 v[164:167], a[140:143], v[124:127], v[164:167]
    ds_read_b128 a[216:219], v3 offset:6144
    v_cvt_pk_bf16_f32 v201, v58, v59
    v_exp_f32 v62, v154
    v_mfma_f32_16x16x32_bf16 v[176:179], a[144:147], v[96:99], v[32:35]
    ds_read_b128 a[220:223], v3 offset:7168
    v_exp_f32 v63, v155
    v_mfma_f32_16x16x32_bf16 v[180:183], a[144:147], v[112:115], v[36:39]
    ds_read_b128 a[224:227], v3 offset:8192
    v_add_f32 v50, v50, v60
    v_mfma_f32_16x16x32_bf16 v[176:179], a[148:151], v[100:103], v[176:179]
    ds_read_b128 a[228:231], v3 offset:9216
    v_add_f32 v50, v50, v61
    v_cvt_pk_bf16_f32 v202, v60, v61
    v_mfma_f32_16x16x32_bf16 v[180:183], a[148:151], v[116:119], v[180:183]
    ds_read_b128 a[232:235], v3 offset:10240
    v_exp_f32 v56, v140
    v_mfma_f32_16x16x32_bf16 v[176:179], a[152:155], v[104:107], v[176:179]
    ds_read_b128 a[236:239], v3 offset:11264
    v_exp_f32 v57, v141
    v_add_f32 v50, v50, v62
    v_mfma_f32_16x16x32_bf16 v[180:183], a[152:155], v[120:123], v[180:183]
    v_add_f32 v50, v50, v63
    v_mfma_f32_16x16x32_bf16 v[176:179], a[156:159], v[108:111], v[176:179]
    ds_read_b128 a[240:243], v3 offset:12288
    v_cvt_pk_bf16_f32 v203, v62, v63
    v_mfma_f32_16x16x32_bf16 v[180:183], a[156:159], v[124:127], v[180:183]
    ds_read_b128 a[244:247], v3 offset:13312
    v_exp_f32 v58, v142
    v_exp_f32 v59, v143
    v_mfma_f32_16x16x32_bf16 v[168:171], a[160:163], v[96:99], v[24:27]
    ds_read_b128 a[248:251], v3 offset:14336
    v_add_f32 v51, v56, v57
    v_mfma_f32_16x16x32_bf16 v[172:175], a[160:163], v[112:115], v[28:31]
    ds_read_b128 a[252:255], v3 offset:15360
    v_cvt_pk_bf16_f32 v204, v56, v57
    v_exp_f32 v60, v156
    v_mfma_f32_16x16x32_bf16 v[168:171], a[164:167], v[100:103], v[168:171]
    v_add_u32 v3, 16384, v3
    v_and_b32 v3, 0xffff, v3
    v_or_b32 v3, 0x10000, v3
    v_exp_f32 v61, v157
    v_mfma_f32_16x16x32_bf16 v[172:175], a[164:167], v[116:119], v[172:175]
    v_add_f32 v51, v51, v58
    v_mfma_f32_16x16x32_bf16 v[168:171], a[168:171], v[104:107], v[168:171]
    v_add_f32 v51, v51, v59
    v_cvt_pk_bf16_f32 v205, v58, v59
    v_mfma_f32_16x16x32_bf16 v[172:175], a[168:171], v[120:123], v[172:175]
    v_exp_f32 v62, v158
    v_mfma_f32_16x16x32_bf16 v[168:171], a[172:175], v[108:111], v[168:171]
    v_exp_f32 v63, v159
    v_add_f32 v51, v51, v60
    v_mfma_f32_16x16x32_bf16 v[172:175], a[172:175], v[124:127], v[172:175]
    v_add_f32 v51, v51, v61
    v_mfma_f32_16x16x32_bf16 v[184:187], a[176:179], v[96:99], v[40:43]
    v_cvt_pk_bf16_f32 v206, v60, v61
    v_mfma_f32_16x16x32_bf16 v[188:191], a[176:179], v[112:115], v[44:47]
    s_nop 0
    v_add_f32 v51, v51, v62
    v_mfma_f32_16x16x32_bf16 v[184:187], a[180:183], v[100:103], v[184:187]
    v_add_f32 v51, v51, v63
    v_mfma_f32_16x16x32_bf16 v[188:191], a[180:183], v[116:119], v[188:191]
    v_cvt_pk_bf16_f32 v207, v62, v63
    v_mfma_f32_16x16x32_bf16 v[184:187], a[184:187], v[104:107], v[184:187]
    v_mfma_f32_16x16x32_bf16 v[188:191], a[184:187], v[120:123], v[188:191]
    v_mfma_f32_16x16x32_bf16 v[184:187], a[188:191], v[108:111], v[184:187]
    v_mfma_f32_16x16x32_bf16 v[188:191], a[188:191], v[124:127], v[188:191]
    s_add_u32 s36, s36, 64
    v_max3_f32 v6, v48, v49, v50
    v_max_f32 v6, v6, v51
    v_cmp_nge_f32 vcc, s37, v6
    s_cbranch_vccnz k2_rare_30
k2_ret_31:
    v_add_f32 v14, v14, v48
    v_add_f32 v15, v15, v49
    v_add_f32 v14, v14, v50
    v_add_f32 v15, v15, v51
    s_sub_u32 s63, s63, 1
    s_cmp_lg_u32 s63, 0
    s_cbranch_scc1 k2_sloop_24
k2_sdone_25:
    s_waitcnt vmcnt(16) lgkmcnt(0)
    s_barrier
    v_mfma_f32_16x16x32_bf16 a[8:11], a[192:195], v[192:195], a[8:11]
    v_exp_f32 v56, v160
    v_exp_f32 v57, v161
    v_exp_f32 v58, v162
    v_mfma_f32_16x16x32_bf16 a[12:15], a[192:195], v[196:199], a[12:15]
    v_exp_f32 v59, v163
    v_add_f32 v48, v56, v57
    v_mfma_f32_16x16x32_bf16 a[24:27], a[196:199], v[192:195], a[24:27]
    v_cvt_pk_bf16_f32 v208, v56, v57
    v_exp_f32 v60, v176
    v_exp_f32 v61, v177
    v_mfma_f32_16x16x32_bf16 a[28:31], a[196:199], v[196:199], a[28:31]
    v_add_f32 v48, v48, v58
    v_add_f32 v48, v48, v59
    v_mfma_f32_16x16x32_bf16 a[40:43], a[200:203], v[192:195], a[40:43]
    v_cvt_pk_bf16_f32 v209, v58, v59
    v_exp_f32 v62, v178
    v_exp_f32 v63, v179
    s_mov_b32 m0, s34
    s_nop 0
    buffer_load_dwordx4 v1, s[16:19], s32 offen offset:0 lds
    v_mfma_f32_16x16x32_bf16 a[44:47], a[200:203], v[196:199], a[44:47]
    v_add_f32 v48, v48, v60
    v_add_f32 v48, v48, v61
    v_mfma_f32_16x16x32_bf16 a[56:59], a[204:207], v[192:195], a[56:59]
    v_cvt_pk_bf16_f32 v210, v60, v61
    v_exp_f32 v56, v164
    buffer_load_dwordx4 v1, s[16:19], s32 offen offset:1024 lds
    v_mfma_f32_16x16x32_bf16 a[60:63], a[204:207], v[196:199], a[60:63]
    v_exp_f32 v57, v165
    v_add_f32 v48, v48, v62
    v_add_f32 v48, v48, v63
    v_mfma_f32_16x16x32_bf16 a[72:75], a[208:211], v[192:195], a[72:75]
    v_cvt_pk_bf16_f32 v211, v62, v63
    v_exp_f32 v58, v166
    v_mfma_f32_16x16x32_bf16 a[76:79], a[208:211], v[196:199], a[76:79]
    v_exp_f32 v59, v167
    v_add_f32 v49, v56, v57
    v_cvt_pk_bf16_f32 v212, v56, v57
    buffer_load_dwordx4 v1, s[16:19], s32 offen offset:2048 lds
    v_mfma_f32_16x16x32_bf16 a[88:91], a[212:215], v[192:195], a[88:91]
    v_exp_f32 v60, v180
    v_exp_f32 v61, v181
    v_mfma_f32_16x16x32_bf16 a[92:95], a[212:215], v[196:199], a[92:95]
    v_add_f32 v49, v49, v58
    v_add_f32 v49, v49, v59
    v_mfma_f32_16x16x32_bf16 a[104:107], a[216:219], v[192:195], a[104:107]
    v_cvt_pk_bf16_f32 v213, v58, v59
    v_exp_f32 v62, v182
    v_exp_f32 v63, v183
    buffer_load_dwordx4 v1, s[16:19], s32 offen offset:3072 lds
    v_mfma_f32_16x16x32_bf16 a[108:111], a[216:219], v[196:199], a[108:111]
    v_add_f32 v49, v49, v60
    v_add_f32 v49, v49, v61
    v_mfma_f32_16x16x32_bf16 a[120:123], a[220:223], v[192:195], a[120:123]
    v_cvt_pk_bf16_f32 v214, v60, v61
    v_exp_f32 v56, v168
    v_exp_f32 v57, v169
    v_mfma_f32_16x16x32_bf16 a[124:127], a[220:223], v[196:199], a[124:127]
    v_add_f32 v49, v49, v62
    v_add_f32 v49, v49, v63
    s_mov_b32 m0, s35
    s_nop 0
    buffer_load_dwordx4 v1, s[20:23], s33 offen offset:0 lds
    v_mfma_f32_16x16x32_bf16 a[8:11], a[224:227], v[200:203], a[8:11]
    v_cvt_pk_bf16_f32 v215, v62, v63
    v_exp_f32 v58, v170
    v_mfma_f32_16x16x32_bf16 a[12:15], a[224:227], v[204:207], a[12:15]
    v_exp_f32 v59, v171
    v_add_f32 v50, v56, v57
    v_cvt_pk_bf16_f32 v216, v56, v57
    v_mfma_f32_16x16x32_bf16 a[24:27], a[228:231], v[200:203], a[24:27]
    v_exp_f32 v60, v184
    v_exp_f32 v61, v185
    buffer_load_dwordx4 v1, s[20:23], s33 offen offset:1024 lds
    v_mfma_f32_16x16x32_bf16 a[28:31], a[228:231], v[204:207], a[28:31]
    v_add_f32 v50, v50, v58
    v_add_f32 v50, v50, v59
    v_cvt_pk_bf16_f32 v217, v58, v59
    v_mfma_f32_16x16x32_bf16 a[40:43], a[232:235], v[200:203], a[40:43]
    v_exp_f32 v62, v186
    v_exp_f32 v63, v187
    v_mfma_f32_16x16x32_bf16 a[44:47], a[232:235], v[204:207], a[44:47]
    v_add_f32 v50, v50, v60
    v_add_f32 v50, v50, v61
    buffer_load_dwordx4 v1, s[20:23], s33 offen offset:2048 lds
    v_mfma_f32_16x16x32_bf16 a[56:59], a[236:239], v[200:203], a[56:59]
    v_cvt_pk_bf16_f32 v218, v60, v61
    v_exp_f32 v56, v172
    v_exp_f32 v57, v173
    v_mfma_f32_16x16x32_bf16 a[60:63], a[236:239], v[204:207], a[60:63]
    v_add_f32 v50, v50, v62
    v_add_f32 v50, v50, v63
    v_mfma_f32_16x16x32_bf16 a[72:75], a[240:243], v[200:203], a[72:75]
    v_cvt_pk_bf16_f32 v219, v62, v63
    v_exp_f32 v58, v174
    v_exp_f32 v59, v175
    buffer_load_dwordx4 v1, s[20:23], s33 offen offset:3072 lds
    v_mfma_f32_16x16x32_bf16 a[76:79], a[240:243], v[204:207], a[76:79]
    v_add_f32 v51, v56, v57
    v_cvt_pk_bf16_f32 v220, v56, v57
    v_mfma_f32_16x16x32_bf16 a[88:91], a[244:247], v[200:203], a[88:91]
    v_exp_f32 v60, v188
    v_exp_f32 v61, v189
    v_mfma_f32_16x16x32_bf16 a[92:95], a[244:247], v[204:207], a[92:95]
    v_add_f32 v51, v51, v58
    v_add_f32 v51, v51, v59
    v_cvt_pk_bf16_f32 v221, v58, v59
    s_add_u32 s32, s32, 0x80000
    s_add_u32 s33, s33, 0x80000
    s_add_u32 s34, s34, 0x4000
    s_and_b32 s34, s34, 0xffff
    s_add_u32 s35, s35, 0x4000
    s_and_b32 s35, s35, 0xffff
    s_or_b32 s35, s35, 0x10000
    v_mfma_f32_16x16x32_bf16 a[104:107], a[248:251], v[200:203], a[104:107]
    v_exp_f32 v62, v190
    v_exp_f32 v63, v191
    v_mfma_f32_16x16x32_bf16 a[108:111], a[248:251], v[204:207], a[108:111]
    v_add_f32 v51, v51, v60
    v_add_f32 v51, v51, v61
    v_cvt_pk_bf16_f32 v222, v60, v61
    v_mfma_f32_16x16x32_bf16 a[120:123], a[252:255], v[200:203], a[120:123]
    s_nop 0
    v_add_f32 v51, v51, v62
    v_mfma_f32_16x16x32_bf16 a[124:127], a[252:255], v[204:207], a[124:127]
    v_add_f32 v51, v51, v63
    v_cvt_pk_bf16_f32 v223, v62, v63
    ds_read_b128 a[192:195], v3 offset:0
    ds_read_b128 a[196:199], v3 offset:1024
    ds_read_b128 a[200:203], v3 offset:2048
    ds_read_b128 a[204:207], v3 offset:3072
    ds_read_b128 a[208:211], v3 offset:4096
    ds_read_b128 a[212:215], v3 offset:5120
    ds_read_b128 a[216:219], v3 offset:6144
    ds_read_b128 a[220:223], v3 offset:7168
    ds_read_b128 a[224:227], v3 offset:8192
    ds_read_b128 a[228:231], v3 offset:9216
    ds_read_b128 a[232:235], v3 offset:10240
    ds_read_b128 a[236:239], v3 offset:11264
    ds_read_b128 a[240:243], v3 offset:12288
    ds_read_b128 a[244:247], v3 offset:13312
    ds_read_b128 a[248:251], v3 offset:14336
    ds_read_b128 a[252:255], v3 offset:15360
    v_add_u32 v3, 16384, v3
    v_and_b32 v3, 0xffff, v3
    v_or_b32 v3, 0x10000, v3
    v_max3_f32 v6, v48, v49, v50
    v_max_f32 v6, v6, v51
    v_cmp_nge_f32 vcc, s37, v6
    s_cbranch_vccnz k2_rare_32
k2_ret_33:
    v_add_f32 v14, v14, v48
    v_add_f32 v15, v15, v49
    v_add_f32 v14, v14, v50
    v_add_f32 v15, v15, v51
    s_waitcnt lgkmcnt(0)
    v_mfma_f32_16x16x32_bf16 a[8:11], a[192:195], v[208:211], a[8:11]
    v_mfma_f32_16x16x32_bf16 a[12:15], a[192:195], v[212:215], a[12:15]
    v_mfma_f32_16x16x32_bf16 a[24:27], a[196:199], v[208:211], a[24:27]
    v_mfma_f32_16x16x32_bf16 a[28:31], a[196:199], v[212:215], a[28:31]
    v_mfma_f32_16x16x32_bf16 a[40:43], a[200:203], v[208:211], a[40:43]
    v_mfma_f32_16x16x32_bf16 a[44:47], a[200:203], v[212:215], a[44:47]
    v_mfma_f32_16x16x32_bf16 a[56:59], a[204:207], v[208:211], a[56:59]
    v_mfma_f32_16x16x32_bf16 a[60:63], a[204:207], v[212:215], a[60:63]
    v_mfma_f32_16x16x32_bf16 a[72:75], a[208:211], v[208:211], a[72:75]
    v_mfma_f32_16x16x32_bf16 a[76:79], a[208:211], v[212:215], a[76:79]
    v_mfma_f32_16x16x32_bf16 a[88:91], a[212:215], v[208:211], a[88:91]
    v_mfma_f32_16x16x32_bf16 a[92:95], a[212:215], v[212:215], a[92:95]
    v_mfma_f32_16x16x32_bf16 a[104:107], a[216:219], v[208:211], a[104:107]
    v_mfma_f32_16x16x32_bf16 a[108:111], a[216:219], v[212:215], a[108:111]
    v_mfma_f32_16x16x32_bf16 a[120:123], a[220:223], v[208:211], a[120:123]
    v_mfma_f32_16x16x32_bf16 a[124:127], a[220:223], v[212:215], a[124:127]
    v_mfma_f32_16x16x32_bf16 a[8:11], a[224:227], v[216:219], a[8:11]
    v_mfma_f32_16x16x32_bf16 a[12:15], a[224:227], v[220:223], a[12:15]
    v_mfma_f32_16x16x32_bf16 a[24:27], a[228:231], v[216:219], a[24:27]
    v_mfma_f32_16x16x32_bf16 a[28:31], a[228:231], v[220:223], a[28:31]
    v_mfma_f32_16x16x32_bf16 a[40:43], a[232:235], v[216:219], a[40:43]
    v_mfma_f32_16x16x32_bf16 a[44:47], a[232:235], v[220:223], a[44:47]
    v_mfma_f32_16x16x32_bf16 a[56:59], a[236:239], v[216:219], a[56:59]
    v_mfma_f32_16x16x32_bf16 a[60:63], a[236:239], v[220:223], a[60:63]
    v_mfma_f32_16x16x32_bf16 a[72:75], a[240:243], v[216:219], a[72:75]
    v_mfma_f32_16x16x32_bf16 a[76:79], a[240:243], v[220:223], a[76:79]
    v_mfma_f32_16x16x32_bf16 a[88:91], a[244:247], v[216:219], a[88:91]
    v_mfma_f32_16x16x32_bf16 a[92:95], a[244:247], v[220:223], a[92:95]
    v_mfma_f32_16x16x32_bf16 a[104:107], a[248:251], v[216:219], a[104:107]
    v_mfma_f32_16x16x32_bf16 a[108:111], a[248:251], v[220:223], a[108:111]
    v_mfma_f32_16x16x32_bf16 a[120:123], a[252:255], v[216:219], a[120:123]
    v_mfma_f32_16x16x32_bf16 a[124:127], a[252:255], v[220:223], a[124:127]
    v_mov_b32 v6, v12
    s_nop 1
    v_permlane16_swap_b32 v12, v6
    s_nop 1
    v_add_f32 v12, v12, v6
    v_mov_b32 v6, v12
    s_nop 1
    v_permlane32_swap_b32 v12, v6
    s_nop 1
    v_add_f32 v12, v12, v6
    v_rcp_f32 v12, v12
    v_mov_b32 v6, v13
    s_nop 1
    v_permlane16_swap_b32 v13, v6
    s_nop 1
    v_add_f32 v13, v13, v6
    v_mov_b32 v6, v13
    s_nop 1
    v_permlane32_swap_b32 v13, v6
    s_nop 1
    v_add_f32 v13, v13, v6
    v_rcp_f32 v13, v13
    v_mov_b32 v6, v14
    s_nop 1
    v_permlane16_swap_b32 v14, v6
    s_nop 1
    v_add_f32 v14, v14, v6
    v_mov_b32 v6, v14
    s_nop 1
    v_permlane32_swap_b32 v14, v6
    s_nop 1
    v_add_f32 v14, v14, v6
    v_rcp_f32 v14, v14
    v_mov_b32 v6, v15
    s_nop 1
    v_permlane16_swap_b32 v15, v6
    s_nop 1
    v_add_f32 v15, v15, v6
    v_mov_b32 v6, v15
    s_nop 1
    v_permlane32_swap_b32 v15, v6
    s_nop 1
    v_add_f32 v15, v15, v6
    v_rcp_f32 v15, v15
    s_lshl_b32 s31, s28, 19
    s_lshl_b32 s40, s38, 6
    s_add_u32 s40, s40, s31
    s_lshl_b32 s44, s39, 6
    s_add_u32 s44, s44, s31
    s_add_u32 s41, s40, 131072
    s_add_u32 s45, s44, 131072
    s_add_u32 s42, s40, 262144
    s_add_u32 s46, s44, 262144
    s_add_u32 s43, s40, 393216
    s_add_u32 s47, s44, 393216
    v_accvgpr_read_b32 v132, a0
    v_accvgpr_read_b32 v133, a1
    v_accvgpr_read_b32 v134, a2
    v_accvgpr_read_b32 v135, a3
    v_accvgpr_read_b32 v136, a16
    v_accvgpr_read_b32 v137, a17
    v_accvgpr_read_b32 v138, a18
    v_accvgpr_read_b32 v139, a19
    v_mul_f32 v132, v132, v12
    v_mul_f32 v133, v133, v12
    v_mul_f32 v134, v134, v12
    v_mul_f32 v135, v135, v12
    v_mul_f32 v136, v136, v12
    v_mul_f32 v137, v137, v12
    v_mul_f32 v138, v138, v12
    v_mul_f32 v139, v139, v12
    v_cvt_pk_bf16_f32 v128, v132, v133
    v_cvt_pk_bf16_f32 v129, v134, v135
    v_cvt_pk_bf16_f32 v130, v136, v137
    v_cvt_pk_bf16_f32 v131, v138, v139
    buffer_store_dwordx4 v[128:131], v1, s[24:27], s40 offen offset:0
    v_accvgpr_read_b32 v144, a32
    v_accvgpr_read_b32 v145, a33
    v_accvgpr_read_b32 v146, a34
    v_accvgpr_read_b32 v147, a35
    v_accvgpr_read_b32 v148, a48
    v_accvgpr_read_b32 v149, a49
    v_accvgpr_read_b32 v150, a50
    v_accvgpr_read_b32 v151, a51
    v_mul_f32 v144, v144, v12
    v_mul_f32 v145, v145, v12
    v_mul_f32 v146, v146, v12
    v_mul_f32 v147, v147, v12
    v_mul_f32 v148, v148, v12
    v_mul_f32 v149, v149, v12
    v_mul_f32 v150, v150, v12
    v_mul_f32 v151, v151, v12
    v_cvt_pk_bf16_f32 v140, v144, v145
    v_cvt_pk_bf16_f32 v141, v146, v147
    v_cvt_pk_bf16_f32 v142, v148, v149
    v_cvt_pk_bf16_f32 v143, v150, v151
    buffer_store_dwordx4 v[140:143], v1, s[24:27], s41 offen offset:0
    v_accvgpr_read_b32 v156, a64
    v_accvgpr_read_b32 v157, a65
    v_accvgpr_read_b32 v158, a66
    v_accvgpr_read_b32 v159, a67
    v_accvgpr_read_b32 v160, a80
    v_accvgpr_read_b32 v161, a81
    v_accvgpr_read_b32 v162, a82
    v_accvgpr_read_b32 v163, a83
    v_mul_f32 v156, v156, v12
    v_mul_f32 v157, v157, v12
    v_mul_f32 v158, v158, v12
    v_mul_f32 v159, v159, v12
    v_mul_f32 v160, v160, v12
    v_mul_f32 v161, v161, v12
    v_mul_f32 v162, v162, v12
    v_mul_f32 v163, v163, v12
    v_cvt_pk_bf16_f32 v152, v156, v157
    v_cvt_pk_bf16_f32 v153, v158, v159
    v_cvt_pk_bf16_f32 v154, v160, v161
    v_cvt_pk_bf16_f32 v155, v162, v163
    buffer_store_dwordx4 v[152:155], v1, s[24:27], s42 offen offset:0
    v_accvgpr_read_b32 v168, a96
    v_accvgpr_read_b32 v169, a97
    v_accvgpr_read_b32 v170, a98
    v_accvgpr_read_b32 v171, a99
    v_accvgpr_read_b32 v172, a112
    v_accvgpr_read_b32 v173, a113
    v_accvgpr_read_b32 v174, a114
    v_accvgpr_read_b32 v175, a115
    v_mul_f32 v168, v168, v12
    v_mul_f32 v169, v169, v12
    v_mul_f32 v170, v170, v12
    v_mul_f32 v171, v171, v12
    v_mul_f32 v172, v172, v12
    v_mul_f32 v173, v173, v12
    v_mul_f32 v174, v174, v12
    v_mul_f32 v175, v175, v12
    v_cvt_pk_bf16_f32 v164, v168, v169
    v_cvt_pk_bf16_f32 v165, v170, v171
    v_cvt_pk_bf16_f32 v166, v172, v173
    v_cvt_pk_bf16_f32 v167, v174, v175
    buffer_store_dwordx4 v[164:167], v1, s[24:27], s43 offen offset:0
    v_accvgpr_read_b32 v132, a4
    v_accvgpr_read_b32 v133, a5
    v_accvgpr_read_b32 v134, a6
    v_accvgpr_read_b32 v135, a7
    v_accvgpr_read_b32 v136, a20
    v_accvgpr_read_b32 v137, a21
    v_accvgpr_read_b32 v138, a22
    v_accvgpr_read_b32 v139, a23
    v_mul_f32 v132, v132, v13
    v_mul_f32 v133, v133, v13
    v_mul_f32 v134, v134, v13
    v_mul_f32 v135, v135, v13
    v_mul_f32 v136, v136, v13
    v_mul_f32 v137, v137, v13
    v_mul_f32 v138, v138, v13
    v_mul_f32 v139, v139, v13
    v_cvt_pk_bf16_f32 v128, v132, v133
    v_cvt_pk_bf16_f32 v129, v134, v135
    v_cvt_pk_bf16_f32 v130, v136, v137
    v_cvt_pk_bf16_f32 v131, v138, v139
    buffer_store_dwordx4 v[128:131], v1, s[24:27], s40 offen offset:1024
    v_accvgpr_read_b32 v144, a36
    v_accvgpr_read_b32 v145, a37
    v_accvgpr_read_b32 v146, a38
    v_accvgpr_read_b32 v147, a39
    v_accvgpr_read_b32 v148, a52
    v_accvgpr_read_b32 v149, a53
    v_accvgpr_read_b32 v150, a54
    v_accvgpr_read_b32 v151, a55
    v_mul_f32 v144, v144, v13
    v_mul_f32 v145, v145, v13
    v_mul_f32 v146, v146, v13
    v_mul_f32 v147, v147, v13
    v_mul_f32 v148, v148, v13
    v_mul_f32 v149, v149, v13
    v_mul_f32 v150, v150, v13
    v_mul_f32 v151, v151, v13
    v_cvt_pk_bf16_f32 v140, v144, v145
    v_cvt_pk_bf16_f32 v141, v146, v147
    v_cvt_pk_bf16_f32 v142, v148, v149
    v_cvt_pk_bf16_f32 v143, v150, v151
    buffer_store_dwordx4 v[140:143], v1, s[24:27], s41 offen offset:1024
    v_accvgpr_read_b32 v156, a68
    v_accvgpr_read_b32 v157, a69
    v_accvgpr_read_b32 v158, a70
    v_accvgpr_read_b32 v159, a71
    v_accvgpr_read_b32 v160, a84
    v_accvgpr_read_b32 v161, a85
    v_accvgpr_read_b32 v162, a86
    v_accvgpr_read_b32 v163, a87
    v_mul_f32 v156, v156, v13
    v_mul_f32 v157, v157, v13
    v_mul_f32 v158, v158, v13
    v_mul_f32 v159, v159, v13
    v_mul_f32 v160, v160, v13
    v_mul_f32 v161, v161, v13
    v_mul_f32 v162, v162, v13
    v_mul_f32 v163, v163, v13
    v_cvt_pk_bf16_f32 v152, v156, v157
    v_cvt_pk_bf16_f32 v153, v158, v159
    v_cvt_pk_bf16_f32 v154, v160, v161
    v_cvt_pk_bf16_f32 v155, v162, v163
    buffer_store_dwordx4 v[152:155], v1, s[24:27], s42 offen offset:1024
    v_accvgpr_read_b32 v168, a100
    v_accvgpr_read_b32 v169, a101
    v_accvgpr_read_b32 v170, a102
    v_accvgpr_read_b32 v171, a103
    v_accvgpr_read_b32 v172, a116
    v_accvgpr_read_b32 v173, a117
    v_accvgpr_read_b32 v174, a118
    v_accvgpr_read_b32 v175, a119
    v_mul_f32 v168, v168, v13
    v_mul_f32 v169, v169, v13
    v_mul_f32 v170, v170, v13
    v_mul_f32 v171, v171, v13
    v_mul_f32 v172, v172, v13
    v_mul_f32 v173, v173, v13
    v_mul_f32 v174, v174, v13
    v_mul_f32 v175, v175, v13
    v_cvt_pk_bf16_f32 v164, v168, v169
    v_cvt_pk_bf16_f32 v165, v170, v171
    v_cvt_pk_bf16_f32 v166, v172, v173
    v_cvt_pk_bf16_f32 v167, v174, v175
    buffer_store_dwordx4 v[164:167], v1, s[24:27], s43 offen offset:1024
    v_accvgpr_read_b32 v132, a8
    v_accvgpr_read_b32 v133, a9
    v_accvgpr_read_b32 v134, a10
    v_accvgpr_read_b32 v135, a11
    v_accvgpr_read_b32 v136, a24
    v_accvgpr_read_b32 v137, a25
    v_accvgpr_read_b32 v138, a26
    v_accvgpr_read_b32 v139, a27
    v_mul_f32 v132, v132, v14
    v_mul_f32 v133, v133, v14
    v_mul_f32 v134, v134, v14
    v_mul_f32 v135, v135, v14
    v_mul_f32 v136, v136, v14
    v_mul_f32 v137, v137, v14
    v_mul_f32 v138, v138, v14
    v_mul_f32 v139, v139, v14
    v_cvt_pk_bf16_f32 v128, v132, v133
    v_cvt_pk_bf16_f32 v129, v134, v135
    v_cvt_pk_bf16_f32 v130, v136, v137
    v_cvt_pk_bf16_f32 v131, v138, v139
    buffer_store_dwordx4 v[128:131], v1, s[24:27], s44 offen offset:0
    v_accvgpr_read_b32 v144, a40
    v_accvgpr_read_b32 v145, a41
    v_accvgpr_read_b32 v146, a42
    v_accvgpr_read_b32 v147, a43
    v_accvgpr_read_b32 v148, a56
    v_accvgpr_read_b32 v149, a57
    v_accvgpr_read_b32 v150, a58
    v_accvgpr_read_b32 v151, a59
    v_mul_f32 v144, v144, v14
    v_mul_f32 v145, v145, v14
    v_mul_f32 v146, v146, v14
    v_mul_f32 v147, v147, v14
    v_mul_f32 v148, v148, v14
    v_mul_f32 v149, v149, v14
    v_mul_f32 v150, v150, v14
    v_mul_f32 v151, v151, v14
    v_cvt_pk_bf16_f32 v140, v144, v145
    v_cvt_pk_bf16_f32 v141, v146, v147
    v_cvt_pk_bf16_f32 v142, v148, v149
    v_cvt_pk_bf16_f32 v143, v150, v151
    buffer_store_dwordx4 v[140:143], v1, s[24:27], s45 offen offset:0
    v_accvgpr_read_b32 v156, a72
    v_accvgpr_read_b32 v157, a73
    v_accvgpr_read_b32 v158, a74
    v_accvgpr_read_b32 v159, a75
    v_accvgpr_read_b32 v160, a88
    v_accvgpr_read_b32 v161, a89
    v_accvgpr_read_b32 v162, a90
    v_accvgpr_read_b32 v163, a91
    v_mul_f32 v156, v156, v14
    v_mul_f32 v157, v157, v14
    v_mul_f32 v158, v158, v14
    v_mul_f32 v159, v159, v14
    v_mul_f32 v160, v160, v14
    v_mul_f32 v161, v161, v14
    v_mul_f32 v162, v162, v14
    v_mul_f32 v163, v163, v14
    v_cvt_pk_bf16_f32 v152, v156, v157
    v_cvt_pk_bf16_f32 v153, v158, v159
    v_cvt_pk_bf16_f32 v154, v160, v161
    v_cvt_pk_bf16_f32 v155, v162, v163
    buffer_store_dwordx4 v[152:155], v1, s[24:27], s46 offen offset:0
    v_accvgpr_read_b32 v168, a104
    v_accvgpr_read_b32 v169, a105
    v_accvgpr_read_b32 v170, a106
    v_accvgpr_read_b32 v171, a107
    v_accvgpr_read_b32 v172, a120
    v_accvgpr_read_b32 v173, a121
    v_accvgpr_read_b32 v174, a122
    v_accvgpr_read_b32 v175, a123
    v_mul_f32 v168, v168, v14
    v_mul_f32 v169, v169, v14
    v_mul_f32 v170, v170, v14
    v_mul_f32 v171, v171, v14
    v_mul_f32 v172, v172, v14
    v_mul_f32 v173, v173, v14
    v_mul_f32 v174, v174, v14
    v_mul_f32 v175, v175, v14
    v_cvt_pk_bf16_f32 v164, v168, v169
    v_cvt_pk_bf16_f32 v165, v170, v171
    v_cvt_pk_bf16_f32 v166, v172, v173
    v_cvt_pk_bf16_f32 v167, v174, v175
    buffer_store_dwordx4 v[164:167], v1, s[24:27], s47 offen offset:0
    v_accvgpr_read_b32 v132, a12
    v_accvgpr_read_b32 v133, a13
    v_accvgpr_read_b32 v134, a14
    v_accvgpr_read_b32 v135, a15
    v_accvgpr_read_b32 v136, a28
    v_accvgpr_read_b32 v137, a29
    v_accvgpr_read_b32 v138, a30
    v_accvgpr_read_b32 v139, a31
    v_mul_f32 v132, v132, v15
    v_mul_f32 v133, v133, v15
    v_mul_f32 v134, v134, v15
    v_mul_f32 v135, v135, v15
    v_mul_f32 v136, v136, v15
    v_mul_f32 v137, v137, v15
    v_mul_f32 v138, v138, v15
    v_mul_f32 v139, v139, v15
    v_cvt_pk_bf16_f32 v128, v132, v133
    v_cvt_pk_bf16_f32 v129, v134, v135
    v_cvt_pk_bf16_f32 v130, v136, v137
    v_cvt_pk_bf16_f32 v131, v138, v139
    buffer_store_dwordx4 v[128:131], v1, s[24:27], s44 offen offset:1024
    v_accvgpr_read_b32 v144, a44
    v_accvgpr_read_b32 v145, a45
    v_accvgpr_read_b32 v146, a46
    v_accvgpr_read_b32 v147, a47
    v_accvgpr_read_b32 v148, a60
    v_accvgpr_read_b32 v149, a61
    v_accvgpr_read_b32 v150, a62
    v_accvgpr_read_b32 v151, a63
    v_mul_f32 v144, v144, v15
    v_mul_f32 v145, v145, v15
    v_mul_f32 v146, v146, v15
    v_mul_f32 v147, v147, v15
    v_mul_f32 v148, v148, v15
    v_mul_f32 v149, v149, v15
    v_mul_f32 v150, v150, v15
    v_mul_f32 v151, v151, v15
    v_cvt_pk_bf16_f32 v140, v144, v145
    v_cvt_pk_bf16_f32 v141, v146, v147
    v_cvt_pk_bf16_f32 v142, v148, v149
    v_cvt_pk_bf16_f32 v143, v150, v151
    buffer_store_dwordx4 v[140:143], v1, s[24:27], s45 offen offset:1024
    v_accvgpr_read_b32 v156, a76
    v_accvgpr_read_b32 v157, a77
    v_accvgpr_read_b32 v158, a78
    v_accvgpr_read_b32 v159, a79
    v_accvgpr_read_b32 v160, a92
    v_accvgpr_read_b32 v161, a93
    v_accvgpr_read_b32 v162, a94
    v_accvgpr_read_b32 v163, a95
    v_mul_f32 v156, v156, v15
    v_mul_f32 v157, v157, v15
    v_mul_f32 v158, v158, v15
    v_mul_f32 v159, v159, v15
    v_mul_f32 v160, v160, v15
    v_mul_f32 v161, v161, v15
    v_mul_f32 v162, v162, v15
    v_mul_f32 v163, v163, v15
    v_cvt_pk_bf16_f32 v152, v156, v157
    v_cvt_pk_bf16_f32 v153, v158, v159
    v_cvt_pk_bf16_f32 v154, v160, v161
    v_cvt_pk_bf16_f32 v155, v162, v163
    buffer_store_dwordx4 v[152:155], v1, s[24:27], s46 offen offset:1024
    v_accvgpr_read_b32 v168, a108
    v_accvgpr_read_b32 v169, a109
    v_accvgpr_read_b32 v170, a110
    v_accvgpr_read_b32 v171, a111
    v_accvgpr_read_b32 v172, a124
    v_accvgpr_read_b32 v173, a125
    v_accvgpr_read_b32 v174, a126
    v_accvgpr_read_b32 v175, a127
    v_mul_f32 v168, v168, v15
    v_mul_f32 v169, v169, v15
    v_mul_f32 v170, v170, v15
    v_mul_f32 v171, v171, v15
    v_mul_f32 v172, v172, v15
    v_mul_f32 v173, v173, v15
    v_mul_f32 v174, v174, v15
    v_mul_f32 v175, v175, v15
    v_cvt_pk_bf16_f32 v164, v168, v169
    v_cvt_pk_bf16_f32 v165, v170, v171
    v_cvt_pk_bf16_f32 v166, v172, v173
    v_cvt_pk_bf16_f32 v167, v174, v175
    buffer_store_dwordx4 v[164:167], v1, s[24:27], s47 offen offset:1024
k2_end_6:
    s_endpgm
k2_rare_10:
    s_nop 7
    v_max_f32 v52, v128, v129
    v_max3_f32 v52, v52, v130, v131
    v_max3_f32 v52, v52, v144, v145
    v_max3_f32 v52, v52, v146, v147
    v_mov_b32 v6, v52
    s_nop 1
    v_permlane16_swap_b32 v52, v6
    s_nop 1
    v_max_f32 v52, v52, v6
    v_mov_b32 v6, v52
    s_nop 1
    v_permlane32_swap_b32 v52, v6
    s_nop 1
    v_max_f32 v52, v52, v6
    v_max_f32 v52, 0, v52
    v_max_f32 v53, v132, v133
    v_max3_f32 v53, v53, v134, v135
    v_max3_f32 v53, v53, v148, v149
    v_max3_f32 v53, v53, v150, v151
    v_mov_b32 v6, v53
    s_nop 1
    v_permlane16_swap_b32 v53, v6
    s_nop 1
    v_max_f32 v53, v53, v6
    v_mov_b32 v6, v53
    s_nop 1
    v_permlane32_swap_b32 v53, v6
    s_nop 1
    v_max_f32 v53, v53, v6
    v_max_f32 v53, 0, v53
    v_max_f32 v54, v136, v137
    v_max3_f32 v54, v54, v138, v139
    v_max3_f32 v54, v54, v152, v153
    v_max3_f32 v54, v54, v154, v155
    v_mov_b32 v6, v54
    s_nop 1
    v_permlane16_swap_b32 v54, v6
    s_nop 1
    v_max_f32 v54, v54, v6
    v_mov_b32 v6, v54
    s_nop 1
    v_permlane32_swap_b32 v54, v6
    s_nop 1
    v_max_f32 v54, v54, v6
    v_max_f32 v54, 0, v54
    v_max_f32 v55, v140, v141
    v_max3_f32 v55, v55, v142, v143
    v_max3_f32 v55, v55, v156, v157
    v_max3_f32 v55, v55, v158, v159
    v_mov_b32 v6, v55
    s_nop 1
    v_permlane16_swap_b32 v55, v6
    s_nop 1
    v_max_f32 v55, v55, v6
    v_mov_b32 v6, v55
    s_nop 1
    v_permlane32_swap_b32 v55, v6
    s_nop 1
    v_max_f32 v55, v55, v6
    v_max_f32 v55, 0, v55
    v_sub_f32 v128, v128, v52
    v_sub_f32 v129, v129, v52
    v_sub_f32 v130, v130, v52
    v_sub_f32 v131, v131, v52
    v_sub_f32 v132, v132, v53
    v_sub_f32 v133, v133, v53
    v_sub_f32 v134, v134, v53
    v_sub_f32 v135, v135, v53
    v_sub_f32 v136, v136, v54
    v_sub_f32 v137, v137, v54
    v_sub_f32 v138, v138, v54
    v_sub_f32 v139, v139, v54
    v_sub_f32 v140, v140, v55
    v_sub_f32 v141, v141, v55
    v_sub_f32 v142, v142, v55
    v_sub_f32 v143, v143, v55
    v_sub_f32 v144, v144, v52
    v_sub_f32 v145, v145, v52
    v_sub_f32 v146, v146, v52
    v_sub_f32 v147, v147, v52
    v_sub_f32 v148, v148, v53
    v_sub_f32 v149, v149, v53
    v_sub_f32 v150, v150, v53
    v_sub_f32 v151, v151, v53
    v_sub_f32 v152, v152, v54
    v_sub_f32 v153, v153, v54
    v_sub_f32 v154, v154, v54
    v_sub_f32 v155, v155, v54
    v_sub_f32 v156, v156, v55
    v_sub_f32 v157, v157, v55
    v_sub_f32 v158, v158, v55
    v_sub_f32 v159, v159, v55
    v_sub_f32 v160, v160, v52
    v_sub_f32 v16, v16, v52
    v_sub_f32 v161, v161, v52
    v_sub_f32 v17, v17, v52
    v_sub_f32 v162, v162, v52
    v_sub_f32 v18, v18, v52
    v_sub_f32 v163, v163, v52
    v_sub_f32 v19, v19, v52
    v_sub_f32 v164, v164, v53
    v_sub_f32 v20, v20, v53
    v_sub_f32 v165, v165, v53
    v_sub_f32 v21, v21, v53
    v_sub_f32 v166, v166, v53
    v_sub_f32 v22, v22, v53
    v_sub_f32 v167, v167, v53
    v_sub_f32 v23, v23, v53
    v_sub_f32 v168, v168, v54
    v_sub_f32 v24, v24, v54
    v_sub_f32 v169, v169, v54
    v_sub_f32 v25, v25, v54
    v_sub_f32 v170, v170, v54
    v_sub_f32 v26, v26, v54
    v_sub_f32 v171, v171, v54
    v_sub_f32 v27, v27, v54
    v_sub_f32 v172, v172, v55
    v_sub_f32 v28, v28, v55
    v_sub_f32 v173, v173, v55
    v_sub_f32 v29, v29, v55
    v_sub_f32 v174, v174, v55
    v_sub_f32 v30, v30, v55
    v_sub_f32 v175, v175, v55
    v_sub_f32 v31, v31, v55
    v_sub_f32 v176, v176, v52
    v_sub_f32 v32, v32, v52
    v_sub_f32 v177, v177, v52
    v_sub_f32 v33, v33, v52
    v_sub_f32 v178, v178, v52
    v_sub_f32 v34, v34, v52
    v_sub_f32 v179, v179, v52
    v_sub_f32 v35, v35, v52
    v_sub_f32 v180, v180, v53
    v_sub_f32 v36, v36, v53
    v_sub_f32 v181, v181, v53
    v_sub_f32 v37, v37, v53
    v_sub_f32 v182, v182, v53
    v_sub_f32 v38, v38, v53
    v_sub_f32 v183, v183, v53
    v_sub_f32 v39, v39, v53
    v_sub_f32 v184, v184, v54
    v_sub_f32 v40, v40, v54
    v_sub_f32 v185, v185, v54
    v_sub_f32 v41, v41, v54
    v_sub_f32 v186, v186, v54
    v_sub_f32 v42, v42, v54
    v_sub_f32 v187, v187, v54
    v_sub_f32 v43, v43, v54
    v_sub_f32 v188, v188, v55
    v_sub_f32 v44, v44, v55
    v_sub_f32 v189, v189, v55
    v_sub_f32 v45, v45, v55
    v_sub_f32 v190, v190, v55
    v_sub_f32 v46, v46, v55
    v_sub_f32 v191, v191, v55
    v_sub_f32 v47, v47, v55
    v_sub_f32 v8, v8, v52
    v_exp_f32 v52, -v52
    v_sub_f32 v9, v9, v53
    v_exp_f32 v53, -v53
    v_sub_f32 v10, v10, v54
    v_exp_f32 v54, -v54
    v_sub_f32 v11, v11, v55
    v_exp_f32 v55, -v55
    s_nop 0
    v_mul_f32 v12, v12, v52
    v_mul_f32 v13, v13, v53
    v_mul_f32 v14, v14, v54
    v_mul_f32 v15, v15, v55
    v_accvgpr_read_b32 v224, a0
    v_accvgpr_read_b32 v225, a1
    v_accvgpr_read_b32 v226, a2
    v_accvgpr_read_b32 v227, a3
    v_mul_f32 v224, v224, v52
    v_mul_f32 v225, v225, v52
    v_mul_f32 v226, v226, v52
    v_mul_f32 v227, v227, v52
    v_accvgpr_write_b32 a0, v224
    v_accvgpr_write_b32 a1, v225
    v_accvgpr_write_b32 a2, v226
    v_accvgpr_write_b32 a3, v227
    v_accvgpr_read_b32 v224, a4
    v_accvgpr_read_b32 v225, a5
    v_accvgpr_read_b32 v226, a6
    v_accvgpr_read_b32 v227, a7
    v_mul_f32 v224, v224, v53
    v_mul_f32 v225, v225, v53
    v_mul_f32 v226, v226, v53
    v_mul_f32 v227, v227, v53
    v_accvgpr_write_b32 a4, v224
    v_accvgpr_write_b32 a5, v225
    v_accvgpr_write_b32 a6, v226
    v_accvgpr_write_b32 a7, v227
    v_accvgpr_read_b32 v224, a8
    v_accvgpr_read_b32 v225, a9
    v_accvgpr_read_b32 v226, a10
    v_accvgpr_read_b32 v227, a11
    v_mul_f32 v224, v224, v54
    v_mul_f32 v225, v225, v54
    v_mul_f32 v226, v226, v54
    v_mul_f32 v227, v227, v54
    v_accvgpr_write_b32 a8, v224
    v_accvgpr_write_b32 a9, v225
    v_accvgpr_write_b32 a10, v226
    v_accvgpr_write_b32 a11, v227
    v_accvgpr_read_b32 v224, a12
    v_accvgpr_read_b32 v225, a13
    v_accvgpr_read_b32 v226, a14
    v_accvgpr_read_b32 v227, a15
    v_mul_f32 v224, v224, v55
    v_mul_f32 v225, v225, v55
    v_mul_f32 v226, v226, v55
    v_mul_f32 v227, v227, v55
    v_accvgpr_write_b32 a12, v224
    v_accvgpr_write_b32 a13, v225
    v_accvgpr_write_b32 a14, v226
    v_accvgpr_write_b32 a15, v227
    v_accvgpr_read_b32 v224, a16
    v_accvgpr_read_b32 v225, a17
    v_accvgpr_read_b32 v226, a18
    v_accvgpr_read_b32 v227, a19
    v_mul_f32 v224, v224, v52
    v_mul_f32 v225, v225, v52
    v_mul_f32 v226, v226, v52
    v_mul_f32 v227, v227, v52
    v_accvgpr_write_b32 a16, v224
    v_accvgpr_write_b32 a17, v225
    v_accvgpr_write_b32 a18, v226
    v_accvgpr_write_b32 a19, v227
    v_accvgpr_read_b32 v224, a20
    v_accvgpr_read_b32 v225, a21
    v_accvgpr_read_b32 v226, a22
    v_accvgpr_read_b32 v227, a23
    v_mul_f32 v224, v224, v53
    v_mul_f32 v225, v225, v53
    v_mul_f32 v226, v226, v53
    v_mul_f32 v227, v227, v53
    v_accvgpr_write_b32 a20, v224
    v_accvgpr_write_b32 a21, v225
    v_accvgpr_write_b32 a22, v226
    v_accvgpr_write_b32 a23, v227
    v_accvgpr_read_b32 v224, a24
    v_accvgpr_read_b32 v225, a25
    v_accvgpr_read_b32 v226, a26
    v_accvgpr_read_b32 v227, a27
    v_mul_f32 v224, v224, v54
    v_mul_f32 v225, v225, v54
    v_mul_f32 v226, v226, v54
    v_mul_f32 v227, v227, v54
    v_accvgpr_write_b32 a24, v224
    v_accvgpr_write_b32 a25, v225
    v_accvgpr_write_b32 a26, v226
    v_accvgpr_write_b32 a27, v227
    v_accvgpr_read_b32 v224, a28
    v_accvgpr_read_b32 v225, a29
    v_accvgpr_read_b32 v226, a30
    v_accvgpr_read_b32 v227, a31
    v_mul_f32 v224, v224, v55
    v_mul_f32 v225, v225, v55
    v_mul_f32 v226, v226, v55
    v_mul_f32 v227, v227, v55
    v_accvgpr_write_b32 a28, v224
    v_accvgpr_write_b32 a29, v225
    v_accvgpr_write_b32 a30, v226
    v_accvgpr_write_b32 a31, v227
    v_accvgpr_read_b32 v224, a32
    v_accvgpr_read_b32 v225, a33
    v_accvgpr_read_b32 v226, a34
    v_accvgpr_read_b32 v227, a35
    v_mul_f32 v224, v224, v52
    v_mul_f32 v225, v225, v52
    v_mul_f32 v226, v226, v52
    v_mul_f32 v227, v227, v52
    v_accvgpr_write_b32 a32, v224
    v_accvgpr_write_b32 a33, v225
    v_accvgpr_write_b32 a34, v226
    v_accvgpr_write_b32 a35, v227
    v_accvgpr_read_b32 v224, a36
    v_accvgpr_read_b32 v225, a37
    v_accvgpr_read_b32 v226, a38
    v_accvgpr_read_b32 v227, a39
    v_mul_f32 v224, v224, v53
    v_mul_f32 v225, v225, v53
    v_mul_f32 v226, v226, v53
    v_mul_f32 v227, v227, v53
    v_accvgpr_write_b32 a36, v224
    v_accvgpr_write_b32 a37, v225
    v_accvgpr_write_b32 a38, v226
    v_accvgpr_write_b32 a39, v227
    v_accvgpr_read_b32 v224, a40
    v_accvgpr_read_b32 v225, a41
    v_accvgpr_read_b32 v226, a42
    v_accvgpr_read_b32 v227, a43
    v_mul_f32 v224, v224, v54
    v_mul_f32 v225, v225, v54
    v_mul_f32 v226, v226, v54
    v_mul_f32 v227, v227, v54
    v_accvgpr_write_b32 a40, v224
    v_accvgpr_write_b32 a41, v225
    v_accvgpr_write_b32 a42, v226
    v_accvgpr_write_b32 a43, v227
    v_accvgpr_read_b32 v224, a44
    v_accvgpr_read_b32 v225, a45
    v_accvgpr_read_b32 v226, a46
    v_accvgpr_read_b32 v227, a47
    v_mul_f32 v224, v224, v55
    v_mul_f32 v225, v225, v55
    v_mul_f32 v226, v226, v55
    v_mul_f32 v227, v227, v55
    v_accvgpr_write_b32 a44, v224
    v_accvgpr_write_b32 a45, v225
    v_accvgpr_write_b32 a46, v226
    v_accvgpr_write_b32 a47, v227
    v_accvgpr_read_b32 v224, a48
    v_accvgpr_read_b32 v225, a49
    v_accvgpr_read_b32 v226, a50
    v_accvgpr_read_b32 v227, a51
    v_mul_f32 v224, v224, v52
    v_mul_f32 v225, v225, v52
    v_mul_f32 v226, v226, v52
    v_mul_f32 v227, v227, v52
    v_accvgpr_write_b32 a48, v224
    v_accvgpr_write_b32 a49, v225
    v_accvgpr_write_b32 a50, v226
    v_accvgpr_write_b32 a51, v227
    v_accvgpr_read_b32 v224, a52
    v_accvgpr_read_b32 v225, a53
    v_accvgpr_read_b32 v226, a54
    v_accvgpr_read_b32 v227, a55
    v_mul_f32 v224, v224, v53
    v_mul_f32 v225, v225, v53
    v_mul_f32 v226, v226, v53
    v_mul_f32 v227, v227, v53
    v_accvgpr_write_b32 a52, v224
    v_accvgpr_write_b32 a53, v225
    v_accvgpr_write_b32 a54, v226
    v_accvgpr_write_b32 a55, v227
    v_accvgpr_read_b32 v224, a56
    v_accvgpr_read_b32 v225, a57
    v_accvgpr_read_b32 v226, a58
    v_accvgpr_read_b32 v227, a59
    v_mul_f32 v224, v224, v54
    v_mul_f32 v225, v225, v54
    v_mul_f32 v226, v226, v54
    v_mul_f32 v227, v227, v54
    v_accvgpr_write_b32 a56, v224
    v_accvgpr_write_b32 a57, v225
    v_accvgpr_write_b32 a58, v226
    v_accvgpr_write_b32 a59, v227
    v_accvgpr_read_b32 v224, a60
    v_accvgpr_read_b32 v225, a61
    v_accvgpr_read_b32 v226, a62
    v_accvgpr_read_b32 v227, a63
    v_mul_f32 v224, v224, v55
    v_mul_f32 v225, v225, v55
    v_mul_f32 v226, v226, v55
    v_mul_f32 v227, v227, v55
    v_accvgpr_write_b32 a60, v224
    v_accvgpr_write_b32 a61, v225
    v_accvgpr_write_b32 a62, v226
    v_accvgpr_write_b32 a63, v227
    v_accvgpr_read_b32 v224, a64
    v_accvgpr_read_b32 v225, a65
    v_accvgpr_read_b32 v226, a66
    v_accvgpr_read_b32 v227, a67
    v_mul_f32 v224, v224, v52
    v_mul_f32 v225, v225, v52
    v_mul_f32 v226, v226, v52
    v_mul_f32 v227, v227, v52
    v_accvgpr_write_b32 a64, v224
    v_accvgpr_write_b32 a65, v225
    v_accvgpr_write_b32 a66, v226
    v_accvgpr_write_b32 a67, v227
    v_accvgpr_read_b32 v224, a68
    v_accvgpr_read_b32 v225, a69
    v_accvgpr_read_b32 v226, a70
    v_accvgpr_read_b32 v227, a71
    v_mul_f32 v224, v224, v53
    v_mul_f32 v225, v225, v53
    v_mul_f32 v226, v226, v53
    v_mul_f32 v227, v227, v53
    v_accvgpr_write_b32 a68, v224
    v_accvgpr_write_b32 a69, v225
    v_accvgpr_write_b32 a70, v226
    v_accvgpr_write_b32 a71, v227
    v_accvgpr_read_b32 v224, a72
    v_accvgpr_read_b32 v225, a73
    v_accvgpr_read_b32 v226, a74
    v_accvgpr_read_b32 v227, a75
    v_mul_f32 v224, v224, v54
    v_mul_f32 v225, v225, v54
    v_mul_f32 v226, v226, v54
    v_mul_f32 v227, v227, v54
    v_accvgpr_write_b32 a72, v224
    v_accvgpr_write_b32 a73, v225
    v_accvgpr_write_b32 a74, v226
    v_accvgpr_write_b32 a75, v227
    v_accvgpr_read_b32 v224, a76
    v_accvgpr_read_b32 v225, a77
    v_accvgpr_read_b32 v226, a78
    v_accvgpr_read_b32 v227, a79
    v_mul_f32 v224, v224, v55
    v_mul_f32 v225, v225, v55
    v_mul_f32 v226, v226, v55
    v_mul_f32 v227, v227, v55
    v_accvgpr_write_b32 a76, v224
    v_accvgpr_write_b32 a77, v225
    v_accvgpr_write_b32 a78, v226
    v_accvgpr_write_b32 a79, v227
    v_accvgpr_read_b32 v224, a80
    v_accvgpr_read_b32 v225, a81
    v_accvgpr_read_b32 v226, a82
    v_accvgpr_read_b32 v227, a83
    v_mul_f32 v224, v224, v52
    v_mul_f32 v225, v225, v52
    v_mul_f32 v226, v226, v52
    v_mul_f32 v227, v227, v52
    v_accvgpr_write_b32 a80, v224
    v_accvgpr_write_b32 a81, v225
    v_accvgpr_write_b32 a82, v226
    v_accvgpr_write_b32 a83, v227
    v_accvgpr_read_b32 v224, a84
    v_accvgpr_read_b32 v225, a85
    v_accvgpr_read_b32 v226, a86
    v_accvgpr_read_b32 v227, a87
    v_mul_f32 v224, v224, v53
    v_mul_f32 v225, v225, v53
    v_mul_f32 v226, v226, v53
    v_mul_f32 v227, v227, v53
    v_accvgpr_write_b32 a84, v224
    v_accvgpr_write_b32 a85, v225
    v_accvgpr_write_b32 a86, v226
    v_accvgpr_write_b32 a87, v227
    v_accvgpr_read_b32 v224, a88
    v_accvgpr_read_b32 v225, a89
    v_accvgpr_read_b32 v226, a90
    v_accvgpr_read_b32 v227, a91
    v_mul_f32 v224, v224, v54
    v_mul_f32 v225, v225, v54
    v_mul_f32 v226, v226, v54
    v_mul_f32 v227, v227, v54
    v_accvgpr_write_b32 a88, v224
    v_accvgpr_write_b32 a89, v225
    v_accvgpr_write_b32 a90, v226
    v_accvgpr_write_b32 a91, v227
    v_accvgpr_read_b32 v224, a92
    v_accvgpr_read_b32 v225, a93
    v_accvgpr_read_b32 v226, a94
    v_accvgpr_read_b32 v227, a95
    v_mul_f32 v224, v224, v55
    v_mul_f32 v225, v225, v55
    v_mul_f32 v226, v226, v55
    v_mul_f32 v227, v227, v55
    v_accvgpr_write_b32 a92, v224
    v_accvgpr_write_b32 a93, v225
    v_accvgpr_write_b32 a94, v226
    v_accvgpr_write_b32 a95, v227
    v_accvgpr_read_b32 v224, a96
    v_accvgpr_read_b32 v225, a97
    v_accvgpr_read_b32 v226, a98
    v_accvgpr_read_b32 v227, a99
    v_mul_f32 v224, v224, v52
    v_mul_f32 v225, v225, v52
    v_mul_f32 v226, v226, v52
    v_mul_f32 v227, v227, v52
    v_accvgpr_write_b32 a96, v224
    v_accvgpr_write_b32 a97, v225
    v_accvgpr_write_b32 a98, v226
    v_accvgpr_write_b32 a99, v227
    v_accvgpr_read_b32 v224, a100
    v_accvgpr_read_b32 v225, a101
    v_accvgpr_read_b32 v226, a102
    v_accvgpr_read_b32 v227, a103
    v_mul_f32 v224, v224, v53
    v_mul_f32 v225, v225, v53
    v_mul_f32 v226, v226, v53
    v_mul_f32 v227, v227, v53
    v_accvgpr_write_b32 a100, v224
    v_accvgpr_write_b32 a101, v225
    v_accvgpr_write_b32 a102, v226
    v_accvgpr_write_b32 a103, v227
    v_accvgpr_read_b32 v224, a104
    v_accvgpr_read_b32 v225, a105
    v_accvgpr_read_b32 v226, a106
    v_accvgpr_read_b32 v227, a107
    v_mul_f32 v224, v224, v54
    v_mul_f32 v225, v225, v54
    v_mul_f32 v226, v226, v54
    v_mul_f32 v227, v227, v54
    v_accvgpr_write_b32 a104, v224
    v_accvgpr_write_b32 a105, v225
    v_accvgpr_write_b32 a106, v226
    v_accvgpr_write_b32 a107, v227
    v_accvgpr_read_b32 v224, a108
    v_accvgpr_read_b32 v225, a109
    v_accvgpr_read_b32 v226, a110
    v_accvgpr_read_b32 v227, a111
    v_mul_f32 v224, v224, v55
    v_mul_f32 v225, v225, v55
    v_mul_f32 v226, v226, v55
    v_mul_f32 v227, v227, v55
    v_accvgpr_write_b32 a108, v224
    v_accvgpr_write_b32 a109, v225
    v_accvgpr_write_b32 a110, v226
    v_accvgpr_write_b32 a111, v227
    v_accvgpr_read_b32 v224, a112
    v_accvgpr_read_b32 v225, a113
    v_accvgpr_read_b32 v226, a114
    v_accvgpr_read_b32 v227, a115
    v_mul_f32 v224, v224, v52
    v_mul_f32 v225, v225, v52
    v_mul_f32 v226, v226, v52
    v_mul_f32 v227, v227, v52
    v_accvgpr_write_b32 a112, v224
    v_accvgpr_write_b32 a113, v225
    v_accvgpr_write_b32 a114, v226
    v_accvgpr_write_b32 a115, v227
    v_accvgpr_read_b32 v224, a116
    v_accvgpr_read_b32 v225, a117
    v_accvgpr_read_b32 v226, a118
    v_accvgpr_read_b32 v227, a119
    v_mul_f32 v224, v224, v53
    v_mul_f32 v225, v225, v53
    v_mul_f32 v226, v226, v53
    v_mul_f32 v227, v227, v53
    v_accvgpr_write_b32 a116, v224
    v_accvgpr_write_b32 a117, v225
    v_accvgpr_write_b32 a118, v226
    v_accvgpr_write_b32 a119, v227
    v_accvgpr_read_b32 v224, a120
    v_accvgpr_read_b32 v225, a121
    v_accvgpr_read_b32 v226, a122
    v_accvgpr_read_b32 v227, a123
    v_mul_f32 v224, v224, v54
    v_mul_f32 v225, v225, v54
    v_mul_f32 v226, v226, v54
    v_mul_f32 v227, v227, v54
    v_accvgpr_write_b32 a120, v224
    v_accvgpr_write_b32 a121, v225
    v_accvgpr_write_b32 a122, v226
    v_accvgpr_write_b32 a123, v227
    v_accvgpr_read_b32 v224, a124
    v_accvgpr_read_b32 v225, a125
    v_accvgpr_read_b32 v226, a126
    v_accvgpr_read_b32 v227, a127
    v_mul_f32 v224, v224, v55
    v_mul_f32 v225, v225, v55
    v_mul_f32 v226, v226, v55
    v_mul_f32 v227, v227, v55
    v_accvgpr_write_b32 a124, v224
    v_accvgpr_write_b32 a125, v225
    v_accvgpr_write_b32 a126, v226
    v_accvgpr_write_b32 a127, v227
    v_exp_f32 v56, v128
    v_exp_f32 v57, v129
    v_exp_f32 v58, v130
    v_exp_f32 v59, v131
    v_add_f32 v48, v56, v57
    v_cvt_pk_bf16_f32 v192, v56, v57
    v_exp_f32 v60, v144
    v_exp_f32 v61, v145
    v_add_f32 v48, v48, v58
    v_add_f32 v48, v48, v59
    v_cvt_pk_bf16_f32 v193, v58, v59
    v_exp_f32 v62, v146
    v_exp_f32 v63, v147
    v_add_f32 v48, v48, v60
    v_add_f32 v48, v48, v61
    v_cvt_pk_bf16_f32 v194, v60, v61
    v_exp_f32 v56, v132
    v_exp_f32 v57, v133
    v_add_f32 v48, v48, v62
    v_add_f32 v48, v48, v63
    v_cvt_pk_bf16_f32 v195, v62, v63
    v_exp_f32 v58, v134
    v_exp_f32 v59, v135
    v_add_f32 v49, v56, v57
    v_cvt_pk_bf16_f32 v196, v56, v57
    v_exp_f32 v60, v148
    v_exp_f32 v61, v149
    v_add_f32 v49, v49, v58
    v_add_f32 v49, v49, v59
    v_cvt_pk_bf16_f32 v197, v58, v59
    v_exp_f32 v62, v150
    v_exp_f32 v63, v151
    v_add_f32 v49, v49, v60
    v_add_f32 v49, v49, v61
    v_cvt_pk_bf16_f32 v198, v60, v61
    v_exp_f32 v56, v136
    v_exp_f32 v57, v137
    v_add_f32 v49, v49, v62
    v_add_f32 v49, v49, v63
    v_cvt_pk_bf16_f32 v199, v62, v63
    v_exp_f32 v58, v138
    v_exp_f32 v59, v139
    v_add_f32 v50, v56, v57
    v_cvt_pk_bf16_f32 v200, v56, v57
    v_exp_f32 v60, v152
    v_exp_f32 v61, v153
    v_add_f32 v50, v50, v58
    v_add_f32 v50, v50, v59
    v_cvt_pk_bf16_f32 v201, v58, v59
    v_exp_f32 v62, v154
    v_exp_f32 v63, v155
    v_add_f32 v50, v50, v60
    v_add_f32 v50, v50, v61
    v_cvt_pk_bf16_f32 v202, v60, v61
    v_exp_f32 v56, v140
    v_exp_f32 v57, v141
    v_add_f32 v50, v50, v62
    v_add_f32 v50, v50, v63
    v_cvt_pk_bf16_f32 v203, v62, v63
    v_exp_f32 v58, v142
    v_exp_f32 v59, v143
    v_add_f32 v51, v56, v57
    v_cvt_pk_bf16_f32 v204, v56, v57
    v_exp_f32 v60, v156
    v_exp_f32 v61, v157
    v_add_f32 v51, v51, v58
    v_add_f32 v51, v51, v59
    v_cvt_pk_bf16_f32 v205, v58, v59
    v_exp_f32 v62, v158
    v_exp_f32 v63, v159
    v_add_f32 v51, v51, v60
    v_add_f32 v51, v51, v61
    v_cvt_pk_bf16_f32 v206, v60, v61
    s_nop 0
    v_add_f32 v51, v51, v62
    v_add_f32 v51, v51, v63
    v_cvt_pk_bf16_f32 v207, v62, v63
    s_nop 1
    s_branch k2_ret_11
k2_rare_14:
    s_nop 7
    v_max_f32 v52, v160, v161
    v_max3_f32 v52, v52, v162, v163
    v_max3_f32 v52, v52, v176, v177
    v_max3_f32 v52, v52, v178, v179
    v_mov_b32 v6, v52
    s_nop 1
    v_permlane16_swap_b32 v52, v6
    s_nop 1
    v_max_f32 v52, v52, v6
    v_mov_b32 v6, v52
    s_nop 1
    v_permlane32_swap_b32 v52, v6
    s_nop 1
    v_max_f32 v52, v52, v6
    v_max_f32 v52, 0, v52
    v_max_f32 v53, v164, v165
    v_max3_f32 v53, v53, v166, v167
    v_max3_f32 v53, v53, v180, v181
    v_max3_f32 v53, v53, v182, v183
    v_mov_b32 v6, v53
    s_nop 1
    v_permlane16_swap_b32 v53, v6
    s_nop 1
    v_max_f32 v53, v53, v6
    v_mov_b32 v6, v53
    s_nop 1
    v_permlane32_swap_b32 v53, v6
    s_nop 1
    v_max_f32 v53, v53, v6
    v_max_f32 v53, 0, v53
    v_max_f32 v54, v168, v169
    v_max3_f32 v54, v54, v170, v171
    v_max3_f32 v54, v54, v184, v185
    v_max3_f32 v54, v54, v186, v187
    v_mov_b32 v6, v54
    s_nop 1
    v_permlane16_swap_b32 v54, v6
    s_nop 1
    v_max_f32 v54, v54, v6
    v_mov_b32 v6, v54
    s_nop 1
    v_permlane32_swap_b32 v54, v6
    s_nop 1
    v_max_f32 v54, v54, v6
    v_max_f32 v54, 0, v54
    v_max_f32 v55, v172, v173
    v_max3_f32 v55, v55, v174, v175
    v_max3_f32 v55, v55, v188, v189
    v_max3_f32 v55, v55, v190, v191
    v_mov_b32 v6, v55
    s_nop 1
    v_permlane16_swap_b32 v55, v6
    s_nop 1
    v_max_f32 v55, v55, v6
    v_mov_b32 v6, v55
    s_nop 1
    v_permlane32_swap_b32 v55, v6
    s_nop 1
    v_max_f32 v55, v55, v6
    v_max_f32 v55, 0, v55
    v_sub_f32 v160, v160, v52
    v_sub_f32 v161, v161, v52
    v_sub_f32 v162, v162, v52
    v_sub_f32 v163, v163, v52
    v_sub_f32 v164, v164, v53
    v_sub_f32 v165, v165, v53
    v_sub_f32 v166, v166, v53
    v_sub_f32 v167, v167, v53
    v_sub_f32 v168, v168, v54
    v_sub_f32 v169, v169, v54
    v_sub_f32 v170, v170, v54
    v_sub_f32 v171, v171, v54
    v_sub_f32 v172, v172, v55
    v_sub_f32 v173, v173, v55
    v_sub_f32 v174, v174, v55
    v_sub_f32 v175, v175, v55
    v_sub_f32 v176, v176, v52
    v_sub_f32 v177, v177, v52
    v_sub_f32 v178, v178, v52
    v_sub_f32 v179, v179, v52
    v_sub_f32 v180, v180, v53
    v_sub_f32 v181, v181, v53
    v_sub_f32 v182, v182, v53
    v_sub_f32 v183, v183, v53
    v_sub_f32 v184, v184, v54
    v_sub_f32 v185, v185, v54
    v_sub_f32 v186, v186, v54
    v_sub_f32 v187, v187, v54
    v_sub_f32 v188, v188, v55
    v_sub_f32 v189, v189, v55
    v_sub_f32 v190, v190, v55
    v_sub_f32 v191, v191, v55
    v_sub_f32 v128, v128, v52
    v_sub_f32 v16, v16, v52
    v_sub_f32 v129, v129, v52
    v_sub_f32 v17, v17, v52
    v_sub_f32 v130, v130, v52
    v_sub_f32 v18, v18, v52
    v_sub_f32 v131, v131, v52
    v_sub_f32 v19, v19, v52
    v_sub_f32 v132, v132, v53
    v_sub_f32 v20, v20, v53
    v_sub_f32 v133, v133, v53
    v_sub_f32 v21, v21, v53
    v_sub_f32 v134, v134, v53
    v_sub_f32 v22, v22, v53
    v_sub_f32 v135, v135, v53
    v_sub_f32 v23, v23, v53
    v_sub_f32 v136, v136, v54
    v_sub_f32 v24, v24, v54
    v_sub_f32 v137, v137, v54
    v_sub_f32 v25, v25, v54
    v_sub_f32 v138, v138, v54
    v_sub_f32 v26, v26, v54
    v_sub_f32 v139, v139, v54
    v_sub_f32 v27, v27, v54
    v_sub_f32 v140, v140, v55
    v_sub_f32 v28, v28, v55
    v_sub_f32 v141, v141, v55
    v_sub_f32 v29, v29, v55
    v_sub_f32 v142, v142, v55
    v_sub_f32 v30, v30, v55
    v_sub_f32 v143, v143, v55
    v_sub_f32 v31, v31, v55
    v_sub_f32 v144, v144, v52
    v_sub_f32 v32, v32, v52
    v_sub_f32 v145, v145, v52
    v_sub_f32 v33, v33, v52
    v_sub_f32 v146, v146, v52
    v_sub_f32 v34, v34, v52
    v_sub_f32 v147, v147, v52
    v_sub_f32 v35, v35, v52
    v_sub_f32 v148, v148, v53
    v_sub_f32 v36, v36, v53
    v_sub_f32 v149, v149, v53
    v_sub_f32 v37, v37, v53
    v_sub_f32 v150, v150, v53
    v_sub_f32 v38, v38, v53
    v_sub_f32 v151, v151, v53
    v_sub_f32 v39, v39, v53
    v_sub_f32 v152, v152, v54
    v_sub_f32 v40, v40, v54
    v_sub_f32 v153, v153, v54
    v_sub_f32 v41, v41, v54
    v_sub_f32 v154, v154, v54
    v_sub_f32 v42, v42, v54
    v_sub_f32 v155, v155, v54
    v_sub_f32 v43, v43, v54
    v_sub_f32 v156, v156, v55
    v_sub_f32 v44, v44, v55
    v_sub_f32 v157, v157, v55
    v_sub_f32 v45, v45, v55
    v_sub_f32 v158, v158, v55
    v_sub_f32 v46, v46, v55
    v_sub_f32 v159, v159, v55
    v_sub_f32 v47, v47, v55
    v_sub_f32 v8, v8, v52
    v_exp_f32 v52, -v52
    v_sub_f32 v9, v9, v53
    v_exp_f32 v53, -v53
    v_sub_f32 v10, v10, v54
    v_exp_f32 v54, -v54
    v_sub_f32 v11, v11, v55
    v_exp_f32 v55, -v55
    s_nop 0
    v_mul_f32 v12, v12, v52
    v_mul_f32 v13, v13, v53
    v_mul_f32 v14, v14, v54
    v_mul_f32 v15, v15, v55
    v_accvgpr_read_b32 v224, a0
    v_accvgpr_read_b32 v225, a1
    v_accvgpr_read_b32 v226, a2
    v_accvgpr_read_b32 v227, a3
    v_mul_f32 v224, v224, v52
    v_mul_f32 v225, v225, v52
    v_mul_f32 v226, v226, v52
    v_mul_f32 v227, v227, v52
    v_accvgpr_write_b32 a0, v224
    v_accvgpr_write_b32 a1, v225
    v_accvgpr_write_b32 a2, v226
    v_accvgpr_write_b32 a3, v227
    v_accvgpr_read_b32 v224, a4
    v_accvgpr_read_b32 v225, a5
    v_accvgpr_read_b32 v226, a6
    v_accvgpr_read_b32 v227, a7
    v_mul_f32 v224, v224, v53
    v_mul_f32 v225, v225, v53
    v_mul_f32 v226, v226, v53
    v_mul_f32 v227, v227, v53
    v_accvgpr_write_b32 a4, v224
    v_accvgpr_write_b32 a5, v225
    v_accvgpr_write_b32 a6, v226
    v_accvgpr_write_b32 a7, v227
    v_accvgpr_read_b32 v224, a8
    v_accvgpr_read_b32 v225, a9
    v_accvgpr_read_b32 v226, a10
    v_accvgpr_read_b32 v227, a11
    v_mul_f32 v224, v224, v54
    v_mul_f32 v225, v225, v54
    v_mul_f32 v226, v226, v54
    v_mul_f32 v227, v227, v54
    v_accvgpr_write_b32 a8, v224
    v_accvgpr_write_b32 a9, v225
    v_accvgpr_write_b32 a10, v226
    v_accvgpr_write_b32 a11, v227
    v_accvgpr_read_b32 v224, a12
    v_accvgpr_read_b32 v225, a13
    v_accvgpr_read_b32 v226, a14
    v_accvgpr_read_b32 v227, a15
    v_mul_f32 v224, v224, v55
    v_mul_f32 v225, v225, v55
    v_mul_f32 v226, v226, v55
    v_mul_f32 v227, v227, v55
    v_accvgpr_write_b32 a12, v224
    v_accvgpr_write_b32 a13, v225
    v_accvgpr_write_b32 a14, v226
    v_accvgpr_write_b32 a15, v227
    v_accvgpr_read_b32 v224, a16
    v_accvgpr_read_b32 v225, a17
    v_accvgpr_read_b32 v226, a18
    v_accvgpr_read_b32 v227, a19
    v_mul_f32 v224, v224, v52
    v_mul_f32 v225, v225, v52
    v_mul_f32 v226, v226, v52
    v_mul_f32 v227, v227, v52
    v_accvgpr_write_b32 a16, v224
    v_accvgpr_write_b32 a17, v225
    v_accvgpr_write_b32 a18, v226
    v_accvgpr_write_b32 a19, v227
    v_accvgpr_read_b32 v224, a20
    v_accvgpr_read_b32 v225, a21
    v_accvgpr_read_b32 v226, a22
    v_accvgpr_read_b32 v227, a23
    v_mul_f32 v224, v224, v53
    v_mul_f32 v225, v225, v53
    v_mul_f32 v226, v226, v53
    v_mul_f32 v227, v227, v53
    v_accvgpr_write_b32 a20, v224
    v_accvgpr_write_b32 a21, v225
    v_accvgpr_write_b32 a22, v226
    v_accvgpr_write_b32 a23, v227
    v_accvgpr_read_b32 v224, a24
    v_accvgpr_read_b32 v225, a25
    v_accvgpr_read_b32 v226, a26
    v_accvgpr_read_b32 v227, a27
    v_mul_f32 v224, v224, v54
    v_mul_f32 v225, v225, v54
    v_mul_f32 v226, v226, v54
    v_mul_f32 v227, v227, v54
    v_accvgpr_write_b32 a24, v224
    v_accvgpr_write_b32 a25, v225
    v_accvgpr_write_b32 a26, v226
    v_accvgpr_write_b32 a27, v227
    v_accvgpr_read_b32 v224, a28
    v_accvgpr_read_b32 v225, a29
    v_accvgpr_read_b32 v226, a30
    v_accvgpr_read_b32 v227, a31
    v_mul_f32 v224, v224, v55
    v_mul_f32 v225, v225, v55
    v_mul_f32 v226, v226, v55
    v_mul_f32 v227, v227, v55
    v_accvgpr_write_b32 a28, v224
    v_accvgpr_write_b32 a29, v225
    v_accvgpr_write_b32 a30, v226
    v_accvgpr_write_b32 a31, v227
    v_accvgpr_read_b32 v224, a32
    v_accvgpr_read_b32 v225, a33
    v_accvgpr_read_b32 v226, a34
    v_accvgpr_read_b32 v227, a35
    v_mul_f32 v224, v224, v52
    v_mul_f32 v225, v225, v52
    v_mul_f32 v226, v226, v52
    v_mul_f32 v227, v227, v52
    v_accvgpr_write_b32 a32, v224
    v_accvgpr_write_b32 a33, v225
    v_accvgpr_write_b32 a34, v226
    v_accvgpr_write_b32 a35, v227
    v_accvgpr_read_b32 v224, a36
    v_accvgpr_read_b32 v225, a37
    v_accvgpr_read_b32 v226, a38
    v_accvgpr_read_b32 v227, a39
    v_mul_f32 v224, v224, v53
    v_mul_f32 v225, v225, v53
    v_mul_f32 v226, v226, v53
    v_mul_f32 v227, v227, v53
    v_accvgpr_write_b32 a36, v224
    v_accvgpr_write_b32 a37, v225
    v_accvgpr_write_b32 a38, v226
    v_accvgpr_write_b32 a39, v227
    v_accvgpr_read_b32 v224, a40
    v_accvgpr_read_b32 v225, a41
    v_accvgpr_read_b32 v226, a42
    v_accvgpr_read_b32 v227, a43
    v_mul_f32 v224, v224, v54
    v_mul_f32 v225, v225, v54
    v_mul_f32 v226, v226, v54
    v_mul_f32 v227, v227, v54
    v_accvgpr_write_b32 a40, v224
    v_accvgpr_write_b32 a41, v225
    v_accvgpr_write_b32 a42, v226
    v_accvgpr_write_b32 a43, v227
    v_accvgpr_read_b32 v224, a44
    v_accvgpr_read_b32 v225, a45
    v_accvgpr_read_b32 v226, a46
    v_accvgpr_read_b32 v227, a47
    v_mul_f32 v224, v224, v55
    v_mul_f32 v225, v225, v55
    v_mul_f32 v226, v226, v55
    v_mul_f32 v227, v227, v55
    v_accvgpr_write_b32 a44, v224
    v_accvgpr_write_b32 a45, v225
    v_accvgpr_write_b32 a46, v226
    v_accvgpr_write_b32 a47, v227
    v_accvgpr_read_b32 v224, a48
    v_accvgpr_read_b32 v225, a49
    v_accvgpr_read_b32 v226, a50
    v_accvgpr_read_b32 v227, a51
    v_mul_f32 v224, v224, v52
    v_mul_f32 v225, v225, v52
    v_mul_f32 v226, v226, v52
    v_mul_f32 v227, v227, v52
    v_accvgpr_write_b32 a48, v224
    v_accvgpr_write_b32 a49, v225
    v_accvgpr_write_b32 a50, v226
    v_accvgpr_write_b32 a51, v227
    v_accvgpr_read_b32 v224, a52
    v_accvgpr_read_b32 v225, a53
    v_accvgpr_read_b32 v226, a54
    v_accvgpr_read_b32 v227, a55
    v_mul_f32 v224, v224, v53
    v_mul_f32 v225, v225, v53
    v_mul_f32 v226, v226, v53
    v_mul_f32 v227, v227, v53
    v_accvgpr_write_b32 a52, v224
    v_accvgpr_write_b32 a53, v225
    v_accvgpr_write_b32 a54, v226
    v_accvgpr_write_b32 a55, v227
    v_accvgpr_read_b32 v224, a56
    v_accvgpr_read_b32 v225, a57
    v_accvgpr_read_b32 v226, a58
    v_accvgpr_read_b32 v227, a59
    v_mul_f32 v224, v224, v54
    v_mul_f32 v225, v225, v54
    v_mul_f32 v226, v226, v54
    v_mul_f32 v227, v227, v54
    v_accvgpr_write_b32 a56, v224
    v_accvgpr_write_b32 a57, v225
    v_accvgpr_write_b32 a58, v226
    v_accvgpr_write_b32 a59, v227
    v_accvgpr_read_b32 v224, a60
    v_accvgpr_read_b32 v225, a61
    v_accvgpr_read_b32 v226, a62
    v_accvgpr_read_b32 v227, a63
    v_mul_f32 v224, v224, v55
    v_mul_f32 v225, v225, v55
    v_mul_f32 v226, v226, v55
    v_mul_f32 v227, v227, v55
    v_accvgpr_write_b32 a60, v224
    v_accvgpr_write_b32 a61, v225
    v_accvgpr_write_b32 a62, v226
    v_accvgpr_write_b32 a63, v227
    v_accvgpr_read_b32 v224, a64
    v_accvgpr_read_b32 v225, a65
    v_accvgpr_read_b32 v226, a66
    v_accvgpr_read_b32 v227, a67
    v_mul_f32 v224, v224, v52
    v_mul_f32 v225, v225, v52
    v_mul_f32 v226, v226, v52
    v_mul_f32 v227, v227, v52
    v_accvgpr_write_b32 a64, v224
    v_accvgpr_write_b32 a65, v225
    v_accvgpr_write_b32 a66, v226
    v_accvgpr_write_b32 a67, v227
    v_accvgpr_read_b32 v224, a68
    v_accvgpr_read_b32 v225, a69
    v_accvgpr_read_b32 v226, a70
    v_accvgpr_read_b32 v227, a71
    v_mul_f32 v224, v224, v53
    v_mul_f32 v225, v225, v53
    v_mul_f32 v226, v226, v53
    v_mul_f32 v227, v227, v53
    v_accvgpr_write_b32 a68, v224
    v_accvgpr_write_b32 a69, v225
    v_accvgpr_write_b32 a70, v226
    v_accvgpr_write_b32 a71, v227
    v_accvgpr_read_b32 v224, a72
    v_accvgpr_read_b32 v225, a73
    v_accvgpr_read_b32 v226, a74
    v_accvgpr_read_b32 v227, a75
    v_mul_f32 v224, v224, v54
    v_mul_f32 v225, v225, v54
    v_mul_f32 v226, v226, v54
    v_mul_f32 v227, v227, v54
    v_accvgpr_write_b32 a72, v224
    v_accvgpr_write_b32 a73, v225
    v_accvgpr_write_b32 a74, v226
    v_accvgpr_write_b32 a75, v227
    v_accvgpr_read_b32 v224, a76
    v_accvgpr_read_b32 v225, a77
    v_accvgpr_read_b32 v226, a78
    v_accvgpr_read_b32 v227, a79
    v_mul_f32 v224, v224, v55
    v_mul_f32 v225, v225, v55
    v_mul_f32 v226, v226, v55
    v_mul_f32 v227, v227, v55
    v_accvgpr_write_b32 a76, v224
    v_accvgpr_write_b32 a77, v225
    v_accvgpr_write_b32 a78, v226
    v_accvgpr_write_b32 a79, v227
    v_accvgpr_read_b32 v224, a80
    v_accvgpr_read_b32 v225, a81
    v_accvgpr_read_b32 v226, a82
    v_accvgpr_read_b32 v227, a83
    v_mul_f32 v224, v224, v52
    v_mul_f32 v225, v225, v52
    v_mul_f32 v226, v226, v52
    v_mul_f32 v227, v227, v52
    v_accvgpr_write_b32 a80, v224
    v_accvgpr_write_b32 a81, v225
    v_accvgpr_write_b32 a82, v226
    v_accvgpr_write_b32 a83, v227
    v_accvgpr_read_b32 v224, a84
    v_accvgpr_read_b32 v225, a85
    v_accvgpr_read_b32 v226, a86
    v_accvgpr_read_b32 v227, a87
    v_mul_f32 v224, v224, v53
    v_mul_f32 v225, v225, v53
    v_mul_f32 v226, v226, v53
    v_mul_f32 v227, v227, v53
    v_accvgpr_write_b32 a84, v224
    v_accvgpr_write_b32 a85, v225
    v_accvgpr_write_b32 a86, v226
    v_accvgpr_write_b32 a87, v227
    v_accvgpr_read_b32 v224, a88
    v_accvgpr_read_b32 v225, a89
    v_accvgpr_read_b32 v226, a90
    v_accvgpr_read_b32 v227, a91
    v_mul_f32 v224, v224, v54
    v_mul_f32 v225, v225, v54
    v_mul_f32 v226, v226, v54
    v_mul_f32 v227, v227, v54
    v_accvgpr_write_b32 a88, v224
    v_accvgpr_write_b32 a89, v225
    v_accvgpr_write_b32 a90, v226
    v_accvgpr_write_b32 a91, v227
    v_accvgpr_read_b32 v224, a92
    v_accvgpr_read_b32 v225, a93
    v_accvgpr_read_b32 v226, a94
    v_accvgpr_read_b32 v227, a95
    v_mul_f32 v224, v224, v55
    v_mul_f32 v225, v225, v55
    v_mul_f32 v226, v226, v55
    v_mul_f32 v227, v227, v55
    v_accvgpr_write_b32 a92, v224
    v_accvgpr_write_b32 a93, v225
    v_accvgpr_write_b32 a94, v226
    v_accvgpr_write_b32 a95, v227
    v_accvgpr_read_b32 v224, a96
    v_accvgpr_read_b32 v225, a97
    v_accvgpr_read_b32 v226, a98
    v_accvgpr_read_b32 v227, a99
    v_mul_f32 v224, v224, v52
    v_mul_f32 v225, v225, v52
    v_mul_f32 v226, v226, v52
    v_mul_f32 v227, v227, v52
    v_accvgpr_write_b32 a96, v224
    v_accvgpr_write_b32 a97, v225
    v_accvgpr_write_b32 a98, v226
    v_accvgpr_write_b32 a99, v227
    v_accvgpr_read_b32 v224, a100
    v_accvgpr_read_b32 v225, a101
    v_accvgpr_read_b32 v226, a102
    v_accvgpr_read_b32 v227, a103
    v_mul_f32 v224, v224, v53
    v_mul_f32 v225, v225, v53
    v_mul_f32 v226, v226, v53
    v_mul_f32 v227, v227, v53
    v_accvgpr_write_b32 a100, v224
    v_accvgpr_write_b32 a101, v225
    v_accvgpr_write_b32 a102, v226
    v_accvgpr_write_b32 a103, v227
    v_accvgpr_read_b32 v224, a104
    v_accvgpr_read_b32 v225, a105
    v_accvgpr_read_b32 v226, a106
    v_accvgpr_read_b32 v227, a107
    v_mul_f32 v224, v224, v54
    v_mul_f32 v225, v225, v54
    v_mul_f32 v226, v226, v54
    v_mul_f32 v227, v227, v54
    v_accvgpr_write_b32 a104, v224
    v_accvgpr_write_b32 a105, v225
    v_accvgpr_write_b32 a106, v226
    v_accvgpr_write_b32 a107, v227
    v_accvgpr_read_b32 v224, a108
    v_accvgpr_read_b32 v225, a109
    v_accvgpr_read_b32 v226, a110
    v_accvgpr_read_b32 v227, a111
    v_mul_f32 v224, v224, v55
    v_mul_f32 v225, v225, v55
    v_mul_f32 v226, v226, v55
    v_mul_f32 v227, v227, v55
    v_accvgpr_write_b32 a108, v224
    v_accvgpr_write_b32 a109, v225
    v_accvgpr_write_b32 a110, v226
    v_accvgpr_write_b32 a111, v227
    v_accvgpr_read_b32 v224, a112
    v_accvgpr_read_b32 v225, a113
    v_accvgpr_read_b32 v226, a114
    v_accvgpr_read_b32 v227, a115
    v_mul_f32 v224, v224, v52
    v_mul_f32 v225, v225, v52
    v_mul_f32 v226, v226, v52
    v_mul_f32 v227, v227, v52
    v_accvgpr_write_b32 a112, v224
    v_accvgpr_write_b32 a113, v225
    v_accvgpr_write_b32 a114, v226
    v_accvgpr_write_b32 a115, v227
    v_accvgpr_read_b32 v224, a116
    v_accvgpr_read_b32 v225, a117
    v_accvgpr_read_b32 v226, a118
    v_accvgpr_read_b32 v227, a119
    v_mul_f32 v224, v224, v53
    v_mul_f32 v225, v225, v53
    v_mul_f32 v226, v226, v53
    v_mul_f32 v227, v227, v53
    v_accvgpr_write_b32 a116, v224
    v_accvgpr_write_b32 a117, v225
    v_accvgpr_write_b32 a118, v226
    v_accvgpr_write_b32 a119, v227
    v_accvgpr_read_b32 v224, a120
    v_accvgpr_read_b32 v225, a121
    v_accvgpr_read_b32 v226, a122
    v_accvgpr_read_b32 v227, a123
    v_mul_f32 v224, v224, v54
    v_mul_f32 v225, v225, v54
    v_mul_f32 v226, v226, v54
    v_mul_f32 v227, v227, v54
    v_accvgpr_write_b32 a120, v224
    v_accvgpr_write_b32 a121, v225
    v_accvgpr_write_b32 a122, v226
    v_accvgpr_write_b32 a123, v227
    v_accvgpr_read_b32 v224, a124
    v_accvgpr_read_b32 v225, a125
    v_accvgpr_read_b32 v226, a126
    v_accvgpr_read_b32 v227, a127
    v_mul_f32 v224, v224, v55
    v_mul_f32 v225, v225, v55
    v_mul_f32 v226, v226, v55
    v_mul_f32 v227, v227, v55
    v_accvgpr_write_b32 a124, v224
    v_accvgpr_write_b32 a125, v225
    v_accvgpr_write_b32 a126, v226
    v_accvgpr_write_b32 a127, v227
    v_exp_f32 v56, v160
    v_exp_f32 v57, v161
    v_exp_f32 v58, v162
    v_exp_f32 v59, v163
    v_add_f32 v48, v56, v57
    v_cvt_pk_bf16_f32 v208, v56, v57
    v_exp_f32 v60, v176
    v_exp_f32 v61, v177
    v_add_f32 v48, v48, v58
    v_add_f32 v48, v48, v59
    v_cvt_pk_bf16_f32 v209, v58, v59
    v_exp_f32 v62, v178
    v_exp_f32 v63, v179
    v_add_f32 v48, v48, v60
    v_add_f32 v48, v48, v61
    v_cvt_pk_bf16_f32 v210, v60, v61
    v_exp_f32 v56, v164
    v_exp_f32 v57, v165
    v_add_f32 v48, v48, v62
    v_add_f32 v48, v48, v63
    v_cvt_pk_bf16_f32 v211, v62, v63
    v_exp_f32 v58, v166
    v_exp_f32 v59, v167
    v_add_f32 v49, v56, v57
    v_cvt_pk_bf16_f32 v212, v56, v57
    v_exp_f32 v60, v180
    v_exp_f32 v61, v181
    v_add_f32 v49, v49, v58
    v_add_f32 v49, v49, v59
    v_cvt_pk_bf16_f32 v213, v58, v59
    v_exp_f32 v62, v182
    v_exp_f32 v63, v183
    v_add_f32 v49, v49, v60
    v_add_f32 v49, v49, v61
    v_cvt_pk_bf16_f32 v214, v60, v61
    v_exp_f32 v56, v168
    v_exp_f32 v57, v169
    v_add_f32 v49, v49, v62
    v_add_f32 v49, v49, v63
    v_cvt_pk_bf16_f32 v215, v62, v63
    v_exp_f32 v58, v170
    v_exp_f32 v59, v171
    v_add_f32 v50, v56, v57
    v_cvt_pk_bf16_f32 v216, v56, v57
    v_exp_f32 v60, v184
    v_exp_f32 v61, v185
    v_add_f32 v50, v50, v58
    v_add_f32 v50, v50, v59
    v_cvt_pk_bf16_f32 v217, v58, v59
    v_exp_f32 v62, v186
    v_exp_f32 v63, v187
    v_add_f32 v50, v50, v60
    v_add_f32 v50, v50, v61
    v_cvt_pk_bf16_f32 v218, v60, v61
    v_exp_f32 v56, v172
    v_exp_f32 v57, v173
    v_add_f32 v50, v50, v62
    v_add_f32 v50, v50, v63
    v_cvt_pk_bf16_f32 v219, v62, v63
    v_exp_f32 v58, v174
    v_exp_f32 v59, v175
    v_add_f32 v51, v56, v57
    v_cvt_pk_bf16_f32 v220, v56, v57
    v_exp_f32 v60, v188
    v_exp_f32 v61, v189
    v_add_f32 v51, v51, v58
    v_add_f32 v51, v51, v59
    v_cvt_pk_bf16_f32 v221, v58, v59
    v_exp_f32 v62, v190
    v_exp_f32 v63, v191
    v_add_f32 v51, v51, v60
    v_add_f32 v51, v51, v61
    v_cvt_pk_bf16_f32 v222, v60, v61
    s_nop 0
    v_add_f32 v51, v51, v62
    v_add_f32 v51, v51, v63
    v_cvt_pk_bf16_f32 v223, v62, v63
    s_nop 1
    s_branch k2_ret_15
k2_rare_17:
    s_nop 7
    v_max_f32 v52, v128, v129
    v_max3_f32 v52, v52, v130, v131
    v_max3_f32 v52, v52, v144, v145
    v_max3_f32 v52, v52, v146, v147
    v_mov_b32 v6, v52
    s_nop 1
    v_permlane16_swap_b32 v52, v6
    s_nop 1
    v_max_f32 v52, v52, v6
    v_mov_b32 v6, v52
    s_nop 1
    v_permlane32_swap_b32 v52, v6
    s_nop 1
    v_max_f32 v52, v52, v6
    v_max_f32 v52, 0, v52
    v_max_f32 v53, v132, v133
    v_max3_f32 v53, v53, v134, v135
    v_max3_f32 v53, v53, v148, v149
    v_max3_f32 v53, v53, v150, v151
    v_mov_b32 v6, v53
    s_nop 1
    v_permlane16_swap_b32 v53, v6
    s_nop 1
    v_max_f32 v53, v53, v6
    v_mov_b32 v6, v53
    s_nop 1
    v_permlane32_swap_b32 v53, v6
    s_nop 1
    v_max_f32 v53, v53, v6
    v_max_f32 v53, 0, v53
    v_max_f32 v54, v136, v137
    v_max3_f32 v54, v54, v138, v139
    v_max3_f32 v54, v54, v152, v153
    v_max3_f32 v54, v54, v154, v155
    v_mov_b32 v6, v54
    s_nop 1
    v_permlane16_swap_b32 v54, v6
    s_nop 1
    v_max_f32 v54, v54, v6
    v_mov_b32 v6, v54
    s_nop 1
    v_permlane32_swap_b32 v54, v6
    s_nop 1
    v_max_f32 v54, v54, v6
    v_max_f32 v54, 0, v54
    v_max_f32 v55, v140, v141
    v_max3_f32 v55, v55, v142, v143
    v_max3_f32 v55, v55, v156, v157
    v_max3_f32 v55, v55, v158, v159
    v_mov_b32 v6, v55
    s_nop 1
    v_permlane16_swap_b32 v55, v6
    s_nop 1
    v_max_f32 v55, v55, v6
    v_mov_b32 v6, v55
    s_nop 1
    v_permlane32_swap_b32 v55, v6
    s_nop 1
    v_max_f32 v55, v55, v6
    v_max_f32 v55, 0, v55
    v_sub_f32 v128, v128, v52
    v_sub_f32 v129, v129, v52
    v_sub_f32 v130, v130, v52
    v_sub_f32 v131, v131, v52
    v_sub_f32 v132, v132, v53
    v_sub_f32 v133, v133, v53
    v_sub_f32 v134, v134, v53
    v_sub_f32 v135, v135, v53
    v_sub_f32 v136, v136, v54
    v_sub_f32 v137, v137, v54
    v_sub_f32 v138, v138, v54
    v_sub_f32 v139, v139, v54
    v_sub_f32 v140, v140, v55
    v_sub_f32 v141, v141, v55
    v_sub_f32 v142, v142, v55
    v_sub_f32 v143, v143, v55
    v_sub_f32 v144, v144, v52
    v_sub_f32 v145, v145, v52
    v_sub_f32 v146, v146, v52
    v_sub_f32 v147, v147, v52
    v_sub_f32 v148, v148, v53
    v_sub_f32 v149, v149, v53
    v_sub_f32 v150, v150, v53
    v_sub_f32 v151, v151, v53
    v_sub_f32 v152, v152, v54
    v_sub_f32 v153, v153, v54
    v_sub_f32 v154, v154, v54
    v_sub_f32 v155, v155, v54
    v_sub_f32 v156, v156, v55
    v_sub_f32 v157, v157, v55
    v_sub_f32 v158, v158, v55
    v_sub_f32 v159, v159, v55
    v_sub_f32 v160, v160, v52
    v_sub_f32 v16, v16, v52
    v_sub_f32 v161, v161, v52
    v_sub_f32 v17, v17, v52
    v_sub_f32 v162, v162, v52
    v_sub_f32 v18, v18, v52
    v_sub_f32 v163, v163, v52
    v_sub_f32 v19, v19, v52
    v_sub_f32 v164, v164, v53
    v_sub_f32 v20, v20, v53
    v_sub_f32 v165, v165, v53
    v_sub_f32 v21, v21, v53
    v_sub_f32 v166, v166, v53
    v_sub_f32 v22, v22, v53
    v_sub_f32 v167, v167, v53
    v_sub_f32 v23, v23, v53
    v_sub_f32 v168, v168, v54
    v_sub_f32 v24, v24, v54
    v_sub_f32 v169, v169, v54
    v_sub_f32 v25, v25, v54
    v_sub_f32 v170, v170, v54
    v_sub_f32 v26, v26, v54
    v_sub_f32 v171, v171, v54
    v_sub_f32 v27, v27, v54
    v_sub_f32 v172, v172, v55
    v_sub_f32 v28, v28, v55
    v_sub_f32 v173, v173, v55
    v_sub_f32 v29, v29, v55
    v_sub_f32 v174, v174, v55
    v_sub_f32 v30, v30, v55
    v_sub_f32 v175, v175, v55
    v_sub_f32 v31, v31, v55
    v_sub_f32 v176, v176, v52
    v_sub_f32 v32, v32, v52
    v_sub_f32 v177, v177, v52
    v_sub_f32 v33, v33, v52
    v_sub_f32 v178, v178, v52
    v_sub_f32 v34, v34, v52
    v_sub_f32 v179, v179, v52
    v_sub_f32 v35, v35, v52
    v_sub_f32 v180, v180, v53
    v_sub_f32 v36, v36, v53
    v_sub_f32 v181, v181, v53
    v_sub_f32 v37, v37, v53
    v_sub_f32 v182, v182, v53
    v_sub_f32 v38, v38, v53
    v_sub_f32 v183, v183, v53
    v_sub_f32 v39, v39, v53
    v_sub_f32 v184, v184, v54
    v_sub_f32 v40, v40, v54
    v_sub_f32 v185, v185, v54
    v_sub_f32 v41, v41, v54
    v_sub_f32 v186, v186, v54
    v_sub_f32 v42, v42, v54
    v_sub_f32 v187, v187, v54
    v_sub_f32 v43, v43, v54
    v_sub_f32 v188, v188, v55
    v_sub_f32 v44, v44, v55
    v_sub_f32 v189, v189, v55
    v_sub_f32 v45, v45, v55
    v_sub_f32 v190, v190, v55
    v_sub_f32 v46, v46, v55
    v_sub_f32 v191, v191, v55
    v_sub_f32 v47, v47, v55
    v_sub_f32 v8, v8, v52
    v_exp_f32 v52, -v52
    v_sub_f32 v9, v9, v53
    v_exp_f32 v53, -v53
    v_sub_f32 v10, v10, v54
    v_exp_f32 v54, -v54
    v_sub_f32 v11, v11, v55
    v_exp_f32 v55, -v55
    s_nop 0
    v_mul_f32 v12, v12, v52
    v_mul_f32 v13, v13, v53
    v_mul_f32 v14, v14, v54
    v_mul_f32 v15, v15, v55
    v_accvgpr_read_b32 v224, a0
    v_accvgpr_read_b32 v225, a1
    v_accvgpr_read_b32 v226, a2
    v_accvgpr_read_b32 v227, a3
    v_mul_f32 v224, v224, v52
    v_mul_f32 v225, v225, v52
    v_mul_f32 v226, v226, v52
    v_mul_f32 v227, v227, v52
    v_accvgpr_write_b32 a0, v224
    v_accvgpr_write_b32 a1, v225
    v_accvgpr_write_b32 a2, v226
    v_accvgpr_write_b32 a3, v227
    v_accvgpr_read_b32 v224, a4
    v_accvgpr_read_b32 v225, a5
    v_accvgpr_read_b32 v226, a6
    v_accvgpr_read_b32 v227, a7
    v_mul_f32 v224, v224, v53
    v_mul_f32 v225, v225, v53
    v_mul_f32 v226, v226, v53
    v_mul_f32 v227, v227, v53
    v_accvgpr_write_b32 a4, v224
    v_accvgpr_write_b32 a5, v225
    v_accvgpr_write_b32 a6, v226
    v_accvgpr_write_b32 a7, v227
    v_accvgpr_read_b32 v224, a8
    v_accvgpr_read_b32 v225, a9
    v_accvgpr_read_b32 v226, a10
    v_accvgpr_read_b32 v227, a11
    v_mul_f32 v224, v224, v54
    v_mul_f32 v225, v225, v54
    v_mul_f32 v226, v226, v54
    v_mul_f32 v227, v227, v54
    v_accvgpr_write_b32 a8, v224
    v_accvgpr_write_b32 a9, v225
    v_accvgpr_write_b32 a10, v226
    v_accvgpr_write_b32 a11, v227
    v_accvgpr_read_b32 v224, a12
    v_accvgpr_read_b32 v225, a13
    v_accvgpr_read_b32 v226, a14
    v_accvgpr_read_b32 v227, a15
    v_mul_f32 v224, v224, v55
    v_mul_f32 v225, v225, v55
    v_mul_f32 v226, v226, v55
    v_mul_f32 v227, v227, v55
    v_accvgpr_write_b32 a12, v224
    v_accvgpr_write_b32 a13, v225
    v_accvgpr_write_b32 a14, v226
    v_accvgpr_write_b32 a15, v227
    v_accvgpr_read_b32 v224, a16
    v_accvgpr_read_b32 v225, a17
    v_accvgpr_read_b32 v226, a18
    v_accvgpr_read_b32 v227, a19
    v_mul_f32 v224, v224, v52
    v_mul_f32 v225, v225, v52
    v_mul_f32 v226, v226, v52
    v_mul_f32 v227, v227, v52
    v_accvgpr_write_b32 a16, v224
    v_accvgpr_write_b32 a17, v225
    v_accvgpr_write_b32 a18, v226
    v_accvgpr_write_b32 a19, v227
    v_accvgpr_read_b32 v224, a20
    v_accvgpr_read_b32 v225, a21
    v_accvgpr_read_b32 v226, a22
    v_accvgpr_read_b32 v227, a23
    v_mul_f32 v224, v224, v53
    v_mul_f32 v225, v225, v53
    v_mul_f32 v226, v226, v53
    v_mul_f32 v227, v227, v53
    v_accvgpr_write_b32 a20, v224
    v_accvgpr_write_b32 a21, v225
    v_accvgpr_write_b32 a22, v226
    v_accvgpr_write_b32 a23, v227
    v_accvgpr_read_b32 v224, a24
    v_accvgpr_read_b32 v225, a25
    v_accvgpr_read_b32 v226, a26
    v_accvgpr_read_b32 v227, a27
    v_mul_f32 v224, v224, v54
    v_mul_f32 v225, v225, v54
    v_mul_f32 v226, v226, v54
    v_mul_f32 v227, v227, v54
    v_accvgpr_write_b32 a24, v224
    v_accvgpr_write_b32 a25, v225
    v_accvgpr_write_b32 a26, v226
    v_accvgpr_write_b32 a27, v227
    v_accvgpr_read_b32 v224, a28
    v_accvgpr_read_b32 v225, a29
    v_accvgpr_read_b32 v226, a30
    v_accvgpr_read_b32 v227, a31
    v_mul_f32 v224, v224, v55
    v_mul_f32 v225, v225, v55
    v_mul_f32 v226, v226, v55
    v_mul_f32 v227, v227, v55
    v_accvgpr_write_b32 a28, v224
    v_accvgpr_write_b32 a29, v225
    v_accvgpr_write_b32 a30, v226
    v_accvgpr_write_b32 a31, v227
    v_accvgpr_read_b32 v224, a32
    v_accvgpr_read_b32 v225, a33
    v_accvgpr_read_b32 v226, a34
    v_accvgpr_read_b32 v227, a35
    v_mul_f32 v224, v224, v52
    v_mul_f32 v225, v225, v52
    v_mul_f32 v226, v226, v52
    v_mul_f32 v227, v227, v52
    v_accvgpr_write_b32 a32, v224
    v_accvgpr_write_b32 a33, v225
    v_accvgpr_write_b32 a34, v226
    v_accvgpr_write_b32 a35, v227
    v_accvgpr_read_b32 v224, a36
    v_accvgpr_read_b32 v225, a37
    v_accvgpr_read_b32 v226, a38
    v_accvgpr_read_b32 v227, a39
    v_mul_f32 v224, v224, v53
    v_mul_f32 v225, v225, v53
    v_mul_f32 v226, v226, v53
    v_mul_f32 v227, v227, v53
    v_accvgpr_write_b32 a36, v224
    v_accvgpr_write_b32 a37, v225
    v_accvgpr_write_b32 a38, v226
    v_accvgpr_write_b32 a39, v227
    v_accvgpr_read_b32 v224, a40
    v_accvgpr_read_b32 v225, a41
    v_accvgpr_read_b32 v226, a42
    v_accvgpr_read_b32 v227, a43
    v_mul_f32 v224, v224, v54
    v_mul_f32 v225, v225, v54
    v_mul_f32 v226, v226, v54
    v_mul_f32 v227, v227, v54
    v_accvgpr_write_b32 a40, v224
    v_accvgpr_write_b32 a41, v225
    v_accvgpr_write_b32 a42, v226
    v_accvgpr_write_b32 a43, v227
    v_accvgpr_read_b32 v224, a44
    v_accvgpr_read_b32 v225, a45
    v_accvgpr_read_b32 v226, a46
    v_accvgpr_read_b32 v227, a47
    v_mul_f32 v224, v224, v55
    v_mul_f32 v225, v225, v55
    v_mul_f32 v226, v226, v55
    v_mul_f32 v227, v227, v55
    v_accvgpr_write_b32 a44, v224
    v_accvgpr_write_b32 a45, v225
    v_accvgpr_write_b32 a46, v226
    v_accvgpr_write_b32 a47, v227
    v_accvgpr_read_b32 v224, a48
    v_accvgpr_read_b32 v225, a49
    v_accvgpr_read_b32 v226, a50
    v_accvgpr_read_b32 v227, a51
    v_mul_f32 v224, v224, v52
    v_mul_f32 v225, v225, v52
    v_mul_f32 v226, v226, v52
    v_mul_f32 v227, v227, v52
    v_accvgpr_write_b32 a48, v224
    v_accvgpr_write_b32 a49, v225
    v_accvgpr_write_b32 a50, v226
    v_accvgpr_write_b32 a51, v227
    v_accvgpr_read_b32 v224, a52
    v_accvgpr_read_b32 v225, a53
    v_accvgpr_read_b32 v226, a54
    v_accvgpr_read_b32 v227, a55
    v_mul_f32 v224, v224, v53
    v_mul_f32 v225, v225, v53
    v_mul_f32 v226, v226, v53
    v_mul_f32 v227, v227, v53
    v_accvgpr_write_b32 a52, v224
    v_accvgpr_write_b32 a53, v225
    v_accvgpr_write_b32 a54, v226
    v_accvgpr_write_b32 a55, v227
    v_accvgpr_read_b32 v224, a56
    v_accvgpr_read_b32 v225, a57
    v_accvgpr_read_b32 v226, a58
    v_accvgpr_read_b32 v227, a59
    v_mul_f32 v224, v224, v54
    v_mul_f32 v225, v225, v54
    v_mul_f32 v226, v226, v54
    v_mul_f32 v227, v227, v54
    v_accvgpr_write_b32 a56, v224
    v_accvgpr_write_b32 a57, v225
    v_accvgpr_write_b32 a58, v226
    v_accvgpr_write_b32 a59, v227
    v_accvgpr_read_b32 v224, a60
    v_accvgpr_read_b32 v225, a61
    v_accvgpr_read_b32 v226, a62
    v_accvgpr_read_b32 v227, a63
    v_mul_f32 v224, v224, v55
    v_mul_f32 v225, v225, v55
    v_mul_f32 v226, v226, v55
    v_mul_f32 v227, v227, v55
    v_accvgpr_write_b32 a60, v224
    v_accvgpr_write_b32 a61, v225
    v_accvgpr_write_b32 a62, v226
    v_accvgpr_write_b32 a63, v227
    v_accvgpr_read_b32 v224, a64
    v_accvgpr_read_b32 v225, a65
    v_accvgpr_read_b32 v226, a66
    v_accvgpr_read_b32 v227, a67
    v_mul_f32 v224, v224, v52
    v_mul_f32 v225, v225, v52
    v_mul_f32 v226, v226, v52
    v_mul_f32 v227, v227, v52
    v_accvgpr_write_b32 a64, v224
    v_accvgpr_write_b32 a65, v225
    v_accvgpr_write_b32 a66, v226
    v_accvgpr_write_b32 a67, v227
    v_accvgpr_read_b32 v224, a68
    v_accvgpr_read_b32 v225, a69
    v_accvgpr_read_b32 v226, a70
    v_accvgpr_read_b32 v227, a71
    v_mul_f32 v224, v224, v53
    v_mul_f32 v225, v225, v53
    v_mul_f32 v226, v226, v53
    v_mul_f32 v227, v227, v53
    v_accvgpr_write_b32 a68, v224
    v_accvgpr_write_b32 a69, v225
    v_accvgpr_write_b32 a70, v226
    v_accvgpr_write_b32 a71, v227
    v_accvgpr_read_b32 v224, a72
    v_accvgpr_read_b32 v225, a73
    v_accvgpr_read_b32 v226, a74
    v_accvgpr_read_b32 v227, a75
    v_mul_f32 v224, v224, v54
    v_mul_f32 v225, v225, v54
    v_mul_f32 v226, v226, v54
    v_mul_f32 v227, v227, v54
    v_accvgpr_write_b32 a72, v224
    v_accvgpr_write_b32 a73, v225
    v_accvgpr_write_b32 a74, v226
    v_accvgpr_write_b32 a75, v227
    v_accvgpr_read_b32 v224, a76
    v_accvgpr_read_b32 v225, a77
    v_accvgpr_read_b32 v226, a78
    v_accvgpr_read_b32 v227, a79
    v_mul_f32 v224, v224, v55
    v_mul_f32 v225, v225, v55
    v_mul_f32 v226, v226, v55
    v_mul_f32 v227, v227, v55
    v_accvgpr_write_b32 a76, v224
    v_accvgpr_write_b32 a77, v225
    v_accvgpr_write_b32 a78, v226
    v_accvgpr_write_b32 a79, v227
    v_accvgpr_read_b32 v224, a80
    v_accvgpr_read_b32 v225, a81
    v_accvgpr_read_b32 v226, a82
    v_accvgpr_read_b32 v227, a83
    v_mul_f32 v224, v224, v52
    v_mul_f32 v225, v225, v52
    v_mul_f32 v226, v226, v52
    v_mul_f32 v227, v227, v52
    v_accvgpr_write_b32 a80, v224
    v_accvgpr_write_b32 a81, v225
    v_accvgpr_write_b32 a82, v226
    v_accvgpr_write_b32 a83, v227
    v_accvgpr_read_b32 v224, a84
    v_accvgpr_read_b32 v225, a85
    v_accvgpr_read_b32 v226, a86
    v_accvgpr_read_b32 v227, a87
    v_mul_f32 v224, v224, v53
    v_mul_f32 v225, v225, v53
    v_mul_f32 v226, v226, v53
    v_mul_f32 v227, v227, v53
    v_accvgpr_write_b32 a84, v224
    v_accvgpr_write_b32 a85, v225
    v_accvgpr_write_b32 a86, v226
    v_accvgpr_write_b32 a87, v227
    v_accvgpr_read_b32 v224, a88
    v_accvgpr_read_b32 v225, a89
    v_accvgpr_read_b32 v226, a90
    v_accvgpr_read_b32 v227, a91
    v_mul_f32 v224, v224, v54
    v_mul_f32 v225, v225, v54
    v_mul_f32 v226, v226, v54
    v_mul_f32 v227, v227, v54
    v_accvgpr_write_b32 a88, v224
    v_accvgpr_write_b32 a89, v225
    v_accvgpr_write_b32 a90, v226
    v_accvgpr_write_b32 a91, v227
    v_accvgpr_read_b32 v224, a92
    v_accvgpr_read_b32 v225, a93
    v_accvgpr_read_b32 v226, a94
    v_accvgpr_read_b32 v227, a95
    v_mul_f32 v224, v224, v55
    v_mul_f32 v225, v225, v55
    v_mul_f32 v226, v226, v55
    v_mul_f32 v227, v227, v55
    v_accvgpr_write_b32 a92, v224
    v_accvgpr_write_b32 a93, v225
    v_accvgpr_write_b32 a94, v226
    v_accvgpr_write_b32 a95, v227
    v_accvgpr_read_b32 v224, a96
    v_accvgpr_read_b32 v225, a97
    v_accvgpr_read_b32 v226, a98
    v_accvgpr_read_b32 v227, a99
    v_mul_f32 v224, v224, v52
    v_mul_f32 v225, v225, v52
    v_mul_f32 v226, v226, v52
    v_mul_f32 v227, v227, v52
    v_accvgpr_write_b32 a96, v224
    v_accvgpr_write_b32 a97, v225
    v_accvgpr_write_b32 a98, v226
    v_accvgpr_write_b32 a99, v227
    v_accvgpr_read_b32 v224, a100
    v_accvgpr_read_b32 v225, a101
    v_accvgpr_read_b32 v226, a102
    v_accvgpr_read_b32 v227, a103
    v_mul_f32 v224, v224, v53
    v_mul_f32 v225, v225, v53
    v_mul_f32 v226, v226, v53
    v_mul_f32 v227, v227, v53
    v_accvgpr_write_b32 a100, v224
    v_accvgpr_write_b32 a101, v225
    v_accvgpr_write_b32 a102, v226
    v_accvgpr_write_b32 a103, v227
    v_accvgpr_read_b32 v224, a104
    v_accvgpr_read_b32 v225, a105
    v_accvgpr_read_b32 v226, a106
    v_accvgpr_read_b32 v227, a107
    v_mul_f32 v224, v224, v54
    v_mul_f32 v225, v225, v54
    v_mul_f32 v226, v226, v54
    v_mul_f32 v227, v227, v54
    v_accvgpr_write_b32 a104, v224
    v_accvgpr_write_b32 a105, v225
    v_accvgpr_write_b32 a106, v226
    v_accvgpr_write_b32 a107, v227
    v_accvgpr_read_b32 v224, a108
    v_accvgpr_read_b32 v225, a109
    v_accvgpr_read_b32 v226, a110
    v_accvgpr_read_b32 v227, a111
    v_mul_f32 v224, v224, v55
    v_mul_f32 v225, v225, v55
    v_mul_f32 v226, v226, v55
    v_mul_f32 v227, v227, v55
    v_accvgpr_write_b32 a108, v224
    v_accvgpr_write_b32 a109, v225
    v_accvgpr_write_b32 a110, v226
    v_accvgpr_write_b32 a111, v227
    v_accvgpr_read_b32 v224, a112
    v_accvgpr_read_b32 v225, a113
    v_accvgpr_read_b32 v226, a114
    v_accvgpr_read_b32 v227, a115
    v_mul_f32 v224, v224, v52
    v_mul_f32 v225, v225, v52
    v_mul_f32 v226, v226, v52
    v_mul_f32 v227, v227, v52
    v_accvgpr_write_b32 a112, v224
    v_accvgpr_write_b32 a113, v225
    v_accvgpr_write_b32 a114, v226
    v_accvgpr_write_b32 a115, v227
    v_accvgpr_read_b32 v224, a116
    v_accvgpr_read_b32 v225, a117
    v_accvgpr_read_b32 v226, a118
    v_accvgpr_read_b32 v227, a119
    v_mul_f32 v224, v224, v53
    v_mul_f32 v225, v225, v53
    v_mul_f32 v226, v226, v53
    v_mul_f32 v227, v227, v53
    v_accvgpr_write_b32 a116, v224
    v_accvgpr_write_b32 a117, v225
    v_accvgpr_write_b32 a118, v226
    v_accvgpr_write_b32 a119, v227
    v_accvgpr_read_b32 v224, a120
    v_accvgpr_read_b32 v225, a121
    v_accvgpr_read_b32 v226, a122
    v_accvgpr_read_b32 v227, a123
    v_mul_f32 v224, v224, v54
    v_mul_f32 v225, v225, v54
    v_mul_f32 v226, v226, v54
    v_mul_f32 v227, v227, v54
    v_accvgpr_write_b32 a120, v224
    v_accvgpr_write_b32 a121, v225
    v_accvgpr_write_b32 a122, v226
    v_accvgpr_write_b32 a123, v227
    v_accvgpr_read_b32 v224, a124
    v_accvgpr_read_b32 v225, a125
    v_accvgpr_read_b32 v226, a126
    v_accvgpr_read_b32 v227, a127
    v_mul_f32 v224, v224, v55
    v_mul_f32 v225, v225, v55
    v_mul_f32 v226, v226, v55
    v_mul_f32 v227, v227, v55
    v_accvgpr_write_b32 a124, v224
    v_accvgpr_write_b32 a125, v225
    v_accvgpr_write_b32 a126, v226
    v_accvgpr_write_b32 a127, v227
    v_exp_f32 v56, v128
    v_exp_f32 v57, v129
    v_exp_f32 v58, v130
    v_exp_f32 v59, v131
    v_add_f32 v48, v56, v57
    v_cvt_pk_bf16_f32 v192, v56, v57
    v_exp_f32 v60, v144
    v_exp_f32 v61, v145
    v_add_f32 v48, v48, v58
    v_add_f32 v48, v48, v59
    v_cvt_pk_bf16_f32 v193, v58, v59
    v_exp_f32 v62, v146
    v_exp_f32 v63, v147
    v_add_f32 v48, v48, v60
    v_add_f32 v48, v48, v61
    v_cvt_pk_bf16_f32 v194, v60, v61
    v_exp_f32 v56, v132
    v_exp_f32 v57, v133
    v_add_f32 v48, v48, v62
    v_add_f32 v48, v48, v63
    v_cvt_pk_bf16_f32 v195, v62, v63
    v_exp_f32 v58, v134
    v_exp_f32 v59, v135
    v_add_f32 v49, v56, v57
    v_cvt_pk_bf16_f32 v196, v56, v57
    v_exp_f32 v60, v148
    v_exp_f32 v61, v149
    v_add_f32 v49, v49, v58
    v_add_f32 v49, v49, v59
    v_cvt_pk_bf16_f32 v197, v58, v59
    v_exp_f32 v62, v150
    v_exp_f32 v63, v151
    v_add_f32 v49, v49, v60
    v_add_f32 v49, v49, v61
    v_cvt_pk_bf16_f32 v198, v60, v61
    v_exp_f32 v56, v136
    v_exp_f32 v57, v137
    v_add_f32 v49, v49, v62
    v_add_f32 v49, v49, v63
    v_cvt_pk_bf16_f32 v199, v62, v63
    v_exp_f32 v58, v138
    v_exp_f32 v59, v139
    v_add_f32 v50, v56, v57
    v_cvt_pk_bf16_f32 v200, v56, v57
    v_exp_f32 v60, v152
    v_exp_f32 v61, v153
    v_add_f32 v50, v50, v58
    v_add_f32 v50, v50, v59
    v_cvt_pk_bf16_f32 v201, v58, v59
    v_exp_f32 v62, v154
    v_exp_f32 v63, v155
    v_add_f32 v50, v50, v60
    v_add_f32 v50, v50, v61
    v_cvt_pk_bf16_f32 v202, v60, v61
    v_exp_f32 v56, v140
    v_exp_f32 v57, v141
    v_add_f32 v50, v50, v62
    v_add_f32 v50, v50, v63
    v_cvt_pk_bf16_f32 v203, v62, v63
    v_exp_f32 v58, v142
    v_exp_f32 v59, v143
    v_add_f32 v51, v56, v57
    v_cvt_pk_bf16_f32 v204, v56, v57
    v_exp_f32 v60, v156
    v_exp_f32 v61, v157
    v_add_f32 v51, v51, v58
    v_add_f32 v51, v51, v59
    v_cvt_pk_bf16_f32 v205, v58, v59
    v_exp_f32 v62, v158
    v_exp_f32 v63, v159
    v_add_f32 v51, v51, v60
    v_add_f32 v51, v51, v61
    v_cvt_pk_bf16_f32 v206, v60, v61
    s_nop 0
    v_add_f32 v51, v51, v62
    v_add_f32 v51, v51, v63
    v_cvt_pk_bf16_f32 v207, v62, v63
    s_nop 1
    s_branch k2_ret_18
k2_rare_19:
    s_nop 7
    v_max_f32 v52, v160, v161
    v_max3_f32 v52, v52, v162, v163
    v_max3_f32 v52, v52, v176, v177
    v_max3_f32 v52, v52, v178, v179
    v_mov_b32 v6, v52
    s_nop 1
    v_permlane16_swap_b32 v52, v6
    s_nop 1
    v_max_f32 v52, v52, v6
    v_mov_b32 v6, v52
    s_nop 1
    v_permlane32_swap_b32 v52, v6
    s_nop 1
    v_max_f32 v52, v52, v6
    v_max_f32 v52, 0, v52
    v_max_f32 v53, v164, v165
    v_max3_f32 v53, v53, v166, v167
    v_max3_f32 v53, v53, v180, v181
    v_max3_f32 v53, v53, v182, v183
    v_mov_b32 v6, v53
    s_nop 1
    v_permlane16_swap_b32 v53, v6
    s_nop 1
    v_max_f32 v53, v53, v6
    v_mov_b32 v6, v53
    s_nop 1
    v_permlane32_swap_b32 v53, v6
    s_nop 1
    v_max_f32 v53, v53, v6
    v_max_f32 v53, 0, v53
    v_max_f32 v54, v168, v169
    v_max3_f32 v54, v54, v170, v171
    v_max3_f32 v54, v54, v184, v185
    v_max3_f32 v54, v54, v186, v187
    v_mov_b32 v6, v54
    s_nop 1
    v_permlane16_swap_b32 v54, v6
    s_nop 1
    v_max_f32 v54, v54, v6
    v_mov_b32 v6, v54
    s_nop 1
    v_permlane32_swap_b32 v54, v6
    s_nop 1
    v_max_f32 v54, v54, v6
    v_max_f32 v54, 0, v54
    v_max_f32 v55, v172, v173
    v_max3_f32 v55, v55, v174, v175
    v_max3_f32 v55, v55, v188, v189
    v_max3_f32 v55, v55, v190, v191
    v_mov_b32 v6, v55
    s_nop 1
    v_permlane16_swap_b32 v55, v6
    s_nop 1
    v_max_f32 v55, v55, v6
    v_mov_b32 v6, v55
    s_nop 1
    v_permlane32_swap_b32 v55, v6
    s_nop 1
    v_max_f32 v55, v55, v6
    v_max_f32 v55, 0, v55
    v_sub_f32 v160, v160, v52
    v_sub_f32 v161, v161, v52
    v_sub_f32 v162, v162, v52
    v_sub_f32 v163, v163, v52
    v_sub_f32 v164, v164, v53
    v_sub_f32 v165, v165, v53
    v_sub_f32 v166, v166, v53
    v_sub_f32 v167, v167, v53
    v_sub_f32 v168, v168, v54
    v_sub_f32 v169, v169, v54
    v_sub_f32 v170, v170, v54
    v_sub_f32 v171, v171, v54
    v_sub_f32 v172, v172, v55
    v_sub_f32 v173, v173, v55
    v_sub_f32 v174, v174, v55
    v_sub_f32 v175, v175, v55
    v_sub_f32 v176, v176, v52
    v_sub_f32 v177, v177, v52
    v_sub_f32 v178, v178, v52
    v_sub_f32 v179, v179, v52
    v_sub_f32 v180, v180, v53
    v_sub_f32 v181, v181, v53
    v_sub_f32 v182, v182, v53
    v_sub_f32 v183, v183, v53
    v_sub_f32 v184, v184, v54
    v_sub_f32 v185, v185, v54
    v_sub_f32 v186, v186, v54
    v_sub_f32 v187, v187, v54
    v_sub_f32 v188, v188, v55
    v_sub_f32 v189, v189, v55
    v_sub_f32 v190, v190, v55
    v_sub_f32 v191, v191, v55
    v_sub_f32 v128, v128, v54
    v_sub_f32 v16, v16, v54
    v_sub_f32 v129, v129, v54
    v_sub_f32 v17, v17, v54
    v_sub_f32 v130, v130, v54
    v_sub_f32 v18, v18, v54
    v_sub_f32 v131, v131, v54
    v_sub_f32 v19, v19, v54
    v_sub_f32 v132, v132, v55
    v_sub_f32 v20, v20, v55
    v_sub_f32 v133, v133, v55
    v_sub_f32 v21, v21, v55
    v_sub_f32 v134, v134, v55
    v_sub_f32 v22, v22, v55
    v_sub_f32 v135, v135, v55
    v_sub_f32 v23, v23, v55
    v_sub_f32 v136, v136, v54
    v_sub_f32 v24, v24, v54
    v_sub_f32 v137, v137, v54
    v_sub_f32 v25, v25, v54
    v_sub_f32 v138, v138, v54
    v_sub_f32 v26, v26, v54
    v_sub_f32 v139, v139, v54
    v_sub_f32 v27, v27, v54
    v_sub_f32 v140, v140, v55
    v_sub_f32 v28, v28, v55
    v_sub_f32 v141, v141, v55
    v_sub_f32 v29, v29, v55
    v_sub_f32 v142, v142, v55
    v_sub_f32 v30, v30, v55
    v_sub_f32 v143, v143, v55
    v_sub_f32 v31, v31, v55
    v_sub_f32 v144, v144, v54
    v_sub_f32 v32, v32, v54
    v_sub_f32 v145, v145, v54
    v_sub_f32 v33, v33, v54
    v_sub_f32 v146, v146, v54
    v_sub_f32 v34, v34, v54
    v_sub_f32 v147, v147, v54
    v_sub_f32 v35, v35, v54
    v_sub_f32 v148, v148, v55
    v_sub_f32 v36, v36, v55
    v_sub_f32 v149, v149, v55
    v_sub_f32 v37, v37, v55
    v_sub_f32 v150, v150, v55
    v_sub_f32 v38, v38, v55
    v_sub_f32 v151, v151, v55
    v_sub_f32 v39, v39, v55
    v_sub_f32 v152, v152, v54
    v_sub_f32 v40, v40, v54
    v_sub_f32 v153, v153, v54
    v_sub_f32 v41, v41, v54
    v_sub_f32 v154, v154, v54
    v_sub_f32 v42, v42, v54
    v_sub_f32 v155, v155, v54
    v_sub_f32 v43, v43, v54
    v_sub_f32 v156, v156, v55
    v_sub_f32 v44, v44, v55
    v_sub_f32 v157, v157, v55
    v_sub_f32 v45, v45, v55
    v_sub_f32 v158, v158, v55
    v_sub_f32 v46, v46, v55
    v_sub_f32 v159, v159, v55
    v_sub_f32 v47, v47, v55
    v_sub_f32 v8, v8, v52
    v_exp_f32 v52, -v52
    v_sub_f32 v9, v9, v53
    v_exp_f32 v53, -v53
    v_sub_f32 v10, v10, v54
    v_exp_f32 v54, -v54
    v_sub_f32 v11, v11, v55
    v_exp_f32 v55, -v55
    s_nop 0
    v_mul_f32 v12, v12, v52
    v_mul_f32 v13, v13, v53
    v_mul_f32 v14, v14, v54
    v_mul_f32 v15, v15, v55
    v_accvgpr_read_b32 v224, a0
    v_accvgpr_read_b32 v225, a1
    v_accvgpr_read_b32 v226, a2
    v_accvgpr_read_b32 v227, a3
    v_mul_f32 v224, v224, v52
    v_mul_f32 v225, v225, v52
    v_mul_f32 v226, v226, v52
    v_mul_f32 v227, v227, v52
    v_accvgpr_write_b32 a0, v224
    v_accvgpr_write_b32 a1, v225
    v_accvgpr_write_b32 a2, v226
    v_accvgpr_write_b32 a3, v227
    v_accvgpr_read_b32 v224, a4
    v_accvgpr_read_b32 v225, a5
    v_accvgpr_read_b32 v226, a6
    v_accvgpr_read_b32 v227, a7
    v_mul_f32 v224, v224, v53
    v_mul_f32 v225, v225, v53
    v_mul_f32 v226, v226, v53
    v_mul_f32 v227, v227, v53
    v_accvgpr_write_b32 a4, v224
    v_accvgpr_write_b32 a5, v225
    v_accvgpr_write_b32 a6, v226
    v_accvgpr_write_b32 a7, v227
    v_accvgpr_read_b32 v224, a8
    v_accvgpr_read_b32 v225, a9
    v_accvgpr_read_b32 v226, a10
    v_accvgpr_read_b32 v227, a11
    v_mul_f32 v224, v224, v54
    v_mul_f32 v225, v225, v54
    v_mul_f32 v226, v226, v54
    v_mul_f32 v227, v227, v54
    v_accvgpr_write_b32 a8, v224
    v_accvgpr_write_b32 a9, v225
    v_accvgpr_write_b32 a10, v226
    v_accvgpr_write_b32 a11, v227
    v_accvgpr_read_b32 v224, a12
    v_accvgpr_read_b32 v225, a13
    v_accvgpr_read_b32 v226, a14
    v_accvgpr_read_b32 v227, a15
    v_mul_f32 v224, v224, v55
    v_mul_f32 v225, v225, v55
    v_mul_f32 v226, v226, v55
    v_mul_f32 v227, v227, v55
    v_accvgpr_write_b32 a12, v224
    v_accvgpr_write_b32 a13, v225
    v_accvgpr_write_b32 a14, v226
    v_accvgpr_write_b32 a15, v227
    v_accvgpr_read_b32 v224, a16
    v_accvgpr_read_b32 v225, a17
    v_accvgpr_read_b32 v226, a18
    v_accvgpr_read_b32 v227, a19
    v_mul_f32 v224, v224, v52
    v_mul_f32 v225, v225, v52
    v_mul_f32 v226, v226, v52
    v_mul_f32 v227, v227, v52
    v_accvgpr_write_b32 a16, v224
    v_accvgpr_write_b32 a17, v225
    v_accvgpr_write_b32 a18, v226
    v_accvgpr_write_b32 a19, v227
    v_accvgpr_read_b32 v224, a20
    v_accvgpr_read_b32 v225, a21
    v_accvgpr_read_b32 v226, a22
    v_accvgpr_read_b32 v227, a23
    v_mul_f32 v224, v224, v53
    v_mul_f32 v225, v225, v53
    v_mul_f32 v226, v226, v53
    v_mul_f32 v227, v227, v53
    v_accvgpr_write_b32 a20, v224
    v_accvgpr_write_b32 a21, v225
    v_accvgpr_write_b32 a22, v226
    v_accvgpr_write_b32 a23, v227
    v_accvgpr_read_b32 v224, a24
    v_accvgpr_read_b32 v225, a25
    v_accvgpr_read_b32 v226, a26
    v_accvgpr_read_b32 v227, a27
    v_mul_f32 v224, v224, v54
    v_mul_f32 v225, v225, v54
    v_mul_f32 v226, v226, v54
    v_mul_f32 v227, v227, v54
    v_accvgpr_write_b32 a24, v224
    v_accvgpr_write_b32 a25, v225
    v_accvgpr_write_b32 a26, v226
    v_accvgpr_write_b32 a27, v227
    v_accvgpr_read_b32 v224, a28
    v_accvgpr_read_b32 v225, a29
    v_accvgpr_read_b32 v226, a30
    v_accvgpr_read_b32 v227, a31
    v_mul_f32 v224, v224, v55
    v_mul_f32 v225, v225, v55
    v_mul_f32 v226, v226, v55
    v_mul_f32 v227, v227, v55
    v_accvgpr_write_b32 a28, v224
    v_accvgpr_write_b32 a29, v225
    v_accvgpr_write_b32 a30, v226
    v_accvgpr_write_b32 a31, v227
    v_accvgpr_read_b32 v224, a32
    v_accvgpr_read_b32 v225, a33
    v_accvgpr_read_b32 v226, a34
    v_accvgpr_read_b32 v227, a35
    v_mul_f32 v224, v224, v52
    v_mul_f32 v225, v225, v52
    v_mul_f32 v226, v226, v52
    v_mul_f32 v227, v227, v52
    v_accvgpr_write_b32 a32, v224
    v_accvgpr_write_b32 a33, v225
    v_accvgpr_write_b32 a34, v226
    v_accvgpr_write_b32 a35, v227
    v_accvgpr_read_b32 v224, a36
    v_accvgpr_read_b32 v225, a37
    v_accvgpr_read_b32 v226, a38
    v_accvgpr_read_b32 v227, a39
    v_mul_f32 v224, v224, v53
    v_mul_f32 v225, v225, v53
    v_mul_f32 v226, v226, v53
    v_mul_f32 v227, v227, v53
    v_accvgpr_write_b32 a36, v224
    v_accvgpr_write_b32 a37, v225
    v_accvgpr_write_b32 a38, v226
    v_accvgpr_write_b32 a39, v227
    v_accvgpr_read_b32 v224, a40
    v_accvgpr_read_b32 v225, a41
    v_accvgpr_read_b32 v226, a42
    v_accvgpr_read_b32 v227, a43
    v_mul_f32 v224, v224, v54
    v_mul_f32 v225, v225, v54
    v_mul_f32 v226, v226, v54
    v_mul_f32 v227, v227, v54
    v_accvgpr_write_b32 a40, v224
    v_accvgpr_write_b32 a41, v225
    v_accvgpr_write_b32 a42, v226
    v_accvgpr_write_b32 a43, v227
    v_accvgpr_read_b32 v224, a44
    v_accvgpr_read_b32 v225, a45
    v_accvgpr_read_b32 v226, a46
    v_accvgpr_read_b32 v227, a47
    v_mul_f32 v224, v224, v55
    v_mul_f32 v225, v225, v55
    v_mul_f32 v226, v226, v55
    v_mul_f32 v227, v227, v55
    v_accvgpr_write_b32 a44, v224
    v_accvgpr_write_b32 a45, v225
    v_accvgpr_write_b32 a46, v226
    v_accvgpr_write_b32 a47, v227
    v_accvgpr_read_b32 v224, a48
    v_accvgpr_read_b32 v225, a49
    v_accvgpr_read_b32 v226, a50
    v_accvgpr_read_b32 v227, a51
    v_mul_f32 v224, v224, v52
    v_mul_f32 v225, v225, v52
    v_mul_f32 v226, v226, v52
    v_mul_f32 v227, v227, v52
    v_accvgpr_write_b32 a48, v224
    v_accvgpr_write_b32 a49, v225
    v_accvgpr_write_b32 a50, v226
    v_accvgpr_write_b32 a51, v227
    v_accvgpr_read_b32 v224, a52
    v_accvgpr_read_b32 v225, a53
    v_accvgpr_read_b32 v226, a54
    v_accvgpr_read_b32 v227, a55
    v_mul_f32 v224, v224, v53
    v_mul_f32 v225, v225, v53
    v_mul_f32 v226, v226, v53
    v_mul_f32 v227, v227, v53
    v_accvgpr_write_b32 a52, v224
    v_accvgpr_write_b32 a53, v225
    v_accvgpr_write_b32 a54, v226
    v_accvgpr_write_b32 a55, v227
    v_accvgpr_read_b32 v224, a56
    v_accvgpr_read_b32 v225, a57
    v_accvgpr_read_b32 v226, a58
    v_accvgpr_read_b32 v227, a59
    v_mul_f32 v224, v224, v54
    v_mul_f32 v225, v225, v54
    v_mul_f32 v226, v226, v54
    v_mul_f32 v227, v227, v54
    v_accvgpr_write_b32 a56, v224
    v_accvgpr_write_b32 a57, v225
    v_accvgpr_write_b32 a58, v226
    v_accvgpr_write_b32 a59, v227
    v_accvgpr_read_b32 v224, a60
    v_accvgpr_read_b32 v225, a61
    v_accvgpr_read_b32 v226, a62
    v_accvgpr_read_b32 v227, a63
    v_mul_f32 v224, v224, v55
    v_mul_f32 v225, v225, v55
    v_mul_f32 v226, v226, v55
    v_mul_f32 v227, v227, v55
    v_accvgpr_write_b32 a60, v224
    v_accvgpr_write_b32 a61, v225
    v_accvgpr_write_b32 a62, v226
    v_accvgpr_write_b32 a63, v227
    v_accvgpr_read_b32 v224, a64
    v_accvgpr_read_b32 v225, a65
    v_accvgpr_read_b32 v226, a66
    v_accvgpr_read_b32 v227, a67
    v_mul_f32 v224, v224, v52
    v_mul_f32 v225, v225, v52
    v_mul_f32 v226, v226, v52
    v_mul_f32 v227, v227, v52
    v_accvgpr_write_b32 a64, v224
    v_accvgpr_write_b32 a65, v225
    v_accvgpr_write_b32 a66, v226
    v_accvgpr_write_b32 a67, v227
    v_accvgpr_read_b32 v224, a68
    v_accvgpr_read_b32 v225, a69
    v_accvgpr_read_b32 v226, a70
    v_accvgpr_read_b32 v227, a71
    v_mul_f32 v224, v224, v53
    v_mul_f32 v225, v225, v53
    v_mul_f32 v226, v226, v53
    v_mul_f32 v227, v227, v53
    v_accvgpr_write_b32 a68, v224
    v_accvgpr_write_b32 a69, v225
    v_accvgpr_write_b32 a70, v226
    v_accvgpr_write_b32 a71, v227
    v_accvgpr_read_b32 v224, a72
    v_accvgpr_read_b32 v225, a73
    v_accvgpr_read_b32 v226, a74
    v_accvgpr_read_b32 v227, a75
    v_mul_f32 v224, v224, v54
    v_mul_f32 v225, v225, v54
    v_mul_f32 v226, v226, v54
    v_mul_f32 v227, v227, v54
    v_accvgpr_write_b32 a72, v224
    v_accvgpr_write_b32 a73, v225
    v_accvgpr_write_b32 a74, v226
    v_accvgpr_write_b32 a75, v227
    v_accvgpr_read_b32 v224, a76
    v_accvgpr_read_b32 v225, a77
    v_accvgpr_read_b32 v226, a78
    v_accvgpr_read_b32 v227, a79
    v_mul_f32 v224, v224, v55
    v_mul_f32 v225, v225, v55
    v_mul_f32 v226, v226, v55
    v_mul_f32 v227, v227, v55
    v_accvgpr_write_b32 a76, v224
    v_accvgpr_write_b32 a77, v225
    v_accvgpr_write_b32 a78, v226
    v_accvgpr_write_b32 a79, v227
    v_accvgpr_read_b32 v224, a80
    v_accvgpr_read_b32 v225, a81
    v_accvgpr_read_b32 v226, a82
    v_accvgpr_read_b32 v227, a83
    v_mul_f32 v224, v224, v52
    v_mul_f32 v225, v225, v52
    v_mul_f32 v226, v226, v52
    v_mul_f32 v227, v227, v52
    v_accvgpr_write_b32 a80, v224
    v_accvgpr_write_b32 a81, v225
    v_accvgpr_write_b32 a82, v226
    v_accvgpr_write_b32 a83, v227
    v_accvgpr_read_b32 v224, a84
    v_accvgpr_read_b32 v225, a85
    v_accvgpr_read_b32 v226, a86
    v_accvgpr_read_b32 v227, a87
    v_mul_f32 v224, v224, v53
    v_mul_f32 v225, v225, v53
    v_mul_f32 v226, v226, v53
    v_mul_f32 v227, v227, v53
    v_accvgpr_write_b32 a84, v224
    v_accvgpr_write_b32 a85, v225
    v_accvgpr_write_b32 a86, v226
    v_accvgpr_write_b32 a87, v227
    v_accvgpr_read_b32 v224, a88
    v_accvgpr_read_b32 v225, a89
    v_accvgpr_read_b32 v226, a90
    v_accvgpr_read_b32 v227, a91
    v_mul_f32 v224, v224, v54
    v_mul_f32 v225, v225, v54
    v_mul_f32 v226, v226, v54
    v_mul_f32 v227, v227, v54
    v_accvgpr_write_b32 a88, v224
    v_accvgpr_write_b32 a89, v225
    v_accvgpr_write_b32 a90, v226
    v_accvgpr_write_b32 a91, v227
    v_accvgpr_read_b32 v224, a92
    v_accvgpr_read_b32 v225, a93
    v_accvgpr_read_b32 v226, a94
    v_accvgpr_read_b32 v227, a95
    v_mul_f32 v224, v224, v55
    v_mul_f32 v225, v225, v55
    v_mul_f32 v226, v226, v55
    v_mul_f32 v227, v227, v55
    v_accvgpr_write_b32 a92, v224
    v_accvgpr_write_b32 a93, v225
    v_accvgpr_write_b32 a94, v226
    v_accvgpr_write_b32 a95, v227
    v_accvgpr_read_b32 v224, a96
    v_accvgpr_read_b32 v225, a97
    v_accvgpr_read_b32 v226, a98
    v_accvgpr_read_b32 v227, a99
    v_mul_f32 v224, v224, v52
    v_mul_f32 v225, v225, v52
    v_mul_f32 v226, v226, v52
    v_mul_f32 v227, v227, v52
    v_accvgpr_write_b32 a96, v224
    v_accvgpr_write_b32 a97, v225
    v_accvgpr_write_b32 a98, v226
    v_accvgpr_write_b32 a99, v227
    v_accvgpr_read_b32 v224, a100
    v_accvgpr_read_b32 v225, a101
    v_accvgpr_read_b32 v226, a102
    v_accvgpr_read_b32 v227, a103
    v_mul_f32 v224, v224, v53
    v_mul_f32 v225, v225, v53
    v_mul_f32 v226, v226, v53
    v_mul_f32 v227, v227, v53
    v_accvgpr_write_b32 a100, v224
    v_accvgpr_write_b32 a101, v225
    v_accvgpr_write_b32 a102, v226
    v_accvgpr_write_b32 a103, v227
    v_accvgpr_read_b32 v224, a104
    v_accvgpr_read_b32 v225, a105
    v_accvgpr_read_b32 v226, a106
    v_accvgpr_read_b32 v227, a107
    v_mul_f32 v224, v224, v54
    v_mul_f32 v225, v225, v54
    v_mul_f32 v226, v226, v54
    v_mul_f32 v227, v227, v54
    v_accvgpr_write_b32 a104, v224
    v_accvgpr_write_b32 a105, v225
    v_accvgpr_write_b32 a106, v226
    v_accvgpr_write_b32 a107, v227
    v_accvgpr_read_b32 v224, a108
    v_accvgpr_read_b32 v225, a109
    v_accvgpr_read_b32 v226, a110
    v_accvgpr_read_b32 v227, a111
    v_mul_f32 v224, v224, v55
    v_mul_f32 v225, v225, v55
    v_mul_f32 v226, v226, v55
    v_mul_f32 v227, v227, v55
    v_accvgpr_write_b32 a108, v224
    v_accvgpr_write_b32 a109, v225
    v_accvgpr_write_b32 a110, v226
    v_accvgpr_write_b32 a111, v227
    v_accvgpr_read_b32 v224, a112
    v_accvgpr_read_b32 v225, a113
    v_accvgpr_read_b32 v226, a114
    v_accvgpr_read_b32 v227, a115
    v_mul_f32 v224, v224, v52
    v_mul_f32 v225, v225, v52
    v_mul_f32 v226, v226, v52
    v_mul_f32 v227, v227, v52
    v_accvgpr_write_b32 a112, v224
    v_accvgpr_write_b32 a113, v225
    v_accvgpr_write_b32 a114, v226
    v_accvgpr_write_b32 a115, v227
    v_accvgpr_read_b32 v224, a116
    v_accvgpr_read_b32 v225, a117
    v_accvgpr_read_b32 v226, a118
    v_accvgpr_read_b32 v227, a119
    v_mul_f32 v224, v224, v53
    v_mul_f32 v225, v225, v53
    v_mul_f32 v226, v226, v53
    v_mul_f32 v227, v227, v53
    v_accvgpr_write_b32 a116, v224
    v_accvgpr_write_b32 a117, v225
    v_accvgpr_write_b32 a118, v226
    v_accvgpr_write_b32 a119, v227
    v_accvgpr_read_b32 v224, a120
    v_accvgpr_read_b32 v225, a121
    v_accvgpr_read_b32 v226, a122
    v_accvgpr_read_b32 v227, a123
    v_mul_f32 v224, v224, v54
    v_mul_f32 v225, v225, v54
    v_mul_f32 v226, v226, v54
    v_mul_f32 v227, v227, v54
    v_accvgpr_write_b32 a120, v224
    v_accvgpr_write_b32 a121, v225
    v_accvgpr_write_b32 a122, v226
    v_accvgpr_write_b32 a123, v227
    v_accvgpr_read_b32 v224, a124
    v_accvgpr_read_b32 v225, a125
    v_accvgpr_read_b32 v226, a126
    v_accvgpr_read_b32 v227, a127
    v_mul_f32 v224, v224, v55
    v_mul_f32 v225, v225, v55
    v_mul_f32 v226, v226, v55
    v_mul_f32 v227, v227, v55
    v_accvgpr_write_b32 a124, v224
    v_accvgpr_write_b32 a125, v225
    v_accvgpr_write_b32 a126, v226
    v_accvgpr_write_b32 a127, v227
    v_exp_f32 v56, v160
    v_exp_f32 v57, v161
    v_exp_f32 v58, v162
    v_exp_f32 v59, v163
    v_add_f32 v48, v56, v57
    v_cvt_pk_bf16_f32 v208, v56, v57
    v_exp_f32 v60, v176
    v_exp_f32 v61, v177
    v_add_f32 v48, v48, v58
    v_add_f32 v48, v48, v59
    v_cvt_pk_bf16_f32 v209, v58, v59
    v_exp_f32 v62, v178
    v_exp_f32 v63, v179
    v_add_f32 v48, v48, v60
    v_add_f32 v48, v48, v61
    v_cvt_pk_bf16_f32 v210, v60, v61
    v_exp_f32 v56, v164
    v_exp_f32 v57, v165
    v_add_f32 v48, v48, v62
    v_add_f32 v48, v48, v63
    v_cvt_pk_bf16_f32 v211, v62, v63
    v_exp_f32 v58, v166
    v_exp_f32 v59, v167
    v_add_f32 v49, v56, v57
    v_cvt_pk_bf16_f32 v212, v56, v57
    v_exp_f32 v60, v180
    v_exp_f32 v61, v181
    v_add_f32 v49, v49, v58
    v_add_f32 v49, v49, v59
    v_cvt_pk_bf16_f32 v213, v58, v59
    v_exp_f32 v62, v182
    v_exp_f32 v63, v183
    v_add_f32 v49, v49, v60
    v_add_f32 v49, v49, v61
    v_cvt_pk_bf16_f32 v214, v60, v61
    v_exp_f32 v56, v168
    v_exp_f32 v57, v169
    v_add_f32 v49, v49, v62
    v_add_f32 v49, v49, v63
    v_cvt_pk_bf16_f32 v215, v62, v63
    v_exp_f32 v58, v170
    v_exp_f32 v59, v171
    v_add_f32 v50, v56, v57
    v_cvt_pk_bf16_f32 v216, v56, v57
    v_exp_f32 v60, v184
    v_exp_f32 v61, v185
    v_add_f32 v50, v50, v58
    v_add_f32 v50, v50, v59
    v_cvt_pk_bf16_f32 v217, v58, v59
    v_exp_f32 v62, v186
    v_exp_f32 v63, v187
    v_add_f32 v50, v50, v60
    v_add_f32 v50, v50, v61
    v_cvt_pk_bf16_f32 v218, v60, v61
    v_exp_f32 v56, v172
    v_exp_f32 v57, v173
    v_add_f32 v50, v50, v62
    v_add_f32 v50, v50, v63
    v_cvt_pk_bf16_f32 v219, v62, v63
    v_exp_f32 v58, v174
    v_exp_f32 v59, v175
    v_add_f32 v51, v56, v57
    v_cvt_pk_bf16_f32 v220, v56, v57
    v_exp_f32 v60, v188
    v_exp_f32 v61, v189
    v_add_f32 v51, v51, v58
    v_add_f32 v51, v51, v59
    v_cvt_pk_bf16_f32 v221, v58, v59
    v_exp_f32 v62, v190
    v_exp_f32 v63, v191
    v_add_f32 v51, v51, v60
    v_add_f32 v51, v51, v61
    v_cvt_pk_bf16_f32 v222, v60, v61
    s_nop 0
    v_add_f32 v51, v51, v62
    v_add_f32 v51, v51, v63
    v_cvt_pk_bf16_f32 v223, v62, v63
    s_nop 1
    s_branch k2_ret_20
k2_rare_22:
    s_nop 7
    v_max_f32 v54, v128, v129
    v_max3_f32 v54, v54, v130, v131
    v_max3_f32 v54, v54, v144, v145
    v_max3_f32 v54, v54, v146, v147
    v_max3_f32 v54, v54, v136, v137
    v_max3_f32 v54, v54, v138, v139
    v_max3_f32 v54, v54, v152, v153
    v_max3_f32 v54, v54, v154, v155
    v_mov_b32 v6, v54
    s_nop 1
    v_permlane16_swap_b32 v54, v6
    s_nop 1
    v_max_f32 v54, v54, v6
    v_mov_b32 v6, v54
    s_nop 1
    v_permlane32_swap_b32 v54, v6
    s_nop 1
    v_max_f32 v54, v54, v6
    v_max_f32 v54, 0, v54
    v_max_f32 v55, v132, v133
    v_max3_f32 v55, v55, v134, v135
    v_max3_f32 v55, v55, v148, v149
    v_max3_f32 v55, v55, v150, v151
    v_max3_f32 v55, v55, v140, v141
    v_max3_f32 v55, v55, v142, v143
    v_max3_f32 v55, v55, v156, v157
    v_max3_f32 v55, v55, v158, v159
    v_mov_b32 v6, v55
    s_nop 1
    v_permlane16_swap_b32 v55, v6
    s_nop 1
    v_max_f32 v55, v55, v6
    v_mov_b32 v6, v55
    s_nop 1
    v_permlane32_swap_b32 v55, v6
    s_nop 1
    v_max_f32 v55, v55, v6
    v_max_f32 v55, 0, v55
    v_sub_f32 v128, v128, v54
    v_sub_f32 v129, v129, v54
    v_sub_f32 v130, v130, v54
    v_sub_f32 v131, v131, v54
    v_sub_f32 v132, v132, v55
    v_sub_f32 v133, v133, v55
    v_sub_f32 v134, v134, v55
    v_sub_f32 v135, v135, v55
    v_sub_f32 v136, v136, v54
    v_sub_f32 v137, v137, v54
    v_sub_f32 v138, v138, v54
    v_sub_f32 v139, v139, v54
    v_sub_f32 v140, v140, v55
    v_sub_f32 v141, v141, v55
    v_sub_f32 v142, v142, v55
    v_sub_f32 v143, v143, v55
    v_sub_f32 v144, v144, v54
    v_sub_f32 v145, v145, v54
    v_sub_f32 v146, v146, v54
    v_sub_f32 v147, v147, v54
    v_sub_f32 v148, v148, v55
    v_sub_f32 v149, v149, v55
    v_sub_f32 v150, v150, v55
    v_sub_f32 v151, v151, v55
    v_sub_f32 v152, v152, v54
    v_sub_f32 v153, v153, v54
    v_sub_f32 v154, v154, v54
    v_sub_f32 v155, v155, v54
    v_sub_f32 v156, v156, v55
    v_sub_f32 v157, v157, v55
    v_sub_f32 v158, v158, v55
    v_sub_f32 v159, v159, v55
    v_sub_f32 v160, v160, v54
    v_sub_f32 v16, v16, v54
    v_sub_f32 v161, v161, v54
    v_sub_f32 v17, v17, v54
    v_sub_f32 v162, v162, v54
    v_sub_f32 v18, v18, v54
    v_sub_f32 v163, v163, v54
    v_sub_f32 v19, v19, v54
    v_sub_f32 v164, v164, v55
    v_sub_f32 v20, v20, v55
    v_sub_f32 v165, v165, v55
    v_sub_f32 v21, v21, v55
    v_sub_f32 v166, v166, v55
    v_sub_f32 v22, v22, v55
    v_sub_f32 v167, v167, v55
    v_sub_f32 v23, v23, v55
    v_sub_f32 v168, v168, v54
    v_sub_f32 v24, v24, v54
    v_sub_f32 v169, v169, v54
    v_sub_f32 v25, v25, v54
    v_sub_f32 v170, v170, v54
    v_sub_f32 v26, v26, v54
    v_sub_f32 v171, v171, v54
    v_sub_f32 v27, v27, v54
    v_sub_f32 v172, v172, v55
    v_sub_f32 v28, v28, v55
    v_sub_f32 v173, v173, v55
    v_sub_f32 v29, v29, v55
    v_sub_f32 v174, v174, v55
    v_sub_f32 v30, v30, v55
    v_sub_f32 v175, v175, v55
    v_sub_f32 v31, v31, v55
    v_sub_f32 v176, v176, v54
    v_sub_f32 v32, v32, v54
    v_sub_f32 v177, v177, v54
    v_sub_f32 v33, v33, v54
    v_sub_f32 v178, v178, v54
    v_sub_f32 v34, v34, v54
    v_sub_f32 v179, v179, v54
    v_sub_f32 v35, v35, v54
    v_sub_f32 v180, v180, v55
    v_sub_f32 v36, v36, v55
    v_sub_f32 v181, v181, v55
    v_sub_f32 v37, v37, v55
    v_sub_f32 v182, v182, v55
    v_sub_f32 v38, v38, v55
    v_sub_f32 v183, v183, v55
    v_sub_f32 v39, v39, v55
    v_sub_f32 v184, v184, v54
    v_sub_f32 v40, v40, v54
    v_sub_f32 v185, v185, v54
    v_sub_f32 v41, v41, v54
    v_sub_f32 v186, v186, v54
    v_sub_f32 v42, v42, v54
    v_sub_f32 v187, v187, v54
    v_sub_f32 v43, v43, v54
    v_sub_f32 v188, v188, v55
    v_sub_f32 v44, v44, v55
    v_sub_f32 v189, v189, v55
    v_sub_f32 v45, v45, v55
    v_sub_f32 v190, v190, v55
    v_sub_f32 v46, v46, v55
    v_sub_f32 v191, v191, v55
    v_sub_f32 v47, v47, v55
    v_sub_f32 v10, v10, v54
    v_exp_f32 v54, -v54
    v_sub_f32 v11, v11, v55
    v_exp_f32 v55, -v55
    s_nop 0
    v_mul_f32 v14, v14, v54
    v_mul_f32 v15, v15, v55
    v_accvgpr_read_b32 v224, a8
    v_accvgpr_read_b32 v225, a9
    v_accvgpr_read_b32 v226, a10
    v_accvgpr_read_b32 v227, a11
    v_mul_f32 v224, v224, v54
    v_mul_f32 v225, v225, v54
    v_mul_f32 v226, v226, v54
    v_mul_f32 v227, v227, v54
    v_accvgpr_write_b32 a8, v224
    v_accvgpr_write_b32 a9, v225
    v_accvgpr_write_b32 a10, v226
    v_accvgpr_write_b32 a11, v227
    v_accvgpr_read_b32 v224, a12
    v_accvgpr_read_b32 v225, a13
    v_accvgpr_read_b32 v226, a14
    v_accvgpr_read_b32 v227, a15
    v_mul_f32 v224, v224, v55
    v_mul_f32 v225, v225, v55
    v_mul_f32 v226, v226, v55
    v_mul_f32 v227, v227, v55
    v_accvgpr_write_b32 a12, v224
    v_accvgpr_write_b32 a13, v225
    v_accvgpr_write_b32 a14, v226
    v_accvgpr_write_b32 a15, v227
    v_accvgpr_read_b32 v224, a24
    v_accvgpr_read_b32 v225, a25
    v_accvgpr_read_b32 v226, a26
    v_accvgpr_read_b32 v227, a27
    v_mul_f32 v224, v224, v54
    v_mul_f32 v225, v225, v54
    v_mul_f32 v226, v226, v54
    v_mul_f32 v227, v227, v54
    v_accvgpr_write_b32 a24, v224
    v_accvgpr_write_b32 a25, v225
    v_accvgpr_write_b32 a26, v226
    v_accvgpr_write_b32 a27, v227
    v_accvgpr_read_b32 v224, a28
    v_accvgpr_read_b32 v225, a29
    v_accvgpr_read_b32 v226, a30
    v_accvgpr_read_b32 v227, a31
    v_mul_f32 v224, v224, v55
    v_mul_f32 v225, v225, v55
    v_mul_f32 v226, v226, v55
    v_mul_f32 v227, v227, v55
    v_accvgpr_write_b32 a28, v224
    v_accvgpr_write_b32 a29, v225
    v_accvgpr_write_b32 a30, v226
    v_accvgpr_write_b32 a31, v227
    v_accvgpr_read_b32 v224, a40
    v_accvgpr_read_b32 v225, a41
    v_accvgpr_read_b32 v226, a42
    v_accvgpr_read_b32 v227, a43
    v_mul_f32 v224, v224, v54
    v_mul_f32 v225, v225, v54
    v_mul_f32 v226, v226, v54
    v_mul_f32 v227, v227, v54
    v_accvgpr_write_b32 a40, v224
    v_accvgpr_write_b32 a41, v225
    v_accvgpr_write_b32 a42, v226
    v_accvgpr_write_b32 a43, v227
    v_accvgpr_read_b32 v224, a44
    v_accvgpr_read_b32 v225, a45
    v_accvgpr_read_b32 v226, a46
    v_accvgpr_read_b32 v227, a47
    v_mul_f32 v224, v224, v55
    v_mul_f32 v225, v225, v55
    v_mul_f32 v226, v226, v55
    v_mul_f32 v227, v227, v55
    v_accvgpr_write_b32 a44, v224
    v_accvgpr_write_b32 a45, v225
    v_accvgpr_write_b32 a46, v226
    v_accvgpr_write_b32 a47, v227
    v_accvgpr_read_b32 v224, a56
    v_accvgpr_read_b32 v225, a57
    v_accvgpr_read_b32 v226, a58
    v_accvgpr_read_b32 v227, a59
    v_mul_f32 v224, v224, v54
    v_mul_f32 v225, v225, v54
    v_mul_f32 v226, v226, v54
    v_mul_f32 v227, v227, v54
    v_accvgpr_write_b32 a56, v224
    v_accvgpr_write_b32 a57, v225
    v_accvgpr_write_b32 a58, v226
    v_accvgpr_write_b32 a59, v227
    v_accvgpr_read_b32 v224, a60
    v_accvgpr_read_b32 v225, a61
    v_accvgpr_read_b32 v226, a62
    v_accvgpr_read_b32 v227, a63
    v_mul_f32 v224, v224, v55
    v_mul_f32 v225, v225, v55
    v_mul_f32 v226, v226, v55
    v_mul_f32 v227, v227, v55
    v_accvgpr_write_b32 a60, v224
    v_accvgpr_write_b32 a61, v225
    v_accvgpr_write_b32 a62, v226
    v_accvgpr_write_b32 a63, v227
    v_accvgpr_read_b32 v224, a72
    v_accvgpr_read_b32 v225, a73
    v_accvgpr_read_b32 v226, a74
    v_accvgpr_read_b32 v227, a75
    v_mul_f32 v224, v224, v54
    v_mul_f32 v225, v225, v54
    v_mul_f32 v226, v226, v54
    v_mul_f32 v227, v227, v54
    v_accvgpr_write_b32 a72, v224
    v_accvgpr_write_b32 a73, v225
    v_accvgpr_write_b32 a74, v226
    v_accvgpr_write_b32 a75, v227
    v_accvgpr_read_b32 v224, a76
    v_accvgpr_read_b32 v225, a77
    v_accvgpr_read_b32 v226, a78
    v_accvgpr_read_b32 v227, a79
    v_mul_f32 v224, v224, v55
    v_mul_f32 v225, v225, v55
    v_mul_f32 v226, v226, v55
    v_mul_f32 v227, v227, v55
    v_accvgpr_write_b32 a76, v224
    v_accvgpr_write_b32 a77, v225
    v_accvgpr_write_b32 a78, v226
    v_accvgpr_write_b32 a79, v227
    v_accvgpr_read_b32 v224, a88
    v_accvgpr_read_b32 v225, a89
    v_accvgpr_read_b32 v226, a90
    v_accvgpr_read_b32 v227, a91
    v_mul_f32 v224, v224, v54
    v_mul_f32 v225, v225, v54
    v_mul_f32 v226, v226, v54
    v_mul_f32 v227, v227, v54
    v_accvgpr_write_b32 a88, v224
    v_accvgpr_write_b32 a89, v225
    v_accvgpr_write_b32 a90, v226
    v_accvgpr_write_b32 a91, v227
    v_accvgpr_read_b32 v224, a92
    v_accvgpr_read_b32 v225, a93
    v_accvgpr_read_b32 v226, a94
    v_accvgpr_read_b32 v227, a95
    v_mul_f32 v224, v224, v55
    v_mul_f32 v225, v225, v55
    v_mul_f32 v226, v226, v55
    v_mul_f32 v227, v227, v55
    v_accvgpr_write_b32 a92, v224
    v_accvgpr_write_b32 a93, v225
    v_accvgpr_write_b32 a94, v226
    v_accvgpr_write_b32 a95, v227
    v_accvgpr_read_b32 v224, a104
    v_accvgpr_read_b32 v225, a105
    v_accvgpr_read_b32 v226, a106
    v_accvgpr_read_b32 v227, a107
    v_mul_f32 v224, v224, v54
    v_mul_f32 v225, v225, v54
    v_mul_f32 v226, v226, v54
    v_mul_f32 v227, v227, v54
    v_accvgpr_write_b32 a104, v224
    v_accvgpr_write_b32 a105, v225
    v_accvgpr_write_b32 a106, v226
    v_accvgpr_write_b32 a107, v227
    v_accvgpr_read_b32 v224, a108
    v_accvgpr_read_b32 v225, a109
    v_accvgpr_read_b32 v226, a110
    v_accvgpr_read_b32 v227, a111
    v_mul_f32 v224, v224, v55
    v_mul_f32 v225, v225, v55
    v_mul_f32 v226, v226, v55
    v_mul_f32 v227, v227, v55
    v_accvgpr_write_b32 a108, v224
    v_accvgpr_write_b32 a109, v225
    v_accvgpr_write_b32 a110, v226
    v_accvgpr_write_b32 a111, v227
    v_accvgpr_read_b32 v224, a120
    v_accvgpr_read_b32 v225, a121
    v_accvgpr_read_b32 v226, a122
    v_accvgpr_read_b32 v227, a123
    v_mul_f32 v224, v224, v54
    v_mul_f32 v225, v225, v54
    v_mul_f32 v226, v226, v54
    v_mul_f32 v227, v227, v54
    v_accvgpr_write_b32 a120, v224
    v_accvgpr_write_b32 a121, v225
    v_accvgpr_write_b32 a122, v226
    v_accvgpr_write_b32 a123, v227
    v_accvgpr_read_b32 v224, a124
    v_accvgpr_read_b32 v225, a125
    v_accvgpr_read_b32 v226, a126
    v_accvgpr_read_b32 v227, a127
    v_mul_f32 v224, v224, v55
    v_mul_f32 v225, v225, v55
    v_mul_f32 v226, v226, v55
    v_mul_f32 v227, v227, v55
    v_accvgpr_write_b32 a124, v224
    v_accvgpr_write_b32 a125, v225
    v_accvgpr_write_b32 a126, v226
    v_accvgpr_write_b32 a127, v227
    v_exp_f32 v56, v128
    v_exp_f32 v57, v129
    v_exp_f32 v58, v130
    v_exp_f32 v59, v131
    v_add_f32 v48, v56, v57
    v_cvt_pk_bf16_f32 v192, v56, v57
    v_exp_f32 v60, v144
    v_exp_f32 v61, v145
    v_add_f32 v48, v48, v58
    v_add_f32 v48, v48, v59
    v_cvt_pk_bf16_f32 v193, v58, v59
    v_exp_f32 v62, v146
    v_exp_f32 v63, v147
    v_add_f32 v48, v48, v60
    v_add_f32 v48, v48, v61
    v_cvt_pk_bf16_f32 v194, v60, v61
    v_exp_f32 v56, v132
    v_exp_f32 v57, v133
    v_add_f32 v48, v48, v62
    v_add_f32 v48, v48, v63
    v_cvt_pk_bf16_f32 v195, v62, v63
    v_exp_f32 v58, v134
    v_exp_f32 v59, v135
    v_add_f32 v49, v56, v57
    v_cvt_pk_bf16_f32 v196, v56, v57
    v_exp_f32 v60, v148
    v_exp_f32 v61, v149
    v_add_f32 v49, v49, v58
    v_add_f32 v49, v49, v59
    v_cvt_pk_bf16_f32 v197, v58, v59
    v_exp_f32 v62, v150
    v_exp_f32 v63, v151
    v_add_f32 v49, v49, v60
    v_add_f32 v49, v49, v61
    v_cvt_pk_bf16_f32 v198, v60, v61
    v_exp_f32 v56, v136
    v_exp_f32 v57, v137
    v_add_f32 v49, v49, v62
    v_add_f32 v49, v49, v63
    v_cvt_pk_bf16_f32 v199, v62, v63
    v_exp_f32 v58, v138
    v_exp_f32 v59, v139
    v_add_f32 v50, v56, v57
    v_cvt_pk_bf16_f32 v200, v56, v57
    v_exp_f32 v60, v152
    v_exp_f32 v61, v153
    v_add_f32 v50, v50, v58
    v_add_f32 v50, v50, v59
    v_cvt_pk_bf16_f32 v201, v58, v59
    v_exp_f32 v62, v154
    v_exp_f32 v63, v155
    v_add_f32 v50, v50, v60
    v_add_f32 v50, v50, v61
    v_cvt_pk_bf16_f32 v202, v60, v61
    v_exp_f32 v56, v140
    v_exp_f32 v57, v141
    v_add_f32 v50, v50, v62
    v_add_f32 v50, v50, v63
    v_cvt_pk_bf16_f32 v203, v62, v63
    v_exp_f32 v58, v142
    v_exp_f32 v59, v143
    v_add_f32 v51, v56, v57
    v_cvt_pk_bf16_f32 v204, v56, v57
    v_exp_f32 v60, v156
    v_exp_f32 v61, v157
    v_add_f32 v51, v51, v58
    v_add_f32 v51, v51, v59
    v_cvt_pk_bf16_f32 v205, v58, v59
    v_exp_f32 v62, v158
    v_exp_f32 v63, v159
    v_add_f32 v51, v51, v60
    v_add_f32 v51, v51, v61
    v_cvt_pk_bf16_f32 v206, v60, v61
    s_nop 0
    v_add_f32 v51, v51, v62
    v_add_f32 v51, v51, v63
    v_cvt_pk_bf16_f32 v207, v62, v63
    s_nop 1
    s_branch k2_ret_23
k2_rare_27:
    s_nop 7
    v_max_f32 v54, v160, v161
    v_max3_f32 v54, v54, v162, v163
    v_max3_f32 v54, v54, v176, v177
    v_max3_f32 v54, v54, v178, v179
    v_max3_f32 v54, v54, v168, v169
    v_max3_f32 v54, v54, v170, v171
    v_max3_f32 v54, v54, v184, v185
    v_max3_f32 v54, v54, v186, v187
    v_mov_b32 v6, v54
    s_nop 1
    v_permlane16_swap_b32 v54, v6
    s_nop 1
    v_max_f32 v54, v54, v6
    v_mov_b32 v6, v54
    s_nop 1
    v_permlane32_swap_b32 v54, v6
    s_nop 1
    v_max_f32 v54, v54, v6
    v_max_f32 v54, 0, v54
    v_max_f32 v55, v164, v165
    v_max3_f32 v55, v55, v166, v167
    v_max3_f32 v55, v55, v180, v181
    v_max3_f32 v55, v55, v182, v183
    v_max3_f32 v55, v55, v172, v173
    v_max3_f32 v55, v55, v174, v175
    v_max3_f32 v55, v55, v188, v189
    v_max3_f32 v55, v55, v190, v191
    v_mov_b32 v6, v55
    s_nop 1
    v_permlane16_swap_b32 v55, v6
    s_nop 1
    v_max_f32 v55, v55, v6
    v_mov_b32 v6, v55
    s_nop 1
    v_permlane32_swap_b32 v55, v6
    s_nop 1
    v_max_f32 v55, v55, v6
    v_max_f32 v55, 0, v55
    v_sub_f32 v160, v160, v54
    v_sub_f32 v161, v161, v54
    v_sub_f32 v162, v162, v54
    v_sub_f32 v163, v163, v54
    v_sub_f32 v164, v164, v55
    v_sub_f32 v165, v165, v55
    v_sub_f32 v166, v166, v55
    v_sub_f32 v167, v167, v55
    v_sub_f32 v168, v168, v54
    v_sub_f32 v169, v169, v54
    v_sub_f32 v170, v170, v54
    v_sub_f32 v171, v171, v54
    v_sub_f32 v172, v172, v55
    v_sub_f32 v173, v173, v55
    v_sub_f32 v174, v174, v55
    v_sub_f32 v175, v175, v55
    v_sub_f32 v176, v176, v54
    v_sub_f32 v177, v177, v54
    v_sub_f32 v178, v178, v54
    v_sub_f32 v179, v179, v54
    v_sub_f32 v180, v180, v55
    v_sub_f32 v181, v181, v55
    v_sub_f32 v182, v182, v55
    v_sub_f32 v183, v183, v55
    v_sub_f32 v184, v184, v54
    v_sub_f32 v185, v185, v54
    v_sub_f32 v186, v186, v54
    v_sub_f32 v187, v187, v54
    v_sub_f32 v188, v188, v55
    v_sub_f32 v189, v189, v55
    v_sub_f32 v190, v190, v55
    v_sub_f32 v191, v191, v55
    v_sub_f32 v128, v128, v54
    v_sub_f32 v16, v16, v54
    v_sub_f32 v129, v129, v54
    v_sub_f32 v17, v17, v54
    v_sub_f32 v130, v130, v54
    v_sub_f32 v18, v18, v54
    v_sub_f32 v131, v131, v54
    v_sub_f32 v19, v19, v54
    v_sub_f32 v132, v132, v55
    v_sub_f32 v20, v20, v55
    v_sub_f32 v133, v133, v55
    v_sub_f32 v21, v21, v55
    v_sub_f32 v134, v134, v55
    v_sub_f32 v22, v22, v55
    v_sub_f32 v135, v135, v55
    v_sub_f32 v23, v23, v55
    v_sub_f32 v136, v136, v54
    v_sub_f32 v24, v24, v54
    v_sub_f32 v137, v137, v54
    v_sub_f32 v25, v25, v54
    v_sub_f32 v138, v138, v54
    v_sub_f32 v26, v26, v54
    v_sub_f32 v139, v139, v54
    v_sub_f32 v27, v27, v54
    v_sub_f32 v140, v140, v55
    v_sub_f32 v28, v28, v55
    v_sub_f32 v141, v141, v55
    v_sub_f32 v29, v29, v55
    v_sub_f32 v142, v142, v55
    v_sub_f32 v30, v30, v55
    v_sub_f32 v143, v143, v55
    v_sub_f32 v31, v31, v55
    v_sub_f32 v144, v144, v54
    v_sub_f32 v32, v32, v54
    v_sub_f32 v145, v145, v54
    v_sub_f32 v33, v33, v54
    v_sub_f32 v146, v146, v54
    v_sub_f32 v34, v34, v54
    v_sub_f32 v147, v147, v54
    v_sub_f32 v35, v35, v54
    v_sub_f32 v148, v148, v55
    v_sub_f32 v36, v36, v55
    v_sub_f32 v149, v149, v55
    v_sub_f32 v37, v37, v55
    v_sub_f32 v150, v150, v55
    v_sub_f32 v38, v38, v55
    v_sub_f32 v151, v151, v55
    v_sub_f32 v39, v39, v55
    v_sub_f32 v152, v152, v54
    v_sub_f32 v40, v40, v54
    v_sub_f32 v153, v153, v54
    v_sub_f32 v41, v41, v54
    v_sub_f32 v154, v154, v54
    v_sub_f32 v42, v42, v54
    v_sub_f32 v155, v155, v54
    v_sub_f32 v43, v43, v54
    v_sub_f32 v156, v156, v55
    v_sub_f32 v44, v44, v55
    v_sub_f32 v157, v157, v55
    v_sub_f32 v45, v45, v55
    v_sub_f32 v158, v158, v55
    v_sub_f32 v46, v46, v55
    v_sub_f32 v159, v159, v55
    v_sub_f32 v47, v47, v55
    v_sub_f32 v10, v10, v54
    v_exp_f32 v54, -v54
    v_sub_f32 v11, v11, v55
    v_exp_f32 v55, -v55
    s_nop 0
    v_mul_f32 v14, v14, v54
    v_mul_f32 v15, v15, v55
    v_accvgpr_read_b32 v224, a8
    v_accvgpr_read_b32 v225, a9
    v_accvgpr_read_b32 v226, a10
    v_accvgpr_read_b32 v227, a11
    v_mul_f32 v224, v224, v54
    v_mul_f32 v225, v225, v54
    v_mul_f32 v226, v226, v54
    v_mul_f32 v227, v227, v54
    v_accvgpr_write_b32 a8, v224
    v_accvgpr_write_b32 a9, v225
    v_accvgpr_write_b32 a10, v226
    v_accvgpr_write_b32 a11, v227
    v_accvgpr_read_b32 v224, a12
    v_accvgpr_read_b32 v225, a13
    v_accvgpr_read_b32 v226, a14
    v_accvgpr_read_b32 v227, a15
    v_mul_f32 v224, v224, v55
    v_mul_f32 v225, v225, v55
    v_mul_f32 v226, v226, v55
    v_mul_f32 v227, v227, v55
    v_accvgpr_write_b32 a12, v224
    v_accvgpr_write_b32 a13, v225
    v_accvgpr_write_b32 a14, v226
    v_accvgpr_write_b32 a15, v227
    v_accvgpr_read_b32 v224, a24
    v_accvgpr_read_b32 v225, a25
    v_accvgpr_read_b32 v226, a26
    v_accvgpr_read_b32 v227, a27
    v_mul_f32 v224, v224, v54
    v_mul_f32 v225, v225, v54
    v_mul_f32 v226, v226, v54
    v_mul_f32 v227, v227, v54
    v_accvgpr_write_b32 a24, v224
    v_accvgpr_write_b32 a25, v225
    v_accvgpr_write_b32 a26, v226
    v_accvgpr_write_b32 a27, v227
    v_accvgpr_read_b32 v224, a28
    v_accvgpr_read_b32 v225, a29
    v_accvgpr_read_b32 v226, a30
    v_accvgpr_read_b32 v227, a31
    v_mul_f32 v224, v224, v55
    v_mul_f32 v225, v225, v55
    v_mul_f32 v226, v226, v55
    v_mul_f32 v227, v227, v55
    v_accvgpr_write_b32 a28, v224
    v_accvgpr_write_b32 a29, v225
    v_accvgpr_write_b32 a30, v226
    v_accvgpr_write_b32 a31, v227
    v_accvgpr_read_b32 v224, a40
    v_accvgpr_read_b32 v225, a41
    v_accvgpr_read_b32 v226, a42
    v_accvgpr_read_b32 v227, a43
    v_mul_f32 v224, v224, v54
    v_mul_f32 v225, v225, v54
    v_mul_f32 v226, v226, v54
    v_mul_f32 v227, v227, v54
    v_accvgpr_write_b32 a40, v224
    v_accvgpr_write_b32 a41, v225
    v_accvgpr_write_b32 a42, v226
    v_accvgpr_write_b32 a43, v227
    v_accvgpr_read_b32 v224, a44
    v_accvgpr_read_b32 v225, a45
    v_accvgpr_read_b32 v226, a46
    v_accvgpr_read_b32 v227, a47
    v_mul_f32 v224, v224, v55
    v_mul_f32 v225, v225, v55
    v_mul_f32 v226, v226, v55
    v_mul_f32 v227, v227, v55
    v_accvgpr_write_b32 a44, v224
    v_accvgpr_write_b32 a45, v225
    v_accvgpr_write_b32 a46, v226
    v_accvgpr_write_b32 a47, v227
    v_accvgpr_read_b32 v224, a56
    v_accvgpr_read_b32 v225, a57
    v_accvgpr_read_b32 v226, a58
    v_accvgpr_read_b32 v227, a59
    v_mul_f32 v224, v224, v54
    v_mul_f32 v225, v225, v54
    v_mul_f32 v226, v226, v54
    v_mul_f32 v227, v227, v54
    v_accvgpr_write_b32 a56, v224
    v_accvgpr_write_b32 a57, v225
    v_accvgpr_write_b32 a58, v226
    v_accvgpr_write_b32 a59, v227
    v_accvgpr_read_b32 v224, a60
    v_accvgpr_read_b32 v225, a61
    v_accvgpr_read_b32 v226, a62
    v_accvgpr_read_b32 v227, a63
    v_mul_f32 v224, v224, v55
    v_mul_f32 v225, v225, v55
    v_mul_f32 v226, v226, v55
    v_mul_f32 v227, v227, v55
    v_accvgpr_write_b32 a60, v224
    v_accvgpr_write_b32 a61, v225
    v_accvgpr_write_b32 a62, v226
    v_accvgpr_write_b32 a63, v227
    v_accvgpr_read_b32 v224, a72
    v_accvgpr_read_b32 v225, a73
    v_accvgpr_read_b32 v226, a74
    v_accvgpr_read_b32 v227, a75
    v_mul_f32 v224, v224, v54
    v_mul_f32 v225, v225, v54
    v_mul_f32 v226, v226, v54
    v_mul_f32 v227, v227, v54
    v_accvgpr_write_b32 a72, v224
    v_accvgpr_write_b32 a73, v225
    v_accvgpr_write_b32 a74, v226
    v_accvgpr_write_b32 a75, v227
    v_accvgpr_read_b32 v224, a76
    v_accvgpr_read_b32 v225, a77
    v_accvgpr_read_b32 v226, a78
    v_accvgpr_read_b32 v227, a79
    v_mul_f32 v224, v224, v55
    v_mul_f32 v225, v225, v55
    v_mul_f32 v226, v226, v55
    v_mul_f32 v227, v227, v55
    v_accvgpr_write_b32 a76, v224
    v_accvgpr_write_b32 a77, v225
    v_accvgpr_write_b32 a78, v226
    v_accvgpr_write_b32 a79, v227
    v_accvgpr_read_b32 v224, a88
    v_accvgpr_read_b32 v225, a89
    v_accvgpr_read_b32 v226, a90
    v_accvgpr_read_b32 v227, a91
    v_mul_f32 v224, v224, v54
    v_mul_f32 v225, v225, v54
    v_mul_f32 v226, v226, v54
    v_mul_f32 v227, v227, v54
    v_accvgpr_write_b32 a88, v224
    v_accvgpr_write_b32 a89, v225
    v_accvgpr_write_b32 a90, v226
    v_accvgpr_write_b32 a91, v227
    v_accvgpr_read_b32 v224, a92
    v_accvgpr_read_b32 v225, a93
    v_accvgpr_read_b32 v226, a94
    v_accvgpr_read_b32 v227, a95
    v_mul_f32 v224, v224, v55
    v_mul_f32 v225, v225, v55
    v_mul_f32 v226, v226, v55
    v_mul_f32 v227, v227, v55
    v_accvgpr_write_b32 a92, v224
    v_accvgpr_write_b32 a93, v225
    v_accvgpr_write_b32 a94, v226
    v_accvgpr_write_b32 a95, v227
    v_accvgpr_read_b32 v224, a104
    v_accvgpr_read_b32 v225, a105
    v_accvgpr_read_b32 v226, a106
    v_accvgpr_read_b32 v227, a107
    v_mul_f32 v224, v224, v54
    v_mul_f32 v225, v225, v54
    v_mul_f32 v226, v226, v54
    v_mul_f32 v227, v227, v54
    v_accvgpr_write_b32 a104, v224
    v_accvgpr_write_b32 a105, v225
    v_accvgpr_write_b32 a106, v226
    v_accvgpr_write_b32 a107, v227
    v_accvgpr_read_b32 v224, a108
    v_accvgpr_read_b32 v225, a109
    v_accvgpr_read_b32 v226, a110
    v_accvgpr_read_b32 v227, a111
    v_mul_f32 v224, v224, v55
    v_mul_f32 v225, v225, v55
    v_mul_f32 v226, v226, v55
    v_mul_f32 v227, v227, v55
    v_accvgpr_write_b32 a108, v224
    v_accvgpr_write_b32 a109, v225
    v_accvgpr_write_b32 a110, v226
    v_accvgpr_write_b32 a111, v227
    v_accvgpr_read_b32 v224, a120
    v_accvgpr_read_b32 v225, a121
    v_accvgpr_read_b32 v226, a122
    v_accvgpr_read_b32 v227, a123
    v_mul_f32 v224, v224, v54
    v_mul_f32 v225, v225, v54
    v_mul_f32 v226, v226, v54
    v_mul_f32 v227, v227, v54
    v_accvgpr_write_b32 a120, v224
    v_accvgpr_write_b32 a121, v225
    v_accvgpr_write_b32 a122, v226
    v_accvgpr_write_b32 a123, v227
    v_accvgpr_read_b32 v224, a124
    v_accvgpr_read_b32 v225, a125
    v_accvgpr_read_b32 v226, a126
    v_accvgpr_read_b32 v227, a127
    v_mul_f32 v224, v224, v55
    v_mul_f32 v225, v225, v55
    v_mul_f32 v226, v226, v55
    v_mul_f32 v227, v227, v55
    v_accvgpr_write_b32 a124, v224
    v_accvgpr_write_b32 a125, v225
    v_accvgpr_write_b32 a126, v226
    v_accvgpr_write_b32 a127, v227
    v_exp_f32 v56, v160
    v_exp_f32 v57, v161
    v_exp_f32 v58, v162
    v_exp_f32 v59, v163
    v_add_f32 v48, v56, v57
    v_cvt_pk_bf16_f32 v208, v56, v57
    v_exp_f32 v60, v176
    v_exp_f32 v61, v177
    v_add_f32 v48, v48, v58
    v_add_f32 v48, v48, v59
    v_cvt_pk_bf16_f32 v209, v58, v59
    v_exp_f32 v62, v178
    v_exp_f32 v63, v179
    v_add_f32 v48, v48, v60
    v_add_f32 v48, v48, v61
    v_cvt_pk_bf16_f32 v210, v60, v61
    v_exp_f32 v56, v164
    v_exp_f32 v57, v165
    v_add_f32 v48, v48, v62
    v_add_f32 v48, v48, v63
    v_cvt_pk_bf16_f32 v211, v62, v63
    v_exp_f32 v58, v166
    v_exp_f32 v59, v167
    v_add_f32 v49, v56, v57
    v_cvt_pk_bf16_f32 v212, v56, v57
    v_exp_f32 v60, v180
    v_exp_f32 v61, v181
    v_add_f32 v49, v49, v58
    v_add_f32 v49, v49, v59
    v_cvt_pk_bf16_f32 v213, v58, v59
    v_exp_f32 v62, v182
    v_exp_f32 v63, v183
    v_add_f32 v49, v49, v60
    v_add_f32 v49, v49, v61
    v_cvt_pk_bf16_f32 v214, v60, v61
    v_exp_f32 v56, v168
    v_exp_f32 v57, v169
    v_add_f32 v49, v49, v62
    v_add_f32 v49, v49, v63
    v_cvt_pk_bf16_f32 v215, v62, v63
    v_exp_f32 v58, v170
    v_exp_f32 v59, v171
    v_add_f32 v50, v56, v57
    v_cvt_pk_bf16_f32 v216, v56, v57
    v_exp_f32 v60, v184
    v_exp_f32 v61, v185
    v_add_f32 v50, v50, v58
    v_add_f32 v50, v50, v59
    v_cvt_pk_bf16_f32 v217, v58, v59
    v_exp_f32 v62, v186
    v_exp_f32 v63, v187
    v_add_f32 v50, v50, v60
    v_add_f32 v50, v50, v61
    v_cvt_pk_bf16_f32 v218, v60, v61
    v_exp_f32 v56, v172
    v_exp_f32 v57, v173
    v_add_f32 v50, v50, v62
    v_add_f32 v50, v50, v63
    v_cvt_pk_bf16_f32 v219, v62, v63
    v_exp_f32 v58, v174
    v_exp_f32 v59, v175
    v_add_f32 v51, v56, v57
    v_cvt_pk_bf16_f32 v220, v56, v57
    v_exp_f32 v60, v188
    v_exp_f32 v61, v189
    v_add_f32 v51, v51, v58
    v_add_f32 v51, v51, v59
    v_cvt_pk_bf16_f32 v221, v58, v59
    v_exp_f32 v62, v190
    v_exp_f32 v63, v191
    v_add_f32 v51, v51, v60
    v_add_f32 v51, v51, v61
    v_cvt_pk_bf16_f32 v222, v60, v61
    s_nop 0
    v_add_f32 v51, v51, v62
    v_add_f32 v51, v51, v63
    v_cvt_pk_bf16_f32 v223, v62, v63
    s_nop 1
    s_branch k2_ret_28
k2_rare_30:
    s_nop 7
    v_max_f32 v54, v128, v129
    v_max3_f32 v54, v54, v130, v131
    v_max3_f32 v54, v54, v144, v145
    v_max3_f32 v54, v54, v146, v147
    v_max3_f32 v54, v54, v136, v137
    v_max3_f32 v54, v54, v138, v139
    v_max3_f32 v54, v54, v152, v153
    v_max3_f32 v54, v54, v154, v155
    v_mov_b32 v6, v54
    s_nop 1
    v_permlane16_swap_b32 v54, v6
    s_nop 1
    v_max_f32 v54, v54, v6
    v_mov_b32 v6, v54
    s_nop 1
    v_permlane32_swap_b32 v54, v6
    s_nop 1
    v_max_f32 v54, v54, v6
    v_max_f32 v54, 0, v54
    v_max_f32 v55, v132, v133
    v_max3_f32 v55, v55, v134, v135
    v_max3_f32 v55, v55, v148, v149
    v_max3_f32 v55, v55, v150, v151
    v_max3_f32 v55, v55, v140, v141
    v_max3_f32 v55, v55, v142, v143
    v_max3_f32 v55, v55, v156, v157
    v_max3_f32 v55, v55, v158, v159
    v_mov_b32 v6, v55
    s_nop 1
    v_permlane16_swap_b32 v55, v6
    s_nop 1
    v_max_f32 v55, v55, v6
    v_mov_b32 v6, v55
    s_nop 1
    v_permlane32_swap_b32 v55, v6
    s_nop 1
    v_max_f32 v55, v55, v6
    v_max_f32 v55, 0, v55
    v_sub_f32 v128, v128, v54
    v_sub_f32 v129, v129, v54
    v_sub_f32 v130, v130, v54
    v_sub_f32 v131, v131, v54
    v_sub_f32 v132, v132, v55
    v_sub_f32 v133, v133, v55
    v_sub_f32 v134, v134, v55
    v_sub_f32 v135, v135, v55
    v_sub_f32 v136, v136, v54
    v_sub_f32 v137, v137, v54
    v_sub_f32 v138, v138, v54
    v_sub_f32 v139, v139, v54
    v_sub_f32 v140, v140, v55
    v_sub_f32 v141, v141, v55
    v_sub_f32 v142, v142, v55
    v_sub_f32 v143, v143, v55
    v_sub_f32 v144, v144, v54
    v_sub_f32 v145, v145, v54
    v_sub_f32 v146, v146, v54
    v_sub_f32 v147, v147, v54
    v_sub_f32 v148, v148, v55
    v_sub_f32 v149, v149, v55
    v_sub_f32 v150, v150, v55
    v_sub_f32 v151, v151, v55
    v_sub_f32 v152, v152, v54
    v_sub_f32 v153, v153, v54
    v_sub_f32 v154, v154, v54
    v_sub_f32 v155, v155, v54
    v_sub_f32 v156, v156, v55
    v_sub_f32 v157, v157, v55
    v_sub_f32 v158, v158, v55
    v_sub_f32 v159, v159, v55
    v_sub_f32 v160, v160, v54
    v_sub_f32 v16, v16, v54
    v_sub_f32 v161, v161, v54
    v_sub_f32 v17, v17, v54
    v_sub_f32 v162, v162, v54
    v_sub_f32 v18, v18, v54
    v_sub_f32 v163, v163, v54
    v_sub_f32 v19, v19, v54
    v_sub_f32 v164, v164, v55
    v_sub_f32 v20, v20, v55
    v_sub_f32 v165, v165, v55
    v_sub_f32 v21, v21, v55
    v_sub_f32 v166, v166, v55
    v_sub_f32 v22, v22, v55
    v_sub_f32 v167, v167, v55
    v_sub_f32 v23, v23, v55
    v_sub_f32 v168, v168, v54
    v_sub_f32 v24, v24, v54
    v_sub_f32 v169, v169, v54
    v_sub_f32 v25, v25, v54
    v_sub_f32 v170, v170, v54
    v_sub_f32 v26, v26, v54
    v_sub_f32 v171, v171, v54
    v_sub_f32 v27, v27, v54
    v_sub_f32 v172, v172, v55
    v_sub_f32 v28, v28, v55
    v_sub_f32 v173, v173, v55
    v_sub_f32 v29, v29, v55
    v_sub_f32 v174, v174, v55
    v_sub_f32 v30, v30, v55
    v_sub_f32 v175, v175, v55
    v_sub_f32 v31, v31, v55
    v_sub_f32 v176, v176, v54
    v_sub_f32 v32, v32, v54
    v_sub_f32 v177, v177, v54
    v_sub_f32 v33, v33, v54
    v_sub_f32 v178, v178, v54
    v_sub_f32 v34, v34, v54
    v_sub_f32 v179, v179, v54
    v_sub_f32 v35, v35, v54
    v_sub_f32 v180, v180, v55
    v_sub_f32 v36, v36, v55
    v_sub_f32 v181, v181, v55
    v_sub_f32 v37, v37, v55
    v_sub_f32 v182, v182, v55
    v_sub_f32 v38, v38, v55
    v_sub_f32 v183, v183, v55
    v_sub_f32 v39, v39, v55
    v_sub_f32 v184, v184, v54
    v_sub_f32 v40, v40, v54
    v_sub_f32 v185, v185, v54
    v_sub_f32 v41, v41, v54
    v_sub_f32 v186, v186, v54
    v_sub_f32 v42, v42, v54
    v_sub_f32 v187, v187, v54
    v_sub_f32 v43, v43, v54
    v_sub_f32 v188, v188, v55
    v_sub_f32 v44, v44, v55
    v_sub_f32 v189, v189, v55
    v_sub_f32 v45, v45, v55
    v_sub_f32 v190, v190, v55
    v_sub_f32 v46, v46, v55
    v_sub_f32 v191, v191, v55
    v_sub_f32 v47, v47, v55
    v_sub_f32 v10, v10, v54
    v_exp_f32 v54, -v54
    v_sub_f32 v11, v11, v55
    v_exp_f32 v55, -v55
    s_nop 0
    v_mul_f32 v14, v14, v54
    v_mul_f32 v15, v15, v55
    v_accvgpr_read_b32 v224, a8
    v_accvgpr_read_b32 v225, a9
    v_accvgpr_read_b32 v226, a10
    v_accvgpr_read_b32 v227, a11
    v_mul_f32 v224, v224, v54
    v_mul_f32 v225, v225, v54
    v_mul_f32 v226, v226, v54
    v_mul_f32 v227, v227, v54
    v_accvgpr_write_b32 a8, v224
    v_accvgpr_write_b32 a9, v225
    v_accvgpr_write_b32 a10, v226
    v_accvgpr_write_b32 a11, v227
    v_accvgpr_read_b32 v224, a12
    v_accvgpr_read_b32 v225, a13
    v_accvgpr_read_b32 v226, a14
    v_accvgpr_read_b32 v227, a15
    v_mul_f32 v224, v224, v55
    v_mul_f32 v225, v225, v55
    v_mul_f32 v226, v226, v55
    v_mul_f32 v227, v227, v55
    v_accvgpr_write_b32 a12, v224
    v_accvgpr_write_b32 a13, v225
    v_accvgpr_write_b32 a14, v226
    v_accvgpr_write_b32 a15, v227
    v_accvgpr_read_b32 v224, a24
    v_accvgpr_read_b32 v225, a25
    v_accvgpr_read_b32 v226, a26
    v_accvgpr_read_b32 v227, a27
    v_mul_f32 v224, v224, v54
    v_mul_f32 v225, v225, v54
    v_mul_f32 v226, v226, v54
    v_mul_f32 v227, v227, v54
    v_accvgpr_write_b32 a24, v224
    v_accvgpr_write_b32 a25, v225
    v_accvgpr_write_b32 a26, v226
    v_accvgpr_write_b32 a27, v227
    v_accvgpr_read_b32 v224, a28
    v_accvgpr_read_b32 v225, a29
    v_accvgpr_read_b32 v226, a30
    v_accvgpr_read_b32 v227, a31
    v_mul_f32 v224, v224, v55
    v_mul_f32 v225, v225, v55
    v_mul_f32 v226, v226, v55
    v_mul_f32 v227, v227, v55
    v_accvgpr_write_b32 a28, v224
    v_accvgpr_write_b32 a29, v225
    v_accvgpr_write_b32 a30, v226
    v_accvgpr_write_b32 a31, v227
    v_accvgpr_read_b32 v224, a40
    v_accvgpr_read_b32 v225, a41
    v_accvgpr_read_b32 v226, a42
    v_accvgpr_read_b32 v227, a43
    v_mul_f32 v224, v224, v54
    v_mul_f32 v225, v225, v54
    v_mul_f32 v226, v226, v54
    v_mul_f32 v227, v227, v54
    v_accvgpr_write_b32 a40, v224
    v_accvgpr_write_b32 a41, v225
    v_accvgpr_write_b32 a42, v226
    v_accvgpr_write_b32 a43, v227
    v_accvgpr_read_b32 v224, a44
    v_accvgpr_read_b32 v225, a45
    v_accvgpr_read_b32 v226, a46
    v_accvgpr_read_b32 v227, a47
    v_mul_f32 v224, v224, v55
    v_mul_f32 v225, v225, v55
    v_mul_f32 v226, v226, v55
    v_mul_f32 v227, v227, v55
    v_accvgpr_write_b32 a44, v224
    v_accvgpr_write_b32 a45, v225
    v_accvgpr_write_b32 a46, v226
    v_accvgpr_write_b32 a47, v227
    v_accvgpr_read_b32 v224, a56
    v_accvgpr_read_b32 v225, a57
    v_accvgpr_read_b32 v226, a58
    v_accvgpr_read_b32 v227, a59
    v_mul_f32 v224, v224, v54
    v_mul_f32 v225, v225, v54
    v_mul_f32 v226, v226, v54
    v_mul_f32 v227, v227, v54
    v_accvgpr_write_b32 a56, v224
    v_accvgpr_write_b32 a57, v225
    v_accvgpr_write_b32 a58, v226
    v_accvgpr_write_b32 a59, v227
    v_accvgpr_read_b32 v224, a60
    v_accvgpr_read_b32 v225, a61
    v_accvgpr_read_b32 v226, a62
    v_accvgpr_read_b32 v227, a63
    v_mul_f32 v224, v224, v55
    v_mul_f32 v225, v225, v55
    v_mul_f32 v226, v226, v55
    v_mul_f32 v227, v227, v55
    v_accvgpr_write_b32 a60, v224
    v_accvgpr_write_b32 a61, v225
    v_accvgpr_write_b32 a62, v226
    v_accvgpr_write_b32 a63, v227
    v_accvgpr_read_b32 v224, a72
    v_accvgpr_read_b32 v225, a73
    v_accvgpr_read_b32 v226, a74
    v_accvgpr_read_b32 v227, a75
    v_mul_f32 v224, v224, v54
    v_mul_f32 v225, v225, v54
    v_mul_f32 v226, v226, v54
    v_mul_f32 v227, v227, v54
    v_accvgpr_write_b32 a72, v224
    v_accvgpr_write_b32 a73, v225
    v_accvgpr_write_b32 a74, v226
    v_accvgpr_write_b32 a75, v227
    v_accvgpr_read_b32 v224, a76
    v_accvgpr_read_b32 v225, a77
    v_accvgpr_read_b32 v226, a78
    v_accvgpr_read_b32 v227, a79
    v_mul_f32 v224, v224, v55
    v_mul_f32 v225, v225, v55
    v_mul_f32 v226, v226, v55
    v_mul_f32 v227, v227, v55
    v_accvgpr_write_b32 a76, v224
    v_accvgpr_write_b32 a77, v225
    v_accvgpr_write_b32 a78, v226
    v_accvgpr_write_b32 a79, v227
    v_accvgpr_read_b32 v224, a88
    v_accvgpr_read_b32 v225, a89
    v_accvgpr_read_b32 v226, a90
    v_accvgpr_read_b32 v227, a91
    v_mul_f32 v224, v224, v54
    v_mul_f32 v225, v225, v54
    v_mul_f32 v226, v226, v54
    v_mul_f32 v227, v227, v54
    v_accvgpr_write_b32 a88, v224
    v_accvgpr_write_b32 a89, v225
    v_accvgpr_write_b32 a90, v226
    v_accvgpr_write_b32 a91, v227
    v_accvgpr_read_b32 v224, a92
    v_accvgpr_read_b32 v225, a93
    v_accvgpr_read_b32 v226, a94
    v_accvgpr_read_b32 v227, a95
    v_mul_f32 v224, v224, v55
    v_mul_f32 v225, v225, v55
    v_mul_f32 v226, v226, v55
    v_mul_f32 v227, v227, v55
    v_accvgpr_write_b32 a92, v224
    v_accvgpr_write_b32 a93, v225
    v_accvgpr_write_b32 a94, v226
    v_accvgpr_write_b32 a95, v227
    v_accvgpr_read_b32 v224, a104
    v_accvgpr_read_b32 v225, a105
    v_accvgpr_read_b32 v226, a106
    v_accvgpr_read_b32 v227, a107
    v_mul_f32 v224, v224, v54
    v_mul_f32 v225, v225, v54
    v_mul_f32 v226, v226, v54
    v_mul_f32 v227, v227, v54
    v_accvgpr_write_b32 a104, v224
    v_accvgpr_write_b32 a105, v225
    v_accvgpr_write_b32 a106, v226
    v_accvgpr_write_b32 a107, v227
    v_accvgpr_read_b32 v224, a108
    v_accvgpr_read_b32 v225, a109
    v_accvgpr_read_b32 v226, a110
    v_accvgpr_read_b32 v227, a111
    v_mul_f32 v224, v224, v55
    v_mul_f32 v225, v225, v55
    v_mul_f32 v226, v226, v55
    v_mul_f32 v227, v227, v55
    v_accvgpr_write_b32 a108, v224
    v_accvgpr_write_b32 a109, v225
    v_accvgpr_write_b32 a110, v226
    v_accvgpr_write_b32 a111, v227
    v_accvgpr_read_b32 v224, a120
    v_accvgpr_read_b32 v225, a121
    v_accvgpr_read_b32 v226, a122
    v_accvgpr_read_b32 v227, a123
    v_mul_f32 v224, v224, v54
    v_mul_f32 v225, v225, v54
    v_mul_f32 v226, v226, v54
    v_mul_f32 v227, v227, v54
    v_accvgpr_write_b32 a120, v224
    v_accvgpr_write_b32 a121, v225
    v_accvgpr_write_b32 a122, v226
    v_accvgpr_write_b32 a123, v227
    v_accvgpr_read_b32 v224, a124
    v_accvgpr_read_b32 v225, a125
    v_accvgpr_read_b32 v226, a126
    v_accvgpr_read_b32 v227, a127
    v_mul_f32 v224, v224, v55
    v_mul_f32 v225, v225, v55
    v_mul_f32 v226, v226, v55
    v_mul_f32 v227, v227, v55
    v_accvgpr_write_b32 a124, v224
    v_accvgpr_write_b32 a125, v225
    v_accvgpr_write_b32 a126, v226
    v_accvgpr_write_b32 a127, v227
    v_exp_f32 v56, v128
    v_exp_f32 v57, v129
    v_exp_f32 v58, v130
    v_exp_f32 v59, v131
    v_add_f32 v48, v56, v57
    v_cvt_pk_bf16_f32 v192, v56, v57
    v_exp_f32 v60, v144
    v_exp_f32 v61, v145
    v_add_f32 v48, v48, v58
    v_add_f32 v48, v48, v59
    v_cvt_pk_bf16_f32 v193, v58, v59
    v_exp_f32 v62, v146
    v_exp_f32 v63, v147
    v_add_f32 v48, v48, v60
    v_add_f32 v48, v48, v61
    v_cvt_pk_bf16_f32 v194, v60, v61
    v_exp_f32 v56, v132
    v_exp_f32 v57, v133
    v_add_f32 v48, v48, v62
    v_add_f32 v48, v48, v63
    v_cvt_pk_bf16_f32 v195, v62, v63
    v_exp_f32 v58, v134
    v_exp_f32 v59, v135
    v_add_f32 v49, v56, v57
    v_cvt_pk_bf16_f32 v196, v56, v57
    v_exp_f32 v60, v148
    v_exp_f32 v61, v149
    v_add_f32 v49, v49, v58
    v_add_f32 v49, v49, v59
    v_cvt_pk_bf16_f32 v197, v58, v59
    v_exp_f32 v62, v150
    v_exp_f32 v63, v151
    v_add_f32 v49, v49, v60
    v_add_f32 v49, v49, v61
    v_cvt_pk_bf16_f32 v198, v60, v61
    v_exp_f32 v56, v136
    v_exp_f32 v57, v137
    v_add_f32 v49, v49, v62
    v_add_f32 v49, v49, v63
    v_cvt_pk_bf16_f32 v199, v62, v63
    v_exp_f32 v58, v138
    v_exp_f32 v59, v139
    v_add_f32 v50, v56, v57
    v_cvt_pk_bf16_f32 v200, v56, v57
    v_exp_f32 v60, v152
    v_exp_f32 v61, v153
    v_add_f32 v50, v50, v58
    v_add_f32 v50, v50, v59
    v_cvt_pk_bf16_f32 v201, v58, v59
    v_exp_f32 v62, v154
    v_exp_f32 v63, v155
    v_add_f32 v50, v50, v60
    v_add_f32 v50, v50, v61
    v_cvt_pk_bf16_f32 v202, v60, v61
    v_exp_f32 v56, v140
    v_exp_f32 v57, v141
    v_add_f32 v50, v50, v62
    v_add_f32 v50, v50, v63
    v_cvt_pk_bf16_f32 v203, v62, v63
    v_exp_f32 v58, v142
    v_exp_f32 v59, v143
    v_add_f32 v51, v56, v57
    v_cvt_pk_bf16_f32 v204, v56, v57
    v_exp_f32 v60, v156
    v_exp_f32 v61, v157
    v_add_f32 v51, v51, v58
    v_add_f32 v51, v51, v59
    v_cvt_pk_bf16_f32 v205, v58, v59
    v_exp_f32 v62, v158
    v_exp_f32 v63, v159
    v_add_f32 v51, v51, v60
    v_add_f32 v51, v51, v61
    v_cvt_pk_bf16_f32 v206, v60, v61
    s_nop 0
    v_add_f32 v51, v51, v62
    v_add_f32 v51, v51, v63
    v_cvt_pk_bf16_f32 v207, v62, v63
    s_nop 1
    s_branch k2_ret_31
k2_rare_32:
    s_nop 7
    v_max_f32 v54, v160, v161
    v_max3_f32 v54, v54, v162, v163
    v_max3_f32 v54, v54, v176, v177
    v_max3_f32 v54, v54, v178, v179
    v_max3_f32 v54, v54, v168, v169
    v_max3_f32 v54, v54, v170, v171
    v_max3_f32 v54, v54, v184, v185
    v_max3_f32 v54, v54, v186, v187
    v_mov_b32 v6, v54
    s_nop 1
    v_permlane16_swap_b32 v54, v6
    s_nop 1
    v_max_f32 v54, v54, v6
    v_mov_b32 v6, v54
    s_nop 1
    v_permlane32_swap_b32 v54, v6
    s_nop 1
    v_max_f32 v54, v54, v6
    v_max_f32 v54, 0, v54
    v_max_f32 v55, v164, v165
    v_max3_f32 v55, v55, v166, v167
    v_max3_f32 v55, v55, v180, v181
    v_max3_f32 v55, v55, v182, v183
    v_max3_f32 v55, v55, v172, v173
    v_max3_f32 v55, v55, v174, v175
    v_max3_f32 v55, v55, v188, v189
    v_max3_f32 v55, v55, v190, v191
    v_mov_b32 v6, v55
    s_nop 1
    v_permlane16_swap_b32 v55, v6
    s_nop 1
    v_max_f32 v55, v55, v6
    v_mov_b32 v6, v55
    s_nop 1
    v_permlane32_swap_b32 v55, v6
    s_nop 1
    v_max_f32 v55, v55, v6
    v_max_f32 v55, 0, v55
    v_sub_f32 v160, v160, v54
    v_sub_f32 v161, v161, v54
    v_sub_f32 v162, v162, v54
    v_sub_f32 v163, v163, v54
    v_sub_f32 v164, v164, v55
    v_sub_f32 v165, v165, v55
    v_sub_f32 v166, v166, v55
    v_sub_f32 v167, v167, v55
    v_sub_f32 v168, v168, v54
    v_sub_f32 v169, v169, v54
    v_sub_f32 v170, v170, v54
    v_sub_f32 v171, v171, v54
    v_sub_f32 v172, v172, v55
    v_sub_f32 v173, v173, v55
    v_sub_f32 v174, v174, v55
    v_sub_f32 v175, v175, v55
    v_sub_f32 v176, v176, v54
    v_sub_f32 v177, v177, v54
    v_sub_f32 v178, v178, v54
    v_sub_f32 v179, v179, v54
    v_sub_f32 v180, v180, v55
    v_sub_f32 v181, v181, v55
    v_sub_f32 v182, v182, v55
    v_sub_f32 v183, v183, v55
    v_sub_f32 v184, v184, v54
    v_sub_f32 v185, v185, v54
    v_sub_f32 v186, v186, v54
    v_sub_f32 v187, v187, v54
    v_sub_f32 v188, v188, v55
    v_sub_f32 v189, v189, v55
    v_sub_f32 v190, v190, v55
    v_sub_f32 v191, v191, v55
    v_sub_f32 v10, v10, v54
    v_exp_f32 v54, -v54
    v_sub_f32 v11, v11, v55
    v_exp_f32 v55, -v55
    s_nop 0
    v_mul_f32 v14, v14, v54
    v_mul_f32 v15, v15, v55
    v_accvgpr_read_b32 v224, a8
    v_accvgpr_read_b32 v225, a9
    v_accvgpr_read_b32 v226, a10
    v_accvgpr_read_b32 v227, a11
    v_mul_f32 v224, v224, v54
    v_mul_f32 v225, v225, v54
    v_mul_f32 v226, v226, v54
    v_mul_f32 v227, v227, v54
    v_accvgpr_write_b32 a8, v224
    v_accvgpr_write_b32 a9, v225
    v_accvgpr_write_b32 a10, v226
    v_accvgpr_write_b32 a11, v227
    v_accvgpr_read_b32 v224, a12
    v_accvgpr_read_b32 v225, a13
    v_accvgpr_read_b32 v226, a14
    v_accvgpr_read_b32 v227, a15
    v_mul_f32 v224, v224, v55
    v_mul_f32 v225, v225, v55
    v_mul_f32 v226, v226, v55
    v_mul_f32 v227, v227, v55
    v_accvgpr_write_b32 a12, v224
    v_accvgpr_write_b32 a13, v225
    v_accvgpr_write_b32 a14, v226
    v_accvgpr_write_b32 a15, v227
    v_accvgpr_read_b32 v224, a24
    v_accvgpr_read_b32 v225, a25
    v_accvgpr_read_b32 v226, a26
    v_accvgpr_read_b32 v227, a27
    v_mul_f32 v224, v224, v54
    v_mul_f32 v225, v225, v54
    v_mul_f32 v226, v226, v54
    v_mul_f32 v227, v227, v54
    v_accvgpr_write_b32 a24, v224
    v_accvgpr_write_b32 a25, v225
    v_accvgpr_write_b32 a26, v226
    v_accvgpr_write_b32 a27, v227
    v_accvgpr_read_b32 v224, a28
    v_accvgpr_read_b32 v225, a29
    v_accvgpr_read_b32 v226, a30
    v_accvgpr_read_b32 v227, a31
    v_mul_f32 v224, v224, v55
    v_mul_f32 v225, v225, v55
    v_mul_f32 v226, v226, v55
    v_mul_f32 v227, v227, v55
    v_accvgpr_write_b32 a28, v224
    v_accvgpr_write_b32 a29, v225
    v_accvgpr_write_b32 a30, v226
    v_accvgpr_write_b32 a31, v227
    v_accvgpr_read_b32 v224, a40
    v_accvgpr_read_b32 v225, a41
    v_accvgpr_read_b32 v226, a42
    v_accvgpr_read_b32 v227, a43
    v_mul_f32 v224, v224, v54
    v_mul_f32 v225, v225, v54
    v_mul_f32 v226, v226, v54
    v_mul_f32 v227, v227, v54
    v_accvgpr_write_b32 a40, v224
    v_accvgpr_write_b32 a41, v225
    v_accvgpr_write_b32 a42, v226
    v_accvgpr_write_b32 a43, v227
    v_accvgpr_read_b32 v224, a44
    v_accvgpr_read_b32 v225, a45
    v_accvgpr_read_b32 v226, a46
    v_accvgpr_read_b32 v227, a47
    v_mul_f32 v224, v224, v55
    v_mul_f32 v225, v225, v55
    v_mul_f32 v226, v226, v55
    v_mul_f32 v227, v227, v55
    v_accvgpr_write_b32 a44, v224
    v_accvgpr_write_b32 a45, v225
    v_accvgpr_write_b32 a46, v226
    v_accvgpr_write_b32 a47, v227
    v_accvgpr_read_b32 v224, a56
    v_accvgpr_read_b32 v225, a57
    v_accvgpr_read_b32 v226, a58
    v_accvgpr_read_b32 v227, a59
    v_mul_f32 v224, v224, v54
    v_mul_f32 v225, v225, v54
    v_mul_f32 v226, v226, v54
    v_mul_f32 v227, v227, v54
    v_accvgpr_write_b32 a56, v224
    v_accvgpr_write_b32 a57, v225
    v_accvgpr_write_b32 a58, v226
    v_accvgpr_write_b32 a59, v227
    v_accvgpr_read_b32 v224, a60
    v_accvgpr_read_b32 v225, a61
    v_accvgpr_read_b32 v226, a62
    v_accvgpr_read_b32 v227, a63
    v_mul_f32 v224, v224, v55
    v_mul_f32 v225, v225, v55
    v_mul_f32 v226, v226, v55
    v_mul_f32 v227, v227, v55
    v_accvgpr_write_b32 a60, v224
    v_accvgpr_write_b32 a61, v225
    v_accvgpr_write_b32 a62, v226
    v_accvgpr_write_b32 a63, v227
    v_accvgpr_read_b32 v224, a72
    v_accvgpr_read_b32 v225, a73
    v_accvgpr_read_b32 v226, a74
    v_accvgpr_read_b32 v227, a75
    v_mul_f32 v224, v224, v54
    v_mul_f32 v225, v225, v54
    v_mul_f32 v226, v226, v54
    v_mul_f32 v227, v227, v54
    v_accvgpr_write_b32 a72, v224
    v_accvgpr_write_b32 a73, v225
    v_accvgpr_write_b32 a74, v226
    v_accvgpr_write_b32 a75, v227
    v_accvgpr_read_b32 v224, a76
    v_accvgpr_read_b32 v225, a77
    v_accvgpr_read_b32 v226, a78
    v_accvgpr_read_b32 v227, a79
    v_mul_f32 v224, v224, v55
    v_mul_f32 v225, v225, v55
    v_mul_f32 v226, v226, v55
    v_mul_f32 v227, v227, v55
    v_accvgpr_write_b32 a76, v224
    v_accvgpr_write_b32 a77, v225
    v_accvgpr_write_b32 a78, v226
    v_accvgpr_write_b32 a79, v227
    v_accvgpr_read_b32 v224, a88
    v_accvgpr_read_b32 v225, a89
    v_accvgpr_read_b32 v226, a90
    v_accvgpr_read_b32 v227, a91
    v_mul_f32 v224, v224, v54
    v_mul_f32 v225, v225, v54
    v_mul_f32 v226, v226, v54
    v_mul_f32 v227, v227, v54
    v_accvgpr_write_b32 a88, v224
    v_accvgpr_write_b32 a89, v225
    v_accvgpr_write_b32 a90, v226
    v_accvgpr_write_b32 a91, v227
    v_accvgpr_read_b32 v224, a92
    v_accvgpr_read_b32 v225, a93
    v_accvgpr_read_b32 v226, a94
    v_accvgpr_read_b32 v227, a95
    v_mul_f32 v224, v224, v55
    v_mul_f32 v225, v225, v55
    v_mul_f32 v226, v226, v55
    v_mul_f32 v227, v227, v55
    v_accvgpr_write_b32 a92, v224
    v_accvgpr_write_b32 a93, v225
    v_accvgpr_write_b32 a94, v226
    v_accvgpr_write_b32 a95, v227
    v_accvgpr_read_b32 v224, a104
    v_accvgpr_read_b32 v225, a105
    v_accvgpr_read_b32 v226, a106
    v_accvgpr_read_b32 v227, a107
    v_mul_f32 v224, v224, v54
    v_mul_f32 v225, v225, v54
    v_mul_f32 v226, v226, v54
    v_mul_f32 v227, v227, v54
    v_accvgpr_write_b32 a104, v224
    v_accvgpr_write_b32 a105, v225
    v_accvgpr_write_b32 a106, v226
    v_accvgpr_write_b32 a107, v227
    v_accvgpr_read_b32 v224, a108
    v_accvgpr_read_b32 v225, a109
    v_accvgpr_read_b32 v226, a110
    v_accvgpr_read_b32 v227, a111
    v_mul_f32 v224, v224, v55
    v_mul_f32 v225, v225, v55
    v_mul_f32 v226, v226, v55
    v_mul_f32 v227, v227, v55
    v_accvgpr_write_b32 a108, v224
    v_accvgpr_write_b32 a109, v225
    v_accvgpr_write_b32 a110, v226
    v_accvgpr_write_b32 a111, v227
    v_accvgpr_read_b32 v224, a120
    v_accvgpr_read_b32 v225, a121
    v_accvgpr_read_b32 v226, a122
    v_accvgpr_read_b32 v227, a123
    v_mul_f32 v224, v224, v54
    v_mul_f32 v225, v225, v54
    v_mul_f32 v226, v226, v54
    v_mul_f32 v227, v227, v54
    v_accvgpr_write_b32 a120, v224
    v_accvgpr_write_b32 a121, v225
    v_accvgpr_write_b32 a122, v226
    v_accvgpr_write_b32 a123, v227
    v_accvgpr_read_b32 v224, a124
    v_accvgpr_read_b32 v225, a125
    v_accvgpr_read_b32 v226, a126
    v_accvgpr_read_b32 v227, a127
    v_mul_f32 v224, v224, v55
    v_mul_f32 v225, v225, v55
    v_mul_f32 v226, v226, v55
    v_mul_f32 v227, v227, v55
    v_accvgpr_write_b32 a124, v224
    v_accvgpr_write_b32 a125, v225
    v_accvgpr_write_b32 a126, v226
    v_accvgpr_write_b32 a127, v227
    v_exp_f32 v56, v160
    v_exp_f32 v57, v161
    v_exp_f32 v58, v162
    v_exp_f32 v59, v163
    v_add_f32 v48, v56, v57
    v_cvt_pk_bf16_f32 v208, v56, v57
    v_exp_f32 v60, v176
    v_exp_f32 v61, v177
    v_add_f32 v48, v48, v58
    v_add_f32 v48, v48, v59
    v_cvt_pk_bf16_f32 v209, v58, v59
    v_exp_f32 v62, v178
    v_exp_f32 v63, v179
    v_add_f32 v48, v48, v60
    v_add_f32 v48, v48, v61
    v_cvt_pk_bf16_f32 v210, v60, v61
    v_exp_f32 v56, v164
    v_exp_f32 v57, v165
    v_add_f32 v48, v48, v62
    v_add_f32 v48, v48, v63
    v_cvt_pk_bf16_f32 v211, v62, v63
    v_exp_f32 v58, v166
    v_exp_f32 v59, v167
    v_add_f32 v49, v56, v57
    v_cvt_pk_bf16_f32 v212, v56, v57
    v_exp_f32 v60, v180
    v_exp_f32 v61, v181
    v_add_f32 v49, v49, v58
    v_add_f32 v49, v49, v59
    v_cvt_pk_bf16_f32 v213, v58, v59
    v_exp_f32 v62, v182
    v_exp_f32 v63, v183
    v_add_f32 v49, v49, v60
    v_add_f32 v49, v49, v61
    v_cvt_pk_bf16_f32 v214, v60, v61
    v_exp_f32 v56, v168
    v_exp_f32 v57, v169
    v_add_f32 v49, v49, v62
    v_add_f32 v49, v49, v63
    v_cvt_pk_bf16_f32 v215, v62, v63
    v_exp_f32 v58, v170
    v_exp_f32 v59, v171
    v_add_f32 v50, v56, v57
    v_cvt_pk_bf16_f32 v216, v56, v57
    v_exp_f32 v60, v184
    v_exp_f32 v61, v185
    v_add_f32 v50, v50, v58
    v_add_f32 v50, v50, v59
    v_cvt_pk_bf16_f32 v217, v58, v59
    v_exp_f32 v62, v186
    v_exp_f32 v63, v187
    v_add_f32 v50, v50, v60
    v_add_f32 v50, v50, v61
    v_cvt_pk_bf16_f32 v218, v60, v61
    v_exp_f32 v56, v172
    v_exp_f32 v57, v173
    v_add_f32 v50, v50, v62
    v_add_f32 v50, v50, v63
    v_cvt_pk_bf16_f32 v219, v62, v63
    v_exp_f32 v58, v174
    v_exp_f32 v59, v175
    v_add_f32 v51, v56, v57
    v_cvt_pk_bf16_f32 v220, v56, v57
    v_exp_f32 v60, v188
    v_exp_f32 v61, v189
    v_add_f32 v51, v51, v58
    v_add_f32 v51, v51, v59
    v_cvt_pk_bf16_f32 v221, v58, v59
    v_exp_f32 v62, v190
    v_exp_f32 v63, v191
    v_add_f32 v51, v51, v60
    v_add_f32 v51, v51, v61
    v_cvt_pk_bf16_f32 v222, v60, v61
    s_nop 0
    v_add_f32 v51, v51, v62
    v_add_f32 v51, v51, v63
    v_cvt_pk_bf16_f32 v223, v62, v63
    s_nop 1
    s_branch k2_ret_33
.globl k3_kernel
.p2align 8
.type k3_kernel,@function
k3_kernel:
    s_cmp_ge_u32 s2, 256
    s_cbranch_scc1 k3_end_34
    s_load_dwordx2 s[4:5], s[0:1], 40
    s_load_dwordx2 s[6:7], s[0:1], 104
    s_load_dwordx2 s[28:29], s[0:1], 0
    s_load_dwordx2 s[30:31], s[0:1], 56
    s_and_b32 s40, s2, 7
    s_lshr_b32 s41, s2, 3
    s_and_b32 s42, s40, 3
    s_lshl_b32 s42, s42, 2
    s_and_b32 s43, s41, 3
    s_add_u32 s42, s42, s43
    s_lshr_b32 s43, s40, 2
    s_lshl_b32 s43, s43, 3
    s_lshr_b32 s44, s41, 2
    s_add_u32 s43, s43, s44
    v_lshrrev_b32 v10, 6, v0
    v_and_b32 v11, 63, v0
    v_readfirstlane_b32 s45, v10
    v_lshlrev_b32 v1, 4, v11
    s_lshl_b32 s46, s42, 7
    s_lshl_b32 s47, s45, 5
    s_add_u32 s46, s46, s47
    s_lshl_b32 s47, s46, 6
    v_add_u32 v12, s47, v1
    v_add_u32 v13, 0x20000, v12
    v_lshrrev_b32 v20, 3, v11
    v_bfe_u32 v21, v11, 1, 2
    v_bfe_u32 v22, v11, 4, 2
    v_xor_b32 v21, v21, v22
    v_and_b32 v22, 1, v11
    v_lshl_add_u32 v23, v10, 5, v20
    v_lshlrev_b32 v23, 11, v23
    v_lshl_add_u32 v23, v22, 4, v23
    v_lshl_add_u32 v23, v21, 5, v23
    s_lshl_b32 s47, s43, 7
    v_add_u32 v23, s47, v23
    v_add_u32 v16, 0, v23
    v_add_u32 v17, 15360, v23
    v_add_u32 v18, 30720, v23
    v_add_u32 v19, 46080, v23
    s_waitcnt lgkmcnt(0)
    s_add_u32 s8, s6, 0x3000000
    s_addc_u32 s9, s7, 0
    s_and_b32 s9, s9, 0xffff
    s_mov_b32 s10, 0x1000000
    s_mov_b32 s11, 0x00020000
    s_mov_b32 s12, s4
    s_and_b32 s13, s5, 0xffff
    s_mov_b32 s14, 0x800000
    s_mov_b32 s15, 0x00020000
    s_lshl_b32 s60, s45, 12
    s_mov_b32 s61, 0
    s_mov_b32 s62, 0
    s_lshl_b32 s50, s41, 2
    s_add_u32 s50, s50, s45
    s_and_b32 s51, s50, 63
    s_lshr_b32 s52, s51, 2
    s_lshl_b32 s52, s52, 17
    s_and_b32 s53, s51, 3
    s_lshl_b32 s53, s53, 13
    s_add_u32 s52, s52, s53
    s_and_b32 s53, s40, 3
    s_lshl_b32 s53, s53, 15
    s_add_u32 s52, s52, s53
    v_lshlrev_b32 v5, 7, v11
    s_lshl_b32 s53, s51, 14
    s_lshr_b32 s54, s40, 2
    s_lshl_b32 s54, s54, 10
    s_add_u32 s53, s53, s54
    v_and_b32 v6, 7, v11
    v_lshlrev_b32 v6, 7, v6
    v_lshl_add_u32 v6, v20, 11, v6
    s_cmp_lt_u32 s50, 64
    s_cselect_b32 s36, s8, s12
    s_cselect_b32 s37, s9, s13
    s_cselect_b32 s38, s10, s14
    s_mov_b32 s39, 0x00020000
    s_cselect_b32 s55, s52, s53
    s_mov_b32 s56, 0x100000
    s_cselect_b32 s56, 0x200000, s56
    s_cselect_b64 vcc, -1, 0
    v_cndmask_b32 v5, v6, v5, vcc
    buffer_load_dword v7, v5, s[36:39], s55 offen
    s_add_u32 s55, s55, s56
    buffer_load_dword v7, v5, s[36:39], s55 offen
    s_add_u32 s55, s55, s56
    s_mov_b32 s16, s28
    s_and_b32 s17, s29, 0xffff
    s_mov_b32 s18, 0x400000
    s_mov_b32 s19, 0x00020000
    s_mov_b32 s20, s30
    s_and_b32 s21, s31, 0xffff
    s_mov_b32 s22, 0x800
    s_mov_b32 s23, 0x00020000
    s_add_u32 s24, s6, 0x4000000
    s_addc_u32 s25, s7, 0
    s_and_b32 s25, s25, 0xffff
    s_mov_b32 s26, 0x400000
    s_mov_b32 s27, 0x00020000
    s_add_u32 s32, s6, 0x4800000
    s_addc_u32 s33, s7, 0
    s_and_b32 s33, s33, 0xffff
    s_mov_b32 s34, 0x6000
    s_mov_b32 s35, 0x00020000
    v_and_b32 v21, 15, v11
    v_lshrrev_b32 v20, 4, v11
    v_add_u32 v22, s46, v21
    v_lshlrev_b32 v2, 2, v22
    v_lshl_add_u32 v2, v20, 13, v2
    v_lshlrev_b32 v22, 11, v22
    v_lshl_add_u32 v14, v20, 3, s47
    v_add_u32 v3, v22, v14
    v_add_u32 v4, 0x8000, v3
    s_add_u32 m0, s60, 0
    s_nop 0
    buffer_load_dwordx4 v16, s[12:15], s61 offen offset:0 lds
    buffer_load_dwordx4 v17, s[12:15], s61 offen offset:1024 lds
    buffer_load_dwordx4 v18, s[12:15], s61 offen offset:2048 lds
    buffer_load_dwordx4 v19, s[12:15], s61 offen offset:3072 lds
    s_add_u32 s61, s61, 0x40000
    buffer_load_dwordx4 a[0:3], v12, s[8:11], s62 offen offset:0
    buffer_load_dwordx4 a[4:7], v12, s[8:11], s62 offen offset:1024
    buffer_load_dwordx4 a[8:11], v13, s[8:11], s62 offen offset:0
    buffer_load_dwordx4 a[12:15], v13, s[8:11], s62 offen offset:1024
    s_add_u32 s62, s62, 0x40000
    s_add_u32 m0, s60, 16384
    s_nop 0
    buffer_load_dwordx4 v16, s[12:15], s61 offen offset:0 lds
    buffer_load_dwordx4 v17, s[12:15], s61 offen offset:1024 lds
    buffer_load_dwordx4 v18, s[12:15], s61 offen offset:2048 lds
    buffer_load_dwordx4 v19, s[12:15], s61 offen offset:3072 lds
    s_add_u32 s61, s61, 0x40000
    buffer_load_dwordx4 a[16:19], v12, s[8:11], s62 offen offset:0
    buffer_load_dwordx4 a[20:23], v12, s[8:11], s62 offen offset:1024
    buffer_load_dwordx4 a[24:27], v13, s[8:11], s62 offen offset:0
    buffer_load_dwordx4 a[28:31], v13, s[8:11], s62 offen offset:1024
    s_add_u32 s62, s62, 0x40000
    buffer_load_dwordx4 a[32:35], v12, s[8:11], s62 offen offset:0
    buffer_load_dwordx4 a[36:39], v12, s[8:11], s62 offen offset:1024
    buffer_load_dwordx4 a[40:43], v13, s[8:11], s62 offen offset:0
    buffer_load_dwordx4 a[44:47], v13, s[8:11], s62 offen offset:1024
    s_add_u32 s62, s62, 0x40000
    s_add_u32 m0, s60, 32768
    s_nop 0
    buffer_load_dwordx4 v16, s[12:15], s61 offen offset:0 lds
    buffer_load_dwordx4 v17, s[12:15], s61 offen offset:1024 lds
    buffer_load_dwordx4 v18, s[12:15], s61 offen offset:2048 lds
    buffer_load_dwordx4 v19, s[12:15], s61 offen offset:3072 lds
    s_add_u32 s61, s61, 0x40000
    buffer_load_dwordx4 a[48:51], v12, s[8:11], s62 offen offset:0
    buffer_load_dwordx4 a[52:55], v12, s[8:11], s62 offen offset:1024
    buffer_load_dwordx4 a[56:59], v13, s[8:11], s62 offen offset:0
    buffer_load_dwordx4 a[60:63], v13, s[8:11], s62 offen offset:1024
    s_add_u32 s62, s62, 0x40000
    buffer_load_dwordx4 a[64:67], v12, s[8:11], s62 offen offset:0
    buffer_load_dwordx4 a[68:71], v12, s[8:11], s62 offen offset:1024
    buffer_load_dwordx4 a[72:75], v13, s[8:11], s62 offen offset:0
    buffer_load_dwordx4 a[76:79], v13, s[8:11], s62 offen offset:1024
    s_add_u32 s62, s62, 0x40000
    s_add_u32 m0, s60, 49152
    s_nop 0
    buffer_load_dwordx4 v16, s[12:15], s61 offen offset:0 lds
    buffer_load_dwordx4 v17, s[12:15], s61 offen offset:1024 lds
    buffer_load_dwordx4 v18, s[12:15], s61 offen offset:2048 lds
    buffer_load_dwordx4 v19, s[12:15], s61 offen offset:3072 lds
    s_add_u32 s61, s61, 0x40000
    buffer_load_dwordx4 a[80:83], v12, s[8:11], s62 offen offset:0
    buffer_load_dwordx4 a[84:87], v12, s[8:11], s62 offen offset:1024
    buffer_load_dwordx4 a[88:91], v13, s[8:11], s62 offen offset:0
    buffer_load_dwordx4 a[92:95], v13, s[8:11], s62 offen offset:1024
    s_add_u32 s62, s62, 0x40000
    buffer_load_dwordx4 a[96:99], v12, s[8:11], s62 offen offset:0
    buffer_load_dwordx4 a[100:103], v12, s[8:11], s62 offen offset:1024
    buffer_load_dwordx4 a[104:107], v13, s[8:11], s62 offen offset:0
    buffer_load_dwordx4 a[108:111], v13, s[8:11], s62 offen offset:1024
    s_add_u32 s62, s62, 0x40000
    v_lshrrev_b32 v22, 2, v21
    v_lshl_add_u32 v22, v20, 2, v22
    v_bfe_u32 v23, v22, 1, 2
    v_lshlrev_b32 v22, 7, v22
    v_and_b32 v28, 3, v11
    v_lshl_add_u32 v22, v28, 3, v22
    v_xor_b32 v28, 0, v23
    v_lshl_add_u32 v24, v28, 5, v22
    v_xor_b32 v28, 1, v23
    v_lshl_add_u32 v25, v28, 5, v22
    v_xor_b32 v28, 2, v23
    v_lshl_add_u32 v26, v28, 5, v22
    v_xor_b32 v28, 3, v23
    v_lshl_add_u32 v27, v28, 5, v22
    v_mov_b32 v64, 0
    v_mov_b32 v65, 0
    v_mov_b32 v66, 0
    v_mov_b32 v67, 0
    v_mov_b32 v68, 0
    v_mov_b32 v69, 0
    v_mov_b32 v70, 0
    v_mov_b32 v71, 0
    v_mov_b32 v72, 0
    v_mov_b32 v73, 0
    v_mov_b32 v74, 0
    v_mov_b32 v75, 0
    v_mov_b32 v76, 0
    v_mov_b32 v77, 0
    v_mov_b32 v78, 0
    v_mov_b32 v79, 0
    v_mov_b32 v80, 0
    v_mov_b32 v81, 0
    v_mov_b32 v82, 0
    v_mov_b32 v83, 0
    v_mov_b32 v84, 0
    v_mov_b32 v85, 0
    v_mov_b32 v86, 0
    v_mov_b32 v87, 0
    v_mov_b32 v88, 0
    v_mov_b32 v89, 0
    v_mov_b32 v90, 0
    v_mov_b32 v91, 0
    v_mov_b32 v92, 0
    v_mov_b32 v93, 0
    v_mov_b32 v94, 0
    v_mov_b32 v95, 0
    s_waitcnt vmcnt(40)
    s_barrier
    ds_read_b64_tr_b16 a[128:129], v24 offset:0
    ds_read_b64_tr_b16 a[130:131], v24 offset:2048
    ds_read_b64_tr_b16 a[132:133], v25 offset:0
    ds_read_b64_tr_b16 a[134:135], v25 offset:2048
    ds_read_b64_tr_b16 a[136:137], v26 offset:0
    ds_read_b64_tr_b16 a[138:139], v26 offset:2048
    ds_read_b64_tr_b16 a[140:141], v27 offset:0
    ds_read_b64_tr_b16 a[142:143], v27 offset:2048
    ds_read_b64_tr_b16 a[144:145], v24 offset:4096
    ds_read_b64_tr_b16 a[146:147], v24 offset:6144
    ds_read_b64_tr_b16 a[148:149], v25 offset:4096
    ds_read_b64_tr_b16 a[150:151], v25 offset:6144
    ds_read_b64_tr_b16 a[152:153], v26 offset:4096
    ds_read_b64_tr_b16 a[154:155], v26 offset:6144
    ds_read_b64_tr_b16 a[156:157], v27 offset:4096
    ds_read_b64_tr_b16 a[158:159], v27 offset:6144
    s_mov_b32 s63, 0
k3_loop_35:
    s_waitcnt vmcnt(36) lgkmcnt(0)
    v_mfma_f32_16x16x32_bf16 v[64:67], a[128:131], a[0:3], v[64:67]
    ds_read_b64_tr_b16 a[160:161], v24 offset:8192
    ds_read_b64_tr_b16 a[162:163], v24 offset:10240
    v_mfma_f32_16x16x32_bf16 v[68:71], a[128:131], a[4:7], v[68:71]
    ds_read_b64_tr_b16 a[164:165], v25 offset:8192
    ds_read_b64_tr_b16 a[166:167], v25 offset:10240
    v_mfma_f32_16x16x32_bf16 v[72:75], a[132:135], a[0:3], v[72:75]
    ds_read_b64_tr_b16 a[168:169], v26 offset:8192
    buffer_load_dword v7, v5, s[36:39], s55 offen
    s_add_u32 s55, s55, s56
    v_mfma_f32_16x16x32_bf16 v[76:79], a[132:135], a[4:7], v[76:79]
    ds_read_b64_tr_b16 a[170:171], v26 offset:10240
    ds_read_b64_tr_b16 a[172:173], v27 offset:8192
    v_mfma_f32_16x16x32_bf16 v[80:83], a[136:139], a[0:3], v[80:83]
    ds_read_b64_tr_b16 a[174:175], v27 offset:10240
    buffer_load_dwordx4 a[112:115], v12, s[8:11], s62 offen offset:0
    v_mfma_f32_16x16x32_bf16 v[84:87], a[136:139], a[4:7], v[84:87]
    ds_read_b64_tr_b16 a[176:177], v24 offset:12288
    ds_read_b64_tr_b16 a[178:179], v24 offset:14336
    v_mfma_f32_16x16x32_bf16 v[88:91], a[140:143], a[0:3], v[88:91]
    ds_read_b64_tr_b16 a[180:181], v25 offset:12288
    ds_read_b64_tr_b16 a[182:183], v25 offset:14336
    buffer_load_dwordx4 a[116:119], v12, s[8:11], s62 offen offset:1024
    v_mfma_f32_16x16x32_bf16 v[92:95], a[140:143], a[4:7], v[92:95]
    ds_read_b64_tr_b16 a[184:185], v26 offset:12288
    v_mfma_f32_16x16x32_bf16 v[64:67], a[144:147], a[8:11], v[64:67]
    ds_read_b64_tr_b16 a[186:187], v26 offset:14336
    ds_read_b64_tr_b16 a[188:189], v27 offset:12288
    buffer_load_dwordx4 a[120:123], v13, s[8:11], s62 offen offset:0
    v_mfma_f32_16x16x32_bf16 v[68:71], a[144:147], a[12:15], v[68:71]
    ds_read_b64_tr_b16 a[190:191], v27 offset:14336
    v_mfma_f32_16x16x32_bf16 v[72:75], a[148:151], a[8:11], v[72:75]
    buffer_load_dwordx4 a[124:127], v13, s[8:11], s62 offen offset:1024
    v_mfma_f32_16x16x32_bf16 v[76:79], a[148:151], a[12:15], v[76:79]
    v_mfma_f32_16x16x32_bf16 v[80:83], a[152:155], a[8:11], v[80:83]
    s_add_u32 s62, s62, 0x40000
    v_mfma_f32_16x16x32_bf16 v[84:87], a[152:155], a[12:15], v[84:87]
    v_mfma_f32_16x16x32_bf16 v[88:91], a[156:159], a[8:11], v[88:91]
    v_mfma_f32_16x16x32_bf16 v[92:95], a[156:159], a[12:15], v[92:95]
    s_waitcnt vmcnt(32) lgkmcnt(0)
    s_barrier
    v_mfma_f32_16x16x32_bf16 v[64:67], a[160:163], a[16:19], v[64:67]
    ds_read_b64_tr_b16 a[128:129], v24 offset:16384
    ds_read_b64_tr_b16 a[130:131], v24 offset:18432
    v_mfma_f32_16x16x32_bf16 v[68:71], a[160:163], a[20:23], v[68:71]
    ds_read_b64_tr_b16 a[132:133], v25 offset:16384
    ds_read_b64_tr_b16 a[134:135], v25 offset:18432
    s_add_u32 m0, s60, 0
    s_nop 0
    buffer_load_dwordx4 v16, s[12:15], s61 offen offset:0 lds
    v_mfma_f32_16x16x32_bf16 v[72:75], a[164:167], a[16:19], v[72:75]
    ds_read_b64_tr_b16 a[136:137], v26 offset:16384
    buffer_load_dwordx4 v17, s[12:15], s61 offen offset:1024 lds
    v_mfma_f32_16x16x32_bf16 v[76:79], a[164:167], a[20:23], v[76:79]
    ds_read_b64_tr_b16 a[138:139], v26 offset:18432
    ds_read_b64_tr_b16 a[140:141], v27 offset:16384
    buffer_load_dwordx4 v18, s[12:15], s61 offen offset:2048 lds
    v_mfma_f32_16x16x32_bf16 v[80:83], a[168:171], a[16:19], v[80:83]
    ds_read_b64_tr_b16 a[142:143], v27 offset:18432
    v_mfma_f32_16x16x32_bf16 v[84:87], a[168:171], a[20:23], v[84:87]
    ds_read_b64_tr_b16 a[144:145], v24 offset:20480
    ds_read_b64_tr_b16 a[146:147], v24 offset:22528
    buffer_load_dwordx4 v19, s[12:15], s61 offen offset:3072 lds
    v_mfma_f32_16x16x32_bf16 v[88:91], a[172:175], a[16:19], v[88:91]
    ds_read_b64_tr_b16 a[148:149], v25 offset:20480
    ds_read_b64_tr_b16 a[150:151], v25 offset:22528
    s_add_u32 s61, s61, 0x40000
    v_mfma_f32_16x16x32_bf16 v[92:95], a[172:175], a[20:23], v[92:95]
    ds_read_b64_tr_b16 a[152:153], v26 offset:20480
    v_mfma_f32_16x16x32_bf16 v[64:67], a[176:179], a[24:27], v[64:67]
    ds_read_b64_tr_b16 a[154:155], v26 offset:22528
    ds_read_b64_tr_b16 a[156:157], v27 offset:20480
    buffer_load_dwordx4 a[0:3], v12, s[8:11], s62 offen offset:0
    v_mfma_f32_16x16x32_bf16 v[68:71], a[176:179], a[28:31], v[68:71]
    ds_read_b64_tr_b16 a[158:159], v27 offset:22528
    buffer_load_dwordx4 a[4:7], v12, s[8:11], s62 offen offset:1024
    v_mfma_f32_16x16x32_bf16 v[72:75], a[180:183], a[24:27], v[72:75]
    buffer_load_dwordx4 a[8:11], v13, s[8:11], s62 offen offset:0
    v_mfma_f32_16x16x32_bf16 v[76:79], a[180:183], a[28:31], v[76:79]
    v_mfma_f32_16x16x32_bf16 v[80:83], a[184:187], a[24:27], v[80:83]
    buffer_load_dwordx4 a[12:15], v13, s[8:11], s62 offen offset:1024
    v_mfma_f32_16x16x32_bf16 v[84:87], a[184:187], a[28:31], v[84:87]
    s_add_u32 s62, s62, 0x40000
    v_mfma_f32_16x16x32_bf16 v[88:91], a[188:191], a[24:27], v[88:91]
    v_mfma_f32_16x16x32_bf16 v[92:95], a[188:191], a[28:31], v[92:95]
    s_waitcnt vmcnt(36) lgkmcnt(0)
    v_mfma_f32_16x16x32_bf16 v[64:67], a[128:131], a[32:35], v[64:67]
    ds_read_b64_tr_b16 a[160:161], v24 offset:24576
    ds_read_b64_tr_b16 a[162:163], v24 offset:26624
    v_mfma_f32_16x16x32_bf16 v[68:71], a[128:131], a[36:39], v[68:71]
    ds_read_b64_tr_b16 a[164:165], v25 offset:24576
    ds_read_b64_tr_b16 a[166:167], v25 offset:26624
    v_mfma_f32_16x16x32_bf16 v[72:75], a[132:135], a[32:35], v[72:75]
    ds_read_b64_tr_b16 a[168:169], v26 offset:24576
    buffer_load_dwordx4 a[16:19], v12, s[8:11], s62 offen offset:0
    v_mfma_f32_16x16x32_bf16 v[76:79], a[132:135], a[36:39], v[76:79]
    ds_read_b64_tr_b16 a[170:171], v26 offset:26624
    ds_read_b64_tr_b16 a[172:173], v27 offset:24576
    v_mfma_f32_16x16x32_bf16 v[80:83], a[136:139], a[32:35], v[80:83]
    ds_read_b64_tr_b16 a[174:175], v27 offset:26624
    buffer_load_dwordx4 a[20:23], v12, s[8:11], s62 offen offset:1024
    v_mfma_f32_16x16x32_bf16 v[84:87], a[136:139], a[36:39], v[84:87]
    ds_read_b64_tr_b16 a[176:177], v24 offset:28672
    ds_read_b64_tr_b16 a[178:179], v24 offset:30720
    v_mfma_f32_16x16x32_bf16 v[88:91], a[140:143], a[32:35], v[88:91]
    ds_read_b64_tr_b16 a[180:181], v25 offset:28672
    ds_read_b64_tr_b16 a[182:183], v25 offset:30720
    buffer_load_dwordx4 a[24:27], v13, s[8:11], s62 offen offset:0
    v_mfma_f32_16x16x32_bf16 v[92:95], a[140:143], a[36:39], v[92:95]
    ds_read_b64_tr_b16 a[184:185], v26 offset:28672
    v_mfma_f32_16x16x32_bf16 v[64:67], a[144:147], a[40:43], v[64:67]
    ds_read_b64_tr_b16 a[186:187], v26 offset:30720
    ds_read_b64_tr_b16 a[188:189], v27 offset:28672
    v_mfma_f32_16x16x32_bf16 v[68:71], a[144:147], a[44:47], v[68:71]
    ds_read_b64_tr_b16 a[190:191], v27 offset:30720
    buffer_load_dwordx4 a[28:31], v13, s[8:11], s62 offen offset:1024
    v_mfma_f32_16x16x32_bf16 v[72:75], a[148:151], a[40:43], v[72:75]
    v_mfma_f32_16x16x32_bf16 v[76:79], a[148:151], a[44:47], v[76:79]
    s_add_u32 s62, s62, 0x40000
    v_mfma_f32_16x16x32_bf16 v[80:83], a[152:155], a[40:43], v[80:83]
    v_mfma_f32_16x16x32_bf16 v[84:87], a[152:155], a[44:47], v[84:87]
    v_mfma_f32_16x16x32_bf16 v[88:91], a[156:159], a[40:43], v[88:91]
    v_mfma_f32_16x16x32_bf16 v[92:95], a[156:159], a[44:47], v[92:95]
    s_waitcnt vmcnt(32) lgkmcnt(0)
    s_barrier
    v_mfma_f32_16x16x32_bf16 v[64:67], a[160:163], a[48:51], v[64:67]
    ds_read_b64_tr_b16 a[128:129], v24 offset:32768
    ds_read_b64_tr_b16 a[130:131], v24 offset:34816
    v_mfma_f32_16x16x32_bf16 v[68:71], a[160:163], a[52:55], v[68:71]
    ds_read_b64_tr_b16 a[132:133], v25 offset:32768
    ds_read_b64_tr_b16 a[134:135], v25 offset:34816
    s_add_u32 m0, s60, 16384
    s_nop 0
    buffer_load_dwordx4 v16, s[12:15], s61 offen offset:0 lds
    v_mfma_f32_16x16x32_bf16 v[72:75], a[164:167], a[48:51], v[72:75]
    ds_read_b64_tr_b16 a[136:137], v26 offset:32768
    buffer_load_dwordx4 v17, s[12:15], s61 offen offset:1024 lds
    v_mfma_f32_16x16x32_bf16 v[76:79], a[164:167], a[52:55], v[76:79]
    ds_read_b64_tr_b16 a[138:139], v26 offset:34816
    ds_read_b64_tr_b16 a[140:141], v27 offset:32768
    buffer_load_dwordx4 v18, s[12:15], s61 offen offset:2048 lds
    v_mfma_f32_16x16x32_bf16 v[80:83], a[168:171], a[48:51], v[80:83]
    ds_read_b64_tr_b16 a[142:143], v27 offset:34816
    v_mfma_f32_16x16x32_bf16 v[84:87], a[168:171], a[52:55], v[84:87]
    ds_read_b64_tr_b16 a[144:145], v24 offset:36864
    ds_read_b64_tr_b16 a[146:147], v24 offset:38912
    buffer_load_dwordx4 v19, s[12:15], s61 offen offset:3072 lds
    v_mfma_f32_16x16x32_bf16 v[88:91], a[172:175], a[48:51], v[88:91]
    ds_read_b64_tr_b16 a[148:149], v25 offset:36864
    ds_read_b64_tr_b16 a[150:151], v25 offset:38912
    s_add_u32 s61, s61, 0x40000
    v_mfma_f32_16x16x32_bf16 v[92:95], a[172:175], a[52:55], v[92:95]
    ds_read_b64_tr_b16 a[152:153], v26 offset:36864
    v_mfma_f32_16x16x32_bf16 v[64:67], a[176:179], a[56:59], v[64:67]
    ds_read_b64_tr_b16 a[154:155], v26 offset:38912
    ds_read_b64_tr_b16 a[156:157], v27 offset:36864
    buffer_load_dwordx4 a[32:35], v12, s[8:11], s62 offen offset:0
    v_mfma_f32_16x16x32_bf16 v[68:71], a[176:179], a[60:63], v[68:71]
    ds_read_b64_tr_b16 a[158:159], v27 offset:38912
    buffer_load_dwordx4 a[36:39], v12, s[8:11], s62 offen offset:1024
    v_mfma_f32_16x16x32_bf16 v[72:75], a[180:183], a[56:59], v[72:75]
    buffer_load_dwordx4 a[40:43], v13, s[8:11], s62 offen offset:0
    v_mfma_f32_16x16x32_bf16 v[76:79], a[180:183], a[60:63], v[76:79]
    v_mfma_f32_16x16x32_bf16 v[80:83], a[184:187], a[56:59], v[80:83]
    buffer_load_dwordx4 a[44:47], v13, s[8:11], s62 offen offset:1024
    v_mfma_f32_16x16x32_bf16 v[84:87], a[184:187], a[60:63], v[84:87]
    s_add_u32 s62, s62, 0x40000
    v_mfma_f32_16x16x32_bf16 v[88:91], a[188:191], a[56:59], v[88:91]
    v_mfma_f32_16x16x32_bf16 v[92:95], a[188:191], a[60:63], v[92:95]
    s_waitcnt vmcnt(36) lgkmcnt(0)
    v_mfma_f32_16x16x32_bf16 v[64:67], a[128:131], a[64:67], v[64:67]
    ds_read_b64_tr_b16 a[160:161], v24 offset:40960
    ds_read_b64_tr_b16 a[162:163], v24 offset:43008
    v_mfma_f32_16x16x32_bf16 v[68:71], a[128:131], a[68:71], v[68:71]
    ds_read_b64_tr_b16 a[164:165], v25 offset:40960
    ds_read_b64_tr_b16 a[166:167], v25 offset:43008
    v_mfma_f32_16x16x32_bf16 v[72:75], a[132:135], a[64:67], v[72:75]
    ds_read_b64_tr_b16 a[168:169], v26 offset:40960
    buffer_load_dwordx4 a[48:51], v12, s[8:11], s62 offen offset:0
    v_mfma_f32_16x16x32_bf16 v[76:79], a[132:135], a[68:71], v[76:79]
    ds_read_b64_tr_b16 a[170:171], v26 offset:43008
    ds_read_b64_tr_b16 a[172:173], v27 offset:40960
    v_mfma_f32_16x16x32_bf16 v[80:83], a[136:139], a[64:67], v[80:83]
    ds_read_b64_tr_b16 a[174:175], v27 offset:43008
    buffer_load_dwordx4 a[52:55], v12, s[8:11], s62 offen offset:1024
    v_mfma_f32_16x16x32_bf16 v[84:87], a[136:139], a[68:71], v[84:87]
    ds_read_b64_tr_b16 a[176:177], v24 offset:45056
    ds_read_b64_tr_b16 a[178:179], v24 offset:47104
    v_mfma_f32_16x16x32_bf16 v[88:91], a[140:143], a[64:67], v[88:91]
    ds_read_b64_tr_b16 a[180:181], v25 offset:45056
    ds_read_b64_tr_b16 a[182:183], v25 offset:47104
    buffer_load_dwordx4 a[56:59], v13, s[8:11], s62 offen offset:0
    v_mfma_f32_16x16x32_bf16 v[92:95], a[140:143], a[68:71], v[92:95]
    ds_read_b64_tr_b16 a[184:185], v26 offset:45056
    v_mfma_f32_16x16x32_bf16 v[64:67], a[144:147], a[72:75], v[64:67]
    ds_read_b64_tr_b16 a[186:187], v26 offset:47104
    ds_read_b64_tr_b16 a[188:189], v27 offset:45056
    v_mfma_f32_16x16x32_bf16 v[68:71], a[144:147], a[76:79], v[68:71]
    ds_read_b64_tr_b16 a[190:191], v27 offset:47104
    buffer_load_dwordx4 a[60:63], v13, s[8:11], s62 offen offset:1024
    v_mfma_f32_16x16x32_bf16 v[72:75], a[148:151], a[72:75], v[72:75]
    v_mfma_f32_16x16x32_bf16 v[76:79], a[148:151], a[76:79], v[76:79]
    s_add_u32 s62, s62, 0x40000
    v_mfma_f32_16x16x32_bf16 v[80:83], a[152:155], a[72:75], v[80:83]
    v_mfma_f32_16x16x32_bf16 v[84:87], a[152:155], a[76:79], v[84:87]
    v_mfma_f32_16x16x32_bf16 v[88:91], a[156:159], a[72:75], v[88:91]
    v_mfma_f32_16x16x32_bf16 v[92:95], a[156:159], a[76:79], v[92:95]
    s_waitcnt vmcnt(32) lgkmcnt(0)
    s_barrier
    v_mfma_f32_16x16x32_bf16 v[64:67], a[160:163], a[80:83], v[64:67]
    ds_read_b64_tr_b16 a[128:129], v24 offset:49152
    ds_read_b64_tr_b16 a[130:131], v24 offset:51200
    v_mfma_f32_16x16x32_bf16 v[68:71], a[160:163], a[84:87], v[68:71]
    ds_read_b64_tr_b16 a[132:133], v25 offset:49152
    ds_read_b64_tr_b16 a[134:135], v25 offset:51200
    s_add_u32 m0, s60, 32768
    s_nop 0
    buffer_load_dwordx4 v16, s[12:15], s61 offen offset:0 lds
    v_mfma_f32_16x16x32_bf16 v[72:75], a[164:167], a[80:83], v[72:75]
    ds_read_b64_tr_b16 a[136:137], v26 offset:49152
    buffer_load_dwordx4 v17, s[12:15], s61 offen offset:1024 lds
    v_mfma_f32_16x16x32_bf16 v[76:79], a[164:167], a[84:87], v[76:79]
    ds_read_b64_tr_b16 a[138:139], v26 offset:51200
    ds_read_b64_tr_b16 a[140:141], v27 offset:49152
    buffer_load_dwordx4 v18, s[12:15], s61 offen offset:2048 lds
    v_mfma_f32_16x16x32_bf16 v[80:83], a[168:171], a[80:83], v[80:83]
    ds_read_b64_tr_b16 a[142:143], v27 offset:51200
    v_mfma_f32_16x16x32_bf16 v[84:87], a[168:171], a[84:87], v[84:87]
    ds_read_b64_tr_b16 a[144:145], v24 offset:53248
    ds_read_b64_tr_b16 a[146:147], v24 offset:55296
    buffer_load_dwordx4 v19, s[12:15], s61 offen offset:3072 lds
    v_mfma_f32_16x16x32_bf16 v[88:91], a[172:175], a[80:83], v[88:91]
    ds_read_b64_tr_b16 a[148:149], v25 offset:53248
    ds_read_b64_tr_b16 a[150:151], v25 offset:55296
    s_add_u32 s61, s61, 0x40000
    v_mfma_f32_16x16x32_bf16 v[92:95], a[172:175], a[84:87], v[92:95]
    ds_read_b64_tr_b16 a[152:153], v26 offset:53248
    v_mfma_f32_16x16x32_bf16 v[64:67], a[176:179], a[88:91], v[64:67]
    ds_read_b64_tr_b16 a[154:155], v26 offset:55296
    ds_read_b64_tr_b16 a[156:157], v27 offset:53248
    buffer_load_dwordx4 a[64:67], v12, s[8:11], s62 offen offset:0
    v_mfma_f32_16x16x32_bf16 v[68:71], a[176:179], a[92:95], v[68:71]
    ds_read_b64_tr_b16 a[158:159], v27 offset:55296
    buffer_load_dwordx4 a[68:71], v12, s[8:11], s62 offen offset:1024
    v_mfma_f32_16x16x32_bf16 v[72:75], a[180:183], a[88:91], v[72:75]
    buffer_load_dwordx4 a[72:75], v13, s[8:11], s62 offen offset:0
    v_mfma_f32_16x16x32_bf16 v[76:79], a[180:183], a[92:95], v[76:79]
    v_mfma_f32_16x16x32_bf16 v[80:83], a[184:187], a[88:91], v[80:83]
    buffer_load_dwordx4 a[76:79], v13, s[8:11], s62 offen offset:1024
    v_mfma_f32_16x16x32_bf16 v[84:87], a[184:187], a[92:95], v[84:87]
    s_add_u32 s62, s62, 0x40000
    v_mfma_f32_16x16x32_bf16 v[88:91], a[188:191], a[88:91], v[88:91]
    v_mfma_f32_16x16x32_bf16 v[92:95], a[188:191], a[92:95], v[92:95]
    s_waitcnt vmcnt(36) lgkmcnt(0)
    v_mfma_f32_16x16x32_bf16 v[64:67], a[128:131], a[96:99], v[64:67]
    ds_read_b64_tr_b16 a[160:161], v24 offset:57344
    ds_read_b64_tr_b16 a[162:163], v24 offset:59392
    v_mfma_f32_16x16x32_bf16 v[68:71], a[128:131], a[100:103], v[68:71]
    ds_read_b64_tr_b16 a[164:165], v25 offset:57344
    ds_read_b64_tr_b16 a[166:167], v25 offset:59392
    v_mfma_f32_16x16x32_bf16 v[72:75], a[132:135], a[96:99], v[72:75]
    ds_read_b64_tr_b16 a[168:169], v26 offset:57344
    buffer_load_dwordx4 a[80:83], v12, s[8:11], s62 offen offset:0
    v_mfma_f32_16x16x32_bf16 v[76:79], a[132:135], a[100:103], v[76:79]
    ds_read_b64_tr_b16 a[170:171], v26 offset:59392
    ds_read_b64_tr_b16 a[172:173], v27 offset:57344
    v_mfma_f32_16x16x32_bf16 v[80:83], a[136:139], a[96:99], v[80:83]
    ds_read_b64_tr_b16 a[174:175], v27 offset:59392
    buffer_load_dwordx4 a[84:87], v12, s[8:11], s62 offen offset:1024
    v_mfma_f32_16x16x32_bf16 v[84:87], a[136:139], a[100:103], v[84:87]
    ds_read_b64_tr_b16 a[176:177], v24 offset:61440
    ds_read_b64_tr_b16 a[178:179], v24 offset:63488
    v_mfma_f32_16x16x32_bf16 v[88:91], a[140:143], a[96:99], v[88:91]
    ds_read_b64_tr_b16 a[180:181], v25 offset:61440
    ds_read_b64_tr_b16 a[182:183], v25 offset:63488
    buffer_load_dwordx4 a[88:91], v13, s[8:11], s62 offen offset:0
    v_mfma_f32_16x16x32_bf16 v[92:95], a[140:143], a[100:103], v[92:95]
    ds_read_b64_tr_b16 a[184:185], v26 offset:61440
    v_mfma_f32_16x16x32_bf16 v[64:67], a[144:147], a[104:107], v[64:67]
    ds_read_b64_tr_b16 a[186:187], v26 offset:63488
    ds_read_b64_tr_b16 a[188:189], v27 offset:61440
    v_mfma_f32_16x16x32_bf16 v[68:71], a[144:147], a[108:111], v[68:71]
    ds_read_b64_tr_b16 a[190:191], v27 offset:63488
    buffer_load_dwordx4 a[92:95], v13, s[8:11], s62 offen offset:1024
    v_mfma_f32_16x16x32_bf16 v[72:75], a[148:151], a[104:107], v[72:75]
    v_mfma_f32_16x16x32_bf16 v[76:79], a[148:151], a[108:111], v[76:79]
    s_add_u32 s62, s62, 0x40000
    v_mfma_f32_16x16x32_bf16 v[80:83], a[152:155], a[104:107], v[80:83]
    v_mfma_f32_16x16x32_bf16 v[84:87], a[152:155], a[108:111], v[84:87]
    v_mfma_f32_16x16x32_bf16 v[88:91], a[156:159], a[104:107], v[88:91]
    v_mfma_f32_16x16x32_bf16 v[92:95], a[156:159], a[108:111], v[92:95]
    s_waitcnt vmcnt(32) lgkmcnt(0)
    s_barrier
    v_mfma_f32_16x16x32_bf16 v[64:67], a[160:163], a[112:115], v[64:67]
    ds_read_b64_tr_b16 a[128:129], v24 offset:0
    ds_read_b64_tr_b16 a[130:131], v24 offset:2048
    v_mfma_f32_16x16x32_bf16 v[68:71], a[160:163], a[116:119], v[68:71]
    ds_read_b64_tr_b16 a[132:133], v25 offset:0
    ds_read_b64_tr_b16 a[134:135], v25 offset:2048
    s_add_u32 m0, s60, 49152
    s_nop 0
    buffer_load_dwordx4 v16, s[12:15], s61 offen offset:0 lds
    v_mfma_f32_16x16x32_bf16 v[72:75], a[164:167], a[112:115], v[72:75]
    ds_read_b64_tr_b16 a[136:137], v26 offset:0
    buffer_load_dwordx4 v17, s[12:15], s61 offen offset:1024 lds
    v_mfma_f32_16x16x32_bf16 v[76:79], a[164:167], a[116:119], v[76:79]
    ds_read_b64_tr_b16 a[138:139], v26 offset:2048
    ds_read_b64_tr_b16 a[140:141], v27 offset:0
    buffer_load_dwordx4 v18, s[12:15], s61 offen offset:2048 lds
    v_mfma_f32_16x16x32_bf16 v[80:83], a[168:171], a[112:115], v[80:83]
    ds_read_b64_tr_b16 a[142:143], v27 offset:2048
    v_mfma_f32_16x16x32_bf16 v[84:87], a[168:171], a[116:119], v[84:87]
    ds_read_b64_tr_b16 a[144:145], v24 offset:4096
    ds_read_b64_tr_b16 a[146:147], v24 offset:6144
    buffer_load_dwordx4 v19, s[12:15], s61 offen offset:3072 lds
    v_mfma_f32_16x16x32_bf16 v[88:91], a[172:175], a[112:115], v[88:91]
    ds_read_b64_tr_b16 a[148:149], v25 offset:4096
    ds_read_b64_tr_b16 a[150:151], v25 offset:6144
    s_add_u32 s61, s61, 0x40000
    v_mfma_f32_16x16x32_bf16 v[92:95], a[172:175], a[116:119], v[92:95]
    ds_read_b64_tr_b16 a[152:153], v26 offset:4096
    v_mfma_f32_16x16x32_bf16 v[64:67], a[176:179], a[120:123], v[64:67]
    ds_read_b64_tr_b16 a[154:155], v26 offset:6144
    ds_read_b64_tr_b16 a[156:157], v27 offset:4096
    buffer_load_dwordx4 a[96:99], v12, s[8:11], s62 offen offset:0
    v_mfma_f32_16x16x32_bf16 v[68:71], a[176:179], a[124:127], v[68:71]
    ds_read_b64_tr_b16 a[158:159], v27 offset:6144
    buffer_load_dwordx4 a[100:103], v12, s[8:11], s62 offen offset:1024
    v_mfma_f32_16x16x32_bf16 v[72:75], a[180:183], a[120:123], v[72:75]
    buffer_load_dwordx4 a[104:107], v13, s[8:11], s62 offen offset:0
    v_mfma_f32_16x16x32_bf16 v[76:79], a[180:183], a[124:127], v[76:79]
    v_mfma_f32_16x16x32_bf16 v[80:83], a[184:187], a[120:123], v[80:83]
    buffer_load_dwordx4 a[108:111], v13, s[8:11], s62 offen offset:1024
    v_mfma_f32_16x16x32_bf16 v[84:87], a[184:187], a[124:127], v[84:87]
    s_add_u32 s62, s62, 0x40000
    v_mfma_f32_16x16x32_bf16 v[88:91], a[188:191], a[120:123], v[88:91]
    v_mfma_f32_16x16x32_bf16 v[92:95], a[188:191], a[124:127], v[92:95]
    s_add_u32 s63, s63, 1
    s_cmp_lt_u32 s63, 8
    s_cbranch_scc1 k3_loop_35
    buffer_load_dwordx2 v[96:97], v3, s[16:19], 0 offen offset:0
    buffer_load_dwordx2 v[100:101], v3, s[16:19], 0 offen offset:32
    buffer_load_dwordx2 v[104:105], v3, s[16:19], 0 offen offset:64
    buffer_load_dwordx2 v[108:109], v3, s[16:19], 0 offen offset:96
    buffer_load_dwordx2 v[98:99], v4, s[16:19], 0 offen offset:0
    buffer_load_dwordx2 v[102:103], v4, s[16:19], 0 offen offset:32
    buffer_load_dwordx2 v[106:107], v4, s[16:19], 0 offen offset:64
    buffer_load_dwordx2 v[110:111], v4, s[16:19], 0 offen offset:96
    buffer_load_dwordx2 v[112:113], v14, s[20:23], 0 offen offset:0
    buffer_load_dwordx2 v[114:115], v14, s[20:23], 0 offen offset:32
    buffer_load_dwordx2 v[116:117], v14, s[20:23], 0 offen offset:64
    buffer_load_dwordx2 v[118:119], v14, s[20:23], 0 offen offset:96
    s_waitcnt vmcnt(0)
    v_lshlrev_b32 v32, 16, v112
    v_and_b32 v33, 0xffff0000, v112
    v_lshlrev_b32 v34, 16, v113
    v_and_b32 v35, 0xffff0000, v113
    v_lshlrev_b32 v36, 16, v114
    v_and_b32 v37, 0xffff0000, v114
    v_lshlrev_b32 v38, 16, v115
    v_and_b32 v39, 0xffff0000, v115
    v_lshlrev_b32 v40, 16, v116
    v_and_b32 v41, 0xffff0000, v116
    v_lshlrev_b32 v42, 16, v117
    v_and_b32 v43, 0xffff0000, v117
    v_lshlrev_b32 v44, 16, v118
    v_and_b32 v45, 0xffff0000, v118
    v_lshlrev_b32 v46, 16, v119
    v_and_b32 v47, 0xffff0000, v119
    v_mov_b32 v48, 0
    v_mov_b32 v49, 0
    v_mov_b32 v50, 0
    v_cvt_pk_bf16_f32 v56, v64, v65
    v_lshlrev_b32 v57, 16, v56
    v_and_b32 v58, 0xffff0000, v56
    v_lshlrev_b32 v59, 16, v96
    v_and_b32 v60, 0xffff0000, v96
    v_add_f32 v57, v57, v59
    v_add_f32 v58, v58, v60
    v_cvt_pk_bf16_f32 v96, v57, v58
    v_lshlrev_b32 v57, 16, v96
    v_and_b32 v58, 0xffff0000, v96
    v_add_f32 v48, v48, v57
    v_fmac_f32 v49, v57, v57
    v_fmac_f32 v50, v57, v32
    v_add_f32 v48, v48, v58
    v_fmac_f32 v49, v58, v58
    v_fmac_f32 v50, v58, v33
    v_cvt_pk_bf16_f32 v56, v66, v67
    v_lshlrev_b32 v57, 16, v56
    v_and_b32 v58, 0xffff0000, v56
    v_lshlrev_b32 v59, 16, v97
    v_and_b32 v60, 0xffff0000, v97
    v_add_f32 v57, v57, v59
    v_add_f32 v58, v58, v60
    v_cvt_pk_bf16_f32 v97, v57, v58
    v_lshlrev_b32 v57, 16, v97
    v_and_b32 v58, 0xffff0000, v97
    v_add_f32 v48, v48, v57
    v_fmac_f32 v49, v57, v57
    v_fmac_f32 v50, v57, v34
    v_add_f32 v48, v48, v58
    v_fmac_f32 v49, v58, v58
    v_fmac_f32 v50, v58, v35
    buffer_store_dwordx2 v[96:97], v3, s[24:27], 0 offen offset:0
    v_cvt_pk_bf16_f32 v56, v72, v73
    v_lshlrev_b32 v57, 16, v56
    v_and_b32 v58, 0xffff0000, v56
    v_lshlrev_b32 v59, 16, v100
    v_and_b32 v60, 0xffff0000, v100
    v_add_f32 v57, v57, v59
    v_add_f32 v58, v58, v60
    v_cvt_pk_bf16_f32 v100, v57, v58
    v_lshlrev_b32 v57, 16, v100
    v_and_b32 v58, 0xffff0000, v100
    v_add_f32 v48, v48, v57
    v_fmac_f32 v49, v57, v57
    v_fmac_f32 v50, v57, v36
    v_add_f32 v48, v48, v58
    v_fmac_f32 v49, v58, v58
    v_fmac_f32 v50, v58, v37
    v_cvt_pk_bf16_f32 v56, v74, v75
    v_lshlrev_b32 v57, 16, v56
    v_and_b32 v58, 0xffff0000, v56
    v_lshlrev_b32 v59, 16, v101
    v_and_b32 v60, 0xffff0000, v101
    v_add_f32 v57, v57, v59
    v_add_f32 v58, v58, v60
    v_cvt_pk_bf16_f32 v101, v57, v58
    v_lshlrev_b32 v57, 16, v101
    v_and_b32 v58, 0xffff0000, v101
    v_add_f32 v48, v48, v57
    v_fmac_f32 v49, v57, v57
    v_fmac_f32 v50, v57, v38
    v_add_f32 v48, v48, v58
    v_fmac_f32 v49, v58, v58
    v_fmac_f32 v50, v58, v39
    buffer_store_dwordx2 v[100:101], v3, s[24:27], 0 offen offset:32
    v_cvt_pk_bf16_f32 v56, v80, v81
    v_lshlrev_b32 v57, 16, v56
    v_and_b32 v58, 0xffff0000, v56
    v_lshlrev_b32 v59, 16, v104
    v_and_b32 v60, 0xffff0000, v104
    v_add_f32 v57, v57, v59
    v_add_f32 v58, v58, v60
    v_cvt_pk_bf16_f32 v104, v57, v58
    v_lshlrev_b32 v57, 16, v104
    v_and_b32 v58, 0xffff0000, v104
    v_add_f32 v48, v48, v57
    v_fmac_f32 v49, v57, v57
    v_fmac_f32 v50, v57, v40
    v_add_f32 v48, v48, v58
    v_fmac_f32 v49, v58, v58
    v_fmac_f32 v50, v58, v41
    v_cvt_pk_bf16_f32 v56, v82, v83
    v_lshlrev_b32 v57, 16, v56
    v_and_b32 v58, 0xffff0000, v56
    v_lshlrev_b32 v59, 16, v105
    v_and_b32 v60, 0xffff0000, v105
    v_add_f32 v57, v57, v59
    v_add_f32 v58, v58, v60
    v_cvt_pk_bf16_f32 v105, v57, v58
    v_lshlrev_b32 v57, 16, v105
    v_and_b32 v58, 0xffff0000, v105
    v_add_f32 v48, v48, v57
    v_fmac_f32 v49, v57, v57
    v_fmac_f32 v50, v57, v42
    v_add_f32 v48, v48, v58
    v_fmac_f32 v49, v58, v58
    v_fmac_f32 v50, v58, v43
    buffer_store_dwordx2 v[104:105], v3, s[24:27], 0 offen offset:64
    v_cvt_pk_bf16_f32 v56, v88, v89
    v_lshlrev_b32 v57, 16, v56
    v_and_b32 v58, 0xffff0000, v56
    v_lshlrev_b32 v59, 16, v108
    v_and_b32 v60, 0xffff0000, v108
    v_add_f32 v57, v57, v59
    v_add_f32 v58, v58, v60
    v_cvt_pk_bf16_f32 v108, v57, v58
    v_lshlrev_b32 v57, 16, v108
    v_and_b32 v58, 0xffff0000, v108
    v_add_f32 v48, v48, v57
    v_fmac_f32 v49, v57, v57
    v_fmac_f32 v50, v57, v44
    v_add_f32 v48, v48, v58
    v_fmac_f32 v49, v58, v58
    v_fmac_f32 v50, v58, v45
    v_cvt_pk_bf16_f32 v56, v90, v91
    v_lshlrev_b32 v57, 16, v56
    v_and_b32 v58, 0xffff0000, v56
    v_lshlrev_b32 v59, 16, v109
    v_and_b32 v60, 0xffff0000, v109
    v_add_f32 v57, v57, v59
    v_add_f32 v58, v58, v60
    v_cvt_pk_bf16_f32 v109, v57, v58
    v_lshlrev_b32 v57, 16, v109
    v_and_b32 v58, 0xffff0000, v109
    v_add_f32 v48, v48, v57
    v_fmac_f32 v49, v57, v57
    v_fmac_f32 v50, v57, v46
    v_add_f32 v48, v48, v58
    v_fmac_f32 v49, v58, v58
    v_fmac_f32 v50, v58, v47
    buffer_store_dwordx2 v[108:109], v3, s[24:27], 0 offen offset:96
    v_mov_b32 v52, 0
    v_mov_b32 v53, 0
    v_mov_b32 v54, 0
    v_cvt_pk_bf16_f32 v56, v68, v69
    v_lshlrev_b32 v57, 16, v56
    v_and_b32 v58, 0xffff0000, v56
    v_lshlrev_b32 v59, 16, v98
    v_and_b32 v60, 0xffff0000, v98
    v_add_f32 v57, v57, v59
    v_add_f32 v58, v58, v60
    v_cvt_pk_bf16_f32 v98, v57, v58
    v_lshlrev_b32 v57, 16, v98
    v_and_b32 v58, 0xffff0000, v98
    v_add_f32 v52, v52, v57
    v_fmac_f32 v53, v57, v57
    v_fmac_f32 v54, v57, v32
    v_add_f32 v52, v52, v58
    v_fmac_f32 v53, v58, v58
    v_fmac_f32 v54, v58, v33
    v_cvt_pk_bf16_f32 v56, v70, v71
    v_lshlrev_b32 v57, 16, v56
    v_and_b32 v58, 0xffff0000, v56
    v_lshlrev_b32 v59, 16, v99
    v_and_b32 v60, 0xffff0000, v99
    v_add_f32 v57, v57, v59
    v_add_f32 v58, v58, v60
    v_cvt_pk_bf16_f32 v99, v57, v58
    v_lshlrev_b32 v57, 16, v99
    v_and_b32 v58, 0xffff0000, v99
    v_add_f32 v52, v52, v57
    v_fmac_f32 v53, v57, v57
    v_fmac_f32 v54, v57, v34
    v_add_f32 v52, v52, v58
    v_fmac_f32 v53, v58, v58
    v_fmac_f32 v54, v58, v35
    buffer_store_dwordx2 v[98:99], v4, s[24:27], 0 offen offset:0
    v_cvt_pk_bf16_f32 v56, v76, v77
    v_lshlrev_b32 v57, 16, v56
    v_and_b32 v58, 0xffff0000, v56
    v_lshlrev_b32 v59, 16, v102
    v_and_b32 v60, 0xffff0000, v102
    v_add_f32 v57, v57, v59
    v_add_f32 v58, v58, v60
    v_cvt_pk_bf16_f32 v102, v57, v58
    v_lshlrev_b32 v57, 16, v102
    v_and_b32 v58, 0xffff0000, v102
    v_add_f32 v52, v52, v57
    v_fmac_f32 v53, v57, v57
    v_fmac_f32 v54, v57, v36
    v_add_f32 v52, v52, v58
    v_fmac_f32 v53, v58, v58
    v_fmac_f32 v54, v58, v37
    v_cvt_pk_bf16_f32 v56, v78, v79
    v_lshlrev_b32 v57, 16, v56
    v_and_b32 v58, 0xffff0000, v56
    v_lshlrev_b32 v59, 16, v103
    v_and_b32 v60, 0xffff0000, v103
    v_add_f32 v57, v57, v59
    v_add_f32 v58, v58, v60
    v_cvt_pk_bf16_f32 v103, v57, v58
    v_lshlrev_b32 v57, 16, v103
    v_and_b32 v58, 0xffff0000, v103
    v_add_f32 v52, v52, v57
    v_fmac_f32 v53, v57, v57
    v_fmac_f32 v54, v57, v38
    v_add_f32 v52, v52, v58
    v_fmac_f32 v53, v58, v58
    v_fmac_f32 v54, v58, v39
    buffer_store_dwordx2 v[102:103], v4, s[24:27], 0 offen offset:32
    v_cvt_pk_bf16_f32 v56, v84, v85
    v_lshlrev_b32 v57, 16, v56
    v_and_b32 v58, 0xffff0000, v56
    v_lshlrev_b32 v59, 16, v106
    v_and_b32 v60, 0xffff0000, v106
    v_add_f32 v57, v57, v59
    v_add_f32 v58, v58, v60
    v_cvt_pk_bf16_f32 v106, v57, v58
    v_lshlrev_b32 v57, 16, v106
    v_and_b32 v58, 0xffff0000, v106
    v_add_f32 v52, v52, v57
    v_fmac_f32 v53, v57, v57
    v_fmac_f32 v54, v57, v40
    v_add_f32 v52, v52, v58
    v_fmac_f32 v53, v58, v58
    v_fmac_f32 v54, v58, v41
    v_cvt_pk_bf16_f32 v56, v86, v87
    v_lshlrev_b32 v57, 16, v56
    v_and_b32 v58, 0xffff0000, v56
    v_lshlrev_b32 v59, 16, v107
    v_and_b32 v60, 0xffff0000, v107
    v_add_f32 v57, v57, v59
    v_add_f32 v58, v58, v60
    v_cvt_pk_bf16_f32 v107, v57, v58
    v_lshlrev_b32 v57, 16, v107
    v_and_b32 v58, 0xffff0000, v107
    v_add_f32 v52, v52, v57
    v_fmac_f32 v53, v57, v57
    v_fmac_f32 v54, v57, v42
    v_add_f32 v52, v52, v58
    v_fmac_f32 v53, v58, v58
    v_fmac_f32 v54, v58, v43
    buffer_store_dwordx2 v[106:107], v4, s[24:27], 0 offen offset:64
    v_cvt_pk_bf16_f32 v56, v92, v93
    v_lshlrev_b32 v57, 16, v56
    v_and_b32 v58, 0xffff0000, v56
    v_lshlrev_b32 v59, 16, v110
    v_and_b32 v60, 0xffff0000, v110
    v_add_f32 v57, v57, v59
    v_add_f32 v58, v58, v60
    v_cvt_pk_bf16_f32 v110, v57, v58
    v_lshlrev_b32 v57, 16, v110
    v_and_b32 v58, 0xffff0000, v110
    v_add_f32 v52, v52, v57
    v_fmac_f32 v53, v57, v57
    v_fmac_f32 v54, v57, v44
    v_add_f32 v52, v52, v58
    v_fmac_f32 v53, v58, v58
    v_fmac_f32 v54, v58, v45
    v_cvt_pk_bf16_f32 v56, v94, v95
    v_lshlrev_b32 v57, 16, v56
    v_and_b32 v58, 0xffff0000, v56
    v_lshlrev_b32 v59, 16, v111
    v_and_b32 v60, 0xffff0000, v111
    v_add_f32 v57, v57, v59
    v_add_f32 v58, v58, v60
    v_cvt_pk_bf16_f32 v111, v57, v58
    v_lshlrev_b32 v57, 16, v111
    v_and_b32 v58, 0xffff0000, v111
    v_add_f32 v52, v52, v57
    v_fmac_f32 v53, v57, v57
    v_fmac_f32 v54, v57, v46
    v_add_f32 v52, v52, v58
    v_fmac_f32 v53, v58, v58
    v_fmac_f32 v54, v58, v47
    buffer_store_dwordx2 v[110:111], v4, s[24:27], 0 offen offset:96
    v_mov_b32 v56, v48
    v_mov_b32 v57, v49
    v_mov_b32 v58, v50
    v_mov_b32 v59, v52
    v_mov_b32 v60, v53
    v_mov_b32 v61, v54
    s_nop 1
    v_permlane16_swap_b32 v48, v56
    v_permlane16_swap_b32 v49, v57
    v_permlane16_swap_b32 v50, v58
    v_permlane16_swap_b32 v52, v59
    v_permlane16_swap_b32 v53, v60
    v_permlane16_swap_b32 v54, v61
    s_nop 1
    v_add_f32 v48, v48, v56
    v_add_f32 v49, v49, v57
    v_add_f32 v50, v50, v58
    v_add_f32 v52, v52, v59
    v_add_f32 v53, v53, v60
    v_add_f32 v54, v54, v61
    v_mov_b32 v56, v48
    v_mov_b32 v57, v49
    v_mov_b32 v58, v50
    v_mov_b32 v59, v52
    v_mov_b32 v60, v53
    v_mov_b32 v61, v54
    s_nop 1
    v_permlane32_swap_b32 v48, v56
    v_permlane32_swap_b32 v49, v57
    v_permlane32_swap_b32 v50, v58
    v_permlane32_swap_b32 v52, v59
    v_permlane32_swap_b32 v53, v60
    v_permlane32_swap_b32 v54, v61
    s_nop 1
    v_add_f32 v48, v48, v56
    v_add_f32 v49, v49, v57
    v_add_f32 v50, v50, v58
    v_add_f32 v52, v52, v59
    v_add_f32 v53, v53, v60
    v_add_f32 v54, v54, v61
    v_cmp_eq_u32 s[48:49], 1, v20
    v_cmp_eq_u32 s[50:51], 2, v20
    s_nop 1
    v_cndmask_b32 v48, v48, v49, s[48:49]
    v_cndmask_b32 v48, v48, v50, s[50:51]
    buffer_atomic_add_f32 v48, v2, s[32:35], 0 offen offset:0
    v_cndmask_b32 v52, v52, v53, s[48:49]
    v_cndmask_b32 v52, v52, v54, s[50:51]
    buffer_atomic_add_f32 v52, v2, s[32:35], 0 offen offset:64
k3_end_34:
    s_endpgm
.globl k4_kernel
.p2align 8
.type k4_kernel,@function
k4_kernel:
    s_cmp_ge_u32 s2, 256
    s_cbranch_scc1 k4_end_36
    s_load_dwordx8 s[4:11], s[0:1], 56
    s_load_dwordx2 s[12:13], s[0:1], 88
    s_load_dwordx2 s[14:15], s[0:1], 104
    v_lshrrev_b32 v1, 6, v0
    v_and_b32 v2, 63, v0
    v_readfirstlane_b32 s44, v1
    s_and_b32 s45, s2, 7
    s_lshr_b32 s46, s2, 3
    s_mul_i32 s45, s45, 28
    s_add_u32 s45, s45, s46
    v_lshlrev_b32 v3, 5, v0
    v_and_b32 v4, 31, v2
    v_lshrrev_b32 v5, 5, v2
    v_lshl_add_u32 v6, v1, 1, v5
    s_lshl_b32 s47, s2, 3
    v_add_u32 v6, s47, v6
    v_lshlrev_b32 v6, 11, v6
    v_lshl_add_u32 v6, v4, 4, v6
    v_lshlrev_b32 v7, 4, v4
    v_lshrrev_b32 v8, 1, v2
    v_lshl_add_u32 v8, v1, 8, v8
    v_mul_u32_u24 v8, 7168, v8
    v_and_b32 v9, 1, v2
    v_lshl_add_u32 v8, v9, 4, v8
    s_lshl_b32 s47, s45, 5
    v_add_u32 v8, s47, v8
    v_lshlrev_b32 v9, 3, v0
    s_waitcnt lgkmcnt(0)
    s_add_u32 s16, s14, 0x4800000
    s_addc_u32 s17, s15, 0
    s_and_b32 s17, s17, 0xffff
    s_mov_b32 s18, 0x6000
    s_mov_b32 s19, 0x00020000
    s_add_u32 s20, s14, 0x4000000
    s_addc_u32 s21, s15, 0
    s_and_b32 s21, s21, 0xffff
    s_mov_b32 s22, 0x400000
    s_mov_b32 s23, 0x00020000
    s_mov_b32 s24, s6
    s_and_b32 s25, s7, 0xffff
    s_mov_b32 s26, 0x700000
    s_mov_b32 s27, 0x00020000
    s_mov_b32 s28, s8
    s_and_b32 s29, s9, 0xffff
    s_mov_b32 s30, 0x700000
    s_mov_b32 s31, 0x00020000
    s_mov_b32 s32, s10
    s_and_b32 s33, s11, 0xffff
    s_mov_b32 s34, 0x700000
    s_mov_b32 s35, 0x00020000
    s_mov_b32 s36, s12
    s_and_b32 s37, s13, 0xffff
    s_mov_b32 s38, 0x400000
    s_mov_b32 s39, 0x00020000
    s_mov_b32 s40, s4
    s_and_b32 s41, s5, 0xffff
    s_mov_b32 s42, 0x800
    s_mov_b32 s43, 0x00020000
    s_cmp_ge_u32 s2, 224
    s_cselect_b32 s26, 0, s26
    s_cselect_b32 s30, 0, s30
    s_cselect_b32 s34, 0, s34
    s_mov_b32 s48, 0
    buffer_load_dwordx4 v[16:19], v3, s[16:19], s48 offen
    buffer_load_dwordx4 v[20:23], v3, s[16:19], s48 offen offset:16
    s_mov_b32 s48, 8192
    buffer_load_dwordx4 v[24:27], v3, s[16:19], s48 offen
    buffer_load_dwordx4 v[28:31], v3, s[16:19], s48 offen offset:16
    s_mov_b32 s48, 16384
    buffer_load_dwordx4 v[32:35], v3, s[16:19], s48 offen
    buffer_load_dwordx4 v[36:39], v3, s[16:19], s48 offen offset:16
    buffer_load_dwordx4 v[56:59], v7, s[40:43], 0 offen offset:0
    buffer_load_dwordx4 v[60:63], v7, s[40:43], 0 offen offset:512
    buffer_load_dwordx4 v[64:67], v7, s[40:43], 0 offen offset:1024
    buffer_load_dwordx4 v[68:71], v7, s[40:43], 0 offen offset:1536
    buffer_load_dwordx4 v[40:43], v6, s[20:23], 0 offen offset:0
    buffer_load_dwordx4 v[44:47], v6, s[20:23], 0 offen offset:512
    buffer_load_dwordx4 v[48:51], v6, s[20:23], 0 offen offset:1024
    buffer_load_dwordx4 v[52:55], v6, s[20:23], 0 offen offset:1536
    s_and_b32 s49, s45, 3
    s_lshl_b32 s49, s49, 1
    s_lshl_b32 s50, s44, 13
    s_add_u32 s51, s49, 0
    s_and_b32 s51, s51, 7
    s_mul_i32 s52, s51, 229376
    s_lshl_b32 s51, s51, 10
    s_add_u32 s51, s51, s50
    s_add_u32 m0, s51, 0
    s_nop 0
    buffer_load_dwordx4 v8, s[24:27], s52 offen lds
    s_add_u32 s51, s49, 0
    s_and_b32 s51, s51, 7
    s_mul_i32 s52, s51, 229376
    s_lshl_b32 s51, s51, 10
    s_add_u32 s51, s51, s50
    s_add_u32 m0, s51, 32768
    s_nop 0
    buffer_load_dwordx4 v8, s[28:31], s52 offen lds
    s_add_u32 s51, s49, 1
    s_and_b32 s51, s51, 7
    s_mul_i32 s52, s51, 229376
    s_lshl_b32 s51, s51, 10
    s_add_u32 s51, s51, s50
    s_add_u32 m0, s51, 0
    s_nop 0
    buffer_load_dwordx4 v8, s[24:27], s52 offen lds
    s_add_u32 s51, s49, 1
    s_and_b32 s51, s51, 7
    s_mul_i32 s52, s51, 229376
    s_lshl_b32 s51, s51, 10
    s_add_u32 s51, s51, s50
    s_add_u32 m0, s51, 32768
    s_nop 0
    buffer_load_dwordx4 v8, s[28:31], s52 offen lds
    s_waitcnt vmcnt(8)
    v_lshlrev_b32 v128, 16, v56
    v_and_b32 v129, 0xffff0000, v56
    v_lshlrev_b32 v130, 16, v57
    v_and_b32 v131, 0xffff0000, v57
    v_lshlrev_b32 v132, 16, v58
    v_and_b32 v133, 0xffff0000, v58
    v_lshlrev_b32 v134, 16, v59
    v_and_b32 v135, 0xffff0000, v59
    v_lshlrev_b32 v136, 16, v60
    v_and_b32 v137, 0xffff0000, v60
    v_lshlrev_b32 v138, 16, v61
    v_and_b32 v139, 0xffff0000, v61
    v_lshlrev_b32 v140, 16, v62
    v_and_b32 v141, 0xffff0000, v62
    v_lshlrev_b32 v142, 16, v63
    v_and_b32 v143, 0xffff0000, v63
    v_lshlrev_b32 v144, 16, v64
    v_and_b32 v145, 0xffff0000, v64
    v_lshlrev_b32 v146, 16, v65
    v_and_b32 v147, 0xffff0000, v65
    v_lshlrev_b32 v148, 16, v66
    v_and_b32 v149, 0xffff0000, v66
    v_lshlrev_b32 v150, 16, v67
    v_and_b32 v151, 0xffff0000, v67
    v_lshlrev_b32 v152, 16, v68
    v_and_b32 v153, 0xffff0000, v68
    v_lshlrev_b32 v154, 16, v69
    v_and_b32 v155, 0xffff0000, v69
    v_lshlrev_b32 v156, 16, v70
    v_and_b32 v157, 0xffff0000, v70
    v_lshlrev_b32 v158, 16, v71
    v_and_b32 v159, 0xffff0000, v71
    v_pk_add_f32 v[10:11], v[128:129], v[130:131]
    v_pk_add_f32 v[10:11], v[10:11], v[132:133]
    v_pk_add_f32 v[10:11], v[10:11], v[134:135]
    v_pk_add_f32 v[10:11], v[10:11], v[136:137]
    v_pk_add_f32 v[10:11], v[10:11], v[138:139]
    v_pk_add_f32 v[10:11], v[10:11], v[140:141]
    v_pk_add_f32 v[10:11], v[10:11], v[142:143]
    v_pk_add_f32 v[10:11], v[10:11], v[144:145]
    v_pk_add_f32 v[10:11], v[10:11], v[146:147]
    v_pk_add_f32 v[10:11], v[10:11], v[148:149]
    v_pk_add_f32 v[10:11], v[10:11], v[150:151]
    v_pk_add_f32 v[10:11], v[10:11], v[152:153]
    v_pk_add_f32 v[10:11], v[10:11], v[154:155]
    v_pk_add_f32 v[10:11], v[10:11], v[156:157]
    v_pk_add_f32 v[10:11], v[10:11], v[158:159]
    v_add_f32 v10, v10, v11
    s_nop 1
    v_add_f32_dpp v10, v10, v10 quad_perm:[1,0,3,2] row_mask:0xf bank_mask:0xf
    s_nop 1
    v_add_f32_dpp v10, v10, v10 quad_perm:[2,3,0,1] row_mask:0xf bank_mask:0xf
    s_nop 1
    v_add_f32_dpp v10, v10, v10 row_half_mirror row_mask:0xf bank_mask:0xf
    s_nop 1
    v_add_f32_dpp v10, v10, v10 row_mirror row_mask:0xf bank_mask:0xf
    v_mov_b32 v11, v10
    s_nop 1
    v_permlane16_swap_b32 v10, v11
    s_nop 1
    v_add_f32 v10, v10, v11
    v_lshlrev_b32 v12, 3, v0
    v_sub_u32 v12, 2047, v12
    v_mov_b32 v13, 0
    v_mov_b32 v14, 0
    s_mov_b32 s53, 0x3a800000
    s_mov_b32 s54, 0xfffff800
    v_mul_f32 v16, s53, v16
    v_mul_f32 v24, s53, v24
    v_fma_f32 v24, -v16, v16, v24
    v_max_f32 v24, 0, v24
    v_add_f32 v24, 0x3727c5ac, v24
    v_rsq_f32 v24, v24
    v_fma_f32 v32, -v16, v10, v32
    v_mul_f32 v32, v32, v24
    v_ashrrev_i32 v16, 31, v32
    v_or_b32 v16, 0x80000000, v16
    v_xor_b32 v32, v32, v16
    v_subrev_u32 v16, 0, v12
    v_and_or_b32 v32, v32, s54, v16
    v_med3_u32 v14, v13, v14, v32
    v_max_u32 v13, v13, v32
    v_mul_f32 v17, s53, v17
    v_mul_f32 v25, s53, v25
    v_fma_f32 v25, -v17, v17, v25
    v_max_f32 v25, 0, v25
    v_add_f32 v25, 0x3727c5ac, v25
    v_rsq_f32 v25, v25
    v_fma_f32 v33, -v17, v10, v33
    v_mul_f32 v33, v33, v25
    v_ashrrev_i32 v17, 31, v33
    v_or_b32 v17, 0x80000000, v17
    v_xor_b32 v33, v33, v17
    v_subrev_u32 v17, 1, v12
    v_and_or_b32 v33, v33, s54, v17
    v_med3_u32 v14, v13, v14, v33
    v_max_u32 v13, v13, v33
    v_mul_f32 v18, s53, v18
    v_mul_f32 v26, s53, v26
    v_fma_f32 v26, -v18, v18, v26
    v_max_f32 v26, 0, v26
    v_add_f32 v26, 0x3727c5ac, v26
    v_rsq_f32 v26, v26
    v_fma_f32 v34, -v18, v10, v34
    v_mul_f32 v34, v34, v26
    v_ashrrev_i32 v18, 31, v34
    v_or_b32 v18, 0x80000000, v18
    v_xor_b32 v34, v34, v18
    v_subrev_u32 v18, 2, v12
    v_and_or_b32 v34, v34, s54, v18
    v_med3_u32 v14, v13, v14, v34
    v_max_u32 v13, v13, v34
    v_mul_f32 v19, s53, v19
    v_mul_f32 v27, s53, v27
    v_fma_f32 v27, -v19, v19, v27
    v_max_f32 v27, 0, v27
    v_add_f32 v27, 0x3727c5ac, v27
    v_rsq_f32 v27, v27
    v_fma_f32 v35, -v19, v10, v35
    v_mul_f32 v35, v35, v27
    v_ashrrev_i32 v19, 31, v35
    v_or_b32 v19, 0x80000000, v19
    v_xor_b32 v35, v35, v19
    v_subrev_u32 v19, 3, v12
    v_and_or_b32 v35, v35, s54, v19
    v_med3_u32 v14, v13, v14, v35
    v_max_u32 v13, v13, v35
    v_mul_f32 v20, s53, v20
    v_mul_f32 v28, s53, v28
    v_fma_f32 v28, -v20, v20, v28
    v_max_f32 v28, 0, v28
    v_add_f32 v28, 0x3727c5ac, v28
    v_rsq_f32 v28, v28
    v_fma_f32 v36, -v20, v10, v36
    v_mul_f32 v36, v36, v28
    v_ashrrev_i32 v20, 31, v36
    v_or_b32 v20, 0x80000000, v20
    v_xor_b32 v36, v36, v20
    v_subrev_u32 v20, 4, v12
    v_and_or_b32 v36, v36, s54, v20
    v_med3_u32 v14, v13, v14, v36
    v_max_u32 v13, v13, v36
    v_mul_f32 v21, s53, v21
    v_mul_f32 v29, s53, v29
    v_fma_f32 v29, -v21, v21, v29
    v_max_f32 v29, 0, v29
    v_add_f32 v29, 0x3727c5ac, v29
    v_rsq_f32 v29, v29
    v_fma_f32 v37, -v21, v10, v37
    v_mul_f32 v37, v37, v29
    v_ashrrev_i32 v21, 31, v37
    v_or_b32 v21, 0x80000000, v21
    v_xor_b32 v37, v37, v21
    v_subrev_u32 v21, 5, v12
    v_and_or_b32 v37, v37, s54, v21
    v_med3_u32 v14, v13, v14, v37
    v_max_u32 v13, v13, v37
    v_mul_f32 v22, s53, v22
    v_mul_f32 v30, s53, v30
    v_fma_f32 v30, -v22, v22, v30
    v_max_f32 v30, 0, v30
    v_add_f32 v30, 0x3727c5ac, v30
    v_rsq_f32 v30, v30
    v_fma_f32 v38, -v22, v10, v38
    v_mul_f32 v38, v38, v30
    v_ashrrev_i32 v22, 31, v38
    v_or_b32 v22, 0x80000000, v22
    v_xor_b32 v38, v38, v22
    v_subrev_u32 v22, 6, v12
    v_and_or_b32 v38, v38, s54, v22
    v_med3_u32 v14, v13, v14, v38
    v_max_u32 v13, v13, v38
    v_mul_f32 v23, s53, v23
    v_mul_f32 v31, s53, v31
    v_fma_f32 v31, -v23, v23, v31
    v_max_f32 v31, 0, v31
    v_add_f32 v31, 0x3727c5ac, v31
    v_rsq_f32 v31, v31
    v_fma_f32 v39, -v23, v10, v39
    v_mul_f32 v39, v39, v31
    v_ashrrev_i32 v23, 31, v39
    v_or_b32 v23, 0x80000000, v23
    v_xor_b32 v39, v39, v23
    v_subrev_u32 v23, 7, v12
    v_and_or_b32 v39, v39, s54, v23
    v_med3_u32 v14, v13, v14, v39
    v_max_u32 v13, v13, v39
    s_nop 1
    v_mov_b32_dpp v11, v13 quad_perm:[1,0,3,2] row_mask:0xf bank_mask:0xf
    v_mov_b32_dpp v12, v14 quad_perm:[1,0,3,2] row_mask:0xf bank_mask:0xf
    v_max_u32 v12, v12, v14
    v_med3_u32 v14, v13, v11, v12
    v_max_u32 v13, v13, v11
    s_nop 1
    v_mov_b32_dpp v11, v13 quad_perm:[2,3,0,1] row_mask:0xf bank_mask:0xf
    v_mov_b32_dpp v12, v14 quad_perm:[2,3,0,1] row_mask:0xf bank_mask:0xf
    v_max_u32 v12, v12, v14
    v_med3_u32 v14, v13, v11, v12
    v_max_u32 v13, v13, v11
    s_nop 1
    v_mov_b32_dpp v11, v13 row_half_mirror row_mask:0xf bank_mask:0xf
    v_mov_b32_dpp v12, v14 row_half_mirror row_mask:0xf bank_mask:0xf
    v_max_u32 v12, v12, v14
    v_med3_u32 v14, v13, v11, v12
    v_max_u32 v13, v13, v11
    s_nop 1
    v_mov_b32_dpp v11, v13 row_mirror row_mask:0xf bank_mask:0xf
    v_mov_b32_dpp v12, v14 row_mirror row_mask:0xf bank_mask:0xf
    v_max_u32 v12, v12, v14
    v_med3_u32 v14, v13, v11, v12
    v_max_u32 v13, v13, v11
    v_mov_b32 v11, v13
    v_mov_b32 v12, v14
    s_nop 1
    v_permlane16_swap_b32 v13, v11
    v_permlane16_swap_b32 v14, v12
    s_nop 1
    v_max_u32 v12, v12, v14
    v_med3_u32 v14, v13, v11, v12
    v_max_u32 v13, v13, v11
    v_mov_b32 v11, v13
    v_mov_b32 v12, v14
    s_nop 1
    v_permlane32_swap_b32 v13, v11
    v_permlane32_swap_b32 v14, v12
    s_nop 1
    v_max_u32 v12, v12, v14
    v_med3_u32 v14, v13, v11, v12
    v_max_u32 v13, v13, v11
    v_lshlrev_b32 v11, 3, v1
    v_add_u32 v11, 81920, v11
    v_mov_b32 v12, v13
    v_mov_b32 v13, v14
    ds_write_b64 v11, v[12:13]
    s_waitcnt lgkmcnt(0)
    s_barrier
    v_mov_b32 v11, 81920
    ds_read_b128 v[16:19], v11
    ds_read_b128 v[20:23], v11 offset:16
    s_waitcnt lgkmcnt(0)
    v_max_u32 v19, v19, v17
    v_med3_u32 v17, v16, v18, v19
    v_max_u32 v16, v16, v18
    v_max_u32 v23, v23, v21
    v_med3_u32 v21, v20, v22, v23
    v_max_u32 v20, v20, v22
    v_max_u32 v21, v21, v17
    v_med3_u32 v17, v16, v20, v21
    v_max_u32 v16, v16, v20
    v_cmp_eq_u32 vcc, 0, v5
    s_nop 1
    v_cndmask_b32 v11, v17, v16, vcc
    v_and_b32 v11, 0x7ff, v11
    v_sub_u32 v15, 2047, v11
    v_lshl_add_u32 v11, v15, 11, v7
    buffer_load_dwordx4 v[72:75], v11, s[20:23], 0 offen offset:0
    buffer_load_dwordx4 v[76:79], v11, s[20:23], 0 offen offset:512
    buffer_load_dwordx4 v[80:83], v11, s[20:23], 0 offen offset:1024
    buffer_load_dwordx4 v[84:87], v11, s[20:23], 0 offen offset:1536
    s_add_u32 s51, s49, 2
    s_and_b32 s51, s51, 7
    s_mul_i32 s52, s51, 229376
    s_lshl_b32 s51, s51, 10
    s_add_u32 s51, s51, s50
    s_add_u32 m0, s51, 0
    s_nop 0
    buffer_load_dwordx4 v8, s[24:27], s52 offen lds
    s_add_u32 s51, s49, 2
    s_and_b32 s51, s51, 7
    s_mul_i32 s52, s51, 229376
    s_lshl_b32 s51, s51, 10
    s_add_u32 s51, s51, s50
    s_add_u32 m0, s51, 32768
    s_nop 0
    buffer_load_dwordx4 v8, s[28:31], s52 offen lds
    s_add_u32 s51, s49, 3
    s_and_b32 s51, s51, 7
    s_mul_i32 s52, s51, 229376
    s_lshl_b32 s51, s51, 10
    s_add_u32 s51, s51, s50
    s_add_u32 m0, s51, 0
    s_nop 0
    buffer_load_dwordx4 v8, s[24:27], s52 offen lds
    s_add_u32 s51, s49, 3
    s_and_b32 s51, s51, 7
    s_mul_i32 s52, s51, 229376
    s_lshl_b32 s51, s51, 10
    s_add_u32 s51, s51, s50
    s_add_u32 m0, s51, 32768
    s_nop 0
    buffer_load_dwordx4 v8, s[28:31], s52 offen lds
    s_add_u32 s51, s49, 4
    s_and_b32 s51, s51, 7
    s_mul_i32 s52, s51, 229376
    s_lshl_b32 s51, s51, 10
    s_add_u32 s51, s51, s50
    s_add_u32 m0, s51, 0
    s_nop 0
    buffer_load_dwordx4 v8, s[24:27], s52 offen lds
    s_add_u32 s51, s49, 4
    s_and_b32 s51, s51, 7
    s_mul_i32 s52, s51, 229376
    s_lshl_b32 s51, s51, 10
    s_add_u32 s51, s51, s50
    s_add_u32 m0, s51, 32768
    s_nop 0
    buffer_load_dwordx4 v8, s[28:31], s52 offen lds
    s_waitcnt vmcnt(14)
    v_lshlrev_b32 v200, 16, v40
    v_and_b32 v201, 0xffff0000, v40
    v_lshlrev_b32 v202, 16, v41
    v_and_b32 v203, 0xffff0000, v41
    v_lshlrev_b32 v204, 16, v42
    v_and_b32 v205, 0xffff0000, v42
    v_lshlrev_b32 v206, 16, v43
    v_and_b32 v207, 0xffff0000, v43
    v_lshlrev_b32 v208, 16, v44
    v_and_b32 v209, 0xffff0000, v44
    v_lshlrev_b32 v210, 16, v45
    v_and_b32 v211, 0xffff0000, v45
    v_lshlrev_b32 v212, 16, v46
    v_and_b32 v213, 0xffff0000, v46
    v_lshlrev_b32 v214, 16, v47
    v_and_b32 v215, 0xffff0000, v47
    v_lshlrev_b32 v216, 16, v48
    v_and_b32 v217, 0xffff0000, v48
    v_lshlrev_b32 v218, 16, v49
    v_and_b32 v219, 0xffff0000, v49
    v_lshlrev_b32 v220, 16, v50
    v_and_b32 v221, 0xffff0000, v50
    v_lshlrev_b32 v222, 16, v51
    v_and_b32 v223, 0xffff0000, v51
    v_lshlrev_b32 v224, 16, v52
    v_and_b32 v225, 0xffff0000, v52
    v_lshlrev_b32 v226, 16, v53
    v_and_b32 v227, 0xffff0000, v53
    v_lshlrev_b32 v228, 16, v54
    v_and_b32 v229, 0xffff0000, v54
    v_lshlrev_b32 v230, 16, v55
    v_and_b32 v231, 0xffff0000, v55
    v_pk_add_f32 v[192:193], v[200:201], v[202:203]
    v_pk_add_f32 v[194:195], v[204:205], v[206:207]
    v_pk_add_f32 v[192:193], v[192:193], v[208:209]
    v_pk_add_f32 v[194:195], v[194:195], v[210:211]
    v_pk_add_f32 v[192:193], v[192:193], v[212:213]
    v_pk_add_f32 v[194:195], v[194:195], v[214:215]
    v_pk_add_f32 v[192:193], v[192:193], v[216:217]
    v_pk_add_f32 v[194:195], v[194:195], v[218:219]
    v_pk_add_f32 v[192:193], v[192:193], v[220:221]
    v_pk_add_f32 v[194:195], v[194:195], v[222:223]
    v_pk_add_f32 v[192:193], v[192:193], v[224:225]
    v_pk_add_f32 v[194:195], v[194:195], v[226:227]
    v_pk_add_f32 v[192:193], v[192:193], v[228:229]
    v_pk_add_f32 v[194:195], v[194:195], v[230:231]
    v_pk_add_f32 v[192:193], v[192:193], v[194:195]
    v_add_f32 v192, v192, v193
    s_nop 1
    v_add_f32_dpp v192, v192, v192 quad_perm:[1,0,3,2] row_mask:0xf bank_mask:0xf
    s_nop 1
    v_add_f32_dpp v192, v192, v192 quad_perm:[2,3,0,1] row_mask:0xf bank_mask:0xf
    s_nop 1
    v_add_f32_dpp v192, v192, v192 row_half_mirror row_mask:0xf bank_mask:0xf
    s_nop 1
    v_add_f32_dpp v192, v192, v192 row_mirror row_mask:0xf bank_mask:0xf
    v_mov_b32 v194, v192
    s_nop 1
    v_permlane16_swap_b32 v192, v194
    s_nop 1
    v_add_f32 v192, v192, v194
    v_mul_f32 v192, 0xba800000, v192
    v_mov_b32 v193, v192
    v_pk_add_f32 v[194:195], v[200:201], v[192:193]
    v_pk_add_f32 v[198:199], v[202:203], v[192:193]
    v_pk_mul_f32 v[196:197], v[194:195], v[194:195]
    v_pk_fma_f32 v[196:197], v[198:199], v[198:199], v[196:197]
    v_pk_add_f32 v[194:195], v[204:205], v[192:193]
    v_pk_add_f32 v[198:199], v[206:207], v[192:193]
    v_pk_fma_f32 v[196:197], v[194:195], v[194:195], v[196:197]
    v_pk_fma_f32 v[196:197], v[198:199], v[198:199], v[196:197]
    v_pk_add_f32 v[194:195], v[208:209], v[192:193]
    v_pk_add_f32 v[198:199], v[210:211], v[192:193]
    v_pk_fma_f32 v[196:197], v[194:195], v[194:195], v[196:197]
    v_pk_fma_f32 v[196:197], v[198:199], v[198:199], v[196:197]
    v_pk_add_f32 v[194:195], v[212:213], v[192:193]
    v_pk_add_f32 v[198:199], v[214:215], v[192:193]
    v_pk_fma_f32 v[196:197], v[194:195], v[194:195], v[196:197]
    v_pk_fma_f32 v[196:197], v[198:199], v[198:199], v[196:197]
    v_pk_add_f32 v[194:195], v[216:217], v[192:193]
    v_pk_add_f32 v[198:199], v[218:219], v[192:193]
    v_pk_fma_f32 v[196:197], v[194:195], v[194:195], v[196:197]
    v_pk_fma_f32 v[196:197], v[198:199], v[198:199], v[196:197]
    v_pk_add_f32 v[194:195], v[220:221], v[192:193]
    v_pk_add_f32 v[198:199], v[222:223], v[192:193]
    v_pk_fma_f32 v[196:197], v[194:195], v[194:195], v[196:197]
    v_pk_fma_f32 v[196:197], v[198:199], v[198:199], v[196:197]
    v_pk_add_f32 v[194:195], v[224:225], v[192:193]
    v_pk_add_f32 v[198:199], v[226:227], v[192:193]
    v_pk_fma_f32 v[196:197], v[194:195], v[194:195], v[196:197]
    v_pk_fma_f32 v[196:197], v[198:199], v[198:199], v[196:197]
    v_pk_add_f32 v[194:195], v[228:229], v[192:193]
    v_pk_add_f32 v[198:199], v[230:231], v[192:193]
    v_pk_fma_f32 v[196:197], v[194:195], v[194:195], v[196:197]
    v_pk_fma_f32 v[196:197], v[198:199], v[198:199], v[196:197]
    v_add_f32 v196, v196, v197
    s_nop 1
    v_add_f32_dpp v196, v196, v196 quad_perm:[1,0,3,2] row_mask:0xf bank_mask:0xf
    s_nop 1
    v_add_f32_dpp v196, v196, v196 quad_perm:[2,3,0,1] row_mask:0xf bank_mask:0xf
    s_nop 1
    v_add_f32_dpp v196, v196, v196 row_half_mirror row_mask:0xf bank_mask:0xf
    s_nop 1
    v_add_f32_dpp v196, v196, v196 row_mirror row_mask:0xf bank_mask:0xf
    v_mov_b32 v194, v196
    s_nop 1
    v_permlane16_swap_b32 v196, v194
    s_nop 1
    v_add_f32 v196, v196, v194
    v_mul_f32 v196, 0x3a800000, v196
    v_cvt_pk_bf16_f32 v198, v192, v196
    v_and_b32 v196, 0xffff0000, v198
    v_lshlrev_b32 v198, 16, v198
    v_add_f32 v196, 0x3727c5ac, v196
    v_mov_b32 v199, v198
    v_cvt_pk_bf16_f32 v196, v196, v196
    v_and_b32 v196, 0xffff0000, v196
    v_sqrt_f32 v196, v196
    v_pk_add_f32 v[160:161], v[200:201], v[198:199]
    v_pk_add_f32 v[162:163], v[202:203], v[198:199]
    v_pk_add_f32 v[164:165], v[204:205], v[198:199]
    v_pk_add_f32 v[166:167], v[206:207], v[198:199]
    v_pk_add_f32 v[168:169], v[208:209], v[198:199]
    v_pk_add_f32 v[170:171], v[210:211], v[198:199]
    v_pk_add_f32 v[172:173], v[212:213], v[198:199]
    v_pk_add_f32 v[174:175], v[214:215], v[198:199]
    v_pk_add_f32 v[176:177], v[216:217], v[198:199]
    v_pk_add_f32 v[178:179], v[218:219], v[198:199]
    v_pk_add_f32 v[180:181], v[220:221], v[198:199]
    v_pk_add_f32 v[182:183], v[222:223], v[198:199]
    v_pk_add_f32 v[184:185], v[224:225], v[198:199]
    v_pk_add_f32 v[186:187], v[226:227], v[198:199]
    v_pk_add_f32 v[188:189], v[228:229], v[198:199]
    v_pk_add_f32 v[190:191], v[230:231], v[198:199]
    v_cvt_pk_bf16_f32 v196, v196, v196
    v_and_b32 v196, 0xffff0000, v196
    v_rcp_f32 v196, v196
    v_cvt_pk_bf16_f32 v40, v160, v161
    v_cvt_pk_bf16_f32 v41, v162, v163
    v_cvt_pk_bf16_f32 v42, v164, v165
    v_cvt_pk_bf16_f32 v43, v166, v167
    v_cvt_pk_bf16_f32 v44, v168, v169
    v_cvt_pk_bf16_f32 v45, v170, v171
    v_cvt_pk_bf16_f32 v46, v172, v173
    v_cvt_pk_bf16_f32 v47, v174, v175
    v_cvt_pk_bf16_f32 v48, v176, v177
    v_cvt_pk_bf16_f32 v49, v178, v179
    v_cvt_pk_bf16_f32 v50, v180, v181
    v_cvt_pk_bf16_f32 v51, v182, v183
    v_cvt_pk_bf16_f32 v52, v184, v185
    v_cvt_pk_bf16_f32 v53, v186, v187
    v_cvt_pk_bf16_f32 v54, v188, v189
    v_cvt_pk_bf16_f32 v55, v190, v191
    v_mov_b32 v197, v196
    v_lshlrev_b32 v160, 16, v40
    v_and_b32 v161, 0xffff0000, v40
    v_lshlrev_b32 v162, 16, v41
    v_and_b32 v163, 0xffff0000, v41
    v_lshlrev_b32 v164, 16, v42
    v_and_b32 v165, 0xffff0000, v42
    v_lshlrev_b32 v166, 16, v43
    v_and_b32 v167, 0xffff0000, v43
    v_lshlrev_b32 v168, 16, v44
    v_and_b32 v169, 0xffff0000, v44
    v_lshlrev_b32 v170, 16, v45
    v_and_b32 v171, 0xffff0000, v45
    v_lshlrev_b32 v172, 16, v46
    v_and_b32 v173, 0xffff0000, v46
    v_lshlrev_b32 v174, 16, v47
    v_and_b32 v175, 0xffff0000, v47
    v_lshlrev_b32 v176, 16, v48
    v_and_b32 v177, 0xffff0000, v48
    v_lshlrev_b32 v178, 16, v49
    v_and_b32 v179, 0xffff0000, v49
    v_lshlrev_b32 v180, 16, v50
    v_and_b32 v181, 0xffff0000, v50
    v_lshlrev_b32 v182, 16, v51
    v_and_b32 v183, 0xffff0000, v51
    v_lshlrev_b32 v184, 16, v52
    v_and_b32 v185, 0xffff0000, v52
    v_lshlrev_b32 v186, 16, v53
    v_and_b32 v187, 0xffff0000, v53
    v_lshlrev_b32 v188, 16, v54
    v_and_b32 v189, 0xffff0000, v54
    v_lshlrev_b32 v190, 16, v55
    v_and_b32 v191, 0xffff0000, v55
    v_pk_mul_f32 v[160:161], v[160:161], v[196:197]
    v_pk_mul_f32 v[162:163], v[162:163], v[196:197]
    v_pk_mul_f32 v[164:165], v[164:165], v[196:197]
    v_pk_mul_f32 v[166:167], v[166:167], v[196:197]
    v_pk_mul_f32 v[168:169], v[168:169], v[196:197]
    v_pk_mul_f32 v[170:171], v[170:171], v[196:197]
    v_pk_mul_f32 v[172:173], v[172:173], v[196:197]
    v_pk_mul_f32 v[174:175], v[174:175], v[196:197]
    v_pk_mul_f32 v[176:177], v[176:177], v[196:197]
    v_pk_mul_f32 v[178:179], v[178:179], v[196:197]
    v_pk_mul_f32 v[180:181], v[180:181], v[196:197]
    v_pk_mul_f32 v[182:183], v[182:183], v[196:197]
    v_pk_mul_f32 v[184:185], v[184:185], v[196:197]
    v_pk_mul_f32 v[186:187], v[186:187], v[196:197]
    v_pk_mul_f32 v[188:189], v[188:189], v[196:197]
    v_pk_mul_f32 v[190:191], v[190:191], v[196:197]
    v_cvt_pk_bf16_f32 v40, v160, v161
    v_cvt_pk_bf16_f32 v41, v162, v163
    v_cvt_pk_bf16_f32 v42, v164, v165
    v_cvt_pk_bf16_f32 v43, v166, v167
    v_cvt_pk_bf16_f32 v44, v168, v169
    v_cvt_pk_bf16_f32 v45, v170, v171
    v_cvt_pk_bf16_f32 v46, v172, v173
    v_cvt_pk_bf16_f32 v47, v174, v175
    v_cvt_pk_bf16_f32 v48, v176, v177
    v_cvt_pk_bf16_f32 v49, v178, v179
    v_cvt_pk_bf16_f32 v50, v180, v181
    v_cvt_pk_bf16_f32 v51, v182, v183
    v_cvt_pk_bf16_f32 v52, v184, v185
    v_cvt_pk_bf16_f32 v53, v186, v187
    v_cvt_pk_bf16_f32 v54, v188, v189
    v_cvt_pk_bf16_f32 v55, v190, v191
    v_lshlrev_b32 v160, 16, v40
    v_and_b32 v161, 0xffff0000, v40
    v_lshlrev_b32 v162, 16, v41
    v_and_b32 v163, 0xffff0000, v41
    v_lshlrev_b32 v164, 16, v42
    v_and_b32 v165, 0xffff0000, v42
    v_lshlrev_b32 v166, 16, v43
    v_and_b32 v167, 0xffff0000, v43
    v_lshlrev_b32 v168, 16, v44
    v_and_b32 v169, 0xffff0000, v44
    v_lshlrev_b32 v170, 16, v45
    v_and_b32 v171, 0xffff0000, v45
    v_lshlrev_b32 v172, 16, v46
    v_and_b32 v173, 0xffff0000, v46
    v_lshlrev_b32 v174, 16, v47
    v_and_b32 v175, 0xffff0000, v47
    v_lshlrev_b32 v176, 16, v48
    v_and_b32 v177, 0xffff0000, v48
    v_lshlrev_b32 v178, 16, v49
    v_and_b32 v179, 0xffff0000, v49
    v_lshlrev_b32 v180, 16, v50
    v_and_b32 v181, 0xffff0000, v50
    v_lshlrev_b32 v182, 16, v51
    v_and_b32 v183, 0xffff0000, v51
    v_lshlrev_b32 v184, 16, v52
    v_and_b32 v185, 0xffff0000, v52
    v_lshlrev_b32 v186, 16, v53
    v_and_b32 v187, 0xffff0000, v53
    v_lshlrev_b32 v188, 16, v54
    v_and_b32 v189, 0xffff0000, v54
    v_lshlrev_b32 v190, 16, v55
    v_and_b32 v191, 0xffff0000, v55
    v_pk_add_f32 v[160:161], v[160:161], v[200:201]
    v_pk_add_f32 v[162:163], v[162:163], v[202:203]
    v_pk_add_f32 v[164:165], v[164:165], v[204:205]
    v_pk_add_f32 v[166:167], v[166:167], v[206:207]
    v_pk_add_f32 v[168:169], v[168:169], v[208:209]
    v_pk_add_f32 v[170:171], v[170:171], v[210:211]
    v_pk_add_f32 v[172:173], v[172:173], v[212:213]
    v_pk_add_f32 v[174:175], v[174:175], v[214:215]
    v_pk_add_f32 v[176:177], v[176:177], v[216:217]
    v_pk_add_f32 v[178:179], v[178:179], v[218:219]
    v_pk_add_f32 v[180:181], v[180:181], v[220:221]
    v_pk_add_f32 v[182:183], v[182:183], v[222:223]
    v_pk_add_f32 v[184:185], v[184:185], v[224:225]
    v_pk_add_f32 v[186:187], v[186:187], v[226:227]
    v_pk_add_f32 v[188:189], v[188:189], v[228:229]
    v_pk_add_f32 v[190:191], v[190:191], v[230:231]
    v_cvt_pk_bf16_f32 v40, v160, v161
    v_cvt_pk_bf16_f32 v41, v162, v163
    v_cvt_pk_bf16_f32 v42, v164, v165
    v_cvt_pk_bf16_f32 v43, v166, v167
    v_cvt_pk_bf16_f32 v44, v168, v169
    v_cvt_pk_bf16_f32 v45, v170, v171
    v_cvt_pk_bf16_f32 v46, v172, v173
    v_cvt_pk_bf16_f32 v47, v174, v175
    v_cvt_pk_bf16_f32 v48, v176, v177
    v_cvt_pk_bf16_f32 v49, v178, v179
    v_cvt_pk_bf16_f32 v50, v180, v181
    v_cvt_pk_bf16_f32 v51, v182, v183
    v_cvt_pk_bf16_f32 v52, v184, v185
    v_cvt_pk_bf16_f32 v53, v186, v187
    v_cvt_pk_bf16_f32 v54, v188, v189
    v_cvt_pk_bf16_f32 v55, v190, v191
    buffer_store_dwordx4 v[40:43], v6, s[36:39], 0 offen offset:0
    buffer_store_dwordx4 v[44:47], v6, s[36:39], 0 offen offset:512
    buffer_store_dwordx4 v[48:51], v6, s[36:39], 0 offen offset:1024
    buffer_store_dwordx4 v[52:55], v6, s[36:39], 0 offen offset:1536
    s_cmp_ge_u32 s2, 224
    s_cbranch_scc1 k4_end_36
    s_add_u32 s51, s49, 5
    s_and_b32 s51, s51, 7
    s_mul_i32 s52, s51, 229376
    s_lshl_b32 s51, s51, 10
    s_add_u32 s51, s51, s50
    s_add_u32 m0, s51, 0
    s_nop 0
    buffer_load_dwordx4 v8, s[24:27], s52 offen lds
    s_add_u32 s51, s49, 5
    s_and_b32 s51, s51, 7
    s_mul_i32 s52, s51, 229376
    s_lshl_b32 s51, s51, 10
    s_add_u32 s51, s51, s50
    s_add_u32 m0, s51, 32768
    s_nop 0
    buffer_load_dwordx4 v8, s[28:31], s52 offen lds
    s_add_u32 s51, s49, 6
    s_and_b32 s51, s51, 7
    s_mul_i32 s52, s51, 229376
    s_lshl_b32 s51, s51, 10
    s_add_u32 s51, s51, s50
    s_add_u32 m0, s51, 0
    s_nop 0
    buffer_load_dwordx4 v8, s[24:27], s52 offen lds
    s_add_u32 s51, s49, 6
    s_and_b32 s51, s51, 7
    s_mul_i32 s52, s51, 229376
    s_lshl_b32 s51, s51, 10
    s_add_u32 s51, s51, s50
    s_add_u32 m0, s51, 32768
    s_nop 0
    buffer_load_dwordx4 v8, s[28:31], s52 offen lds
    s_add_u32 s51, s49, 7
    s_and_b32 s51, s51, 7
    s_mul_i32 s52, s51, 229376
    s_lshl_b32 s51, s51, 10
    s_add_u32 s51, s51, s50
    s_add_u32 m0, s51, 0
    s_nop 0
    buffer_load_dwordx4 v8, s[24:27], s52 offen lds
    s_add_u32 s51, s49, 7
    s_and_b32 s51, s51, 7
    s_mul_i32 s52, s51, 229376
    s_lshl_b32 s51, s51, 10
    s_add_u32 s51, s51, s50
    s_add_u32 m0, s51, 32768
    s_nop 0
    buffer_load_dwordx4 v8, s[28:31], s52 offen lds
    s_lshl_b32 s52, s45, 15
    buffer_load_dwordx2 v[88:89], v9, s[32:35], s52 offen offset:0
    buffer_load_dwordx2 v[90:91], v9, s[32:35], s52 offen offset:2048
    s_add_u32 s52, s52, 4096
    buffer_load_dwordx2 v[92:93], v9, s[32:35], s52 offen offset:0
    buffer_load_dwordx2 v[94:95], v9, s[32:35], s52 offen offset:2048
    s_add_u32 s52, s52, 4096
    buffer_load_dwordx2 v[96:97], v9, s[32:35], s52 offen offset:0
    buffer_load_dwordx2 v[98:99], v9, s[32:35], s52 offen offset:2048
    s_add_u32 s52, s52, 4096
    buffer_load_dwordx2 v[100:101], v9, s[32:35], s52 offen offset:0
    buffer_load_dwordx2 v[102:103], v9, s[32:35], s52 offen offset:2048
    s_add_u32 s52, s52, 4096
    buffer_load_dwordx2 v[104:105], v9, s[32:35], s52 offen offset:0
    buffer_load_dwordx2 v[106:107], v9, s[32:35], s52 offen offset:2048
    s_add_u32 s52, s52, 4096
    buffer_load_dwordx2 v[108:109], v9, s[32:35], s52 offen offset:0
    buffer_load_dwordx2 v[110:111], v9, s[32:35], s52 offen offset:2048
    s_add_u32 s52, s52, 4096
    buffer_load_dwordx2 v[112:113], v9, s[32:35], s52 offen offset:0
    buffer_load_dwordx2 v[114:115], v9, s[32:35], s52 offen offset:2048
    s_add_u32 s52, s52, 4096
    buffer_load_dwordx2 v[116:117], v9, s[32:35], s52 offen offset:0
    buffer_load_dwordx2 v[118:119], v9, s[32:35], s52 offen offset:2048
    s_add_u32 s52, s52, 4096
    s_waitcnt vmcnt(32)
    v_lshlrev_b32 v160, 16, v72
    v_and_b32 v161, 0xffff0000, v72
    v_lshlrev_b32 v162, 16, v73
    v_and_b32 v163, 0xffff0000, v73
    v_lshlrev_b32 v164, 16, v74
    v_and_b32 v165, 0xffff0000, v74
    v_lshlrev_b32 v166, 16, v75
    v_and_b32 v167, 0xffff0000, v75
    v_lshlrev_b32 v168, 16, v76
    v_and_b32 v169, 0xffff0000, v76
    v_lshlrev_b32 v170, 16, v77
    v_and_b32 v171, 0xffff0000, v77
    v_lshlrev_b32 v172, 16, v78
    v_and_b32 v173, 0xffff0000, v78
    v_lshlrev_b32 v174, 16, v79
    v_and_b32 v175, 0xffff0000, v79
    v_lshlrev_b32 v176, 16, v80
    v_and_b32 v177, 0xffff0000, v80
    v_lshlrev_b32 v178, 16, v81
    v_and_b32 v179, 0xffff0000, v81
    v_lshlrev_b32 v180, 16, v82
    v_and_b32 v181, 0xffff0000, v82
    v_lshlrev_b32 v182, 16, v83
    v_and_b32 v183, 0xffff0000, v83
    v_lshlrev_b32 v184, 16, v84
    v_and_b32 v185, 0xffff0000, v84
    v_lshlrev_b32 v186, 16, v85
    v_and_b32 v187, 0xffff0000, v85
    v_lshlrev_b32 v188, 16, v86
    v_and_b32 v189, 0xffff0000, v86
    v_lshlrev_b32 v190, 16, v87
    v_and_b32 v191, 0xffff0000, v87
    v_pk_add_f32 v[192:193], v[160:161], v[162:163]
    v_pk_add_f32 v[194:195], v[164:165], v[166:167]
    v_pk_add_f32 v[192:193], v[192:193], v[168:169]
    v_pk_add_f32 v[194:195], v[194:195], v[170:171]
    v_pk_add_f32 v[192:193], v[192:193], v[172:173]
    v_pk_add_f32 v[194:195], v[194:195], v[174:175]
    v_pk_add_f32 v[192:193], v[192:193], v[176:177]
    v_pk_add_f32 v[194:195], v[194:195], v[178:179]
    v_pk_add_f32 v[192:193], v[192:193], v[180:181]
    v_pk_add_f32 v[194:195], v[194:195], v[182:183]
    v_pk_add_f32 v[192:193], v[192:193], v[184:185]
    v_pk_add_f32 v[194:195], v[194:195], v[186:187]
    v_pk_add_f32 v[192:193], v[192:193], v[188:189]
    v_pk_add_f32 v[194:195], v[194:195], v[190:191]
    v_pk_add_f32 v[192:193], v[192:193], v[194:195]
    v_add_f32 v192, v192, v193
    s_nop 1
    v_add_f32_dpp v192, v192, v192 quad_perm:[1,0,3,2] row_mask:0xf bank_mask:0xf
    s_nop 1
    v_add_f32_dpp v192, v192, v192 quad_perm:[2,3,0,1] row_mask:0xf bank_mask:0xf
    s_nop 1
    v_add_f32_dpp v192, v192, v192 row_half_mirror row_mask:0xf bank_mask:0xf
    s_nop 1
    v_add_f32_dpp v192, v192, v192 row_mirror row_mask:0xf bank_mask:0xf
    v_mov_b32 v194, v192
    s_nop 1
    v_permlane16_swap_b32 v192, v194
    s_nop 1
    v_add_f32 v192, v192, v194
    v_mul_f32 v192, 0xba800000, v192
    v_mov_b32 v193, v192
    v_pk_add_f32 v[194:195], v[160:161], v[192:193]
    v_pk_add_f32 v[198:199], v[162:163], v[192:193]
    v_pk_mul_f32 v[196:197], v[194:195], v[194:195]
    v_pk_fma_f32 v[196:197], v[198:199], v[198:199], v[196:197]
    v_pk_add_f32 v[194:195], v[164:165], v[192:193]
    v_pk_add_f32 v[198:199], v[166:167], v[192:193]
    v_pk_fma_f32 v[196:197], v[194:195], v[194:195], v[196:197]
    v_pk_fma_f32 v[196:197], v[198:199], v[198:199], v[196:197]
    v_pk_add_f32 v[194:195], v[168:169], v[192:193]
    v_pk_add_f32 v[198:199], v[170:171], v[192:193]
    v_pk_fma_f32 v[196:197], v[194:195], v[194:195], v[196:197]
    v_pk_fma_f32 v[196:197], v[198:199], v[198:199], v[196:197]
    v_pk_add_f32 v[194:195], v[172:173], v[192:193]
    v_pk_add_f32 v[198:199], v[174:175], v[192:193]
    v_pk_fma_f32 v[196:197], v[194:195], v[194:195], v[196:197]
    v_pk_fma_f32 v[196:197], v[198:199], v[198:199], v[196:197]
    v_pk_add_f32 v[194:195], v[176:177], v[192:193]
    v_pk_add_f32 v[198:199], v[178:179], v[192:193]
    v_pk_fma_f32 v[196:197], v[194:195], v[194:195], v[196:197]
    v_pk_fma_f32 v[196:197], v[198:199], v[198:199], v[196:197]
    v_pk_add_f32 v[194:195], v[180:181], v[192:193]
    v_pk_add_f32 v[198:199], v[182:183], v[192:193]
    v_pk_fma_f32 v[196:197], v[194:195], v[194:195], v[196:197]
    v_pk_fma_f32 v[196:197], v[198:199], v[198:199], v[196:197]
    v_pk_add_f32 v[194:195], v[184:185], v[192:193]
    v_pk_add_f32 v[198:199], v[186:187], v[192:193]
    v_pk_fma_f32 v[196:197], v[194:195], v[194:195], v[196:197]
    v_pk_fma_f32 v[196:197], v[198:199], v[198:199], v[196:197]
    v_pk_add_f32 v[194:195], v[188:189], v[192:193]
    v_pk_add_f32 v[198:199], v[190:191], v[192:193]
    v_pk_fma_f32 v[196:197], v[194:195], v[194:195], v[196:197]
    v_pk_fma_f32 v[196:197], v[198:199], v[198:199], v[196:197]
    v_add_f32 v196, v196, v197
    s_nop 1
    v_add_f32_dpp v196, v196, v196 quad_perm:[1,0,3,2] row_mask:0xf bank_mask:0xf
    s_nop 1
    v_add_f32_dpp v196, v196, v196 quad_perm:[2,3,0,1] row_mask:0xf bank_mask:0xf
    s_nop 1
    v_add_f32_dpp v196, v196, v196 row_half_mirror row_mask:0xf bank_mask:0xf
    s_nop 1
    v_add_f32_dpp v196, v196, v196 row_mirror row_mask:0xf bank_mask:0xf
    v_mov_b32 v194, v196
    s_nop 1
    v_permlane16_swap_b32 v196, v194
    s_nop 1
    v_add_f32 v196, v196, v194
    v_mul_f32 v196, 0x3a800000, v196
    v_cvt_pk_bf16_f32 v198, v192, v196
    v_and_b32 v196, 0xffff0000, v198
    v_lshlrev_b32 v198, 16, v198
    v_add_f32 v196, 0x3727c5ac, v196
    v_mov_b32 v199, v198
    v_cvt_pk_bf16_f32 v196, v196, v196
    v_and_b32 v196, 0xffff0000, v196
    v_sqrt_f32 v196, v196
    v_pk_add_f32 v[160:161], v[160:161], v[198:199]
    v_pk_add_f32 v[162:163], v[162:163], v[198:199]
    v_pk_add_f32 v[164:165], v[164:165], v[198:199]
    v_pk_add_f32 v[166:167], v[166:167], v[198:199]
    v_pk_add_f32 v[168:169], v[168:169], v[198:199]
    v_pk_add_f32 v[170:171], v[170:171], v[198:199]
    v_pk_add_f32 v[172:173], v[172:173], v[198:199]
    v_pk_add_f32 v[174:175], v[174:175], v[198:199]
    v_pk_add_f32 v[176:177], v[176:177], v[198:199]
    v_pk_add_f32 v[178:179], v[178:179], v[198:199]
    v_pk_add_f32 v[180:181], v[180:181], v[198:199]
    v_pk_add_f32 v[182:183], v[182:183], v[198:199]
    v_pk_add_f32 v[184:185], v[184:185], v[198:199]
    v_pk_add_f32 v[186:187], v[186:187], v[198:199]
    v_pk_add_f32 v[188:189], v[188:189], v[198:199]
    v_pk_add_f32 v[190:191], v[190:191], v[198:199]
    v_cvt_pk_bf16_f32 v196, v196, v196
    v_and_b32 v196, 0xffff0000, v196
    v_rcp_f32 v196, v196
    v_cvt_pk_bf16_f32 v72, v160, v161
    v_cvt_pk_bf16_f32 v73, v162, v163
    v_cvt_pk_bf16_f32 v74, v164, v165
    v_cvt_pk_bf16_f32 v75, v166, v167
    v_cvt_pk_bf16_f32 v76, v168, v169
    v_cvt_pk_bf16_f32 v77, v170, v171
    v_cvt_pk_bf16_f32 v78, v172, v173
    v_cvt_pk_bf16_f32 v79, v174, v175
    v_cvt_pk_bf16_f32 v80, v176, v177
    v_cvt_pk_bf16_f32 v81, v178, v179
    v_cvt_pk_bf16_f32 v82, v180, v181
    v_cvt_pk_bf16_f32 v83, v182, v183
    v_cvt_pk_bf16_f32 v84, v184, v185
    v_cvt_pk_bf16_f32 v85, v186, v187
    v_cvt_pk_bf16_f32 v86, v188, v189
    v_cvt_pk_bf16_f32 v87, v190, v191
    v_mov_b32 v197, v196
    v_lshlrev_b32 v160, 16, v72
    v_and_b32 v161, 0xffff0000, v72
    v_lshlrev_b32 v162, 16, v73
    v_and_b32 v163, 0xffff0000, v73
    v_lshlrev_b32 v164, 16, v74
    v_and_b32 v165, 0xffff0000, v74
    v_lshlrev_b32 v166, 16, v75
    v_and_b32 v167, 0xffff0000, v75
    v_lshlrev_b32 v168, 16, v76
    v_and_b32 v169, 0xffff0000, v76
    v_lshlrev_b32 v170, 16, v77
    v_and_b32 v171, 0xffff0000, v77
    v_lshlrev_b32 v172, 16, v78
    v_and_b32 v173, 0xffff0000, v78
    v_lshlrev_b32 v174, 16, v79
    v_and_b32 v175, 0xffff0000, v79
    v_lshlrev_b32 v176, 16, v80
    v_and_b32 v177, 0xffff0000, v80
    v_lshlrev_b32 v178, 16, v81
    v_and_b32 v179, 0xffff0000, v81
    v_lshlrev_b32 v180, 16, v82
    v_and_b32 v181, 0xffff0000, v82
    v_lshlrev_b32 v182, 16, v83
    v_and_b32 v183, 0xffff0000, v83
    v_lshlrev_b32 v184, 16, v84
    v_and_b32 v185, 0xffff0000, v84
    v_lshlrev_b32 v186, 16, v85
    v_and_b32 v187, 0xffff0000, v85
    v_lshlrev_b32 v188, 16, v86
    v_and_b32 v189, 0xffff0000, v86
    v_lshlrev_b32 v190, 16, v87
    v_and_b32 v191, 0xffff0000, v87
    v_pk_mul_f32 v[160:161], v[160:161], v[196:197]
    v_pk_mul_f32 v[162:163], v[162:163], v[196:197]
    v_pk_mul_f32 v[164:165], v[164:165], v[196:197]
    v_pk_mul_f32 v[166:167], v[166:167], v[196:197]
    v_pk_mul_f32 v[168:169], v[168:169], v[196:197]
    v_pk_mul_f32 v[170:171], v[170:171], v[196:197]
    v_pk_mul_f32 v[172:173], v[172:173], v[196:197]
    v_pk_mul_f32 v[174:175], v[174:175], v[196:197]
    v_pk_mul_f32 v[176:177], v[176:177], v[196:197]
    v_pk_mul_f32 v[178:179], v[178:179], v[196:197]
    v_pk_mul_f32 v[180:181], v[180:181], v[196:197]
    v_pk_mul_f32 v[182:183], v[182:183], v[196:197]
    v_pk_mul_f32 v[184:185], v[184:185], v[196:197]
    v_pk_mul_f32 v[186:187], v[186:187], v[196:197]
    v_pk_mul_f32 v[188:189], v[188:189], v[196:197]
    v_pk_mul_f32 v[190:191], v[190:191], v[196:197]
    v_cvt_pk_bf16_f32 v72, v160, v161
    v_cvt_pk_bf16_f32 v73, v162, v163
    v_cvt_pk_bf16_f32 v74, v164, v165
    v_cvt_pk_bf16_f32 v75, v166, v167
    v_cvt_pk_bf16_f32 v76, v168, v169
    v_cvt_pk_bf16_f32 v77, v170, v171
    v_cvt_pk_bf16_f32 v78, v172, v173
    v_cvt_pk_bf16_f32 v79, v174, v175
    v_cvt_pk_bf16_f32 v80, v176, v177
    v_cvt_pk_bf16_f32 v81, v178, v179
    v_cvt_pk_bf16_f32 v82, v180, v181
    v_cvt_pk_bf16_f32 v83, v182, v183
    v_cvt_pk_bf16_f32 v84, v184, v185
    v_cvt_pk_bf16_f32 v85, v186, v187
    v_cvt_pk_bf16_f32 v86, v188, v189
    v_cvt_pk_bf16_f32 v87, v190, v191
    v_lshlrev_b32 v11, 11, v5
    v_add_u32 v11, v11, v7
    s_lshl_b32 s53, s44, 12
    s_add_u32 s53, s53, 65536
    v_add_u32 v11, s53, v11
    ds_write_b128 v11, v[72:75] offset:0
    ds_write_b128 v11, v[76:79] offset:512
    ds_write_b128 v11, v[80:83] offset:1024
    ds_write_b128 v11, v[84:87] offset:1536
    s_or_b32 s54, s2, s44
    s_cmp_lg_u32 s54, 0
    s_cbranch_scc1 k4_nosel_37
    s_add_u32 s56, s14, 0x4c00000
    s_addc_u32 s57, s15, 0
    s_and_b32 s57, s57, 0xffff
    s_mov_b32 s58, 0x2000
    s_mov_b32 s59, 0x00020000
    v_lshlrev_b32 v160, 16, v72
    v_and_b32 v161, 0xffff0000, v72
    v_lshlrev_b32 v162, 16, v73
    v_and_b32 v163, 0xffff0000, v73
    v_lshlrev_b32 v164, 16, v74
    v_and_b32 v165, 0xffff0000, v74
    v_lshlrev_b32 v166, 16, v75
    v_and_b32 v167, 0xffff0000, v75
    v_lshlrev_b32 v168, 16, v76
    v_and_b32 v169, 0xffff0000, v76
    v_lshlrev_b32 v170, 16, v77
    v_and_b32 v171, 0xffff0000, v77
    v_lshlrev_b32 v172, 16, v78
    v_and_b32 v173, 0xffff0000, v78
    v_lshlrev_b32 v174, 16, v79
    v_and_b32 v175, 0xffff0000, v79
    v_lshlrev_b32 v176, 16, v80
    v_and_b32 v177, 0xffff0000, v80
    v_lshlrev_b32 v178, 16, v81
    v_and_b32 v179, 0xffff0000, v81
    v_lshlrev_b32 v180, 16, v82
    v_and_b32 v181, 0xffff0000, v82
    v_lshlrev_b32 v182, 16, v83
    v_and_b32 v183, 0xffff0000, v83
    v_lshlrev_b32 v184, 16, v84
    v_and_b32 v185, 0xffff0000, v84
    v_lshlrev_b32 v186, 16, v85
    v_and_b32 v187, 0xffff0000, v85
    v_lshlrev_b32 v188, 16, v86
    v_and_b32 v189, 0xffff0000, v86
    v_lshlrev_b32 v190, 16, v87
    v_and_b32 v191, 0xffff0000, v87
    v_pk_mul_f32 v[12:13], v[160:161], v[128:129]
    v_pk_fma_f32 v[12:13], v[162:163], v[130:131], v[12:13]
    v_pk_fma_f32 v[12:13], v[164:165], v[132:133], v[12:13]
    v_pk_fma_f32 v[12:13], v[166:167], v[134:135], v[12:13]
    v_pk_fma_f32 v[12:13], v[168:169], v[136:137], v[12:13]
    v_pk_fma_f32 v[12:13], v[170:171], v[138:139], v[12:13]
    v_pk_fma_f32 v[12:13], v[172:173], v[140:141], v[12:13]
    v_pk_fma_f32 v[12:13], v[174:175], v[142:143], v[12:13]
    v_pk_fma_f32 v[12:13], v[176:177], v[144:145], v[12:13]
    v_pk_fma_f32 v[12:13], v[178:179], v[146:147], v[12:13]
    v_pk_fma_f32 v[12:13], v[180:181], v[148:149], v[12:13]
    v_pk_fma_f32 v[12:13], v[182:183], v[150:151], v[12:13]
    v_pk_fma_f32 v[12:13], v[184:185], v[152:153], v[12:13]
    v_pk_fma_f32 v[12:13], v[186:187], v[154:155], v[12:13]
    v_pk_fma_f32 v[12:13], v[188:189], v[156:157], v[12:13]
    v_pk_fma_f32 v[12:13], v[190:191], v[158:159], v[12:13]
    v_add_f32 v12, v12, v13
    s_nop 1
    v_add_f32_dpp v12, v12, v12 quad_perm:[1,0,3,2] row_mask:0xf bank_mask:0xf
    s_nop 1
    v_add_f32_dpp v12, v12, v12 quad_perm:[2,3,0,1] row_mask:0xf bank_mask:0xf
    s_nop 1
    v_add_f32_dpp v12, v12, v12 row_half_mirror row_mask:0xf bank_mask:0xf
    s_nop 1
    v_add_f32_dpp v12, v12, v12 row_mirror row_mask:0xf bank_mask:0xf
    v_mov_b32 v13, v12
    s_nop 1
    v_permlane16_swap_b32 v12, v13
    s_nop 1
    v_add_f32 v12, v12, v13
    v_cvt_pk_bf16_f32 v12, v12, v12
    v_and_b32 v12, 0xffff0000, v12
    v_mul_f32 v12, 0xbfb8aa3b, v12
    v_exp_f32 v12, v12
    s_nop 0
    v_add_f32 v12, 1.0, v12
    v_rcp_f32 v12, v12
    s_nop 0
    v_cvt_pk_bf16_f32 v12, v12, v12
    v_and_b32 v12, 0xffff0000, v12
    v_lshlrev_b32 v13, 2, v5
    buffer_store_dword v15, v13, s[56:59], 0 offen
    buffer_store_dword v12, v13, s[56:59], 0 offen offset:8
    v_lshl_add_u32 v13, v5, 11, v7
    s_mov_b32 s54, 4096
    buffer_store_dwordx4 v[72:75], v13, s[56:59], s54 offen offset:0
    buffer_store_dwordx4 v[76:79], v13, s[56:59], s54 offen offset:512
    buffer_store_dwordx4 v[80:83], v13, s[56:59], s54 offen offset:1024
    buffer_store_dwordx4 v[84:87], v13, s[56:59], s54 offen offset:1536
    s_waitcnt vmcnt(0)
k4_nosel_37:
    v_lshrrev_b32 v12, 4, v2
    v_and_b32 v13, 1, v2
    v_lshlrev_b32 v13, 11, v13
    v_lshl_add_u32 v13, v12, 3, v13
    s_lshl_b32 s54, s44, 9
    s_add_u32 s54, s54, s53
    v_add_u32 v13, s54, v13
    s_waitcnt lgkmcnt(0)
    ds_read_b64 v[160:161], v13 offset:0
    ds_read_b64 v[162:163], v13 offset:32
    ds_read_b64 v[164:165], v13 offset:64
    ds_read_b64 v[166:167], v13 offset:96
    ds_read_b64 v[168:169], v13 offset:128
    ds_read_b64 v[170:171], v13 offset:160
    ds_read_b64 v[172:173], v13 offset:192
    ds_read_b64 v[174:175], v13 offset:224
    ds_read_b64 v[176:177], v13 offset:256
    ds_read_b64 v[178:179], v13 offset:288
    ds_read_b64 v[180:181], v13 offset:320
    ds_read_b64 v[182:183], v13 offset:352
    ds_read_b64 v[184:185], v13 offset:384
    ds_read_b64 v[186:187], v13 offset:416
    ds_read_b64 v[188:189], v13 offset:448
    ds_read_b64 v[190:191], v13 offset:480
    v_lshlrev_b32 v14, 3, v2
    v_add_u32 v14, s50, v14
    s_waitcnt vmcnt(16)
    ds_read_b64_tr_b16 v[192:193], v14 offset:0
    ds_read_b64_tr_b16 v[194:195], v14 offset:512
    ds_read_b64_tr_b16 v[196:197], v14 offset:1024
    ds_read_b64_tr_b16 v[198:199], v14 offset:1536
    ds_read_b64_tr_b16 v[200:201], v14 offset:2048
    ds_read_b64_tr_b16 v[202:203], v14 offset:2560
    ds_read_b64_tr_b16 v[204:205], v14 offset:3072
    ds_read_b64_tr_b16 v[206:207], v14 offset:3584
    ds_read_b64_tr_b16 v[208:209], v14 offset:4096
    ds_read_b64_tr_b16 v[210:211], v14 offset:4608
    ds_read_b64_tr_b16 v[212:213], v14 offset:5120
    ds_read_b64_tr_b16 v[214:215], v14 offset:5632
    ds_read_b64_tr_b16 v[216:217], v14 offset:6144
    ds_read_b64_tr_b16 v[218:219], v14 offset:6656
    ds_read_b64_tr_b16 v[220:221], v14 offset:7168
    ds_read_b64_tr_b16 v[222:223], v14 offset:7680
    ds_read_b64_tr_b16 v[224:225], v14 offset:32768
    ds_read_b64_tr_b16 v[226:227], v14 offset:33280
    ds_read_b64_tr_b16 v[228:229], v14 offset:33792
    ds_read_b64_tr_b16 v[230:231], v14 offset:34304
    ds_read_b64_tr_b16 v[232:233], v14 offset:34816
    ds_read_b64_tr_b16 v[234:235], v14 offset:35328
    ds_read_b64_tr_b16 v[236:237], v14 offset:35840
    ds_read_b64_tr_b16 v[238:239], v14 offset:36352
    ds_read_b64_tr_b16 v[240:241], v14 offset:36864
    ds_read_b64_tr_b16 v[242:243], v14 offset:37376
    ds_read_b64_tr_b16 v[244:245], v14 offset:37888
    ds_read_b64_tr_b16 v[246:247], v14 offset:38400
    ds_read_b64_tr_b16 v[248:249], v14 offset:38912
    ds_read_b64_tr_b16 v[250:251], v14 offset:39424
    ds_read_b64_tr_b16 v[252:253], v14 offset:39936
    ds_read_b64_tr_b16 v[254:255], v14 offset:40448
    s_waitcnt lgkmcnt(0)
    v_mfma_f32_16x16x32_bf16 v[16:19], v[192:195], v[160:163], 0
    v_mfma_f32_16x16x32_bf16 v[20:23], v[224:227], v[160:163], 0
    v_mfma_f32_16x16x32_bf16 v[16:19], v[196:199], v[164:167], v[16:19]
    v_mfma_f32_16x16x32_bf16 v[20:23], v[228:231], v[164:167], v[20:23]
    v_mfma_f32_16x16x32_bf16 v[16:19], v[200:203], v[168:171], v[16:19]
    v_mfma_f32_16x16x32_bf16 v[20:23], v[232:235], v[168:171], v[20:23]
    v_mfma_f32_16x16x32_bf16 v[16:19], v[204:207], v[172:175], v[16:19]
    v_mfma_f32_16x16x32_bf16 v[20:23], v[236:239], v[172:175], v[20:23]
    v_mfma_f32_16x16x32_bf16 v[16:19], v[208:211], v[176:179], v[16:19]
    v_mfma_f32_16x16x32_bf16 v[20:23], v[240:243], v[176:179], v[20:23]
    v_mfma_f32_16x16x32_bf16 v[16:19], v[212:215], v[180:183], v[16:19]
    v_mfma_f32_16x16x32_bf16 v[20:23], v[244:247], v[180:183], v[20:23]
    v_mfma_f32_16x16x32_bf16 v[16:19], v[216:219], v[184:187], v[16:19]
    v_mfma_f32_16x16x32_bf16 v[20:23], v[248:251], v[184:187], v[20:23]
    v_mfma_f32_16x16x32_bf16 v[16:19], v[220:223], v[188:191], v[16:19]
    v_mfma_f32_16x16x32_bf16 v[20:23], v[252:255], v[188:191], v[20:23]
    v_and_b32 v13, 15, v2
    v_lshlrev_b32 v13, 6, v13
    v_lshl_add_u32 v13, v12, 4, v13
    s_lshl_b32 s54, s44, 11
    s_add_u32 s54, s54, 81984
    v_add_u32 v13, s54, v13
    s_nop 4
    ds_write_b128 v13, v[16:19]
    ds_write_b128 v13, v[20:23] offset:1024
    s_waitcnt lgkmcnt(0)
    s_barrier
    v_lshlrev_b32 v13, 2, v4
    v_add_u32 v13, 81984, v13
    ds_read_b32 v16, v13 offset:0
    ds_read_b32 v20, v13 offset:1024
    ds_read_b32 v17, v13 offset:2048
    ds_read_b32 v21, v13 offset:3072
    ds_read_b32 v18, v13 offset:4096
    ds_read_b32 v22, v13 offset:5120
    ds_read_b32 v19, v13 offset:6144
    ds_read_b32 v23, v13 offset:7168
    s_waitcnt lgkmcnt(0)
    v_add_f32 v16, v16, v17
    v_add_f32 v18, v18, v19
    v_add_f32 v20, v20, v21
    v_add_f32 v22, v22, v23
    v_add_f32 v16, v16, v18
    v_add_f32 v20, v20, v22
    v_cvt_pk_bf16_f32 v16, v16, v20
    v_and_b32 v20, 0xffff0000, v16
    v_lshlrev_b32 v16, 16, v16
    v_mul_f32 v17, 0xbfb8aa3b, v16
    v_exp_f32 v17, v17
    s_nop 0
    v_add_f32 v17, 1.0, v17
    v_rcp_f32 v17, v17
    s_nop 0
    v_mul_f32 v16, v16, v17
    v_cvt_pk_bf16_f32 v16, v16, v16
    v_and_b32 v16, 0xffff0000, v16
    v_mul_f32 v16, v16, v20
    s_nop 1
    v_mov_b32_dpp v17, v16 quad_perm:[1,0,3,2] row_mask:0xf bank_mask:0xf
    v_cvt_pk_bf16_f32 v16, v16, v17
    s_nop 0
    v_readlane_b32 s16, v16, 0
    v_readlane_b32 s17, v16, 2
    v_readlane_b32 s18, v16, 4
    v_readlane_b32 s19, v16, 6
    v_readlane_b32 s20, v16, 8
    v_readlane_b32 s21, v16, 10
    v_readlane_b32 s22, v16, 12
    v_readlane_b32 s23, v16, 14
    v_readlane_b32 s24, v16, 16
    v_readlane_b32 s25, v16, 18
    v_readlane_b32 s26, v16, 20
    v_readlane_b32 s27, v16, 22
    v_readlane_b32 s28, v16, 24
    v_readlane_b32 s29, v16, 26
    v_readlane_b32 s30, v16, 28
    v_readlane_b32 s31, v16, 30
    s_mov_b32 s54, 0x05040100
    s_mov_b32 s55, 0x07060302
    s_waitcnt vmcnt(0)
    v_perm_b32 v16, v90, v88, s54
    v_perm_b32 v17, v90, v88, s55
    v_dot2_f32_bf16 v24, v16, s16, 0
    v_dot2_f32_bf16 v25, v17, s16, 0
    v_dot2_f32_bf16 v28, v16, s24, 0
    v_dot2_f32_bf16 v29, v17, s24, 0
    v_perm_b32 v16, v91, v89, s54
    v_perm_b32 v17, v91, v89, s55
    v_dot2_f32_bf16 v26, v16, s16, 0
    v_dot2_f32_bf16 v27, v17, s16, 0
    v_dot2_f32_bf16 v30, v16, s24, 0
    v_dot2_f32_bf16 v31, v17, s24, 0
    v_perm_b32 v16, v94, v92, s54
    v_perm_b32 v17, v94, v92, s55
    v_dot2_f32_bf16 v24, v16, s17, v24
    v_dot2_f32_bf16 v25, v17, s17, v25
    v_dot2_f32_bf16 v28, v16, s25, v28
    v_dot2_f32_bf16 v29, v17, s25, v29
    v_perm_b32 v16, v95, v93, s54
    v_perm_b32 v17, v95, v93, s55
    v_dot2_f32_bf16 v26, v16, s17, v26
    v_dot2_f32_bf16 v27, v17, s17, v27
    v_dot2_f32_bf16 v30, v16, s25, v30
    v_dot2_f32_bf16 v31, v17, s25, v31
    v_perm_b32 v16, v98, v96, s54
    v_perm_b32 v17, v98, v96, s55
    v_dot2_f32_bf16 v24, v16, s18, v24
    v_dot2_f32_bf16 v25, v17, s18, v25
    v_dot2_f32_bf16 v28, v16, s26, v28
    v_dot2_f32_bf16 v29, v17, s26, v29
    v_perm_b32 v16, v99, v97, s54
    v_perm_b32 v17, v99, v97, s55
    v_dot2_f32_bf16 v26, v16, s18, v26
    v_dot2_f32_bf16 v27, v17, s18, v27
    v_dot2_f32_bf16 v30, v16, s26, v30
    v_dot2_f32_bf16 v31, v17, s26, v31
    v_perm_b32 v16, v102, v100, s54
    v_perm_b32 v17, v102, v100, s55
    v_dot2_f32_bf16 v24, v16, s19, v24
    v_dot2_f32_bf16 v25, v17, s19, v25
    v_dot2_f32_bf16 v28, v16, s27, v28
    v_dot2_f32_bf16 v29, v17, s27, v29
    v_perm_b32 v16, v103, v101, s54
    v_perm_b32 v17, v103, v101, s55
    v_dot2_f32_bf16 v26, v16, s19, v26
    v_dot2_f32_bf16 v27, v17, s19, v27
    v_dot2_f32_bf16 v30, v16, s27, v30
    v_dot2_f32_bf16 v31, v17, s27, v31
    v_perm_b32 v16, v106, v104, s54
    v_perm_b32 v17, v106, v104, s55
    v_dot2_f32_bf16 v24, v16, s20, v24
    v_dot2_f32_bf16 v25, v17, s20, v25
    v_dot2_f32_bf16 v28, v16, s28, v28
    v_dot2_f32_bf16 v29, v17, s28, v29
    v_perm_b32 v16, v107, v105, s54
    v_perm_b32 v17, v107, v105, s55
    v_dot2_f32_bf16 v26, v16, s20, v26
    v_dot2_f32_bf16 v27, v17, s20, v27
    v_dot2_f32_bf16 v30, v16, s28, v30
    v_dot2_f32_bf16 v31, v17, s28, v31
    v_perm_b32 v16, v110, v108, s54
    v_perm_b32 v17, v110, v108, s55
    v_dot2_f32_bf16 v24, v16, s21, v24
    v_dot2_f32_bf16 v25, v17, s21, v25
    v_dot2_f32_bf16 v28, v16, s29, v28
    v_dot2_f32_bf16 v29, v17, s29, v29
    v_perm_b32 v16, v111, v109, s54
    v_perm_b32 v17, v111, v109, s55
    v_dot2_f32_bf16 v26, v16, s21, v26
    v_dot2_f32_bf16 v27, v17, s21, v27
    v_dot2_f32_bf16 v30, v16, s29, v30
    v_dot2_f32_bf16 v31, v17, s29, v31
    v_perm_b32 v16, v114, v112, s54
    v_perm_b32 v17, v114, v112, s55
    v_dot2_f32_bf16 v24, v16, s22, v24
    v_dot2_f32_bf16 v25, v17, s22, v25
    v_dot2_f32_bf16 v28, v16, s30, v28
    v_dot2_f32_bf16 v29, v17, s30, v29
    v_perm_b32 v16, v115, v113, s54
    v_perm_b32 v17, v115, v113, s55
    v_dot2_f32_bf16 v26, v16, s22, v26
    v_dot2_f32_bf16 v27, v17, s22, v27
    v_dot2_f32_bf16 v30, v16, s30, v30
    v_dot2_f32_bf16 v31, v17, s30, v31
    v_perm_b32 v16, v118, v116, s54
    v_perm_b32 v17, v118, v116, s55
    v_dot2_f32_bf16 v24, v16, s23, v24
    v_dot2_f32_bf16 v25, v17, s23, v25
    v_dot2_f32_bf16 v28, v16, s31, v28
    v_dot2_f32_bf16 v29, v17, s31, v29
    v_perm_b32 v16, v119, v117, s54
    v_perm_b32 v17, v119, v117, s55
    v_dot2_f32_bf16 v26, v16, s23, v26
    v_dot2_f32_bf16 v27, v17, s23, v27
    v_dot2_f32_bf16 v30, v16, s31, v30
    v_dot2_f32_bf16 v31, v17, s31, v31
    s_add_u32 s56, s14, 0x4900000
    s_addc_u32 s57, s15, 0
    s_and_b32 s57, s57, 0xffff
    s_mov_b32 s58, 0x1c0000
    s_mov_b32 s59, 0x00020000
    v_lshlrev_b32 v13, 4, v0
    s_lshl_b32 s54, s45, 13
    s_add_u32 s55, s54, 4096
    s_nop 2
    buffer_store_dwordx4 v[24:27], v13, s[56:59], s54 offen
    buffer_store_dwordx4 v[28:31], v13, s[56:59], s55 offen
k4_end_36:
    s_endpgm
.globl k5_kernel
.p2align 8
.type k5_kernel,@function
k5_kernel:
    s_cmp_ge_u32 s2, 64
    s_cbranch_scc1 k5_end_38
    s_load_dwordx2 s[12:13], s[0:1], 88
    s_load_dwordx2 s[14:15], s[0:1], 104
    v_and_b32 v2, 7, v0
    v_lshrrev_b32 v3, 3, v0
    v_lshlrev_b32 v4, 13, v3
    v_lshl_add_u32 v4, v2, 4, v4
    s_lshl_b32 s40, s2, 7
    s_lshr_b32 s41, s2, 5
    s_and_b32 s42, s2, 31
    s_waitcnt lgkmcnt(0)
    s_add_u32 s16, s14, 0x4900000
    s_addc_u32 s17, s15, 0
    s_and_b32 s17, s17, 0xffff
    s_mov_b32 s18, 0x1c0000
    s_mov_b32 s19, 0x00020000
    s_add_u32 s20, s14, 0x4c00000
    s_addc_u32 s21, s15, 0
    s_and_b32 s21, s21, 0xffff
    s_mov_b32 s22, 0x2000
    s_mov_b32 s23, 0x00020000
    s_add_u32 s24, s14, 0x4000000
    s_addc_u32 s25, s15, 0
    s_and_b32 s25, s25, 0xffff
    s_mov_b32 s26, 0x400000
    s_mov_b32 s27, 0x00020000
    s_mov_b32 s28, s12
    s_and_b32 s29, s13, 0xffff
    s_mov_b32 s30, 0x400000
    s_mov_b32 s31, 0x00020000
    s_lshl_b32 s43, s41, 2
    v_mov_b32 v5, s43
    buffer_load_dword v6, v5, s[20:23], 0 offen
    buffer_load_dword v7, v5, s[20:23], 0 offen offset:8
    buffer_load_dwordx4 v[16:19], v4, s[16:19], s40 offen
    s_add_u32 s40, s40, 0x40000
    buffer_load_dwordx4 v[20:23], v4, s[16:19], s40 offen
    s_add_u32 s40, s40, 0x40000
    buffer_load_dwordx4 v[24:27], v4, s[16:19], s40 offen
    s_add_u32 s40, s40, 0x40000
    buffer_load_dwordx4 v[28:31], v4, s[16:19], s40 offen
    s_add_u32 s40, s40, 0x40000
    buffer_load_dwordx4 v[32:35], v4, s[16:19], s40 offen
    s_add_u32 s40, s40, 0x40000
    buffer_load_dwordx4 v[36:39], v4, s[16:19], s40 offen
    s_add_u32 s40, s40, 0x40000
    buffer_load_dwordx4 v[40:43], v4, s[16:19], s40 offen
    s_add_u32 s40, s40, 0x40000
    s_lshl_b32 s44, s42, 6
    v_lshl_add_u32 v8, v2, 3, s44
    s_lshl_b32 s45, s41, 11
    s_add_u32 s45, s45, 4096
    buffer_load_dwordx2 v[10:11], v8, s[20:23], s45 offen
    s_waitcnt vmcnt(8)
    v_and_b32 v6, 0x7ff, v6
    v_lshl_add_u32 v9, v6, 11, v8
    buffer_load_dwordx2 v[12:13], v9, s[24:27], 0 offen
    s_waitcnt vmcnt(2)
    v_pk_add_f32 v[16:17], v[16:17], v[20:21]
    v_pk_add_f32 v[18:19], v[18:19], v[22:23]
    v_pk_add_f32 v[16:17], v[16:17], v[24:25]
    v_pk_add_f32 v[18:19], v[18:19], v[26:27]
    v_pk_add_f32 v[16:17], v[16:17], v[28:29]
    v_pk_add_f32 v[18:19], v[18:19], v[30:31]
    v_pk_add_f32 v[16:17], v[16:17], v[32:33]
    v_pk_add_f32 v[18:19], v[18:19], v[34:35]
    v_pk_add_f32 v[16:17], v[16:17], v[36:37]
    v_pk_add_f32 v[18:19], v[18:19], v[38:39]
    v_pk_add_f32 v[16:17], v[16:17], v[40:41]
    v_pk_add_f32 v[18:19], v[18:19], v[42:43]
    s_nop 1
    v_add_f32_dpp v16, v16, v16 row_ror:8 row_mask:0xf bank_mask:0xf
    v_add_f32_dpp v17, v17, v17 row_ror:8 row_mask:0xf bank_mask:0xf
    v_add_f32_dpp v18, v18, v18 row_ror:8 row_mask:0xf bank_mask:0xf
    v_add_f32_dpp v19, v19, v19 row_ror:8 row_mask:0xf bank_mask:0xf
    v_mov_b32 v20, v16
    v_mov_b32 v21, v17
    v_mov_b32 v22, v18
    v_mov_b32 v23, v19
    s_nop 1
    v_permlane16_swap_b32 v16, v20
    v_permlane16_swap_b32 v17, v21
    v_permlane16_swap_b32 v18, v22
    v_permlane16_swap_b32 v19, v23
    s_nop 1
    v_add_f32 v16, v16, v20
    v_add_f32 v17, v17, v21
    v_add_f32 v18, v18, v22
    v_add_f32 v19, v19, v23
    v_mov_b32 v20, v16
    v_mov_b32 v21, v17
    v_mov_b32 v22, v18
    v_mov_b32 v23, v19
    s_nop 1
    v_permlane32_swap_b32 v16, v20
    v_permlane32_swap_b32 v17, v21
    v_permlane32_swap_b32 v18, v22
    v_permlane32_swap_b32 v19, v23
    s_nop 1
    v_add_f32 v16, v16, v20
    v_add_f32 v17, v17, v21
    v_add_f32 v18, v18, v22
    v_add_f32 v19, v19, v23
    v_lshrrev_b32 v14, 6, v0
    v_lshlrev_b32 v14, 7, v14
    v_lshl_add_u32 v14, v2, 4, v14
    ds_write_b128 v14, v[16:19]
    s_waitcnt lgkmcnt(0)
    s_barrier
    v_lshlrev_b32 v14, 4, v2
    ds_read_b128 v[16:19], v14 offset:0
    ds_read_b128 v[20:23], v14 offset:128
    ds_read_b128 v[24:27], v14 offset:256
    ds_read_b128 v[28:31], v14 offset:384
    s_waitcnt vmcnt(0) lgkmcnt(0)
    v_pk_add_f32 v[16:17], v[16:17], v[20:21]
    v_pk_add_f32 v[18:19], v[18:19], v[22:23]
    v_pk_add_f32 v[16:17], v[16:17], v[24:25]
    v_pk_add_f32 v[18:19], v[18:19], v[26:27]
    v_pk_add_f32 v[16:17], v[16:17], v[28:29]
    v_pk_add_f32 v[18:19], v[18:19], v[30:31]
    v_cvt_pk_bf16_f32 v20, v16, v17
    v_lshlrev_b32 v21, 16, v20
    v_and_b32 v22, 0xffff0000, v20
    v_mul_f32 v21, v21, v7
    v_mul_f32 v22, v22, v7
    v_cvt_pk_bf16_f32 v20, v21, v22
    v_lshlrev_b32 v21, 16, v20
    v_and_b32 v22, 0xffff0000, v20
    v_lshlrev_b32 v23, 16, v10
    v_and_b32 v24, 0xffff0000, v10
    v_add_f32 v21, v21, v23
    v_add_f32 v22, v22, v24
    v_cvt_pk_bf16_f32 v20, v21, v22
    v_lshlrev_b32 v21, 16, v20
    v_and_b32 v22, 0xffff0000, v20
    v_lshlrev_b32 v23, 16, v12
    v_and_b32 v24, 0xffff0000, v12
    v_add_f32 v21, v21, v23
    v_add_f32 v22, v22, v24
    v_cvt_pk_bf16_f32 v26, v21, v22
    v_cvt_pk_bf16_f32 v20, v18, v19
    v_lshlrev_b32 v21, 16, v20
    v_and_b32 v22, 0xffff0000, v20
    v_mul_f32 v21, v21, v7
    v_mul_f32 v22, v22, v7
    v_cvt_pk_bf16_f32 v20, v21, v22
    v_lshlrev_b32 v21, 16, v20
    v_and_b32 v22, 0xffff0000, v20
    v_lshlrev_b32 v23, 16, v11
    v_and_b32 v24, 0xffff0000, v11
    v_add_f32 v21, v21, v23
    v_add_f32 v22, v22, v24
    v_cvt_pk_bf16_f32 v20, v21, v22
    v_lshlrev_b32 v21, 16, v20
    v_and_b32 v22, 0xffff0000, v20
    v_lshlrev_b32 v23, 16, v13
    v_and_b32 v24, 0xffff0000, v13
    v_add_f32 v21, v21, v23
    v_add_f32 v22, v22, v24
    v_cvt_pk_bf16_f32 v27, v21, v22
    v_cmp_gt_u32 vcc, 8, v0
    s_and_saveexec_b64 s[46:47], vcc
    s_cbranch_execz k5_skip_39
    buffer_store_dwordx2 v[26:27], v9, s[28:31], 0 offen
k5_skip_39:
    s_mov_b64 exec, s[46:47]
k5_end_38:
    s_endpgm
.section .rodata,"a"
.p2align 6
.amdhsa_kernel k1_kernel
  .amdhsa_next_free_vgpr 512
  .amdhsa_next_free_sgpr 102
  .amdhsa_accum_offset 256
  .amdhsa_group_segment_fixed_size 0
  .amdhsa_kernarg_size 112
  .amdhsa_user_sgpr_count 2
  .amdhsa_user_sgpr_kernarg_segment_ptr 1
  .amdhsa_system_sgpr_workgroup_id_x 1
.end_amdhsa_kernel
.p2align 6
.amdhsa_kernel k2_kernel
  .amdhsa_next_free_vgpr 512
  .amdhsa_next_free_sgpr 102
  .amdhsa_accum_offset 256
  .amdhsa_group_segment_fixed_size 0
  .amdhsa_kernarg_size 112
  .amdhsa_user_sgpr_count 2
  .amdhsa_user_sgpr_kernarg_segment_ptr 1
  .amdhsa_system_sgpr_workgroup_id_x 1
.end_amdhsa_kernel
.p2align 6
.amdhsa_kernel k3_kernel
  .amdhsa_next_free_vgpr 320
  .amdhsa_next_free_sgpr 102
  .amdhsa_accum_offset 128
  .amdhsa_group_segment_fixed_size 0
  .amdhsa_kernarg_size 112
  .amdhsa_user_sgpr_count 2
  .amdhsa_user_sgpr_kernarg_segment_ptr 1
  .amdhsa_system_sgpr_workgroup_id_x 1
.end_amdhsa_kernel
.p2align 6
.amdhsa_kernel k4_kernel
  .amdhsa_next_free_vgpr 256
  .amdhsa_next_free_sgpr 102
  .amdhsa_accum_offset 256
  .amdhsa_group_segment_fixed_size 0
  .amdhsa_kernarg_size 112
  .amdhsa_user_sgpr_count 2
  .amdhsa_user_sgpr_kernarg_segment_ptr 1
  .amdhsa_system_sgpr_workgroup_id_x 1
.end_amdhsa_kernel
.p2align 6
.amdhsa_kernel k5_kernel
  .amdhsa_next_free_vgpr 64
  .amdhsa_next_free_sgpr 102
  .amdhsa_accum_offset 64
  .amdhsa_group_segment_fixed_size 0
  .amdhsa_kernarg_size 112
  .amdhsa_user_sgpr_count 2
  .amdhsa_user_sgpr_kernarg_segment_ptr 1
  .amdhsa_system_sgpr_workgroup_id_x 1
.end_amdhsa_kernel
```

```asm
; @launch kernel=k12_kernel grid=(256,1,1) block=(256,1,1) lds=163840
; @launch kernel=k3_kernel grid=(256,1,1) block=(256,1,1) lds=65536
; @launch kernel=k4_kernel grid=(256,1,1) block=(256,1,1) lds=90176
; @launch kernel=k5_kernel grid=(64,1,1) block=(256,1,1) lds=512
.amdgcn_target "amdgcn-amd-amdhsa--gfx950"
.text
.globl k12_kernel
.p2align 8
.type k12_kernel,@function
k12_kernel:
    s_cmp_ge_u32 s2, 256
    s_cbranch_scc1 k12_end_1
    s_load_dwordx4 s[36:39], s[0:1], 0
    s_load_dwordx4 s[40:43], s[0:1], 24
    s_load_dwordx2 s[4:5], s[0:1], 16
    s_load_dwordx4 s[60:63], s[0:1], 96
    s_and_b32 s58, s2, 7
    s_lshr_b32 s59, s2, 3
    s_and_b32 s45, s59, 7
    s_lshr_b32 s57, s59, 3
    s_and_b32 s44, s57, 1
    s_lshl_b32 s52, s58, 1
    s_add_u32 s44, s44, s52
    s_lshr_b32 s57, s57, 1
    v_lshrrev_b32 v2, 6, v0
    v_and_b32 v3, 63, v0
    v_readfirstlane_b32 s30, v2
    v_lshlrev_b32 v1, 4, v3
    v_lshrrev_b32 v60, 5, v3
    v_lshl_add_u32 v60, v2, 1, v60
    v_and_b32 v61, 31, v3
    v_lshlrev_b32 v6, 11, v60
    v_lshl_add_u32 v62, v61, 4, v6
    s_lshl_b32 s52, s2, 14
    v_lshrrev_b32 v56, 3, v3
    v_and_b32 v57, 7, v3
    v_lshrrev_b32 v58, 1, v56
    v_xor_b32 v6, v57, v58
    v_xor_b32 v7, 4, v6
    v_lshl_add_u32 v58, v2, 6, v56
    v_lshlrev_b32 v58, 10, v58
    s_lshl_b32 s47, s45, 18
    v_add_u32 v58, s47, v58
    v_lshl_add_u32 v10, v6, 4, v58
    v_lshl_add_u32 v11, v7, 4, v58
    v_add_u32 v17, 54272, v11
    v_add_u32 v16, 47104, v10
    v_add_u32 v15, 39936, v11
    v_add_u32 v14, 32768, v10
    v_add_u32 v13, 21504, v11
    v_add_u32 v12, 14336, v10
    v_add_u32 v11, 7168, v11
    v_add_u32 v10, 0, v10
    v_lshrrev_b32 v6, 5, v3
    v_bfe_u32 v7, v3, 1, 4
    v_and_b32 v59, 1, v3
    v_lshl_add_u32 v58, v2, 4, v6
    v_lshlrev_b32 v58, 13, v58
    v_lshl_add_u32 v58, v59, 4, v58
    s_lshl_b32 s47, s44, 9
    v_add_u32 v58, s47, v58
    v_xor_b32 v7, v7, v6
    v_xor_b32 v6, 0, v7
    v_lshl_add_u32 v6, v6, 5, v58
    v_add_u32 v18, 0, v6
    v_xor_b32 v6, 2, v7
    v_lshl_add_u32 v6, v6, 5, v58
    v_add_u32 v19, 15360, v6
    v_xor_b32 v6, 0, v7
    v_lshl_add_u32 v6, v6, 5, v58
    v_add_u32 v20, 30720, v6
    v_xor_b32 v6, 2, v7
    v_lshl_add_u32 v6, v6, 5, v58
    v_add_u32 v21, 46080, v6
    v_xor_b32 v6, 4, v7
    v_lshl_add_u32 v6, v6, 5, v58
    v_add_u32 v22, 65536, v6
    v_xor_b32 v6, 6, v7
    v_lshl_add_u32 v6, v6, 5, v58
    v_add_u32 v23, 80896, v6
    v_xor_b32 v6, 4, v7
    v_lshl_add_u32 v6, v6, 5, v58
    v_add_u32 v24, 96256, v6
    v_xor_b32 v6, 6, v7
    v_lshl_add_u32 v6, v6, 5, v58
    v_add_u32 v25, 111616, v6
    s_lshl_b32 s48, s30, 13
    s_mov_b32 s49, 0
    s_mov_b32 s50, 0
    s_waitcnt lgkmcnt(0)
    s_mov_b32 s24, s36
    s_and_b32 s25, s37, 0xffff
    s_mov_b32 s26, 0x400000
    s_mov_b32 s27, 0x00020000
    buffer_load_dwordx4 v[64:67], v62, s[24:27], s52 offen offset:0 nt
    buffer_load_dwordx4 v[68:71], v62, s[24:27], s52 offen offset:512 nt
    buffer_load_dwordx4 v[72:75], v62, s[24:27], s52 offen offset:1024 nt
    buffer_load_dwordx4 v[76:79], v62, s[24:27], s52 offen offset:1536 nt
    s_mov_b32 s16, s38
    s_and_b32 s17, s39, 0xffff
    s_mov_b32 s18, 0x200000
    s_mov_b32 s19, 0x00020000
    s_cmp_eq_u32 s57, 0
    s_cselect_b32 s20, s40, s42
    s_cselect_b32 s21, s41, s43
    s_and_b32 s21, s21, 0xffff
    s_mov_b32 s22, 0x400000
    s_mov_b32 s23, 0x00020000
    s_add_u32 m0, s48, 0
    s_nop 0
    buffer_load_dwordx4 v10, s[16:19], s49 offen offset:0 lds
    buffer_load_dwordx4 v11, s[16:19], s49 offen offset:1024 lds
    buffer_load_dwordx4 v12, s[16:19], s49 offen offset:2048 lds
    buffer_load_dwordx4 v13, s[16:19], s49 offen offset:3072 lds
    s_add_u32 m0, s48, 4096
    s_nop 0
    buffer_load_dwordx4 v14, s[16:19], s49 offen offset:0 lds
    buffer_load_dwordx4 v15, s[16:19], s49 offen offset:1024 lds
    buffer_load_dwordx4 v16, s[16:19], s49 offen offset:2048 lds
    buffer_load_dwordx4 v17, s[16:19], s49 offen offset:3072 lds
    s_add_u32 s49, s49, 128
    s_add_u32 m0, s48, 65536
    s_nop 0
    buffer_load_dwordx4 v18, s[20:23], s50 offen offset:0 nt lds
    buffer_load_dwordx4 v19, s[20:23], s50 offen offset:1024 nt lds
    buffer_load_dwordx4 v20, s[20:23], s50 offen offset:2048 nt lds
    buffer_load_dwordx4 v21, s[20:23], s50 offen offset:3072 nt lds
    s_add_u32 m0, s48, 69632
    s_nop 0
    buffer_load_dwordx4 v22, s[20:23], s50 offen offset:0 nt lds
    buffer_load_dwordx4 v23, s[20:23], s50 offen offset:1024 nt lds
    buffer_load_dwordx4 v24, s[20:23], s50 offen offset:2048 nt lds
    buffer_load_dwordx4 v25, s[20:23], s50 offen offset:3072 nt lds
    s_add_u32 s50, s50, 0x80000
    s_getpc_b64 s[40:41]
    s_and_b32 s40, s40, 0xffffff00
    s_and_b32 s41, s41, 0xffff
    s_mov_b32 s42, 0x10000
    s_mov_b32 s43, 0x00020000
    s_lshl_b32 s52, s59, 11
    s_lshl_b32 s31, s30, 9
    s_add_u32 s52, s52, s31
    v_and_b32 v6, 3, v3
    v_lshlrev_b32 v6, 7, v6
    buffer_load_dword v51, v6, s[40:43], s52 offen
    s_mov_b64 s[6:7], s[62:63]
    s_add_u32 s8, s6, 0x0
    s_addc_u32 s9, s7, 0
    s_and_b32 s9, s9, 0xffff
    s_mov_b32 s10, 0x400000
    s_mov_b32 s11, 0x00020000
    s_mov_b32 s12, s4
    s_and_b32 s13, s5, 0xffff
    s_mov_b32 s14, 0x800000
    s_mov_b32 s15, 0x00020000
    s_add_u32 s32, s6, 0x1000000
    s_addc_u32 s33, s7, 0
    s_and_b32 s33, s33, 0xffff
    s_mov_b32 s34, 0x2000000
    s_mov_b32 s35, 0x00020000
    s_mov_b32 s24, s60
    s_and_b32 s25, s61, 0xffff
    s_mov_b32 s26, 0x100
    s_mov_b32 s27, 0x00020000
    s_lshl_b32 s28, s58, 2
    s_and_b32 s31, s59, 3
    s_add_u32 s28, s28, s31
    s_lshr_b32 s29, s59, 2
    s_lshl_b32 s42, s29, 7
    s_sub_u32 s43, 1920, s42
    s_lshl_b32 s31, s30, 5
    s_add_u32 s38, s42, s31
    s_add_u32 s39, s43, s31
    s_lshl_b32 s60, s30, 12
    s_mov_b32 s61, 0
    s_mov_b32 s62, 0
    s_lshl_b32 s47, s44, 1
    s_lshr_b32 s52, s30, 1
    s_add_u32 s47, s47, s52
    s_lshl_b32 s47, s47, 14
    s_lshl_b32 s52, s45, 1
    s_and_b32 s53, s30, 1
    s_add_u32 s52, s52, s53
    s_lshl_b32 s52, s52, 20
    s_add_u32 s47, s47, s52
    s_lshl_b32 s52, s57, 24
    s_add_u32 s47, s47, s52
    s_lshl_b32 s54, s44, 8
    s_lshr_b32 s55, s28, 1
    s_lshl_b32 s55, s55, 8
    s_and_b32 s53, s59, 3
    s_add_u32 s53, s53, 1
    s_cmp_eq_u32 s30, 0
    s_cselect_b32 s53, s53, -1
    s_cselect_b32 s46, 6, -1
    v_lshlrev_b32 v6, 13, v56
    v_lshl_add_u32 v50, v57, 7, v6
    s_lshl_b32 s56, s30, 5
    s_add_u32 s56, s56, s59
    s_lshl_b32 s56, s56, 16
    s_lshl_b32 s52, s58, 10
    s_add_u32 s56, s56, s52
    s_lshl_b32 s63, s30, 1
    v_mul_u32_u24 v6, 2064, v60
    v_lshl_add_u32 v6, v61, 4, v6
    v_add_u32 v54, 131072, v6
    v_mul_u32_u24 v7, 2064, v57
    v_lshl_add_u32 v7, v56, 4, v7
    v_lshl_add_u32 v7, v2, 9, v7
    v_add_u32 v55, 131072, v7
    v_lshrrev_b32 v7, 2, v56
    v_lshl_add_u32 v7, v2, 3, v7
    v_lshlrev_b32 v7, 17, v7
    v_and_b32 v6, 3, v56
    v_lshl_add_u32 v7, v6, 8, v7
    v_lshl_add_u32 v7, v57, 4, v7
    s_lshr_b32 s52, s2, 1
    s_lshl_b32 s52, s52, 10
    s_and_b32 s31, s2, 1
    s_lshl_b32 s31, s31, 7
    s_add_u32 s52, s52, s31
    v_add_u32 v53, s52, v7
    v_and_b32 v56, 15, v3
    v_lshrrev_b32 v57, 4, v3
    v_lshrrev_b32 v6, 1, v56
    v_xor_b32 v6, v6, v57
    v_and_b32 v7, 1, v2
    v_lshl_add_u32 v7, v7, 7, v56
    v_lshlrev_b32 v7, 7, v7
    v_lshl_add_u32 v26, v6, 4, v7
    v_xor_b32 v27, 64, v26
    v_lshrrev_b32 v6, 2, v56
    v_and_b32 v58, 1, v57
    v_lshl_add_u32 v58, v58, 2, v6
    v_lshl_add_u32 v59, v57, 3, v6
    v_and_b32 v63, 3, v3
    v_lshlrev_b32 v7, 9, v59
    v_lshrrev_b32 v6, 1, v2
    v_lshl_add_u32 v7, v6, 8, v7
    v_lshl_add_u32 v7, v63, 3, v7
    v_add_u32 v7, 65536, v7
    v_lshlrev_b32 v59, 8, v59
    v_lshl_add_u32 v59, v63, 3, v59
    v_add_u32 v59, 98304, v59
    v_xor_b32 v6, 0, v58
    v_lshl_add_u32 v28, v6, 5, v7
    v_lshl_add_u32 v42, v6, 5, v59
    v_xor_b32 v6, 1, v58
    v_lshl_add_u32 v29, v6, 5, v7
    v_lshl_add_u32 v43, v6, 5, v59
    v_xor_b32 v6, 2, v58
    v_lshl_add_u32 v30, v6, 5, v7
    v_lshl_add_u32 v44, v6, 5, v59
    v_xor_b32 v6, 3, v58
    v_lshl_add_u32 v31, v6, 5, v7
    v_lshl_add_u32 v45, v6, 5, v59
    v_xor_b32 v6, 4, v58
    v_lshl_add_u32 v32, v6, 5, v7
    v_lshl_add_u32 v46, v6, 5, v59
    v_xor_b32 v6, 5, v58
    v_lshl_add_u32 v33, v6, 5, v7
    v_lshl_add_u32 v47, v6, 5, v59
    v_xor_b32 v6, 6, v58
    v_lshl_add_u32 v34, v6, 5, v7
    v_lshl_add_u32 v48, v6, 5, v59
    v_xor_b32 v6, 7, v58
    v_lshl_add_u32 v35, v6, 5, v7
    v_lshl_add_u32 v49, v6, 5, v59
    s_lshl_b32 s31, s38, 6
    v_add_u32 v36, s31, v1
    s_lshl_b32 s31, s39, 6
    v_add_u32 v37, s31, v1
    v_bfe_u32 v6, v3, 1, 3
    v_and_b32 v7, 1, v3
    v_lshl_add_u32 v58, v2, 4, v57
    v_lshlrev_b32 v58, 13, v58
    v_lshl_add_u32 v58, v7, 4, v58
    s_lshl_b32 s31, s28, 8
    v_add_u32 v58, s31, v58
    v_xor_b32 v6, v6, v57
    v_xor_b32 v7, 0, v6
    v_lshl_add_u32 v7, v7, 5, v58
    v_add_u32 v38, 0, v7
    v_xor_b32 v7, 0, v6
    v_lshl_add_u32 v7, v7, 5, v58
    v_add_u32 v39, 31744, v7
    v_xor_b32 v7, 4, v6
    v_lshl_add_u32 v7, v7, 5, v58
    v_add_u32 v40, 63488, v7
    v_xor_b32 v7, 4, v6
    v_lshl_add_u32 v7, v7, 5, v58
    v_add_u32 v41, 95232, v7
    v_lshlrev_b32 v6, 2, v57
    v_sub_u32 v4, v56, v6
    v_mov_b32 v5, 0xff800000
    v_mov_b32 v8, 0
    v_mov_b32 v9, 1
    v_mov_b32 v56, 0
    v_mov_b32 v57, 0
    v_mov_b32 v58, 0
    v_mov_b32 v59, 0
    s_nop 1
    v_mfma_f32_32x32x16_bf16 a[128:143], v[56:59], v[56:59], 0
    v_mfma_f32_32x32x16_bf16 a[144:159], v[56:59], v[56:59], 0
    v_mfma_f32_32x32x16_bf16 a[160:175], v[56:59], v[56:59], 0
    v_mfma_f32_32x32x16_bf16 a[176:191], v[56:59], v[56:59], 0
    v_mfma_f32_32x32x16_bf16 v[128:143], v[56:59], v[56:59], 0
    v_mfma_f32_32x32x16_bf16 v[144:159], v[56:59], v[56:59], 0
    v_mfma_f32_32x32x16_bf16 v[160:175], v[56:59], v[56:59], 0
    v_mfma_f32_32x32x16_bf16 v[176:191], v[56:59], v[56:59], 0
    v_mfma_f32_32x32x16_bf16 v[192:207], v[56:59], v[56:59], 0
    v_mfma_f32_32x32x16_bf16 v[208:223], v[56:59], v[56:59], 0
    v_mfma_f32_32x32x16_bf16 v[224:239], v[56:59], v[56:59], 0
    v_mfma_f32_32x32x16_bf16 v[240:255], v[56:59], v[56:59], 0
    s_waitcnt vmcnt(17)
    v_lshlrev_b32 v80, 16, v64
    v_and_b32 v81, 0xffff0000, v64
    v_lshlrev_b32 v82, 16, v65
    v_and_b32 v83, 0xffff0000, v65
    v_lshlrev_b32 v84, 16, v66
    v_and_b32 v85, 0xffff0000, v66
    v_lshlrev_b32 v86, 16, v67
    v_and_b32 v87, 0xffff0000, v67
    v_lshlrev_b32 v88, 16, v68
    v_and_b32 v89, 0xffff0000, v68
    v_lshlrev_b32 v90, 16, v69
    v_and_b32 v91, 0xffff0000, v69
    v_lshlrev_b32 v92, 16, v70
    v_and_b32 v93, 0xffff0000, v70
    v_lshlrev_b32 v94, 16, v71
    v_and_b32 v95, 0xffff0000, v71
    v_lshlrev_b32 v96, 16, v72
    v_and_b32 v97, 0xffff0000, v72
    v_lshlrev_b32 v98, 16, v73
    v_and_b32 v99, 0xffff0000, v73
    v_lshlrev_b32 v100, 16, v74
    v_and_b32 v101, 0xffff0000, v74
    v_lshlrev_b32 v102, 16, v75
    v_and_b32 v103, 0xffff0000, v75
    v_lshlrev_b32 v104, 16, v76
    v_and_b32 v105, 0xffff0000, v76
    v_lshlrev_b32 v106, 16, v77
    v_and_b32 v107, 0xffff0000, v77
    v_lshlrev_b32 v108, 16, v78
    v_and_b32 v109, 0xffff0000, v78
    v_lshlrev_b32 v110, 16, v79
    v_and_b32 v111, 0xffff0000, v79
    v_pk_add_f32 v[112:113], v[80:81], v[82:83]
    v_pk_add_f32 v[114:115], v[84:85], v[86:87]
    v_pk_add_f32 v[112:113], v[112:113], v[88:89]
    v_pk_add_f32 v[114:115], v[114:115], v[90:91]
    v_pk_add_f32 v[112:113], v[112:113], v[92:93]
    v_pk_add_f32 v[114:115], v[114:115], v[94:95]
    v_pk_add_f32 v[112:113], v[112:113], v[96:97]
    v_pk_add_f32 v[114:115], v[114:115], v[98:99]
    v_pk_add_f32 v[112:113], v[112:113], v[100:101]
    v_pk_add_f32 v[114:115], v[114:115], v[102:103]
    v_pk_add_f32 v[112:113], v[112:113], v[104:105]
    v_pk_add_f32 v[114:115], v[114:115], v[106:107]
    v_pk_add_f32 v[112:113], v[112:113], v[108:109]
    v_pk_add_f32 v[114:115], v[114:115], v[110:111]
    v_pk_add_f32 v[112:113], v[112:113], v[114:115]
    v_add_f32 v112, v112, v113
    s_nop 1
    v_add_f32_dpp v112, v112, v112 quad_perm:[1,0,3,2] row_mask:0xf bank_mask:0xf
    s_nop 1
    v_add_f32_dpp v112, v112, v112 quad_perm:[2,3,0,1] row_mask:0xf bank_mask:0xf
    s_nop 1
    v_add_f32_dpp v112, v112, v112 row_half_mirror row_mask:0xf bank_mask:0xf
    s_nop 1
    v_add_f32_dpp v112, v112, v112 row_mirror row_mask:0xf bank_mask:0xf
    v_mov_b32 v114, v112
    s_nop 1
    v_permlane16_swap_b32 v112, v114
    s_nop 1
    v_add_f32 v112, v112, v114
    v_mul_f32 v112, 0xba800000, v112
    v_mov_b32 v113, v112
    v_pk_add_f32 v[114:115], v[80:81], v[112:113]
    v_pk_add_f32 v[118:119], v[82:83], v[112:113]
    v_pk_mul_f32 v[116:117], v[114:115], v[114:115]
    v_pk_fma_f32 v[116:117], v[118:119], v[118:119], v[116:117]
    v_pk_add_f32 v[114:115], v[84:85], v[112:113]
    v_pk_add_f32 v[118:119], v[86:87], v[112:113]
    v_pk_fma_f32 v[116:117], v[114:115], v[114:115], v[116:117]
    v_pk_fma_f32 v[116:117], v[118:119], v[118:119], v[116:117]
    v_pk_add_f32 v[114:115], v[88:89], v[112:113]
    v_pk_add_f32 v[118:119], v[90:91], v[112:113]
    v_pk_fma_f32 v[116:117], v[114:115], v[114:115], v[116:117]
    v_pk_fma_f32 v[116:117], v[118:119], v[118:119], v[116:117]
    v_pk_add_f32 v[114:115], v[92:93], v[112:113]
    v_pk_add_f32 v[118:119], v[94:95], v[112:113]
    v_pk_fma_f32 v[116:117], v[114:115], v[114:115], v[116:117]
    v_pk_fma_f32 v[116:117], v[118:119], v[118:119], v[116:117]
    v_pk_add_f32 v[114:115], v[96:97], v[112:113]
    v_pk_add_f32 v[118:119], v[98:99], v[112:113]
    v_pk_fma_f32 v[116:117], v[114:115], v[114:115], v[116:117]
    v_pk_fma_f32 v[116:117], v[118:119], v[118:119], v[116:117]
    v_pk_add_f32 v[114:115], v[100:101], v[112:113]
    v_pk_add_f32 v[118:119], v[102:103], v[112:113]
    v_pk_fma_f32 v[116:117], v[114:115], v[114:115], v[116:117]
    v_pk_fma_f32 v[116:117], v[118:119], v[118:119], v[116:117]
    v_pk_add_f32 v[114:115], v[104:105], v[112:113]
    v_pk_add_f32 v[118:119], v[106:107], v[112:113]
    v_pk_fma_f32 v[116:117], v[114:115], v[114:115], v[116:117]
    v_pk_fma_f32 v[116:117], v[118:119], v[118:119], v[116:117]
    v_pk_add_f32 v[114:115], v[108:109], v[112:113]
    v_pk_add_f32 v[118:119], v[110:111], v[112:113]
    v_pk_fma_f32 v[116:117], v[114:115], v[114:115], v[116:117]
    v_pk_fma_f32 v[116:117], v[118:119], v[118:119], v[116:117]
    v_add_f32 v116, v116, v117
    s_nop 1
    v_add_f32_dpp v116, v116, v116 quad_perm:[1,0,3,2] row_mask:0xf bank_mask:0xf
    s_nop 1
    v_add_f32_dpp v116, v116, v116 quad_perm:[2,3,0,1] row_mask:0xf bank_mask:0xf
    s_nop 1
    v_add_f32_dpp v116, v116, v116 row_half_mirror row_mask:0xf bank_mask:0xf
    s_nop 1
    v_add_f32_dpp v116, v116, v116 row_mirror row_mask:0xf bank_mask:0xf
    v_mov_b32 v114, v116
    s_nop 1
    v_permlane16_swap_b32 v116, v114
    s_nop 1
    v_add_f32 v116, v116, v114
    v_mul_f32 v116, 0x3a800000, v116
    v_cvt_pk_bf16_f32 v118, v112, v116
    v_and_b32 v116, 0xffff0000, v118
    v_lshlrev_b32 v118, 16, v118
    v_add_f32 v116, 0x3727c5ac, v116
    v_mov_b32 v119, v118
    v_cvt_pk_bf16_f32 v116, v116, v116
    v_and_b32 v116, 0xffff0000, v116
    v_sqrt_f32 v116, v116
    v_pk_add_f32 v[80:81], v[80:81], v[118:119]
    v_pk_add_f32 v[82:83], v[82:83], v[118:119]
    v_pk_add_f32 v[84:85], v[84:85], v[118:119]
    v_pk_add_f32 v[86:87], v[86:87], v[118:119]
    v_pk_add_f32 v[88:89], v[88:89], v[118:119]
    v_pk_add_f32 v[90:91], v[90:91], v[118:119]
    v_pk_add_f32 v[92:93], v[92:93], v[118:119]
    v_pk_add_f32 v[94:95], v[94:95], v[118:119]
    v_pk_add_f32 v[96:97], v[96:97], v[118:119]
    v_pk_add_f32 v[98:99], v[98:99], v[118:119]
    v_pk_add_f32 v[100:101], v[100:101], v[118:119]
    v_pk_add_f32 v[102:103], v[102:103], v[118:119]
    v_pk_add_f32 v[104:105], v[104:105], v[118:119]
    v_pk_add_f32 v[106:107], v[106:107], v[118:119]
    v_pk_add_f32 v[108:109], v[108:109], v[118:119]
    v_pk_add_f32 v[110:111], v[110:111], v[118:119]
    v_cvt_pk_bf16_f32 v116, v116, v116
    v_and_b32 v116, 0xffff0000, v116
    v_rcp_f32 v116, v116
    v_cvt_pk_bf16_f32 v64, v80, v81
    v_cvt_pk_bf16_f32 v65, v82, v83
    v_cvt_pk_bf16_f32 v66, v84, v85
    v_cvt_pk_bf16_f32 v67, v86, v87
    v_cvt_pk_bf16_f32 v68, v88, v89
    v_cvt_pk_bf16_f32 v69, v90, v91
    v_cvt_pk_bf16_f32 v70, v92, v93
    v_cvt_pk_bf16_f32 v71, v94, v95
    v_cvt_pk_bf16_f32 v72, v96, v97
    v_cvt_pk_bf16_f32 v73, v98, v99
    v_cvt_pk_bf16_f32 v74, v100, v101
    v_cvt_pk_bf16_f32 v75, v102, v103
    v_cvt_pk_bf16_f32 v76, v104, v105
    v_cvt_pk_bf16_f32 v77, v106, v107
    v_cvt_pk_bf16_f32 v78, v108, v109
    v_cvt_pk_bf16_f32 v79, v110, v111
    v_mov_b32 v117, v116
    v_lshlrev_b32 v80, 16, v64
    v_and_b32 v81, 0xffff0000, v64
    v_lshlrev_b32 v82, 16, v65
    v_and_b32 v83, 0xffff0000, v65
    v_lshlrev_b32 v84, 16, v66
    v_and_b32 v85, 0xffff0000, v66
    v_lshlrev_b32 v86, 16, v67
    v_and_b32 v87, 0xffff0000, v67
    v_lshlrev_b32 v88, 16, v68
    v_and_b32 v89, 0xffff0000, v68
    v_lshlrev_b32 v90, 16, v69
    v_and_b32 v91, 0xffff0000, v69
    v_lshlrev_b32 v92, 16, v70
    v_and_b32 v93, 0xffff0000, v70
    v_lshlrev_b32 v94, 16, v71
    v_and_b32 v95, 0xffff0000, v71
    v_lshlrev_b32 v96, 16, v72
    v_and_b32 v97, 0xffff0000, v72
    v_lshlrev_b32 v98, 16, v73
    v_and_b32 v99, 0xffff0000, v73
    v_lshlrev_b32 v100, 16, v74
    v_and_b32 v101, 0xffff0000, v74
    v_lshlrev_b32 v102, 16, v75
    v_and_b32 v103, 0xffff0000, v75
    v_lshlrev_b32 v104, 16, v76
    v_and_b32 v105, 0xffff0000, v76
    v_lshlrev_b32 v106, 16, v77
    v_and_b32 v107, 0xffff0000, v77
    v_lshlrev_b32 v108, 16, v78
    v_and_b32 v109, 0xffff0000, v78
    v_lshlrev_b32 v110, 16, v79
    v_and_b32 v111, 0xffff0000, v79
    v_pk_mul_f32 v[80:81], v[80:81], v[116:117]
    v_pk_mul_f32 v[82:83], v[82:83], v[116:117]
    v_pk_mul_f32 v[84:85], v[84:85], v[116:117]
    v_pk_mul_f32 v[86:87], v[86:87], v[116:117]
    v_pk_mul_f32 v[88:89], v[88:89], v[116:117]
    v_pk_mul_f32 v[90:91], v[90:91], v[116:117]
    v_pk_mul_f32 v[92:93], v[92:93], v[116:117]
    v_pk_mul_f32 v[94:95], v[94:95], v[116:117]
    v_pk_mul_f32 v[96:97], v[96:97], v[116:117]
    v_pk_mul_f32 v[98:99], v[98:99], v[116:117]
    v_pk_mul_f32 v[100:101], v[100:101], v[116:117]
    v_pk_mul_f32 v[102:103], v[102:103], v[116:117]
    v_pk_mul_f32 v[104:105], v[104:105], v[116:117]
    v_pk_mul_f32 v[106:107], v[106:107], v[116:117]
    v_pk_mul_f32 v[108:109], v[108:109], v[116:117]
    v_pk_mul_f32 v[110:111], v[110:111], v[116:117]
    v_cvt_pk_bf16_f32 v64, v80, v81
    v_cvt_pk_bf16_f32 v65, v82, v83
    v_cvt_pk_bf16_f32 v66, v84, v85
    v_cvt_pk_bf16_f32 v67, v86, v87
    v_cvt_pk_bf16_f32 v68, v88, v89
    v_cvt_pk_bf16_f32 v69, v90, v91
    v_cvt_pk_bf16_f32 v70, v92, v93
    v_cvt_pk_bf16_f32 v71, v94, v95
    v_cvt_pk_bf16_f32 v72, v96, v97
    v_cvt_pk_bf16_f32 v73, v98, v99
    v_cvt_pk_bf16_f32 v74, v100, v101
    v_cvt_pk_bf16_f32 v75, v102, v103
    v_cvt_pk_bf16_f32 v76, v104, v105
    v_cvt_pk_bf16_f32 v77, v106, v107
    v_cvt_pk_bf16_f32 v78, v108, v109
    v_cvt_pk_bf16_f32 v79, v110, v111
    ds_write_b128 v54, v[64:67] offset:0
    ds_write_b128 v54, v[68:71] offset:512
    ds_write_b128 v54, v[72:75] offset:1024
    ds_write_b128 v54, v[76:79] offset:1536
    s_add_u32 m0, s48, 32768
    s_nop 0
    buffer_load_dwordx4 v10, s[16:19], s49 offen offset:0 lds
    buffer_load_dwordx4 v11, s[16:19], s49 offen offset:1024 lds
    buffer_load_dwordx4 v12, s[16:19], s49 offen offset:2048 lds
    buffer_load_dwordx4 v13, s[16:19], s49 offen offset:3072 lds
    s_add_u32 m0, s48, 36864
    s_nop 0
    buffer_load_dwordx4 v14, s[16:19], s49 offen offset:0 lds
    buffer_load_dwordx4 v15, s[16:19], s49 offen offset:1024 lds
    buffer_load_dwordx4 v16, s[16:19], s49 offen offset:2048 lds
    buffer_load_dwordx4 v17, s[16:19], s49 offen offset:3072 lds
    s_add_u32 s49, s49, 128
    s_add_u32 m0, s48, 98304
    s_nop 0
    buffer_load_dwordx4 v18, s[20:23], s50 offen offset:0 nt lds
    buffer_load_dwordx4 v19, s[20:23], s50 offen offset:1024 nt lds
    buffer_load_dwordx4 v20, s[20:23], s50 offen offset:2048 nt lds
    buffer_load_dwordx4 v21, s[20:23], s50 offen offset:3072 nt lds
    s_add_u32 m0, s48, 102400
    s_nop 0
    buffer_load_dwordx4 v22, s[20:23], s50 offen offset:0 nt lds
    buffer_load_dwordx4 v23, s[20:23], s50 offen offset:1024 nt lds
    buffer_load_dwordx4 v24, s[20:23], s50 offen offset:2048 nt lds
    buffer_load_dwordx4 v25, s[20:23], s50 offen offset:3072 nt lds
    s_add_u32 s50, s50, 0x80000
    s_waitcnt vmcnt(16) lgkmcnt(0)
    s_barrier
    ds_read_b128 a[192:195], v55 offset:0
    ds_read_b128 a[196:199], v55 offset:128
    ds_read_b128 a[200:203], v55 offset:256
    ds_read_b128 a[204:207], v55 offset:384
    v_mfma_f32_32x32x16_bf16 v[64:79], v[56:59], v[56:59], 0
    v_mfma_f32_32x32x16_bf16 v[80:95], v[56:59], v[56:59], 0
    v_mfma_f32_32x32x16_bf16 v[96:111], v[56:59], v[56:59], 0
    v_mfma_f32_32x32x16_bf16 v[112:127], v[56:59], v[56:59], 0
    s_cmp_ge_u32 s2, 7
    s_cbranch_scc1 k12_nostat_2
    s_lshl_b32 s52, s2, 12
    s_add_u32 s52, s52, 0x3800000
    s_mov_b32 s34, -1
    v_lshlrev_b32 v6, 4, v0
    buffer_store_dwordx4 v[56:59], v6, s[32:35], s52 offen sc1
    s_mov_b32 s34, 0x2000000
k12_nostat_2:
    ds_read_b128 a[0:3], v26 offset:0
    ds_read_b64_tr_b16 a[32:33], v28 offset:0
    ds_read_b64_tr_b16 a[34:35], v28 offset:2048
    ds_read_b128 a[4:7], v26 offset:2048
    ds_read_b64_tr_b16 a[36:37], v29 offset:0
    ds_read_b64_tr_b16 a[38:39], v29 offset:2048
    ds_read_b128 a[8:11], v26 offset:4096
    ds_read_b64_tr_b16 a[40:41], v30 offset:0
    ds_read_b64_tr_b16 a[42:43], v30 offset:2048
    ds_read_b128 a[12:15], v26 offset:6144
    ds_read_b64_tr_b16 a[44:45], v31 offset:0
    ds_read_b64_tr_b16 a[46:47], v31 offset:2048
    ds_read_b128 a[16:19], v26 offset:8192
    ds_read_b64_tr_b16 a[48:49], v32 offset:0
    ds_read_b64_tr_b16 a[50:51], v32 offset:2048
    ds_read_b128 a[20:23], v26 offset:10240
    ds_read_b64_tr_b16 a[52:53], v33 offset:0
    ds_read_b64_tr_b16 a[54:55], v33 offset:2048
    ds_read_b128 a[24:27], v26 offset:12288
    ds_read_b64_tr_b16 a[56:57], v34 offset:0
    ds_read_b64_tr_b16 a[58:59], v34 offset:2048
    ds_read_b128 a[28:31], v26 offset:14336
    ds_read_b64_tr_b16 a[60:61], v35 offset:0
    ds_read_b64_tr_b16 a[62:63], v35 offset:2048
    s_mov_b32 s51, 0
    s_waitcnt lgkmcnt(15)
    s_mov_b32 s52, 0
    buffer_store_dwordx4 a[192:195], v53, s[8:11], s52 offen sc1
    s_mov_b32 s52, 262144
    buffer_store_dwordx4 a[196:199], v53, s[8:11], s52 offen sc1
    s_mov_b32 s52, 524288
    buffer_store_dwordx4 a[200:203], v53, s[8:11], s52 offen sc1
    s_mov_b32 s52, 786432
    buffer_store_dwordx4 a[204:207], v53, s[8:11], s52 offen sc1
    s_waitcnt lgkmcnt(0)
    s_cmp_lg_u32 s57, 0
    s_cbranch_scc1 k12_v_3
k12_loop_5:
    v_mfma_f32_16x16x32_bf16 v[64:67], a[32:35], a[0:3], v[64:67]
    ds_read_b128 a[64:67], v27 offset:0
    v_mfma_f32_16x16x32_bf16 v[80:83], a[32:35], a[4:7], v[80:83]
    ds_read_b64_tr_b16 a[96:97], v28 offset:16384
    v_mfma_f32_16x16x32_bf16 v[96:99], a[32:35], a[8:11], v[96:99]
    v_mfma_f32_16x16x32_bf16 v[112:115], a[32:35], a[12:15], v[112:115]
    s_cmp_eq_u32 s51, s46
    s_cbranch_scc1 k12_ool_7
k12_oolret_8:
    v_mfma_f32_16x16x32_bf16 v[128:131], a[32:35], a[16:19], v[128:131]
    ds_read_b64_tr_b16 a[98:99], v28 offset:18432
    v_mfma_f32_16x16x32_bf16 v[144:147], a[32:35], a[20:23], v[144:147]
    ds_read_b128 a[68:71], v27 offset:2048
    v_mfma_f32_16x16x32_bf16 a[128:131], a[32:35], a[24:27], a[128:131]
    v_mfma_f32_16x16x32_bf16 a[160:163], a[32:35], a[28:31], a[160:163]
    ds_read_b64_tr_b16 a[100:101], v29 offset:16384
    v_mfma_f32_16x16x32_bf16 v[160:163], a[36:39], a[0:3], v[160:163]
    v_mfma_f32_16x16x32_bf16 v[176:179], a[36:39], a[4:7], v[176:179]
    ds_read_b64_tr_b16 a[102:103], v29 offset:18432
    v_mfma_f32_16x16x32_bf16 v[192:195], a[36:39], a[8:11], v[192:195]
    v_mfma_f32_16x16x32_bf16 v[208:211], a[36:39], a[12:15], v[208:211]
    ds_read_b128 a[72:75], v27 offset:4096
    v_mfma_f32_16x16x32_bf16 v[224:227], a[36:39], a[16:19], v[224:227]
    v_mfma_f32_16x16x32_bf16 v[240:243], a[36:39], a[20:23], v[240:243]
    v_mfma_f32_16x16x32_bf16 a[132:135], a[36:39], a[24:27], a[132:135]
    ds_read_b64_tr_b16 a[104:105], v30 offset:16384
    v_mfma_f32_16x16x32_bf16 a[164:167], a[36:39], a[28:31], a[164:167]
    v_mfma_f32_16x16x32_bf16 v[68:71], a[40:43], a[0:3], v[68:71]
    ds_read_b64_tr_b16 a[106:107], v30 offset:18432
    v_mfma_f32_16x16x32_bf16 v[84:87], a[40:43], a[4:7], v[84:87]
    v_mfma_f32_16x16x32_bf16 v[100:103], a[40:43], a[8:11], v[100:103]
    ds_read_b128 a[76:79], v27 offset:6144
    v_mfma_f32_16x16x32_bf16 v[116:119], a[40:43], a[12:15], v[116:119]
    v_mfma_f32_16x16x32_bf16 v[132:135], a[40:43], a[16:19], v[132:135]
    ds_read_b64_tr_b16 a[108:109], v31 offset:16384
    v_mfma_f32_16x16x32_bf16 v[148:151], a[40:43], a[20:23], v[148:151]
    v_mfma_f32_16x16x32_bf16 a[136:139], a[40:43], a[24:27], a[136:139]
    ds_read_b64_tr_b16 a[110:111], v31 offset:18432
    v_mfma_f32_16x16x32_bf16 a[168:171], a[40:43], a[28:31], a[168:171]
    v_mfma_f32_16x16x32_bf16 v[164:167], a[44:47], a[0:3], v[164:167]
    ds_read_b128 a[80:83], v27 offset:8192
    v_mfma_f32_16x16x32_bf16 v[180:183], a[44:47], a[4:7], v[180:183]
    v_mfma_f32_16x16x32_bf16 v[196:199], a[44:47], a[8:11], v[196:199]
    ds_read_b64_tr_b16 a[112:113], v32 offset:16384
    v_mfma_f32_16x16x32_bf16 v[212:215], a[44:47], a[12:15], v[212:215]
    v_mfma_f32_16x16x32_bf16 v[228:231], a[44:47], a[16:19], v[228:231]
    ds_read_b64_tr_b16 a[114:115], v32 offset:18432
    v_mfma_f32_16x16x32_bf16 v[244:247], a[44:47], a[20:23], v[244:247]
    v_mfma_f32_16x16x32_bf16 a[140:143], a[44:47], a[24:27], a[140:143]
    ds_read_b128 a[84:87], v27 offset:10240
    v_mfma_f32_16x16x32_bf16 a[172:175], a[44:47], a[28:31], a[172:175]
    v_mfma_f32_16x16x32_bf16 v[72:75], a[48:51], a[0:3], v[72:75]
    ds_read_b64_tr_b16 a[116:117], v33 offset:16384
    v_mfma_f32_16x16x32_bf16 v[88:91], a[48:51], a[4:7], v[88:91]
    v_mfma_f32_16x16x32_bf16 v[104:107], a[48:51], a[8:11], v[104:107]
    ds_read_b64_tr_b16 a[118:119], v33 offset:18432
    v_mfma_f32_16x16x32_bf16 v[120:123], a[48:51], a[12:15], v[120:123]
    v_mfma_f32_16x16x32_bf16 v[136:139], a[48:51], a[16:19], v[136:139]
    ds_read_b128 a[88:91], v27 offset:12288
    v_mfma_f32_16x16x32_bf16 v[152:155], a[48:51], a[20:23], v[152:155]
    v_mfma_f32_16x16x32_bf16 a[144:147], a[48:51], a[24:27], a[144:147]
    v_mfma_f32_16x16x32_bf16 a[176:179], a[48:51], a[28:31], a[176:179]
    ds_read_b64_tr_b16 a[120:121], v34 offset:16384
    v_mfma_f32_16x16x32_bf16 v[168:171], a[52:55], a[0:3], v[168:171]
    v_mfma_f32_16x16x32_bf16 v[184:187], a[52:55], a[4:7], v[184:187]
    ds_read_b64_tr_b16 a[122:123], v34 offset:18432
    v_mfma_f32_16x16x32_bf16 v[200:203], a[52:55], a[8:11], v[200:203]
    v_mfma_f32_16x16x32_bf16 v[216:219], a[52:55], a[12:15], v[216:219]
    ds_read_b128 a[92:95], v27 offset:14336
    v_mfma_f32_16x16x32_bf16 v[232:235], a[52:55], a[16:19], v[232:235]
    v_mfma_f32_16x16x32_bf16 v[248:251], a[52:55], a[20:23], v[248:251]
    ds_read_b64_tr_b16 a[124:125], v35 offset:16384
    v_mfma_f32_16x16x32_bf16 a[148:151], a[52:55], a[24:27], a[148:151]
    v_mfma_f32_16x16x32_bf16 a[180:183], a[52:55], a[28:31], a[180:183]
    ds_read_b64_tr_b16 a[126:127], v35 offset:18432
    v_mfma_f32_16x16x32_bf16 v[76:79], a[56:59], a[0:3], v[76:79]
    v_mfma_f32_16x16x32_bf16 v[92:95], a[56:59], a[4:7], v[92:95]
    v_mfma_f32_16x16x32_bf16 v[108:111], a[56:59], a[8:11], v[108:111]
    v_mfma_f32_16x16x32_bf16 v[124:127], a[56:59], a[12:15], v[124:127]
    v_mfma_f32_16x16x32_bf16 v[140:143], a[56:59], a[16:19], v[140:143]
    v_mfma_f32_16x16x32_bf16 v[156:159], a[56:59], a[20:23], v[156:159]
    v_mfma_f32_16x16x32_bf16 a[152:155], a[56:59], a[24:27], a[152:155]
    v_mfma_f32_16x16x32_bf16 a[184:187], a[56:59], a[28:31], a[184:187]
    v_mfma_f32_16x16x32_bf16 v[172:175], a[60:63], a[0:3], v[172:175]
    v_mfma_f32_16x16x32_bf16 v[188:191], a[60:63], a[4:7], v[188:191]
    v_mfma_f32_16x16x32_bf16 v[204:207], a[60:63], a[8:11], v[204:207]
    v_mfma_f32_16x16x32_bf16 v[220:223], a[60:63], a[12:15], v[220:223]
    v_mfma_f32_16x16x32_bf16 v[236:239], a[60:63], a[16:19], v[236:239]
    v_mfma_f32_16x16x32_bf16 v[252:255], a[60:63], a[20:23], v[252:255]
    v_mfma_f32_16x16x32_bf16 a[156:159], a[60:63], a[24:27], a[156:159]
    v_mfma_f32_16x16x32_bf16 a[188:191], a[60:63], a[28:31], a[188:191]
    s_waitcnt vmcnt(0) lgkmcnt(0)
    s_barrier
    v_mfma_f32_16x16x32_bf16 v[64:67], a[96:99], a[64:67], v[64:67]
    s_cmp_ge_u32 s49, 1024
    s_cselect_b32 s18, 0, s18
    s_cselect_b32 s22, 0, s22
    ds_read_b128 a[0:3], v26 offset:32768
    v_mfma_f32_16x16x32_bf16 v[80:83], a[96:99], a[68:71], v[80:83]
    s_add_u32 m0, s48, 0
    ds_read_b64_tr_b16 a[32:33], v28 offset:32768
    v_mfma_f32_16x16x32_bf16 v[96:99], a[96:99], a[72:75], v[96:99]
    buffer_load_dwordx4 v10, s[16:19], s49 offen offset:0 lds
    v_mfma_f32_16x16x32_bf16 v[112:115], a[96:99], a[76:79], v[112:115]
    ds_read_b64_tr_b16 a[34:35], v28 offset:34816
    v_mfma_f32_16x16x32_bf16 v[128:131], a[96:99], a[80:83], v[128:131]
    buffer_load_dwordx4 v11, s[16:19], s49 offen offset:1024 lds
    v_mfma_f32_16x16x32_bf16 v[144:147], a[96:99], a[84:87], v[144:147]
    ds_read_b128 a[4:7], v26 offset:34816
    v_mfma_f32_16x16x32_bf16 a[128:131], a[96:99], a[88:91], a[128:131]
    v_mfma_f32_16x16x32_bf16 a[160:163], a[96:99], a[92:95], a[160:163]
    ds_read_b64_tr_b16 a[36:37], v29 offset:32768
    v_mfma_f32_16x16x32_bf16 v[160:163], a[100:103], a[64:67], v[160:163]
    buffer_load_dwordx4 v12, s[16:19], s49 offen offset:2048 lds
    v_mfma_f32_16x16x32_bf16 v[176:179], a[100:103], a[68:71], v[176:179]
    ds_read_b64_tr_b16 a[38:39], v29 offset:34816
    v_mfma_f32_16x16x32_bf16 v[192:195], a[100:103], a[72:75], v[192:195]
    v_mfma_f32_16x16x32_bf16 v[208:211], a[100:103], a[76:79], v[208:211]
    buffer_load_dwordx4 v13, s[16:19], s49 offen offset:3072 lds
    ds_read_b128 a[8:11], v26 offset:36864
    v_mfma_f32_16x16x32_bf16 v[224:227], a[100:103], a[80:83], v[224:227]
    v_mfma_f32_16x16x32_bf16 v[240:243], a[100:103], a[84:87], v[240:243]
    s_add_u32 m0, s48, 4096
    v_mfma_f32_16x16x32_bf16 a[132:135], a[100:103], a[88:91], a[132:135]
    ds_read_b64_tr_b16 a[40:41], v30 offset:32768
    v_mfma_f32_16x16x32_bf16 a[164:167], a[100:103], a[92:95], a[164:167]
    buffer_load_dwordx4 v14, s[16:19], s49 offen offset:0 lds
    v_mfma_f32_16x16x32_bf16 v[68:71], a[104:107], a[64:67], v[68:71]
    ds_read_b64_tr_b16 a[42:43], v30 offset:34816
    v_mfma_f32_16x16x32_bf16 v[84:87], a[104:107], a[68:71], v[84:87]
    v_mfma_f32_16x16x32_bf16 v[100:103], a[104:107], a[72:75], v[100:103]
    buffer_load_dwordx4 v15, s[16:19], s49 offen offset:1024 lds
    ds_read_b128 a[12:15], v26 offset:38912
    v_mfma_f32_16x16x32_bf16 v[116:119], a[104:107], a[76:79], v[116:119]
    v_mfma_f32_16x16x32_bf16 v[132:135], a[104:107], a[80:83], v[132:135]
    ds_read_b64_tr_b16 a[44:45], v31 offset:32768
    v_mfma_f32_16x16x32_bf16 v[148:151], a[104:107], a[84:87], v[148:151]
    v_mfma_f32_16x16x32_bf16 a[136:139], a[104:107], a[88:91], a[136:139]
    buffer_load_dwordx4 v16, s[16:19], s49 offen offset:2048 lds
    ds_read_b64_tr_b16 a[46:47], v31 offset:34816
    v_mfma_f32_16x16x32_bf16 a[168:171], a[104:107], a[92:95], a[168:171]
    v_mfma_f32_16x16x32_bf16 v[164:167], a[108:111], a[64:67], v[164:167]
    ds_read_b128 a[16:19], v26 offset:40960
    v_mfma_f32_16x16x32_bf16 v[180:183], a[108:111], a[68:71], v[180:183]
    buffer_load_dwordx4 v17, s[16:19], s49 offen offset:3072 lds
    v_mfma_f32_16x16x32_bf16 v[196:199], a[108:111], a[72:75], v[196:199]
    ds_read_b64_tr_b16 a[48:49], v32 offset:32768
    v_mfma_f32_16x16x32_bf16 v[212:215], a[108:111], a[76:79], v[212:215]
    s_add_u32 s49, s49, 128
    v_mfma_f32_16x16x32_bf16 v[228:231], a[108:111], a[80:83], v[228:231]
    s_add_u32 m0, s48, 65536
    ds_read_b64_tr_b16 a[50:51], v32 offset:34816
    v_mfma_f32_16x16x32_bf16 v[244:247], a[108:111], a[84:87], v[244:247]
    buffer_load_dwordx4 v18, s[20:23], s50 offen offset:0 nt lds
    v_mfma_f32_16x16x32_bf16 a[140:143], a[108:111], a[88:91], a[140:143]
    ds_read_b128 a[20:23], v26 offset:43008
    v_mfma_f32_16x16x32_bf16 a[172:175], a[108:111], a[92:95], a[172:175]
    v_mfma_f32_16x16x32_bf16 v[72:75], a[112:115], a[64:67], v[72:75]
    buffer_load_dwordx4 v19, s[20:23], s50 offen offset:1024 nt lds
    ds_read_b64_tr_b16 a[52:53], v33 offset:32768
    v_mfma_f32_16x16x32_bf16 v[88:91], a[112:115], a[68:71], v[88:91]
    v_mfma_f32_16x16x32_bf16 v[104:107], a[112:115], a[72:75], v[104:107]
    ds_read_b64_tr_b16 a[54:55], v33 offset:34816
    v_mfma_f32_16x16x32_bf16 v[120:123], a[112:115], a[76:79], v[120:123]
    buffer_load_dwordx4 v20, s[20:23], s50 offen offset:2048 nt lds
    v_mfma_f32_16x16x32_bf16 v[136:139], a[112:115], a[80:83], v[136:139]
    ds_read_b128 a[24:27], v26 offset:45056
    v_mfma_f32_16x16x32_bf16 v[152:155], a[112:115], a[84:87], v[152:155]
    v_mfma_f32_16x16x32_bf16 a[144:147], a[112:115], a[88:91], a[144:147]
    v_mfma_f32_16x16x32_bf16 a[176:179], a[112:115], a[92:95], a[176:179]
    buffer_load_dwordx4 v21, s[20:23], s50 offen offset:3072 nt lds
    ds_read_b64_tr_b16 a[56:57], v34 offset:32768
    v_mfma_f32_16x16x32_bf16 v[168:171], a[116:119], a[64:67], v[168:171]
    s_add_u32 m0, s48, 69632
    v_mfma_f32_16x16x32_bf16 v[184:187], a[116:119], a[68:71], v[184:187]
    ds_read_b64_tr_b16 a[58:59], v34 offset:34816
    v_mfma_f32_16x16x32_bf16 v[200:203], a[116:119], a[72:75], v[200:203]
    buffer_load_dwordx4 v22, s[20:23], s50 offen offset:0 nt lds
    v_mfma_f32_16x16x32_bf16 v[216:219], a[116:119], a[76:79], v[216:219]
    ds_read_b128 a[28:31], v26 offset:47104
    v_mfma_f32_16x16x32_bf16 v[232:235], a[116:119], a[80:83], v[232:235]
    v_mfma_f32_16x16x32_bf16 v[248:251], a[116:119], a[84:87], v[248:251]
    ds_read_b64_tr_b16 a[60:61], v35 offset:32768
    v_mfma_f32_16x16x32_bf16 a[148:151], a[116:119], a[88:91], a[148:151]
    buffer_load_dwordx4 v23, s[20:23], s50 offen offset:1024 nt lds
    v_mfma_f32_16x16x32_bf16 a[180:183], a[116:119], a[92:95], a[180:183]
    ds_read_b64_tr_b16 a[62:63], v35 offset:34816
    v_mfma_f32_16x16x32_bf16 v[76:79], a[120:123], a[64:67], v[76:79]
    v_mfma_f32_16x16x32_bf16 v[92:95], a[120:123], a[68:71], v[92:95]
    buffer_load_dwordx4 v24, s[20:23], s50 offen offset:2048 nt lds
    v_mfma_f32_16x16x32_bf16 v[108:111], a[120:123], a[72:75], v[108:111]
    v_mfma_f32_16x16x32_bf16 v[124:127], a[120:123], a[76:79], v[124:127]
    v_mfma_f32_16x16x32_bf16 v[140:143], a[120:123], a[80:83], v[140:143]
    v_mfma_f32_16x16x32_bf16 v[156:159], a[120:123], a[84:87], v[156:159]
    buffer_load_dwordx4 v25, s[20:23], s50 offen offset:3072 nt lds
    v_mfma_f32_16x16x32_bf16 a[152:155], a[120:123], a[88:91], a[152:155]
    v_mfma_f32_16x16x32_bf16 a[184:187], a[120:123], a[92:95], a[184:187]
    s_add_u32 s50, s50, 0x80000
    v_mfma_f32_16x16x32_bf16 v[172:175], a[124:127], a[64:67], v[172:175]
    v_mfma_f32_16x16x32_bf16 v[188:191], a[124:127], a[68:71], v[188:191]
    s_cmp_eq_u32 s51, s53
    s_cbranch_scc1 k12_ool_9
k12_oolret_10:
    v_mfma_f32_16x16x32_bf16 v[204:207], a[124:127], a[72:75], v[204:207]
    v_mfma_f32_16x16x32_bf16 v[220:223], a[124:127], a[76:79], v[220:223]
    s_cmp_eq_u32 s51, s63
    s_cbranch_scc1 k12_ool_11
k12_oolret_12:
    v_mfma_f32_16x16x32_bf16 v[236:239], a[124:127], a[80:83], v[236:239]
    v_mfma_f32_16x16x32_bf16 v[252:255], a[124:127], a[84:87], v[252:255]
    s_add_u32 s51, s51, 1
    v_mfma_f32_16x16x32_bf16 a[156:159], a[124:127], a[88:91], a[156:159]
    v_mfma_f32_16x16x32_bf16 a[188:191], a[124:127], a[92:95], a[188:191]
    s_waitcnt lgkmcnt(0)
    v_mfma_f32_16x16x32_bf16 v[64:67], a[32:35], a[0:3], v[64:67]
    ds_read_b128 a[64:67], v27 offset:32768
    v_mfma_f32_16x16x32_bf16 v[80:83], a[32:35], a[4:7], v[80:83]
    ds_read_b64_tr_b16 a[96:97], v28 offset:49152
    v_mfma_f32_16x16x32_bf16 v[96:99], a[32:35], a[8:11], v[96:99]
    v_mfma_f32_16x16x32_bf16 v[112:115], a[32:35], a[12:15], v[112:115]
    ds_read_b64_tr_b16 a[98:99], v28 offset:51200
    v_mfma_f32_16x16x32_bf16 v[128:131], a[32:35], a[16:19], v[128:131]
    v_mfma_f32_16x16x32_bf16 v[144:147], a[32:35], a[20:23], v[144:147]
    ds_read_b128 a[68:71], v27 offset:34816
    v_mfma_f32_16x16x32_bf16 a[128:131], a[32:35], a[24:27], a[128:131]
    v_mfma_f32_16x16x32_bf16 a[160:163], a[32:35], a[28:31], a[160:163]
    ds_read_b64_tr_b16 a[100:101], v29 offset:49152
    v_mfma_f32_16x16x32_bf16 v[160:163], a[36:39], a[0:3], v[160:163]
    v_mfma_f32_16x16x32_bf16 v[176:179], a[36:39], a[4:7], v[176:179]
    ds_read_b64_tr_b16 a[102:103], v29 offset:51200
    v_mfma_f32_16x16x32_bf16 v[192:195], a[36:39], a[8:11], v[192:195]
    v_mfma_f32_16x16x32_bf16 v[208:211], a[36:39], a[12:15], v[208:211]
    ds_read_b128 a[72:75], v27 offset:36864
    v_mfma_f32_16x16x32_bf16 v[224:227], a[36:39], a[16:19], v[224:227]
    v_mfma_f32_16x16x32_bf16 v[240:243], a[36:39], a[20:23], v[240:243]
    v_mfma_f32_16x16x32_bf16 a[132:135], a[36:39], a[24:27], a[132:135]
    ds_read_b64_tr_b16 a[104:105], v30 offset:49152
    v_mfma_f32_16x16x32_bf16 a[164:167], a[36:39], a[28:31], a[164:167]
    v_mfma_f32_16x16x32_bf16 v[68:71], a[40:43], a[0:3], v[68:71]
    ds_read_b64_tr_b16 a[106:107], v30 offset:51200
    v_mfma_f32_16x16x32_bf16 v[84:87], a[40:43], a[4:7], v[84:87]
    v_mfma_f32_16x16x32_bf16 v[100:103], a[40:43], a[8:11], v[100:103]
    ds_read_b128 a[76:79], v27 offset:38912
    v_mfma_f32_16x16x32_bf16 v[116:119], a[40:43], a[12:15], v[116:119]
    v_mfma_f32_16x16x32_bf16 v[132:135], a[40:43], a[16:19], v[132:135]
    ds_read_b64_tr_b16 a[108:109], v31 offset:49152
    v_mfma_f32_16x16x32_bf16 v[148:151], a[40:43], a[20:23], v[148:151]
    v_mfma_f32_16x16x32_bf16 a[136:139], a[40:43], a[24:27], a[136:139]
    ds_read_b64_tr_b16 a[110:111], v31 offset:51200
    v_mfma_f32_16x16x32_bf16 a[168:171], a[40:43], a[28:31], a[168:171]
    v_mfma_f32_16x16x32_bf16 v[164:167], a[44:47], a[0:3], v[164:167]
    ds_read_b128 a[80:83], v27 offset:40960
    v_mfma_f32_16x16x32_bf16 v[180:183], a[44:47], a[4:7], v[180:183]
    v_mfma_f32_16x16x32_bf16 v[196:199], a[44:47], a[8:11], v[196:199]
    ds_read_b64_tr_b16 a[112:113], v32 offset:49152
    v_mfma_f32_16x16x32_bf16 v[212:215], a[44:47], a[12:15], v[212:215]
    v_mfma_f32_16x16x32_bf16 v[228:231], a[44:47], a[16:19], v[228:231]
    ds_read_b64_tr_b16 a[114:115], v32 offset:51200
    v_mfma_f32_16x16x32_bf16 v[244:247], a[44:47], a[20:23], v[244:247]
    v_mfma_f32_16x16x32_bf16 a[140:143], a[44:47], a[24:27], a[140:143]
    ds_read_b128 a[84:87], v27 offset:43008
    v_mfma_f32_16x16x32_bf16 a[172:175], a[44:47], a[28:31], a[172:175]
    v_mfma_f32_16x16x32_bf16 v[72:75], a[48:51], a[0:3], v[72:75]
    ds_read_b64_tr_b16 a[116:117], v33 offset:49152
    v_mfma_f32_16x16x32_bf16 v[88:91], a[48:51], a[4:7], v[88:91]
    v_mfma_f32_16x16x32_bf16 v[104:107], a[48:51], a[8:11], v[104:107]
    ds_read_b64_tr_b16 a[118:119], v33 offset:51200
    v_mfma_f32_16x16x32_bf16 v[120:123], a[48:51], a[12:15], v[120:123]
    v_mfma_f32_16x16x32_bf16 v[136:139], a[48:51], a[16:19], v[136:139]
    ds_read_b128 a[88:91], v27 offset:45056
    v_mfma_f32_16x16x32_bf16 v[152:155], a[48:51], a[20:23], v[152:155]
    v_mfma_f32_16x16x32_bf16 a[144:147], a[48:51], a[24:27], a[144:147]
    v_mfma_f32_16x16x32_bf16 a[176:179], a[48:51], a[28:31], a[176:179]
    ds_read_b64_tr_b16 a[120:121], v34 offset:49152
    v_mfma_f32_16x16x32_bf16 v[168:171], a[52:55], a[0:3], v[168:171]
    v_mfma_f32_16x16x32_bf16 v[184:187], a[52:55], a[4:7], v[184:187]
    ds_read_b64_tr_b16 a[122:123], v34 offset:51200
    v_mfma_f32_16x16x32_bf16 v[200:203], a[52:55], a[8:11], v[200:203]
    v_mfma_f32_16x16x32_bf16 v[216:219], a[52:55], a[12:15], v[216:219]
    ds_read_b128 a[92:95], v27 offset:47104
    v_mfma_f32_16x16x32_bf16 v[232:235], a[52:55], a[16:19], v[232:235]
    v_mfma_f32_16x16x32_bf16 v[248:251], a[52:55], a[20:23], v[248:251]
    ds_read_b64_tr_b16 a[124:125], v35 offset:49152
    v_mfma_f32_16x16x32_bf16 a[148:151], a[52:55], a[24:27], a[148:151]
    v_mfma_f32_16x16x32_bf16 a[180:183], a[52:55], a[28:31], a[180:183]
    ds_read_b64_tr_b16 a[126:127], v35 offset:51200
    v_mfma_f32_16x16x32_bf16 v[76:79], a[56:59], a[0:3], v[76:79]
    v_mfma_f32_16x16x32_bf16 v[92:95], a[56:59], a[4:7], v[92:95]
    v_mfma_f32_16x16x32_bf16 v[108:111], a[56:59], a[8:11], v[108:111]
    v_mfma_f32_16x16x32_bf16 v[124:127], a[56:59], a[12:15], v[124:127]
    v_mfma_f32_16x16x32_bf16 v[140:143], a[56:59], a[16:19], v[140:143]
    v_mfma_f32_16x16x32_bf16 v[156:159], a[56:59], a[20:23], v[156:159]
    v_mfma_f32_16x16x32_bf16 a[152:155], a[56:59], a[24:27], a[152:155]
    v_mfma_f32_16x16x32_bf16 a[184:187], a[56:59], a[28:31], a[184:187]
    s_sub_u32 s52, s51, 1
    s_cmp_eq_u32 s52, s46
    s_cbranch_scc1 k12_ool_15
k12_oolret_16:
    v_mfma_f32_16x16x32_bf16 v[172:175], a[60:63], a[0:3], v[172:175]
    v_mfma_f32_16x16x32_bf16 v[188:191], a[60:63], a[4:7], v[188:191]
    v_mfma_f32_16x16x32_bf16 v[204:207], a[60:63], a[8:11], v[204:207]
    v_mfma_f32_16x16x32_bf16 v[220:223], a[60:63], a[12:15], v[220:223]
    v_mfma_f32_16x16x32_bf16 v[236:239], a[60:63], a[16:19], v[236:239]
    v_mfma_f32_16x16x32_bf16 v[252:255], a[60:63], a[20:23], v[252:255]
    v_mfma_f32_16x16x32_bf16 a[156:159], a[60:63], a[24:27], a[156:159]
    v_mfma_f32_16x16x32_bf16 a[188:191], a[60:63], a[28:31], a[188:191]
    s_waitcnt vmcnt(0) lgkmcnt(0)
    s_barrier
    s_cmp_eq_u32 s51, 7
    s_cbranch_scc1 k12_last_6
    v_mfma_f32_16x16x32_bf16 v[64:67], a[96:99], a[64:67], v[64:67]
    ds_read_b128 a[0:3], v26 offset:0
    v_mfma_f32_16x16x32_bf16 v[80:83], a[96:99], a[68:71], v[80:83]
    s_add_u32 m0, s48, 32768
    ds_read_b64_tr_b16 a[32:33], v28 offset:0
    v_mfma_f32_16x16x32_bf16 v[96:99], a[96:99], a[72:75], v[96:99]
    buffer_load_dwordx4 v10, s[16:19], s49 offen offset:0 lds
    v_mfma_f32_16x16x32_bf16 v[112:115], a[96:99], a[76:79], v[112:115]
    ds_read_b64_tr_b16 a[34:35], v28 offset:2048
    v_mfma_f32_16x16x32_bf16 v[128:131], a[96:99], a[80:83], v[128:131]
    buffer_load_dwordx4 v11, s[16:19], s49 offen offset:1024 lds
    v_mfma_f32_16x16x32_bf16 v[144:147], a[96:99], a[84:87], v[144:147]
    ds_read_b128 a[4:7], v26 offset:2048
    v_mfma_f32_16x16x32_bf16 a[128:131], a[96:99], a[88:91], a[128:131]
    v_mfma_f32_16x16x32_bf16 a[160:163], a[96:99], a[92:95], a[160:163]
    ds_read_b64_tr_b16 a[36:37], v29 offset:0
    v_mfma_f32_16x16x32_bf16 v[160:163], a[100:103], a[64:67], v[160:163]
    buffer_load_dwordx4 v12, s[16:19], s49 offen offset:2048 lds
    v_mfma_f32_16x16x32_bf16 v[176:179], a[100:103], a[68:71], v[176:179]
    ds_read_b64_tr_b16 a[38:39], v29 offset:2048
    v_mfma_f32_16x16x32_bf16 v[192:195], a[100:103], a[72:75], v[192:195]
    v_mfma_f32_16x16x32_bf16 v[208:211], a[100:103], a[76:79], v[208:211]
    buffer_load_dwordx4 v13, s[16:19], s49 offen offset:3072 lds
    ds_read_b128 a[8:11], v26 offset:4096
    v_mfma_f32_16x16x32_bf16 v[224:227], a[100:103], a[80:83], v[224:227]
    v_mfma_f32_16x16x32_bf16 v[240:243], a[100:103], a[84:87], v[240:243]
    s_add_u32 m0, s48, 36864
    v_mfma_f32_16x16x32_bf16 a[132:135], a[100:103], a[88:91], a[132:135]
    ds_read_b64_tr_b16 a[40:41], v30 offset:0
    v_mfma_f32_16x16x32_bf16 a[164:167], a[100:103], a[92:95], a[164:167]
    buffer_load_dwordx4 v14, s[16:19], s49 offen offset:0 lds
    v_mfma_f32_16x16x32_bf16 v[68:71], a[104:107], a[64:67], v[68:71]
    ds_read_b64_tr_b16 a[42:43], v30 offset:2048
    v_mfma_f32_16x16x32_bf16 v[84:87], a[104:107], a[68:71], v[84:87]
    v_mfma_f32_16x16x32_bf16 v[100:103], a[104:107], a[72:75], v[100:103]
    buffer_load_dwordx4 v15, s[16:19], s49 offen offset:1024 lds
    ds_read_b128 a[12:15], v26 offset:6144
    v_mfma_f32_16x16x32_bf16 v[116:119], a[104:107], a[76:79], v[116:119]
    v_mfma_f32_16x16x32_bf16 v[132:135], a[104:107], a[80:83], v[132:135]
    ds_read_b64_tr_b16 a[44:45], v31 offset:0
    v_mfma_f32_16x16x32_bf16 v[148:151], a[104:107], a[84:87], v[148:151]
    v_mfma_f32_16x16x32_bf16 a[136:139], a[104:107], a[88:91], a[136:139]
    buffer_load_dwordx4 v16, s[16:19], s49 offen offset:2048 lds
    ds_read_b64_tr_b16 a[46:47], v31 offset:2048
    v_mfma_f32_16x16x32_bf16 a[168:171], a[104:107], a[92:95], a[168:171]
    v_mfma_f32_16x16x32_bf16 v[164:167], a[108:111], a[64:67], v[164:167]
    ds_read_b128 a[16:19], v26 offset:8192
    v_mfma_f32_16x16x32_bf16 v[180:183], a[108:111], a[68:71], v[180:183]
    buffer_load_dwordx4 v17, s[16:19], s49 offen offset:3072 lds
    v_mfma_f32_16x16x32_bf16 v[196:199], a[108:111], a[72:75], v[196:199]
    ds_read_b64_tr_b16 a[48:49], v32 offset:0
    v_mfma_f32_16x16x32_bf16 v[212:215], a[108:111], a[76:79], v[212:215]
    s_add_u32 s49, s49, 128
    v_mfma_f32_16x16x32_bf16 v[228:231], a[108:111], a[80:83], v[228:231]
    s_add_u32 m0, s48, 98304
    ds_read_b64_tr_b16 a[50:51], v32 offset:2048
    v_mfma_f32_16x16x32_bf16 v[244:247], a[108:111], a[84:87], v[244:247]
    buffer_load_dwordx4 v18, s[20:23], s50 offen offset:0 nt lds
    v_mfma_f32_16x16x32_bf16 a[140:143], a[108:111], a[88:91], a[140:143]
    ds_read_b128 a[20:23], v26 offset:10240
    v_mfma_f32_16x16x32_bf16 a[172:175], a[108:111], a[92:95], a[172:175]
    v_mfma_f32_16x16x32_bf16 v[72:75], a[112:115], a[64:67], v[72:75]
    buffer_load_dwordx4 v19, s[20:23], s50 offen offset:1024 nt lds
    ds_read_b64_tr_b16 a[52:53], v33 offset:0
    v_mfma_f32_16x16x32_bf16 v[88:91], a[112:115], a[68:71], v[88:91]
    v_mfma_f32_16x16x32_bf16 v[104:107], a[112:115], a[72:75], v[104:107]
    ds_read_b64_tr_b16 a[54:55], v33 offset:2048
    v_mfma_f32_16x16x32_bf16 v[120:123], a[112:115], a[76:79], v[120:123]
    buffer_load_dwordx4 v20, s[20:23], s50 offen offset:2048 nt lds
    v_mfma_f32_16x16x32_bf16 v[136:139], a[112:115], a[80:83], v[136:139]
    ds_read_b128 a[24:27], v26 offset:12288
    v_mfma_f32_16x16x32_bf16 v[152:155], a[112:115], a[84:87], v[152:155]
    v_mfma_f32_16x16x32_bf16 a[144:147], a[112:115], a[88:91], a[144:147]
    v_mfma_f32_16x16x32_bf16 a[176:179], a[112:115], a[92:95], a[176:179]
    buffer_load_dwordx4 v21, s[20:23], s50 offen offset:3072 nt lds
    ds_read_b64_tr_b16 a[56:57], v34 offset:0
    v_mfma_f32_16x16x32_bf16 v[168:171], a[116:119], a[64:67], v[168:171]
    s_add_u32 m0, s48, 102400
    v_mfma_f32_16x16x32_bf16 v[184:187], a[116:119], a[68:71], v[184:187]
    ds_read_b64_tr_b16 a[58:59], v34 offset:2048
    v_mfma_f32_16x16x32_bf16 v[200:203], a[116:119], a[72:75], v[200:203]
    buffer_load_dwordx4 v22, s[20:23], s50 offen offset:0 nt lds
    v_mfma_f32_16x16x32_bf16 v[216:219], a[116:119], a[76:79], v[216:219]
    ds_read_b128 a[28:31], v26 offset:14336
    v_mfma_f32_16x16x32_bf16 v[232:235], a[116:119], a[80:83], v[232:235]
    v_mfma_f32_16x16x32_bf16 v[248:251], a[116:119], a[84:87], v[248:251]
    ds_read_b64_tr_b16 a[60:61], v35 offset:0
    v_mfma_f32_16x16x32_bf16 a[148:151], a[116:119], a[88:91], a[148:151]
    buffer_load_dwordx4 v23, s[20:23], s50 offen offset:1024 nt lds
    v_mfma_f32_16x16x32_bf16 a[180:183], a[116:119], a[92:95], a[180:183]
    ds_read_b64_tr_b16 a[62:63], v35 offset:2048
    v_mfma_f32_16x16x32_bf16 v[76:79], a[120:123], a[64:67], v[76:79]
    v_mfma_f32_16x16x32_bf16 v[92:95], a[120:123], a[68:71], v[92:95]
    buffer_load_dwordx4 v24, s[20:23], s50 offen offset:2048 nt lds
    v_mfma_f32_16x16x32_bf16 v[108:111], a[120:123], a[72:75], v[108:111]
    v_mfma_f32_16x16x32_bf16 v[124:127], a[120:123], a[76:79], v[124:127]
    v_mfma_f32_16x16x32_bf16 v[140:143], a[120:123], a[80:83], v[140:143]
    v_mfma_f32_16x16x32_bf16 v[156:159], a[120:123], a[84:87], v[156:159]
    buffer_load_dwordx4 v25, s[20:23], s50 offen offset:3072 nt lds
    v_mfma_f32_16x16x32_bf16 a[152:155], a[120:123], a[88:91], a[152:155]
    v_mfma_f32_16x16x32_bf16 a[184:187], a[120:123], a[92:95], a[184:187]
    s_add_u32 s50, s50, 0x80000
    v_mfma_f32_16x16x32_bf16 v[172:175], a[124:127], a[64:67], v[172:175]
    v_mfma_f32_16x16x32_bf16 v[188:191], a[124:127], a[68:71], v[188:191]
    s_cmp_eq_u32 s51, s53
    s_cbranch_scc1 k12_ool_17
k12_oolret_18:
    v_mfma_f32_16x16x32_bf16 v[204:207], a[124:127], a[72:75], v[204:207]
    v_mfma_f32_16x16x32_bf16 v[220:223], a[124:127], a[76:79], v[220:223]
    v_mfma_f32_16x16x32_bf16 v[236:239], a[124:127], a[80:83], v[236:239]
    v_mfma_f32_16x16x32_bf16 v[252:255], a[124:127], a[84:87], v[252:255]
    s_add_u32 s51, s51, 1
    v_mfma_f32_16x16x32_bf16 a[156:159], a[124:127], a[88:91], a[156:159]
    v_mfma_f32_16x16x32_bf16 a[188:191], a[124:127], a[92:95], a[188:191]
    s_waitcnt lgkmcnt(0)
    s_branch k12_loop_5
k12_last_6:
    v_mfma_f32_16x16x32_bf16 v[64:67], a[96:99], a[64:67], v[64:67]
    s_add_u32 m0, s60, 98304
    v_mfma_f32_16x16x32_bf16 v[160:163], a[100:103], a[64:67], v[160:163]
    buffer_load_dwordx4 v38, s[12:15], s61 offen offset:0 lds
    v_mfma_f32_16x16x32_bf16 v[68:71], a[104:107], a[64:67], v[68:71]
    buffer_load_dwordx4 v39, s[12:15], s61 offen offset:1024 lds
    v_mfma_f32_16x16x32_bf16 v[164:167], a[108:111], a[64:67], v[164:167]
    v_mfma_f32_16x16x32_bf16 v[72:75], a[112:115], a[64:67], v[72:75]
    buffer_load_dwordx4 v40, s[12:15], s61 offen offset:2048 lds
    v_mfma_f32_16x16x32_bf16 v[168:171], a[116:119], a[64:67], v[168:171]
    v_cvt_pk_bf16_f32 v64, v64, v65
    v_cvt_pk_bf16_f32 v65, v66, v67
    v_cvt_pk_bf16_f32 v66, v160, v161
    v_mfma_f32_16x16x32_bf16 v[76:79], a[120:123], a[64:67], v[76:79]
    v_cvt_pk_bf16_f32 v67, v162, v163
    v_mfma_f32_16x16x32_bf16 v[172:175], a[124:127], a[64:67], v[172:175]
    v_cvt_pk_bf16_f32 v68, v68, v69
    v_cvt_pk_bf16_f32 v69, v70, v71
    v_cvt_pk_bf16_f32 v70, v164, v165
    v_mfma_f32_16x16x32_bf16 v[80:83], a[96:99], a[68:71], v[80:83]
    buffer_load_dwordx4 v41, s[12:15], s61 offen offset:3072 lds
    v_mfma_f32_16x16x32_bf16 v[176:179], a[100:103], a[68:71], v[176:179]
    s_add_u32 s61, s61, 0x80000
    v_cvt_pk_bf16_f32 v71, v166, v167
    v_cvt_pk_bf16_f32 v72, v72, v73
    v_cvt_pk_bf16_f32 v73, v74, v75
    v_mfma_f32_16x16x32_bf16 v[84:87], a[104:107], a[68:71], v[84:87]
    buffer_load_dwordx4 a[192:195], v36, s[8:11], s62 offen offset:0 sc1
    buffer_load_dwordx4 a[196:199], v36, s[8:11], s62 offen offset:1024 sc1
    v_mfma_f32_16x16x32_bf16 v[180:183], a[108:111], a[68:71], v[180:183]
    v_cvt_pk_bf16_f32 v74, v168, v169
    v_cvt_pk_bf16_f32 v75, v170, v171
    v_cvt_pk_bf16_f32 v76, v76, v77
    v_mfma_f32_16x16x32_bf16 v[88:91], a[112:115], a[68:71], v[88:91]
    v_cvt_pk_bf16_f32 v77, v78, v79
    v_cvt_pk_bf16_f32 v78, v172, v173
    v_cvt_pk_bf16_f32 v79, v174, v175
    v_mfma_f32_16x16x32_bf16 v[184:187], a[116:119], a[68:71], v[184:187]
    v_cvt_pk_bf16_f32 v80, v80, v81
    v_cvt_pk_bf16_f32 v81, v82, v83
    v_cvt_pk_bf16_f32 v82, v176, v177
    v_mfma_f32_16x16x32_bf16 v[92:95], a[120:123], a[68:71], v[92:95]
    buffer_load_dwordx4 a[200:203], v37, s[8:11], s62 offen offset:0 sc1
    buffer_load_dwordx4 a[204:207], v37, s[8:11], s62 offen offset:1024 sc1
    v_mfma_f32_16x16x32_bf16 v[188:191], a[124:127], a[68:71], v[188:191]
    s_add_u32 s62, s62, 0x20000
    v_cvt_pk_bf16_f32 v83, v178, v179
    v_cvt_pk_bf16_f32 v84, v84, v85
    v_cvt_pk_bf16_f32 v85, v86, v87
    v_mfma_f32_16x16x32_bf16 a[128:131], a[96:99], a[88:91], a[128:131]
    v_cvt_pk_bf16_f32 v86, v180, v181
    v_cvt_pk_bf16_f32 v87, v182, v183
    v_mfma_f32_16x16x32_bf16 a[132:135], a[100:103], a[88:91], a[132:135]
    v_cvt_pk_bf16_f32 v88, v88, v89
    v_cvt_pk_bf16_f32 v89, v90, v91
    v_cvt_pk_bf16_f32 v90, v184, v185
    v_mfma_f32_16x16x32_bf16 v[96:99], a[96:99], a[72:75], v[96:99]
    buffer_load_dwordx4 a[208:211], v36, s[8:11], s62 offen offset:0 sc1
    buffer_load_dwordx4 a[212:215], v36, s[8:11], s62 offen offset:1024 sc1
    v_mfma_f32_16x16x32_bf16 v[192:195], a[100:103], a[72:75], v[192:195]
    v_cvt_pk_bf16_f32 v91, v186, v187
    v_cvt_pk_bf16_f32 v92, v92, v93
    v_cvt_pk_bf16_f32 v93, v94, v95
    v_mfma_f32_16x16x32_bf16 v[100:103], a[104:107], a[72:75], v[100:103]
    v_cvt_pk_bf16_f32 v94, v188, v189
    v_cvt_pk_bf16_f32 v95, v190, v191
    v_mfma_f32_16x16x32_bf16 v[196:199], a[108:111], a[72:75], v[196:199]
    v_accvgpr_read_b32 v56, a128
    v_accvgpr_read_b32 v57, a129
    v_accvgpr_read_b32 v58, a130
    v_mfma_f32_16x16x32_bf16 a[136:139], a[104:107], a[88:91], a[136:139]
    buffer_load_dwordx4 a[216:219], v37, s[8:11], s62 offen offset:0 sc1
    buffer_load_dwordx4 a[220:223], v37, s[8:11], s62 offen offset:1024 sc1
    v_mfma_f32_16x16x32_bf16 a[140:143], a[108:111], a[88:91], a[140:143]
    s_add_u32 s62, s62, 0x20000
    v_accvgpr_read_b32 v59, a131
    v_accvgpr_read_b32 v60, a132
    v_cvt_pk_bf16_f32 v96, v96, v97
    v_mfma_f32_16x16x32_bf16 v[104:107], a[112:115], a[72:75], v[104:107]
    s_add_u32 m0, s60, 114688
    v_accvgpr_read_b32 v61, a133
    v_accvgpr_read_b32 v62, a134
    v_cvt_pk_bf16_f32 v97, v98, v99
    v_mfma_f32_16x16x32_bf16 v[200:203], a[116:119], a[72:75], v[200:203]
    v_accvgpr_read_b32 v63, a135
    v_cvt_pk_bf16_f32 v98, v192, v193
    v_cvt_pk_bf16_f32 v160, v56, v57
    v_mfma_f32_16x16x32_bf16 v[108:111], a[120:123], a[72:75], v[108:111]
    v_cvt_pk_bf16_f32 v99, v194, v195
    v_cvt_pk_bf16_f32 v161, v58, v59
    v_cvt_pk_bf16_f32 v100, v100, v101
    v_mfma_f32_16x16x32_bf16 v[204:207], a[124:127], a[72:75], v[204:207]
    buffer_load_dwordx4 v38, s[12:15], s61 offen offset:0 lds
    buffer_load_dwordx4 v39, s[12:15], s61 offen offset:1024 lds
    v_mfma_f32_16x16x32_bf16 a[144:147], a[112:115], a[88:91], a[144:147]
    v_cvt_pk_bf16_f32 v162, v60, v61
    v_cvt_pk_bf16_f32 v101, v102, v103
    v_cvt_pk_bf16_f32 v163, v62, v63
    v_mfma_f32_16x16x32_bf16 a[148:151], a[116:119], a[88:91], a[148:151]
    v_cvt_pk_bf16_f32 v102, v196, v197
    v_cvt_pk_bf16_f32 v103, v198, v199
    v_accvgpr_read_b32 v56, a136
    v_mfma_f32_16x16x32_bf16 v[112:115], a[96:99], a[76:79], v[112:115]
    v_accvgpr_read_b32 v57, a137
    v_accvgpr_read_b32 v58, a138
    v_accvgpr_read_b32 v59, a139
    v_mfma_f32_16x16x32_bf16 v[208:211], a[100:103], a[76:79], v[208:211]
    v_accvgpr_read_b32 v60, a140
    v_cvt_pk_bf16_f32 v104, v104, v105
    v_accvgpr_read_b32 v61, a141
    v_mfma_f32_16x16x32_bf16 v[116:119], a[104:107], a[76:79], v[116:119]
    buffer_load_dwordx4 v40, s[12:15], s61 offen offset:2048 lds
    buffer_load_dwordx4 v41, s[12:15], s61 offen offset:3072 lds
    v_mfma_f32_16x16x32_bf16 v[212:215], a[108:111], a[76:79], v[212:215]
    s_add_u32 s61, s61, 0x80000
    v_accvgpr_read_b32 v62, a142
    v_cvt_pk_bf16_f32 v105, v106, v107
    v_accvgpr_read_b32 v63, a143
    v_mfma_f32_16x16x32_bf16 a[152:155], a[120:123], a[88:91], a[152:155]
    v_cvt_pk_bf16_f32 v106, v200, v201
    v_cvt_pk_bf16_f32 v164, v56, v57
    v_cvt_pk_bf16_f32 v107, v202, v203
    v_mfma_f32_16x16x32_bf16 a[156:159], a[124:127], a[88:91], a[156:159]
    v_cvt_pk_bf16_f32 v165, v58, v59
    v_cvt_pk_bf16_f32 v108, v108, v109
    v_cvt_pk_bf16_f32 v166, v60, v61
    v_mfma_f32_16x16x32_bf16 v[120:123], a[112:115], a[76:79], v[120:123]
    v_cvt_pk_bf16_f32 v109, v110, v111
    v_cvt_pk_bf16_f32 v167, v62, v63
    v_cvt_pk_bf16_f32 v110, v204, v205
    v_mfma_f32_16x16x32_bf16 v[216:219], a[116:119], a[76:79], v[216:219]
    buffer_load_dwordx4 a[224:227], v36, s[8:11], s62 offen offset:0 sc1
    v_cvt_pk_bf16_f32 v111, v206, v207
    v_accvgpr_read_b32 v56, a144
    v_mfma_f32_16x16x32_bf16 v[124:127], a[120:123], a[76:79], v[124:127]
    v_accvgpr_read_b32 v57, a145
    v_accvgpr_read_b32 v58, a146
    v_accvgpr_read_b32 v59, a147
    v_mfma_f32_16x16x32_bf16 v[220:223], a[124:127], a[76:79], v[220:223]
    buffer_load_dwordx4 a[228:231], v36, s[8:11], s62 offen offset:1024 sc1
    v_accvgpr_read_b32 v60, a148
    v_cvt_pk_bf16_f32 v112, v112, v113
    v_mfma_f32_16x16x32_bf16 a[160:163], a[96:99], a[92:95], a[160:163]
    v_accvgpr_read_b32 v61, a149
    v_accvgpr_read_b32 v62, a150
    v_cvt_pk_bf16_f32 v113, v114, v115
    v_mfma_f32_16x16x32_bf16 a[164:167], a[100:103], a[92:95], a[164:167]
    v_accvgpr_read_b32 v63, a151
    v_cvt_pk_bf16_f32 v114, v208, v209
    v_cvt_pk_bf16_f32 v168, v56, v57
    v_mfma_f32_16x16x32_bf16 v[128:131], a[96:99], a[80:83], v[128:131]
    v_cvt_pk_bf16_f32 v115, v210, v211
    v_cvt_pk_bf16_f32 v169, v58, v59
    v_cvt_pk_bf16_f32 v116, v116, v117
    v_mfma_f32_16x16x32_bf16 v[224:227], a[100:103], a[80:83], v[224:227]
    buffer_load_dwordx4 a[232:235], v37, s[8:11], s62 offen offset:0 sc1
    v_cvt_pk_bf16_f32 v170, v60, v61
    v_cvt_pk_bf16_f32 v117, v118, v119
    v_mfma_f32_16x16x32_bf16 v[132:135], a[104:107], a[80:83], v[132:135]
    v_cvt_pk_bf16_f32 v171, v62, v63
    v_cvt_pk_bf16_f32 v118, v212, v213
    v_cvt_pk_bf16_f32 v119, v214, v215
    v_mfma_f32_16x16x32_bf16 v[228:231], a[108:111], a[80:83], v[228:231]
    buffer_load_dwordx4 a[236:239], v37, s[8:11], s62 offen offset:1024 sc1
    v_accvgpr_read_b32 v56, a152
    v_accvgpr_read_b32 v57, a153
    v_mfma_f32_16x16x32_bf16 a[168:171], a[104:107], a[92:95], a[168:171]
    s_add_u32 s62, s62, 0x20000
    v_accvgpr_read_b32 v58, a154
    v_accvgpr_read_b32 v59, a155
    v_accvgpr_read_b32 v60, a156
    v_mfma_f32_16x16x32_bf16 a[172:175], a[108:111], a[92:95], a[172:175]
    s_waitcnt vmcnt(16)
    s_barrier
    v_cvt_pk_bf16_f32 v120, v120, v121
    v_accvgpr_read_b32 v61, a157
    v_accvgpr_read_b32 v62, a158
    v_mfma_f32_16x16x32_bf16 v[136:139], a[112:115], a[80:83], v[136:139]
    v_cvt_pk_bf16_f32 v121, v122, v123
    v_accvgpr_read_b32 v63, a159
    v_cvt_pk_bf16_f32 v122, v216, v217
    v_mfma_f32_16x16x32_bf16 v[232:235], a[116:119], a[80:83], v[232:235]
    v_cvt_pk_bf16_f32 v172, v56, v57
    v_cvt_pk_bf16_f32 v123, v218, v219
    v_cvt_pk_bf16_f32 v173, v58, v59
    v_mfma_f32_16x16x32_bf16 v[140:143], a[120:123], a[80:83], v[140:143]
    v_cvt_pk_bf16_f32 v124, v124, v125
    v_cvt_pk_bf16_f32 v174, v60, v61
    v_cvt_pk_bf16_f32 v125, v126, v127
    v_mfma_f32_16x16x32_bf16 v[236:239], a[124:127], a[80:83], v[236:239]
    v_cvt_pk_bf16_f32 v175, v62, v63
    v_cvt_pk_bf16_f32 v126, v220, v221
    v_cvt_pk_bf16_f32 v127, v222, v223
    v_mfma_f32_16x16x32_bf16 a[176:179], a[112:115], a[92:95], a[176:179]
    ds_read_b64_tr_b16 a[0:1], v42 offset:0
    v_accvgpr_read_b32 v56, a160
    v_accvgpr_read_b32 v57, a161
    v_mfma_f32_16x16x32_bf16 a[180:183], a[116:119], a[92:95], a[180:183]
    ds_read_b64_tr_b16 a[2:3], v42 offset:1024
    v_accvgpr_read_b32 v58, a162
    v_accvgpr_read_b32 v59, a163
    v_mfma_f32_16x16x32_bf16 v[144:147], a[96:99], a[84:87], v[144:147]
    ds_read_b64_tr_b16 a[4:5], v43 offset:0
    v_accvgpr_read_b32 v60, a164
    v_cvt_pk_bf16_f32 v128, v128, v129
    v_mfma_f32_16x16x32_bf16 v[240:243], a[100:103], a[84:87], v[240:243]
    v_accvgpr_read_b32 v61, a165
    v_accvgpr_read_b32 v62, a166
    v_cvt_pk_bf16_f32 v129, v130, v131
    v_mfma_f32_16x16x32_bf16 v[148:151], a[104:107], a[84:87], v[148:151]
    ds_read_b64_tr_b16 a[6:7], v43 offset:1024
    v_accvgpr_read_b32 v63, a167
    v_cvt_pk_bf16_f32 v130, v224, v225
    v_mfma_f32_16x16x32_bf16 v[244:247], a[108:111], a[84:87], v[244:247]
    v_cvt_pk_bf16_f32 v176, v56, v57
    v_cvt_pk_bf16_f32 v131, v226, v227
    v_cvt_pk_bf16_f32 v177, v58, v59
    v_mfma_f32_16x16x32_bf16 a[184:187], a[120:123], a[92:95], a[184:187]
    ds_read_b64_tr_b16 a[8:9], v44 offset:0
    v_cvt_pk_bf16_f32 v132, v132, v133
    v_cvt_pk_bf16_f32 v178, v60, v61
    v_mfma_f32_16x16x32_bf16 a[188:191], a[124:127], a[92:95], a[188:191]
    ds_read_b64_tr_b16 a[10:11], v44 offset:1024
    v_cvt_pk_bf16_f32 v133, v134, v135
    v_cvt_pk_bf16_f32 v179, v62, v63
    v_mfma_f32_16x16x32_bf16 v[152:155], a[112:115], a[84:87], v[152:155]
    ds_read_b64_tr_b16 a[12:13], v45 offset:0
    v_cvt_pk_bf16_f32 v134, v228, v229
    v_cvt_pk_bf16_f32 v135, v230, v231
    v_mfma_f32_16x16x32_bf16 v[248:251], a[116:119], a[84:87], v[248:251]
    ds_read_b64_tr_b16 a[14:15], v45 offset:1024
    v_accvgpr_read_b32 v56, a168
    v_accvgpr_read_b32 v57, a169
    v_mfma_f32_16x16x32_bf16 v[156:159], a[120:123], a[84:87], v[156:159]
    ds_read_b64_tr_b16 a[16:17], v46 offset:0
    v_accvgpr_read_b32 v58, a170
    v_accvgpr_read_b32 v59, a171
    v_mfma_f32_16x16x32_bf16 v[252:255], a[124:127], a[84:87], v[252:255]
    v_accvgpr_read_b32 v60, a172
    v_cvt_pk_bf16_f32 v136, v136, v137
    v_accvgpr_read_b32 v61, a173
    ds_read_b64_tr_b16 a[18:19], v46 offset:1024
    v_accvgpr_read_b32 v62, a174
    v_cvt_pk_bf16_f32 v137, v138, v139
    v_accvgpr_read_b32 v63, a175
    v_cvt_pk_bf16_f32 v138, v232, v233
    v_cvt_pk_bf16_f32 v180, v56, v57
    ds_read_b64_tr_b16 a[20:21], v47 offset:0
    v_cvt_pk_bf16_f32 v139, v234, v235
    v_cvt_pk_bf16_f32 v181, v58, v59
    v_cvt_pk_bf16_f32 v140, v140, v141
    v_cvt_pk_bf16_f32 v182, v60, v61
    ds_read_b64_tr_b16 a[22:23], v47 offset:1024
    v_cvt_pk_bf16_f32 v141, v142, v143
    v_cvt_pk_bf16_f32 v183, v62, v63
    v_cvt_pk_bf16_f32 v142, v236, v237
    ds_read_b64_tr_b16 a[24:25], v48 offset:0
    v_cvt_pk_bf16_f32 v143, v238, v239
    v_accvgpr_read_b32 v56, a176
    ds_read_b64_tr_b16 a[26:27], v48 offset:1024
    v_accvgpr_read_b32 v57, a177
    v_accvgpr_read_b32 v58, a178
    ds_read_b64_tr_b16 a[28:29], v49 offset:0
    v_accvgpr_read_b32 v59, a179
    v_accvgpr_read_b32 v60, a180
    v_cvt_pk_bf16_f32 v144, v144, v145
    ds_read_b64_tr_b16 a[30:31], v49 offset:1024
    v_accvgpr_read_b32 v61, a181
    v_accvgpr_read_b32 v62, a182
    v_cvt_pk_bf16_f32 v145, v146, v147
    v_accvgpr_read_b32 v63, a183
    v_cvt_pk_bf16_f32 v146, v240, v241
    v_cvt_pk_bf16_f32 v184, v56, v57
    v_cvt_pk_bf16_f32 v147, v242, v243
    v_cvt_pk_bf16_f32 v185, v58, v59
    v_cvt_pk_bf16_f32 v148, v148, v149
    v_cvt_pk_bf16_f32 v186, v60, v61
    v_cvt_pk_bf16_f32 v149, v150, v151
    v_cvt_pk_bf16_f32 v187, v62, v63
    v_cvt_pk_bf16_f32 v150, v244, v245
    v_cvt_pk_bf16_f32 v151, v246, v247
    v_accvgpr_read_b32 v56, a184
    v_accvgpr_read_b32 v57, a185
    v_accvgpr_read_b32 v58, a186
    v_accvgpr_read_b32 v59, a187
    v_accvgpr_read_b32 v60, a188
    v_cvt_pk_bf16_f32 v152, v152, v153
    v_accvgpr_read_b32 v61, a189
    v_accvgpr_read_b32 v62, a190
    v_cvt_pk_bf16_f32 v153, v154, v155
    v_accvgpr_read_b32 v63, a191
    v_cvt_pk_bf16_f32 v154, v248, v249
    v_cvt_pk_bf16_f32 v188, v56, v57
    v_cvt_pk_bf16_f32 v155, v250, v251
    v_cvt_pk_bf16_f32 v189, v58, v59
    v_cvt_pk_bf16_f32 v156, v156, v157
    v_cvt_pk_bf16_f32 v190, v60, v61
    v_cvt_pk_bf16_f32 v157, v158, v159
    v_cvt_pk_bf16_f32 v191, v62, v63
    v_cvt_pk_bf16_f32 v158, v252, v253
    v_cvt_pk_bf16_f32 v159, v254, v255
    s_branch k12_join_4
k12_v_3:
k12_loop_19:
    v_mfma_f32_16x16x32_bf16 v[64:67], a[0:3], a[32:35], v[64:67]
    ds_read_b128 a[64:67], v27 offset:0
    v_mfma_f32_16x16x32_bf16 v[68:71], a[0:3], a[36:39], v[68:71]
    ds_read_b64_tr_b16 a[96:97], v28 offset:16384
    v_mfma_f32_16x16x32_bf16 v[72:75], a[0:3], a[40:43], v[72:75]
    v_mfma_f32_16x16x32_bf16 v[76:79], a[0:3], a[44:47], v[76:79]
    s_cmp_eq_u32 s51, s46
    s_cbranch_scc1 k12_ool_21
k12_oolret_22:
    v_mfma_f32_16x16x32_bf16 v[80:83], a[0:3], a[48:51], v[80:83]
    ds_read_b64_tr_b16 a[98:99], v28 offset:18432
    v_mfma_f32_16x16x32_bf16 v[84:87], a[0:3], a[52:55], v[84:87]
    ds_read_b128 a[68:71], v27 offset:2048
    v_mfma_f32_16x16x32_bf16 v[88:91], a[0:3], a[56:59], v[88:91]
    v_mfma_f32_16x16x32_bf16 v[92:95], a[0:3], a[60:63], v[92:95]
    ds_read_b64_tr_b16 a[100:101], v29 offset:16384
    v_mfma_f32_16x16x32_bf16 v[160:163], a[4:7], a[32:35], v[160:163]
    v_mfma_f32_16x16x32_bf16 v[164:167], a[4:7], a[36:39], v[164:167]
    ds_read_b64_tr_b16 a[102:103], v29 offset:18432
    v_mfma_f32_16x16x32_bf16 v[168:171], a[4:7], a[40:43], v[168:171]
    v_mfma_f32_16x16x32_bf16 v[172:175], a[4:7], a[44:47], v[172:175]
    ds_read_b128 a[72:75], v27 offset:4096
    v_mfma_f32_16x16x32_bf16 v[176:179], a[4:7], a[48:51], v[176:179]
    v_mfma_f32_16x16x32_bf16 v[180:183], a[4:7], a[52:55], v[180:183]
    v_mfma_f32_16x16x32_bf16 v[184:187], a[4:7], a[56:59], v[184:187]
    ds_read_b64_tr_b16 a[104:105], v30 offset:16384
    v_mfma_f32_16x16x32_bf16 v[188:191], a[4:7], a[60:63], v[188:191]
    v_mfma_f32_16x16x32_bf16 v[96:99], a[8:11], a[32:35], v[96:99]
    ds_read_b64_tr_b16 a[106:107], v30 offset:18432
    v_mfma_f32_16x16x32_bf16 v[100:103], a[8:11], a[36:39], v[100:103]
    v_mfma_f32_16x16x32_bf16 v[104:107], a[8:11], a[40:43], v[104:107]
    ds_read_b128 a[76:79], v27 offset:6144
    v_mfma_f32_16x16x32_bf16 v[108:111], a[8:11], a[44:47], v[108:111]
    v_mfma_f32_16x16x32_bf16 v[112:115], a[8:11], a[48:51], v[112:115]
    ds_read_b64_tr_b16 a[108:109], v31 offset:16384
    v_mfma_f32_16x16x32_bf16 v[116:119], a[8:11], a[52:55], v[116:119]
    v_mfma_f32_16x16x32_bf16 v[120:123], a[8:11], a[56:59], v[120:123]
    ds_read_b64_tr_b16 a[110:111], v31 offset:18432
    v_mfma_f32_16x16x32_bf16 v[124:127], a[8:11], a[60:63], v[124:127]
    v_mfma_f32_16x16x32_bf16 v[192:195], a[12:15], a[32:35], v[192:195]
    ds_read_b128 a[80:83], v27 offset:8192
    v_mfma_f32_16x16x32_bf16 v[196:199], a[12:15], a[36:39], v[196:199]
    v_mfma_f32_16x16x32_bf16 v[200:203], a[12:15], a[40:43], v[200:203]
    ds_read_b64_tr_b16 a[112:113], v32 offset:16384
    v_mfma_f32_16x16x32_bf16 v[204:207], a[12:15], a[44:47], v[204:207]
    v_mfma_f32_16x16x32_bf16 v[208:211], a[12:15], a[48:51], v[208:211]
    ds_read_b64_tr_b16 a[114:115], v32 offset:18432
    v_mfma_f32_16x16x32_bf16 v[212:215], a[12:15], a[52:55], v[212:215]
    v_mfma_f32_16x16x32_bf16 v[216:219], a[12:15], a[56:59], v[216:219]
    ds_read_b128 a[84:87], v27 offset:10240
    v_mfma_f32_16x16x32_bf16 v[220:223], a[12:15], a[60:63], v[220:223]
    v_mfma_f32_16x16x32_bf16 v[128:131], a[16:19], a[32:35], v[128:131]
    ds_read_b64_tr_b16 a[116:117], v33 offset:16384
    v_mfma_f32_16x16x32_bf16 v[132:135], a[16:19], a[36:39], v[132:135]
    v_mfma_f32_16x16x32_bf16 v[136:139], a[16:19], a[40:43], v[136:139]
    ds_read_b64_tr_b16 a[118:119], v33 offset:18432
    v_mfma_f32_16x16x32_bf16 v[140:143], a[16:19], a[44:47], v[140:143]
    v_mfma_f32_16x16x32_bf16 v[144:147], a[16:19], a[48:51], v[144:147]
    ds_read_b128 a[88:91], v27 offset:12288
    v_mfma_f32_16x16x32_bf16 v[148:151], a[16:19], a[52:55], v[148:151]
    v_mfma_f32_16x16x32_bf16 v[152:155], a[16:19], a[56:59], v[152:155]
    v_mfma_f32_16x16x32_bf16 v[156:159], a[16:19], a[60:63], v[156:159]
    ds_read_b64_tr_b16 a[120:121], v34 offset:16384
    v_mfma_f32_16x16x32_bf16 v[224:227], a[20:23], a[32:35], v[224:227]
    v_mfma_f32_16x16x32_bf16 v[228:231], a[20:23], a[36:39], v[228:231]
    ds_read_b64_tr_b16 a[122:123], v34 offset:18432
    v_mfma_f32_16x16x32_bf16 v[232:235], a[20:23], a[40:43], v[232:235]
    v_mfma_f32_16x16x32_bf16 v[236:239], a[20:23], a[44:47], v[236:239]
    ds_read_b128 a[92:95], v27 offset:14336
    v_mfma_f32_16x16x32_bf16 v[240:243], a[20:23], a[48:51], v[240:243]
    v_mfma_f32_16x16x32_bf16 v[244:247], a[20:23], a[52:55], v[244:247]
    ds_read_b64_tr_b16 a[124:125], v35 offset:16384
    v_mfma_f32_16x16x32_bf16 v[248:251], a[20:23], a[56:59], v[248:251]
    v_mfma_f32_16x16x32_bf16 v[252:255], a[20:23], a[60:63], v[252:255]
    ds_read_b64_tr_b16 a[126:127], v35 offset:18432
    v_mfma_f32_16x16x32_bf16 a[128:131], a[24:27], a[32:35], a[128:131]
    v_mfma_f32_16x16x32_bf16 a[136:139], a[24:27], a[36:39], a[136:139]
    v_mfma_f32_16x16x32_bf16 a[144:147], a[24:27], a[40:43], a[144:147]
    v_mfma_f32_16x16x32_bf16 a[152:155], a[24:27], a[44:47], a[152:155]
    v_mfma_f32_16x16x32_bf16 a[160:163], a[24:27], a[48:51], a[160:163]
    v_mfma_f32_16x16x32_bf16 a[168:171], a[24:27], a[52:55], a[168:171]
    v_mfma_f32_16x16x32_bf16 a[176:179], a[24:27], a[56:59], a[176:179]
    v_mfma_f32_16x16x32_bf16 a[184:187], a[24:27], a[60:63], a[184:187]
    v_mfma_f32_16x16x32_bf16 a[132:135], a[28:31], a[32:35], a[132:135]
    v_mfma_f32_16x16x32_bf16 a[140:143], a[28:31], a[36:39], a[140:143]
    v_mfma_f32_16x16x32_bf16 a[148:151], a[28:31], a[40:43], a[148:151]
    v_mfma_f32_16x16x32_bf16 a[156:159], a[28:31], a[44:47], a[156:159]
    v_mfma_f32_16x16x32_bf16 a[164:167], a[28:31], a[48:51], a[164:167]
    v_mfma_f32_16x16x32_bf16 a[172:175], a[28:31], a[52:55], a[172:175]
    v_mfma_f32_16x16x32_bf16 a[180:183], a[28:31], a[56:59], a[180:183]
    v_mfma_f32_16x16x32_bf16 a[188:191], a[28:31], a[60:63], a[188:191]
    s_waitcnt vmcnt(0) lgkmcnt(0)
    s_barrier
    v_mfma_f32_16x16x32_bf16 v[64:67], a[64:67], a[96:99], v[64:67]
    s_cmp_ge_u32 s49, 1024
    s_cselect_b32 s18, 0, s18
    s_cselect_b32 s22, 0, s22
    ds_read_b128 a[0:3], v26 offset:32768
    v_mfma_f32_16x16x32_bf16 v[68:71], a[64:67], a[100:103], v[68:71]
    s_add_u32 m0, s48, 0
    ds_read_b64_tr_b16 a[32:33], v28 offset:32768
    v_mfma_f32_16x16x32_bf16 v[72:75], a[64:67], a[104:107], v[72:75]
    buffer_load_dwordx4 v10, s[16:19], s49 offen offset:0 lds
    v_mfma_f32_16x16x32_bf16 v[76:79], a[64:67], a[108:111], v[76:79]
    ds_read_b64_tr_b16 a[34:35], v28 offset:34816
    v_mfma_f32_16x16x32_bf16 v[80:83], a[64:67], a[112:115], v[80:83]
    buffer_load_dwordx4 v11, s[16:19], s49 offen offset:1024 lds
    v_mfma_f32_16x16x32_bf16 v[84:87], a[64:67], a[116:119], v[84:87]
    ds_read_b128 a[4:7], v26 offset:34816
    v_mfma_f32_16x16x32_bf16 v[88:91], a[64:67], a[120:123], v[88:91]
    v_mfma_f32_16x16x32_bf16 v[92:95], a[64:67], a[124:127], v[92:95]
    ds_read_b64_tr_b16 a[36:37], v29 offset:32768
    v_mfma_f32_16x16x32_bf16 v[160:163], a[68:71], a[96:99], v[160:163]
    buffer_load_dwordx4 v12, s[16:19], s49 offen offset:2048 lds
    v_mfma_f32_16x16x32_bf16 v[164:167], a[68:71], a[100:103], v[164:167]
    ds_read_b64_tr_b16 a[38:39], v29 offset:34816
    v_mfma_f32_16x16x32_bf16 v[168:171], a[68:71], a[104:107], v[168:171]
    v_mfma_f32_16x16x32_bf16 v[172:175], a[68:71], a[108:111], v[172:175]
    buffer_load_dwordx4 v13, s[16:19], s49 offen offset:3072 lds
    ds_read_b128 a[8:11], v26 offset:36864
    v_mfma_f32_16x16x32_bf16 v[176:179], a[68:71], a[112:115], v[176:179]
    v_mfma_f32_16x16x32_bf16 v[180:183], a[68:71], a[116:119], v[180:183]
    s_add_u32 m0, s48, 4096
    v_mfma_f32_16x16x32_bf16 v[184:187], a[68:71], a[120:123], v[184:187]
    ds_read_b64_tr_b16 a[40:41], v30 offset:32768
    v_mfma_f32_16x16x32_bf16 v[188:191], a[68:71], a[124:127], v[188:191]
    buffer_load_dwordx4 v14, s[16:19], s49 offen offset:0 lds
    v_mfma_f32_16x16x32_bf16 v[96:99], a[72:75], a[96:99], v[96:99]
    ds_read_b64_tr_b16 a[42:43], v30 offset:34816
    v_mfma_f32_16x16x32_bf16 v[100:103], a[72:75], a[100:103], v[100:103]
    v_mfma_f32_16x16x32_bf16 v[104:107], a[72:75], a[104:107], v[104:107]
    buffer_load_dwordx4 v15, s[16:19], s49 offen offset:1024 lds
    ds_read_b128 a[12:15], v26 offset:38912
    v_mfma_f32_16x16x32_bf16 v[108:111], a[72:75], a[108:111], v[108:111]
    v_mfma_f32_16x16x32_bf16 v[112:115], a[72:75], a[112:115], v[112:115]
    ds_read_b64_tr_b16 a[44:45], v31 offset:32768
    v_mfma_f32_16x16x32_bf16 v[116:119], a[72:75], a[116:119], v[116:119]
    v_mfma_f32_16x16x32_bf16 v[120:123], a[72:75], a[120:123], v[120:123]
    buffer_load_dwordx4 v16, s[16:19], s49 offen offset:2048 lds
    ds_read_b64_tr_b16 a[46:47], v31 offset:34816
    v_mfma_f32_16x16x32_bf16 v[124:127], a[72:75], a[124:127], v[124:127]
    v_mfma_f32_16x16x32_bf16 v[192:195], a[76:79], a[96:99], v[192:195]
    ds_read_b128 a[16:19], v26 offset:40960
    v_mfma_f32_16x16x32_bf16 v[196:199], a[76:79], a[100:103], v[196:199]
    buffer_load_dwordx4 v17, s[16:19], s49 offen offset:3072 lds
    v_mfma_f32_16x16x32_bf16 v[200:203], a[76:79], a[104:107], v[200:203]
    ds_read_b64_tr_b16 a[48:49], v32 offset:32768
    v_mfma_f32_16x16x32_bf16 v[204:207], a[76:79], a[108:111], v[204:207]
    s_add_u32 s49, s49, 128
    v_mfma_f32_16x16x32_bf16 v[208:211], a[76:79], a[112:115], v[208:211]
    s_add_u32 m0, s48, 65536
    ds_read_b64_tr_b16 a[50:51], v32 offset:34816
    v_mfma_f32_16x16x32_bf16 v[212:215], a[76:79], a[116:119], v[212:215]
    buffer_load_dwordx4 v18, s[20:23], s50 offen offset:0 nt lds
    v_mfma_f32_16x16x32_bf16 v[216:219], a[76:79], a[120:123], v[216:219]
    ds_read_b128 a[20:23], v26 offset:43008
    v_mfma_f32_16x16x32_bf16 v[220:223], a[76:79], a[124:127], v[220:223]
    v_mfma_f32_16x16x32_bf16 v[128:131], a[80:83], a[96:99], v[128:131]
    buffer_load_dwordx4 v19, s[20:23], s50 offen offset:1024 nt lds
    ds_read_b64_tr_b16 a[52:53], v33 offset:32768
    v_mfma_f32_16x16x32_bf16 v[132:135], a[80:83], a[100:103], v[132:135]
    v_mfma_f32_16x16x32_bf16 v[136:139], a[80:83], a[104:107], v[136:139]
    ds_read_b64_tr_b16 a[54:55], v33 offset:34816
    v_mfma_f32_16x16x32_bf16 v[140:143], a[80:83], a[108:111], v[140:143]
    buffer_load_dwordx4 v20, s[20:23], s50 offen offset:2048 nt lds
    v_mfma_f32_16x16x32_bf16 v[144:147], a[80:83], a[112:115], v[144:147]
    ds_read_b128 a[24:27], v26 offset:45056
    v_mfma_f32_16x16x32_bf16 v[148:151], a[80:83], a[116:119], v[148:151]
    v_mfma_f32_16x16x32_bf16 v[152:155], a[80:83], a[120:123], v[152:155]
    v_mfma_f32_16x16x32_bf16 v[156:159], a[80:83], a[124:127], v[156:159]
    buffer_load_dwordx4 v21, s[20:23], s50 offen offset:3072 nt lds
    ds_read_b64_tr_b16 a[56:57], v34 offset:32768
    v_mfma_f32_16x16x32_bf16 v[224:227], a[84:87], a[96:99], v[224:227]
    s_add_u32 m0, s48, 69632
    v_mfma_f32_16x16x32_bf16 v[228:231], a[84:87], a[100:103], v[228:231]
    ds_read_b64_tr_b16 a[58:59], v34 offset:34816
    v_mfma_f32_16x16x32_bf16 v[232:235], a[84:87], a[104:107], v[232:235]
    buffer_load_dwordx4 v22, s[20:23], s50 offen offset:0 nt lds
    v_mfma_f32_16x16x32_bf16 v[236:239], a[84:87], a[108:111], v[236:239]
    ds_read_b128 a[28:31], v26 offset:47104
    v_mfma_f32_16x16x32_bf16 v[240:243], a[84:87], a[112:115], v[240:243]
    v_mfma_f32_16x16x32_bf16 v[244:247], a[84:87], a[116:119], v[244:247]
    ds_read_b64_tr_b16 a[60:61], v35 offset:32768
    v_mfma_f32_16x16x32_bf16 v[248:251], a[84:87], a[120:123], v[248:251]
    buffer_load_dwordx4 v23, s[20:23], s50 offen offset:1024 nt lds
    v_mfma_f32_16x16x32_bf16 v[252:255], a[84:87], a[124:127], v[252:255]
    ds_read_b64_tr_b16 a[62:63], v35 offset:34816
    v_mfma_f32_16x16x32_bf16 a[128:131], a[88:91], a[96:99], a[128:131]
    v_mfma_f32_16x16x32_bf16 a[136:139], a[88:91], a[100:103], a[136:139]
    buffer_load_dwordx4 v24, s[20:23], s50 offen offset:2048 nt lds
    v_mfma_f32_16x16x32_bf16 a[144:147], a[88:91], a[104:107], a[144:147]
    v_mfma_f32_16x16x32_bf16 a[152:155], a[88:91], a[108:111], a[152:155]
    v_mfma_f32_16x16x32_bf16 a[160:163], a[88:91], a[112:115], a[160:163]
    v_mfma_f32_16x16x32_bf16 a[168:171], a[88:91], a[116:119], a[168:171]
    buffer_load_dwordx4 v25, s[20:23], s50 offen offset:3072 nt lds
    v_mfma_f32_16x16x32_bf16 a[176:179], a[88:91], a[120:123], a[176:179]
    v_mfma_f32_16x16x32_bf16 a[184:187], a[88:91], a[124:127], a[184:187]
    s_add_u32 s50, s50, 0x80000
    v_mfma_f32_16x16x32_bf16 a[132:135], a[92:95], a[96:99], a[132:135]
    v_mfma_f32_16x16x32_bf16 a[140:143], a[92:95], a[100:103], a[140:143]
    s_cmp_eq_u32 s51, s53
    s_cbranch_scc1 k12_ool_23
k12_oolret_24:
    v_mfma_f32_16x16x32_bf16 a[148:151], a[92:95], a[104:107], a[148:151]
    v_mfma_f32_16x16x32_bf16 a[156:159], a[92:95], a[108:111], a[156:159]
    s_cmp_eq_u32 s51, s63
    s_cbranch_scc1 k12_ool_25
k12_oolret_26:
    v_mfma_f32_16x16x32_bf16 a[164:167], a[92:95], a[112:115], a[164:167]
    v_mfma_f32_16x16x32_bf16 a[172:175], a[92:95], a[116:119], a[172:175]
    s_add_u32 s51, s51, 1
    v_mfma_f32_16x16x32_bf16 a[180:183], a[92:95], a[120:123], a[180:183]
    v_mfma_f32_16x16x32_bf16 a[188:191], a[92:95], a[124:127], a[188:191]
    s_waitcnt lgkmcnt(0)
    v_mfma_f32_16x16x32_bf16 v[64:67], a[0:3], a[32:35], v[64:67]
    ds_read_b128 a[64:67], v27 offset:32768
    v_mfma_f32_16x16x32_bf16 v[68:71], a[0:3], a[36:39], v[68:71]
    ds_read_b64_tr_b16 a[96:97], v28 offset:49152
    v_mfma_f32_16x16x32_bf16 v[72:75], a[0:3], a[40:43], v[72:75]
    v_mfma_f32_16x16x32_bf16 v[76:79], a[0:3], a[44:47], v[76:79]
    ds_read_b64_tr_b16 a[98:99], v28 offset:51200
    v_mfma_f32_16x16x32_bf16 v[80:83], a[0:3], a[48:51], v[80:83]
    v_mfma_f32_16x16x32_bf16 v[84:87], a[0:3], a[52:55], v[84:87]
    ds_read_b128 a[68:71], v27 offset:34816
    v_mfma_f32_16x16x32_bf16 v[88:91], a[0:3], a[56:59], v[88:91]
    v_mfma_f32_16x16x32_bf16 v[92:95], a[0:3], a[60:63], v[92:95]
    ds_read_b64_tr_b16 a[100:101], v29 offset:49152
    v_mfma_f32_16x16x32_bf16 v[160:163], a[4:7], a[32:35], v[160:163]
    v_mfma_f32_16x16x32_bf16 v[164:167], a[4:7], a[36:39], v[164:167]
    ds_read_b64_tr_b16 a[102:103], v29 offset:51200
    v_mfma_f32_16x16x32_bf16 v[168:171], a[4:7], a[40:43], v[168:171]
    v_mfma_f32_16x16x32_bf16 v[172:175], a[4:7], a[44:47], v[172:175]
    ds_read_b128 a[72:75], v27 offset:36864
    v_mfma_f32_16x16x32_bf16 v[176:179], a[4:7], a[48:51], v[176:179]
    v_mfma_f32_16x16x32_bf16 v[180:183], a[4:7], a[52:55], v[180:183]
    v_mfma_f32_16x16x32_bf16 v[184:187], a[4:7], a[56:59], v[184:187]
    ds_read_b64_tr_b16 a[104:105], v30 offset:49152
    v_mfma_f32_16x16x32_bf16 v[188:191], a[4:7], a[60:63], v[188:191]
    v_mfma_f32_16x16x32_bf16 v[96:99], a[8:11], a[32:35], v[96:99]
    ds_read_b64_tr_b16 a[106:107], v30 offset:51200
    v_mfma_f32_16x16x32_bf16 v[100:103], a[8:11], a[36:39], v[100:103]
    v_mfma_f32_16x16x32_bf16 v[104:107], a[8:11], a[40:43], v[104:107]
    ds_read_b128 a[76:79], v27 offset:38912
    v_mfma_f32_16x16x32_bf16 v[108:111], a[8:11], a[44:47], v[108:111]
    v_mfma_f32_16x16x32_bf16 v[112:115], a[8:11], a[48:51], v[112:115]
    ds_read_b64_tr_b16 a[108:109], v31 offset:49152
    v_mfma_f32_16x16x32_bf16 v[116:119], a[8:11], a[52:55], v[116:119]
    v_mfma_f32_16x16x32_bf16 v[120:123], a[8:11], a[56:59], v[120:123]
    ds_read_b64_tr_b16 a[110:111], v31 offset:51200
    v_mfma_f32_16x16x32_bf16 v[124:127], a[8:11], a[60:63], v[124:127]
    v_mfma_f32_16x16x32_bf16 v[192:195], a[12:15], a[32:35], v[192:195]
    ds_read_b128 a[80:83], v27 offset:40960
    v_mfma_f32_16x16x32_bf16 v[196:199], a[12:15], a[36:39], v[196:199]
    v_mfma_f32_16x16x32_bf16 v[200:203], a[12:15], a[40:43], v[200:203]
    ds_read_b64_tr_b16 a[112:113], v32 offset:49152
    v_mfma_f32_16x16x32_bf16 v[204:207], a[12:15], a[44:47], v[204:207]
    v_mfma_f32_16x16x32_bf16 v[208:211], a[12:15], a[48:51], v[208:211]
    ds_read_b64_tr_b16 a[114:115], v32 offset:51200
    v_mfma_f32_16x16x32_bf16 v[212:215], a[12:15], a[52:55], v[212:215]
    v_mfma_f32_16x16x32_bf16 v[216:219], a[12:15], a[56:59], v[216:219]
    ds_read_b128 a[84:87], v27 offset:43008
    v_mfma_f32_16x16x32_bf16 v[220:223], a[12:15], a[60:63], v[220:223]
    v_mfma_f32_16x16x32_bf16 v[128:131], a[16:19], a[32:35], v[128:131]
    ds_read_b64_tr_b16 a[116:117], v33 offset:49152
    v_mfma_f32_16x16x32_bf16 v[132:135], a[16:19], a[36:39], v[132:135]
    v_mfma_f32_16x16x32_bf16 v[136:139], a[16:19], a[40:43], v[136:139]
    ds_read_b64_tr_b16 a[118:119], v33 offset:51200
    v_mfma_f32_16x16x32_bf16 v[140:143], a[16:19], a[44:47], v[140:143]
    v_mfma_f32_16x16x32_bf16 v[144:147], a[16:19], a[48:51], v[144:147]
    ds_read_b128 a[88:91], v27 offset:45056
    v_mfma_f32_16x16x32_bf16 v[148:151], a[16:19], a[52:55], v[148:151]
    v_mfma_f32_16x16x32_bf16 v[152:155], a[16:19], a[56:59], v[152:155]
    v_mfma_f32_16x16x32_bf16 v[156:159], a[16:19], a[60:63], v[156:159]
    ds_read_b64_tr_b16 a[120:121], v34 offset:49152
    v_mfma_f32_16x16x32_bf16 v[224:227], a[20:23], a[32:35], v[224:227]
    v_mfma_f32_16x16x32_bf16 v[228:231], a[20:23], a[36:39], v[228:231]
    ds_read_b64_tr_b16 a[122:123], v34 offset:51200
    v_mfma_f32_16x16x32_bf16 v[232:235], a[20:23], a[40:43], v[232:235]
    v_mfma_f32_16x16x32_bf16 v[236:239], a[20:23], a[44:47], v[236:239]
    ds_read_b128 a[92:95], v27 offset:47104
    v_mfma_f32_16x16x32_bf16 v[240:243], a[20:23], a[48:51], v[240:243]
    v_mfma_f32_16x16x32_bf16 v[244:247], a[20:23], a[52:55], v[244:247]
    ds_read_b64_tr_b16 a[124:125], v35 offset:49152
    v_mfma_f32_16x16x32_bf16 v[248:251], a[20:23], a[56:59], v[248:251]
    v_mfma_f32_16x16x32_bf16 v[252:255], a[20:23], a[60:63], v[252:255]
    ds_read_b64_tr_b16 a[126:127], v35 offset:51200
    v_mfma_f32_16x16x32_bf16 a[128:131], a[24:27], a[32:35], a[128:131]
    v_mfma_f32_16x16x32_bf16 a[136:139], a[24:27], a[36:39], a[136:139]
    v_mfma_f32_16x16x32_bf16 a[144:147], a[24:27], a[40:43], a[144:147]
    v_mfma_f32_16x16x32_bf16 a[152:155], a[24:27], a[44:47], a[152:155]
    v_mfma_f32_16x16x32_bf16 a[160:163], a[24:27], a[48:51], a[160:163]
    v_mfma_f32_16x16x32_bf16 a[168:171], a[24:27], a[52:55], a[168:171]
    v_mfma_f32_16x16x32_bf16 a[176:179], a[24:27], a[56:59], a[176:179]
    v_mfma_f32_16x16x32_bf16 a[184:187], a[24:27], a[60:63], a[184:187]
    s_sub_u32 s52, s51, 1
    s_cmp_eq_u32 s52, s46
    s_cbranch_scc1 k12_ool_29
k12_oolret_30:
    v_mfma_f32_16x16x32_bf16 a[132:135], a[28:31], a[32:35], a[132:135]
    v_mfma_f32_16x16x32_bf16 a[140:143], a[28:31], a[36:39], a[140:143]
    v_mfma_f32_16x16x32_bf16 a[148:151], a[28:31], a[40:43], a[148:151]
    v_mfma_f32_16x16x32_bf16 a[156:159], a[28:31], a[44:47], a[156:159]
    v_mfma_f32_16x16x32_bf16 a[164:167], a[28:31], a[48:51], a[164:167]
    v_mfma_f32_16x16x32_bf16 a[172:175], a[28:31], a[52:55], a[172:175]
    v_mfma_f32_16x16x32_bf16 a[180:183], a[28:31], a[56:59], a[180:183]
    v_mfma_f32_16x16x32_bf16 a[188:191], a[28:31], a[60:63], a[188:191]
    s_waitcnt vmcnt(0) lgkmcnt(0)
    s_barrier
    s_cmp_eq_u32 s51, 7
    s_cbranch_scc1 k12_last_20
    v_mfma_f32_16x16x32_bf16 v[64:67], a[64:67], a[96:99], v[64:67]
    ds_read_b128 a[0:3], v26 offset:0
    v_mfma_f32_16x16x32_bf16 v[68:71], a[64:67], a[100:103], v[68:71]
    s_add_u32 m0, s48, 32768
    ds_read_b64_tr_b16 a[32:33], v28 offset:0
    v_mfma_f32_16x16x32_bf16 v[72:75], a[64:67], a[104:107], v[72:75]
    buffer_load_dwordx4 v10, s[16:19], s49 offen offset:0 lds
    v_mfma_f32_16x16x32_bf16 v[76:79], a[64:67], a[108:111], v[76:79]
    ds_read_b64_tr_b16 a[34:35], v28 offset:2048
    v_mfma_f32_16x16x32_bf16 v[80:83], a[64:67], a[112:115], v[80:83]
    buffer_load_dwordx4 v11, s[16:19], s49 offen offset:1024 lds
    v_mfma_f32_16x16x32_bf16 v[84:87], a[64:67], a[116:119], v[84:87]
    ds_read_b128 a[4:7], v26 offset:2048
    v_mfma_f32_16x16x32_bf16 v[88:91], a[64:67], a[120:123], v[88:91]
    v_mfma_f32_16x16x32_bf16 v[92:95], a[64:67], a[124:127], v[92:95]
    ds_read_b64_tr_b16 a[36:37], v29 offset:0
    v_mfma_f32_16x16x32_bf16 v[160:163], a[68:71], a[96:99], v[160:163]
    buffer_load_dwordx4 v12, s[16:19], s49 offen offset:2048 lds
    v_mfma_f32_16x16x32_bf16 v[164:167], a[68:71], a[100:103], v[164:167]
    ds_read_b64_tr_b16 a[38:39], v29 offset:2048
    v_mfma_f32_16x16x32_bf16 v[168:171], a[68:71], a[104:107], v[168:171]
    v_mfma_f32_16x16x32_bf16 v[172:175], a[68:71], a[108:111], v[172:175]
    buffer_load_dwordx4 v13, s[16:19], s49 offen offset:3072 lds
    ds_read_b128 a[8:11], v26 offset:4096
    v_mfma_f32_16x16x32_bf16 v[176:179], a[68:71], a[112:115], v[176:179]
    v_mfma_f32_16x16x32_bf16 v[180:183], a[68:71], a[116:119], v[180:183]
    s_add_u32 m0, s48, 36864
    v_mfma_f32_16x16x32_bf16 v[184:187], a[68:71], a[120:123], v[184:187]
    ds_read_b64_tr_b16 a[40:41], v30 offset:0
    v_mfma_f32_16x16x32_bf16 v[188:191], a[68:71], a[124:127], v[188:191]
    buffer_load_dwordx4 v14, s[16:19], s49 offen offset:0 lds
    v_mfma_f32_16x16x32_bf16 v[96:99], a[72:75], a[96:99], v[96:99]
    ds_read_b64_tr_b16 a[42:43], v30 offset:2048
    v_mfma_f32_16x16x32_bf16 v[100:103], a[72:75], a[100:103], v[100:103]
    v_mfma_f32_16x16x32_bf16 v[104:107], a[72:75], a[104:107], v[104:107]
    buffer_load_dwordx4 v15, s[16:19], s49 offen offset:1024 lds
    ds_read_b128 a[12:15], v26 offset:6144
    v_mfma_f32_16x16x32_bf16 v[108:111], a[72:75], a[108:111], v[108:111]
    v_mfma_f32_16x16x32_bf16 v[112:115], a[72:75], a[112:115], v[112:115]
    ds_read_b64_tr_b16 a[44:45], v31 offset:0
    v_mfma_f32_16x16x32_bf16 v[116:119], a[72:75], a[116:119], v[116:119]
    v_mfma_f32_16x16x32_bf16 v[120:123], a[72:75], a[120:123], v[120:123]
    buffer_load_dwordx4 v16, s[16:19], s49 offen offset:2048 lds
    ds_read_b64_tr_b16 a[46:47], v31 offset:2048
    v_mfma_f32_16x16x32_bf16 v[124:127], a[72:75], a[124:127], v[124:127]
    v_mfma_f32_16x16x32_bf16 v[192:195], a[76:79], a[96:99], v[192:195]
    ds_read_b128 a[16:19], v26 offset:8192
    v_mfma_f32_16x16x32_bf16 v[196:199], a[76:79], a[100:103], v[196:199]
    buffer_load_dwordx4 v17, s[16:19], s49 offen offset:3072 lds
    v_mfma_f32_16x16x32_bf16 v[200:203], a[76:79], a[104:107], v[200:203]
    ds_read_b64_tr_b16 a[48:49], v32 offset:0
    v_mfma_f32_16x16x32_bf16 v[204:207], a[76:79], a[108:111], v[204:207]
    s_add_u32 s49, s49, 128
    v_mfma_f32_16x16x32_bf16 v[208:211], a[76:79], a[112:115], v[208:211]
    s_add_u32 m0, s48, 98304
    ds_read_b64_tr_b16 a[50:51], v32 offset:2048
    v_mfma_f32_16x16x32_bf16 v[212:215], a[76:79], a[116:119], v[212:215]
    buffer_load_dwordx4 v18, s[20:23], s50 offen offset:0 nt lds
    v_mfma_f32_16x16x32_bf16 v[216:219], a[76:79], a[120:123], v[216:219]
    ds_read_b128 a[20:23], v26 offset:10240
    v_mfma_f32_16x16x32_bf16 v[220:223], a[76:79], a[124:127], v[220:223]
    v_mfma_f32_16x16x32_bf16 v[128:131], a[80:83], a[96:99], v[128:131]
    buffer_load_dwordx4 v19, s[20:23], s50 offen offset:1024 nt lds
    ds_read_b64_tr_b16 a[52:53], v33 offset:0
    v_mfma_f32_16x16x32_bf16 v[132:135], a[80:83], a[100:103], v[132:135]
    v_mfma_f32_16x16x32_bf16 v[136:139], a[80:83], a[104:107], v[136:139]
    ds_read_b64_tr_b16 a[54:55], v33 offset:2048
    v_mfma_f32_16x16x32_bf16 v[140:143], a[80:83], a[108:111], v[140:143]
    buffer_load_dwordx4 v20, s[20:23], s50 offen offset:2048 nt lds
    v_mfma_f32_16x16x32_bf16 v[144:147], a[80:83], a[112:115], v[144:147]
    ds_read_b128 a[24:27], v26 offset:12288
    v_mfma_f32_16x16x32_bf16 v[148:151], a[80:83], a[116:119], v[148:151]
    v_mfma_f32_16x16x32_bf16 v[152:155], a[80:83], a[120:123], v[152:155]
    v_mfma_f32_16x16x32_bf16 v[156:159], a[80:83], a[124:127], v[156:159]
    buffer_load_dwordx4 v21, s[20:23], s50 offen offset:3072 nt lds
    ds_read_b64_tr_b16 a[56:57], v34 offset:0
    v_mfma_f32_16x16x32_bf16 v[224:227], a[84:87], a[96:99], v[224:227]
    s_add_u32 m0, s48, 102400
    v_mfma_f32_16x16x32_bf16 v[228:231], a[84:87], a[100:103], v[228:231]
    ds_read_b64_tr_b16 a[58:59], v34 offset:2048
    v_mfma_f32_16x16x32_bf16 v[232:235], a[84:87], a[104:107], v[232:235]
    buffer_load_dwordx4 v22, s[20:23], s50 offen offset:0 nt lds
    v_mfma_f32_16x16x32_bf16 v[236:239], a[84:87], a[108:111], v[236:239]
    ds_read_b128 a[28:31], v26 offset:14336
    v_mfma_f32_16x16x32_bf16 v[240:243], a[84:87], a[112:115], v[240:243]
    v_mfma_f32_16x16x32_bf16 v[244:247], a[84:87], a[116:119], v[244:247]
    ds_read_b64_tr_b16 a[60:61], v35 offset:0
    v_mfma_f32_16x16x32_bf16 v[248:251], a[84:87], a[120:123], v[248:251]
    buffer_load_dwordx4 v23, s[20:23], s50 offen offset:1024 nt lds
    v_mfma_f32_16x16x32_bf16 v[252:255], a[84:87], a[124:127], v[252:255]
    ds_read_b64_tr_b16 a[62:63], v35 offset:2048
    v_mfma_f32_16x16x32_bf16 a[128:131], a[88:91], a[96:99], a[128:131]
    v_mfma_f32_16x16x32_bf16 a[136:139], a[88:91], a[100:103], a[136:139]
    buffer_load_dwordx4 v24, s[20:23], s50 offen offset:2048 nt lds
    v_mfma_f32_16x16x32_bf16 a[144:147], a[88:91], a[104:107], a[144:147]
    v_mfma_f32_16x16x32_bf16 a[152:155], a[88:91], a[108:111], a[152:155]
    v_mfma_f32_16x16x32_bf16 a[160:163], a[88:91], a[112:115], a[160:163]
    v_mfma_f32_16x16x32_bf16 a[168:171], a[88:91], a[116:119], a[168:171]
    buffer_load_dwordx4 v25, s[20:23], s50 offen offset:3072 nt lds
    v_mfma_f32_16x16x32_bf16 a[176:179], a[88:91], a[120:123], a[176:179]
    v_mfma_f32_16x16x32_bf16 a[184:187], a[88:91], a[124:127], a[184:187]
    s_add_u32 s50, s50, 0x80000
    v_mfma_f32_16x16x32_bf16 a[132:135], a[92:95], a[96:99], a[132:135]
    v_mfma_f32_16x16x32_bf16 a[140:143], a[92:95], a[100:103], a[140:143]
    s_cmp_eq_u32 s51, s53
    s_cbranch_scc1 k12_ool_31
k12_oolret_32:
    v_mfma_f32_16x16x32_bf16 a[148:151], a[92:95], a[104:107], a[148:151]
    v_mfma_f32_16x16x32_bf16 a[156:159], a[92:95], a[108:111], a[156:159]
    v_mfma_f32_16x16x32_bf16 a[164:167], a[92:95], a[112:115], a[164:167]
    v_mfma_f32_16x16x32_bf16 a[172:175], a[92:95], a[116:119], a[172:175]
    s_add_u32 s51, s51, 1
    v_mfma_f32_16x16x32_bf16 a[180:183], a[92:95], a[120:123], a[180:183]
    v_mfma_f32_16x16x32_bf16 a[188:191], a[92:95], a[124:127], a[188:191]
    s_waitcnt lgkmcnt(0)
    s_branch k12_loop_19
k12_last_20:
    v_mfma_f32_16x16x32_bf16 v[64:67], a[64:67], a[96:99], v[64:67]
    s_add_u32 m0, s60, 98304
    v_mfma_f32_16x16x32_bf16 v[160:163], a[68:71], a[96:99], v[160:163]
    buffer_load_dwordx4 v38, s[12:15], s61 offen offset:0 lds
    v_mfma_f32_16x16x32_bf16 v[68:71], a[64:67], a[100:103], v[68:71]
    buffer_load_dwordx4 v39, s[12:15], s61 offen offset:1024 lds
    v_mfma_f32_16x16x32_bf16 v[164:167], a[68:71], a[100:103], v[164:167]
    v_mfma_f32_16x16x32_bf16 v[72:75], a[64:67], a[104:107], v[72:75]
    buffer_load_dwordx4 v40, s[12:15], s61 offen offset:2048 lds
    v_mfma_f32_16x16x32_bf16 v[168:171], a[68:71], a[104:107], v[168:171]
    v_cvt_pk_bf16_f32 v64, v64, v65
    v_cvt_pk_bf16_f32 v65, v66, v67
    v_cvt_pk_bf16_f32 v66, v160, v161
    v_mfma_f32_16x16x32_bf16 v[76:79], a[64:67], a[108:111], v[76:79]
    v_cvt_pk_bf16_f32 v67, v162, v163
    v_mfma_f32_16x16x32_bf16 v[172:175], a[68:71], a[108:111], v[172:175]
    v_cvt_pk_bf16_f32 v68, v68, v69
    v_cvt_pk_bf16_f32 v69, v70, v71
    v_cvt_pk_bf16_f32 v70, v164, v165
    v_mfma_f32_16x16x32_bf16 v[80:83], a[64:67], a[112:115], v[80:83]
    buffer_load_dwordx4 v41, s[12:15], s61 offen offset:3072 lds
    v_mfma_f32_16x16x32_bf16 v[176:179], a[68:71], a[112:115], v[176:179]
    s_add_u32 s61, s61, 0x80000
    v_cvt_pk_bf16_f32 v71, v166, v167
    v_cvt_pk_bf16_f32 v72, v72, v73
    v_cvt_pk_bf16_f32 v73, v74, v75
    v_mfma_f32_16x16x32_bf16 v[84:87], a[64:67], a[116:119], v[84:87]
    buffer_load_dwordx4 a[192:195], v36, s[8:11], s62 offen offset:0 sc1
    buffer_load_dwordx4 a[196:199], v36, s[8:11], s62 offen offset:1024 sc1
    v_mfma_f32_16x16x32_bf16 v[180:183], a[68:71], a[116:119], v[180:183]
    v_cvt_pk_bf16_f32 v74, v168, v169
    v_cvt_pk_bf16_f32 v75, v170, v171
    v_cvt_pk_bf16_f32 v76, v76, v77
    v_mfma_f32_16x16x32_bf16 v[88:91], a[64:67], a[120:123], v[88:91]
    v_cvt_pk_bf16_f32 v77, v78, v79
    v_cvt_pk_bf16_f32 v78, v172, v173
    v_cvt_pk_bf16_f32 v79, v174, v175
    v_mfma_f32_16x16x32_bf16 v[184:187], a[68:71], a[120:123], v[184:187]
    v_cvt_pk_bf16_f32 v80, v80, v81
    v_cvt_pk_bf16_f32 v81, v82, v83
    v_cvt_pk_bf16_f32 v82, v176, v177
    v_mfma_f32_16x16x32_bf16 v[92:95], a[64:67], a[124:127], v[92:95]
    buffer_load_dwordx4 a[200:203], v37, s[8:11], s62 offen offset:0 sc1
    buffer_load_dwordx4 a[204:207], v37, s[8:11], s62 offen offset:1024 sc1
    v_mfma_f32_16x16x32_bf16 v[188:191], a[68:71], a[124:127], v[188:191]
    s_add_u32 s62, s62, 0x20000
    v_cvt_pk_bf16_f32 v83, v178, v179
    v_cvt_pk_bf16_f32 v84, v84, v85
    v_cvt_pk_bf16_f32 v85, v86, v87
    v_mfma_f32_16x16x32_bf16 a[128:131], a[88:91], a[96:99], a[128:131]
    v_cvt_pk_bf16_f32 v86, v180, v181
    v_cvt_pk_bf16_f32 v87, v182, v183
    v_mfma_f32_16x16x32_bf16 a[132:135], a[92:95], a[96:99], a[132:135]
    v_cvt_pk_bf16_f32 v88, v88, v89
    v_cvt_pk_bf16_f32 v89, v90, v91
    v_cvt_pk_bf16_f32 v90, v184, v185
    v_mfma_f32_16x16x32_bf16 v[96:99], a[72:75], a[96:99], v[96:99]
    buffer_load_dwordx4 a[208:211], v36, s[8:11], s62 offen offset:0 sc1
    buffer_load_dwordx4 a[212:215], v36, s[8:11], s62 offen offset:1024 sc1
    v_mfma_f32_16x16x32_bf16 v[192:195], a[76:79], a[96:99], v[192:195]
    v_cvt_pk_bf16_f32 v91, v186, v187
    v_cvt_pk_bf16_f32 v92, v92, v93
    v_cvt_pk_bf16_f32 v93, v94, v95
    v_mfma_f32_16x16x32_bf16 v[100:103], a[72:75], a[100:103], v[100:103]
    v_cvt_pk_bf16_f32 v94, v188, v189
    v_cvt_pk_bf16_f32 v95, v190, v191
    v_mfma_f32_16x16x32_bf16 v[196:199], a[76:79], a[100:103], v[196:199]
    v_accvgpr_read_b32 v56, a128
    v_accvgpr_read_b32 v57, a129
    v_accvgpr_read_b32 v58, a130
    v_mfma_f32_16x16x32_bf16 a[136:139], a[88:91], a[100:103], a[136:139]
    buffer_load_dwordx4 a[216:219], v37, s[8:11], s62 offen offset:0 sc1
    buffer_load_dwordx4 a[220:223], v37, s[8:11], s62 offen offset:1024 sc1
    v_mfma_f32_16x16x32_bf16 a[140:143], a[92:95], a[100:103], a[140:143]
    s_add_u32 s62, s62, 0x20000
    v_accvgpr_read_b32 v59, a131
    v_accvgpr_read_b32 v60, a132
    v_cvt_pk_bf16_f32 v96, v96, v97
    v_mfma_f32_16x16x32_bf16 v[104:107], a[72:75], a[104:107], v[104:107]
    s_add_u32 m0, s60, 114688
    v_accvgpr_read_b32 v61, a133
    v_accvgpr_read_b32 v62, a134
    v_cvt_pk_bf16_f32 v97, v98, v99
    v_mfma_f32_16x16x32_bf16 v[200:203], a[76:79], a[104:107], v[200:203]
    v_accvgpr_read_b32 v63, a135
    v_cvt_pk_bf16_f32 v98, v192, v193
    v_cvt_pk_bf16_f32 v160, v56, v57
    v_mfma_f32_16x16x32_bf16 v[108:111], a[72:75], a[108:111], v[108:111]
    v_cvt_pk_bf16_f32 v99, v194, v195
    v_cvt_pk_bf16_f32 v161, v58, v59
    v_cvt_pk_bf16_f32 v100, v100, v101
    v_mfma_f32_16x16x32_bf16 v[204:207], a[76:79], a[108:111], v[204:207]
    buffer_load_dwordx4 v38, s[12:15], s61 offen offset:0 lds
    buffer_load_dwordx4 v39, s[12:15], s61 offen offset:1024 lds
    v_mfma_f32_16x16x32_bf16 a[144:147], a[88:91], a[104:107], a[144:147]
    v_cvt_pk_bf16_f32 v162, v60, v61
    v_cvt_pk_bf16_f32 v101, v102, v103
    v_cvt_pk_bf16_f32 v163, v62, v63
    v_mfma_f32_16x16x32_bf16 a[148:151], a[92:95], a[104:107], a[148:151]
    v_cvt_pk_bf16_f32 v102, v196, v197
    v_cvt_pk_bf16_f32 v103, v198, v199
    v_accvgpr_read_b32 v56, a136
    v_mfma_f32_16x16x32_bf16 v[112:115], a[72:75], a[112:115], v[112:115]
    v_accvgpr_read_b32 v57, a137
    v_accvgpr_read_b32 v58, a138
    v_accvgpr_read_b32 v59, a139
    v_mfma_f32_16x16x32_bf16 v[208:211], a[76:79], a[112:115], v[208:211]
    v_accvgpr_read_b32 v60, a140
    v_cvt_pk_bf16_f32 v104, v104, v105
    v_accvgpr_read_b32 v61, a141
    v_mfma_f32_16x16x32_bf16 v[116:119], a[72:75], a[116:119], v[116:119]
    buffer_load_dwordx4 v40, s[12:15], s61 offen offset:2048 lds
    buffer_load_dwordx4 v41, s[12:15], s61 offen offset:3072 lds
    v_mfma_f32_16x16x32_bf16 v[212:215], a[76:79], a[116:119], v[212:215]
    s_add_u32 s61, s61, 0x80000
    v_accvgpr_read_b32 v62, a142
    v_cvt_pk_bf16_f32 v105, v106, v107
    v_accvgpr_read_b32 v63, a143
    v_mfma_f32_16x16x32_bf16 a[152:155], a[88:91], a[108:111], a[152:155]
    v_cvt_pk_bf16_f32 v106, v200, v201
    v_cvt_pk_bf16_f32 v164, v56, v57
    v_cvt_pk_bf16_f32 v107, v202, v203
    v_mfma_f32_16x16x32_bf16 a[156:159], a[92:95], a[108:111], a[156:159]
    v_cvt_pk_bf16_f32 v165, v58, v59
    v_cvt_pk_bf16_f32 v108, v108, v109
    v_cvt_pk_bf16_f32 v166, v60, v61
    v_mfma_f32_16x16x32_bf16 v[120:123], a[72:75], a[120:123], v[120:123]
    v_cvt_pk_bf16_f32 v109, v110, v111
    v_cvt_pk_bf16_f32 v167, v62, v63
    v_cvt_pk_bf16_f32 v110, v204, v205
    v_mfma_f32_16x16x32_bf16 v[216:219], a[76:79], a[120:123], v[216:219]
    buffer_load_dwordx4 a[224:227], v36, s[8:11], s62 offen offset:0 sc1
    v_cvt_pk_bf16_f32 v111, v206, v207
    v_accvgpr_read_b32 v56, a144
    v_mfma_f32_16x16x32_bf16 v[124:127], a[72:75], a[124:127], v[124:127]
    v_accvgpr_read_b32 v57, a145
    v_accvgpr_read_b32 v58, a146
    v_accvgpr_read_b32 v59, a147
    v_mfma_f32_16x16x32_bf16 v[220:223], a[76:79], a[124:127], v[220:223]
    buffer_load_dwordx4 a[228:231], v36, s[8:11], s62 offen offset:1024 sc1
    v_accvgpr_read_b32 v60, a148
    v_cvt_pk_bf16_f32 v112, v112, v113
    v_mfma_f32_16x16x32_bf16 a[160:163], a[88:91], a[112:115], a[160:163]
    v_accvgpr_read_b32 v61, a149
    v_accvgpr_read_b32 v62, a150
    v_cvt_pk_bf16_f32 v113, v114, v115
    v_mfma_f32_16x16x32_bf16 a[164:167], a[92:95], a[112:115], a[164:167]
    v_accvgpr_read_b32 v63, a151
    v_cvt_pk_bf16_f32 v114, v208, v209
    v_cvt_pk_bf16_f32 v168, v56, v57
    v_mfma_f32_16x16x32_bf16 v[128:131], a[80:83], a[96:99], v[128:131]
    v_cvt_pk_bf16_f32 v115, v210, v211
    v_cvt_pk_bf16_f32 v169, v58, v59
    v_cvt_pk_bf16_f32 v116, v116, v117
    v_mfma_f32_16x16x32_bf16 v[224:227], a[84:87], a[96:99], v[224:227]
    buffer_load_dwordx4 a[232:235], v37, s[8:11], s62 offen offset:0 sc1
    v_cvt_pk_bf16_f32 v170, v60, v61
    v_cvt_pk_bf16_f32 v117, v118, v119
    v_mfma_f32_16x16x32_bf16 v[132:135], a[80:83], a[100:103], v[132:135]
    v_cvt_pk_bf16_f32 v171, v62, v63
    v_cvt_pk_bf16_f32 v118, v212, v213
    v_cvt_pk_bf16_f32 v119, v214, v215
    v_mfma_f32_16x16x32_bf16 v[228:231], a[84:87], a[100:103], v[228:231]
    buffer_load_dwordx4 a[236:239], v37, s[8:11], s62 offen offset:1024 sc1
    v_accvgpr_read_b32 v56, a152
    v_accvgpr_read_b32 v57, a153
    v_mfma_f32_16x16x32_bf16 a[168:171], a[88:91], a[116:119], a[168:171]
    s_add_u32 s62, s62, 0x20000
    v_accvgpr_read_b32 v58, a154
    v_accvgpr_read_b32 v59, a155
    v_accvgpr_read_b32 v60, a156
    v_mfma_f32_16x16x32_bf16 a[172:175], a[92:95], a[116:119], a[172:175]
    s_waitcnt vmcnt(16)
    s_barrier
    v_cvt_pk_bf16_f32 v120, v120, v121
    v_accvgpr_read_b32 v61, a157
    v_accvgpr_read_b32 v62, a158
    v_mfma_f32_16x16x32_bf16 v[136:139], a[80:83], a[104:107], v[136:139]
    v_cvt_pk_bf16_f32 v121, v122, v123
    v_accvgpr_read_b32 v63, a159
    v_cvt_pk_bf16_f32 v122, v216, v217
    v_mfma_f32_16x16x32_bf16 v[232:235], a[84:87], a[104:107], v[232:235]
    v_cvt_pk_bf16_f32 v172, v56, v57
    v_cvt_pk_bf16_f32 v123, v218, v219
    v_cvt_pk_bf16_f32 v173, v58, v59
    v_mfma_f32_16x16x32_bf16 v[140:143], a[80:83], a[108:111], v[140:143]
    v_cvt_pk_bf16_f32 v124, v124, v125
    v_cvt_pk_bf16_f32 v174, v60, v61
    v_cvt_pk_bf16_f32 v125, v126, v127
    v_mfma_f32_16x16x32_bf16 v[236:239], a[84:87], a[108:111], v[236:239]
    v_cvt_pk_bf16_f32 v175, v62, v63
    v_cvt_pk_bf16_f32 v126, v220, v221
    v_cvt_pk_bf16_f32 v127, v222, v223
    v_mfma_f32_16x16x32_bf16 a[176:179], a[88:91], a[120:123], a[176:179]
    ds_read_b64_tr_b16 a[0:1], v42 offset:0
    v_accvgpr_read_b32 v56, a160
    v_accvgpr_read_b32 v57, a161
    v_mfma_f32_16x16x32_bf16 a[180:183], a[92:95], a[120:123], a[180:183]
    ds_read_b64_tr_b16 a[2:3], v42 offset:1024
    v_accvgpr_read_b32 v58, a162
    v_accvgpr_read_b32 v59, a163
    v_mfma_f32_16x16x32_bf16 v[144:147], a[80:83], a[112:115], v[144:147]
    ds_read_b64_tr_b16 a[4:5], v43 offset:0
    v_accvgpr_read_b32 v60, a164
    v_cvt_pk_bf16_f32 v128, v128, v129
    v_mfma_f32_16x16x32_bf16 v[240:243], a[84:87], a[112:115], v[240:243]
    v_accvgpr_read_b32 v61, a165
    v_accvgpr_read_b32 v62, a166
    v_cvt_pk_bf16_f32 v129, v130, v131
    v_mfma_f32_16x16x32_bf16 v[148:151], a[80:83], a[116:119], v[148:151]
    ds_read_b64_tr_b16 a[6:7], v43 offset:1024
    v_accvgpr_read_b32 v63, a167
    v_cvt_pk_bf16_f32 v130, v224, v225
    v_mfma_f32_16x16x32_bf16 v[244:247], a[84:87], a[116:119], v[244:247]
    v_cvt_pk_bf16_f32 v176, v56, v57
    v_cvt_pk_bf16_f32 v131, v226, v227
    v_cvt_pk_bf16_f32 v177, v58, v59
    v_mfma_f32_16x16x32_bf16 a[184:187], a[88:91], a[124:127], a[184:187]
    ds_read_b64_tr_b16 a[8:9], v44 offset:0
    v_cvt_pk_bf16_f32 v132, v132, v133
    v_cvt_pk_bf16_f32 v178, v60, v61
    v_mfma_f32_16x16x32_bf16 a[188:191], a[92:95], a[124:127], a[188:191]
    ds_read_b64_tr_b16 a[10:11], v44 offset:1024
    v_cvt_pk_bf16_f32 v133, v134, v135
    v_cvt_pk_bf16_f32 v179, v62, v63
    v_mfma_f32_16x16x32_bf16 v[152:155], a[80:83], a[120:123], v[152:155]
    ds_read_b64_tr_b16 a[12:13], v45 offset:0
    v_cvt_pk_bf16_f32 v134, v228, v229
    v_cvt_pk_bf16_f32 v135, v230, v231
    v_mfma_f32_16x16x32_bf16 v[248:251], a[84:87], a[120:123], v[248:251]
    ds_read_b64_tr_b16 a[14:15], v45 offset:1024
    v_accvgpr_read_b32 v56, a168
    v_accvgpr_read_b32 v57, a169
    v_mfma_f32_16x16x32_bf16 v[156:159], a[80:83], a[124:127], v[156:159]
    ds_read_b64_tr_b16 a[16:17], v46 offset:0
    v_accvgpr_read_b32 v58, a170
    v_accvgpr_read_b32 v59, a171
    v_mfma_f32_16x16x32_bf16 v[252:255], a[84:87], a[124:127], v[252:255]
    v_accvgpr_read_b32 v60, a172
    v_cvt_pk_bf16_f32 v136, v136, v137
    v_accvgpr_read_b32 v61, a173
    ds_read_b64_tr_b16 a[18:19], v46 offset:1024
    v_accvgpr_read_b32 v62, a174
    v_cvt_pk_bf16_f32 v137, v138, v139
    v_accvgpr_read_b32 v63, a175
    v_cvt_pk_bf16_f32 v138, v232, v233
    v_cvt_pk_bf16_f32 v180, v56, v57
    ds_read_b64_tr_b16 a[20:21], v47 offset:0
    v_cvt_pk_bf16_f32 v139, v234, v235
    v_cvt_pk_bf16_f32 v181, v58, v59
    v_cvt_pk_bf16_f32 v140, v140, v141
    v_cvt_pk_bf16_f32 v182, v60, v61
    ds_read_b64_tr_b16 a[22:23], v47 offset:1024
    v_cvt_pk_bf16_f32 v141, v142, v143
    v_cvt_pk_bf16_f32 v183, v62, v63
    v_cvt_pk_bf16_f32 v142, v236, v237
    ds_read_b64_tr_b16 a[24:25], v48 offset:0
    v_cvt_pk_bf16_f32 v143, v238, v239
    v_accvgpr_read_b32 v56, a176
    ds_read_b64_tr_b16 a[26:27], v48 offset:1024
    v_accvgpr_read_b32 v57, a177
    v_accvgpr_read_b32 v58, a178
    ds_read_b64_tr_b16 a[28:29], v49 offset:0
    v_accvgpr_read_b32 v59, a179
    v_accvgpr_read_b32 v60, a180
    v_cvt_pk_bf16_f32 v144, v144, v145
    ds_read_b64_tr_b16 a[30:31], v49 offset:1024
    v_accvgpr_read_b32 v61, a181
    v_accvgpr_read_b32 v62, a182
    v_cvt_pk_bf16_f32 v145, v146, v147
    v_accvgpr_read_b32 v63, a183
    v_cvt_pk_bf16_f32 v146, v240, v241
    v_cvt_pk_bf16_f32 v184, v56, v57
    v_cvt_pk_bf16_f32 v147, v242, v243
    v_cvt_pk_bf16_f32 v185, v58, v59
    v_cvt_pk_bf16_f32 v148, v148, v149
    v_cvt_pk_bf16_f32 v186, v60, v61
    v_cvt_pk_bf16_f32 v149, v150, v151
    v_cvt_pk_bf16_f32 v187, v62, v63
    v_cvt_pk_bf16_f32 v150, v244, v245
    v_cvt_pk_bf16_f32 v151, v246, v247
    v_accvgpr_read_b32 v56, a184
    v_accvgpr_read_b32 v57, a185
    v_accvgpr_read_b32 v58, a186
    v_accvgpr_read_b32 v59, a187
    v_accvgpr_read_b32 v60, a188
    v_cvt_pk_bf16_f32 v152, v152, v153
    v_accvgpr_read_b32 v61, a189
    v_accvgpr_read_b32 v62, a190
    v_cvt_pk_bf16_f32 v153, v154, v155
    v_accvgpr_read_b32 v63, a191
    v_cvt_pk_bf16_f32 v154, v248, v249
    v_cvt_pk_bf16_f32 v188, v56, v57
    v_cvt_pk_bf16_f32 v155, v250, v251
    v_cvt_pk_bf16_f32 v189, v58, v59
    v_cvt_pk_bf16_f32 v156, v156, v157
    v_cvt_pk_bf16_f32 v190, v60, v61
    v_cvt_pk_bf16_f32 v157, v158, v159
    v_cvt_pk_bf16_f32 v191, v62, v63
    v_cvt_pk_bf16_f32 v158, v252, v253
    v_cvt_pk_bf16_f32 v159, v254, v255
k12_join_4:
    s_waitcnt vmcnt(12) lgkmcnt(0)
    v_mfma_f32_16x16x32_bf16 v[192:195], a[0:3], a[192:195], 0
    ds_read_b64_tr_b16 a[32:33], v42 offset:8192
    ds_read_b64_tr_b16 a[34:35], v42 offset:9216
    v_mfma_f32_16x16x32_bf16 v[196:199], a[0:3], a[196:199], 0
    buffer_load_dwordx4 a[240:243], v36, s[8:11], s62 offen offset:0 sc1
    v_mfma_f32_16x16x32_bf16 a[64:67], a[0:3], a[200:203], 0
    ds_read_b64_tr_b16 a[36:37], v43 offset:8192
    v_mfma_f32_16x16x32_bf16 a[68:71], a[0:3], a[204:207], 0
    ds_read_b64_tr_b16 a[38:39], v43 offset:9216
    v_mfma_f32_16x16x32_bf16 v[200:203], a[4:7], a[192:195], 0
    ds_read_b64_tr_b16 a[40:41], v44 offset:8192
    v_mfma_f32_16x16x32_bf16 v[204:207], a[4:7], a[196:199], 0
    v_mfma_f32_16x16x32_bf16 a[72:75], a[4:7], a[200:203], 0
    s_lshl_b32 s31, s28, 14
    buffer_load_dwordx4 a[244:247], v36, s[8:11], s62 offen offset:1024 sc1
    ds_read_b64_tr_b16 a[42:43], v44 offset:9216
    v_mfma_f32_16x16x32_bf16 a[76:79], a[4:7], a[204:207], 0
    s_add_u32 s16, s6, s31
    s_addc_u32 s17, s7, 0
    ds_read_b64_tr_b16 a[44:45], v45 offset:8192
    v_mfma_f32_16x16x32_bf16 v[208:211], a[8:11], a[192:195], 0
    v_mfma_f32_16x16x32_bf16 v[212:215], a[8:11], a[196:199], 0
    s_add_u32 s20, s16, 0x2000000
    s_addc_u32 s21, s17, 0
    ds_read_b64_tr_b16 a[46:47], v45 offset:9216
    v_mfma_f32_16x16x32_bf16 a[80:83], a[8:11], a[200:203], 0
    ds_read_b64_tr_b16 a[48:49], v46 offset:8192
    v_mfma_f32_16x16x32_bf16 a[84:87], a[8:11], a[204:207], 0
    s_add_u32 s16, s16, 0x1000000
    s_addc_u32 s17, s17, 0
    ds_read_b64_tr_b16 a[50:51], v46 offset:9216
    v_mfma_f32_16x16x32_bf16 v[216:219], a[12:15], a[192:195], 0
    buffer_load_dwordx4 a[248:251], v37, s[8:11], s62 offen offset:0 sc1
    v_mfma_f32_16x16x32_bf16 v[220:223], a[12:15], a[196:199], 0
    s_and_b32 s17, s17, 0xffff
    ds_read_b64_tr_b16 a[52:53], v47 offset:8192
    v_mfma_f32_16x16x32_bf16 a[88:91], a[12:15], a[200:203], 0
    ds_read_b64_tr_b16 a[54:55], v47 offset:9216
    v_mfma_f32_16x16x32_bf16 a[92:95], a[12:15], a[204:207], 0
    s_and_b32 s21, s21, 0xffff
    ds_read_b64_tr_b16 a[56:57], v48 offset:8192
    v_mfma_f32_16x16x32_bf16 v[224:227], a[16:19], a[192:195], 0
    v_mfma_f32_16x16x32_bf16 v[228:231], a[16:19], a[196:199], 0
    s_lshl_b32 s31, s29, 20
    buffer_load_dwordx4 a[252:255], v37, s[8:11], s62 offen offset:1024 sc1
    ds_read_b64_tr_b16 a[58:59], v48 offset:9216
    v_mfma_f32_16x16x32_bf16 a[96:99], a[16:19], a[200:203], 0
    ds_read_b64_tr_b16 a[60:61], v49 offset:8192
    v_mfma_f32_16x16x32_bf16 a[100:103], a[16:19], a[204:207], 0
    s_sub_u32 s18, 0xf84000, s31
    v_mfma_f32_16x16x32_bf16 v[232:235], a[20:23], a[192:195], 0
    ds_read_b64_tr_b16 a[62:63], v49 offset:9216
    v_mfma_f32_16x16x32_bf16 v[236:239], a[20:23], a[196:199], 0
    s_mov_b32 s22, s18
    v_mfma_f32_16x16x32_bf16 a[104:107], a[20:23], a[200:203], 0
    s_add_u32 s62, s62, 0x20000
    v_mfma_f32_16x16x32_bf16 a[108:111], a[20:23], a[204:207], 0
    s_add_u32 s52, s47, 0
    v_mfma_f32_16x16x32_bf16 v[240:243], a[24:27], a[192:195], 0
    s_add_u32 s24, s6, 0x4806000
    s_addc_u32 s25, s7, 0
    buffer_store_dwordx4 v[64:67], v1, s[32:35], s52 offen offset:0 sc1
    v_mfma_f32_16x16x32_bf16 v[244:247], a[24:27], a[196:199], 0
    s_and_b32 s25, s25, 0xffff
    v_mfma_f32_16x16x32_bf16 a[112:115], a[24:27], a[200:203], 0
    v_mfma_f32_16x16x32_bf16 a[116:119], a[24:27], a[204:207], 0
    s_mov_b32 s26, 4096
    v_mfma_f32_16x16x32_bf16 v[248:251], a[28:31], a[192:195], 0
    v_mfma_f32_16x16x32_bf16 v[252:255], a[28:31], a[196:199], 0
    v_mfma_f32_16x16x32_bf16 a[120:123], a[28:31], a[200:203], 0
    v_mfma_f32_16x16x32_bf16 a[124:127], a[28:31], a[204:207], 0
    s_waitcnt vmcnt(9) lgkmcnt(0)
    s_barrier
    v_mfma_f32_16x16x32_bf16 v[192:195], a[32:35], a[208:211], v[192:195]
    ds_read_b64_tr_b16 a[0:1], v42 offset:16384
    ds_read_b64_tr_b16 a[2:3], v42 offset:17408
    v_mfma_f32_16x16x32_bf16 v[196:199], a[32:35], a[212:215], v[196:199]
    s_add_u32 m0, s60, 131072
    v_mfma_f32_16x16x32_bf16 a[64:67], a[32:35], a[216:219], a[64:67]
    buffer_load_dwordx4 v38, s[12:15], s61 offen offset:0 lds
    ds_read_b64_tr_b16 a[4:5], v43 offset:16384
    v_mfma_f32_16x16x32_bf16 a[68:71], a[32:35], a[220:223], a[68:71]
    ds_read_b64_tr_b16 a[6:7], v43 offset:17408
    v_mfma_f32_16x16x32_bf16 v[200:203], a[36:39], a[208:211], v[200:203]
    buffer_load_dwordx4 v39, s[12:15], s61 offen offset:1024 lds
    ds_read_b64_tr_b16 a[8:9], v44 offset:16384
    v_mfma_f32_16x16x32_bf16 v[204:207], a[36:39], a[212:215], v[204:207]
    v_mfma_f32_16x16x32_bf16 a[72:75], a[36:39], a[216:219], a[72:75]
    buffer_load_dwordx4 v40, s[12:15], s61 offen offset:2048 lds
    ds_read_b64_tr_b16 a[10:11], v44 offset:17408
    v_mfma_f32_16x16x32_bf16 a[76:79], a[36:39], a[220:223], a[76:79]
    ds_read_b64_tr_b16 a[12:13], v45 offset:16384
    v_mfma_f32_16x16x32_bf16 v[208:211], a[40:43], a[208:211], v[208:211]
    v_mfma_f32_16x16x32_bf16 v[212:215], a[40:43], a[212:215], v[212:215]
    buffer_load_dwordx4 v41, s[12:15], s61 offen offset:3072 lds
    ds_read_b64_tr_b16 a[14:15], v45 offset:17408
    v_mfma_f32_16x16x32_bf16 a[80:83], a[40:43], a[216:219], a[80:83]
    ds_read_b64_tr_b16 a[16:17], v46 offset:16384
    v_mfma_f32_16x16x32_bf16 a[84:87], a[40:43], a[220:223], a[84:87]
    s_add_u32 s61, s61, 0x80000
    ds_read_b64_tr_b16 a[18:19], v46 offset:17408
    v_mfma_f32_16x16x32_bf16 v[216:219], a[44:47], a[208:211], v[216:219]
    buffer_load_dwordx4 a[192:195], v36, s[8:11], s62 offen offset:0 sc1
    v_mfma_f32_16x16x32_bf16 v[220:223], a[44:47], a[212:215], v[220:223]
    ds_read_b64_tr_b16 a[20:21], v47 offset:16384
    v_mfma_f32_16x16x32_bf16 a[88:91], a[44:47], a[216:219], a[88:91]
    buffer_load_dwordx4 a[196:199], v36, s[8:11], s62 offen offset:1024 sc1
    ds_read_b64_tr_b16 a[22:23], v47 offset:17408
    v_mfma_f32_16x16x32_bf16 a[92:95], a[44:47], a[220:223], a[92:95]
    ds_read_b64_tr_b16 a[24:25], v48 offset:16384
    v_mfma_f32_16x16x32_bf16 v[224:227], a[48:51], a[208:211], v[224:227]
    v_mfma_f32_16x16x32_bf16 v[228:231], a[48:51], a[212:215], v[228:231]
    buffer_load_dwordx4 a[200:203], v37, s[8:11], s62 offen offset:0 sc1
    ds_read_b64_tr_b16 a[26:27], v48 offset:17408
    v_mfma_f32_16x16x32_bf16 a[96:99], a[48:51], a[216:219], a[96:99]
    ds_read_b64_tr_b16 a[28:29], v49 offset:16384
    v_mfma_f32_16x16x32_bf16 a[100:103], a[48:51], a[220:223], a[100:103]
    v_mfma_f32_16x16x32_bf16 v[232:235], a[52:55], a[208:211], v[232:235]
    buffer_load_dwordx4 a[204:207], v37, s[8:11], s62 offen offset:1024 sc1
    ds_read_b64_tr_b16 a[30:31], v49 offset:17408
    v_mfma_f32_16x16x32_bf16 v[236:239], a[52:55], a[212:215], v[236:239]
    v_mfma_f32_16x16x32_bf16 a[104:107], a[52:55], a[216:219], a[104:107]
    s_add_u32 s62, s62, 0x20000
    v_mfma_f32_16x16x32_bf16 a[108:111], a[52:55], a[220:223], a[108:111]
    s_add_u32 s52, s47, 0
    v_mfma_f32_16x16x32_bf16 v[240:243], a[56:59], a[208:211], v[240:243]
    buffer_store_dwordx4 v[68:71], v1, s[32:35], s52 offen offset:1024 sc1
    v_mfma_f32_16x16x32_bf16 v[244:247], a[56:59], a[212:215], v[244:247]
    s_add_u32 s52, s47, 0
    v_mfma_f32_16x16x32_bf16 a[112:115], a[56:59], a[216:219], a[112:115]
    buffer_store_dwordx4 v[72:75], v1, s[32:35], s52 offen offset:2048 sc1
    v_mfma_f32_16x16x32_bf16 a[116:119], a[56:59], a[220:223], a[116:119]
    v_mfma_f32_16x16x32_bf16 v[248:251], a[60:63], a[208:211], v[248:251]
    v_mfma_f32_16x16x32_bf16 v[252:255], a[60:63], a[212:215], v[252:255]
    v_mfma_f32_16x16x32_bf16 a[120:123], a[60:63], a[216:219], a[120:123]
    v_mfma_f32_16x16x32_bf16 a[124:127], a[60:63], a[220:223], a[124:127]
    s_waitcnt vmcnt(15) lgkmcnt(0)
    v_mfma_f32_16x16x32_bf16 v[192:195], a[0:3], a[224:227], v[192:195]
    ds_read_b64_tr_b16 a[32:33], v42 offset:24576
    ds_read_b64_tr_b16 a[34:35], v42 offset:25600
    v_mfma_f32_16x16x32_bf16 v[196:199], a[0:3], a[228:231], v[196:199]
    buffer_load_dwordx4 a[208:211], v36, s[8:11], s62 offen offset:0 sc1
    v_mfma_f32_16x16x32_bf16 a[64:67], a[0:3], a[232:235], a[64:67]
    ds_read_b64_tr_b16 a[36:37], v43 offset:24576
    v_mfma_f32_16x16x32_bf16 a[68:71], a[0:3], a[236:239], a[68:71]
    ds_read_b64_tr_b16 a[38:39], v43 offset:25600
    v_mfma_f32_16x16x32_bf16 v[200:203], a[4:7], a[224:227], v[200:203]
    ds_read_b64_tr_b16 a[40:41], v44 offset:24576
    v_mfma_f32_16x16x32_bf16 v[204:207], a[4:7], a[228:231], v[204:207]
    v_mfma_f32_16x16x32_bf16 a[72:75], a[4:7], a[232:235], a[72:75]
    buffer_load_dwordx4 a[212:215], v36, s[8:11], s62 offen offset:1024 sc1
    ds_read_b64_tr_b16 a[42:43], v44 offset:25600
    v_mfma_f32_16x16x32_bf16 a[76:79], a[4:7], a[236:239], a[76:79]
    ds_read_b64_tr_b16 a[44:45], v45 offset:24576
    v_mfma_f32_16x16x32_bf16 v[208:211], a[8:11], a[224:227], v[208:211]
    v_mfma_f32_16x16x32_bf16 v[212:215], a[8:11], a[228:231], v[212:215]
    ds_read_b64_tr_b16 a[46:47], v45 offset:25600
    v_mfma_f32_16x16x32_bf16 a[80:83], a[8:11], a[232:235], a[80:83]
    ds_read_b64_tr_b16 a[48:49], v46 offset:24576
    v_mfma_f32_16x16x32_bf16 a[84:87], a[8:11], a[236:239], a[84:87]
    ds_read_b64_tr_b16 a[50:51], v46 offset:25600
    v_mfma_f32_16x16x32_bf16 v[216:219], a[12:15], a[224:227], v[216:219]
    buffer_load_dwordx4 a[216:219], v37, s[8:11], s62 offen offset:0 sc1
    v_mfma_f32_16x16x32_bf16 v[220:223], a[12:15], a[228:231], v[220:223]
    ds_read_b64_tr_b16 a[52:53], v47 offset:24576
    v_mfma_f32_16x16x32_bf16 a[88:91], a[12:15], a[232:235], a[88:91]
    ds_read_b64_tr_b16 a[54:55], v47 offset:25600
    v_mfma_f32_16x16x32_bf16 a[92:95], a[12:15], a[236:239], a[92:95]
    ds_read_b64_tr_b16 a[56:57], v48 offset:24576
    v_mfma_f32_16x16x32_bf16 v[224:227], a[16:19], a[224:227], v[224:227]
    v_mfma_f32_16x16x32_bf16 v[228:231], a[16:19], a[228:231], v[228:231]
    buffer_load_dwordx4 a[220:223], v37, s[8:11], s62 offen offset:1024 sc1
    ds_read_b64_tr_b16 a[58:59], v48 offset:25600
    v_mfma_f32_16x16x32_bf16 a[96:99], a[16:19], a[232:235], a[96:99]
    ds_read_b64_tr_b16 a[60:61], v49 offset:24576
    v_mfma_f32_16x16x32_bf16 a[100:103], a[16:19], a[236:239], a[100:103]
    v_mfma_f32_16x16x32_bf16 v[232:235], a[20:23], a[224:227], v[232:235]
    ds_read_b64_tr_b16 a[62:63], v49 offset:25600
    v_mfma_f32_16x16x32_bf16 v[236:239], a[20:23], a[228:231], v[236:239]
    v_mfma_f32_16x16x32_bf16 a[104:107], a[20:23], a[232:235], a[104:107]
    s_add_u32 s62, s62, 0x20000
    v_mfma_f32_16x16x32_bf16 a[108:111], a[20:23], a[236:239], a[108:111]
    s_add_u32 s52, s47, 0
    v_mfma_f32_16x16x32_bf16 v[240:243], a[24:27], a[224:227], v[240:243]
    buffer_store_dwordx4 v[76:79], v1, s[32:35], s52 offen offset:3072 sc1
    v_mfma_f32_16x16x32_bf16 v[244:247], a[24:27], a[228:231], v[244:247]
    v_mfma_f32_16x16x32_bf16 a[112:115], a[24:27], a[232:235], a[112:115]
    v_mfma_f32_16x16x32_bf16 a[116:119], a[24:27], a[236:239], a[116:119]
    v_mfma_f32_16x16x32_bf16 v[248:251], a[28:31], a[224:227], v[248:251]
    v_mfma_f32_16x16x32_bf16 v[252:255], a[28:31], a[228:231], v[252:255]
    v_mfma_f32_16x16x32_bf16 a[120:123], a[28:31], a[232:235], a[120:123]
    v_mfma_f32_16x16x32_bf16 a[124:127], a[28:31], a[236:239], a[124:127]
    s_waitcnt vmcnt(11) lgkmcnt(0)
    s_barrier
    v_mfma_f32_16x16x32_bf16 v[192:195], a[32:35], a[240:243], v[192:195]
    ds_read_b64_tr_b16 a[0:1], v42 offset:32768
    ds_read_b64_tr_b16 a[2:3], v42 offset:33792
    v_mfma_f32_16x16x32_bf16 v[196:199], a[32:35], a[244:247], v[196:199]
    s_add_u32 m0, s60, 147456
    v_mfma_f32_16x16x32_bf16 a[64:67], a[32:35], a[248:251], a[64:67]
    buffer_load_dwordx4 v38, s[12:15], s61 offen offset:0 lds
    ds_read_b64_tr_b16 a[4:5], v43 offset:32768
    v_mfma_f32_16x16x32_bf16 a[68:71], a[32:35], a[252:255], a[68:71]
    ds_read_b64_tr_b16 a[6:7], v43 offset:33792
    v_mfma_f32_16x16x32_bf16 v[200:203], a[36:39], a[240:243], v[200:203]
    buffer_load_dwordx4 v39, s[12:15], s61 offen offset:1024 lds
    ds_read_b64_tr_b16 a[8:9], v44 offset:32768
    v_mfma_f32_16x16x32_bf16 v[204:207], a[36:39], a[244:247], v[204:207]
    v_mfma_f32_16x16x32_bf16 a[72:75], a[36:39], a[248:251], a[72:75]
    buffer_load_dwordx4 v40, s[12:15], s61 offen offset:2048 lds
    ds_read_b64_tr_b16 a[10:11], v44 offset:33792
    v_mfma_f32_16x16x32_bf16 a[76:79], a[36:39], a[252:255], a[76:79]
    ds_read_b64_tr_b16 a[12:13], v45 offset:32768
    v_mfma_f32_16x16x32_bf16 v[208:211], a[40:43], a[240:243], v[208:211]
    v_mfma_f32_16x16x32_bf16 v[212:215], a[40:43], a[244:247], v[212:215]
    buffer_load_dwordx4 v41, s[12:15], s61 offen offset:3072 lds
    ds_read_b64_tr_b16 a[14:15], v45 offset:33792
    v_mfma_f32_16x16x32_bf16 a[80:83], a[40:43], a[248:251], a[80:83]
    ds_read_b64_tr_b16 a[16:17], v46 offset:32768
    v_mfma_f32_16x16x32_bf16 a[84:87], a[40:43], a[252:255], a[84:87]
    s_add_u32 s61, s61, 0x80000
    ds_read_b64_tr_b16 a[18:19], v46 offset:33792
    v_mfma_f32_16x16x32_bf16 v[216:219], a[44:47], a[240:243], v[216:219]
    buffer_load_dwordx4 a[224:227], v36, s[8:11], s62 offen offset:0 sc1
    v_mfma_f32_16x16x32_bf16 v[220:223], a[44:47], a[244:247], v[220:223]
    ds_read_b64_tr_b16 a[20:21], v47 offset:32768
    v_mfma_f32_16x16x32_bf16 a[88:91], a[44:47], a[248:251], a[88:91]
    buffer_load_dwordx4 a[228:231], v36, s[8:11], s62 offen offset:1024 sc1
    ds_read_b64_tr_b16 a[22:23], v47 offset:33792
    v_mfma_f32_16x16x32_bf16 a[92:95], a[44:47], a[252:255], a[92:95]
    ds_read_b64_tr_b16 a[24:25], v48 offset:32768
    v_mfma_f32_16x16x32_bf16 v[224:227], a[48:51], a[240:243], v[224:227]
    v_mfma_f32_16x16x32_bf16 v[228:231], a[48:51], a[244:247], v[228:231]
    buffer_load_dwordx4 a[232:235], v37, s[8:11], s62 offen offset:0 sc1
    ds_read_b64_tr_b16 a[26:27], v48 offset:33792
    v_mfma_f32_16x16x32_bf16 a[96:99], a[48:51], a[248:251], a[96:99]
    ds_read_b64_tr_b16 a[28:29], v49 offset:32768
    v_mfma_f32_16x16x32_bf16 a[100:103], a[48:51], a[252:255], a[100:103]
    v_mfma_f32_16x16x32_bf16 v[232:235], a[52:55], a[240:243], v[232:235]
    buffer_load_dwordx4 a[236:239], v37, s[8:11], s62 offen offset:1024 sc1
    ds_read_b64_tr_b16 a[30:31], v49 offset:33792
    v_mfma_f32_16x16x32_bf16 v[236:239], a[52:55], a[244:247], v[236:239]
    v_mfma_f32_16x16x32_bf16 a[104:107], a[52:55], a[248:251], a[104:107]
    s_add_u32 s62, s62, 0x20000
    v_mfma_f32_16x16x32_bf16 a[108:111], a[52:55], a[252:255], a[108:111]
    s_add_u32 s52, s47, 4096
    v_mfma_f32_16x16x32_bf16 v[240:243], a[56:59], a[240:243], v[240:243]
    buffer_store_dwordx4 v[80:83], v1, s[32:35], s52 offen offset:0 sc1
    v_mfma_f32_16x16x32_bf16 v[244:247], a[56:59], a[244:247], v[244:247]
    s_add_u32 s52, s47, 4096
    v_mfma_f32_16x16x32_bf16 a[112:115], a[56:59], a[248:251], a[112:115]
    buffer_store_dwordx4 v[84:87], v1, s[32:35], s52 offen offset:1024 sc1
    v_mfma_f32_16x16x32_bf16 a[116:119], a[56:59], a[252:255], a[116:119]
    v_mfma_f32_16x16x32_bf16 v[248:251], a[60:63], a[240:243], v[248:251]
    v_mfma_f32_16x16x32_bf16 v[252:255], a[60:63], a[244:247], v[252:255]
    v_mfma_f32_16x16x32_bf16 a[120:123], a[60:63], a[248:251], a[120:123]
    v_mfma_f32_16x16x32_bf16 a[124:127], a[60:63], a[252:255], a[124:127]
    s_waitcnt vmcnt(17) lgkmcnt(0)
    v_mfma_f32_16x16x32_bf16 v[192:195], a[0:3], a[192:195], v[192:195]
    ds_read_b64_tr_b16 a[32:33], v42 offset:40960
    ds_read_b64_tr_b16 a[34:35], v42 offset:41984
    v_mfma_f32_16x16x32_bf16 v[196:199], a[0:3], a[196:199], v[196:199]
    buffer_load_dwordx4 a[240:243], v36, s[8:11], s62 offen offset:0 sc1
    v_mfma_f32_16x16x32_bf16 a[64:67], a[0:3], a[200:203], a[64:67]
    ds_read_b64_tr_b16 a[36:37], v43 offset:40960
    v_mfma_f32_16x16x32_bf16 a[68:71], a[0:3], a[204:207], a[68:71]
    ds_read_b64_tr_b16 a[38:39], v43 offset:41984
    v_mfma_f32_16x16x32_bf16 v[200:203], a[4:7], a[192:195], v[200:203]
    ds_read_b64_tr_b16 a[40:41], v44 offset:40960
    v_mfma_f32_16x16x32_bf16 v[204:207], a[4:7], a[196:199], v[204:207]
    buffer_load_dwordx4 a[244:247], v36, s[8:11], s62 offen offset:1024 sc1
    v_mfma_f32_16x16x32_bf16 a[72:75], a[4:7], a[200:203], a[72:75]
    ds_read_b64_tr_b16 a[42:43], v44 offset:41984
    v_mfma_f32_16x16x32_bf16 a[76:79], a[4:7], a[204:207], a[76:79]
    ds_read_b64_tr_b16 a[44:45], v45 offset:40960
    v_mfma_f32_16x16x32_bf16 v[208:211], a[8:11], a[192:195], v[208:211]
    v_mfma_f32_16x16x32_bf16 v[212:215], a[8:11], a[196:199], v[212:215]
    ds_read_b64_tr_b16 a[46:47], v45 offset:41984
    v_mfma_f32_16x16x32_bf16 a[80:83], a[8:11], a[200:203], a[80:83]
    buffer_load_dwordx4 a[248:251], v37, s[8:11], s62 offen offset:0 sc1
    ds_read_b64_tr_b16 a[48:49], v46 offset:40960
    v_mfma_f32_16x16x32_bf16 a[84:87], a[8:11], a[204:207], a[84:87]
    ds_read_b64_tr_b16 a[50:51], v46 offset:41984
    v_mfma_f32_16x16x32_bf16 v[216:219], a[12:15], a[192:195], v[216:219]
    v_mfma_f32_16x16x32_bf16 v[220:223], a[12:15], a[196:199], v[220:223]
    ds_read_b64_tr_b16 a[52:53], v47 offset:40960
    v_mfma_f32_16x16x32_bf16 a[88:91], a[12:15], a[200:203], a[88:91]
    buffer_load_dwordx4 a[252:255], v37, s[8:11], s62 offen offset:1024 sc1
    ds_read_b64_tr_b16 a[54:55], v47 offset:41984
    v_mfma_f32_16x16x32_bf16 a[92:95], a[12:15], a[204:207], a[92:95]
    ds_read_b64_tr_b16 a[56:57], v48 offset:40960
    v_mfma_f32_16x16x32_bf16 v[224:227], a[16:19], a[192:195], v[224:227]
    v_mfma_f32_16x16x32_bf16 v[228:231], a[16:19], a[196:199], v[228:231]
    ds_read_b64_tr_b16 a[58:59], v48 offset:41984
    v_mfma_f32_16x16x32_bf16 a[96:99], a[16:19], a[200:203], a[96:99]
    s_add_u32 s62, s62, 0x20000
    ds_read_b64_tr_b16 a[60:61], v49 offset:40960
    v_mfma_f32_16x16x32_bf16 a[100:103], a[16:19], a[204:207], a[100:103]
    s_add_u32 s52, s47, 4096
    v_mfma_f32_16x16x32_bf16 v[232:235], a[20:23], a[192:195], v[232:235]
    buffer_store_dwordx4 v[88:91], v1, s[32:35], s52 offen offset:2048 sc1
    ds_read_b64_tr_b16 a[62:63], v49 offset:41984
    v_mfma_f32_16x16x32_bf16 v[236:239], a[20:23], a[196:199], v[236:239]
    s_add_u32 s52, s47, 4096
    v_mfma_f32_16x16x32_bf16 a[104:107], a[20:23], a[200:203], a[104:107]
    v_mfma_f32_16x16x32_bf16 a[108:111], a[20:23], a[204:207], a[108:111]
    buffer_store_dwordx4 v[92:95], v1, s[32:35], s52 offen offset:3072 sc1
    v_mfma_f32_16x16x32_bf16 v[240:243], a[24:27], a[192:195], v[240:243]
    v_mfma_f32_16x16x32_bf16 v[244:247], a[24:27], a[196:199], v[244:247]
    v_mfma_f32_16x16x32_bf16 a[112:115], a[24:27], a[200:203], a[112:115]
    v_mfma_f32_16x16x32_bf16 a[116:119], a[24:27], a[204:207], a[116:119]
    v_mfma_f32_16x16x32_bf16 v[248:251], a[28:31], a[192:195], v[248:251]
    v_mfma_f32_16x16x32_bf16 v[252:255], a[28:31], a[196:199], v[252:255]
    v_mfma_f32_16x16x32_bf16 a[120:123], a[28:31], a[200:203], a[120:123]
    v_mfma_f32_16x16x32_bf16 a[124:127], a[28:31], a[204:207], a[124:127]
    s_waitcnt vmcnt(12) lgkmcnt(0)
    s_barrier
    v_mfma_f32_16x16x32_bf16 v[192:195], a[32:35], a[208:211], v[192:195]
    ds_read_b64_tr_b16 a[0:1], v42 offset:49152
    ds_read_b64_tr_b16 a[2:3], v42 offset:50176
    v_mfma_f32_16x16x32_bf16 v[196:199], a[32:35], a[212:215], v[196:199]
    s_add_u32 m0, s60, 98304
    v_mfma_f32_16x16x32_bf16 a[64:67], a[32:35], a[216:219], a[64:67]
    buffer_load_dwordx4 v38, s[12:15], s61 offen offset:0 lds
    ds_read_b64_tr_b16 a[4:5], v43 offset:49152
    v_mfma_f32_16x16x32_bf16 a[68:71], a[32:35], a[220:223], a[68:71]
    ds_read_b64_tr_b16 a[6:7], v43 offset:50176
    v_mfma_f32_16x16x32_bf16 v[200:203], a[36:39], a[208:211], v[200:203]
    buffer_load_dwordx4 v39, s[12:15], s61 offen offset:1024 lds
    ds_read_b64_tr_b16 a[8:9], v44 offset:49152
    v_mfma_f32_16x16x32_bf16 v[204:207], a[36:39], a[212:215], v[204:207]
    v_mfma_f32_16x16x32_bf16 a[72:75], a[36:39], a[216:219], a[72:75]
    ds_read_b64_tr_b16 a[10:11], v44 offset:50176
    v_mfma_f32_16x16x32_bf16 a[76:79], a[36:39], a[220:223], a[76:79]
    buffer_load_dwordx4 v40, s[12:15], s61 offen offset:2048 lds
    ds_read_b64_tr_b16 a[12:13], v45 offset:49152
    v_mfma_f32_16x16x32_bf16 v[208:211], a[40:43], a[208:211], v[208:211]
    v_mfma_f32_16x16x32_bf16 v[212:215], a[40:43], a[212:215], v[212:215]
    ds_read_b64_tr_b16 a[14:15], v45 offset:50176
    v_mfma_f32_16x16x32_bf16 a[80:83], a[40:43], a[216:219], a[80:83]
    buffer_load_dwordx4 v41, s[12:15], s61 offen offset:3072 lds
    ds_read_b64_tr_b16 a[16:17], v46 offset:49152
    v_mfma_f32_16x16x32_bf16 a[84:87], a[40:43], a[220:223], a[84:87]
    ds_read_b64_tr_b16 a[18:19], v46 offset:50176
    v_mfma_f32_16x16x32_bf16 v[216:219], a[44:47], a[208:211], v[216:219]
    s_add_u32 s61, s61, 0x80000
    v_mfma_f32_16x16x32_bf16 v[220:223], a[44:47], a[212:215], v[220:223]
    buffer_load_dwordx4 a[192:195], v36, s[8:11], s62 offen offset:0 sc1
    ds_read_b64_tr_b16 a[20:21], v47 offset:49152
    v_mfma_f32_16x16x32_bf16 a[88:91], a[44:47], a[216:219], a[88:91]
    ds_read_b64_tr_b16 a[22:23], v47 offset:50176
    v_mfma_f32_16x16x32_bf16 a[92:95], a[44:47], a[220:223], a[92:95]
    ds_read_b64_tr_b16 a[24:25], v48 offset:49152
    v_mfma_f32_16x16x32_bf16 v[224:227], a[48:51], a[208:211], v[224:227]
    buffer_load_dwordx4 a[196:199], v36, s[8:11], s62 offen offset:1024 sc1
    v_mfma_f32_16x16x32_bf16 v[228:231], a[48:51], a[212:215], v[228:231]
    ds_read_b64_tr_b16 a[26:27], v48 offset:50176
    v_mfma_f32_16x16x32_bf16 a[96:99], a[48:51], a[216:219], a[96:99]
    ds_read_b64_tr_b16 a[28:29], v49 offset:49152
    v_mfma_f32_16x16x32_bf16 a[100:103], a[48:51], a[220:223], a[100:103]
    buffer_load_dwordx4 a[200:203], v37, s[8:11], s62 offen offset:0 sc1
    v_mfma_f32_16x16x32_bf16 v[232:235], a[52:55], a[208:211], v[232:235]
    ds_read_b64_tr_b16 a[30:31], v49 offset:50176
    v_mfma_f32_16x16x32_bf16 v[236:239], a[52:55], a[212:215], v[236:239]
    v_mfma_f32_16x16x32_bf16 a[104:107], a[52:55], a[216:219], a[104:107]
    buffer_load_dwordx4 a[204:207], v37, s[8:11], s62 offen offset:1024 sc1
    v_mfma_f32_16x16x32_bf16 a[108:111], a[52:55], a[220:223], a[108:111]
    v_mfma_f32_16x16x32_bf16 v[240:243], a[56:59], a[208:211], v[240:243]
    s_add_u32 s62, s62, 0x20000
    v_mfma_f32_16x16x32_bf16 v[244:247], a[56:59], a[212:215], v[244:247]
    s_add_u32 s52, s47, 8192
    v_mfma_f32_16x16x32_bf16 a[112:115], a[56:59], a[216:219], a[112:115]
    buffer_store_dwordx4 v[96:99], v1, s[32:35], s52 offen offset:0 sc1
    v_mfma_f32_16x16x32_bf16 a[116:119], a[56:59], a[220:223], a[116:119]
    v_mfma_f32_16x16x32_bf16 v[248:251], a[60:63], a[208:211], v[248:251]
    v_mfma_f32_16x16x32_bf16 v[252:255], a[60:63], a[212:215], v[252:255]
    v_mfma_f32_16x16x32_bf16 a[120:123], a[60:63], a[216:219], a[120:123]
    v_mfma_f32_16x16x32_bf16 a[124:127], a[60:63], a[220:223], a[124:127]
    s_waitcnt vmcnt(17) lgkmcnt(0)
    v_mfma_f32_16x16x32_bf16 v[192:195], a[0:3], a[224:227], v[192:195]
    ds_read_b64_tr_b16 a[32:33], v42 offset:57344
    ds_read_b64_tr_b16 a[34:35], v42 offset:58368
    v_mfma_f32_16x16x32_bf16 v[196:199], a[0:3], a[228:231], v[196:199]
    buffer_load_dwordx4 a[208:211], v36, s[8:11], s62 offen offset:0 sc1
    v_mfma_f32_16x16x32_bf16 a[64:67], a[0:3], a[232:235], a[64:67]
    ds_read_b64_tr_b16 a[36:37], v43 offset:57344
    v_mfma_f32_16x16x32_bf16 a[68:71], a[0:3], a[236:239], a[68:71]
    ds_read_b64_tr_b16 a[38:39], v43 offset:58368
    v_mfma_f32_16x16x32_bf16 v[200:203], a[4:7], a[224:227], v[200:203]
    ds_read_b64_tr_b16 a[40:41], v44 offset:57344
    v_mfma_f32_16x16x32_bf16 v[204:207], a[4:7], a[228:231], v[204:207]
    buffer_load_dwordx4 a[212:215], v36, s[8:11], s62 offen offset:1024 sc1
    v_mfma_f32_16x16x32_bf16 a[72:75], a[4:7], a[232:235], a[72:75]
    ds_read_b64_tr_b16 a[42:43], v44 offset:58368
    v_mfma_f32_16x16x32_bf16 a[76:79], a[4:7], a[236:239], a[76:79]
    ds_read_b64_tr_b16 a[44:45], v45 offset:57344
    v_mfma_f32_16x16x32_bf16 v[208:211], a[8:11], a[224:227], v[208:211]
    v_mfma_f32_16x16x32_bf16 v[212:215], a[8:11], a[228:231], v[212:215]
    ds_read_b64_tr_b16 a[46:47], v45 offset:58368
    v_mfma_f32_16x16x32_bf16 a[80:83], a[8:11], a[232:235], a[80:83]
    buffer_load_dwordx4 a[216:219], v37, s[8:11], s62 offen offset:0 sc1
    ds_read_b64_tr_b16 a[48:49], v46 offset:57344
    v_mfma_f32_16x16x32_bf16 a[84:87], a[8:11], a[236:239], a[84:87]
    ds_read_b64_tr_b16 a[50:51], v46 offset:58368
    v_mfma_f32_16x16x32_bf16 v[216:219], a[12:15], a[224:227], v[216:219]
    v_mfma_f32_16x16x32_bf16 v[220:223], a[12:15], a[228:231], v[220:223]
    ds_read_b64_tr_b16 a[52:53], v47 offset:57344
    v_mfma_f32_16x16x32_bf16 a[88:91], a[12:15], a[232:235], a[88:91]
    buffer_load_dwordx4 a[220:223], v37, s[8:11], s62 offen offset:1024 sc1
    ds_read_b64_tr_b16 a[54:55], v47 offset:58368
    v_mfma_f32_16x16x32_bf16 a[92:95], a[12:15], a[236:239], a[92:95]
    ds_read_b64_tr_b16 a[56:57], v48 offset:57344
    v_mfma_f32_16x16x32_bf16 v[224:227], a[16:19], a[224:227], v[224:227]
    v_mfma_f32_16x16x32_bf16 v[228:231], a[16:19], a[228:231], v[228:231]
    ds_read_b64_tr_b16 a[58:59], v48 offset:58368
    v_mfma_f32_16x16x32_bf16 a[96:99], a[16:19], a[232:235], a[96:99]
    s_add_u32 s62, s62, 0x20000
    ds_read_b64_tr_b16 a[60:61], v49 offset:57344
    v_mfma_f32_16x16x32_bf16 a[100:103], a[16:19], a[236:239], a[100:103]
    s_add_u32 s52, s47, 8192
    v_mfma_f32_16x16x32_bf16 v[232:235], a[20:23], a[224:227], v[232:235]
    buffer_store_dwordx4 v[100:103], v1, s[32:35], s52 offen offset:1024 sc1
    ds_read_b64_tr_b16 a[62:63], v49 offset:58368
    v_mfma_f32_16x16x32_bf16 v[236:239], a[20:23], a[228:231], v[236:239]
    s_add_u32 s52, s47, 8192
    v_mfma_f32_16x16x32_bf16 a[104:107], a[20:23], a[232:235], a[104:107]
    v_mfma_f32_16x16x32_bf16 a[108:111], a[20:23], a[236:239], a[108:111]
    buffer_store_dwordx4 v[104:107], v1, s[32:35], s52 offen offset:2048 sc1
    v_mfma_f32_16x16x32_bf16 v[240:243], a[24:27], a[224:227], v[240:243]
    v_mfma_f32_16x16x32_bf16 v[244:247], a[24:27], a[228:231], v[244:247]
    v_mfma_f32_16x16x32_bf16 a[112:115], a[24:27], a[232:235], a[112:115]
    v_mfma_f32_16x16x32_bf16 a[116:119], a[24:27], a[236:239], a[116:119]
    v_mfma_f32_16x16x32_bf16 v[248:251], a[28:31], a[224:227], v[248:251]
    v_mfma_f32_16x16x32_bf16 v[252:255], a[28:31], a[228:231], v[252:255]
    v_mfma_f32_16x16x32_bf16 a[120:123], a[28:31], a[232:235], a[120:123]
    v_mfma_f32_16x16x32_bf16 a[124:127], a[28:31], a[236:239], a[124:127]
    s_waitcnt vmcnt(11) lgkmcnt(0)
    s_barrier
    v_mfma_f32_16x16x32_bf16 v[192:195], a[32:35], a[240:243], v[192:195]
    ds_read_b64_tr_b16 a[0:1], v42 offset:0
    ds_read_b64_tr_b16 a[2:3], v42 offset:1024
    v_mfma_f32_16x16x32_bf16 v[196:199], a[32:35], a[244:247], v[196:199]
    s_add_u32 m0, s60, 114688
    v_mfma_f32_16x16x32_bf16 a[64:67], a[32:35], a[248:251], a[64:67]
    buffer_load_dwordx4 v38, s[12:15], s61 offen offset:0 lds
    ds_read_b64_tr_b16 a[4:5], v43 offset:0
    v_mfma_f32_16x16x32_bf16 a[68:71], a[32:35], a[252:255], a[68:71]
    ds_read_b64_tr_b16 a[6:7], v43 offset:1024
    v_mfma_f32_16x16x32_bf16 v[200:203], a[36:39], a[240:243], v[200:203]
    buffer_load_dwordx4 v39, s[12:15], s61 offen offset:1024 lds
    ds_read_b64_tr_b16 a[8:9], v44 offset:0
    v_mfma_f32_16x16x32_bf16 v[204:207], a[36:39], a[244:247], v[204:207]
    v_mfma_f32_16x16x32_bf16 a[72:75], a[36:39], a[248:251], a[72:75]
    ds_read_b64_tr_b16 a[10:11], v44 offset:1024
    v_mfma_f32_16x16x32_bf16 a[76:79], a[36:39], a[252:255], a[76:79]
    buffer_load_dwordx4 v40, s[12:15], s61 offen offset:2048 lds
    ds_read_b64_tr_b16 a[12:13], v45 offset:0
    v_mfma_f32_16x16x32_bf16 v[208:211], a[40:43], a[240:243], v[208:211]
    v_mfma_f32_16x16x32_bf16 v[212:215], a[40:43], a[244:247], v[212:215]
    ds_read_b64_tr_b16 a[14:15], v45 offset:1024
    v_mfma_f32_16x16x32_bf16 a[80:83], a[40:43], a[248:251], a[80:83]
    buffer_load_dwordx4 v41, s[12:15], s61 offen offset:3072 lds
    ds_read_b64_tr_b16 a[16:17], v46 offset:0
    v_mfma_f32_16x16x32_bf16 a[84:87], a[40:43], a[252:255], a[84:87]
    ds_read_b64_tr_b16 a[18:19], v46 offset:1024
    v_mfma_f32_16x16x32_bf16 v[216:219], a[44:47], a[240:243], v[216:219]
    s_add_u32 s61, s61, 0x80000
    v_mfma_f32_16x16x32_bf16 v[220:223], a[44:47], a[244:247], v[220:223]
    buffer_load_dwordx4 a[224:227], v36, s[8:11], s62 offen offset:0 sc1
    ds_read_b64_tr_b16 a[20:21], v47 offset:0
    v_mfma_f32_16x16x32_bf16 a[88:91], a[44:47], a[248:251], a[88:91]
    ds_read_b64_tr_b16 a[22:23], v47 offset:1024
    v_mfma_f32_16x16x32_bf16 a[92:95], a[44:47], a[252:255], a[92:95]
    ds_read_b64_tr_b16 a[24:25], v48 offset:0
    v_mfma_f32_16x16x32_bf16 v[224:227], a[48:51], a[240:243], v[224:227]
    buffer_load_dwordx4 a[228:231], v36, s[8:11], s62 offen offset:1024 sc1
    v_mfma_f32_16x16x32_bf16 v[228:231], a[48:51], a[244:247], v[228:231]
    ds_read_b64_tr_b16 a[26:27], v48 offset:1024
    v_mfma_f32_16x16x32_bf16 a[96:99], a[48:51], a[248:251], a[96:99]
    ds_read_b64_tr_b16 a[28:29], v49 offset:0
    v_mfma_f32_16x16x32_bf16 a[100:103], a[48:51], a[252:255], a[100:103]
    buffer_load_dwordx4 a[232:235], v37, s[8:11], s62 offen offset:0 sc1
    v_mfma_f32_16x16x32_bf16 v[232:235], a[52:55], a[240:243], v[232:235]
    ds_read_b64_tr_b16 a[30:31], v49 offset:1024
    v_mfma_f32_16x16x32_bf16 v[236:239], a[52:55], a[244:247], v[236:239]
    v_mfma_f32_16x16x32_bf16 a[104:107], a[52:55], a[248:251], a[104:107]
    buffer_load_dwordx4 a[236:239], v37, s[8:11], s62 offen offset:1024 sc1
    v_mfma_f32_16x16x32_bf16 a[108:111], a[52:55], a[252:255], a[108:111]
    v_mfma_f32_16x16x32_bf16 v[240:243], a[56:59], a[240:243], v[240:243]
    s_add_u32 s62, s62, 0x20000
    v_mfma_f32_16x16x32_bf16 v[244:247], a[56:59], a[244:247], v[244:247]
    s_add_u32 s52, s47, 8192
    v_mfma_f32_16x16x32_bf16 a[112:115], a[56:59], a[248:251], a[112:115]
    buffer_store_dwordx4 v[108:111], v1, s[32:35], s52 offen offset:3072 sc1
    v_mfma_f32_16x16x32_bf16 a[116:119], a[56:59], a[252:255], a[116:119]
    v_mfma_f32_16x16x32_bf16 v[248:251], a[60:63], a[240:243], v[248:251]
    v_mfma_f32_16x16x32_bf16 v[252:255], a[60:63], a[244:247], v[252:255]
    v_mfma_f32_16x16x32_bf16 a[120:123], a[60:63], a[248:251], a[120:123]
    v_mfma_f32_16x16x32_bf16 a[124:127], a[60:63], a[252:255], a[124:127]
    s_waitcnt vmcnt(16) lgkmcnt(0)
    v_mfma_f32_16x16x32_bf16 v[192:195], a[0:3], a[192:195], v[192:195]
    ds_read_b64_tr_b16 a[32:33], v42 offset:8192
    ds_read_b64_tr_b16 a[34:35], v42 offset:9216
    v_mfma_f32_16x16x32_bf16 v[196:199], a[0:3], a[196:199], v[196:199]
    buffer_load_dwordx4 a[240:243], v36, s[8:11], s62 offen offset:0 sc1
    v_mfma_f32_16x16x32_bf16 a[64:67], a[0:3], a[200:203], a[64:67]
    ds_read_b64_tr_b16 a[36:37], v43 offset:8192
    v_mfma_f32_16x16x32_bf16 a[68:71], a[0:3], a[204:207], a[68:71]
    ds_read_b64_tr_b16 a[38:39], v43 offset:9216
    v_mfma_f32_16x16x32_bf16 v[200:203], a[4:7], a[192:195], v[200:203]
    ds_read_b64_tr_b16 a[40:41], v44 offset:8192
    v_mfma_f32_16x16x32_bf16 v[204:207], a[4:7], a[196:199], v[204:207]
    buffer_load_dwordx4 a[244:247], v36, s[8:11], s62 offen offset:1024 sc1
    v_mfma_f32_16x16x32_bf16 a[72:75], a[4:7], a[200:203], a[72:75]
    ds_read_b64_tr_b16 a[42:43], v44 offset:9216
    v_mfma_f32_16x16x32_bf16 a[76:79], a[4:7], a[204:207], a[76:79]
    ds_read_b64_tr_b16 a[44:45], v45 offset:8192
    v_mfma_f32_16x16x32_bf16 v[208:211], a[8:11], a[192:195], v[208:211]
    v_mfma_f32_16x16x32_bf16 v[212:215], a[8:11], a[196:199], v[212:215]
    ds_read_b64_tr_b16 a[46:47], v45 offset:9216
    v_mfma_f32_16x16x32_bf16 a[80:83], a[8:11], a[200:203], a[80:83]
    buffer_load_dwordx4 a[248:251], v37, s[8:11], s62 offen offset:0 sc1
    ds_read_b64_tr_b16 a[48:49], v46 offset:8192
    v_mfma_f32_16x16x32_bf16 a[84:87], a[8:11], a[204:207], a[84:87]
    ds_read_b64_tr_b16 a[50:51], v46 offset:9216
    v_mfma_f32_16x16x32_bf16 v[216:219], a[12:15], a[192:195], v[216:219]
    v_mfma_f32_16x16x32_bf16 v[220:223], a[12:15], a[196:199], v[220:223]
    ds_read_b64_tr_b16 a[52:53], v47 offset:8192
    v_mfma_f32_16x16x32_bf16 a[88:91], a[12:15], a[200:203], a[88:91]
    buffer_load_dwordx4 a[252:255], v37, s[8:11], s62 offen offset:1024 sc1
    ds_read_b64_tr_b16 a[54:55], v47 offset:9216
    v_mfma_f32_16x16x32_bf16 a[92:95], a[12:15], a[204:207], a[92:95]
    ds_read_b64_tr_b16 a[56:57], v48 offset:8192
    v_mfma_f32_16x16x32_bf16 v[224:227], a[16:19], a[192:195], v[224:227]
    v_mfma_f32_16x16x32_bf16 v[228:231], a[16:19], a[196:199], v[228:231]
    ds_read_b64_tr_b16 a[58:59], v48 offset:9216
    v_mfma_f32_16x16x32_bf16 a[96:99], a[16:19], a[200:203], a[96:99]
    s_add_u32 s62, s62, 0x20000
    ds_read_b64_tr_b16 a[60:61], v49 offset:8192
    v_mfma_f32_16x16x32_bf16 a[100:103], a[16:19], a[204:207], a[100:103]
    s_add_u32 s52, s47, 12288
    v_mfma_f32_16x16x32_bf16 v[232:235], a[20:23], a[192:195], v[232:235]
    buffer_store_dwordx4 v[112:115], v1, s[32:35], s52 offen offset:0 sc1
    ds_read_b64_tr_b16 a[62:63], v49 offset:9216
    v_mfma_f32_16x16x32_bf16 v[236:239], a[20:23], a[196:199], v[236:239]
    s_add_u32 s52, s47, 12288
    v_mfma_f32_16x16x32_bf16 a[104:107], a[20:23], a[200:203], a[104:107]
    v_mfma_f32_16x16x32_bf16 a[108:111], a[20:23], a[204:207], a[108:111]
    buffer_store_dwordx4 v[116:119], v1, s[32:35], s52 offen offset:1024 sc1
    v_mfma_f32_16x16x32_bf16 v[240:243], a[24:27], a[192:195], v[240:243]
    v_mfma_f32_16x16x32_bf16 v[244:247], a[24:27], a[196:199], v[244:247]
    v_mfma_f32_16x16x32_bf16 a[112:115], a[24:27], a[200:203], a[112:115]
    v_mfma_f32_16x16x32_bf16 a[116:119], a[24:27], a[204:207], a[116:119]
    v_mfma_f32_16x16x32_bf16 v[248:251], a[28:31], a[192:195], v[248:251]
    v_mfma_f32_16x16x32_bf16 v[252:255], a[28:31], a[196:199], v[252:255]
    v_mfma_f32_16x16x32_bf16 a[120:123], a[28:31], a[200:203], a[120:123]
    v_mfma_f32_16x16x32_bf16 a[124:127], a[28:31], a[204:207], a[124:127]
    s_waitcnt vmcnt(11) lgkmcnt(0)
    s_barrier
    v_mfma_f32_16x16x32_bf16 v[192:195], a[32:35], a[208:211], v[192:195]
    ds_read_b64_tr_b16 a[0:1], v42 offset:16384
    ds_read_b64_tr_b16 a[2:3], v42 offset:17408
    v_mfma_f32_16x16x32_bf16 v[196:199], a[32:35], a[212:215], v[196:199]
    s_add_u32 m0, s60, 131072
    v_mfma_f32_16x16x32_bf16 a[64:67], a[32:35], a[216:219], a[64:67]
    buffer_load_dwordx4 v38, s[12:15], s61 offen offset:0 lds
    ds_read_b64_tr_b16 a[4:5], v43 offset:16384
    v_mfma_f32_16x16x32_bf16 a[68:71], a[32:35], a[220:223], a[68:71]
    ds_read_b64_tr_b16 a[6:7], v43 offset:17408
    v_mfma_f32_16x16x32_bf16 v[200:203], a[36:39], a[208:211], v[200:203]
    buffer_load_dwordx4 v39, s[12:15], s61 offen offset:1024 lds
    ds_read_b64_tr_b16 a[8:9], v44 offset:16384
    v_mfma_f32_16x16x32_bf16 v[204:207], a[36:39], a[212:215], v[204:207]
    v_mfma_f32_16x16x32_bf16 a[72:75], a[36:39], a[216:219], a[72:75]
    buffer_load_dwordx4 v40, s[12:15], s61 offen offset:2048 lds
    ds_read_b64_tr_b16 a[10:11], v44 offset:17408
    v_mfma_f32_16x16x32_bf16 a[76:79], a[36:39], a[220:223], a[76:79]
    ds_read_b64_tr_b16 a[12:13], v45 offset:16384
    v_mfma_f32_16x16x32_bf16 v[208:211], a[40:43], a[208:211], v[208:211]
    v_mfma_f32_16x16x32_bf16 v[212:215], a[40:43], a[212:215], v[212:215]
    buffer_load_dwordx4 v41, s[12:15], s61 offen offset:3072 lds
    ds_read_b64_tr_b16 a[14:15], v45 offset:17408
    v_mfma_f32_16x16x32_bf16 a[80:83], a[40:43], a[216:219], a[80:83]
    ds_read_b64_tr_b16 a[16:17], v46 offset:16384
    v_mfma_f32_16x16x32_bf16 a[84:87], a[40:43], a[220:223], a[84:87]
    s_add_u32 s61, s61, 0x80000
    ds_read_b64_tr_b16 a[18:19], v46 offset:17408
    v_mfma_f32_16x16x32_bf16 v[216:219], a[44:47], a[208:211], v[216:219]
    buffer_load_dwordx4 a[192:195], v36, s[8:11], s62 offen offset:0 sc1
    v_mfma_f32_16x16x32_bf16 v[220:223], a[44:47], a[212:215], v[220:223]
    ds_read_b64_tr_b16 a[20:21], v47 offset:16384
    v_mfma_f32_16x16x32_bf16 a[88:91], a[44:47], a[216:219], a[88:91]
    buffer_load_dwordx4 a[196:199], v36, s[8:11], s62 offen offset:1024 sc1
    ds_read_b64_tr_b16 a[22:23], v47 offset:17408
    v_mfma_f32_16x16x32_bf16 a[92:95], a[44:47], a[220:223], a[92:95]
    ds_read_b64_tr_b16 a[24:25], v48 offset:16384
    v_mfma_f32_16x16x32_bf16 v[224:227], a[48:51], a[208:211], v[224:227]
    v_mfma_f32_16x16x32_bf16 v[228:231], a[48:51], a[212:215], v[228:231]
    buffer_load_dwordx4 a[200:203], v37, s[8:11], s62 offen offset:0 sc1
    ds_read_b64_tr_b16 a[26:27], v48 offset:17408
    v_mfma_f32_16x16x32_bf16 a[96:99], a[48:51], a[216:219], a[96:99]
    ds_read_b64_tr_b16 a[28:29], v49 offset:16384
    v_mfma_f32_16x16x32_bf16 a[100:103], a[48:51], a[220:223], a[100:103]
    v_mfma_f32_16x16x32_bf16 v[232:235], a[52:55], a[208:211], v[232:235]
    buffer_load_dwordx4 a[204:207], v37, s[8:11], s62 offen offset:1024 sc1
    ds_read_b64_tr_b16 a[30:31], v49 offset:17408
    v_mfma_f32_16x16x32_bf16 v[236:239], a[52:55], a[212:215], v[236:239]
    v_mfma_f32_16x16x32_bf16 a[104:107], a[52:55], a[216:219], a[104:107]
    s_add_u32 s62, s62, 0x20000
    v_mfma_f32_16x16x32_bf16 a[108:111], a[52:55], a[220:223], a[108:111]
    s_add_u32 s52, s47, 12288
    v_mfma_f32_16x16x32_bf16 v[240:243], a[56:59], a[208:211], v[240:243]
    buffer_store_dwordx4 v[120:123], v1, s[32:35], s52 offen offset:2048 sc1
    v_mfma_f32_16x16x32_bf16 v[244:247], a[56:59], a[212:215], v[244:247]
    s_add_u32 s52, s47, 12288
    v_mfma_f32_16x16x32_bf16 a[112:115], a[56:59], a[216:219], a[112:115]
    buffer_store_dwordx4 v[124:127], v1, s[32:35], s52 offen offset:3072 sc1
    v_mfma_f32_16x16x32_bf16 a[116:119], a[56:59], a[220:223], a[116:119]
    v_mfma_f32_16x16x32_bf16 v[248:251], a[60:63], a[208:211], v[248:251]
    v_mfma_f32_16x16x32_bf16 v[252:255], a[60:63], a[212:215], v[252:255]
    v_mfma_f32_16x16x32_bf16 a[120:123], a[60:63], a[216:219], a[120:123]
    v_mfma_f32_16x16x32_bf16 a[124:127], a[60:63], a[220:223], a[124:127]
    s_waitcnt vmcnt(17) lgkmcnt(0)
    v_mfma_f32_16x16x32_bf16 v[192:195], a[0:3], a[224:227], v[192:195]
    ds_read_b64_tr_b16 a[32:33], v42 offset:24576
    ds_read_b64_tr_b16 a[34:35], v42 offset:25600
    v_mfma_f32_16x16x32_bf16 v[196:199], a[0:3], a[228:231], v[196:199]
    buffer_load_dwordx4 a[208:211], v36, s[8:11], s62 offen offset:0 sc1
    v_mfma_f32_16x16x32_bf16 a[64:67], a[0:3], a[232:235], a[64:67]
    ds_read_b64_tr_b16 a[36:37], v43 offset:24576
    v_mfma_f32_16x16x32_bf16 a[68:71], a[0:3], a[236:239], a[68:71]
    ds_read_b64_tr_b16 a[38:39], v43 offset:25600
    v_mfma_f32_16x16x32_bf16 v[200:203], a[4:7], a[224:227], v[200:203]
    ds_read_b64_tr_b16 a[40:41], v44 offset:24576
    v_mfma_f32_16x16x32_bf16 v[204:207], a[4:7], a[228:231], v[204:207]
    v_mfma_f32_16x16x32_bf16 a[72:75], a[4:7], a[232:235], a[72:75]
    buffer_load_dwordx4 a[212:215], v36, s[8:11], s62 offen offset:1024 sc1
    ds_read_b64_tr_b16 a[42:43], v44 offset:25600
    v_mfma_f32_16x16x32_bf16 a[76:79], a[4:7], a[236:239], a[76:79]
    ds_read_b64_tr_b16 a[44:45], v45 offset:24576
    v_mfma_f32_16x16x32_bf16 v[208:211], a[8:11], a[224:227], v[208:211]
    v_mfma_f32_16x16x32_bf16 v[212:215], a[8:11], a[228:231], v[212:215]
    ds_read_b64_tr_b16 a[46:47], v45 offset:25600
    v_mfma_f32_16x16x32_bf16 a[80:83], a[8:11], a[232:235], a[80:83]
    ds_read_b64_tr_b16 a[48:49], v46 offset:24576
    v_mfma_f32_16x16x32_bf16 a[84:87], a[8:11], a[236:239], a[84:87]
    ds_read_b64_tr_b16 a[50:51], v46 offset:25600
    v_mfma_f32_16x16x32_bf16 v[216:219], a[12:15], a[224:227], v[216:219]
    buffer_load_dwordx4 a[216:219], v37, s[8:11], s62 offen offset:0 sc1
    v_mfma_f32_16x16x32_bf16 v[220:223], a[12:15], a[228:231], v[220:223]
    ds_read_b64_tr_b16 a[52:53], v47 offset:24576
    v_mfma_f32_16x16x32_bf16 a[88:91], a[12:15], a[232:235], a[88:91]
    ds_read_b64_tr_b16 a[54:55], v47 offset:25600
    v_mfma_f32_16x16x32_bf16 a[92:95], a[12:15], a[236:239], a[92:95]
    ds_read_b64_tr_b16 a[56:57], v48 offset:24576
    v_mfma_f32_16x16x32_bf16 v[224:227], a[16:19], a[224:227], v[224:227]
    v_mfma_f32_16x16x32_bf16 v[228:231], a[16:19], a[228:231], v[228:231]
    buffer_load_dwordx4 a[220:223], v37, s[8:11], s62 offen offset:1024 sc1
    ds_read_b64_tr_b16 a[58:59], v48 offset:25600
    v_mfma_f32_16x16x32_bf16 a[96:99], a[16:19], a[232:235], a[96:99]
    ds_read_b64_tr_b16 a[60:61], v49 offset:24576
    v_mfma_f32_16x16x32_bf16 a[100:103], a[16:19], a[236:239], a[100:103]
    v_mfma_f32_16x16x32_bf16 v[232:235], a[20:23], a[224:227], v[232:235]
    ds_read_b64_tr_b16 a[62:63], v49 offset:25600
    v_mfma_f32_16x16x32_bf16 v[236:239], a[20:23], a[228:231], v[236:239]
    v_mfma_f32_16x16x32_bf16 a[104:107], a[20:23], a[232:235], a[104:107]
    s_add_u32 s62, s62, 0x20000
    v_mfma_f32_16x16x32_bf16 a[108:111], a[20:23], a[236:239], a[108:111]
    s_add_u32 s52, s47, 524288
    v_mfma_f32_16x16x32_bf16 v[240:243], a[24:27], a[224:227], v[240:243]
    buffer_store_dwordx4 v[128:131], v1, s[32:35], s52 offen offset:0 sc1
    v_mfma_f32_16x16x32_bf16 v[244:247], a[24:27], a[228:231], v[244:247]
    v_mfma_f32_16x16x32_bf16 a[112:115], a[24:27], a[232:235], a[112:115]
    v_mfma_f32_16x16x32_bf16 a[116:119], a[24:27], a[236:239], a[116:119]
    v_mfma_f32_16x16x32_bf16 v[248:251], a[28:31], a[224:227], v[248:251]
    v_mfma_f32_16x16x32_bf16 v[252:255], a[28:31], a[228:231], v[252:255]
    v_mfma_f32_16x16x32_bf16 a[120:123], a[28:31], a[232:235], a[120:123]
    v_mfma_f32_16x16x32_bf16 a[124:127], a[28:31], a[236:239], a[124:127]
    s_waitcnt vmcnt(11) lgkmcnt(0)
    s_barrier
    v_mfma_f32_16x16x32_bf16 v[192:195], a[32:35], a[240:243], v[192:195]
    ds_read_b64_tr_b16 a[0:1], v42 offset:32768
    ds_read_b64_tr_b16 a[2:3], v42 offset:33792
    v_mfma_f32_16x16x32_bf16 v[196:199], a[32:35], a[244:247], v[196:199]
    s_add_u32 m0, s60, 147456
    v_mfma_f32_16x16x32_bf16 a[64:67], a[32:35], a[248:251], a[64:67]
    buffer_load_dwordx4 v38, s[12:15], s61 offen offset:0 lds
    ds_read_b64_tr_b16 a[4:5], v43 offset:32768
    v_mfma_f32_16x16x32_bf16 a[68:71], a[32:35], a[252:255], a[68:71]
    ds_read_b64_tr_b16 a[6:7], v43 offset:33792
    v_mfma_f32_16x16x32_bf16 v[200:203], a[36:39], a[240:243], v[200:203]
    buffer_load_dwordx4 v39, s[12:15], s61 offen offset:1024 lds
    ds_read_b64_tr_b16 a[8:9], v44 offset:32768
    v_mfma_f32_16x16x32_bf16 v[204:207], a[36:39], a[244:247], v[204:207]
    v_mfma_f32_16x16x32_bf16 a[72:75], a[36:39], a[248:251], a[72:75]
    buffer_load_dwordx4 v40, s[12:15], s61 offen offset:2048 lds
    ds_read_b64_tr_b16 a[10:11], v44 offset:33792
    v_mfma_f32_16x16x32_bf16 a[76:79], a[36:39], a[252:255], a[76:79]
    ds_read_b64_tr_b16 a[12:13], v45 offset:32768
    v_mfma_f32_16x16x32_bf16 v[208:211], a[40:43], a[240:243], v[208:211]
    v_mfma_f32_16x16x32_bf16 v[212:215], a[40:43], a[244:247], v[212:215]
    buffer_load_dwordx4 v41, s[12:15], s61 offen offset:3072 lds
    ds_read_b64_tr_b16 a[14:15], v45 offset:33792
    v_mfma_f32_16x16x32_bf16 a[80:83], a[40:43], a[248:251], a[80:83]
    ds_read_b64_tr_b16 a[16:17], v46 offset:32768
    v_mfma_f32_16x16x32_bf16 a[84:87], a[40:43], a[252:255], a[84:87]
    s_add_u32 s61, s61, 0x80000
    ds_read_b64_tr_b16 a[18:19], v46 offset:33792
    v_mfma_f32_16x16x32_bf16 v[216:219], a[44:47], a[240:243], v[216:219]
    buffer_load_dwordx4 a[224:227], v36, s[8:11], s62 offen offset:0 sc1
    v_mfma_f32_16x16x32_bf16 v[220:223], a[44:47], a[244:247], v[220:223]
    ds_read_b64_tr_b16 a[20:21], v47 offset:32768
    v_mfma_f32_16x16x32_bf16 a[88:91], a[44:47], a[248:251], a[88:91]
    buffer_load_dwordx4 a[228:231], v36, s[8:11], s62 offen offset:1024 sc1
    ds_read_b64_tr_b16 a[22:23], v47 offset:33792
    v_mfma_f32_16x16x32_bf16 a[92:95], a[44:47], a[252:255], a[92:95]
    ds_read_b64_tr_b16 a[24:25], v48 offset:32768
    v_mfma_f32_16x16x32_bf16 v[224:227], a[48:51], a[240:243], v[224:227]
    v_mfma_f32_16x16x32_bf16 v[228:231], a[48:51], a[244:247], v[228:231]
    buffer_load_dwordx4 a[232:235], v37, s[8:11], s62 offen offset:0 sc1
    ds_read_b64_tr_b16 a[26:27], v48 offset:33792
    v_mfma_f32_16x16x32_bf16 a[96:99], a[48:51], a[248:251], a[96:99]
    ds_read_b64_tr_b16 a[28:29], v49 offset:32768
    v_mfma_f32_16x16x32_bf16 a[100:103], a[48:51], a[252:255], a[100:103]
    v_mfma_f32_16x16x32_bf16 v[232:235], a[52:55], a[240:243], v[232:235]
    buffer_load_dwordx4 a[236:239], v37, s[8:11], s62 offen offset:1024 sc1
    ds_read_b64_tr_b16 a[30:31], v49 offset:33792
    v_mfma_f32_16x16x32_bf16 v[236:239], a[52:55], a[244:247], v[236:239]
    v_mfma_f32_16x16x32_bf16 a[104:107], a[52:55], a[248:251], a[104:107]
    s_add_u32 s62, s62, 0x20000
    v_mfma_f32_16x16x32_bf16 a[108:111], a[52:55], a[252:255], a[108:111]
    s_add_u32 s52, s47, 524288
    v_mfma_f32_16x16x32_bf16 v[240:243], a[56:59], a[240:243], v[240:243]
    buffer_store_dwordx4 v[132:135], v1, s[32:35], s52 offen offset:1024 sc1
    v_mfma_f32_16x16x32_bf16 v[244:247], a[56:59], a[244:247], v[244:247]
    s_add_u32 s52, s47, 524288
    v_mfma_f32_16x16x32_bf16 a[112:115], a[56:59], a[248:251], a[112:115]
    buffer_store_dwordx4 v[136:139], v1, s[32:35], s52 offen offset:2048 sc1
    v_mfma_f32_16x16x32_bf16 a[116:119], a[56:59], a[252:255], a[116:119]
    v_mfma_f32_16x16x32_bf16 v[248:251], a[60:63], a[240:243], v[248:251]
    v_mfma_f32_16x16x32_bf16 v[252:255], a[60:63], a[244:247], v[252:255]
    v_mfma_f32_16x16x32_bf16 a[120:123], a[60:63], a[248:251], a[120:123]
    v_mfma_f32_16x16x32_bf16 a[124:127], a[60:63], a[252:255], a[124:127]
    s_waitcnt vmcnt(17) lgkmcnt(0)
    v_mfma_f32_16x16x32_bf16 v[192:195], a[0:3], a[192:195], v[192:195]
    ds_read_b64_tr_b16 a[32:33], v42 offset:40960
    ds_read_b64_tr_b16 a[34:35], v42 offset:41984
    v_mfma_f32_16x16x32_bf16 v[196:199], a[0:3], a[196:199], v[196:199]
    buffer_load_dwordx4 a[240:243], v36, s[8:11], s62 offen offset:0 sc1
    v_mfma_f32_16x16x32_bf16 a[64:67], a[0:3], a[200:203], a[64:67]
    ds_read_b64_tr_b16 a[36:37], v43 offset:40960
    v_mfma_f32_16x16x32_bf16 a[68:71], a[0:3], a[204:207], a[68:71]
    ds_read_b64_tr_b16 a[38:39], v43 offset:41984
    v_mfma_f32_16x16x32_bf16 v[200:203], a[4:7], a[192:195], v[200:203]
    ds_read_b64_tr_b16 a[40:41], v44 offset:40960
    v_mfma_f32_16x16x32_bf16 v[204:207], a[4:7], a[196:199], v[204:207]
    v_mfma_f32_16x16x32_bf16 a[72:75], a[4:7], a[200:203], a[72:75]
    buffer_load_dwordx4 a[244:247], v36, s[8:11], s62 offen offset:1024 sc1
    ds_read_b64_tr_b16 a[42:43], v44 offset:41984
    v_mfma_f32_16x16x32_bf16 a[76:79], a[4:7], a[204:207], a[76:79]
    ds_read_b64_tr_b16 a[44:45], v45 offset:40960
    v_mfma_f32_16x16x32_bf16 v[208:211], a[8:11], a[192:195], v[208:211]
    v_mfma_f32_16x16x32_bf16 v[212:215], a[8:11], a[196:199], v[212:215]
    ds_read_b64_tr_b16 a[46:47], v45 offset:41984
    v_mfma_f32_16x16x32_bf16 a[80:83], a[8:11], a[200:203], a[80:83]
    ds_read_b64_tr_b16 a[48:49], v46 offset:40960
    v_mfma_f32_16x16x32_bf16 a[84:87], a[8:11], a[204:207], a[84:87]
    ds_read_b64_tr_b16 a[50:51], v46 offset:41984
    v_mfma_f32_16x16x32_bf16 v[216:219], a[12:15], a[192:195], v[216:219]
    buffer_load_dwordx4 a[248:251], v37, s[8:11], s62 offen offset:0 sc1
    v_mfma_f32_16x16x32_bf16 v[220:223], a[12:15], a[196:199], v[220:223]
    ds_read_b64_tr_b16 a[52:53], v47 offset:40960
    v_mfma_f32_16x16x32_bf16 a[88:91], a[12:15], a[200:203], a[88:91]
    ds_read_b64_tr_b16 a[54:55], v47 offset:41984
    v_mfma_f32_16x16x32_bf16 a[92:95], a[12:15], a[204:207], a[92:95]
    ds_read_b64_tr_b16 a[56:57], v48 offset:40960
    v_mfma_f32_16x16x32_bf16 v[224:227], a[16:19], a[192:195], v[224:227]
    v_mfma_f32_16x16x32_bf16 v[228:231], a[16:19], a[196:199], v[228:231]
    buffer_load_dwordx4 a[252:255], v37, s[8:11], s62 offen offset:1024 sc1
    ds_read_b64_tr_b16 a[58:59], v48 offset:41984
    v_mfma_f32_16x16x32_bf16 a[96:99], a[16:19], a[200:203], a[96:99]
    ds_read_b64_tr_b16 a[60:61], v49 offset:40960
    v_mfma_f32_16x16x32_bf16 a[100:103], a[16:19], a[204:207], a[100:103]
    v_mfma_f32_16x16x32_bf16 v[232:235], a[20:23], a[192:195], v[232:235]
    ds_read_b64_tr_b16 a[62:63], v49 offset:41984
    v_mfma_f32_16x16x32_bf16 v[236:239], a[20:23], a[196:199], v[236:239]
    v_mfma_f32_16x16x32_bf16 a[104:107], a[20:23], a[200:203], a[104:107]
    s_add_u32 s62, s62, 0x20000
    v_mfma_f32_16x16x32_bf16 a[108:111], a[20:23], a[204:207], a[108:111]
    s_add_u32 s52, s47, 524288
    v_mfma_f32_16x16x32_bf16 v[240:243], a[24:27], a[192:195], v[240:243]
    buffer_store_dwordx4 v[140:143], v1, s[32:35], s52 offen offset:3072 sc1
    v_mfma_f32_16x16x32_bf16 v[244:247], a[24:27], a[196:199], v[244:247]
    v_mfma_f32_16x16x32_bf16 a[112:115], a[24:27], a[200:203], a[112:115]
    v_mfma_f32_16x16x32_bf16 a[116:119], a[24:27], a[204:207], a[116:119]
    v_mfma_f32_16x16x32_bf16 v[248:251], a[28:31], a[192:195], v[248:251]
    v_mfma_f32_16x16x32_bf16 v[252:255], a[28:31], a[196:199], v[252:255]
    v_mfma_f32_16x16x32_bf16 a[120:123], a[28:31], a[200:203], a[120:123]
    v_mfma_f32_16x16x32_bf16 a[124:127], a[28:31], a[204:207], a[124:127]
    s_waitcnt vmcnt(11) lgkmcnt(0)
    s_barrier
    v_mfma_f32_16x16x32_bf16 v[192:195], a[32:35], a[208:211], v[192:195]
    ds_read_b64_tr_b16 a[0:1], v42 offset:49152
    ds_read_b64_tr_b16 a[2:3], v42 offset:50176
    v_mfma_f32_16x16x32_bf16 v[196:199], a[32:35], a[212:215], v[196:199]
    s_add_u32 m0, s60, 98304
    v_mfma_f32_16x16x32_bf16 a[64:67], a[32:35], a[216:219], a[64:67]
    buffer_load_dwordx4 v38, s[12:15], s61 offen offset:0 lds
    ds_read_b64_tr_b16 a[4:5], v43 offset:49152
    v_mfma_f32_16x16x32_bf16 a[68:71], a[32:35], a[220:223], a[68:71]
    ds_read_b64_tr_b16 a[6:7], v43 offset:50176
    v_mfma_f32_16x16x32_bf16 v[200:203], a[36:39], a[208:211], v[200:203]
    buffer_load_dwordx4 v39, s[12:15], s61 offen offset:1024 lds
    ds_read_b64_tr_b16 a[8:9], v44 offset:49152
    v_mfma_f32_16x16x32_bf16 v[204:207], a[36:39], a[212:215], v[204:207]
    v_mfma_f32_16x16x32_bf16 a[72:75], a[36:39], a[216:219], a[72:75]
    buffer_load_dwordx4 v40, s[12:15], s61 offen offset:2048 lds
    ds_read_b64_tr_b16 a[10:11], v44 offset:50176
    v_mfma_f32_16x16x32_bf16 a[76:79], a[36:39], a[220:223], a[76:79]
    ds_read_b64_tr_b16 a[12:13], v45 offset:49152
    v_mfma_f32_16x16x32_bf16 v[208:211], a[40:43], a[208:211], v[208:211]
    v_mfma_f32_16x16x32_bf16 v[212:215], a[40:43], a[212:215], v[212:215]
    buffer_load_dwordx4 v41, s[12:15], s61 offen offset:3072 lds
    ds_read_b64_tr_b16 a[14:15], v45 offset:50176
    v_mfma_f32_16x16x32_bf16 a[80:83], a[40:43], a[216:219], a[80:83]
    ds_read_b64_tr_b16 a[16:17], v46 offset:49152
    v_mfma_f32_16x16x32_bf16 a[84:87], a[40:43], a[220:223], a[84:87]
    s_add_u32 s61, s61, 0x80000
    ds_read_b64_tr_b16 a[18:19], v46 offset:50176
    v_mfma_f32_16x16x32_bf16 v[216:219], a[44:47], a[208:211], v[216:219]
    buffer_load_dwordx4 a[192:195], v36, s[8:11], s62 offen offset:0 sc1
    v_mfma_f32_16x16x32_bf16 v[220:223], a[44:47], a[212:215], v[220:223]
    ds_read_b64_tr_b16 a[20:21], v47 offset:49152
    v_mfma_f32_16x16x32_bf16 a[88:91], a[44:47], a[216:219], a[88:91]
    buffer_load_dwordx4 a[196:199], v36, s[8:11], s62 offen offset:1024 sc1
    ds_read_b64_tr_b16 a[22:23], v47 offset:50176
    v_mfma_f32_16x16x32_bf16 a[92:95], a[44:47], a[220:223], a[92:95]
    ds_read_b64_tr_b16 a[24:25], v48 offset:49152
    v_mfma_f32_16x16x32_bf16 v[224:227], a[48:51], a[208:211], v[224:227]
    v_mfma_f32_16x16x32_bf16 v[228:231], a[48:51], a[212:215], v[228:231]
    buffer_load_dwordx4 a[200:203], v37, s[8:11], s62 offen offset:0 sc1
    ds_read_b64_tr_b16 a[26:27], v48 offset:50176
    v_mfma_f32_16x16x32_bf16 a[96:99], a[48:51], a[216:219], a[96:99]
    ds_read_b64_tr_b16 a[28:29], v49 offset:49152
    v_mfma_f32_16x16x32_bf16 a[100:103], a[48:51], a[220:223], a[100:103]
    v_mfma_f32_16x16x32_bf16 v[232:235], a[52:55], a[208:211], v[232:235]
    buffer_load_dwordx4 a[204:207], v37, s[8:11], s62 offen offset:1024 sc1
    ds_read_b64_tr_b16 a[30:31], v49 offset:50176
    v_mfma_f32_16x16x32_bf16 v[236:239], a[52:55], a[212:215], v[236:239]
    v_mfma_f32_16x16x32_bf16 a[104:107], a[52:55], a[216:219], a[104:107]
    s_add_u32 s62, s62, 0x20000
    v_mfma_f32_16x16x32_bf16 a[108:111], a[52:55], a[220:223], a[108:111]
    s_add_u32 s52, s47, 528384
    v_mfma_f32_16x16x32_bf16 v[240:243], a[56:59], a[208:211], v[240:243]
    buffer_store_dwordx4 v[144:147], v1, s[32:35], s52 offen offset:0 sc1
    v_mfma_f32_16x16x32_bf16 v[244:247], a[56:59], a[212:215], v[244:247]
    s_add_u32 s52, s47, 528384
    v_mfma_f32_16x16x32_bf16 a[112:115], a[56:59], a[216:219], a[112:115]
    buffer_store_dwordx4 v[148:151], v1, s[32:35], s52 offen offset:1024 sc1
    v_mfma_f32_16x16x32_bf16 a[116:119], a[56:59], a[220:223], a[116:119]
    v_mfma_f32_16x16x32_bf16 v[248:251], a[60:63], a[208:211], v[248:251]
    v_mfma_f32_16x16x32_bf16 v[252:255], a[60:63], a[212:215], v[252:255]
    v_mfma_f32_16x16x32_bf16 a[120:123], a[60:63], a[216:219], a[120:123]
    v_mfma_f32_16x16x32_bf16 a[124:127], a[60:63], a[220:223], a[124:127]
    s_waitcnt vmcnt(17) lgkmcnt(0)
    v_mfma_f32_16x16x32_bf16 v[192:195], a[0:3], a[224:227], v[192:195]
    ds_read_b64_tr_b16 a[32:33], v42 offset:57344
    ds_read_b64_tr_b16 a[34:35], v42 offset:58368
    v_mfma_f32_16x16x32_bf16 v[196:199], a[0:3], a[228:231], v[196:199]
    buffer_load_dwordx4 a[208:211], v36, s[8:11], s62 offen offset:0 sc1
    v_mfma_f32_16x16x32_bf16 a[64:67], a[0:3], a[232:235], a[64:67]
    ds_read_b64_tr_b16 a[36:37], v43 offset:57344
    v_mfma_f32_16x16x32_bf16 a[68:71], a[0:3], a[236:239], a[68:71]
    ds_read_b64_tr_b16 a[38:39], v43 offset:58368
    v_mfma_f32_16x16x32_bf16 v[200:203], a[4:7], a[224:227], v[200:203]
    ds_read_b64_tr_b16 a[40:41], v44 offset:57344
    v_mfma_f32_16x16x32_bf16 v[204:207], a[4:7], a[228:231], v[204:207]
    buffer_load_dwordx4 a[212:215], v36, s[8:11], s62 offen offset:1024 sc1
    v_mfma_f32_16x16x32_bf16 a[72:75], a[4:7], a[232:235], a[72:75]
    ds_read_b64_tr_b16 a[42:43], v44 offset:58368
    v_mfma_f32_16x16x32_bf16 a[76:79], a[4:7], a[236:239], a[76:79]
    ds_read_b64_tr_b16 a[44:45], v45 offset:57344
    v_mfma_f32_16x16x32_bf16 v[208:211], a[8:11], a[224:227], v[208:211]
    v_mfma_f32_16x16x32_bf16 v[212:215], a[8:11], a[228:231], v[212:215]
    ds_read_b64_tr_b16 a[46:47], v45 offset:58368
    v_mfma_f32_16x16x32_bf16 a[80:83], a[8:11], a[232:235], a[80:83]
    buffer_load_dwordx4 a[216:219], v37, s[8:11], s62 offen offset:0 sc1
    ds_read_b64_tr_b16 a[48:49], v46 offset:57344
    v_mfma_f32_16x16x32_bf16 a[84:87], a[8:11], a[236:239], a[84:87]
    ds_read_b64_tr_b16 a[50:51], v46 offset:58368
    v_mfma_f32_16x16x32_bf16 v[216:219], a[12:15], a[224:227], v[216:219]
    v_mfma_f32_16x16x32_bf16 v[220:223], a[12:15], a[228:231], v[220:223]
    ds_read_b64_tr_b16 a[52:53], v47 offset:57344
    v_mfma_f32_16x16x32_bf16 a[88:91], a[12:15], a[232:235], a[88:91]
    buffer_load_dwordx4 a[220:223], v37, s[8:11], s62 offen offset:1024 sc1
    ds_read_b64_tr_b16 a[54:55], v47 offset:58368
    v_mfma_f32_16x16x32_bf16 a[92:95], a[12:15], a[236:239], a[92:95]
    ds_read_b64_tr_b16 a[56:57], v48 offset:57344
    v_mfma_f32_16x16x32_bf16 v[224:227], a[16:19], a[224:227], v[224:227]
    v_mfma_f32_16x16x32_bf16 v[228:231], a[16:19], a[228:231], v[228:231]
    ds_read_b64_tr_b16 a[58:59], v48 offset:58368
    v_mfma_f32_16x16x32_bf16 a[96:99], a[16:19], a[232:235], a[96:99]
    s_add_u32 s62, s62, 0x20000
    ds_read_b64_tr_b16 a[60:61], v49 offset:57344
    v_mfma_f32_16x16x32_bf16 a[100:103], a[16:19], a[236:239], a[100:103]
    s_add_u32 s52, s47, 528384
    v_mfma_f32_16x16x32_bf16 v[232:235], a[20:23], a[224:227], v[232:235]
    buffer_store_dwordx4 v[152:155], v1, s[32:35], s52 offen offset:2048 sc1
    ds_read_b64_tr_b16 a[62:63], v49 offset:58368
    v_mfma_f32_16x16x32_bf16 v[236:239], a[20:23], a[228:231], v[236:239]
    s_add_u32 s52, s47, 528384
    v_mfma_f32_16x16x32_bf16 a[104:107], a[20:23], a[232:235], a[104:107]
    v_mfma_f32_16x16x32_bf16 a[108:111], a[20:23], a[236:239], a[108:111]
    buffer_store_dwordx4 v[156:159], v1, s[32:35], s52 offen offset:3072 sc1
    v_mfma_f32_16x16x32_bf16 v[240:243], a[24:27], a[224:227], v[240:243]
    v_mfma_f32_16x16x32_bf16 v[244:247], a[24:27], a[228:231], v[244:247]
    v_mfma_f32_16x16x32_bf16 a[112:115], a[24:27], a[232:235], a[112:115]
    v_mfma_f32_16x16x32_bf16 a[116:119], a[24:27], a[236:239], a[116:119]
    v_mfma_f32_16x16x32_bf16 v[248:251], a[28:31], a[224:227], v[248:251]
    v_mfma_f32_16x16x32_bf16 v[252:255], a[28:31], a[228:231], v[252:255]
    v_mfma_f32_16x16x32_bf16 a[120:123], a[28:31], a[232:235], a[120:123]
    v_mfma_f32_16x16x32_bf16 a[124:127], a[28:31], a[236:239], a[124:127]
    s_waitcnt vmcnt(12) lgkmcnt(0)
    s_barrier
    v_mfma_f32_16x16x32_bf16 v[192:195], a[32:35], a[240:243], v[192:195]
    ds_read_b64_tr_b16 a[0:1], v42 offset:0
    ds_read_b64_tr_b16 a[2:3], v42 offset:1024
    v_mfma_f32_16x16x32_bf16 v[196:199], a[32:35], a[244:247], v[196:199]
    s_add_u32 m0, s60, 114688
    v_mfma_f32_16x16x32_bf16 a[64:67], a[32:35], a[248:251], a[64:67]
    buffer_load_dwordx4 v38, s[12:15], s61 offen offset:0 lds
    ds_read_b64_tr_b16 a[4:5], v43 offset:0
    v_mfma_f32_16x16x32_bf16 a[68:71], a[32:35], a[252:255], a[68:71]
    ds_read_b64_tr_b16 a[6:7], v43 offset:1024
    v_mfma_f32_16x16x32_bf16 v[200:203], a[36:39], a[240:243], v[200:203]
    buffer_load_dwordx4 v39, s[12:15], s61 offen offset:1024 lds
    ds_read_b64_tr_b16 a[8:9], v44 offset:0
    v_mfma_f32_16x16x32_bf16 v[204:207], a[36:39], a[244:247], v[204:207]
    v_mfma_f32_16x16x32_bf16 a[72:75], a[36:39], a[248:251], a[72:75]
    ds_read_b64_tr_b16 a[10:11], v44 offset:1024
    v_mfma_f32_16x16x32_bf16 a[76:79], a[36:39], a[252:255], a[76:79]
    buffer_load_dwordx4 v40, s[12:15], s61 offen offset:2048 lds
    ds_read_b64_tr_b16 a[12:13], v45 offset:0
    v_mfma_f32_16x16x32_bf16 v[208:211], a[40:43], a[240:243], v[208:211]
    v_mfma_f32_16x16x32_bf16 v[212:215], a[40:43], a[244:247], v[212:215]
    ds_read_b64_tr_b16 a[14:15], v45 offset:1024
    v_mfma_f32_16x16x32_bf16 a[80:83], a[40:43], a[248:251], a[80:83]
    buffer_load_dwordx4 v41, s[12:15], s61 offen offset:3072 lds
    ds_read_b64_tr_b16 a[16:17], v46 offset:0
    v_mfma_f32_16x16x32_bf16 a[84:87], a[40:43], a[252:255], a[84:87]
    ds_read_b64_tr_b16 a[18:19], v46 offset:1024
    v_mfma_f32_16x16x32_bf16 v[216:219], a[44:47], a[240:243], v[216:219]
    s_add_u32 s61, s61, 0x80000
    v_mfma_f32_16x16x32_bf16 v[220:223], a[44:47], a[244:247], v[220:223]
    buffer_load_dwordx4 a[224:227], v36, s[8:11], s62 offen offset:0 sc1
    ds_read_b64_tr_b16 a[20:21], v47 offset:0
    v_mfma_f32_16x16x32_bf16 a[88:91], a[44:47], a[248:251], a[88:91]
    ds_read_b64_tr_b16 a[22:23], v47 offset:1024
    v_mfma_f32_16x16x32_bf16 a[92:95], a[44:47], a[252:255], a[92:95]
    ds_read_b64_tr_b16 a[24:25], v48 offset:0
    v_mfma_f32_16x16x32_bf16 v[224:227], a[48:51], a[240:243], v[224:227]
    buffer_load_dwordx4 a[228:231], v36, s[8:11], s62 offen offset:1024 sc1
    v_mfma_f32_16x16x32_bf16 v[228:231], a[48:51], a[244:247], v[228:231]
    ds_read_b64_tr_b16 a[26:27], v48 offset:1024
    v_mfma_f32_16x16x32_bf16 a[96:99], a[48:51], a[248:251], a[96:99]
    ds_read_b64_tr_b16 a[28:29], v49 offset:0
    v_mfma_f32_16x16x32_bf16 a[100:103], a[48:51], a[252:255], a[100:103]
    buffer_load_dwordx4 a[232:235], v37, s[8:11], s62 offen offset:0 sc1
    v_mfma_f32_16x16x32_bf16 v[232:235], a[52:55], a[240:243], v[232:235]
    ds_read_b64_tr_b16 a[30:31], v49 offset:1024
    v_mfma_f32_16x16x32_bf16 v[236:239], a[52:55], a[244:247], v[236:239]
    v_mfma_f32_16x16x32_bf16 a[104:107], a[52:55], a[248:251], a[104:107]
    buffer_load_dwordx4 a[236:239], v37, s[8:11], s62 offen offset:1024 sc1
    v_mfma_f32_16x16x32_bf16 a[108:111], a[52:55], a[252:255], a[108:111]
    v_mfma_f32_16x16x32_bf16 v[240:243], a[56:59], a[240:243], v[240:243]
    s_add_u32 s62, s62, 0x20000
    v_mfma_f32_16x16x32_bf16 v[244:247], a[56:59], a[244:247], v[244:247]
    s_add_u32 s52, s47, 532480
    v_mfma_f32_16x16x32_bf16 a[112:115], a[56:59], a[248:251], a[112:115]
    buffer_store_dwordx4 v[160:163], v1, s[32:35], s52 offen offset:0 sc1
    v_mfma_f32_16x16x32_bf16 a[116:119], a[56:59], a[252:255], a[116:119]
    v_mfma_f32_16x16x32_bf16 v[248:251], a[60:63], a[240:243], v[248:251]
    v_mfma_f32_16x16x32_bf16 v[252:255], a[60:63], a[244:247], v[252:255]
    v_mfma_f32_16x16x32_bf16 a[120:123], a[60:63], a[248:251], a[120:123]
    v_mfma_f32_16x16x32_bf16 a[124:127], a[60:63], a[252:255], a[124:127]
    s_waitcnt vmcnt(17) lgkmcnt(0)
    v_mfma_f32_16x16x32_bf16 v[192:195], a[0:3], a[192:195], v[192:195]
    ds_read_b64_tr_b16 a[32:33], v42 offset:8192
    ds_read_b64_tr_b16 a[34:35], v42 offset:9216
    v_mfma_f32_16x16x32_bf16 v[196:199], a[0:3], a[196:199], v[196:199]
    buffer_load_dwordx4 a[240:243], v36, s[8:11], s62 offen offset:0 sc1
    v_mfma_f32_16x16x32_bf16 a[64:67], a[0:3], a[200:203], a[64:67]
    ds_read_b64_tr_b16 a[36:37], v43 offset:8192
    v_mfma_f32_16x16x32_bf16 a[68:71], a[0:3], a[204:207], a[68:71]
    ds_read_b64_tr_b16 a[38:39], v43 offset:9216
    v_mfma_f32_16x16x32_bf16 v[200:203], a[4:7], a[192:195], v[200:203]
    ds_read_b64_tr_b16 a[40:41], v44 offset:8192
    v_mfma_f32_16x16x32_bf16 v[204:207], a[4:7], a[196:199], v[204:207]
    buffer_load_dwordx4 a[244:247], v36, s[8:11], s62 offen offset:1024 sc1
    v_mfma_f32_16x16x32_bf16 a[72:75], a[4:7], a[200:203], a[72:75]
    ds_read_b64_tr_b16 a[42:43], v44 offset:9216
    v_mfma_f32_16x16x32_bf16 a[76:79], a[4:7], a[204:207], a[76:79]
    ds_read_b64_tr_b16 a[44:45], v45 offset:8192
    v_mfma_f32_16x16x32_bf16 v[208:211], a[8:11], a[192:195], v[208:211]
    v_mfma_f32_16x16x32_bf16 v[212:215], a[8:11], a[196:199], v[212:215]
    ds_read_b64_tr_b16 a[46:47], v45 offset:9216
    v_mfma_f32_16x16x32_bf16 a[80:83], a[8:11], a[200:203], a[80:83]
    buffer_load_dwordx4 a[248:251], v37, s[8:11], s62 offen offset:0 sc1
    ds_read_b64_tr_b16 a[48:49], v46 offset:8192
    v_mfma_f32_16x16x32_bf16 a[84:87], a[8:11], a[204:207], a[84:87]
    ds_read_b64_tr_b16 a[50:51], v46 offset:9216
    v_mfma_f32_16x16x32_bf16 v[216:219], a[12:15], a[192:195], v[216:219]
    v_mfma_f32_16x16x32_bf16 v[220:223], a[12:15], a[196:199], v[220:223]
    ds_read_b64_tr_b16 a[52:53], v47 offset:8192
    v_mfma_f32_16x16x32_bf16 a[88:91], a[12:15], a[200:203], a[88:91]
    buffer_load_dwordx4 a[252:255], v37, s[8:11], s62 offen offset:1024 sc1
    ds_read_b64_tr_b16 a[54:55], v47 offset:9216
    v_mfma_f32_16x16x32_bf16 a[92:95], a[12:15], a[204:207], a[92:95]
    ds_read_b64_tr_b16 a[56:57], v48 offset:8192
    v_mfma_f32_16x16x32_bf16 v[224:227], a[16:19], a[192:195], v[224:227]
    v_mfma_f32_16x16x32_bf16 v[228:231], a[16:19], a[196:199], v[228:231]
    ds_read_b64_tr_b16 a[58:59], v48 offset:9216
    v_mfma_f32_16x16x32_bf16 a[96:99], a[16:19], a[200:203], a[96:99]
    s_add_u32 s62, s62, 0x20000
    ds_read_b64_tr_b16 a[60:61], v49 offset:8192
    v_mfma_f32_16x16x32_bf16 a[100:103], a[16:19], a[204:207], a[100:103]
    s_add_u32 s52, s47, 532480
    v_mfma_f32_16x16x32_bf16 v[232:235], a[20:23], a[192:195], v[232:235]
    buffer_store_dwordx4 v[164:167], v1, s[32:35], s52 offen offset:1024 sc1
    ds_read_b64_tr_b16 a[62:63], v49 offset:9216
    v_mfma_f32_16x16x32_bf16 v[236:239], a[20:23], a[196:199], v[236:239]
    s_add_u32 s52, s47, 532480
    v_mfma_f32_16x16x32_bf16 a[104:107], a[20:23], a[200:203], a[104:107]
    v_mfma_f32_16x16x32_bf16 a[108:111], a[20:23], a[204:207], a[108:111]
    buffer_store_dwordx4 v[168:171], v1, s[32:35], s52 offen offset:2048 sc1
    v_mfma_f32_16x16x32_bf16 v[240:243], a[24:27], a[192:195], v[240:243]
    v_mfma_f32_16x16x32_bf16 v[244:247], a[24:27], a[196:199], v[244:247]
    v_mfma_f32_16x16x32_bf16 a[112:115], a[24:27], a[200:203], a[112:115]
    v_mfma_f32_16x16x32_bf16 a[116:119], a[24:27], a[204:207], a[116:119]
    v_mfma_f32_16x16x32_bf16 v[248:251], a[28:31], a[192:195], v[248:251]
    v_mfma_f32_16x16x32_bf16 v[252:255], a[28:31], a[196:199], v[252:255]
    v_mfma_f32_16x16x32_bf16 a[120:123], a[28:31], a[200:203], a[120:123]
    v_mfma_f32_16x16x32_bf16 a[124:127], a[28:31], a[204:207], a[124:127]
    s_waitcnt vmcnt(11) lgkmcnt(0)
    s_barrier
    v_mfma_f32_16x16x32_bf16 v[192:195], a[32:35], a[208:211], v[192:195]
    ds_read_b64_tr_b16 a[0:1], v42 offset:16384
    ds_read_b64_tr_b16 a[2:3], v42 offset:17408
    v_mfma_f32_16x16x32_bf16 v[196:199], a[32:35], a[212:215], v[196:199]
    s_add_u32 m0, s60, 131072
    v_mfma_f32_16x16x32_bf16 a[64:67], a[32:35], a[216:219], a[64:67]
    buffer_load_dwordx4 v38, s[12:15], s61 offen offset:0 lds
    ds_read_b64_tr_b16 a[4:5], v43 offset:16384
    v_mfma_f32_16x16x32_bf16 a[68:71], a[32:35], a[220:223], a[68:71]
    ds_read_b64_tr_b16 a[6:7], v43 offset:17408
    v_mfma_f32_16x16x32_bf16 v[200:203], a[36:39], a[208:211], v[200:203]
    buffer_load_dwordx4 v39, s[12:15], s61 offen offset:1024 lds
    ds_read_b64_tr_b16 a[8:9], v44 offset:16384
    v_mfma_f32_16x16x32_bf16 v[204:207], a[36:39], a[212:215], v[204:207]
    v_mfma_f32_16x16x32_bf16 a[72:75], a[36:39], a[216:219], a[72:75]
    ds_read_b64_tr_b16 a[10:11], v44 offset:17408
    v_mfma_f32_16x16x32_bf16 a[76:79], a[36:39], a[220:223], a[76:79]
    buffer_load_dwordx4 v40, s[12:15], s61 offen offset:2048 lds
    ds_read_b64_tr_b16 a[12:13], v45 offset:16384
    v_mfma_f32_16x16x32_bf16 v[208:211], a[40:43], a[208:211], v[208:211]
    v_mfma_f32_16x16x32_bf16 v[212:215], a[40:43], a[212:215], v[212:215]
    ds_read_b64_tr_b16 a[14:15], v45 offset:17408
    v_mfma_f32_16x16x32_bf16 a[80:83], a[40:43], a[216:219], a[80:83]
    buffer_load_dwordx4 v41, s[12:15], s61 offen offset:3072 lds
    ds_read_b64_tr_b16 a[16:17], v46 offset:16384
    v_mfma_f32_16x16x32_bf16 a[84:87], a[40:43], a[220:223], a[84:87]
    ds_read_b64_tr_b16 a[18:19], v46 offset:17408
    v_mfma_f32_16x16x32_bf16 v[216:219], a[44:47], a[208:211], v[216:219]
    s_add_u32 s61, s61, 0x80000
    v_mfma_f32_16x16x32_bf16 v[220:223], a[44:47], a[212:215], v[220:223]
    buffer_load_dwordx4 a[192:195], v36, s[8:11], s62 offen offset:0 sc1
    ds_read_b64_tr_b16 a[20:21], v47 offset:16384
    v_mfma_f32_16x16x32_bf16 a[88:91], a[44:47], a[216:219], a[88:91]
    ds_read_b64_tr_b16 a[22:23], v47 offset:17408
    v_mfma_f32_16x16x32_bf16 a[92:95], a[44:47], a[220:223], a[92:95]
    ds_read_b64_tr_b16 a[24:25], v48 offset:16384
    v_mfma_f32_16x16x32_bf16 v[224:227], a[48:51], a[208:211], v[224:227]
    buffer_load_dwordx4 a[196:199], v36, s[8:11], s62 offen offset:1024 sc1
    v_mfma_f32_16x16x32_bf16 v[228:231], a[48:51], a[212:215], v[228:231]
    ds_read_b64_tr_b16 a[26:27], v48 offset:17408
    v_mfma_f32_16x16x32_bf16 a[96:99], a[48:51], a[216:219], a[96:99]
    ds_read_b64_tr_b16 a[28:29], v49 offset:16384
    v_mfma_f32_16x16x32_bf16 a[100:103], a[48:51], a[220:223], a[100:103]
    buffer_load_dwordx4 a[200:203], v37, s[8:11], s62 offen offset:0 sc1
    v_mfma_f32_16x16x32_bf16 v[232:235], a[52:55], a[208:211], v[232:235]
    ds_read_b64_tr_b16 a[30:31], v49 offset:17408
    v_mfma_f32_16x16x32_bf16 v[236:239], a[52:55], a[212:215], v[236:239]
    v_mfma_f32_16x16x32_bf16 a[104:107], a[52:55], a[216:219], a[104:107]
    buffer_load_dwordx4 a[204:207], v37, s[8:11], s62 offen offset:1024 sc1
    v_mfma_f32_16x16x32_bf16 a[108:111], a[52:55], a[220:223], a[108:111]
    v_mfma_f32_16x16x32_bf16 v[240:243], a[56:59], a[208:211], v[240:243]
    s_add_u32 s62, s62, 0x20000
    v_mfma_f32_16x16x32_bf16 v[244:247], a[56:59], a[212:215], v[244:247]
    s_add_u32 s52, s47, 532480
    v_mfma_f32_16x16x32_bf16 a[112:115], a[56:59], a[216:219], a[112:115]
    buffer_store_dwordx4 v[172:175], v1, s[32:35], s52 offen offset:3072 sc1
    v_mfma_f32_16x16x32_bf16 a[116:119], a[56:59], a[220:223], a[116:119]
    v_mfma_f32_16x16x32_bf16 v[248:251], a[60:63], a[208:211], v[248:251]
    v_mfma_f32_16x16x32_bf16 v[252:255], a[60:63], a[212:215], v[252:255]
    v_mfma_f32_16x16x32_bf16 a[120:123], a[60:63], a[216:219], a[120:123]
    v_mfma_f32_16x16x32_bf16 a[124:127], a[60:63], a[220:223], a[124:127]
    s_waitcnt vmcnt(16) lgkmcnt(0)
    v_mfma_f32_16x16x32_bf16 v[192:195], a[0:3], a[224:227], v[192:195]
    ds_read_b64_tr_b16 a[32:33], v42 offset:24576
    ds_read_b64_tr_b16 a[34:35], v42 offset:25600
    v_mfma_f32_16x16x32_bf16 v[196:199], a[0:3], a[228:231], v[196:199]
    buffer_load_dwordx4 a[208:211], v36, s[8:11], s62 offen offset:0 sc1
    v_mfma_f32_16x16x32_bf16 a[64:67], a[0:3], a[232:235], a[64:67]
    ds_read_b64_tr_b16 a[36:37], v43 offset:24576
    v_mfma_f32_16x16x32_bf16 a[68:71], a[0:3], a[236:239], a[68:71]
    ds_read_b64_tr_b16 a[38:39], v43 offset:25600
    v_mfma_f32_16x16x32_bf16 v[200:203], a[4:7], a[224:227], v[200:203]
    ds_read_b64_tr_b16 a[40:41], v44 offset:24576
    v_mfma_f32_16x16x32_bf16 v[204:207], a[4:7], a[228:231], v[204:207]
    buffer_load_dwordx4 a[212:215], v36, s[8:11], s62 offen offset:1024 sc1
    v_mfma_f32_16x16x32_bf16 a[72:75], a[4:7], a[232:235], a[72:75]
    ds_read_b64_tr_b16 a[42:43], v44 offset:25600
    v_mfma_f32_16x16x32_bf16 a[76:79], a[4:7], a[236:239], a[76:79]
    ds_read_b64_tr_b16 a[44:45], v45 offset:24576
    v_mfma_f32_16x16x32_bf16 v[208:211], a[8:11], a[224:227], v[208:211]
    v_mfma_f32_16x16x32_bf16 v[212:215], a[8:11], a[228:231], v[212:215]
    ds_read_b64_tr_b16 a[46:47], v45 offset:25600
    v_mfma_f32_16x16x32_bf16 a[80:83], a[8:11], a[232:235], a[80:83]
    buffer_load_dwordx4 a[216:219], v37, s[8:11], s62 offen offset:0 sc1
    ds_read_b64_tr_b16 a[48:49], v46 offset:24576
    v_mfma_f32_16x16x32_bf16 a[84:87], a[8:11], a[236:239], a[84:87]
    ds_read_b64_tr_b16 a[50:51], v46 offset:25600
    v_mfma_f32_16x16x32_bf16 v[216:219], a[12:15], a[224:227], v[216:219]
    v_mfma_f32_16x16x32_bf16 v[220:223], a[12:15], a[228:231], v[220:223]
    ds_read_b64_tr_b16 a[52:53], v47 offset:24576
    v_mfma_f32_16x16x32_bf16 a[88:91], a[12:15], a[232:235], a[88:91]
    buffer_load_dwordx4 a[220:223], v37, s[8:11], s62 offen offset:1024 sc1
    ds_read_b64_tr_b16 a[54:55], v47 offset:25600
    v_mfma_f32_16x16x32_bf16 a[92:95], a[12:15], a[236:239], a[92:95]
    ds_read_b64_tr_b16 a[56:57], v48 offset:24576
    v_mfma_f32_16x16x32_bf16 v[224:227], a[16:19], a[224:227], v[224:227]
    v_mfma_f32_16x16x32_bf16 v[228:231], a[16:19], a[228:231], v[228:231]
    ds_read_b64_tr_b16 a[58:59], v48 offset:25600
    v_mfma_f32_16x16x32_bf16 a[96:99], a[16:19], a[232:235], a[96:99]
    s_add_u32 s62, s62, 0x20000
    ds_read_b64_tr_b16 a[60:61], v49 offset:24576
    v_mfma_f32_16x16x32_bf16 a[100:103], a[16:19], a[236:239], a[100:103]
    s_add_u32 s52, s47, 536576
    v_mfma_f32_16x16x32_bf16 v[232:235], a[20:23], a[224:227], v[232:235]
    buffer_store_dwordx4 v[176:179], v1, s[32:35], s52 offen offset:0 sc1
    ds_read_b64_tr_b16 a[62:63], v49 offset:25600
    v_mfma_f32_16x16x32_bf16 v[236:239], a[20:23], a[228:231], v[236:239]
    s_add_u32 s52, s47, 536576
    v_mfma_f32_16x16x32_bf16 a[104:107], a[20:23], a[232:235], a[104:107]
    v_mfma_f32_16x16x32_bf16 a[108:111], a[20:23], a[236:239], a[108:111]
    buffer_store_dwordx4 v[180:183], v1, s[32:35], s52 offen offset:1024 sc1
    v_mfma_f32_16x16x32_bf16 v[240:243], a[24:27], a[224:227], v[240:243]
    v_mfma_f32_16x16x32_bf16 v[244:247], a[24:27], a[228:231], v[244:247]
    v_mfma_f32_16x16x32_bf16 a[112:115], a[24:27], a[232:235], a[112:115]
    v_mfma_f32_16x16x32_bf16 a[116:119], a[24:27], a[236:239], a[116:119]
    v_mfma_f32_16x16x32_bf16 v[248:251], a[28:31], a[224:227], v[248:251]
    v_mfma_f32_16x16x32_bf16 v[252:255], a[28:31], a[228:231], v[252:255]
    v_mfma_f32_16x16x32_bf16 a[120:123], a[28:31], a[232:235], a[120:123]
    v_mfma_f32_16x16x32_bf16 a[124:127], a[28:31], a[236:239], a[124:127]
    s_waitcnt vmcnt(11) lgkmcnt(0)
    s_barrier
    v_mfma_f32_16x16x32_bf16 v[192:195], a[32:35], a[240:243], v[192:195]
    ds_read_b64_tr_b16 a[0:1], v42 offset:32768
    ds_read_b64_tr_b16 a[2:3], v42 offset:33792
    v_mfma_f32_16x16x32_bf16 v[196:199], a[32:35], a[244:247], v[196:199]
    s_add_u32 m0, s60, 147456
    v_mfma_f32_16x16x32_bf16 a[64:67], a[32:35], a[248:251], a[64:67]
    buffer_load_dwordx4 v38, s[12:15], s61 offen offset:0 lds
    ds_read_b64_tr_b16 a[4:5], v43 offset:32768
    v_mfma_f32_16x16x32_bf16 a[68:71], a[32:35], a[252:255], a[68:71]
    ds_read_b64_tr_b16 a[6:7], v43 offset:33792
    v_mfma_f32_16x16x32_bf16 v[200:203], a[36:39], a[240:243], v[200:203]
    buffer_load_dwordx4 v39, s[12:15], s61 offen offset:1024 lds
    ds_read_b64_tr_b16 a[8:9], v44 offset:32768
    v_mfma_f32_16x16x32_bf16 v[204:207], a[36:39], a[244:247], v[204:207]
    v_mfma_f32_16x16x32_bf16 a[72:75], a[36:39], a[248:251], a[72:75]
    buffer_load_dwordx4 v40, s[12:15], s61 offen offset:2048 lds
    ds_read_b64_tr_b16 a[10:11], v44 offset:33792
    v_mfma_f32_16x16x32_bf16 a[76:79], a[36:39], a[252:255], a[76:79]
    ds_read_b64_tr_b16 a[12:13], v45 offset:32768
    v_mfma_f32_16x16x32_bf16 v[208:211], a[40:43], a[240:243], v[208:211]
    v_mfma_f32_16x16x32_bf16 v[212:215], a[40:43], a[244:247], v[212:215]
    buffer_load_dwordx4 v41, s[12:15], s61 offen offset:3072 lds
    ds_read_b64_tr_b16 a[14:15], v45 offset:33792
    v_mfma_f32_16x16x32_bf16 a[80:83], a[40:43], a[248:251], a[80:83]
    ds_read_b64_tr_b16 a[16:17], v46 offset:32768
    v_mfma_f32_16x16x32_bf16 a[84:87], a[40:43], a[252:255], a[84:87]
    s_add_u32 s61, s61, 0x80000
    ds_read_b64_tr_b16 a[18:19], v46 offset:33792
    v_mfma_f32_16x16x32_bf16 v[216:219], a[44:47], a[240:243], v[216:219]
    buffer_load_dwordx4 a[224:227], v36, s[8:11], s62 offen offset:0 sc1
    v_mfma_f32_16x16x32_bf16 v[220:223], a[44:47], a[244:247], v[220:223]
    ds_read_b64_tr_b16 a[20:21], v47 offset:32768
    v_mfma_f32_16x16x32_bf16 a[88:91], a[44:47], a[248:251], a[88:91]
    buffer_load_dwordx4 a[228:231], v36, s[8:11], s62 offen offset:1024 sc1
    ds_read_b64_tr_b16 a[22:23], v47 offset:33792
    v_mfma_f32_16x16x32_bf16 a[92:95], a[44:47], a[252:255], a[92:95]
    ds_read_b64_tr_b16 a[24:25], v48 offset:32768
    v_mfma_f32_16x16x32_bf16 v[224:227], a[48:51], a[240:243], v[224:227]
    v_mfma_f32_16x16x32_bf16 v[228:231], a[48:51], a[244:247], v[228:231]
    buffer_load_dwordx4 a[232:235], v37, s[8:11], s62 offen offset:0 sc1
    ds_read_b64_tr_b16 a[26:27], v48 offset:33792
    v_mfma_f32_16x16x32_bf16 a[96:99], a[48:51], a[248:251], a[96:99]
    ds_read_b64_tr_b16 a[28:29], v49 offset:32768
    v_mfma_f32_16x16x32_bf16 a[100:103], a[48:51], a[252:255], a[100:103]
    v_mfma_f32_16x16x32_bf16 v[232:235], a[52:55], a[240:243], v[232:235]
    buffer_load_dwordx4 a[236:239], v37, s[8:11], s62 offen offset:1024 sc1
    ds_read_b64_tr_b16 a[30:31], v49 offset:33792
    v_mfma_f32_16x16x32_bf16 v[236:239], a[52:55], a[244:247], v[236:239]
    v_mfma_f32_16x16x32_bf16 a[104:107], a[52:55], a[248:251], a[104:107]
    s_add_u32 s62, s62, 0x20000
    v_mfma_f32_16x16x32_bf16 a[108:111], a[52:55], a[252:255], a[108:111]
    s_add_u32 s52, s47, 536576
    v_mfma_f32_16x16x32_bf16 v[240:243], a[56:59], a[240:243], v[240:243]
    buffer_store_dwordx4 v[184:187], v1, s[32:35], s52 offen offset:2048 sc1
    v_mfma_f32_16x16x32_bf16 v[244:247], a[56:59], a[244:247], v[244:247]
    s_add_u32 s52, s47, 536576
    v_mfma_f32_16x16x32_bf16 a[112:115], a[56:59], a[248:251], a[112:115]
    buffer_store_dwordx4 v[188:191], v1, s[32:35], s52 offen offset:3072 sc1
    v_mfma_f32_16x16x32_bf16 a[116:119], a[56:59], a[252:255], a[116:119]
    v_mfma_f32_16x16x32_bf16 v[248:251], a[60:63], a[240:243], v[248:251]
    v_mfma_f32_16x16x32_bf16 v[252:255], a[60:63], a[244:247], v[252:255]
    v_mfma_f32_16x16x32_bf16 a[120:123], a[60:63], a[248:251], a[120:123]
    v_mfma_f32_16x16x32_bf16 a[124:127], a[60:63], a[252:255], a[124:127]
    s_waitcnt vmcnt(17) lgkmcnt(0)
    v_mfma_f32_16x16x32_bf16 v[192:195], a[0:3], a[192:195], v[192:195]
    ds_read_b64_tr_b16 a[32:33], v42 offset:40960
    ds_read_b64_tr_b16 a[34:35], v42 offset:41984
    v_mfma_f32_16x16x32_bf16 v[196:199], a[0:3], a[196:199], v[196:199]
    buffer_load_dwordx4 a[240:243], v36, s[8:11], s62 offen offset:0 sc1
    v_mfma_f32_16x16x32_bf16 a[64:67], a[0:3], a[200:203], a[64:67]
    ds_read_b64_tr_b16 a[36:37], v43 offset:40960
    v_mfma_f32_16x16x32_bf16 a[68:71], a[0:3], a[204:207], a[68:71]
    ds_read_b64_tr_b16 a[38:39], v43 offset:41984
    v_mfma_f32_16x16x32_bf16 v[200:203], a[4:7], a[192:195], v[200:203]
    ds_read_b64_tr_b16 a[40:41], v44 offset:40960
    v_mfma_f32_16x16x32_bf16 v[204:207], a[4:7], a[196:199], v[204:207]
    v_mfma_f32_16x16x32_bf16 a[72:75], a[4:7], a[200:203], a[72:75]
    ds_read_b64_tr_b16 a[42:43], v44 offset:41984
    v_mfma_f32_16x16x32_bf16 a[76:79], a[4:7], a[204:207], a[76:79]
    ds_read_b64_tr_b16 a[44:45], v45 offset:40960
    v_mfma_f32_16x16x32_bf16 v[208:211], a[8:11], a[192:195], v[208:211]
    buffer_load_dwordx4 a[244:247], v36, s[8:11], s62 offen offset:1024 sc1
    v_mfma_f32_16x16x32_bf16 v[212:215], a[8:11], a[196:199], v[212:215]
    ds_read_b64_tr_b16 a[46:47], v45 offset:41984
    v_mfma_f32_16x16x32_bf16 a[80:83], a[8:11], a[200:203], a[80:83]
    ds_read_b64_tr_b16 a[48:49], v46 offset:40960
    v_mfma_f32_16x16x32_bf16 a[84:87], a[8:11], a[204:207], a[84:87]
    ds_read_b64_tr_b16 a[50:51], v46 offset:41984
    v_mfma_f32_16x16x32_bf16 v[216:219], a[12:15], a[192:195], v[216:219]
    v_mfma_f32_16x16x32_bf16 v[220:223], a[12:15], a[196:199], v[220:223]
    ds_read_b64_tr_b16 a[52:53], v47 offset:40960
    v_mfma_f32_16x16x32_bf16 a[88:91], a[12:15], a[200:203], a[88:91]
    buffer_load_dwordx4 a[248:251], v37, s[8:11], s62 offen offset:0 sc1
    ds_read_b64_tr_b16 a[54:55], v47 offset:41984
    v_mfma_f32_16x16x32_bf16 a[92:95], a[12:15], a[204:207], a[92:95]
    ds_read_b64_tr_b16 a[56:57], v48 offset:40960
    v_mfma_f32_16x16x32_bf16 v[224:227], a[16:19], a[192:195], v[224:227]
    v_mfma_f32_16x16x32_bf16 v[228:231], a[16:19], a[196:199], v[228:231]
    ds_read_b64_tr_b16 a[58:59], v48 offset:41984
    v_mfma_f32_16x16x32_bf16 a[96:99], a[16:19], a[200:203], a[96:99]
    ds_read_b64_tr_b16 a[60:61], v49 offset:40960
    v_mfma_f32_16x16x32_bf16 a[100:103], a[16:19], a[204:207], a[100:103]
    v_mfma_f32_16x16x32_bf16 v[232:235], a[20:23], a[192:195], v[232:235]
    ds_read_b64_tr_b16 a[62:63], v49 offset:41984
    v_mfma_f32_16x16x32_bf16 v[236:239], a[20:23], a[196:199], v[236:239]
    buffer_load_dwordx4 a[252:255], v37, s[8:11], s62 offen offset:1024 sc1
    v_mfma_f32_16x16x32_bf16 a[104:107], a[20:23], a[200:203], a[104:107]
    v_mfma_f32_16x16x32_bf16 a[108:111], a[20:23], a[204:207], a[108:111]
    v_mfma_f32_16x16x32_bf16 v[240:243], a[24:27], a[192:195], v[240:243]
    v_mfma_f32_16x16x32_bf16 v[244:247], a[24:27], a[196:199], v[244:247]
    v_mfma_f32_16x16x32_bf16 a[112:115], a[24:27], a[200:203], a[112:115]
    v_mfma_f32_16x16x32_bf16 a[116:119], a[24:27], a[204:207], a[116:119]
    s_add_u32 s62, s62, 0x20000
    v_mfma_f32_16x16x32_bf16 v[248:251], a[28:31], a[192:195], v[248:251]
    v_mfma_f32_16x16x32_bf16 v[252:255], a[28:31], a[196:199], v[252:255]
    v_mfma_f32_16x16x32_bf16 a[120:123], a[28:31], a[200:203], a[120:123]
    v_mfma_f32_16x16x32_bf16 a[124:127], a[28:31], a[204:207], a[124:127]
    s_waitcnt vmcnt(10) lgkmcnt(0)
    s_barrier
    v_mfma_f32_16x16x32_bf16 v[192:195], a[32:35], a[208:211], v[192:195]
    ds_read_b64_tr_b16 a[0:1], v42 offset:49152
    ds_read_b64_tr_b16 a[2:3], v42 offset:50176
    v_mfma_f32_16x16x32_bf16 v[196:199], a[32:35], a[212:215], v[196:199]
    s_add_u32 m0, s60, 98304
    v_mfma_f32_16x16x32_bf16 a[64:67], a[32:35], a[216:219], a[64:67]
    buffer_load_dwordx4 v38, s[12:15], s61 offen offset:0 lds
    ds_read_b64_tr_b16 a[4:5], v43 offset:49152
    v_mfma_f32_16x16x32_bf16 a[68:71], a[32:35], a[220:223], a[68:71]
    ds_read_b64_tr_b16 a[6:7], v43 offset:50176
    v_mfma_f32_16x16x32_bf16 v[200:203], a[36:39], a[208:211], v[200:203]
    buffer_load_dwordx4 v39, s[12:15], s61 offen offset:1024 lds
    ds_read_b64_tr_b16 a[8:9], v44 offset:49152
    v_mfma_f32_16x16x32_bf16 v[204:207], a[36:39], a[212:215], v[204:207]
    v_mfma_f32_16x16x32_bf16 a[72:75], a[36:39], a[216:219], a[72:75]
    ds_read_b64_tr_b16 a[10:11], v44 offset:50176
    v_mfma_f32_16x16x32_bf16 a[76:79], a[36:39], a[220:223], a[76:79]
    ds_read_b64_tr_b16 a[12:13], v45 offset:49152
    v_mfma_f32_16x16x32_bf16 v[208:211], a[40:43], a[208:211], v[208:211]
    buffer_load_dwordx4 v40, s[12:15], s61 offen offset:2048 lds
    v_mfma_f32_16x16x32_bf16 v[212:215], a[40:43], a[212:215], v[212:215]
    ds_read_b64_tr_b16 a[14:15], v45 offset:50176
    v_mfma_f32_16x16x32_bf16 a[80:83], a[40:43], a[216:219], a[80:83]
    ds_read_b64_tr_b16 a[16:17], v46 offset:49152
    v_mfma_f32_16x16x32_bf16 a[84:87], a[40:43], a[220:223], a[84:87]
    buffer_load_dwordx4 v41, s[12:15], s61 offen offset:3072 lds
    ds_read_b64_tr_b16 a[18:19], v46 offset:50176
    v_mfma_f32_16x16x32_bf16 v[216:219], a[44:47], a[208:211], v[216:219]
    v_mfma_f32_16x16x32_bf16 v[220:223], a[44:47], a[212:215], v[220:223]
    s_add_u32 s61, s61, 0x80000
    ds_read_b64_tr_b16 a[20:21], v47 offset:49152
    v_mfma_f32_16x16x32_bf16 a[88:91], a[44:47], a[216:219], a[88:91]
    buffer_load_dwordx4 a[192:195], v36, s[8:11], s62 offen offset:0 sc1
    ds_read_b64_tr_b16 a[22:23], v47 offset:50176
    v_mfma_f32_16x16x32_bf16 a[92:95], a[44:47], a[220:223], a[92:95]
    ds_read_b64_tr_b16 a[24:25], v48 offset:49152
    v_mfma_f32_16x16x32_bf16 v[224:227], a[48:51], a[208:211], v[224:227]
    v_mfma_f32_16x16x32_bf16 v[228:231], a[48:51], a[212:215], v[228:231]
    ds_read_b64_tr_b16 a[26:27], v48 offset:50176
    v_mfma_f32_16x16x32_bf16 a[96:99], a[48:51], a[216:219], a[96:99]
    buffer_load_dwordx4 a[196:199], v36, s[8:11], s62 offen offset:1024 sc1
    ds_read_b64_tr_b16 a[28:29], v49 offset:49152
    v_mfma_f32_16x16x32_bf16 a[100:103], a[48:51], a[220:223], a[100:103]
    v_mfma_f32_16x16x32_bf16 v[232:235], a[52:55], a[208:211], v[232:235]
    ds_read_b64_tr_b16 a[30:31], v49 offset:50176
    v_mfma_f32_16x16x32_bf16 v[236:239], a[52:55], a[212:215], v[236:239]
    buffer_load_dwordx4 a[200:203], v37, s[8:11], s62 offen offset:0 sc1
    v_mfma_f32_16x16x32_bf16 a[104:107], a[52:55], a[216:219], a[104:107]
    v_mfma_f32_16x16x32_bf16 a[108:111], a[52:55], a[220:223], a[108:111]
    v_mfma_f32_16x16x32_bf16 v[240:243], a[56:59], a[208:211], v[240:243]
    v_mfma_f32_16x16x32_bf16 v[244:247], a[56:59], a[212:215], v[244:247]
    buffer_load_dwordx4 a[204:207], v37, s[8:11], s62 offen offset:1024 sc1
    v_mfma_f32_16x16x32_bf16 a[112:115], a[56:59], a[216:219], a[112:115]
    v_mfma_f32_16x16x32_bf16 a[116:119], a[56:59], a[220:223], a[116:119]
    s_add_u32 s62, s62, 0x20000
    v_mfma_f32_16x16x32_bf16 v[248:251], a[60:63], a[208:211], v[248:251]
    v_mfma_f32_16x16x32_bf16 v[252:255], a[60:63], a[212:215], v[252:255]
    v_mfma_f32_16x16x32_bf16 a[120:123], a[60:63], a[216:219], a[120:123]
    v_mfma_f32_16x16x32_bf16 a[124:127], a[60:63], a[220:223], a[124:127]
    s_waitcnt vmcnt(14) lgkmcnt(0)
    v_mfma_f32_16x16x32_bf16 v[192:195], a[0:3], a[224:227], v[192:195]
    ds_read_b64_tr_b16 a[32:33], v42 offset:57344
    ds_read_b64_tr_b16 a[34:35], v42 offset:58368
    v_mfma_f32_16x16x32_bf16 v[196:199], a[0:3], a[228:231], v[196:199]
    buffer_load_dwordx4 a[208:211], v36, s[8:11], s62 offen offset:0 sc1
    v_mfma_f32_16x16x32_bf16 a[64:67], a[0:3], a[232:235], a[64:67]
    ds_read_b64_tr_b16 a[36:37], v43 offset:57344
    v_mfma_f32_16x16x32_bf16 a[68:71], a[0:3], a[236:239], a[68:71]
    ds_read_b64_tr_b16 a[38:39], v43 offset:58368
    v_mfma_f32_16x16x32_bf16 v[200:203], a[4:7], a[224:227], v[200:203]
    ds_read_b64_tr_b16 a[40:41], v44 offset:57344
    v_mfma_f32_16x16x32_bf16 v[204:207], a[4:7], a[228:231], v[204:207]
    v_mfma_f32_16x16x32_bf16 a[72:75], a[4:7], a[232:235], a[72:75]
    ds_read_b64_tr_b16 a[42:43], v44 offset:58368
    v_mfma_f32_16x16x32_bf16 a[76:79], a[4:7], a[236:239], a[76:79]
    ds_read_b64_tr_b16 a[44:45], v45 offset:57344
    v_mfma_f32_16x16x32_bf16 v[208:211], a[8:11], a[224:227], v[208:211]
    buffer_load_dwordx4 a[212:215], v36, s[8:11], s62 offen offset:1024 sc1
    v_mfma_f32_16x16x32_bf16 v[212:215], a[8:11], a[228:231], v[212:215]
    ds_read_b64_tr_b16 a[46:47], v45 offset:58368
    v_mfma_f32_16x16x32_bf16 a[80:83], a[8:11], a[232:235], a[80:83]
    ds_read_b64_tr_b16 a[48:49], v46 offset:57344
    v_mfma_f32_16x16x32_bf16 a[84:87], a[8:11], a[236:239], a[84:87]
    ds_read_b64_tr_b16 a[50:51], v46 offset:58368
    v_mfma_f32_16x16x32_bf16 v[216:219], a[12:15], a[224:227], v[216:219]
    v_mfma_f32_16x16x32_bf16 v[220:223], a[12:15], a[228:231], v[220:223]
    ds_read_b64_tr_b16 a[52:53], v47 offset:57344
    v_mfma_f32_16x16x32_bf16 a[88:91], a[12:15], a[232:235], a[88:91]
    buffer_load_dwordx4 a[216:219], v37, s[8:11], s62 offen offset:0 sc1
    ds_read_b64_tr_b16 a[54:55], v47 offset:58368
    v_mfma_f32_16x16x32_bf16 a[92:95], a[12:15], a[236:239], a[92:95]
    ds_read_b64_tr_b16 a[56:57], v48 offset:57344
    v_mfma_f32_16x16x32_bf16 v[224:227], a[16:19], a[224:227], v[224:227]
    v_mfma_f32_16x16x32_bf16 v[228:231], a[16:19], a[228:231], v[228:231]
    ds_read_b64_tr_b16 a[58:59], v48 offset:58368
    v_mfma_f32_16x16x32_bf16 a[96:99], a[16:19], a[232:235], a[96:99]
    ds_read_b64_tr_b16 a[60:61], v49 offset:57344
    v_mfma_f32_16x16x32_bf16 a[100:103], a[16:19], a[236:239], a[100:103]
    v_mfma_f32_16x16x32_bf16 v[232:235], a[20:23], a[224:227], v[232:235]
    ds_read_b64_tr_b16 a[62:63], v49 offset:58368
    v_mfma_f32_16x16x32_bf16 v[236:239], a[20:23], a[228:231], v[236:239]
    buffer_load_dwordx4 a[220:223], v37, s[8:11], s62 offen offset:1024 sc1
    v_mfma_f32_16x16x32_bf16 a[104:107], a[20:23], a[232:235], a[104:107]
    v_mfma_f32_16x16x32_bf16 a[108:111], a[20:23], a[236:239], a[108:111]
    v_mfma_f32_16x16x32_bf16 v[240:243], a[24:27], a[224:227], v[240:243]
    v_mfma_f32_16x16x32_bf16 v[244:247], a[24:27], a[228:231], v[244:247]
    v_mfma_f32_16x16x32_bf16 a[112:115], a[24:27], a[232:235], a[112:115]
    v_mfma_f32_16x16x32_bf16 a[116:119], a[24:27], a[236:239], a[116:119]
    s_add_u32 s62, s62, 0x20000
    v_mfma_f32_16x16x32_bf16 v[248:251], a[28:31], a[224:227], v[248:251]
    v_mfma_f32_16x16x32_bf16 v[252:255], a[28:31], a[228:231], v[252:255]
    v_mfma_f32_16x16x32_bf16 a[120:123], a[28:31], a[232:235], a[120:123]
    v_mfma_f32_16x16x32_bf16 a[124:127], a[28:31], a[236:239], a[124:127]
    s_waitcnt vmcnt(8) lgkmcnt(0)
    s_barrier
    v_mfma_f32_16x16x32_bf16 v[192:195], a[32:35], a[240:243], v[192:195]
    ds_read_b64_tr_b16 a[0:1], v42 offset:0
    ds_read_b64_tr_b16 a[2:3], v42 offset:1024
    v_mfma_f32_16x16x32_bf16 v[196:199], a[32:35], a[244:247], v[196:199]
    s_cmp_eq_u32 s30, 0
    s_cbranch_scc1 k12_ool_33
k12_oolret_34:
    v_mfma_f32_16x16x32_bf16 a[64:67], a[32:35], a[248:251], a[64:67]
    s_add_u32 m0, s60, 114688
    ds_read_b64_tr_b16 a[4:5], v43 offset:0
    v_mfma_f32_16x16x32_bf16 a[68:71], a[32:35], a[252:255], a[68:71]
    buffer_load_dwordx4 v38, s[12:15], s61 offen offset:0 lds
    ds_read_b64_tr_b16 a[6:7], v43 offset:1024
    v_mfma_f32_16x16x32_bf16 v[200:203], a[36:39], a[240:243], v[200:203]
    buffer_load_dwordx4 v39, s[12:15], s61 offen offset:1024 lds
    ds_read_b64_tr_b16 a[8:9], v44 offset:0
    v_mfma_f32_16x16x32_bf16 v[204:207], a[36:39], a[244:247], v[204:207]
    v_mfma_f32_16x16x32_bf16 a[72:75], a[36:39], a[248:251], a[72:75]
    ds_read_b64_tr_b16 a[10:11], v44 offset:1024
    v_mfma_f32_16x16x32_bf16 a[76:79], a[36:39], a[252:255], a[76:79]
    ds_read_b64_tr_b16 a[12:13], v45 offset:0
    v_mfma_f32_16x16x32_bf16 v[208:211], a[40:43], a[240:243], v[208:211]
    s_mov_b32 s32, s60
    buffer_load_dwordx4 v40, s[12:15], s61 offen offset:2048 lds
    v_mfma_f32_16x16x32_bf16 v[212:215], a[40:43], a[244:247], v[212:215]
    ds_read_b64_tr_b16 a[14:15], v45 offset:1024
    v_mfma_f32_16x16x32_bf16 a[80:83], a[40:43], a[248:251], a[80:83]
    s_mov_b32 s34, s60
    ds_read_b64_tr_b16 a[16:17], v46 offset:0
    v_mfma_f32_16x16x32_bf16 a[84:87], a[40:43], a[252:255], a[84:87]
    buffer_load_dwordx4 v41, s[12:15], s61 offen offset:3072 lds
    ds_read_b64_tr_b16 a[18:19], v46 offset:1024
    v_mfma_f32_16x16x32_bf16 v[216:219], a[44:47], a[240:243], v[216:219]
    v_mfma_f32_16x16x32_bf16 v[220:223], a[44:47], a[244:247], v[220:223]
    s_mov_b32 s33, s60
    ds_read_b64_tr_b16 a[20:21], v47 offset:0
    v_mfma_f32_16x16x32_bf16 a[88:91], a[44:47], a[248:251], a[88:91]
    s_add_u32 s61, s61, 0x80000
    buffer_load_dwordx4 a[224:227], v36, s[8:11], s62 offen offset:0 sc1
    ds_read_b64_tr_b16 a[22:23], v47 offset:1024
    v_mfma_f32_16x16x32_bf16 a[92:95], a[44:47], a[252:255], a[92:95]
    ds_read_b64_tr_b16 a[24:25], v48 offset:0
    v_mfma_f32_16x16x32_bf16 v[224:227], a[48:51], a[240:243], v[224:227]
    s_add_u32 s35, s60, 0x10000
    v_mfma_f32_16x16x32_bf16 v[228:231], a[48:51], a[244:247], v[228:231]
    ds_read_b64_tr_b16 a[26:27], v48 offset:1024
    v_mfma_f32_16x16x32_bf16 a[96:99], a[48:51], a[248:251], a[96:99]
    buffer_load_dwordx4 a[228:231], v36, s[8:11], s62 offen offset:1024 sc1
    ds_read_b64_tr_b16 a[28:29], v49 offset:0
    v_mfma_f32_16x16x32_bf16 a[100:103], a[48:51], a[252:255], a[100:103]
    v_mfma_f32_16x16x32_bf16 v[232:235], a[52:55], a[240:243], v[232:235]
    ds_read_b64_tr_b16 a[30:31], v49 offset:1024
    v_mfma_f32_16x16x32_bf16 v[236:239], a[52:55], a[244:247], v[236:239]
    buffer_load_dwordx4 a[232:235], v37, s[8:11], s62 offen offset:0 sc1
    v_mfma_f32_16x16x32_bf16 a[104:107], a[52:55], a[248:251], a[104:107]
    v_mfma_f32_16x16x32_bf16 a[108:111], a[52:55], a[252:255], a[108:111]
    v_mfma_f32_16x16x32_bf16 v[240:243], a[56:59], a[240:243], v[240:243]
    v_mfma_f32_16x16x32_bf16 v[244:247], a[56:59], a[244:247], v[244:247]
    buffer_load_dwordx4 a[236:239], v37, s[8:11], s62 offen offset:1024 sc1
    v_mfma_f32_16x16x32_bf16 a[112:115], a[56:59], a[248:251], a[112:115]
    v_mfma_f32_16x16x32_bf16 a[116:119], a[56:59], a[252:255], a[116:119]
    s_add_u32 s62, s62, 0x20000
    v_mfma_f32_16x16x32_bf16 v[248:251], a[60:63], a[240:243], v[248:251]
    v_mfma_f32_16x16x32_bf16 v[252:255], a[60:63], a[244:247], v[252:255]
    v_mfma_f32_16x16x32_bf16 a[120:123], a[60:63], a[248:251], a[120:123]
    v_mfma_f32_16x16x32_bf16 a[124:127], a[60:63], a[252:255], a[124:127]
    s_waitcnt vmcnt(12) lgkmcnt(0)
    v_mfma_f32_16x16x32_bf16 v[192:195], a[0:3], a[192:195], v[192:195]
    ds_read_b64_tr_b16 a[32:33], v42 offset:8192
    ds_read_b64_tr_b16 a[34:35], v42 offset:9216
    v_mfma_f32_16x16x32_bf16 v[196:199], a[0:3], a[196:199], v[196:199]
    buffer_load_dwordx4 a[240:243], v36, s[8:11], s62 offen offset:0 sc1
    v_mfma_f32_16x16x32_bf16 a[64:67], a[0:3], a[200:203], a[64:67]
    ds_read_b64_tr_b16 a[36:37], v43 offset:8192
    v_mfma_f32_16x16x32_bf16 a[68:71], a[0:3], a[204:207], a[68:71]
    ds_read_b64_tr_b16 a[38:39], v43 offset:9216
    v_mfma_f32_16x16x32_bf16 v[200:203], a[4:7], a[192:195], v[200:203]
    ds_read_b64_tr_b16 a[40:41], v44 offset:8192
    v_mfma_f32_16x16x32_bf16 v[204:207], a[4:7], a[196:199], v[204:207]
    v_mfma_f32_16x16x32_bf16 a[72:75], a[4:7], a[200:203], a[72:75]
    ds_read_b64_tr_b16 a[42:43], v44 offset:9216
    v_mfma_f32_16x16x32_bf16 a[76:79], a[4:7], a[204:207], a[76:79]
    ds_read_b64_tr_b16 a[44:45], v45 offset:8192
    v_mfma_f32_16x16x32_bf16 v[208:211], a[8:11], a[192:195], v[208:211]
    buffer_load_dwordx4 a[244:247], v36, s[8:11], s62 offen offset:1024 sc1
    v_mfma_f32_16x16x32_bf16 v[212:215], a[8:11], a[196:199], v[212:215]
    ds_read_b64_tr_b16 a[46:47], v45 offset:9216
    v_mfma_f32_16x16x32_bf16 a[80:83], a[8:11], a[200:203], a[80:83]
    ds_read_b64_tr_b16 a[48:49], v46 offset:8192
    v_mfma_f32_16x16x32_bf16 a[84:87], a[8:11], a[204:207], a[84:87]
    ds_read_b64_tr_b16 a[50:51], v46 offset:9216
    v_mfma_f32_16x16x32_bf16 v[216:219], a[12:15], a[192:195], v[216:219]
    v_mfma_f32_16x16x32_bf16 v[220:223], a[12:15], a[196:199], v[220:223]
    ds_read_b64_tr_b16 a[52:53], v47 offset:8192
    v_mfma_f32_16x16x32_bf16 a[88:91], a[12:15], a[200:203], a[88:91]
    buffer_load_dwordx4 a[248:251], v37, s[8:11], s62 offen offset:0 sc1
    ds_read_b64_tr_b16 a[54:55], v47 offset:9216
    v_mfma_f32_16x16x32_bf16 a[92:95], a[12:15], a[204:207], a[92:95]
    ds_read_b64_tr_b16 a[56:57], v48 offset:8192
    v_mfma_f32_16x16x32_bf16 v[224:227], a[16:19], a[192:195], v[224:227]
    v_mfma_f32_16x16x32_bf16 v[228:231], a[16:19], a[196:199], v[228:231]
    ds_read_b64_tr_b16 a[58:59], v48 offset:9216
    v_mfma_f32_16x16x32_bf16 a[96:99], a[16:19], a[200:203], a[96:99]
    ds_read_b64_tr_b16 a[60:61], v49 offset:8192
    v_mfma_f32_16x16x32_bf16 a[100:103], a[16:19], a[204:207], a[100:103]
    v_mfma_f32_16x16x32_bf16 v[232:235], a[20:23], a[192:195], v[232:235]
    ds_read_b64_tr_b16 a[62:63], v49 offset:9216
    v_mfma_f32_16x16x32_bf16 v[236:239], a[20:23], a[196:199], v[236:239]
    buffer_load_dwordx4 a[252:255], v37, s[8:11], s62 offen offset:1024 sc1
    v_mfma_f32_16x16x32_bf16 a[104:107], a[20:23], a[200:203], a[104:107]
    v_mfma_f32_16x16x32_bf16 a[108:111], a[20:23], a[204:207], a[108:111]
    v_mfma_f32_16x16x32_bf16 v[240:243], a[24:27], a[192:195], v[240:243]
    v_mfma_f32_16x16x32_bf16 v[244:247], a[24:27], a[196:199], v[244:247]
    v_mfma_f32_16x16x32_bf16 a[112:115], a[24:27], a[200:203], a[112:115]
    v_mfma_f32_16x16x32_bf16 a[116:119], a[24:27], a[204:207], a[116:119]
    s_add_u32 s62, s62, 0x20000
    v_mfma_f32_16x16x32_bf16 v[248:251], a[28:31], a[192:195], v[248:251]
    v_mfma_f32_16x16x32_bf16 v[252:255], a[28:31], a[196:199], v[252:255]
    v_mfma_f32_16x16x32_bf16 a[120:123], a[28:31], a[200:203], a[120:123]
    v_mfma_f32_16x16x32_bf16 a[124:127], a[28:31], a[204:207], a[124:127]
    s_waitcnt vmcnt(8) lgkmcnt(0)
    s_barrier
    v_mfma_f32_16x16x32_bf16 v[192:195], a[32:35], a[208:211], v[192:195]
    ds_read_b64_tr_b16 a[0:1], v42 offset:16384
    ds_read_b64_tr_b16 a[2:3], v42 offset:17408
    v_mfma_f32_16x16x32_bf16 v[196:199], a[32:35], a[212:215], v[196:199]
    s_add_u32 m0, s60, 131072
    v_mfma_f32_16x16x32_bf16 a[64:67], a[32:35], a[216:219], a[64:67]
    buffer_load_dwordx4 v38, s[12:15], s61 offen offset:0 lds
    ds_read_b64_tr_b16 a[4:5], v43 offset:16384
    v_mfma_f32_16x16x32_bf16 a[68:71], a[32:35], a[220:223], a[68:71]
    ds_read_b64_tr_b16 a[6:7], v43 offset:17408
    v_mfma_f32_16x16x32_bf16 v[200:203], a[36:39], a[208:211], v[200:203]
    buffer_load_dwordx4 v39, s[12:15], s61 offen offset:1024 lds
    ds_read_b64_tr_b16 a[8:9], v44 offset:16384
    v_mfma_f32_16x16x32_bf16 v[204:207], a[36:39], a[212:215], v[204:207]
    v_mfma_f32_16x16x32_bf16 a[72:75], a[36:39], a[216:219], a[72:75]
    ds_read_b64_tr_b16 a[10:11], v44 offset:17408
    v_mfma_f32_16x16x32_bf16 a[76:79], a[36:39], a[220:223], a[76:79]
    ds_read_b64_tr_b16 a[12:13], v45 offset:16384
    v_mfma_f32_16x16x32_bf16 v[208:211], a[40:43], a[208:211], v[208:211]
    buffer_load_dwordx4 v40, s[12:15], s61 offen offset:2048 lds
    v_mfma_f32_16x16x32_bf16 v[212:215], a[40:43], a[212:215], v[212:215]
    ds_read_b64_tr_b16 a[14:15], v45 offset:17408
    v_mfma_f32_16x16x32_bf16 a[80:83], a[40:43], a[216:219], a[80:83]
    ds_read_b64_tr_b16 a[16:17], v46 offset:16384
    v_mfma_f32_16x16x32_bf16 a[84:87], a[40:43], a[220:223], a[84:87]
    buffer_load_dwordx4 v41, s[12:15], s61 offen offset:3072 lds
    ds_read_b64_tr_b16 a[18:19], v46 offset:17408
    v_mfma_f32_16x16x32_bf16 v[216:219], a[44:47], a[208:211], v[216:219]
    v_mfma_f32_16x16x32_bf16 v[220:223], a[44:47], a[212:215], v[220:223]
    s_add_u32 s61, s61, 0x80000
    ds_read_b64_tr_b16 a[20:21], v47 offset:16384
    v_mfma_f32_16x16x32_bf16 a[88:91], a[44:47], a[216:219], a[88:91]
    buffer_load_dwordx4 a[192:195], v36, s[8:11], s62 offen offset:0 sc1
    ds_read_b64_tr_b16 a[22:23], v47 offset:17408
    v_mfma_f32_16x16x32_bf16 a[92:95], a[44:47], a[220:223], a[92:95]
    ds_read_b64_tr_b16 a[24:25], v48 offset:16384
    v_mfma_f32_16x16x32_bf16 v[224:227], a[48:51], a[208:211], v[224:227]
    v_mfma_f32_16x16x32_bf16 v[228:231], a[48:51], a[212:215], v[228:231]
    ds_read_b64_tr_b16 a[26:27], v48 offset:17408
    v_mfma_f32_16x16x32_bf16 a[96:99], a[48:51], a[216:219], a[96:99]
    buffer_load_dwordx4 a[196:199], v36, s[8:11], s62 offen offset:1024 sc1
    ds_read_b64_tr_b16 a[28:29], v49 offset:16384
    v_mfma_f32_16x16x32_bf16 a[100:103], a[48:51], a[220:223], a[100:103]
    v_mfma_f32_16x16x32_bf16 v[232:235], a[52:55], a[208:211], v[232:235]
    ds_read_b64_tr_b16 a[30:31], v49 offset:17408
    v_mfma_f32_16x16x32_bf16 v[236:239], a[52:55], a[212:215], v[236:239]
    buffer_load_dwordx4 a[200:203], v37, s[8:11], s62 offen offset:0 sc1
    v_mfma_f32_16x16x32_bf16 a[104:107], a[52:55], a[216:219], a[104:107]
    v_mfma_f32_16x16x32_bf16 a[108:111], a[52:55], a[220:223], a[108:111]
    v_mfma_f32_16x16x32_bf16 v[240:243], a[56:59], a[208:211], v[240:243]
    v_mfma_f32_16x16x32_bf16 v[244:247], a[56:59], a[212:215], v[244:247]
    buffer_load_dwordx4 a[204:207], v37, s[8:11], s62 offen offset:1024 sc1
    v_mfma_f32_16x16x32_bf16 a[112:115], a[56:59], a[216:219], a[112:115]
    v_mfma_f32_16x16x32_bf16 a[116:119], a[56:59], a[220:223], a[116:119]
    s_add_u32 s62, s62, 0x20000
    v_mfma_f32_16x16x32_bf16 v[248:251], a[60:63], a[208:211], v[248:251]
    v_mfma_f32_16x16x32_bf16 v[252:255], a[60:63], a[212:215], v[252:255]
    v_mfma_f32_16x16x32_bf16 a[120:123], a[60:63], a[216:219], a[120:123]
    v_mfma_f32_16x16x32_bf16 a[124:127], a[60:63], a[220:223], a[124:127]
    s_waitcnt vmcnt(12) lgkmcnt(0)
    v_mfma_f32_16x16x32_bf16 v[192:195], a[0:3], a[224:227], v[192:195]
    ds_read_b64_tr_b16 a[32:33], v42 offset:24576
    ds_read_b64_tr_b16 a[34:35], v42 offset:25600
    v_mfma_f32_16x16x32_bf16 v[196:199], a[0:3], a[228:231], v[196:199]
    buffer_load_dwordx4 a[208:211], v36, s[8:11], s62 offen offset:0 sc1
    v_mfma_f32_16x16x32_bf16 a[64:67], a[0:3], a[232:235], a[64:67]
    ds_read_b64_tr_b16 a[36:37], v43 offset:24576
    v_mfma_f32_16x16x32_bf16 a[68:71], a[0:3], a[236:239], a[68:71]
    ds_read_b64_tr_b16 a[38:39], v43 offset:25600
    v_mfma_f32_16x16x32_bf16 v[200:203], a[4:7], a[224:227], v[200:203]
    ds_read_b64_tr_b16 a[40:41], v44 offset:24576
    v_mfma_f32_16x16x32_bf16 v[204:207], a[4:7], a[228:231], v[204:207]
    v_mfma_f32_16x16x32_bf16 a[72:75], a[4:7], a[232:235], a[72:75]
    ds_read_b64_tr_b16 a[42:43], v44 offset:25600
    v_mfma_f32_16x16x32_bf16 a[76:79], a[4:7], a[236:239], a[76:79]
    ds_read_b64_tr_b16 a[44:45], v45 offset:24576
    v_mfma_f32_16x16x32_bf16 v[208:211], a[8:11], a[224:227], v[208:211]
    buffer_load_dwordx4 a[212:215], v36, s[8:11], s62 offen offset:1024 sc1
    v_mfma_f32_16x16x32_bf16 v[212:215], a[8:11], a[228:231], v[212:215]
    ds_read_b64_tr_b16 a[46:47], v45 offset:25600
    v_mfma_f32_16x16x32_bf16 a[80:83], a[8:11], a[232:235], a[80:83]
    ds_read_b64_tr_b16 a[48:49], v46 offset:24576
    v_mfma_f32_16x16x32_bf16 a[84:87], a[8:11], a[236:239], a[84:87]
    ds_read_b64_tr_b16 a[50:51], v46 offset:25600
    v_mfma_f32_16x16x32_bf16 v[216:219], a[12:15], a[224:227], v[216:219]
    v_mfma_f32_16x16x32_bf16 v[220:223], a[12:15], a[228:231], v[220:223]
    ds_read_b64_tr_b16 a[52:53], v47 offset:24576
    v_mfma_f32_16x16x32_bf16 a[88:91], a[12:15], a[232:235], a[88:91]
    buffer_load_dwordx4 a[216:219], v37, s[8:11], s62 offen offset:0 sc1
    ds_read_b64_tr_b16 a[54:55], v47 offset:25600
    v_mfma_f32_16x16x32_bf16 a[92:95], a[12:15], a[236:239], a[92:95]
    ds_read_b64_tr_b16 a[56:57], v48 offset:24576
    v_mfma_f32_16x16x32_bf16 v[224:227], a[16:19], a[224:227], v[224:227]
    v_mfma_f32_16x16x32_bf16 v[228:231], a[16:19], a[228:231], v[228:231]
    ds_read_b64_tr_b16 a[58:59], v48 offset:25600
    v_mfma_f32_16x16x32_bf16 a[96:99], a[16:19], a[232:235], a[96:99]
    ds_read_b64_tr_b16 a[60:61], v49 offset:24576
    v_mfma_f32_16x16x32_bf16 a[100:103], a[16:19], a[236:239], a[100:103]
    v_mfma_f32_16x16x32_bf16 v[232:235], a[20:23], a[224:227], v[232:235]
    ds_read_b64_tr_b16 a[62:63], v49 offset:25600
    v_mfma_f32_16x16x32_bf16 v[236:239], a[20:23], a[228:231], v[236:239]
    buffer_load_dwordx4 a[220:223], v37, s[8:11], s62 offen offset:1024 sc1
    v_mfma_f32_16x16x32_bf16 a[104:107], a[20:23], a[232:235], a[104:107]
    v_mfma_f32_16x16x32_bf16 a[108:111], a[20:23], a[236:239], a[108:111]
    v_mfma_f32_16x16x32_bf16 v[240:243], a[24:27], a[224:227], v[240:243]
    v_mfma_f32_16x16x32_bf16 v[244:247], a[24:27], a[228:231], v[244:247]
    v_mfma_f32_16x16x32_bf16 a[112:115], a[24:27], a[232:235], a[112:115]
    v_mfma_f32_16x16x32_bf16 a[116:119], a[24:27], a[236:239], a[116:119]
    s_add_u32 s62, s62, 0x20000
    v_mfma_f32_16x16x32_bf16 v[248:251], a[28:31], a[224:227], v[248:251]
    v_mfma_f32_16x16x32_bf16 v[252:255], a[28:31], a[228:231], v[252:255]
    v_mfma_f32_16x16x32_bf16 a[120:123], a[28:31], a[232:235], a[120:123]
    v_mfma_f32_16x16x32_bf16 a[124:127], a[28:31], a[236:239], a[124:127]
    s_waitcnt vmcnt(8) lgkmcnt(0)
    s_barrier
    v_mfma_f32_16x16x32_bf16 v[192:195], a[32:35], a[240:243], v[192:195]
    ds_read_b64_tr_b16 a[0:1], v42 offset:32768
    ds_read_b64_tr_b16 a[2:3], v42 offset:33792
    v_mfma_f32_16x16x32_bf16 v[196:199], a[32:35], a[244:247], v[196:199]
    s_cmp_eq_u32 s30, 0
    s_cbranch_scc1 k12_ool_35
k12_oolret_36:
    v_mfma_f32_16x16x32_bf16 a[64:67], a[32:35], a[248:251], a[64:67]
    s_add_u32 m0, s60, 147456
    ds_read_b64_tr_b16 a[4:5], v43 offset:32768
    v_mfma_f32_16x16x32_bf16 a[68:71], a[32:35], a[252:255], a[68:71]
    buffer_load_dwordx4 v38, s[12:15], s61 offen offset:0 lds
    ds_read_b64_tr_b16 a[6:7], v43 offset:33792
    v_mfma_f32_16x16x32_bf16 v[200:203], a[36:39], a[240:243], v[200:203]
    buffer_load_dwordx4 v39, s[12:15], s61 offen offset:1024 lds
    ds_read_b64_tr_b16 a[8:9], v44 offset:32768
    v_mfma_f32_16x16x32_bf16 v[204:207], a[36:39], a[244:247], v[204:207]
    v_mfma_f32_16x16x32_bf16 a[72:75], a[36:39], a[248:251], a[72:75]
    ds_read_b64_tr_b16 a[10:11], v44 offset:33792
    v_mfma_f32_16x16x32_bf16 a[76:79], a[36:39], a[252:255], a[76:79]
    ds_read_b64_tr_b16 a[12:13], v45 offset:32768
    v_mfma_f32_16x16x32_bf16 v[208:211], a[40:43], a[240:243], v[208:211]
    buffer_load_dwordx4 v40, s[12:15], s61 offen offset:2048 lds
    v_mfma_f32_16x16x32_bf16 v[212:215], a[40:43], a[244:247], v[212:215]
    ds_read_b64_tr_b16 a[14:15], v45 offset:33792
    v_mfma_f32_16x16x32_bf16 a[80:83], a[40:43], a[248:251], a[80:83]
    ds_read_b64_tr_b16 a[16:17], v46 offset:32768
    v_mfma_f32_16x16x32_bf16 a[84:87], a[40:43], a[252:255], a[84:87]
    buffer_load_dwordx4 v41, s[12:15], s61 offen offset:3072 lds
    ds_read_b64_tr_b16 a[18:19], v46 offset:33792
    v_mfma_f32_16x16x32_bf16 v[216:219], a[44:47], a[240:243], v[216:219]
    v_mfma_f32_16x16x32_bf16 v[220:223], a[44:47], a[244:247], v[220:223]
    s_add_u32 s61, s61, 0x80000
    ds_read_b64_tr_b16 a[20:21], v47 offset:32768
    v_mfma_f32_16x16x32_bf16 a[88:91], a[44:47], a[248:251], a[88:91]
    buffer_load_dwordx4 a[224:227], v36, s[8:11], s62 offen offset:0 sc1
    ds_read_b64_tr_b16 a[22:23], v47 offset:33792
    v_mfma_f32_16x16x32_bf16 a[92:95], a[44:47], a[252:255], a[92:95]
    ds_read_b64_tr_b16 a[24:25], v48 offset:32768
    v_mfma_f32_16x16x32_bf16 v[224:227], a[48:51], a[240:243], v[224:227]
    v_mfma_f32_16x16x32_bf16 v[228:231], a[48:51], a[244:247], v[228:231]
    ds_read_b64_tr_b16 a[26:27], v48 offset:33792
    v_mfma_f32_16x16x32_bf16 a[96:99], a[48:51], a[248:251], a[96:99]
    buffer_load_dwordx4 a[228:231], v36, s[8:11], s62 offen offset:1024 sc1
    ds_read_b64_tr_b16 a[28:29], v49 offset:32768
    v_mfma_f32_16x16x32_bf16 a[100:103], a[48:51], a[252:255], a[100:103]
    v_mfma_f32_16x16x32_bf16 v[232:235], a[52:55], a[240:243], v[232:235]
    ds_read_b64_tr_b16 a[30:31], v49 offset:33792
    v_mfma_f32_16x16x32_bf16 v[236:239], a[52:55], a[244:247], v[236:239]
    buffer_load_dwordx4 a[232:235], v37, s[8:11], s62 offen offset:0 sc1
    v_mfma_f32_16x16x32_bf16 a[104:107], a[52:55], a[248:251], a[104:107]
    v_mfma_f32_16x16x32_bf16 a[108:111], a[52:55], a[252:255], a[108:111]
    v_mfma_f32_16x16x32_bf16 v[240:243], a[56:59], a[240:243], v[240:243]
    v_mfma_f32_16x16x32_bf16 v[244:247], a[56:59], a[244:247], v[244:247]
    buffer_load_dwordx4 a[236:239], v37, s[8:11], s62 offen offset:1024 sc1
    v_mfma_f32_16x16x32_bf16 a[112:115], a[56:59], a[248:251], a[112:115]
    v_mfma_f32_16x16x32_bf16 a[116:119], a[56:59], a[252:255], a[116:119]
    s_add_u32 s62, s62, 0x20000
    v_mfma_f32_16x16x32_bf16 v[248:251], a[60:63], a[240:243], v[248:251]
    v_mfma_f32_16x16x32_bf16 v[252:255], a[60:63], a[244:247], v[252:255]
    v_mfma_f32_16x16x32_bf16 a[120:123], a[60:63], a[248:251], a[120:123]
    v_mfma_f32_16x16x32_bf16 a[124:127], a[60:63], a[252:255], a[124:127]
    s_waitcnt vmcnt(12) lgkmcnt(0)
    v_mfma_f32_16x16x32_bf16 v[192:195], a[0:3], a[192:195], v[192:195]
    ds_read_b64_tr_b16 a[32:33], v42 offset:40960
    ds_read_b64_tr_b16 a[34:35], v42 offset:41984
    v_mfma_f32_16x16x32_bf16 v[196:199], a[0:3], a[196:199], v[196:199]
    buffer_load_dwordx4 a[240:243], v36, s[8:11], s62 offen offset:0 sc1
    v_mfma_f32_16x16x32_bf16 a[64:67], a[0:3], a[200:203], a[64:67]
    ds_read_b64_tr_b16 a[36:37], v43 offset:40960
    v_mfma_f32_16x16x32_bf16 a[68:71], a[0:3], a[204:207], a[68:71]
    ds_read_b64_tr_b16 a[38:39], v43 offset:41984
    v_mfma_f32_16x16x32_bf16 v[200:203], a[4:7], a[192:195], v[200:203]
    ds_read_b64_tr_b16 a[40:41], v44 offset:40960
    v_mfma_f32_16x16x32_bf16 v[204:207], a[4:7], a[196:199], v[204:207]
    v_mfma_f32_16x16x32_bf16 a[72:75], a[4:7], a[200:203], a[72:75]
    ds_read_b64_tr_b16 a[42:43], v44 offset:41984
    v_mfma_f32_16x16x32_bf16 a[76:79], a[4:7], a[204:207], a[76:79]
    ds_read_b64_tr_b16 a[44:45], v45 offset:40960
    v_mfma_f32_16x16x32_bf16 v[208:211], a[8:11], a[192:195], v[208:211]
    buffer_load_dwordx4 a[244:247], v36, s[8:11], s62 offen offset:1024 sc1
    v_mfma_f32_16x16x32_bf16 v[212:215], a[8:11], a[196:199], v[212:215]
    ds_read_b64_tr_b16 a[46:47], v45 offset:41984
    v_mfma_f32_16x16x32_bf16 a[80:83], a[8:11], a[200:203], a[80:83]
    ds_read_b64_tr_b16 a[48:49], v46 offset:40960
    v_mfma_f32_16x16x32_bf16 a[84:87], a[8:11], a[204:207], a[84:87]
    ds_read_b64_tr_b16 a[50:51], v46 offset:41984
    v_mfma_f32_16x16x32_bf16 v[216:219], a[12:15], a[192:195], v[216:219]
    v_mfma_f32_16x16x32_bf16 v[220:223], a[12:15], a[196:199], v[220:223]
    ds_read_b64_tr_b16 a[52:53], v47 offset:40960
    v_mfma_f32_16x16x32_bf16 a[88:91], a[12:15], a[200:203], a[88:91]
    buffer_load_dwordx4 a[248:251], v37, s[8:11], s62 offen offset:0 sc1
    ds_read_b64_tr_b16 a[54:55], v47 offset:41984
    v_mfma_f32_16x16x32_bf16 a[92:95], a[12:15], a[204:207], a[92:95]
    ds_read_b64_tr_b16 a[56:57], v48 offset:40960
    v_mfma_f32_16x16x32_bf16 v[224:227], a[16:19], a[192:195], v[224:227]
    v_mfma_f32_16x16x32_bf16 v[228:231], a[16:19], a[196:199], v[228:231]
    ds_read_b64_tr_b16 a[58:59], v48 offset:41984
    v_mfma_f32_16x16x32_bf16 a[96:99], a[16:19], a[200:203], a[96:99]
    ds_read_b64_tr_b16 a[60:61], v49 offset:40960
    v_mfma_f32_16x16x32_bf16 a[100:103], a[16:19], a[204:207], a[100:103]
    v_mfma_f32_16x16x32_bf16 v[232:235], a[20:23], a[192:195], v[232:235]
    ds_read_b64_tr_b16 a[62:63], v49 offset:41984
    v_mfma_f32_16x16x32_bf16 v[236:239], a[20:23], a[196:199], v[236:239]
    buffer_load_dwordx4 a[252:255], v37, s[8:11], s62 offen offset:1024 sc1
    v_mfma_f32_16x16x32_bf16 a[104:107], a[20:23], a[200:203], a[104:107]
    v_mfma_f32_16x16x32_bf16 a[108:111], a[20:23], a[204:207], a[108:111]
    v_mfma_f32_16x16x32_bf16 v[240:243], a[24:27], a[192:195], v[240:243]
    v_mfma_f32_16x16x32_bf16 v[244:247], a[24:27], a[196:199], v[244:247]
    v_mfma_f32_16x16x32_bf16 a[112:115], a[24:27], a[200:203], a[112:115]
    v_mfma_f32_16x16x32_bf16 a[116:119], a[24:27], a[204:207], a[116:119]
    s_add_u32 s62, s62, 0x20000
    v_mfma_f32_16x16x32_bf16 v[248:251], a[28:31], a[192:195], v[248:251]
    s_cmp_eq_u32 s30, 0
    s_cbranch_scc1 k12_ool_39
k12_oolret_40:
    v_mfma_f32_16x16x32_bf16 v[252:255], a[28:31], a[196:199], v[252:255]
    v_mfma_f32_16x16x32_bf16 a[120:123], a[28:31], a[200:203], a[120:123]
    v_mfma_f32_16x16x32_bf16 a[124:127], a[28:31], a[204:207], a[124:127]
    s_waitcnt vmcnt(8) lgkmcnt(0)
    s_barrier
    v_mfma_f32_16x16x32_bf16 v[192:195], a[32:35], a[208:211], v[192:195]
    ds_read_b64_tr_b16 a[0:1], v42 offset:49152
    ds_read_b64_tr_b16 a[2:3], v42 offset:50176
    v_mfma_f32_16x16x32_bf16 v[196:199], a[32:35], a[212:215], v[196:199]
    s_mov_b32 m0, s34
    v_mfma_f32_16x16x32_bf16 a[64:67], a[32:35], a[216:219], a[64:67]
    buffer_load_dwordx4 v1, s[16:19], s32 offen offset:0 sc1 lds
    ds_read_b64_tr_b16 a[4:5], v43 offset:49152
    v_mfma_f32_16x16x32_bf16 a[68:71], a[32:35], a[220:223], a[68:71]
    ds_read_b64_tr_b16 a[6:7], v43 offset:50176
    v_mfma_f32_16x16x32_bf16 v[200:203], a[36:39], a[208:211], v[200:203]
    buffer_load_dwordx4 v1, s[16:19], s32 offen offset:1024 sc1 lds
    ds_read_b64_tr_b16 a[8:9], v44 offset:49152
    v_mfma_f32_16x16x32_bf16 v[204:207], a[36:39], a[212:215], v[204:207]
    v_mfma_f32_16x16x32_bf16 a[72:75], a[36:39], a[216:219], a[72:75]
    ds_read_b64_tr_b16 a[10:11], v44 offset:50176
    v_mfma_f32_16x16x32_bf16 a[76:79], a[36:39], a[220:223], a[76:79]
    ds_read_b64_tr_b16 a[12:13], v45 offset:49152
    v_mfma_f32_16x16x32_bf16 v[208:211], a[40:43], a[208:211], v[208:211]
    buffer_load_dwordx4 v1, s[16:19], s32 offen offset:2048 sc1 lds
    v_mfma_f32_16x16x32_bf16 v[212:215], a[40:43], a[212:215], v[212:215]
    ds_read_b64_tr_b16 a[14:15], v45 offset:50176
    v_mfma_f32_16x16x32_bf16 a[80:83], a[40:43], a[216:219], a[80:83]
    ds_read_b64_tr_b16 a[16:17], v46 offset:49152
    v_mfma_f32_16x16x32_bf16 a[84:87], a[40:43], a[220:223], a[84:87]
    buffer_load_dwordx4 v1, s[16:19], s32 offen offset:3072 sc1 lds
    ds_read_b64_tr_b16 a[18:19], v46 offset:50176
    v_mfma_f32_16x16x32_bf16 v[216:219], a[44:47], a[208:211], v[216:219]
    v_mfma_f32_16x16x32_bf16 v[220:223], a[44:47], a[212:215], v[220:223]
    s_add_u32 s32, s32, 0x80000
    ds_read_b64_tr_b16 a[20:21], v47 offset:49152
    v_mfma_f32_16x16x32_bf16 a[88:91], a[44:47], a[216:219], a[88:91]
    s_add_u32 s34, s34, 0x4000
    ds_read_b64_tr_b16 a[22:23], v47 offset:50176
    v_mfma_f32_16x16x32_bf16 a[92:95], a[44:47], a[220:223], a[92:95]
    s_mov_b32 m0, s34
    ds_read_b64_tr_b16 a[24:25], v48 offset:49152
    v_mfma_f32_16x16x32_bf16 v[224:227], a[48:51], a[208:211], v[224:227]
    buffer_load_dwordx4 v1, s[16:19], s32 offen offset:0 sc1 lds
    v_mfma_f32_16x16x32_bf16 v[228:231], a[48:51], a[212:215], v[228:231]
    ds_read_b64_tr_b16 a[26:27], v48 offset:50176
    v_mfma_f32_16x16x32_bf16 a[96:99], a[48:51], a[216:219], a[96:99]
    buffer_load_dwordx4 v1, s[16:19], s32 offen offset:1024 sc1 lds
    ds_read_b64_tr_b16 a[28:29], v49 offset:49152
    v_mfma_f32_16x16x32_bf16 a[100:103], a[48:51], a[220:223], a[100:103]
    v_mfma_f32_16x16x32_bf16 v[232:235], a[52:55], a[208:211], v[232:235]
    ds_read_b64_tr_b16 a[30:31], v49 offset:50176
    v_mfma_f32_16x16x32_bf16 v[236:239], a[52:55], a[212:215], v[236:239]
    buffer_load_dwordx4 v1, s[16:19], s32 offen offset:2048 sc1 lds
    v_mfma_f32_16x16x32_bf16 a[104:107], a[52:55], a[216:219], a[104:107]
    v_mfma_f32_16x16x32_bf16 a[108:111], a[52:55], a[220:223], a[108:111]
    v_mfma_f32_16x16x32_bf16 v[240:243], a[56:59], a[208:211], v[240:243]
    v_mfma_f32_16x16x32_bf16 v[244:247], a[56:59], a[212:215], v[244:247]
    buffer_load_dwordx4 v1, s[16:19], s32 offen offset:3072 sc1 lds
    v_mfma_f32_16x16x32_bf16 a[112:115], a[56:59], a[216:219], a[112:115]
    v_mfma_f32_16x16x32_bf16 a[116:119], a[56:59], a[220:223], a[116:119]
    s_add_u32 s32, s32, 0x80000
    v_mfma_f32_16x16x32_bf16 v[248:251], a[60:63], a[208:211], v[248:251]
    s_add_u32 s34, s34, 0x4000
    v_mfma_f32_16x16x32_bf16 v[252:255], a[60:63], a[212:215], v[252:255]
    v_mfma_f32_16x16x32_bf16 a[120:123], a[60:63], a[216:219], a[120:123]
    v_mfma_f32_16x16x32_bf16 a[124:127], a[60:63], a[220:223], a[124:127]
    s_waitcnt vmcnt(12) lgkmcnt(0)
    v_mfma_f32_16x16x32_bf16 v[192:195], a[0:3], a[224:227], v[192:195]
    ds_read_b64_tr_b16 a[32:33], v42 offset:57344
    ds_read_b64_tr_b16 a[34:35], v42 offset:58368
    v_mfma_f32_16x16x32_bf16 v[196:199], a[0:3], a[228:231], v[196:199]
    s_mov_b32 m0, s35
    v_mfma_f32_16x16x32_bf16 a[64:67], a[0:3], a[232:235], a[64:67]
    buffer_load_dwordx4 v1, s[20:23], s33 offen offset:0 sc1 lds
    ds_read_b64_tr_b16 a[36:37], v43 offset:57344
    v_mfma_f32_16x16x32_bf16 a[68:71], a[0:3], a[236:239], a[68:71]
    ds_read_b64_tr_b16 a[38:39], v43 offset:58368
    v_mfma_f32_16x16x32_bf16 v[200:203], a[4:7], a[224:227], v[200:203]
    buffer_load_dwordx4 v1, s[20:23], s33 offen offset:1024 sc1 lds
    ds_read_b64_tr_b16 a[40:41], v44 offset:57344
    v_mfma_f32_16x16x32_bf16 v[204:207], a[4:7], a[228:231], v[204:207]
    v_mfma_f32_16x16x32_bf16 a[72:75], a[4:7], a[232:235], a[72:75]
    ds_read_b64_tr_b16 a[42:43], v44 offset:58368
    v_mfma_f32_16x16x32_bf16 a[76:79], a[4:7], a[236:239], a[76:79]
    ds_read_b64_tr_b16 a[44:45], v45 offset:57344
    v_mfma_f32_16x16x32_bf16 v[208:211], a[8:11], a[224:227], v[208:211]
    buffer_load_dwordx4 v1, s[20:23], s33 offen offset:2048 sc1 lds
    v_mfma_f32_16x16x32_bf16 v[212:215], a[8:11], a[228:231], v[212:215]
    ds_read_b64_tr_b16 a[46:47], v45 offset:58368
    v_mfma_f32_16x16x32_bf16 a[80:83], a[8:11], a[232:235], a[80:83]
    ds_read_b64_tr_b16 a[48:49], v46 offset:57344
    v_mfma_f32_16x16x32_bf16 a[84:87], a[8:11], a[236:239], a[84:87]
    buffer_load_dwordx4 v1, s[20:23], s33 offen offset:3072 sc1 lds
    ds_read_b64_tr_b16 a[50:51], v46 offset:58368
    v_mfma_f32_16x16x32_bf16 v[216:219], a[12:15], a[224:227], v[216:219]
    v_mfma_f32_16x16x32_bf16 v[220:223], a[12:15], a[228:231], v[220:223]
    s_add_u32 s33, s33, 0x80000
    ds_read_b64_tr_b16 a[52:53], v47 offset:57344
    v_mfma_f32_16x16x32_bf16 a[88:91], a[12:15], a[232:235], a[88:91]
    s_add_u32 s35, s35, 0x4000
    ds_read_b64_tr_b16 a[54:55], v47 offset:58368
    v_mfma_f32_16x16x32_bf16 a[92:95], a[12:15], a[236:239], a[92:95]
    s_mov_b32 m0, s34
    ds_read_b64_tr_b16 a[56:57], v48 offset:57344
    v_mfma_f32_16x16x32_bf16 v[224:227], a[16:19], a[224:227], v[224:227]
    buffer_load_dwordx4 v1, s[16:19], s32 offen offset:0 sc1 lds
    v_mfma_f32_16x16x32_bf16 v[228:231], a[16:19], a[228:231], v[228:231]
    ds_read_b64_tr_b16 a[58:59], v48 offset:58368
    v_mfma_f32_16x16x32_bf16 a[96:99], a[16:19], a[232:235], a[96:99]
    buffer_load_dwordx4 v1, s[16:19], s32 offen offset:1024 sc1 lds
    ds_read_b64_tr_b16 a[60:61], v49 offset:57344
    v_mfma_f32_16x16x32_bf16 a[100:103], a[16:19], a[236:239], a[100:103]
    v_mfma_f32_16x16x32_bf16 v[232:235], a[20:23], a[224:227], v[232:235]
    ds_read_b64_tr_b16 a[62:63], v49 offset:58368
    v_mfma_f32_16x16x32_bf16 v[236:239], a[20:23], a[228:231], v[236:239]
    buffer_load_dwordx4 v1, s[16:19], s32 offen offset:2048 sc1 lds
    v_mfma_f32_16x16x32_bf16 a[104:107], a[20:23], a[232:235], a[104:107]
    v_mfma_f32_16x16x32_bf16 a[108:111], a[20:23], a[236:239], a[108:111]
    v_mfma_f32_16x16x32_bf16 v[240:243], a[24:27], a[224:227], v[240:243]
    v_mfma_f32_16x16x32_bf16 v[244:247], a[24:27], a[228:231], v[244:247]
    buffer_load_dwordx4 v1, s[16:19], s32 offen offset:3072 sc1 lds
    v_mfma_f32_16x16x32_bf16 a[112:115], a[24:27], a[232:235], a[112:115]
    v_mfma_f32_16x16x32_bf16 a[116:119], a[24:27], a[236:239], a[116:119]
    s_add_u32 s32, s32, 0x80000
    v_mfma_f32_16x16x32_bf16 v[248:251], a[28:31], a[224:227], v[248:251]
    s_add_u32 s34, s34, 0x4000
    v_mfma_f32_16x16x32_bf16 v[252:255], a[28:31], a[228:231], v[252:255]
    v_mfma_f32_16x16x32_bf16 a[120:123], a[28:31], a[232:235], a[120:123]
    v_mfma_f32_16x16x32_bf16 a[124:127], a[28:31], a[236:239], a[124:127]
    s_waitcnt vmcnt(16) lgkmcnt(0)
    s_barrier
    v_mfma_f32_16x16x32_bf16 v[192:195], a[32:35], a[240:243], v[192:195]
    v_mfma_f32_16x16x32_bf16 v[196:199], a[32:35], a[244:247], v[196:199]
    s_mov_b32 m0, s35
    v_mfma_f32_16x16x32_bf16 a[64:67], a[32:35], a[248:251], a[64:67]
    buffer_load_dwordx4 v1, s[20:23], s33 offen offset:0 sc1 lds
    v_mfma_f32_16x16x32_bf16 a[68:71], a[32:35], a[252:255], a[68:71]
    v_mfma_f32_16x16x32_bf16 v[200:203], a[36:39], a[240:243], v[200:203]
    v_mfma_f32_16x16x32_bf16 v[204:207], a[36:39], a[244:247], v[204:207]
    v_mfma_f32_16x16x32_bf16 a[72:75], a[36:39], a[248:251], a[72:75]
    v_mfma_f32_16x16x32_bf16 a[76:79], a[36:39], a[252:255], a[76:79]
    v_mfma_f32_16x16x32_bf16 v[208:211], a[40:43], a[240:243], v[208:211]
    buffer_load_dwordx4 v1, s[20:23], s33 offen offset:1024 sc1 lds
    v_mfma_f32_16x16x32_bf16 v[212:215], a[40:43], a[244:247], v[212:215]
    v_mfma_f32_16x16x32_bf16 a[80:83], a[40:43], a[248:251], a[80:83]
    v_mfma_f32_16x16x32_bf16 a[84:87], a[40:43], a[252:255], a[84:87]
    v_mfma_f32_16x16x32_bf16 v[216:219], a[44:47], a[240:243], v[216:219]
    v_mfma_f32_16x16x32_bf16 v[220:223], a[44:47], a[244:247], v[220:223]
    v_mfma_f32_16x16x32_bf16 a[88:91], a[44:47], a[248:251], a[88:91]
    buffer_load_dwordx4 v1, s[20:23], s33 offen offset:2048 sc1 lds
    v_mfma_f32_16x16x32_bf16 a[92:95], a[44:47], a[252:255], a[92:95]
    v_mfma_f32_16x16x32_bf16 v[224:227], a[48:51], a[240:243], v[224:227]
    v_mfma_f32_16x16x32_bf16 v[228:231], a[48:51], a[244:247], v[228:231]
    v_mfma_f32_16x16x32_bf16 a[96:99], a[48:51], a[248:251], a[96:99]
    v_mfma_f32_16x16x32_bf16 a[100:103], a[48:51], a[252:255], a[100:103]
    v_mfma_f32_16x16x32_bf16 v[232:235], a[52:55], a[240:243], v[232:235]
    v_mfma_f32_16x16x32_bf16 v[236:239], a[52:55], a[244:247], v[236:239]
    buffer_load_dwordx4 v1, s[20:23], s33 offen offset:3072 sc1 lds
    v_mfma_f32_16x16x32_bf16 a[104:107], a[52:55], a[248:251], a[104:107]
    v_mfma_f32_16x16x32_bf16 a[108:111], a[52:55], a[252:255], a[108:111]
    v_mfma_f32_16x16x32_bf16 v[240:243], a[56:59], a[240:243], v[240:243]
    v_mfma_f32_16x16x32_bf16 v[244:247], a[56:59], a[244:247], v[244:247]
    v_mfma_f32_16x16x32_bf16 a[112:115], a[56:59], a[248:251], a[112:115]
    v_mfma_f32_16x16x32_bf16 a[116:119], a[56:59], a[252:255], a[116:119]
    s_add_u32 s33, s33, 0x80000
    v_mfma_f32_16x16x32_bf16 v[248:251], a[60:63], a[240:243], v[248:251]
    s_add_u32 s35, s35, 0x4000
    v_mfma_f32_16x16x32_bf16 v[252:255], a[60:63], a[244:247], v[252:255]
    v_mfma_f32_16x16x32_bf16 a[120:123], a[60:63], a[248:251], a[120:123]
    v_mfma_f32_16x16x32_bf16 a[124:127], a[60:63], a[252:255], a[124:127]
    s_add_u32 s24, s6, 0x3000000
    s_addc_u32 s25, s7, 0
    s_and_b32 s25, s25, 0xffff
    s_mov_b32 s26, 0x1000000
    s_mov_b32 s27, 0x00020000
    s_load_dwordx2 s[44:45], s[0:1], 40
    s_load_dwordx2 s[46:47], s[0:1], 64
    s_load_dwordx4 s[48:51], s[0:1], 72
    s_mov_b32 s40, 0x3e0293ee
    s_mov_b32 s41, 0x3e0293ee
    s_mov_b32 m0, s34
    s_nop 0
    buffer_load_dwordx4 v1, s[16:19], s32 offen offset:0 sc1 lds
    buffer_load_dwordx4 v1, s[16:19], s32 offen offset:1024 sc1 lds
    buffer_load_dwordx4 v1, s[16:19], s32 offen offset:2048 sc1 lds
    buffer_load_dwordx4 v1, s[16:19], s32 offen offset:3072 sc1 lds
    s_mov_b32 m0, s35
    s_nop 0
    buffer_load_dwordx4 v1, s[20:23], s33 offen offset:0 sc1 lds
    buffer_load_dwordx4 v1, s[20:23], s33 offen offset:1024 sc1 lds
    buffer_load_dwordx4 v1, s[20:23], s33 offen offset:2048 sc1 lds
    buffer_load_dwordx4 v1, s[20:23], s33 offen offset:3072 sc1 lds
    s_add_u32 s32, s32, 0x80000
    s_add_u32 s33, s33, 0x80000
    s_add_u32 s34, s34, 0x4000
    s_and_b32 s34, s34, 0xffff
    s_add_u32 s35, s35, 0x4000
    s_and_b32 s35, s35, 0xffff
    s_or_b32 s35, s35, 0x10000
    s_nop 4
    v_accvgpr_read_b32 v128, a64
    v_accvgpr_read_b32 v129, a65
    v_accvgpr_read_b32 v130, a66
    v_accvgpr_read_b32 v131, a67
    v_pk_mul_f32 v[128:129], v[128:129], s[40:41]
    v_pk_mul_f32 v[130:131], v[130:131], s[40:41]
    v_cvt_pk_bf16_f32 v96, v128, v129
    v_cvt_pk_bf16_f32 v97, v130, v131
    v_accvgpr_read_b32 v132, a72
    v_accvgpr_read_b32 v133, a73
    v_accvgpr_read_b32 v134, a74
    v_accvgpr_read_b32 v135, a75
    v_pk_mul_f32 v[132:133], v[132:133], s[40:41]
    v_pk_mul_f32 v[134:135], v[134:135], s[40:41]
    v_cvt_pk_bf16_f32 v98, v132, v133
    v_cvt_pk_bf16_f32 v99, v134, v135
    v_accvgpr_read_b32 v136, a80
    v_accvgpr_read_b32 v137, a81
    v_accvgpr_read_b32 v138, a82
    v_accvgpr_read_b32 v139, a83
    v_pk_mul_f32 v[136:137], v[136:137], s[40:41]
    v_pk_mul_f32 v[138:139], v[138:139], s[40:41]
    v_cvt_pk_bf16_f32 v100, v136, v137
    v_cvt_pk_bf16_f32 v101, v138, v139
    v_accvgpr_read_b32 v140, a88
    v_accvgpr_read_b32 v141, a89
    v_accvgpr_read_b32 v142, a90
    v_accvgpr_read_b32 v143, a91
    v_pk_mul_f32 v[140:141], v[140:141], s[40:41]
    v_pk_mul_f32 v[142:143], v[142:143], s[40:41]
    v_cvt_pk_bf16_f32 v102, v140, v141
    v_cvt_pk_bf16_f32 v103, v142, v143
    v_accvgpr_read_b32 v128, a96
    v_accvgpr_read_b32 v129, a97
    v_accvgpr_read_b32 v130, a98
    v_accvgpr_read_b32 v131, a99
    v_pk_mul_f32 v[128:129], v[128:129], s[40:41]
    v_pk_mul_f32 v[130:131], v[130:131], s[40:41]
    v_cvt_pk_bf16_f32 v104, v128, v129
    v_cvt_pk_bf16_f32 v105, v130, v131
    v_accvgpr_read_b32 v132, a104
    v_accvgpr_read_b32 v133, a105
    v_accvgpr_read_b32 v134, a106
    v_accvgpr_read_b32 v135, a107
    v_pk_mul_f32 v[132:133], v[132:133], s[40:41]
    v_pk_mul_f32 v[134:135], v[134:135], s[40:41]
    v_cvt_pk_bf16_f32 v106, v132, v133
    v_cvt_pk_bf16_f32 v107, v134, v135
    v_accvgpr_read_b32 v136, a112
    v_accvgpr_read_b32 v137, a113
    v_accvgpr_read_b32 v138, a114
    v_accvgpr_read_b32 v139, a115
    v_pk_mul_f32 v[136:137], v[136:137], s[40:41]
    v_pk_mul_f32 v[138:139], v[138:139], s[40:41]
    v_cvt_pk_bf16_f32 v108, v136, v137
    v_cvt_pk_bf16_f32 v109, v138, v139
    v_accvgpr_read_b32 v140, a120
    v_accvgpr_read_b32 v141, a121
    v_accvgpr_read_b32 v142, a122
    v_accvgpr_read_b32 v143, a123
    v_pk_mul_f32 v[140:141], v[140:141], s[40:41]
    v_pk_mul_f32 v[142:143], v[142:143], s[40:41]
    v_cvt_pk_bf16_f32 v110, v140, v141
    v_cvt_pk_bf16_f32 v111, v142, v143
    v_accvgpr_read_b32 v128, a68
    v_accvgpr_read_b32 v129, a69
    v_accvgpr_read_b32 v130, a70
    v_accvgpr_read_b32 v131, a71
    v_pk_mul_f32 v[128:129], v[128:129], s[40:41]
    v_pk_mul_f32 v[130:131], v[130:131], s[40:41]
    v_cvt_pk_bf16_f32 v112, v128, v129
    v_cvt_pk_bf16_f32 v113, v130, v131
    v_accvgpr_read_b32 v132, a76
    v_accvgpr_read_b32 v133, a77
    v_accvgpr_read_b32 v134, a78
    v_accvgpr_read_b32 v135, a79
    v_pk_mul_f32 v[132:133], v[132:133], s[40:41]
    v_pk_mul_f32 v[134:135], v[134:135], s[40:41]
    v_cvt_pk_bf16_f32 v114, v132, v133
    v_cvt_pk_bf16_f32 v115, v134, v135
    v_accvgpr_read_b32 v136, a84
    v_accvgpr_read_b32 v137, a85
    v_accvgpr_read_b32 v138, a86
    v_accvgpr_read_b32 v139, a87
    v_pk_mul_f32 v[136:137], v[136:137], s[40:41]
    v_pk_mul_f32 v[138:139], v[138:139], s[40:41]
    v_cvt_pk_bf16_f32 v116, v136, v137
    v_cvt_pk_bf16_f32 v117, v138, v139
    v_accvgpr_read_b32 v140, a92
    v_accvgpr_read_b32 v141, a93
    v_accvgpr_read_b32 v142, a94
    v_accvgpr_read_b32 v143, a95
    v_pk_mul_f32 v[140:141], v[140:141], s[40:41]
    v_pk_mul_f32 v[142:143], v[142:143], s[40:41]
    v_cvt_pk_bf16_f32 v118, v140, v141
    v_cvt_pk_bf16_f32 v119, v142, v143
    v_accvgpr_read_b32 v128, a100
    v_accvgpr_read_b32 v129, a101
    v_accvgpr_read_b32 v130, a102
    v_accvgpr_read_b32 v131, a103
    v_pk_mul_f32 v[128:129], v[128:129], s[40:41]
    v_pk_mul_f32 v[130:131], v[130:131], s[40:41]
    v_cvt_pk_bf16_f32 v120, v128, v129
    v_cvt_pk_bf16_f32 v121, v130, v131
    v_accvgpr_read_b32 v132, a108
    v_accvgpr_read_b32 v133, a109
    v_accvgpr_read_b32 v134, a110
    v_accvgpr_read_b32 v135, a111
    v_pk_mul_f32 v[132:133], v[132:133], s[40:41]
    v_pk_mul_f32 v[134:135], v[134:135], s[40:41]
    v_cvt_pk_bf16_f32 v122, v132, v133
    v_cvt_pk_bf16_f32 v123, v134, v135
    v_accvgpr_read_b32 v136, a116
    v_accvgpr_read_b32 v137, a117
    v_accvgpr_read_b32 v138, a118
    v_accvgpr_read_b32 v139, a119
    v_pk_mul_f32 v[136:137], v[136:137], s[40:41]
    v_pk_mul_f32 v[138:139], v[138:139], s[40:41]
    v_cvt_pk_bf16_f32 v124, v136, v137
    v_cvt_pk_bf16_f32 v125, v138, v139
    v_accvgpr_read_b32 v140, a124
    v_accvgpr_read_b32 v141, a125
    v_accvgpr_read_b32 v142, a126
    v_accvgpr_read_b32 v143, a127
    v_pk_mul_f32 v[140:141], v[140:141], s[40:41]
    v_pk_mul_f32 v[142:143], v[142:143], s[40:41]
    v_cvt_pk_bf16_f32 v126, v140, v141
    v_cvt_pk_bf16_f32 v127, v142, v143
    v_pk_mul_f32 v[192:193], v[192:193], s[40:41]
    v_pk_mul_f32 v[194:195], v[194:195], s[40:41]
    v_cvt_pk_bf16_f32 v64, v192, v193
    v_cvt_pk_bf16_f32 v65, v194, v195
    v_pk_mul_f32 v[200:201], v[200:201], s[40:41]
    v_pk_mul_f32 v[202:203], v[202:203], s[40:41]
    v_cvt_pk_bf16_f32 v66, v200, v201
    v_cvt_pk_bf16_f32 v67, v202, v203
    v_pk_mul_f32 v[208:209], v[208:209], s[40:41]
    v_pk_mul_f32 v[210:211], v[210:211], s[40:41]
    v_cvt_pk_bf16_f32 v68, v208, v209
    v_cvt_pk_bf16_f32 v69, v210, v211
    v_pk_mul_f32 v[216:217], v[216:217], s[40:41]
    v_pk_mul_f32 v[218:219], v[218:219], s[40:41]
    v_cvt_pk_bf16_f32 v70, v216, v217
    v_cvt_pk_bf16_f32 v71, v218, v219
    v_pk_mul_f32 v[224:225], v[224:225], s[40:41]
    v_pk_mul_f32 v[226:227], v[226:227], s[40:41]
    v_cvt_pk_bf16_f32 v72, v224, v225
    v_cvt_pk_bf16_f32 v73, v226, v227
    v_pk_mul_f32 v[232:233], v[232:233], s[40:41]
    v_pk_mul_f32 v[234:235], v[234:235], s[40:41]
    v_cvt_pk_bf16_f32 v74, v232, v233
    v_cvt_pk_bf16_f32 v75, v234, v235
    v_pk_mul_f32 v[240:241], v[240:241], s[40:41]
    v_pk_mul_f32 v[242:243], v[242:243], s[40:41]
    v_cvt_pk_bf16_f32 v76, v240, v241
    v_cvt_pk_bf16_f32 v77, v242, v243
    v_pk_mul_f32 v[248:249], v[248:249], s[40:41]
    v_pk_mul_f32 v[250:251], v[250:251], s[40:41]
    v_cvt_pk_bf16_f32 v78, v248, v249
    v_cvt_pk_bf16_f32 v79, v250, v251
    v_pk_mul_f32 v[196:197], v[196:197], s[40:41]
    v_pk_mul_f32 v[198:199], v[198:199], s[40:41]
    v_cvt_pk_bf16_f32 v80, v196, v197
    v_cvt_pk_bf16_f32 v81, v198, v199
    v_pk_mul_f32 v[204:205], v[204:205], s[40:41]
    v_pk_mul_f32 v[206:207], v[206:207], s[40:41]
    v_cvt_pk_bf16_f32 v82, v204, v205
    v_cvt_pk_bf16_f32 v83, v206, v207
    v_pk_mul_f32 v[212:213], v[212:213], s[40:41]
    v_pk_mul_f32 v[214:215], v[214:215], s[40:41]
    v_cvt_pk_bf16_f32 v84, v212, v213
    v_cvt_pk_bf16_f32 v85, v214, v215
    v_pk_mul_f32 v[220:221], v[220:221], s[40:41]
    v_pk_mul_f32 v[222:223], v[222:223], s[40:41]
    v_cvt_pk_bf16_f32 v86, v220, v221
    v_cvt_pk_bf16_f32 v87, v222, v223
    v_pk_mul_f32 v[228:229], v[228:229], s[40:41]
    v_pk_mul_f32 v[230:231], v[230:231], s[40:41]
    v_cvt_pk_bf16_f32 v88, v228, v229
    v_cvt_pk_bf16_f32 v89, v230, v231
    v_pk_mul_f32 v[236:237], v[236:237], s[40:41]
    v_pk_mul_f32 v[238:239], v[238:239], s[40:41]
    v_cvt_pk_bf16_f32 v90, v236, v237
    v_cvt_pk_bf16_f32 v91, v238, v239
    v_pk_mul_f32 v[244:245], v[244:245], s[40:41]
    v_pk_mul_f32 v[246:247], v[246:247], s[40:41]
    v_cvt_pk_bf16_f32 v92, v244, v245
    v_cvt_pk_bf16_f32 v93, v246, v247
    v_pk_mul_f32 v[252:253], v[252:253], s[40:41]
    v_pk_mul_f32 v[254:255], v[254:255], s[40:41]
    v_cvt_pk_bf16_f32 v94, v252, v253
    v_cvt_pk_bf16_f32 v95, v254, v255
    v_mov_b32 v128, 0
    v_mov_b32 v129, 0
    v_mov_b32 v130, 0
    v_mov_b32 v131, 0
    s_nop 1
    v_mfma_f32_32x32x16_bf16 a[0:15], v[128:131], v[128:131], 0
    v_mfma_f32_32x32x16_bf16 a[16:31], v[128:131], v[128:131], 0
    v_mfma_f32_32x32x16_bf16 a[32:47], v[128:131], v[128:131], 0
    v_mfma_f32_32x32x16_bf16 a[48:63], v[128:131], v[128:131], 0
    v_mfma_f32_32x32x16_bf16 a[64:79], v[128:131], v[128:131], 0
    v_mfma_f32_32x32x16_bf16 a[80:95], v[128:131], v[128:131], 0
    v_mfma_f32_32x32x16_bf16 a[96:111], v[128:131], v[128:131], 0
    v_mfma_f32_32x32x16_bf16 a[112:127], v[128:131], v[128:131], 0
    s_waitcnt lgkmcnt(0)
    s_cmp_eq_u32 s30, 1
    s_cselect_b64 s[12:13], s[46:47], s[44:45]
    s_cmp_eq_u32 s30, 2
    s_cselect_b64 s[12:13], s[48:49], s[12:13]
    s_cmp_eq_u32 s30, 3
    s_cselect_b64 s[12:13], s[50:51], s[12:13]
    s_and_b32 s13, s13, 0xffff
    s_mul_i32 s62, s28, 63
    s_mul_i32 s31, s29, s29
    s_add_u32 s62, s62, s31
    s_sub_u32 s62, s62, 1
    s_lshl_b32 s62, s62, 12
    s_cmp_eq_u32 s30, 0
    s_cselect_b32 s14, 0x800000, 0x0
    s_max_u32 s14, s14, 0x700000
    s_cmp_eq_u32 s29, 0
    s_cselect_b32 s14, 0, s14
    s_cselect_b32 s62, 0, s62
    v_lshlrev_b32 v228, 2, v1
    v_mov_b32 v2, v1
    v_or_b32 v3, 0x10000, v1
    v_mov_b32 v56, v3
    s_mov_b32 s52, 0
    s_mov_b32 s53, 0
    v_mov_b32 v8, 0
    v_mov_b32 v12, 0
    v_mov_b32 v9, 0
    v_mov_b32 v13, 0
    v_mov_b32 v10, 0
    v_mov_b32 v14, 0
    v_mov_b32 v11, 0
    v_mov_b32 v15, 0
    v_mov_b32 v16, 0
    v_mov_b32 v17, 0
    v_mov_b32 v18, 0
    v_mov_b32 v19, 0
    v_mov_b32 v20, 0
    v_mov_b32 v21, 0
    v_mov_b32 v22, 0
    v_mov_b32 v23, 0
    v_mov_b32 v24, 0
    v_mov_b32 v25, 0
    v_mov_b32 v26, 0
    v_mov_b32 v27, 0
    v_mov_b32 v28, 0
    v_mov_b32 v29, 0
    v_mov_b32 v30, 0
    v_mov_b32 v31, 0
    v_mov_b32 v32, 0
    v_mov_b32 v33, 0
    v_mov_b32 v34, 0
    v_mov_b32 v35, 0
    v_mov_b32 v36, 0
    v_mov_b32 v37, 0
    v_mov_b32 v38, 0
    v_mov_b32 v39, 0
    v_mov_b32 v40, 0
    v_mov_b32 v41, 0
    v_mov_b32 v42, 0
    v_mov_b32 v43, 0
    v_mov_b32 v44, 0
    v_mov_b32 v45, 0
    v_mov_b32 v46, 0
    v_mov_b32 v47, 0
    s_mov_b32 s36, 0
    s_mov_b32 s37, 0x46800000
    s_waitcnt vmcnt(16)
    s_barrier
    ds_read_b128 a[128:131], v2 offset:0
    ds_read_b128 a[132:135], v2 offset:1024
    ds_read_b128 a[136:139], v2 offset:2048
    ds_read_b128 a[140:143], v2 offset:3072
    ds_read_b128 a[144:147], v2 offset:4096
    ds_read_b128 a[148:151], v2 offset:5120
    ds_read_b128 a[152:155], v2 offset:6144
    ds_read_b128 a[156:159], v2 offset:7168
    s_add_u32 s52, s52, 8192
    s_and_b32 s52, s52, 0xffff
    v_add_u32 v2, s52, v1
    s_waitcnt lgkmcnt(0)
    s_cmp_ge_u32 s36, s42
    s_cbranch_scc1 k2_prep_41
k2_prepret_42:
    v_mfma_f32_16x16x32_bf16 v[128:131], a[128:131], v[64:67], v[16:19]
    v_mfma_f32_16x16x32_bf16 v[132:135], a[128:131], v[80:83], v[20:23]
    v_mfma_f32_16x16x32_bf16 v[136:139], a[128:131], v[96:99], v[24:27]
    v_mfma_f32_16x16x32_bf16 v[140:143], a[128:131], v[112:115], v[28:31]
    s_add_u32 s36, s36, 32
    v_mfma_f32_16x16x32_bf16 v[128:131], a[132:135], v[68:71], v[128:131]
    v_mfma_f32_16x16x32_bf16 v[132:135], a[132:135], v[84:87], v[132:135]
    v_mfma_f32_16x16x32_bf16 v[136:139], a[132:135], v[100:103], v[136:139]
    v_mfma_f32_16x16x32_bf16 v[140:143], a[132:135], v[116:119], v[140:143]
    v_mfma_f32_16x16x32_bf16 v[128:131], a[136:139], v[72:75], v[128:131]
    v_mfma_f32_16x16x32_bf16 v[132:135], a[136:139], v[88:91], v[132:135]
    v_mfma_f32_16x16x32_bf16 v[136:139], a[136:139], v[104:107], v[136:139]
    v_mfma_f32_16x16x32_bf16 v[140:143], a[136:139], v[120:123], v[140:143]
    v_mfma_f32_16x16x32_bf16 v[128:131], a[140:143], v[76:79], v[128:131]
    v_mfma_f32_16x16x32_bf16 v[132:135], a[140:143], v[92:95], v[132:135]
    v_mfma_f32_16x16x32_bf16 v[136:139], a[140:143], v[108:111], v[136:139]
    v_mfma_f32_16x16x32_bf16 v[140:143], a[140:143], v[124:127], v[140:143]
    v_mfma_f32_16x16x32_bf16 v[144:147], a[144:147], v[64:67], v[32:35]
    v_mfma_f32_16x16x32_bf16 v[148:151], a[144:147], v[80:83], v[36:39]
    v_mfma_f32_16x16x32_bf16 v[152:155], a[144:147], v[96:99], v[40:43]
    v_mfma_f32_16x16x32_bf16 v[156:159], a[144:147], v[112:115], v[44:47]
    v_mfma_f32_16x16x32_bf16 v[144:147], a[148:151], v[68:71], v[144:147]
    v_mfma_f32_16x16x32_bf16 v[148:151], a[148:151], v[84:87], v[148:151]
    v_mfma_f32_16x16x32_bf16 v[152:155], a[148:151], v[100:103], v[152:155]
    v_mfma_f32_16x16x32_bf16 v[156:159], a[148:151], v[116:119], v[156:159]
    v_mfma_f32_16x16x32_bf16 v[144:147], a[152:155], v[72:75], v[144:147]
    v_mfma_f32_16x16x32_bf16 v[148:151], a[152:155], v[88:91], v[148:151]
    v_mfma_f32_16x16x32_bf16 v[152:155], a[152:155], v[104:107], v[152:155]
    v_mfma_f32_16x16x32_bf16 v[156:159], a[152:155], v[120:123], v[156:159]
    v_mfma_f32_16x16x32_bf16 v[144:147], a[156:159], v[76:79], v[144:147]
    v_mfma_f32_16x16x32_bf16 v[148:151], a[156:159], v[92:95], v[148:151]
    v_mfma_f32_16x16x32_bf16 v[152:155], a[156:159], v[108:111], v[152:155]
    v_mfma_f32_16x16x32_bf16 v[156:159], a[156:159], v[124:127], v[156:159]
    s_nop 7
    v_max_f32 v52, v128, v129
    v_max3_f32 v52, v52, v130, v131
    v_max3_f32 v52, v52, v144, v145
    v_max3_f32 v52, v52, v146, v147
    v_mov_b32 v6, v52
    s_nop 1
    v_permlane16_swap_b32 v52, v6
    s_nop 1
    v_max_f32 v52, v52, v6
    v_mov_b32 v6, v52
    s_nop 1
    v_permlane32_swap_b32 v52, v6
    s_nop 1
    v_max_f32 v52, v52, v6
    v_max_f32 v53, v132, v133
    v_max3_f32 v53, v53, v134, v135
    v_max3_f32 v53, v53, v148, v149
    v_max3_f32 v53, v53, v150, v151
    v_mov_b32 v6, v53
    s_nop 1
    v_permlane16_swap_b32 v53, v6
    s_nop 1
    v_max_f32 v53, v53, v6
    v_mov_b32 v6, v53
    s_nop 1
    v_permlane32_swap_b32 v53, v6
    s_nop 1
    v_max_f32 v53, v53, v6
    v_max_f32 v54, v136, v137
    v_max3_f32 v54, v54, v138, v139
    v_max3_f32 v54, v54, v152, v153
    v_max3_f32 v54, v54, v154, v155
    v_mov_b32 v6, v54
    s_nop 1
    v_permlane16_swap_b32 v54, v6
    s_nop 1
    v_max_f32 v54, v54, v6
    v_mov_b32 v6, v54
    s_nop 1
    v_permlane32_swap_b32 v54, v6
    s_nop 1
    v_max_f32 v54, v54, v6
    v_max_f32 v55, v140, v141
    v_max3_f32 v55, v55, v142, v143
    v_max3_f32 v55, v55, v156, v157
    v_max3_f32 v55, v55, v158, v159
    v_mov_b32 v6, v55
    s_nop 1
    v_permlane16_swap_b32 v55, v6
    s_nop 1
    v_max_f32 v55, v55, v6
    v_mov_b32 v6, v55
    s_nop 1
    v_permlane32_swap_b32 v55, v6
    s_nop 1
    v_max_f32 v55, v55, v6
    v_sub_f32 v128, v128, v52
    v_sub_f32 v16, 0, v52
    v_sub_f32 v129, v129, v52
    v_sub_f32 v17, 0, v52
    v_sub_f32 v130, v130, v52
    v_sub_f32 v18, 0, v52
    v_sub_f32 v131, v131, v52
    v_sub_f32 v19, 0, v52
    v_sub_f32 v132, v132, v53
    v_sub_f32 v20, 0, v53
    v_sub_f32 v133, v133, v53
    v_sub_f32 v21, 0, v53
    v_sub_f32 v134, v134, v53
    v_sub_f32 v22, 0, v53
    v_sub_f32 v135, v135, v53
    v_sub_f32 v23, 0, v53
    v_sub_f32 v136, v136, v54
    v_sub_f32 v24, 0, v54
    v_sub_f32 v137, v137, v54
    v_sub_f32 v25, 0, v54
    v_sub_f32 v138, v138, v54
    v_sub_f32 v26, 0, v54
    v_sub_f32 v139, v139, v54
    v_sub_f32 v27, 0, v54
    v_sub_f32 v140, v140, v55
    v_sub_f32 v28, 0, v55
    v_sub_f32 v141, v141, v55
    v_sub_f32 v29, 0, v55
    v_sub_f32 v142, v142, v55
    v_sub_f32 v30, 0, v55
    v_sub_f32 v143, v143, v55
    v_sub_f32 v31, 0, v55
    v_sub_f32 v144, v144, v52
    v_sub_f32 v32, 0, v52
    v_sub_f32 v145, v145, v52
    v_sub_f32 v33, 0, v52
    v_sub_f32 v146, v146, v52
    v_sub_f32 v34, 0, v52
    v_sub_f32 v147, v147, v52
    v_sub_f32 v35, 0, v52
    v_sub_f32 v148, v148, v53
    v_sub_f32 v36, 0, v53
    v_sub_f32 v149, v149, v53
    v_sub_f32 v37, 0, v53
    v_sub_f32 v150, v150, v53
    v_sub_f32 v38, 0, v53
    v_sub_f32 v151, v151, v53
    v_sub_f32 v39, 0, v53
    v_sub_f32 v152, v152, v54
    v_sub_f32 v40, 0, v54
    v_sub_f32 v153, v153, v54
    v_sub_f32 v41, 0, v54
    v_sub_f32 v154, v154, v54
    v_sub_f32 v42, 0, v54
    v_sub_f32 v155, v155, v54
    v_sub_f32 v43, 0, v54
    v_sub_f32 v156, v156, v55
    v_sub_f32 v44, 0, v55
    v_sub_f32 v157, v157, v55
    v_sub_f32 v45, 0, v55
    v_sub_f32 v158, v158, v55
    v_sub_f32 v46, 0, v55
    v_sub_f32 v159, v159, v55
    v_sub_f32 v47, 0, v55
    v_sub_f32 v8, 0, v52
    v_sub_f32 v9, 0, v53
    v_sub_f32 v10, 0, v54
    v_sub_f32 v11, 0, v55
    ds_read_b128 a[128:131], v2 offset:0
    ds_read_b128 a[132:135], v2 offset:1024
    ds_read_b128 a[136:139], v2 offset:2048
    ds_read_b128 a[140:143], v2 offset:3072
    ds_read_b128 a[144:147], v2 offset:4096
    ds_read_b128 a[148:151], v2 offset:5120
    ds_read_b128 a[152:155], v2 offset:6144
    ds_read_b128 a[156:159], v2 offset:7168
    s_add_u32 s52, s52, 8192
    s_and_b32 s52, s52, 0xffff
    v_add_u32 v2, s52, v1
    s_waitcnt lgkmcnt(0)
    s_cmp_ge_u32 s36, s42
    s_cbranch_scc1 k2_prep_43
k2_prepret_44:
    v_mfma_f32_16x16x32_bf16 v[160:163], a[128:131], v[64:67], v[16:19]
    v_exp_f32 v232, v128
    v_mfma_f32_16x16x32_bf16 v[164:167], a[128:131], v[80:83], v[20:23]
    v_exp_f32 v233, v129
    v_mfma_f32_16x16x32_bf16 v[168:171], a[128:131], v[96:99], v[24:27]
    v_add_f32 v48, v232, v233
    v_exp_f32 v234, v130
    v_mfma_f32_16x16x32_bf16 v[172:175], a[128:131], v[112:115], v[28:31]
    s_add_u32 s36, s36, 32
    v_cvt_pk_bf16_f32 v192, v232, v233
    v_exp_f32 v235, v131
    v_mfma_f32_16x16x32_bf16 v[160:163], a[132:135], v[68:71], v[160:163]
    v_add_f32 v48, v48, v234
    v_add_f32 v48, v48, v235
    v_cvt_pk_bf16_f32 v193, v234, v235
    v_mfma_f32_16x16x32_bf16 v[164:167], a[132:135], v[84:87], v[164:167]
    v_exp_f32 v236, v144
    v_mfma_f32_16x16x32_bf16 v[168:171], a[132:135], v[100:103], v[168:171]
    v_exp_f32 v237, v145
    v_add_f32 v48, v48, v236
    v_mfma_f32_16x16x32_bf16 v[172:175], a[132:135], v[116:119], v[172:175]
    v_add_f32 v48, v48, v237
    v_exp_f32 v238, v146
    v_mfma_f32_16x16x32_bf16 v[160:163], a[136:139], v[72:75], v[160:163]
    v_cvt_pk_bf16_f32 v194, v236, v237
    v_exp_f32 v239, v147
    v_mfma_f32_16x16x32_bf16 v[164:167], a[136:139], v[88:91], v[164:167]
    v_add_f32 v48, v48, v238
    v_add_f32 v48, v48, v239
    v_cvt_pk_bf16_f32 v195, v238, v239
    v_mfma_f32_16x16x32_bf16 v[168:171], a[136:139], v[104:107], v[168:171]
    v_exp_f32 v240, v132
    v_mfma_f32_16x16x32_bf16 v[172:175], a[136:139], v[120:123], v[172:175]
    v_exp_f32 v241, v133
    v_mfma_f32_16x16x32_bf16 v[160:163], a[140:143], v[76:79], v[160:163]
    v_add_f32 v49, v240, v241
    v_exp_f32 v242, v134
    v_mfma_f32_16x16x32_bf16 v[164:167], a[140:143], v[92:95], v[164:167]
    v_cvt_pk_bf16_f32 v196, v240, v241
    v_exp_f32 v243, v135
    v_mfma_f32_16x16x32_bf16 v[168:171], a[140:143], v[108:111], v[168:171]
    v_add_f32 v49, v49, v242
    v_add_f32 v49, v49, v243
    v_exp_f32 v244, v148
    v_mfma_f32_16x16x32_bf16 v[172:175], a[140:143], v[124:127], v[172:175]
    v_cvt_pk_bf16_f32 v197, v242, v243
    v_exp_f32 v245, v149
    v_mfma_f32_16x16x32_bf16 v[176:179], a[144:147], v[64:67], v[32:35]
    v_add_f32 v49, v49, v244
    v_add_f32 v49, v49, v245
    v_exp_f32 v246, v150
    v_mfma_f32_16x16x32_bf16 v[180:183], a[144:147], v[80:83], v[36:39]
    v_cvt_pk_bf16_f32 v198, v244, v245
    v_exp_f32 v247, v151
    v_mfma_f32_16x16x32_bf16 v[184:187], a[144:147], v[96:99], v[40:43]
    v_add_f32 v49, v49, v246
    v_add_f32 v49, v49, v247
    v_exp_f32 v232, v136
    v_mfma_f32_16x16x32_bf16 v[188:191], a[144:147], v[112:115], v[44:47]
    v_cvt_pk_bf16_f32 v199, v246, v247
    v_exp_f32 v233, v137
    v_mfma_f32_16x16x32_bf16 v[176:179], a[148:151], v[68:71], v[176:179]
    ds_read_b128 a[192:195], v3 offset:0
    v_add_f32 v50, v232, v233
    v_exp_f32 v234, v138
    v_mfma_f32_16x16x32_bf16 v[180:183], a[148:151], v[84:87], v[180:183]
    v_cvt_pk_bf16_f32 v200, v232, v233
    v_exp_f32 v235, v139
    v_mfma_f32_16x16x32_bf16 v[184:187], a[148:151], v[100:103], v[184:187]
    v_add_f32 v50, v50, v234
    v_add_f32 v50, v50, v235
    v_exp_f32 v236, v152
    v_mfma_f32_16x16x32_bf16 v[188:191], a[148:151], v[116:119], v[188:191]
    v_cvt_pk_bf16_f32 v201, v234, v235
    v_exp_f32 v237, v153
    v_mfma_f32_16x16x32_bf16 v[176:179], a[152:155], v[72:75], v[176:179]
    v_add_f32 v50, v50, v236
    v_add_f32 v50, v50, v237
    v_exp_f32 v238, v154
    v_mfma_f32_16x16x32_bf16 v[180:183], a[152:155], v[88:91], v[180:183]
    ds_read_b128 a[196:199], v3 offset:1024
    v_cvt_pk_bf16_f32 v202, v236, v237
    v_exp_f32 v239, v155
    v_mfma_f32_16x16x32_bf16 v[184:187], a[152:155], v[104:107], v[184:187]
    v_add_f32 v50, v50, v238
    v_add_f32 v50, v50, v239
    v_exp_f32 v240, v140
    v_mfma_f32_16x16x32_bf16 v[188:191], a[152:155], v[120:123], v[188:191]
    v_cvt_pk_bf16_f32 v203, v238, v239
    v_exp_f32 v241, v141
    v_mfma_f32_16x16x32_bf16 v[176:179], a[156:159], v[76:79], v[176:179]
    v_add_f32 v51, v240, v241
    v_exp_f32 v242, v142
    v_mfma_f32_16x16x32_bf16 v[180:183], a[156:159], v[92:95], v[180:183]
    ds_read_b128 a[200:203], v3 offset:2048
    v_cvt_pk_bf16_f32 v204, v240, v241
    v_exp_f32 v243, v143
    v_mfma_f32_16x16x32_bf16 v[184:187], a[156:159], v[108:111], v[184:187]
    v_add_f32 v51, v51, v242
    v_add_f32 v51, v51, v243
    v_exp_f32 v244, v156
    v_mfma_f32_16x16x32_bf16 v[188:191], a[156:159], v[124:127], v[188:191]
    s_waitcnt vmcnt(8)
    s_barrier
    v_cvt_pk_bf16_f32 v205, v242, v243
    v_exp_f32 v245, v157
    v_add_f32 v51, v51, v244
    v_add_f32 v51, v51, v245
    v_exp_f32 v246, v158
    v_cvt_pk_bf16_f32 v206, v244, v245
    v_max3_f32 v6, v48, v49, v50
    v_exp_f32 v247, v159
    ds_read_b128 a[204:207], v3 offset:3072
    v_add_f32 v51, v51, v246
    v_add_f32 v51, v51, v247
    v_cvt_pk_bf16_f32 v207, v246, v247
    v_max_f32 v6, v6, v51
    v_cmp_nge_f32 vcc, s37, v6
    s_cbranch_vccnz k2_rare_45
k2_ret_46:
    s_lshl_b32 s63, s29, 1
    s_add_u32 s63, s63, 1
k2_dloop_47:
    s_waitcnt lgkmcnt(2)
    v_mfma_f32_16x16x32_bf16 a[0:3], a[192:195], v[192:195], a[0:3]
    ds_read_b128 a[208:211], v3 offset:4096
    v_add_f32 v12, v12, v48
    v_mfma_f32_16x16x32_bf16 a[4:7], a[192:195], v[196:199], a[4:7]
    v_exp_f32 v232, v160
    v_mfma_f32_16x16x32_bf16 a[8:11], a[192:195], v[200:203], a[8:11]
    s_mov_b32 m0, s34
    v_add_f32 v13, v13, v49
    v_add_f32 v14, v14, v50
    v_add_f32 v15, v15, v51
    v_mfma_f32_16x16x32_bf16 a[12:15], a[192:195], v[204:207], a[12:15]
    s_add_u32 s53, s53, 8192
    v_exp_f32 v233, v161
    v_mfma_f32_16x16x32_bf16 a[16:19], a[196:199], v[192:195], a[16:19]
    s_and_b32 s53, s53, 0xffff
    buffer_load_dwordx4 v1, s[16:19], s32 offen offset:0 sc1 lds
    ds_read_b128 a[212:215], v3 offset:5120
    v_mfma_f32_16x16x32_bf16 a[20:23], a[196:199], v[196:199], a[20:23]
    v_add_f32 v48, v232, v233
    v_cvt_pk_bf16_f32 v208, v232, v233
    v_mfma_f32_16x16x32_bf16 a[24:27], a[196:199], v[200:203], a[24:27]
    v_exp_f32 v234, v162
    v_mfma_f32_16x16x32_bf16 a[28:31], a[196:199], v[204:207], a[28:31]
    s_waitcnt lgkmcnt(2)
    v_exp_f32 v235, v163
    v_add_f32 v48, v48, v234
    v_mfma_f32_16x16x32_bf16 a[32:35], a[200:203], v[192:195], a[32:35]
    ds_read_b128 a[216:219], v3 offset:6144
    v_add_f32 v48, v48, v235
    v_mfma_f32_16x16x32_bf16 a[36:39], a[200:203], v[196:199], a[36:39]
    v_exp_f32 v236, v176
    v_mfma_f32_16x16x32_bf16 a[40:43], a[200:203], v[200:203], a[40:43]
    v_cvt_pk_bf16_f32 v209, v234, v235
    v_add_f32 v48, v48, v236
    v_mfma_f32_16x16x32_bf16 a[44:47], a[200:203], v[204:207], a[44:47]
    v_exp_f32 v237, v177
    v_mfma_f32_16x16x32_bf16 a[48:51], a[204:207], v[192:195], a[48:51]
    ds_read_b128 a[220:223], v3 offset:7168
    v_add_f32 v48, v48, v237
    v_cvt_pk_bf16_f32 v210, v236, v237
    v_mfma_f32_16x16x32_bf16 a[52:55], a[204:207], v[196:199], a[52:55]
    v_exp_f32 v238, v178
    v_mfma_f32_16x16x32_bf16 a[56:59], a[204:207], v[200:203], a[56:59]
    v_exp_f32 v239, v179
    v_mfma_f32_16x16x32_bf16 a[60:63], a[204:207], v[204:207], a[60:63]
    s_waitcnt lgkmcnt(2)
    v_add_f32 v48, v48, v238
    v_add_f32 v48, v48, v239
    v_mfma_f32_16x16x32_bf16 a[64:67], a[208:211], v[192:195], a[64:67]
    s_add_u32 s34, s34, 0x4000
    v_exp_f32 v240, v164
    v_mfma_f32_16x16x32_bf16 a[68:71], a[208:211], v[196:199], a[68:71]
    ds_read_b128 a[128:131], v2 offset:0
    v_cvt_pk_bf16_f32 v211, v238, v239
    v_add_u32 v3, s53, v56
    v_mfma_f32_16x16x32_bf16 a[72:75], a[208:211], v[200:203], a[72:75]
    v_exp_f32 v241, v165
    v_mfma_f32_16x16x32_bf16 a[76:79], a[208:211], v[204:207], a[76:79]
    buffer_load_dwordx4 v1, s[16:19], s32 offen offset:1024 sc1 lds
    ds_read_b128 a[132:135], v2 offset:1024
    v_mfma_f32_16x16x32_bf16 a[80:83], a[212:215], v[192:195], a[80:83]
    v_add_f32 v49, v240, v241
    v_cvt_pk_bf16_f32 v212, v240, v241
    v_mfma_f32_16x16x32_bf16 a[84:87], a[212:215], v[196:199], a[84:87]
    v_exp_f32 v242, v166
    v_mfma_f32_16x16x32_bf16 a[88:91], a[212:215], v[200:203], a[88:91]
    v_exp_f32 v243, v167
    v_add_f32 v49, v49, v242
    v_mfma_f32_16x16x32_bf16 a[92:95], a[212:215], v[204:207], a[92:95]
    s_waitcnt lgkmcnt(2)
    ds_read_b128 a[136:139], v2 offset:2048
    v_add_f32 v49, v49, v243
    v_mfma_f32_16x16x32_bf16 a[96:99], a[216:219], v[192:195], a[96:99]
    v_exp_f32 v244, v180
    v_mfma_f32_16x16x32_bf16 a[100:103], a[216:219], v[196:199], a[100:103]
    v_cvt_pk_bf16_f32 v213, v242, v243
    v_add_f32 v49, v49, v244
    v_mfma_f32_16x16x32_bf16 a[104:107], a[216:219], v[200:203], a[104:107]
    v_exp_f32 v245, v181
    v_mfma_f32_16x16x32_bf16 a[108:111], a[216:219], v[204:207], a[108:111]
    s_cmp_ge_u32 s36, s42
    s_cbranch_scc1 k2_prep_48
k2_prepret_49:
    v_add_f32 v49, v49, v245
    v_mfma_f32_16x16x32_bf16 a[112:115], a[220:223], v[192:195], a[112:115]
    v_exp_f32 v246, v182
    v_mfma_f32_16x16x32_bf16 a[116:119], a[220:223], v[196:199], a[116:119]
    s_and_b32 s34, s34, 0xffff
    ds_read_b128 a[140:143], v2 offset:3072
    v_cvt_pk_bf16_f32 v214, v244, v245
    v_mfma_f32_16x16x32_bf16 a[120:123], a[220:223], v[200:203], a[120:123]
    v_exp_f32 v247, v183
    v_mfma_f32_16x16x32_bf16 a[124:127], a[220:223], v[204:207], a[124:127]
    s_waitcnt lgkmcnt(2)
    v_add_f32 v49, v49, v246
    v_add_f32 v49, v49, v247
    v_mfma_f32_16x16x32_bf16 v[128:131], a[128:131], v[64:67], v[16:19]
    v_exp_f32 v232, v168
    v_cvt_pk_bf16_f32 v215, v246, v247
    v_mfma_f32_16x16x32_bf16 v[132:135], a[128:131], v[80:83], v[20:23]
    buffer_load_dwordx4 v1, s[16:19], s32 offen offset:2048 sc1 lds
    ds_read_b128 a[144:147], v2 offset:4096
    v_mfma_f32_16x16x32_bf16 v[136:139], a[128:131], v[96:99], v[24:27]
    v_exp_f32 v233, v169
    v_mfma_f32_16x16x32_bf16 v[140:143], a[128:131], v[112:115], v[28:31]
    s_add_u32 s36, s36, 32
    v_add_f32 v50, v232, v233
    v_cvt_pk_bf16_f32 v216, v232, v233
    v_mfma_f32_16x16x32_bf16 v[128:131], a[132:135], v[68:71], v[128:131]
    ds_read_b128 a[148:151], v2 offset:5120
    v_exp_f32 v234, v170
    v_mfma_f32_16x16x32_bf16 v[132:135], a[132:135], v[84:87], v[132:135]
    v_exp_f32 v235, v171
    v_mfma_f32_16x16x32_bf16 v[136:139], a[132:135], v[100:103], v[136:139]
    v_add_f32 v50, v50, v234
    v_add_f32 v50, v50, v235
    v_mfma_f32_16x16x32_bf16 v[140:143], a[132:135], v[116:119], v[140:143]
    s_waitcnt lgkmcnt(2)
    v_exp_f32 v236, v184
    v_mfma_f32_16x16x32_bf16 v[128:131], a[136:139], v[72:75], v[128:131]
    s_add_u32 s52, s52, 8192
    ds_read_b128 a[152:155], v2 offset:6144
    v_cvt_pk_bf16_f32 v217, v234, v235
    v_mfma_f32_16x16x32_bf16 v[132:135], a[136:139], v[88:91], v[132:135]
    v_exp_f32 v237, v185
    v_add_f32 v50, v50, v236
    v_mfma_f32_16x16x32_bf16 v[136:139], a[136:139], v[104:107], v[136:139]
    s_and_b32 s52, s52, 0xffff
    v_add_f32 v50, v50, v237
    v_cvt_pk_bf16_f32 v218, v236, v237
    v_mfma_f32_16x16x32_bf16 v[140:143], a[136:139], v[120:123], v[140:143]
    v_exp_f32 v238, v186
    v_mfma_f32_16x16x32_bf16 v[128:131], a[140:143], v[76:79], v[128:131]
    ds_read_b128 a[156:159], v2 offset:7168
    v_add_f32 v50, v50, v238
    v_mfma_f32_16x16x32_bf16 v[132:135], a[140:143], v[92:95], v[132:135]
    v_exp_f32 v239, v187
    v_mfma_f32_16x16x32_bf16 v[136:139], a[140:143], v[108:111], v[136:139]
    v_add_f32 v50, v50, v239
    v_exp_f32 v240, v172
    v_mfma_f32_16x16x32_bf16 v[140:143], a[140:143], v[124:127], v[140:143]
    s_waitcnt lgkmcnt(2)
    ds_read_b128 a[192:195], v3 offset:0
    v_cvt_pk_bf16_f32 v219, v238, v239
    v_mfma_f32_16x16x32_bf16 v[144:147], a[144:147], v[64:67], v[32:35]
    buffer_load_dwordx4 v1, s[16:19], s32 offen offset:3072 sc1 lds
    s_add_u32 s32, s32, 0x80000
    v_mfma_f32_16x16x32_bf16 v[148:151], a[144:147], v[80:83], v[36:39]
    v_exp_f32 v241, v173
    v_mfma_f32_16x16x32_bf16 v[152:155], a[144:147], v[96:99], v[40:43]
    v_add_f32 v51, v240, v241
    v_cvt_pk_bf16_f32 v220, v240, v241
    v_mfma_f32_16x16x32_bf16 v[156:159], a[144:147], v[112:115], v[44:47]
    v_exp_f32 v242, v174
    v_add_u32 v2, s52, v1
    v_mfma_f32_16x16x32_bf16 v[144:147], a[148:151], v[68:71], v[144:147]
    v_exp_f32 v243, v175
    v_mfma_f32_16x16x32_bf16 v[148:151], a[148:151], v[84:87], v[148:151]
    ds_read_b128 a[196:199], v3 offset:1024
    v_add_f32 v51, v51, v242
    v_mfma_f32_16x16x32_bf16 v[152:155], a[148:151], v[100:103], v[152:155]
    v_add_f32 v51, v51, v243
    v_cvt_pk_bf16_f32 v221, v242, v243
    v_mfma_f32_16x16x32_bf16 v[156:159], a[148:151], v[116:119], v[156:159]
    s_waitcnt lgkmcnt(2)
    v_exp_f32 v244, v188
    v_mfma_f32_16x16x32_bf16 v[144:147], a[152:155], v[72:75], v[144:147]
    v_exp_f32 v245, v189
    v_add_f32 v51, v51, v244
    v_mfma_f32_16x16x32_bf16 v[148:151], a[152:155], v[88:91], v[148:151]
    ds_read_b128 a[200:203], v3 offset:2048
    v_add_f32 v51, v51, v245
    v_mfma_f32_16x16x32_bf16 v[152:155], a[152:155], v[104:107], v[152:155]
    v_exp_f32 v246, v190
    v_mfma_f32_16x16x32_bf16 v[156:159], a[152:155], v[120:123], v[156:159]
    v_cvt_pk_bf16_f32 v222, v244, v245
    v_add_f32 v51, v51, v246
    v_mfma_f32_16x16x32_bf16 v[144:147], a[156:159], v[76:79], v[144:147]
    v_exp_f32 v247, v191
    v_mfma_f32_16x16x32_bf16 v[148:151], a[156:159], v[92:95], v[148:151]
    ds_read_b128 a[204:207], v3 offset:3072
    v_max3_f32 v6, v48, v49, v50
    v_add_f32 v51, v51, v247
    v_mfma_f32_16x16x32_bf16 v[152:155], a[156:159], v[108:111], v[152:155]
    v_cvt_pk_bf16_f32 v223, v246, v247
    v_max_f32 v6, v6, v51
    v_mfma_f32_16x16x32_bf16 v[156:159], a[156:159], v[124:127], v[156:159]
    v_cmp_nge_f32 vcc, s37, v6
    s_cbranch_vccnz k2_rare_50
k2_ret_51:
    s_waitcnt lgkmcnt(2)
    v_mfma_f32_16x16x32_bf16 a[0:3], a[192:195], v[208:211], a[0:3]
    ds_read_b128 a[208:211], v3 offset:4096
    v_add_f32 v12, v12, v48
    v_mfma_f32_16x16x32_bf16 a[4:7], a[192:195], v[212:215], a[4:7]
    v_exp_f32 v232, v128
    v_mfma_f32_16x16x32_bf16 a[8:11], a[192:195], v[216:219], a[8:11]
    s_mov_b32 m0, s35
    v_add_f32 v13, v13, v49
    v_add_f32 v14, v14, v50
    v_add_f32 v15, v15, v51
    v_mfma_f32_16x16x32_bf16 a[12:15], a[192:195], v[220:223], a[12:15]
    s_add_u32 s53, s53, 8192
    v_exp_f32 v233, v129
    v_mfma_f32_16x16x32_bf16 a[16:19], a[196:199], v[208:211], a[16:19]
    s_and_b32 s53, s53, 0xffff
    buffer_load_dwordx4 v1, s[20:23], s33 offen offset:0 sc1 lds
    ds_read_b128 a[212:215], v3 offset:5120
    v_mfma_f32_16x16x32_bf16 a[20:23], a[196:199], v[212:215], a[20:23]
    v_add_f32 v48, v232, v233
    v_cvt_pk_bf16_f32 v192, v232, v233
    v_mfma_f32_16x16x32_bf16 a[24:27], a[196:199], v[216:219], a[24:27]
    ds_read_b128 a[216:219], v3 offset:6144
    v_exp_f32 v234, v130
    v_mfma_f32_16x16x32_bf16 a[28:31], a[196:199], v[220:223], a[28:31]
    s_waitcnt lgkmcnt(3)
    v_exp_f32 v235, v131
    v_mfma_f32_16x16x32_bf16 a[32:35], a[200:203], v[208:211], a[32:35]
    v_add_f32 v48, v48, v234
    v_add_f32 v48, v48, v235
    v_mfma_f32_16x16x32_bf16 a[36:39], a[200:203], v[212:215], a[36:39]
    v_exp_f32 v236, v144
    v_mfma_f32_16x16x32_bf16 a[40:43], a[200:203], v[216:219], a[40:43]
    v_cvt_pk_bf16_f32 v193, v234, v235
    v_add_f32 v48, v48, v236
    v_mfma_f32_16x16x32_bf16 a[44:47], a[200:203], v[220:223], a[44:47]
    ds_read_b128 a[220:223], v3 offset:7168
    v_exp_f32 v237, v145
    v_mfma_f32_16x16x32_bf16 a[48:51], a[204:207], v[208:211], a[48:51]
    s_add_u32 s35, s35, 0x4000
    v_add_f32 v48, v48, v237
    v_cvt_pk_bf16_f32 v194, v236, v237
    v_mfma_f32_16x16x32_bf16 a[52:55], a[204:207], v[212:215], a[52:55]
    v_exp_f32 v238, v146
    v_mfma_f32_16x16x32_bf16 a[56:59], a[204:207], v[216:219], a[56:59]
    v_exp_f32 v239, v147
    v_mfma_f32_16x16x32_bf16 a[60:63], a[204:207], v[220:223], a[60:63]
    s_waitcnt lgkmcnt(2)
    ds_read_b128 a[128:131], v2 offset:0
    v_add_f32 v48, v48, v238
    v_add_f32 v48, v48, v239
    v_mfma_f32_16x16x32_bf16 a[64:67], a[208:211], v[208:211], a[64:67]
    buffer_load_dwordx4 v1, s[20:23], s33 offen offset:1024 sc1 lds
    v_mfma_f32_16x16x32_bf16 a[68:71], a[208:211], v[212:215], a[68:71]
    v_exp_f32 v240, v132
    v_cvt_pk_bf16_f32 v195, v238, v239
    v_mfma_f32_16x16x32_bf16 a[72:75], a[208:211], v[216:219], a[72:75]
    v_exp_f32 v241, v133
    v_mfma_f32_16x16x32_bf16 a[76:79], a[208:211], v[220:223], a[76:79]
    v_add_u32 v3, s53, v56
    v_add_f32 v49, v240, v241
    v_mfma_f32_16x16x32_bf16 a[80:83], a[212:215], v[208:211], a[80:83]
    ds_read_b128 a[132:135], v2 offset:1024
    v_exp_f32 v242, v134
    v_mfma_f32_16x16x32_bf16 a[84:87], a[212:215], v[212:215], a[84:87]
    v_cvt_pk_bf16_f32 v196, v240, v241
    v_add_f32 v49, v49, v242
    v_mfma_f32_16x16x32_bf16 a[88:91], a[212:215], v[216:219], a[88:91]
    v_exp_f32 v243, v135
    v_mfma_f32_16x16x32_bf16 a[92:95], a[212:215], v[220:223], a[92:95]
    s_waitcnt lgkmcnt(2)
    ds_read_b128 a[136:139], v2 offset:2048
    v_add_f32 v49, v49, v243
    v_mfma_f32_16x16x32_bf16 a[96:99], a[216:219], v[208:211], a[96:99]
    s_and_b32 s35, s35, 0xffff
    v_exp_f32 v244, v148
    v_mfma_f32_16x16x32_bf16 a[100:103], a[216:219], v[212:215], a[100:103]
    v_cvt_pk_bf16_f32 v197, v242, v243
    v_exp_f32 v245, v149
    v_mfma_f32_16x16x32_bf16 a[104:107], a[216:219], v[216:219], a[104:107]
    s_cmp_ge_u32 s36, s42
    s_cbranch_scc1 k2_prep_52
k2_prepret_53:
    v_mfma_f32_16x16x32_bf16 a[108:111], a[216:219], v[220:223], a[108:111]
    v_add_f32 v49, v49, v244
    v_add_f32 v49, v49, v245
    v_mfma_f32_16x16x32_bf16 a[112:115], a[220:223], v[208:211], a[112:115]
    buffer_load_dwordx4 v1, s[20:23], s33 offen offset:2048 sc1 lds
    ds_read_b128 a[140:143], v2 offset:3072
    v_mfma_f32_16x16x32_bf16 a[116:119], a[220:223], v[212:215], a[116:119]
    s_or_b32 s35, s35, 0x10000
    v_exp_f32 v246, v150
    v_cvt_pk_bf16_f32 v198, v244, v245
    v_mfma_f32_16x16x32_bf16 a[120:123], a[220:223], v[216:219], a[120:123]
    v_exp_f32 v247, v151
    v_mfma_f32_16x16x32_bf16 a[124:127], a[220:223], v[220:223], a[124:127]
    s_waitcnt lgkmcnt(2)
    v_add_f32 v49, v49, v246
    v_add_f32 v49, v49, v247
    v_mfma_f32_16x16x32_bf16 v[160:163], a[128:131], v[64:67], v[16:19]
    v_exp_f32 v232, v136
    v_mfma_f32_16x16x32_bf16 v[164:167], a[128:131], v[80:83], v[20:23]
    ds_read_b128 a[144:147], v2 offset:4096
    v_cvt_pk_bf16_f32 v199, v246, v247
    v_mfma_f32_16x16x32_bf16 v[168:171], a[128:131], v[96:99], v[24:27]
    ds_read_b128 a[148:151], v2 offset:5120
    v_exp_f32 v233, v137
    v_mfma_f32_16x16x32_bf16 v[172:175], a[128:131], v[112:115], v[28:31]
    s_add_u32 s36, s36, 32
    v_add_f32 v50, v232, v233
    v_cvt_pk_bf16_f32 v200, v232, v233
    v_mfma_f32_16x16x32_bf16 v[160:163], a[132:135], v[68:71], v[160:163]
    v_exp_f32 v234, v138
    v_mfma_f32_16x16x32_bf16 v[164:167], a[132:135], v[84:87], v[164:167]
    v_exp_f32 v235, v139
    v_mfma_f32_16x16x32_bf16 v[168:171], a[132:135], v[100:103], v[168:171]
    v_add_f32 v50, v50, v234
    v_add_f32 v50, v50, v235
    v_cvt_pk_bf16_f32 v201, v234, v235
    v_mfma_f32_16x16x32_bf16 v[172:175], a[132:135], v[116:119], v[172:175]
    s_waitcnt lgkmcnt(2)
    v_exp_f32 v236, v152
    v_mfma_f32_16x16x32_bf16 v[160:163], a[136:139], v[72:75], v[160:163]
    s_add_u32 s52, s52, 8192
    buffer_load_dwordx4 v1, s[20:23], s33 offen offset:3072 sc1 lds
    s_add_u32 s33, s33, 0x80000
    v_mfma_f32_16x16x32_bf16 v[164:167], a[136:139], v[88:91], v[164:167]
    ds_read_b128 a[152:155], v2 offset:6144
    v_add_f32 v50, v50, v236
    v_mfma_f32_16x16x32_bf16 v[168:171], a[136:139], v[104:107], v[168:171]
    s_and_b32 s52, s52, 0xffff
    v_exp_f32 v237, v153
    v_mfma_f32_16x16x32_bf16 v[172:175], a[136:139], v[120:123], v[172:175]
    v_add_f32 v50, v50, v237
    v_exp_f32 v238, v154
    v_mfma_f32_16x16x32_bf16 v[160:163], a[140:143], v[76:79], v[160:163]
    ds_read_b128 a[156:159], v2 offset:7168
    v_cvt_pk_bf16_f32 v202, v236, v237
    v_mfma_f32_16x16x32_bf16 v[164:167], a[140:143], v[92:95], v[164:167]
    v_exp_f32 v239, v155
    v_mfma_f32_16x16x32_bf16 v[168:171], a[140:143], v[108:111], v[168:171]
    v_add_f32 v50, v50, v238
    v_add_f32 v50, v50, v239
    v_mfma_f32_16x16x32_bf16 v[172:175], a[140:143], v[124:127], v[172:175]
    s_waitcnt lgkmcnt(2)
    v_exp_f32 v240, v140
    v_mfma_f32_16x16x32_bf16 v[176:179], a[144:147], v[64:67], v[32:35]
    v_cvt_pk_bf16_f32 v203, v238, v239
    v_exp_f32 v241, v141
    v_mfma_f32_16x16x32_bf16 v[180:183], a[144:147], v[80:83], v[36:39]
    ds_read_b128 a[192:195], v3 offset:0
    v_add_f32 v51, v240, v241
    v_mfma_f32_16x16x32_bf16 v[184:187], a[144:147], v[96:99], v[40:43]
    v_exp_f32 v242, v142
    v_mfma_f32_16x16x32_bf16 v[188:191], a[144:147], v[112:115], v[44:47]
    buffer_load_dword v7, v228, s[12:15], s62 offen
    s_add_u32 s62, s62, 0x1000
    v_mfma_f32_16x16x32_bf16 v[176:179], a[148:151], v[68:71], v[176:179]
    v_cvt_pk_bf16_f32 v204, v240, v241
    v_exp_f32 v243, v143
    v_mfma_f32_16x16x32_bf16 v[180:183], a[148:151], v[84:87], v[180:183]
    v_add_u32 v2, s52, v1
    v_add_f32 v51, v51, v242
    v_mfma_f32_16x16x32_bf16 v[184:187], a[148:151], v[100:103], v[184:187]
    ds_read_b128 a[196:199], v3 offset:1024
    v_add_f32 v51, v51, v243
    v_mfma_f32_16x16x32_bf16 v[188:191], a[148:151], v[116:119], v[188:191]
    s_waitcnt lgkmcnt(2)
    v_exp_f32 v244, v156
    v_mfma_f32_16x16x32_bf16 v[176:179], a[152:155], v[72:75], v[176:179]
    s_sub_u32 s63, s63, 1
    v_cvt_pk_bf16_f32 v205, v242, v243
    v_add_f32 v51, v51, v244
    v_mfma_f32_16x16x32_bf16 v[180:183], a[152:155], v[88:91], v[180:183]
    ds_read_b128 a[200:203], v3 offset:2048
    v_exp_f32 v245, v157
    v_mfma_f32_16x16x32_bf16 v[184:187], a[152:155], v[104:107], v[184:187]
    v_add_f32 v51, v51, v245
    v_cvt_pk_bf16_f32 v206, v244, v245
    v_mfma_f32_16x16x32_bf16 v[188:191], a[152:155], v[120:123], v[188:191]
    v_exp_f32 v246, v158
    v_mfma_f32_16x16x32_bf16 v[176:179], a[156:159], v[76:79], v[176:179]
    v_exp_f32 v247, v159
    v_mfma_f32_16x16x32_bf16 v[180:183], a[156:159], v[92:95], v[180:183]
    ds_read_b128 a[204:207], v3 offset:3072
    v_add_f32 v51, v51, v246
    v_max3_f32 v6, v48, v49, v50
    v_mfma_f32_16x16x32_bf16 v[184:187], a[156:159], v[108:111], v[184:187]
    v_add_f32 v51, v51, v247
    v_cvt_pk_bf16_f32 v207, v246, v247
    v_mfma_f32_16x16x32_bf16 v[188:191], a[156:159], v[124:127], v[188:191]
    s_waitcnt vmcnt(8)
    s_barrier
    v_max_f32 v6, v6, v51
    v_cmp_nge_f32 vcc, s37, v6
    s_cbranch_vccnz k2_rare_54
k2_ret_55:
    s_cmp_lg_u32 s63, 0
    s_cbranch_scc1 k2_dloop_47
    s_waitcnt lgkmcnt(2)
    v_mfma_f32_16x16x32_bf16 a[0:3], a[192:195], v[192:195], a[0:3]
    ds_read_b128 a[208:211], v3 offset:4096
    v_add_f32 v12, v12, v48
    v_mfma_f32_16x16x32_bf16 a[4:7], a[192:195], v[196:199], a[4:7]
    v_exp_f32 v232, v160
    v_add_f32 v13, v13, v49
    v_mfma_f32_16x16x32_bf16 a[8:11], a[192:195], v[200:203], a[8:11]
    s_mov_b32 m0, s34
    v_add_f32 v14, v14, v50
    v_add_f32 v15, v15, v51
    v_mfma_f32_16x16x32_bf16 a[12:15], a[192:195], v[204:207], a[12:15]
    s_add_u32 s53, s53, 8192
    v_exp_f32 v233, v161
    v_mfma_f32_16x16x32_bf16 a[16:19], a[196:199], v[192:195], a[16:19]
    s_and_b32 s53, s53, 0xffff
    buffer_load_dwordx4 v1, s[16:19], s32 offen offset:0 sc1 lds
    ds_read_b128 a[212:215], v3 offset:5120
    v_mfma_f32_16x16x32_bf16 a[20:23], a[196:199], v[196:199], a[20:23]
    v_add_f32 v48, v232, v233
    v_exp_f32 v234, v162
    v_mfma_f32_16x16x32_bf16 a[24:27], a[196:199], v[200:203], a[24:27]
    v_cvt_pk_bf16_f32 v208, v232, v233
    v_add_f32 v48, v48, v234
    v_mfma_f32_16x16x32_bf16 a[28:31], a[196:199], v[204:207], a[28:31]
    s_waitcnt lgkmcnt(2)
    ds_read_b128 a[216:219], v3 offset:6144
    v_exp_f32 v235, v163
    v_mfma_f32_16x16x32_bf16 a[32:35], a[200:203], v[192:195], a[32:35]
    v_add_f32 v48, v48, v235
    v_cvt_pk_bf16_f32 v209, v234, v235
    v_mfma_f32_16x16x32_bf16 a[36:39], a[200:203], v[196:199], a[36:39]
    v_exp_f32 v236, v176
    v_mfma_f32_16x16x32_bf16 a[40:43], a[200:203], v[200:203], a[40:43]
    v_exp_f32 v237, v177
    v_add_f32 v48, v48, v236
    v_mfma_f32_16x16x32_bf16 a[44:47], a[200:203], v[204:207], a[44:47]
    ds_read_b128 a[220:223], v3 offset:7168
    v_add_f32 v48, v48, v237
    v_mfma_f32_16x16x32_bf16 a[48:51], a[204:207], v[192:195], a[48:51]
    v_exp_f32 v238, v178
    v_mfma_f32_16x16x32_bf16 a[52:55], a[204:207], v[196:199], a[52:55]
    v_cvt_pk_bf16_f32 v210, v236, v237
    v_exp_f32 v239, v179
    v_mfma_f32_16x16x32_bf16 a[56:59], a[204:207], v[200:203], a[56:59]
    v_add_f32 v48, v48, v238
    v_add_f32 v48, v48, v239
    v_mfma_f32_16x16x32_bf16 a[60:63], a[204:207], v[204:207], a[60:63]
    s_waitcnt lgkmcnt(2)
    v_exp_f32 v240, v164
    v_mfma_f32_16x16x32_bf16 a[64:67], a[208:211], v[192:195], a[64:67]
    s_add_u32 s34, s34, 0x4000
    ds_read_b128 a[128:131], v2 offset:0
    ds_read_b128 a[132:135], v2 offset:1024
    v_cvt_pk_bf16_f32 v211, v238, v239
    v_mfma_f32_16x16x32_bf16 a[68:71], a[208:211], v[196:199], a[68:71]
    v_exp_f32 v241, v165
    v_mfma_f32_16x16x32_bf16 a[72:75], a[208:211], v[200:203], a[72:75]
    buffer_load_dwordx4 v1, s[16:19], s32 offen offset:1024 sc1 lds
    ds_read_b128 a[136:139], v2 offset:2048
    v_mfma_f32_16x16x32_bf16 a[76:79], a[208:211], v[204:207], a[76:79]
    v_add_u32 v3, s53, v56
    v_add_f32 v49, v240, v241
    v_cvt_pk_bf16_f32 v212, v240, v241
    v_mfma_f32_16x16x32_bf16 a[80:83], a[212:215], v[192:195], a[80:83]
    v_exp_f32 v242, v166
    v_mfma_f32_16x16x32_bf16 a[84:87], a[212:215], v[196:199], a[84:87]
    v_exp_f32 v243, v167
    v_mfma_f32_16x16x32_bf16 a[88:91], a[212:215], v[200:203], a[88:91]
    ds_read_b128 a[140:143], v2 offset:3072
    v_add_f32 v49, v49, v242
    v_add_f32 v49, v49, v243
    v_mfma_f32_16x16x32_bf16 a[92:95], a[212:215], v[204:207], a[92:95]
    s_waitcnt lgkmcnt(4)
    v_exp_f32 v244, v180
    v_mfma_f32_16x16x32_bf16 a[96:99], a[216:219], v[192:195], a[96:99]
    ds_read_b128 a[144:147], v2 offset:4096
    v_cvt_pk_bf16_f32 v213, v242, v243
    v_mfma_f32_16x16x32_bf16 a[100:103], a[216:219], v[196:199], a[100:103]
    v_exp_f32 v245, v181
    v_add_f32 v49, v49, v244
    v_mfma_f32_16x16x32_bf16 a[104:107], a[216:219], v[200:203], a[104:107]
    s_branch k2_prep_56
k2_prepret_57:
    v_mfma_f32_16x16x32_bf16 a[108:111], a[216:219], v[204:207], a[108:111]
    ds_read_b128 a[148:151], v2 offset:5120
    v_add_f32 v49, v49, v245
    v_mfma_f32_16x16x32_bf16 a[112:115], a[220:223], v[192:195], a[112:115]
    v_exp_f32 v246, v182
    v_cvt_pk_bf16_f32 v214, v244, v245
    v_mfma_f32_16x16x32_bf16 a[116:119], a[220:223], v[196:199], a[116:119]
    s_and_b32 s34, s34, 0xffff
    ds_read_b128 a[152:155], v2 offset:6144
    v_add_f32 v49, v49, v246
    v_mfma_f32_16x16x32_bf16 a[120:123], a[220:223], v[200:203], a[120:123]
    v_exp_f32 v247, v183
    v_mfma_f32_16x16x32_bf16 a[124:127], a[220:223], v[204:207], a[124:127]
    s_waitcnt lgkmcnt(5)
    ds_read_b128 a[156:159], v2 offset:7168
    v_add_f32 v49, v49, v247
    v_mfma_f32_16x16x32_bf16 v[128:131], a[128:131], v[96:99], v[16:19]
    v_exp_f32 v232, v168
    v_cvt_pk_bf16_f32 v215, v246, v247
    v_mfma_f32_16x16x32_bf16 v[132:135], a[128:131], v[112:115], v[20:23]
    buffer_load_dwordx4 v1, s[16:19], s32 offen offset:2048 sc1 lds
    ds_read_b128 a[160:163], v2 offset:8192
    v_mfma_f32_16x16x32_bf16 v[128:131], a[132:135], v[100:103], v[128:131]
    v_exp_f32 v233, v169
    v_mfma_f32_16x16x32_bf16 v[132:135], a[132:135], v[116:119], v[132:135]
    s_waitcnt lgkmcnt(5)
    ds_read_b128 a[164:167], v2 offset:9216
    v_add_f32 v50, v232, v233
    v_cvt_pk_bf16_f32 v216, v232, v233
    v_mfma_f32_16x16x32_bf16 v[128:131], a[136:139], v[104:107], v[128:131]
    s_add_u32 s36, s36, 64
    v_exp_f32 v234, v170
    v_mfma_f32_16x16x32_bf16 v[132:135], a[136:139], v[120:123], v[132:135]
    ds_read_b128 a[168:171], v2 offset:10240
    v_add_f32 v50, v50, v234
    v_mfma_f32_16x16x32_bf16 v[128:131], a[140:143], v[108:111], v[128:131]
    ds_read_b128 a[172:175], v2 offset:11264
    v_exp_f32 v235, v171
    v_mfma_f32_16x16x32_bf16 v[132:135], a[140:143], v[124:127], v[132:135]
    s_waitcnt lgkmcnt(6)
    v_add_f32 v50, v50, v235
    v_cvt_pk_bf16_f32 v217, v234, v235
    v_mfma_f32_16x16x32_bf16 v[144:147], a[144:147], v[96:99], v[32:35]
    s_add_u32 s52, s52, 16384
    v_exp_f32 v236, v184
    v_mfma_f32_16x16x32_bf16 v[148:151], a[144:147], v[112:115], v[36:39]
    ds_read_b128 a[176:179], v2 offset:12288
    v_exp_f32 v237, v185
    v_mfma_f32_16x16x32_bf16 v[144:147], a[148:151], v[100:103], v[144:147]
    s_and_b32 s52, s52, 0xffff
    ds_read_b128 a[180:183], v2 offset:13312
    v_add_f32 v50, v50, v236
    v_mfma_f32_16x16x32_bf16 v[148:151], a[148:151], v[116:119], v[148:151]
    s_waitcnt lgkmcnt(6)
    v_add_f32 v50, v50, v237
    v_cvt_pk_bf16_f32 v218, v236, v237
    v_mfma_f32_16x16x32_bf16 v[144:147], a[152:155], v[104:107], v[144:147]
    ds_read_b128 a[184:187], v2 offset:14336
    v_exp_f32 v238, v186
    v_mfma_f32_16x16x32_bf16 v[148:151], a[152:155], v[120:123], v[148:151]
    v_exp_f32 v239, v187
    v_mfma_f32_16x16x32_bf16 v[144:147], a[156:159], v[108:111], v[144:147]
    ds_read_b128 a[188:191], v2 offset:15360
    v_add_f32 v50, v50, v238
    v_mfma_f32_16x16x32_bf16 v[148:151], a[156:159], v[124:127], v[148:151]
    s_waitcnt lgkmcnt(6)
    v_add_f32 v50, v50, v239
    v_exp_f32 v240, v172
    v_mfma_f32_16x16x32_bf16 v[136:139], a[160:163], v[96:99], v[24:27]
    ds_read_b128 a[192:195], v3 offset:0
    v_cvt_pk_bf16_f32 v219, v238, v239
    v_mfma_f32_16x16x32_bf16 v[140:143], a[160:163], v[112:115], v[28:31]
    buffer_load_dwordx4 v1, s[16:19], s32 offen offset:3072 sc1 lds
    s_add_u32 s32, s32, 0x80000
    v_mfma_f32_16x16x32_bf16 v[136:139], a[164:167], v[100:103], v[136:139]
    v_exp_f32 v241, v173
    v_add_u32 v2, s52, v1
    v_mfma_f32_16x16x32_bf16 v[140:143], a[164:167], v[116:119], v[140:143]
    s_waitcnt lgkmcnt(5)
    v_add_f32 v51, v240, v241
    v_exp_f32 v242, v174
    v_mfma_f32_16x16x32_bf16 v[136:139], a[168:171], v[104:107], v[136:139]
    v_cvt_pk_bf16_f32 v220, v240, v241
    v_add_f32 v51, v51, v242
    v_mfma_f32_16x16x32_bf16 v[140:143], a[168:171], v[120:123], v[140:143]
    v_exp_f32 v243, v175
    v_mfma_f32_16x16x32_bf16 v[136:139], a[172:175], v[108:111], v[136:139]
    ds_read_b128 a[196:199], v3 offset:1024
    v_add_f32 v51, v51, v243
    v_mfma_f32_16x16x32_bf16 v[140:143], a[172:175], v[124:127], v[140:143]
    s_waitcnt lgkmcnt(4)
    v_exp_f32 v244, v188
    v_mfma_f32_16x16x32_bf16 v[152:155], a[176:179], v[96:99], v[40:43]
    v_cvt_pk_bf16_f32 v221, v242, v243
    v_exp_f32 v245, v189
    v_mfma_f32_16x16x32_bf16 v[156:159], a[176:179], v[112:115], v[44:47]
    ds_read_b128 a[200:203], v3 offset:2048
    v_add_f32 v51, v51, v244
    v_mfma_f32_16x16x32_bf16 v[152:155], a[180:183], v[100:103], v[152:155]
    v_add_f32 v51, v51, v245
    v_cvt_pk_bf16_f32 v222, v244, v245
    v_mfma_f32_16x16x32_bf16 v[156:159], a[180:183], v[116:119], v[156:159]
    s_waitcnt lgkmcnt(3)
    v_exp_f32 v246, v190
    v_max3_f32 v6, v48, v49, v50
    v_mfma_f32_16x16x32_bf16 v[152:155], a[184:187], v[104:107], v[152:155]
    v_exp_f32 v247, v191
    v_mfma_f32_16x16x32_bf16 v[156:159], a[184:187], v[120:123], v[156:159]
    ds_read_b128 a[204:207], v3 offset:3072
    v_add_f32 v51, v51, v246
    v_mfma_f32_16x16x32_bf16 v[152:155], a[188:191], v[108:111], v[152:155]
    v_add_f32 v51, v51, v247
    v_cvt_pk_bf16_f32 v223, v246, v247
    v_max_f32 v6, v6, v51
    v_mfma_f32_16x16x32_bf16 v[156:159], a[188:191], v[124:127], v[156:159]
    v_cmp_nge_f32 vcc, s37, v6
    s_cbranch_vccnz k2_rare_58
k2_ret_59:
    s_waitcnt lgkmcnt(2)
    v_mfma_f32_16x16x32_bf16 a[0:3], a[192:195], v[208:211], a[0:3]
    ds_read_b128 a[208:211], v3 offset:4096
    v_add_f32 v12, v12, v48
    v_mfma_f32_16x16x32_bf16 a[4:7], a[192:195], v[212:215], a[4:7]
    s_mov_b32 m0, s35
    v_exp_f32 v232, v128
    v_add_f32 v13, v13, v49
    v_mfma_f32_16x16x32_bf16 a[8:11], a[192:195], v[216:219], a[8:11]
    s_add_u32 s53, s53, 8192
    v_add_f32 v14, v14, v50
    v_add_f32 v15, v15, v51
    v_mfma_f32_16x16x32_bf16 a[12:15], a[192:195], v[220:223], a[12:15]
    ds_read_b128 a[212:215], v3 offset:5120
    v_exp_f32 v233, v129
    v_mfma_f32_16x16x32_bf16 a[16:19], a[196:199], v[208:211], a[16:19]
    s_and_b32 s53, s53, 0xffff
    buffer_load_dwordx4 v1, s[20:23], s33 offen offset:0 sc1 lds
    v_mfma_f32_16x16x32_bf16 a[20:23], a[196:199], v[212:215], a[20:23]
    v_add_f32 v48, v232, v233
    v_exp_f32 v234, v130
    v_mfma_f32_16x16x32_bf16 a[24:27], a[196:199], v[216:219], a[24:27]
    v_cvt_pk_bf16_f32 v192, v232, v233
    v_exp_f32 v235, v131
    v_mfma_f32_16x16x32_bf16 a[28:31], a[196:199], v[220:223], a[28:31]
    s_waitcnt lgkmcnt(2)
    ds_read_b128 a[216:219], v3 offset:6144
    v_add_f32 v48, v48, v234
    v_add_f32 v48, v48, v235
    v_mfma_f32_16x16x32_bf16 a[32:35], a[200:203], v[208:211], a[32:35]
    s_add_u32 s35, s35, 0x4000
    v_exp_f32 v236, v144
    v_mfma_f32_16x16x32_bf16 a[36:39], a[200:203], v[212:215], a[36:39]
    v_cvt_pk_bf16_f32 v193, v234, v235
    v_exp_f32 v237, v145
    v_mfma_f32_16x16x32_bf16 a[40:43], a[200:203], v[216:219], a[40:43]
    buffer_load_dwordx4 v1, s[20:23], s33 offen offset:1024 sc1 lds
    ds_read_b128 a[220:223], v3 offset:7168
    v_mfma_f32_16x16x32_bf16 a[44:47], a[200:203], v[220:223], a[44:47]
    v_add_f32 v48, v48, v236
    v_add_f32 v48, v48, v237
    v_mfma_f32_16x16x32_bf16 a[48:51], a[204:207], v[208:211], a[48:51]
    v_exp_f32 v238, v146
    v_cvt_pk_bf16_f32 v194, v236, v237
    v_mfma_f32_16x16x32_bf16 a[52:55], a[204:207], v[212:215], a[52:55]
    v_exp_f32 v239, v147
    v_mfma_f32_16x16x32_bf16 a[56:59], a[204:207], v[216:219], a[56:59]
    s_and_b32 s35, s35, 0xffff
    v_add_f32 v48, v48, v238
    v_add_f32 v48, v48, v239
    v_cvt_pk_bf16_f32 v195, v238, v239
    v_mfma_f32_16x16x32_bf16 a[60:63], a[204:207], v[220:223], a[60:63]
    s_waitcnt lgkmcnt(2)
    v_exp_f32 v240, v132
    v_mfma_f32_16x16x32_bf16 a[64:67], a[208:211], v[208:211], a[64:67]
    buffer_load_dwordx4 v1, s[20:23], s33 offen offset:2048 sc1 lds
    ds_read_b128 a[128:131], v2 offset:0
    ds_read_b128 a[132:135], v2 offset:1024
    v_mfma_f32_16x16x32_bf16 a[68:71], a[208:211], v[212:215], a[68:71]
    v_exp_f32 v241, v133
    v_mfma_f32_16x16x32_bf16 a[72:75], a[208:211], v[216:219], a[72:75]
    s_or_b32 s35, s35, 0x10000
    ds_read_b128 a[136:139], v2 offset:2048
    v_add_u32 v3, s53, v56
    v_add_f32 v49, v240, v241
    v_mfma_f32_16x16x32_bf16 a[76:79], a[208:211], v[220:223], a[76:79]
    v_exp_f32 v242, v134
    v_mfma_f32_16x16x32_bf16 a[80:83], a[212:215], v[208:211], a[80:83]
    v_cvt_pk_bf16_f32 v196, v240, v241
    v_exp_f32 v243, v135
    v_mfma_f32_16x16x32_bf16 a[84:87], a[212:215], v[212:215], a[84:87]
    ds_read_b128 a[140:143], v2 offset:3072
    v_add_f32 v49, v49, v242
    v_mfma_f32_16x16x32_bf16 a[88:91], a[212:215], v[216:219], a[88:91]
    ds_read_b128 a[144:147], v2 offset:4096
    v_add_f32 v49, v49, v243
    v_mfma_f32_16x16x32_bf16 a[92:95], a[212:215], v[220:223], a[92:95]
    s_waitcnt lgkmcnt(5)
    v_exp_f32 v244, v148
    v_cvt_pk_bf16_f32 v197, v242, v243
    v_mfma_f32_16x16x32_bf16 a[96:99], a[216:219], v[208:211], a[96:99]
    buffer_load_dwordx4 v1, s[20:23], s33 offen offset:3072 sc1 lds
    ds_read_b128 a[148:151], v2 offset:5120
    v_mfma_f32_16x16x32_bf16 a[100:103], a[216:219], v[212:215], a[100:103]
    s_add_u32 s33, s33, 0x80000
    v_exp_f32 v245, v149
    v_add_f32 v49, v49, v244
    v_mfma_f32_16x16x32_bf16 a[104:107], a[216:219], v[216:219], a[104:107]
    s_cmp_ge_u32 s36, s43
    s_cbranch_scc1 k2_prep_60
k2_prepret_61:
    v_mfma_f32_16x16x32_bf16 a[108:111], a[216:219], v[220:223], a[108:111]
    v_add_f32 v49, v49, v245
    v_exp_f32 v246, v150
    v_mfma_f32_16x16x32_bf16 a[112:115], a[220:223], v[208:211], a[112:115]
    ds_read_b128 a[152:155], v2 offset:6144
    v_cvt_pk_bf16_f32 v198, v244, v245
    v_mfma_f32_16x16x32_bf16 a[116:119], a[220:223], v[212:215], a[116:119]
    v_exp_f32 v247, v151
    v_add_f32 v49, v49, v246
    v_mfma_f32_16x16x32_bf16 a[120:123], a[220:223], v[216:219], a[120:123]
    ds_read_b128 a[156:159], v2 offset:7168
    v_add_f32 v49, v49, v247
    v_mfma_f32_16x16x32_bf16 a[124:127], a[220:223], v[220:223], a[124:127]
    s_waitcnt lgkmcnt(6)
    v_exp_f32 v232, v136
    v_mfma_f32_16x16x32_bf16 v[160:163], a[128:131], v[96:99], v[16:19]
    s_waitcnt vmcnt(12)
    s_barrier
    ds_read_b128 a[160:163], v2 offset:8192
    ds_read_b128 a[164:167], v2 offset:9216
    v_cvt_pk_bf16_f32 v199, v246, v247
    v_mfma_f32_16x16x32_bf16 v[164:167], a[128:131], v[112:115], v[20:23]
    s_mov_b32 m0, s34
    v_exp_f32 v233, v137
    v_mfma_f32_16x16x32_bf16 v[160:163], a[132:135], v[100:103], v[160:163]
    v_add_f32 v50, v232, v233
    v_exp_f32 v234, v138
    v_mfma_f32_16x16x32_bf16 v[164:167], a[132:135], v[116:119], v[164:167]
    s_waitcnt lgkmcnt(6)
    ds_read_b128 a[168:171], v2 offset:10240
    v_cvt_pk_bf16_f32 v200, v232, v233
    v_mfma_f32_16x16x32_bf16 v[160:163], a[136:139], v[104:107], v[160:163]
    s_add_u32 s36, s36, 64
    buffer_load_dwordx4 v1, s[16:19], s32 offen offset:0 sc1 lds
    ds_read_b128 a[172:175], v2 offset:11264
    v_mfma_f32_16x16x32_bf16 v[164:167], a[136:139], v[120:123], v[164:167]
    v_exp_f32 v235, v139
    v_add_f32 v50, v50, v234
    v_mfma_f32_16x16x32_bf16 v[160:163], a[140:143], v[108:111], v[160:163]
    v_add_f32 v50, v50, v235
    v_exp_f32 v236, v152
    v_mfma_f32_16x16x32_bf16 v[164:167], a[140:143], v[124:127], v[164:167]
    s_waitcnt lgkmcnt(6)
    ds_read_b128 a[176:179], v2 offset:12288
    v_cvt_pk_bf16_f32 v201, v234, v235
    v_mfma_f32_16x16x32_bf16 v[176:179], a[144:147], v[96:99], v[32:35]
    s_add_u32 s34, s34, 0x4000
    v_exp_f32 v237, v153
    v_add_f32 v50, v50, v236
    v_mfma_f32_16x16x32_bf16 v[180:183], a[144:147], v[112:115], v[36:39]
    s_add_u32 s52, s52, 16384
    ds_read_b128 a[180:183], v2 offset:13312
    v_add_f32 v50, v50, v237
    v_mfma_f32_16x16x32_bf16 v[176:179], a[148:151], v[100:103], v[176:179]
    s_and_b32 s52, s52, 0xffff
    v_exp_f32 v238, v154
    v_mfma_f32_16x16x32_bf16 v[180:183], a[148:151], v[116:119], v[180:183]
    s_waitcnt lgkmcnt(6)
    buffer_load_dwordx4 v1, s[16:19], s32 offen offset:1024 sc1 lds
    ds_read_b128 a[184:187], v2 offset:14336
    ds_read_b128 a[188:191], v2 offset:15360
    v_mfma_f32_16x16x32_bf16 v[176:179], a[152:155], v[104:107], v[176:179]
    v_cvt_pk_bf16_f32 v202, v236, v237
    v_add_f32 v50, v50, v238
    v_mfma_f32_16x16x32_bf16 v[180:183], a[152:155], v[120:123], v[180:183]
    v_exp_f32 v239, v155
    v_mfma_f32_16x16x32_bf16 v[176:179], a[156:159], v[108:111], v[176:179]
    s_and_b32 s34, s34, 0xffff
    v_add_f32 v50, v50, v239
    v_exp_f32 v240, v140
    v_mfma_f32_16x16x32_bf16 v[180:183], a[156:159], v[124:127], v[180:183]
    s_waitcnt lgkmcnt(6)
    v_cvt_pk_bf16_f32 v203, v238, v239
    v_exp_f32 v241, v141
    v_mfma_f32_16x16x32_bf16 v[168:171], a[160:163], v[96:99], v[24:27]
    ds_read_b128 a[192:195], v3 offset:0
    v_add_f32 v51, v240, v241
    v_mfma_f32_16x16x32_bf16 v[172:175], a[160:163], v[112:115], v[28:31]
    v_exp_f32 v242, v142
    v_cvt_pk_bf16_f32 v204, v240, v241
    v_mfma_f32_16x16x32_bf16 v[168:171], a[164:167], v[100:103], v[168:171]
    buffer_load_dwordx4 v1, s[16:19], s32 offen offset:2048 sc1 lds
    ds_read_b128 a[196:199], v3 offset:1024
    v_mfma_f32_16x16x32_bf16 v[172:175], a[164:167], v[116:119], v[172:175]
    s_waitcnt lgkmcnt(6)
    v_exp_f32 v243, v143
    v_add_u32 v2, s52, v1
    v_mfma_f32_16x16x32_bf16 v[168:171], a[168:171], v[104:107], v[168:171]
    ds_read_b128 a[200:203], v3 offset:2048
    v_add_f32 v51, v51, v242
    v_mfma_f32_16x16x32_bf16 v[172:175], a[168:171], v[120:123], v[172:175]
    v_add_f32 v51, v51, v243
    v_cvt_pk_bf16_f32 v205, v242, v243
    v_mfma_f32_16x16x32_bf16 v[168:171], a[172:175], v[108:111], v[168:171]
    ds_read_b128 a[204:207], v3 offset:3072
    v_exp_f32 v244, v156
    v_mfma_f32_16x16x32_bf16 v[172:175], a[172:175], v[124:127], v[172:175]
    s_waitcnt lgkmcnt(6)
    v_exp_f32 v245, v157
    v_mfma_f32_16x16x32_bf16 v[184:187], a[176:179], v[96:99], v[40:43]
    ds_read_b128 a[208:211], v3 offset:4096
    v_add_f32 v51, v51, v244
    v_add_f32 v51, v51, v245
    v_mfma_f32_16x16x32_bf16 v[188:191], a[176:179], v[112:115], v[44:47]
    v_exp_f32 v246, v158
    v_mfma_f32_16x16x32_bf16 v[184:187], a[180:183], v[100:103], v[184:187]
    buffer_load_dwordx4 v1, s[16:19], s32 offen offset:3072 sc1 lds
    ds_read_b128 a[212:215], v3 offset:5120
    s_add_u32 s32, s32, 0x80000
    v_mfma_f32_16x16x32_bf16 v[188:191], a[180:183], v[116:119], v[188:191]
    s_waitcnt lgkmcnt(6)
    v_cvt_pk_bf16_f32 v206, v244, v245
    v_add_f32 v51, v51, v246
    v_mfma_f32_16x16x32_bf16 v[184:187], a[184:187], v[104:107], v[184:187]
    v_exp_f32 v247, v159
    v_max3_f32 v6, v48, v49, v50
    v_mfma_f32_16x16x32_bf16 v[188:191], a[184:187], v[120:123], v[188:191]
    ds_read_b128 a[216:219], v3 offset:6144
    v_add_f32 v51, v51, v247
    v_mfma_f32_16x16x32_bf16 v[184:187], a[188:191], v[108:111], v[184:187]
    ds_read_b128 a[220:223], v3 offset:7168
    v_cvt_pk_bf16_f32 v207, v246, v247
    v_max_f32 v6, v6, v51
    v_mfma_f32_16x16x32_bf16 v[188:191], a[188:191], v[124:127], v[188:191]
    v_cmp_nge_f32 vcc, s37, v6
    s_cbranch_vccnz k2_rare_62
k2_ret_63:
    s_lshl_b32 s63, s29, 1
    s_sub_u32 s63, 14, s63
    s_cmp_eq_u32 s63, 0
    s_cbranch_scc1 k2_sdone_65
k2_sloop_64:
    s_waitcnt lgkmcnt(6)
    v_mfma_f32_16x16x32_bf16 a[8:11], a[192:195], v[192:195], a[8:11]
    ds_read_b128 a[224:227], v3 offset:8192
    v_add_f32 v14, v14, v48
    v_add_f32 v15, v15, v49
    v_mfma_f32_16x16x32_bf16 a[12:15], a[192:195], v[196:199], a[12:15]
    s_mov_b32 m0, s35
    v_exp_f32 v232, v160
    v_mfma_f32_16x16x32_bf16 a[24:27], a[196:199], v[192:195], a[24:27]
    s_add_u32 s53, s53, 16384
    ds_read_b128 a[228:231], v3 offset:9216
    v_add_f32 v14, v14, v50
    v_add_f32 v15, v15, v51
    v_mfma_f32_16x16x32_bf16 a[28:31], a[196:199], v[196:199], a[28:31]
    s_waitcnt lgkmcnt(6)
    v_exp_f32 v233, v161
    v_mfma_f32_16x16x32_bf16 a[40:43], a[200:203], v[192:195], a[40:43]
    s_and_b32 s53, s53, 0xffff
    buffer_load_dwordx4 v1, s[20:23], s33 offen offset:0 sc1 lds
    ds_read_b128 a[232:235], v3 offset:10240
    ds_read_b128 a[236:239], v3 offset:11264
    v_mfma_f32_16x16x32_bf16 a[44:47], a[200:203], v[196:199], a[44:47]
    v_add_f32 v48, v232, v233
    v_cvt_pk_bf16_f32 v208, v232, v233
    v_mfma_f32_16x16x32_bf16 a[56:59], a[204:207], v[192:195], a[56:59]
    ds_read_b128 a[240:243], v3 offset:12288
    v_exp_f32 v234, v162
    v_mfma_f32_16x16x32_bf16 a[60:63], a[204:207], v[196:199], a[60:63]
    s_waitcnt lgkmcnt(7)
    v_exp_f32 v235, v163
    v_mfma_f32_16x16x32_bf16 a[72:75], a[208:211], v[192:195], a[72:75]
    s_add_u32 s35, s35, 0x4000
    v_add_f32 v48, v48, v234
    v_add_f32 v48, v48, v235
    v_cvt_pk_bf16_f32 v209, v234, v235
    v_mfma_f32_16x16x32_bf16 a[76:79], a[208:211], v[196:199], a[76:79]
    v_exp_f32 v236, v176
    v_mfma_f32_16x16x32_bf16 a[88:91], a[212:215], v[192:195], a[88:91]
    ds_read_b128 a[244:247], v3 offset:13312
    v_exp_f32 v237, v177
    v_mfma_f32_16x16x32_bf16 a[92:95], a[212:215], v[196:199], a[92:95]
    s_waitcnt lgkmcnt(6)
    buffer_load_dwordx4 v1, s[20:23], s33 offen offset:1024 sc1 lds
    ds_read_b128 a[248:251], v3 offset:14336
    v_mfma_f32_16x16x32_bf16 a[104:107], a[216:219], v[192:195], a[104:107]
    v_add_f32 v48, v48, v236
    v_add_f32 v48, v48, v237
    v_cvt_pk_bf16_f32 v210, v236, v237
    v_mfma_f32_16x16x32_bf16 a[108:111], a[216:219], v[196:199], a[108:111]
    v_exp_f32 v238, v178
    v_mfma_f32_16x16x32_bf16 a[120:123], a[220:223], v[192:195], a[120:123]
    s_and_b32 s35, s35, 0xffff
    ds_read_b128 a[252:255], v3 offset:15360
    v_exp_f32 v239, v179
    v_mfma_f32_16x16x32_bf16 a[124:127], a[220:223], v[196:199], a[124:127]
    s_waitcnt lgkmcnt(6)
    v_add_f32 v48, v48, v238
    v_add_f32 v48, v48, v239
    v_mfma_f32_16x16x32_bf16 a[8:11], a[224:227], v[200:203], a[8:11]
    ds_read_b128 a[128:131], v2 offset:0
    v_exp_f32 v240, v164
    v_mfma_f32_16x16x32_bf16 a[12:15], a[224:227], v[204:207], a[12:15]
    ds_read_b128 a[132:135], v2 offset:1024
    v_cvt_pk_bf16_f32 v211, v238, v239
    v_mfma_f32_16x16x32_bf16 a[24:27], a[228:231], v[200:203], a[24:27]
    s_or_b32 s35, s35, 0x10000
    buffer_load_dwordx4 v1, s[20:23], s33 offen offset:2048 sc1 lds
    ds_read_b128 a[136:139], v2 offset:2048
    v_mfma_f32_16x16x32_bf16 a[28:31], a[228:231], v[204:207], a[28:31]
    s_waitcnt lgkmcnt(7)
    v_exp_f32 v241, v165
    v_add_u32 v3, s53, v56
    v_mfma_f32_16x16x32_bf16 a[40:43], a[232:235], v[200:203], a[40:43]
    v_add_f32 v49, v240, v241
    v_exp_f32 v242, v166
    v_mfma_f32_16x16x32_bf16 a[44:47], a[232:235], v[204:207], a[44:47]
    v_cvt_pk_bf16_f32 v212, v240, v241
    v_add_f32 v49, v49, v242
    v_mfma_f32_16x16x32_bf16 a[56:59], a[236:239], v[200:203], a[56:59]
    ds_read_b128 a[140:143], v2 offset:3072
    v_exp_f32 v243, v167
    v_mfma_f32_16x16x32_bf16 a[60:63], a[236:239], v[204:207], a[60:63]
    s_waitcnt lgkmcnt(6)
    ds_read_b128 a[144:147], v2 offset:4096
    v_add_f32 v49, v49, v243
    v_mfma_f32_16x16x32_bf16 a[72:75], a[240:243], v[200:203], a[72:75]
    v_exp_f32 v244, v180
    v_cvt_pk_bf16_f32 v213, v242, v243
    v_mfma_f32_16x16x32_bf16 a[76:79], a[240:243], v[204:207], a[76:79]
    buffer_load_dwordx4 v1, s[20:23], s33 offen offset:3072 sc1 lds
    ds_read_b128 a[148:151], v2 offset:5120
    v_mfma_f32_16x16x32_bf16 a[88:91], a[244:247], v[200:203], a[88:91]
    s_add_u32 s33, s33, 0x80000
    v_exp_f32 v245, v181
    v_add_f32 v49, v49, v244
    v_mfma_f32_16x16x32_bf16 a[92:95], a[244:247], v[204:207], a[92:95]
    s_waitcnt lgkmcnt(6)
    s_cmp_ge_u32 s36, s43
    s_cbranch_scc1 k2_prep_66
k2_prepret_67:
    v_mfma_f32_16x16x32_bf16 a[104:107], a[248:251], v[200:203], a[104:107]
    v_add_f32 v49, v49, v245
    v_exp_f32 v246, v182
    v_mfma_f32_16x16x32_bf16 a[108:111], a[248:251], v[204:207], a[108:111]
    ds_read_b128 a[152:155], v2 offset:6144
    v_cvt_pk_bf16_f32 v214, v244, v245
    v_mfma_f32_16x16x32_bf16 a[120:123], a[252:255], v[200:203], a[120:123]
    v_exp_f32 v247, v183
    v_add_f32 v49, v49, v246
    v_mfma_f32_16x16x32_bf16 a[124:127], a[252:255], v[204:207], a[124:127]
    s_waitcnt lgkmcnt(5)
    ds_read_b128 a[156:159], v2 offset:7168
    v_add_f32 v49, v49, v247
    v_mfma_f32_16x16x32_bf16 v[128:131], a[128:131], v[96:99], v[16:19]
    s_waitcnt vmcnt(12)
    s_barrier
    v_exp_f32 v232, v168
    v_cvt_pk_bf16_f32 v215, v246, v247
    v_mfma_f32_16x16x32_bf16 v[132:135], a[128:131], v[112:115], v[20:23]
    s_mov_b32 m0, s34
    ds_read_b128 a[160:163], v2 offset:8192
    v_exp_f32 v233, v169
    v_mfma_f32_16x16x32_bf16 v[128:131], a[132:135], v[100:103], v[128:131]
    ds_read_b128 a[164:167], v2 offset:9216
    v_add_f32 v50, v232, v233
    v_mfma_f32_16x16x32_bf16 v[132:135], a[132:135], v[116:119], v[132:135]
    s_waitcnt lgkmcnt(6)
    v_exp_f32 v234, v170
    v_cvt_pk_bf16_f32 v216, v232, v233
    v_mfma_f32_16x16x32_bf16 v[128:131], a[136:139], v[104:107], v[128:131]
    s_add_u32 s36, s36, 64
    buffer_load_dwordx4 v1, s[16:19], s32 offen offset:0 sc1 lds
    ds_read_b128 a[168:171], v2 offset:10240
    v_mfma_f32_16x16x32_bf16 v[132:135], a[136:139], v[120:123], v[132:135]
    v_exp_f32 v235, v171
    v_add_f32 v50, v50, v234
    v_mfma_f32_16x16x32_bf16 v[128:131], a[140:143], v[108:111], v[128:131]
    ds_read_b128 a[172:175], v2 offset:11264
    v_add_f32 v50, v50, v235
    v_mfma_f32_16x16x32_bf16 v[132:135], a[140:143], v[124:127], v[132:135]
    s_waitcnt lgkmcnt(6)
    v_exp_f32 v236, v184
    v_cvt_pk_bf16_f32 v217, v234, v235
    v_mfma_f32_16x16x32_bf16 v[144:147], a[144:147], v[96:99], v[32:35]
    s_add_u32 s34, s34, 0x4000
    ds_read_b128 a[176:179], v2 offset:12288
    v_add_f32 v50, v50, v236
    v_mfma_f32_16x16x32_bf16 v[148:151], a[144:147], v[112:115], v[36:39]
    s_add_u32 s52, s52, 16384
    ds_read_b128 a[180:183], v2 offset:13312
    v_exp_f32 v237, v185
    v_mfma_f32_16x16x32_bf16 v[144:147], a[148:151], v[100:103], v[144:147]
    s_and_b32 s52, s52, 0xffff
    v_add_f32 v50, v50, v237
    v_cvt_pk_bf16_f32 v218, v236, v237
    v_mfma_f32_16x16x32_bf16 v[148:151], a[148:151], v[116:119], v[148:151]
    s_waitcnt lgkmcnt(6)
    ds_read_b128 a[184:187], v2 offset:14336
    v_exp_f32 v238, v186
    v_mfma_f32_16x16x32_bf16 v[144:147], a[152:155], v[104:107], v[144:147]
    buffer_load_dwordx4 v1, s[16:19], s32 offen offset:1024 sc1 lds
    ds_read_b128 a[188:191], v2 offset:15360
    v_mfma_f32_16x16x32_bf16 v[148:151], a[152:155], v[120:123], v[148:151]
    v_exp_f32 v239, v187
    v_add_f32 v50, v50, v238
    v_mfma_f32_16x16x32_bf16 v[144:147], a[156:159], v[108:111], v[144:147]
    s_and_b32 s34, s34, 0xffff
    v_add_f32 v50, v50, v239
    v_cvt_pk_bf16_f32 v219, v238, v239
    v_mfma_f32_16x16x32_bf16 v[148:151], a[156:159], v[124:127], v[148:151]
    s_waitcnt lgkmcnt(6)
    ds_read_b128 a[192:195], v3 offset:0
    v_exp_f32 v240, v172
    v_mfma_f32_16x16x32_bf16 v[136:139], a[160:163], v[96:99], v[24:27]
    v_exp_f32 v241, v173
    v_mfma_f32_16x16x32_bf16 v[140:143], a[160:163], v[112:115], v[28:31]
    v_add_f32 v51, v240, v241
    v_exp_f32 v242, v174
    v_mfma_f32_16x16x32_bf16 v[136:139], a[164:167], v[100:103], v[136:139]
    buffer_load_dwordx4 v1, s[16:19], s32 offen offset:2048 sc1 lds
    ds_read_b128 a[196:199], v3 offset:1024
    v_mfma_f32_16x16x32_bf16 v[140:143], a[164:167], v[116:119], v[140:143]
    s_waitcnt lgkmcnt(6)
    v_cvt_pk_bf16_f32 v220, v240, v241
    v_exp_f32 v243, v175
    v_mfma_f32_16x16x32_bf16 v[136:139], a[168:171], v[104:107], v[136:139]
    v_add_u32 v2, s52, v1
    v_add_f32 v51, v51, v242
    v_mfma_f32_16x16x32_bf16 v[140:143], a[168:171], v[120:123], v[140:143]
    ds_read_b128 a[200:203], v3 offset:2048
    v_add_f32 v51, v51, v243
    v_cvt_pk_bf16_f32 v221, v242, v243
    v_mfma_f32_16x16x32_bf16 v[136:139], a[172:175], v[108:111], v[136:139]
    v_exp_f32 v244, v188
    v_mfma_f32_16x16x32_bf16 v[140:143], a[172:175], v[124:127], v[140:143]
    s_waitcnt lgkmcnt(5)
    ds_read_b128 a[204:207], v3 offset:3072
    v_exp_f32 v245, v189
    v_mfma_f32_16x16x32_bf16 v[152:155], a[176:179], v[96:99], v[40:43]
    ds_read_b128 a[208:211], v3 offset:4096
    v_add_f32 v51, v51, v244
    v_mfma_f32_16x16x32_bf16 v[156:159], a[176:179], v[112:115], v[44:47]
    v_add_f32 v51, v51, v245
    v_exp_f32 v246, v190
    v_mfma_f32_16x16x32_bf16 v[152:155], a[180:183], v[100:103], v[152:155]
    buffer_load_dwordx4 v1, s[16:19], s32 offen offset:3072 sc1 lds
    ds_read_b128 a[212:215], v3 offset:5120
    v_mfma_f32_16x16x32_bf16 v[156:159], a[180:183], v[116:119], v[156:159]
    s_waitcnt lgkmcnt(6)
    v_cvt_pk_bf16_f32 v222, v244, v245
    s_add_u32 s32, s32, 0x80000
    v_add_f32 v51, v51, v246
    v_mfma_f32_16x16x32_bf16 v[152:155], a[184:187], v[104:107], v[152:155]
    v_exp_f32 v247, v191
    v_mfma_f32_16x16x32_bf16 v[156:159], a[184:187], v[120:123], v[156:159]
    ds_read_b128 a[216:219], v3 offset:6144
    v_max3_f32 v6, v48, v49, v50
    v_add_f32 v51, v51, v247
    v_mfma_f32_16x16x32_bf16 v[152:155], a[188:191], v[108:111], v[152:155]
    ds_read_b128 a[220:223], v3 offset:7168
    v_cvt_pk_bf16_f32 v223, v246, v247
    v_mfma_f32_16x16x32_bf16 v[156:159], a[188:191], v[124:127], v[156:159]
    v_max_f32 v6, v6, v51
    v_cmp_nge_f32 vcc, s37, v6
    s_cbranch_vccnz k2_rare_68
k2_ret_69:
    s_waitcnt lgkmcnt(6)
    v_mfma_f32_16x16x32_bf16 a[8:11], a[192:195], v[208:211], a[8:11]
    ds_read_b128 a[224:227], v3 offset:8192
    v_add_f32 v14, v14, v48
    v_add_f32 v15, v15, v49
    v_mfma_f32_16x16x32_bf16 a[12:15], a[192:195], v[212:215], a[12:15]
    s_mov_b32 m0, s35
    v_exp_f32 v232, v128
    v_mfma_f32_16x16x32_bf16 a[24:27], a[196:199], v[208:211], a[24:27]
    s_add_u32 s53, s53, 16384
    ds_read_b128 a[228:231], v3 offset:9216
    v_add_f32 v14, v14, v50
    v_add_f32 v15, v15, v51
    v_mfma_f32_16x16x32_bf16 a[28:31], a[196:199], v[212:215], a[28:31]
    s_waitcnt lgkmcnt(6)
    v_exp_f32 v233, v129
    v_mfma_f32_16x16x32_bf16 a[40:43], a[200:203], v[208:211], a[40:43]
    s_and_b32 s53, s53, 0xffff
    buffer_load_dwordx4 v1, s[20:23], s33 offen offset:0 sc1 lds
    ds_read_b128 a[232:235], v3 offset:10240
    ds_read_b128 a[236:239], v3 offset:11264
    v_mfma_f32_16x16x32_bf16 a[44:47], a[200:203], v[212:215], a[44:47]
    v_add_f32 v48, v232, v233
    v_cvt_pk_bf16_f32 v192, v232, v233
    v_mfma_f32_16x16x32_bf16 a[56:59], a[204:207], v[208:211], a[56:59]
    ds_read_b128 a[240:243], v3 offset:12288
    v_exp_f32 v234, v130
    v_mfma_f32_16x16x32_bf16 a[60:63], a[204:207], v[212:215], a[60:63]
    s_waitcnt lgkmcnt(7)
    v_exp_f32 v235, v131
    v_mfma_f32_16x16x32_bf16 a[72:75], a[208:211], v[208:211], a[72:75]
    s_add_u32 s35, s35, 0x4000
    v_add_f32 v48, v48, v234
    v_add_f32 v48, v48, v235
    v_cvt_pk_bf16_f32 v193, v234, v235
    v_mfma_f32_16x16x32_bf16 a[76:79], a[208:211], v[212:215], a[76:79]
    v_exp_f32 v236, v144
    v_mfma_f32_16x16x32_bf16 a[88:91], a[212:215], v[208:211], a[88:91]
    ds_read_b128 a[244:247], v3 offset:13312
    v_exp_f32 v237, v145
    v_mfma_f32_16x16x32_bf16 a[92:95], a[212:215], v[212:215], a[92:95]
    s_waitcnt lgkmcnt(6)
    buffer_load_dwordx4 v1, s[20:23], s33 offen offset:1024 sc1 lds
    ds_read_b128 a[248:251], v3 offset:14336
    v_mfma_f32_16x16x32_bf16 a[104:107], a[216:219], v[208:211], a[104:107]
    v_add_f32 v48, v48, v236
    v_add_f32 v48, v48, v237
    v_cvt_pk_bf16_f32 v194, v236, v237
    v_mfma_f32_16x16x32_bf16 a[108:111], a[216:219], v[212:215], a[108:111]
    v_exp_f32 v238, v146
    v_mfma_f32_16x16x32_bf16 a[120:123], a[220:223], v[208:211], a[120:123]
    s_and_b32 s35, s35, 0xffff
    ds_read_b128 a[252:255], v3 offset:15360
    v_exp_f32 v239, v147
    v_mfma_f32_16x16x32_bf16 a[124:127], a[220:223], v[212:215], a[124:127]
    s_waitcnt lgkmcnt(6)
    v_add_f32 v48, v48, v238
    v_add_f32 v48, v48, v239
    v_mfma_f32_16x16x32_bf16 a[8:11], a[224:227], v[216:219], a[8:11]
    ds_read_b128 a[128:131], v2 offset:0
    v_exp_f32 v240, v132
    v_mfma_f32_16x16x32_bf16 a[12:15], a[224:227], v[220:223], a[12:15]
    ds_read_b128 a[132:135], v2 offset:1024
    v_cvt_pk_bf16_f32 v195, v238, v239
    v_mfma_f32_16x16x32_bf16 a[24:27], a[228:231], v[216:219], a[24:27]
    s_or_b32 s35, s35, 0x10000
    buffer_load_dwordx4 v1, s[20:23], s33 offen offset:2048 sc1 lds
    ds_read_b128 a[136:139], v2 offset:2048
    v_mfma_f32_16x16x32_bf16 a[28:31], a[228:231], v[220:223], a[28:31]
    s_waitcnt lgkmcnt(7)
    v_exp_f32 v241, v133
    v_add_u32 v3, s53, v56
    v_mfma_f32_16x16x32_bf16 a[40:43], a[232:235], v[216:219], a[40:43]
    v_add_f32 v49, v240, v241
    v_exp_f32 v242, v134
    v_mfma_f32_16x16x32_bf16 a[44:47], a[232:235], v[220:223], a[44:47]
    v_cvt_pk_bf16_f32 v196, v240, v241
    v_add_f32 v49, v49, v242
    v_mfma_f32_16x16x32_bf16 a[56:59], a[236:239], v[216:219], a[56:59]
    ds_read_b128 a[140:143], v2 offset:3072
    v_exp_f32 v243, v135
    v_mfma_f32_16x16x32_bf16 a[60:63], a[236:239], v[220:223], a[60:63]
    s_waitcnt lgkmcnt(6)
    ds_read_b128 a[144:147], v2 offset:4096
    v_add_f32 v49, v49, v243
    v_mfma_f32_16x16x32_bf16 a[72:75], a[240:243], v[216:219], a[72:75]
    v_exp_f32 v244, v148
    v_cvt_pk_bf16_f32 v197, v242, v243
    v_mfma_f32_16x16x32_bf16 a[76:79], a[240:243], v[220:223], a[76:79]
    buffer_load_dwordx4 v1, s[20:23], s33 offen offset:3072 sc1 lds
    ds_read_b128 a[148:151], v2 offset:5120
    v_mfma_f32_16x16x32_bf16 a[88:91], a[244:247], v[216:219], a[88:91]
    s_add_u32 s33, s33, 0x80000
    v_exp_f32 v245, v149
    v_add_f32 v49, v49, v244
    v_mfma_f32_16x16x32_bf16 a[92:95], a[244:247], v[220:223], a[92:95]
    s_waitcnt lgkmcnt(6)
    s_cmp_ge_u32 s36, s43
    s_cbranch_scc1 k2_prep_70
k2_prepret_71:
    v_mfma_f32_16x16x32_bf16 a[104:107], a[248:251], v[216:219], a[104:107]
    v_add_f32 v49, v49, v245
    v_exp_f32 v246, v150
    v_mfma_f32_16x16x32_bf16 a[108:111], a[248:251], v[220:223], a[108:111]
    ds_read_b128 a[152:155], v2 offset:6144
    v_cvt_pk_bf16_f32 v198, v244, v245
    v_mfma_f32_16x16x32_bf16 a[120:123], a[252:255], v[216:219], a[120:123]
    v_exp_f32 v247, v151
    v_add_f32 v49, v49, v246
    v_mfma_f32_16x16x32_bf16 a[124:127], a[252:255], v[220:223], a[124:127]
    s_waitcnt lgkmcnt(5)
    ds_read_b128 a[156:159], v2 offset:7168
    v_add_f32 v49, v49, v247
    v_mfma_f32_16x16x32_bf16 v[160:163], a[128:131], v[96:99], v[16:19]
    s_waitcnt vmcnt(12)
    s_barrier
    v_exp_f32 v232, v136
    v_cvt_pk_bf16_f32 v199, v246, v247
    v_mfma_f32_16x16x32_bf16 v[164:167], a[128:131], v[112:115], v[20:23]
    s_mov_b32 m0, s34
    ds_read_b128 a[160:163], v2 offset:8192
    v_exp_f32 v233, v137
    v_mfma_f32_16x16x32_bf16 v[160:163], a[132:135], v[100:103], v[160:163]
    ds_read_b128 a[164:167], v2 offset:9216
    v_add_f32 v50, v232, v233
    v_mfma_f32_16x16x32_bf16 v[164:167], a[132:135], v[116:119], v[164:167]
    s_waitcnt lgkmcnt(6)
    v_exp_f32 v234, v138
    v_cvt_pk_bf16_f32 v200, v232, v233
    v_mfma_f32_16x16x32_bf16 v[160:163], a[136:139], v[104:107], v[160:163]
    s_add_u32 s36, s36, 64
    buffer_load_dwordx4 v1, s[16:19], s32 offen offset:0 sc1 lds
    ds_read_b128 a[168:171], v2 offset:10240
    v_mfma_f32_16x16x32_bf16 v[164:167], a[136:139], v[120:123], v[164:167]
    v_exp_f32 v235, v139
    v_add_f32 v50, v50, v234
    v_mfma_f32_16x16x32_bf16 v[160:163], a[140:143], v[108:111], v[160:163]
    ds_read_b128 a[172:175], v2 offset:11264
    v_add_f32 v50, v50, v235
    v_mfma_f32_16x16x32_bf16 v[164:167], a[140:143], v[124:127], v[164:167]
    s_waitcnt lgkmcnt(6)
    v_exp_f32 v236, v152
    v_cvt_pk_bf16_f32 v201, v234, v235
    v_mfma_f32_16x16x32_bf16 v[176:179], a[144:147], v[96:99], v[32:35]
    s_add_u32 s34, s34, 0x4000
    ds_read_b128 a[176:179], v2 offset:12288
    v_add_f32 v50, v50, v236
    v_mfma_f32_16x16x32_bf16 v[180:183], a[144:147], v[112:115], v[36:39]
    s_add_u32 s52, s52, 16384
    ds_read_b128 a[180:183], v2 offset:13312
    v_exp_f32 v237, v153
    v_mfma_f32_16x16x32_bf16 v[176:179], a[148:151], v[100:103], v[176:179]
    s_and_b32 s52, s52, 0xffff
    v_add_f32 v50, v50, v237
    v_cvt_pk_bf16_f32 v202, v236, v237
    v_mfma_f32_16x16x32_bf16 v[180:183], a[148:151], v[116:119], v[180:183]
    s_waitcnt lgkmcnt(6)
    ds_read_b128 a[184:187], v2 offset:14336
    v_exp_f32 v238, v154
    v_mfma_f32_16x16x32_bf16 v[176:179], a[152:155], v[104:107], v[176:179]
    buffer_load_dwordx4 v1, s[16:19], s32 offen offset:1024 sc1 lds
    ds_read_b128 a[188:191], v2 offset:15360
    v_mfma_f32_16x16x32_bf16 v[180:183], a[152:155], v[120:123], v[180:183]
    v_exp_f32 v239, v155
    v_add_f32 v50, v50, v238
    v_mfma_f32_16x16x32_bf16 v[176:179], a[156:159], v[108:111], v[176:179]
    s_and_b32 s34, s34, 0xffff
    v_add_f32 v50, v50, v239
    v_cvt_pk_bf16_f32 v203, v238, v239
    v_mfma_f32_16x16x32_bf16 v[180:183], a[156:159], v[124:127], v[180:183]
    s_waitcnt lgkmcnt(6)
    ds_read_b128 a[192:195], v3 offset:0
    v_exp_f32 v240, v140
    v_mfma_f32_16x16x32_bf16 v[168:171], a[160:163], v[96:99], v[24:27]
    v_exp_f32 v241, v141
    v_mfma_f32_16x16x32_bf16 v[172:175], a[160:163], v[112:115], v[28:31]
    v_add_f32 v51, v240, v241
    v_exp_f32 v242, v142
    v_mfma_f32_16x16x32_bf16 v[168:171], a[164:167], v[100:103], v[168:171]
    buffer_load_dwordx4 v1, s[16:19], s32 offen offset:2048 sc1 lds
    ds_read_b128 a[196:199], v3 offset:1024
    v_mfma_f32_16x16x32_bf16 v[172:175], a[164:167], v[116:119], v[172:175]
    s_waitcnt lgkmcnt(6)
    v_cvt_pk_bf16_f32 v204, v240, v241
    v_exp_f32 v243, v143
    v_mfma_f32_16x16x32_bf16 v[168:171], a[168:171], v[104:107], v[168:171]
    v_add_u32 v2, s52, v1
    v_add_f32 v51, v51, v242
    v_mfma_f32_16x16x32_bf16 v[172:175], a[168:171], v[120:123], v[172:175]
    ds_read_b128 a[200:203], v3 offset:2048
    v_add_f32 v51, v51, v243
    v_cvt_pk_bf16_f32 v205, v242, v243
    v_mfma_f32_16x16x32_bf16 v[168:171], a[172:175], v[108:111], v[168:171]
    v_exp_f32 v244, v156
    v_mfma_f32_16x16x32_bf16 v[172:175], a[172:175], v[124:127], v[172:175]
    s_waitcnt lgkmcnt(5)
    ds_read_b128 a[204:207], v3 offset:3072
    v_exp_f32 v245, v157
    v_mfma_f32_16x16x32_bf16 v[184:187], a[176:179], v[96:99], v[40:43]
    s_sub_u32 s63, s63, 1
    ds_read_b128 a[208:211], v3 offset:4096
    v_add_f32 v51, v51, v244
    v_mfma_f32_16x16x32_bf16 v[188:191], a[176:179], v[112:115], v[44:47]
    v_add_f32 v51, v51, v245
    v_exp_f32 v246, v158
    v_mfma_f32_16x16x32_bf16 v[184:187], a[180:183], v[100:103], v[184:187]
    buffer_load_dwordx4 v1, s[16:19], s32 offen offset:3072 sc1 lds
    ds_read_b128 a[212:215], v3 offset:5120
    v_mfma_f32_16x16x32_bf16 v[188:191], a[180:183], v[116:119], v[188:191]
    s_waitcnt lgkmcnt(6)
    v_cvt_pk_bf16_f32 v206, v244, v245
    s_add_u32 s32, s32, 0x80000
    v_add_f32 v51, v51, v246
    v_mfma_f32_16x16x32_bf16 v[184:187], a[184:187], v[104:107], v[184:187]
    v_exp_f32 v247, v159
    v_mfma_f32_16x16x32_bf16 v[188:191], a[184:187], v[120:123], v[188:191]
    ds_read_b128 a[216:219], v3 offset:6144
    v_max3_f32 v6, v48, v49, v50
    v_add_f32 v51, v51, v247
    v_mfma_f32_16x16x32_bf16 v[184:187], a[188:191], v[108:111], v[184:187]
    ds_read_b128 a[220:223], v3 offset:7168
    v_cvt_pk_bf16_f32 v207, v246, v247
    v_mfma_f32_16x16x32_bf16 v[188:191], a[188:191], v[124:127], v[188:191]
    v_max_f32 v6, v6, v51
    v_cmp_nge_f32 vcc, s37, v6
    s_cbranch_vccnz k2_rare_72
k2_ret_73:
    s_cmp_lg_u32 s63, 0
    s_cbranch_scc1 k2_sloop_64
k2_sdone_65:
    s_waitcnt lgkmcnt(6)
    v_mfma_f32_16x16x32_bf16 a[8:11], a[192:195], v[192:195], a[8:11]
    s_waitcnt vmcnt(0)
    s_barrier
    ds_read_b128 a[224:227], v3 offset:8192
    v_add_f32 v14, v14, v48
    v_add_f32 v15, v15, v49
    v_mfma_f32_16x16x32_bf16 a[12:15], a[192:195], v[196:199], a[12:15]
    v_exp_f32 v232, v160
    v_add_f32 v14, v14, v50
    v_mfma_f32_16x16x32_bf16 a[24:27], a[196:199], v[192:195], a[24:27]
    s_add_u32 s53, s53, 16384
    ds_read_b128 a[228:231], v3 offset:9216
    v_exp_f32 v233, v161
    v_mfma_f32_16x16x32_bf16 a[28:31], a[196:199], v[196:199], a[28:31]
    s_waitcnt lgkmcnt(6)
    v_add_f32 v48, v232, v233
    v_exp_f32 v234, v162
    v_mfma_f32_16x16x32_bf16 a[40:43], a[200:203], v[192:195], a[40:43]
    s_and_b32 s53, s53, 0xffff
    v_cvt_pk_bf16_f32 v208, v232, v233
    v_add_f32 v15, v15, v51
    v_add_f32 v48, v48, v234
    v_mfma_f32_16x16x32_bf16 a[44:47], a[200:203], v[196:199], a[44:47]
    ds_read_b128 a[232:235], v3 offset:10240
    v_exp_f32 v235, v163
    v_mfma_f32_16x16x32_bf16 a[56:59], a[204:207], v[192:195], a[56:59]
    v_add_f32 v48, v48, v235
    v_exp_f32 v236, v176
    v_mfma_f32_16x16x32_bf16 a[60:63], a[204:207], v[196:199], a[60:63]
    s_waitcnt lgkmcnt(5)
    v_cvt_pk_bf16_f32 v209, v234, v235
    v_exp_f32 v237, v177
    v_mfma_f32_16x16x32_bf16 a[72:75], a[208:211], v[192:195], a[72:75]
    ds_read_b128 a[236:239], v3 offset:11264
    v_add_f32 v48, v48, v236
    v_add_f32 v48, v48, v237
    v_mfma_f32_16x16x32_bf16 a[76:79], a[208:211], v[196:199], a[76:79]
    v_exp_f32 v238, v178
    v_cvt_pk_bf16_f32 v210, v236, v237
    v_mfma_f32_16x16x32_bf16 a[88:91], a[212:215], v[192:195], a[88:91]
    v_exp_f32 v239, v179
    v_add_f32 v48, v48, v238
    v_mfma_f32_16x16x32_bf16 a[92:95], a[212:215], v[196:199], a[92:95]
    s_waitcnt lgkmcnt(4)
    v_add_f32 v48, v48, v239
    v_exp_f32 v240, v164
    v_mfma_f32_16x16x32_bf16 a[104:107], a[216:219], v[192:195], a[104:107]
    ds_read_b128 a[240:243], v3 offset:12288
    v_cvt_pk_bf16_f32 v211, v238, v239
    v_exp_f32 v241, v165
    v_mfma_f32_16x16x32_bf16 a[108:111], a[216:219], v[196:199], a[108:111]
    v_add_f32 v49, v240, v241
    v_exp_f32 v242, v166
    v_mfma_f32_16x16x32_bf16 a[120:123], a[220:223], v[192:195], a[120:123]
    ds_read_b128 a[244:247], v3 offset:13312
    v_cvt_pk_bf16_f32 v212, v240, v241
    v_exp_f32 v243, v167
    v_mfma_f32_16x16x32_bf16 a[124:127], a[220:223], v[196:199], a[124:127]
    s_waitcnt lgkmcnt(4)
    v_add_f32 v49, v49, v242
    v_add_f32 v49, v49, v243
    v_exp_f32 v244, v180
    v_mfma_f32_16x16x32_bf16 a[8:11], a[224:227], v[200:203], a[8:11]
    ds_read_b128 a[248:251], v3 offset:14336
    v_cvt_pk_bf16_f32 v213, v242, v243
    v_exp_f32 v245, v181
    v_mfma_f32_16x16x32_bf16 a[12:15], a[224:227], v[204:207], a[12:15]
    v_add_f32 v49, v49, v244
    v_add_f32 v49, v49, v245
    v_exp_f32 v246, v182
    v_mfma_f32_16x16x32_bf16 a[24:27], a[228:231], v[200:203], a[24:27]
    ds_read_b128 a[252:255], v3 offset:15360
    v_cvt_pk_bf16_f32 v214, v244, v245
    v_exp_f32 v247, v183
    v_mfma_f32_16x16x32_bf16 a[28:31], a[228:231], v[204:207], a[28:31]
    s_waitcnt lgkmcnt(4)
    v_add_f32 v49, v49, v246
    v_add_f32 v49, v49, v247
    v_exp_f32 v232, v168
    v_mfma_f32_16x16x32_bf16 a[40:43], a[232:235], v[200:203], a[40:43]
    v_cvt_pk_bf16_f32 v215, v246, v247
    v_exp_f32 v233, v169
    v_mfma_f32_16x16x32_bf16 a[44:47], a[232:235], v[204:207], a[44:47]
    v_add_f32 v50, v232, v233
    v_exp_f32 v234, v170
    v_mfma_f32_16x16x32_bf16 a[56:59], a[236:239], v[200:203], a[56:59]
    v_cvt_pk_bf16_f32 v216, v232, v233
    v_exp_f32 v235, v171
    v_mfma_f32_16x16x32_bf16 a[60:63], a[236:239], v[204:207], a[60:63]
    s_waitcnt lgkmcnt(2)
    v_add_f32 v50, v50, v234
    v_add_f32 v50, v50, v235
    v_exp_f32 v236, v184
    v_mfma_f32_16x16x32_bf16 a[72:75], a[240:243], v[200:203], a[72:75]
    v_cvt_pk_bf16_f32 v217, v234, v235
    v_exp_f32 v237, v185
    v_mfma_f32_16x16x32_bf16 a[76:79], a[240:243], v[204:207], a[76:79]
    v_add_f32 v50, v50, v236
    v_add_u32 v3, s53, v56
    ds_read_b128 a[192:195], v3 offset:0
    v_mfma_f32_16x16x32_bf16 a[88:91], a[244:247], v[200:203], a[88:91]
    ds_read_b128 a[196:199], v3 offset:1024
    ds_read_b128 a[200:203], v3 offset:2048
    v_add_f32 v50, v50, v237
    v_mfma_f32_16x16x32_bf16 a[92:95], a[244:247], v[204:207], a[92:95]
    s_waitcnt lgkmcnt(3)
    v_exp_f32 v238, v186
    v_cvt_pk_bf16_f32 v218, v236, v237
    v_mfma_f32_16x16x32_bf16 a[104:107], a[248:251], v[200:203], a[104:107]
    v_exp_f32 v239, v187
    v_add_f32 v50, v50, v238
    v_mfma_f32_16x16x32_bf16 a[108:111], a[248:251], v[204:207], a[108:111]
    ds_read_b128 a[204:207], v3 offset:3072
    v_add_f32 v50, v50, v239
    v_exp_f32 v240, v172
    v_mfma_f32_16x16x32_bf16 a[120:123], a[252:255], v[200:203], a[120:123]
    ds_read_b128 a[208:211], v3 offset:4096
    v_cvt_pk_bf16_f32 v219, v238, v239
    v_exp_f32 v241, v173
    v_mfma_f32_16x16x32_bf16 a[124:127], a[252:255], v[204:207], a[124:127]
    v_add_f32 v51, v240, v241
    v_exp_f32 v242, v174
    ds_read_b128 a[212:215], v3 offset:5120
    v_cvt_pk_bf16_f32 v220, v240, v241
    v_exp_f32 v243, v175
    v_add_f32 v51, v51, v242
    ds_read_b128 a[216:219], v3 offset:6144
    v_add_f32 v51, v51, v243
    v_exp_f32 v244, v188
    v_cvt_pk_bf16_f32 v221, v242, v243
    v_exp_f32 v245, v189
    v_add_f32 v51, v51, v244
    ds_read_b128 a[220:223], v3 offset:7168
    v_add_f32 v51, v51, v245
    v_exp_f32 v246, v190
    v_cvt_pk_bf16_f32 v222, v244, v245
    ds_read_b128 a[224:227], v3 offset:8192
    v_max3_f32 v6, v48, v49, v50
    v_exp_f32 v247, v191
    v_add_f32 v51, v51, v246
    v_add_f32 v51, v51, v247
    ds_read_b128 a[228:231], v3 offset:9216
    v_cvt_pk_bf16_f32 v223, v246, v247
    ds_read_b128 a[232:235], v3 offset:10240
    v_max_f32 v6, v6, v51
    ds_read_b128 a[236:239], v3 offset:11264
    v_cmp_nge_f32 vcc, s37, v6
    ds_read_b128 a[240:243], v3 offset:12288
    ds_read_b128 a[244:247], v3 offset:13312
    ds_read_b128 a[248:251], v3 offset:14336
    ds_read_b128 a[252:255], v3 offset:15360
    s_cbranch_vccnz k2_rare_74
k2_ret_75:
    s_waitcnt lgkmcnt(14)
    v_mfma_f32_16x16x32_bf16 a[8:11], a[192:195], v[208:211], a[8:11]
    v_add_f32 v14, v14, v48
    v_add_f32 v15, v15, v49
    v_mfma_f32_16x16x32_bf16 a[12:15], a[192:195], v[212:215], a[12:15]
    v_add_f32 v14, v14, v50
    v_add_f32 v15, v15, v51
    v_mfma_f32_16x16x32_bf16 a[24:27], a[196:199], v[208:211], a[24:27]
    v_mfma_f32_16x16x32_bf16 a[28:31], a[196:199], v[212:215], a[28:31]
    s_waitcnt lgkmcnt(12)
    v_mfma_f32_16x16x32_bf16 a[40:43], a[200:203], v[208:211], a[40:43]
    v_mfma_f32_16x16x32_bf16 a[44:47], a[200:203], v[212:215], a[44:47]
    v_mfma_f32_16x16x32_bf16 a[56:59], a[204:207], v[208:211], a[56:59]
    v_mfma_f32_16x16x32_bf16 a[60:63], a[204:207], v[212:215], a[60:63]
    s_waitcnt lgkmcnt(10)
    v_mfma_f32_16x16x32_bf16 a[72:75], a[208:211], v[208:211], a[72:75]
    v_mfma_f32_16x16x32_bf16 a[76:79], a[208:211], v[212:215], a[76:79]
    v_mfma_f32_16x16x32_bf16 a[88:91], a[212:215], v[208:211], a[88:91]
    v_mfma_f32_16x16x32_bf16 a[92:95], a[212:215], v[212:215], a[92:95]
    s_waitcnt lgkmcnt(8)
    v_mfma_f32_16x16x32_bf16 a[104:107], a[216:219], v[208:211], a[104:107]
    v_mfma_f32_16x16x32_bf16 a[108:111], a[216:219], v[212:215], a[108:111]
    v_mfma_f32_16x16x32_bf16 a[120:123], a[220:223], v[208:211], a[120:123]
    v_mfma_f32_16x16x32_bf16 a[124:127], a[220:223], v[212:215], a[124:127]
    s_waitcnt lgkmcnt(6)
    v_mfma_f32_16x16x32_bf16 a[8:11], a[224:227], v[216:219], a[8:11]
    v_mfma_f32_16x16x32_bf16 a[12:15], a[224:227], v[220:223], a[12:15]
    v_mfma_f32_16x16x32_bf16 a[24:27], a[228:231], v[216:219], a[24:27]
    v_mfma_f32_16x16x32_bf16 a[28:31], a[228:231], v[220:223], a[28:31]
    s_waitcnt lgkmcnt(4)
    v_mfma_f32_16x16x32_bf16 a[40:43], a[232:235], v[216:219], a[40:43]
    v_mfma_f32_16x16x32_bf16 a[44:47], a[232:235], v[220:223], a[44:47]
    v_mfma_f32_16x16x32_bf16 a[56:59], a[236:239], v[216:219], a[56:59]
    v_mfma_f32_16x16x32_bf16 a[60:63], a[236:239], v[220:223], a[60:63]
    s_waitcnt lgkmcnt(2)
    v_mfma_f32_16x16x32_bf16 a[72:75], a[240:243], v[216:219], a[72:75]
    v_mfma_f32_16x16x32_bf16 a[76:79], a[240:243], v[220:223], a[76:79]
    v_mfma_f32_16x16x32_bf16 a[88:91], a[244:247], v[216:219], a[88:91]
    v_mfma_f32_16x16x32_bf16 a[92:95], a[244:247], v[220:223], a[92:95]
    s_waitcnt lgkmcnt(0)
    v_mfma_f32_16x16x32_bf16 a[104:107], a[248:251], v[216:219], a[104:107]
    v_mfma_f32_16x16x32_bf16 a[108:111], a[248:251], v[220:223], a[108:111]
    v_mfma_f32_16x16x32_bf16 a[120:123], a[252:255], v[216:219], a[120:123]
    v_mfma_f32_16x16x32_bf16 a[124:127], a[252:255], v[220:223], a[124:127]
    v_mov_b32 v6, v12
    s_nop 1
    v_permlane16_swap_b32 v12, v6
    s_nop 1
    v_add_f32 v12, v12, v6
    v_mov_b32 v6, v12
    s_nop 1
    v_permlane32_swap_b32 v12, v6
    s_nop 1
    v_add_f32 v12, v12, v6
    v_rcp_f32 v12, v12
    v_mov_b32 v6, v13
    s_nop 1
    v_permlane16_swap_b32 v13, v6
    s_nop 1
    v_add_f32 v13, v13, v6
    v_mov_b32 v6, v13
    s_nop 1
    v_permlane32_swap_b32 v13, v6
    s_nop 1
    v_add_f32 v13, v13, v6
    v_rcp_f32 v13, v13
    v_mov_b32 v6, v14
    s_nop 1
    v_permlane16_swap_b32 v14, v6
    s_nop 1
    v_add_f32 v14, v14, v6
    v_mov_b32 v6, v14
    s_nop 1
    v_permlane32_swap_b32 v14, v6
    s_nop 1
    v_add_f32 v14, v14, v6
    v_rcp_f32 v14, v14
    v_mov_b32 v6, v15
    s_nop 1
    v_permlane16_swap_b32 v15, v6
    s_nop 1
    v_add_f32 v15, v15, v6
    v_mov_b32 v6, v15
    s_nop 1
    v_permlane32_swap_b32 v15, v6
    s_nop 1
    v_add_f32 v15, v15, v6
    v_rcp_f32 v15, v15
    s_lshl_b32 s31, s28, 19
    s_lshl_b32 s40, s38, 6
    s_add_u32 s40, s40, s31
    s_lshl_b32 s44, s39, 6
    s_add_u32 s44, s44, s31
    s_add_u32 s41, s40, 131072
    s_add_u32 s45, s44, 131072
    s_add_u32 s42, s40, 262144
    s_add_u32 s46, s44, 262144
    s_add_u32 s43, s40, 393216
    s_add_u32 s47, s44, 393216
    v_accvgpr_read_b32 v132, a0
    v_accvgpr_read_b32 v133, a1
    v_accvgpr_read_b32 v134, a2
    v_accvgpr_read_b32 v135, a3
    v_accvgpr_read_b32 v136, a16
    v_accvgpr_read_b32 v137, a17
    v_accvgpr_read_b32 v138, a18
    v_accvgpr_read_b32 v139, a19
    v_mul_f32 v132, v132, v12
    v_mul_f32 v133, v133, v12
    v_mul_f32 v134, v134, v12
    v_mul_f32 v135, v135, v12
    v_mul_f32 v136, v136, v12
    v_mul_f32 v137, v137, v12
    v_mul_f32 v138, v138, v12
    v_mul_f32 v139, v139, v12
    v_cvt_pk_bf16_f32 v128, v132, v133
    v_cvt_pk_bf16_f32 v129, v134, v135
    v_cvt_pk_bf16_f32 v130, v136, v137
    v_cvt_pk_bf16_f32 v131, v138, v139
    buffer_store_dwordx4 v[128:131], v1, s[24:27], s40 offen offset:0
    v_accvgpr_read_b32 v144, a32
    v_accvgpr_read_b32 v145, a33
    v_accvgpr_read_b32 v146, a34
    v_accvgpr_read_b32 v147, a35
    v_accvgpr_read_b32 v148, a48
    v_accvgpr_read_b32 v149, a49
    v_accvgpr_read_b32 v150, a50
    v_accvgpr_read_b32 v151, a51
    v_mul_f32 v144, v144, v12
    v_mul_f32 v145, v145, v12
    v_mul_f32 v146, v146, v12
    v_mul_f32 v147, v147, v12
    v_mul_f32 v148, v148, v12
    v_mul_f32 v149, v149, v12
    v_mul_f32 v150, v150, v12
    v_mul_f32 v151, v151, v12
    v_cvt_pk_bf16_f32 v140, v144, v145
    v_cvt_pk_bf16_f32 v141, v146, v147
    v_cvt_pk_bf16_f32 v142, v148, v149
    v_cvt_pk_bf16_f32 v143, v150, v151
    buffer_store_dwordx4 v[140:143], v1, s[24:27], s41 offen offset:0
    v_accvgpr_read_b32 v156, a64
    v_accvgpr_read_b32 v157, a65
    v_accvgpr_read_b32 v158, a66
    v_accvgpr_read_b32 v159, a67
    v_accvgpr_read_b32 v160, a80
    v_accvgpr_read_b32 v161, a81
    v_accvgpr_read_b32 v162, a82
    v_accvgpr_read_b32 v163, a83
    v_mul_f32 v156, v156, v12
    v_mul_f32 v157, v157, v12
    v_mul_f32 v158, v158, v12
    v_mul_f32 v159, v159, v12
    v_mul_f32 v160, v160, v12
    v_mul_f32 v161, v161, v12
    v_mul_f32 v162, v162, v12
    v_mul_f32 v163, v163, v12
    v_cvt_pk_bf16_f32 v152, v156, v157
    v_cvt_pk_bf16_f32 v153, v158, v159
    v_cvt_pk_bf16_f32 v154, v160, v161
    v_cvt_pk_bf16_f32 v155, v162, v163
    buffer_store_dwordx4 v[152:155], v1, s[24:27], s42 offen offset:0
    v_accvgpr_read_b32 v168, a96
    v_accvgpr_read_b32 v169, a97
    v_accvgpr_read_b32 v170, a98
    v_accvgpr_read_b32 v171, a99
    v_accvgpr_read_b32 v172, a112
    v_accvgpr_read_b32 v173, a113
    v_accvgpr_read_b32 v174, a114
    v_accvgpr_read_b32 v175, a115
    v_mul_f32 v168, v168, v12
    v_mul_f32 v169, v169, v12
    v_mul_f32 v170, v170, v12
    v_mul_f32 v171, v171, v12
    v_mul_f32 v172, v172, v12
    v_mul_f32 v173, v173, v12
    v_mul_f32 v174, v174, v12
    v_mul_f32 v175, v175, v12
    v_cvt_pk_bf16_f32 v164, v168, v169
    v_cvt_pk_bf16_f32 v165, v170, v171
    v_cvt_pk_bf16_f32 v166, v172, v173
    v_cvt_pk_bf16_f32 v167, v174, v175
    buffer_store_dwordx4 v[164:167], v1, s[24:27], s43 offen offset:0
    v_accvgpr_read_b32 v132, a4
    v_accvgpr_read_b32 v133, a5
    v_accvgpr_read_b32 v134, a6
    v_accvgpr_read_b32 v135, a7
    v_accvgpr_read_b32 v136, a20
    v_accvgpr_read_b32 v137, a21
    v_accvgpr_read_b32 v138, a22
    v_accvgpr_read_b32 v139, a23
    v_mul_f32 v132, v132, v13
    v_mul_f32 v133, v133, v13
    v_mul_f32 v134, v134, v13
    v_mul_f32 v135, v135, v13
    v_mul_f32 v136, v136, v13
    v_mul_f32 v137, v137, v13
    v_mul_f32 v138, v138, v13
    v_mul_f32 v139, v139, v13
    v_cvt_pk_bf16_f32 v128, v132, v133
    v_cvt_pk_bf16_f32 v129, v134, v135
    v_cvt_pk_bf16_f32 v130, v136, v137
    v_cvt_pk_bf16_f32 v131, v138, v139
    buffer_store_dwordx4 v[128:131], v1, s[24:27], s40 offen offset:1024
    v_accvgpr_read_b32 v144, a36
    v_accvgpr_read_b32 v145, a37
    v_accvgpr_read_b32 v146, a38
    v_accvgpr_read_b32 v147, a39
    v_accvgpr_read_b32 v148, a52
    v_accvgpr_read_b32 v149, a53
    v_accvgpr_read_b32 v150, a54
    v_accvgpr_read_b32 v151, a55
    v_mul_f32 v144, v144, v13
    v_mul_f32 v145, v145, v13
    v_mul_f32 v146, v146, v13
    v_mul_f32 v147, v147, v13
    v_mul_f32 v148, v148, v13
    v_mul_f32 v149, v149, v13
    v_mul_f32 v150, v150, v13
    v_mul_f32 v151, v151, v13
    v_cvt_pk_bf16_f32 v140, v144, v145
    v_cvt_pk_bf16_f32 v141, v146, v147
    v_cvt_pk_bf16_f32 v142, v148, v149
    v_cvt_pk_bf16_f32 v143, v150, v151
    buffer_store_dwordx4 v[140:143], v1, s[24:27], s41 offen offset:1024
    v_accvgpr_read_b32 v156, a68
    v_accvgpr_read_b32 v157, a69
    v_accvgpr_read_b32 v158, a70
    v_accvgpr_read_b32 v159, a71
    v_accvgpr_read_b32 v160, a84
    v_accvgpr_read_b32 v161, a85
    v_accvgpr_read_b32 v162, a86
    v_accvgpr_read_b32 v163, a87
    v_mul_f32 v156, v156, v13
    v_mul_f32 v157, v157, v13
    v_mul_f32 v158, v158, v13
    v_mul_f32 v159, v159, v13
    v_mul_f32 v160, v160, v13
    v_mul_f32 v161, v161, v13
    v_mul_f32 v162, v162, v13
    v_mul_f32 v163, v163, v13
    v_cvt_pk_bf16_f32 v152, v156, v157
    v_cvt_pk_bf16_f32 v153, v158, v159
    v_cvt_pk_bf16_f32 v154, v160, v161
    v_cvt_pk_bf16_f32 v155, v162, v163
    buffer_store_dwordx4 v[152:155], v1, s[24:27], s42 offen offset:1024
    v_accvgpr_read_b32 v168, a100
    v_accvgpr_read_b32 v169, a101
    v_accvgpr_read_b32 v170, a102
    v_accvgpr_read_b32 v171, a103
    v_accvgpr_read_b32 v172, a116
    v_accvgpr_read_b32 v173, a117
    v_accvgpr_read_b32 v174, a118
    v_accvgpr_read_b32 v175, a119
    v_mul_f32 v168, v168, v13
    v_mul_f32 v169, v169, v13
    v_mul_f32 v170, v170, v13
    v_mul_f32 v171, v171, v13
    v_mul_f32 v172, v172, v13
    v_mul_f32 v173, v173, v13
    v_mul_f32 v174, v174, v13
    v_mul_f32 v175, v175, v13
    v_cvt_pk_bf16_f32 v164, v168, v169
    v_cvt_pk_bf16_f32 v165, v170, v171
    v_cvt_pk_bf16_f32 v166, v172, v173
    v_cvt_pk_bf16_f32 v167, v174, v175
    buffer_store_dwordx4 v[164:167], v1, s[24:27], s43 offen offset:1024
    v_accvgpr_read_b32 v132, a8
    v_accvgpr_read_b32 v133, a9
    v_accvgpr_read_b32 v134, a10
    v_accvgpr_read_b32 v135, a11
    v_accvgpr_read_b32 v136, a24
    v_accvgpr_read_b32 v137, a25
    v_accvgpr_read_b32 v138, a26
    v_accvgpr_read_b32 v139, a27
    v_mul_f32 v132, v132, v14
    v_mul_f32 v133, v133, v14
    v_mul_f32 v134, v134, v14
    v_mul_f32 v135, v135, v14
    v_mul_f32 v136, v136, v14
    v_mul_f32 v137, v137, v14
    v_mul_f32 v138, v138, v14
    v_mul_f32 v139, v139, v14
    v_cvt_pk_bf16_f32 v128, v132, v133
    v_cvt_pk_bf16_f32 v129, v134, v135
    v_cvt_pk_bf16_f32 v130, v136, v137
    v_cvt_pk_bf16_f32 v131, v138, v139
    buffer_store_dwordx4 v[128:131], v1, s[24:27], s44 offen offset:0
    v_accvgpr_read_b32 v144, a40
    v_accvgpr_read_b32 v145, a41
    v_accvgpr_read_b32 v146, a42
    v_accvgpr_read_b32 v147, a43
    v_accvgpr_read_b32 v148, a56
    v_accvgpr_read_b32 v149, a57
    v_accvgpr_read_b32 v150, a58
    v_accvgpr_read_b32 v151, a59
    v_mul_f32 v144, v144, v14
    v_mul_f32 v145, v145, v14
    v_mul_f32 v146, v146, v14
    v_mul_f32 v147, v147, v14
    v_mul_f32 v148, v148, v14
    v_mul_f32 v149, v149, v14
    v_mul_f32 v150, v150, v14
    v_mul_f32 v151, v151, v14
    v_cvt_pk_bf16_f32 v140, v144, v145
    v_cvt_pk_bf16_f32 v141, v146, v147
    v_cvt_pk_bf16_f32 v142, v148, v149
    v_cvt_pk_bf16_f32 v143, v150, v151
    buffer_store_dwordx4 v[140:143], v1, s[24:27], s45 offen offset:0
    v_accvgpr_read_b32 v156, a72
    v_accvgpr_read_b32 v157, a73
    v_accvgpr_read_b32 v158, a74
    v_accvgpr_read_b32 v159, a75
    v_accvgpr_read_b32 v160, a88
    v_accvgpr_read_b32 v161, a89
    v_accvgpr_read_b32 v162, a90
    v_accvgpr_read_b32 v163, a91
    v_mul_f32 v156, v156, v14
    v_mul_f32 v157, v157, v14
    v_mul_f32 v158, v158, v14
    v_mul_f32 v159, v159, v14
    v_mul_f32 v160, v160, v14
    v_mul_f32 v161, v161, v14
    v_mul_f32 v162, v162, v14
    v_mul_f32 v163, v163, v14
    v_cvt_pk_bf16_f32 v152, v156, v157
    v_cvt_pk_bf16_f32 v153, v158, v159
    v_cvt_pk_bf16_f32 v154, v160, v161
    v_cvt_pk_bf16_f32 v155, v162, v163
    buffer_store_dwordx4 v[152:155], v1, s[24:27], s46 offen offset:0
    v_accvgpr_read_b32 v168, a104
    v_accvgpr_read_b32 v169, a105
    v_accvgpr_read_b32 v170, a106
    v_accvgpr_read_b32 v171, a107
    v_accvgpr_read_b32 v172, a120
    v_accvgpr_read_b32 v173, a121
    v_accvgpr_read_b32 v174, a122
    v_accvgpr_read_b32 v175, a123
    v_mul_f32 v168, v168, v14
    v_mul_f32 v169, v169, v14
    v_mul_f32 v170, v170, v14
    v_mul_f32 v171, v171, v14
    v_mul_f32 v172, v172, v14
    v_mul_f32 v173, v173, v14
    v_mul_f32 v174, v174, v14
    v_mul_f32 v175, v175, v14
    v_cvt_pk_bf16_f32 v164, v168, v169
    v_cvt_pk_bf16_f32 v165, v170, v171
    v_cvt_pk_bf16_f32 v166, v172, v173
    v_cvt_pk_bf16_f32 v167, v174, v175
    buffer_store_dwordx4 v[164:167], v1, s[24:27], s47 offen offset:0
    v_accvgpr_read_b32 v132, a12
    v_accvgpr_read_b32 v133, a13
    v_accvgpr_read_b32 v134, a14
    v_accvgpr_read_b32 v135, a15
    v_accvgpr_read_b32 v136, a28
    v_accvgpr_read_b32 v137, a29
    v_accvgpr_read_b32 v138, a30
    v_accvgpr_read_b32 v139, a31
    v_mul_f32 v132, v132, v15
    v_mul_f32 v133, v133, v15
    v_mul_f32 v134, v134, v15
    v_mul_f32 v135, v135, v15
    v_mul_f32 v136, v136, v15
    v_mul_f32 v137, v137, v15
    v_mul_f32 v138, v138, v15
    v_mul_f32 v139, v139, v15
    v_cvt_pk_bf16_f32 v128, v132, v133
    v_cvt_pk_bf16_f32 v129, v134, v135
    v_cvt_pk_bf16_f32 v130, v136, v137
    v_cvt_pk_bf16_f32 v131, v138, v139
    buffer_store_dwordx4 v[128:131], v1, s[24:27], s44 offen offset:1024
    v_accvgpr_read_b32 v144, a44
    v_accvgpr_read_b32 v145, a45
    v_accvgpr_read_b32 v146, a46
    v_accvgpr_read_b32 v147, a47
    v_accvgpr_read_b32 v148, a60
    v_accvgpr_read_b32 v149, a61
    v_accvgpr_read_b32 v150, a62
    v_accvgpr_read_b32 v151, a63
    v_mul_f32 v144, v144, v15
    v_mul_f32 v145, v145, v15
    v_mul_f32 v146, v146, v15
    v_mul_f32 v147, v147, v15
    v_mul_f32 v148, v148, v15
    v_mul_f32 v149, v149, v15
    v_mul_f32 v150, v150, v15
    v_mul_f32 v151, v151, v15
    v_cvt_pk_bf16_f32 v140, v144, v145
    v_cvt_pk_bf16_f32 v141, v146, v147
    v_cvt_pk_bf16_f32 v142, v148, v149
    v_cvt_pk_bf16_f32 v143, v150, v151
    buffer_store_dwordx4 v[140:143], v1, s[24:27], s45 offen offset:1024
    v_accvgpr_read_b32 v156, a76
    v_accvgpr_read_b32 v157, a77
    v_accvgpr_read_b32 v158, a78
    v_accvgpr_read_b32 v159, a79
    v_accvgpr_read_b32 v160, a92
    v_accvgpr_read_b32 v161, a93
    v_accvgpr_read_b32 v162, a94
    v_accvgpr_read_b32 v163, a95
    v_mul_f32 v156, v156, v15
    v_mul_f32 v157, v157, v15
    v_mul_f32 v158, v158, v15
    v_mul_f32 v159, v159, v15
    v_mul_f32 v160, v160, v15
    v_mul_f32 v161, v161, v15
    v_mul_f32 v162, v162, v15
    v_mul_f32 v163, v163, v15
    v_cvt_pk_bf16_f32 v152, v156, v157
    v_cvt_pk_bf16_f32 v153, v158, v159
    v_cvt_pk_bf16_f32 v154, v160, v161
    v_cvt_pk_bf16_f32 v155, v162, v163
    buffer_store_dwordx4 v[152:155], v1, s[24:27], s46 offen offset:1024
    v_accvgpr_read_b32 v168, a108
    v_accvgpr_read_b32 v169, a109
    v_accvgpr_read_b32 v170, a110
    v_accvgpr_read_b32 v171, a111
    v_accvgpr_read_b32 v172, a124
    v_accvgpr_read_b32 v173, a125
    v_accvgpr_read_b32 v174, a126
    v_accvgpr_read_b32 v175, a127
    v_mul_f32 v168, v168, v15
    v_mul_f32 v169, v169, v15
    v_mul_f32 v170, v170, v15
    v_mul_f32 v171, v171, v15
    v_mul_f32 v172, v172, v15
    v_mul_f32 v173, v173, v15
    v_mul_f32 v174, v174, v15
    v_mul_f32 v175, v175, v15
    v_cvt_pk_bf16_f32 v164, v168, v169
    v_cvt_pk_bf16_f32 v165, v170, v171
    v_cvt_pk_bf16_f32 v166, v172, v173
    v_cvt_pk_bf16_f32 v167, v174, v175
    buffer_store_dwordx4 v[164:167], v1, s[24:27], s47 offen offset:1024
k12_end_1:
    s_endpgm
k2_prep_41:
    s_sub_u32 s40, s36, s38
    v_subrev_u32 v6, s40, v4
    v_cmp_gt_i32 s[44:45], -16, v6
    v_cmp_gt_i32 s[46:47], -15, v6
    v_cmp_gt_i32 s[48:49], -14, v6
    v_cmp_gt_i32 s[50:51], -13, v6
    s_nop 1
    v_cndmask_b32 v20, v9, v5, s[44:45]
    v_cndmask_b32 v21, v9, v5, s[46:47]
    v_cndmask_b32 v22, v9, v5, s[48:49]
    v_cndmask_b32 v23, v9, v5, s[50:51]
    v_cmp_gt_i32 s[54:55], 0, v6
    v_cmp_gt_i32 s[56:57], 1, v6
    v_cmp_gt_i32 s[58:59], 2, v6
    v_cmp_gt_i32 s[60:61], 3, v6
    s_nop 1
    v_cndmask_b32 v16, v8, v5, s[54:55]
    v_cndmask_b32 v17, v8, v5, s[56:57]
    v_cndmask_b32 v18, v8, v5, s[58:59]
    v_cndmask_b32 v19, v8, v5, s[60:61]
    v_cndmask_b32 v36, v9, v5, s[54:55]
    v_cndmask_b32 v37, v9, v5, s[56:57]
    v_cndmask_b32 v38, v9, v5, s[58:59]
    v_cndmask_b32 v39, v9, v5, s[60:61]
    v_cmp_gt_i32 s[44:45], 16, v6
    v_cmp_gt_i32 s[46:47], 17, v6
    v_cmp_gt_i32 s[48:49], 18, v6
    v_cmp_gt_i32 s[50:51], 19, v6
    s_nop 1
    v_cndmask_b32 v32, v8, v5, s[44:45]
    v_cndmask_b32 v33, v8, v5, s[46:47]
    v_cndmask_b32 v34, v8, v5, s[48:49]
    v_cndmask_b32 v35, v8, v5, s[50:51]
    s_nop 1
    s_branch k2_prepret_42
k2_prep_43:
    s_sub_u32 s40, s36, s38
    v_subrev_u32 v6, s40, v4
    v_cmp_gt_i32 s[44:45], -16, v6
    v_cmp_gt_i32 s[46:47], -15, v6
    v_cmp_gt_i32 s[48:49], -14, v6
    v_cmp_gt_i32 s[50:51], -13, v6
    s_nop 1
    v_cndmask_b32 v20, v9, v5, s[44:45]
    v_cndmask_b32 v21, v9, v5, s[46:47]
    v_cndmask_b32 v22, v9, v5, s[48:49]
    v_cndmask_b32 v23, v9, v5, s[50:51]
    v_cmp_gt_i32 s[54:55], 0, v6
    v_cmp_gt_i32 s[56:57], 1, v6
    v_cmp_gt_i32 s[58:59], 2, v6
    v_cmp_gt_i32 s[60:61], 3, v6
    s_nop 1
    v_cndmask_b32 v16, v8, v5, s[54:55]
    v_cndmask_b32 v17, v8, v5, s[56:57]
    v_cndmask_b32 v18, v8, v5, s[58:59]
    v_cndmask_b32 v19, v8, v5, s[60:61]
    v_cndmask_b32 v36, v9, v5, s[54:55]
    v_cndmask_b32 v37, v9, v5, s[56:57]
    v_cndmask_b32 v38, v9, v5, s[58:59]
    v_cndmask_b32 v39, v9, v5, s[60:61]
    v_cmp_gt_i32 s[44:45], 16, v6
    v_cmp_gt_i32 s[46:47], 17, v6
    v_cmp_gt_i32 s[48:49], 18, v6
    v_cmp_gt_i32 s[50:51], 19, v6
    s_nop 1
    v_cndmask_b32 v32, v8, v5, s[44:45]
    v_cndmask_b32 v33, v8, v5, s[46:47]
    v_cndmask_b32 v34, v8, v5, s[48:49]
    v_cndmask_b32 v35, v8, v5, s[50:51]
    s_nop 1
    s_branch k2_prepret_44
k2_prep_48:
    s_sub_u32 s40, s36, s38
    v_subrev_u32 v6, s40, v4
    v_cmp_gt_i32 s[44:45], -16, v6
    v_cmp_gt_i32 s[46:47], -15, v6
    v_cmp_gt_i32 s[48:49], -14, v6
    v_cmp_gt_i32 s[50:51], -13, v6
    s_nop 1
    v_cndmask_b32 v20, v9, v5, s[44:45]
    v_cndmask_b32 v21, v9, v5, s[46:47]
    v_cndmask_b32 v22, v9, v5, s[48:49]
    v_cndmask_b32 v23, v9, v5, s[50:51]
    v_cmp_gt_i32 s[54:55], 0, v6
    v_cmp_gt_i32 s[56:57], 1, v6
    v_cmp_gt_i32 s[58:59], 2, v6
    v_cmp_gt_i32 s[60:61], 3, v6
    s_nop 1
    v_cndmask_b32 v16, v8, v5, s[54:55]
    v_cndmask_b32 v17, v8, v5, s[56:57]
    v_cndmask_b32 v18, v8, v5, s[58:59]
    v_cndmask_b32 v19, v8, v5, s[60:61]
    v_cndmask_b32 v36, v9, v5, s[54:55]
    v_cndmask_b32 v37, v9, v5, s[56:57]
    v_cndmask_b32 v38, v9, v5, s[58:59]
    v_cndmask_b32 v39, v9, v5, s[60:61]
    v_cmp_gt_i32 s[44:45], 16, v6
    v_cmp_gt_i32 s[46:47], 17, v6
    v_cmp_gt_i32 s[48:49], 18, v6
    v_cmp_gt_i32 s[50:51], 19, v6
    s_nop 1
    v_cndmask_b32 v32, v8, v5, s[44:45]
    v_cndmask_b32 v33, v8, v5, s[46:47]
    v_cndmask_b32 v34, v8, v5, s[48:49]
    v_cndmask_b32 v35, v8, v5, s[50:51]
    s_nop 1
    s_branch k2_prepret_49
k2_prep_52:
    s_sub_u32 s40, s36, s38
    v_subrev_u32 v6, s40, v4
    v_cmp_gt_i32 s[44:45], -16, v6
    v_cmp_gt_i32 s[46:47], -15, v6
    v_cmp_gt_i32 s[48:49], -14, v6
    v_cmp_gt_i32 s[50:51], -13, v6
    s_nop 1
    v_cndmask_b32 v20, v9, v5, s[44:45]
    v_cndmask_b32 v21, v9, v5, s[46:47]
    v_cndmask_b32 v22, v9, v5, s[48:49]
    v_cndmask_b32 v23, v9, v5, s[50:51]
    v_cmp_gt_i32 s[54:55], 0, v6
    v_cmp_gt_i32 s[56:57], 1, v6
    v_cmp_gt_i32 s[58:59], 2, v6
    v_cmp_gt_i32 s[60:61], 3, v6
    s_nop 1
    v_cndmask_b32 v16, v8, v5, s[54:55]
    v_cndmask_b32 v17, v8, v5, s[56:57]
    v_cndmask_b32 v18, v8, v5, s[58:59]
    v_cndmask_b32 v19, v8, v5, s[60:61]
    v_cndmask_b32 v36, v9, v5, s[54:55]
    v_cndmask_b32 v37, v9, v5, s[56:57]
    v_cndmask_b32 v38, v9, v5, s[58:59]
    v_cndmask_b32 v39, v9, v5, s[60:61]
    v_cmp_gt_i32 s[44:45], 16, v6
    v_cmp_gt_i32 s[46:47], 17, v6
    v_cmp_gt_i32 s[48:49], 18, v6
    v_cmp_gt_i32 s[50:51], 19, v6
    s_nop 1
    v_cndmask_b32 v32, v8, v5, s[44:45]
    v_cndmask_b32 v33, v8, v5, s[46:47]
    v_cndmask_b32 v34, v8, v5, s[48:49]
    v_cndmask_b32 v35, v8, v5, s[50:51]
    s_nop 1
    s_branch k2_prepret_53
k2_prep_56:
    s_sub_u32 s40, s36, s39
    v_subrev_u32 v6, s40, v4
    v_cmp_gt_i32 s[44:45], -16, v6
    v_cmp_gt_i32 s[46:47], -15, v6
    v_cmp_gt_i32 s[48:49], -14, v6
    v_cmp_gt_i32 s[50:51], -13, v6
    s_nop 1
    v_cndmask_b32 v20, v11, v5, s[44:45]
    v_cndmask_b32 v21, v11, v5, s[46:47]
    v_cndmask_b32 v22, v11, v5, s[48:49]
    v_cndmask_b32 v23, v11, v5, s[50:51]
    v_cmp_gt_i32 s[54:55], 0, v6
    v_cmp_gt_i32 s[56:57], 1, v6
    v_cmp_gt_i32 s[58:59], 2, v6
    v_cmp_gt_i32 s[60:61], 3, v6
    s_nop 1
    v_cndmask_b32 v16, v10, v5, s[54:55]
    v_cndmask_b32 v17, v10, v5, s[56:57]
    v_cndmask_b32 v18, v10, v5, s[58:59]
    v_cndmask_b32 v19, v10, v5, s[60:61]
    v_cndmask_b32 v36, v11, v5, s[54:55]
    v_cndmask_b32 v37, v11, v5, s[56:57]
    v_cndmask_b32 v38, v11, v5, s[58:59]
    v_cndmask_b32 v39, v11, v5, s[60:61]
    v_cmp_gt_i32 s[44:45], 16, v6
    v_cmp_gt_i32 s[46:47], 17, v6
    v_cmp_gt_i32 s[48:49], 18, v6
    v_cmp_gt_i32 s[50:51], 19, v6
    s_nop 1
    v_cndmask_b32 v32, v10, v5, s[44:45]
    v_cndmask_b32 v33, v10, v5, s[46:47]
    v_cndmask_b32 v34, v10, v5, s[48:49]
    v_cndmask_b32 v35, v10, v5, s[50:51]
    v_cndmask_b32 v28, v11, v5, s[44:45]
    v_cndmask_b32 v29, v11, v5, s[46:47]
    v_cndmask_b32 v30, v11, v5, s[48:49]
    v_cndmask_b32 v31, v11, v5, s[50:51]
    v_cmp_gt_i32 s[54:55], 32, v6
    v_cmp_gt_i32 s[56:57], 33, v6
    v_cmp_gt_i32 s[58:59], 34, v6
    v_cmp_gt_i32 s[60:61], 35, v6
    s_nop 1
    v_cndmask_b32 v24, v10, v5, s[54:55]
    v_cndmask_b32 v25, v10, v5, s[56:57]
    v_cndmask_b32 v26, v10, v5, s[58:59]
    v_cndmask_b32 v27, v10, v5, s[60:61]
    v_cndmask_b32 v44, v11, v5, s[54:55]
    v_cndmask_b32 v45, v11, v5, s[56:57]
    v_cndmask_b32 v46, v11, v5, s[58:59]
    v_cndmask_b32 v47, v11, v5, s[60:61]
    v_cmp_gt_i32 s[44:45], 48, v6
    v_cmp_gt_i32 s[46:47], 49, v6
    v_cmp_gt_i32 s[48:49], 50, v6
    v_cmp_gt_i32 s[50:51], 51, v6
    s_nop 1
    v_cndmask_b32 v40, v10, v5, s[44:45]
    v_cndmask_b32 v41, v10, v5, s[46:47]
    v_cndmask_b32 v42, v10, v5, s[48:49]
    v_cndmask_b32 v43, v10, v5, s[50:51]
    s_nop 1
    s_branch k2_prepret_57
k2_prep_60:
    s_sub_u32 s40, s36, s39
    v_subrev_u32 v6, s40, v4
    v_cmp_gt_i32 s[44:45], -16, v6
    v_cmp_gt_i32 s[46:47], -15, v6
    v_cmp_gt_i32 s[48:49], -14, v6
    v_cmp_gt_i32 s[50:51], -13, v6
    s_nop 1
    v_cndmask_b32 v20, v11, v5, s[44:45]
    v_cndmask_b32 v21, v11, v5, s[46:47]
    v_cndmask_b32 v22, v11, v5, s[48:49]
    v_cndmask_b32 v23, v11, v5, s[50:51]
    v_cmp_gt_i32 s[54:55], 0, v6
    v_cmp_gt_i32 s[56:57], 1, v6
    v_cmp_gt_i32 s[58:59], 2, v6
    v_cmp_gt_i32 s[60:61], 3, v6
    s_nop 1
    v_cndmask_b32 v16, v10, v5, s[54:55]
    v_cndmask_b32 v17, v10, v5, s[56:57]
    v_cndmask_b32 v18, v10, v5, s[58:59]
    v_cndmask_b32 v19, v10, v5, s[60:61]
    v_cndmask_b32 v36, v11, v5, s[54:55]
    v_cndmask_b32 v37, v11, v5, s[56:57]
    v_cndmask_b32 v38, v11, v5, s[58:59]
    v_cndmask_b32 v39, v11, v5, s[60:61]
    v_cmp_gt_i32 s[44:45], 16, v6
    v_cmp_gt_i32 s[46:47], 17, v6
    v_cmp_gt_i32 s[48:49], 18, v6
    v_cmp_gt_i32 s[50:51], 19, v6
    s_nop 1
    v_cndmask_b32 v32, v10, v5, s[44:45]
    v_cndmask_b32 v33, v10, v5, s[46:47]
    v_cndmask_b32 v34, v10, v5, s[48:49]
    v_cndmask_b32 v35, v10, v5, s[50:51]
    v_cndmask_b32 v28, v11, v5, s[44:45]
    v_cndmask_b32 v29, v11, v5, s[46:47]
    v_cndmask_b32 v30, v11, v5, s[48:49]
    v_cndmask_b32 v31, v11, v5, s[50:51]
    v_cmp_gt_i32 s[54:55], 32, v6
    v_cmp_gt_i32 s[56:57], 33, v6
    v_cmp_gt_i32 s[58:59], 34, v6
    v_cmp_gt_i32 s[60:61], 35, v6
    s_nop 1
    v_cndmask_b32 v24, v10, v5, s[54:55]
    v_cndmask_b32 v25, v10, v5, s[56:57]
    v_cndmask_b32 v26, v10, v5, s[58:59]
    v_cndmask_b32 v27, v10, v5, s[60:61]
    v_cndmask_b32 v44, v11, v5, s[54:55]
    v_cndmask_b32 v45, v11, v5, s[56:57]
    v_cndmask_b32 v46, v11, v5, s[58:59]
    v_cndmask_b32 v47, v11, v5, s[60:61]
    v_cmp_gt_i32 s[44:45], 48, v6
    v_cmp_gt_i32 s[46:47], 49, v6
    v_cmp_gt_i32 s[48:49], 50, v6
    v_cmp_gt_i32 s[50:51], 51, v6
    s_nop 1
    v_cndmask_b32 v40, v10, v5, s[44:45]
    v_cndmask_b32 v41, v10, v5, s[46:47]
    v_cndmask_b32 v42, v10, v5, s[48:49]
    v_cndmask_b32 v43, v10, v5, s[50:51]
    s_nop 1
    s_branch k2_prepret_61
k2_prep_66:
    s_sub_u32 s40, s36, s39
    v_subrev_u32 v6, s40, v4
    v_cmp_gt_i32 s[44:45], -16, v6
    v_cmp_gt_i32 s[46:47], -15, v6
    v_cmp_gt_i32 s[48:49], -14, v6
    v_cmp_gt_i32 s[50:51], -13, v6
    s_nop 1
    v_cndmask_b32 v20, v11, v5, s[44:45]
    v_cndmask_b32 v21, v11, v5, s[46:47]
    v_cndmask_b32 v22, v11, v5, s[48:49]
    v_cndmask_b32 v23, v11, v5, s[50:51]
    v_cmp_gt_i32 s[54:55], 0, v6
    v_cmp_gt_i32 s[56:57], 1, v6
    v_cmp_gt_i32 s[58:59], 2, v6
    v_cmp_gt_i32 s[60:61], 3, v6
    s_nop 1
    v_cndmask_b32 v16, v10, v5, s[54:55]
    v_cndmask_b32 v17, v10, v5, s[56:57]
    v_cndmask_b32 v18, v10, v5, s[58:59]
    v_cndmask_b32 v19, v10, v5, s[60:61]
    v_cndmask_b32 v36, v11, v5, s[54:55]
    v_cndmask_b32 v37, v11, v5, s[56:57]
    v_cndmask_b32 v38, v11, v5, s[58:59]
    v_cndmask_b32 v39, v11, v5, s[60:61]
    v_cmp_gt_i32 s[44:45], 16, v6
    v_cmp_gt_i32 s[46:47], 17, v6
    v_cmp_gt_i32 s[48:49], 18, v6
    v_cmp_gt_i32 s[50:51], 19, v6
    s_nop 1
    v_cndmask_b32 v32, v10, v5, s[44:45]
    v_cndmask_b32 v33, v10, v5, s[46:47]
    v_cndmask_b32 v34, v10, v5, s[48:49]
    v_cndmask_b32 v35, v10, v5, s[50:51]
    v_cndmask_b32 v28, v11, v5, s[44:45]
    v_cndmask_b32 v29, v11, v5, s[46:47]
    v_cndmask_b32 v30, v11, v5, s[48:49]
    v_cndmask_b32 v31, v11, v5, s[50:51]
    v_cmp_gt_i32 s[54:55], 32, v6
    v_cmp_gt_i32 s[56:57], 33, v6
    v_cmp_gt_i32 s[58:59], 34, v6
    v_cmp_gt_i32 s[60:61], 35, v6
    s_nop 1
    v_cndmask_b32 v24, v10, v5, s[54:55]
    v_cndmask_b32 v25, v10, v5, s[56:57]
    v_cndmask_b32 v26, v10, v5, s[58:59]
    v_cndmask_b32 v27, v10, v5, s[60:61]
    v_cndmask_b32 v44, v11, v5, s[54:55]
    v_cndmask_b32 v45, v11, v5, s[56:57]
    v_cndmask_b32 v46, v11, v5, s[58:59]
    v_cndmask_b32 v47, v11, v5, s[60:61]
    v_cmp_gt_i32 s[44:45], 48, v6
    v_cmp_gt_i32 s[46:47], 49, v6
    v_cmp_gt_i32 s[48:49], 50, v6
    v_cmp_gt_i32 s[50:51], 51, v6
    s_nop 1
    v_cndmask_b32 v40, v10, v5, s[44:45]
    v_cndmask_b32 v41, v10, v5, s[46:47]
    v_cndmask_b32 v42, v10, v5, s[48:49]
    v_cndmask_b32 v43, v10, v5, s[50:51]
    s_nop 1
    s_branch k2_prepret_67
k2_prep_70:
    s_sub_u32 s40, s36, s39
    v_subrev_u32 v6, s40, v4
    v_cmp_gt_i32 s[44:45], -16, v6
    v_cmp_gt_i32 s[46:47], -15, v6
    v_cmp_gt_i32 s[48:49], -14, v6
    v_cmp_gt_i32 s[50:51], -13, v6
    s_nop 1
    v_cndmask_b32 v20, v11, v5, s[44:45]
    v_cndmask_b32 v21, v11, v5, s[46:47]
    v_cndmask_b32 v22, v11, v5, s[48:49]
    v_cndmask_b32 v23, v11, v5, s[50:51]
    v_cmp_gt_i32 s[54:55], 0, v6
    v_cmp_gt_i32 s[56:57], 1, v6
    v_cmp_gt_i32 s[58:59], 2, v6
    v_cmp_gt_i32 s[60:61], 3, v6
    s_nop 1
    v_cndmask_b32 v16, v10, v5, s[54:55]
    v_cndmask_b32 v17, v10, v5, s[56:57]
    v_cndmask_b32 v18, v10, v5, s[58:59]
    v_cndmask_b32 v19, v10, v5, s[60:61]
    v_cndmask_b32 v36, v11, v5, s[54:55]
    v_cndmask_b32 v37, v11, v5, s[56:57]
    v_cndmask_b32 v38, v11, v5, s[58:59]
    v_cndmask_b32 v39, v11, v5, s[60:61]
    v_cmp_gt_i32 s[44:45], 16, v6
    v_cmp_gt_i32 s[46:47], 17, v6
    v_cmp_gt_i32 s[48:49], 18, v6
    v_cmp_gt_i32 s[50:51], 19, v6
    s_nop 1
    v_cndmask_b32 v32, v10, v5, s[44:45]
    v_cndmask_b32 v33, v10, v5, s[46:47]
    v_cndmask_b32 v34, v10, v5, s[48:49]
    v_cndmask_b32 v35, v10, v5, s[50:51]
    v_cndmask_b32 v28, v11, v5, s[44:45]
    v_cndmask_b32 v29, v11, v5, s[46:47]
    v_cndmask_b32 v30, v11, v5, s[48:49]
    v_cndmask_b32 v31, v11, v5, s[50:51]
    v_cmp_gt_i32 s[54:55], 32, v6
    v_cmp_gt_i32 s[56:57], 33, v6
    v_cmp_gt_i32 s[58:59], 34, v6
    v_cmp_gt_i32 s[60:61], 35, v6
    s_nop 1
    v_cndmask_b32 v24, v10, v5, s[54:55]
    v_cndmask_b32 v25, v10, v5, s[56:57]
    v_cndmask_b32 v26, v10, v5, s[58:59]
    v_cndmask_b32 v27, v10, v5, s[60:61]
    v_cndmask_b32 v44, v11, v5, s[54:55]
    v_cndmask_b32 v45, v11, v5, s[56:57]
    v_cndmask_b32 v46, v11, v5, s[58:59]
    v_cndmask_b32 v47, v11, v5, s[60:61]
    v_cmp_gt_i32 s[44:45], 48, v6
    v_cmp_gt_i32 s[46:47], 49, v6
    v_cmp_gt_i32 s[48:49], 50, v6
    v_cmp_gt_i32 s[50:51], 51, v6
    s_nop 1
    v_cndmask_b32 v40, v10, v5, s[44:45]
    v_cndmask_b32 v41, v10, v5, s[46:47]
    v_cndmask_b32 v42, v10, v5, s[48:49]
    v_cndmask_b32 v43, v10, v5, s[50:51]
    s_nop 1
    s_branch k2_prepret_71
k2_rare_45:
    s_nop 7
    v_max_f32 v52, v128, v129
    v_max3_f32 v52, v52, v130, v131
    v_max3_f32 v52, v52, v144, v145
    v_max3_f32 v52, v52, v146, v147
    v_mov_b32 v6, v52
    s_nop 1
    v_permlane16_swap_b32 v52, v6
    s_nop 1
    v_max_f32 v52, v52, v6
    v_mov_b32 v6, v52
    s_nop 1
    v_permlane32_swap_b32 v52, v6
    s_nop 1
    v_max_f32 v52, v52, v6
    v_max_f32 v52, 0, v52
    v_max_f32 v53, v132, v133
    v_max3_f32 v53, v53, v134, v135
    v_max3_f32 v53, v53, v148, v149
    v_max3_f32 v53, v53, v150, v151
    v_mov_b32 v6, v53
    s_nop 1
    v_permlane16_swap_b32 v53, v6
    s_nop 1
    v_max_f32 v53, v53, v6
    v_mov_b32 v6, v53
    s_nop 1
    v_permlane32_swap_b32 v53, v6
    s_nop 1
    v_max_f32 v53, v53, v6
    v_max_f32 v53, 0, v53
    v_max_f32 v54, v136, v137
    v_max3_f32 v54, v54, v138, v139
    v_max3_f32 v54, v54, v152, v153
    v_max3_f32 v54, v54, v154, v155
    v_mov_b32 v6, v54
    s_nop 1
    v_permlane16_swap_b32 v54, v6
    s_nop 1
    v_max_f32 v54, v54, v6
    v_mov_b32 v6, v54
    s_nop 1
    v_permlane32_swap_b32 v54, v6
    s_nop 1
    v_max_f32 v54, v54, v6
    v_max_f32 v54, 0, v54
    v_max_f32 v55, v140, v141
    v_max3_f32 v55, v55, v142, v143
    v_max3_f32 v55, v55, v156, v157
    v_max3_f32 v55, v55, v158, v159
    v_mov_b32 v6, v55
    s_nop 1
    v_permlane16_swap_b32 v55, v6
    s_nop 1
    v_max_f32 v55, v55, v6
    v_mov_b32 v6, v55
    s_nop 1
    v_permlane32_swap_b32 v55, v6
    s_nop 1
    v_max_f32 v55, v55, v6
    v_max_f32 v55, 0, v55
    v_sub_f32 v128, v128, v52
    v_sub_f32 v129, v129, v52
    v_sub_f32 v130, v130, v52
    v_sub_f32 v131, v131, v52
    v_sub_f32 v132, v132, v53
    v_sub_f32 v133, v133, v53
    v_sub_f32 v134, v134, v53
    v_sub_f32 v135, v135, v53
    v_sub_f32 v136, v136, v54
    v_sub_f32 v137, v137, v54
    v_sub_f32 v138, v138, v54
    v_sub_f32 v139, v139, v54
    v_sub_f32 v140, v140, v55
    v_sub_f32 v141, v141, v55
    v_sub_f32 v142, v142, v55
    v_sub_f32 v143, v143, v55
    v_sub_f32 v144, v144, v52
    v_sub_f32 v145, v145, v52
    v_sub_f32 v146, v146, v52
    v_sub_f32 v147, v147, v52
    v_sub_f32 v148, v148, v53
    v_sub_f32 v149, v149, v53
    v_sub_f32 v150, v150, v53
    v_sub_f32 v151, v151, v53
    v_sub_f32 v152, v152, v54
    v_sub_f32 v153, v153, v54
    v_sub_f32 v154, v154, v54
    v_sub_f32 v155, v155, v54
    v_sub_f32 v156, v156, v55
    v_sub_f32 v157, v157, v55
    v_sub_f32 v158, v158, v55
    v_sub_f32 v159, v159, v55
    v_sub_f32 v160, v160, v52
    v_sub_f32 v16, v16, v52
    v_sub_f32 v161, v161, v52
    v_sub_f32 v17, v17, v52
    v_sub_f32 v162, v162, v52
    v_sub_f32 v18, v18, v52
    v_sub_f32 v163, v163, v52
    v_sub_f32 v19, v19, v52
    v_sub_f32 v164, v164, v53
    v_sub_f32 v20, v20, v53
    v_sub_f32 v165, v165, v53
    v_sub_f32 v21, v21, v53
    v_sub_f32 v166, v166, v53
    v_sub_f32 v22, v22, v53
    v_sub_f32 v167, v167, v53
    v_sub_f32 v23, v23, v53
    v_sub_f32 v168, v168, v54
    v_sub_f32 v24, v24, v54
    v_sub_f32 v169, v169, v54
    v_sub_f32 v25, v25, v54
    v_sub_f32 v170, v170, v54
    v_sub_f32 v26, v26, v54
    v_sub_f32 v171, v171, v54
    v_sub_f32 v27, v27, v54
    v_sub_f32 v172, v172, v55
    v_sub_f32 v28, v28, v55
    v_sub_f32 v173, v173, v55
    v_sub_f32 v29, v29, v55
    v_sub_f32 v174, v174, v55
    v_sub_f32 v30, v30, v55
    v_sub_f32 v175, v175, v55
    v_sub_f32 v31, v31, v55
    v_sub_f32 v176, v176, v52
    v_sub_f32 v32, v32, v52
    v_sub_f32 v177, v177, v52
    v_sub_f32 v33, v33, v52
    v_sub_f32 v178, v178, v52
    v_sub_f32 v34, v34, v52
    v_sub_f32 v179, v179, v52
    v_sub_f32 v35, v35, v52
    v_sub_f32 v180, v180, v53
    v_sub_f32 v36, v36, v53
    v_sub_f32 v181, v181, v53
    v_sub_f32 v37, v37, v53
    v_sub_f32 v182, v182, v53
    v_sub_f32 v38, v38, v53
    v_sub_f32 v183, v183, v53
    v_sub_f32 v39, v39, v53
    v_sub_f32 v184, v184, v54
    v_sub_f32 v40, v40, v54
    v_sub_f32 v185, v185, v54
    v_sub_f32 v41, v41, v54
    v_sub_f32 v186, v186, v54
    v_sub_f32 v42, v42, v54
    v_sub_f32 v187, v187, v54
    v_sub_f32 v43, v43, v54
    v_sub_f32 v188, v188, v55
    v_sub_f32 v44, v44, v55
    v_sub_f32 v189, v189, v55
    v_sub_f32 v45, v45, v55
    v_sub_f32 v190, v190, v55
    v_sub_f32 v46, v46, v55
    v_sub_f32 v191, v191, v55
    v_sub_f32 v47, v47, v55
    v_sub_f32 v8, v8, v52
    v_exp_f32 v52, -v52
    v_sub_f32 v9, v9, v53
    v_exp_f32 v53, -v53
    v_sub_f32 v10, v10, v54
    v_exp_f32 v54, -v54
    v_sub_f32 v11, v11, v55
    v_exp_f32 v55, -v55
    s_nop 0
    v_mul_f32 v12, v12, v52
    v_mul_f32 v13, v13, v53
    v_mul_f32 v14, v14, v54
    v_mul_f32 v15, v15, v55
    v_accvgpr_read_b32 v224, a0
    v_accvgpr_read_b32 v225, a1
    v_accvgpr_read_b32 v226, a2
    v_accvgpr_read_b32 v227, a3
    v_mul_f32 v224, v224, v52
    v_mul_f32 v225, v225, v52
    v_mul_f32 v226, v226, v52
    v_mul_f32 v227, v227, v52
    v_accvgpr_write_b32 a0, v224
    v_accvgpr_write_b32 a1, v225
    v_accvgpr_write_b32 a2, v226
    v_accvgpr_write_b32 a3, v227
    v_accvgpr_read_b32 v224, a4
    v_accvgpr_read_b32 v225, a5
    v_accvgpr_read_b32 v226, a6
    v_accvgpr_read_b32 v227, a7
    v_mul_f32 v224, v224, v53
    v_mul_f32 v225, v225, v53
    v_mul_f32 v226, v226, v53
    v_mul_f32 v227, v227, v53
    v_accvgpr_write_b32 a4, v224
    v_accvgpr_write_b32 a5, v225
    v_accvgpr_write_b32 a6, v226
    v_accvgpr_write_b32 a7, v227
    v_accvgpr_read_b32 v224, a8
    v_accvgpr_read_b32 v225, a9
    v_accvgpr_read_b32 v226, a10
    v_accvgpr_read_b32 v227, a11
    v_mul_f32 v224, v224, v54
    v_mul_f32 v225, v225, v54
    v_mul_f32 v226, v226, v54
    v_mul_f32 v227, v227, v54
    v_accvgpr_write_b32 a8, v224
    v_accvgpr_write_b32 a9, v225
    v_accvgpr_write_b32 a10, v226
    v_accvgpr_write_b32 a11, v227
    v_accvgpr_read_b32 v224, a12
    v_accvgpr_read_b32 v225, a13
    v_accvgpr_read_b32 v226, a14
    v_accvgpr_read_b32 v227, a15
    v_mul_f32 v224, v224, v55
    v_mul_f32 v225, v225, v55
    v_mul_f32 v226, v226, v55
    v_mul_f32 v227, v227, v55
    v_accvgpr_write_b32 a12, v224
    v_accvgpr_write_b32 a13, v225
    v_accvgpr_write_b32 a14, v226
    v_accvgpr_write_b32 a15, v227
    v_accvgpr_read_b32 v224, a16
    v_accvgpr_read_b32 v225, a17
    v_accvgpr_read_b32 v226, a18
    v_accvgpr_read_b32 v227, a19
    v_mul_f32 v224, v224, v52
    v_mul_f32 v225, v225, v52
    v_mul_f32 v226, v226, v52
    v_mul_f32 v227, v227, v52
    v_accvgpr_write_b32 a16, v224
    v_accvgpr_write_b32 a17, v225
    v_accvgpr_write_b32 a18, v226
    v_accvgpr_write_b32 a19, v227
    v_accvgpr_read_b32 v224, a20
    v_accvgpr_read_b32 v225, a21
    v_accvgpr_read_b32 v226, a22
    v_accvgpr_read_b32 v227, a23
    v_mul_f32 v224, v224, v53
    v_mul_f32 v225, v225, v53
    v_mul_f32 v226, v226, v53
    v_mul_f32 v227, v227, v53
    v_accvgpr_write_b32 a20, v224
    v_accvgpr_write_b32 a21, v225
    v_accvgpr_write_b32 a22, v226
    v_accvgpr_write_b32 a23, v227
    v_accvgpr_read_b32 v224, a24
    v_accvgpr_read_b32 v225, a25
    v_accvgpr_read_b32 v226, a26
    v_accvgpr_read_b32 v227, a27
    v_mul_f32 v224, v224, v54
    v_mul_f32 v225, v225, v54
    v_mul_f32 v226, v226, v54
    v_mul_f32 v227, v227, v54
    v_accvgpr_write_b32 a24, v224
    v_accvgpr_write_b32 a25, v225
    v_accvgpr_write_b32 a26, v226
    v_accvgpr_write_b32 a27, v227
    v_accvgpr_read_b32 v224, a28
    v_accvgpr_read_b32 v225, a29
    v_accvgpr_read_b32 v226, a30
    v_accvgpr_read_b32 v227, a31
    v_mul_f32 v224, v224, v55
    v_mul_f32 v225, v225, v55
    v_mul_f32 v226, v226, v55
    v_mul_f32 v227, v227, v55
    v_accvgpr_write_b32 a28, v224
    v_accvgpr_write_b32 a29, v225
    v_accvgpr_write_b32 a30, v226
    v_accvgpr_write_b32 a31, v227
    v_accvgpr_read_b32 v224, a32
    v_accvgpr_read_b32 v225, a33
    v_accvgpr_read_b32 v226, a34
    v_accvgpr_read_b32 v227, a35
    v_mul_f32 v224, v224, v52
    v_mul_f32 v225, v225, v52
    v_mul_f32 v226, v226, v52
    v_mul_f32 v227, v227, v52
    v_accvgpr_write_b32 a32, v224
    v_accvgpr_write_b32 a33, v225
    v_accvgpr_write_b32 a34, v226
    v_accvgpr_write_b32 a35, v227
    v_accvgpr_read_b32 v224, a36
    v_accvgpr_read_b32 v225, a37
    v_accvgpr_read_b32 v226, a38
    v_accvgpr_read_b32 v227, a39
    v_mul_f32 v224, v224, v53
    v_mul_f32 v225, v225, v53
    v_mul_f32 v226, v226, v53
    v_mul_f32 v227, v227, v53
    v_accvgpr_write_b32 a36, v224
    v_accvgpr_write_b32 a37, v225
    v_accvgpr_write_b32 a38, v226
    v_accvgpr_write_b32 a39, v227
    v_accvgpr_read_b32 v224, a40
    v_accvgpr_read_b32 v225, a41
    v_accvgpr_read_b32 v226, a42
    v_accvgpr_read_b32 v227, a43
    v_mul_f32 v224, v224, v54
    v_mul_f32 v225, v225, v54
    v_mul_f32 v226, v226, v54
    v_mul_f32 v227, v227, v54
    v_accvgpr_write_b32 a40, v224
    v_accvgpr_write_b32 a41, v225
    v_accvgpr_write_b32 a42, v226
    v_accvgpr_write_b32 a43, v227
    v_accvgpr_read_b32 v224, a44
    v_accvgpr_read_b32 v225, a45
    v_accvgpr_read_b32 v226, a46
    v_accvgpr_read_b32 v227, a47
    v_mul_f32 v224, v224, v55
    v_mul_f32 v225, v225, v55
    v_mul_f32 v226, v226, v55
    v_mul_f32 v227, v227, v55
    v_accvgpr_write_b32 a44, v224
    v_accvgpr_write_b32 a45, v225
    v_accvgpr_write_b32 a46, v226
    v_accvgpr_write_b32 a47, v227
    v_accvgpr_read_b32 v224, a48
    v_accvgpr_read_b32 v225, a49
    v_accvgpr_read_b32 v226, a50
    v_accvgpr_read_b32 v227, a51
    v_mul_f32 v224, v224, v52
    v_mul_f32 v225, v225, v52
    v_mul_f32 v226, v226, v52
    v_mul_f32 v227, v227, v52
    v_accvgpr_write_b32 a48, v224
    v_accvgpr_write_b32 a49, v225
    v_accvgpr_write_b32 a50, v226
    v_accvgpr_write_b32 a51, v227
    v_accvgpr_read_b32 v224, a52
    v_accvgpr_read_b32 v225, a53
    v_accvgpr_read_b32 v226, a54
    v_accvgpr_read_b32 v227, a55
    v_mul_f32 v224, v224, v53
    v_mul_f32 v225, v225, v53
    v_mul_f32 v226, v226, v53
    v_mul_f32 v227, v227, v53
    v_accvgpr_write_b32 a52, v224
    v_accvgpr_write_b32 a53, v225
    v_accvgpr_write_b32 a54, v226
    v_accvgpr_write_b32 a55, v227
    v_accvgpr_read_b32 v224, a56
    v_accvgpr_read_b32 v225, a57
    v_accvgpr_read_b32 v226, a58
    v_accvgpr_read_b32 v227, a59
    v_mul_f32 v224, v224, v54
    v_mul_f32 v225, v225, v54
    v_mul_f32 v226, v226, v54
    v_mul_f32 v227, v227, v54
    v_accvgpr_write_b32 a56, v224
    v_accvgpr_write_b32 a57, v225
    v_accvgpr_write_b32 a58, v226
    v_accvgpr_write_b32 a59, v227
    v_accvgpr_read_b32 v224, a60
    v_accvgpr_read_b32 v225, a61
    v_accvgpr_read_b32 v226, a62
    v_accvgpr_read_b32 v227, a63
    v_mul_f32 v224, v224, v55
    v_mul_f32 v225, v225, v55
    v_mul_f32 v226, v226, v55
    v_mul_f32 v227, v227, v55
    v_accvgpr_write_b32 a60, v224
    v_accvgpr_write_b32 a61, v225
    v_accvgpr_write_b32 a62, v226
    v_accvgpr_write_b32 a63, v227
    v_accvgpr_read_b32 v224, a64
    v_accvgpr_read_b32 v225, a65
    v_accvgpr_read_b32 v226, a66
    v_accvgpr_read_b32 v227, a67
    v_mul_f32 v224, v224, v52
    v_mul_f32 v225, v225, v52
    v_mul_f32 v226, v226, v52
    v_mul_f32 v227, v227, v52
    v_accvgpr_write_b32 a64, v224
    v_accvgpr_write_b32 a65, v225
    v_accvgpr_write_b32 a66, v226
    v_accvgpr_write_b32 a67, v227
    v_accvgpr_read_b32 v224, a68
    v_accvgpr_read_b32 v225, a69
    v_accvgpr_read_b32 v226, a70
    v_accvgpr_read_b32 v227, a71
    v_mul_f32 v224, v224, v53
    v_mul_f32 v225, v225, v53
    v_mul_f32 v226, v226, v53
    v_mul_f32 v227, v227, v53
    v_accvgpr_write_b32 a68, v224
    v_accvgpr_write_b32 a69, v225
    v_accvgpr_write_b32 a70, v226
    v_accvgpr_write_b32 a71, v227
    v_accvgpr_read_b32 v224, a72
    v_accvgpr_read_b32 v225, a73
    v_accvgpr_read_b32 v226, a74
    v_accvgpr_read_b32 v227, a75
    v_mul_f32 v224, v224, v54
    v_mul_f32 v225, v225, v54
    v_mul_f32 v226, v226, v54
    v_mul_f32 v227, v227, v54
    v_accvgpr_write_b32 a72, v224
    v_accvgpr_write_b32 a73, v225
    v_accvgpr_write_b32 a74, v226
    v_accvgpr_write_b32 a75, v227
    v_accvgpr_read_b32 v224, a76
    v_accvgpr_read_b32 v225, a77
    v_accvgpr_read_b32 v226, a78
    v_accvgpr_read_b32 v227, a79
    v_mul_f32 v224, v224, v55
    v_mul_f32 v225, v225, v55
    v_mul_f32 v226, v226, v55
    v_mul_f32 v227, v227, v55
    v_accvgpr_write_b32 a76, v224
    v_accvgpr_write_b32 a77, v225
    v_accvgpr_write_b32 a78, v226
    v_accvgpr_write_b32 a79, v227
    v_accvgpr_read_b32 v224, a80
    v_accvgpr_read_b32 v225, a81
    v_accvgpr_read_b32 v226, a82
    v_accvgpr_read_b32 v227, a83
    v_mul_f32 v224, v224, v52
    v_mul_f32 v225, v225, v52
    v_mul_f32 v226, v226, v52
    v_mul_f32 v227, v227, v52
    v_accvgpr_write_b32 a80, v224
    v_accvgpr_write_b32 a81, v225
    v_accvgpr_write_b32 a82, v226
    v_accvgpr_write_b32 a83, v227
    v_accvgpr_read_b32 v224, a84
    v_accvgpr_read_b32 v225, a85
    v_accvgpr_read_b32 v226, a86
    v_accvgpr_read_b32 v227, a87
    v_mul_f32 v224, v224, v53
    v_mul_f32 v225, v225, v53
    v_mul_f32 v226, v226, v53
    v_mul_f32 v227, v227, v53
    v_accvgpr_write_b32 a84, v224
    v_accvgpr_write_b32 a85, v225
    v_accvgpr_write_b32 a86, v226
    v_accvgpr_write_b32 a87, v227
    v_accvgpr_read_b32 v224, a88
    v_accvgpr_read_b32 v225, a89
    v_accvgpr_read_b32 v226, a90
    v_accvgpr_read_b32 v227, a91
    v_mul_f32 v224, v224, v54
    v_mul_f32 v225, v225, v54
    v_mul_f32 v226, v226, v54
    v_mul_f32 v227, v227, v54
    v_accvgpr_write_b32 a88, v224
    v_accvgpr_write_b32 a89, v225
    v_accvgpr_write_b32 a90, v226
    v_accvgpr_write_b32 a91, v227
    v_accvgpr_read_b32 v224, a92
    v_accvgpr_read_b32 v225, a93
    v_accvgpr_read_b32 v226, a94
    v_accvgpr_read_b32 v227, a95
    v_mul_f32 v224, v224, v55
    v_mul_f32 v225, v225, v55
    v_mul_f32 v226, v226, v55
    v_mul_f32 v227, v227, v55
    v_accvgpr_write_b32 a92, v224
    v_accvgpr_write_b32 a93, v225
    v_accvgpr_write_b32 a94, v226
    v_accvgpr_write_b32 a95, v227
    v_accvgpr_read_b32 v224, a96
    v_accvgpr_read_b32 v225, a97
    v_accvgpr_read_b32 v226, a98
    v_accvgpr_read_b32 v227, a99
    v_mul_f32 v224, v224, v52
    v_mul_f32 v225, v225, v52
    v_mul_f32 v226, v226, v52
    v_mul_f32 v227, v227, v52
    v_accvgpr_write_b32 a96, v224
    v_accvgpr_write_b32 a97, v225
    v_accvgpr_write_b32 a98, v226
    v_accvgpr_write_b32 a99, v227
    v_accvgpr_read_b32 v224, a100
    v_accvgpr_read_b32 v225, a101
    v_accvgpr_read_b32 v226, a102
    v_accvgpr_read_b32 v227, a103
    v_mul_f32 v224, v224, v53
    v_mul_f32 v225, v225, v53
    v_mul_f32 v226, v226, v53
    v_mul_f32 v227, v227, v53
    v_accvgpr_write_b32 a100, v224
    v_accvgpr_write_b32 a101, v225
    v_accvgpr_write_b32 a102, v226
    v_accvgpr_write_b32 a103, v227
    v_accvgpr_read_b32 v224, a104
    v_accvgpr_read_b32 v225, a105
    v_accvgpr_read_b32 v226, a106
    v_accvgpr_read_b32 v227, a107
    v_mul_f32 v224, v224, v54
    v_mul_f32 v225, v225, v54
    v_mul_f32 v226, v226, v54
    v_mul_f32 v227, v227, v54
    v_accvgpr_write_b32 a104, v224
    v_accvgpr_write_b32 a105, v225
    v_accvgpr_write_b32 a106, v226
    v_accvgpr_write_b32 a107, v227
    v_accvgpr_read_b32 v224, a108
    v_accvgpr_read_b32 v225, a109
    v_accvgpr_read_b32 v226, a110
    v_accvgpr_read_b32 v227, a111
    v_mul_f32 v224, v224, v55
    v_mul_f32 v225, v225, v55
    v_mul_f32 v226, v226, v55
    v_mul_f32 v227, v227, v55
    v_accvgpr_write_b32 a108, v224
    v_accvgpr_write_b32 a109, v225
    v_accvgpr_write_b32 a110, v226
    v_accvgpr_write_b32 a111, v227
    v_accvgpr_read_b32 v224, a112
    v_accvgpr_read_b32 v225, a113
    v_accvgpr_read_b32 v226, a114
    v_accvgpr_read_b32 v227, a115
    v_mul_f32 v224, v224, v52
    v_mul_f32 v225, v225, v52
    v_mul_f32 v226, v226, v52
    v_mul_f32 v227, v227, v52
    v_accvgpr_write_b32 a112, v224
    v_accvgpr_write_b32 a113, v225
    v_accvgpr_write_b32 a114, v226
    v_accvgpr_write_b32 a115, v227
    v_accvgpr_read_b32 v224, a116
    v_accvgpr_read_b32 v225, a117
    v_accvgpr_read_b32 v226, a118
    v_accvgpr_read_b32 v227, a119
    v_mul_f32 v224, v224, v53
    v_mul_f32 v225, v225, v53
    v_mul_f32 v226, v226, v53
    v_mul_f32 v227, v227, v53
    v_accvgpr_write_b32 a116, v224
    v_accvgpr_write_b32 a117, v225
    v_accvgpr_write_b32 a118, v226
    v_accvgpr_write_b32 a119, v227
    v_accvgpr_read_b32 v224, a120
    v_accvgpr_read_b32 v225, a121
    v_accvgpr_read_b32 v226, a122
    v_accvgpr_read_b32 v227, a123
    v_mul_f32 v224, v224, v54
    v_mul_f32 v225, v225, v54
    v_mul_f32 v226, v226, v54
    v_mul_f32 v227, v227, v54
    v_accvgpr_write_b32 a120, v224
    v_accvgpr_write_b32 a121, v225
    v_accvgpr_write_b32 a122, v226
    v_accvgpr_write_b32 a123, v227
    v_accvgpr_read_b32 v224, a124
    v_accvgpr_read_b32 v225, a125
    v_accvgpr_read_b32 v226, a126
    v_accvgpr_read_b32 v227, a127
    v_mul_f32 v224, v224, v55
    v_mul_f32 v225, v225, v55
    v_mul_f32 v226, v226, v55
    v_mul_f32 v227, v227, v55
    v_accvgpr_write_b32 a124, v224
    v_accvgpr_write_b32 a125, v225
    v_accvgpr_write_b32 a126, v226
    v_accvgpr_write_b32 a127, v227
    v_exp_f32 v232, v128
    v_exp_f32 v233, v129
    v_exp_f32 v234, v130
    v_exp_f32 v235, v131
    v_add_f32 v48, v232, v233
    v_cvt_pk_bf16_f32 v192, v232, v233
    v_exp_f32 v236, v144
    v_exp_f32 v237, v145
    v_add_f32 v48, v48, v234
    v_add_f32 v48, v48, v235
    v_cvt_pk_bf16_f32 v193, v234, v235
    v_exp_f32 v238, v146
    v_exp_f32 v239, v147
    v_add_f32 v48, v48, v236
    v_add_f32 v48, v48, v237
    v_cvt_pk_bf16_f32 v194, v236, v237
    v_exp_f32 v240, v132
    v_exp_f32 v241, v133
    v_add_f32 v48, v48, v238
    v_add_f32 v48, v48, v239
    v_cvt_pk_bf16_f32 v195, v238, v239
    v_exp_f32 v242, v134
    v_exp_f32 v243, v135
    v_add_f32 v49, v240, v241
    v_cvt_pk_bf16_f32 v196, v240, v241
    v_exp_f32 v244, v148
    v_exp_f32 v245, v149
    v_add_f32 v49, v49, v242
    v_add_f32 v49, v49, v243
    v_cvt_pk_bf16_f32 v197, v242, v243
    v_exp_f32 v246, v150
    v_exp_f32 v247, v151
    v_add_f32 v49, v49, v244
    v_add_f32 v49, v49, v245
    v_cvt_pk_bf16_f32 v198, v244, v245
    v_exp_f32 v232, v136
    v_exp_f32 v233, v137
    v_add_f32 v49, v49, v246
    v_add_f32 v49, v49, v247
    v_cvt_pk_bf16_f32 v199, v246, v247
    v_exp_f32 v234, v138
    v_exp_f32 v235, v139
    v_add_f32 v50, v232, v233
    v_cvt_pk_bf16_f32 v200, v232, v233
    v_exp_f32 v236, v152
    v_exp_f32 v237, v153
    v_add_f32 v50, v50, v234
    v_add_f32 v50, v50, v235
    v_cvt_pk_bf16_f32 v201, v234, v235
    v_exp_f32 v238, v154
    v_exp_f32 v239, v155
    v_add_f32 v50, v50, v236
    v_add_f32 v50, v50, v237
    v_cvt_pk_bf16_f32 v202, v236, v237
    v_exp_f32 v240, v140
    v_exp_f32 v241, v141
    v_add_f32 v50, v50, v238
    v_add_f32 v50, v50, v239
    v_cvt_pk_bf16_f32 v203, v238, v239
    v_exp_f32 v242, v142
    v_exp_f32 v243, v143
    v_add_f32 v51, v240, v241
    v_cvt_pk_bf16_f32 v204, v240, v241
    v_exp_f32 v244, v156
    v_exp_f32 v245, v157
    v_add_f32 v51, v51, v242
    v_add_f32 v51, v51, v243
    v_cvt_pk_bf16_f32 v205, v242, v243
    v_exp_f32 v246, v158
    v_exp_f32 v247, v159
    v_add_f32 v51, v51, v244
    v_add_f32 v51, v51, v245
    v_cvt_pk_bf16_f32 v206, v244, v245
    s_nop 0
    v_add_f32 v51, v51, v246
    v_add_f32 v51, v51, v247
    v_cvt_pk_bf16_f32 v207, v246, v247
    s_nop 1
    s_branch k2_ret_46
k2_rare_50:
    s_nop 7
    v_max_f32 v52, v160, v161
    v_max3_f32 v52, v52, v162, v163
    v_max3_f32 v52, v52, v176, v177
    v_max3_f32 v52, v52, v178, v179
    v_mov_b32 v6, v52
    s_nop 1
    v_permlane16_swap_b32 v52, v6
    s_nop 1
    v_max_f32 v52, v52, v6
    v_mov_b32 v6, v52
    s_nop 1
    v_permlane32_swap_b32 v52, v6
    s_nop 1
    v_max_f32 v52, v52, v6
    v_max_f32 v52, 0, v52
    v_max_f32 v53, v164, v165
    v_max3_f32 v53, v53, v166, v167
    v_max3_f32 v53, v53, v180, v181
    v_max3_f32 v53, v53, v182, v183
    v_mov_b32 v6, v53
    s_nop 1
    v_permlane16_swap_b32 v53, v6
    s_nop 1
    v_max_f32 v53, v53, v6
    v_mov_b32 v6, v53
    s_nop 1
    v_permlane32_swap_b32 v53, v6
    s_nop 1
    v_max_f32 v53, v53, v6
    v_max_f32 v53, 0, v53
    v_max_f32 v54, v168, v169
    v_max3_f32 v54, v54, v170, v171
    v_max3_f32 v54, v54, v184, v185
    v_max3_f32 v54, v54, v186, v187
    v_mov_b32 v6, v54
    s_nop 1
    v_permlane16_swap_b32 v54, v6
    s_nop 1
    v_max_f32 v54, v54, v6
    v_mov_b32 v6, v54
    s_nop 1
    v_permlane32_swap_b32 v54, v6
    s_nop 1
    v_max_f32 v54, v54, v6
    v_max_f32 v54, 0, v54
    v_max_f32 v55, v172, v173
    v_max3_f32 v55, v55, v174, v175
    v_max3_f32 v55, v55, v188, v189
    v_max3_f32 v55, v55, v190, v191
    v_mov_b32 v6, v55
    s_nop 1
    v_permlane16_swap_b32 v55, v6
    s_nop 1
    v_max_f32 v55, v55, v6
    v_mov_b32 v6, v55
    s_nop 1
    v_permlane32_swap_b32 v55, v6
    s_nop 1
    v_max_f32 v55, v55, v6
    v_max_f32 v55, 0, v55
    v_sub_f32 v160, v160, v52
    v_sub_f32 v161, v161, v52
    v_sub_f32 v162, v162, v52
    v_sub_f32 v163, v163, v52
    v_sub_f32 v164, v164, v53
    v_sub_f32 v165, v165, v53
    v_sub_f32 v166, v166, v53
    v_sub_f32 v167, v167, v53
    v_sub_f32 v168, v168, v54
    v_sub_f32 v169, v169, v54
    v_sub_f32 v170, v170, v54
    v_sub_f32 v171, v171, v54
    v_sub_f32 v172, v172, v55
    v_sub_f32 v173, v173, v55
    v_sub_f32 v174, v174, v55
    v_sub_f32 v175, v175, v55
    v_sub_f32 v176, v176, v52
    v_sub_f32 v177, v177, v52
    v_sub_f32 v178, v178, v52
    v_sub_f32 v179, v179, v52
    v_sub_f32 v180, v180, v53
    v_sub_f32 v181, v181, v53
    v_sub_f32 v182, v182, v53
    v_sub_f32 v183, v183, v53
    v_sub_f32 v184, v184, v54
    v_sub_f32 v185, v185, v54
    v_sub_f32 v186, v186, v54
    v_sub_f32 v187, v187, v54
    v_sub_f32 v188, v188, v55
    v_sub_f32 v189, v189, v55
    v_sub_f32 v190, v190, v55
    v_sub_f32 v191, v191, v55
    v_sub_f32 v128, v128, v52
    v_sub_f32 v16, v16, v52
    v_sub_f32 v129, v129, v52
    v_sub_f32 v17, v17, v52
    v_sub_f32 v130, v130, v52
    v_sub_f32 v18, v18, v52
    v_sub_f32 v131, v131, v52
    v_sub_f32 v19, v19, v52
    v_sub_f32 v132, v132, v53
    v_sub_f32 v20, v20, v53
    v_sub_f32 v133, v133, v53
    v_sub_f32 v21, v21, v53
    v_sub_f32 v134, v134, v53
    v_sub_f32 v22, v22, v53
    v_sub_f32 v135, v135, v53
    v_sub_f32 v23, v23, v53
    v_sub_f32 v136, v136, v54
    v_sub_f32 v24, v24, v54
    v_sub_f32 v137, v137, v54
    v_sub_f32 v25, v25, v54
    v_sub_f32 v138, v138, v54
    v_sub_f32 v26, v26, v54
    v_sub_f32 v139, v139, v54
    v_sub_f32 v27, v27, v54
    v_sub_f32 v140, v140, v55
    v_sub_f32 v28, v28, v55
    v_sub_f32 v141, v141, v55
    v_sub_f32 v29, v29, v55
    v_sub_f32 v142, v142, v55
    v_sub_f32 v30, v30, v55
    v_sub_f32 v143, v143, v55
    v_sub_f32 v31, v31, v55
    v_sub_f32 v144, v144, v52
    v_sub_f32 v32, v32, v52
    v_sub_f32 v145, v145, v52
    v_sub_f32 v33, v33, v52
    v_sub_f32 v146, v146, v52
    v_sub_f32 v34, v34, v52
    v_sub_f32 v147, v147, v52
    v_sub_f32 v35, v35, v52
    v_sub_f32 v148, v148, v53
    v_sub_f32 v36, v36, v53
    v_sub_f32 v149, v149, v53
    v_sub_f32 v37, v37, v53
    v_sub_f32 v150, v150, v53
    v_sub_f32 v38, v38, v53
    v_sub_f32 v151, v151, v53
    v_sub_f32 v39, v39, v53
    v_sub_f32 v152, v152, v54
    v_sub_f32 v40, v40, v54
    v_sub_f32 v153, v153, v54
    v_sub_f32 v41, v41, v54
    v_sub_f32 v154, v154, v54
    v_sub_f32 v42, v42, v54
    v_sub_f32 v155, v155, v54
    v_sub_f32 v43, v43, v54
    v_sub_f32 v156, v156, v55
    v_sub_f32 v44, v44, v55
    v_sub_f32 v157, v157, v55
    v_sub_f32 v45, v45, v55
    v_sub_f32 v158, v158, v55
    v_sub_f32 v46, v46, v55
    v_sub_f32 v159, v159, v55
    v_sub_f32 v47, v47, v55
    v_sub_f32 v8, v8, v52
    v_exp_f32 v52, -v52
    v_sub_f32 v9, v9, v53
    v_exp_f32 v53, -v53
    v_sub_f32 v10, v10, v54
    v_exp_f32 v54, -v54
    v_sub_f32 v11, v11, v55
    v_exp_f32 v55, -v55
    s_nop 0
    v_mul_f32 v12, v12, v52
    v_mul_f32 v13, v13, v53
    v_mul_f32 v14, v14, v54
    v_mul_f32 v15, v15, v55
    v_accvgpr_read_b32 v224, a0
    v_accvgpr_read_b32 v225, a1
    v_accvgpr_read_b32 v226, a2
    v_accvgpr_read_b32 v227, a3
    v_mul_f32 v224, v224, v52
    v_mul_f32 v225, v225, v52
    v_mul_f32 v226, v226, v52
    v_mul_f32 v227, v227, v52
    v_accvgpr_write_b32 a0, v224
    v_accvgpr_write_b32 a1, v225
    v_accvgpr_write_b32 a2, v226
    v_accvgpr_write_b32 a3, v227
    v_accvgpr_read_b32 v224, a4
    v_accvgpr_read_b32 v225, a5
    v_accvgpr_read_b32 v226, a6
    v_accvgpr_read_b32 v227, a7
    v_mul_f32 v224, v224, v53
    v_mul_f32 v225, v225, v53
    v_mul_f32 v226, v226, v53
    v_mul_f32 v227, v227, v53
    v_accvgpr_write_b32 a4, v224
    v_accvgpr_write_b32 a5, v225
    v_accvgpr_write_b32 a6, v226
    v_accvgpr_write_b32 a7, v227
    v_accvgpr_read_b32 v224, a8
    v_accvgpr_read_b32 v225, a9
    v_accvgpr_read_b32 v226, a10
    v_accvgpr_read_b32 v227, a11
    v_mul_f32 v224, v224, v54
    v_mul_f32 v225, v225, v54
    v_mul_f32 v226, v226, v54
    v_mul_f32 v227, v227, v54
    v_accvgpr_write_b32 a8, v224
    v_accvgpr_write_b32 a9, v225
    v_accvgpr_write_b32 a10, v226
    v_accvgpr_write_b32 a11, v227
    v_accvgpr_read_b32 v224, a12
    v_accvgpr_read_b32 v225, a13
    v_accvgpr_read_b32 v226, a14
    v_accvgpr_read_b32 v227, a15
    v_mul_f32 v224, v224, v55
    v_mul_f32 v225, v225, v55
    v_mul_f32 v226, v226, v55
    v_mul_f32 v227, v227, v55
    v_accvgpr_write_b32 a12, v224
    v_accvgpr_write_b32 a13, v225
    v_accvgpr_write_b32 a14, v226
    v_accvgpr_write_b32 a15, v227
    v_accvgpr_read_b32 v224, a16
    v_accvgpr_read_b32 v225, a17
    v_accvgpr_read_b32 v226, a18
    v_accvgpr_read_b32 v227, a19
    v_mul_f32 v224, v224, v52
    v_mul_f32 v225, v225, v52
    v_mul_f32 v226, v226, v52
    v_mul_f32 v227, v227, v52
    v_accvgpr_write_b32 a16, v224
    v_accvgpr_write_b32 a17, v225
    v_accvgpr_write_b32 a18, v226
    v_accvgpr_write_b32 a19, v227
    v_accvgpr_read_b32 v224, a20
    v_accvgpr_read_b32 v225, a21
    v_accvgpr_read_b32 v226, a22
    v_accvgpr_read_b32 v227, a23
    v_mul_f32 v224, v224, v53
    v_mul_f32 v225, v225, v53
    v_mul_f32 v226, v226, v53
    v_mul_f32 v227, v227, v53
    v_accvgpr_write_b32 a20, v224
    v_accvgpr_write_b32 a21, v225
    v_accvgpr_write_b32 a22, v226
    v_accvgpr_write_b32 a23, v227
    v_accvgpr_read_b32 v224, a24
    v_accvgpr_read_b32 v225, a25
    v_accvgpr_read_b32 v226, a26
    v_accvgpr_read_b32 v227, a27
    v_mul_f32 v224, v224, v54
    v_mul_f32 v225, v225, v54
    v_mul_f32 v226, v226, v54
    v_mul_f32 v227, v227, v54
    v_accvgpr_write_b32 a24, v224
    v_accvgpr_write_b32 a25, v225
    v_accvgpr_write_b32 a26, v226
    v_accvgpr_write_b32 a27, v227
    v_accvgpr_read_b32 v224, a28
    v_accvgpr_read_b32 v225, a29
    v_accvgpr_read_b32 v226, a30
    v_accvgpr_read_b32 v227, a31
    v_mul_f32 v224, v224, v55
    v_mul_f32 v225, v225, v55
    v_mul_f32 v226, v226, v55
    v_mul_f32 v227, v227, v55
    v_accvgpr_write_b32 a28, v224
    v_accvgpr_write_b32 a29, v225
    v_accvgpr_write_b32 a30, v226
    v_accvgpr_write_b32 a31, v227
    v_accvgpr_read_b32 v224, a32
    v_accvgpr_read_b32 v225, a33
    v_accvgpr_read_b32 v226, a34
    v_accvgpr_read_b32 v227, a35
    v_mul_f32 v224, v224, v52
    v_mul_f32 v225, v225, v52
    v_mul_f32 v226, v226, v52
    v_mul_f32 v227, v227, v52
    v_accvgpr_write_b32 a32, v224
    v_accvgpr_write_b32 a33, v225
    v_accvgpr_write_b32 a34, v226
    v_accvgpr_write_b32 a35, v227
    v_accvgpr_read_b32 v224, a36
    v_accvgpr_read_b32 v225, a37
    v_accvgpr_read_b32 v226, a38
    v_accvgpr_read_b32 v227, a39
    v_mul_f32 v224, v224, v53
    v_mul_f32 v225, v225, v53
    v_mul_f32 v226, v226, v53
    v_mul_f32 v227, v227, v53
    v_accvgpr_write_b32 a36, v224
    v_accvgpr_write_b32 a37, v225
    v_accvgpr_write_b32 a38, v226
    v_accvgpr_write_b32 a39, v227
    v_accvgpr_read_b32 v224, a40
    v_accvgpr_read_b32 v225, a41
    v_accvgpr_read_b32 v226, a42
    v_accvgpr_read_b32 v227, a43
    v_mul_f32 v224, v224, v54
    v_mul_f32 v225, v225, v54
    v_mul_f32 v226, v226, v54
    v_mul_f32 v227, v227, v54
    v_accvgpr_write_b32 a40, v224
    v_accvgpr_write_b32 a41, v225
    v_accvgpr_write_b32 a42, v226
    v_accvgpr_write_b32 a43, v227
    v_accvgpr_read_b32 v224, a44
    v_accvgpr_read_b32 v225, a45
    v_accvgpr_read_b32 v226, a46
    v_accvgpr_read_b32 v227, a47
    v_mul_f32 v224, v224, v55
    v_mul_f32 v225, v225, v55
    v_mul_f32 v226, v226, v55
    v_mul_f32 v227, v227, v55
    v_accvgpr_write_b32 a44, v224
    v_accvgpr_write_b32 a45, v225
    v_accvgpr_write_b32 a46, v226
    v_accvgpr_write_b32 a47, v227
    v_accvgpr_read_b32 v224, a48
    v_accvgpr_read_b32 v225, a49
    v_accvgpr_read_b32 v226, a50
    v_accvgpr_read_b32 v227, a51
    v_mul_f32 v224, v224, v52
    v_mul_f32 v225, v225, v52
    v_mul_f32 v226, v226, v52
    v_mul_f32 v227, v227, v52
    v_accvgpr_write_b32 a48, v224
    v_accvgpr_write_b32 a49, v225
    v_accvgpr_write_b32 a50, v226
    v_accvgpr_write_b32 a51, v227
    v_accvgpr_read_b32 v224, a52
    v_accvgpr_read_b32 v225, a53
    v_accvgpr_read_b32 v226, a54
    v_accvgpr_read_b32 v227, a55
    v_mul_f32 v224, v224, v53
    v_mul_f32 v225, v225, v53
    v_mul_f32 v226, v226, v53
    v_mul_f32 v227, v227, v53
    v_accvgpr_write_b32 a52, v224
    v_accvgpr_write_b32 a53, v225
    v_accvgpr_write_b32 a54, v226
    v_accvgpr_write_b32 a55, v227
    v_accvgpr_read_b32 v224, a56
    v_accvgpr_read_b32 v225, a57
    v_accvgpr_read_b32 v226, a58
    v_accvgpr_read_b32 v227, a59
    v_mul_f32 v224, v224, v54
    v_mul_f32 v225, v225, v54
    v_mul_f32 v226, v226, v54
    v_mul_f32 v227, v227, v54
    v_accvgpr_write_b32 a56, v224
    v_accvgpr_write_b32 a57, v225
    v_accvgpr_write_b32 a58, v226
    v_accvgpr_write_b32 a59, v227
    v_accvgpr_read_b32 v224, a60
    v_accvgpr_read_b32 v225, a61
    v_accvgpr_read_b32 v226, a62
    v_accvgpr_read_b32 v227, a63
    v_mul_f32 v224, v224, v55
    v_mul_f32 v225, v225, v55
    v_mul_f32 v226, v226, v55
    v_mul_f32 v227, v227, v55
    v_accvgpr_write_b32 a60, v224
    v_accvgpr_write_b32 a61, v225
    v_accvgpr_write_b32 a62, v226
    v_accvgpr_write_b32 a63, v227
    v_accvgpr_read_b32 v224, a64
    v_accvgpr_read_b32 v225, a65
    v_accvgpr_read_b32 v226, a66
    v_accvgpr_read_b32 v227, a67
    v_mul_f32 v224, v224, v52
    v_mul_f32 v225, v225, v52
    v_mul_f32 v226, v226, v52
    v_mul_f32 v227, v227, v52
    v_accvgpr_write_b32 a64, v224
    v_accvgpr_write_b32 a65, v225
    v_accvgpr_write_b32 a66, v226
    v_accvgpr_write_b32 a67, v227
    v_accvgpr_read_b32 v224, a68
    v_accvgpr_read_b32 v225, a69
    v_accvgpr_read_b32 v226, a70
    v_accvgpr_read_b32 v227, a71
    v_mul_f32 v224, v224, v53
    v_mul_f32 v225, v225, v53
    v_mul_f32 v226, v226, v53
    v_mul_f32 v227, v227, v53
    v_accvgpr_write_b32 a68, v224
    v_accvgpr_write_b32 a69, v225
    v_accvgpr_write_b32 a70, v226
    v_accvgpr_write_b32 a71, v227
    v_accvgpr_read_b32 v224, a72
    v_accvgpr_read_b32 v225, a73
    v_accvgpr_read_b32 v226, a74
    v_accvgpr_read_b32 v227, a75
    v_mul_f32 v224, v224, v54
    v_mul_f32 v225, v225, v54
    v_mul_f32 v226, v226, v54
    v_mul_f32 v227, v227, v54
    v_accvgpr_write_b32 a72, v224
    v_accvgpr_write_b32 a73, v225
    v_accvgpr_write_b32 a74, v226
    v_accvgpr_write_b32 a75, v227
    v_accvgpr_read_b32 v224, a76
    v_accvgpr_read_b32 v225, a77
    v_accvgpr_read_b32 v226, a78
    v_accvgpr_read_b32 v227, a79
    v_mul_f32 v224, v224, v55
    v_mul_f32 v225, v225, v55
    v_mul_f32 v226, v226, v55
    v_mul_f32 v227, v227, v55
    v_accvgpr_write_b32 a76, v224
    v_accvgpr_write_b32 a77, v225
    v_accvgpr_write_b32 a78, v226
    v_accvgpr_write_b32 a79, v227
    v_accvgpr_read_b32 v224, a80
    v_accvgpr_read_b32 v225, a81
    v_accvgpr_read_b32 v226, a82
    v_accvgpr_read_b32 v227, a83
    v_mul_f32 v224, v224, v52
    v_mul_f32 v225, v225, v52
    v_mul_f32 v226, v226, v52
    v_mul_f32 v227, v227, v52
    v_accvgpr_write_b32 a80, v224
    v_accvgpr_write_b32 a81, v225
    v_accvgpr_write_b32 a82, v226
    v_accvgpr_write_b32 a83, v227
    v_accvgpr_read_b32 v224, a84
    v_accvgpr_read_b32 v225, a85
    v_accvgpr_read_b32 v226, a86
    v_accvgpr_read_b32 v227, a87
    v_mul_f32 v224, v224, v53
    v_mul_f32 v225, v225, v53
    v_mul_f32 v226, v226, v53
    v_mul_f32 v227, v227, v53
    v_accvgpr_write_b32 a84, v224
    v_accvgpr_write_b32 a85, v225
    v_accvgpr_write_b32 a86, v226
    v_accvgpr_write_b32 a87, v227
    v_accvgpr_read_b32 v224, a88
    v_accvgpr_read_b32 v225, a89
    v_accvgpr_read_b32 v226, a90
    v_accvgpr_read_b32 v227, a91
    v_mul_f32 v224, v224, v54
    v_mul_f32 v225, v225, v54
    v_mul_f32 v226, v226, v54
    v_mul_f32 v227, v227, v54
    v_accvgpr_write_b32 a88, v224
    v_accvgpr_write_b32 a89, v225
    v_accvgpr_write_b32 a90, v226
    v_accvgpr_write_b32 a91, v227
    v_accvgpr_read_b32 v224, a92
    v_accvgpr_read_b32 v225, a93
    v_accvgpr_read_b32 v226, a94
    v_accvgpr_read_b32 v227, a95
    v_mul_f32 v224, v224, v55
    v_mul_f32 v225, v225, v55
    v_mul_f32 v226, v226, v55
    v_mul_f32 v227, v227, v55
    v_accvgpr_write_b32 a92, v224
    v_accvgpr_write_b32 a93, v225
    v_accvgpr_write_b32 a94, v226
    v_accvgpr_write_b32 a95, v227
    v_accvgpr_read_b32 v224, a96
    v_accvgpr_read_b32 v225, a97
    v_accvgpr_read_b32 v226, a98
    v_accvgpr_read_b32 v227, a99
    v_mul_f32 v224, v224, v52
    v_mul_f32 v225, v225, v52
    v_mul_f32 v226, v226, v52
    v_mul_f32 v227, v227, v52
    v_accvgpr_write_b32 a96, v224
    v_accvgpr_write_b32 a97, v225
    v_accvgpr_write_b32 a98, v226
    v_accvgpr_write_b32 a99, v227
    v_accvgpr_read_b32 v224, a100
    v_accvgpr_read_b32 v225, a101
    v_accvgpr_read_b32 v226, a102
    v_accvgpr_read_b32 v227, a103
    v_mul_f32 v224, v224, v53
    v_mul_f32 v225, v225, v53
    v_mul_f32 v226, v226, v53
    v_mul_f32 v227, v227, v53
    v_accvgpr_write_b32 a100, v224
    v_accvgpr_write_b32 a101, v225
    v_accvgpr_write_b32 a102, v226
    v_accvgpr_write_b32 a103, v227
    v_accvgpr_read_b32 v224, a104
    v_accvgpr_read_b32 v225, a105
    v_accvgpr_read_b32 v226, a106
    v_accvgpr_read_b32 v227, a107
    v_mul_f32 v224, v224, v54
    v_mul_f32 v225, v225, v54
    v_mul_f32 v226, v226, v54
    v_mul_f32 v227, v227, v54
    v_accvgpr_write_b32 a104, v224
    v_accvgpr_write_b32 a105, v225
    v_accvgpr_write_b32 a106, v226
    v_accvgpr_write_b32 a107, v227
    v_accvgpr_read_b32 v224, a108
    v_accvgpr_read_b32 v225, a109
    v_accvgpr_read_b32 v226, a110
    v_accvgpr_read_b32 v227, a111
    v_mul_f32 v224, v224, v55
    v_mul_f32 v225, v225, v55
    v_mul_f32 v226, v226, v55
    v_mul_f32 v227, v227, v55
    v_accvgpr_write_b32 a108, v224
    v_accvgpr_write_b32 a109, v225
    v_accvgpr_write_b32 a110, v226
    v_accvgpr_write_b32 a111, v227
    v_accvgpr_read_b32 v224, a112
    v_accvgpr_read_b32 v225, a113
    v_accvgpr_read_b32 v226, a114
    v_accvgpr_read_b32 v227, a115
    v_mul_f32 v224, v224, v52
    v_mul_f32 v225, v225, v52
    v_mul_f32 v226, v226, v52
    v_mul_f32 v227, v227, v52
    v_accvgpr_write_b32 a112, v224
    v_accvgpr_write_b32 a113, v225
    v_accvgpr_write_b32 a114, v226
    v_accvgpr_write_b32 a115, v227
    v_accvgpr_read_b32 v224, a116
    v_accvgpr_read_b32 v225, a117
    v_accvgpr_read_b32 v226, a118
    v_accvgpr_read_b32 v227, a119
    v_mul_f32 v224, v224, v53
    v_mul_f32 v225, v225, v53
    v_mul_f32 v226, v226, v53
    v_mul_f32 v227, v227, v53
    v_accvgpr_write_b32 a116, v224
    v_accvgpr_write_b32 a117, v225
    v_accvgpr_write_b32 a118, v226
    v_accvgpr_write_b32 a119, v227
    v_accvgpr_read_b32 v224, a120
    v_accvgpr_read_b32 v225, a121
    v_accvgpr_read_b32 v226, a122
    v_accvgpr_read_b32 v227, a123
    v_mul_f32 v224, v224, v54
    v_mul_f32 v225, v225, v54
    v_mul_f32 v226, v226, v54
    v_mul_f32 v227, v227, v54
    v_accvgpr_write_b32 a120, v224
    v_accvgpr_write_b32 a121, v225
    v_accvgpr_write_b32 a122, v226
    v_accvgpr_write_b32 a123, v227
    v_accvgpr_read_b32 v224, a124
    v_accvgpr_read_b32 v225, a125
    v_accvgpr_read_b32 v226, a126
    v_accvgpr_read_b32 v227, a127
    v_mul_f32 v224, v224, v55
    v_mul_f32 v225, v225, v55
    v_mul_f32 v226, v226, v55
    v_mul_f32 v227, v227, v55
    v_accvgpr_write_b32 a124, v224
    v_accvgpr_write_b32 a125, v225
    v_accvgpr_write_b32 a126, v226
    v_accvgpr_write_b32 a127, v227
    v_exp_f32 v232, v160
    v_exp_f32 v233, v161
    v_exp_f32 v234, v162
    v_exp_f32 v235, v163
    v_add_f32 v48, v232, v233
    v_cvt_pk_bf16_f32 v208, v232, v233
    v_exp_f32 v236, v176
    v_exp_f32 v237, v177
    v_add_f32 v48, v48, v234
    v_add_f32 v48, v48, v235
    v_cvt_pk_bf16_f32 v209, v234, v235
    v_exp_f32 v238, v178
    v_exp_f32 v239, v179
    v_add_f32 v48, v48, v236
    v_add_f32 v48, v48, v237
    v_cvt_pk_bf16_f32 v210, v236, v237
    v_exp_f32 v240, v164
    v_exp_f32 v241, v165
    v_add_f32 v48, v48, v238
    v_add_f32 v48, v48, v239
    v_cvt_pk_bf16_f32 v211, v238, v239
    v_exp_f32 v242, v166
    v_exp_f32 v243, v167
    v_add_f32 v49, v240, v241
    v_cvt_pk_bf16_f32 v212, v240, v241
    v_exp_f32 v244, v180
    v_exp_f32 v245, v181
    v_add_f32 v49, v49, v242
    v_add_f32 v49, v49, v243
    v_cvt_pk_bf16_f32 v213, v242, v243
    v_exp_f32 v246, v182
    v_exp_f32 v247, v183
    v_add_f32 v49, v49, v244
    v_add_f32 v49, v49, v245
    v_cvt_pk_bf16_f32 v214, v244, v245
    v_exp_f32 v232, v168
    v_exp_f32 v233, v169
    v_add_f32 v49, v49, v246
    v_add_f32 v49, v49, v247
    v_cvt_pk_bf16_f32 v215, v246, v247
    v_exp_f32 v234, v170
    v_exp_f32 v235, v171
    v_add_f32 v50, v232, v233
    v_cvt_pk_bf16_f32 v216, v232, v233
    v_exp_f32 v236, v184
    v_exp_f32 v237, v185
    v_add_f32 v50, v50, v234
    v_add_f32 v50, v50, v235
    v_cvt_pk_bf16_f32 v217, v234, v235
    v_exp_f32 v238, v186
    v_exp_f32 v239, v187
    v_add_f32 v50, v50, v236
    v_add_f32 v50, v50, v237
    v_cvt_pk_bf16_f32 v218, v236, v237
    v_exp_f32 v240, v172
    v_exp_f32 v241, v173
    v_add_f32 v50, v50, v238
    v_add_f32 v50, v50, v239
    v_cvt_pk_bf16_f32 v219, v238, v239
    v_exp_f32 v242, v174
    v_exp_f32 v243, v175
    v_add_f32 v51, v240, v241
    v_cvt_pk_bf16_f32 v220, v240, v241
    v_exp_f32 v244, v188
    v_exp_f32 v245, v189
    v_add_f32 v51, v51, v242
    v_add_f32 v51, v51, v243
    v_cvt_pk_bf16_f32 v221, v242, v243
    v_exp_f32 v246, v190
    v_exp_f32 v247, v191
    v_add_f32 v51, v51, v244
    v_add_f32 v51, v51, v245
    v_cvt_pk_bf16_f32 v222, v244, v245
    s_nop 0
    v_add_f32 v51, v51, v246
    v_add_f32 v51, v51, v247
    v_cvt_pk_bf16_f32 v223, v246, v247
    s_nop 1
    s_branch k2_ret_51
k2_rare_54:
    s_nop 7
    v_max_f32 v52, v128, v129
    v_max3_f32 v52, v52, v130, v131
    v_max3_f32 v52, v52, v144, v145
    v_max3_f32 v52, v52, v146, v147
    v_mov_b32 v6, v52
    s_nop 1
    v_permlane16_swap_b32 v52, v6
    s_nop 1
    v_max_f32 v52, v52, v6
    v_mov_b32 v6, v52
    s_nop 1
    v_permlane32_swap_b32 v52, v6
    s_nop 1
    v_max_f32 v52, v52, v6
    v_max_f32 v52, 0, v52
    v_max_f32 v53, v132, v133
    v_max3_f32 v53, v53, v134, v135
    v_max3_f32 v53, v53, v148, v149
    v_max3_f32 v53, v53, v150, v151
    v_mov_b32 v6, v53
    s_nop 1
    v_permlane16_swap_b32 v53, v6
    s_nop 1
    v_max_f32 v53, v53, v6
    v_mov_b32 v6, v53
    s_nop 1
    v_permlane32_swap_b32 v53, v6
    s_nop 1
    v_max_f32 v53, v53, v6
    v_max_f32 v53, 0, v53
    v_max_f32 v54, v136, v137
    v_max3_f32 v54, v54, v138, v139
    v_max3_f32 v54, v54, v152, v153
    v_max3_f32 v54, v54, v154, v155
    v_mov_b32 v6, v54
    s_nop 1
    v_permlane16_swap_b32 v54, v6
    s_nop 1
    v_max_f32 v54, v54, v6
    v_mov_b32 v6, v54
    s_nop 1
    v_permlane32_swap_b32 v54, v6
    s_nop 1
    v_max_f32 v54, v54, v6
    v_max_f32 v54, 0, v54
    v_max_f32 v55, v140, v141
    v_max3_f32 v55, v55, v142, v143
    v_max3_f32 v55, v55, v156, v157
    v_max3_f32 v55, v55, v158, v159
    v_mov_b32 v6, v55
    s_nop 1
    v_permlane16_swap_b32 v55, v6
    s_nop 1
    v_max_f32 v55, v55, v6
    v_mov_b32 v6, v55
    s_nop 1
    v_permlane32_swap_b32 v55, v6
    s_nop 1
    v_max_f32 v55, v55, v6
    v_max_f32 v55, 0, v55
    v_sub_f32 v128, v128, v52
    v_sub_f32 v129, v129, v52
    v_sub_f32 v130, v130, v52
    v_sub_f32 v131, v131, v52
    v_sub_f32 v132, v132, v53
    v_sub_f32 v133, v133, v53
    v_sub_f32 v134, v134, v53
    v_sub_f32 v135, v135, v53
    v_sub_f32 v136, v136, v54
    v_sub_f32 v137, v137, v54
    v_sub_f32 v138, v138, v54
    v_sub_f32 v139, v139, v54
    v_sub_f32 v140, v140, v55
    v_sub_f32 v141, v141, v55
    v_sub_f32 v142, v142, v55
    v_sub_f32 v143, v143, v55
    v_sub_f32 v144, v144, v52
    v_sub_f32 v145, v145, v52
    v_sub_f32 v146, v146, v52
    v_sub_f32 v147, v147, v52
    v_sub_f32 v148, v148, v53
    v_sub_f32 v149, v149, v53
    v_sub_f32 v150, v150, v53
    v_sub_f32 v151, v151, v53
    v_sub_f32 v152, v152, v54
    v_sub_f32 v153, v153, v54
    v_sub_f32 v154, v154, v54
    v_sub_f32 v155, v155, v54
    v_sub_f32 v156, v156, v55
    v_sub_f32 v157, v157, v55
    v_sub_f32 v158, v158, v55
    v_sub_f32 v159, v159, v55
    v_sub_f32 v160, v160, v52
    v_sub_f32 v16, v16, v52
    v_sub_f32 v161, v161, v52
    v_sub_f32 v17, v17, v52
    v_sub_f32 v162, v162, v52
    v_sub_f32 v18, v18, v52
    v_sub_f32 v163, v163, v52
    v_sub_f32 v19, v19, v52
    v_sub_f32 v164, v164, v53
    v_sub_f32 v20, v20, v53
    v_sub_f32 v165, v165, v53
    v_sub_f32 v21, v21, v53
    v_sub_f32 v166, v166, v53
    v_sub_f32 v22, v22, v53
    v_sub_f32 v167, v167, v53
    v_sub_f32 v23, v23, v53
    v_sub_f32 v168, v168, v54
    v_sub_f32 v24, v24, v54
    v_sub_f32 v169, v169, v54
    v_sub_f32 v25, v25, v54
    v_sub_f32 v170, v170, v54
    v_sub_f32 v26, v26, v54
    v_sub_f32 v171, v171, v54
    v_sub_f32 v27, v27, v54
    v_sub_f32 v172, v172, v55
    v_sub_f32 v28, v28, v55
    v_sub_f32 v173, v173, v55
    v_sub_f32 v29, v29, v55
    v_sub_f32 v174, v174, v55
    v_sub_f32 v30, v30, v55
    v_sub_f32 v175, v175, v55
    v_sub_f32 v31, v31, v55
    v_sub_f32 v176, v176, v52
    v_sub_f32 v32, v32, v52
    v_sub_f32 v177, v177, v52
    v_sub_f32 v33, v33, v52
    v_sub_f32 v178, v178, v52
    v_sub_f32 v34, v34, v52
    v_sub_f32 v179, v179, v52
    v_sub_f32 v35, v35, v52
    v_sub_f32 v180, v180, v53
    v_sub_f32 v36, v36, v53
    v_sub_f32 v181, v181, v53
    v_sub_f32 v37, v37, v53
    v_sub_f32 v182, v182, v53
    v_sub_f32 v38, v38, v53
    v_sub_f32 v183, v183, v53
    v_sub_f32 v39, v39, v53
    v_sub_f32 v184, v184, v54
    v_sub_f32 v40, v40, v54
    v_sub_f32 v185, v185, v54
    v_sub_f32 v41, v41, v54
    v_sub_f32 v186, v186, v54
    v_sub_f32 v42, v42, v54
    v_sub_f32 v187, v187, v54
    v_sub_f32 v43, v43, v54
    v_sub_f32 v188, v188, v55
    v_sub_f32 v44, v44, v55
    v_sub_f32 v189, v189, v55
    v_sub_f32 v45, v45, v55
    v_sub_f32 v190, v190, v55
    v_sub_f32 v46, v46, v55
    v_sub_f32 v191, v191, v55
    v_sub_f32 v47, v47, v55
    v_sub_f32 v8, v8, v52
    v_exp_f32 v52, -v52
    v_sub_f32 v9, v9, v53
    v_exp_f32 v53, -v53
    v_sub_f32 v10, v10, v54
    v_exp_f32 v54, -v54
    v_sub_f32 v11, v11, v55
    v_exp_f32 v55, -v55
    s_nop 0
    v_mul_f32 v12, v12, v52
    v_mul_f32 v13, v13, v53
    v_mul_f32 v14, v14, v54
    v_mul_f32 v15, v15, v55
    v_accvgpr_read_b32 v224, a0
    v_accvgpr_read_b32 v225, a1
    v_accvgpr_read_b32 v226, a2
    v_accvgpr_read_b32 v227, a3
    v_mul_f32 v224, v224, v52
    v_mul_f32 v225, v225, v52
    v_mul_f32 v226, v226, v52
    v_mul_f32 v227, v227, v52
    v_accvgpr_write_b32 a0, v224
    v_accvgpr_write_b32 a1, v225
    v_accvgpr_write_b32 a2, v226
    v_accvgpr_write_b32 a3, v227
    v_accvgpr_read_b32 v224, a4
    v_accvgpr_read_b32 v225, a5
    v_accvgpr_read_b32 v226, a6
    v_accvgpr_read_b32 v227, a7
    v_mul_f32 v224, v224, v53
    v_mul_f32 v225, v225, v53
    v_mul_f32 v226, v226, v53
    v_mul_f32 v227, v227, v53
    v_accvgpr_write_b32 a4, v224
    v_accvgpr_write_b32 a5, v225
    v_accvgpr_write_b32 a6, v226
    v_accvgpr_write_b32 a7, v227
    v_accvgpr_read_b32 v224, a8
    v_accvgpr_read_b32 v225, a9
    v_accvgpr_read_b32 v226, a10
    v_accvgpr_read_b32 v227, a11
    v_mul_f32 v224, v224, v54
    v_mul_f32 v225, v225, v54
    v_mul_f32 v226, v226, v54
    v_mul_f32 v227, v227, v54
    v_accvgpr_write_b32 a8, v224
    v_accvgpr_write_b32 a9, v225
    v_accvgpr_write_b32 a10, v226
    v_accvgpr_write_b32 a11, v227
    v_accvgpr_read_b32 v224, a12
    v_accvgpr_read_b32 v225, a13
    v_accvgpr_read_b32 v226, a14
    v_accvgpr_read_b32 v227, a15
    v_mul_f32 v224, v224, v55
    v_mul_f32 v225, v225, v55
    v_mul_f32 v226, v226, v55
    v_mul_f32 v227, v227, v55
    v_accvgpr_write_b32 a12, v224
    v_accvgpr_write_b32 a13, v225
    v_accvgpr_write_b32 a14, v226
    v_accvgpr_write_b32 a15, v227
    v_accvgpr_read_b32 v224, a16
    v_accvgpr_read_b32 v225, a17
    v_accvgpr_read_b32 v226, a18
    v_accvgpr_read_b32 v227, a19
    v_mul_f32 v224, v224, v52
    v_mul_f32 v225, v225, v52
    v_mul_f32 v226, v226, v52
    v_mul_f32 v227, v227, v52
    v_accvgpr_write_b32 a16, v224
    v_accvgpr_write_b32 a17, v225
    v_accvgpr_write_b32 a18, v226
    v_accvgpr_write_b32 a19, v227
    v_accvgpr_read_b32 v224, a20
    v_accvgpr_read_b32 v225, a21
    v_accvgpr_read_b32 v226, a22
    v_accvgpr_read_b32 v227, a23
    v_mul_f32 v224, v224, v53
    v_mul_f32 v225, v225, v53
    v_mul_f32 v226, v226, v53
    v_mul_f32 v227, v227, v53
    v_accvgpr_write_b32 a20, v224
    v_accvgpr_write_b32 a21, v225
    v_accvgpr_write_b32 a22, v226
    v_accvgpr_write_b32 a23, v227
    v_accvgpr_read_b32 v224, a24
    v_accvgpr_read_b32 v225, a25
    v_accvgpr_read_b32 v226, a26
    v_accvgpr_read_b32 v227, a27
    v_mul_f32 v224, v224, v54
    v_mul_f32 v225, v225, v54
    v_mul_f32 v226, v226, v54
    v_mul_f32 v227, v227, v54
    v_accvgpr_write_b32 a24, v224
    v_accvgpr_write_b32 a25, v225
    v_accvgpr_write_b32 a26, v226
    v_accvgpr_write_b32 a27, v227
    v_accvgpr_read_b32 v224, a28
    v_accvgpr_read_b32 v225, a29
    v_accvgpr_read_b32 v226, a30
    v_accvgpr_read_b32 v227, a31
    v_mul_f32 v224, v224, v55
    v_mul_f32 v225, v225, v55
    v_mul_f32 v226, v226, v55
    v_mul_f32 v227, v227, v55
    v_accvgpr_write_b32 a28, v224
    v_accvgpr_write_b32 a29, v225
    v_accvgpr_write_b32 a30, v226
    v_accvgpr_write_b32 a31, v227
    v_accvgpr_read_b32 v224, a32
    v_accvgpr_read_b32 v225, a33
    v_accvgpr_read_b32 v226, a34
    v_accvgpr_read_b32 v227, a35
    v_mul_f32 v224, v224, v52
    v_mul_f32 v225, v225, v52
    v_mul_f32 v226, v226, v52
    v_mul_f32 v227, v227, v52
    v_accvgpr_write_b32 a32, v224
    v_accvgpr_write_b32 a33, v225
    v_accvgpr_write_b32 a34, v226
    v_accvgpr_write_b32 a35, v227
    v_accvgpr_read_b32 v224, a36
    v_accvgpr_read_b32 v225, a37
    v_accvgpr_read_b32 v226, a38
    v_accvgpr_read_b32 v227, a39
    v_mul_f32 v224, v224, v53
    v_mul_f32 v225, v225, v53
    v_mul_f32 v226, v226, v53
    v_mul_f32 v227, v227, v53
    v_accvgpr_write_b32 a36, v224
    v_accvgpr_write_b32 a37, v225
    v_accvgpr_write_b32 a38, v226
    v_accvgpr_write_b32 a39, v227
    v_accvgpr_read_b32 v224, a40
    v_accvgpr_read_b32 v225, a41
    v_accvgpr_read_b32 v226, a42
    v_accvgpr_read_b32 v227, a43
    v_mul_f32 v224, v224, v54
    v_mul_f32 v225, v225, v54
    v_mul_f32 v226, v226, v54
    v_mul_f32 v227, v227, v54
    v_accvgpr_write_b32 a40, v224
    v_accvgpr_write_b32 a41, v225
    v_accvgpr_write_b32 a42, v226
    v_accvgpr_write_b32 a43, v227
    v_accvgpr_read_b32 v224, a44
    v_accvgpr_read_b32 v225, a45
    v_accvgpr_read_b32 v226, a46
    v_accvgpr_read_b32 v227, a47
    v_mul_f32 v224, v224, v55
    v_mul_f32 v225, v225, v55
    v_mul_f32 v226, v226, v55
    v_mul_f32 v227, v227, v55
    v_accvgpr_write_b32 a44, v224
    v_accvgpr_write_b32 a45, v225
    v_accvgpr_write_b32 a46, v226
    v_accvgpr_write_b32 a47, v227
    v_accvgpr_read_b32 v224, a48
    v_accvgpr_read_b32 v225, a49
    v_accvgpr_read_b32 v226, a50
    v_accvgpr_read_b32 v227, a51
    v_mul_f32 v224, v224, v52
    v_mul_f32 v225, v225, v52
    v_mul_f32 v226, v226, v52
    v_mul_f32 v227, v227, v52
    v_accvgpr_write_b32 a48, v224
    v_accvgpr_write_b32 a49, v225
    v_accvgpr_write_b32 a50, v226
    v_accvgpr_write_b32 a51, v227
    v_accvgpr_read_b32 v224, a52
    v_accvgpr_read_b32 v225, a53
    v_accvgpr_read_b32 v226, a54
    v_accvgpr_read_b32 v227, a55
    v_mul_f32 v224, v224, v53
    v_mul_f32 v225, v225, v53
    v_mul_f32 v226, v226, v53
    v_mul_f32 v227, v227, v53
    v_accvgpr_write_b32 a52, v224
    v_accvgpr_write_b32 a53, v225
    v_accvgpr_write_b32 a54, v226
    v_accvgpr_write_b32 a55, v227
    v_accvgpr_read_b32 v224, a56
    v_accvgpr_read_b32 v225, a57
    v_accvgpr_read_b32 v226, a58
    v_accvgpr_read_b32 v227, a59
    v_mul_f32 v224, v224, v54
    v_mul_f32 v225, v225, v54
    v_mul_f32 v226, v226, v54
    v_mul_f32 v227, v227, v54
    v_accvgpr_write_b32 a56, v224
    v_accvgpr_write_b32 a57, v225
    v_accvgpr_write_b32 a58, v226
    v_accvgpr_write_b32 a59, v227
    v_accvgpr_read_b32 v224, a60
    v_accvgpr_read_b32 v225, a61
    v_accvgpr_read_b32 v226, a62
    v_accvgpr_read_b32 v227, a63
    v_mul_f32 v224, v224, v55
    v_mul_f32 v225, v225, v55
    v_mul_f32 v226, v226, v55
    v_mul_f32 v227, v227, v55
    v_accvgpr_write_b32 a60, v224
    v_accvgpr_write_b32 a61, v225
    v_accvgpr_write_b32 a62, v226
    v_accvgpr_write_b32 a63, v227
    v_accvgpr_read_b32 v224, a64
    v_accvgpr_read_b32 v225, a65
    v_accvgpr_read_b32 v226, a66
    v_accvgpr_read_b32 v227, a67
    v_mul_f32 v224, v224, v52
    v_mul_f32 v225, v225, v52
    v_mul_f32 v226, v226, v52
    v_mul_f32 v227, v227, v52
    v_accvgpr_write_b32 a64, v224
    v_accvgpr_write_b32 a65, v225
    v_accvgpr_write_b32 a66, v226
    v_accvgpr_write_b32 a67, v227
    v_accvgpr_read_b32 v224, a68
    v_accvgpr_read_b32 v225, a69
    v_accvgpr_read_b32 v226, a70
    v_accvgpr_read_b32 v227, a71
    v_mul_f32 v224, v224, v53
    v_mul_f32 v225, v225, v53
    v_mul_f32 v226, v226, v53
    v_mul_f32 v227, v227, v53
    v_accvgpr_write_b32 a68, v224
    v_accvgpr_write_b32 a69, v225
    v_accvgpr_write_b32 a70, v226
    v_accvgpr_write_b32 a71, v227
    v_accvgpr_read_b32 v224, a72
    v_accvgpr_read_b32 v225, a73
    v_accvgpr_read_b32 v226, a74
    v_accvgpr_read_b32 v227, a75
    v_mul_f32 v224, v224, v54
    v_mul_f32 v225, v225, v54
    v_mul_f32 v226, v226, v54
    v_mul_f32 v227, v227, v54
    v_accvgpr_write_b32 a72, v224
    v_accvgpr_write_b32 a73, v225
    v_accvgpr_write_b32 a74, v226
    v_accvgpr_write_b32 a75, v227
    v_accvgpr_read_b32 v224, a76
    v_accvgpr_read_b32 v225, a77
    v_accvgpr_read_b32 v226, a78
    v_accvgpr_read_b32 v227, a79
    v_mul_f32 v224, v224, v55
    v_mul_f32 v225, v225, v55
    v_mul_f32 v226, v226, v55
    v_mul_f32 v227, v227, v55
    v_accvgpr_write_b32 a76, v224
    v_accvgpr_write_b32 a77, v225
    v_accvgpr_write_b32 a78, v226
    v_accvgpr_write_b32 a79, v227
    v_accvgpr_read_b32 v224, a80
    v_accvgpr_read_b32 v225, a81
    v_accvgpr_read_b32 v226, a82
    v_accvgpr_read_b32 v227, a83
    v_mul_f32 v224, v224, v52
    v_mul_f32 v225, v225, v52
    v_mul_f32 v226, v226, v52
    v_mul_f32 v227, v227, v52
    v_accvgpr_write_b32 a80, v224
    v_accvgpr_write_b32 a81, v225
    v_accvgpr_write_b32 a82, v226
    v_accvgpr_write_b32 a83, v227
    v_accvgpr_read_b32 v224, a84
    v_accvgpr_read_b32 v225, a85
    v_accvgpr_read_b32 v226, a86
    v_accvgpr_read_b32 v227, a87
    v_mul_f32 v224, v224, v53
    v_mul_f32 v225, v225, v53
    v_mul_f32 v226, v226, v53
    v_mul_f32 v227, v227, v53
    v_accvgpr_write_b32 a84, v224
    v_accvgpr_write_b32 a85, v225
    v_accvgpr_write_b32 a86, v226
    v_accvgpr_write_b32 a87, v227
    v_accvgpr_read_b32 v224, a88
    v_accvgpr_read_b32 v225, a89
    v_accvgpr_read_b32 v226, a90
    v_accvgpr_read_b32 v227, a91
    v_mul_f32 v224, v224, v54
    v_mul_f32 v225, v225, v54
    v_mul_f32 v226, v226, v54
    v_mul_f32 v227, v227, v54
    v_accvgpr_write_b32 a88, v224
    v_accvgpr_write_b32 a89, v225
    v_accvgpr_write_b32 a90, v226
    v_accvgpr_write_b32 a91, v227
    v_accvgpr_read_b32 v224, a92
    v_accvgpr_read_b32 v225, a93
    v_accvgpr_read_b32 v226, a94
    v_accvgpr_read_b32 v227, a95
    v_mul_f32 v224, v224, v55
    v_mul_f32 v225, v225, v55
    v_mul_f32 v226, v226, v55
    v_mul_f32 v227, v227, v55
    v_accvgpr_write_b32 a92, v224
    v_accvgpr_write_b32 a93, v225
    v_accvgpr_write_b32 a94, v226
    v_accvgpr_write_b32 a95, v227
    v_accvgpr_read_b32 v224, a96
    v_accvgpr_read_b32 v225, a97
    v_accvgpr_read_b32 v226, a98
    v_accvgpr_read_b32 v227, a99
    v_mul_f32 v224, v224, v52
    v_mul_f32 v225, v225, v52
    v_mul_f32 v226, v226, v52
    v_mul_f32 v227, v227, v52
    v_accvgpr_write_b32 a96, v224
    v_accvgpr_write_b32 a97, v225
    v_accvgpr_write_b32 a98, v226
    v_accvgpr_write_b32 a99, v227
    v_accvgpr_read_b32 v224, a100
    v_accvgpr_read_b32 v225, a101
    v_accvgpr_read_b32 v226, a102
    v_accvgpr_read_b32 v227, a103
    v_mul_f32 v224, v224, v53
    v_mul_f32 v225, v225, v53
    v_mul_f32 v226, v226, v53
    v_mul_f32 v227, v227, v53
    v_accvgpr_write_b32 a100, v224
    v_accvgpr_write_b32 a101, v225
    v_accvgpr_write_b32 a102, v226
    v_accvgpr_write_b32 a103, v227
    v_accvgpr_read_b32 v224, a104
    v_accvgpr_read_b32 v225, a105
    v_accvgpr_read_b32 v226, a106
    v_accvgpr_read_b32 v227, a107
    v_mul_f32 v224, v224, v54
    v_mul_f32 v225, v225, v54
    v_mul_f32 v226, v226, v54
    v_mul_f32 v227, v227, v54
    v_accvgpr_write_b32 a104, v224
    v_accvgpr_write_b32 a105, v225
    v_accvgpr_write_b32 a106, v226
    v_accvgpr_write_b32 a107, v227
    v_accvgpr_read_b32 v224, a108
    v_accvgpr_read_b32 v225, a109
    v_accvgpr_read_b32 v226, a110
    v_accvgpr_read_b32 v227, a111
    v_mul_f32 v224, v224, v55
    v_mul_f32 v225, v225, v55
    v_mul_f32 v226, v226, v55
    v_mul_f32 v227, v227, v55
    v_accvgpr_write_b32 a108, v224
    v_accvgpr_write_b32 a109, v225
    v_accvgpr_write_b32 a110, v226
    v_accvgpr_write_b32 a111, v227
    v_accvgpr_read_b32 v224, a112
    v_accvgpr_read_b32 v225, a113
    v_accvgpr_read_b32 v226, a114
    v_accvgpr_read_b32 v227, a115
    v_mul_f32 v224, v224, v52
    v_mul_f32 v225, v225, v52
    v_mul_f32 v226, v226, v52
    v_mul_f32 v227, v227, v52
    v_accvgpr_write_b32 a112, v224
    v_accvgpr_write_b32 a113, v225
    v_accvgpr_write_b32 a114, v226
    v_accvgpr_write_b32 a115, v227
    v_accvgpr_read_b32 v224, a116
    v_accvgpr_read_b32 v225, a117
    v_accvgpr_read_b32 v226, a118
    v_accvgpr_read_b32 v227, a119
    v_mul_f32 v224, v224, v53
    v_mul_f32 v225, v225, v53
    v_mul_f32 v226, v226, v53
    v_mul_f32 v227, v227, v53
    v_accvgpr_write_b32 a116, v224
    v_accvgpr_write_b32 a117, v225
    v_accvgpr_write_b32 a118, v226
    v_accvgpr_write_b32 a119, v227
    v_accvgpr_read_b32 v224, a120
    v_accvgpr_read_b32 v225, a121
    v_accvgpr_read_b32 v226, a122
    v_accvgpr_read_b32 v227, a123
    v_mul_f32 v224, v224, v54
    v_mul_f32 v225, v225, v54
    v_mul_f32 v226, v226, v54
    v_mul_f32 v227, v227, v54
    v_accvgpr_write_b32 a120, v224
    v_accvgpr_write_b32 a121, v225
    v_accvgpr_write_b32 a122, v226
    v_accvgpr_write_b32 a123, v227
    v_accvgpr_read_b32 v224, a124
    v_accvgpr_read_b32 v225, a125
    v_accvgpr_read_b32 v226, a126
    v_accvgpr_read_b32 v227, a127
    v_mul_f32 v224, v224, v55
    v_mul_f32 v225, v225, v55
    v_mul_f32 v226, v226, v55
    v_mul_f32 v227, v227, v55
    v_accvgpr_write_b32 a124, v224
    v_accvgpr_write_b32 a125, v225
    v_accvgpr_write_b32 a126, v226
    v_accvgpr_write_b32 a127, v227
    v_exp_f32 v232, v128
    v_exp_f32 v233, v129
    v_exp_f32 v234, v130
    v_exp_f32 v235, v131
    v_add_f32 v48, v232, v233
    v_cvt_pk_bf16_f32 v192, v232, v233
    v_exp_f32 v236, v144
    v_exp_f32 v237, v145
    v_add_f32 v48, v48, v234
    v_add_f32 v48, v48, v235
    v_cvt_pk_bf16_f32 v193, v234, v235
    v_exp_f32 v238, v146
    v_exp_f32 v239, v147
    v_add_f32 v48, v48, v236
    v_add_f32 v48, v48, v237
    v_cvt_pk_bf16_f32 v194, v236, v237
    v_exp_f32 v240, v132
    v_exp_f32 v241, v133
    v_add_f32 v48, v48, v238
    v_add_f32 v48, v48, v239
    v_cvt_pk_bf16_f32 v195, v238, v239
    v_exp_f32 v242, v134
    v_exp_f32 v243, v135
    v_add_f32 v49, v240, v241
    v_cvt_pk_bf16_f32 v196, v240, v241
    v_exp_f32 v244, v148
    v_exp_f32 v245, v149
    v_add_f32 v49, v49, v242
    v_add_f32 v49, v49, v243
    v_cvt_pk_bf16_f32 v197, v242, v243
    v_exp_f32 v246, v150
    v_exp_f32 v247, v151
    v_add_f32 v49, v49, v244
    v_add_f32 v49, v49, v245
    v_cvt_pk_bf16_f32 v198, v244, v245
    v_exp_f32 v232, v136
    v_exp_f32 v233, v137
    v_add_f32 v49, v49, v246
    v_add_f32 v49, v49, v247
    v_cvt_pk_bf16_f32 v199, v246, v247
    v_exp_f32 v234, v138
    v_exp_f32 v235, v139
    v_add_f32 v50, v232, v233
    v_cvt_pk_bf16_f32 v200, v232, v233
    v_exp_f32 v236, v152
    v_exp_f32 v237, v153
    v_add_f32 v50, v50, v234
    v_add_f32 v50, v50, v235
    v_cvt_pk_bf16_f32 v201, v234, v235
    v_exp_f32 v238, v154
    v_exp_f32 v239, v155
    v_add_f32 v50, v50, v236
    v_add_f32 v50, v50, v237
    v_cvt_pk_bf16_f32 v202, v236, v237
    v_exp_f32 v240, v140
    v_exp_f32 v241, v141
    v_add_f32 v50, v50, v238
    v_add_f32 v50, v50, v239
    v_cvt_pk_bf16_f32 v203, v238, v239
    v_exp_f32 v242, v142
    v_exp_f32 v243, v143
    v_add_f32 v51, v240, v241
    v_cvt_pk_bf16_f32 v204, v240, v241
    v_exp_f32 v244, v156
    v_exp_f32 v245, v157
    v_add_f32 v51, v51, v242
    v_add_f32 v51, v51, v243
    v_cvt_pk_bf16_f32 v205, v242, v243
    v_exp_f32 v246, v158
    v_exp_f32 v247, v159
    v_add_f32 v51, v51, v244
    v_add_f32 v51, v51, v245
    v_cvt_pk_bf16_f32 v206, v244, v245
    s_nop 0
    v_add_f32 v51, v51, v246
    v_add_f32 v51, v51, v247
    v_cvt_pk_bf16_f32 v207, v246, v247
    s_nop 1
    s_branch k2_ret_55
k2_rare_58:
    s_nop 7
    v_max_f32 v52, v160, v161
    v_max3_f32 v52, v52, v162, v163
    v_max3_f32 v52, v52, v176, v177
    v_max3_f32 v52, v52, v178, v179
    v_mov_b32 v6, v52
    s_nop 1
    v_permlane16_swap_b32 v52, v6
    s_nop 1
    v_max_f32 v52, v52, v6
    v_mov_b32 v6, v52
    s_nop 1
    v_permlane32_swap_b32 v52, v6
    s_nop 1
    v_max_f32 v52, v52, v6
    v_max_f32 v52, 0, v52
    v_max_f32 v53, v164, v165
    v_max3_f32 v53, v53, v166, v167
    v_max3_f32 v53, v53, v180, v181
    v_max3_f32 v53, v53, v182, v183
    v_mov_b32 v6, v53
    s_nop 1
    v_permlane16_swap_b32 v53, v6
    s_nop 1
    v_max_f32 v53, v53, v6
    v_mov_b32 v6, v53
    s_nop 1
    v_permlane32_swap_b32 v53, v6
    s_nop 1
    v_max_f32 v53, v53, v6
    v_max_f32 v53, 0, v53
    v_max_f32 v54, v168, v169
    v_max3_f32 v54, v54, v170, v171
    v_max3_f32 v54, v54, v184, v185
    v_max3_f32 v54, v54, v186, v187
    v_mov_b32 v6, v54
    s_nop 1
    v_permlane16_swap_b32 v54, v6
    s_nop 1
    v_max_f32 v54, v54, v6
    v_mov_b32 v6, v54
    s_nop 1
    v_permlane32_swap_b32 v54, v6
    s_nop 1
    v_max_f32 v54, v54, v6
    v_max_f32 v54, 0, v54
    v_max_f32 v55, v172, v173
    v_max3_f32 v55, v55, v174, v175
    v_max3_f32 v55, v55, v188, v189
    v_max3_f32 v55, v55, v190, v191
    v_mov_b32 v6, v55
    s_nop 1
    v_permlane16_swap_b32 v55, v6
    s_nop 1
    v_max_f32 v55, v55, v6
    v_mov_b32 v6, v55
    s_nop 1
    v_permlane32_swap_b32 v55, v6
    s_nop 1
    v_max_f32 v55, v55, v6
    v_max_f32 v55, 0, v55
    v_sub_f32 v160, v160, v52
    v_sub_f32 v161, v161, v52
    v_sub_f32 v162, v162, v52
    v_sub_f32 v163, v163, v52
    v_sub_f32 v164, v164, v53
    v_sub_f32 v165, v165, v53
    v_sub_f32 v166, v166, v53
    v_sub_f32 v167, v167, v53
    v_sub_f32 v168, v168, v54
    v_sub_f32 v169, v169, v54
    v_sub_f32 v170, v170, v54
    v_sub_f32 v171, v171, v54
    v_sub_f32 v172, v172, v55
    v_sub_f32 v173, v173, v55
    v_sub_f32 v174, v174, v55
    v_sub_f32 v175, v175, v55
    v_sub_f32 v176, v176, v52
    v_sub_f32 v177, v177, v52
    v_sub_f32 v178, v178, v52
    v_sub_f32 v179, v179, v52
    v_sub_f32 v180, v180, v53
    v_sub_f32 v181, v181, v53
    v_sub_f32 v182, v182, v53
    v_sub_f32 v183, v183, v53
    v_sub_f32 v184, v184, v54
    v_sub_f32 v185, v185, v54
    v_sub_f32 v186, v186, v54
    v_sub_f32 v187, v187, v54
    v_sub_f32 v188, v188, v55
    v_sub_f32 v189, v189, v55
    v_sub_f32 v190, v190, v55
    v_sub_f32 v191, v191, v55
    v_sub_f32 v128, v128, v54
    v_sub_f32 v16, v16, v54
    v_sub_f32 v129, v129, v54
    v_sub_f32 v17, v17, v54
    v_sub_f32 v130, v130, v54
    v_sub_f32 v18, v18, v54
    v_sub_f32 v131, v131, v54
    v_sub_f32 v19, v19, v54
    v_sub_f32 v132, v132, v55
    v_sub_f32 v20, v20, v55
    v_sub_f32 v133, v133, v55
    v_sub_f32 v21, v21, v55
    v_sub_f32 v134, v134, v55
    v_sub_f32 v22, v22, v55
    v_sub_f32 v135, v135, v55
    v_sub_f32 v23, v23, v55
    v_sub_f32 v136, v136, v54
    v_sub_f32 v24, v24, v54
    v_sub_f32 v137, v137, v54
    v_sub_f32 v25, v25, v54
    v_sub_f32 v138, v138, v54
    v_sub_f32 v26, v26, v54
    v_sub_f32 v139, v139, v54
    v_sub_f32 v27, v27, v54
    v_sub_f32 v140, v140, v55
    v_sub_f32 v28, v28, v55
    v_sub_f32 v141, v141, v55
    v_sub_f32 v29, v29, v55
    v_sub_f32 v142, v142, v55
    v_sub_f32 v30, v30, v55
    v_sub_f32 v143, v143, v55
    v_sub_f32 v31, v31, v55
    v_sub_f32 v144, v144, v54
    v_sub_f32 v32, v32, v54
    v_sub_f32 v145, v145, v54
    v_sub_f32 v33, v33, v54
    v_sub_f32 v146, v146, v54
    v_sub_f32 v34, v34, v54
    v_sub_f32 v147, v147, v54
    v_sub_f32 v35, v35, v54
    v_sub_f32 v148, v148, v55
    v_sub_f32 v36, v36, v55
    v_sub_f32 v149, v149, v55
    v_sub_f32 v37, v37, v55
    v_sub_f32 v150, v150, v55
    v_sub_f32 v38, v38, v55
    v_sub_f32 v151, v151, v55
    v_sub_f32 v39, v39, v55
    v_sub_f32 v152, v152, v54
    v_sub_f32 v40, v40, v54
    v_sub_f32 v153, v153, v54
    v_sub_f32 v41, v41, v54
    v_sub_f32 v154, v154, v54
    v_sub_f32 v42, v42, v54
    v_sub_f32 v155, v155, v54
    v_sub_f32 v43, v43, v54
    v_sub_f32 v156, v156, v55
    v_sub_f32 v44, v44, v55
    v_sub_f32 v157, v157, v55
    v_sub_f32 v45, v45, v55
    v_sub_f32 v158, v158, v55
    v_sub_f32 v46, v46, v55
    v_sub_f32 v159, v159, v55
    v_sub_f32 v47, v47, v55
    v_sub_f32 v8, v8, v52
    v_exp_f32 v52, -v52
    v_sub_f32 v9, v9, v53
    v_exp_f32 v53, -v53
    v_sub_f32 v10, v10, v54
    v_exp_f32 v54, -v54
    v_sub_f32 v11, v11, v55
    v_exp_f32 v55, -v55
    s_nop 0
    v_mul_f32 v12, v12, v52
    v_mul_f32 v13, v13, v53
    v_mul_f32 v14, v14, v54
    v_mul_f32 v15, v15, v55
    v_accvgpr_read_b32 v224, a0
    v_accvgpr_read_b32 v225, a1
    v_accvgpr_read_b32 v226, a2
    v_accvgpr_read_b32 v227, a3
    v_mul_f32 v224, v224, v52
    v_mul_f32 v225, v225, v52
    v_mul_f32 v226, v226, v52
    v_mul_f32 v227, v227, v52
    v_accvgpr_write_b32 a0, v224
    v_accvgpr_write_b32 a1, v225
    v_accvgpr_write_b32 a2, v226
    v_accvgpr_write_b32 a3, v227
    v_accvgpr_read_b32 v224, a4
    v_accvgpr_read_b32 v225, a5
    v_accvgpr_read_b32 v226, a6
    v_accvgpr_read_b32 v227, a7
    v_mul_f32 v224, v224, v53
    v_mul_f32 v225, v225, v53
    v_mul_f32 v226, v226, v53
    v_mul_f32 v227, v227, v53
    v_accvgpr_write_b32 a4, v224
    v_accvgpr_write_b32 a5, v225
    v_accvgpr_write_b32 a6, v226
    v_accvgpr_write_b32 a7, v227
    v_accvgpr_read_b32 v224, a8
    v_accvgpr_read_b32 v225, a9
    v_accvgpr_read_b32 v226, a10
    v_accvgpr_read_b32 v227, a11
    v_mul_f32 v224, v224, v54
    v_mul_f32 v225, v225, v54
    v_mul_f32 v226, v226, v54
    v_mul_f32 v227, v227, v54
    v_accvgpr_write_b32 a8, v224
    v_accvgpr_write_b32 a9, v225
    v_accvgpr_write_b32 a10, v226
    v_accvgpr_write_b32 a11, v227
    v_accvgpr_read_b32 v224, a12
    v_accvgpr_read_b32 v225, a13
    v_accvgpr_read_b32 v226, a14
    v_accvgpr_read_b32 v227, a15
    v_mul_f32 v224, v224, v55
    v_mul_f32 v225, v225, v55
    v_mul_f32 v226, v226, v55
    v_mul_f32 v227, v227, v55
    v_accvgpr_write_b32 a12, v224
    v_accvgpr_write_b32 a13, v225
    v_accvgpr_write_b32 a14, v226
    v_accvgpr_write_b32 a15, v227
    v_accvgpr_read_b32 v224, a16
    v_accvgpr_read_b32 v225, a17
    v_accvgpr_read_b32 v226, a18
    v_accvgpr_read_b32 v227, a19
    v_mul_f32 v224, v224, v52
    v_mul_f32 v225, v225, v52
    v_mul_f32 v226, v226, v52
    v_mul_f32 v227, v227, v52
    v_accvgpr_write_b32 a16, v224
    v_accvgpr_write_b32 a17, v225
    v_accvgpr_write_b32 a18, v226
    v_accvgpr_write_b32 a19, v227
    v_accvgpr_read_b32 v224, a20
    v_accvgpr_read_b32 v225, a21
    v_accvgpr_read_b32 v226, a22
    v_accvgpr_read_b32 v227, a23
    v_mul_f32 v224, v224, v53
    v_mul_f32 v225, v225, v53
    v_mul_f32 v226, v226, v53
    v_mul_f32 v227, v227, v53
    v_accvgpr_write_b32 a20, v224
    v_accvgpr_write_b32 a21, v225
    v_accvgpr_write_b32 a22, v226
    v_accvgpr_write_b32 a23, v227
    v_accvgpr_read_b32 v224, a24
    v_accvgpr_read_b32 v225, a25
    v_accvgpr_read_b32 v226, a26
    v_accvgpr_read_b32 v227, a27
    v_mul_f32 v224, v224, v54
    v_mul_f32 v225, v225, v54
    v_mul_f32 v226, v226, v54
    v_mul_f32 v227, v227, v54
    v_accvgpr_write_b32 a24, v224
    v_accvgpr_write_b32 a25, v225
    v_accvgpr_write_b32 a26, v226
    v_accvgpr_write_b32 a27, v227
    v_accvgpr_read_b32 v224, a28
    v_accvgpr_read_b32 v225, a29
    v_accvgpr_read_b32 v226, a30
    v_accvgpr_read_b32 v227, a31
    v_mul_f32 v224, v224, v55
    v_mul_f32 v225, v225, v55
    v_mul_f32 v226, v226, v55
    v_mul_f32 v227, v227, v55
    v_accvgpr_write_b32 a28, v224
    v_accvgpr_write_b32 a29, v225
    v_accvgpr_write_b32 a30, v226
    v_accvgpr_write_b32 a31, v227
    v_accvgpr_read_b32 v224, a32
    v_accvgpr_read_b32 v225, a33
    v_accvgpr_read_b32 v226, a34
    v_accvgpr_read_b32 v227, a35
    v_mul_f32 v224, v224, v52
    v_mul_f32 v225, v225, v52
    v_mul_f32 v226, v226, v52
    v_mul_f32 v227, v227, v52
    v_accvgpr_write_b32 a32, v224
    v_accvgpr_write_b32 a33, v225
    v_accvgpr_write_b32 a34, v226
    v_accvgpr_write_b32 a35, v227
    v_accvgpr_read_b32 v224, a36
    v_accvgpr_read_b32 v225, a37
    v_accvgpr_read_b32 v226, a38
    v_accvgpr_read_b32 v227, a39
    v_mul_f32 v224, v224, v53
    v_mul_f32 v225, v225, v53
    v_mul_f32 v226, v226, v53
    v_mul_f32 v227, v227, v53
    v_accvgpr_write_b32 a36, v224
    v_accvgpr_write_b32 a37, v225
    v_accvgpr_write_b32 a38, v226
    v_accvgpr_write_b32 a39, v227
    v_accvgpr_read_b32 v224, a40
    v_accvgpr_read_b32 v225, a41
    v_accvgpr_read_b32 v226, a42
    v_accvgpr_read_b32 v227, a43
    v_mul_f32 v224, v224, v54
    v_mul_f32 v225, v225, v54
    v_mul_f32 v226, v226, v54
    v_mul_f32 v227, v227, v54
    v_accvgpr_write_b32 a40, v224
    v_accvgpr_write_b32 a41, v225
    v_accvgpr_write_b32 a42, v226
    v_accvgpr_write_b32 a43, v227
    v_accvgpr_read_b32 v224, a44
    v_accvgpr_read_b32 v225, a45
    v_accvgpr_read_b32 v226, a46
    v_accvgpr_read_b32 v227, a47
    v_mul_f32 v224, v224, v55
    v_mul_f32 v225, v225, v55
    v_mul_f32 v226, v226, v55
    v_mul_f32 v227, v227, v55
    v_accvgpr_write_b32 a44, v224
    v_accvgpr_write_b32 a45, v225
    v_accvgpr_write_b32 a46, v226
    v_accvgpr_write_b32 a47, v227
    v_accvgpr_read_b32 v224, a48
    v_accvgpr_read_b32 v225, a49
    v_accvgpr_read_b32 v226, a50
    v_accvgpr_read_b32 v227, a51
    v_mul_f32 v224, v224, v52
    v_mul_f32 v225, v225, v52
    v_mul_f32 v226, v226, v52
    v_mul_f32 v227, v227, v52
    v_accvgpr_write_b32 a48, v224
    v_accvgpr_write_b32 a49, v225
    v_accvgpr_write_b32 a50, v226
    v_accvgpr_write_b32 a51, v227
    v_accvgpr_read_b32 v224, a52
    v_accvgpr_read_b32 v225, a53
    v_accvgpr_read_b32 v226, a54
    v_accvgpr_read_b32 v227, a55
    v_mul_f32 v224, v224, v53
    v_mul_f32 v225, v225, v53
    v_mul_f32 v226, v226, v53
    v_mul_f32 v227, v227, v53
    v_accvgpr_write_b32 a52, v224
    v_accvgpr_write_b32 a53, v225
    v_accvgpr_write_b32 a54, v226
    v_accvgpr_write_b32 a55, v227
    v_accvgpr_read_b32 v224, a56
    v_accvgpr_read_b32 v225, a57
    v_accvgpr_read_b32 v226, a58
    v_accvgpr_read_b32 v227, a59
    v_mul_f32 v224, v224, v54
    v_mul_f32 v225, v225, v54
    v_mul_f32 v226, v226, v54
    v_mul_f32 v227, v227, v54
    v_accvgpr_write_b32 a56, v224
    v_accvgpr_write_b32 a57, v225
    v_accvgpr_write_b32 a58, v226
    v_accvgpr_write_b32 a59, v227
    v_accvgpr_read_b32 v224, a60
    v_accvgpr_read_b32 v225, a61
    v_accvgpr_read_b32 v226, a62
    v_accvgpr_read_b32 v227, a63
    v_mul_f32 v224, v224, v55
    v_mul_f32 v225, v225, v55
    v_mul_f32 v226, v226, v55
    v_mul_f32 v227, v227, v55
    v_accvgpr_write_b32 a60, v224
    v_accvgpr_write_b32 a61, v225
    v_accvgpr_write_b32 a62, v226
    v_accvgpr_write_b32 a63, v227
    v_accvgpr_read_b32 v224, a64
    v_accvgpr_read_b32 v225, a65
    v_accvgpr_read_b32 v226, a66
    v_accvgpr_read_b32 v227, a67
    v_mul_f32 v224, v224, v52
    v_mul_f32 v225, v225, v52
    v_mul_f32 v226, v226, v52
    v_mul_f32 v227, v227, v52
    v_accvgpr_write_b32 a64, v224
    v_accvgpr_write_b32 a65, v225
    v_accvgpr_write_b32 a66, v226
    v_accvgpr_write_b32 a67, v227
    v_accvgpr_read_b32 v224, a68
    v_accvgpr_read_b32 v225, a69
    v_accvgpr_read_b32 v226, a70
    v_accvgpr_read_b32 v227, a71
    v_mul_f32 v224, v224, v53
    v_mul_f32 v225, v225, v53
    v_mul_f32 v226, v226, v53
    v_mul_f32 v227, v227, v53
    v_accvgpr_write_b32 a68, v224
    v_accvgpr_write_b32 a69, v225
    v_accvgpr_write_b32 a70, v226
    v_accvgpr_write_b32 a71, v227
    v_accvgpr_read_b32 v224, a72
    v_accvgpr_read_b32 v225, a73
    v_accvgpr_read_b32 v226, a74
    v_accvgpr_read_b32 v227, a75
    v_mul_f32 v224, v224, v54
    v_mul_f32 v225, v225, v54
    v_mul_f32 v226, v226, v54
    v_mul_f32 v227, v227, v54
    v_accvgpr_write_b32 a72, v224
    v_accvgpr_write_b32 a73, v225
    v_accvgpr_write_b32 a74, v226
    v_accvgpr_write_b32 a75, v227
    v_accvgpr_read_b32 v224, a76
    v_accvgpr_read_b32 v225, a77
    v_accvgpr_read_b32 v226, a78
    v_accvgpr_read_b32 v227, a79
    v_mul_f32 v224, v224, v55
    v_mul_f32 v225, v225, v55
    v_mul_f32 v226, v226, v55
    v_mul_f32 v227, v227, v55
    v_accvgpr_write_b32 a76, v224
    v_accvgpr_write_b32 a77, v225
    v_accvgpr_write_b32 a78, v226
    v_accvgpr_write_b32 a79, v227
    v_accvgpr_read_b32 v224, a80
    v_accvgpr_read_b32 v225, a81
    v_accvgpr_read_b32 v226, a82
    v_accvgpr_read_b32 v227, a83
    v_mul_f32 v224, v224, v52
    v_mul_f32 v225, v225, v52
    v_mul_f32 v226, v226, v52
    v_mul_f32 v227, v227, v52
    v_accvgpr_write_b32 a80, v224
    v_accvgpr_write_b32 a81, v225
    v_accvgpr_write_b32 a82, v226
    v_accvgpr_write_b32 a83, v227
    v_accvgpr_read_b32 v224, a84
    v_accvgpr_read_b32 v225, a85
    v_accvgpr_read_b32 v226, a86
    v_accvgpr_read_b32 v227, a87
    v_mul_f32 v224, v224, v53
    v_mul_f32 v225, v225, v53
    v_mul_f32 v226, v226, v53
    v_mul_f32 v227, v227, v53
    v_accvgpr_write_b32 a84, v224
    v_accvgpr_write_b32 a85, v225
    v_accvgpr_write_b32 a86, v226
    v_accvgpr_write_b32 a87, v227
    v_accvgpr_read_b32 v224, a88
    v_accvgpr_read_b32 v225, a89
    v_accvgpr_read_b32 v226, a90
    v_accvgpr_read_b32 v227, a91
    v_mul_f32 v224, v224, v54
    v_mul_f32 v225, v225, v54
    v_mul_f32 v226, v226, v54
    v_mul_f32 v227, v227, v54
    v_accvgpr_write_b32 a88, v224
    v_accvgpr_write_b32 a89, v225
    v_accvgpr_write_b32 a90, v226
    v_accvgpr_write_b32 a91, v227
    v_accvgpr_read_b32 v224, a92
    v_accvgpr_read_b32 v225, a93
    v_accvgpr_read_b32 v226, a94
    v_accvgpr_read_b32 v227, a95
    v_mul_f32 v224, v224, v55
    v_mul_f32 v225, v225, v55
    v_mul_f32 v226, v226, v55
    v_mul_f32 v227, v227, v55
    v_accvgpr_write_b32 a92, v224
    v_accvgpr_write_b32 a93, v225
    v_accvgpr_write_b32 a94, v226
    v_accvgpr_write_b32 a95, v227
    v_accvgpr_read_b32 v224, a96
    v_accvgpr_read_b32 v225, a97
    v_accvgpr_read_b32 v226, a98
    v_accvgpr_read_b32 v227, a99
    v_mul_f32 v224, v224, v52
    v_mul_f32 v225, v225, v52
    v_mul_f32 v226, v226, v52
    v_mul_f32 v227, v227, v52
    v_accvgpr_write_b32 a96, v224
    v_accvgpr_write_b32 a97, v225
    v_accvgpr_write_b32 a98, v226
    v_accvgpr_write_b32 a99, v227
    v_accvgpr_read_b32 v224, a100
    v_accvgpr_read_b32 v225, a101
    v_accvgpr_read_b32 v226, a102
    v_accvgpr_read_b32 v227, a103
    v_mul_f32 v224, v224, v53
    v_mul_f32 v225, v225, v53
    v_mul_f32 v226, v226, v53
    v_mul_f32 v227, v227, v53
    v_accvgpr_write_b32 a100, v224
    v_accvgpr_write_b32 a101, v225
    v_accvgpr_write_b32 a102, v226
    v_accvgpr_write_b32 a103, v227
    v_accvgpr_read_b32 v224, a104
    v_accvgpr_read_b32 v225, a105
    v_accvgpr_read_b32 v226, a106
    v_accvgpr_read_b32 v227, a107
    v_mul_f32 v224, v224, v54
    v_mul_f32 v225, v225, v54
    v_mul_f32 v226, v226, v54
    v_mul_f32 v227, v227, v54
    v_accvgpr_write_b32 a104, v224
    v_accvgpr_write_b32 a105, v225
    v_accvgpr_write_b32 a106, v226
    v_accvgpr_write_b32 a107, v227
    v_accvgpr_read_b32 v224, a108
    v_accvgpr_read_b32 v225, a109
    v_accvgpr_read_b32 v226, a110
    v_accvgpr_read_b32 v227, a111
    v_mul_f32 v224, v224, v55
    v_mul_f32 v225, v225, v55
    v_mul_f32 v226, v226, v55
    v_mul_f32 v227, v227, v55
    v_accvgpr_write_b32 a108, v224
    v_accvgpr_write_b32 a109, v225
    v_accvgpr_write_b32 a110, v226
    v_accvgpr_write_b32 a111, v227
    v_accvgpr_read_b32 v224, a112
    v_accvgpr_read_b32 v225, a113
    v_accvgpr_read_b32 v226, a114
    v_accvgpr_read_b32 v227, a115
    v_mul_f32 v224, v224, v52
    v_mul_f32 v225, v225, v52
    v_mul_f32 v226, v226, v52
    v_mul_f32 v227, v227, v52
    v_accvgpr_write_b32 a112, v224
    v_accvgpr_write_b32 a113, v225
    v_accvgpr_write_b32 a114, v226
    v_accvgpr_write_b32 a115, v227
    v_accvgpr_read_b32 v224, a116
    v_accvgpr_read_b32 v225, a117
    v_accvgpr_read_b32 v226, a118
    v_accvgpr_read_b32 v227, a119
    v_mul_f32 v224, v224, v53
    v_mul_f32 v225, v225, v53
    v_mul_f32 v226, v226, v53
    v_mul_f32 v227, v227, v53
    v_accvgpr_write_b32 a116, v224
    v_accvgpr_write_b32 a117, v225
    v_accvgpr_write_b32 a118, v226
    v_accvgpr_write_b32 a119, v227
    v_accvgpr_read_b32 v224, a120
    v_accvgpr_read_b32 v225, a121
    v_accvgpr_read_b32 v226, a122
    v_accvgpr_read_b32 v227, a123
    v_mul_f32 v224, v224, v54
    v_mul_f32 v225, v225, v54
    v_mul_f32 v226, v226, v54
    v_mul_f32 v227, v227, v54
    v_accvgpr_write_b32 a120, v224
    v_accvgpr_write_b32 a121, v225
    v_accvgpr_write_b32 a122, v226
    v_accvgpr_write_b32 a123, v227
    v_accvgpr_read_b32 v224, a124
    v_accvgpr_read_b32 v225, a125
    v_accvgpr_read_b32 v226, a126
    v_accvgpr_read_b32 v227, a127
    v_mul_f32 v224, v224, v55
    v_mul_f32 v225, v225, v55
    v_mul_f32 v226, v226, v55
    v_mul_f32 v227, v227, v55
    v_accvgpr_write_b32 a124, v224
    v_accvgpr_write_b32 a125, v225
    v_accvgpr_write_b32 a126, v226
    v_accvgpr_write_b32 a127, v227
    v_exp_f32 v232, v160
    v_exp_f32 v233, v161
    v_exp_f32 v234, v162
    v_exp_f32 v235, v163
    v_add_f32 v48, v232, v233
    v_cvt_pk_bf16_f32 v208, v232, v233
    v_exp_f32 v236, v176
    v_exp_f32 v237, v177
    v_add_f32 v48, v48, v234
    v_add_f32 v48, v48, v235
    v_cvt_pk_bf16_f32 v209, v234, v235
    v_exp_f32 v238, v178
    v_exp_f32 v239, v179
    v_add_f32 v48, v48, v236
    v_add_f32 v48, v48, v237
    v_cvt_pk_bf16_f32 v210, v236, v237
    v_exp_f32 v240, v164
    v_exp_f32 v241, v165
    v_add_f32 v48, v48, v238
    v_add_f32 v48, v48, v239
    v_cvt_pk_bf16_f32 v211, v238, v239
    v_exp_f32 v242, v166
    v_exp_f32 v243, v167
    v_add_f32 v49, v240, v241
    v_cvt_pk_bf16_f32 v212, v240, v241
    v_exp_f32 v244, v180
    v_exp_f32 v245, v181
    v_add_f32 v49, v49, v242
    v_add_f32 v49, v49, v243
    v_cvt_pk_bf16_f32 v213, v242, v243
    v_exp_f32 v246, v182
    v_exp_f32 v247, v183
    v_add_f32 v49, v49, v244
    v_add_f32 v49, v49, v245
    v_cvt_pk_bf16_f32 v214, v244, v245
    v_exp_f32 v232, v168
    v_exp_f32 v233, v169
    v_add_f32 v49, v49, v246
    v_add_f32 v49, v49, v247
    v_cvt_pk_bf16_f32 v215, v246, v247
    v_exp_f32 v234, v170
    v_exp_f32 v235, v171
    v_add_f32 v50, v232, v233
    v_cvt_pk_bf16_f32 v216, v232, v233
    v_exp_f32 v236, v184
    v_exp_f32 v237, v185
    v_add_f32 v50, v50, v234
    v_add_f32 v50, v50, v235
    v_cvt_pk_bf16_f32 v217, v234, v235
    v_exp_f32 v238, v186
    v_exp_f32 v239, v187
    v_add_f32 v50, v50, v236
    v_add_f32 v50, v50, v237
    v_cvt_pk_bf16_f32 v218, v236, v237
    v_exp_f32 v240, v172
    v_exp_f32 v241, v173
    v_add_f32 v50, v50, v238
    v_add_f32 v50, v50, v239
    v_cvt_pk_bf16_f32 v219, v238, v239
    v_exp_f32 v242, v174
    v_exp_f32 v243, v175
    v_add_f32 v51, v240, v241
    v_cvt_pk_bf16_f32 v220, v240, v241
    v_exp_f32 v244, v188
    v_exp_f32 v245, v189
    v_add_f32 v51, v51, v242
    v_add_f32 v51, v51, v243
    v_cvt_pk_bf16_f32 v221, v242, v243
    v_exp_f32 v246, v190
    v_exp_f32 v247, v191
    v_add_f32 v51, v51, v244
    v_add_f32 v51, v51, v245
    v_cvt_pk_bf16_f32 v222, v244, v245
    s_nop 0
    v_add_f32 v51, v51, v246
    v_add_f32 v51, v51, v247
    v_cvt_pk_bf16_f32 v223, v246, v247
    s_nop 1
    s_branch k2_ret_59
k2_rare_62:
    s_nop 7
    v_max_f32 v54, v128, v129
    v_max3_f32 v54, v54, v130, v131
    v_max3_f32 v54, v54, v144, v145
    v_max3_f32 v54, v54, v146, v147
    v_max3_f32 v54, v54, v136, v137
    v_max3_f32 v54, v54, v138, v139
    v_max3_f32 v54, v54, v152, v153
    v_max3_f32 v54, v54, v154, v155
    v_mov_b32 v6, v54
    s_nop 1
    v_permlane16_swap_b32 v54, v6
    s_nop 1
    v_max_f32 v54, v54, v6
    v_mov_b32 v6, v54
    s_nop 1
    v_permlane32_swap_b32 v54, v6
    s_nop 1
    v_max_f32 v54, v54, v6
    v_max_f32 v54, 0, v54
    v_max_f32 v55, v132, v133
    v_max3_f32 v55, v55, v134, v135
    v_max3_f32 v55, v55, v148, v149
    v_max3_f32 v55, v55, v150, v151
    v_max3_f32 v55, v55, v140, v141
    v_max3_f32 v55, v55, v142, v143
    v_max3_f32 v55, v55, v156, v157
    v_max3_f32 v55, v55, v158, v159
    v_mov_b32 v6, v55
    s_nop 1
    v_permlane16_swap_b32 v55, v6
    s_nop 1
    v_max_f32 v55, v55, v6
    v_mov_b32 v6, v55
    s_nop 1
    v_permlane32_swap_b32 v55, v6
    s_nop 1
    v_max_f32 v55, v55, v6
    v_max_f32 v55, 0, v55
    v_sub_f32 v128, v128, v54
    v_sub_f32 v129, v129, v54
    v_sub_f32 v130, v130, v54
    v_sub_f32 v131, v131, v54
    v_sub_f32 v132, v132, v55
    v_sub_f32 v133, v133, v55
    v_sub_f32 v134, v134, v55
    v_sub_f32 v135, v135, v55
    v_sub_f32 v136, v136, v54
    v_sub_f32 v137, v137, v54
    v_sub_f32 v138, v138, v54
    v_sub_f32 v139, v139, v54
    v_sub_f32 v140, v140, v55
    v_sub_f32 v141, v141, v55
    v_sub_f32 v142, v142, v55
    v_sub_f32 v143, v143, v55
    v_sub_f32 v144, v144, v54
    v_sub_f32 v145, v145, v54
    v_sub_f32 v146, v146, v54
    v_sub_f32 v147, v147, v54
    v_sub_f32 v148, v148, v55
    v_sub_f32 v149, v149, v55
    v_sub_f32 v150, v150, v55
    v_sub_f32 v151, v151, v55
    v_sub_f32 v152, v152, v54
    v_sub_f32 v153, v153, v54
    v_sub_f32 v154, v154, v54
    v_sub_f32 v155, v155, v54
    v_sub_f32 v156, v156, v55
    v_sub_f32 v157, v157, v55
    v_sub_f32 v158, v158, v55
    v_sub_f32 v159, v159, v55
    v_sub_f32 v160, v160, v54
    v_sub_f32 v16, v16, v54
    v_sub_f32 v161, v161, v54
    v_sub_f32 v17, v17, v54
    v_sub_f32 v162, v162, v54
    v_sub_f32 v18, v18, v54
    v_sub_f32 v163, v163, v54
    v_sub_f32 v19, v19, v54
    v_sub_f32 v164, v164, v55
    v_sub_f32 v20, v20, v55
    v_sub_f32 v165, v165, v55
    v_sub_f32 v21, v21, v55
    v_sub_f32 v166, v166, v55
    v_sub_f32 v22, v22, v55
    v_sub_f32 v167, v167, v55
    v_sub_f32 v23, v23, v55
    v_sub_f32 v168, v168, v54
    v_sub_f32 v24, v24, v54
    v_sub_f32 v169, v169, v54
    v_sub_f32 v25, v25, v54
    v_sub_f32 v170, v170, v54
    v_sub_f32 v26, v26, v54
    v_sub_f32 v171, v171, v54
    v_sub_f32 v27, v27, v54
    v_sub_f32 v172, v172, v55
    v_sub_f32 v28, v28, v55
    v_sub_f32 v173, v173, v55
    v_sub_f32 v29, v29, v55
    v_sub_f32 v174, v174, v55
    v_sub_f32 v30, v30, v55
    v_sub_f32 v175, v175, v55
    v_sub_f32 v31, v31, v55
    v_sub_f32 v176, v176, v54
    v_sub_f32 v32, v32, v54
    v_sub_f32 v177, v177, v54
    v_sub_f32 v33, v33, v54
    v_sub_f32 v178, v178, v54
    v_sub_f32 v34, v34, v54
    v_sub_f32 v179, v179, v54
    v_sub_f32 v35, v35, v54
    v_sub_f32 v180, v180, v55
    v_sub_f32 v36, v36, v55
    v_sub_f32 v181, v181, v55
    v_sub_f32 v37, v37, v55
    v_sub_f32 v182, v182, v55
    v_sub_f32 v38, v38, v55
    v_sub_f32 v183, v183, v55
    v_sub_f32 v39, v39, v55
    v_sub_f32 v184, v184, v54
    v_sub_f32 v40, v40, v54
    v_sub_f32 v185, v185, v54
    v_sub_f32 v41, v41, v54
    v_sub_f32 v186, v186, v54
    v_sub_f32 v42, v42, v54
    v_sub_f32 v187, v187, v54
    v_sub_f32 v43, v43, v54
    v_sub_f32 v188, v188, v55
    v_sub_f32 v44, v44, v55
    v_sub_f32 v189, v189, v55
    v_sub_f32 v45, v45, v55
    v_sub_f32 v190, v190, v55
    v_sub_f32 v46, v46, v55
    v_sub_f32 v191, v191, v55
    v_sub_f32 v47, v47, v55
    v_sub_f32 v10, v10, v54
    v_exp_f32 v54, -v54
    v_sub_f32 v11, v11, v55
    v_exp_f32 v55, -v55
    s_nop 0
    v_mul_f32 v14, v14, v54
    v_mul_f32 v15, v15, v55
    v_accvgpr_read_b32 v224, a8
    v_accvgpr_read_b32 v225, a9
    v_accvgpr_read_b32 v226, a10
    v_accvgpr_read_b32 v227, a11
    v_mul_f32 v224, v224, v54
    v_mul_f32 v225, v225, v54
    v_mul_f32 v226, v226, v54
    v_mul_f32 v227, v227, v54
    v_accvgpr_write_b32 a8, v224
    v_accvgpr_write_b32 a9, v225
    v_accvgpr_write_b32 a10, v226
    v_accvgpr_write_b32 a11, v227
    v_accvgpr_read_b32 v224, a12
    v_accvgpr_read_b32 v225, a13
    v_accvgpr_read_b32 v226, a14
    v_accvgpr_read_b32 v227, a15
    v_mul_f32 v224, v224, v55
    v_mul_f32 v225, v225, v55
    v_mul_f32 v226, v226, v55
    v_mul_f32 v227, v227, v55
    v_accvgpr_write_b32 a12, v224
    v_accvgpr_write_b32 a13, v225
    v_accvgpr_write_b32 a14, v226
    v_accvgpr_write_b32 a15, v227
    v_accvgpr_read_b32 v224, a24
    v_accvgpr_read_b32 v225, a25
    v_accvgpr_read_b32 v226, a26
    v_accvgpr_read_b32 v227, a27
    v_mul_f32 v224, v224, v54
    v_mul_f32 v225, v225, v54
    v_mul_f32 v226, v226, v54
    v_mul_f32 v227, v227, v54
    v_accvgpr_write_b32 a24, v224
    v_accvgpr_write_b32 a25, v225
    v_accvgpr_write_b32 a26, v226
    v_accvgpr_write_b32 a27, v227
    v_accvgpr_read_b32 v224, a28
    v_accvgpr_read_b32 v225, a29
    v_accvgpr_read_b32 v226, a30
    v_accvgpr_read_b32 v227, a31
    v_mul_f32 v224, v224, v55
    v_mul_f32 v225, v225, v55
    v_mul_f32 v226, v226, v55
    v_mul_f32 v227, v227, v55
    v_accvgpr_write_b32 a28, v224
    v_accvgpr_write_b32 a29, v225
    v_accvgpr_write_b32 a30, v226
    v_accvgpr_write_b32 a31, v227
    v_accvgpr_read_b32 v224, a40
    v_accvgpr_read_b32 v225, a41
    v_accvgpr_read_b32 v226, a42
    v_accvgpr_read_b32 v227, a43
    v_mul_f32 v224, v224, v54
    v_mul_f32 v225, v225, v54
    v_mul_f32 v226, v226, v54
    v_mul_f32 v227, v227, v54
    v_accvgpr_write_b32 a40, v224
    v_accvgpr_write_b32 a41, v225
    v_accvgpr_write_b32 a42, v226
    v_accvgpr_write_b32 a43, v227
    v_accvgpr_read_b32 v224, a44
    v_accvgpr_read_b32 v225, a45
    v_accvgpr_read_b32 v226, a46
    v_accvgpr_read_b32 v227, a47
    v_mul_f32 v224, v224, v55
    v_mul_f32 v225, v225, v55
    v_mul_f32 v226, v226, v55
    v_mul_f32 v227, v227, v55
    v_accvgpr_write_b32 a44, v224
    v_accvgpr_write_b32 a45, v225
    v_accvgpr_write_b32 a46, v226
    v_accvgpr_write_b32 a47, v227
    v_accvgpr_read_b32 v224, a56
    v_accvgpr_read_b32 v225, a57
    v_accvgpr_read_b32 v226, a58
    v_accvgpr_read_b32 v227, a59
    v_mul_f32 v224, v224, v54
    v_mul_f32 v225, v225, v54
    v_mul_f32 v226, v226, v54
    v_mul_f32 v227, v227, v54
    v_accvgpr_write_b32 a56, v224
    v_accvgpr_write_b32 a57, v225
    v_accvgpr_write_b32 a58, v226
    v_accvgpr_write_b32 a59, v227
    v_accvgpr_read_b32 v224, a60
    v_accvgpr_read_b32 v225, a61
    v_accvgpr_read_b32 v226, a62
    v_accvgpr_read_b32 v227, a63
    v_mul_f32 v224, v224, v55
    v_mul_f32 v225, v225, v55
    v_mul_f32 v226, v226, v55
    v_mul_f32 v227, v227, v55
    v_accvgpr_write_b32 a60, v224
    v_accvgpr_write_b32 a61, v225
    v_accvgpr_write_b32 a62, v226
    v_accvgpr_write_b32 a63, v227
    v_accvgpr_read_b32 v224, a72
    v_accvgpr_read_b32 v225, a73
    v_accvgpr_read_b32 v226, a74
    v_accvgpr_read_b32 v227, a75
    v_mul_f32 v224, v224, v54
    v_mul_f32 v225, v225, v54
    v_mul_f32 v226, v226, v54
    v_mul_f32 v227, v227, v54
    v_accvgpr_write_b32 a72, v224
    v_accvgpr_write_b32 a73, v225
    v_accvgpr_write_b32 a74, v226
    v_accvgpr_write_b32 a75, v227
    v_accvgpr_read_b32 v224, a76
    v_accvgpr_read_b32 v225, a77
    v_accvgpr_read_b32 v226, a78
    v_accvgpr_read_b32 v227, a79
    v_mul_f32 v224, v224, v55
    v_mul_f32 v225, v225, v55
    v_mul_f32 v226, v226, v55
    v_mul_f32 v227, v227, v55
    v_accvgpr_write_b32 a76, v224
    v_accvgpr_write_b32 a77, v225
    v_accvgpr_write_b32 a78, v226
    v_accvgpr_write_b32 a79, v227
    v_accvgpr_read_b32 v224, a88
    v_accvgpr_read_b32 v225, a89
    v_accvgpr_read_b32 v226, a90
    v_accvgpr_read_b32 v227, a91
    v_mul_f32 v224, v224, v54
    v_mul_f32 v225, v225, v54
    v_mul_f32 v226, v226, v54
    v_mul_f32 v227, v227, v54
    v_accvgpr_write_b32 a88, v224
    v_accvgpr_write_b32 a89, v225
    v_accvgpr_write_b32 a90, v226
    v_accvgpr_write_b32 a91, v227
    v_accvgpr_read_b32 v224, a92
    v_accvgpr_read_b32 v225, a93
    v_accvgpr_read_b32 v226, a94
    v_accvgpr_read_b32 v227, a95
    v_mul_f32 v224, v224, v55
    v_mul_f32 v225, v225, v55
    v_mul_f32 v226, v226, v55
    v_mul_f32 v227, v227, v55
    v_accvgpr_write_b32 a92, v224
    v_accvgpr_write_b32 a93, v225
    v_accvgpr_write_b32 a94, v226
    v_accvgpr_write_b32 a95, v227
    v_accvgpr_read_b32 v224, a104
    v_accvgpr_read_b32 v225, a105
    v_accvgpr_read_b32 v226, a106
    v_accvgpr_read_b32 v227, a107
    v_mul_f32 v224, v224, v54
    v_mul_f32 v225, v225, v54
    v_mul_f32 v226, v226, v54
    v_mul_f32 v227, v227, v54
    v_accvgpr_write_b32 a104, v224
    v_accvgpr_write_b32 a105, v225
    v_accvgpr_write_b32 a106, v226
    v_accvgpr_write_b32 a107, v227
    v_accvgpr_read_b32 v224, a108
    v_accvgpr_read_b32 v225, a109
    v_accvgpr_read_b32 v226, a110
    v_accvgpr_read_b32 v227, a111
    v_mul_f32 v224, v224, v55
    v_mul_f32 v225, v225, v55
    v_mul_f32 v226, v226, v55
    v_mul_f32 v227, v227, v55
    v_accvgpr_write_b32 a108, v224
    v_accvgpr_write_b32 a109, v225
    v_accvgpr_write_b32 a110, v226
    v_accvgpr_write_b32 a111, v227
    v_accvgpr_read_b32 v224, a120
    v_accvgpr_read_b32 v225, a121
    v_accvgpr_read_b32 v226, a122
    v_accvgpr_read_b32 v227, a123
    v_mul_f32 v224, v224, v54
    v_mul_f32 v225, v225, v54
    v_mul_f32 v226, v226, v54
    v_mul_f32 v227, v227, v54
    v_accvgpr_write_b32 a120, v224
    v_accvgpr_write_b32 a121, v225
    v_accvgpr_write_b32 a122, v226
    v_accvgpr_write_b32 a123, v227
    v_accvgpr_read_b32 v224, a124
    v_accvgpr_read_b32 v225, a125
    v_accvgpr_read_b32 v226, a126
    v_accvgpr_read_b32 v227, a127
    v_mul_f32 v224, v224, v55
    v_mul_f32 v225, v225, v55
    v_mul_f32 v226, v226, v55
    v_mul_f32 v227, v227, v55
    v_accvgpr_write_b32 a124, v224
    v_accvgpr_write_b32 a125, v225
    v_accvgpr_write_b32 a126, v226
    v_accvgpr_write_b32 a127, v227
    v_exp_f32 v232, v128
    v_exp_f32 v233, v129
    v_exp_f32 v234, v130
    v_exp_f32 v235, v131
    v_add_f32 v48, v232, v233
    v_cvt_pk_bf16_f32 v192, v232, v233
    v_exp_f32 v236, v144
    v_exp_f32 v237, v145
    v_add_f32 v48, v48, v234
    v_add_f32 v48, v48, v235
    v_cvt_pk_bf16_f32 v193, v234, v235
    v_exp_f32 v238, v146
    v_exp_f32 v239, v147
    v_add_f32 v48, v48, v236
    v_add_f32 v48, v48, v237
    v_cvt_pk_bf16_f32 v194, v236, v237
    v_exp_f32 v240, v132
    v_exp_f32 v241, v133
    v_add_f32 v48, v48, v238
    v_add_f32 v48, v48, v239
    v_cvt_pk_bf16_f32 v195, v238, v239
    v_exp_f32 v242, v134
    v_exp_f32 v243, v135
    v_add_f32 v49, v240, v241
    v_cvt_pk_bf16_f32 v196, v240, v241
    v_exp_f32 v244, v148
    v_exp_f32 v245, v149
    v_add_f32 v49, v49, v242
    v_add_f32 v49, v49, v243
    v_cvt_pk_bf16_f32 v197, v242, v243
    v_exp_f32 v246, v150
    v_exp_f32 v247, v151
    v_add_f32 v49, v49, v244
    v_add_f32 v49, v49, v245
    v_cvt_pk_bf16_f32 v198, v244, v245
    v_exp_f32 v232, v136
    v_exp_f32 v233, v137
    v_add_f32 v49, v49, v246
    v_add_f32 v49, v49, v247
    v_cvt_pk_bf16_f32 v199, v246, v247
    v_exp_f32 v234, v138
    v_exp_f32 v235, v139
    v_add_f32 v50, v232, v233
    v_cvt_pk_bf16_f32 v200, v232, v233
    v_exp_f32 v236, v152
    v_exp_f32 v237, v153
    v_add_f32 v50, v50, v234
    v_add_f32 v50, v50, v235
    v_cvt_pk_bf16_f32 v201, v234, v235
    v_exp_f32 v238, v154
    v_exp_f32 v239, v155
    v_add_f32 v50, v50, v236
    v_add_f32 v50, v50, v237
    v_cvt_pk_bf16_f32 v202, v236, v237
    v_exp_f32 v240, v140
    v_exp_f32 v241, v141
    v_add_f32 v50, v50, v238
    v_add_f32 v50, v50, v239
    v_cvt_pk_bf16_f32 v203, v238, v239
    v_exp_f32 v242, v142
    v_exp_f32 v243, v143
    v_add_f32 v51, v240, v241
    v_cvt_pk_bf16_f32 v204, v240, v241
    v_exp_f32 v244, v156
    v_exp_f32 v245, v157
    v_add_f32 v51, v51, v242
    v_add_f32 v51, v51, v243
    v_cvt_pk_bf16_f32 v205, v242, v243
    v_exp_f32 v246, v158
    v_exp_f32 v247, v159
    v_add_f32 v51, v51, v244
    v_add_f32 v51, v51, v245
    v_cvt_pk_bf16_f32 v206, v244, v245
    s_nop 0
    v_add_f32 v51, v51, v246
    v_add_f32 v51, v51, v247
    v_cvt_pk_bf16_f32 v207, v246, v247
    s_nop 1
    s_branch k2_ret_63
k2_rare_68:
    s_nop 7
    v_max_f32 v54, v160, v161
    v_max3_f32 v54, v54, v162, v163
    v_max3_f32 v54, v54, v176, v177
    v_max3_f32 v54, v54, v178, v179
    v_max3_f32 v54, v54, v168, v169
    v_max3_f32 v54, v54, v170, v171
    v_max3_f32 v54, v54, v184, v185
    v_max3_f32 v54, v54, v186, v187
    v_mov_b32 v6, v54
    s_nop 1
    v_permlane16_swap_b32 v54, v6
    s_nop 1
    v_max_f32 v54, v54, v6
    v_mov_b32 v6, v54
    s_nop 1
    v_permlane32_swap_b32 v54, v6
    s_nop 1
    v_max_f32 v54, v54, v6
    v_max_f32 v54, 0, v54
    v_max_f32 v55, v164, v165
    v_max3_f32 v55, v55, v166, v167
    v_max3_f32 v55, v55, v180, v181
    v_max3_f32 v55, v55, v182, v183
    v_max3_f32 v55, v55, v172, v173
    v_max3_f32 v55, v55, v174, v175
    v_max3_f32 v55, v55, v188, v189
    v_max3_f32 v55, v55, v190, v191
    v_mov_b32 v6, v55
    s_nop 1
    v_permlane16_swap_b32 v55, v6
    s_nop 1
    v_max_f32 v55, v55, v6
    v_mov_b32 v6, v55
    s_nop 1
    v_permlane32_swap_b32 v55, v6
    s_nop 1
    v_max_f32 v55, v55, v6
    v_max_f32 v55, 0, v55
    v_sub_f32 v160, v160, v54
    v_sub_f32 v161, v161, v54
    v_sub_f32 v162, v162, v54
    v_sub_f32 v163, v163, v54
    v_sub_f32 v164, v164, v55
    v_sub_f32 v165, v165, v55
    v_sub_f32 v166, v166, v55
    v_sub_f32 v167, v167, v55
    v_sub_f32 v168, v168, v54
    v_sub_f32 v169, v169, v54
    v_sub_f32 v170, v170, v54
    v_sub_f32 v171, v171, v54
    v_sub_f32 v172, v172, v55
    v_sub_f32 v173, v173, v55
    v_sub_f32 v174, v174, v55
    v_sub_f32 v175, v175, v55
    v_sub_f32 v176, v176, v54
    v_sub_f32 v177, v177, v54
    v_sub_f32 v178, v178, v54
    v_sub_f32 v179, v179, v54
    v_sub_f32 v180, v180, v55
    v_sub_f32 v181, v181, v55
    v_sub_f32 v182, v182, v55
    v_sub_f32 v183, v183, v55
    v_sub_f32 v184, v184, v54
    v_sub_f32 v185, v185, v54
    v_sub_f32 v186, v186, v54
    v_sub_f32 v187, v187, v54
    v_sub_f32 v188, v188, v55
    v_sub_f32 v189, v189, v55
    v_sub_f32 v190, v190, v55
    v_sub_f32 v191, v191, v55
    v_sub_f32 v128, v128, v54
    v_sub_f32 v16, v16, v54
    v_sub_f32 v129, v129, v54
    v_sub_f32 v17, v17, v54
    v_sub_f32 v130, v130, v54
    v_sub_f32 v18, v18, v54
    v_sub_f32 v131, v131, v54
    v_sub_f32 v19, v19, v54
    v_sub_f32 v132, v132, v55
    v_sub_f32 v20, v20, v55
    v_sub_f32 v133, v133, v55
    v_sub_f32 v21, v21, v55
    v_sub_f32 v134, v134, v55
    v_sub_f32 v22, v22, v55
    v_sub_f32 v135, v135, v55
    v_sub_f32 v23, v23, v55
    v_sub_f32 v136, v136, v54
    v_sub_f32 v24, v24, v54
    v_sub_f32 v137, v137, v54
    v_sub_f32 v25, v25, v54
    v_sub_f32 v138, v138, v54
    v_sub_f32 v26, v26, v54
    v_sub_f32 v139, v139, v54
    v_sub_f32 v27, v27, v54
    v_sub_f32 v140, v140, v55
    v_sub_f32 v28, v28, v55
    v_sub_f32 v141, v141, v55
    v_sub_f32 v29, v29, v55
    v_sub_f32 v142, v142, v55
    v_sub_f32 v30, v30, v55
    v_sub_f32 v143, v143, v55
    v_sub_f32 v31, v31, v55
    v_sub_f32 v144, v144, v54
    v_sub_f32 v32, v32, v54
    v_sub_f32 v145, v145, v54
    v_sub_f32 v33, v33, v54
    v_sub_f32 v146, v146, v54
    v_sub_f32 v34, v34, v54
    v_sub_f32 v147, v147, v54
    v_sub_f32 v35, v35, v54
    v_sub_f32 v148, v148, v55
    v_sub_f32 v36, v36, v55
    v_sub_f32 v149, v149, v55
    v_sub_f32 v37, v37, v55
    v_sub_f32 v150, v150, v55
    v_sub_f32 v38, v38, v55
    v_sub_f32 v151, v151, v55
    v_sub_f32 v39, v39, v55
    v_sub_f32 v152, v152, v54
    v_sub_f32 v40, v40, v54
    v_sub_f32 v153, v153, v54
    v_sub_f32 v41, v41, v54
    v_sub_f32 v154, v154, v54
    v_sub_f32 v42, v42, v54
    v_sub_f32 v155, v155, v54
    v_sub_f32 v43, v43, v54
    v_sub_f32 v156, v156, v55
    v_sub_f32 v44, v44, v55
    v_sub_f32 v157, v157, v55
    v_sub_f32 v45, v45, v55
    v_sub_f32 v158, v158, v55
    v_sub_f32 v46, v46, v55
    v_sub_f32 v159, v159, v55
    v_sub_f32 v47, v47, v55
    v_sub_f32 v10, v10, v54
    v_exp_f32 v54, -v54
    v_sub_f32 v11, v11, v55
    v_exp_f32 v55, -v55
    s_nop 0
    v_mul_f32 v14, v14, v54
    v_mul_f32 v15, v15, v55
    v_accvgpr_read_b32 v224, a8
    v_accvgpr_read_b32 v225, a9
    v_accvgpr_read_b32 v226, a10
    v_accvgpr_read_b32 v227, a11
    v_mul_f32 v224, v224, v54
    v_mul_f32 v225, v225, v54
    v_mul_f32 v226, v226, v54
    v_mul_f32 v227, v227, v54
    v_accvgpr_write_b32 a8, v224
    v_accvgpr_write_b32 a9, v225
    v_accvgpr_write_b32 a10, v226
    v_accvgpr_write_b32 a11, v227
    v_accvgpr_read_b32 v224, a12
    v_accvgpr_read_b32 v225, a13
    v_accvgpr_read_b32 v226, a14
    v_accvgpr_read_b32 v227, a15
    v_mul_f32 v224, v224, v55
    v_mul_f32 v225, v225, v55
    v_mul_f32 v226, v226, v55
    v_mul_f32 v227, v227, v55
    v_accvgpr_write_b32 a12, v224
    v_accvgpr_write_b32 a13, v225
    v_accvgpr_write_b32 a14, v226
    v_accvgpr_write_b32 a15, v227
    v_accvgpr_read_b32 v224, a24
    v_accvgpr_read_b32 v225, a25
    v_accvgpr_read_b32 v226, a26
    v_accvgpr_read_b32 v227, a27
    v_mul_f32 v224, v224, v54
    v_mul_f32 v225, v225, v54
    v_mul_f32 v226, v226, v54
    v_mul_f32 v227, v227, v54
    v_accvgpr_write_b32 a24, v224
    v_accvgpr_write_b32 a25, v225
    v_accvgpr_write_b32 a26, v226
    v_accvgpr_write_b32 a27, v227
    v_accvgpr_read_b32 v224, a28
    v_accvgpr_read_b32 v225, a29
    v_accvgpr_read_b32 v226, a30
    v_accvgpr_read_b32 v227, a31
    v_mul_f32 v224, v224, v55
    v_mul_f32 v225, v225, v55
    v_mul_f32 v226, v226, v55
    v_mul_f32 v227, v227, v55
    v_accvgpr_write_b32 a28, v224
    v_accvgpr_write_b32 a29, v225
    v_accvgpr_write_b32 a30, v226
    v_accvgpr_write_b32 a31, v227
    v_accvgpr_read_b32 v224, a40
    v_accvgpr_read_b32 v225, a41
    v_accvgpr_read_b32 v226, a42
    v_accvgpr_read_b32 v227, a43
    v_mul_f32 v224, v224, v54
    v_mul_f32 v225, v225, v54
    v_mul_f32 v226, v226, v54
    v_mul_f32 v227, v227, v54
    v_accvgpr_write_b32 a40, v224
    v_accvgpr_write_b32 a41, v225
    v_accvgpr_write_b32 a42, v226
    v_accvgpr_write_b32 a43, v227
    v_accvgpr_read_b32 v224, a44
    v_accvgpr_read_b32 v225, a45
    v_accvgpr_read_b32 v226, a46
    v_accvgpr_read_b32 v227, a47
    v_mul_f32 v224, v224, v55
    v_mul_f32 v225, v225, v55
    v_mul_f32 v226, v226, v55
    v_mul_f32 v227, v227, v55
    v_accvgpr_write_b32 a44, v224
    v_accvgpr_write_b32 a45, v225
    v_accvgpr_write_b32 a46, v226
    v_accvgpr_write_b32 a47, v227
    v_accvgpr_read_b32 v224, a56
    v_accvgpr_read_b32 v225, a57
    v_accvgpr_read_b32 v226, a58
    v_accvgpr_read_b32 v227, a59
    v_mul_f32 v224, v224, v54
    v_mul_f32 v225, v225, v54
    v_mul_f32 v226, v226, v54
    v_mul_f32 v227, v227, v54
    v_accvgpr_write_b32 a56, v224
    v_accvgpr_write_b32 a57, v225
    v_accvgpr_write_b32 a58, v226
    v_accvgpr_write_b32 a59, v227
    v_accvgpr_read_b32 v224, a60
    v_accvgpr_read_b32 v225, a61
    v_accvgpr_read_b32 v226, a62
    v_accvgpr_read_b32 v227, a63
    v_mul_f32 v224, v224, v55
    v_mul_f32 v225, v225, v55
    v_mul_f32 v226, v226, v55
    v_mul_f32 v227, v227, v55
    v_accvgpr_write_b32 a60, v224
    v_accvgpr_write_b32 a61, v225
    v_accvgpr_write_b32 a62, v226
    v_accvgpr_write_b32 a63, v227
    v_accvgpr_read_b32 v224, a72
    v_accvgpr_read_b32 v225, a73
    v_accvgpr_read_b32 v226, a74
    v_accvgpr_read_b32 v227, a75
    v_mul_f32 v224, v224, v54
    v_mul_f32 v225, v225, v54
    v_mul_f32 v226, v226, v54
    v_mul_f32 v227, v227, v54
    v_accvgpr_write_b32 a72, v224
    v_accvgpr_write_b32 a73, v225
    v_accvgpr_write_b32 a74, v226
    v_accvgpr_write_b32 a75, v227
    v_accvgpr_read_b32 v224, a76
    v_accvgpr_read_b32 v225, a77
    v_accvgpr_read_b32 v226, a78
    v_accvgpr_read_b32 v227, a79
    v_mul_f32 v224, v224, v55
    v_mul_f32 v225, v225, v55
    v_mul_f32 v226, v226, v55
    v_mul_f32 v227, v227, v55
    v_accvgpr_write_b32 a76, v224
    v_accvgpr_write_b32 a77, v225
    v_accvgpr_write_b32 a78, v226
    v_accvgpr_write_b32 a79, v227
    v_accvgpr_read_b32 v224, a88
    v_accvgpr_read_b32 v225, a89
    v_accvgpr_read_b32 v226, a90
    v_accvgpr_read_b32 v227, a91
    v_mul_f32 v224, v224, v54
    v_mul_f32 v225, v225, v54
    v_mul_f32 v226, v226, v54
    v_mul_f32 v227, v227, v54
    v_accvgpr_write_b32 a88, v224
    v_accvgpr_write_b32 a89, v225
    v_accvgpr_write_b32 a90, v226
    v_accvgpr_write_b32 a91, v227
    v_accvgpr_read_b32 v224, a92
    v_accvgpr_read_b32 v225, a93
    v_accvgpr_read_b32 v226, a94
    v_accvgpr_read_b32 v227, a95
    v_mul_f32 v224, v224, v55
    v_mul_f32 v225, v225, v55
    v_mul_f32 v226, v226, v55
    v_mul_f32 v227, v227, v55
    v_accvgpr_write_b32 a92, v224
    v_accvgpr_write_b32 a93, v225
    v_accvgpr_write_b32 a94, v226
    v_accvgpr_write_b32 a95, v227
    v_accvgpr_read_b32 v224, a104
    v_accvgpr_read_b32 v225, a105
    v_accvgpr_read_b32 v226, a106
    v_accvgpr_read_b32 v227, a107
    v_mul_f32 v224, v224, v54
    v_mul_f32 v225, v225, v54
    v_mul_f32 v226, v226, v54
    v_mul_f32 v227, v227, v54
    v_accvgpr_write_b32 a104, v224
    v_accvgpr_write_b32 a105, v225
    v_accvgpr_write_b32 a106, v226
    v_accvgpr_write_b32 a107, v227
    v_accvgpr_read_b32 v224, a108
    v_accvgpr_read_b32 v225, a109
    v_accvgpr_read_b32 v226, a110
    v_accvgpr_read_b32 v227, a111
    v_mul_f32 v224, v224, v55
    v_mul_f32 v225, v225, v55
    v_mul_f32 v226, v226, v55
    v_mul_f32 v227, v227, v55
    v_accvgpr_write_b32 a108, v224
    v_accvgpr_write_b32 a109, v225
    v_accvgpr_write_b32 a110, v226
    v_accvgpr_write_b32 a111, v227
    v_accvgpr_read_b32 v224, a120
    v_accvgpr_read_b32 v225, a121
    v_accvgpr_read_b32 v226, a122
    v_accvgpr_read_b32 v227, a123
    v_mul_f32 v224, v224, v54
    v_mul_f32 v225, v225, v54
    v_mul_f32 v226, v226, v54
    v_mul_f32 v227, v227, v54
    v_accvgpr_write_b32 a120, v224
    v_accvgpr_write_b32 a121, v225
    v_accvgpr_write_b32 a122, v226
    v_accvgpr_write_b32 a123, v227
    v_accvgpr_read_b32 v224, a124
    v_accvgpr_read_b32 v225, a125
    v_accvgpr_read_b32 v226, a126
    v_accvgpr_read_b32 v227, a127
    v_mul_f32 v224, v224, v55
    v_mul_f32 v225, v225, v55
    v_mul_f32 v226, v226, v55
    v_mul_f32 v227, v227, v55
    v_accvgpr_write_b32 a124, v224
    v_accvgpr_write_b32 a125, v225
    v_accvgpr_write_b32 a126, v226
    v_accvgpr_write_b32 a127, v227
    v_exp_f32 v232, v160
    v_exp_f32 v233, v161
    v_exp_f32 v234, v162
    v_exp_f32 v235, v163
    v_add_f32 v48, v232, v233
    v_cvt_pk_bf16_f32 v208, v232, v233
    v_exp_f32 v236, v176
    v_exp_f32 v237, v177
    v_add_f32 v48, v48, v234
    v_add_f32 v48, v48, v235
    v_cvt_pk_bf16_f32 v209, v234, v235
    v_exp_f32 v238, v178
    v_exp_f32 v239, v179
    v_add_f32 v48, v48, v236
    v_add_f32 v48, v48, v237
    v_cvt_pk_bf16_f32 v210, v236, v237
    v_exp_f32 v240, v164
    v_exp_f32 v241, v165
    v_add_f32 v48, v48, v238
    v_add_f32 v48, v48, v239
    v_cvt_pk_bf16_f32 v211, v238, v239
    v_exp_f32 v242, v166
    v_exp_f32 v243, v167
    v_add_f32 v49, v240, v241
    v_cvt_pk_bf16_f32 v212, v240, v241
    v_exp_f32 v244, v180
    v_exp_f32 v245, v181
    v_add_f32 v49, v49, v242
    v_add_f32 v49, v49, v243
    v_cvt_pk_bf16_f32 v213, v242, v243
    v_exp_f32 v246, v182
    v_exp_f32 v247, v183
    v_add_f32 v49, v49, v244
    v_add_f32 v49, v49, v245
    v_cvt_pk_bf16_f32 v214, v244, v245
    v_exp_f32 v232, v168
    v_exp_f32 v233, v169
    v_add_f32 v49, v49, v246
    v_add_f32 v49, v49, v247
    v_cvt_pk_bf16_f32 v215, v246, v247
    v_exp_f32 v234, v170
    v_exp_f32 v235, v171
    v_add_f32 v50, v232, v233
    v_cvt_pk_bf16_f32 v216, v232, v233
    v_exp_f32 v236, v184
    v_exp_f32 v237, v185
    v_add_f32 v50, v50, v234
    v_add_f32 v50, v50, v235
    v_cvt_pk_bf16_f32 v217, v234, v235
    v_exp_f32 v238, v186
    v_exp_f32 v239, v187
    v_add_f32 v50, v50, v236
    v_add_f32 v50, v50, v237
    v_cvt_pk_bf16_f32 v218, v236, v237
    v_exp_f32 v240, v172
    v_exp_f32 v241, v173
    v_add_f32 v50, v50, v238
    v_add_f32 v50, v50, v239
    v_cvt_pk_bf16_f32 v219, v238, v239
    v_exp_f32 v242, v174
    v_exp_f32 v243, v175
    v_add_f32 v51, v240, v241
    v_cvt_pk_bf16_f32 v220, v240, v241
    v_exp_f32 v244, v188
    v_exp_f32 v245, v189
    v_add_f32 v51, v51, v242
    v_add_f32 v51, v51, v243
    v_cvt_pk_bf16_f32 v221, v242, v243
    v_exp_f32 v246, v190
    v_exp_f32 v247, v191
    v_add_f32 v51, v51, v244
    v_add_f32 v51, v51, v245
    v_cvt_pk_bf16_f32 v222, v244, v245
    s_nop 0
    v_add_f32 v51, v51, v246
    v_add_f32 v51, v51, v247
    v_cvt_pk_bf16_f32 v223, v246, v247
    s_nop 1
    s_branch k2_ret_69
k2_rare_72:
    s_nop 7
    v_max_f32 v54, v128, v129
    v_max3_f32 v54, v54, v130, v131
    v_max3_f32 v54, v54, v144, v145
    v_max3_f32 v54, v54, v146, v147
    v_max3_f32 v54, v54, v136, v137
    v_max3_f32 v54, v54, v138, v139
    v_max3_f32 v54, v54, v152, v153
    v_max3_f32 v54, v54, v154, v155
    v_mov_b32 v6, v54
    s_nop 1
    v_permlane16_swap_b32 v54, v6
    s_nop 1
    v_max_f32 v54, v54, v6
    v_mov_b32 v6, v54
    s_nop 1
    v_permlane32_swap_b32 v54, v6
    s_nop 1
    v_max_f32 v54, v54, v6
    v_max_f32 v54, 0, v54
    v_max_f32 v55, v132, v133
    v_max3_f32 v55, v55, v134, v135
    v_max3_f32 v55, v55, v148, v149
    v_max3_f32 v55, v55, v150, v151
    v_max3_f32 v55, v55, v140, v141
    v_max3_f32 v55, v55, v142, v143
    v_max3_f32 v55, v55, v156, v157
    v_max3_f32 v55, v55, v158, v159
    v_mov_b32 v6, v55
    s_nop 1
    v_permlane16_swap_b32 v55, v6
    s_nop 1
    v_max_f32 v55, v55, v6
    v_mov_b32 v6, v55
    s_nop 1
    v_permlane32_swap_b32 v55, v6
    s_nop 1
    v_max_f32 v55, v55, v6
    v_max_f32 v55, 0, v55
    v_sub_f32 v128, v128, v54
    v_sub_f32 v129, v129, v54
    v_sub_f32 v130, v130, v54
    v_sub_f32 v131, v131, v54
    v_sub_f32 v132, v132, v55
    v_sub_f32 v133, v133, v55
    v_sub_f32 v134, v134, v55
    v_sub_f32 v135, v135, v55
    v_sub_f32 v136, v136, v54
    v_sub_f32 v137, v137, v54
    v_sub_f32 v138, v138, v54
    v_sub_f32 v139, v139, v54
    v_sub_f32 v140, v140, v55
    v_sub_f32 v141, v141, v55
    v_sub_f32 v142, v142, v55
    v_sub_f32 v143, v143, v55
    v_sub_f32 v144, v144, v54
    v_sub_f32 v145, v145, v54
    v_sub_f32 v146, v146, v54
    v_sub_f32 v147, v147, v54
    v_sub_f32 v148, v148, v55
    v_sub_f32 v149, v149, v55
    v_sub_f32 v150, v150, v55
    v_sub_f32 v151, v151, v55
    v_sub_f32 v152, v152, v54
    v_sub_f32 v153, v153, v54
    v_sub_f32 v154, v154, v54
    v_sub_f32 v155, v155, v54
    v_sub_f32 v156, v156, v55
    v_sub_f32 v157, v157, v55
    v_sub_f32 v158, v158, v55
    v_sub_f32 v159, v159, v55
    v_sub_f32 v160, v160, v54
    v_sub_f32 v16, v16, v54
    v_sub_f32 v161, v161, v54
    v_sub_f32 v17, v17, v54
    v_sub_f32 v162, v162, v54
    v_sub_f32 v18, v18, v54
    v_sub_f32 v163, v163, v54
    v_sub_f32 v19, v19, v54
    v_sub_f32 v164, v164, v55
    v_sub_f32 v20, v20, v55
    v_sub_f32 v165, v165, v55
    v_sub_f32 v21, v21, v55
    v_sub_f32 v166, v166, v55
    v_sub_f32 v22, v22, v55
    v_sub_f32 v167, v167, v55
    v_sub_f32 v23, v23, v55
    v_sub_f32 v168, v168, v54
    v_sub_f32 v24, v24, v54
    v_sub_f32 v169, v169, v54
    v_sub_f32 v25, v25, v54
    v_sub_f32 v170, v170, v54
    v_sub_f32 v26, v26, v54
    v_sub_f32 v171, v171, v54
    v_sub_f32 v27, v27, v54
    v_sub_f32 v172, v172, v55
    v_sub_f32 v28, v28, v55
    v_sub_f32 v173, v173, v55
    v_sub_f32 v29, v29, v55
    v_sub_f32 v174, v174, v55
    v_sub_f32 v30, v30, v55
    v_sub_f32 v175, v175, v55
    v_sub_f32 v31, v31, v55
    v_sub_f32 v176, v176, v54
    v_sub_f32 v32, v32, v54
    v_sub_f32 v177, v177, v54
    v_sub_f32 v33, v33, v54
    v_sub_f32 v178, v178, v54
    v_sub_f32 v34, v34, v54
    v_sub_f32 v179, v179, v54
    v_sub_f32 v35, v35, v54
    v_sub_f32 v180, v180, v55
    v_sub_f32 v36, v36, v55
    v_sub_f32 v181, v181, v55
    v_sub_f32 v37, v37, v55
    v_sub_f32 v182, v182, v55
    v_sub_f32 v38, v38, v55
    v_sub_f32 v183, v183, v55
    v_sub_f32 v39, v39, v55
    v_sub_f32 v184, v184, v54
    v_sub_f32 v40, v40, v54
    v_sub_f32 v185, v185, v54
    v_sub_f32 v41, v41, v54
    v_sub_f32 v186, v186, v54
    v_sub_f32 v42, v42, v54
    v_sub_f32 v187, v187, v54
    v_sub_f32 v43, v43, v54
    v_sub_f32 v188, v188, v55
    v_sub_f32 v44, v44, v55
    v_sub_f32 v189, v189, v55
    v_sub_f32 v45, v45, v55
    v_sub_f32 v190, v190, v55
    v_sub_f32 v46, v46, v55
    v_sub_f32 v191, v191, v55
    v_sub_f32 v47, v47, v55
    v_sub_f32 v10, v10, v54
    v_exp_f32 v54, -v54
    v_sub_f32 v11, v11, v55
    v_exp_f32 v55, -v55
    s_nop 0
    v_mul_f32 v14, v14, v54
    v_mul_f32 v15, v15, v55
    v_accvgpr_read_b32 v224, a8
    v_accvgpr_read_b32 v225, a9
    v_accvgpr_read_b32 v226, a10
    v_accvgpr_read_b32 v227, a11
    v_mul_f32 v224, v224, v54
    v_mul_f32 v225, v225, v54
    v_mul_f32 v226, v226, v54
    v_mul_f32 v227, v227, v54
    v_accvgpr_write_b32 a8, v224
    v_accvgpr_write_b32 a9, v225
    v_accvgpr_write_b32 a10, v226
    v_accvgpr_write_b32 a11, v227
    v_accvgpr_read_b32 v224, a12
    v_accvgpr_read_b32 v225, a13
    v_accvgpr_read_b32 v226, a14
    v_accvgpr_read_b32 v227, a15
    v_mul_f32 v224, v224, v55
    v_mul_f32 v225, v225, v55
    v_mul_f32 v226, v226, v55
    v_mul_f32 v227, v227, v55
    v_accvgpr_write_b32 a12, v224
    v_accvgpr_write_b32 a13, v225
    v_accvgpr_write_b32 a14, v226
    v_accvgpr_write_b32 a15, v227
    v_accvgpr_read_b32 v224, a24
    v_accvgpr_read_b32 v225, a25
    v_accvgpr_read_b32 v226, a26
    v_accvgpr_read_b32 v227, a27
    v_mul_f32 v224, v224, v54
    v_mul_f32 v225, v225, v54
    v_mul_f32 v226, v226, v54
    v_mul_f32 v227, v227, v54
    v_accvgpr_write_b32 a24, v224
    v_accvgpr_write_b32 a25, v225
    v_accvgpr_write_b32 a26, v226
    v_accvgpr_write_b32 a27, v227
    v_accvgpr_read_b32 v224, a28
    v_accvgpr_read_b32 v225, a29
    v_accvgpr_read_b32 v226, a30
    v_accvgpr_read_b32 v227, a31
    v_mul_f32 v224, v224, v55
    v_mul_f32 v225, v225, v55
    v_mul_f32 v226, v226, v55
    v_mul_f32 v227, v227, v55
    v_accvgpr_write_b32 a28, v224
    v_accvgpr_write_b32 a29, v225
    v_accvgpr_write_b32 a30, v226
    v_accvgpr_write_b32 a31, v227
    v_accvgpr_read_b32 v224, a40
    v_accvgpr_read_b32 v225, a41
    v_accvgpr_read_b32 v226, a42
    v_accvgpr_read_b32 v227, a43
    v_mul_f32 v224, v224, v54
    v_mul_f32 v225, v225, v54
    v_mul_f32 v226, v226, v54
    v_mul_f32 v227, v227, v54
    v_accvgpr_write_b32 a40, v224
    v_accvgpr_write_b32 a41, v225
    v_accvgpr_write_b32 a42, v226
    v_accvgpr_write_b32 a43, v227
    v_accvgpr_read_b32 v224, a44
    v_accvgpr_read_b32 v225, a45
    v_accvgpr_read_b32 v226, a46
    v_accvgpr_read_b32 v227, a47
    v_mul_f32 v224, v224, v55
    v_mul_f32 v225, v225, v55
    v_mul_f32 v226, v226, v55
    v_mul_f32 v227, v227, v55
    v_accvgpr_write_b32 a44, v224
    v_accvgpr_write_b32 a45, v225
    v_accvgpr_write_b32 a46, v226
    v_accvgpr_write_b32 a47, v227
    v_accvgpr_read_b32 v224, a56
    v_accvgpr_read_b32 v225, a57
    v_accvgpr_read_b32 v226, a58
    v_accvgpr_read_b32 v227, a59
    v_mul_f32 v224, v224, v54
    v_mul_f32 v225, v225, v54
    v_mul_f32 v226, v226, v54
    v_mul_f32 v227, v227, v54
    v_accvgpr_write_b32 a56, v224
    v_accvgpr_write_b32 a57, v225
    v_accvgpr_write_b32 a58, v226
    v_accvgpr_write_b32 a59, v227
    v_accvgpr_read_b32 v224, a60
    v_accvgpr_read_b32 v225, a61
    v_accvgpr_read_b32 v226, a62
    v_accvgpr_read_b32 v227, a63
    v_mul_f32 v224, v224, v55
    v_mul_f32 v225, v225, v55
    v_mul_f32 v226, v226, v55
    v_mul_f32 v227, v227, v55
    v_accvgpr_write_b32 a60, v224
    v_accvgpr_write_b32 a61, v225
    v_accvgpr_write_b32 a62, v226
    v_accvgpr_write_b32 a63, v227
    v_accvgpr_read_b32 v224, a72
    v_accvgpr_read_b32 v225, a73
    v_accvgpr_read_b32 v226, a74
    v_accvgpr_read_b32 v227, a75
    v_mul_f32 v224, v224, v54
    v_mul_f32 v225, v225, v54
    v_mul_f32 v226, v226, v54
    v_mul_f32 v227, v227, v54
    v_accvgpr_write_b32 a72, v224
    v_accvgpr_write_b32 a73, v225
    v_accvgpr_write_b32 a74, v226
    v_accvgpr_write_b32 a75, v227
    v_accvgpr_read_b32 v224, a76
    v_accvgpr_read_b32 v225, a77
    v_accvgpr_read_b32 v226, a78
    v_accvgpr_read_b32 v227, a79
    v_mul_f32 v224, v224, v55
    v_mul_f32 v225, v225, v55
    v_mul_f32 v226, v226, v55
    v_mul_f32 v227, v227, v55
    v_accvgpr_write_b32 a76, v224
    v_accvgpr_write_b32 a77, v225
    v_accvgpr_write_b32 a78, v226
    v_accvgpr_write_b32 a79, v227
    v_accvgpr_read_b32 v224, a88
    v_accvgpr_read_b32 v225, a89
    v_accvgpr_read_b32 v226, a90
    v_accvgpr_read_b32 v227, a91
    v_mul_f32 v224, v224, v54
    v_mul_f32 v225, v225, v54
    v_mul_f32 v226, v226, v54
    v_mul_f32 v227, v227, v54
    v_accvgpr_write_b32 a88, v224
    v_accvgpr_write_b32 a89, v225
    v_accvgpr_write_b32 a90, v226
    v_accvgpr_write_b32 a91, v227
    v_accvgpr_read_b32 v224, a92
    v_accvgpr_read_b32 v225, a93
    v_accvgpr_read_b32 v226, a94
    v_accvgpr_read_b32 v227, a95
    v_mul_f32 v224, v224, v55
    v_mul_f32 v225, v225, v55
    v_mul_f32 v226, v226, v55
    v_mul_f32 v227, v227, v55
    v_accvgpr_write_b32 a92, v224
    v_accvgpr_write_b32 a93, v225
    v_accvgpr_write_b32 a94, v226
    v_accvgpr_write_b32 a95, v227
    v_accvgpr_read_b32 v224, a104
    v_accvgpr_read_b32 v225, a105
    v_accvgpr_read_b32 v226, a106
    v_accvgpr_read_b32 v227, a107
    v_mul_f32 v224, v224, v54
    v_mul_f32 v225, v225, v54
    v_mul_f32 v226, v226, v54
    v_mul_f32 v227, v227, v54
    v_accvgpr_write_b32 a104, v224
    v_accvgpr_write_b32 a105, v225
    v_accvgpr_write_b32 a106, v226
    v_accvgpr_write_b32 a107, v227
    v_accvgpr_read_b32 v224, a108
    v_accvgpr_read_b32 v225, a109
    v_accvgpr_read_b32 v226, a110
    v_accvgpr_read_b32 v227, a111
    v_mul_f32 v224, v224, v55
    v_mul_f32 v225, v225, v55
    v_mul_f32 v226, v226, v55
    v_mul_f32 v227, v227, v55
    v_accvgpr_write_b32 a108, v224
    v_accvgpr_write_b32 a109, v225
    v_accvgpr_write_b32 a110, v226
    v_accvgpr_write_b32 a111, v227
    v_accvgpr_read_b32 v224, a120
    v_accvgpr_read_b32 v225, a121
    v_accvgpr_read_b32 v226, a122
    v_accvgpr_read_b32 v227, a123
    v_mul_f32 v224, v224, v54
    v_mul_f32 v225, v225, v54
    v_mul_f32 v226, v226, v54
    v_mul_f32 v227, v227, v54
    v_accvgpr_write_b32 a120, v224
    v_accvgpr_write_b32 a121, v225
    v_accvgpr_write_b32 a122, v226
    v_accvgpr_write_b32 a123, v227
    v_accvgpr_read_b32 v224, a124
    v_accvgpr_read_b32 v225, a125
    v_accvgpr_read_b32 v226, a126
    v_accvgpr_read_b32 v227, a127
    v_mul_f32 v224, v224, v55
    v_mul_f32 v225, v225, v55
    v_mul_f32 v226, v226, v55
    v_mul_f32 v227, v227, v55
    v_accvgpr_write_b32 a124, v224
    v_accvgpr_write_b32 a125, v225
    v_accvgpr_write_b32 a126, v226
    v_accvgpr_write_b32 a127, v227
    v_exp_f32 v232, v128
    v_exp_f32 v233, v129
    v_exp_f32 v234, v130
    v_exp_f32 v235, v131
    v_add_f32 v48, v232, v233
    v_cvt_pk_bf16_f32 v192, v232, v233
    v_exp_f32 v236, v144
    v_exp_f32 v237, v145
    v_add_f32 v48, v48, v234
    v_add_f32 v48, v48, v235
    v_cvt_pk_bf16_f32 v193, v234, v235
    v_exp_f32 v238, v146
    v_exp_f32 v239, v147
    v_add_f32 v48, v48, v236
    v_add_f32 v48, v48, v237
    v_cvt_pk_bf16_f32 v194, v236, v237
    v_exp_f32 v240, v132
    v_exp_f32 v241, v133
    v_add_f32 v48, v48, v238
    v_add_f32 v48, v48, v239
    v_cvt_pk_bf16_f32 v195, v238, v239
    v_exp_f32 v242, v134
    v_exp_f32 v243, v135
    v_add_f32 v49, v240, v241
    v_cvt_pk_bf16_f32 v196, v240, v241
    v_exp_f32 v244, v148
    v_exp_f32 v245, v149
    v_add_f32 v49, v49, v242
    v_add_f32 v49, v49, v243
    v_cvt_pk_bf16_f32 v197, v242, v243
    v_exp_f32 v246, v150
    v_exp_f32 v247, v151
    v_add_f32 v49, v49, v244
    v_add_f32 v49, v49, v245
    v_cvt_pk_bf16_f32 v198, v244, v245
    v_exp_f32 v232, v136
    v_exp_f32 v233, v137
    v_add_f32 v49, v49, v246
    v_add_f32 v49, v49, v247
    v_cvt_pk_bf16_f32 v199, v246, v247
    v_exp_f32 v234, v138
    v_exp_f32 v235, v139
    v_add_f32 v50, v232, v233
    v_cvt_pk_bf16_f32 v200, v232, v233
    v_exp_f32 v236, v152
    v_exp_f32 v237, v153
    v_add_f32 v50, v50, v234
    v_add_f32 v50, v50, v235
    v_cvt_pk_bf16_f32 v201, v234, v235
    v_exp_f32 v238, v154
    v_exp_f32 v239, v155
    v_add_f32 v50, v50, v236
    v_add_f32 v50, v50, v237
    v_cvt_pk_bf16_f32 v202, v236, v237
    v_exp_f32 v240, v140
    v_exp_f32 v241, v141
    v_add_f32 v50, v50, v238
    v_add_f32 v50, v50, v239
    v_cvt_pk_bf16_f32 v203, v238, v239
    v_exp_f32 v242, v142
    v_exp_f32 v243, v143
    v_add_f32 v51, v240, v241
    v_cvt_pk_bf16_f32 v204, v240, v241
    v_exp_f32 v244, v156
    v_exp_f32 v245, v157
    v_add_f32 v51, v51, v242
    v_add_f32 v51, v51, v243
    v_cvt_pk_bf16_f32 v205, v242, v243
    v_exp_f32 v246, v158
    v_exp_f32 v247, v159
    v_add_f32 v51, v51, v244
    v_add_f32 v51, v51, v245
    v_cvt_pk_bf16_f32 v206, v244, v245
    s_nop 0
    v_add_f32 v51, v51, v246
    v_add_f32 v51, v51, v247
    v_cvt_pk_bf16_f32 v207, v246, v247
    s_nop 1
    s_branch k2_ret_73
k2_rare_74:
    s_nop 7
    v_max_f32 v54, v160, v161
    v_max3_f32 v54, v54, v162, v163
    v_max3_f32 v54, v54, v176, v177
    v_max3_f32 v54, v54, v178, v179
    v_max3_f32 v54, v54, v168, v169
    v_max3_f32 v54, v54, v170, v171
    v_max3_f32 v54, v54, v184, v185
    v_max3_f32 v54, v54, v186, v187
    v_mov_b32 v6, v54
    s_nop 1
    v_permlane16_swap_b32 v54, v6
    s_nop 1
    v_max_f32 v54, v54, v6
    v_mov_b32 v6, v54
    s_nop 1
    v_permlane32_swap_b32 v54, v6
    s_nop 1
    v_max_f32 v54, v54, v6
    v_max_f32 v54, 0, v54
    v_max_f32 v55, v164, v165
    v_max3_f32 v55, v55, v166, v167
    v_max3_f32 v55, v55, v180, v181
    v_max3_f32 v55, v55, v182, v183
    v_max3_f32 v55, v55, v172, v173
    v_max3_f32 v55, v55, v174, v175
    v_max3_f32 v55, v55, v188, v189
    v_max3_f32 v55, v55, v190, v191
    v_mov_b32 v6, v55
    s_nop 1
    v_permlane16_swap_b32 v55, v6
    s_nop 1
    v_max_f32 v55, v55, v6
    v_mov_b32 v6, v55
    s_nop 1
    v_permlane32_swap_b32 v55, v6
    s_nop 1
    v_max_f32 v55, v55, v6
    v_max_f32 v55, 0, v55
    v_sub_f32 v160, v160, v54
    v_sub_f32 v161, v161, v54
    v_sub_f32 v162, v162, v54
    v_sub_f32 v163, v163, v54
    v_sub_f32 v164, v164, v55
    v_sub_f32 v165, v165, v55
    v_sub_f32 v166, v166, v55
    v_sub_f32 v167, v167, v55
    v_sub_f32 v168, v168, v54
    v_sub_f32 v169, v169, v54
    v_sub_f32 v170, v170, v54
    v_sub_f32 v171, v171, v54
    v_sub_f32 v172, v172, v55
    v_sub_f32 v173, v173, v55
    v_sub_f32 v174, v174, v55
    v_sub_f32 v175, v175, v55
    v_sub_f32 v176, v176, v54
    v_sub_f32 v177, v177, v54
    v_sub_f32 v178, v178, v54
    v_sub_f32 v179, v179, v54
    v_sub_f32 v180, v180, v55
    v_sub_f32 v181, v181, v55
    v_sub_f32 v182, v182, v55
    v_sub_f32 v183, v183, v55
    v_sub_f32 v184, v184, v54
    v_sub_f32 v185, v185, v54
    v_sub_f32 v186, v186, v54
    v_sub_f32 v187, v187, v54
    v_sub_f32 v188, v188, v55
    v_sub_f32 v189, v189, v55
    v_sub_f32 v190, v190, v55
    v_sub_f32 v191, v191, v55
    v_sub_f32 v10, v10, v54
    v_exp_f32 v54, -v54
    v_sub_f32 v11, v11, v55
    v_exp_f32 v55, -v55
    s_nop 0
    v_mul_f32 v14, v14, v54
    v_mul_f32 v15, v15, v55
    v_accvgpr_read_b32 v224, a8
    v_accvgpr_read_b32 v225, a9
    v_accvgpr_read_b32 v226, a10
    v_accvgpr_read_b32 v227, a11
    v_mul_f32 v224, v224, v54
    v_mul_f32 v225, v225, v54
    v_mul_f32 v226, v226, v54
    v_mul_f32 v227, v227, v54
    v_accvgpr_write_b32 a8, v224
    v_accvgpr_write_b32 a9, v225
    v_accvgpr_write_b32 a10, v226
    v_accvgpr_write_b32 a11, v227
    v_accvgpr_read_b32 v224, a12
    v_accvgpr_read_b32 v225, a13
    v_accvgpr_read_b32 v226, a14
    v_accvgpr_read_b32 v227, a15
    v_mul_f32 v224, v224, v55
    v_mul_f32 v225, v225, v55
    v_mul_f32 v226, v226, v55
    v_mul_f32 v227, v227, v55
    v_accvgpr_write_b32 a12, v224
    v_accvgpr_write_b32 a13, v225
    v_accvgpr_write_b32 a14, v226
    v_accvgpr_write_b32 a15, v227
    v_accvgpr_read_b32 v224, a24
    v_accvgpr_read_b32 v225, a25
    v_accvgpr_read_b32 v226, a26
    v_accvgpr_read_b32 v227, a27
    v_mul_f32 v224, v224, v54
    v_mul_f32 v225, v225, v54
    v_mul_f32 v226, v226, v54
    v_mul_f32 v227, v227, v54
    v_accvgpr_write_b32 a24, v224
    v_accvgpr_write_b32 a25, v225
    v_accvgpr_write_b32 a26, v226
    v_accvgpr_write_b32 a27, v227
    v_accvgpr_read_b32 v224, a28
    v_accvgpr_read_b32 v225, a29
    v_accvgpr_read_b32 v226, a30
    v_accvgpr_read_b32 v227, a31
    v_mul_f32 v224, v224, v55
    v_mul_f32 v225, v225, v55
    v_mul_f32 v226, v226, v55
    v_mul_f32 v227, v227, v55
    v_accvgpr_write_b32 a28, v224
    v_accvgpr_write_b32 a29, v225
    v_accvgpr_write_b32 a30, v226
    v_accvgpr_write_b32 a31, v227
    v_accvgpr_read_b32 v224, a40
    v_accvgpr_read_b32 v225, a41
    v_accvgpr_read_b32 v226, a42
    v_accvgpr_read_b32 v227, a43
    v_mul_f32 v224, v224, v54
    v_mul_f32 v225, v225, v54
    v_mul_f32 v226, v226, v54
    v_mul_f32 v227, v227, v54
    v_accvgpr_write_b32 a40, v224
    v_accvgpr_write_b32 a41, v225
    v_accvgpr_write_b32 a42, v226
    v_accvgpr_write_b32 a43, v227
    v_accvgpr_read_b32 v224, a44
    v_accvgpr_read_b32 v225, a45
    v_accvgpr_read_b32 v226, a46
    v_accvgpr_read_b32 v227, a47
    v_mul_f32 v224, v224, v55
    v_mul_f32 v225, v225, v55
    v_mul_f32 v226, v226, v55
    v_mul_f32 v227, v227, v55
    v_accvgpr_write_b32 a44, v224
    v_accvgpr_write_b32 a45, v225
    v_accvgpr_write_b32 a46, v226
    v_accvgpr_write_b32 a47, v227
    v_accvgpr_read_b32 v224, a56
    v_accvgpr_read_b32 v225, a57
    v_accvgpr_read_b32 v226, a58
    v_accvgpr_read_b32 v227, a59
    v_mul_f32 v224, v224, v54
    v_mul_f32 v225, v225, v54
    v_mul_f32 v226, v226, v54
    v_mul_f32 v227, v227, v54
    v_accvgpr_write_b32 a56, v224
    v_accvgpr_write_b32 a57, v225
    v_accvgpr_write_b32 a58, v226
    v_accvgpr_write_b32 a59, v227
    v_accvgpr_read_b32 v224, a60
    v_accvgpr_read_b32 v225, a61
    v_accvgpr_read_b32 v226, a62
    v_accvgpr_read_b32 v227, a63
    v_mul_f32 v224, v224, v55
    v_mul_f32 v225, v225, v55
    v_mul_f32 v226, v226, v55
    v_mul_f32 v227, v227, v55
    v_accvgpr_write_b32 a60, v224
    v_accvgpr_write_b32 a61, v225
    v_accvgpr_write_b32 a62, v226
    v_accvgpr_write_b32 a63, v227
    v_accvgpr_read_b32 v224, a72
    v_accvgpr_read_b32 v225, a73
    v_accvgpr_read_b32 v226, a74
    v_accvgpr_read_b32 v227, a75
    v_mul_f32 v224, v224, v54
    v_mul_f32 v225, v225, v54
    v_mul_f32 v226, v226, v54
    v_mul_f32 v227, v227, v54
    v_accvgpr_write_b32 a72, v224
    v_accvgpr_write_b32 a73, v225
    v_accvgpr_write_b32 a74, v226
    v_accvgpr_write_b32 a75, v227
    v_accvgpr_read_b32 v224, a76
    v_accvgpr_read_b32 v225, a77
    v_accvgpr_read_b32 v226, a78
    v_accvgpr_read_b32 v227, a79
    v_mul_f32 v224, v224, v55
    v_mul_f32 v225, v225, v55
    v_mul_f32 v226, v226, v55
    v_mul_f32 v227, v227, v55
    v_accvgpr_write_b32 a76, v224
    v_accvgpr_write_b32 a77, v225
    v_accvgpr_write_b32 a78, v226
    v_accvgpr_write_b32 a79, v227
    v_accvgpr_read_b32 v224, a88
    v_accvgpr_read_b32 v225, a89
    v_accvgpr_read_b32 v226, a90
    v_accvgpr_read_b32 v227, a91
    v_mul_f32 v224, v224, v54
    v_mul_f32 v225, v225, v54
    v_mul_f32 v226, v226, v54
    v_mul_f32 v227, v227, v54
    v_accvgpr_write_b32 a88, v224
    v_accvgpr_write_b32 a89, v225
    v_accvgpr_write_b32 a90, v226
    v_accvgpr_write_b32 a91, v227
    v_accvgpr_read_b32 v224, a92
    v_accvgpr_read_b32 v225, a93
    v_accvgpr_read_b32 v226, a94
    v_accvgpr_read_b32 v227, a95
    v_mul_f32 v224, v224, v55
    v_mul_f32 v225, v225, v55
    v_mul_f32 v226, v226, v55
    v_mul_f32 v227, v227, v55
    v_accvgpr_write_b32 a92, v224
    v_accvgpr_write_b32 a93, v225
    v_accvgpr_write_b32 a94, v226
    v_accvgpr_write_b32 a95, v227
    v_accvgpr_read_b32 v224, a104
    v_accvgpr_read_b32 v225, a105
    v_accvgpr_read_b32 v226, a106
    v_accvgpr_read_b32 v227, a107
    v_mul_f32 v224, v224, v54
    v_mul_f32 v225, v225, v54
    v_mul_f32 v226, v226, v54
    v_mul_f32 v227, v227, v54
    v_accvgpr_write_b32 a104, v224
    v_accvgpr_write_b32 a105, v225
    v_accvgpr_write_b32 a106, v226
    v_accvgpr_write_b32 a107, v227
    v_accvgpr_read_b32 v224, a108
    v_accvgpr_read_b32 v225, a109
    v_accvgpr_read_b32 v226, a110
    v_accvgpr_read_b32 v227, a111
    v_mul_f32 v224, v224, v55
    v_mul_f32 v225, v225, v55
    v_mul_f32 v226, v226, v55
    v_mul_f32 v227, v227, v55
    v_accvgpr_write_b32 a108, v224
    v_accvgpr_write_b32 a109, v225
    v_accvgpr_write_b32 a110, v226
    v_accvgpr_write_b32 a111, v227
    v_accvgpr_read_b32 v224, a120
    v_accvgpr_read_b32 v225, a121
    v_accvgpr_read_b32 v226, a122
    v_accvgpr_read_b32 v227, a123
    v_mul_f32 v224, v224, v54
    v_mul_f32 v225, v225, v54
    v_mul_f32 v226, v226, v54
    v_mul_f32 v227, v227, v54
    v_accvgpr_write_b32 a120, v224
    v_accvgpr_write_b32 a121, v225
    v_accvgpr_write_b32 a122, v226
    v_accvgpr_write_b32 a123, v227
    v_accvgpr_read_b32 v224, a124
    v_accvgpr_read_b32 v225, a125
    v_accvgpr_read_b32 v226, a126
    v_accvgpr_read_b32 v227, a127
    v_mul_f32 v224, v224, v55
    v_mul_f32 v225, v225, v55
    v_mul_f32 v226, v226, v55
    v_mul_f32 v227, v227, v55
    v_accvgpr_write_b32 a124, v224
    v_accvgpr_write_b32 a125, v225
    v_accvgpr_write_b32 a126, v226
    v_accvgpr_write_b32 a127, v227
    v_exp_f32 v232, v160
    v_exp_f32 v233, v161
    v_exp_f32 v234, v162
    v_exp_f32 v235, v163
    v_add_f32 v48, v232, v233
    v_cvt_pk_bf16_f32 v208, v232, v233
    v_exp_f32 v236, v176
    v_exp_f32 v237, v177
    v_add_f32 v48, v48, v234
    v_add_f32 v48, v48, v235
    v_cvt_pk_bf16_f32 v209, v234, v235
    v_exp_f32 v238, v178
    v_exp_f32 v239, v179
    v_add_f32 v48, v48, v236
    v_add_f32 v48, v48, v237
    v_cvt_pk_bf16_f32 v210, v236, v237
    v_exp_f32 v240, v164
    v_exp_f32 v241, v165
    v_add_f32 v48, v48, v238
    v_add_f32 v48, v48, v239
    v_cvt_pk_bf16_f32 v211, v238, v239
    v_exp_f32 v242, v166
    v_exp_f32 v243, v167
    v_add_f32 v49, v240, v241
    v_cvt_pk_bf16_f32 v212, v240, v241
    v_exp_f32 v244, v180
    v_exp_f32 v245, v181
    v_add_f32 v49, v49, v242
    v_add_f32 v49, v49, v243
    v_cvt_pk_bf16_f32 v213, v242, v243
    v_exp_f32 v246, v182
    v_exp_f32 v247, v183
    v_add_f32 v49, v49, v244
    v_add_f32 v49, v49, v245
    v_cvt_pk_bf16_f32 v214, v244, v245
    v_exp_f32 v232, v168
    v_exp_f32 v233, v169
    v_add_f32 v49, v49, v246
    v_add_f32 v49, v49, v247
    v_cvt_pk_bf16_f32 v215, v246, v247
    v_exp_f32 v234, v170
    v_exp_f32 v235, v171
    v_add_f32 v50, v232, v233
    v_cvt_pk_bf16_f32 v216, v232, v233
    v_exp_f32 v236, v184
    v_exp_f32 v237, v185
    v_add_f32 v50, v50, v234
    v_add_f32 v50, v50, v235
    v_cvt_pk_bf16_f32 v217, v234, v235
    v_exp_f32 v238, v186
    v_exp_f32 v239, v187
    v_add_f32 v50, v50, v236
    v_add_f32 v50, v50, v237
    v_cvt_pk_bf16_f32 v218, v236, v237
    v_exp_f32 v240, v172
    v_exp_f32 v241, v173
    v_add_f32 v50, v50, v238
    v_add_f32 v50, v50, v239
    v_cvt_pk_bf16_f32 v219, v238, v239
    v_exp_f32 v242, v174
    v_exp_f32 v243, v175
    v_add_f32 v51, v240, v241
    v_cvt_pk_bf16_f32 v220, v240, v241
    v_exp_f32 v244, v188
    v_exp_f32 v245, v189
    v_add_f32 v51, v51, v242
    v_add_f32 v51, v51, v243
    v_cvt_pk_bf16_f32 v221, v242, v243
    v_exp_f32 v246, v190
    v_exp_f32 v247, v191
    v_add_f32 v51, v51, v244
    v_add_f32 v51, v51, v245
    v_cvt_pk_bf16_f32 v222, v244, v245
    s_nop 0
    v_add_f32 v51, v51, v246
    v_add_f32 v51, v51, v247
    v_cvt_pk_bf16_f32 v223, v246, v247
    s_nop 1
    s_branch k2_ret_75
k12_ool_7:
    buffer_load_dword v52, v8, s[24:27], 0 offen sc1
    s_branch k12_oolret_8
k12_ool_9:
    s_mov_b64 exec, 1
    buffer_atomic_add v9, v8, s[24:27], 0 offen sc1
    s_mov_b64 exec, -1
    s_branch k12_oolret_10
k12_ool_11:
    buffer_load_dword v51, v50, s[12:15], s56 offen
    s_branch k12_oolret_12
k12_ool_15:
    v_readfirstlane_b32 s31, v52
    s_cmp_ge_u32 s31, 256
    s_cbranch_scc1 spin_ok_13
    s_mov_b32 s40, 1048576
spin_14:
    s_sleep 8
    buffer_load_dword v52, v8, s[24:27], 0 offen sc1
    s_waitcnt vmcnt(0)
    v_readfirstlane_b32 s31, v52
    s_sub_u32 s40, s40, 1
    s_cselect_b32 s31, -1, s31
    s_cmp_lt_u32 s31, 256
    s_cbranch_scc1 spin_14
spin_ok_13:
    s_branch k12_oolret_16
k12_ool_17:
    s_mov_b64 exec, 1
    buffer_atomic_add v9, v8, s[24:27], 0 offen sc1
    s_mov_b64 exec, -1
    s_branch k12_oolret_18
k12_ool_21:
    buffer_load_dword v52, v8, s[24:27], 0 offen sc1
    s_branch k12_oolret_22
k12_ool_23:
    s_mov_b64 exec, 1
    buffer_atomic_add v9, v8, s[24:27], 0 offen sc1
    s_mov_b64 exec, -1
    s_branch k12_oolret_24
k12_ool_25:
    buffer_load_dword v51, v50, s[12:15], s56 offen
    s_branch k12_oolret_26
k12_ool_29:
    v_readfirstlane_b32 s31, v52
    s_cmp_ge_u32 s31, 256
    s_cbranch_scc1 spin_ok_27
    s_mov_b32 s40, 1048576
spin_28:
    s_sleep 8
    buffer_load_dword v52, v8, s[24:27], 0 offen sc1
    s_waitcnt vmcnt(0)
    v_readfirstlane_b32 s31, v52
    s_sub_u32 s40, s40, 1
    s_cselect_b32 s31, -1, s31
    s_cmp_lt_u32 s31, 256
    s_cbranch_scc1 spin_28
spin_ok_27:
    s_branch k12_oolret_30
k12_ool_31:
    s_mov_b64 exec, 1
    buffer_atomic_add v9, v8, s[24:27], 0 offen sc1
    s_mov_b64 exec, -1
    s_branch k12_oolret_32
k12_ool_33:
    s_mov_b64 exec, 1
    buffer_atomic_add v9, v8, s[24:27], s54 offen sc1
    s_mov_b64 exec, -1
    s_branch k12_oolret_34
k12_ool_35:
    buffer_load_dword v52, v8, s[24:27], s55 offen sc1
    s_branch k12_oolret_36
k12_ool_39:
    s_waitcnt vmcnt(12)
    v_readfirstlane_b32 s31, v52
    s_cmp_ge_u32 s31, 16
    s_cbranch_scc1 spin_ok_37
    s_mov_b32 s40, 1048576
spin_38:
    s_sleep 8
    buffer_load_dword v52, v8, s[24:27], s55 offen sc1
    s_waitcnt vmcnt(0)
    v_readfirstlane_b32 s31, v52
    s_sub_u32 s40, s40, 1
    s_cselect_b32 s31, -1, s31
    s_cmp_lt_u32 s31, 16
    s_cbranch_scc1 spin_38
spin_ok_37:
    s_branch k12_oolret_40
.globl k3_kernel
.p2align 8
.type k3_kernel,@function
k3_kernel:
    s_cmp_ge_u32 s2, 256
    s_cbranch_scc1 k3_end_76
    s_load_dwordx2 s[4:5], s[0:1], 40
    s_load_dwordx2 s[6:7], s[0:1], 104
    s_load_dwordx2 s[28:29], s[0:1], 0
    s_load_dwordx2 s[30:31], s[0:1], 56
    s_and_b32 s40, s2, 7
    s_lshr_b32 s41, s2, 3
    s_and_b32 s42, s40, 3
    s_lshl_b32 s42, s42, 2
    s_and_b32 s43, s41, 3
    s_add_u32 s42, s42, s43
    s_lshr_b32 s43, s40, 2
    s_lshl_b32 s43, s43, 3
    s_lshr_b32 s44, s41, 2
    s_add_u32 s43, s43, s44
    v_lshrrev_b32 v10, 6, v0
    v_and_b32 v11, 63, v0
    v_readfirstlane_b32 s45, v10
    v_lshlrev_b32 v1, 4, v11
    s_lshl_b32 s46, s42, 7
    s_lshl_b32 s47, s45, 5
    s_add_u32 s46, s46, s47
    s_lshl_b32 s47, s46, 6
    v_add_u32 v12, s47, v1
    v_add_u32 v13, 0x20000, v12
    v_lshrrev_b32 v20, 3, v11
    v_bfe_u32 v21, v11, 1, 2
    v_bfe_u32 v22, v11, 4, 2
    v_xor_b32 v21, v21, v22
    v_and_b32 v22, 1, v11
    v_lshl_add_u32 v23, v10, 5, v20
    v_lshlrev_b32 v23, 11, v23
    v_lshl_add_u32 v23, v22, 4, v23
    v_lshl_add_u32 v23, v21, 5, v23
    s_lshl_b32 s47, s43, 7
    v_add_u32 v23, s47, v23
    v_add_u32 v16, 0, v23
    v_add_u32 v17, 15360, v23
    v_add_u32 v18, 30720, v23
    v_add_u32 v19, 46080, v23
    s_waitcnt lgkmcnt(0)
    s_add_u32 s8, s6, 0x3000000
    s_addc_u32 s9, s7, 0
    s_and_b32 s9, s9, 0xffff
    s_mov_b32 s10, 0x1000000
    s_mov_b32 s11, 0x00020000
    s_mov_b32 s12, s4
    s_and_b32 s13, s5, 0xffff
    s_mov_b32 s14, 0x800000
    s_mov_b32 s15, 0x00020000
    s_lshl_b32 s60, s45, 12
    s_mov_b32 s61, 0
    s_mov_b32 s62, 0
    s_and_b32 s51, s41, 15
    s_add_u32 s50, s45, 36
    s_lshl_b32 s52, s50, 2
    s_lshr_b32 s53, s51, 2
    s_add_u32 s52, s52, s53
    s_lshl_b32 s52, s52, 17
    s_and_b32 s53, s51, 3
    s_lshl_b32 s53, s53, 13
    s_add_u32 s52, s52, s53
    s_and_b32 s53, s40, 3
    s_lshl_b32 s53, s53, 15
    s_add_u32 s52, s52, s53
    v_lshlrev_b32 v5, 7, v11
    s_lshl_b32 s53, s50, 18
    s_lshl_b32 s54, s51, 14
    s_add_u32 s53, s53, s54
    s_lshr_b32 s54, s40, 2
    s_lshl_b32 s54, s54, 10
    s_add_u32 s53, s53, s54
    v_and_b32 v6, 7, v11
    v_lshlrev_b32 v6, 7, v6
    v_lshl_add_u32 v6, v20, 11, v6
    s_cmp_lt_u32 s41, 16
    s_cselect_b32 s36, s8, s12
    s_cselect_b32 s37, s9, s13
    s_cselect_b32 s38, s10, s14
    s_mov_b32 s39, 0x00020000
    s_cselect_b32 s55, s52, s53
    s_mov_b32 s56, 0x100000
    s_cselect_b32 s56, 0x200000, s56
    s_cselect_b64 vcc, -1, 0
    v_cndmask_b32 v5, v6, v5, vcc
    s_mov_b32 s16, s28
    s_and_b32 s17, s29, 0xffff
    s_mov_b32 s18, 0x400000
    s_mov_b32 s19, 0x00020000
    s_mov_b32 s20, s30
    s_and_b32 s21, s31, 0xffff
    s_mov_b32 s22, 0x800
    s_mov_b32 s23, 0x00020000
    s_add_u32 s24, s6, 0x4000000
    s_addc_u32 s25, s7, 0
    s_and_b32 s25, s25, 0xffff
    s_mov_b32 s26, 0x400000
    s_mov_b32 s27, 0x00020000
    s_add_u32 s32, s6, 0x4800000
    s_addc_u32 s33, s7, 0
    s_and_b32 s33, s33, 0xffff
    s_mov_b32 s34, 0x6000
    s_mov_b32 s35, 0x00020000
    v_and_b32 v21, 15, v11
    v_lshrrev_b32 v20, 4, v11
    v_add_u32 v22, s46, v21
    v_lshlrev_b32 v2, 2, v22
    v_lshl_add_u32 v2, v20, 13, v2
    v_lshlrev_b32 v22, 11, v22
    v_lshl_add_u32 v14, v20, 3, s47
    v_add_u32 v3, v22, v14
    v_add_u32 v4, 0x8000, v3
    buffer_load_dwordx2 v[96:97], v3, s[16:19], 0 offen offset:0
    buffer_load_dwordx2 v[100:101], v3, s[16:19], 0 offen offset:32
    buffer_load_dwordx2 v[104:105], v3, s[16:19], 0 offen offset:64
    buffer_load_dwordx2 v[108:109], v3, s[16:19], 0 offen offset:96
    buffer_load_dwordx2 v[98:99], v4, s[16:19], 0 offen offset:0
    buffer_load_dwordx2 v[102:103], v4, s[16:19], 0 offen offset:32
    buffer_load_dwordx2 v[106:107], v4, s[16:19], 0 offen offset:64
    buffer_load_dwordx2 v[110:111], v4, s[16:19], 0 offen offset:96
    buffer_load_dwordx2 v[112:113], v14, s[20:23], 0 offen offset:0
    buffer_load_dwordx2 v[114:115], v14, s[20:23], 0 offen offset:32
    buffer_load_dwordx2 v[116:117], v14, s[20:23], 0 offen offset:64
    buffer_load_dwordx2 v[118:119], v14, s[20:23], 0 offen offset:96
    s_add_u32 m0, s60, 0
    s_nop 0
    buffer_load_dwordx4 v16, s[12:15], s61 offen offset:0 lds
    buffer_load_dwordx4 v17, s[12:15], s61 offen offset:1024 lds
    buffer_load_dwordx4 v18, s[12:15], s61 offen offset:2048 lds
    buffer_load_dwordx4 v19, s[12:15], s61 offen offset:3072 lds
    s_add_u32 s61, s61, 0x40000
    buffer_load_dwordx4 a[0:3], v12, s[8:11], s62 offen offset:0
    buffer_load_dwordx4 a[4:7], v12, s[8:11], s62 offen offset:1024
    buffer_load_dwordx4 a[8:11], v13, s[8:11], s62 offen offset:0
    buffer_load_dwordx4 a[12:15], v13, s[8:11], s62 offen offset:1024
    s_add_u32 s62, s62, 0x40000
    buffer_load_dwordx4 a[16:19], v12, s[8:11], s62 offen offset:0
    buffer_load_dwordx4 a[20:23], v12, s[8:11], s62 offen offset:1024
    buffer_load_dwordx4 a[24:27], v13, s[8:11], s62 offen offset:0
    buffer_load_dwordx4 a[28:31], v13, s[8:11], s62 offen offset:1024
    s_add_u32 s62, s62, 0x40000
    s_add_u32 m0, s60, 16384
    s_nop 0
    buffer_load_dwordx4 v16, s[12:15], s61 offen offset:0 lds
    buffer_load_dwordx4 v17, s[12:15], s61 offen offset:1024 lds
    buffer_load_dwordx4 v18, s[12:15], s61 offen offset:2048 lds
    buffer_load_dwordx4 v19, s[12:15], s61 offen offset:3072 lds
    s_add_u32 s61, s61, 0x40000
    buffer_load_dwordx4 a[32:35], v12, s[8:11], s62 offen offset:0
    buffer_load_dwordx4 a[36:39], v12, s[8:11], s62 offen offset:1024
    buffer_load_dwordx4 a[40:43], v13, s[8:11], s62 offen offset:0
    buffer_load_dwordx4 a[44:47], v13, s[8:11], s62 offen offset:1024
    s_add_u32 s62, s62, 0x40000
    buffer_load_dword v7, v5, s[36:39], s55 offen
    s_add_u32 s55, s55, s56
    v_lshrrev_b32 v22, 2, v21
    v_lshl_add_u32 v22, v20, 2, v22
    v_bfe_u32 v23, v22, 1, 2
    v_lshlrev_b32 v22, 7, v22
    v_and_b32 v28, 3, v11
    v_lshl_add_u32 v22, v28, 3, v22
    v_xor_b32 v28, 0, v23
    v_lshl_add_u32 v24, v28, 5, v22
    v_xor_b32 v28, 1, v23
    v_lshl_add_u32 v25, v28, 5, v22
    v_xor_b32 v28, 2, v23
    v_lshl_add_u32 v26, v28, 5, v22
    v_xor_b32 v28, 3, v23
    v_lshl_add_u32 v27, v28, 5, v22
    v_mov_b32 v64, 0
    v_mov_b32 v65, 0
    v_mov_b32 v66, 0
    v_mov_b32 v67, 0
    v_mov_b32 v68, 0
    v_mov_b32 v69, 0
    v_mov_b32 v70, 0
    v_mov_b32 v71, 0
    v_mov_b32 v72, 0
    v_mov_b32 v73, 0
    v_mov_b32 v74, 0
    v_mov_b32 v75, 0
    v_mov_b32 v76, 0
    v_mov_b32 v77, 0
    v_mov_b32 v78, 0
    v_mov_b32 v79, 0
    v_mov_b32 v80, 0
    v_mov_b32 v81, 0
    v_mov_b32 v82, 0
    v_mov_b32 v83, 0
    v_mov_b32 v84, 0
    v_mov_b32 v85, 0
    v_mov_b32 v86, 0
    v_mov_b32 v87, 0
    v_mov_b32 v88, 0
    v_mov_b32 v89, 0
    v_mov_b32 v90, 0
    v_mov_b32 v91, 0
    v_mov_b32 v92, 0
    v_mov_b32 v93, 0
    v_mov_b32 v94, 0
    v_mov_b32 v95, 0
    s_waitcnt vmcnt(17)
    s_barrier
    ds_read_b64_tr_b16 a[128:129], v24 offset:0
    ds_read_b64_tr_b16 a[130:131], v24 offset:2048
    ds_read_b64_tr_b16 a[132:133], v25 offset:0
    ds_read_b64_tr_b16 a[134:135], v25 offset:2048
    ds_read_b64_tr_b16 a[136:137], v26 offset:0
    ds_read_b64_tr_b16 a[138:139], v26 offset:2048
    ds_read_b64_tr_b16 a[140:141], v27 offset:0
    ds_read_b64_tr_b16 a[142:143], v27 offset:2048
    ds_read_b64_tr_b16 a[144:145], v24 offset:4096
    ds_read_b64_tr_b16 a[146:147], v24 offset:6144
    ds_read_b64_tr_b16 a[148:149], v25 offset:4096
    ds_read_b64_tr_b16 a[150:151], v25 offset:6144
    ds_read_b64_tr_b16 a[152:153], v26 offset:4096
    ds_read_b64_tr_b16 a[154:155], v26 offset:6144
    ds_read_b64_tr_b16 a[156:157], v27 offset:4096
    ds_read_b64_tr_b16 a[158:159], v27 offset:6144
    s_mov_b32 s63, 0
k3_loop_77:
    s_waitcnt vmcnt(12) lgkmcnt(0)
    v_mfma_f32_16x16x32_bf16 v[64:67], a[128:131], a[0:3], v[64:67]
    ds_read_b64_tr_b16 a[160:161], v24 offset:8192
    ds_read_b64_tr_b16 a[162:163], v24 offset:10240
    v_mfma_f32_16x16x32_bf16 v[68:71], a[128:131], a[4:7], v[68:71]
    ds_read_b64_tr_b16 a[164:165], v25 offset:8192
    ds_read_b64_tr_b16 a[166:167], v25 offset:10240
    v_mfma_f32_16x16x32_bf16 v[72:75], a[132:135], a[0:3], v[72:75]
    ds_read_b64_tr_b16 a[168:169], v26 offset:8192
    buffer_load_dwordx4 a[48:51], v12, s[8:11], s62 offen offset:0
    v_mfma_f32_16x16x32_bf16 v[76:79], a[132:135], a[4:7], v[76:79]
    ds_read_b64_tr_b16 a[170:171], v26 offset:10240
    ds_read_b64_tr_b16 a[172:173], v27 offset:8192
    v_mfma_f32_16x16x32_bf16 v[80:83], a[136:139], a[0:3], v[80:83]
    ds_read_b64_tr_b16 a[174:175], v27 offset:10240
    buffer_load_dwordx4 a[52:55], v12, s[8:11], s62 offen offset:1024
    v_mfma_f32_16x16x32_bf16 v[84:87], a[136:139], a[4:7], v[84:87]
    ds_read_b64_tr_b16 a[176:177], v24 offset:12288
    ds_read_b64_tr_b16 a[178:179], v24 offset:14336
    v_mfma_f32_16x16x32_bf16 v[88:91], a[140:143], a[0:3], v[88:91]
    ds_read_b64_tr_b16 a[180:181], v25 offset:12288
    ds_read_b64_tr_b16 a[182:183], v25 offset:14336
    buffer_load_dwordx4 a[56:59], v13, s[8:11], s62 offen offset:0
    v_mfma_f32_16x16x32_bf16 v[92:95], a[140:143], a[4:7], v[92:95]
    ds_read_b64_tr_b16 a[184:185], v26 offset:12288
    v_mfma_f32_16x16x32_bf16 v[64:67], a[144:147], a[8:11], v[64:67]
    ds_read_b64_tr_b16 a[186:187], v26 offset:14336
    ds_read_b64_tr_b16 a[188:189], v27 offset:12288
    buffer_load_dwordx4 a[60:63], v13, s[8:11], s62 offen offset:1024
    v_mfma_f32_16x16x32_bf16 v[68:71], a[144:147], a[12:15], v[68:71]
    ds_read_b64_tr_b16 a[190:191], v27 offset:14336
    v_mfma_f32_16x16x32_bf16 v[72:75], a[148:151], a[8:11], v[72:75]
    s_add_u32 s62, s62, 0x40000
    v_mfma_f32_16x16x32_bf16 v[76:79], a[148:151], a[12:15], v[76:79]
    v_mfma_f32_16x16x32_bf16 v[80:83], a[152:155], a[8:11], v[80:83]
    s_cmp_lg_u32 s45, 0
    s_cbranch_scc1 k3_pf_78
    buffer_load_dword v7, v5, s[36:39], s55 offen
    s_add_u32 s55, s55, s56
k3_pf_78:
    v_mfma_f32_16x16x32_bf16 v[84:87], a[152:155], a[12:15], v[84:87]
    v_mfma_f32_16x16x32_bf16 v[88:91], a[156:159], a[8:11], v[88:91]
    v_mfma_f32_16x16x32_bf16 v[92:95], a[156:159], a[12:15], v[92:95]
    s_waitcnt vmcnt(8) lgkmcnt(0)
    s_barrier
    v_mfma_f32_16x16x32_bf16 v[64:67], a[160:163], a[16:19], v[64:67]
    ds_read_b64_tr_b16 a[128:129], v24 offset:16384
    ds_read_b64_tr_b16 a[130:131], v24 offset:18432
    v_mfma_f32_16x16x32_bf16 v[68:71], a[160:163], a[20:23], v[68:71]
    ds_read_b64_tr_b16 a[132:133], v25 offset:16384
    ds_read_b64_tr_b16 a[134:135], v25 offset:18432
    s_add_u32 m0, s60, 32768
    s_nop 0
    buffer_load_dwordx4 v16, s[12:15], s61 offen offset:0 lds
    v_mfma_f32_16x16x32_bf16 v[72:75], a[164:167], a[16:19], v[72:75]
    ds_read_b64_tr_b16 a[136:137], v26 offset:16384
    buffer_load_dwordx4 v17, s[12:15], s61 offen offset:1024 lds
    v_mfma_f32_16x16x32_bf16 v[76:79], a[164:167], a[20:23], v[76:79]
    ds_read_b64_tr_b16 a[138:139], v26 offset:18432
    ds_read_b64_tr_b16 a[140:141], v27 offset:16384
    buffer_load_dwordx4 v18, s[12:15], s61 offen offset:2048 lds
    v_mfma_f32_16x16x32_bf16 v[80:83], a[168:171], a[16:19], v[80:83]
    ds_read_b64_tr_b16 a[142:143], v27 offset:18432
    v_mfma_f32_16x16x32_bf16 v[84:87], a[168:171], a[20:23], v[84:87]
    ds_read_b64_tr_b16 a[144:145], v24 offset:20480
    ds_read_b64_tr_b16 a[146:147], v24 offset:22528
    buffer_load_dwordx4 v19, s[12:15], s61 offen offset:3072 lds
    v_mfma_f32_16x16x32_bf16 v[88:91], a[172:175], a[16:19], v[88:91]
    ds_read_b64_tr_b16 a[148:149], v25 offset:20480
    ds_read_b64_tr_b16 a[150:151], v25 offset:22528
    s_add_u32 s61, s61, 0x40000
    v_mfma_f32_16x16x32_bf16 v[92:95], a[172:175], a[20:23], v[92:95]
    ds_read_b64_tr_b16 a[152:153], v26 offset:20480
    v_mfma_f32_16x16x32_bf16 v[64:67], a[176:179], a[24:27], v[64:67]
    ds_read_b64_tr_b16 a[154:155], v26 offset:22528
    ds_read_b64_tr_b16 a[156:157], v27 offset:20480
    buffer_load_dwordx4 a[64:67], v12, s[8:11], s62 offen offset:0
    v_mfma_f32_16x16x32_bf16 v[68:71], a[176:179], a[28:31], v[68:71]
    ds_read_b64_tr_b16 a[158:159], v27 offset:22528
    buffer_load_dwordx4 a[68:71], v12, s[8:11], s62 offen offset:1024
    v_mfma_f32_16x16x32_bf16 v[72:75], a[180:183], a[24:27], v[72:75]
    buffer_load_dwordx4 a[72:75], v13, s[8:11], s62 offen offset:0
    v_mfma_f32_16x16x32_bf16 v[76:79], a[180:183], a[28:31], v[76:79]
    v_mfma_f32_16x16x32_bf16 v[80:83], a[184:187], a[24:27], v[80:83]
    buffer_load_dwordx4 a[76:79], v13, s[8:11], s62 offen offset:1024
    v_mfma_f32_16x16x32_bf16 v[84:87], a[184:187], a[28:31], v[84:87]
    s_add_u32 s62, s62, 0x40000
    v_mfma_f32_16x16x32_bf16 v[88:91], a[188:191], a[24:27], v[88:91]
    v_mfma_f32_16x16x32_bf16 v[92:95], a[188:191], a[28:31], v[92:95]
    s_waitcnt vmcnt(12) lgkmcnt(0)
    v_mfma_f32_16x16x32_bf16 v[64:67], a[128:131], a[32:35], v[64:67]
    ds_read_b64_tr_b16 a[160:161], v24 offset:24576
    ds_read_b64_tr_b16 a[162:163], v24 offset:26624
    v_mfma_f32_16x16x32_bf16 v[68:71], a[128:131], a[36:39], v[68:71]
    ds_read_b64_tr_b16 a[164:165], v25 offset:24576
    ds_read_b64_tr_b16 a[166:167], v25 offset:26624
    v_mfma_f32_16x16x32_bf16 v[72:75], a[132:135], a[32:35], v[72:75]
    ds_read_b64_tr_b16 a[168:169], v26 offset:24576
    buffer_load_dwordx4 a[80:83], v12, s[8:11], s62 offen offset:0
    v_mfma_f32_16x16x32_bf16 v[76:79], a[132:135], a[36:39], v[76:79]
    ds_read_b64_tr_b16 a[170:171], v26 offset:26624
    ds_read_b64_tr_b16 a[172:173], v27 offset:24576
    v_mfma_f32_16x16x32_bf16 v[80:83], a[136:139], a[32:35], v[80:83]
    ds_read_b64_tr_b16 a[174:175], v27 offset:26624
    buffer_load_dwordx4 a[84:87], v12, s[8:11], s62 offen offset:1024
    v_mfma_f32_16x16x32_bf16 v[84:87], a[136:139], a[36:39], v[84:87]
    ds_read_b64_tr_b16 a[176:177], v24 offset:28672
    ds_read_b64_tr_b16 a[178:179], v24 offset:30720
    v_mfma_f32_16x16x32_bf16 v[88:91], a[140:143], a[32:35], v[88:91]
    ds_read_b64_tr_b16 a[180:181], v25 offset:28672
    ds_read_b64_tr_b16 a[182:183], v25 offset:30720
    buffer_load_dwordx4 a[88:91], v13, s[8:11], s62 offen offset:0
    v_mfma_f32_16x16x32_bf16 v[92:95], a[140:143], a[36:39], v[92:95]
    ds_read_b64_tr_b16 a[184:185], v26 offset:28672
    v_mfma_f32_16x16x32_bf16 v[64:67], a[144:147], a[40:43], v[64:67]
    ds_read_b64_tr_b16 a[186:187], v26 offset:30720
    ds_read_b64_tr_b16 a[188:189], v27 offset:28672
    buffer_load_dwordx4 a[92:95], v13, s[8:11], s62 offen offset:1024
    v_mfma_f32_16x16x32_bf16 v[68:71], a[144:147], a[44:47], v[68:71]
    ds_read_b64_tr_b16 a[190:191], v27 offset:30720
    v_mfma_f32_16x16x32_bf16 v[72:75], a[148:151], a[40:43], v[72:75]
    s_add_u32 s62, s62, 0x40000
    v_mfma_f32_16x16x32_bf16 v[76:79], a[148:151], a[44:47], v[76:79]
    v_mfma_f32_16x16x32_bf16 v[80:83], a[152:155], a[40:43], v[80:83]
    s_cmp_lg_u32 s45, 1
    s_cbranch_scc1 k3_pf_79
    buffer_load_dword v7, v5, s[36:39], s55 offen
    s_add_u32 s55, s55, s56
k3_pf_79:
    v_mfma_f32_16x16x32_bf16 v[84:87], a[152:155], a[44:47], v[84:87]
    v_mfma_f32_16x16x32_bf16 v[88:91], a[156:159], a[40:43], v[88:91]
    v_mfma_f32_16x16x32_bf16 v[92:95], a[156:159], a[44:47], v[92:95]
    s_waitcnt vmcnt(8) lgkmcnt(0)
    s_barrier
    v_mfma_f32_16x16x32_bf16 v[64:67], a[160:163], a[48:51], v[64:67]
    ds_read_b64_tr_b16 a[128:129], v24 offset:32768
    ds_read_b64_tr_b16 a[130:131], v24 offset:34816
    v_mfma_f32_16x16x32_bf16 v[68:71], a[160:163], a[52:55], v[68:71]
    ds_read_b64_tr_b16 a[132:133], v25 offset:32768
    ds_read_b64_tr_b16 a[134:135], v25 offset:34816
    s_add_u32 m0, s60, 49152
    s_nop 0
    buffer_load_dwordx4 v16, s[12:15], s61 offen offset:0 lds
    v_mfma_f32_16x16x32_bf16 v[72:75], a[164:167], a[48:51], v[72:75]
    ds_read_b64_tr_b16 a[136:137], v26 offset:32768
    buffer_load_dwordx4 v17, s[12:15], s61 offen offset:1024 lds
    v_mfma_f32_16x16x32_bf16 v[76:79], a[164:167], a[52:55], v[76:79]
    ds_read_b64_tr_b16 a[138:139], v26 offset:34816
    ds_read_b64_tr_b16 a[140:141], v27 offset:32768
    buffer_load_dwordx4 v18, s[12:15], s61 offen offset:2048 lds
    v_mfma_f32_16x16x32_bf16 v[80:83], a[168:171], a[48:51], v[80:83]
    ds_read_b64_tr_b16 a[142:143], v27 offset:34816
    v_mfma_f32_16x16x32_bf16 v[84:87], a[168:171], a[52:55], v[84:87]
    ds_read_b64_tr_b16 a[144:145], v24 offset:36864
    ds_read_b64_tr_b16 a[146:147], v24 offset:38912
    buffer_load_dwordx4 v19, s[12:15], s61 offen offset:3072 lds
    v_mfma_f32_16x16x32_bf16 v[88:91], a[172:175], a[48:51], v[88:91]
    ds_read_b64_tr_b16 a[148:149], v25 offset:36864
    ds_read_b64_tr_b16 a[150:151], v25 offset:38912
    s_add_u32 s61, s61, 0x40000
    v_mfma_f32_16x16x32_bf16 v[92:95], a[172:175], a[52:55], v[92:95]
    ds_read_b64_tr_b16 a[152:153], v26 offset:36864
    v_mfma_f32_16x16x32_bf16 v[64:67], a[176:179], a[56:59], v[64:67]
    ds_read_b64_tr_b16 a[154:155], v26 offset:38912
    ds_read_b64_tr_b16 a[156:157], v27 offset:36864
    buffer_load_dwordx4 a[96:99], v12, s[8:11], s62 offen offset:0
    v_mfma_f32_16x16x32_bf16 v[68:71], a[176:179], a[60:63], v[68:71]
    ds_read_b64_tr_b16 a[158:159], v27 offset:38912
    buffer_load_dwordx4 a[100:103], v12, s[8:11], s62 offen offset:1024
    v_mfma_f32_16x16x32_bf16 v[72:75], a[180:183], a[56:59], v[72:75]
    buffer_load_dwordx4 a[104:107], v13, s[8:11], s62 offen offset:0
    v_mfma_f32_16x16x32_bf16 v[76:79], a[180:183], a[60:63], v[76:79]
    v_mfma_f32_16x16x32_bf16 v[80:83], a[184:187], a[56:59], v[80:83]
    buffer_load_dwordx4 a[108:111], v13, s[8:11], s62 offen offset:1024
    v_mfma_f32_16x16x32_bf16 v[84:87], a[184:187], a[60:63], v[84:87]
    s_add_u32 s62, s62, 0x40000
    v_mfma_f32_16x16x32_bf16 v[88:91], a[188:191], a[56:59], v[88:91]
    v_mfma_f32_16x16x32_bf16 v[92:95], a[188:191], a[60:63], v[92:95]
    s_waitcnt vmcnt(12) lgkmcnt(0)
    v_mfma_f32_16x16x32_bf16 v[64:67], a[128:131], a[64:67], v[64:67]
    ds_read_b64_tr_b16 a[160:161], v24 offset:40960
    ds_read_b64_tr_b16 a[162:163], v24 offset:43008
    v_mfma_f32_16x16x32_bf16 v[68:71], a[128:131], a[68:71], v[68:71]
    ds_read_b64_tr_b16 a[164:165], v25 offset:40960
    ds_read_b64_tr_b16 a[166:167], v25 offset:43008
    v_mfma_f32_16x16x32_bf16 v[72:75], a[132:135], a[64:67], v[72:75]
    ds_read_b64_tr_b16 a[168:169], v26 offset:40960
    buffer_load_dwordx4 a[112:115], v12, s[8:11], s62 offen offset:0
    v_mfma_f32_16x16x32_bf16 v[76:79], a[132:135], a[68:71], v[76:79]
    ds_read_b64_tr_b16 a[170:171], v26 offset:43008
    ds_read_b64_tr_b16 a[172:173], v27 offset:40960
    v_mfma_f32_16x16x32_bf16 v[80:83], a[136:139], a[64:67], v[80:83]
    ds_read_b64_tr_b16 a[174:175], v27 offset:43008
    buffer_load_dwordx4 a[116:119], v12, s[8:11], s62 offen offset:1024
    v_mfma_f32_16x16x32_bf16 v[84:87], a[136:139], a[68:71], v[84:87]
    ds_read_b64_tr_b16 a[176:177], v24 offset:45056
    ds_read_b64_tr_b16 a[178:179], v24 offset:47104
    v_mfma_f32_16x16x32_bf16 v[88:91], a[140:143], a[64:67], v[88:91]
    ds_read_b64_tr_b16 a[180:181], v25 offset:45056
    ds_read_b64_tr_b16 a[182:183], v25 offset:47104
    buffer_load_dwordx4 a[120:123], v13, s[8:11], s62 offen offset:0
    v_mfma_f32_16x16x32_bf16 v[92:95], a[140:143], a[68:71], v[92:95]
    ds_read_b64_tr_b16 a[184:185], v26 offset:45056
    v_mfma_f32_16x16x32_bf16 v[64:67], a[144:147], a[72:75], v[64:67]
    ds_read_b64_tr_b16 a[186:187], v26 offset:47104
    ds_read_b64_tr_b16 a[188:189], v27 offset:45056
    buffer_load_dwordx4 a[124:127], v13, s[8:11], s62 offen offset:1024
    v_mfma_f32_16x16x32_bf16 v[68:71], a[144:147], a[76:79], v[68:71]
    ds_read_b64_tr_b16 a[190:191], v27 offset:47104
    v_mfma_f32_16x16x32_bf16 v[72:75], a[148:151], a[72:75], v[72:75]
    s_add_u32 s62, s62, 0x40000
    v_mfma_f32_16x16x32_bf16 v[76:79], a[148:151], a[76:79], v[76:79]
    v_mfma_f32_16x16x32_bf16 v[80:83], a[152:155], a[72:75], v[80:83]
    s_cmp_lg_u32 s45, 2
    s_cbranch_scc1 k3_pf_80
    buffer_load_dword v7, v5, s[36:39], s55 offen
    s_add_u32 s55, s55, s56
k3_pf_80:
    v_mfma_f32_16x16x32_bf16 v[84:87], a[152:155], a[76:79], v[84:87]
    v_mfma_f32_16x16x32_bf16 v[88:91], a[156:159], a[72:75], v[88:91]
    v_mfma_f32_16x16x32_bf16 v[92:95], a[156:159], a[76:79], v[92:95]
    s_waitcnt vmcnt(8) lgkmcnt(0)
    s_barrier
    v_mfma_f32_16x16x32_bf16 v[64:67], a[160:163], a[80:83], v[64:67]
    ds_read_b64_tr_b16 a[128:129], v24 offset:49152
    ds_read_b64_tr_b16 a[130:131], v24 offset:51200
    v_mfma_f32_16x16x32_bf16 v[68:71], a[160:163], a[84:87], v[68:71]
    ds_read_b64_tr_b16 a[132:133], v25 offset:49152
    ds_read_b64_tr_b16 a[134:135], v25 offset:51200
    s_add_u32 m0, s60, 0
    s_nop 0
    buffer_load_dwordx4 v16, s[12:15], s61 offen offset:0 lds
    v_mfma_f32_16x16x32_bf16 v[72:75], a[164:167], a[80:83], v[72:75]
    ds_read_b64_tr_b16 a[136:137], v26 offset:49152
    buffer_load_dwordx4 v17, s[12:15], s61 offen offset:1024 lds
    v_mfma_f32_16x16x32_bf16 v[76:79], a[164:167], a[84:87], v[76:79]
    ds_read_b64_tr_b16 a[138:139], v26 offset:51200
    ds_read_b64_tr_b16 a[140:141], v27 offset:49152
    buffer_load_dwordx4 v18, s[12:15], s61 offen offset:2048 lds
    v_mfma_f32_16x16x32_bf16 v[80:83], a[168:171], a[80:83], v[80:83]
    ds_read_b64_tr_b16 a[142:143], v27 offset:51200
    v_mfma_f32_16x16x32_bf16 v[84:87], a[168:171], a[84:87], v[84:87]
    ds_read_b64_tr_b16 a[144:145], v24 offset:53248
    ds_read_b64_tr_b16 a[146:147], v24 offset:55296
    buffer_load_dwordx4 v19, s[12:15], s61 offen offset:3072 lds
    v_mfma_f32_16x16x32_bf16 v[88:91], a[172:175], a[80:83], v[88:91]
    ds_read_b64_tr_b16 a[148:149], v25 offset:53248
    ds_read_b64_tr_b16 a[150:151], v25 offset:55296
    s_add_u32 s61, s61, 0x40000
    v_mfma_f32_16x16x32_bf16 v[92:95], a[172:175], a[84:87], v[92:95]
    ds_read_b64_tr_b16 a[152:153], v26 offset:53248
    v_mfma_f32_16x16x32_bf16 v[64:67], a[176:179], a[88:91], v[64:67]
    ds_read_b64_tr_b16 a[154:155], v26 offset:55296
    ds_read_b64_tr_b16 a[156:157], v27 offset:53248
    buffer_load_dwordx4 a[0:3], v12, s[8:11], s62 offen offset:0
    v_mfma_f32_16x16x32_bf16 v[68:71], a[176:179], a[92:95], v[68:71]
    ds_read_b64_tr_b16 a[158:159], v27 offset:55296
    buffer_load_dwordx4 a[4:7], v12, s[8:11], s62 offen offset:1024
    v_mfma_f32_16x16x32_bf16 v[72:75], a[180:183], a[88:91], v[72:75]
    buffer_load_dwordx4 a[8:11], v13, s[8:11], s62 offen offset:0
    v_mfma_f32_16x16x32_bf16 v[76:79], a[180:183], a[92:95], v[76:79]
    v_mfma_f32_16x16x32_bf16 v[80:83], a[184:187], a[88:91], v[80:83]
    buffer_load_dwordx4 a[12:15], v13, s[8:11], s62 offen offset:1024
    v_mfma_f32_16x16x32_bf16 v[84:87], a[184:187], a[92:95], v[84:87]
    s_add_u32 s62, s62, 0x40000
    v_mfma_f32_16x16x32_bf16 v[88:91], a[188:191], a[88:91], v[88:91]
    v_mfma_f32_16x16x32_bf16 v[92:95], a[188:191], a[92:95], v[92:95]
    s_waitcnt vmcnt(12) lgkmcnt(0)
    v_mfma_f32_16x16x32_bf16 v[64:67], a[128:131], a[96:99], v[64:67]
    ds_read_b64_tr_b16 a[160:161], v24 offset:57344
    ds_read_b64_tr_b16 a[162:163], v24 offset:59392
    v_mfma_f32_16x16x32_bf16 v[68:71], a[128:131], a[100:103], v[68:71]
    ds_read_b64_tr_b16 a[164:165], v25 offset:57344
    ds_read_b64_tr_b16 a[166:167], v25 offset:59392
    v_mfma_f32_16x16x32_bf16 v[72:75], a[132:135], a[96:99], v[72:75]
    ds_read_b64_tr_b16 a[168:169], v26 offset:57344
    buffer_load_dwordx4 a[16:19], v12, s[8:11], s62 offen offset:0
    v_mfma_f32_16x16x32_bf16 v[76:79], a[132:135], a[100:103], v[76:79]
    ds_read_b64_tr_b16 a[170:171], v26 offset:59392
    ds_read_b64_tr_b16 a[172:173], v27 offset:57344
    v_mfma_f32_16x16x32_bf16 v[80:83], a[136:139], a[96:99], v[80:83]
    ds_read_b64_tr_b16 a[174:175], v27 offset:59392
    buffer_load_dwordx4 a[20:23], v12, s[8:11], s62 offen offset:1024
    v_mfma_f32_16x16x32_bf16 v[84:87], a[136:139], a[100:103], v[84:87]
    ds_read_b64_tr_b16 a[176:177], v24 offset:61440
    ds_read_b64_tr_b16 a[178:179], v24 offset:63488
    v_mfma_f32_16x16x32_bf16 v[88:91], a[140:143], a[96:99], v[88:91]
    ds_read_b64_tr_b16 a[180:181], v25 offset:61440
    ds_read_b64_tr_b16 a[182:183], v25 offset:63488
    buffer_load_dwordx4 a[24:27], v13, s[8:11], s62 offen offset:0
    v_mfma_f32_16x16x32_bf16 v[92:95], a[140:143], a[100:103], v[92:95]
    ds_read_b64_tr_b16 a[184:185], v26 offset:61440
    v_mfma_f32_16x16x32_bf16 v[64:67], a[144:147], a[104:107], v[64:67]
    ds_read_b64_tr_b16 a[186:187], v26 offset:63488
    ds_read_b64_tr_b16 a[188:189], v27 offset:61440
    buffer_load_dwordx4 a[28:31], v13, s[8:11], s62 offen offset:1024
    v_mfma_f32_16x16x32_bf16 v[68:71], a[144:147], a[108:111], v[68:71]
    ds_read_b64_tr_b16 a[190:191], v27 offset:63488
    v_mfma_f32_16x16x32_bf16 v[72:75], a[148:151], a[104:107], v[72:75]
    s_add_u32 s62, s62, 0x40000
    v_mfma_f32_16x16x32_bf16 v[76:79], a[148:151], a[108:111], v[76:79]
    v_mfma_f32_16x16x32_bf16 v[80:83], a[152:155], a[104:107], v[80:83]
    s_cmp_lg_u32 s45, 3
    s_cbranch_scc1 k3_pf_81
    buffer_load_dword v7, v5, s[36:39], s55 offen
    s_add_u32 s55, s55, s56
k3_pf_81:
    v_mfma_f32_16x16x32_bf16 v[84:87], a[152:155], a[108:111], v[84:87]
    v_mfma_f32_16x16x32_bf16 v[88:91], a[156:159], a[104:107], v[88:91]
    v_mfma_f32_16x16x32_bf16 v[92:95], a[156:159], a[108:111], v[92:95]
    s_waitcnt vmcnt(8) lgkmcnt(0)
    s_barrier
    v_mfma_f32_16x16x32_bf16 v[64:67], a[160:163], a[112:115], v[64:67]
    ds_read_b64_tr_b16 a[128:129], v24 offset:0
    ds_read_b64_tr_b16 a[130:131], v24 offset:2048
    v_mfma_f32_16x16x32_bf16 v[68:71], a[160:163], a[116:119], v[68:71]
    ds_read_b64_tr_b16 a[132:133], v25 offset:0
    ds_read_b64_tr_b16 a[134:135], v25 offset:2048
    s_add_u32 m0, s60, 16384
    s_nop 0
    buffer_load_dwordx4 v16, s[12:15], s61 offen offset:0 lds
    v_mfma_f32_16x16x32_bf16 v[72:75], a[164:167], a[112:115], v[72:75]
    ds_read_b64_tr_b16 a[136:137], v26 offset:0
    buffer_load_dwordx4 v17, s[12:15], s61 offen offset:1024 lds
    v_mfma_f32_16x16x32_bf16 v[76:79], a[164:167], a[116:119], v[76:79]
    ds_read_b64_tr_b16 a[138:139], v26 offset:2048
    ds_read_b64_tr_b16 a[140:141], v27 offset:0
    buffer_load_dwordx4 v18, s[12:15], s61 offen offset:2048 lds
    v_mfma_f32_16x16x32_bf16 v[80:83], a[168:171], a[112:115], v[80:83]
    ds_read_b64_tr_b16 a[142:143], v27 offset:2048
    v_mfma_f32_16x16x32_bf16 v[84:87], a[168:171], a[116:119], v[84:87]
    ds_read_b64_tr_b16 a[144:145], v24 offset:4096
    ds_read_b64_tr_b16 a[146:147], v24 offset:6144
    buffer_load_dwordx4 v19, s[12:15], s61 offen offset:3072 lds
    v_mfma_f32_16x16x32_bf16 v[88:91], a[172:175], a[112:115], v[88:91]
    ds_read_b64_tr_b16 a[148:149], v25 offset:4096
    ds_read_b64_tr_b16 a[150:151], v25 offset:6144
    s_add_u32 s61, s61, 0x40000
    v_mfma_f32_16x16x32_bf16 v[92:95], a[172:175], a[116:119], v[92:95]
    ds_read_b64_tr_b16 a[152:153], v26 offset:4096
    v_mfma_f32_16x16x32_bf16 v[64:67], a[176:179], a[120:123], v[64:67]
    ds_read_b64_tr_b16 a[154:155], v26 offset:6144
    ds_read_b64_tr_b16 a[156:157], v27 offset:4096
    buffer_load_dwordx4 a[32:35], v12, s[8:11], s62 offen offset:0
    v_mfma_f32_16x16x32_bf16 v[68:71], a[176:179], a[124:127], v[68:71]
    ds_read_b64_tr_b16 a[158:159], v27 offset:6144
    buffer_load_dwordx4 a[36:39], v12, s[8:11], s62 offen offset:1024
    v_mfma_f32_16x16x32_bf16 v[72:75], a[180:183], a[120:123], v[72:75]
    buffer_load_dwordx4 a[40:43], v13, s[8:11], s62 offen offset:0
    v_mfma_f32_16x16x32_bf16 v[76:79], a[180:183], a[124:127], v[76:79]
    v_mfma_f32_16x16x32_bf16 v[80:83], a[184:187], a[120:123], v[80:83]
    buffer_load_dwordx4 a[44:47], v13, s[8:11], s62 offen offset:1024
    v_mfma_f32_16x16x32_bf16 v[84:87], a[184:187], a[124:127], v[84:87]
    s_add_u32 s62, s62, 0x40000
    v_mfma_f32_16x16x32_bf16 v[88:91], a[188:191], a[120:123], v[88:91]
    v_mfma_f32_16x16x32_bf16 v[92:95], a[188:191], a[124:127], v[92:95]
    s_add_u32 s63, s63, 1
    s_cmp_lt_u32 s63, 8
    s_cbranch_scc1 k3_loop_77
    v_lshlrev_b32 v32, 16, v112
    v_and_b32 v33, 0xffff0000, v112
    v_lshlrev_b32 v34, 16, v113
    v_and_b32 v35, 0xffff0000, v113
    v_lshlrev_b32 v36, 16, v114
    v_and_b32 v37, 0xffff0000, v114
    v_lshlrev_b32 v38, 16, v115
    v_and_b32 v39, 0xffff0000, v115
    v_lshlrev_b32 v40, 16, v116
    v_and_b32 v41, 0xffff0000, v116
    v_lshlrev_b32 v42, 16, v117
    v_and_b32 v43, 0xffff0000, v117
    v_lshlrev_b32 v44, 16, v118
    v_and_b32 v45, 0xffff0000, v118
    v_lshlrev_b32 v46, 16, v119
    v_and_b32 v47, 0xffff0000, v119
    v_mov_b32 v48, 0
    v_mov_b32 v49, 0
    v_mov_b32 v50, 0
    v_cvt_pk_bf16_f32 v56, v64, v65
    v_lshlrev_b32 v57, 16, v56
    v_and_b32 v58, 0xffff0000, v56
    v_lshlrev_b32 v59, 16, v96
    v_and_b32 v60, 0xffff0000, v96
    v_add_f32 v57, v57, v59
    v_add_f32 v58, v58, v60
    v_cvt_pk_bf16_f32 v96, v57, v58
    v_lshlrev_b32 v57, 16, v96
    v_and_b32 v58, 0xffff0000, v96
    v_add_f32 v48, v48, v57
    v_fmac_f32 v49, v57, v57
    v_fmac_f32 v50, v57, v32
    v_add_f32 v48, v48, v58
    v_fmac_f32 v49, v58, v58
    v_fmac_f32 v50, v58, v33
    v_cvt_pk_bf16_f32 v56, v66, v67
    v_lshlrev_b32 v57, 16, v56
    v_and_b32 v58, 0xffff0000, v56
    v_lshlrev_b32 v59, 16, v97
    v_and_b32 v60, 0xffff0000, v97
    v_add_f32 v57, v57, v59
    v_add_f32 v58, v58, v60
    v_cvt_pk_bf16_f32 v97, v57, v58
    v_lshlrev_b32 v57, 16, v97
    v_and_b32 v58, 0xffff0000, v97
    v_add_f32 v48, v48, v57
    v_fmac_f32 v49, v57, v57
    v_fmac_f32 v50, v57, v34
    v_add_f32 v48, v48, v58
    v_fmac_f32 v49, v58, v58
    v_fmac_f32 v50, v58, v35
    buffer_store_dwordx2 v[96:97], v3, s[24:27], 0 offen offset:0
    v_cvt_pk_bf16_f32 v56, v72, v73
    v_lshlrev_b32 v57, 16, v56
    v_and_b32 v58, 0xffff0000, v56
    v_lshlrev_b32 v59, 16, v100
    v_and_b32 v60, 0xffff0000, v100
    v_add_f32 v57, v57, v59
    v_add_f32 v58, v58, v60
    v_cvt_pk_bf16_f32 v100, v57, v58
    v_lshlrev_b32 v57, 16, v100
    v_and_b32 v58, 0xffff0000, v100
    v_add_f32 v48, v48, v57
    v_fmac_f32 v49, v57, v57
    v_fmac_f32 v50, v57, v36
    v_add_f32 v48, v48, v58
    v_fmac_f32 v49, v58, v58
    v_fmac_f32 v50, v58, v37
    v_cvt_pk_bf16_f32 v56, v74, v75
    v_lshlrev_b32 v57, 16, v56
    v_and_b32 v58, 0xffff0000, v56
    v_lshlrev_b32 v59, 16, v101
    v_and_b32 v60, 0xffff0000, v101
    v_add_f32 v57, v57, v59
    v_add_f32 v58, v58, v60
    v_cvt_pk_bf16_f32 v101, v57, v58
    v_lshlrev_b32 v57, 16, v101
    v_and_b32 v58, 0xffff0000, v101
    v_add_f32 v48, v48, v57
    v_fmac_f32 v49, v57, v57
    v_fmac_f32 v50, v57, v38
    v_add_f32 v48, v48, v58
    v_fmac_f32 v49, v58, v58
    v_fmac_f32 v50, v58, v39
    buffer_store_dwordx2 v[100:101], v3, s[24:27], 0 offen offset:32
    v_cvt_pk_bf16_f32 v56, v80, v81
    v_lshlrev_b32 v57, 16, v56
    v_and_b32 v58, 0xffff0000, v56
    v_lshlrev_b32 v59, 16, v104
    v_and_b32 v60, 0xffff0000, v104
    v_add_f32 v57, v57, v59
    v_add_f32 v58, v58, v60
    v_cvt_pk_bf16_f32 v104, v57, v58
    v_lshlrev_b32 v57, 16, v104
    v_and_b32 v58, 0xffff0000, v104
    v_add_f32 v48, v48, v57
    v_fmac_f32 v49, v57, v57
    v_fmac_f32 v50, v57, v40
    v_add_f32 v48, v48, v58
    v_fmac_f32 v49, v58, v58
    v_fmac_f32 v50, v58, v41
    v_cvt_pk_bf16_f32 v56, v82, v83
    v_lshlrev_b32 v57, 16, v56
    v_and_b32 v58, 0xffff0000, v56
    v_lshlrev_b32 v59, 16, v105
    v_and_b32 v60, 0xffff0000, v105
    v_add_f32 v57, v57, v59
    v_add_f32 v58, v58, v60
    v_cvt_pk_bf16_f32 v105, v57, v58
    v_lshlrev_b32 v57, 16, v105
    v_and_b32 v58, 0xffff0000, v105
    v_add_f32 v48, v48, v57
    v_fmac_f32 v49, v57, v57
    v_fmac_f32 v50, v57, v42
    v_add_f32 v48, v48, v58
    v_fmac_f32 v49, v58, v58
    v_fmac_f32 v50, v58, v43
    buffer_store_dwordx2 v[104:105], v3, s[24:27], 0 offen offset:64
    v_cvt_pk_bf16_f32 v56, v88, v89
    v_lshlrev_b32 v57, 16, v56
    v_and_b32 v58, 0xffff0000, v56
    v_lshlrev_b32 v59, 16, v108
    v_and_b32 v60, 0xffff0000, v108
    v_add_f32 v57, v57, v59
    v_add_f32 v58, v58, v60
    v_cvt_pk_bf16_f32 v108, v57, v58
    v_lshlrev_b32 v57, 16, v108
    v_and_b32 v58, 0xffff0000, v108
    v_add_f32 v48, v48, v57
    v_fmac_f32 v49, v57, v57
    v_fmac_f32 v50, v57, v44
    v_add_f32 v48, v48, v58
    v_fmac_f32 v49, v58, v58
    v_fmac_f32 v50, v58, v45
    v_cvt_pk_bf16_f32 v56, v90, v91
    v_lshlrev_b32 v57, 16, v56
    v_and_b32 v58, 0xffff0000, v56
    v_lshlrev_b32 v59, 16, v109
    v_and_b32 v60, 0xffff0000, v109
    v_add_f32 v57, v57, v59
    v_add_f32 v58, v58, v60
    v_cvt_pk_bf16_f32 v109, v57, v58
    v_lshlrev_b32 v57, 16, v109
    v_and_b32 v58, 0xffff0000, v109
    v_add_f32 v48, v48, v57
    v_fmac_f32 v49, v57, v57
    v_fmac_f32 v50, v57, v46
    v_add_f32 v48, v48, v58
    v_fmac_f32 v49, v58, v58
    v_fmac_f32 v50, v58, v47
    buffer_store_dwordx2 v[108:109], v3, s[24:27], 0 offen offset:96
    v_mov_b32 v52, 0
    v_mov_b32 v53, 0
    v_mov_b32 v54, 0
    v_cvt_pk_bf16_f32 v56, v68, v69
    v_lshlrev_b32 v57, 16, v56
    v_and_b32 v58, 0xffff0000, v56
    v_lshlrev_b32 v59, 16, v98
    v_and_b32 v60, 0xffff0000, v98
    v_add_f32 v57, v57, v59
    v_add_f32 v58, v58, v60
    v_cvt_pk_bf16_f32 v98, v57, v58
    v_lshlrev_b32 v57, 16, v98
    v_and_b32 v58, 0xffff0000, v98
    v_add_f32 v52, v52, v57
    v_fmac_f32 v53, v57, v57
    v_fmac_f32 v54, v57, v32
    v_add_f32 v52, v52, v58
    v_fmac_f32 v53, v58, v58
    v_fmac_f32 v54, v58, v33
    v_cvt_pk_bf16_f32 v56, v70, v71
    v_lshlrev_b32 v57, 16, v56
    v_and_b32 v58, 0xffff0000, v56
    v_lshlrev_b32 v59, 16, v99
    v_and_b32 v60, 0xffff0000, v99
    v_add_f32 v57, v57, v59
    v_add_f32 v58, v58, v60
    v_cvt_pk_bf16_f32 v99, v57, v58
    v_lshlrev_b32 v57, 16, v99
    v_and_b32 v58, 0xffff0000, v99
    v_add_f32 v52, v52, v57
    v_fmac_f32 v53, v57, v57
    v_fmac_f32 v54, v57, v34
    v_add_f32 v52, v52, v58
    v_fmac_f32 v53, v58, v58
    v_fmac_f32 v54, v58, v35
    buffer_store_dwordx2 v[98:99], v4, s[24:27], 0 offen offset:0
    v_cvt_pk_bf16_f32 v56, v76, v77
    v_lshlrev_b32 v57, 16, v56
    v_and_b32 v58, 0xffff0000, v56
    v_lshlrev_b32 v59, 16, v102
    v_and_b32 v60, 0xffff0000, v102
    v_add_f32 v57, v57, v59
    v_add_f32 v58, v58, v60
    v_cvt_pk_bf16_f32 v102, v57, v58
    v_lshlrev_b32 v57, 16, v102
    v_and_b32 v58, 0xffff0000, v102
    v_add_f32 v52, v52, v57
    v_fmac_f32 v53, v57, v57
    v_fmac_f32 v54, v57, v36
    v_add_f32 v52, v52, v58
    v_fmac_f32 v53, v58, v58
    v_fmac_f32 v54, v58, v37
    v_cvt_pk_bf16_f32 v56, v78, v79
    v_lshlrev_b32 v57, 16, v56
    v_and_b32 v58, 0xffff0000, v56
    v_lshlrev_b32 v59, 16, v103
    v_and_b32 v60, 0xffff0000, v103
    v_add_f32 v57, v57, v59
    v_add_f32 v58, v58, v60
    v_cvt_pk_bf16_f32 v103, v57, v58
    v_lshlrev_b32 v57, 16, v103
    v_and_b32 v58, 0xffff0000, v103
    v_add_f32 v52, v52, v57
    v_fmac_f32 v53, v57, v57
    v_fmac_f32 v54, v57, v38
    v_add_f32 v52, v52, v58
    v_fmac_f32 v53, v58, v58
    v_fmac_f32 v54, v58, v39
    buffer_store_dwordx2 v[102:103], v4, s[24:27], 0 offen offset:32
    v_cvt_pk_bf16_f32 v56, v84, v85
    v_lshlrev_b32 v57, 16, v56
    v_and_b32 v58, 0xffff0000, v56
    v_lshlrev_b32 v59, 16, v106
    v_and_b32 v60, 0xffff0000, v106
    v_add_f32 v57, v57, v59
    v_add_f32 v58, v58, v60
    v_cvt_pk_bf16_f32 v106, v57, v58
    v_lshlrev_b32 v57, 16, v106
    v_and_b32 v58, 0xffff0000, v106
    v_add_f32 v52, v52, v57
    v_fmac_f32 v53, v57, v57
    v_fmac_f32 v54, v57, v40
    v_add_f32 v52, v52, v58
    v_fmac_f32 v53, v58, v58
    v_fmac_f32 v54, v58, v41
    v_cvt_pk_bf16_f32 v56, v86, v87
    v_lshlrev_b32 v57, 16, v56
    v_and_b32 v58, 0xffff0000, v56
    v_lshlrev_b32 v59, 16, v107
    v_and_b32 v60, 0xffff0000, v107
    v_add_f32 v57, v57, v59
    v_add_f32 v58, v58, v60
    v_cvt_pk_bf16_f32 v107, v57, v58
    v_lshlrev_b32 v57, 16, v107
    v_and_b32 v58, 0xffff0000, v107
    v_add_f32 v52, v52, v57
    v_fmac_f32 v53, v57, v57
    v_fmac_f32 v54, v57, v42
    v_add_f32 v52, v52, v58
    v_fmac_f32 v53, v58, v58
    v_fmac_f32 v54, v58, v43
    buffer_store_dwordx2 v[106:107], v4, s[24:27], 0 offen offset:64
    v_cvt_pk_bf16_f32 v56, v92, v93
    v_lshlrev_b32 v57, 16, v56
    v_and_b32 v58, 0xffff0000, v56
    v_lshlrev_b32 v59, 16, v110
    v_and_b32 v60, 0xffff0000, v110
    v_add_f32 v57, v57, v59
    v_add_f32 v58, v58, v60
    v_cvt_pk_bf16_f32 v110, v57, v58
    v_lshlrev_b32 v57, 16, v110
    v_and_b32 v58, 0xffff0000, v110
    v_add_f32 v52, v52, v57
    v_fmac_f32 v53, v57, v57
    v_fmac_f32 v54, v57, v44
    v_add_f32 v52, v52, v58
    v_fmac_f32 v53, v58, v58
    v_fmac_f32 v54, v58, v45
    v_cvt_pk_bf16_f32 v56, v94, v95
    v_lshlrev_b32 v57, 16, v56
    v_and_b32 v58, 0xffff0000, v56
    v_lshlrev_b32 v59, 16, v111
    v_and_b32 v60, 0xffff0000, v111
    v_add_f32 v57, v57, v59
    v_add_f32 v58, v58, v60
    v_cvt_pk_bf16_f32 v111, v57, v58
    v_lshlrev_b32 v57, 16, v111
    v_and_b32 v58, 0xffff0000, v111
    v_add_f32 v52, v52, v57
    v_fmac_f32 v53, v57, v57
    v_fmac_f32 v54, v57, v46
    v_add_f32 v52, v52, v58
    v_fmac_f32 v53, v58, v58
    v_fmac_f32 v54, v58, v47
    buffer_store_dwordx2 v[110:111], v4, s[24:27], 0 offen offset:96
    v_mov_b32 v56, v48
    v_mov_b32 v57, v49
    v_mov_b32 v58, v50
    v_mov_b32 v59, v52
    v_mov_b32 v60, v53
    v_mov_b32 v61, v54
    s_nop 1
    v_permlane16_swap_b32 v48, v56
    v_permlane16_swap_b32 v49, v57
    v_permlane16_swap_b32 v50, v58
    v_permlane16_swap_b32 v52, v59
    v_permlane16_swap_b32 v53, v60
    v_permlane16_swap_b32 v54, v61
    s_nop 1
    v_add_f32 v48, v48, v56
    v_add_f32 v49, v49, v57
    v_add_f32 v50, v50, v58
    v_add_f32 v52, v52, v59
    v_add_f32 v53, v53, v60
    v_add_f32 v54, v54, v61
    v_mov_b32 v56, v48
    v_mov_b32 v57, v49
    v_mov_b32 v58, v50
    v_mov_b32 v59, v52
    v_mov_b32 v60, v53
    v_mov_b32 v61, v54
    s_nop 1
    v_permlane32_swap_b32 v48, v56
    v_permlane32_swap_b32 v49, v57
    v_permlane32_swap_b32 v50, v58
    v_permlane32_swap_b32 v52, v59
    v_permlane32_swap_b32 v53, v60
    v_permlane32_swap_b32 v54, v61
    s_nop 1
    v_add_f32 v48, v48, v56
    v_add_f32 v49, v49, v57
    v_add_f32 v50, v50, v58
    v_add_f32 v52, v52, v59
    v_add_f32 v53, v53, v60
    v_add_f32 v54, v54, v61
    v_cmp_eq_u32 s[48:49], 1, v20
    v_cmp_eq_u32 s[50:51], 2, v20
    s_nop 1
    v_cndmask_b32 v48, v48, v49, s[48:49]
    v_cndmask_b32 v48, v48, v50, s[50:51]
    buffer_atomic_add_f32 v48, v2, s[32:35], 0 offen offset:0
    v_cndmask_b32 v52, v52, v53, s[48:49]
    v_cndmask_b32 v52, v52, v54, s[50:51]
    buffer_atomic_add_f32 v52, v2, s[32:35], 0 offen offset:64
k3_end_76:
    s_endpgm
.globl k4_kernel
.p2align 8
.type k4_kernel,@function
k4_kernel:
    s_cmp_ge_u32 s2, 256
    s_cbranch_scc1 k4_end_82
    s_load_dwordx8 s[4:11], s[0:1], 56
    s_load_dwordx2 s[12:13], s[0:1], 88
    s_load_dwordx2 s[14:15], s[0:1], 104
    v_lshrrev_b32 v1, 6, v0
    v_and_b32 v2, 63, v0
    v_readfirstlane_b32 s44, v1
    s_and_b32 s45, s2, 7
    s_lshr_b32 s46, s2, 3
    s_mul_i32 s45, s45, 28
    s_add_u32 s45, s45, s46
    v_lshlrev_b32 v3, 5, v0
    v_and_b32 v4, 31, v2
    v_lshrrev_b32 v5, 5, v2
    v_lshl_add_u32 v6, v1, 1, v5
    s_lshl_b32 s47, s2, 3
    v_add_u32 v6, s47, v6
    v_lshlrev_b32 v6, 11, v6
    v_lshl_add_u32 v6, v4, 4, v6
    v_lshlrev_b32 v7, 4, v4
    v_lshrrev_b32 v8, 1, v2
    v_lshl_add_u32 v8, v1, 8, v8
    v_mul_u32_u24 v8, 7168, v8
    v_and_b32 v9, 1, v2
    v_lshl_add_u32 v8, v9, 4, v8
    s_lshl_b32 s47, s45, 5
    v_add_u32 v8, s47, v8
    v_lshlrev_b32 v9, 3, v0
    s_waitcnt lgkmcnt(0)
    s_add_u32 s16, s14, 0x4800000
    s_addc_u32 s17, s15, 0
    s_and_b32 s17, s17, 0xffff
    s_mov_b32 s18, 0x6000
    s_mov_b32 s19, 0x00020000
    s_add_u32 s20, s14, 0x4000000
    s_addc_u32 s21, s15, 0
    s_and_b32 s21, s21, 0xffff
    s_mov_b32 s22, 0x400000
    s_mov_b32 s23, 0x00020000
    s_mov_b32 s24, s6
    s_and_b32 s25, s7, 0xffff
    s_mov_b32 s26, 0x700000
    s_mov_b32 s27, 0x00020000
    s_mov_b32 s28, s8
    s_and_b32 s29, s9, 0xffff
    s_mov_b32 s30, 0x700000
    s_mov_b32 s31, 0x00020000
    s_mov_b32 s32, s10
    s_and_b32 s33, s11, 0xffff
    s_mov_b32 s34, 0x700000
    s_mov_b32 s35, 0x00020000
    s_mov_b32 s36, s12
    s_and_b32 s37, s13, 0xffff
    s_mov_b32 s38, 0x400000
    s_mov_b32 s39, 0x00020000
    s_mov_b32 s40, s4
    s_and_b32 s41, s5, 0xffff
    s_mov_b32 s42, 0x800
    s_mov_b32 s43, 0x00020000
    s_cmp_ge_u32 s2, 224
    s_cselect_b32 s26, 0, s26
    s_cselect_b32 s30, 0, s30
    s_cselect_b32 s34, 0, s34
    s_mov_b32 s48, 0
    buffer_load_dwordx4 v[16:19], v3, s[16:19], s48 offen
    buffer_load_dwordx4 v[20:23], v3, s[16:19], s48 offen offset:16
    s_mov_b32 s48, 8192
    buffer_load_dwordx4 v[24:27], v3, s[16:19], s48 offen
    buffer_load_dwordx4 v[28:31], v3, s[16:19], s48 offen offset:16
    s_mov_b32 s48, 16384
    buffer_load_dwordx4 v[32:35], v3, s[16:19], s48 offen
    buffer_load_dwordx4 v[36:39], v3, s[16:19], s48 offen offset:16
    buffer_load_dwordx4 v[56:59], v7, s[40:43], 0 offen offset:0
    buffer_load_dwordx4 v[60:63], v7, s[40:43], 0 offen offset:512
    buffer_load_dwordx4 v[64:67], v7, s[40:43], 0 offen offset:1024
    buffer_load_dwordx4 v[68:71], v7, s[40:43], 0 offen offset:1536
    buffer_load_dwordx4 v[40:43], v6, s[20:23], 0 offen offset:0
    buffer_load_dwordx4 v[44:47], v6, s[20:23], 0 offen offset:512
    buffer_load_dwordx4 v[48:51], v6, s[20:23], 0 offen offset:1024
    buffer_load_dwordx4 v[52:55], v6, s[20:23], 0 offen offset:1536
    s_and_b32 s49, s45, 3
    s_lshl_b32 s49, s49, 1
    s_lshl_b32 s50, s44, 13
    s_add_u32 s51, s49, 0
    s_and_b32 s51, s51, 7
    s_mul_i32 s52, s51, 229376
    s_lshl_b32 s51, s51, 10
    s_add_u32 s51, s51, s50
    s_add_u32 m0, s51, 0
    s_nop 0
    buffer_load_dwordx4 v8, s[24:27], s52 offen lds
    s_add_u32 s51, s49, 0
    s_and_b32 s51, s51, 7
    s_mul_i32 s52, s51, 229376
    s_lshl_b32 s51, s51, 10
    s_add_u32 s51, s51, s50
    s_add_u32 m0, s51, 32768
    s_nop 0
    buffer_load_dwordx4 v8, s[28:31], s52 offen lds
    s_add_u32 s51, s49, 1
    s_and_b32 s51, s51, 7
    s_mul_i32 s52, s51, 229376
    s_lshl_b32 s51, s51, 10
    s_add_u32 s51, s51, s50
    s_add_u32 m0, s51, 0
    s_nop 0
    buffer_load_dwordx4 v8, s[24:27], s52 offen lds
    s_add_u32 s51, s49, 1
    s_and_b32 s51, s51, 7
    s_mul_i32 s52, s51, 229376
    s_lshl_b32 s51, s51, 10
    s_add_u32 s51, s51, s50
    s_add_u32 m0, s51, 32768
    s_nop 0
    buffer_load_dwordx4 v8, s[28:31], s52 offen lds
    s_waitcnt vmcnt(8)
    v_lshlrev_b32 v128, 16, v56
    v_and_b32 v129, 0xffff0000, v56
    v_lshlrev_b32 v130, 16, v57
    v_and_b32 v131, 0xffff0000, v57
    v_lshlrev_b32 v132, 16, v58
    v_and_b32 v133, 0xffff0000, v58
    v_lshlrev_b32 v134, 16, v59
    v_and_b32 v135, 0xffff0000, v59
    v_lshlrev_b32 v136, 16, v60
    v_and_b32 v137, 0xffff0000, v60
    v_lshlrev_b32 v138, 16, v61
    v_and_b32 v139, 0xffff0000, v61
    v_lshlrev_b32 v140, 16, v62
    v_and_b32 v141, 0xffff0000, v62
    v_lshlrev_b32 v142, 16, v63
    v_and_b32 v143, 0xffff0000, v63
    v_lshlrev_b32 v144, 16, v64
    v_and_b32 v145, 0xffff0000, v64
    v_lshlrev_b32 v146, 16, v65
    v_and_b32 v147, 0xffff0000, v65
    v_lshlrev_b32 v148, 16, v66
    v_and_b32 v149, 0xffff0000, v66
    v_lshlrev_b32 v150, 16, v67
    v_and_b32 v151, 0xffff0000, v67
    v_lshlrev_b32 v152, 16, v68
    v_and_b32 v153, 0xffff0000, v68
    v_lshlrev_b32 v154, 16, v69
    v_and_b32 v155, 0xffff0000, v69
    v_lshlrev_b32 v156, 16, v70
    v_and_b32 v157, 0xffff0000, v70
    v_lshlrev_b32 v158, 16, v71
    v_and_b32 v159, 0xffff0000, v71
    v_pk_add_f32 v[10:11], v[128:129], v[130:131]
    v_pk_add_f32 v[10:11], v[10:11], v[132:133]
    v_pk_add_f32 v[10:11], v[10:11], v[134:135]
    v_pk_add_f32 v[10:11], v[10:11], v[136:137]
    v_pk_add_f32 v[10:11], v[10:11], v[138:139]
    v_pk_add_f32 v[10:11], v[10:11], v[140:141]
    v_pk_add_f32 v[10:11], v[10:11], v[142:143]
    v_pk_add_f32 v[10:11], v[10:11], v[144:145]
    v_pk_add_f32 v[10:11], v[10:11], v[146:147]
    v_pk_add_f32 v[10:11], v[10:11], v[148:149]
    v_pk_add_f32 v[10:11], v[10:11], v[150:151]
    v_pk_add_f32 v[10:11], v[10:11], v[152:153]
    v_pk_add_f32 v[10:11], v[10:11], v[154:155]
    v_pk_add_f32 v[10:11], v[10:11], v[156:157]
    v_pk_add_f32 v[10:11], v[10:11], v[158:159]
    v_add_f32 v10, v10, v11
    s_nop 1
    v_add_f32_dpp v10, v10, v10 quad_perm:[1,0,3,2] row_mask:0xf bank_mask:0xf
    s_nop 1
    v_add_f32_dpp v10, v10, v10 quad_perm:[2,3,0,1] row_mask:0xf bank_mask:0xf
    s_nop 1
    v_add_f32_dpp v10, v10, v10 row_half_mirror row_mask:0xf bank_mask:0xf
    s_nop 1
    v_add_f32_dpp v10, v10, v10 row_mirror row_mask:0xf bank_mask:0xf
    v_mov_b32 v11, v10
    s_nop 1
    v_permlane16_swap_b32 v10, v11
    s_nop 1
    v_add_f32 v10, v10, v11
    v_lshlrev_b32 v12, 3, v0
    v_sub_u32 v12, 2047, v12
    v_mov_b32 v13, 0
    v_mov_b32 v14, 0
    s_mov_b32 s53, 0x3a800000
    s_mov_b32 s54, 0xfffff800
    v_mul_f32 v16, s53, v16
    v_mul_f32 v24, s53, v24
    v_fma_f32 v24, -v16, v16, v24
    v_max_f32 v24, 0, v24
    v_add_f32 v24, 0x3727c5ac, v24
    v_rsq_f32 v24, v24
    v_fma_f32 v32, -v16, v10, v32
    v_mul_f32 v32, v32, v24
    v_ashrrev_i32 v16, 31, v32
    v_or_b32 v16, 0x80000000, v16
    v_xor_b32 v32, v32, v16
    v_subrev_u32 v16, 0, v12
    v_and_or_b32 v32, v32, s54, v16
    v_med3_u32 v14, v13, v14, v32
    v_max_u32 v13, v13, v32
    v_mul_f32 v17, s53, v17
    v_mul_f32 v25, s53, v25
    v_fma_f32 v25, -v17, v17, v25
    v_max_f32 v25, 0, v25
    v_add_f32 v25, 0x3727c5ac, v25
    v_rsq_f32 v25, v25
    v_fma_f32 v33, -v17, v10, v33
    v_mul_f32 v33, v33, v25
    v_ashrrev_i32 v17, 31, v33
    v_or_b32 v17, 0x80000000, v17
    v_xor_b32 v33, v33, v17
    v_subrev_u32 v17, 1, v12
    v_and_or_b32 v33, v33, s54, v17
    v_med3_u32 v14, v13, v14, v33
    v_max_u32 v13, v13, v33
    v_mul_f32 v18, s53, v18
    v_mul_f32 v26, s53, v26
    v_fma_f32 v26, -v18, v18, v26
    v_max_f32 v26, 0, v26
    v_add_f32 v26, 0x3727c5ac, v26
    v_rsq_f32 v26, v26
    v_fma_f32 v34, -v18, v10, v34
    v_mul_f32 v34, v34, v26
    v_ashrrev_i32 v18, 31, v34
    v_or_b32 v18, 0x80000000, v18
    v_xor_b32 v34, v34, v18
    v_subrev_u32 v18, 2, v12
    v_and_or_b32 v34, v34, s54, v18
    v_med3_u32 v14, v13, v14, v34
    v_max_u32 v13, v13, v34
    v_mul_f32 v19, s53, v19
    v_mul_f32 v27, s53, v27
    v_fma_f32 v27, -v19, v19, v27
    v_max_f32 v27, 0, v27
    v_add_f32 v27, 0x3727c5ac, v27
    v_rsq_f32 v27, v27
    v_fma_f32 v35, -v19, v10, v35
    v_mul_f32 v35, v35, v27
    v_ashrrev_i32 v19, 31, v35
    v_or_b32 v19, 0x80000000, v19
    v_xor_b32 v35, v35, v19
    v_subrev_u32 v19, 3, v12
    v_and_or_b32 v35, v35, s54, v19
    v_med3_u32 v14, v13, v14, v35
    v_max_u32 v13, v13, v35
    v_mul_f32 v20, s53, v20
    v_mul_f32 v28, s53, v28
    v_fma_f32 v28, -v20, v20, v28
    v_max_f32 v28, 0, v28
    v_add_f32 v28, 0x3727c5ac, v28
    v_rsq_f32 v28, v28
    v_fma_f32 v36, -v20, v10, v36
    v_mul_f32 v36, v36, v28
    v_ashrrev_i32 v20, 31, v36
    v_or_b32 v20, 0x80000000, v20
    v_xor_b32 v36, v36, v20
    v_subrev_u32 v20, 4, v12
    v_and_or_b32 v36, v36, s54, v20
    v_med3_u32 v14, v13, v14, v36
    v_max_u32 v13, v13, v36
    v_mul_f32 v21, s53, v21
    v_mul_f32 v29, s53, v29
    v_fma_f32 v29, -v21, v21, v29
    v_max_f32 v29, 0, v29
    v_add_f32 v29, 0x3727c5ac, v29
    v_rsq_f32 v29, v29
    v_fma_f32 v37, -v21, v10, v37
    v_mul_f32 v37, v37, v29
    v_ashrrev_i32 v21, 31, v37
    v_or_b32 v21, 0x80000000, v21
    v_xor_b32 v37, v37, v21
    v_subrev_u32 v21, 5, v12
    v_and_or_b32 v37, v37, s54, v21
    v_med3_u32 v14, v13, v14, v37
    v_max_u32 v13, v13, v37
    v_mul_f32 v22, s53, v22
    v_mul_f32 v30, s53, v30
    v_fma_f32 v30, -v22, v22, v30
    v_max_f32 v30, 0, v30
    v_add_f32 v30, 0x3727c5ac, v30
    v_rsq_f32 v30, v30
    v_fma_f32 v38, -v22, v10, v38
    v_mul_f32 v38, v38, v30
    v_ashrrev_i32 v22, 31, v38
    v_or_b32 v22, 0x80000000, v22
    v_xor_b32 v38, v38, v22
    v_subrev_u32 v22, 6, v12
    v_and_or_b32 v38, v38, s54, v22
    v_med3_u32 v14, v13, v14, v38
    v_max_u32 v13, v13, v38
    v_mul_f32 v23, s53, v23
    v_mul_f32 v31, s53, v31
    v_fma_f32 v31, -v23, v23, v31
    v_max_f32 v31, 0, v31
    v_add_f32 v31, 0x3727c5ac, v31
    v_rsq_f32 v31, v31
    v_fma_f32 v39, -v23, v10, v39
    v_mul_f32 v39, v39, v31
    v_ashrrev_i32 v23, 31, v39
    v_or_b32 v23, 0x80000000, v23
    v_xor_b32 v39, v39, v23
    v_subrev_u32 v23, 7, v12
    v_and_or_b32 v39, v39, s54, v23
    v_med3_u32 v14, v13, v14, v39
    v_max_u32 v13, v13, v39
    s_nop 1
    v_mov_b32_dpp v11, v13 quad_perm:[1,0,3,2] row_mask:0xf bank_mask:0xf
    v_mov_b32_dpp v12, v14 quad_perm:[1,0,3,2] row_mask:0xf bank_mask:0xf
    v_max_u32 v12, v12, v14
    v_med3_u32 v14, v13, v11, v12
    v_max_u32 v13, v13, v11
    s_nop 1
    v_mov_b32_dpp v11, v13 quad_perm:[2,3,0,1] row_mask:0xf bank_mask:0xf
    v_mov_b32_dpp v12, v14 quad_perm:[2,3,0,1] row_mask:0xf bank_mask:0xf
    v_max_u32 v12, v12, v14
    v_med3_u32 v14, v13, v11, v12
    v_max_u32 v13, v13, v11
    s_nop 1
    v_mov_b32_dpp v11, v13 row_half_mirror row_mask:0xf bank_mask:0xf
    v_mov_b32_dpp v12, v14 row_half_mirror row_mask:0xf bank_mask:0xf
    v_max_u32 v12, v12, v14
    v_med3_u32 v14, v13, v11, v12
    v_max_u32 v13, v13, v11
    s_nop 1
    v_mov_b32_dpp v11, v13 row_mirror row_mask:0xf bank_mask:0xf
    v_mov_b32_dpp v12, v14 row_mirror row_mask:0xf bank_mask:0xf
    v_max_u32 v12, v12, v14
    v_med3_u32 v14, v13, v11, v12
    v_max_u32 v13, v13, v11
    v_mov_b32 v11, v13
    v_mov_b32 v12, v14
    s_nop 1
    v_permlane16_swap_b32 v13, v11
    v_permlane16_swap_b32 v14, v12
    s_nop 1
    v_max_u32 v12, v12, v14
    v_med3_u32 v14, v13, v11, v12
    v_max_u32 v13, v13, v11
    v_mov_b32 v11, v13
    v_mov_b32 v12, v14
    s_nop 1
    v_permlane32_swap_b32 v13, v11
    v_permlane32_swap_b32 v14, v12
    s_nop 1
    v_max_u32 v12, v12, v14
    v_med3_u32 v14, v13, v11, v12
    v_max_u32 v13, v13, v11
    v_lshlrev_b32 v11, 3, v1
    v_add_u32 v11, 81920, v11
    v_mov_b32 v12, v13
    v_mov_b32 v13, v14
    ds_write_b64 v11, v[12:13]
    s_waitcnt lgkmcnt(0)
    s_barrier
    v_mov_b32 v11, 81920
    ds_read_b128 v[16:19], v11
    ds_read_b128 v[20:23], v11 offset:16
    s_waitcnt lgkmcnt(0)
    v_max_u32 v19, v19, v17
    v_med3_u32 v17, v16, v18, v19
    v_max_u32 v16, v16, v18
    v_max_u32 v23, v23, v21
    v_med3_u32 v21, v20, v22, v23
    v_max_u32 v20, v20, v22
    v_max_u32 v21, v21, v17
    v_med3_u32 v17, v16, v20, v21
    v_max_u32 v16, v16, v20
    v_cmp_eq_u32 vcc, 0, v5
    s_nop 1
    v_cndmask_b32 v11, v17, v16, vcc
    v_and_b32 v11, 0x7ff, v11
    v_sub_u32 v15, 2047, v11
    v_lshl_add_u32 v11, v15, 11, v7
    buffer_load_dwordx4 v[72:75], v11, s[20:23], 0 offen offset:0
    buffer_load_dwordx4 v[76:79], v11, s[20:23], 0 offen offset:512
    buffer_load_dwordx4 v[80:83], v11, s[20:23], 0 offen offset:1024
    buffer_load_dwordx4 v[84:87], v11, s[20:23], 0 offen offset:1536
    s_add_u32 s51, s49, 2
    s_and_b32 s51, s51, 7
    s_mul_i32 s52, s51, 229376
    s_lshl_b32 s51, s51, 10
    s_add_u32 s51, s51, s50
    s_add_u32 m0, s51, 0
    s_nop 0
    buffer_load_dwordx4 v8, s[24:27], s52 offen lds
    s_add_u32 s51, s49, 2
    s_and_b32 s51, s51, 7
    s_mul_i32 s52, s51, 229376
    s_lshl_b32 s51, s51, 10
    s_add_u32 s51, s51, s50
    s_add_u32 m0, s51, 32768
    s_nop 0
    buffer_load_dwordx4 v8, s[28:31], s52 offen lds
    s_add_u32 s51, s49, 3
    s_and_b32 s51, s51, 7
    s_mul_i32 s52, s51, 229376
    s_lshl_b32 s51, s51, 10
    s_add_u32 s51, s51, s50
    s_add_u32 m0, s51, 0
    s_nop 0
    buffer_load_dwordx4 v8, s[24:27], s52 offen lds
    s_add_u32 s51, s49, 3
    s_and_b32 s51, s51, 7
    s_mul_i32 s52, s51, 229376
    s_lshl_b32 s51, s51, 10
    s_add_u32 s51, s51, s50
    s_add_u32 m0, s51, 32768
    s_nop 0
    buffer_load_dwordx4 v8, s[28:31], s52 offen lds
    s_add_u32 s51, s49, 4
    s_and_b32 s51, s51, 7
    s_mul_i32 s52, s51, 229376
    s_lshl_b32 s51, s51, 10
    s_add_u32 s51, s51, s50
    s_add_u32 m0, s51, 0
    s_nop 0
    buffer_load_dwordx4 v8, s[24:27], s52 offen lds
    s_add_u32 s51, s49, 4
    s_and_b32 s51, s51, 7
    s_mul_i32 s52, s51, 229376
    s_lshl_b32 s51, s51, 10
    s_add_u32 s51, s51, s50
    s_add_u32 m0, s51, 32768
    s_nop 0
    buffer_load_dwordx4 v8, s[28:31], s52 offen lds
    s_waitcnt vmcnt(14)
    v_lshlrev_b32 v200, 16, v40
    v_and_b32 v201, 0xffff0000, v40
    v_lshlrev_b32 v202, 16, v41
    v_and_b32 v203, 0xffff0000, v41
    v_lshlrev_b32 v204, 16, v42
    v_and_b32 v205, 0xffff0000, v42
    v_lshlrev_b32 v206, 16, v43
    v_and_b32 v207, 0xffff0000, v43
    v_lshlrev_b32 v208, 16, v44
    v_and_b32 v209, 0xffff0000, v44
    v_lshlrev_b32 v210, 16, v45
    v_and_b32 v211, 0xffff0000, v45
    v_lshlrev_b32 v212, 16, v46
    v_and_b32 v213, 0xffff0000, v46
    v_lshlrev_b32 v214, 16, v47
    v_and_b32 v215, 0xffff0000, v47
    v_lshlrev_b32 v216, 16, v48
    v_and_b32 v217, 0xffff0000, v48
    v_lshlrev_b32 v218, 16, v49
    v_and_b32 v219, 0xffff0000, v49
    v_lshlrev_b32 v220, 16, v50
    v_and_b32 v221, 0xffff0000, v50
    v_lshlrev_b32 v222, 16, v51
    v_and_b32 v223, 0xffff0000, v51
    v_lshlrev_b32 v224, 16, v52
    v_and_b32 v225, 0xffff0000, v52
    v_lshlrev_b32 v226, 16, v53
    v_and_b32 v227, 0xffff0000, v53
    v_lshlrev_b32 v228, 16, v54
    v_and_b32 v229, 0xffff0000, v54
    v_lshlrev_b32 v230, 16, v55
    v_and_b32 v231, 0xffff0000, v55
    v_pk_add_f32 v[192:193], v[200:201], v[202:203]
    v_pk_add_f32 v[194:195], v[204:205], v[206:207]
    v_pk_add_f32 v[192:193], v[192:193], v[208:209]
    v_pk_add_f32 v[194:195], v[194:195], v[210:211]
    v_pk_add_f32 v[192:193], v[192:193], v[212:213]
    v_pk_add_f32 v[194:195], v[194:195], v[214:215]
    v_pk_add_f32 v[192:193], v[192:193], v[216:217]
    v_pk_add_f32 v[194:195], v[194:195], v[218:219]
    v_pk_add_f32 v[192:193], v[192:193], v[220:221]
    v_pk_add_f32 v[194:195], v[194:195], v[222:223]
    v_pk_add_f32 v[192:193], v[192:193], v[224:225]
    v_pk_add_f32 v[194:195], v[194:195], v[226:227]
    v_pk_add_f32 v[192:193], v[192:193], v[228:229]
    v_pk_add_f32 v[194:195], v[194:195], v[230:231]
    v_pk_add_f32 v[192:193], v[192:193], v[194:195]
    v_add_f32 v192, v192, v193
    s_nop 1
    v_add_f32_dpp v192, v192, v192 quad_perm:[1,0,3,2] row_mask:0xf bank_mask:0xf
    s_nop 1
    v_add_f32_dpp v192, v192, v192 quad_perm:[2,3,0,1] row_mask:0xf bank_mask:0xf
    s_nop 1
    v_add_f32_dpp v192, v192, v192 row_half_mirror row_mask:0xf bank_mask:0xf
    s_nop 1
    v_add_f32_dpp v192, v192, v192 row_mirror row_mask:0xf bank_mask:0xf
    v_mov_b32 v194, v192
    s_nop 1
    v_permlane16_swap_b32 v192, v194
    s_nop 1
    v_add_f32 v192, v192, v194
    v_mul_f32 v192, 0xba800000, v192
    v_mov_b32 v193, v192
    v_pk_add_f32 v[194:195], v[200:201], v[192:193]
    v_pk_add_f32 v[198:199], v[202:203], v[192:193]
    v_pk_mul_f32 v[196:197], v[194:195], v[194:195]
    v_pk_fma_f32 v[196:197], v[198:199], v[198:199], v[196:197]
    v_pk_add_f32 v[194:195], v[204:205], v[192:193]
    v_pk_add_f32 v[198:199], v[206:207], v[192:193]
    v_pk_fma_f32 v[196:197], v[194:195], v[194:195], v[196:197]
    v_pk_fma_f32 v[196:197], v[198:199], v[198:199], v[196:197]
    v_pk_add_f32 v[194:195], v[208:209], v[192:193]
    v_pk_add_f32 v[198:199], v[210:211], v[192:193]
    v_pk_fma_f32 v[196:197], v[194:195], v[194:195], v[196:197]
    v_pk_fma_f32 v[196:197], v[198:199], v[198:199], v[196:197]
    v_pk_add_f32 v[194:195], v[212:213], v[192:193]
    v_pk_add_f32 v[198:199], v[214:215], v[192:193]
    v_pk_fma_f32 v[196:197], v[194:195], v[194:195], v[196:197]
    v_pk_fma_f32 v[196:197], v[198:199], v[198:199], v[196:197]
    v_pk_add_f32 v[194:195], v[216:217], v[192:193]
    v_pk_add_f32 v[198:199], v[218:219], v[192:193]
    v_pk_fma_f32 v[196:197], v[194:195], v[194:195], v[196:197]
    v_pk_fma_f32 v[196:197], v[198:199], v[198:199], v[196:197]
    v_pk_add_f32 v[194:195], v[220:221], v[192:193]
    v_pk_add_f32 v[198:199], v[222:223], v[192:193]
    v_pk_fma_f32 v[196:197], v[194:195], v[194:195], v[196:197]
    v_pk_fma_f32 v[196:197], v[198:199], v[198:199], v[196:197]
    v_pk_add_f32 v[194:195], v[224:225], v[192:193]
    v_pk_add_f32 v[198:199], v[226:227], v[192:193]
    v_pk_fma_f32 v[196:197], v[194:195], v[194:195], v[196:197]
    v_pk_fma_f32 v[196:197], v[198:199], v[198:199], v[196:197]
    v_pk_add_f32 v[194:195], v[228:229], v[192:193]
    v_pk_add_f32 v[198:199], v[230:231], v[192:193]
    v_pk_fma_f32 v[196:197], v[194:195], v[194:195], v[196:197]
    v_pk_fma_f32 v[196:197], v[198:199], v[198:199], v[196:197]
    v_add_f32 v196, v196, v197
    s_nop 1
    v_add_f32_dpp v196, v196, v196 quad_perm:[1,0,3,2] row_mask:0xf bank_mask:0xf
    s_nop 1
    v_add_f32_dpp v196, v196, v196 quad_perm:[2,3,0,1] row_mask:0xf bank_mask:0xf
    s_nop 1
    v_add_f32_dpp v196, v196, v196 row_half_mirror row_mask:0xf bank_mask:0xf
    s_nop 1
    v_add_f32_dpp v196, v196, v196 row_mirror row_mask:0xf bank_mask:0xf
    v_mov_b32 v194, v196
    s_nop 1
    v_permlane16_swap_b32 v196, v194
    s_nop 1
    v_add_f32 v196, v196, v194
    v_mul_f32 v196, 0x3a800000, v196
    v_cvt_pk_bf16_f32 v198, v192, v196
    v_and_b32 v196, 0xffff0000, v198
    v_lshlrev_b32 v198, 16, v198
    v_add_f32 v196, 0x3727c5ac, v196
    v_mov_b32 v199, v198
    v_cvt_pk_bf16_f32 v196, v196, v196
    v_and_b32 v196, 0xffff0000, v196
    v_sqrt_f32 v196, v196
    v_pk_add_f32 v[160:161], v[200:201], v[198:199]
    v_pk_add_f32 v[162:163], v[202:203], v[198:199]
    v_pk_add_f32 v[164:165], v[204:205], v[198:199]
    v_pk_add_f32 v[166:167], v[206:207], v[198:199]
    v_pk_add_f32 v[168:169], v[208:209], v[198:199]
    v_pk_add_f32 v[170:171], v[210:211], v[198:199]
    v_pk_add_f32 v[172:173], v[212:213], v[198:199]
    v_pk_add_f32 v[174:175], v[214:215], v[198:199]
    v_pk_add_f32 v[176:177], v[216:217], v[198:199]
    v_pk_add_f32 v[178:179], v[218:219], v[198:199]
    v_pk_add_f32 v[180:181], v[220:221], v[198:199]
    v_pk_add_f32 v[182:183], v[222:223], v[198:199]
    v_pk_add_f32 v[184:185], v[224:225], v[198:199]
    v_pk_add_f32 v[186:187], v[226:227], v[198:199]
    v_pk_add_f32 v[188:189], v[228:229], v[198:199]
    v_pk_add_f32 v[190:191], v[230:231], v[198:199]
    v_cvt_pk_bf16_f32 v196, v196, v196
    v_and_b32 v196, 0xffff0000, v196
    v_rcp_f32 v196, v196
    v_cvt_pk_bf16_f32 v40, v160, v161
    v_cvt_pk_bf16_f32 v41, v162, v163
    v_cvt_pk_bf16_f32 v42, v164, v165
    v_cvt_pk_bf16_f32 v43, v166, v167
    v_cvt_pk_bf16_f32 v44, v168, v169
    v_cvt_pk_bf16_f32 v45, v170, v171
    v_cvt_pk_bf16_f32 v46, v172, v173
    v_cvt_pk_bf16_f32 v47, v174, v175
    v_cvt_pk_bf16_f32 v48, v176, v177
    v_cvt_pk_bf16_f32 v49, v178, v179
    v_cvt_pk_bf16_f32 v50, v180, v181
    v_cvt_pk_bf16_f32 v51, v182, v183
    v_cvt_pk_bf16_f32 v52, v184, v185
    v_cvt_pk_bf16_f32 v53, v186, v187
    v_cvt_pk_bf16_f32 v54, v188, v189
    v_cvt_pk_bf16_f32 v55, v190, v191
    v_mov_b32 v197, v196
    v_lshlrev_b32 v160, 16, v40
    v_and_b32 v161, 0xffff0000, v40
    v_lshlrev_b32 v162, 16, v41
    v_and_b32 v163, 0xffff0000, v41
    v_lshlrev_b32 v164, 16, v42
    v_and_b32 v165, 0xffff0000, v42
    v_lshlrev_b32 v166, 16, v43
    v_and_b32 v167, 0xffff0000, v43
    v_lshlrev_b32 v168, 16, v44
    v_and_b32 v169, 0xffff0000, v44
    v_lshlrev_b32 v170, 16, v45
    v_and_b32 v171, 0xffff0000, v45
    v_lshlrev_b32 v172, 16, v46
    v_and_b32 v173, 0xffff0000, v46
    v_lshlrev_b32 v174, 16, v47
    v_and_b32 v175, 0xffff0000, v47
    v_lshlrev_b32 v176, 16, v48
    v_and_b32 v177, 0xffff0000, v48
    v_lshlrev_b32 v178, 16, v49
    v_and_b32 v179, 0xffff0000, v49
    v_lshlrev_b32 v180, 16, v50
    v_and_b32 v181, 0xffff0000, v50
    v_lshlrev_b32 v182, 16, v51
    v_and_b32 v183, 0xffff0000, v51
    v_lshlrev_b32 v184, 16, v52
    v_and_b32 v185, 0xffff0000, v52
    v_lshlrev_b32 v186, 16, v53
    v_and_b32 v187, 0xffff0000, v53
    v_lshlrev_b32 v188, 16, v54
    v_and_b32 v189, 0xffff0000, v54
    v_lshlrev_b32 v190, 16, v55
    v_and_b32 v191, 0xffff0000, v55
    v_pk_mul_f32 v[160:161], v[160:161], v[196:197]
    v_pk_mul_f32 v[162:163], v[162:163], v[196:197]
    v_pk_mul_f32 v[164:165], v[164:165], v[196:197]
    v_pk_mul_f32 v[166:167], v[166:167], v[196:197]
    v_pk_mul_f32 v[168:169], v[168:169], v[196:197]
    v_pk_mul_f32 v[170:171], v[170:171], v[196:197]
    v_pk_mul_f32 v[172:173], v[172:173], v[196:197]
    v_pk_mul_f32 v[174:175], v[174:175], v[196:197]
    v_pk_mul_f32 v[176:177], v[176:177], v[196:197]
    v_pk_mul_f32 v[178:179], v[178:179], v[196:197]
    v_pk_mul_f32 v[180:181], v[180:181], v[196:197]
    v_pk_mul_f32 v[182:183], v[182:183], v[196:197]
    v_pk_mul_f32 v[184:185], v[184:185], v[196:197]
    v_pk_mul_f32 v[186:187], v[186:187], v[196:197]
    v_pk_mul_f32 v[188:189], v[188:189], v[196:197]
    v_pk_mul_f32 v[190:191], v[190:191], v[196:197]
    v_cvt_pk_bf16_f32 v40, v160, v161
    v_cvt_pk_bf16_f32 v41, v162, v163
    v_cvt_pk_bf16_f32 v42, v164, v165
    v_cvt_pk_bf16_f32 v43, v166, v167
    v_cvt_pk_bf16_f32 v44, v168, v169
    v_cvt_pk_bf16_f32 v45, v170, v171
    v_cvt_pk_bf16_f32 v46, v172, v173
    v_cvt_pk_bf16_f32 v47, v174, v175
    v_cvt_pk_bf16_f32 v48, v176, v177
    v_cvt_pk_bf16_f32 v49, v178, v179
    v_cvt_pk_bf16_f32 v50, v180, v181
    v_cvt_pk_bf16_f32 v51, v182, v183
    v_cvt_pk_bf16_f32 v52, v184, v185
    v_cvt_pk_bf16_f32 v53, v186, v187
    v_cvt_pk_bf16_f32 v54, v188, v189
    v_cvt_pk_bf16_f32 v55, v190, v191
    v_lshlrev_b32 v160, 16, v40
    v_and_b32 v161, 0xffff0000, v40
    v_lshlrev_b32 v162, 16, v41
    v_and_b32 v163, 0xffff0000, v41
    v_lshlrev_b32 v164, 16, v42
    v_and_b32 v165, 0xffff0000, v42
    v_lshlrev_b32 v166, 16, v43
    v_and_b32 v167, 0xffff0000, v43
    v_lshlrev_b32 v168, 16, v44
    v_and_b32 v169, 0xffff0000, v44
    v_lshlrev_b32 v170, 16, v45
    v_and_b32 v171, 0xffff0000, v45
    v_lshlrev_b32 v172, 16, v46
    v_and_b32 v173, 0xffff0000, v46
    v_lshlrev_b32 v174, 16, v47
    v_and_b32 v175, 0xffff0000, v47
    v_lshlrev_b32 v176, 16, v48
    v_and_b32 v177, 0xffff0000, v48
    v_lshlrev_b32 v178, 16, v49
    v_and_b32 v179, 0xffff0000, v49
    v_lshlrev_b32 v180, 16, v50
    v_and_b32 v181, 0xffff0000, v50
    v_lshlrev_b32 v182, 16, v51
    v_and_b32 v183, 0xffff0000, v51
    v_lshlrev_b32 v184, 16, v52
    v_and_b32 v185, 0xffff0000, v52
    v_lshlrev_b32 v186, 16, v53
    v_and_b32 v187, 0xffff0000, v53
    v_lshlrev_b32 v188, 16, v54
    v_and_b32 v189, 0xffff0000, v54
    v_lshlrev_b32 v190, 16, v55
    v_and_b32 v191, 0xffff0000, v55
    v_pk_add_f32 v[160:161], v[160:161], v[200:201]
    v_pk_add_f32 v[162:163], v[162:163], v[202:203]
    v_pk_add_f32 v[164:165], v[164:165], v[204:205]
    v_pk_add_f32 v[166:167], v[166:167], v[206:207]
    v_pk_add_f32 v[168:169], v[168:169], v[208:209]
    v_pk_add_f32 v[170:171], v[170:171], v[210:211]
    v_pk_add_f32 v[172:173], v[172:173], v[212:213]
    v_pk_add_f32 v[174:175], v[174:175], v[214:215]
    v_pk_add_f32 v[176:177], v[176:177], v[216:217]
    v_pk_add_f32 v[178:179], v[178:179], v[218:219]
    v_pk_add_f32 v[180:181], v[180:181], v[220:221]
    v_pk_add_f32 v[182:183], v[182:183], v[222:223]
    v_pk_add_f32 v[184:185], v[184:185], v[224:225]
    v_pk_add_f32 v[186:187], v[186:187], v[226:227]
    v_pk_add_f32 v[188:189], v[188:189], v[228:229]
    v_pk_add_f32 v[190:191], v[190:191], v[230:231]
    v_cvt_pk_bf16_f32 v40, v160, v161
    v_cvt_pk_bf16_f32 v41, v162, v163
    v_cvt_pk_bf16_f32 v42, v164, v165
    v_cvt_pk_bf16_f32 v43, v166, v167
    v_cvt_pk_bf16_f32 v44, v168, v169
    v_cvt_pk_bf16_f32 v45, v170, v171
    v_cvt_pk_bf16_f32 v46, v172, v173
    v_cvt_pk_bf16_f32 v47, v174, v175
    v_cvt_pk_bf16_f32 v48, v176, v177
    v_cvt_pk_bf16_f32 v49, v178, v179
    v_cvt_pk_bf16_f32 v50, v180, v181
    v_cvt_pk_bf16_f32 v51, v182, v183
    v_cvt_pk_bf16_f32 v52, v184, v185
    v_cvt_pk_bf16_f32 v53, v186, v187
    v_cvt_pk_bf16_f32 v54, v188, v189
    v_cvt_pk_bf16_f32 v55, v190, v191
    buffer_store_dwordx4 v[40:43], v6, s[36:39], 0 offen offset:0
    buffer_store_dwordx4 v[44:47], v6, s[36:39], 0 offen offset:512
    buffer_store_dwordx4 v[48:51], v6, s[36:39], 0 offen offset:1024
    buffer_store_dwordx4 v[52:55], v6, s[36:39], 0 offen offset:1536
    s_cmp_ge_u32 s2, 224
    s_cbranch_scc1 k4_end_82
    s_add_u32 s51, s49, 5
    s_and_b32 s51, s51, 7
    s_mul_i32 s52, s51, 229376
    s_lshl_b32 s51, s51, 10
    s_add_u32 s51, s51, s50
    s_add_u32 m0, s51, 0
    s_nop 0
    buffer_load_dwordx4 v8, s[24:27], s52 offen lds
    s_add_u32 s51, s49, 5
    s_and_b32 s51, s51, 7
    s_mul_i32 s52, s51, 229376
    s_lshl_b32 s51, s51, 10
    s_add_u32 s51, s51, s50
    s_add_u32 m0, s51, 32768
    s_nop 0
    buffer_load_dwordx4 v8, s[28:31], s52 offen lds
    s_add_u32 s51, s49, 6
    s_and_b32 s51, s51, 7
    s_mul_i32 s52, s51, 229376
    s_lshl_b32 s51, s51, 10
    s_add_u32 s51, s51, s50
    s_add_u32 m0, s51, 0
    s_nop 0
    buffer_load_dwordx4 v8, s[24:27], s52 offen lds
    s_add_u32 s51, s49, 6
    s_and_b32 s51, s51, 7
    s_mul_i32 s52, s51, 229376
    s_lshl_b32 s51, s51, 10
    s_add_u32 s51, s51, s50
    s_add_u32 m0, s51, 32768
    s_nop 0
    buffer_load_dwordx4 v8, s[28:31], s52 offen lds
    s_add_u32 s51, s49, 7
    s_and_b32 s51, s51, 7
    s_mul_i32 s52, s51, 229376
    s_lshl_b32 s51, s51, 10
    s_add_u32 s51, s51, s50
    s_add_u32 m0, s51, 0
    s_nop 0
    buffer_load_dwordx4 v8, s[24:27], s52 offen lds
    s_add_u32 s51, s49, 7
    s_and_b32 s51, s51, 7
    s_mul_i32 s52, s51, 229376
    s_lshl_b32 s51, s51, 10
    s_add_u32 s51, s51, s50
    s_add_u32 m0, s51, 32768
    s_nop 0
    buffer_load_dwordx4 v8, s[28:31], s52 offen lds
    s_lshl_b32 s52, s45, 15
    buffer_load_dwordx2 v[88:89], v9, s[32:35], s52 offen offset:0
    buffer_load_dwordx2 v[90:91], v9, s[32:35], s52 offen offset:2048
    s_add_u32 s52, s52, 4096
    buffer_load_dwordx2 v[92:93], v9, s[32:35], s52 offen offset:0
    buffer_load_dwordx2 v[94:95], v9, s[32:35], s52 offen offset:2048
    s_add_u32 s52, s52, 4096
    buffer_load_dwordx2 v[96:97], v9, s[32:35], s52 offen offset:0
    buffer_load_dwordx2 v[98:99], v9, s[32:35], s52 offen offset:2048
    s_add_u32 s52, s52, 4096
    buffer_load_dwordx2 v[100:101], v9, s[32:35], s52 offen offset:0
    buffer_load_dwordx2 v[102:103], v9, s[32:35], s52 offen offset:2048
    s_add_u32 s52, s52, 4096
    buffer_load_dwordx2 v[104:105], v9, s[32:35], s52 offen offset:0
    buffer_load_dwordx2 v[106:107], v9, s[32:35], s52 offen offset:2048
    s_add_u32 s52, s52, 4096
    buffer_load_dwordx2 v[108:109], v9, s[32:35], s52 offen offset:0
    buffer_load_dwordx2 v[110:111], v9, s[32:35], s52 offen offset:2048
    s_add_u32 s52, s52, 4096
    buffer_load_dwordx2 v[112:113], v9, s[32:35], s52 offen offset:0
    buffer_load_dwordx2 v[114:115], v9, s[32:35], s52 offen offset:2048
    s_add_u32 s52, s52, 4096
    buffer_load_dwordx2 v[116:117], v9, s[32:35], s52 offen offset:0
    buffer_load_dwordx2 v[118:119], v9, s[32:35], s52 offen offset:2048
    s_add_u32 s52, s52, 4096
    s_waitcnt vmcnt(32)
    v_lshlrev_b32 v160, 16, v72
    v_and_b32 v161, 0xffff0000, v72
    v_lshlrev_b32 v162, 16, v73
    v_and_b32 v163, 0xffff0000, v73
    v_lshlrev_b32 v164, 16, v74
    v_and_b32 v165, 0xffff0000, v74
    v_lshlrev_b32 v166, 16, v75
    v_and_b32 v167, 0xffff0000, v75
    v_lshlrev_b32 v168, 16, v76
    v_and_b32 v169, 0xffff0000, v76
    v_lshlrev_b32 v170, 16, v77
    v_and_b32 v171, 0xffff0000, v77
    v_lshlrev_b32 v172, 16, v78
    v_and_b32 v173, 0xffff0000, v78
    v_lshlrev_b32 v174, 16, v79
    v_and_b32 v175, 0xffff0000, v79
    v_lshlrev_b32 v176, 16, v80
    v_and_b32 v177, 0xffff0000, v80
    v_lshlrev_b32 v178, 16, v81
    v_and_b32 v179, 0xffff0000, v81
    v_lshlrev_b32 v180, 16, v82
    v_and_b32 v181, 0xffff0000, v82
    v_lshlrev_b32 v182, 16, v83
    v_and_b32 v183, 0xffff0000, v83
    v_lshlrev_b32 v184, 16, v84
    v_and_b32 v185, 0xffff0000, v84
    v_lshlrev_b32 v186, 16, v85
    v_and_b32 v187, 0xffff0000, v85
    v_lshlrev_b32 v188, 16, v86
    v_and_b32 v189, 0xffff0000, v86
    v_lshlrev_b32 v190, 16, v87
    v_and_b32 v191, 0xffff0000, v87
    v_pk_add_f32 v[192:193], v[160:161], v[162:163]
    v_pk_add_f32 v[194:195], v[164:165], v[166:167]
    v_pk_add_f32 v[192:193], v[192:193], v[168:169]
    v_pk_add_f32 v[194:195], v[194:195], v[170:171]
    v_pk_add_f32 v[192:193], v[192:193], v[172:173]
    v_pk_add_f32 v[194:195], v[194:195], v[174:175]
    v_pk_add_f32 v[192:193], v[192:193], v[176:177]
    v_pk_add_f32 v[194:195], v[194:195], v[178:179]
    v_pk_add_f32 v[192:193], v[192:193], v[180:181]
    v_pk_add_f32 v[194:195], v[194:195], v[182:183]
    v_pk_add_f32 v[192:193], v[192:193], v[184:185]
    v_pk_add_f32 v[194:195], v[194:195], v[186:187]
    v_pk_add_f32 v[192:193], v[192:193], v[188:189]
    v_pk_add_f32 v[194:195], v[194:195], v[190:191]
    v_pk_add_f32 v[192:193], v[192:193], v[194:195]
    v_add_f32 v192, v192, v193
    s_nop 1
    v_add_f32_dpp v192, v192, v192 quad_perm:[1,0,3,2] row_mask:0xf bank_mask:0xf
    s_nop 1
    v_add_f32_dpp v192, v192, v192 quad_perm:[2,3,0,1] row_mask:0xf bank_mask:0xf
    s_nop 1
    v_add_f32_dpp v192, v192, v192 row_half_mirror row_mask:0xf bank_mask:0xf
    s_nop 1
    v_add_f32_dpp v192, v192, v192 row_mirror row_mask:0xf bank_mask:0xf
    v_mov_b32 v194, v192
    s_nop 1
    v_permlane16_swap_b32 v192, v194
    s_nop 1
    v_add_f32 v192, v192, v194
    v_mul_f32 v192, 0xba800000, v192
    v_mov_b32 v193, v192
    v_pk_add_f32 v[194:195], v[160:161], v[192:193]
    v_pk_add_f32 v[198:199], v[162:163], v[192:193]
    v_pk_mul_f32 v[196:197], v[194:195], v[194:195]
    v_pk_fma_f32 v[196:197], v[198:199], v[198:199], v[196:197]
    v_pk_add_f32 v[194:195], v[164:165], v[192:193]
    v_pk_add_f32 v[198:199], v[166:167], v[192:193]
    v_pk_fma_f32 v[196:197], v[194:195], v[194:195], v[196:197]
    v_pk_fma_f32 v[196:197], v[198:199], v[198:199], v[196:197]
    v_pk_add_f32 v[194:195], v[168:169], v[192:193]
    v_pk_add_f32 v[198:199], v[170:171], v[192:193]
    v_pk_fma_f32 v[196:197], v[194:195], v[194:195], v[196:197]
    v_pk_fma_f32 v[196:197], v[198:199], v[198:199], v[196:197]
    v_pk_add_f32 v[194:195], v[172:173], v[192:193]
    v_pk_add_f32 v[198:199], v[174:175], v[192:193]
    v_pk_fma_f32 v[196:197], v[194:195], v[194:195], v[196:197]
    v_pk_fma_f32 v[196:197], v[198:199], v[198:199], v[196:197]
    v_pk_add_f32 v[194:195], v[176:177], v[192:193]
    v_pk_add_f32 v[198:199], v[178:179], v[192:193]
    v_pk_fma_f32 v[196:197], v[194:195], v[194:195], v[196:197]
    v_pk_fma_f32 v[196:197], v[198:199], v[198:199], v[196:197]
    v_pk_add_f32 v[194:195], v[180:181], v[192:193]
    v_pk_add_f32 v[198:199], v[182:183], v[192:193]
    v_pk_fma_f32 v[196:197], v[194:195], v[194:195], v[196:197]
    v_pk_fma_f32 v[196:197], v[198:199], v[198:199], v[196:197]
    v_pk_add_f32 v[194:195], v[184:185], v[192:193]
    v_pk_add_f32 v[198:199], v[186:187], v[192:193]
    v_pk_fma_f32 v[196:197], v[194:195], v[194:195], v[196:197]
    v_pk_fma_f32 v[196:197], v[198:199], v[198:199], v[196:197]
    v_pk_add_f32 v[194:195], v[188:189], v[192:193]
    v_pk_add_f32 v[198:199], v[190:191], v[192:193]
    v_pk_fma_f32 v[196:197], v[194:195], v[194:195], v[196:197]
    v_pk_fma_f32 v[196:197], v[198:199], v[198:199], v[196:197]
    v_add_f32 v196, v196, v197
    s_nop 1
    v_add_f32_dpp v196, v196, v196 quad_perm:[1,0,3,2] row_mask:0xf bank_mask:0xf
    s_nop 1
    v_add_f32_dpp v196, v196, v196 quad_perm:[2,3,0,1] row_mask:0xf bank_mask:0xf
    s_nop 1
    v_add_f32_dpp v196, v196, v196 row_half_mirror row_mask:0xf bank_mask:0xf
    s_nop 1
    v_add_f32_dpp v196, v196, v196 row_mirror row_mask:0xf bank_mask:0xf
    v_mov_b32 v194, v196
    s_nop 1
    v_permlane16_swap_b32 v196, v194
    s_nop 1
    v_add_f32 v196, v196, v194
    v_mul_f32 v196, 0x3a800000, v196
    v_cvt_pk_bf16_f32 v198, v192, v196
    v_and_b32 v196, 0xffff0000, v198
    v_lshlrev_b32 v198, 16, v198
    v_add_f32 v196, 0x3727c5ac, v196
    v_mov_b32 v199, v198
    v_cvt_pk_bf16_f32 v196, v196, v196
    v_and_b32 v196, 0xffff0000, v196
    v_sqrt_f32 v196, v196
    v_pk_add_f32 v[160:161], v[160:161], v[198:199]
    v_pk_add_f32 v[162:163], v[162:163], v[198:199]
    v_pk_add_f32 v[164:165], v[164:165], v[198:199]
    v_pk_add_f32 v[166:167], v[166:167], v[198:199]
    v_pk_add_f32 v[168:169], v[168:169], v[198:199]
    v_pk_add_f32 v[170:171], v[170:171], v[198:199]
    v_pk_add_f32 v[172:173], v[172:173], v[198:199]
    v_pk_add_f32 v[174:175], v[174:175], v[198:199]
    v_pk_add_f32 v[176:177], v[176:177], v[198:199]
    v_pk_add_f32 v[178:179], v[178:179], v[198:199]
    v_pk_add_f32 v[180:181], v[180:181], v[198:199]
    v_pk_add_f32 v[182:183], v[182:183], v[198:199]
    v_pk_add_f32 v[184:185], v[184:185], v[198:199]
    v_pk_add_f32 v[186:187], v[186:187], v[198:199]
    v_pk_add_f32 v[188:189], v[188:189], v[198:199]
    v_pk_add_f32 v[190:191], v[190:191], v[198:199]
    v_cvt_pk_bf16_f32 v196, v196, v196
    v_and_b32 v196, 0xffff0000, v196
    v_rcp_f32 v196, v196
    v_cvt_pk_bf16_f32 v72, v160, v161
    v_cvt_pk_bf16_f32 v73, v162, v163
    v_cvt_pk_bf16_f32 v74, v164, v165
    v_cvt_pk_bf16_f32 v75, v166, v167
    v_cvt_pk_bf16_f32 v76, v168, v169
    v_cvt_pk_bf16_f32 v77, v170, v171
    v_cvt_pk_bf16_f32 v78, v172, v173
    v_cvt_pk_bf16_f32 v79, v174, v175
    v_cvt_pk_bf16_f32 v80, v176, v177
    v_cvt_pk_bf16_f32 v81, v178, v179
    v_cvt_pk_bf16_f32 v82, v180, v181
    v_cvt_pk_bf16_f32 v83, v182, v183
    v_cvt_pk_bf16_f32 v84, v184, v185
    v_cvt_pk_bf16_f32 v85, v186, v187
    v_cvt_pk_bf16_f32 v86, v188, v189
    v_cvt_pk_bf16_f32 v87, v190, v191
    v_mov_b32 v197, v196
    v_lshlrev_b32 v160, 16, v72
    v_and_b32 v161, 0xffff0000, v72
    v_lshlrev_b32 v162, 16, v73
    v_and_b32 v163, 0xffff0000, v73
    v_lshlrev_b32 v164, 16, v74
    v_and_b32 v165, 0xffff0000, v74
    v_lshlrev_b32 v166, 16, v75
    v_and_b32 v167, 0xffff0000, v75
    v_lshlrev_b32 v168, 16, v76
    v_and_b32 v169, 0xffff0000, v76
    v_lshlrev_b32 v170, 16, v77
    v_and_b32 v171, 0xffff0000, v77
    v_lshlrev_b32 v172, 16, v78
    v_and_b32 v173, 0xffff0000, v78
    v_lshlrev_b32 v174, 16, v79
    v_and_b32 v175, 0xffff0000, v79
    v_lshlrev_b32 v176, 16, v80
    v_and_b32 v177, 0xffff0000, v80
    v_lshlrev_b32 v178, 16, v81
    v_and_b32 v179, 0xffff0000, v81
    v_lshlrev_b32 v180, 16, v82
    v_and_b32 v181, 0xffff0000, v82
    v_lshlrev_b32 v182, 16, v83
    v_and_b32 v183, 0xffff0000, v83
    v_lshlrev_b32 v184, 16, v84
    v_and_b32 v185, 0xffff0000, v84
    v_lshlrev_b32 v186, 16, v85
    v_and_b32 v187, 0xffff0000, v85
    v_lshlrev_b32 v188, 16, v86
    v_and_b32 v189, 0xffff0000, v86
    v_lshlrev_b32 v190, 16, v87
    v_and_b32 v191, 0xffff0000, v87
    v_pk_mul_f32 v[160:161], v[160:161], v[196:197]
    v_pk_mul_f32 v[162:163], v[162:163], v[196:197]
    v_pk_mul_f32 v[164:165], v[164:165], v[196:197]
    v_pk_mul_f32 v[166:167], v[166:167], v[196:197]
    v_pk_mul_f32 v[168:169], v[168:169], v[196:197]
    v_pk_mul_f32 v[170:171], v[170:171], v[196:197]
    v_pk_mul_f32 v[172:173], v[172:173], v[196:197]
    v_pk_mul_f32 v[174:175], v[174:175], v[196:197]
    v_pk_mul_f32 v[176:177], v[176:177], v[196:197]
    v_pk_mul_f32 v[178:179], v[178:179], v[196:197]
    v_pk_mul_f32 v[180:181], v[180:181], v[196:197]
    v_pk_mul_f32 v[182:183], v[182:183], v[196:197]
    v_pk_mul_f32 v[184:185], v[184:185], v[196:197]
    v_pk_mul_f32 v[186:187], v[186:187], v[196:197]
    v_pk_mul_f32 v[188:189], v[188:189], v[196:197]
    v_pk_mul_f32 v[190:191], v[190:191], v[196:197]
    v_cvt_pk_bf16_f32 v72, v160, v161
    v_cvt_pk_bf16_f32 v73, v162, v163
    v_cvt_pk_bf16_f32 v74, v164, v165
    v_cvt_pk_bf16_f32 v75, v166, v167
    v_cvt_pk_bf16_f32 v76, v168, v169
    v_cvt_pk_bf16_f32 v77, v170, v171
    v_cvt_pk_bf16_f32 v78, v172, v173
    v_cvt_pk_bf16_f32 v79, v174, v175
    v_cvt_pk_bf16_f32 v80, v176, v177
    v_cvt_pk_bf16_f32 v81, v178, v179
    v_cvt_pk_bf16_f32 v82, v180, v181
    v_cvt_pk_bf16_f32 v83, v182, v183
    v_cvt_pk_bf16_f32 v84, v184, v185
    v_cvt_pk_bf16_f32 v85, v186, v187
    v_cvt_pk_bf16_f32 v86, v188, v189
    v_cvt_pk_bf16_f32 v87, v190, v191
    v_lshlrev_b32 v11, 11, v5
    v_add_u32 v11, v11, v7
    s_lshl_b32 s53, s44, 12
    s_add_u32 s53, s53, 65536
    v_add_u32 v11, s53, v11
    ds_write_b128 v11, v[72:75] offset:0
    ds_write_b128 v11, v[76:79] offset:512
    ds_write_b128 v11, v[80:83] offset:1024
    ds_write_b128 v11, v[84:87] offset:1536
    s_or_b32 s54, s2, s44
    s_cmp_lg_u32 s54, 0
    s_cbranch_scc1 k4_nosel_83
    s_add_u32 s56, s14, 0x4c00000
    s_addc_u32 s57, s15, 0
    s_and_b32 s57, s57, 0xffff
    s_mov_b32 s58, 0x2000
    s_mov_b32 s59, 0x00020000
    v_lshlrev_b32 v160, 16, v72
    v_and_b32 v161, 0xffff0000, v72
    v_lshlrev_b32 v162, 16, v73
    v_and_b32 v163, 0xffff0000, v73
    v_lshlrev_b32 v164, 16, v74
    v_and_b32 v165, 0xffff0000, v74
    v_lshlrev_b32 v166, 16, v75
    v_and_b32 v167, 0xffff0000, v75
    v_lshlrev_b32 v168, 16, v76
    v_and_b32 v169, 0xffff0000, v76
    v_lshlrev_b32 v170, 16, v77
    v_and_b32 v171, 0xffff0000, v77
    v_lshlrev_b32 v172, 16, v78
    v_and_b32 v173, 0xffff0000, v78
    v_lshlrev_b32 v174, 16, v79
    v_and_b32 v175, 0xffff0000, v79
    v_lshlrev_b32 v176, 16, v80
    v_and_b32 v177, 0xffff0000, v80
    v_lshlrev_b32 v178, 16, v81
    v_and_b32 v179, 0xffff0000, v81
    v_lshlrev_b32 v180, 16, v82
    v_and_b32 v181, 0xffff0000, v82
    v_lshlrev_b32 v182, 16, v83
    v_and_b32 v183, 0xffff0000, v83
    v_lshlrev_b32 v184, 16, v84
    v_and_b32 v185, 0xffff0000, v84
    v_lshlrev_b32 v186, 16, v85
    v_and_b32 v187, 0xffff0000, v85
    v_lshlrev_b32 v188, 16, v86
    v_and_b32 v189, 0xffff0000, v86
    v_lshlrev_b32 v190, 16, v87
    v_and_b32 v191, 0xffff0000, v87
    v_pk_mul_f32 v[12:13], v[160:161], v[128:129]
    v_pk_fma_f32 v[12:13], v[162:163], v[130:131], v[12:13]
    v_pk_fma_f32 v[12:13], v[164:165], v[132:133], v[12:13]
    v_pk_fma_f32 v[12:13], v[166:167], v[134:135], v[12:13]
    v_pk_fma_f32 v[12:13], v[168:169], v[136:137], v[12:13]
    v_pk_fma_f32 v[12:13], v[170:171], v[138:139], v[12:13]
    v_pk_fma_f32 v[12:13], v[172:173], v[140:141], v[12:13]
    v_pk_fma_f32 v[12:13], v[174:175], v[142:143], v[12:13]
    v_pk_fma_f32 v[12:13], v[176:177], v[144:145], v[12:13]
    v_pk_fma_f32 v[12:13], v[178:179], v[146:147], v[12:13]
    v_pk_fma_f32 v[12:13], v[180:181], v[148:149], v[12:13]
    v_pk_fma_f32 v[12:13], v[182:183], v[150:151], v[12:13]
    v_pk_fma_f32 v[12:13], v[184:185], v[152:153], v[12:13]
    v_pk_fma_f32 v[12:13], v[186:187], v[154:155], v[12:13]
    v_pk_fma_f32 v[12:13], v[188:189], v[156:157], v[12:13]
    v_pk_fma_f32 v[12:13], v[190:191], v[158:159], v[12:13]
    v_add_f32 v12, v12, v13
    s_nop 1
    v_add_f32_dpp v12, v12, v12 quad_perm:[1,0,3,2] row_mask:0xf bank_mask:0xf
    s_nop 1
    v_add_f32_dpp v12, v12, v12 quad_perm:[2,3,0,1] row_mask:0xf bank_mask:0xf
    s_nop 1
    v_add_f32_dpp v12, v12, v12 row_half_mirror row_mask:0xf bank_mask:0xf
    s_nop 1
    v_add_f32_dpp v12, v12, v12 row_mirror row_mask:0xf bank_mask:0xf
    v_mov_b32 v13, v12
    s_nop 1
    v_permlane16_swap_b32 v12, v13
    s_nop 1
    v_add_f32 v12, v12, v13
    v_cvt_pk_bf16_f32 v12, v12, v12
    v_and_b32 v12, 0xffff0000, v12
    v_mul_f32 v12, 0xbfb8aa3b, v12
    v_exp_f32 v12, v12
    s_nop 0
    v_add_f32 v12, 1.0, v12
    v_rcp_f32 v12, v12
    s_nop 0
    v_cvt_pk_bf16_f32 v12, v12, v12
    v_and_b32 v12, 0xffff0000, v12
    v_lshlrev_b32 v13, 2, v5
    buffer_store_dword v15, v13, s[56:59], 0 offen
    buffer_store_dword v12, v13, s[56:59], 0 offen offset:8
    v_lshl_add_u32 v13, v5, 11, v7
    s_mov_b32 s54, 4096
    buffer_store_dwordx4 v[72:75], v13, s[56:59], s54 offen offset:0
    buffer_store_dwordx4 v[76:79], v13, s[56:59], s54 offen offset:512
    buffer_store_dwordx4 v[80:83], v13, s[56:59], s54 offen offset:1024
    buffer_store_dwordx4 v[84:87], v13, s[56:59], s54 offen offset:1536
    s_waitcnt vmcnt(0)
k4_nosel_83:
    v_lshrrev_b32 v12, 4, v2
    v_and_b32 v13, 1, v2
    v_lshlrev_b32 v13, 11, v13
    v_lshl_add_u32 v13, v12, 3, v13
    s_lshl_b32 s54, s44, 9
    s_add_u32 s54, s54, s53
    v_add_u32 v13, s54, v13
    s_waitcnt lgkmcnt(0)
    ds_read_b64 v[160:161], v13 offset:0
    ds_read_b64 v[162:163], v13 offset:32
    ds_read_b64 v[164:165], v13 offset:64
    ds_read_b64 v[166:167], v13 offset:96
    ds_read_b64 v[168:169], v13 offset:128
    ds_read_b64 v[170:171], v13 offset:160
    ds_read_b64 v[172:173], v13 offset:192
    ds_read_b64 v[174:175], v13 offset:224
    ds_read_b64 v[176:177], v13 offset:256
    ds_read_b64 v[178:179], v13 offset:288
    ds_read_b64 v[180:181], v13 offset:320
    ds_read_b64 v[182:183], v13 offset:352
    ds_read_b64 v[184:185], v13 offset:384
    ds_read_b64 v[186:187], v13 offset:416
    ds_read_b64 v[188:189], v13 offset:448
    ds_read_b64 v[190:191], v13 offset:480
    v_lshlrev_b32 v14, 3, v2
    v_add_u32 v14, s50, v14
    s_waitcnt vmcnt(16)
    ds_read_b64_tr_b16 v[192:193], v14 offset:0
    ds_read_b64_tr_b16 v[194:195], v14 offset:512
    ds_read_b64_tr_b16 v[196:197], v14 offset:1024
    ds_read_b64_tr_b16 v[198:199], v14 offset:1536
    ds_read_b64_tr_b16 v[200:201], v14 offset:2048
    ds_read_b64_tr_b16 v[202:203], v14 offset:2560
    ds_read_b64_tr_b16 v[204:205], v14 offset:3072
    ds_read_b64_tr_b16 v[206:207], v14 offset:3584
    ds_read_b64_tr_b16 v[208:209], v14 offset:4096
    ds_read_b64_tr_b16 v[210:211], v14 offset:4608
    ds_read_b64_tr_b16 v[212:213], v14 offset:5120
    ds_read_b64_tr_b16 v[214:215], v14 offset:5632
    ds_read_b64_tr_b16 v[216:217], v14 offset:6144
    ds_read_b64_tr_b16 v[218:219], v14 offset:6656
    ds_read_b64_tr_b16 v[220:221], v14 offset:7168
    ds_read_b64_tr_b16 v[222:223], v14 offset:7680
    ds_read_b64_tr_b16 v[224:225], v14 offset:32768
    ds_read_b64_tr_b16 v[226:227], v14 offset:33280
    ds_read_b64_tr_b16 v[228:229], v14 offset:33792
    ds_read_b64_tr_b16 v[230:231], v14 offset:34304
    ds_read_b64_tr_b16 v[232:233], v14 offset:34816
    ds_read_b64_tr_b16 v[234:235], v14 offset:35328
    ds_read_b64_tr_b16 v[236:237], v14 offset:35840
    ds_read_b64_tr_b16 v[238:239], v14 offset:36352
    ds_read_b64_tr_b16 v[240:241], v14 offset:36864
    ds_read_b64_tr_b16 v[242:243], v14 offset:37376
    ds_read_b64_tr_b16 v[244:245], v14 offset:37888
    ds_read_b64_tr_b16 v[246:247], v14 offset:38400
    ds_read_b64_tr_b16 v[248:249], v14 offset:38912
    ds_read_b64_tr_b16 v[250:251], v14 offset:39424
    ds_read_b64_tr_b16 v[252:253], v14 offset:39936
    ds_read_b64_tr_b16 v[254:255], v14 offset:40448
    s_waitcnt lgkmcnt(0)
    v_mfma_f32_16x16x32_bf16 v[16:19], v[192:195], v[160:163], 0
    v_mfma_f32_16x16x32_bf16 v[20:23], v[224:227], v[160:163], 0
    v_mfma_f32_16x16x32_bf16 v[16:19], v[196:199], v[164:167], v[16:19]
    v_mfma_f32_16x16x32_bf16 v[20:23], v[228:231], v[164:167], v[20:23]
    v_mfma_f32_16x16x32_bf16 v[16:19], v[200:203], v[168:171], v[16:19]
    v_mfma_f32_16x16x32_bf16 v[20:23], v[232:235], v[168:171], v[20:23]
    v_mfma_f32_16x16x32_bf16 v[16:19], v[204:207], v[172:175], v[16:19]
    v_mfma_f32_16x16x32_bf16 v[20:23], v[236:239], v[172:175], v[20:23]
    v_mfma_f32_16x16x32_bf16 v[16:19], v[208:211], v[176:179], v[16:19]
    v_mfma_f32_16x16x32_bf16 v[20:23], v[240:243], v[176:179], v[20:23]
    v_mfma_f32_16x16x32_bf16 v[16:19], v[212:215], v[180:183], v[16:19]
    v_mfma_f32_16x16x32_bf16 v[20:23], v[244:247], v[180:183], v[20:23]
    v_mfma_f32_16x16x32_bf16 v[16:19], v[216:219], v[184:187], v[16:19]
    v_mfma_f32_16x16x32_bf16 v[20:23], v[248:251], v[184:187], v[20:23]
    v_mfma_f32_16x16x32_bf16 v[16:19], v[220:223], v[188:191], v[16:19]
    v_mfma_f32_16x16x32_bf16 v[20:23], v[252:255], v[188:191], v[20:23]
    v_and_b32 v13, 15, v2
    v_lshlrev_b32 v13, 6, v13
    v_lshl_add_u32 v13, v12, 4, v13
    s_lshl_b32 s54, s44, 11
    s_add_u32 s54, s54, 81984
    v_add_u32 v13, s54, v13
    s_nop 4
    ds_write_b128 v13, v[16:19]
    ds_write_b128 v13, v[20:23] offset:1024
    s_waitcnt lgkmcnt(0)
    s_barrier
    v_lshlrev_b32 v13, 2, v4
    v_add_u32 v13, 81984, v13
    ds_read_b32 v16, v13 offset:0
    ds_read_b32 v20, v13 offset:1024
    ds_read_b32 v17, v13 offset:2048
    ds_read_b32 v21, v13 offset:3072
    ds_read_b32 v18, v13 offset:4096
    ds_read_b32 v22, v13 offset:5120
    ds_read_b32 v19, v13 offset:6144
    ds_read_b32 v23, v13 offset:7168
    s_waitcnt lgkmcnt(0)
    v_add_f32 v16, v16, v17
    v_add_f32 v18, v18, v19
    v_add_f32 v20, v20, v21
    v_add_f32 v22, v22, v23
    v_add_f32 v16, v16, v18
    v_add_f32 v20, v20, v22
    v_cvt_pk_bf16_f32 v16, v16, v20
    v_and_b32 v20, 0xffff0000, v16
    v_lshlrev_b32 v16, 16, v16
    v_mul_f32 v17, 0xbfb8aa3b, v16
    v_exp_f32 v17, v17
    s_nop 0
    v_add_f32 v17, 1.0, v17
    v_rcp_f32 v17, v17
    s_nop 0
    v_mul_f32 v16, v16, v17
    v_cvt_pk_bf16_f32 v16, v16, v16
    v_and_b32 v16, 0xffff0000, v16
    v_mul_f32 v16, v16, v20
    s_nop 1
    v_mov_b32_dpp v17, v16 quad_perm:[1,0,3,2] row_mask:0xf bank_mask:0xf
    v_cvt_pk_bf16_f32 v16, v16, v17
    s_nop 0
    v_readlane_b32 s16, v16, 0
    v_readlane_b32 s17, v16, 2
    v_readlane_b32 s18, v16, 4
    v_readlane_b32 s19, v16, 6
    v_readlane_b32 s20, v16, 8
    v_readlane_b32 s21, v16, 10
    v_readlane_b32 s22, v16, 12
    v_readlane_b32 s23, v16, 14
    v_readlane_b32 s24, v16, 16
    v_readlane_b32 s25, v16, 18
    v_readlane_b32 s26, v16, 20
    v_readlane_b32 s27, v16, 22
    v_readlane_b32 s28, v16, 24
    v_readlane_b32 s29, v16, 26
    v_readlane_b32 s30, v16, 28
    v_readlane_b32 s31, v16, 30
    s_mov_b32 s54, 0x05040100
    s_mov_b32 s55, 0x07060302
    s_waitcnt vmcnt(0)
    v_perm_b32 v16, v90, v88, s54
    v_perm_b32 v17, v90, v88, s55
    v_dot2_f32_bf16 v24, v16, s16, 0
    v_dot2_f32_bf16 v25, v17, s16, 0
    v_dot2_f32_bf16 v28, v16, s24, 0
    v_dot2_f32_bf16 v29, v17, s24, 0
    v_perm_b32 v16, v91, v89, s54
    v_perm_b32 v17, v91, v89, s55
    v_dot2_f32_bf16 v26, v16, s16, 0
    v_dot2_f32_bf16 v27, v17, s16, 0
    v_dot2_f32_bf16 v30, v16, s24, 0
    v_dot2_f32_bf16 v31, v17, s24, 0
    v_perm_b32 v16, v94, v92, s54
    v_perm_b32 v17, v94, v92, s55
    v_dot2_f32_bf16 v24, v16, s17, v24
    v_dot2_f32_bf16 v25, v17, s17, v25
    v_dot2_f32_bf16 v28, v16, s25, v28
    v_dot2_f32_bf16 v29, v17, s25, v29
    v_perm_b32 v16, v95, v93, s54
    v_perm_b32 v17, v95, v93, s55
    v_dot2_f32_bf16 v26, v16, s17, v26
    v_dot2_f32_bf16 v27, v17, s17, v27
    v_dot2_f32_bf16 v30, v16, s25, v30
    v_dot2_f32_bf16 v31, v17, s25, v31
    v_perm_b32 v16, v98, v96, s54
    v_perm_b32 v17, v98, v96, s55
    v_dot2_f32_bf16 v24, v16, s18, v24
    v_dot2_f32_bf16 v25, v17, s18, v25
    v_dot2_f32_bf16 v28, v16, s26, v28
    v_dot2_f32_bf16 v29, v17, s26, v29
    v_perm_b32 v16, v99, v97, s54
    v_perm_b32 v17, v99, v97, s55
    v_dot2_f32_bf16 v26, v16, s18, v26
    v_dot2_f32_bf16 v27, v17, s18, v27
    v_dot2_f32_bf16 v30, v16, s26, v30
    v_dot2_f32_bf16 v31, v17, s26, v31
    v_perm_b32 v16, v102, v100, s54
    v_perm_b32 v17, v102, v100, s55
    v_dot2_f32_bf16 v24, v16, s19, v24
    v_dot2_f32_bf16 v25, v17, s19, v25
    v_dot2_f32_bf16 v28, v16, s27, v28
    v_dot2_f32_bf16 v29, v17, s27, v29
    v_perm_b32 v16, v103, v101, s54
    v_perm_b32 v17, v103, v101, s55
    v_dot2_f32_bf16 v26, v16, s19, v26
    v_dot2_f32_bf16 v27, v17, s19, v27
    v_dot2_f32_bf16 v30, v16, s27, v30
    v_dot2_f32_bf16 v31, v17, s27, v31
    v_perm_b32 v16, v106, v104, s54
    v_perm_b32 v17, v106, v104, s55
    v_dot2_f32_bf16 v24, v16, s20, v24
    v_dot2_f32_bf16 v25, v17, s20, v25
    v_dot2_f32_bf16 v28, v16, s28, v28
    v_dot2_f32_bf16 v29, v17, s28, v29
    v_perm_b32 v16, v107, v105, s54
    v_perm_b32 v17, v107, v105, s55
    v_dot2_f32_bf16 v26, v16, s20, v26
    v_dot2_f32_bf16 v27, v17, s20, v27
    v_dot2_f32_bf16 v30, v16, s28, v30
    v_dot2_f32_bf16 v31, v17, s28, v31
    v_perm_b32 v16, v110, v108, s54
    v_perm_b32 v17, v110, v108, s55
    v_dot2_f32_bf16 v24, v16, s21, v24
    v_dot2_f32_bf16 v25, v17, s21, v25
    v_dot2_f32_bf16 v28, v16, s29, v28
    v_dot2_f32_bf16 v29, v17, s29, v29
    v_perm_b32 v16, v111, v109, s54
    v_perm_b32 v17, v111, v109, s55
    v_dot2_f32_bf16 v26, v16, s21, v26
    v_dot2_f32_bf16 v27, v17, s21, v27
    v_dot2_f32_bf16 v30, v16, s29, v30
    v_dot2_f32_bf16 v31, v17, s29, v31
    v_perm_b32 v16, v114, v112, s54
    v_perm_b32 v17, v114, v112, s55
    v_dot2_f32_bf16 v24, v16, s22, v24
    v_dot2_f32_bf16 v25, v17, s22, v25
    v_dot2_f32_bf16 v28, v16, s30, v28
    v_dot2_f32_bf16 v29, v17, s30, v29
    v_perm_b32 v16, v115, v113, s54
    v_perm_b32 v17, v115, v113, s55
    v_dot2_f32_bf16 v26, v16, s22, v26
    v_dot2_f32_bf16 v27, v17, s22, v27
    v_dot2_f32_bf16 v30, v16, s30, v30
    v_dot2_f32_bf16 v31, v17, s30, v31
    v_perm_b32 v16, v118, v116, s54
    v_perm_b32 v17, v118, v116, s55
    v_dot2_f32_bf16 v24, v16, s23, v24
    v_dot2_f32_bf16 v25, v17, s23, v25
    v_dot2_f32_bf16 v28, v16, s31, v28
    v_dot2_f32_bf16 v29, v17, s31, v29
    v_perm_b32 v16, v119, v117, s54
    v_perm_b32 v17, v119, v117, s55
    v_dot2_f32_bf16 v26, v16, s23, v26
    v_dot2_f32_bf16 v27, v17, s23, v27
    v_dot2_f32_bf16 v30, v16, s31, v30
    v_dot2_f32_bf16 v31, v17, s31, v31
    s_add_u32 s56, s14, 0x4900000
    s_addc_u32 s57, s15, 0
    s_and_b32 s57, s57, 0xffff
    s_mov_b32 s58, 0x1c0000
    s_mov_b32 s59, 0x00020000
    v_lshlrev_b32 v13, 4, v0
    s_lshl_b32 s54, s45, 13
    s_add_u32 s55, s54, 4096
    s_nop 2
    buffer_store_dwordx4 v[24:27], v13, s[56:59], s54 offen
    buffer_store_dwordx4 v[28:31], v13, s[56:59], s55 offen
k4_end_82:
    s_endpgm
.globl k5_kernel
.p2align 8
.type k5_kernel,@function
k5_kernel:
    s_cmp_ge_u32 s2, 64
    s_cbranch_scc1 k5_end_84
    s_load_dwordx2 s[12:13], s[0:1], 88
    s_load_dwordx2 s[14:15], s[0:1], 104
    v_and_b32 v2, 7, v0
    v_lshrrev_b32 v3, 3, v0
    v_lshlrev_b32 v4, 13, v3
    v_lshl_add_u32 v4, v2, 4, v4
    s_lshl_b32 s40, s2, 7
    s_lshr_b32 s41, s2, 5
    s_and_b32 s42, s2, 31
    s_waitcnt lgkmcnt(0)
    s_add_u32 s16, s14, 0x4900000
    s_addc_u32 s17, s15, 0
    s_and_b32 s17, s17, 0xffff
    s_mov_b32 s18, 0x1c0000
    s_mov_b32 s19, 0x00020000
    s_add_u32 s20, s14, 0x4c00000
    s_addc_u32 s21, s15, 0
    s_and_b32 s21, s21, 0xffff
    s_mov_b32 s22, 0x2000
    s_mov_b32 s23, 0x00020000
    s_add_u32 s24, s14, 0x4000000
    s_addc_u32 s25, s15, 0
    s_and_b32 s25, s25, 0xffff
    s_mov_b32 s26, 0x400000
    s_mov_b32 s27, 0x00020000
    s_mov_b32 s28, s12
    s_and_b32 s29, s13, 0xffff
    s_mov_b32 s30, 0x400000
    s_mov_b32 s31, 0x00020000
    s_lshl_b32 s43, s41, 2
    v_mov_b32 v5, s43
    buffer_load_dword v6, v5, s[20:23], 0 offen
    buffer_load_dword v7, v5, s[20:23], 0 offen offset:8
    buffer_load_dwordx4 v[16:19], v4, s[16:19], s40 offen
    s_add_u32 s40, s40, 0x40000
    buffer_load_dwordx4 v[20:23], v4, s[16:19], s40 offen
    s_add_u32 s40, s40, 0x40000
    buffer_load_dwordx4 v[24:27], v4, s[16:19], s40 offen
    s_add_u32 s40, s40, 0x40000
    buffer_load_dwordx4 v[28:31], v4, s[16:19], s40 offen
    s_add_u32 s40, s40, 0x40000
    buffer_load_dwordx4 v[32:35], v4, s[16:19], s40 offen
    s_add_u32 s40, s40, 0x40000
    buffer_load_dwordx4 v[36:39], v4, s[16:19], s40 offen
    s_add_u32 s40, s40, 0x40000
    buffer_load_dwordx4 v[40:43], v4, s[16:19], s40 offen
    s_add_u32 s40, s40, 0x40000
    s_lshl_b32 s44, s42, 6
    v_lshl_add_u32 v8, v2, 3, s44
    s_lshl_b32 s45, s41, 11
    s_add_u32 s45, s45, 4096
    buffer_load_dwordx2 v[10:11], v8, s[20:23], s45 offen
    s_waitcnt vmcnt(8)
    v_and_b32 v6, 0x7ff, v6
    v_lshl_add_u32 v9, v6, 11, v8
    buffer_load_dwordx2 v[12:13], v9, s[24:27], 0 offen
    s_waitcnt vmcnt(2)
    v_pk_add_f32 v[16:17], v[16:17], v[20:21]
    v_pk_add_f32 v[18:19], v[18:19], v[22:23]
    v_pk_add_f32 v[16:17], v[16:17], v[24:25]
    v_pk_add_f32 v[18:19], v[18:19], v[26:27]
    v_pk_add_f32 v[16:17], v[16:17], v[28:29]
    v_pk_add_f32 v[18:19], v[18:19], v[30:31]
    v_pk_add_f32 v[16:17], v[16:17], v[32:33]
    v_pk_add_f32 v[18:19], v[18:19], v[34:35]
    v_pk_add_f32 v[16:17], v[16:17], v[36:37]
    v_pk_add_f32 v[18:19], v[18:19], v[38:39]
    v_pk_add_f32 v[16:17], v[16:17], v[40:41]
    v_pk_add_f32 v[18:19], v[18:19], v[42:43]
    s_nop 1
    v_add_f32_dpp v16, v16, v16 row_ror:8 row_mask:0xf bank_mask:0xf
    v_add_f32_dpp v17, v17, v17 row_ror:8 row_mask:0xf bank_mask:0xf
    v_add_f32_dpp v18, v18, v18 row_ror:8 row_mask:0xf bank_mask:0xf
    v_add_f32_dpp v19, v19, v19 row_ror:8 row_mask:0xf bank_mask:0xf
    v_mov_b32 v20, v16
    v_mov_b32 v21, v17
    v_mov_b32 v22, v18
    v_mov_b32 v23, v19
    s_nop 1
    v_permlane16_swap_b32 v16, v20
    v_permlane16_swap_b32 v17, v21
    v_permlane16_swap_b32 v18, v22
    v_permlane16_swap_b32 v19, v23
    s_nop 1
    v_add_f32 v16, v16, v20
    v_add_f32 v17, v17, v21
    v_add_f32 v18, v18, v22
    v_add_f32 v19, v19, v23
    v_mov_b32 v20, v16
    v_mov_b32 v21, v17
    v_mov_b32 v22, v18
    v_mov_b32 v23, v19
    s_nop 1
    v_permlane32_swap_b32 v16, v20
    v_permlane32_swap_b32 v17, v21
    v_permlane32_swap_b32 v18, v22
    v_permlane32_swap_b32 v19, v23
    s_nop 1
    v_add_f32 v16, v16, v20
    v_add_f32 v17, v17, v21
    v_add_f32 v18, v18, v22
    v_add_f32 v19, v19, v23
    v_lshrrev_b32 v14, 6, v0
    v_lshlrev_b32 v14, 7, v14
    v_lshl_add_u32 v14, v2, 4, v14
    ds_write_b128 v14, v[16:19]
    s_waitcnt lgkmcnt(0)
    s_barrier
    v_lshlrev_b32 v14, 4, v2
    ds_read_b128 v[16:19], v14 offset:0
    ds_read_b128 v[20:23], v14 offset:128
    ds_read_b128 v[24:27], v14 offset:256
    ds_read_b128 v[28:31], v14 offset:384
    s_waitcnt vmcnt(0) lgkmcnt(0)
    v_pk_add_f32 v[16:17], v[16:17], v[20:21]
    v_pk_add_f32 v[18:19], v[18:19], v[22:23]
    v_pk_add_f32 v[16:17], v[16:17], v[24:25]
    v_pk_add_f32 v[18:19], v[18:19], v[26:27]
    v_pk_add_f32 v[16:17], v[16:17], v[28:29]
    v_pk_add_f32 v[18:19], v[18:19], v[30:31]
    v_cvt_pk_bf16_f32 v20, v16, v17
    v_lshlrev_b32 v21, 16, v20
    v_and_b32 v22, 0xffff0000, v20
    v_mul_f32 v21, v21, v7
    v_mul_f32 v22, v22, v7
    v_cvt_pk_bf16_f32 v20, v21, v22
    v_lshlrev_b32 v21, 16, v20
    v_and_b32 v22, 0xffff0000, v20
    v_lshlrev_b32 v23, 16, v10
    v_and_b32 v24, 0xffff0000, v10
    v_add_f32 v21, v21, v23
    v_add_f32 v22, v22, v24
    v_cvt_pk_bf16_f32 v20, v21, v22
    v_lshlrev_b32 v21, 16, v20
    v_and_b32 v22, 0xffff0000, v20
    v_lshlrev_b32 v23, 16, v12
    v_and_b32 v24, 0xffff0000, v12
    v_add_f32 v21, v21, v23
    v_add_f32 v22, v22, v24
    v_cvt_pk_bf16_f32 v26, v21, v22
    v_cvt_pk_bf16_f32 v20, v18, v19
    v_lshlrev_b32 v21, 16, v20
    v_and_b32 v22, 0xffff0000, v20
    v_mul_f32 v21, v21, v7
    v_mul_f32 v22, v22, v7
    v_cvt_pk_bf16_f32 v20, v21, v22
    v_lshlrev_b32 v21, 16, v20
    v_and_b32 v22, 0xffff0000, v20
    v_lshlrev_b32 v23, 16, v11
    v_and_b32 v24, 0xffff0000, v11
    v_add_f32 v21, v21, v23
    v_add_f32 v22, v22, v24
    v_cvt_pk_bf16_f32 v20, v21, v22
    v_lshlrev_b32 v21, 16, v20
    v_and_b32 v22, 0xffff0000, v20
    v_lshlrev_b32 v23, 16, v13
    v_and_b32 v24, 0xffff0000, v13
    v_add_f32 v21, v21, v23
    v_add_f32 v22, v22, v24
    v_cvt_pk_bf16_f32 v27, v21, v22
    v_cmp_gt_u32 vcc, 8, v0
    s_and_saveexec_b64 s[46:47], vcc
    s_cbranch_execz k5_skip_85
    buffer_store_dwordx2 v[26:27], v9, s[28:31], 0 offen
k5_skip_85:
    s_mov_b64 exec, s[46:47]
k5_end_84:
    s_endpgm
.section .rodata,"a"
.p2align 6
.amdhsa_kernel k12_kernel
  .amdhsa_next_free_vgpr 512
  .amdhsa_next_free_sgpr 102
  .amdhsa_accum_offset 256
  .amdhsa_group_segment_fixed_size 0
  .amdhsa_kernarg_size 112
  .amdhsa_user_sgpr_count 2
  .amdhsa_user_sgpr_kernarg_segment_ptr 1
  .amdhsa_system_sgpr_workgroup_id_x 1
.end_amdhsa_kernel
.p2align 6
.amdhsa_kernel k3_kernel
  .amdhsa_next_free_vgpr 320
  .amdhsa_next_free_sgpr 102
  .amdhsa_accum_offset 128
  .amdhsa_group_segment_fixed_size 0
  .amdhsa_kernarg_size 112
  .amdhsa_user_sgpr_count 2
  .amdhsa_user_sgpr_kernarg_segment_ptr 1
  .amdhsa_system_sgpr_workgroup_id_x 1
.end_amdhsa_kernel
.p2align 6
.amdhsa_kernel k4_kernel
  .amdhsa_next_free_vgpr 256
  .amdhsa_next_free_sgpr 102
  .amdhsa_accum_offset 256
  .amdhsa_group_segment_fixed_size 0
  .amdhsa_kernarg_size 112
  .amdhsa_user_sgpr_count 2
  .amdhsa_user_sgpr_kernarg_segment_ptr 1
  .amdhsa_system_sgpr_workgroup_id_x 1
.end_amdhsa_kernel
.p2align 6
.amdhsa_kernel k5_kernel
  .amdhsa_next_free_vgpr 64
  .amdhsa_next_free_sgpr 102
  .amdhsa_accum_offset 64
  .amdhsa_group_segment_fixed_size 0
  .amdhsa_kernarg_size 112
  .amdhsa_user_sgpr_count 2
  .amdhsa_user_sgpr_kernarg_segment_ptr 1
  .amdhsa_system_sgpr_workgroup_id_x 1
.end_amdhsa_kernel
```

```asm
; @launch kernel=k12_kernel grid=(256,1,1) block=(256,1,1) lds=163840
; @launch kernel=k3_kernel grid=(256,1,1) block=(256,1,1) lds=65536
; @launch kernel=k4_kernel grid=(256,1,1) block=(512,1,1) lds=86272
; @launch kernel=k5_kernel grid=(64,1,1) block=(256,1,1) lds=512
.amdgcn_target "amdgcn-amd-amdhsa--gfx950"
.text
.globl k12_kernel
.p2align 8
.type k12_kernel,@function
k12_kernel:
    s_cmp_ge_u32 s2, 256
    s_cbranch_scc1 k12_end_1
    s_load_dwordx4 s[36:39], s[0:1], 0
    s_load_dwordx4 s[40:43], s[0:1], 24
    s_load_dwordx2 s[4:5], s[0:1], 16
    s_load_dwordx4 s[60:63], s[0:1], 96
    s_lshr_b32 s59, s2, 3
    s_lshl_b32 s58, s59, 4
    v_add_u32 v6, s58, v0
    v_cmp_gt_u32 vcc, 48, v0
    v_cmp_gt_u32 s[56:57], 64, v0
    s_nop 0
    v_cndmask_b32 v6, v6, v0, vcc
    s_getpc_b64 s[52:53]
pc_2:
    s_add_u32 s52, s52, k12_code0-pc_2
    s_addc_u32 s53, s53, 0
    v_lshlrev_b32 v58, 7, v6
    v_mov_b32 v59, s53
    v_add_co_u32 v58, vcc, s52, v58
    s_nop 1
    v_addc_co_u32 v59, vcc, 0, v59, vcc
k12_code0:
    s_mov_b64 exec, s[56:57]
    s_cbranch_execz k12_nocode_3
    global_load_dword v51, v[58:59], off
k12_nocode_3:
    s_mov_b64 exec, -1
    s_and_b32 s58, s2, 7
    s_lshr_b32 s59, s2, 3
    s_and_b32 s45, s59, 7
    s_lshr_b32 s57, s59, 3
    s_and_b32 s44, s57, 1
    s_lshl_b32 s52, s58, 1
    s_add_u32 s44, s44, s52
    s_lshr_b32 s57, s57, 1
    v_lshrrev_b32 v2, 6, v0
    v_and_b32 v3, 63, v0
    v_readfirstlane_b32 s30, v2
    v_lshlrev_b32 v1, 4, v3
    v_lshrrev_b32 v60, 5, v3
    v_lshl_add_u32 v60, v2, 1, v60
    v_and_b32 v61, 31, v3
    v_lshlrev_b32 v6, 11, v60
    v_lshl_add_u32 v62, v61, 4, v6
    s_lshl_b32 s52, s2, 14
    v_lshrrev_b32 v56, 3, v3
    v_and_b32 v57, 7, v3
    v_lshrrev_b32 v58, 1, v56
    v_xor_b32 v6, v57, v58
    v_xor_b32 v7, 4, v6
    v_lshl_add_u32 v58, v2, 6, v56
    v_lshlrev_b32 v58, 10, v58
    s_lshl_b32 s47, s45, 18
    v_add_u32 v58, s47, v58
    v_lshl_add_u32 v10, v6, 4, v58
    v_lshl_add_u32 v11, v7, 4, v58
    v_add_u32 v17, 54272, v11
    v_add_u32 v16, 47104, v10
    v_add_u32 v15, 39936, v11
    v_add_u32 v14, 32768, v10
    v_add_u32 v13, 21504, v11
    v_add_u32 v12, 14336, v10
    v_add_u32 v11, 7168, v11
    v_add_u32 v10, 0, v10
    v_lshrrev_b32 v6, 5, v3
    v_bfe_u32 v7, v3, 1, 4
    v_and_b32 v59, 1, v3
    v_lshl_add_u32 v58, v2, 4, v6
    v_lshlrev_b32 v58, 13, v58
    v_lshl_add_u32 v58, v59, 4, v58
    s_lshl_b32 s47, s44, 9
    v_add_u32 v58, s47, v58
    v_xor_b32 v7, v7, v6
    v_xor_b32 v6, 0, v7
    v_lshl_add_u32 v6, v6, 5, v58
    v_add_u32 v18, 0, v6
    v_xor_b32 v6, 2, v7
    v_lshl_add_u32 v6, v6, 5, v58
    v_add_u32 v19, 15360, v6
    v_xor_b32 v6, 0, v7
    v_lshl_add_u32 v6, v6, 5, v58
    v_add_u32 v20, 30720, v6
    v_xor_b32 v6, 2, v7
    v_lshl_add_u32 v6, v6, 5, v58
    v_add_u32 v21, 46080, v6
    v_xor_b32 v6, 4, v7
    v_lshl_add_u32 v6, v6, 5, v58
    v_add_u32 v22, 65536, v6
    v_xor_b32 v6, 6, v7
    v_lshl_add_u32 v6, v6, 5, v58
    v_add_u32 v23, 80896, v6
    v_xor_b32 v6, 4, v7
    v_lshl_add_u32 v6, v6, 5, v58
    v_add_u32 v24, 96256, v6
    v_xor_b32 v6, 6, v7
    v_lshl_add_u32 v6, v6, 5, v58
    v_add_u32 v25, 111616, v6
    s_lshl_b32 s48, s30, 13
    s_mov_b32 s49, 0
    s_mov_b32 s50, 0
    s_waitcnt lgkmcnt(0)
    s_mov_b32 s24, s36
    s_and_b32 s25, s37, 0xffff
    s_mov_b32 s26, 0x400000
    s_mov_b32 s27, 0x00020000
    buffer_load_dwordx4 v[64:67], v62, s[24:27], s52 offen offset:0
    buffer_load_dwordx4 v[68:71], v62, s[24:27], s52 offen offset:512
    buffer_load_dwordx4 v[72:75], v62, s[24:27], s52 offen offset:1024
    buffer_load_dwordx4 v[76:79], v62, s[24:27], s52 offen offset:1536
    s_mov_b32 s16, s38
    s_and_b32 s17, s39, 0xffff
    s_mov_b32 s18, 0x200000
    s_mov_b32 s19, 0x00020000
    s_cmp_eq_u32 s57, 0
    s_cselect_b32 s20, s40, s42
    s_cselect_b32 s21, s41, s43
    s_and_b32 s21, s21, 0xffff
    s_mov_b32 s22, 0x400000
    s_mov_b32 s23, 0x00020000
    s_add_u32 m0, s48, 0
    s_nop 0
    buffer_load_dwordx4 v10, s[16:19], s49 offen offset:0 lds
    buffer_load_dwordx4 v11, s[16:19], s49 offen offset:1024 lds
    buffer_load_dwordx4 v12, s[16:19], s49 offen offset:2048 lds
    buffer_load_dwordx4 v13, s[16:19], s49 offen offset:3072 lds
    s_add_u32 m0, s48, 4096
    s_nop 0
    buffer_load_dwordx4 v14, s[16:19], s49 offen offset:0 lds
    buffer_load_dwordx4 v15, s[16:19], s49 offen offset:1024 lds
    buffer_load_dwordx4 v16, s[16:19], s49 offen offset:2048 lds
    buffer_load_dwordx4 v17, s[16:19], s49 offen offset:3072 lds
    s_add_u32 s49, s49, 128
    s_add_u32 m0, s48, 65536
    s_nop 0
    buffer_load_dwordx4 v18, s[20:23], s50 offen offset:0 lds
    buffer_load_dwordx4 v19, s[20:23], s50 offen offset:1024 lds
    buffer_load_dwordx4 v20, s[20:23], s50 offen offset:2048 lds
    buffer_load_dwordx4 v21, s[20:23], s50 offen offset:3072 lds
    s_add_u32 m0, s48, 69632
    s_nop 0
    buffer_load_dwordx4 v22, s[20:23], s50 offen offset:0 lds
    buffer_load_dwordx4 v23, s[20:23], s50 offen offset:1024 lds
    buffer_load_dwordx4 v24, s[20:23], s50 offen offset:2048 lds
    buffer_load_dwordx4 v25, s[20:23], s50 offen offset:3072 lds
    s_add_u32 s50, s50, 0x80000
    s_mov_b64 s[6:7], s[62:63]
    s_add_u32 s8, s6, 0x0
    s_addc_u32 s9, s7, 0
    s_and_b32 s9, s9, 0xffff
    s_mov_b32 s10, 0x400000
    s_mov_b32 s11, 0x00020000
    s_mov_b32 s12, s4
    s_and_b32 s13, s5, 0xffff
    s_mov_b32 s14, 0x800000
    s_mov_b32 s15, 0x00020000
    s_add_u32 s32, s6, 0x1000000
    s_addc_u32 s33, s7, 0
    s_and_b32 s33, s33, 0xffff
    s_mov_b32 s34, 0x2000000
    s_mov_b32 s35, 0x00020000
    s_mov_b32 s24, s60
    s_and_b32 s25, s61, 0xffff
    s_mov_b32 s26, 0x100
    s_mov_b32 s27, 0x00020000
    s_lshl_b32 s28, s58, 2
    s_and_b32 s31, s59, 3
    s_add_u32 s28, s28, s31
    s_lshr_b32 s29, s59, 2
    s_lshl_b32 s42, s29, 7
    s_sub_u32 s43, 1920, s42
    s_lshl_b32 s31, s30, 5
    s_add_u32 s38, s42, s31
    s_add_u32 s39, s43, s31
    s_lshl_b32 s60, s30, 12
    s_mov_b32 s61, 0
    s_mov_b32 s62, 0
    s_lshl_b32 s47, s44, 1
    s_lshr_b32 s52, s30, 1
    s_add_u32 s47, s47, s52
    s_lshl_b32 s47, s47, 14
    s_lshl_b32 s52, s45, 1
    s_and_b32 s53, s30, 1
    s_add_u32 s52, s52, s53
    s_lshl_b32 s52, s52, 20
    s_add_u32 s47, s47, s52
    s_lshl_b32 s52, s57, 24
    s_add_u32 s47, s47, s52
    s_lshl_b32 s54, s44, 8
    s_lshr_b32 s55, s28, 1
    s_lshl_b32 s55, s55, 8
    s_and_b32 s53, s59, 3
    s_add_u32 s53, s53, 1
    s_cmp_eq_u32 s30, 0
    s_cselect_b32 s53, s53, -1
    s_cselect_b32 s46, 6, -1
    v_lshlrev_b32 v6, 13, v56
    v_lshl_add_u32 v50, v57, 7, v6
    s_lshl_b32 s56, s30, 5
    s_add_u32 s56, s56, s59
    s_lshl_b32 s56, s56, 16
    s_lshl_b32 s52, s58, 10
    s_add_u32 s56, s56, s52
    s_lshl_b32 s63, s30, 1
    v_mul_u32_u24 v6, 2064, v60
    v_lshl_add_u32 v6, v61, 4, v6
    v_add_u32 v54, 131072, v6
    v_mul_u32_u24 v7, 2064, v57
    v_lshl_add_u32 v7, v56, 4, v7
    v_lshl_add_u32 v7, v2, 9, v7
    v_add_u32 v55, 131072, v7
    v_lshrrev_b32 v7, 2, v56
    v_lshl_add_u32 v7, v2, 3, v7
    v_lshlrev_b32 v7, 17, v7
    v_and_b32 v6, 3, v56
    v_lshl_add_u32 v7, v6, 8, v7
    v_lshl_add_u32 v7, v57, 4, v7
    s_lshr_b32 s52, s2, 1
    s_lshl_b32 s52, s52, 10
    s_and_b32 s31, s2, 1
    s_lshl_b32 s31, s31, 7
    s_add_u32 s52, s52, s31
    v_add_u32 v53, s52, v7
    v_and_b32 v56, 15, v3
    v_lshrrev_b32 v57, 4, v3
    v_lshrrev_b32 v6, 1, v56
    v_xor_b32 v6, v6, v57
    v_and_b32 v7, 1, v2
    v_lshl_add_u32 v7, v7, 7, v56
    v_lshlrev_b32 v7, 7, v7
    v_lshl_add_u32 v26, v6, 4, v7
    v_xor_b32 v27, 64, v26
    v_lshrrev_b32 v6, 2, v56
    v_and_b32 v58, 1, v57
    v_lshl_add_u32 v58, v58, 2, v6
    v_lshl_add_u32 v59, v57, 3, v6
    v_and_b32 v63, 3, v3
    v_lshlrev_b32 v7, 9, v59
    v_lshrrev_b32 v6, 1, v2
    v_lshl_add_u32 v7, v6, 8, v7
    v_lshl_add_u32 v7, v63, 3, v7
    v_add_u32 v7, 65536, v7
    v_lshlrev_b32 v59, 8, v59
    v_lshl_add_u32 v59, v63, 3, v59
    v_add_u32 v59, 98304, v59
    v_xor_b32 v6, 0, v58
    v_lshl_add_u32 v28, v6, 5, v7
    v_lshl_add_u32 v42, v6, 5, v59
    v_xor_b32 v6, 1, v58
    v_lshl_add_u32 v29, v6, 5, v7
    v_lshl_add_u32 v43, v6, 5, v59
    v_xor_b32 v6, 2, v58
    v_lshl_add_u32 v30, v6, 5, v7
    v_lshl_add_u32 v44, v6, 5, v59
    v_xor_b32 v6, 3, v58
    v_lshl_add_u32 v31, v6, 5, v7
    v_lshl_add_u32 v45, v6, 5, v59
    v_xor_b32 v6, 4, v58
    v_lshl_add_u32 v32, v6, 5, v7
    v_lshl_add_u32 v46, v6, 5, v59
    v_xor_b32 v6, 5, v58
    v_lshl_add_u32 v33, v6, 5, v7
    v_lshl_add_u32 v47, v6, 5, v59
    v_xor_b32 v6, 6, v58
    v_lshl_add_u32 v34, v6, 5, v7
    v_lshl_add_u32 v48, v6, 5, v59
    v_xor_b32 v6, 7, v58
    v_lshl_add_u32 v35, v6, 5, v7
    v_lshl_add_u32 v49, v6, 5, v59
    s_lshl_b32 s31, s38, 6
    v_add_u32 v36, s31, v1
    s_lshl_b32 s31, s39, 6
    v_add_u32 v37, s31, v1
    v_bfe_u32 v6, v3, 1, 3
    v_and_b32 v7, 1, v3
    v_lshl_add_u32 v58, v2, 4, v57
    v_lshlrev_b32 v58, 13, v58
    v_lshl_add_u32 v58, v7, 4, v58
    s_lshl_b32 s31, s28, 8
    v_add_u32 v58, s31, v58
    v_xor_b32 v6, v6, v57
    v_xor_b32 v7, 0, v6
    v_lshl_add_u32 v7, v7, 5, v58
    v_add_u32 v38, 0, v7
    v_xor_b32 v7, 0, v6
    v_lshl_add_u32 v7, v7, 5, v58
    v_add_u32 v39, 31744, v7
    v_xor_b32 v7, 4, v6
    v_lshl_add_u32 v7, v7, 5, v58
    v_add_u32 v40, 63488, v7
    v_xor_b32 v7, 4, v6
    v_lshl_add_u32 v7, v7, 5, v58
    v_add_u32 v41, 95232, v7
    v_lshlrev_b32 v6, 2, v57
    v_sub_u32 v4, v56, v6
    v_mov_b32 v5, 0xff800000
    v_mov_b32 v8, 0
    v_mov_b32 v9, 1
    v_mov_b32 v56, 0
    v_mov_b32 v57, 0
    v_mov_b32 v58, 0
    v_mov_b32 v59, 0
    s_nop 1
    v_mfma_f32_32x32x16_bf16 a[128:143], v[56:59], v[56:59], 0
    v_mfma_f32_32x32x16_bf16 a[144:159], v[56:59], v[56:59], 0
    v_mfma_f32_32x32x16_bf16 a[160:175], v[56:59], v[56:59], 0
    v_mfma_f32_32x32x16_bf16 a[176:191], v[56:59], v[56:59], 0
    v_mfma_f32_32x32x16_bf16 v[128:143], v[56:59], v[56:59], 0
    v_mfma_f32_32x32x16_bf16 v[144:159], v[56:59], v[56:59], 0
    v_mfma_f32_32x32x16_bf16 v[160:175], v[56:59], v[56:59], 0
    v_mfma_f32_32x32x16_bf16 v[176:191], v[56:59], v[56:59], 0
    v_mfma_f32_32x32x16_bf16 v[192:207], v[56:59], v[56:59], 0
    v_mfma_f32_32x32x16_bf16 v[208:223], v[56:59], v[56:59], 0
    v_mfma_f32_32x32x16_bf16 v[224:239], v[56:59], v[56:59], 0
    v_mfma_f32_32x32x16_bf16 v[240:255], v[56:59], v[56:59], 0
    s_waitcnt vmcnt(16)
    v_lshlrev_b32 v80, 16, v64
    v_and_b32 v81, 0xffff0000, v64
    v_lshlrev_b32 v82, 16, v65
    v_and_b32 v83, 0xffff0000, v65
    v_lshlrev_b32 v84, 16, v66
    v_and_b32 v85, 0xffff0000, v66
    v_lshlrev_b32 v86, 16, v67
    v_and_b32 v87, 0xffff0000, v67
    v_lshlrev_b32 v88, 16, v68
    v_and_b32 v89, 0xffff0000, v68
    v_lshlrev_b32 v90, 16, v69
    v_and_b32 v91, 0xffff0000, v69
    v_lshlrev_b32 v92, 16, v70
    v_and_b32 v93, 0xffff0000, v70
    v_lshlrev_b32 v94, 16, v71
    v_and_b32 v95, 0xffff0000, v71
    v_lshlrev_b32 v96, 16, v72
    v_and_b32 v97, 0xffff0000, v72
    v_lshlrev_b32 v98, 16, v73
    v_and_b32 v99, 0xffff0000, v73
    v_lshlrev_b32 v100, 16, v74
    v_and_b32 v101, 0xffff0000, v74
    v_lshlrev_b32 v102, 16, v75
    v_and_b32 v103, 0xffff0000, v75
    v_lshlrev_b32 v104, 16, v76
    v_and_b32 v105, 0xffff0000, v76
    v_lshlrev_b32 v106, 16, v77
    v_and_b32 v107, 0xffff0000, v77
    v_lshlrev_b32 v108, 16, v78
    v_and_b32 v109, 0xffff0000, v78
    v_lshlrev_b32 v110, 16, v79
    v_and_b32 v111, 0xffff0000, v79
    v_pk_add_f32 v[112:113], v[80:81], v[82:83]
    v_pk_add_f32 v[114:115], v[84:85], v[86:87]
    v_pk_add_f32 v[112:113], v[112:113], v[88:89]
    v_pk_add_f32 v[114:115], v[114:115], v[90:91]
    v_pk_add_f32 v[112:113], v[112:113], v[92:93]
    v_pk_add_f32 v[114:115], v[114:115], v[94:95]
    v_pk_add_f32 v[112:113], v[112:113], v[96:97]
    v_pk_add_f32 v[114:115], v[114:115], v[98:99]
    v_pk_add_f32 v[112:113], v[112:113], v[100:101]
    v_pk_add_f32 v[114:115], v[114:115], v[102:103]
    v_pk_add_f32 v[112:113], v[112:113], v[104:105]
    v_pk_add_f32 v[114:115], v[114:115], v[106:107]
    v_pk_add_f32 v[112:113], v[112:113], v[108:109]
    v_pk_add_f32 v[114:115], v[114:115], v[110:111]
    v_pk_add_f32 v[112:113], v[112:113], v[114:115]
    v_add_f32 v112, v112, v113
    s_nop 1
    v_add_f32_dpp v112, v112, v112 quad_perm:[1,0,3,2] row_mask:0xf bank_mask:0xf
    s_nop 1
    v_add_f32_dpp v112, v112, v112 quad_perm:[2,3,0,1] row_mask:0xf bank_mask:0xf
    s_nop 1
    v_add_f32_dpp v112, v112, v112 row_half_mirror row_mask:0xf bank_mask:0xf
    s_nop 1
    v_add_f32_dpp v112, v112, v112 row_mirror row_mask:0xf bank_mask:0xf
    v_mov_b32 v114, v112
    s_nop 1
    v_permlane16_swap_b32 v112, v114
    s_nop 1
    v_add_f32 v112, v112, v114
    v_mul_f32 v112, 0xba800000, v112
    v_mov_b32 v113, v112
    v_pk_add_f32 v[114:115], v[80:81], v[112:113]
    v_pk_add_f32 v[118:119], v[82:83], v[112:113]
    v_pk_mul_f32 v[116:117], v[114:115], v[114:115]
    v_pk_fma_f32 v[116:117], v[118:119], v[118:119], v[116:117]
    v_pk_add_f32 v[114:115], v[84:85], v[112:113]
    v_pk_add_f32 v[118:119], v[86:87], v[112:113]
    v_pk_fma_f32 v[116:117], v[114:115], v[114:115], v[116:117]
    v_pk_fma_f32 v[116:117], v[118:119], v[118:119], v[116:117]
    v_pk_add_f32 v[114:115], v[88:89], v[112:113]
    v_pk_add_f32 v[118:119], v[90:91], v[112:113]
    v_pk_fma_f32 v[116:117], v[114:115], v[114:115], v[116:117]
    v_pk_fma_f32 v[116:117], v[118:119], v[118:119], v[116:117]
    v_pk_add_f32 v[114:115], v[92:93], v[112:113]
    v_pk_add_f32 v[118:119], v[94:95], v[112:113]
    v_pk_fma_f32 v[116:117], v[114:115], v[114:115], v[116:117]
    v_pk_fma_f32 v[116:117], v[118:119], v[118:119], v[116:117]
    v_pk_add_f32 v[114:115], v[96:97], v[112:113]
    v_pk_add_f32 v[118:119], v[98:99], v[112:113]
    v_pk_fma_f32 v[116:117], v[114:115], v[114:115], v[116:117]
    v_pk_fma_f32 v[116:117], v[118:119], v[118:119], v[116:117]
    v_pk_add_f32 v[114:115], v[100:101], v[112:113]
    v_pk_add_f32 v[118:119], v[102:103], v[112:113]
    v_pk_fma_f32 v[116:117], v[114:115], v[114:115], v[116:117]
    v_pk_fma_f32 v[116:117], v[118:119], v[118:119], v[116:117]
    v_pk_add_f32 v[114:115], v[104:105], v[112:113]
    v_pk_add_f32 v[118:119], v[106:107], v[112:113]
    v_pk_fma_f32 v[116:117], v[114:115], v[114:115], v[116:117]
    v_pk_fma_f32 v[116:117], v[118:119], v[118:119], v[116:117]
    v_pk_add_f32 v[114:115], v[108:109], v[112:113]
    v_pk_add_f32 v[118:119], v[110:111], v[112:113]
    v_pk_fma_f32 v[116:117], v[114:115], v[114:115], v[116:117]
    v_pk_fma_f32 v[116:117], v[118:119], v[118:119], v[116:117]
    v_add_f32 v116, v116, v117
    s_nop 1
    v_add_f32_dpp v116, v116, v116 quad_perm:[1,0,3,2] row_mask:0xf bank_mask:0xf
    s_nop 1
    v_add_f32_dpp v116, v116, v116 quad_perm:[2,3,0,1] row_mask:0xf bank_mask:0xf
    s_nop 1
    v_add_f32_dpp v116, v116, v116 row_half_mirror row_mask:0xf bank_mask:0xf
    s_nop 1
    v_add_f32_dpp v116, v116, v116 row_mirror row_mask:0xf bank_mask:0xf
    v_mov_b32 v114, v116
    s_nop 1
    v_permlane16_swap_b32 v116, v114
    s_nop 1
    v_add_f32 v116, v116, v114
    v_mul_f32 v116, 0x3a800000, v116
    v_cvt_pk_bf16_f32 v118, v112, v116
    v_and_b32 v116, 0xffff0000, v118
    v_lshlrev_b32 v118, 16, v118
    v_add_f32 v116, 0x3727c5ac, v116
    v_mov_b32 v119, v118
    v_cvt_pk_bf16_f32 v116, v116, v116
    v_and_b32 v116, 0xffff0000, v116
    v_sqrt_f32 v116, v116
    v_pk_add_f32 v[80:81], v[80:81], v[118:119]
    v_pk_add_f32 v[82:83], v[82:83], v[118:119]
    v_pk_add_f32 v[84:85], v[84:85], v[118:119]
    v_pk_add_f32 v[86:87], v[86:87], v[118:119]
    v_pk_add_f32 v[88:89], v[88:89], v[118:119]
    v_pk_add_f32 v[90:91], v[90:91], v[118:119]
    v_pk_add_f32 v[92:93], v[92:93], v[118:119]
    v_pk_add_f32 v[94:95], v[94:95], v[118:119]
    v_pk_add_f32 v[96:97], v[96:97], v[118:119]
    v_pk_add_f32 v[98:99], v[98:99], v[118:119]
    v_pk_add_f32 v[100:101], v[100:101], v[118:119]
    v_pk_add_f32 v[102:103], v[102:103], v[118:119]
    v_pk_add_f32 v[104:105], v[104:105], v[118:119]
    v_pk_add_f32 v[106:107], v[106:107], v[118:119]
    v_pk_add_f32 v[108:109], v[108:109], v[118:119]
    v_pk_add_f32 v[110:111], v[110:111], v[118:119]
    v_cvt_pk_bf16_f32 v116, v116, v116
    v_and_b32 v116, 0xffff0000, v116
    v_rcp_f32 v116, v116
    v_cvt_pk_bf16_f32 v64, v80, v81
    v_cvt_pk_bf16_f32 v65, v82, v83
    v_cvt_pk_bf16_f32 v66, v84, v85
    v_cvt_pk_bf16_f32 v67, v86, v87
    v_cvt_pk_bf16_f32 v68, v88, v89
    v_cvt_pk_bf16_f32 v69, v90, v91
    v_cvt_pk_bf16_f32 v70, v92, v93
    v_cvt_pk_bf16_f32 v71, v94, v95
    v_cvt_pk_bf16_f32 v72, v96, v97
    v_cvt_pk_bf16_f32 v73, v98, v99
    v_cvt_pk_bf16_f32 v74, v100, v101
    v_cvt_pk_bf16_f32 v75, v102, v103
    v_cvt_pk_bf16_f32 v76, v104, v105
    v_cvt_pk_bf16_f32 v77, v106, v107
    v_cvt_pk_bf16_f32 v78, v108, v109
    v_cvt_pk_bf16_f32 v79, v110, v111
    v_mov_b32 v117, v116
    v_lshlrev_b32 v80, 16, v64
    v_and_b32 v81, 0xffff0000, v64
    v_lshlrev_b32 v82, 16, v65
    v_and_b32 v83, 0xffff0000, v65
    v_lshlrev_b32 v84, 16, v66
    v_and_b32 v85, 0xffff0000, v66
    v_lshlrev_b32 v86, 16, v67
    v_and_b32 v87, 0xffff0000, v67
    v_lshlrev_b32 v88, 16, v68
    v_and_b32 v89, 0xffff0000, v68
    v_lshlrev_b32 v90, 16, v69
    v_and_b32 v91, 0xffff0000, v69
    v_lshlrev_b32 v92, 16, v70
    v_and_b32 v93, 0xffff0000, v70
    v_lshlrev_b32 v94, 16, v71
    v_and_b32 v95, 0xffff0000, v71
    v_lshlrev_b32 v96, 16, v72
    v_and_b32 v97, 0xffff0000, v72
    v_lshlrev_b32 v98, 16, v73
    v_and_b32 v99, 0xffff0000, v73
    v_lshlrev_b32 v100, 16, v74
    v_and_b32 v101, 0xffff0000, v74
    v_lshlrev_b32 v102, 16, v75
    v_and_b32 v103, 0xffff0000, v75
    v_lshlrev_b32 v104, 16, v76
    v_and_b32 v105, 0xffff0000, v76
    v_lshlrev_b32 v106, 16, v77
    v_and_b32 v107, 0xffff0000, v77
    v_lshlrev_b32 v108, 16, v78
    v_and_b32 v109, 0xffff0000, v78
    v_lshlrev_b32 v110, 16, v79
    v_and_b32 v111, 0xffff0000, v79
    v_pk_mul_f32 v[80:81], v[80:81], v[116:117]
    v_pk_mul_f32 v[82:83], v[82:83], v[116:117]
    v_pk_mul_f32 v[84:85], v[84:85], v[116:117]
    v_pk_mul_f32 v[86:87], v[86:87], v[116:117]
    v_pk_mul_f32 v[88:89], v[88:89], v[116:117]
    v_pk_mul_f32 v[90:91], v[90:91], v[116:117]
    v_pk_mul_f32 v[92:93], v[92:93], v[116:117]
    v_pk_mul_f32 v[94:95], v[94:95], v[116:117]
    v_pk_mul_f32 v[96:97], v[96:97], v[116:117]
    v_pk_mul_f32 v[98:99], v[98:99], v[116:117]
    v_pk_mul_f32 v[100:101], v[100:101], v[116:117]
    v_pk_mul_f32 v[102:103], v[102:103], v[116:117]
    v_pk_mul_f32 v[104:105], v[104:105], v[116:117]
    v_pk_mul_f32 v[106:107], v[106:107], v[116:117]
    v_pk_mul_f32 v[108:109], v[108:109], v[116:117]
    v_pk_mul_f32 v[110:111], v[110:111], v[116:117]
    v_cvt_pk_bf16_f32 v64, v80, v81
    v_cvt_pk_bf16_f32 v65, v82, v83
    v_cvt_pk_bf16_f32 v66, v84, v85
    v_cvt_pk_bf16_f32 v67, v86, v87
    v_cvt_pk_bf16_f32 v68, v88, v89
    v_cvt_pk_bf16_f32 v69, v90, v91
    v_cvt_pk_bf16_f32 v70, v92, v93
    v_cvt_pk_bf16_f32 v71, v94, v95
    v_cvt_pk_bf16_f32 v72, v96, v97
    v_cvt_pk_bf16_f32 v73, v98, v99
    v_cvt_pk_bf16_f32 v74, v100, v101
    v_cvt_pk_bf16_f32 v75, v102, v103
    v_cvt_pk_bf16_f32 v76, v104, v105
    v_cvt_pk_bf16_f32 v77, v106, v107
    v_cvt_pk_bf16_f32 v78, v108, v109
    v_cvt_pk_bf16_f32 v79, v110, v111
    ds_write_b128 v54, v[64:67] offset:0
    ds_write_b128 v54, v[68:71] offset:512
    ds_write_b128 v54, v[72:75] offset:1024
    ds_write_b128 v54, v[76:79] offset:1536
    s_add_u32 m0, s48, 32768
    s_nop 0
    buffer_load_dwordx4 v10, s[16:19], s49 offen offset:0 lds
    buffer_load_dwordx4 v11, s[16:19], s49 offen offset:1024 lds
    buffer_load_dwordx4 v12, s[16:19], s49 offen offset:2048 lds
    buffer_load_dwordx4 v13, s[16:19], s49 offen offset:3072 lds
    s_add_u32 m0, s48, 36864
    s_nop 0
    buffer_load_dwordx4 v14, s[16:19], s49 offen offset:0 lds
    buffer_load_dwordx4 v15, s[16:19], s49 offen offset:1024 lds
    buffer_load_dwordx4 v16, s[16:19], s49 offen offset:2048 lds
    buffer_load_dwordx4 v17, s[16:19], s49 offen offset:3072 lds
    s_add_u32 s49, s49, 128
    s_add_u32 m0, s48, 98304
    s_nop 0
    buffer_load_dwordx4 v18, s[20:23], s50 offen offset:0 lds
    buffer_load_dwordx4 v19, s[20:23], s50 offen offset:1024 lds
    buffer_load_dwordx4 v20, s[20:23], s50 offen offset:2048 lds
    buffer_load_dwordx4 v21, s[20:23], s50 offen offset:3072 lds
    s_add_u32 m0, s48, 102400
    s_nop 0
    buffer_load_dwordx4 v22, s[20:23], s50 offen offset:0 lds
    buffer_load_dwordx4 v23, s[20:23], s50 offen offset:1024 lds
    buffer_load_dwordx4 v24, s[20:23], s50 offen offset:2048 lds
    buffer_load_dwordx4 v25, s[20:23], s50 offen offset:3072 lds
    s_add_u32 s50, s50, 0x80000
    s_waitcnt vmcnt(16) lgkmcnt(0)
    s_barrier
    ds_read_b128 a[192:195], v55 offset:0
    ds_read_b128 a[196:199], v55 offset:128
    ds_read_b128 a[200:203], v55 offset:256
    ds_read_b128 a[204:207], v55 offset:384
    v_mfma_f32_32x32x16_bf16 v[64:79], v[56:59], v[56:59], 0
    v_mfma_f32_32x32x16_bf16 v[80:95], v[56:59], v[56:59], 0
    v_mfma_f32_32x32x16_bf16 v[96:111], v[56:59], v[56:59], 0
    v_mfma_f32_32x32x16_bf16 v[112:127], v[56:59], v[56:59], 0
    s_cmp_ge_u32 s2, 15
    s_cbranch_scc1 k12_nostat_4
    s_lshl_b32 s52, s2, 12
    s_add_u32 s52, s52, 0x3800000
    s_mov_b32 s34, -1
    v_lshlrev_b32 v6, 4, v0
    buffer_store_dwordx4 v[56:59], v6, s[32:35], s52 offen sc1
    s_mov_b32 s34, 0x2000000
k12_nostat_4:
    ds_read_b128 a[0:3], v26 offset:0
    ds_read_b64_tr_b16 a[32:33], v28 offset:0
    ds_read_b64_tr_b16 a[34:35], v28 offset:2048
    ds_read_b128 a[4:7], v26 offset:2048
    ds_read_b64_tr_b16 a[36:37], v29 offset:0
    ds_read_b64_tr_b16 a[38:39], v29 offset:2048
    ds_read_b128 a[8:11], v26 offset:4096
    ds_read_b64_tr_b16 a[40:41], v30 offset:0
    ds_read_b64_tr_b16 a[42:43], v30 offset:2048
    ds_read_b128 a[12:15], v26 offset:6144
    ds_read_b64_tr_b16 a[44:45], v31 offset:0
    ds_read_b64_tr_b16 a[46:47], v31 offset:2048
    ds_read_b128 a[16:19], v26 offset:8192
    ds_read_b64_tr_b16 a[48:49], v32 offset:0
    ds_read_b64_tr_b16 a[50:51], v32 offset:2048
    ds_read_b128 a[20:23], v26 offset:10240
    ds_read_b64_tr_b16 a[52:53], v33 offset:0
    ds_read_b64_tr_b16 a[54:55], v33 offset:2048
    ds_read_b128 a[24:27], v26 offset:12288
    ds_read_b64_tr_b16 a[56:57], v34 offset:0
    ds_read_b64_tr_b16 a[58:59], v34 offset:2048
    ds_read_b128 a[28:31], v26 offset:14336
    ds_read_b64_tr_b16 a[60:61], v35 offset:0
    ds_read_b64_tr_b16 a[62:63], v35 offset:2048
    s_mov_b32 s51, 0
    s_waitcnt lgkmcnt(15)
    s_mov_b32 s52, 0
    buffer_store_dwordx4 a[192:195], v53, s[8:11], s52 offen sc1
    s_mov_b32 s52, 262144
    buffer_store_dwordx4 a[196:199], v53, s[8:11], s52 offen sc1
    s_mov_b32 s52, 524288
    buffer_store_dwordx4 a[200:203], v53, s[8:11], s52 offen sc1
    s_mov_b32 s52, 786432
    buffer_store_dwordx4 a[204:207], v53, s[8:11], s52 offen sc1
    s_waitcnt lgkmcnt(0)
    s_cmp_lg_u32 s57, 0
    s_cbranch_scc1 k12_v_5
k12_loop_7:
    v_mfma_f32_16x16x32_bf16 v[64:67], a[32:35], a[0:3], v[64:67]
    ds_read_b128 a[64:67], v27 offset:0
    v_mfma_f32_16x16x32_bf16 v[80:83], a[32:35], a[4:7], v[80:83]
    ds_read_b64_tr_b16 a[96:97], v28 offset:16384
    v_mfma_f32_16x16x32_bf16 v[96:99], a[32:35], a[8:11], v[96:99]
    v_mfma_f32_16x16x32_bf16 v[112:115], a[32:35], a[12:15], v[112:115]
    s_cmp_eq_u32 s51, s46
    s_cbranch_scc1 k12_ool_9
k12_oolret_10:
    v_mfma_f32_16x16x32_bf16 v[128:131], a[32:35], a[16:19], v[128:131]
    ds_read_b64_tr_b16 a[98:99], v28 offset:18432
    v_mfma_f32_16x16x32_bf16 v[144:147], a[32:35], a[20:23], v[144:147]
    ds_read_b128 a[68:71], v27 offset:2048
    v_mfma_f32_16x16x32_bf16 a[128:131], a[32:35], a[24:27], a[128:131]
    v_mfma_f32_16x16x32_bf16 a[160:163], a[32:35], a[28:31], a[160:163]
    ds_read_b64_tr_b16 a[100:101], v29 offset:16384
    v_mfma_f32_16x16x32_bf16 v[160:163], a[36:39], a[0:3], v[160:163]
    v_mfma_f32_16x16x32_bf16 v[176:179], a[36:39], a[4:7], v[176:179]
    ds_read_b64_tr_b16 a[102:103], v29 offset:18432
    v_mfma_f32_16x16x32_bf16 v[192:195], a[36:39], a[8:11], v[192:195]
    v_mfma_f32_16x16x32_bf16 v[208:211], a[36:39], a[12:15], v[208:211]
    ds_read_b128 a[72:75], v27 offset:4096
    v_mfma_f32_16x16x32_bf16 v[224:227], a[36:39], a[16:19], v[224:227]
    v_mfma_f32_16x16x32_bf16 v[240:243], a[36:39], a[20:23], v[240:243]
    v_mfma_f32_16x16x32_bf16 a[132:135], a[36:39], a[24:27], a[132:135]
    ds_read_b64_tr_b16 a[104:105], v30 offset:16384
    v_mfma_f32_16x16x32_bf16 a[164:167], a[36:39], a[28:31], a[164:167]
    v_mfma_f32_16x16x32_bf16 v[68:71], a[40:43], a[0:3], v[68:71]
    ds_read_b64_tr_b16 a[106:107], v30 offset:18432
    v_mfma_f32_16x16x32_bf16 v[84:87], a[40:43], a[4:7], v[84:87]
    v_mfma_f32_16x16x32_bf16 v[100:103], a[40:43], a[8:11], v[100:103]
    ds_read_b128 a[76:79], v27 offset:6144
    v_mfma_f32_16x16x32_bf16 v[116:119], a[40:43], a[12:15], v[116:119]
    v_mfma_f32_16x16x32_bf16 v[132:135], a[40:43], a[16:19], v[132:135]
    ds_read_b64_tr_b16 a[108:109], v31 offset:16384
    v_mfma_f32_16x16x32_bf16 v[148:151], a[40:43], a[20:23], v[148:151]
    v_mfma_f32_16x16x32_bf16 a[136:139], a[40:43], a[24:27], a[136:139]
    ds_read_b64_tr_b16 a[110:111], v31 offset:18432
    v_mfma_f32_16x16x32_bf16 a[168:171], a[40:43], a[28:31], a[168:171]
    v_mfma_f32_16x16x32_bf16 v[164:167], a[44:47], a[0:3], v[164:167]
    ds_read_b128 a[80:83], v27 offset:8192
    v_mfma_f32_16x16x32_bf16 v[180:183], a[44:47], a[4:7], v[180:183]
    v_mfma_f32_16x16x32_bf16 v[196:199], a[44:47], a[8:11], v[196:199]
    ds_read_b64_tr_b16 a[112:113], v32 offset:16384
    v_mfma_f32_16x16x32_bf16 v[212:215], a[44:47], a[12:15], v[212:215]
    v_mfma_f32_16x16x32_bf16 v[228:231], a[44:47], a[16:19], v[228:231]
    ds_read_b64_tr_b16 a[114:115], v32 offset:18432
    v_mfma_f32_16x16x32_bf16 v[244:247], a[44:47], a[20:23], v[244:247]
    v_mfma_f32_16x16x32_bf16 a[140:143], a[44:47], a[24:27], a[140:143]
    ds_read_b128 a[84:87], v27 offset:10240
    v_mfma_f32_16x16x32_bf16 a[172:175], a[44:47], a[28:31], a[172:175]
    v_mfma_f32_16x16x32_bf16 v[72:75], a[48:51], a[0:3], v[72:75]
    ds_read_b64_tr_b16 a[116:117], v33 offset:16384
    v_mfma_f32_16x16x32_bf16 v[88:91], a[48:51], a[4:7], v[88:91]
    v_mfma_f32_16x16x32_bf16 v[104:107], a[48:51], a[8:11], v[104:107]
    ds_read_b64_tr_b16 a[118:119], v33 offset:18432
    v_mfma_f32_16x16x32_bf16 v[120:123], a[48:51], a[12:15], v[120:123]
    v_mfma_f32_16x16x32_bf16 v[136:139], a[48:51], a[16:19], v[136:139]
    ds_read_b128 a[88:91], v27 offset:12288
    v_mfma_f32_16x16x32_bf16 v[152:155], a[48:51], a[20:23], v[152:155]
    v_mfma_f32_16x16x32_bf16 a[144:147], a[48:51], a[24:27], a[144:147]
    v_mfma_f32_16x16x32_bf16 a[176:179], a[48:51], a[28:31], a[176:179]
    ds_read_b64_tr_b16 a[120:121], v34 offset:16384
    v_mfma_f32_16x16x32_bf16 v[168:171], a[52:55], a[0:3], v[168:171]
    v_mfma_f32_16x16x32_bf16 v[184:187], a[52:55], a[4:7], v[184:187]
    ds_read_b64_tr_b16 a[122:123], v34 offset:18432
    v_mfma_f32_16x16x32_bf16 v[200:203], a[52:55], a[8:11], v[200:203]
    v_mfma_f32_16x16x32_bf16 v[216:219], a[52:55], a[12:15], v[216:219]
    ds_read_b128 a[92:95], v27 offset:14336
    v_mfma_f32_16x16x32_bf16 v[232:235], a[52:55], a[16:19], v[232:235]
    v_mfma_f32_16x16x32_bf16 v[248:251], a[52:55], a[20:23], v[248:251]
    ds_read_b64_tr_b16 a[124:125], v35 offset:16384
    v_mfma_f32_16x16x32_bf16 a[148:151], a[52:55], a[24:27], a[148:151]
    v_mfma_f32_16x16x32_bf16 a[180:183], a[52:55], a[28:31], a[180:183]
    ds_read_b64_tr_b16 a[126:127], v35 offset:18432
    v_mfma_f32_16x16x32_bf16 v[76:79], a[56:59], a[0:3], v[76:79]
    v_mfma_f32_16x16x32_bf16 v[92:95], a[56:59], a[4:7], v[92:95]
    v_mfma_f32_16x16x32_bf16 v[108:111], a[56:59], a[8:11], v[108:111]
    v_mfma_f32_16x16x32_bf16 v[124:127], a[56:59], a[12:15], v[124:127]
    v_mfma_f32_16x16x32_bf16 v[140:143], a[56:59], a[16:19], v[140:143]
    v_mfma_f32_16x16x32_bf16 v[156:159], a[56:59], a[20:23], v[156:159]
    v_mfma_f32_16x16x32_bf16 a[152:155], a[56:59], a[24:27], a[152:155]
    v_mfma_f32_16x16x32_bf16 a[184:187], a[56:59], a[28:31], a[184:187]
    v_mfma_f32_16x16x32_bf16 v[172:175], a[60:63], a[0:3], v[172:175]
    v_mfma_f32_16x16x32_bf16 v[188:191], a[60:63], a[4:7], v[188:191]
    v_mfma_f32_16x16x32_bf16 v[204:207], a[60:63], a[8:11], v[204:207]
    v_mfma_f32_16x16x32_bf16 v[220:223], a[60:63], a[12:15], v[220:223]
    v_mfma_f32_16x16x32_bf16 v[236:239], a[60:63], a[16:19], v[236:239]
    v_mfma_f32_16x16x32_bf16 v[252:255], a[60:63], a[20:23], v[252:255]
    v_mfma_f32_16x16x32_bf16 a[156:159], a[60:63], a[24:27], a[156:159]
    v_mfma_f32_16x16x32_bf16 a[188:191], a[60:63], a[28:31], a[188:191]
    s_waitcnt vmcnt(0) lgkmcnt(0)
    s_barrier
    v_mfma_f32_16x16x32_bf16 v[64:67], a[96:99], a[64:67], v[64:67]
    s_cmp_ge_u32 s49, 1024
    s_cselect_b32 s18, 0, s18
    s_cselect_b32 s22, 0, s22
    ds_read_b128 a[0:3], v26 offset:32768
    v_mfma_f32_16x16x32_bf16 v[80:83], a[96:99], a[68:71], v[80:83]
    s_add_u32 m0, s48, 0
    ds_read_b64_tr_b16 a[32:33], v28 offset:32768
    v_mfma_f32_16x16x32_bf16 v[96:99], a[96:99], a[72:75], v[96:99]
    buffer_load_dwordx4 v10, s[16:19], s49 offen offset:0 lds
    v_mfma_f32_16x16x32_bf16 v[112:115], a[96:99], a[76:79], v[112:115]
    ds_read_b64_tr_b16 a[34:35], v28 offset:34816
    v_mfma_f32_16x16x32_bf16 v[128:131], a[96:99], a[80:83], v[128:131]
    buffer_load_dwordx4 v11, s[16:19], s49 offen offset:1024 lds
    v_mfma_f32_16x16x32_bf16 v[144:147], a[96:99], a[84:87], v[144:147]
    ds_read_b128 a[4:7], v26 offset:34816
    v_mfma_f32_16x16x32_bf16 a[128:131], a[96:99], a[88:91], a[128:131]
    v_mfma_f32_16x16x32_bf16 a[160:163], a[96:99], a[92:95], a[160:163]
    ds_read_b64_tr_b16 a[36:37], v29 offset:32768
    v_mfma_f32_16x16x32_bf16 v[160:163], a[100:103], a[64:67], v[160:163]
    buffer_load_dwordx4 v12, s[16:19], s49 offen offset:2048 lds
    v_mfma_f32_16x16x32_bf16 v[176:179], a[100:103], a[68:71], v[176:179]
    ds_read_b64_tr_b16 a[38:39], v29 offset:34816
    v_mfma_f32_16x16x32_bf16 v[192:195], a[100:103], a[72:75], v[192:195]
    v_mfma_f32_16x16x32_bf16 v[208:211], a[100:103], a[76:79], v[208:211]
    buffer_load_dwordx4 v13, s[16:19], s49 offen offset:3072 lds
    ds_read_b128 a[8:11], v26 offset:36864
    v_mfma_f32_16x16x32_bf16 v[224:227], a[100:103], a[80:83], v[224:227]
    v_mfma_f32_16x16x32_bf16 v[240:243], a[100:103], a[84:87], v[240:243]
    s_add_u32 m0, s48, 4096
    v_mfma_f32_16x16x32_bf16 a[132:135], a[100:103], a[88:91], a[132:135]
    ds_read_b64_tr_b16 a[40:41], v30 offset:32768
    v_mfma_f32_16x16x32_bf16 a[164:167], a[100:103], a[92:95], a[164:167]
    buffer_load_dwordx4 v14, s[16:19], s49 offen offset:0 lds
    v_mfma_f32_16x16x32_bf16 v[68:71], a[104:107], a[64:67], v[68:71]
    ds_read_b64_tr_b16 a[42:43], v30 offset:34816
    v_mfma_f32_16x16x32_bf16 v[84:87], a[104:107], a[68:71], v[84:87]
    v_mfma_f32_16x16x32_bf16 v[100:103], a[104:107], a[72:75], v[100:103]
    buffer_load_dwordx4 v15, s[16:19], s49 offen offset:1024 lds
    ds_read_b128 a[12:15], v26 offset:38912
    v_mfma_f32_16x16x32_bf16 v[116:119], a[104:107], a[76:79], v[116:119]
    v_mfma_f32_16x16x32_bf16 v[132:135], a[104:107], a[80:83], v[132:135]
    ds_read_b64_tr_b16 a[44:45], v31 offset:32768
    v_mfma_f32_16x16x32_bf16 v[148:151], a[104:107], a[84:87], v[148:151]
    v_mfma_f32_16x16x32_bf16 a[136:139], a[104:107], a[88:91], a[136:139]
    buffer_load_dwordx4 v16, s[16:19], s49 offen offset:2048 lds
    ds_read_b64_tr_b16 a[46:47], v31 offset:34816
    v_mfma_f32_16x16x32_bf16 a[168:171], a[104:107], a[92:95], a[168:171]
    v_mfma_f32_16x16x32_bf16 v[164:167], a[108:111], a[64:67], v[164:167]
    ds_read_b128 a[16:19], v26 offset:40960
    v_mfma_f32_16x16x32_bf16 v[180:183], a[108:111], a[68:71], v[180:183]
    buffer_load_dwordx4 v17, s[16:19], s49 offen offset:3072 lds
    v_mfma_f32_16x16x32_bf16 v[196:199], a[108:111], a[72:75], v[196:199]
    ds_read_b64_tr_b16 a[48:49], v32 offset:32768
    v_mfma_f32_16x16x32_bf16 v[212:215], a[108:111], a[76:79], v[212:215]
    s_add_u32 s49, s49, 128
    v_mfma_f32_16x16x32_bf16 v[228:231], a[108:111], a[80:83], v[228:231]
    s_add_u32 m0, s48, 65536
    ds_read_b64_tr_b16 a[50:51], v32 offset:34816
    v_mfma_f32_16x16x32_bf16 v[244:247], a[108:111], a[84:87], v[244:247]
    buffer_load_dwordx4 v18, s[20:23], s50 offen offset:0 lds
    v_mfma_f32_16x16x32_bf16 a[140:143], a[108:111], a[88:91], a[140:143]
    ds_read_b128 a[20:23], v26 offset:43008
    v_mfma_f32_16x16x32_bf16 a[172:175], a[108:111], a[92:95], a[172:175]
    v_mfma_f32_16x16x32_bf16 v[72:75], a[112:115], a[64:67], v[72:75]
    buffer_load_dwordx4 v19, s[20:23], s50 offen offset:1024 lds
    ds_read_b64_tr_b16 a[52:53], v33 offset:32768
    v_mfma_f32_16x16x32_bf16 v[88:91], a[112:115], a[68:71], v[88:91]
    v_mfma_f32_16x16x32_bf16 v[104:107], a[112:115], a[72:75], v[104:107]
    ds_read_b64_tr_b16 a[54:55], v33 offset:34816
    v_mfma_f32_16x16x32_bf16 v[120:123], a[112:115], a[76:79], v[120:123]
    buffer_load_dwordx4 v20, s[20:23], s50 offen offset:2048 lds
    v_mfma_f32_16x16x32_bf16 v[136:139], a[112:115], a[80:83], v[136:139]
    ds_read_b128 a[24:27], v26 offset:45056
    v_mfma_f32_16x16x32_bf16 v[152:155], a[112:115], a[84:87], v[152:155]
    v_mfma_f32_16x16x32_bf16 a[144:147], a[112:115], a[88:91], a[144:147]
    v_mfma_f32_16x16x32_bf16 a[176:179], a[112:115], a[92:95], a[176:179]
    buffer_load_dwordx4 v21, s[20:23], s50 offen offset:3072 lds
    ds_read_b64_tr_b16 a[56:57], v34 offset:32768
    v_mfma_f32_16x16x32_bf16 v[168:171], a[116:119], a[64:67], v[168:171]
    s_add_u32 m0, s48, 69632
    v_mfma_f32_16x16x32_bf16 v[184:187], a[116:119], a[68:71], v[184:187]
    ds_read_b64_tr_b16 a[58:59], v34 offset:34816
    v_mfma_f32_16x16x32_bf16 v[200:203], a[116:119], a[72:75], v[200:203]
    buffer_load_dwordx4 v22, s[20:23], s50 offen offset:0 lds
    v_mfma_f32_16x16x32_bf16 v[216:219], a[116:119], a[76:79], v[216:219]
    ds_read_b128 a[28:31], v26 offset:47104
    v_mfma_f32_16x16x32_bf16 v[232:235], a[116:119], a[80:83], v[232:235]
    v_mfma_f32_16x16x32_bf16 v[248:251], a[116:119], a[84:87], v[248:251]
    ds_read_b64_tr_b16 a[60:61], v35 offset:32768
    v_mfma_f32_16x16x32_bf16 a[148:151], a[116:119], a[88:91], a[148:151]
    buffer_load_dwordx4 v23, s[20:23], s50 offen offset:1024 lds
    v_mfma_f32_16x16x32_bf16 a[180:183], a[116:119], a[92:95], a[180:183]
    ds_read_b64_tr_b16 a[62:63], v35 offset:34816
    v_mfma_f32_16x16x32_bf16 v[76:79], a[120:123], a[64:67], v[76:79]
    v_mfma_f32_16x16x32_bf16 v[92:95], a[120:123], a[68:71], v[92:95]
    buffer_load_dwordx4 v24, s[20:23], s50 offen offset:2048 lds
    v_mfma_f32_16x16x32_bf16 v[108:111], a[120:123], a[72:75], v[108:111]
    v_mfma_f32_16x16x32_bf16 v[124:127], a[120:123], a[76:79], v[124:127]
    v_mfma_f32_16x16x32_bf16 v[140:143], a[120:123], a[80:83], v[140:143]
    v_mfma_f32_16x16x32_bf16 v[156:159], a[120:123], a[84:87], v[156:159]
    buffer_load_dwordx4 v25, s[20:23], s50 offen offset:3072 lds
    v_mfma_f32_16x16x32_bf16 a[152:155], a[120:123], a[88:91], a[152:155]
    v_mfma_f32_16x16x32_bf16 a[184:187], a[120:123], a[92:95], a[184:187]
    s_add_u32 s50, s50, 0x80000
    v_mfma_f32_16x16x32_bf16 v[172:175], a[124:127], a[64:67], v[172:175]
    v_mfma_f32_16x16x32_bf16 v[188:191], a[124:127], a[68:71], v[188:191]
    s_cmp_eq_u32 s51, s53
    s_cbranch_scc1 k12_ool_11
k12_oolret_12:
    v_mfma_f32_16x16x32_bf16 v[204:207], a[124:127], a[72:75], v[204:207]
    v_mfma_f32_16x16x32_bf16 v[220:223], a[124:127], a[76:79], v[220:223]
    s_cmp_eq_u32 s51, s63
    s_cbranch_scc1 k12_ool_13
k12_oolret_14:
    v_mfma_f32_16x16x32_bf16 v[236:239], a[124:127], a[80:83], v[236:239]
    v_mfma_f32_16x16x32_bf16 v[252:255], a[124:127], a[84:87], v[252:255]
    s_add_u32 s51, s51, 1
    v_mfma_f32_16x16x32_bf16 a[156:159], a[124:127], a[88:91], a[156:159]
    v_mfma_f32_16x16x32_bf16 a[188:191], a[124:127], a[92:95], a[188:191]
    s_waitcnt lgkmcnt(0)
    v_mfma_f32_16x16x32_bf16 v[64:67], a[32:35], a[0:3], v[64:67]
    ds_read_b128 a[64:67], v27 offset:32768
    v_mfma_f32_16x16x32_bf16 v[80:83], a[32:35], a[4:7], v[80:83]
    ds_read_b64_tr_b16 a[96:97], v28 offset:49152
    v_mfma_f32_16x16x32_bf16 v[96:99], a[32:35], a[8:11], v[96:99]
    v_mfma_f32_16x16x32_bf16 v[112:115], a[32:35], a[12:15], v[112:115]
    ds_read_b64_tr_b16 a[98:99], v28 offset:51200
    v_mfma_f32_16x16x32_bf16 v[128:131], a[32:35], a[16:19], v[128:131]
    v_mfma_f32_16x16x32_bf16 v[144:147], a[32:35], a[20:23], v[144:147]
    ds_read_b128 a[68:71], v27 offset:34816
    v_mfma_f32_16x16x32_bf16 a[128:131], a[32:35], a[24:27], a[128:131]
    v_mfma_f32_16x16x32_bf16 a[160:163], a[32:35], a[28:31], a[160:163]
    ds_read_b64_tr_b16 a[100:101], v29 offset:49152
    v_mfma_f32_16x16x32_bf16 v[160:163], a[36:39], a[0:3], v[160:163]
    v_mfma_f32_16x16x32_bf16 v[176:179], a[36:39], a[4:7], v[176:179]
    ds_read_b64_tr_b16 a[102:103], v29 offset:51200
    v_mfma_f32_16x16x32_bf16 v[192:195], a[36:39], a[8:11], v[192:195]
    v_mfma_f32_16x16x32_bf16 v[208:211], a[36:39], a[12:15], v[208:211]
    ds_read_b128 a[72:75], v27 offset:36864
    v_mfma_f32_16x16x32_bf16 v[224:227], a[36:39], a[16:19], v[224:227]
    v_mfma_f32_16x16x32_bf16 v[240:243], a[36:39], a[20:23], v[240:243]
    v_mfma_f32_16x16x32_bf16 a[132:135], a[36:39], a[24:27], a[132:135]
    ds_read_b64_tr_b16 a[104:105], v30 offset:49152
    v_mfma_f32_16x16x32_bf16 a[164:167], a[36:39], a[28:31], a[164:167]
    v_mfma_f32_16x16x32_bf16 v[68:71], a[40:43], a[0:3], v[68:71]
    ds_read_b64_tr_b16 a[106:107], v30 offset:51200
    v_mfma_f32_16x16x32_bf16 v[84:87], a[40:43], a[4:7], v[84:87]
    v_mfma_f32_16x16x32_bf16 v[100:103], a[40:43], a[8:11], v[100:103]
    ds_read_b128 a[76:79], v27 offset:38912
    v_mfma_f32_16x16x32_bf16 v[116:119], a[40:43], a[12:15], v[116:119]
    v_mfma_f32_16x16x32_bf16 v[132:135], a[40:43], a[16:19], v[132:135]
    ds_read_b64_tr_b16 a[108:109], v31 offset:49152
    v_mfma_f32_16x16x32_bf16 v[148:151], a[40:43], a[20:23], v[148:151]
    v_mfma_f32_16x16x32_bf16 a[136:139], a[40:43], a[24:27], a[136:139]
    ds_read_b64_tr_b16 a[110:111], v31 offset:51200
    v_mfma_f32_16x16x32_bf16 a[168:171], a[40:43], a[28:31], a[168:171]
    v_mfma_f32_16x16x32_bf16 v[164:167], a[44:47], a[0:3], v[164:167]
    ds_read_b128 a[80:83], v27 offset:40960
    v_mfma_f32_16x16x32_bf16 v[180:183], a[44:47], a[4:7], v[180:183]
    v_mfma_f32_16x16x32_bf16 v[196:199], a[44:47], a[8:11], v[196:199]
    ds_read_b64_tr_b16 a[112:113], v32 offset:49152
    v_mfma_f32_16x16x32_bf16 v[212:215], a[44:47], a[12:15], v[212:215]
    v_mfma_f32_16x16x32_bf16 v[228:231], a[44:47], a[16:19], v[228:231]
    ds_read_b64_tr_b16 a[114:115], v32 offset:51200
    v_mfma_f32_16x16x32_bf16 v[244:247], a[44:47], a[20:23], v[244:247]
    v_mfma_f32_16x16x32_bf16 a[140:143], a[44:47], a[24:27], a[140:143]
    ds_read_b128 a[84:87], v27 offset:43008
    v_mfma_f32_16x16x32_bf16 a[172:175], a[44:47], a[28:31], a[172:175]
    v_mfma_f32_16x16x32_bf16 v[72:75], a[48:51], a[0:3], v[72:75]
    ds_read_b64_tr_b16 a[116:117], v33 offset:49152
    v_mfma_f32_16x16x32_bf16 v[88:91], a[48:51], a[4:7], v[88:91]
    v_mfma_f32_16x16x32_bf16 v[104:107], a[48:51], a[8:11], v[104:107]
    ds_read_b64_tr_b16 a[118:119], v33 offset:51200
    v_mfma_f32_16x16x32_bf16 v[120:123], a[48:51], a[12:15], v[120:123]
    v_mfma_f32_16x16x32_bf16 v[136:139], a[48:51], a[16:19], v[136:139]
    ds_read_b128 a[88:91], v27 offset:45056
    v_mfma_f32_16x16x32_bf16 v[152:155], a[48:51], a[20:23], v[152:155]
    v_mfma_f32_16x16x32_bf16 a[144:147], a[48:51], a[24:27], a[144:147]
    v_mfma_f32_16x16x32_bf16 a[176:179], a[48:51], a[28:31], a[176:179]
    ds_read_b64_tr_b16 a[120:121], v34 offset:49152
    v_mfma_f32_16x16x32_bf16 v[168:171], a[52:55], a[0:3], v[168:171]
    v_mfma_f32_16x16x32_bf16 v[184:187], a[52:55], a[4:7], v[184:187]
    ds_read_b64_tr_b16 a[122:123], v34 offset:51200
    v_mfma_f32_16x16x32_bf16 v[200:203], a[52:55], a[8:11], v[200:203]
    v_mfma_f32_16x16x32_bf16 v[216:219], a[52:55], a[12:15], v[216:219]
    ds_read_b128 a[92:95], v27 offset:47104
    v_mfma_f32_16x16x32_bf16 v[232:235], a[52:55], a[16:19], v[232:235]
    v_mfma_f32_16x16x32_bf16 v[248:251], a[52:55], a[20:23], v[248:251]
    ds_read_b64_tr_b16 a[124:125], v35 offset:49152
    v_mfma_f32_16x16x32_bf16 a[148:151], a[52:55], a[24:27], a[148:151]
    v_mfma_f32_16x16x32_bf16 a[180:183], a[52:55], a[28:31], a[180:183]
    ds_read_b64_tr_b16 a[126:127], v35 offset:51200
    v_mfma_f32_16x16x32_bf16 v[76:79], a[56:59], a[0:3], v[76:79]
    v_mfma_f32_16x16x32_bf16 v[92:95], a[56:59], a[4:7], v[92:95]
    v_mfma_f32_16x16x32_bf16 v[108:111], a[56:59], a[8:11], v[108:111]
    v_mfma_f32_16x16x32_bf16 v[124:127], a[56:59], a[12:15], v[124:127]
    v_mfma_f32_16x16x32_bf16 v[140:143], a[56:59], a[16:19], v[140:143]
    v_mfma_f32_16x16x32_bf16 v[156:159], a[56:59], a[20:23], v[156:159]
    v_mfma_f32_16x16x32_bf16 a[152:155], a[56:59], a[24:27], a[152:155]
    v_mfma_f32_16x16x32_bf16 a[184:187], a[56:59], a[28:31], a[184:187]
    s_sub_u32 s52, s51, 1
    s_cmp_eq_u32 s52, s46
    s_cbranch_scc1 k12_ool_17
k12_oolret_18:
    v_mfma_f32_16x16x32_bf16 v[172:175], a[60:63], a[0:3], v[172:175]
    v_mfma_f32_16x16x32_bf16 v[188:191], a[60:63], a[4:7], v[188:191]
    v_mfma_f32_16x16x32_bf16 v[204:207], a[60:63], a[8:11], v[204:207]
    v_mfma_f32_16x16x32_bf16 v[220:223], a[60:63], a[12:15], v[220:223]
    v_mfma_f32_16x16x32_bf16 v[236:239], a[60:63], a[16:19], v[236:239]
    v_mfma_f32_16x16x32_bf16 v[252:255], a[60:63], a[20:23], v[252:255]
    v_mfma_f32_16x16x32_bf16 a[156:159], a[60:63], a[24:27], a[156:159]
    v_mfma_f32_16x16x32_bf16 a[188:191], a[60:63], a[28:31], a[188:191]
    s_waitcnt vmcnt(0) lgkmcnt(0)
    s_barrier
    s_cmp_eq_u32 s51, 7
    s_cbranch_scc1 k12_last_8
    v_mfma_f32_16x16x32_bf16 v[64:67], a[96:99], a[64:67], v[64:67]
    ds_read_b128 a[0:3], v26 offset:0
    v_mfma_f32_16x16x32_bf16 v[80:83], a[96:99], a[68:71], v[80:83]
    s_add_u32 m0, s48, 32768
    ds_read_b64_tr_b16 a[32:33], v28 offset:0
    v_mfma_f32_16x16x32_bf16 v[96:99], a[96:99], a[72:75], v[96:99]
    buffer_load_dwordx4 v10, s[16:19], s49 offen offset:0 lds
    v_mfma_f32_16x16x32_bf16 v[112:115], a[96:99], a[76:79], v[112:115]
    ds_read_b64_tr_b16 a[34:35], v28 offset:2048
    v_mfma_f32_16x16x32_bf16 v[128:131], a[96:99], a[80:83], v[128:131]
    buffer_load_dwordx4 v11, s[16:19], s49 offen offset:1024 lds
    v_mfma_f32_16x16x32_bf16 v[144:147], a[96:99], a[84:87], v[144:147]
    ds_read_b128 a[4:7], v26 offset:2048
    v_mfma_f32_16x16x32_bf16 a[128:131], a[96:99], a[88:91], a[128:131]
    v_mfma_f32_16x16x32_bf16 a[160:163], a[96:99], a[92:95], a[160:163]
    ds_read_b64_tr_b16 a[36:37], v29 offset:0
    v_mfma_f32_16x16x32_bf16 v[160:163], a[100:103], a[64:67], v[160:163]
    buffer_load_dwordx4 v12, s[16:19], s49 offen offset:2048 lds
    v_mfma_f32_16x16x32_bf16 v[176:179], a[100:103], a[68:71], v[176:179]
    ds_read_b64_tr_b16 a[38:39], v29 offset:2048
    v_mfma_f32_16x16x32_bf16 v[192:195], a[100:103], a[72:75], v[192:195]
    v_mfma_f32_16x16x32_bf16 v[208:211], a[100:103], a[76:79], v[208:211]
    buffer_load_dwordx4 v13, s[16:19], s49 offen offset:3072 lds
    ds_read_b128 a[8:11], v26 offset:4096
    v_mfma_f32_16x16x32_bf16 v[224:227], a[100:103], a[80:83], v[224:227]
    v_mfma_f32_16x16x32_bf16 v[240:243], a[100:103], a[84:87], v[240:243]
    s_add_u32 m0, s48, 36864
    v_mfma_f32_16x16x32_bf16 a[132:135], a[100:103], a[88:91], a[132:135]
    ds_read_b64_tr_b16 a[40:41], v30 offset:0
    v_mfma_f32_16x16x32_bf16 a[164:167], a[100:103], a[92:95], a[164:167]
    buffer_load_dwordx4 v14, s[16:19], s49 offen offset:0 lds
    v_mfma_f32_16x16x32_bf16 v[68:71], a[104:107], a[64:67], v[68:71]
    ds_read_b64_tr_b16 a[42:43], v30 offset:2048
    v_mfma_f32_16x16x32_bf16 v[84:87], a[104:107], a[68:71], v[84:87]
    v_mfma_f32_16x16x32_bf16 v[100:103], a[104:107], a[72:75], v[100:103]
    buffer_load_dwordx4 v15, s[16:19], s49 offen offset:1024 lds
    ds_read_b128 a[12:15], v26 offset:6144
    v_mfma_f32_16x16x32_bf16 v[116:119], a[104:107], a[76:79], v[116:119]
    v_mfma_f32_16x16x32_bf16 v[132:135], a[104:107], a[80:83], v[132:135]
    ds_read_b64_tr_b16 a[44:45], v31 offset:0
    v_mfma_f32_16x16x32_bf16 v[148:151], a[104:107], a[84:87], v[148:151]
    v_mfma_f32_16x16x32_bf16 a[136:139], a[104:107], a[88:91], a[136:139]
    buffer_load_dwordx4 v16, s[16:19], s49 offen offset:2048 lds
    ds_read_b64_tr_b16 a[46:47], v31 offset:2048
    v_mfma_f32_16x16x32_bf16 a[168:171], a[104:107], a[92:95], a[168:171]
    v_mfma_f32_16x16x32_bf16 v[164:167], a[108:111], a[64:67], v[164:167]
    ds_read_b128 a[16:19], v26 offset:8192
    v_mfma_f32_16x16x32_bf16 v[180:183], a[108:111], a[68:71], v[180:183]
    buffer_load_dwordx4 v17, s[16:19], s49 offen offset:3072 lds
    v_mfma_f32_16x16x32_bf16 v[196:199], a[108:111], a[72:75], v[196:199]
    ds_read_b64_tr_b16 a[48:49], v32 offset:0
    v_mfma_f32_16x16x32_bf16 v[212:215], a[108:111], a[76:79], v[212:215]
    s_add_u32 s49, s49, 128
    v_mfma_f32_16x16x32_bf16 v[228:231], a[108:111], a[80:83], v[228:231]
    s_add_u32 m0, s48, 98304
    ds_read_b64_tr_b16 a[50:51], v32 offset:2048
    v_mfma_f32_16x16x32_bf16 v[244:247], a[108:111], a[84:87], v[244:247]
    buffer_load_dwordx4 v18, s[20:23], s50 offen offset:0 lds
    v_mfma_f32_16x16x32_bf16 a[140:143], a[108:111], a[88:91], a[140:143]
    ds_read_b128 a[20:23], v26 offset:10240
    v_mfma_f32_16x16x32_bf16 a[172:175], a[108:111], a[92:95], a[172:175]
    v_mfma_f32_16x16x32_bf16 v[72:75], a[112:115], a[64:67], v[72:75]
    buffer_load_dwordx4 v19, s[20:23], s50 offen offset:1024 lds
    ds_read_b64_tr_b16 a[52:53], v33 offset:0
    v_mfma_f32_16x16x32_bf16 v[88:91], a[112:115], a[68:71], v[88:91]
    v_mfma_f32_16x16x32_bf16 v[104:107], a[112:115], a[72:75], v[104:107]
    ds_read_b64_tr_b16 a[54:55], v33 offset:2048
    v_mfma_f32_16x16x32_bf16 v[120:123], a[112:115], a[76:79], v[120:123]
    buffer_load_dwordx4 v20, s[20:23], s50 offen offset:2048 lds
    v_mfma_f32_16x16x32_bf16 v[136:139], a[112:115], a[80:83], v[136:139]
    ds_read_b128 a[24:27], v26 offset:12288
    v_mfma_f32_16x16x32_bf16 v[152:155], a[112:115], a[84:87], v[152:155]
    v_mfma_f32_16x16x32_bf16 a[144:147], a[112:115], a[88:91], a[144:147]
    v_mfma_f32_16x16x32_bf16 a[176:179], a[112:115], a[92:95], a[176:179]
    buffer_load_dwordx4 v21, s[20:23], s50 offen offset:3072 lds
    ds_read_b64_tr_b16 a[56:57], v34 offset:0
    v_mfma_f32_16x16x32_bf16 v[168:171], a[116:119], a[64:67], v[168:171]
    s_add_u32 m0, s48, 102400
    v_mfma_f32_16x16x32_bf16 v[184:187], a[116:119], a[68:71], v[184:187]
    ds_read_b64_tr_b16 a[58:59], v34 offset:2048
    v_mfma_f32_16x16x32_bf16 v[200:203], a[116:119], a[72:75], v[200:203]
    buffer_load_dwordx4 v22, s[20:23], s50 offen offset:0 lds
    v_mfma_f32_16x16x32_bf16 v[216:219], a[116:119], a[76:79], v[216:219]
    ds_read_b128 a[28:31], v26 offset:14336
    v_mfma_f32_16x16x32_bf16 v[232:235], a[116:119], a[80:83], v[232:235]
    v_mfma_f32_16x16x32_bf16 v[248:251], a[116:119], a[84:87], v[248:251]
    ds_read_b64_tr_b16 a[60:61], v35 offset:0
    v_mfma_f32_16x16x32_bf16 a[148:151], a[116:119], a[88:91], a[148:151]
    buffer_load_dwordx4 v23, s[20:23], s50 offen offset:1024 lds
    v_mfma_f32_16x16x32_bf16 a[180:183], a[116:119], a[92:95], a[180:183]
    ds_read_b64_tr_b16 a[62:63], v35 offset:2048
    v_mfma_f32_16x16x32_bf16 v[76:79], a[120:123], a[64:67], v[76:79]
    v_mfma_f32_16x16x32_bf16 v[92:95], a[120:123], a[68:71], v[92:95]
    buffer_load_dwordx4 v24, s[20:23], s50 offen offset:2048 lds
    v_mfma_f32_16x16x32_bf16 v[108:111], a[120:123], a[72:75], v[108:111]
    v_mfma_f32_16x16x32_bf16 v[124:127], a[120:123], a[76:79], v[124:127]
    v_mfma_f32_16x16x32_bf16 v[140:143], a[120:123], a[80:83], v[140:143]
    v_mfma_f32_16x16x32_bf16 v[156:159], a[120:123], a[84:87], v[156:159]
    buffer_load_dwordx4 v25, s[20:23], s50 offen offset:3072 lds
    v_mfma_f32_16x16x32_bf16 a[152:155], a[120:123], a[88:91], a[152:155]
    v_mfma_f32_16x16x32_bf16 a[184:187], a[120:123], a[92:95], a[184:187]
    s_add_u32 s50, s50, 0x80000
    v_mfma_f32_16x16x32_bf16 v[172:175], a[124:127], a[64:67], v[172:175]
    v_mfma_f32_16x16x32_bf16 v[188:191], a[124:127], a[68:71], v[188:191]
    s_cmp_eq_u32 s51, s53
    s_cbranch_scc1 k12_ool_19
k12_oolret_20:
    v_mfma_f32_16x16x32_bf16 v[204:207], a[124:127], a[72:75], v[204:207]
    v_mfma_f32_16x16x32_bf16 v[220:223], a[124:127], a[76:79], v[220:223]
    v_mfma_f32_16x16x32_bf16 v[236:239], a[124:127], a[80:83], v[236:239]
    v_mfma_f32_16x16x32_bf16 v[252:255], a[124:127], a[84:87], v[252:255]
    s_add_u32 s51, s51, 1
    v_mfma_f32_16x16x32_bf16 a[156:159], a[124:127], a[88:91], a[156:159]
    v_mfma_f32_16x16x32_bf16 a[188:191], a[124:127], a[92:95], a[188:191]
    s_waitcnt lgkmcnt(0)
    s_branch k12_loop_7
k12_last_8:
    v_mfma_f32_16x16x32_bf16 v[64:67], a[96:99], a[64:67], v[64:67]
    s_add_u32 m0, s60, 98304
    v_mfma_f32_16x16x32_bf16 v[160:163], a[100:103], a[64:67], v[160:163]
    buffer_load_dwordx4 v38, s[12:15], s61 offen offset:0 lds
    v_mfma_f32_16x16x32_bf16 v[68:71], a[104:107], a[64:67], v[68:71]
    buffer_load_dwordx4 v39, s[12:15], s61 offen offset:1024 lds
    v_mfma_f32_16x16x32_bf16 v[164:167], a[108:111], a[64:67], v[164:167]
    v_mfma_f32_16x16x32_bf16 v[72:75], a[112:115], a[64:67], v[72:75]
    buffer_load_dwordx4 v40, s[12:15], s61 offen offset:2048 lds
    v_mfma_f32_16x16x32_bf16 v[168:171], a[116:119], a[64:67], v[168:171]
    v_cvt_pk_bf16_f32 v64, v64, v65
    v_cvt_pk_bf16_f32 v65, v66, v67
    v_cvt_pk_bf16_f32 v66, v160, v161
    v_mfma_f32_16x16x32_bf16 v[76:79], a[120:123], a[64:67], v[76:79]
    v_cvt_pk_bf16_f32 v67, v162, v163
    v_mfma_f32_16x16x32_bf16 v[172:175], a[124:127], a[64:67], v[172:175]
    v_cvt_pk_bf16_f32 v68, v68, v69
    v_cvt_pk_bf16_f32 v69, v70, v71
    v_cvt_pk_bf16_f32 v70, v164, v165
    v_mfma_f32_16x16x32_bf16 v[80:83], a[96:99], a[68:71], v[80:83]
    buffer_load_dwordx4 v41, s[12:15], s61 offen offset:3072 lds
    v_mfma_f32_16x16x32_bf16 v[176:179], a[100:103], a[68:71], v[176:179]
    s_add_u32 s61, s61, 0x80000
    v_cvt_pk_bf16_f32 v71, v166, v167
    v_cvt_pk_bf16_f32 v72, v72, v73
    v_cvt_pk_bf16_f32 v73, v74, v75
    v_mfma_f32_16x16x32_bf16 v[84:87], a[104:107], a[68:71], v[84:87]
    buffer_load_dwordx4 a[192:195], v36, s[8:11], s62 offen offset:0 sc1
    buffer_load_dwordx4 a[196:199], v36, s[8:11], s62 offen offset:1024 sc1
    v_mfma_f32_16x16x32_bf16 v[180:183], a[108:111], a[68:71], v[180:183]
    v_cvt_pk_bf16_f32 v74, v168, v169
    v_cvt_pk_bf16_f32 v75, v170, v171
    v_cvt_pk_bf16_f32 v76, v76, v77
    v_mfma_f32_16x16x32_bf16 v[88:91], a[112:115], a[68:71], v[88:91]
    v_cvt_pk_bf16_f32 v77, v78, v79
    v_cvt_pk_bf16_f32 v78, v172, v173
    v_cvt_pk_bf16_f32 v79, v174, v175
    v_mfma_f32_16x16x32_bf16 v[184:187], a[116:119], a[68:71], v[184:187]
    v_cvt_pk_bf16_f32 v80, v80, v81
    v_cvt_pk_bf16_f32 v81, v82, v83
    v_cvt_pk_bf16_f32 v82, v176, v177
    v_mfma_f32_16x16x32_bf16 v[92:95], a[120:123], a[68:71], v[92:95]
    buffer_load_dwordx4 a[200:203], v37, s[8:11], s62 offen offset:0 sc1
    buffer_load_dwordx4 a[204:207], v37, s[8:11], s62 offen offset:1024 sc1
    v_mfma_f32_16x16x32_bf16 v[188:191], a[124:127], a[68:71], v[188:191]
    s_add_u32 s62, s62, 0x20000
    v_cvt_pk_bf16_f32 v83, v178, v179
    v_cvt_pk_bf16_f32 v84, v84, v85
    v_cvt_pk_bf16_f32 v85, v86, v87
    v_mfma_f32_16x16x32_bf16 a[128:131], a[96:99], a[88:91], a[128:131]
    v_cvt_pk_bf16_f32 v86, v180, v181
    v_cvt_pk_bf16_f32 v87, v182, v183
    v_mfma_f32_16x16x32_bf16 a[132:135], a[100:103], a[88:91], a[132:135]
    v_cvt_pk_bf16_f32 v88, v88, v89
    v_cvt_pk_bf16_f32 v89, v90, v91
    v_cvt_pk_bf16_f32 v90, v184, v185
    v_mfma_f32_16x16x32_bf16 v[96:99], a[96:99], a[72:75], v[96:99]
    buffer_load_dwordx4 a[208:211], v36, s[8:11], s62 offen offset:0 sc1
    buffer_load_dwordx4 a[212:215], v36, s[8:11], s62 offen offset:1024 sc1
    v_mfma_f32_16x16x32_bf16 v[192:195], a[100:103], a[72:75], v[192:195]
    v_cvt_pk_bf16_f32 v91, v186, v187
    v_cvt_pk_bf16_f32 v92, v92, v93
    v_cvt_pk_bf16_f32 v93, v94, v95
    v_mfma_f32_16x16x32_bf16 v[100:103], a[104:107], a[72:75], v[100:103]
    v_cvt_pk_bf16_f32 v94, v188, v189
    v_cvt_pk_bf16_f32 v95, v190, v191
    v_mfma_f32_16x16x32_bf16 v[196:199], a[108:111], a[72:75], v[196:199]
    v_accvgpr_read_b32 v56, a128
    v_accvgpr_read_b32 v57, a129
    v_accvgpr_read_b32 v58, a130
    v_mfma_f32_16x16x32_bf16 a[136:139], a[104:107], a[88:91], a[136:139]
    buffer_load_dwordx4 a[216:219], v37, s[8:11], s62 offen offset:0 sc1
    buffer_load_dwordx4 a[220:223], v37, s[8:11], s62 offen offset:1024 sc1
    v_mfma_f32_16x16x32_bf16 a[140:143], a[108:111], a[88:91], a[140:143]
    s_add_u32 s62, s62, 0x20000
    v_accvgpr_read_b32 v59, a131
    v_accvgpr_read_b32 v60, a132
    v_cvt_pk_bf16_f32 v96, v96, v97
    v_mfma_f32_16x16x32_bf16 v[104:107], a[112:115], a[72:75], v[104:107]
    s_add_u32 m0, s60, 114688
    v_accvgpr_read_b32 v61, a133
    v_accvgpr_read_b32 v62, a134
    v_cvt_pk_bf16_f32 v97, v98, v99
    v_mfma_f32_16x16x32_bf16 v[200:203], a[116:119], a[72:75], v[200:203]
    v_accvgpr_read_b32 v63, a135
    v_cvt_pk_bf16_f32 v98, v192, v193
    v_cvt_pk_bf16_f32 v160, v56, v57
    v_mfma_f32_16x16x32_bf16 v[108:111], a[120:123], a[72:75], v[108:111]
    v_cvt_pk_bf16_f32 v99, v194, v195
    v_cvt_pk_bf16_f32 v161, v58, v59
    v_cvt_pk_bf16_f32 v100, v100, v101
    v_mfma_f32_16x16x32_bf16 v[204:207], a[124:127], a[72:75], v[204:207]
    buffer_load_dwordx4 v38, s[12:15], s61 offen offset:0 lds
    buffer_load_dwordx4 v39, s[12:15], s61 offen offset:1024 lds
    v_mfma_f32_16x16x32_bf16 a[144:147], a[112:115], a[88:91], a[144:147]
    v_cvt_pk_bf16_f32 v162, v60, v61
    v_cvt_pk_bf16_f32 v101, v102, v103
    v_cvt_pk_bf16_f32 v163, v62, v63
    v_mfma_f32_16x16x32_bf16 a[148:151], a[116:119], a[88:91], a[148:151]
    v_cvt_pk_bf16_f32 v102, v196, v197
    v_cvt_pk_bf16_f32 v103, v198, v199
    v_accvgpr_read_b32 v56, a136
    v_mfma_f32_16x16x32_bf16 v[112:115], a[96:99], a[76:79], v[112:115]
    v_accvgpr_read_b32 v57, a137
    v_accvgpr_read_b32 v58, a138
    v_accvgpr_read_b32 v59, a139
    v_mfma_f32_16x16x32_bf16 v[208:211], a[100:103], a[76:79], v[208:211]
    v_accvgpr_read_b32 v60, a140
    v_cvt_pk_bf16_f32 v104, v104, v105
    v_accvgpr_read_b32 v61, a141
    v_mfma_f32_16x16x32_bf16 v[116:119], a[104:107], a[76:79], v[116:119]
    buffer_load_dwordx4 v40, s[12:15], s61 offen offset:2048 lds
    buffer_load_dwordx4 v41, s[12:15], s61 offen offset:3072 lds
    v_mfma_f32_16x16x32_bf16 v[212:215], a[108:111], a[76:79], v[212:215]
    s_add_u32 s61, s61, 0x80000
    v_accvgpr_read_b32 v62, a142
    v_cvt_pk_bf16_f32 v105, v106, v107
    v_accvgpr_read_b32 v63, a143
    v_mfma_f32_16x16x32_bf16 a[152:155], a[120:123], a[88:91], a[152:155]
    v_cvt_pk_bf16_f32 v106, v200, v201
    v_cvt_pk_bf16_f32 v164, v56, v57
    v_cvt_pk_bf16_f32 v107, v202, v203
    v_mfma_f32_16x16x32_bf16 a[156:159], a[124:127], a[88:91], a[156:159]
    v_cvt_pk_bf16_f32 v165, v58, v59
    v_cvt_pk_bf16_f32 v108, v108, v109
    v_cvt_pk_bf16_f32 v166, v60, v61
    v_mfma_f32_16x16x32_bf16 v[120:123], a[112:115], a[76:79], v[120:123]
    v_cvt_pk_bf16_f32 v109, v110, v111
    v_cvt_pk_bf16_f32 v167, v62, v63
    v_cvt_pk_bf16_f32 v110, v204, v205
    v_mfma_f32_16x16x32_bf16 v[216:219], a[116:119], a[76:79], v[216:219]
    buffer_load_dwordx4 a[224:227], v36, s[8:11], s62 offen offset:0 sc1
    v_cvt_pk_bf16_f32 v111, v206, v207
    v_accvgpr_read_b32 v56, a144
    v_mfma_f32_16x16x32_bf16 v[124:127], a[120:123], a[76:79], v[124:127]
    v_accvgpr_read_b32 v57, a145
    v_accvgpr_read_b32 v58, a146
    v_accvgpr_read_b32 v59, a147
    v_mfma_f32_16x16x32_bf16 v[220:223], a[124:127], a[76:79], v[220:223]
    buffer_load_dwordx4 a[228:231], v36, s[8:11], s62 offen offset:1024 sc1
    v_accvgpr_read_b32 v60, a148
    v_cvt_pk_bf16_f32 v112, v112, v113
    v_mfma_f32_16x16x32_bf16 a[160:163], a[96:99], a[92:95], a[160:163]
    v_accvgpr_read_b32 v61, a149
    v_accvgpr_read_b32 v62, a150
    v_cvt_pk_bf16_f32 v113, v114, v115
    v_mfma_f32_16x16x32_bf16 a[164:167], a[100:103], a[92:95], a[164:167]
    v_accvgpr_read_b32 v63, a151
    v_cvt_pk_bf16_f32 v114, v208, v209
    v_cvt_pk_bf16_f32 v168, v56, v57
    v_mfma_f32_16x16x32_bf16 v[128:131], a[96:99], a[80:83], v[128:131]
    v_cvt_pk_bf16_f32 v115, v210, v211
    v_cvt_pk_bf16_f32 v169, v58, v59
    v_cvt_pk_bf16_f32 v116, v116, v117
    v_mfma_f32_16x16x32_bf16 v[224:227], a[100:103], a[80:83], v[224:227]
    buffer_load_dwordx4 a[232:235], v37, s[8:11], s62 offen offset:0 sc1
    v_cvt_pk_bf16_f32 v170, v60, v61
    v_cvt_pk_bf16_f32 v117, v118, v119
    v_mfma_f32_16x16x32_bf16 v[132:135], a[104:107], a[80:83], v[132:135]
    v_cvt_pk_bf16_f32 v171, v62, v63
    v_cvt_pk_bf16_f32 v118, v212, v213
    v_cvt_pk_bf16_f32 v119, v214, v215
    v_mfma_f32_16x16x32_bf16 v[228:231], a[108:111], a[80:83], v[228:231]
    buffer_load_dwordx4 a[236:239], v37, s[8:11], s62 offen offset:1024 sc1
    v_accvgpr_read_b32 v56, a152
    v_accvgpr_read_b32 v57, a153
    v_mfma_f32_16x16x32_bf16 a[168:171], a[104:107], a[92:95], a[168:171]
    s_add_u32 s62, s62, 0x20000
    v_accvgpr_read_b32 v58, a154
    v_accvgpr_read_b32 v59, a155
    v_accvgpr_read_b32 v60, a156
    v_mfma_f32_16x16x32_bf16 a[172:175], a[108:111], a[92:95], a[172:175]
    s_waitcnt vmcnt(16)
    s_barrier
    v_cvt_pk_bf16_f32 v120, v120, v121
    v_accvgpr_read_b32 v61, a157
    v_accvgpr_read_b32 v62, a158
    v_mfma_f32_16x16x32_bf16 v[136:139], a[112:115], a[80:83], v[136:139]
    v_cvt_pk_bf16_f32 v121, v122, v123
    v_accvgpr_read_b32 v63, a159
    v_cvt_pk_bf16_f32 v122, v216, v217
    v_mfma_f32_16x16x32_bf16 v[232:235], a[116:119], a[80:83], v[232:235]
    v_cvt_pk_bf16_f32 v172, v56, v57
    v_cvt_pk_bf16_f32 v123, v218, v219
    v_cvt_pk_bf16_f32 v173, v58, v59
    v_mfma_f32_16x16x32_bf16 v[140:143], a[120:123], a[80:83], v[140:143]
    v_cvt_pk_bf16_f32 v124, v124, v125
    v_cvt_pk_bf16_f32 v174, v60, v61
    v_cvt_pk_bf16_f32 v125, v126, v127
    v_mfma_f32_16x16x32_bf16 v[236:239], a[124:127], a[80:83], v[236:239]
    v_cvt_pk_bf16_f32 v175, v62, v63
    v_cvt_pk_bf16_f32 v126, v220, v221
    v_cvt_pk_bf16_f32 v127, v222, v223
    v_mfma_f32_16x16x32_bf16 a[176:179], a[112:115], a[92:95], a[176:179]
    ds_read_b64_tr_b16 a[0:1], v42 offset:0
    v_accvgpr_read_b32 v56, a160
    v_accvgpr_read_b32 v57, a161
    v_mfma_f32_16x16x32_bf16 a[180:183], a[116:119], a[92:95], a[180:183]
    ds_read_b64_tr_b16 a[2:3], v42 offset:1024
    v_accvgpr_read_b32 v58, a162
    v_accvgpr_read_b32 v59, a163
    v_mfma_f32_16x16x32_bf16 v[144:147], a[96:99], a[84:87], v[144:147]
    ds_read_b64_tr_b16 a[4:5], v43 offset:0
    v_accvgpr_read_b32 v60, a164
    v_cvt_pk_bf16_f32 v128, v128, v129
    v_mfma_f32_16x16x32_bf16 v[240:243], a[100:103], a[84:87], v[240:243]
    v_accvgpr_read_b32 v61, a165
    v_accvgpr_read_b32 v62, a166
    v_cvt_pk_bf16_f32 v129, v130, v131
    v_mfma_f32_16x16x32_bf16 v[148:151], a[104:107], a[84:87], v[148:151]
    ds_read_b64_tr_b16 a[6:7], v43 offset:1024
    v_accvgpr_read_b32 v63, a167
    v_cvt_pk_bf16_f32 v130, v224, v225
    v_mfma_f32_16x16x32_bf16 v[244:247], a[108:111], a[84:87], v[244:247]
    v_cvt_pk_bf16_f32 v176, v56, v57
    v_cvt_pk_bf16_f32 v131, v226, v227
    v_cvt_pk_bf16_f32 v177, v58, v59
    v_mfma_f32_16x16x32_bf16 a[184:187], a[120:123], a[92:95], a[184:187]
    ds_read_b64_tr_b16 a[8:9], v44 offset:0
    v_cvt_pk_bf16_f32 v132, v132, v133
    v_cvt_pk_bf16_f32 v178, v60, v61
    v_mfma_f32_16x16x32_bf16 a[188:191], a[124:127], a[92:95], a[188:191]
    ds_read_b64_tr_b16 a[10:11], v44 offset:1024
    v_cvt_pk_bf16_f32 v133, v134, v135
    v_cvt_pk_bf16_f32 v179, v62, v63
    v_mfma_f32_16x16x32_bf16 v[152:155], a[112:115], a[84:87], v[152:155]
    ds_read_b64_tr_b16 a[12:13], v45 offset:0
    v_cvt_pk_bf16_f32 v134, v228, v229
    v_cvt_pk_bf16_f32 v135, v230, v231
    v_mfma_f32_16x16x32_bf16 v[248:251], a[116:119], a[84:87], v[248:251]
    ds_read_b64_tr_b16 a[14:15], v45 offset:1024
    v_accvgpr_read_b32 v56, a168
    v_accvgpr_read_b32 v57, a169
    v_mfma_f32_16x16x32_bf16 v[156:159], a[120:123], a[84:87], v[156:159]
    ds_read_b64_tr_b16 a[16:17], v46 offset:0
    v_accvgpr_read_b32 v58, a170
    v_accvgpr_read_b32 v59, a171
    v_mfma_f32_16x16x32_bf16 v[252:255], a[124:127], a[84:87], v[252:255]
    v_accvgpr_read_b32 v60, a172
    v_cvt_pk_bf16_f32 v136, v136, v137
    v_accvgpr_read_b32 v61, a173
    ds_read_b64_tr_b16 a[18:19], v46 offset:1024
    v_accvgpr_read_b32 v62, a174
    v_cvt_pk_bf16_f32 v137, v138, v139
    v_accvgpr_read_b32 v63, a175
    v_cvt_pk_bf16_f32 v138, v232, v233
    v_cvt_pk_bf16_f32 v180, v56, v57
    ds_read_b64_tr_b16 a[20:21], v47 offset:0
    v_cvt_pk_bf16_f32 v139, v234, v235
    v_cvt_pk_bf16_f32 v181, v58, v59
    v_cvt_pk_bf16_f32 v140, v140, v141
    v_cvt_pk_bf16_f32 v182, v60, v61
    ds_read_b64_tr_b16 a[22:23], v47 offset:1024
    v_cvt_pk_bf16_f32 v141, v142, v143
    v_cvt_pk_bf16_f32 v183, v62, v63
    v_cvt_pk_bf16_f32 v142, v236, v237
    ds_read_b64_tr_b16 a[24:25], v48 offset:0
    v_cvt_pk_bf16_f32 v143, v238, v239
    v_accvgpr_read_b32 v56, a176
    ds_read_b64_tr_b16 a[26:27], v48 offset:1024
    v_accvgpr_read_b32 v57, a177
    v_accvgpr_read_b32 v58, a178
    ds_read_b64_tr_b16 a[28:29], v49 offset:0
    v_accvgpr_read_b32 v59, a179
    v_accvgpr_read_b32 v60, a180
    v_cvt_pk_bf16_f32 v144, v144, v145
    ds_read_b64_tr_b16 a[30:31], v49 offset:1024
    v_accvgpr_read_b32 v61, a181
    v_accvgpr_read_b32 v62, a182
    v_cvt_pk_bf16_f32 v145, v146, v147
    v_accvgpr_read_b32 v63, a183
    v_cvt_pk_bf16_f32 v146, v240, v241
    v_cvt_pk_bf16_f32 v184, v56, v57
    v_cvt_pk_bf16_f32 v147, v242, v243
    v_cvt_pk_bf16_f32 v185, v58, v59
    v_cvt_pk_bf16_f32 v148, v148, v149
    v_cvt_pk_bf16_f32 v186, v60, v61
    v_cvt_pk_bf16_f32 v149, v150, v151
    v_cvt_pk_bf16_f32 v187, v62, v63
    v_cvt_pk_bf16_f32 v150, v244, v245
    v_cvt_pk_bf16_f32 v151, v246, v247
    v_accvgpr_read_b32 v56, a184
    v_accvgpr_read_b32 v57, a185
    v_accvgpr_read_b32 v58, a186
    v_accvgpr_read_b32 v59, a187
    v_accvgpr_read_b32 v60, a188
    v_cvt_pk_bf16_f32 v152, v152, v153
    v_accvgpr_read_b32 v61, a189
    v_accvgpr_read_b32 v62, a190
    v_cvt_pk_bf16_f32 v153, v154, v155
    v_accvgpr_read_b32 v63, a191
    v_cvt_pk_bf16_f32 v154, v248, v249
    v_cvt_pk_bf16_f32 v188, v56, v57
    v_cvt_pk_bf16_f32 v155, v250, v251
    v_cvt_pk_bf16_f32 v189, v58, v59
    v_cvt_pk_bf16_f32 v156, v156, v157
    v_cvt_pk_bf16_f32 v190, v60, v61
    v_cvt_pk_bf16_f32 v157, v158, v159
    v_cvt_pk_bf16_f32 v191, v62, v63
    v_cvt_pk_bf16_f32 v158, v252, v253
    v_cvt_pk_bf16_f32 v159, v254, v255
    s_branch k12_join_6
k12_v_5:
k12_loop_21:
    v_mfma_f32_16x16x32_bf16 v[64:67], a[0:3], a[32:35], v[64:67]
    ds_read_b128 a[64:67], v27 offset:0
    v_mfma_f32_16x16x32_bf16 v[68:71], a[0:3], a[36:39], v[68:71]
    ds_read_b64_tr_b16 a[96:97], v28 offset:16384
    v_mfma_f32_16x16x32_bf16 v[72:75], a[0:3], a[40:43], v[72:75]
    v_mfma_f32_16x16x32_bf16 v[76:79], a[0:3], a[44:47], v[76:79]
    s_cmp_eq_u32 s51, s46
    s_cbranch_scc1 k12_ool_23
k12_oolret_24:
    v_mfma_f32_16x16x32_bf16 v[80:83], a[0:3], a[48:51], v[80:83]
    ds_read_b64_tr_b16 a[98:99], v28 offset:18432
    v_mfma_f32_16x16x32_bf16 v[84:87], a[0:3], a[52:55], v[84:87]
    ds_read_b128 a[68:71], v27 offset:2048
    v_mfma_f32_16x16x32_bf16 v[88:91], a[0:3], a[56:59], v[88:91]
    v_mfma_f32_16x16x32_bf16 v[92:95], a[0:3], a[60:63], v[92:95]
    ds_read_b64_tr_b16 a[100:101], v29 offset:16384
    v_mfma_f32_16x16x32_bf16 v[160:163], a[4:7], a[32:35], v[160:163]
    v_mfma_f32_16x16x32_bf16 v[164:167], a[4:7], a[36:39], v[164:167]
    ds_read_b64_tr_b16 a[102:103], v29 offset:18432
    v_mfma_f32_16x16x32_bf16 v[168:171], a[4:7], a[40:43], v[168:171]
    v_mfma_f32_16x16x32_bf16 v[172:175], a[4:7], a[44:47], v[172:175]
    ds_read_b128 a[72:75], v27 offset:4096
    v_mfma_f32_16x16x32_bf16 v[176:179], a[4:7], a[48:51], v[176:179]
    v_mfma_f32_16x16x32_bf16 v[180:183], a[4:7], a[52:55], v[180:183]
    v_mfma_f32_16x16x32_bf16 v[184:187], a[4:7], a[56:59], v[184:187]
    ds_read_b64_tr_b16 a[104:105], v30 offset:16384
    v_mfma_f32_16x16x32_bf16 v[188:191], a[4:7], a[60:63], v[188:191]
    v_mfma_f32_16x16x32_bf16 v[96:99], a[8:11], a[32:35], v[96:99]
    ds_read_b64_tr_b16 a[106:107], v30 offset:18432
    v_mfma_f32_16x16x32_bf16 v[100:103], a[8:11], a[36:39], v[100:103]
    v_mfma_f32_16x16x32_bf16 v[104:107], a[8:11], a[40:43], v[104:107]
    ds_read_b128 a[76:79], v27 offset:6144
    v_mfma_f32_16x16x32_bf16 v[108:111], a[8:11], a[44:47], v[108:111]
    v_mfma_f32_16x16x32_bf16 v[112:115], a[8:11], a[48:51], v[112:115]
    ds_read_b64_tr_b16 a[108:109], v31 offset:16384
    v_mfma_f32_16x16x32_bf16 v[116:119], a[8:11], a[52:55], v[116:119]
    v_mfma_f32_16x16x32_bf16 v[120:123], a[8:11], a[56:59], v[120:123]
    ds_read_b64_tr_b16 a[110:111], v31 offset:18432
    v_mfma_f32_16x16x32_bf16 v[124:127], a[8:11], a[60:63], v[124:127]
    v_mfma_f32_16x16x32_bf16 v[192:195], a[12:15], a[32:35], v[192:195]
    ds_read_b128 a[80:83], v27 offset:8192
    v_mfma_f32_16x16x32_bf16 v[196:199], a[12:15], a[36:39], v[196:199]
    v_mfma_f32_16x16x32_bf16 v[200:203], a[12:15], a[40:43], v[200:203]
    ds_read_b64_tr_b16 a[112:113], v32 offset:16384
    v_mfma_f32_16x16x32_bf16 v[204:207], a[12:15], a[44:47], v[204:207]
    v_mfma_f32_16x16x32_bf16 v[208:211], a[12:15], a[48:51], v[208:211]
    ds_read_b64_tr_b16 a[114:115], v32 offset:18432
    v_mfma_f32_16x16x32_bf16 v[212:215], a[12:15], a[52:55], v[212:215]
    v_mfma_f32_16x16x32_bf16 v[216:219], a[12:15], a[56:59], v[216:219]
    ds_read_b128 a[84:87], v27 offset:10240
    v_mfma_f32_16x16x32_bf16 v[220:223], a[12:15], a[60:63], v[220:223]
    v_mfma_f32_16x16x32_bf16 v[128:131], a[16:19], a[32:35], v[128:131]
    ds_read_b64_tr_b16 a[116:117], v33 offset:16384
    v_mfma_f32_16x16x32_bf16 v[132:135], a[16:19], a[36:39], v[132:135]
    v_mfma_f32_16x16x32_bf16 v[136:139], a[16:19], a[40:43], v[136:139]
    ds_read_b64_tr_b16 a[118:119], v33 offset:18432
    v_mfma_f32_16x16x32_bf16 v[140:143], a[16:19], a[44:47], v[140:143]
    v_mfma_f32_16x16x32_bf16 v[144:147], a[16:19], a[48:51], v[144:147]
    ds_read_b128 a[88:91], v27 offset:12288
    v_mfma_f32_16x16x32_bf16 v[148:151], a[16:19], a[52:55], v[148:151]
    v_mfma_f32_16x16x32_bf16 v[152:155], a[16:19], a[56:59], v[152:155]
    v_mfma_f32_16x16x32_bf16 v[156:159], a[16:19], a[60:63], v[156:159]
    ds_read_b64_tr_b16 a[120:121], v34 offset:16384
    v_mfma_f32_16x16x32_bf16 v[224:227], a[20:23], a[32:35], v[224:227]
    v_mfma_f32_16x16x32_bf16 v[228:231], a[20:23], a[36:39], v[228:231]
    ds_read_b64_tr_b16 a[122:123], v34 offset:18432
    v_mfma_f32_16x16x32_bf16 v[232:235], a[20:23], a[40:43], v[232:235]
    v_mfma_f32_16x16x32_bf16 v[236:239], a[20:23], a[44:47], v[236:239]
    ds_read_b128 a[92:95], v27 offset:14336
    v_mfma_f32_16x16x32_bf16 v[240:243], a[20:23], a[48:51], v[240:243]
    v_mfma_f32_16x16x32_bf16 v[244:247], a[20:23], a[52:55], v[244:247]
    ds_read_b64_tr_b16 a[124:125], v35 offset:16384
    v_mfma_f32_16x16x32_bf16 v[248:251], a[20:23], a[56:59], v[248:251]
    v_mfma_f32_16x16x32_bf16 v[252:255], a[20:23], a[60:63], v[252:255]
    ds_read_b64_tr_b16 a[126:127], v35 offset:18432
    v_mfma_f32_16x16x32_bf16 a[128:131], a[24:27], a[32:35], a[128:131]
    v_mfma_f32_16x16x32_bf16 a[136:139], a[24:27], a[36:39], a[136:139]
    v_mfma_f32_16x16x32_bf16 a[144:147], a[24:27], a[40:43], a[144:147]
    v_mfma_f32_16x16x32_bf16 a[152:155], a[24:27], a[44:47], a[152:155]
    v_mfma_f32_16x16x32_bf16 a[160:163], a[24:27], a[48:51], a[160:163]
    v_mfma_f32_16x16x32_bf16 a[168:171], a[24:27], a[52:55], a[168:171]
    v_mfma_f32_16x16x32_bf16 a[176:179], a[24:27], a[56:59], a[176:179]
    v_mfma_f32_16x16x32_bf16 a[184:187], a[24:27], a[60:63], a[184:187]
    v_mfma_f32_16x16x32_bf16 a[132:135], a[28:31], a[32:35], a[132:135]
    v_mfma_f32_16x16x32_bf16 a[140:143], a[28:31], a[36:39], a[140:143]
    v_mfma_f32_16x16x32_bf16 a[148:151], a[28:31], a[40:43], a[148:151]
    v_mfma_f32_16x16x32_bf16 a[156:159], a[28:31], a[44:47], a[156:159]
    v_mfma_f32_16x16x32_bf16 a[164:167], a[28:31], a[48:51], a[164:167]
    v_mfma_f32_16x16x32_bf16 a[172:175], a[28:31], a[52:55], a[172:175]
    v_mfma_f32_16x16x32_bf16 a[180:183], a[28:31], a[56:59], a[180:183]
    v_mfma_f32_16x16x32_bf16 a[188:191], a[28:31], a[60:63], a[188:191]
    s_waitcnt vmcnt(0) lgkmcnt(0)
    s_barrier
    v_mfma_f32_16x16x32_bf16 v[64:67], a[64:67], a[96:99], v[64:67]
    s_cmp_ge_u32 s49, 1024
    s_cselect_b32 s18, 0, s18
    s_cselect_b32 s22, 0, s22
    ds_read_b128 a[0:3], v26 offset:32768
    v_mfma_f32_16x16x32_bf16 v[68:71], a[64:67], a[100:103], v[68:71]
    s_add_u32 m0, s48, 0
    ds_read_b64_tr_b16 a[32:33], v28 offset:32768
    v_mfma_f32_16x16x32_bf16 v[72:75], a[64:67], a[104:107], v[72:75]
    buffer_load_dwordx4 v10, s[16:19], s49 offen offset:0 lds
    v_mfma_f32_16x16x32_bf16 v[76:79], a[64:67], a[108:111], v[76:79]
    ds_read_b64_tr_b16 a[34:35], v28 offset:34816
    v_mfma_f32_16x16x32_bf16 v[80:83], a[64:67], a[112:115], v[80:83]
    buffer_load_dwordx4 v11, s[16:19], s49 offen offset:1024 lds
    v_mfma_f32_16x16x32_bf16 v[84:87], a[64:67], a[116:119], v[84:87]
    ds_read_b128 a[4:7], v26 offset:34816
    v_mfma_f32_16x16x32_bf16 v[88:91], a[64:67], a[120:123], v[88:91]
    v_mfma_f32_16x16x32_bf16 v[92:95], a[64:67], a[124:127], v[92:95]
    ds_read_b64_tr_b16 a[36:37], v29 offset:32768
    v_mfma_f32_16x16x32_bf16 v[160:163], a[68:71], a[96:99], v[160:163]
    buffer_load_dwordx4 v12, s[16:19], s49 offen offset:2048 lds
    v_mfma_f32_16x16x32_bf16 v[164:167], a[68:71], a[100:103], v[164:167]
    ds_read_b64_tr_b16 a[38:39], v29 offset:34816
    v_mfma_f32_16x16x32_bf16 v[168:171], a[68:71], a[104:107], v[168:171]
    v_mfma_f32_16x16x32_bf16 v[172:175], a[68:71], a[108:111], v[172:175]
    buffer_load_dwordx4 v13, s[16:19], s49 offen offset:3072 lds
    ds_read_b128 a[8:11], v26 offset:36864
    v_mfma_f32_16x16x32_bf16 v[176:179], a[68:71], a[112:115], v[176:179]
    v_mfma_f32_16x16x32_bf16 v[180:183], a[68:71], a[116:119], v[180:183]
    s_add_u32 m0, s48, 4096
    v_mfma_f32_16x16x32_bf16 v[184:187], a[68:71], a[120:123], v[184:187]
    ds_read_b64_tr_b16 a[40:41], v30 offset:32768
    v_mfma_f32_16x16x32_bf16 v[188:191], a[68:71], a[124:127], v[188:191]
    buffer_load_dwordx4 v14, s[16:19], s49 offen offset:0 lds
    v_mfma_f32_16x16x32_bf16 v[96:99], a[72:75], a[96:99], v[96:99]
    ds_read_b64_tr_b16 a[42:43], v30 offset:34816
    v_mfma_f32_16x16x32_bf16 v[100:103], a[72:75], a[100:103], v[100:103]
    v_mfma_f32_16x16x32_bf16 v[104:107], a[72:75], a[104:107], v[104:107]
    buffer_load_dwordx4 v15, s[16:19], s49 offen offset:1024 lds
    ds_read_b128 a[12:15], v26 offset:38912
    v_mfma_f32_16x16x32_bf16 v[108:111], a[72:75], a[108:111], v[108:111]
    v_mfma_f32_16x16x32_bf16 v[112:115], a[72:75], a[112:115], v[112:115]
    ds_read_b64_tr_b16 a[44:45], v31 offset:32768
    v_mfma_f32_16x16x32_bf16 v[116:119], a[72:75], a[116:119], v[116:119]
    v_mfma_f32_16x16x32_bf16 v[120:123], a[72:75], a[120:123], v[120:123]
    buffer_load_dwordx4 v16, s[16:19], s49 offen offset:2048 lds
    ds_read_b64_tr_b16 a[46:47], v31 offset:34816
    v_mfma_f32_16x16x32_bf16 v[124:127], a[72:75], a[124:127], v[124:127]
    v_mfma_f32_16x16x32_bf16 v[192:195], a[76:79], a[96:99], v[192:195]
    ds_read_b128 a[16:19], v26 offset:40960
    v_mfma_f32_16x16x32_bf16 v[196:199], a[76:79], a[100:103], v[196:199]
    buffer_load_dwordx4 v17, s[16:19], s49 offen offset:3072 lds
    v_mfma_f32_16x16x32_bf16 v[200:203], a[76:79], a[104:107], v[200:203]
    ds_read_b64_tr_b16 a[48:49], v32 offset:32768
    v_mfma_f32_16x16x32_bf16 v[204:207], a[76:79], a[108:111], v[204:207]
    s_add_u32 s49, s49, 128
    v_mfma_f32_16x16x32_bf16 v[208:211], a[76:79], a[112:115], v[208:211]
    s_add_u32 m0, s48, 65536
    ds_read_b64_tr_b16 a[50:51], v32 offset:34816
    v_mfma_f32_16x16x32_bf16 v[212:215], a[76:79], a[116:119], v[212:215]
    buffer_load_dwordx4 v18, s[20:23], s50 offen offset:0 lds
    v_mfma_f32_16x16x32_bf16 v[216:219], a[76:79], a[120:123], v[216:219]
    ds_read_b128 a[20:23], v26 offset:43008
    v_mfma_f32_16x16x32_bf16 v[220:223], a[76:79], a[124:127], v[220:223]
    v_mfma_f32_16x16x32_bf16 v[128:131], a[80:83], a[96:99], v[128:131]
    buffer_load_dwordx4 v19, s[20:23], s50 offen offset:1024 lds
    ds_read_b64_tr_b16 a[52:53], v33 offset:32768
    v_mfma_f32_16x16x32_bf16 v[132:135], a[80:83], a[100:103], v[132:135]
    v_mfma_f32_16x16x32_bf16 v[136:139], a[80:83], a[104:107], v[136:139]
    ds_read_b64_tr_b16 a[54:55], v33 offset:34816
    v_mfma_f32_16x16x32_bf16 v[140:143], a[80:83], a[108:111], v[140:143]
    buffer_load_dwordx4 v20, s[20:23], s50 offen offset:2048 lds
    v_mfma_f32_16x16x32_bf16 v[144:147], a[80:83], a[112:115], v[144:147]
    ds_read_b128 a[24:27], v26 offset:45056
    v_mfma_f32_16x16x32_bf16 v[148:151], a[80:83], a[116:119], v[148:151]
    v_mfma_f32_16x16x32_bf16 v[152:155], a[80:83], a[120:123], v[152:155]
    v_mfma_f32_16x16x32_bf16 v[156:159], a[80:83], a[124:127], v[156:159]
    buffer_load_dwordx4 v21, s[20:23], s50 offen offset:3072 lds
    ds_read_b64_tr_b16 a[56:57], v34 offset:32768
    v_mfma_f32_16x16x32_bf16 v[224:227], a[84:87], a[96:99], v[224:227]
    s_add_u32 m0, s48, 69632
    v_mfma_f32_16x16x32_bf16 v[228:231], a[84:87], a[100:103], v[228:231]
    ds_read_b64_tr_b16 a[58:59], v34 offset:34816
    v_mfma_f32_16x16x32_bf16 v[232:235], a[84:87], a[104:107], v[232:235]
    buffer_load_dwordx4 v22, s[20:23], s50 offen offset:0 lds
    v_mfma_f32_16x16x32_bf16 v[236:239], a[84:87], a[108:111], v[236:239]
    ds_read_b128 a[28:31], v26 offset:47104
    v_mfma_f32_16x16x32_bf16 v[240:243], a[84:87], a[112:115], v[240:243]
    v_mfma_f32_16x16x32_bf16 v[244:247], a[84:87], a[116:119], v[244:247]
    ds_read_b64_tr_b16 a[60:61], v35 offset:32768
    v_mfma_f32_16x16x32_bf16 v[248:251], a[84:87], a[120:123], v[248:251]
    buffer_load_dwordx4 v23, s[20:23], s50 offen offset:1024 lds
    v_mfma_f32_16x16x32_bf16 v[252:255], a[84:87], a[124:127], v[252:255]
    ds_read_b64_tr_b16 a[62:63], v35 offset:34816
    v_mfma_f32_16x16x32_bf16 a[128:131], a[88:91], a[96:99], a[128:131]
    v_mfma_f32_16x16x32_bf16 a[136:139], a[88:91], a[100:103], a[136:139]
    buffer_load_dwordx4 v24, s[20:23], s50 offen offset:2048 lds
    v_mfma_f32_16x16x32_bf16 a[144:147], a[88:91], a[104:107], a[144:147]
    v_mfma_f32_16x16x32_bf16 a[152:155], a[88:91], a[108:111], a[152:155]
    v_mfma_f32_16x16x32_bf16 a[160:163], a[88:91], a[112:115], a[160:163]
    v_mfma_f32_16x16x32_bf16 a[168:171], a[88:91], a[116:119], a[168:171]
    buffer_load_dwordx4 v25, s[20:23], s50 offen offset:3072 lds
    v_mfma_f32_16x16x32_bf16 a[176:179], a[88:91], a[120:123], a[176:179]
    v_mfma_f32_16x16x32_bf16 a[184:187], a[88:91], a[124:127], a[184:187]
    s_add_u32 s50, s50, 0x80000
    v_mfma_f32_16x16x32_bf16 a[132:135], a[92:95], a[96:99], a[132:135]
    v_mfma_f32_16x16x32_bf16 a[140:143], a[92:95], a[100:103], a[140:143]
    s_cmp_eq_u32 s51, s53
    s_cbranch_scc1 k12_ool_25
k12_oolret_26:
    v_mfma_f32_16x16x32_bf16 a[148:151], a[92:95], a[104:107], a[148:151]
    v_mfma_f32_16x16x32_bf16 a[156:159], a[92:95], a[108:111], a[156:159]
    s_cmp_eq_u32 s51, s63
    s_cbranch_scc1 k12_ool_27
k12_oolret_28:
    v_mfma_f32_16x16x32_bf16 a[164:167], a[92:95], a[112:115], a[164:167]
    v_mfma_f32_16x16x32_bf16 a[172:175], a[92:95], a[116:119], a[172:175]
    s_add_u32 s51, s51, 1
    v_mfma_f32_16x16x32_bf16 a[180:183], a[92:95], a[120:123], a[180:183]
    v_mfma_f32_16x16x32_bf16 a[188:191], a[92:95], a[124:127], a[188:191]
    s_waitcnt lgkmcnt(0)
    v_mfma_f32_16x16x32_bf16 v[64:67], a[0:3], a[32:35], v[64:67]
    ds_read_b128 a[64:67], v27 offset:32768
    v_mfma_f32_16x16x32_bf16 v[68:71], a[0:3], a[36:39], v[68:71]
    ds_read_b64_tr_b16 a[96:97], v28 offset:49152
    v_mfma_f32_16x16x32_bf16 v[72:75], a[0:3], a[40:43], v[72:75]
    v_mfma_f32_16x16x32_bf16 v[76:79], a[0:3], a[44:47], v[76:79]
    ds_read_b64_tr_b16 a[98:99], v28 offset:51200
    v_mfma_f32_16x16x32_bf16 v[80:83], a[0:3], a[48:51], v[80:83]
    v_mfma_f32_16x16x32_bf16 v[84:87], a[0:3], a[52:55], v[84:87]
    ds_read_b128 a[68:71], v27 offset:34816
    v_mfma_f32_16x16x32_bf16 v[88:91], a[0:3], a[56:59], v[88:91]
    v_mfma_f32_16x16x32_bf16 v[92:95], a[0:3], a[60:63], v[92:95]
    ds_read_b64_tr_b16 a[100:101], v29 offset:49152
    v_mfma_f32_16x16x32_bf16 v[160:163], a[4:7], a[32:35], v[160:163]
    v_mfma_f32_16x16x32_bf16 v[164:167], a[4:7], a[36:39], v[164:167]
    ds_read_b64_tr_b16 a[102:103], v29 offset:51200
    v_mfma_f32_16x16x32_bf16 v[168:171], a[4:7], a[40:43], v[168:171]
    v_mfma_f32_16x16x32_bf16 v[172:175], a[4:7], a[44:47], v[172:175]
    ds_read_b128 a[72:75], v27 offset:36864
    v_mfma_f32_16x16x32_bf16 v[176:179], a[4:7], a[48:51], v[176:179]
    v_mfma_f32_16x16x32_bf16 v[180:183], a[4:7], a[52:55], v[180:183]
    v_mfma_f32_16x16x32_bf16 v[184:187], a[4:7], a[56:59], v[184:187]
    ds_read_b64_tr_b16 a[104:105], v30 offset:49152
    v_mfma_f32_16x16x32_bf16 v[188:191], a[4:7], a[60:63], v[188:191]
    v_mfma_f32_16x16x32_bf16 v[96:99], a[8:11], a[32:35], v[96:99]
    ds_read_b64_tr_b16 a[106:107], v30 offset:51200
    v_mfma_f32_16x16x32_bf16 v[100:103], a[8:11], a[36:39], v[100:103]
    v_mfma_f32_16x16x32_bf16 v[104:107], a[8:11], a[40:43], v[104:107]
    ds_read_b128 a[76:79], v27 offset:38912
    v_mfma_f32_16x16x32_bf16 v[108:111], a[8:11], a[44:47], v[108:111]
    v_mfma_f32_16x16x32_bf16 v[112:115], a[8:11], a[48:51], v[112:115]
    ds_read_b64_tr_b16 a[108:109], v31 offset:49152
    v_mfma_f32_16x16x32_bf16 v[116:119], a[8:11], a[52:55], v[116:119]
    v_mfma_f32_16x16x32_bf16 v[120:123], a[8:11], a[56:59], v[120:123]
    ds_read_b64_tr_b16 a[110:111], v31 offset:51200
    v_mfma_f32_16x16x32_bf16 v[124:127], a[8:11], a[60:63], v[124:127]
    v_mfma_f32_16x16x32_bf16 v[192:195], a[12:15], a[32:35], v[192:195]
    ds_read_b128 a[80:83], v27 offset:40960
    v_mfma_f32_16x16x32_bf16 v[196:199], a[12:15], a[36:39], v[196:199]
    v_mfma_f32_16x16x32_bf16 v[200:203], a[12:15], a[40:43], v[200:203]
    ds_read_b64_tr_b16 a[112:113], v32 offset:49152
    v_mfma_f32_16x16x32_bf16 v[204:207], a[12:15], a[44:47], v[204:207]
    v_mfma_f32_16x16x32_bf16 v[208:211], a[12:15], a[48:51], v[208:211]
    ds_read_b64_tr_b16 a[114:115], v32 offset:51200
    v_mfma_f32_16x16x32_bf16 v[212:215], a[12:15], a[52:55], v[212:215]
    v_mfma_f32_16x16x32_bf16 v[216:219], a[12:15], a[56:59], v[216:219]
    ds_read_b128 a[84:87], v27 offset:43008
    v_mfma_f32_16x16x32_bf16 v[220:223], a[12:15], a[60:63], v[220:223]
    v_mfma_f32_16x16x32_bf16 v[128:131], a[16:19], a[32:35], v[128:131]
    ds_read_b64_tr_b16 a[116:117], v33 offset:49152
    v_mfma_f32_16x16x32_bf16 v[132:135], a[16:19], a[36:39], v[132:135]
    v_mfma_f32_16x16x32_bf16 v[136:139], a[16:19], a[40:43], v[136:139]
    ds_read_b64_tr_b16 a[118:119], v33 offset:51200
    v_mfma_f32_16x16x32_bf16 v[140:143], a[16:19], a[44:47], v[140:143]
    v_mfma_f32_16x16x32_bf16 v[144:147], a[16:19], a[48:51], v[144:147]
    ds_read_b128 a[88:91], v27 offset:45056
    v_mfma_f32_16x16x32_bf16 v[148:151], a[16:19], a[52:55], v[148:151]
    v_mfma_f32_16x16x32_bf16 v[152:155], a[16:19], a[56:59], v[152:155]
    v_mfma_f32_16x16x32_bf16 v[156:159], a[16:19], a[60:63], v[156:159]
    ds_read_b64_tr_b16 a[120:121], v34 offset:49152
    v_mfma_f32_16x16x32_bf16 v[224:227], a[20:23], a[32:35], v[224:227]
    v_mfma_f32_16x16x32_bf16 v[228:231], a[20:23], a[36:39], v[228:231]
    ds_read_b64_tr_b16 a[122:123], v34 offset:51200
    v_mfma_f32_16x16x32_bf16 v[232:235], a[20:23], a[40:43], v[232:235]
    v_mfma_f32_16x16x32_bf16 v[236:239], a[20:23], a[44:47], v[236:239]
    ds_read_b128 a[92:95], v27 offset:47104
    v_mfma_f32_16x16x32_bf16 v[240:243], a[20:23], a[48:51], v[240:243]
    v_mfma_f32_16x16x32_bf16 v[244:247], a[20:23], a[52:55], v[244:247]
    ds_read_b64_tr_b16 a[124:125], v35 offset:49152
    v_mfma_f32_16x16x32_bf16 v[248:251], a[20:23], a[56:59], v[248:251]
    v_mfma_f32_16x16x32_bf16 v[252:255], a[20:23], a[60:63], v[252:255]
    ds_read_b64_tr_b16 a[126:127], v35 offset:51200
    v_mfma_f32_16x16x32_bf16 a[128:131], a[24:27], a[32:35], a[128:131]
    v_mfma_f32_16x16x32_bf16 a[136:139], a[24:27], a[36:39], a[136:139]
    v_mfma_f32_16x16x32_bf16 a[144:147], a[24:27], a[40:43], a[144:147]
    v_mfma_f32_16x16x32_bf16 a[152:155], a[24:27], a[44:47], a[152:155]
    v_mfma_f32_16x16x32_bf16 a[160:163], a[24:27], a[48:51], a[160:163]
    v_mfma_f32_16x16x32_bf16 a[168:171], a[24:27], a[52:55], a[168:171]
    v_mfma_f32_16x16x32_bf16 a[176:179], a[24:27], a[56:59], a[176:179]
    v_mfma_f32_16x16x32_bf16 a[184:187], a[24:27], a[60:63], a[184:187]
    s_sub_u32 s52, s51, 1
    s_cmp_eq_u32 s52, s46
    s_cbranch_scc1 k12_ool_31
k12_oolret_32:
    v_mfma_f32_16x16x32_bf16 a[132:135], a[28:31], a[32:35], a[132:135]
    v_mfma_f32_16x16x32_bf16 a[140:143], a[28:31], a[36:39], a[140:143]
    v_mfma_f32_16x16x32_bf16 a[148:151], a[28:31], a[40:43], a[148:151]
    v_mfma_f32_16x16x32_bf16 a[156:159], a[28:31], a[44:47], a[156:159]
    v_mfma_f32_16x16x32_bf16 a[164:167], a[28:31], a[48:51], a[164:167]
    v_mfma_f32_16x16x32_bf16 a[172:175], a[28:31], a[52:55], a[172:175]
    v_mfma_f32_16x16x32_bf16 a[180:183], a[28:31], a[56:59], a[180:183]
    v_mfma_f32_16x16x32_bf16 a[188:191], a[28:31], a[60:63], a[188:191]
    s_waitcnt vmcnt(0) lgkmcnt(0)
    s_barrier
    s_cmp_eq_u32 s51, 7
    s_cbranch_scc1 k12_last_22
    v_mfma_f32_16x16x32_bf16 v[64:67], a[64:67], a[96:99], v[64:67]
    ds_read_b128 a[0:3], v26 offset:0
    v_mfma_f32_16x16x32_bf16 v[68:71], a[64:67], a[100:103], v[68:71]
    s_add_u32 m0, s48, 32768
    ds_read_b64_tr_b16 a[32:33], v28 offset:0
    v_mfma_f32_16x16x32_bf16 v[72:75], a[64:67], a[104:107], v[72:75]
    buffer_load_dwordx4 v10, s[16:19], s49 offen offset:0 lds
    v_mfma_f32_16x16x32_bf16 v[76:79], a[64:67], a[108:111], v[76:79]
    ds_read_b64_tr_b16 a[34:35], v28 offset:2048
    v_mfma_f32_16x16x32_bf16 v[80:83], a[64:67], a[112:115], v[80:83]
    buffer_load_dwordx4 v11, s[16:19], s49 offen offset:1024 lds
    v_mfma_f32_16x16x32_bf16 v[84:87], a[64:67], a[116:119], v[84:87]
    ds_read_b128 a[4:7], v26 offset:2048
    v_mfma_f32_16x16x32_bf16 v[88:91], a[64:67], a[120:123], v[88:91]
    v_mfma_f32_16x16x32_bf16 v[92:95], a[64:67], a[124:127], v[92:95]
    ds_read_b64_tr_b16 a[36:37], v29 offset:0
    v_mfma_f32_16x16x32_bf16 v[160:163], a[68:71], a[96:99], v[160:163]
    buffer_load_dwordx4 v12, s[16:19], s49 offen offset:2048 lds
    v_mfma_f32_16x16x32_bf16 v[164:167], a[68:71], a[100:103], v[164:167]
    ds_read_b64_tr_b16 a[38:39], v29 offset:2048
    v_mfma_f32_16x16x32_bf16 v[168:171], a[68:71], a[104:107], v[168:171]
    v_mfma_f32_16x16x32_bf16 v[172:175], a[68:71], a[108:111], v[172:175]
    buffer_load_dwordx4 v13, s[16:19], s49 offen offset:3072 lds
    ds_read_b128 a[8:11], v26 offset:4096
    v_mfma_f32_16x16x32_bf16 v[176:179], a[68:71], a[112:115], v[176:179]
    v_mfma_f32_16x16x32_bf16 v[180:183], a[68:71], a[116:119], v[180:183]
    s_add_u32 m0, s48, 36864
    v_mfma_f32_16x16x32_bf16 v[184:187], a[68:71], a[120:123], v[184:187]
    ds_read_b64_tr_b16 a[40:41], v30 offset:0
    v_mfma_f32_16x16x32_bf16 v[188:191], a[68:71], a[124:127], v[188:191]
    buffer_load_dwordx4 v14, s[16:19], s49 offen offset:0 lds
    v_mfma_f32_16x16x32_bf16 v[96:99], a[72:75], a[96:99], v[96:99]
    ds_read_b64_tr_b16 a[42:43], v30 offset:2048
    v_mfma_f32_16x16x32_bf16 v[100:103], a[72:75], a[100:103], v[100:103]
    v_mfma_f32_16x16x32_bf16 v[104:107], a[72:75], a[104:107], v[104:107]
    buffer_load_dwordx4 v15, s[16:19], s49 offen offset:1024 lds
    ds_read_b128 a[12:15], v26 offset:6144
    v_mfma_f32_16x16x32_bf16 v[108:111], a[72:75], a[108:111], v[108:111]
    v_mfma_f32_16x16x32_bf16 v[112:115], a[72:75], a[112:115], v[112:115]
    ds_read_b64_tr_b16 a[44:45], v31 offset:0
    v_mfma_f32_16x16x32_bf16 v[116:119], a[72:75], a[116:119], v[116:119]
    v_mfma_f32_16x16x32_bf16 v[120:123], a[72:75], a[120:123], v[120:123]
    buffer_load_dwordx4 v16, s[16:19], s49 offen offset:2048 lds
    ds_read_b64_tr_b16 a[46:47], v31 offset:2048
    v_mfma_f32_16x16x32_bf16 v[124:127], a[72:75], a[124:127], v[124:127]
    v_mfma_f32_16x16x32_bf16 v[192:195], a[76:79], a[96:99], v[192:195]
    ds_read_b128 a[16:19], v26 offset:8192
    v_mfma_f32_16x16x32_bf16 v[196:199], a[76:79], a[100:103], v[196:199]
    buffer_load_dwordx4 v17, s[16:19], s49 offen offset:3072 lds
    v_mfma_f32_16x16x32_bf16 v[200:203], a[76:79], a[104:107], v[200:203]
    ds_read_b64_tr_b16 a[48:49], v32 offset:0
    v_mfma_f32_16x16x32_bf16 v[204:207], a[76:79], a[108:111], v[204:207]
    s_add_u32 s49, s49, 128
    v_mfma_f32_16x16x32_bf16 v[208:211], a[76:79], a[112:115], v[208:211]
    s_add_u32 m0, s48, 98304
    ds_read_b64_tr_b16 a[50:51], v32 offset:2048
    v_mfma_f32_16x16x32_bf16 v[212:215], a[76:79], a[116:119], v[212:215]
    buffer_load_dwordx4 v18, s[20:23], s50 offen offset:0 lds
    v_mfma_f32_16x16x32_bf16 v[216:219], a[76:79], a[120:123], v[216:219]
    ds_read_b128 a[20:23], v26 offset:10240
    v_mfma_f32_16x16x32_bf16 v[220:223], a[76:79], a[124:127], v[220:223]
    v_mfma_f32_16x16x32_bf16 v[128:131], a[80:83], a[96:99], v[128:131]
    buffer_load_dwordx4 v19, s[20:23], s50 offen offset:1024 lds
    ds_read_b64_tr_b16 a[52:53], v33 offset:0
    v_mfma_f32_16x16x32_bf16 v[132:135], a[80:83], a[100:103], v[132:135]
    v_mfma_f32_16x16x32_bf16 v[136:139], a[80:83], a[104:107], v[136:139]
    ds_read_b64_tr_b16 a[54:55], v33 offset:2048
    v_mfma_f32_16x16x32_bf16 v[140:143], a[80:83], a[108:111], v[140:143]
    buffer_load_dwordx4 v20, s[20:23], s50 offen offset:2048 lds
    v_mfma_f32_16x16x32_bf16 v[144:147], a[80:83], a[112:115], v[144:147]
    ds_read_b128 a[24:27], v26 offset:12288
    v_mfma_f32_16x16x32_bf16 v[148:151], a[80:83], a[116:119], v[148:151]
    v_mfma_f32_16x16x32_bf16 v[152:155], a[80:83], a[120:123], v[152:155]
    v_mfma_f32_16x16x32_bf16 v[156:159], a[80:83], a[124:127], v[156:159]
    buffer_load_dwordx4 v21, s[20:23], s50 offen offset:3072 lds
    ds_read_b64_tr_b16 a[56:57], v34 offset:0
    v_mfma_f32_16x16x32_bf16 v[224:227], a[84:87], a[96:99], v[224:227]
    s_add_u32 m0, s48, 102400
    v_mfma_f32_16x16x32_bf16 v[228:231], a[84:87], a[100:103], v[228:231]
    ds_read_b64_tr_b16 a[58:59], v34 offset:2048
    v_mfma_f32_16x16x32_bf16 v[232:235], a[84:87], a[104:107], v[232:235]
    buffer_load_dwordx4 v22, s[20:23], s50 offen offset:0 lds
    v_mfma_f32_16x16x32_bf16 v[236:239], a[84:87], a[108:111], v[236:239]
    ds_read_b128 a[28:31], v26 offset:14336
    v_mfma_f32_16x16x32_bf16 v[240:243], a[84:87], a[112:115], v[240:243]
    v_mfma_f32_16x16x32_bf16 v[244:247], a[84:87], a[116:119], v[244:247]
    ds_read_b64_tr_b16 a[60:61], v35 offset:0
    v_mfma_f32_16x16x32_bf16 v[248:251], a[84:87], a[120:123], v[248:251]
    buffer_load_dwordx4 v23, s[20:23], s50 offen offset:1024 lds
    v_mfma_f32_16x16x32_bf16 v[252:255], a[84:87], a[124:127], v[252:255]
    ds_read_b64_tr_b16 a[62:63], v35 offset:2048
    v_mfma_f32_16x16x32_bf16 a[128:131], a[88:91], a[96:99], a[128:131]
    v_mfma_f32_16x16x32_bf16 a[136:139], a[88:91], a[100:103], a[136:139]
    buffer_load_dwordx4 v24, s[20:23], s50 offen offset:2048 lds
    v_mfma_f32_16x16x32_bf16 a[144:147], a[88:91], a[104:107], a[144:147]
    v_mfma_f32_16x16x32_bf16 a[152:155], a[88:91], a[108:111], a[152:155]
    v_mfma_f32_16x16x32_bf16 a[160:163], a[88:91], a[112:115], a[160:163]
    v_mfma_f32_16x16x32_bf16 a[168:171], a[88:91], a[116:119], a[168:171]
    buffer_load_dwordx4 v25, s[20:23], s50 offen offset:3072 lds
    v_mfma_f32_16x16x32_bf16 a[176:179], a[88:91], a[120:123], a[176:179]
    v_mfma_f32_16x16x32_bf16 a[184:187], a[88:91], a[124:127], a[184:187]
    s_add_u32 s50, s50, 0x80000
    v_mfma_f32_16x16x32_bf16 a[132:135], a[92:95], a[96:99], a[132:135]
    v_mfma_f32_16x16x32_bf16 a[140:143], a[92:95], a[100:103], a[140:143]
    s_cmp_eq_u32 s51, s53
    s_cbranch_scc1 k12_ool_33
k12_oolret_34:
    v_mfma_f32_16x16x32_bf16 a[148:151], a[92:95], a[104:107], a[148:151]
    v_mfma_f32_16x16x32_bf16 a[156:159], a[92:95], a[108:111], a[156:159]
    v_mfma_f32_16x16x32_bf16 a[164:167], a[92:95], a[112:115], a[164:167]
    v_mfma_f32_16x16x32_bf16 a[172:175], a[92:95], a[116:119], a[172:175]
    s_add_u32 s51, s51, 1
    v_mfma_f32_16x16x32_bf16 a[180:183], a[92:95], a[120:123], a[180:183]
    v_mfma_f32_16x16x32_bf16 a[188:191], a[92:95], a[124:127], a[188:191]
    s_waitcnt lgkmcnt(0)
    s_branch k12_loop_21
k12_last_22:
    v_mfma_f32_16x16x32_bf16 v[64:67], a[64:67], a[96:99], v[64:67]
    s_add_u32 m0, s60, 98304
    v_mfma_f32_16x16x32_bf16 v[160:163], a[68:71], a[96:99], v[160:163]
    buffer_load_dwordx4 v38, s[12:15], s61 offen offset:0 lds
    v_mfma_f32_16x16x32_bf16 v[68:71], a[64:67], a[100:103], v[68:71]
    buffer_load_dwordx4 v39, s[12:15], s61 offen offset:1024 lds
    v_mfma_f32_16x16x32_bf16 v[164:167], a[68:71], a[100:103], v[164:167]
    v_mfma_f32_16x16x32_bf16 v[72:75], a[64:67], a[104:107], v[72:75]
    buffer_load_dwordx4 v40, s[12:15], s61 offen offset:2048 lds
    v_mfma_f32_16x16x32_bf16 v[168:171], a[68:71], a[104:107], v[168:171]
    v_cvt_pk_bf16_f32 v64, v64, v65
    v_cvt_pk_bf16_f32 v65, v66, v67
    v_cvt_pk_bf16_f32 v66, v160, v161
    v_mfma_f32_16x16x32_bf16 v[76:79], a[64:67], a[108:111], v[76:79]
    v_cvt_pk_bf16_f32 v67, v162, v163
    v_mfma_f32_16x16x32_bf16 v[172:175], a[68:71], a[108:111], v[172:175]
    v_cvt_pk_bf16_f32 v68, v68, v69
    v_cvt_pk_bf16_f32 v69, v70, v71
    v_cvt_pk_bf16_f32 v70, v164, v165
    v_mfma_f32_16x16x32_bf16 v[80:83], a[64:67], a[112:115], v[80:83]
    buffer_load_dwordx4 v41, s[12:15], s61 offen offset:3072 lds
    v_mfma_f32_16x16x32_bf16 v[176:179], a[68:71], a[112:115], v[176:179]
    s_add_u32 s61, s61, 0x80000
    v_cvt_pk_bf16_f32 v71, v166, v167
    v_cvt_pk_bf16_f32 v72, v72, v73
    v_cvt_pk_bf16_f32 v73, v74, v75
    v_mfma_f32_16x16x32_bf16 v[84:87], a[64:67], a[116:119], v[84:87]
    buffer_load_dwordx4 a[192:195], v36, s[8:11], s62 offen offset:0 sc1
    buffer_load_dwordx4 a[196:199], v36, s[8:11], s62 offen offset:1024 sc1
    v_mfma_f32_16x16x32_bf16 v[180:183], a[68:71], a[116:119], v[180:183]
    v_cvt_pk_bf16_f32 v74, v168, v169
    v_cvt_pk_bf16_f32 v75, v170, v171
    v_cvt_pk_bf16_f32 v76, v76, v77
    v_mfma_f32_16x16x32_bf16 v[88:91], a[64:67], a[120:123], v[88:91]
    v_cvt_pk_bf16_f32 v77, v78, v79
    v_cvt_pk_bf16_f32 v78, v172, v173
    v_cvt_pk_bf16_f32 v79, v174, v175
    v_mfma_f32_16x16x32_bf16 v[184:187], a[68:71], a[120:123], v[184:187]
    v_cvt_pk_bf16_f32 v80, v80, v81
    v_cvt_pk_bf16_f32 v81, v82, v83
    v_cvt_pk_bf16_f32 v82, v176, v177
    v_mfma_f32_16x16x32_bf16 v[92:95], a[64:67], a[124:127], v[92:95]
    buffer_load_dwordx4 a[200:203], v37, s[8:11], s62 offen offset:0 sc1
    buffer_load_dwordx4 a[204:207], v37, s[8:11], s62 offen offset:1024 sc1
    v_mfma_f32_16x16x32_bf16 v[188:191], a[68:71], a[124:127], v[188:191]
    s_add_u32 s62, s62, 0x20000
    v_cvt_pk_bf16_f32 v83, v178, v179
    v_cvt_pk_bf16_f32 v84, v84, v85
    v_cvt_pk_bf16_f32 v85, v86, v87
    v_mfma_f32_16x16x32_bf16 a[128:131], a[88:91], a[96:99], a[128:131]
    v_cvt_pk_bf16_f32 v86, v180, v181
    v_cvt_pk_bf16_f32 v87, v182, v183
    v_mfma_f32_16x16x32_bf16 a[132:135], a[92:95], a[96:99], a[132:135]
    v_cvt_pk_bf16_f32 v88, v88, v89
    v_cvt_pk_bf16_f32 v89, v90, v91
    v_cvt_pk_bf16_f32 v90, v184, v185
    v_mfma_f32_16x16x32_bf16 v[96:99], a[72:75], a[96:99], v[96:99]
    buffer_load_dwordx4 a[208:211], v36, s[8:11], s62 offen offset:0 sc1
    buffer_load_dwordx4 a[212:215], v36, s[8:11], s62 offen offset:1024 sc1
    v_mfma_f32_16x16x32_bf16 v[192:195], a[76:79], a[96:99], v[192:195]
    v_cvt_pk_bf16_f32 v91, v186, v187
    v_cvt_pk_bf16_f32 v92, v92, v93
    v_cvt_pk_bf16_f32 v93, v94, v95
    v_mfma_f32_16x16x32_bf16 v[100:103], a[72:75], a[100:103], v[100:103]
    v_cvt_pk_bf16_f32 v94, v188, v189
    v_cvt_pk_bf16_f32 v95, v190, v191
    v_mfma_f32_16x16x32_bf16 v[196:199], a[76:79], a[100:103], v[196:199]
    v_accvgpr_read_b32 v56, a128
    v_accvgpr_read_b32 v57, a129
    v_accvgpr_read_b32 v58, a130
    v_mfma_f32_16x16x32_bf16 a[136:139], a[88:91], a[100:103], a[136:139]
    buffer_load_dwordx4 a[216:219], v37, s[8:11], s62 offen offset:0 sc1
    buffer_load_dwordx4 a[220:223], v37, s[8:11], s62 offen offset:1024 sc1
    v_mfma_f32_16x16x32_bf16 a[140:143], a[92:95], a[100:103], a[140:143]
    s_add_u32 s62, s62, 0x20000
    v_accvgpr_read_b32 v59, a131
    v_accvgpr_read_b32 v60, a132
    v_cvt_pk_bf16_f32 v96, v96, v97
    v_mfma_f32_16x16x32_bf16 v[104:107], a[72:75], a[104:107], v[104:107]
    s_add_u32 m0, s60, 114688
    v_accvgpr_read_b32 v61, a133
    v_accvgpr_read_b32 v62, a134
    v_cvt_pk_bf16_f32 v97, v98, v99
    v_mfma_f32_16x16x32_bf16 v[200:203], a[76:79], a[104:107], v[200:203]
    v_accvgpr_read_b32 v63, a135
    v_cvt_pk_bf16_f32 v98, v192, v193
    v_cvt_pk_bf16_f32 v160, v56, v57
    v_mfma_f32_16x16x32_bf16 v[108:111], a[72:75], a[108:111], v[108:111]
    v_cvt_pk_bf16_f32 v99, v194, v195
    v_cvt_pk_bf16_f32 v161, v58, v59
    v_cvt_pk_bf16_f32 v100, v100, v101
    v_mfma_f32_16x16x32_bf16 v[204:207], a[76:79], a[108:111], v[204:207]
    buffer_load_dwordx4 v38, s[12:15], s61 offen offset:0 lds
    buffer_load_dwordx4 v39, s[12:15], s61 offen offset:1024 lds
    v_mfma_f32_16x16x32_bf16 a[144:147], a[88:91], a[104:107], a[144:147]
    v_cvt_pk_bf16_f32 v162, v60, v61
    v_cvt_pk_bf16_f32 v101, v102, v103
    v_cvt_pk_bf16_f32 v163, v62, v63
    v_mfma_f32_16x16x32_bf16 a[148:151], a[92:95], a[104:107], a[148:151]
    v_cvt_pk_bf16_f32 v102, v196, v197
    v_cvt_pk_bf16_f32 v103, v198, v199
    v_accvgpr_read_b32 v56, a136
    v_mfma_f32_16x16x32_bf16 v[112:115], a[72:75], a[112:115], v[112:115]
    v_accvgpr_read_b32 v57, a137
    v_accvgpr_read_b32 v58, a138
    v_accvgpr_read_b32 v59, a139
    v_mfma_f32_16x16x32_bf16 v[208:211], a[76:79], a[112:115], v[208:211]
    v_accvgpr_read_b32 v60, a140
    v_cvt_pk_bf16_f32 v104, v104, v105
    v_accvgpr_read_b32 v61, a141
    v_mfma_f32_16x16x32_bf16 v[116:119], a[72:75], a[116:119], v[116:119]
    buffer_load_dwordx4 v40, s[12:15], s61 offen offset:2048 lds
    buffer_load_dwordx4 v41, s[12:15], s61 offen offset:3072 lds
    v_mfma_f32_16x16x32_bf16 v[212:215], a[76:79], a[116:119], v[212:215]
    s_add_u32 s61, s61, 0x80000
    v_accvgpr_read_b32 v62, a142
    v_cvt_pk_bf16_f32 v105, v106, v107
    v_accvgpr_read_b32 v63, a143
    v_mfma_f32_16x16x32_bf16 a[152:155], a[88:91], a[108:111], a[152:155]
    v_cvt_pk_bf16_f32 v106, v200, v201
    v_cvt_pk_bf16_f32 v164, v56, v57
    v_cvt_pk_bf16_f32 v107, v202, v203
    v_mfma_f32_16x16x32_bf16 a[156:159], a[92:95], a[108:111], a[156:159]
    v_cvt_pk_bf16_f32 v165, v58, v59
    v_cvt_pk_bf16_f32 v108, v108, v109
    v_cvt_pk_bf16_f32 v166, v60, v61
    v_mfma_f32_16x16x32_bf16 v[120:123], a[72:75], a[120:123], v[120:123]
    v_cvt_pk_bf16_f32 v109, v110, v111
    v_cvt_pk_bf16_f32 v167, v62, v63
    v_cvt_pk_bf16_f32 v110, v204, v205
    v_mfma_f32_16x16x32_bf16 v[216:219], a[76:79], a[120:123], v[216:219]
    buffer_load_dwordx4 a[224:227], v36, s[8:11], s62 offen offset:0 sc1
    v_cvt_pk_bf16_f32 v111, v206, v207
    v_accvgpr_read_b32 v56, a144
    v_mfma_f32_16x16x32_bf16 v[124:127], a[72:75], a[124:127], v[124:127]
    v_accvgpr_read_b32 v57, a145
    v_accvgpr_read_b32 v58, a146
    v_accvgpr_read_b32 v59, a147
    v_mfma_f32_16x16x32_bf16 v[220:223], a[76:79], a[124:127], v[220:223]
    buffer_load_dwordx4 a[228:231], v36, s[8:11], s62 offen offset:1024 sc1
    v_accvgpr_read_b32 v60, a148
    v_cvt_pk_bf16_f32 v112, v112, v113
    v_mfma_f32_16x16x32_bf16 a[160:163], a[88:91], a[112:115], a[160:163]
    v_accvgpr_read_b32 v61, a149
    v_accvgpr_read_b32 v62, a150
    v_cvt_pk_bf16_f32 v113, v114, v115
    v_mfma_f32_16x16x32_bf16 a[164:167], a[92:95], a[112:115], a[164:167]
    v_accvgpr_read_b32 v63, a151
    v_cvt_pk_bf16_f32 v114, v208, v209
    v_cvt_pk_bf16_f32 v168, v56, v57
    v_mfma_f32_16x16x32_bf16 v[128:131], a[80:83], a[96:99], v[128:131]
    v_cvt_pk_bf16_f32 v115, v210, v211
    v_cvt_pk_bf16_f32 v169, v58, v59
    v_cvt_pk_bf16_f32 v116, v116, v117
    v_mfma_f32_16x16x32_bf16 v[224:227], a[84:87], a[96:99], v[224:227]
    buffer_load_dwordx4 a[232:235], v37, s[8:11], s62 offen offset:0 sc1
    v_cvt_pk_bf16_f32 v170, v60, v61
    v_cvt_pk_bf16_f32 v117, v118, v119
    v_mfma_f32_16x16x32_bf16 v[132:135], a[80:83], a[100:103], v[132:135]
    v_cvt_pk_bf16_f32 v171, v62, v63
    v_cvt_pk_bf16_f32 v118, v212, v213
    v_cvt_pk_bf16_f32 v119, v214, v215
    v_mfma_f32_16x16x32_bf16 v[228:231], a[84:87], a[100:103], v[228:231]
    buffer_load_dwordx4 a[236:239], v37, s[8:11], s62 offen offset:1024 sc1
    v_accvgpr_read_b32 v56, a152
    v_accvgpr_read_b32 v57, a153
    v_mfma_f32_16x16x32_bf16 a[168:171], a[88:91], a[116:119], a[168:171]
    s_add_u32 s62, s62, 0x20000
    v_accvgpr_read_b32 v58, a154
    v_accvgpr_read_b32 v59, a155
    v_accvgpr_read_b32 v60, a156
    v_mfma_f32_16x16x32_bf16 a[172:175], a[92:95], a[116:119], a[172:175]
    s_waitcnt vmcnt(16)
    s_barrier
    v_cvt_pk_bf16_f32 v120, v120, v121
    v_accvgpr_read_b32 v61, a157
    v_accvgpr_read_b32 v62, a158
    v_mfma_f32_16x16x32_bf16 v[136:139], a[80:83], a[104:107], v[136:139]
    v_cvt_pk_bf16_f32 v121, v122, v123
    v_accvgpr_read_b32 v63, a159
    v_cvt_pk_bf16_f32 v122, v216, v217
    v_mfma_f32_16x16x32_bf16 v[232:235], a[84:87], a[104:107], v[232:235]
    v_cvt_pk_bf16_f32 v172, v56, v57
    v_cvt_pk_bf16_f32 v123, v218, v219
    v_cvt_pk_bf16_f32 v173, v58, v59
    v_mfma_f32_16x16x32_bf16 v[140:143], a[80:83], a[108:111], v[140:143]
    v_cvt_pk_bf16_f32 v124, v124, v125
    v_cvt_pk_bf16_f32 v174, v60, v61
    v_cvt_pk_bf16_f32 v125, v126, v127
    v_mfma_f32_16x16x32_bf16 v[236:239], a[84:87], a[108:111], v[236:239]
    v_cvt_pk_bf16_f32 v175, v62, v63
    v_cvt_pk_bf16_f32 v126, v220, v221
    v_cvt_pk_bf16_f32 v127, v222, v223
    v_mfma_f32_16x16x32_bf16 a[176:179], a[88:91], a[120:123], a[176:179]
    ds_read_b64_tr_b16 a[0:1], v42 offset:0
    v_accvgpr_read_b32 v56, a160
    v_accvgpr_read_b32 v57, a161
    v_mfma_f32_16x16x32_bf16 a[180:183], a[92:95], a[120:123], a[180:183]
    ds_read_b64_tr_b16 a[2:3], v42 offset:1024
    v_accvgpr_read_b32 v58, a162
    v_accvgpr_read_b32 v59, a163
    v_mfma_f32_16x16x32_bf16 v[144:147], a[80:83], a[112:115], v[144:147]
    ds_read_b64_tr_b16 a[4:5], v43 offset:0
    v_accvgpr_read_b32 v60, a164
    v_cvt_pk_bf16_f32 v128, v128, v129
    v_mfma_f32_16x16x32_bf16 v[240:243], a[84:87], a[112:115], v[240:243]
    v_accvgpr_read_b32 v61, a165
    v_accvgpr_read_b32 v62, a166
    v_cvt_pk_bf16_f32 v129, v130, v131
    v_mfma_f32_16x16x32_bf16 v[148:151], a[80:83], a[116:119], v[148:151]
    ds_read_b64_tr_b16 a[6:7], v43 offset:1024
    v_accvgpr_read_b32 v63, a167
    v_cvt_pk_bf16_f32 v130, v224, v225
    v_mfma_f32_16x16x32_bf16 v[244:247], a[84:87], a[116:119], v[244:247]
    v_cvt_pk_bf16_f32 v176, v56, v57
    v_cvt_pk_bf16_f32 v131, v226, v227
    v_cvt_pk_bf16_f32 v177, v58, v59
    v_mfma_f32_16x16x32_bf16 a[184:187], a[88:91], a[124:127], a[184:187]
    ds_read_b64_tr_b16 a[8:9], v44 offset:0
    v_cvt_pk_bf16_f32 v132, v132, v133
    v_cvt_pk_bf16_f32 v178, v60, v61
    v_mfma_f32_16x16x32_bf16 a[188:191], a[92:95], a[124:127], a[188:191]
    ds_read_b64_tr_b16 a[10:11], v44 offset:1024
    v_cvt_pk_bf16_f32 v133, v134, v135
    v_cvt_pk_bf16_f32 v179, v62, v63
    v_mfma_f32_16x16x32_bf16 v[152:155], a[80:83], a[120:123], v[152:155]
    ds_read_b64_tr_b16 a[12:13], v45 offset:0
    v_cvt_pk_bf16_f32 v134, v228, v229
    v_cvt_pk_bf16_f32 v135, v230, v231
    v_mfma_f32_16x16x32_bf16 v[248:251], a[84:87], a[120:123], v[248:251]
    ds_read_b64_tr_b16 a[14:15], v45 offset:1024
    v_accvgpr_read_b32 v56, a168
    v_accvgpr_read_b32 v57, a169
    v_mfma_f32_16x16x32_bf16 v[156:159], a[80:83], a[124:127], v[156:159]
    ds_read_b64_tr_b16 a[16:17], v46 offset:0
    v_accvgpr_read_b32 v58, a170
    v_accvgpr_read_b32 v59, a171
    v_mfma_f32_16x16x32_bf16 v[252:255], a[84:87], a[124:127], v[252:255]
    v_accvgpr_read_b32 v60, a172
    v_cvt_pk_bf16_f32 v136, v136, v137
    v_accvgpr_read_b32 v61, a173
    ds_read_b64_tr_b16 a[18:19], v46 offset:1024
    v_accvgpr_read_b32 v62, a174
    v_cvt_pk_bf16_f32 v137, v138, v139
    v_accvgpr_read_b32 v63, a175
    v_cvt_pk_bf16_f32 v138, v232, v233
    v_cvt_pk_bf16_f32 v180, v56, v57
    ds_read_b64_tr_b16 a[20:21], v47 offset:0
    v_cvt_pk_bf16_f32 v139, v234, v235
    v_cvt_pk_bf16_f32 v181, v58, v59
    v_cvt_pk_bf16_f32 v140, v140, v141
    v_cvt_pk_bf16_f32 v182, v60, v61
    ds_read_b64_tr_b16 a[22:23], v47 offset:1024
    v_cvt_pk_bf16_f32 v141, v142, v143
    v_cvt_pk_bf16_f32 v183, v62, v63
    v_cvt_pk_bf16_f32 v142, v236, v237
    ds_read_b64_tr_b16 a[24:25], v48 offset:0
    v_cvt_pk_bf16_f32 v143, v238, v239
    v_accvgpr_read_b32 v56, a176
    ds_read_b64_tr_b16 a[26:27], v48 offset:1024
    v_accvgpr_read_b32 v57, a177
    v_accvgpr_read_b32 v58, a178
    ds_read_b64_tr_b16 a[28:29], v49 offset:0
    v_accvgpr_read_b32 v59, a179
    v_accvgpr_read_b32 v60, a180
    v_cvt_pk_bf16_f32 v144, v144, v145
    ds_read_b64_tr_b16 a[30:31], v49 offset:1024
    v_accvgpr_read_b32 v61, a181
    v_accvgpr_read_b32 v62, a182
    v_cvt_pk_bf16_f32 v145, v146, v147
    v_accvgpr_read_b32 v63, a183
    v_cvt_pk_bf16_f32 v146, v240, v241
    v_cvt_pk_bf16_f32 v184, v56, v57
    v_cvt_pk_bf16_f32 v147, v242, v243
    v_cvt_pk_bf16_f32 v185, v58, v59
    v_cvt_pk_bf16_f32 v148, v148, v149
    v_cvt_pk_bf16_f32 v186, v60, v61
    v_cvt_pk_bf16_f32 v149, v150, v151
    v_cvt_pk_bf16_f32 v187, v62, v63
    v_cvt_pk_bf16_f32 v150, v244, v245
    v_cvt_pk_bf16_f32 v151, v246, v247
    v_accvgpr_read_b32 v56, a184
    v_accvgpr_read_b32 v57, a185
    v_accvgpr_read_b32 v58, a186
    v_accvgpr_read_b32 v59, a187
    v_accvgpr_read_b32 v60, a188
    v_cvt_pk_bf16_f32 v152, v152, v153
    v_accvgpr_read_b32 v61, a189
    v_accvgpr_read_b32 v62, a190
    v_cvt_pk_bf16_f32 v153, v154, v155
    v_accvgpr_read_b32 v63, a191
    v_cvt_pk_bf16_f32 v154, v248, v249
    v_cvt_pk_bf16_f32 v188, v56, v57
    v_cvt_pk_bf16_f32 v155, v250, v251
    v_cvt_pk_bf16_f32 v189, v58, v59
    v_cvt_pk_bf16_f32 v156, v156, v157
    v_cvt_pk_bf16_f32 v190, v60, v61
    v_cvt_pk_bf16_f32 v157, v158, v159
    v_cvt_pk_bf16_f32 v191, v62, v63
    v_cvt_pk_bf16_f32 v158, v252, v253
    v_cvt_pk_bf16_f32 v159, v254, v255
k12_join_6:
    s_waitcnt vmcnt(12) lgkmcnt(0)
    v_mfma_f32_16x16x32_bf16 v[192:195], a[0:3], a[192:195], 0
    ds_read_b64_tr_b16 a[32:33], v42 offset:8192
    ds_read_b64_tr_b16 a[34:35], v42 offset:9216
    v_mfma_f32_16x16x32_bf16 v[196:199], a[0:3], a[196:199], 0
    buffer_load_dwordx4 a[240:243], v36, s[8:11], s62 offen offset:0 sc1
    v_mfma_f32_16x16x32_bf16 a[64:67], a[0:3], a[200:203], 0
    ds_read_b64_tr_b16 a[36:37], v43 offset:8192
    v_mfma_f32_16x16x32_bf16 a[68:71], a[0:3], a[204:207], 0
    ds_read_b64_tr_b16 a[38:39], v43 offset:9216
    v_mfma_f32_16x16x32_bf16 v[200:203], a[4:7], a[192:195], 0
    ds_read_b64_tr_b16 a[40:41], v44 offset:8192
    v_mfma_f32_16x16x32_bf16 v[204:207], a[4:7], a[196:199], 0
    v_mfma_f32_16x16x32_bf16 a[72:75], a[4:7], a[200:203], 0
    s_lshl_b32 s31, s28, 14
    buffer_load_dwordx4 a[244:247], v36, s[8:11], s62 offen offset:1024 sc1
    ds_read_b64_tr_b16 a[42:43], v44 offset:9216
    v_mfma_f32_16x16x32_bf16 a[76:79], a[4:7], a[204:207], 0
    s_add_u32 s16, s6, s31
    s_addc_u32 s17, s7, 0
    ds_read_b64_tr_b16 a[44:45], v45 offset:8192
    v_mfma_f32_16x16x32_bf16 v[208:211], a[8:11], a[192:195], 0
    v_mfma_f32_16x16x32_bf16 v[212:215], a[8:11], a[196:199], 0
    s_add_u32 s20, s16, 0x2000000
    s_addc_u32 s21, s17, 0
    ds_read_b64_tr_b16 a[46:47], v45 offset:9216
    v_mfma_f32_16x16x32_bf16 a[80:83], a[8:11], a[200:203], 0
    ds_read_b64_tr_b16 a[48:49], v46 offset:8192
    v_mfma_f32_16x16x32_bf16 a[84:87], a[8:11], a[204:207], 0
    s_add_u32 s16, s16, 0x1000000
    s_addc_u32 s17, s17, 0
    ds_read_b64_tr_b16 a[50:51], v46 offset:9216
    v_mfma_f32_16x16x32_bf16 v[216:219], a[12:15], a[192:195], 0
    buffer_load_dwordx4 a[248:251], v37, s[8:11], s62 offen offset:0 sc1
    v_mfma_f32_16x16x32_bf16 v[220:223], a[12:15], a[196:199], 0
    s_and_b32 s17, s17, 0xffff
    ds_read_b64_tr_b16 a[52:53], v47 offset:8192
    v_mfma_f32_16x16x32_bf16 a[88:91], a[12:15], a[200:203], 0
    ds_read_b64_tr_b16 a[54:55], v47 offset:9216
    v_mfma_f32_16x16x32_bf16 a[92:95], a[12:15], a[204:207], 0
    s_and_b32 s21, s21, 0xffff
    ds_read_b64_tr_b16 a[56:57], v48 offset:8192
    v_mfma_f32_16x16x32_bf16 v[224:227], a[16:19], a[192:195], 0
    v_mfma_f32_16x16x32_bf16 v[228:231], a[16:19], a[196:199], 0
    s_lshl_b32 s31, s29, 20
    buffer_load_dwordx4 a[252:255], v37, s[8:11], s62 offen offset:1024 sc1
    ds_read_b64_tr_b16 a[58:59], v48 offset:9216
    v_mfma_f32_16x16x32_bf16 a[96:99], a[16:19], a[200:203], 0
    ds_read_b64_tr_b16 a[60:61], v49 offset:8192
    v_mfma_f32_16x16x32_bf16 a[100:103], a[16:19], a[204:207], 0
    s_sub_u32 s18, 0xf84000, s31
    v_mfma_f32_16x16x32_bf16 v[232:235], a[20:23], a[192:195], 0
    ds_read_b64_tr_b16 a[62:63], v49 offset:9216
    v_mfma_f32_16x16x32_bf16 v[236:239], a[20:23], a[196:199], 0
    s_mov_b32 s22, s18
    v_mfma_f32_16x16x32_bf16 a[104:107], a[20:23], a[200:203], 0
    s_add_u32 s62, s62, 0x20000
    v_mfma_f32_16x16x32_bf16 a[108:111], a[20:23], a[204:207], 0
    s_add_u32 s52, s47, 0
    v_mfma_f32_16x16x32_bf16 v[240:243], a[24:27], a[192:195], 0
    s_add_u32 s24, s6, 0x4806000
    s_addc_u32 s25, s7, 0
    buffer_store_dwordx4 v[64:67], v1, s[32:35], s52 offen offset:0 sc1
    v_mfma_f32_16x16x32_bf16 v[244:247], a[24:27], a[196:199], 0
    s_and_b32 s25, s25, 0xffff
    v_mfma_f32_16x16x32_bf16 a[112:115], a[24:27], a[200:203], 0
    v_mfma_f32_16x16x32_bf16 a[116:119], a[24:27], a[204:207], 0
    s_mov_b32 s26, 4096
    v_mfma_f32_16x16x32_bf16 v[248:251], a[28:31], a[192:195], 0
    v_mfma_f32_16x16x32_bf16 v[252:255], a[28:31], a[196:199], 0
    v_mfma_f32_16x16x32_bf16 a[120:123], a[28:31], a[200:203], 0
    v_mfma_f32_16x16x32_bf16 a[124:127], a[28:31], a[204:207], 0
    s_waitcnt vmcnt(9) lgkmcnt(0)
    s_barrier
    v_mfma_f32_16x16x32_bf16 v[192:195], a[32:35], a[208:211], v[192:195]
    ds_read_b64_tr_b16 a[0:1], v42 offset:16384
    ds_read_b64_tr_b16 a[2:3], v42 offset:17408
    v_mfma_f32_16x16x32_bf16 v[196:199], a[32:35], a[212:215], v[196:199]
    s_add_u32 m0, s60, 131072
    v_mfma_f32_16x16x32_bf16 a[64:67], a[32:35], a[216:219], a[64:67]
    buffer_load_dwordx4 v38, s[12:15], s61 offen offset:0 lds
    ds_read_b64_tr_b16 a[4:5], v43 offset:16384
    v_mfma_f32_16x16x32_bf16 a[68:71], a[32:35], a[220:223], a[68:71]
    ds_read_b64_tr_b16 a[6:7], v43 offset:17408
    v_mfma_f32_16x16x32_bf16 v[200:203], a[36:39], a[208:211], v[200:203]
    buffer_load_dwordx4 v39, s[12:15], s61 offen offset:1024 lds
    ds_read_b64_tr_b16 a[8:9], v44 offset:16384
    v_mfma_f32_16x16x32_bf16 v[204:207], a[36:39], a[212:215], v[204:207]
    v_mfma_f32_16x16x32_bf16 a[72:75], a[36:39], a[216:219], a[72:75]
    buffer_load_dwordx4 v40, s[12:15], s61 offen offset:2048 lds
    ds_read_b64_tr_b16 a[10:11], v44 offset:17408
    v_mfma_f32_16x16x32_bf16 a[76:79], a[36:39], a[220:223], a[76:79]
    ds_read_b64_tr_b16 a[12:13], v45 offset:16384
    v_mfma_f32_16x16x32_bf16 v[208:211], a[40:43], a[208:211], v[208:211]
    v_mfma_f32_16x16x32_bf16 v[212:215], a[40:43], a[212:215], v[212:215]
    buffer_load_dwordx4 v41, s[12:15], s61 offen offset:3072 lds
    ds_read_b64_tr_b16 a[14:15], v45 offset:17408
    v_mfma_f32_16x16x32_bf16 a[80:83], a[40:43], a[216:219], a[80:83]
    ds_read_b64_tr_b16 a[16:17], v46 offset:16384
    v_mfma_f32_16x16x32_bf16 a[84:87], a[40:43], a[220:223], a[84:87]
    s_add_u32 s61, s61, 0x80000
    ds_read_b64_tr_b16 a[18:19], v46 offset:17408
    v_mfma_f32_16x16x32_bf16 v[216:219], a[44:47], a[208:211], v[216:219]
    buffer_load_dwordx4 a[192:195], v36, s[8:11], s62 offen offset:0 sc1
    v_mfma_f32_16x16x32_bf16 v[220:223], a[44:47], a[212:215], v[220:223]
    ds_read_b64_tr_b16 a[20:21], v47 offset:16384
    v_mfma_f32_16x16x32_bf16 a[88:91], a[44:47], a[216:219], a[88:91]
    buffer_load_dwordx4 a[196:199], v36, s[8:11], s62 offen offset:1024 sc1
    ds_read_b64_tr_b16 a[22:23], v47 offset:17408
    v_mfma_f32_16x16x32_bf16 a[92:95], a[44:47], a[220:223], a[92:95]
    ds_read_b64_tr_b16 a[24:25], v48 offset:16384
    v_mfma_f32_16x16x32_bf16 v[224:227], a[48:51], a[208:211], v[224:227]
    v_mfma_f32_16x16x32_bf16 v[228:231], a[48:51], a[212:215], v[228:231]
    buffer_load_dwordx4 a[200:203], v37, s[8:11], s62 offen offset:0 sc1
    ds_read_b64_tr_b16 a[26:27], v48 offset:17408
    v_mfma_f32_16x16x32_bf16 a[96:99], a[48:51], a[216:219], a[96:99]
    ds_read_b64_tr_b16 a[28:29], v49 offset:16384
    v_mfma_f32_16x16x32_bf16 a[100:103], a[48:51], a[220:223], a[100:103]
    v_mfma_f32_16x16x32_bf16 v[232:235], a[52:55], a[208:211], v[232:235]
    buffer_load_dwordx4 a[204:207], v37, s[8:11], s62 offen offset:1024 sc1
    ds_read_b64_tr_b16 a[30:31], v49 offset:17408
    v_mfma_f32_16x16x32_bf16 v[236:239], a[52:55], a[212:215], v[236:239]
    v_mfma_f32_16x16x32_bf16 a[104:107], a[52:55], a[216:219], a[104:107]
    s_add_u32 s62, s62, 0x20000
    v_mfma_f32_16x16x32_bf16 a[108:111], a[52:55], a[220:223], a[108:111]
    s_add_u32 s52, s47, 0
    v_mfma_f32_16x16x32_bf16 v[240:243], a[56:59], a[208:211], v[240:243]
    buffer_store_dwordx4 v[68:71], v1, s[32:35], s52 offen offset:1024 sc1
    v_mfma_f32_16x16x32_bf16 v[244:247], a[56:59], a[212:215], v[244:247]
    s_add_u32 s52, s47, 0
    v_mfma_f32_16x16x32_bf16 a[112:115], a[56:59], a[216:219], a[112:115]
    buffer_store_dwordx4 v[72:75], v1, s[32:35], s52 offen offset:2048 sc1
    v_mfma_f32_16x16x32_bf16 a[116:119], a[56:59], a[220:223], a[116:119]
    v_mfma_f32_16x16x32_bf16 v[248:251], a[60:63], a[208:211], v[248:251]
    v_mfma_f32_16x16x32_bf16 v[252:255], a[60:63], a[212:215], v[252:255]
    v_mfma_f32_16x16x32_bf16 a[120:123], a[60:63], a[216:219], a[120:123]
    v_mfma_f32_16x16x32_bf16 a[124:127], a[60:63], a[220:223], a[124:127]
    s_waitcnt vmcnt(15) lgkmcnt(0)
    v_mfma_f32_16x16x32_bf16 v[192:195], a[0:3], a[224:227], v[192:195]
    ds_read_b64_tr_b16 a[32:33], v42 offset:24576
    ds_read_b64_tr_b16 a[34:35], v42 offset:25600
    v_mfma_f32_16x16x32_bf16 v[196:199], a[0:3], a[228:231], v[196:199]
    buffer_load_dwordx4 a[208:211], v36, s[8:11], s62 offen offset:0 sc1
    v_mfma_f32_16x16x32_bf16 a[64:67], a[0:3], a[232:235], a[64:67]
    ds_read_b64_tr_b16 a[36:37], v43 offset:24576
    v_mfma_f32_16x16x32_bf16 a[68:71], a[0:3], a[236:239], a[68:71]
    ds_read_b64_tr_b16 a[38:39], v43 offset:25600
    v_mfma_f32_16x16x32_bf16 v[200:203], a[4:7], a[224:227], v[200:203]
    ds_read_b64_tr_b16 a[40:41], v44 offset:24576
    v_mfma_f32_16x16x32_bf16 v[204:207], a[4:7], a[228:231], v[204:207]
    v_mfma_f32_16x16x32_bf16 a[72:75], a[4:7], a[232:235], a[72:75]
    buffer_load_dwordx4 a[212:215], v36, s[8:11], s62 offen offset:1024 sc1
    ds_read_b64_tr_b16 a[42:43], v44 offset:25600
    v_mfma_f32_16x16x32_bf16 a[76:79], a[4:7], a[236:239], a[76:79]
    ds_read_b64_tr_b16 a[44:45], v45 offset:24576
    v_mfma_f32_16x16x32_bf16 v[208:211], a[8:11], a[224:227], v[208:211]
    v_mfma_f32_16x16x32_bf16 v[212:215], a[8:11], a[228:231], v[212:215]
    ds_read_b64_tr_b16 a[46:47], v45 offset:25600
    v_mfma_f32_16x16x32_bf16 a[80:83], a[8:11], a[232:235], a[80:83]
    ds_read_b64_tr_b16 a[48:49], v46 offset:24576
    v_mfma_f32_16x16x32_bf16 a[84:87], a[8:11], a[236:239], a[84:87]
    ds_read_b64_tr_b16 a[50:51], v46 offset:25600
    v_mfma_f32_16x16x32_bf16 v[216:219], a[12:15], a[224:227], v[216:219]
    buffer_load_dwordx4 a[216:219], v37, s[8:11], s62 offen offset:0 sc1
    v_mfma_f32_16x16x32_bf16 v[220:223], a[12:15], a[228:231], v[220:223]
    ds_read_b64_tr_b16 a[52:53], v47 offset:24576
    v_mfma_f32_16x16x32_bf16 a[88:91], a[12:15], a[232:235], a[88:91]
    ds_read_b64_tr_b16 a[54:55], v47 offset:25600
    v_mfma_f32_16x16x32_bf16 a[92:95], a[12:15], a[236:239], a[92:95]
    ds_read_b64_tr_b16 a[56:57], v48 offset:24576
    v_mfma_f32_16x16x32_bf16 v[224:227], a[16:19], a[224:227], v[224:227]
    v_mfma_f32_16x16x32_bf16 v[228:231], a[16:19], a[228:231], v[228:231]
    buffer_load_dwordx4 a[220:223], v37, s[8:11], s62 offen offset:1024 sc1
    ds_read_b64_tr_b16 a[58:59], v48 offset:25600
    v_mfma_f32_16x16x32_bf16 a[96:99], a[16:19], a[232:235], a[96:99]
    ds_read_b64_tr_b16 a[60:61], v49 offset:24576
    v_mfma_f32_16x16x32_bf16 a[100:103], a[16:19], a[236:239], a[100:103]
    v_mfma_f32_16x16x32_bf16 v[232:235], a[20:23], a[224:227], v[232:235]
    ds_read_b64_tr_b16 a[62:63], v49 offset:25600
    v_mfma_f32_16x16x32_bf16 v[236:239], a[20:23], a[228:231], v[236:239]
    v_mfma_f32_16x16x32_bf16 a[104:107], a[20:23], a[232:235], a[104:107]
    s_add_u32 s62, s62, 0x20000
    v_mfma_f32_16x16x32_bf16 a[108:111], a[20:23], a[236:239], a[108:111]
    s_add_u32 s52, s47, 0
    v_mfma_f32_16x16x32_bf16 v[240:243], a[24:27], a[224:227], v[240:243]
    buffer_store_dwordx4 v[76:79], v1, s[32:35], s52 offen offset:3072 sc1
    v_mfma_f32_16x16x32_bf16 v[244:247], a[24:27], a[228:231], v[244:247]
    v_mfma_f32_16x16x32_bf16 a[112:115], a[24:27], a[232:235], a[112:115]
    v_mfma_f32_16x16x32_bf16 a[116:119], a[24:27], a[236:239], a[116:119]
    v_mfma_f32_16x16x32_bf16 v[248:251], a[28:31], a[224:227], v[248:251]
    v_mfma_f32_16x16x32_bf16 v[252:255], a[28:31], a[228:231], v[252:255]
    v_mfma_f32_16x16x32_bf16 a[120:123], a[28:31], a[232:235], a[120:123]
    v_mfma_f32_16x16x32_bf16 a[124:127], a[28:31], a[236:239], a[124:127]
    s_waitcnt vmcnt(11) lgkmcnt(0)
    s_barrier
    v_mfma_f32_16x16x32_bf16 v[192:195], a[32:35], a[240:243], v[192:195]
    ds_read_b64_tr_b16 a[0:1], v42 offset:32768
    ds_read_b64_tr_b16 a[2:3], v42 offset:33792
    v_mfma_f32_16x16x32_bf16 v[196:199], a[32:35], a[244:247], v[196:199]
    s_add_u32 m0, s60, 147456
    v_mfma_f32_16x16x32_bf16 a[64:67], a[32:35], a[248:251], a[64:67]
    buffer_load_dwordx4 v38, s[12:15], s61 offen offset:0 lds
    ds_read_b64_tr_b16 a[4:5], v43 offset:32768
    v_mfma_f32_16x16x32_bf16 a[68:71], a[32:35], a[252:255], a[68:71]
    ds_read_b64_tr_b16 a[6:7], v43 offset:33792
    v_mfma_f32_16x16x32_bf16 v[200:203], a[36:39], a[240:243], v[200:203]
    buffer_load_dwordx4 v39, s[12:15], s61 offen offset:1024 lds
    ds_read_b64_tr_b16 a[8:9], v44 offset:32768
    v_mfma_f32_16x16x32_bf16 v[204:207], a[36:39], a[244:247], v[204:207]
    v_mfma_f32_16x16x32_bf16 a[72:75], a[36:39], a[248:251], a[72:75]
    buffer_load_dwordx4 v40, s[12:15], s61 offen offset:2048 lds
    ds_read_b64_tr_b16 a[10:11], v44 offset:33792
    v_mfma_f32_16x16x32_bf16 a[76:79], a[36:39], a[252:255], a[76:79]
    ds_read_b64_tr_b16 a[12:13], v45 offset:32768
    v_mfma_f32_16x16x32_bf16 v[208:211], a[40:43], a[240:243], v[208:211]
    v_mfma_f32_16x16x32_bf16 v[212:215], a[40:43], a[244:247], v[212:215]
    buffer_load_dwordx4 v41, s[12:15], s61 offen offset:3072 lds
    ds_read_b64_tr_b16 a[14:15], v45 offset:33792
    v_mfma_f32_16x16x32_bf16 a[80:83], a[40:43], a[248:251], a[80:83]
    ds_read_b64_tr_b16 a[16:17], v46 offset:32768
    v_mfma_f32_16x16x32_bf16 a[84:87], a[40:43], a[252:255], a[84:87]
    s_add_u32 s61, s61, 0x80000
    ds_read_b64_tr_b16 a[18:19], v46 offset:33792
    v_mfma_f32_16x16x32_bf16 v[216:219], a[44:47], a[240:243], v[216:219]
    buffer_load_dwordx4 a[224:227], v36, s[8:11], s62 offen offset:0 sc1
    v_mfma_f32_16x16x32_bf16 v[220:223], a[44:47], a[244:247], v[220:223]
    ds_read_b64_tr_b16 a[20:21], v47 offset:32768
    v_mfma_f32_16x16x32_bf16 a[88:91], a[44:47], a[248:251], a[88:91]
    buffer_load_dwordx4 a[228:231], v36, s[8:11], s62 offen offset:1024 sc1
    ds_read_b64_tr_b16 a[22:23], v47 offset:33792
    v_mfma_f32_16x16x32_bf16 a[92:95], a[44:47], a[252:255], a[92:95]
    ds_read_b64_tr_b16 a[24:25], v48 offset:32768
    v_mfma_f32_16x16x32_bf16 v[224:227], a[48:51], a[240:243], v[224:227]
    v_mfma_f32_16x16x32_bf16 v[228:231], a[48:51], a[244:247], v[228:231]
    buffer_load_dwordx4 a[232:235], v37, s[8:11], s62 offen offset:0 sc1
    ds_read_b64_tr_b16 a[26:27], v48 offset:33792
    v_mfma_f32_16x16x32_bf16 a[96:99], a[48:51], a[248:251], a[96:99]
    ds_read_b64_tr_b16 a[28:29], v49 offset:32768
    v_mfma_f32_16x16x32_bf16 a[100:103], a[48:51], a[252:255], a[100:103]
    v_mfma_f32_16x16x32_bf16 v[232:235], a[52:55], a[240:243], v[232:235]
    buffer_load_dwordx4 a[236:239], v37, s[8:11], s62 offen offset:1024 sc1
    ds_read_b64_tr_b16 a[30:31], v49 offset:33792
    v_mfma_f32_16x16x32_bf16 v[236:239], a[52:55], a[244:247], v[236:239]
    v_mfma_f32_16x16x32_bf16 a[104:107], a[52:55], a[248:251], a[104:107]
    s_add_u32 s62, s62, 0x20000
    v_mfma_f32_16x16x32_bf16 a[108:111], a[52:55], a[252:255], a[108:111]
    s_add_u32 s52, s47, 4096
    v_mfma_f32_16x16x32_bf16 v[240:243], a[56:59], a[240:243], v[240:243]
    buffer_store_dwordx4 v[80:83], v1, s[32:35], s52 offen offset:0 sc1
    v_mfma_f32_16x16x32_bf16 v[244:247], a[56:59], a[244:247], v[244:247]
    s_add_u32 s52, s47, 4096
    v_mfma_f32_16x16x32_bf16 a[112:115], a[56:59], a[248:251], a[112:115]
    buffer_store_dwordx4 v[84:87], v1, s[32:35], s52 offen offset:1024 sc1
    v_mfma_f32_16x16x32_bf16 a[116:119], a[56:59], a[252:255], a[116:119]
    v_mfma_f32_16x16x32_bf16 v[248:251], a[60:63], a[240:243], v[248:251]
    v_mfma_f32_16x16x32_bf16 v[252:255], a[60:63], a[244:247], v[252:255]
    v_mfma_f32_16x16x32_bf16 a[120:123], a[60:63], a[248:251], a[120:123]
    v_mfma_f32_16x16x32_bf16 a[124:127], a[60:63], a[252:255], a[124:127]
    s_waitcnt vmcnt(17) lgkmcnt(0)
    v_mfma_f32_16x16x32_bf16 v[192:195], a[0:3], a[192:195], v[192:195]
    ds_read_b64_tr_b16 a[32:33], v42 offset:40960
    ds_read_b64_tr_b16 a[34:35], v42 offset:41984
    v_mfma_f32_16x16x32_bf16 v[196:199], a[0:3], a[196:199], v[196:199]
    buffer_load_dwordx4 a[240:243], v36, s[8:11], s62 offen offset:0 sc1
    v_mfma_f32_16x16x32_bf16 a[64:67], a[0:3], a[200:203], a[64:67]
    ds_read_b64_tr_b16 a[36:37], v43 offset:40960
    v_mfma_f32_16x16x32_bf16 a[68:71], a[0:3], a[204:207], a[68:71]
    ds_read_b64_tr_b16 a[38:39], v43 offset:41984
    v_mfma_f32_16x16x32_bf16 v[200:203], a[4:7], a[192:195], v[200:203]
    ds_read_b64_tr_b16 a[40:41], v44 offset:40960
    v_mfma_f32_16x16x32_bf16 v[204:207], a[4:7], a[196:199], v[204:207]
    buffer_load_dwordx4 a[244:247], v36, s[8:11], s62 offen offset:1024 sc1
    v_mfma_f32_16x16x32_bf16 a[72:75], a[4:7], a[200:203], a[72:75]
    ds_read_b64_tr_b16 a[42:43], v44 offset:41984
    v_mfma_f32_16x16x32_bf16 a[76:79], a[4:7], a[204:207], a[76:79]
    ds_read_b64_tr_b16 a[44:45], v45 offset:40960
    v_mfma_f32_16x16x32_bf16 v[208:211], a[8:11], a[192:195], v[208:211]
    v_mfma_f32_16x16x32_bf16 v[212:215], a[8:11], a[196:199], v[212:215]
    ds_read_b64_tr_b16 a[46:47], v45 offset:41984
    v_mfma_f32_16x16x32_bf16 a[80:83], a[8:11], a[200:203], a[80:83]
    buffer_load_dwordx4 a[248:251], v37, s[8:11], s62 offen offset:0 sc1
    ds_read_b64_tr_b16 a[48:49], v46 offset:40960
    v_mfma_f32_16x16x32_bf16 a[84:87], a[8:11], a[204:207], a[84:87]
    ds_read_b64_tr_b16 a[50:51], v46 offset:41984
    v_mfma_f32_16x16x32_bf16 v[216:219], a[12:15], a[192:195], v[216:219]
    v_mfma_f32_16x16x32_bf16 v[220:223], a[12:15], a[196:199], v[220:223]
    ds_read_b64_tr_b16 a[52:53], v47 offset:40960
    v_mfma_f32_16x16x32_bf16 a[88:91], a[12:15], a[200:203], a[88:91]
    buffer_load_dwordx4 a[252:255], v37, s[8:11], s62 offen offset:1024 sc1
    ds_read_b64_tr_b16 a[54:55], v47 offset:41984
    v_mfma_f32_16x16x32_bf16 a[92:95], a[12:15], a[204:207], a[92:95]
    ds_read_b64_tr_b16 a[56:57], v48 offset:40960
    v_mfma_f32_16x16x32_bf16 v[224:227], a[16:19], a[192:195], v[224:227]
    v_mfma_f32_16x16x32_bf16 v[228:231], a[16:19], a[196:199], v[228:231]
    ds_read_b64_tr_b16 a[58:59], v48 offset:41984
    v_mfma_f32_16x16x32_bf16 a[96:99], a[16:19], a[200:203], a[96:99]
    s_add_u32 s62, s62, 0x20000
    ds_read_b64_tr_b16 a[60:61], v49 offset:40960
    v_mfma_f32_16x16x32_bf16 a[100:103], a[16:19], a[204:207], a[100:103]
    s_add_u32 s52, s47, 4096
    v_mfma_f32_16x16x32_bf16 v[232:235], a[20:23], a[192:195], v[232:235]
    buffer_store_dwordx4 v[88:91], v1, s[32:35], s52 offen offset:2048 sc1
    ds_read_b64_tr_b16 a[62:63], v49 offset:41984
    v_mfma_f32_16x16x32_bf16 v[236:239], a[20:23], a[196:199], v[236:239]
    s_add_u32 s52, s47, 4096
    v_mfma_f32_16x16x32_bf16 a[104:107], a[20:23], a[200:203], a[104:107]
    v_mfma_f32_16x16x32_bf16 a[108:111], a[20:23], a[204:207], a[108:111]
    buffer_store_dwordx4 v[92:95], v1, s[32:35], s52 offen offset:3072 sc1
    v_mfma_f32_16x16x32_bf16 v[240:243], a[24:27], a[192:195], v[240:243]
    v_mfma_f32_16x16x32_bf16 v[244:247], a[24:27], a[196:199], v[244:247]
    v_mfma_f32_16x16x32_bf16 a[112:115], a[24:27], a[200:203], a[112:115]
    v_mfma_f32_16x16x32_bf16 a[116:119], a[24:27], a[204:207], a[116:119]
    v_mfma_f32_16x16x32_bf16 v[248:251], a[28:31], a[192:195], v[248:251]
    v_mfma_f32_16x16x32_bf16 v[252:255], a[28:31], a[196:199], v[252:255]
    v_mfma_f32_16x16x32_bf16 a[120:123], a[28:31], a[200:203], a[120:123]
    v_mfma_f32_16x16x32_bf16 a[124:127], a[28:31], a[204:207], a[124:127]
    s_waitcnt vmcnt(12) lgkmcnt(0)
    s_barrier
    v_mfma_f32_16x16x32_bf16 v[192:195], a[32:35], a[208:211], v[192:195]
    ds_read_b64_tr_b16 a[0:1], v42 offset:49152
    ds_read_b64_tr_b16 a[2:3], v42 offset:50176
    v_mfma_f32_16x16x32_bf16 v[196:199], a[32:35], a[212:215], v[196:199]
    s_add_u32 m0, s60, 98304
    v_mfma_f32_16x16x32_bf16 a[64:67], a[32:35], a[216:219], a[64:67]
    buffer_load_dwordx4 v38, s[12:15], s61 offen offset:0 lds
    ds_read_b64_tr_b16 a[4:5], v43 offset:49152
    v_mfma_f32_16x16x32_bf16 a[68:71], a[32:35], a[220:223], a[68:71]
    ds_read_b64_tr_b16 a[6:7], v43 offset:50176
    v_mfma_f32_16x16x32_bf16 v[200:203], a[36:39], a[208:211], v[200:203]
    buffer_load_dwordx4 v39, s[12:15], s61 offen offset:1024 lds
    ds_read_b64_tr_b16 a[8:9], v44 offset:49152
    v_mfma_f32_16x16x32_bf16 v[204:207], a[36:39], a[212:215], v[204:207]
    v_mfma_f32_16x16x32_bf16 a[72:75], a[36:39], a[216:219], a[72:75]
    ds_read_b64_tr_b16 a[10:11], v44 offset:50176
    v_mfma_f32_16x16x32_bf16 a[76:79], a[36:39], a[220:223], a[76:79]
    buffer_load_dwordx4 v40, s[12:15], s61 offen offset:2048 lds
    ds_read_b64_tr_b16 a[12:13], v45 offset:49152
    v_mfma_f32_16x16x32_bf16 v[208:211], a[40:43], a[208:211], v[208:211]
    v_mfma_f32_16x16x32_bf16 v[212:215], a[40:43], a[212:215], v[212:215]
    ds_read_b64_tr_b16 a[14:15], v45 offset:50176
    v_mfma_f32_16x16x32_bf16 a[80:83], a[40:43], a[216:219], a[80:83]
    buffer_load_dwordx4 v41, s[12:15], s61 offen offset:3072 lds
    ds_read_b64_tr_b16 a[16:17], v46 offset:49152
    v_mfma_f32_16x16x32_bf16 a[84:87], a[40:43], a[220:223], a[84:87]
    ds_read_b64_tr_b16 a[18:19], v46 offset:50176
    v_mfma_f32_16x16x32_bf16 v[216:219], a[44:47], a[208:211], v[216:219]
    s_add_u32 s61, s61, 0x80000
    v_mfma_f32_16x16x32_bf16 v[220:223], a[44:47], a[212:215], v[220:223]
    buffer_load_dwordx4 a[192:195], v36, s[8:11], s62 offen offset:0 sc1
    ds_read_b64_tr_b16 a[20:21], v47 offset:49152
    v_mfma_f32_16x16x32_bf16 a[88:91], a[44:47], a[216:219], a[88:91]
    ds_read_b64_tr_b16 a[22:23], v47 offset:50176
    v_mfma_f32_16x16x32_bf16 a[92:95], a[44:47], a[220:223], a[92:95]
    ds_read_b64_tr_b16 a[24:25], v48 offset:49152
    v_mfma_f32_16x16x32_bf16 v[224:227], a[48:51], a[208:211], v[224:227]
    buffer_load_dwordx4 a[196:199], v36, s[8:11], s62 offen offset:1024 sc1
    v_mfma_f32_16x16x32_bf16 v[228:231], a[48:51], a[212:215], v[228:231]
    ds_read_b64_tr_b16 a[26:27], v48 offset:50176
    v_mfma_f32_16x16x32_bf16 a[96:99], a[48:51], a[216:219], a[96:99]
    ds_read_b64_tr_b16 a[28:29], v49 offset:49152
    v_mfma_f32_16x16x32_bf16 a[100:103], a[48:51], a[220:223], a[100:103]
    buffer_load_dwordx4 a[200:203], v37, s[8:11], s62 offen offset:0 sc1
    v_mfma_f32_16x16x32_bf16 v[232:235], a[52:55], a[208:211], v[232:235]
    ds_read_b64_tr_b16 a[30:31], v49 offset:50176
    v_mfma_f32_16x16x32_bf16 v[236:239], a[52:55], a[212:215], v[236:239]
    v_mfma_f32_16x16x32_bf16 a[104:107], a[52:55], a[216:219], a[104:107]
    buffer_load_dwordx4 a[204:207], v37, s[8:11], s62 offen offset:1024 sc1
    v_mfma_f32_16x16x32_bf16 a[108:111], a[52:55], a[220:223], a[108:111]
    v_mfma_f32_16x16x32_bf16 v[240:243], a[56:59], a[208:211], v[240:243]
    s_add_u32 s62, s62, 0x20000
    v_mfma_f32_16x16x32_bf16 v[244:247], a[56:59], a[212:215], v[244:247]
    s_add_u32 s52, s47, 8192
    v_mfma_f32_16x16x32_bf16 a[112:115], a[56:59], a[216:219], a[112:115]
    buffer_store_dwordx4 v[96:99], v1, s[32:35], s52 offen offset:0 sc1
    v_mfma_f32_16x16x32_bf16 a[116:119], a[56:59], a[220:223], a[116:119]
    v_mfma_f32_16x16x32_bf16 v[248:251], a[60:63], a[208:211], v[248:251]
    v_mfma_f32_16x16x32_bf16 v[252:255], a[60:63], a[212:215], v[252:255]
    v_mfma_f32_16x16x32_bf16 a[120:123], a[60:63], a[216:219], a[120:123]
    v_mfma_f32_16x16x32_bf16 a[124:127], a[60:63], a[220:223], a[124:127]
    s_waitcnt vmcnt(17) lgkmcnt(0)
    v_mfma_f32_16x16x32_bf16 v[192:195], a[0:3], a[224:227], v[192:195]
    ds_read_b64_tr_b16 a[32:33], v42 offset:57344
    ds_read_b64_tr_b16 a[34:35], v42 offset:58368
    v_mfma_f32_16x16x32_bf16 v[196:199], a[0:3], a[228:231], v[196:199]
    buffer_load_dwordx4 a[208:211], v36, s[8:11], s62 offen offset:0 sc1
    v_mfma_f32_16x16x32_bf16 a[64:67], a[0:3], a[232:235], a[64:67]
    ds_read_b64_tr_b16 a[36:37], v43 offset:57344
    v_mfma_f32_16x16x32_bf16 a[68:71], a[0:3], a[236:239], a[68:71]
    ds_read_b64_tr_b16 a[38:39], v43 offset:58368
    v_mfma_f32_16x16x32_bf16 v[200:203], a[4:7], a[224:227], v[200:203]
    ds_read_b64_tr_b16 a[40:41], v44 offset:57344
    v_mfma_f32_16x16x32_bf16 v[204:207], a[4:7], a[228:231], v[204:207]
    buffer_load_dwordx4 a[212:215], v36, s[8:11], s62 offen offset:1024 sc1
    v_mfma_f32_16x16x32_bf16 a[72:75], a[4:7], a[232:235], a[72:75]
    ds_read_b64_tr_b16 a[42:43], v44 offset:58368
    v_mfma_f32_16x16x32_bf16 a[76:79], a[4:7], a[236:239], a[76:79]
    ds_read_b64_tr_b16 a[44:45], v45 offset:57344
    v_mfma_f32_16x16x32_bf16 v[208:211], a[8:11], a[224:227], v[208:211]
    v_mfma_f32_16x16x32_bf16 v[212:215], a[8:11], a[228:231], v[212:215]
    ds_read_b64_tr_b16 a[46:47], v45 offset:58368
    v_mfma_f32_16x16x32_bf16 a[80:83], a[8:11], a[232:235], a[80:83]
    buffer_load_dwordx4 a[216:219], v37, s[8:11], s62 offen offset:0 sc1
    ds_read_b64_tr_b16 a[48:49], v46 offset:57344
    v_mfma_f32_16x16x32_bf16 a[84:87], a[8:11], a[236:239], a[84:87]
    ds_read_b64_tr_b16 a[50:51], v46 offset:58368
    v_mfma_f32_16x16x32_bf16 v[216:219], a[12:15], a[224:227], v[216:219]
    v_mfma_f32_16x16x32_bf16 v[220:223], a[12:15], a[228:231], v[220:223]
    ds_read_b64_tr_b16 a[52:53], v47 offset:57344
    v_mfma_f32_16x16x32_bf16 a[88:91], a[12:15], a[232:235], a[88:91]
    buffer_load_dwordx4 a[220:223], v37, s[8:11], s62 offen offset:1024 sc1
    ds_read_b64_tr_b16 a[54:55], v47 offset:58368
    v_mfma_f32_16x16x32_bf16 a[92:95], a[12:15], a[236:239], a[92:95]
    ds_read_b64_tr_b16 a[56:57], v48 offset:57344
    v_mfma_f32_16x16x32_bf16 v[224:227], a[16:19], a[224:227], v[224:227]
    v_mfma_f32_16x16x32_bf16 v[228:231], a[16:19], a[228:231], v[228:231]
    ds_read_b64_tr_b16 a[58:59], v48 offset:58368
    v_mfma_f32_16x16x32_bf16 a[96:99], a[16:19], a[232:235], a[96:99]
    s_add_u32 s62, s62, 0x20000
    ds_read_b64_tr_b16 a[60:61], v49 offset:57344
    v_mfma_f32_16x16x32_bf16 a[100:103], a[16:19], a[236:239], a[100:103]
    s_add_u32 s52, s47, 8192
    v_mfma_f32_16x16x32_bf16 v[232:235], a[20:23], a[224:227], v[232:235]
    buffer_store_dwordx4 v[100:103], v1, s[32:35], s52 offen offset:1024 sc1
    ds_read_b64_tr_b16 a[62:63], v49 offset:58368
    v_mfma_f32_16x16x32_bf16 v[236:239], a[20:23], a[228:231], v[236:239]
    s_add_u32 s52, s47, 8192
    v_mfma_f32_16x16x32_bf16 a[104:107], a[20:23], a[232:235], a[104:107]
    v_mfma_f32_16x16x32_bf16 a[108:111], a[20:23], a[236:239], a[108:111]
    buffer_store_dwordx4 v[104:107], v1, s[32:35], s52 offen offset:2048 sc1
    v_mfma_f32_16x16x32_bf16 v[240:243], a[24:27], a[224:227], v[240:243]
    v_mfma_f32_16x16x32_bf16 v[244:247], a[24:27], a[228:231], v[244:247]
    v_mfma_f32_16x16x32_bf16 a[112:115], a[24:27], a[232:235], a[112:115]
    v_mfma_f32_16x16x32_bf16 a[116:119], a[24:27], a[236:239], a[116:119]
    v_mfma_f32_16x16x32_bf16 v[248:251], a[28:31], a[224:227], v[248:251]
    v_mfma_f32_16x16x32_bf16 v[252:255], a[28:31], a[228:231], v[252:255]
    v_mfma_f32_16x16x32_bf16 a[120:123], a[28:31], a[232:235], a[120:123]
    v_mfma_f32_16x16x32_bf16 a[124:127], a[28:31], a[236:239], a[124:127]
    s_waitcnt vmcnt(11) lgkmcnt(0)
    s_barrier
    v_mfma_f32_16x16x32_bf16 v[192:195], a[32:35], a[240:243], v[192:195]
    ds_read_b64_tr_b16 a[0:1], v42 offset:0
    ds_read_b64_tr_b16 a[2:3], v42 offset:1024
    v_mfma_f32_16x16x32_bf16 v[196:199], a[32:35], a[244:247], v[196:199]
    s_add_u32 m0, s60, 114688
    v_mfma_f32_16x16x32_bf16 a[64:67], a[32:35], a[248:251], a[64:67]
    buffer_load_dwordx4 v38, s[12:15], s61 offen offset:0 lds
    ds_read_b64_tr_b16 a[4:5], v43 offset:0
    v_mfma_f32_16x16x32_bf16 a[68:71], a[32:35], a[252:255], a[68:71]
    ds_read_b64_tr_b16 a[6:7], v43 offset:1024
    v_mfma_f32_16x16x32_bf16 v[200:203], a[36:39], a[240:243], v[200:203]
    buffer_load_dwordx4 v39, s[12:15], s61 offen offset:1024 lds
    ds_read_b64_tr_b16 a[8:9], v44 offset:0
    v_mfma_f32_16x16x32_bf16 v[204:207], a[36:39], a[244:247], v[204:207]
    v_mfma_f32_16x16x32_bf16 a[72:75], a[36:39], a[248:251], a[72:75]
    ds_read_b64_tr_b16 a[10:11], v44 offset:1024
    v_mfma_f32_16x16x32_bf16 a[76:79], a[36:39], a[252:255], a[76:79]
    buffer_load_dwordx4 v40, s[12:15], s61 offen offset:2048 lds
    ds_read_b64_tr_b16 a[12:13], v45 offset:0
    v_mfma_f32_16x16x32_bf16 v[208:211], a[40:43], a[240:243], v[208:211]
    v_mfma_f32_16x16x32_bf16 v[212:215], a[40:43], a[244:247], v[212:215]
    ds_read_b64_tr_b16 a[14:15], v45 offset:1024
    v_mfma_f32_16x16x32_bf16 a[80:83], a[40:43], a[248:251], a[80:83]
    buffer_load_dwordx4 v41, s[12:15], s61 offen offset:3072 lds
    ds_read_b64_tr_b16 a[16:17], v46 offset:0
    v_mfma_f32_16x16x32_bf16 a[84:87], a[40:43], a[252:255], a[84:87]
    ds_read_b64_tr_b16 a[18:19], v46 offset:1024
    v_mfma_f32_16x16x32_bf16 v[216:219], a[44:47], a[240:243], v[216:219]
    s_add_u32 s61, s61, 0x80000
    v_mfma_f32_16x16x32_bf16 v[220:223], a[44:47], a[244:247], v[220:223]
    buffer_load_dwordx4 a[224:227], v36, s[8:11], s62 offen offset:0 sc1
    ds_read_b64_tr_b16 a[20:21], v47 offset:0
    v_mfma_f32_16x16x32_bf16 a[88:91], a[44:47], a[248:251], a[88:91]
    ds_read_b64_tr_b16 a[22:23], v47 offset:1024
    v_mfma_f32_16x16x32_bf16 a[92:95], a[44:47], a[252:255], a[92:95]
    ds_read_b64_tr_b16 a[24:25], v48 offset:0
    v_mfma_f32_16x16x32_bf16 v[224:227], a[48:51], a[240:243], v[224:227]
    buffer_load_dwordx4 a[228:231], v36, s[8:11], s62 offen offset:1024 sc1
    v_mfma_f32_16x16x32_bf16 v[228:231], a[48:51], a[244:247], v[228:231]
    ds_read_b64_tr_b16 a[26:27], v48 offset:1024
    v_mfma_f32_16x16x32_bf16 a[96:99], a[48:51], a[248:251], a[96:99]
    ds_read_b64_tr_b16 a[28:29], v49 offset:0
    v_mfma_f32_16x16x32_bf16 a[100:103], a[48:51], a[252:255], a[100:103]
    buffer_load_dwordx4 a[232:235], v37, s[8:11], s62 offen offset:0 sc1
    v_mfma_f32_16x16x32_bf16 v[232:235], a[52:55], a[240:243], v[232:235]
    ds_read_b64_tr_b16 a[30:31], v49 offset:1024
    v_mfma_f32_16x16x32_bf16 v[236:239], a[52:55], a[244:247], v[236:239]
    v_mfma_f32_16x16x32_bf16 a[104:107], a[52:55], a[248:251], a[104:107]
    buffer_load_dwordx4 a[236:239], v37, s[8:11], s62 offen offset:1024 sc1
    v_mfma_f32_16x16x32_bf16 a[108:111], a[52:55], a[252:255], a[108:111]
    v_mfma_f32_16x16x32_bf16 v[240:243], a[56:59], a[240:243], v[240:243]
    s_add_u32 s62, s62, 0x20000
    v_mfma_f32_16x16x32_bf16 v[244:247], a[56:59], a[244:247], v[244:247]
    s_add_u32 s52, s47, 8192
    v_mfma_f32_16x16x32_bf16 a[112:115], a[56:59], a[248:251], a[112:115]
    buffer_store_dwordx4 v[108:111], v1, s[32:35], s52 offen offset:3072 sc1
    v_mfma_f32_16x16x32_bf16 a[116:119], a[56:59], a[252:255], a[116:119]
    v_mfma_f32_16x16x32_bf16 v[248:251], a[60:63], a[240:243], v[248:251]
    v_mfma_f32_16x16x32_bf16 v[252:255], a[60:63], a[244:247], v[252:255]
    v_mfma_f32_16x16x32_bf16 a[120:123], a[60:63], a[248:251], a[120:123]
    v_mfma_f32_16x16x32_bf16 a[124:127], a[60:63], a[252:255], a[124:127]
    s_waitcnt vmcnt(16) lgkmcnt(0)
    v_mfma_f32_16x16x32_bf16 v[192:195], a[0:3], a[192:195], v[192:195]
    ds_read_b64_tr_b16 a[32:33], v42 offset:8192
    ds_read_b64_tr_b16 a[34:35], v42 offset:9216
    v_mfma_f32_16x16x32_bf16 v[196:199], a[0:3], a[196:199], v[196:199]
    buffer_load_dwordx4 a[240:243], v36, s[8:11], s62 offen offset:0 sc1
    v_mfma_f32_16x16x32_bf16 a[64:67], a[0:3], a[200:203], a[64:67]
    ds_read_b64_tr_b16 a[36:37], v43 offset:8192
    v_mfma_f32_16x16x32_bf16 a[68:71], a[0:3], a[204:207], a[68:71]
    ds_read_b64_tr_b16 a[38:39], v43 offset:9216
    v_mfma_f32_16x16x32_bf16 v[200:203], a[4:7], a[192:195], v[200:203]
    ds_read_b64_tr_b16 a[40:41], v44 offset:8192
    v_mfma_f32_16x16x32_bf16 v[204:207], a[4:7], a[196:199], v[204:207]
    buffer_load_dwordx4 a[244:247], v36, s[8:11], s62 offen offset:1024 sc1
    v_mfma_f32_16x16x32_bf16 a[72:75], a[4:7], a[200:203], a[72:75]
    ds_read_b64_tr_b16 a[42:43], v44 offset:9216
    v_mfma_f32_16x16x32_bf16 a[76:79], a[4:7], a[204:207], a[76:79]
    ds_read_b64_tr_b16 a[44:45], v45 offset:8192
    v_mfma_f32_16x16x32_bf16 v[208:211], a[8:11], a[192:195], v[208:211]
    v_mfma_f32_16x16x32_bf16 v[212:215], a[8:11], a[196:199], v[212:215]
    ds_read_b64_tr_b16 a[46:47], v45 offset:9216
    v_mfma_f32_16x16x32_bf16 a[80:83], a[8:11], a[200:203], a[80:83]
    buffer_load_dwordx4 a[248:251], v37, s[8:11], s62 offen offset:0 sc1
    ds_read_b64_tr_b16 a[48:49], v46 offset:8192
    v_mfma_f32_16x16x32_bf16 a[84:87], a[8:11], a[204:207], a[84:87]
    ds_read_b64_tr_b16 a[50:51], v46 offset:9216
    v_mfma_f32_16x16x32_bf16 v[216:219], a[12:15], a[192:195], v[216:219]
    v_mfma_f32_16x16x32_bf16 v[220:223], a[12:15], a[196:199], v[220:223]
    ds_read_b64_tr_b16 a[52:53], v47 offset:8192
    v_mfma_f32_16x16x32_bf16 a[88:91], a[12:15], a[200:203], a[88:91]
    buffer_load_dwordx4 a[252:255], v37, s[8:11], s62 offen offset:1024 sc1
    ds_read_b64_tr_b16 a[54:55], v47 offset:9216
    v_mfma_f32_16x16x32_bf16 a[92:95], a[12:15], a[204:207], a[92:95]
    ds_read_b64_tr_b16 a[56:57], v48 offset:8192
    v_mfma_f32_16x16x32_bf16 v[224:227], a[16:19], a[192:195], v[224:227]
    v_mfma_f32_16x16x32_bf16 v[228:231], a[16:19], a[196:199], v[228:231]
    ds_read_b64_tr_b16 a[58:59], v48 offset:9216
    v_mfma_f32_16x16x32_bf16 a[96:99], a[16:19], a[200:203], a[96:99]
    s_add_u32 s62, s62, 0x20000
    ds_read_b64_tr_b16 a[60:61], v49 offset:8192
    v_mfma_f32_16x16x32_bf16 a[100:103], a[16:19], a[204:207], a[100:103]
    s_add_u32 s52, s47, 12288
    v_mfma_f32_16x16x32_bf16 v[232:235], a[20:23], a[192:195], v[232:235]
    buffer_store_dwordx4 v[112:115], v1, s[32:35], s52 offen offset:0 sc1
    ds_read_b64_tr_b16 a[62:63], v49 offset:9216
    v_mfma_f32_16x16x32_bf16 v[236:239], a[20:23], a[196:199], v[236:239]
    s_add_u32 s52, s47, 12288
    v_mfma_f32_16x16x32_bf16 a[104:107], a[20:23], a[200:203], a[104:107]
    v_mfma_f32_16x16x32_bf16 a[108:111], a[20:23], a[204:207], a[108:111]
    buffer_store_dwordx4 v[116:119], v1, s[32:35], s52 offen offset:1024 sc1
    v_mfma_f32_16x16x32_bf16 v[240:243], a[24:27], a[192:195], v[240:243]
    v_mfma_f32_16x16x32_bf16 v[244:247], a[24:27], a[196:199], v[244:247]
    v_mfma_f32_16x16x32_bf16 a[112:115], a[24:27], a[200:203], a[112:115]
    v_mfma_f32_16x16x32_bf16 a[116:119], a[24:27], a[204:207], a[116:119]
    v_mfma_f32_16x16x32_bf16 v[248:251], a[28:31], a[192:195], v[248:251]
    v_mfma_f32_16x16x32_bf16 v[252:255], a[28:31], a[196:199], v[252:255]
    v_mfma_f32_16x16x32_bf16 a[120:123], a[28:31], a[200:203], a[120:123]
    v_mfma_f32_16x16x32_bf16 a[124:127], a[28:31], a[204:207], a[124:127]
    s_waitcnt vmcnt(11) lgkmcnt(0)
    s_barrier
    v_mfma_f32_16x16x32_bf16 v[192:195], a[32:35], a[208:211], v[192:195]
    ds_read_b64_tr_b16 a[0:1], v42 offset:16384
    ds_read_b64_tr_b16 a[2:3], v42 offset:17408
    v_mfma_f32_16x16x32_bf16 v[196:199], a[32:35], a[212:215], v[196:199]
    s_add_u32 m0, s60, 131072
    v_mfma_f32_16x16x32_bf16 a[64:67], a[32:35], a[216:219], a[64:67]
    buffer_load_dwordx4 v38, s[12:15], s61 offen offset:0 lds
    ds_read_b64_tr_b16 a[4:5], v43 offset:16384
    v_mfma_f32_16x16x32_bf16 a[68:71], a[32:35], a[220:223], a[68:71]
    ds_read_b64_tr_b16 a[6:7], v43 offset:17408
    v_mfma_f32_16x16x32_bf16 v[200:203], a[36:39], a[208:211], v[200:203]
    buffer_load_dwordx4 v39, s[12:15], s61 offen offset:1024 lds
    ds_read_b64_tr_b16 a[8:9], v44 offset:16384
    v_mfma_f32_16x16x32_bf16 v[204:207], a[36:39], a[212:215], v[204:207]
    v_mfma_f32_16x16x32_bf16 a[72:75], a[36:39], a[216:219], a[72:75]
    buffer_load_dwordx4 v40, s[12:15], s61 offen offset:2048 lds
    ds_read_b64_tr_b16 a[10:11], v44 offset:17408
    v_mfma_f32_16x16x32_bf16 a[76:79], a[36:39], a[220:223], a[76:79]
    ds_read_b64_tr_b16 a[12:13], v45 offset:16384
    v_mfma_f32_16x16x32_bf16 v[208:211], a[40:43], a[208:211], v[208:211]
    v_mfma_f32_16x16x32_bf16 v[212:215], a[40:43], a[212:215], v[212:215]
    buffer_load_dwordx4 v41, s[12:15], s61 offen offset:3072 lds
    ds_read_b64_tr_b16 a[14:15], v45 offset:17408
    v_mfma_f32_16x16x32_bf16 a[80:83], a[40:43], a[216:219], a[80:83]
    ds_read_b64_tr_b16 a[16:17], v46 offset:16384
    v_mfma_f32_16x16x32_bf16 a[84:87], a[40:43], a[220:223], a[84:87]
    s_add_u32 s61, s61, 0x80000
    ds_read_b64_tr_b16 a[18:19], v46 offset:17408
    v_mfma_f32_16x16x32_bf16 v[216:219], a[44:47], a[208:211], v[216:219]
    buffer_load_dwordx4 a[192:195], v36, s[8:11], s62 offen offset:0 sc1
    v_mfma_f32_16x16x32_bf16 v[220:223], a[44:47], a[212:215], v[220:223]
    ds_read_b64_tr_b16 a[20:21], v47 offset:16384
    v_mfma_f32_16x16x32_bf16 a[88:91], a[44:47], a[216:219], a[88:91]
    buffer_load_dwordx4 a[196:199], v36, s[8:11], s62 offen offset:1024 sc1
    ds_read_b64_tr_b16 a[22:23], v47 offset:17408
    v_mfma_f32_16x16x32_bf16 a[92:95], a[44:47], a[220:223], a[92:95]
    ds_read_b64_tr_b16 a[24:25], v48 offset:16384
    v_mfma_f32_16x16x32_bf16 v[224:227], a[48:51], a[208:211], v[224:227]
    v_mfma_f32_16x16x32_bf16 v[228:231], a[48:51], a[212:215], v[228:231]
    buffer_load_dwordx4 a[200:203], v37, s[8:11], s62 offen offset:0 sc1
    ds_read_b64_tr_b16 a[26:27], v48 offset:17408
    v_mfma_f32_16x16x32_bf16 a[96:99], a[48:51], a[216:219], a[96:99]
    ds_read_b64_tr_b16 a[28:29], v49 offset:16384
    v_mfma_f32_16x16x32_bf16 a[100:103], a[48:51], a[220:223], a[100:103]
    v_mfma_f32_16x16x32_bf16 v[232:235], a[52:55], a[208:211], v[232:235]
    buffer_load_dwordx4 a[204:207], v37, s[8:11], s62 offen offset:1024 sc1
    ds_read_b64_tr_b16 a[30:31], v49 offset:17408
    v_mfma_f32_16x16x32_bf16 v[236:239], a[52:55], a[212:215], v[236:239]
    v_mfma_f32_16x16x32_bf16 a[104:107], a[52:55], a[216:219], a[104:107]
    s_add_u32 s62, s62, 0x20000
    v_mfma_f32_16x16x32_bf16 a[108:111], a[52:55], a[220:223], a[108:111]
    s_add_u32 s52, s47, 12288
    v_mfma_f32_16x16x32_bf16 v[240:243], a[56:59], a[208:211], v[240:243]
    buffer_store_dwordx4 v[120:123], v1, s[32:35], s52 offen offset:2048 sc1
    v_mfma_f32_16x16x32_bf16 v[244:247], a[56:59], a[212:215], v[244:247]
    s_add_u32 s52, s47, 12288
    v_mfma_f32_16x16x32_bf16 a[112:115], a[56:59], a[216:219], a[112:115]
    buffer_store_dwordx4 v[124:127], v1, s[32:35], s52 offen offset:3072 sc1
    v_mfma_f32_16x16x32_bf16 a[116:119], a[56:59], a[220:223], a[116:119]
    v_mfma_f32_16x16x32_bf16 v[248:251], a[60:63], a[208:211], v[248:251]
    v_mfma_f32_16x16x32_bf16 v[252:255], a[60:63], a[212:215], v[252:255]
    v_mfma_f32_16x16x32_bf16 a[120:123], a[60:63], a[216:219], a[120:123]
    v_mfma_f32_16x16x32_bf16 a[124:127], a[60:63], a[220:223], a[124:127]
    s_waitcnt vmcnt(17) lgkmcnt(0)
    v_mfma_f32_16x16x32_bf16 v[192:195], a[0:3], a[224:227], v[192:195]
    ds_read_b64_tr_b16 a[32:33], v42 offset:24576
    ds_read_b64_tr_b16 a[34:35], v42 offset:25600
    v_mfma_f32_16x16x32_bf16 v[196:199], a[0:3], a[228:231], v[196:199]
    buffer_load_dwordx4 a[208:211], v36, s[8:11], s62 offen offset:0 sc1
    v_mfma_f32_16x16x32_bf16 a[64:67], a[0:3], a[232:235], a[64:67]
    ds_read_b64_tr_b16 a[36:37], v43 offset:24576
    v_mfma_f32_16x16x32_bf16 a[68:71], a[0:3], a[236:239], a[68:71]
    ds_read_b64_tr_b16 a[38:39], v43 offset:25600
    v_mfma_f32_16x16x32_bf16 v[200:203], a[4:7], a[224:227], v[200:203]
    ds_read_b64_tr_b16 a[40:41], v44 offset:24576
    v_mfma_f32_16x16x32_bf16 v[204:207], a[4:7], a[228:231], v[204:207]
    v_mfma_f32_16x16x32_bf16 a[72:75], a[4:7], a[232:235], a[72:75]
    buffer_load_dwordx4 a[212:215], v36, s[8:11], s62 offen offset:1024 sc1
    ds_read_b64_tr_b16 a[42:43], v44 offset:25600
    v_mfma_f32_16x16x32_bf16 a[76:79], a[4:7], a[236:239], a[76:79]
    ds_read_b64_tr_b16 a[44:45], v45 offset:24576
    v_mfma_f32_16x16x32_bf16 v[208:211], a[8:11], a[224:227], v[208:211]
    v_mfma_f32_16x16x32_bf16 v[212:215], a[8:11], a[228:231], v[212:215]
    ds_read_b64_tr_b16 a[46:47], v45 offset:25600
    v_mfma_f32_16x16x32_bf16 a[80:83], a[8:11], a[232:235], a[80:83]
    ds_read_b64_tr_b16 a[48:49], v46 offset:24576
    v_mfma_f32_16x16x32_bf16 a[84:87], a[8:11], a[236:239], a[84:87]
    ds_read_b64_tr_b16 a[50:51], v46 offset:25600
    v_mfma_f32_16x16x32_bf16 v[216:219], a[12:15], a[224:227], v[216:219]
    buffer_load_dwordx4 a[216:219], v37, s[8:11], s62 offen offset:0 sc1
    v_mfma_f32_16x16x32_bf16 v[220:223], a[12:15], a[228:231], v[220:223]
    ds_read_b64_tr_b16 a[52:53], v47 offset:24576
    v_mfma_f32_16x16x32_bf16 a[88:91], a[12:15], a[232:235], a[88:91]
    ds_read_b64_tr_b16 a[54:55], v47 offset:25600
    v_mfma_f32_16x16x32_bf16 a[92:95], a[12:15], a[236:239], a[92:95]
    ds_read_b64_tr_b16 a[56:57], v48 offset:24576
    v_mfma_f32_16x16x32_bf16 v[224:227], a[16:19], a[224:227], v[224:227]
    v_mfma_f32_16x16x32_bf16 v[228:231], a[16:19], a[228:231], v[228:231]
    buffer_load_dwordx4 a[220:223], v37, s[8:11], s62 offen offset:1024 sc1
    ds_read_b64_tr_b16 a[58:59], v48 offset:25600
    v_mfma_f32_16x16x32_bf16 a[96:99], a[16:19], a[232:235], a[96:99]
    ds_read_b64_tr_b16 a[60:61], v49 offset:24576
    v_mfma_f32_16x16x32_bf16 a[100:103], a[16:19], a[236:239], a[100:103]
    v_mfma_f32_16x16x32_bf16 v[232:235], a[20:23], a[224:227], v[232:235]
    ds_read_b64_tr_b16 a[62:63], v49 offset:25600
    v_mfma_f32_16x16x32_bf16 v[236:239], a[20:23], a[228:231], v[236:239]
    v_mfma_f32_16x16x32_bf16 a[104:107], a[20:23], a[232:235], a[104:107]
    s_add_u32 s62, s62, 0x20000
    v_mfma_f32_16x16x32_bf16 a[108:111], a[20:23], a[236:239], a[108:111]
    s_add_u32 s52, s47, 524288
    v_mfma_f32_16x16x32_bf16 v[240:243], a[24:27], a[224:227], v[240:243]
    buffer_store_dwordx4 v[128:131], v1, s[32:35], s52 offen offset:0 sc1
    v_mfma_f32_16x16x32_bf16 v[244:247], a[24:27], a[228:231], v[244:247]
    v_mfma_f32_16x16x32_bf16 a[112:115], a[24:27], a[232:235], a[112:115]
    v_mfma_f32_16x16x32_bf16 a[116:119], a[24:27], a[236:239], a[116:119]
    v_mfma_f32_16x16x32_bf16 v[248:251], a[28:31], a[224:227], v[248:251]
    v_mfma_f32_16x16x32_bf16 v[252:255], a[28:31], a[228:231], v[252:255]
    v_mfma_f32_16x16x32_bf16 a[120:123], a[28:31], a[232:235], a[120:123]
    v_mfma_f32_16x16x32_bf16 a[124:127], a[28:31], a[236:239], a[124:127]
    s_waitcnt vmcnt(11) lgkmcnt(0)
    s_barrier
    v_mfma_f32_16x16x32_bf16 v[192:195], a[32:35], a[240:243], v[192:195]
    ds_read_b64_tr_b16 a[0:1], v42 offset:32768
    ds_read_b64_tr_b16 a[2:3], v42 offset:33792
    v_mfma_f32_16x16x32_bf16 v[196:199], a[32:35], a[244:247], v[196:199]
    s_add_u32 m0, s60, 147456
    v_mfma_f32_16x16x32_bf16 a[64:67], a[32:35], a[248:251], a[64:67]
    buffer_load_dwordx4 v38, s[12:15], s61 offen offset:0 lds
    ds_read_b64_tr_b16 a[4:5], v43 offset:32768
    v_mfma_f32_16x16x32_bf16 a[68:71], a[32:35], a[252:255], a[68:71]
    ds_read_b64_tr_b16 a[6:7], v43 offset:33792
    v_mfma_f32_16x16x32_bf16 v[200:203], a[36:39], a[240:243], v[200:203]
    buffer_load_dwordx4 v39, s[12:15], s61 offen offset:1024 lds
    ds_read_b64_tr_b16 a[8:9], v44 offset:32768
    v_mfma_f32_16x16x32_bf16 v[204:207], a[36:39], a[244:247], v[204:207]
    v_mfma_f32_16x16x32_bf16 a[72:75], a[36:39], a[248:251], a[72:75]
    buffer_load_dwordx4 v40, s[12:15], s61 offen offset:2048 lds
    ds_read_b64_tr_b16 a[10:11], v44 offset:33792
    v_mfma_f32_16x16x32_bf16 a[76:79], a[36:39], a[252:255], a[76:79]
    ds_read_b64_tr_b16 a[12:13], v45 offset:32768
    v_mfma_f32_16x16x32_bf16 v[208:211], a[40:43], a[240:243], v[208:211]
    v_mfma_f32_16x16x32_bf16 v[212:215], a[40:43], a[244:247], v[212:215]
    buffer_load_dwordx4 v41, s[12:15], s61 offen offset:3072 lds
    ds_read_b64_tr_b16 a[14:15], v45 offset:33792
    v_mfma_f32_16x16x32_bf16 a[80:83], a[40:43], a[248:251], a[80:83]
    ds_read_b64_tr_b16 a[16:17], v46 offset:32768
    v_mfma_f32_16x16x32_bf16 a[84:87], a[40:43], a[252:255], a[84:87]
    s_add_u32 s61, s61, 0x80000
    ds_read_b64_tr_b16 a[18:19], v46 offset:33792
    v_mfma_f32_16x16x32_bf16 v[216:219], a[44:47], a[240:243], v[216:219]
    buffer_load_dwordx4 a[224:227], v36, s[8:11], s62 offen offset:0 sc1
    v_mfma_f32_16x16x32_bf16 v[220:223], a[44:47], a[244:247], v[220:223]
    ds_read_b64_tr_b16 a[20:21], v47 offset:32768
    v_mfma_f32_16x16x32_bf16 a[88:91], a[44:47], a[248:251], a[88:91]
    buffer_load_dwordx4 a[228:231], v36, s[8:11], s62 offen offset:1024 sc1
    ds_read_b64_tr_b16 a[22:23], v47 offset:33792
    v_mfma_f32_16x16x32_bf16 a[92:95], a[44:47], a[252:255], a[92:95]
    ds_read_b64_tr_b16 a[24:25], v48 offset:32768
    v_mfma_f32_16x16x32_bf16 v[224:227], a[48:51], a[240:243], v[224:227]
    v_mfma_f32_16x16x32_bf16 v[228:231], a[48:51], a[244:247], v[228:231]
    buffer_load_dwordx4 a[232:235], v37, s[8:11], s62 offen offset:0 sc1
    ds_read_b64_tr_b16 a[26:27], v48 offset:33792
    v_mfma_f32_16x16x32_bf16 a[96:99], a[48:51], a[248:251], a[96:99]
    ds_read_b64_tr_b16 a[28:29], v49 offset:32768
    v_mfma_f32_16x16x32_bf16 a[100:103], a[48:51], a[252:255], a[100:103]
    v_mfma_f32_16x16x32_bf16 v[232:235], a[52:55], a[240:243], v[232:235]
    buffer_load_dwordx4 a[236:239], v37, s[8:11], s62 offen offset:1024 sc1
    ds_read_b64_tr_b16 a[30:31], v49 offset:33792
    v_mfma_f32_16x16x32_bf16 v[236:239], a[52:55], a[244:247], v[236:239]
    v_mfma_f32_16x16x32_bf16 a[104:107], a[52:55], a[248:251], a[104:107]
    s_add_u32 s62, s62, 0x20000
    v_mfma_f32_16x16x32_bf16 a[108:111], a[52:55], a[252:255], a[108:111]
    s_add_u32 s52, s47, 524288
    v_mfma_f32_16x16x32_bf16 v[240:243], a[56:59], a[240:243], v[240:243]
    buffer_store_dwordx4 v[132:135], v1, s[32:35], s52 offen offset:1024 sc1
    v_mfma_f32_16x16x32_bf16 v[244:247], a[56:59], a[244:247], v[244:247]
    s_add_u32 s52, s47, 524288
    v_mfma_f32_16x16x32_bf16 a[112:115], a[56:59], a[248:251], a[112:115]
    buffer_store_dwordx4 v[136:139], v1, s[32:35], s52 offen offset:2048 sc1
    v_mfma_f32_16x16x32_bf16 a[116:119], a[56:59], a[252:255], a[116:119]
    v_mfma_f32_16x16x32_bf16 v[248:251], a[60:63], a[240:243], v[248:251]
    v_mfma_f32_16x16x32_bf16 v[252:255], a[60:63], a[244:247], v[252:255]
    v_mfma_f32_16x16x32_bf16 a[120:123], a[60:63], a[248:251], a[120:123]
    v_mfma_f32_16x16x32_bf16 a[124:127], a[60:63], a[252:255], a[124:127]
    s_waitcnt vmcnt(17) lgkmcnt(0)
    v_mfma_f32_16x16x32_bf16 v[192:195], a[0:3], a[192:195], v[192:195]
    ds_read_b64_tr_b16 a[32:33], v42 offset:40960
    ds_read_b64_tr_b16 a[34:35], v42 offset:41984
    v_mfma_f32_16x16x32_bf16 v[196:199], a[0:3], a[196:199], v[196:199]
    buffer_load_dwordx4 a[240:243], v36, s[8:11], s62 offen offset:0 sc1
    v_mfma_f32_16x16x32_bf16 a[64:67], a[0:3], a[200:203], a[64:67]
    ds_read_b64_tr_b16 a[36:37], v43 offset:40960
    v_mfma_f32_16x16x32_bf16 a[68:71], a[0:3], a[204:207], a[68:71]
    ds_read_b64_tr_b16 a[38:39], v43 offset:41984
    v_mfma_f32_16x16x32_bf16 v[200:203], a[4:7], a[192:195], v[200:203]
    ds_read_b64_tr_b16 a[40:41], v44 offset:40960
    v_mfma_f32_16x16x32_bf16 v[204:207], a[4:7], a[196:199], v[204:207]
    v_mfma_f32_16x16x32_bf16 a[72:75], a[4:7], a[200:203], a[72:75]
    buffer_load_dwordx4 a[244:247], v36, s[8:11], s62 offen offset:1024 sc1
    ds_read_b64_tr_b16 a[42:43], v44 offset:41984
    v_mfma_f32_16x16x32_bf16 a[76:79], a[4:7], a[204:207], a[76:79]
    ds_read_b64_tr_b16 a[44:45], v45 offset:40960
    v_mfma_f32_16x16x32_bf16 v[208:211], a[8:11], a[192:195], v[208:211]
    v_mfma_f32_16x16x32_bf16 v[212:215], a[8:11], a[196:199], v[212:215]
    ds_read_b64_tr_b16 a[46:47], v45 offset:41984
    v_mfma_f32_16x16x32_bf16 a[80:83], a[8:11], a[200:203], a[80:83]
    ds_read_b64_tr_b16 a[48:49], v46 offset:40960
    v_mfma_f32_16x16x32_bf16 a[84:87], a[8:11], a[204:207], a[84:87]
    ds_read_b64_tr_b16 a[50:51], v46 offset:41984
    v_mfma_f32_16x16x32_bf16 v[216:219], a[12:15], a[192:195], v[216:219]
    buffer_load_dwordx4 a[248:251], v37, s[8:11], s62 offen offset:0 sc1
    v_mfma_f32_16x16x32_bf16 v[220:223], a[12:15], a[196:199], v[220:223]
    ds_read_b64_tr_b16 a[52:53], v47 offset:40960
    v_mfma_f32_16x16x32_bf16 a[88:91], a[12:15], a[200:203], a[88:91]
    ds_read_b64_tr_b16 a[54:55], v47 offset:41984
    v_mfma_f32_16x16x32_bf16 a[92:95], a[12:15], a[204:207], a[92:95]
    ds_read_b64_tr_b16 a[56:57], v48 offset:40960
    v_mfma_f32_16x16x32_bf16 v[224:227], a[16:19], a[192:195], v[224:227]
    v_mfma_f32_16x16x32_bf16 v[228:231], a[16:19], a[196:199], v[228:231]
    buffer_load_dwordx4 a[252:255], v37, s[8:11], s62 offen offset:1024 sc1
    ds_read_b64_tr_b16 a[58:59], v48 offset:41984
    v_mfma_f32_16x16x32_bf16 a[96:99], a[16:19], a[200:203], a[96:99]
    ds_read_b64_tr_b16 a[60:61], v49 offset:40960
    v_mfma_f32_16x16x32_bf16 a[100:103], a[16:19], a[204:207], a[100:103]
    v_mfma_f32_16x16x32_bf16 v[232:235], a[20:23], a[192:195], v[232:235]
    ds_read_b64_tr_b16 a[62:63], v49 offset:41984
    v_mfma_f32_16x16x32_bf16 v[236:239], a[20:23], a[196:199], v[236:239]
    v_mfma_f32_16x16x32_bf16 a[104:107], a[20:23], a[200:203], a[104:107]
    s_add_u32 s62, s62, 0x20000
    v_mfma_f32_16x16x32_bf16 a[108:111], a[20:23], a[204:207], a[108:111]
    s_add_u32 s52, s47, 524288
    v_mfma_f32_16x16x32_bf16 v[240:243], a[24:27], a[192:195], v[240:243]
    buffer_store_dwordx4 v[140:143], v1, s[32:35], s52 offen offset:3072 sc1
    v_mfma_f32_16x16x32_bf16 v[244:247], a[24:27], a[196:199], v[244:247]
    v_mfma_f32_16x16x32_bf16 a[112:115], a[24:27], a[200:203], a[112:115]
    v_mfma_f32_16x16x32_bf16 a[116:119], a[24:27], a[204:207], a[116:119]
    v_mfma_f32_16x16x32_bf16 v[248:251], a[28:31], a[192:195], v[248:251]
    v_mfma_f32_16x16x32_bf16 v[252:255], a[28:31], a[196:199], v[252:255]
    v_mfma_f32_16x16x32_bf16 a[120:123], a[28:31], a[200:203], a[120:123]
    v_mfma_f32_16x16x32_bf16 a[124:127], a[28:31], a[204:207], a[124:127]
    s_waitcnt vmcnt(11) lgkmcnt(0)
    s_barrier
    v_mfma_f32_16x16x32_bf16 v[192:195], a[32:35], a[208:211], v[192:195]
    ds_read_b64_tr_b16 a[0:1], v42 offset:49152
    ds_read_b64_tr_b16 a[2:3], v42 offset:50176
    v_mfma_f32_16x16x32_bf16 v[196:199], a[32:35], a[212:215], v[196:199]
    s_add_u32 m0, s60, 98304
    v_mfma_f32_16x16x32_bf16 a[64:67], a[32:35], a[216:219], a[64:67]
    buffer_load_dwordx4 v38, s[12:15], s61 offen offset:0 lds
    ds_read_b64_tr_b16 a[4:5], v43 offset:49152
    v_mfma_f32_16x16x32_bf16 a[68:71], a[32:35], a[220:223], a[68:71]
    ds_read_b64_tr_b16 a[6:7], v43 offset:50176
    v_mfma_f32_16x16x32_bf16 v[200:203], a[36:39], a[208:211], v[200:203]
    buffer_load_dwordx4 v39, s[12:15], s61 offen offset:1024 lds
    ds_read_b64_tr_b16 a[8:9], v44 offset:49152
    v_mfma_f32_16x16x32_bf16 v[204:207], a[36:39], a[212:215], v[204:207]
    v_mfma_f32_16x16x32_bf16 a[72:75], a[36:39], a[216:219], a[72:75]
    buffer_load_dwordx4 v40, s[12:15], s61 offen offset:2048 lds
    ds_read_b64_tr_b16 a[10:11], v44 offset:50176
    v_mfma_f32_16x16x32_bf16 a[76:79], a[36:39], a[220:223], a[76:79]
    ds_read_b64_tr_b16 a[12:13], v45 offset:49152
    v_mfma_f32_16x16x32_bf16 v[208:211], a[40:43], a[208:211], v[208:211]
    v_mfma_f32_16x16x32_bf16 v[212:215], a[40:43], a[212:215], v[212:215]
    buffer_load_dwordx4 v41, s[12:15], s61 offen offset:3072 lds
    ds_read_b64_tr_b16 a[14:15], v45 offset:50176
    v_mfma_f32_16x16x32_bf16 a[80:83], a[40:43], a[216:219], a[80:83]
    ds_read_b64_tr_b16 a[16:17], v46 offset:49152
    v_mfma_f32_16x16x32_bf16 a[84:87], a[40:43], a[220:223], a[84:87]
    s_add_u32 s61, s61, 0x80000
    ds_read_b64_tr_b16 a[18:19], v46 offset:50176
    v_mfma_f32_16x16x32_bf16 v[216:219], a[44:47], a[208:211], v[216:219]
    buffer_load_dwordx4 a[192:195], v36, s[8:11], s62 offen offset:0 sc1
    v_mfma_f32_16x16x32_bf16 v[220:223], a[44:47], a[212:215], v[220:223]
    ds_read_b64_tr_b16 a[20:21], v47 offset:49152
    v_mfma_f32_16x16x32_bf16 a[88:91], a[44:47], a[216:219], a[88:91]
    buffer_load_dwordx4 a[196:199], v36, s[8:11], s62 offen offset:1024 sc1
    ds_read_b64_tr_b16 a[22:23], v47 offset:50176
    v_mfma_f32_16x16x32_bf16 a[92:95], a[44:47], a[220:223], a[92:95]
    ds_read_b64_tr_b16 a[24:25], v48 offset:49152
    v_mfma_f32_16x16x32_bf16 v[224:227], a[48:51], a[208:211], v[224:227]
    v_mfma_f32_16x16x32_bf16 v[228:231], a[48:51], a[212:215], v[228:231]
    buffer_load_dwordx4 a[200:203], v37, s[8:11], s62 offen offset:0 sc1
    ds_read_b64_tr_b16 a[26:27], v48 offset:50176
    v_mfma_f32_16x16x32_bf16 a[96:99], a[48:51], a[216:219], a[96:99]
    ds_read_b64_tr_b16 a[28:29], v49 offset:49152
    v_mfma_f32_16x16x32_bf16 a[100:103], a[48:51], a[220:223], a[100:103]
    v_mfma_f32_16x16x32_bf16 v[232:235], a[52:55], a[208:211], v[232:235]
    buffer_load_dwordx4 a[204:207], v37, s[8:11], s62 offen offset:1024 sc1
    ds_read_b64_tr_b16 a[30:31], v49 offset:50176
    v_mfma_f32_16x16x32_bf16 v[236:239], a[52:55], a[212:215], v[236:239]
    v_mfma_f32_16x16x32_bf16 a[104:107], a[52:55], a[216:219], a[104:107]
    s_add_u32 s62, s62, 0x20000
    v_mfma_f32_16x16x32_bf16 a[108:111], a[52:55], a[220:223], a[108:111]
    s_add_u32 s52, s47, 528384
    v_mfma_f32_16x16x32_bf16 v[240:243], a[56:59], a[208:211], v[240:243]
    buffer_store_dwordx4 v[144:147], v1, s[32:35], s52 offen offset:0 sc1
    v_mfma_f32_16x16x32_bf16 v[244:247], a[56:59], a[212:215], v[244:247]
    s_add_u32 s52, s47, 528384
    v_mfma_f32_16x16x32_bf16 a[112:115], a[56:59], a[216:219], a[112:115]
    buffer_store_dwordx4 v[148:151], v1, s[32:35], s52 offen offset:1024 sc1
    v_mfma_f32_16x16x32_bf16 a[116:119], a[56:59], a[220:223], a[116:119]
    v_mfma_f32_16x16x32_bf16 v[248:251], a[60:63], a[208:211], v[248:251]
    v_mfma_f32_16x16x32_bf16 v[252:255], a[60:63], a[212:215], v[252:255]
    v_mfma_f32_16x16x32_bf16 a[120:123], a[60:63], a[216:219], a[120:123]
    v_mfma_f32_16x16x32_bf16 a[124:127], a[60:63], a[220:223], a[124:127]
    s_waitcnt vmcnt(17) lgkmcnt(0)
    v_mfma_f32_16x16x32_bf16 v[192:195], a[0:3], a[224:227], v[192:195]
    ds_read_b64_tr_b16 a[32:33], v42 offset:57344
    ds_read_b64_tr_b16 a[34:35], v42 offset:58368
    v_mfma_f32_16x16x32_bf16 v[196:199], a[0:3], a[228:231], v[196:199]
    buffer_load_dwordx4 a[208:211], v36, s[8:11], s62 offen offset:0 sc1
    v_mfma_f32_16x16x32_bf16 a[64:67], a[0:3], a[232:235], a[64:67]
    ds_read_b64_tr_b16 a[36:37], v43 offset:57344
    v_mfma_f32_16x16x32_bf16 a[68:71], a[0:3], a[236:239], a[68:71]
    ds_read_b64_tr_b16 a[38:39], v43 offset:58368
    v_mfma_f32_16x16x32_bf16 v[200:203], a[4:7], a[224:227], v[200:203]
    ds_read_b64_tr_b16 a[40:41], v44 offset:57344
    v_mfma_f32_16x16x32_bf16 v[204:207], a[4:7], a[228:231], v[204:207]
    buffer_load_dwordx4 a[212:215], v36, s[8:11], s62 offen offset:1024 sc1
    v_mfma_f32_16x16x32_bf16 a[72:75], a[4:7], a[232:235], a[72:75]
    ds_read_b64_tr_b16 a[42:43], v44 offset:58368
    v_mfma_f32_16x16x32_bf16 a[76:79], a[4:7], a[236:239], a[76:79]
    ds_read_b64_tr_b16 a[44:45], v45 offset:57344
    v_mfma_f32_16x16x32_bf16 v[208:211], a[8:11], a[224:227], v[208:211]
    v_mfma_f32_16x16x32_bf16 v[212:215], a[8:11], a[228:231], v[212:215]
    ds_read_b64_tr_b16 a[46:47], v45 offset:58368
    v_mfma_f32_16x16x32_bf16 a[80:83], a[8:11], a[232:235], a[80:83]
    buffer_load_dwordx4 a[216:219], v37, s[8:11], s62 offen offset:0 sc1
    ds_read_b64_tr_b16 a[48:49], v46 offset:57344
    v_mfma_f32_16x16x32_bf16 a[84:87], a[8:11], a[236:239], a[84:87]
    ds_read_b64_tr_b16 a[50:51], v46 offset:58368
    v_mfma_f32_16x16x32_bf16 v[216:219], a[12:15], a[224:227], v[216:219]
    v_mfma_f32_16x16x32_bf16 v[220:223], a[12:15], a[228:231], v[220:223]
    ds_read_b64_tr_b16 a[52:53], v47 offset:57344
    v_mfma_f32_16x16x32_bf16 a[88:91], a[12:15], a[232:235], a[88:91]
    buffer_load_dwordx4 a[220:223], v37, s[8:11], s62 offen offset:1024 sc1
    ds_read_b64_tr_b16 a[54:55], v47 offset:58368
    v_mfma_f32_16x16x32_bf16 a[92:95], a[12:15], a[236:239], a[92:95]
    ds_read_b64_tr_b16 a[56:57], v48 offset:57344
    v_mfma_f32_16x16x32_bf16 v[224:227], a[16:19], a[224:227], v[224:227]
    v_mfma_f32_16x16x32_bf16 v[228:231], a[16:19], a[228:231], v[228:231]
    ds_read_b64_tr_b16 a[58:59], v48 offset:58368
    v_mfma_f32_16x16x32_bf16 a[96:99], a[16:19], a[232:235], a[96:99]
    s_add_u32 s62, s62, 0x20000
    ds_read_b64_tr_b16 a[60:61], v49 offset:57344
    v_mfma_f32_16x16x32_bf16 a[100:103], a[16:19], a[236:239], a[100:103]
    s_add_u32 s52, s47, 528384
    v_mfma_f32_16x16x32_bf16 v[232:235], a[20:23], a[224:227], v[232:235]
    buffer_store_dwordx4 v[152:155], v1, s[32:35], s52 offen offset:2048 sc1
    ds_read_b64_tr_b16 a[62:63], v49 offset:58368
    v_mfma_f32_16x16x32_bf16 v[236:239], a[20:23], a[228:231], v[236:239]
    s_add_u32 s52, s47, 528384
    v_mfma_f32_16x16x32_bf16 a[104:107], a[20:23], a[232:235], a[104:107]
    v_mfma_f32_16x16x32_bf16 a[108:111], a[20:23], a[236:239], a[108:111]
    buffer_store_dwordx4 v[156:159], v1, s[32:35], s52 offen offset:3072 sc1
    v_mfma_f32_16x16x32_bf16 v[240:243], a[24:27], a[224:227], v[240:243]
    v_mfma_f32_16x16x32_bf16 v[244:247], a[24:27], a[228:231], v[244:247]
    v_mfma_f32_16x16x32_bf16 a[112:115], a[24:27], a[232:235], a[112:115]
    v_mfma_f32_16x16x32_bf16 a[116:119], a[24:27], a[236:239], a[116:119]
    v_mfma_f32_16x16x32_bf16 v[248:251], a[28:31], a[224:227], v[248:251]
    v_mfma_f32_16x16x32_bf16 v[252:255], a[28:31], a[228:231], v[252:255]
    v_mfma_f32_16x16x32_bf16 a[120:123], a[28:31], a[232:235], a[120:123]
    v_mfma_f32_16x16x32_bf16 a[124:127], a[28:31], a[236:239], a[124:127]
    s_waitcnt vmcnt(12) lgkmcnt(0)
    s_barrier
    v_mfma_f32_16x16x32_bf16 v[192:195], a[32:35], a[240:243], v[192:195]
    ds_read_b64_tr_b16 a[0:1], v42 offset:0
    ds_read_b64_tr_b16 a[2:3], v42 offset:1024
    v_mfma_f32_16x16x32_bf16 v[196:199], a[32:35], a[244:247], v[196:199]
    s_add_u32 m0, s60, 114688
    v_mfma_f32_16x16x32_bf16 a[64:67], a[32:35], a[248:251], a[64:67]
    buffer_load_dwordx4 v38, s[12:15], s61 offen offset:0 lds
    ds_read_b64_tr_b16 a[4:5], v43 offset:0
    v_mfma_f32_16x16x32_bf16 a[68:71], a[32:35], a[252:255], a[68:71]
    ds_read_b64_tr_b16 a[6:7], v43 offset:1024
    v_mfma_f32_16x16x32_bf16 v[200:203], a[36:39], a[240:243], v[200:203]
    buffer_load_dwordx4 v39, s[12:15], s61 offen offset:1024 lds
    ds_read_b64_tr_b16 a[8:9], v44 offset:0
    v_mfma_f32_16x16x32_bf16 v[204:207], a[36:39], a[244:247], v[204:207]
    v_mfma_f32_16x16x32_bf16 a[72:75], a[36:39], a[248:251], a[72:75]
    ds_read_b64_tr_b16 a[10:11], v44 offset:1024
    v_mfma_f32_16x16x32_bf16 a[76:79], a[36:39], a[252:255], a[76:79]
    buffer_load_dwordx4 v40, s[12:15], s61 offen offset:2048 lds
    ds_read_b64_tr_b16 a[12:13], v45 offset:0
    v_mfma_f32_16x16x32_bf16 v[208:211], a[40:43], a[240:243], v[208:211]
    v_mfma_f32_16x16x32_bf16 v[212:215], a[40:43], a[244:247], v[212:215]
    ds_read_b64_tr_b16 a[14:15], v45 offset:1024
    v_mfma_f32_16x16x32_bf16 a[80:83], a[40:43], a[248:251], a[80:83]
    buffer_load_dwordx4 v41, s[12:15], s61 offen offset:3072 lds
    ds_read_b64_tr_b16 a[16:17], v46 offset:0
    v_mfma_f32_16x16x32_bf16 a[84:87], a[40:43], a[252:255], a[84:87]
    ds_read_b64_tr_b16 a[18:19], v46 offset:1024
    v_mfma_f32_16x16x32_bf16 v[216:219], a[44:47], a[240:243], v[216:219]
    s_add_u32 s61, s61, 0x80000
    v_mfma_f32_16x16x32_bf16 v[220:223], a[44:47], a[244:247], v[220:223]
    buffer_load_dwordx4 a[224:227], v36, s[8:11], s62 offen offset:0 sc1
    ds_read_b64_tr_b16 a[20:21], v47 offset:0
    v_mfma_f32_16x16x32_bf16 a[88:91], a[44:47], a[248:251], a[88:91]
    ds_read_b64_tr_b16 a[22:23], v47 offset:1024
    v_mfma_f32_16x16x32_bf16 a[92:95], a[44:47], a[252:255], a[92:95]
    ds_read_b64_tr_b16 a[24:25], v48 offset:0
    v_mfma_f32_16x16x32_bf16 v[224:227], a[48:51], a[240:243], v[224:227]
    buffer_load_dwordx4 a[228:231], v36, s[8:11], s62 offen offset:1024 sc1
    v_mfma_f32_16x16x32_bf16 v[228:231], a[48:51], a[244:247], v[228:231]
    ds_read_b64_tr_b16 a[26:27], v48 offset:1024
    v_mfma_f32_16x16x32_bf16 a[96:99], a[48:51], a[248:251], a[96:99]
    ds_read_b64_tr_b16 a[28:29], v49 offset:0
    v_mfma_f32_16x16x32_bf16 a[100:103], a[48:51], a[252:255], a[100:103]
    buffer_load_dwordx4 a[232:235], v37, s[8:11], s62 offen offset:0 sc1
    v_mfma_f32_16x16x32_bf16 v[232:235], a[52:55], a[240:243], v[232:235]
    ds_read_b64_tr_b16 a[30:31], v49 offset:1024
    v_mfma_f32_16x16x32_bf16 v[236:239], a[52:55], a[244:247], v[236:239]
    v_mfma_f32_16x16x32_bf16 a[104:107], a[52:55], a[248:251], a[104:107]
    buffer_load_dwordx4 a[236:239], v37, s[8:11], s62 offen offset:1024 sc1
    v_mfma_f32_16x16x32_bf16 a[108:111], a[52:55], a[252:255], a[108:111]
    v_mfma_f32_16x16x32_bf16 v[240:243], a[56:59], a[240:243], v[240:243]
    s_add_u32 s62, s62, 0x20000
    v_mfma_f32_16x16x32_bf16 v[244:247], a[56:59], a[244:247], v[244:247]
    s_add_u32 s52, s47, 532480
    v_mfma_f32_16x16x32_bf16 a[112:115], a[56:59], a[248:251], a[112:115]
    buffer_store_dwordx4 v[160:163], v1, s[32:35], s52 offen offset:0 sc1
    v_mfma_f32_16x16x32_bf16 a[116:119], a[56:59], a[252:255], a[116:119]
    v_mfma_f32_16x16x32_bf16 v[248:251], a[60:63], a[240:243], v[248:251]
    v_mfma_f32_16x16x32_bf16 v[252:255], a[60:63], a[244:247], v[252:255]
    v_mfma_f32_16x16x32_bf16 a[120:123], a[60:63], a[248:251], a[120:123]
    v_mfma_f32_16x16x32_bf16 a[124:127], a[60:63], a[252:255], a[124:127]
    s_waitcnt vmcnt(17) lgkmcnt(0)
    v_mfma_f32_16x16x32_bf16 v[192:195], a[0:3], a[192:195], v[192:195]
    ds_read_b64_tr_b16 a[32:33], v42 offset:8192
    ds_read_b64_tr_b16 a[34:35], v42 offset:9216
    v_mfma_f32_16x16x32_bf16 v[196:199], a[0:3], a[196:199], v[196:199]
    buffer_load_dwordx4 a[240:243], v36, s[8:11], s62 offen offset:0 sc1
    v_mfma_f32_16x16x32_bf16 a[64:67], a[0:3], a[200:203], a[64:67]
    ds_read_b64_tr_b16 a[36:37], v43 offset:8192
    v_mfma_f32_16x16x32_bf16 a[68:71], a[0:3], a[204:207], a[68:71]
    ds_read_b64_tr_b16 a[38:39], v43 offset:9216
    v_mfma_f32_16x16x32_bf16 v[200:203], a[4:7], a[192:195], v[200:203]
    ds_read_b64_tr_b16 a[40:41], v44 offset:8192
    v_mfma_f32_16x16x32_bf16 v[204:207], a[4:7], a[196:199], v[204:207]
    buffer_load_dwordx4 a[244:247], v36, s[8:11], s62 offen offset:1024 sc1
    v_mfma_f32_16x16x32_bf16 a[72:75], a[4:7], a[200:203], a[72:75]
    ds_read_b64_tr_b16 a[42:43], v44 offset:9216
    v_mfma_f32_16x16x32_bf16 a[76:79], a[4:7], a[204:207], a[76:79]
    ds_read_b64_tr_b16 a[44:45], v45 offset:8192
    v_mfma_f32_16x16x32_bf16 v[208:211], a[8:11], a[192:195], v[208:211]
    v_mfma_f32_16x16x32_bf16 v[212:215], a[8:11], a[196:199], v[212:215]
    ds_read_b64_tr_b16 a[46:47], v45 offset:9216
    v_mfma_f32_16x16x32_bf16 a[80:83], a[8:11], a[200:203], a[80:83]
    buffer_load_dwordx4 a[248:251], v37, s[8:11], s62 offen offset:0 sc1
    ds_read_b64_tr_b16 a[48:49], v46 offset:8192
    v_mfma_f32_16x16x32_bf16 a[84:87], a[8:11], a[204:207], a[84:87]
    ds_read_b64_tr_b16 a[50:51], v46 offset:9216
    v_mfma_f32_16x16x32_bf16 v[216:219], a[12:15], a[192:195], v[216:219]
    v_mfma_f32_16x16x32_bf16 v[220:223], a[12:15], a[196:199], v[220:223]
    ds_read_b64_tr_b16 a[52:53], v47 offset:8192
    v_mfma_f32_16x16x32_bf16 a[88:91], a[12:15], a[200:203], a[88:91]
    buffer_load_dwordx4 a[252:255], v37, s[8:11], s62 offen offset:1024 sc1
    ds_read_b64_tr_b16 a[54:55], v47 offset:9216
    v_mfma_f32_16x16x32_bf16 a[92:95], a[12:15], a[204:207], a[92:95]
    ds_read_b64_tr_b16 a[56:57], v48 offset:8192
    v_mfma_f32_16x16x32_bf16 v[224:227], a[16:19], a[192:195], v[224:227]
    v_mfma_f32_16x16x32_bf16 v[228:231], a[16:19], a[196:199], v[228:231]
    ds_read_b64_tr_b16 a[58:59], v48 offset:9216
    v_mfma_f32_16x16x32_bf16 a[96:99], a[16:19], a[200:203], a[96:99]
    s_add_u32 s62, s62, 0x20000
    ds_read_b64_tr_b16 a[60:61], v49 offset:8192
    v_mfma_f32_16x16x32_bf16 a[100:103], a[16:19], a[204:207], a[100:103]
    s_add_u32 s52, s47, 532480
    v_mfma_f32_16x16x32_bf16 v[232:235], a[20:23], a[192:195], v[232:235]
    buffer_store_dwordx4 v[164:167], v1, s[32:35], s52 offen offset:1024 sc1
    ds_read_b64_tr_b16 a[62:63], v49 offset:9216
    v_mfma_f32_16x16x32_bf16 v[236:239], a[20:23], a[196:199], v[236:239]
    s_add_u32 s52, s47, 532480
    v_mfma_f32_16x16x32_bf16 a[104:107], a[20:23], a[200:203], a[104:107]
    v_mfma_f32_16x16x32_bf16 a[108:111], a[20:23], a[204:207], a[108:111]
    buffer_store_dwordx4 v[168:171], v1, s[32:35], s52 offen offset:2048 sc1
    v_mfma_f32_16x16x32_bf16 v[240:243], a[24:27], a[192:195], v[240:243]
    v_mfma_f32_16x16x32_bf16 v[244:247], a[24:27], a[196:199], v[244:247]
    v_mfma_f32_16x16x32_bf16 a[112:115], a[24:27], a[200:203], a[112:115]
    v_mfma_f32_16x16x32_bf16 a[116:119], a[24:27], a[204:207], a[116:119]
    v_mfma_f32_16x16x32_bf16 v[248:251], a[28:31], a[192:195], v[248:251]
    v_mfma_f32_16x16x32_bf16 v[252:255], a[28:31], a[196:199], v[252:255]
    v_mfma_f32_16x16x32_bf16 a[120:123], a[28:31], a[200:203], a[120:123]
    v_mfma_f32_16x16x32_bf16 a[124:127], a[28:31], a[204:207], a[124:127]
    s_waitcnt vmcnt(11) lgkmcnt(0)
    s_barrier
    v_mfma_f32_16x16x32_bf16 v[192:195], a[32:35], a[208:211], v[192:195]
    ds_read_b64_tr_b16 a[0:1], v42 offset:16384
    ds_read_b64_tr_b16 a[2:3], v42 offset:17408
    v_mfma_f32_16x16x32_bf16 v[196:199], a[32:35], a[212:215], v[196:199]
    s_add_u32 m0, s60, 131072
    v_mfma_f32_16x16x32_bf16 a[64:67], a[32:35], a[216:219], a[64:67]
    buffer_load_dwordx4 v38, s[12:15], s61 offen offset:0 lds
    ds_read_b64_tr_b16 a[4:5], v43 offset:16384
    v_mfma_f32_16x16x32_bf16 a[68:71], a[32:35], a[220:223], a[68:71]
    ds_read_b64_tr_b16 a[6:7], v43 offset:17408
    v_mfma_f32_16x16x32_bf16 v[200:203], a[36:39], a[208:211], v[200:203]
    buffer_load_dwordx4 v39, s[12:15], s61 offen offset:1024 lds
    ds_read_b64_tr_b16 a[8:9], v44 offset:16384
    v_mfma_f32_16x16x32_bf16 v[204:207], a[36:39], a[212:215], v[204:207]
    v_mfma_f32_16x16x32_bf16 a[72:75], a[36:39], a[216:219], a[72:75]
    ds_read_b64_tr_b16 a[10:11], v44 offset:17408
    v_mfma_f32_16x16x32_bf16 a[76:79], a[36:39], a[220:223], a[76:79]
    buffer_load_dwordx4 v40, s[12:15], s61 offen offset:2048 lds
    ds_read_b64_tr_b16 a[12:13], v45 offset:16384
    v_mfma_f32_16x16x32_bf16 v[208:211], a[40:43], a[208:211], v[208:211]
    v_mfma_f32_16x16x32_bf16 v[212:215], a[40:43], a[212:215], v[212:215]
    ds_read_b64_tr_b16 a[14:15], v45 offset:17408
    v_mfma_f32_16x16x32_bf16 a[80:83], a[40:43], a[216:219], a[80:83]
    buffer_load_dwordx4 v41, s[12:15], s61 offen offset:3072 lds
    ds_read_b64_tr_b16 a[16:17], v46 offset:16384
    v_mfma_f32_16x16x32_bf16 a[84:87], a[40:43], a[220:223], a[84:87]
    ds_read_b64_tr_b16 a[18:19], v46 offset:17408
    v_mfma_f32_16x16x32_bf16 v[216:219], a[44:47], a[208:211], v[216:219]
    s_add_u32 s61, s61, 0x80000
    v_mfma_f32_16x16x32_bf16 v[220:223], a[44:47], a[212:215], v[220:223]
    buffer_load_dwordx4 a[192:195], v36, s[8:11], s62 offen offset:0 sc1
    ds_read_b64_tr_b16 a[20:21], v47 offset:16384
    v_mfma_f32_16x16x32_bf16 a[88:91], a[44:47], a[216:219], a[88:91]
    ds_read_b64_tr_b16 a[22:23], v47 offset:17408
    v_mfma_f32_16x16x32_bf16 a[92:95], a[44:47], a[220:223], a[92:95]
    ds_read_b64_tr_b16 a[24:25], v48 offset:16384
    v_mfma_f32_16x16x32_bf16 v[224:227], a[48:51], a[208:211], v[224:227]
    buffer_load_dwordx4 a[196:199], v36, s[8:11], s62 offen offset:1024 sc1
    v_mfma_f32_16x16x32_bf16 v[228:231], a[48:51], a[212:215], v[228:231]
    ds_read_b64_tr_b16 a[26:27], v48 offset:17408
    v_mfma_f32_16x16x32_bf16 a[96:99], a[48:51], a[216:219], a[96:99]
    ds_read_b64_tr_b16 a[28:29], v49 offset:16384
    v_mfma_f32_16x16x32_bf16 a[100:103], a[48:51], a[220:223], a[100:103]
    buffer_load_dwordx4 a[200:203], v37, s[8:11], s62 offen offset:0 sc1
    v_mfma_f32_16x16x32_bf16 v[232:235], a[52:55], a[208:211], v[232:235]
    ds_read_b64_tr_b16 a[30:31], v49 offset:17408
    v_mfma_f32_16x16x32_bf16 v[236:239], a[52:55], a[212:215], v[236:239]
    v_mfma_f32_16x16x32_bf16 a[104:107], a[52:55], a[216:219], a[104:107]
    buffer_load_dwordx4 a[204:207], v37, s[8:11], s62 offen offset:1024 sc1
    v_mfma_f32_16x16x32_bf16 a[108:111], a[52:55], a[220:223], a[108:111]
    v_mfma_f32_16x16x32_bf16 v[240:243], a[56:59], a[208:211], v[240:243]
    s_add_u32 s62, s62, 0x20000
    v_mfma_f32_16x16x32_bf16 v[244:247], a[56:59], a[212:215], v[244:247]
    s_add_u32 s52, s47, 532480
    v_mfma_f32_16x16x32_bf16 a[112:115], a[56:59], a[216:219], a[112:115]
    buffer_store_dwordx4 v[172:175], v1, s[32:35], s52 offen offset:3072 sc1
    v_mfma_f32_16x16x32_bf16 a[116:119], a[56:59], a[220:223], a[116:119]
    v_mfma_f32_16x16x32_bf16 v[248:251], a[60:63], a[208:211], v[248:251]
    v_mfma_f32_16x16x32_bf16 v[252:255], a[60:63], a[212:215], v[252:255]
    v_mfma_f32_16x16x32_bf16 a[120:123], a[60:63], a[216:219], a[120:123]
    v_mfma_f32_16x16x32_bf16 a[124:127], a[60:63], a[220:223], a[124:127]
    s_waitcnt vmcnt(16) lgkmcnt(0)
    v_mfma_f32_16x16x32_bf16 v[192:195], a[0:3], a[224:227], v[192:195]
    ds_read_b64_tr_b16 a[32:33], v42 offset:24576
    ds_read_b64_tr_b16 a[34:35], v42 offset:25600
    v_mfma_f32_16x16x32_bf16 v[196:199], a[0:3], a[228:231], v[196:199]
    buffer_load_dwordx4 a[208:211], v36, s[8:11], s62 offen offset:0 sc1
    v_mfma_f32_16x16x32_bf16 a[64:67], a[0:3], a[232:235], a[64:67]
    ds_read_b64_tr_b16 a[36:37], v43 offset:24576
    v_mfma_f32_16x16x32_bf16 a[68:71], a[0:3], a[236:239], a[68:71]
    ds_read_b64_tr_b16 a[38:39], v43 offset:25600
    v_mfma_f32_16x16x32_bf16 v[200:203], a[4:7], a[224:227], v[200:203]
    ds_read_b64_tr_b16 a[40:41], v44 offset:24576
    v_mfma_f32_16x16x32_bf16 v[204:207], a[4:7], a[228:231], v[204:207]
    buffer_load_dwordx4 a[212:215], v36, s[8:11], s62 offen offset:1024 sc1
    v_mfma_f32_16x16x32_bf16 a[72:75], a[4:7], a[232:235], a[72:75]
    ds_read_b64_tr_b16 a[42:43], v44 offset:25600
    v_mfma_f32_16x16x32_bf16 a[76:79], a[4:7], a[236:239], a[76:79]
    ds_read_b64_tr_b16 a[44:45], v45 offset:24576
    v_mfma_f32_16x16x32_bf16 v[208:211], a[8:11], a[224:227], v[208:211]
    v_mfma_f32_16x16x32_bf16 v[212:215], a[8:11], a[228:231], v[212:215]
    ds_read_b64_tr_b16 a[46:47], v45 offset:25600
    v_mfma_f32_16x16x32_bf16 a[80:83], a[8:11], a[232:235], a[80:83]
    buffer_load_dwordx4 a[216:219], v37, s[8:11], s62 offen offset:0 sc1
    ds_read_b64_tr_b16 a[48:49], v46 offset:24576
    v_mfma_f32_16x16x32_bf16 a[84:87], a[8:11], a[236:239], a[84:87]
    ds_read_b64_tr_b16 a[50:51], v46 offset:25600
    v_mfma_f32_16x16x32_bf16 v[216:219], a[12:15], a[224:227], v[216:219]
    v_mfma_f32_16x16x32_bf16 v[220:223], a[12:15], a[228:231], v[220:223]
    ds_read_b64_tr_b16 a[52:53], v47 offset:24576
    v_mfma_f32_16x16x32_bf16 a[88:91], a[12:15], a[232:235], a[88:91]
    buffer_load_dwordx4 a[220:223], v37, s[8:11], s62 offen offset:1024 sc1
    ds_read_b64_tr_b16 a[54:55], v47 offset:25600
    v_mfma_f32_16x16x32_bf16 a[92:95], a[12:15], a[236:239], a[92:95]
    ds_read_b64_tr_b16 a[56:57], v48 offset:24576
    v_mfma_f32_16x16x32_bf16 v[224:227], a[16:19], a[224:227], v[224:227]
    v_mfma_f32_16x16x32_bf16 v[228:231], a[16:19], a[228:231], v[228:231]
    ds_read_b64_tr_b16 a[58:59], v48 offset:25600
    v_mfma_f32_16x16x32_bf16 a[96:99], a[16:19], a[232:235], a[96:99]
    s_add_u32 s62, s62, 0x20000
    ds_read_b64_tr_b16 a[60:61], v49 offset:24576
    v_mfma_f32_16x16x32_bf16 a[100:103], a[16:19], a[236:239], a[100:103]
    s_add_u32 s52, s47, 536576
    v_mfma_f32_16x16x32_bf16 v[232:235], a[20:23], a[224:227], v[232:235]
    buffer_store_dwordx4 v[176:179], v1, s[32:35], s52 offen offset:0 sc1
    ds_read_b64_tr_b16 a[62:63], v49 offset:25600
    v_mfma_f32_16x16x32_bf16 v[236:239], a[20:23], a[228:231], v[236:239]
    s_add_u32 s52, s47, 536576
    v_mfma_f32_16x16x32_bf16 a[104:107], a[20:23], a[232:235], a[104:107]
    v_mfma_f32_16x16x32_bf16 a[108:111], a[20:23], a[236:239], a[108:111]
    buffer_store_dwordx4 v[180:183], v1, s[32:35], s52 offen offset:1024 sc1
    v_mfma_f32_16x16x32_bf16 v[240:243], a[24:27], a[224:227], v[240:243]
    v_mfma_f32_16x16x32_bf16 v[244:247], a[24:27], a[228:231], v[244:247]
    v_mfma_f32_16x16x32_bf16 a[112:115], a[24:27], a[232:235], a[112:115]
    v_mfma_f32_16x16x32_bf16 a[116:119], a[24:27], a[236:239], a[116:119]
    v_mfma_f32_16x16x32_bf16 v[248:251], a[28:31], a[224:227], v[248:251]
    v_mfma_f32_16x16x32_bf16 v[252:255], a[28:31], a[228:231], v[252:255]
    v_mfma_f32_16x16x32_bf16 a[120:123], a[28:31], a[232:235], a[120:123]
    v_mfma_f32_16x16x32_bf16 a[124:127], a[28:31], a[236:239], a[124:127]
    s_waitcnt vmcnt(11) lgkmcnt(0)
    s_barrier
    v_mfma_f32_16x16x32_bf16 v[192:195], a[32:35], a[240:243], v[192:195]
    ds_read_b64_tr_b16 a[0:1], v42 offset:32768
    ds_read_b64_tr_b16 a[2:3], v42 offset:33792
    v_mfma_f32_16x16x32_bf16 v[196:199], a[32:35], a[244:247], v[196:199]
    s_add_u32 m0, s60, 147456
    v_mfma_f32_16x16x32_bf16 a[64:67], a[32:35], a[248:251], a[64:67]
    buffer_load_dwordx4 v38, s[12:15], s61 offen offset:0 lds
    ds_read_b64_tr_b16 a[4:5], v43 offset:32768
    v_mfma_f32_16x16x32_bf16 a[68:71], a[32:35], a[252:255], a[68:71]
    ds_read_b64_tr_b16 a[6:7], v43 offset:33792
    v_mfma_f32_16x16x32_bf16 v[200:203], a[36:39], a[240:243], v[200:203]
    buffer_load_dwordx4 v39, s[12:15], s61 offen offset:1024 lds
    ds_read_b64_tr_b16 a[8:9], v44 offset:32768
    v_mfma_f32_16x16x32_bf16 v[204:207], a[36:39], a[244:247], v[204:207]
    v_mfma_f32_16x16x32_bf16 a[72:75], a[36:39], a[248:251], a[72:75]
    buffer_load_dwordx4 v40, s[12:15], s61 offen offset:2048 lds
    ds_read_b64_tr_b16 a[10:11], v44 offset:33792
    v_mfma_f32_16x16x32_bf16 a[76:79], a[36:39], a[252:255], a[76:79]
    ds_read_b64_tr_b16 a[12:13], v45 offset:32768
    v_mfma_f32_16x16x32_bf16 v[208:211], a[40:43], a[240:243], v[208:211]
    v_mfma_f32_16x16x32_bf16 v[212:215], a[40:43], a[244:247], v[212:215]
    buffer_load_dwordx4 v41, s[12:15], s61 offen offset:3072 lds
    ds_read_b64_tr_b16 a[14:15], v45 offset:33792
    v_mfma_f32_16x16x32_bf16 a[80:83], a[40:43], a[248:251], a[80:83]
    ds_read_b64_tr_b16 a[16:17], v46 offset:32768
    v_mfma_f32_16x16x32_bf16 a[84:87], a[40:43], a[252:255], a[84:87]
    s_add_u32 s61, s61, 0x80000
    ds_read_b64_tr_b16 a[18:19], v46 offset:33792
    v_mfma_f32_16x16x32_bf16 v[216:219], a[44:47], a[240:243], v[216:219]
    buffer_load_dwordx4 a[224:227], v36, s[8:11], s62 offen offset:0 sc1
    v_mfma_f32_16x16x32_bf16 v[220:223], a[44:47], a[244:247], v[220:223]
    ds_read_b64_tr_b16 a[20:21], v47 offset:32768
    v_mfma_f32_16x16x32_bf16 a[88:91], a[44:47], a[248:251], a[88:91]
    buffer_load_dwordx4 a[228:231], v36, s[8:11], s62 offen offset:1024 sc1
    ds_read_b64_tr_b16 a[22:23], v47 offset:33792
    v_mfma_f32_16x16x32_bf16 a[92:95], a[44:47], a[252:255], a[92:95]
    ds_read_b64_tr_b16 a[24:25], v48 offset:32768
    v_mfma_f32_16x16x32_bf16 v[224:227], a[48:51], a[240:243], v[224:227]
    v_mfma_f32_16x16x32_bf16 v[228:231], a[48:51], a[244:247], v[228:231]
    buffer_load_dwordx4 a[232:235], v37, s[8:11], s62 offen offset:0 sc1
    ds_read_b64_tr_b16 a[26:27], v48 offset:33792
    v_mfma_f32_16x16x32_bf16 a[96:99], a[48:51], a[248:251], a[96:99]
    ds_read_b64_tr_b16 a[28:29], v49 offset:32768
    v_mfma_f32_16x16x32_bf16 a[100:103], a[48:51], a[252:255], a[100:103]
    v_mfma_f32_16x16x32_bf16 v[232:235], a[52:55], a[240:243], v[232:235]
    buffer_load_dwordx4 a[236:239], v37, s[8:11], s62 offen offset:1024 sc1
    ds_read_b64_tr_b16 a[30:31], v49 offset:33792
    v_mfma_f32_16x16x32_bf16 v[236:239], a[52:55], a[244:247], v[236:239]
    v_mfma_f32_16x16x32_bf16 a[104:107], a[52:55], a[248:251], a[104:107]
    s_add_u32 s62, s62, 0x20000
    v_mfma_f32_16x16x32_bf16 a[108:111], a[52:55], a[252:255], a[108:111]
    s_add_u32 s52, s47, 536576
    v_mfma_f32_16x16x32_bf16 v[240:243], a[56:59], a[240:243], v[240:243]
    buffer_store_dwordx4 v[184:187], v1, s[32:35], s52 offen offset:2048 sc1
    v_mfma_f32_16x16x32_bf16 v[244:247], a[56:59], a[244:247], v[244:247]
    s_add_u32 s52, s47, 536576
    v_mfma_f32_16x16x32_bf16 a[112:115], a[56:59], a[248:251], a[112:115]
    buffer_store_dwordx4 v[188:191], v1, s[32:35], s52 offen offset:3072 sc1
    v_mfma_f32_16x16x32_bf16 a[116:119], a[56:59], a[252:255], a[116:119]
    v_mfma_f32_16x16x32_bf16 v[248:251], a[60:63], a[240:243], v[248:251]
    v_mfma_f32_16x16x32_bf16 v[252:255], a[60:63], a[244:247], v[252:255]
    v_mfma_f32_16x16x32_bf16 a[120:123], a[60:63], a[248:251], a[120:123]
    v_mfma_f32_16x16x32_bf16 a[124:127], a[60:63], a[252:255], a[124:127]
    s_waitcnt vmcnt(17) lgkmcnt(0)
    v_mfma_f32_16x16x32_bf16 v[192:195], a[0:3], a[192:195], v[192:195]
    ds_read_b64_tr_b16 a[32:33], v42 offset:40960
    ds_read_b64_tr_b16 a[34:35], v42 offset:41984
    v_mfma_f32_16x16x32_bf16 v[196:199], a[0:3], a[196:199], v[196:199]
    buffer_load_dwordx4 a[240:243], v36, s[8:11], s62 offen offset:0 sc1
    v_mfma_f32_16x16x32_bf16 a[64:67], a[0:3], a[200:203], a[64:67]
    ds_read_b64_tr_b16 a[36:37], v43 offset:40960
    v_mfma_f32_16x16x32_bf16 a[68:71], a[0:3], a[204:207], a[68:71]
    ds_read_b64_tr_b16 a[38:39], v43 offset:41984
    v_mfma_f32_16x16x32_bf16 v[200:203], a[4:7], a[192:195], v[200:203]
    ds_read_b64_tr_b16 a[40:41], v44 offset:40960
    v_mfma_f32_16x16x32_bf16 v[204:207], a[4:7], a[196:199], v[204:207]
    v_mfma_f32_16x16x32_bf16 a[72:75], a[4:7], a[200:203], a[72:75]
    ds_read_b64_tr_b16 a[42:43], v44 offset:41984
    v_mfma_f32_16x16x32_bf16 a[76:79], a[4:7], a[204:207], a[76:79]
    ds_read_b64_tr_b16 a[44:45], v45 offset:40960
    v_mfma_f32_16x16x32_bf16 v[208:211], a[8:11], a[192:195], v[208:211]
    buffer_load_dwordx4 a[244:247], v36, s[8:11], s62 offen offset:1024 sc1
    v_mfma_f32_16x16x32_bf16 v[212:215], a[8:11], a[196:199], v[212:215]
    ds_read_b64_tr_b16 a[46:47], v45 offset:41984
    v_mfma_f32_16x16x32_bf16 a[80:83], a[8:11], a[200:203], a[80:83]
    ds_read_b64_tr_b16 a[48:49], v46 offset:40960
    v_mfma_f32_16x16x32_bf16 a[84:87], a[8:11], a[204:207], a[84:87]
    ds_read_b64_tr_b16 a[50:51], v46 offset:41984
    v_mfma_f32_16x16x32_bf16 v[216:219], a[12:15], a[192:195], v[216:219]
    v_mfma_f32_16x16x32_bf16 v[220:223], a[12:15], a[196:199], v[220:223]
    ds_read_b64_tr_b16 a[52:53], v47 offset:40960
    v_mfma_f32_16x16x32_bf16 a[88:91], a[12:15], a[200:203], a[88:91]
    buffer_load_dwordx4 a[248:251], v37, s[8:11], s62 offen offset:0 sc1
    ds_read_b64_tr_b16 a[54:55], v47 offset:41984
    v_mfma_f32_16x16x32_bf16 a[92:95], a[12:15], a[204:207], a[92:95]
    ds_read_b64_tr_b16 a[56:57], v48 offset:40960
    v_mfma_f32_16x16x32_bf16 v[224:227], a[16:19], a[192:195], v[224:227]
    v_mfma_f32_16x16x32_bf16 v[228:231], a[16:19], a[196:199], v[228:231]
    ds_read_b64_tr_b16 a[58:59], v48 offset:41984
    v_mfma_f32_16x16x32_bf16 a[96:99], a[16:19], a[200:203], a[96:99]
    ds_read_b64_tr_b16 a[60:61], v49 offset:40960
    v_mfma_f32_16x16x32_bf16 a[100:103], a[16:19], a[204:207], a[100:103]
    v_mfma_f32_16x16x32_bf16 v[232:235], a[20:23], a[192:195], v[232:235]
    ds_read_b64_tr_b16 a[62:63], v49 offset:41984
    v_mfma_f32_16x16x32_bf16 v[236:239], a[20:23], a[196:199], v[236:239]
    buffer_load_dwordx4 a[252:255], v37, s[8:11], s62 offen offset:1024 sc1
    v_mfma_f32_16x16x32_bf16 a[104:107], a[20:23], a[200:203], a[104:107]
    v_mfma_f32_16x16x32_bf16 a[108:111], a[20:23], a[204:207], a[108:111]
    v_mfma_f32_16x16x32_bf16 v[240:243], a[24:27], a[192:195], v[240:243]
    v_mfma_f32_16x16x32_bf16 v[244:247], a[24:27], a[196:199], v[244:247]
    v_mfma_f32_16x16x32_bf16 a[112:115], a[24:27], a[200:203], a[112:115]
    v_mfma_f32_16x16x32_bf16 a[116:119], a[24:27], a[204:207], a[116:119]
    s_add_u32 s62, s62, 0x20000
    v_mfma_f32_16x16x32_bf16 v[248:251], a[28:31], a[192:195], v[248:251]
    v_mfma_f32_16x16x32_bf16 v[252:255], a[28:31], a[196:199], v[252:255]
    v_mfma_f32_16x16x32_bf16 a[120:123], a[28:31], a[200:203], a[120:123]
    v_mfma_f32_16x16x32_bf16 a[124:127], a[28:31], a[204:207], a[124:127]
    s_waitcnt vmcnt(10) lgkmcnt(0)
    s_barrier
    v_mfma_f32_16x16x32_bf16 v[192:195], a[32:35], a[208:211], v[192:195]
    ds_read_b64_tr_b16 a[0:1], v42 offset:49152
    ds_read_b64_tr_b16 a[2:3], v42 offset:50176
    v_mfma_f32_16x16x32_bf16 v[196:199], a[32:35], a[212:215], v[196:199]
    s_add_u32 m0, s60, 98304
    v_mfma_f32_16x16x32_bf16 a[64:67], a[32:35], a[216:219], a[64:67]
    buffer_load_dwordx4 v38, s[12:15], s61 offen offset:0 lds
    ds_read_b64_tr_b16 a[4:5], v43 offset:49152
    v_mfma_f32_16x16x32_bf16 a[68:71], a[32:35], a[220:223], a[68:71]
    ds_read_b64_tr_b16 a[6:7], v43 offset:50176
    v_mfma_f32_16x16x32_bf16 v[200:203], a[36:39], a[208:211], v[200:203]
    buffer_load_dwordx4 v39, s[12:15], s61 offen offset:1024 lds
    ds_read_b64_tr_b16 a[8:9], v44 offset:49152
    v_mfma_f32_16x16x32_bf16 v[204:207], a[36:39], a[212:215], v[204:207]
    v_mfma_f32_16x16x32_bf16 a[72:75], a[36:39], a[216:219], a[72:75]
    ds_read_b64_tr_b16 a[10:11], v44 offset:50176
    v_mfma_f32_16x16x32_bf16 a[76:79], a[36:39], a[220:223], a[76:79]
    ds_read_b64_tr_b16 a[12:13], v45 offset:49152
    v_mfma_f32_16x16x32_bf16 v[208:211], a[40:43], a[208:211], v[208:211]
    buffer_load_dwordx4 v40, s[12:15], s61 offen offset:2048 lds
    v_mfma_f32_16x16x32_bf16 v[212:215], a[40:43], a[212:215], v[212:215]
    ds_read_b64_tr_b16 a[14:15], v45 offset:50176
    v_mfma_f32_16x16x32_bf16 a[80:83], a[40:43], a[216:219], a[80:83]
    ds_read_b64_tr_b16 a[16:17], v46 offset:49152
    v_mfma_f32_16x16x32_bf16 a[84:87], a[40:43], a[220:223], a[84:87]
    buffer_load_dwordx4 v41, s[12:15], s61 offen offset:3072 lds
    ds_read_b64_tr_b16 a[18:19], v46 offset:50176
    v_mfma_f32_16x16x32_bf16 v[216:219], a[44:47], a[208:211], v[216:219]
    v_mfma_f32_16x16x32_bf16 v[220:223], a[44:47], a[212:215], v[220:223]
    s_add_u32 s61, s61, 0x80000
    ds_read_b64_tr_b16 a[20:21], v47 offset:49152
    v_mfma_f32_16x16x32_bf16 a[88:91], a[44:47], a[216:219], a[88:91]
    buffer_load_dwordx4 a[192:195], v36, s[8:11], s62 offen offset:0 sc1
    ds_read_b64_tr_b16 a[22:23], v47 offset:50176
    v_mfma_f32_16x16x32_bf16 a[92:95], a[44:47], a[220:223], a[92:95]
    ds_read_b64_tr_b16 a[24:25], v48 offset:49152
    v_mfma_f32_16x16x32_bf16 v[224:227], a[48:51], a[208:211], v[224:227]
    v_mfma_f32_16x16x32_bf16 v[228:231], a[48:51], a[212:215], v[228:231]
    ds_read_b64_tr_b16 a[26:27], v48 offset:50176
    v_mfma_f32_16x16x32_bf16 a[96:99], a[48:51], a[216:219], a[96:99]
    buffer_load_dwordx4 a[196:199], v36, s[8:11], s62 offen offset:1024 sc1
    ds_read_b64_tr_b16 a[28:29], v49 offset:49152
    v_mfma_f32_16x16x32_bf16 a[100:103], a[48:51], a[220:223], a[100:103]
    v_mfma_f32_16x16x32_bf16 v[232:235], a[52:55], a[208:211], v[232:235]
    ds_read_b64_tr_b16 a[30:31], v49 offset:50176
    v_mfma_f32_16x16x32_bf16 v[236:239], a[52:55], a[212:215], v[236:239]
    buffer_load_dwordx4 a[200:203], v37, s[8:11], s62 offen offset:0 sc1
    v_mfma_f32_16x16x32_bf16 a[104:107], a[52:55], a[216:219], a[104:107]
    v_mfma_f32_16x16x32_bf16 a[108:111], a[52:55], a[220:223], a[108:111]
    v_mfma_f32_16x16x32_bf16 v[240:243], a[56:59], a[208:211], v[240:243]
    v_mfma_f32_16x16x32_bf16 v[244:247], a[56:59], a[212:215], v[244:247]
    buffer_load_dwordx4 a[204:207], v37, s[8:11], s62 offen offset:1024 sc1
    v_mfma_f32_16x16x32_bf16 a[112:115], a[56:59], a[216:219], a[112:115]
    v_mfma_f32_16x16x32_bf16 a[116:119], a[56:59], a[220:223], a[116:119]
    s_add_u32 s62, s62, 0x20000
    v_mfma_f32_16x16x32_bf16 v[248:251], a[60:63], a[208:211], v[248:251]
    v_mfma_f32_16x16x32_bf16 v[252:255], a[60:63], a[212:215], v[252:255]
    v_mfma_f32_16x16x32_bf16 a[120:123], a[60:63], a[216:219], a[120:123]
    v_mfma_f32_16x16x32_bf16 a[124:127], a[60:63], a[220:223], a[124:127]
    s_waitcnt vmcnt(14) lgkmcnt(0)
    v_mfma_f32_16x16x32_bf16 v[192:195], a[0:3], a[224:227], v[192:195]
    ds_read_b64_tr_b16 a[32:33], v42 offset:57344
    ds_read_b64_tr_b16 a[34:35], v42 offset:58368
    v_mfma_f32_16x16x32_bf16 v[196:199], a[0:3], a[228:231], v[196:199]
    buffer_load_dwordx4 a[208:211], v36, s[8:11], s62 offen offset:0 sc1
    v_mfma_f32_16x16x32_bf16 a[64:67], a[0:3], a[232:235], a[64:67]
    ds_read_b64_tr_b16 a[36:37], v43 offset:57344
    v_mfma_f32_16x16x32_bf16 a[68:71], a[0:3], a[236:239], a[68:71]
    ds_read_b64_tr_b16 a[38:39], v43 offset:58368
    v_mfma_f32_16x16x32_bf16 v[200:203], a[4:7], a[224:227], v[200:203]
    ds_read_b64_tr_b16 a[40:41], v44 offset:57344
    v_mfma_f32_16x16x32_bf16 v[204:207], a[4:7], a[228:231], v[204:207]
    v_mfma_f32_16x16x32_bf16 a[72:75], a[4:7], a[232:235], a[72:75]
    ds_read_b64_tr_b16 a[42:43], v44 offset:58368
    v_mfma_f32_16x16x32_bf16 a[76:79], a[4:7], a[236:239], a[76:79]
    ds_read_b64_tr_b16 a[44:45], v45 offset:57344
    v_mfma_f32_16x16x32_bf16 v[208:211], a[8:11], a[224:227], v[208:211]
    buffer_load_dwordx4 a[212:215], v36, s[8:11], s62 offen offset:1024 sc1
    v_mfma_f32_16x16x32_bf16 v[212:215], a[8:11], a[228:231], v[212:215]
    ds_read_b64_tr_b16 a[46:47], v45 offset:58368
    v_mfma_f32_16x16x32_bf16 a[80:83], a[8:11], a[232:235], a[80:83]
    ds_read_b64_tr_b16 a[48:49], v46 offset:57344
    v_mfma_f32_16x16x32_bf16 a[84:87], a[8:11], a[236:239], a[84:87]
    ds_read_b64_tr_b16 a[50:51], v46 offset:58368
    v_mfma_f32_16x16x32_bf16 v[216:219], a[12:15], a[224:227], v[216:219]
    v_mfma_f32_16x16x32_bf16 v[220:223], a[12:15], a[228:231], v[220:223]
    ds_read_b64_tr_b16 a[52:53], v47 offset:57344
    v_mfma_f32_16x16x32_bf16 a[88:91], a[12:15], a[232:235], a[88:91]
    buffer_load_dwordx4 a[216:219], v37, s[8:11], s62 offen offset:0 sc1
    ds_read_b64_tr_b16 a[54:55], v47 offset:58368
    v_mfma_f32_16x16x32_bf16 a[92:95], a[12:15], a[236:239], a[92:95]
    ds_read_b64_tr_b16 a[56:57], v48 offset:57344
    v_mfma_f32_16x16x32_bf16 v[224:227], a[16:19], a[224:227], v[224:227]
    v_mfma_f32_16x16x32_bf16 v[228:231], a[16:19], a[228:231], v[228:231]
    ds_read_b64_tr_b16 a[58:59], v48 offset:58368
    v_mfma_f32_16x16x32_bf16 a[96:99], a[16:19], a[232:235], a[96:99]
    ds_read_b64_tr_b16 a[60:61], v49 offset:57344
    v_mfma_f32_16x16x32_bf16 a[100:103], a[16:19], a[236:239], a[100:103]
    v_mfma_f32_16x16x32_bf16 v[232:235], a[20:23], a[224:227], v[232:235]
    ds_read_b64_tr_b16 a[62:63], v49 offset:58368
    v_mfma_f32_16x16x32_bf16 v[236:239], a[20:23], a[228:231], v[236:239]
    buffer_load_dwordx4 a[220:223], v37, s[8:11], s62 offen offset:1024 sc1
    v_mfma_f32_16x16x32_bf16 a[104:107], a[20:23], a[232:235], a[104:107]
    v_mfma_f32_16x16x32_bf16 a[108:111], a[20:23], a[236:239], a[108:111]
    v_mfma_f32_16x16x32_bf16 v[240:243], a[24:27], a[224:227], v[240:243]
    v_mfma_f32_16x16x32_bf16 v[244:247], a[24:27], a[228:231], v[244:247]
    v_mfma_f32_16x16x32_bf16 a[112:115], a[24:27], a[232:235], a[112:115]
    v_mfma_f32_16x16x32_bf16 a[116:119], a[24:27], a[236:239], a[116:119]
    s_add_u32 s62, s62, 0x20000
    v_mfma_f32_16x16x32_bf16 v[248:251], a[28:31], a[224:227], v[248:251]
    v_mfma_f32_16x16x32_bf16 v[252:255], a[28:31], a[228:231], v[252:255]
    v_mfma_f32_16x16x32_bf16 a[120:123], a[28:31], a[232:235], a[120:123]
    v_mfma_f32_16x16x32_bf16 a[124:127], a[28:31], a[236:239], a[124:127]
    s_waitcnt vmcnt(8) lgkmcnt(0)
    s_barrier
    v_mfma_f32_16x16x32_bf16 v[192:195], a[32:35], a[240:243], v[192:195]
    ds_read_b64_tr_b16 a[0:1], v42 offset:0
    ds_read_b64_tr_b16 a[2:3], v42 offset:1024
    v_mfma_f32_16x16x32_bf16 v[196:199], a[32:35], a[244:247], v[196:199]
    s_cmp_eq_u32 s30, 0
    s_cbranch_scc1 k12_ool_35
k12_oolret_36:
    v_mfma_f32_16x16x32_bf16 a[64:67], a[32:35], a[248:251], a[64:67]
    s_add_u32 m0, s60, 114688
    ds_read_b64_tr_b16 a[4:5], v43 offset:0
    v_mfma_f32_16x16x32_bf16 a[68:71], a[32:35], a[252:255], a[68:71]
    buffer_load_dwordx4 v38, s[12:15], s61 offen offset:0 lds
    ds_read_b64_tr_b16 a[6:7], v43 offset:1024
    v_mfma_f32_16x16x32_bf16 v[200:203], a[36:39], a[240:243], v[200:203]
    buffer_load_dwordx4 v39, s[12:15], s61 offen offset:1024 lds
    ds_read_b64_tr_b16 a[8:9], v44 offset:0
    v_mfma_f32_16x16x32_bf16 v[204:207], a[36:39], a[244:247], v[204:207]
    v_mfma_f32_16x16x32_bf16 a[72:75], a[36:39], a[248:251], a[72:75]
    ds_read_b64_tr_b16 a[10:11], v44 offset:1024
    v_mfma_f32_16x16x32_bf16 a[76:79], a[36:39], a[252:255], a[76:79]
    ds_read_b64_tr_b16 a[12:13], v45 offset:0
    v_mfma_f32_16x16x32_bf16 v[208:211], a[40:43], a[240:243], v[208:211]
    s_mov_b32 s32, s60
    buffer_load_dwordx4 v40, s[12:15], s61 offen offset:2048 lds
    v_mfma_f32_16x16x32_bf16 v[212:215], a[40:43], a[244:247], v[212:215]
    ds_read_b64_tr_b16 a[14:15], v45 offset:1024
    v_mfma_f32_16x16x32_bf16 a[80:83], a[40:43], a[248:251], a[80:83]
    s_mov_b32 s34, s60
    ds_read_b64_tr_b16 a[16:17], v46 offset:0
    v_mfma_f32_16x16x32_bf16 a[84:87], a[40:43], a[252:255], a[84:87]
    buffer_load_dwordx4 v41, s[12:15], s61 offen offset:3072 lds
    ds_read_b64_tr_b16 a[18:19], v46 offset:1024
    v_mfma_f32_16x16x32_bf16 v[216:219], a[44:47], a[240:243], v[216:219]
    v_mfma_f32_16x16x32_bf16 v[220:223], a[44:47], a[244:247], v[220:223]
    s_mov_b32 s33, s60
    ds_read_b64_tr_b16 a[20:21], v47 offset:0
    v_mfma_f32_16x16x32_bf16 a[88:91], a[44:47], a[248:251], a[88:91]
    s_add_u32 s61, s61, 0x80000
    buffer_load_dwordx4 a[224:227], v36, s[8:11], s62 offen offset:0 sc1
    ds_read_b64_tr_b16 a[22:23], v47 offset:1024
    v_mfma_f32_16x16x32_bf16 a[92:95], a[44:47], a[252:255], a[92:95]
    ds_read_b64_tr_b16 a[24:25], v48 offset:0
    v_mfma_f32_16x16x32_bf16 v[224:227], a[48:51], a[240:243], v[224:227]
    s_add_u32 s35, s60, 0x10000
    v_mfma_f32_16x16x32_bf16 v[228:231], a[48:51], a[244:247], v[228:231]
    ds_read_b64_tr_b16 a[26:27], v48 offset:1024
    v_mfma_f32_16x16x32_bf16 a[96:99], a[48:51], a[248:251], a[96:99]
    buffer_load_dwordx4 a[228:231], v36, s[8:11], s62 offen offset:1024 sc1
    ds_read_b64_tr_b16 a[28:29], v49 offset:0
    v_mfma_f32_16x16x32_bf16 a[100:103], a[48:51], a[252:255], a[100:103]
    v_mfma_f32_16x16x32_bf16 v[232:235], a[52:55], a[240:243], v[232:235]
    ds_read_b64_tr_b16 a[30:31], v49 offset:1024
    v_mfma_f32_16x16x32_bf16 v[236:239], a[52:55], a[244:247], v[236:239]
    buffer_load_dwordx4 a[232:235], v37, s[8:11], s62 offen offset:0 sc1
    v_mfma_f32_16x16x32_bf16 a[104:107], a[52:55], a[248:251], a[104:107]
    v_mfma_f32_16x16x32_bf16 a[108:111], a[52:55], a[252:255], a[108:111]
    v_mfma_f32_16x16x32_bf16 v[240:243], a[56:59], a[240:243], v[240:243]
    v_mfma_f32_16x16x32_bf16 v[244:247], a[56:59], a[244:247], v[244:247]
    buffer_load_dwordx4 a[236:239], v37, s[8:11], s62 offen offset:1024 sc1
    v_mfma_f32_16x16x32_bf16 a[112:115], a[56:59], a[248:251], a[112:115]
    v_mfma_f32_16x16x32_bf16 a[116:119], a[56:59], a[252:255], a[116:119]
    s_add_u32 s62, s62, 0x20000
    v_mfma_f32_16x16x32_bf16 v[248:251], a[60:63], a[240:243], v[248:251]
    v_mfma_f32_16x16x32_bf16 v[252:255], a[60:63], a[244:247], v[252:255]
    v_mfma_f32_16x16x32_bf16 a[120:123], a[60:63], a[248:251], a[120:123]
    v_mfma_f32_16x16x32_bf16 a[124:127], a[60:63], a[252:255], a[124:127]
    s_waitcnt vmcnt(12) lgkmcnt(0)
    v_mfma_f32_16x16x32_bf16 v[192:195], a[0:3], a[192:195], v[192:195]
    ds_read_b64_tr_b16 a[32:33], v42 offset:8192
    ds_read_b64_tr_b16 a[34:35], v42 offset:9216
    v_mfma_f32_16x16x32_bf16 v[196:199], a[0:3], a[196:199], v[196:199]
    buffer_load_dwordx4 a[240:243], v36, s[8:11], s62 offen offset:0 sc1
    v_mfma_f32_16x16x32_bf16 a[64:67], a[0:3], a[200:203], a[64:67]
    ds_read_b64_tr_b16 a[36:37], v43 offset:8192
    v_mfma_f32_16x16x32_bf16 a[68:71], a[0:3], a[204:207], a[68:71]
    ds_read_b64_tr_b16 a[38:39], v43 offset:9216
    v_mfma_f32_16x16x32_bf16 v[200:203], a[4:7], a[192:195], v[200:203]
    ds_read_b64_tr_b16 a[40:41], v44 offset:8192
    v_mfma_f32_16x16x32_bf16 v[204:207], a[4:7], a[196:199], v[204:207]
    v_mfma_f32_16x16x32_bf16 a[72:75], a[4:7], a[200:203], a[72:75]
    ds_read_b64_tr_b16 a[42:43], v44 offset:9216
    v_mfma_f32_16x16x32_bf16 a[76:79], a[4:7], a[204:207], a[76:79]
    ds_read_b64_tr_b16 a[44:45], v45 offset:8192
    v_mfma_f32_16x16x32_bf16 v[208:211], a[8:11], a[192:195], v[208:211]
    buffer_load_dwordx4 a[244:247], v36, s[8:11], s62 offen offset:1024 sc1
    v_mfma_f32_16x16x32_bf16 v[212:215], a[8:11], a[196:199], v[212:215]
    ds_read_b64_tr_b16 a[46:47], v45 offset:9216
    v_mfma_f32_16x16x32_bf16 a[80:83], a[8:11], a[200:203], a[80:83]
    ds_read_b64_tr_b16 a[48:49], v46 offset:8192
    v_mfma_f32_16x16x32_bf16 a[84:87], a[8:11], a[204:207], a[84:87]
    ds_read_b64_tr_b16 a[50:51], v46 offset:9216
    v_mfma_f32_16x16x32_bf16 v[216:219], a[12:15], a[192:195], v[216:219]
    v_mfma_f32_16x16x32_bf16 v[220:223], a[12:15], a[196:199], v[220:223]
    ds_read_b64_tr_b16 a[52:53], v47 offset:8192
    v_mfma_f32_16x16x32_bf16 a[88:91], a[12:15], a[200:203], a[88:91]
    buffer_load_dwordx4 a[248:251], v37, s[8:11], s62 offen offset:0 sc1
    ds_read_b64_tr_b16 a[54:55], v47 offset:9216
    v_mfma_f32_16x16x32_bf16 a[92:95], a[12:15], a[204:207], a[92:95]
    ds_read_b64_tr_b16 a[56:57], v48 offset:8192
    v_mfma_f32_16x16x32_bf16 v[224:227], a[16:19], a[192:195], v[224:227]
    v_mfma_f32_16x16x32_bf16 v[228:231], a[16:19], a[196:199], v[228:231]
    ds_read_b64_tr_b16 a[58:59], v48 offset:9216
    v_mfma_f32_16x16x32_bf16 a[96:99], a[16:19], a[200:203], a[96:99]
    ds_read_b64_tr_b16 a[60:61], v49 offset:8192
    v_mfma_f32_16x16x32_bf16 a[100:103], a[16:19], a[204:207], a[100:103]
    v_mfma_f32_16x16x32_bf16 v[232:235], a[20:23], a[192:195], v[232:235]
    ds_read_b64_tr_b16 a[62:63], v49 offset:9216
    v_mfma_f32_16x16x32_bf16 v[236:239], a[20:23], a[196:199], v[236:239]
    buffer_load_dwordx4 a[252:255], v37, s[8:11], s62 offen offset:1024 sc1
    v_mfma_f32_16x16x32_bf16 a[104:107], a[20:23], a[200:203], a[104:107]
    v_mfma_f32_16x16x32_bf16 a[108:111], a[20:23], a[204:207], a[108:111]
    v_mfma_f32_16x16x32_bf16 v[240:243], a[24:27], a[192:195], v[240:243]
    v_mfma_f32_16x16x32_bf16 v[244:247], a[24:27], a[196:199], v[244:247]
    v_mfma_f32_16x16x32_bf16 a[112:115], a[24:27], a[200:203], a[112:115]
    v_mfma_f32_16x16x32_bf16 a[116:119], a[24:27], a[204:207], a[116:119]
    s_add_u32 s62, s62, 0x20000
    v_mfma_f32_16x16x32_bf16 v[248:251], a[28:31], a[192:195], v[248:251]
    v_mfma_f32_16x16x32_bf16 v[252:255], a[28:31], a[196:199], v[252:255]
    v_mfma_f32_16x16x32_bf16 a[120:123], a[28:31], a[200:203], a[120:123]
    v_mfma_f32_16x16x32_bf16 a[124:127], a[28:31], a[204:207], a[124:127]
    s_waitcnt vmcnt(8) lgkmcnt(0)
    s_barrier
    v_mfma_f32_16x16x32_bf16 v[192:195], a[32:35], a[208:211], v[192:195]
    ds_read_b64_tr_b16 a[0:1], v42 offset:16384
    ds_read_b64_tr_b16 a[2:3], v42 offset:17408
    v_mfma_f32_16x16x32_bf16 v[196:199], a[32:35], a[212:215], v[196:199]
    s_add_u32 m0, s60, 131072
    v_mfma_f32_16x16x32_bf16 a[64:67], a[32:35], a[216:219], a[64:67]
    buffer_load_dwordx4 v38, s[12:15], s61 offen offset:0 lds
    ds_read_b64_tr_b16 a[4:5], v43 offset:16384
    v_mfma_f32_16x16x32_bf16 a[68:71], a[32:35], a[220:223], a[68:71]
    ds_read_b64_tr_b16 a[6:7], v43 offset:17408
    v_mfma_f32_16x16x32_bf16 v[200:203], a[36:39], a[208:211], v[200:203]
    buffer_load_dwordx4 v39, s[12:15], s61 offen offset:1024 lds
    ds_read_b64_tr_b16 a[8:9], v44 offset:16384
    v_mfma_f32_16x16x32_bf16 v[204:207], a[36:39], a[212:215], v[204:207]
    v_mfma_f32_16x16x32_bf16 a[72:75], a[36:39], a[216:219], a[72:75]
    ds_read_b64_tr_b16 a[10:11], v44 offset:17408
    v_mfma_f32_16x16x32_bf16 a[76:79], a[36:39], a[220:223], a[76:79]
    ds_read_b64_tr_b16 a[12:13], v45 offset:16384
    v_mfma_f32_16x16x32_bf16 v[208:211], a[40:43], a[208:211], v[208:211]
    buffer_load_dwordx4 v40, s[12:15], s61 offen offset:2048 lds
    v_mfma_f32_16x16x32_bf16 v[212:215], a[40:43], a[212:215], v[212:215]
    ds_read_b64_tr_b16 a[14:15], v45 offset:17408
    v_mfma_f32_16x16x32_bf16 a[80:83], a[40:43], a[216:219], a[80:83]
    ds_read_b64_tr_b16 a[16:17], v46 offset:16384
    v_mfma_f32_16x16x32_bf16 a[84:87], a[40:43], a[220:223], a[84:87]
    buffer_load_dwordx4 v41, s[12:15], s61 offen offset:3072 lds
    ds_read_b64_tr_b16 a[18:19], v46 offset:17408
    v_mfma_f32_16x16x32_bf16 v[216:219], a[44:47], a[208:211], v[216:219]
    v_mfma_f32_16x16x32_bf16 v[220:223], a[44:47], a[212:215], v[220:223]
    s_add_u32 s61, s61, 0x80000
    ds_read_b64_tr_b16 a[20:21], v47 offset:16384
    v_mfma_f32_16x16x32_bf16 a[88:91], a[44:47], a[216:219], a[88:91]
    buffer_load_dwordx4 a[192:195], v36, s[8:11], s62 offen offset:0 sc1
    ds_read_b64_tr_b16 a[22:23], v47 offset:17408
    v_mfma_f32_16x16x32_bf16 a[92:95], a[44:47], a[220:223], a[92:95]
    ds_read_b64_tr_b16 a[24:25], v48 offset:16384
    v_mfma_f32_16x16x32_bf16 v[224:227], a[48:51], a[208:211], v[224:227]
    v_mfma_f32_16x16x32_bf16 v[228:231], a[48:51], a[212:215], v[228:231]
    ds_read_b64_tr_b16 a[26:27], v48 offset:17408
    v_mfma_f32_16x16x32_bf16 a[96:99], a[48:51], a[216:219], a[96:99]
    buffer_load_dwordx4 a[196:199], v36, s[8:11], s62 offen offset:1024 sc1
    ds_read_b64_tr_b16 a[28:29], v49 offset:16384
    v_mfma_f32_16x16x32_bf16 a[100:103], a[48:51], a[220:223], a[100:103]
    v_mfma_f32_16x16x32_bf16 v[232:235], a[52:55], a[208:211], v[232:235]
    ds_read_b64_tr_b16 a[30:31], v49 offset:17408
    v_mfma_f32_16x16x32_bf16 v[236:239], a[52:55], a[212:215], v[236:239]
    buffer_load_dwordx4 a[200:203], v37, s[8:11], s62 offen offset:0 sc1
    v_mfma_f32_16x16x32_bf16 a[104:107], a[52:55], a[216:219], a[104:107]
    v_mfma_f32_16x16x32_bf16 a[108:111], a[52:55], a[220:223], a[108:111]
    v_mfma_f32_16x16x32_bf16 v[240:243], a[56:59], a[208:211], v[240:243]
    v_mfma_f32_16x16x32_bf16 v[244:247], a[56:59], a[212:215], v[244:247]
    buffer_load_dwordx4 a[204:207], v37, s[8:11], s62 offen offset:1024 sc1
    v_mfma_f32_16x16x32_bf16 a[112:115], a[56:59], a[216:219], a[112:115]
    v_mfma_f32_16x16x32_bf16 a[116:119], a[56:59], a[220:223], a[116:119]
    s_add_u32 s62, s62, 0x20000
    v_mfma_f32_16x16x32_bf16 v[248:251], a[60:63], a[208:211], v[248:251]
    v_mfma_f32_16x16x32_bf16 v[252:255], a[60:63], a[212:215], v[252:255]
    v_mfma_f32_16x16x32_bf16 a[120:123], a[60:63], a[216:219], a[120:123]
    v_mfma_f32_16x16x32_bf16 a[124:127], a[60:63], a[220:223], a[124:127]
    s_waitcnt vmcnt(12) lgkmcnt(0)
    v_mfma_f32_16x16x32_bf16 v[192:195], a[0:3], a[224:227], v[192:195]
    ds_read_b64_tr_b16 a[32:33], v42 offset:24576
    ds_read_b64_tr_b16 a[34:35], v42 offset:25600
    v_mfma_f32_16x16x32_bf16 v[196:199], a[0:3], a[228:231], v[196:199]
    buffer_load_dwordx4 a[208:211], v36, s[8:11], s62 offen offset:0 sc1
    v_mfma_f32_16x16x32_bf16 a[64:67], a[0:3], a[232:235], a[64:67]
    ds_read_b64_tr_b16 a[36:37], v43 offset:24576
    v_mfma_f32_16x16x32_bf16 a[68:71], a[0:3], a[236:239], a[68:71]
    ds_read_b64_tr_b16 a[38:39], v43 offset:25600
    v_mfma_f32_16x16x32_bf16 v[200:203], a[4:7], a[224:227], v[200:203]
    ds_read_b64_tr_b16 a[40:41], v44 offset:24576
    v_mfma_f32_16x16x32_bf16 v[204:207], a[4:7], a[228:231], v[204:207]
    v_mfma_f32_16x16x32_bf16 a[72:75], a[4:7], a[232:235], a[72:75]
    ds_read_b64_tr_b16 a[42:43], v44 offset:25600
    v_mfma_f32_16x16x32_bf16 a[76:79], a[4:7], a[236:239], a[76:79]
    ds_read_b64_tr_b16 a[44:45], v45 offset:24576
    v_mfma_f32_16x16x32_bf16 v[208:211], a[8:11], a[224:227], v[208:211]
    buffer_load_dwordx4 a[212:215], v36, s[8:11], s62 offen offset:1024 sc1
    v_mfma_f32_16x16x32_bf16 v[212:215], a[8:11], a[228:231], v[212:215]
    ds_read_b64_tr_b16 a[46:47], v45 offset:25600
    v_mfma_f32_16x16x32_bf16 a[80:83], a[8:11], a[232:235], a[80:83]
    ds_read_b64_tr_b16 a[48:49], v46 offset:24576
    v_mfma_f32_16x16x32_bf16 a[84:87], a[8:11], a[236:239], a[84:87]
    ds_read_b64_tr_b16 a[50:51], v46 offset:25600
    v_mfma_f32_16x16x32_bf16 v[216:219], a[12:15], a[224:227], v[216:219]
    v_mfma_f32_16x16x32_bf16 v[220:223], a[12:15], a[228:231], v[220:223]
    ds_read_b64_tr_b16 a[52:53], v47 offset:24576
    v_mfma_f32_16x16x32_bf16 a[88:91], a[12:15], a[232:235], a[88:91]
    buffer_load_dwordx4 a[216:219], v37, s[8:11], s62 offen offset:0 sc1
    ds_read_b64_tr_b16 a[54:55], v47 offset:25600
    v_mfma_f32_16x16x32_bf16 a[92:95], a[12:15], a[236:239], a[92:95]
    ds_read_b64_tr_b16 a[56:57], v48 offset:24576
    v_mfma_f32_16x16x32_bf16 v[224:227], a[16:19], a[224:227], v[224:227]
    v_mfma_f32_16x16x32_bf16 v[228:231], a[16:19], a[228:231], v[228:231]
    ds_read_b64_tr_b16 a[58:59], v48 offset:25600
    v_mfma_f32_16x16x32_bf16 a[96:99], a[16:19], a[232:235], a[96:99]
    ds_read_b64_tr_b16 a[60:61], v49 offset:24576
    v_mfma_f32_16x16x32_bf16 a[100:103], a[16:19], a[236:239], a[100:103]
    v_mfma_f32_16x16x32_bf16 v[232:235], a[20:23], a[224:227], v[232:235]
    ds_read_b64_tr_b16 a[62:63], v49 offset:25600
    v_mfma_f32_16x16x32_bf16 v[236:239], a[20:23], a[228:231], v[236:239]
    buffer_load_dwordx4 a[220:223], v37, s[8:11], s62 offen offset:1024 sc1
    v_mfma_f32_16x16x32_bf16 a[104:107], a[20:23], a[232:235], a[104:107]
    v_mfma_f32_16x16x32_bf16 a[108:111], a[20:23], a[236:239], a[108:111]
    v_mfma_f32_16x16x32_bf16 v[240:243], a[24:27], a[224:227], v[240:243]
    v_mfma_f32_16x16x32_bf16 v[244:247], a[24:27], a[228:231], v[244:247]
    v_mfma_f32_16x16x32_bf16 a[112:115], a[24:27], a[232:235], a[112:115]
    v_mfma_f32_16x16x32_bf16 a[116:119], a[24:27], a[236:239], a[116:119]
    s_add_u32 s62, s62, 0x20000
    v_mfma_f32_16x16x32_bf16 v[248:251], a[28:31], a[224:227], v[248:251]
    v_mfma_f32_16x16x32_bf16 v[252:255], a[28:31], a[228:231], v[252:255]
    v_mfma_f32_16x16x32_bf16 a[120:123], a[28:31], a[232:235], a[120:123]
    v_mfma_f32_16x16x32_bf16 a[124:127], a[28:31], a[236:239], a[124:127]
    s_waitcnt vmcnt(8) lgkmcnt(0)
    s_barrier
    v_mfma_f32_16x16x32_bf16 v[192:195], a[32:35], a[240:243], v[192:195]
    ds_read_b64_tr_b16 a[0:1], v42 offset:32768
    ds_read_b64_tr_b16 a[2:3], v42 offset:33792
    v_mfma_f32_16x16x32_bf16 v[196:199], a[32:35], a[244:247], v[196:199]
    s_cmp_eq_u32 s30, 0
    s_cbranch_scc1 k12_ool_37
k12_oolret_38:
    v_mfma_f32_16x16x32_bf16 a[64:67], a[32:35], a[248:251], a[64:67]
    s_add_u32 m0, s60, 147456
    ds_read_b64_tr_b16 a[4:5], v43 offset:32768
    v_mfma_f32_16x16x32_bf16 a[68:71], a[32:35], a[252:255], a[68:71]
    buffer_load_dwordx4 v38, s[12:15], s61 offen offset:0 lds
    ds_read_b64_tr_b16 a[6:7], v43 offset:33792
    v_mfma_f32_16x16x32_bf16 v[200:203], a[36:39], a[240:243], v[200:203]
    buffer_load_dwordx4 v39, s[12:15], s61 offen offset:1024 lds
    ds_read_b64_tr_b16 a[8:9], v44 offset:32768
    v_mfma_f32_16x16x32_bf16 v[204:207], a[36:39], a[244:247], v[204:207]
    v_mfma_f32_16x16x32_bf16 a[72:75], a[36:39], a[248:251], a[72:75]
    ds_read_b64_tr_b16 a[10:11], v44 offset:33792
    v_mfma_f32_16x16x32_bf16 a[76:79], a[36:39], a[252:255], a[76:79]
    ds_read_b64_tr_b16 a[12:13], v45 offset:32768
    v_mfma_f32_16x16x32_bf16 v[208:211], a[40:43], a[240:243], v[208:211]
    buffer_load_dwordx4 v40, s[12:15], s61 offen offset:2048 lds
    v_mfma_f32_16x16x32_bf16 v[212:215], a[40:43], a[244:247], v[212:215]
    ds_read_b64_tr_b16 a[14:15], v45 offset:33792
    v_mfma_f32_16x16x32_bf16 a[80:83], a[40:43], a[248:251], a[80:83]
    ds_read_b64_tr_b16 a[16:17], v46 offset:32768
    v_mfma_f32_16x16x32_bf16 a[84:87], a[40:43], a[252:255], a[84:87]
    buffer_load_dwordx4 v41, s[12:15], s61 offen offset:3072 lds
    ds_read_b64_tr_b16 a[18:19], v46 offset:33792
    v_mfma_f32_16x16x32_bf16 v[216:219], a[44:47], a[240:243], v[216:219]
    v_mfma_f32_16x16x32_bf16 v[220:223], a[44:47], a[244:247], v[220:223]
    s_add_u32 s61, s61, 0x80000
    ds_read_b64_tr_b16 a[20:21], v47 offset:32768
    v_mfma_f32_16x16x32_bf16 a[88:91], a[44:47], a[248:251], a[88:91]
    buffer_load_dwordx4 a[224:227], v36, s[8:11], s62 offen offset:0 sc1
    ds_read_b64_tr_b16 a[22:23], v47 offset:33792
    v_mfma_f32_16x16x32_bf16 a[92:95], a[44:47], a[252:255], a[92:95]
    ds_read_b64_tr_b16 a[24:25], v48 offset:32768
    v_mfma_f32_16x16x32_bf16 v[224:227], a[48:51], a[240:243], v[224:227]
    v_mfma_f32_16x16x32_bf16 v[228:231], a[48:51], a[244:247], v[228:231]
    ds_read_b64_tr_b16 a[26:27], v48 offset:33792
    v_mfma_f32_16x16x32_bf16 a[96:99], a[48:51], a[248:251], a[96:99]
    buffer_load_dwordx4 a[228:231], v36, s[8:11], s62 offen offset:1024 sc1
    ds_read_b64_tr_b16 a[28:29], v49 offset:32768
    v_mfma_f32_16x16x32_bf16 a[100:103], a[48:51], a[252:255], a[100:103]
    v_mfma_f32_16x16x32_bf16 v[232:235], a[52:55], a[240:243], v[232:235]
    ds_read_b64_tr_b16 a[30:31], v49 offset:33792
    v_mfma_f32_16x16x32_bf16 v[236:239], a[52:55], a[244:247], v[236:239]
    buffer_load_dwordx4 a[232:235], v37, s[8:11], s62 offen offset:0 sc1
    v_mfma_f32_16x16x32_bf16 a[104:107], a[52:55], a[248:251], a[104:107]
    v_mfma_f32_16x16x32_bf16 a[108:111], a[52:55], a[252:255], a[108:111]
    v_mfma_f32_16x16x32_bf16 v[240:243], a[56:59], a[240:243], v[240:243]
    v_mfma_f32_16x16x32_bf16 v[244:247], a[56:59], a[244:247], v[244:247]
    buffer_load_dwordx4 a[236:239], v37, s[8:11], s62 offen offset:1024 sc1
    v_mfma_f32_16x16x32_bf16 a[112:115], a[56:59], a[248:251], a[112:115]
    v_mfma_f32_16x16x32_bf16 a[116:119], a[56:59], a[252:255], a[116:119]
    s_add_u32 s62, s62, 0x20000
    v_mfma_f32_16x16x32_bf16 v[248:251], a[60:63], a[240:243], v[248:251]
    v_mfma_f32_16x16x32_bf16 v[252:255], a[60:63], a[244:247], v[252:255]
    v_mfma_f32_16x16x32_bf16 a[120:123], a[60:63], a[248:251], a[120:123]
    v_mfma_f32_16x16x32_bf16 a[124:127], a[60:63], a[252:255], a[124:127]
    s_waitcnt vmcnt(12) lgkmcnt(0)
    v_mfma_f32_16x16x32_bf16 v[192:195], a[0:3], a[192:195], v[192:195]
    ds_read_b64_tr_b16 a[32:33], v42 offset:40960
    ds_read_b64_tr_b16 a[34:35], v42 offset:41984
    v_mfma_f32_16x16x32_bf16 v[196:199], a[0:3], a[196:199], v[196:199]
    buffer_load_dwordx4 a[240:243], v36, s[8:11], s62 offen offset:0 sc1
    v_mfma_f32_16x16x32_bf16 a[64:67], a[0:3], a[200:203], a[64:67]
    ds_read_b64_tr_b16 a[36:37], v43 offset:40960
    v_mfma_f32_16x16x32_bf16 a[68:71], a[0:3], a[204:207], a[68:71]
    ds_read_b64_tr_b16 a[38:39], v43 offset:41984
    v_mfma_f32_16x16x32_bf16 v[200:203], a[4:7], a[192:195], v[200:203]
    ds_read_b64_tr_b16 a[40:41], v44 offset:40960
    v_mfma_f32_16x16x32_bf16 v[204:207], a[4:7], a[196:199], v[204:207]
    v_mfma_f32_16x16x32_bf16 a[72:75], a[4:7], a[200:203], a[72:75]
    ds_read_b64_tr_b16 a[42:43], v44 offset:41984
    v_mfma_f32_16x16x32_bf16 a[76:79], a[4:7], a[204:207], a[76:79]
    ds_read_b64_tr_b16 a[44:45], v45 offset:40960
    v_mfma_f32_16x16x32_bf16 v[208:211], a[8:11], a[192:195], v[208:211]
    buffer_load_dwordx4 a[244:247], v36, s[8:11], s62 offen offset:1024 sc1
    v_mfma_f32_16x16x32_bf16 v[212:215], a[8:11], a[196:199], v[212:215]
    ds_read_b64_tr_b16 a[46:47], v45 offset:41984
    v_mfma_f32_16x16x32_bf16 a[80:83], a[8:11], a[200:203], a[80:83]
    ds_read_b64_tr_b16 a[48:49], v46 offset:40960
    v_mfma_f32_16x16x32_bf16 a[84:87], a[8:11], a[204:207], a[84:87]
    ds_read_b64_tr_b16 a[50:51], v46 offset:41984
    v_mfma_f32_16x16x32_bf16 v[216:219], a[12:15], a[192:195], v[216:219]
    v_mfma_f32_16x16x32_bf16 v[220:223], a[12:15], a[196:199], v[220:223]
    ds_read_b64_tr_b16 a[52:53], v47 offset:40960
    v_mfma_f32_16x16x32_bf16 a[88:91], a[12:15], a[200:203], a[88:91]
    buffer_load_dwordx4 a[248:251], v37, s[8:11], s62 offen offset:0 sc1
    ds_read_b64_tr_b16 a[54:55], v47 offset:41984
    v_mfma_f32_16x16x32_bf16 a[92:95], a[12:15], a[204:207], a[92:95]
    ds_read_b64_tr_b16 a[56:57], v48 offset:40960
    v_mfma_f32_16x16x32_bf16 v[224:227], a[16:19], a[192:195], v[224:227]
    v_mfma_f32_16x16x32_bf16 v[228:231], a[16:19], a[196:199], v[228:231]
    ds_read_b64_tr_b16 a[58:59], v48 offset:41984
    v_mfma_f32_16x16x32_bf16 a[96:99], a[16:19], a[200:203], a[96:99]
    ds_read_b64_tr_b16 a[60:61], v49 offset:40960
    v_mfma_f32_16x16x32_bf16 a[100:103], a[16:19], a[204:207], a[100:103]
    v_mfma_f32_16x16x32_bf16 v[232:235], a[20:23], a[192:195], v[232:235]
    ds_read_b64_tr_b16 a[62:63], v49 offset:41984
    v_mfma_f32_16x16x32_bf16 v[236:239], a[20:23], a[196:199], v[236:239]
    buffer_load_dwordx4 a[252:255], v37, s[8:11], s62 offen offset:1024 sc1
    v_mfma_f32_16x16x32_bf16 a[104:107], a[20:23], a[200:203], a[104:107]
    v_mfma_f32_16x16x32_bf16 a[108:111], a[20:23], a[204:207], a[108:111]
    v_mfma_f32_16x16x32_bf16 v[240:243], a[24:27], a[192:195], v[240:243]
    v_mfma_f32_16x16x32_bf16 v[244:247], a[24:27], a[196:199], v[244:247]
    v_mfma_f32_16x16x32_bf16 a[112:115], a[24:27], a[200:203], a[112:115]
    v_mfma_f32_16x16x32_bf16 a[116:119], a[24:27], a[204:207], a[116:119]
    s_add_u32 s62, s62, 0x20000
    v_mfma_f32_16x16x32_bf16 v[248:251], a[28:31], a[192:195], v[248:251]
    s_cmp_eq_u32 s30, 0
    s_cbranch_scc1 k12_ool_41
k12_oolret_42:
    v_mfma_f32_16x16x32_bf16 v[252:255], a[28:31], a[196:199], v[252:255]
    v_mfma_f32_16x16x32_bf16 a[120:123], a[28:31], a[200:203], a[120:123]
    v_mfma_f32_16x16x32_bf16 a[124:127], a[28:31], a[204:207], a[124:127]
    s_waitcnt vmcnt(8) lgkmcnt(0)
    s_barrier
    v_mfma_f32_16x16x32_bf16 v[192:195], a[32:35], a[208:211], v[192:195]
    ds_read_b64_tr_b16 a[0:1], v42 offset:49152
    ds_read_b64_tr_b16 a[2:3], v42 offset:50176
    v_mfma_f32_16x16x32_bf16 v[196:199], a[32:35], a[212:215], v[196:199]
    s_mov_b32 m0, s34
    v_mfma_f32_16x16x32_bf16 a[64:67], a[32:35], a[216:219], a[64:67]
    buffer_load_dwordx4 v1, s[16:19], s32 offen offset:0 sc1 lds
    ds_read_b64_tr_b16 a[4:5], v43 offset:49152
    v_mfma_f32_16x16x32_bf16 a[68:71], a[32:35], a[220:223], a[68:71]
    ds_read_b64_tr_b16 a[6:7], v43 offset:50176
    v_mfma_f32_16x16x32_bf16 v[200:203], a[36:39], a[208:211], v[200:203]
    buffer_load_dwordx4 v1, s[16:19], s32 offen offset:1024 sc1 lds
    ds_read_b64_tr_b16 a[8:9], v44 offset:49152
    v_mfma_f32_16x16x32_bf16 v[204:207], a[36:39], a[212:215], v[204:207]
    v_mfma_f32_16x16x32_bf16 a[72:75], a[36:39], a[216:219], a[72:75]
    ds_read_b64_tr_b16 a[10:11], v44 offset:50176
    v_mfma_f32_16x16x32_bf16 a[76:79], a[36:39], a[220:223], a[76:79]
    ds_read_b64_tr_b16 a[12:13], v45 offset:49152
    v_mfma_f32_16x16x32_bf16 v[208:211], a[40:43], a[208:211], v[208:211]
    buffer_load_dwordx4 v1, s[16:19], s32 offen offset:2048 sc1 lds
    v_mfma_f32_16x16x32_bf16 v[212:215], a[40:43], a[212:215], v[212:215]
    ds_read_b64_tr_b16 a[14:15], v45 offset:50176
    v_mfma_f32_16x16x32_bf16 a[80:83], a[40:43], a[216:219], a[80:83]
    ds_read_b64_tr_b16 a[16:17], v46 offset:49152
    v_mfma_f32_16x16x32_bf16 a[84:87], a[40:43], a[220:223], a[84:87]
    buffer_load_dwordx4 v1, s[16:19], s32 offen offset:3072 sc1 lds
    ds_read_b64_tr_b16 a[18:19], v46 offset:50176
    v_mfma_f32_16x16x32_bf16 v[216:219], a[44:47], a[208:211], v[216:219]
    v_mfma_f32_16x16x32_bf16 v[220:223], a[44:47], a[212:215], v[220:223]
    s_add_u32 s32, s32, 0x80000
    ds_read_b64_tr_b16 a[20:21], v47 offset:49152
    v_mfma_f32_16x16x32_bf16 a[88:91], a[44:47], a[216:219], a[88:91]
    s_add_u32 s34, s34, 0x4000
    ds_read_b64_tr_b16 a[22:23], v47 offset:50176
    v_mfma_f32_16x16x32_bf16 a[92:95], a[44:47], a[220:223], a[92:95]
    s_mov_b32 m0, s34
    ds_read_b64_tr_b16 a[24:25], v48 offset:49152
    v_mfma_f32_16x16x32_bf16 v[224:227], a[48:51], a[208:211], v[224:227]
    buffer_load_dwordx4 v1, s[16:19], s32 offen offset:0 sc1 lds
    v_mfma_f32_16x16x32_bf16 v[228:231], a[48:51], a[212:215], v[228:231]
    ds_read_b64_tr_b16 a[26:27], v48 offset:50176
    v_mfma_f32_16x16x32_bf16 a[96:99], a[48:51], a[216:219], a[96:99]
    buffer_load_dwordx4 v1, s[16:19], s32 offen offset:1024 sc1 lds
    ds_read_b64_tr_b16 a[28:29], v49 offset:49152
    v_mfma_f32_16x16x32_bf16 a[100:103], a[48:51], a[220:223], a[100:103]
    v_mfma_f32_16x16x32_bf16 v[232:235], a[52:55], a[208:211], v[232:235]
    ds_read_b64_tr_b16 a[30:31], v49 offset:50176
    v_mfma_f32_16x16x32_bf16 v[236:239], a[52:55], a[212:215], v[236:239]
    buffer_load_dwordx4 v1, s[16:19], s32 offen offset:2048 sc1 lds
    v_mfma_f32_16x16x32_bf16 a[104:107], a[52:55], a[216:219], a[104:107]
    v_mfma_f32_16x16x32_bf16 a[108:111], a[52:55], a[220:223], a[108:111]
    v_mfma_f32_16x16x32_bf16 v[240:243], a[56:59], a[208:211], v[240:243]
    v_mfma_f32_16x16x32_bf16 v[244:247], a[56:59], a[212:215], v[244:247]
    buffer_load_dwordx4 v1, s[16:19], s32 offen offset:3072 sc1 lds
    v_mfma_f32_16x16x32_bf16 a[112:115], a[56:59], a[216:219], a[112:115]
    v_mfma_f32_16x16x32_bf16 a[116:119], a[56:59], a[220:223], a[116:119]
    s_add_u32 s32, s32, 0x80000
    v_mfma_f32_16x16x32_bf16 v[248:251], a[60:63], a[208:211], v[248:251]
    s_add_u32 s34, s34, 0x4000
    v_mfma_f32_16x16x32_bf16 v[252:255], a[60:63], a[212:215], v[252:255]
    v_mfma_f32_16x16x32_bf16 a[120:123], a[60:63], a[216:219], a[120:123]
    v_mfma_f32_16x16x32_bf16 a[124:127], a[60:63], a[220:223], a[124:127]
    s_waitcnt vmcnt(12) lgkmcnt(0)
    v_mfma_f32_16x16x32_bf16 v[192:195], a[0:3], a[224:227], v[192:195]
    ds_read_b64_tr_b16 a[32:33], v42 offset:57344
    ds_read_b64_tr_b16 a[34:35], v42 offset:58368
    v_mfma_f32_16x16x32_bf16 v[196:199], a[0:3], a[228:231], v[196:199]
    s_mov_b32 m0, s35
    v_mfma_f32_16x16x32_bf16 a[64:67], a[0:3], a[232:235], a[64:67]
    buffer_load_dwordx4 v1, s[20:23], s33 offen offset:0 sc1 lds
    ds_read_b64_tr_b16 a[36:37], v43 offset:57344
    v_mfma_f32_16x16x32_bf16 a[68:71], a[0:3], a[236:239], a[68:71]
    ds_read_b64_tr_b16 a[38:39], v43 offset:58368
    v_mfma_f32_16x16x32_bf16 v[200:203], a[4:7], a[224:227], v[200:203]
    buffer_load_dwordx4 v1, s[20:23], s33 offen offset:1024 sc1 lds
    ds_read_b64_tr_b16 a[40:41], v44 offset:57344
    v_mfma_f32_16x16x32_bf16 v[204:207], a[4:7], a[228:231], v[204:207]
    v_mfma_f32_16x16x32_bf16 a[72:75], a[4:7], a[232:235], a[72:75]
    ds_read_b64_tr_b16 a[42:43], v44 offset:58368
    v_mfma_f32_16x16x32_bf16 a[76:79], a[4:7], a[236:239], a[76:79]
    ds_read_b64_tr_b16 a[44:45], v45 offset:57344
    v_mfma_f32_16x16x32_bf16 v[208:211], a[8:11], a[224:227], v[208:211]
    buffer_load_dwordx4 v1, s[20:23], s33 offen offset:2048 sc1 lds
    v_mfma_f32_16x16x32_bf16 v[212:215], a[8:11], a[228:231], v[212:215]
    ds_read_b64_tr_b16 a[46:47], v45 offset:58368
    v_mfma_f32_16x16x32_bf16 a[80:83], a[8:11], a[232:235], a[80:83]
    ds_read_b64_tr_b16 a[48:49], v46 offset:57344
    v_mfma_f32_16x16x32_bf16 a[84:87], a[8:11], a[236:239], a[84:87]
    buffer_load_dwordx4 v1, s[20:23], s33 offen offset:3072 sc1 lds
    ds_read_b64_tr_b16 a[50:51], v46 offset:58368
    v_mfma_f32_16x16x32_bf16 v[216:219], a[12:15], a[224:227], v[216:219]
    v_mfma_f32_16x16x32_bf16 v[220:223], a[12:15], a[228:231], v[220:223]
    s_add_u32 s33, s33, 0x80000
    ds_read_b64_tr_b16 a[52:53], v47 offset:57344
    v_mfma_f32_16x16x32_bf16 a[88:91], a[12:15], a[232:235], a[88:91]
    s_add_u32 s35, s35, 0x4000
    ds_read_b64_tr_b16 a[54:55], v47 offset:58368
    v_mfma_f32_16x16x32_bf16 a[92:95], a[12:15], a[236:239], a[92:95]
    s_mov_b32 m0, s34
    ds_read_b64_tr_b16 a[56:57], v48 offset:57344
    v_mfma_f32_16x16x32_bf16 v[224:227], a[16:19], a[224:227], v[224:227]
    buffer_load_dwordx4 v1, s[16:19], s32 offen offset:0 sc1 lds
    v_mfma_f32_16x16x32_bf16 v[228:231], a[16:19], a[228:231], v[228:231]
    ds_read_b64_tr_b16 a[58:59], v48 offset:58368
    v_mfma_f32_16x16x32_bf16 a[96:99], a[16:19], a[232:235], a[96:99]
    buffer_load_dwordx4 v1, s[16:19], s32 offen offset:1024 sc1 lds
    ds_read_b64_tr_b16 a[60:61], v49 offset:57344
    v_mfma_f32_16x16x32_bf16 a[100:103], a[16:19], a[236:239], a[100:103]
    v_mfma_f32_16x16x32_bf16 v[232:235], a[20:23], a[224:227], v[232:235]
    ds_read_b64_tr_b16 a[62:63], v49 offset:58368
    v_mfma_f32_16x16x32_bf16 v[236:239], a[20:23], a[228:231], v[236:239]
    buffer_load_dwordx4 v1, s[16:19], s32 offen offset:2048 sc1 lds
    v_mfma_f32_16x16x32_bf16 a[104:107], a[20:23], a[232:235], a[104:107]
    v_mfma_f32_16x16x32_bf16 a[108:111], a[20:23], a[236:239], a[108:111]
    v_mfma_f32_16x16x32_bf16 v[240:243], a[24:27], a[224:227], v[240:243]
    v_mfma_f32_16x16x32_bf16 v[244:247], a[24:27], a[228:231], v[244:247]
    buffer_load_dwordx4 v1, s[16:19], s32 offen offset:3072 sc1 lds
    v_mfma_f32_16x16x32_bf16 a[112:115], a[24:27], a[232:235], a[112:115]
    v_mfma_f32_16x16x32_bf16 a[116:119], a[24:27], a[236:239], a[116:119]
    s_add_u32 s32, s32, 0x80000
    v_mfma_f32_16x16x32_bf16 v[248:251], a[28:31], a[224:227], v[248:251]
    s_add_u32 s34, s34, 0x4000
    v_mfma_f32_16x16x32_bf16 v[252:255], a[28:31], a[228:231], v[252:255]
    v_mfma_f32_16x16x32_bf16 a[120:123], a[28:31], a[232:235], a[120:123]
    v_mfma_f32_16x16x32_bf16 a[124:127], a[28:31], a[236:239], a[124:127]
    s_waitcnt vmcnt(16) lgkmcnt(0)
    s_barrier
    v_mfma_f32_16x16x32_bf16 v[192:195], a[32:35], a[240:243], v[192:195]
    v_mfma_f32_16x16x32_bf16 v[196:199], a[32:35], a[244:247], v[196:199]
    s_mov_b32 m0, s35
    v_mfma_f32_16x16x32_bf16 a[64:67], a[32:35], a[248:251], a[64:67]
    buffer_load_dwordx4 v1, s[20:23], s33 offen offset:0 sc1 lds
    v_mfma_f32_16x16x32_bf16 a[68:71], a[32:35], a[252:255], a[68:71]
    v_mfma_f32_16x16x32_bf16 v[200:203], a[36:39], a[240:243], v[200:203]
    v_mfma_f32_16x16x32_bf16 v[204:207], a[36:39], a[244:247], v[204:207]
    v_mfma_f32_16x16x32_bf16 a[72:75], a[36:39], a[248:251], a[72:75]
    v_mfma_f32_16x16x32_bf16 a[76:79], a[36:39], a[252:255], a[76:79]
    v_mfma_f32_16x16x32_bf16 v[208:211], a[40:43], a[240:243], v[208:211]
    buffer_load_dwordx4 v1, s[20:23], s33 offen offset:1024 sc1 lds
    v_mfma_f32_16x16x32_bf16 v[212:215], a[40:43], a[244:247], v[212:215]
    v_mfma_f32_16x16x32_bf16 a[80:83], a[40:43], a[248:251], a[80:83]
    v_mfma_f32_16x16x32_bf16 a[84:87], a[40:43], a[252:255], a[84:87]
    v_mfma_f32_16x16x32_bf16 v[216:219], a[44:47], a[240:243], v[216:219]
    v_mfma_f32_16x16x32_bf16 v[220:223], a[44:47], a[244:247], v[220:223]
    v_mfma_f32_16x16x32_bf16 a[88:91], a[44:47], a[248:251], a[88:91]
    buffer_load_dwordx4 v1, s[20:23], s33 offen offset:2048 sc1 lds
    v_mfma_f32_16x16x32_bf16 a[92:95], a[44:47], a[252:255], a[92:95]
    v_mfma_f32_16x16x32_bf16 v[224:227], a[48:51], a[240:243], v[224:227]
    v_mfma_f32_16x16x32_bf16 v[228:231], a[48:51], a[244:247], v[228:231]
    v_mfma_f32_16x16x32_bf16 a[96:99], a[48:51], a[248:251], a[96:99]
    v_mfma_f32_16x16x32_bf16 a[100:103], a[48:51], a[252:255], a[100:103]
    v_mfma_f32_16x16x32_bf16 v[232:235], a[52:55], a[240:243], v[232:235]
    v_mfma_f32_16x16x32_bf16 v[236:239], a[52:55], a[244:247], v[236:239]
    buffer_load_dwordx4 v1, s[20:23], s33 offen offset:3072 sc1 lds
    v_mfma_f32_16x16x32_bf16 a[104:107], a[52:55], a[248:251], a[104:107]
    v_mfma_f32_16x16x32_bf16 a[108:111], a[52:55], a[252:255], a[108:111]
    v_mfma_f32_16x16x32_bf16 v[240:243], a[56:59], a[240:243], v[240:243]
    v_mfma_f32_16x16x32_bf16 v[244:247], a[56:59], a[244:247], v[244:247]
    v_mfma_f32_16x16x32_bf16 a[112:115], a[56:59], a[248:251], a[112:115]
    v_mfma_f32_16x16x32_bf16 a[116:119], a[56:59], a[252:255], a[116:119]
    s_add_u32 s33, s33, 0x80000
    v_mfma_f32_16x16x32_bf16 v[248:251], a[60:63], a[240:243], v[248:251]
    s_add_u32 s35, s35, 0x4000
    v_mfma_f32_16x16x32_bf16 v[252:255], a[60:63], a[244:247], v[252:255]
    v_mfma_f32_16x16x32_bf16 a[120:123], a[60:63], a[248:251], a[120:123]
    v_mfma_f32_16x16x32_bf16 a[124:127], a[60:63], a[252:255], a[124:127]
    s_add_u32 s24, s6, 0x3000000
    s_addc_u32 s25, s7, 0
    s_and_b32 s25, s25, 0xffff
    s_mov_b32 s26, 0x1000000
    s_mov_b32 s27, 0x00020000
    s_load_dwordx2 s[44:45], s[0:1], 40
    s_load_dwordx2 s[46:47], s[0:1], 64
    s_load_dwordx4 s[48:51], s[0:1], 72
    s_mov_b32 s40, 0x3e0293ee
    s_mov_b32 s41, 0x3e0293ee
    s_mov_b32 m0, s34
    s_nop 0
    buffer_load_dwordx4 v1, s[16:19], s32 offen offset:0 sc1 lds
    buffer_load_dwordx4 v1, s[16:19], s32 offen offset:1024 sc1 lds
    buffer_load_dwordx4 v1, s[16:19], s32 offen offset:2048 sc1 lds
    buffer_load_dwordx4 v1, s[16:19], s32 offen offset:3072 sc1 lds
    s_mov_b32 m0, s35
    s_nop 0
    buffer_load_dwordx4 v1, s[20:23], s33 offen offset:0 sc1 lds
    buffer_load_dwordx4 v1, s[20:23], s33 offen offset:1024 sc1 lds
    buffer_load_dwordx4 v1, s[20:23], s33 offen offset:2048 sc1 lds
    buffer_load_dwordx4 v1, s[20:23], s33 offen offset:3072 sc1 lds
    s_add_u32 s32, s32, 0x80000
    s_add_u32 s33, s33, 0x80000
    s_add_u32 s34, s34, 0x4000
    s_and_b32 s34, s34, 0xffff
    s_add_u32 s35, s35, 0x4000
    s_and_b32 s35, s35, 0xffff
    s_or_b32 s35, s35, 0x10000
    s_nop 4
    v_accvgpr_read_b32 v128, a64
    v_accvgpr_read_b32 v129, a65
    v_accvgpr_read_b32 v130, a66
    v_accvgpr_read_b32 v131, a67
    v_pk_mul_f32 v[128:129], v[128:129], s[40:41]
    v_pk_mul_f32 v[130:131], v[130:131], s[40:41]
    v_cvt_pk_bf16_f32 v96, v128, v129
    v_cvt_pk_bf16_f32 v97, v130, v131
    v_accvgpr_read_b32 v132, a72
    v_accvgpr_read_b32 v133, a73
    v_accvgpr_read_b32 v134, a74
    v_accvgpr_read_b32 v135, a75
    v_pk_mul_f32 v[132:133], v[132:133], s[40:41]
    v_pk_mul_f32 v[134:135], v[134:135], s[40:41]
    v_cvt_pk_bf16_f32 v98, v132, v133
    v_cvt_pk_bf16_f32 v99, v134, v135
    v_accvgpr_read_b32 v136, a80
    v_accvgpr_read_b32 v137, a81
    v_accvgpr_read_b32 v138, a82
    v_accvgpr_read_b32 v139, a83
    v_pk_mul_f32 v[136:137], v[136:137], s[40:41]
    v_pk_mul_f32 v[138:139], v[138:139], s[40:41]
    v_cvt_pk_bf16_f32 v100, v136, v137
    v_cvt_pk_bf16_f32 v101, v138, v139
    v_accvgpr_read_b32 v140, a88
    v_accvgpr_read_b32 v141, a89
    v_accvgpr_read_b32 v142, a90
    v_accvgpr_read_b32 v143, a91
    v_pk_mul_f32 v[140:141], v[140:141], s[40:41]
    v_pk_mul_f32 v[142:143], v[142:143], s[40:41]
    v_cvt_pk_bf16_f32 v102, v140, v141
    v_cvt_pk_bf16_f32 v103, v142, v143
    v_accvgpr_read_b32 v128, a96
    v_accvgpr_read_b32 v129, a97
    v_accvgpr_read_b32 v130, a98
    v_accvgpr_read_b32 v131, a99
    v_pk_mul_f32 v[128:129], v[128:129], s[40:41]
    v_pk_mul_f32 v[130:131], v[130:131], s[40:41]
    v_cvt_pk_bf16_f32 v104, v128, v129
    v_cvt_pk_bf16_f32 v105, v130, v131
    v_accvgpr_read_b32 v132, a104
    v_accvgpr_read_b32 v133, a105
    v_accvgpr_read_b32 v134, a106
    v_accvgpr_read_b32 v135, a107
    v_pk_mul_f32 v[132:133], v[132:133], s[40:41]
    v_pk_mul_f32 v[134:135], v[134:135], s[40:41]
    v_cvt_pk_bf16_f32 v106, v132, v133
    v_cvt_pk_bf16_f32 v107, v134, v135
    v_accvgpr_read_b32 v136, a112
    v_accvgpr_read_b32 v137, a113
    v_accvgpr_read_b32 v138, a114
    v_accvgpr_read_b32 v139, a115
    v_pk_mul_f32 v[136:137], v[136:137], s[40:41]
    v_pk_mul_f32 v[138:139], v[138:139], s[40:41]
    v_cvt_pk_bf16_f32 v108, v136, v137
    v_cvt_pk_bf16_f32 v109, v138, v139
    v_accvgpr_read_b32 v140, a120
    v_accvgpr_read_b32 v141, a121
    v_accvgpr_read_b32 v142, a122
    v_accvgpr_read_b32 v143, a123
    v_pk_mul_f32 v[140:141], v[140:141], s[40:41]
    v_pk_mul_f32 v[142:143], v[142:143], s[40:41]
    v_cvt_pk_bf16_f32 v110, v140, v141
    v_cvt_pk_bf16_f32 v111, v142, v143
    v_accvgpr_read_b32 v128, a68
    v_accvgpr_read_b32 v129, a69
    v_accvgpr_read_b32 v130, a70
    v_accvgpr_read_b32 v131, a71
    v_pk_mul_f32 v[128:129], v[128:129], s[40:41]
    v_pk_mul_f32 v[130:131], v[130:131], s[40:41]
    v_cvt_pk_bf16_f32 v112, v128, v129
    v_cvt_pk_bf16_f32 v113, v130, v131
    v_accvgpr_read_b32 v132, a76
    v_accvgpr_read_b32 v133, a77
    v_accvgpr_read_b32 v134, a78
    v_accvgpr_read_b32 v135, a79
    v_pk_mul_f32 v[132:133], v[132:133], s[40:41]
    v_pk_mul_f32 v[134:135], v[134:135], s[40:41]
    v_cvt_pk_bf16_f32 v114, v132, v133
    v_cvt_pk_bf16_f32 v115, v134, v135
    v_accvgpr_read_b32 v136, a84
    v_accvgpr_read_b32 v137, a85
    v_accvgpr_read_b32 v138, a86
    v_accvgpr_read_b32 v139, a87
    v_pk_mul_f32 v[136:137], v[136:137], s[40:41]
    v_pk_mul_f32 v[138:139], v[138:139], s[40:41]
    v_cvt_pk_bf16_f32 v116, v136, v137
    v_cvt_pk_bf16_f32 v117, v138, v139
    v_accvgpr_read_b32 v140, a92
    v_accvgpr_read_b32 v141, a93
    v_accvgpr_read_b32 v142, a94
    v_accvgpr_read_b32 v143, a95
    v_pk_mul_f32 v[140:141], v[140:141], s[40:41]
    v_pk_mul_f32 v[142:143], v[142:143], s[40:41]
    v_cvt_pk_bf16_f32 v118, v140, v141
    v_cvt_pk_bf16_f32 v119, v142, v143
    v_accvgpr_read_b32 v128, a100
    v_accvgpr_read_b32 v129, a101
    v_accvgpr_read_b32 v130, a102
    v_accvgpr_read_b32 v131, a103
    v_pk_mul_f32 v[128:129], v[128:129], s[40:41]
    v_pk_mul_f32 v[130:131], v[130:131], s[40:41]
    v_cvt_pk_bf16_f32 v120, v128, v129
    v_cvt_pk_bf16_f32 v121, v130, v131
    v_accvgpr_read_b32 v132, a108
    v_accvgpr_read_b32 v133, a109
    v_accvgpr_read_b32 v134, a110
    v_accvgpr_read_b32 v135, a111
    v_pk_mul_f32 v[132:133], v[132:133], s[40:41]
    v_pk_mul_f32 v[134:135], v[134:135], s[40:41]
    v_cvt_pk_bf16_f32 v122, v132, v133
    v_cvt_pk_bf16_f32 v123, v134, v135
    v_accvgpr_read_b32 v136, a116
    v_accvgpr_read_b32 v137, a117
    v_accvgpr_read_b32 v138, a118
    v_accvgpr_read_b32 v139, a119
    v_pk_mul_f32 v[136:137], v[136:137], s[40:41]
    v_pk_mul_f32 v[138:139], v[138:139], s[40:41]
    v_cvt_pk_bf16_f32 v124, v136, v137
    v_cvt_pk_bf16_f32 v125, v138, v139
    v_accvgpr_read_b32 v140, a124
    v_accvgpr_read_b32 v141, a125
    v_accvgpr_read_b32 v142, a126
    v_accvgpr_read_b32 v143, a127
    v_pk_mul_f32 v[140:141], v[140:141], s[40:41]
    v_pk_mul_f32 v[142:143], v[142:143], s[40:41]
    v_cvt_pk_bf16_f32 v126, v140, v141
    v_cvt_pk_bf16_f32 v127, v142, v143
    v_pk_mul_f32 v[192:193], v[192:193], s[40:41]
    v_pk_mul_f32 v[194:195], v[194:195], s[40:41]
    v_cvt_pk_bf16_f32 v64, v192, v193
    v_cvt_pk_bf16_f32 v65, v194, v195
    v_pk_mul_f32 v[200:201], v[200:201], s[40:41]
    v_pk_mul_f32 v[202:203], v[202:203], s[40:41]
    v_cvt_pk_bf16_f32 v66, v200, v201
    v_cvt_pk_bf16_f32 v67, v202, v203
    v_pk_mul_f32 v[208:209], v[208:209], s[40:41]
    v_pk_mul_f32 v[210:211], v[210:211], s[40:41]
    v_cvt_pk_bf16_f32 v68, v208, v209
    v_cvt_pk_bf16_f32 v69, v210, v211
    v_pk_mul_f32 v[216:217], v[216:217], s[40:41]
    v_pk_mul_f32 v[218:219], v[218:219], s[40:41]
    v_cvt_pk_bf16_f32 v70, v216, v217
    v_cvt_pk_bf16_f32 v71, v218, v219
    v_pk_mul_f32 v[224:225], v[224:225], s[40:41]
    v_pk_mul_f32 v[226:227], v[226:227], s[40:41]
    v_cvt_pk_bf16_f32 v72, v224, v225
    v_cvt_pk_bf16_f32 v73, v226, v227
    v_pk_mul_f32 v[232:233], v[232:233], s[40:41]
    v_pk_mul_f32 v[234:235], v[234:235], s[40:41]
    v_cvt_pk_bf16_f32 v74, v232, v233
    v_cvt_pk_bf16_f32 v75, v234, v235
    v_pk_mul_f32 v[240:241], v[240:241], s[40:41]
    v_pk_mul_f32 v[242:243], v[242:243], s[40:41]
    v_cvt_pk_bf16_f32 v76, v240, v241
    v_cvt_pk_bf16_f32 v77, v242, v243
    v_pk_mul_f32 v[248:249], v[248:249], s[40:41]
    v_pk_mul_f32 v[250:251], v[250:251], s[40:41]
    v_cvt_pk_bf16_f32 v78, v248, v249
    v_cvt_pk_bf16_f32 v79, v250, v251
    v_pk_mul_f32 v[196:197], v[196:197], s[40:41]
    v_pk_mul_f32 v[198:199], v[198:199], s[40:41]
    v_cvt_pk_bf16_f32 v80, v196, v197
    v_cvt_pk_bf16_f32 v81, v198, v199
    v_pk_mul_f32 v[204:205], v[204:205], s[40:41]
    v_pk_mul_f32 v[206:207], v[206:207], s[40:41]
    v_cvt_pk_bf16_f32 v82, v204, v205
    v_cvt_pk_bf16_f32 v83, v206, v207
    v_pk_mul_f32 v[212:213], v[212:213], s[40:41]
    v_pk_mul_f32 v[214:215], v[214:215], s[40:41]
    v_cvt_pk_bf16_f32 v84, v212, v213
    v_cvt_pk_bf16_f32 v85, v214, v215
    v_pk_mul_f32 v[220:221], v[220:221], s[40:41]
    v_pk_mul_f32 v[222:223], v[222:223], s[40:41]
    v_cvt_pk_bf16_f32 v86, v220, v221
    v_cvt_pk_bf16_f32 v87, v222, v223
    v_pk_mul_f32 v[228:229], v[228:229], s[40:41]
    v_pk_mul_f32 v[230:231], v[230:231], s[40:41]
    v_cvt_pk_bf16_f32 v88, v228, v229
    v_cvt_pk_bf16_f32 v89, v230, v231
    v_pk_mul_f32 v[236:237], v[236:237], s[40:41]
    v_pk_mul_f32 v[238:239], v[238:239], s[40:41]
    v_cvt_pk_bf16_f32 v90, v236, v237
    v_cvt_pk_bf16_f32 v91, v238, v239
    v_pk_mul_f32 v[244:245], v[244:245], s[40:41]
    v_pk_mul_f32 v[246:247], v[246:247], s[40:41]
    v_cvt_pk_bf16_f32 v92, v244, v245
    v_cvt_pk_bf16_f32 v93, v246, v247
    v_pk_mul_f32 v[252:253], v[252:253], s[40:41]
    v_pk_mul_f32 v[254:255], v[254:255], s[40:41]
    v_cvt_pk_bf16_f32 v94, v252, v253
    v_cvt_pk_bf16_f32 v95, v254, v255
    v_mov_b32 v128, 0
    v_mov_b32 v129, 0
    v_mov_b32 v130, 0
    v_mov_b32 v131, 0
    s_nop 1
    v_mfma_f32_32x32x16_bf16 a[0:15], v[128:131], v[128:131], 0
    v_mfma_f32_32x32x16_bf16 a[16:31], v[128:131], v[128:131], 0
    v_mfma_f32_32x32x16_bf16 a[32:47], v[128:131], v[128:131], 0
    v_mfma_f32_32x32x16_bf16 a[48:63], v[128:131], v[128:131], 0
    v_mfma_f32_32x32x16_bf16 a[64:79], v[128:131], v[128:131], 0
    v_mfma_f32_32x32x16_bf16 a[80:95], v[128:131], v[128:131], 0
    v_mfma_f32_32x32x16_bf16 a[96:111], v[128:131], v[128:131], 0
    v_mfma_f32_32x32x16_bf16 a[112:127], v[128:131], v[128:131], 0
    s_waitcnt lgkmcnt(0)
    s_cmp_eq_u32 s30, 1
    s_cselect_b64 s[12:13], s[46:47], s[44:45]
    s_cmp_eq_u32 s30, 2
    s_cselect_b64 s[12:13], s[48:49], s[12:13]
    s_cmp_eq_u32 s30, 3
    s_cselect_b64 s[12:13], s[50:51], s[12:13]
    s_and_b32 s13, s13, 0xffff
    s_mul_i32 s62, s28, 63
    s_mul_i32 s31, s29, s29
    s_add_u32 s62, s62, s31
    s_sub_u32 s62, s62, 1
    s_lshl_b32 s62, s62, 12
    s_cmp_eq_u32 s30, 0
    s_cselect_b32 s14, 0x800000, 0x0
    s_max_u32 s14, s14, 0x700000
    s_cmp_eq_u32 s29, 0
    s_cselect_b32 s14, 0, s14
    s_cselect_b32 s62, 0, s62
    v_lshlrev_b32 v228, 2, v1
    v_mov_b32 v2, v1
    v_or_b32 v3, 0x10000, v1
    v_mov_b32 v56, v3
    s_mov_b32 s52, 0
    s_mov_b32 s53, 0
    v_mov_b32 v8, 0
    v_mov_b32 v12, 0
    v_mov_b32 v9, 0
    v_mov_b32 v13, 0
    v_mov_b32 v10, 0
    v_mov_b32 v14, 0
    v_mov_b32 v11, 0
    v_mov_b32 v15, 0
    v_mov_b32 v16, 0
    v_mov_b32 v17, 0
    v_mov_b32 v18, 0
    v_mov_b32 v19, 0
    v_mov_b32 v20, 0
    v_mov_b32 v21, 0
    v_mov_b32 v22, 0
    v_mov_b32 v23, 0
    v_mov_b32 v24, 0
    v_mov_b32 v25, 0
    v_mov_b32 v26, 0
    v_mov_b32 v27, 0
    v_mov_b32 v28, 0
    v_mov_b32 v29, 0
    v_mov_b32 v30, 0
    v_mov_b32 v31, 0
    v_mov_b32 v32, 0
    v_mov_b32 v33, 0
    v_mov_b32 v34, 0
    v_mov_b32 v35, 0
    v_mov_b32 v36, 0
    v_mov_b32 v37, 0
    v_mov_b32 v38, 0
    v_mov_b32 v39, 0
    v_mov_b32 v40, 0
    v_mov_b32 v41, 0
    v_mov_b32 v42, 0
    v_mov_b32 v43, 0
    v_mov_b32 v44, 0
    v_mov_b32 v45, 0
    v_mov_b32 v46, 0
    v_mov_b32 v47, 0
    s_mov_b32 s36, 0
    s_mov_b32 s37, 0x46800000
    s_waitcnt vmcnt(16)
    s_barrier
    ds_read_b128 a[128:131], v2 offset:0
    ds_read_b128 a[132:135], v2 offset:1024
    ds_read_b128 a[136:139], v2 offset:2048
    ds_read_b128 a[140:143], v2 offset:3072
    ds_read_b128 a[144:147], v2 offset:4096
    ds_read_b128 a[148:151], v2 offset:5120
    ds_read_b128 a[152:155], v2 offset:6144
    ds_read_b128 a[156:159], v2 offset:7168
    s_add_u32 s52, s52, 8192
    s_and_b32 s52, s52, 0xffff
    v_add_u32 v2, s52, v1
    s_waitcnt lgkmcnt(0)
    s_cmp_ge_u32 s36, s42
    s_cbranch_scc1 k2_prep_43
k2_prepret_44:
    v_mfma_f32_16x16x32_bf16 v[128:131], a[128:131], v[64:67], v[16:19]
    v_mfma_f32_16x16x32_bf16 v[132:135], a[128:131], v[80:83], v[20:23]
    v_mfma_f32_16x16x32_bf16 v[136:139], a[128:131], v[96:99], v[24:27]
    v_mfma_f32_16x16x32_bf16 v[140:143], a[128:131], v[112:115], v[28:31]
    s_add_u32 s36, s36, 32
    v_mfma_f32_16x16x32_bf16 v[128:131], a[132:135], v[68:71], v[128:131]
    v_mfma_f32_16x16x32_bf16 v[132:135], a[132:135], v[84:87], v[132:135]
    v_mfma_f32_16x16x32_bf16 v[136:139], a[132:135], v[100:103], v[136:139]
    v_mfma_f32_16x16x32_bf16 v[140:143], a[132:135], v[116:119], v[140:143]
    v_mfma_f32_16x16x32_bf16 v[128:131], a[136:139], v[72:75], v[128:131]
    v_mfma_f32_16x16x32_bf16 v[132:135], a[136:139], v[88:91], v[132:135]
    v_mfma_f32_16x16x32_bf16 v[136:139], a[136:139], v[104:107], v[136:139]
    v_mfma_f32_16x16x32_bf16 v[140:143], a[136:139], v[120:123], v[140:143]
    v_mfma_f32_16x16x32_bf16 v[128:131], a[140:143], v[76:79], v[128:131]
    v_mfma_f32_16x16x32_bf16 v[132:135], a[140:143], v[92:95], v[132:135]
    v_mfma_f32_16x16x32_bf16 v[136:139], a[140:143], v[108:111], v[136:139]
    v_mfma_f32_16x16x32_bf16 v[140:143], a[140:143], v[124:127], v[140:143]
    v_mfma_f32_16x16x32_bf16 v[144:147], a[144:147], v[64:67], v[32:35]
    v_mfma_f32_16x16x32_bf16 v[148:151], a[144:147], v[80:83], v[36:39]
    v_mfma_f32_16x16x32_bf16 v[152:155], a[144:147], v[96:99], v[40:43]
    v_mfma_f32_16x16x32_bf16 v[156:159], a[144:147], v[112:115], v[44:47]
    v_mfma_f32_16x16x32_bf16 v[144:147], a[148:151], v[68:71], v[144:147]
    v_mfma_f32_16x16x32_bf16 v[148:151], a[148:151], v[84:87], v[148:151]
    v_mfma_f32_16x16x32_bf16 v[152:155], a[148:151], v[100:103], v[152:155]
    v_mfma_f32_16x16x32_bf16 v[156:159], a[148:151], v[116:119], v[156:159]
    v_mfma_f32_16x16x32_bf16 v[144:147], a[152:155], v[72:75], v[144:147]
    v_mfma_f32_16x16x32_bf16 v[148:151], a[152:155], v[88:91], v[148:151]
    v_mfma_f32_16x16x32_bf16 v[152:155], a[152:155], v[104:107], v[152:155]
    v_mfma_f32_16x16x32_bf16 v[156:159], a[152:155], v[120:123], v[156:159]
    v_mfma_f32_16x16x32_bf16 v[144:147], a[156:159], v[76:79], v[144:147]
    v_mfma_f32_16x16x32_bf16 v[148:151], a[156:159], v[92:95], v[148:151]
    v_mfma_f32_16x16x32_bf16 v[152:155], a[156:159], v[108:111], v[152:155]
    v_mfma_f32_16x16x32_bf16 v[156:159], a[156:159], v[124:127], v[156:159]
    s_nop 7
    v_max_f32 v52, v128, v129
    v_max3_f32 v52, v52, v130, v131
    v_max3_f32 v52, v52, v144, v145
    v_max3_f32 v52, v52, v146, v147
    v_mov_b32 v6, v52
    s_nop 1
    v_permlane16_swap_b32 v52, v6
    s_nop 1
    v_max_f32 v52, v52, v6
    v_mov_b32 v6, v52
    s_nop 1
    v_permlane32_swap_b32 v52, v6
    s_nop 1
    v_max_f32 v52, v52, v6
    v_max_f32 v53, v132, v133
    v_max3_f32 v53, v53, v134, v135
    v_max3_f32 v53, v53, v148, v149
    v_max3_f32 v53, v53, v150, v151
    v_mov_b32 v6, v53
    s_nop 1
    v_permlane16_swap_b32 v53, v6
    s_nop 1
    v_max_f32 v53, v53, v6
    v_mov_b32 v6, v53
    s_nop 1
    v_permlane32_swap_b32 v53, v6
    s_nop 1
    v_max_f32 v53, v53, v6
    v_max_f32 v54, v136, v137
    v_max3_f32 v54, v54, v138, v139
    v_max3_f32 v54, v54, v152, v153
    v_max3_f32 v54, v54, v154, v155
    v_mov_b32 v6, v54
    s_nop 1
    v_permlane16_swap_b32 v54, v6
    s_nop 1
    v_max_f32 v54, v54, v6
    v_mov_b32 v6, v54
    s_nop 1
    v_permlane32_swap_b32 v54, v6
    s_nop 1
    v_max_f32 v54, v54, v6
    v_max_f32 v55, v140, v141
    v_max3_f32 v55, v55, v142, v143
    v_max3_f32 v55, v55, v156, v157
    v_max3_f32 v55, v55, v158, v159
    v_mov_b32 v6, v55
    s_nop 1
    v_permlane16_swap_b32 v55, v6
    s_nop 1
    v_max_f32 v55, v55, v6
    v_mov_b32 v6, v55
    s_nop 1
    v_permlane32_swap_b32 v55, v6
    s_nop 1
    v_max_f32 v55, v55, v6
    v_sub_f32 v128, v128, v52
    v_sub_f32 v16, 0, v52
    v_sub_f32 v129, v129, v52
    v_sub_f32 v17, 0, v52
    v_sub_f32 v130, v130, v52
    v_sub_f32 v18, 0, v52
    v_sub_f32 v131, v131, v52
    v_sub_f32 v19, 0, v52
    v_sub_f32 v132, v132, v53
    v_sub_f32 v20, 0, v53
    v_sub_f32 v133, v133, v53
    v_sub_f32 v21, 0, v53
    v_sub_f32 v134, v134, v53
    v_sub_f32 v22, 0, v53
    v_sub_f32 v135, v135, v53
    v_sub_f32 v23, 0, v53
    v_sub_f32 v136, v136, v54
    v_sub_f32 v24, 0, v54
    v_sub_f32 v137, v137, v54
    v_sub_f32 v25, 0, v54
    v_sub_f32 v138, v138, v54
    v_sub_f32 v26, 0, v54
    v_sub_f32 v139, v139, v54
    v_sub_f32 v27, 0, v54
    v_sub_f32 v140, v140, v55
    v_sub_f32 v28, 0, v55
    v_sub_f32 v141, v141, v55
    v_sub_f32 v29, 0, v55
    v_sub_f32 v142, v142, v55
    v_sub_f32 v30, 0, v55
    v_sub_f32 v143, v143, v55
    v_sub_f32 v31, 0, v55
    v_sub_f32 v144, v144, v52
    v_sub_f32 v32, 0, v52
    v_sub_f32 v145, v145, v52
    v_sub_f32 v33, 0, v52
    v_sub_f32 v146, v146, v52
    v_sub_f32 v34, 0, v52
    v_sub_f32 v147, v147, v52
    v_sub_f32 v35, 0, v52
    v_sub_f32 v148, v148, v53
    v_sub_f32 v36, 0, v53
    v_sub_f32 v149, v149, v53
    v_sub_f32 v37, 0, v53
    v_sub_f32 v150, v150, v53
    v_sub_f32 v38, 0, v53
    v_sub_f32 v151, v151, v53
    v_sub_f32 v39, 0, v53
    v_sub_f32 v152, v152, v54
    v_sub_f32 v40, 0, v54
    v_sub_f32 v153, v153, v54
    v_sub_f32 v41, 0, v54
    v_sub_f32 v154, v154, v54
    v_sub_f32 v42, 0, v54
    v_sub_f32 v155, v155, v54
    v_sub_f32 v43, 0, v54
    v_sub_f32 v156, v156, v55
    v_sub_f32 v44, 0, v55
    v_sub_f32 v157, v157, v55
    v_sub_f32 v45, 0, v55
    v_sub_f32 v158, v158, v55
    v_sub_f32 v46, 0, v55
    v_sub_f32 v159, v159, v55
    v_sub_f32 v47, 0, v55
    v_sub_f32 v8, 0, v52
    v_sub_f32 v9, 0, v53
    v_sub_f32 v10, 0, v54
    v_sub_f32 v11, 0, v55
    ds_read_b128 a[128:131], v2 offset:0
    ds_read_b128 a[132:135], v2 offset:1024
    ds_read_b128 a[136:139], v2 offset:2048
    ds_read_b128 a[140:143], v2 offset:3072
    ds_read_b128 a[144:147], v2 offset:4096
    ds_read_b128 a[148:151], v2 offset:5120
    ds_read_b128 a[152:155], v2 offset:6144
    ds_read_b128 a[156:159], v2 offset:7168
    s_add_u32 s52, s52, 8192
    s_and_b32 s52, s52, 0xffff
    v_add_u32 v2, s52, v1
    s_waitcnt lgkmcnt(0)
    s_cmp_ge_u32 s36, s42
    s_cbranch_scc1 k2_prep_45
k2_prepret_46:
    v_mfma_f32_16x16x32_bf16 v[160:163], a[128:131], v[64:67], v[16:19]
    v_exp_f32 v232, v128
    v_mfma_f32_16x16x32_bf16 v[164:167], a[128:131], v[80:83], v[20:23]
    v_exp_f32 v233, v129
    v_mfma_f32_16x16x32_bf16 v[168:171], a[128:131], v[96:99], v[24:27]
    v_add_f32 v48, v232, v233
    v_exp_f32 v234, v130
    v_mfma_f32_16x16x32_bf16 v[172:175], a[128:131], v[112:115], v[28:31]
    s_add_u32 s36, s36, 32
    v_cvt_pk_bf16_f32 v192, v232, v233
    v_exp_f32 v235, v131
    v_mfma_f32_16x16x32_bf16 v[160:163], a[132:135], v[68:71], v[160:163]
    v_add_f32 v48, v48, v234
    v_add_f32 v48, v48, v235
    v_cvt_pk_bf16_f32 v193, v234, v235
    v_mfma_f32_16x16x32_bf16 v[164:167], a[132:135], v[84:87], v[164:167]
    v_exp_f32 v236, v144
    v_mfma_f32_16x16x32_bf16 v[168:171], a[132:135], v[100:103], v[168:171]
    v_exp_f32 v237, v145
    v_add_f32 v48, v48, v236
    v_mfma_f32_16x16x32_bf16 v[172:175], a[132:135], v[116:119], v[172:175]
    v_add_f32 v48, v48, v237
    v_exp_f32 v238, v146
    v_mfma_f32_16x16x32_bf16 v[160:163], a[136:139], v[72:75], v[160:163]
    v_cvt_pk_bf16_f32 v194, v236, v237
    v_exp_f32 v239, v147
    v_mfma_f32_16x16x32_bf16 v[164:167], a[136:139], v[88:91], v[164:167]
    v_add_f32 v48, v48, v238
    v_add_f32 v48, v48, v239
    v_cvt_pk_bf16_f32 v195, v238, v239
    v_mfma_f32_16x16x32_bf16 v[168:171], a[136:139], v[104:107], v[168:171]
    v_exp_f32 v240, v132
    v_mfma_f32_16x16x32_bf16 v[172:175], a[136:139], v[120:123], v[172:175]
    v_exp_f32 v241, v133
    v_mfma_f32_16x16x32_bf16 v[160:163], a[140:143], v[76:79], v[160:163]
    v_add_f32 v49, v240, v241
    v_exp_f32 v242, v134
    v_mfma_f32_16x16x32_bf16 v[164:167], a[140:143], v[92:95], v[164:167]
    v_cvt_pk_bf16_f32 v196, v240, v241
    v_exp_f32 v243, v135
    v_mfma_f32_16x16x32_bf16 v[168:171], a[140:143], v[108:111], v[168:171]
    v_add_f32 v49, v49, v242
    v_add_f32 v49, v49, v243
    v_exp_f32 v244, v148
    v_mfma_f32_16x16x32_bf16 v[172:175], a[140:143], v[124:127], v[172:175]
    v_cvt_pk_bf16_f32 v197, v242, v243
    v_exp_f32 v245, v149
    v_mfma_f32_16x16x32_bf16 v[176:179], a[144:147], v[64:67], v[32:35]
    v_add_f32 v49, v49, v244
    v_add_f32 v49, v49, v245
    v_exp_f32 v246, v150
    v_mfma_f32_16x16x32_bf16 v[180:183], a[144:147], v[80:83], v[36:39]
    v_cvt_pk_bf16_f32 v198, v244, v245
    v_exp_f32 v247, v151
    v_mfma_f32_16x16x32_bf16 v[184:187], a[144:147], v[96:99], v[40:43]
    v_add_f32 v49, v49, v246
    v_add_f32 v49, v49, v247
    v_exp_f32 v232, v136
    v_mfma_f32_16x16x32_bf16 v[188:191], a[144:147], v[112:115], v[44:47]
    v_cvt_pk_bf16_f32 v199, v246, v247
    v_exp_f32 v233, v137
    v_mfma_f32_16x16x32_bf16 v[176:179], a[148:151], v[68:71], v[176:179]
    ds_read_b128 a[192:195], v3 offset:0
    v_add_f32 v50, v232, v233
    v_exp_f32 v234, v138
    v_mfma_f32_16x16x32_bf16 v[180:183], a[148:151], v[84:87], v[180:183]
    v_cvt_pk_bf16_f32 v200, v232, v233
    v_exp_f32 v235, v139
    v_mfma_f32_16x16x32_bf16 v[184:187], a[148:151], v[100:103], v[184:187]
    v_add_f32 v50, v50, v234
    v_add_f32 v50, v50, v235
    v_exp_f32 v236, v152
    v_mfma_f32_16x16x32_bf16 v[188:191], a[148:151], v[116:119], v[188:191]
    v_cvt_pk_bf16_f32 v201, v234, v235
    v_exp_f32 v237, v153
    v_mfma_f32_16x16x32_bf16 v[176:179], a[152:155], v[72:75], v[176:179]
    v_add_f32 v50, v50, v236
    v_add_f32 v50, v50, v237
    v_exp_f32 v238, v154
    v_mfma_f32_16x16x32_bf16 v[180:183], a[152:155], v[88:91], v[180:183]
    ds_read_b128 a[196:199], v3 offset:1024
    v_cvt_pk_bf16_f32 v202, v236, v237
    v_exp_f32 v239, v155
    v_mfma_f32_16x16x32_bf16 v[184:187], a[152:155], v[104:107], v[184:187]
    v_add_f32 v50, v50, v238
    v_add_f32 v50, v50, v239
    v_exp_f32 v240, v140
    v_mfma_f32_16x16x32_bf16 v[188:191], a[152:155], v[120:123], v[188:191]
    v_cvt_pk_bf16_f32 v203, v238, v239
    v_exp_f32 v241, v141
    v_mfma_f32_16x16x32_bf16 v[176:179], a[156:159], v[76:79], v[176:179]
    v_add_f32 v51, v240, v241
    v_exp_f32 v242, v142
    v_mfma_f32_16x16x32_bf16 v[180:183], a[156:159], v[92:95], v[180:183]
    ds_read_b128 a[200:203], v3 offset:2048
    v_cvt_pk_bf16_f32 v204, v240, v241
    v_exp_f32 v243, v143
    v_mfma_f32_16x16x32_bf16 v[184:187], a[156:159], v[108:111], v[184:187]
    v_add_f32 v51, v51, v242
    v_add_f32 v51, v51, v243
    v_exp_f32 v244, v156
    v_mfma_f32_16x16x32_bf16 v[188:191], a[156:159], v[124:127], v[188:191]
    s_waitcnt vmcnt(8)
    s_barrier
    v_cvt_pk_bf16_f32 v205, v242, v243
    v_exp_f32 v245, v157
    v_add_f32 v51, v51, v244
    v_add_f32 v51, v51, v245
    v_exp_f32 v246, v158
    v_cvt_pk_bf16_f32 v206, v244, v245
    v_max3_f32 v6, v48, v49, v50
    v_exp_f32 v247, v159
    ds_read_b128 a[204:207], v3 offset:3072
    v_add_f32 v51, v51, v246
    v_add_f32 v51, v51, v247
    v_cvt_pk_bf16_f32 v207, v246, v247
    v_max_f32 v6, v6, v51
    v_cmp_nge_f32 vcc, s37, v6
    s_cbranch_vccnz k2_rare_47
k2_ret_48:
    s_lshl_b32 s63, s29, 1
    s_add_u32 s63, s63, 1
k2_dloop_49:
    s_waitcnt lgkmcnt(2)
    v_mfma_f32_16x16x32_bf16 a[0:3], a[192:195], v[192:195], a[0:3]
    ds_read_b128 a[208:211], v3 offset:4096
    v_add_f32 v12, v12, v48
    v_mfma_f32_16x16x32_bf16 a[4:7], a[192:195], v[196:199], a[4:7]
    v_exp_f32 v232, v160
    v_mfma_f32_16x16x32_bf16 a[8:11], a[192:195], v[200:203], a[8:11]
    s_mov_b32 m0, s34
    v_add_f32 v13, v13, v49
    v_add_f32 v14, v14, v50
    v_add_f32 v15, v15, v51
    v_mfma_f32_16x16x32_bf16 a[12:15], a[192:195], v[204:207], a[12:15]
    s_add_u32 s53, s53, 8192
    v_exp_f32 v233, v161
    v_mfma_f32_16x16x32_bf16 a[16:19], a[196:199], v[192:195], a[16:19]
    s_and_b32 s53, s53, 0xffff
    buffer_load_dwordx4 v1, s[16:19], s32 offen offset:0 sc1 lds
    ds_read_b128 a[212:215], v3 offset:5120
    v_mfma_f32_16x16x32_bf16 a[20:23], a[196:199], v[196:199], a[20:23]
    v_add_f32 v48, v232, v233
    v_cvt_pk_bf16_f32 v208, v232, v233
    v_mfma_f32_16x16x32_bf16 a[24:27], a[196:199], v[200:203], a[24:27]
    v_exp_f32 v234, v162
    v_mfma_f32_16x16x32_bf16 a[28:31], a[196:199], v[204:207], a[28:31]
    s_waitcnt lgkmcnt(2)
    v_exp_f32 v235, v163
    v_add_f32 v48, v48, v234
    v_mfma_f32_16x16x32_bf16 a[32:35], a[200:203], v[192:195], a[32:35]
    ds_read_b128 a[216:219], v3 offset:6144
    v_add_f32 v48, v48, v235
    v_mfma_f32_16x16x32_bf16 a[36:39], a[200:203], v[196:199], a[36:39]
    v_exp_f32 v236, v176
    v_mfma_f32_16x16x32_bf16 a[40:43], a[200:203], v[200:203], a[40:43]
    v_cvt_pk_bf16_f32 v209, v234, v235
    v_add_f32 v48, v48, v236
    v_mfma_f32_16x16x32_bf16 a[44:47], a[200:203], v[204:207], a[44:47]
    v_exp_f32 v237, v177
    v_mfma_f32_16x16x32_bf16 a[48:51], a[204:207], v[192:195], a[48:51]
    ds_read_b128 a[220:223], v3 offset:7168
    v_add_f32 v48, v48, v237
    v_cvt_pk_bf16_f32 v210, v236, v237
    v_mfma_f32_16x16x32_bf16 a[52:55], a[204:207], v[196:199], a[52:55]
    v_exp_f32 v238, v178
    v_mfma_f32_16x16x32_bf16 a[56:59], a[204:207], v[200:203], a[56:59]
    v_exp_f32 v239, v179
    v_mfma_f32_16x16x32_bf16 a[60:63], a[204:207], v[204:207], a[60:63]
    s_waitcnt lgkmcnt(2)
    v_add_f32 v48, v48, v238
    v_add_f32 v48, v48, v239
    v_mfma_f32_16x16x32_bf16 a[64:67], a[208:211], v[192:195], a[64:67]
    s_add_u32 s34, s34, 0x4000
    v_exp_f32 v240, v164
    v_mfma_f32_16x16x32_bf16 a[68:71], a[208:211], v[196:199], a[68:71]
    ds_read_b128 a[128:131], v2 offset:0
    v_cvt_pk_bf16_f32 v211, v238, v239
    v_add_u32 v3, s53, v56
    v_mfma_f32_16x16x32_bf16 a[72:75], a[208:211], v[200:203], a[72:75]
    v_exp_f32 v241, v165
    v_mfma_f32_16x16x32_bf16 a[76:79], a[208:211], v[204:207], a[76:79]
    buffer_load_dwordx4 v1, s[16:19], s32 offen offset:1024 sc1 lds
    ds_read_b128 a[132:135], v2 offset:1024
    v_mfma_f32_16x16x32_bf16 a[80:83], a[212:215], v[192:195], a[80:83]
    v_add_f32 v49, v240, v241
    v_cvt_pk_bf16_f32 v212, v240, v241
    v_mfma_f32_16x16x32_bf16 a[84:87], a[212:215], v[196:199], a[84:87]
    v_exp_f32 v242, v166
    v_mfma_f32_16x16x32_bf16 a[88:91], a[212:215], v[200:203], a[88:91]
    v_exp_f32 v243, v167
    v_add_f32 v49, v49, v242
    v_mfma_f32_16x16x32_bf16 a[92:95], a[212:215], v[204:207], a[92:95]
    s_waitcnt lgkmcnt(2)
    ds_read_b128 a[136:139], v2 offset:2048
    v_add_f32 v49, v49, v243
    v_mfma_f32_16x16x32_bf16 a[96:99], a[216:219], v[192:195], a[96:99]
    v_exp_f32 v244, v180
    v_mfma_f32_16x16x32_bf16 a[100:103], a[216:219], v[196:199], a[100:103]
    v_cvt_pk_bf16_f32 v213, v242, v243
    v_add_f32 v49, v49, v244
    v_mfma_f32_16x16x32_bf16 a[104:107], a[216:219], v[200:203], a[104:107]
    v_exp_f32 v245, v181
    v_mfma_f32_16x16x32_bf16 a[108:111], a[216:219], v[204:207], a[108:111]
    s_cmp_ge_u32 s36, s42
    s_cbranch_scc1 k2_prep_50
k2_prepret_51:
    v_add_f32 v49, v49, v245
    v_mfma_f32_16x16x32_bf16 a[112:115], a[220:223], v[192:195], a[112:115]
    v_exp_f32 v246, v182
    v_mfma_f32_16x16x32_bf16 a[116:119], a[220:223], v[196:199], a[116:119]
    s_and_b32 s34, s34, 0xffff
    ds_read_b128 a[140:143], v2 offset:3072
    v_cvt_pk_bf16_f32 v214, v244, v245
    v_mfma_f32_16x16x32_bf16 a[120:123], a[220:223], v[200:203], a[120:123]
    v_exp_f32 v247, v183
    v_mfma_f32_16x16x32_bf16 a[124:127], a[220:223], v[204:207], a[124:127]
    s_waitcnt lgkmcnt(2)
    v_add_f32 v49, v49, v246
    v_add_f32 v49, v49, v247
    v_mfma_f32_16x16x32_bf16 v[128:131], a[128:131], v[64:67], v[16:19]
    v_exp_f32 v232, v168
    v_cvt_pk_bf16_f32 v215, v246, v247
    v_mfma_f32_16x16x32_bf16 v[132:135], a[128:131], v[80:83], v[20:23]
    buffer_load_dwordx4 v1, s[16:19], s32 offen offset:2048 sc1 lds
    ds_read_b128 a[144:147], v2 offset:4096
    v_mfma_f32_16x16x32_bf16 v[136:139], a[128:131], v[96:99], v[24:27]
    v_exp_f32 v233, v169
    v_mfma_f32_16x16x32_bf16 v[140:143], a[128:131], v[112:115], v[28:31]
    s_add_u32 s36, s36, 32
    v_add_f32 v50, v232, v233
    v_cvt_pk_bf16_f32 v216, v232, v233
    v_mfma_f32_16x16x32_bf16 v[128:131], a[132:135], v[68:71], v[128:131]
    ds_read_b128 a[148:151], v2 offset:5120
    v_exp_f32 v234, v170
    v_mfma_f32_16x16x32_bf16 v[132:135], a[132:135], v[84:87], v[132:135]
    v_exp_f32 v235, v171
    v_mfma_f32_16x16x32_bf16 v[136:139], a[132:135], v[100:103], v[136:139]
    v_add_f32 v50, v50, v234
    v_add_f32 v50, v50, v235
    v_mfma_f32_16x16x32_bf16 v[140:143], a[132:135], v[116:119], v[140:143]
    s_waitcnt lgkmcnt(2)
    v_exp_f32 v236, v184
    v_mfma_f32_16x16x32_bf16 v[128:131], a[136:139], v[72:75], v[128:131]
    s_add_u32 s52, s52, 8192
    ds_read_b128 a[152:155], v2 offset:6144
    v_cvt_pk_bf16_f32 v217, v234, v235
    v_mfma_f32_16x16x32_bf16 v[132:135], a[136:139], v[88:91], v[132:135]
    v_exp_f32 v237, v185
    v_add_f32 v50, v50, v236
    v_mfma_f32_16x16x32_bf16 v[136:139], a[136:139], v[104:107], v[136:139]
    s_and_b32 s52, s52, 0xffff
    v_add_f32 v50, v50, v237
    v_cvt_pk_bf16_f32 v218, v236, v237
    v_mfma_f32_16x16x32_bf16 v[140:143], a[136:139], v[120:123], v[140:143]
    v_exp_f32 v238, v186
    v_mfma_f32_16x16x32_bf16 v[128:131], a[140:143], v[76:79], v[128:131]
    ds_read_b128 a[156:159], v2 offset:7168
    v_add_f32 v50, v50, v238
    v_mfma_f32_16x16x32_bf16 v[132:135], a[140:143], v[92:95], v[132:135]
    v_exp_f32 v239, v187
    v_mfma_f32_16x16x32_bf16 v[136:139], a[140:143], v[108:111], v[136:139]
    v_add_f32 v50, v50, v239
    v_exp_f32 v240, v172
    v_mfma_f32_16x16x32_bf16 v[140:143], a[140:143], v[124:127], v[140:143]
    s_waitcnt lgkmcnt(2)
    ds_read_b128 a[192:195], v3 offset:0
    v_cvt_pk_bf16_f32 v219, v238, v239
    v_mfma_f32_16x16x32_bf16 v[144:147], a[144:147], v[64:67], v[32:35]
    buffer_load_dwordx4 v1, s[16:19], s32 offen offset:3072 sc1 lds
    s_add_u32 s32, s32, 0x80000
    v_mfma_f32_16x16x32_bf16 v[148:151], a[144:147], v[80:83], v[36:39]
    v_exp_f32 v241, v173
    v_mfma_f32_16x16x32_bf16 v[152:155], a[144:147], v[96:99], v[40:43]
    v_add_f32 v51, v240, v241
    v_cvt_pk_bf16_f32 v220, v240, v241
    v_mfma_f32_16x16x32_bf16 v[156:159], a[144:147], v[112:115], v[44:47]
    v_exp_f32 v242, v174
    v_add_u32 v2, s52, v1
    v_mfma_f32_16x16x32_bf16 v[144:147], a[148:151], v[68:71], v[144:147]
    v_exp_f32 v243, v175
    v_mfma_f32_16x16x32_bf16 v[148:151], a[148:151], v[84:87], v[148:151]
    ds_read_b128 a[196:199], v3 offset:1024
    v_add_f32 v51, v51, v242
    v_mfma_f32_16x16x32_bf16 v[152:155], a[148:151], v[100:103], v[152:155]
    v_add_f32 v51, v51, v243
    v_cvt_pk_bf16_f32 v221, v242, v243
    v_mfma_f32_16x16x32_bf16 v[156:159], a[148:151], v[116:119], v[156:159]
    s_waitcnt lgkmcnt(2)
    v_exp_f32 v244, v188
    v_mfma_f32_16x16x32_bf16 v[144:147], a[152:155], v[72:75], v[144:147]
    v_exp_f32 v245, v189
    v_add_f32 v51, v51, v244
    v_mfma_f32_16x16x32_bf16 v[148:151], a[152:155], v[88:91], v[148:151]
    ds_read_b128 a[200:203], v3 offset:2048
    v_add_f32 v51, v51, v245
    v_mfma_f32_16x16x32_bf16 v[152:155], a[152:155], v[104:107], v[152:155]
    v_exp_f32 v246, v190
    v_mfma_f32_16x16x32_bf16 v[156:159], a[152:155], v[120:123], v[156:159]
    v_cvt_pk_bf16_f32 v222, v244, v245
    v_add_f32 v51, v51, v246
    v_mfma_f32_16x16x32_bf16 v[144:147], a[156:159], v[76:79], v[144:147]
    v_exp_f32 v247, v191
    v_mfma_f32_16x16x32_bf16 v[148:151], a[156:159], v[92:95], v[148:151]
    ds_read_b128 a[204:207], v3 offset:3072
    v_max3_f32 v6, v48, v49, v50
    v_add_f32 v51, v51, v247
    v_mfma_f32_16x16x32_bf16 v[152:155], a[156:159], v[108:111], v[152:155]
    v_cvt_pk_bf16_f32 v223, v246, v247
    v_max_f32 v6, v6, v51
    v_mfma_f32_16x16x32_bf16 v[156:159], a[156:159], v[124:127], v[156:159]
    v_cmp_nge_f32 vcc, s37, v6
    s_cbranch_vccnz k2_rare_52
k2_ret_53:
    s_waitcnt lgkmcnt(2)
    v_mfma_f32_16x16x32_bf16 a[0:3], a[192:195], v[208:211], a[0:3]
    ds_read_b128 a[208:211], v3 offset:4096
    v_add_f32 v12, v12, v48
    v_mfma_f32_16x16x32_bf16 a[4:7], a[192:195], v[212:215], a[4:7]
    v_exp_f32 v232, v128
    v_mfma_f32_16x16x32_bf16 a[8:11], a[192:195], v[216:219], a[8:11]
    s_mov_b32 m0, s35
    v_add_f32 v13, v13, v49
    v_add_f32 v14, v14, v50
    v_add_f32 v15, v15, v51
    v_mfma_f32_16x16x32_bf16 a[12:15], a[192:195], v[220:223], a[12:15]
    s_add_u32 s53, s53, 8192
    v_exp_f32 v233, v129
    v_mfma_f32_16x16x32_bf16 a[16:19], a[196:199], v[208:211], a[16:19]
    s_and_b32 s53, s53, 0xffff
    buffer_load_dwordx4 v1, s[20:23], s33 offen offset:0 sc1 lds
    ds_read_b128 a[212:215], v3 offset:5120
    v_mfma_f32_16x16x32_bf16 a[20:23], a[196:199], v[212:215], a[20:23]
    v_add_f32 v48, v232, v233
    v_cvt_pk_bf16_f32 v192, v232, v233
    v_mfma_f32_16x16x32_bf16 a[24:27], a[196:199], v[216:219], a[24:27]
    ds_read_b128 a[216:219], v3 offset:6144
    v_exp_f32 v234, v130
    v_mfma_f32_16x16x32_bf16 a[28:31], a[196:199], v[220:223], a[28:31]
    s_waitcnt lgkmcnt(3)
    v_exp_f32 v235, v131
    v_mfma_f32_16x16x32_bf16 a[32:35], a[200:203], v[208:211], a[32:35]
    v_add_f32 v48, v48, v234
    v_add_f32 v48, v48, v235
    v_mfma_f32_16x16x32_bf16 a[36:39], a[200:203], v[212:215], a[36:39]
    v_exp_f32 v236, v144
    v_mfma_f32_16x16x32_bf16 a[40:43], a[200:203], v[216:219], a[40:43]
    v_cvt_pk_bf16_f32 v193, v234, v235
    v_add_f32 v48, v48, v236
    v_mfma_f32_16x16x32_bf16 a[44:47], a[200:203], v[220:223], a[44:47]
    ds_read_b128 a[220:223], v3 offset:7168
    v_exp_f32 v237, v145
    v_mfma_f32_16x16x32_bf16 a[48:51], a[204:207], v[208:211], a[48:51]
    s_add_u32 s35, s35, 0x4000
    v_add_f32 v48, v48, v237
    v_cvt_pk_bf16_f32 v194, v236, v237
    v_mfma_f32_16x16x32_bf16 a[52:55], a[204:207], v[212:215], a[52:55]
    v_exp_f32 v238, v146
    v_mfma_f32_16x16x32_bf16 a[56:59], a[204:207], v[216:219], a[56:59]
    v_exp_f32 v239, v147
    v_mfma_f32_16x16x32_bf16 a[60:63], a[204:207], v[220:223], a[60:63]
    s_waitcnt lgkmcnt(2)
    ds_read_b128 a[128:131], v2 offset:0
    v_add_f32 v48, v48, v238
    v_add_f32 v48, v48, v239
    v_mfma_f32_16x16x32_bf16 a[64:67], a[208:211], v[208:211], a[64:67]
    buffer_load_dwordx4 v1, s[20:23], s33 offen offset:1024 sc1 lds
    v_mfma_f32_16x16x32_bf16 a[68:71], a[208:211], v[212:215], a[68:71]
    v_exp_f32 v240, v132
    v_cvt_pk_bf16_f32 v195, v238, v239
    v_mfma_f32_16x16x32_bf16 a[72:75], a[208:211], v[216:219], a[72:75]
    v_exp_f32 v241, v133
    v_mfma_f32_16x16x32_bf16 a[76:79], a[208:211], v[220:223], a[76:79]
    v_add_u32 v3, s53, v56
    v_add_f32 v49, v240, v241
    v_mfma_f32_16x16x32_bf16 a[80:83], a[212:215], v[208:211], a[80:83]
    ds_read_b128 a[132:135], v2 offset:1024
    v_exp_f32 v242, v134
    v_mfma_f32_16x16x32_bf16 a[84:87], a[212:215], v[212:215], a[84:87]
    v_cvt_pk_bf16_f32 v196, v240, v241
    v_add_f32 v49, v49, v242
    v_mfma_f32_16x16x32_bf16 a[88:91], a[212:215], v[216:219], a[88:91]
    v_exp_f32 v243, v135
    v_mfma_f32_16x16x32_bf16 a[92:95], a[212:215], v[220:223], a[92:95]
    s_waitcnt lgkmcnt(2)
    ds_read_b128 a[136:139], v2 offset:2048
    v_add_f32 v49, v49, v243
    v_mfma_f32_16x16x32_bf16 a[96:99], a[216:219], v[208:211], a[96:99]
    s_and_b32 s35, s35, 0xffff
    v_exp_f32 v244, v148
    v_mfma_f32_16x16x32_bf16 a[100:103], a[216:219], v[212:215], a[100:103]
    v_cvt_pk_bf16_f32 v197, v242, v243
    v_exp_f32 v245, v149
    v_mfma_f32_16x16x32_bf16 a[104:107], a[216:219], v[216:219], a[104:107]
    s_cmp_ge_u32 s36, s42
    s_cbranch_scc1 k2_prep_54
k2_prepret_55:
    v_mfma_f32_16x16x32_bf16 a[108:111], a[216:219], v[220:223], a[108:111]
    v_add_f32 v49, v49, v244
    v_add_f32 v49, v49, v245
    v_mfma_f32_16x16x32_bf16 a[112:115], a[220:223], v[208:211], a[112:115]
    buffer_load_dwordx4 v1, s[20:23], s33 offen offset:2048 sc1 lds
    ds_read_b128 a[140:143], v2 offset:3072
    v_mfma_f32_16x16x32_bf16 a[116:119], a[220:223], v[212:215], a[116:119]
    s_or_b32 s35, s35, 0x10000
    v_exp_f32 v246, v150
    v_cvt_pk_bf16_f32 v198, v244, v245
    v_mfma_f32_16x16x32_bf16 a[120:123], a[220:223], v[216:219], a[120:123]
    v_exp_f32 v247, v151
    v_mfma_f32_16x16x32_bf16 a[124:127], a[220:223], v[220:223], a[124:127]
    s_waitcnt lgkmcnt(2)
    v_add_f32 v49, v49, v246
    v_add_f32 v49, v49, v247
    v_mfma_f32_16x16x32_bf16 v[160:163], a[128:131], v[64:67], v[16:19]
    v_exp_f32 v232, v136
    v_mfma_f32_16x16x32_bf16 v[164:167], a[128:131], v[80:83], v[20:23]
    ds_read_b128 a[144:147], v2 offset:4096
    v_cvt_pk_bf16_f32 v199, v246, v247
    v_mfma_f32_16x16x32_bf16 v[168:171], a[128:131], v[96:99], v[24:27]
    ds_read_b128 a[148:151], v2 offset:5120
    v_exp_f32 v233, v137
    v_mfma_f32_16x16x32_bf16 v[172:175], a[128:131], v[112:115], v[28:31]
    s_add_u32 s36, s36, 32
    v_add_f32 v50, v232, v233
    v_cvt_pk_bf16_f32 v200, v232, v233
    v_mfma_f32_16x16x32_bf16 v[160:163], a[132:135], v[68:71], v[160:163]
    v_exp_f32 v234, v138
    v_mfma_f32_16x16x32_bf16 v[164:167], a[132:135], v[84:87], v[164:167]
    v_exp_f32 v235, v139
    v_mfma_f32_16x16x32_bf16 v[168:171], a[132:135], v[100:103], v[168:171]
    v_add_f32 v50, v50, v234
    v_add_f32 v50, v50, v235
    v_cvt_pk_bf16_f32 v201, v234, v235
    v_mfma_f32_16x16x32_bf16 v[172:175], a[132:135], v[116:119], v[172:175]
    s_waitcnt lgkmcnt(2)
    v_exp_f32 v236, v152
    v_mfma_f32_16x16x32_bf16 v[160:163], a[136:139], v[72:75], v[160:163]
    s_add_u32 s52, s52, 8192
    buffer_load_dwordx4 v1, s[20:23], s33 offen offset:3072 sc1 lds
    s_add_u32 s33, s33, 0x80000
    v_mfma_f32_16x16x32_bf16 v[164:167], a[136:139], v[88:91], v[164:167]
    ds_read_b128 a[152:155], v2 offset:6144
    v_add_f32 v50, v50, v236
    v_mfma_f32_16x16x32_bf16 v[168:171], a[136:139], v[104:107], v[168:171]
    s_and_b32 s52, s52, 0xffff
    v_exp_f32 v237, v153
    v_mfma_f32_16x16x32_bf16 v[172:175], a[136:139], v[120:123], v[172:175]
    v_add_f32 v50, v50, v237
    v_exp_f32 v238, v154
    v_mfma_f32_16x16x32_bf16 v[160:163], a[140:143], v[76:79], v[160:163]
    ds_read_b128 a[156:159], v2 offset:7168
    v_cvt_pk_bf16_f32 v202, v236, v237
    v_mfma_f32_16x16x32_bf16 v[164:167], a[140:143], v[92:95], v[164:167]
    v_exp_f32 v239, v155
    v_mfma_f32_16x16x32_bf16 v[168:171], a[140:143], v[108:111], v[168:171]
    v_add_f32 v50, v50, v238
    v_add_f32 v50, v50, v239
    v_mfma_f32_16x16x32_bf16 v[172:175], a[140:143], v[124:127], v[172:175]
    s_waitcnt lgkmcnt(2)
    v_exp_f32 v240, v140
    v_mfma_f32_16x16x32_bf16 v[176:179], a[144:147], v[64:67], v[32:35]
    v_cvt_pk_bf16_f32 v203, v238, v239
    v_exp_f32 v241, v141
    v_mfma_f32_16x16x32_bf16 v[180:183], a[144:147], v[80:83], v[36:39]
    ds_read_b128 a[192:195], v3 offset:0
    v_add_f32 v51, v240, v241
    v_mfma_f32_16x16x32_bf16 v[184:187], a[144:147], v[96:99], v[40:43]
    v_exp_f32 v242, v142
    v_mfma_f32_16x16x32_bf16 v[188:191], a[144:147], v[112:115], v[44:47]
    buffer_load_dword v7, v228, s[12:15], s62 offen
    s_add_u32 s62, s62, 0x1000
    v_mfma_f32_16x16x32_bf16 v[176:179], a[148:151], v[68:71], v[176:179]
    v_cvt_pk_bf16_f32 v204, v240, v241
    v_exp_f32 v243, v143
    v_mfma_f32_16x16x32_bf16 v[180:183], a[148:151], v[84:87], v[180:183]
    v_add_u32 v2, s52, v1
    v_add_f32 v51, v51, v242
    v_mfma_f32_16x16x32_bf16 v[184:187], a[148:151], v[100:103], v[184:187]
    ds_read_b128 a[196:199], v3 offset:1024
    v_add_f32 v51, v51, v243
    v_mfma_f32_16x16x32_bf16 v[188:191], a[148:151], v[116:119], v[188:191]
    s_waitcnt lgkmcnt(2)
    v_exp_f32 v244, v156
    v_mfma_f32_16x16x32_bf16 v[176:179], a[152:155], v[72:75], v[176:179]
    s_sub_u32 s63, s63, 1
    v_cvt_pk_bf16_f32 v205, v242, v243
    v_add_f32 v51, v51, v244
    v_mfma_f32_16x16x32_bf16 v[180:183], a[152:155], v[88:91], v[180:183]
    ds_read_b128 a[200:203], v3 offset:2048
    v_exp_f32 v245, v157
    v_mfma_f32_16x16x32_bf16 v[184:187], a[152:155], v[104:107], v[184:187]
    v_add_f32 v51, v51, v245
    v_cvt_pk_bf16_f32 v206, v244, v245
    v_mfma_f32_16x16x32_bf16 v[188:191], a[152:155], v[120:123], v[188:191]
    v_exp_f32 v246, v158
    v_mfma_f32_16x16x32_bf16 v[176:179], a[156:159], v[76:79], v[176:179]
    v_exp_f32 v247, v159
    v_mfma_f32_16x16x32_bf16 v[180:183], a[156:159], v[92:95], v[180:183]
    ds_read_b128 a[204:207], v3 offset:3072
    v_add_f32 v51, v51, v246
    v_max3_f32 v6, v48, v49, v50
    v_mfma_f32_16x16x32_bf16 v[184:187], a[156:159], v[108:111], v[184:187]
    v_add_f32 v51, v51, v247
    v_cvt_pk_bf16_f32 v207, v246, v247
    v_mfma_f32_16x16x32_bf16 v[188:191], a[156:159], v[124:127], v[188:191]
    s_waitcnt vmcnt(8)
    s_barrier
    v_max_f32 v6, v6, v51
    v_cmp_nge_f32 vcc, s37, v6
    s_cbranch_vccnz k2_rare_56
k2_ret_57:
    s_cmp_lg_u32 s63, 0
    s_cbranch_scc1 k2_dloop_49
    s_waitcnt lgkmcnt(2)
    v_mfma_f32_16x16x32_bf16 a[0:3], a[192:195], v[192:195], a[0:3]
    ds_read_b128 a[208:211], v3 offset:4096
    v_add_f32 v12, v12, v48
    v_mfma_f32_16x16x32_bf16 a[4:7], a[192:195], v[196:199], a[4:7]
    v_exp_f32 v232, v160
    v_add_f32 v13, v13, v49
    v_mfma_f32_16x16x32_bf16 a[8:11], a[192:195], v[200:203], a[8:11]
    s_mov_b32 m0, s34
    v_add_f32 v14, v14, v50
    v_add_f32 v15, v15, v51
    v_mfma_f32_16x16x32_bf16 a[12:15], a[192:195], v[204:207], a[12:15]
    s_add_u32 s53, s53, 8192
    v_exp_f32 v233, v161
    v_mfma_f32_16x16x32_bf16 a[16:19], a[196:199], v[192:195], a[16:19]
    s_and_b32 s53, s53, 0xffff
    buffer_load_dwordx4 v1, s[16:19], s32 offen offset:0 sc1 lds
    ds_read_b128 a[212:215], v3 offset:5120
    v_mfma_f32_16x16x32_bf16 a[20:23], a[196:199], v[196:199], a[20:23]
    v_add_f32 v48, v232, v233
    v_exp_f32 v234, v162
    v_mfma_f32_16x16x32_bf16 a[24:27], a[196:199], v[200:203], a[24:27]
    v_cvt_pk_bf16_f32 v208, v232, v233
    v_add_f32 v48, v48, v234
    v_mfma_f32_16x16x32_bf16 a[28:31], a[196:199], v[204:207], a[28:31]
    s_waitcnt lgkmcnt(2)
    ds_read_b128 a[216:219], v3 offset:6144
    v_exp_f32 v235, v163
    v_mfma_f32_16x16x32_bf16 a[32:35], a[200:203], v[192:195], a[32:35]
    v_add_f32 v48, v48, v235
    v_cvt_pk_bf16_f32 v209, v234, v235
    v_mfma_f32_16x16x32_bf16 a[36:39], a[200:203], v[196:199], a[36:39]
    v_exp_f32 v236, v176
    v_mfma_f32_16x16x32_bf16 a[40:43], a[200:203], v[200:203], a[40:43]
    v_exp_f32 v237, v177
    v_add_f32 v48, v48, v236
    v_mfma_f32_16x16x32_bf16 a[44:47], a[200:203], v[204:207], a[44:47]
    ds_read_b128 a[220:223], v3 offset:7168
    v_add_f32 v48, v48, v237
    v_mfma_f32_16x16x32_bf16 a[48:51], a[204:207], v[192:195], a[48:51]
    v_exp_f32 v238, v178
    v_mfma_f32_16x16x32_bf16 a[52:55], a[204:207], v[196:199], a[52:55]
    v_cvt_pk_bf16_f32 v210, v236, v237
    v_exp_f32 v239, v179
    v_mfma_f32_16x16x32_bf16 a[56:59], a[204:207], v[200:203], a[56:59]
    v_add_f32 v48, v48, v238
    v_add_f32 v48, v48, v239
    v_mfma_f32_16x16x32_bf16 a[60:63], a[204:207], v[204:207], a[60:63]
    s_waitcnt lgkmcnt(2)
    v_exp_f32 v240, v164
    v_mfma_f32_16x16x32_bf16 a[64:67], a[208:211], v[192:195], a[64:67]
    s_add_u32 s34, s34, 0x4000
    ds_read_b128 a[128:131], v2 offset:0
    ds_read_b128 a[132:135], v2 offset:1024
    v_cvt_pk_bf16_f32 v211, v238, v239
    v_mfma_f32_16x16x32_bf16 a[68:71], a[208:211], v[196:199], a[68:71]
    v_exp_f32 v241, v165
    v_mfma_f32_16x16x32_bf16 a[72:75], a[208:211], v[200:203], a[72:75]
    buffer_load_dwordx4 v1, s[16:19], s32 offen offset:1024 sc1 lds
    ds_read_b128 a[136:139], v2 offset:2048
    v_mfma_f32_16x16x32_bf16 a[76:79], a[208:211], v[204:207], a[76:79]
    v_add_u32 v3, s53, v56
    v_add_f32 v49, v240, v241
    v_cvt_pk_bf16_f32 v212, v240, v241
    v_mfma_f32_16x16x32_bf16 a[80:83], a[212:215], v[192:195], a[80:83]
    v_exp_f32 v242, v166
    v_mfma_f32_16x16x32_bf16 a[84:87], a[212:215], v[196:199], a[84:87]
    v_exp_f32 v243, v167
    v_mfma_f32_16x16x32_bf16 a[88:91], a[212:215], v[200:203], a[88:91]
    ds_read_b128 a[140:143], v2 offset:3072
    v_add_f32 v49, v49, v242
    v_add_f32 v49, v49, v243
    v_mfma_f32_16x16x32_bf16 a[92:95], a[212:215], v[204:207], a[92:95]
    s_waitcnt lgkmcnt(4)
    v_exp_f32 v244, v180
    v_mfma_f32_16x16x32_bf16 a[96:99], a[216:219], v[192:195], a[96:99]
    ds_read_b128 a[144:147], v2 offset:4096
    v_cvt_pk_bf16_f32 v213, v242, v243
    v_mfma_f32_16x16x32_bf16 a[100:103], a[216:219], v[196:199], a[100:103]
    v_exp_f32 v245, v181
    v_add_f32 v49, v49, v244
    v_mfma_f32_16x16x32_bf16 a[104:107], a[216:219], v[200:203], a[104:107]
    s_branch k2_prep_58
k2_prepret_59:
    v_mfma_f32_16x16x32_bf16 a[108:111], a[216:219], v[204:207], a[108:111]
    ds_read_b128 a[148:151], v2 offset:5120
    v_add_f32 v49, v49, v245
    v_mfma_f32_16x16x32_bf16 a[112:115], a[220:223], v[192:195], a[112:115]
    v_exp_f32 v246, v182
    v_cvt_pk_bf16_f32 v214, v244, v245
    v_mfma_f32_16x16x32_bf16 a[116:119], a[220:223], v[196:199], a[116:119]
    s_and_b32 s34, s34, 0xffff
    ds_read_b128 a[152:155], v2 offset:6144
    v_add_f32 v49, v49, v246
    v_mfma_f32_16x16x32_bf16 a[120:123], a[220:223], v[200:203], a[120:123]
    v_exp_f32 v247, v183
    v_mfma_f32_16x16x32_bf16 a[124:127], a[220:223], v[204:207], a[124:127]
    s_waitcnt lgkmcnt(5)
    ds_read_b128 a[156:159], v2 offset:7168
    v_add_f32 v49, v49, v247
    v_mfma_f32_16x16x32_bf16 v[128:131], a[128:131], v[96:99], v[16:19]
    v_exp_f32 v232, v168
    v_cvt_pk_bf16_f32 v215, v246, v247
    v_mfma_f32_16x16x32_bf16 v[132:135], a[128:131], v[112:115], v[20:23]
    buffer_load_dwordx4 v1, s[16:19], s32 offen offset:2048 sc1 lds
    ds_read_b128 a[160:163], v2 offset:8192
    v_mfma_f32_16x16x32_bf16 v[128:131], a[132:135], v[100:103], v[128:131]
    v_exp_f32 v233, v169
    v_mfma_f32_16x16x32_bf16 v[132:135], a[132:135], v[116:119], v[132:135]
    s_waitcnt lgkmcnt(5)
    ds_read_b128 a[164:167], v2 offset:9216
    v_add_f32 v50, v232, v233
    v_cvt_pk_bf16_f32 v216, v232, v233
    v_mfma_f32_16x16x32_bf16 v[128:131], a[136:139], v[104:107], v[128:131]
    s_add_u32 s36, s36, 64
    v_exp_f32 v234, v170
    v_mfma_f32_16x16x32_bf16 v[132:135], a[136:139], v[120:123], v[132:135]
    ds_read_b128 a[168:171], v2 offset:10240
    v_add_f32 v50, v50, v234
    v_mfma_f32_16x16x32_bf16 v[128:131], a[140:143], v[108:111], v[128:131]
    ds_read_b128 a[172:175], v2 offset:11264
    v_exp_f32 v235, v171
    v_mfma_f32_16x16x32_bf16 v[132:135], a[140:143], v[124:127], v[132:135]
    s_waitcnt lgkmcnt(6)
    v_add_f32 v50, v50, v235
    v_cvt_pk_bf16_f32 v217, v234, v235
    v_mfma_f32_16x16x32_bf16 v[144:147], a[144:147], v[96:99], v[32:35]
    s_add_u32 s52, s52, 16384
    v_exp_f32 v236, v184
    v_mfma_f32_16x16x32_bf16 v[148:151], a[144:147], v[112:115], v[36:39]
    ds_read_b128 a[176:179], v2 offset:12288
    v_exp_f32 v237, v185
    v_mfma_f32_16x16x32_bf16 v[144:147], a[148:151], v[100:103], v[144:147]
    s_and_b32 s52, s52, 0xffff
    ds_read_b128 a[180:183], v2 offset:13312
    v_add_f32 v50, v50, v236
    v_mfma_f32_16x16x32_bf16 v[148:151], a[148:151], v[116:119], v[148:151]
    s_waitcnt lgkmcnt(6)
    v_add_f32 v50, v50, v237
    v_cvt_pk_bf16_f32 v218, v236, v237
    v_mfma_f32_16x16x32_bf16 v[144:147], a[152:155], v[104:107], v[144:147]
    ds_read_b128 a[184:187], v2 offset:14336
    v_exp_f32 v238, v186
    v_mfma_f32_16x16x32_bf16 v[148:151], a[152:155], v[120:123], v[148:151]
    v_exp_f32 v239, v187
    v_mfma_f32_16x16x32_bf16 v[144:147], a[156:159], v[108:111], v[144:147]
    ds_read_b128 a[188:191], v2 offset:15360
    v_add_f32 v50, v50, v238
    v_mfma_f32_16x16x32_bf16 v[148:151], a[156:159], v[124:127], v[148:151]
    s_waitcnt lgkmcnt(6)
    v_add_f32 v50, v50, v239
    v_exp_f32 v240, v172
    v_mfma_f32_16x16x32_bf16 v[136:139], a[160:163], v[96:99], v[24:27]
    ds_read_b128 a[192:195], v3 offset:0
    v_cvt_pk_bf16_f32 v219, v238, v239
    v_mfma_f32_16x16x32_bf16 v[140:143], a[160:163], v[112:115], v[28:31]
    buffer_load_dwordx4 v1, s[16:19], s32 offen offset:3072 sc1 lds
    s_add_u32 s32, s32, 0x80000
    v_mfma_f32_16x16x32_bf16 v[136:139], a[164:167], v[100:103], v[136:139]
    v_exp_f32 v241, v173
    v_add_u32 v2, s52, v1
    v_mfma_f32_16x16x32_bf16 v[140:143], a[164:167], v[116:119], v[140:143]
    s_waitcnt lgkmcnt(5)
    v_add_f32 v51, v240, v241
    v_exp_f32 v242, v174
    v_mfma_f32_16x16x32_bf16 v[136:139], a[168:171], v[104:107], v[136:139]
    v_cvt_pk_bf16_f32 v220, v240, v241
    v_add_f32 v51, v51, v242
    v_mfma_f32_16x16x32_bf16 v[140:143], a[168:171], v[120:123], v[140:143]
    v_exp_f32 v243, v175
    v_mfma_f32_16x16x32_bf16 v[136:139], a[172:175], v[108:111], v[136:139]
    ds_read_b128 a[196:199], v3 offset:1024
    v_add_f32 v51, v51, v243
    v_mfma_f32_16x16x32_bf16 v[140:143], a[172:175], v[124:127], v[140:143]
    s_waitcnt lgkmcnt(4)
    v_exp_f32 v244, v188
    v_mfma_f32_16x16x32_bf16 v[152:155], a[176:179], v[96:99], v[40:43]
    v_cvt_pk_bf16_f32 v221, v242, v243
    v_exp_f32 v245, v189
    v_mfma_f32_16x16x32_bf16 v[156:159], a[176:179], v[112:115], v[44:47]
    ds_read_b128 a[200:203], v3 offset:2048
    v_add_f32 v51, v51, v244
    v_mfma_f32_16x16x32_bf16 v[152:155], a[180:183], v[100:103], v[152:155]
    v_add_f32 v51, v51, v245
    v_cvt_pk_bf16_f32 v222, v244, v245
    v_mfma_f32_16x16x32_bf16 v[156:159], a[180:183], v[116:119], v[156:159]
    s_waitcnt lgkmcnt(3)
    v_exp_f32 v246, v190
    v_max3_f32 v6, v48, v49, v50
    v_mfma_f32_16x16x32_bf16 v[152:155], a[184:187], v[104:107], v[152:155]
    v_exp_f32 v247, v191
    v_mfma_f32_16x16x32_bf16 v[156:159], a[184:187], v[120:123], v[156:159]
    ds_read_b128 a[204:207], v3 offset:3072
    v_add_f32 v51, v51, v246
    v_mfma_f32_16x16x32_bf16 v[152:155], a[188:191], v[108:111], v[152:155]
    v_add_f32 v51, v51, v247
    v_cvt_pk_bf16_f32 v223, v246, v247
    v_max_f32 v6, v6, v51
    v_mfma_f32_16x16x32_bf16 v[156:159], a[188:191], v[124:127], v[156:159]
    v_cmp_nge_f32 vcc, s37, v6
    s_cbranch_vccnz k2_rare_60
k2_ret_61:
    s_waitcnt lgkmcnt(2)
    v_mfma_f32_16x16x32_bf16 a[0:3], a[192:195], v[208:211], a[0:3]
    ds_read_b128 a[208:211], v3 offset:4096
    v_add_f32 v12, v12, v48
    v_mfma_f32_16x16x32_bf16 a[4:7], a[192:195], v[212:215], a[4:7]
    s_mov_b32 m0, s35
    v_exp_f32 v232, v128
    v_add_f32 v13, v13, v49
    v_mfma_f32_16x16x32_bf16 a[8:11], a[192:195], v[216:219], a[8:11]
    s_add_u32 s53, s53, 8192
    v_add_f32 v14, v14, v50
    v_add_f32 v15, v15, v51
    v_mfma_f32_16x16x32_bf16 a[12:15], a[192:195], v[220:223], a[12:15]
    ds_read_b128 a[212:215], v3 offset:5120
    v_exp_f32 v233, v129
    v_mfma_f32_16x16x32_bf16 a[16:19], a[196:199], v[208:211], a[16:19]
    s_and_b32 s53, s53, 0xffff
    buffer_load_dwordx4 v1, s[20:23], s33 offen offset:0 sc1 lds
    v_mfma_f32_16x16x32_bf16 a[20:23], a[196:199], v[212:215], a[20:23]
    v_add_f32 v48, v232, v233
    v_exp_f32 v234, v130
    v_mfma_f32_16x16x32_bf16 a[24:27], a[196:199], v[216:219], a[24:27]
    v_cvt_pk_bf16_f32 v192, v232, v233
    v_exp_f32 v235, v131
    v_mfma_f32_16x16x32_bf16 a[28:31], a[196:199], v[220:223], a[28:31]
    s_waitcnt lgkmcnt(2)
    ds_read_b128 a[216:219], v3 offset:6144
    v_add_f32 v48, v48, v234
    v_add_f32 v48, v48, v235
    v_mfma_f32_16x16x32_bf16 a[32:35], a[200:203], v[208:211], a[32:35]
    s_add_u32 s35, s35, 0x4000
    v_exp_f32 v236, v144
    v_mfma_f32_16x16x32_bf16 a[36:39], a[200:203], v[212:215], a[36:39]
    v_cvt_pk_bf16_f32 v193, v234, v235
    v_exp_f32 v237, v145
    v_mfma_f32_16x16x32_bf16 a[40:43], a[200:203], v[216:219], a[40:43]
    buffer_load_dwordx4 v1, s[20:23], s33 offen offset:1024 sc1 lds
    ds_read_b128 a[220:223], v3 offset:7168
    v_mfma_f32_16x16x32_bf16 a[44:47], a[200:203], v[220:223], a[44:47]
    v_add_f32 v48, v48, v236
    v_add_f32 v48, v48, v237
    v_mfma_f32_16x16x32_bf16 a[48:51], a[204:207], v[208:211], a[48:51]
    v_exp_f32 v238, v146
    v_cvt_pk_bf16_f32 v194, v236, v237
    v_mfma_f32_16x16x32_bf16 a[52:55], a[204:207], v[212:215], a[52:55]
    v_exp_f32 v239, v147
    v_mfma_f32_16x16x32_bf16 a[56:59], a[204:207], v[216:219], a[56:59]
    s_and_b32 s35, s35, 0xffff
    v_add_f32 v48, v48, v238
    v_add_f32 v48, v48, v239
    v_cvt_pk_bf16_f32 v195, v238, v239
    v_mfma_f32_16x16x32_bf16 a[60:63], a[204:207], v[220:223], a[60:63]
    s_waitcnt lgkmcnt(2)
    v_exp_f32 v240, v132
    v_mfma_f32_16x16x32_bf16 a[64:67], a[208:211], v[208:211], a[64:67]
    buffer_load_dwordx4 v1, s[20:23], s33 offen offset:2048 sc1 lds
    ds_read_b128 a[128:131], v2 offset:0
    ds_read_b128 a[132:135], v2 offset:1024
    v_mfma_f32_16x16x32_bf16 a[68:71], a[208:211], v[212:215], a[68:71]
    v_exp_f32 v241, v133
    v_mfma_f32_16x16x32_bf16 a[72:75], a[208:211], v[216:219], a[72:75]
    s_or_b32 s35, s35, 0x10000
    ds_read_b128 a[136:139], v2 offset:2048
    v_add_u32 v3, s53, v56
    v_add_f32 v49, v240, v241
    v_mfma_f32_16x16x32_bf16 a[76:79], a[208:211], v[220:223], a[76:79]
    v_exp_f32 v242, v134
    v_mfma_f32_16x16x32_bf16 a[80:83], a[212:215], v[208:211], a[80:83]
    v_cvt_pk_bf16_f32 v196, v240, v241
    v_exp_f32 v243, v135
    v_mfma_f32_16x16x32_bf16 a[84:87], a[212:215], v[212:215], a[84:87]
    ds_read_b128 a[140:143], v2 offset:3072
    v_add_f32 v49, v49, v242
    v_mfma_f32_16x16x32_bf16 a[88:91], a[212:215], v[216:219], a[88:91]
    ds_read_b128 a[144:147], v2 offset:4096
    v_add_f32 v49, v49, v243
    v_mfma_f32_16x16x32_bf16 a[92:95], a[212:215], v[220:223], a[92:95]
    s_waitcnt lgkmcnt(5)
    v_exp_f32 v244, v148
    v_cvt_pk_bf16_f32 v197, v242, v243
    v_mfma_f32_16x16x32_bf16 a[96:99], a[216:219], v[208:211], a[96:99]
    buffer_load_dwordx4 v1, s[20:23], s33 offen offset:3072 sc1 lds
    ds_read_b128 a[148:151], v2 offset:5120
    v_mfma_f32_16x16x32_bf16 a[100:103], a[216:219], v[212:215], a[100:103]
    s_add_u32 s33, s33, 0x80000
    v_exp_f32 v245, v149
    v_add_f32 v49, v49, v244
    v_mfma_f32_16x16x32_bf16 a[104:107], a[216:219], v[216:219], a[104:107]
    s_cmp_ge_u32 s36, s43
    s_cbranch_scc1 k2_prep_62
k2_prepret_63:
    v_mfma_f32_16x16x32_bf16 a[108:111], a[216:219], v[220:223], a[108:111]
    v_add_f32 v49, v49, v245
    v_exp_f32 v246, v150
    v_mfma_f32_16x16x32_bf16 a[112:115], a[220:223], v[208:211], a[112:115]
    ds_read_b128 a[152:155], v2 offset:6144
    v_cvt_pk_bf16_f32 v198, v244, v245
    v_mfma_f32_16x16x32_bf16 a[116:119], a[220:223], v[212:215], a[116:119]
    v_exp_f32 v247, v151
    v_add_f32 v49, v49, v246
    v_mfma_f32_16x16x32_bf16 a[120:123], a[220:223], v[216:219], a[120:123]
    ds_read_b128 a[156:159], v2 offset:7168
    v_add_f32 v49, v49, v247
    v_mfma_f32_16x16x32_bf16 a[124:127], a[220:223], v[220:223], a[124:127]
    s_waitcnt lgkmcnt(6)
    v_exp_f32 v232, v136
    v_mfma_f32_16x16x32_bf16 v[160:163], a[128:131], v[96:99], v[16:19]
    s_waitcnt vmcnt(12)
    s_barrier
    ds_read_b128 a[160:163], v2 offset:8192
    ds_read_b128 a[164:167], v2 offset:9216
    v_cvt_pk_bf16_f32 v199, v246, v247
    v_mfma_f32_16x16x32_bf16 v[164:167], a[128:131], v[112:115], v[20:23]
    s_mov_b32 m0, s34
    v_exp_f32 v233, v137
    v_mfma_f32_16x16x32_bf16 v[160:163], a[132:135], v[100:103], v[160:163]
    v_add_f32 v50, v232, v233
    v_exp_f32 v234, v138
    v_mfma_f32_16x16x32_bf16 v[164:167], a[132:135], v[116:119], v[164:167]
    s_waitcnt lgkmcnt(6)
    ds_read_b128 a[168:171], v2 offset:10240
    v_cvt_pk_bf16_f32 v200, v232, v233
    v_mfma_f32_16x16x32_bf16 v[160:163], a[136:139], v[104:107], v[160:163]
    s_add_u32 s36, s36, 64
    buffer_load_dwordx4 v1, s[16:19], s32 offen offset:0 sc1 lds
    ds_read_b128 a[172:175], v2 offset:11264
    v_mfma_f32_16x16x32_bf16 v[164:167], a[136:139], v[120:123], v[164:167]
    v_exp_f32 v235, v139
    v_add_f32 v50, v50, v234
    v_mfma_f32_16x16x32_bf16 v[160:163], a[140:143], v[108:111], v[160:163]
    v_add_f32 v50, v50, v235
    v_exp_f32 v236, v152
    v_mfma_f32_16x16x32_bf16 v[164:167], a[140:143], v[124:127], v[164:167]
    s_waitcnt lgkmcnt(6)
    ds_read_b128 a[176:179], v2 offset:12288
    v_cvt_pk_bf16_f32 v201, v234, v235
    v_mfma_f32_16x16x32_bf16 v[176:179], a[144:147], v[96:99], v[32:35]
    s_add_u32 s34, s34, 0x4000
    v_exp_f32 v237, v153
    v_add_f32 v50, v50, v236
    v_mfma_f32_16x16x32_bf16 v[180:183], a[144:147], v[112:115], v[36:39]
    s_add_u32 s52, s52, 16384
    ds_read_b128 a[180:183], v2 offset:13312
    v_add_f32 v50, v50, v237
    v_mfma_f32_16x16x32_bf16 v[176:179], a[148:151], v[100:103], v[176:179]
    s_and_b32 s52, s52, 0xffff
    v_exp_f32 v238, v154
    v_mfma_f32_16x16x32_bf16 v[180:183], a[148:151], v[116:119], v[180:183]
    s_waitcnt lgkmcnt(6)
    buffer_load_dwordx4 v1, s[16:19], s32 offen offset:1024 sc1 lds
    ds_read_b128 a[184:187], v2 offset:14336
    ds_read_b128 a[188:191], v2 offset:15360
    v_mfma_f32_16x16x32_bf16 v[176:179], a[152:155], v[104:107], v[176:179]
    v_cvt_pk_bf16_f32 v202, v236, v237
    v_add_f32 v50, v50, v238
    v_mfma_f32_16x16x32_bf16 v[180:183], a[152:155], v[120:123], v[180:183]
    v_exp_f32 v239, v155
    v_mfma_f32_16x16x32_bf16 v[176:179], a[156:159], v[108:111], v[176:179]
    s_and_b32 s34, s34, 0xffff
    v_add_f32 v50, v50, v239
    v_exp_f32 v240, v140
    v_mfma_f32_16x16x32_bf16 v[180:183], a[156:159], v[124:127], v[180:183]
    s_waitcnt lgkmcnt(6)
    v_cvt_pk_bf16_f32 v203, v238, v239
    v_exp_f32 v241, v141
    v_mfma_f32_16x16x32_bf16 v[168:171], a[160:163], v[96:99], v[24:27]
    ds_read_b128 a[192:195], v3 offset:0
    v_add_f32 v51, v240, v241
    v_mfma_f32_16x16x32_bf16 v[172:175], a[160:163], v[112:115], v[28:31]
    v_exp_f32 v242, v142
    v_cvt_pk_bf16_f32 v204, v240, v241
    v_mfma_f32_16x16x32_bf16 v[168:171], a[164:167], v[100:103], v[168:171]
    buffer_load_dwordx4 v1, s[16:19], s32 offen offset:2048 sc1 lds
    ds_read_b128 a[196:199], v3 offset:1024
    v_mfma_f32_16x16x32_bf16 v[172:175], a[164:167], v[116:119], v[172:175]
    s_waitcnt lgkmcnt(6)
    v_exp_f32 v243, v143
    v_add_u32 v2, s52, v1
    v_mfma_f32_16x16x32_bf16 v[168:171], a[168:171], v[104:107], v[168:171]
    ds_read_b128 a[200:203], v3 offset:2048
    v_add_f32 v51, v51, v242
    v_mfma_f32_16x16x32_bf16 v[172:175], a[168:171], v[120:123], v[172:175]
    v_add_f32 v51, v51, v243
    v_cvt_pk_bf16_f32 v205, v242, v243
    v_mfma_f32_16x16x32_bf16 v[168:171], a[172:175], v[108:111], v[168:171]
    ds_read_b128 a[204:207], v3 offset:3072
    v_exp_f32 v244, v156
    v_mfma_f32_16x16x32_bf16 v[172:175], a[172:175], v[124:127], v[172:175]
    s_waitcnt lgkmcnt(6)
    v_exp_f32 v245, v157
    v_mfma_f32_16x16x32_bf16 v[184:187], a[176:179], v[96:99], v[40:43]
    ds_read_b128 a[208:211], v3 offset:4096
    v_add_f32 v51, v51, v244
    v_add_f32 v51, v51, v245
    v_mfma_f32_16x16x32_bf16 v[188:191], a[176:179], v[112:115], v[44:47]
    v_exp_f32 v246, v158
    v_mfma_f32_16x16x32_bf16 v[184:187], a[180:183], v[100:103], v[184:187]
    buffer_load_dwordx4 v1, s[16:19], s32 offen offset:3072 sc1 lds
    ds_read_b128 a[212:215], v3 offset:5120
    s_add_u32 s32, s32, 0x80000
    v_mfma_f32_16x16x32_bf16 v[188:191], a[180:183], v[116:119], v[188:191]
    s_waitcnt lgkmcnt(6)
    v_cvt_pk_bf16_f32 v206, v244, v245
    v_add_f32 v51, v51, v246
    v_mfma_f32_16x16x32_bf16 v[184:187], a[184:187], v[104:107], v[184:187]
    v_exp_f32 v247, v159
    v_max3_f32 v6, v48, v49, v50
    v_mfma_f32_16x16x32_bf16 v[188:191], a[184:187], v[120:123], v[188:191]
    ds_read_b128 a[216:219], v3 offset:6144
    v_add_f32 v51, v51, v247
    v_mfma_f32_16x16x32_bf16 v[184:187], a[188:191], v[108:111], v[184:187]
    ds_read_b128 a[220:223], v3 offset:7168
    v_cvt_pk_bf16_f32 v207, v246, v247
    v_max_f32 v6, v6, v51
    v_mfma_f32_16x16x32_bf16 v[188:191], a[188:191], v[124:127], v[188:191]
    v_cmp_nge_f32 vcc, s37, v6
    s_cbranch_vccnz k2_rare_64
k2_ret_65:
    s_lshl_b32 s63, s29, 1
    s_sub_u32 s63, 14, s63
    s_cmp_eq_u32 s63, 0
    s_cbranch_scc1 k2_sdone_67
k2_sloop_66:
    s_waitcnt lgkmcnt(6)
    v_mfma_f32_16x16x32_bf16 a[8:11], a[192:195], v[192:195], a[8:11]
    ds_read_b128 a[224:227], v3 offset:8192
    v_add_f32 v14, v14, v48
    v_add_f32 v15, v15, v49
    v_mfma_f32_16x16x32_bf16 a[12:15], a[192:195], v[196:199], a[12:15]
    s_mov_b32 m0, s35
    v_exp_f32 v232, v160
    v_mfma_f32_16x16x32_bf16 a[24:27], a[196:199], v[192:195], a[24:27]
    s_add_u32 s53, s53, 16384
    ds_read_b128 a[228:231], v3 offset:9216
    v_add_f32 v14, v14, v50
    v_add_f32 v15, v15, v51
    v_mfma_f32_16x16x32_bf16 a[28:31], a[196:199], v[196:199], a[28:31]
    s_waitcnt lgkmcnt(6)
    v_exp_f32 v233, v161
    v_mfma_f32_16x16x32_bf16 a[40:43], a[200:203], v[192:195], a[40:43]
    s_and_b32 s53, s53, 0xffff
    buffer_load_dwordx4 v1, s[20:23], s33 offen offset:0 sc1 lds
    ds_read_b128 a[232:235], v3 offset:10240
    ds_read_b128 a[236:239], v3 offset:11264
    v_mfma_f32_16x16x32_bf16 a[44:47], a[200:203], v[196:199], a[44:47]
    v_add_f32 v48, v232, v233
    v_cvt_pk_bf16_f32 v208, v232, v233
    v_mfma_f32_16x16x32_bf16 a[56:59], a[204:207], v[192:195], a[56:59]
    ds_read_b128 a[240:243], v3 offset:12288
    v_exp_f32 v234, v162
    v_mfma_f32_16x16x32_bf16 a[60:63], a[204:207], v[196:199], a[60:63]
    s_waitcnt lgkmcnt(7)
    v_exp_f32 v235, v163
    v_mfma_f32_16x16x32_bf16 a[72:75], a[208:211], v[192:195], a[72:75]
    s_add_u32 s35, s35, 0x4000
    v_add_f32 v48, v48, v234
    v_add_f32 v48, v48, v235
    v_cvt_pk_bf16_f32 v209, v234, v235
    v_mfma_f32_16x16x32_bf16 a[76:79], a[208:211], v[196:199], a[76:79]
    v_exp_f32 v236, v176
    v_mfma_f32_16x16x32_bf16 a[88:91], a[212:215], v[192:195], a[88:91]
    ds_read_b128 a[244:247], v3 offset:13312
    v_exp_f32 v237, v177
    v_mfma_f32_16x16x32_bf16 a[92:95], a[212:215], v[196:199], a[92:95]
    s_waitcnt lgkmcnt(6)
    buffer_load_dwordx4 v1, s[20:23], s33 offen offset:1024 sc1 lds
    ds_read_b128 a[248:251], v3 offset:14336
    v_mfma_f32_16x16x32_bf16 a[104:107], a[216:219], v[192:195], a[104:107]
    v_add_f32 v48, v48, v236
    v_add_f32 v48, v48, v237
    v_cvt_pk_bf16_f32 v210, v236, v237
    v_mfma_f32_16x16x32_bf16 a[108:111], a[216:219], v[196:199], a[108:111]
    v_exp_f32 v238, v178
    v_mfma_f32_16x16x32_bf16 a[120:123], a[220:223], v[192:195], a[120:123]
    s_and_b32 s35, s35, 0xffff
    ds_read_b128 a[252:255], v3 offset:15360
    v_exp_f32 v239, v179
    v_mfma_f32_16x16x32_bf16 a[124:127], a[220:223], v[196:199], a[124:127]
    s_waitcnt lgkmcnt(6)
    v_add_f32 v48, v48, v238
    v_add_f32 v48, v48, v239
    v_mfma_f32_16x16x32_bf16 a[8:11], a[224:227], v[200:203], a[8:11]
    ds_read_b128 a[128:131], v2 offset:0
    v_exp_f32 v240, v164
    v_mfma_f32_16x16x32_bf16 a[12:15], a[224:227], v[204:207], a[12:15]
    ds_read_b128 a[132:135], v2 offset:1024
    v_cvt_pk_bf16_f32 v211, v238, v239
    v_mfma_f32_16x16x32_bf16 a[24:27], a[228:231], v[200:203], a[24:27]
    s_or_b32 s35, s35, 0x10000
    buffer_load_dwordx4 v1, s[20:23], s33 offen offset:2048 sc1 lds
    ds_read_b128 a[136:139], v2 offset:2048
    v_mfma_f32_16x16x32_bf16 a[28:31], a[228:231], v[204:207], a[28:31]
    s_waitcnt lgkmcnt(7)
    v_exp_f32 v241, v165
    v_add_u32 v3, s53, v56
    v_mfma_f32_16x16x32_bf16 a[40:43], a[232:235], v[200:203], a[40:43]
    v_add_f32 v49, v240, v241
    v_exp_f32 v242, v166
    v_mfma_f32_16x16x32_bf16 a[44:47], a[232:235], v[204:207], a[44:47]
    v_cvt_pk_bf16_f32 v212, v240, v241
    v_add_f32 v49, v49, v242
    v_mfma_f32_16x16x32_bf16 a[56:59], a[236:239], v[200:203], a[56:59]
    ds_read_b128 a[140:143], v2 offset:3072
    v_exp_f32 v243, v167
    v_mfma_f32_16x16x32_bf16 a[60:63], a[236:239], v[204:207], a[60:63]
    s_waitcnt lgkmcnt(6)
    ds_read_b128 a[144:147], v2 offset:4096
    v_add_f32 v49, v49, v243
    v_mfma_f32_16x16x32_bf16 a[72:75], a[240:243], v[200:203], a[72:75]
    v_exp_f32 v244, v180
    v_cvt_pk_bf16_f32 v213, v242, v243
    v_mfma_f32_16x16x32_bf16 a[76:79], a[240:243], v[204:207], a[76:79]
    buffer_load_dwordx4 v1, s[20:23], s33 offen offset:3072 sc1 lds
    ds_read_b128 a[148:151], v2 offset:5120
    v_mfma_f32_16x16x32_bf16 a[88:91], a[244:247], v[200:203], a[88:91]
    s_add_u32 s33, s33, 0x80000
    v_exp_f32 v245, v181
    v_add_f32 v49, v49, v244
    v_mfma_f32_16x16x32_bf16 a[92:95], a[244:247], v[204:207], a[92:95]
    s_waitcnt lgkmcnt(6)
    s_cmp_ge_u32 s36, s43
    s_cbranch_scc1 k2_prep_68
k2_prepret_69:
    v_mfma_f32_16x16x32_bf16 a[104:107], a[248:251], v[200:203], a[104:107]
    v_add_f32 v49, v49, v245
    v_exp_f32 v246, v182
    v_mfma_f32_16x16x32_bf16 a[108:111], a[248:251], v[204:207], a[108:111]
    ds_read_b128 a[152:155], v2 offset:6144
    v_cvt_pk_bf16_f32 v214, v244, v245
    v_mfma_f32_16x16x32_bf16 a[120:123], a[252:255], v[200:203], a[120:123]
    v_exp_f32 v247, v183
    v_add_f32 v49, v49, v246
    v_mfma_f32_16x16x32_bf16 a[124:127], a[252:255], v[204:207], a[124:127]
    s_waitcnt lgkmcnt(5)
    ds_read_b128 a[156:159], v2 offset:7168
    v_add_f32 v49, v49, v247
    v_mfma_f32_16x16x32_bf16 v[128:131], a[128:131], v[96:99], v[16:19]
    s_waitcnt vmcnt(12)
    s_barrier
    v_exp_f32 v232, v168
    v_cvt_pk_bf16_f32 v215, v246, v247
    v_mfma_f32_16x16x32_bf16 v[132:135], a[128:131], v[112:115], v[20:23]
    s_mov_b32 m0, s34
    ds_read_b128 a[160:163], v2 offset:8192
    v_exp_f32 v233, v169
    v_mfma_f32_16x16x32_bf16 v[128:131], a[132:135], v[100:103], v[128:131]
    ds_read_b128 a[164:167], v2 offset:9216
    v_add_f32 v50, v232, v233
    v_mfma_f32_16x16x32_bf16 v[132:135], a[132:135], v[116:119], v[132:135]
    s_waitcnt lgkmcnt(6)
    v_exp_f32 v234, v170
    v_cvt_pk_bf16_f32 v216, v232, v233
    v_mfma_f32_16x16x32_bf16 v[128:131], a[136:139], v[104:107], v[128:131]
    s_add_u32 s36, s36, 64
    buffer_load_dwordx4 v1, s[16:19], s32 offen offset:0 sc1 lds
    ds_read_b128 a[168:171], v2 offset:10240
    v_mfma_f32_16x16x32_bf16 v[132:135], a[136:139], v[120:123], v[132:135]
    v_exp_f32 v235, v171
    v_add_f32 v50, v50, v234
    v_mfma_f32_16x16x32_bf16 v[128:131], a[140:143], v[108:111], v[128:131]
    ds_read_b128 a[172:175], v2 offset:11264
    v_add_f32 v50, v50, v235
    v_mfma_f32_16x16x32_bf16 v[132:135], a[140:143], v[124:127], v[132:135]
    s_waitcnt lgkmcnt(6)
    v_exp_f32 v236, v184
    v_cvt_pk_bf16_f32 v217, v234, v235
    v_mfma_f32_16x16x32_bf16 v[144:147], a[144:147], v[96:99], v[32:35]
    s_add_u32 s34, s34, 0x4000
    ds_read_b128 a[176:179], v2 offset:12288
    v_add_f32 v50, v50, v236
    v_mfma_f32_16x16x32_bf16 v[148:151], a[144:147], v[112:115], v[36:39]
    s_add_u32 s52, s52, 16384
    ds_read_b128 a[180:183], v2 offset:13312
    v_exp_f32 v237, v185
    v_mfma_f32_16x16x32_bf16 v[144:147], a[148:151], v[100:103], v[144:147]
    s_and_b32 s52, s52, 0xffff
    v_add_f32 v50, v50, v237
    v_cvt_pk_bf16_f32 v218, v236, v237
    v_mfma_f32_16x16x32_bf16 v[148:151], a[148:151], v[116:119], v[148:151]
    s_waitcnt lgkmcnt(6)
    ds_read_b128 a[184:187], v2 offset:14336
    v_exp_f32 v238, v186
    v_mfma_f32_16x16x32_bf16 v[144:147], a[152:155], v[104:107], v[144:147]
    buffer_load_dwordx4 v1, s[16:19], s32 offen offset:1024 sc1 lds
    ds_read_b128 a[188:191], v2 offset:15360
    v_mfma_f32_16x16x32_bf16 v[148:151], a[152:155], v[120:123], v[148:151]
    v_exp_f32 v239, v187
    v_add_f32 v50, v50, v238
    v_mfma_f32_16x16x32_bf16 v[144:147], a[156:159], v[108:111], v[144:147]
    s_and_b32 s34, s34, 0xffff
    v_add_f32 v50, v50, v239
    v_cvt_pk_bf16_f32 v219, v238, v239
    v_mfma_f32_16x16x32_bf16 v[148:151], a[156:159], v[124:127], v[148:151]
    s_waitcnt lgkmcnt(6)
    ds_read_b128 a[192:195], v3 offset:0
    v_exp_f32 v240, v172
    v_mfma_f32_16x16x32_bf16 v[136:139], a[160:163], v[96:99], v[24:27]
    v_exp_f32 v241, v173
    v_mfma_f32_16x16x32_bf16 v[140:143], a[160:163], v[112:115], v[28:31]
    v_add_f32 v51, v240, v241
    v_exp_f32 v242, v174
    v_mfma_f32_16x16x32_bf16 v[136:139], a[164:167], v[100:103], v[136:139]
    buffer_load_dwordx4 v1, s[16:19], s32 offen offset:2048 sc1 lds
    ds_read_b128 a[196:199], v3 offset:1024
    v_mfma_f32_16x16x32_bf16 v[140:143], a[164:167], v[116:119], v[140:143]
    s_waitcnt lgkmcnt(6)
    v_cvt_pk_bf16_f32 v220, v240, v241
    v_exp_f32 v243, v175
    v_mfma_f32_16x16x32_bf16 v[136:139], a[168:171], v[104:107], v[136:139]
    v_add_u32 v2, s52, v1
    v_add_f32 v51, v51, v242
    v_mfma_f32_16x16x32_bf16 v[140:143], a[168:171], v[120:123], v[140:143]
    ds_read_b128 a[200:203], v3 offset:2048
    v_add_f32 v51, v51, v243
    v_cvt_pk_bf16_f32 v221, v242, v243
    v_mfma_f32_16x16x32_bf16 v[136:139], a[172:175], v[108:111], v[136:139]
    v_exp_f32 v244, v188
    v_mfma_f32_16x16x32_bf16 v[140:143], a[172:175], v[124:127], v[140:143]
    s_waitcnt lgkmcnt(5)
    ds_read_b128 a[204:207], v3 offset:3072
    v_exp_f32 v245, v189
    v_mfma_f32_16x16x32_bf16 v[152:155], a[176:179], v[96:99], v[40:43]
    ds_read_b128 a[208:211], v3 offset:4096
    v_add_f32 v51, v51, v244
    v_mfma_f32_16x16x32_bf16 v[156:159], a[176:179], v[112:115], v[44:47]
    v_add_f32 v51, v51, v245
    v_exp_f32 v246, v190
    v_mfma_f32_16x16x32_bf16 v[152:155], a[180:183], v[100:103], v[152:155]
    buffer_load_dwordx4 v1, s[16:19], s32 offen offset:3072 sc1 lds
    ds_read_b128 a[212:215], v3 offset:5120
    v_mfma_f32_16x16x32_bf16 v[156:159], a[180:183], v[116:119], v[156:159]
    s_waitcnt lgkmcnt(6)
    v_cvt_pk_bf16_f32 v222, v244, v245
    s_add_u32 s32, s32, 0x80000
    v_add_f32 v51, v51, v246
    v_mfma_f32_16x16x32_bf16 v[152:155], a[184:187], v[104:107], v[152:155]
    v_exp_f32 v247, v191
    v_mfma_f32_16x16x32_bf16 v[156:159], a[184:187], v[120:123], v[156:159]
    ds_read_b128 a[216:219], v3 offset:6144
    v_max3_f32 v6, v48, v49, v50
    v_add_f32 v51, v51, v247
    v_mfma_f32_16x16x32_bf16 v[152:155], a[188:191], v[108:111], v[152:155]
    ds_read_b128 a[220:223], v3 offset:7168
    v_cvt_pk_bf16_f32 v223, v246, v247
    v_mfma_f32_16x16x32_bf16 v[156:159], a[188:191], v[124:127], v[156:159]
    v_max_f32 v6, v6, v51
    v_cmp_nge_f32 vcc, s37, v6
    s_cbranch_vccnz k2_rare_70
k2_ret_71:
    s_waitcnt lgkmcnt(6)
    v_mfma_f32_16x16x32_bf16 a[8:11], a[192:195], v[208:211], a[8:11]
    ds_read_b128 a[224:227], v3 offset:8192
    v_add_f32 v14, v14, v48
    v_add_f32 v15, v15, v49
    v_mfma_f32_16x16x32_bf16 a[12:15], a[192:195], v[212:215], a[12:15]
    s_mov_b32 m0, s35
    v_exp_f32 v232, v128
    v_mfma_f32_16x16x32_bf16 a[24:27], a[196:199], v[208:211], a[24:27]
    s_add_u32 s53, s53, 16384
    ds_read_b128 a[228:231], v3 offset:9216
    v_add_f32 v14, v14, v50
    v_add_f32 v15, v15, v51
    v_mfma_f32_16x16x32_bf16 a[28:31], a[196:199], v[212:215], a[28:31]
    s_waitcnt lgkmcnt(6)
    v_exp_f32 v233, v129
    v_mfma_f32_16x16x32_bf16 a[40:43], a[200:203], v[208:211], a[40:43]
    s_and_b32 s53, s53, 0xffff
    buffer_load_dwordx4 v1, s[20:23], s33 offen offset:0 sc1 lds
    ds_read_b128 a[232:235], v3 offset:10240
    ds_read_b128 a[236:239], v3 offset:11264
    v_mfma_f32_16x16x32_bf16 a[44:47], a[200:203], v[212:215], a[44:47]
    v_add_f32 v48, v232, v233
    v_cvt_pk_bf16_f32 v192, v232, v233
    v_mfma_f32_16x16x32_bf16 a[56:59], a[204:207], v[208:211], a[56:59]
    ds_read_b128 a[240:243], v3 offset:12288
    v_exp_f32 v234, v130
    v_mfma_f32_16x16x32_bf16 a[60:63], a[204:207], v[212:215], a[60:63]
    s_waitcnt lgkmcnt(7)
    v_exp_f32 v235, v131
    v_mfma_f32_16x16x32_bf16 a[72:75], a[208:211], v[208:211], a[72:75]
    s_add_u32 s35, s35, 0x4000
    v_add_f32 v48, v48, v234
    v_add_f32 v48, v48, v235
    v_cvt_pk_bf16_f32 v193, v234, v235
    v_mfma_f32_16x16x32_bf16 a[76:79], a[208:211], v[212:215], a[76:79]
    v_exp_f32 v236, v144
    v_mfma_f32_16x16x32_bf16 a[88:91], a[212:215], v[208:211], a[88:91]
    ds_read_b128 a[244:247], v3 offset:13312
    v_exp_f32 v237, v145
    v_mfma_f32_16x16x32_bf16 a[92:95], a[212:215], v[212:215], a[92:95]
    s_waitcnt lgkmcnt(6)
    buffer_load_dwordx4 v1, s[20:23], s33 offen offset:1024 sc1 lds
    ds_read_b128 a[248:251], v3 offset:14336
    v_mfma_f32_16x16x32_bf16 a[104:107], a[216:219], v[208:211], a[104:107]
    v_add_f32 v48, v48, v236
    v_add_f32 v48, v48, v237
    v_cvt_pk_bf16_f32 v194, v236, v237
    v_mfma_f32_16x16x32_bf16 a[108:111], a[216:219], v[212:215], a[108:111]
    v_exp_f32 v238, v146
    v_mfma_f32_16x16x32_bf16 a[120:123], a[220:223], v[208:211], a[120:123]
    s_and_b32 s35, s35, 0xffff
    ds_read_b128 a[252:255], v3 offset:15360
    v_exp_f32 v239, v147
    v_mfma_f32_16x16x32_bf16 a[124:127], a[220:223], v[212:215], a[124:127]
    s_waitcnt lgkmcnt(6)
    v_add_f32 v48, v48, v238
    v_add_f32 v48, v48, v239
    v_mfma_f32_16x16x32_bf16 a[8:11], a[224:227], v[216:219], a[8:11]
    ds_read_b128 a[128:131], v2 offset:0
    v_exp_f32 v240, v132
    v_mfma_f32_16x16x32_bf16 a[12:15], a[224:227], v[220:223], a[12:15]
    ds_read_b128 a[132:135], v2 offset:1024
    v_cvt_pk_bf16_f32 v195, v238, v239
    v_mfma_f32_16x16x32_bf16 a[24:27], a[228:231], v[216:219], a[24:27]
    s_or_b32 s35, s35, 0x10000
    buffer_load_dwordx4 v1, s[20:23], s33 offen offset:2048 sc1 lds
    ds_read_b128 a[136:139], v2 offset:2048
    v_mfma_f32_16x16x32_bf16 a[28:31], a[228:231], v[220:223], a[28:31]
    s_waitcnt lgkmcnt(7)
    v_exp_f32 v241, v133
    v_add_u32 v3, s53, v56
    v_mfma_f32_16x16x32_bf16 a[40:43], a[232:235], v[216:219], a[40:43]
    v_add_f32 v49, v240, v241
    v_exp_f32 v242, v134
    v_mfma_f32_16x16x32_bf16 a[44:47], a[232:235], v[220:223], a[44:47]
    v_cvt_pk_bf16_f32 v196, v240, v241
    v_add_f32 v49, v49, v242
    v_mfma_f32_16x16x32_bf16 a[56:59], a[236:239], v[216:219], a[56:59]
    ds_read_b128 a[140:143], v2 offset:3072
    v_exp_f32 v243, v135
    v_mfma_f32_16x16x32_bf16 a[60:63], a[236:239], v[220:223], a[60:63]
    s_waitcnt lgkmcnt(6)
    ds_read_b128 a[144:147], v2 offset:4096
    v_add_f32 v49, v49, v243
    v_mfma_f32_16x16x32_bf16 a[72:75], a[240:243], v[216:219], a[72:75]
    v_exp_f32 v244, v148
    v_cvt_pk_bf16_f32 v197, v242, v243
    v_mfma_f32_16x16x32_bf16 a[76:79], a[240:243], v[220:223], a[76:79]
    buffer_load_dwordx4 v1, s[20:23], s33 offen offset:3072 sc1 lds
    ds_read_b128 a[148:151], v2 offset:5120
    v_mfma_f32_16x16x32_bf16 a[88:91], a[244:247], v[216:219], a[88:91]
    s_add_u32 s33, s33, 0x80000
    v_exp_f32 v245, v149
    v_add_f32 v49, v49, v244
    v_mfma_f32_16x16x32_bf16 a[92:95], a[244:247], v[220:223], a[92:95]
    s_waitcnt lgkmcnt(6)
    s_cmp_ge_u32 s36, s43
    s_cbranch_scc1 k2_prep_72
k2_prepret_73:
    v_mfma_f32_16x16x32_bf16 a[104:107], a[248:251], v[216:219], a[104:107]
    v_add_f32 v49, v49, v245
    v_exp_f32 v246, v150
    v_mfma_f32_16x16x32_bf16 a[108:111], a[248:251], v[220:223], a[108:111]
    ds_read_b128 a[152:155], v2 offset:6144
    v_cvt_pk_bf16_f32 v198, v244, v245
    v_mfma_f32_16x16x32_bf16 a[120:123], a[252:255], v[216:219], a[120:123]
    v_exp_f32 v247, v151
    v_add_f32 v49, v49, v246
    v_mfma_f32_16x16x32_bf16 a[124:127], a[252:255], v[220:223], a[124:127]
    s_waitcnt lgkmcnt(5)
    ds_read_b128 a[156:159], v2 offset:7168
    v_add_f32 v49, v49, v247
    v_mfma_f32_16x16x32_bf16 v[160:163], a[128:131], v[96:99], v[16:19]
    s_waitcnt vmcnt(12)
    s_barrier
    v_exp_f32 v232, v136
    v_cvt_pk_bf16_f32 v199, v246, v247
    v_mfma_f32_16x16x32_bf16 v[164:167], a[128:131], v[112:115], v[20:23]
    s_mov_b32 m0, s34
    ds_read_b128 a[160:163], v2 offset:8192
    v_exp_f32 v233, v137
    v_mfma_f32_16x16x32_bf16 v[160:163], a[132:135], v[100:103], v[160:163]
    ds_read_b128 a[164:167], v2 offset:9216
    v_add_f32 v50, v232, v233
    v_mfma_f32_16x16x32_bf16 v[164:167], a[132:135], v[116:119], v[164:167]
    s_waitcnt lgkmcnt(6)
    v_exp_f32 v234, v138
    v_cvt_pk_bf16_f32 v200, v232, v233
    v_mfma_f32_16x16x32_bf16 v[160:163], a[136:139], v[104:107], v[160:163]
    s_add_u32 s36, s36, 64
    buffer_load_dwordx4 v1, s[16:19], s32 offen offset:0 sc1 lds
    ds_read_b128 a[168:171], v2 offset:10240
    v_mfma_f32_16x16x32_bf16 v[164:167], a[136:139], v[120:123], v[164:167]
    v_exp_f32 v235, v139
    v_add_f32 v50, v50, v234
    v_mfma_f32_16x16x32_bf16 v[160:163], a[140:143], v[108:111], v[160:163]
    ds_read_b128 a[172:175], v2 offset:11264
    v_add_f32 v50, v50, v235
    v_mfma_f32_16x16x32_bf16 v[164:167], a[140:143], v[124:127], v[164:167]
    s_waitcnt lgkmcnt(6)
    v_exp_f32 v236, v152
    v_cvt_pk_bf16_f32 v201, v234, v235
    v_mfma_f32_16x16x32_bf16 v[176:179], a[144:147], v[96:99], v[32:35]
    s_add_u32 s34, s34, 0x4000
    ds_read_b128 a[176:179], v2 offset:12288
    v_add_f32 v50, v50, v236
    v_mfma_f32_16x16x32_bf16 v[180:183], a[144:147], v[112:115], v[36:39]
    s_add_u32 s52, s52, 16384
    ds_read_b128 a[180:183], v2 offset:13312
    v_exp_f32 v237, v153
    v_mfma_f32_16x16x32_bf16 v[176:179], a[148:151], v[100:103], v[176:179]
    s_and_b32 s52, s52, 0xffff
    v_add_f32 v50, v50, v237
    v_cvt_pk_bf16_f32 v202, v236, v237
    v_mfma_f32_16x16x32_bf16 v[180:183], a[148:151], v[116:119], v[180:183]
    s_waitcnt lgkmcnt(6)
    ds_read_b128 a[184:187], v2 offset:14336
    v_exp_f32 v238, v154
    v_mfma_f32_16x16x32_bf16 v[176:179], a[152:155], v[104:107], v[176:179]
    buffer_load_dwordx4 v1, s[16:19], s32 offen offset:1024 sc1 lds
    ds_read_b128 a[188:191], v2 offset:15360
    v_mfma_f32_16x16x32_bf16 v[180:183], a[152:155], v[120:123], v[180:183]
    v_exp_f32 v239, v155
    v_add_f32 v50, v50, v238
    v_mfma_f32_16x16x32_bf16 v[176:179], a[156:159], v[108:111], v[176:179]
    s_and_b32 s34, s34, 0xffff
    v_add_f32 v50, v50, v239
    v_cvt_pk_bf16_f32 v203, v238, v239
    v_mfma_f32_16x16x32_bf16 v[180:183], a[156:159], v[124:127], v[180:183]
    s_waitcnt lgkmcnt(6)
    ds_read_b128 a[192:195], v3 offset:0
    v_exp_f32 v240, v140
    v_mfma_f32_16x16x32_bf16 v[168:171], a[160:163], v[96:99], v[24:27]
    v_exp_f32 v241, v141
    v_mfma_f32_16x16x32_bf16 v[172:175], a[160:163], v[112:115], v[28:31]
    v_add_f32 v51, v240, v241
    v_exp_f32 v242, v142
    v_mfma_f32_16x16x32_bf16 v[168:171], a[164:167], v[100:103], v[168:171]
    buffer_load_dwordx4 v1, s[16:19], s32 offen offset:2048 sc1 lds
    ds_read_b128 a[196:199], v3 offset:1024
    v_mfma_f32_16x16x32_bf16 v[172:175], a[164:167], v[116:119], v[172:175]
    s_waitcnt lgkmcnt(6)
    v_cvt_pk_bf16_f32 v204, v240, v241
    v_exp_f32 v243, v143
    v_mfma_f32_16x16x32_bf16 v[168:171], a[168:171], v[104:107], v[168:171]
    v_add_u32 v2, s52, v1
    v_add_f32 v51, v51, v242
    v_mfma_f32_16x16x32_bf16 v[172:175], a[168:171], v[120:123], v[172:175]
    ds_read_b128 a[200:203], v3 offset:2048
    v_add_f32 v51, v51, v243
    v_cvt_pk_bf16_f32 v205, v242, v243
    v_mfma_f32_16x16x32_bf16 v[168:171], a[172:175], v[108:111], v[168:171]
    v_exp_f32 v244, v156
    v_mfma_f32_16x16x32_bf16 v[172:175], a[172:175], v[124:127], v[172:175]
    s_waitcnt lgkmcnt(5)
    ds_read_b128 a[204:207], v3 offset:3072
    v_exp_f32 v245, v157
    v_mfma_f32_16x16x32_bf16 v[184:187], a[176:179], v[96:99], v[40:43]
    s_sub_u32 s63, s63, 1
    ds_read_b128 a[208:211], v3 offset:4096
    v_add_f32 v51, v51, v244
    v_mfma_f32_16x16x32_bf16 v[188:191], a[176:179], v[112:115], v[44:47]
    v_add_f32 v51, v51, v245
    v_exp_f32 v246, v158
    v_mfma_f32_16x16x32_bf16 v[184:187], a[180:183], v[100:103], v[184:187]
    buffer_load_dwordx4 v1, s[16:19], s32 offen offset:3072 sc1 lds
    ds_read_b128 a[212:215], v3 offset:5120
    v_mfma_f32_16x16x32_bf16 v[188:191], a[180:183], v[116:119], v[188:191]
    s_waitcnt lgkmcnt(6)
    v_cvt_pk_bf16_f32 v206, v244, v245
    s_add_u32 s32, s32, 0x80000
    v_add_f32 v51, v51, v246
    v_mfma_f32_16x16x32_bf16 v[184:187], a[184:187], v[104:107], v[184:187]
    v_exp_f32 v247, v159
    v_mfma_f32_16x16x32_bf16 v[188:191], a[184:187], v[120:123], v[188:191]
    ds_read_b128 a[216:219], v3 offset:6144
    v_max3_f32 v6, v48, v49, v50
    v_add_f32 v51, v51, v247
    v_mfma_f32_16x16x32_bf16 v[184:187], a[188:191], v[108:111], v[184:187]
    ds_read_b128 a[220:223], v3 offset:7168
    v_cvt_pk_bf16_f32 v207, v246, v247
    v_mfma_f32_16x16x32_bf16 v[188:191], a[188:191], v[124:127], v[188:191]
    v_max_f32 v6, v6, v51
    v_cmp_nge_f32 vcc, s37, v6
    s_cbranch_vccnz k2_rare_74
k2_ret_75:
    s_cmp_lg_u32 s63, 0
    s_cbranch_scc1 k2_sloop_66
k2_sdone_67:
    s_waitcnt lgkmcnt(6)
    v_mfma_f32_16x16x32_bf16 a[8:11], a[192:195], v[192:195], a[8:11]
    s_waitcnt vmcnt(0)
    s_barrier
    ds_read_b128 a[224:227], v3 offset:8192
    v_add_f32 v14, v14, v48
    v_add_f32 v15, v15, v49
    v_mfma_f32_16x16x32_bf16 a[12:15], a[192:195], v[196:199], a[12:15]
    v_exp_f32 v232, v160
    v_add_f32 v14, v14, v50
    v_mfma_f32_16x16x32_bf16 a[24:27], a[196:199], v[192:195], a[24:27]
    s_add_u32 s53, s53, 16384
    ds_read_b128 a[228:231], v3 offset:9216
    v_exp_f32 v233, v161
    v_mfma_f32_16x16x32_bf16 a[28:31], a[196:199], v[196:199], a[28:31]
    s_waitcnt lgkmcnt(6)
    v_add_f32 v48, v232, v233
    v_exp_f32 v234, v162
    v_mfma_f32_16x16x32_bf16 a[40:43], a[200:203], v[192:195], a[40:43]
    s_and_b32 s53, s53, 0xffff
    v_cvt_pk_bf16_f32 v208, v232, v233
    v_add_f32 v15, v15, v51
    v_add_f32 v48, v48, v234
    v_mfma_f32_16x16x32_bf16 a[44:47], a[200:203], v[196:199], a[44:47]
    ds_read_b128 a[232:235], v3 offset:10240
    v_exp_f32 v235, v163
    v_mfma_f32_16x16x32_bf16 a[56:59], a[204:207], v[192:195], a[56:59]
    v_add_f32 v48, v48, v235
    v_exp_f32 v236, v176
    v_mfma_f32_16x16x32_bf16 a[60:63], a[204:207], v[196:199], a[60:63]
    s_waitcnt lgkmcnt(5)
    v_cvt_pk_bf16_f32 v209, v234, v235
    v_exp_f32 v237, v177
    v_mfma_f32_16x16x32_bf16 a[72:75], a[208:211], v[192:195], a[72:75]
    ds_read_b128 a[236:239], v3 offset:11264
    v_add_f32 v48, v48, v236
    v_add_f32 v48, v48, v237
    v_mfma_f32_16x16x32_bf16 a[76:79], a[208:211], v[196:199], a[76:79]
    v_exp_f32 v238, v178
    v_cvt_pk_bf16_f32 v210, v236, v237
    v_mfma_f32_16x16x32_bf16 a[88:91], a[212:215], v[192:195], a[88:91]
    v_exp_f32 v239, v179
    v_add_f32 v48, v48, v238
    v_mfma_f32_16x16x32_bf16 a[92:95], a[212:215], v[196:199], a[92:95]
    s_waitcnt lgkmcnt(4)
    v_add_f32 v48, v48, v239
    v_exp_f32 v240, v164
    v_mfma_f32_16x16x32_bf16 a[104:107], a[216:219], v[192:195], a[104:107]
    ds_read_b128 a[240:243], v3 offset:12288
    v_cvt_pk_bf16_f32 v211, v238, v239
    v_exp_f32 v241, v165
    v_mfma_f32_16x16x32_bf16 a[108:111], a[216:219], v[196:199], a[108:111]
    v_add_f32 v49, v240, v241
    v_exp_f32 v242, v166
    v_mfma_f32_16x16x32_bf16 a[120:123], a[220:223], v[192:195], a[120:123]
    ds_read_b128 a[244:247], v3 offset:13312
    v_cvt_pk_bf16_f32 v212, v240, v241
    v_exp_f32 v243, v167
    v_mfma_f32_16x16x32_bf16 a[124:127], a[220:223], v[196:199], a[124:127]
    s_waitcnt lgkmcnt(4)
    v_add_f32 v49, v49, v242
    v_add_f32 v49, v49, v243
    v_exp_f32 v244, v180
    v_mfma_f32_16x16x32_bf16 a[8:11], a[224:227], v[200:203], a[8:11]
    ds_read_b128 a[248:251], v3 offset:14336
    v_cvt_pk_bf16_f32 v213, v242, v243
    v_exp_f32 v245, v181
    v_mfma_f32_16x16x32_bf16 a[12:15], a[224:227], v[204:207], a[12:15]
    v_add_f32 v49, v49, v244
    v_add_f32 v49, v49, v245
    v_exp_f32 v246, v182
    v_mfma_f32_16x16x32_bf16 a[24:27], a[228:231], v[200:203], a[24:27]
    ds_read_b128 a[252:255], v3 offset:15360
    v_cvt_pk_bf16_f32 v214, v244, v245
    v_exp_f32 v247, v183
    v_mfma_f32_16x16x32_bf16 a[28:31], a[228:231], v[204:207], a[28:31]
    s_waitcnt lgkmcnt(4)
    v_add_f32 v49, v49, v246
    v_add_f32 v49, v49, v247
    v_exp_f32 v232, v168
    v_mfma_f32_16x16x32_bf16 a[40:43], a[232:235], v[200:203], a[40:43]
    v_cvt_pk_bf16_f32 v215, v246, v247
    v_exp_f32 v233, v169
    v_mfma_f32_16x16x32_bf16 a[44:47], a[232:235], v[204:207], a[44:47]
    v_add_f32 v50, v232, v233
    v_exp_f32 v234, v170
    v_mfma_f32_16x16x32_bf16 a[56:59], a[236:239], v[200:203], a[56:59]
    v_cvt_pk_bf16_f32 v216, v232, v233
    v_exp_f32 v235, v171
    v_mfma_f32_16x16x32_bf16 a[60:63], a[236:239], v[204:207], a[60:63]
    s_waitcnt lgkmcnt(2)
    v_add_f32 v50, v50, v234
    v_add_f32 v50, v50, v235
    v_exp_f32 v236, v184
    v_mfma_f32_16x16x32_bf16 a[72:75], a[240:243], v[200:203], a[72:75]
    v_cvt_pk_bf16_f32 v217, v234, v235
    v_exp_f32 v237, v185
    v_mfma_f32_16x16x32_bf16 a[76:79], a[240:243], v[204:207], a[76:79]
    v_add_f32 v50, v50, v236
    v_add_u32 v3, s53, v56
    ds_read_b128 a[192:195], v3 offset:0
    v_mfma_f32_16x16x32_bf16 a[88:91], a[244:247], v[200:203], a[88:91]
    ds_read_b128 a[196:199], v3 offset:1024
    ds_read_b128 a[200:203], v3 offset:2048
    v_add_f32 v50, v50, v237
    v_mfma_f32_16x16x32_bf16 a[92:95], a[244:247], v[204:207], a[92:95]
    s_waitcnt lgkmcnt(3)
    v_exp_f32 v238, v186
    v_cvt_pk_bf16_f32 v218, v236, v237
    v_mfma_f32_16x16x32_bf16 a[104:107], a[248:251], v[200:203], a[104:107]
    v_exp_f32 v239, v187
    v_add_f32 v50, v50, v238
    v_mfma_f32_16x16x32_bf16 a[108:111], a[248:251], v[204:207], a[108:111]
    ds_read_b128 a[204:207], v3 offset:3072
    v_add_f32 v50, v50, v239
    v_exp_f32 v240, v172
    v_mfma_f32_16x16x32_bf16 a[120:123], a[252:255], v[200:203], a[120:123]
    ds_read_b128 a[208:211], v3 offset:4096
    v_cvt_pk_bf16_f32 v219, v238, v239
    v_exp_f32 v241, v173
    v_mfma_f32_16x16x32_bf16 a[124:127], a[252:255], v[204:207], a[124:127]
    v_add_f32 v51, v240, v241
    v_exp_f32 v242, v174
    ds_read_b128 a[212:215], v3 offset:5120
    v_cvt_pk_bf16_f32 v220, v240, v241
    v_exp_f32 v243, v175
    v_add_f32 v51, v51, v242
    ds_read_b128 a[216:219], v3 offset:6144
    v_add_f32 v51, v51, v243
    v_exp_f32 v244, v188
    v_cvt_pk_bf16_f32 v221, v242, v243
    v_exp_f32 v245, v189
    v_add_f32 v51, v51, v244
    ds_read_b128 a[220:223], v3 offset:7168
    v_add_f32 v51, v51, v245
    v_exp_f32 v246, v190
    v_cvt_pk_bf16_f32 v222, v244, v245
    ds_read_b128 a[224:227], v3 offset:8192
    v_max3_f32 v6, v48, v49, v50
    v_exp_f32 v247, v191
    v_add_f32 v51, v51, v246
    v_add_f32 v51, v51, v247
    ds_read_b128 a[228:231], v3 offset:9216
    v_cvt_pk_bf16_f32 v223, v246, v247
    ds_read_b128 a[232:235], v3 offset:10240
    v_max_f32 v6, v6, v51
    ds_read_b128 a[236:239], v3 offset:11264
    v_cmp_nge_f32 vcc, s37, v6
    ds_read_b128 a[240:243], v3 offset:12288
    ds_read_b128 a[244:247], v3 offset:13312
    ds_read_b128 a[248:251], v3 offset:14336
    ds_read_b128 a[252:255], v3 offset:15360
    s_cbranch_vccnz k2_rare_76
k2_ret_77:
    s_waitcnt lgkmcnt(14)
    v_mfma_f32_16x16x32_bf16 a[8:11], a[192:195], v[208:211], a[8:11]
    v_add_f32 v14, v14, v48
    v_add_f32 v15, v15, v49
    v_mfma_f32_16x16x32_bf16 a[12:15], a[192:195], v[212:215], a[12:15]
    v_add_f32 v14, v14, v50
    v_add_f32 v15, v15, v51
    v_mfma_f32_16x16x32_bf16 a[24:27], a[196:199], v[208:211], a[24:27]
    v_mfma_f32_16x16x32_bf16 a[28:31], a[196:199], v[212:215], a[28:31]
    s_waitcnt lgkmcnt(12)
    v_mfma_f32_16x16x32_bf16 a[40:43], a[200:203], v[208:211], a[40:43]
    v_mfma_f32_16x16x32_bf16 a[44:47], a[200:203], v[212:215], a[44:47]
    v_mfma_f32_16x16x32_bf16 a[56:59], a[204:207], v[208:211], a[56:59]
    v_mfma_f32_16x16x32_bf16 a[60:63], a[204:207], v[212:215], a[60:63]
    s_waitcnt lgkmcnt(10)
    v_mfma_f32_16x16x32_bf16 a[72:75], a[208:211], v[208:211], a[72:75]
    v_mfma_f32_16x16x32_bf16 a[76:79], a[208:211], v[212:215], a[76:79]
    v_mfma_f32_16x16x32_bf16 a[88:91], a[212:215], v[208:211], a[88:91]
    v_mfma_f32_16x16x32_bf16 a[92:95], a[212:215], v[212:215], a[92:95]
    s_waitcnt lgkmcnt(8)
    v_mfma_f32_16x16x32_bf16 a[104:107], a[216:219], v[208:211], a[104:107]
    v_mfma_f32_16x16x32_bf16 a[108:111], a[216:219], v[212:215], a[108:111]
    v_mfma_f32_16x16x32_bf16 a[120:123], a[220:223], v[208:211], a[120:123]
    v_mfma_f32_16x16x32_bf16 a[124:127], a[220:223], v[212:215], a[124:127]
    s_waitcnt lgkmcnt(6)
    v_mfma_f32_16x16x32_bf16 a[8:11], a[224:227], v[216:219], a[8:11]
    v_mfma_f32_16x16x32_bf16 a[12:15], a[224:227], v[220:223], a[12:15]
    v_mfma_f32_16x16x32_bf16 a[24:27], a[228:231], v[216:219], a[24:27]
    v_mfma_f32_16x16x32_bf16 a[28:31], a[228:231], v[220:223], a[28:31]
    s_waitcnt lgkmcnt(4)
    v_mfma_f32_16x16x32_bf16 a[40:43], a[232:235], v[216:219], a[40:43]
    v_mfma_f32_16x16x32_bf16 a[44:47], a[232:235], v[220:223], a[44:47]
    v_mfma_f32_16x16x32_bf16 a[56:59], a[236:239], v[216:219], a[56:59]
    v_mfma_f32_16x16x32_bf16 a[60:63], a[236:239], v[220:223], a[60:63]
    s_waitcnt lgkmcnt(2)
    v_mfma_f32_16x16x32_bf16 a[72:75], a[240:243], v[216:219], a[72:75]
    v_mfma_f32_16x16x32_bf16 a[76:79], a[240:243], v[220:223], a[76:79]
    v_mfma_f32_16x16x32_bf16 a[88:91], a[244:247], v[216:219], a[88:91]
    v_mfma_f32_16x16x32_bf16 a[92:95], a[244:247], v[220:223], a[92:95]
    s_waitcnt lgkmcnt(0)
    v_mfma_f32_16x16x32_bf16 a[104:107], a[248:251], v[216:219], a[104:107]
    v_mfma_f32_16x16x32_bf16 a[108:111], a[248:251], v[220:223], a[108:111]
    v_mfma_f32_16x16x32_bf16 a[120:123], a[252:255], v[216:219], a[120:123]
    v_mfma_f32_16x16x32_bf16 a[124:127], a[252:255], v[220:223], a[124:127]
    v_mov_b32 v6, v12
    s_nop 1
    v_permlane16_swap_b32 v12, v6
    s_nop 1
    v_add_f32 v12, v12, v6
    v_mov_b32 v6, v12
    s_nop 1
    v_permlane32_swap_b32 v12, v6
    s_nop 1
    v_add_f32 v12, v12, v6
    v_rcp_f32 v12, v12
    v_mov_b32 v6, v13
    s_nop 1
    v_permlane16_swap_b32 v13, v6
    s_nop 1
    v_add_f32 v13, v13, v6
    v_mov_b32 v6, v13
    s_nop 1
    v_permlane32_swap_b32 v13, v6
    s_nop 1
    v_add_f32 v13, v13, v6
    v_rcp_f32 v13, v13
    v_mov_b32 v6, v14
    s_nop 1
    v_permlane16_swap_b32 v14, v6
    s_nop 1
    v_add_f32 v14, v14, v6
    v_mov_b32 v6, v14
    s_nop 1
    v_permlane32_swap_b32 v14, v6
    s_nop 1
    v_add_f32 v14, v14, v6
    v_rcp_f32 v14, v14
    v_mov_b32 v6, v15
    s_nop 1
    v_permlane16_swap_b32 v15, v6
    s_nop 1
    v_add_f32 v15, v15, v6
    v_mov_b32 v6, v15
    s_nop 1
    v_permlane32_swap_b32 v15, v6
    s_nop 1
    v_add_f32 v15, v15, v6
    v_rcp_f32 v15, v15
    s_lshl_b32 s31, s28, 19
    s_lshl_b32 s40, s38, 6
    s_add_u32 s40, s40, s31
    s_lshl_b32 s44, s39, 6
    s_add_u32 s44, s44, s31
    s_add_u32 s41, s40, 131072
    s_add_u32 s45, s44, 131072
    s_add_u32 s42, s40, 262144
    s_add_u32 s46, s44, 262144
    s_add_u32 s43, s40, 393216
    s_add_u32 s47, s44, 393216
    v_accvgpr_read_b32 v132, a0
    v_accvgpr_read_b32 v133, a1
    v_accvgpr_read_b32 v134, a2
    v_accvgpr_read_b32 v135, a3
    v_accvgpr_read_b32 v136, a16
    v_accvgpr_read_b32 v137, a17
    v_accvgpr_read_b32 v138, a18
    v_accvgpr_read_b32 v139, a19
    v_mul_f32 v132, v132, v12
    v_mul_f32 v133, v133, v12
    v_mul_f32 v134, v134, v12
    v_mul_f32 v135, v135, v12
    v_mul_f32 v136, v136, v12
    v_mul_f32 v137, v137, v12
    v_mul_f32 v138, v138, v12
    v_mul_f32 v139, v139, v12
    v_cvt_pk_bf16_f32 v128, v132, v133
    v_cvt_pk_bf16_f32 v129, v134, v135
    v_cvt_pk_bf16_f32 v130, v136, v137
    v_cvt_pk_bf16_f32 v131, v138, v139
    buffer_store_dwordx4 v[128:131], v1, s[24:27], s40 offen offset:0 sc1
    v_accvgpr_read_b32 v144, a32
    v_accvgpr_read_b32 v145, a33
    v_accvgpr_read_b32 v146, a34
    v_accvgpr_read_b32 v147, a35
    v_accvgpr_read_b32 v148, a48
    v_accvgpr_read_b32 v149, a49
    v_accvgpr_read_b32 v150, a50
    v_accvgpr_read_b32 v151, a51
    v_mul_f32 v144, v144, v12
    v_mul_f32 v145, v145, v12
    v_mul_f32 v146, v146, v12
    v_mul_f32 v147, v147, v12
    v_mul_f32 v148, v148, v12
    v_mul_f32 v149, v149, v12
    v_mul_f32 v150, v150, v12
    v_mul_f32 v151, v151, v12
    v_cvt_pk_bf16_f32 v140, v144, v145
    v_cvt_pk_bf16_f32 v141, v146, v147
    v_cvt_pk_bf16_f32 v142, v148, v149
    v_cvt_pk_bf16_f32 v143, v150, v151
    buffer_store_dwordx4 v[140:143], v1, s[24:27], s41 offen offset:0 sc1
    v_accvgpr_read_b32 v156, a64
    v_accvgpr_read_b32 v157, a65
    v_accvgpr_read_b32 v158, a66
    v_accvgpr_read_b32 v159, a67
    v_accvgpr_read_b32 v160, a80
    v_accvgpr_read_b32 v161, a81
    v_accvgpr_read_b32 v162, a82
    v_accvgpr_read_b32 v163, a83
    v_mul_f32 v156, v156, v12
    v_mul_f32 v157, v157, v12
    v_mul_f32 v158, v158, v12
    v_mul_f32 v159, v159, v12
    v_mul_f32 v160, v160, v12
    v_mul_f32 v161, v161, v12
    v_mul_f32 v162, v162, v12
    v_mul_f32 v163, v163, v12
    v_cvt_pk_bf16_f32 v152, v156, v157
    v_cvt_pk_bf16_f32 v153, v158, v159
    v_cvt_pk_bf16_f32 v154, v160, v161
    v_cvt_pk_bf16_f32 v155, v162, v163
    buffer_store_dwordx4 v[152:155], v1, s[24:27], s42 offen offset:0 sc1
    v_accvgpr_read_b32 v168, a96
    v_accvgpr_read_b32 v169, a97
    v_accvgpr_read_b32 v170, a98
    v_accvgpr_read_b32 v171, a99
    v_accvgpr_read_b32 v172, a112
    v_accvgpr_read_b32 v173, a113
    v_accvgpr_read_b32 v174, a114
    v_accvgpr_read_b32 v175, a115
    v_mul_f32 v168, v168, v12
    v_mul_f32 v169, v169, v12
    v_mul_f32 v170, v170, v12
    v_mul_f32 v171, v171, v12
    v_mul_f32 v172, v172, v12
    v_mul_f32 v173, v173, v12
    v_mul_f32 v174, v174, v12
    v_mul_f32 v175, v175, v12
    v_cvt_pk_bf16_f32 v164, v168, v169
    v_cvt_pk_bf16_f32 v165, v170, v171
    v_cvt_pk_bf16_f32 v166, v172, v173
    v_cvt_pk_bf16_f32 v167, v174, v175
    buffer_store_dwordx4 v[164:167], v1, s[24:27], s43 offen offset:0 sc1
    v_accvgpr_read_b32 v132, a4
    v_accvgpr_read_b32 v133, a5
    v_accvgpr_read_b32 v134, a6
    v_accvgpr_read_b32 v135, a7
    v_accvgpr_read_b32 v136, a20
    v_accvgpr_read_b32 v137, a21
    v_accvgpr_read_b32 v138, a22
    v_accvgpr_read_b32 v139, a23
    v_mul_f32 v132, v132, v13
    v_mul_f32 v133, v133, v13
    v_mul_f32 v134, v134, v13
    v_mul_f32 v135, v135, v13
    v_mul_f32 v136, v136, v13
    v_mul_f32 v137, v137, v13
    v_mul_f32 v138, v138, v13
    v_mul_f32 v139, v139, v13
    v_cvt_pk_bf16_f32 v128, v132, v133
    v_cvt_pk_bf16_f32 v129, v134, v135
    v_cvt_pk_bf16_f32 v130, v136, v137
    v_cvt_pk_bf16_f32 v131, v138, v139
    buffer_store_dwordx4 v[128:131], v1, s[24:27], s40 offen offset:1024 sc1
    v_accvgpr_read_b32 v144, a36
    v_accvgpr_read_b32 v145, a37
    v_accvgpr_read_b32 v146, a38
    v_accvgpr_read_b32 v147, a39
    v_accvgpr_read_b32 v148, a52
    v_accvgpr_read_b32 v149, a53
    v_accvgpr_read_b32 v150, a54
    v_accvgpr_read_b32 v151, a55
    v_mul_f32 v144, v144, v13
    v_mul_f32 v145, v145, v13
    v_mul_f32 v146, v146, v13
    v_mul_f32 v147, v147, v13
    v_mul_f32 v148, v148, v13
    v_mul_f32 v149, v149, v13
    v_mul_f32 v150, v150, v13
    v_mul_f32 v151, v151, v13
    v_cvt_pk_bf16_f32 v140, v144, v145
    v_cvt_pk_bf16_f32 v141, v146, v147
    v_cvt_pk_bf16_f32 v142, v148, v149
    v_cvt_pk_bf16_f32 v143, v150, v151
    buffer_store_dwordx4 v[140:143], v1, s[24:27], s41 offen offset:1024 sc1
    v_accvgpr_read_b32 v156, a68
    v_accvgpr_read_b32 v157, a69
    v_accvgpr_read_b32 v158, a70
    v_accvgpr_read_b32 v159, a71
    v_accvgpr_read_b32 v160, a84
    v_accvgpr_read_b32 v161, a85
    v_accvgpr_read_b32 v162, a86
    v_accvgpr_read_b32 v163, a87
    v_mul_f32 v156, v156, v13
    v_mul_f32 v157, v157, v13
    v_mul_f32 v158, v158, v13
    v_mul_f32 v159, v159, v13
    v_mul_f32 v160, v160, v13
    v_mul_f32 v161, v161, v13
    v_mul_f32 v162, v162, v13
    v_mul_f32 v163, v163, v13
    v_cvt_pk_bf16_f32 v152, v156, v157
    v_cvt_pk_bf16_f32 v153, v158, v159
    v_cvt_pk_bf16_f32 v154, v160, v161
    v_cvt_pk_bf16_f32 v155, v162, v163
    buffer_store_dwordx4 v[152:155], v1, s[24:27], s42 offen offset:1024 sc1
    v_accvgpr_read_b32 v168, a100
    v_accvgpr_read_b32 v169, a101
    v_accvgpr_read_b32 v170, a102
    v_accvgpr_read_b32 v171, a103
    v_accvgpr_read_b32 v172, a116
    v_accvgpr_read_b32 v173, a117
    v_accvgpr_read_b32 v174, a118
    v_accvgpr_read_b32 v175, a119
    v_mul_f32 v168, v168, v13
    v_mul_f32 v169, v169, v13
    v_mul_f32 v170, v170, v13
    v_mul_f32 v171, v171, v13
    v_mul_f32 v172, v172, v13
    v_mul_f32 v173, v173, v13
    v_mul_f32 v174, v174, v13
    v_mul_f32 v175, v175, v13
    v_cvt_pk_bf16_f32 v164, v168, v169
    v_cvt_pk_bf16_f32 v165, v170, v171
    v_cvt_pk_bf16_f32 v166, v172, v173
    v_cvt_pk_bf16_f32 v167, v174, v175
    buffer_store_dwordx4 v[164:167], v1, s[24:27], s43 offen offset:1024 sc1
    v_accvgpr_read_b32 v132, a8
    v_accvgpr_read_b32 v133, a9
    v_accvgpr_read_b32 v134, a10
    v_accvgpr_read_b32 v135, a11
    v_accvgpr_read_b32 v136, a24
    v_accvgpr_read_b32 v137, a25
    v_accvgpr_read_b32 v138, a26
    v_accvgpr_read_b32 v139, a27
    v_mul_f32 v132, v132, v14
    v_mul_f32 v133, v133, v14
    v_mul_f32 v134, v134, v14
    v_mul_f32 v135, v135, v14
    v_mul_f32 v136, v136, v14
    v_mul_f32 v137, v137, v14
    v_mul_f32 v138, v138, v14
    v_mul_f32 v139, v139, v14
    v_cvt_pk_bf16_f32 v128, v132, v133
    v_cvt_pk_bf16_f32 v129, v134, v135
    v_cvt_pk_bf16_f32 v130, v136, v137
    v_cvt_pk_bf16_f32 v131, v138, v139
    buffer_store_dwordx4 v[128:131], v1, s[24:27], s44 offen offset:0 sc1
    v_accvgpr_read_b32 v144, a40
    v_accvgpr_read_b32 v145, a41
    v_accvgpr_read_b32 v146, a42
    v_accvgpr_read_b32 v147, a43
    v_accvgpr_read_b32 v148, a56
    v_accvgpr_read_b32 v149, a57
    v_accvgpr_read_b32 v150, a58
    v_accvgpr_read_b32 v151, a59
    v_mul_f32 v144, v144, v14
    v_mul_f32 v145, v145, v14
    v_mul_f32 v146, v146, v14
    v_mul_f32 v147, v147, v14
    v_mul_f32 v148, v148, v14
    v_mul_f32 v149, v149, v14
    v_mul_f32 v150, v150, v14
    v_mul_f32 v151, v151, v14
    v_cvt_pk_bf16_f32 v140, v144, v145
    v_cvt_pk_bf16_f32 v141, v146, v147
    v_cvt_pk_bf16_f32 v142, v148, v149
    v_cvt_pk_bf16_f32 v143, v150, v151
    buffer_store_dwordx4 v[140:143], v1, s[24:27], s45 offen offset:0 sc1
    v_accvgpr_read_b32 v156, a72
    v_accvgpr_read_b32 v157, a73
    v_accvgpr_read_b32 v158, a74
    v_accvgpr_read_b32 v159, a75
    v_accvgpr_read_b32 v160, a88
    v_accvgpr_read_b32 v161, a89
    v_accvgpr_read_b32 v162, a90
    v_accvgpr_read_b32 v163, a91
    v_mul_f32 v156, v156, v14
    v_mul_f32 v157, v157, v14
    v_mul_f32 v158, v158, v14
    v_mul_f32 v159, v159, v14
    v_mul_f32 v160, v160, v14
    v_mul_f32 v161, v161, v14
    v_mul_f32 v162, v162, v14
    v_mul_f32 v163, v163, v14
    v_cvt_pk_bf16_f32 v152, v156, v157
    v_cvt_pk_bf16_f32 v153, v158, v159
    v_cvt_pk_bf16_f32 v154, v160, v161
    v_cvt_pk_bf16_f32 v155, v162, v163
    buffer_store_dwordx4 v[152:155], v1, s[24:27], s46 offen offset:0 sc1
    v_accvgpr_read_b32 v168, a104
    v_accvgpr_read_b32 v169, a105
    v_accvgpr_read_b32 v170, a106
    v_accvgpr_read_b32 v171, a107
    v_accvgpr_read_b32 v172, a120
    v_accvgpr_read_b32 v173, a121
    v_accvgpr_read_b32 v174, a122
    v_accvgpr_read_b32 v175, a123
    v_mul_f32 v168, v168, v14
    v_mul_f32 v169, v169, v14
    v_mul_f32 v170, v170, v14
    v_mul_f32 v171, v171, v14
    v_mul_f32 v172, v172, v14
    v_mul_f32 v173, v173, v14
    v_mul_f32 v174, v174, v14
    v_mul_f32 v175, v175, v14
    v_cvt_pk_bf16_f32 v164, v168, v169
    v_cvt_pk_bf16_f32 v165, v170, v171
    v_cvt_pk_bf16_f32 v166, v172, v173
    v_cvt_pk_bf16_f32 v167, v174, v175
    buffer_store_dwordx4 v[164:167], v1, s[24:27], s47 offen offset:0 sc1
    v_accvgpr_read_b32 v132, a12
    v_accvgpr_read_b32 v133, a13
    v_accvgpr_read_b32 v134, a14
    v_accvgpr_read_b32 v135, a15
    v_accvgpr_read_b32 v136, a28
    v_accvgpr_read_b32 v137, a29
    v_accvgpr_read_b32 v138, a30
    v_accvgpr_read_b32 v139, a31
    v_mul_f32 v132, v132, v15
    v_mul_f32 v133, v133, v15
    v_mul_f32 v134, v134, v15
    v_mul_f32 v135, v135, v15
    v_mul_f32 v136, v136, v15
    v_mul_f32 v137, v137, v15
    v_mul_f32 v138, v138, v15
    v_mul_f32 v139, v139, v15
    v_cvt_pk_bf16_f32 v128, v132, v133
    v_cvt_pk_bf16_f32 v129, v134, v135
    v_cvt_pk_bf16_f32 v130, v136, v137
    v_cvt_pk_bf16_f32 v131, v138, v139
    buffer_store_dwordx4 v[128:131], v1, s[24:27], s44 offen offset:1024 sc1
    v_accvgpr_read_b32 v144, a44
    v_accvgpr_read_b32 v145, a45
    v_accvgpr_read_b32 v146, a46
    v_accvgpr_read_b32 v147, a47
    v_accvgpr_read_b32 v148, a60
    v_accvgpr_read_b32 v149, a61
    v_accvgpr_read_b32 v150, a62
    v_accvgpr_read_b32 v151, a63
    v_mul_f32 v144, v144, v15
    v_mul_f32 v145, v145, v15
    v_mul_f32 v146, v146, v15
    v_mul_f32 v147, v147, v15
    v_mul_f32 v148, v148, v15
    v_mul_f32 v149, v149, v15
    v_mul_f32 v150, v150, v15
    v_mul_f32 v151, v151, v15
    v_cvt_pk_bf16_f32 v140, v144, v145
    v_cvt_pk_bf16_f32 v141, v146, v147
    v_cvt_pk_bf16_f32 v142, v148, v149
    v_cvt_pk_bf16_f32 v143, v150, v151
    buffer_store_dwordx4 v[140:143], v1, s[24:27], s45 offen offset:1024 sc1
    v_accvgpr_read_b32 v156, a76
    v_accvgpr_read_b32 v157, a77
    v_accvgpr_read_b32 v158, a78
    v_accvgpr_read_b32 v159, a79
    v_accvgpr_read_b32 v160, a92
    v_accvgpr_read_b32 v161, a93
    v_accvgpr_read_b32 v162, a94
    v_accvgpr_read_b32 v163, a95
    v_mul_f32 v156, v156, v15
    v_mul_f32 v157, v157, v15
    v_mul_f32 v158, v158, v15
    v_mul_f32 v159, v159, v15
    v_mul_f32 v160, v160, v15
    v_mul_f32 v161, v161, v15
    v_mul_f32 v162, v162, v15
    v_mul_f32 v163, v163, v15
    v_cvt_pk_bf16_f32 v152, v156, v157
    v_cvt_pk_bf16_f32 v153, v158, v159
    v_cvt_pk_bf16_f32 v154, v160, v161
    v_cvt_pk_bf16_f32 v155, v162, v163
    buffer_store_dwordx4 v[152:155], v1, s[24:27], s46 offen offset:1024 sc1
    v_accvgpr_read_b32 v168, a108
    v_accvgpr_read_b32 v169, a109
    v_accvgpr_read_b32 v170, a110
    v_accvgpr_read_b32 v171, a111
    v_accvgpr_read_b32 v172, a124
    v_accvgpr_read_b32 v173, a125
    v_accvgpr_read_b32 v174, a126
    v_accvgpr_read_b32 v175, a127
    v_mul_f32 v168, v168, v15
    v_mul_f32 v169, v169, v15
    v_mul_f32 v170, v170, v15
    v_mul_f32 v171, v171, v15
    v_mul_f32 v172, v172, v15
    v_mul_f32 v173, v173, v15
    v_mul_f32 v174, v174, v15
    v_mul_f32 v175, v175, v15
    v_cvt_pk_bf16_f32 v164, v168, v169
    v_cvt_pk_bf16_f32 v165, v170, v171
    v_cvt_pk_bf16_f32 v166, v172, v173
    v_cvt_pk_bf16_f32 v167, v174, v175
    buffer_store_dwordx4 v[164:167], v1, s[24:27], s47 offen offset:1024 sc1
k12_end_1:
    s_endpgm
k2_prep_43:
    s_sub_u32 s40, s36, s38
    v_subrev_u32 v6, s40, v4
    v_cmp_gt_i32 s[44:45], -16, v6
    v_cmp_gt_i32 s[46:47], -15, v6
    v_cmp_gt_i32 s[48:49], -14, v6
    v_cmp_gt_i32 s[50:51], -13, v6
    s_nop 1
    v_cndmask_b32 v20, v9, v5, s[44:45]
    v_cndmask_b32 v21, v9, v5, s[46:47]
    v_cndmask_b32 v22, v9, v5, s[48:49]
    v_cndmask_b32 v23, v9, v5, s[50:51]
    v_cmp_gt_i32 s[54:55], 0, v6
    v_cmp_gt_i32 s[56:57], 1, v6
    v_cmp_gt_i32 s[58:59], 2, v6
    v_cmp_gt_i32 s[60:61], 3, v6
    s_nop 1
    v_cndmask_b32 v16, v8, v5, s[54:55]
    v_cndmask_b32 v17, v8, v5, s[56:57]
    v_cndmask_b32 v18, v8, v5, s[58:59]
    v_cndmask_b32 v19, v8, v5, s[60:61]
    v_cndmask_b32 v36, v9, v5, s[54:55]
    v_cndmask_b32 v37, v9, v5, s[56:57]
    v_cndmask_b32 v38, v9, v5, s[58:59]
    v_cndmask_b32 v39, v9, v5, s[60:61]
    v_cmp_gt_i32 s[44:45], 16, v6
    v_cmp_gt_i32 s[46:47], 17, v6
    v_cmp_gt_i32 s[48:49], 18, v6
    v_cmp_gt_i32 s[50:51], 19, v6
    s_nop 1
    v_cndmask_b32 v32, v8, v5, s[44:45]
    v_cndmask_b32 v33, v8, v5, s[46:47]
    v_cndmask_b32 v34, v8, v5, s[48:49]
    v_cndmask_b32 v35, v8, v5, s[50:51]
    s_nop 1
    s_branch k2_prepret_44
k2_prep_45:
    s_sub_u32 s40, s36, s38
    v_subrev_u32 v6, s40, v4
    v_cmp_gt_i32 s[44:45], -16, v6
    v_cmp_gt_i32 s[46:47], -15, v6
    v_cmp_gt_i32 s[48:49], -14, v6
    v_cmp_gt_i32 s[50:51], -13, v6
    s_nop 1
    v_cndmask_b32 v20, v9, v5, s[44:45]
    v_cndmask_b32 v21, v9, v5, s[46:47]
    v_cndmask_b32 v22, v9, v5, s[48:49]
    v_cndmask_b32 v23, v9, v5, s[50:51]
    v_cmp_gt_i32 s[54:55], 0, v6
    v_cmp_gt_i32 s[56:57], 1, v6
    v_cmp_gt_i32 s[58:59], 2, v6
    v_cmp_gt_i32 s[60:61], 3, v6
    s_nop 1
    v_cndmask_b32 v16, v8, v5, s[54:55]
    v_cndmask_b32 v17, v8, v5, s[56:57]
    v_cndmask_b32 v18, v8, v5, s[58:59]
    v_cndmask_b32 v19, v8, v5, s[60:61]
    v_cndmask_b32 v36, v9, v5, s[54:55]
    v_cndmask_b32 v37, v9, v5, s[56:57]
    v_cndmask_b32 v38, v9, v5, s[58:59]
    v_cndmask_b32 v39, v9, v5, s[60:61]
    v_cmp_gt_i32 s[44:45], 16, v6
    v_cmp_gt_i32 s[46:47], 17, v6
    v_cmp_gt_i32 s[48:49], 18, v6
    v_cmp_gt_i32 s[50:51], 19, v6
    s_nop 1
    v_cndmask_b32 v32, v8, v5, s[44:45]
    v_cndmask_b32 v33, v8, v5, s[46:47]
    v_cndmask_b32 v34, v8, v5, s[48:49]
    v_cndmask_b32 v35, v8, v5, s[50:51]
    s_nop 1
    s_branch k2_prepret_46
k2_prep_50:
    s_sub_u32 s40, s36, s38
    v_subrev_u32 v6, s40, v4
    v_cmp_gt_i32 s[44:45], -16, v6
    v_cmp_gt_i32 s[46:47], -15, v6
    v_cmp_gt_i32 s[48:49], -14, v6
    v_cmp_gt_i32 s[50:51], -13, v6
    s_nop 1
    v_cndmask_b32 v20, v9, v5, s[44:45]
    v_cndmask_b32 v21, v9, v5, s[46:47]
    v_cndmask_b32 v22, v9, v5, s[48:49]
    v_cndmask_b32 v23, v9, v5, s[50:51]
    v_cmp_gt_i32 s[54:55], 0, v6
    v_cmp_gt_i32 s[56:57], 1, v6
    v_cmp_gt_i32 s[58:59], 2, v6
    v_cmp_gt_i32 s[60:61], 3, v6
    s_nop 1
    v_cndmask_b32 v16, v8, v5, s[54:55]
    v_cndmask_b32 v17, v8, v5, s[56:57]
    v_cndmask_b32 v18, v8, v5, s[58:59]
    v_cndmask_b32 v19, v8, v5, s[60:61]
    v_cndmask_b32 v36, v9, v5, s[54:55]
    v_cndmask_b32 v37, v9, v5, s[56:57]
    v_cndmask_b32 v38, v9, v5, s[58:59]
    v_cndmask_b32 v39, v9, v5, s[60:61]
    v_cmp_gt_i32 s[44:45], 16, v6
    v_cmp_gt_i32 s[46:47], 17, v6
    v_cmp_gt_i32 s[48:49], 18, v6
    v_cmp_gt_i32 s[50:51], 19, v6
    s_nop 1
    v_cndmask_b32 v32, v8, v5, s[44:45]
    v_cndmask_b32 v33, v8, v5, s[46:47]
    v_cndmask_b32 v34, v8, v5, s[48:49]
    v_cndmask_b32 v35, v8, v5, s[50:51]
    s_nop 1
    s_branch k2_prepret_51
k2_prep_54:
    s_sub_u32 s40, s36, s38
    v_subrev_u32 v6, s40, v4
    v_cmp_gt_i32 s[44:45], -16, v6
    v_cmp_gt_i32 s[46:47], -15, v6
    v_cmp_gt_i32 s[48:49], -14, v6
    v_cmp_gt_i32 s[50:51], -13, v6
    s_nop 1
    v_cndmask_b32 v20, v9, v5, s[44:45]
    v_cndmask_b32 v21, v9, v5, s[46:47]
    v_cndmask_b32 v22, v9, v5, s[48:49]
    v_cndmask_b32 v23, v9, v5, s[50:51]
    v_cmp_gt_i32 s[54:55], 0, v6
    v_cmp_gt_i32 s[56:57], 1, v6
    v_cmp_gt_i32 s[58:59], 2, v6
    v_cmp_gt_i32 s[60:61], 3, v6
    s_nop 1
    v_cndmask_b32 v16, v8, v5, s[54:55]
    v_cndmask_b32 v17, v8, v5, s[56:57]
    v_cndmask_b32 v18, v8, v5, s[58:59]
    v_cndmask_b32 v19, v8, v5, s[60:61]
    v_cndmask_b32 v36, v9, v5, s[54:55]
    v_cndmask_b32 v37, v9, v5, s[56:57]
    v_cndmask_b32 v38, v9, v5, s[58:59]
    v_cndmask_b32 v39, v9, v5, s[60:61]
    v_cmp_gt_i32 s[44:45], 16, v6
    v_cmp_gt_i32 s[46:47], 17, v6
    v_cmp_gt_i32 s[48:49], 18, v6
    v_cmp_gt_i32 s[50:51], 19, v6
    s_nop 1
    v_cndmask_b32 v32, v8, v5, s[44:45]
    v_cndmask_b32 v33, v8, v5, s[46:47]
    v_cndmask_b32 v34, v8, v5, s[48:49]
    v_cndmask_b32 v35, v8, v5, s[50:51]
    s_nop 1
    s_branch k2_prepret_55
k2_prep_58:
    s_sub_u32 s40, s36, s39
    v_subrev_u32 v6, s40, v4
    v_cmp_gt_i32 s[44:45], -16, v6
    v_cmp_gt_i32 s[46:47], -15, v6
    v_cmp_gt_i32 s[48:49], -14, v6
    v_cmp_gt_i32 s[50:51], -13, v6
    s_nop 1
    v_cndmask_b32 v20, v11, v5, s[44:45]
    v_cndmask_b32 v21, v11, v5, s[46:47]
    v_cndmask_b32 v22, v11, v5, s[48:49]
    v_cndmask_b32 v23, v11, v5, s[50:51]
    v_cmp_gt_i32 s[54:55], 0, v6
    v_cmp_gt_i32 s[56:57], 1, v6
    v_cmp_gt_i32 s[58:59], 2, v6
    v_cmp_gt_i32 s[60:61], 3, v6
    s_nop 1
    v_cndmask_b32 v16, v10, v5, s[54:55]
    v_cndmask_b32 v17, v10, v5, s[56:57]
    v_cndmask_b32 v18, v10, v5, s[58:59]
    v_cndmask_b32 v19, v10, v5, s[60:61]
    v_cndmask_b32 v36, v11, v5, s[54:55]
    v_cndmask_b32 v37, v11, v5, s[56:57]
    v_cndmask_b32 v38, v11, v5, s[58:59]
    v_cndmask_b32 v39, v11, v5, s[60:61]
    v_cmp_gt_i32 s[44:45], 16, v6
    v_cmp_gt_i32 s[46:47], 17, v6
    v_cmp_gt_i32 s[48:49], 18, v6
    v_cmp_gt_i32 s[50:51], 19, v6
    s_nop 1
    v_cndmask_b32 v32, v10, v5, s[44:45]
    v_cndmask_b32 v33, v10, v5, s[46:47]
    v_cndmask_b32 v34, v10, v5, s[48:49]
    v_cndmask_b32 v35, v10, v5, s[50:51]
    v_cndmask_b32 v28, v11, v5, s[44:45]
    v_cndmask_b32 v29, v11, v5, s[46:47]
    v_cndmask_b32 v30, v11, v5, s[48:49]
    v_cndmask_b32 v31, v11, v5, s[50:51]
    v_cmp_gt_i32 s[54:55], 32, v6
    v_cmp_gt_i32 s[56:57], 33, v6
    v_cmp_gt_i32 s[58:59], 34, v6
    v_cmp_gt_i32 s[60:61], 35, v6
    s_nop 1
    v_cndmask_b32 v24, v10, v5, s[54:55]
    v_cndmask_b32 v25, v10, v5, s[56:57]
    v_cndmask_b32 v26, v10, v5, s[58:59]
    v_cndmask_b32 v27, v10, v5, s[60:61]
    v_cndmask_b32 v44, v11, v5, s[54:55]
    v_cndmask_b32 v45, v11, v5, s[56:57]
    v_cndmask_b32 v46, v11, v5, s[58:59]
    v_cndmask_b32 v47, v11, v5, s[60:61]
    v_cmp_gt_i32 s[44:45], 48, v6
    v_cmp_gt_i32 s[46:47], 49, v6
    v_cmp_gt_i32 s[48:49], 50, v6
    v_cmp_gt_i32 s[50:51], 51, v6
    s_nop 1
    v_cndmask_b32 v40, v10, v5, s[44:45]
    v_cndmask_b32 v41, v10, v5, s[46:47]
    v_cndmask_b32 v42, v10, v5, s[48:49]
    v_cndmask_b32 v43, v10, v5, s[50:51]
    s_nop 1
    s_branch k2_prepret_59
k2_prep_62:
    s_sub_u32 s40, s36, s39
    v_subrev_u32 v6, s40, v4
    v_cmp_gt_i32 s[44:45], -16, v6
    v_cmp_gt_i32 s[46:47], -15, v6
    v_cmp_gt_i32 s[48:49], -14, v6
    v_cmp_gt_i32 s[50:51], -13, v6
    s_nop 1
    v_cndmask_b32 v20, v11, v5, s[44:45]
    v_cndmask_b32 v21, v11, v5, s[46:47]
    v_cndmask_b32 v22, v11, v5, s[48:49]
    v_cndmask_b32 v23, v11, v5, s[50:51]
    v_cmp_gt_i32 s[54:55], 0, v6
    v_cmp_gt_i32 s[56:57], 1, v6
    v_cmp_gt_i32 s[58:59], 2, v6
    v_cmp_gt_i32 s[60:61], 3, v6
    s_nop 1
    v_cndmask_b32 v16, v10, v5, s[54:55]
    v_cndmask_b32 v17, v10, v5, s[56:57]
    v_cndmask_b32 v18, v10, v5, s[58:59]
    v_cndmask_b32 v19, v10, v5, s[60:61]
    v_cndmask_b32 v36, v11, v5, s[54:55]
    v_cndmask_b32 v37, v11, v5, s[56:57]
    v_cndmask_b32 v38, v11, v5, s[58:59]
    v_cndmask_b32 v39, v11, v5, s[60:61]
    v_cmp_gt_i32 s[44:45], 16, v6
    v_cmp_gt_i32 s[46:47], 17, v6
    v_cmp_gt_i32 s[48:49], 18, v6
    v_cmp_gt_i32 s[50:51], 19, v6
    s_nop 1
    v_cndmask_b32 v32, v10, v5, s[44:45]
    v_cndmask_b32 v33, v10, v5, s[46:47]
    v_cndmask_b32 v34, v10, v5, s[48:49]
    v_cndmask_b32 v35, v10, v5, s[50:51]
    v_cndmask_b32 v28, v11, v5, s[44:45]
    v_cndmask_b32 v29, v11, v5, s[46:47]
    v_cndmask_b32 v30, v11, v5, s[48:49]
    v_cndmask_b32 v31, v11, v5, s[50:51]
    v_cmp_gt_i32 s[54:55], 32, v6
    v_cmp_gt_i32 s[56:57], 33, v6
    v_cmp_gt_i32 s[58:59], 34, v6
    v_cmp_gt_i32 s[60:61], 35, v6
    s_nop 1
    v_cndmask_b32 v24, v10, v5, s[54:55]
    v_cndmask_b32 v25, v10, v5, s[56:57]
    v_cndmask_b32 v26, v10, v5, s[58:59]
    v_cndmask_b32 v27, v10, v5, s[60:61]
    v_cndmask_b32 v44, v11, v5, s[54:55]
    v_cndmask_b32 v45, v11, v5, s[56:57]
    v_cndmask_b32 v46, v11, v5, s[58:59]
    v_cndmask_b32 v47, v11, v5, s[60:61]
    v_cmp_gt_i32 s[44:45], 48, v6
    v_cmp_gt_i32 s[46:47], 49, v6
    v_cmp_gt_i32 s[48:49], 50, v6
    v_cmp_gt_i32 s[50:51], 51, v6
    s_nop 1
    v_cndmask_b32 v40, v10, v5, s[44:45]
    v_cndmask_b32 v41, v10, v5, s[46:47]
    v_cndmask_b32 v42, v10, v5, s[48:49]
    v_cndmask_b32 v43, v10, v5, s[50:51]
    s_nop 1
    s_branch k2_prepret_63
k2_prep_68:
    s_sub_u32 s40, s36, s39
    v_subrev_u32 v6, s40, v4
    v_cmp_gt_i32 s[44:45], -16, v6
    v_cmp_gt_i32 s[46:47], -15, v6
    v_cmp_gt_i32 s[48:49], -14, v6
    v_cmp_gt_i32 s[50:51], -13, v6
    s_nop 1
    v_cndmask_b32 v20, v11, v5, s[44:45]
    v_cndmask_b32 v21, v11, v5, s[46:47]
    v_cndmask_b32 v22, v11, v5, s[48:49]
    v_cndmask_b32 v23, v11, v5, s[50:51]
    v_cmp_gt_i32 s[54:55], 0, v6
    v_cmp_gt_i32 s[56:57], 1, v6
    v_cmp_gt_i32 s[58:59], 2, v6
    v_cmp_gt_i32 s[60:61], 3, v6
    s_nop 1
    v_cndmask_b32 v16, v10, v5, s[54:55]
    v_cndmask_b32 v17, v10, v5, s[56:57]
    v_cndmask_b32 v18, v10, v5, s[58:59]
    v_cndmask_b32 v19, v10, v5, s[60:61]
    v_cndmask_b32 v36, v11, v5, s[54:55]
    v_cndmask_b32 v37, v11, v5, s[56:57]
    v_cndmask_b32 v38, v11, v5, s[58:59]
    v_cndmask_b32 v39, v11, v5, s[60:61]
    v_cmp_gt_i32 s[44:45], 16, v6
    v_cmp_gt_i32 s[46:47], 17, v6
    v_cmp_gt_i32 s[48:49], 18, v6
    v_cmp_gt_i32 s[50:51], 19, v6
    s_nop 1
    v_cndmask_b32 v32, v10, v5, s[44:45]
    v_cndmask_b32 v33, v10, v5, s[46:47]
    v_cndmask_b32 v34, v10, v5, s[48:49]
    v_cndmask_b32 v35, v10, v5, s[50:51]
    v_cndmask_b32 v28, v11, v5, s[44:45]
    v_cndmask_b32 v29, v11, v5, s[46:47]
    v_cndmask_b32 v30, v11, v5, s[48:49]
    v_cndmask_b32 v31, v11, v5, s[50:51]
    v_cmp_gt_i32 s[54:55], 32, v6
    v_cmp_gt_i32 s[56:57], 33, v6
    v_cmp_gt_i32 s[58:59], 34, v6
    v_cmp_gt_i32 s[60:61], 35, v6
    s_nop 1
    v_cndmask_b32 v24, v10, v5, s[54:55]
    v_cndmask_b32 v25, v10, v5, s[56:57]
    v_cndmask_b32 v26, v10, v5, s[58:59]
    v_cndmask_b32 v27, v10, v5, s[60:61]
    v_cndmask_b32 v44, v11, v5, s[54:55]
    v_cndmask_b32 v45, v11, v5, s[56:57]
    v_cndmask_b32 v46, v11, v5, s[58:59]
    v_cndmask_b32 v47, v11, v5, s[60:61]
    v_cmp_gt_i32 s[44:45], 48, v6
    v_cmp_gt_i32 s[46:47], 49, v6
    v_cmp_gt_i32 s[48:49], 50, v6
    v_cmp_gt_i32 s[50:51], 51, v6
    s_nop 1
    v_cndmask_b32 v40, v10, v5, s[44:45]
    v_cndmask_b32 v41, v10, v5, s[46:47]
    v_cndmask_b32 v42, v10, v5, s[48:49]
    v_cndmask_b32 v43, v10, v5, s[50:51]
    s_nop 1
    s_branch k2_prepret_69
k2_prep_72:
    s_sub_u32 s40, s36, s39
    v_subrev_u32 v6, s40, v4
    v_cmp_gt_i32 s[44:45], -16, v6
    v_cmp_gt_i32 s[46:47], -15, v6
    v_cmp_gt_i32 s[48:49], -14, v6
    v_cmp_gt_i32 s[50:51], -13, v6
    s_nop 1
    v_cndmask_b32 v20, v11, v5, s[44:45]
    v_cndmask_b32 v21, v11, v5, s[46:47]
    v_cndmask_b32 v22, v11, v5, s[48:49]
    v_cndmask_b32 v23, v11, v5, s[50:51]
    v_cmp_gt_i32 s[54:55], 0, v6
    v_cmp_gt_i32 s[56:57], 1, v6
    v_cmp_gt_i32 s[58:59], 2, v6
    v_cmp_gt_i32 s[60:61], 3, v6
    s_nop 1
    v_cndmask_b32 v16, v10, v5, s[54:55]
    v_cndmask_b32 v17, v10, v5, s[56:57]
    v_cndmask_b32 v18, v10, v5, s[58:59]
    v_cndmask_b32 v19, v10, v5, s[60:61]
    v_cndmask_b32 v36, v11, v5, s[54:55]
    v_cndmask_b32 v37, v11, v5, s[56:57]
    v_cndmask_b32 v38, v11, v5, s[58:59]
    v_cndmask_b32 v39, v11, v5, s[60:61]
    v_cmp_gt_i32 s[44:45], 16, v6
    v_cmp_gt_i32 s[46:47], 17, v6
    v_cmp_gt_i32 s[48:49], 18, v6
    v_cmp_gt_i32 s[50:51], 19, v6
    s_nop 1
    v_cndmask_b32 v32, v10, v5, s[44:45]
    v_cndmask_b32 v33, v10, v5, s[46:47]
    v_cndmask_b32 v34, v10, v5, s[48:49]
    v_cndmask_b32 v35, v10, v5, s[50:51]
    v_cndmask_b32 v28, v11, v5, s[44:45]
    v_cndmask_b32 v29, v11, v5, s[46:47]
    v_cndmask_b32 v30, v11, v5, s[48:49]
    v_cndmask_b32 v31, v11, v5, s[50:51]
    v_cmp_gt_i32 s[54:55], 32, v6
    v_cmp_gt_i32 s[56:57], 33, v6
    v_cmp_gt_i32 s[58:59], 34, v6
    v_cmp_gt_i32 s[60:61], 35, v6
    s_nop 1
    v_cndmask_b32 v24, v10, v5, s[54:55]
    v_cndmask_b32 v25, v10, v5, s[56:57]
    v_cndmask_b32 v26, v10, v5, s[58:59]
    v_cndmask_b32 v27, v10, v5, s[60:61]
    v_cndmask_b32 v44, v11, v5, s[54:55]
    v_cndmask_b32 v45, v11, v5, s[56:57]
    v_cndmask_b32 v46, v11, v5, s[58:59]
    v_cndmask_b32 v47, v11, v5, s[60:61]
    v_cmp_gt_i32 s[44:45], 48, v6
    v_cmp_gt_i32 s[46:47], 49, v6
    v_cmp_gt_i32 s[48:49], 50, v6
    v_cmp_gt_i32 s[50:51], 51, v6
    s_nop 1
    v_cndmask_b32 v40, v10, v5, s[44:45]
    v_cndmask_b32 v41, v10, v5, s[46:47]
    v_cndmask_b32 v42, v10, v5, s[48:49]
    v_cndmask_b32 v43, v10, v5, s[50:51]
    s_nop 1
    s_branch k2_prepret_73
k12_ool_9:
    buffer_load_dword v52, v8, s[24:27], 0 offen sc1
    s_branch k12_oolret_10
k12_ool_11:
    s_mov_b64 exec, 1
    buffer_atomic_add v9, v8, s[24:27], 0 offen sc1
    s_mov_b64 exec, -1
    s_branch k12_oolret_12
k12_ool_13:
    buffer_load_dword v51, v50, s[12:15], s56 offen
    s_branch k12_oolret_14
k12_ool_17:
    v_readfirstlane_b32 s31, v52
    s_cmp_ge_u32 s31, 256
    s_cbranch_scc1 spin_ok_15
    s_mov_b32 s40, 1048576
spin_16:
    s_sleep 8
    buffer_load_dword v52, v8, s[24:27], 0 offen sc1
    s_waitcnt vmcnt(0)
    v_readfirstlane_b32 s31, v52
    s_sub_u32 s40, s40, 1
    s_cselect_b32 s31, -1, s31
    s_cmp_lt_u32 s31, 256
    s_cbranch_scc1 spin_16
spin_ok_15:
    s_branch k12_oolret_18
k12_ool_19:
    s_mov_b64 exec, 1
    buffer_atomic_add v9, v8, s[24:27], 0 offen sc1
    s_mov_b64 exec, -1
    s_branch k12_oolret_20
k12_ool_23:
    buffer_load_dword v52, v8, s[24:27], 0 offen sc1
    s_branch k12_oolret_24
k12_ool_25:
    s_mov_b64 exec, 1
    buffer_atomic_add v9, v8, s[24:27], 0 offen sc1
    s_mov_b64 exec, -1
    s_branch k12_oolret_26
k12_ool_27:
    buffer_load_dword v51, v50, s[12:15], s56 offen
    s_branch k12_oolret_28
k12_ool_31:
    v_readfirstlane_b32 s31, v52
    s_cmp_ge_u32 s31, 256
    s_cbranch_scc1 spin_ok_29
    s_mov_b32 s40, 1048576
spin_30:
    s_sleep 8
    buffer_load_dword v52, v8, s[24:27], 0 offen sc1
    s_waitcnt vmcnt(0)
    v_readfirstlane_b32 s31, v52
    s_sub_u32 s40, s40, 1
    s_cselect_b32 s31, -1, s31
    s_cmp_lt_u32 s31, 256
    s_cbranch_scc1 spin_30
spin_ok_29:
    s_branch k12_oolret_32
k12_ool_33:
    s_mov_b64 exec, 1
    buffer_atomic_add v9, v8, s[24:27], 0 offen sc1
    s_mov_b64 exec, -1
    s_branch k12_oolret_34
k12_ool_35:
    s_mov_b64 exec, 1
    buffer_atomic_add v9, v8, s[24:27], s54 offen sc1
    s_mov_b64 exec, -1
    s_branch k12_oolret_36
k12_ool_37:
    buffer_load_dword v52, v8, s[24:27], s55 offen sc1
    s_branch k12_oolret_38
k12_ool_41:
    s_waitcnt vmcnt(12)
    v_readfirstlane_b32 s31, v52
    s_cmp_ge_u32 s31, 16
    s_cbranch_scc1 spin_ok_39
    s_mov_b32 s40, 1048576
spin_40:
    s_sleep 8
    buffer_load_dword v52, v8, s[24:27], s55 offen sc1
    s_waitcnt vmcnt(0)
    v_readfirstlane_b32 s31, v52
    s_sub_u32 s40, s40, 1
    s_cselect_b32 s31, -1, s31
    s_cmp_lt_u32 s31, 16
    s_cbranch_scc1 spin_40
spin_ok_39:
    s_branch k12_oolret_42
k2_rare_47:
    s_nop 7
    v_max_f32 v52, v128, v129
    v_max3_f32 v52, v52, v130, v131
    v_max3_f32 v52, v52, v144, v145
    v_max3_f32 v52, v52, v146, v147
    v_mov_b32 v6, v52
    s_nop 1
    v_permlane16_swap_b32 v52, v6
    s_nop 1
    v_max_f32 v52, v52, v6
    v_mov_b32 v6, v52
    s_nop 1
    v_permlane32_swap_b32 v52, v6
    s_nop 1
    v_max_f32 v52, v52, v6
    v_max_f32 v52, 0, v52
    v_max_f32 v53, v132, v133
    v_max3_f32 v53, v53, v134, v135
    v_max3_f32 v53, v53, v148, v149
    v_max3_f32 v53, v53, v150, v151
    v_mov_b32 v6, v53
    s_nop 1
    v_permlane16_swap_b32 v53, v6
    s_nop 1
    v_max_f32 v53, v53, v6
    v_mov_b32 v6, v53
    s_nop 1
    v_permlane32_swap_b32 v53, v6
    s_nop 1
    v_max_f32 v53, v53, v6
    v_max_f32 v53, 0, v53
    v_max_f32 v54, v136, v137
    v_max3_f32 v54, v54, v138, v139
    v_max3_f32 v54, v54, v152, v153
    v_max3_f32 v54, v54, v154, v155
    v_mov_b32 v6, v54
    s_nop 1
    v_permlane16_swap_b32 v54, v6
    s_nop 1
    v_max_f32 v54, v54, v6
    v_mov_b32 v6, v54
    s_nop 1
    v_permlane32_swap_b32 v54, v6
    s_nop 1
    v_max_f32 v54, v54, v6
    v_max_f32 v54, 0, v54
    v_max_f32 v55, v140, v141
    v_max3_f32 v55, v55, v142, v143
    v_max3_f32 v55, v55, v156, v157
    v_max3_f32 v55, v55, v158, v159
    v_mov_b32 v6, v55
    s_nop 1
    v_permlane16_swap_b32 v55, v6
    s_nop 1
    v_max_f32 v55, v55, v6
    v_mov_b32 v6, v55
    s_nop 1
    v_permlane32_swap_b32 v55, v6
    s_nop 1
    v_max_f32 v55, v55, v6
    v_max_f32 v55, 0, v55
    v_sub_f32 v128, v128, v52
    v_sub_f32 v129, v129, v52
    v_sub_f32 v130, v130, v52
    v_sub_f32 v131, v131, v52
    v_sub_f32 v132, v132, v53
    v_sub_f32 v133, v133, v53
    v_sub_f32 v134, v134, v53
    v_sub_f32 v135, v135, v53
    v_sub_f32 v136, v136, v54
    v_sub_f32 v137, v137, v54
    v_sub_f32 v138, v138, v54
    v_sub_f32 v139, v139, v54
    v_sub_f32 v140, v140, v55
    v_sub_f32 v141, v141, v55
    v_sub_f32 v142, v142, v55
    v_sub_f32 v143, v143, v55
    v_sub_f32 v144, v144, v52
    v_sub_f32 v145, v145, v52
    v_sub_f32 v146, v146, v52
    v_sub_f32 v147, v147, v52
    v_sub_f32 v148, v148, v53
    v_sub_f32 v149, v149, v53
    v_sub_f32 v150, v150, v53
    v_sub_f32 v151, v151, v53
    v_sub_f32 v152, v152, v54
    v_sub_f32 v153, v153, v54
    v_sub_f32 v154, v154, v54
    v_sub_f32 v155, v155, v54
    v_sub_f32 v156, v156, v55
    v_sub_f32 v157, v157, v55
    v_sub_f32 v158, v158, v55
    v_sub_f32 v159, v159, v55
    v_sub_f32 v160, v160, v52
    v_sub_f32 v16, v16, v52
    v_sub_f32 v161, v161, v52
    v_sub_f32 v17, v17, v52
    v_sub_f32 v162, v162, v52
    v_sub_f32 v18, v18, v52
    v_sub_f32 v163, v163, v52
    v_sub_f32 v19, v19, v52
    v_sub_f32 v164, v164, v53
    v_sub_f32 v20, v20, v53
    v_sub_f32 v165, v165, v53
    v_sub_f32 v21, v21, v53
    v_sub_f32 v166, v166, v53
    v_sub_f32 v22, v22, v53
    v_sub_f32 v167, v167, v53
    v_sub_f32 v23, v23, v53
    v_sub_f32 v168, v168, v54
    v_sub_f32 v24, v24, v54
    v_sub_f32 v169, v169, v54
    v_sub_f32 v25, v25, v54
    v_sub_f32 v170, v170, v54
    v_sub_f32 v26, v26, v54
    v_sub_f32 v171, v171, v54
    v_sub_f32 v27, v27, v54
    v_sub_f32 v172, v172, v55
    v_sub_f32 v28, v28, v55
    v_sub_f32 v173, v173, v55
    v_sub_f32 v29, v29, v55
    v_sub_f32 v174, v174, v55
    v_sub_f32 v30, v30, v55
    v_sub_f32 v175, v175, v55
    v_sub_f32 v31, v31, v55
    v_sub_f32 v176, v176, v52
    v_sub_f32 v32, v32, v52
    v_sub_f32 v177, v177, v52
    v_sub_f32 v33, v33, v52
    v_sub_f32 v178, v178, v52
    v_sub_f32 v34, v34, v52
    v_sub_f32 v179, v179, v52
    v_sub_f32 v35, v35, v52
    v_sub_f32 v180, v180, v53
    v_sub_f32 v36, v36, v53
    v_sub_f32 v181, v181, v53
    v_sub_f32 v37, v37, v53
    v_sub_f32 v182, v182, v53
    v_sub_f32 v38, v38, v53
    v_sub_f32 v183, v183, v53
    v_sub_f32 v39, v39, v53
    v_sub_f32 v184, v184, v54
    v_sub_f32 v40, v40, v54
    v_sub_f32 v185, v185, v54
    v_sub_f32 v41, v41, v54
    v_sub_f32 v186, v186, v54
    v_sub_f32 v42, v42, v54
    v_sub_f32 v187, v187, v54
    v_sub_f32 v43, v43, v54
    v_sub_f32 v188, v188, v55
    v_sub_f32 v44, v44, v55
    v_sub_f32 v189, v189, v55
    v_sub_f32 v45, v45, v55
    v_sub_f32 v190, v190, v55
    v_sub_f32 v46, v46, v55
    v_sub_f32 v191, v191, v55
    v_sub_f32 v47, v47, v55
    v_sub_f32 v8, v8, v52
    v_exp_f32 v52, -v52
    v_sub_f32 v9, v9, v53
    v_exp_f32 v53, -v53
    v_sub_f32 v10, v10, v54
    v_exp_f32 v54, -v54
    v_sub_f32 v11, v11, v55
    v_exp_f32 v55, -v55
    s_nop 0
    v_mul_f32 v12, v12, v52
    v_mul_f32 v13, v13, v53
    v_mul_f32 v14, v14, v54
    v_mul_f32 v15, v15, v55
    v_accvgpr_read_b32 v224, a0
    v_accvgpr_read_b32 v225, a1
    v_accvgpr_read_b32 v226, a2
    v_accvgpr_read_b32 v227, a3
    v_mul_f32 v224, v224, v52
    v_mul_f32 v225, v225, v52
    v_mul_f32 v226, v226, v52
    v_mul_f32 v227, v227, v52
    v_accvgpr_write_b32 a0, v224
    v_accvgpr_write_b32 a1, v225
    v_accvgpr_write_b32 a2, v226
    v_accvgpr_write_b32 a3, v227
    v_accvgpr_read_b32 v224, a4
    v_accvgpr_read_b32 v225, a5
    v_accvgpr_read_b32 v226, a6
    v_accvgpr_read_b32 v227, a7
    v_mul_f32 v224, v224, v53
    v_mul_f32 v225, v225, v53
    v_mul_f32 v226, v226, v53
    v_mul_f32 v227, v227, v53
    v_accvgpr_write_b32 a4, v224
    v_accvgpr_write_b32 a5, v225
    v_accvgpr_write_b32 a6, v226
    v_accvgpr_write_b32 a7, v227
    v_accvgpr_read_b32 v224, a8
    v_accvgpr_read_b32 v225, a9
    v_accvgpr_read_b32 v226, a10
    v_accvgpr_read_b32 v227, a11
    v_mul_f32 v224, v224, v54
    v_mul_f32 v225, v225, v54
    v_mul_f32 v226, v226, v54
    v_mul_f32 v227, v227, v54
    v_accvgpr_write_b32 a8, v224
    v_accvgpr_write_b32 a9, v225
    v_accvgpr_write_b32 a10, v226
    v_accvgpr_write_b32 a11, v227
    v_accvgpr_read_b32 v224, a12
    v_accvgpr_read_b32 v225, a13
    v_accvgpr_read_b32 v226, a14
    v_accvgpr_read_b32 v227, a15
    v_mul_f32 v224, v224, v55
    v_mul_f32 v225, v225, v55
    v_mul_f32 v226, v226, v55
    v_mul_f32 v227, v227, v55
    v_accvgpr_write_b32 a12, v224
    v_accvgpr_write_b32 a13, v225
    v_accvgpr_write_b32 a14, v226
    v_accvgpr_write_b32 a15, v227
    v_accvgpr_read_b32 v224, a16
    v_accvgpr_read_b32 v225, a17
    v_accvgpr_read_b32 v226, a18
    v_accvgpr_read_b32 v227, a19
    v_mul_f32 v224, v224, v52
    v_mul_f32 v225, v225, v52
    v_mul_f32 v226, v226, v52
    v_mul_f32 v227, v227, v52
    v_accvgpr_write_b32 a16, v224
    v_accvgpr_write_b32 a17, v225
    v_accvgpr_write_b32 a18, v226
    v_accvgpr_write_b32 a19, v227
    v_accvgpr_read_b32 v224, a20
    v_accvgpr_read_b32 v225, a21
    v_accvgpr_read_b32 v226, a22
    v_accvgpr_read_b32 v227, a23
    v_mul_f32 v224, v224, v53
    v_mul_f32 v225, v225, v53
    v_mul_f32 v226, v226, v53
    v_mul_f32 v227, v227, v53
    v_accvgpr_write_b32 a20, v224
    v_accvgpr_write_b32 a21, v225
    v_accvgpr_write_b32 a22, v226
    v_accvgpr_write_b32 a23, v227
    v_accvgpr_read_b32 v224, a24
    v_accvgpr_read_b32 v225, a25
    v_accvgpr_read_b32 v226, a26
    v_accvgpr_read_b32 v227, a27
    v_mul_f32 v224, v224, v54
    v_mul_f32 v225, v225, v54
    v_mul_f32 v226, v226, v54
    v_mul_f32 v227, v227, v54
    v_accvgpr_write_b32 a24, v224
    v_accvgpr_write_b32 a25, v225
    v_accvgpr_write_b32 a26, v226
    v_accvgpr_write_b32 a27, v227
    v_accvgpr_read_b32 v224, a28
    v_accvgpr_read_b32 v225, a29
    v_accvgpr_read_b32 v226, a30
    v_accvgpr_read_b32 v227, a31
    v_mul_f32 v224, v224, v55
    v_mul_f32 v225, v225, v55
    v_mul_f32 v226, v226, v55
    v_mul_f32 v227, v227, v55
    v_accvgpr_write_b32 a28, v224
    v_accvgpr_write_b32 a29, v225
    v_accvgpr_write_b32 a30, v226
    v_accvgpr_write_b32 a31, v227
    v_accvgpr_read_b32 v224, a32
    v_accvgpr_read_b32 v225, a33
    v_accvgpr_read_b32 v226, a34
    v_accvgpr_read_b32 v227, a35
    v_mul_f32 v224, v224, v52
    v_mul_f32 v225, v225, v52
    v_mul_f32 v226, v226, v52
    v_mul_f32 v227, v227, v52
    v_accvgpr_write_b32 a32, v224
    v_accvgpr_write_b32 a33, v225
    v_accvgpr_write_b32 a34, v226
    v_accvgpr_write_b32 a35, v227
    v_accvgpr_read_b32 v224, a36
    v_accvgpr_read_b32 v225, a37
    v_accvgpr_read_b32 v226, a38
    v_accvgpr_read_b32 v227, a39
    v_mul_f32 v224, v224, v53
    v_mul_f32 v225, v225, v53
    v_mul_f32 v226, v226, v53
    v_mul_f32 v227, v227, v53
    v_accvgpr_write_b32 a36, v224
    v_accvgpr_write_b32 a37, v225
    v_accvgpr_write_b32 a38, v226
    v_accvgpr_write_b32 a39, v227
    v_accvgpr_read_b32 v224, a40
    v_accvgpr_read_b32 v225, a41
    v_accvgpr_read_b32 v226, a42
    v_accvgpr_read_b32 v227, a43
    v_mul_f32 v224, v224, v54
    v_mul_f32 v225, v225, v54
    v_mul_f32 v226, v226, v54
    v_mul_f32 v227, v227, v54
    v_accvgpr_write_b32 a40, v224
    v_accvgpr_write_b32 a41, v225
    v_accvgpr_write_b32 a42, v226
    v_accvgpr_write_b32 a43, v227
    v_accvgpr_read_b32 v224, a44
    v_accvgpr_read_b32 v225, a45
    v_accvgpr_read_b32 v226, a46
    v_accvgpr_read_b32 v227, a47
    v_mul_f32 v224, v224, v55
    v_mul_f32 v225, v225, v55
    v_mul_f32 v226, v226, v55
    v_mul_f32 v227, v227, v55
    v_accvgpr_write_b32 a44, v224
    v_accvgpr_write_b32 a45, v225
    v_accvgpr_write_b32 a46, v226
    v_accvgpr_write_b32 a47, v227
    v_accvgpr_read_b32 v224, a48
    v_accvgpr_read_b32 v225, a49
    v_accvgpr_read_b32 v226, a50
    v_accvgpr_read_b32 v227, a51
    v_mul_f32 v224, v224, v52
    v_mul_f32 v225, v225, v52
    v_mul_f32 v226, v226, v52
    v_mul_f32 v227, v227, v52
    v_accvgpr_write_b32 a48, v224
    v_accvgpr_write_b32 a49, v225
    v_accvgpr_write_b32 a50, v226
    v_accvgpr_write_b32 a51, v227
    v_accvgpr_read_b32 v224, a52
    v_accvgpr_read_b32 v225, a53
    v_accvgpr_read_b32 v226, a54
    v_accvgpr_read_b32 v227, a55
    v_mul_f32 v224, v224, v53
    v_mul_f32 v225, v225, v53
    v_mul_f32 v226, v226, v53
    v_mul_f32 v227, v227, v53
    v_accvgpr_write_b32 a52, v224
    v_accvgpr_write_b32 a53, v225
    v_accvgpr_write_b32 a54, v226
    v_accvgpr_write_b32 a55, v227
    v_accvgpr_read_b32 v224, a56
    v_accvgpr_read_b32 v225, a57
    v_accvgpr_read_b32 v226, a58
    v_accvgpr_read_b32 v227, a59
    v_mul_f32 v224, v224, v54
    v_mul_f32 v225, v225, v54
    v_mul_f32 v226, v226, v54
    v_mul_f32 v227, v227, v54
    v_accvgpr_write_b32 a56, v224
    v_accvgpr_write_b32 a57, v225
    v_accvgpr_write_b32 a58, v226
    v_accvgpr_write_b32 a59, v227
    v_accvgpr_read_b32 v224, a60
    v_accvgpr_read_b32 v225, a61
    v_accvgpr_read_b32 v226, a62
    v_accvgpr_read_b32 v227, a63
    v_mul_f32 v224, v224, v55
    v_mul_f32 v225, v225, v55
    v_mul_f32 v226, v226, v55
    v_mul_f32 v227, v227, v55
    v_accvgpr_write_b32 a60, v224
    v_accvgpr_write_b32 a61, v225
    v_accvgpr_write_b32 a62, v226
    v_accvgpr_write_b32 a63, v227
    v_accvgpr_read_b32 v224, a64
    v_accvgpr_read_b32 v225, a65
    v_accvgpr_read_b32 v226, a66
    v_accvgpr_read_b32 v227, a67
    v_mul_f32 v224, v224, v52
    v_mul_f32 v225, v225, v52
    v_mul_f32 v226, v226, v52
    v_mul_f32 v227, v227, v52
    v_accvgpr_write_b32 a64, v224
    v_accvgpr_write_b32 a65, v225
    v_accvgpr_write_b32 a66, v226
    v_accvgpr_write_b32 a67, v227
    v_accvgpr_read_b32 v224, a68
    v_accvgpr_read_b32 v225, a69
    v_accvgpr_read_b32 v226, a70
    v_accvgpr_read_b32 v227, a71
    v_mul_f32 v224, v224, v53
    v_mul_f32 v225, v225, v53
    v_mul_f32 v226, v226, v53
    v_mul_f32 v227, v227, v53
    v_accvgpr_write_b32 a68, v224
    v_accvgpr_write_b32 a69, v225
    v_accvgpr_write_b32 a70, v226
    v_accvgpr_write_b32 a71, v227
    v_accvgpr_read_b32 v224, a72
    v_accvgpr_read_b32 v225, a73
    v_accvgpr_read_b32 v226, a74
    v_accvgpr_read_b32 v227, a75
    v_mul_f32 v224, v224, v54
    v_mul_f32 v225, v225, v54
    v_mul_f32 v226, v226, v54
    v_mul_f32 v227, v227, v54
    v_accvgpr_write_b32 a72, v224
    v_accvgpr_write_b32 a73, v225
    v_accvgpr_write_b32 a74, v226
    v_accvgpr_write_b32 a75, v227
    v_accvgpr_read_b32 v224, a76
    v_accvgpr_read_b32 v225, a77
    v_accvgpr_read_b32 v226, a78
    v_accvgpr_read_b32 v227, a79
    v_mul_f32 v224, v224, v55
    v_mul_f32 v225, v225, v55
    v_mul_f32 v226, v226, v55
    v_mul_f32 v227, v227, v55
    v_accvgpr_write_b32 a76, v224
    v_accvgpr_write_b32 a77, v225
    v_accvgpr_write_b32 a78, v226
    v_accvgpr_write_b32 a79, v227
    v_accvgpr_read_b32 v224, a80
    v_accvgpr_read_b32 v225, a81
    v_accvgpr_read_b32 v226, a82
    v_accvgpr_read_b32 v227, a83
    v_mul_f32 v224, v224, v52
    v_mul_f32 v225, v225, v52
    v_mul_f32 v226, v226, v52
    v_mul_f32 v227, v227, v52
    v_accvgpr_write_b32 a80, v224
    v_accvgpr_write_b32 a81, v225
    v_accvgpr_write_b32 a82, v226
    v_accvgpr_write_b32 a83, v227
    v_accvgpr_read_b32 v224, a84
    v_accvgpr_read_b32 v225, a85
    v_accvgpr_read_b32 v226, a86
    v_accvgpr_read_b32 v227, a87
    v_mul_f32 v224, v224, v53
    v_mul_f32 v225, v225, v53
    v_mul_f32 v226, v226, v53
    v_mul_f32 v227, v227, v53
    v_accvgpr_write_b32 a84, v224
    v_accvgpr_write_b32 a85, v225
    v_accvgpr_write_b32 a86, v226
    v_accvgpr_write_b32 a87, v227
    v_accvgpr_read_b32 v224, a88
    v_accvgpr_read_b32 v225, a89
    v_accvgpr_read_b32 v226, a90
    v_accvgpr_read_b32 v227, a91
    v_mul_f32 v224, v224, v54
    v_mul_f32 v225, v225, v54
    v_mul_f32 v226, v226, v54
    v_mul_f32 v227, v227, v54
    v_accvgpr_write_b32 a88, v224
    v_accvgpr_write_b32 a89, v225
    v_accvgpr_write_b32 a90, v226
    v_accvgpr_write_b32 a91, v227
    v_accvgpr_read_b32 v224, a92
    v_accvgpr_read_b32 v225, a93
    v_accvgpr_read_b32 v226, a94
    v_accvgpr_read_b32 v227, a95
    v_mul_f32 v224, v224, v55
    v_mul_f32 v225, v225, v55
    v_mul_f32 v226, v226, v55
    v_mul_f32 v227, v227, v55
    v_accvgpr_write_b32 a92, v224
    v_accvgpr_write_b32 a93, v225
    v_accvgpr_write_b32 a94, v226
    v_accvgpr_write_b32 a95, v227
    v_accvgpr_read_b32 v224, a96
    v_accvgpr_read_b32 v225, a97
    v_accvgpr_read_b32 v226, a98
    v_accvgpr_read_b32 v227, a99
    v_mul_f32 v224, v224, v52
    v_mul_f32 v225, v225, v52
    v_mul_f32 v226, v226, v52
    v_mul_f32 v227, v227, v52
    v_accvgpr_write_b32 a96, v224
    v_accvgpr_write_b32 a97, v225
    v_accvgpr_write_b32 a98, v226
    v_accvgpr_write_b32 a99, v227
    v_accvgpr_read_b32 v224, a100
    v_accvgpr_read_b32 v225, a101
    v_accvgpr_read_b32 v226, a102
    v_accvgpr_read_b32 v227, a103
    v_mul_f32 v224, v224, v53
    v_mul_f32 v225, v225, v53
    v_mul_f32 v226, v226, v53
    v_mul_f32 v227, v227, v53
    v_accvgpr_write_b32 a100, v224
    v_accvgpr_write_b32 a101, v225
    v_accvgpr_write_b32 a102, v226
    v_accvgpr_write_b32 a103, v227
    v_accvgpr_read_b32 v224, a104
    v_accvgpr_read_b32 v225, a105
    v_accvgpr_read_b32 v226, a106
    v_accvgpr_read_b32 v227, a107
    v_mul_f32 v224, v224, v54
    v_mul_f32 v225, v225, v54
    v_mul_f32 v226, v226, v54
    v_mul_f32 v227, v227, v54
    v_accvgpr_write_b32 a104, v224
    v_accvgpr_write_b32 a105, v225
    v_accvgpr_write_b32 a106, v226
    v_accvgpr_write_b32 a107, v227
    v_accvgpr_read_b32 v224, a108
    v_accvgpr_read_b32 v225, a109
    v_accvgpr_read_b32 v226, a110
    v_accvgpr_read_b32 v227, a111
    v_mul_f32 v224, v224, v55
    v_mul_f32 v225, v225, v55
    v_mul_f32 v226, v226, v55
    v_mul_f32 v227, v227, v55
    v_accvgpr_write_b32 a108, v224
    v_accvgpr_write_b32 a109, v225
    v_accvgpr_write_b32 a110, v226
    v_accvgpr_write_b32 a111, v227
    v_accvgpr_read_b32 v224, a112
    v_accvgpr_read_b32 v225, a113
    v_accvgpr_read_b32 v226, a114
    v_accvgpr_read_b32 v227, a115
    v_mul_f32 v224, v224, v52
    v_mul_f32 v225, v225, v52
    v_mul_f32 v226, v226, v52
    v_mul_f32 v227, v227, v52
    v_accvgpr_write_b32 a112, v224
    v_accvgpr_write_b32 a113, v225
    v_accvgpr_write_b32 a114, v226
    v_accvgpr_write_b32 a115, v227
    v_accvgpr_read_b32 v224, a116
    v_accvgpr_read_b32 v225, a117
    v_accvgpr_read_b32 v226, a118
    v_accvgpr_read_b32 v227, a119
    v_mul_f32 v224, v224, v53
    v_mul_f32 v225, v225, v53
    v_mul_f32 v226, v226, v53
    v_mul_f32 v227, v227, v53
    v_accvgpr_write_b32 a116, v224
    v_accvgpr_write_b32 a117, v225
    v_accvgpr_write_b32 a118, v226
    v_accvgpr_write_b32 a119, v227
    v_accvgpr_read_b32 v224, a120
    v_accvgpr_read_b32 v225, a121
    v_accvgpr_read_b32 v226, a122
    v_accvgpr_read_b32 v227, a123
    v_mul_f32 v224, v224, v54
    v_mul_f32 v225, v225, v54
    v_mul_f32 v226, v226, v54
    v_mul_f32 v227, v227, v54
    v_accvgpr_write_b32 a120, v224
    v_accvgpr_write_b32 a121, v225
    v_accvgpr_write_b32 a122, v226
    v_accvgpr_write_b32 a123, v227
    v_accvgpr_read_b32 v224, a124
    v_accvgpr_read_b32 v225, a125
    v_accvgpr_read_b32 v226, a126
    v_accvgpr_read_b32 v227, a127
    v_mul_f32 v224, v224, v55
    v_mul_f32 v225, v225, v55
    v_mul_f32 v226, v226, v55
    v_mul_f32 v227, v227, v55
    v_accvgpr_write_b32 a124, v224
    v_accvgpr_write_b32 a125, v225
    v_accvgpr_write_b32 a126, v226
    v_accvgpr_write_b32 a127, v227
    v_exp_f32 v232, v128
    v_exp_f32 v233, v129
    v_exp_f32 v234, v130
    v_exp_f32 v235, v131
    v_add_f32 v48, v232, v233
    v_cvt_pk_bf16_f32 v192, v232, v233
    v_exp_f32 v236, v144
    v_exp_f32 v237, v145
    v_add_f32 v48, v48, v234
    v_add_f32 v48, v48, v235
    v_cvt_pk_bf16_f32 v193, v234, v235
    v_exp_f32 v238, v146
    v_exp_f32 v239, v147
    v_add_f32 v48, v48, v236
    v_add_f32 v48, v48, v237
    v_cvt_pk_bf16_f32 v194, v236, v237
    v_exp_f32 v240, v132
    v_exp_f32 v241, v133
    v_add_f32 v48, v48, v238
    v_add_f32 v48, v48, v239
    v_cvt_pk_bf16_f32 v195, v238, v239
    v_exp_f32 v242, v134
    v_exp_f32 v243, v135
    v_add_f32 v49, v240, v241
    v_cvt_pk_bf16_f32 v196, v240, v241
    v_exp_f32 v244, v148
    v_exp_f32 v245, v149
    v_add_f32 v49, v49, v242
    v_add_f32 v49, v49, v243
    v_cvt_pk_bf16_f32 v197, v242, v243
    v_exp_f32 v246, v150
    v_exp_f32 v247, v151
    v_add_f32 v49, v49, v244
    v_add_f32 v49, v49, v245
    v_cvt_pk_bf16_f32 v198, v244, v245
    v_exp_f32 v232, v136
    v_exp_f32 v233, v137
    v_add_f32 v49, v49, v246
    v_add_f32 v49, v49, v247
    v_cvt_pk_bf16_f32 v199, v246, v247
    v_exp_f32 v234, v138
    v_exp_f32 v235, v139
    v_add_f32 v50, v232, v233
    v_cvt_pk_bf16_f32 v200, v232, v233
    v_exp_f32 v236, v152
    v_exp_f32 v237, v153
    v_add_f32 v50, v50, v234
    v_add_f32 v50, v50, v235
    v_cvt_pk_bf16_f32 v201, v234, v235
    v_exp_f32 v238, v154
    v_exp_f32 v239, v155
    v_add_f32 v50, v50, v236
    v_add_f32 v50, v50, v237
    v_cvt_pk_bf16_f32 v202, v236, v237
    v_exp_f32 v240, v140
    v_exp_f32 v241, v141
    v_add_f32 v50, v50, v238
    v_add_f32 v50, v50, v239
    v_cvt_pk_bf16_f32 v203, v238, v239
    v_exp_f32 v242, v142
    v_exp_f32 v243, v143
    v_add_f32 v51, v240, v241
    v_cvt_pk_bf16_f32 v204, v240, v241
    v_exp_f32 v244, v156
    v_exp_f32 v245, v157
    v_add_f32 v51, v51, v242
    v_add_f32 v51, v51, v243
    v_cvt_pk_bf16_f32 v205, v242, v243
    v_exp_f32 v246, v158
    v_exp_f32 v247, v159
    v_add_f32 v51, v51, v244
    v_add_f32 v51, v51, v245
    v_cvt_pk_bf16_f32 v206, v244, v245
    s_nop 0
    v_add_f32 v51, v51, v246
    v_add_f32 v51, v51, v247
    v_cvt_pk_bf16_f32 v207, v246, v247
    s_nop 1
    s_branch k2_ret_48
k2_rare_52:
    s_nop 7
    v_max_f32 v52, v160, v161
    v_max3_f32 v52, v52, v162, v163
    v_max3_f32 v52, v52, v176, v177
    v_max3_f32 v52, v52, v178, v179
    v_mov_b32 v6, v52
    s_nop 1
    v_permlane16_swap_b32 v52, v6
    s_nop 1
    v_max_f32 v52, v52, v6
    v_mov_b32 v6, v52
    s_nop 1
    v_permlane32_swap_b32 v52, v6
    s_nop 1
    v_max_f32 v52, v52, v6
    v_max_f32 v52, 0, v52
    v_max_f32 v53, v164, v165
    v_max3_f32 v53, v53, v166, v167
    v_max3_f32 v53, v53, v180, v181
    v_max3_f32 v53, v53, v182, v183
    v_mov_b32 v6, v53
    s_nop 1
    v_permlane16_swap_b32 v53, v6
    s_nop 1
    v_max_f32 v53, v53, v6
    v_mov_b32 v6, v53
    s_nop 1
    v_permlane32_swap_b32 v53, v6
    s_nop 1
    v_max_f32 v53, v53, v6
    v_max_f32 v53, 0, v53
    v_max_f32 v54, v168, v169
    v_max3_f32 v54, v54, v170, v171
    v_max3_f32 v54, v54, v184, v185
    v_max3_f32 v54, v54, v186, v187
    v_mov_b32 v6, v54
    s_nop 1
    v_permlane16_swap_b32 v54, v6
    s_nop 1
    v_max_f32 v54, v54, v6
    v_mov_b32 v6, v54
    s_nop 1
    v_permlane32_swap_b32 v54, v6
    s_nop 1
    v_max_f32 v54, v54, v6
    v_max_f32 v54, 0, v54
    v_max_f32 v55, v172, v173
    v_max3_f32 v55, v55, v174, v175
    v_max3_f32 v55, v55, v188, v189
    v_max3_f32 v55, v55, v190, v191
    v_mov_b32 v6, v55
    s_nop 1
    v_permlane16_swap_b32 v55, v6
    s_nop 1
    v_max_f32 v55, v55, v6
    v_mov_b32 v6, v55
    s_nop 1
    v_permlane32_swap_b32 v55, v6
    s_nop 1
    v_max_f32 v55, v55, v6
    v_max_f32 v55, 0, v55
    v_sub_f32 v160, v160, v52
    v_sub_f32 v161, v161, v52
    v_sub_f32 v162, v162, v52
    v_sub_f32 v163, v163, v52
    v_sub_f32 v164, v164, v53
    v_sub_f32 v165, v165, v53
    v_sub_f32 v166, v166, v53
    v_sub_f32 v167, v167, v53
    v_sub_f32 v168, v168, v54
    v_sub_f32 v169, v169, v54
    v_sub_f32 v170, v170, v54
    v_sub_f32 v171, v171, v54
    v_sub_f32 v172, v172, v55
    v_sub_f32 v173, v173, v55
    v_sub_f32 v174, v174, v55
    v_sub_f32 v175, v175, v55
    v_sub_f32 v176, v176, v52
    v_sub_f32 v177, v177, v52
    v_sub_f32 v178, v178, v52
    v_sub_f32 v179, v179, v52
    v_sub_f32 v180, v180, v53
    v_sub_f32 v181, v181, v53
    v_sub_f32 v182, v182, v53
    v_sub_f32 v183, v183, v53
    v_sub_f32 v184, v184, v54
    v_sub_f32 v185, v185, v54
    v_sub_f32 v186, v186, v54
    v_sub_f32 v187, v187, v54
    v_sub_f32 v188, v188, v55
    v_sub_f32 v189, v189, v55
    v_sub_f32 v190, v190, v55
    v_sub_f32 v191, v191, v55
    v_sub_f32 v128, v128, v52
    v_sub_f32 v16, v16, v52
    v_sub_f32 v129, v129, v52
    v_sub_f32 v17, v17, v52
    v_sub_f32 v130, v130, v52
    v_sub_f32 v18, v18, v52
    v_sub_f32 v131, v131, v52
    v_sub_f32 v19, v19, v52
    v_sub_f32 v132, v132, v53
    v_sub_f32 v20, v20, v53
    v_sub_f32 v133, v133, v53
    v_sub_f32 v21, v21, v53
    v_sub_f32 v134, v134, v53
    v_sub_f32 v22, v22, v53
    v_sub_f32 v135, v135, v53
    v_sub_f32 v23, v23, v53
    v_sub_f32 v136, v136, v54
    v_sub_f32 v24, v24, v54
    v_sub_f32 v137, v137, v54
    v_sub_f32 v25, v25, v54
    v_sub_f32 v138, v138, v54
    v_sub_f32 v26, v26, v54
    v_sub_f32 v139, v139, v54
    v_sub_f32 v27, v27, v54
    v_sub_f32 v140, v140, v55
    v_sub_f32 v28, v28, v55
    v_sub_f32 v141, v141, v55
    v_sub_f32 v29, v29, v55
    v_sub_f32 v142, v142, v55
    v_sub_f32 v30, v30, v55
    v_sub_f32 v143, v143, v55
    v_sub_f32 v31, v31, v55
    v_sub_f32 v144, v144, v52
    v_sub_f32 v32, v32, v52
    v_sub_f32 v145, v145, v52
    v_sub_f32 v33, v33, v52
    v_sub_f32 v146, v146, v52
    v_sub_f32 v34, v34, v52
    v_sub_f32 v147, v147, v52
    v_sub_f32 v35, v35, v52
    v_sub_f32 v148, v148, v53
    v_sub_f32 v36, v36, v53
    v_sub_f32 v149, v149, v53
    v_sub_f32 v37, v37, v53
    v_sub_f32 v150, v150, v53
    v_sub_f32 v38, v38, v53
    v_sub_f32 v151, v151, v53
    v_sub_f32 v39, v39, v53
    v_sub_f32 v152, v152, v54
    v_sub_f32 v40, v40, v54
    v_sub_f32 v153, v153, v54
    v_sub_f32 v41, v41, v54
    v_sub_f32 v154, v154, v54
    v_sub_f32 v42, v42, v54
    v_sub_f32 v155, v155, v54
    v_sub_f32 v43, v43, v54
    v_sub_f32 v156, v156, v55
    v_sub_f32 v44, v44, v55
    v_sub_f32 v157, v157, v55
    v_sub_f32 v45, v45, v55
    v_sub_f32 v158, v158, v55
    v_sub_f32 v46, v46, v55
    v_sub_f32 v159, v159, v55
    v_sub_f32 v47, v47, v55
    v_sub_f32 v8, v8, v52
    v_exp_f32 v52, -v52
    v_sub_f32 v9, v9, v53
    v_exp_f32 v53, -v53
    v_sub_f32 v10, v10, v54
    v_exp_f32 v54, -v54
    v_sub_f32 v11, v11, v55
    v_exp_f32 v55, -v55
    s_nop 0
    v_mul_f32 v12, v12, v52
    v_mul_f32 v13, v13, v53
    v_mul_f32 v14, v14, v54
    v_mul_f32 v15, v15, v55
    v_accvgpr_read_b32 v224, a0
    v_accvgpr_read_b32 v225, a1
    v_accvgpr_read_b32 v226, a2
    v_accvgpr_read_b32 v227, a3
    v_mul_f32 v224, v224, v52
    v_mul_f32 v225, v225, v52
    v_mul_f32 v226, v226, v52
    v_mul_f32 v227, v227, v52
    v_accvgpr_write_b32 a0, v224
    v_accvgpr_write_b32 a1, v225
    v_accvgpr_write_b32 a2, v226
    v_accvgpr_write_b32 a3, v227
    v_accvgpr_read_b32 v224, a4
    v_accvgpr_read_b32 v225, a5
    v_accvgpr_read_b32 v226, a6
    v_accvgpr_read_b32 v227, a7
    v_mul_f32 v224, v224, v53
    v_mul_f32 v225, v225, v53
    v_mul_f32 v226, v226, v53
    v_mul_f32 v227, v227, v53
    v_accvgpr_write_b32 a4, v224
    v_accvgpr_write_b32 a5, v225
    v_accvgpr_write_b32 a6, v226
    v_accvgpr_write_b32 a7, v227
    v_accvgpr_read_b32 v224, a8
    v_accvgpr_read_b32 v225, a9
    v_accvgpr_read_b32 v226, a10
    v_accvgpr_read_b32 v227, a11
    v_mul_f32 v224, v224, v54
    v_mul_f32 v225, v225, v54
    v_mul_f32 v226, v226, v54
    v_mul_f32 v227, v227, v54
    v_accvgpr_write_b32 a8, v224
    v_accvgpr_write_b32 a9, v225
    v_accvgpr_write_b32 a10, v226
    v_accvgpr_write_b32 a11, v227
    v_accvgpr_read_b32 v224, a12
    v_accvgpr_read_b32 v225, a13
    v_accvgpr_read_b32 v226, a14
    v_accvgpr_read_b32 v227, a15
    v_mul_f32 v224, v224, v55
    v_mul_f32 v225, v225, v55
    v_mul_f32 v226, v226, v55
    v_mul_f32 v227, v227, v55
    v_accvgpr_write_b32 a12, v224
    v_accvgpr_write_b32 a13, v225
    v_accvgpr_write_b32 a14, v226
    v_accvgpr_write_b32 a15, v227
    v_accvgpr_read_b32 v224, a16
    v_accvgpr_read_b32 v225, a17
    v_accvgpr_read_b32 v226, a18
    v_accvgpr_read_b32 v227, a19
    v_mul_f32 v224, v224, v52
    v_mul_f32 v225, v225, v52
    v_mul_f32 v226, v226, v52
    v_mul_f32 v227, v227, v52
    v_accvgpr_write_b32 a16, v224
    v_accvgpr_write_b32 a17, v225
    v_accvgpr_write_b32 a18, v226
    v_accvgpr_write_b32 a19, v227
    v_accvgpr_read_b32 v224, a20
    v_accvgpr_read_b32 v225, a21
    v_accvgpr_read_b32 v226, a22
    v_accvgpr_read_b32 v227, a23
    v_mul_f32 v224, v224, v53
    v_mul_f32 v225, v225, v53
    v_mul_f32 v226, v226, v53
    v_mul_f32 v227, v227, v53
    v_accvgpr_write_b32 a20, v224
    v_accvgpr_write_b32 a21, v225
    v_accvgpr_write_b32 a22, v226
    v_accvgpr_write_b32 a23, v227
    v_accvgpr_read_b32 v224, a24
    v_accvgpr_read_b32 v225, a25
    v_accvgpr_read_b32 v226, a26
    v_accvgpr_read_b32 v227, a27
    v_mul_f32 v224, v224, v54
    v_mul_f32 v225, v225, v54
    v_mul_f32 v226, v226, v54
    v_mul_f32 v227, v227, v54
    v_accvgpr_write_b32 a24, v224
    v_accvgpr_write_b32 a25, v225
    v_accvgpr_write_b32 a26, v226
    v_accvgpr_write_b32 a27, v227
    v_accvgpr_read_b32 v224, a28
    v_accvgpr_read_b32 v225, a29
    v_accvgpr_read_b32 v226, a30
    v_accvgpr_read_b32 v227, a31
    v_mul_f32 v224, v224, v55
    v_mul_f32 v225, v225, v55
    v_mul_f32 v226, v226, v55
    v_mul_f32 v227, v227, v55
    v_accvgpr_write_b32 a28, v224
    v_accvgpr_write_b32 a29, v225
    v_accvgpr_write_b32 a30, v226
    v_accvgpr_write_b32 a31, v227
    v_accvgpr_read_b32 v224, a32
    v_accvgpr_read_b32 v225, a33
    v_accvgpr_read_b32 v226, a34
    v_accvgpr_read_b32 v227, a35
    v_mul_f32 v224, v224, v52
    v_mul_f32 v225, v225, v52
    v_mul_f32 v226, v226, v52
    v_mul_f32 v227, v227, v52
    v_accvgpr_write_b32 a32, v224
    v_accvgpr_write_b32 a33, v225
    v_accvgpr_write_b32 a34, v226
    v_accvgpr_write_b32 a35, v227
    v_accvgpr_read_b32 v224, a36
    v_accvgpr_read_b32 v225, a37
    v_accvgpr_read_b32 v226, a38
    v_accvgpr_read_b32 v227, a39
    v_mul_f32 v224, v224, v53
    v_mul_f32 v225, v225, v53
    v_mul_f32 v226, v226, v53
    v_mul_f32 v227, v227, v53
    v_accvgpr_write_b32 a36, v224
    v_accvgpr_write_b32 a37, v225
    v_accvgpr_write_b32 a38, v226
    v_accvgpr_write_b32 a39, v227
    v_accvgpr_read_b32 v224, a40
    v_accvgpr_read_b32 v225, a41
    v_accvgpr_read_b32 v226, a42
    v_accvgpr_read_b32 v227, a43
    v_mul_f32 v224, v224, v54
    v_mul_f32 v225, v225, v54
    v_mul_f32 v226, v226, v54
    v_mul_f32 v227, v227, v54
    v_accvgpr_write_b32 a40, v224
    v_accvgpr_write_b32 a41, v225
    v_accvgpr_write_b32 a42, v226
    v_accvgpr_write_b32 a43, v227
    v_accvgpr_read_b32 v224, a44
    v_accvgpr_read_b32 v225, a45
    v_accvgpr_read_b32 v226, a46
    v_accvgpr_read_b32 v227, a47
    v_mul_f32 v224, v224, v55
    v_mul_f32 v225, v225, v55
    v_mul_f32 v226, v226, v55
    v_mul_f32 v227, v227, v55
    v_accvgpr_write_b32 a44, v224
    v_accvgpr_write_b32 a45, v225
    v_accvgpr_write_b32 a46, v226
    v_accvgpr_write_b32 a47, v227
    v_accvgpr_read_b32 v224, a48
    v_accvgpr_read_b32 v225, a49
    v_accvgpr_read_b32 v226, a50
    v_accvgpr_read_b32 v227, a51
    v_mul_f32 v224, v224, v52
    v_mul_f32 v225, v225, v52
    v_mul_f32 v226, v226, v52
    v_mul_f32 v227, v227, v52
    v_accvgpr_write_b32 a48, v224
    v_accvgpr_write_b32 a49, v225
    v_accvgpr_write_b32 a50, v226
    v_accvgpr_write_b32 a51, v227
    v_accvgpr_read_b32 v224, a52
    v_accvgpr_read_b32 v225, a53
    v_accvgpr_read_b32 v226, a54
    v_accvgpr_read_b32 v227, a55
    v_mul_f32 v224, v224, v53
    v_mul_f32 v225, v225, v53
    v_mul_f32 v226, v226, v53
    v_mul_f32 v227, v227, v53
    v_accvgpr_write_b32 a52, v224
    v_accvgpr_write_b32 a53, v225
    v_accvgpr_write_b32 a54, v226
    v_accvgpr_write_b32 a55, v227
    v_accvgpr_read_b32 v224, a56
    v_accvgpr_read_b32 v225, a57
    v_accvgpr_read_b32 v226, a58
    v_accvgpr_read_b32 v227, a59
    v_mul_f32 v224, v224, v54
    v_mul_f32 v225, v225, v54
    v_mul_f32 v226, v226, v54
    v_mul_f32 v227, v227, v54
    v_accvgpr_write_b32 a56, v224
    v_accvgpr_write_b32 a57, v225
    v_accvgpr_write_b32 a58, v226
    v_accvgpr_write_b32 a59, v227
    v_accvgpr_read_b32 v224, a60
    v_accvgpr_read_b32 v225, a61
    v_accvgpr_read_b32 v226, a62
    v_accvgpr_read_b32 v227, a63
    v_mul_f32 v224, v224, v55
    v_mul_f32 v225, v225, v55
    v_mul_f32 v226, v226, v55
    v_mul_f32 v227, v227, v55
    v_accvgpr_write_b32 a60, v224
    v_accvgpr_write_b32 a61, v225
    v_accvgpr_write_b32 a62, v226
    v_accvgpr_write_b32 a63, v227
    v_accvgpr_read_b32 v224, a64
    v_accvgpr_read_b32 v225, a65
    v_accvgpr_read_b32 v226, a66
    v_accvgpr_read_b32 v227, a67
    v_mul_f32 v224, v224, v52
    v_mul_f32 v225, v225, v52
    v_mul_f32 v226, v226, v52
    v_mul_f32 v227, v227, v52
    v_accvgpr_write_b32 a64, v224
    v_accvgpr_write_b32 a65, v225
    v_accvgpr_write_b32 a66, v226
    v_accvgpr_write_b32 a67, v227
    v_accvgpr_read_b32 v224, a68
    v_accvgpr_read_b32 v225, a69
    v_accvgpr_read_b32 v226, a70
    v_accvgpr_read_b32 v227, a71
    v_mul_f32 v224, v224, v53
    v_mul_f32 v225, v225, v53
    v_mul_f32 v226, v226, v53
    v_mul_f32 v227, v227, v53
    v_accvgpr_write_b32 a68, v224
    v_accvgpr_write_b32 a69, v225
    v_accvgpr_write_b32 a70, v226
    v_accvgpr_write_b32 a71, v227
    v_accvgpr_read_b32 v224, a72
    v_accvgpr_read_b32 v225, a73
    v_accvgpr_read_b32 v226, a74
    v_accvgpr_read_b32 v227, a75
    v_mul_f32 v224, v224, v54
    v_mul_f32 v225, v225, v54
    v_mul_f32 v226, v226, v54
    v_mul_f32 v227, v227, v54
    v_accvgpr_write_b32 a72, v224
    v_accvgpr_write_b32 a73, v225
    v_accvgpr_write_b32 a74, v226
    v_accvgpr_write_b32 a75, v227
    v_accvgpr_read_b32 v224, a76
    v_accvgpr_read_b32 v225, a77
    v_accvgpr_read_b32 v226, a78
    v_accvgpr_read_b32 v227, a79
    v_mul_f32 v224, v224, v55
    v_mul_f32 v225, v225, v55
    v_mul_f32 v226, v226, v55
    v_mul_f32 v227, v227, v55
    v_accvgpr_write_b32 a76, v224
    v_accvgpr_write_b32 a77, v225
    v_accvgpr_write_b32 a78, v226
    v_accvgpr_write_b32 a79, v227
    v_accvgpr_read_b32 v224, a80
    v_accvgpr_read_b32 v225, a81
    v_accvgpr_read_b32 v226, a82
    v_accvgpr_read_b32 v227, a83
    v_mul_f32 v224, v224, v52
    v_mul_f32 v225, v225, v52
    v_mul_f32 v226, v226, v52
    v_mul_f32 v227, v227, v52
    v_accvgpr_write_b32 a80, v224
    v_accvgpr_write_b32 a81, v225
    v_accvgpr_write_b32 a82, v226
    v_accvgpr_write_b32 a83, v227
    v_accvgpr_read_b32 v224, a84
    v_accvgpr_read_b32 v225, a85
    v_accvgpr_read_b32 v226, a86
    v_accvgpr_read_b32 v227, a87
    v_mul_f32 v224, v224, v53
    v_mul_f32 v225, v225, v53
    v_mul_f32 v226, v226, v53
    v_mul_f32 v227, v227, v53
    v_accvgpr_write_b32 a84, v224
    v_accvgpr_write_b32 a85, v225
    v_accvgpr_write_b32 a86, v226
    v_accvgpr_write_b32 a87, v227
    v_accvgpr_read_b32 v224, a88
    v_accvgpr_read_b32 v225, a89
    v_accvgpr_read_b32 v226, a90
    v_accvgpr_read_b32 v227, a91
    v_mul_f32 v224, v224, v54
    v_mul_f32 v225, v225, v54
    v_mul_f32 v226, v226, v54
    v_mul_f32 v227, v227, v54
    v_accvgpr_write_b32 a88, v224
    v_accvgpr_write_b32 a89, v225
    v_accvgpr_write_b32 a90, v226
    v_accvgpr_write_b32 a91, v227
    v_accvgpr_read_b32 v224, a92
    v_accvgpr_read_b32 v225, a93
    v_accvgpr_read_b32 v226, a94
    v_accvgpr_read_b32 v227, a95
    v_mul_f32 v224, v224, v55
    v_mul_f32 v225, v225, v55
    v_mul_f32 v226, v226, v55
    v_mul_f32 v227, v227, v55
    v_accvgpr_write_b32 a92, v224
    v_accvgpr_write_b32 a93, v225
    v_accvgpr_write_b32 a94, v226
    v_accvgpr_write_b32 a95, v227
    v_accvgpr_read_b32 v224, a96
    v_accvgpr_read_b32 v225, a97
    v_accvgpr_read_b32 v226, a98
    v_accvgpr_read_b32 v227, a99
    v_mul_f32 v224, v224, v52
    v_mul_f32 v225, v225, v52
    v_mul_f32 v226, v226, v52
    v_mul_f32 v227, v227, v52
    v_accvgpr_write_b32 a96, v224
    v_accvgpr_write_b32 a97, v225
    v_accvgpr_write_b32 a98, v226
    v_accvgpr_write_b32 a99, v227
    v_accvgpr_read_b32 v224, a100
    v_accvgpr_read_b32 v225, a101
    v_accvgpr_read_b32 v226, a102
    v_accvgpr_read_b32 v227, a103
    v_mul_f32 v224, v224, v53
    v_mul_f32 v225, v225, v53
    v_mul_f32 v226, v226, v53
    v_mul_f32 v227, v227, v53
    v_accvgpr_write_b32 a100, v224
    v_accvgpr_write_b32 a101, v225
    v_accvgpr_write_b32 a102, v226
    v_accvgpr_write_b32 a103, v227
    v_accvgpr_read_b32 v224, a104
    v_accvgpr_read_b32 v225, a105
    v_accvgpr_read_b32 v226, a106
    v_accvgpr_read_b32 v227, a107
    v_mul_f32 v224, v224, v54
    v_mul_f32 v225, v225, v54
    v_mul_f32 v226, v226, v54
    v_mul_f32 v227, v227, v54
    v_accvgpr_write_b32 a104, v224
    v_accvgpr_write_b32 a105, v225
    v_accvgpr_write_b32 a106, v226
    v_accvgpr_write_b32 a107, v227
    v_accvgpr_read_b32 v224, a108
    v_accvgpr_read_b32 v225, a109
    v_accvgpr_read_b32 v226, a110
    v_accvgpr_read_b32 v227, a111
    v_mul_f32 v224, v224, v55
    v_mul_f32 v225, v225, v55
    v_mul_f32 v226, v226, v55
    v_mul_f32 v227, v227, v55
    v_accvgpr_write_b32 a108, v224
    v_accvgpr_write_b32 a109, v225
    v_accvgpr_write_b32 a110, v226
    v_accvgpr_write_b32 a111, v227
    v_accvgpr_read_b32 v224, a112
    v_accvgpr_read_b32 v225, a113
    v_accvgpr_read_b32 v226, a114
    v_accvgpr_read_b32 v227, a115
    v_mul_f32 v224, v224, v52
    v_mul_f32 v225, v225, v52
    v_mul_f32 v226, v226, v52
    v_mul_f32 v227, v227, v52
    v_accvgpr_write_b32 a112, v224
    v_accvgpr_write_b32 a113, v225
    v_accvgpr_write_b32 a114, v226
    v_accvgpr_write_b32 a115, v227
    v_accvgpr_read_b32 v224, a116
    v_accvgpr_read_b32 v225, a117
    v_accvgpr_read_b32 v226, a118
    v_accvgpr_read_b32 v227, a119
    v_mul_f32 v224, v224, v53
    v_mul_f32 v225, v225, v53
    v_mul_f32 v226, v226, v53
    v_mul_f32 v227, v227, v53
    v_accvgpr_write_b32 a116, v224
    v_accvgpr_write_b32 a117, v225
    v_accvgpr_write_b32 a118, v226
    v_accvgpr_write_b32 a119, v227
    v_accvgpr_read_b32 v224, a120
    v_accvgpr_read_b32 v225, a121
    v_accvgpr_read_b32 v226, a122
    v_accvgpr_read_b32 v227, a123
    v_mul_f32 v224, v224, v54
    v_mul_f32 v225, v225, v54
    v_mul_f32 v226, v226, v54
    v_mul_f32 v227, v227, v54
    v_accvgpr_write_b32 a120, v224
    v_accvgpr_write_b32 a121, v225
    v_accvgpr_write_b32 a122, v226
    v_accvgpr_write_b32 a123, v227
    v_accvgpr_read_b32 v224, a124
    v_accvgpr_read_b32 v225, a125
    v_accvgpr_read_b32 v226, a126
    v_accvgpr_read_b32 v227, a127
    v_mul_f32 v224, v224, v55
    v_mul_f32 v225, v225, v55
    v_mul_f32 v226, v226, v55
    v_mul_f32 v227, v227, v55
    v_accvgpr_write_b32 a124, v224
    v_accvgpr_write_b32 a125, v225
    v_accvgpr_write_b32 a126, v226
    v_accvgpr_write_b32 a127, v227
    v_exp_f32 v232, v160
    v_exp_f32 v233, v161
    v_exp_f32 v234, v162
    v_exp_f32 v235, v163
    v_add_f32 v48, v232, v233
    v_cvt_pk_bf16_f32 v208, v232, v233
    v_exp_f32 v236, v176
    v_exp_f32 v237, v177
    v_add_f32 v48, v48, v234
    v_add_f32 v48, v48, v235
    v_cvt_pk_bf16_f32 v209, v234, v235
    v_exp_f32 v238, v178
    v_exp_f32 v239, v179
    v_add_f32 v48, v48, v236
    v_add_f32 v48, v48, v237
    v_cvt_pk_bf16_f32 v210, v236, v237
    v_exp_f32 v240, v164
    v_exp_f32 v241, v165
    v_add_f32 v48, v48, v238
    v_add_f32 v48, v48, v239
    v_cvt_pk_bf16_f32 v211, v238, v239
    v_exp_f32 v242, v166
    v_exp_f32 v243, v167
    v_add_f32 v49, v240, v241
    v_cvt_pk_bf16_f32 v212, v240, v241
    v_exp_f32 v244, v180
    v_exp_f32 v245, v181
    v_add_f32 v49, v49, v242
    v_add_f32 v49, v49, v243
    v_cvt_pk_bf16_f32 v213, v242, v243
    v_exp_f32 v246, v182
    v_exp_f32 v247, v183
    v_add_f32 v49, v49, v244
    v_add_f32 v49, v49, v245
    v_cvt_pk_bf16_f32 v214, v244, v245
    v_exp_f32 v232, v168
    v_exp_f32 v233, v169
    v_add_f32 v49, v49, v246
    v_add_f32 v49, v49, v247
    v_cvt_pk_bf16_f32 v215, v246, v247
    v_exp_f32 v234, v170
    v_exp_f32 v235, v171
    v_add_f32 v50, v232, v233
    v_cvt_pk_bf16_f32 v216, v232, v233
    v_exp_f32 v236, v184
    v_exp_f32 v237, v185
    v_add_f32 v50, v50, v234
    v_add_f32 v50, v50, v235
    v_cvt_pk_bf16_f32 v217, v234, v235
    v_exp_f32 v238, v186
    v_exp_f32 v239, v187
    v_add_f32 v50, v50, v236
    v_add_f32 v50, v50, v237
    v_cvt_pk_bf16_f32 v218, v236, v237
    v_exp_f32 v240, v172
    v_exp_f32 v241, v173
    v_add_f32 v50, v50, v238
    v_add_f32 v50, v50, v239
    v_cvt_pk_bf16_f32 v219, v238, v239
    v_exp_f32 v242, v174
    v_exp_f32 v243, v175
    v_add_f32 v51, v240, v241
    v_cvt_pk_bf16_f32 v220, v240, v241
    v_exp_f32 v244, v188
    v_exp_f32 v245, v189
    v_add_f32 v51, v51, v242
    v_add_f32 v51, v51, v243
    v_cvt_pk_bf16_f32 v221, v242, v243
    v_exp_f32 v246, v190
    v_exp_f32 v247, v191
    v_add_f32 v51, v51, v244
    v_add_f32 v51, v51, v245
    v_cvt_pk_bf16_f32 v222, v244, v245
    s_nop 0
    v_add_f32 v51, v51, v246
    v_add_f32 v51, v51, v247
    v_cvt_pk_bf16_f32 v223, v246, v247
    s_nop 1
    s_branch k2_ret_53
k2_rare_56:
    s_nop 7
    v_max_f32 v52, v128, v129
    v_max3_f32 v52, v52, v130, v131
    v_max3_f32 v52, v52, v144, v145
    v_max3_f32 v52, v52, v146, v147
    v_mov_b32 v6, v52
    s_nop 1
    v_permlane16_swap_b32 v52, v6
    s_nop 1
    v_max_f32 v52, v52, v6
    v_mov_b32 v6, v52
    s_nop 1
    v_permlane32_swap_b32 v52, v6
    s_nop 1
    v_max_f32 v52, v52, v6
    v_max_f32 v52, 0, v52
    v_max_f32 v53, v132, v133
    v_max3_f32 v53, v53, v134, v135
    v_max3_f32 v53, v53, v148, v149
    v_max3_f32 v53, v53, v150, v151
    v_mov_b32 v6, v53
    s_nop 1
    v_permlane16_swap_b32 v53, v6
    s_nop 1
    v_max_f32 v53, v53, v6
    v_mov_b32 v6, v53
    s_nop 1
    v_permlane32_swap_b32 v53, v6
    s_nop 1
    v_max_f32 v53, v53, v6
    v_max_f32 v53, 0, v53
    v_max_f32 v54, v136, v137
    v_max3_f32 v54, v54, v138, v139
    v_max3_f32 v54, v54, v152, v153
    v_max3_f32 v54, v54, v154, v155
    v_mov_b32 v6, v54
    s_nop 1
    v_permlane16_swap_b32 v54, v6
    s_nop 1
    v_max_f32 v54, v54, v6
    v_mov_b32 v6, v54
    s_nop 1
    v_permlane32_swap_b32 v54, v6
    s_nop 1
    v_max_f32 v54, v54, v6
    v_max_f32 v54, 0, v54
    v_max_f32 v55, v140, v141
    v_max3_f32 v55, v55, v142, v143
    v_max3_f32 v55, v55, v156, v157
    v_max3_f32 v55, v55, v158, v159
    v_mov_b32 v6, v55
    s_nop 1
    v_permlane16_swap_b32 v55, v6
    s_nop 1
    v_max_f32 v55, v55, v6
    v_mov_b32 v6, v55
    s_nop 1
    v_permlane32_swap_b32 v55, v6
    s_nop 1
    v_max_f32 v55, v55, v6
    v_max_f32 v55, 0, v55
    v_sub_f32 v128, v128, v52
    v_sub_f32 v129, v129, v52
    v_sub_f32 v130, v130, v52
    v_sub_f32 v131, v131, v52
    v_sub_f32 v132, v132, v53
    v_sub_f32 v133, v133, v53
    v_sub_f32 v134, v134, v53
    v_sub_f32 v135, v135, v53
    v_sub_f32 v136, v136, v54
    v_sub_f32 v137, v137, v54
    v_sub_f32 v138, v138, v54
    v_sub_f32 v139, v139, v54
    v_sub_f32 v140, v140, v55
    v_sub_f32 v141, v141, v55
    v_sub_f32 v142, v142, v55
    v_sub_f32 v143, v143, v55
    v_sub_f32 v144, v144, v52
    v_sub_f32 v145, v145, v52
    v_sub_f32 v146, v146, v52
    v_sub_f32 v147, v147, v52
    v_sub_f32 v148, v148, v53
    v_sub_f32 v149, v149, v53
    v_sub_f32 v150, v150, v53
    v_sub_f32 v151, v151, v53
    v_sub_f32 v152, v152, v54
    v_sub_f32 v153, v153, v54
    v_sub_f32 v154, v154, v54
    v_sub_f32 v155, v155, v54
    v_sub_f32 v156, v156, v55
    v_sub_f32 v157, v157, v55
    v_sub_f32 v158, v158, v55
    v_sub_f32 v159, v159, v55
    v_sub_f32 v160, v160, v52
    v_sub_f32 v16, v16, v52
    v_sub_f32 v161, v161, v52
    v_sub_f32 v17, v17, v52
    v_sub_f32 v162, v162, v52
    v_sub_f32 v18, v18, v52
    v_sub_f32 v163, v163, v52
    v_sub_f32 v19, v19, v52
    v_sub_f32 v164, v164, v53
    v_sub_f32 v20, v20, v53
    v_sub_f32 v165, v165, v53
    v_sub_f32 v21, v21, v53
    v_sub_f32 v166, v166, v53
    v_sub_f32 v22, v22, v53
    v_sub_f32 v167, v167, v53
    v_sub_f32 v23, v23, v53
    v_sub_f32 v168, v168, v54
    v_sub_f32 v24, v24, v54
    v_sub_f32 v169, v169, v54
    v_sub_f32 v25, v25, v54
    v_sub_f32 v170, v170, v54
    v_sub_f32 v26, v26, v54
    v_sub_f32 v171, v171, v54
    v_sub_f32 v27, v27, v54
    v_sub_f32 v172, v172, v55
    v_sub_f32 v28, v28, v55
    v_sub_f32 v173, v173, v55
    v_sub_f32 v29, v29, v55
    v_sub_f32 v174, v174, v55
    v_sub_f32 v30, v30, v55
    v_sub_f32 v175, v175, v55
    v_sub_f32 v31, v31, v55
    v_sub_f32 v176, v176, v52
    v_sub_f32 v32, v32, v52
    v_sub_f32 v177, v177, v52
    v_sub_f32 v33, v33, v52
    v_sub_f32 v178, v178, v52
    v_sub_f32 v34, v34, v52
    v_sub_f32 v179, v179, v52
    v_sub_f32 v35, v35, v52
    v_sub_f32 v180, v180, v53
    v_sub_f32 v36, v36, v53
    v_sub_f32 v181, v181, v53
    v_sub_f32 v37, v37, v53
    v_sub_f32 v182, v182, v53
    v_sub_f32 v38, v38, v53
    v_sub_f32 v183, v183, v53
    v_sub_f32 v39, v39, v53
    v_sub_f32 v184, v184, v54
    v_sub_f32 v40, v40, v54
    v_sub_f32 v185, v185, v54
    v_sub_f32 v41, v41, v54
    v_sub_f32 v186, v186, v54
    v_sub_f32 v42, v42, v54
    v_sub_f32 v187, v187, v54
    v_sub_f32 v43, v43, v54
    v_sub_f32 v188, v188, v55
    v_sub_f32 v44, v44, v55
    v_sub_f32 v189, v189, v55
    v_sub_f32 v45, v45, v55
    v_sub_f32 v190, v190, v55
    v_sub_f32 v46, v46, v55
    v_sub_f32 v191, v191, v55
    v_sub_f32 v47, v47, v55
    v_sub_f32 v8, v8, v52
    v_exp_f32 v52, -v52
    v_sub_f32 v9, v9, v53
    v_exp_f32 v53, -v53
    v_sub_f32 v10, v10, v54
    v_exp_f32 v54, -v54
    v_sub_f32 v11, v11, v55
    v_exp_f32 v55, -v55
    s_nop 0
    v_mul_f32 v12, v12, v52
    v_mul_f32 v13, v13, v53
    v_mul_f32 v14, v14, v54
    v_mul_f32 v15, v15, v55
    v_accvgpr_read_b32 v224, a0
    v_accvgpr_read_b32 v225, a1
    v_accvgpr_read_b32 v226, a2
    v_accvgpr_read_b32 v227, a3
    v_mul_f32 v224, v224, v52
    v_mul_f32 v225, v225, v52
    v_mul_f32 v226, v226, v52
    v_mul_f32 v227, v227, v52
    v_accvgpr_write_b32 a0, v224
    v_accvgpr_write_b32 a1, v225
    v_accvgpr_write_b32 a2, v226
    v_accvgpr_write_b32 a3, v227
    v_accvgpr_read_b32 v224, a4
    v_accvgpr_read_b32 v225, a5
    v_accvgpr_read_b32 v226, a6
    v_accvgpr_read_b32 v227, a7
    v_mul_f32 v224, v224, v53
    v_mul_f32 v225, v225, v53
    v_mul_f32 v226, v226, v53
    v_mul_f32 v227, v227, v53
    v_accvgpr_write_b32 a4, v224
    v_accvgpr_write_b32 a5, v225
    v_accvgpr_write_b32 a6, v226
    v_accvgpr_write_b32 a7, v227
    v_accvgpr_read_b32 v224, a8
    v_accvgpr_read_b32 v225, a9
    v_accvgpr_read_b32 v226, a10
    v_accvgpr_read_b32 v227, a11
    v_mul_f32 v224, v224, v54
    v_mul_f32 v225, v225, v54
    v_mul_f32 v226, v226, v54
    v_mul_f32 v227, v227, v54
    v_accvgpr_write_b32 a8, v224
    v_accvgpr_write_b32 a9, v225
    v_accvgpr_write_b32 a10, v226
    v_accvgpr_write_b32 a11, v227
    v_accvgpr_read_b32 v224, a12
    v_accvgpr_read_b32 v225, a13
    v_accvgpr_read_b32 v226, a14
    v_accvgpr_read_b32 v227, a15
    v_mul_f32 v224, v224, v55
    v_mul_f32 v225, v225, v55
    v_mul_f32 v226, v226, v55
    v_mul_f32 v227, v227, v55
    v_accvgpr_write_b32 a12, v224
    v_accvgpr_write_b32 a13, v225
    v_accvgpr_write_b32 a14, v226
    v_accvgpr_write_b32 a15, v227
    v_accvgpr_read_b32 v224, a16
    v_accvgpr_read_b32 v225, a17
    v_accvgpr_read_b32 v226, a18
    v_accvgpr_read_b32 v227, a19
    v_mul_f32 v224, v224, v52
    v_mul_f32 v225, v225, v52
    v_mul_f32 v226, v226, v52
    v_mul_f32 v227, v227, v52
    v_accvgpr_write_b32 a16, v224
    v_accvgpr_write_b32 a17, v225
    v_accvgpr_write_b32 a18, v226
    v_accvgpr_write_b32 a19, v227
    v_accvgpr_read_b32 v224, a20
    v_accvgpr_read_b32 v225, a21
    v_accvgpr_read_b32 v226, a22
    v_accvgpr_read_b32 v227, a23
    v_mul_f32 v224, v224, v53
    v_mul_f32 v225, v225, v53
    v_mul_f32 v226, v226, v53
    v_mul_f32 v227, v227, v53
    v_accvgpr_write_b32 a20, v224
    v_accvgpr_write_b32 a21, v225
    v_accvgpr_write_b32 a22, v226
    v_accvgpr_write_b32 a23, v227
    v_accvgpr_read_b32 v224, a24
    v_accvgpr_read_b32 v225, a25
    v_accvgpr_read_b32 v226, a26
    v_accvgpr_read_b32 v227, a27
    v_mul_f32 v224, v224, v54
    v_mul_f32 v225, v225, v54
    v_mul_f32 v226, v226, v54
    v_mul_f32 v227, v227, v54
    v_accvgpr_write_b32 a24, v224
    v_accvgpr_write_b32 a25, v225
    v_accvgpr_write_b32 a26, v226
    v_accvgpr_write_b32 a27, v227
    v_accvgpr_read_b32 v224, a28
    v_accvgpr_read_b32 v225, a29
    v_accvgpr_read_b32 v226, a30
    v_accvgpr_read_b32 v227, a31
    v_mul_f32 v224, v224, v55
    v_mul_f32 v225, v225, v55
    v_mul_f32 v226, v226, v55
    v_mul_f32 v227, v227, v55
    v_accvgpr_write_b32 a28, v224
    v_accvgpr_write_b32 a29, v225
    v_accvgpr_write_b32 a30, v226
    v_accvgpr_write_b32 a31, v227
    v_accvgpr_read_b32 v224, a32
    v_accvgpr_read_b32 v225, a33
    v_accvgpr_read_b32 v226, a34
    v_accvgpr_read_b32 v227, a35
    v_mul_f32 v224, v224, v52
    v_mul_f32 v225, v225, v52
    v_mul_f32 v226, v226, v52
    v_mul_f32 v227, v227, v52
    v_accvgpr_write_b32 a32, v224
    v_accvgpr_write_b32 a33, v225
    v_accvgpr_write_b32 a34, v226
    v_accvgpr_write_b32 a35, v227
    v_accvgpr_read_b32 v224, a36
    v_accvgpr_read_b32 v225, a37
    v_accvgpr_read_b32 v226, a38
    v_accvgpr_read_b32 v227, a39
    v_mul_f32 v224, v224, v53
    v_mul_f32 v225, v225, v53
    v_mul_f32 v226, v226, v53
    v_mul_f32 v227, v227, v53
    v_accvgpr_write_b32 a36, v224
    v_accvgpr_write_b32 a37, v225
    v_accvgpr_write_b32 a38, v226
    v_accvgpr_write_b32 a39, v227
    v_accvgpr_read_b32 v224, a40
    v_accvgpr_read_b32 v225, a41
    v_accvgpr_read_b32 v226, a42
    v_accvgpr_read_b32 v227, a43
    v_mul_f32 v224, v224, v54
    v_mul_f32 v225, v225, v54
    v_mul_f32 v226, v226, v54
    v_mul_f32 v227, v227, v54
    v_accvgpr_write_b32 a40, v224
    v_accvgpr_write_b32 a41, v225
    v_accvgpr_write_b32 a42, v226
    v_accvgpr_write_b32 a43, v227
    v_accvgpr_read_b32 v224, a44
    v_accvgpr_read_b32 v225, a45
    v_accvgpr_read_b32 v226, a46
    v_accvgpr_read_b32 v227, a47
    v_mul_f32 v224, v224, v55
    v_mul_f32 v225, v225, v55
    v_mul_f32 v226, v226, v55
    v_mul_f32 v227, v227, v55
    v_accvgpr_write_b32 a44, v224
    v_accvgpr_write_b32 a45, v225
    v_accvgpr_write_b32 a46, v226
    v_accvgpr_write_b32 a47, v227
    v_accvgpr_read_b32 v224, a48
    v_accvgpr_read_b32 v225, a49
    v_accvgpr_read_b32 v226, a50
    v_accvgpr_read_b32 v227, a51
    v_mul_f32 v224, v224, v52
    v_mul_f32 v225, v225, v52
    v_mul_f32 v226, v226, v52
    v_mul_f32 v227, v227, v52
    v_accvgpr_write_b32 a48, v224
    v_accvgpr_write_b32 a49, v225
    v_accvgpr_write_b32 a50, v226
    v_accvgpr_write_b32 a51, v227
    v_accvgpr_read_b32 v224, a52
    v_accvgpr_read_b32 v225, a53
    v_accvgpr_read_b32 v226, a54
    v_accvgpr_read_b32 v227, a55
    v_mul_f32 v224, v224, v53
    v_mul_f32 v225, v225, v53
    v_mul_f32 v226, v226, v53
    v_mul_f32 v227, v227, v53
    v_accvgpr_write_b32 a52, v224
    v_accvgpr_write_b32 a53, v225
    v_accvgpr_write_b32 a54, v226
    v_accvgpr_write_b32 a55, v227
    v_accvgpr_read_b32 v224, a56
    v_accvgpr_read_b32 v225, a57
    v_accvgpr_read_b32 v226, a58
    v_accvgpr_read_b32 v227, a59
    v_mul_f32 v224, v224, v54
    v_mul_f32 v225, v225, v54
    v_mul_f32 v226, v226, v54
    v_mul_f32 v227, v227, v54
    v_accvgpr_write_b32 a56, v224
    v_accvgpr_write_b32 a57, v225
    v_accvgpr_write_b32 a58, v226
    v_accvgpr_write_b32 a59, v227
    v_accvgpr_read_b32 v224, a60
    v_accvgpr_read_b32 v225, a61
    v_accvgpr_read_b32 v226, a62
    v_accvgpr_read_b32 v227, a63
    v_mul_f32 v224, v224, v55
    v_mul_f32 v225, v225, v55
    v_mul_f32 v226, v226, v55
    v_mul_f32 v227, v227, v55
    v_accvgpr_write_b32 a60, v224
    v_accvgpr_write_b32 a61, v225
    v_accvgpr_write_b32 a62, v226
    v_accvgpr_write_b32 a63, v227
    v_accvgpr_read_b32 v224, a64
    v_accvgpr_read_b32 v225, a65
    v_accvgpr_read_b32 v226, a66
    v_accvgpr_read_b32 v227, a67
    v_mul_f32 v224, v224, v52
    v_mul_f32 v225, v225, v52
    v_mul_f32 v226, v226, v52
    v_mul_f32 v227, v227, v52
    v_accvgpr_write_b32 a64, v224
    v_accvgpr_write_b32 a65, v225
    v_accvgpr_write_b32 a66, v226
    v_accvgpr_write_b32 a67, v227
    v_accvgpr_read_b32 v224, a68
    v_accvgpr_read_b32 v225, a69
    v_accvgpr_read_b32 v226, a70
    v_accvgpr_read_b32 v227, a71
    v_mul_f32 v224, v224, v53
    v_mul_f32 v225, v225, v53
    v_mul_f32 v226, v226, v53
    v_mul_f32 v227, v227, v53
    v_accvgpr_write_b32 a68, v224
    v_accvgpr_write_b32 a69, v225
    v_accvgpr_write_b32 a70, v226
    v_accvgpr_write_b32 a71, v227
    v_accvgpr_read_b32 v224, a72
    v_accvgpr_read_b32 v225, a73
    v_accvgpr_read_b32 v226, a74
    v_accvgpr_read_b32 v227, a75
    v_mul_f32 v224, v224, v54
    v_mul_f32 v225, v225, v54
    v_mul_f32 v226, v226, v54
    v_mul_f32 v227, v227, v54
    v_accvgpr_write_b32 a72, v224
    v_accvgpr_write_b32 a73, v225
    v_accvgpr_write_b32 a74, v226
    v_accvgpr_write_b32 a75, v227
    v_accvgpr_read_b32 v224, a76
    v_accvgpr_read_b32 v225, a77
    v_accvgpr_read_b32 v226, a78
    v_accvgpr_read_b32 v227, a79
    v_mul_f32 v224, v224, v55
    v_mul_f32 v225, v225, v55
    v_mul_f32 v226, v226, v55
    v_mul_f32 v227, v227, v55
    v_accvgpr_write_b32 a76, v224
    v_accvgpr_write_b32 a77, v225
    v_accvgpr_write_b32 a78, v226
    v_accvgpr_write_b32 a79, v227
    v_accvgpr_read_b32 v224, a80
    v_accvgpr_read_b32 v225, a81
    v_accvgpr_read_b32 v226, a82
    v_accvgpr_read_b32 v227, a83
    v_mul_f32 v224, v224, v52
    v_mul_f32 v225, v225, v52
    v_mul_f32 v226, v226, v52
    v_mul_f32 v227, v227, v52
    v_accvgpr_write_b32 a80, v224
    v_accvgpr_write_b32 a81, v225
    v_accvgpr_write_b32 a82, v226
    v_accvgpr_write_b32 a83, v227
    v_accvgpr_read_b32 v224, a84
    v_accvgpr_read_b32 v225, a85
    v_accvgpr_read_b32 v226, a86
    v_accvgpr_read_b32 v227, a87
    v_mul_f32 v224, v224, v53
    v_mul_f32 v225, v225, v53
    v_mul_f32 v226, v226, v53
    v_mul_f32 v227, v227, v53
    v_accvgpr_write_b32 a84, v224
    v_accvgpr_write_b32 a85, v225
    v_accvgpr_write_b32 a86, v226
    v_accvgpr_write_b32 a87, v227
    v_accvgpr_read_b32 v224, a88
    v_accvgpr_read_b32 v225, a89
    v_accvgpr_read_b32 v226, a90
    v_accvgpr_read_b32 v227, a91
    v_mul_f32 v224, v224, v54
    v_mul_f32 v225, v225, v54
    v_mul_f32 v226, v226, v54
    v_mul_f32 v227, v227, v54
    v_accvgpr_write_b32 a88, v224
    v_accvgpr_write_b32 a89, v225
    v_accvgpr_write_b32 a90, v226
    v_accvgpr_write_b32 a91, v227
    v_accvgpr_read_b32 v224, a92
    v_accvgpr_read_b32 v225, a93
    v_accvgpr_read_b32 v226, a94
    v_accvgpr_read_b32 v227, a95
    v_mul_f32 v224, v224, v55
    v_mul_f32 v225, v225, v55
    v_mul_f32 v226, v226, v55
    v_mul_f32 v227, v227, v55
    v_accvgpr_write_b32 a92, v224
    v_accvgpr_write_b32 a93, v225
    v_accvgpr_write_b32 a94, v226
    v_accvgpr_write_b32 a95, v227
    v_accvgpr_read_b32 v224, a96
    v_accvgpr_read_b32 v225, a97
    v_accvgpr_read_b32 v226, a98
    v_accvgpr_read_b32 v227, a99
    v_mul_f32 v224, v224, v52
    v_mul_f32 v225, v225, v52
    v_mul_f32 v226, v226, v52
    v_mul_f32 v227, v227, v52
    v_accvgpr_write_b32 a96, v224
    v_accvgpr_write_b32 a97, v225
    v_accvgpr_write_b32 a98, v226
    v_accvgpr_write_b32 a99, v227
    v_accvgpr_read_b32 v224, a100
    v_accvgpr_read_b32 v225, a101
    v_accvgpr_read_b32 v226, a102
    v_accvgpr_read_b32 v227, a103
    v_mul_f32 v224, v224, v53
    v_mul_f32 v225, v225, v53
    v_mul_f32 v226, v226, v53
    v_mul_f32 v227, v227, v53
    v_accvgpr_write_b32 a100, v224
    v_accvgpr_write_b32 a101, v225
    v_accvgpr_write_b32 a102, v226
    v_accvgpr_write_b32 a103, v227
    v_accvgpr_read_b32 v224, a104
    v_accvgpr_read_b32 v225, a105
    v_accvgpr_read_b32 v226, a106
    v_accvgpr_read_b32 v227, a107
    v_mul_f32 v224, v224, v54
    v_mul_f32 v225, v225, v54
    v_mul_f32 v226, v226, v54
    v_mul_f32 v227, v227, v54
    v_accvgpr_write_b32 a104, v224
    v_accvgpr_write_b32 a105, v225
    v_accvgpr_write_b32 a106, v226
    v_accvgpr_write_b32 a107, v227
    v_accvgpr_read_b32 v224, a108
    v_accvgpr_read_b32 v225, a109
    v_accvgpr_read_b32 v226, a110
    v_accvgpr_read_b32 v227, a111
    v_mul_f32 v224, v224, v55
    v_mul_f32 v225, v225, v55
    v_mul_f32 v226, v226, v55
    v_mul_f32 v227, v227, v55
    v_accvgpr_write_b32 a108, v224
    v_accvgpr_write_b32 a109, v225
    v_accvgpr_write_b32 a110, v226
    v_accvgpr_write_b32 a111, v227
    v_accvgpr_read_b32 v224, a112
    v_accvgpr_read_b32 v225, a113
    v_accvgpr_read_b32 v226, a114
    v_accvgpr_read_b32 v227, a115
    v_mul_f32 v224, v224, v52
    v_mul_f32 v225, v225, v52
    v_mul_f32 v226, v226, v52
    v_mul_f32 v227, v227, v52
    v_accvgpr_write_b32 a112, v224
    v_accvgpr_write_b32 a113, v225
    v_accvgpr_write_b32 a114, v226
    v_accvgpr_write_b32 a115, v227
    v_accvgpr_read_b32 v224, a116
    v_accvgpr_read_b32 v225, a117
    v_accvgpr_read_b32 v226, a118
    v_accvgpr_read_b32 v227, a119
    v_mul_f32 v224, v224, v53
    v_mul_f32 v225, v225, v53
    v_mul_f32 v226, v226, v53
    v_mul_f32 v227, v227, v53
    v_accvgpr_write_b32 a116, v224
    v_accvgpr_write_b32 a117, v225
    v_accvgpr_write_b32 a118, v226
    v_accvgpr_write_b32 a119, v227
    v_accvgpr_read_b32 v224, a120
    v_accvgpr_read_b32 v225, a121
    v_accvgpr_read_b32 v226, a122
    v_accvgpr_read_b32 v227, a123
    v_mul_f32 v224, v224, v54
    v_mul_f32 v225, v225, v54
    v_mul_f32 v226, v226, v54
    v_mul_f32 v227, v227, v54
    v_accvgpr_write_b32 a120, v224
    v_accvgpr_write_b32 a121, v225
    v_accvgpr_write_b32 a122, v226
    v_accvgpr_write_b32 a123, v227
    v_accvgpr_read_b32 v224, a124
    v_accvgpr_read_b32 v225, a125
    v_accvgpr_read_b32 v226, a126
    v_accvgpr_read_b32 v227, a127
    v_mul_f32 v224, v224, v55
    v_mul_f32 v225, v225, v55
    v_mul_f32 v226, v226, v55
    v_mul_f32 v227, v227, v55
    v_accvgpr_write_b32 a124, v224
    v_accvgpr_write_b32 a125, v225
    v_accvgpr_write_b32 a126, v226
    v_accvgpr_write_b32 a127, v227
    v_exp_f32 v232, v128
    v_exp_f32 v233, v129
    v_exp_f32 v234, v130
    v_exp_f32 v235, v131
    v_add_f32 v48, v232, v233
    v_cvt_pk_bf16_f32 v192, v232, v233
    v_exp_f32 v236, v144
    v_exp_f32 v237, v145
    v_add_f32 v48, v48, v234
    v_add_f32 v48, v48, v235
    v_cvt_pk_bf16_f32 v193, v234, v235
    v_exp_f32 v238, v146
    v_exp_f32 v239, v147
    v_add_f32 v48, v48, v236
    v_add_f32 v48, v48, v237
    v_cvt_pk_bf16_f32 v194, v236, v237
    v_exp_f32 v240, v132
    v_exp_f32 v241, v133
    v_add_f32 v48, v48, v238
    v_add_f32 v48, v48, v239
    v_cvt_pk_bf16_f32 v195, v238, v239
    v_exp_f32 v242, v134
    v_exp_f32 v243, v135
    v_add_f32 v49, v240, v241
    v_cvt_pk_bf16_f32 v196, v240, v241
    v_exp_f32 v244, v148
    v_exp_f32 v245, v149
    v_add_f32 v49, v49, v242
    v_add_f32 v49, v49, v243
    v_cvt_pk_bf16_f32 v197, v242, v243
    v_exp_f32 v246, v150
    v_exp_f32 v247, v151
    v_add_f32 v49, v49, v244
    v_add_f32 v49, v49, v245
    v_cvt_pk_bf16_f32 v198, v244, v245
    v_exp_f32 v232, v136
    v_exp_f32 v233, v137
    v_add_f32 v49, v49, v246
    v_add_f32 v49, v49, v247
    v_cvt_pk_bf16_f32 v199, v246, v247
    v_exp_f32 v234, v138
    v_exp_f32 v235, v139
    v_add_f32 v50, v232, v233
    v_cvt_pk_bf16_f32 v200, v232, v233
    v_exp_f32 v236, v152
    v_exp_f32 v237, v153
    v_add_f32 v50, v50, v234
    v_add_f32 v50, v50, v235
    v_cvt_pk_bf16_f32 v201, v234, v235
    v_exp_f32 v238, v154
    v_exp_f32 v239, v155
    v_add_f32 v50, v50, v236
    v_add_f32 v50, v50, v237
    v_cvt_pk_bf16_f32 v202, v236, v237
    v_exp_f32 v240, v140
    v_exp_f32 v241, v141
    v_add_f32 v50, v50, v238
    v_add_f32 v50, v50, v239
    v_cvt_pk_bf16_f32 v203, v238, v239
    v_exp_f32 v242, v142
    v_exp_f32 v243, v143
    v_add_f32 v51, v240, v241
    v_cvt_pk_bf16_f32 v204, v240, v241
    v_exp_f32 v244, v156
    v_exp_f32 v245, v157
    v_add_f32 v51, v51, v242
    v_add_f32 v51, v51, v243
    v_cvt_pk_bf16_f32 v205, v242, v243
    v_exp_f32 v246, v158
    v_exp_f32 v247, v159
    v_add_f32 v51, v51, v244
    v_add_f32 v51, v51, v245
    v_cvt_pk_bf16_f32 v206, v244, v245
    s_nop 0
    v_add_f32 v51, v51, v246
    v_add_f32 v51, v51, v247
    v_cvt_pk_bf16_f32 v207, v246, v247
    s_nop 1
    s_branch k2_ret_57
k2_rare_60:
    s_nop 7
    v_max_f32 v52, v160, v161
    v_max3_f32 v52, v52, v162, v163
    v_max3_f32 v52, v52, v176, v177
    v_max3_f32 v52, v52, v178, v179
    v_mov_b32 v6, v52
    s_nop 1
    v_permlane16_swap_b32 v52, v6
    s_nop 1
    v_max_f32 v52, v52, v6
    v_mov_b32 v6, v52
    s_nop 1
    v_permlane32_swap_b32 v52, v6
    s_nop 1
    v_max_f32 v52, v52, v6
    v_max_f32 v52, 0, v52
    v_max_f32 v53, v164, v165
    v_max3_f32 v53, v53, v166, v167
    v_max3_f32 v53, v53, v180, v181
    v_max3_f32 v53, v53, v182, v183
    v_mov_b32 v6, v53
    s_nop 1
    v_permlane16_swap_b32 v53, v6
    s_nop 1
    v_max_f32 v53, v53, v6
    v_mov_b32 v6, v53
    s_nop 1
    v_permlane32_swap_b32 v53, v6
    s_nop 1
    v_max_f32 v53, v53, v6
    v_max_f32 v53, 0, v53
    v_max_f32 v54, v168, v169
    v_max3_f32 v54, v54, v170, v171
    v_max3_f32 v54, v54, v184, v185
    v_max3_f32 v54, v54, v186, v187
    v_mov_b32 v6, v54
    s_nop 1
    v_permlane16_swap_b32 v54, v6
    s_nop 1
    v_max_f32 v54, v54, v6
    v_mov_b32 v6, v54
    s_nop 1
    v_permlane32_swap_b32 v54, v6
    s_nop 1
    v_max_f32 v54, v54, v6
    v_max_f32 v54, 0, v54
    v_max_f32 v55, v172, v173
    v_max3_f32 v55, v55, v174, v175
    v_max3_f32 v55, v55, v188, v189
    v_max3_f32 v55, v55, v190, v191
    v_mov_b32 v6, v55
    s_nop 1
    v_permlane16_swap_b32 v55, v6
    s_nop 1
    v_max_f32 v55, v55, v6
    v_mov_b32 v6, v55
    s_nop 1
    v_permlane32_swap_b32 v55, v6
    s_nop 1
    v_max_f32 v55, v55, v6
    v_max_f32 v55, 0, v55
    v_sub_f32 v160, v160, v52
    v_sub_f32 v161, v161, v52
    v_sub_f32 v162, v162, v52
    v_sub_f32 v163, v163, v52
    v_sub_f32 v164, v164, v53
    v_sub_f32 v165, v165, v53
    v_sub_f32 v166, v166, v53
    v_sub_f32 v167, v167, v53
    v_sub_f32 v168, v168, v54
    v_sub_f32 v169, v169, v54
    v_sub_f32 v170, v170, v54
    v_sub_f32 v171, v171, v54
    v_sub_f32 v172, v172, v55
    v_sub_f32 v173, v173, v55
    v_sub_f32 v174, v174, v55
    v_sub_f32 v175, v175, v55
    v_sub_f32 v176, v176, v52
    v_sub_f32 v177, v177, v52
    v_sub_f32 v178, v178, v52
    v_sub_f32 v179, v179, v52
    v_sub_f32 v180, v180, v53
    v_sub_f32 v181, v181, v53
    v_sub_f32 v182, v182, v53
    v_sub_f32 v183, v183, v53
    v_sub_f32 v184, v184, v54
    v_sub_f32 v185, v185, v54
    v_sub_f32 v186, v186, v54
    v_sub_f32 v187, v187, v54
    v_sub_f32 v188, v188, v55
    v_sub_f32 v189, v189, v55
    v_sub_f32 v190, v190, v55
    v_sub_f32 v191, v191, v55
    v_sub_f32 v128, v128, v54
    v_sub_f32 v16, v16, v54
    v_sub_f32 v129, v129, v54
    v_sub_f32 v17, v17, v54
    v_sub_f32 v130, v130, v54
    v_sub_f32 v18, v18, v54
    v_sub_f32 v131, v131, v54
    v_sub_f32 v19, v19, v54
    v_sub_f32 v132, v132, v55
    v_sub_f32 v20, v20, v55
    v_sub_f32 v133, v133, v55
    v_sub_f32 v21, v21, v55
    v_sub_f32 v134, v134, v55
    v_sub_f32 v22, v22, v55
    v_sub_f32 v135, v135, v55
    v_sub_f32 v23, v23, v55
    v_sub_f32 v136, v136, v54
    v_sub_f32 v24, v24, v54
    v_sub_f32 v137, v137, v54
    v_sub_f32 v25, v25, v54
    v_sub_f32 v138, v138, v54
    v_sub_f32 v26, v26, v54
    v_sub_f32 v139, v139, v54
    v_sub_f32 v27, v27, v54
    v_sub_f32 v140, v140, v55
    v_sub_f32 v28, v28, v55
    v_sub_f32 v141, v141, v55
    v_sub_f32 v29, v29, v55
    v_sub_f32 v142, v142, v55
    v_sub_f32 v30, v30, v55
    v_sub_f32 v143, v143, v55
    v_sub_f32 v31, v31, v55
    v_sub_f32 v144, v144, v54
    v_sub_f32 v32, v32, v54
    v_sub_f32 v145, v145, v54
    v_sub_f32 v33, v33, v54
    v_sub_f32 v146, v146, v54
    v_sub_f32 v34, v34, v54
    v_sub_f32 v147, v147, v54
    v_sub_f32 v35, v35, v54
    v_sub_f32 v148, v148, v55
    v_sub_f32 v36, v36, v55
    v_sub_f32 v149, v149, v55
    v_sub_f32 v37, v37, v55
    v_sub_f32 v150, v150, v55
    v_sub_f32 v38, v38, v55
    v_sub_f32 v151, v151, v55
    v_sub_f32 v39, v39, v55
    v_sub_f32 v152, v152, v54
    v_sub_f32 v40, v40, v54
    v_sub_f32 v153, v153, v54
    v_sub_f32 v41, v41, v54
    v_sub_f32 v154, v154, v54
    v_sub_f32 v42, v42, v54
    v_sub_f32 v155, v155, v54
    v_sub_f32 v43, v43, v54
    v_sub_f32 v156, v156, v55
    v_sub_f32 v44, v44, v55
    v_sub_f32 v157, v157, v55
    v_sub_f32 v45, v45, v55
    v_sub_f32 v158, v158, v55
    v_sub_f32 v46, v46, v55
    v_sub_f32 v159, v159, v55
    v_sub_f32 v47, v47, v55
    v_sub_f32 v8, v8, v52
    v_exp_f32 v52, -v52
    v_sub_f32 v9, v9, v53
    v_exp_f32 v53, -v53
    v_sub_f32 v10, v10, v54
    v_exp_f32 v54, -v54
    v_sub_f32 v11, v11, v55
    v_exp_f32 v55, -v55
    s_nop 0
    v_mul_f32 v12, v12, v52
    v_mul_f32 v13, v13, v53
    v_mul_f32 v14, v14, v54
    v_mul_f32 v15, v15, v55
    v_accvgpr_read_b32 v224, a0
    v_accvgpr_read_b32 v225, a1
    v_accvgpr_read_b32 v226, a2
    v_accvgpr_read_b32 v227, a3
    v_mul_f32 v224, v224, v52
    v_mul_f32 v225, v225, v52
    v_mul_f32 v226, v226, v52
    v_mul_f32 v227, v227, v52
    v_accvgpr_write_b32 a0, v224
    v_accvgpr_write_b32 a1, v225
    v_accvgpr_write_b32 a2, v226
    v_accvgpr_write_b32 a3, v227
    v_accvgpr_read_b32 v224, a4
    v_accvgpr_read_b32 v225, a5
    v_accvgpr_read_b32 v226, a6
    v_accvgpr_read_b32 v227, a7
    v_mul_f32 v224, v224, v53
    v_mul_f32 v225, v225, v53
    v_mul_f32 v226, v226, v53
    v_mul_f32 v227, v227, v53
    v_accvgpr_write_b32 a4, v224
    v_accvgpr_write_b32 a5, v225
    v_accvgpr_write_b32 a6, v226
    v_accvgpr_write_b32 a7, v227
    v_accvgpr_read_b32 v224, a8
    v_accvgpr_read_b32 v225, a9
    v_accvgpr_read_b32 v226, a10
    v_accvgpr_read_b32 v227, a11
    v_mul_f32 v224, v224, v54
    v_mul_f32 v225, v225, v54
    v_mul_f32 v226, v226, v54
    v_mul_f32 v227, v227, v54
    v_accvgpr_write_b32 a8, v224
    v_accvgpr_write_b32 a9, v225
    v_accvgpr_write_b32 a10, v226
    v_accvgpr_write_b32 a11, v227
    v_accvgpr_read_b32 v224, a12
    v_accvgpr_read_b32 v225, a13
    v_accvgpr_read_b32 v226, a14
    v_accvgpr_read_b32 v227, a15
    v_mul_f32 v224, v224, v55
    v_mul_f32 v225, v225, v55
    v_mul_f32 v226, v226, v55
    v_mul_f32 v227, v227, v55
    v_accvgpr_write_b32 a12, v224
    v_accvgpr_write_b32 a13, v225
    v_accvgpr_write_b32 a14, v226
    v_accvgpr_write_b32 a15, v227
    v_accvgpr_read_b32 v224, a16
    v_accvgpr_read_b32 v225, a17
    v_accvgpr_read_b32 v226, a18
    v_accvgpr_read_b32 v227, a19
    v_mul_f32 v224, v224, v52
    v_mul_f32 v225, v225, v52
    v_mul_f32 v226, v226, v52
    v_mul_f32 v227, v227, v52
    v_accvgpr_write_b32 a16, v224
    v_accvgpr_write_b32 a17, v225
    v_accvgpr_write_b32 a18, v226
    v_accvgpr_write_b32 a19, v227
    v_accvgpr_read_b32 v224, a20
    v_accvgpr_read_b32 v225, a21
    v_accvgpr_read_b32 v226, a22
    v_accvgpr_read_b32 v227, a23
    v_mul_f32 v224, v224, v53
    v_mul_f32 v225, v225, v53
    v_mul_f32 v226, v226, v53
    v_mul_f32 v227, v227, v53
    v_accvgpr_write_b32 a20, v224
    v_accvgpr_write_b32 a21, v225
    v_accvgpr_write_b32 a22, v226
    v_accvgpr_write_b32 a23, v227
    v_accvgpr_read_b32 v224, a24
    v_accvgpr_read_b32 v225, a25
    v_accvgpr_read_b32 v226, a26
    v_accvgpr_read_b32 v227, a27
    v_mul_f32 v224, v224, v54
    v_mul_f32 v225, v225, v54
    v_mul_f32 v226, v226, v54
    v_mul_f32 v227, v227, v54
    v_accvgpr_write_b32 a24, v224
    v_accvgpr_write_b32 a25, v225
    v_accvgpr_write_b32 a26, v226
    v_accvgpr_write_b32 a27, v227
    v_accvgpr_read_b32 v224, a28
    v_accvgpr_read_b32 v225, a29
    v_accvgpr_read_b32 v226, a30
    v_accvgpr_read_b32 v227, a31
    v_mul_f32 v224, v224, v55
    v_mul_f32 v225, v225, v55
    v_mul_f32 v226, v226, v55
    v_mul_f32 v227, v227, v55
    v_accvgpr_write_b32 a28, v224
    v_accvgpr_write_b32 a29, v225
    v_accvgpr_write_b32 a30, v226
    v_accvgpr_write_b32 a31, v227
    v_accvgpr_read_b32 v224, a32
    v_accvgpr_read_b32 v225, a33
    v_accvgpr_read_b32 v226, a34
    v_accvgpr_read_b32 v227, a35
    v_mul_f32 v224, v224, v52
    v_mul_f32 v225, v225, v52
    v_mul_f32 v226, v226, v52
    v_mul_f32 v227, v227, v52
    v_accvgpr_write_b32 a32, v224
    v_accvgpr_write_b32 a33, v225
    v_accvgpr_write_b32 a34, v226
    v_accvgpr_write_b32 a35, v227
    v_accvgpr_read_b32 v224, a36
    v_accvgpr_read_b32 v225, a37
    v_accvgpr_read_b32 v226, a38
    v_accvgpr_read_b32 v227, a39
    v_mul_f32 v224, v224, v53
    v_mul_f32 v225, v225, v53
    v_mul_f32 v226, v226, v53
    v_mul_f32 v227, v227, v53
    v_accvgpr_write_b32 a36, v224
    v_accvgpr_write_b32 a37, v225
    v_accvgpr_write_b32 a38, v226
    v_accvgpr_write_b32 a39, v227
    v_accvgpr_read_b32 v224, a40
    v_accvgpr_read_b32 v225, a41
    v_accvgpr_read_b32 v226, a42
    v_accvgpr_read_b32 v227, a43
    v_mul_f32 v224, v224, v54
    v_mul_f32 v225, v225, v54
    v_mul_f32 v226, v226, v54
    v_mul_f32 v227, v227, v54
    v_accvgpr_write_b32 a40, v224
    v_accvgpr_write_b32 a41, v225
    v_accvgpr_write_b32 a42, v226
    v_accvgpr_write_b32 a43, v227
    v_accvgpr_read_b32 v224, a44
    v_accvgpr_read_b32 v225, a45
    v_accvgpr_read_b32 v226, a46
    v_accvgpr_read_b32 v227, a47
    v_mul_f32 v224, v224, v55
    v_mul_f32 v225, v225, v55
    v_mul_f32 v226, v226, v55
    v_mul_f32 v227, v227, v55
    v_accvgpr_write_b32 a44, v224
    v_accvgpr_write_b32 a45, v225
    v_accvgpr_write_b32 a46, v226
    v_accvgpr_write_b32 a47, v227
    v_accvgpr_read_b32 v224, a48
    v_accvgpr_read_b32 v225, a49
    v_accvgpr_read_b32 v226, a50
    v_accvgpr_read_b32 v227, a51
    v_mul_f32 v224, v224, v52
    v_mul_f32 v225, v225, v52
    v_mul_f32 v226, v226, v52
    v_mul_f32 v227, v227, v52
    v_accvgpr_write_b32 a48, v224
    v_accvgpr_write_b32 a49, v225
    v_accvgpr_write_b32 a50, v226
    v_accvgpr_write_b32 a51, v227
    v_accvgpr_read_b32 v224, a52
    v_accvgpr_read_b32 v225, a53
    v_accvgpr_read_b32 v226, a54
    v_accvgpr_read_b32 v227, a55
    v_mul_f32 v224, v224, v53
    v_mul_f32 v225, v225, v53
    v_mul_f32 v226, v226, v53
    v_mul_f32 v227, v227, v53
    v_accvgpr_write_b32 a52, v224
    v_accvgpr_write_b32 a53, v225
    v_accvgpr_write_b32 a54, v226
    v_accvgpr_write_b32 a55, v227
    v_accvgpr_read_b32 v224, a56
    v_accvgpr_read_b32 v225, a57
    v_accvgpr_read_b32 v226, a58
    v_accvgpr_read_b32 v227, a59
    v_mul_f32 v224, v224, v54
    v_mul_f32 v225, v225, v54
    v_mul_f32 v226, v226, v54
    v_mul_f32 v227, v227, v54
    v_accvgpr_write_b32 a56, v224
    v_accvgpr_write_b32 a57, v225
    v_accvgpr_write_b32 a58, v226
    v_accvgpr_write_b32 a59, v227
    v_accvgpr_read_b32 v224, a60
    v_accvgpr_read_b32 v225, a61
    v_accvgpr_read_b32 v226, a62
    v_accvgpr_read_b32 v227, a63
    v_mul_f32 v224, v224, v55
    v_mul_f32 v225, v225, v55
    v_mul_f32 v226, v226, v55
    v_mul_f32 v227, v227, v55
    v_accvgpr_write_b32 a60, v224
    v_accvgpr_write_b32 a61, v225
    v_accvgpr_write_b32 a62, v226
    v_accvgpr_write_b32 a63, v227
    v_accvgpr_read_b32 v224, a64
    v_accvgpr_read_b32 v225, a65
    v_accvgpr_read_b32 v226, a66
    v_accvgpr_read_b32 v227, a67
    v_mul_f32 v224, v224, v52
    v_mul_f32 v225, v225, v52
    v_mul_f32 v226, v226, v52
    v_mul_f32 v227, v227, v52
    v_accvgpr_write_b32 a64, v224
    v_accvgpr_write_b32 a65, v225
    v_accvgpr_write_b32 a66, v226
    v_accvgpr_write_b32 a67, v227
    v_accvgpr_read_b32 v224, a68
    v_accvgpr_read_b32 v225, a69
    v_accvgpr_read_b32 v226, a70
    v_accvgpr_read_b32 v227, a71
    v_mul_f32 v224, v224, v53
    v_mul_f32 v225, v225, v53
    v_mul_f32 v226, v226, v53
    v_mul_f32 v227, v227, v53
    v_accvgpr_write_b32 a68, v224
    v_accvgpr_write_b32 a69, v225
    v_accvgpr_write_b32 a70, v226
    v_accvgpr_write_b32 a71, v227
    v_accvgpr_read_b32 v224, a72
    v_accvgpr_read_b32 v225, a73
    v_accvgpr_read_b32 v226, a74
    v_accvgpr_read_b32 v227, a75
    v_mul_f32 v224, v224, v54
    v_mul_f32 v225, v225, v54
    v_mul_f32 v226, v226, v54
    v_mul_f32 v227, v227, v54
    v_accvgpr_write_b32 a72, v224
    v_accvgpr_write_b32 a73, v225
    v_accvgpr_write_b32 a74, v226
    v_accvgpr_write_b32 a75, v227
    v_accvgpr_read_b32 v224, a76
    v_accvgpr_read_b32 v225, a77
    v_accvgpr_read_b32 v226, a78
    v_accvgpr_read_b32 v227, a79
    v_mul_f32 v224, v224, v55
    v_mul_f32 v225, v225, v55
    v_mul_f32 v226, v226, v55
    v_mul_f32 v227, v227, v55
    v_accvgpr_write_b32 a76, v224
    v_accvgpr_write_b32 a77, v225
    v_accvgpr_write_b32 a78, v226
    v_accvgpr_write_b32 a79, v227
    v_accvgpr_read_b32 v224, a80
    v_accvgpr_read_b32 v225, a81
    v_accvgpr_read_b32 v226, a82
    v_accvgpr_read_b32 v227, a83
    v_mul_f32 v224, v224, v52
    v_mul_f32 v225, v225, v52
    v_mul_f32 v226, v226, v52
    v_mul_f32 v227, v227, v52
    v_accvgpr_write_b32 a80, v224
    v_accvgpr_write_b32 a81, v225
    v_accvgpr_write_b32 a82, v226
    v_accvgpr_write_b32 a83, v227
    v_accvgpr_read_b32 v224, a84
    v_accvgpr_read_b32 v225, a85
    v_accvgpr_read_b32 v226, a86
    v_accvgpr_read_b32 v227, a87
    v_mul_f32 v224, v224, v53
    v_mul_f32 v225, v225, v53
    v_mul_f32 v226, v226, v53
    v_mul_f32 v227, v227, v53
    v_accvgpr_write_b32 a84, v224
    v_accvgpr_write_b32 a85, v225
    v_accvgpr_write_b32 a86, v226
    v_accvgpr_write_b32 a87, v227
    v_accvgpr_read_b32 v224, a88
    v_accvgpr_read_b32 v225, a89
    v_accvgpr_read_b32 v226, a90
    v_accvgpr_read_b32 v227, a91
    v_mul_f32 v224, v224, v54
    v_mul_f32 v225, v225, v54
    v_mul_f32 v226, v226, v54
    v_mul_f32 v227, v227, v54
    v_accvgpr_write_b32 a88, v224
    v_accvgpr_write_b32 a89, v225
    v_accvgpr_write_b32 a90, v226
    v_accvgpr_write_b32 a91, v227
    v_accvgpr_read_b32 v224, a92
    v_accvgpr_read_b32 v225, a93
    v_accvgpr_read_b32 v226, a94
    v_accvgpr_read_b32 v227, a95
    v_mul_f32 v224, v224, v55
    v_mul_f32 v225, v225, v55
    v_mul_f32 v226, v226, v55
    v_mul_f32 v227, v227, v55
    v_accvgpr_write_b32 a92, v224
    v_accvgpr_write_b32 a93, v225
    v_accvgpr_write_b32 a94, v226
    v_accvgpr_write_b32 a95, v227
    v_accvgpr_read_b32 v224, a96
    v_accvgpr_read_b32 v225, a97
    v_accvgpr_read_b32 v226, a98
    v_accvgpr_read_b32 v227, a99
    v_mul_f32 v224, v224, v52
    v_mul_f32 v225, v225, v52
    v_mul_f32 v226, v226, v52
    v_mul_f32 v227, v227, v52
    v_accvgpr_write_b32 a96, v224
    v_accvgpr_write_b32 a97, v225
    v_accvgpr_write_b32 a98, v226
    v_accvgpr_write_b32 a99, v227
    v_accvgpr_read_b32 v224, a100
    v_accvgpr_read_b32 v225, a101
    v_accvgpr_read_b32 v226, a102
    v_accvgpr_read_b32 v227, a103
    v_mul_f32 v224, v224, v53
    v_mul_f32 v225, v225, v53
    v_mul_f32 v226, v226, v53
    v_mul_f32 v227, v227, v53
    v_accvgpr_write_b32 a100, v224
    v_accvgpr_write_b32 a101, v225
    v_accvgpr_write_b32 a102, v226
    v_accvgpr_write_b32 a103, v227
    v_accvgpr_read_b32 v224, a104
    v_accvgpr_read_b32 v225, a105
    v_accvgpr_read_b32 v226, a106
    v_accvgpr_read_b32 v227, a107
    v_mul_f32 v224, v224, v54
    v_mul_f32 v225, v225, v54
    v_mul_f32 v226, v226, v54
    v_mul_f32 v227, v227, v54
    v_accvgpr_write_b32 a104, v224
    v_accvgpr_write_b32 a105, v225
    v_accvgpr_write_b32 a106, v226
    v_accvgpr_write_b32 a107, v227
    v_accvgpr_read_b32 v224, a108
    v_accvgpr_read_b32 v225, a109
    v_accvgpr_read_b32 v226, a110
    v_accvgpr_read_b32 v227, a111
    v_mul_f32 v224, v224, v55
    v_mul_f32 v225, v225, v55
    v_mul_f32 v226, v226, v55
    v_mul_f32 v227, v227, v55
    v_accvgpr_write_b32 a108, v224
    v_accvgpr_write_b32 a109, v225
    v_accvgpr_write_b32 a110, v226
    v_accvgpr_write_b32 a111, v227
    v_accvgpr_read_b32 v224, a112
    v_accvgpr_read_b32 v225, a113
    v_accvgpr_read_b32 v226, a114
    v_accvgpr_read_b32 v227, a115
    v_mul_f32 v224, v224, v52
    v_mul_f32 v225, v225, v52
    v_mul_f32 v226, v226, v52
    v_mul_f32 v227, v227, v52
    v_accvgpr_write_b32 a112, v224
    v_accvgpr_write_b32 a113, v225
    v_accvgpr_write_b32 a114, v226
    v_accvgpr_write_b32 a115, v227
    v_accvgpr_read_b32 v224, a116
    v_accvgpr_read_b32 v225, a117
    v_accvgpr_read_b32 v226, a118
    v_accvgpr_read_b32 v227, a119
    v_mul_f32 v224, v224, v53
    v_mul_f32 v225, v225, v53
    v_mul_f32 v226, v226, v53
    v_mul_f32 v227, v227, v53
    v_accvgpr_write_b32 a116, v224
    v_accvgpr_write_b32 a117, v225
    v_accvgpr_write_b32 a118, v226
    v_accvgpr_write_b32 a119, v227
    v_accvgpr_read_b32 v224, a120
    v_accvgpr_read_b32 v225, a121
    v_accvgpr_read_b32 v226, a122
    v_accvgpr_read_b32 v227, a123
    v_mul_f32 v224, v224, v54
    v_mul_f32 v225, v225, v54
    v_mul_f32 v226, v226, v54
    v_mul_f32 v227, v227, v54
    v_accvgpr_write_b32 a120, v224
    v_accvgpr_write_b32 a121, v225
    v_accvgpr_write_b32 a122, v226
    v_accvgpr_write_b32 a123, v227
    v_accvgpr_read_b32 v224, a124
    v_accvgpr_read_b32 v225, a125
    v_accvgpr_read_b32 v226, a126
    v_accvgpr_read_b32 v227, a127
    v_mul_f32 v224, v224, v55
    v_mul_f32 v225, v225, v55
    v_mul_f32 v226, v226, v55
    v_mul_f32 v227, v227, v55
    v_accvgpr_write_b32 a124, v224
    v_accvgpr_write_b32 a125, v225
    v_accvgpr_write_b32 a126, v226
    v_accvgpr_write_b32 a127, v227
    v_exp_f32 v232, v160
    v_exp_f32 v233, v161
    v_exp_f32 v234, v162
    v_exp_f32 v235, v163
    v_add_f32 v48, v232, v233
    v_cvt_pk_bf16_f32 v208, v232, v233
    v_exp_f32 v236, v176
    v_exp_f32 v237, v177
    v_add_f32 v48, v48, v234
    v_add_f32 v48, v48, v235
    v_cvt_pk_bf16_f32 v209, v234, v235
    v_exp_f32 v238, v178
    v_exp_f32 v239, v179
    v_add_f32 v48, v48, v236
    v_add_f32 v48, v48, v237
    v_cvt_pk_bf16_f32 v210, v236, v237
    v_exp_f32 v240, v164
    v_exp_f32 v241, v165
    v_add_f32 v48, v48, v238
    v_add_f32 v48, v48, v239
    v_cvt_pk_bf16_f32 v211, v238, v239
    v_exp_f32 v242, v166
    v_exp_f32 v243, v167
    v_add_f32 v49, v240, v241
    v_cvt_pk_bf16_f32 v212, v240, v241
    v_exp_f32 v244, v180
    v_exp_f32 v245, v181
    v_add_f32 v49, v49, v242
    v_add_f32 v49, v49, v243
    v_cvt_pk_bf16_f32 v213, v242, v243
    v_exp_f32 v246, v182
    v_exp_f32 v247, v183
    v_add_f32 v49, v49, v244
    v_add_f32 v49, v49, v245
    v_cvt_pk_bf16_f32 v214, v244, v245
    v_exp_f32 v232, v168
    v_exp_f32 v233, v169
    v_add_f32 v49, v49, v246
    v_add_f32 v49, v49, v247
    v_cvt_pk_bf16_f32 v215, v246, v247
    v_exp_f32 v234, v170
    v_exp_f32 v235, v171
    v_add_f32 v50, v232, v233
    v_cvt_pk_bf16_f32 v216, v232, v233
    v_exp_f32 v236, v184
    v_exp_f32 v237, v185
    v_add_f32 v50, v50, v234
    v_add_f32 v50, v50, v235
    v_cvt_pk_bf16_f32 v217, v234, v235
    v_exp_f32 v238, v186
    v_exp_f32 v239, v187
    v_add_f32 v50, v50, v236
    v_add_f32 v50, v50, v237
    v_cvt_pk_bf16_f32 v218, v236, v237
    v_exp_f32 v240, v172
    v_exp_f32 v241, v173
    v_add_f32 v50, v50, v238
    v_add_f32 v50, v50, v239
    v_cvt_pk_bf16_f32 v219, v238, v239
    v_exp_f32 v242, v174
    v_exp_f32 v243, v175
    v_add_f32 v51, v240, v241
    v_cvt_pk_bf16_f32 v220, v240, v241
    v_exp_f32 v244, v188
    v_exp_f32 v245, v189
    v_add_f32 v51, v51, v242
    v_add_f32 v51, v51, v243
    v_cvt_pk_bf16_f32 v221, v242, v243
    v_exp_f32 v246, v190
    v_exp_f32 v247, v191
    v_add_f32 v51, v51, v244
    v_add_f32 v51, v51, v245
    v_cvt_pk_bf16_f32 v222, v244, v245
    s_nop 0
    v_add_f32 v51, v51, v246
    v_add_f32 v51, v51, v247
    v_cvt_pk_bf16_f32 v223, v246, v247
    s_nop 1
    s_branch k2_ret_61
k2_rare_64:
    s_nop 7
    v_max_f32 v54, v128, v129
    v_max3_f32 v54, v54, v130, v131
    v_max3_f32 v54, v54, v144, v145
    v_max3_f32 v54, v54, v146, v147
    v_max3_f32 v54, v54, v136, v137
    v_max3_f32 v54, v54, v138, v139
    v_max3_f32 v54, v54, v152, v153
    v_max3_f32 v54, v54, v154, v155
    v_mov_b32 v6, v54
    s_nop 1
    v_permlane16_swap_b32 v54, v6
    s_nop 1
    v_max_f32 v54, v54, v6
    v_mov_b32 v6, v54
    s_nop 1
    v_permlane32_swap_b32 v54, v6
    s_nop 1
    v_max_f32 v54, v54, v6
    v_max_f32 v54, 0, v54
    v_max_f32 v55, v132, v133
    v_max3_f32 v55, v55, v134, v135
    v_max3_f32 v55, v55, v148, v149
    v_max3_f32 v55, v55, v150, v151
    v_max3_f32 v55, v55, v140, v141
    v_max3_f32 v55, v55, v142, v143
    v_max3_f32 v55, v55, v156, v157
    v_max3_f32 v55, v55, v158, v159
    v_mov_b32 v6, v55
    s_nop 1
    v_permlane16_swap_b32 v55, v6
    s_nop 1
    v_max_f32 v55, v55, v6
    v_mov_b32 v6, v55
    s_nop 1
    v_permlane32_swap_b32 v55, v6
    s_nop 1
    v_max_f32 v55, v55, v6
    v_max_f32 v55, 0, v55
    v_sub_f32 v128, v128, v54
    v_sub_f32 v129, v129, v54
    v_sub_f32 v130, v130, v54
    v_sub_f32 v131, v131, v54
    v_sub_f32 v132, v132, v55
    v_sub_f32 v133, v133, v55
    v_sub_f32 v134, v134, v55
    v_sub_f32 v135, v135, v55
    v_sub_f32 v136, v136, v54
    v_sub_f32 v137, v137, v54
    v_sub_f32 v138, v138, v54
    v_sub_f32 v139, v139, v54
    v_sub_f32 v140, v140, v55
    v_sub_f32 v141, v141, v55
    v_sub_f32 v142, v142, v55
    v_sub_f32 v143, v143, v55
    v_sub_f32 v144, v144, v54
    v_sub_f32 v145, v145, v54
    v_sub_f32 v146, v146, v54
    v_sub_f32 v147, v147, v54
    v_sub_f32 v148, v148, v55
    v_sub_f32 v149, v149, v55
    v_sub_f32 v150, v150, v55
    v_sub_f32 v151, v151, v55
    v_sub_f32 v152, v152, v54
    v_sub_f32 v153, v153, v54
    v_sub_f32 v154, v154, v54
    v_sub_f32 v155, v155, v54
    v_sub_f32 v156, v156, v55
    v_sub_f32 v157, v157, v55
    v_sub_f32 v158, v158, v55
    v_sub_f32 v159, v159, v55
    v_sub_f32 v160, v160, v54
    v_sub_f32 v16, v16, v54
    v_sub_f32 v161, v161, v54
    v_sub_f32 v17, v17, v54
    v_sub_f32 v162, v162, v54
    v_sub_f32 v18, v18, v54
    v_sub_f32 v163, v163, v54
    v_sub_f32 v19, v19, v54
    v_sub_f32 v164, v164, v55
    v_sub_f32 v20, v20, v55
    v_sub_f32 v165, v165, v55
    v_sub_f32 v21, v21, v55
    v_sub_f32 v166, v166, v55
    v_sub_f32 v22, v22, v55
    v_sub_f32 v167, v167, v55
    v_sub_f32 v23, v23, v55
    v_sub_f32 v168, v168, v54
    v_sub_f32 v24, v24, v54
    v_sub_f32 v169, v169, v54
    v_sub_f32 v25, v25, v54
    v_sub_f32 v170, v170, v54
    v_sub_f32 v26, v26, v54
    v_sub_f32 v171, v171, v54
    v_sub_f32 v27, v27, v54
    v_sub_f32 v172, v172, v55
    v_sub_f32 v28, v28, v55
    v_sub_f32 v173, v173, v55
    v_sub_f32 v29, v29, v55
    v_sub_f32 v174, v174, v55
    v_sub_f32 v30, v30, v55
    v_sub_f32 v175, v175, v55
    v_sub_f32 v31, v31, v55
    v_sub_f32 v176, v176, v54
    v_sub_f32 v32, v32, v54
    v_sub_f32 v177, v177, v54
    v_sub_f32 v33, v33, v54
    v_sub_f32 v178, v178, v54
    v_sub_f32 v34, v34, v54
    v_sub_f32 v179, v179, v54
    v_sub_f32 v35, v35, v54
    v_sub_f32 v180, v180, v55
    v_sub_f32 v36, v36, v55
    v_sub_f32 v181, v181, v55
    v_sub_f32 v37, v37, v55
    v_sub_f32 v182, v182, v55
    v_sub_f32 v38, v38, v55
    v_sub_f32 v183, v183, v55
    v_sub_f32 v39, v39, v55
    v_sub_f32 v184, v184, v54
    v_sub_f32 v40, v40, v54
    v_sub_f32 v185, v185, v54
    v_sub_f32 v41, v41, v54
    v_sub_f32 v186, v186, v54
    v_sub_f32 v42, v42, v54
    v_sub_f32 v187, v187, v54
    v_sub_f32 v43, v43, v54
    v_sub_f32 v188, v188, v55
    v_sub_f32 v44, v44, v55
    v_sub_f32 v189, v189, v55
    v_sub_f32 v45, v45, v55
    v_sub_f32 v190, v190, v55
    v_sub_f32 v46, v46, v55
    v_sub_f32 v191, v191, v55
    v_sub_f32 v47, v47, v55
    v_sub_f32 v10, v10, v54
    v_exp_f32 v54, -v54
    v_sub_f32 v11, v11, v55
    v_exp_f32 v55, -v55
    s_nop 0
    v_mul_f32 v14, v14, v54
    v_mul_f32 v15, v15, v55
    v_accvgpr_read_b32 v224, a8
    v_accvgpr_read_b32 v225, a9
    v_accvgpr_read_b32 v226, a10
    v_accvgpr_read_b32 v227, a11
    v_mul_f32 v224, v224, v54
    v_mul_f32 v225, v225, v54
    v_mul_f32 v226, v226, v54
    v_mul_f32 v227, v227, v54
    v_accvgpr_write_b32 a8, v224
    v_accvgpr_write_b32 a9, v225
    v_accvgpr_write_b32 a10, v226
    v_accvgpr_write_b32 a11, v227
    v_accvgpr_read_b32 v224, a12
    v_accvgpr_read_b32 v225, a13
    v_accvgpr_read_b32 v226, a14
    v_accvgpr_read_b32 v227, a15
    v_mul_f32 v224, v224, v55
    v_mul_f32 v225, v225, v55
    v_mul_f32 v226, v226, v55
    v_mul_f32 v227, v227, v55
    v_accvgpr_write_b32 a12, v224
    v_accvgpr_write_b32 a13, v225
    v_accvgpr_write_b32 a14, v226
    v_accvgpr_write_b32 a15, v227
    v_accvgpr_read_b32 v224, a24
    v_accvgpr_read_b32 v225, a25
    v_accvgpr_read_b32 v226, a26
    v_accvgpr_read_b32 v227, a27
    v_mul_f32 v224, v224, v54
    v_mul_f32 v225, v225, v54
    v_mul_f32 v226, v226, v54
    v_mul_f32 v227, v227, v54
    v_accvgpr_write_b32 a24, v224
    v_accvgpr_write_b32 a25, v225
    v_accvgpr_write_b32 a26, v226
    v_accvgpr_write_b32 a27, v227
    v_accvgpr_read_b32 v224, a28
    v_accvgpr_read_b32 v225, a29
    v_accvgpr_read_b32 v226, a30
    v_accvgpr_read_b32 v227, a31
    v_mul_f32 v224, v224, v55
    v_mul_f32 v225, v225, v55
    v_mul_f32 v226, v226, v55
    v_mul_f32 v227, v227, v55
    v_accvgpr_write_b32 a28, v224
    v_accvgpr_write_b32 a29, v225
    v_accvgpr_write_b32 a30, v226
    v_accvgpr_write_b32 a31, v227
    v_accvgpr_read_b32 v224, a40
    v_accvgpr_read_b32 v225, a41
    v_accvgpr_read_b32 v226, a42
    v_accvgpr_read_b32 v227, a43
    v_mul_f32 v224, v224, v54
    v_mul_f32 v225, v225, v54
    v_mul_f32 v226, v226, v54
    v_mul_f32 v227, v227, v54
    v_accvgpr_write_b32 a40, v224
    v_accvgpr_write_b32 a41, v225
    v_accvgpr_write_b32 a42, v226
    v_accvgpr_write_b32 a43, v227
    v_accvgpr_read_b32 v224, a44
    v_accvgpr_read_b32 v225, a45
    v_accvgpr_read_b32 v226, a46
    v_accvgpr_read_b32 v227, a47
    v_mul_f32 v224, v224, v55
    v_mul_f32 v225, v225, v55
    v_mul_f32 v226, v226, v55
    v_mul_f32 v227, v227, v55
    v_accvgpr_write_b32 a44, v224
    v_accvgpr_write_b32 a45, v225
    v_accvgpr_write_b32 a46, v226
    v_accvgpr_write_b32 a47, v227
    v_accvgpr_read_b32 v224, a56
    v_accvgpr_read_b32 v225, a57
    v_accvgpr_read_b32 v226, a58
    v_accvgpr_read_b32 v227, a59
    v_mul_f32 v224, v224, v54
    v_mul_f32 v225, v225, v54
    v_mul_f32 v226, v226, v54
    v_mul_f32 v227, v227, v54
    v_accvgpr_write_b32 a56, v224
    v_accvgpr_write_b32 a57, v225
    v_accvgpr_write_b32 a58, v226
    v_accvgpr_write_b32 a59, v227
    v_accvgpr_read_b32 v224, a60
    v_accvgpr_read_b32 v225, a61
    v_accvgpr_read_b32 v226, a62
    v_accvgpr_read_b32 v227, a63
    v_mul_f32 v224, v224, v55
    v_mul_f32 v225, v225, v55
    v_mul_f32 v226, v226, v55
    v_mul_f32 v227, v227, v55
    v_accvgpr_write_b32 a60, v224
    v_accvgpr_write_b32 a61, v225
    v_accvgpr_write_b32 a62, v226
    v_accvgpr_write_b32 a63, v227
    v_accvgpr_read_b32 v224, a72
    v_accvgpr_read_b32 v225, a73
    v_accvgpr_read_b32 v226, a74
    v_accvgpr_read_b32 v227, a75
    v_mul_f32 v224, v224, v54
    v_mul_f32 v225, v225, v54
    v_mul_f32 v226, v226, v54
    v_mul_f32 v227, v227, v54
    v_accvgpr_write_b32 a72, v224
    v_accvgpr_write_b32 a73, v225
    v_accvgpr_write_b32 a74, v226
    v_accvgpr_write_b32 a75, v227
    v_accvgpr_read_b32 v224, a76
    v_accvgpr_read_b32 v225, a77
    v_accvgpr_read_b32 v226, a78
    v_accvgpr_read_b32 v227, a79
    v_mul_f32 v224, v224, v55
    v_mul_f32 v225, v225, v55
    v_mul_f32 v226, v226, v55
    v_mul_f32 v227, v227, v55
    v_accvgpr_write_b32 a76, v224
    v_accvgpr_write_b32 a77, v225
    v_accvgpr_write_b32 a78, v226
    v_accvgpr_write_b32 a79, v227
    v_accvgpr_read_b32 v224, a88
    v_accvgpr_read_b32 v225, a89
    v_accvgpr_read_b32 v226, a90
    v_accvgpr_read_b32 v227, a91
    v_mul_f32 v224, v224, v54
    v_mul_f32 v225, v225, v54
    v_mul_f32 v226, v226, v54
    v_mul_f32 v227, v227, v54
    v_accvgpr_write_b32 a88, v224
    v_accvgpr_write_b32 a89, v225
    v_accvgpr_write_b32 a90, v226
    v_accvgpr_write_b32 a91, v227
    v_accvgpr_read_b32 v224, a92
    v_accvgpr_read_b32 v225, a93
    v_accvgpr_read_b32 v226, a94
    v_accvgpr_read_b32 v227, a95
    v_mul_f32 v224, v224, v55
    v_mul_f32 v225, v225, v55
    v_mul_f32 v226, v226, v55
    v_mul_f32 v227, v227, v55
    v_accvgpr_write_b32 a92, v224
    v_accvgpr_write_b32 a93, v225
    v_accvgpr_write_b32 a94, v226
    v_accvgpr_write_b32 a95, v227
    v_accvgpr_read_b32 v224, a104
    v_accvgpr_read_b32 v225, a105
    v_accvgpr_read_b32 v226, a106
    v_accvgpr_read_b32 v227, a107
    v_mul_f32 v224, v224, v54
    v_mul_f32 v225, v225, v54
    v_mul_f32 v226, v226, v54
    v_mul_f32 v227, v227, v54
    v_accvgpr_write_b32 a104, v224
    v_accvgpr_write_b32 a105, v225
    v_accvgpr_write_b32 a106, v226
    v_accvgpr_write_b32 a107, v227
    v_accvgpr_read_b32 v224, a108
    v_accvgpr_read_b32 v225, a109
    v_accvgpr_read_b32 v226, a110
    v_accvgpr_read_b32 v227, a111
    v_mul_f32 v224, v224, v55
    v_mul_f32 v225, v225, v55
    v_mul_f32 v226, v226, v55
    v_mul_f32 v227, v227, v55
    v_accvgpr_write_b32 a108, v224
    v_accvgpr_write_b32 a109, v225
    v_accvgpr_write_b32 a110, v226
    v_accvgpr_write_b32 a111, v227
    v_accvgpr_read_b32 v224, a120
    v_accvgpr_read_b32 v225, a121
    v_accvgpr_read_b32 v226, a122
    v_accvgpr_read_b32 v227, a123
    v_mul_f32 v224, v224, v54
    v_mul_f32 v225, v225, v54
    v_mul_f32 v226, v226, v54
    v_mul_f32 v227, v227, v54
    v_accvgpr_write_b32 a120, v224
    v_accvgpr_write_b32 a121, v225
    v_accvgpr_write_b32 a122, v226
    v_accvgpr_write_b32 a123, v227
    v_accvgpr_read_b32 v224, a124
    v_accvgpr_read_b32 v225, a125
    v_accvgpr_read_b32 v226, a126
    v_accvgpr_read_b32 v227, a127
    v_mul_f32 v224, v224, v55
    v_mul_f32 v225, v225, v55
    v_mul_f32 v226, v226, v55
    v_mul_f32 v227, v227, v55
    v_accvgpr_write_b32 a124, v224
    v_accvgpr_write_b32 a125, v225
    v_accvgpr_write_b32 a126, v226
    v_accvgpr_write_b32 a127, v227
    v_exp_f32 v232, v128
    v_exp_f32 v233, v129
    v_exp_f32 v234, v130
    v_exp_f32 v235, v131
    v_add_f32 v48, v232, v233
    v_cvt_pk_bf16_f32 v192, v232, v233
    v_exp_f32 v236, v144
    v_exp_f32 v237, v145
    v_add_f32 v48, v48, v234
    v_add_f32 v48, v48, v235
    v_cvt_pk_bf16_f32 v193, v234, v235
    v_exp_f32 v238, v146
    v_exp_f32 v239, v147
    v_add_f32 v48, v48, v236
    v_add_f32 v48, v48, v237
    v_cvt_pk_bf16_f32 v194, v236, v237
    v_exp_f32 v240, v132
    v_exp_f32 v241, v133
    v_add_f32 v48, v48, v238
    v_add_f32 v48, v48, v239
    v_cvt_pk_bf16_f32 v195, v238, v239
    v_exp_f32 v242, v134
    v_exp_f32 v243, v135
    v_add_f32 v49, v240, v241
    v_cvt_pk_bf16_f32 v196, v240, v241
    v_exp_f32 v244, v148
    v_exp_f32 v245, v149
    v_add_f32 v49, v49, v242
    v_add_f32 v49, v49, v243
    v_cvt_pk_bf16_f32 v197, v242, v243
    v_exp_f32 v246, v150
    v_exp_f32 v247, v151
    v_add_f32 v49, v49, v244
    v_add_f32 v49, v49, v245
    v_cvt_pk_bf16_f32 v198, v244, v245
    v_exp_f32 v232, v136
    v_exp_f32 v233, v137
    v_add_f32 v49, v49, v246
    v_add_f32 v49, v49, v247
    v_cvt_pk_bf16_f32 v199, v246, v247
    v_exp_f32 v234, v138
    v_exp_f32 v235, v139
    v_add_f32 v50, v232, v233
    v_cvt_pk_bf16_f32 v200, v232, v233
    v_exp_f32 v236, v152
    v_exp_f32 v237, v153
    v_add_f32 v50, v50, v234
    v_add_f32 v50, v50, v235
    v_cvt_pk_bf16_f32 v201, v234, v235
    v_exp_f32 v238, v154
    v_exp_f32 v239, v155
    v_add_f32 v50, v50, v236
    v_add_f32 v50, v50, v237
    v_cvt_pk_bf16_f32 v202, v236, v237
    v_exp_f32 v240, v140
    v_exp_f32 v241, v141
    v_add_f32 v50, v50, v238
    v_add_f32 v50, v50, v239
    v_cvt_pk_bf16_f32 v203, v238, v239
    v_exp_f32 v242, v142
    v_exp_f32 v243, v143
    v_add_f32 v51, v240, v241
    v_cvt_pk_bf16_f32 v204, v240, v241
    v_exp_f32 v244, v156
    v_exp_f32 v245, v157
    v_add_f32 v51, v51, v242
    v_add_f32 v51, v51, v243
    v_cvt_pk_bf16_f32 v205, v242, v243
    v_exp_f32 v246, v158
    v_exp_f32 v247, v159
    v_add_f32 v51, v51, v244
    v_add_f32 v51, v51, v245
    v_cvt_pk_bf16_f32 v206, v244, v245
    s_nop 0
    v_add_f32 v51, v51, v246
    v_add_f32 v51, v51, v247
    v_cvt_pk_bf16_f32 v207, v246, v247
    s_nop 1
    s_branch k2_ret_65
k2_rare_70:
    s_nop 7
    v_max_f32 v54, v160, v161
    v_max3_f32 v54, v54, v162, v163
    v_max3_f32 v54, v54, v176, v177
    v_max3_f32 v54, v54, v178, v179
    v_max3_f32 v54, v54, v168, v169
    v_max3_f32 v54, v54, v170, v171
    v_max3_f32 v54, v54, v184, v185
    v_max3_f32 v54, v54, v186, v187
    v_mov_b32 v6, v54
    s_nop 1
    v_permlane16_swap_b32 v54, v6
    s_nop 1
    v_max_f32 v54, v54, v6
    v_mov_b32 v6, v54
    s_nop 1
    v_permlane32_swap_b32 v54, v6
    s_nop 1
    v_max_f32 v54, v54, v6
    v_max_f32 v54, 0, v54
    v_max_f32 v55, v164, v165
    v_max3_f32 v55, v55, v166, v167
    v_max3_f32 v55, v55, v180, v181
    v_max3_f32 v55, v55, v182, v183
    v_max3_f32 v55, v55, v172, v173
    v_max3_f32 v55, v55, v174, v175
    v_max3_f32 v55, v55, v188, v189
    v_max3_f32 v55, v55, v190, v191
    v_mov_b32 v6, v55
    s_nop 1
    v_permlane16_swap_b32 v55, v6
    s_nop 1
    v_max_f32 v55, v55, v6
    v_mov_b32 v6, v55
    s_nop 1
    v_permlane32_swap_b32 v55, v6
    s_nop 1
    v_max_f32 v55, v55, v6
    v_max_f32 v55, 0, v55
    v_sub_f32 v160, v160, v54
    v_sub_f32 v161, v161, v54
    v_sub_f32 v162, v162, v54
    v_sub_f32 v163, v163, v54
    v_sub_f32 v164, v164, v55
    v_sub_f32 v165, v165, v55
    v_sub_f32 v166, v166, v55
    v_sub_f32 v167, v167, v55
    v_sub_f32 v168, v168, v54
    v_sub_f32 v169, v169, v54
    v_sub_f32 v170, v170, v54
    v_sub_f32 v171, v171, v54
    v_sub_f32 v172, v172, v55
    v_sub_f32 v173, v173, v55
    v_sub_f32 v174, v174, v55
    v_sub_f32 v175, v175, v55
    v_sub_f32 v176, v176, v54
    v_sub_f32 v177, v177, v54
    v_sub_f32 v178, v178, v54
    v_sub_f32 v179, v179, v54
    v_sub_f32 v180, v180, v55
    v_sub_f32 v181, v181, v55
    v_sub_f32 v182, v182, v55
    v_sub_f32 v183, v183, v55
    v_sub_f32 v184, v184, v54
    v_sub_f32 v185, v185, v54
    v_sub_f32 v186, v186, v54
    v_sub_f32 v187, v187, v54
    v_sub_f32 v188, v188, v55
    v_sub_f32 v189, v189, v55
    v_sub_f32 v190, v190, v55
    v_sub_f32 v191, v191, v55
    v_sub_f32 v128, v128, v54
    v_sub_f32 v16, v16, v54
    v_sub_f32 v129, v129, v54
    v_sub_f32 v17, v17, v54
    v_sub_f32 v130, v130, v54
    v_sub_f32 v18, v18, v54
    v_sub_f32 v131, v131, v54
    v_sub_f32 v19, v19, v54
    v_sub_f32 v132, v132, v55
    v_sub_f32 v20, v20, v55
    v_sub_f32 v133, v133, v55
    v_sub_f32 v21, v21, v55
    v_sub_f32 v134, v134, v55
    v_sub_f32 v22, v22, v55
    v_sub_f32 v135, v135, v55
    v_sub_f32 v23, v23, v55
    v_sub_f32 v136, v136, v54
    v_sub_f32 v24, v24, v54
    v_sub_f32 v137, v137, v54
    v_sub_f32 v25, v25, v54
    v_sub_f32 v138, v138, v54
    v_sub_f32 v26, v26, v54
    v_sub_f32 v139, v139, v54
    v_sub_f32 v27, v27, v54
    v_sub_f32 v140, v140, v55
    v_sub_f32 v28, v28, v55
    v_sub_f32 v141, v141, v55
    v_sub_f32 v29, v29, v55
    v_sub_f32 v142, v142, v55
    v_sub_f32 v30, v30, v55
    v_sub_f32 v143, v143, v55
    v_sub_f32 v31, v31, v55
    v_sub_f32 v144, v144, v54
    v_sub_f32 v32, v32, v54
    v_sub_f32 v145, v145, v54
    v_sub_f32 v33, v33, v54
    v_sub_f32 v146, v146, v54
    v_sub_f32 v34, v34, v54
    v_sub_f32 v147, v147, v54
    v_sub_f32 v35, v35, v54
    v_sub_f32 v148, v148, v55
    v_sub_f32 v36, v36, v55
    v_sub_f32 v149, v149, v55
    v_sub_f32 v37, v37, v55
    v_sub_f32 v150, v150, v55
    v_sub_f32 v38, v38, v55
    v_sub_f32 v151, v151, v55
    v_sub_f32 v39, v39, v55
    v_sub_f32 v152, v152, v54
    v_sub_f32 v40, v40, v54
    v_sub_f32 v153, v153, v54
    v_sub_f32 v41, v41, v54
    v_sub_f32 v154, v154, v54
    v_sub_f32 v42, v42, v54
    v_sub_f32 v155, v155, v54
    v_sub_f32 v43, v43, v54
    v_sub_f32 v156, v156, v55
    v_sub_f32 v44, v44, v55
    v_sub_f32 v157, v157, v55
    v_sub_f32 v45, v45, v55
    v_sub_f32 v158, v158, v55
    v_sub_f32 v46, v46, v55
    v_sub_f32 v159, v159, v55
    v_sub_f32 v47, v47, v55
    v_sub_f32 v10, v10, v54
    v_exp_f32 v54, -v54
    v_sub_f32 v11, v11, v55
    v_exp_f32 v55, -v55
    s_nop 0
    v_mul_f32 v14, v14, v54
    v_mul_f32 v15, v15, v55
    v_accvgpr_read_b32 v224, a8
    v_accvgpr_read_b32 v225, a9
    v_accvgpr_read_b32 v226, a10
    v_accvgpr_read_b32 v227, a11
    v_mul_f32 v224, v224, v54
    v_mul_f32 v225, v225, v54
    v_mul_f32 v226, v226, v54
    v_mul_f32 v227, v227, v54
    v_accvgpr_write_b32 a8, v224
    v_accvgpr_write_b32 a9, v225
    v_accvgpr_write_b32 a10, v226
    v_accvgpr_write_b32 a11, v227
    v_accvgpr_read_b32 v224, a12
    v_accvgpr_read_b32 v225, a13
    v_accvgpr_read_b32 v226, a14
    v_accvgpr_read_b32 v227, a15
    v_mul_f32 v224, v224, v55
    v_mul_f32 v225, v225, v55
    v_mul_f32 v226, v226, v55
    v_mul_f32 v227, v227, v55
    v_accvgpr_write_b32 a12, v224
    v_accvgpr_write_b32 a13, v225
    v_accvgpr_write_b32 a14, v226
    v_accvgpr_write_b32 a15, v227
    v_accvgpr_read_b32 v224, a24
    v_accvgpr_read_b32 v225, a25
    v_accvgpr_read_b32 v226, a26
    v_accvgpr_read_b32 v227, a27
    v_mul_f32 v224, v224, v54
    v_mul_f32 v225, v225, v54
    v_mul_f32 v226, v226, v54
    v_mul_f32 v227, v227, v54
    v_accvgpr_write_b32 a24, v224
    v_accvgpr_write_b32 a25, v225
    v_accvgpr_write_b32 a26, v226
    v_accvgpr_write_b32 a27, v227
    v_accvgpr_read_b32 v224, a28
    v_accvgpr_read_b32 v225, a29
    v_accvgpr_read_b32 v226, a30
    v_accvgpr_read_b32 v227, a31
    v_mul_f32 v224, v224, v55
    v_mul_f32 v225, v225, v55
    v_mul_f32 v226, v226, v55
    v_mul_f32 v227, v227, v55
    v_accvgpr_write_b32 a28, v224
    v_accvgpr_write_b32 a29, v225
    v_accvgpr_write_b32 a30, v226
    v_accvgpr_write_b32 a31, v227
    v_accvgpr_read_b32 v224, a40
    v_accvgpr_read_b32 v225, a41
    v_accvgpr_read_b32 v226, a42
    v_accvgpr_read_b32 v227, a43
    v_mul_f32 v224, v224, v54
    v_mul_f32 v225, v225, v54
    v_mul_f32 v226, v226, v54
    v_mul_f32 v227, v227, v54
    v_accvgpr_write_b32 a40, v224
    v_accvgpr_write_b32 a41, v225
    v_accvgpr_write_b32 a42, v226
    v_accvgpr_write_b32 a43, v227
    v_accvgpr_read_b32 v224, a44
    v_accvgpr_read_b32 v225, a45
    v_accvgpr_read_b32 v226, a46
    v_accvgpr_read_b32 v227, a47
    v_mul_f32 v224, v224, v55
    v_mul_f32 v225, v225, v55
    v_mul_f32 v226, v226, v55
    v_mul_f32 v227, v227, v55
    v_accvgpr_write_b32 a44, v224
    v_accvgpr_write_b32 a45, v225
    v_accvgpr_write_b32 a46, v226
    v_accvgpr_write_b32 a47, v227
    v_accvgpr_read_b32 v224, a56
    v_accvgpr_read_b32 v225, a57
    v_accvgpr_read_b32 v226, a58
    v_accvgpr_read_b32 v227, a59
    v_mul_f32 v224, v224, v54
    v_mul_f32 v225, v225, v54
    v_mul_f32 v226, v226, v54
    v_mul_f32 v227, v227, v54
    v_accvgpr_write_b32 a56, v224
    v_accvgpr_write_b32 a57, v225
    v_accvgpr_write_b32 a58, v226
    v_accvgpr_write_b32 a59, v227
    v_accvgpr_read_b32 v224, a60
    v_accvgpr_read_b32 v225, a61
    v_accvgpr_read_b32 v226, a62
    v_accvgpr_read_b32 v227, a63
    v_mul_f32 v224, v224, v55
    v_mul_f32 v225, v225, v55
    v_mul_f32 v226, v226, v55
    v_mul_f32 v227, v227, v55
    v_accvgpr_write_b32 a60, v224
    v_accvgpr_write_b32 a61, v225
    v_accvgpr_write_b32 a62, v226
    v_accvgpr_write_b32 a63, v227
    v_accvgpr_read_b32 v224, a72
    v_accvgpr_read_b32 v225, a73
    v_accvgpr_read_b32 v226, a74
    v_accvgpr_read_b32 v227, a75
    v_mul_f32 v224, v224, v54
    v_mul_f32 v225, v225, v54
    v_mul_f32 v226, v226, v54
    v_mul_f32 v227, v227, v54
    v_accvgpr_write_b32 a72, v224
    v_accvgpr_write_b32 a73, v225
    v_accvgpr_write_b32 a74, v226
    v_accvgpr_write_b32 a75, v227
    v_accvgpr_read_b32 v224, a76
    v_accvgpr_read_b32 v225, a77
    v_accvgpr_read_b32 v226, a78
    v_accvgpr_read_b32 v227, a79
    v_mul_f32 v224, v224, v55
    v_mul_f32 v225, v225, v55
    v_mul_f32 v226, v226, v55
    v_mul_f32 v227, v227, v55
    v_accvgpr_write_b32 a76, v224
    v_accvgpr_write_b32 a77, v225
    v_accvgpr_write_b32 a78, v226
    v_accvgpr_write_b32 a79, v227
    v_accvgpr_read_b32 v224, a88
    v_accvgpr_read_b32 v225, a89
    v_accvgpr_read_b32 v226, a90
    v_accvgpr_read_b32 v227, a91
    v_mul_f32 v224, v224, v54
    v_mul_f32 v225, v225, v54
    v_mul_f32 v226, v226, v54
    v_mul_f32 v227, v227, v54
    v_accvgpr_write_b32 a88, v224
    v_accvgpr_write_b32 a89, v225
    v_accvgpr_write_b32 a90, v226
    v_accvgpr_write_b32 a91, v227
    v_accvgpr_read_b32 v224, a92
    v_accvgpr_read_b32 v225, a93
    v_accvgpr_read_b32 v226, a94
    v_accvgpr_read_b32 v227, a95
    v_mul_f32 v224, v224, v55
    v_mul_f32 v225, v225, v55
    v_mul_f32 v226, v226, v55
    v_mul_f32 v227, v227, v55
    v_accvgpr_write_b32 a92, v224
    v_accvgpr_write_b32 a93, v225
    v_accvgpr_write_b32 a94, v226
    v_accvgpr_write_b32 a95, v227
    v_accvgpr_read_b32 v224, a104
    v_accvgpr_read_b32 v225, a105
    v_accvgpr_read_b32 v226, a106
    v_accvgpr_read_b32 v227, a107
    v_mul_f32 v224, v224, v54
    v_mul_f32 v225, v225, v54
    v_mul_f32 v226, v226, v54
    v_mul_f32 v227, v227, v54
    v_accvgpr_write_b32 a104, v224
    v_accvgpr_write_b32 a105, v225
    v_accvgpr_write_b32 a106, v226
    v_accvgpr_write_b32 a107, v227
    v_accvgpr_read_b32 v224, a108
    v_accvgpr_read_b32 v225, a109
    v_accvgpr_read_b32 v226, a110
    v_accvgpr_read_b32 v227, a111
    v_mul_f32 v224, v224, v55
    v_mul_f32 v225, v225, v55
    v_mul_f32 v226, v226, v55
    v_mul_f32 v227, v227, v55
    v_accvgpr_write_b32 a108, v224
    v_accvgpr_write_b32 a109, v225
    v_accvgpr_write_b32 a110, v226
    v_accvgpr_write_b32 a111, v227
    v_accvgpr_read_b32 v224, a120
    v_accvgpr_read_b32 v225, a121
    v_accvgpr_read_b32 v226, a122
    v_accvgpr_read_b32 v227, a123
    v_mul_f32 v224, v224, v54
    v_mul_f32 v225, v225, v54
    v_mul_f32 v226, v226, v54
    v_mul_f32 v227, v227, v54
    v_accvgpr_write_b32 a120, v224
    v_accvgpr_write_b32 a121, v225
    v_accvgpr_write_b32 a122, v226
    v_accvgpr_write_b32 a123, v227
    v_accvgpr_read_b32 v224, a124
    v_accvgpr_read_b32 v225, a125
    v_accvgpr_read_b32 v226, a126
    v_accvgpr_read_b32 v227, a127
    v_mul_f32 v224, v224, v55
    v_mul_f32 v225, v225, v55
    v_mul_f32 v226, v226, v55
    v_mul_f32 v227, v227, v55
    v_accvgpr_write_b32 a124, v224
    v_accvgpr_write_b32 a125, v225
    v_accvgpr_write_b32 a126, v226
    v_accvgpr_write_b32 a127, v227
    v_exp_f32 v232, v160
    v_exp_f32 v233, v161
    v_exp_f32 v234, v162
    v_exp_f32 v235, v163
    v_add_f32 v48, v232, v233
    v_cvt_pk_bf16_f32 v208, v232, v233
    v_exp_f32 v236, v176
    v_exp_f32 v237, v177
    v_add_f32 v48, v48, v234
    v_add_f32 v48, v48, v235
    v_cvt_pk_bf16_f32 v209, v234, v235
    v_exp_f32 v238, v178
    v_exp_f32 v239, v179
    v_add_f32 v48, v48, v236
    v_add_f32 v48, v48, v237
    v_cvt_pk_bf16_f32 v210, v236, v237
    v_exp_f32 v240, v164
    v_exp_f32 v241, v165
    v_add_f32 v48, v48, v238
    v_add_f32 v48, v48, v239
    v_cvt_pk_bf16_f32 v211, v238, v239
    v_exp_f32 v242, v166
    v_exp_f32 v243, v167
    v_add_f32 v49, v240, v241
    v_cvt_pk_bf16_f32 v212, v240, v241
    v_exp_f32 v244, v180
    v_exp_f32 v245, v181
    v_add_f32 v49, v49, v242
    v_add_f32 v49, v49, v243
    v_cvt_pk_bf16_f32 v213, v242, v243
    v_exp_f32 v246, v182
    v_exp_f32 v247, v183
    v_add_f32 v49, v49, v244
    v_add_f32 v49, v49, v245
    v_cvt_pk_bf16_f32 v214, v244, v245
    v_exp_f32 v232, v168
    v_exp_f32 v233, v169
    v_add_f32 v49, v49, v246
    v_add_f32 v49, v49, v247
    v_cvt_pk_bf16_f32 v215, v246, v247
    v_exp_f32 v234, v170
    v_exp_f32 v235, v171
    v_add_f32 v50, v232, v233
    v_cvt_pk_bf16_f32 v216, v232, v233
    v_exp_f32 v236, v184
    v_exp_f32 v237, v185
    v_add_f32 v50, v50, v234
    v_add_f32 v50, v50, v235
    v_cvt_pk_bf16_f32 v217, v234, v235
    v_exp_f32 v238, v186
    v_exp_f32 v239, v187
    v_add_f32 v50, v50, v236
    v_add_f32 v50, v50, v237
    v_cvt_pk_bf16_f32 v218, v236, v237
    v_exp_f32 v240, v172
    v_exp_f32 v241, v173
    v_add_f32 v50, v50, v238
    v_add_f32 v50, v50, v239
    v_cvt_pk_bf16_f32 v219, v238, v239
    v_exp_f32 v242, v174
    v_exp_f32 v243, v175
    v_add_f32 v51, v240, v241
    v_cvt_pk_bf16_f32 v220, v240, v241
    v_exp_f32 v244, v188
    v_exp_f32 v245, v189
    v_add_f32 v51, v51, v242
    v_add_f32 v51, v51, v243
    v_cvt_pk_bf16_f32 v221, v242, v243
    v_exp_f32 v246, v190
    v_exp_f32 v247, v191
    v_add_f32 v51, v51, v244
    v_add_f32 v51, v51, v245
    v_cvt_pk_bf16_f32 v222, v244, v245
    s_nop 0
    v_add_f32 v51, v51, v246
    v_add_f32 v51, v51, v247
    v_cvt_pk_bf16_f32 v223, v246, v247
    s_nop 1
    s_branch k2_ret_71
k2_rare_74:
    s_nop 7
    v_max_f32 v54, v128, v129
    v_max3_f32 v54, v54, v130, v131
    v_max3_f32 v54, v54, v144, v145
    v_max3_f32 v54, v54, v146, v147
    v_max3_f32 v54, v54, v136, v137
    v_max3_f32 v54, v54, v138, v139
    v_max3_f32 v54, v54, v152, v153
    v_max3_f32 v54, v54, v154, v155
    v_mov_b32 v6, v54
    s_nop 1
    v_permlane16_swap_b32 v54, v6
    s_nop 1
    v_max_f32 v54, v54, v6
    v_mov_b32 v6, v54
    s_nop 1
    v_permlane32_swap_b32 v54, v6
    s_nop 1
    v_max_f32 v54, v54, v6
    v_max_f32 v54, 0, v54
    v_max_f32 v55, v132, v133
    v_max3_f32 v55, v55, v134, v135
    v_max3_f32 v55, v55, v148, v149
    v_max3_f32 v55, v55, v150, v151
    v_max3_f32 v55, v55, v140, v141
    v_max3_f32 v55, v55, v142, v143
    v_max3_f32 v55, v55, v156, v157
    v_max3_f32 v55, v55, v158, v159
    v_mov_b32 v6, v55
    s_nop 1
    v_permlane16_swap_b32 v55, v6
    s_nop 1
    v_max_f32 v55, v55, v6
    v_mov_b32 v6, v55
    s_nop 1
    v_permlane32_swap_b32 v55, v6
    s_nop 1
    v_max_f32 v55, v55, v6
    v_max_f32 v55, 0, v55
    v_sub_f32 v128, v128, v54
    v_sub_f32 v129, v129, v54
    v_sub_f32 v130, v130, v54
    v_sub_f32 v131, v131, v54
    v_sub_f32 v132, v132, v55
    v_sub_f32 v133, v133, v55
    v_sub_f32 v134, v134, v55
    v_sub_f32 v135, v135, v55
    v_sub_f32 v136, v136, v54
    v_sub_f32 v137, v137, v54
    v_sub_f32 v138, v138, v54
    v_sub_f32 v139, v139, v54
    v_sub_f32 v140, v140, v55
    v_sub_f32 v141, v141, v55
    v_sub_f32 v142, v142, v55
    v_sub_f32 v143, v143, v55
    v_sub_f32 v144, v144, v54
    v_sub_f32 v145, v145, v54
    v_sub_f32 v146, v146, v54
    v_sub_f32 v147, v147, v54
    v_sub_f32 v148, v148, v55
    v_sub_f32 v149, v149, v55
    v_sub_f32 v150, v150, v55
    v_sub_f32 v151, v151, v55
    v_sub_f32 v152, v152, v54
    v_sub_f32 v153, v153, v54
    v_sub_f32 v154, v154, v54
    v_sub_f32 v155, v155, v54
    v_sub_f32 v156, v156, v55
    v_sub_f32 v157, v157, v55
    v_sub_f32 v158, v158, v55
    v_sub_f32 v159, v159, v55
    v_sub_f32 v160, v160, v54
    v_sub_f32 v16, v16, v54
    v_sub_f32 v161, v161, v54
    v_sub_f32 v17, v17, v54
    v_sub_f32 v162, v162, v54
    v_sub_f32 v18, v18, v54
    v_sub_f32 v163, v163, v54
    v_sub_f32 v19, v19, v54
    v_sub_f32 v164, v164, v55
    v_sub_f32 v20, v20, v55
    v_sub_f32 v165, v165, v55
    v_sub_f32 v21, v21, v55
    v_sub_f32 v166, v166, v55
    v_sub_f32 v22, v22, v55
    v_sub_f32 v167, v167, v55
    v_sub_f32 v23, v23, v55
    v_sub_f32 v168, v168, v54
    v_sub_f32 v24, v24, v54
    v_sub_f32 v169, v169, v54
    v_sub_f32 v25, v25, v54
    v_sub_f32 v170, v170, v54
    v_sub_f32 v26, v26, v54
    v_sub_f32 v171, v171, v54
    v_sub_f32 v27, v27, v54
    v_sub_f32 v172, v172, v55
    v_sub_f32 v28, v28, v55
    v_sub_f32 v173, v173, v55
    v_sub_f32 v29, v29, v55
    v_sub_f32 v174, v174, v55
    v_sub_f32 v30, v30, v55
    v_sub_f32 v175, v175, v55
    v_sub_f32 v31, v31, v55
    v_sub_f32 v176, v176, v54
    v_sub_f32 v32, v32, v54
    v_sub_f32 v177, v177, v54
    v_sub_f32 v33, v33, v54
    v_sub_f32 v178, v178, v54
    v_sub_f32 v34, v34, v54
    v_sub_f32 v179, v179, v54
    v_sub_f32 v35, v35, v54
    v_sub_f32 v180, v180, v55
    v_sub_f32 v36, v36, v55
    v_sub_f32 v181, v181, v55
    v_sub_f32 v37, v37, v55
    v_sub_f32 v182, v182, v55
    v_sub_f32 v38, v38, v55
    v_sub_f32 v183, v183, v55
    v_sub_f32 v39, v39, v55
    v_sub_f32 v184, v184, v54
    v_sub_f32 v40, v40, v54
    v_sub_f32 v185, v185, v54
    v_sub_f32 v41, v41, v54
    v_sub_f32 v186, v186, v54
    v_sub_f32 v42, v42, v54
    v_sub_f32 v187, v187, v54
    v_sub_f32 v43, v43, v54
    v_sub_f32 v188, v188, v55
    v_sub_f32 v44, v44, v55
    v_sub_f32 v189, v189, v55
    v_sub_f32 v45, v45, v55
    v_sub_f32 v190, v190, v55
    v_sub_f32 v46, v46, v55
    v_sub_f32 v191, v191, v55
    v_sub_f32 v47, v47, v55
    v_sub_f32 v10, v10, v54
    v_exp_f32 v54, -v54
    v_sub_f32 v11, v11, v55
    v_exp_f32 v55, -v55
    s_nop 0
    v_mul_f32 v14, v14, v54
    v_mul_f32 v15, v15, v55
    v_accvgpr_read_b32 v224, a8
    v_accvgpr_read_b32 v225, a9
    v_accvgpr_read_b32 v226, a10
    v_accvgpr_read_b32 v227, a11
    v_mul_f32 v224, v224, v54
    v_mul_f32 v225, v225, v54
    v_mul_f32 v226, v226, v54
    v_mul_f32 v227, v227, v54
    v_accvgpr_write_b32 a8, v224
    v_accvgpr_write_b32 a9, v225
    v_accvgpr_write_b32 a10, v226
    v_accvgpr_write_b32 a11, v227
    v_accvgpr_read_b32 v224, a12
    v_accvgpr_read_b32 v225, a13
    v_accvgpr_read_b32 v226, a14
    v_accvgpr_read_b32 v227, a15
    v_mul_f32 v224, v224, v55
    v_mul_f32 v225, v225, v55
    v_mul_f32 v226, v226, v55
    v_mul_f32 v227, v227, v55
    v_accvgpr_write_b32 a12, v224
    v_accvgpr_write_b32 a13, v225
    v_accvgpr_write_b32 a14, v226
    v_accvgpr_write_b32 a15, v227
    v_accvgpr_read_b32 v224, a24
    v_accvgpr_read_b32 v225, a25
    v_accvgpr_read_b32 v226, a26
    v_accvgpr_read_b32 v227, a27
    v_mul_f32 v224, v224, v54
    v_mul_f32 v225, v225, v54
    v_mul_f32 v226, v226, v54
    v_mul_f32 v227, v227, v54
    v_accvgpr_write_b32 a24, v224
    v_accvgpr_write_b32 a25, v225
    v_accvgpr_write_b32 a26, v226
    v_accvgpr_write_b32 a27, v227
    v_accvgpr_read_b32 v224, a28
    v_accvgpr_read_b32 v225, a29
    v_accvgpr_read_b32 v226, a30
    v_accvgpr_read_b32 v227, a31
    v_mul_f32 v224, v224, v55
    v_mul_f32 v225, v225, v55
    v_mul_f32 v226, v226, v55
    v_mul_f32 v227, v227, v55
    v_accvgpr_write_b32 a28, v224
    v_accvgpr_write_b32 a29, v225
    v_accvgpr_write_b32 a30, v226
    v_accvgpr_write_b32 a31, v227
    v_accvgpr_read_b32 v224, a40
    v_accvgpr_read_b32 v225, a41
    v_accvgpr_read_b32 v226, a42
    v_accvgpr_read_b32 v227, a43
    v_mul_f32 v224, v224, v54
    v_mul_f32 v225, v225, v54
    v_mul_f32 v226, v226, v54
    v_mul_f32 v227, v227, v54
    v_accvgpr_write_b32 a40, v224
    v_accvgpr_write_b32 a41, v225
    v_accvgpr_write_b32 a42, v226
    v_accvgpr_write_b32 a43, v227
    v_accvgpr_read_b32 v224, a44
    v_accvgpr_read_b32 v225, a45
    v_accvgpr_read_b32 v226, a46
    v_accvgpr_read_b32 v227, a47
    v_mul_f32 v224, v224, v55
    v_mul_f32 v225, v225, v55
    v_mul_f32 v226, v226, v55
    v_mul_f32 v227, v227, v55
    v_accvgpr_write_b32 a44, v224
    v_accvgpr_write_b32 a45, v225
    v_accvgpr_write_b32 a46, v226
    v_accvgpr_write_b32 a47, v227
    v_accvgpr_read_b32 v224, a56
    v_accvgpr_read_b32 v225, a57
    v_accvgpr_read_b32 v226, a58
    v_accvgpr_read_b32 v227, a59
    v_mul_f32 v224, v224, v54
    v_mul_f32 v225, v225, v54
    v_mul_f32 v226, v226, v54
    v_mul_f32 v227, v227, v54
    v_accvgpr_write_b32 a56, v224
    v_accvgpr_write_b32 a57, v225
    v_accvgpr_write_b32 a58, v226
    v_accvgpr_write_b32 a59, v227
    v_accvgpr_read_b32 v224, a60
    v_accvgpr_read_b32 v225, a61
    v_accvgpr_read_b32 v226, a62
    v_accvgpr_read_b32 v227, a63
    v_mul_f32 v224, v224, v55
    v_mul_f32 v225, v225, v55
    v_mul_f32 v226, v226, v55
    v_mul_f32 v227, v227, v55
    v_accvgpr_write_b32 a60, v224
    v_accvgpr_write_b32 a61, v225
    v_accvgpr_write_b32 a62, v226
    v_accvgpr_write_b32 a63, v227
    v_accvgpr_read_b32 v224, a72
    v_accvgpr_read_b32 v225, a73
    v_accvgpr_read_b32 v226, a74
    v_accvgpr_read_b32 v227, a75
    v_mul_f32 v224, v224, v54
    v_mul_f32 v225, v225, v54
    v_mul_f32 v226, v226, v54
    v_mul_f32 v227, v227, v54
    v_accvgpr_write_b32 a72, v224
    v_accvgpr_write_b32 a73, v225
    v_accvgpr_write_b32 a74, v226
    v_accvgpr_write_b32 a75, v227
    v_accvgpr_read_b32 v224, a76
    v_accvgpr_read_b32 v225, a77
    v_accvgpr_read_b32 v226, a78
    v_accvgpr_read_b32 v227, a79
    v_mul_f32 v224, v224, v55
    v_mul_f32 v225, v225, v55
    v_mul_f32 v226, v226, v55
    v_mul_f32 v227, v227, v55
    v_accvgpr_write_b32 a76, v224
    v_accvgpr_write_b32 a77, v225
    v_accvgpr_write_b32 a78, v226
    v_accvgpr_write_b32 a79, v227
    v_accvgpr_read_b32 v224, a88
    v_accvgpr_read_b32 v225, a89
    v_accvgpr_read_b32 v226, a90
    v_accvgpr_read_b32 v227, a91
    v_mul_f32 v224, v224, v54
    v_mul_f32 v225, v225, v54
    v_mul_f32 v226, v226, v54
    v_mul_f32 v227, v227, v54
    v_accvgpr_write_b32 a88, v224
    v_accvgpr_write_b32 a89, v225
    v_accvgpr_write_b32 a90, v226
    v_accvgpr_write_b32 a91, v227
    v_accvgpr_read_b32 v224, a92
    v_accvgpr_read_b32 v225, a93
    v_accvgpr_read_b32 v226, a94
    v_accvgpr_read_b32 v227, a95
    v_mul_f32 v224, v224, v55
    v_mul_f32 v225, v225, v55
    v_mul_f32 v226, v226, v55
    v_mul_f32 v227, v227, v55
    v_accvgpr_write_b32 a92, v224
    v_accvgpr_write_b32 a93, v225
    v_accvgpr_write_b32 a94, v226
    v_accvgpr_write_b32 a95, v227
    v_accvgpr_read_b32 v224, a104
    v_accvgpr_read_b32 v225, a105
    v_accvgpr_read_b32 v226, a106
    v_accvgpr_read_b32 v227, a107
    v_mul_f32 v224, v224, v54
    v_mul_f32 v225, v225, v54
    v_mul_f32 v226, v226, v54
    v_mul_f32 v227, v227, v54
    v_accvgpr_write_b32 a104, v224
    v_accvgpr_write_b32 a105, v225
    v_accvgpr_write_b32 a106, v226
    v_accvgpr_write_b32 a107, v227
    v_accvgpr_read_b32 v224, a108
    v_accvgpr_read_b32 v225, a109
    v_accvgpr_read_b32 v226, a110
    v_accvgpr_read_b32 v227, a111
    v_mul_f32 v224, v224, v55
    v_mul_f32 v225, v225, v55
    v_mul_f32 v226, v226, v55
    v_mul_f32 v227, v227, v55
    v_accvgpr_write_b32 a108, v224
    v_accvgpr_write_b32 a109, v225
    v_accvgpr_write_b32 a110, v226
    v_accvgpr_write_b32 a111, v227
    v_accvgpr_read_b32 v224, a120
    v_accvgpr_read_b32 v225, a121
    v_accvgpr_read_b32 v226, a122
    v_accvgpr_read_b32 v227, a123
    v_mul_f32 v224, v224, v54
    v_mul_f32 v225, v225, v54
    v_mul_f32 v226, v226, v54
    v_mul_f32 v227, v227, v54
    v_accvgpr_write_b32 a120, v224
    v_accvgpr_write_b32 a121, v225
    v_accvgpr_write_b32 a122, v226
    v_accvgpr_write_b32 a123, v227
    v_accvgpr_read_b32 v224, a124
    v_accvgpr_read_b32 v225, a125
    v_accvgpr_read_b32 v226, a126
    v_accvgpr_read_b32 v227, a127
    v_mul_f32 v224, v224, v55
    v_mul_f32 v225, v225, v55
    v_mul_f32 v226, v226, v55
    v_mul_f32 v227, v227, v55
    v_accvgpr_write_b32 a124, v224
    v_accvgpr_write_b32 a125, v225
    v_accvgpr_write_b32 a126, v226
    v_accvgpr_write_b32 a127, v227
    v_exp_f32 v232, v128
    v_exp_f32 v233, v129
    v_exp_f32 v234, v130
    v_exp_f32 v235, v131
    v_add_f32 v48, v232, v233
    v_cvt_pk_bf16_f32 v192, v232, v233
    v_exp_f32 v236, v144
    v_exp_f32 v237, v145
    v_add_f32 v48, v48, v234
    v_add_f32 v48, v48, v235
    v_cvt_pk_bf16_f32 v193, v234, v235
    v_exp_f32 v238, v146
    v_exp_f32 v239, v147
    v_add_f32 v48, v48, v236
    v_add_f32 v48, v48, v237
    v_cvt_pk_bf16_f32 v194, v236, v237
    v_exp_f32 v240, v132
    v_exp_f32 v241, v133
    v_add_f32 v48, v48, v238
    v_add_f32 v48, v48, v239
    v_cvt_pk_bf16_f32 v195, v238, v239
    v_exp_f32 v242, v134
    v_exp_f32 v243, v135
    v_add_f32 v49, v240, v241
    v_cvt_pk_bf16_f32 v196, v240, v241
    v_exp_f32 v244, v148
    v_exp_f32 v245, v149
    v_add_f32 v49, v49, v242
    v_add_f32 v49, v49, v243
    v_cvt_pk_bf16_f32 v197, v242, v243
    v_exp_f32 v246, v150
    v_exp_f32 v247, v151
    v_add_f32 v49, v49, v244
    v_add_f32 v49, v49, v245
    v_cvt_pk_bf16_f32 v198, v244, v245
    v_exp_f32 v232, v136
    v_exp_f32 v233, v137
    v_add_f32 v49, v49, v246
    v_add_f32 v49, v49, v247
    v_cvt_pk_bf16_f32 v199, v246, v247
    v_exp_f32 v234, v138
    v_exp_f32 v235, v139
    v_add_f32 v50, v232, v233
    v_cvt_pk_bf16_f32 v200, v232, v233
    v_exp_f32 v236, v152
    v_exp_f32 v237, v153
    v_add_f32 v50, v50, v234
    v_add_f32 v50, v50, v235
    v_cvt_pk_bf16_f32 v201, v234, v235
    v_exp_f32 v238, v154
    v_exp_f32 v239, v155
    v_add_f32 v50, v50, v236
    v_add_f32 v50, v50, v237
    v_cvt_pk_bf16_f32 v202, v236, v237
    v_exp_f32 v240, v140
    v_exp_f32 v241, v141
    v_add_f32 v50, v50, v238
    v_add_f32 v50, v50, v239
    v_cvt_pk_bf16_f32 v203, v238, v239
    v_exp_f32 v242, v142
    v_exp_f32 v243, v143
    v_add_f32 v51, v240, v241
    v_cvt_pk_bf16_f32 v204, v240, v241
    v_exp_f32 v244, v156
    v_exp_f32 v245, v157
    v_add_f32 v51, v51, v242
    v_add_f32 v51, v51, v243
    v_cvt_pk_bf16_f32 v205, v242, v243
    v_exp_f32 v246, v158
    v_exp_f32 v247, v159
    v_add_f32 v51, v51, v244
    v_add_f32 v51, v51, v245
    v_cvt_pk_bf16_f32 v206, v244, v245
    s_nop 0
    v_add_f32 v51, v51, v246
    v_add_f32 v51, v51, v247
    v_cvt_pk_bf16_f32 v207, v246, v247
    s_nop 1
    s_branch k2_ret_75
k2_rare_76:
    s_nop 7
    v_max_f32 v54, v160, v161
    v_max3_f32 v54, v54, v162, v163
    v_max3_f32 v54, v54, v176, v177
    v_max3_f32 v54, v54, v178, v179
    v_max3_f32 v54, v54, v168, v169
    v_max3_f32 v54, v54, v170, v171
    v_max3_f32 v54, v54, v184, v185
    v_max3_f32 v54, v54, v186, v187
    v_mov_b32 v6, v54
    s_nop 1
    v_permlane16_swap_b32 v54, v6
    s_nop 1
    v_max_f32 v54, v54, v6
    v_mov_b32 v6, v54
    s_nop 1
    v_permlane32_swap_b32 v54, v6
    s_nop 1
    v_max_f32 v54, v54, v6
    v_max_f32 v54, 0, v54
    v_max_f32 v55, v164, v165
    v_max3_f32 v55, v55, v166, v167
    v_max3_f32 v55, v55, v180, v181
    v_max3_f32 v55, v55, v182, v183
    v_max3_f32 v55, v55, v172, v173
    v_max3_f32 v55, v55, v174, v175
    v_max3_f32 v55, v55, v188, v189
    v_max3_f32 v55, v55, v190, v191
    v_mov_b32 v6, v55
    s_nop 1
    v_permlane16_swap_b32 v55, v6
    s_nop 1
    v_max_f32 v55, v55, v6
    v_mov_b32 v6, v55
    s_nop 1
    v_permlane32_swap_b32 v55, v6
    s_nop 1
    v_max_f32 v55, v55, v6
    v_max_f32 v55, 0, v55
    v_sub_f32 v160, v160, v54
    v_sub_f32 v161, v161, v54
    v_sub_f32 v162, v162, v54
    v_sub_f32 v163, v163, v54
    v_sub_f32 v164, v164, v55
    v_sub_f32 v165, v165, v55
    v_sub_f32 v166, v166, v55
    v_sub_f32 v167, v167, v55
    v_sub_f32 v168, v168, v54
    v_sub_f32 v169, v169, v54
    v_sub_f32 v170, v170, v54
    v_sub_f32 v171, v171, v54
    v_sub_f32 v172, v172, v55
    v_sub_f32 v173, v173, v55
    v_sub_f32 v174, v174, v55
    v_sub_f32 v175, v175, v55
    v_sub_f32 v176, v176, v54
    v_sub_f32 v177, v177, v54
    v_sub_f32 v178, v178, v54
    v_sub_f32 v179, v179, v54
    v_sub_f32 v180, v180, v55
    v_sub_f32 v181, v181, v55
    v_sub_f32 v182, v182, v55
    v_sub_f32 v183, v183, v55
    v_sub_f32 v184, v184, v54
    v_sub_f32 v185, v185, v54
    v_sub_f32 v186, v186, v54
    v_sub_f32 v187, v187, v54
    v_sub_f32 v188, v188, v55
    v_sub_f32 v189, v189, v55
    v_sub_f32 v190, v190, v55
    v_sub_f32 v191, v191, v55
    v_sub_f32 v10, v10, v54
    v_exp_f32 v54, -v54
    v_sub_f32 v11, v11, v55
    v_exp_f32 v55, -v55
    s_nop 0
    v_mul_f32 v14, v14, v54
    v_mul_f32 v15, v15, v55
    v_accvgpr_read_b32 v224, a8
    v_accvgpr_read_b32 v225, a9
    v_accvgpr_read_b32 v226, a10
    v_accvgpr_read_b32 v227, a11
    v_mul_f32 v224, v224, v54
    v_mul_f32 v225, v225, v54
    v_mul_f32 v226, v226, v54
    v_mul_f32 v227, v227, v54
    v_accvgpr_write_b32 a8, v224
    v_accvgpr_write_b32 a9, v225
    v_accvgpr_write_b32 a10, v226
    v_accvgpr_write_b32 a11, v227
    v_accvgpr_read_b32 v224, a12
    v_accvgpr_read_b32 v225, a13
    v_accvgpr_read_b32 v226, a14
    v_accvgpr_read_b32 v227, a15
    v_mul_f32 v224, v224, v55
    v_mul_f32 v225, v225, v55
    v_mul_f32 v226, v226, v55
    v_mul_f32 v227, v227, v55
    v_accvgpr_write_b32 a12, v224
    v_accvgpr_write_b32 a13, v225
    v_accvgpr_write_b32 a14, v226
    v_accvgpr_write_b32 a15, v227
    v_accvgpr_read_b32 v224, a24
    v_accvgpr_read_b32 v225, a25
    v_accvgpr_read_b32 v226, a26
    v_accvgpr_read_b32 v227, a27
    v_mul_f32 v224, v224, v54
    v_mul_f32 v225, v225, v54
    v_mul_f32 v226, v226, v54
    v_mul_f32 v227, v227, v54
    v_accvgpr_write_b32 a24, v224
    v_accvgpr_write_b32 a25, v225
    v_accvgpr_write_b32 a26, v226
    v_accvgpr_write_b32 a27, v227
    v_accvgpr_read_b32 v224, a28
    v_accvgpr_read_b32 v225, a29
    v_accvgpr_read_b32 v226, a30
    v_accvgpr_read_b32 v227, a31
    v_mul_f32 v224, v224, v55
    v_mul_f32 v225, v225, v55
    v_mul_f32 v226, v226, v55
    v_mul_f32 v227, v227, v55
    v_accvgpr_write_b32 a28, v224
    v_accvgpr_write_b32 a29, v225
    v_accvgpr_write_b32 a30, v226
    v_accvgpr_write_b32 a31, v227
    v_accvgpr_read_b32 v224, a40
    v_accvgpr_read_b32 v225, a41
    v_accvgpr_read_b32 v226, a42
    v_accvgpr_read_b32 v227, a43
    v_mul_f32 v224, v224, v54
    v_mul_f32 v225, v225, v54
    v_mul_f32 v226, v226, v54
    v_mul_f32 v227, v227, v54
    v_accvgpr_write_b32 a40, v224
    v_accvgpr_write_b32 a41, v225
    v_accvgpr_write_b32 a42, v226
    v_accvgpr_write_b32 a43, v227
    v_accvgpr_read_b32 v224, a44
    v_accvgpr_read_b32 v225, a45
    v_accvgpr_read_b32 v226, a46
    v_accvgpr_read_b32 v227, a47
    v_mul_f32 v224, v224, v55
    v_mul_f32 v225, v225, v55
    v_mul_f32 v226, v226, v55
    v_mul_f32 v227, v227, v55
    v_accvgpr_write_b32 a44, v224
    v_accvgpr_write_b32 a45, v225
    v_accvgpr_write_b32 a46, v226
    v_accvgpr_write_b32 a47, v227
    v_accvgpr_read_b32 v224, a56
    v_accvgpr_read_b32 v225, a57
    v_accvgpr_read_b32 v226, a58
    v_accvgpr_read_b32 v227, a59
    v_mul_f32 v224, v224, v54
    v_mul_f32 v225, v225, v54
    v_mul_f32 v226, v226, v54
    v_mul_f32 v227, v227, v54
    v_accvgpr_write_b32 a56, v224
    v_accvgpr_write_b32 a57, v225
    v_accvgpr_write_b32 a58, v226
    v_accvgpr_write_b32 a59, v227
    v_accvgpr_read_b32 v224, a60
    v_accvgpr_read_b32 v225, a61
    v_accvgpr_read_b32 v226, a62
    v_accvgpr_read_b32 v227, a63
    v_mul_f32 v224, v224, v55
    v_mul_f32 v225, v225, v55
    v_mul_f32 v226, v226, v55
    v_mul_f32 v227, v227, v55
    v_accvgpr_write_b32 a60, v224
    v_accvgpr_write_b32 a61, v225
    v_accvgpr_write_b32 a62, v226
    v_accvgpr_write_b32 a63, v227
    v_accvgpr_read_b32 v224, a72
    v_accvgpr_read_b32 v225, a73
    v_accvgpr_read_b32 v226, a74
    v_accvgpr_read_b32 v227, a75
    v_mul_f32 v224, v224, v54
    v_mul_f32 v225, v225, v54
    v_mul_f32 v226, v226, v54
    v_mul_f32 v227, v227, v54
    v_accvgpr_write_b32 a72, v224
    v_accvgpr_write_b32 a73, v225
    v_accvgpr_write_b32 a74, v226
    v_accvgpr_write_b32 a75, v227
    v_accvgpr_read_b32 v224, a76
    v_accvgpr_read_b32 v225, a77
    v_accvgpr_read_b32 v226, a78
    v_accvgpr_read_b32 v227, a79
    v_mul_f32 v224, v224, v55
    v_mul_f32 v225, v225, v55
    v_mul_f32 v226, v226, v55
    v_mul_f32 v227, v227, v55
    v_accvgpr_write_b32 a76, v224
    v_accvgpr_write_b32 a77, v225
    v_accvgpr_write_b32 a78, v226
    v_accvgpr_write_b32 a79, v227
    v_accvgpr_read_b32 v224, a88
    v_accvgpr_read_b32 v225, a89
    v_accvgpr_read_b32 v226, a90
    v_accvgpr_read_b32 v227, a91
    v_mul_f32 v224, v224, v54
    v_mul_f32 v225, v225, v54
    v_mul_f32 v226, v226, v54
    v_mul_f32 v227, v227, v54
    v_accvgpr_write_b32 a88, v224
    v_accvgpr_write_b32 a89, v225
    v_accvgpr_write_b32 a90, v226
    v_accvgpr_write_b32 a91, v227
    v_accvgpr_read_b32 v224, a92
    v_accvgpr_read_b32 v225, a93
    v_accvgpr_read_b32 v226, a94
    v_accvgpr_read_b32 v227, a95
    v_mul_f32 v224, v224, v55
    v_mul_f32 v225, v225, v55
    v_mul_f32 v226, v226, v55
    v_mul_f32 v227, v227, v55
    v_accvgpr_write_b32 a92, v224
    v_accvgpr_write_b32 a93, v225
    v_accvgpr_write_b32 a94, v226
    v_accvgpr_write_b32 a95, v227
    v_accvgpr_read_b32 v224, a104
    v_accvgpr_read_b32 v225, a105
    v_accvgpr_read_b32 v226, a106
    v_accvgpr_read_b32 v227, a107
    v_mul_f32 v224, v224, v54
    v_mul_f32 v225, v225, v54
    v_mul_f32 v226, v226, v54
    v_mul_f32 v227, v227, v54
    v_accvgpr_write_b32 a104, v224
    v_accvgpr_write_b32 a105, v225
    v_accvgpr_write_b32 a106, v226
    v_accvgpr_write_b32 a107, v227
    v_accvgpr_read_b32 v224, a108
    v_accvgpr_read_b32 v225, a109
    v_accvgpr_read_b32 v226, a110
    v_accvgpr_read_b32 v227, a111
    v_mul_f32 v224, v224, v55
    v_mul_f32 v225, v225, v55
    v_mul_f32 v226, v226, v55
    v_mul_f32 v227, v227, v55
    v_accvgpr_write_b32 a108, v224
    v_accvgpr_write_b32 a109, v225
    v_accvgpr_write_b32 a110, v226
    v_accvgpr_write_b32 a111, v227
    v_accvgpr_read_b32 v224, a120
    v_accvgpr_read_b32 v225, a121
    v_accvgpr_read_b32 v226, a122
    v_accvgpr_read_b32 v227, a123
    v_mul_f32 v224, v224, v54
    v_mul_f32 v225, v225, v54
    v_mul_f32 v226, v226, v54
    v_mul_f32 v227, v227, v54
    v_accvgpr_write_b32 a120, v224
    v_accvgpr_write_b32 a121, v225
    v_accvgpr_write_b32 a122, v226
    v_accvgpr_write_b32 a123, v227
    v_accvgpr_read_b32 v224, a124
    v_accvgpr_read_b32 v225, a125
    v_accvgpr_read_b32 v226, a126
    v_accvgpr_read_b32 v227, a127
    v_mul_f32 v224, v224, v55
    v_mul_f32 v225, v225, v55
    v_mul_f32 v226, v226, v55
    v_mul_f32 v227, v227, v55
    v_accvgpr_write_b32 a124, v224
    v_accvgpr_write_b32 a125, v225
    v_accvgpr_write_b32 a126, v226
    v_accvgpr_write_b32 a127, v227
    v_exp_f32 v232, v160
    v_exp_f32 v233, v161
    v_exp_f32 v234, v162
    v_exp_f32 v235, v163
    v_add_f32 v48, v232, v233
    v_cvt_pk_bf16_f32 v208, v232, v233
    v_exp_f32 v236, v176
    v_exp_f32 v237, v177
    v_add_f32 v48, v48, v234
    v_add_f32 v48, v48, v235
    v_cvt_pk_bf16_f32 v209, v234, v235
    v_exp_f32 v238, v178
    v_exp_f32 v239, v179
    v_add_f32 v48, v48, v236
    v_add_f32 v48, v48, v237
    v_cvt_pk_bf16_f32 v210, v236, v237
    v_exp_f32 v240, v164
    v_exp_f32 v241, v165
    v_add_f32 v48, v48, v238
    v_add_f32 v48, v48, v239
    v_cvt_pk_bf16_f32 v211, v238, v239
    v_exp_f32 v242, v166
    v_exp_f32 v243, v167
    v_add_f32 v49, v240, v241
    v_cvt_pk_bf16_f32 v212, v240, v241
    v_exp_f32 v244, v180
    v_exp_f32 v245, v181
    v_add_f32 v49, v49, v242
    v_add_f32 v49, v49, v243
    v_cvt_pk_bf16_f32 v213, v242, v243
    v_exp_f32 v246, v182
    v_exp_f32 v247, v183
    v_add_f32 v49, v49, v244
    v_add_f32 v49, v49, v245
    v_cvt_pk_bf16_f32 v214, v244, v245
    v_exp_f32 v232, v168
    v_exp_f32 v233, v169
    v_add_f32 v49, v49, v246
    v_add_f32 v49, v49, v247
    v_cvt_pk_bf16_f32 v215, v246, v247
    v_exp_f32 v234, v170
    v_exp_f32 v235, v171
    v_add_f32 v50, v232, v233
    v_cvt_pk_bf16_f32 v216, v232, v233
    v_exp_f32 v236, v184
    v_exp_f32 v237, v185
    v_add_f32 v50, v50, v234
    v_add_f32 v50, v50, v235
    v_cvt_pk_bf16_f32 v217, v234, v235
    v_exp_f32 v238, v186
    v_exp_f32 v239, v187
    v_add_f32 v50, v50, v236
    v_add_f32 v50, v50, v237
    v_cvt_pk_bf16_f32 v218, v236, v237
    v_exp_f32 v240, v172
    v_exp_f32 v241, v173
    v_add_f32 v50, v50, v238
    v_add_f32 v50, v50, v239
    v_cvt_pk_bf16_f32 v219, v238, v239
    v_exp_f32 v242, v174
    v_exp_f32 v243, v175
    v_add_f32 v51, v240, v241
    v_cvt_pk_bf16_f32 v220, v240, v241
    v_exp_f32 v244, v188
    v_exp_f32 v245, v189
    v_add_f32 v51, v51, v242
    v_add_f32 v51, v51, v243
    v_cvt_pk_bf16_f32 v221, v242, v243
    v_exp_f32 v246, v190
    v_exp_f32 v247, v191
    v_add_f32 v51, v51, v244
    v_add_f32 v51, v51, v245
    v_cvt_pk_bf16_f32 v222, v244, v245
    s_nop 0
    v_add_f32 v51, v51, v246
    v_add_f32 v51, v51, v247
    v_cvt_pk_bf16_f32 v223, v246, v247
    s_nop 1
    s_branch k2_ret_77
.globl k3_kernel
.p2align 8
.type k3_kernel,@function
k3_kernel:
    s_cmp_ge_u32 s2, 256
    s_cbranch_scc1 k3_end_78
    s_load_dwordx2 s[4:5], s[0:1], 40
    s_load_dwordx2 s[6:7], s[0:1], 104
    s_load_dwordx2 s[28:29], s[0:1], 0
    s_load_dwordx2 s[30:31], s[0:1], 56
    s_lshr_b32 s41, s2, 3
    s_bfe_u32 s44, s2, 0x10002
    s_and_b32 s42, s2, 1
    s_lshl_b32 s42, s42, 3
    s_and_b32 s43, s41, 7
    s_add_u32 s42, s42, s43
    s_and_b32 s43, s2, 2
    s_lshl_b32 s43, s43, 1
    s_lshr_b32 s40, s41, 3
    s_add_u32 s43, s43, s40
    v_lshrrev_b32 v10, 6, v0
    v_and_b32 v11, 63, v0
    v_readfirstlane_b32 s45, v10
    v_lshlrev_b32 v1, 4, v11
    s_lshl_b32 s46, s42, 7
    s_lshl_b32 s47, s45, 5
    s_add_u32 s46, s46, s47
    s_lshl_b32 s47, s46, 6
    v_add_u32 v12, s47, v1
    v_add_u32 v13, 0x20000, v12
    v_lshrrev_b32 v20, 4, v11
    v_bfe_u32 v21, v11, 1, 3
    v_xor_b32 v21, v21, v20
    v_and_b32 v22, 1, v11
    v_lshl_add_u32 v23, v10, 4, v20
    v_lshlrev_b32 v23, 11, v23
    v_lshl_add_u32 v23, v22, 4, v23
    s_lshl_b32 s47, s43, 8
    v_add_u32 v23, s47, v23
    v_xor_b32 v22, 0, v21
    v_lshl_add_u32 v22, v22, 5, v23
    v_add_u32 v16, 0, v22
    v_xor_b32 v22, 4, v21
    v_lshl_add_u32 v22, v22, 5, v23
    v_add_u32 v17, 7168, v22
    v_xor_b32 v22, 0, v21
    v_lshl_add_u32 v22, v22, 5, v23
    v_add_u32 v18, 14336, v22
    v_xor_b32 v22, 4, v21
    v_lshl_add_u32 v22, v22, 5, v23
    v_add_u32 v19, 21504, v22
    s_lshl_b32 s60, s45, 12
    s_lshl_b32 s61, s44, 22
    s_lshl_b32 s62, s44, 23
    s_waitcnt lgkmcnt(0)
    s_add_u32 s8, s6, 0x3000000
    s_addc_u32 s9, s7, 0
    s_and_b32 s9, s9, 0xffff
    s_mov_b32 s10, 0x1000000
    s_mov_b32 s11, 0x00020000
    s_mov_b32 s12, s4
    s_and_b32 s13, s5, 0xffff
    s_mov_b32 s14, 0x800000
    s_mov_b32 s15, 0x00020000
    s_add_u32 s10, s62, 0x800000
    s_add_u32 s14, s61, 0x400000
    s_add_u32 m0, s60, 0
    s_nop 0
    buffer_load_dwordx4 v16, s[12:15], s61 offen offset:0 lds
    buffer_load_dwordx4 v17, s[12:15], s61 offen offset:1024 lds
    buffer_load_dwordx4 v18, s[12:15], s61 offen offset:2048 lds
    buffer_load_dwordx4 v19, s[12:15], s61 offen offset:3072 lds
    s_add_u32 s61, s61, 0x20000
    buffer_load_dwordx4 a[128:131], v12, s[8:11], s62 offen offset:0
    buffer_load_dwordx4 a[132:135], v12, s[8:11], s62 offen offset:1024
    buffer_load_dwordx4 a[136:139], v13, s[8:11], s62 offen offset:0
    buffer_load_dwordx4 a[140:143], v13, s[8:11], s62 offen offset:1024
    s_add_u32 s62, s62, 0x40000
    s_add_u32 m0, s60, 16384
    s_nop 0
    buffer_load_dwordx4 v16, s[12:15], s61 offen offset:0 lds
    buffer_load_dwordx4 v17, s[12:15], s61 offen offset:1024 lds
    buffer_load_dwordx4 v18, s[12:15], s61 offen offset:2048 lds
    buffer_load_dwordx4 v19, s[12:15], s61 offen offset:3072 lds
    s_add_u32 s61, s61, 0x20000
    buffer_load_dwordx4 a[144:147], v12, s[8:11], s62 offen offset:0
    buffer_load_dwordx4 a[148:151], v12, s[8:11], s62 offen offset:1024
    buffer_load_dwordx4 a[152:155], v13, s[8:11], s62 offen offset:0
    buffer_load_dwordx4 a[156:159], v13, s[8:11], s62 offen offset:1024
    s_add_u32 s62, s62, 0x40000
    s_add_u32 m0, s60, 32768
    s_nop 0
    buffer_load_dwordx4 v16, s[12:15], s61 offen offset:0 lds
    buffer_load_dwordx4 v17, s[12:15], s61 offen offset:1024 lds
    buffer_load_dwordx4 v18, s[12:15], s61 offen offset:2048 lds
    buffer_load_dwordx4 v19, s[12:15], s61 offen offset:3072 lds
    s_add_u32 s61, s61, 0x20000
    buffer_load_dwordx4 a[160:163], v12, s[8:11], s62 offen offset:0
    buffer_load_dwordx4 a[164:167], v12, s[8:11], s62 offen offset:1024
    buffer_load_dwordx4 a[168:171], v13, s[8:11], s62 offen offset:0
    buffer_load_dwordx4 a[172:175], v13, s[8:11], s62 offen offset:1024
    s_add_u32 s62, s62, 0x40000
    s_mov_b32 s16, s28
    s_and_b32 s17, s29, 0xffff
    s_mov_b32 s18, 0x400000
    s_mov_b32 s19, 0x00020000
    s_mov_b32 s20, s30
    s_and_b32 s21, s31, 0xffff
    s_mov_b32 s22, 0x800
    s_mov_b32 s23, 0x00020000
    s_add_u32 s24, s6, 0x4000000
    s_addc_u32 s25, s7, 0
    s_and_b32 s25, s25, 0xffff
    s_mov_b32 s26, 0x400000
    s_mov_b32 s27, 0x00020000
    s_add_u32 s32, s6, 0x4800000
    s_addc_u32 s33, s7, 0
    s_and_b32 s33, s33, 0xffff
    s_mov_b32 s34, 0x6000
    s_mov_b32 s35, 0x00020000
    s_add_u32 s36, s6, 0x5000000
    s_addc_u32 s37, s7, 0
    s_and_b32 s37, s37, 0xffff
    s_mov_b32 s38, 0x800000
    s_mov_b32 s39, 0x00020000
    s_add_u32 s48, s6, 0x4807000
    s_addc_u32 s49, s7, 0
    s_and_b32 s49, s49, 0xffff
    s_mov_b32 s50, 0x8000
    s_mov_b32 s51, 0x00020000
    v_and_b32 v21, 15, v11
    v_add_u32 v22, s46, v21
    v_lshlrev_b32 v2, 2, v22
    v_lshl_add_u32 v2, v20, 13, v2
    v_lshlrev_b32 v22, 11, v22
    s_lshl_b32 s52, s44, 7
    s_add_u32 s47, s47, s52
    v_lshl_add_u32 v14, v20, 3, s47
    v_add_u32 v3, v22, v14
    v_add_u32 v4, 0x8000, v3
    s_lshl_b32 s52, s2, 14
    s_add_u32 s52, s52, s60
    s_xor_b32 s53, s52, 0x10000
    s_lshl_b32 s54, s2, 7
    s_xor_b32 s55, s54, 0x200
    v_mov_b32 v5, 0
    v_mov_b32 v6, 1
    v_lshrrev_b32 v22, 2, v21
    v_lshl_add_u32 v22, v20, 2, v22
    v_and_b32 v23, 7, v22
    s_lshl_b32 s56, s44, 2
    v_xor_b32 v23, s56, v23
    v_lshlrev_b32 v22, 8, v22
    v_and_b32 v32, 3, v11
    v_lshl_add_u32 v22, v32, 3, v22
    v_xor_b32 v32, 0, v23
    v_lshl_add_u32 v24, v32, 5, v22
    v_xor_b32 v32, 1, v23
    v_lshl_add_u32 v25, v32, 5, v22
    v_xor_b32 v32, 2, v23
    v_lshl_add_u32 v26, v32, 5, v22
    v_xor_b32 v32, 3, v23
    v_lshl_add_u32 v27, v32, 5, v22
    v_xor_b32 v32, 4, v23
    v_lshl_add_u32 v28, v32, 5, v22
    v_xor_b32 v32, 5, v23
    v_lshl_add_u32 v29, v32, 5, v22
    v_xor_b32 v32, 6, v23
    v_lshl_add_u32 v30, v32, 5, v22
    v_xor_b32 v32, 7, v23
    v_lshl_add_u32 v31, v32, 5, v22
    s_mov_b32 s57, (code_end-k3_tail)/128
    v_mov_b32 v56, 0
    v_mov_b32 v57, 0
    v_mov_b32 v58, 0
    v_mov_b32 v59, 0
    s_nop 1
    v_mfma_f32_32x32x16_bf16 v[64:79], v[56:59], v[56:59], 0
    v_mfma_f32_32x32x16_bf16 v[80:95], v[56:59], v[56:59], 0
    v_mfma_f32_32x32x16_bf16 v[96:111], v[56:59], v[56:59], 0
    v_mfma_f32_32x32x16_bf16 v[112:127], v[56:59], v[56:59], 0
    v_min_u32 v33, s57, v0
    s_getpc_b64 s[58:59]
pc_79:
    s_add_u32 s58, s58, k3_tail-pc_79
    s_addc_u32 s59, s59, 0
    v_lshlrev_b32 v8, 7, v33
    v_mov_b32 v9, s59
    v_add_co_u32 v8, vcc, s58, v8
    s_nop 1
    v_addc_co_u32 v9, vcc, 0, v9, vcc
    s_lshl_b32 s56, s41, 2
    s_add_u32 s56, s56, s45
    s_and_b32 s57, s2, 7
    v_lshrrev_b32 v34, 3, v11
    v_and_b32 v35, 7, v11
    v_min_u32 v35, 6, v35
    v_mul_u32_u24 v34, 7168, v34
    v_lshl_add_u32 v34, v35, 7, v34
    s_mul_i32 s58, s56, 57344
    s_mul_i32 s59, s57, 896
    s_add_u32 s58, s58, s59
    v_add_u32 v34, s58, v34
    v_min_u32 v35, 55, v11
    v_lshlrev_b32 v35, 7, v35
    s_mul_i32 s58, s56, 7168
    s_mul_i32 s59, s57, 917504
    s_add_u32 s58, s58, s59
    v_add_u32 v35, s58, v35
    s_waitcnt vmcnt(20)
    s_barrier
    ds_read_b64_tr_b16 a[0:1], v24 offset:0
    ds_read_b64_tr_b16 a[2:3], v24 offset:4096
    ds_read_b64_tr_b16 a[4:5], v25 offset:0
    ds_read_b64_tr_b16 a[6:7], v25 offset:4096
    ds_read_b64_tr_b16 a[8:9], v26 offset:0
    ds_read_b64_tr_b16 a[10:11], v26 offset:4096
    ds_read_b64_tr_b16 a[12:13], v27 offset:0
    ds_read_b64_tr_b16 a[14:15], v27 offset:4096
    ds_read_b64_tr_b16 a[16:17], v28 offset:0
    ds_read_b64_tr_b16 a[18:19], v28 offset:4096
    ds_read_b64_tr_b16 a[20:21], v29 offset:0
    ds_read_b64_tr_b16 a[22:23], v29 offset:4096
    ds_read_b64_tr_b16 a[24:25], v30 offset:0
    ds_read_b64_tr_b16 a[26:27], v30 offset:4096
    ds_read_b64_tr_b16 a[28:29], v31 offset:0
    ds_read_b64_tr_b16 a[30:31], v31 offset:4096
    ds_read_b64_tr_b16 a[32:33], v24 offset:8192
    ds_read_b64_tr_b16 a[34:35], v24 offset:12288
    ds_read_b64_tr_b16 a[36:37], v25 offset:8192
    ds_read_b64_tr_b16 a[38:39], v25 offset:12288
    ds_read_b64_tr_b16 a[40:41], v26 offset:8192
    ds_read_b64_tr_b16 a[42:43], v26 offset:12288
    ds_read_b64_tr_b16 a[44:45], v27 offset:8192
    ds_read_b64_tr_b16 a[46:47], v27 offset:12288
    ds_read_b64_tr_b16 a[48:49], v28 offset:8192
    ds_read_b64_tr_b16 a[50:51], v28 offset:12288
    ds_read_b64_tr_b16 a[52:53], v29 offset:8192
    ds_read_b64_tr_b16 a[54:55], v29 offset:12288
    ds_read_b64_tr_b16 a[56:57], v30 offset:8192
    ds_read_b64_tr_b16 a[58:59], v30 offset:12288
    ds_read_b64_tr_b16 a[60:61], v31 offset:8192
    ds_read_b64_tr_b16 a[62:63], v31 offset:12288
    s_mov_b32 s63, 0
    s_waitcnt vmcnt(12) lgkmcnt(0)
    s_barrier
k3_loop_80:
    v_mfma_f32_16x16x32_bf16 v[96:99], a[16:19], a[128:131], v[96:99]
    s_add_u32 m0, s60, 49152
    ds_read_b64_tr_b16 a[64:65], v24 offset:16384
    ds_read_b64_tr_b16 a[66:67], v24 offset:20480
    v_mfma_f32_16x16x32_bf16 v[100:103], a[16:19], a[132:135], v[100:103]
    buffer_load_dwordx4 v16, s[12:15], s61 offen offset:0 lds
    ds_read_b64_tr_b16 a[68:69], v25 offset:16384
    v_mfma_f32_16x16x32_bf16 v[104:107], a[20:23], a[128:131], v[104:107]
    ds_read_b64_tr_b16 a[70:71], v25 offset:20480
    ds_read_b64_tr_b16 a[72:73], v26 offset:16384
    v_mfma_f32_16x16x32_bf16 v[108:111], a[20:23], a[132:135], v[108:111]
    buffer_load_dwordx4 v17, s[12:15], s61 offen offset:1024 lds
    ds_read_b64_tr_b16 a[74:75], v26 offset:20480
    v_mfma_f32_16x16x32_bf16 v[112:115], a[24:27], a[128:131], v[112:115]
    ds_read_b64_tr_b16 a[76:77], v27 offset:16384
    ds_read_b64_tr_b16 a[78:79], v27 offset:20480
    v_mfma_f32_16x16x32_bf16 v[116:119], a[24:27], a[132:135], v[116:119]
    ds_read_b64_tr_b16 a[80:81], v28 offset:16384
    v_mfma_f32_16x16x32_bf16 v[120:123], a[28:31], a[128:131], v[120:123]
    ds_read_b64_tr_b16 a[82:83], v28 offset:20480
    v_mfma_f32_16x16x32_bf16 v[124:127], a[28:31], a[132:135], v[124:127]
    buffer_load_dwordx4 v18, s[12:15], s61 offen offset:2048 lds
    ds_read_b64_tr_b16 a[84:85], v29 offset:16384
    v_mfma_f32_16x16x32_bf16 v[64:67], a[0:3], a[128:131], v[64:67]
    ds_read_b64_tr_b16 a[86:87], v29 offset:20480
    ds_read_b64_tr_b16 a[88:89], v30 offset:16384
    v_mfma_f32_16x16x32_bf16 v[68:71], a[0:3], a[132:135], v[68:71]
    ds_read_b64_tr_b16 a[90:91], v30 offset:20480
    v_mfma_f32_16x16x32_bf16 v[72:75], a[4:7], a[128:131], v[72:75]
    buffer_load_dwordx4 v19, s[12:15], s61 offen offset:3072 lds
    ds_read_b64_tr_b16 a[92:93], v31 offset:16384
    v_mfma_f32_16x16x32_bf16 v[76:79], a[4:7], a[132:135], v[76:79]
    ds_read_b64_tr_b16 a[94:95], v31 offset:20480
    ds_read_b64_tr_b16 a[96:97], v24 offset:24576
    v_mfma_f32_16x16x32_bf16 v[80:83], a[8:11], a[128:131], v[80:83]
    ds_read_b64_tr_b16 a[98:99], v24 offset:28672
    v_mfma_f32_16x16x32_bf16 v[84:87], a[8:11], a[132:135], v[84:87]
    ds_read_b64_tr_b16 a[100:101], v25 offset:24576
    v_mfma_f32_16x16x32_bf16 v[88:91], a[12:15], a[128:131], v[88:91]
    buffer_load_dwordx4 a[176:179], v12, s[8:11], s62 offen offset:0
    ds_read_b64_tr_b16 a[102:103], v25 offset:28672
    v_mfma_f32_16x16x32_bf16 v[92:95], a[12:15], a[132:135], v[92:95]
    s_add_u32 s61, s61, 0x20000
    ds_read_b64_tr_b16 a[104:105], v26 offset:24576
    ds_read_b64_tr_b16 a[106:107], v26 offset:28672
    v_mfma_f32_16x16x32_bf16 v[96:99], a[48:51], a[136:139], v[96:99]
    ds_read_b64_tr_b16 a[108:109], v27 offset:24576
    v_mfma_f32_16x16x32_bf16 v[100:103], a[48:51], a[140:143], v[100:103]
    buffer_load_dwordx4 a[180:183], v12, s[8:11], s62 offen offset:1024
    ds_read_b64_tr_b16 a[110:111], v27 offset:28672
    v_mfma_f32_16x16x32_bf16 v[104:107], a[52:55], a[136:139], v[104:107]
    ds_read_b64_tr_b16 a[112:113], v28 offset:24576
    v_mfma_f32_16x16x32_bf16 v[108:111], a[52:55], a[140:143], v[108:111]
    ds_read_b64_tr_b16 a[114:115], v28 offset:28672
    ds_read_b64_tr_b16 a[116:117], v29 offset:24576
    v_mfma_f32_16x16x32_bf16 v[112:115], a[56:59], a[136:139], v[112:115]
    ds_read_b64_tr_b16 a[118:119], v29 offset:28672
    v_mfma_f32_16x16x32_bf16 v[116:119], a[56:59], a[140:143], v[116:119]
    buffer_load_dwordx4 a[184:187], v13, s[8:11], s62 offen offset:0
    ds_read_b64_tr_b16 a[120:121], v30 offset:24576
    v_mfma_f32_16x16x32_bf16 v[120:123], a[60:63], a[136:139], v[120:123]
    ds_read_b64_tr_b16 a[122:123], v30 offset:28672
    ds_read_b64_tr_b16 a[124:125], v31 offset:24576
    v_mfma_f32_16x16x32_bf16 v[124:127], a[60:63], a[140:143], v[124:127]
    ds_read_b64_tr_b16 a[126:127], v31 offset:28672
    v_mfma_f32_16x16x32_bf16 v[64:67], a[32:35], a[136:139], v[64:67]
    buffer_load_dwordx4 a[188:191], v13, s[8:11], s62 offen offset:1024
    v_mfma_f32_16x16x32_bf16 v[68:71], a[32:35], a[140:143], v[68:71]
    v_mfma_f32_16x16x32_bf16 v[72:75], a[36:39], a[136:139], v[72:75]
    v_mfma_f32_16x16x32_bf16 v[76:79], a[36:39], a[140:143], v[76:79]
    v_mfma_f32_16x16x32_bf16 v[80:83], a[40:43], a[136:139], v[80:83]
    s_cmp_eq_u32 s63, 7
    s_cbranch_scc1 k3_ool_81
k3_oolret_82:
    v_mfma_f32_16x16x32_bf16 v[84:87], a[40:43], a[140:143], v[84:87]
    s_add_u32 s62, s62, 0x40000
    v_mfma_f32_16x16x32_bf16 v[88:91], a[44:47], a[136:139], v[88:91]
    v_mfma_f32_16x16x32_bf16 v[92:95], a[44:47], a[140:143], v[92:95]
    s_waitcnt vmcnt(12) lgkmcnt(0)
    s_barrier
    v_mfma_f32_16x16x32_bf16 v[96:99], a[80:83], a[144:147], v[96:99]
    s_add_u32 m0, s60, 0
    ds_read_b64_tr_b16 a[0:1], v24 offset:32768
    ds_read_b64_tr_b16 a[2:3], v24 offset:36864
    v_mfma_f32_16x16x32_bf16 v[100:103], a[80:83], a[148:151], v[100:103]
    buffer_load_dwordx4 v16, s[12:15], s61 offen offset:0 lds
    ds_read_b64_tr_b16 a[4:5], v25 offset:32768
    v_mfma_f32_16x16x32_bf16 v[104:107], a[84:87], a[144:147], v[104:107]
    ds_read_b64_tr_b16 a[6:7], v25 offset:36864
    ds_read_b64_tr_b16 a[8:9], v26 offset:32768
    v_mfma_f32_16x16x32_bf16 v[108:111], a[84:87], a[148:151], v[108:111]
    buffer_load_dwordx4 v17, s[12:15], s61 offen offset:1024 lds
    ds_read_b64_tr_b16 a[10:11], v26 offset:36864
    v_mfma_f32_16x16x32_bf16 v[112:115], a[88:91], a[144:147], v[112:115]
    ds_read_b64_tr_b16 a[12:13], v27 offset:32768
    ds_read_b64_tr_b16 a[14:15], v27 offset:36864
    v_mfma_f32_16x16x32_bf16 v[116:119], a[88:91], a[148:151], v[116:119]
    ds_read_b64_tr_b16 a[16:17], v28 offset:32768
    v_mfma_f32_16x16x32_bf16 v[120:123], a[92:95], a[144:147], v[120:123]
    ds_read_b64_tr_b16 a[18:19], v28 offset:36864
    v_mfma_f32_16x16x32_bf16 v[124:127], a[92:95], a[148:151], v[124:127]
    buffer_load_dwordx4 v18, s[12:15], s61 offen offset:2048 lds
    ds_read_b64_tr_b16 a[20:21], v29 offset:32768
    v_mfma_f32_16x16x32_bf16 v[64:67], a[64:67], a[144:147], v[64:67]
    ds_read_b64_tr_b16 a[22:23], v29 offset:36864
    ds_read_b64_tr_b16 a[24:25], v30 offset:32768
    v_mfma_f32_16x16x32_bf16 v[68:71], a[64:67], a[148:151], v[68:71]
    ds_read_b64_tr_b16 a[26:27], v30 offset:36864
    v_mfma_f32_16x16x32_bf16 v[72:75], a[68:71], a[144:147], v[72:75]
    buffer_load_dwordx4 v19, s[12:15], s61 offen offset:3072 lds
    ds_read_b64_tr_b16 a[28:29], v31 offset:32768
    v_mfma_f32_16x16x32_bf16 v[76:79], a[68:71], a[148:151], v[76:79]
    ds_read_b64_tr_b16 a[30:31], v31 offset:36864
    ds_read_b64_tr_b16 a[32:33], v24 offset:40960
    v_mfma_f32_16x16x32_bf16 v[80:83], a[72:75], a[144:147], v[80:83]
    ds_read_b64_tr_b16 a[34:35], v24 offset:45056
    v_mfma_f32_16x16x32_bf16 v[84:87], a[72:75], a[148:151], v[84:87]
    ds_read_b64_tr_b16 a[36:37], v25 offset:40960
    v_mfma_f32_16x16x32_bf16 v[88:91], a[76:79], a[144:147], v[88:91]
    buffer_load_dwordx4 a[128:131], v12, s[8:11], s62 offen offset:0
    ds_read_b64_tr_b16 a[38:39], v25 offset:45056
    v_mfma_f32_16x16x32_bf16 v[92:95], a[76:79], a[148:151], v[92:95]
    s_add_u32 s61, s61, 0x20000
    ds_read_b64_tr_b16 a[40:41], v26 offset:40960
    ds_read_b64_tr_b16 a[42:43], v26 offset:45056
    v_mfma_f32_16x16x32_bf16 v[96:99], a[112:115], a[152:155], v[96:99]
    ds_read_b64_tr_b16 a[44:45], v27 offset:40960
    v_mfma_f32_16x16x32_bf16 v[100:103], a[112:115], a[156:159], v[100:103]
    buffer_load_dwordx4 a[132:135], v12, s[8:11], s62 offen offset:1024
    ds_read_b64_tr_b16 a[46:47], v27 offset:45056
    v_mfma_f32_16x16x32_bf16 v[104:107], a[116:119], a[152:155], v[104:107]
    ds_read_b64_tr_b16 a[48:49], v28 offset:40960
    v_mfma_f32_16x16x32_bf16 v[108:111], a[116:119], a[156:159], v[108:111]
    ds_read_b64_tr_b16 a[50:51], v28 offset:45056
    ds_read_b64_tr_b16 a[52:53], v29 offset:40960
    v_mfma_f32_16x16x32_bf16 v[112:115], a[120:123], a[152:155], v[112:115]
    ds_read_b64_tr_b16 a[54:55], v29 offset:45056
    v_mfma_f32_16x16x32_bf16 v[116:119], a[120:123], a[156:159], v[116:119]
    buffer_load_dwordx4 a[136:139], v13, s[8:11], s62 offen offset:0
    ds_read_b64_tr_b16 a[56:57], v30 offset:40960
    v_mfma_f32_16x16x32_bf16 v[120:123], a[124:127], a[152:155], v[120:123]
    ds_read_b64_tr_b16 a[58:59], v30 offset:45056
    ds_read_b64_tr_b16 a[60:61], v31 offset:40960
    v_mfma_f32_16x16x32_bf16 v[124:127], a[124:127], a[156:159], v[124:127]
    ds_read_b64_tr_b16 a[62:63], v31 offset:45056
    v_mfma_f32_16x16x32_bf16 v[64:67], a[96:99], a[152:155], v[64:67]
    buffer_load_dwordx4 a[140:143], v13, s[8:11], s62 offen offset:1024
    v_mfma_f32_16x16x32_bf16 v[68:71], a[96:99], a[156:159], v[68:71]
    v_mfma_f32_16x16x32_bf16 v[72:75], a[100:103], a[152:155], v[72:75]
    v_mfma_f32_16x16x32_bf16 v[76:79], a[100:103], a[156:159], v[76:79]
    v_mfma_f32_16x16x32_bf16 v[80:83], a[104:107], a[152:155], v[80:83]
    v_mfma_f32_16x16x32_bf16 v[84:87], a[104:107], a[156:159], v[84:87]
    s_add_u32 s62, s62, 0x40000
    v_mfma_f32_16x16x32_bf16 v[88:91], a[108:111], a[152:155], v[88:91]
    v_mfma_f32_16x16x32_bf16 v[92:95], a[108:111], a[156:159], v[92:95]
    s_waitcnt vmcnt(12) lgkmcnt(0)
    s_barrier
    v_mfma_f32_16x16x32_bf16 v[96:99], a[16:19], a[160:163], v[96:99]
    s_add_u32 m0, s60, 16384
    ds_read_b64_tr_b16 a[64:65], v24 offset:49152
    ds_read_b64_tr_b16 a[66:67], v24 offset:53248
    v_mfma_f32_16x16x32_bf16 v[100:103], a[16:19], a[164:167], v[100:103]
    buffer_load_dwordx4 v16, s[12:15], s61 offen offset:0 lds
    ds_read_b64_tr_b16 a[68:69], v25 offset:49152
    v_mfma_f32_16x16x32_bf16 v[104:107], a[20:23], a[160:163], v[104:107]
    ds_read_b64_tr_b16 a[70:71], v25 offset:53248
    ds_read_b64_tr_b16 a[72:73], v26 offset:49152
    v_mfma_f32_16x16x32_bf16 v[108:111], a[20:23], a[164:167], v[108:111]
    buffer_load_dwordx4 v17, s[12:15], s61 offen offset:1024 lds
    ds_read_b64_tr_b16 a[74:75], v26 offset:53248
    v_mfma_f32_16x16x32_bf16 v[112:115], a[24:27], a[160:163], v[112:115]
    ds_read_b64_tr_b16 a[76:77], v27 offset:49152
    ds_read_b64_tr_b16 a[78:79], v27 offset:53248
    v_mfma_f32_16x16x32_bf16 v[116:119], a[24:27], a[164:167], v[116:119]
    ds_read_b64_tr_b16 a[80:81], v28 offset:49152
    v_mfma_f32_16x16x32_bf16 v[120:123], a[28:31], a[160:163], v[120:123]
    ds_read_b64_tr_b16 a[82:83], v28 offset:53248
    v_mfma_f32_16x16x32_bf16 v[124:127], a[28:31], a[164:167], v[124:127]
    buffer_load_dwordx4 v18, s[12:15], s61 offen offset:2048 lds
    ds_read_b64_tr_b16 a[84:85], v29 offset:49152
    v_mfma_f32_16x16x32_bf16 v[64:67], a[0:3], a[160:163], v[64:67]
    ds_read_b64_tr_b16 a[86:87], v29 offset:53248
    ds_read_b64_tr_b16 a[88:89], v30 offset:49152
    v_mfma_f32_16x16x32_bf16 v[68:71], a[0:3], a[164:167], v[68:71]
    ds_read_b64_tr_b16 a[90:91], v30 offset:53248
    v_mfma_f32_16x16x32_bf16 v[72:75], a[4:7], a[160:163], v[72:75]
    buffer_load_dwordx4 v19, s[12:15], s61 offen offset:3072 lds
    ds_read_b64_tr_b16 a[92:93], v31 offset:49152
    v_mfma_f32_16x16x32_bf16 v[76:79], a[4:7], a[164:167], v[76:79]
    ds_read_b64_tr_b16 a[94:95], v31 offset:53248
    ds_read_b64_tr_b16 a[96:97], v24 offset:57344
    v_mfma_f32_16x16x32_bf16 v[80:83], a[8:11], a[160:163], v[80:83]
    ds_read_b64_tr_b16 a[98:99], v24 offset:61440
    v_mfma_f32_16x16x32_bf16 v[84:87], a[8:11], a[164:167], v[84:87]
    ds_read_b64_tr_b16 a[100:101], v25 offset:57344
    v_mfma_f32_16x16x32_bf16 v[88:91], a[12:15], a[160:163], v[88:91]
    buffer_load_dwordx4 a[144:147], v12, s[8:11], s62 offen offset:0
    ds_read_b64_tr_b16 a[102:103], v25 offset:61440
    v_mfma_f32_16x16x32_bf16 v[92:95], a[12:15], a[164:167], v[92:95]
    s_add_u32 s61, s61, 0x20000
    ds_read_b64_tr_b16 a[104:105], v26 offset:57344
    ds_read_b64_tr_b16 a[106:107], v26 offset:61440
    v_mfma_f32_16x16x32_bf16 v[96:99], a[48:51], a[168:171], v[96:99]
    ds_read_b64_tr_b16 a[108:109], v27 offset:57344
    v_mfma_f32_16x16x32_bf16 v[100:103], a[48:51], a[172:175], v[100:103]
    buffer_load_dwordx4 a[148:151], v12, s[8:11], s62 offen offset:1024
    ds_read_b64_tr_b16 a[110:111], v27 offset:61440
    v_mfma_f32_16x16x32_bf16 v[104:107], a[52:55], a[168:171], v[104:107]
    ds_read_b64_tr_b16 a[112:113], v28 offset:57344
    v_mfma_f32_16x16x32_bf16 v[108:111], a[52:55], a[172:175], v[108:111]
    ds_read_b64_tr_b16 a[114:115], v28 offset:61440
    ds_read_b64_tr_b16 a[116:117], v29 offset:57344
    v_mfma_f32_16x16x32_bf16 v[112:115], a[56:59], a[168:171], v[112:115]
    ds_read_b64_tr_b16 a[118:119], v29 offset:61440
    v_mfma_f32_16x16x32_bf16 v[116:119], a[56:59], a[172:175], v[116:119]
    buffer_load_dwordx4 a[152:155], v13, s[8:11], s62 offen offset:0
    ds_read_b64_tr_b16 a[120:121], v30 offset:57344
    v_mfma_f32_16x16x32_bf16 v[120:123], a[60:63], a[168:171], v[120:123]
    ds_read_b64_tr_b16 a[122:123], v30 offset:61440
    ds_read_b64_tr_b16 a[124:125], v31 offset:57344
    v_mfma_f32_16x16x32_bf16 v[124:127], a[60:63], a[172:175], v[124:127]
    ds_read_b64_tr_b16 a[126:127], v31 offset:61440
    v_mfma_f32_16x16x32_bf16 v[64:67], a[32:35], a[168:171], v[64:67]
    buffer_load_dwordx4 a[156:159], v13, s[8:11], s62 offen offset:1024
    v_mfma_f32_16x16x32_bf16 v[68:71], a[32:35], a[172:175], v[68:71]
    v_mfma_f32_16x16x32_bf16 v[72:75], a[36:39], a[168:171], v[72:75]
    v_mfma_f32_16x16x32_bf16 v[76:79], a[36:39], a[172:175], v[76:79]
    v_mfma_f32_16x16x32_bf16 v[80:83], a[40:43], a[168:171], v[80:83]
    v_mfma_f32_16x16x32_bf16 v[84:87], a[40:43], a[172:175], v[84:87]
    s_add_u32 s62, s62, 0x40000
    v_mfma_f32_16x16x32_bf16 v[88:91], a[44:47], a[168:171], v[88:91]
    v_mfma_f32_16x16x32_bf16 v[92:95], a[44:47], a[172:175], v[92:95]
    s_waitcnt vmcnt(12) lgkmcnt(0)
    s_barrier
    v_mfma_f32_16x16x32_bf16 v[96:99], a[80:83], a[176:179], v[96:99]
    s_add_u32 m0, s60, 32768
    ds_read_b64_tr_b16 a[0:1], v24 offset:0
    ds_read_b64_tr_b16 a[2:3], v24 offset:4096
    v_mfma_f32_16x16x32_bf16 v[100:103], a[80:83], a[180:183], v[100:103]
    buffer_load_dwordx4 v16, s[12:15], s61 offen offset:0 lds
    ds_read_b64_tr_b16 a[4:5], v25 offset:0
    v_mfma_f32_16x16x32_bf16 v[104:107], a[84:87], a[176:179], v[104:107]
    ds_read_b64_tr_b16 a[6:7], v25 offset:4096
    ds_read_b64_tr_b16 a[8:9], v26 offset:0
    v_mfma_f32_16x16x32_bf16 v[108:111], a[84:87], a[180:183], v[108:111]
    buffer_load_dwordx4 v17, s[12:15], s61 offen offset:1024 lds
    ds_read_b64_tr_b16 a[10:11], v26 offset:4096
    v_mfma_f32_16x16x32_bf16 v[112:115], a[88:91], a[176:179], v[112:115]
    ds_read_b64_tr_b16 a[12:13], v27 offset:0
    ds_read_b64_tr_b16 a[14:15], v27 offset:4096
    v_mfma_f32_16x16x32_bf16 v[116:119], a[88:91], a[180:183], v[116:119]
    ds_read_b64_tr_b16 a[16:17], v28 offset:0
    v_mfma_f32_16x16x32_bf16 v[120:123], a[92:95], a[176:179], v[120:123]
    ds_read_b64_tr_b16 a[18:19], v28 offset:4096
    v_mfma_f32_16x16x32_bf16 v[124:127], a[92:95], a[180:183], v[124:127]
    buffer_load_dwordx4 v18, s[12:15], s61 offen offset:2048 lds
    ds_read_b64_tr_b16 a[20:21], v29 offset:0
    v_mfma_f32_16x16x32_bf16 v[64:67], a[64:67], a[176:179], v[64:67]
    ds_read_b64_tr_b16 a[22:23], v29 offset:4096
    ds_read_b64_tr_b16 a[24:25], v30 offset:0
    v_mfma_f32_16x16x32_bf16 v[68:71], a[64:67], a[180:183], v[68:71]
    ds_read_b64_tr_b16 a[26:27], v30 offset:4096
    v_mfma_f32_16x16x32_bf16 v[72:75], a[68:71], a[176:179], v[72:75]
    buffer_load_dwordx4 v19, s[12:15], s61 offen offset:3072 lds
    ds_read_b64_tr_b16 a[28:29], v31 offset:0
    v_mfma_f32_16x16x32_bf16 v[76:79], a[68:71], a[180:183], v[76:79]
    ds_read_b64_tr_b16 a[30:31], v31 offset:4096
    ds_read_b64_tr_b16 a[32:33], v24 offset:8192
    v_mfma_f32_16x16x32_bf16 v[80:83], a[72:75], a[176:179], v[80:83]
    ds_read_b64_tr_b16 a[34:35], v24 offset:12288
    v_mfma_f32_16x16x32_bf16 v[84:87], a[72:75], a[180:183], v[84:87]
    ds_read_b64_tr_b16 a[36:37], v25 offset:8192
    v_mfma_f32_16x16x32_bf16 v[88:91], a[76:79], a[176:179], v[88:91]
    buffer_load_dwordx4 a[160:163], v12, s[8:11], s62 offen offset:0
    ds_read_b64_tr_b16 a[38:39], v25 offset:12288
    v_mfma_f32_16x16x32_bf16 v[92:95], a[76:79], a[180:183], v[92:95]
    s_add_u32 s61, s61, 0x20000
    ds_read_b64_tr_b16 a[40:41], v26 offset:8192
    ds_read_b64_tr_b16 a[42:43], v26 offset:12288
    v_mfma_f32_16x16x32_bf16 v[96:99], a[112:115], a[184:187], v[96:99]
    ds_read_b64_tr_b16 a[44:45], v27 offset:8192
    v_mfma_f32_16x16x32_bf16 v[100:103], a[112:115], a[188:191], v[100:103]
    buffer_load_dwordx4 a[164:167], v12, s[8:11], s62 offen offset:1024
    ds_read_b64_tr_b16 a[46:47], v27 offset:12288
    v_mfma_f32_16x16x32_bf16 v[104:107], a[116:119], a[184:187], v[104:107]
    ds_read_b64_tr_b16 a[48:49], v28 offset:8192
    v_mfma_f32_16x16x32_bf16 v[108:111], a[116:119], a[188:191], v[108:111]
    ds_read_b64_tr_b16 a[50:51], v28 offset:12288
    ds_read_b64_tr_b16 a[52:53], v29 offset:8192
    v_mfma_f32_16x16x32_bf16 v[112:115], a[120:123], a[184:187], v[112:115]
    ds_read_b64_tr_b16 a[54:55], v29 offset:12288
    v_mfma_f32_16x16x32_bf16 v[116:119], a[120:123], a[188:191], v[116:119]
    buffer_load_dwordx4 a[168:171], v13, s[8:11], s62 offen offset:0
    ds_read_b64_tr_b16 a[56:57], v30 offset:8192
    v_mfma_f32_16x16x32_bf16 v[120:123], a[124:127], a[184:187], v[120:123]
    ds_read_b64_tr_b16 a[58:59], v30 offset:12288
    ds_read_b64_tr_b16 a[60:61], v31 offset:8192
    v_mfma_f32_16x16x32_bf16 v[124:127], a[124:127], a[188:191], v[124:127]
    ds_read_b64_tr_b16 a[62:63], v31 offset:12288
    v_mfma_f32_16x16x32_bf16 v[64:67], a[96:99], a[184:187], v[64:67]
    buffer_load_dwordx4 a[172:175], v13, s[8:11], s62 offen offset:1024
    v_mfma_f32_16x16x32_bf16 v[68:71], a[96:99], a[188:191], v[68:71]
    v_mfma_f32_16x16x32_bf16 v[72:75], a[100:103], a[184:187], v[72:75]
    v_mfma_f32_16x16x32_bf16 v[76:79], a[100:103], a[188:191], v[76:79]
    v_mfma_f32_16x16x32_bf16 v[80:83], a[104:107], a[184:187], v[80:83]
    v_mfma_f32_16x16x32_bf16 v[84:87], a[104:107], a[188:191], v[84:87]
    s_add_u32 s62, s62, 0x40000
    v_mfma_f32_16x16x32_bf16 v[88:91], a[108:111], a[184:187], v[88:91]
    s_add_u32 s63, s63, 1
    v_mfma_f32_16x16x32_bf16 v[92:95], a[108:111], a[188:191], v[92:95]
    s_waitcnt vmcnt(12) lgkmcnt(0)
    s_barrier
    s_cmp_lt_u32 s63, 8
    s_cbranch_scc1 k3_loop_80
k3_tail:
    s_nop 1
    v_cvt_pk_bf16_f32 v96, v96, v97
    v_cvt_pk_bf16_f32 v97, v98, v99
    v_cvt_pk_bf16_f32 v98, v100, v101
    v_cvt_pk_bf16_f32 v99, v102, v103
    buffer_store_dwordx4 v[96:99], v1, s[36:39], s52 offen offset:0 sc1
    v_cvt_pk_bf16_f32 v104, v104, v105
    v_cvt_pk_bf16_f32 v105, v106, v107
    v_cvt_pk_bf16_f32 v106, v108, v109
    v_cvt_pk_bf16_f32 v107, v110, v111
    buffer_store_dwordx4 v[104:107], v1, s[36:39], s52 offen offset:1024 sc1
    v_cvt_pk_bf16_f32 v112, v112, v113
    v_cvt_pk_bf16_f32 v113, v114, v115
    v_cvt_pk_bf16_f32 v114, v116, v117
    v_cvt_pk_bf16_f32 v115, v118, v119
    buffer_store_dwordx4 v[112:115], v1, s[36:39], s52 offen offset:2048 sc1
    v_cvt_pk_bf16_f32 v120, v120, v121
    v_cvt_pk_bf16_f32 v121, v122, v123
    v_cvt_pk_bf16_f32 v122, v124, v125
    v_cvt_pk_bf16_f32 v123, v126, v127
    buffer_store_dwordx4 v[120:123], v1, s[36:39], s52 offen offset:3072 sc1
    s_waitcnt vmcnt(4)
    v_lshlrev_b32 v58, 16, v128
    v_and_b32 v59, 0xffff0000, v128
    v_pk_add_f32 v[64:65], v[64:65], v[58:59]
    v_lshlrev_b32 v58, 16, v129
    v_and_b32 v59, 0xffff0000, v129
    v_pk_add_f32 v[66:67], v[66:67], v[58:59]
    v_lshlrev_b32 v58, 16, v136
    v_and_b32 v59, 0xffff0000, v136
    v_pk_add_f32 v[68:69], v[68:69], v[58:59]
    v_lshlrev_b32 v58, 16, v137
    v_and_b32 v59, 0xffff0000, v137
    v_pk_add_f32 v[70:71], v[70:71], v[58:59]
    v_lshlrev_b32 v58, 16, v130
    v_and_b32 v59, 0xffff0000, v130
    v_pk_add_f32 v[72:73], v[72:73], v[58:59]
    v_lshlrev_b32 v58, 16, v131
    v_and_b32 v59, 0xffff0000, v131
    v_pk_add_f32 v[74:75], v[74:75], v[58:59]
    v_lshlrev_b32 v58, 16, v138
    v_and_b32 v59, 0xffff0000, v138
    v_pk_add_f32 v[76:77], v[76:77], v[58:59]
    v_lshlrev_b32 v58, 16, v139
    v_and_b32 v59, 0xffff0000, v139
    v_pk_add_f32 v[78:79], v[78:79], v[58:59]
    v_lshlrev_b32 v58, 16, v132
    v_and_b32 v59, 0xffff0000, v132
    v_pk_add_f32 v[80:81], v[80:81], v[58:59]
    v_lshlrev_b32 v58, 16, v133
    v_and_b32 v59, 0xffff0000, v133
    v_pk_add_f32 v[82:83], v[82:83], v[58:59]
    v_lshlrev_b32 v58, 16, v140
    v_and_b32 v59, 0xffff0000, v140
    v_pk_add_f32 v[84:85], v[84:85], v[58:59]
    v_lshlrev_b32 v58, 16, v141
    v_and_b32 v59, 0xffff0000, v141
    v_pk_add_f32 v[86:87], v[86:87], v[58:59]
    v_lshlrev_b32 v58, 16, v134
    v_and_b32 v59, 0xffff0000, v134
    v_pk_add_f32 v[88:89], v[88:89], v[58:59]
    v_lshlrev_b32 v58, 16, v135
    v_and_b32 v59, 0xffff0000, v135
    v_pk_add_f32 v[90:91], v[90:91], v[58:59]
    v_lshlrev_b32 v58, 16, v142
    v_and_b32 v59, 0xffff0000, v142
    v_pk_add_f32 v[92:93], v[92:93], v[58:59]
    v_lshlrev_b32 v58, 16, v143
    v_and_b32 v59, 0xffff0000, v143
    v_pk_add_f32 v[94:95], v[94:95], v[58:59]
    v_and_b32 v58, 1, v20
    v_lshrrev_b32 v59, 1, v20
    v_lshlrev_b32 v58, 5, v58
    v_lshl_add_u32 v58, v59, 4, v58
    v_lshlrev_b32 v59, 3, v20
    v_sub_u32 v58, v58, v59
    v_add_u32 v3, v3, v58
    v_add_u32 v4, v4, v58
    v_lshlrev_b32 v32, 16, v144
    v_and_b32 v33, 0xffff0000, v144
    v_lshlrev_b32 v34, 16, v145
    v_and_b32 v35, 0xffff0000, v145
    v_lshlrev_b32 v36, 16, v146
    v_and_b32 v37, 0xffff0000, v146
    v_lshlrev_b32 v38, 16, v147
    v_and_b32 v39, 0xffff0000, v147
    v_lshlrev_b32 v40, 16, v148
    v_and_b32 v41, 0xffff0000, v148
    v_lshlrev_b32 v42, 16, v149
    v_and_b32 v43, 0xffff0000, v149
    v_lshlrev_b32 v44, 16, v150
    v_and_b32 v45, 0xffff0000, v150
    v_lshlrev_b32 v46, 16, v151
    v_and_b32 v47, 0xffff0000, v151
    s_or_b32 s57, s42, s45
    s_cbranch_scc1 k3_nowr_83
    v_pk_add_f32 v[56:57], v[32:33], v[34:35]
    v_pk_add_f32 v[56:57], v[56:57], v[36:37]
    v_pk_add_f32 v[56:57], v[56:57], v[38:39]
    v_pk_add_f32 v[56:57], v[56:57], v[40:41]
    v_pk_add_f32 v[56:57], v[56:57], v[42:43]
    v_pk_add_f32 v[56:57], v[56:57], v[44:45]
    v_pk_add_f32 v[56:57], v[56:57], v[46:47]
    v_add_f32 v56, v56, v57
    v_mov_b32 v57, v56
    s_nop 1
    v_permlane16_swap_b32 v56, v57
    s_nop 1
    v_add_f32 v56, v56, v57
    v_mov_b32 v57, v56
    s_nop 1
    v_permlane32_swap_b32 v56, v57
    s_nop 1
    v_add_f32 v56, v56, v57
    s_mov_b32 s57, 24704
    s_mov_b32 s34, 24708
    s_mov_b64 exec, 1
    buffer_atomic_add_f32 v56, v5, s[32:35], s57 offen
    s_mov_b64 exec, -1
    s_mov_b32 s34, 24576
k3_nowr_83:
    v_mov_b32 v144, 0
    v_mov_b32 v145, 0
    v_mov_b32 v146, 0
    v_mov_b32 v147, 0
    v_mov_b32 v148, 0
    v_mov_b32 v149, 0
    v_mov_b32 v150, 0
    v_mov_b32 v151, 0
    v_mov_b32 v152, 0
    v_mov_b32 v153, 0
    v_mov_b32 v154, 0
    v_mov_b32 v155, 0
    s_waitcnt vmcnt(0)
    s_barrier
    s_cmp_lg_u32 s45, 0
    s_cbranch_scc1 k3_nopoll_84
    s_mov_b64 exec, 1
    buffer_store_dword v6, v5, s[48:51], s54 offen sc1
    s_mov_b64 exec, -1
    s_mov_b32 s57, 1048576
k3_spin_85:
    buffer_load_dword v7, v5, s[48:51], s55 offen sc1
    s_waitcnt vmcnt(0)
    v_readfirstlane_b32 s58, v7
    s_sub_u32 s57, s57, 1
    s_cselect_b32 s58, 1, s58
    s_cmp_eq_u32 s58, 0
    s_cbranch_scc1 k3_spin_85
k3_nopoll_84:
    s_barrier
    buffer_load_dwordx4 v[96:99], v1, s[36:39], s53 offen offset:0 sc1
    buffer_load_dwordx4 v[100:103], v1, s[36:39], s53 offen offset:1024 sc1
    buffer_load_dwordx4 v[104:107], v1, s[36:39], s53 offen offset:2048 sc1
    buffer_load_dwordx4 v[108:111], v1, s[36:39], s53 offen offset:3072 sc1
    s_waitcnt vmcnt(3)
    v_lshlrev_b32 v56, 16, v96
    v_and_b32 v57, 0xffff0000, v96
    v_lshlrev_b32 v58, 16, v97
    v_and_b32 v59, 0xffff0000, v97
    v_pk_add_f32 v[64:65], v[64:65], v[56:57]
    v_pk_add_f32 v[66:67], v[66:67], v[58:59]
    v_cvt_pk_bf16_f32 v128, v64, v65
    v_cvt_pk_bf16_f32 v129, v66, v67
    v_lshlrev_b32 v64, 16, v128
    v_and_b32 v65, 0xffff0000, v128
    v_lshlrev_b32 v66, 16, v129
    v_and_b32 v67, 0xffff0000, v129
    v_pk_add_f32 v[144:145], v[144:145], v[64:65]
    v_pk_fma_f32 v[146:147], v[64:65], v[64:65], v[146:147]
    v_pk_fma_f32 v[148:149], v[64:65], v[32:33], v[148:149]
    v_pk_add_f32 v[144:145], v[144:145], v[66:67]
    v_pk_fma_f32 v[146:147], v[66:67], v[66:67], v[146:147]
    v_pk_fma_f32 v[148:149], v[66:67], v[34:35], v[148:149]
    v_lshlrev_b32 v56, 16, v98
    v_and_b32 v57, 0xffff0000, v98
    v_lshlrev_b32 v58, 16, v99
    v_and_b32 v59, 0xffff0000, v99
    v_pk_add_f32 v[68:69], v[68:69], v[56:57]
    v_pk_add_f32 v[70:71], v[70:71], v[58:59]
    v_cvt_pk_bf16_f32 v136, v68, v69
    v_cvt_pk_bf16_f32 v137, v70, v71
    v_lshlrev_b32 v68, 16, v136
    v_and_b32 v69, 0xffff0000, v136
    v_lshlrev_b32 v70, 16, v137
    v_and_b32 v71, 0xffff0000, v137
    v_pk_add_f32 v[150:151], v[150:151], v[68:69]
    v_pk_fma_f32 v[152:153], v[68:69], v[68:69], v[152:153]
    v_pk_fma_f32 v[154:155], v[68:69], v[32:33], v[154:155]
    v_pk_add_f32 v[150:151], v[150:151], v[70:71]
    v_pk_fma_f32 v[152:153], v[70:71], v[70:71], v[152:153]
    v_pk_fma_f32 v[154:155], v[70:71], v[34:35], v[154:155]
    s_waitcnt vmcnt(2)
    v_lshlrev_b32 v56, 16, v100
    v_and_b32 v57, 0xffff0000, v100
    v_lshlrev_b32 v58, 16, v101
    v_and_b32 v59, 0xffff0000, v101
    v_pk_add_f32 v[72:73], v[72:73], v[56:57]
    v_pk_add_f32 v[74:75], v[74:75], v[58:59]
    v_cvt_pk_bf16_f32 v130, v72, v73
    v_cvt_pk_bf16_f32 v131, v74, v75
    v_lshlrev_b32 v72, 16, v130
    v_and_b32 v73, 0xffff0000, v130
    v_lshlrev_b32 v74, 16, v131
    v_and_b32 v75, 0xffff0000, v131
    v_permlane16_swap_b32 v128, v130
    v_permlane16_swap_b32 v129, v131
    buffer_store_dwordx4 v[128:131], v3, s[24:27], 0 offen offset:0 sc1
    v_pk_add_f32 v[144:145], v[144:145], v[72:73]
    v_pk_fma_f32 v[146:147], v[72:73], v[72:73], v[146:147]
    v_pk_fma_f32 v[148:149], v[72:73], v[36:37], v[148:149]
    v_pk_add_f32 v[144:145], v[144:145], v[74:75]
    v_pk_fma_f32 v[146:147], v[74:75], v[74:75], v[146:147]
    v_pk_fma_f32 v[148:149], v[74:75], v[38:39], v[148:149]
    v_lshlrev_b32 v56, 16, v102
    v_and_b32 v57, 0xffff0000, v102
    v_lshlrev_b32 v58, 16, v103
    v_and_b32 v59, 0xffff0000, v103
    v_pk_add_f32 v[76:77], v[76:77], v[56:57]
    v_pk_add_f32 v[78:79], v[78:79], v[58:59]
    v_cvt_pk_bf16_f32 v138, v76, v77
    v_cvt_pk_bf16_f32 v139, v78, v79
    v_lshlrev_b32 v76, 16, v138
    v_and_b32 v77, 0xffff0000, v138
    v_lshlrev_b32 v78, 16, v139
    v_and_b32 v79, 0xffff0000, v139
    v_permlane16_swap_b32 v136, v138
    v_permlane16_swap_b32 v137, v139
    buffer_store_dwordx4 v[136:139], v4, s[24:27], 0 offen offset:0 sc1
    v_pk_add_f32 v[150:151], v[150:151], v[76:77]
    v_pk_fma_f32 v[152:153], v[76:77], v[76:77], v[152:153]
    v_pk_fma_f32 v[154:155], v[76:77], v[36:37], v[154:155]
    v_pk_add_f32 v[150:151], v[150:151], v[78:79]
    v_pk_fma_f32 v[152:153], v[78:79], v[78:79], v[152:153]
    v_pk_fma_f32 v[154:155], v[78:79], v[38:39], v[154:155]
    s_waitcnt vmcnt(3)
    v_lshlrev_b32 v56, 16, v104
    v_and_b32 v57, 0xffff0000, v104
    v_lshlrev_b32 v58, 16, v105
    v_and_b32 v59, 0xffff0000, v105
    v_pk_add_f32 v[80:81], v[80:81], v[56:57]
    v_pk_add_f32 v[82:83], v[82:83], v[58:59]
    v_cvt_pk_bf16_f32 v132, v80, v81
    v_cvt_pk_bf16_f32 v133, v82, v83
    v_lshlrev_b32 v80, 16, v132
    v_and_b32 v81, 0xffff0000, v132
    v_lshlrev_b32 v82, 16, v133
    v_and_b32 v83, 0xffff0000, v133
    v_pk_add_f32 v[144:145], v[144:145], v[80:81]
    v_pk_fma_f32 v[146:147], v[80:81], v[80:81], v[146:147]
    v_pk_fma_f32 v[148:149], v[80:81], v[40:41], v[148:149]
    v_pk_add_f32 v[144:145], v[144:145], v[82:83]
    v_pk_fma_f32 v[146:147], v[82:83], v[82:83], v[146:147]
    v_pk_fma_f32 v[148:149], v[82:83], v[42:43], v[148:149]
    v_lshlrev_b32 v56, 16, v106
    v_and_b32 v57, 0xffff0000, v106
    v_lshlrev_b32 v58, 16, v107
    v_and_b32 v59, 0xffff0000, v107
    v_pk_add_f32 v[84:85], v[84:85], v[56:57]
    v_pk_add_f32 v[86:87], v[86:87], v[58:59]
    v_cvt_pk_bf16_f32 v140, v84, v85
    v_cvt_pk_bf16_f32 v141, v86, v87
    v_lshlrev_b32 v84, 16, v140
    v_and_b32 v85, 0xffff0000, v140
    v_lshlrev_b32 v86, 16, v141
    v_and_b32 v87, 0xffff0000, v141
    v_pk_add_f32 v[150:151], v[150:151], v[84:85]
    v_pk_fma_f32 v[152:153], v[84:85], v[84:85], v[152:153]
    v_pk_fma_f32 v[154:155], v[84:85], v[40:41], v[154:155]
    v_pk_add_f32 v[150:151], v[150:151], v[86:87]
    v_pk_fma_f32 v[152:153], v[86:87], v[86:87], v[152:153]
    v_pk_fma_f32 v[154:155], v[86:87], v[42:43], v[154:155]
    s_waitcnt vmcnt(2)
    v_lshlrev_b32 v56, 16, v108
    v_and_b32 v57, 0xffff0000, v108
    v_lshlrev_b32 v58, 16, v109
    v_and_b32 v59, 0xffff0000, v109
    v_pk_add_f32 v[88:89], v[88:89], v[56:57]
    v_pk_add_f32 v[90:91], v[90:91], v[58:59]
    v_cvt_pk_bf16_f32 v134, v88, v89
    v_cvt_pk_bf16_f32 v135, v90, v91
    v_lshlrev_b32 v88, 16, v134
    v_and_b32 v89, 0xffff0000, v134
    v_lshlrev_b32 v90, 16, v135
    v_and_b32 v91, 0xffff0000, v135
    v_permlane16_swap_b32 v132, v134
    v_permlane16_swap_b32 v133, v135
    buffer_store_dwordx4 v[132:135], v3, s[24:27], 0 offen offset:64 sc1
    v_pk_add_f32 v[144:145], v[144:145], v[88:89]
    v_pk_fma_f32 v[146:147], v[88:89], v[88:89], v[146:147]
    v_pk_fma_f32 v[148:149], v[88:89], v[44:45], v[148:149]
    v_pk_add_f32 v[144:145], v[144:145], v[90:91]
    v_pk_fma_f32 v[146:147], v[90:91], v[90:91], v[146:147]
    v_pk_fma_f32 v[148:149], v[90:91], v[46:47], v[148:149]
    v_lshlrev_b32 v56, 16, v110
    v_and_b32 v57, 0xffff0000, v110
    v_lshlrev_b32 v58, 16, v111
    v_and_b32 v59, 0xffff0000, v111
    v_pk_add_f32 v[92:93], v[92:93], v[56:57]
    v_pk_add_f32 v[94:95], v[94:95], v[58:59]
    v_cvt_pk_bf16_f32 v142, v92, v93
    v_cvt_pk_bf16_f32 v143, v94, v95
    v_lshlrev_b32 v92, 16, v142
    v_and_b32 v93, 0xffff0000, v142
    v_lshlrev_b32 v94, 16, v143
    v_and_b32 v95, 0xffff0000, v143
    v_permlane16_swap_b32 v140, v142
    v_permlane16_swap_b32 v141, v143
    buffer_store_dwordx4 v[140:143], v4, s[24:27], 0 offen offset:64 sc1
    v_pk_add_f32 v[150:151], v[150:151], v[92:93]
    v_pk_fma_f32 v[152:153], v[92:93], v[92:93], v[152:153]
    v_pk_fma_f32 v[154:155], v[92:93], v[44:45], v[154:155]
    v_pk_add_f32 v[150:151], v[150:151], v[94:95]
    v_pk_fma_f32 v[152:153], v[94:95], v[94:95], v[152:153]
    v_pk_fma_f32 v[154:155], v[94:95], v[46:47], v[154:155]
    v_add_f32 v48, v144, v145
    v_add_f32 v49, v146, v147
    v_add_f32 v50, v148, v149
    v_add_f32 v52, v150, v151
    v_add_f32 v53, v152, v153
    v_add_f32 v54, v154, v155
    v_mov_b32 v56, v48
    v_mov_b32 v57, v49
    v_mov_b32 v58, v50
    v_mov_b32 v59, v52
    v_mov_b32 v60, v53
    v_mov_b32 v61, v54
    s_nop 1
    v_permlane16_swap_b32 v48, v56
    v_permlane16_swap_b32 v49, v57
    v_permlane16_swap_b32 v50, v58
    v_permlane16_swap_b32 v52, v59
    v_permlane16_swap_b32 v53, v60
    v_permlane16_swap_b32 v54, v61
    s_nop 1
    v_add_f32 v48, v48, v56
    v_add_f32 v49, v49, v57
    v_add_f32 v50, v50, v58
    v_add_f32 v52, v52, v59
    v_add_f32 v53, v53, v60
    v_add_f32 v54, v54, v61
    v_mov_b32 v56, v48
    v_mov_b32 v57, v49
    v_mov_b32 v58, v50
    v_mov_b32 v59, v52
    v_mov_b32 v60, v53
    v_mov_b32 v61, v54
    s_nop 1
    v_permlane32_swap_b32 v48, v56
    v_permlane32_swap_b32 v49, v57
    v_permlane32_swap_b32 v50, v58
    v_permlane32_swap_b32 v52, v59
    v_permlane32_swap_b32 v53, v60
    v_permlane32_swap_b32 v54, v61
    s_nop 1
    v_add_f32 v48, v48, v56
    v_add_f32 v49, v49, v57
    v_add_f32 v50, v50, v58
    v_add_f32 v52, v52, v59
    v_add_f32 v53, v53, v60
    v_add_f32 v54, v54, v61
    v_cmp_eq_u32 s[56:57], 1, v20
    v_cmp_eq_u32 s[58:59], 2, v20
    s_nop 1
    v_cndmask_b32 v48, v48, v49, s[56:57]
    v_cndmask_b32 v48, v48, v50, s[58:59]
    buffer_atomic_add_f32 v48, v2, s[32:35], 0 offen offset:0
    v_cndmask_b32 v52, v52, v53, s[56:57]
    v_cndmask_b32 v52, v52, v54, s[58:59]
    buffer_atomic_add_f32 v52, v2, s[32:35], 0 offen offset:64
k3_end_78:
    s_endpgm
k3_ool_81:
    buffer_load_dwordx2 v[128:129], v3, s[16:19], 0 offen offset:0
    buffer_load_dwordx2 v[130:131], v3, s[16:19], 0 offen offset:32
    buffer_load_dwordx2 v[132:133], v3, s[16:19], 0 offen offset:64
    buffer_load_dwordx2 v[134:135], v3, s[16:19], 0 offen offset:96
    buffer_load_dwordx2 v[136:137], v4, s[16:19], 0 offen offset:0
    buffer_load_dwordx2 v[138:139], v4, s[16:19], 0 offen offset:32
    buffer_load_dwordx2 v[140:141], v4, s[16:19], 0 offen offset:64
    buffer_load_dwordx2 v[142:143], v4, s[16:19], 0 offen offset:96
    buffer_load_dwordx2 v[144:145], v14, s[20:23], 0 offen offset:0
    buffer_load_dwordx2 v[146:147], v14, s[20:23], 0 offen offset:32
    buffer_load_dwordx2 v[148:149], v14, s[20:23], 0 offen offset:64
    buffer_load_dwordx2 v[150:151], v14, s[20:23], 0 offen offset:96
    global_load_dword v7, v[8:9], off
    s_branch k3_oolret_82
.globl k4_kernel
.p2align 8
.type k4_kernel,@function
k4_kernel:
    s_cmp_ge_u32 s2, 256
    s_cbranch_scc1 k4_end_86
    s_load_dwordx8 s[4:11], s[0:1], 56
    s_load_dwordx2 s[12:13], s[0:1], 88
    s_load_dwordx2 s[14:15], s[0:1], 104
    v_lshrrev_b32 v1, 6, v0
    v_and_b32 v2, 63, v0
    v_readfirstlane_b32 s44, v1
    s_and_b32 s45, s2, 7
    s_lshr_b32 s46, s2, 3
    s_mul_i32 s45, s45, 28
    s_add_u32 s45, s45, s46
    v_and_b32 v4, 31, v2
    v_lshrrev_b32 v5, 5, v2
    v_lshlrev_b32 v7, 4, v4
    v_mov_b32 v11, 69632
    v_lshl_add_u32 v12, v2, 2, v11
    v_mov_b32 v13, 0
    ds_write_b32 v12, v13
    s_waitcnt lgkmcnt(0)
    s_barrier
    s_add_u32 s20, s14, 0x4000000
    s_addc_u32 s21, s15, 0
    s_and_b32 s21, s21, 0xffff
    s_mov_b32 s22, 0x400000
    s_mov_b32 s23, 0x00020000
    s_cmp_ge_u32 s44, 4
    s_cbranch_scc1 k4_b_87
    s_cmp_ge_u32 s2, 224
    s_cbranch_scc1 k4_end_86
    s_setprio 3
    s_add_u32 s16, s14, 0x4800000
    s_addc_u32 s17, s15, 0
    s_and_b32 s17, s17, 0xffff
    s_mov_b32 s18, 0x6084
    s_mov_b32 s19, 0x00020000
    v_lshlrev_b32 v3, 5, v0
    s_mov_b32 s48, 0
    buffer_load_dwordx4 v[16:19], v3, s[16:19], s48 offen
    buffer_load_dwordx4 v[20:23], v3, s[16:19], s48 offen offset:16
    s_mov_b32 s48, 8192
    buffer_load_dwordx4 v[24:27], v3, s[16:19], s48 offen
    buffer_load_dwordx4 v[28:31], v3, s[16:19], s48 offen offset:16
    s_mov_b32 s48, 16384
    buffer_load_dwordx4 v[32:35], v3, s[16:19], s48 offen
    buffer_load_dwordx4 v[36:39], v3, s[16:19], s48 offen offset:16
    s_mov_b32 s48, 24704
    buffer_load_dword v10, v13, s[16:19], s48 offen
    s_mov_b32 s32, s10
    s_and_b32 s33, s11, 0xffff
    s_mov_b32 s34, 0x700000
    s_mov_b32 s35, 0x00020000
    s_mov_b32 s52, 0x3a800000
    s_mov_b32 s53, 0x3a800000
    s_mov_b32 s54, 0x7ff
    v_mov_b32 v14, 0x3727c5ac
    v_mov_b32 v15, v14
    v_mov_b32 v8, 0xff800000
    v_mov_b32 v9, v8
    s_waitcnt vmcnt(0)
    v_sub_f32 v10, 0, v10
    v_mov_b32 v11, v10
    v_pk_mul_f32 v[16:17], v[16:17], s[52:53]
    v_pk_fma_f32 v[24:25], v[24:25], s[52:53], v[14:15]
    v_pk_fma_f32 v[32:33], v[16:17], v[10:11], v[32:33]
    v_pk_fma_f32 v[24:25], v[16:17], v[16:17], v[24:25] neg_lo:[1,0,0] neg_hi:[1,0,0]
    v_pk_mul_f32 v[18:19], v[18:19], s[52:53]
    v_pk_fma_f32 v[26:27], v[26:27], s[52:53], v[14:15]
    v_pk_fma_f32 v[34:35], v[18:19], v[10:11], v[34:35]
    v_pk_fma_f32 v[26:27], v[18:19], v[18:19], v[26:27] neg_lo:[1,0,0] neg_hi:[1,0,0]
    v_pk_mul_f32 v[20:21], v[20:21], s[52:53]
    v_pk_fma_f32 v[28:29], v[28:29], s[52:53], v[14:15]
    v_pk_fma_f32 v[36:37], v[20:21], v[10:11], v[36:37]
    v_pk_fma_f32 v[28:29], v[20:21], v[20:21], v[28:29] neg_lo:[1,0,0] neg_hi:[1,0,0]
    v_pk_mul_f32 v[22:23], v[22:23], s[52:53]
    v_pk_fma_f32 v[30:31], v[30:31], s[52:53], v[14:15]
    v_pk_fma_f32 v[38:39], v[22:23], v[10:11], v[38:39]
    v_pk_fma_f32 v[30:31], v[22:23], v[22:23], v[30:31] neg_lo:[1,0,0] neg_hi:[1,0,0]
    v_max_f32 v24, v14, v24
    v_max_f32 v25, v14, v25
    v_max_f32 v26, v14, v26
    v_max_f32 v27, v14, v27
    v_max_f32 v28, v14, v28
    v_max_f32 v29, v14, v29
    v_max_f32 v30, v14, v30
    v_max_f32 v31, v14, v31
    v_rsq_f32 v24, v24
    v_rsq_f32 v25, v25
    v_rsq_f32 v26, v26
    v_rsq_f32 v27, v27
    v_rsq_f32 v28, v28
    v_rsq_f32 v29, v29
    v_rsq_f32 v30, v30
    v_rsq_f32 v31, v31
    v_pk_mul_f32 v[32:33], v[32:33], v[24:25]
    v_pk_mul_f32 v[34:35], v[34:35], v[26:27]
    v_pk_mul_f32 v[36:37], v[36:37], v[28:29]
    v_pk_mul_f32 v[38:39], v[38:39], v[30:31]
    v_bfi_b32 v32, s54, 0, v32
    v_med3_f32 v9, v8, v9, v32
    v_max_f32 v8, v8, v32
    v_bfi_b32 v33, s54, 1, v33
    v_med3_f32 v9, v8, v9, v33
    v_max_f32 v8, v8, v33
    v_bfi_b32 v34, s54, 2, v34
    v_med3_f32 v9, v8, v9, v34
    v_max_f32 v8, v8, v34
    v_bfi_b32 v35, s54, 3, v35
    v_med3_f32 v9, v8, v9, v35
    v_max_f32 v8, v8, v35
    v_bfi_b32 v36, s54, 4, v36
    v_med3_f32 v9, v8, v9, v36
    v_max_f32 v8, v8, v36
    v_bfi_b32 v37, s54, 5, v37
    v_med3_f32 v9, v8, v9, v37
    v_max_f32 v8, v8, v37
    v_bfi_b32 v38, s54, 6, v38
    v_med3_f32 v9, v8, v9, v38
    v_max_f32 v8, v8, v38
    v_bfi_b32 v39, s54, 7, v39
    v_med3_f32 v9, v8, v9, v39
    v_max_f32 v8, v8, v39
    v_lshl_or_b32 v8, v0, 3, v8
    v_lshl_or_b32 v9, v0, 3, v9
    s_nop 1
    v_mov_b32_dpp v10, v8 quad_perm:[1,0,3,2] row_mask:0xf bank_mask:0xf
    v_mov_b32_dpp v11, v9 quad_perm:[1,0,3,2] row_mask:0xf bank_mask:0xf
    v_max_f32 v11, v11, v9
    v_med3_f32 v9, v8, v10, v11
    v_max_f32 v8, v8, v10
    s_nop 1
    v_mov_b32_dpp v10, v8 quad_perm:[2,3,0,1] row_mask:0xf bank_mask:0xf
    v_mov_b32_dpp v11, v9 quad_perm:[2,3,0,1] row_mask:0xf bank_mask:0xf
    v_max_f32 v11, v11, v9
    v_med3_f32 v9, v8, v10, v11
    v_max_f32 v8, v8, v10
    s_nop 1
    v_mov_b32_dpp v10, v8 row_half_mirror row_mask:0xf bank_mask:0xf
    v_mov_b32_dpp v11, v9 row_half_mirror row_mask:0xf bank_mask:0xf
    v_max_f32 v11, v11, v9
    v_med3_f32 v9, v8, v10, v11
    v_max_f32 v8, v8, v10
    s_nop 1
    v_mov_b32_dpp v10, v8 row_mirror row_mask:0xf bank_mask:0xf
    v_mov_b32_dpp v11, v9 row_mirror row_mask:0xf bank_mask:0xf
    v_max_f32 v11, v11, v9
    v_med3_f32 v9, v8, v10, v11
    v_max_f32 v8, v8, v10
    v_mov_b32 v10, v8
    v_mov_b32 v11, v9
    s_nop 1
    v_permlane16_swap_b32 v8, v10
    v_permlane16_swap_b32 v9, v11
    s_nop 1
    v_max_f32 v11, v11, v9
    v_med3_f32 v9, v8, v10, v11
    v_max_f32 v8, v8, v10
    v_mov_b32 v10, v8
    v_mov_b32 v11, v9
    s_nop 1
    v_permlane32_swap_b32 v8, v10
    v_permlane32_swap_b32 v9, v11
    s_nop 1
    v_max_f32 v11, v11, v9
    v_med3_f32 v9, v8, v10, v11
    v_max_f32 v8, v8, v10
    v_mov_b32 v10, 1
    v_mov_b32 v11, 1
    v_lshlrev_b32 v12, 4, v1
    v_add_u32 v12, 69632, v12
    ds_write_b128 v12, v[8:11]
    v_mov_b32 v12, 69632
k4_mail_91:
    ds_read_b128 v[16:19], v12 offset:0
    ds_read_b128 v[20:23], v12 offset:16
    ds_read_b128 v[24:27], v12 offset:32
    ds_read_b128 v[28:31], v12 offset:48
    s_waitcnt lgkmcnt(0)
    v_and_b32 v10, v18, v22
    v_and_b32 v11, v26, v30
    v_and_b32 v10, v10, v11
    v_cmp_eq_u32 vcc, 0, v10
    s_cbranch_vccnz k4_mail_91
    v_max_f32 v21, v21, v17
    v_med3_f32 v17, v16, v20, v21
    v_max_f32 v16, v16, v20
    v_max_f32 v29, v29, v25
    v_med3_f32 v25, v24, v28, v29
    v_max_f32 v24, v24, v28
    v_max_f32 v25, v25, v17
    v_med3_f32 v17, v16, v24, v25
    v_max_f32 v16, v16, v24
    v_cmp_eq_u32 vcc, 0, v5
    s_lshl_b32 s52, s45, 15
    v_lshlrev_b32 v9, 3, v0
    v_cndmask_b32 v11, v17, v16, vcc
    v_and_b32 v15, 0x7ff, v11
    v_lshl_add_u32 v11, v15, 11, v7
    buffer_load_dwordx4 v[40:43], v11, s[20:23], 0 offen offset:0
    buffer_load_dwordx4 v[44:47], v11, s[20:23], 0 offen offset:512
    buffer_load_dwordx4 v[48:51], v11, s[20:23], 0 offen offset:1024
    buffer_load_dwordx4 v[52:55], v11, s[20:23], 0 offen offset:1536
    buffer_load_dwordx2 v[88:89], v9, s[32:35], s52 offen offset:0
    buffer_load_dwordx2 v[90:91], v9, s[32:35], s52 offen offset:2048
    s_add_u32 s52, s52, 4096
    buffer_load_dwordx2 v[92:93], v9, s[32:35], s52 offen offset:0
    buffer_load_dwordx2 v[94:95], v9, s[32:35], s52 offen offset:2048
    s_add_u32 s52, s52, 4096
    buffer_load_dwordx2 v[96:97], v9, s[32:35], s52 offen offset:0
    buffer_load_dwordx2 v[98:99], v9, s[32:35], s52 offen offset:2048
    s_add_u32 s52, s52, 4096
    buffer_load_dwordx2 v[100:101], v9, s[32:35], s52 offen offset:0
    buffer_load_dwordx2 v[102:103], v9, s[32:35], s52 offen offset:2048
    s_add_u32 s52, s52, 4096
    buffer_load_dwordx2 v[104:105], v9, s[32:35], s52 offen offset:0
    buffer_load_dwordx2 v[106:107], v9, s[32:35], s52 offen offset:2048
    s_add_u32 s52, s52, 4096
    buffer_load_dwordx2 v[108:109], v9, s[32:35], s52 offen offset:0
    buffer_load_dwordx2 v[110:111], v9, s[32:35], s52 offen offset:2048
    s_add_u32 s52, s52, 4096
    buffer_load_dwordx2 v[112:113], v9, s[32:35], s52 offen offset:0
    buffer_load_dwordx2 v[114:115], v9, s[32:35], s52 offen offset:2048
    s_add_u32 s52, s52, 4096
    buffer_load_dwordx2 v[116:117], v9, s[32:35], s52 offen offset:0
    buffer_load_dwordx2 v[118:119], v9, s[32:35], s52 offen offset:2048
    s_add_u32 s52, s52, 4096
    s_waitcnt vmcnt(16)
k4_ln_88:
    v_lshlrev_b32 v200, 16, v40
    v_and_b32 v201, 0xffff0000, v40
    v_lshlrev_b32 v202, 16, v41
    v_and_b32 v203, 0xffff0000, v41
    v_lshlrev_b32 v204, 16, v42
    v_and_b32 v205, 0xffff0000, v42
    v_lshlrev_b32 v206, 16, v43
    v_and_b32 v207, 0xffff0000, v43
    v_lshlrev_b32 v208, 16, v44
    v_and_b32 v209, 0xffff0000, v44
    v_lshlrev_b32 v210, 16, v45
    v_and_b32 v211, 0xffff0000, v45
    v_lshlrev_b32 v212, 16, v46
    v_and_b32 v213, 0xffff0000, v46
    v_lshlrev_b32 v214, 16, v47
    v_and_b32 v215, 0xffff0000, v47
    v_lshlrev_b32 v216, 16, v48
    v_and_b32 v217, 0xffff0000, v48
    v_lshlrev_b32 v218, 16, v49
    v_and_b32 v219, 0xffff0000, v49
    v_lshlrev_b32 v220, 16, v50
    v_and_b32 v221, 0xffff0000, v50
    v_lshlrev_b32 v222, 16, v51
    v_and_b32 v223, 0xffff0000, v51
    v_lshlrev_b32 v224, 16, v52
    v_and_b32 v225, 0xffff0000, v52
    v_lshlrev_b32 v226, 16, v53
    v_and_b32 v227, 0xffff0000, v53
    v_lshlrev_b32 v228, 16, v54
    v_and_b32 v229, 0xffff0000, v54
    v_lshlrev_b32 v230, 16, v55
    v_and_b32 v231, 0xffff0000, v55
    v_pk_add_f32 v[192:193], v[200:201], v[202:203]
    v_pk_add_f32 v[194:195], v[204:205], v[206:207]
    v_pk_add_f32 v[192:193], v[192:193], v[208:209]
    v_pk_add_f32 v[194:195], v[194:195], v[210:211]
    v_pk_add_f32 v[192:193], v[192:193], v[212:213]
    v_pk_add_f32 v[194:195], v[194:195], v[214:215]
    v_pk_add_f32 v[192:193], v[192:193], v[216:217]
    v_pk_add_f32 v[194:195], v[194:195], v[218:219]
    v_pk_add_f32 v[192:193], v[192:193], v[220:221]
    v_pk_add_f32 v[194:195], v[194:195], v[222:223]
    v_pk_add_f32 v[192:193], v[192:193], v[224:225]
    v_pk_add_f32 v[194:195], v[194:195], v[226:227]
    v_pk_add_f32 v[192:193], v[192:193], v[228:229]
    v_pk_add_f32 v[194:195], v[194:195], v[230:231]
    v_pk_add_f32 v[192:193], v[192:193], v[194:195]
    v_add_f32 v192, v192, v193
    s_nop 1
    v_add_f32_dpp v192, v192, v192 quad_perm:[1,0,3,2] row_mask:0xf bank_mask:0xf
    s_nop 1
    v_add_f32_dpp v192, v192, v192 quad_perm:[2,3,0,1] row_mask:0xf bank_mask:0xf
    s_nop 1
    v_add_f32_dpp v192, v192, v192 row_half_mirror row_mask:0xf bank_mask:0xf
    s_nop 1
    v_add_f32_dpp v192, v192, v192 row_mirror row_mask:0xf bank_mask:0xf
    v_mov_b32 v194, v192
    s_nop 1
    v_permlane16_swap_b32 v192, v194
    s_nop 1
    v_add_f32 v192, v192, v194
    v_mul_f32 v192, 0xba800000, v192
    v_mov_b32 v193, v192
    v_pk_add_f32 v[194:195], v[200:201], v[192:193]
    v_pk_add_f32 v[198:199], v[202:203], v[192:193]
    v_pk_mul_f32 v[196:197], v[194:195], v[194:195]
    v_pk_fma_f32 v[196:197], v[198:199], v[198:199], v[196:197]
    v_pk_add_f32 v[194:195], v[204:205], v[192:193]
    v_pk_add_f32 v[198:199], v[206:207], v[192:193]
    v_pk_fma_f32 v[196:197], v[194:195], v[194:195], v[196:197]
    v_pk_fma_f32 v[196:197], v[198:199], v[198:199], v[196:197]
    v_pk_add_f32 v[194:195], v[208:209], v[192:193]
    v_pk_add_f32 v[198:199], v[210:211], v[192:193]
    v_pk_fma_f32 v[196:197], v[194:195], v[194:195], v[196:197]
    v_pk_fma_f32 v[196:197], v[198:199], v[198:199], v[196:197]
    v_pk_add_f32 v[194:195], v[212:213], v[192:193]
    v_pk_add_f32 v[198:199], v[214:215], v[192:193]
    v_pk_fma_f32 v[196:197], v[194:195], v[194:195], v[196:197]
    v_pk_fma_f32 v[196:197], v[198:199], v[198:199], v[196:197]
    v_pk_add_f32 v[194:195], v[216:217], v[192:193]
    v_pk_add_f32 v[198:199], v[218:219], v[192:193]
    v_pk_fma_f32 v[196:197], v[194:195], v[194:195], v[196:197]
    v_pk_fma_f32 v[196:197], v[198:199], v[198:199], v[196:197]
    v_pk_add_f32 v[194:195], v[220:221], v[192:193]
    v_pk_add_f32 v[198:199], v[222:223], v[192:193]
    v_pk_fma_f32 v[196:197], v[194:195], v[194:195], v[196:197]
    v_pk_fma_f32 v[196:197], v[198:199], v[198:199], v[196:197]
    v_pk_add_f32 v[194:195], v[224:225], v[192:193]
    v_pk_add_f32 v[198:199], v[226:227], v[192:193]
    v_pk_fma_f32 v[196:197], v[194:195], v[194:195], v[196:197]
    v_pk_fma_f32 v[196:197], v[198:199], v[198:199], v[196:197]
    v_pk_add_f32 v[194:195], v[228:229], v[192:193]
    v_pk_add_f32 v[198:199], v[230:231], v[192:193]
    v_pk_fma_f32 v[196:197], v[194:195], v[194:195], v[196:197]
    v_pk_fma_f32 v[196:197], v[198:199], v[198:199], v[196:197]
    v_add_f32 v196, v196, v197
    s_nop 1
    v_add_f32_dpp v196, v196, v196 quad_perm:[1,0,3,2] row_mask:0xf bank_mask:0xf
    s_nop 1
    v_add_f32_dpp v196, v196, v196 quad_perm:[2,3,0,1] row_mask:0xf bank_mask:0xf
    s_nop 1
    v_add_f32_dpp v196, v196, v196 row_half_mirror row_mask:0xf bank_mask:0xf
    s_nop 1
    v_add_f32_dpp v196, v196, v196 row_mirror row_mask:0xf bank_mask:0xf
    v_mov_b32 v194, v196
    s_nop 1
    v_permlane16_swap_b32 v196, v194
    s_nop 1
    v_add_f32 v196, v196, v194
    v_mul_f32 v196, 0x3a800000, v196
    v_cvt_pk_bf16_f32 v198, v192, v196
    v_and_b32 v196, 0xffff0000, v198
    v_lshlrev_b32 v198, 16, v198
    v_add_f32 v196, 0x3727c5ac, v196
    v_mov_b32 v199, v198
    v_cvt_pk_bf16_f32 v196, v196, v196
    v_and_b32 v196, 0xffff0000, v196
    v_sqrt_f32 v196, v196
    v_pk_add_f32 v[160:161], v[200:201], v[198:199]
    v_pk_add_f32 v[162:163], v[202:203], v[198:199]
    v_pk_add_f32 v[164:165], v[204:205], v[198:199]
    v_pk_add_f32 v[166:167], v[206:207], v[198:199]
    v_pk_add_f32 v[168:169], v[208:209], v[198:199]
    v_pk_add_f32 v[170:171], v[210:211], v[198:199]
    v_pk_add_f32 v[172:173], v[212:213], v[198:199]
    v_pk_add_f32 v[174:175], v[214:215], v[198:199]
    v_pk_add_f32 v[176:177], v[216:217], v[198:199]
    v_pk_add_f32 v[178:179], v[218:219], v[198:199]
    v_pk_add_f32 v[180:181], v[220:221], v[198:199]
    v_pk_add_f32 v[182:183], v[222:223], v[198:199]
    v_pk_add_f32 v[184:185], v[224:225], v[198:199]
    v_pk_add_f32 v[186:187], v[226:227], v[198:199]
    v_pk_add_f32 v[188:189], v[228:229], v[198:199]
    v_pk_add_f32 v[190:191], v[230:231], v[198:199]
    v_cvt_pk_bf16_f32 v196, v196, v196
    v_and_b32 v196, 0xffff0000, v196
    v_rcp_f32 v196, v196
    v_cvt_pk_bf16_f32 v40, v160, v161
    v_cvt_pk_bf16_f32 v41, v162, v163
    v_cvt_pk_bf16_f32 v42, v164, v165
    v_cvt_pk_bf16_f32 v43, v166, v167
    v_cvt_pk_bf16_f32 v44, v168, v169
    v_cvt_pk_bf16_f32 v45, v170, v171
    v_cvt_pk_bf16_f32 v46, v172, v173
    v_cvt_pk_bf16_f32 v47, v174, v175
    v_cvt_pk_bf16_f32 v48, v176, v177
    v_cvt_pk_bf16_f32 v49, v178, v179
    v_cvt_pk_bf16_f32 v50, v180, v181
    v_cvt_pk_bf16_f32 v51, v182, v183
    v_cvt_pk_bf16_f32 v52, v184, v185
    v_cvt_pk_bf16_f32 v53, v186, v187
    v_cvt_pk_bf16_f32 v54, v188, v189
    v_cvt_pk_bf16_f32 v55, v190, v191
    v_mov_b32 v197, v196
    v_lshlrev_b32 v160, 16, v40
    v_and_b32 v161, 0xffff0000, v40
    v_lshlrev_b32 v162, 16, v41
    v_and_b32 v163, 0xffff0000, v41
    v_lshlrev_b32 v164, 16, v42
    v_and_b32 v165, 0xffff0000, v42
    v_lshlrev_b32 v166, 16, v43
    v_and_b32 v167, 0xffff0000, v43
    v_lshlrev_b32 v168, 16, v44
    v_and_b32 v169, 0xffff0000, v44
    v_lshlrev_b32 v170, 16, v45
    v_and_b32 v171, 0xffff0000, v45
    v_lshlrev_b32 v172, 16, v46
    v_and_b32 v173, 0xffff0000, v46
    v_lshlrev_b32 v174, 16, v47
    v_and_b32 v175, 0xffff0000, v47
    v_lshlrev_b32 v176, 16, v48
    v_and_b32 v177, 0xffff0000, v48
    v_lshlrev_b32 v178, 16, v49
    v_and_b32 v179, 0xffff0000, v49
    v_lshlrev_b32 v180, 16, v50
    v_and_b32 v181, 0xffff0000, v50
    v_lshlrev_b32 v182, 16, v51
    v_and_b32 v183, 0xffff0000, v51
    v_lshlrev_b32 v184, 16, v52
    v_and_b32 v185, 0xffff0000, v52
    v_lshlrev_b32 v186, 16, v53
    v_and_b32 v187, 0xffff0000, v53
    v_lshlrev_b32 v188, 16, v54
    v_and_b32 v189, 0xffff0000, v54
    v_lshlrev_b32 v190, 16, v55
    v_and_b32 v191, 0xffff0000, v55
    v_pk_mul_f32 v[160:161], v[160:161], v[196:197]
    v_pk_mul_f32 v[162:163], v[162:163], v[196:197]
    v_pk_mul_f32 v[164:165], v[164:165], v[196:197]
    v_pk_mul_f32 v[166:167], v[166:167], v[196:197]
    v_pk_mul_f32 v[168:169], v[168:169], v[196:197]
    v_pk_mul_f32 v[170:171], v[170:171], v[196:197]
    v_pk_mul_f32 v[172:173], v[172:173], v[196:197]
    v_pk_mul_f32 v[174:175], v[174:175], v[196:197]
    v_pk_mul_f32 v[176:177], v[176:177], v[196:197]
    v_pk_mul_f32 v[178:179], v[178:179], v[196:197]
    v_pk_mul_f32 v[180:181], v[180:181], v[196:197]
    v_pk_mul_f32 v[182:183], v[182:183], v[196:197]
    v_pk_mul_f32 v[184:185], v[184:185], v[196:197]
    v_pk_mul_f32 v[186:187], v[186:187], v[196:197]
    v_pk_mul_f32 v[188:189], v[188:189], v[196:197]
    v_pk_mul_f32 v[190:191], v[190:191], v[196:197]
    v_cvt_pk_bf16_f32 v40, v160, v161
    v_cvt_pk_bf16_f32 v41, v162, v163
    v_cvt_pk_bf16_f32 v42, v164, v165
    v_cvt_pk_bf16_f32 v43, v166, v167
    v_cvt_pk_bf16_f32 v44, v168, v169
    v_cvt_pk_bf16_f32 v45, v170, v171
    v_cvt_pk_bf16_f32 v46, v172, v173
    v_cvt_pk_bf16_f32 v47, v174, v175
    v_cvt_pk_bf16_f32 v48, v176, v177
    v_cvt_pk_bf16_f32 v49, v178, v179
    v_cvt_pk_bf16_f32 v50, v180, v181
    v_cvt_pk_bf16_f32 v51, v182, v183
    v_cvt_pk_bf16_f32 v52, v184, v185
    v_cvt_pk_bf16_f32 v53, v186, v187
    v_cvt_pk_bf16_f32 v54, v188, v189
    v_cvt_pk_bf16_f32 v55, v190, v191
    s_cmp_ge_u32 s44, 4
    s_cbranch_scc1 k4_bout_90
    v_lshl_add_u32 v11, v5, 11, v7
    v_add_u32 v12, 65536, v11
    ds_write_b128 v12, v[40:43] offset:0
    ds_write_b128 v12, v[44:47] offset:512
    ds_write_b128 v12, v[48:51] offset:1024
    ds_write_b128 v12, v[52:55] offset:1536
    s_waitcnt lgkmcnt(0)
k4_mm_89:
    s_barrier
    v_lshrrev_b32 v12, 4, v2
    v_and_b32 v13, 1, v2
    v_lshlrev_b32 v13, 11, v13
    v_lshl_add_u32 v13, v12, 3, v13
    s_lshl_b32 s54, s44, 8
    s_add_u32 s54, s54, 65536
    v_add_u32 v13, s54, v13
    v_lshlrev_b32 v14, 3, v2
    s_lshl_b32 s54, s44, 12
    v_add_u32 v14, s54, v14
    ds_read_b64 v[128:129], v13 offset:0
    ds_read_b64 v[130:131], v13 offset:32
    ds_read_b64_tr_b16 v[144:145], v14 offset:0
    ds_read_b64_tr_b16 v[146:147], v14 offset:512
    ds_read_b64_tr_b16 v[160:161], v14 offset:32768
    ds_read_b64_tr_b16 v[162:163], v14 offset:33280
    ds_read_b64 v[132:133], v13 offset:64
    ds_read_b64 v[134:135], v13 offset:96
    ds_read_b64_tr_b16 v[148:149], v14 offset:1024
    ds_read_b64_tr_b16 v[150:151], v14 offset:1536
    ds_read_b64_tr_b16 v[164:165], v14 offset:33792
    ds_read_b64_tr_b16 v[166:167], v14 offset:34304
    ds_read_b64 v[136:137], v13 offset:128
    ds_read_b64 v[138:139], v13 offset:160
    ds_read_b64_tr_b16 v[152:153], v14 offset:2048
    ds_read_b64_tr_b16 v[154:155], v14 offset:2560
    ds_read_b64_tr_b16 v[168:169], v14 offset:34816
    ds_read_b64_tr_b16 v[170:171], v14 offset:35328
    ds_read_b64 v[140:141], v13 offset:192
    ds_read_b64 v[142:143], v13 offset:224
    ds_read_b64_tr_b16 v[156:157], v14 offset:3072
    ds_read_b64_tr_b16 v[158:159], v14 offset:3584
    ds_read_b64_tr_b16 v[172:173], v14 offset:35840
    ds_read_b64_tr_b16 v[174:175], v14 offset:36352
    v_and_b32 v13, 15, v2
    v_lshlrev_b32 v13, 6, v13
    v_lshl_add_u32 v13, v12, 4, v13
    s_lshl_b32 s54, s44, 11
    s_add_u32 s54, s54, 69888
    v_add_u32 v13, s54, v13
    s_waitcnt lgkmcnt(0)
    v_mfma_f32_16x16x32_bf16 v[16:19], v[144:147], v[128:131], 0
    v_mfma_f32_16x16x32_bf16 v[20:23], v[160:163], v[128:131], 0
    v_mfma_f32_16x16x32_bf16 v[16:19], v[148:151], v[132:135], v[16:19]
    v_mfma_f32_16x16x32_bf16 v[20:23], v[164:167], v[132:135], v[20:23]
    v_mfma_f32_16x16x32_bf16 v[16:19], v[152:155], v[136:139], v[16:19]
    v_mfma_f32_16x16x32_bf16 v[20:23], v[168:171], v[136:139], v[20:23]
    v_mfma_f32_16x16x32_bf16 v[16:19], v[156:159], v[140:143], v[16:19]
    v_mfma_f32_16x16x32_bf16 v[20:23], v[172:175], v[140:143], v[20:23]
    s_nop 7
    ds_write_b128 v13, v[16:19]
    ds_write_b128 v13, v[20:23] offset:1024
    s_waitcnt lgkmcnt(0)
    s_barrier
    s_cmp_ge_u32 s44, 4
    s_cbranch_scc1 k4_ln_88
    v_lshlrev_b32 v13, 2, v4
    v_add_u32 v13, 69888, v13
    ds_read2st64_b32 v[16:17], v13 offset0:0 offset1:4
    ds_read2st64_b32 v[18:19], v13 offset0:8 offset1:12
    ds_read2st64_b32 v[20:21], v13 offset0:16 offset1:20
    ds_read2st64_b32 v[22:23], v13 offset0:24 offset1:28
    ds_read2st64_b32 v[24:25], v13 offset0:32 offset1:36
    ds_read2st64_b32 v[26:27], v13 offset0:40 offset1:44
    ds_read2st64_b32 v[28:29], v13 offset0:48 offset1:52
    ds_read2st64_b32 v[30:31], v13 offset0:56 offset1:60
    s_add_u32 s56, s14, 0x4900000
    s_addc_u32 s57, s15, 0
    s_and_b32 s57, s57, 0xffff
    s_mov_b32 s58, 0x1c0000
    s_mov_b32 s59, 0x00020000
    s_waitcnt lgkmcnt(0)
    v_pk_add_f32 v[16:17], v[16:17], v[24:25]
    v_pk_add_f32 v[18:19], v[18:19], v[26:27]
    v_pk_add_f32 v[20:21], v[20:21], v[28:29]
    v_pk_add_f32 v[22:23], v[22:23], v[30:31]
    v_pk_add_f32 v[16:17], v[16:17], v[20:21]
    v_pk_add_f32 v[18:19], v[18:19], v[22:23]
    v_pk_add_f32 v[16:17], v[16:17], v[18:19]
    v_cvt_pk_bf16_f32 v16, v16, v17
    v_and_b32 v20, 0xffff0000, v16
    v_lshlrev_b32 v16, 16, v16
    v_mul_f32 v17, 0xbfb8aa3b, v16
    v_exp_f32 v17, v17
    s_mov_b32 s54, 0x05040100
    v_add_f32 v17, 1.0, v17
    v_rcp_f32 v17, v17
    s_mov_b32 s55, 0x07060302
    v_mul_f32 v16, v16, v17
    v_cvt_pk_bf16_f32 v16, v16, v16
    v_and_b32 v16, 0xffff0000, v16
    v_mul_f32 v16, v16, v20
    s_nop 1
    v_mov_b32_dpp v17, v16 quad_perm:[1,0,3,2] row_mask:0xf bank_mask:0xf
    v_cvt_pk_bf16_f32 v16, v16, v17
    s_waitcnt vmcnt(0)
    v_readlane_b32 s24, v16, 0
    v_readlane_b32 s25, v16, 2
    v_readlane_b32 s26, v16, 4
    v_readlane_b32 s27, v16, 6
    v_readlane_b32 s28, v16, 8
    v_readlane_b32 s29, v16, 10
    v_readlane_b32 s30, v16, 12
    v_readlane_b32 s31, v16, 14
    v_readlane_b32 s32, v16, 16
    v_readlane_b32 s33, v16, 18
    v_readlane_b32 s34, v16, 20
    v_readlane_b32 s35, v16, 22
    v_readlane_b32 s36, v16, 24
    v_readlane_b32 s37, v16, 26
    v_readlane_b32 s38, v16, 28
    v_readlane_b32 s39, v16, 30
    v_perm_b32 v16, v90, v88, s54
    v_perm_b32 v17, v90, v88, s55
    v_dot2_f32_bf16 v24, v16, s24, 0
    v_dot2_f32_bf16 v25, v17, s24, 0
    v_dot2_f32_bf16 v28, v16, s32, 0
    v_dot2_f32_bf16 v29, v17, s32, 0
    v_perm_b32 v16, v91, v89, s54
    v_perm_b32 v17, v91, v89, s55
    v_dot2_f32_bf16 v26, v16, s24, 0
    v_dot2_f32_bf16 v27, v17, s24, 0
    v_dot2_f32_bf16 v30, v16, s32, 0
    v_dot2_f32_bf16 v31, v17, s32, 0
    v_perm_b32 v16, v94, v92, s54
    v_perm_b32 v17, v94, v92, s55
    v_dot2_f32_bf16 v24, v16, s25, v24
    v_dot2_f32_bf16 v25, v17, s25, v25
    v_dot2_f32_bf16 v28, v16, s33, v28
    v_dot2_f32_bf16 v29, v17, s33, v29
    v_perm_b32 v16, v95, v93, s54
    v_perm_b32 v17, v95, v93, s55
    v_dot2_f32_bf16 v26, v16, s25, v26
    v_dot2_f32_bf16 v27, v17, s25, v27
    v_dot2_f32_bf16 v30, v16, s33, v30
    v_dot2_f32_bf16 v31, v17, s33, v31
    v_perm_b32 v16, v98, v96, s54
    v_perm_b32 v17, v98, v96, s55
    v_dot2_f32_bf16 v24, v16, s26, v24
    v_dot2_f32_bf16 v25, v17, s26, v25
    v_dot2_f32_bf16 v28, v16, s34, v28
    v_dot2_f32_bf16 v29, v17, s34, v29
    v_perm_b32 v16, v99, v97, s54
    v_perm_b32 v17, v99, v97, s55
    v_dot2_f32_bf16 v26, v16, s26, v26
    v_dot2_f32_bf16 v27, v17, s26, v27
    v_dot2_f32_bf16 v30, v16, s34, v30
    v_dot2_f32_bf16 v31, v17, s34, v31
    v_perm_b32 v16, v102, v100, s54
    v_perm_b32 v17, v102, v100, s55
    v_dot2_f32_bf16 v24, v16, s27, v24
    v_dot2_f32_bf16 v25, v17, s27, v25
    v_dot2_f32_bf16 v28, v16, s35, v28
    v_dot2_f32_bf16 v29, v17, s35, v29
    v_perm_b32 v16, v103, v101, s54
    v_perm_b32 v17, v103, v101, s55
    v_dot2_f32_bf16 v26, v16, s27, v26
    v_dot2_f32_bf16 v27, v17, s27, v27
    v_dot2_f32_bf16 v30, v16, s35, v30
    v_dot2_f32_bf16 v31, v17, s35, v31
    v_perm_b32 v16, v106, v104, s54
    v_perm_b32 v17, v106, v104, s55
    v_dot2_f32_bf16 v24, v16, s28, v24
    v_dot2_f32_bf16 v25, v17, s28, v25
    v_dot2_f32_bf16 v28, v16, s36, v28
    v_dot2_f32_bf16 v29, v17, s36, v29
    v_perm_b32 v16, v107, v105, s54
    v_perm_b32 v17, v107, v105, s55
    v_dot2_f32_bf16 v26, v16, s28, v26
    v_dot2_f32_bf16 v27, v17, s28, v27
    v_dot2_f32_bf16 v30, v16, s36, v30
    v_dot2_f32_bf16 v31, v17, s36, v31
    v_perm_b32 v16, v110, v108, s54
    v_perm_b32 v17, v110, v108, s55
    v_dot2_f32_bf16 v24, v16, s29, v24
    v_dot2_f32_bf16 v25, v17, s29, v25
    v_dot2_f32_bf16 v28, v16, s37, v28
    v_dot2_f32_bf16 v29, v17, s37, v29
    v_perm_b32 v16, v111, v109, s54
    v_perm_b32 v17, v111, v109, s55
    v_dot2_f32_bf16 v26, v16, s29, v26
    v_dot2_f32_bf16 v27, v17, s29, v27
    v_dot2_f32_bf16 v30, v16, s37, v30
    v_dot2_f32_bf16 v31, v17, s37, v31
    v_perm_b32 v16, v114, v112, s54
    v_perm_b32 v17, v114, v112, s55
    v_dot2_f32_bf16 v24, v16, s30, v24
    v_dot2_f32_bf16 v25, v17, s30, v25
    v_dot2_f32_bf16 v28, v16, s38, v28
    v_dot2_f32_bf16 v29, v17, s38, v29
    v_perm_b32 v16, v115, v113, s54
    v_perm_b32 v17, v115, v113, s55
    v_dot2_f32_bf16 v26, v16, s30, v26
    v_dot2_f32_bf16 v27, v17, s30, v27
    v_dot2_f32_bf16 v30, v16, s38, v30
    v_dot2_f32_bf16 v31, v17, s38, v31
    v_perm_b32 v16, v118, v116, s54
    v_perm_b32 v17, v118, v116, s55
    v_dot2_f32_bf16 v24, v16, s31, v24
    v_dot2_f32_bf16 v25, v17, s31, v25
    v_dot2_f32_bf16 v28, v16, s39, v28
    v_dot2_f32_bf16 v29, v17, s39, v29
    v_perm_b32 v16, v119, v117, s54
    v_perm_b32 v17, v119, v117, s55
    v_dot2_f32_bf16 v26, v16, s31, v26
    v_dot2_f32_bf16 v27, v17, s31, v27
    v_dot2_f32_bf16 v30, v16, s39, v30
    v_dot2_f32_bf16 v31, v17, s39, v31
    v_lshlrev_b32 v13, 4, v0
    s_lshl_b32 s54, s45, 13
    s_add_u32 s55, s54, 4096
    s_nop 2
    buffer_store_dwordx4 v[24:27], v13, s[56:59], s54 offen sc1
    buffer_store_dwordx4 v[28:31], v13, s[56:59], s55 offen sc1
    s_or_b32 s54, s2, s44
    s_cbranch_scc1 k4_nosel_92
    s_mov_b32 s40, s4
    s_and_b32 s41, s5, 0xffff
    s_mov_b32 s42, 0x800
    s_mov_b32 s43, 0x00020000
    buffer_load_dwordx4 v[56:59], v7, s[40:43], 0 offen offset:0
    buffer_load_dwordx4 v[60:63], v7, s[40:43], 0 offen offset:512
    buffer_load_dwordx4 v[64:67], v7, s[40:43], 0 offen offset:1024
    buffer_load_dwordx4 v[68:71], v7, s[40:43], 0 offen offset:1536
    s_add_u32 s56, s14, 0x4c00000
    s_addc_u32 s57, s15, 0
    s_and_b32 s57, s57, 0xffff
    s_mov_b32 s58, 0x2000
    s_mov_b32 s59, 0x00020000
    s_mov_b32 s54, 4096
    buffer_store_dwordx4 v[40:43], v11, s[56:59], s54 offen offset:0 sc1
    buffer_store_dwordx4 v[44:47], v11, s[56:59], s54 offen offset:512 sc1
    buffer_store_dwordx4 v[48:51], v11, s[56:59], s54 offen offset:1024 sc1
    buffer_store_dwordx4 v[52:55], v11, s[56:59], s54 offen offset:1536 sc1
    s_waitcnt vmcnt(4)
    v_dot2_f32_bf16 v12, v40, v56, 0
    v_dot2_f32_bf16 v12, v41, v57, v12
    v_dot2_f32_bf16 v12, v42, v58, v12
    v_dot2_f32_bf16 v12, v43, v59, v12
    v_dot2_f32_bf16 v12, v44, v60, v12
    v_dot2_f32_bf16 v12, v45, v61, v12
    v_dot2_f32_bf16 v12, v46, v62, v12
    v_dot2_f32_bf16 v12, v47, v63, v12
    v_dot2_f32_bf16 v12, v48, v64, v12
    v_dot2_f32_bf16 v12, v49, v65, v12
    v_dot2_f32_bf16 v12, v50, v66, v12
    v_dot2_f32_bf16 v12, v51, v67, v12
    v_dot2_f32_bf16 v12, v52, v68, v12
    v_dot2_f32_bf16 v12, v53, v69, v12
    v_dot2_f32_bf16 v12, v54, v70, v12
    v_dot2_f32_bf16 v12, v55, v71, v12
    s_nop 2
    s_nop 1
    v_add_f32_dpp v12, v12, v12 quad_perm:[1,0,3,2] row_mask:0xf bank_mask:0xf
    s_nop 1
    v_add_f32_dpp v12, v12, v12 quad_perm:[2,3,0,1] row_mask:0xf bank_mask:0xf
    s_nop 1
    v_add_f32_dpp v12, v12, v12 row_half_mirror row_mask:0xf bank_mask:0xf
    s_nop 1
    v_add_f32_dpp v12, v12, v12 row_mirror row_mask:0xf bank_mask:0xf
    v_mov_b32 v13, v12
    s_nop 1
    v_permlane16_swap_b32 v12, v13
    s_nop 1
    v_add_f32 v12, v12, v13
    v_cvt_pk_bf16_f32 v12, v12, v12
    v_and_b32 v12, 0xffff0000, v12
    v_mul_f32 v12, 0xbfb8aa3b, v12
    v_exp_f32 v12, v12
    s_nop 0
    v_add_f32 v12, 1.0, v12
    v_rcp_f32 v12, v12
    s_nop 0
    v_cvt_pk_bf16_f32 v12, v12, v12
    v_and_b32 v12, 0xffff0000, v12
    v_lshlrev_b32 v13, 2, v5
    buffer_store_dword v15, v13, s[56:59], 0 offen sc1
    buffer_store_dword v12, v13, s[56:59], 0 offen offset:8 sc1
k4_nosel_92:
    s_endpgm
k4_b_87:
    v_lshl_add_u32 v6, v1, 1, v5
    s_lshl_b32 s47, s2, 3
    s_sub_u32 s47, s47, 8
    v_add_u32 v6, s47, v6
    v_lshl_add_u32 v6, v6, 11, v7
    s_mov_b32 s36, s12
    s_and_b32 s37, s13, 0xffff
    s_mov_b32 s38, 0x400000
    s_mov_b32 s39, 0x00020000
    s_cmp_ge_u32 s2, 224
    s_cbranch_scc1 k4_noffn_93
    s_mov_b32 s24, s6
    s_and_b32 s25, s7, 0xffff
    s_mov_b32 s26, 0x700000
    s_mov_b32 s27, 0x00020000
    s_mov_b32 s28, s8
    s_and_b32 s29, s9, 0xffff
    s_mov_b32 s30, 0x700000
    s_mov_b32 s31, 0x00020000
    s_and_b32 s50, s44, 3
    v_lshrrev_b32 v8, 1, v2
    s_lshl_b32 s47, s50, 8
    v_add_u32 v8, s47, v8
    v_mul_u32_u24 v8, 7168, v8
    v_and_b32 v9, 1, v2
    v_lshl_add_u32 v8, v9, 4, v8
    s_lshl_b32 s47, s45, 5
    v_add_u32 v8, s47, v8
    s_and_b32 s49, s45, 3
    s_lshl_b32 s49, s49, 1
    s_lshl_b32 s50, s50, 13
    s_mov_b32 s53, 8
k4_dma_94:
    s_mul_i32 s52, s49, 229376
    s_lshl_b32 s51, s49, 10
    s_add_u32 m0, s51, s50
    s_add_u32 s49, s49, 1
    buffer_load_dwordx4 v8, s[24:27], s52 offen lds
    s_add_u32 m0, m0, 32768
    s_and_b32 s49, s49, 7
    buffer_load_dwordx4 v8, s[28:31], s52 offen lds
    s_sub_u32 s53, s53, 1
    s_cmp_lg_u32 s53, 0
    s_cbranch_scc1 k4_dma_94
    buffer_load_dwordx4 v[40:43], v6, s[20:23], 0 offen offset:0
    buffer_load_dwordx4 v[44:47], v6, s[20:23], 0 offen offset:512
    buffer_load_dwordx4 v[48:51], v6, s[20:23], 0 offen offset:1024
    buffer_load_dwordx4 v[52:55], v6, s[20:23], 0 offen offset:1536
    s_waitcnt vmcnt(0)
    s_branch k4_mm_89
k4_noffn_93:
    buffer_load_dwordx4 v[40:43], v6, s[20:23], 0 offen offset:0
    buffer_load_dwordx4 v[44:47], v6, s[20:23], 0 offen offset:512
    buffer_load_dwordx4 v[48:51], v6, s[20:23], 0 offen offset:1024
    buffer_load_dwordx4 v[52:55], v6, s[20:23], 0 offen offset:1536
    s_waitcnt vmcnt(0)
    s_branch k4_ln_88
k4_bout_90:
    v_lshlrev_b32 v160, 16, v40
    v_and_b32 v161, 0xffff0000, v40
    v_lshlrev_b32 v162, 16, v41
    v_and_b32 v163, 0xffff0000, v41
    v_lshlrev_b32 v164, 16, v42
    v_and_b32 v165, 0xffff0000, v42
    v_lshlrev_b32 v166, 16, v43
    v_and_b32 v167, 0xffff0000, v43
    v_lshlrev_b32 v168, 16, v44
    v_and_b32 v169, 0xffff0000, v44
    v_lshlrev_b32 v170, 16, v45
    v_and_b32 v171, 0xffff0000, v45
    v_lshlrev_b32 v172, 16, v46
    v_and_b32 v173, 0xffff0000, v46
    v_lshlrev_b32 v174, 16, v47
    v_and_b32 v175, 0xffff0000, v47
    v_lshlrev_b32 v176, 16, v48
    v_and_b32 v177, 0xffff0000, v48
    v_lshlrev_b32 v178, 16, v49
    v_and_b32 v179, 0xffff0000, v49
    v_lshlrev_b32 v180, 16, v50
    v_and_b32 v181, 0xffff0000, v50
    v_lshlrev_b32 v182, 16, v51
    v_and_b32 v183, 0xffff0000, v51
    v_lshlrev_b32 v184, 16, v52
    v_and_b32 v185, 0xffff0000, v52
    v_lshlrev_b32 v186, 16, v53
    v_and_b32 v187, 0xffff0000, v53
    v_lshlrev_b32 v188, 16, v54
    v_and_b32 v189, 0xffff0000, v54
    v_lshlrev_b32 v190, 16, v55
    v_and_b32 v191, 0xffff0000, v55
    v_pk_add_f32 v[160:161], v[160:161], v[200:201]
    v_pk_add_f32 v[162:163], v[162:163], v[202:203]
    v_pk_add_f32 v[164:165], v[164:165], v[204:205]
    v_pk_add_f32 v[166:167], v[166:167], v[206:207]
    v_pk_add_f32 v[168:169], v[168:169], v[208:209]
    v_pk_add_f32 v[170:171], v[170:171], v[210:211]
    v_pk_add_f32 v[172:173], v[172:173], v[212:213]
    v_pk_add_f32 v[174:175], v[174:175], v[214:215]
    v_pk_add_f32 v[176:177], v[176:177], v[216:217]
    v_pk_add_f32 v[178:179], v[178:179], v[218:219]
    v_pk_add_f32 v[180:181], v[180:181], v[220:221]
    v_pk_add_f32 v[182:183], v[182:183], v[222:223]
    v_pk_add_f32 v[184:185], v[184:185], v[224:225]
    v_pk_add_f32 v[186:187], v[186:187], v[226:227]
    v_pk_add_f32 v[188:189], v[188:189], v[228:229]
    v_pk_add_f32 v[190:191], v[190:191], v[230:231]
    v_cvt_pk_bf16_f32 v40, v160, v161
    v_cvt_pk_bf16_f32 v41, v162, v163
    v_cvt_pk_bf16_f32 v42, v164, v165
    v_cvt_pk_bf16_f32 v43, v166, v167
    v_cvt_pk_bf16_f32 v44, v168, v169
    v_cvt_pk_bf16_f32 v45, v170, v171
    v_cvt_pk_bf16_f32 v46, v172, v173
    v_cvt_pk_bf16_f32 v47, v174, v175
    v_cvt_pk_bf16_f32 v48, v176, v177
    v_cvt_pk_bf16_f32 v49, v178, v179
    v_cvt_pk_bf16_f32 v50, v180, v181
    v_cvt_pk_bf16_f32 v51, v182, v183
    v_cvt_pk_bf16_f32 v52, v184, v185
    v_cvt_pk_bf16_f32 v53, v186, v187
    v_cvt_pk_bf16_f32 v54, v188, v189
    v_cvt_pk_bf16_f32 v55, v190, v191
    buffer_store_dwordx4 v[40:43], v6, s[36:39], 0 offen offset:0 sc1
    buffer_store_dwordx4 v[44:47], v6, s[36:39], 0 offen offset:512 sc1
    buffer_store_dwordx4 v[48:51], v6, s[36:39], 0 offen offset:1024 sc1
    buffer_store_dwordx4 v[52:55], v6, s[36:39], 0 offen offset:1536 sc1
k4_end_86:
    s_endpgm
.globl k5_kernel
.p2align 8
.type k5_kernel,@function
k5_kernel:
    s_cmp_ge_u32 s2, 64
    s_cbranch_scc1 k5_end_95
    s_load_dwordx2 s[12:13], s[0:1], 88
    s_load_dwordx2 s[14:15], s[0:1], 104
    v_and_b32 v2, 7, v0
    v_lshrrev_b32 v3, 3, v0
    v_lshlrev_b32 v4, 13, v3
    v_lshl_add_u32 v4, v2, 4, v4
    s_lshl_b32 s40, s2, 7
    s_lshr_b32 s41, s2, 5
    s_and_b32 s42, s2, 31
    s_waitcnt lgkmcnt(0)
    s_add_u32 s16, s14, 0x4900000
    s_addc_u32 s17, s15, 0
    s_and_b32 s17, s17, 0xffff
    s_mov_b32 s18, 0x1c0000
    s_mov_b32 s19, 0x00020000
    s_add_u32 s20, s14, 0x4c00000
    s_addc_u32 s21, s15, 0
    s_and_b32 s21, s21, 0xffff
    s_mov_b32 s22, 0x2000
    s_mov_b32 s23, 0x00020000
    s_add_u32 s24, s14, 0x4000000
    s_addc_u32 s25, s15, 0
    s_and_b32 s25, s25, 0xffff
    s_mov_b32 s26, 0x400000
    s_mov_b32 s27, 0x00020000
    s_mov_b32 s28, s12
    s_and_b32 s29, s13, 0xffff
    s_mov_b32 s30, 0x400000
    s_mov_b32 s31, 0x00020000
    s_lshl_b32 s43, s41, 2
    v_mov_b32 v5, s43
    buffer_load_dword v6, v5, s[20:23], 0 offen
    buffer_load_dword v7, v5, s[20:23], 0 offen offset:8
    buffer_load_dwordx4 v[16:19], v4, s[16:19], s40 offen
    s_add_u32 s40, s40, 0x40000
    buffer_load_dwordx4 v[20:23], v4, s[16:19], s40 offen
    s_add_u32 s40, s40, 0x40000
    buffer_load_dwordx4 v[24:27], v4, s[16:19], s40 offen
    s_add_u32 s40, s40, 0x40000
    buffer_load_dwordx4 v[28:31], v4, s[16:19], s40 offen
    s_add_u32 s40, s40, 0x40000
    buffer_load_dwordx4 v[32:35], v4, s[16:19], s40 offen
    s_add_u32 s40, s40, 0x40000
    buffer_load_dwordx4 v[36:39], v4, s[16:19], s40 offen
    s_add_u32 s40, s40, 0x40000
    buffer_load_dwordx4 v[40:43], v4, s[16:19], s40 offen
    s_add_u32 s40, s40, 0x40000
    s_lshl_b32 s44, s42, 6
    v_lshl_add_u32 v8, v2, 3, s44
    s_lshl_b32 s45, s41, 11
    s_add_u32 s45, s45, 4096
    buffer_load_dwordx2 v[10:11], v8, s[20:23], s45 offen
    s_waitcnt vmcnt(8)
    v_and_b32 v6, 0x7ff, v6
    v_lshl_add_u32 v9, v6, 11, v8
    buffer_load_dwordx2 v[12:13], v9, s[24:27], 0 offen
    s_waitcnt vmcnt(2)
    v_pk_add_f32 v[16:17], v[16:17], v[20:21]
    v_pk_add_f32 v[18:19], v[18:19], v[22:23]
    v_pk_add_f32 v[16:17], v[16:17], v[24:25]
    v_pk_add_f32 v[18:19], v[18:19], v[26:27]
    v_pk_add_f32 v[16:17], v[16:17], v[28:29]
    v_pk_add_f32 v[18:19], v[18:19], v[30:31]
    v_pk_add_f32 v[16:17], v[16:17], v[32:33]
    v_pk_add_f32 v[18:19], v[18:19], v[34:35]
    v_pk_add_f32 v[16:17], v[16:17], v[36:37]
    v_pk_add_f32 v[18:19], v[18:19], v[38:39]
    v_pk_add_f32 v[16:17], v[16:17], v[40:41]
    v_pk_add_f32 v[18:19], v[18:19], v[42:43]
    s_nop 1
    v_add_f32_dpp v16, v16, v16 row_ror:8 row_mask:0xf bank_mask:0xf
    v_add_f32_dpp v17, v17, v17 row_ror:8 row_mask:0xf bank_mask:0xf
    v_add_f32_dpp v18, v18, v18 row_ror:8 row_mask:0xf bank_mask:0xf
    v_add_f32_dpp v19, v19, v19 row_ror:8 row_mask:0xf bank_mask:0xf
    v_mov_b32 v20, v16
    v_mov_b32 v21, v17
    v_mov_b32 v22, v18
    v_mov_b32 v23, v19
    s_nop 1
    v_permlane16_swap_b32 v16, v20
    v_permlane16_swap_b32 v17, v21
    v_permlane16_swap_b32 v18, v22
    v_permlane16_swap_b32 v19, v23
    s_nop 1
    v_add_f32 v16, v16, v20
    v_add_f32 v17, v17, v21
    v_add_f32 v18, v18, v22
    v_add_f32 v19, v19, v23
    v_mov_b32 v20, v16
    v_mov_b32 v21, v17
    v_mov_b32 v22, v18
    v_mov_b32 v23, v19
    s_nop 1
    v_permlane32_swap_b32 v16, v20
    v_permlane32_swap_b32 v17, v21
    v_permlane32_swap_b32 v18, v22
    v_permlane32_swap_b32 v19, v23
    s_nop 1
    v_add_f32 v16, v16, v20
    v_add_f32 v17, v17, v21
    v_add_f32 v18, v18, v22
    v_add_f32 v19, v19, v23
    v_lshrrev_b32 v14, 6, v0
    v_lshlrev_b32 v14, 7, v14
    v_lshl_add_u32 v14, v2, 4, v14
    ds_write_b128 v14, v[16:19]
    s_waitcnt lgkmcnt(0)
    s_barrier
    v_lshlrev_b32 v14, 4, v2
    ds_read_b128 v[16:19], v14 offset:0
    ds_read_b128 v[20:23], v14 offset:128
    ds_read_b128 v[24:27], v14 offset:256
    ds_read_b128 v[28:31], v14 offset:384
    s_waitcnt vmcnt(0) lgkmcnt(0)
    v_pk_add_f32 v[16:17], v[16:17], v[20:21]
    v_pk_add_f32 v[18:19], v[18:19], v[22:23]
    v_pk_add_f32 v[16:17], v[16:17], v[24:25]
    v_pk_add_f32 v[18:19], v[18:19], v[26:27]
    v_pk_add_f32 v[16:17], v[16:17], v[28:29]
    v_pk_add_f32 v[18:19], v[18:19], v[30:31]
    v_cvt_pk_bf16_f32 v20, v16, v17
    v_lshlrev_b32 v21, 16, v20
    v_and_b32 v22, 0xffff0000, v20
    v_mul_f32 v21, v21, v7
    v_mul_f32 v22, v22, v7
    v_cvt_pk_bf16_f32 v20, v21, v22
    v_lshlrev_b32 v21, 16, v20
    v_and_b32 v22, 0xffff0000, v20
    v_lshlrev_b32 v23, 16, v10
    v_and_b32 v24, 0xffff0000, v10
    v_add_f32 v21, v21, v23
    v_add_f32 v22, v22, v24
    v_cvt_pk_bf16_f32 v20, v21, v22
    v_lshlrev_b32 v21, 16, v20
    v_and_b32 v22, 0xffff0000, v20
    v_lshlrev_b32 v23, 16, v12
    v_and_b32 v24, 0xffff0000, v12
    v_add_f32 v21, v21, v23
    v_add_f32 v22, v22, v24
    v_cvt_pk_bf16_f32 v26, v21, v22
    v_cvt_pk_bf16_f32 v20, v18, v19
    v_lshlrev_b32 v21, 16, v20
    v_and_b32 v22, 0xffff0000, v20
    v_mul_f32 v21, v21, v7
    v_mul_f32 v22, v22, v7
    v_cvt_pk_bf16_f32 v20, v21, v22
    v_lshlrev_b32 v21, 16, v20
    v_and_b32 v22, 0xffff0000, v20
    v_lshlrev_b32 v23, 16, v11
    v_and_b32 v24, 0xffff0000, v11
    v_add_f32 v21, v21, v23
    v_add_f32 v22, v22, v24
    v_cvt_pk_bf16_f32 v20, v21, v22
    v_lshlrev_b32 v21, 16, v20
    v_and_b32 v22, 0xffff0000, v20
    v_lshlrev_b32 v23, 16, v13
    v_and_b32 v24, 0xffff0000, v13
    v_add_f32 v21, v21, v23
    v_add_f32 v22, v22, v24
    v_cvt_pk_bf16_f32 v27, v21, v22
    v_cmp_gt_u32 vcc, 8, v0
    s_and_saveexec_b64 s[46:47], vcc
    s_cbranch_execz k5_skip_96
    buffer_store_dwordx2 v[26:27], v9, s[28:31], 0 offen
k5_skip_96:
    s_mov_b64 exec, s[46:47]
k5_end_95:
    s_endpgm
code_end:
    s_endpgm
.section .rodata,"a"
.p2align 6
.amdhsa_kernel k12_kernel
  .amdhsa_next_free_vgpr 512
  .amdhsa_next_free_sgpr 102
  .amdhsa_accum_offset 256
  .amdhsa_group_segment_fixed_size 0
  .amdhsa_kernarg_size 112
  .amdhsa_user_sgpr_count 2
  .amdhsa_user_sgpr_kernarg_segment_ptr 1
  .amdhsa_system_sgpr_workgroup_id_x 1
.end_amdhsa_kernel
.p2align 6
.amdhsa_kernel k3_kernel
  .amdhsa_next_free_vgpr 348
  .amdhsa_next_free_sgpr 102
  .amdhsa_accum_offset 156
  .amdhsa_group_segment_fixed_size 0
  .amdhsa_kernarg_size 112
  .amdhsa_user_sgpr_count 2
  .amdhsa_user_sgpr_kernarg_segment_ptr 1
  .amdhsa_system_sgpr_workgroup_id_x 1
.end_amdhsa_kernel
.p2align 6
.amdhsa_kernel k4_kernel
  .amdhsa_next_free_vgpr 232
  .amdhsa_next_free_sgpr 102
  .amdhsa_accum_offset 232
  .amdhsa_group_segment_fixed_size 0
  .amdhsa_kernarg_size 112
  .amdhsa_user_sgpr_count 2
  .amdhsa_user_sgpr_kernarg_segment_ptr 1
  .amdhsa_system_sgpr_workgroup_id_x 1
  .amdhsa_float_denorm_mode_32 3
.end_amdhsa_kernel
.p2align 6
.amdhsa_kernel k5_kernel
  .amdhsa_next_free_vgpr 64
  .amdhsa_next_free_sgpr 102
  .amdhsa_accum_offset 64
  .amdhsa_group_segment_fixed_size 0
  .amdhsa_kernarg_size 112
  .amdhsa_user_sgpr_count 2
  .amdhsa_user_sgpr_kernarg_segment_ptr 1
  .amdhsa_system_sgpr_workgroup_id_x 1
.end_amdhsa_kernel
```

```asm
; @launch kernel=k12_kernel grid=(256,1,1) block=(256,1,1) lds=163840
; @launch kernel=k3_kernel grid=(256,1,1) block=(256,1,1) lds=65536
; @launch kernel=k4_kernel grid=(256,1,1) block=(512,1,1) lds=86272
.amdgcn_target "amdgcn-amd-amdhsa--gfx950"
.text
.globl k12_kernel
.p2align 8
.type k12_kernel,@function
k12_kernel:
    s_cmp_ge_u32 s2, 256
    s_cbranch_scc1 k12_end_1
    s_load_dwordx4 s[36:39], s[0:1], 0
    s_load_dwordx4 s[40:43], s[0:1], 24
    s_load_dwordx2 s[4:5], s[0:1], 16
    s_load_dwordx4 s[60:63], s[0:1], 96
    s_lshr_b32 s59, s2, 3
    s_lshl_b32 s58, s59, 4
    v_add_u32 v6, s58, v0
    v_cmp_gt_u32 vcc, 48, v0
    v_cmp_gt_u32 s[56:57], 64, v0
    s_nop 0
    v_cndmask_b32 v6, v6, v0, vcc
    s_getpc_b64 s[52:53]
pc_2:
    s_add_u32 s52, s52, k12_code0-pc_2
    s_addc_u32 s53, s53, 0
    v_lshlrev_b32 v58, 7, v6
    v_mov_b32 v59, s53
    v_add_co_u32 v58, vcc, s52, v58
    s_nop 1
    v_addc_co_u32 v59, vcc, 0, v59, vcc
k12_code0:
    s_mov_b64 exec, s[56:57]
    s_cbranch_execz k12_nocode_3
    global_load_dword v51, v[58:59], off
k12_nocode_3:
    s_mov_b64 exec, -1
    s_and_b32 s58, s2, 7
    s_lshr_b32 s59, s2, 3
    s_and_b32 s45, s59, 7
    s_lshr_b32 s57, s59, 3
    s_and_b32 s44, s57, 1
    s_lshl_b32 s52, s58, 1
    s_add_u32 s44, s44, s52
    s_lshr_b32 s57, s57, 1
    v_lshrrev_b32 v2, 6, v0
    v_and_b32 v3, 63, v0
    v_readfirstlane_b32 s30, v2
    v_lshlrev_b32 v1, 4, v3
    v_lshrrev_b32 v60, 5, v3
    v_lshl_add_u32 v60, v2, 1, v60
    v_and_b32 v61, 31, v3
    v_lshlrev_b32 v6, 11, v60
    v_lshl_add_u32 v62, v61, 4, v6
    s_lshl_b32 s52, s2, 14
    v_lshrrev_b32 v56, 3, v3
    v_and_b32 v57, 7, v3
    v_lshrrev_b32 v58, 1, v56
    v_xor_b32 v6, v57, v58
    v_xor_b32 v7, 4, v6
    v_lshl_add_u32 v58, v2, 6, v56
    v_lshlrev_b32 v58, 10, v58
    s_lshl_b32 s47, s45, 18
    v_add_u32 v58, s47, v58
    v_lshl_add_u32 v10, v6, 4, v58
    v_lshl_add_u32 v11, v7, 4, v58
    v_add_u32 v17, 54272, v11
    v_add_u32 v16, 47104, v10
    v_add_u32 v15, 39936, v11
    v_add_u32 v14, 32768, v10
    v_add_u32 v13, 21504, v11
    v_add_u32 v12, 14336, v10
    v_add_u32 v11, 7168, v11
    v_add_u32 v10, 0, v10
    v_lshrrev_b32 v6, 5, v3
    v_bfe_u32 v7, v3, 1, 4
    v_and_b32 v59, 1, v3
    v_lshl_add_u32 v58, v2, 4, v6
    v_lshlrev_b32 v58, 13, v58
    v_lshl_add_u32 v58, v59, 4, v58
    s_lshl_b32 s47, s44, 9
    v_add_u32 v58, s47, v58
    v_xor_b32 v7, v7, v6
    v_xor_b32 v6, 0, v7
    v_lshl_add_u32 v6, v6, 5, v58
    v_add_u32 v18, 0, v6
    v_xor_b32 v6, 2, v7
    v_lshl_add_u32 v6, v6, 5, v58
    v_add_u32 v19, 15360, v6
    v_xor_b32 v6, 0, v7
    v_lshl_add_u32 v6, v6, 5, v58
    v_add_u32 v20, 30720, v6
    v_xor_b32 v6, 2, v7
    v_lshl_add_u32 v6, v6, 5, v58
    v_add_u32 v21, 46080, v6
    v_xor_b32 v6, 4, v7
    v_lshl_add_u32 v6, v6, 5, v58
    v_add_u32 v22, 65536, v6
    v_xor_b32 v6, 6, v7
    v_lshl_add_u32 v6, v6, 5, v58
    v_add_u32 v23, 80896, v6
    v_xor_b32 v6, 4, v7
    v_lshl_add_u32 v6, v6, 5, v58
    v_add_u32 v24, 96256, v6
    v_xor_b32 v6, 6, v7
    v_lshl_add_u32 v6, v6, 5, v58
    v_add_u32 v25, 111616, v6
    s_lshl_b32 s48, s30, 13
    s_mov_b32 s49, 0
    s_mov_b32 s50, 0
    s_waitcnt lgkmcnt(0)
    s_mov_b32 s24, s36
    s_and_b32 s25, s37, 0xffff
    s_mov_b32 s26, 0x400000
    s_mov_b32 s27, 0x00020000
    buffer_load_dwordx4 v[64:67], v62, s[24:27], s52 offen offset:0
    buffer_load_dwordx4 v[68:71], v62, s[24:27], s52 offen offset:512
    buffer_load_dwordx4 v[72:75], v62, s[24:27], s52 offen offset:1024
    buffer_load_dwordx4 v[76:79], v62, s[24:27], s52 offen offset:1536
    s_mov_b32 s16, s38
    s_and_b32 s17, s39, 0xffff
    s_mov_b32 s18, 0x200000
    s_mov_b32 s19, 0x00020000
    s_cmp_eq_u32 s57, 0
    s_cselect_b32 s20, s40, s42
    s_cselect_b32 s21, s41, s43
    s_and_b32 s21, s21, 0xffff
    s_mov_b32 s22, 0x400000
    s_mov_b32 s23, 0x00020000
    s_add_u32 m0, s48, 0
    s_nop 0
    buffer_load_dwordx4 v10, s[16:19], s49 offen offset:0 lds
    buffer_load_dwordx4 v11, s[16:19], s49 offen offset:1024 lds
    buffer_load_dwordx4 v12, s[16:19], s49 offen offset:2048 lds
    buffer_load_dwordx4 v13, s[16:19], s49 offen offset:3072 lds
    s_add_u32 m0, s48, 4096
    s_nop 0
    buffer_load_dwordx4 v14, s[16:19], s49 offen offset:0 lds
    buffer_load_dwordx4 v15, s[16:19], s49 offen offset:1024 lds
    buffer_load_dwordx4 v16, s[16:19], s49 offen offset:2048 lds
    buffer_load_dwordx4 v17, s[16:19], s49 offen offset:3072 lds
    s_add_u32 s49, s49, 128
    s_add_u32 m0, s48, 65536
    s_nop 0
    buffer_load_dwordx4 v18, s[20:23], s50 offen offset:0 lds
    buffer_load_dwordx4 v19, s[20:23], s50 offen offset:1024 lds
    buffer_load_dwordx4 v20, s[20:23], s50 offen offset:2048 lds
    buffer_load_dwordx4 v21, s[20:23], s50 offen offset:3072 lds
    s_add_u32 m0, s48, 69632
    s_nop 0
    buffer_load_dwordx4 v22, s[20:23], s50 offen offset:0 lds
    buffer_load_dwordx4 v23, s[20:23], s50 offen offset:1024 lds
    buffer_load_dwordx4 v24, s[20:23], s50 offen offset:2048 lds
    buffer_load_dwordx4 v25, s[20:23], s50 offen offset:3072 lds
    s_add_u32 s50, s50, 0x80000
    s_mov_b64 s[6:7], s[62:63]
    s_add_u32 s8, s6, 0x0
    s_addc_u32 s9, s7, 0
    s_and_b32 s9, s9, 0xffff
    s_mov_b32 s10, 0x400000
    s_mov_b32 s11, 0x00020000
    s_mov_b32 s12, s4
    s_and_b32 s13, s5, 0xffff
    s_mov_b32 s14, 0x800000
    s_mov_b32 s15, 0x00020000
    s_add_u32 s32, s6, 0x1000000
    s_addc_u32 s33, s7, 0
    s_and_b32 s33, s33, 0xffff
    s_mov_b32 s34, 0x2000000
    s_mov_b32 s35, 0x00020000
    s_mov_b32 s24, s60
    s_and_b32 s25, s61, 0xffff
    s_mov_b32 s26, 0x100
    s_mov_b32 s27, 0x00020000
    s_lshl_b32 s28, s58, 2
    s_and_b32 s31, s59, 3
    s_add_u32 s28, s28, s31
    s_lshr_b32 s29, s59, 2
    s_lshl_b32 s42, s29, 7
    s_sub_u32 s43, 1920, s42
    s_lshl_b32 s31, s30, 5
    s_add_u32 s38, s42, s31
    s_add_u32 s39, s43, s31
    s_lshl_b32 s60, s30, 12
    s_mov_b32 s61, 0
    s_mov_b32 s62, 0
    s_lshl_b32 s47, s44, 1
    s_lshr_b32 s52, s30, 1
    s_add_u32 s47, s47, s52
    s_lshl_b32 s47, s47, 14
    s_lshl_b32 s52, s45, 1
    s_and_b32 s53, s30, 1
    s_add_u32 s52, s52, s53
    s_lshl_b32 s52, s52, 20
    s_add_u32 s47, s47, s52
    s_lshl_b32 s52, s57, 24
    s_add_u32 s47, s47, s52
    s_lshl_b32 s54, s44, 8
    s_lshr_b32 s55, s28, 1
    s_lshl_b32 s55, s55, 8
    s_and_b32 s53, s59, 3
    s_add_u32 s53, s53, 1
    s_cmp_eq_u32 s30, 0
    s_cselect_b32 s53, s53, -1
    s_cselect_b32 s46, 6, -1
    v_lshlrev_b32 v6, 13, v56
    v_lshl_add_u32 v50, v57, 7, v6
    s_lshl_b32 s56, s30, 5
    s_add_u32 s56, s56, s59
    s_lshl_b32 s56, s56, 16
    s_lshl_b32 s52, s58, 10
    s_add_u32 s56, s56, s52
    s_lshl_b32 s63, s30, 1
    v_mul_u32_u24 v6, 2064, v60
    v_lshl_add_u32 v6, v61, 4, v6
    v_add_u32 v54, 131072, v6
    v_mul_u32_u24 v7, 2064, v57
    v_lshl_add_u32 v7, v56, 4, v7
    v_lshl_add_u32 v7, v2, 9, v7
    v_add_u32 v55, 131072, v7
    v_lshrrev_b32 v7, 2, v56
    v_lshl_add_u32 v7, v2, 3, v7
    v_lshlrev_b32 v7, 17, v7
    v_and_b32 v6, 3, v56
    v_lshl_add_u32 v7, v6, 8, v7
    v_lshl_add_u32 v7, v57, 4, v7
    s_lshr_b32 s52, s2, 1
    s_lshl_b32 s52, s52, 10
    s_and_b32 s31, s2, 1
    s_lshl_b32 s31, s31, 7
    s_add_u32 s52, s52, s31
    v_add_u32 v53, s52, v7
    v_and_b32 v56, 15, v3
    v_lshrrev_b32 v57, 4, v3
    v_lshrrev_b32 v6, 1, v56
    v_xor_b32 v6, v6, v57
    v_and_b32 v7, 1, v2
    v_lshl_add_u32 v7, v7, 7, v56
    v_lshlrev_b32 v7, 7, v7
    v_lshl_add_u32 v26, v6, 4, v7
    v_xor_b32 v27, 64, v26
    v_lshrrev_b32 v6, 2, v56
    v_and_b32 v58, 1, v57
    v_lshl_add_u32 v58, v58, 2, v6
    v_lshl_add_u32 v59, v57, 3, v6
    v_and_b32 v63, 3, v3
    v_lshlrev_b32 v7, 9, v59
    v_lshrrev_b32 v6, 1, v2
    v_lshl_add_u32 v7, v6, 8, v7
    v_lshl_add_u32 v7, v63, 3, v7
    v_add_u32 v7, 65536, v7
    v_lshlrev_b32 v59, 8, v59
    v_lshl_add_u32 v59, v63, 3, v59
    v_add_u32 v59, 98304, v59
    v_xor_b32 v6, 0, v58
    v_lshl_add_u32 v28, v6, 5, v7
    v_lshl_add_u32 v42, v6, 5, v59
    v_xor_b32 v6, 1, v58
    v_lshl_add_u32 v29, v6, 5, v7
    v_lshl_add_u32 v43, v6, 5, v59
    v_xor_b32 v6, 2, v58
    v_lshl_add_u32 v30, v6, 5, v7
    v_lshl_add_u32 v44, v6, 5, v59
    v_xor_b32 v6, 3, v58
    v_lshl_add_u32 v31, v6, 5, v7
    v_lshl_add_u32 v45, v6, 5, v59
    v_xor_b32 v6, 4, v58
    v_lshl_add_u32 v32, v6, 5, v7
    v_lshl_add_u32 v46, v6, 5, v59
    v_xor_b32 v6, 5, v58
    v_lshl_add_u32 v33, v6, 5, v7
    v_lshl_add_u32 v47, v6, 5, v59
    v_xor_b32 v6, 6, v58
    v_lshl_add_u32 v34, v6, 5, v7
    v_lshl_add_u32 v48, v6, 5, v59
    v_xor_b32 v6, 7, v58
    v_lshl_add_u32 v35, v6, 5, v7
    v_lshl_add_u32 v49, v6, 5, v59
    s_lshl_b32 s31, s38, 6
    v_add_u32 v36, s31, v1
    s_lshl_b32 s31, s39, 6
    v_add_u32 v37, s31, v1
    v_bfe_u32 v6, v3, 1, 3
    v_and_b32 v7, 1, v3
    v_lshl_add_u32 v58, v2, 4, v57
    v_lshlrev_b32 v58, 13, v58
    v_lshl_add_u32 v58, v7, 4, v58
    s_lshl_b32 s31, s28, 8
    v_add_u32 v58, s31, v58
    v_xor_b32 v6, v6, v57
    v_xor_b32 v7, 0, v6
    v_lshl_add_u32 v7, v7, 5, v58
    v_add_u32 v38, 0, v7
    v_xor_b32 v7, 0, v6
    v_lshl_add_u32 v7, v7, 5, v58
    v_add_u32 v39, 31744, v7
    v_xor_b32 v7, 4, v6
    v_lshl_add_u32 v7, v7, 5, v58
    v_add_u32 v40, 63488, v7
    v_xor_b32 v7, 4, v6
    v_lshl_add_u32 v7, v7, 5, v58
    v_add_u32 v41, 95232, v7
    v_lshlrev_b32 v6, 2, v57
    v_sub_u32 v4, v56, v6
    v_mov_b32 v5, 0xff800000
    v_mov_b32 v8, 0
    v_mov_b32 v9, 1
    s_lshl_b32 s52, s59, 2
    s_add_u32 s52, s52, s30
    v_and_b32 v6, 1, v3
    v_lshl_add_u32 v6, s52, 1, v6
    s_getpc_b64 s[40:41]
pc_4:
    s_add_u32 s40, s40, k12_qcode-pc_4
    s_addc_u32 s41, s41, 0
    v_lshlrev_b32 v2, 7, v6
    v_mov_b32 v3, s41
    v_add_co_u32 v2, vcc, s40, v2
    s_nop 1
    v_addc_co_u32 v3, vcc, 0, v3, vcc
    v_mov_b32 v56, 0
    v_mov_b32 v57, 0
    v_mov_b32 v58, 0
    v_mov_b32 v59, 0
    s_nop 1
    v_mfma_f32_32x32x16_bf16 a[128:143], v[56:59], v[56:59], 0
    v_mfma_f32_32x32x16_bf16 a[144:159], v[56:59], v[56:59], 0
    v_mfma_f32_32x32x16_bf16 a[160:175], v[56:59], v[56:59], 0
    v_mfma_f32_32x32x16_bf16 a[176:191], v[56:59], v[56:59], 0
    v_mfma_f32_32x32x16_bf16 v[128:143], v[56:59], v[56:59], 0
    v_mfma_f32_32x32x16_bf16 v[144:159], v[56:59], v[56:59], 0
    v_mfma_f32_32x32x16_bf16 v[160:175], v[56:59], v[56:59], 0
    v_mfma_f32_32x32x16_bf16 v[176:191], v[56:59], v[56:59], 0
    v_mfma_f32_32x32x16_bf16 v[192:207], v[56:59], v[56:59], 0
    v_mfma_f32_32x32x16_bf16 v[208:223], v[56:59], v[56:59], 0
    v_mfma_f32_32x32x16_bf16 v[224:239], v[56:59], v[56:59], 0
    v_mfma_f32_32x32x16_bf16 v[240:255], v[56:59], v[56:59], 0
    s_waitcnt vmcnt(16)
    v_lshlrev_b32 v80, 16, v64
    v_and_b32 v81, 0xffff0000, v64
    v_lshlrev_b32 v82, 16, v65
    v_and_b32 v83, 0xffff0000, v65
    v_lshlrev_b32 v84, 16, v66
    v_and_b32 v85, 0xffff0000, v66
    v_lshlrev_b32 v86, 16, v67
    v_and_b32 v87, 0xffff0000, v67
    v_lshlrev_b32 v88, 16, v68
    v_and_b32 v89, 0xffff0000, v68
    v_lshlrev_b32 v90, 16, v69
    v_and_b32 v91, 0xffff0000, v69
    v_lshlrev_b32 v92, 16, v70
    v_and_b32 v93, 0xffff0000, v70
    v_lshlrev_b32 v94, 16, v71
    v_and_b32 v95, 0xffff0000, v71
    v_lshlrev_b32 v96, 16, v72
    v_and_b32 v97, 0xffff0000, v72
    v_lshlrev_b32 v98, 16, v73
    v_and_b32 v99, 0xffff0000, v73
    v_lshlrev_b32 v100, 16, v74
    v_and_b32 v101, 0xffff0000, v74
    v_lshlrev_b32 v102, 16, v75
    v_and_b32 v103, 0xffff0000, v75
    v_lshlrev_b32 v104, 16, v76
    v_and_b32 v105, 0xffff0000, v76
    v_lshlrev_b32 v106, 16, v77
    v_and_b32 v107, 0xffff0000, v77
    v_lshlrev_b32 v108, 16, v78
    v_and_b32 v109, 0xffff0000, v78
    v_lshlrev_b32 v110, 16, v79
    v_and_b32 v111, 0xffff0000, v79
    v_pk_add_f32 v[112:113], v[80:81], v[82:83]
    v_pk_add_f32 v[114:115], v[84:85], v[86:87]
    v_pk_add_f32 v[112:113], v[112:113], v[88:89]
    v_pk_add_f32 v[114:115], v[114:115], v[90:91]
    v_pk_add_f32 v[112:113], v[112:113], v[92:93]
    v_pk_add_f32 v[114:115], v[114:115], v[94:95]
    v_pk_add_f32 v[112:113], v[112:113], v[96:97]
    v_pk_add_f32 v[114:115], v[114:115], v[98:99]
    v_pk_add_f32 v[112:113], v[112:113], v[100:101]
    v_pk_add_f32 v[114:115], v[114:115], v[102:103]
    v_pk_add_f32 v[112:113], v[112:113], v[104:105]
    v_pk_add_f32 v[114:115], v[114:115], v[106:107]
    v_pk_add_f32 v[112:113], v[112:113], v[108:109]
    v_pk_add_f32 v[114:115], v[114:115], v[110:111]
    v_pk_add_f32 v[112:113], v[112:113], v[114:115]
    v_add_f32 v112, v112, v113
    s_nop 1
    v_add_f32_dpp v112, v112, v112 quad_perm:[1,0,3,2] row_mask:0xf bank_mask:0xf
    s_nop 1
    v_add_f32_dpp v112, v112, v112 quad_perm:[2,3,0,1] row_mask:0xf bank_mask:0xf
    s_nop 1
    v_add_f32_dpp v112, v112, v112 row_half_mirror row_mask:0xf bank_mask:0xf
    s_nop 1
    v_add_f32_dpp v112, v112, v112 row_mirror row_mask:0xf bank_mask:0xf
    v_mov_b32 v114, v112
    s_nop 1
    v_permlane16_swap_b32 v112, v114
    s_nop 1
    v_add_f32 v112, v112, v114
    v_mul_f32 v112, 0xba800000, v112
    v_mov_b32 v113, v112
    v_pk_add_f32 v[114:115], v[80:81], v[112:113]
    v_pk_add_f32 v[118:119], v[82:83], v[112:113]
    v_pk_mul_f32 v[116:117], v[114:115], v[114:115]
    v_pk_fma_f32 v[116:117], v[118:119], v[118:119], v[116:117]
    v_pk_add_f32 v[114:115], v[84:85], v[112:113]
    v_pk_add_f32 v[118:119], v[86:87], v[112:113]
    v_pk_fma_f32 v[116:117], v[114:115], v[114:115], v[116:117]
    v_pk_fma_f32 v[116:117], v[118:119], v[118:119], v[116:117]
    v_pk_add_f32 v[114:115], v[88:89], v[112:113]
    v_pk_add_f32 v[118:119], v[90:91], v[112:113]
    v_pk_fma_f32 v[116:117], v[114:115], v[114:115], v[116:117]
    v_pk_fma_f32 v[116:117], v[118:119], v[118:119], v[116:117]
    v_pk_add_f32 v[114:115], v[92:93], v[112:113]
    v_pk_add_f32 v[118:119], v[94:95], v[112:113]
    v_pk_fma_f32 v[116:117], v[114:115], v[114:115], v[116:117]
    v_pk_fma_f32 v[116:117], v[118:119], v[118:119], v[116:117]
    v_pk_add_f32 v[114:115], v[96:97], v[112:113]
    v_pk_add_f32 v[118:119], v[98:99], v[112:113]
    v_pk_fma_f32 v[116:117], v[114:115], v[114:115], v[116:117]
    v_pk_fma_f32 v[116:117], v[118:119], v[118:119], v[116:117]
    v_pk_add_f32 v[114:115], v[100:101], v[112:113]
    v_pk_add_f32 v[118:119], v[102:103], v[112:113]
    v_pk_fma_f32 v[116:117], v[114:115], v[114:115], v[116:117]
    v_pk_fma_f32 v[116:117], v[118:119], v[118:119], v[116:117]
    v_pk_add_f32 v[114:115], v[104:105], v[112:113]
    v_pk_add_f32 v[118:119], v[106:107], v[112:113]
    v_pk_fma_f32 v[116:117], v[114:115], v[114:115], v[116:117]
    v_pk_fma_f32 v[116:117], v[118:119], v[118:119], v[116:117]
    v_pk_add_f32 v[114:115], v[108:109], v[112:113]
    v_pk_add_f32 v[118:119], v[110:111], v[112:113]
    v_pk_fma_f32 v[116:117], v[114:115], v[114:115], v[116:117]
    v_pk_fma_f32 v[116:117], v[118:119], v[118:119], v[116:117]
    v_add_f32 v116, v116, v117
    s_nop 1
    v_add_f32_dpp v116, v116, v116 quad_perm:[1,0,3,2] row_mask:0xf bank_mask:0xf
    s_nop 1
    v_add_f32_dpp v116, v116, v116 quad_perm:[2,3,0,1] row_mask:0xf bank_mask:0xf
    s_nop 1
    v_add_f32_dpp v116, v116, v116 row_half_mirror row_mask:0xf bank_mask:0xf
    s_nop 1
    v_add_f32_dpp v116, v116, v116 row_mirror row_mask:0xf bank_mask:0xf
    v_mov_b32 v114, v116
    s_nop 1
    v_permlane16_swap_b32 v116, v114
    s_nop 1
    v_add_f32 v116, v116, v114
    v_mul_f32 v116, 0x3a800000, v116
    v_cvt_pk_bf16_f32 v118, v112, v116
    v_and_b32 v116, 0xffff0000, v118
    v_lshlrev_b32 v118, 16, v118
    v_add_f32 v116, 0x3727c5ac, v116
    v_mov_b32 v119, v118
    v_cvt_pk_bf16_f32 v116, v116, v116
    v_and_b32 v116, 0xffff0000, v116
    v_sqrt_f32 v116, v116
    v_pk_add_f32 v[80:81], v[80:81], v[118:119]
    v_pk_add_f32 v[82:83], v[82:83], v[118:119]
    v_pk_add_f32 v[84:85], v[84:85], v[118:119]
    v_pk_add_f32 v[86:87], v[86:87], v[118:119]
    v_pk_add_f32 v[88:89], v[88:89], v[118:119]
    v_pk_add_f32 v[90:91], v[90:91], v[118:119]
    v_pk_add_f32 v[92:93], v[92:93], v[118:119]
    v_pk_add_f32 v[94:95], v[94:95], v[118:119]
    v_pk_add_f32 v[96:97], v[96:97], v[118:119]
    v_pk_add_f32 v[98:99], v[98:99], v[118:119]
    v_pk_add_f32 v[100:101], v[100:101], v[118:119]
    v_pk_add_f32 v[102:103], v[102:103], v[118:119]
    v_pk_add_f32 v[104:105], v[104:105], v[118:119]
    v_pk_add_f32 v[106:107], v[106:107], v[118:119]
    v_pk_add_f32 v[108:109], v[108:109], v[118:119]
    v_pk_add_f32 v[110:111], v[110:111], v[118:119]
    v_cvt_pk_bf16_f32 v116, v116, v116
    v_and_b32 v116, 0xffff0000, v116
    v_rcp_f32 v116, v116
    v_cvt_pk_bf16_f32 v64, v80, v81
    v_cvt_pk_bf16_f32 v65, v82, v83
    v_cvt_pk_bf16_f32 v66, v84, v85
    v_cvt_pk_bf16_f32 v67, v86, v87
    v_cvt_pk_bf16_f32 v68, v88, v89
    v_cvt_pk_bf16_f32 v69, v90, v91
    v_cvt_pk_bf16_f32 v70, v92, v93
    v_cvt_pk_bf16_f32 v71, v94, v95
    v_cvt_pk_bf16_f32 v72, v96, v97
    v_cvt_pk_bf16_f32 v73, v98, v99
    v_cvt_pk_bf16_f32 v74, v100, v101
    v_cvt_pk_bf16_f32 v75, v102, v103
    v_cvt_pk_bf16_f32 v76, v104, v105
    v_cvt_pk_bf16_f32 v77, v106, v107
    v_cvt_pk_bf16_f32 v78, v108, v109
    v_cvt_pk_bf16_f32 v79, v110, v111
    v_mov_b32 v117, v116
    v_lshlrev_b32 v80, 16, v64
    v_and_b32 v81, 0xffff0000, v64
    v_lshlrev_b32 v82, 16, v65
    v_and_b32 v83, 0xffff0000, v65
    v_lshlrev_b32 v84, 16, v66
    v_and_b32 v85, 0xffff0000, v66
    v_lshlrev_b32 v86, 16, v67
    v_and_b32 v87, 0xffff0000, v67
    v_lshlrev_b32 v88, 16, v68
    v_and_b32 v89, 0xffff0000, v68
    v_lshlrev_b32 v90, 16, v69
    v_and_b32 v91, 0xffff0000, v69
    v_lshlrev_b32 v92, 16, v70
    v_and_b32 v93, 0xffff0000, v70
    v_lshlrev_b32 v94, 16, v71
    v_and_b32 v95, 0xffff0000, v71
    v_lshlrev_b32 v96, 16, v72
    v_and_b32 v97, 0xffff0000, v72
    v_lshlrev_b32 v98, 16, v73
    v_and_b32 v99, 0xffff0000, v73
    v_lshlrev_b32 v100, 16, v74
    v_and_b32 v101, 0xffff0000, v74
    v_lshlrev_b32 v102, 16, v75
    v_and_b32 v103, 0xffff0000, v75
    v_lshlrev_b32 v104, 16, v76
    v_and_b32 v105, 0xffff0000, v76
    v_lshlrev_b32 v106, 16, v77
    v_and_b32 v107, 0xffff0000, v77
    v_lshlrev_b32 v108, 16, v78
    v_and_b32 v109, 0xffff0000, v78
    v_lshlrev_b32 v110, 16, v79
    v_and_b32 v111, 0xffff0000, v79
    v_pk_mul_f32 v[80:81], v[80:81], v[116:117]
    v_pk_mul_f32 v[82:83], v[82:83], v[116:117]
    v_pk_mul_f32 v[84:85], v[84:85], v[116:117]
    v_pk_mul_f32 v[86:87], v[86:87], v[116:117]
    v_pk_mul_f32 v[88:89], v[88:89], v[116:117]
    v_pk_mul_f32 v[90:91], v[90:91], v[116:117]
    v_pk_mul_f32 v[92:93], v[92:93], v[116:117]
    v_pk_mul_f32 v[94:95], v[94:95], v[116:117]
    v_pk_mul_f32 v[96:97], v[96:97], v[116:117]
    v_pk_mul_f32 v[98:99], v[98:99], v[116:117]
    v_pk_mul_f32 v[100:101], v[100:101], v[116:117]
    v_pk_mul_f32 v[102:103], v[102:103], v[116:117]
    v_pk_mul_f32 v[104:105], v[104:105], v[116:117]
    v_pk_mul_f32 v[106:107], v[106:107], v[116:117]
    v_pk_mul_f32 v[108:109], v[108:109], v[116:117]
    v_pk_mul_f32 v[110:111], v[110:111], v[116:117]
    v_cvt_pk_bf16_f32 v64, v80, v81
    v_cvt_pk_bf16_f32 v65, v82, v83
    v_cvt_pk_bf16_f32 v66, v84, v85
    v_cvt_pk_bf16_f32 v67, v86, v87
    v_cvt_pk_bf16_f32 v68, v88, v89
    v_cvt_pk_bf16_f32 v69, v90, v91
    v_cvt_pk_bf16_f32 v70, v92, v93
    v_cvt_pk_bf16_f32 v71, v94, v95
    v_cvt_pk_bf16_f32 v72, v96, v97
    v_cvt_pk_bf16_f32 v73, v98, v99
    v_cvt_pk_bf16_f32 v74, v100, v101
    v_cvt_pk_bf16_f32 v75, v102, v103
    v_cvt_pk_bf16_f32 v76, v104, v105
    v_cvt_pk_bf16_f32 v77, v106, v107
    v_cvt_pk_bf16_f32 v78, v108, v109
    v_cvt_pk_bf16_f32 v79, v110, v111
    ds_write_b128 v54, v[64:67] offset:0
    ds_write_b128 v54, v[68:71] offset:512
    ds_write_b128 v54, v[72:75] offset:1024
    ds_write_b128 v54, v[76:79] offset:1536
    s_add_u32 m0, s48, 32768
    s_nop 0
    buffer_load_dwordx4 v10, s[16:19], s49 offen offset:0 lds
    buffer_load_dwordx4 v11, s[16:19], s49 offen offset:1024 lds
    buffer_load_dwordx4 v12, s[16:19], s49 offen offset:2048 lds
    buffer_load_dwordx4 v13, s[16:19], s49 offen offset:3072 lds
    s_add_u32 m0, s48, 36864
    s_nop 0
    buffer_load_dwordx4 v14, s[16:19], s49 offen offset:0 lds
    buffer_load_dwordx4 v15, s[16:19], s49 offen offset:1024 lds
    buffer_load_dwordx4 v16, s[16:19], s49 offen offset:2048 lds
    buffer_load_dwordx4 v17, s[16:19], s49 offen offset:3072 lds
    s_add_u32 s49, s49, 128
    s_add_u32 m0, s48, 98304
    s_nop 0
    buffer_load_dwordx4 v18, s[20:23], s50 offen offset:0 lds
    buffer_load_dwordx4 v19, s[20:23], s50 offen offset:1024 lds
    buffer_load_dwordx4 v20, s[20:23], s50 offen offset:2048 lds
    buffer_load_dwordx4 v21, s[20:23], s50 offen offset:3072 lds
    s_add_u32 m0, s48, 102400
    s_nop 0
    buffer_load_dwordx4 v22, s[20:23], s50 offen offset:0 lds
    buffer_load_dwordx4 v23, s[20:23], s50 offen offset:1024 lds
    buffer_load_dwordx4 v24, s[20:23], s50 offen offset:2048 lds
    buffer_load_dwordx4 v25, s[20:23], s50 offen offset:3072 lds
    s_add_u32 s50, s50, 0x80000
    s_waitcnt vmcnt(16) lgkmcnt(0)
    s_barrier
    ds_read_b128 a[192:195], v55 offset:0
    ds_read_b128 a[196:199], v55 offset:128
    ds_read_b128 a[200:203], v55 offset:256
    ds_read_b128 a[204:207], v55 offset:384
    v_mfma_f32_32x32x16_bf16 v[64:79], v[56:59], v[56:59], 0
    v_mfma_f32_32x32x16_bf16 v[80:95], v[56:59], v[56:59], 0
    v_mfma_f32_32x32x16_bf16 v[96:111], v[56:59], v[56:59], 0
    v_mfma_f32_32x32x16_bf16 v[112:127], v[56:59], v[56:59], 0
    s_cmp_ge_u32 s2, 17
    s_cbranch_scc1 k12_nostat_5
    s_lshl_b32 s52, s2, 12
    s_add_u32 s52, s52, 0x3800000
    s_mov_b32 s34, -1
    v_lshlrev_b32 v6, 4, v0
    buffer_store_dwordx4 v[56:59], v6, s[32:35], s52 offen sc1
    s_mov_b32 s34, 0x2000000
k12_nostat_5:
    ds_read_b128 a[0:3], v26 offset:0
    ds_read_b64_tr_b16 a[32:33], v28 offset:0
    ds_read_b64_tr_b16 a[34:35], v28 offset:2048
    ds_read_b128 a[4:7], v26 offset:2048
    ds_read_b64_tr_b16 a[36:37], v29 offset:0
    ds_read_b64_tr_b16 a[38:39], v29 offset:2048
    ds_read_b128 a[8:11], v26 offset:4096
    ds_read_b64_tr_b16 a[40:41], v30 offset:0
    ds_read_b64_tr_b16 a[42:43], v30 offset:2048
    ds_read_b128 a[12:15], v26 offset:6144
    ds_read_b64_tr_b16 a[44:45], v31 offset:0
    ds_read_b64_tr_b16 a[46:47], v31 offset:2048
    ds_read_b128 a[16:19], v26 offset:8192
    ds_read_b64_tr_b16 a[48:49], v32 offset:0
    ds_read_b64_tr_b16 a[50:51], v32 offset:2048
    ds_read_b128 a[20:23], v26 offset:10240
    ds_read_b64_tr_b16 a[52:53], v33 offset:0
    ds_read_b64_tr_b16 a[54:55], v33 offset:2048
    ds_read_b128 a[24:27], v26 offset:12288
    ds_read_b64_tr_b16 a[56:57], v34 offset:0
    ds_read_b64_tr_b16 a[58:59], v34 offset:2048
    ds_read_b128 a[28:31], v26 offset:14336
    ds_read_b64_tr_b16 a[60:61], v35 offset:0
    ds_read_b64_tr_b16 a[62:63], v35 offset:2048
    s_mov_b32 s51, 0
    s_waitcnt lgkmcnt(15)
    s_mov_b32 s52, 0
    buffer_store_dwordx4 a[192:195], v53, s[8:11], s52 offen sc1
    s_mov_b32 s52, 262144
    buffer_store_dwordx4 a[196:199], v53, s[8:11], s52 offen sc1
    s_mov_b32 s52, 524288
    buffer_store_dwordx4 a[200:203], v53, s[8:11], s52 offen sc1
    s_mov_b32 s52, 786432
    buffer_store_dwordx4 a[204:207], v53, s[8:11], s52 offen sc1
    s_waitcnt lgkmcnt(0)
    s_cmp_lg_u32 s57, 0
    s_cbranch_scc1 k12_v_6
k12_loop_8:
    v_mfma_f32_16x16x32_bf16 v[64:67], a[32:35], a[0:3], v[64:67]
    ds_read_b128 a[64:67], v27 offset:0
    v_mfma_f32_16x16x32_bf16 v[80:83], a[32:35], a[4:7], v[80:83]
    ds_read_b64_tr_b16 a[96:97], v28 offset:16384
    v_mfma_f32_16x16x32_bf16 v[96:99], a[32:35], a[8:11], v[96:99]
    v_mfma_f32_16x16x32_bf16 v[112:115], a[32:35], a[12:15], v[112:115]
    s_cmp_eq_u32 s51, s46
    s_cbranch_scc1 k12_ool_10
k12_oolret_11:
    v_mfma_f32_16x16x32_bf16 v[128:131], a[32:35], a[16:19], v[128:131]
    ds_read_b64_tr_b16 a[98:99], v28 offset:18432
    v_mfma_f32_16x16x32_bf16 v[144:147], a[32:35], a[20:23], v[144:147]
    ds_read_b128 a[68:71], v27 offset:2048
    v_mfma_f32_16x16x32_bf16 a[128:131], a[32:35], a[24:27], a[128:131]
    v_mfma_f32_16x16x32_bf16 a[160:163], a[32:35], a[28:31], a[160:163]
    ds_read_b64_tr_b16 a[100:101], v29 offset:16384
    v_mfma_f32_16x16x32_bf16 v[160:163], a[36:39], a[0:3], v[160:163]
    v_mfma_f32_16x16x32_bf16 v[176:179], a[36:39], a[4:7], v[176:179]
    ds_read_b64_tr_b16 a[102:103], v29 offset:18432
    v_mfma_f32_16x16x32_bf16 v[192:195], a[36:39], a[8:11], v[192:195]
    v_mfma_f32_16x16x32_bf16 v[208:211], a[36:39], a[12:15], v[208:211]
    ds_read_b128 a[72:75], v27 offset:4096
    v_mfma_f32_16x16x32_bf16 v[224:227], a[36:39], a[16:19], v[224:227]
    v_mfma_f32_16x16x32_bf16 v[240:243], a[36:39], a[20:23], v[240:243]
    v_mfma_f32_16x16x32_bf16 a[132:135], a[36:39], a[24:27], a[132:135]
    ds_read_b64_tr_b16 a[104:105], v30 offset:16384
    v_mfma_f32_16x16x32_bf16 a[164:167], a[36:39], a[28:31], a[164:167]
    v_mfma_f32_16x16x32_bf16 v[68:71], a[40:43], a[0:3], v[68:71]
    ds_read_b64_tr_b16 a[106:107], v30 offset:18432
    v_mfma_f32_16x16x32_bf16 v[84:87], a[40:43], a[4:7], v[84:87]
    v_mfma_f32_16x16x32_bf16 v[100:103], a[40:43], a[8:11], v[100:103]
    ds_read_b128 a[76:79], v27 offset:6144
    v_mfma_f32_16x16x32_bf16 v[116:119], a[40:43], a[12:15], v[116:119]
    v_mfma_f32_16x16x32_bf16 v[132:135], a[40:43], a[16:19], v[132:135]
    ds_read_b64_tr_b16 a[108:109], v31 offset:16384
    v_mfma_f32_16x16x32_bf16 v[148:151], a[40:43], a[20:23], v[148:151]
    v_mfma_f32_16x16x32_bf16 a[136:139], a[40:43], a[24:27], a[136:139]
    ds_read_b64_tr_b16 a[110:111], v31 offset:18432
    v_mfma_f32_16x16x32_bf16 a[168:171], a[40:43], a[28:31], a[168:171]
    v_mfma_f32_16x16x32_bf16 v[164:167], a[44:47], a[0:3], v[164:167]
    ds_read_b128 a[80:83], v27 offset:8192
    v_mfma_f32_16x16x32_bf16 v[180:183], a[44:47], a[4:7], v[180:183]
    v_mfma_f32_16x16x32_bf16 v[196:199], a[44:47], a[8:11], v[196:199]
    ds_read_b64_tr_b16 a[112:113], v32 offset:16384
    v_mfma_f32_16x16x32_bf16 v[212:215], a[44:47], a[12:15], v[212:215]
    v_mfma_f32_16x16x32_bf16 v[228:231], a[44:47], a[16:19], v[228:231]
    ds_read_b64_tr_b16 a[114:115], v32 offset:18432
    v_mfma_f32_16x16x32_bf16 v[244:247], a[44:47], a[20:23], v[244:247]
    v_mfma_f32_16x16x32_bf16 a[140:143], a[44:47], a[24:27], a[140:143]
    ds_read_b128 a[84:87], v27 offset:10240
    v_mfma_f32_16x16x32_bf16 a[172:175], a[44:47], a[28:31], a[172:175]
    v_mfma_f32_16x16x32_bf16 v[72:75], a[48:51], a[0:3], v[72:75]
    ds_read_b64_tr_b16 a[116:117], v33 offset:16384
    v_mfma_f32_16x16x32_bf16 v[88:91], a[48:51], a[4:7], v[88:91]
    v_mfma_f32_16x16x32_bf16 v[104:107], a[48:51], a[8:11], v[104:107]
    ds_read_b64_tr_b16 a[118:119], v33 offset:18432
    v_mfma_f32_16x16x32_bf16 v[120:123], a[48:51], a[12:15], v[120:123]
    v_mfma_f32_16x16x32_bf16 v[136:139], a[48:51], a[16:19], v[136:139]
    ds_read_b128 a[88:91], v27 offset:12288
    v_mfma_f32_16x16x32_bf16 v[152:155], a[48:51], a[20:23], v[152:155]
    v_mfma_f32_16x16x32_bf16 a[144:147], a[48:51], a[24:27], a[144:147]
    v_mfma_f32_16x16x32_bf16 a[176:179], a[48:51], a[28:31], a[176:179]
    ds_read_b64_tr_b16 a[120:121], v34 offset:16384
    v_mfma_f32_16x16x32_bf16 v[168:171], a[52:55], a[0:3], v[168:171]
    v_mfma_f32_16x16x32_bf16 v[184:187], a[52:55], a[4:7], v[184:187]
    ds_read_b64_tr_b16 a[122:123], v34 offset:18432
    v_mfma_f32_16x16x32_bf16 v[200:203], a[52:55], a[8:11], v[200:203]
    v_mfma_f32_16x16x32_bf16 v[216:219], a[52:55], a[12:15], v[216:219]
    ds_read_b128 a[92:95], v27 offset:14336
    v_mfma_f32_16x16x32_bf16 v[232:235], a[52:55], a[16:19], v[232:235]
    v_mfma_f32_16x16x32_bf16 v[248:251], a[52:55], a[20:23], v[248:251]
    ds_read_b64_tr_b16 a[124:125], v35 offset:16384
    v_mfma_f32_16x16x32_bf16 a[148:151], a[52:55], a[24:27], a[148:151]
    v_mfma_f32_16x16x32_bf16 a[180:183], a[52:55], a[28:31], a[180:183]
    ds_read_b64_tr_b16 a[126:127], v35 offset:18432
    v_mfma_f32_16x16x32_bf16 v[76:79], a[56:59], a[0:3], v[76:79]
    v_mfma_f32_16x16x32_bf16 v[92:95], a[56:59], a[4:7], v[92:95]
    v_mfma_f32_16x16x32_bf16 v[108:111], a[56:59], a[8:11], v[108:111]
    v_mfma_f32_16x16x32_bf16 v[124:127], a[56:59], a[12:15], v[124:127]
    v_mfma_f32_16x16x32_bf16 v[140:143], a[56:59], a[16:19], v[140:143]
    v_mfma_f32_16x16x32_bf16 v[156:159], a[56:59], a[20:23], v[156:159]
    v_mfma_f32_16x16x32_bf16 a[152:155], a[56:59], a[24:27], a[152:155]
    v_mfma_f32_16x16x32_bf16 a[184:187], a[56:59], a[28:31], a[184:187]
    v_mfma_f32_16x16x32_bf16 v[172:175], a[60:63], a[0:3], v[172:175]
    v_mfma_f32_16x16x32_bf16 v[188:191], a[60:63], a[4:7], v[188:191]
    v_mfma_f32_16x16x32_bf16 v[204:207], a[60:63], a[8:11], v[204:207]
    v_mfma_f32_16x16x32_bf16 v[220:223], a[60:63], a[12:15], v[220:223]
    v_mfma_f32_16x16x32_bf16 v[236:239], a[60:63], a[16:19], v[236:239]
    v_mfma_f32_16x16x32_bf16 v[252:255], a[60:63], a[20:23], v[252:255]
    v_mfma_f32_16x16x32_bf16 a[156:159], a[60:63], a[24:27], a[156:159]
    v_mfma_f32_16x16x32_bf16 a[188:191], a[60:63], a[28:31], a[188:191]
    s_waitcnt vmcnt(0) lgkmcnt(0)
    s_barrier
    v_mfma_f32_16x16x32_bf16 v[64:67], a[96:99], a[64:67], v[64:67]
    s_cmp_ge_u32 s49, 1024
    s_cselect_b32 s18, 0, s18
    s_cselect_b32 s22, 0, s22
    ds_read_b128 a[0:3], v26 offset:32768
    v_mfma_f32_16x16x32_bf16 v[80:83], a[96:99], a[68:71], v[80:83]
    s_add_u32 m0, s48, 0
    ds_read_b64_tr_b16 a[32:33], v28 offset:32768
    v_mfma_f32_16x16x32_bf16 v[96:99], a[96:99], a[72:75], v[96:99]
    buffer_load_dwordx4 v10, s[16:19], s49 offen offset:0 lds
    v_mfma_f32_16x16x32_bf16 v[112:115], a[96:99], a[76:79], v[112:115]
    ds_read_b64_tr_b16 a[34:35], v28 offset:34816
    v_mfma_f32_16x16x32_bf16 v[128:131], a[96:99], a[80:83], v[128:131]
    buffer_load_dwordx4 v11, s[16:19], s49 offen offset:1024 lds
    v_mfma_f32_16x16x32_bf16 v[144:147], a[96:99], a[84:87], v[144:147]
    ds_read_b128 a[4:7], v26 offset:34816
    v_mfma_f32_16x16x32_bf16 a[128:131], a[96:99], a[88:91], a[128:131]
    v_mfma_f32_16x16x32_bf16 a[160:163], a[96:99], a[92:95], a[160:163]
    ds_read_b64_tr_b16 a[36:37], v29 offset:32768
    v_mfma_f32_16x16x32_bf16 v[160:163], a[100:103], a[64:67], v[160:163]
    buffer_load_dwordx4 v12, s[16:19], s49 offen offset:2048 lds
    v_mfma_f32_16x16x32_bf16 v[176:179], a[100:103], a[68:71], v[176:179]
    ds_read_b64_tr_b16 a[38:39], v29 offset:34816
    v_mfma_f32_16x16x32_bf16 v[192:195], a[100:103], a[72:75], v[192:195]
    v_mfma_f32_16x16x32_bf16 v[208:211], a[100:103], a[76:79], v[208:211]
    buffer_load_dwordx4 v13, s[16:19], s49 offen offset:3072 lds
    ds_read_b128 a[8:11], v26 offset:36864
    v_mfma_f32_16x16x32_bf16 v[224:227], a[100:103], a[80:83], v[224:227]
    v_mfma_f32_16x16x32_bf16 v[240:243], a[100:103], a[84:87], v[240:243]
    s_add_u32 m0, s48, 4096
    v_mfma_f32_16x16x32_bf16 a[132:135], a[100:103], a[88:91], a[132:135]
    ds_read_b64_tr_b16 a[40:41], v30 offset:32768
    v_mfma_f32_16x16x32_bf16 a[164:167], a[100:103], a[92:95], a[164:167]
    buffer_load_dwordx4 v14, s[16:19], s49 offen offset:0 lds
    v_mfma_f32_16x16x32_bf16 v[68:71], a[104:107], a[64:67], v[68:71]
    ds_read_b64_tr_b16 a[42:43], v30 offset:34816
    v_mfma_f32_16x16x32_bf16 v[84:87], a[104:107], a[68:71], v[84:87]
    v_mfma_f32_16x16x32_bf16 v[100:103], a[104:107], a[72:75], v[100:103]
    buffer_load_dwordx4 v15, s[16:19], s49 offen offset:1024 lds
    ds_read_b128 a[12:15], v26 offset:38912
    v_mfma_f32_16x16x32_bf16 v[116:119], a[104:107], a[76:79], v[116:119]
    v_mfma_f32_16x16x32_bf16 v[132:135], a[104:107], a[80:83], v[132:135]
    ds_read_b64_tr_b16 a[44:45], v31 offset:32768
    v_mfma_f32_16x16x32_bf16 v[148:151], a[104:107], a[84:87], v[148:151]
    v_mfma_f32_16x16x32_bf16 a[136:139], a[104:107], a[88:91], a[136:139]
    buffer_load_dwordx4 v16, s[16:19], s49 offen offset:2048 lds
    ds_read_b64_tr_b16 a[46:47], v31 offset:34816
    v_mfma_f32_16x16x32_bf16 a[168:171], a[104:107], a[92:95], a[168:171]
    v_mfma_f32_16x16x32_bf16 v[164:167], a[108:111], a[64:67], v[164:167]
    ds_read_b128 a[16:19], v26 offset:40960
    v_mfma_f32_16x16x32_bf16 v[180:183], a[108:111], a[68:71], v[180:183]
    buffer_load_dwordx4 v17, s[16:19], s49 offen offset:3072 lds
    v_mfma_f32_16x16x32_bf16 v[196:199], a[108:111], a[72:75], v[196:199]
    ds_read_b64_tr_b16 a[48:49], v32 offset:32768
    v_mfma_f32_16x16x32_bf16 v[212:215], a[108:111], a[76:79], v[212:215]
    s_add_u32 s49, s49, 128
    v_mfma_f32_16x16x32_bf16 v[228:231], a[108:111], a[80:83], v[228:231]
    s_add_u32 m0, s48, 65536
    ds_read_b64_tr_b16 a[50:51], v32 offset:34816
    v_mfma_f32_16x16x32_bf16 v[244:247], a[108:111], a[84:87], v[244:247]
    buffer_load_dwordx4 v18, s[20:23], s50 offen offset:0 lds
    v_mfma_f32_16x16x32_bf16 a[140:143], a[108:111], a[88:91], a[140:143]
    ds_read_b128 a[20:23], v26 offset:43008
    v_mfma_f32_16x16x32_bf16 a[172:175], a[108:111], a[92:95], a[172:175]
    v_mfma_f32_16x16x32_bf16 v[72:75], a[112:115], a[64:67], v[72:75]
    buffer_load_dwordx4 v19, s[20:23], s50 offen offset:1024 lds
    ds_read_b64_tr_b16 a[52:53], v33 offset:32768
    v_mfma_f32_16x16x32_bf16 v[88:91], a[112:115], a[68:71], v[88:91]
    v_mfma_f32_16x16x32_bf16 v[104:107], a[112:115], a[72:75], v[104:107]
    ds_read_b64_tr_b16 a[54:55], v33 offset:34816
    v_mfma_f32_16x16x32_bf16 v[120:123], a[112:115], a[76:79], v[120:123]
    buffer_load_dwordx4 v20, s[20:23], s50 offen offset:2048 lds
    v_mfma_f32_16x16x32_bf16 v[136:139], a[112:115], a[80:83], v[136:139]
    ds_read_b128 a[24:27], v26 offset:45056
    v_mfma_f32_16x16x32_bf16 v[152:155], a[112:115], a[84:87], v[152:155]
    v_mfma_f32_16x16x32_bf16 a[144:147], a[112:115], a[88:91], a[144:147]
    v_mfma_f32_16x16x32_bf16 a[176:179], a[112:115], a[92:95], a[176:179]
    buffer_load_dwordx4 v21, s[20:23], s50 offen offset:3072 lds
    ds_read_b64_tr_b16 a[56:57], v34 offset:32768
    v_mfma_f32_16x16x32_bf16 v[168:171], a[116:119], a[64:67], v[168:171]
    s_add_u32 m0, s48, 69632
    v_mfma_f32_16x16x32_bf16 v[184:187], a[116:119], a[68:71], v[184:187]
    ds_read_b64_tr_b16 a[58:59], v34 offset:34816
    v_mfma_f32_16x16x32_bf16 v[200:203], a[116:119], a[72:75], v[200:203]
    buffer_load_dwordx4 v22, s[20:23], s50 offen offset:0 lds
    v_mfma_f32_16x16x32_bf16 v[216:219], a[116:119], a[76:79], v[216:219]
    ds_read_b128 a[28:31], v26 offset:47104
    v_mfma_f32_16x16x32_bf16 v[232:235], a[116:119], a[80:83], v[232:235]
    v_mfma_f32_16x16x32_bf16 v[248:251], a[116:119], a[84:87], v[248:251]
    ds_read_b64_tr_b16 a[60:61], v35 offset:32768
    v_mfma_f32_16x16x32_bf16 a[148:151], a[116:119], a[88:91], a[148:151]
    buffer_load_dwordx4 v23, s[20:23], s50 offen offset:1024 lds
    v_mfma_f32_16x16x32_bf16 a[180:183], a[116:119], a[92:95], a[180:183]
    ds_read_b64_tr_b16 a[62:63], v35 offset:34816
    v_mfma_f32_16x16x32_bf16 v[76:79], a[120:123], a[64:67], v[76:79]
    v_mfma_f32_16x16x32_bf16 v[92:95], a[120:123], a[68:71], v[92:95]
    buffer_load_dwordx4 v24, s[20:23], s50 offen offset:2048 lds
    v_mfma_f32_16x16x32_bf16 v[108:111], a[120:123], a[72:75], v[108:111]
    v_mfma_f32_16x16x32_bf16 v[124:127], a[120:123], a[76:79], v[124:127]
    v_mfma_f32_16x16x32_bf16 v[140:143], a[120:123], a[80:83], v[140:143]
    v_mfma_f32_16x16x32_bf16 v[156:159], a[120:123], a[84:87], v[156:159]
    buffer_load_dwordx4 v25, s[20:23], s50 offen offset:3072 lds
    v_mfma_f32_16x16x32_bf16 a[152:155], a[120:123], a[88:91], a[152:155]
    v_mfma_f32_16x16x32_bf16 a[184:187], a[120:123], a[92:95], a[184:187]
    s_add_u32 s50, s50, 0x80000
    v_mfma_f32_16x16x32_bf16 v[172:175], a[124:127], a[64:67], v[172:175]
    v_mfma_f32_16x16x32_bf16 v[188:191], a[124:127], a[68:71], v[188:191]
    s_cmp_eq_u32 s51, s53
    s_cbranch_scc1 k12_ool_12
k12_oolret_13:
    v_mfma_f32_16x16x32_bf16 v[204:207], a[124:127], a[72:75], v[204:207]
    v_mfma_f32_16x16x32_bf16 v[220:223], a[124:127], a[76:79], v[220:223]
    s_cmp_eq_u32 s51, s63
    s_cbranch_scc1 k12_ool_14
k12_oolret_15:
    v_mfma_f32_16x16x32_bf16 v[236:239], a[124:127], a[80:83], v[236:239]
    v_mfma_f32_16x16x32_bf16 v[252:255], a[124:127], a[84:87], v[252:255]
    s_add_u32 s51, s51, 1
    v_mfma_f32_16x16x32_bf16 a[156:159], a[124:127], a[88:91], a[156:159]
    v_mfma_f32_16x16x32_bf16 a[188:191], a[124:127], a[92:95], a[188:191]
    s_waitcnt lgkmcnt(0)
    v_mfma_f32_16x16x32_bf16 v[64:67], a[32:35], a[0:3], v[64:67]
    ds_read_b128 a[64:67], v27 offset:32768
    v_mfma_f32_16x16x32_bf16 v[80:83], a[32:35], a[4:7], v[80:83]
    ds_read_b64_tr_b16 a[96:97], v28 offset:49152
    v_mfma_f32_16x16x32_bf16 v[96:99], a[32:35], a[8:11], v[96:99]
    v_mfma_f32_16x16x32_bf16 v[112:115], a[32:35], a[12:15], v[112:115]
    ds_read_b64_tr_b16 a[98:99], v28 offset:51200
    v_mfma_f32_16x16x32_bf16 v[128:131], a[32:35], a[16:19], v[128:131]
    v_mfma_f32_16x16x32_bf16 v[144:147], a[32:35], a[20:23], v[144:147]
    ds_read_b128 a[68:71], v27 offset:34816
    v_mfma_f32_16x16x32_bf16 a[128:131], a[32:35], a[24:27], a[128:131]
    v_mfma_f32_16x16x32_bf16 a[160:163], a[32:35], a[28:31], a[160:163]
    ds_read_b64_tr_b16 a[100:101], v29 offset:49152
    v_mfma_f32_16x16x32_bf16 v[160:163], a[36:39], a[0:3], v[160:163]
    v_mfma_f32_16x16x32_bf16 v[176:179], a[36:39], a[4:7], v[176:179]
    ds_read_b64_tr_b16 a[102:103], v29 offset:51200
    v_mfma_f32_16x16x32_bf16 v[192:195], a[36:39], a[8:11], v[192:195]
    v_mfma_f32_16x16x32_bf16 v[208:211], a[36:39], a[12:15], v[208:211]
    ds_read_b128 a[72:75], v27 offset:36864
    v_mfma_f32_16x16x32_bf16 v[224:227], a[36:39], a[16:19], v[224:227]
    v_mfma_f32_16x16x32_bf16 v[240:243], a[36:39], a[20:23], v[240:243]
    v_mfma_f32_16x16x32_bf16 a[132:135], a[36:39], a[24:27], a[132:135]
    ds_read_b64_tr_b16 a[104:105], v30 offset:49152
    v_mfma_f32_16x16x32_bf16 a[164:167], a[36:39], a[28:31], a[164:167]
    v_mfma_f32_16x16x32_bf16 v[68:71], a[40:43], a[0:3], v[68:71]
    ds_read_b64_tr_b16 a[106:107], v30 offset:51200
    v_mfma_f32_16x16x32_bf16 v[84:87], a[40:43], a[4:7], v[84:87]
    v_mfma_f32_16x16x32_bf16 v[100:103], a[40:43], a[8:11], v[100:103]
    ds_read_b128 a[76:79], v27 offset:38912
    v_mfma_f32_16x16x32_bf16 v[116:119], a[40:43], a[12:15], v[116:119]
    v_mfma_f32_16x16x32_bf16 v[132:135], a[40:43], a[16:19], v[132:135]
    ds_read_b64_tr_b16 a[108:109], v31 offset:49152
    v_mfma_f32_16x16x32_bf16 v[148:151], a[40:43], a[20:23], v[148:151]
    v_mfma_f32_16x16x32_bf16 a[136:139], a[40:43], a[24:27], a[136:139]
    ds_read_b64_tr_b16 a[110:111], v31 offset:51200
    v_mfma_f32_16x16x32_bf16 a[168:171], a[40:43], a[28:31], a[168:171]
    v_mfma_f32_16x16x32_bf16 v[164:167], a[44:47], a[0:3], v[164:167]
    ds_read_b128 a[80:83], v27 offset:40960
    v_mfma_f32_16x16x32_bf16 v[180:183], a[44:47], a[4:7], v[180:183]
    v_mfma_f32_16x16x32_bf16 v[196:199], a[44:47], a[8:11], v[196:199]
    ds_read_b64_tr_b16 a[112:113], v32 offset:49152
    v_mfma_f32_16x16x32_bf16 v[212:215], a[44:47], a[12:15], v[212:215]
    v_mfma_f32_16x16x32_bf16 v[228:231], a[44:47], a[16:19], v[228:231]
    ds_read_b64_tr_b16 a[114:115], v32 offset:51200
    v_mfma_f32_16x16x32_bf16 v[244:247], a[44:47], a[20:23], v[244:247]
    v_mfma_f32_16x16x32_bf16 a[140:143], a[44:47], a[24:27], a[140:143]
    ds_read_b128 a[84:87], v27 offset:43008
    v_mfma_f32_16x16x32_bf16 a[172:175], a[44:47], a[28:31], a[172:175]
    v_mfma_f32_16x16x32_bf16 v[72:75], a[48:51], a[0:3], v[72:75]
    ds_read_b64_tr_b16 a[116:117], v33 offset:49152
    v_mfma_f32_16x16x32_bf16 v[88:91], a[48:51], a[4:7], v[88:91]
    v_mfma_f32_16x16x32_bf16 v[104:107], a[48:51], a[8:11], v[104:107]
    ds_read_b64_tr_b16 a[118:119], v33 offset:51200
    v_mfma_f32_16x16x32_bf16 v[120:123], a[48:51], a[12:15], v[120:123]
    v_mfma_f32_16x16x32_bf16 v[136:139], a[48:51], a[16:19], v[136:139]
    ds_read_b128 a[88:91], v27 offset:45056
    v_mfma_f32_16x16x32_bf16 v[152:155], a[48:51], a[20:23], v[152:155]
    v_mfma_f32_16x16x32_bf16 a[144:147], a[48:51], a[24:27], a[144:147]
    v_mfma_f32_16x16x32_bf16 a[176:179], a[48:51], a[28:31], a[176:179]
    ds_read_b64_tr_b16 a[120:121], v34 offset:49152
    v_mfma_f32_16x16x32_bf16 v[168:171], a[52:55], a[0:3], v[168:171]
    v_mfma_f32_16x16x32_bf16 v[184:187], a[52:55], a[4:7], v[184:187]
    ds_read_b64_tr_b16 a[122:123], v34 offset:51200
    v_mfma_f32_16x16x32_bf16 v[200:203], a[52:55], a[8:11], v[200:203]
    v_mfma_f32_16x16x32_bf16 v[216:219], a[52:55], a[12:15], v[216:219]
    ds_read_b128 a[92:95], v27 offset:47104
    v_mfma_f32_16x16x32_bf16 v[232:235], a[52:55], a[16:19], v[232:235]
    v_mfma_f32_16x16x32_bf16 v[248:251], a[52:55], a[20:23], v[248:251]
    ds_read_b64_tr_b16 a[124:125], v35 offset:49152
    v_mfma_f32_16x16x32_bf16 a[148:151], a[52:55], a[24:27], a[148:151]
    v_mfma_f32_16x16x32_bf16 a[180:183], a[52:55], a[28:31], a[180:183]
    ds_read_b64_tr_b16 a[126:127], v35 offset:51200
    v_mfma_f32_16x16x32_bf16 v[76:79], a[56:59], a[0:3], v[76:79]
    v_mfma_f32_16x16x32_bf16 v[92:95], a[56:59], a[4:7], v[92:95]
    v_mfma_f32_16x16x32_bf16 v[108:111], a[56:59], a[8:11], v[108:111]
    v_mfma_f32_16x16x32_bf16 v[124:127], a[56:59], a[12:15], v[124:127]
    v_mfma_f32_16x16x32_bf16 v[140:143], a[56:59], a[16:19], v[140:143]
    v_mfma_f32_16x16x32_bf16 v[156:159], a[56:59], a[20:23], v[156:159]
    v_mfma_f32_16x16x32_bf16 a[152:155], a[56:59], a[24:27], a[152:155]
    v_mfma_f32_16x16x32_bf16 a[184:187], a[56:59], a[28:31], a[184:187]
    s_sub_u32 s52, s51, 1
    s_cmp_eq_u32 s52, s46
    s_cbranch_scc1 k12_ool_18
k12_oolret_19:
    v_mfma_f32_16x16x32_bf16 v[172:175], a[60:63], a[0:3], v[172:175]
    v_mfma_f32_16x16x32_bf16 v[188:191], a[60:63], a[4:7], v[188:191]
    v_mfma_f32_16x16x32_bf16 v[204:207], a[60:63], a[8:11], v[204:207]
    v_mfma_f32_16x16x32_bf16 v[220:223], a[60:63], a[12:15], v[220:223]
    v_mfma_f32_16x16x32_bf16 v[236:239], a[60:63], a[16:19], v[236:239]
    v_mfma_f32_16x16x32_bf16 v[252:255], a[60:63], a[20:23], v[252:255]
    v_mfma_f32_16x16x32_bf16 a[156:159], a[60:63], a[24:27], a[156:159]
    v_mfma_f32_16x16x32_bf16 a[188:191], a[60:63], a[28:31], a[188:191]
    s_waitcnt vmcnt(0) lgkmcnt(0)
    s_barrier
    s_cmp_eq_u32 s51, 7
    s_cbranch_scc1 k12_last_9
    v_mfma_f32_16x16x32_bf16 v[64:67], a[96:99], a[64:67], v[64:67]
    ds_read_b128 a[0:3], v26 offset:0
    v_mfma_f32_16x16x32_bf16 v[80:83], a[96:99], a[68:71], v[80:83]
    s_add_u32 m0, s48, 32768
    ds_read_b64_tr_b16 a[32:33], v28 offset:0
    v_mfma_f32_16x16x32_bf16 v[96:99], a[96:99], a[72:75], v[96:99]
    buffer_load_dwordx4 v10, s[16:19], s49 offen offset:0 lds
    v_mfma_f32_16x16x32_bf16 v[112:115], a[96:99], a[76:79], v[112:115]
    ds_read_b64_tr_b16 a[34:35], v28 offset:2048
    v_mfma_f32_16x16x32_bf16 v[128:131], a[96:99], a[80:83], v[128:131]
    buffer_load_dwordx4 v11, s[16:19], s49 offen offset:1024 lds
    v_mfma_f32_16x16x32_bf16 v[144:147], a[96:99], a[84:87], v[144:147]
    ds_read_b128 a[4:7], v26 offset:2048
    v_mfma_f32_16x16x32_bf16 a[128:131], a[96:99], a[88:91], a[128:131]
    v_mfma_f32_16x16x32_bf16 a[160:163], a[96:99], a[92:95], a[160:163]
    ds_read_b64_tr_b16 a[36:37], v29 offset:0
    v_mfma_f32_16x16x32_bf16 v[160:163], a[100:103], a[64:67], v[160:163]
    buffer_load_dwordx4 v12, s[16:19], s49 offen offset:2048 lds
    v_mfma_f32_16x16x32_bf16 v[176:179], a[100:103], a[68:71], v[176:179]
    ds_read_b64_tr_b16 a[38:39], v29 offset:2048
    v_mfma_f32_16x16x32_bf16 v[192:195], a[100:103], a[72:75], v[192:195]
    v_mfma_f32_16x16x32_bf16 v[208:211], a[100:103], a[76:79], v[208:211]
    buffer_load_dwordx4 v13, s[16:19], s49 offen offset:3072 lds
    ds_read_b128 a[8:11], v26 offset:4096
    v_mfma_f32_16x16x32_bf16 v[224:227], a[100:103], a[80:83], v[224:227]
    v_mfma_f32_16x16x32_bf16 v[240:243], a[100:103], a[84:87], v[240:243]
    s_add_u32 m0, s48, 36864
    v_mfma_f32_16x16x32_bf16 a[132:135], a[100:103], a[88:91], a[132:135]
    ds_read_b64_tr_b16 a[40:41], v30 offset:0
    v_mfma_f32_16x16x32_bf16 a[164:167], a[100:103], a[92:95], a[164:167]
    buffer_load_dwordx4 v14, s[16:19], s49 offen offset:0 lds
    v_mfma_f32_16x16x32_bf16 v[68:71], a[104:107], a[64:67], v[68:71]
    ds_read_b64_tr_b16 a[42:43], v30 offset:2048
    v_mfma_f32_16x16x32_bf16 v[84:87], a[104:107], a[68:71], v[84:87]
    v_mfma_f32_16x16x32_bf16 v[100:103], a[104:107], a[72:75], v[100:103]
    buffer_load_dwordx4 v15, s[16:19], s49 offen offset:1024 lds
    ds_read_b128 a[12:15], v26 offset:6144
    v_mfma_f32_16x16x32_bf16 v[116:119], a[104:107], a[76:79], v[116:119]
    v_mfma_f32_16x16x32_bf16 v[132:135], a[104:107], a[80:83], v[132:135]
    ds_read_b64_tr_b16 a[44:45], v31 offset:0
    v_mfma_f32_16x16x32_bf16 v[148:151], a[104:107], a[84:87], v[148:151]
    v_mfma_f32_16x16x32_bf16 a[136:139], a[104:107], a[88:91], a[136:139]
    buffer_load_dwordx4 v16, s[16:19], s49 offen offset:2048 lds
    ds_read_b64_tr_b16 a[46:47], v31 offset:2048
    v_mfma_f32_16x16x32_bf16 a[168:171], a[104:107], a[92:95], a[168:171]
    v_mfma_f32_16x16x32_bf16 v[164:167], a[108:111], a[64:67], v[164:167]
    ds_read_b128 a[16:19], v26 offset:8192
    v_mfma_f32_16x16x32_bf16 v[180:183], a[108:111], a[68:71], v[180:183]
    buffer_load_dwordx4 v17, s[16:19], s49 offen offset:3072 lds
    v_mfma_f32_16x16x32_bf16 v[196:199], a[108:111], a[72:75], v[196:199]
    ds_read_b64_tr_b16 a[48:49], v32 offset:0
    v_mfma_f32_16x16x32_bf16 v[212:215], a[108:111], a[76:79], v[212:215]
    s_add_u32 s49, s49, 128
    v_mfma_f32_16x16x32_bf16 v[228:231], a[108:111], a[80:83], v[228:231]
    s_add_u32 m0, s48, 98304
    ds_read_b64_tr_b16 a[50:51], v32 offset:2048
    v_mfma_f32_16x16x32_bf16 v[244:247], a[108:111], a[84:87], v[244:247]
    buffer_load_dwordx4 v18, s[20:23], s50 offen offset:0 lds
    v_mfma_f32_16x16x32_bf16 a[140:143], a[108:111], a[88:91], a[140:143]
    ds_read_b128 a[20:23], v26 offset:10240
    v_mfma_f32_16x16x32_bf16 a[172:175], a[108:111], a[92:95], a[172:175]
    v_mfma_f32_16x16x32_bf16 v[72:75], a[112:115], a[64:67], v[72:75]
    buffer_load_dwordx4 v19, s[20:23], s50 offen offset:1024 lds
    ds_read_b64_tr_b16 a[52:53], v33 offset:0
    v_mfma_f32_16x16x32_bf16 v[88:91], a[112:115], a[68:71], v[88:91]
    v_mfma_f32_16x16x32_bf16 v[104:107], a[112:115], a[72:75], v[104:107]
    ds_read_b64_tr_b16 a[54:55], v33 offset:2048
    v_mfma_f32_16x16x32_bf16 v[120:123], a[112:115], a[76:79], v[120:123]
    buffer_load_dwordx4 v20, s[20:23], s50 offen offset:2048 lds
    v_mfma_f32_16x16x32_bf16 v[136:139], a[112:115], a[80:83], v[136:139]
    ds_read_b128 a[24:27], v26 offset:12288
    v_mfma_f32_16x16x32_bf16 v[152:155], a[112:115], a[84:87], v[152:155]
    v_mfma_f32_16x16x32_bf16 a[144:147], a[112:115], a[88:91], a[144:147]
    v_mfma_f32_16x16x32_bf16 a[176:179], a[112:115], a[92:95], a[176:179]
    buffer_load_dwordx4 v21, s[20:23], s50 offen offset:3072 lds
    ds_read_b64_tr_b16 a[56:57], v34 offset:0
    v_mfma_f32_16x16x32_bf16 v[168:171], a[116:119], a[64:67], v[168:171]
    s_add_u32 m0, s48, 102400
    v_mfma_f32_16x16x32_bf16 v[184:187], a[116:119], a[68:71], v[184:187]
    ds_read_b64_tr_b16 a[58:59], v34 offset:2048
    v_mfma_f32_16x16x32_bf16 v[200:203], a[116:119], a[72:75], v[200:203]
    buffer_load_dwordx4 v22, s[20:23], s50 offen offset:0 lds
    v_mfma_f32_16x16x32_bf16 v[216:219], a[116:119], a[76:79], v[216:219]
    ds_read_b128 a[28:31], v26 offset:14336
    v_mfma_f32_16x16x32_bf16 v[232:235], a[116:119], a[80:83], v[232:235]
    v_mfma_f32_16x16x32_bf16 v[248:251], a[116:119], a[84:87], v[248:251]
    ds_read_b64_tr_b16 a[60:61], v35 offset:0
    v_mfma_f32_16x16x32_bf16 a[148:151], a[116:119], a[88:91], a[148:151]
    buffer_load_dwordx4 v23, s[20:23], s50 offen offset:1024 lds
    v_mfma_f32_16x16x32_bf16 a[180:183], a[116:119], a[92:95], a[180:183]
    ds_read_b64_tr_b16 a[62:63], v35 offset:2048
    v_mfma_f32_16x16x32_bf16 v[76:79], a[120:123], a[64:67], v[76:79]
    v_mfma_f32_16x16x32_bf16 v[92:95], a[120:123], a[68:71], v[92:95]
    buffer_load_dwordx4 v24, s[20:23], s50 offen offset:2048 lds
    v_mfma_f32_16x16x32_bf16 v[108:111], a[120:123], a[72:75], v[108:111]
    v_mfma_f32_16x16x32_bf16 v[124:127], a[120:123], a[76:79], v[124:127]
    v_mfma_f32_16x16x32_bf16 v[140:143], a[120:123], a[80:83], v[140:143]
    v_mfma_f32_16x16x32_bf16 v[156:159], a[120:123], a[84:87], v[156:159]
    buffer_load_dwordx4 v25, s[20:23], s50 offen offset:3072 lds
    v_mfma_f32_16x16x32_bf16 a[152:155], a[120:123], a[88:91], a[152:155]
    v_mfma_f32_16x16x32_bf16 a[184:187], a[120:123], a[92:95], a[184:187]
    s_add_u32 s50, s50, 0x80000
    v_mfma_f32_16x16x32_bf16 v[172:175], a[124:127], a[64:67], v[172:175]
    v_mfma_f32_16x16x32_bf16 v[188:191], a[124:127], a[68:71], v[188:191]
    s_cmp_eq_u32 s51, s53
    s_cbranch_scc1 k12_ool_20
k12_oolret_21:
    v_mfma_f32_16x16x32_bf16 v[204:207], a[124:127], a[72:75], v[204:207]
    v_mfma_f32_16x16x32_bf16 v[220:223], a[124:127], a[76:79], v[220:223]
    s_cmp_eq_u32 s51, 5
    s_cbranch_scc1 k12_ool_22
k12_oolret_23:
    v_mfma_f32_16x16x32_bf16 v[236:239], a[124:127], a[80:83], v[236:239]
    v_mfma_f32_16x16x32_bf16 v[252:255], a[124:127], a[84:87], v[252:255]
    s_add_u32 s51, s51, 1
    v_mfma_f32_16x16x32_bf16 a[156:159], a[124:127], a[88:91], a[156:159]
    v_mfma_f32_16x16x32_bf16 a[188:191], a[124:127], a[92:95], a[188:191]
    s_waitcnt lgkmcnt(0)
    s_branch k12_loop_8
k12_last_9:
    v_mfma_f32_16x16x32_bf16 v[64:67], a[96:99], a[64:67], v[64:67]
    s_add_u32 m0, s60, 98304
    v_mfma_f32_16x16x32_bf16 v[160:163], a[100:103], a[64:67], v[160:163]
    buffer_load_dwordx4 v38, s[12:15], s61 offen offset:0 lds
    v_mfma_f32_16x16x32_bf16 v[68:71], a[104:107], a[64:67], v[68:71]
    buffer_load_dwordx4 v39, s[12:15], s61 offen offset:1024 lds
    v_mfma_f32_16x16x32_bf16 v[164:167], a[108:111], a[64:67], v[164:167]
    v_mfma_f32_16x16x32_bf16 v[72:75], a[112:115], a[64:67], v[72:75]
    buffer_load_dwordx4 v40, s[12:15], s61 offen offset:2048 lds
    v_mfma_f32_16x16x32_bf16 v[168:171], a[116:119], a[64:67], v[168:171]
    v_cvt_pk_bf16_f32 v64, v64, v65
    v_cvt_pk_bf16_f32 v65, v66, v67
    v_cvt_pk_bf16_f32 v66, v160, v161
    v_mfma_f32_16x16x32_bf16 v[76:79], a[120:123], a[64:67], v[76:79]
    v_cvt_pk_bf16_f32 v67, v162, v163
    v_mfma_f32_16x16x32_bf16 v[172:175], a[124:127], a[64:67], v[172:175]
    v_cvt_pk_bf16_f32 v68, v68, v69
    v_cvt_pk_bf16_f32 v69, v70, v71
    v_cvt_pk_bf16_f32 v70, v164, v165
    v_mfma_f32_16x16x32_bf16 v[80:83], a[96:99], a[68:71], v[80:83]
    buffer_load_dwordx4 v41, s[12:15], s61 offen offset:3072 lds
    v_mfma_f32_16x16x32_bf16 v[176:179], a[100:103], a[68:71], v[176:179]
    s_add_u32 s61, s61, 0x80000
    v_cvt_pk_bf16_f32 v71, v166, v167
    v_cvt_pk_bf16_f32 v72, v72, v73
    v_cvt_pk_bf16_f32 v73, v74, v75
    v_mfma_f32_16x16x32_bf16 v[84:87], a[104:107], a[68:71], v[84:87]
    buffer_load_dwordx4 a[192:195], v36, s[8:11], s62 offen offset:0 sc1
    buffer_load_dwordx4 a[196:199], v36, s[8:11], s62 offen offset:1024 sc1
    v_mfma_f32_16x16x32_bf16 v[180:183], a[108:111], a[68:71], v[180:183]
    v_cvt_pk_bf16_f32 v74, v168, v169
    v_cvt_pk_bf16_f32 v75, v170, v171
    v_cvt_pk_bf16_f32 v76, v76, v77
    v_mfma_f32_16x16x32_bf16 v[88:91], a[112:115], a[68:71], v[88:91]
    v_cvt_pk_bf16_f32 v77, v78, v79
    v_cvt_pk_bf16_f32 v78, v172, v173
    v_cvt_pk_bf16_f32 v79, v174, v175
    v_mfma_f32_16x16x32_bf16 v[184:187], a[116:119], a[68:71], v[184:187]
    v_cvt_pk_bf16_f32 v80, v80, v81
    v_cvt_pk_bf16_f32 v81, v82, v83
    v_cvt_pk_bf16_f32 v82, v176, v177
    v_mfma_f32_16x16x32_bf16 v[92:95], a[120:123], a[68:71], v[92:95]
    buffer_load_dwordx4 a[200:203], v37, s[8:11], s62 offen offset:0 sc1
    buffer_load_dwordx4 a[204:207], v37, s[8:11], s62 offen offset:1024 sc1
    v_mfma_f32_16x16x32_bf16 v[188:191], a[124:127], a[68:71], v[188:191]
    s_add_u32 s62, s62, 0x20000
    v_cvt_pk_bf16_f32 v83, v178, v179
    v_cvt_pk_bf16_f32 v84, v84, v85
    v_cvt_pk_bf16_f32 v85, v86, v87
    v_mfma_f32_16x16x32_bf16 a[128:131], a[96:99], a[88:91], a[128:131]
    v_cvt_pk_bf16_f32 v86, v180, v181
    v_cvt_pk_bf16_f32 v87, v182, v183
    v_mfma_f32_16x16x32_bf16 a[132:135], a[100:103], a[88:91], a[132:135]
    v_cvt_pk_bf16_f32 v88, v88, v89
    v_cvt_pk_bf16_f32 v89, v90, v91
    v_cvt_pk_bf16_f32 v90, v184, v185
    v_mfma_f32_16x16x32_bf16 v[96:99], a[96:99], a[72:75], v[96:99]
    buffer_load_dwordx4 a[208:211], v36, s[8:11], s62 offen offset:0 sc1
    buffer_load_dwordx4 a[212:215], v36, s[8:11], s62 offen offset:1024 sc1
    v_mfma_f32_16x16x32_bf16 v[192:195], a[100:103], a[72:75], v[192:195]
    v_cvt_pk_bf16_f32 v91, v186, v187
    v_cvt_pk_bf16_f32 v92, v92, v93
    v_cvt_pk_bf16_f32 v93, v94, v95
    v_mfma_f32_16x16x32_bf16 v[100:103], a[104:107], a[72:75], v[100:103]
    v_cvt_pk_bf16_f32 v94, v188, v189
    v_cvt_pk_bf16_f32 v95, v190, v191
    v_mfma_f32_16x16x32_bf16 v[196:199], a[108:111], a[72:75], v[196:199]
    v_accvgpr_read_b32 v56, a128
    v_accvgpr_read_b32 v57, a129
    v_accvgpr_read_b32 v58, a130
    v_mfma_f32_16x16x32_bf16 a[136:139], a[104:107], a[88:91], a[136:139]
    buffer_load_dwordx4 a[216:219], v37, s[8:11], s62 offen offset:0 sc1
    buffer_load_dwordx4 a[220:223], v37, s[8:11], s62 offen offset:1024 sc1
    v_mfma_f32_16x16x32_bf16 a[140:143], a[108:111], a[88:91], a[140:143]
    s_add_u32 s62, s62, 0x20000
    v_accvgpr_read_b32 v59, a131
    v_accvgpr_read_b32 v60, a132
    v_cvt_pk_bf16_f32 v96, v96, v97
    v_mfma_f32_16x16x32_bf16 v[104:107], a[112:115], a[72:75], v[104:107]
    s_add_u32 m0, s60, 114688
    v_accvgpr_read_b32 v61, a133
    v_accvgpr_read_b32 v62, a134
    v_cvt_pk_bf16_f32 v97, v98, v99
    v_mfma_f32_16x16x32_bf16 v[200:203], a[116:119], a[72:75], v[200:203]
    v_accvgpr_read_b32 v63, a135
    v_cvt_pk_bf16_f32 v98, v192, v193
    v_cvt_pk_bf16_f32 v160, v56, v57
    v_mfma_f32_16x16x32_bf16 v[108:111], a[120:123], a[72:75], v[108:111]
    v_cvt_pk_bf16_f32 v99, v194, v195
    v_cvt_pk_bf16_f32 v161, v58, v59
    v_cvt_pk_bf16_f32 v100, v100, v101
    v_mfma_f32_16x16x32_bf16 v[204:207], a[124:127], a[72:75], v[204:207]
    buffer_load_dwordx4 v38, s[12:15], s61 offen offset:0 lds
    buffer_load_dwordx4 v39, s[12:15], s61 offen offset:1024 lds
    v_mfma_f32_16x16x32_bf16 a[144:147], a[112:115], a[88:91], a[144:147]
    v_cvt_pk_bf16_f32 v162, v60, v61
    v_cvt_pk_bf16_f32 v101, v102, v103
    v_cvt_pk_bf16_f32 v163, v62, v63
    v_mfma_f32_16x16x32_bf16 a[148:151], a[116:119], a[88:91], a[148:151]
    v_cvt_pk_bf16_f32 v102, v196, v197
    v_cvt_pk_bf16_f32 v103, v198, v199
    v_accvgpr_read_b32 v56, a136
    v_mfma_f32_16x16x32_bf16 v[112:115], a[96:99], a[76:79], v[112:115]
    v_accvgpr_read_b32 v57, a137
    v_accvgpr_read_b32 v58, a138
    v_accvgpr_read_b32 v59, a139
    v_mfma_f32_16x16x32_bf16 v[208:211], a[100:103], a[76:79], v[208:211]
    v_accvgpr_read_b32 v60, a140
    v_cvt_pk_bf16_f32 v104, v104, v105
    v_accvgpr_read_b32 v61, a141
    v_mfma_f32_16x16x32_bf16 v[116:119], a[104:107], a[76:79], v[116:119]
    buffer_load_dwordx4 v40, s[12:15], s61 offen offset:2048 lds
    buffer_load_dwordx4 v41, s[12:15], s61 offen offset:3072 lds
    v_mfma_f32_16x16x32_bf16 v[212:215], a[108:111], a[76:79], v[212:215]
    s_add_u32 s61, s61, 0x80000
    v_accvgpr_read_b32 v62, a142
    v_cvt_pk_bf16_f32 v105, v106, v107
    v_accvgpr_read_b32 v63, a143
    v_mfma_f32_16x16x32_bf16 a[152:155], a[120:123], a[88:91], a[152:155]
    v_cvt_pk_bf16_f32 v106, v200, v201
    v_cvt_pk_bf16_f32 v164, v56, v57
    v_cvt_pk_bf16_f32 v107, v202, v203
    v_mfma_f32_16x16x32_bf16 a[156:159], a[124:127], a[88:91], a[156:159]
    v_cvt_pk_bf16_f32 v165, v58, v59
    v_cvt_pk_bf16_f32 v108, v108, v109
    v_cvt_pk_bf16_f32 v166, v60, v61
    v_mfma_f32_16x16x32_bf16 v[120:123], a[112:115], a[76:79], v[120:123]
    v_cvt_pk_bf16_f32 v109, v110, v111
    v_cvt_pk_bf16_f32 v167, v62, v63
    v_cvt_pk_bf16_f32 v110, v204, v205
    v_mfma_f32_16x16x32_bf16 v[216:219], a[116:119], a[76:79], v[216:219]
    buffer_load_dwordx4 a[224:227], v36, s[8:11], s62 offen offset:0 sc1
    v_cvt_pk_bf16_f32 v111, v206, v207
    v_accvgpr_read_b32 v56, a144
    v_mfma_f32_16x16x32_bf16 v[124:127], a[120:123], a[76:79], v[124:127]
    v_accvgpr_read_b32 v57, a145
    v_accvgpr_read_b32 v58, a146
    v_accvgpr_read_b32 v59, a147
    v_mfma_f32_16x16x32_bf16 v[220:223], a[124:127], a[76:79], v[220:223]
    buffer_load_dwordx4 a[228:231], v36, s[8:11], s62 offen offset:1024 sc1
    v_accvgpr_read_b32 v60, a148
    v_cvt_pk_bf16_f32 v112, v112, v113
    v_mfma_f32_16x16x32_bf16 a[160:163], a[96:99], a[92:95], a[160:163]
    v_accvgpr_read_b32 v61, a149
    v_accvgpr_read_b32 v62, a150
    v_cvt_pk_bf16_f32 v113, v114, v115
    v_mfma_f32_16x16x32_bf16 a[164:167], a[100:103], a[92:95], a[164:167]
    v_accvgpr_read_b32 v63, a151
    v_cvt_pk_bf16_f32 v114, v208, v209
    v_cvt_pk_bf16_f32 v168, v56, v57
    v_mfma_f32_16x16x32_bf16 v[128:131], a[96:99], a[80:83], v[128:131]
    v_cvt_pk_bf16_f32 v115, v210, v211
    v_cvt_pk_bf16_f32 v169, v58, v59
    v_cvt_pk_bf16_f32 v116, v116, v117
    v_mfma_f32_16x16x32_bf16 v[224:227], a[100:103], a[80:83], v[224:227]
    buffer_load_dwordx4 a[232:235], v37, s[8:11], s62 offen offset:0 sc1
    v_cvt_pk_bf16_f32 v170, v60, v61
    v_cvt_pk_bf16_f32 v117, v118, v119
    v_mfma_f32_16x16x32_bf16 v[132:135], a[104:107], a[80:83], v[132:135]
    v_cvt_pk_bf16_f32 v171, v62, v63
    v_cvt_pk_bf16_f32 v118, v212, v213
    v_cvt_pk_bf16_f32 v119, v214, v215
    v_mfma_f32_16x16x32_bf16 v[228:231], a[108:111], a[80:83], v[228:231]
    buffer_load_dwordx4 a[236:239], v37, s[8:11], s62 offen offset:1024 sc1
    v_accvgpr_read_b32 v56, a152
    v_accvgpr_read_b32 v57, a153
    v_mfma_f32_16x16x32_bf16 a[168:171], a[104:107], a[92:95], a[168:171]
    s_add_u32 s62, s62, 0x20000
    v_accvgpr_read_b32 v58, a154
    v_accvgpr_read_b32 v59, a155
    v_accvgpr_read_b32 v60, a156
    v_mfma_f32_16x16x32_bf16 a[172:175], a[108:111], a[92:95], a[172:175]
    s_waitcnt vmcnt(16)
    s_barrier
    v_cvt_pk_bf16_f32 v120, v120, v121
    v_accvgpr_read_b32 v61, a157
    v_accvgpr_read_b32 v62, a158
    v_mfma_f32_16x16x32_bf16 v[136:139], a[112:115], a[80:83], v[136:139]
    v_cvt_pk_bf16_f32 v121, v122, v123
    v_accvgpr_read_b32 v63, a159
    v_cvt_pk_bf16_f32 v122, v216, v217
    v_mfma_f32_16x16x32_bf16 v[232:235], a[116:119], a[80:83], v[232:235]
    v_cvt_pk_bf16_f32 v172, v56, v57
    v_cvt_pk_bf16_f32 v123, v218, v219
    v_cvt_pk_bf16_f32 v173, v58, v59
    v_mfma_f32_16x16x32_bf16 v[140:143], a[120:123], a[80:83], v[140:143]
    v_cvt_pk_bf16_f32 v124, v124, v125
    v_cvt_pk_bf16_f32 v174, v60, v61
    v_cvt_pk_bf16_f32 v125, v126, v127
    v_mfma_f32_16x16x32_bf16 v[236:239], a[124:127], a[80:83], v[236:239]
    v_cvt_pk_bf16_f32 v175, v62, v63
    v_cvt_pk_bf16_f32 v126, v220, v221
    v_cvt_pk_bf16_f32 v127, v222, v223
    v_mfma_f32_16x16x32_bf16 a[176:179], a[112:115], a[92:95], a[176:179]
    ds_read_b64_tr_b16 a[0:1], v42 offset:0
    v_accvgpr_read_b32 v56, a160
    v_accvgpr_read_b32 v57, a161
    v_mfma_f32_16x16x32_bf16 a[180:183], a[116:119], a[92:95], a[180:183]
    ds_read_b64_tr_b16 a[2:3], v42 offset:1024
    v_accvgpr_read_b32 v58, a162
    v_accvgpr_read_b32 v59, a163
    v_mfma_f32_16x16x32_bf16 v[144:147], a[96:99], a[84:87], v[144:147]
    ds_read_b64_tr_b16 a[4:5], v43 offset:0
    v_accvgpr_read_b32 v60, a164
    v_cvt_pk_bf16_f32 v128, v128, v129
    v_mfma_f32_16x16x32_bf16 v[240:243], a[100:103], a[84:87], v[240:243]
    v_accvgpr_read_b32 v61, a165
    v_accvgpr_read_b32 v62, a166
    v_cvt_pk_bf16_f32 v129, v130, v131
    v_mfma_f32_16x16x32_bf16 v[148:151], a[104:107], a[84:87], v[148:151]
    ds_read_b64_tr_b16 a[6:7], v43 offset:1024
    v_accvgpr_read_b32 v63, a167
    v_cvt_pk_bf16_f32 v130, v224, v225
    v_mfma_f32_16x16x32_bf16 v[244:247], a[108:111], a[84:87], v[244:247]
    v_cvt_pk_bf16_f32 v176, v56, v57
    v_cvt_pk_bf16_f32 v131, v226, v227
    v_cvt_pk_bf16_f32 v177, v58, v59
    v_mfma_f32_16x16x32_bf16 a[184:187], a[120:123], a[92:95], a[184:187]
    ds_read_b64_tr_b16 a[8:9], v44 offset:0
    v_cvt_pk_bf16_f32 v132, v132, v133
    v_cvt_pk_bf16_f32 v178, v60, v61
    v_mfma_f32_16x16x32_bf16 a[188:191], a[124:127], a[92:95], a[188:191]
    ds_read_b64_tr_b16 a[10:11], v44 offset:1024
    v_cvt_pk_bf16_f32 v133, v134, v135
    v_cvt_pk_bf16_f32 v179, v62, v63
    v_mfma_f32_16x16x32_bf16 v[152:155], a[112:115], a[84:87], v[152:155]
    ds_read_b64_tr_b16 a[12:13], v45 offset:0
    v_cvt_pk_bf16_f32 v134, v228, v229
    v_cvt_pk_bf16_f32 v135, v230, v231
    v_mfma_f32_16x16x32_bf16 v[248:251], a[116:119], a[84:87], v[248:251]
    ds_read_b64_tr_b16 a[14:15], v45 offset:1024
    v_accvgpr_read_b32 v56, a168
    v_accvgpr_read_b32 v57, a169
    v_mfma_f32_16x16x32_bf16 v[156:159], a[120:123], a[84:87], v[156:159]
    ds_read_b64_tr_b16 a[16:17], v46 offset:0
    v_accvgpr_read_b32 v58, a170
    v_accvgpr_read_b32 v59, a171
    v_mfma_f32_16x16x32_bf16 v[252:255], a[124:127], a[84:87], v[252:255]
    v_accvgpr_read_b32 v60, a172
    v_cvt_pk_bf16_f32 v136, v136, v137
    v_accvgpr_read_b32 v61, a173
    ds_read_b64_tr_b16 a[18:19], v46 offset:1024
    v_accvgpr_read_b32 v62, a174
    v_cvt_pk_bf16_f32 v137, v138, v139
    v_accvgpr_read_b32 v63, a175
    v_cvt_pk_bf16_f32 v138, v232, v233
    v_cvt_pk_bf16_f32 v180, v56, v57
    ds_read_b64_tr_b16 a[20:21], v47 offset:0
    v_cvt_pk_bf16_f32 v139, v234, v235
    v_cvt_pk_bf16_f32 v181, v58, v59
    v_cvt_pk_bf16_f32 v140, v140, v141
    v_cvt_pk_bf16_f32 v182, v60, v61
    ds_read_b64_tr_b16 a[22:23], v47 offset:1024
    v_cvt_pk_bf16_f32 v141, v142, v143
    v_cvt_pk_bf16_f32 v183, v62, v63
    v_cvt_pk_bf16_f32 v142, v236, v237
    ds_read_b64_tr_b16 a[24:25], v48 offset:0
    v_cvt_pk_bf16_f32 v143, v238, v239
    v_accvgpr_read_b32 v56, a176
    ds_read_b64_tr_b16 a[26:27], v48 offset:1024
    v_accvgpr_read_b32 v57, a177
    v_accvgpr_read_b32 v58, a178
    ds_read_b64_tr_b16 a[28:29], v49 offset:0
    v_accvgpr_read_b32 v59, a179
    v_accvgpr_read_b32 v60, a180
    v_cvt_pk_bf16_f32 v144, v144, v145
    ds_read_b64_tr_b16 a[30:31], v49 offset:1024
    v_accvgpr_read_b32 v61, a181
    v_accvgpr_read_b32 v62, a182
    v_cvt_pk_bf16_f32 v145, v146, v147
    v_accvgpr_read_b32 v63, a183
    v_cvt_pk_bf16_f32 v146, v240, v241
    v_cvt_pk_bf16_f32 v184, v56, v57
    v_cvt_pk_bf16_f32 v147, v242, v243
    v_cvt_pk_bf16_f32 v185, v58, v59
    v_cvt_pk_bf16_f32 v148, v148, v149
    v_cvt_pk_bf16_f32 v186, v60, v61
    v_cvt_pk_bf16_f32 v149, v150, v151
    v_cvt_pk_bf16_f32 v187, v62, v63
    v_cvt_pk_bf16_f32 v150, v244, v245
    v_cvt_pk_bf16_f32 v151, v246, v247
    v_accvgpr_read_b32 v56, a184
    v_accvgpr_read_b32 v57, a185
    v_accvgpr_read_b32 v58, a186
    v_accvgpr_read_b32 v59, a187
    v_accvgpr_read_b32 v60, a188
    v_cvt_pk_bf16_f32 v152, v152, v153
    v_accvgpr_read_b32 v61, a189
    v_accvgpr_read_b32 v62, a190
    v_cvt_pk_bf16_f32 v153, v154, v155
    v_accvgpr_read_b32 v63, a191
    v_cvt_pk_bf16_f32 v154, v248, v249
    v_cvt_pk_bf16_f32 v188, v56, v57
    v_cvt_pk_bf16_f32 v155, v250, v251
    v_cvt_pk_bf16_f32 v189, v58, v59
    v_cvt_pk_bf16_f32 v156, v156, v157
    v_cvt_pk_bf16_f32 v190, v60, v61
    v_cvt_pk_bf16_f32 v157, v158, v159
    v_cvt_pk_bf16_f32 v191, v62, v63
    v_cvt_pk_bf16_f32 v158, v252, v253
    v_cvt_pk_bf16_f32 v159, v254, v255
    s_branch k12_join_7
k12_v_6:
k12_loop_24:
    v_mfma_f32_16x16x32_bf16 v[64:67], a[0:3], a[32:35], v[64:67]
    ds_read_b128 a[64:67], v27 offset:0
    v_mfma_f32_16x16x32_bf16 v[68:71], a[0:3], a[36:39], v[68:71]
    ds_read_b64_tr_b16 a[96:97], v28 offset:16384
    v_mfma_f32_16x16x32_bf16 v[72:75], a[0:3], a[40:43], v[72:75]
    v_mfma_f32_16x16x32_bf16 v[76:79], a[0:3], a[44:47], v[76:79]
    s_cmp_eq_u32 s51, s46
    s_cbranch_scc1 k12_ool_26
k12_oolret_27:
    v_mfma_f32_16x16x32_bf16 v[80:83], a[0:3], a[48:51], v[80:83]
    ds_read_b64_tr_b16 a[98:99], v28 offset:18432
    v_mfma_f32_16x16x32_bf16 v[84:87], a[0:3], a[52:55], v[84:87]
    ds_read_b128 a[68:71], v27 offset:2048
    v_mfma_f32_16x16x32_bf16 v[88:91], a[0:3], a[56:59], v[88:91]
    v_mfma_f32_16x16x32_bf16 v[92:95], a[0:3], a[60:63], v[92:95]
    ds_read_b64_tr_b16 a[100:101], v29 offset:16384
    v_mfma_f32_16x16x32_bf16 v[160:163], a[4:7], a[32:35], v[160:163]
    v_mfma_f32_16x16x32_bf16 v[164:167], a[4:7], a[36:39], v[164:167]
    ds_read_b64_tr_b16 a[102:103], v29 offset:18432
    v_mfma_f32_16x16x32_bf16 v[168:171], a[4:7], a[40:43], v[168:171]
    v_mfma_f32_16x16x32_bf16 v[172:175], a[4:7], a[44:47], v[172:175]
    ds_read_b128 a[72:75], v27 offset:4096
    v_mfma_f32_16x16x32_bf16 v[176:179], a[4:7], a[48:51], v[176:179]
    v_mfma_f32_16x16x32_bf16 v[180:183], a[4:7], a[52:55], v[180:183]
    v_mfma_f32_16x16x32_bf16 v[184:187], a[4:7], a[56:59], v[184:187]
    ds_read_b64_tr_b16 a[104:105], v30 offset:16384
    v_mfma_f32_16x16x32_bf16 v[188:191], a[4:7], a[60:63], v[188:191]
    v_mfma_f32_16x16x32_bf16 v[96:99], a[8:11], a[32:35], v[96:99]
    ds_read_b64_tr_b16 a[106:107], v30 offset:18432
    v_mfma_f32_16x16x32_bf16 v[100:103], a[8:11], a[36:39], v[100:103]
    v_mfma_f32_16x16x32_bf16 v[104:107], a[8:11], a[40:43], v[104:107]
    ds_read_b128 a[76:79], v27 offset:6144
    v_mfma_f32_16x16x32_bf16 v[108:111], a[8:11], a[44:47], v[108:111]
    v_mfma_f32_16x16x32_bf16 v[112:115], a[8:11], a[48:51], v[112:115]
    ds_read_b64_tr_b16 a[108:109], v31 offset:16384
    v_mfma_f32_16x16x32_bf16 v[116:119], a[8:11], a[52:55], v[116:119]
    v_mfma_f32_16x16x32_bf16 v[120:123], a[8:11], a[56:59], v[120:123]
    ds_read_b64_tr_b16 a[110:111], v31 offset:18432
    v_mfma_f32_16x16x32_bf16 v[124:127], a[8:11], a[60:63], v[124:127]
    v_mfma_f32_16x16x32_bf16 v[192:195], a[12:15], a[32:35], v[192:195]
    ds_read_b128 a[80:83], v27 offset:8192
    v_mfma_f32_16x16x32_bf16 v[196:199], a[12:15], a[36:39], v[196:199]
    v_mfma_f32_16x16x32_bf16 v[200:203], a[12:15], a[40:43], v[200:203]
    ds_read_b64_tr_b16 a[112:113], v32 offset:16384
    v_mfma_f32_16x16x32_bf16 v[204:207], a[12:15], a[44:47], v[204:207]
    v_mfma_f32_16x16x32_bf16 v[208:211], a[12:15], a[48:51], v[208:211]
    ds_read_b64_tr_b16 a[114:115], v32 offset:18432
    v_mfma_f32_16x16x32_bf16 v[212:215], a[12:15], a[52:55], v[212:215]
    v_mfma_f32_16x16x32_bf16 v[216:219], a[12:15], a[56:59], v[216:219]
    ds_read_b128 a[84:87], v27 offset:10240
    v_mfma_f32_16x16x32_bf16 v[220:223], a[12:15], a[60:63], v[220:223]
    v_mfma_f32_16x16x32_bf16 v[128:131], a[16:19], a[32:35], v[128:131]
    ds_read_b64_tr_b16 a[116:117], v33 offset:16384
    v_mfma_f32_16x16x32_bf16 v[132:135], a[16:19], a[36:39], v[132:135]
    v_mfma_f32_16x16x32_bf16 v[136:139], a[16:19], a[40:43], v[136:139]
    ds_read_b64_tr_b16 a[118:119], v33 offset:18432
    v_mfma_f32_16x16x32_bf16 v[140:143], a[16:19], a[44:47], v[140:143]
    v_mfma_f32_16x16x32_bf16 v[144:147], a[16:19], a[48:51], v[144:147]
    ds_read_b128 a[88:91], v27 offset:12288
    v_mfma_f32_16x16x32_bf16 v[148:151], a[16:19], a[52:55], v[148:151]
    v_mfma_f32_16x16x32_bf16 v[152:155], a[16:19], a[56:59], v[152:155]
    v_mfma_f32_16x16x32_bf16 v[156:159], a[16:19], a[60:63], v[156:159]
    ds_read_b64_tr_b16 a[120:121], v34 offset:16384
    v_mfma_f32_16x16x32_bf16 v[224:227], a[20:23], a[32:35], v[224:227]
    v_mfma_f32_16x16x32_bf16 v[228:231], a[20:23], a[36:39], v[228:231]
    ds_read_b64_tr_b16 a[122:123], v34 offset:18432
    v_mfma_f32_16x16x32_bf16 v[232:235], a[20:23], a[40:43], v[232:235]
    v_mfma_f32_16x16x32_bf16 v[236:239], a[20:23], a[44:47], v[236:239]
    ds_read_b128 a[92:95], v27 offset:14336
    v_mfma_f32_16x16x32_bf16 v[240:243], a[20:23], a[48:51], v[240:243]
    v_mfma_f32_16x16x32_bf16 v[244:247], a[20:23], a[52:55], v[244:247]
    ds_read_b64_tr_b16 a[124:125], v35 offset:16384
    v_mfma_f32_16x16x32_bf16 v[248:251], a[20:23], a[56:59], v[248:251]
    v_mfma_f32_16x16x32_bf16 v[252:255], a[20:23], a[60:63], v[252:255]
    ds_read_b64_tr_b16 a[126:127], v35 offset:18432
    v_mfma_f32_16x16x32_bf16 a[128:131], a[24:27], a[32:35], a[128:131]
    v_mfma_f32_16x16x32_bf16 a[136:139], a[24:27], a[36:39], a[136:139]
    v_mfma_f32_16x16x32_bf16 a[144:147], a[24:27], a[40:43], a[144:147]
    v_mfma_f32_16x16x32_bf16 a[152:155], a[24:27], a[44:47], a[152:155]
    v_mfma_f32_16x16x32_bf16 a[160:163], a[24:27], a[48:51], a[160:163]
    v_mfma_f32_16x16x32_bf16 a[168:171], a[24:27], a[52:55], a[168:171]
    v_mfma_f32_16x16x32_bf16 a[176:179], a[24:27], a[56:59], a[176:179]
    v_mfma_f32_16x16x32_bf16 a[184:187], a[24:27], a[60:63], a[184:187]
    v_mfma_f32_16x16x32_bf16 a[132:135], a[28:31], a[32:35], a[132:135]
    v_mfma_f32_16x16x32_bf16 a[140:143], a[28:31], a[36:39], a[140:143]
    v_mfma_f32_16x16x32_bf16 a[148:151], a[28:31], a[40:43], a[148:151]
    v_mfma_f32_16x16x32_bf16 a[156:159], a[28:31], a[44:47], a[156:159]
    v_mfma_f32_16x16x32_bf16 a[164:167], a[28:31], a[48:51], a[164:167]
    v_mfma_f32_16x16x32_bf16 a[172:175], a[28:31], a[52:55], a[172:175]
    v_mfma_f32_16x16x32_bf16 a[180:183], a[28:31], a[56:59], a[180:183]
    v_mfma_f32_16x16x32_bf16 a[188:191], a[28:31], a[60:63], a[188:191]
    s_waitcnt vmcnt(0) lgkmcnt(0)
    s_barrier
    v_mfma_f32_16x16x32_bf16 v[64:67], a[64:67], a[96:99], v[64:67]
    s_cmp_ge_u32 s49, 1024
    s_cselect_b32 s18, 0, s18
    s_cselect_b32 s22, 0, s22
    ds_read_b128 a[0:3], v26 offset:32768
    v_mfma_f32_16x16x32_bf16 v[68:71], a[64:67], a[100:103], v[68:71]
    s_add_u32 m0, s48, 0
    ds_read_b64_tr_b16 a[32:33], v28 offset:32768
    v_mfma_f32_16x16x32_bf16 v[72:75], a[64:67], a[104:107], v[72:75]
    buffer_load_dwordx4 v10, s[16:19], s49 offen offset:0 lds
    v_mfma_f32_16x16x32_bf16 v[76:79], a[64:67], a[108:111], v[76:79]
    ds_read_b64_tr_b16 a[34:35], v28 offset:34816
    v_mfma_f32_16x16x32_bf16 v[80:83], a[64:67], a[112:115], v[80:83]
    buffer_load_dwordx4 v11, s[16:19], s49 offen offset:1024 lds
    v_mfma_f32_16x16x32_bf16 v[84:87], a[64:67], a[116:119], v[84:87]
    ds_read_b128 a[4:7], v26 offset:34816
    v_mfma_f32_16x16x32_bf16 v[88:91], a[64:67], a[120:123], v[88:91]
    v_mfma_f32_16x16x32_bf16 v[92:95], a[64:67], a[124:127], v[92:95]
    ds_read_b64_tr_b16 a[36:37], v29 offset:32768
    v_mfma_f32_16x16x32_bf16 v[160:163], a[68:71], a[96:99], v[160:163]
    buffer_load_dwordx4 v12, s[16:19], s49 offen offset:2048 lds
    v_mfma_f32_16x16x32_bf16 v[164:167], a[68:71], a[100:103], v[164:167]
    ds_read_b64_tr_b16 a[38:39], v29 offset:34816
    v_mfma_f32_16x16x32_bf16 v[168:171], a[68:71], a[104:107], v[168:171]
    v_mfma_f32_16x16x32_bf16 v[172:175], a[68:71], a[108:111], v[172:175]
    buffer_load_dwordx4 v13, s[16:19], s49 offen offset:3072 lds
    ds_read_b128 a[8:11], v26 offset:36864
    v_mfma_f32_16x16x32_bf16 v[176:179], a[68:71], a[112:115], v[176:179]
    v_mfma_f32_16x16x32_bf16 v[180:183], a[68:71], a[116:119], v[180:183]
    s_add_u32 m0, s48, 4096
    v_mfma_f32_16x16x32_bf16 v[184:187], a[68:71], a[120:123], v[184:187]
    ds_read_b64_tr_b16 a[40:41], v30 offset:32768
    v_mfma_f32_16x16x32_bf16 v[188:191], a[68:71], a[124:127], v[188:191]
    buffer_load_dwordx4 v14, s[16:19], s49 offen offset:0 lds
    v_mfma_f32_16x16x32_bf16 v[96:99], a[72:75], a[96:99], v[96:99]
    ds_read_b64_tr_b16 a[42:43], v30 offset:34816
    v_mfma_f32_16x16x32_bf16 v[100:103], a[72:75], a[100:103], v[100:103]
    v_mfma_f32_16x16x32_bf16 v[104:107], a[72:75], a[104:107], v[104:107]
    buffer_load_dwordx4 v15, s[16:19], s49 offen offset:1024 lds
    ds_read_b128 a[12:15], v26 offset:38912
    v_mfma_f32_16x16x32_bf16 v[108:111], a[72:75], a[108:111], v[108:111]
    v_mfma_f32_16x16x32_bf16 v[112:115], a[72:75], a[112:115], v[112:115]
    ds_read_b64_tr_b16 a[44:45], v31 offset:32768
    v_mfma_f32_16x16x32_bf16 v[116:119], a[72:75], a[116:119], v[116:119]
    v_mfma_f32_16x16x32_bf16 v[120:123], a[72:75], a[120:123], v[120:123]
    buffer_load_dwordx4 v16, s[16:19], s49 offen offset:2048 lds
    ds_read_b64_tr_b16 a[46:47], v31 offset:34816
    v_mfma_f32_16x16x32_bf16 v[124:127], a[72:75], a[124:127], v[124:127]
    v_mfma_f32_16x16x32_bf16 v[192:195], a[76:79], a[96:99], v[192:195]
    ds_read_b128 a[16:19], v26 offset:40960
    v_mfma_f32_16x16x32_bf16 v[196:199], a[76:79], a[100:103], v[196:199]
    buffer_load_dwordx4 v17, s[16:19], s49 offen offset:3072 lds
    v_mfma_f32_16x16x32_bf16 v[200:203], a[76:79], a[104:107], v[200:203]
    ds_read_b64_tr_b16 a[48:49], v32 offset:32768
    v_mfma_f32_16x16x32_bf16 v[204:207], a[76:79], a[108:111], v[204:207]
    s_add_u32 s49, s49, 128
    v_mfma_f32_16x16x32_bf16 v[208:211], a[76:79], a[112:115], v[208:211]
    s_add_u32 m0, s48, 65536
    ds_read_b64_tr_b16 a[50:51], v32 offset:34816
    v_mfma_f32_16x16x32_bf16 v[212:215], a[76:79], a[116:119], v[212:215]
    buffer_load_dwordx4 v18, s[20:23], s50 offen offset:0 lds
    v_mfma_f32_16x16x32_bf16 v[216:219], a[76:79], a[120:123], v[216:219]
    ds_read_b128 a[20:23], v26 offset:43008
    v_mfma_f32_16x16x32_bf16 v[220:223], a[76:79], a[124:127], v[220:223]
    v_mfma_f32_16x16x32_bf16 v[128:131], a[80:83], a[96:99], v[128:131]
    buffer_load_dwordx4 v19, s[20:23], s50 offen offset:1024 lds
    ds_read_b64_tr_b16 a[52:53], v33 offset:32768
    v_mfma_f32_16x16x32_bf16 v[132:135], a[80:83], a[100:103], v[132:135]
    v_mfma_f32_16x16x32_bf16 v[136:139], a[80:83], a[104:107], v[136:139]
    ds_read_b64_tr_b16 a[54:55], v33 offset:34816
    v_mfma_f32_16x16x32_bf16 v[140:143], a[80:83], a[108:111], v[140:143]
    buffer_load_dwordx4 v20, s[20:23], s50 offen offset:2048 lds
    v_mfma_f32_16x16x32_bf16 v[144:147], a[80:83], a[112:115], v[144:147]
    ds_read_b128 a[24:27], v26 offset:45056
    v_mfma_f32_16x16x32_bf16 v[148:151], a[80:83], a[116:119], v[148:151]
    v_mfma_f32_16x16x32_bf16 v[152:155], a[80:83], a[120:123], v[152:155]
    v_mfma_f32_16x16x32_bf16 v[156:159], a[80:83], a[124:127], v[156:159]
    buffer_load_dwordx4 v21, s[20:23], s50 offen offset:3072 lds
    ds_read_b64_tr_b16 a[56:57], v34 offset:32768
    v_mfma_f32_16x16x32_bf16 v[224:227], a[84:87], a[96:99], v[224:227]
    s_add_u32 m0, s48, 69632
    v_mfma_f32_16x16x32_bf16 v[228:231], a[84:87], a[100:103], v[228:231]
    ds_read_b64_tr_b16 a[58:59], v34 offset:34816
    v_mfma_f32_16x16x32_bf16 v[232:235], a[84:87], a[104:107], v[232:235]
    buffer_load_dwordx4 v22, s[20:23], s50 offen offset:0 lds
    v_mfma_f32_16x16x32_bf16 v[236:239], a[84:87], a[108:111], v[236:239]
    ds_read_b128 a[28:31], v26 offset:47104
    v_mfma_f32_16x16x32_bf16 v[240:243], a[84:87], a[112:115], v[240:243]
    v_mfma_f32_16x16x32_bf16 v[244:247], a[84:87], a[116:119], v[244:247]
    ds_read_b64_tr_b16 a[60:61], v35 offset:32768
    v_mfma_f32_16x16x32_bf16 v[248:251], a[84:87], a[120:123], v[248:251]
    buffer_load_dwordx4 v23, s[20:23], s50 offen offset:1024 lds
    v_mfma_f32_16x16x32_bf16 v[252:255], a[84:87], a[124:127], v[252:255]
    ds_read_b64_tr_b16 a[62:63], v35 offset:34816
    v_mfma_f32_16x16x32_bf16 a[128:131], a[88:91], a[96:99], a[128:131]
    v_mfma_f32_16x16x32_bf16 a[136:139], a[88:91], a[100:103], a[136:139]
    buffer_load_dwordx4 v24, s[20:23], s50 offen offset:2048 lds
    v_mfma_f32_16x16x32_bf16 a[144:147], a[88:91], a[104:107], a[144:147]
    v_mfma_f32_16x16x32_bf16 a[152:155], a[88:91], a[108:111], a[152:155]
    v_mfma_f32_16x16x32_bf16 a[160:163], a[88:91], a[112:115], a[160:163]
    v_mfma_f32_16x16x32_bf16 a[168:171], a[88:91], a[116:119], a[168:171]
    buffer_load_dwordx4 v25, s[20:23], s50 offen offset:3072 lds
    v_mfma_f32_16x16x32_bf16 a[176:179], a[88:91], a[120:123], a[176:179]
    v_mfma_f32_16x16x32_bf16 a[184:187], a[88:91], a[124:127], a[184:187]
    s_add_u32 s50, s50, 0x80000
    v_mfma_f32_16x16x32_bf16 a[132:135], a[92:95], a[96:99], a[132:135]
    v_mfma_f32_16x16x32_bf16 a[140:143], a[92:95], a[100:103], a[140:143]
    s_cmp_eq_u32 s51, s53
    s_cbranch_scc1 k12_ool_28
k12_oolret_29:
    v_mfma_f32_16x16x32_bf16 a[148:151], a[92:95], a[104:107], a[148:151]
    v_mfma_f32_16x16x32_bf16 a[156:159], a[92:95], a[108:111], a[156:159]
    s_cmp_eq_u32 s51, s63
    s_cbranch_scc1 k12_ool_30
k12_oolret_31:
    v_mfma_f32_16x16x32_bf16 a[164:167], a[92:95], a[112:115], a[164:167]
    v_mfma_f32_16x16x32_bf16 a[172:175], a[92:95], a[116:119], a[172:175]
    s_add_u32 s51, s51, 1
    v_mfma_f32_16x16x32_bf16 a[180:183], a[92:95], a[120:123], a[180:183]
    v_mfma_f32_16x16x32_bf16 a[188:191], a[92:95], a[124:127], a[188:191]
    s_waitcnt lgkmcnt(0)
    v_mfma_f32_16x16x32_bf16 v[64:67], a[0:3], a[32:35], v[64:67]
    ds_read_b128 a[64:67], v27 offset:32768
    v_mfma_f32_16x16x32_bf16 v[68:71], a[0:3], a[36:39], v[68:71]
    ds_read_b64_tr_b16 a[96:97], v28 offset:49152
    v_mfma_f32_16x16x32_bf16 v[72:75], a[0:3], a[40:43], v[72:75]
    v_mfma_f32_16x16x32_bf16 v[76:79], a[0:3], a[44:47], v[76:79]
    ds_read_b64_tr_b16 a[98:99], v28 offset:51200
    v_mfma_f32_16x16x32_bf16 v[80:83], a[0:3], a[48:51], v[80:83]
    v_mfma_f32_16x16x32_bf16 v[84:87], a[0:3], a[52:55], v[84:87]
    ds_read_b128 a[68:71], v27 offset:34816
    v_mfma_f32_16x16x32_bf16 v[88:91], a[0:3], a[56:59], v[88:91]
    v_mfma_f32_16x16x32_bf16 v[92:95], a[0:3], a[60:63], v[92:95]
    ds_read_b64_tr_b16 a[100:101], v29 offset:49152
    v_mfma_f32_16x16x32_bf16 v[160:163], a[4:7], a[32:35], v[160:163]
    v_mfma_f32_16x16x32_bf16 v[164:167], a[4:7], a[36:39], v[164:167]
    ds_read_b64_tr_b16 a[102:103], v29 offset:51200
    v_mfma_f32_16x16x32_bf16 v[168:171], a[4:7], a[40:43], v[168:171]
    v_mfma_f32_16x16x32_bf16 v[172:175], a[4:7], a[44:47], v[172:175]
    ds_read_b128 a[72:75], v27 offset:36864
    v_mfma_f32_16x16x32_bf16 v[176:179], a[4:7], a[48:51], v[176:179]
    v_mfma_f32_16x16x32_bf16 v[180:183], a[4:7], a[52:55], v[180:183]
    v_mfma_f32_16x16x32_bf16 v[184:187], a[4:7], a[56:59], v[184:187]
    ds_read_b64_tr_b16 a[104:105], v30 offset:49152
    v_mfma_f32_16x16x32_bf16 v[188:191], a[4:7], a[60:63], v[188:191]
    v_mfma_f32_16x16x32_bf16 v[96:99], a[8:11], a[32:35], v[96:99]
    ds_read_b64_tr_b16 a[106:107], v30 offset:51200
    v_mfma_f32_16x16x32_bf16 v[100:103], a[8:11], a[36:39], v[100:103]
    v_mfma_f32_16x16x32_bf16 v[104:107], a[8:11], a[40:43], v[104:107]
    ds_read_b128 a[76:79], v27 offset:38912
    v_mfma_f32_16x16x32_bf16 v[108:111], a[8:11], a[44:47], v[108:111]
    v_mfma_f32_16x16x32_bf16 v[112:115], a[8:11], a[48:51], v[112:115]
    ds_read_b64_tr_b16 a[108:109], v31 offset:49152
    v_mfma_f32_16x16x32_bf16 v[116:119], a[8:11], a[52:55], v[116:119]
    v_mfma_f32_16x16x32_bf16 v[120:123], a[8:11], a[56:59], v[120:123]
    ds_read_b64_tr_b16 a[110:111], v31 offset:51200
    v_mfma_f32_16x16x32_bf16 v[124:127], a[8:11], a[60:63], v[124:127]
    v_mfma_f32_16x16x32_bf16 v[192:195], a[12:15], a[32:35], v[192:195]
    ds_read_b128 a[80:83], v27 offset:40960
    v_mfma_f32_16x16x32_bf16 v[196:199], a[12:15], a[36:39], v[196:199]
    v_mfma_f32_16x16x32_bf16 v[200:203], a[12:15], a[40:43], v[200:203]
    ds_read_b64_tr_b16 a[112:113], v32 offset:49152
    v_mfma_f32_16x16x32_bf16 v[204:207], a[12:15], a[44:47], v[204:207]
    v_mfma_f32_16x16x32_bf16 v[208:211], a[12:15], a[48:51], v[208:211]
    ds_read_b64_tr_b16 a[114:115], v32 offset:51200
    v_mfma_f32_16x16x32_bf16 v[212:215], a[12:15], a[52:55], v[212:215]
    v_mfma_f32_16x16x32_bf16 v[216:219], a[12:15], a[56:59], v[216:219]
    ds_read_b128 a[84:87], v27 offset:43008
    v_mfma_f32_16x16x32_bf16 v[220:223], a[12:15], a[60:63], v[220:223]
    v_mfma_f32_16x16x32_bf16 v[128:131], a[16:19], a[32:35], v[128:131]
    ds_read_b64_tr_b16 a[116:117], v33 offset:49152
    v_mfma_f32_16x16x32_bf16 v[132:135], a[16:19], a[36:39], v[132:135]
    v_mfma_f32_16x16x32_bf16 v[136:139], a[16:19], a[40:43], v[136:139]
    ds_read_b64_tr_b16 a[118:119], v33 offset:51200
    v_mfma_f32_16x16x32_bf16 v[140:143], a[16:19], a[44:47], v[140:143]
    v_mfma_f32_16x16x32_bf16 v[144:147], a[16:19], a[48:51], v[144:147]
    ds_read_b128 a[88:91], v27 offset:45056
    v_mfma_f32_16x16x32_bf16 v[148:151], a[16:19], a[52:55], v[148:151]
    v_mfma_f32_16x16x32_bf16 v[152:155], a[16:19], a[56:59], v[152:155]
    v_mfma_f32_16x16x32_bf16 v[156:159], a[16:19], a[60:63], v[156:159]
    ds_read_b64_tr_b16 a[120:121], v34 offset:49152
    v_mfma_f32_16x16x32_bf16 v[224:227], a[20:23], a[32:35], v[224:227]
    v_mfma_f32_16x16x32_bf16 v[228:231], a[20:23], a[36:39], v[228:231]
    ds_read_b64_tr_b16 a[122:123], v34 offset:51200
    v_mfma_f32_16x16x32_bf16 v[232:235], a[20:23], a[40:43], v[232:235]
    v_mfma_f32_16x16x32_bf16 v[236:239], a[20:23], a[44:47], v[236:239]
    ds_read_b128 a[92:95], v27 offset:47104
    v_mfma_f32_16x16x32_bf16 v[240:243], a[20:23], a[48:51], v[240:243]
    v_mfma_f32_16x16x32_bf16 v[244:247], a[20:23], a[52:55], v[244:247]
    ds_read_b64_tr_b16 a[124:125], v35 offset:49152
    v_mfma_f32_16x16x32_bf16 v[248:251], a[20:23], a[56:59], v[248:251]
    v_mfma_f32_16x16x32_bf16 v[252:255], a[20:23], a[60:63], v[252:255]
    ds_read_b64_tr_b16 a[126:127], v35 offset:51200
    v_mfma_f32_16x16x32_bf16 a[128:131], a[24:27], a[32:35], a[128:131]
    v_mfma_f32_16x16x32_bf16 a[136:139], a[24:27], a[36:39], a[136:139]
    v_mfma_f32_16x16x32_bf16 a[144:147], a[24:27], a[40:43], a[144:147]
    v_mfma_f32_16x16x32_bf16 a[152:155], a[24:27], a[44:47], a[152:155]
    v_mfma_f32_16x16x32_bf16 a[160:163], a[24:27], a[48:51], a[160:163]
    v_mfma_f32_16x16x32_bf16 a[168:171], a[24:27], a[52:55], a[168:171]
    v_mfma_f32_16x16x32_bf16 a[176:179], a[24:27], a[56:59], a[176:179]
    v_mfma_f32_16x16x32_bf16 a[184:187], a[24:27], a[60:63], a[184:187]
    s_sub_u32 s52, s51, 1
    s_cmp_eq_u32 s52, s46
    s_cbranch_scc1 k12_ool_34
k12_oolret_35:
    v_mfma_f32_16x16x32_bf16 a[132:135], a[28:31], a[32:35], a[132:135]
    v_mfma_f32_16x16x32_bf16 a[140:143], a[28:31], a[36:39], a[140:143]
    v_mfma_f32_16x16x32_bf16 a[148:151], a[28:31], a[40:43], a[148:151]
    v_mfma_f32_16x16x32_bf16 a[156:159], a[28:31], a[44:47], a[156:159]
    v_mfma_f32_16x16x32_bf16 a[164:167], a[28:31], a[48:51], a[164:167]
    v_mfma_f32_16x16x32_bf16 a[172:175], a[28:31], a[52:55], a[172:175]
    v_mfma_f32_16x16x32_bf16 a[180:183], a[28:31], a[56:59], a[180:183]
    v_mfma_f32_16x16x32_bf16 a[188:191], a[28:31], a[60:63], a[188:191]
    s_waitcnt vmcnt(0) lgkmcnt(0)
    s_barrier
    s_cmp_eq_u32 s51, 7
    s_cbranch_scc1 k12_last_25
    v_mfma_f32_16x16x32_bf16 v[64:67], a[64:67], a[96:99], v[64:67]
    ds_read_b128 a[0:3], v26 offset:0
    v_mfma_f32_16x16x32_bf16 v[68:71], a[64:67], a[100:103], v[68:71]
    s_add_u32 m0, s48, 32768
    ds_read_b64_tr_b16 a[32:33], v28 offset:0
    v_mfma_f32_16x16x32_bf16 v[72:75], a[64:67], a[104:107], v[72:75]
    buffer_load_dwordx4 v10, s[16:19], s49 offen offset:0 lds
    v_mfma_f32_16x16x32_bf16 v[76:79], a[64:67], a[108:111], v[76:79]
    ds_read_b64_tr_b16 a[34:35], v28 offset:2048
    v_mfma_f32_16x16x32_bf16 v[80:83], a[64:67], a[112:115], v[80:83]
    buffer_load_dwordx4 v11, s[16:19], s49 offen offset:1024 lds
    v_mfma_f32_16x16x32_bf16 v[84:87], a[64:67], a[116:119], v[84:87]
    ds_read_b128 a[4:7], v26 offset:2048
    v_mfma_f32_16x16x32_bf16 v[88:91], a[64:67], a[120:123], v[88:91]
    v_mfma_f32_16x16x32_bf16 v[92:95], a[64:67], a[124:127], v[92:95]
    ds_read_b64_tr_b16 a[36:37], v29 offset:0
    v_mfma_f32_16x16x32_bf16 v[160:163], a[68:71], a[96:99], v[160:163]
    buffer_load_dwordx4 v12, s[16:19], s49 offen offset:2048 lds
    v_mfma_f32_16x16x32_bf16 v[164:167], a[68:71], a[100:103], v[164:167]
    ds_read_b64_tr_b16 a[38:39], v29 offset:2048
    v_mfma_f32_16x16x32_bf16 v[168:171], a[68:71], a[104:107], v[168:171]
    v_mfma_f32_16x16x32_bf16 v[172:175], a[68:71], a[108:111], v[172:175]
    buffer_load_dwordx4 v13, s[16:19], s49 offen offset:3072 lds
    ds_read_b128 a[8:11], v26 offset:4096
    v_mfma_f32_16x16x32_bf16 v[176:179], a[68:71], a[112:115], v[176:179]
    v_mfma_f32_16x16x32_bf16 v[180:183], a[68:71], a[116:119], v[180:183]
    s_add_u32 m0, s48, 36864
    v_mfma_f32_16x16x32_bf16 v[184:187], a[68:71], a[120:123], v[184:187]
    ds_read_b64_tr_b16 a[40:41], v30 offset:0
    v_mfma_f32_16x16x32_bf16 v[188:191], a[68:71], a[124:127], v[188:191]
    buffer_load_dwordx4 v14, s[16:19], s49 offen offset:0 lds
    v_mfma_f32_16x16x32_bf16 v[96:99], a[72:75], a[96:99], v[96:99]
    ds_read_b64_tr_b16 a[42:43], v30 offset:2048
    v_mfma_f32_16x16x32_bf16 v[100:103], a[72:75], a[100:103], v[100:103]
    v_mfma_f32_16x16x32_bf16 v[104:107], a[72:75], a[104:107], v[104:107]
    buffer_load_dwordx4 v15, s[16:19], s49 offen offset:1024 lds
    ds_read_b128 a[12:15], v26 offset:6144
    v_mfma_f32_16x16x32_bf16 v[108:111], a[72:75], a[108:111], v[108:111]
    v_mfma_f32_16x16x32_bf16 v[112:115], a[72:75], a[112:115], v[112:115]
    ds_read_b64_tr_b16 a[44:45], v31 offset:0
    v_mfma_f32_16x16x32_bf16 v[116:119], a[72:75], a[116:119], v[116:119]
    v_mfma_f32_16x16x32_bf16 v[120:123], a[72:75], a[120:123], v[120:123]
    buffer_load_dwordx4 v16, s[16:19], s49 offen offset:2048 lds
    ds_read_b64_tr_b16 a[46:47], v31 offset:2048
    v_mfma_f32_16x16x32_bf16 v[124:127], a[72:75], a[124:127], v[124:127]
    v_mfma_f32_16x16x32_bf16 v[192:195], a[76:79], a[96:99], v[192:195]
    ds_read_b128 a[16:19], v26 offset:8192
    v_mfma_f32_16x16x32_bf16 v[196:199], a[76:79], a[100:103], v[196:199]
    buffer_load_dwordx4 v17, s[16:19], s49 offen offset:3072 lds
    v_mfma_f32_16x16x32_bf16 v[200:203], a[76:79], a[104:107], v[200:203]
    ds_read_b64_tr_b16 a[48:49], v32 offset:0
    v_mfma_f32_16x16x32_bf16 v[204:207], a[76:79], a[108:111], v[204:207]
    s_add_u32 s49, s49, 128
    v_mfma_f32_16x16x32_bf16 v[208:211], a[76:79], a[112:115], v[208:211]
    s_add_u32 m0, s48, 98304
    ds_read_b64_tr_b16 a[50:51], v32 offset:2048
    v_mfma_f32_16x16x32_bf16 v[212:215], a[76:79], a[116:119], v[212:215]
    buffer_load_dwordx4 v18, s[20:23], s50 offen offset:0 lds
    v_mfma_f32_16x16x32_bf16 v[216:219], a[76:79], a[120:123], v[216:219]
    ds_read_b128 a[20:23], v26 offset:10240
    v_mfma_f32_16x16x32_bf16 v[220:223], a[76:79], a[124:127], v[220:223]
    v_mfma_f32_16x16x32_bf16 v[128:131], a[80:83], a[96:99], v[128:131]
    buffer_load_dwordx4 v19, s[20:23], s50 offen offset:1024 lds
    ds_read_b64_tr_b16 a[52:53], v33 offset:0
    v_mfma_f32_16x16x32_bf16 v[132:135], a[80:83], a[100:103], v[132:135]
    v_mfma_f32_16x16x32_bf16 v[136:139], a[80:83], a[104:107], v[136:139]
    ds_read_b64_tr_b16 a[54:55], v33 offset:2048
    v_mfma_f32_16x16x32_bf16 v[140:143], a[80:83], a[108:111], v[140:143]
    buffer_load_dwordx4 v20, s[20:23], s50 offen offset:2048 lds
    v_mfma_f32_16x16x32_bf16 v[144:147], a[80:83], a[112:115], v[144:147]
    ds_read_b128 a[24:27], v26 offset:12288
    v_mfma_f32_16x16x32_bf16 v[148:151], a[80:83], a[116:119], v[148:151]
    v_mfma_f32_16x16x32_bf16 v[152:155], a[80:83], a[120:123], v[152:155]
    v_mfma_f32_16x16x32_bf16 v[156:159], a[80:83], a[124:127], v[156:159]
    buffer_load_dwordx4 v21, s[20:23], s50 offen offset:3072 lds
    ds_read_b64_tr_b16 a[56:57], v34 offset:0
    v_mfma_f32_16x16x32_bf16 v[224:227], a[84:87], a[96:99], v[224:227]
    s_add_u32 m0, s48, 102400
    v_mfma_f32_16x16x32_bf16 v[228:231], a[84:87], a[100:103], v[228:231]
    ds_read_b64_tr_b16 a[58:59], v34 offset:2048
    v_mfma_f32_16x16x32_bf16 v[232:235], a[84:87], a[104:107], v[232:235]
    buffer_load_dwordx4 v22, s[20:23], s50 offen offset:0 lds
    v_mfma_f32_16x16x32_bf16 v[236:239], a[84:87], a[108:111], v[236:239]
    ds_read_b128 a[28:31], v26 offset:14336
    v_mfma_f32_16x16x32_bf16 v[240:243], a[84:87], a[112:115], v[240:243]
    v_mfma_f32_16x16x32_bf16 v[244:247], a[84:87], a[116:119], v[244:247]
    ds_read_b64_tr_b16 a[60:61], v35 offset:0
    v_mfma_f32_16x16x32_bf16 v[248:251], a[84:87], a[120:123], v[248:251]
    buffer_load_dwordx4 v23, s[20:23], s50 offen offset:1024 lds
    v_mfma_f32_16x16x32_bf16 v[252:255], a[84:87], a[124:127], v[252:255]
    ds_read_b64_tr_b16 a[62:63], v35 offset:2048
    v_mfma_f32_16x16x32_bf16 a[128:131], a[88:91], a[96:99], a[128:131]
    v_mfma_f32_16x16x32_bf16 a[136:139], a[88:91], a[100:103], a[136:139]
    buffer_load_dwordx4 v24, s[20:23], s50 offen offset:2048 lds
    v_mfma_f32_16x16x32_bf16 a[144:147], a[88:91], a[104:107], a[144:147]
    v_mfma_f32_16x16x32_bf16 a[152:155], a[88:91], a[108:111], a[152:155]
    v_mfma_f32_16x16x32_bf16 a[160:163], a[88:91], a[112:115], a[160:163]
    v_mfma_f32_16x16x32_bf16 a[168:171], a[88:91], a[116:119], a[168:171]
    buffer_load_dwordx4 v25, s[20:23], s50 offen offset:3072 lds
    v_mfma_f32_16x16x32_bf16 a[176:179], a[88:91], a[120:123], a[176:179]
    v_mfma_f32_16x16x32_bf16 a[184:187], a[88:91], a[124:127], a[184:187]
    s_add_u32 s50, s50, 0x80000
    v_mfma_f32_16x16x32_bf16 a[132:135], a[92:95], a[96:99], a[132:135]
    v_mfma_f32_16x16x32_bf16 a[140:143], a[92:95], a[100:103], a[140:143]
    s_cmp_eq_u32 s51, s53
    s_cbranch_scc1 k12_ool_36
k12_oolret_37:
    v_mfma_f32_16x16x32_bf16 a[148:151], a[92:95], a[104:107], a[148:151]
    v_mfma_f32_16x16x32_bf16 a[156:159], a[92:95], a[108:111], a[156:159]
    s_cmp_eq_u32 s51, 5
    s_cbranch_scc1 k12_ool_38
k12_oolret_39:
    v_mfma_f32_16x16x32_bf16 a[164:167], a[92:95], a[112:115], a[164:167]
    v_mfma_f32_16x16x32_bf16 a[172:175], a[92:95], a[116:119], a[172:175]
    s_add_u32 s51, s51, 1
    v_mfma_f32_16x16x32_bf16 a[180:183], a[92:95], a[120:123], a[180:183]
    v_mfma_f32_16x16x32_bf16 a[188:191], a[92:95], a[124:127], a[188:191]
    s_waitcnt lgkmcnt(0)
    s_branch k12_loop_24
k12_last_25:
    v_mfma_f32_16x16x32_bf16 v[64:67], a[64:67], a[96:99], v[64:67]
    s_add_u32 m0, s60, 98304
    v_mfma_f32_16x16x32_bf16 v[160:163], a[68:71], a[96:99], v[160:163]
    buffer_load_dwordx4 v38, s[12:15], s61 offen offset:0 lds
    v_mfma_f32_16x16x32_bf16 v[68:71], a[64:67], a[100:103], v[68:71]
    buffer_load_dwordx4 v39, s[12:15], s61 offen offset:1024 lds
    v_mfma_f32_16x16x32_bf16 v[164:167], a[68:71], a[100:103], v[164:167]
    v_mfma_f32_16x16x32_bf16 v[72:75], a[64:67], a[104:107], v[72:75]
    buffer_load_dwordx4 v40, s[12:15], s61 offen offset:2048 lds
    v_mfma_f32_16x16x32_bf16 v[168:171], a[68:71], a[104:107], v[168:171]
    v_cvt_pk_bf16_f32 v64, v64, v65
    v_cvt_pk_bf16_f32 v65, v66, v67
    v_cvt_pk_bf16_f32 v66, v160, v161
    v_mfma_f32_16x16x32_bf16 v[76:79], a[64:67], a[108:111], v[76:79]
    v_cvt_pk_bf16_f32 v67, v162, v163
    v_mfma_f32_16x16x32_bf16 v[172:175], a[68:71], a[108:111], v[172:175]
    v_cvt_pk_bf16_f32 v68, v68, v69
    v_cvt_pk_bf16_f32 v69, v70, v71
    v_cvt_pk_bf16_f32 v70, v164, v165
    v_mfma_f32_16x16x32_bf16 v[80:83], a[64:67], a[112:115], v[80:83]
    buffer_load_dwordx4 v41, s[12:15], s61 offen offset:3072 lds
    v_mfma_f32_16x16x32_bf16 v[176:179], a[68:71], a[112:115], v[176:179]
    s_add_u32 s61, s61, 0x80000
    v_cvt_pk_bf16_f32 v71, v166, v167
    v_cvt_pk_bf16_f32 v72, v72, v73
    v_cvt_pk_bf16_f32 v73, v74, v75
    v_mfma_f32_16x16x32_bf16 v[84:87], a[64:67], a[116:119], v[84:87]
    buffer_load_dwordx4 a[192:195], v36, s[8:11], s62 offen offset:0 sc1
    buffer_load_dwordx4 a[196:199], v36, s[8:11], s62 offen offset:1024 sc1
    v_mfma_f32_16x16x32_bf16 v[180:183], a[68:71], a[116:119], v[180:183]
    v_cvt_pk_bf16_f32 v74, v168, v169
    v_cvt_pk_bf16_f32 v75, v170, v171
    v_cvt_pk_bf16_f32 v76, v76, v77
    v_mfma_f32_16x16x32_bf16 v[88:91], a[64:67], a[120:123], v[88:91]
    v_cvt_pk_bf16_f32 v77, v78, v79
    v_cvt_pk_bf16_f32 v78, v172, v173
    v_cvt_pk_bf16_f32 v79, v174, v175
    v_mfma_f32_16x16x32_bf16 v[184:187], a[68:71], a[120:123], v[184:187]
    v_cvt_pk_bf16_f32 v80, v80, v81
    v_cvt_pk_bf16_f32 v81, v82, v83
    v_cvt_pk_bf16_f32 v82, v176, v177
    v_mfma_f32_16x16x32_bf16 v[92:95], a[64:67], a[124:127], v[92:95]
    buffer_load_dwordx4 a[200:203], v37, s[8:11], s62 offen offset:0 sc1
    buffer_load_dwordx4 a[204:207], v37, s[8:11], s62 offen offset:1024 sc1
    v_mfma_f32_16x16x32_bf16 v[188:191], a[68:71], a[124:127], v[188:191]
    s_add_u32 s62, s62, 0x20000
    v_cvt_pk_bf16_f32 v83, v178, v179
    v_cvt_pk_bf16_f32 v84, v84, v85
    v_cvt_pk_bf16_f32 v85, v86, v87
    v_mfma_f32_16x16x32_bf16 a[128:131], a[88:91], a[96:99], a[128:131]
    v_cvt_pk_bf16_f32 v86, v180, v181
    v_cvt_pk_bf16_f32 v87, v182, v183
    v_mfma_f32_16x16x32_bf16 a[132:135], a[92:95], a[96:99], a[132:135]
    v_cvt_pk_bf16_f32 v88, v88, v89
    v_cvt_pk_bf16_f32 v89, v90, v91
    v_cvt_pk_bf16_f32 v90, v184, v185
    v_mfma_f32_16x16x32_bf16 v[96:99], a[72:75], a[96:99], v[96:99]
    buffer_load_dwordx4 a[208:211], v36, s[8:11], s62 offen offset:0 sc1
    buffer_load_dwordx4 a[212:215], v36, s[8:11], s62 offen offset:1024 sc1
    v_mfma_f32_16x16x32_bf16 v[192:195], a[76:79], a[96:99], v[192:195]
    v_cvt_pk_bf16_f32 v91, v186, v187
    v_cvt_pk_bf16_f32 v92, v92, v93
    v_cvt_pk_bf16_f32 v93, v94, v95
    v_mfma_f32_16x16x32_bf16 v[100:103], a[72:75], a[100:103], v[100:103]
    v_cvt_pk_bf16_f32 v94, v188, v189
    v_cvt_pk_bf16_f32 v95, v190, v191
    v_mfma_f32_16x16x32_bf16 v[196:199], a[76:79], a[100:103], v[196:199]
    v_accvgpr_read_b32 v56, a128
    v_accvgpr_read_b32 v57, a129
    v_accvgpr_read_b32 v58, a130
    v_mfma_f32_16x16x32_bf16 a[136:139], a[88:91], a[100:103], a[136:139]
    buffer_load_dwordx4 a[216:219], v37, s[8:11], s62 offen offset:0 sc1
    buffer_load_dwordx4 a[220:223], v37, s[8:11], s62 offen offset:1024 sc1
    v_mfma_f32_16x16x32_bf16 a[140:143], a[92:95], a[100:103], a[140:143]
    s_add_u32 s62, s62, 0x20000
    v_accvgpr_read_b32 v59, a131
    v_accvgpr_read_b32 v60, a132
    v_cvt_pk_bf16_f32 v96, v96, v97
    v_mfma_f32_16x16x32_bf16 v[104:107], a[72:75], a[104:107], v[104:107]
    s_add_u32 m0, s60, 114688
    v_accvgpr_read_b32 v61, a133
    v_accvgpr_read_b32 v62, a134
    v_cvt_pk_bf16_f32 v97, v98, v99
    v_mfma_f32_16x16x32_bf16 v[200:203], a[76:79], a[104:107], v[200:203]
    v_accvgpr_read_b32 v63, a135
    v_cvt_pk_bf16_f32 v98, v192, v193
    v_cvt_pk_bf16_f32 v160, v56, v57
    v_mfma_f32_16x16x32_bf16 v[108:111], a[72:75], a[108:111], v[108:111]
    v_cvt_pk_bf16_f32 v99, v194, v195
    v_cvt_pk_bf16_f32 v161, v58, v59
    v_cvt_pk_bf16_f32 v100, v100, v101
    v_mfma_f32_16x16x32_bf16 v[204:207], a[76:79], a[108:111], v[204:207]
    buffer_load_dwordx4 v38, s[12:15], s61 offen offset:0 lds
    buffer_load_dwordx4 v39, s[12:15], s61 offen offset:1024 lds
    v_mfma_f32_16x16x32_bf16 a[144:147], a[88:91], a[104:107], a[144:147]
    v_cvt_pk_bf16_f32 v162, v60, v61
    v_cvt_pk_bf16_f32 v101, v102, v103
    v_cvt_pk_bf16_f32 v163, v62, v63
    v_mfma_f32_16x16x32_bf16 a[148:151], a[92:95], a[104:107], a[148:151]
    v_cvt_pk_bf16_f32 v102, v196, v197
    v_cvt_pk_bf16_f32 v103, v198, v199
    v_accvgpr_read_b32 v56, a136
    v_mfma_f32_16x16x32_bf16 v[112:115], a[72:75], a[112:115], v[112:115]
    v_accvgpr_read_b32 v57, a137
    v_accvgpr_read_b32 v58, a138
    v_accvgpr_read_b32 v59, a139
    v_mfma_f32_16x16x32_bf16 v[208:211], a[76:79], a[112:115], v[208:211]
    v_accvgpr_read_b32 v60, a140
    v_cvt_pk_bf16_f32 v104, v104, v105
    v_accvgpr_read_b32 v61, a141
    v_mfma_f32_16x16x32_bf16 v[116:119], a[72:75], a[116:119], v[116:119]
    buffer_load_dwordx4 v40, s[12:15], s61 offen offset:2048 lds
    buffer_load_dwordx4 v41, s[12:15], s61 offen offset:3072 lds
    v_mfma_f32_16x16x32_bf16 v[212:215], a[76:79], a[116:119], v[212:215]
    s_add_u32 s61, s61, 0x80000
    v_accvgpr_read_b32 v62, a142
    v_cvt_pk_bf16_f32 v105, v106, v107
    v_accvgpr_read_b32 v63, a143
    v_mfma_f32_16x16x32_bf16 a[152:155], a[88:91], a[108:111], a[152:155]
    v_cvt_pk_bf16_f32 v106, v200, v201
    v_cvt_pk_bf16_f32 v164, v56, v57
    v_cvt_pk_bf16_f32 v107, v202, v203
    v_mfma_f32_16x16x32_bf16 a[156:159], a[92:95], a[108:111], a[156:159]
    v_cvt_pk_bf16_f32 v165, v58, v59
    v_cvt_pk_bf16_f32 v108, v108, v109
    v_cvt_pk_bf16_f32 v166, v60, v61
    v_mfma_f32_16x16x32_bf16 v[120:123], a[72:75], a[120:123], v[120:123]
    v_cvt_pk_bf16_f32 v109, v110, v111
    v_cvt_pk_bf16_f32 v167, v62, v63
    v_cvt_pk_bf16_f32 v110, v204, v205
    v_mfma_f32_16x16x32_bf16 v[216:219], a[76:79], a[120:123], v[216:219]
    buffer_load_dwordx4 a[224:227], v36, s[8:11], s62 offen offset:0 sc1
    v_cvt_pk_bf16_f32 v111, v206, v207
    v_accvgpr_read_b32 v56, a144
    v_mfma_f32_16x16x32_bf16 v[124:127], a[72:75], a[124:127], v[124:127]
    v_accvgpr_read_b32 v57, a145
    v_accvgpr_read_b32 v58, a146
    v_accvgpr_read_b32 v59, a147
    v_mfma_f32_16x16x32_bf16 v[220:223], a[76:79], a[124:127], v[220:223]
    buffer_load_dwordx4 a[228:231], v36, s[8:11], s62 offen offset:1024 sc1
    v_accvgpr_read_b32 v60, a148
    v_cvt_pk_bf16_f32 v112, v112, v113
    v_mfma_f32_16x16x32_bf16 a[160:163], a[88:91], a[112:115], a[160:163]
    v_accvgpr_read_b32 v61, a149
    v_accvgpr_read_b32 v62, a150
    v_cvt_pk_bf16_f32 v113, v114, v115
    v_mfma_f32_16x16x32_bf16 a[164:167], a[92:95], a[112:115], a[164:167]
    v_accvgpr_read_b32 v63, a151
    v_cvt_pk_bf16_f32 v114, v208, v209
    v_cvt_pk_bf16_f32 v168, v56, v57
    v_mfma_f32_16x16x32_bf16 v[128:131], a[80:83], a[96:99], v[128:131]
    v_cvt_pk_bf16_f32 v115, v210, v211
    v_cvt_pk_bf16_f32 v169, v58, v59
    v_cvt_pk_bf16_f32 v116, v116, v117
    v_mfma_f32_16x16x32_bf16 v[224:227], a[84:87], a[96:99], v[224:227]
    buffer_load_dwordx4 a[232:235], v37, s[8:11], s62 offen offset:0 sc1
    v_cvt_pk_bf16_f32 v170, v60, v61
    v_cvt_pk_bf16_f32 v117, v118, v119
    v_mfma_f32_16x16x32_bf16 v[132:135], a[80:83], a[100:103], v[132:135]
    v_cvt_pk_bf16_f32 v171, v62, v63
    v_cvt_pk_bf16_f32 v118, v212, v213
    v_cvt_pk_bf16_f32 v119, v214, v215
    v_mfma_f32_16x16x32_bf16 v[228:231], a[84:87], a[100:103], v[228:231]
    buffer_load_dwordx4 a[236:239], v37, s[8:11], s62 offen offset:1024 sc1
    v_accvgpr_read_b32 v56, a152
    v_accvgpr_read_b32 v57, a153
    v_mfma_f32_16x16x32_bf16 a[168:171], a[88:91], a[116:119], a[168:171]
    s_add_u32 s62, s62, 0x20000
    v_accvgpr_read_b32 v58, a154
    v_accvgpr_read_b32 v59, a155
    v_accvgpr_read_b32 v60, a156
    v_mfma_f32_16x16x32_bf16 a[172:175], a[92:95], a[116:119], a[172:175]
    s_waitcnt vmcnt(16)
    s_barrier
    v_cvt_pk_bf16_f32 v120, v120, v121
    v_accvgpr_read_b32 v61, a157
    v_accvgpr_read_b32 v62, a158
    v_mfma_f32_16x16x32_bf16 v[136:139], a[80:83], a[104:107], v[136:139]
    v_cvt_pk_bf16_f32 v121, v122, v123
    v_accvgpr_read_b32 v63, a159
    v_cvt_pk_bf16_f32 v122, v216, v217
    v_mfma_f32_16x16x32_bf16 v[232:235], a[84:87], a[104:107], v[232:235]
    v_cvt_pk_bf16_f32 v172, v56, v57
    v_cvt_pk_bf16_f32 v123, v218, v219
    v_cvt_pk_bf16_f32 v173, v58, v59
    v_mfma_f32_16x16x32_bf16 v[140:143], a[80:83], a[108:111], v[140:143]
    v_cvt_pk_bf16_f32 v124, v124, v125
    v_cvt_pk_bf16_f32 v174, v60, v61
    v_cvt_pk_bf16_f32 v125, v126, v127
    v_mfma_f32_16x16x32_bf16 v[236:239], a[84:87], a[108:111], v[236:239]
    v_cvt_pk_bf16_f32 v175, v62, v63
    v_cvt_pk_bf16_f32 v126, v220, v221
    v_cvt_pk_bf16_f32 v127, v222, v223
    v_mfma_f32_16x16x32_bf16 a[176:179], a[88:91], a[120:123], a[176:179]
    ds_read_b64_tr_b16 a[0:1], v42 offset:0
    v_accvgpr_read_b32 v56, a160
    v_accvgpr_read_b32 v57, a161
    v_mfma_f32_16x16x32_bf16 a[180:183], a[92:95], a[120:123], a[180:183]
    ds_read_b64_tr_b16 a[2:3], v42 offset:1024
    v_accvgpr_read_b32 v58, a162
    v_accvgpr_read_b32 v59, a163
    v_mfma_f32_16x16x32_bf16 v[144:147], a[80:83], a[112:115], v[144:147]
    ds_read_b64_tr_b16 a[4:5], v43 offset:0
    v_accvgpr_read_b32 v60, a164
    v_cvt_pk_bf16_f32 v128, v128, v129
    v_mfma_f32_16x16x32_bf16 v[240:243], a[84:87], a[112:115], v[240:243]
    v_accvgpr_read_b32 v61, a165
    v_accvgpr_read_b32 v62, a166
    v_cvt_pk_bf16_f32 v129, v130, v131
    v_mfma_f32_16x16x32_bf16 v[148:151], a[80:83], a[116:119], v[148:151]
    ds_read_b64_tr_b16 a[6:7], v43 offset:1024
    v_accvgpr_read_b32 v63, a167
    v_cvt_pk_bf16_f32 v130, v224, v225
    v_mfma_f32_16x16x32_bf16 v[244:247], a[84:87], a[116:119], v[244:247]
    v_cvt_pk_bf16_f32 v176, v56, v57
    v_cvt_pk_bf16_f32 v131, v226, v227
    v_cvt_pk_bf16_f32 v177, v58, v59
    v_mfma_f32_16x16x32_bf16 a[184:187], a[88:91], a[124:127], a[184:187]
    ds_read_b64_tr_b16 a[8:9], v44 offset:0
    v_cvt_pk_bf16_f32 v132, v132, v133
    v_cvt_pk_bf16_f32 v178, v60, v61
    v_mfma_f32_16x16x32_bf16 a[188:191], a[92:95], a[124:127], a[188:191]
    ds_read_b64_tr_b16 a[10:11], v44 offset:1024
    v_cvt_pk_bf16_f32 v133, v134, v135
    v_cvt_pk_bf16_f32 v179, v62, v63
    v_mfma_f32_16x16x32_bf16 v[152:155], a[80:83], a[120:123], v[152:155]
    ds_read_b64_tr_b16 a[12:13], v45 offset:0
    v_cvt_pk_bf16_f32 v134, v228, v229
    v_cvt_pk_bf16_f32 v135, v230, v231
    v_mfma_f32_16x16x32_bf16 v[248:251], a[84:87], a[120:123], v[248:251]
    ds_read_b64_tr_b16 a[14:15], v45 offset:1024
    v_accvgpr_read_b32 v56, a168
    v_accvgpr_read_b32 v57, a169
    v_mfma_f32_16x16x32_bf16 v[156:159], a[80:83], a[124:127], v[156:159]
    ds_read_b64_tr_b16 a[16:17], v46 offset:0
    v_accvgpr_read_b32 v58, a170
    v_accvgpr_read_b32 v59, a171
    v_mfma_f32_16x16x32_bf16 v[252:255], a[84:87], a[124:127], v[252:255]
    v_accvgpr_read_b32 v60, a172
    v_cvt_pk_bf16_f32 v136, v136, v137
    v_accvgpr_read_b32 v61, a173
    ds_read_b64_tr_b16 a[18:19], v46 offset:1024
    v_accvgpr_read_b32 v62, a174
    v_cvt_pk_bf16_f32 v137, v138, v139
    v_accvgpr_read_b32 v63, a175
    v_cvt_pk_bf16_f32 v138, v232, v233
    v_cvt_pk_bf16_f32 v180, v56, v57
    ds_read_b64_tr_b16 a[20:21], v47 offset:0
    v_cvt_pk_bf16_f32 v139, v234, v235
    v_cvt_pk_bf16_f32 v181, v58, v59
    v_cvt_pk_bf16_f32 v140, v140, v141
    v_cvt_pk_bf16_f32 v182, v60, v61
    ds_read_b64_tr_b16 a[22:23], v47 offset:1024
    v_cvt_pk_bf16_f32 v141, v142, v143
    v_cvt_pk_bf16_f32 v183, v62, v63
    v_cvt_pk_bf16_f32 v142, v236, v237
    ds_read_b64_tr_b16 a[24:25], v48 offset:0
    v_cvt_pk_bf16_f32 v143, v238, v239
    v_accvgpr_read_b32 v56, a176
    ds_read_b64_tr_b16 a[26:27], v48 offset:1024
    v_accvgpr_read_b32 v57, a177
    v_accvgpr_read_b32 v58, a178
    ds_read_b64_tr_b16 a[28:29], v49 offset:0
    v_accvgpr_read_b32 v59, a179
    v_accvgpr_read_b32 v60, a180
    v_cvt_pk_bf16_f32 v144, v144, v145
    ds_read_b64_tr_b16 a[30:31], v49 offset:1024
    v_accvgpr_read_b32 v61, a181
    v_accvgpr_read_b32 v62, a182
    v_cvt_pk_bf16_f32 v145, v146, v147
    v_accvgpr_read_b32 v63, a183
    v_cvt_pk_bf16_f32 v146, v240, v241
    v_cvt_pk_bf16_f32 v184, v56, v57
    v_cvt_pk_bf16_f32 v147, v242, v243
    v_cvt_pk_bf16_f32 v185, v58, v59
    v_cvt_pk_bf16_f32 v148, v148, v149
    v_cvt_pk_bf16_f32 v186, v60, v61
    v_cvt_pk_bf16_f32 v149, v150, v151
    v_cvt_pk_bf16_f32 v187, v62, v63
    v_cvt_pk_bf16_f32 v150, v244, v245
    v_cvt_pk_bf16_f32 v151, v246, v247
    v_accvgpr_read_b32 v56, a184
    v_accvgpr_read_b32 v57, a185
    v_accvgpr_read_b32 v58, a186
    v_accvgpr_read_b32 v59, a187
    v_accvgpr_read_b32 v60, a188
    v_cvt_pk_bf16_f32 v152, v152, v153
    v_accvgpr_read_b32 v61, a189
    v_accvgpr_read_b32 v62, a190
    v_cvt_pk_bf16_f32 v153, v154, v155
    v_accvgpr_read_b32 v63, a191
    v_cvt_pk_bf16_f32 v154, v248, v249
    v_cvt_pk_bf16_f32 v188, v56, v57
    v_cvt_pk_bf16_f32 v155, v250, v251
    v_cvt_pk_bf16_f32 v189, v58, v59
    v_cvt_pk_bf16_f32 v156, v156, v157
    v_cvt_pk_bf16_f32 v190, v60, v61
    v_cvt_pk_bf16_f32 v157, v158, v159
    v_cvt_pk_bf16_f32 v191, v62, v63
    v_cvt_pk_bf16_f32 v158, v252, v253
    v_cvt_pk_bf16_f32 v159, v254, v255
k12_join_7:
k12_qcode:
    s_waitcnt vmcnt(12) lgkmcnt(0)
    v_mfma_f32_16x16x32_bf16 v[192:195], a[0:3], a[192:195], 0
    ds_read_b64_tr_b16 a[32:33], v42 offset:8192
    ds_read_b64_tr_b16 a[34:35], v42 offset:9216
    v_mfma_f32_16x16x32_bf16 v[196:199], a[0:3], a[196:199], 0
    buffer_load_dwordx4 a[240:243], v36, s[8:11], s62 offen offset:0 sc1
    v_mfma_f32_16x16x32_bf16 a[64:67], a[0:3], a[200:203], 0
    ds_read_b64_tr_b16 a[36:37], v43 offset:8192
    v_mfma_f32_16x16x32_bf16 a[68:71], a[0:3], a[204:207], 0
    ds_read_b64_tr_b16 a[38:39], v43 offset:9216
    v_mfma_f32_16x16x32_bf16 v[200:203], a[4:7], a[192:195], 0
    ds_read_b64_tr_b16 a[40:41], v44 offset:8192
    v_mfma_f32_16x16x32_bf16 v[204:207], a[4:7], a[196:199], 0
    v_mfma_f32_16x16x32_bf16 a[72:75], a[4:7], a[200:203], 0
    s_lshl_b32 s31, s28, 14
    buffer_load_dwordx4 a[244:247], v36, s[8:11], s62 offen offset:1024 sc1
    ds_read_b64_tr_b16 a[42:43], v44 offset:9216
    v_mfma_f32_16x16x32_bf16 a[76:79], a[4:7], a[204:207], 0
    s_add_u32 s16, s6, s31
    s_addc_u32 s17, s7, 0
    ds_read_b64_tr_b16 a[44:45], v45 offset:8192
    v_mfma_f32_16x16x32_bf16 v[208:211], a[8:11], a[192:195], 0
    v_mfma_f32_16x16x32_bf16 v[212:215], a[8:11], a[196:199], 0
    s_add_u32 s20, s16, 0x2000000
    s_addc_u32 s21, s17, 0
    ds_read_b64_tr_b16 a[46:47], v45 offset:9216
    v_mfma_f32_16x16x32_bf16 a[80:83], a[8:11], a[200:203], 0
    ds_read_b64_tr_b16 a[48:49], v46 offset:8192
    v_mfma_f32_16x16x32_bf16 a[84:87], a[8:11], a[204:207], 0
    s_add_u32 s16, s16, 0x1000000
    s_addc_u32 s17, s17, 0
    ds_read_b64_tr_b16 a[50:51], v46 offset:9216
    v_mfma_f32_16x16x32_bf16 v[216:219], a[12:15], a[192:195], 0
    buffer_load_dwordx4 a[248:251], v37, s[8:11], s62 offen offset:0 sc1
    v_mfma_f32_16x16x32_bf16 v[220:223], a[12:15], a[196:199], 0
    s_and_b32 s17, s17, 0xffff
    ds_read_b64_tr_b16 a[52:53], v47 offset:8192
    v_mfma_f32_16x16x32_bf16 a[88:91], a[12:15], a[200:203], 0
    ds_read_b64_tr_b16 a[54:55], v47 offset:9216
    v_mfma_f32_16x16x32_bf16 a[92:95], a[12:15], a[204:207], 0
    s_and_b32 s21, s21, 0xffff
    ds_read_b64_tr_b16 a[56:57], v48 offset:8192
    v_mfma_f32_16x16x32_bf16 v[224:227], a[16:19], a[192:195], 0
    v_mfma_f32_16x16x32_bf16 v[228:231], a[16:19], a[196:199], 0
    s_lshl_b32 s31, s29, 20
    buffer_load_dwordx4 a[252:255], v37, s[8:11], s62 offen offset:1024 sc1
    ds_read_b64_tr_b16 a[58:59], v48 offset:9216
    v_mfma_f32_16x16x32_bf16 a[96:99], a[16:19], a[200:203], 0
    ds_read_b64_tr_b16 a[60:61], v49 offset:8192
    v_mfma_f32_16x16x32_bf16 a[100:103], a[16:19], a[204:207], 0
    s_sub_u32 s18, 0xf84000, s31
    v_mfma_f32_16x16x32_bf16 v[232:235], a[20:23], a[192:195], 0
    ds_read_b64_tr_b16 a[62:63], v49 offset:9216
    v_mfma_f32_16x16x32_bf16 v[236:239], a[20:23], a[196:199], 0
    s_mov_b32 s22, s18
    v_mfma_f32_16x16x32_bf16 a[104:107], a[20:23], a[200:203], 0
    s_add_u32 s62, s62, 0x20000
    v_mfma_f32_16x16x32_bf16 a[108:111], a[20:23], a[204:207], 0
    s_add_u32 s52, s47, 0
    v_mfma_f32_16x16x32_bf16 v[240:243], a[24:27], a[192:195], 0
    s_add_u32 s24, s6, 0x4806000
    s_addc_u32 s25, s7, 0
    buffer_store_dwordx4 v[64:67], v1, s[32:35], s52 offen offset:0 sc1
    v_mfma_f32_16x16x32_bf16 v[244:247], a[24:27], a[196:199], 0
    s_and_b32 s25, s25, 0xffff
    v_mfma_f32_16x16x32_bf16 a[112:115], a[24:27], a[200:203], 0
    v_mfma_f32_16x16x32_bf16 a[116:119], a[24:27], a[204:207], 0
    s_mov_b32 s26, 4096
    v_mfma_f32_16x16x32_bf16 v[248:251], a[28:31], a[192:195], 0
    v_mfma_f32_16x16x32_bf16 v[252:255], a[28:31], a[196:199], 0
    v_mfma_f32_16x16x32_bf16 a[120:123], a[28:31], a[200:203], 0
    v_mfma_f32_16x16x32_bf16 a[124:127], a[28:31], a[204:207], 0
    s_waitcnt vmcnt(9) lgkmcnt(0)
    s_barrier
    v_mfma_f32_16x16x32_bf16 v[192:195], a[32:35], a[208:211], v[192:195]
    ds_read_b64_tr_b16 a[0:1], v42 offset:16384
    ds_read_b64_tr_b16 a[2:3], v42 offset:17408
    v_mfma_f32_16x16x32_bf16 v[196:199], a[32:35], a[212:215], v[196:199]
    s_add_u32 m0, s60, 131072
    v_mfma_f32_16x16x32_bf16 a[64:67], a[32:35], a[216:219], a[64:67]
    buffer_load_dwordx4 v38, s[12:15], s61 offen offset:0 lds
    ds_read_b64_tr_b16 a[4:5], v43 offset:16384
    v_mfma_f32_16x16x32_bf16 a[68:71], a[32:35], a[220:223], a[68:71]
    ds_read_b64_tr_b16 a[6:7], v43 offset:17408
    v_mfma_f32_16x16x32_bf16 v[200:203], a[36:39], a[208:211], v[200:203]
    buffer_load_dwordx4 v39, s[12:15], s61 offen offset:1024 lds
    ds_read_b64_tr_b16 a[8:9], v44 offset:16384
    v_mfma_f32_16x16x32_bf16 v[204:207], a[36:39], a[212:215], v[204:207]
    v_mfma_f32_16x16x32_bf16 a[72:75], a[36:39], a[216:219], a[72:75]
    buffer_load_dwordx4 v40, s[12:15], s61 offen offset:2048 lds
    ds_read_b64_tr_b16 a[10:11], v44 offset:17408
    v_mfma_f32_16x16x32_bf16 a[76:79], a[36:39], a[220:223], a[76:79]
    ds_read_b64_tr_b16 a[12:13], v45 offset:16384
    v_mfma_f32_16x16x32_bf16 v[208:211], a[40:43], a[208:211], v[208:211]
    v_mfma_f32_16x16x32_bf16 v[212:215], a[40:43], a[212:215], v[212:215]
    buffer_load_dwordx4 v41, s[12:15], s61 offen offset:3072 lds
    ds_read_b64_tr_b16 a[14:15], v45 offset:17408
    v_mfma_f32_16x16x32_bf16 a[80:83], a[40:43], a[216:219], a[80:83]
    ds_read_b64_tr_b16 a[16:17], v46 offset:16384
    v_mfma_f32_16x16x32_bf16 a[84:87], a[40:43], a[220:223], a[84:87]
    s_add_u32 s61, s61, 0x80000
    ds_read_b64_tr_b16 a[18:19], v46 offset:17408
    v_mfma_f32_16x16x32_bf16 v[216:219], a[44:47], a[208:211], v[216:219]
    buffer_load_dwordx4 a[128:131], v36, s[8:11], s62 offen offset:0 sc1
    v_mfma_f32_16x16x32_bf16 v[220:223], a[44:47], a[212:215], v[220:223]
    ds_read_b64_tr_b16 a[20:21], v47 offset:16384
    v_mfma_f32_16x16x32_bf16 a[88:91], a[44:47], a[216:219], a[88:91]
    buffer_load_dwordx4 a[132:135], v36, s[8:11], s62 offen offset:1024 sc1
    ds_read_b64_tr_b16 a[22:23], v47 offset:17408
    v_mfma_f32_16x16x32_bf16 a[92:95], a[44:47], a[220:223], a[92:95]
    ds_read_b64_tr_b16 a[24:25], v48 offset:16384
    v_mfma_f32_16x16x32_bf16 v[224:227], a[48:51], a[208:211], v[224:227]
    v_mfma_f32_16x16x32_bf16 v[228:231], a[48:51], a[212:215], v[228:231]
    buffer_load_dwordx4 a[136:139], v37, s[8:11], s62 offen offset:0 sc1
    ds_read_b64_tr_b16 a[26:27], v48 offset:17408
    v_mfma_f32_16x16x32_bf16 a[96:99], a[48:51], a[216:219], a[96:99]
    ds_read_b64_tr_b16 a[28:29], v49 offset:16384
    v_mfma_f32_16x16x32_bf16 a[100:103], a[48:51], a[220:223], a[100:103]
    v_mfma_f32_16x16x32_bf16 v[232:235], a[52:55], a[208:211], v[232:235]
    buffer_load_dwordx4 a[140:143], v37, s[8:11], s62 offen offset:1024 sc1
    ds_read_b64_tr_b16 a[30:31], v49 offset:17408
    v_mfma_f32_16x16x32_bf16 v[236:239], a[52:55], a[212:215], v[236:239]
    v_mfma_f32_16x16x32_bf16 a[104:107], a[52:55], a[216:219], a[104:107]
    s_add_u32 s62, s62, 0x20000
    v_mfma_f32_16x16x32_bf16 a[108:111], a[52:55], a[220:223], a[108:111]
    s_add_u32 s52, s47, 0
    v_mfma_f32_16x16x32_bf16 v[240:243], a[56:59], a[208:211], v[240:243]
    buffer_store_dwordx4 v[68:71], v1, s[32:35], s52 offen offset:1024 sc1
    v_mfma_f32_16x16x32_bf16 v[244:247], a[56:59], a[212:215], v[244:247]
    s_add_u32 s52, s47, 0
    v_mfma_f32_16x16x32_bf16 a[112:115], a[56:59], a[216:219], a[112:115]
    buffer_store_dwordx4 v[72:75], v1, s[32:35], s52 offen offset:2048 sc1
    v_mfma_f32_16x16x32_bf16 a[116:119], a[56:59], a[220:223], a[116:119]
    v_mfma_f32_16x16x32_bf16 v[248:251], a[60:63], a[208:211], v[248:251]
    v_mfma_f32_16x16x32_bf16 v[252:255], a[60:63], a[212:215], v[252:255]
    v_mfma_f32_16x16x32_bf16 a[120:123], a[60:63], a[216:219], a[120:123]
    v_mfma_f32_16x16x32_bf16 a[124:127], a[60:63], a[220:223], a[124:127]
    s_waitcnt vmcnt(15) lgkmcnt(0)
    v_mfma_f32_16x16x32_bf16 v[192:195], a[0:3], a[224:227], v[192:195]
    ds_read_b64_tr_b16 a[32:33], v42 offset:24576
    ds_read_b64_tr_b16 a[34:35], v42 offset:25600
    v_mfma_f32_16x16x32_bf16 v[196:199], a[0:3], a[228:231], v[196:199]
    buffer_load_dwordx4 a[144:147], v36, s[8:11], s62 offen offset:0 sc1
    v_mfma_f32_16x16x32_bf16 a[64:67], a[0:3], a[232:235], a[64:67]
    ds_read_b64_tr_b16 a[36:37], v43 offset:24576
    v_mfma_f32_16x16x32_bf16 a[68:71], a[0:3], a[236:239], a[68:71]
    ds_read_b64_tr_b16 a[38:39], v43 offset:25600
    v_mfma_f32_16x16x32_bf16 v[200:203], a[4:7], a[224:227], v[200:203]
    ds_read_b64_tr_b16 a[40:41], v44 offset:24576
    v_mfma_f32_16x16x32_bf16 v[204:207], a[4:7], a[228:231], v[204:207]
    v_mfma_f32_16x16x32_bf16 a[72:75], a[4:7], a[232:235], a[72:75]
    buffer_load_dwordx4 a[148:151], v36, s[8:11], s62 offen offset:1024 sc1
    ds_read_b64_tr_b16 a[42:43], v44 offset:25600
    v_mfma_f32_16x16x32_bf16 a[76:79], a[4:7], a[236:239], a[76:79]
    ds_read_b64_tr_b16 a[44:45], v45 offset:24576
    v_mfma_f32_16x16x32_bf16 v[208:211], a[8:11], a[224:227], v[208:211]
    v_mfma_f32_16x16x32_bf16 v[212:215], a[8:11], a[228:231], v[212:215]
    ds_read_b64_tr_b16 a[46:47], v45 offset:25600
    v_mfma_f32_16x16x32_bf16 a[80:83], a[8:11], a[232:235], a[80:83]
    ds_read_b64_tr_b16 a[48:49], v46 offset:24576
    v_mfma_f32_16x16x32_bf16 a[84:87], a[8:11], a[236:239], a[84:87]
    ds_read_b64_tr_b16 a[50:51], v46 offset:25600
    v_mfma_f32_16x16x32_bf16 v[216:219], a[12:15], a[224:227], v[216:219]
    buffer_load_dwordx4 a[152:155], v37, s[8:11], s62 offen offset:0 sc1
    v_mfma_f32_16x16x32_bf16 v[220:223], a[12:15], a[228:231], v[220:223]
    ds_read_b64_tr_b16 a[52:53], v47 offset:24576
    v_mfma_f32_16x16x32_bf16 a[88:91], a[12:15], a[232:235], a[88:91]
    ds_read_b64_tr_b16 a[54:55], v47 offset:25600
    v_mfma_f32_16x16x32_bf16 a[92:95], a[12:15], a[236:239], a[92:95]
    ds_read_b64_tr_b16 a[56:57], v48 offset:24576
    v_mfma_f32_16x16x32_bf16 v[224:227], a[16:19], a[224:227], v[224:227]
    v_mfma_f32_16x16x32_bf16 v[228:231], a[16:19], a[228:231], v[228:231]
    buffer_load_dwordx4 a[156:159], v37, s[8:11], s62 offen offset:1024 sc1
    ds_read_b64_tr_b16 a[58:59], v48 offset:25600
    v_mfma_f32_16x16x32_bf16 a[96:99], a[16:19], a[232:235], a[96:99]
    ds_read_b64_tr_b16 a[60:61], v49 offset:24576
    v_mfma_f32_16x16x32_bf16 a[100:103], a[16:19], a[236:239], a[100:103]
    v_mfma_f32_16x16x32_bf16 v[232:235], a[20:23], a[224:227], v[232:235]
    ds_read_b64_tr_b16 a[62:63], v49 offset:25600
    v_mfma_f32_16x16x32_bf16 v[236:239], a[20:23], a[228:231], v[236:239]
    v_mfma_f32_16x16x32_bf16 a[104:107], a[20:23], a[232:235], a[104:107]
    s_add_u32 s62, s62, 0x20000
    v_mfma_f32_16x16x32_bf16 a[108:111], a[20:23], a[236:239], a[108:111]
    s_add_u32 s52, s47, 0
    v_mfma_f32_16x16x32_bf16 v[240:243], a[24:27], a[224:227], v[240:243]
    buffer_store_dwordx4 v[76:79], v1, s[32:35], s52 offen offset:3072 sc1
    v_mfma_f32_16x16x32_bf16 v[244:247], a[24:27], a[228:231], v[244:247]
    v_mfma_f32_16x16x32_bf16 a[112:115], a[24:27], a[232:235], a[112:115]
    v_mfma_f32_16x16x32_bf16 a[116:119], a[24:27], a[236:239], a[116:119]
    v_mfma_f32_16x16x32_bf16 v[248:251], a[28:31], a[224:227], v[248:251]
    v_mfma_f32_16x16x32_bf16 v[252:255], a[28:31], a[228:231], v[252:255]
    v_mfma_f32_16x16x32_bf16 a[120:123], a[28:31], a[232:235], a[120:123]
    v_mfma_f32_16x16x32_bf16 a[124:127], a[28:31], a[236:239], a[124:127]
    s_waitcnt vmcnt(11) lgkmcnt(0)
    s_barrier
    v_mfma_f32_16x16x32_bf16 v[192:195], a[32:35], a[240:243], v[192:195]
    ds_read_b64_tr_b16 a[0:1], v42 offset:32768
    ds_read_b64_tr_b16 a[2:3], v42 offset:33792
    v_mfma_f32_16x16x32_bf16 v[196:199], a[32:35], a[244:247], v[196:199]
    s_add_u32 m0, s60, 147456
    v_mfma_f32_16x16x32_bf16 a[64:67], a[32:35], a[248:251], a[64:67]
    buffer_load_dwordx4 v38, s[12:15], s61 offen offset:0 lds
    ds_read_b64_tr_b16 a[4:5], v43 offset:32768
    v_mfma_f32_16x16x32_bf16 a[68:71], a[32:35], a[252:255], a[68:71]
    ds_read_b64_tr_b16 a[6:7], v43 offset:33792
    v_mfma_f32_16x16x32_bf16 v[200:203], a[36:39], a[240:243], v[200:203]
    buffer_load_dwordx4 v39, s[12:15], s61 offen offset:1024 lds
    ds_read_b64_tr_b16 a[8:9], v44 offset:32768
    v_mfma_f32_16x16x32_bf16 v[204:207], a[36:39], a[244:247], v[204:207]
    v_mfma_f32_16x16x32_bf16 a[72:75], a[36:39], a[248:251], a[72:75]
    buffer_load_dwordx4 v40, s[12:15], s61 offen offset:2048 lds
    ds_read_b64_tr_b16 a[10:11], v44 offset:33792
    v_mfma_f32_16x16x32_bf16 a[76:79], a[36:39], a[252:255], a[76:79]
    ds_read_b64_tr_b16 a[12:13], v45 offset:32768
    v_mfma_f32_16x16x32_bf16 v[208:211], a[40:43], a[240:243], v[208:211]
    v_mfma_f32_16x16x32_bf16 v[212:215], a[40:43], a[244:247], v[212:215]
    buffer_load_dwordx4 v41, s[12:15], s61 offen offset:3072 lds
    ds_read_b64_tr_b16 a[14:15], v45 offset:33792
    v_mfma_f32_16x16x32_bf16 a[80:83], a[40:43], a[248:251], a[80:83]
    ds_read_b64_tr_b16 a[16:17], v46 offset:32768
    v_mfma_f32_16x16x32_bf16 a[84:87], a[40:43], a[252:255], a[84:87]
    s_add_u32 s61, s61, 0x80000
    ds_read_b64_tr_b16 a[18:19], v46 offset:33792
    v_mfma_f32_16x16x32_bf16 v[216:219], a[44:47], a[240:243], v[216:219]
    buffer_load_dwordx4 a[160:163], v36, s[8:11], s62 offen offset:0 sc1
    v_mfma_f32_16x16x32_bf16 v[220:223], a[44:47], a[244:247], v[220:223]
    ds_read_b64_tr_b16 a[20:21], v47 offset:32768
    v_mfma_f32_16x16x32_bf16 a[88:91], a[44:47], a[248:251], a[88:91]
    buffer_load_dwordx4 a[164:167], v36, s[8:11], s62 offen offset:1024 sc1
    ds_read_b64_tr_b16 a[22:23], v47 offset:33792
    v_mfma_f32_16x16x32_bf16 a[92:95], a[44:47], a[252:255], a[92:95]
    ds_read_b64_tr_b16 a[24:25], v48 offset:32768
    v_mfma_f32_16x16x32_bf16 v[224:227], a[48:51], a[240:243], v[224:227]
    v_mfma_f32_16x16x32_bf16 v[228:231], a[48:51], a[244:247], v[228:231]
    buffer_load_dwordx4 a[168:171], v37, s[8:11], s62 offen offset:0 sc1
    ds_read_b64_tr_b16 a[26:27], v48 offset:33792
    v_mfma_f32_16x16x32_bf16 a[96:99], a[48:51], a[248:251], a[96:99]
    ds_read_b64_tr_b16 a[28:29], v49 offset:32768
    v_mfma_f32_16x16x32_bf16 a[100:103], a[48:51], a[252:255], a[100:103]
    v_mfma_f32_16x16x32_bf16 v[232:235], a[52:55], a[240:243], v[232:235]
    buffer_load_dwordx4 a[172:175], v37, s[8:11], s62 offen offset:1024 sc1
    ds_read_b64_tr_b16 a[30:31], v49 offset:33792
    v_mfma_f32_16x16x32_bf16 v[236:239], a[52:55], a[244:247], v[236:239]
    v_mfma_f32_16x16x32_bf16 a[104:107], a[52:55], a[248:251], a[104:107]
    s_add_u32 s62, s62, 0x20000
    v_mfma_f32_16x16x32_bf16 a[108:111], a[52:55], a[252:255], a[108:111]
    s_add_u32 s52, s47, 4096
    v_mfma_f32_16x16x32_bf16 v[240:243], a[56:59], a[240:243], v[240:243]
    buffer_store_dwordx4 v[80:83], v1, s[32:35], s52 offen offset:0 sc1
    v_mfma_f32_16x16x32_bf16 v[244:247], a[56:59], a[244:247], v[244:247]
    s_add_u32 s52, s47, 4096
    v_mfma_f32_16x16x32_bf16 a[112:115], a[56:59], a[248:251], a[112:115]
    buffer_store_dwordx4 v[84:87], v1, s[32:35], s52 offen offset:1024 sc1
    v_mfma_f32_16x16x32_bf16 a[116:119], a[56:59], a[252:255], a[116:119]
    v_mfma_f32_16x16x32_bf16 v[248:251], a[60:63], a[240:243], v[248:251]
    v_mfma_f32_16x16x32_bf16 v[252:255], a[60:63], a[244:247], v[252:255]
    v_mfma_f32_16x16x32_bf16 a[120:123], a[60:63], a[248:251], a[120:123]
    v_mfma_f32_16x16x32_bf16 a[124:127], a[60:63], a[252:255], a[124:127]
    s_waitcnt vmcnt(17) lgkmcnt(0)
    v_mfma_f32_16x16x32_bf16 v[192:195], a[0:3], a[128:131], v[192:195]
    ds_read_b64_tr_b16 a[32:33], v42 offset:40960
    ds_read_b64_tr_b16 a[34:35], v42 offset:41984
    v_mfma_f32_16x16x32_bf16 v[196:199], a[0:3], a[132:135], v[196:199]
    buffer_load_dwordx4 a[176:179], v36, s[8:11], s62 offen offset:0 sc1
    v_mfma_f32_16x16x32_bf16 a[64:67], a[0:3], a[136:139], a[64:67]
    ds_read_b64_tr_b16 a[36:37], v43 offset:40960
    v_mfma_f32_16x16x32_bf16 a[68:71], a[0:3], a[140:143], a[68:71]
    ds_read_b64_tr_b16 a[38:39], v43 offset:41984
    v_mfma_f32_16x16x32_bf16 v[200:203], a[4:7], a[128:131], v[200:203]
    ds_read_b64_tr_b16 a[40:41], v44 offset:40960
    v_mfma_f32_16x16x32_bf16 v[204:207], a[4:7], a[132:135], v[204:207]
    buffer_load_dwordx4 a[180:183], v36, s[8:11], s62 offen offset:1024 sc1
    v_mfma_f32_16x16x32_bf16 a[72:75], a[4:7], a[136:139], a[72:75]
    ds_read_b64_tr_b16 a[42:43], v44 offset:41984
    v_mfma_f32_16x16x32_bf16 a[76:79], a[4:7], a[140:143], a[76:79]
    ds_read_b64_tr_b16 a[44:45], v45 offset:40960
    v_mfma_f32_16x16x32_bf16 v[208:211], a[8:11], a[128:131], v[208:211]
    v_mfma_f32_16x16x32_bf16 v[212:215], a[8:11], a[132:135], v[212:215]
    ds_read_b64_tr_b16 a[46:47], v45 offset:41984
    v_mfma_f32_16x16x32_bf16 a[80:83], a[8:11], a[136:139], a[80:83]
    buffer_load_dwordx4 a[184:187], v37, s[8:11], s62 offen offset:0 sc1
    ds_read_b64_tr_b16 a[48:49], v46 offset:40960
    v_mfma_f32_16x16x32_bf16 a[84:87], a[8:11], a[140:143], a[84:87]
    ds_read_b64_tr_b16 a[50:51], v46 offset:41984
    v_mfma_f32_16x16x32_bf16 v[216:219], a[12:15], a[128:131], v[216:219]
    v_mfma_f32_16x16x32_bf16 v[220:223], a[12:15], a[132:135], v[220:223]
    ds_read_b64_tr_b16 a[52:53], v47 offset:40960
    v_mfma_f32_16x16x32_bf16 a[88:91], a[12:15], a[136:139], a[88:91]
    buffer_load_dwordx4 a[188:191], v37, s[8:11], s62 offen offset:1024 sc1
    ds_read_b64_tr_b16 a[54:55], v47 offset:41984
    v_mfma_f32_16x16x32_bf16 a[92:95], a[12:15], a[140:143], a[92:95]
    ds_read_b64_tr_b16 a[56:57], v48 offset:40960
    v_mfma_f32_16x16x32_bf16 v[224:227], a[16:19], a[128:131], v[224:227]
    v_mfma_f32_16x16x32_bf16 v[228:231], a[16:19], a[132:135], v[228:231]
    ds_read_b64_tr_b16 a[58:59], v48 offset:41984
    v_mfma_f32_16x16x32_bf16 a[96:99], a[16:19], a[136:139], a[96:99]
    s_add_u32 s62, s62, 0x20000
    ds_read_b64_tr_b16 a[60:61], v49 offset:40960
    v_mfma_f32_16x16x32_bf16 a[100:103], a[16:19], a[140:143], a[100:103]
    s_add_u32 s52, s47, 4096
    v_mfma_f32_16x16x32_bf16 v[232:235], a[20:23], a[128:131], v[232:235]
    buffer_store_dwordx4 v[88:91], v1, s[32:35], s52 offen offset:2048 sc1
    ds_read_b64_tr_b16 a[62:63], v49 offset:41984
    v_mfma_f32_16x16x32_bf16 v[236:239], a[20:23], a[132:135], v[236:239]
    s_add_u32 s52, s47, 4096
    v_mfma_f32_16x16x32_bf16 a[104:107], a[20:23], a[136:139], a[104:107]
    v_mfma_f32_16x16x32_bf16 a[108:111], a[20:23], a[140:143], a[108:111]
    buffer_store_dwordx4 v[92:95], v1, s[32:35], s52 offen offset:3072 sc1
    v_mfma_f32_16x16x32_bf16 v[240:243], a[24:27], a[128:131], v[240:243]
    v_mfma_f32_16x16x32_bf16 v[244:247], a[24:27], a[132:135], v[244:247]
    v_mfma_f32_16x16x32_bf16 a[112:115], a[24:27], a[136:139], a[112:115]
    v_mfma_f32_16x16x32_bf16 a[116:119], a[24:27], a[140:143], a[116:119]
    v_mfma_f32_16x16x32_bf16 v[248:251], a[28:31], a[128:131], v[248:251]
    v_mfma_f32_16x16x32_bf16 v[252:255], a[28:31], a[132:135], v[252:255]
    v_mfma_f32_16x16x32_bf16 a[120:123], a[28:31], a[136:139], a[120:123]
    v_mfma_f32_16x16x32_bf16 a[124:127], a[28:31], a[140:143], a[124:127]
    s_waitcnt vmcnt(12) lgkmcnt(0)
    s_barrier
    v_mfma_f32_16x16x32_bf16 v[192:195], a[32:35], a[144:147], v[192:195]
    ds_read_b64_tr_b16 a[0:1], v42 offset:49152
    ds_read_b64_tr_b16 a[2:3], v42 offset:50176
    v_mfma_f32_16x16x32_bf16 v[196:199], a[32:35], a[148:151], v[196:199]
    s_add_u32 m0, s60, 98304
    v_mfma_f32_16x16x32_bf16 a[64:67], a[32:35], a[152:155], a[64:67]
    buffer_load_dwordx4 v38, s[12:15], s61 offen offset:0 lds
    ds_read_b64_tr_b16 a[4:5], v43 offset:49152
    v_mfma_f32_16x16x32_bf16 a[68:71], a[32:35], a[156:159], a[68:71]
    ds_read_b64_tr_b16 a[6:7], v43 offset:50176
    v_mfma_f32_16x16x32_bf16 v[200:203], a[36:39], a[144:147], v[200:203]
    buffer_load_dwordx4 v39, s[12:15], s61 offen offset:1024 lds
    ds_read_b64_tr_b16 a[8:9], v44 offset:49152
    v_mfma_f32_16x16x32_bf16 v[204:207], a[36:39], a[148:151], v[204:207]
    v_mfma_f32_16x16x32_bf16 a[72:75], a[36:39], a[152:155], a[72:75]
    ds_read_b64_tr_b16 a[10:11], v44 offset:50176
    v_mfma_f32_16x16x32_bf16 a[76:79], a[36:39], a[156:159], a[76:79]
    buffer_load_dwordx4 v40, s[12:15], s61 offen offset:2048 lds
    ds_read_b64_tr_b16 a[12:13], v45 offset:49152
    v_mfma_f32_16x16x32_bf16 v[208:211], a[40:43], a[144:147], v[208:211]
    v_mfma_f32_16x16x32_bf16 v[212:215], a[40:43], a[148:151], v[212:215]
    ds_read_b64_tr_b16 a[14:15], v45 offset:50176
    v_mfma_f32_16x16x32_bf16 a[80:83], a[40:43], a[152:155], a[80:83]
    buffer_load_dwordx4 v41, s[12:15], s61 offen offset:3072 lds
    ds_read_b64_tr_b16 a[16:17], v46 offset:49152
    v_mfma_f32_16x16x32_bf16 a[84:87], a[40:43], a[156:159], a[84:87]
    ds_read_b64_tr_b16 a[18:19], v46 offset:50176
    v_mfma_f32_16x16x32_bf16 v[216:219], a[44:47], a[144:147], v[216:219]
    s_add_u32 s61, s61, 0x80000
    v_mfma_f32_16x16x32_bf16 v[220:223], a[44:47], a[148:151], v[220:223]
    buffer_load_dwordx4 a[192:195], v36, s[8:11], s62 offen offset:0 sc1
    ds_read_b64_tr_b16 a[20:21], v47 offset:49152
    v_mfma_f32_16x16x32_bf16 a[88:91], a[44:47], a[152:155], a[88:91]
    ds_read_b64_tr_b16 a[22:23], v47 offset:50176
    v_mfma_f32_16x16x32_bf16 a[92:95], a[44:47], a[156:159], a[92:95]
    ds_read_b64_tr_b16 a[24:25], v48 offset:49152
    v_mfma_f32_16x16x32_bf16 v[224:227], a[48:51], a[144:147], v[224:227]
    buffer_load_dwordx4 a[196:199], v36, s[8:11], s62 offen offset:1024 sc1
    v_mfma_f32_16x16x32_bf16 v[228:231], a[48:51], a[148:151], v[228:231]
    ds_read_b64_tr_b16 a[26:27], v48 offset:50176
    v_mfma_f32_16x16x32_bf16 a[96:99], a[48:51], a[152:155], a[96:99]
    ds_read_b64_tr_b16 a[28:29], v49 offset:49152
    v_mfma_f32_16x16x32_bf16 a[100:103], a[48:51], a[156:159], a[100:103]
    buffer_load_dwordx4 a[200:203], v37, s[8:11], s62 offen offset:0 sc1
    v_mfma_f32_16x16x32_bf16 v[232:235], a[52:55], a[144:147], v[232:235]
    ds_read_b64_tr_b16 a[30:31], v49 offset:50176
    v_mfma_f32_16x16x32_bf16 v[236:239], a[52:55], a[148:151], v[236:239]
    v_mfma_f32_16x16x32_bf16 a[104:107], a[52:55], a[152:155], a[104:107]
    buffer_load_dwordx4 a[204:207], v37, s[8:11], s62 offen offset:1024 sc1
    v_mfma_f32_16x16x32_bf16 a[108:111], a[52:55], a[156:159], a[108:111]
    v_mfma_f32_16x16x32_bf16 v[240:243], a[56:59], a[144:147], v[240:243]
    s_add_u32 s62, s62, 0x20000
    v_mfma_f32_16x16x32_bf16 v[244:247], a[56:59], a[148:151], v[244:247]
    s_add_u32 s52, s47, 8192
    v_mfma_f32_16x16x32_bf16 a[112:115], a[56:59], a[152:155], a[112:115]
    buffer_store_dwordx4 v[96:99], v1, s[32:35], s52 offen offset:0 sc1
    v_mfma_f32_16x16x32_bf16 a[116:119], a[56:59], a[156:159], a[116:119]
    v_mfma_f32_16x16x32_bf16 v[248:251], a[60:63], a[144:147], v[248:251]
    v_mfma_f32_16x16x32_bf16 v[252:255], a[60:63], a[148:151], v[252:255]
    v_mfma_f32_16x16x32_bf16 a[120:123], a[60:63], a[152:155], a[120:123]
    v_mfma_f32_16x16x32_bf16 a[124:127], a[60:63], a[156:159], a[124:127]
    s_waitcnt vmcnt(17) lgkmcnt(0)
    v_mfma_f32_16x16x32_bf16 v[192:195], a[0:3], a[160:163], v[192:195]
    ds_read_b64_tr_b16 a[32:33], v42 offset:57344
    ds_read_b64_tr_b16 a[34:35], v42 offset:58368
    v_mfma_f32_16x16x32_bf16 v[196:199], a[0:3], a[164:167], v[196:199]
    buffer_load_dwordx4 a[208:211], v36, s[8:11], s62 offen offset:0 sc1
    v_mfma_f32_16x16x32_bf16 a[64:67], a[0:3], a[168:171], a[64:67]
    ds_read_b64_tr_b16 a[36:37], v43 offset:57344
    v_mfma_f32_16x16x32_bf16 a[68:71], a[0:3], a[172:175], a[68:71]
    ds_read_b64_tr_b16 a[38:39], v43 offset:58368
    v_mfma_f32_16x16x32_bf16 v[200:203], a[4:7], a[160:163], v[200:203]
    ds_read_b64_tr_b16 a[40:41], v44 offset:57344
    v_mfma_f32_16x16x32_bf16 v[204:207], a[4:7], a[164:167], v[204:207]
    buffer_load_dwordx4 a[212:215], v36, s[8:11], s62 offen offset:1024 sc1
    v_mfma_f32_16x16x32_bf16 a[72:75], a[4:7], a[168:171], a[72:75]
    ds_read_b64_tr_b16 a[42:43], v44 offset:58368
    v_mfma_f32_16x16x32_bf16 a[76:79], a[4:7], a[172:175], a[76:79]
    ds_read_b64_tr_b16 a[44:45], v45 offset:57344
    v_mfma_f32_16x16x32_bf16 v[208:211], a[8:11], a[160:163], v[208:211]
    v_mfma_f32_16x16x32_bf16 v[212:215], a[8:11], a[164:167], v[212:215]
    ds_read_b64_tr_b16 a[46:47], v45 offset:58368
    v_mfma_f32_16x16x32_bf16 a[80:83], a[8:11], a[168:171], a[80:83]
    buffer_load_dwordx4 a[216:219], v37, s[8:11], s62 offen offset:0 sc1
    ds_read_b64_tr_b16 a[48:49], v46 offset:57344
    v_mfma_f32_16x16x32_bf16 a[84:87], a[8:11], a[172:175], a[84:87]
    ds_read_b64_tr_b16 a[50:51], v46 offset:58368
    v_mfma_f32_16x16x32_bf16 v[216:219], a[12:15], a[160:163], v[216:219]
    v_mfma_f32_16x16x32_bf16 v[220:223], a[12:15], a[164:167], v[220:223]
    ds_read_b64_tr_b16 a[52:53], v47 offset:57344
    v_mfma_f32_16x16x32_bf16 a[88:91], a[12:15], a[168:171], a[88:91]
    buffer_load_dwordx4 a[220:223], v37, s[8:11], s62 offen offset:1024 sc1
    ds_read_b64_tr_b16 a[54:55], v47 offset:58368
    v_mfma_f32_16x16x32_bf16 a[92:95], a[12:15], a[172:175], a[92:95]
    ds_read_b64_tr_b16 a[56:57], v48 offset:57344
    v_mfma_f32_16x16x32_bf16 v[224:227], a[16:19], a[160:163], v[224:227]
    v_mfma_f32_16x16x32_bf16 v[228:231], a[16:19], a[164:167], v[228:231]
    ds_read_b64_tr_b16 a[58:59], v48 offset:58368
    v_mfma_f32_16x16x32_bf16 a[96:99], a[16:19], a[168:171], a[96:99]
    s_add_u32 s62, s62, 0x20000
    ds_read_b64_tr_b16 a[60:61], v49 offset:57344
    v_mfma_f32_16x16x32_bf16 a[100:103], a[16:19], a[172:175], a[100:103]
    s_add_u32 s52, s47, 8192
    v_mfma_f32_16x16x32_bf16 v[232:235], a[20:23], a[160:163], v[232:235]
    buffer_store_dwordx4 v[100:103], v1, s[32:35], s52 offen offset:1024 sc1
    ds_read_b64_tr_b16 a[62:63], v49 offset:58368
    v_mfma_f32_16x16x32_bf16 v[236:239], a[20:23], a[164:167], v[236:239]
    s_add_u32 s52, s47, 8192
    v_mfma_f32_16x16x32_bf16 a[104:107], a[20:23], a[168:171], a[104:107]
    v_mfma_f32_16x16x32_bf16 a[108:111], a[20:23], a[172:175], a[108:111]
    buffer_store_dwordx4 v[104:107], v1, s[32:35], s52 offen offset:2048 sc1
    v_mfma_f32_16x16x32_bf16 v[240:243], a[24:27], a[160:163], v[240:243]
    v_mfma_f32_16x16x32_bf16 v[244:247], a[24:27], a[164:167], v[244:247]
    v_mfma_f32_16x16x32_bf16 a[112:115], a[24:27], a[168:171], a[112:115]
    v_mfma_f32_16x16x32_bf16 a[116:119], a[24:27], a[172:175], a[116:119]
    v_mfma_f32_16x16x32_bf16 v[248:251], a[28:31], a[160:163], v[248:251]
    v_mfma_f32_16x16x32_bf16 v[252:255], a[28:31], a[164:167], v[252:255]
    v_mfma_f32_16x16x32_bf16 a[120:123], a[28:31], a[168:171], a[120:123]
    v_mfma_f32_16x16x32_bf16 a[124:127], a[28:31], a[172:175], a[124:127]
    s_waitcnt vmcnt(11) lgkmcnt(0)
    s_barrier
    v_mfma_f32_16x16x32_bf16 v[192:195], a[32:35], a[176:179], v[192:195]
    ds_read_b64_tr_b16 a[0:1], v42 offset:0
    ds_read_b64_tr_b16 a[2:3], v42 offset:1024
    v_mfma_f32_16x16x32_bf16 v[196:199], a[32:35], a[180:183], v[196:199]
    s_add_u32 m0, s60, 114688
    v_mfma_f32_16x16x32_bf16 a[64:67], a[32:35], a[184:187], a[64:67]
    buffer_load_dwordx4 v38, s[12:15], s61 offen offset:0 lds
    ds_read_b64_tr_b16 a[4:5], v43 offset:0
    v_mfma_f32_16x16x32_bf16 a[68:71], a[32:35], a[188:191], a[68:71]
    ds_read_b64_tr_b16 a[6:7], v43 offset:1024
    v_mfma_f32_16x16x32_bf16 v[200:203], a[36:39], a[176:179], v[200:203]
    buffer_load_dwordx4 v39, s[12:15], s61 offen offset:1024 lds
    ds_read_b64_tr_b16 a[8:9], v44 offset:0
    v_mfma_f32_16x16x32_bf16 v[204:207], a[36:39], a[180:183], v[204:207]
    v_mfma_f32_16x16x32_bf16 a[72:75], a[36:39], a[184:187], a[72:75]
    ds_read_b64_tr_b16 a[10:11], v44 offset:1024
    v_mfma_f32_16x16x32_bf16 a[76:79], a[36:39], a[188:191], a[76:79]
    buffer_load_dwordx4 v40, s[12:15], s61 offen offset:2048 lds
    ds_read_b64_tr_b16 a[12:13], v45 offset:0
    v_mfma_f32_16x16x32_bf16 v[208:211], a[40:43], a[176:179], v[208:211]
    v_mfma_f32_16x16x32_bf16 v[212:215], a[40:43], a[180:183], v[212:215]
    ds_read_b64_tr_b16 a[14:15], v45 offset:1024
    v_mfma_f32_16x16x32_bf16 a[80:83], a[40:43], a[184:187], a[80:83]
    buffer_load_dwordx4 v41, s[12:15], s61 offen offset:3072 lds
    ds_read_b64_tr_b16 a[16:17], v46 offset:0
    v_mfma_f32_16x16x32_bf16 a[84:87], a[40:43], a[188:191], a[84:87]
    ds_read_b64_tr_b16 a[18:19], v46 offset:1024
    v_mfma_f32_16x16x32_bf16 v[216:219], a[44:47], a[176:179], v[216:219]
    s_add_u32 s61, s61, 0x80000
    v_mfma_f32_16x16x32_bf16 v[220:223], a[44:47], a[180:183], v[220:223]
    buffer_load_dwordx4 a[224:227], v36, s[8:11], s62 offen offset:0 sc1
    ds_read_b64_tr_b16 a[20:21], v47 offset:0
    v_mfma_f32_16x16x32_bf16 a[88:91], a[44:47], a[184:187], a[88:91]
    ds_read_b64_tr_b16 a[22:23], v47 offset:1024
    v_mfma_f32_16x16x32_bf16 a[92:95], a[44:47], a[188:191], a[92:95]
    ds_read_b64_tr_b16 a[24:25], v48 offset:0
    v_mfma_f32_16x16x32_bf16 v[224:227], a[48:51], a[176:179], v[224:227]
    buffer_load_dwordx4 a[228:231], v36, s[8:11], s62 offen offset:1024 sc1
    v_mfma_f32_16x16x32_bf16 v[228:231], a[48:51], a[180:183], v[228:231]
    ds_read_b64_tr_b16 a[26:27], v48 offset:1024
    v_mfma_f32_16x16x32_bf16 a[96:99], a[48:51], a[184:187], a[96:99]
    ds_read_b64_tr_b16 a[28:29], v49 offset:0
    v_mfma_f32_16x16x32_bf16 a[100:103], a[48:51], a[188:191], a[100:103]
    buffer_load_dwordx4 a[232:235], v37, s[8:11], s62 offen offset:0 sc1
    v_mfma_f32_16x16x32_bf16 v[232:235], a[52:55], a[176:179], v[232:235]
    ds_read_b64_tr_b16 a[30:31], v49 offset:1024
    v_mfma_f32_16x16x32_bf16 v[236:239], a[52:55], a[180:183], v[236:239]
    v_mfma_f32_16x16x32_bf16 a[104:107], a[52:55], a[184:187], a[104:107]
    buffer_load_dwordx4 a[236:239], v37, s[8:11], s62 offen offset:1024 sc1
    v_mfma_f32_16x16x32_bf16 a[108:111], a[52:55], a[188:191], a[108:111]
    v_mfma_f32_16x16x32_bf16 v[240:243], a[56:59], a[176:179], v[240:243]
    s_add_u32 s62, s62, 0x20000
    v_mfma_f32_16x16x32_bf16 v[244:247], a[56:59], a[180:183], v[244:247]
    s_add_u32 s52, s47, 8192
    v_mfma_f32_16x16x32_bf16 a[112:115], a[56:59], a[184:187], a[112:115]
    buffer_store_dwordx4 v[108:111], v1, s[32:35], s52 offen offset:3072 sc1
    v_mfma_f32_16x16x32_bf16 a[116:119], a[56:59], a[188:191], a[116:119]
    v_mfma_f32_16x16x32_bf16 v[248:251], a[60:63], a[176:179], v[248:251]
    v_mfma_f32_16x16x32_bf16 v[252:255], a[60:63], a[180:183], v[252:255]
    v_mfma_f32_16x16x32_bf16 a[120:123], a[60:63], a[184:187], a[120:123]
    v_mfma_f32_16x16x32_bf16 a[124:127], a[60:63], a[188:191], a[124:127]
    s_waitcnt vmcnt(16) lgkmcnt(0)
    v_mfma_f32_16x16x32_bf16 v[192:195], a[0:3], a[192:195], v[192:195]
    ds_read_b64_tr_b16 a[32:33], v42 offset:8192
    ds_read_b64_tr_b16 a[34:35], v42 offset:9216
    v_mfma_f32_16x16x32_bf16 v[196:199], a[0:3], a[196:199], v[196:199]
    buffer_load_dwordx4 a[240:243], v36, s[8:11], s62 offen offset:0 sc1
    v_mfma_f32_16x16x32_bf16 a[64:67], a[0:3], a[200:203], a[64:67]
    ds_read_b64_tr_b16 a[36:37], v43 offset:8192
    v_mfma_f32_16x16x32_bf16 a[68:71], a[0:3], a[204:207], a[68:71]
    ds_read_b64_tr_b16 a[38:39], v43 offset:9216
    v_mfma_f32_16x16x32_bf16 v[200:203], a[4:7], a[192:195], v[200:203]
    ds_read_b64_tr_b16 a[40:41], v44 offset:8192
    v_mfma_f32_16x16x32_bf16 v[204:207], a[4:7], a[196:199], v[204:207]
    buffer_load_dwordx4 a[244:247], v36, s[8:11], s62 offen offset:1024 sc1
    v_mfma_f32_16x16x32_bf16 a[72:75], a[4:7], a[200:203], a[72:75]
    ds_read_b64_tr_b16 a[42:43], v44 offset:9216
    v_mfma_f32_16x16x32_bf16 a[76:79], a[4:7], a[204:207], a[76:79]
    ds_read_b64_tr_b16 a[44:45], v45 offset:8192
    v_mfma_f32_16x16x32_bf16 v[208:211], a[8:11], a[192:195], v[208:211]
    v_mfma_f32_16x16x32_bf16 v[212:215], a[8:11], a[196:199], v[212:215]
    ds_read_b64_tr_b16 a[46:47], v45 offset:9216
    v_mfma_f32_16x16x32_bf16 a[80:83], a[8:11], a[200:203], a[80:83]
    buffer_load_dwordx4 a[248:251], v37, s[8:11], s62 offen offset:0 sc1
    ds_read_b64_tr_b16 a[48:49], v46 offset:8192
    v_mfma_f32_16x16x32_bf16 a[84:87], a[8:11], a[204:207], a[84:87]
    ds_read_b64_tr_b16 a[50:51], v46 offset:9216
    v_mfma_f32_16x16x32_bf16 v[216:219], a[12:15], a[192:195], v[216:219]
    v_mfma_f32_16x16x32_bf16 v[220:223], a[12:15], a[196:199], v[220:223]
    ds_read_b64_tr_b16 a[52:53], v47 offset:8192
    v_mfma_f32_16x16x32_bf16 a[88:91], a[12:15], a[200:203], a[88:91]
    buffer_load_dwordx4 a[252:255], v37, s[8:11], s62 offen offset:1024 sc1
    ds_read_b64_tr_b16 a[54:55], v47 offset:9216
    v_mfma_f32_16x16x32_bf16 a[92:95], a[12:15], a[204:207], a[92:95]
    ds_read_b64_tr_b16 a[56:57], v48 offset:8192
    v_mfma_f32_16x16x32_bf16 v[224:227], a[16:19], a[192:195], v[224:227]
    v_mfma_f32_16x16x32_bf16 v[228:231], a[16:19], a[196:199], v[228:231]
    ds_read_b64_tr_b16 a[58:59], v48 offset:9216
    v_mfma_f32_16x16x32_bf16 a[96:99], a[16:19], a[200:203], a[96:99]
    s_add_u32 s62, s62, 0x20000
    ds_read_b64_tr_b16 a[60:61], v49 offset:8192
    v_mfma_f32_16x16x32_bf16 a[100:103], a[16:19], a[204:207], a[100:103]
    s_add_u32 s52, s47, 12288
    v_mfma_f32_16x16x32_bf16 v[232:235], a[20:23], a[192:195], v[232:235]
    buffer_store_dwordx4 v[112:115], v1, s[32:35], s52 offen offset:0 sc1
    ds_read_b64_tr_b16 a[62:63], v49 offset:9216
    v_mfma_f32_16x16x32_bf16 v[236:239], a[20:23], a[196:199], v[236:239]
    s_add_u32 s52, s47, 12288
    v_mfma_f32_16x16x32_bf16 a[104:107], a[20:23], a[200:203], a[104:107]
    v_mfma_f32_16x16x32_bf16 a[108:111], a[20:23], a[204:207], a[108:111]
    buffer_store_dwordx4 v[116:119], v1, s[32:35], s52 offen offset:1024 sc1
    v_mfma_f32_16x16x32_bf16 v[240:243], a[24:27], a[192:195], v[240:243]
    v_mfma_f32_16x16x32_bf16 v[244:247], a[24:27], a[196:199], v[244:247]
    v_mfma_f32_16x16x32_bf16 a[112:115], a[24:27], a[200:203], a[112:115]
    v_mfma_f32_16x16x32_bf16 a[116:119], a[24:27], a[204:207], a[116:119]
    v_mfma_f32_16x16x32_bf16 v[248:251], a[28:31], a[192:195], v[248:251]
    v_mfma_f32_16x16x32_bf16 v[252:255], a[28:31], a[196:199], v[252:255]
    v_mfma_f32_16x16x32_bf16 a[120:123], a[28:31], a[200:203], a[120:123]
    v_mfma_f32_16x16x32_bf16 a[124:127], a[28:31], a[204:207], a[124:127]
    s_waitcnt vmcnt(11) lgkmcnt(0)
    s_barrier
    v_mfma_f32_16x16x32_bf16 v[192:195], a[32:35], a[208:211], v[192:195]
    ds_read_b64_tr_b16 a[0:1], v42 offset:16384
    ds_read_b64_tr_b16 a[2:3], v42 offset:17408
    v_mfma_f32_16x16x32_bf16 v[196:199], a[32:35], a[212:215], v[196:199]
    s_add_u32 m0, s60, 131072
    v_mfma_f32_16x16x32_bf16 a[64:67], a[32:35], a[216:219], a[64:67]
    buffer_load_dwordx4 v38, s[12:15], s61 offen offset:0 lds
    ds_read_b64_tr_b16 a[4:5], v43 offset:16384
    v_mfma_f32_16x16x32_bf16 a[68:71], a[32:35], a[220:223], a[68:71]
    ds_read_b64_tr_b16 a[6:7], v43 offset:17408
    v_mfma_f32_16x16x32_bf16 v[200:203], a[36:39], a[208:211], v[200:203]
    buffer_load_dwordx4 v39, s[12:15], s61 offen offset:1024 lds
    ds_read_b64_tr_b16 a[8:9], v44 offset:16384
    v_mfma_f32_16x16x32_bf16 v[204:207], a[36:39], a[212:215], v[204:207]
    v_mfma_f32_16x16x32_bf16 a[72:75], a[36:39], a[216:219], a[72:75]
    buffer_load_dwordx4 v40, s[12:15], s61 offen offset:2048 lds
    ds_read_b64_tr_b16 a[10:11], v44 offset:17408
    v_mfma_f32_16x16x32_bf16 a[76:79], a[36:39], a[220:223], a[76:79]
    ds_read_b64_tr_b16 a[12:13], v45 offset:16384
    v_mfma_f32_16x16x32_bf16 v[208:211], a[40:43], a[208:211], v[208:211]
    v_mfma_f32_16x16x32_bf16 v[212:215], a[40:43], a[212:215], v[212:215]
    buffer_load_dwordx4 v41, s[12:15], s61 offen offset:3072 lds
    ds_read_b64_tr_b16 a[14:15], v45 offset:17408
    v_mfma_f32_16x16x32_bf16 a[80:83], a[40:43], a[216:219], a[80:83]
    ds_read_b64_tr_b16 a[16:17], v46 offset:16384
    v_mfma_f32_16x16x32_bf16 a[84:87], a[40:43], a[220:223], a[84:87]
    s_add_u32 s61, s61, 0x80000
    ds_read_b64_tr_b16 a[18:19], v46 offset:17408
    v_mfma_f32_16x16x32_bf16 v[216:219], a[44:47], a[208:211], v[216:219]
    buffer_load_dwordx4 a[128:131], v36, s[8:11], s62 offen offset:0 sc1
    v_mfma_f32_16x16x32_bf16 v[220:223], a[44:47], a[212:215], v[220:223]
    ds_read_b64_tr_b16 a[20:21], v47 offset:16384
    v_mfma_f32_16x16x32_bf16 a[88:91], a[44:47], a[216:219], a[88:91]
    buffer_load_dwordx4 a[132:135], v36, s[8:11], s62 offen offset:1024 sc1
    ds_read_b64_tr_b16 a[22:23], v47 offset:17408
    v_mfma_f32_16x16x32_bf16 a[92:95], a[44:47], a[220:223], a[92:95]
    ds_read_b64_tr_b16 a[24:25], v48 offset:16384
    v_mfma_f32_16x16x32_bf16 v[224:227], a[48:51], a[208:211], v[224:227]
    v_mfma_f32_16x16x32_bf16 v[228:231], a[48:51], a[212:215], v[228:231]
    buffer_load_dwordx4 a[136:139], v37, s[8:11], s62 offen offset:0 sc1
    ds_read_b64_tr_b16 a[26:27], v48 offset:17408
    v_mfma_f32_16x16x32_bf16 a[96:99], a[48:51], a[216:219], a[96:99]
    ds_read_b64_tr_b16 a[28:29], v49 offset:16384
    v_mfma_f32_16x16x32_bf16 a[100:103], a[48:51], a[220:223], a[100:103]
    v_mfma_f32_16x16x32_bf16 v[232:235], a[52:55], a[208:211], v[232:235]
    buffer_load_dwordx4 a[140:143], v37, s[8:11], s62 offen offset:1024 sc1
    ds_read_b64_tr_b16 a[30:31], v49 offset:17408
    v_mfma_f32_16x16x32_bf16 v[236:239], a[52:55], a[212:215], v[236:239]
    v_mfma_f32_16x16x32_bf16 a[104:107], a[52:55], a[216:219], a[104:107]
    s_add_u32 s62, s62, 0x20000
    v_mfma_f32_16x16x32_bf16 a[108:111], a[52:55], a[220:223], a[108:111]
    s_add_u32 s52, s47, 12288
    v_mfma_f32_16x16x32_bf16 v[240:243], a[56:59], a[208:211], v[240:243]
    buffer_store_dwordx4 v[120:123], v1, s[32:35], s52 offen offset:2048 sc1
    v_mfma_f32_16x16x32_bf16 v[244:247], a[56:59], a[212:215], v[244:247]
    s_add_u32 s52, s47, 12288
    v_mfma_f32_16x16x32_bf16 a[112:115], a[56:59], a[216:219], a[112:115]
    buffer_store_dwordx4 v[124:127], v1, s[32:35], s52 offen offset:3072 sc1
    v_mfma_f32_16x16x32_bf16 a[116:119], a[56:59], a[220:223], a[116:119]
    v_mfma_f32_16x16x32_bf16 v[248:251], a[60:63], a[208:211], v[248:251]
    v_mfma_f32_16x16x32_bf16 v[252:255], a[60:63], a[212:215], v[252:255]
    v_mfma_f32_16x16x32_bf16 a[120:123], a[60:63], a[216:219], a[120:123]
    v_mfma_f32_16x16x32_bf16 a[124:127], a[60:63], a[220:223], a[124:127]
    s_waitcnt vmcnt(17) lgkmcnt(0)
    v_mfma_f32_16x16x32_bf16 v[192:195], a[0:3], a[224:227], v[192:195]
    ds_read_b64_tr_b16 a[32:33], v42 offset:24576
    ds_read_b64_tr_b16 a[34:35], v42 offset:25600
    v_mfma_f32_16x16x32_bf16 v[196:199], a[0:3], a[228:231], v[196:199]
    buffer_load_dwordx4 a[144:147], v36, s[8:11], s62 offen offset:0 sc1
    v_mfma_f32_16x16x32_bf16 a[64:67], a[0:3], a[232:235], a[64:67]
    ds_read_b64_tr_b16 a[36:37], v43 offset:24576
    v_mfma_f32_16x16x32_bf16 a[68:71], a[0:3], a[236:239], a[68:71]
    ds_read_b64_tr_b16 a[38:39], v43 offset:25600
    v_mfma_f32_16x16x32_bf16 v[200:203], a[4:7], a[224:227], v[200:203]
    ds_read_b64_tr_b16 a[40:41], v44 offset:24576
    v_mfma_f32_16x16x32_bf16 v[204:207], a[4:7], a[228:231], v[204:207]
    v_mfma_f32_16x16x32_bf16 a[72:75], a[4:7], a[232:235], a[72:75]
    buffer_load_dwordx4 a[148:151], v36, s[8:11], s62 offen offset:1024 sc1
    ds_read_b64_tr_b16 a[42:43], v44 offset:25600
    v_mfma_f32_16x16x32_bf16 a[76:79], a[4:7], a[236:239], a[76:79]
    ds_read_b64_tr_b16 a[44:45], v45 offset:24576
    v_mfma_f32_16x16x32_bf16 v[208:211], a[8:11], a[224:227], v[208:211]
    v_mfma_f32_16x16x32_bf16 v[212:215], a[8:11], a[228:231], v[212:215]
    ds_read_b64_tr_b16 a[46:47], v45 offset:25600
    v_mfma_f32_16x16x32_bf16 a[80:83], a[8:11], a[232:235], a[80:83]
    ds_read_b64_tr_b16 a[48:49], v46 offset:24576
    v_mfma_f32_16x16x32_bf16 a[84:87], a[8:11], a[236:239], a[84:87]
    ds_read_b64_tr_b16 a[50:51], v46 offset:25600
    v_mfma_f32_16x16x32_bf16 v[216:219], a[12:15], a[224:227], v[216:219]
    buffer_load_dwordx4 a[152:155], v37, s[8:11], s62 offen offset:0 sc1
    v_mfma_f32_16x16x32_bf16 v[220:223], a[12:15], a[228:231], v[220:223]
    ds_read_b64_tr_b16 a[52:53], v47 offset:24576
    v_mfma_f32_16x16x32_bf16 a[88:91], a[12:15], a[232:235], a[88:91]
    ds_read_b64_tr_b16 a[54:55], v47 offset:25600
    v_mfma_f32_16x16x32_bf16 a[92:95], a[12:15], a[236:239], a[92:95]
    ds_read_b64_tr_b16 a[56:57], v48 offset:24576
    v_mfma_f32_16x16x32_bf16 v[224:227], a[16:19], a[224:227], v[224:227]
    v_mfma_f32_16x16x32_bf16 v[228:231], a[16:19], a[228:231], v[228:231]
    buffer_load_dwordx4 a[156:159], v37, s[8:11], s62 offen offset:1024 sc1
    ds_read_b64_tr_b16 a[58:59], v48 offset:25600
    v_mfma_f32_16x16x32_bf16 a[96:99], a[16:19], a[232:235], a[96:99]
    ds_read_b64_tr_b16 a[60:61], v49 offset:24576
    v_mfma_f32_16x16x32_bf16 a[100:103], a[16:19], a[236:239], a[100:103]
    v_mfma_f32_16x16x32_bf16 v[232:235], a[20:23], a[224:227], v[232:235]
    ds_read_b64_tr_b16 a[62:63], v49 offset:25600
    v_mfma_f32_16x16x32_bf16 v[236:239], a[20:23], a[228:231], v[236:239]
    v_mfma_f32_16x16x32_bf16 a[104:107], a[20:23], a[232:235], a[104:107]
    s_add_u32 s62, s62, 0x20000
    v_mfma_f32_16x16x32_bf16 a[108:111], a[20:23], a[236:239], a[108:111]
    s_add_u32 s52, s47, 524288
    v_mfma_f32_16x16x32_bf16 v[240:243], a[24:27], a[224:227], v[240:243]
    buffer_store_dwordx4 v[128:131], v1, s[32:35], s52 offen offset:0 sc1
    v_mfma_f32_16x16x32_bf16 v[244:247], a[24:27], a[228:231], v[244:247]
    v_mfma_f32_16x16x32_bf16 a[112:115], a[24:27], a[232:235], a[112:115]
    v_mfma_f32_16x16x32_bf16 a[116:119], a[24:27], a[236:239], a[116:119]
    v_mfma_f32_16x16x32_bf16 v[248:251], a[28:31], a[224:227], v[248:251]
    v_mfma_f32_16x16x32_bf16 v[252:255], a[28:31], a[228:231], v[252:255]
    v_mfma_f32_16x16x32_bf16 a[120:123], a[28:31], a[232:235], a[120:123]
    v_mfma_f32_16x16x32_bf16 a[124:127], a[28:31], a[236:239], a[124:127]
    s_waitcnt vmcnt(11) lgkmcnt(0)
    s_barrier
    v_mfma_f32_16x16x32_bf16 v[192:195], a[32:35], a[240:243], v[192:195]
    ds_read_b64_tr_b16 a[0:1], v42 offset:32768
    ds_read_b64_tr_b16 a[2:3], v42 offset:33792
    v_mfma_f32_16x16x32_bf16 v[196:199], a[32:35], a[244:247], v[196:199]
    s_add_u32 m0, s60, 147456
    v_mfma_f32_16x16x32_bf16 a[64:67], a[32:35], a[248:251], a[64:67]
    buffer_load_dwordx4 v38, s[12:15], s61 offen offset:0 lds
    ds_read_b64_tr_b16 a[4:5], v43 offset:32768
    v_mfma_f32_16x16x32_bf16 a[68:71], a[32:35], a[252:255], a[68:71]
    ds_read_b64_tr_b16 a[6:7], v43 offset:33792
    v_mfma_f32_16x16x32_bf16 v[200:203], a[36:39], a[240:243], v[200:203]
    buffer_load_dwordx4 v39, s[12:15], s61 offen offset:1024 lds
    ds_read_b64_tr_b16 a[8:9], v44 offset:32768
    v_mfma_f32_16x16x32_bf16 v[204:207], a[36:39], a[244:247], v[204:207]
    v_mfma_f32_16x16x32_bf16 a[72:75], a[36:39], a[248:251], a[72:75]
    buffer_load_dwordx4 v40, s[12:15], s61 offen offset:2048 lds
    ds_read_b64_tr_b16 a[10:11], v44 offset:33792
    v_mfma_f32_16x16x32_bf16 a[76:79], a[36:39], a[252:255], a[76:79]
    ds_read_b64_tr_b16 a[12:13], v45 offset:32768
    v_mfma_f32_16x16x32_bf16 v[208:211], a[40:43], a[240:243], v[208:211]
    v_mfma_f32_16x16x32_bf16 v[212:215], a[40:43], a[244:247], v[212:215]
    buffer_load_dwordx4 v41, s[12:15], s61 offen offset:3072 lds
    ds_read_b64_tr_b16 a[14:15], v45 offset:33792
    v_mfma_f32_16x16x32_bf16 a[80:83], a[40:43], a[248:251], a[80:83]
    ds_read_b64_tr_b16 a[16:17], v46 offset:32768
    v_mfma_f32_16x16x32_bf16 a[84:87], a[40:43], a[252:255], a[84:87]
    s_add_u32 s61, s61, 0x80000
    ds_read_b64_tr_b16 a[18:19], v46 offset:33792
    v_mfma_f32_16x16x32_bf16 v[216:219], a[44:47], a[240:243], v[216:219]
    buffer_load_dwordx4 a[160:163], v36, s[8:11], s62 offen offset:0 sc1
    v_mfma_f32_16x16x32_bf16 v[220:223], a[44:47], a[244:247], v[220:223]
    ds_read_b64_tr_b16 a[20:21], v47 offset:32768
    v_mfma_f32_16x16x32_bf16 a[88:91], a[44:47], a[248:251], a[88:91]
    buffer_load_dwordx4 a[164:167], v36, s[8:11], s62 offen offset:1024 sc1
    ds_read_b64_tr_b16 a[22:23], v47 offset:33792
    v_mfma_f32_16x16x32_bf16 a[92:95], a[44:47], a[252:255], a[92:95]
    ds_read_b64_tr_b16 a[24:25], v48 offset:32768
    v_mfma_f32_16x16x32_bf16 v[224:227], a[48:51], a[240:243], v[224:227]
    v_mfma_f32_16x16x32_bf16 v[228:231], a[48:51], a[244:247], v[228:231]
    buffer_load_dwordx4 a[168:171], v37, s[8:11], s62 offen offset:0 sc1
    ds_read_b64_tr_b16 a[26:27], v48 offset:33792
    v_mfma_f32_16x16x32_bf16 a[96:99], a[48:51], a[248:251], a[96:99]
    ds_read_b64_tr_b16 a[28:29], v49 offset:32768
    v_mfma_f32_16x16x32_bf16 a[100:103], a[48:51], a[252:255], a[100:103]
    v_mfma_f32_16x16x32_bf16 v[232:235], a[52:55], a[240:243], v[232:235]
    buffer_load_dwordx4 a[172:175], v37, s[8:11], s62 offen offset:1024 sc1
    ds_read_b64_tr_b16 a[30:31], v49 offset:33792
    v_mfma_f32_16x16x32_bf16 v[236:239], a[52:55], a[244:247], v[236:239]
    v_mfma_f32_16x16x32_bf16 a[104:107], a[52:55], a[248:251], a[104:107]
    s_add_u32 s62, s62, 0x20000
    v_mfma_f32_16x16x32_bf16 a[108:111], a[52:55], a[252:255], a[108:111]
    s_add_u32 s52, s47, 524288
    v_mfma_f32_16x16x32_bf16 v[240:243], a[56:59], a[240:243], v[240:243]
    buffer_store_dwordx4 v[132:135], v1, s[32:35], s52 offen offset:1024 sc1
    v_mfma_f32_16x16x32_bf16 v[244:247], a[56:59], a[244:247], v[244:247]
    s_add_u32 s52, s47, 524288
    v_mfma_f32_16x16x32_bf16 a[112:115], a[56:59], a[248:251], a[112:115]
    buffer_store_dwordx4 v[136:139], v1, s[32:35], s52 offen offset:2048 sc1
    v_mfma_f32_16x16x32_bf16 a[116:119], a[56:59], a[252:255], a[116:119]
    v_mfma_f32_16x16x32_bf16 v[248:251], a[60:63], a[240:243], v[248:251]
    v_mfma_f32_16x16x32_bf16 v[252:255], a[60:63], a[244:247], v[252:255]
    v_mfma_f32_16x16x32_bf16 a[120:123], a[60:63], a[248:251], a[120:123]
    v_mfma_f32_16x16x32_bf16 a[124:127], a[60:63], a[252:255], a[124:127]
    s_waitcnt vmcnt(17) lgkmcnt(0)
    v_mfma_f32_16x16x32_bf16 v[192:195], a[0:3], a[128:131], v[192:195]
    ds_read_b64_tr_b16 a[32:33], v42 offset:40960
    ds_read_b64_tr_b16 a[34:35], v42 offset:41984
    v_mfma_f32_16x16x32_bf16 v[196:199], a[0:3], a[132:135], v[196:199]
    buffer_load_dwordx4 a[176:179], v36, s[8:11], s62 offen offset:0 sc1
    v_mfma_f32_16x16x32_bf16 a[64:67], a[0:3], a[136:139], a[64:67]
    ds_read_b64_tr_b16 a[36:37], v43 offset:40960
    v_mfma_f32_16x16x32_bf16 a[68:71], a[0:3], a[140:143], a[68:71]
    ds_read_b64_tr_b16 a[38:39], v43 offset:41984
    v_mfma_f32_16x16x32_bf16 v[200:203], a[4:7], a[128:131], v[200:203]
    ds_read_b64_tr_b16 a[40:41], v44 offset:40960
    v_mfma_f32_16x16x32_bf16 v[204:207], a[4:7], a[132:135], v[204:207]
    v_mfma_f32_16x16x32_bf16 a[72:75], a[4:7], a[136:139], a[72:75]
    buffer_load_dwordx4 a[180:183], v36, s[8:11], s62 offen offset:1024 sc1
    ds_read_b64_tr_b16 a[42:43], v44 offset:41984
    v_mfma_f32_16x16x32_bf16 a[76:79], a[4:7], a[140:143], a[76:79]
    ds_read_b64_tr_b16 a[44:45], v45 offset:40960
    v_mfma_f32_16x16x32_bf16 v[208:211], a[8:11], a[128:131], v[208:211]
    v_mfma_f32_16x16x32_bf16 v[212:215], a[8:11], a[132:135], v[212:215]
    ds_read_b64_tr_b16 a[46:47], v45 offset:41984
    v_mfma_f32_16x16x32_bf16 a[80:83], a[8:11], a[136:139], a[80:83]
    ds_read_b64_tr_b16 a[48:49], v46 offset:40960
    v_mfma_f32_16x16x32_bf16 a[84:87], a[8:11], a[140:143], a[84:87]
    ds_read_b64_tr_b16 a[50:51], v46 offset:41984
    v_mfma_f32_16x16x32_bf16 v[216:219], a[12:15], a[128:131], v[216:219]
    buffer_load_dwordx4 a[184:187], v37, s[8:11], s62 offen offset:0 sc1
    v_mfma_f32_16x16x32_bf16 v[220:223], a[12:15], a[132:135], v[220:223]
    ds_read_b64_tr_b16 a[52:53], v47 offset:40960
    v_mfma_f32_16x16x32_bf16 a[88:91], a[12:15], a[136:139], a[88:91]
    ds_read_b64_tr_b16 a[54:55], v47 offset:41984
    v_mfma_f32_16x16x32_bf16 a[92:95], a[12:15], a[140:143], a[92:95]
    ds_read_b64_tr_b16 a[56:57], v48 offset:40960
    v_mfma_f32_16x16x32_bf16 v[224:227], a[16:19], a[128:131], v[224:227]
    v_mfma_f32_16x16x32_bf16 v[228:231], a[16:19], a[132:135], v[228:231]
    buffer_load_dwordx4 a[188:191], v37, s[8:11], s62 offen offset:1024 sc1
    ds_read_b64_tr_b16 a[58:59], v48 offset:41984
    v_mfma_f32_16x16x32_bf16 a[96:99], a[16:19], a[136:139], a[96:99]
    ds_read_b64_tr_b16 a[60:61], v49 offset:40960
    v_mfma_f32_16x16x32_bf16 a[100:103], a[16:19], a[140:143], a[100:103]
    v_mfma_f32_16x16x32_bf16 v[232:235], a[20:23], a[128:131], v[232:235]
    ds_read_b64_tr_b16 a[62:63], v49 offset:41984
    v_mfma_f32_16x16x32_bf16 v[236:239], a[20:23], a[132:135], v[236:239]
    v_mfma_f32_16x16x32_bf16 a[104:107], a[20:23], a[136:139], a[104:107]
    s_add_u32 s62, s62, 0x20000
    v_mfma_f32_16x16x32_bf16 a[108:111], a[20:23], a[140:143], a[108:111]
    s_add_u32 s52, s47, 524288
    v_mfma_f32_16x16x32_bf16 v[240:243], a[24:27], a[128:131], v[240:243]
    buffer_store_dwordx4 v[140:143], v1, s[32:35], s52 offen offset:3072 sc1
    v_mfma_f32_16x16x32_bf16 v[244:247], a[24:27], a[132:135], v[244:247]
    v_mfma_f32_16x16x32_bf16 a[112:115], a[24:27], a[136:139], a[112:115]
    v_mfma_f32_16x16x32_bf16 a[116:119], a[24:27], a[140:143], a[116:119]
    v_mfma_f32_16x16x32_bf16 v[248:251], a[28:31], a[128:131], v[248:251]
    v_mfma_f32_16x16x32_bf16 v[252:255], a[28:31], a[132:135], v[252:255]
    v_mfma_f32_16x16x32_bf16 a[120:123], a[28:31], a[136:139], a[120:123]
    v_mfma_f32_16x16x32_bf16 a[124:127], a[28:31], a[140:143], a[124:127]
    s_waitcnt vmcnt(11) lgkmcnt(0)
    s_barrier
    v_mfma_f32_16x16x32_bf16 v[192:195], a[32:35], a[144:147], v[192:195]
    ds_read_b64_tr_b16 a[0:1], v42 offset:49152
    ds_read_b64_tr_b16 a[2:3], v42 offset:50176
    v_mfma_f32_16x16x32_bf16 v[196:199], a[32:35], a[148:151], v[196:199]
    s_add_u32 m0, s60, 98304
    v_mfma_f32_16x16x32_bf16 a[64:67], a[32:35], a[152:155], a[64:67]
    buffer_load_dwordx4 v38, s[12:15], s61 offen offset:0 lds
    ds_read_b64_tr_b16 a[4:5], v43 offset:49152
    v_mfma_f32_16x16x32_bf16 a[68:71], a[32:35], a[156:159], a[68:71]
    ds_read_b64_tr_b16 a[6:7], v43 offset:50176
    v_mfma_f32_16x16x32_bf16 v[200:203], a[36:39], a[144:147], v[200:203]
    buffer_load_dwordx4 v39, s[12:15], s61 offen offset:1024 lds
    ds_read_b64_tr_b16 a[8:9], v44 offset:49152
    v_mfma_f32_16x16x32_bf16 v[204:207], a[36:39], a[148:151], v[204:207]
    v_mfma_f32_16x16x32_bf16 a[72:75], a[36:39], a[152:155], a[72:75]
    buffer_load_dwordx4 v40, s[12:15], s61 offen offset:2048 lds
    ds_read_b64_tr_b16 a[10:11], v44 offset:50176
    v_mfma_f32_16x16x32_bf16 a[76:79], a[36:39], a[156:159], a[76:79]
    ds_read_b64_tr_b16 a[12:13], v45 offset:49152
    v_mfma_f32_16x16x32_bf16 v[208:211], a[40:43], a[144:147], v[208:211]
    v_mfma_f32_16x16x32_bf16 v[212:215], a[40:43], a[148:151], v[212:215]
    buffer_load_dwordx4 v41, s[12:15], s61 offen offset:3072 lds
    ds_read_b64_tr_b16 a[14:15], v45 offset:50176
    v_mfma_f32_16x16x32_bf16 a[80:83], a[40:43], a[152:155], a[80:83]
    ds_read_b64_tr_b16 a[16:17], v46 offset:49152
    v_mfma_f32_16x16x32_bf16 a[84:87], a[40:43], a[156:159], a[84:87]
    s_add_u32 s61, s61, 0x80000
    ds_read_b64_tr_b16 a[18:19], v46 offset:50176
    v_mfma_f32_16x16x32_bf16 v[216:219], a[44:47], a[144:147], v[216:219]
    buffer_load_dwordx4 a[192:195], v36, s[8:11], s62 offen offset:0 sc1
    v_mfma_f32_16x16x32_bf16 v[220:223], a[44:47], a[148:151], v[220:223]
    ds_read_b64_tr_b16 a[20:21], v47 offset:49152
    v_mfma_f32_16x16x32_bf16 a[88:91], a[44:47], a[152:155], a[88:91]
    buffer_load_dwordx4 a[196:199], v36, s[8:11], s62 offen offset:1024 sc1
    ds_read_b64_tr_b16 a[22:23], v47 offset:50176
    v_mfma_f32_16x16x32_bf16 a[92:95], a[44:47], a[156:159], a[92:95]
    ds_read_b64_tr_b16 a[24:25], v48 offset:49152
    v_mfma_f32_16x16x32_bf16 v[224:227], a[48:51], a[144:147], v[224:227]
    v_mfma_f32_16x16x32_bf16 v[228:231], a[48:51], a[148:151], v[228:231]
    buffer_load_dwordx4 a[200:203], v37, s[8:11], s62 offen offset:0 sc1
    ds_read_b64_tr_b16 a[26:27], v48 offset:50176
    v_mfma_f32_16x16x32_bf16 a[96:99], a[48:51], a[152:155], a[96:99]
    ds_read_b64_tr_b16 a[28:29], v49 offset:49152
    v_mfma_f32_16x16x32_bf16 a[100:103], a[48:51], a[156:159], a[100:103]
    v_mfma_f32_16x16x32_bf16 v[232:235], a[52:55], a[144:147], v[232:235]
    buffer_load_dwordx4 a[204:207], v37, s[8:11], s62 offen offset:1024 sc1
    ds_read_b64_tr_b16 a[30:31], v49 offset:50176
    v_mfma_f32_16x16x32_bf16 v[236:239], a[52:55], a[148:151], v[236:239]
    v_mfma_f32_16x16x32_bf16 a[104:107], a[52:55], a[152:155], a[104:107]
    s_add_u32 s62, s62, 0x20000
    v_mfma_f32_16x16x32_bf16 a[108:111], a[52:55], a[156:159], a[108:111]
    s_add_u32 s52, s47, 528384
    v_mfma_f32_16x16x32_bf16 v[240:243], a[56:59], a[144:147], v[240:243]
    buffer_store_dwordx4 v[144:147], v1, s[32:35], s52 offen offset:0 sc1
    v_mfma_f32_16x16x32_bf16 v[244:247], a[56:59], a[148:151], v[244:247]
    s_add_u32 s52, s47, 528384
    v_mfma_f32_16x16x32_bf16 a[112:115], a[56:59], a[152:155], a[112:115]
    buffer_store_dwordx4 v[148:151], v1, s[32:35], s52 offen offset:1024 sc1
    v_mfma_f32_16x16x32_bf16 a[116:119], a[56:59], a[156:159], a[116:119]
    v_mfma_f32_16x16x32_bf16 v[248:251], a[60:63], a[144:147], v[248:251]
    v_mfma_f32_16x16x32_bf16 v[252:255], a[60:63], a[148:151], v[252:255]
    v_mfma_f32_16x16x32_bf16 a[120:123], a[60:63], a[152:155], a[120:123]
    v_mfma_f32_16x16x32_bf16 a[124:127], a[60:63], a[156:159], a[124:127]
    s_waitcnt vmcnt(17) lgkmcnt(0)
    v_mfma_f32_16x16x32_bf16 v[192:195], a[0:3], a[160:163], v[192:195]
    ds_read_b64_tr_b16 a[32:33], v42 offset:57344
    ds_read_b64_tr_b16 a[34:35], v42 offset:58368
    v_mfma_f32_16x16x32_bf16 v[196:199], a[0:3], a[164:167], v[196:199]
    buffer_load_dwordx4 a[208:211], v36, s[8:11], s62 offen offset:0 sc1
    v_mfma_f32_16x16x32_bf16 a[64:67], a[0:3], a[168:171], a[64:67]
    ds_read_b64_tr_b16 a[36:37], v43 offset:57344
    v_mfma_f32_16x16x32_bf16 a[68:71], a[0:3], a[172:175], a[68:71]
    ds_read_b64_tr_b16 a[38:39], v43 offset:58368
    v_mfma_f32_16x16x32_bf16 v[200:203], a[4:7], a[160:163], v[200:203]
    ds_read_b64_tr_b16 a[40:41], v44 offset:57344
    v_mfma_f32_16x16x32_bf16 v[204:207], a[4:7], a[164:167], v[204:207]
    buffer_load_dwordx4 a[212:215], v36, s[8:11], s62 offen offset:1024 sc1
    v_mfma_f32_16x16x32_bf16 a[72:75], a[4:7], a[168:171], a[72:75]
    ds_read_b64_tr_b16 a[42:43], v44 offset:58368
    v_mfma_f32_16x16x32_bf16 a[76:79], a[4:7], a[172:175], a[76:79]
    ds_read_b64_tr_b16 a[44:45], v45 offset:57344
    v_mfma_f32_16x16x32_bf16 v[208:211], a[8:11], a[160:163], v[208:211]
    v_mfma_f32_16x16x32_bf16 v[212:215], a[8:11], a[164:167], v[212:215]
    ds_read_b64_tr_b16 a[46:47], v45 offset:58368
    v_mfma_f32_16x16x32_bf16 a[80:83], a[8:11], a[168:171], a[80:83]
    buffer_load_dwordx4 a[216:219], v37, s[8:11], s62 offen offset:0 sc1
    ds_read_b64_tr_b16 a[48:49], v46 offset:57344
    v_mfma_f32_16x16x32_bf16 a[84:87], a[8:11], a[172:175], a[84:87]
    ds_read_b64_tr_b16 a[50:51], v46 offset:58368
    v_mfma_f32_16x16x32_bf16 v[216:219], a[12:15], a[160:163], v[216:219]
    v_mfma_f32_16x16x32_bf16 v[220:223], a[12:15], a[164:167], v[220:223]
    ds_read_b64_tr_b16 a[52:53], v47 offset:57344
    v_mfma_f32_16x16x32_bf16 a[88:91], a[12:15], a[168:171], a[88:91]
    buffer_load_dwordx4 a[220:223], v37, s[8:11], s62 offen offset:1024 sc1
    ds_read_b64_tr_b16 a[54:55], v47 offset:58368
    v_mfma_f32_16x16x32_bf16 a[92:95], a[12:15], a[172:175], a[92:95]
    ds_read_b64_tr_b16 a[56:57], v48 offset:57344
    v_mfma_f32_16x16x32_bf16 v[224:227], a[16:19], a[160:163], v[224:227]
    v_mfma_f32_16x16x32_bf16 v[228:231], a[16:19], a[164:167], v[228:231]
    ds_read_b64_tr_b16 a[58:59], v48 offset:58368
    v_mfma_f32_16x16x32_bf16 a[96:99], a[16:19], a[168:171], a[96:99]
    s_add_u32 s62, s62, 0x20000
    ds_read_b64_tr_b16 a[60:61], v49 offset:57344
    v_mfma_f32_16x16x32_bf16 a[100:103], a[16:19], a[172:175], a[100:103]
    s_add_u32 s52, s47, 528384
    v_mfma_f32_16x16x32_bf16 v[232:235], a[20:23], a[160:163], v[232:235]
    buffer_store_dwordx4 v[152:155], v1, s[32:35], s52 offen offset:2048 sc1
    ds_read_b64_tr_b16 a[62:63], v49 offset:58368
    v_mfma_f32_16x16x32_bf16 v[236:239], a[20:23], a[164:167], v[236:239]
    s_add_u32 s52, s47, 528384
    v_mfma_f32_16x16x32_bf16 a[104:107], a[20:23], a[168:171], a[104:107]
    v_mfma_f32_16x16x32_bf16 a[108:111], a[20:23], a[172:175], a[108:111]
    buffer_store_dwordx4 v[156:159], v1, s[32:35], s52 offen offset:3072 sc1
    v_mfma_f32_16x16x32_bf16 v[240:243], a[24:27], a[160:163], v[240:243]
    v_mfma_f32_16x16x32_bf16 v[244:247], a[24:27], a[164:167], v[244:247]
    v_mfma_f32_16x16x32_bf16 a[112:115], a[24:27], a[168:171], a[112:115]
    v_mfma_f32_16x16x32_bf16 a[116:119], a[24:27], a[172:175], a[116:119]
    v_mfma_f32_16x16x32_bf16 v[248:251], a[28:31], a[160:163], v[248:251]
    v_mfma_f32_16x16x32_bf16 v[252:255], a[28:31], a[164:167], v[252:255]
    v_mfma_f32_16x16x32_bf16 a[120:123], a[28:31], a[168:171], a[120:123]
    v_mfma_f32_16x16x32_bf16 a[124:127], a[28:31], a[172:175], a[124:127]
    s_waitcnt vmcnt(12) lgkmcnt(0)
    s_barrier
    v_mfma_f32_16x16x32_bf16 v[192:195], a[32:35], a[176:179], v[192:195]
    ds_read_b64_tr_b16 a[0:1], v42 offset:0
    ds_read_b64_tr_b16 a[2:3], v42 offset:1024
    v_mfma_f32_16x16x32_bf16 v[196:199], a[32:35], a[180:183], v[196:199]
    s_add_u32 m0, s60, 114688
    v_mfma_f32_16x16x32_bf16 a[64:67], a[32:35], a[184:187], a[64:67]
    buffer_load_dwordx4 v38, s[12:15], s61 offen offset:0 lds
    ds_read_b64_tr_b16 a[4:5], v43 offset:0
    v_mfma_f32_16x16x32_bf16 a[68:71], a[32:35], a[188:191], a[68:71]
    ds_read_b64_tr_b16 a[6:7], v43 offset:1024
    v_mfma_f32_16x16x32_bf16 v[200:203], a[36:39], a[176:179], v[200:203]
    buffer_load_dwordx4 v39, s[12:15], s61 offen offset:1024 lds
    ds_read_b64_tr_b16 a[8:9], v44 offset:0
    v_mfma_f32_16x16x32_bf16 v[204:207], a[36:39], a[180:183], v[204:207]
    v_mfma_f32_16x16x32_bf16 a[72:75], a[36:39], a[184:187], a[72:75]
    ds_read_b64_tr_b16 a[10:11], v44 offset:1024
    v_mfma_f32_16x16x32_bf16 a[76:79], a[36:39], a[188:191], a[76:79]
    buffer_load_dwordx4 v40, s[12:15], s61 offen offset:2048 lds
    ds_read_b64_tr_b16 a[12:13], v45 offset:0
    v_mfma_f32_16x16x32_bf16 v[208:211], a[40:43], a[176:179], v[208:211]
    v_mfma_f32_16x16x32_bf16 v[212:215], a[40:43], a[180:183], v[212:215]
    ds_read_b64_tr_b16 a[14:15], v45 offset:1024
    v_mfma_f32_16x16x32_bf16 a[80:83], a[40:43], a[184:187], a[80:83]
    buffer_load_dwordx4 v41, s[12:15], s61 offen offset:3072 lds
    ds_read_b64_tr_b16 a[16:17], v46 offset:0
    v_mfma_f32_16x16x32_bf16 a[84:87], a[40:43], a[188:191], a[84:87]
    ds_read_b64_tr_b16 a[18:19], v46 offset:1024
    v_mfma_f32_16x16x32_bf16 v[216:219], a[44:47], a[176:179], v[216:219]
    s_add_u32 s61, s61, 0x80000
    v_mfma_f32_16x16x32_bf16 v[220:223], a[44:47], a[180:183], v[220:223]
    buffer_load_dwordx4 a[224:227], v36, s[8:11], s62 offen offset:0 sc1
    ds_read_b64_tr_b16 a[20:21], v47 offset:0
    v_mfma_f32_16x16x32_bf16 a[88:91], a[44:47], a[184:187], a[88:91]
    ds_read_b64_tr_b16 a[22:23], v47 offset:1024
    v_mfma_f32_16x16x32_bf16 a[92:95], a[44:47], a[188:191], a[92:95]
    ds_read_b64_tr_b16 a[24:25], v48 offset:0
    v_mfma_f32_16x16x32_bf16 v[224:227], a[48:51], a[176:179], v[224:227]
    buffer_load_dwordx4 a[228:231], v36, s[8:11], s62 offen offset:1024 sc1
    v_mfma_f32_16x16x32_bf16 v[228:231], a[48:51], a[180:183], v[228:231]
    ds_read_b64_tr_b16 a[26:27], v48 offset:1024
    v_mfma_f32_16x16x32_bf16 a[96:99], a[48:51], a[184:187], a[96:99]
    ds_read_b64_tr_b16 a[28:29], v49 offset:0
    v_mfma_f32_16x16x32_bf16 a[100:103], a[48:51], a[188:191], a[100:103]
    buffer_load_dwordx4 a[232:235], v37, s[8:11], s62 offen offset:0 sc1
    v_mfma_f32_16x16x32_bf16 v[232:235], a[52:55], a[176:179], v[232:235]
    ds_read_b64_tr_b16 a[30:31], v49 offset:1024
    v_mfma_f32_16x16x32_bf16 v[236:239], a[52:55], a[180:183], v[236:239]
    v_mfma_f32_16x16x32_bf16 a[104:107], a[52:55], a[184:187], a[104:107]
    buffer_load_dwordx4 a[236:239], v37, s[8:11], s62 offen offset:1024 sc1
    v_mfma_f32_16x16x32_bf16 a[108:111], a[52:55], a[188:191], a[108:111]
    v_mfma_f32_16x16x32_bf16 v[240:243], a[56:59], a[176:179], v[240:243]
    s_add_u32 s62, s62, 0x20000
    v_mfma_f32_16x16x32_bf16 v[244:247], a[56:59], a[180:183], v[244:247]
    s_add_u32 s52, s47, 532480
    v_mfma_f32_16x16x32_bf16 a[112:115], a[56:59], a[184:187], a[112:115]
    buffer_store_dwordx4 v[160:163], v1, s[32:35], s52 offen offset:0 sc1
    v_mfma_f32_16x16x32_bf16 a[116:119], a[56:59], a[188:191], a[116:119]
    v_mfma_f32_16x16x32_bf16 v[248:251], a[60:63], a[176:179], v[248:251]
    v_mfma_f32_16x16x32_bf16 v[252:255], a[60:63], a[180:183], v[252:255]
    v_mfma_f32_16x16x32_bf16 a[120:123], a[60:63], a[184:187], a[120:123]
    v_mfma_f32_16x16x32_bf16 a[124:127], a[60:63], a[188:191], a[124:127]
    s_waitcnt vmcnt(17) lgkmcnt(0)
    v_mfma_f32_16x16x32_bf16 v[192:195], a[0:3], a[192:195], v[192:195]
    ds_read_b64_tr_b16 a[32:33], v42 offset:8192
    ds_read_b64_tr_b16 a[34:35], v42 offset:9216
    v_mfma_f32_16x16x32_bf16 v[196:199], a[0:3], a[196:199], v[196:199]
    buffer_load_dwordx4 a[240:243], v36, s[8:11], s62 offen offset:0 sc1
    v_mfma_f32_16x16x32_bf16 a[64:67], a[0:3], a[200:203], a[64:67]
    ds_read_b64_tr_b16 a[36:37], v43 offset:8192
    v_mfma_f32_16x16x32_bf16 a[68:71], a[0:3], a[204:207], a[68:71]
    ds_read_b64_tr_b16 a[38:39], v43 offset:9216
    v_mfma_f32_16x16x32_bf16 v[200:203], a[4:7], a[192:195], v[200:203]
    ds_read_b64_tr_b16 a[40:41], v44 offset:8192
    v_mfma_f32_16x16x32_bf16 v[204:207], a[4:7], a[196:199], v[204:207]
    buffer_load_dwordx4 a[244:247], v36, s[8:11], s62 offen offset:1024 sc1
    v_mfma_f32_16x16x32_bf16 a[72:75], a[4:7], a[200:203], a[72:75]
    ds_read_b64_tr_b16 a[42:43], v44 offset:9216
    v_mfma_f32_16x16x32_bf16 a[76:79], a[4:7], a[204:207], a[76:79]
    ds_read_b64_tr_b16 a[44:45], v45 offset:8192
    v_mfma_f32_16x16x32_bf16 v[208:211], a[8:11], a[192:195], v[208:211]
    v_mfma_f32_16x16x32_bf16 v[212:215], a[8:11], a[196:199], v[212:215]
    ds_read_b64_tr_b16 a[46:47], v45 offset:9216
    v_mfma_f32_16x16x32_bf16 a[80:83], a[8:11], a[200:203], a[80:83]
    buffer_load_dwordx4 a[248:251], v37, s[8:11], s62 offen offset:0 sc1
    ds_read_b64_tr_b16 a[48:49], v46 offset:8192
    v_mfma_f32_16x16x32_bf16 a[84:87], a[8:11], a[204:207], a[84:87]
    ds_read_b64_tr_b16 a[50:51], v46 offset:9216
    v_mfma_f32_16x16x32_bf16 v[216:219], a[12:15], a[192:195], v[216:219]
    v_mfma_f32_16x16x32_bf16 v[220:223], a[12:15], a[196:199], v[220:223]
    ds_read_b64_tr_b16 a[52:53], v47 offset:8192
    v_mfma_f32_16x16x32_bf16 a[88:91], a[12:15], a[200:203], a[88:91]
    buffer_load_dwordx4 a[252:255], v37, s[8:11], s62 offen offset:1024 sc1
    ds_read_b64_tr_b16 a[54:55], v47 offset:9216
    v_mfma_f32_16x16x32_bf16 a[92:95], a[12:15], a[204:207], a[92:95]
    ds_read_b64_tr_b16 a[56:57], v48 offset:8192
    v_mfma_f32_16x16x32_bf16 v[224:227], a[16:19], a[192:195], v[224:227]
    v_mfma_f32_16x16x32_bf16 v[228:231], a[16:19], a[196:199], v[228:231]
    ds_read_b64_tr_b16 a[58:59], v48 offset:9216
    v_mfma_f32_16x16x32_bf16 a[96:99], a[16:19], a[200:203], a[96:99]
    s_add_u32 s62, s62, 0x20000
    ds_read_b64_tr_b16 a[60:61], v49 offset:8192
    v_mfma_f32_16x16x32_bf16 a[100:103], a[16:19], a[204:207], a[100:103]
    s_add_u32 s52, s47, 532480
    v_mfma_f32_16x16x32_bf16 v[232:235], a[20:23], a[192:195], v[232:235]
    buffer_store_dwordx4 v[164:167], v1, s[32:35], s52 offen offset:1024 sc1
    ds_read_b64_tr_b16 a[62:63], v49 offset:9216
    v_mfma_f32_16x16x32_bf16 v[236:239], a[20:23], a[196:199], v[236:239]
    s_add_u32 s52, s47, 532480
    v_mfma_f32_16x16x32_bf16 a[104:107], a[20:23], a[200:203], a[104:107]
    v_mfma_f32_16x16x32_bf16 a[108:111], a[20:23], a[204:207], a[108:111]
    buffer_store_dwordx4 v[168:171], v1, s[32:35], s52 offen offset:2048 sc1
    v_mfma_f32_16x16x32_bf16 v[240:243], a[24:27], a[192:195], v[240:243]
    v_mfma_f32_16x16x32_bf16 v[244:247], a[24:27], a[196:199], v[244:247]
    v_mfma_f32_16x16x32_bf16 a[112:115], a[24:27], a[200:203], a[112:115]
    v_mfma_f32_16x16x32_bf16 a[116:119], a[24:27], a[204:207], a[116:119]
    v_mfma_f32_16x16x32_bf16 v[248:251], a[28:31], a[192:195], v[248:251]
    v_mfma_f32_16x16x32_bf16 v[252:255], a[28:31], a[196:199], v[252:255]
    v_mfma_f32_16x16x32_bf16 a[120:123], a[28:31], a[200:203], a[120:123]
    v_mfma_f32_16x16x32_bf16 a[124:127], a[28:31], a[204:207], a[124:127]
    s_waitcnt vmcnt(11) lgkmcnt(0)
    s_barrier
    v_mfma_f32_16x16x32_bf16 v[192:195], a[32:35], a[208:211], v[192:195]
    ds_read_b64_tr_b16 a[0:1], v42 offset:16384
    ds_read_b64_tr_b16 a[2:3], v42 offset:17408
    v_mfma_f32_16x16x32_bf16 v[196:199], a[32:35], a[212:215], v[196:199]
    s_add_u32 m0, s60, 131072
    v_mfma_f32_16x16x32_bf16 a[64:67], a[32:35], a[216:219], a[64:67]
    buffer_load_dwordx4 v38, s[12:15], s61 offen offset:0 lds
    ds_read_b64_tr_b16 a[4:5], v43 offset:16384
    v_mfma_f32_16x16x32_bf16 a[68:71], a[32:35], a[220:223], a[68:71]
    ds_read_b64_tr_b16 a[6:7], v43 offset:17408
    v_mfma_f32_16x16x32_bf16 v[200:203], a[36:39], a[208:211], v[200:203]
    buffer_load_dwordx4 v39, s[12:15], s61 offen offset:1024 lds
    ds_read_b64_tr_b16 a[8:9], v44 offset:16384
    v_mfma_f32_16x16x32_bf16 v[204:207], a[36:39], a[212:215], v[204:207]
    v_mfma_f32_16x16x32_bf16 a[72:75], a[36:39], a[216:219], a[72:75]
    ds_read_b64_tr_b16 a[10:11], v44 offset:17408
    v_mfma_f32_16x16x32_bf16 a[76:79], a[36:39], a[220:223], a[76:79]
    buffer_load_dwordx4 v40, s[12:15], s61 offen offset:2048 lds
    ds_read_b64_tr_b16 a[12:13], v45 offset:16384
    v_mfma_f32_16x16x32_bf16 v[208:211], a[40:43], a[208:211], v[208:211]
    v_mfma_f32_16x16x32_bf16 v[212:215], a[40:43], a[212:215], v[212:215]
    ds_read_b64_tr_b16 a[14:15], v45 offset:17408
    v_mfma_f32_16x16x32_bf16 a[80:83], a[40:43], a[216:219], a[80:83]
    buffer_load_dwordx4 v41, s[12:15], s61 offen offset:3072 lds
    ds_read_b64_tr_b16 a[16:17], v46 offset:16384
    v_mfma_f32_16x16x32_bf16 a[84:87], a[40:43], a[220:223], a[84:87]
    ds_read_b64_tr_b16 a[18:19], v46 offset:17408
    v_mfma_f32_16x16x32_bf16 v[216:219], a[44:47], a[208:211], v[216:219]
    s_add_u32 s61, s61, 0x80000
    v_mfma_f32_16x16x32_bf16 v[220:223], a[44:47], a[212:215], v[220:223]
    buffer_load_dwordx4 a[128:131], v36, s[8:11], s62 offen offset:0 sc1
    ds_read_b64_tr_b16 a[20:21], v47 offset:16384
    v_mfma_f32_16x16x32_bf16 a[88:91], a[44:47], a[216:219], a[88:91]
    ds_read_b64_tr_b16 a[22:23], v47 offset:17408
    v_mfma_f32_16x16x32_bf16 a[92:95], a[44:47], a[220:223], a[92:95]
    ds_read_b64_tr_b16 a[24:25], v48 offset:16384
    v_mfma_f32_16x16x32_bf16 v[224:227], a[48:51], a[208:211], v[224:227]
    buffer_load_dwordx4 a[132:135], v36, s[8:11], s62 offen offset:1024 sc1
    v_mfma_f32_16x16x32_bf16 v[228:231], a[48:51], a[212:215], v[228:231]
    ds_read_b64_tr_b16 a[26:27], v48 offset:17408
    v_mfma_f32_16x16x32_bf16 a[96:99], a[48:51], a[216:219], a[96:99]
    ds_read_b64_tr_b16 a[28:29], v49 offset:16384
    v_mfma_f32_16x16x32_bf16 a[100:103], a[48:51], a[220:223], a[100:103]
    buffer_load_dwordx4 a[136:139], v37, s[8:11], s62 offen offset:0 sc1
    v_mfma_f32_16x16x32_bf16 v[232:235], a[52:55], a[208:211], v[232:235]
    ds_read_b64_tr_b16 a[30:31], v49 offset:17408
    v_mfma_f32_16x16x32_bf16 v[236:239], a[52:55], a[212:215], v[236:239]
    v_mfma_f32_16x16x32_bf16 a[104:107], a[52:55], a[216:219], a[104:107]
    buffer_load_dwordx4 a[140:143], v37, s[8:11], s62 offen offset:1024 sc1
    v_mfma_f32_16x16x32_bf16 a[108:111], a[52:55], a[220:223], a[108:111]
    v_mfma_f32_16x16x32_bf16 v[240:243], a[56:59], a[208:211], v[240:243]
    s_add_u32 s62, s62, 0x20000
    v_mfma_f32_16x16x32_bf16 v[244:247], a[56:59], a[212:215], v[244:247]
    s_add_u32 s52, s47, 532480
    v_mfma_f32_16x16x32_bf16 a[112:115], a[56:59], a[216:219], a[112:115]
    buffer_store_dwordx4 v[172:175], v1, s[32:35], s52 offen offset:3072 sc1
    v_mfma_f32_16x16x32_bf16 a[116:119], a[56:59], a[220:223], a[116:119]
    v_mfma_f32_16x16x32_bf16 v[248:251], a[60:63], a[208:211], v[248:251]
    v_mfma_f32_16x16x32_bf16 v[252:255], a[60:63], a[212:215], v[252:255]
    v_mfma_f32_16x16x32_bf16 a[120:123], a[60:63], a[216:219], a[120:123]
    v_mfma_f32_16x16x32_bf16 a[124:127], a[60:63], a[220:223], a[124:127]
    s_waitcnt vmcnt(16) lgkmcnt(0)
    v_mfma_f32_16x16x32_bf16 v[192:195], a[0:3], a[224:227], v[192:195]
    ds_read_b64_tr_b16 a[32:33], v42 offset:24576
    ds_read_b64_tr_b16 a[34:35], v42 offset:25600
    v_mfma_f32_16x16x32_bf16 v[196:199], a[0:3], a[228:231], v[196:199]
    buffer_load_dwordx4 a[144:147], v36, s[8:11], s62 offen offset:0 sc1
    v_mfma_f32_16x16x32_bf16 a[64:67], a[0:3], a[232:235], a[64:67]
    ds_read_b64_tr_b16 a[36:37], v43 offset:24576
    v_mfma_f32_16x16x32_bf16 a[68:71], a[0:3], a[236:239], a[68:71]
    ds_read_b64_tr_b16 a[38:39], v43 offset:25600
    v_mfma_f32_16x16x32_bf16 v[200:203], a[4:7], a[224:227], v[200:203]
    ds_read_b64_tr_b16 a[40:41], v44 offset:24576
    v_mfma_f32_16x16x32_bf16 v[204:207], a[4:7], a[228:231], v[204:207]
    buffer_load_dwordx4 a[148:151], v36, s[8:11], s62 offen offset:1024 sc1
    v_mfma_f32_16x16x32_bf16 a[72:75], a[4:7], a[232:235], a[72:75]
    ds_read_b64_tr_b16 a[42:43], v44 offset:25600
    v_mfma_f32_16x16x32_bf16 a[76:79], a[4:7], a[236:239], a[76:79]
    ds_read_b64_tr_b16 a[44:45], v45 offset:24576
    v_mfma_f32_16x16x32_bf16 v[208:211], a[8:11], a[224:227], v[208:211]
    v_mfma_f32_16x16x32_bf16 v[212:215], a[8:11], a[228:231], v[212:215]
    ds_read_b64_tr_b16 a[46:47], v45 offset:25600
    v_mfma_f32_16x16x32_bf16 a[80:83], a[8:11], a[232:235], a[80:83]
    buffer_load_dwordx4 a[152:155], v37, s[8:11], s62 offen offset:0 sc1
    ds_read_b64_tr_b16 a[48:49], v46 offset:24576
    v_mfma_f32_16x16x32_bf16 a[84:87], a[8:11], a[236:239], a[84:87]
    ds_read_b64_tr_b16 a[50:51], v46 offset:25600
    v_mfma_f32_16x16x32_bf16 v[216:219], a[12:15], a[224:227], v[216:219]
    v_mfma_f32_16x16x32_bf16 v[220:223], a[12:15], a[228:231], v[220:223]
    ds_read_b64_tr_b16 a[52:53], v47 offset:24576
    v_mfma_f32_16x16x32_bf16 a[88:91], a[12:15], a[232:235], a[88:91]
    buffer_load_dwordx4 a[156:159], v37, s[8:11], s62 offen offset:1024 sc1
    ds_read_b64_tr_b16 a[54:55], v47 offset:25600
    v_mfma_f32_16x16x32_bf16 a[92:95], a[12:15], a[236:239], a[92:95]
    ds_read_b64_tr_b16 a[56:57], v48 offset:24576
    v_mfma_f32_16x16x32_bf16 v[224:227], a[16:19], a[224:227], v[224:227]
    v_mfma_f32_16x16x32_bf16 v[228:231], a[16:19], a[228:231], v[228:231]
    ds_read_b64_tr_b16 a[58:59], v48 offset:25600
    v_mfma_f32_16x16x32_bf16 a[96:99], a[16:19], a[232:235], a[96:99]
    s_add_u32 s62, s62, 0x20000
    ds_read_b64_tr_b16 a[60:61], v49 offset:24576
    v_mfma_f32_16x16x32_bf16 a[100:103], a[16:19], a[236:239], a[100:103]
    s_add_u32 s52, s47, 536576
    v_mfma_f32_16x16x32_bf16 v[232:235], a[20:23], a[224:227], v[232:235]
    buffer_store_dwordx4 v[176:179], v1, s[32:35], s52 offen offset:0 sc1
    ds_read_b64_tr_b16 a[62:63], v49 offset:25600
    v_mfma_f32_16x16x32_bf16 v[236:239], a[20:23], a[228:231], v[236:239]
    s_add_u32 s52, s47, 536576
    v_mfma_f32_16x16x32_bf16 a[104:107], a[20:23], a[232:235], a[104:107]
    v_mfma_f32_16x16x32_bf16 a[108:111], a[20:23], a[236:239], a[108:111]
    buffer_store_dwordx4 v[180:183], v1, s[32:35], s52 offen offset:1024 sc1
    v_mfma_f32_16x16x32_bf16 v[240:243], a[24:27], a[224:227], v[240:243]
    v_mfma_f32_16x16x32_bf16 v[244:247], a[24:27], a[228:231], v[244:247]
    v_mfma_f32_16x16x32_bf16 a[112:115], a[24:27], a[232:235], a[112:115]
    v_mfma_f32_16x16x32_bf16 a[116:119], a[24:27], a[236:239], a[116:119]
    v_mfma_f32_16x16x32_bf16 v[248:251], a[28:31], a[224:227], v[248:251]
    v_mfma_f32_16x16x32_bf16 v[252:255], a[28:31], a[228:231], v[252:255]
    v_mfma_f32_16x16x32_bf16 a[120:123], a[28:31], a[232:235], a[120:123]
    v_mfma_f32_16x16x32_bf16 a[124:127], a[28:31], a[236:239], a[124:127]
    s_waitcnt vmcnt(11) lgkmcnt(0)
    s_barrier
    v_mfma_f32_16x16x32_bf16 v[192:195], a[32:35], a[240:243], v[192:195]
    ds_read_b64_tr_b16 a[0:1], v42 offset:32768
    ds_read_b64_tr_b16 a[2:3], v42 offset:33792
    v_mfma_f32_16x16x32_bf16 v[196:199], a[32:35], a[244:247], v[196:199]
    s_add_u32 m0, s60, 147456
    v_mfma_f32_16x16x32_bf16 a[64:67], a[32:35], a[248:251], a[64:67]
    buffer_load_dwordx4 v38, s[12:15], s61 offen offset:0 lds
    ds_read_b64_tr_b16 a[4:5], v43 offset:32768
    v_mfma_f32_16x16x32_bf16 a[68:71], a[32:35], a[252:255], a[68:71]
    ds_read_b64_tr_b16 a[6:7], v43 offset:33792
    v_mfma_f32_16x16x32_bf16 v[200:203], a[36:39], a[240:243], v[200:203]
    buffer_load_dwordx4 v39, s[12:15], s61 offen offset:1024 lds
    ds_read_b64_tr_b16 a[8:9], v44 offset:32768
    v_mfma_f32_16x16x32_bf16 v[204:207], a[36:39], a[244:247], v[204:207]
    v_mfma_f32_16x16x32_bf16 a[72:75], a[36:39], a[248:251], a[72:75]
    buffer_load_dwordx4 v40, s[12:15], s61 offen offset:2048 lds
    ds_read_b64_tr_b16 a[10:11], v44 offset:33792
    v_mfma_f32_16x16x32_bf16 a[76:79], a[36:39], a[252:255], a[76:79]
    ds_read_b64_tr_b16 a[12:13], v45 offset:32768
    v_mfma_f32_16x16x32_bf16 v[208:211], a[40:43], a[240:243], v[208:211]
    v_mfma_f32_16x16x32_bf16 v[212:215], a[40:43], a[244:247], v[212:215]
    buffer_load_dwordx4 v41, s[12:15], s61 offen offset:3072 lds
    ds_read_b64_tr_b16 a[14:15], v45 offset:33792
    v_mfma_f32_16x16x32_bf16 a[80:83], a[40:43], a[248:251], a[80:83]
    ds_read_b64_tr_b16 a[16:17], v46 offset:32768
    v_mfma_f32_16x16x32_bf16 a[84:87], a[40:43], a[252:255], a[84:87]
    s_add_u32 s61, s61, 0x80000
    ds_read_b64_tr_b16 a[18:19], v46 offset:33792
    v_mfma_f32_16x16x32_bf16 v[216:219], a[44:47], a[240:243], v[216:219]
    buffer_load_dwordx4 a[160:163], v36, s[8:11], s62 offen offset:0 sc1
    v_mfma_f32_16x16x32_bf16 v[220:223], a[44:47], a[244:247], v[220:223]
    ds_read_b64_tr_b16 a[20:21], v47 offset:32768
    v_mfma_f32_16x16x32_bf16 a[88:91], a[44:47], a[248:251], a[88:91]
    buffer_load_dwordx4 a[164:167], v36, s[8:11], s62 offen offset:1024 sc1
    ds_read_b64_tr_b16 a[22:23], v47 offset:33792
    v_mfma_f32_16x16x32_bf16 a[92:95], a[44:47], a[252:255], a[92:95]
    ds_read_b64_tr_b16 a[24:25], v48 offset:32768
    v_mfma_f32_16x16x32_bf16 v[224:227], a[48:51], a[240:243], v[224:227]
    v_mfma_f32_16x16x32_bf16 v[228:231], a[48:51], a[244:247], v[228:231]
    buffer_load_dwordx4 a[168:171], v37, s[8:11], s62 offen offset:0 sc1
    ds_read_b64_tr_b16 a[26:27], v48 offset:33792
    v_mfma_f32_16x16x32_bf16 a[96:99], a[48:51], a[248:251], a[96:99]
    ds_read_b64_tr_b16 a[28:29], v49 offset:32768
    v_mfma_f32_16x16x32_bf16 a[100:103], a[48:51], a[252:255], a[100:103]
    v_mfma_f32_16x16x32_bf16 v[232:235], a[52:55], a[240:243], v[232:235]
    buffer_load_dwordx4 a[172:175], v37, s[8:11], s62 offen offset:1024 sc1
    ds_read_b64_tr_b16 a[30:31], v49 offset:33792
    v_mfma_f32_16x16x32_bf16 v[236:239], a[52:55], a[244:247], v[236:239]
    v_mfma_f32_16x16x32_bf16 a[104:107], a[52:55], a[248:251], a[104:107]
    s_add_u32 s62, s62, 0x20000
    v_mfma_f32_16x16x32_bf16 a[108:111], a[52:55], a[252:255], a[108:111]
    s_add_u32 s52, s47, 536576
    v_mfma_f32_16x16x32_bf16 v[240:243], a[56:59], a[240:243], v[240:243]
    buffer_store_dwordx4 v[184:187], v1, s[32:35], s52 offen offset:2048 sc1
    v_mfma_f32_16x16x32_bf16 v[244:247], a[56:59], a[244:247], v[244:247]
    s_add_u32 s52, s47, 536576
    v_mfma_f32_16x16x32_bf16 a[112:115], a[56:59], a[248:251], a[112:115]
    buffer_store_dwordx4 v[188:191], v1, s[32:35], s52 offen offset:3072 sc1
    v_mfma_f32_16x16x32_bf16 a[116:119], a[56:59], a[252:255], a[116:119]
    v_mfma_f32_16x16x32_bf16 v[248:251], a[60:63], a[240:243], v[248:251]
    v_mfma_f32_16x16x32_bf16 v[252:255], a[60:63], a[244:247], v[252:255]
    v_mfma_f32_16x16x32_bf16 a[120:123], a[60:63], a[248:251], a[120:123]
    v_mfma_f32_16x16x32_bf16 a[124:127], a[60:63], a[252:255], a[124:127]
    s_waitcnt vmcnt(17) lgkmcnt(0)
    v_mfma_f32_16x16x32_bf16 v[192:195], a[0:3], a[128:131], v[192:195]
    ds_read_b64_tr_b16 a[32:33], v42 offset:40960
    ds_read_b64_tr_b16 a[34:35], v42 offset:41984
    v_mfma_f32_16x16x32_bf16 v[196:199], a[0:3], a[132:135], v[196:199]
    buffer_load_dwordx4 a[176:179], v36, s[8:11], s62 offen offset:0 sc1
    v_mfma_f32_16x16x32_bf16 a[64:67], a[0:3], a[136:139], a[64:67]
    ds_read_b64_tr_b16 a[36:37], v43 offset:40960
    v_mfma_f32_16x16x32_bf16 a[68:71], a[0:3], a[140:143], a[68:71]
    ds_read_b64_tr_b16 a[38:39], v43 offset:41984
    v_mfma_f32_16x16x32_bf16 v[200:203], a[4:7], a[128:131], v[200:203]
    ds_read_b64_tr_b16 a[40:41], v44 offset:40960
    v_mfma_f32_16x16x32_bf16 v[204:207], a[4:7], a[132:135], v[204:207]
    v_mfma_f32_16x16x32_bf16 a[72:75], a[4:7], a[136:139], a[72:75]
    ds_read_b64_tr_b16 a[42:43], v44 offset:41984
    v_mfma_f32_16x16x32_bf16 a[76:79], a[4:7], a[140:143], a[76:79]
    ds_read_b64_tr_b16 a[44:45], v45 offset:40960
    v_mfma_f32_16x16x32_bf16 v[208:211], a[8:11], a[128:131], v[208:211]
    buffer_load_dwordx4 a[180:183], v36, s[8:11], s62 offen offset:1024 sc1
    v_mfma_f32_16x16x32_bf16 v[212:215], a[8:11], a[132:135], v[212:215]
    ds_read_b64_tr_b16 a[46:47], v45 offset:41984
    v_mfma_f32_16x16x32_bf16 a[80:83], a[8:11], a[136:139], a[80:83]
    ds_read_b64_tr_b16 a[48:49], v46 offset:40960
    v_mfma_f32_16x16x32_bf16 a[84:87], a[8:11], a[140:143], a[84:87]
    ds_read_b64_tr_b16 a[50:51], v46 offset:41984
    v_mfma_f32_16x16x32_bf16 v[216:219], a[12:15], a[128:131], v[216:219]
    v_mfma_f32_16x16x32_bf16 v[220:223], a[12:15], a[132:135], v[220:223]
    ds_read_b64_tr_b16 a[52:53], v47 offset:40960
    v_mfma_f32_16x16x32_bf16 a[88:91], a[12:15], a[136:139], a[88:91]
    buffer_load_dwordx4 a[184:187], v37, s[8:11], s62 offen offset:0 sc1
    ds_read_b64_tr_b16 a[54:55], v47 offset:41984
    v_mfma_f32_16x16x32_bf16 a[92:95], a[12:15], a[140:143], a[92:95]
    ds_read_b64_tr_b16 a[56:57], v48 offset:40960
    v_mfma_f32_16x16x32_bf16 v[224:227], a[16:19], a[128:131], v[224:227]
    v_mfma_f32_16x16x32_bf16 v[228:231], a[16:19], a[132:135], v[228:231]
    ds_read_b64_tr_b16 a[58:59], v48 offset:41984
    v_mfma_f32_16x16x32_bf16 a[96:99], a[16:19], a[136:139], a[96:99]
    ds_read_b64_tr_b16 a[60:61], v49 offset:40960
    v_mfma_f32_16x16x32_bf16 a[100:103], a[16:19], a[140:143], a[100:103]
    v_mfma_f32_16x16x32_bf16 v[232:235], a[20:23], a[128:131], v[232:235]
    ds_read_b64_tr_b16 a[62:63], v49 offset:41984
    v_mfma_f32_16x16x32_bf16 v[236:239], a[20:23], a[132:135], v[236:239]
    buffer_load_dwordx4 a[188:191], v37, s[8:11], s62 offen offset:1024 sc1
    v_mfma_f32_16x16x32_bf16 a[104:107], a[20:23], a[136:139], a[104:107]
    v_mfma_f32_16x16x32_bf16 a[108:111], a[20:23], a[140:143], a[108:111]
    v_mfma_f32_16x16x32_bf16 v[240:243], a[24:27], a[128:131], v[240:243]
    v_mfma_f32_16x16x32_bf16 v[244:247], a[24:27], a[132:135], v[244:247]
    v_mfma_f32_16x16x32_bf16 a[112:115], a[24:27], a[136:139], a[112:115]
    v_mfma_f32_16x16x32_bf16 a[116:119], a[24:27], a[140:143], a[116:119]
    s_add_u32 s62, s62, 0x20000
    v_mfma_f32_16x16x32_bf16 v[248:251], a[28:31], a[128:131], v[248:251]
    v_mfma_f32_16x16x32_bf16 v[252:255], a[28:31], a[132:135], v[252:255]
    v_mfma_f32_16x16x32_bf16 a[120:123], a[28:31], a[136:139], a[120:123]
    v_mfma_f32_16x16x32_bf16 a[124:127], a[28:31], a[140:143], a[124:127]
    s_waitcnt vmcnt(10) lgkmcnt(0)
    s_barrier
    v_mfma_f32_16x16x32_bf16 v[192:195], a[32:35], a[144:147], v[192:195]
    ds_read_b64_tr_b16 a[0:1], v42 offset:49152
    ds_read_b64_tr_b16 a[2:3], v42 offset:50176
    v_mfma_f32_16x16x32_bf16 v[196:199], a[32:35], a[148:151], v[196:199]
    s_add_u32 m0, s60, 98304
    v_mfma_f32_16x16x32_bf16 a[64:67], a[32:35], a[152:155], a[64:67]
    buffer_load_dwordx4 v38, s[12:15], s61 offen offset:0 lds
    ds_read_b64_tr_b16 a[4:5], v43 offset:49152
    v_mfma_f32_16x16x32_bf16 a[68:71], a[32:35], a[156:159], a[68:71]
    ds_read_b64_tr_b16 a[6:7], v43 offset:50176
    v_mfma_f32_16x16x32_bf16 v[200:203], a[36:39], a[144:147], v[200:203]
    buffer_load_dwordx4 v39, s[12:15], s61 offen offset:1024 lds
    ds_read_b64_tr_b16 a[8:9], v44 offset:49152
    v_mfma_f32_16x16x32_bf16 v[204:207], a[36:39], a[148:151], v[204:207]
    v_mfma_f32_16x16x32_bf16 a[72:75], a[36:39], a[152:155], a[72:75]
    ds_read_b64_tr_b16 a[10:11], v44 offset:50176
    v_mfma_f32_16x16x32_bf16 a[76:79], a[36:39], a[156:159], a[76:79]
    ds_read_b64_tr_b16 a[12:13], v45 offset:49152
    v_mfma_f32_16x16x32_bf16 v[208:211], a[40:43], a[144:147], v[208:211]
    buffer_load_dwordx4 v40, s[12:15], s61 offen offset:2048 lds
    v_mfma_f32_16x16x32_bf16 v[212:215], a[40:43], a[148:151], v[212:215]
    ds_read_b64_tr_b16 a[14:15], v45 offset:50176
    v_mfma_f32_16x16x32_bf16 a[80:83], a[40:43], a[152:155], a[80:83]
    ds_read_b64_tr_b16 a[16:17], v46 offset:49152
    v_mfma_f32_16x16x32_bf16 a[84:87], a[40:43], a[156:159], a[84:87]
    buffer_load_dwordx4 v41, s[12:15], s61 offen offset:3072 lds
    ds_read_b64_tr_b16 a[18:19], v46 offset:50176
    v_mfma_f32_16x16x32_bf16 v[216:219], a[44:47], a[144:147], v[216:219]
    v_mfma_f32_16x16x32_bf16 v[220:223], a[44:47], a[148:151], v[220:223]
    s_add_u32 s61, s61, 0x80000
    ds_read_b64_tr_b16 a[20:21], v47 offset:49152
    v_mfma_f32_16x16x32_bf16 a[88:91], a[44:47], a[152:155], a[88:91]
    buffer_load_dwordx4 a[192:195], v36, s[8:11], s62 offen offset:0 sc1
    ds_read_b64_tr_b16 a[22:23], v47 offset:50176
    v_mfma_f32_16x16x32_bf16 a[92:95], a[44:47], a[156:159], a[92:95]
    ds_read_b64_tr_b16 a[24:25], v48 offset:49152
    v_mfma_f32_16x16x32_bf16 v[224:227], a[48:51], a[144:147], v[224:227]
    v_mfma_f32_16x16x32_bf16 v[228:231], a[48:51], a[148:151], v[228:231]
    ds_read_b64_tr_b16 a[26:27], v48 offset:50176
    v_mfma_f32_16x16x32_bf16 a[96:99], a[48:51], a[152:155], a[96:99]
    buffer_load_dwordx4 a[196:199], v36, s[8:11], s62 offen offset:1024 sc1
    ds_read_b64_tr_b16 a[28:29], v49 offset:49152
    v_mfma_f32_16x16x32_bf16 a[100:103], a[48:51], a[156:159], a[100:103]
    v_mfma_f32_16x16x32_bf16 v[232:235], a[52:55], a[144:147], v[232:235]
    ds_read_b64_tr_b16 a[30:31], v49 offset:50176
    v_mfma_f32_16x16x32_bf16 v[236:239], a[52:55], a[148:151], v[236:239]
    buffer_load_dwordx4 a[200:203], v37, s[8:11], s62 offen offset:0 sc1
    v_mfma_f32_16x16x32_bf16 a[104:107], a[52:55], a[152:155], a[104:107]
    v_mfma_f32_16x16x32_bf16 a[108:111], a[52:55], a[156:159], a[108:111]
    v_mfma_f32_16x16x32_bf16 v[240:243], a[56:59], a[144:147], v[240:243]
    v_mfma_f32_16x16x32_bf16 v[244:247], a[56:59], a[148:151], v[244:247]
    buffer_load_dwordx4 a[204:207], v37, s[8:11], s62 offen offset:1024 sc1
    v_mfma_f32_16x16x32_bf16 a[112:115], a[56:59], a[152:155], a[112:115]
    v_mfma_f32_16x16x32_bf16 a[116:119], a[56:59], a[156:159], a[116:119]
    s_add_u32 s62, s62, 0x20000
    v_mfma_f32_16x16x32_bf16 v[248:251], a[60:63], a[144:147], v[248:251]
    v_mfma_f32_16x16x32_bf16 v[252:255], a[60:63], a[148:151], v[252:255]
    v_mfma_f32_16x16x32_bf16 a[120:123], a[60:63], a[152:155], a[120:123]
    v_mfma_f32_16x16x32_bf16 a[124:127], a[60:63], a[156:159], a[124:127]
    s_waitcnt vmcnt(14) lgkmcnt(0)
    v_mfma_f32_16x16x32_bf16 v[192:195], a[0:3], a[160:163], v[192:195]
    ds_read_b64_tr_b16 a[32:33], v42 offset:57344
    ds_read_b64_tr_b16 a[34:35], v42 offset:58368
    v_mfma_f32_16x16x32_bf16 v[196:199], a[0:3], a[164:167], v[196:199]
    buffer_load_dwordx4 a[208:211], v36, s[8:11], s62 offen offset:0 sc1
    v_mfma_f32_16x16x32_bf16 a[64:67], a[0:3], a[168:171], a[64:67]
    ds_read_b64_tr_b16 a[36:37], v43 offset:57344
    v_mfma_f32_16x16x32_bf16 a[68:71], a[0:3], a[172:175], a[68:71]
    ds_read_b64_tr_b16 a[38:39], v43 offset:58368
    v_mfma_f32_16x16x32_bf16 v[200:203], a[4:7], a[160:163], v[200:203]
    ds_read_b64_tr_b16 a[40:41], v44 offset:57344
    v_mfma_f32_16x16x32_bf16 v[204:207], a[4:7], a[164:167], v[204:207]
    v_mfma_f32_16x16x32_bf16 a[72:75], a[4:7], a[168:171], a[72:75]
    ds_read_b64_tr_b16 a[42:43], v44 offset:58368
    v_mfma_f32_16x16x32_bf16 a[76:79], a[4:7], a[172:175], a[76:79]
    ds_read_b64_tr_b16 a[44:45], v45 offset:57344
    v_mfma_f32_16x16x32_bf16 v[208:211], a[8:11], a[160:163], v[208:211]
    buffer_load_dwordx4 a[212:215], v36, s[8:11], s62 offen offset:1024 sc1
    v_mfma_f32_16x16x32_bf16 v[212:215], a[8:11], a[164:167], v[212:215]
    ds_read_b64_tr_b16 a[46:47], v45 offset:58368
    v_mfma_f32_16x16x32_bf16 a[80:83], a[8:11], a[168:171], a[80:83]
    ds_read_b64_tr_b16 a[48:49], v46 offset:57344
    v_mfma_f32_16x16x32_bf16 a[84:87], a[8:11], a[172:175], a[84:87]
    ds_read_b64_tr_b16 a[50:51], v46 offset:58368
    v_mfma_f32_16x16x32_bf16 v[216:219], a[12:15], a[160:163], v[216:219]
    v_mfma_f32_16x16x32_bf16 v[220:223], a[12:15], a[164:167], v[220:223]
    ds_read_b64_tr_b16 a[52:53], v47 offset:57344
    v_mfma_f32_16x16x32_bf16 a[88:91], a[12:15], a[168:171], a[88:91]
    buffer_load_dwordx4 a[216:219], v37, s[8:11], s62 offen offset:0 sc1
    ds_read_b64_tr_b16 a[54:55], v47 offset:58368
    v_mfma_f32_16x16x32_bf16 a[92:95], a[12:15], a[172:175], a[92:95]
    ds_read_b64_tr_b16 a[56:57], v48 offset:57344
    v_mfma_f32_16x16x32_bf16 v[224:227], a[16:19], a[160:163], v[224:227]
    v_mfma_f32_16x16x32_bf16 v[228:231], a[16:19], a[164:167], v[228:231]
    ds_read_b64_tr_b16 a[58:59], v48 offset:58368
    v_mfma_f32_16x16x32_bf16 a[96:99], a[16:19], a[168:171], a[96:99]
    ds_read_b64_tr_b16 a[60:61], v49 offset:57344
    v_mfma_f32_16x16x32_bf16 a[100:103], a[16:19], a[172:175], a[100:103]
    v_mfma_f32_16x16x32_bf16 v[232:235], a[20:23], a[160:163], v[232:235]
    ds_read_b64_tr_b16 a[62:63], v49 offset:58368
    v_mfma_f32_16x16x32_bf16 v[236:239], a[20:23], a[164:167], v[236:239]
    buffer_load_dwordx4 a[220:223], v37, s[8:11], s62 offen offset:1024 sc1
    v_mfma_f32_16x16x32_bf16 a[104:107], a[20:23], a[168:171], a[104:107]
    v_mfma_f32_16x16x32_bf16 a[108:111], a[20:23], a[172:175], a[108:111]
    v_mfma_f32_16x16x32_bf16 v[240:243], a[24:27], a[160:163], v[240:243]
    v_mfma_f32_16x16x32_bf16 v[244:247], a[24:27], a[164:167], v[244:247]
    v_mfma_f32_16x16x32_bf16 a[112:115], a[24:27], a[168:171], a[112:115]
    v_mfma_f32_16x16x32_bf16 a[116:119], a[24:27], a[172:175], a[116:119]
    s_add_u32 s62, s62, 0x20000
    v_mfma_f32_16x16x32_bf16 v[248:251], a[28:31], a[160:163], v[248:251]
    v_mfma_f32_16x16x32_bf16 v[252:255], a[28:31], a[164:167], v[252:255]
    v_mfma_f32_16x16x32_bf16 a[120:123], a[28:31], a[168:171], a[120:123]
    v_mfma_f32_16x16x32_bf16 a[124:127], a[28:31], a[172:175], a[124:127]
    s_waitcnt vmcnt(8) lgkmcnt(0)
    s_barrier
    v_mfma_f32_16x16x32_bf16 v[192:195], a[32:35], a[176:179], v[192:195]
    ds_read_b64_tr_b16 a[0:1], v42 offset:0
    ds_read_b64_tr_b16 a[2:3], v42 offset:1024
    v_mfma_f32_16x16x32_bf16 v[196:199], a[32:35], a[180:183], v[196:199]
    s_cmp_eq_u32 s30, 0
    s_cbranch_scc1 k12_ool_40
k12_oolret_41:
    v_mfma_f32_16x16x32_bf16 a[64:67], a[32:35], a[184:187], a[64:67]
    s_add_u32 m0, s60, 114688
    ds_read_b64_tr_b16 a[4:5], v43 offset:0
    v_mfma_f32_16x16x32_bf16 a[68:71], a[32:35], a[188:191], a[68:71]
    buffer_load_dwordx4 v38, s[12:15], s61 offen offset:0 lds
    ds_read_b64_tr_b16 a[6:7], v43 offset:1024
    v_mfma_f32_16x16x32_bf16 v[200:203], a[36:39], a[176:179], v[200:203]
    buffer_load_dwordx4 v39, s[12:15], s61 offen offset:1024 lds
    ds_read_b64_tr_b16 a[8:9], v44 offset:0
    v_mfma_f32_16x16x32_bf16 v[204:207], a[36:39], a[180:183], v[204:207]
    v_mfma_f32_16x16x32_bf16 a[72:75], a[36:39], a[184:187], a[72:75]
    ds_read_b64_tr_b16 a[10:11], v44 offset:1024
    v_mfma_f32_16x16x32_bf16 a[76:79], a[36:39], a[188:191], a[76:79]
    ds_read_b64_tr_b16 a[12:13], v45 offset:0
    v_mfma_f32_16x16x32_bf16 v[208:211], a[40:43], a[176:179], v[208:211]
    s_mov_b32 s32, s60
    buffer_load_dwordx4 v40, s[12:15], s61 offen offset:2048 lds
    v_mfma_f32_16x16x32_bf16 v[212:215], a[40:43], a[180:183], v[212:215]
    ds_read_b64_tr_b16 a[14:15], v45 offset:1024
    v_mfma_f32_16x16x32_bf16 a[80:83], a[40:43], a[184:187], a[80:83]
    s_mov_b32 s34, s60
    ds_read_b64_tr_b16 a[16:17], v46 offset:0
    v_mfma_f32_16x16x32_bf16 a[84:87], a[40:43], a[188:191], a[84:87]
    buffer_load_dwordx4 v41, s[12:15], s61 offen offset:3072 lds
    ds_read_b64_tr_b16 a[18:19], v46 offset:1024
    v_mfma_f32_16x16x32_bf16 v[216:219], a[44:47], a[176:179], v[216:219]
    v_mfma_f32_16x16x32_bf16 v[220:223], a[44:47], a[180:183], v[220:223]
    s_mov_b32 s33, s60
    ds_read_b64_tr_b16 a[20:21], v47 offset:0
    v_mfma_f32_16x16x32_bf16 a[88:91], a[44:47], a[184:187], a[88:91]
    s_add_u32 s61, s61, 0x80000
    buffer_load_dwordx4 a[224:227], v36, s[8:11], s62 offen offset:0 sc1
    ds_read_b64_tr_b16 a[22:23], v47 offset:1024
    v_mfma_f32_16x16x32_bf16 a[92:95], a[44:47], a[188:191], a[92:95]
    ds_read_b64_tr_b16 a[24:25], v48 offset:0
    v_mfma_f32_16x16x32_bf16 v[224:227], a[48:51], a[176:179], v[224:227]
    s_add_u32 s35, s60, 0x10000
    v_mfma_f32_16x16x32_bf16 v[228:231], a[48:51], a[180:183], v[228:231]
    ds_read_b64_tr_b16 a[26:27], v48 offset:1024
    v_mfma_f32_16x16x32_bf16 a[96:99], a[48:51], a[184:187], a[96:99]
    buffer_load_dwordx4 a[228:231], v36, s[8:11], s62 offen offset:1024 sc1
    ds_read_b64_tr_b16 a[28:29], v49 offset:0
    v_mfma_f32_16x16x32_bf16 a[100:103], a[48:51], a[188:191], a[100:103]
    v_mfma_f32_16x16x32_bf16 v[232:235], a[52:55], a[176:179], v[232:235]
    ds_read_b64_tr_b16 a[30:31], v49 offset:1024
    v_mfma_f32_16x16x32_bf16 v[236:239], a[52:55], a[180:183], v[236:239]
    buffer_load_dwordx4 a[232:235], v37, s[8:11], s62 offen offset:0 sc1
    v_mfma_f32_16x16x32_bf16 a[104:107], a[52:55], a[184:187], a[104:107]
    v_mfma_f32_16x16x32_bf16 a[108:111], a[52:55], a[188:191], a[108:111]
    v_mfma_f32_16x16x32_bf16 v[240:243], a[56:59], a[176:179], v[240:243]
    v_mfma_f32_16x16x32_bf16 v[244:247], a[56:59], a[180:183], v[244:247]
    buffer_load_dwordx4 a[236:239], v37, s[8:11], s62 offen offset:1024 sc1
    v_mfma_f32_16x16x32_bf16 a[112:115], a[56:59], a[184:187], a[112:115]
    v_mfma_f32_16x16x32_bf16 a[116:119], a[56:59], a[188:191], a[116:119]
    s_add_u32 s62, s62, 0x20000
    v_mfma_f32_16x16x32_bf16 v[248:251], a[60:63], a[176:179], v[248:251]
    v_mfma_f32_16x16x32_bf16 v[252:255], a[60:63], a[180:183], v[252:255]
    v_mfma_f32_16x16x32_bf16 a[120:123], a[60:63], a[184:187], a[120:123]
    v_mfma_f32_16x16x32_bf16 a[124:127], a[60:63], a[188:191], a[124:127]
    s_waitcnt vmcnt(12) lgkmcnt(0)
    v_mfma_f32_16x16x32_bf16 v[192:195], a[0:3], a[192:195], v[192:195]
    ds_read_b64_tr_b16 a[32:33], v42 offset:8192
    ds_read_b64_tr_b16 a[34:35], v42 offset:9216
    v_mfma_f32_16x16x32_bf16 v[196:199], a[0:3], a[196:199], v[196:199]
    buffer_load_dwordx4 a[240:243], v36, s[8:11], s62 offen offset:0 sc1
    v_mfma_f32_16x16x32_bf16 a[64:67], a[0:3], a[200:203], a[64:67]
    ds_read_b64_tr_b16 a[36:37], v43 offset:8192
    v_mfma_f32_16x16x32_bf16 a[68:71], a[0:3], a[204:207], a[68:71]
    ds_read_b64_tr_b16 a[38:39], v43 offset:9216
    v_mfma_f32_16x16x32_bf16 v[200:203], a[4:7], a[192:195], v[200:203]
    ds_read_b64_tr_b16 a[40:41], v44 offset:8192
    v_mfma_f32_16x16x32_bf16 v[204:207], a[4:7], a[196:199], v[204:207]
    v_mfma_f32_16x16x32_bf16 a[72:75], a[4:7], a[200:203], a[72:75]
    ds_read_b64_tr_b16 a[42:43], v44 offset:9216
    v_mfma_f32_16x16x32_bf16 a[76:79], a[4:7], a[204:207], a[76:79]
    ds_read_b64_tr_b16 a[44:45], v45 offset:8192
    v_mfma_f32_16x16x32_bf16 v[208:211], a[8:11], a[192:195], v[208:211]
    buffer_load_dwordx4 a[244:247], v36, s[8:11], s62 offen offset:1024 sc1
    v_mfma_f32_16x16x32_bf16 v[212:215], a[8:11], a[196:199], v[212:215]
    ds_read_b64_tr_b16 a[46:47], v45 offset:9216
    v_mfma_f32_16x16x32_bf16 a[80:83], a[8:11], a[200:203], a[80:83]
    ds_read_b64_tr_b16 a[48:49], v46 offset:8192
    v_mfma_f32_16x16x32_bf16 a[84:87], a[8:11], a[204:207], a[84:87]
    ds_read_b64_tr_b16 a[50:51], v46 offset:9216
    v_mfma_f32_16x16x32_bf16 v[216:219], a[12:15], a[192:195], v[216:219]
    v_mfma_f32_16x16x32_bf16 v[220:223], a[12:15], a[196:199], v[220:223]
    ds_read_b64_tr_b16 a[52:53], v47 offset:8192
    v_mfma_f32_16x16x32_bf16 a[88:91], a[12:15], a[200:203], a[88:91]
    buffer_load_dwordx4 a[248:251], v37, s[8:11], s62 offen offset:0 sc1
    ds_read_b64_tr_b16 a[54:55], v47 offset:9216
    v_mfma_f32_16x16x32_bf16 a[92:95], a[12:15], a[204:207], a[92:95]
    ds_read_b64_tr_b16 a[56:57], v48 offset:8192
    v_mfma_f32_16x16x32_bf16 v[224:227], a[16:19], a[192:195], v[224:227]
    v_mfma_f32_16x16x32_bf16 v[228:231], a[16:19], a[196:199], v[228:231]
    ds_read_b64_tr_b16 a[58:59], v48 offset:9216
    v_mfma_f32_16x16x32_bf16 a[96:99], a[16:19], a[200:203], a[96:99]
    ds_read_b64_tr_b16 a[60:61], v49 offset:8192
    v_mfma_f32_16x16x32_bf16 a[100:103], a[16:19], a[204:207], a[100:103]
    v_mfma_f32_16x16x32_bf16 v[232:235], a[20:23], a[192:195], v[232:235]
    ds_read_b64_tr_b16 a[62:63], v49 offset:9216
    v_mfma_f32_16x16x32_bf16 v[236:239], a[20:23], a[196:199], v[236:239]
    buffer_load_dwordx4 a[252:255], v37, s[8:11], s62 offen offset:1024 sc1
    v_mfma_f32_16x16x32_bf16 a[104:107], a[20:23], a[200:203], a[104:107]
    v_mfma_f32_16x16x32_bf16 a[108:111], a[20:23], a[204:207], a[108:111]
    v_mfma_f32_16x16x32_bf16 v[240:243], a[24:27], a[192:195], v[240:243]
    v_mfma_f32_16x16x32_bf16 v[244:247], a[24:27], a[196:199], v[244:247]
    v_mfma_f32_16x16x32_bf16 a[112:115], a[24:27], a[200:203], a[112:115]
    v_mfma_f32_16x16x32_bf16 a[116:119], a[24:27], a[204:207], a[116:119]
    s_add_u32 s62, s62, 0x20000
    v_mfma_f32_16x16x32_bf16 v[248:251], a[28:31], a[192:195], v[248:251]
    v_add_co_u32 v2, vcc, 0x4000, v2
    s_nop 1
    v_addc_co_u32 v3, vcc, 0, v3, vcc
    global_load_dword v51, v[2:3], off
    v_mfma_f32_16x16x32_bf16 v[252:255], a[28:31], a[196:199], v[252:255]
    v_mfma_f32_16x16x32_bf16 a[120:123], a[28:31], a[200:203], a[120:123]
    v_mfma_f32_16x16x32_bf16 a[124:127], a[28:31], a[204:207], a[124:127]
    s_waitcnt vmcnt(8) lgkmcnt(0)
    s_barrier
    v_mfma_f32_16x16x32_bf16 v[192:195], a[32:35], a[208:211], v[192:195]
    ds_read_b64_tr_b16 a[0:1], v42 offset:16384
    ds_read_b64_tr_b16 a[2:3], v42 offset:17408
    v_mfma_f32_16x16x32_bf16 v[196:199], a[32:35], a[212:215], v[196:199]
    s_add_u32 m0, s60, 131072
    v_mfma_f32_16x16x32_bf16 a[64:67], a[32:35], a[216:219], a[64:67]
    buffer_load_dwordx4 v38, s[12:15], s61 offen offset:0 lds
    ds_read_b64_tr_b16 a[4:5], v43 offset:16384
    v_mfma_f32_16x16x32_bf16 a[68:71], a[32:35], a[220:223], a[68:71]
    ds_read_b64_tr_b16 a[6:7], v43 offset:17408
    v_mfma_f32_16x16x32_bf16 v[200:203], a[36:39], a[208:211], v[200:203]
    buffer_load_dwordx4 v39, s[12:15], s61 offen offset:1024 lds
    ds_read_b64_tr_b16 a[8:9], v44 offset:16384
    v_mfma_f32_16x16x32_bf16 v[204:207], a[36:39], a[212:215], v[204:207]
    v_mfma_f32_16x16x32_bf16 a[72:75], a[36:39], a[216:219], a[72:75]
    ds_read_b64_tr_b16 a[10:11], v44 offset:17408
    v_mfma_f32_16x16x32_bf16 a[76:79], a[36:39], a[220:223], a[76:79]
    ds_read_b64_tr_b16 a[12:13], v45 offset:16384
    v_mfma_f32_16x16x32_bf16 v[208:211], a[40:43], a[208:211], v[208:211]
    buffer_load_dwordx4 v40, s[12:15], s61 offen offset:2048 lds
    v_mfma_f32_16x16x32_bf16 v[212:215], a[40:43], a[212:215], v[212:215]
    ds_read_b64_tr_b16 a[14:15], v45 offset:17408
    v_mfma_f32_16x16x32_bf16 a[80:83], a[40:43], a[216:219], a[80:83]
    ds_read_b64_tr_b16 a[16:17], v46 offset:16384
    v_mfma_f32_16x16x32_bf16 a[84:87], a[40:43], a[220:223], a[84:87]
    buffer_load_dwordx4 v41, s[12:15], s61 offen offset:3072 lds
    ds_read_b64_tr_b16 a[18:19], v46 offset:17408
    v_mfma_f32_16x16x32_bf16 v[216:219], a[44:47], a[208:211], v[216:219]
    v_mfma_f32_16x16x32_bf16 v[220:223], a[44:47], a[212:215], v[220:223]
    s_add_u32 s61, s61, 0x80000
    ds_read_b64_tr_b16 a[20:21], v47 offset:16384
    v_mfma_f32_16x16x32_bf16 a[88:91], a[44:47], a[216:219], a[88:91]
    buffer_load_dwordx4 a[128:131], v36, s[8:11], s62 offen offset:0 sc1
    ds_read_b64_tr_b16 a[22:23], v47 offset:17408
    v_mfma_f32_16x16x32_bf16 a[92:95], a[44:47], a[220:223], a[92:95]
    ds_read_b64_tr_b16 a[24:25], v48 offset:16384
    v_mfma_f32_16x16x32_bf16 v[224:227], a[48:51], a[208:211], v[224:227]
    v_mfma_f32_16x16x32_bf16 v[228:231], a[48:51], a[212:215], v[228:231]
    ds_read_b64_tr_b16 a[26:27], v48 offset:17408
    v_mfma_f32_16x16x32_bf16 a[96:99], a[48:51], a[216:219], a[96:99]
    buffer_load_dwordx4 a[132:135], v36, s[8:11], s62 offen offset:1024 sc1
    ds_read_b64_tr_b16 a[28:29], v49 offset:16384
    v_mfma_f32_16x16x32_bf16 a[100:103], a[48:51], a[220:223], a[100:103]
    v_mfma_f32_16x16x32_bf16 v[232:235], a[52:55], a[208:211], v[232:235]
    ds_read_b64_tr_b16 a[30:31], v49 offset:17408
    v_mfma_f32_16x16x32_bf16 v[236:239], a[52:55], a[212:215], v[236:239]
    buffer_load_dwordx4 a[136:139], v37, s[8:11], s62 offen offset:0 sc1
    v_mfma_f32_16x16x32_bf16 a[104:107], a[52:55], a[216:219], a[104:107]
    v_mfma_f32_16x16x32_bf16 a[108:111], a[52:55], a[220:223], a[108:111]
    v_mfma_f32_16x16x32_bf16 v[240:243], a[56:59], a[208:211], v[240:243]
    v_mfma_f32_16x16x32_bf16 v[244:247], a[56:59], a[212:215], v[244:247]
    buffer_load_dwordx4 a[140:143], v37, s[8:11], s62 offen offset:1024 sc1
    v_mfma_f32_16x16x32_bf16 a[112:115], a[56:59], a[216:219], a[112:115]
    v_mfma_f32_16x16x32_bf16 a[116:119], a[56:59], a[220:223], a[116:119]
    s_add_u32 s62, s62, 0x20000
    v_mfma_f32_16x16x32_bf16 v[248:251], a[60:63], a[208:211], v[248:251]
    v_mfma_f32_16x16x32_bf16 v[252:255], a[60:63], a[212:215], v[252:255]
    v_mfma_f32_16x16x32_bf16 a[120:123], a[60:63], a[216:219], a[120:123]
    v_mfma_f32_16x16x32_bf16 a[124:127], a[60:63], a[220:223], a[124:127]
    s_waitcnt vmcnt(12) lgkmcnt(0)
    v_mfma_f32_16x16x32_bf16 v[192:195], a[0:3], a[224:227], v[192:195]
    ds_read_b64_tr_b16 a[32:33], v42 offset:24576
    ds_read_b64_tr_b16 a[34:35], v42 offset:25600
    v_mfma_f32_16x16x32_bf16 v[196:199], a[0:3], a[228:231], v[196:199]
    buffer_load_dwordx4 a[144:147], v36, s[8:11], s62 offen offset:0 sc1
    v_mfma_f32_16x16x32_bf16 a[64:67], a[0:3], a[232:235], a[64:67]
    ds_read_b64_tr_b16 a[36:37], v43 offset:24576
    v_mfma_f32_16x16x32_bf16 a[68:71], a[0:3], a[236:239], a[68:71]
    ds_read_b64_tr_b16 a[38:39], v43 offset:25600
    v_mfma_f32_16x16x32_bf16 v[200:203], a[4:7], a[224:227], v[200:203]
    ds_read_b64_tr_b16 a[40:41], v44 offset:24576
    v_mfma_f32_16x16x32_bf16 v[204:207], a[4:7], a[228:231], v[204:207]
    v_mfma_f32_16x16x32_bf16 a[72:75], a[4:7], a[232:235], a[72:75]
    ds_read_b64_tr_b16 a[42:43], v44 offset:25600
    v_mfma_f32_16x16x32_bf16 a[76:79], a[4:7], a[236:239], a[76:79]
    ds_read_b64_tr_b16 a[44:45], v45 offset:24576
    v_mfma_f32_16x16x32_bf16 v[208:211], a[8:11], a[224:227], v[208:211]
    buffer_load_dwordx4 a[148:151], v36, s[8:11], s62 offen offset:1024 sc1
    v_mfma_f32_16x16x32_bf16 v[212:215], a[8:11], a[228:231], v[212:215]
    ds_read_b64_tr_b16 a[46:47], v45 offset:25600
    v_mfma_f32_16x16x32_bf16 a[80:83], a[8:11], a[232:235], a[80:83]
    ds_read_b64_tr_b16 a[48:49], v46 offset:24576
    v_mfma_f32_16x16x32_bf16 a[84:87], a[8:11], a[236:239], a[84:87]
    ds_read_b64_tr_b16 a[50:51], v46 offset:25600
    v_mfma_f32_16x16x32_bf16 v[216:219], a[12:15], a[224:227], v[216:219]
    v_mfma_f32_16x16x32_bf16 v[220:223], a[12:15], a[228:231], v[220:223]
    ds_read_b64_tr_b16 a[52:53], v47 offset:24576
    v_mfma_f32_16x16x32_bf16 a[88:91], a[12:15], a[232:235], a[88:91]
    buffer_load_dwordx4 a[152:155], v37, s[8:11], s62 offen offset:0 sc1
    ds_read_b64_tr_b16 a[54:55], v47 offset:25600
    v_mfma_f32_16x16x32_bf16 a[92:95], a[12:15], a[236:239], a[92:95]
    ds_read_b64_tr_b16 a[56:57], v48 offset:24576
    v_mfma_f32_16x16x32_bf16 v[224:227], a[16:19], a[224:227], v[224:227]
    v_mfma_f32_16x16x32_bf16 v[228:231], a[16:19], a[228:231], v[228:231]
    ds_read_b64_tr_b16 a[58:59], v48 offset:25600
    v_mfma_f32_16x16x32_bf16 a[96:99], a[16:19], a[232:235], a[96:99]
    ds_read_b64_tr_b16 a[60:61], v49 offset:24576
    v_mfma_f32_16x16x32_bf16 a[100:103], a[16:19], a[236:239], a[100:103]
    v_mfma_f32_16x16x32_bf16 v[232:235], a[20:23], a[224:227], v[232:235]
    ds_read_b64_tr_b16 a[62:63], v49 offset:25600
    v_mfma_f32_16x16x32_bf16 v[236:239], a[20:23], a[228:231], v[236:239]
    buffer_load_dwordx4 a[156:159], v37, s[8:11], s62 offen offset:1024 sc1
    v_mfma_f32_16x16x32_bf16 a[104:107], a[20:23], a[232:235], a[104:107]
    v_mfma_f32_16x16x32_bf16 a[108:111], a[20:23], a[236:239], a[108:111]
    v_mfma_f32_16x16x32_bf16 v[240:243], a[24:27], a[224:227], v[240:243]
    v_mfma_f32_16x16x32_bf16 v[244:247], a[24:27], a[228:231], v[244:247]
    v_mfma_f32_16x16x32_bf16 a[112:115], a[24:27], a[232:235], a[112:115]
    v_mfma_f32_16x16x32_bf16 a[116:119], a[24:27], a[236:239], a[116:119]
    s_add_u32 s62, s62, 0x20000
    v_mfma_f32_16x16x32_bf16 v[248:251], a[28:31], a[224:227], v[248:251]
    v_mfma_f32_16x16x32_bf16 v[252:255], a[28:31], a[228:231], v[252:255]
    v_mfma_f32_16x16x32_bf16 a[120:123], a[28:31], a[232:235], a[120:123]
    v_mfma_f32_16x16x32_bf16 a[124:127], a[28:31], a[236:239], a[124:127]
    s_waitcnt vmcnt(8) lgkmcnt(0)
    s_barrier
    v_mfma_f32_16x16x32_bf16 v[192:195], a[32:35], a[240:243], v[192:195]
    ds_read_b64_tr_b16 a[0:1], v42 offset:32768
    ds_read_b64_tr_b16 a[2:3], v42 offset:33792
    v_mfma_f32_16x16x32_bf16 v[196:199], a[32:35], a[244:247], v[196:199]
    s_cmp_eq_u32 s30, 0
    s_cbranch_scc1 k12_ool_42
k12_oolret_43:
    v_mfma_f32_16x16x32_bf16 a[64:67], a[32:35], a[248:251], a[64:67]
    s_add_u32 m0, s60, 147456
    ds_read_b64_tr_b16 a[4:5], v43 offset:32768
    v_mfma_f32_16x16x32_bf16 a[68:71], a[32:35], a[252:255], a[68:71]
    buffer_load_dwordx4 v38, s[12:15], s61 offen offset:0 lds
    ds_read_b64_tr_b16 a[6:7], v43 offset:33792
    v_mfma_f32_16x16x32_bf16 v[200:203], a[36:39], a[240:243], v[200:203]
    buffer_load_dwordx4 v39, s[12:15], s61 offen offset:1024 lds
    ds_read_b64_tr_b16 a[8:9], v44 offset:32768
    v_mfma_f32_16x16x32_bf16 v[204:207], a[36:39], a[244:247], v[204:207]
    v_mfma_f32_16x16x32_bf16 a[72:75], a[36:39], a[248:251], a[72:75]
    ds_read_b64_tr_b16 a[10:11], v44 offset:33792
    v_mfma_f32_16x16x32_bf16 a[76:79], a[36:39], a[252:255], a[76:79]
    ds_read_b64_tr_b16 a[12:13], v45 offset:32768
    v_mfma_f32_16x16x32_bf16 v[208:211], a[40:43], a[240:243], v[208:211]
    buffer_load_dwordx4 v40, s[12:15], s61 offen offset:2048 lds
    v_mfma_f32_16x16x32_bf16 v[212:215], a[40:43], a[244:247], v[212:215]
    ds_read_b64_tr_b16 a[14:15], v45 offset:33792
    v_mfma_f32_16x16x32_bf16 a[80:83], a[40:43], a[248:251], a[80:83]
    ds_read_b64_tr_b16 a[16:17], v46 offset:32768
    v_mfma_f32_16x16x32_bf16 a[84:87], a[40:43], a[252:255], a[84:87]
    buffer_load_dwordx4 v41, s[12:15], s61 offen offset:3072 lds
    ds_read_b64_tr_b16 a[18:19], v46 offset:33792
    v_mfma_f32_16x16x32_bf16 v[216:219], a[44:47], a[240:243], v[216:219]
    v_mfma_f32_16x16x32_bf16 v[220:223], a[44:47], a[244:247], v[220:223]
    s_add_u32 s61, s61, 0x80000
    ds_read_b64_tr_b16 a[20:21], v47 offset:32768
    v_mfma_f32_16x16x32_bf16 a[88:91], a[44:47], a[248:251], a[88:91]
    buffer_load_dwordx4 a[160:163], v36, s[8:11], s62 offen offset:0 sc1
    ds_read_b64_tr_b16 a[22:23], v47 offset:33792
    v_mfma_f32_16x16x32_bf16 a[92:95], a[44:47], a[252:255], a[92:95]
    ds_read_b64_tr_b16 a[24:25], v48 offset:32768
    v_mfma_f32_16x16x32_bf16 v[224:227], a[48:51], a[240:243], v[224:227]
    v_mfma_f32_16x16x32_bf16 v[228:231], a[48:51], a[244:247], v[228:231]
    ds_read_b64_tr_b16 a[26:27], v48 offset:33792
    v_mfma_f32_16x16x32_bf16 a[96:99], a[48:51], a[248:251], a[96:99]
    buffer_load_dwordx4 a[164:167], v36, s[8:11], s62 offen offset:1024 sc1
    ds_read_b64_tr_b16 a[28:29], v49 offset:32768
    v_mfma_f32_16x16x32_bf16 a[100:103], a[48:51], a[252:255], a[100:103]
    v_mfma_f32_16x16x32_bf16 v[232:235], a[52:55], a[240:243], v[232:235]
    ds_read_b64_tr_b16 a[30:31], v49 offset:33792
    v_mfma_f32_16x16x32_bf16 v[236:239], a[52:55], a[244:247], v[236:239]
    buffer_load_dwordx4 a[168:171], v37, s[8:11], s62 offen offset:0 sc1
    v_mfma_f32_16x16x32_bf16 a[104:107], a[52:55], a[248:251], a[104:107]
    v_mfma_f32_16x16x32_bf16 a[108:111], a[52:55], a[252:255], a[108:111]
    v_mfma_f32_16x16x32_bf16 v[240:243], a[56:59], a[240:243], v[240:243]
    v_mfma_f32_16x16x32_bf16 v[244:247], a[56:59], a[244:247], v[244:247]
    buffer_load_dwordx4 a[172:175], v37, s[8:11], s62 offen offset:1024 sc1
    v_mfma_f32_16x16x32_bf16 a[112:115], a[56:59], a[248:251], a[112:115]
    v_mfma_f32_16x16x32_bf16 a[116:119], a[56:59], a[252:255], a[116:119]
    s_add_u32 s62, s62, 0x20000
    v_mfma_f32_16x16x32_bf16 v[248:251], a[60:63], a[240:243], v[248:251]
    v_mfma_f32_16x16x32_bf16 v[252:255], a[60:63], a[244:247], v[252:255]
    v_mfma_f32_16x16x32_bf16 a[120:123], a[60:63], a[248:251], a[120:123]
    v_mfma_f32_16x16x32_bf16 a[124:127], a[60:63], a[252:255], a[124:127]
    s_waitcnt vmcnt(12) lgkmcnt(0)
    v_mfma_f32_16x16x32_bf16 v[192:195], a[0:3], a[128:131], v[192:195]
    ds_read_b64_tr_b16 a[32:33], v42 offset:40960
    ds_read_b64_tr_b16 a[34:35], v42 offset:41984
    v_mfma_f32_16x16x32_bf16 v[196:199], a[0:3], a[132:135], v[196:199]
    buffer_load_dwordx4 a[176:179], v36, s[8:11], s62 offen offset:0 sc1
    v_mfma_f32_16x16x32_bf16 a[64:67], a[0:3], a[136:139], a[64:67]
    ds_read_b64_tr_b16 a[36:37], v43 offset:40960
    v_mfma_f32_16x16x32_bf16 a[68:71], a[0:3], a[140:143], a[68:71]
    ds_read_b64_tr_b16 a[38:39], v43 offset:41984
    v_mfma_f32_16x16x32_bf16 v[200:203], a[4:7], a[128:131], v[200:203]
    ds_read_b64_tr_b16 a[40:41], v44 offset:40960
    v_mfma_f32_16x16x32_bf16 v[204:207], a[4:7], a[132:135], v[204:207]
    v_mfma_f32_16x16x32_bf16 a[72:75], a[4:7], a[136:139], a[72:75]
    ds_read_b64_tr_b16 a[42:43], v44 offset:41984
    v_mfma_f32_16x16x32_bf16 a[76:79], a[4:7], a[140:143], a[76:79]
    ds_read_b64_tr_b16 a[44:45], v45 offset:40960
    v_mfma_f32_16x16x32_bf16 v[208:211], a[8:11], a[128:131], v[208:211]
    buffer_load_dwordx4 a[180:183], v36, s[8:11], s62 offen offset:1024 sc1
    v_mfma_f32_16x16x32_bf16 v[212:215], a[8:11], a[132:135], v[212:215]
    ds_read_b64_tr_b16 a[46:47], v45 offset:41984
    v_mfma_f32_16x16x32_bf16 a[80:83], a[8:11], a[136:139], a[80:83]
    ds_read_b64_tr_b16 a[48:49], v46 offset:40960
    v_mfma_f32_16x16x32_bf16 a[84:87], a[8:11], a[140:143], a[84:87]
    ds_read_b64_tr_b16 a[50:51], v46 offset:41984
    v_mfma_f32_16x16x32_bf16 v[216:219], a[12:15], a[128:131], v[216:219]
    v_mfma_f32_16x16x32_bf16 v[220:223], a[12:15], a[132:135], v[220:223]
    ds_read_b64_tr_b16 a[52:53], v47 offset:40960
    v_mfma_f32_16x16x32_bf16 a[88:91], a[12:15], a[136:139], a[88:91]
    buffer_load_dwordx4 a[184:187], v37, s[8:11], s62 offen offset:0 sc1
    ds_read_b64_tr_b16 a[54:55], v47 offset:41984
    v_mfma_f32_16x16x32_bf16 a[92:95], a[12:15], a[140:143], a[92:95]
    ds_read_b64_tr_b16 a[56:57], v48 offset:40960
    v_mfma_f32_16x16x32_bf16 v[224:227], a[16:19], a[128:131], v[224:227]
    v_mfma_f32_16x16x32_bf16 v[228:231], a[16:19], a[132:135], v[228:231]
    ds_read_b64_tr_b16 a[58:59], v48 offset:41984
    v_mfma_f32_16x16x32_bf16 a[96:99], a[16:19], a[136:139], a[96:99]
    ds_read_b64_tr_b16 a[60:61], v49 offset:40960
    v_mfma_f32_16x16x32_bf16 a[100:103], a[16:19], a[140:143], a[100:103]
    v_mfma_f32_16x16x32_bf16 v[232:235], a[20:23], a[128:131], v[232:235]
    ds_read_b64_tr_b16 a[62:63], v49 offset:41984
    v_mfma_f32_16x16x32_bf16 v[236:239], a[20:23], a[132:135], v[236:239]
    buffer_load_dwordx4 a[188:191], v37, s[8:11], s62 offen offset:1024 sc1
    v_mfma_f32_16x16x32_bf16 a[104:107], a[20:23], a[136:139], a[104:107]
    v_mfma_f32_16x16x32_bf16 a[108:111], a[20:23], a[140:143], a[108:111]
    v_mfma_f32_16x16x32_bf16 v[240:243], a[24:27], a[128:131], v[240:243]
    v_mfma_f32_16x16x32_bf16 v[244:247], a[24:27], a[132:135], v[244:247]
    v_mfma_f32_16x16x32_bf16 a[112:115], a[24:27], a[136:139], a[112:115]
    v_mfma_f32_16x16x32_bf16 a[116:119], a[24:27], a[140:143], a[116:119]
    s_add_u32 s62, s62, 0x20000
    v_mfma_f32_16x16x32_bf16 v[248:251], a[28:31], a[128:131], v[248:251]
    s_cmp_eq_u32 s30, 0
    s_cbranch_scc1 k12_ool_46
k12_oolret_47:
    v_mfma_f32_16x16x32_bf16 v[252:255], a[28:31], a[132:135], v[252:255]
    v_mfma_f32_16x16x32_bf16 a[120:123], a[28:31], a[136:139], a[120:123]
    v_mfma_f32_16x16x32_bf16 a[124:127], a[28:31], a[140:143], a[124:127]
    s_waitcnt vmcnt(8) lgkmcnt(0)
    s_barrier
    v_mfma_f32_16x16x32_bf16 v[192:195], a[32:35], a[144:147], v[192:195]
    ds_read_b64_tr_b16 a[0:1], v42 offset:49152
    ds_read_b64_tr_b16 a[2:3], v42 offset:50176
    v_mfma_f32_16x16x32_bf16 v[196:199], a[32:35], a[148:151], v[196:199]
    s_mov_b32 m0, s34
    v_mfma_f32_16x16x32_bf16 a[64:67], a[32:35], a[152:155], a[64:67]
    buffer_load_dwordx4 v1, s[16:19], s32 offen offset:0 sc1 lds
    ds_read_b64_tr_b16 a[4:5], v43 offset:49152
    v_mfma_f32_16x16x32_bf16 a[68:71], a[32:35], a[156:159], a[68:71]
    ds_read_b64_tr_b16 a[6:7], v43 offset:50176
    v_mfma_f32_16x16x32_bf16 v[200:203], a[36:39], a[144:147], v[200:203]
    buffer_load_dwordx4 v1, s[16:19], s32 offen offset:1024 sc1 lds
    ds_read_b64_tr_b16 a[8:9], v44 offset:49152
    v_mfma_f32_16x16x32_bf16 v[204:207], a[36:39], a[148:151], v[204:207]
    v_mfma_f32_16x16x32_bf16 a[72:75], a[36:39], a[152:155], a[72:75]
    ds_read_b64_tr_b16 a[10:11], v44 offset:50176
    v_mfma_f32_16x16x32_bf16 a[76:79], a[36:39], a[156:159], a[76:79]
    ds_read_b64_tr_b16 a[12:13], v45 offset:49152
    v_mfma_f32_16x16x32_bf16 v[208:211], a[40:43], a[144:147], v[208:211]
    buffer_load_dwordx4 v1, s[16:19], s32 offen offset:2048 sc1 lds
    v_mfma_f32_16x16x32_bf16 v[212:215], a[40:43], a[148:151], v[212:215]
    ds_read_b64_tr_b16 a[14:15], v45 offset:50176
    v_mfma_f32_16x16x32_bf16 a[80:83], a[40:43], a[152:155], a[80:83]
    ds_read_b64_tr_b16 a[16:17], v46 offset:49152
    v_mfma_f32_16x16x32_bf16 a[84:87], a[40:43], a[156:159], a[84:87]
    buffer_load_dwordx4 v1, s[16:19], s32 offen offset:3072 sc1 lds
    ds_read_b64_tr_b16 a[18:19], v46 offset:50176
    v_mfma_f32_16x16x32_bf16 v[216:219], a[44:47], a[144:147], v[216:219]
    v_mfma_f32_16x16x32_bf16 v[220:223], a[44:47], a[148:151], v[220:223]
    s_add_u32 s32, s32, 0x80000
    ds_read_b64_tr_b16 a[20:21], v47 offset:49152
    v_mfma_f32_16x16x32_bf16 a[88:91], a[44:47], a[152:155], a[88:91]
    s_add_u32 s34, s34, 0x4000
    ds_read_b64_tr_b16 a[22:23], v47 offset:50176
    v_mfma_f32_16x16x32_bf16 a[92:95], a[44:47], a[156:159], a[92:95]
    s_mov_b32 m0, s34
    ds_read_b64_tr_b16 a[24:25], v48 offset:49152
    v_mfma_f32_16x16x32_bf16 v[224:227], a[48:51], a[144:147], v[224:227]
    buffer_load_dwordx4 v1, s[16:19], s32 offen offset:0 sc1 lds
    v_mfma_f32_16x16x32_bf16 v[228:231], a[48:51], a[148:151], v[228:231]
    ds_read_b64_tr_b16 a[26:27], v48 offset:50176
    v_mfma_f32_16x16x32_bf16 a[96:99], a[48:51], a[152:155], a[96:99]
    buffer_load_dwordx4 v1, s[16:19], s32 offen offset:1024 sc1 lds
    ds_read_b64_tr_b16 a[28:29], v49 offset:49152
    v_mfma_f32_16x16x32_bf16 a[100:103], a[48:51], a[156:159], a[100:103]
    v_mfma_f32_16x16x32_bf16 v[232:235], a[52:55], a[144:147], v[232:235]
    ds_read_b64_tr_b16 a[30:31], v49 offset:50176
    v_mfma_f32_16x16x32_bf16 v[236:239], a[52:55], a[148:151], v[236:239]
    buffer_load_dwordx4 v1, s[16:19], s32 offen offset:2048 sc1 lds
    v_mfma_f32_16x16x32_bf16 a[104:107], a[52:55], a[152:155], a[104:107]
    v_mfma_f32_16x16x32_bf16 a[108:111], a[52:55], a[156:159], a[108:111]
    v_mfma_f32_16x16x32_bf16 v[240:243], a[56:59], a[144:147], v[240:243]
    v_mfma_f32_16x16x32_bf16 v[244:247], a[56:59], a[148:151], v[244:247]
    buffer_load_dwordx4 v1, s[16:19], s32 offen offset:3072 sc1 lds
    v_mfma_f32_16x16x32_bf16 a[112:115], a[56:59], a[152:155], a[112:115]
    v_mfma_f32_16x16x32_bf16 a[116:119], a[56:59], a[156:159], a[116:119]
    s_add_u32 s32, s32, 0x80000
    v_mfma_f32_16x16x32_bf16 v[248:251], a[60:63], a[144:147], v[248:251]
    s_add_u32 s34, s34, 0x4000
    v_mfma_f32_16x16x32_bf16 v[252:255], a[60:63], a[148:151], v[252:255]
    v_mfma_f32_16x16x32_bf16 a[120:123], a[60:63], a[152:155], a[120:123]
    v_mfma_f32_16x16x32_bf16 a[124:127], a[60:63], a[156:159], a[124:127]
    s_waitcnt vmcnt(12) lgkmcnt(0)
    v_mfma_f32_16x16x32_bf16 v[192:195], a[0:3], a[160:163], v[192:195]
    ds_read_b64_tr_b16 a[32:33], v42 offset:57344
    ds_read_b64_tr_b16 a[34:35], v42 offset:58368
    v_mfma_f32_16x16x32_bf16 v[196:199], a[0:3], a[164:167], v[196:199]
    s_mov_b32 m0, s35
    v_mfma_f32_16x16x32_bf16 a[64:67], a[0:3], a[168:171], a[64:67]
    buffer_load_dwordx4 v1, s[20:23], s33 offen offset:0 sc1 lds
    ds_read_b64_tr_b16 a[36:37], v43 offset:57344
    v_mfma_f32_16x16x32_bf16 a[68:71], a[0:3], a[172:175], a[68:71]
    ds_read_b64_tr_b16 a[38:39], v43 offset:58368
    v_mfma_f32_16x16x32_bf16 v[200:203], a[4:7], a[160:163], v[200:203]
    buffer_load_dwordx4 v1, s[20:23], s33 offen offset:1024 sc1 lds
    ds_read_b64_tr_b16 a[40:41], v44 offset:57344
    v_mfma_f32_16x16x32_bf16 v[204:207], a[4:7], a[164:167], v[204:207]
    v_mfma_f32_16x16x32_bf16 a[72:75], a[4:7], a[168:171], a[72:75]
    ds_read_b64_tr_b16 a[42:43], v44 offset:58368
    v_mfma_f32_16x16x32_bf16 a[76:79], a[4:7], a[172:175], a[76:79]
    ds_read_b64_tr_b16 a[44:45], v45 offset:57344
    v_mfma_f32_16x16x32_bf16 v[208:211], a[8:11], a[160:163], v[208:211]
    buffer_load_dwordx4 v1, s[20:23], s33 offen offset:2048 sc1 lds
    v_mfma_f32_16x16x32_bf16 v[212:215], a[8:11], a[164:167], v[212:215]
    ds_read_b64_tr_b16 a[46:47], v45 offset:58368
    v_mfma_f32_16x16x32_bf16 a[80:83], a[8:11], a[168:171], a[80:83]
    ds_read_b64_tr_b16 a[48:49], v46 offset:57344
    v_mfma_f32_16x16x32_bf16 a[84:87], a[8:11], a[172:175], a[84:87]
    buffer_load_dwordx4 v1, s[20:23], s33 offen offset:3072 sc1 lds
    ds_read_b64_tr_b16 a[50:51], v46 offset:58368
    v_mfma_f32_16x16x32_bf16 v[216:219], a[12:15], a[160:163], v[216:219]
    v_mfma_f32_16x16x32_bf16 v[220:223], a[12:15], a[164:167], v[220:223]
    s_add_u32 s33, s33, 0x80000
    ds_read_b64_tr_b16 a[52:53], v47 offset:57344
    v_mfma_f32_16x16x32_bf16 a[88:91], a[12:15], a[168:171], a[88:91]
    s_add_u32 s35, s35, 0x4000
    ds_read_b64_tr_b16 a[54:55], v47 offset:58368
    v_mfma_f32_16x16x32_bf16 a[92:95], a[12:15], a[172:175], a[92:95]
    s_mov_b32 m0, s34
    ds_read_b64_tr_b16 a[56:57], v48 offset:57344
    v_mfma_f32_16x16x32_bf16 v[224:227], a[16:19], a[160:163], v[224:227]
    buffer_load_dwordx4 v1, s[16:19], s32 offen offset:0 sc1 lds
    v_mfma_f32_16x16x32_bf16 v[228:231], a[16:19], a[164:167], v[228:231]
    ds_read_b64_tr_b16 a[58:59], v48 offset:58368
    v_mfma_f32_16x16x32_bf16 a[96:99], a[16:19], a[168:171], a[96:99]
    buffer_load_dwordx4 v1, s[16:19], s32 offen offset:1024 sc1 lds
    ds_read_b64_tr_b16 a[60:61], v49 offset:57344
    v_mfma_f32_16x16x32_bf16 a[100:103], a[16:19], a[172:175], a[100:103]
    v_mfma_f32_16x16x32_bf16 v[232:235], a[20:23], a[160:163], v[232:235]
    ds_read_b64_tr_b16 a[62:63], v49 offset:58368
    v_mfma_f32_16x16x32_bf16 v[236:239], a[20:23], a[164:167], v[236:239]
    buffer_load_dwordx4 v1, s[16:19], s32 offen offset:2048 sc1 lds
    v_mfma_f32_16x16x32_bf16 a[104:107], a[20:23], a[168:171], a[104:107]
    v_mfma_f32_16x16x32_bf16 a[108:111], a[20:23], a[172:175], a[108:111]
    v_mfma_f32_16x16x32_bf16 v[240:243], a[24:27], a[160:163], v[240:243]
    v_mfma_f32_16x16x32_bf16 v[244:247], a[24:27], a[164:167], v[244:247]
    buffer_load_dwordx4 v1, s[16:19], s32 offen offset:3072 sc1 lds
    v_mfma_f32_16x16x32_bf16 a[112:115], a[24:27], a[168:171], a[112:115]
    v_mfma_f32_16x16x32_bf16 a[116:119], a[24:27], a[172:175], a[116:119]
    s_add_u32 s32, s32, 0x80000
    v_mfma_f32_16x16x32_bf16 v[248:251], a[28:31], a[160:163], v[248:251]
    s_add_u32 s34, s34, 0x4000
    v_mfma_f32_16x16x32_bf16 v[252:255], a[28:31], a[164:167], v[252:255]
    v_mfma_f32_16x16x32_bf16 a[120:123], a[28:31], a[168:171], a[120:123]
    v_mfma_f32_16x16x32_bf16 a[124:127], a[28:31], a[172:175], a[124:127]
    s_waitcnt vmcnt(16) lgkmcnt(0)
    s_barrier
    v_mfma_f32_16x16x32_bf16 v[192:195], a[32:35], a[176:179], v[192:195]
    v_mfma_f32_16x16x32_bf16 v[196:199], a[32:35], a[180:183], v[196:199]
    s_mov_b32 m0, s35
    v_mfma_f32_16x16x32_bf16 a[64:67], a[32:35], a[184:187], a[64:67]
    buffer_load_dwordx4 v1, s[20:23], s33 offen offset:0 sc1 lds
    v_mfma_f32_16x16x32_bf16 a[68:71], a[32:35], a[188:191], a[68:71]
    v_mfma_f32_16x16x32_bf16 v[200:203], a[36:39], a[176:179], v[200:203]
    v_mfma_f32_16x16x32_bf16 v[204:207], a[36:39], a[180:183], v[204:207]
    v_mfma_f32_16x16x32_bf16 a[72:75], a[36:39], a[184:187], a[72:75]
    v_mfma_f32_16x16x32_bf16 a[76:79], a[36:39], a[188:191], a[76:79]
    v_mfma_f32_16x16x32_bf16 v[208:211], a[40:43], a[176:179], v[208:211]
    buffer_load_dwordx4 v1, s[20:23], s33 offen offset:1024 sc1 lds
    v_mfma_f32_16x16x32_bf16 v[212:215], a[40:43], a[180:183], v[212:215]
    v_mfma_f32_16x16x32_bf16 a[80:83], a[40:43], a[184:187], a[80:83]
    v_mfma_f32_16x16x32_bf16 a[84:87], a[40:43], a[188:191], a[84:87]
    v_mfma_f32_16x16x32_bf16 v[216:219], a[44:47], a[176:179], v[216:219]
    v_mfma_f32_16x16x32_bf16 v[220:223], a[44:47], a[180:183], v[220:223]
    v_mfma_f32_16x16x32_bf16 a[88:91], a[44:47], a[184:187], a[88:91]
    buffer_load_dwordx4 v1, s[20:23], s33 offen offset:2048 sc1 lds
    v_mfma_f32_16x16x32_bf16 a[92:95], a[44:47], a[188:191], a[92:95]
    v_mfma_f32_16x16x32_bf16 v[224:227], a[48:51], a[176:179], v[224:227]
    v_mfma_f32_16x16x32_bf16 v[228:231], a[48:51], a[180:183], v[228:231]
    v_mfma_f32_16x16x32_bf16 a[96:99], a[48:51], a[184:187], a[96:99]
    v_mfma_f32_16x16x32_bf16 a[100:103], a[48:51], a[188:191], a[100:103]
    v_mfma_f32_16x16x32_bf16 v[232:235], a[52:55], a[176:179], v[232:235]
    v_mfma_f32_16x16x32_bf16 v[236:239], a[52:55], a[180:183], v[236:239]
    buffer_load_dwordx4 v1, s[20:23], s33 offen offset:3072 sc1 lds
    v_mfma_f32_16x16x32_bf16 a[104:107], a[52:55], a[184:187], a[104:107]
    v_mfma_f32_16x16x32_bf16 a[108:111], a[52:55], a[188:191], a[108:111]
    v_mfma_f32_16x16x32_bf16 v[240:243], a[56:59], a[176:179], v[240:243]
    v_mfma_f32_16x16x32_bf16 v[244:247], a[56:59], a[180:183], v[244:247]
    v_mfma_f32_16x16x32_bf16 a[112:115], a[56:59], a[184:187], a[112:115]
    v_mfma_f32_16x16x32_bf16 a[116:119], a[56:59], a[188:191], a[116:119]
    s_add_u32 s33, s33, 0x80000
    v_mfma_f32_16x16x32_bf16 v[248:251], a[60:63], a[176:179], v[248:251]
    s_add_u32 s35, s35, 0x4000
    v_mfma_f32_16x16x32_bf16 v[252:255], a[60:63], a[180:183], v[252:255]
    v_mfma_f32_16x16x32_bf16 a[120:123], a[60:63], a[184:187], a[120:123]
    v_mfma_f32_16x16x32_bf16 a[124:127], a[60:63], a[188:191], a[124:127]
    s_add_u32 s24, s6, 0x3000000
    s_addc_u32 s25, s7, 0
    s_and_b32 s25, s25, 0xffff
    s_mov_b32 s26, 0x1000000
    s_mov_b32 s27, 0x00020000
    s_load_dwordx2 s[44:45], s[0:1], 40
    s_load_dwordx2 s[46:47], s[0:1], 64
    s_load_dwordx4 s[48:51], s[0:1], 72
    s_mov_b32 s40, 0x3e0293ee
    s_mov_b32 s41, 0x3e0293ee
    s_mov_b32 m0, s34
    s_nop 0
    buffer_load_dwordx4 v1, s[16:19], s32 offen offset:0 sc1 lds
    buffer_load_dwordx4 v1, s[16:19], s32 offen offset:1024 sc1 lds
    buffer_load_dwordx4 v1, s[16:19], s32 offen offset:2048 sc1 lds
    buffer_load_dwordx4 v1, s[16:19], s32 offen offset:3072 sc1 lds
    s_mov_b32 m0, s35
    s_nop 0
    buffer_load_dwordx4 v1, s[20:23], s33 offen offset:0 sc1 lds
    buffer_load_dwordx4 v1, s[20:23], s33 offen offset:1024 sc1 lds
    buffer_load_dwordx4 v1, s[20:23], s33 offen offset:2048 sc1 lds
    buffer_load_dwordx4 v1, s[20:23], s33 offen offset:3072 sc1 lds
    s_add_u32 s32, s32, 0x80000
    s_add_u32 s33, s33, 0x80000
    s_add_u32 s34, s34, 0x4000
    s_and_b32 s34, s34, 0xffff
    s_add_u32 s35, s35, 0x4000
    s_and_b32 s35, s35, 0xffff
    s_or_b32 s35, s35, 0x10000
    v_mov_b32 v2, v1
    v_or_b32 v3, 0x10000, v1
    v_mov_b32 v56, v3
    s_mov_b32 s52, 0x4000
    s_mov_b32 s53, 0
    s_mul_i32 s62, s28, 63
    s_mul_i32 s31, s29, s29
    s_add_u32 s62, s62, s31
    s_sub_u32 s62, s62, 1
    s_lshl_b32 s62, s62, 12
    s_cmp_eq_u32 s30, 0
    s_cselect_b32 s14, 0x800000, 0x0
    s_max_u32 s14, s14, 0x700000
    s_cmp_eq_u32 s29, 0
    s_cselect_b32 s14, 0, s14
    s_cselect_b32 s62, 0, s62
    s_waitcnt vmcnt(16) lgkmcnt(0)
    s_barrier
    ds_read_b128 a[128:131], v2 offset:0
    ds_read_b128 a[132:135], v2 offset:1024
    ds_read_b128 a[136:139], v2 offset:2048
    ds_read_b128 a[140:143], v2 offset:3072
    ds_read_b128 a[144:147], v2 offset:4096
    ds_read_b128 a[148:151], v2 offset:5120
    ds_read_b128 a[152:155], v2 offset:6144
    ds_read_b128 a[156:159], v2 offset:7168
    ds_read_b128 a[160:163], v2 offset:8192
    ds_read_b128 a[164:167], v2 offset:9216
    ds_read_b128 a[168:171], v2 offset:10240
    ds_read_b128 a[172:175], v2 offset:11264
    ds_read_b128 a[176:179], v2 offset:12288
    ds_read_b128 a[180:183], v2 offset:13312
    ds_read_b128 a[184:187], v2 offset:14336
    ds_read_b128 a[188:191], v2 offset:15360
    s_cmp_eq_u32 s30, 1
    s_cselect_b64 s[12:13], s[46:47], s[44:45]
    s_cmp_eq_u32 s30, 2
    s_cselect_b64 s[12:13], s[48:49], s[12:13]
    s_cmp_eq_u32 s30, 3
    s_cselect_b64 s[12:13], s[50:51], s[12:13]
    s_and_b32 s13, s13, 0xffff
    v_accvgpr_read_b32 v128, a64
    v_accvgpr_read_b32 v129, a65
    v_accvgpr_read_b32 v130, a66
    v_accvgpr_read_b32 v131, a67
    v_pk_mul_f32 v[128:129], v[128:129], s[40:41]
    v_pk_mul_f32 v[130:131], v[130:131], s[40:41]
    v_cvt_pk_bf16_f32 v96, v128, v129
    v_cvt_pk_bf16_f32 v97, v130, v131
    v_accvgpr_read_b32 v132, a72
    v_accvgpr_read_b32 v133, a73
    v_accvgpr_read_b32 v134, a74
    v_accvgpr_read_b32 v135, a75
    v_pk_mul_f32 v[132:133], v[132:133], s[40:41]
    v_pk_mul_f32 v[134:135], v[134:135], s[40:41]
    v_cvt_pk_bf16_f32 v98, v132, v133
    v_cvt_pk_bf16_f32 v99, v134, v135
    v_accvgpr_read_b32 v136, a80
    v_accvgpr_read_b32 v137, a81
    v_accvgpr_read_b32 v138, a82
    v_accvgpr_read_b32 v139, a83
    v_pk_mul_f32 v[136:137], v[136:137], s[40:41]
    v_pk_mul_f32 v[138:139], v[138:139], s[40:41]
    v_cvt_pk_bf16_f32 v100, v136, v137
    v_cvt_pk_bf16_f32 v101, v138, v139
    v_accvgpr_read_b32 v140, a88
    v_accvgpr_read_b32 v141, a89
    v_accvgpr_read_b32 v142, a90
    v_accvgpr_read_b32 v143, a91
    v_pk_mul_f32 v[140:141], v[140:141], s[40:41]
    v_pk_mul_f32 v[142:143], v[142:143], s[40:41]
    v_cvt_pk_bf16_f32 v102, v140, v141
    v_cvt_pk_bf16_f32 v103, v142, v143
    v_accvgpr_read_b32 v128, a96
    v_accvgpr_read_b32 v129, a97
    v_accvgpr_read_b32 v130, a98
    v_accvgpr_read_b32 v131, a99
    v_pk_mul_f32 v[128:129], v[128:129], s[40:41]
    v_pk_mul_f32 v[130:131], v[130:131], s[40:41]
    v_cvt_pk_bf16_f32 v104, v128, v129
    v_cvt_pk_bf16_f32 v105, v130, v131
    v_accvgpr_read_b32 v132, a104
    v_accvgpr_read_b32 v133, a105
    v_accvgpr_read_b32 v134, a106
    v_accvgpr_read_b32 v135, a107
    v_pk_mul_f32 v[132:133], v[132:133], s[40:41]
    v_pk_mul_f32 v[134:135], v[134:135], s[40:41]
    v_cvt_pk_bf16_f32 v106, v132, v133
    v_cvt_pk_bf16_f32 v107, v134, v135
    v_accvgpr_read_b32 v136, a112
    v_accvgpr_read_b32 v137, a113
    v_accvgpr_read_b32 v138, a114
    v_accvgpr_read_b32 v139, a115
    v_pk_mul_f32 v[136:137], v[136:137], s[40:41]
    v_pk_mul_f32 v[138:139], v[138:139], s[40:41]
    v_cvt_pk_bf16_f32 v108, v136, v137
    v_cvt_pk_bf16_f32 v109, v138, v139
    v_accvgpr_read_b32 v140, a120
    v_accvgpr_read_b32 v141, a121
    v_accvgpr_read_b32 v142, a122
    v_accvgpr_read_b32 v143, a123
    v_pk_mul_f32 v[140:141], v[140:141], s[40:41]
    v_pk_mul_f32 v[142:143], v[142:143], s[40:41]
    v_cvt_pk_bf16_f32 v110, v140, v141
    v_cvt_pk_bf16_f32 v111, v142, v143
    v_accvgpr_read_b32 v128, a68
    v_accvgpr_read_b32 v129, a69
    v_accvgpr_read_b32 v130, a70
    v_accvgpr_read_b32 v131, a71
    v_pk_mul_f32 v[128:129], v[128:129], s[40:41]
    v_pk_mul_f32 v[130:131], v[130:131], s[40:41]
    v_cvt_pk_bf16_f32 v112, v128, v129
    v_cvt_pk_bf16_f32 v113, v130, v131
    v_accvgpr_read_b32 v132, a76
    v_accvgpr_read_b32 v133, a77
    v_accvgpr_read_b32 v134, a78
    v_accvgpr_read_b32 v135, a79
    v_pk_mul_f32 v[132:133], v[132:133], s[40:41]
    v_pk_mul_f32 v[134:135], v[134:135], s[40:41]
    v_cvt_pk_bf16_f32 v114, v132, v133
    v_cvt_pk_bf16_f32 v115, v134, v135
    v_accvgpr_read_b32 v136, a84
    v_accvgpr_read_b32 v137, a85
    v_accvgpr_read_b32 v138, a86
    v_accvgpr_read_b32 v139, a87
    v_pk_mul_f32 v[136:137], v[136:137], s[40:41]
    v_pk_mul_f32 v[138:139], v[138:139], s[40:41]
    v_cvt_pk_bf16_f32 v116, v136, v137
    v_cvt_pk_bf16_f32 v117, v138, v139
    v_accvgpr_read_b32 v140, a92
    v_accvgpr_read_b32 v141, a93
    v_accvgpr_read_b32 v142, a94
    v_accvgpr_read_b32 v143, a95
    v_pk_mul_f32 v[140:141], v[140:141], s[40:41]
    v_pk_mul_f32 v[142:143], v[142:143], s[40:41]
    v_cvt_pk_bf16_f32 v118, v140, v141
    v_cvt_pk_bf16_f32 v119, v142, v143
    v_accvgpr_read_b32 v128, a100
    v_accvgpr_read_b32 v129, a101
    v_accvgpr_read_b32 v130, a102
    v_accvgpr_read_b32 v131, a103
    v_pk_mul_f32 v[128:129], v[128:129], s[40:41]
    v_pk_mul_f32 v[130:131], v[130:131], s[40:41]
    v_cvt_pk_bf16_f32 v120, v128, v129
    v_cvt_pk_bf16_f32 v121, v130, v131
    v_accvgpr_read_b32 v132, a108
    v_accvgpr_read_b32 v133, a109
    v_accvgpr_read_b32 v134, a110
    v_accvgpr_read_b32 v135, a111
    v_pk_mul_f32 v[132:133], v[132:133], s[40:41]
    v_pk_mul_f32 v[134:135], v[134:135], s[40:41]
    v_cvt_pk_bf16_f32 v122, v132, v133
    v_cvt_pk_bf16_f32 v123, v134, v135
    v_accvgpr_read_b32 v136, a116
    v_accvgpr_read_b32 v137, a117
    v_accvgpr_read_b32 v138, a118
    v_accvgpr_read_b32 v139, a119
    v_pk_mul_f32 v[136:137], v[136:137], s[40:41]
    v_pk_mul_f32 v[138:139], v[138:139], s[40:41]
    v_cvt_pk_bf16_f32 v124, v136, v137
    v_cvt_pk_bf16_f32 v125, v138, v139
    v_accvgpr_read_b32 v140, a124
    v_accvgpr_read_b32 v141, a125
    v_accvgpr_read_b32 v142, a126
    v_accvgpr_read_b32 v143, a127
    v_pk_mul_f32 v[140:141], v[140:141], s[40:41]
    v_pk_mul_f32 v[142:143], v[142:143], s[40:41]
    v_cvt_pk_bf16_f32 v126, v140, v141
    v_cvt_pk_bf16_f32 v127, v142, v143
    v_pk_mul_f32 v[192:193], v[192:193], s[40:41]
    v_pk_mul_f32 v[194:195], v[194:195], s[40:41]
    v_cvt_pk_bf16_f32 v64, v192, v193
    v_cvt_pk_bf16_f32 v65, v194, v195
    v_pk_mul_f32 v[200:201], v[200:201], s[40:41]
    v_pk_mul_f32 v[202:203], v[202:203], s[40:41]
    v_cvt_pk_bf16_f32 v66, v200, v201
    v_cvt_pk_bf16_f32 v67, v202, v203
    v_pk_mul_f32 v[208:209], v[208:209], s[40:41]
    v_pk_mul_f32 v[210:211], v[210:211], s[40:41]
    v_cvt_pk_bf16_f32 v68, v208, v209
    v_cvt_pk_bf16_f32 v69, v210, v211
    v_pk_mul_f32 v[216:217], v[216:217], s[40:41]
    v_pk_mul_f32 v[218:219], v[218:219], s[40:41]
    v_cvt_pk_bf16_f32 v70, v216, v217
    v_cvt_pk_bf16_f32 v71, v218, v219
    v_pk_mul_f32 v[224:225], v[224:225], s[40:41]
    v_pk_mul_f32 v[226:227], v[226:227], s[40:41]
    v_cvt_pk_bf16_f32 v72, v224, v225
    v_cvt_pk_bf16_f32 v73, v226, v227
    v_pk_mul_f32 v[232:233], v[232:233], s[40:41]
    v_pk_mul_f32 v[234:235], v[234:235], s[40:41]
    v_cvt_pk_bf16_f32 v74, v232, v233
    v_cvt_pk_bf16_f32 v75, v234, v235
    v_pk_mul_f32 v[240:241], v[240:241], s[40:41]
    v_pk_mul_f32 v[242:243], v[242:243], s[40:41]
    v_cvt_pk_bf16_f32 v76, v240, v241
    v_cvt_pk_bf16_f32 v77, v242, v243
    v_pk_mul_f32 v[248:249], v[248:249], s[40:41]
    v_pk_mul_f32 v[250:251], v[250:251], s[40:41]
    v_cvt_pk_bf16_f32 v78, v248, v249
    v_cvt_pk_bf16_f32 v79, v250, v251
    v_pk_mul_f32 v[196:197], v[196:197], s[40:41]
    v_pk_mul_f32 v[198:199], v[198:199], s[40:41]
    v_cvt_pk_bf16_f32 v80, v196, v197
    v_cvt_pk_bf16_f32 v81, v198, v199
    v_pk_mul_f32 v[204:205], v[204:205], s[40:41]
    v_pk_mul_f32 v[206:207], v[206:207], s[40:41]
    v_cvt_pk_bf16_f32 v82, v204, v205
    v_cvt_pk_bf16_f32 v83, v206, v207
    v_pk_mul_f32 v[212:213], v[212:213], s[40:41]
    v_pk_mul_f32 v[214:215], v[214:215], s[40:41]
    v_cvt_pk_bf16_f32 v84, v212, v213
    v_cvt_pk_bf16_f32 v85, v214, v215
    v_pk_mul_f32 v[220:221], v[220:221], s[40:41]
    v_pk_mul_f32 v[222:223], v[222:223], s[40:41]
    v_cvt_pk_bf16_f32 v86, v220, v221
    v_cvt_pk_bf16_f32 v87, v222, v223
    v_pk_mul_f32 v[228:229], v[228:229], s[40:41]
    v_pk_mul_f32 v[230:231], v[230:231], s[40:41]
    v_cvt_pk_bf16_f32 v88, v228, v229
    v_cvt_pk_bf16_f32 v89, v230, v231
    v_pk_mul_f32 v[236:237], v[236:237], s[40:41]
    v_pk_mul_f32 v[238:239], v[238:239], s[40:41]
    v_cvt_pk_bf16_f32 v90, v236, v237
    v_cvt_pk_bf16_f32 v91, v238, v239
    v_pk_mul_f32 v[244:245], v[244:245], s[40:41]
    v_pk_mul_f32 v[246:247], v[246:247], s[40:41]
    v_cvt_pk_bf16_f32 v92, v244, v245
    v_cvt_pk_bf16_f32 v93, v246, v247
    v_pk_mul_f32 v[252:253], v[252:253], s[40:41]
    v_pk_mul_f32 v[254:255], v[254:255], s[40:41]
    v_cvt_pk_bf16_f32 v94, v252, v253
    v_cvt_pk_bf16_f32 v95, v254, v255
    v_add_u32 v2, 0x4000, v1
    v_mov_b32 v8, 0
    v_mov_b32 v232, 0
    v_mov_b32 v9, 0
    v_mov_b32 v233, 0
    v_mov_b32 v10, 0
    v_mov_b32 v234, 0
    v_mov_b32 v11, 0
    v_mov_b32 v235, 0
    s_mov_b32 s36, 0
    s_mov_b32 s37, 0x40004000
    v_mfma_f32_32x32x16_bf16 v[16:31], v[232:235], v[232:235], 0
    v_mfma_f32_32x32x16_bf16 v[32:47], v[232:235], v[232:235], 0
    v_and_b32 v6, 0xf0, v1
    v_cmp_eq_u32 vcc, 0, v6
    v_mov_b32 v6, 0x3f803f80
    v_lshlrev_b32 v228, 2, v1
    v_cndmask_b32 v60, 0, v6, vcc
    v_cndmask_b32 v61, 0, v6, vcc
    v_cndmask_b32 v62, 0, v6, vcc
    v_cndmask_b32 v63, 0, v6, vcc
    v_mov_b32 v12, 0
    v_mov_b32 v13, 0
    v_mov_b32 v14, 0
    v_mov_b32 v15, 0
    v_mov_b32 v48, 0
    v_mov_b32 v49, 0
    v_mov_b32 v50, 0
    v_mov_b32 v51, 0
    v_mov_b32 v248, 0
    v_mov_b32 v249, 0
    v_mov_b32 v250, 0
    v_mov_b32 v251, 0
    v_mov_b32 v252, 0
    v_mov_b32 v253, 0
    v_mov_b32 v254, 0
    v_mov_b32 v255, 0
    s_waitcnt lgkmcnt(0)
    s_cmp_ge_u32 s36, s42
    s_cbranch_scc1 k2_prep_48
k2_prepret_49:
    v_mfma_f32_16x16x32_bf16 v[128:131], a[128:131], v[64:67], v[16:19]
    v_mfma_f32_16x16x32_bf16 v[132:135], a[128:131], v[80:83], v[20:23]
    v_mfma_f32_16x16x32_bf16 v[136:139], a[128:131], v[96:99], v[24:27]
    v_mfma_f32_16x16x32_bf16 v[140:143], a[128:131], v[112:115], v[28:31]
    s_add_u32 s36, s36, 32
    v_mfma_f32_16x16x32_bf16 v[128:131], a[132:135], v[68:71], v[128:131]
    v_mfma_f32_16x16x32_bf16 v[132:135], a[132:135], v[84:87], v[132:135]
    v_mfma_f32_16x16x32_bf16 v[136:139], a[132:135], v[100:103], v[136:139]
    v_mfma_f32_16x16x32_bf16 v[140:143], a[132:135], v[116:119], v[140:143]
    v_mfma_f32_16x16x32_bf16 v[128:131], a[136:139], v[72:75], v[128:131]
    v_mfma_f32_16x16x32_bf16 v[132:135], a[136:139], v[88:91], v[132:135]
    v_mfma_f32_16x16x32_bf16 v[136:139], a[136:139], v[104:107], v[136:139]
    v_mfma_f32_16x16x32_bf16 v[140:143], a[136:139], v[120:123], v[140:143]
    v_mfma_f32_16x16x32_bf16 v[128:131], a[140:143], v[76:79], v[128:131]
    v_mfma_f32_16x16x32_bf16 v[132:135], a[140:143], v[92:95], v[132:135]
    v_mfma_f32_16x16x32_bf16 v[136:139], a[140:143], v[108:111], v[136:139]
    v_mfma_f32_16x16x32_bf16 v[140:143], a[140:143], v[124:127], v[140:143]
    v_mfma_f32_16x16x32_bf16 v[144:147], a[144:147], v[64:67], v[32:35]
    v_mfma_f32_16x16x32_bf16 v[148:151], a[144:147], v[80:83], v[36:39]
    v_mfma_f32_16x16x32_bf16 v[152:155], a[144:147], v[96:99], v[40:43]
    v_mfma_f32_16x16x32_bf16 v[156:159], a[144:147], v[112:115], v[44:47]
    v_mfma_f32_16x16x32_bf16 v[144:147], a[148:151], v[68:71], v[144:147]
    v_mfma_f32_16x16x32_bf16 v[148:151], a[148:151], v[84:87], v[148:151]
    v_mfma_f32_16x16x32_bf16 v[152:155], a[148:151], v[100:103], v[152:155]
    v_mfma_f32_16x16x32_bf16 v[156:159], a[148:151], v[116:119], v[156:159]
    v_mfma_f32_16x16x32_bf16 v[144:147], a[152:155], v[72:75], v[144:147]
    v_mfma_f32_16x16x32_bf16 v[148:151], a[152:155], v[88:91], v[148:151]
    v_mfma_f32_16x16x32_bf16 v[152:155], a[152:155], v[104:107], v[152:155]
    v_mfma_f32_16x16x32_bf16 v[156:159], a[152:155], v[120:123], v[156:159]
    v_mfma_f32_16x16x32_bf16 v[144:147], a[156:159], v[76:79], v[144:147]
    v_mfma_f32_16x16x32_bf16 v[148:151], a[156:159], v[92:95], v[148:151]
    v_mfma_f32_16x16x32_bf16 v[152:155], a[156:159], v[108:111], v[152:155]
    v_mfma_f32_16x16x32_bf16 v[156:159], a[156:159], v[124:127], v[156:159]
    v_mfma_f32_32x32x16_bf16 a[0:15], v[232:235], v[232:235], 0
    v_mfma_f32_32x32x16_bf16 a[16:31], v[232:235], v[232:235], 0
    v_mfma_f32_32x32x16_bf16 a[32:47], v[232:235], v[232:235], 0
    v_mfma_f32_32x32x16_bf16 a[48:63], v[232:235], v[232:235], 0
    v_mfma_f32_32x32x16_bf16 a[64:79], v[232:235], v[232:235], 0
    v_mfma_f32_32x32x16_bf16 a[80:95], v[232:235], v[232:235], 0
    v_mfma_f32_32x32x16_bf16 a[96:111], v[232:235], v[232:235], 0
    v_mfma_f32_32x32x16_bf16 a[112:127], v[232:235], v[232:235], 0
    v_max_f32 v52, v128, v129
    v_max3_f32 v52, v52, v130, v131
    v_max3_f32 v52, v52, v144, v145
    v_max3_f32 v52, v52, v146, v147
    v_max_f32 v53, v132, v133
    v_max3_f32 v53, v53, v134, v135
    v_max3_f32 v53, v53, v148, v149
    v_max3_f32 v53, v53, v150, v151
    v_max_f32 v54, v136, v137
    v_max3_f32 v54, v54, v138, v139
    v_max3_f32 v54, v54, v152, v153
    v_max3_f32 v54, v54, v154, v155
    v_max_f32 v55, v140, v141
    v_max3_f32 v55, v55, v142, v143
    v_max3_f32 v55, v55, v156, v157
    v_max3_f32 v55, v55, v158, v159
    v_mov_b32 v224, v52
    v_mov_b32 v225, v53
    v_mov_b32 v226, v54
    v_mov_b32 v227, v55
    s_nop 1
    v_permlane16_swap_b32 v52, v224
    v_permlane16_swap_b32 v53, v225
    v_permlane16_swap_b32 v54, v226
    v_permlane16_swap_b32 v55, v227
    s_nop 1
    v_max_f32 v52, v52, v224
    v_max_f32 v53, v53, v225
    v_max_f32 v54, v54, v226
    v_max_f32 v55, v55, v227
    v_mov_b32 v224, v52
    v_mov_b32 v225, v53
    v_mov_b32 v226, v54
    v_mov_b32 v227, v55
    s_nop 1
    v_permlane32_swap_b32 v52, v224
    v_permlane32_swap_b32 v53, v225
    v_permlane32_swap_b32 v54, v226
    v_permlane32_swap_b32 v55, v227
    s_nop 1
    v_max_f32 v52, v52, v224
    v_max_f32 v53, v53, v225
    v_max_f32 v54, v54, v226
    v_max_f32 v55, v55, v227
    v_add_f32 v52, 0x41400000, v52
    v_add_f32 v53, 0x41400000, v53
    v_add_f32 v54, 0x41400000, v54
    v_add_f32 v55, 0x41400000, v55
    v_sub_f32 v16, 0, v52
    v_sub_f32 v17, 0, v52
    v_sub_f32 v18, 0, v52
    v_sub_f32 v19, 0, v52
    v_sub_f32 v20, 0, v53
    v_sub_f32 v21, 0, v53
    v_sub_f32 v22, 0, v53
    v_sub_f32 v23, 0, v53
    v_sub_f32 v24, 0, v54
    v_sub_f32 v25, 0, v54
    v_sub_f32 v26, 0, v54
    v_sub_f32 v27, 0, v54
    v_sub_f32 v28, 0, v55
    v_sub_f32 v29, 0, v55
    v_sub_f32 v30, 0, v55
    v_sub_f32 v31, 0, v55
    v_sub_f32 v32, 0, v52
    v_sub_f32 v33, 0, v52
    v_sub_f32 v34, 0, v52
    v_sub_f32 v35, 0, v52
    v_sub_f32 v36, 0, v53
    v_sub_f32 v37, 0, v53
    v_sub_f32 v38, 0, v53
    v_sub_f32 v39, 0, v53
    v_sub_f32 v40, 0, v54
    v_sub_f32 v41, 0, v54
    v_sub_f32 v42, 0, v54
    v_sub_f32 v43, 0, v54
    v_sub_f32 v44, 0, v55
    v_sub_f32 v45, 0, v55
    v_sub_f32 v46, 0, v55
    v_sub_f32 v47, 0, v55
    v_sub_f32 v8, 0, v52
    v_sub_f32 v9, 0, v53
    v_sub_f32 v10, 0, v54
    v_sub_f32 v11, 0, v55
    s_cmp_ge_u32 s36, s42
    s_cbranch_scc1 k2_prep_50
k2_prepret_51:
    v_mfma_f32_16x16x32_bf16 v[160:163], a[160:163], v[64:67], v[16:19]
    v_sub_f32 v128, v128, v52
    v_sub_f32 v129, v129, v52
    v_sub_f32 v130, v130, v52
    v_mfma_f32_16x16x32_bf16 v[164:167], a[160:163], v[80:83], v[20:23]
    v_exp_f32 v232, v128
    v_sub_f32 v131, v131, v52
    v_mfma_f32_16x16x32_bf16 v[168:171], a[160:163], v[96:99], v[24:27]
    v_exp_f32 v233, v129
    v_sub_f32 v144, v144, v52
    v_mfma_f32_16x16x32_bf16 v[172:175], a[160:163], v[112:115], v[28:31]
    s_add_u32 s36, s36, 32
    v_exp_f32 v234, v130
    v_sub_f32 v145, v145, v52
    v_mfma_f32_16x16x32_bf16 v[160:163], a[164:167], v[68:71], v[160:163]
    v_cvt_pk_bf16_f32 v192, v232, v233
    v_exp_f32 v235, v131
    v_mfma_f32_16x16x32_bf16 v[164:167], a[164:167], v[84:87], v[164:167]
    v_exp_f32 v236, v144
    v_sub_f32 v146, v146, v52
    v_mfma_f32_16x16x32_bf16 v[168:171], a[164:167], v[100:103], v[168:171]
    v_sub_f32 v147, v147, v52
    v_cvt_pk_bf16_f32 v193, v234, v235
    v_sub_f32 v132, v132, v53
    v_mfma_f32_16x16x32_bf16 v[172:175], a[164:167], v[116:119], v[172:175]
    v_exp_f32 v237, v145
    v_sub_f32 v133, v133, v53
    v_mfma_f32_16x16x32_bf16 v[160:163], a[168:171], v[72:75], v[160:163]
    v_exp_f32 v238, v146
    v_cvt_pk_bf16_f32 v194, v236, v237
    v_mfma_f32_16x16x32_bf16 v[164:167], a[168:171], v[88:91], v[164:167]
    v_exp_f32 v239, v147
    v_or3_b32 v57, v192, v193, v194
    v_mfma_f32_16x16x32_bf16 v[168:171], a[168:171], v[104:107], v[168:171]
    v_exp_f32 v240, v132
    v_sub_f32 v134, v134, v53
    v_mfma_f32_16x16x32_bf16 v[172:175], a[168:171], v[120:123], v[172:175]
    v_sub_f32 v135, v135, v53
    v_cvt_pk_bf16_f32 v195, v238, v239
    v_sub_f32 v148, v148, v53
    v_mfma_f32_16x16x32_bf16 v[160:163], a[172:175], v[76:79], v[160:163]
    v_exp_f32 v241, v133
    v_sub_f32 v149, v149, v53
    v_mfma_f32_16x16x32_bf16 v[164:167], a[172:175], v[92:95], v[164:167]
    v_exp_f32 v242, v134
    v_cvt_pk_bf16_f32 v196, v240, v241
    v_mfma_f32_16x16x32_bf16 v[168:171], a[172:175], v[108:111], v[168:171]
    v_exp_f32 v243, v135
    v_or3_b32 v57, v57, v195, v196
    v_mfma_f32_16x16x32_bf16 v[172:175], a[172:175], v[124:127], v[172:175]
    v_exp_f32 v244, v148
    v_sub_f32 v150, v150, v53
    v_mfma_f32_16x16x32_bf16 v[176:179], a[176:179], v[64:67], v[32:35]
    v_sub_f32 v151, v151, v53
    v_cvt_pk_bf16_f32 v197, v242, v243
    v_exp_f32 v245, v149
    v_mfma_f32_16x16x32_bf16 v[180:183], a[176:179], v[80:83], v[36:39]
    v_exp_f32 v246, v150
    v_sub_f32 v136, v136, v54
    v_mfma_f32_16x16x32_bf16 v[184:187], a[176:179], v[96:99], v[40:43]
    v_sub_f32 v137, v137, v54
    v_cvt_pk_bf16_f32 v198, v244, v245
    v_exp_f32 v247, v151
    v_mfma_f32_16x16x32_bf16 v[188:191], a[176:179], v[112:115], v[44:47]
    v_or3_b32 v57, v57, v197, v198
    v_exp_f32 v232, v136
    v_mfma_f32_16x16x32_bf16 v[176:179], a[180:183], v[68:71], v[176:179]
    v_sub_f32 v138, v138, v54
    v_sub_f32 v139, v139, v54
    v_cvt_pk_bf16_f32 v199, v246, v247
    v_mfma_f32_16x16x32_bf16 v[180:183], a[180:183], v[84:87], v[180:183]
    ds_read_b128 a[192:195], v3 offset:0
    v_exp_f32 v233, v137
    v_mfma_f32_16x16x32_bf16 v[184:187], a[180:183], v[100:103], v[184:187]
    v_exp_f32 v234, v138
    v_sub_f32 v152, v152, v54
    v_mfma_f32_16x16x32_bf16 v[188:191], a[180:183], v[116:119], v[188:191]
    v_sub_f32 v153, v153, v54
    v_cvt_pk_bf16_f32 v200, v232, v233
    v_exp_f32 v235, v139
    v_mfma_f32_16x16x32_bf16 v[176:179], a[184:187], v[72:75], v[176:179]
    v_or3_b32 v57, v57, v199, v200
    v_exp_f32 v236, v152
    v_mfma_f32_16x16x32_bf16 v[180:183], a[184:187], v[88:91], v[180:183]
    v_sub_f32 v154, v154, v54
    v_sub_f32 v155, v155, v54
    v_cvt_pk_bf16_f32 v201, v234, v235
    v_mfma_f32_16x16x32_bf16 v[184:187], a[184:187], v[104:107], v[184:187]
    ds_read_b128 a[196:199], v3 offset:1024
    v_exp_f32 v237, v153
    v_mfma_f32_16x16x32_bf16 v[188:191], a[184:187], v[120:123], v[188:191]
    v_exp_f32 v238, v154
    v_sub_f32 v140, v140, v55
    v_mfma_f32_16x16x32_bf16 v[176:179], a[188:191], v[76:79], v[176:179]
    v_sub_f32 v141, v141, v55
    v_cvt_pk_bf16_f32 v202, v236, v237
    v_exp_f32 v239, v155
    v_mfma_f32_16x16x32_bf16 v[180:183], a[188:191], v[92:95], v[180:183]
    v_or3_b32 v57, v57, v201, v202
    v_exp_f32 v240, v140
    v_mfma_f32_16x16x32_bf16 v[184:187], a[188:191], v[108:111], v[184:187]
    v_sub_f32 v142, v142, v55
    v_sub_f32 v143, v143, v55
    v_cvt_pk_bf16_f32 v203, v238, v239
    v_mfma_f32_16x16x32_bf16 v[188:191], a[188:191], v[124:127], v[188:191]
    s_waitcnt vmcnt(8)
    s_barrier
    ds_read_b128 a[200:203], v3 offset:2048
    v_exp_f32 v241, v141
    v_exp_f32 v242, v142
    v_sub_f32 v156, v156, v55
    v_sub_f32 v157, v157, v55
    v_cvt_pk_bf16_f32 v204, v240, v241
    v_exp_f32 v243, v143
    v_or3_b32 v57, v57, v203, v204
    v_exp_f32 v244, v156
    v_sub_f32 v158, v158, v55
    v_sub_f32 v159, v159, v55
    v_cvt_pk_bf16_f32 v205, v242, v243
    v_exp_f32 v245, v157
    ds_read_b128 a[204:207], v3 offset:3072
    v_exp_f32 v246, v158
    v_cvt_pk_bf16_f32 v206, v244, v245
    v_exp_f32 v247, v159
    v_or3_b32 v57, v57, v205, v206
    v_cvt_pk_bf16_f32 v207, v246, v247
    v_bitop3_b32 v57, v57, v207, s37 bitop3:0xa8
    v_cmp_ne_u32 vcc, 0, v57
    s_cbranch_vccnz k2_rare_52
k2_ret_53:
    s_lshl_b32 s63, s29, 1
    s_add_u32 s63, s63, 1
k2_dloop_54:
    v_mfma_f32_16x16x32_bf16 v[12:15], v[60:63], v[192:195], v[12:15]
    ds_read_b128 a[208:211], v3 offset:4096
    v_mfma_f32_16x16x32_bf16 v[48:51], v[60:63], v[196:199], v[48:51]
    v_exp_f32 v232, v160
    v_mfma_f32_16x16x32_bf16 v[248:251], v[60:63], v[200:203], v[248:251]
    s_mov_b32 m0, s34
    v_exp_f32 v233, v161
    v_mfma_f32_16x16x32_bf16 v[252:255], v[60:63], v[204:207], v[252:255]
    s_waitcnt lgkmcnt(3)
    buffer_load_dwordx4 v1, s[16:19], s32 offen offset:0 sc1 lds
    ds_read_b128 a[212:215], v3 offset:5120
    v_mfma_f32_16x16x32_bf16 a[0:3], a[192:195], v[192:195], a[0:3]
    s_add_u32 s53, s53, 8192
    v_exp_f32 v234, v162
    v_mfma_f32_16x16x32_bf16 a[4:7], a[192:195], v[196:199], a[4:7]
    s_and_b32 s53, s53, 0xffff
    v_cvt_pk_bf16_f32 v208, v232, v233
    v_mfma_f32_16x16x32_bf16 a[8:11], a[192:195], v[200:203], a[8:11]
    v_exp_f32 v235, v163
    v_mfma_f32_16x16x32_bf16 a[12:15], a[192:195], v[204:207], a[12:15]
    ds_read_b128 a[216:219], v3 offset:6144
    v_cvt_pk_bf16_f32 v209, v234, v235
    v_mfma_f32_16x16x32_bf16 a[16:19], a[196:199], v[192:195], a[16:19]
    v_exp_f32 v236, v176
    v_mfma_f32_16x16x32_bf16 a[20:23], a[196:199], v[196:199], a[20:23]
    v_exp_f32 v237, v177
    v_mfma_f32_16x16x32_bf16 a[24:27], a[196:199], v[200:203], a[24:27]
    v_mfma_f32_16x16x32_bf16 a[28:31], a[196:199], v[204:207], a[28:31]
    s_waitcnt lgkmcnt(3)
    ds_read_b128 a[220:223], v3 offset:7168
    v_cvt_pk_bf16_f32 v210, v236, v237
    v_mfma_f32_16x16x32_bf16 a[32:35], a[200:203], v[192:195], a[32:35]
    v_exp_f32 v238, v178
    v_mfma_f32_16x16x32_bf16 a[36:39], a[200:203], v[196:199], a[36:39]
    v_exp_f32 v239, v179
    v_mfma_f32_16x16x32_bf16 a[40:43], a[200:203], v[200:203], a[40:43]
    v_or3_b32 v57, v208, v209, v210
    v_mfma_f32_16x16x32_bf16 a[44:47], a[200:203], v[204:207], a[44:47]
    v_exp_f32 v240, v164
    v_mfma_f32_16x16x32_bf16 a[48:51], a[204:207], v[192:195], a[48:51]
    s_add_u32 s34, s34, 0x4000
    v_cvt_pk_bf16_f32 v211, v238, v239
    v_mfma_f32_16x16x32_bf16 a[52:55], a[204:207], v[196:199], a[52:55]
    buffer_load_dwordx4 v1, s[16:19], s32 offen offset:1024 sc1 lds
    ds_read_b128 a[128:131], v2 offset:0
    v_mfma_f32_16x16x32_bf16 a[56:59], a[204:207], v[200:203], a[56:59]
    v_exp_f32 v241, v165
    v_mfma_f32_16x16x32_bf16 a[60:63], a[204:207], v[204:207], a[60:63]
    s_waitcnt lgkmcnt(3)
    v_add_u32 v3, s53, v56
    v_cvt_pk_bf16_f32 v212, v240, v241
    v_mfma_f32_16x16x32_bf16 a[64:67], a[208:211], v[192:195], a[64:67]
    v_exp_f32 v242, v166
    v_mfma_f32_16x16x32_bf16 a[68:71], a[208:211], v[196:199], a[68:71]
    ds_read_b128 a[132:135], v2 offset:1024
    v_or3_b32 v57, v57, v211, v212
    v_mfma_f32_16x16x32_bf16 a[72:75], a[208:211], v[200:203], a[72:75]
    v_exp_f32 v243, v167
    v_mfma_f32_16x16x32_bf16 a[76:79], a[208:211], v[204:207], a[76:79]
    s_cmp_ge_u32 s36, s42
    s_cbranch_scc1 k2_prep_55
k2_prepret_56:
    v_mfma_f32_16x16x32_bf16 a[80:83], a[212:215], v[192:195], a[80:83]
    v_exp_f32 v244, v180
    v_mfma_f32_16x16x32_bf16 a[84:87], a[212:215], v[196:199], a[84:87]
    ds_read_b128 a[136:139], v2 offset:2048
    v_cvt_pk_bf16_f32 v213, v242, v243
    v_mfma_f32_16x16x32_bf16 a[88:91], a[212:215], v[200:203], a[88:91]
    v_exp_f32 v245, v181
    v_mfma_f32_16x16x32_bf16 a[92:95], a[212:215], v[204:207], a[92:95]
    s_waitcnt lgkmcnt(3)
    v_exp_f32 v246, v182
    v_mfma_f32_16x16x32_bf16 a[96:99], a[216:219], v[192:195], a[96:99]
    ds_read_b128 a[140:143], v2 offset:3072
    v_cvt_pk_bf16_f32 v214, v244, v245
    v_mfma_f32_16x16x32_bf16 a[100:103], a[216:219], v[196:199], a[100:103]
    v_exp_f32 v247, v183
    v_mfma_f32_16x16x32_bf16 a[104:107], a[216:219], v[200:203], a[104:107]
    v_or3_b32 v57, v57, v213, v214
    v_mfma_f32_16x16x32_bf16 a[108:111], a[216:219], v[204:207], a[108:111]
    s_and_b32 s34, s34, 0xffff
    v_exp_f32 v232, v168
    v_mfma_f32_16x16x32_bf16 a[112:115], a[220:223], v[192:195], a[112:115]
    ds_read_b128 a[144:147], v2 offset:4096
    v_cvt_pk_bf16_f32 v215, v246, v247
    v_mfma_f32_16x16x32_bf16 a[116:119], a[220:223], v[196:199], a[116:119]
    buffer_load_dwordx4 v1, s[16:19], s32 offen offset:2048 sc1 lds
    v_mfma_f32_16x16x32_bf16 a[120:123], a[220:223], v[200:203], a[120:123]
    v_exp_f32 v233, v169
    v_mfma_f32_16x16x32_bf16 a[124:127], a[220:223], v[204:207], a[124:127]
    s_waitcnt lgkmcnt(3)
    v_exp_f32 v234, v170
    v_mfma_f32_16x16x32_bf16 v[128:131], a[128:131], v[64:67], v[16:19]
    v_cvt_pk_bf16_f32 v216, v232, v233
    v_mfma_f32_16x16x32_bf16 v[132:135], a[128:131], v[80:83], v[20:23]
    ds_read_b128 a[148:151], v2 offset:5120
    v_or3_b32 v57, v57, v215, v216
    v_mfma_f32_16x16x32_bf16 v[136:139], a[128:131], v[96:99], v[24:27]
    v_exp_f32 v235, v171
    v_mfma_f32_16x16x32_bf16 v[140:143], a[128:131], v[112:115], v[28:31]
    s_add_u32 s36, s36, 32
    v_exp_f32 v236, v184
    v_mfma_f32_16x16x32_bf16 v[128:131], a[132:135], v[68:71], v[128:131]
    v_cvt_pk_bf16_f32 v217, v234, v235
    v_mfma_f32_16x16x32_bf16 v[132:135], a[132:135], v[84:87], v[132:135]
    ds_read_b128 a[152:155], v2 offset:6144
    v_mfma_f32_16x16x32_bf16 v[136:139], a[132:135], v[100:103], v[136:139]
    v_exp_f32 v237, v185
    v_mfma_f32_16x16x32_bf16 v[140:143], a[132:135], v[116:119], v[140:143]
    s_waitcnt lgkmcnt(3)
    v_exp_f32 v238, v186
    v_mfma_f32_16x16x32_bf16 v[128:131], a[136:139], v[72:75], v[128:131]
    s_add_u32 s52, s52, 8192
    v_cvt_pk_bf16_f32 v218, v236, v237
    v_mfma_f32_16x16x32_bf16 v[132:135], a[136:139], v[88:91], v[132:135]
    ds_read_b128 a[156:159], v2 offset:7168
    v_or3_b32 v57, v57, v217, v218
    v_mfma_f32_16x16x32_bf16 v[136:139], a[136:139], v[104:107], v[136:139]
    s_and_b32 s52, s52, 0xffff
    v_exp_f32 v239, v187
    v_mfma_f32_16x16x32_bf16 v[140:143], a[136:139], v[120:123], v[140:143]
    v_exp_f32 v240, v172
    v_mfma_f32_16x16x32_bf16 v[128:131], a[140:143], v[76:79], v[128:131]
    v_cvt_pk_bf16_f32 v219, v238, v239
    v_mfma_f32_16x16x32_bf16 v[132:135], a[140:143], v[92:95], v[132:135]
    buffer_load_dwordx4 v1, s[16:19], s32 offen offset:3072 sc1 lds
    v_mfma_f32_16x16x32_bf16 v[136:139], a[140:143], v[108:111], v[136:139]
    s_add_u32 s32, s32, 0x80000
    v_exp_f32 v241, v173
    v_mfma_f32_16x16x32_bf16 v[140:143], a[140:143], v[124:127], v[140:143]
    s_waitcnt lgkmcnt(2)
    ds_read_b128 a[192:195], v3 offset:0
    v_cvt_pk_bf16_f32 v220, v240, v241
    v_mfma_f32_16x16x32_bf16 v[144:147], a[144:147], v[64:67], v[32:35]
    v_exp_f32 v242, v174
    v_mfma_f32_16x16x32_bf16 v[148:151], a[144:147], v[80:83], v[36:39]
    v_add_u32 v2, s52, v1
    v_or3_b32 v57, v57, v219, v220
    v_mfma_f32_16x16x32_bf16 v[152:155], a[144:147], v[96:99], v[40:43]
    v_exp_f32 v243, v175
    v_mfma_f32_16x16x32_bf16 v[156:159], a[144:147], v[112:115], v[44:47]
    ds_read_b128 a[196:199], v3 offset:1024
    v_cvt_pk_bf16_f32 v221, v242, v243
    v_mfma_f32_16x16x32_bf16 v[144:147], a[148:151], v[68:71], v[144:147]
    v_exp_f32 v244, v188
    v_mfma_f32_16x16x32_bf16 v[148:151], a[148:151], v[84:87], v[148:151]
    v_exp_f32 v245, v189
    v_mfma_f32_16x16x32_bf16 v[152:155], a[148:151], v[100:103], v[152:155]
    ds_read_b128 a[200:203], v3 offset:2048
    v_mfma_f32_16x16x32_bf16 v[156:159], a[148:151], v[116:119], v[156:159]
    s_waitcnt lgkmcnt(3)
    v_exp_f32 v246, v190
    v_mfma_f32_16x16x32_bf16 v[144:147], a[152:155], v[72:75], v[144:147]
    v_cvt_pk_bf16_f32 v222, v244, v245
    v_mfma_f32_16x16x32_bf16 v[148:151], a[152:155], v[88:91], v[148:151]
    v_exp_f32 v247, v191
    v_mfma_f32_16x16x32_bf16 v[152:155], a[152:155], v[104:107], v[152:155]
    ds_read_b128 a[204:207], v3 offset:3072
    v_or3_b32 v57, v57, v221, v222
    v_mfma_f32_16x16x32_bf16 v[156:159], a[152:155], v[120:123], v[156:159]
    v_cvt_pk_bf16_f32 v223, v246, v247
    v_mfma_f32_16x16x32_bf16 v[144:147], a[156:159], v[76:79], v[144:147]
    v_mfma_f32_16x16x32_bf16 v[148:151], a[156:159], v[92:95], v[148:151]
    v_bitop3_b32 v57, v57, v223, s37 bitop3:0xa8
    v_cmp_ne_u32 vcc, 0, v57
    v_mfma_f32_16x16x32_bf16 v[152:155], a[156:159], v[108:111], v[152:155]
    v_mfma_f32_16x16x32_bf16 v[156:159], a[156:159], v[124:127], v[156:159]
    s_cbranch_vccnz k2_rare_57
k2_ret_58:
    v_mfma_f32_16x16x32_bf16 v[12:15], v[60:63], v[208:211], v[12:15]
    ds_read_b128 a[208:211], v3 offset:4096
    v_mfma_f32_16x16x32_bf16 v[48:51], v[60:63], v[212:215], v[48:51]
    v_exp_f32 v232, v128
    v_mfma_f32_16x16x32_bf16 v[248:251], v[60:63], v[216:219], v[248:251]
    s_mov_b32 m0, s35
    v_exp_f32 v233, v129
    v_mfma_f32_16x16x32_bf16 v[252:255], v[60:63], v[220:223], v[252:255]
    s_waitcnt lgkmcnt(3)
    buffer_load_dwordx4 v1, s[20:23], s33 offen offset:0 sc1 lds
    ds_read_b128 a[212:215], v3 offset:5120
    v_mfma_f32_16x16x32_bf16 a[0:3], a[192:195], v[208:211], a[0:3]
    s_add_u32 s53, s53, 8192
    v_exp_f32 v234, v130
    v_mfma_f32_16x16x32_bf16 a[4:7], a[192:195], v[212:215], a[4:7]
    s_and_b32 s53, s53, 0xffff
    v_cvt_pk_bf16_f32 v192, v232, v233
    v_mfma_f32_16x16x32_bf16 a[8:11], a[192:195], v[216:219], a[8:11]
    v_exp_f32 v235, v131
    v_mfma_f32_16x16x32_bf16 a[12:15], a[192:195], v[220:223], a[12:15]
    ds_read_b128 a[216:219], v3 offset:6144
    v_cvt_pk_bf16_f32 v193, v234, v235
    v_mfma_f32_16x16x32_bf16 a[16:19], a[196:199], v[208:211], a[16:19]
    v_exp_f32 v236, v144
    v_mfma_f32_16x16x32_bf16 a[20:23], a[196:199], v[212:215], a[20:23]
    v_exp_f32 v237, v145
    v_mfma_f32_16x16x32_bf16 a[24:27], a[196:199], v[216:219], a[24:27]
    v_mfma_f32_16x16x32_bf16 a[28:31], a[196:199], v[220:223], a[28:31]
    s_waitcnt lgkmcnt(3)
    ds_read_b128 a[220:223], v3 offset:7168
    v_cvt_pk_bf16_f32 v194, v236, v237
    v_mfma_f32_16x16x32_bf16 a[32:35], a[200:203], v[208:211], a[32:35]
    v_exp_f32 v238, v146
    v_mfma_f32_16x16x32_bf16 a[36:39], a[200:203], v[212:215], a[36:39]
    s_add_u32 s35, s35, 0x4000
    v_exp_f32 v239, v147
    v_mfma_f32_16x16x32_bf16 a[40:43], a[200:203], v[216:219], a[40:43]
    v_or3_b32 v57, v192, v193, v194
    v_mfma_f32_16x16x32_bf16 a[44:47], a[200:203], v[220:223], a[44:47]
    buffer_load_dwordx4 v1, s[20:23], s33 offen offset:1024 sc1 lds
    v_mfma_f32_16x16x32_bf16 a[48:51], a[204:207], v[208:211], a[48:51]
    v_exp_f32 v240, v132
    v_mfma_f32_16x16x32_bf16 a[52:55], a[204:207], v[212:215], a[52:55]
    ds_read_b128 a[128:131], v2 offset:0
    v_cvt_pk_bf16_f32 v195, v238, v239
    v_mfma_f32_16x16x32_bf16 a[56:59], a[204:207], v[216:219], a[56:59]
    v_exp_f32 v241, v133
    v_mfma_f32_16x16x32_bf16 a[60:63], a[204:207], v[220:223], a[60:63]
    s_waitcnt lgkmcnt(3)
    v_add_u32 v3, s53, v56
    v_cvt_pk_bf16_f32 v196, v240, v241
    v_mfma_f32_16x16x32_bf16 a[64:67], a[208:211], v[208:211], a[64:67]
    v_exp_f32 v242, v134
    v_mfma_f32_16x16x32_bf16 a[68:71], a[208:211], v[212:215], a[68:71]
    ds_read_b128 a[132:135], v2 offset:1024
    v_or3_b32 v57, v57, v195, v196
    v_mfma_f32_16x16x32_bf16 a[72:75], a[208:211], v[216:219], a[72:75]
    v_exp_f32 v243, v135
    v_mfma_f32_16x16x32_bf16 a[76:79], a[208:211], v[220:223], a[76:79]
    s_cmp_ge_u32 s36, s42
    s_cbranch_scc1 k2_prep_59
k2_prepret_60:
    v_mfma_f32_16x16x32_bf16 a[80:83], a[212:215], v[208:211], a[80:83]
    v_exp_f32 v244, v148
    v_mfma_f32_16x16x32_bf16 a[84:87], a[212:215], v[212:215], a[84:87]
    s_and_b32 s35, s35, 0xffff
    ds_read_b128 a[136:139], v2 offset:2048
    v_cvt_pk_bf16_f32 v197, v242, v243
    v_mfma_f32_16x16x32_bf16 a[88:91], a[212:215], v[216:219], a[88:91]
    v_exp_f32 v245, v149
    v_mfma_f32_16x16x32_bf16 a[92:95], a[212:215], v[220:223], a[92:95]
    s_waitcnt lgkmcnt(3)
    buffer_load_dwordx4 v1, s[20:23], s33 offen offset:2048 sc1 lds
    v_mfma_f32_16x16x32_bf16 a[96:99], a[216:219], v[208:211], a[96:99]
    v_exp_f32 v246, v150
    v_mfma_f32_16x16x32_bf16 a[100:103], a[216:219], v[212:215], a[100:103]
    ds_read_b128 a[140:143], v2 offset:3072
    v_cvt_pk_bf16_f32 v198, v244, v245
    v_mfma_f32_16x16x32_bf16 a[104:107], a[216:219], v[216:219], a[104:107]
    v_exp_f32 v247, v151
    v_mfma_f32_16x16x32_bf16 a[108:111], a[216:219], v[220:223], a[108:111]
    s_or_b32 s35, s35, 0x10000
    v_or3_b32 v57, v57, v197, v198
    v_cvt_pk_bf16_f32 v199, v246, v247
    v_mfma_f32_16x16x32_bf16 a[112:115], a[220:223], v[208:211], a[112:115]
    v_exp_f32 v232, v136
    v_mfma_f32_16x16x32_bf16 a[116:119], a[220:223], v[212:215], a[116:119]
    ds_read_b128 a[144:147], v2 offset:4096
    v_mfma_f32_16x16x32_bf16 a[120:123], a[220:223], v[216:219], a[120:123]
    v_exp_f32 v233, v137
    v_mfma_f32_16x16x32_bf16 a[124:127], a[220:223], v[220:223], a[124:127]
    s_waitcnt lgkmcnt(3)
    v_exp_f32 v234, v138
    v_mfma_f32_16x16x32_bf16 v[160:163], a[128:131], v[64:67], v[16:19]
    v_cvt_pk_bf16_f32 v200, v232, v233
    v_mfma_f32_16x16x32_bf16 v[164:167], a[128:131], v[80:83], v[20:23]
    ds_read_b128 a[148:151], v2 offset:5120
    v_or3_b32 v57, v57, v199, v200
    v_mfma_f32_16x16x32_bf16 v[168:171], a[128:131], v[96:99], v[24:27]
    v_exp_f32 v235, v139
    v_mfma_f32_16x16x32_bf16 v[172:175], a[128:131], v[112:115], v[28:31]
    s_add_u32 s36, s36, 32
    buffer_load_dwordx4 v1, s[20:23], s33 offen offset:3072 sc1 lds
    v_mfma_f32_16x16x32_bf16 v[160:163], a[132:135], v[68:71], v[160:163]
    s_add_u32 s33, s33, 0x80000
    v_exp_f32 v236, v152
    v_mfma_f32_16x16x32_bf16 v[164:167], a[132:135], v[84:87], v[164:167]
    ds_read_b128 a[152:155], v2 offset:6144
    v_cvt_pk_bf16_f32 v201, v234, v235
    v_mfma_f32_16x16x32_bf16 v[168:171], a[132:135], v[100:103], v[168:171]
    v_exp_f32 v237, v153
    v_mfma_f32_16x16x32_bf16 v[172:175], a[132:135], v[116:119], v[172:175]
    s_waitcnt lgkmcnt(3)
    v_exp_f32 v238, v154
    v_mfma_f32_16x16x32_bf16 v[160:163], a[136:139], v[72:75], v[160:163]
    s_add_u32 s52, s52, 8192
    v_cvt_pk_bf16_f32 v202, v236, v237
    v_mfma_f32_16x16x32_bf16 v[164:167], a[136:139], v[88:91], v[164:167]
    ds_read_b128 a[156:159], v2 offset:7168
    v_or3_b32 v57, v57, v201, v202
    v_mfma_f32_16x16x32_bf16 v[168:171], a[136:139], v[104:107], v[168:171]
    s_and_b32 s52, s52, 0xffff
    v_exp_f32 v239, v155
    v_mfma_f32_16x16x32_bf16 v[172:175], a[136:139], v[120:123], v[172:175]
    v_exp_f32 v240, v140
    v_mfma_f32_16x16x32_bf16 v[160:163], a[140:143], v[76:79], v[160:163]
    v_cvt_pk_bf16_f32 v203, v238, v239
    v_mfma_f32_16x16x32_bf16 v[164:167], a[140:143], v[92:95], v[164:167]
    v_exp_f32 v241, v141
    v_mfma_f32_16x16x32_bf16 v[168:171], a[140:143], v[108:111], v[168:171]
    v_mfma_f32_16x16x32_bf16 v[172:175], a[140:143], v[124:127], v[172:175]
    s_waitcnt lgkmcnt(2)
    buffer_load_dword v7, v228, s[12:15], s62 offen
    ds_read_b128 a[192:195], v3 offset:0
    v_mfma_f32_16x16x32_bf16 v[176:179], a[144:147], v[64:67], v[32:35]
    s_add_u32 s62, s62, 0x1000
    v_exp_f32 v242, v142
    v_mfma_f32_16x16x32_bf16 v[180:183], a[144:147], v[80:83], v[36:39]
    v_cvt_pk_bf16_f32 v204, v240, v241
    v_add_u32 v2, s52, v1
    v_mfma_f32_16x16x32_bf16 v[184:187], a[144:147], v[96:99], v[40:43]
    v_exp_f32 v243, v143
    v_mfma_f32_16x16x32_bf16 v[188:191], a[144:147], v[112:115], v[44:47]
    ds_read_b128 a[196:199], v3 offset:1024
    v_or3_b32 v57, v57, v203, v204
    v_mfma_f32_16x16x32_bf16 v[176:179], a[148:151], v[68:71], v[176:179]
    v_exp_f32 v244, v156
    v_mfma_f32_16x16x32_bf16 v[180:183], a[148:151], v[84:87], v[180:183]
    ds_read_b128 a[200:203], v3 offset:2048
    v_cvt_pk_bf16_f32 v205, v242, v243
    v_mfma_f32_16x16x32_bf16 v[184:187], a[148:151], v[100:103], v[184:187]
    v_exp_f32 v245, v157
    v_mfma_f32_16x16x32_bf16 v[188:191], a[148:151], v[116:119], v[188:191]
    s_waitcnt lgkmcnt(3)
    v_exp_f32 v246, v158
    v_mfma_f32_16x16x32_bf16 v[176:179], a[152:155], v[72:75], v[176:179]
    s_sub_u32 s63, s63, 1
    v_cvt_pk_bf16_f32 v206, v244, v245
    v_mfma_f32_16x16x32_bf16 v[180:183], a[152:155], v[88:91], v[180:183]
    v_exp_f32 v247, v159
    v_mfma_f32_16x16x32_bf16 v[184:187], a[152:155], v[104:107], v[184:187]
    ds_read_b128 a[204:207], v3 offset:3072
    v_or3_b32 v57, v57, v205, v206
    v_mfma_f32_16x16x32_bf16 v[188:191], a[152:155], v[120:123], v[188:191]
    v_cvt_pk_bf16_f32 v207, v246, v247
    v_mfma_f32_16x16x32_bf16 v[176:179], a[156:159], v[76:79], v[176:179]
    v_mfma_f32_16x16x32_bf16 v[180:183], a[156:159], v[92:95], v[180:183]
    v_bitop3_b32 v57, v57, v207, s37 bitop3:0xa8
    v_cmp_ne_u32 vcc, 0, v57
    v_mfma_f32_16x16x32_bf16 v[184:187], a[156:159], v[108:111], v[184:187]
    v_mfma_f32_16x16x32_bf16 v[188:191], a[156:159], v[124:127], v[188:191]
    s_waitcnt vmcnt(8)
    s_barrier
    s_cbranch_vccnz k2_rare_61
k2_ret_62:
    s_cmp_lg_u32 s63, 0
    s_cbranch_scc1 k2_dloop_54
    v_mfma_f32_16x16x32_bf16 v[12:15], v[60:63], v[192:195], v[12:15]
    ds_read_b128 a[208:211], v3 offset:4096
    v_mfma_f32_16x16x32_bf16 v[48:51], v[60:63], v[196:199], v[48:51]
    v_exp_f32 v232, v160
    v_mfma_f32_16x16x32_bf16 v[248:251], v[60:63], v[200:203], v[248:251]
    s_mov_b32 m0, s34
    v_exp_f32 v233, v161
    v_mfma_f32_16x16x32_bf16 v[252:255], v[60:63], v[204:207], v[252:255]
    s_waitcnt lgkmcnt(3)
    buffer_load_dwordx4 v1, s[16:19], s32 offen offset:0 sc1 lds
    ds_read_b128 a[212:215], v3 offset:5120
    v_mfma_f32_16x16x32_bf16 a[0:3], a[192:195], v[192:195], a[0:3]
    s_add_u32 s53, s53, 8192
    v_exp_f32 v234, v162
    v_mfma_f32_16x16x32_bf16 a[4:7], a[192:195], v[196:199], a[4:7]
    s_and_b32 s53, s53, 0xffff
    v_cvt_pk_bf16_f32 v208, v232, v233
    v_mfma_f32_16x16x32_bf16 a[8:11], a[192:195], v[200:203], a[8:11]
    v_exp_f32 v235, v163
    v_mfma_f32_16x16x32_bf16 a[12:15], a[192:195], v[204:207], a[12:15]
    ds_read_b128 a[216:219], v3 offset:6144
    v_cvt_pk_bf16_f32 v209, v234, v235
    v_mfma_f32_16x16x32_bf16 a[16:19], a[196:199], v[192:195], a[16:19]
    v_exp_f32 v236, v176
    v_mfma_f32_16x16x32_bf16 a[20:23], a[196:199], v[196:199], a[20:23]
    v_exp_f32 v237, v177
    v_mfma_f32_16x16x32_bf16 a[24:27], a[196:199], v[200:203], a[24:27]
    v_mfma_f32_16x16x32_bf16 a[28:31], a[196:199], v[204:207], a[28:31]
    s_waitcnt lgkmcnt(3)
    ds_read_b128 a[220:223], v3 offset:7168
    v_cvt_pk_bf16_f32 v210, v236, v237
    v_mfma_f32_16x16x32_bf16 a[32:35], a[200:203], v[192:195], a[32:35]
    v_exp_f32 v238, v178
    v_mfma_f32_16x16x32_bf16 a[36:39], a[200:203], v[196:199], a[36:39]
    v_exp_f32 v239, v179
    v_mfma_f32_16x16x32_bf16 a[40:43], a[200:203], v[200:203], a[40:43]
    v_or3_b32 v57, v208, v209, v210
    v_mfma_f32_16x16x32_bf16 a[44:47], a[200:203], v[204:207], a[44:47]
    v_exp_f32 v240, v164
    v_mfma_f32_16x16x32_bf16 a[48:51], a[204:207], v[192:195], a[48:51]
    s_add_u32 s34, s34, 0x4000
    v_cvt_pk_bf16_f32 v211, v238, v239
    v_mfma_f32_16x16x32_bf16 a[52:55], a[204:207], v[196:199], a[52:55]
    buffer_load_dwordx4 v1, s[16:19], s32 offen offset:1024 sc1 lds
    ds_read_b128 a[128:131], v2 offset:0
    v_mfma_f32_16x16x32_bf16 a[56:59], a[204:207], v[200:203], a[56:59]
    v_exp_f32 v241, v165
    v_mfma_f32_16x16x32_bf16 a[60:63], a[204:207], v[204:207], a[60:63]
    s_waitcnt lgkmcnt(3)
    ds_read_b128 a[132:135], v2 offset:1024
    v_add_u32 v3, s53, v56
    v_mfma_f32_16x16x32_bf16 a[64:67], a[208:211], v[192:195], a[64:67]
    v_exp_f32 v242, v166
    v_mfma_f32_16x16x32_bf16 a[68:71], a[208:211], v[196:199], a[68:71]
    ds_read_b128 a[136:139], v2 offset:2048
    v_cvt_pk_bf16_f32 v212, v240, v241
    v_mfma_f32_16x16x32_bf16 a[72:75], a[208:211], v[200:203], a[72:75]
    v_exp_f32 v243, v167
    v_mfma_f32_16x16x32_bf16 a[76:79], a[208:211], v[204:207], a[76:79]
    ds_read_b128 a[140:143], v2 offset:3072
    v_or3_b32 v57, v57, v211, v212
    v_mfma_f32_16x16x32_bf16 a[80:83], a[212:215], v[192:195], a[80:83]
    s_branch k2_prep_63
k2_prepret_64:
    v_mfma_f32_16x16x32_bf16 a[84:87], a[212:215], v[196:199], a[84:87]
    v_exp_f32 v244, v180
    v_mfma_f32_16x16x32_bf16 a[88:91], a[212:215], v[200:203], a[88:91]
    ds_read_b128 a[144:147], v2 offset:4096
    v_cvt_pk_bf16_f32 v213, v242, v243
    v_mfma_f32_16x16x32_bf16 a[92:95], a[212:215], v[204:207], a[92:95]
    s_waitcnt lgkmcnt(5)
    v_exp_f32 v245, v181
    v_mfma_f32_16x16x32_bf16 a[96:99], a[216:219], v[192:195], a[96:99]
    ds_read_b128 a[148:151], v2 offset:5120
    v_cvt_pk_bf16_f32 v214, v244, v245
    v_mfma_f32_16x16x32_bf16 a[100:103], a[216:219], v[196:199], a[100:103]
    v_exp_f32 v246, v182
    v_mfma_f32_16x16x32_bf16 a[104:107], a[216:219], v[200:203], a[104:107]
    ds_read_b128 a[152:155], v2 offset:6144
    v_or3_b32 v57, v57, v213, v214
    v_mfma_f32_16x16x32_bf16 a[108:111], a[216:219], v[204:207], a[108:111]
    s_and_b32 s34, s34, 0xffff
    v_exp_f32 v247, v183
    v_mfma_f32_16x16x32_bf16 a[112:115], a[220:223], v[192:195], a[112:115]
    ds_read_b128 a[156:159], v2 offset:7168
    v_cvt_pk_bf16_f32 v215, v246, v247
    v_mfma_f32_16x16x32_bf16 a[116:119], a[220:223], v[196:199], a[116:119]
    v_exp_f32 v232, v168
    v_mfma_f32_16x16x32_bf16 a[120:123], a[220:223], v[200:203], a[120:123]
    buffer_load_dwordx4 v1, s[16:19], s32 offen offset:2048 sc1 lds
    ds_read_b128 a[160:163], v2 offset:8192
    v_mfma_f32_16x16x32_bf16 a[124:127], a[220:223], v[204:207], a[124:127]
    s_waitcnt lgkmcnt(7)
    v_exp_f32 v233, v169
    v_mfma_f32_16x16x32_bf16 v[128:131], a[128:131], v[96:99], v[16:19]
    ds_read_b128 a[164:167], v2 offset:9216
    v_cvt_pk_bf16_f32 v216, v232, v233
    v_mfma_f32_16x16x32_bf16 v[132:135], a[128:131], v[112:115], v[20:23]
    v_exp_f32 v234, v170
    v_mfma_f32_16x16x32_bf16 v[128:131], a[132:135], v[100:103], v[128:131]
    ds_read_b128 a[168:171], v2 offset:10240
    v_or3_b32 v57, v57, v215, v216
    v_mfma_f32_16x16x32_bf16 v[132:135], a[132:135], v[116:119], v[132:135]
    s_waitcnt lgkmcnt(7)
    v_exp_f32 v235, v171
    v_mfma_f32_16x16x32_bf16 v[128:131], a[136:139], v[104:107], v[128:131]
    s_add_u32 s36, s36, 64
    ds_read_b128 a[172:175], v2 offset:11264
    v_cvt_pk_bf16_f32 v217, v234, v235
    v_mfma_f32_16x16x32_bf16 v[132:135], a[136:139], v[120:123], v[132:135]
    v_exp_f32 v236, v184
    v_mfma_f32_16x16x32_bf16 v[128:131], a[140:143], v[108:111], v[128:131]
    ds_read_b128 a[176:179], v2 offset:12288
    v_mfma_f32_16x16x32_bf16 v[132:135], a[140:143], v[124:127], v[132:135]
    s_waitcnt lgkmcnt(7)
    v_exp_f32 v237, v185
    v_mfma_f32_16x16x32_bf16 v[144:147], a[144:147], v[96:99], v[32:35]
    s_add_u32 s52, s52, 16384
    ds_read_b128 a[180:183], v2 offset:13312
    v_cvt_pk_bf16_f32 v218, v236, v237
    v_mfma_f32_16x16x32_bf16 v[148:151], a[144:147], v[112:115], v[36:39]
    v_exp_f32 v238, v186
    v_mfma_f32_16x16x32_bf16 v[144:147], a[148:151], v[100:103], v[144:147]
    s_and_b32 s52, s52, 0xffff
    ds_read_b128 a[184:187], v2 offset:14336
    v_or3_b32 v57, v57, v217, v218
    v_mfma_f32_16x16x32_bf16 v[148:151], a[148:151], v[116:119], v[148:151]
    s_waitcnt lgkmcnt(7)
    v_exp_f32 v239, v187
    v_mfma_f32_16x16x32_bf16 v[144:147], a[152:155], v[104:107], v[144:147]
    ds_read_b128 a[188:191], v2 offset:15360
    v_cvt_pk_bf16_f32 v219, v238, v239
    v_mfma_f32_16x16x32_bf16 v[148:151], a[152:155], v[120:123], v[148:151]
    v_exp_f32 v240, v172
    v_mfma_f32_16x16x32_bf16 v[144:147], a[156:159], v[108:111], v[144:147]
    buffer_load_dwordx4 v1, s[16:19], s32 offen offset:3072 sc1 lds
    v_mfma_f32_16x16x32_bf16 v[148:151], a[156:159], v[124:127], v[148:151]
    s_waitcnt lgkmcnt(6)
    ds_read_b128 a[192:195], v3 offset:0
    s_add_u32 s32, s32, 0x80000
    v_mfma_f32_16x16x32_bf16 v[136:139], a[160:163], v[96:99], v[24:27]
    v_exp_f32 v241, v173
    v_mfma_f32_16x16x32_bf16 v[140:143], a[160:163], v[112:115], v[28:31]
    v_exp_f32 v242, v174
    v_mfma_f32_16x16x32_bf16 v[136:139], a[164:167], v[100:103], v[136:139]
    v_cvt_pk_bf16_f32 v220, v240, v241
    v_add_u32 v2, s52, v1
    v_mfma_f32_16x16x32_bf16 v[140:143], a[164:167], v[116:119], v[140:143]
    s_waitcnt lgkmcnt(5)
    v_exp_f32 v243, v175
    v_mfma_f32_16x16x32_bf16 v[136:139], a[168:171], v[104:107], v[136:139]
    ds_read_b128 a[196:199], v3 offset:1024
    v_or3_b32 v57, v57, v219, v220
    v_mfma_f32_16x16x32_bf16 v[140:143], a[168:171], v[120:123], v[140:143]
    v_exp_f32 v244, v188
    v_mfma_f32_16x16x32_bf16 v[136:139], a[172:175], v[108:111], v[136:139]
    ds_read_b128 a[200:203], v3 offset:2048
    v_cvt_pk_bf16_f32 v221, v242, v243
    v_mfma_f32_16x16x32_bf16 v[140:143], a[172:175], v[124:127], v[140:143]
    s_waitcnt lgkmcnt(5)
    v_exp_f32 v245, v189
    v_mfma_f32_16x16x32_bf16 v[152:155], a[176:179], v[96:99], v[40:43]
    v_exp_f32 v246, v190
    v_mfma_f32_16x16x32_bf16 v[156:159], a[176:179], v[112:115], v[44:47]
    ds_read_b128 a[204:207], v3 offset:3072
    v_cvt_pk_bf16_f32 v222, v244, v245
    v_mfma_f32_16x16x32_bf16 v[152:155], a[180:183], v[100:103], v[152:155]
    v_exp_f32 v247, v191
    v_mfma_f32_16x16x32_bf16 v[156:159], a[180:183], v[116:119], v[156:159]
    s_waitcnt lgkmcnt(4)
    v_or3_b32 v57, v57, v221, v222
    v_cvt_pk_bf16_f32 v223, v246, v247
    v_mfma_f32_16x16x32_bf16 v[152:155], a[184:187], v[104:107], v[152:155]
    v_mfma_f32_16x16x32_bf16 v[156:159], a[184:187], v[120:123], v[156:159]
    v_bitop3_b32 v57, v57, v223, s37 bitop3:0xa8
    v_cmp_ne_u32 vcc, 0, v57
    v_mfma_f32_16x16x32_bf16 v[152:155], a[188:191], v[108:111], v[152:155]
    v_mfma_f32_16x16x32_bf16 v[156:159], a[188:191], v[124:127], v[156:159]
    s_cbranch_vccnz k2_rare_65
k2_ret_66:
    v_mfma_f32_16x16x32_bf16 v[12:15], v[60:63], v[208:211], v[12:15]
    ds_read_b128 a[208:211], v3 offset:4096
    v_mfma_f32_16x16x32_bf16 v[48:51], v[60:63], v[212:215], v[48:51]
    s_mov_b32 m0, s35
    v_exp_f32 v232, v128
    v_mfma_f32_16x16x32_bf16 v[248:251], v[60:63], v[216:219], v[248:251]
    s_add_u32 s53, s53, 8192
    buffer_load_dwordx4 v1, s[20:23], s33 offen offset:0 sc1 lds
    v_mfma_f32_16x16x32_bf16 v[252:255], v[60:63], v[220:223], v[252:255]
    s_waitcnt lgkmcnt(3)
    v_exp_f32 v233, v129
    v_mfma_f32_16x16x32_bf16 a[0:3], a[192:195], v[208:211], a[0:3]
    s_and_b32 s53, s53, 0xffff
    ds_read_b128 a[212:215], v3 offset:5120
    v_cvt_pk_bf16_f32 v192, v232, v233
    v_mfma_f32_16x16x32_bf16 a[4:7], a[192:195], v[212:215], a[4:7]
    v_exp_f32 v234, v130
    v_mfma_f32_16x16x32_bf16 a[8:11], a[192:195], v[216:219], a[8:11]
    v_exp_f32 v235, v131
    v_mfma_f32_16x16x32_bf16 a[12:15], a[192:195], v[220:223], a[12:15]
    ds_read_b128 a[216:219], v3 offset:6144
    v_cvt_pk_bf16_f32 v193, v234, v235
    v_mfma_f32_16x16x32_bf16 a[16:19], a[196:199], v[208:211], a[16:19]
    s_add_u32 s35, s35, 0x4000
    v_exp_f32 v236, v144
    v_mfma_f32_16x16x32_bf16 a[20:23], a[196:199], v[212:215], a[20:23]
    v_exp_f32 v237, v145
    v_mfma_f32_16x16x32_bf16 a[24:27], a[196:199], v[216:219], a[24:27]
    buffer_load_dwordx4 v1, s[20:23], s33 offen offset:1024 sc1 lds
    v_mfma_f32_16x16x32_bf16 a[28:31], a[196:199], v[220:223], a[28:31]
    s_waitcnt lgkmcnt(3)
    ds_read_b128 a[220:223], v3 offset:7168
    v_cvt_pk_bf16_f32 v194, v236, v237
    v_mfma_f32_16x16x32_bf16 a[32:35], a[200:203], v[208:211], a[32:35]
    v_exp_f32 v238, v146
    v_mfma_f32_16x16x32_bf16 a[36:39], a[200:203], v[212:215], a[36:39]
    v_exp_f32 v239, v147
    v_mfma_f32_16x16x32_bf16 a[40:43], a[200:203], v[216:219], a[40:43]
    v_or3_b32 v57, v192, v193, v194
    v_mfma_f32_16x16x32_bf16 a[44:47], a[200:203], v[220:223], a[44:47]
    v_exp_f32 v240, v132
    v_mfma_f32_16x16x32_bf16 a[48:51], a[204:207], v[208:211], a[48:51]
    s_and_b32 s35, s35, 0xffff
    v_cvt_pk_bf16_f32 v195, v238, v239
    v_mfma_f32_16x16x32_bf16 a[52:55], a[204:207], v[212:215], a[52:55]
    buffer_load_dwordx4 v1, s[20:23], s33 offen offset:2048 sc1 lds
    ds_read_b128 a[128:131], v2 offset:0
    v_mfma_f32_16x16x32_bf16 a[56:59], a[204:207], v[216:219], a[56:59]
    v_exp_f32 v241, v133
    v_mfma_f32_16x16x32_bf16 a[60:63], a[204:207], v[220:223], a[60:63]
    s_waitcnt lgkmcnt(3)
    ds_read_b128 a[132:135], v2 offset:1024
    v_add_u32 v3, s53, v56
    v_mfma_f32_16x16x32_bf16 a[64:67], a[208:211], v[208:211], a[64:67]
    v_exp_f32 v242, v134
    v_mfma_f32_16x16x32_bf16 a[68:71], a[208:211], v[212:215], a[68:71]
    s_or_b32 s35, s35, 0x10000
    ds_read_b128 a[136:139], v2 offset:2048
    v_cvt_pk_bf16_f32 v196, v240, v241
    v_mfma_f32_16x16x32_bf16 a[72:75], a[208:211], v[216:219], a[72:75]
    v_exp_f32 v243, v135
    v_mfma_f32_16x16x32_bf16 a[76:79], a[208:211], v[220:223], a[76:79]
    ds_read_b128 a[140:143], v2 offset:3072
    v_or3_b32 v57, v57, v195, v196
    v_mfma_f32_16x16x32_bf16 a[80:83], a[212:215], v[208:211], a[80:83]
    s_cmp_ge_u32 s36, s43
    s_cbranch_scc1 k2_prep_67
k2_prepret_68:
    v_mfma_f32_16x16x32_bf16 a[84:87], a[212:215], v[212:215], a[84:87]
    v_exp_f32 v244, v148
    v_mfma_f32_16x16x32_bf16 a[88:91], a[212:215], v[216:219], a[88:91]
    ds_read_b128 a[144:147], v2 offset:4096
    v_cvt_pk_bf16_f32 v197, v242, v243
    v_mfma_f32_16x16x32_bf16 a[92:95], a[212:215], v[220:223], a[92:95]
    s_waitcnt lgkmcnt(5)
    v_exp_f32 v245, v149
    v_mfma_f32_16x16x32_bf16 a[96:99], a[216:219], v[208:211], a[96:99]
    buffer_load_dwordx4 v1, s[20:23], s33 offen offset:3072 sc1 lds
    ds_read_b128 a[148:151], v2 offset:5120
    v_mfma_f32_16x16x32_bf16 a[100:103], a[216:219], v[212:215], a[100:103]
    s_add_u32 s33, s33, 0x80000
    v_exp_f32 v246, v150
    v_mfma_f32_16x16x32_bf16 a[104:107], a[216:219], v[216:219], a[104:107]
    ds_read_b128 a[152:155], v2 offset:6144
    v_cvt_pk_bf16_f32 v198, v244, v245
    v_mfma_f32_16x16x32_bf16 a[108:111], a[216:219], v[220:223], a[108:111]
    v_exp_f32 v247, v151
    v_mfma_f32_16x16x32_bf16 a[112:115], a[220:223], v[208:211], a[112:115]
    ds_read_b128 a[156:159], v2 offset:7168
    v_or3_b32 v57, v57, v197, v198
    v_mfma_f32_16x16x32_bf16 a[116:119], a[220:223], v[212:215], a[116:119]
    v_exp_f32 v232, v136
    v_mfma_f32_16x16x32_bf16 a[120:123], a[220:223], v[216:219], a[120:123]
    ds_read_b128 a[160:163], v2 offset:8192
    v_cvt_pk_bf16_f32 v199, v246, v247
    v_mfma_f32_16x16x32_bf16 a[124:127], a[220:223], v[220:223], a[124:127]
    s_waitcnt lgkmcnt(7)
    v_exp_f32 v233, v137
    v_mfma_f32_16x16x32_bf16 v[160:163], a[128:131], v[96:99], v[16:19]
    s_waitcnt vmcnt(12)
    s_barrier
    ds_read_b128 a[164:167], v2 offset:9216
    v_cvt_pk_bf16_f32 v200, v232, v233
    v_mfma_f32_16x16x32_bf16 v[164:167], a[128:131], v[112:115], v[20:23]
    s_mov_b32 m0, s34
    v_exp_f32 v234, v138
    v_mfma_f32_16x16x32_bf16 v[160:163], a[132:135], v[100:103], v[160:163]
    buffer_load_dwordx4 v1, s[16:19], s32 offen offset:0 sc1 lds
    ds_read_b128 a[168:171], v2 offset:10240
    v_mfma_f32_16x16x32_bf16 v[164:167], a[132:135], v[116:119], v[164:167]
    s_waitcnt lgkmcnt(7)
    v_exp_f32 v235, v139
    v_mfma_f32_16x16x32_bf16 v[160:163], a[136:139], v[104:107], v[160:163]
    s_add_u32 s36, s36, 64
    ds_read_b128 a[172:175], v2 offset:11264
    v_or3_b32 v57, v57, v199, v200
    v_mfma_f32_16x16x32_bf16 v[164:167], a[136:139], v[120:123], v[164:167]
    v_exp_f32 v236, v152
    v_mfma_f32_16x16x32_bf16 v[160:163], a[140:143], v[108:111], v[160:163]
    ds_read_b128 a[176:179], v2 offset:12288
    v_cvt_pk_bf16_f32 v201, v234, v235
    v_mfma_f32_16x16x32_bf16 v[164:167], a[140:143], v[124:127], v[164:167]
    s_waitcnt lgkmcnt(7)
    v_exp_f32 v237, v153
    v_mfma_f32_16x16x32_bf16 v[176:179], a[144:147], v[96:99], v[32:35]
    s_add_u32 s34, s34, 0x4000
    ds_read_b128 a[180:183], v2 offset:13312
    v_cvt_pk_bf16_f32 v202, v236, v237
    v_mfma_f32_16x16x32_bf16 v[180:183], a[144:147], v[112:115], v[36:39]
    s_add_u32 s52, s52, 16384
    v_exp_f32 v238, v154
    v_mfma_f32_16x16x32_bf16 v[176:179], a[148:151], v[100:103], v[176:179]
    s_and_b32 s52, s52, 0xffff
    buffer_load_dwordx4 v1, s[16:19], s32 offen offset:1024 sc1 lds
    ds_read_b128 a[184:187], v2 offset:14336
    v_mfma_f32_16x16x32_bf16 v[180:183], a[148:151], v[116:119], v[180:183]
    s_waitcnt lgkmcnt(7)
    v_exp_f32 v239, v155
    v_mfma_f32_16x16x32_bf16 v[176:179], a[152:155], v[104:107], v[176:179]
    ds_read_b128 a[188:191], v2 offset:15360
    v_or3_b32 v57, v57, v201, v202
    v_mfma_f32_16x16x32_bf16 v[180:183], a[152:155], v[120:123], v[180:183]
    v_exp_f32 v240, v140
    v_mfma_f32_16x16x32_bf16 v[176:179], a[156:159], v[108:111], v[176:179]
    s_and_b32 s34, s34, 0xffff
    v_cvt_pk_bf16_f32 v203, v238, v239
    v_mfma_f32_16x16x32_bf16 v[180:183], a[156:159], v[124:127], v[180:183]
    s_waitcnt lgkmcnt(6)
    v_exp_f32 v241, v141
    v_mfma_f32_16x16x32_bf16 v[168:171], a[160:163], v[96:99], v[24:27]
    ds_read_b128 a[192:195], v3 offset:0
    v_cvt_pk_bf16_f32 v204, v240, v241
    v_mfma_f32_16x16x32_bf16 v[172:175], a[160:163], v[112:115], v[28:31]
    v_exp_f32 v242, v142
    v_mfma_f32_16x16x32_bf16 v[168:171], a[164:167], v[100:103], v[168:171]
    buffer_load_dwordx4 v1, s[16:19], s32 offen offset:2048 sc1 lds
    ds_read_b128 a[196:199], v3 offset:1024
    v_mfma_f32_16x16x32_bf16 v[172:175], a[164:167], v[116:119], v[172:175]
    s_waitcnt lgkmcnt(6)
    v_add_u32 v2, s52, v1
    v_or3_b32 v57, v57, v203, v204
    v_mfma_f32_16x16x32_bf16 v[168:171], a[168:171], v[104:107], v[168:171]
    v_exp_f32 v243, v143
    v_mfma_f32_16x16x32_bf16 v[172:175], a[168:171], v[120:123], v[172:175]
    ds_read_b128 a[200:203], v3 offset:2048
    v_cvt_pk_bf16_f32 v205, v242, v243
    v_mfma_f32_16x16x32_bf16 v[168:171], a[172:175], v[108:111], v[168:171]
    v_exp_f32 v244, v156
    v_mfma_f32_16x16x32_bf16 v[172:175], a[172:175], v[124:127], v[172:175]
    s_waitcnt lgkmcnt(5)
    ds_read_b128 a[204:207], v3 offset:3072
    ds_read_b128 a[208:211], v3 offset:4096
    v_mfma_f32_16x16x32_bf16 v[184:187], a[176:179], v[96:99], v[40:43]
    v_exp_f32 v245, v157
    v_mfma_f32_16x16x32_bf16 v[188:191], a[176:179], v[112:115], v[44:47]
    buffer_load_dwordx4 v1, s[16:19], s32 offen offset:3072 sc1 lds
    ds_read_b128 a[212:215], v3 offset:5120
    v_mfma_f32_16x16x32_bf16 v[184:187], a[180:183], v[100:103], v[184:187]
    s_add_u32 s32, s32, 0x80000
    v_exp_f32 v246, v158
    v_mfma_f32_16x16x32_bf16 v[188:191], a[180:183], v[116:119], v[188:191]
    s_waitcnt lgkmcnt(6)
    ds_read_b128 a[216:219], v3 offset:6144
    v_cvt_pk_bf16_f32 v206, v244, v245
    v_mfma_f32_16x16x32_bf16 v[184:187], a[184:187], v[104:107], v[184:187]
    v_exp_f32 v247, v159
    v_mfma_f32_16x16x32_bf16 v[188:191], a[184:187], v[120:123], v[188:191]
    ds_read_b128 a[220:223], v3 offset:7168
    v_or3_b32 v57, v57, v205, v206
    v_mfma_f32_16x16x32_bf16 v[184:187], a[188:191], v[108:111], v[184:187]
    v_cvt_pk_bf16_f32 v207, v246, v247
    v_bitop3_b32 v57, v57, v207, s37 bitop3:0xa8
    v_mfma_f32_16x16x32_bf16 v[188:191], a[188:191], v[124:127], v[188:191]
    v_cmp_ne_u32 vcc, 0, v57
    s_cbranch_vccnz k2_rare_69
k2_ret_70:
    s_lshl_b32 s31, s28, 19
    s_lshl_b32 s44, s38, 6
    s_add_u32 s44, s44, s31
    s_add_u32 s45, s44, 131072
    s_add_u32 s46, s44, 262144
    s_add_u32 s47, s44, 393216
    v_mov_b32 v13, v12
    v_mov_b32 v49, v48
    s_nop 1
    v_permlane16_swap_b32 v12, v13
    v_permlane16_swap_b32 v48, v49
    s_nop 1
    v_add_f32 v12, v12, v13
    v_add_f32 v48, v48, v49
    v_mov_b32 v13, v12
    v_mov_b32 v49, v48
    s_nop 1
    v_permlane32_swap_b32 v12, v13
    v_permlane32_swap_b32 v48, v49
    s_nop 1
    v_add_f32 v12, v12, v13
    v_add_f32 v48, v48, v49
    v_rcp_f32 v13, v12
    v_rcp_f32 v49, v48
    v_rcp_f32 v12, v12
    v_rcp_f32 v48, v48
    s_nop 0
    v_accvgpr_read_b32 v68, a0
    v_accvgpr_read_b32 v69, a1
    v_accvgpr_read_b32 v70, a2
    v_accvgpr_read_b32 v71, a3
    v_accvgpr_read_b32 v72, a16
    v_accvgpr_read_b32 v73, a17
    v_accvgpr_read_b32 v74, a18
    v_accvgpr_read_b32 v75, a19
    v_pk_mul_f32 v[68:69], v[68:69], v[12:13]
    v_pk_mul_f32 v[70:71], v[70:71], v[12:13]
    v_pk_mul_f32 v[72:73], v[72:73], v[12:13]
    v_pk_mul_f32 v[74:75], v[74:75], v[12:13]
    v_cvt_pk_bf16_f32 v64, v68, v69
    v_cvt_pk_bf16_f32 v65, v70, v71
    v_cvt_pk_bf16_f32 v66, v72, v73
    v_cvt_pk_bf16_f32 v67, v74, v75
    buffer_store_dwordx4 v[64:67], v1, s[24:27], s44 offen offset:0 sc1
    v_accvgpr_read_b32 v80, a32
    v_accvgpr_read_b32 v81, a33
    v_accvgpr_read_b32 v82, a34
    v_accvgpr_read_b32 v83, a35
    v_accvgpr_read_b32 v84, a48
    v_accvgpr_read_b32 v85, a49
    v_accvgpr_read_b32 v86, a50
    v_accvgpr_read_b32 v87, a51
    v_pk_mul_f32 v[80:81], v[80:81], v[12:13]
    v_pk_mul_f32 v[82:83], v[82:83], v[12:13]
    v_pk_mul_f32 v[84:85], v[84:85], v[12:13]
    v_pk_mul_f32 v[86:87], v[86:87], v[12:13]
    v_cvt_pk_bf16_f32 v76, v80, v81
    v_cvt_pk_bf16_f32 v77, v82, v83
    v_cvt_pk_bf16_f32 v78, v84, v85
    v_cvt_pk_bf16_f32 v79, v86, v87
    buffer_store_dwordx4 v[76:79], v1, s[24:27], s45 offen offset:0 sc1
    v_accvgpr_read_b32 v68, a64
    v_accvgpr_read_b32 v69, a65
    v_accvgpr_read_b32 v70, a66
    v_accvgpr_read_b32 v71, a67
    v_accvgpr_read_b32 v72, a80
    v_accvgpr_read_b32 v73, a81
    v_accvgpr_read_b32 v74, a82
    v_accvgpr_read_b32 v75, a83
    v_pk_mul_f32 v[68:69], v[68:69], v[12:13]
    v_pk_mul_f32 v[70:71], v[70:71], v[12:13]
    v_pk_mul_f32 v[72:73], v[72:73], v[12:13]
    v_pk_mul_f32 v[74:75], v[74:75], v[12:13]
    v_cvt_pk_bf16_f32 v64, v68, v69
    v_cvt_pk_bf16_f32 v65, v70, v71
    v_cvt_pk_bf16_f32 v66, v72, v73
    v_cvt_pk_bf16_f32 v67, v74, v75
    buffer_store_dwordx4 v[64:67], v1, s[24:27], s46 offen offset:0 sc1
    v_accvgpr_read_b32 v80, a96
    v_accvgpr_read_b32 v81, a97
    v_accvgpr_read_b32 v82, a98
    v_accvgpr_read_b32 v83, a99
    v_accvgpr_read_b32 v84, a112
    v_accvgpr_read_b32 v85, a113
    v_accvgpr_read_b32 v86, a114
    v_accvgpr_read_b32 v87, a115
    v_pk_mul_f32 v[80:81], v[80:81], v[12:13]
    v_pk_mul_f32 v[82:83], v[82:83], v[12:13]
    v_pk_mul_f32 v[84:85], v[84:85], v[12:13]
    v_pk_mul_f32 v[86:87], v[86:87], v[12:13]
    v_cvt_pk_bf16_f32 v76, v80, v81
    v_cvt_pk_bf16_f32 v77, v82, v83
    v_cvt_pk_bf16_f32 v78, v84, v85
    v_cvt_pk_bf16_f32 v79, v86, v87
    buffer_store_dwordx4 v[76:79], v1, s[24:27], s47 offen offset:0 sc1
    v_accvgpr_read_b32 v68, a4
    v_accvgpr_read_b32 v69, a5
    v_accvgpr_read_b32 v70, a6
    v_accvgpr_read_b32 v71, a7
    v_accvgpr_read_b32 v72, a20
    v_accvgpr_read_b32 v73, a21
    v_accvgpr_read_b32 v74, a22
    v_accvgpr_read_b32 v75, a23
    v_pk_mul_f32 v[68:69], v[68:69], v[48:49]
    v_pk_mul_f32 v[70:71], v[70:71], v[48:49]
    v_pk_mul_f32 v[72:73], v[72:73], v[48:49]
    v_pk_mul_f32 v[74:75], v[74:75], v[48:49]
    v_cvt_pk_bf16_f32 v64, v68, v69
    v_cvt_pk_bf16_f32 v65, v70, v71
    v_cvt_pk_bf16_f32 v66, v72, v73
    v_cvt_pk_bf16_f32 v67, v74, v75
    buffer_store_dwordx4 v[64:67], v1, s[24:27], s44 offen offset:1024 sc1
    v_accvgpr_read_b32 v80, a36
    v_accvgpr_read_b32 v81, a37
    v_accvgpr_read_b32 v82, a38
    v_accvgpr_read_b32 v83, a39
    v_accvgpr_read_b32 v84, a52
    v_accvgpr_read_b32 v85, a53
    v_accvgpr_read_b32 v86, a54
    v_accvgpr_read_b32 v87, a55
    v_pk_mul_f32 v[80:81], v[80:81], v[48:49]
    v_pk_mul_f32 v[82:83], v[82:83], v[48:49]
    v_pk_mul_f32 v[84:85], v[84:85], v[48:49]
    v_pk_mul_f32 v[86:87], v[86:87], v[48:49]
    v_cvt_pk_bf16_f32 v76, v80, v81
    v_cvt_pk_bf16_f32 v77, v82, v83
    v_cvt_pk_bf16_f32 v78, v84, v85
    v_cvt_pk_bf16_f32 v79, v86, v87
    buffer_store_dwordx4 v[76:79], v1, s[24:27], s45 offen offset:1024 sc1
    v_accvgpr_read_b32 v68, a68
    v_accvgpr_read_b32 v69, a69
    v_accvgpr_read_b32 v70, a70
    v_accvgpr_read_b32 v71, a71
    v_accvgpr_read_b32 v72, a84
    v_accvgpr_read_b32 v73, a85
    v_accvgpr_read_b32 v74, a86
    v_accvgpr_read_b32 v75, a87
    v_pk_mul_f32 v[68:69], v[68:69], v[48:49]
    v_pk_mul_f32 v[70:71], v[70:71], v[48:49]
    v_pk_mul_f32 v[72:73], v[72:73], v[48:49]
    v_pk_mul_f32 v[74:75], v[74:75], v[48:49]
    v_cvt_pk_bf16_f32 v64, v68, v69
    v_cvt_pk_bf16_f32 v65, v70, v71
    v_cvt_pk_bf16_f32 v66, v72, v73
    v_cvt_pk_bf16_f32 v67, v74, v75
    buffer_store_dwordx4 v[64:67], v1, s[24:27], s46 offen offset:1024 sc1
    v_accvgpr_read_b32 v80, a100
    v_accvgpr_read_b32 v81, a101
    v_accvgpr_read_b32 v82, a102
    v_accvgpr_read_b32 v83, a103
    v_accvgpr_read_b32 v84, a116
    v_accvgpr_read_b32 v85, a117
    v_accvgpr_read_b32 v86, a118
    v_accvgpr_read_b32 v87, a119
    v_pk_mul_f32 v[80:81], v[80:81], v[48:49]
    v_pk_mul_f32 v[82:83], v[82:83], v[48:49]
    v_pk_mul_f32 v[84:85], v[84:85], v[48:49]
    v_pk_mul_f32 v[86:87], v[86:87], v[48:49]
    v_cvt_pk_bf16_f32 v76, v80, v81
    v_cvt_pk_bf16_f32 v77, v82, v83
    v_cvt_pk_bf16_f32 v78, v84, v85
    v_cvt_pk_bf16_f32 v79, v86, v87
    buffer_store_dwordx4 v[76:79], v1, s[24:27], s47 offen offset:1024 sc1
    s_lshl_b32 s63, s29, 1
    s_sub_u32 s63, 14, s63
    s_cmp_eq_u32 s63, 0
    s_cbranch_scc1 k2_sdone_72
k2_sloop_71:
    v_mfma_f32_16x16x32_bf16 v[248:251], v[60:63], v[192:195], v[248:251]
    ds_read_b128 a[224:227], v3 offset:8192
    v_mfma_f32_16x16x32_bf16 v[252:255], v[60:63], v[196:199], v[252:255]
    s_mov_b32 m0, s35
    v_exp_f32 v232, v160
    v_mfma_f32_16x16x32_bf16 v[248:251], v[60:63], v[200:203], v[248:251]
    s_add_u32 s53, s53, 16384
    buffer_load_dwordx4 v1, s[20:23], s33 offen offset:0 sc1 lds
    ds_read_b128 a[228:231], v3 offset:9216
    v_mfma_f32_16x16x32_bf16 v[252:255], v[60:63], v[204:207], v[252:255]
    s_waitcnt lgkmcnt(8)
    v_exp_f32 v233, v161
    v_mfma_f32_16x16x32_bf16 a[8:11], a[192:195], v[192:195], a[8:11]
    s_and_b32 s53, s53, 0xffff
    ds_read_b128 a[232:235], v3 offset:10240
    v_cvt_pk_bf16_f32 v208, v232, v233
    v_mfma_f32_16x16x32_bf16 a[12:15], a[192:195], v[196:199], a[12:15]
    v_exp_f32 v234, v162
    v_mfma_f32_16x16x32_bf16 a[24:27], a[196:199], v[192:195], a[24:27]
    ds_read_b128 a[236:239], v3 offset:11264
    v_mfma_f32_16x16x32_bf16 a[28:31], a[196:199], v[196:199], a[28:31]
    s_waitcnt lgkmcnt(8)
    v_exp_f32 v235, v163
    v_mfma_f32_16x16x32_bf16 a[40:43], a[200:203], v[192:195], a[40:43]
    s_add_u32 s35, s35, 0x4000
    ds_read_b128 a[240:243], v3 offset:12288
    v_cvt_pk_bf16_f32 v209, v234, v235
    v_mfma_f32_16x16x32_bf16 a[44:47], a[200:203], v[196:199], a[44:47]
    v_exp_f32 v236, v176
    v_mfma_f32_16x16x32_bf16 a[56:59], a[204:207], v[192:195], a[56:59]
    buffer_load_dwordx4 v1, s[20:23], s33 offen offset:1024 sc1 lds
    ds_read_b128 a[244:247], v3 offset:13312
    v_mfma_f32_16x16x32_bf16 a[60:63], a[204:207], v[196:199], a[60:63]
    s_waitcnt lgkmcnt(8)
    v_exp_f32 v237, v177
    v_mfma_f32_16x16x32_bf16 a[72:75], a[208:211], v[192:195], a[72:75]
    ds_read_b128 a[248:251], v3 offset:14336
    v_cvt_pk_bf16_f32 v210, v236, v237
    v_mfma_f32_16x16x32_bf16 a[76:79], a[208:211], v[196:199], a[76:79]
    v_exp_f32 v238, v178
    v_mfma_f32_16x16x32_bf16 a[88:91], a[212:215], v[192:195], a[88:91]
    ds_read_b128 a[252:255], v3 offset:15360
    v_or3_b32 v57, v208, v209, v210
    v_mfma_f32_16x16x32_bf16 a[92:95], a[212:215], v[196:199], a[92:95]
    s_waitcnt lgkmcnt(8)
    v_exp_f32 v239, v179
    v_mfma_f32_16x16x32_bf16 a[104:107], a[216:219], v[192:195], a[104:107]
    s_and_b32 s35, s35, 0xffff
    v_exp_f32 v240, v164
    v_mfma_f32_16x16x32_bf16 a[108:111], a[216:219], v[196:199], a[108:111]
    ds_read_b128 a[128:131], v2 offset:0
    v_cvt_pk_bf16_f32 v211, v238, v239
    v_mfma_f32_16x16x32_bf16 a[120:123], a[220:223], v[192:195], a[120:123]
    v_exp_f32 v241, v165
    v_mfma_f32_16x16x32_bf16 a[124:127], a[220:223], v[196:199], a[124:127]
    s_waitcnt lgkmcnt(7)
    buffer_load_dwordx4 v1, s[20:23], s33 offen offset:2048 sc1 lds
    ds_read_b128 a[132:135], v2 offset:1024
    v_mfma_f32_16x16x32_bf16 a[8:11], a[224:227], v[200:203], a[8:11]
    v_add_u32 v3, s53, v56
    v_cvt_pk_bf16_f32 v212, v240, v241
    v_mfma_f32_16x16x32_bf16 a[12:15], a[224:227], v[204:207], a[12:15]
    s_or_b32 s35, s35, 0x10000
    v_exp_f32 v242, v166
    v_mfma_f32_16x16x32_bf16 a[24:27], a[228:231], v[200:203], a[24:27]
    ds_read_b128 a[136:139], v2 offset:2048
    v_or3_b32 v57, v57, v211, v212
    v_mfma_f32_16x16x32_bf16 a[28:31], a[228:231], v[204:207], a[28:31]
    s_waitcnt lgkmcnt(7)
    v_exp_f32 v243, v167
    v_mfma_f32_16x16x32_bf16 a[40:43], a[232:235], v[200:203], a[40:43]
    ds_read_b128 a[140:143], v2 offset:3072
    v_cvt_pk_bf16_f32 v213, v242, v243
    v_mfma_f32_16x16x32_bf16 a[44:47], a[232:235], v[204:207], a[44:47]
    s_cmp_ge_u32 s36, s43
    s_cbranch_scc1 k2_prep_73
k2_prepret_74:
    v_mfma_f32_16x16x32_bf16 a[56:59], a[236:239], v[200:203], a[56:59]
    v_exp_f32 v244, v180
    v_mfma_f32_16x16x32_bf16 a[60:63], a[236:239], v[204:207], a[60:63]
    s_waitcnt lgkmcnt(6)
    buffer_load_dwordx4 v1, s[20:23], s33 offen offset:3072 sc1 lds
    ds_read_b128 a[144:147], v2 offset:4096
    v_mfma_f32_16x16x32_bf16 a[72:75], a[240:243], v[200:203], a[72:75]
    s_add_u32 s33, s33, 0x80000
    v_exp_f32 v245, v181
    v_mfma_f32_16x16x32_bf16 a[76:79], a[240:243], v[204:207], a[76:79]
    ds_read_b128 a[148:151], v2 offset:5120
    v_cvt_pk_bf16_f32 v214, v244, v245
    v_mfma_f32_16x16x32_bf16 a[88:91], a[244:247], v[200:203], a[88:91]
    v_exp_f32 v246, v182
    v_mfma_f32_16x16x32_bf16 a[92:95], a[244:247], v[204:207], a[92:95]
    s_waitcnt lgkmcnt(6)
    ds_read_b128 a[152:155], v2 offset:6144
    v_or3_b32 v57, v57, v213, v214
    v_mfma_f32_16x16x32_bf16 a[104:107], a[248:251], v[200:203], a[104:107]
    v_exp_f32 v247, v183
    v_mfma_f32_16x16x32_bf16 a[108:111], a[248:251], v[204:207], a[108:111]
    ds_read_b128 a[156:159], v2 offset:7168
    v_cvt_pk_bf16_f32 v215, v246, v247
    v_mfma_f32_16x16x32_bf16 a[120:123], a[252:255], v[200:203], a[120:123]
    v_exp_f32 v232, v168
    v_mfma_f32_16x16x32_bf16 a[124:127], a[252:255], v[204:207], a[124:127]
    s_waitcnt lgkmcnt(6)
    ds_read_b128 a[160:163], v2 offset:8192
    ds_read_b128 a[164:167], v2 offset:9216
    v_mfma_f32_16x16x32_bf16 v[128:131], a[128:131], v[96:99], v[16:19]
    s_waitcnt vmcnt(12)
    s_barrier
    v_exp_f32 v233, v169
    v_mfma_f32_16x16x32_bf16 v[132:135], a[128:131], v[112:115], v[20:23]
    s_mov_b32 m0, s34
    v_exp_f32 v234, v170
    v_mfma_f32_16x16x32_bf16 v[128:131], a[132:135], v[100:103], v[128:131]
    ds_read_b128 a[168:171], v2 offset:10240
    v_cvt_pk_bf16_f32 v216, v232, v233
    v_mfma_f32_16x16x32_bf16 v[132:135], a[132:135], v[116:119], v[132:135]
    s_waitcnt lgkmcnt(7)
    buffer_load_dwordx4 v1, s[16:19], s32 offen offset:0 sc1 lds
    ds_read_b128 a[172:175], v2 offset:11264
    v_mfma_f32_16x16x32_bf16 v[128:131], a[136:139], v[104:107], v[128:131]
    s_add_u32 s36, s36, 64
    v_exp_f32 v235, v171
    v_mfma_f32_16x16x32_bf16 v[132:135], a[136:139], v[120:123], v[132:135]
    v_or3_b32 v57, v57, v215, v216
    v_cvt_pk_bf16_f32 v217, v234, v235
    v_mfma_f32_16x16x32_bf16 v[128:131], a[140:143], v[108:111], v[128:131]
    v_exp_f32 v236, v184
    v_mfma_f32_16x16x32_bf16 v[132:135], a[140:143], v[124:127], v[132:135]
    s_waitcnt lgkmcnt(6)
    ds_read_b128 a[176:179], v2 offset:12288
    ds_read_b128 a[180:183], v2 offset:13312
    v_mfma_f32_16x16x32_bf16 v[144:147], a[144:147], v[96:99], v[32:35]
    s_add_u32 s34, s34, 0x4000
    v_exp_f32 v237, v185
    v_mfma_f32_16x16x32_bf16 v[148:151], a[144:147], v[112:115], v[36:39]
    s_add_u32 s52, s52, 16384
    v_exp_f32 v238, v186
    v_mfma_f32_16x16x32_bf16 v[144:147], a[148:151], v[100:103], v[144:147]
    s_and_b32 s52, s52, 0xffff
    ds_read_b128 a[184:187], v2 offset:14336
    v_cvt_pk_bf16_f32 v218, v236, v237
    v_mfma_f32_16x16x32_bf16 v[148:151], a[148:151], v[116:119], v[148:151]
    s_waitcnt lgkmcnt(7)
    buffer_load_dwordx4 v1, s[16:19], s32 offen offset:1024 sc1 lds
    ds_read_b128 a[188:191], v2 offset:15360
    v_mfma_f32_16x16x32_bf16 v[144:147], a[152:155], v[104:107], v[144:147]
    v_exp_f32 v239, v187
    v_mfma_f32_16x16x32_bf16 v[148:151], a[152:155], v[120:123], v[148:151]
    v_or3_b32 v57, v57, v217, v218
    v_cvt_pk_bf16_f32 v219, v238, v239
    v_mfma_f32_16x16x32_bf16 v[144:147], a[156:159], v[108:111], v[144:147]
    s_and_b32 s34, s34, 0xffff
    v_exp_f32 v240, v172
    v_mfma_f32_16x16x32_bf16 v[148:151], a[156:159], v[124:127], v[148:151]
    s_waitcnt lgkmcnt(6)
    v_exp_f32 v241, v173
    v_mfma_f32_16x16x32_bf16 v[136:139], a[160:163], v[96:99], v[24:27]
    ds_read_b128 a[192:195], v3 offset:0
    v_cvt_pk_bf16_f32 v220, v240, v241
    v_mfma_f32_16x16x32_bf16 v[140:143], a[160:163], v[112:115], v[28:31]
    v_exp_f32 v242, v174
    v_mfma_f32_16x16x32_bf16 v[136:139], a[164:167], v[100:103], v[136:139]
    buffer_load_dwordx4 v1, s[16:19], s32 offen offset:2048 sc1 lds
    ds_read_b128 a[196:199], v3 offset:1024
    v_mfma_f32_16x16x32_bf16 v[140:143], a[164:167], v[116:119], v[140:143]
    s_waitcnt lgkmcnt(6)
    v_add_u32 v2, s52, v1
    v_or3_b32 v57, v57, v219, v220
    v_mfma_f32_16x16x32_bf16 v[136:139], a[168:171], v[104:107], v[136:139]
    v_exp_f32 v243, v175
    v_mfma_f32_16x16x32_bf16 v[140:143], a[168:171], v[120:123], v[140:143]
    ds_read_b128 a[200:203], v3 offset:2048
    v_cvt_pk_bf16_f32 v221, v242, v243
    v_mfma_f32_16x16x32_bf16 v[136:139], a[172:175], v[108:111], v[136:139]
    v_exp_f32 v244, v188
    v_mfma_f32_16x16x32_bf16 v[140:143], a[172:175], v[124:127], v[140:143]
    s_waitcnt lgkmcnt(5)
    ds_read_b128 a[204:207], v3 offset:3072
    ds_read_b128 a[208:211], v3 offset:4096
    v_mfma_f32_16x16x32_bf16 v[152:155], a[176:179], v[96:99], v[40:43]
    v_exp_f32 v245, v189
    v_mfma_f32_16x16x32_bf16 v[156:159], a[176:179], v[112:115], v[44:47]
    buffer_load_dwordx4 v1, s[16:19], s32 offen offset:3072 sc1 lds
    ds_read_b128 a[212:215], v3 offset:5120
    v_mfma_f32_16x16x32_bf16 v[152:155], a[180:183], v[100:103], v[152:155]
    s_add_u32 s32, s32, 0x80000
    v_exp_f32 v246, v190
    v_mfma_f32_16x16x32_bf16 v[156:159], a[180:183], v[116:119], v[156:159]
    s_waitcnt lgkmcnt(6)
    ds_read_b128 a[216:219], v3 offset:6144
    v_cvt_pk_bf16_f32 v222, v244, v245
    v_mfma_f32_16x16x32_bf16 v[152:155], a[184:187], v[104:107], v[152:155]
    v_exp_f32 v247, v191
    v_mfma_f32_16x16x32_bf16 v[156:159], a[184:187], v[120:123], v[156:159]
    ds_read_b128 a[220:223], v3 offset:7168
    v_or3_b32 v57, v57, v221, v222
    v_mfma_f32_16x16x32_bf16 v[152:155], a[188:191], v[108:111], v[152:155]
    v_cvt_pk_bf16_f32 v223, v246, v247
    v_bitop3_b32 v57, v57, v223, s37 bitop3:0xa8
    v_mfma_f32_16x16x32_bf16 v[156:159], a[188:191], v[124:127], v[156:159]
    v_cmp_ne_u32 vcc, 0, v57
    s_cbranch_vccnz k2_rare_75
k2_ret_76:
    v_mfma_f32_16x16x32_bf16 v[248:251], v[60:63], v[208:211], v[248:251]
    ds_read_b128 a[224:227], v3 offset:8192
    v_mfma_f32_16x16x32_bf16 v[252:255], v[60:63], v[212:215], v[252:255]
    s_mov_b32 m0, s35
    v_exp_f32 v232, v128
    v_mfma_f32_16x16x32_bf16 v[248:251], v[60:63], v[216:219], v[248:251]
    s_add_u32 s53, s53, 16384
    buffer_load_dwordx4 v1, s[20:23], s33 offen offset:0 sc1 lds
    ds_read_b128 a[228:231], v3 offset:9216
    v_mfma_f32_16x16x32_bf16 v[252:255], v[60:63], v[220:223], v[252:255]
    s_waitcnt lgkmcnt(8)
    v_exp_f32 v233, v129
    v_mfma_f32_16x16x32_bf16 a[8:11], a[192:195], v[208:211], a[8:11]
    s_and_b32 s53, s53, 0xffff
    ds_read_b128 a[232:235], v3 offset:10240
    v_cvt_pk_bf16_f32 v192, v232, v233
    v_mfma_f32_16x16x32_bf16 a[12:15], a[192:195], v[212:215], a[12:15]
    v_exp_f32 v234, v130
    v_mfma_f32_16x16x32_bf16 a[24:27], a[196:199], v[208:211], a[24:27]
    ds_read_b128 a[236:239], v3 offset:11264
    v_mfma_f32_16x16x32_bf16 a[28:31], a[196:199], v[212:215], a[28:31]
    s_waitcnt lgkmcnt(8)
    v_exp_f32 v235, v131
    v_mfma_f32_16x16x32_bf16 a[40:43], a[200:203], v[208:211], a[40:43]
    s_add_u32 s35, s35, 0x4000
    ds_read_b128 a[240:243], v3 offset:12288
    v_cvt_pk_bf16_f32 v193, v234, v235
    v_mfma_f32_16x16x32_bf16 a[44:47], a[200:203], v[212:215], a[44:47]
    v_exp_f32 v236, v144
    v_mfma_f32_16x16x32_bf16 a[56:59], a[204:207], v[208:211], a[56:59]
    buffer_load_dwordx4 v1, s[20:23], s33 offen offset:1024 sc1 lds
    ds_read_b128 a[244:247], v3 offset:13312
    v_mfma_f32_16x16x32_bf16 a[60:63], a[204:207], v[212:215], a[60:63]
    s_waitcnt lgkmcnt(8)
    v_exp_f32 v237, v145
    v_mfma_f32_16x16x32_bf16 a[72:75], a[208:211], v[208:211], a[72:75]
    ds_read_b128 a[248:251], v3 offset:14336
    v_cvt_pk_bf16_f32 v194, v236, v237
    v_mfma_f32_16x16x32_bf16 a[76:79], a[208:211], v[212:215], a[76:79]
    v_exp_f32 v238, v146
    v_mfma_f32_16x16x32_bf16 a[88:91], a[212:215], v[208:211], a[88:91]
    ds_read_b128 a[252:255], v3 offset:15360
    v_or3_b32 v57, v192, v193, v194
    v_mfma_f32_16x16x32_bf16 a[92:95], a[212:215], v[212:215], a[92:95]
    s_waitcnt lgkmcnt(8)
    v_exp_f32 v239, v147
    v_mfma_f32_16x16x32_bf16 a[104:107], a[216:219], v[208:211], a[104:107]
    s_and_b32 s35, s35, 0xffff
    v_exp_f32 v240, v132
    v_mfma_f32_16x16x32_bf16 a[108:111], a[216:219], v[212:215], a[108:111]
    ds_read_b128 a[128:131], v2 offset:0
    v_cvt_pk_bf16_f32 v195, v238, v239
    v_mfma_f32_16x16x32_bf16 a[120:123], a[220:223], v[208:211], a[120:123]
    v_exp_f32 v241, v133
    v_mfma_f32_16x16x32_bf16 a[124:127], a[220:223], v[212:215], a[124:127]
    s_waitcnt lgkmcnt(7)
    buffer_load_dwordx4 v1, s[20:23], s33 offen offset:2048 sc1 lds
    ds_read_b128 a[132:135], v2 offset:1024
    v_mfma_f32_16x16x32_bf16 a[8:11], a[224:227], v[216:219], a[8:11]
    v_add_u32 v3, s53, v56
    v_cvt_pk_bf16_f32 v196, v240, v241
    v_mfma_f32_16x16x32_bf16 a[12:15], a[224:227], v[220:223], a[12:15]
    s_or_b32 s35, s35, 0x10000
    v_exp_f32 v242, v134
    v_mfma_f32_16x16x32_bf16 a[24:27], a[228:231], v[216:219], a[24:27]
    ds_read_b128 a[136:139], v2 offset:2048
    v_or3_b32 v57, v57, v195, v196
    v_mfma_f32_16x16x32_bf16 a[28:31], a[228:231], v[220:223], a[28:31]
    s_waitcnt lgkmcnt(7)
    v_exp_f32 v243, v135
    v_mfma_f32_16x16x32_bf16 a[40:43], a[232:235], v[216:219], a[40:43]
    ds_read_b128 a[140:143], v2 offset:3072
    v_cvt_pk_bf16_f32 v197, v242, v243
    v_mfma_f32_16x16x32_bf16 a[44:47], a[232:235], v[220:223], a[44:47]
    s_cmp_ge_u32 s36, s43
    s_cbranch_scc1 k2_prep_77
k2_prepret_78:
    v_mfma_f32_16x16x32_bf16 a[56:59], a[236:239], v[216:219], a[56:59]
    v_exp_f32 v244, v148
    v_mfma_f32_16x16x32_bf16 a[60:63], a[236:239], v[220:223], a[60:63]
    s_waitcnt lgkmcnt(6)
    buffer_load_dwordx4 v1, s[20:23], s33 offen offset:3072 sc1 lds
    ds_read_b128 a[144:147], v2 offset:4096
    v_mfma_f32_16x16x32_bf16 a[72:75], a[240:243], v[216:219], a[72:75]
    s_add_u32 s33, s33, 0x80000
    v_exp_f32 v245, v149
    v_mfma_f32_16x16x32_bf16 a[76:79], a[240:243], v[220:223], a[76:79]
    ds_read_b128 a[148:151], v2 offset:5120
    v_cvt_pk_bf16_f32 v198, v244, v245
    v_mfma_f32_16x16x32_bf16 a[88:91], a[244:247], v[216:219], a[88:91]
    v_exp_f32 v246, v150
    v_mfma_f32_16x16x32_bf16 a[92:95], a[244:247], v[220:223], a[92:95]
    s_waitcnt lgkmcnt(6)
    ds_read_b128 a[152:155], v2 offset:6144
    v_or3_b32 v57, v57, v197, v198
    v_mfma_f32_16x16x32_bf16 a[104:107], a[248:251], v[216:219], a[104:107]
    v_exp_f32 v247, v151
    v_mfma_f32_16x16x32_bf16 a[108:111], a[248:251], v[220:223], a[108:111]
    ds_read_b128 a[156:159], v2 offset:7168
    v_cvt_pk_bf16_f32 v199, v246, v247
    v_mfma_f32_16x16x32_bf16 a[120:123], a[252:255], v[216:219], a[120:123]
    v_exp_f32 v232, v136
    v_mfma_f32_16x16x32_bf16 a[124:127], a[252:255], v[220:223], a[124:127]
    s_waitcnt lgkmcnt(6)
    ds_read_b128 a[160:163], v2 offset:8192
    ds_read_b128 a[164:167], v2 offset:9216
    v_mfma_f32_16x16x32_bf16 v[160:163], a[128:131], v[96:99], v[16:19]
    s_waitcnt vmcnt(12)
    s_barrier
    v_exp_f32 v233, v137
    v_mfma_f32_16x16x32_bf16 v[164:167], a[128:131], v[112:115], v[20:23]
    s_mov_b32 m0, s34
    v_exp_f32 v234, v138
    v_mfma_f32_16x16x32_bf16 v[160:163], a[132:135], v[100:103], v[160:163]
    ds_read_b128 a[168:171], v2 offset:10240
    v_cvt_pk_bf16_f32 v200, v232, v233
    v_mfma_f32_16x16x32_bf16 v[164:167], a[132:135], v[116:119], v[164:167]
    s_waitcnt lgkmcnt(7)
    buffer_load_dwordx4 v1, s[16:19], s32 offen offset:0 sc1 lds
    ds_read_b128 a[172:175], v2 offset:11264
    v_mfma_f32_16x16x32_bf16 v[160:163], a[136:139], v[104:107], v[160:163]
    s_add_u32 s36, s36, 64
    v_exp_f32 v235, v139
    v_mfma_f32_16x16x32_bf16 v[164:167], a[136:139], v[120:123], v[164:167]
    v_or3_b32 v57, v57, v199, v200
    v_cvt_pk_bf16_f32 v201, v234, v235
    v_mfma_f32_16x16x32_bf16 v[160:163], a[140:143], v[108:111], v[160:163]
    v_exp_f32 v236, v152
    v_mfma_f32_16x16x32_bf16 v[164:167], a[140:143], v[124:127], v[164:167]
    s_waitcnt lgkmcnt(6)
    ds_read_b128 a[176:179], v2 offset:12288
    ds_read_b128 a[180:183], v2 offset:13312
    v_mfma_f32_16x16x32_bf16 v[176:179], a[144:147], v[96:99], v[32:35]
    s_add_u32 s34, s34, 0x4000
    v_exp_f32 v237, v153
    v_mfma_f32_16x16x32_bf16 v[180:183], a[144:147], v[112:115], v[36:39]
    s_add_u32 s52, s52, 16384
    v_exp_f32 v238, v154
    v_mfma_f32_16x16x32_bf16 v[176:179], a[148:151], v[100:103], v[176:179]
    s_and_b32 s52, s52, 0xffff
    ds_read_b128 a[184:187], v2 offset:14336
    v_cvt_pk_bf16_f32 v202, v236, v237
    v_mfma_f32_16x16x32_bf16 v[180:183], a[148:151], v[116:119], v[180:183]
    s_waitcnt lgkmcnt(7)
    buffer_load_dwordx4 v1, s[16:19], s32 offen offset:1024 sc1 lds
    ds_read_b128 a[188:191], v2 offset:15360
    v_mfma_f32_16x16x32_bf16 v[176:179], a[152:155], v[104:107], v[176:179]
    v_exp_f32 v239, v155
    v_mfma_f32_16x16x32_bf16 v[180:183], a[152:155], v[120:123], v[180:183]
    v_or3_b32 v57, v57, v201, v202
    v_cvt_pk_bf16_f32 v203, v238, v239
    v_mfma_f32_16x16x32_bf16 v[176:179], a[156:159], v[108:111], v[176:179]
    s_and_b32 s34, s34, 0xffff
    v_exp_f32 v240, v140
    v_mfma_f32_16x16x32_bf16 v[180:183], a[156:159], v[124:127], v[180:183]
    s_waitcnt lgkmcnt(6)
    v_exp_f32 v241, v141
    v_mfma_f32_16x16x32_bf16 v[168:171], a[160:163], v[96:99], v[24:27]
    ds_read_b128 a[192:195], v3 offset:0
    v_cvt_pk_bf16_f32 v204, v240, v241
    v_mfma_f32_16x16x32_bf16 v[172:175], a[160:163], v[112:115], v[28:31]
    v_exp_f32 v242, v142
    v_mfma_f32_16x16x32_bf16 v[168:171], a[164:167], v[100:103], v[168:171]
    buffer_load_dwordx4 v1, s[16:19], s32 offen offset:2048 sc1 lds
    ds_read_b128 a[196:199], v3 offset:1024
    v_mfma_f32_16x16x32_bf16 v[172:175], a[164:167], v[116:119], v[172:175]
    s_waitcnt lgkmcnt(6)
    v_add_u32 v2, s52, v1
    v_or3_b32 v57, v57, v203, v204
    v_mfma_f32_16x16x32_bf16 v[168:171], a[168:171], v[104:107], v[168:171]
    v_exp_f32 v243, v143
    v_mfma_f32_16x16x32_bf16 v[172:175], a[168:171], v[120:123], v[172:175]
    ds_read_b128 a[200:203], v3 offset:2048
    v_cvt_pk_bf16_f32 v205, v242, v243
    v_mfma_f32_16x16x32_bf16 v[168:171], a[172:175], v[108:111], v[168:171]
    v_exp_f32 v244, v156
    v_mfma_f32_16x16x32_bf16 v[172:175], a[172:175], v[124:127], v[172:175]
    s_waitcnt lgkmcnt(5)
    ds_read_b128 a[204:207], v3 offset:3072
    ds_read_b128 a[208:211], v3 offset:4096
    v_mfma_f32_16x16x32_bf16 v[184:187], a[176:179], v[96:99], v[40:43]
    s_sub_u32 s63, s63, 1
    v_exp_f32 v245, v157
    v_mfma_f32_16x16x32_bf16 v[188:191], a[176:179], v[112:115], v[44:47]
    buffer_load_dwordx4 v1, s[16:19], s32 offen offset:3072 sc1 lds
    ds_read_b128 a[212:215], v3 offset:5120
    v_mfma_f32_16x16x32_bf16 v[184:187], a[180:183], v[100:103], v[184:187]
    s_add_u32 s32, s32, 0x80000
    v_exp_f32 v246, v158
    v_mfma_f32_16x16x32_bf16 v[188:191], a[180:183], v[116:119], v[188:191]
    s_waitcnt lgkmcnt(6)
    ds_read_b128 a[216:219], v3 offset:6144
    v_cvt_pk_bf16_f32 v206, v244, v245
    v_mfma_f32_16x16x32_bf16 v[184:187], a[184:187], v[104:107], v[184:187]
    v_exp_f32 v247, v159
    v_mfma_f32_16x16x32_bf16 v[188:191], a[184:187], v[120:123], v[188:191]
    ds_read_b128 a[220:223], v3 offset:7168
    v_or3_b32 v57, v57, v205, v206
    v_mfma_f32_16x16x32_bf16 v[184:187], a[188:191], v[108:111], v[184:187]
    v_cvt_pk_bf16_f32 v207, v246, v247
    v_bitop3_b32 v57, v57, v207, s37 bitop3:0xa8
    v_mfma_f32_16x16x32_bf16 v[188:191], a[188:191], v[124:127], v[188:191]
    v_cmp_ne_u32 vcc, 0, v57
    s_cbranch_vccnz k2_rare_79
k2_ret_80:
    s_cmp_lg_u32 s63, 0
    s_cbranch_scc1 k2_sloop_71
k2_sdone_72:
    v_mfma_f32_16x16x32_bf16 v[248:251], v[60:63], v[192:195], v[248:251]
    s_waitcnt vmcnt(0)
    s_barrier
    ds_read_b128 a[224:227], v3 offset:8192
    v_exp_f32 v232, v160
    v_mfma_f32_16x16x32_bf16 v[252:255], v[60:63], v[196:199], v[252:255]
    ds_read_b128 a[228:231], v3 offset:9216
    v_exp_f32 v233, v161
    v_mfma_f32_16x16x32_bf16 v[248:251], v[60:63], v[200:203], v[248:251]
    s_add_u32 s53, s53, 16384
    v_exp_f32 v234, v162
    v_cvt_pk_bf16_f32 v208, v232, v233
    v_mfma_f32_16x16x32_bf16 v[252:255], v[60:63], v[204:207], v[252:255]
    s_waitcnt lgkmcnt(8)
    ds_read_b128 a[232:235], v3 offset:10240
    v_exp_f32 v235, v163
    v_mfma_f32_16x16x32_bf16 a[8:11], a[192:195], v[192:195], a[8:11]
    s_and_b32 s53, s53, 0xffff
    v_exp_f32 v236, v176
    v_cvt_pk_bf16_f32 v209, v234, v235
    v_mfma_f32_16x16x32_bf16 a[12:15], a[192:195], v[196:199], a[12:15]
    ds_read_b128 a[236:239], v3 offset:11264
    v_exp_f32 v237, v177
    v_mfma_f32_16x16x32_bf16 a[24:27], a[196:199], v[192:195], a[24:27]
    v_exp_f32 v238, v178
    v_cvt_pk_bf16_f32 v210, v236, v237
    v_mfma_f32_16x16x32_bf16 a[28:31], a[196:199], v[196:199], a[28:31]
    s_waitcnt lgkmcnt(8)
    v_exp_f32 v239, v179
    v_or3_b32 v57, v208, v209, v210
    v_mfma_f32_16x16x32_bf16 a[40:43], a[200:203], v[192:195], a[40:43]
    ds_read_b128 a[240:243], v3 offset:12288
    v_exp_f32 v240, v164
    v_mfma_f32_16x16x32_bf16 a[44:47], a[200:203], v[196:199], a[44:47]
    v_cvt_pk_bf16_f32 v211, v238, v239
    v_exp_f32 v241, v165
    v_mfma_f32_16x16x32_bf16 a[56:59], a[204:207], v[192:195], a[56:59]
    ds_read_b128 a[244:247], v3 offset:13312
    v_exp_f32 v242, v166
    v_mfma_f32_16x16x32_bf16 a[60:63], a[204:207], v[196:199], a[60:63]
    s_waitcnt lgkmcnt(8)
    v_cvt_pk_bf16_f32 v212, v240, v241
    v_exp_f32 v243, v167
    v_mfma_f32_16x16x32_bf16 a[72:75], a[208:211], v[192:195], a[72:75]
    ds_read_b128 a[248:251], v3 offset:14336
    v_or3_b32 v57, v57, v211, v212
    v_cvt_pk_bf16_f32 v213, v242, v243
    v_mfma_f32_16x16x32_bf16 a[76:79], a[208:211], v[196:199], a[76:79]
    ds_read_b128 a[252:255], v3 offset:15360
    v_exp_f32 v244, v180
    v_mfma_f32_16x16x32_bf16 a[88:91], a[212:215], v[192:195], a[88:91]
    v_exp_f32 v245, v181
    v_mfma_f32_16x16x32_bf16 a[92:95], a[212:215], v[196:199], a[92:95]
    s_waitcnt lgkmcnt(8)
    v_exp_f32 v246, v182
    v_cvt_pk_bf16_f32 v214, v244, v245
    v_mfma_f32_16x16x32_bf16 a[104:107], a[216:219], v[192:195], a[104:107]
    v_exp_f32 v247, v183
    v_or3_b32 v57, v57, v213, v214
    v_mfma_f32_16x16x32_bf16 a[108:111], a[216:219], v[196:199], a[108:111]
    v_exp_f32 v232, v168
    v_cvt_pk_bf16_f32 v215, v246, v247
    v_mfma_f32_16x16x32_bf16 a[120:123], a[220:223], v[192:195], a[120:123]
    v_exp_f32 v233, v169
    v_mfma_f32_16x16x32_bf16 a[124:127], a[220:223], v[196:199], a[124:127]
    s_waitcnt lgkmcnt(6)
    v_exp_f32 v234, v170
    v_cvt_pk_bf16_f32 v216, v232, v233
    v_mfma_f32_16x16x32_bf16 a[8:11], a[224:227], v[200:203], a[8:11]
    v_exp_f32 v235, v171
    v_or3_b32 v57, v57, v215, v216
    v_mfma_f32_16x16x32_bf16 a[12:15], a[224:227], v[204:207], a[12:15]
    v_add_u32 v3, s53, v56
    ds_read_b128 a[192:195], v3 offset:0
    ds_read_b128 a[196:199], v3 offset:1024
    v_mfma_f32_16x16x32_bf16 a[24:27], a[228:231], v[200:203], a[24:27]
    v_exp_f32 v236, v184
    v_cvt_pk_bf16_f32 v217, v234, v235
    v_mfma_f32_16x16x32_bf16 a[28:31], a[228:231], v[204:207], a[28:31]
    s_waitcnt lgkmcnt(6)
    ds_read_b128 a[200:203], v3 offset:2048
    v_exp_f32 v237, v185
    v_mfma_f32_16x16x32_bf16 a[40:43], a[232:235], v[200:203], a[40:43]
    ds_read_b128 a[204:207], v3 offset:3072
    v_exp_f32 v238, v186
    v_mfma_f32_16x16x32_bf16 a[44:47], a[232:235], v[204:207], a[44:47]
    v_cvt_pk_bf16_f32 v218, v236, v237
    v_exp_f32 v239, v187
    v_mfma_f32_16x16x32_bf16 a[56:59], a[236:239], v[200:203], a[56:59]
    ds_read_b128 a[208:211], v3 offset:4096
    v_or3_b32 v57, v57, v217, v218
    v_cvt_pk_bf16_f32 v219, v238, v239
    v_mfma_f32_16x16x32_bf16 a[60:63], a[236:239], v[204:207], a[60:63]
    s_waitcnt lgkmcnt(7)
    ds_read_b128 a[212:215], v3 offset:5120
    v_exp_f32 v240, v172
    v_mfma_f32_16x16x32_bf16 a[72:75], a[240:243], v[200:203], a[72:75]
    ds_read_b128 a[216:219], v3 offset:6144
    v_exp_f32 v241, v173
    v_mfma_f32_16x16x32_bf16 a[76:79], a[240:243], v[204:207], a[76:79]
    v_exp_f32 v242, v174
    v_cvt_pk_bf16_f32 v220, v240, v241
    v_mfma_f32_16x16x32_bf16 a[88:91], a[244:247], v[200:203], a[88:91]
    v_exp_f32 v243, v175
    v_or3_b32 v57, v57, v219, v220
    v_mfma_f32_16x16x32_bf16 a[92:95], a[244:247], v[204:207], a[92:95]
    s_waitcnt lgkmcnt(7)
    ds_read_b128 a[220:223], v3 offset:7168
    v_exp_f32 v244, v188
    v_mfma_f32_16x16x32_bf16 a[104:107], a[248:251], v[200:203], a[104:107]
    ds_read_b128 a[224:227], v3 offset:8192
    ds_read_b128 a[228:231], v3 offset:9216
    v_cvt_pk_bf16_f32 v221, v242, v243
    v_mfma_f32_16x16x32_bf16 a[108:111], a[248:251], v[204:207], a[108:111]
    ds_read_b128 a[232:235], v3 offset:10240
    v_exp_f32 v245, v189
    v_mfma_f32_16x16x32_bf16 a[120:123], a[252:255], v[200:203], a[120:123]
    v_exp_f32 v246, v190
    v_cvt_pk_bf16_f32 v222, v244, v245
    v_mfma_f32_16x16x32_bf16 a[124:127], a[252:255], v[204:207], a[124:127]
    v_exp_f32 v247, v191
    v_or3_b32 v57, v57, v221, v222
    v_cvt_pk_bf16_f32 v223, v246, v247
    v_bitop3_b32 v57, v57, v223, s37 bitop3:0xa8
    ds_read_b128 a[236:239], v3 offset:11264
    v_cmp_ne_u32 vcc, 0, v57
    ds_read_b128 a[240:243], v3 offset:12288
    ds_read_b128 a[244:247], v3 offset:13312
    ds_read_b128 a[248:251], v3 offset:14336
    ds_read_b128 a[252:255], v3 offset:15360
    s_cbranch_vccnz k2_rare_81
k2_ret_82:
    v_lshrrev_b32 v6, 4, v1
    v_and_b32 v6, 31, v6
    s_getpc_b64 s[40:41]
pc_83:
    s_add_u32 s40, s40, k3_kernel-pc_83
    s_addc_u32 s41, s41, 0
    v_lshlrev_b32 v224, 7, v6
    v_mov_b32 v225, s41
    v_add_co_u32 v224, vcc, s40, v224
    s_nop 1
    v_addc_co_u32 v225, vcc, 0, v225, vcc
    global_load_dword v7, v[224:225], off
    v_mfma_f32_16x16x32_bf16 v[248:251], v[60:63], v[208:211], v[248:251]
    s_lshl_b32 s31, s28, 19
    v_mfma_f32_16x16x32_bf16 v[252:255], v[60:63], v[212:215], v[252:255]
    s_lshl_b32 s44, s39, 6
    v_mfma_f32_16x16x32_bf16 v[248:251], v[60:63], v[216:219], v[248:251]
    s_add_u32 s44, s44, s31
    v_mfma_f32_16x16x32_bf16 v[252:255], v[60:63], v[220:223], v[252:255]
    s_waitcnt lgkmcnt(0)
    v_mfma_f32_16x16x32_bf16 a[8:11], a[192:195], v[208:211], a[8:11]
    s_add_u32 s45, s44, 131072
    v_mfma_f32_16x16x32_bf16 a[12:15], a[192:195], v[212:215], a[12:15]
    s_add_u32 s46, s44, 262144
    v_mfma_f32_16x16x32_bf16 a[8:11], a[224:227], v[216:219], a[8:11]
    s_add_u32 s47, s44, 393216
    v_mfma_f32_16x16x32_bf16 a[12:15], a[224:227], v[220:223], a[12:15]
    v_mfma_f32_16x16x32_bf16 a[24:27], a[196:199], v[208:211], a[24:27]
    v_mov_b32 v249, v248
    v_mov_b32 v253, v252
    s_nop 1
    v_mfma_f32_16x16x32_bf16 a[28:31], a[196:199], v[212:215], a[28:31]
    v_permlane16_swap_b32 v248, v249
    v_permlane16_swap_b32 v252, v253
    s_nop 1
    v_mfma_f32_16x16x32_bf16 a[24:27], a[228:231], v[216:219], a[24:27]
    v_add_f32 v248, v248, v249
    v_add_f32 v252, v252, v253
    v_mov_b32 v249, v248
    v_mfma_f32_16x16x32_bf16 a[28:31], a[228:231], v[220:223], a[28:31]
    v_mov_b32 v253, v252
    s_nop 1
    v_permlane32_swap_b32 v248, v249
    v_mfma_f32_16x16x32_bf16 a[40:43], a[200:203], v[208:211], a[40:43]
    v_permlane32_swap_b32 v252, v253
    s_nop 1
    v_add_f32 v248, v248, v249
    v_mfma_f32_16x16x32_bf16 a[44:47], a[200:203], v[212:215], a[44:47]
    v_add_f32 v252, v252, v253
    v_rcp_f32 v249, v248
    v_rcp_f32 v253, v252
    v_mfma_f32_16x16x32_bf16 a[40:43], a[232:235], v[216:219], a[40:43]
    v_rcp_f32 v248, v248
    v_rcp_f32 v252, v252
    s_nop 0
    v_mfma_f32_16x16x32_bf16 a[44:47], a[232:235], v[220:223], a[44:47]
    v_accvgpr_read_b32 v132, a8
    v_accvgpr_read_b32 v144, a12
    v_accvgpr_read_b32 v133, a9
    v_mfma_f32_16x16x32_bf16 a[56:59], a[204:207], v[208:211], a[56:59]
    v_accvgpr_read_b32 v145, a13
    v_accvgpr_read_b32 v134, a10
    v_accvgpr_read_b32 v146, a14
    v_mfma_f32_16x16x32_bf16 a[60:63], a[204:207], v[212:215], a[60:63]
    v_accvgpr_read_b32 v135, a11
    v_accvgpr_read_b32 v147, a15
    v_accvgpr_read_b32 v136, a24
    v_mfma_f32_16x16x32_bf16 a[56:59], a[236:239], v[216:219], a[56:59]
    v_accvgpr_read_b32 v148, a28
    v_accvgpr_read_b32 v137, a25
    v_accvgpr_read_b32 v149, a29
    v_mfma_f32_16x16x32_bf16 a[60:63], a[236:239], v[220:223], a[60:63]
    v_accvgpr_read_b32 v138, a26
    v_accvgpr_read_b32 v150, a30
    v_accvgpr_read_b32 v139, a27
    v_mfma_f32_16x16x32_bf16 a[72:75], a[208:211], v[208:211], a[72:75]
    v_accvgpr_read_b32 v151, a31
    v_mul_f32 v132, v132, v248
    v_mul_f32 v144, v144, v252
    v_mfma_f32_16x16x32_bf16 a[76:79], a[208:211], v[212:215], a[76:79]
    v_mul_f32 v133, v133, v248
    v_mul_f32 v145, v145, v252
    v_mul_f32 v134, v134, v248
    v_mfma_f32_16x16x32_bf16 a[72:75], a[240:243], v[216:219], a[72:75]
    v_mul_f32 v146, v146, v252
    v_mul_f32 v135, v135, v248
    v_mul_f32 v147, v147, v252
    v_mfma_f32_16x16x32_bf16 a[76:79], a[240:243], v[220:223], a[76:79]
    v_mul_f32 v136, v136, v248
    v_mul_f32 v148, v148, v252
    v_mul_f32 v137, v137, v248
    v_mfma_f32_16x16x32_bf16 a[88:91], a[212:215], v[208:211], a[88:91]
    v_mul_f32 v149, v149, v252
    v_mul_f32 v138, v138, v248
    v_mul_f32 v150, v150, v252
    v_mfma_f32_16x16x32_bf16 a[92:95], a[212:215], v[212:215], a[92:95]
    v_mul_f32 v139, v139, v248
    v_mul_f32 v151, v151, v252
    v_cvt_pk_bf16_f32 v128, v132, v133
    v_mfma_f32_16x16x32_bf16 a[88:91], a[244:247], v[216:219], a[88:91]
    v_cvt_pk_bf16_f32 v140, v144, v145
    v_cvt_pk_bf16_f32 v129, v134, v135
    v_cvt_pk_bf16_f32 v141, v146, v147
    v_mfma_f32_16x16x32_bf16 a[92:95], a[244:247], v[220:223], a[92:95]
    v_cvt_pk_bf16_f32 v130, v136, v137
    v_cvt_pk_bf16_f32 v142, v148, v149
    v_cvt_pk_bf16_f32 v131, v138, v139
    v_mfma_f32_16x16x32_bf16 a[104:107], a[216:219], v[208:211], a[104:107]
    buffer_store_dwordx4 v[128:131], v1, s[24:27], s44 offen offset:0 sc1
    v_cvt_pk_bf16_f32 v143, v150, v151
    buffer_store_dwordx4 v[140:143], v1, s[24:27], s44 offen offset:1024 sc1
    v_mfma_f32_16x16x32_bf16 a[108:111], a[216:219], v[212:215], a[108:111]
    v_accvgpr_read_b32 v156, a40
    v_accvgpr_read_b32 v168, a44
    v_accvgpr_read_b32 v157, a41
    v_mfma_f32_16x16x32_bf16 a[104:107], a[248:251], v[216:219], a[104:107]
    v_accvgpr_read_b32 v169, a45
    v_accvgpr_read_b32 v158, a42
    v_accvgpr_read_b32 v170, a46
    v_mfma_f32_16x16x32_bf16 a[108:111], a[248:251], v[220:223], a[108:111]
    v_accvgpr_read_b32 v159, a43
    v_accvgpr_read_b32 v171, a47
    v_accvgpr_read_b32 v160, a56
    v_mfma_f32_16x16x32_bf16 a[120:123], a[220:223], v[208:211], a[120:123]
    v_accvgpr_read_b32 v172, a60
    v_accvgpr_read_b32 v161, a57
    v_accvgpr_read_b32 v173, a61
    v_mfma_f32_16x16x32_bf16 a[124:127], a[220:223], v[212:215], a[124:127]
    v_accvgpr_read_b32 v162, a58
    v_accvgpr_read_b32 v174, a62
    v_accvgpr_read_b32 v163, a59
    v_mfma_f32_16x16x32_bf16 a[120:123], a[252:255], v[216:219], a[120:123]
    v_accvgpr_read_b32 v175, a63
    v_mul_f32 v156, v156, v248
    v_mul_f32 v168, v168, v252
    v_mfma_f32_16x16x32_bf16 a[124:127], a[252:255], v[220:223], a[124:127]
    v_mul_f32 v157, v157, v248
    v_mul_f32 v169, v169, v252
    v_mul_f32 v158, v158, v248
    v_mul_f32 v170, v170, v252
    v_mul_f32 v159, v159, v248
    v_mul_f32 v171, v171, v252
    v_mul_f32 v160, v160, v248
    v_mul_f32 v172, v172, v252
    v_mul_f32 v161, v161, v248
    v_mul_f32 v173, v173, v252
    v_mul_f32 v162, v162, v248
    v_mul_f32 v174, v174, v252
    v_mul_f32 v163, v163, v248
    v_mul_f32 v175, v175, v252
    v_cvt_pk_bf16_f32 v152, v156, v157
    v_cvt_pk_bf16_f32 v164, v168, v169
    v_cvt_pk_bf16_f32 v153, v158, v159
    v_cvt_pk_bf16_f32 v165, v170, v171
    v_cvt_pk_bf16_f32 v154, v160, v161
    v_cvt_pk_bf16_f32 v166, v172, v173
    v_cvt_pk_bf16_f32 v155, v162, v163
    v_cvt_pk_bf16_f32 v167, v174, v175
    buffer_store_dwordx4 v[152:155], v1, s[24:27], s45 offen offset:0 sc1
    buffer_store_dwordx4 v[164:167], v1, s[24:27], s45 offen offset:1024 sc1
    v_accvgpr_read_b32 v132, a72
    v_accvgpr_read_b32 v144, a76
    v_accvgpr_read_b32 v133, a73
    v_accvgpr_read_b32 v145, a77
    v_accvgpr_read_b32 v134, a74
    v_accvgpr_read_b32 v146, a78
    v_accvgpr_read_b32 v135, a75
    v_accvgpr_read_b32 v147, a79
    v_accvgpr_read_b32 v136, a88
    v_accvgpr_read_b32 v148, a92
    v_accvgpr_read_b32 v137, a89
    v_accvgpr_read_b32 v149, a93
    v_accvgpr_read_b32 v138, a90
    v_accvgpr_read_b32 v150, a94
    v_accvgpr_read_b32 v139, a91
    v_accvgpr_read_b32 v151, a95
    v_mul_f32 v132, v132, v248
    v_mul_f32 v144, v144, v252
    v_mul_f32 v133, v133, v248
    v_mul_f32 v145, v145, v252
    v_mul_f32 v134, v134, v248
    v_mul_f32 v146, v146, v252
    v_mul_f32 v135, v135, v248
    v_mul_f32 v147, v147, v252
    v_mul_f32 v136, v136, v248
    v_mul_f32 v148, v148, v252
    v_mul_f32 v137, v137, v248
    v_mul_f32 v149, v149, v252
    v_mul_f32 v138, v138, v248
    v_mul_f32 v150, v150, v252
    v_mul_f32 v139, v139, v248
    v_mul_f32 v151, v151, v252
    v_cvt_pk_bf16_f32 v128, v132, v133
    v_cvt_pk_bf16_f32 v140, v144, v145
    v_cvt_pk_bf16_f32 v129, v134, v135
    v_cvt_pk_bf16_f32 v141, v146, v147
    v_cvt_pk_bf16_f32 v130, v136, v137
    v_cvt_pk_bf16_f32 v142, v148, v149
    v_cvt_pk_bf16_f32 v131, v138, v139
    v_cvt_pk_bf16_f32 v143, v150, v151
    buffer_store_dwordx4 v[128:131], v1, s[24:27], s46 offen offset:0 sc1
    buffer_store_dwordx4 v[140:143], v1, s[24:27], s46 offen offset:1024 sc1
    v_accvgpr_read_b32 v156, a104
    v_accvgpr_read_b32 v168, a108
    v_accvgpr_read_b32 v157, a105
    v_accvgpr_read_b32 v169, a109
    v_accvgpr_read_b32 v158, a106
    v_accvgpr_read_b32 v170, a110
    v_accvgpr_read_b32 v159, a107
    v_accvgpr_read_b32 v171, a111
    v_accvgpr_read_b32 v160, a120
    v_accvgpr_read_b32 v172, a124
    v_accvgpr_read_b32 v161, a121
    v_accvgpr_read_b32 v173, a125
    v_accvgpr_read_b32 v162, a122
    v_accvgpr_read_b32 v174, a126
    v_accvgpr_read_b32 v163, a123
    v_accvgpr_read_b32 v175, a127
    v_mul_f32 v156, v156, v248
    v_mul_f32 v168, v168, v252
    v_mul_f32 v157, v157, v248
    v_mul_f32 v169, v169, v252
    v_mul_f32 v158, v158, v248
    v_mul_f32 v170, v170, v252
    v_mul_f32 v159, v159, v248
    v_mul_f32 v171, v171, v252
    v_mul_f32 v160, v160, v248
    v_mul_f32 v172, v172, v252
    v_mul_f32 v161, v161, v248
    v_mul_f32 v173, v173, v252
    v_mul_f32 v162, v162, v248
    v_mul_f32 v174, v174, v252
    v_mul_f32 v163, v163, v248
    v_mul_f32 v175, v175, v252
    v_cvt_pk_bf16_f32 v152, v156, v157
    v_cvt_pk_bf16_f32 v164, v168, v169
    v_cvt_pk_bf16_f32 v153, v158, v159
    v_cvt_pk_bf16_f32 v165, v170, v171
    v_cvt_pk_bf16_f32 v154, v160, v161
    v_cvt_pk_bf16_f32 v166, v172, v173
    v_cvt_pk_bf16_f32 v155, v162, v163
    v_cvt_pk_bf16_f32 v167, v174, v175
    buffer_store_dwordx4 v[152:155], v1, s[24:27], s47 offen offset:0 sc1
    buffer_store_dwordx4 v[164:167], v1, s[24:27], s47 offen offset:1024 sc1
k12_end_1:
    s_endpgm
k2_prep_48:
    s_sub_u32 s40, s36, s38
    v_subrev_u32 v6, s40, v4
    v_cmp_gt_i32 s[44:45], -16, v6
    v_cmp_gt_i32 s[46:47], -15, v6
    v_cmp_gt_i32 s[48:49], -14, v6
    v_cmp_gt_i32 s[50:51], -13, v6
    s_nop 1
    v_cndmask_b32 v20, v9, v5, s[44:45]
    v_cndmask_b32 v21, v9, v5, s[46:47]
    v_cndmask_b32 v22, v9, v5, s[48:49]
    v_cndmask_b32 v23, v9, v5, s[50:51]
    v_cmp_gt_i32 s[54:55], 0, v6
    v_cmp_gt_i32 s[56:57], 1, v6
    v_cmp_gt_i32 s[58:59], 2, v6
    v_cmp_gt_i32 s[60:61], 3, v6
    s_nop 1
    v_cndmask_b32 v16, v8, v5, s[54:55]
    v_cndmask_b32 v17, v8, v5, s[56:57]
    v_cndmask_b32 v18, v8, v5, s[58:59]
    v_cndmask_b32 v19, v8, v5, s[60:61]
    v_cndmask_b32 v36, v9, v5, s[54:55]
    v_cndmask_b32 v37, v9, v5, s[56:57]
    v_cndmask_b32 v38, v9, v5, s[58:59]
    v_cndmask_b32 v39, v9, v5, s[60:61]
    v_cmp_gt_i32 s[44:45], 16, v6
    v_cmp_gt_i32 s[46:47], 17, v6
    v_cmp_gt_i32 s[48:49], 18, v6
    v_cmp_gt_i32 s[50:51], 19, v6
    s_nop 1
    v_cndmask_b32 v32, v8, v5, s[44:45]
    v_cndmask_b32 v33, v8, v5, s[46:47]
    v_cndmask_b32 v34, v8, v5, s[48:49]
    v_cndmask_b32 v35, v8, v5, s[50:51]
    s_nop 1
    s_branch k2_prepret_49
k2_prep_50:
    s_sub_u32 s40, s36, s38
    v_subrev_u32 v6, s40, v4
    v_cmp_gt_i32 s[44:45], -16, v6
    v_cmp_gt_i32 s[46:47], -15, v6
    v_cmp_gt_i32 s[48:49], -14, v6
    v_cmp_gt_i32 s[50:51], -13, v6
    s_nop 1
    v_cndmask_b32 v20, v9, v5, s[44:45]
    v_cndmask_b32 v21, v9, v5, s[46:47]
    v_cndmask_b32 v22, v9, v5, s[48:49]
    v_cndmask_b32 v23, v9, v5, s[50:51]
    v_cmp_gt_i32 s[54:55], 0, v6
    v_cmp_gt_i32 s[56:57], 1, v6
    v_cmp_gt_i32 s[58:59], 2, v6
    v_cmp_gt_i32 s[60:61], 3, v6
    s_nop 1
    v_cndmask_b32 v16, v8, v5, s[54:55]
    v_cndmask_b32 v17, v8, v5, s[56:57]
    v_cndmask_b32 v18, v8, v5, s[58:59]
    v_cndmask_b32 v19, v8, v5, s[60:61]
    v_cndmask_b32 v36, v9, v5, s[54:55]
    v_cndmask_b32 v37, v9, v5, s[56:57]
    v_cndmask_b32 v38, v9, v5, s[58:59]
    v_cndmask_b32 v39, v9, v5, s[60:61]
    v_cmp_gt_i32 s[44:45], 16, v6
    v_cmp_gt_i32 s[46:47], 17, v6
    v_cmp_gt_i32 s[48:49], 18, v6
    v_cmp_gt_i32 s[50:51], 19, v6
    s_nop 1
    v_cndmask_b32 v32, v8, v5, s[44:45]
    v_cndmask_b32 v33, v8, v5, s[46:47]
    v_cndmask_b32 v34, v8, v5, s[48:49]
    v_cndmask_b32 v35, v8, v5, s[50:51]
    s_nop 1
    s_branch k2_prepret_51
k2_prep_55:
    s_sub_u32 s40, s36, s38
    v_subrev_u32 v6, s40, v4
    v_cmp_gt_i32 s[44:45], -16, v6
    v_cmp_gt_i32 s[46:47], -15, v6
    v_cmp_gt_i32 s[48:49], -14, v6
    v_cmp_gt_i32 s[50:51], -13, v6
    s_nop 1
    v_cndmask_b32 v20, v9, v5, s[44:45]
    v_cndmask_b32 v21, v9, v5, s[46:47]
    v_cndmask_b32 v22, v9, v5, s[48:49]
    v_cndmask_b32 v23, v9, v5, s[50:51]
    v_cmp_gt_i32 s[54:55], 0, v6
    v_cmp_gt_i32 s[56:57], 1, v6
    v_cmp_gt_i32 s[58:59], 2, v6
    v_cmp_gt_i32 s[60:61], 3, v6
    s_nop 1
    v_cndmask_b32 v16, v8, v5, s[54:55]
    v_cndmask_b32 v17, v8, v5, s[56:57]
    v_cndmask_b32 v18, v8, v5, s[58:59]
    v_cndmask_b32 v19, v8, v5, s[60:61]
    v_cndmask_b32 v36, v9, v5, s[54:55]
    v_cndmask_b32 v37, v9, v5, s[56:57]
    v_cndmask_b32 v38, v9, v5, s[58:59]
    v_cndmask_b32 v39, v9, v5, s[60:61]
    v_cmp_gt_i32 s[44:45], 16, v6
    v_cmp_gt_i32 s[46:47], 17, v6
    v_cmp_gt_i32 s[48:49], 18, v6
    v_cmp_gt_i32 s[50:51], 19, v6
    s_nop 1
    v_cndmask_b32 v32, v8, v5, s[44:45]
    v_cndmask_b32 v33, v8, v5, s[46:47]
    v_cndmask_b32 v34, v8, v5, s[48:49]
    v_cndmask_b32 v35, v8, v5, s[50:51]
    s_nop 1
    s_branch k2_prepret_56
k2_prep_59:
    s_sub_u32 s40, s36, s38
    v_subrev_u32 v6, s40, v4
    v_cmp_gt_i32 s[44:45], -16, v6
    v_cmp_gt_i32 s[46:47], -15, v6
    v_cmp_gt_i32 s[48:49], -14, v6
    v_cmp_gt_i32 s[50:51], -13, v6
    s_nop 1
    v_cndmask_b32 v20, v9, v5, s[44:45]
    v_cndmask_b32 v21, v9, v5, s[46:47]
    v_cndmask_b32 v22, v9, v5, s[48:49]
    v_cndmask_b32 v23, v9, v5, s[50:51]
    v_cmp_gt_i32 s[54:55], 0, v6
    v_cmp_gt_i32 s[56:57], 1, v6
    v_cmp_gt_i32 s[58:59], 2, v6
    v_cmp_gt_i32 s[60:61], 3, v6
    s_nop 1
    v_cndmask_b32 v16, v8, v5, s[54:55]
    v_cndmask_b32 v17, v8, v5, s[56:57]
    v_cndmask_b32 v18, v8, v5, s[58:59]
    v_cndmask_b32 v19, v8, v5, s[60:61]
    v_cndmask_b32 v36, v9, v5, s[54:55]
    v_cndmask_b32 v37, v9, v5, s[56:57]
    v_cndmask_b32 v38, v9, v5, s[58:59]
    v_cndmask_b32 v39, v9, v5, s[60:61]
    v_cmp_gt_i32 s[44:45], 16, v6
    v_cmp_gt_i32 s[46:47], 17, v6
    v_cmp_gt_i32 s[48:49], 18, v6
    v_cmp_gt_i32 s[50:51], 19, v6
    s_nop 1
    v_cndmask_b32 v32, v8, v5, s[44:45]
    v_cndmask_b32 v33, v8, v5, s[46:47]
    v_cndmask_b32 v34, v8, v5, s[48:49]
    v_cndmask_b32 v35, v8, v5, s[50:51]
    s_nop 1
    s_branch k2_prepret_60
k2_prep_63:
    s_sub_u32 s40, s36, s39
    v_subrev_u32 v6, s40, v4
    v_cmp_gt_i32 s[44:45], -16, v6
    v_cmp_gt_i32 s[46:47], -15, v6
    v_cmp_gt_i32 s[48:49], -14, v6
    v_cmp_gt_i32 s[50:51], -13, v6
    s_nop 1
    v_cndmask_b32 v20, v11, v5, s[44:45]
    v_cndmask_b32 v21, v11, v5, s[46:47]
    v_cndmask_b32 v22, v11, v5, s[48:49]
    v_cndmask_b32 v23, v11, v5, s[50:51]
    v_cmp_gt_i32 s[54:55], 0, v6
    v_cmp_gt_i32 s[56:57], 1, v6
    v_cmp_gt_i32 s[58:59], 2, v6
    v_cmp_gt_i32 s[60:61], 3, v6
    s_nop 1
    v_cndmask_b32 v16, v10, v5, s[54:55]
    v_cndmask_b32 v17, v10, v5, s[56:57]
    v_cndmask_b32 v18, v10, v5, s[58:59]
    v_cndmask_b32 v19, v10, v5, s[60:61]
    v_cndmask_b32 v36, v11, v5, s[54:55]
    v_cndmask_b32 v37, v11, v5, s[56:57]
    v_cndmask_b32 v38, v11, v5, s[58:59]
    v_cndmask_b32 v39, v11, v5, s[60:61]
    v_cmp_gt_i32 s[44:45], 16, v6
    v_cmp_gt_i32 s[46:47], 17, v6
    v_cmp_gt_i32 s[48:49], 18, v6
    v_cmp_gt_i32 s[50:51], 19, v6
    s_nop 1
    v_cndmask_b32 v32, v10, v5, s[44:45]
    v_cndmask_b32 v33, v10, v5, s[46:47]
    v_cndmask_b32 v34, v10, v5, s[48:49]
    v_cndmask_b32 v35, v10, v5, s[50:51]
    v_cndmask_b32 v28, v11, v5, s[44:45]
    v_cndmask_b32 v29, v11, v5, s[46:47]
    v_cndmask_b32 v30, v11, v5, s[48:49]
    v_cndmask_b32 v31, v11, v5, s[50:51]
    v_cmp_gt_i32 s[54:55], 32, v6
    v_cmp_gt_i32 s[56:57], 33, v6
    v_cmp_gt_i32 s[58:59], 34, v6
    v_cmp_gt_i32 s[60:61], 35, v6
    s_nop 1
    v_cndmask_b32 v24, v10, v5, s[54:55]
    v_cndmask_b32 v25, v10, v5, s[56:57]
    v_cndmask_b32 v26, v10, v5, s[58:59]
    v_cndmask_b32 v27, v10, v5, s[60:61]
    v_cndmask_b32 v44, v11, v5, s[54:55]
    v_cndmask_b32 v45, v11, v5, s[56:57]
    v_cndmask_b32 v46, v11, v5, s[58:59]
    v_cndmask_b32 v47, v11, v5, s[60:61]
    v_cmp_gt_i32 s[44:45], 48, v6
    v_cmp_gt_i32 s[46:47], 49, v6
    v_cmp_gt_i32 s[48:49], 50, v6
    v_cmp_gt_i32 s[50:51], 51, v6
    s_nop 1
    v_cndmask_b32 v40, v10, v5, s[44:45]
    v_cndmask_b32 v41, v10, v5, s[46:47]
    v_cndmask_b32 v42, v10, v5, s[48:49]
    v_cndmask_b32 v43, v10, v5, s[50:51]
    s_nop 1
    s_branch k2_prepret_64
k2_prep_67:
    s_sub_u32 s40, s36, s39
    v_subrev_u32 v6, s40, v4
    v_cmp_gt_i32 s[44:45], -16, v6
    v_cmp_gt_i32 s[46:47], -15, v6
    v_cmp_gt_i32 s[48:49], -14, v6
    v_cmp_gt_i32 s[50:51], -13, v6
    s_nop 1
    v_cndmask_b32 v20, v11, v5, s[44:45]
    v_cndmask_b32 v21, v11, v5, s[46:47]
    v_cndmask_b32 v22, v11, v5, s[48:49]
    v_cndmask_b32 v23, v11, v5, s[50:51]
    v_cmp_gt_i32 s[54:55], 0, v6
    v_cmp_gt_i32 s[56:57], 1, v6
    v_cmp_gt_i32 s[58:59], 2, v6
    v_cmp_gt_i32 s[60:61], 3, v6
    s_nop 1
    v_cndmask_b32 v16, v10, v5, s[54:55]
    v_cndmask_b32 v17, v10, v5, s[56:57]
    v_cndmask_b32 v18, v10, v5, s[58:59]
    v_cndmask_b32 v19, v10, v5, s[60:61]
    v_cndmask_b32 v36, v11, v5, s[54:55]
    v_cndmask_b32 v37, v11, v5, s[56:57]
    v_cndmask_b32 v38, v11, v5, s[58:59]
    v_cndmask_b32 v39, v11, v5, s[60:61]
    v_cmp_gt_i32 s[44:45], 16, v6
    v_cmp_gt_i32 s[46:47], 17, v6
    v_cmp_gt_i32 s[48:49], 18, v6
    v_cmp_gt_i32 s[50:51], 19, v6
    s_nop 1
    v_cndmask_b32 v32, v10, v5, s[44:45]
    v_cndmask_b32 v33, v10, v5, s[46:47]
    v_cndmask_b32 v34, v10, v5, s[48:49]
    v_cndmask_b32 v35, v10, v5, s[50:51]
    v_cndmask_b32 v28, v11, v5, s[44:45]
    v_cndmask_b32 v29, v11, v5, s[46:47]
    v_cndmask_b32 v30, v11, v5, s[48:49]
    v_cndmask_b32 v31, v11, v5, s[50:51]
    v_cmp_gt_i32 s[54:55], 32, v6
    v_cmp_gt_i32 s[56:57], 33, v6
    v_cmp_gt_i32 s[58:59], 34, v6
    v_cmp_gt_i32 s[60:61], 35, v6
    s_nop 1
    v_cndmask_b32 v24, v10, v5, s[54:55]
    v_cndmask_b32 v25, v10, v5, s[56:57]
    v_cndmask_b32 v26, v10, v5, s[58:59]
    v_cndmask_b32 v27, v10, v5, s[60:61]
    v_cndmask_b32 v44, v11, v5, s[54:55]
    v_cndmask_b32 v45, v11, v5, s[56:57]
    v_cndmask_b32 v46, v11, v5, s[58:59]
    v_cndmask_b32 v47, v11, v5, s[60:61]
    v_cmp_gt_i32 s[44:45], 48, v6
    v_cmp_gt_i32 s[46:47], 49, v6
    v_cmp_gt_i32 s[48:49], 50, v6
    v_cmp_gt_i32 s[50:51], 51, v6
    s_nop 1
    v_cndmask_b32 v40, v10, v5, s[44:45]
    v_cndmask_b32 v41, v10, v5, s[46:47]
    v_cndmask_b32 v42, v10, v5, s[48:49]
    v_cndmask_b32 v43, v10, v5, s[50:51]
    s_nop 1
    s_branch k2_prepret_68
k2_prep_73:
    s_sub_u32 s40, s36, s39
    v_subrev_u32 v6, s40, v4
    v_cmp_gt_i32 s[44:45], -16, v6
    v_cmp_gt_i32 s[46:47], -15, v6
    v_cmp_gt_i32 s[48:49], -14, v6
    v_cmp_gt_i32 s[50:51], -13, v6
    s_nop 1
    v_cndmask_b32 v20, v11, v5, s[44:45]
    v_cndmask_b32 v21, v11, v5, s[46:47]
    v_cndmask_b32 v22, v11, v5, s[48:49]
    v_cndmask_b32 v23, v11, v5, s[50:51]
    v_cmp_gt_i32 s[54:55], 0, v6
    v_cmp_gt_i32 s[56:57], 1, v6
    v_cmp_gt_i32 s[58:59], 2, v6
    v_cmp_gt_i32 s[60:61], 3, v6
    s_nop 1
    v_cndmask_b32 v16, v10, v5, s[54:55]
    v_cndmask_b32 v17, v10, v5, s[56:57]
    v_cndmask_b32 v18, v10, v5, s[58:59]
    v_cndmask_b32 v19, v10, v5, s[60:61]
    v_cndmask_b32 v36, v11, v5, s[54:55]
    v_cndmask_b32 v37, v11, v5, s[56:57]
    v_cndmask_b32 v38, v11, v5, s[58:59]
    v_cndmask_b32 v39, v11, v5, s[60:61]
    v_cmp_gt_i32 s[44:45], 16, v6
    v_cmp_gt_i32 s[46:47], 17, v6
    v_cmp_gt_i32 s[48:49], 18, v6
    v_cmp_gt_i32 s[50:51], 19, v6
    s_nop 1
    v_cndmask_b32 v32, v10, v5, s[44:45]
    v_cndmask_b32 v33, v10, v5, s[46:47]
    v_cndmask_b32 v34, v10, v5, s[48:49]
    v_cndmask_b32 v35, v10, v5, s[50:51]
    v_cndmask_b32 v28, v11, v5, s[44:45]
    v_cndmask_b32 v29, v11, v5, s[46:47]
    v_cndmask_b32 v30, v11, v5, s[48:49]
    v_cndmask_b32 v31, v11, v5, s[50:51]
    v_cmp_gt_i32 s[54:55], 32, v6
    v_cmp_gt_i32 s[56:57], 33, v6
    v_cmp_gt_i32 s[58:59], 34, v6
    v_cmp_gt_i32 s[60:61], 35, v6
    s_nop 1
    v_cndmask_b32 v24, v10, v5, s[54:55]
    v_cndmask_b32 v25, v10, v5, s[56:57]
    v_cndmask_b32 v26, v10, v5, s[58:59]
    v_cndmask_b32 v27, v10, v5, s[60:61]
    v_cndmask_b32 v44, v11, v5, s[54:55]
    v_cndmask_b32 v45, v11, v5, s[56:57]
    v_cndmask_b32 v46, v11, v5, s[58:59]
    v_cndmask_b32 v47, v11, v5, s[60:61]
    v_cmp_gt_i32 s[44:45], 48, v6
    v_cmp_gt_i32 s[46:47], 49, v6
    v_cmp_gt_i32 s[48:49], 50, v6
    v_cmp_gt_i32 s[50:51], 51, v6
    s_nop 1
    v_cndmask_b32 v40, v10, v5, s[44:45]
    v_cndmask_b32 v41, v10, v5, s[46:47]
    v_cndmask_b32 v42, v10, v5, s[48:49]
    v_cndmask_b32 v43, v10, v5, s[50:51]
    s_nop 1
    s_branch k2_prepret_74
k2_prep_77:
    s_sub_u32 s40, s36, s39
    v_subrev_u32 v6, s40, v4
    v_cmp_gt_i32 s[44:45], -16, v6
    v_cmp_gt_i32 s[46:47], -15, v6
    v_cmp_gt_i32 s[48:49], -14, v6
    v_cmp_gt_i32 s[50:51], -13, v6
    s_nop 1
    v_cndmask_b32 v20, v11, v5, s[44:45]
    v_cndmask_b32 v21, v11, v5, s[46:47]
    v_cndmask_b32 v22, v11, v5, s[48:49]
    v_cndmask_b32 v23, v11, v5, s[50:51]
    v_cmp_gt_i32 s[54:55], 0, v6
    v_cmp_gt_i32 s[56:57], 1, v6
    v_cmp_gt_i32 s[58:59], 2, v6
    v_cmp_gt_i32 s[60:61], 3, v6
    s_nop 1
    v_cndmask_b32 v16, v10, v5, s[54:55]
    v_cndmask_b32 v17, v10, v5, s[56:57]
    v_cndmask_b32 v18, v10, v5, s[58:59]
    v_cndmask_b32 v19, v10, v5, s[60:61]
    v_cndmask_b32 v36, v11, v5, s[54:55]
    v_cndmask_b32 v37, v11, v5, s[56:57]
    v_cndmask_b32 v38, v11, v5, s[58:59]
    v_cndmask_b32 v39, v11, v5, s[60:61]
    v_cmp_gt_i32 s[44:45], 16, v6
    v_cmp_gt_i32 s[46:47], 17, v6
    v_cmp_gt_i32 s[48:49], 18, v6
    v_cmp_gt_i32 s[50:51], 19, v6
    s_nop 1
    v_cndmask_b32 v32, v10, v5, s[44:45]
    v_cndmask_b32 v33, v10, v5, s[46:47]
    v_cndmask_b32 v34, v10, v5, s[48:49]
    v_cndmask_b32 v35, v10, v5, s[50:51]
    v_cndmask_b32 v28, v11, v5, s[44:45]
    v_cndmask_b32 v29, v11, v5, s[46:47]
    v_cndmask_b32 v30, v11, v5, s[48:49]
    v_cndmask_b32 v31, v11, v5, s[50:51]
    v_cmp_gt_i32 s[54:55], 32, v6
    v_cmp_gt_i32 s[56:57], 33, v6
    v_cmp_gt_i32 s[58:59], 34, v6
    v_cmp_gt_i32 s[60:61], 35, v6
    s_nop 1
    v_cndmask_b32 v24, v10, v5, s[54:55]
    v_cndmask_b32 v25, v10, v5, s[56:57]
    v_cndmask_b32 v26, v10, v5, s[58:59]
    v_cndmask_b32 v27, v10, v5, s[60:61]
    v_cndmask_b32 v44, v11, v5, s[54:55]
    v_cndmask_b32 v45, v11, v5, s[56:57]
    v_cndmask_b32 v46, v11, v5, s[58:59]
    v_cndmask_b32 v47, v11, v5, s[60:61]
    v_cmp_gt_i32 s[44:45], 48, v6
    v_cmp_gt_i32 s[46:47], 49, v6
    v_cmp_gt_i32 s[48:49], 50, v6
    v_cmp_gt_i32 s[50:51], 51, v6
    s_nop 1
    v_cndmask_b32 v40, v10, v5, s[44:45]
    v_cndmask_b32 v41, v10, v5, s[46:47]
    v_cndmask_b32 v42, v10, v5, s[48:49]
    v_cndmask_b32 v43, v10, v5, s[50:51]
    s_nop 1
    s_branch k2_prepret_78
k12_ool_10:
    buffer_load_dword v52, v8, s[24:27], 0 offen sc1
    s_branch k12_oolret_11
k12_ool_12:
    s_mov_b64 exec, 1
    buffer_atomic_add v9, v8, s[24:27], 0 offen sc1
    s_mov_b64 exec, -1
    s_branch k12_oolret_13
k12_ool_14:
    buffer_load_dword v51, v50, s[12:15], s56 offen
    s_branch k12_oolret_15
k12_ool_18:
    v_readfirstlane_b32 s31, v52
    s_cmp_ge_u32 s31, 256
    s_cbranch_scc1 spin_ok_16
    s_mov_b32 s40, 1048576
spin_17:
    s_sleep 8
    buffer_load_dword v52, v8, s[24:27], 0 offen sc1
    s_waitcnt vmcnt(0)
    v_readfirstlane_b32 s31, v52
    s_sub_u32 s40, s40, 1
    s_cselect_b32 s31, -1, s31
    s_cmp_lt_u32 s31, 256
    s_cbranch_scc1 spin_17
spin_ok_16:
    s_branch k12_oolret_19
k12_ool_20:
    s_mov_b64 exec, 1
    buffer_atomic_add v9, v8, s[24:27], 0 offen sc1
    s_mov_b64 exec, -1
    s_branch k12_oolret_21
k12_ool_22:
    global_load_dword v51, v[2:3], off
    s_branch k12_oolret_23
k12_ool_26:
    buffer_load_dword v52, v8, s[24:27], 0 offen sc1
    s_branch k12_oolret_27
k12_ool_28:
    s_mov_b64 exec, 1
    buffer_atomic_add v9, v8, s[24:27], 0 offen sc1
    s_mov_b64 exec, -1
    s_branch k12_oolret_29
k12_ool_30:
    buffer_load_dword v51, v50, s[12:15], s56 offen
    s_branch k12_oolret_31
k12_ool_34:
    v_readfirstlane_b32 s31, v52
    s_cmp_ge_u32 s31, 256
    s_cbranch_scc1 spin_ok_32
    s_mov_b32 s40, 1048576
spin_33:
    s_sleep 8
    buffer_load_dword v52, v8, s[24:27], 0 offen sc1
    s_waitcnt vmcnt(0)
    v_readfirstlane_b32 s31, v52
    s_sub_u32 s40, s40, 1
    s_cselect_b32 s31, -1, s31
    s_cmp_lt_u32 s31, 256
    s_cbranch_scc1 spin_33
spin_ok_32:
    s_branch k12_oolret_35
k12_ool_36:
    s_mov_b64 exec, 1
    buffer_atomic_add v9, v8, s[24:27], 0 offen sc1
    s_mov_b64 exec, -1
    s_branch k12_oolret_37
k12_ool_38:
    global_load_dword v51, v[2:3], off
    s_branch k12_oolret_39
k12_ool_40:
    s_mov_b64 exec, 1
    buffer_atomic_add v9, v8, s[24:27], s54 offen sc1
    s_mov_b64 exec, -1
    s_branch k12_oolret_41
k12_ool_42:
    buffer_load_dword v52, v8, s[24:27], s55 offen sc1
    s_branch k12_oolret_43
k12_ool_46:
    s_waitcnt vmcnt(12)
    v_readfirstlane_b32 s31, v52
    s_cmp_ge_u32 s31, 16
    s_cbranch_scc1 spin_ok_44
    s_mov_b32 s40, 1048576
spin_45:
    s_sleep 8
    buffer_load_dword v52, v8, s[24:27], s55 offen sc1
    s_waitcnt vmcnt(0)
    v_readfirstlane_b32 s31, v52
    s_sub_u32 s40, s40, 1
    s_cselect_b32 s31, -1, s31
    s_cmp_lt_u32 s31, 16
    s_cbranch_scc1 spin_45
spin_ok_44:
    s_branch k12_oolret_47
k2_rare_52:
    s_nop 7
    v_max_f32 v52, v128, v129
    v_max3_f32 v52, v52, v130, v131
    v_max3_f32 v52, v52, v144, v145
    v_max3_f32 v52, v52, v146, v147
    v_max_f32 v53, v132, v133
    v_max3_f32 v53, v53, v134, v135
    v_max3_f32 v53, v53, v148, v149
    v_max3_f32 v53, v53, v150, v151
    v_max_f32 v54, v136, v137
    v_max3_f32 v54, v54, v138, v139
    v_max3_f32 v54, v54, v152, v153
    v_max3_f32 v54, v54, v154, v155
    v_max_f32 v55, v140, v141
    v_max3_f32 v55, v55, v142, v143
    v_max3_f32 v55, v55, v156, v157
    v_max3_f32 v55, v55, v158, v159
    v_mov_b32 v224, v52
    v_mov_b32 v225, v53
    v_mov_b32 v226, v54
    v_mov_b32 v227, v55
    s_nop 1
    v_permlane16_swap_b32 v52, v224
    v_permlane16_swap_b32 v53, v225
    v_permlane16_swap_b32 v54, v226
    v_permlane16_swap_b32 v55, v227
    s_nop 1
    v_max_f32 v52, v52, v224
    v_max_f32 v53, v53, v225
    v_max_f32 v54, v54, v226
    v_max_f32 v55, v55, v227
    v_mov_b32 v224, v52
    v_mov_b32 v225, v53
    v_mov_b32 v226, v54
    v_mov_b32 v227, v55
    s_nop 1
    v_permlane32_swap_b32 v52, v224
    v_permlane32_swap_b32 v53, v225
    v_permlane32_swap_b32 v54, v226
    v_permlane32_swap_b32 v55, v227
    s_nop 1
    v_max_f32 v52, v52, v224
    v_max_f32 v53, v53, v225
    v_max_f32 v54, v54, v226
    v_max_f32 v55, v55, v227
    v_add_f32 v52, 0x41400000, v52
    v_max_f32 v52, 0, v52
    v_add_f32 v53, 0x41400000, v53
    v_max_f32 v53, 0, v53
    v_add_f32 v54, 0x41400000, v54
    v_max_f32 v54, 0, v54
    v_add_f32 v55, 0x41400000, v55
    v_max_f32 v55, 0, v55
    v_sub_f32 v128, v128, v52
    v_sub_f32 v129, v129, v52
    v_sub_f32 v130, v130, v52
    v_sub_f32 v131, v131, v52
    v_sub_f32 v132, v132, v53
    v_sub_f32 v133, v133, v53
    v_sub_f32 v134, v134, v53
    v_sub_f32 v135, v135, v53
    v_sub_f32 v136, v136, v54
    v_sub_f32 v137, v137, v54
    v_sub_f32 v138, v138, v54
    v_sub_f32 v139, v139, v54
    v_sub_f32 v140, v140, v55
    v_sub_f32 v141, v141, v55
    v_sub_f32 v142, v142, v55
    v_sub_f32 v143, v143, v55
    v_sub_f32 v144, v144, v52
    v_sub_f32 v145, v145, v52
    v_sub_f32 v146, v146, v52
    v_sub_f32 v147, v147, v52
    v_sub_f32 v148, v148, v53
    v_sub_f32 v149, v149, v53
    v_sub_f32 v150, v150, v53
    v_sub_f32 v151, v151, v53
    v_sub_f32 v152, v152, v54
    v_sub_f32 v153, v153, v54
    v_sub_f32 v154, v154, v54
    v_sub_f32 v155, v155, v54
    v_sub_f32 v156, v156, v55
    v_sub_f32 v157, v157, v55
    v_sub_f32 v158, v158, v55
    v_sub_f32 v159, v159, v55
    v_sub_f32 v160, v160, v52
    v_sub_f32 v16, v16, v52
    v_sub_f32 v161, v161, v52
    v_sub_f32 v17, v17, v52
    v_sub_f32 v162, v162, v52
    v_sub_f32 v18, v18, v52
    v_sub_f32 v163, v163, v52
    v_sub_f32 v19, v19, v52
    v_sub_f32 v164, v164, v53
    v_sub_f32 v20, v20, v53
    v_sub_f32 v165, v165, v53
    v_sub_f32 v21, v21, v53
    v_sub_f32 v166, v166, v53
    v_sub_f32 v22, v22, v53
    v_sub_f32 v167, v167, v53
    v_sub_f32 v23, v23, v53
    v_sub_f32 v168, v168, v54
    v_sub_f32 v24, v24, v54
    v_sub_f32 v169, v169, v54
    v_sub_f32 v25, v25, v54
    v_sub_f32 v170, v170, v54
    v_sub_f32 v26, v26, v54
    v_sub_f32 v171, v171, v54
    v_sub_f32 v27, v27, v54
    v_sub_f32 v172, v172, v55
    v_sub_f32 v28, v28, v55
    v_sub_f32 v173, v173, v55
    v_sub_f32 v29, v29, v55
    v_sub_f32 v174, v174, v55
    v_sub_f32 v30, v30, v55
    v_sub_f32 v175, v175, v55
    v_sub_f32 v31, v31, v55
    v_sub_f32 v176, v176, v52
    v_sub_f32 v32, v32, v52
    v_sub_f32 v177, v177, v52
    v_sub_f32 v33, v33, v52
    v_sub_f32 v178, v178, v52
    v_sub_f32 v34, v34, v52
    v_sub_f32 v179, v179, v52
    v_sub_f32 v35, v35, v52
    v_sub_f32 v180, v180, v53
    v_sub_f32 v36, v36, v53
    v_sub_f32 v181, v181, v53
    v_sub_f32 v37, v37, v53
    v_sub_f32 v182, v182, v53
    v_sub_f32 v38, v38, v53
    v_sub_f32 v183, v183, v53
    v_sub_f32 v39, v39, v53
    v_sub_f32 v184, v184, v54
    v_sub_f32 v40, v40, v54
    v_sub_f32 v185, v185, v54
    v_sub_f32 v41, v41, v54
    v_sub_f32 v186, v186, v54
    v_sub_f32 v42, v42, v54
    v_sub_f32 v187, v187, v54
    v_sub_f32 v43, v43, v54
    v_sub_f32 v188, v188, v55
    v_sub_f32 v44, v44, v55
    v_sub_f32 v189, v189, v55
    v_sub_f32 v45, v45, v55
    v_sub_f32 v190, v190, v55
    v_sub_f32 v46, v46, v55
    v_sub_f32 v191, v191, v55
    v_sub_f32 v47, v47, v55
    v_sub_f32 v8, v8, v52
    v_exp_f32 v52, -v52
    v_sub_f32 v9, v9, v53
    v_exp_f32 v53, -v53
    v_sub_f32 v10, v10, v54
    v_exp_f32 v54, -v54
    v_sub_f32 v11, v11, v55
    v_exp_f32 v55, -v55
    s_nop 0
    v_mul_f32 v12, v12, v52
    v_mul_f32 v48, v48, v53
    v_mul_f32 v248, v248, v54
    v_mul_f32 v252, v252, v55
    v_accvgpr_read_b32 v224, a0
    v_accvgpr_read_b32 v225, a1
    v_accvgpr_read_b32 v226, a2
    v_accvgpr_read_b32 v227, a3
    v_mul_f32 v224, v224, v52
    v_mul_f32 v225, v225, v52
    v_mul_f32 v226, v226, v52
    v_mul_f32 v227, v227, v52
    v_accvgpr_write_b32 a0, v224
    v_accvgpr_write_b32 a1, v225
    v_accvgpr_write_b32 a2, v226
    v_accvgpr_write_b32 a3, v227
    v_accvgpr_read_b32 v224, a4
    v_accvgpr_read_b32 v225, a5
    v_accvgpr_read_b32 v226, a6
    v_accvgpr_read_b32 v227, a7
    v_mul_f32 v224, v224, v53
    v_mul_f32 v225, v225, v53
    v_mul_f32 v226, v226, v53
    v_mul_f32 v227, v227, v53
    v_accvgpr_write_b32 a4, v224
    v_accvgpr_write_b32 a5, v225
    v_accvgpr_write_b32 a6, v226
    v_accvgpr_write_b32 a7, v227
    v_accvgpr_read_b32 v224, a8
    v_accvgpr_read_b32 v225, a9
    v_accvgpr_read_b32 v226, a10
    v_accvgpr_read_b32 v227, a11
    v_mul_f32 v224, v224, v54
    v_mul_f32 v225, v225, v54
    v_mul_f32 v226, v226, v54
    v_mul_f32 v227, v227, v54
    v_accvgpr_write_b32 a8, v224
    v_accvgpr_write_b32 a9, v225
    v_accvgpr_write_b32 a10, v226
    v_accvgpr_write_b32 a11, v227
    v_accvgpr_read_b32 v224, a12
    v_accvgpr_read_b32 v225, a13
    v_accvgpr_read_b32 v226, a14
    v_accvgpr_read_b32 v227, a15
    v_mul_f32 v224, v224, v55
    v_mul_f32 v225, v225, v55
    v_mul_f32 v226, v226, v55
    v_mul_f32 v227, v227, v55
    v_accvgpr_write_b32 a12, v224
    v_accvgpr_write_b32 a13, v225
    v_accvgpr_write_b32 a14, v226
    v_accvgpr_write_b32 a15, v227
    v_accvgpr_read_b32 v224, a16
    v_accvgpr_read_b32 v225, a17
    v_accvgpr_read_b32 v226, a18
    v_accvgpr_read_b32 v227, a19
    v_mul_f32 v224, v224, v52
    v_mul_f32 v225, v225, v52
    v_mul_f32 v226, v226, v52
    v_mul_f32 v227, v227, v52
    v_accvgpr_write_b32 a16, v224
    v_accvgpr_write_b32 a17, v225
    v_accvgpr_write_b32 a18, v226
    v_accvgpr_write_b32 a19, v227
    v_accvgpr_read_b32 v224, a20
    v_accvgpr_read_b32 v225, a21
    v_accvgpr_read_b32 v226, a22
    v_accvgpr_read_b32 v227, a23
    v_mul_f32 v224, v224, v53
    v_mul_f32 v225, v225, v53
    v_mul_f32 v226, v226, v53
    v_mul_f32 v227, v227, v53
    v_accvgpr_write_b32 a20, v224
    v_accvgpr_write_b32 a21, v225
    v_accvgpr_write_b32 a22, v226
    v_accvgpr_write_b32 a23, v227
    v_accvgpr_read_b32 v224, a24
    v_accvgpr_read_b32 v225, a25
    v_accvgpr_read_b32 v226, a26
    v_accvgpr_read_b32 v227, a27
    v_mul_f32 v224, v224, v54
    v_mul_f32 v225, v225, v54
    v_mul_f32 v226, v226, v54
    v_mul_f32 v227, v227, v54
    v_accvgpr_write_b32 a24, v224
    v_accvgpr_write_b32 a25, v225
    v_accvgpr_write_b32 a26, v226
    v_accvgpr_write_b32 a27, v227
    v_accvgpr_read_b32 v224, a28
    v_accvgpr_read_b32 v225, a29
    v_accvgpr_read_b32 v226, a30
    v_accvgpr_read_b32 v227, a31
    v_mul_f32 v224, v224, v55
    v_mul_f32 v225, v225, v55
    v_mul_f32 v226, v226, v55
    v_mul_f32 v227, v227, v55
    v_accvgpr_write_b32 a28, v224
    v_accvgpr_write_b32 a29, v225
    v_accvgpr_write_b32 a30, v226
    v_accvgpr_write_b32 a31, v227
    v_accvgpr_read_b32 v224, a32
    v_accvgpr_read_b32 v225, a33
    v_accvgpr_read_b32 v226, a34
    v_accvgpr_read_b32 v227, a35
    v_mul_f32 v224, v224, v52
    v_mul_f32 v225, v225, v52
    v_mul_f32 v226, v226, v52
    v_mul_f32 v227, v227, v52
    v_accvgpr_write_b32 a32, v224
    v_accvgpr_write_b32 a33, v225
    v_accvgpr_write_b32 a34, v226
    v_accvgpr_write_b32 a35, v227
    v_accvgpr_read_b32 v224, a36
    v_accvgpr_read_b32 v225, a37
    v_accvgpr_read_b32 v226, a38
    v_accvgpr_read_b32 v227, a39
    v_mul_f32 v224, v224, v53
    v_mul_f32 v225, v225, v53
    v_mul_f32 v226, v226, v53
    v_mul_f32 v227, v227, v53
    v_accvgpr_write_b32 a36, v224
    v_accvgpr_write_b32 a37, v225
    v_accvgpr_write_b32 a38, v226
    v_accvgpr_write_b32 a39, v227
    v_accvgpr_read_b32 v224, a40
    v_accvgpr_read_b32 v225, a41
    v_accvgpr_read_b32 v226, a42
    v_accvgpr_read_b32 v227, a43
    v_mul_f32 v224, v224, v54
    v_mul_f32 v225, v225, v54
    v_mul_f32 v226, v226, v54
    v_mul_f32 v227, v227, v54
    v_accvgpr_write_b32 a40, v224
    v_accvgpr_write_b32 a41, v225
    v_accvgpr_write_b32 a42, v226
    v_accvgpr_write_b32 a43, v227
    v_accvgpr_read_b32 v224, a44
    v_accvgpr_read_b32 v225, a45
    v_accvgpr_read_b32 v226, a46
    v_accvgpr_read_b32 v227, a47
    v_mul_f32 v224, v224, v55
    v_mul_f32 v225, v225, v55
    v_mul_f32 v226, v226, v55
    v_mul_f32 v227, v227, v55
    v_accvgpr_write_b32 a44, v224
    v_accvgpr_write_b32 a45, v225
    v_accvgpr_write_b32 a46, v226
    v_accvgpr_write_b32 a47, v227
    v_accvgpr_read_b32 v224, a48
    v_accvgpr_read_b32 v225, a49
    v_accvgpr_read_b32 v226, a50
    v_accvgpr_read_b32 v227, a51
    v_mul_f32 v224, v224, v52
    v_mul_f32 v225, v225, v52
    v_mul_f32 v226, v226, v52
    v_mul_f32 v227, v227, v52
    v_accvgpr_write_b32 a48, v224
    v_accvgpr_write_b32 a49, v225
    v_accvgpr_write_b32 a50, v226
    v_accvgpr_write_b32 a51, v227
    v_accvgpr_read_b32 v224, a52
    v_accvgpr_read_b32 v225, a53
    v_accvgpr_read_b32 v226, a54
    v_accvgpr_read_b32 v227, a55
    v_mul_f32 v224, v224, v53
    v_mul_f32 v225, v225, v53
    v_mul_f32 v226, v226, v53
    v_mul_f32 v227, v227, v53
    v_accvgpr_write_b32 a52, v224
    v_accvgpr_write_b32 a53, v225
    v_accvgpr_write_b32 a54, v226
    v_accvgpr_write_b32 a55, v227
    v_accvgpr_read_b32 v224, a56
    v_accvgpr_read_b32 v225, a57
    v_accvgpr_read_b32 v226, a58
    v_accvgpr_read_b32 v227, a59
    v_mul_f32 v224, v224, v54
    v_mul_f32 v225, v225, v54
    v_mul_f32 v226, v226, v54
    v_mul_f32 v227, v227, v54
    v_accvgpr_write_b32 a56, v224
    v_accvgpr_write_b32 a57, v225
    v_accvgpr_write_b32 a58, v226
    v_accvgpr_write_b32 a59, v227
    v_accvgpr_read_b32 v224, a60
    v_accvgpr_read_b32 v225, a61
    v_accvgpr_read_b32 v226, a62
    v_accvgpr_read_b32 v227, a63
    v_mul_f32 v224, v224, v55
    v_mul_f32 v225, v225, v55
    v_mul_f32 v226, v226, v55
    v_mul_f32 v227, v227, v55
    v_accvgpr_write_b32 a60, v224
    v_accvgpr_write_b32 a61, v225
    v_accvgpr_write_b32 a62, v226
    v_accvgpr_write_b32 a63, v227
    v_accvgpr_read_b32 v224, a64
    v_accvgpr_read_b32 v225, a65
    v_accvgpr_read_b32 v226, a66
    v_accvgpr_read_b32 v227, a67
    v_mul_f32 v224, v224, v52
    v_mul_f32 v225, v225, v52
    v_mul_f32 v226, v226, v52
    v_mul_f32 v227, v227, v52
    v_accvgpr_write_b32 a64, v224
    v_accvgpr_write_b32 a65, v225
    v_accvgpr_write_b32 a66, v226
    v_accvgpr_write_b32 a67, v227
    v_accvgpr_read_b32 v224, a68
    v_accvgpr_read_b32 v225, a69
    v_accvgpr_read_b32 v226, a70
    v_accvgpr_read_b32 v227, a71
    v_mul_f32 v224, v224, v53
    v_mul_f32 v225, v225, v53
    v_mul_f32 v226, v226, v53
    v_mul_f32 v227, v227, v53
    v_accvgpr_write_b32 a68, v224
    v_accvgpr_write_b32 a69, v225
    v_accvgpr_write_b32 a70, v226
    v_accvgpr_write_b32 a71, v227
    v_accvgpr_read_b32 v224, a72
    v_accvgpr_read_b32 v225, a73
    v_accvgpr_read_b32 v226, a74
    v_accvgpr_read_b32 v227, a75
    v_mul_f32 v224, v224, v54
    v_mul_f32 v225, v225, v54
    v_mul_f32 v226, v226, v54
    v_mul_f32 v227, v227, v54
    v_accvgpr_write_b32 a72, v224
    v_accvgpr_write_b32 a73, v225
    v_accvgpr_write_b32 a74, v226
    v_accvgpr_write_b32 a75, v227
    v_accvgpr_read_b32 v224, a76
    v_accvgpr_read_b32 v225, a77
    v_accvgpr_read_b32 v226, a78
    v_accvgpr_read_b32 v227, a79
    v_mul_f32 v224, v224, v55
    v_mul_f32 v225, v225, v55
    v_mul_f32 v226, v226, v55
    v_mul_f32 v227, v227, v55
    v_accvgpr_write_b32 a76, v224
    v_accvgpr_write_b32 a77, v225
    v_accvgpr_write_b32 a78, v226
    v_accvgpr_write_b32 a79, v227
    v_accvgpr_read_b32 v224, a80
    v_accvgpr_read_b32 v225, a81
    v_accvgpr_read_b32 v226, a82
    v_accvgpr_read_b32 v227, a83
    v_mul_f32 v224, v224, v52
    v_mul_f32 v225, v225, v52
    v_mul_f32 v226, v226, v52
    v_mul_f32 v227, v227, v52
    v_accvgpr_write_b32 a80, v224
    v_accvgpr_write_b32 a81, v225
    v_accvgpr_write_b32 a82, v226
    v_accvgpr_write_b32 a83, v227
    v_accvgpr_read_b32 v224, a84
    v_accvgpr_read_b32 v225, a85
    v_accvgpr_read_b32 v226, a86
    v_accvgpr_read_b32 v227, a87
    v_mul_f32 v224, v224, v53
    v_mul_f32 v225, v225, v53
    v_mul_f32 v226, v226, v53
    v_mul_f32 v227, v227, v53
    v_accvgpr_write_b32 a84, v224
    v_accvgpr_write_b32 a85, v225
    v_accvgpr_write_b32 a86, v226
    v_accvgpr_write_b32 a87, v227
    v_accvgpr_read_b32 v224, a88
    v_accvgpr_read_b32 v225, a89
    v_accvgpr_read_b32 v226, a90
    v_accvgpr_read_b32 v227, a91
    v_mul_f32 v224, v224, v54
    v_mul_f32 v225, v225, v54
    v_mul_f32 v226, v226, v54
    v_mul_f32 v227, v227, v54
    v_accvgpr_write_b32 a88, v224
    v_accvgpr_write_b32 a89, v225
    v_accvgpr_write_b32 a90, v226
    v_accvgpr_write_b32 a91, v227
    v_accvgpr_read_b32 v224, a92
    v_accvgpr_read_b32 v225, a93
    v_accvgpr_read_b32 v226, a94
    v_accvgpr_read_b32 v227, a95
    v_mul_f32 v224, v224, v55
    v_mul_f32 v225, v225, v55
    v_mul_f32 v226, v226, v55
    v_mul_f32 v227, v227, v55
    v_accvgpr_write_b32 a92, v224
    v_accvgpr_write_b32 a93, v225
    v_accvgpr_write_b32 a94, v226
    v_accvgpr_write_b32 a95, v227
    v_accvgpr_read_b32 v224, a96
    v_accvgpr_read_b32 v225, a97
    v_accvgpr_read_b32 v226, a98
    v_accvgpr_read_b32 v227, a99
    v_mul_f32 v224, v224, v52
    v_mul_f32 v225, v225, v52
    v_mul_f32 v226, v226, v52
    v_mul_f32 v227, v227, v52
    v_accvgpr_write_b32 a96, v224
    v_accvgpr_write_b32 a97, v225
    v_accvgpr_write_b32 a98, v226
    v_accvgpr_write_b32 a99, v227
    v_accvgpr_read_b32 v224, a100
    v_accvgpr_read_b32 v225, a101
    v_accvgpr_read_b32 v226, a102
    v_accvgpr_read_b32 v227, a103
    v_mul_f32 v224, v224, v53
    v_mul_f32 v225, v225, v53
    v_mul_f32 v226, v226, v53
    v_mul_f32 v227, v227, v53
    v_accvgpr_write_b32 a100, v224
    v_accvgpr_write_b32 a101, v225
    v_accvgpr_write_b32 a102, v226
    v_accvgpr_write_b32 a103, v227
    v_accvgpr_read_b32 v224, a104
    v_accvgpr_read_b32 v225, a105
    v_accvgpr_read_b32 v226, a106
    v_accvgpr_read_b32 v227, a107
    v_mul_f32 v224, v224, v54
    v_mul_f32 v225, v225, v54
    v_mul_f32 v226, v226, v54
    v_mul_f32 v227, v227, v54
    v_accvgpr_write_b32 a104, v224
    v_accvgpr_write_b32 a105, v225
    v_accvgpr_write_b32 a106, v226
    v_accvgpr_write_b32 a107, v227
    v_accvgpr_read_b32 v224, a108
    v_accvgpr_read_b32 v225, a109
    v_accvgpr_read_b32 v226, a110
    v_accvgpr_read_b32 v227, a111
    v_mul_f32 v224, v224, v55
    v_mul_f32 v225, v225, v55
    v_mul_f32 v226, v226, v55
    v_mul_f32 v227, v227, v55
    v_accvgpr_write_b32 a108, v224
    v_accvgpr_write_b32 a109, v225
    v_accvgpr_write_b32 a110, v226
    v_accvgpr_write_b32 a111, v227
    v_accvgpr_read_b32 v224, a112
    v_accvgpr_read_b32 v225, a113
    v_accvgpr_read_b32 v226, a114
    v_accvgpr_read_b32 v227, a115
    v_mul_f32 v224, v224, v52
    v_mul_f32 v225, v225, v52
    v_mul_f32 v226, v226, v52
    v_mul_f32 v227, v227, v52
    v_accvgpr_write_b32 a112, v224
    v_accvgpr_write_b32 a113, v225
    v_accvgpr_write_b32 a114, v226
    v_accvgpr_write_b32 a115, v227
    v_accvgpr_read_b32 v224, a116
    v_accvgpr_read_b32 v225, a117
    v_accvgpr_read_b32 v226, a118
    v_accvgpr_read_b32 v227, a119
    v_mul_f32 v224, v224, v53
    v_mul_f32 v225, v225, v53
    v_mul_f32 v226, v226, v53
    v_mul_f32 v227, v227, v53
    v_accvgpr_write_b32 a116, v224
    v_accvgpr_write_b32 a117, v225
    v_accvgpr_write_b32 a118, v226
    v_accvgpr_write_b32 a119, v227
    v_accvgpr_read_b32 v224, a120
    v_accvgpr_read_b32 v225, a121
    v_accvgpr_read_b32 v226, a122
    v_accvgpr_read_b32 v227, a123
    v_mul_f32 v224, v224, v54
    v_mul_f32 v225, v225, v54
    v_mul_f32 v226, v226, v54
    v_mul_f32 v227, v227, v54
    v_accvgpr_write_b32 a120, v224
    v_accvgpr_write_b32 a121, v225
    v_accvgpr_write_b32 a122, v226
    v_accvgpr_write_b32 a123, v227
    v_accvgpr_read_b32 v224, a124
    v_accvgpr_read_b32 v225, a125
    v_accvgpr_read_b32 v226, a126
    v_accvgpr_read_b32 v227, a127
    v_mul_f32 v224, v224, v55
    v_mul_f32 v225, v225, v55
    v_mul_f32 v226, v226, v55
    v_mul_f32 v227, v227, v55
    v_accvgpr_write_b32 a124, v224
    v_accvgpr_write_b32 a125, v225
    v_accvgpr_write_b32 a126, v226
    v_accvgpr_write_b32 a127, v227
    v_exp_f32 v232, v128
    v_exp_f32 v233, v129
    v_exp_f32 v234, v130
    v_exp_f32 v235, v131
    s_nop 0
    v_cvt_pk_bf16_f32 v192, v232, v233
    v_cvt_pk_bf16_f32 v193, v234, v235
    v_exp_f32 v232, v144
    v_exp_f32 v233, v145
    v_exp_f32 v234, v146
    v_exp_f32 v235, v147
    s_nop 0
    v_cvt_pk_bf16_f32 v194, v232, v233
    v_cvt_pk_bf16_f32 v195, v234, v235
    v_exp_f32 v232, v132
    v_exp_f32 v233, v133
    v_exp_f32 v234, v134
    v_exp_f32 v235, v135
    s_nop 0
    v_cvt_pk_bf16_f32 v196, v232, v233
    v_cvt_pk_bf16_f32 v197, v234, v235
    v_exp_f32 v232, v148
    v_exp_f32 v233, v149
    v_exp_f32 v234, v150
    v_exp_f32 v235, v151
    s_nop 0
    v_cvt_pk_bf16_f32 v198, v232, v233
    v_cvt_pk_bf16_f32 v199, v234, v235
    v_exp_f32 v232, v136
    v_exp_f32 v233, v137
    v_exp_f32 v234, v138
    v_exp_f32 v235, v139
    s_nop 0
    v_cvt_pk_bf16_f32 v200, v232, v233
    v_cvt_pk_bf16_f32 v201, v234, v235
    v_exp_f32 v232, v152
    v_exp_f32 v233, v153
    v_exp_f32 v234, v154
    v_exp_f32 v235, v155
    s_nop 0
    v_cvt_pk_bf16_f32 v202, v232, v233
    v_cvt_pk_bf16_f32 v203, v234, v235
    v_exp_f32 v232, v140
    v_exp_f32 v233, v141
    v_exp_f32 v234, v142
    v_exp_f32 v235, v143
    s_nop 0
    v_cvt_pk_bf16_f32 v204, v232, v233
    v_cvt_pk_bf16_f32 v205, v234, v235
    v_exp_f32 v232, v156
    v_exp_f32 v233, v157
    v_exp_f32 v234, v158
    v_exp_f32 v235, v159
    s_nop 0
    v_cvt_pk_bf16_f32 v206, v232, v233
    v_cvt_pk_bf16_f32 v207, v234, v235
    s_nop 1
    s_branch k2_ret_53
k2_rare_57:
    s_nop 7
    v_max_f32 v52, v160, v161
    v_max3_f32 v52, v52, v162, v163
    v_max3_f32 v52, v52, v176, v177
    v_max3_f32 v52, v52, v178, v179
    v_max_f32 v53, v164, v165
    v_max3_f32 v53, v53, v166, v167
    v_max3_f32 v53, v53, v180, v181
    v_max3_f32 v53, v53, v182, v183
    v_max_f32 v54, v168, v169
    v_max3_f32 v54, v54, v170, v171
    v_max3_f32 v54, v54, v184, v185
    v_max3_f32 v54, v54, v186, v187
    v_max_f32 v55, v172, v173
    v_max3_f32 v55, v55, v174, v175
    v_max3_f32 v55, v55, v188, v189
    v_max3_f32 v55, v55, v190, v191
    v_mov_b32 v224, v52
    v_mov_b32 v225, v53
    v_mov_b32 v226, v54
    v_mov_b32 v227, v55
    s_nop 1
    v_permlane16_swap_b32 v52, v224
    v_permlane16_swap_b32 v53, v225
    v_permlane16_swap_b32 v54, v226
    v_permlane16_swap_b32 v55, v227
    s_nop 1
    v_max_f32 v52, v52, v224
    v_max_f32 v53, v53, v225
    v_max_f32 v54, v54, v226
    v_max_f32 v55, v55, v227
    v_mov_b32 v224, v52
    v_mov_b32 v225, v53
    v_mov_b32 v226, v54
    v_mov_b32 v227, v55
    s_nop 1
    v_permlane32_swap_b32 v52, v224
    v_permlane32_swap_b32 v53, v225
    v_permlane32_swap_b32 v54, v226
    v_permlane32_swap_b32 v55, v227
    s_nop 1
    v_max_f32 v52, v52, v224
    v_max_f32 v53, v53, v225
    v_max_f32 v54, v54, v226
    v_max_f32 v55, v55, v227
    v_add_f32 v52, 0x41400000, v52
    v_max_f32 v52, 0, v52
    v_add_f32 v53, 0x41400000, v53
    v_max_f32 v53, 0, v53
    v_add_f32 v54, 0x41400000, v54
    v_max_f32 v54, 0, v54
    v_add_f32 v55, 0x41400000, v55
    v_max_f32 v55, 0, v55
    v_sub_f32 v160, v160, v52
    v_sub_f32 v161, v161, v52
    v_sub_f32 v162, v162, v52
    v_sub_f32 v163, v163, v52
    v_sub_f32 v164, v164, v53
    v_sub_f32 v165, v165, v53
    v_sub_f32 v166, v166, v53
    v_sub_f32 v167, v167, v53
    v_sub_f32 v168, v168, v54
    v_sub_f32 v169, v169, v54
    v_sub_f32 v170, v170, v54
    v_sub_f32 v171, v171, v54
    v_sub_f32 v172, v172, v55
    v_sub_f32 v173, v173, v55
    v_sub_f32 v174, v174, v55
    v_sub_f32 v175, v175, v55
    v_sub_f32 v176, v176, v52
    v_sub_f32 v177, v177, v52
    v_sub_f32 v178, v178, v52
    v_sub_f32 v179, v179, v52
    v_sub_f32 v180, v180, v53
    v_sub_f32 v181, v181, v53
    v_sub_f32 v182, v182, v53
    v_sub_f32 v183, v183, v53
    v_sub_f32 v184, v184, v54
    v_sub_f32 v185, v185, v54
    v_sub_f32 v186, v186, v54
    v_sub_f32 v187, v187, v54
    v_sub_f32 v188, v188, v55
    v_sub_f32 v189, v189, v55
    v_sub_f32 v190, v190, v55
    v_sub_f32 v191, v191, v55
    v_sub_f32 v128, v128, v52
    v_sub_f32 v16, v16, v52
    v_sub_f32 v129, v129, v52
    v_sub_f32 v17, v17, v52
    v_sub_f32 v130, v130, v52
    v_sub_f32 v18, v18, v52
    v_sub_f32 v131, v131, v52
    v_sub_f32 v19, v19, v52
    v_sub_f32 v132, v132, v53
    v_sub_f32 v20, v20, v53
    v_sub_f32 v133, v133, v53
    v_sub_f32 v21, v21, v53
    v_sub_f32 v134, v134, v53
    v_sub_f32 v22, v22, v53
    v_sub_f32 v135, v135, v53
    v_sub_f32 v23, v23, v53
    v_sub_f32 v136, v136, v54
    v_sub_f32 v24, v24, v54
    v_sub_f32 v137, v137, v54
    v_sub_f32 v25, v25, v54
    v_sub_f32 v138, v138, v54
    v_sub_f32 v26, v26, v54
    v_sub_f32 v139, v139, v54
    v_sub_f32 v27, v27, v54
    v_sub_f32 v140, v140, v55
    v_sub_f32 v28, v28, v55
    v_sub_f32 v141, v141, v55
    v_sub_f32 v29, v29, v55
    v_sub_f32 v142, v142, v55
    v_sub_f32 v30, v30, v55
    v_sub_f32 v143, v143, v55
    v_sub_f32 v31, v31, v55
    v_sub_f32 v144, v144, v52
    v_sub_f32 v32, v32, v52
    v_sub_f32 v145, v145, v52
    v_sub_f32 v33, v33, v52
    v_sub_f32 v146, v146, v52
    v_sub_f32 v34, v34, v52
    v_sub_f32 v147, v147, v52
    v_sub_f32 v35, v35, v52
    v_sub_f32 v148, v148, v53
    v_sub_f32 v36, v36, v53
    v_sub_f32 v149, v149, v53
    v_sub_f32 v37, v37, v53
    v_sub_f32 v150, v150, v53
    v_sub_f32 v38, v38, v53
    v_sub_f32 v151, v151, v53
    v_sub_f32 v39, v39, v53
    v_sub_f32 v152, v152, v54
    v_sub_f32 v40, v40, v54
    v_sub_f32 v153, v153, v54
    v_sub_f32 v41, v41, v54
    v_sub_f32 v154, v154, v54
    v_sub_f32 v42, v42, v54
    v_sub_f32 v155, v155, v54
    v_sub_f32 v43, v43, v54
    v_sub_f32 v156, v156, v55
    v_sub_f32 v44, v44, v55
    v_sub_f32 v157, v157, v55
    v_sub_f32 v45, v45, v55
    v_sub_f32 v158, v158, v55
    v_sub_f32 v46, v46, v55
    v_sub_f32 v159, v159, v55
    v_sub_f32 v47, v47, v55
    v_sub_f32 v8, v8, v52
    v_exp_f32 v52, -v52
    v_sub_f32 v9, v9, v53
    v_exp_f32 v53, -v53
    v_sub_f32 v10, v10, v54
    v_exp_f32 v54, -v54
    v_sub_f32 v11, v11, v55
    v_exp_f32 v55, -v55
    s_nop 0
    v_mul_f32 v12, v12, v52
    v_mul_f32 v48, v48, v53
    v_mul_f32 v248, v248, v54
    v_mul_f32 v252, v252, v55
    v_accvgpr_read_b32 v224, a0
    v_accvgpr_read_b32 v225, a1
    v_accvgpr_read_b32 v226, a2
    v_accvgpr_read_b32 v227, a3
    v_mul_f32 v224, v224, v52
    v_mul_f32 v225, v225, v52
    v_mul_f32 v226, v226, v52
    v_mul_f32 v227, v227, v52
    v_accvgpr_write_b32 a0, v224
    v_accvgpr_write_b32 a1, v225
    v_accvgpr_write_b32 a2, v226
    v_accvgpr_write_b32 a3, v227
    v_accvgpr_read_b32 v224, a4
    v_accvgpr_read_b32 v225, a5
    v_accvgpr_read_b32 v226, a6
    v_accvgpr_read_b32 v227, a7
    v_mul_f32 v224, v224, v53
    v_mul_f32 v225, v225, v53
    v_mul_f32 v226, v226, v53
    v_mul_f32 v227, v227, v53
    v_accvgpr_write_b32 a4, v224
    v_accvgpr_write_b32 a5, v225
    v_accvgpr_write_b32 a6, v226
    v_accvgpr_write_b32 a7, v227
    v_accvgpr_read_b32 v224, a8
    v_accvgpr_read_b32 v225, a9
    v_accvgpr_read_b32 v226, a10
    v_accvgpr_read_b32 v227, a11
    v_mul_f32 v224, v224, v54
    v_mul_f32 v225, v225, v54
    v_mul_f32 v226, v226, v54
    v_mul_f32 v227, v227, v54
    v_accvgpr_write_b32 a8, v224
    v_accvgpr_write_b32 a9, v225
    v_accvgpr_write_b32 a10, v226
    v_accvgpr_write_b32 a11, v227
    v_accvgpr_read_b32 v224, a12
    v_accvgpr_read_b32 v225, a13
    v_accvgpr_read_b32 v226, a14
    v_accvgpr_read_b32 v227, a15
    v_mul_f32 v224, v224, v55
    v_mul_f32 v225, v225, v55
    v_mul_f32 v226, v226, v55
    v_mul_f32 v227, v227, v55
    v_accvgpr_write_b32 a12, v224
    v_accvgpr_write_b32 a13, v225
    v_accvgpr_write_b32 a14, v226
    v_accvgpr_write_b32 a15, v227
    v_accvgpr_read_b32 v224, a16
    v_accvgpr_read_b32 v225, a17
    v_accvgpr_read_b32 v226, a18
    v_accvgpr_read_b32 v227, a19
    v_mul_f32 v224, v224, v52
    v_mul_f32 v225, v225, v52
    v_mul_f32 v226, v226, v52
    v_mul_f32 v227, v227, v52
    v_accvgpr_write_b32 a16, v224
    v_accvgpr_write_b32 a17, v225
    v_accvgpr_write_b32 a18, v226
    v_accvgpr_write_b32 a19, v227
    v_accvgpr_read_b32 v224, a20
    v_accvgpr_read_b32 v225, a21
    v_accvgpr_read_b32 v226, a22
    v_accvgpr_read_b32 v227, a23
    v_mul_f32 v224, v224, v53
    v_mul_f32 v225, v225, v53
    v_mul_f32 v226, v226, v53
    v_mul_f32 v227, v227, v53
    v_accvgpr_write_b32 a20, v224
    v_accvgpr_write_b32 a21, v225
    v_accvgpr_write_b32 a22, v226
    v_accvgpr_write_b32 a23, v227
    v_accvgpr_read_b32 v224, a24
    v_accvgpr_read_b32 v225, a25
    v_accvgpr_read_b32 v226, a26
    v_accvgpr_read_b32 v227, a27
    v_mul_f32 v224, v224, v54
    v_mul_f32 v225, v225, v54
    v_mul_f32 v226, v226, v54
    v_mul_f32 v227, v227, v54
    v_accvgpr_write_b32 a24, v224
    v_accvgpr_write_b32 a25, v225
    v_accvgpr_write_b32 a26, v226
    v_accvgpr_write_b32 a27, v227
    v_accvgpr_read_b32 v224, a28
    v_accvgpr_read_b32 v225, a29
    v_accvgpr_read_b32 v226, a30
    v_accvgpr_read_b32 v227, a31
    v_mul_f32 v224, v224, v55
    v_mul_f32 v225, v225, v55
    v_mul_f32 v226, v226, v55
    v_mul_f32 v227, v227, v55
    v_accvgpr_write_b32 a28, v224
    v_accvgpr_write_b32 a29, v225
    v_accvgpr_write_b32 a30, v226
    v_accvgpr_write_b32 a31, v227
    v_accvgpr_read_b32 v224, a32
    v_accvgpr_read_b32 v225, a33
    v_accvgpr_read_b32 v226, a34
    v_accvgpr_read_b32 v227, a35
    v_mul_f32 v224, v224, v52
    v_mul_f32 v225, v225, v52
    v_mul_f32 v226, v226, v52
    v_mul_f32 v227, v227, v52
    v_accvgpr_write_b32 a32, v224
    v_accvgpr_write_b32 a33, v225
    v_accvgpr_write_b32 a34, v226
    v_accvgpr_write_b32 a35, v227
    v_accvgpr_read_b32 v224, a36
    v_accvgpr_read_b32 v225, a37
    v_accvgpr_read_b32 v226, a38
    v_accvgpr_read_b32 v227, a39
    v_mul_f32 v224, v224, v53
    v_mul_f32 v225, v225, v53
    v_mul_f32 v226, v226, v53
    v_mul_f32 v227, v227, v53
    v_accvgpr_write_b32 a36, v224
    v_accvgpr_write_b32 a37, v225
    v_accvgpr_write_b32 a38, v226
    v_accvgpr_write_b32 a39, v227
    v_accvgpr_read_b32 v224, a40
    v_accvgpr_read_b32 v225, a41
    v_accvgpr_read_b32 v226, a42
    v_accvgpr_read_b32 v227, a43
    v_mul_f32 v224, v224, v54
    v_mul_f32 v225, v225, v54
    v_mul_f32 v226, v226, v54
    v_mul_f32 v227, v227, v54
    v_accvgpr_write_b32 a40, v224
    v_accvgpr_write_b32 a41, v225
    v_accvgpr_write_b32 a42, v226
    v_accvgpr_write_b32 a43, v227
    v_accvgpr_read_b32 v224, a44
    v_accvgpr_read_b32 v225, a45
    v_accvgpr_read_b32 v226, a46
    v_accvgpr_read_b32 v227, a47
    v_mul_f32 v224, v224, v55
    v_mul_f32 v225, v225, v55
    v_mul_f32 v226, v226, v55
    v_mul_f32 v227, v227, v55
    v_accvgpr_write_b32 a44, v224
    v_accvgpr_write_b32 a45, v225
    v_accvgpr_write_b32 a46, v226
    v_accvgpr_write_b32 a47, v227
    v_accvgpr_read_b32 v224, a48
    v_accvgpr_read_b32 v225, a49
    v_accvgpr_read_b32 v226, a50
    v_accvgpr_read_b32 v227, a51
    v_mul_f32 v224, v224, v52
    v_mul_f32 v225, v225, v52
    v_mul_f32 v226, v226, v52
    v_mul_f32 v227, v227, v52
    v_accvgpr_write_b32 a48, v224
    v_accvgpr_write_b32 a49, v225
    v_accvgpr_write_b32 a50, v226
    v_accvgpr_write_b32 a51, v227
    v_accvgpr_read_b32 v224, a52
    v_accvgpr_read_b32 v225, a53
    v_accvgpr_read_b32 v226, a54
    v_accvgpr_read_b32 v227, a55
    v_mul_f32 v224, v224, v53
    v_mul_f32 v225, v225, v53
    v_mul_f32 v226, v226, v53
    v_mul_f32 v227, v227, v53
    v_accvgpr_write_b32 a52, v224
    v_accvgpr_write_b32 a53, v225
    v_accvgpr_write_b32 a54, v226
    v_accvgpr_write_b32 a55, v227
    v_accvgpr_read_b32 v224, a56
    v_accvgpr_read_b32 v225, a57
    v_accvgpr_read_b32 v226, a58
    v_accvgpr_read_b32 v227, a59
    v_mul_f32 v224, v224, v54
    v_mul_f32 v225, v225, v54
    v_mul_f32 v226, v226, v54
    v_mul_f32 v227, v227, v54
    v_accvgpr_write_b32 a56, v224
    v_accvgpr_write_b32 a57, v225
    v_accvgpr_write_b32 a58, v226
    v_accvgpr_write_b32 a59, v227
    v_accvgpr_read_b32 v224, a60
    v_accvgpr_read_b32 v225, a61
    v_accvgpr_read_b32 v226, a62
    v_accvgpr_read_b32 v227, a63
    v_mul_f32 v224, v224, v55
    v_mul_f32 v225, v225, v55
    v_mul_f32 v226, v226, v55
    v_mul_f32 v227, v227, v55
    v_accvgpr_write_b32 a60, v224
    v_accvgpr_write_b32 a61, v225
    v_accvgpr_write_b32 a62, v226
    v_accvgpr_write_b32 a63, v227
    v_accvgpr_read_b32 v224, a64
    v_accvgpr_read_b32 v225, a65
    v_accvgpr_read_b32 v226, a66
    v_accvgpr_read_b32 v227, a67
    v_mul_f32 v224, v224, v52
    v_mul_f32 v225, v225, v52
    v_mul_f32 v226, v226, v52
    v_mul_f32 v227, v227, v52
    v_accvgpr_write_b32 a64, v224
    v_accvgpr_write_b32 a65, v225
    v_accvgpr_write_b32 a66, v226
    v_accvgpr_write_b32 a67, v227
    v_accvgpr_read_b32 v224, a68
    v_accvgpr_read_b32 v225, a69
    v_accvgpr_read_b32 v226, a70
    v_accvgpr_read_b32 v227, a71
    v_mul_f32 v224, v224, v53
    v_mul_f32 v225, v225, v53
    v_mul_f32 v226, v226, v53
    v_mul_f32 v227, v227, v53
    v_accvgpr_write_b32 a68, v224
    v_accvgpr_write_b32 a69, v225
    v_accvgpr_write_b32 a70, v226
    v_accvgpr_write_b32 a71, v227
    v_accvgpr_read_b32 v224, a72
    v_accvgpr_read_b32 v225, a73
    v_accvgpr_read_b32 v226, a74
    v_accvgpr_read_b32 v227, a75
    v_mul_f32 v224, v224, v54
    v_mul_f32 v225, v225, v54
    v_mul_f32 v226, v226, v54
    v_mul_f32 v227, v227, v54
    v_accvgpr_write_b32 a72, v224
    v_accvgpr_write_b32 a73, v225
    v_accvgpr_write_b32 a74, v226
    v_accvgpr_write_b32 a75, v227
    v_accvgpr_read_b32 v224, a76
    v_accvgpr_read_b32 v225, a77
    v_accvgpr_read_b32 v226, a78
    v_accvgpr_read_b32 v227, a79
    v_mul_f32 v224, v224, v55
    v_mul_f32 v225, v225, v55
    v_mul_f32 v226, v226, v55
    v_mul_f32 v227, v227, v55
    v_accvgpr_write_b32 a76, v224
    v_accvgpr_write_b32 a77, v225
    v_accvgpr_write_b32 a78, v226
    v_accvgpr_write_b32 a79, v227
    v_accvgpr_read_b32 v224, a80
    v_accvgpr_read_b32 v225, a81
    v_accvgpr_read_b32 v226, a82
    v_accvgpr_read_b32 v227, a83
    v_mul_f32 v224, v224, v52
    v_mul_f32 v225, v225, v52
    v_mul_f32 v226, v226, v52
    v_mul_f32 v227, v227, v52
    v_accvgpr_write_b32 a80, v224
    v_accvgpr_write_b32 a81, v225
    v_accvgpr_write_b32 a82, v226
    v_accvgpr_write_b32 a83, v227
    v_accvgpr_read_b32 v224, a84
    v_accvgpr_read_b32 v225, a85
    v_accvgpr_read_b32 v226, a86
    v_accvgpr_read_b32 v227, a87
    v_mul_f32 v224, v224, v53
    v_mul_f32 v225, v225, v53
    v_mul_f32 v226, v226, v53
    v_mul_f32 v227, v227, v53
    v_accvgpr_write_b32 a84, v224
    v_accvgpr_write_b32 a85, v225
    v_accvgpr_write_b32 a86, v226
    v_accvgpr_write_b32 a87, v227
    v_accvgpr_read_b32 v224, a88
    v_accvgpr_read_b32 v225, a89
    v_accvgpr_read_b32 v226, a90
    v_accvgpr_read_b32 v227, a91
    v_mul_f32 v224, v224, v54
    v_mul_f32 v225, v225, v54
    v_mul_f32 v226, v226, v54
    v_mul_f32 v227, v227, v54
    v_accvgpr_write_b32 a88, v224
    v_accvgpr_write_b32 a89, v225
    v_accvgpr_write_b32 a90, v226
    v_accvgpr_write_b32 a91, v227
    v_accvgpr_read_b32 v224, a92
    v_accvgpr_read_b32 v225, a93
    v_accvgpr_read_b32 v226, a94
    v_accvgpr_read_b32 v227, a95
    v_mul_f32 v224, v224, v55
    v_mul_f32 v225, v225, v55
    v_mul_f32 v226, v226, v55
    v_mul_f32 v227, v227, v55
    v_accvgpr_write_b32 a92, v224
    v_accvgpr_write_b32 a93, v225
    v_accvgpr_write_b32 a94, v226
    v_accvgpr_write_b32 a95, v227
    v_accvgpr_read_b32 v224, a96
    v_accvgpr_read_b32 v225, a97
    v_accvgpr_read_b32 v226, a98
    v_accvgpr_read_b32 v227, a99
    v_mul_f32 v224, v224, v52
    v_mul_f32 v225, v225, v52
    v_mul_f32 v226, v226, v52
    v_mul_f32 v227, v227, v52
    v_accvgpr_write_b32 a96, v224
    v_accvgpr_write_b32 a97, v225
    v_accvgpr_write_b32 a98, v226
    v_accvgpr_write_b32 a99, v227
    v_accvgpr_read_b32 v224, a100
    v_accvgpr_read_b32 v225, a101
    v_accvgpr_read_b32 v226, a102
    v_accvgpr_read_b32 v227, a103
    v_mul_f32 v224, v224, v53
    v_mul_f32 v225, v225, v53
    v_mul_f32 v226, v226, v53
    v_mul_f32 v227, v227, v53
    v_accvgpr_write_b32 a100, v224
    v_accvgpr_write_b32 a101, v225
    v_accvgpr_write_b32 a102, v226
    v_accvgpr_write_b32 a103, v227
    v_accvgpr_read_b32 v224, a104
    v_accvgpr_read_b32 v225, a105
    v_accvgpr_read_b32 v226, a106
    v_accvgpr_read_b32 v227, a107
    v_mul_f32 v224, v224, v54
    v_mul_f32 v225, v225, v54
    v_mul_f32 v226, v226, v54
    v_mul_f32 v227, v227, v54
    v_accvgpr_write_b32 a104, v224
    v_accvgpr_write_b32 a105, v225
    v_accvgpr_write_b32 a106, v226
    v_accvgpr_write_b32 a107, v227
    v_accvgpr_read_b32 v224, a108
    v_accvgpr_read_b32 v225, a109
    v_accvgpr_read_b32 v226, a110
    v_accvgpr_read_b32 v227, a111
    v_mul_f32 v224, v224, v55
    v_mul_f32 v225, v225, v55
    v_mul_f32 v226, v226, v55
    v_mul_f32 v227, v227, v55
    v_accvgpr_write_b32 a108, v224
    v_accvgpr_write_b32 a109, v225
    v_accvgpr_write_b32 a110, v226
    v_accvgpr_write_b32 a111, v227
    v_accvgpr_read_b32 v224, a112
    v_accvgpr_read_b32 v225, a113
    v_accvgpr_read_b32 v226, a114
    v_accvgpr_read_b32 v227, a115
    v_mul_f32 v224, v224, v52
    v_mul_f32 v225, v225, v52
    v_mul_f32 v226, v226, v52
    v_mul_f32 v227, v227, v52
    v_accvgpr_write_b32 a112, v224
    v_accvgpr_write_b32 a113, v225
    v_accvgpr_write_b32 a114, v226
    v_accvgpr_write_b32 a115, v227
    v_accvgpr_read_b32 v224, a116
    v_accvgpr_read_b32 v225, a117
    v_accvgpr_read_b32 v226, a118
    v_accvgpr_read_b32 v227, a119
    v_mul_f32 v224, v224, v53
    v_mul_f32 v225, v225, v53
    v_mul_f32 v226, v226, v53
    v_mul_f32 v227, v227, v53
    v_accvgpr_write_b32 a116, v224
    v_accvgpr_write_b32 a117, v225
    v_accvgpr_write_b32 a118, v226
    v_accvgpr_write_b32 a119, v227
    v_accvgpr_read_b32 v224, a120
    v_accvgpr_read_b32 v225, a121
    v_accvgpr_read_b32 v226, a122
    v_accvgpr_read_b32 v227, a123
    v_mul_f32 v224, v224, v54
    v_mul_f32 v225, v225, v54
    v_mul_f32 v226, v226, v54
    v_mul_f32 v227, v227, v54
    v_accvgpr_write_b32 a120, v224
    v_accvgpr_write_b32 a121, v225
    v_accvgpr_write_b32 a122, v226
    v_accvgpr_write_b32 a123, v227
    v_accvgpr_read_b32 v224, a124
    v_accvgpr_read_b32 v225, a125
    v_accvgpr_read_b32 v226, a126
    v_accvgpr_read_b32 v227, a127
    v_mul_f32 v224, v224, v55
    v_mul_f32 v225, v225, v55
    v_mul_f32 v226, v226, v55
    v_mul_f32 v227, v227, v55
    v_accvgpr_write_b32 a124, v224
    v_accvgpr_write_b32 a125, v225
    v_accvgpr_write_b32 a126, v226
    v_accvgpr_write_b32 a127, v227
    v_exp_f32 v232, v160
    v_exp_f32 v233, v161
    v_exp_f32 v234, v162
    v_exp_f32 v235, v163
    s_nop 0
    v_cvt_pk_bf16_f32 v208, v232, v233
    v_cvt_pk_bf16_f32 v209, v234, v235
    v_exp_f32 v232, v176
    v_exp_f32 v233, v177
    v_exp_f32 v234, v178
    v_exp_f32 v235, v179
    s_nop 0
    v_cvt_pk_bf16_f32 v210, v232, v233
    v_cvt_pk_bf16_f32 v211, v234, v235
    v_exp_f32 v232, v164
    v_exp_f32 v233, v165
    v_exp_f32 v234, v166
    v_exp_f32 v235, v167
    s_nop 0
    v_cvt_pk_bf16_f32 v212, v232, v233
    v_cvt_pk_bf16_f32 v213, v234, v235
    v_exp_f32 v232, v180
    v_exp_f32 v233, v181
    v_exp_f32 v234, v182
    v_exp_f32 v235, v183
    s_nop 0
    v_cvt_pk_bf16_f32 v214, v232, v233
    v_cvt_pk_bf16_f32 v215, v234, v235
    v_exp_f32 v232, v168
    v_exp_f32 v233, v169
    v_exp_f32 v234, v170
    v_exp_f32 v235, v171
    s_nop 0
    v_cvt_pk_bf16_f32 v216, v232, v233
    v_cvt_pk_bf16_f32 v217, v234, v235
    v_exp_f32 v232, v184
    v_exp_f32 v233, v185
    v_exp_f32 v234, v186
    v_exp_f32 v235, v187
    s_nop 0
    v_cvt_pk_bf16_f32 v218, v232, v233
    v_cvt_pk_bf16_f32 v219, v234, v235
    v_exp_f32 v232, v172
    v_exp_f32 v233, v173
    v_exp_f32 v234, v174
    v_exp_f32 v235, v175
    s_nop 0
    v_cvt_pk_bf16_f32 v220, v232, v233
    v_cvt_pk_bf16_f32 v221, v234, v235
    v_exp_f32 v232, v188
    v_exp_f32 v233, v189
    v_exp_f32 v234, v190
    v_exp_f32 v235, v191
    s_nop 0
    v_cvt_pk_bf16_f32 v222, v232, v233
    v_cvt_pk_bf16_f32 v223, v234, v235
    s_nop 1
    s_branch k2_ret_58
k2_rare_61:
    s_nop 7
    v_max_f32 v52, v128, v129
    v_max3_f32 v52, v52, v130, v131
    v_max3_f32 v52, v52, v144, v145
    v_max3_f32 v52, v52, v146, v147
    v_max_f32 v53, v132, v133
    v_max3_f32 v53, v53, v134, v135
    v_max3_f32 v53, v53, v148, v149
    v_max3_f32 v53, v53, v150, v151
    v_max_f32 v54, v136, v137
    v_max3_f32 v54, v54, v138, v139
    v_max3_f32 v54, v54, v152, v153
    v_max3_f32 v54, v54, v154, v155
    v_max_f32 v55, v140, v141
    v_max3_f32 v55, v55, v142, v143
    v_max3_f32 v55, v55, v156, v157
    v_max3_f32 v55, v55, v158, v159
    v_mov_b32 v224, v52
    v_mov_b32 v225, v53
    v_mov_b32 v226, v54
    v_mov_b32 v227, v55
    s_nop 1
    v_permlane16_swap_b32 v52, v224
    v_permlane16_swap_b32 v53, v225
    v_permlane16_swap_b32 v54, v226
    v_permlane16_swap_b32 v55, v227
    s_nop 1
    v_max_f32 v52, v52, v224
    v_max_f32 v53, v53, v225
    v_max_f32 v54, v54, v226
    v_max_f32 v55, v55, v227
    v_mov_b32 v224, v52
    v_mov_b32 v225, v53
    v_mov_b32 v226, v54
    v_mov_b32 v227, v55
    s_nop 1
    v_permlane32_swap_b32 v52, v224
    v_permlane32_swap_b32 v53, v225
    v_permlane32_swap_b32 v54, v226
    v_permlane32_swap_b32 v55, v227
    s_nop 1
    v_max_f32 v52, v52, v224
    v_max_f32 v53, v53, v225
    v_max_f32 v54, v54, v226
    v_max_f32 v55, v55, v227
    v_add_f32 v52, 0x41400000, v52
    v_max_f32 v52, 0, v52
    v_add_f32 v53, 0x41400000, v53
    v_max_f32 v53, 0, v53
    v_add_f32 v54, 0x41400000, v54
    v_max_f32 v54, 0, v54
    v_add_f32 v55, 0x41400000, v55
    v_max_f32 v55, 0, v55
    v_sub_f32 v128, v128, v52
    v_sub_f32 v129, v129, v52
    v_sub_f32 v130, v130, v52
    v_sub_f32 v131, v131, v52
    v_sub_f32 v132, v132, v53
    v_sub_f32 v133, v133, v53
    v_sub_f32 v134, v134, v53
    v_sub_f32 v135, v135, v53
    v_sub_f32 v136, v136, v54
    v_sub_f32 v137, v137, v54
    v_sub_f32 v138, v138, v54
    v_sub_f32 v139, v139, v54
    v_sub_f32 v140, v140, v55
    v_sub_f32 v141, v141, v55
    v_sub_f32 v142, v142, v55
    v_sub_f32 v143, v143, v55
    v_sub_f32 v144, v144, v52
    v_sub_f32 v145, v145, v52
    v_sub_f32 v146, v146, v52
    v_sub_f32 v147, v147, v52
    v_sub_f32 v148, v148, v53
    v_sub_f32 v149, v149, v53
    v_sub_f32 v150, v150, v53
    v_sub_f32 v151, v151, v53
    v_sub_f32 v152, v152, v54
    v_sub_f32 v153, v153, v54
    v_sub_f32 v154, v154, v54
    v_sub_f32 v155, v155, v54
    v_sub_f32 v156, v156, v55
    v_sub_f32 v157, v157, v55
    v_sub_f32 v158, v158, v55
    v_sub_f32 v159, v159, v55
    v_sub_f32 v160, v160, v52
    v_sub_f32 v16, v16, v52
    v_sub_f32 v161, v161, v52
    v_sub_f32 v17, v17, v52
    v_sub_f32 v162, v162, v52
    v_sub_f32 v18, v18, v52
    v_sub_f32 v163, v163, v52
    v_sub_f32 v19, v19, v52
    v_sub_f32 v164, v164, v53
    v_sub_f32 v20, v20, v53
    v_sub_f32 v165, v165, v53
    v_sub_f32 v21, v21, v53
    v_sub_f32 v166, v166, v53
    v_sub_f32 v22, v22, v53
    v_sub_f32 v167, v167, v53
    v_sub_f32 v23, v23, v53
    v_sub_f32 v168, v168, v54
    v_sub_f32 v24, v24, v54
    v_sub_f32 v169, v169, v54
    v_sub_f32 v25, v25, v54
    v_sub_f32 v170, v170, v54
    v_sub_f32 v26, v26, v54
    v_sub_f32 v171, v171, v54
    v_sub_f32 v27, v27, v54
    v_sub_f32 v172, v172, v55
    v_sub_f32 v28, v28, v55
    v_sub_f32 v173, v173, v55
    v_sub_f32 v29, v29, v55
    v_sub_f32 v174, v174, v55
    v_sub_f32 v30, v30, v55
    v_sub_f32 v175, v175, v55
    v_sub_f32 v31, v31, v55
    v_sub_f32 v176, v176, v52
    v_sub_f32 v32, v32, v52
    v_sub_f32 v177, v177, v52
    v_sub_f32 v33, v33, v52
    v_sub_f32 v178, v178, v52
    v_sub_f32 v34, v34, v52
    v_sub_f32 v179, v179, v52
    v_sub_f32 v35, v35, v52
    v_sub_f32 v180, v180, v53
    v_sub_f32 v36, v36, v53
    v_sub_f32 v181, v181, v53
    v_sub_f32 v37, v37, v53
    v_sub_f32 v182, v182, v53
    v_sub_f32 v38, v38, v53
    v_sub_f32 v183, v183, v53
    v_sub_f32 v39, v39, v53
    v_sub_f32 v184, v184, v54
    v_sub_f32 v40, v40, v54
    v_sub_f32 v185, v185, v54
    v_sub_f32 v41, v41, v54
    v_sub_f32 v186, v186, v54
    v_sub_f32 v42, v42, v54
    v_sub_f32 v187, v187, v54
    v_sub_f32 v43, v43, v54
    v_sub_f32 v188, v188, v55
    v_sub_f32 v44, v44, v55
    v_sub_f32 v189, v189, v55
    v_sub_f32 v45, v45, v55
    v_sub_f32 v190, v190, v55
    v_sub_f32 v46, v46, v55
    v_sub_f32 v191, v191, v55
    v_sub_f32 v47, v47, v55
    v_sub_f32 v8, v8, v52
    v_exp_f32 v52, -v52
    v_sub_f32 v9, v9, v53
    v_exp_f32 v53, -v53
    v_sub_f32 v10, v10, v54
    v_exp_f32 v54, -v54
    v_sub_f32 v11, v11, v55
    v_exp_f32 v55, -v55
    s_nop 0
    v_mul_f32 v12, v12, v52
    v_mul_f32 v48, v48, v53
    v_mul_f32 v248, v248, v54
    v_mul_f32 v252, v252, v55
    v_accvgpr_read_b32 v224, a0
    v_accvgpr_read_b32 v225, a1
    v_accvgpr_read_b32 v226, a2
    v_accvgpr_read_b32 v227, a3
    v_mul_f32 v224, v224, v52
    v_mul_f32 v225, v225, v52
    v_mul_f32 v226, v226, v52
    v_mul_f32 v227, v227, v52
    v_accvgpr_write_b32 a0, v224
    v_accvgpr_write_b32 a1, v225
    v_accvgpr_write_b32 a2, v226
    v_accvgpr_write_b32 a3, v227
    v_accvgpr_read_b32 v224, a4
    v_accvgpr_read_b32 v225, a5
    v_accvgpr_read_b32 v226, a6
    v_accvgpr_read_b32 v227, a7
    v_mul_f32 v224, v224, v53
    v_mul_f32 v225, v225, v53
    v_mul_f32 v226, v226, v53
    v_mul_f32 v227, v227, v53
    v_accvgpr_write_b32 a4, v224
    v_accvgpr_write_b32 a5, v225
    v_accvgpr_write_b32 a6, v226
    v_accvgpr_write_b32 a7, v227
    v_accvgpr_read_b32 v224, a8
    v_accvgpr_read_b32 v225, a9
    v_accvgpr_read_b32 v226, a10
    v_accvgpr_read_b32 v227, a11
    v_mul_f32 v224, v224, v54
    v_mul_f32 v225, v225, v54
    v_mul_f32 v226, v226, v54
    v_mul_f32 v227, v227, v54
    v_accvgpr_write_b32 a8, v224
    v_accvgpr_write_b32 a9, v225
    v_accvgpr_write_b32 a10, v226
    v_accvgpr_write_b32 a11, v227
    v_accvgpr_read_b32 v224, a12
    v_accvgpr_read_b32 v225, a13
    v_accvgpr_read_b32 v226, a14
    v_accvgpr_read_b32 v227, a15
    v_mul_f32 v224, v224, v55
    v_mul_f32 v225, v225, v55
    v_mul_f32 v226, v226, v55
    v_mul_f32 v227, v227, v55
    v_accvgpr_write_b32 a12, v224
    v_accvgpr_write_b32 a13, v225
    v_accvgpr_write_b32 a14, v226
    v_accvgpr_write_b32 a15, v227
    v_accvgpr_read_b32 v224, a16
    v_accvgpr_read_b32 v225, a17
    v_accvgpr_read_b32 v226, a18
    v_accvgpr_read_b32 v227, a19
    v_mul_f32 v224, v224, v52
    v_mul_f32 v225, v225, v52
    v_mul_f32 v226, v226, v52
    v_mul_f32 v227, v227, v52
    v_accvgpr_write_b32 a16, v224
    v_accvgpr_write_b32 a17, v225
    v_accvgpr_write_b32 a18, v226
    v_accvgpr_write_b32 a19, v227
    v_accvgpr_read_b32 v224, a20
    v_accvgpr_read_b32 v225, a21
    v_accvgpr_read_b32 v226, a22
    v_accvgpr_read_b32 v227, a23
    v_mul_f32 v224, v224, v53
    v_mul_f32 v225, v225, v53
    v_mul_f32 v226, v226, v53
    v_mul_f32 v227, v227, v53
    v_accvgpr_write_b32 a20, v224
    v_accvgpr_write_b32 a21, v225
    v_accvgpr_write_b32 a22, v226
    v_accvgpr_write_b32 a23, v227
    v_accvgpr_read_b32 v224, a24
    v_accvgpr_read_b32 v225, a25
    v_accvgpr_read_b32 v226, a26
    v_accvgpr_read_b32 v227, a27
    v_mul_f32 v224, v224, v54
    v_mul_f32 v225, v225, v54
    v_mul_f32 v226, v226, v54
    v_mul_f32 v227, v227, v54
    v_accvgpr_write_b32 a24, v224
    v_accvgpr_write_b32 a25, v225
    v_accvgpr_write_b32 a26, v226
    v_accvgpr_write_b32 a27, v227
    v_accvgpr_read_b32 v224, a28
    v_accvgpr_read_b32 v225, a29
    v_accvgpr_read_b32 v226, a30
    v_accvgpr_read_b32 v227, a31
    v_mul_f32 v224, v224, v55
    v_mul_f32 v225, v225, v55
    v_mul_f32 v226, v226, v55
    v_mul_f32 v227, v227, v55
    v_accvgpr_write_b32 a28, v224
    v_accvgpr_write_b32 a29, v225
    v_accvgpr_write_b32 a30, v226
    v_accvgpr_write_b32 a31, v227
    v_accvgpr_read_b32 v224, a32
    v_accvgpr_read_b32 v225, a33
    v_accvgpr_read_b32 v226, a34
    v_accvgpr_read_b32 v227, a35
    v_mul_f32 v224, v224, v52
    v_mul_f32 v225, v225, v52
    v_mul_f32 v226, v226, v52
    v_mul_f32 v227, v227, v52
    v_accvgpr_write_b32 a32, v224
    v_accvgpr_write_b32 a33, v225
    v_accvgpr_write_b32 a34, v226
    v_accvgpr_write_b32 a35, v227
    v_accvgpr_read_b32 v224, a36
    v_accvgpr_read_b32 v225, a37
    v_accvgpr_read_b32 v226, a38
    v_accvgpr_read_b32 v227, a39
    v_mul_f32 v224, v224, v53
    v_mul_f32 v225, v225, v53
    v_mul_f32 v226, v226, v53
    v_mul_f32 v227, v227, v53
    v_accvgpr_write_b32 a36, v224
    v_accvgpr_write_b32 a37, v225
    v_accvgpr_write_b32 a38, v226
    v_accvgpr_write_b32 a39, v227
    v_accvgpr_read_b32 v224, a40
    v_accvgpr_read_b32 v225, a41
    v_accvgpr_read_b32 v226, a42
    v_accvgpr_read_b32 v227, a43
    v_mul_f32 v224, v224, v54
    v_mul_f32 v225, v225, v54
    v_mul_f32 v226, v226, v54
    v_mul_f32 v227, v227, v54
    v_accvgpr_write_b32 a40, v224
    v_accvgpr_write_b32 a41, v225
    v_accvgpr_write_b32 a42, v226
    v_accvgpr_write_b32 a43, v227
    v_accvgpr_read_b32 v224, a44
    v_accvgpr_read_b32 v225, a45
    v_accvgpr_read_b32 v226, a46
    v_accvgpr_read_b32 v227, a47
    v_mul_f32 v224, v224, v55
    v_mul_f32 v225, v225, v55
    v_mul_f32 v226, v226, v55
    v_mul_f32 v227, v227, v55
    v_accvgpr_write_b32 a44, v224
    v_accvgpr_write_b32 a45, v225
    v_accvgpr_write_b32 a46, v226
    v_accvgpr_write_b32 a47, v227
    v_accvgpr_read_b32 v224, a48
    v_accvgpr_read_b32 v225, a49
    v_accvgpr_read_b32 v226, a50
    v_accvgpr_read_b32 v227, a51
    v_mul_f32 v224, v224, v52
    v_mul_f32 v225, v225, v52
    v_mul_f32 v226, v226, v52
    v_mul_f32 v227, v227, v52
    v_accvgpr_write_b32 a48, v224
    v_accvgpr_write_b32 a49, v225
    v_accvgpr_write_b32 a50, v226
    v_accvgpr_write_b32 a51, v227
    v_accvgpr_read_b32 v224, a52
    v_accvgpr_read_b32 v225, a53
    v_accvgpr_read_b32 v226, a54
    v_accvgpr_read_b32 v227, a55
    v_mul_f32 v224, v224, v53
    v_mul_f32 v225, v225, v53
    v_mul_f32 v226, v226, v53
    v_mul_f32 v227, v227, v53
    v_accvgpr_write_b32 a52, v224
    v_accvgpr_write_b32 a53, v225
    v_accvgpr_write_b32 a54, v226
    v_accvgpr_write_b32 a55, v227
    v_accvgpr_read_b32 v224, a56
    v_accvgpr_read_b32 v225, a57
    v_accvgpr_read_b32 v226, a58
    v_accvgpr_read_b32 v227, a59
    v_mul_f32 v224, v224, v54
    v_mul_f32 v225, v225, v54
    v_mul_f32 v226, v226, v54
    v_mul_f32 v227, v227, v54
    v_accvgpr_write_b32 a56, v224
    v_accvgpr_write_b32 a57, v225
    v_accvgpr_write_b32 a58, v226
    v_accvgpr_write_b32 a59, v227
    v_accvgpr_read_b32 v224, a60
    v_accvgpr_read_b32 v225, a61
    v_accvgpr_read_b32 v226, a62
    v_accvgpr_read_b32 v227, a63
    v_mul_f32 v224, v224, v55
    v_mul_f32 v225, v225, v55
    v_mul_f32 v226, v226, v55
    v_mul_f32 v227, v227, v55
    v_accvgpr_write_b32 a60, v224
    v_accvgpr_write_b32 a61, v225
    v_accvgpr_write_b32 a62, v226
    v_accvgpr_write_b32 a63, v227
    v_accvgpr_read_b32 v224, a64
    v_accvgpr_read_b32 v225, a65
    v_accvgpr_read_b32 v226, a66
    v_accvgpr_read_b32 v227, a67
    v_mul_f32 v224, v224, v52
    v_mul_f32 v225, v225, v52
    v_mul_f32 v226, v226, v52
    v_mul_f32 v227, v227, v52
    v_accvgpr_write_b32 a64, v224
    v_accvgpr_write_b32 a65, v225
    v_accvgpr_write_b32 a66, v226
    v_accvgpr_write_b32 a67, v227
    v_accvgpr_read_b32 v224, a68
    v_accvgpr_read_b32 v225, a69
    v_accvgpr_read_b32 v226, a70
    v_accvgpr_read_b32 v227, a71
    v_mul_f32 v224, v224, v53
    v_mul_f32 v225, v225, v53
    v_mul_f32 v226, v226, v53
    v_mul_f32 v227, v227, v53
    v_accvgpr_write_b32 a68, v224
    v_accvgpr_write_b32 a69, v225
    v_accvgpr_write_b32 a70, v226
    v_accvgpr_write_b32 a71, v227
    v_accvgpr_read_b32 v224, a72
    v_accvgpr_read_b32 v225, a73
    v_accvgpr_read_b32 v226, a74
    v_accvgpr_read_b32 v227, a75
    v_mul_f32 v224, v224, v54
    v_mul_f32 v225, v225, v54
    v_mul_f32 v226, v226, v54
    v_mul_f32 v227, v227, v54
    v_accvgpr_write_b32 a72, v224
    v_accvgpr_write_b32 a73, v225
    v_accvgpr_write_b32 a74, v226
    v_accvgpr_write_b32 a75, v227
    v_accvgpr_read_b32 v224, a76
    v_accvgpr_read_b32 v225, a77
    v_accvgpr_read_b32 v226, a78
    v_accvgpr_read_b32 v227, a79
    v_mul_f32 v224, v224, v55
    v_mul_f32 v225, v225, v55
    v_mul_f32 v226, v226, v55
    v_mul_f32 v227, v227, v55
    v_accvgpr_write_b32 a76, v224
    v_accvgpr_write_b32 a77, v225
    v_accvgpr_write_b32 a78, v226
    v_accvgpr_write_b32 a79, v227
    v_accvgpr_read_b32 v224, a80
    v_accvgpr_read_b32 v225, a81
    v_accvgpr_read_b32 v226, a82
    v_accvgpr_read_b32 v227, a83
    v_mul_f32 v224, v224, v52
    v_mul_f32 v225, v225, v52
    v_mul_f32 v226, v226, v52
    v_mul_f32 v227, v227, v52
    v_accvgpr_write_b32 a80, v224
    v_accvgpr_write_b32 a81, v225
    v_accvgpr_write_b32 a82, v226
    v_accvgpr_write_b32 a83, v227
    v_accvgpr_read_b32 v224, a84
    v_accvgpr_read_b32 v225, a85
    v_accvgpr_read_b32 v226, a86
    v_accvgpr_read_b32 v227, a87
    v_mul_f32 v224, v224, v53
    v_mul_f32 v225, v225, v53
    v_mul_f32 v226, v226, v53
    v_mul_f32 v227, v227, v53
    v_accvgpr_write_b32 a84, v224
    v_accvgpr_write_b32 a85, v225
    v_accvgpr_write_b32 a86, v226
    v_accvgpr_write_b32 a87, v227
    v_accvgpr_read_b32 v224, a88
    v_accvgpr_read_b32 v225, a89
    v_accvgpr_read_b32 v226, a90
    v_accvgpr_read_b32 v227, a91
    v_mul_f32 v224, v224, v54
    v_mul_f32 v225, v225, v54
    v_mul_f32 v226, v226, v54
    v_mul_f32 v227, v227, v54
    v_accvgpr_write_b32 a88, v224
    v_accvgpr_write_b32 a89, v225
    v_accvgpr_write_b32 a90, v226
    v_accvgpr_write_b32 a91, v227
    v_accvgpr_read_b32 v224, a92
    v_accvgpr_read_b32 v225, a93
    v_accvgpr_read_b32 v226, a94
    v_accvgpr_read_b32 v227, a95
    v_mul_f32 v224, v224, v55
    v_mul_f32 v225, v225, v55
    v_mul_f32 v226, v226, v55
    v_mul_f32 v227, v227, v55
    v_accvgpr_write_b32 a92, v224
    v_accvgpr_write_b32 a93, v225
    v_accvgpr_write_b32 a94, v226
    v_accvgpr_write_b32 a95, v227
    v_accvgpr_read_b32 v224, a96
    v_accvgpr_read_b32 v225, a97
    v_accvgpr_read_b32 v226, a98
    v_accvgpr_read_b32 v227, a99
    v_mul_f32 v224, v224, v52
    v_mul_f32 v225, v225, v52
    v_mul_f32 v226, v226, v52
    v_mul_f32 v227, v227, v52
    v_accvgpr_write_b32 a96, v224
    v_accvgpr_write_b32 a97, v225
    v_accvgpr_write_b32 a98, v226
    v_accvgpr_write_b32 a99, v227
    v_accvgpr_read_b32 v224, a100
    v_accvgpr_read_b32 v225, a101
    v_accvgpr_read_b32 v226, a102
    v_accvgpr_read_b32 v227, a103
    v_mul_f32 v224, v224, v53
    v_mul_f32 v225, v225, v53
    v_mul_f32 v226, v226, v53
    v_mul_f32 v227, v227, v53
    v_accvgpr_write_b32 a100, v224
    v_accvgpr_write_b32 a101, v225
    v_accvgpr_write_b32 a102, v226
    v_accvgpr_write_b32 a103, v227
    v_accvgpr_read_b32 v224, a104
    v_accvgpr_read_b32 v225, a105
    v_accvgpr_read_b32 v226, a106
    v_accvgpr_read_b32 v227, a107
    v_mul_f32 v224, v224, v54
    v_mul_f32 v225, v225, v54
    v_mul_f32 v226, v226, v54
    v_mul_f32 v227, v227, v54
    v_accvgpr_write_b32 a104, v224
    v_accvgpr_write_b32 a105, v225
    v_accvgpr_write_b32 a106, v226
    v_accvgpr_write_b32 a107, v227
    v_accvgpr_read_b32 v224, a108
    v_accvgpr_read_b32 v225, a109
    v_accvgpr_read_b32 v226, a110
    v_accvgpr_read_b32 v227, a111
    v_mul_f32 v224, v224, v55
    v_mul_f32 v225, v225, v55
    v_mul_f32 v226, v226, v55
    v_mul_f32 v227, v227, v55
    v_accvgpr_write_b32 a108, v224
    v_accvgpr_write_b32 a109, v225
    v_accvgpr_write_b32 a110, v226
    v_accvgpr_write_b32 a111, v227
    v_accvgpr_read_b32 v224, a112
    v_accvgpr_read_b32 v225, a113
    v_accvgpr_read_b32 v226, a114
    v_accvgpr_read_b32 v227, a115
    v_mul_f32 v224, v224, v52
    v_mul_f32 v225, v225, v52
    v_mul_f32 v226, v226, v52
    v_mul_f32 v227, v227, v52
    v_accvgpr_write_b32 a112, v224
    v_accvgpr_write_b32 a113, v225
    v_accvgpr_write_b32 a114, v226
    v_accvgpr_write_b32 a115, v227
    v_accvgpr_read_b32 v224, a116
    v_accvgpr_read_b32 v225, a117
    v_accvgpr_read_b32 v226, a118
    v_accvgpr_read_b32 v227, a119
    v_mul_f32 v224, v224, v53
    v_mul_f32 v225, v225, v53
    v_mul_f32 v226, v226, v53
    v_mul_f32 v227, v227, v53
    v_accvgpr_write_b32 a116, v224
    v_accvgpr_write_b32 a117, v225
    v_accvgpr_write_b32 a118, v226
    v_accvgpr_write_b32 a119, v227
    v_accvgpr_read_b32 v224, a120
    v_accvgpr_read_b32 v225, a121
    v_accvgpr_read_b32 v226, a122
    v_accvgpr_read_b32 v227, a123
    v_mul_f32 v224, v224, v54
    v_mul_f32 v225, v225, v54
    v_mul_f32 v226, v226, v54
    v_mul_f32 v227, v227, v54
    v_accvgpr_write_b32 a120, v224
    v_accvgpr_write_b32 a121, v225
    v_accvgpr_write_b32 a122, v226
    v_accvgpr_write_b32 a123, v227
    v_accvgpr_read_b32 v224, a124
    v_accvgpr_read_b32 v225, a125
    v_accvgpr_read_b32 v226, a126
    v_accvgpr_read_b32 v227, a127
    v_mul_f32 v224, v224, v55
    v_mul_f32 v225, v225, v55
    v_mul_f32 v226, v226, v55
    v_mul_f32 v227, v227, v55
    v_accvgpr_write_b32 a124, v224
    v_accvgpr_write_b32 a125, v225
    v_accvgpr_write_b32 a126, v226
    v_accvgpr_write_b32 a127, v227
    v_exp_f32 v232, v128
    v_exp_f32 v233, v129
    v_exp_f32 v234, v130
    v_exp_f32 v235, v131
    s_nop 0
    v_cvt_pk_bf16_f32 v192, v232, v233
    v_cvt_pk_bf16_f32 v193, v234, v235
    v_exp_f32 v232, v144
    v_exp_f32 v233, v145
    v_exp_f32 v234, v146
    v_exp_f32 v235, v147
    s_nop 0
    v_cvt_pk_bf16_f32 v194, v232, v233
    v_cvt_pk_bf16_f32 v195, v234, v235
    v_exp_f32 v232, v132
    v_exp_f32 v233, v133
    v_exp_f32 v234, v134
    v_exp_f32 v235, v135
    s_nop 0
    v_cvt_pk_bf16_f32 v196, v232, v233
    v_cvt_pk_bf16_f32 v197, v234, v235
    v_exp_f32 v232, v148
    v_exp_f32 v233, v149
    v_exp_f32 v234, v150
    v_exp_f32 v235, v151
    s_nop 0
    v_cvt_pk_bf16_f32 v198, v232, v233
    v_cvt_pk_bf16_f32 v199, v234, v235
    v_exp_f32 v232, v136
    v_exp_f32 v233, v137
    v_exp_f32 v234, v138
    v_exp_f32 v235, v139
    s_nop 0
    v_cvt_pk_bf16_f32 v200, v232, v233
    v_cvt_pk_bf16_f32 v201, v234, v235
    v_exp_f32 v232, v152
    v_exp_f32 v233, v153
    v_exp_f32 v234, v154
    v_exp_f32 v235, v155
    s_nop 0
    v_cvt_pk_bf16_f32 v202, v232, v233
    v_cvt_pk_bf16_f32 v203, v234, v235
    v_exp_f32 v232, v140
    v_exp_f32 v233, v141
    v_exp_f32 v234, v142
    v_exp_f32 v235, v143
    s_nop 0
    v_cvt_pk_bf16_f32 v204, v232, v233
    v_cvt_pk_bf16_f32 v205, v234, v235
    v_exp_f32 v232, v156
    v_exp_f32 v233, v157
    v_exp_f32 v234, v158
    v_exp_f32 v235, v159
    s_nop 0
    v_cvt_pk_bf16_f32 v206, v232, v233
    v_cvt_pk_bf16_f32 v207, v234, v235
    s_nop 1
    s_branch k2_ret_62
k2_rare_65:
    s_nop 7
    v_max_f32 v52, v160, v161
    v_max3_f32 v52, v52, v162, v163
    v_max3_f32 v52, v52, v176, v177
    v_max3_f32 v52, v52, v178, v179
    v_max_f32 v53, v164, v165
    v_max3_f32 v53, v53, v166, v167
    v_max3_f32 v53, v53, v180, v181
    v_max3_f32 v53, v53, v182, v183
    v_max_f32 v54, v168, v169
    v_max3_f32 v54, v54, v170, v171
    v_max3_f32 v54, v54, v184, v185
    v_max3_f32 v54, v54, v186, v187
    v_max_f32 v55, v172, v173
    v_max3_f32 v55, v55, v174, v175
    v_max3_f32 v55, v55, v188, v189
    v_max3_f32 v55, v55, v190, v191
    v_mov_b32 v224, v52
    v_mov_b32 v225, v53
    v_mov_b32 v226, v54
    v_mov_b32 v227, v55
    s_nop 1
    v_permlane16_swap_b32 v52, v224
    v_permlane16_swap_b32 v53, v225
    v_permlane16_swap_b32 v54, v226
    v_permlane16_swap_b32 v55, v227
    s_nop 1
    v_max_f32 v52, v52, v224
    v_max_f32 v53, v53, v225
    v_max_f32 v54, v54, v226
    v_max_f32 v55, v55, v227
    v_mov_b32 v224, v52
    v_mov_b32 v225, v53
    v_mov_b32 v226, v54
    v_mov_b32 v227, v55
    s_nop 1
    v_permlane32_swap_b32 v52, v224
    v_permlane32_swap_b32 v53, v225
    v_permlane32_swap_b32 v54, v226
    v_permlane32_swap_b32 v55, v227
    s_nop 1
    v_max_f32 v52, v52, v224
    v_max_f32 v53, v53, v225
    v_max_f32 v54, v54, v226
    v_max_f32 v55, v55, v227
    v_add_f32 v52, 0x41400000, v52
    v_max_f32 v52, 0, v52
    v_add_f32 v53, 0x41400000, v53
    v_max_f32 v53, 0, v53
    v_add_f32 v54, 0x41400000, v54
    v_max_f32 v54, 0, v54
    v_add_f32 v55, 0x41400000, v55
    v_max_f32 v55, 0, v55
    v_sub_f32 v160, v160, v52
    v_sub_f32 v161, v161, v52
    v_sub_f32 v162, v162, v52
    v_sub_f32 v163, v163, v52
    v_sub_f32 v164, v164, v53
    v_sub_f32 v165, v165, v53
    v_sub_f32 v166, v166, v53
    v_sub_f32 v167, v167, v53
    v_sub_f32 v168, v168, v54
    v_sub_f32 v169, v169, v54
    v_sub_f32 v170, v170, v54
    v_sub_f32 v171, v171, v54
    v_sub_f32 v172, v172, v55
    v_sub_f32 v173, v173, v55
    v_sub_f32 v174, v174, v55
    v_sub_f32 v175, v175, v55
    v_sub_f32 v176, v176, v52
    v_sub_f32 v177, v177, v52
    v_sub_f32 v178, v178, v52
    v_sub_f32 v179, v179, v52
    v_sub_f32 v180, v180, v53
    v_sub_f32 v181, v181, v53
    v_sub_f32 v182, v182, v53
    v_sub_f32 v183, v183, v53
    v_sub_f32 v184, v184, v54
    v_sub_f32 v185, v185, v54
    v_sub_f32 v186, v186, v54
    v_sub_f32 v187, v187, v54
    v_sub_f32 v188, v188, v55
    v_sub_f32 v189, v189, v55
    v_sub_f32 v190, v190, v55
    v_sub_f32 v191, v191, v55
    v_sub_f32 v128, v128, v54
    v_sub_f32 v16, v16, v54
    v_sub_f32 v129, v129, v54
    v_sub_f32 v17, v17, v54
    v_sub_f32 v130, v130, v54
    v_sub_f32 v18, v18, v54
    v_sub_f32 v131, v131, v54
    v_sub_f32 v19, v19, v54
    v_sub_f32 v132, v132, v55
    v_sub_f32 v20, v20, v55
    v_sub_f32 v133, v133, v55
    v_sub_f32 v21, v21, v55
    v_sub_f32 v134, v134, v55
    v_sub_f32 v22, v22, v55
    v_sub_f32 v135, v135, v55
    v_sub_f32 v23, v23, v55
    v_sub_f32 v136, v136, v54
    v_sub_f32 v24, v24, v54
    v_sub_f32 v137, v137, v54
    v_sub_f32 v25, v25, v54
    v_sub_f32 v138, v138, v54
    v_sub_f32 v26, v26, v54
    v_sub_f32 v139, v139, v54
    v_sub_f32 v27, v27, v54
    v_sub_f32 v140, v140, v55
    v_sub_f32 v28, v28, v55
    v_sub_f32 v141, v141, v55
    v_sub_f32 v29, v29, v55
    v_sub_f32 v142, v142, v55
    v_sub_f32 v30, v30, v55
    v_sub_f32 v143, v143, v55
    v_sub_f32 v31, v31, v55
    v_sub_f32 v144, v144, v54
    v_sub_f32 v32, v32, v54
    v_sub_f32 v145, v145, v54
    v_sub_f32 v33, v33, v54
    v_sub_f32 v146, v146, v54
    v_sub_f32 v34, v34, v54
    v_sub_f32 v147, v147, v54
    v_sub_f32 v35, v35, v54
    v_sub_f32 v148, v148, v55
    v_sub_f32 v36, v36, v55
    v_sub_f32 v149, v149, v55
    v_sub_f32 v37, v37, v55
    v_sub_f32 v150, v150, v55
    v_sub_f32 v38, v38, v55
    v_sub_f32 v151, v151, v55
    v_sub_f32 v39, v39, v55
    v_sub_f32 v152, v152, v54
    v_sub_f32 v40, v40, v54
    v_sub_f32 v153, v153, v54
    v_sub_f32 v41, v41, v54
    v_sub_f32 v154, v154, v54
    v_sub_f32 v42, v42, v54
    v_sub_f32 v155, v155, v54
    v_sub_f32 v43, v43, v54
    v_sub_f32 v156, v156, v55
    v_sub_f32 v44, v44, v55
    v_sub_f32 v157, v157, v55
    v_sub_f32 v45, v45, v55
    v_sub_f32 v158, v158, v55
    v_sub_f32 v46, v46, v55
    v_sub_f32 v159, v159, v55
    v_sub_f32 v47, v47, v55
    v_sub_f32 v8, v8, v52
    v_exp_f32 v52, -v52
    v_sub_f32 v9, v9, v53
    v_exp_f32 v53, -v53
    v_sub_f32 v10, v10, v54
    v_exp_f32 v54, -v54
    v_sub_f32 v11, v11, v55
    v_exp_f32 v55, -v55
    s_nop 0
    v_mul_f32 v12, v12, v52
    v_mul_f32 v48, v48, v53
    v_mul_f32 v248, v248, v54
    v_mul_f32 v252, v252, v55
    v_accvgpr_read_b32 v224, a0
    v_accvgpr_read_b32 v225, a1
    v_accvgpr_read_b32 v226, a2
    v_accvgpr_read_b32 v227, a3
    v_mul_f32 v224, v224, v52
    v_mul_f32 v225, v225, v52
    v_mul_f32 v226, v226, v52
    v_mul_f32 v227, v227, v52
    v_accvgpr_write_b32 a0, v224
    v_accvgpr_write_b32 a1, v225
    v_accvgpr_write_b32 a2, v226
    v_accvgpr_write_b32 a3, v227
    v_accvgpr_read_b32 v224, a4
    v_accvgpr_read_b32 v225, a5
    v_accvgpr_read_b32 v226, a6
    v_accvgpr_read_b32 v227, a7
    v_mul_f32 v224, v224, v53
    v_mul_f32 v225, v225, v53
    v_mul_f32 v226, v226, v53
    v_mul_f32 v227, v227, v53
    v_accvgpr_write_b32 a4, v224
    v_accvgpr_write_b32 a5, v225
    v_accvgpr_write_b32 a6, v226
    v_accvgpr_write_b32 a7, v227
    v_accvgpr_read_b32 v224, a8
    v_accvgpr_read_b32 v225, a9
    v_accvgpr_read_b32 v226, a10
    v_accvgpr_read_b32 v227, a11
    v_mul_f32 v224, v224, v54
    v_mul_f32 v225, v225, v54
    v_mul_f32 v226, v226, v54
    v_mul_f32 v227, v227, v54
    v_accvgpr_write_b32 a8, v224
    v_accvgpr_write_b32 a9, v225
    v_accvgpr_write_b32 a10, v226
    v_accvgpr_write_b32 a11, v227
    v_accvgpr_read_b32 v224, a12
    v_accvgpr_read_b32 v225, a13
    v_accvgpr_read_b32 v226, a14
    v_accvgpr_read_b32 v227, a15
    v_mul_f32 v224, v224, v55
    v_mul_f32 v225, v225, v55
    v_mul_f32 v226, v226, v55
    v_mul_f32 v227, v227, v55
    v_accvgpr_write_b32 a12, v224
    v_accvgpr_write_b32 a13, v225
    v_accvgpr_write_b32 a14, v226
    v_accvgpr_write_b32 a15, v227
    v_accvgpr_read_b32 v224, a16
    v_accvgpr_read_b32 v225, a17
    v_accvgpr_read_b32 v226, a18
    v_accvgpr_read_b32 v227, a19
    v_mul_f32 v224, v224, v52
    v_mul_f32 v225, v225, v52
    v_mul_f32 v226, v226, v52
    v_mul_f32 v227, v227, v52
    v_accvgpr_write_b32 a16, v224
    v_accvgpr_write_b32 a17, v225
    v_accvgpr_write_b32 a18, v226
    v_accvgpr_write_b32 a19, v227
    v_accvgpr_read_b32 v224, a20
    v_accvgpr_read_b32 v225, a21
    v_accvgpr_read_b32 v226, a22
    v_accvgpr_read_b32 v227, a23
    v_mul_f32 v224, v224, v53
    v_mul_f32 v225, v225, v53
    v_mul_f32 v226, v226, v53
    v_mul_f32 v227, v227, v53
    v_accvgpr_write_b32 a20, v224
    v_accvgpr_write_b32 a21, v225
    v_accvgpr_write_b32 a22, v226
    v_accvgpr_write_b32 a23, v227
    v_accvgpr_read_b32 v224, a24
    v_accvgpr_read_b32 v225, a25
    v_accvgpr_read_b32 v226, a26
    v_accvgpr_read_b32 v227, a27
    v_mul_f32 v224, v224, v54
    v_mul_f32 v225, v225, v54
    v_mul_f32 v226, v226, v54
    v_mul_f32 v227, v227, v54
    v_accvgpr_write_b32 a24, v224
    v_accvgpr_write_b32 a25, v225
    v_accvgpr_write_b32 a26, v226
    v_accvgpr_write_b32 a27, v227
    v_accvgpr_read_b32 v224, a28
    v_accvgpr_read_b32 v225, a29
    v_accvgpr_read_b32 v226, a30
    v_accvgpr_read_b32 v227, a31
    v_mul_f32 v224, v224, v55
    v_mul_f32 v225, v225, v55
    v_mul_f32 v226, v226, v55
    v_mul_f32 v227, v227, v55
    v_accvgpr_write_b32 a28, v224
    v_accvgpr_write_b32 a29, v225
    v_accvgpr_write_b32 a30, v226
    v_accvgpr_write_b32 a31, v227
    v_accvgpr_read_b32 v224, a32
    v_accvgpr_read_b32 v225, a33
    v_accvgpr_read_b32 v226, a34
    v_accvgpr_read_b32 v227, a35
    v_mul_f32 v224, v224, v52
    v_mul_f32 v225, v225, v52
    v_mul_f32 v226, v226, v52
    v_mul_f32 v227, v227, v52
    v_accvgpr_write_b32 a32, v224
    v_accvgpr_write_b32 a33, v225
    v_accvgpr_write_b32 a34, v226
    v_accvgpr_write_b32 a35, v227
    v_accvgpr_read_b32 v224, a36
    v_accvgpr_read_b32 v225, a37
    v_accvgpr_read_b32 v226, a38
    v_accvgpr_read_b32 v227, a39
    v_mul_f32 v224, v224, v53
    v_mul_f32 v225, v225, v53
    v_mul_f32 v226, v226, v53
    v_mul_f32 v227, v227, v53
    v_accvgpr_write_b32 a36, v224
    v_accvgpr_write_b32 a37, v225
    v_accvgpr_write_b32 a38, v226
    v_accvgpr_write_b32 a39, v227
    v_accvgpr_read_b32 v224, a40
    v_accvgpr_read_b32 v225, a41
    v_accvgpr_read_b32 v226, a42
    v_accvgpr_read_b32 v227, a43
    v_mul_f32 v224, v224, v54
    v_mul_f32 v225, v225, v54
    v_mul_f32 v226, v226, v54
    v_mul_f32 v227, v227, v54
    v_accvgpr_write_b32 a40, v224
    v_accvgpr_write_b32 a41, v225
    v_accvgpr_write_b32 a42, v226
    v_accvgpr_write_b32 a43, v227
    v_accvgpr_read_b32 v224, a44
    v_accvgpr_read_b32 v225, a45
    v_accvgpr_read_b32 v226, a46
    v_accvgpr_read_b32 v227, a47
    v_mul_f32 v224, v224, v55
    v_mul_f32 v225, v225, v55
    v_mul_f32 v226, v226, v55
    v_mul_f32 v227, v227, v55
    v_accvgpr_write_b32 a44, v224
    v_accvgpr_write_b32 a45, v225
    v_accvgpr_write_b32 a46, v226
    v_accvgpr_write_b32 a47, v227
    v_accvgpr_read_b32 v224, a48
    v_accvgpr_read_b32 v225, a49
    v_accvgpr_read_b32 v226, a50
    v_accvgpr_read_b32 v227, a51
    v_mul_f32 v224, v224, v52
    v_mul_f32 v225, v225, v52
    v_mul_f32 v226, v226, v52
    v_mul_f32 v227, v227, v52
    v_accvgpr_write_b32 a48, v224
    v_accvgpr_write_b32 a49, v225
    v_accvgpr_write_b32 a50, v226
    v_accvgpr_write_b32 a51, v227
    v_accvgpr_read_b32 v224, a52
    v_accvgpr_read_b32 v225, a53
    v_accvgpr_read_b32 v226, a54
    v_accvgpr_read_b32 v227, a55
    v_mul_f32 v224, v224, v53
    v_mul_f32 v225, v225, v53
    v_mul_f32 v226, v226, v53
    v_mul_f32 v227, v227, v53
    v_accvgpr_write_b32 a52, v224
    v_accvgpr_write_b32 a53, v225
    v_accvgpr_write_b32 a54, v226
    v_accvgpr_write_b32 a55, v227
    v_accvgpr_read_b32 v224, a56
    v_accvgpr_read_b32 v225, a57
    v_accvgpr_read_b32 v226, a58
    v_accvgpr_read_b32 v227, a59
    v_mul_f32 v224, v224, v54
    v_mul_f32 v225, v225, v54
    v_mul_f32 v226, v226, v54
    v_mul_f32 v227, v227, v54
    v_accvgpr_write_b32 a56, v224
    v_accvgpr_write_b32 a57, v225
    v_accvgpr_write_b32 a58, v226
    v_accvgpr_write_b32 a59, v227
    v_accvgpr_read_b32 v224, a60
    v_accvgpr_read_b32 v225, a61
    v_accvgpr_read_b32 v226, a62
    v_accvgpr_read_b32 v227, a63
    v_mul_f32 v224, v224, v55
    v_mul_f32 v225, v225, v55
    v_mul_f32 v226, v226, v55
    v_mul_f32 v227, v227, v55
    v_accvgpr_write_b32 a60, v224
    v_accvgpr_write_b32 a61, v225
    v_accvgpr_write_b32 a62, v226
    v_accvgpr_write_b32 a63, v227
    v_accvgpr_read_b32 v224, a64
    v_accvgpr_read_b32 v225, a65
    v_accvgpr_read_b32 v226, a66
    v_accvgpr_read_b32 v227, a67
    v_mul_f32 v224, v224, v52
    v_mul_f32 v225, v225, v52
    v_mul_f32 v226, v226, v52
    v_mul_f32 v227, v227, v52
    v_accvgpr_write_b32 a64, v224
    v_accvgpr_write_b32 a65, v225
    v_accvgpr_write_b32 a66, v226
    v_accvgpr_write_b32 a67, v227
    v_accvgpr_read_b32 v224, a68
    v_accvgpr_read_b32 v225, a69
    v_accvgpr_read_b32 v226, a70
    v_accvgpr_read_b32 v227, a71
    v_mul_f32 v224, v224, v53
    v_mul_f32 v225, v225, v53
    v_mul_f32 v226, v226, v53
    v_mul_f32 v227, v227, v53
    v_accvgpr_write_b32 a68, v224
    v_accvgpr_write_b32 a69, v225
    v_accvgpr_write_b32 a70, v226
    v_accvgpr_write_b32 a71, v227
    v_accvgpr_read_b32 v224, a72
    v_accvgpr_read_b32 v225, a73
    v_accvgpr_read_b32 v226, a74
    v_accvgpr_read_b32 v227, a75
    v_mul_f32 v224, v224, v54
    v_mul_f32 v225, v225, v54
    v_mul_f32 v226, v226, v54
    v_mul_f32 v227, v227, v54
    v_accvgpr_write_b32 a72, v224
    v_accvgpr_write_b32 a73, v225
    v_accvgpr_write_b32 a74, v226
    v_accvgpr_write_b32 a75, v227
    v_accvgpr_read_b32 v224, a76
    v_accvgpr_read_b32 v225, a77
    v_accvgpr_read_b32 v226, a78
    v_accvgpr_read_b32 v227, a79
    v_mul_f32 v224, v224, v55
    v_mul_f32 v225, v225, v55
    v_mul_f32 v226, v226, v55
    v_mul_f32 v227, v227, v55
    v_accvgpr_write_b32 a76, v224
    v_accvgpr_write_b32 a77, v225
    v_accvgpr_write_b32 a78, v226
    v_accvgpr_write_b32 a79, v227
    v_accvgpr_read_b32 v224, a80
    v_accvgpr_read_b32 v225, a81
    v_accvgpr_read_b32 v226, a82
    v_accvgpr_read_b32 v227, a83
    v_mul_f32 v224, v224, v52
    v_mul_f32 v225, v225, v52
    v_mul_f32 v226, v226, v52
    v_mul_f32 v227, v227, v52
    v_accvgpr_write_b32 a80, v224
    v_accvgpr_write_b32 a81, v225
    v_accvgpr_write_b32 a82, v226
    v_accvgpr_write_b32 a83, v227
    v_accvgpr_read_b32 v224, a84
    v_accvgpr_read_b32 v225, a85
    v_accvgpr_read_b32 v226, a86
    v_accvgpr_read_b32 v227, a87
    v_mul_f32 v224, v224, v53
    v_mul_f32 v225, v225, v53
    v_mul_f32 v226, v226, v53
    v_mul_f32 v227, v227, v53
    v_accvgpr_write_b32 a84, v224
    v_accvgpr_write_b32 a85, v225
    v_accvgpr_write_b32 a86, v226
    v_accvgpr_write_b32 a87, v227
    v_accvgpr_read_b32 v224, a88
    v_accvgpr_read_b32 v225, a89
    v_accvgpr_read_b32 v226, a90
    v_accvgpr_read_b32 v227, a91
    v_mul_f32 v224, v224, v54
    v_mul_f32 v225, v225, v54
    v_mul_f32 v226, v226, v54
    v_mul_f32 v227, v227, v54
    v_accvgpr_write_b32 a88, v224
    v_accvgpr_write_b32 a89, v225
    v_accvgpr_write_b32 a90, v226
    v_accvgpr_write_b32 a91, v227
    v_accvgpr_read_b32 v224, a92
    v_accvgpr_read_b32 v225, a93
    v_accvgpr_read_b32 v226, a94
    v_accvgpr_read_b32 v227, a95
    v_mul_f32 v224, v224, v55
    v_mul_f32 v225, v225, v55
    v_mul_f32 v226, v226, v55
    v_mul_f32 v227, v227, v55
    v_accvgpr_write_b32 a92, v224
    v_accvgpr_write_b32 a93, v225
    v_accvgpr_write_b32 a94, v226
    v_accvgpr_write_b32 a95, v227
    v_accvgpr_read_b32 v224, a96
    v_accvgpr_read_b32 v225, a97
    v_accvgpr_read_b32 v226, a98
    v_accvgpr_read_b32 v227, a99
    v_mul_f32 v224, v224, v52
    v_mul_f32 v225, v225, v52
    v_mul_f32 v226, v226, v52
    v_mul_f32 v227, v227, v52
    v_accvgpr_write_b32 a96, v224
    v_accvgpr_write_b32 a97, v225
    v_accvgpr_write_b32 a98, v226
    v_accvgpr_write_b32 a99, v227
    v_accvgpr_read_b32 v224, a100
    v_accvgpr_read_b32 v225, a101
    v_accvgpr_read_b32 v226, a102
    v_accvgpr_read_b32 v227, a103
    v_mul_f32 v224, v224, v53
    v_mul_f32 v225, v225, v53
    v_mul_f32 v226, v226, v53
    v_mul_f32 v227, v227, v53
    v_accvgpr_write_b32 a100, v224
    v_accvgpr_write_b32 a101, v225
    v_accvgpr_write_b32 a102, v226
    v_accvgpr_write_b32 a103, v227
    v_accvgpr_read_b32 v224, a104
    v_accvgpr_read_b32 v225, a105
    v_accvgpr_read_b32 v226, a106
    v_accvgpr_read_b32 v227, a107
    v_mul_f32 v224, v224, v54
    v_mul_f32 v225, v225, v54
    v_mul_f32 v226, v226, v54
    v_mul_f32 v227, v227, v54
    v_accvgpr_write_b32 a104, v224
    v_accvgpr_write_b32 a105, v225
    v_accvgpr_write_b32 a106, v226
    v_accvgpr_write_b32 a107, v227
    v_accvgpr_read_b32 v224, a108
    v_accvgpr_read_b32 v225, a109
    v_accvgpr_read_b32 v226, a110
    v_accvgpr_read_b32 v227, a111
    v_mul_f32 v224, v224, v55
    v_mul_f32 v225, v225, v55
    v_mul_f32 v226, v226, v55
    v_mul_f32 v227, v227, v55
    v_accvgpr_write_b32 a108, v224
    v_accvgpr_write_b32 a109, v225
    v_accvgpr_write_b32 a110, v226
    v_accvgpr_write_b32 a111, v227
    v_accvgpr_read_b32 v224, a112
    v_accvgpr_read_b32 v225, a113
    v_accvgpr_read_b32 v226, a114
    v_accvgpr_read_b32 v227, a115
    v_mul_f32 v224, v224, v52
    v_mul_f32 v225, v225, v52
    v_mul_f32 v226, v226, v52
    v_mul_f32 v227, v227, v52
    v_accvgpr_write_b32 a112, v224
    v_accvgpr_write_b32 a113, v225
    v_accvgpr_write_b32 a114, v226
    v_accvgpr_write_b32 a115, v227
    v_accvgpr_read_b32 v224, a116
    v_accvgpr_read_b32 v225, a117
    v_accvgpr_read_b32 v226, a118
    v_accvgpr_read_b32 v227, a119
    v_mul_f32 v224, v224, v53
    v_mul_f32 v225, v225, v53
    v_mul_f32 v226, v226, v53
    v_mul_f32 v227, v227, v53
    v_accvgpr_write_b32 a116, v224
    v_accvgpr_write_b32 a117, v225
    v_accvgpr_write_b32 a118, v226
    v_accvgpr_write_b32 a119, v227
    v_accvgpr_read_b32 v224, a120
    v_accvgpr_read_b32 v225, a121
    v_accvgpr_read_b32 v226, a122
    v_accvgpr_read_b32 v227, a123
    v_mul_f32 v224, v224, v54
    v_mul_f32 v225, v225, v54
    v_mul_f32 v226, v226, v54
    v_mul_f32 v227, v227, v54
    v_accvgpr_write_b32 a120, v224
    v_accvgpr_write_b32 a121, v225
    v_accvgpr_write_b32 a122, v226
    v_accvgpr_write_b32 a123, v227
    v_accvgpr_read_b32 v224, a124
    v_accvgpr_read_b32 v225, a125
    v_accvgpr_read_b32 v226, a126
    v_accvgpr_read_b32 v227, a127
    v_mul_f32 v224, v224, v55
    v_mul_f32 v225, v225, v55
    v_mul_f32 v226, v226, v55
    v_mul_f32 v227, v227, v55
    v_accvgpr_write_b32 a124, v224
    v_accvgpr_write_b32 a125, v225
    v_accvgpr_write_b32 a126, v226
    v_accvgpr_write_b32 a127, v227
    v_exp_f32 v232, v160
    v_exp_f32 v233, v161
    v_exp_f32 v234, v162
    v_exp_f32 v235, v163
    s_nop 0
    v_cvt_pk_bf16_f32 v208, v232, v233
    v_cvt_pk_bf16_f32 v209, v234, v235
    v_exp_f32 v232, v176
    v_exp_f32 v233, v177
    v_exp_f32 v234, v178
    v_exp_f32 v235, v179
    s_nop 0
    v_cvt_pk_bf16_f32 v210, v232, v233
    v_cvt_pk_bf16_f32 v211, v234, v235
    v_exp_f32 v232, v164
    v_exp_f32 v233, v165
    v_exp_f32 v234, v166
    v_exp_f32 v235, v167
    s_nop 0
    v_cvt_pk_bf16_f32 v212, v232, v233
    v_cvt_pk_bf16_f32 v213, v234, v235
    v_exp_f32 v232, v180
    v_exp_f32 v233, v181
    v_exp_f32 v234, v182
    v_exp_f32 v235, v183
    s_nop 0
    v_cvt_pk_bf16_f32 v214, v232, v233
    v_cvt_pk_bf16_f32 v215, v234, v235
    v_exp_f32 v232, v168
    v_exp_f32 v233, v169
    v_exp_f32 v234, v170
    v_exp_f32 v235, v171
    s_nop 0
    v_cvt_pk_bf16_f32 v216, v232, v233
    v_cvt_pk_bf16_f32 v217, v234, v235
    v_exp_f32 v232, v184
    v_exp_f32 v233, v185
    v_exp_f32 v234, v186
    v_exp_f32 v235, v187
    s_nop 0
    v_cvt_pk_bf16_f32 v218, v232, v233
    v_cvt_pk_bf16_f32 v219, v234, v235
    v_exp_f32 v232, v172
    v_exp_f32 v233, v173
    v_exp_f32 v234, v174
    v_exp_f32 v235, v175
    s_nop 0
    v_cvt_pk_bf16_f32 v220, v232, v233
    v_cvt_pk_bf16_f32 v221, v234, v235
    v_exp_f32 v232, v188
    v_exp_f32 v233, v189
    v_exp_f32 v234, v190
    v_exp_f32 v235, v191
    s_nop 0
    v_cvt_pk_bf16_f32 v222, v232, v233
    v_cvt_pk_bf16_f32 v223, v234, v235
    s_nop 1
    s_branch k2_ret_66
k2_rare_69:
    s_nop 7
    v_max_f32 v54, v128, v129
    v_max3_f32 v54, v54, v130, v131
    v_max3_f32 v54, v54, v144, v145
    v_max3_f32 v54, v54, v146, v147
    v_max3_f32 v54, v54, v136, v137
    v_max3_f32 v54, v54, v138, v139
    v_max3_f32 v54, v54, v152, v153
    v_max3_f32 v54, v54, v154, v155
    v_max_f32 v55, v132, v133
    v_max3_f32 v55, v55, v134, v135
    v_max3_f32 v55, v55, v148, v149
    v_max3_f32 v55, v55, v150, v151
    v_max3_f32 v55, v55, v140, v141
    v_max3_f32 v55, v55, v142, v143
    v_max3_f32 v55, v55, v156, v157
    v_max3_f32 v55, v55, v158, v159
    v_mov_b32 v226, v54
    v_mov_b32 v227, v55
    s_nop 1
    v_permlane16_swap_b32 v54, v226
    v_permlane16_swap_b32 v55, v227
    s_nop 1
    v_max_f32 v54, v54, v226
    v_max_f32 v55, v55, v227
    v_mov_b32 v226, v54
    v_mov_b32 v227, v55
    s_nop 1
    v_permlane32_swap_b32 v54, v226
    v_permlane32_swap_b32 v55, v227
    s_nop 1
    v_max_f32 v54, v54, v226
    v_max_f32 v55, v55, v227
    v_add_f32 v54, 0x41400000, v54
    v_max_f32 v54, 0, v54
    v_add_f32 v55, 0x41400000, v55
    v_max_f32 v55, 0, v55
    v_sub_f32 v128, v128, v54
    v_sub_f32 v129, v129, v54
    v_sub_f32 v130, v130, v54
    v_sub_f32 v131, v131, v54
    v_sub_f32 v132, v132, v55
    v_sub_f32 v133, v133, v55
    v_sub_f32 v134, v134, v55
    v_sub_f32 v135, v135, v55
    v_sub_f32 v136, v136, v54
    v_sub_f32 v137, v137, v54
    v_sub_f32 v138, v138, v54
    v_sub_f32 v139, v139, v54
    v_sub_f32 v140, v140, v55
    v_sub_f32 v141, v141, v55
    v_sub_f32 v142, v142, v55
    v_sub_f32 v143, v143, v55
    v_sub_f32 v144, v144, v54
    v_sub_f32 v145, v145, v54
    v_sub_f32 v146, v146, v54
    v_sub_f32 v147, v147, v54
    v_sub_f32 v148, v148, v55
    v_sub_f32 v149, v149, v55
    v_sub_f32 v150, v150, v55
    v_sub_f32 v151, v151, v55
    v_sub_f32 v152, v152, v54
    v_sub_f32 v153, v153, v54
    v_sub_f32 v154, v154, v54
    v_sub_f32 v155, v155, v54
    v_sub_f32 v156, v156, v55
    v_sub_f32 v157, v157, v55
    v_sub_f32 v158, v158, v55
    v_sub_f32 v159, v159, v55
    v_sub_f32 v160, v160, v54
    v_sub_f32 v16, v16, v54
    v_sub_f32 v161, v161, v54
    v_sub_f32 v17, v17, v54
    v_sub_f32 v162, v162, v54
    v_sub_f32 v18, v18, v54
    v_sub_f32 v163, v163, v54
    v_sub_f32 v19, v19, v54
    v_sub_f32 v164, v164, v55
    v_sub_f32 v20, v20, v55
    v_sub_f32 v165, v165, v55
    v_sub_f32 v21, v21, v55
    v_sub_f32 v166, v166, v55
    v_sub_f32 v22, v22, v55
    v_sub_f32 v167, v167, v55
    v_sub_f32 v23, v23, v55
    v_sub_f32 v168, v168, v54
    v_sub_f32 v24, v24, v54
    v_sub_f32 v169, v169, v54
    v_sub_f32 v25, v25, v54
    v_sub_f32 v170, v170, v54
    v_sub_f32 v26, v26, v54
    v_sub_f32 v171, v171, v54
    v_sub_f32 v27, v27, v54
    v_sub_f32 v172, v172, v55
    v_sub_f32 v28, v28, v55
    v_sub_f32 v173, v173, v55
    v_sub_f32 v29, v29, v55
    v_sub_f32 v174, v174, v55
    v_sub_f32 v30, v30, v55
    v_sub_f32 v175, v175, v55
    v_sub_f32 v31, v31, v55
    v_sub_f32 v176, v176, v54
    v_sub_f32 v32, v32, v54
    v_sub_f32 v177, v177, v54
    v_sub_f32 v33, v33, v54
    v_sub_f32 v178, v178, v54
    v_sub_f32 v34, v34, v54
    v_sub_f32 v179, v179, v54
    v_sub_f32 v35, v35, v54
    v_sub_f32 v180, v180, v55
    v_sub_f32 v36, v36, v55
    v_sub_f32 v181, v181, v55
    v_sub_f32 v37, v37, v55
    v_sub_f32 v182, v182, v55
    v_sub_f32 v38, v38, v55
    v_sub_f32 v183, v183, v55
    v_sub_f32 v39, v39, v55
    v_sub_f32 v184, v184, v54
    v_sub_f32 v40, v40, v54
    v_sub_f32 v185, v185, v54
    v_sub_f32 v41, v41, v54
    v_sub_f32 v186, v186, v54
    v_sub_f32 v42, v42, v54
    v_sub_f32 v187, v187, v54
    v_sub_f32 v43, v43, v54
    v_sub_f32 v188, v188, v55
    v_sub_f32 v44, v44, v55
    v_sub_f32 v189, v189, v55
    v_sub_f32 v45, v45, v55
    v_sub_f32 v190, v190, v55
    v_sub_f32 v46, v46, v55
    v_sub_f32 v191, v191, v55
    v_sub_f32 v47, v47, v55
    v_sub_f32 v10, v10, v54
    v_exp_f32 v54, -v54
    v_sub_f32 v11, v11, v55
    v_exp_f32 v55, -v55
    s_nop 0
    v_mul_f32 v248, v248, v54
    v_mul_f32 v252, v252, v55
    v_accvgpr_read_b32 v224, a8
    v_accvgpr_read_b32 v225, a9
    v_accvgpr_read_b32 v226, a10
    v_accvgpr_read_b32 v227, a11
    v_mul_f32 v224, v224, v54
    v_mul_f32 v225, v225, v54
    v_mul_f32 v226, v226, v54
    v_mul_f32 v227, v227, v54
    v_accvgpr_write_b32 a8, v224
    v_accvgpr_write_b32 a9, v225
    v_accvgpr_write_b32 a10, v226
    v_accvgpr_write_b32 a11, v227
    v_accvgpr_read_b32 v224, a12
    v_accvgpr_read_b32 v225, a13
    v_accvgpr_read_b32 v226, a14
    v_accvgpr_read_b32 v227, a15
    v_mul_f32 v224, v224, v55
    v_mul_f32 v225, v225, v55
    v_mul_f32 v226, v226, v55
    v_mul_f32 v227, v227, v55
    v_accvgpr_write_b32 a12, v224
    v_accvgpr_write_b32 a13, v225
    v_accvgpr_write_b32 a14, v226
    v_accvgpr_write_b32 a15, v227
    v_accvgpr_read_b32 v224, a24
    v_accvgpr_read_b32 v225, a25
    v_accvgpr_read_b32 v226, a26
    v_accvgpr_read_b32 v227, a27
    v_mul_f32 v224, v224, v54
    v_mul_f32 v225, v225, v54
    v_mul_f32 v226, v226, v54
    v_mul_f32 v227, v227, v54
    v_accvgpr_write_b32 a24, v224
    v_accvgpr_write_b32 a25, v225
    v_accvgpr_write_b32 a26, v226
    v_accvgpr_write_b32 a27, v227
    v_accvgpr_read_b32 v224, a28
    v_accvgpr_read_b32 v225, a29
    v_accvgpr_read_b32 v226, a30
    v_accvgpr_read_b32 v227, a31
    v_mul_f32 v224, v224, v55
    v_mul_f32 v225, v225, v55
    v_mul_f32 v226, v226, v55
    v_mul_f32 v227, v227, v55
    v_accvgpr_write_b32 a28, v224
    v_accvgpr_write_b32 a29, v225
    v_accvgpr_write_b32 a30, v226
    v_accvgpr_write_b32 a31, v227
    v_accvgpr_read_b32 v224, a40
    v_accvgpr_read_b32 v225, a41
    v_accvgpr_read_b32 v226, a42
    v_accvgpr_read_b32 v227, a43
    v_mul_f32 v224, v224, v54
    v_mul_f32 v225, v225, v54
    v_mul_f32 v226, v226, v54
    v_mul_f32 v227, v227, v54
    v_accvgpr_write_b32 a40, v224
    v_accvgpr_write_b32 a41, v225
    v_accvgpr_write_b32 a42, v226
    v_accvgpr_write_b32 a43, v227
    v_accvgpr_read_b32 v224, a44
    v_accvgpr_read_b32 v225, a45
    v_accvgpr_read_b32 v226, a46
    v_accvgpr_read_b32 v227, a47
    v_mul_f32 v224, v224, v55
    v_mul_f32 v225, v225, v55
    v_mul_f32 v226, v226, v55
    v_mul_f32 v227, v227, v55
    v_accvgpr_write_b32 a44, v224
    v_accvgpr_write_b32 a45, v225
    v_accvgpr_write_b32 a46, v226
    v_accvgpr_write_b32 a47, v227
    v_accvgpr_read_b32 v224, a56
    v_accvgpr_read_b32 v225, a57
    v_accvgpr_read_b32 v226, a58
    v_accvgpr_read_b32 v227, a59
    v_mul_f32 v224, v224, v54
    v_mul_f32 v225, v225, v54
    v_mul_f32 v226, v226, v54
    v_mul_f32 v227, v227, v54
    v_accvgpr_write_b32 a56, v224
    v_accvgpr_write_b32 a57, v225
    v_accvgpr_write_b32 a58, v226
    v_accvgpr_write_b32 a59, v227
    v_accvgpr_read_b32 v224, a60
    v_accvgpr_read_b32 v225, a61
    v_accvgpr_read_b32 v226, a62
    v_accvgpr_read_b32 v227, a63
    v_mul_f32 v224, v224, v55
    v_mul_f32 v225, v225, v55
    v_mul_f32 v226, v226, v55
    v_mul_f32 v227, v227, v55
    v_accvgpr_write_b32 a60, v224
    v_accvgpr_write_b32 a61, v225
    v_accvgpr_write_b32 a62, v226
    v_accvgpr_write_b32 a63, v227
    v_accvgpr_read_b32 v224, a72
    v_accvgpr_read_b32 v225, a73
    v_accvgpr_read_b32 v226, a74
    v_accvgpr_read_b32 v227, a75
    v_mul_f32 v224, v224, v54
    v_mul_f32 v225, v225, v54
    v_mul_f32 v226, v226, v54
    v_mul_f32 v227, v227, v54
    v_accvgpr_write_b32 a72, v224
    v_accvgpr_write_b32 a73, v225
    v_accvgpr_write_b32 a74, v226
    v_accvgpr_write_b32 a75, v227
    v_accvgpr_read_b32 v224, a76
    v_accvgpr_read_b32 v225, a77
    v_accvgpr_read_b32 v226, a78
    v_accvgpr_read_b32 v227, a79
    v_mul_f32 v224, v224, v55
    v_mul_f32 v225, v225, v55
    v_mul_f32 v226, v226, v55
    v_mul_f32 v227, v227, v55
    v_accvgpr_write_b32 a76, v224
    v_accvgpr_write_b32 a77, v225
    v_accvgpr_write_b32 a78, v226
    v_accvgpr_write_b32 a79, v227
    v_accvgpr_read_b32 v224, a88
    v_accvgpr_read_b32 v225, a89
    v_accvgpr_read_b32 v226, a90
    v_accvgpr_read_b32 v227, a91
    v_mul_f32 v224, v224, v54
    v_mul_f32 v225, v225, v54
    v_mul_f32 v226, v226, v54
    v_mul_f32 v227, v227, v54
    v_accvgpr_write_b32 a88, v224
    v_accvgpr_write_b32 a89, v225
    v_accvgpr_write_b32 a90, v226
    v_accvgpr_write_b32 a91, v227
    v_accvgpr_read_b32 v224, a92
    v_accvgpr_read_b32 v225, a93
    v_accvgpr_read_b32 v226, a94
    v_accvgpr_read_b32 v227, a95
    v_mul_f32 v224, v224, v55
    v_mul_f32 v225, v225, v55
    v_mul_f32 v226, v226, v55
    v_mul_f32 v227, v227, v55
    v_accvgpr_write_b32 a92, v224
    v_accvgpr_write_b32 a93, v225
    v_accvgpr_write_b32 a94, v226
    v_accvgpr_write_b32 a95, v227
    v_accvgpr_read_b32 v224, a104
    v_accvgpr_read_b32 v225, a105
    v_accvgpr_read_b32 v226, a106
    v_accvgpr_read_b32 v227, a107
    v_mul_f32 v224, v224, v54
    v_mul_f32 v225, v225, v54
    v_mul_f32 v226, v226, v54
    v_mul_f32 v227, v227, v54
    v_accvgpr_write_b32 a104, v224
    v_accvgpr_write_b32 a105, v225
    v_accvgpr_write_b32 a106, v226
    v_accvgpr_write_b32 a107, v227
    v_accvgpr_read_b32 v224, a108
    v_accvgpr_read_b32 v225, a109
    v_accvgpr_read_b32 v226, a110
    v_accvgpr_read_b32 v227, a111
    v_mul_f32 v224, v224, v55
    v_mul_f32 v225, v225, v55
    v_mul_f32 v226, v226, v55
    v_mul_f32 v227, v227, v55
    v_accvgpr_write_b32 a108, v224
    v_accvgpr_write_b32 a109, v225
    v_accvgpr_write_b32 a110, v226
    v_accvgpr_write_b32 a111, v227
    v_accvgpr_read_b32 v224, a120
    v_accvgpr_read_b32 v225, a121
    v_accvgpr_read_b32 v226, a122
    v_accvgpr_read_b32 v227, a123
    v_mul_f32 v224, v224, v54
    v_mul_f32 v225, v225, v54
    v_mul_f32 v226, v226, v54
    v_mul_f32 v227, v227, v54
    v_accvgpr_write_b32 a120, v224
    v_accvgpr_write_b32 a121, v225
    v_accvgpr_write_b32 a122, v226
    v_accvgpr_write_b32 a123, v227
    v_accvgpr_read_b32 v224, a124
    v_accvgpr_read_b32 v225, a125
    v_accvgpr_read_b32 v226, a126
    v_accvgpr_read_b32 v227, a127
    v_mul_f32 v224, v224, v55
    v_mul_f32 v225, v225, v55
    v_mul_f32 v226, v226, v55
    v_mul_f32 v227, v227, v55
    v_accvgpr_write_b32 a124, v224
    v_accvgpr_write_b32 a125, v225
    v_accvgpr_write_b32 a126, v226
    v_accvgpr_write_b32 a127, v227
    v_exp_f32 v232, v128
    v_exp_f32 v233, v129
    v_exp_f32 v234, v130
    v_exp_f32 v235, v131
    s_nop 0
    v_cvt_pk_bf16_f32 v192, v232, v233
    v_cvt_pk_bf16_f32 v193, v234, v235
    v_exp_f32 v232, v144
    v_exp_f32 v233, v145
    v_exp_f32 v234, v146
    v_exp_f32 v235, v147
    s_nop 0
    v_cvt_pk_bf16_f32 v194, v232, v233
    v_cvt_pk_bf16_f32 v195, v234, v235
    v_exp_f32 v232, v132
    v_exp_f32 v233, v133
    v_exp_f32 v234, v134
    v_exp_f32 v235, v135
    s_nop 0
    v_cvt_pk_bf16_f32 v196, v232, v233
    v_cvt_pk_bf16_f32 v197, v234, v235
    v_exp_f32 v232, v148
    v_exp_f32 v233, v149
    v_exp_f32 v234, v150
    v_exp_f32 v235, v151
    s_nop 0
    v_cvt_pk_bf16_f32 v198, v232, v233
    v_cvt_pk_bf16_f32 v199, v234, v235
    v_exp_f32 v232, v136
    v_exp_f32 v233, v137
    v_exp_f32 v234, v138
    v_exp_f32 v235, v139
    s_nop 0
    v_cvt_pk_bf16_f32 v200, v232, v233
    v_cvt_pk_bf16_f32 v201, v234, v235
    v_exp_f32 v232, v152
    v_exp_f32 v233, v153
    v_exp_f32 v234, v154
    v_exp_f32 v235, v155
    s_nop 0
    v_cvt_pk_bf16_f32 v202, v232, v233
    v_cvt_pk_bf16_f32 v203, v234, v235
    v_exp_f32 v232, v140
    v_exp_f32 v233, v141
    v_exp_f32 v234, v142
    v_exp_f32 v235, v143
    s_nop 0
    v_cvt_pk_bf16_f32 v204, v232, v233
    v_cvt_pk_bf16_f32 v205, v234, v235
    v_exp_f32 v232, v156
    v_exp_f32 v233, v157
    v_exp_f32 v234, v158
    v_exp_f32 v235, v159
    s_nop 0
    v_cvt_pk_bf16_f32 v206, v232, v233
    v_cvt_pk_bf16_f32 v207, v234, v235
    s_nop 1
    s_branch k2_ret_70
k2_rare_75:
    s_nop 7
    v_max_f32 v54, v160, v161
    v_max3_f32 v54, v54, v162, v163
    v_max3_f32 v54, v54, v176, v177
    v_max3_f32 v54, v54, v178, v179
    v_max3_f32 v54, v54, v168, v169
    v_max3_f32 v54, v54, v170, v171
    v_max3_f32 v54, v54, v184, v185
    v_max3_f32 v54, v54, v186, v187
    v_max_f32 v55, v164, v165
    v_max3_f32 v55, v55, v166, v167
    v_max3_f32 v55, v55, v180, v181
    v_max3_f32 v55, v55, v182, v183
    v_max3_f32 v55, v55, v172, v173
    v_max3_f32 v55, v55, v174, v175
    v_max3_f32 v55, v55, v188, v189
    v_max3_f32 v55, v55, v190, v191
    v_mov_b32 v226, v54
    v_mov_b32 v227, v55
    s_nop 1
    v_permlane16_swap_b32 v54, v226
    v_permlane16_swap_b32 v55, v227
    s_nop 1
    v_max_f32 v54, v54, v226
    v_max_f32 v55, v55, v227
    v_mov_b32 v226, v54
    v_mov_b32 v227, v55
    s_nop 1
    v_permlane32_swap_b32 v54, v226
    v_permlane32_swap_b32 v55, v227
    s_nop 1
    v_max_f32 v54, v54, v226
    v_max_f32 v55, v55, v227
    v_add_f32 v54, 0x41400000, v54
    v_max_f32 v54, 0, v54
    v_add_f32 v55, 0x41400000, v55
    v_max_f32 v55, 0, v55
    v_sub_f32 v160, v160, v54
    v_sub_f32 v161, v161, v54
    v_sub_f32 v162, v162, v54
    v_sub_f32 v163, v163, v54
    v_sub_f32 v164, v164, v55
    v_sub_f32 v165, v165, v55
    v_sub_f32 v166, v166, v55
    v_sub_f32 v167, v167, v55
    v_sub_f32 v168, v168, v54
    v_sub_f32 v169, v169, v54
    v_sub_f32 v170, v170, v54
    v_sub_f32 v171, v171, v54
    v_sub_f32 v172, v172, v55
    v_sub_f32 v173, v173, v55
    v_sub_f32 v174, v174, v55
    v_sub_f32 v175, v175, v55
    v_sub_f32 v176, v176, v54
    v_sub_f32 v177, v177, v54
    v_sub_f32 v178, v178, v54
    v_sub_f32 v179, v179, v54
    v_sub_f32 v180, v180, v55
    v_sub_f32 v181, v181, v55
    v_sub_f32 v182, v182, v55
    v_sub_f32 v183, v183, v55
    v_sub_f32 v184, v184, v54
    v_sub_f32 v185, v185, v54
    v_sub_f32 v186, v186, v54
    v_sub_f32 v187, v187, v54
    v_sub_f32 v188, v188, v55
    v_sub_f32 v189, v189, v55
    v_sub_f32 v190, v190, v55
    v_sub_f32 v191, v191, v55
    v_sub_f32 v128, v128, v54
    v_sub_f32 v16, v16, v54
    v_sub_f32 v129, v129, v54
    v_sub_f32 v17, v17, v54
    v_sub_f32 v130, v130, v54
    v_sub_f32 v18, v18, v54
    v_sub_f32 v131, v131, v54
    v_sub_f32 v19, v19, v54
    v_sub_f32 v132, v132, v55
    v_sub_f32 v20, v20, v55
    v_sub_f32 v133, v133, v55
    v_sub_f32 v21, v21, v55
    v_sub_f32 v134, v134, v55
    v_sub_f32 v22, v22, v55
    v_sub_f32 v135, v135, v55
    v_sub_f32 v23, v23, v55
    v_sub_f32 v136, v136, v54
    v_sub_f32 v24, v24, v54
    v_sub_f32 v137, v137, v54
    v_sub_f32 v25, v25, v54
    v_sub_f32 v138, v138, v54
    v_sub_f32 v26, v26, v54
    v_sub_f32 v139, v139, v54
    v_sub_f32 v27, v27, v54
    v_sub_f32 v140, v140, v55
    v_sub_f32 v28, v28, v55
    v_sub_f32 v141, v141, v55
    v_sub_f32 v29, v29, v55
    v_sub_f32 v142, v142, v55
    v_sub_f32 v30, v30, v55
    v_sub_f32 v143, v143, v55
    v_sub_f32 v31, v31, v55
    v_sub_f32 v144, v144, v54
    v_sub_f32 v32, v32, v54
    v_sub_f32 v145, v145, v54
    v_sub_f32 v33, v33, v54
    v_sub_f32 v146, v146, v54
    v_sub_f32 v34, v34, v54
    v_sub_f32 v147, v147, v54
    v_sub_f32 v35, v35, v54
    v_sub_f32 v148, v148, v55
    v_sub_f32 v36, v36, v55
    v_sub_f32 v149, v149, v55
    v_sub_f32 v37, v37, v55
    v_sub_f32 v150, v150, v55
    v_sub_f32 v38, v38, v55
    v_sub_f32 v151, v151, v55
    v_sub_f32 v39, v39, v55
    v_sub_f32 v152, v152, v54
    v_sub_f32 v40, v40, v54
    v_sub_f32 v153, v153, v54
    v_sub_f32 v41, v41, v54
    v_sub_f32 v154, v154, v54
    v_sub_f32 v42, v42, v54
    v_sub_f32 v155, v155, v54
    v_sub_f32 v43, v43, v54
    v_sub_f32 v156, v156, v55
    v_sub_f32 v44, v44, v55
    v_sub_f32 v157, v157, v55
    v_sub_f32 v45, v45, v55
    v_sub_f32 v158, v158, v55
    v_sub_f32 v46, v46, v55
    v_sub_f32 v159, v159, v55
    v_sub_f32 v47, v47, v55
    v_sub_f32 v10, v10, v54
    v_exp_f32 v54, -v54
    v_sub_f32 v11, v11, v55
    v_exp_f32 v55, -v55
    s_nop 0
    v_mul_f32 v248, v248, v54
    v_mul_f32 v252, v252, v55
    v_accvgpr_read_b32 v224, a8
    v_accvgpr_read_b32 v225, a9
    v_accvgpr_read_b32 v226, a10
    v_accvgpr_read_b32 v227, a11
    v_mul_f32 v224, v224, v54
    v_mul_f32 v225, v225, v54
    v_mul_f32 v226, v226, v54
    v_mul_f32 v227, v227, v54
    v_accvgpr_write_b32 a8, v224
    v_accvgpr_write_b32 a9, v225
    v_accvgpr_write_b32 a10, v226
    v_accvgpr_write_b32 a11, v227
    v_accvgpr_read_b32 v224, a12
    v_accvgpr_read_b32 v225, a13
    v_accvgpr_read_b32 v226, a14
    v_accvgpr_read_b32 v227, a15
    v_mul_f32 v224, v224, v55
    v_mul_f32 v225, v225, v55
    v_mul_f32 v226, v226, v55
    v_mul_f32 v227, v227, v55
    v_accvgpr_write_b32 a12, v224
    v_accvgpr_write_b32 a13, v225
    v_accvgpr_write_b32 a14, v226
    v_accvgpr_write_b32 a15, v227
    v_accvgpr_read_b32 v224, a24
    v_accvgpr_read_b32 v225, a25
    v_accvgpr_read_b32 v226, a26
    v_accvgpr_read_b32 v227, a27
    v_mul_f32 v224, v224, v54
    v_mul_f32 v225, v225, v54
    v_mul_f32 v226, v226, v54
    v_mul_f32 v227, v227, v54
    v_accvgpr_write_b32 a24, v224
    v_accvgpr_write_b32 a25, v225
    v_accvgpr_write_b32 a26, v226
    v_accvgpr_write_b32 a27, v227
    v_accvgpr_read_b32 v224, a28
    v_accvgpr_read_b32 v225, a29
    v_accvgpr_read_b32 v226, a30
    v_accvgpr_read_b32 v227, a31
    v_mul_f32 v224, v224, v55
    v_mul_f32 v225, v225, v55
    v_mul_f32 v226, v226, v55
    v_mul_f32 v227, v227, v55
    v_accvgpr_write_b32 a28, v224
    v_accvgpr_write_b32 a29, v225
    v_accvgpr_write_b32 a30, v226
    v_accvgpr_write_b32 a31, v227
    v_accvgpr_read_b32 v224, a40
    v_accvgpr_read_b32 v225, a41
    v_accvgpr_read_b32 v226, a42
    v_accvgpr_read_b32 v227, a43
    v_mul_f32 v224, v224, v54
    v_mul_f32 v225, v225, v54
    v_mul_f32 v226, v226, v54
    v_mul_f32 v227, v227, v54
    v_accvgpr_write_b32 a40, v224
    v_accvgpr_write_b32 a41, v225
    v_accvgpr_write_b32 a42, v226
    v_accvgpr_write_b32 a43, v227
    v_accvgpr_read_b32 v224, a44
    v_accvgpr_read_b32 v225, a45
    v_accvgpr_read_b32 v226, a46
    v_accvgpr_read_b32 v227, a47
    v_mul_f32 v224, v224, v55
    v_mul_f32 v225, v225, v55
    v_mul_f32 v226, v226, v55
    v_mul_f32 v227, v227, v55
    v_accvgpr_write_b32 a44, v224
    v_accvgpr_write_b32 a45, v225
    v_accvgpr_write_b32 a46, v226
    v_accvgpr_write_b32 a47, v227
    v_accvgpr_read_b32 v224, a56
    v_accvgpr_read_b32 v225, a57
    v_accvgpr_read_b32 v226, a58
    v_accvgpr_read_b32 v227, a59
    v_mul_f32 v224, v224, v54
    v_mul_f32 v225, v225, v54
    v_mul_f32 v226, v226, v54
    v_mul_f32 v227, v227, v54
    v_accvgpr_write_b32 a56, v224
    v_accvgpr_write_b32 a57, v225
    v_accvgpr_write_b32 a58, v226
    v_accvgpr_write_b32 a59, v227
    v_accvgpr_read_b32 v224, a60
    v_accvgpr_read_b32 v225, a61
    v_accvgpr_read_b32 v226, a62
    v_accvgpr_read_b32 v227, a63
    v_mul_f32 v224, v224, v55
    v_mul_f32 v225, v225, v55
    v_mul_f32 v226, v226, v55
    v_mul_f32 v227, v227, v55
    v_accvgpr_write_b32 a60, v224
    v_accvgpr_write_b32 a61, v225
    v_accvgpr_write_b32 a62, v226
    v_accvgpr_write_b32 a63, v227
    v_accvgpr_read_b32 v224, a72
    v_accvgpr_read_b32 v225, a73
    v_accvgpr_read_b32 v226, a74
    v_accvgpr_read_b32 v227, a75
    v_mul_f32 v224, v224, v54
    v_mul_f32 v225, v225, v54
    v_mul_f32 v226, v226, v54
    v_mul_f32 v227, v227, v54
    v_accvgpr_write_b32 a72, v224
    v_accvgpr_write_b32 a73, v225
    v_accvgpr_write_b32 a74, v226
    v_accvgpr_write_b32 a75, v227
    v_accvgpr_read_b32 v224, a76
    v_accvgpr_read_b32 v225, a77
    v_accvgpr_read_b32 v226, a78
    v_accvgpr_read_b32 v227, a79
    v_mul_f32 v224, v224, v55
    v_mul_f32 v225, v225, v55
    v_mul_f32 v226, v226, v55
    v_mul_f32 v227, v227, v55
    v_accvgpr_write_b32 a76, v224
    v_accvgpr_write_b32 a77, v225
    v_accvgpr_write_b32 a78, v226
    v_accvgpr_write_b32 a79, v227
    v_accvgpr_read_b32 v224, a88
    v_accvgpr_read_b32 v225, a89
    v_accvgpr_read_b32 v226, a90
    v_accvgpr_read_b32 v227, a91
    v_mul_f32 v224, v224, v54
    v_mul_f32 v225, v225, v54
    v_mul_f32 v226, v226, v54
    v_mul_f32 v227, v227, v54
    v_accvgpr_write_b32 a88, v224
    v_accvgpr_write_b32 a89, v225
    v_accvgpr_write_b32 a90, v226
    v_accvgpr_write_b32 a91, v227
    v_accvgpr_read_b32 v224, a92
    v_accvgpr_read_b32 v225, a93
    v_accvgpr_read_b32 v226, a94
    v_accvgpr_read_b32 v227, a95
    v_mul_f32 v224, v224, v55
    v_mul_f32 v225, v225, v55
    v_mul_f32 v226, v226, v55
    v_mul_f32 v227, v227, v55
    v_accvgpr_write_b32 a92, v224
    v_accvgpr_write_b32 a93, v225
    v_accvgpr_write_b32 a94, v226
    v_accvgpr_write_b32 a95, v227
    v_accvgpr_read_b32 v224, a104
    v_accvgpr_read_b32 v225, a105
    v_accvgpr_read_b32 v226, a106
    v_accvgpr_read_b32 v227, a107
    v_mul_f32 v224, v224, v54
    v_mul_f32 v225, v225, v54
    v_mul_f32 v226, v226, v54
    v_mul_f32 v227, v227, v54
    v_accvgpr_write_b32 a104, v224
    v_accvgpr_write_b32 a105, v225
    v_accvgpr_write_b32 a106, v226
    v_accvgpr_write_b32 a107, v227
    v_accvgpr_read_b32 v224, a108
    v_accvgpr_read_b32 v225, a109
    v_accvgpr_read_b32 v226, a110
    v_accvgpr_read_b32 v227, a111
    v_mul_f32 v224, v224, v55
    v_mul_f32 v225, v225, v55
    v_mul_f32 v226, v226, v55
    v_mul_f32 v227, v227, v55
    v_accvgpr_write_b32 a108, v224
    v_accvgpr_write_b32 a109, v225
    v_accvgpr_write_b32 a110, v226
    v_accvgpr_write_b32 a111, v227
    v_accvgpr_read_b32 v224, a120
    v_accvgpr_read_b32 v225, a121
    v_accvgpr_read_b32 v226, a122
    v_accvgpr_read_b32 v227, a123
    v_mul_f32 v224, v224, v54
    v_mul_f32 v225, v225, v54
    v_mul_f32 v226, v226, v54
    v_mul_f32 v227, v227, v54
    v_accvgpr_write_b32 a120, v224
    v_accvgpr_write_b32 a121, v225
    v_accvgpr_write_b32 a122, v226
    v_accvgpr_write_b32 a123, v227
    v_accvgpr_read_b32 v224, a124
    v_accvgpr_read_b32 v225, a125
    v_accvgpr_read_b32 v226, a126
    v_accvgpr_read_b32 v227, a127
    v_mul_f32 v224, v224, v55
    v_mul_f32 v225, v225, v55
    v_mul_f32 v226, v226, v55
    v_mul_f32 v227, v227, v55
    v_accvgpr_write_b32 a124, v224
    v_accvgpr_write_b32 a125, v225
    v_accvgpr_write_b32 a126, v226
    v_accvgpr_write_b32 a127, v227
    v_exp_f32 v232, v160
    v_exp_f32 v233, v161
    v_exp_f32 v234, v162
    v_exp_f32 v235, v163
    s_nop 0
    v_cvt_pk_bf16_f32 v208, v232, v233
    v_cvt_pk_bf16_f32 v209, v234, v235
    v_exp_f32 v232, v176
    v_exp_f32 v233, v177
    v_exp_f32 v234, v178
    v_exp_f32 v235, v179
    s_nop 0
    v_cvt_pk_bf16_f32 v210, v232, v233
    v_cvt_pk_bf16_f32 v211, v234, v235
    v_exp_f32 v232, v164
    v_exp_f32 v233, v165
    v_exp_f32 v234, v166
    v_exp_f32 v235, v167
    s_nop 0
    v_cvt_pk_bf16_f32 v212, v232, v233
    v_cvt_pk_bf16_f32 v213, v234, v235
    v_exp_f32 v232, v180
    v_exp_f32 v233, v181
    v_exp_f32 v234, v182
    v_exp_f32 v235, v183
    s_nop 0
    v_cvt_pk_bf16_f32 v214, v232, v233
    v_cvt_pk_bf16_f32 v215, v234, v235
    v_exp_f32 v232, v168
    v_exp_f32 v233, v169
    v_exp_f32 v234, v170
    v_exp_f32 v235, v171
    s_nop 0
    v_cvt_pk_bf16_f32 v216, v232, v233
    v_cvt_pk_bf16_f32 v217, v234, v235
    v_exp_f32 v232, v184
    v_exp_f32 v233, v185
    v_exp_f32 v234, v186
    v_exp_f32 v235, v187
    s_nop 0
    v_cvt_pk_bf16_f32 v218, v232, v233
    v_cvt_pk_bf16_f32 v219, v234, v235
    v_exp_f32 v232, v172
    v_exp_f32 v233, v173
    v_exp_f32 v234, v174
    v_exp_f32 v235, v175
    s_nop 0
    v_cvt_pk_bf16_f32 v220, v232, v233
    v_cvt_pk_bf16_f32 v221, v234, v235
    v_exp_f32 v232, v188
    v_exp_f32 v233, v189
    v_exp_f32 v234, v190
    v_exp_f32 v235, v191
    s_nop 0
    v_cvt_pk_bf16_f32 v222, v232, v233
    v_cvt_pk_bf16_f32 v223, v234, v235
    s_nop 1
    s_branch k2_ret_76
k2_rare_79:
    s_nop 7
    v_max_f32 v54, v128, v129
    v_max3_f32 v54, v54, v130, v131
    v_max3_f32 v54, v54, v144, v145
    v_max3_f32 v54, v54, v146, v147
    v_max3_f32 v54, v54, v136, v137
    v_max3_f32 v54, v54, v138, v139
    v_max3_f32 v54, v54, v152, v153
    v_max3_f32 v54, v54, v154, v155
    v_max_f32 v55, v132, v133
    v_max3_f32 v55, v55, v134, v135
    v_max3_f32 v55, v55, v148, v149
    v_max3_f32 v55, v55, v150, v151
    v_max3_f32 v55, v55, v140, v141
    v_max3_f32 v55, v55, v142, v143
    v_max3_f32 v55, v55, v156, v157
    v_max3_f32 v55, v55, v158, v159
    v_mov_b32 v226, v54
    v_mov_b32 v227, v55
    s_nop 1
    v_permlane16_swap_b32 v54, v226
    v_permlane16_swap_b32 v55, v227
    s_nop 1
    v_max_f32 v54, v54, v226
    v_max_f32 v55, v55, v227
    v_mov_b32 v226, v54
    v_mov_b32 v227, v55
    s_nop 1
    v_permlane32_swap_b32 v54, v226
    v_permlane32_swap_b32 v55, v227
    s_nop 1
    v_max_f32 v54, v54, v226
    v_max_f32 v55, v55, v227
    v_add_f32 v54, 0x41400000, v54
    v_max_f32 v54, 0, v54
    v_add_f32 v55, 0x41400000, v55
    v_max_f32 v55, 0, v55
    v_sub_f32 v128, v128, v54
    v_sub_f32 v129, v129, v54
    v_sub_f32 v130, v130, v54
    v_sub_f32 v131, v131, v54
    v_sub_f32 v132, v132, v55
    v_sub_f32 v133, v133, v55
    v_sub_f32 v134, v134, v55
    v_sub_f32 v135, v135, v55
    v_sub_f32 v136, v136, v54
    v_sub_f32 v137, v137, v54
    v_sub_f32 v138, v138, v54
    v_sub_f32 v139, v139, v54
    v_sub_f32 v140, v140, v55
    v_sub_f32 v141, v141, v55
    v_sub_f32 v142, v142, v55
    v_sub_f32 v143, v143, v55
    v_sub_f32 v144, v144, v54
    v_sub_f32 v145, v145, v54
    v_sub_f32 v146, v146, v54
    v_sub_f32 v147, v147, v54
    v_sub_f32 v148, v148, v55
    v_sub_f32 v149, v149, v55
    v_sub_f32 v150, v150, v55
    v_sub_f32 v151, v151, v55
    v_sub_f32 v152, v152, v54
    v_sub_f32 v153, v153, v54
    v_sub_f32 v154, v154, v54
    v_sub_f32 v155, v155, v54
    v_sub_f32 v156, v156, v55
    v_sub_f32 v157, v157, v55
    v_sub_f32 v158, v158, v55
    v_sub_f32 v159, v159, v55
    v_sub_f32 v160, v160, v54
    v_sub_f32 v16, v16, v54
    v_sub_f32 v161, v161, v54
    v_sub_f32 v17, v17, v54
    v_sub_f32 v162, v162, v54
    v_sub_f32 v18, v18, v54
    v_sub_f32 v163, v163, v54
    v_sub_f32 v19, v19, v54
    v_sub_f32 v164, v164, v55
    v_sub_f32 v20, v20, v55
    v_sub_f32 v165, v165, v55
    v_sub_f32 v21, v21, v55
    v_sub_f32 v166, v166, v55
    v_sub_f32 v22, v22, v55
    v_sub_f32 v167, v167, v55
    v_sub_f32 v23, v23, v55
    v_sub_f32 v168, v168, v54
    v_sub_f32 v24, v24, v54
    v_sub_f32 v169, v169, v54
    v_sub_f32 v25, v25, v54
    v_sub_f32 v170, v170, v54
    v_sub_f32 v26, v26, v54
    v_sub_f32 v171, v171, v54
    v_sub_f32 v27, v27, v54
    v_sub_f32 v172, v172, v55
    v_sub_f32 v28, v28, v55
    v_sub_f32 v173, v173, v55
    v_sub_f32 v29, v29, v55
    v_sub_f32 v174, v174, v55
    v_sub_f32 v30, v30, v55
    v_sub_f32 v175, v175, v55
    v_sub_f32 v31, v31, v55
    v_sub_f32 v176, v176, v54
    v_sub_f32 v32, v32, v54
    v_sub_f32 v177, v177, v54
    v_sub_f32 v33, v33, v54
    v_sub_f32 v178, v178, v54
    v_sub_f32 v34, v34, v54
    v_sub_f32 v179, v179, v54
    v_sub_f32 v35, v35, v54
    v_sub_f32 v180, v180, v55
    v_sub_f32 v36, v36, v55
    v_sub_f32 v181, v181, v55
    v_sub_f32 v37, v37, v55
    v_sub_f32 v182, v182, v55
    v_sub_f32 v38, v38, v55
    v_sub_f32 v183, v183, v55
    v_sub_f32 v39, v39, v55
    v_sub_f32 v184, v184, v54
    v_sub_f32 v40, v40, v54
    v_sub_f32 v185, v185, v54
    v_sub_f32 v41, v41, v54
    v_sub_f32 v186, v186, v54
    v_sub_f32 v42, v42, v54
    v_sub_f32 v187, v187, v54
    v_sub_f32 v43, v43, v54
    v_sub_f32 v188, v188, v55
    v_sub_f32 v44, v44, v55
    v_sub_f32 v189, v189, v55
    v_sub_f32 v45, v45, v55
    v_sub_f32 v190, v190, v55
    v_sub_f32 v46, v46, v55
    v_sub_f32 v191, v191, v55
    v_sub_f32 v47, v47, v55
    v_sub_f32 v10, v10, v54
    v_exp_f32 v54, -v54
    v_sub_f32 v11, v11, v55
    v_exp_f32 v55, -v55
    s_nop 0
    v_mul_f32 v248, v248, v54
    v_mul_f32 v252, v252, v55
    v_accvgpr_read_b32 v224, a8
    v_accvgpr_read_b32 v225, a9
    v_accvgpr_read_b32 v226, a10
    v_accvgpr_read_b32 v227, a11
    v_mul_f32 v224, v224, v54
    v_mul_f32 v225, v225, v54
    v_mul_f32 v226, v226, v54
    v_mul_f32 v227, v227, v54
    v_accvgpr_write_b32 a8, v224
    v_accvgpr_write_b32 a9, v225
    v_accvgpr_write_b32 a10, v226
    v_accvgpr_write_b32 a11, v227
    v_accvgpr_read_b32 v224, a12
    v_accvgpr_read_b32 v225, a13
    v_accvgpr_read_b32 v226, a14
    v_accvgpr_read_b32 v227, a15
    v_mul_f32 v224, v224, v55
    v_mul_f32 v225, v225, v55
    v_mul_f32 v226, v226, v55
    v_mul_f32 v227, v227, v55
    v_accvgpr_write_b32 a12, v224
    v_accvgpr_write_b32 a13, v225
    v_accvgpr_write_b32 a14, v226
    v_accvgpr_write_b32 a15, v227
    v_accvgpr_read_b32 v224, a24
    v_accvgpr_read_b32 v225, a25
    v_accvgpr_read_b32 v226, a26
    v_accvgpr_read_b32 v227, a27
    v_mul_f32 v224, v224, v54
    v_mul_f32 v225, v225, v54
    v_mul_f32 v226, v226, v54
    v_mul_f32 v227, v227, v54
    v_accvgpr_write_b32 a24, v224
    v_accvgpr_write_b32 a25, v225
    v_accvgpr_write_b32 a26, v226
    v_accvgpr_write_b32 a27, v227
    v_accvgpr_read_b32 v224, a28
    v_accvgpr_read_b32 v225, a29
    v_accvgpr_read_b32 v226, a30
    v_accvgpr_read_b32 v227, a31
    v_mul_f32 v224, v224, v55
    v_mul_f32 v225, v225, v55
    v_mul_f32 v226, v226, v55
    v_mul_f32 v227, v227, v55
    v_accvgpr_write_b32 a28, v224
    v_accvgpr_write_b32 a29, v225
    v_accvgpr_write_b32 a30, v226
    v_accvgpr_write_b32 a31, v227
    v_accvgpr_read_b32 v224, a40
    v_accvgpr_read_b32 v225, a41
    v_accvgpr_read_b32 v226, a42
    v_accvgpr_read_b32 v227, a43
    v_mul_f32 v224, v224, v54
    v_mul_f32 v225, v225, v54
    v_mul_f32 v226, v226, v54
    v_mul_f32 v227, v227, v54
    v_accvgpr_write_b32 a40, v224
    v_accvgpr_write_b32 a41, v225
    v_accvgpr_write_b32 a42, v226
    v_accvgpr_write_b32 a43, v227
    v_accvgpr_read_b32 v224, a44
    v_accvgpr_read_b32 v225, a45
    v_accvgpr_read_b32 v226, a46
    v_accvgpr_read_b32 v227, a47
    v_mul_f32 v224, v224, v55
    v_mul_f32 v225, v225, v55
    v_mul_f32 v226, v226, v55
    v_mul_f32 v227, v227, v55
    v_accvgpr_write_b32 a44, v224
    v_accvgpr_write_b32 a45, v225
    v_accvgpr_write_b32 a46, v226
    v_accvgpr_write_b32 a47, v227
    v_accvgpr_read_b32 v224, a56
    v_accvgpr_read_b32 v225, a57
    v_accvgpr_read_b32 v226, a58
    v_accvgpr_read_b32 v227, a59
    v_mul_f32 v224, v224, v54
    v_mul_f32 v225, v225, v54
    v_mul_f32 v226, v226, v54
    v_mul_f32 v227, v227, v54
    v_accvgpr_write_b32 a56, v224
    v_accvgpr_write_b32 a57, v225
    v_accvgpr_write_b32 a58, v226
    v_accvgpr_write_b32 a59, v227
    v_accvgpr_read_b32 v224, a60
    v_accvgpr_read_b32 v225, a61
    v_accvgpr_read_b32 v226, a62
    v_accvgpr_read_b32 v227, a63
    v_mul_f32 v224, v224, v55
    v_mul_f32 v225, v225, v55
    v_mul_f32 v226, v226, v55
    v_mul_f32 v227, v227, v55
    v_accvgpr_write_b32 a60, v224
    v_accvgpr_write_b32 a61, v225
    v_accvgpr_write_b32 a62, v226
    v_accvgpr_write_b32 a63, v227
    v_accvgpr_read_b32 v224, a72
    v_accvgpr_read_b32 v225, a73
    v_accvgpr_read_b32 v226, a74
    v_accvgpr_read_b32 v227, a75
    v_mul_f32 v224, v224, v54
    v_mul_f32 v225, v225, v54
    v_mul_f32 v226, v226, v54
    v_mul_f32 v227, v227, v54
    v_accvgpr_write_b32 a72, v224
    v_accvgpr_write_b32 a73, v225
    v_accvgpr_write_b32 a74, v226
    v_accvgpr_write_b32 a75, v227
    v_accvgpr_read_b32 v224, a76
    v_accvgpr_read_b32 v225, a77
    v_accvgpr_read_b32 v226, a78
    v_accvgpr_read_b32 v227, a79
    v_mul_f32 v224, v224, v55
    v_mul_f32 v225, v225, v55
    v_mul_f32 v226, v226, v55
    v_mul_f32 v227, v227, v55
    v_accvgpr_write_b32 a76, v224
    v_accvgpr_write_b32 a77, v225
    v_accvgpr_write_b32 a78, v226
    v_accvgpr_write_b32 a79, v227
    v_accvgpr_read_b32 v224, a88
    v_accvgpr_read_b32 v225, a89
    v_accvgpr_read_b32 v226, a90
    v_accvgpr_read_b32 v227, a91
    v_mul_f32 v224, v224, v54
    v_mul_f32 v225, v225, v54
    v_mul_f32 v226, v226, v54
    v_mul_f32 v227, v227, v54
    v_accvgpr_write_b32 a88, v224
    v_accvgpr_write_b32 a89, v225
    v_accvgpr_write_b32 a90, v226
    v_accvgpr_write_b32 a91, v227
    v_accvgpr_read_b32 v224, a92
    v_accvgpr_read_b32 v225, a93
    v_accvgpr_read_b32 v226, a94
    v_accvgpr_read_b32 v227, a95
    v_mul_f32 v224, v224, v55
    v_mul_f32 v225, v225, v55
    v_mul_f32 v226, v226, v55
    v_mul_f32 v227, v227, v55
    v_accvgpr_write_b32 a92, v224
    v_accvgpr_write_b32 a93, v225
    v_accvgpr_write_b32 a94, v226
    v_accvgpr_write_b32 a95, v227
    v_accvgpr_read_b32 v224, a104
    v_accvgpr_read_b32 v225, a105
    v_accvgpr_read_b32 v226, a106
    v_accvgpr_read_b32 v227, a107
    v_mul_f32 v224, v224, v54
    v_mul_f32 v225, v225, v54
    v_mul_f32 v226, v226, v54
    v_mul_f32 v227, v227, v54
    v_accvgpr_write_b32 a104, v224
    v_accvgpr_write_b32 a105, v225
    v_accvgpr_write_b32 a106, v226
    v_accvgpr_write_b32 a107, v227
    v_accvgpr_read_b32 v224, a108
    v_accvgpr_read_b32 v225, a109
    v_accvgpr_read_b32 v226, a110
    v_accvgpr_read_b32 v227, a111
    v_mul_f32 v224, v224, v55
    v_mul_f32 v225, v225, v55
    v_mul_f32 v226, v226, v55
    v_mul_f32 v227, v227, v55
    v_accvgpr_write_b32 a108, v224
    v_accvgpr_write_b32 a109, v225
    v_accvgpr_write_b32 a110, v226
    v_accvgpr_write_b32 a111, v227
    v_accvgpr_read_b32 v224, a120
    v_accvgpr_read_b32 v225, a121
    v_accvgpr_read_b32 v226, a122
    v_accvgpr_read_b32 v227, a123
    v_mul_f32 v224, v224, v54
    v_mul_f32 v225, v225, v54
    v_mul_f32 v226, v226, v54
    v_mul_f32 v227, v227, v54
    v_accvgpr_write_b32 a120, v224
    v_accvgpr_write_b32 a121, v225
    v_accvgpr_write_b32 a122, v226
    v_accvgpr_write_b32 a123, v227
    v_accvgpr_read_b32 v224, a124
    v_accvgpr_read_b32 v225, a125
    v_accvgpr_read_b32 v226, a126
    v_accvgpr_read_b32 v227, a127
    v_mul_f32 v224, v224, v55
    v_mul_f32 v225, v225, v55
    v_mul_f32 v226, v226, v55
    v_mul_f32 v227, v227, v55
    v_accvgpr_write_b32 a124, v224
    v_accvgpr_write_b32 a125, v225
    v_accvgpr_write_b32 a126, v226
    v_accvgpr_write_b32 a127, v227
    v_exp_f32 v232, v128
    v_exp_f32 v233, v129
    v_exp_f32 v234, v130
    v_exp_f32 v235, v131
    s_nop 0
    v_cvt_pk_bf16_f32 v192, v232, v233
    v_cvt_pk_bf16_f32 v193, v234, v235
    v_exp_f32 v232, v144
    v_exp_f32 v233, v145
    v_exp_f32 v234, v146
    v_exp_f32 v235, v147
    s_nop 0
    v_cvt_pk_bf16_f32 v194, v232, v233
    v_cvt_pk_bf16_f32 v195, v234, v235
    v_exp_f32 v232, v132
    v_exp_f32 v233, v133
    v_exp_f32 v234, v134
    v_exp_f32 v235, v135
    s_nop 0
    v_cvt_pk_bf16_f32 v196, v232, v233
    v_cvt_pk_bf16_f32 v197, v234, v235
    v_exp_f32 v232, v148
    v_exp_f32 v233, v149
    v_exp_f32 v234, v150
    v_exp_f32 v235, v151
    s_nop 0
    v_cvt_pk_bf16_f32 v198, v232, v233
    v_cvt_pk_bf16_f32 v199, v234, v235
    v_exp_f32 v232, v136
    v_exp_f32 v233, v137
    v_exp_f32 v234, v138
    v_exp_f32 v235, v139
    s_nop 0
    v_cvt_pk_bf16_f32 v200, v232, v233
    v_cvt_pk_bf16_f32 v201, v234, v235
    v_exp_f32 v232, v152
    v_exp_f32 v233, v153
    v_exp_f32 v234, v154
    v_exp_f32 v235, v155
    s_nop 0
    v_cvt_pk_bf16_f32 v202, v232, v233
    v_cvt_pk_bf16_f32 v203, v234, v235
    v_exp_f32 v232, v140
    v_exp_f32 v233, v141
    v_exp_f32 v234, v142
    v_exp_f32 v235, v143
    s_nop 0
    v_cvt_pk_bf16_f32 v204, v232, v233
    v_cvt_pk_bf16_f32 v205, v234, v235
    v_exp_f32 v232, v156
    v_exp_f32 v233, v157
    v_exp_f32 v234, v158
    v_exp_f32 v235, v159
    s_nop 0
    v_cvt_pk_bf16_f32 v206, v232, v233
    v_cvt_pk_bf16_f32 v207, v234, v235
    s_nop 1
    s_branch k2_ret_80
k2_rare_81:
    s_nop 7
    v_max_f32 v54, v160, v161
    v_max3_f32 v54, v54, v162, v163
    v_max3_f32 v54, v54, v176, v177
    v_max3_f32 v54, v54, v178, v179
    v_max3_f32 v54, v54, v168, v169
    v_max3_f32 v54, v54, v170, v171
    v_max3_f32 v54, v54, v184, v185
    v_max3_f32 v54, v54, v186, v187
    v_max_f32 v55, v164, v165
    v_max3_f32 v55, v55, v166, v167
    v_max3_f32 v55, v55, v180, v181
    v_max3_f32 v55, v55, v182, v183
    v_max3_f32 v55, v55, v172, v173
    v_max3_f32 v55, v55, v174, v175
    v_max3_f32 v55, v55, v188, v189
    v_max3_f32 v55, v55, v190, v191
    v_mov_b32 v226, v54
    v_mov_b32 v227, v55
    s_nop 1
    v_permlane16_swap_b32 v54, v226
    v_permlane16_swap_b32 v55, v227
    s_nop 1
    v_max_f32 v54, v54, v226
    v_max_f32 v55, v55, v227
    v_mov_b32 v226, v54
    v_mov_b32 v227, v55
    s_nop 1
    v_permlane32_swap_b32 v54, v226
    v_permlane32_swap_b32 v55, v227
    s_nop 1
    v_max_f32 v54, v54, v226
    v_max_f32 v55, v55, v227
    v_add_f32 v54, 0x41400000, v54
    v_max_f32 v54, 0, v54
    v_add_f32 v55, 0x41400000, v55
    v_max_f32 v55, 0, v55
    v_sub_f32 v160, v160, v54
    v_sub_f32 v161, v161, v54
    v_sub_f32 v162, v162, v54
    v_sub_f32 v163, v163, v54
    v_sub_f32 v164, v164, v55
    v_sub_f32 v165, v165, v55
    v_sub_f32 v166, v166, v55
    v_sub_f32 v167, v167, v55
    v_sub_f32 v168, v168, v54
    v_sub_f32 v169, v169, v54
    v_sub_f32 v170, v170, v54
    v_sub_f32 v171, v171, v54
    v_sub_f32 v172, v172, v55
    v_sub_f32 v173, v173, v55
    v_sub_f32 v174, v174, v55
    v_sub_f32 v175, v175, v55
    v_sub_f32 v176, v176, v54
    v_sub_f32 v177, v177, v54
    v_sub_f32 v178, v178, v54
    v_sub_f32 v179, v179, v54
    v_sub_f32 v180, v180, v55
    v_sub_f32 v181, v181, v55
    v_sub_f32 v182, v182, v55
    v_sub_f32 v183, v183, v55
    v_sub_f32 v184, v184, v54
    v_sub_f32 v185, v185, v54
    v_sub_f32 v186, v186, v54
    v_sub_f32 v187, v187, v54
    v_sub_f32 v188, v188, v55
    v_sub_f32 v189, v189, v55
    v_sub_f32 v190, v190, v55
    v_sub_f32 v191, v191, v55
    v_sub_f32 v10, v10, v54
    v_exp_f32 v54, -v54
    v_sub_f32 v11, v11, v55
    v_exp_f32 v55, -v55
    s_nop 0
    v_mul_f32 v248, v248, v54
    v_mul_f32 v252, v252, v55
    v_accvgpr_read_b32 v224, a8
    v_accvgpr_read_b32 v225, a9
    v_accvgpr_read_b32 v226, a10
    v_accvgpr_read_b32 v227, a11
    v_mul_f32 v224, v224, v54
    v_mul_f32 v225, v225, v54
    v_mul_f32 v226, v226, v54
    v_mul_f32 v227, v227, v54
    v_accvgpr_write_b32 a8, v224
    v_accvgpr_write_b32 a9, v225
    v_accvgpr_write_b32 a10, v226
    v_accvgpr_write_b32 a11, v227
    v_accvgpr_read_b32 v224, a12
    v_accvgpr_read_b32 v225, a13
    v_accvgpr_read_b32 v226, a14
    v_accvgpr_read_b32 v227, a15
    v_mul_f32 v224, v224, v55
    v_mul_f32 v225, v225, v55
    v_mul_f32 v226, v226, v55
    v_mul_f32 v227, v227, v55
    v_accvgpr_write_b32 a12, v224
    v_accvgpr_write_b32 a13, v225
    v_accvgpr_write_b32 a14, v226
    v_accvgpr_write_b32 a15, v227
    v_accvgpr_read_b32 v224, a24
    v_accvgpr_read_b32 v225, a25
    v_accvgpr_read_b32 v226, a26
    v_accvgpr_read_b32 v227, a27
    v_mul_f32 v224, v224, v54
    v_mul_f32 v225, v225, v54
    v_mul_f32 v226, v226, v54
    v_mul_f32 v227, v227, v54
    v_accvgpr_write_b32 a24, v224
    v_accvgpr_write_b32 a25, v225
    v_accvgpr_write_b32 a26, v226
    v_accvgpr_write_b32 a27, v227
    v_accvgpr_read_b32 v224, a28
    v_accvgpr_read_b32 v225, a29
    v_accvgpr_read_b32 v226, a30
    v_accvgpr_read_b32 v227, a31
    v_mul_f32 v224, v224, v55
    v_mul_f32 v225, v225, v55
    v_mul_f32 v226, v226, v55
    v_mul_f32 v227, v227, v55
    v_accvgpr_write_b32 a28, v224
    v_accvgpr_write_b32 a29, v225
    v_accvgpr_write_b32 a30, v226
    v_accvgpr_write_b32 a31, v227
    v_accvgpr_read_b32 v224, a40
    v_accvgpr_read_b32 v225, a41
    v_accvgpr_read_b32 v226, a42
    v_accvgpr_read_b32 v227, a43
    v_mul_f32 v224, v224, v54
    v_mul_f32 v225, v225, v54
    v_mul_f32 v226, v226, v54
    v_mul_f32 v227, v227, v54
    v_accvgpr_write_b32 a40, v224
    v_accvgpr_write_b32 a41, v225
    v_accvgpr_write_b32 a42, v226
    v_accvgpr_write_b32 a43, v227
    v_accvgpr_read_b32 v224, a44
    v_accvgpr_read_b32 v225, a45
    v_accvgpr_read_b32 v226, a46
    v_accvgpr_read_b32 v227, a47
    v_mul_f32 v224, v224, v55
    v_mul_f32 v225, v225, v55
    v_mul_f32 v226, v226, v55
    v_mul_f32 v227, v227, v55
    v_accvgpr_write_b32 a44, v224
    v_accvgpr_write_b32 a45, v225
    v_accvgpr_write_b32 a46, v226
    v_accvgpr_write_b32 a47, v227
    v_accvgpr_read_b32 v224, a56
    v_accvgpr_read_b32 v225, a57
    v_accvgpr_read_b32 v226, a58
    v_accvgpr_read_b32 v227, a59
    v_mul_f32 v224, v224, v54
    v_mul_f32 v225, v225, v54
    v_mul_f32 v226, v226, v54
    v_mul_f32 v227, v227, v54
    v_accvgpr_write_b32 a56, v224
    v_accvgpr_write_b32 a57, v225
    v_accvgpr_write_b32 a58, v226
    v_accvgpr_write_b32 a59, v227
    v_accvgpr_read_b32 v224, a60
    v_accvgpr_read_b32 v225, a61
    v_accvgpr_read_b32 v226, a62
    v_accvgpr_read_b32 v227, a63
    v_mul_f32 v224, v224, v55
    v_mul_f32 v225, v225, v55
    v_mul_f32 v226, v226, v55
    v_mul_f32 v227, v227, v55
    v_accvgpr_write_b32 a60, v224
    v_accvgpr_write_b32 a61, v225
    v_accvgpr_write_b32 a62, v226
    v_accvgpr_write_b32 a63, v227
    v_accvgpr_read_b32 v224, a72
    v_accvgpr_read_b32 v225, a73
    v_accvgpr_read_b32 v226, a74
    v_accvgpr_read_b32 v227, a75
    v_mul_f32 v224, v224, v54
    v_mul_f32 v225, v225, v54
    v_mul_f32 v226, v226, v54
    v_mul_f32 v227, v227, v54
    v_accvgpr_write_b32 a72, v224
    v_accvgpr_write_b32 a73, v225
    v_accvgpr_write_b32 a74, v226
    v_accvgpr_write_b32 a75, v227
    v_accvgpr_read_b32 v224, a76
    v_accvgpr_read_b32 v225, a77
    v_accvgpr_read_b32 v226, a78
    v_accvgpr_read_b32 v227, a79
    v_mul_f32 v224, v224, v55
    v_mul_f32 v225, v225, v55
    v_mul_f32 v226, v226, v55
    v_mul_f32 v227, v227, v55
    v_accvgpr_write_b32 a76, v224
    v_accvgpr_write_b32 a77, v225
    v_accvgpr_write_b32 a78, v226
    v_accvgpr_write_b32 a79, v227
    v_accvgpr_read_b32 v224, a88
    v_accvgpr_read_b32 v225, a89
    v_accvgpr_read_b32 v226, a90
    v_accvgpr_read_b32 v227, a91
    v_mul_f32 v224, v224, v54
    v_mul_f32 v225, v225, v54
    v_mul_f32 v226, v226, v54
    v_mul_f32 v227, v227, v54
    v_accvgpr_write_b32 a88, v224
    v_accvgpr_write_b32 a89, v225
    v_accvgpr_write_b32 a90, v226
    v_accvgpr_write_b32 a91, v227
    v_accvgpr_read_b32 v224, a92
    v_accvgpr_read_b32 v225, a93
    v_accvgpr_read_b32 v226, a94
    v_accvgpr_read_b32 v227, a95
    v_mul_f32 v224, v224, v55
    v_mul_f32 v225, v225, v55
    v_mul_f32 v226, v226, v55
    v_mul_f32 v227, v227, v55
    v_accvgpr_write_b32 a92, v224
    v_accvgpr_write_b32 a93, v225
    v_accvgpr_write_b32 a94, v226
    v_accvgpr_write_b32 a95, v227
    v_accvgpr_read_b32 v224, a104
    v_accvgpr_read_b32 v225, a105
    v_accvgpr_read_b32 v226, a106
    v_accvgpr_read_b32 v227, a107
    v_mul_f32 v224, v224, v54
    v_mul_f32 v225, v225, v54
    v_mul_f32 v226, v226, v54
    v_mul_f32 v227, v227, v54
    v_accvgpr_write_b32 a104, v224
    v_accvgpr_write_b32 a105, v225
    v_accvgpr_write_b32 a106, v226
    v_accvgpr_write_b32 a107, v227
    v_accvgpr_read_b32 v224, a108
    v_accvgpr_read_b32 v225, a109
    v_accvgpr_read_b32 v226, a110
    v_accvgpr_read_b32 v227, a111
    v_mul_f32 v224, v224, v55
    v_mul_f32 v225, v225, v55
    v_mul_f32 v226, v226, v55
    v_mul_f32 v227, v227, v55
    v_accvgpr_write_b32 a108, v224
    v_accvgpr_write_b32 a109, v225
    v_accvgpr_write_b32 a110, v226
    v_accvgpr_write_b32 a111, v227
    v_accvgpr_read_b32 v224, a120
    v_accvgpr_read_b32 v225, a121
    v_accvgpr_read_b32 v226, a122
    v_accvgpr_read_b32 v227, a123
    v_mul_f32 v224, v224, v54
    v_mul_f32 v225, v225, v54
    v_mul_f32 v226, v226, v54
    v_mul_f32 v227, v227, v54
    v_accvgpr_write_b32 a120, v224
    v_accvgpr_write_b32 a121, v225
    v_accvgpr_write_b32 a122, v226
    v_accvgpr_write_b32 a123, v227
    v_accvgpr_read_b32 v224, a124
    v_accvgpr_read_b32 v225, a125
    v_accvgpr_read_b32 v226, a126
    v_accvgpr_read_b32 v227, a127
    v_mul_f32 v224, v224, v55
    v_mul_f32 v225, v225, v55
    v_mul_f32 v226, v226, v55
    v_mul_f32 v227, v227, v55
    v_accvgpr_write_b32 a124, v224
    v_accvgpr_write_b32 a125, v225
    v_accvgpr_write_b32 a126, v226
    v_accvgpr_write_b32 a127, v227
    v_exp_f32 v232, v160
    v_exp_f32 v233, v161
    v_exp_f32 v234, v162
    v_exp_f32 v235, v163
    s_nop 0
    v_cvt_pk_bf16_f32 v208, v232, v233
    v_cvt_pk_bf16_f32 v209, v234, v235
    v_exp_f32 v232, v176
    v_exp_f32 v233, v177
    v_exp_f32 v234, v178
    v_exp_f32 v235, v179
    s_nop 0
    v_cvt_pk_bf16_f32 v210, v232, v233
    v_cvt_pk_bf16_f32 v211, v234, v235
    v_exp_f32 v232, v164
    v_exp_f32 v233, v165
    v_exp_f32 v234, v166
    v_exp_f32 v235, v167
    s_nop 0
    v_cvt_pk_bf16_f32 v212, v232, v233
    v_cvt_pk_bf16_f32 v213, v234, v235
    v_exp_f32 v232, v180
    v_exp_f32 v233, v181
    v_exp_f32 v234, v182
    v_exp_f32 v235, v183
    s_nop 0
    v_cvt_pk_bf16_f32 v214, v232, v233
    v_cvt_pk_bf16_f32 v215, v234, v235
    v_exp_f32 v232, v168
    v_exp_f32 v233, v169
    v_exp_f32 v234, v170
    v_exp_f32 v235, v171
    s_nop 0
    v_cvt_pk_bf16_f32 v216, v232, v233
    v_cvt_pk_bf16_f32 v217, v234, v235
    v_exp_f32 v232, v184
    v_exp_f32 v233, v185
    v_exp_f32 v234, v186
    v_exp_f32 v235, v187
    s_nop 0
    v_cvt_pk_bf16_f32 v218, v232, v233
    v_cvt_pk_bf16_f32 v219, v234, v235
    v_exp_f32 v232, v172
    v_exp_f32 v233, v173
    v_exp_f32 v234, v174
    v_exp_f32 v235, v175
    s_nop 0
    v_cvt_pk_bf16_f32 v220, v232, v233
    v_cvt_pk_bf16_f32 v221, v234, v235
    v_exp_f32 v232, v188
    v_exp_f32 v233, v189
    v_exp_f32 v234, v190
    v_exp_f32 v235, v191
    s_nop 0
    v_cvt_pk_bf16_f32 v222, v232, v233
    v_cvt_pk_bf16_f32 v223, v234, v235
    s_nop 1
    s_branch k2_ret_82
.globl k3_kernel
.p2align 8
.type k3_kernel,@function
k3_kernel:
    s_cmp_ge_u32 s2, 256
    s_cbranch_scc1 k3_end_84
    s_load_dwordx2 s[4:5], s[0:1], 40
    s_load_dwordx2 s[6:7], s[0:1], 104
    s_load_dwordx2 s[28:29], s[0:1], 0
    s_load_dwordx2 s[30:31], s[0:1], 56
    s_lshr_b32 s41, s2, 3
    s_bfe_u32 s44, s2, 0x10002
    s_and_b32 s42, s2, 1
    s_lshl_b32 s42, s42, 3
    s_and_b32 s43, s41, 7
    s_add_u32 s42, s42, s43
    s_and_b32 s43, s2, 2
    s_lshl_b32 s43, s43, 1
    s_lshr_b32 s40, s41, 3
    s_add_u32 s43, s43, s40
    v_lshrrev_b32 v10, 6, v0
    v_and_b32 v11, 63, v0
    v_readfirstlane_b32 s45, v10
    v_lshlrev_b32 v1, 4, v11
    s_lshl_b32 s46, s42, 7
    s_lshl_b32 s47, s45, 5
    s_add_u32 s46, s46, s47
    s_lshl_b32 s47, s46, 6
    v_add_u32 v12, s47, v1
    v_add_u32 v13, 0x20000, v12
    v_lshrrev_b32 v20, 4, v11
    v_bfe_u32 v21, v11, 1, 3
    v_xor_b32 v21, v21, v20
    v_and_b32 v22, 1, v11
    v_lshl_add_u32 v23, v10, 4, v20
    v_lshlrev_b32 v23, 11, v23
    v_lshl_add_u32 v23, v22, 4, v23
    s_lshl_b32 s47, s43, 8
    v_add_u32 v23, s47, v23
    v_xor_b32 v22, 0, v21
    v_lshl_add_u32 v22, v22, 5, v23
    v_add_u32 v16, 0, v22
    v_xor_b32 v22, 4, v21
    v_lshl_add_u32 v22, v22, 5, v23
    v_add_u32 v17, 7168, v22
    v_xor_b32 v22, 0, v21
    v_lshl_add_u32 v22, v22, 5, v23
    v_add_u32 v18, 14336, v22
    v_xor_b32 v22, 4, v21
    v_lshl_add_u32 v22, v22, 5, v23
    v_add_u32 v19, 21504, v22
    s_lshl_b32 s60, s45, 12
    s_lshl_b32 s61, s44, 22
    s_lshl_b32 s62, s44, 23
    s_waitcnt lgkmcnt(0)
    s_add_u32 s8, s6, 0x3000000
    s_addc_u32 s9, s7, 0
    s_and_b32 s9, s9, 0xffff
    s_mov_b32 s10, 0x1000000
    s_mov_b32 s11, 0x00020000
    s_mov_b32 s12, s4
    s_and_b32 s13, s5, 0xffff
    s_mov_b32 s14, 0x800000
    s_mov_b32 s15, 0x00020000
    s_add_u32 s10, s62, 0x800000
    s_add_u32 s14, s61, 0x400000
    s_add_u32 m0, s60, 0
    s_nop 0
    buffer_load_dwordx4 v16, s[12:15], s61 offen offset:0 lds
    buffer_load_dwordx4 v17, s[12:15], s61 offen offset:1024 lds
    buffer_load_dwordx4 v18, s[12:15], s61 offen offset:2048 lds
    buffer_load_dwordx4 v19, s[12:15], s61 offen offset:3072 lds
    s_add_u32 s61, s61, 0x20000
    buffer_load_dwordx4 a[128:131], v12, s[8:11], s62 offen offset:0
    buffer_load_dwordx4 a[132:135], v12, s[8:11], s62 offen offset:1024
    buffer_load_dwordx4 a[136:139], v13, s[8:11], s62 offen offset:0
    buffer_load_dwordx4 a[140:143], v13, s[8:11], s62 offen offset:1024
    s_add_u32 s62, s62, 0x40000
    s_add_u32 m0, s60, 16384
    s_nop 0
    buffer_load_dwordx4 v16, s[12:15], s61 offen offset:0 lds
    buffer_load_dwordx4 v17, s[12:15], s61 offen offset:1024 lds
    buffer_load_dwordx4 v18, s[12:15], s61 offen offset:2048 lds
    buffer_load_dwordx4 v19, s[12:15], s61 offen offset:3072 lds
    s_add_u32 s61, s61, 0x20000
    buffer_load_dwordx4 a[144:147], v12, s[8:11], s62 offen offset:0
    buffer_load_dwordx4 a[148:151], v12, s[8:11], s62 offen offset:1024
    buffer_load_dwordx4 a[152:155], v13, s[8:11], s62 offen offset:0
    buffer_load_dwordx4 a[156:159], v13, s[8:11], s62 offen offset:1024
    s_add_u32 s62, s62, 0x40000
    s_add_u32 m0, s60, 32768
    s_nop 0
    buffer_load_dwordx4 v16, s[12:15], s61 offen offset:0 lds
    buffer_load_dwordx4 v17, s[12:15], s61 offen offset:1024 lds
    buffer_load_dwordx4 v18, s[12:15], s61 offen offset:2048 lds
    buffer_load_dwordx4 v19, s[12:15], s61 offen offset:3072 lds
    s_add_u32 s61, s61, 0x20000
    buffer_load_dwordx4 a[160:163], v12, s[8:11], s62 offen offset:0
    buffer_load_dwordx4 a[164:167], v12, s[8:11], s62 offen offset:1024
    buffer_load_dwordx4 a[168:171], v13, s[8:11], s62 offen offset:0
    buffer_load_dwordx4 a[172:175], v13, s[8:11], s62 offen offset:1024
    s_add_u32 s62, s62, 0x40000
    s_mov_b32 s16, s28
    s_and_b32 s17, s29, 0xffff
    s_mov_b32 s18, 0x400000
    s_mov_b32 s19, 0x00020000
    s_mov_b32 s20, s30
    s_and_b32 s21, s31, 0xffff
    s_mov_b32 s22, 0x800
    s_mov_b32 s23, 0x00020000
    s_add_u32 s24, s6, 0x4000000
    s_addc_u32 s25, s7, 0
    s_and_b32 s25, s25, 0xffff
    s_mov_b32 s26, 0x400000
    s_mov_b32 s27, 0x00020000
    s_add_u32 s32, s6, 0x4800000
    s_addc_u32 s33, s7, 0
    s_and_b32 s33, s33, 0xffff
    s_mov_b32 s34, 0x6000
    s_mov_b32 s35, 0x00020000
    s_add_u32 s36, s6, 0x5000000
    s_addc_u32 s37, s7, 0
    s_and_b32 s37, s37, 0xffff
    s_mov_b32 s38, 0x800000
    s_mov_b32 s39, 0x00020000
    s_add_u32 s48, s6, 0x4807000
    s_addc_u32 s49, s7, 0
    s_and_b32 s49, s49, 0xffff
    s_mov_b32 s50, 0x8000
    s_mov_b32 s51, 0x00020000
    v_and_b32 v21, 15, v11
    v_add_u32 v22, s46, v21
    v_lshlrev_b32 v2, 2, v22
    v_lshl_add_u32 v2, v20, 13, v2
    v_lshlrev_b32 v22, 11, v22
    s_lshl_b32 s52, s44, 7
    s_add_u32 s47, s47, s52
    v_lshl_add_u32 v14, v20, 3, s47
    v_add_u32 v3, v22, v14
    v_add_u32 v4, 0x8000, v3
    s_lshl_b32 s52, s2, 14
    s_add_u32 s52, s52, s60
    s_xor_b32 s53, s52, 0x10000
    s_lshl_b32 s54, s2, 7
    s_xor_b32 s55, s54, 0x200
    v_mov_b32 v5, 0
    v_mov_b32 v6, 1
    v_lshrrev_b32 v22, 2, v21
    v_lshl_add_u32 v22, v20, 2, v22
    v_and_b32 v23, 7, v22
    s_lshl_b32 s56, s44, 2
    v_xor_b32 v23, s56, v23
    v_lshlrev_b32 v22, 8, v22
    v_and_b32 v32, 3, v11
    v_lshl_add_u32 v22, v32, 3, v22
    v_xor_b32 v32, 0, v23
    v_lshl_add_u32 v24, v32, 5, v22
    v_xor_b32 v32, 1, v23
    v_lshl_add_u32 v25, v32, 5, v22
    v_xor_b32 v32, 2, v23
    v_lshl_add_u32 v26, v32, 5, v22
    v_xor_b32 v32, 3, v23
    v_lshl_add_u32 v27, v32, 5, v22
    v_xor_b32 v32, 4, v23
    v_lshl_add_u32 v28, v32, 5, v22
    v_xor_b32 v32, 5, v23
    v_lshl_add_u32 v29, v32, 5, v22
    v_xor_b32 v32, 6, v23
    v_lshl_add_u32 v30, v32, 5, v22
    v_xor_b32 v32, 7, v23
    v_lshl_add_u32 v31, v32, 5, v22
    s_mov_b32 s57, (code_end-k3_tail)/128
    v_mov_b32 v56, 0
    v_mov_b32 v57, 0
    v_mov_b32 v58, 0
    v_mov_b32 v59, 0
    s_nop 1
    v_mfma_f32_32x32x16_bf16 v[64:79], v[56:59], v[56:59], 0
    v_mfma_f32_32x32x16_bf16 v[80:95], v[56:59], v[56:59], 0
    v_mfma_f32_32x32x16_bf16 v[96:111], v[56:59], v[56:59], 0
    v_mfma_f32_32x32x16_bf16 v[112:127], v[56:59], v[56:59], 0
    v_min_u32 v33, s57, v0
    s_getpc_b64 s[58:59]
pc_85:
    s_add_u32 s58, s58, k3_tail-pc_85
    s_addc_u32 s59, s59, 0
    v_lshlrev_b32 v8, 7, v33
    v_mov_b32 v9, s59
    v_add_co_u32 v8, vcc, s58, v8
    s_nop 1
    v_addc_co_u32 v9, vcc, 0, v9, vcc
    s_lshl_b32 s56, s41, 2
    s_add_u32 s56, s56, s45
    s_and_b32 s57, s2, 7
    v_lshrrev_b32 v34, 3, v11
    v_and_b32 v35, 7, v11
    v_min_u32 v35, 6, v35
    v_mul_u32_u24 v34, 7168, v34
    v_lshl_add_u32 v34, v35, 7, v34
    s_mul_i32 s58, s56, 57344
    s_mul_i32 s59, s57, 896
    s_add_u32 s58, s58, s59
    v_add_u32 v34, s58, v34
    v_min_u32 v35, 55, v11
    v_lshlrev_b32 v35, 7, v35
    s_mul_i32 s58, s56, 7168
    s_mul_i32 s59, s57, 917504
    s_add_u32 s58, s58, s59
    v_add_u32 v35, s58, v35
    s_waitcnt vmcnt(20)
    s_barrier
    ds_read_b64_tr_b16 a[0:1], v24 offset:0
    ds_read_b64_tr_b16 a[2:3], v24 offset:4096
    ds_read_b64_tr_b16 a[4:5], v25 offset:0
    ds_read_b64_tr_b16 a[6:7], v25 offset:4096
    ds_read_b64_tr_b16 a[8:9], v26 offset:0
    ds_read_b64_tr_b16 a[10:11], v26 offset:4096
    ds_read_b64_tr_b16 a[12:13], v27 offset:0
    ds_read_b64_tr_b16 a[14:15], v27 offset:4096
    ds_read_b64_tr_b16 a[16:17], v28 offset:0
    ds_read_b64_tr_b16 a[18:19], v28 offset:4096
    ds_read_b64_tr_b16 a[20:21], v29 offset:0
    ds_read_b64_tr_b16 a[22:23], v29 offset:4096
    ds_read_b64_tr_b16 a[24:25], v30 offset:0
    ds_read_b64_tr_b16 a[26:27], v30 offset:4096
    ds_read_b64_tr_b16 a[28:29], v31 offset:0
    ds_read_b64_tr_b16 a[30:31], v31 offset:4096
    ds_read_b64_tr_b16 a[32:33], v24 offset:8192
    ds_read_b64_tr_b16 a[34:35], v24 offset:12288
    ds_read_b64_tr_b16 a[36:37], v25 offset:8192
    ds_read_b64_tr_b16 a[38:39], v25 offset:12288
    ds_read_b64_tr_b16 a[40:41], v26 offset:8192
    ds_read_b64_tr_b16 a[42:43], v26 offset:12288
    ds_read_b64_tr_b16 a[44:45], v27 offset:8192
    ds_read_b64_tr_b16 a[46:47], v27 offset:12288
    ds_read_b64_tr_b16 a[48:49], v28 offset:8192
    ds_read_b64_tr_b16 a[50:51], v28 offset:12288
    ds_read_b64_tr_b16 a[52:53], v29 offset:8192
    ds_read_b64_tr_b16 a[54:55], v29 offset:12288
    ds_read_b64_tr_b16 a[56:57], v30 offset:8192
    ds_read_b64_tr_b16 a[58:59], v30 offset:12288
    ds_read_b64_tr_b16 a[60:61], v31 offset:8192
    ds_read_b64_tr_b16 a[62:63], v31 offset:12288
    s_mov_b32 s63, 0
    s_waitcnt vmcnt(12) lgkmcnt(0)
    s_barrier
k3_loop_86:
    v_mfma_f32_16x16x32_bf16 v[96:99], a[16:19], a[128:131], v[96:99]
    s_add_u32 m0, s60, 49152
    ds_read_b64_tr_b16 a[64:65], v24 offset:16384
    ds_read_b64_tr_b16 a[66:67], v24 offset:20480
    v_mfma_f32_16x16x32_bf16 v[100:103], a[16:19], a[132:135], v[100:103]
    buffer_load_dwordx4 v16, s[12:15], s61 offen offset:0 lds
    ds_read_b64_tr_b16 a[68:69], v25 offset:16384
    v_mfma_f32_16x16x32_bf16 v[104:107], a[20:23], a[128:131], v[104:107]
    ds_read_b64_tr_b16 a[70:71], v25 offset:20480
    ds_read_b64_tr_b16 a[72:73], v26 offset:16384
    v_mfma_f32_16x16x32_bf16 v[108:111], a[20:23], a[132:135], v[108:111]
    buffer_load_dwordx4 v17, s[12:15], s61 offen offset:1024 lds
    ds_read_b64_tr_b16 a[74:75], v26 offset:20480
    v_mfma_f32_16x16x32_bf16 v[112:115], a[24:27], a[128:131], v[112:115]
    ds_read_b64_tr_b16 a[76:77], v27 offset:16384
    ds_read_b64_tr_b16 a[78:79], v27 offset:20480
    v_mfma_f32_16x16x32_bf16 v[116:119], a[24:27], a[132:135], v[116:119]
    ds_read_b64_tr_b16 a[80:81], v28 offset:16384
    v_mfma_f32_16x16x32_bf16 v[120:123], a[28:31], a[128:131], v[120:123]
    ds_read_b64_tr_b16 a[82:83], v28 offset:20480
    v_mfma_f32_16x16x32_bf16 v[124:127], a[28:31], a[132:135], v[124:127]
    buffer_load_dwordx4 v18, s[12:15], s61 offen offset:2048 lds
    ds_read_b64_tr_b16 a[84:85], v29 offset:16384
    v_mfma_f32_16x16x32_bf16 v[64:67], a[0:3], a[128:131], v[64:67]
    ds_read_b64_tr_b16 a[86:87], v29 offset:20480
    ds_read_b64_tr_b16 a[88:89], v30 offset:16384
    v_mfma_f32_16x16x32_bf16 v[68:71], a[0:3], a[132:135], v[68:71]
    ds_read_b64_tr_b16 a[90:91], v30 offset:20480
    v_mfma_f32_16x16x32_bf16 v[72:75], a[4:7], a[128:131], v[72:75]
    buffer_load_dwordx4 v19, s[12:15], s61 offen offset:3072 lds
    ds_read_b64_tr_b16 a[92:93], v31 offset:16384
    v_mfma_f32_16x16x32_bf16 v[76:79], a[4:7], a[132:135], v[76:79]
    ds_read_b64_tr_b16 a[94:95], v31 offset:20480
    ds_read_b64_tr_b16 a[96:97], v24 offset:24576
    v_mfma_f32_16x16x32_bf16 v[80:83], a[8:11], a[128:131], v[80:83]
    ds_read_b64_tr_b16 a[98:99], v24 offset:28672
    v_mfma_f32_16x16x32_bf16 v[84:87], a[8:11], a[132:135], v[84:87]
    ds_read_b64_tr_b16 a[100:101], v25 offset:24576
    v_mfma_f32_16x16x32_bf16 v[88:91], a[12:15], a[128:131], v[88:91]
    buffer_load_dwordx4 a[176:179], v12, s[8:11], s62 offen offset:0
    ds_read_b64_tr_b16 a[102:103], v25 offset:28672
    v_mfma_f32_16x16x32_bf16 v[92:95], a[12:15], a[132:135], v[92:95]
    s_add_u32 s61, s61, 0x20000
    ds_read_b64_tr_b16 a[104:105], v26 offset:24576
    ds_read_b64_tr_b16 a[106:107], v26 offset:28672
    v_mfma_f32_16x16x32_bf16 v[96:99], a[48:51], a[136:139], v[96:99]
    ds_read_b64_tr_b16 a[108:109], v27 offset:24576
    v_mfma_f32_16x16x32_bf16 v[100:103], a[48:51], a[140:143], v[100:103]
    buffer_load_dwordx4 a[180:183], v12, s[8:11], s62 offen offset:1024
    ds_read_b64_tr_b16 a[110:111], v27 offset:28672
    v_mfma_f32_16x16x32_bf16 v[104:107], a[52:55], a[136:139], v[104:107]
    ds_read_b64_tr_b16 a[112:113], v28 offset:24576
    v_mfma_f32_16x16x32_bf16 v[108:111], a[52:55], a[140:143], v[108:111]
    ds_read_b64_tr_b16 a[114:115], v28 offset:28672
    ds_read_b64_tr_b16 a[116:117], v29 offset:24576
    v_mfma_f32_16x16x32_bf16 v[112:115], a[56:59], a[136:139], v[112:115]
    ds_read_b64_tr_b16 a[118:119], v29 offset:28672
    v_mfma_f32_16x16x32_bf16 v[116:119], a[56:59], a[140:143], v[116:119]
    buffer_load_dwordx4 a[184:187], v13, s[8:11], s62 offen offset:0
    ds_read_b64_tr_b16 a[120:121], v30 offset:24576
    v_mfma_f32_16x16x32_bf16 v[120:123], a[60:63], a[136:139], v[120:123]
    ds_read_b64_tr_b16 a[122:123], v30 offset:28672
    ds_read_b64_tr_b16 a[124:125], v31 offset:24576
    v_mfma_f32_16x16x32_bf16 v[124:127], a[60:63], a[140:143], v[124:127]
    ds_read_b64_tr_b16 a[126:127], v31 offset:28672
    v_mfma_f32_16x16x32_bf16 v[64:67], a[32:35], a[136:139], v[64:67]
    buffer_load_dwordx4 a[188:191], v13, s[8:11], s62 offen offset:1024
    v_mfma_f32_16x16x32_bf16 v[68:71], a[32:35], a[140:143], v[68:71]
    v_mfma_f32_16x16x32_bf16 v[72:75], a[36:39], a[136:139], v[72:75]
    v_mfma_f32_16x16x32_bf16 v[76:79], a[36:39], a[140:143], v[76:79]
    v_mfma_f32_16x16x32_bf16 v[80:83], a[40:43], a[136:139], v[80:83]
    s_cmp_eq_u32 s63, 7
    s_cbranch_scc1 k3_ool_87
k3_oolret_88:
    v_mfma_f32_16x16x32_bf16 v[84:87], a[40:43], a[140:143], v[84:87]
    s_add_u32 s62, s62, 0x40000
    v_mfma_f32_16x16x32_bf16 v[88:91], a[44:47], a[136:139], v[88:91]
    v_mfma_f32_16x16x32_bf16 v[92:95], a[44:47], a[140:143], v[92:95]
    s_waitcnt vmcnt(12) lgkmcnt(0)
    s_barrier
    v_mfma_f32_16x16x32_bf16 v[96:99], a[80:83], a[144:147], v[96:99]
    s_add_u32 m0, s60, 0
    ds_read_b64_tr_b16 a[0:1], v24 offset:32768
    ds_read_b64_tr_b16 a[2:3], v24 offset:36864
    v_mfma_f32_16x16x32_bf16 v[100:103], a[80:83], a[148:151], v[100:103]
    buffer_load_dwordx4 v16, s[12:15], s61 offen offset:0 lds
    ds_read_b64_tr_b16 a[4:5], v25 offset:32768
    v_mfma_f32_16x16x32_bf16 v[104:107], a[84:87], a[144:147], v[104:107]
    ds_read_b64_tr_b16 a[6:7], v25 offset:36864
    ds_read_b64_tr_b16 a[8:9], v26 offset:32768
    v_mfma_f32_16x16x32_bf16 v[108:111], a[84:87], a[148:151], v[108:111]
    buffer_load_dwordx4 v17, s[12:15], s61 offen offset:1024 lds
    ds_read_b64_tr_b16 a[10:11], v26 offset:36864
    v_mfma_f32_16x16x32_bf16 v[112:115], a[88:91], a[144:147], v[112:115]
    ds_read_b64_tr_b16 a[12:13], v27 offset:32768
    ds_read_b64_tr_b16 a[14:15], v27 offset:36864
    v_mfma_f32_16x16x32_bf16 v[116:119], a[88:91], a[148:151], v[116:119]
    ds_read_b64_tr_b16 a[16:17], v28 offset:32768
    v_mfma_f32_16x16x32_bf16 v[120:123], a[92:95], a[144:147], v[120:123]
    ds_read_b64_tr_b16 a[18:19], v28 offset:36864
    v_mfma_f32_16x16x32_bf16 v[124:127], a[92:95], a[148:151], v[124:127]
    buffer_load_dwordx4 v18, s[12:15], s61 offen offset:2048 lds
    ds_read_b64_tr_b16 a[20:21], v29 offset:32768
    v_mfma_f32_16x16x32_bf16 v[64:67], a[64:67], a[144:147], v[64:67]
    ds_read_b64_tr_b16 a[22:23], v29 offset:36864
    ds_read_b64_tr_b16 a[24:25], v30 offset:32768
    v_mfma_f32_16x16x32_bf16 v[68:71], a[64:67], a[148:151], v[68:71]
    ds_read_b64_tr_b16 a[26:27], v30 offset:36864
    v_mfma_f32_16x16x32_bf16 v[72:75], a[68:71], a[144:147], v[72:75]
    buffer_load_dwordx4 v19, s[12:15], s61 offen offset:3072 lds
    ds_read_b64_tr_b16 a[28:29], v31 offset:32768
    v_mfma_f32_16x16x32_bf16 v[76:79], a[68:71], a[148:151], v[76:79]
    ds_read_b64_tr_b16 a[30:31], v31 offset:36864
    ds_read_b64_tr_b16 a[32:33], v24 offset:40960
    v_mfma_f32_16x16x32_bf16 v[80:83], a[72:75], a[144:147], v[80:83]
    ds_read_b64_tr_b16 a[34:35], v24 offset:45056
    v_mfma_f32_16x16x32_bf16 v[84:87], a[72:75], a[148:151], v[84:87]
    ds_read_b64_tr_b16 a[36:37], v25 offset:40960
    v_mfma_f32_16x16x32_bf16 v[88:91], a[76:79], a[144:147], v[88:91]
    buffer_load_dwordx4 a[128:131], v12, s[8:11], s62 offen offset:0
    ds_read_b64_tr_b16 a[38:39], v25 offset:45056
    v_mfma_f32_16x16x32_bf16 v[92:95], a[76:79], a[148:151], v[92:95]
    s_add_u32 s61, s61, 0x20000
    ds_read_b64_tr_b16 a[40:41], v26 offset:40960
    ds_read_b64_tr_b16 a[42:43], v26 offset:45056
    v_mfma_f32_16x16x32_bf16 v[96:99], a[112:115], a[152:155], v[96:99]
    ds_read_b64_tr_b16 a[44:45], v27 offset:40960
    v_mfma_f32_16x16x32_bf16 v[100:103], a[112:115], a[156:159], v[100:103]
    buffer_load_dwordx4 a[132:135], v12, s[8:11], s62 offen offset:1024
    ds_read_b64_tr_b16 a[46:47], v27 offset:45056
    v_mfma_f32_16x16x32_bf16 v[104:107], a[116:119], a[152:155], v[104:107]
    ds_read_b64_tr_b16 a[48:49], v28 offset:40960
    v_mfma_f32_16x16x32_bf16 v[108:111], a[116:119], a[156:159], v[108:111]
    ds_read_b64_tr_b16 a[50:51], v28 offset:45056
    ds_read_b64_tr_b16 a[52:53], v29 offset:40960
    v_mfma_f32_16x16x32_bf16 v[112:115], a[120:123], a[152:155], v[112:115]
    ds_read_b64_tr_b16 a[54:55], v29 offset:45056
    v_mfma_f32_16x16x32_bf16 v[116:119], a[120:123], a[156:159], v[116:119]
    buffer_load_dwordx4 a[136:139], v13, s[8:11], s62 offen offset:0
    ds_read_b64_tr_b16 a[56:57], v30 offset:40960
    v_mfma_f32_16x16x32_bf16 v[120:123], a[124:127], a[152:155], v[120:123]
    ds_read_b64_tr_b16 a[58:59], v30 offset:45056
    ds_read_b64_tr_b16 a[60:61], v31 offset:40960
    v_mfma_f32_16x16x32_bf16 v[124:127], a[124:127], a[156:159], v[124:127]
    ds_read_b64_tr_b16 a[62:63], v31 offset:45056
    v_mfma_f32_16x16x32_bf16 v[64:67], a[96:99], a[152:155], v[64:67]
    buffer_load_dwordx4 a[140:143], v13, s[8:11], s62 offen offset:1024
    v_mfma_f32_16x16x32_bf16 v[68:71], a[96:99], a[156:159], v[68:71]
    v_mfma_f32_16x16x32_bf16 v[72:75], a[100:103], a[152:155], v[72:75]
    v_mfma_f32_16x16x32_bf16 v[76:79], a[100:103], a[156:159], v[76:79]
    v_mfma_f32_16x16x32_bf16 v[80:83], a[104:107], a[152:155], v[80:83]
    v_mfma_f32_16x16x32_bf16 v[84:87], a[104:107], a[156:159], v[84:87]
    s_add_u32 s62, s62, 0x40000
    v_mfma_f32_16x16x32_bf16 v[88:91], a[108:111], a[152:155], v[88:91]
    v_mfma_f32_16x16x32_bf16 v[92:95], a[108:111], a[156:159], v[92:95]
    s_waitcnt vmcnt(12) lgkmcnt(0)
    s_barrier
    v_mfma_f32_16x16x32_bf16 v[96:99], a[16:19], a[160:163], v[96:99]
    s_add_u32 m0, s60, 16384
    ds_read_b64_tr_b16 a[64:65], v24 offset:49152
    ds_read_b64_tr_b16 a[66:67], v24 offset:53248
    v_mfma_f32_16x16x32_bf16 v[100:103], a[16:19], a[164:167], v[100:103]
    buffer_load_dwordx4 v16, s[12:15], s61 offen offset:0 lds
    ds_read_b64_tr_b16 a[68:69], v25 offset:49152
    v_mfma_f32_16x16x32_bf16 v[104:107], a[20:23], a[160:163], v[104:107]
    ds_read_b64_tr_b16 a[70:71], v25 offset:53248
    ds_read_b64_tr_b16 a[72:73], v26 offset:49152
    v_mfma_f32_16x16x32_bf16 v[108:111], a[20:23], a[164:167], v[108:111]
    buffer_load_dwordx4 v17, s[12:15], s61 offen offset:1024 lds
    ds_read_b64_tr_b16 a[74:75], v26 offset:53248
    v_mfma_f32_16x16x32_bf16 v[112:115], a[24:27], a[160:163], v[112:115]
    ds_read_b64_tr_b16 a[76:77], v27 offset:49152
    ds_read_b64_tr_b16 a[78:79], v27 offset:53248
    v_mfma_f32_16x16x32_bf16 v[116:119], a[24:27], a[164:167], v[116:119]
    ds_read_b64_tr_b16 a[80:81], v28 offset:49152
    v_mfma_f32_16x16x32_bf16 v[120:123], a[28:31], a[160:163], v[120:123]
    ds_read_b64_tr_b16 a[82:83], v28 offset:53248
    v_mfma_f32_16x16x32_bf16 v[124:127], a[28:31], a[164:167], v[124:127]
    buffer_load_dwordx4 v18, s[12:15], s61 offen offset:2048 lds
    ds_read_b64_tr_b16 a[84:85], v29 offset:49152
    v_mfma_f32_16x16x32_bf16 v[64:67], a[0:3], a[160:163], v[64:67]
    ds_read_b64_tr_b16 a[86:87], v29 offset:53248
    ds_read_b64_tr_b16 a[88:89], v30 offset:49152
    v_mfma_f32_16x16x32_bf16 v[68:71], a[0:3], a[164:167], v[68:71]
    ds_read_b64_tr_b16 a[90:91], v30 offset:53248
    v_mfma_f32_16x16x32_bf16 v[72:75], a[4:7], a[160:163], v[72:75]
    buffer_load_dwordx4 v19, s[12:15], s61 offen offset:3072 lds
    ds_read_b64_tr_b16 a[92:93], v31 offset:49152
    v_mfma_f32_16x16x32_bf16 v[76:79], a[4:7], a[164:167], v[76:79]
    ds_read_b64_tr_b16 a[94:95], v31 offset:53248
    ds_read_b64_tr_b16 a[96:97], v24 offset:57344
    v_mfma_f32_16x16x32_bf16 v[80:83], a[8:11], a[160:163], v[80:83]
    ds_read_b64_tr_b16 a[98:99], v24 offset:61440
    v_mfma_f32_16x16x32_bf16 v[84:87], a[8:11], a[164:167], v[84:87]
    ds_read_b64_tr_b16 a[100:101], v25 offset:57344
    v_mfma_f32_16x16x32_bf16 v[88:91], a[12:15], a[160:163], v[88:91]
    buffer_load_dwordx4 a[144:147], v12, s[8:11], s62 offen offset:0
    ds_read_b64_tr_b16 a[102:103], v25 offset:61440
    v_mfma_f32_16x16x32_bf16 v[92:95], a[12:15], a[164:167], v[92:95]
    s_add_u32 s61, s61, 0x20000
    ds_read_b64_tr_b16 a[104:105], v26 offset:57344
    ds_read_b64_tr_b16 a[106:107], v26 offset:61440
    v_mfma_f32_16x16x32_bf16 v[96:99], a[48:51], a[168:171], v[96:99]
    ds_read_b64_tr_b16 a[108:109], v27 offset:57344
    v_mfma_f32_16x16x32_bf16 v[100:103], a[48:51], a[172:175], v[100:103]
    buffer_load_dwordx4 a[148:151], v12, s[8:11], s62 offen offset:1024
    ds_read_b64_tr_b16 a[110:111], v27 offset:61440
    v_mfma_f32_16x16x32_bf16 v[104:107], a[52:55], a[168:171], v[104:107]
    ds_read_b64_tr_b16 a[112:113], v28 offset:57344
    v_mfma_f32_16x16x32_bf16 v[108:111], a[52:55], a[172:175], v[108:111]
    ds_read_b64_tr_b16 a[114:115], v28 offset:61440
    ds_read_b64_tr_b16 a[116:117], v29 offset:57344
    v_mfma_f32_16x16x32_bf16 v[112:115], a[56:59], a[168:171], v[112:115]
    ds_read_b64_tr_b16 a[118:119], v29 offset:61440
    v_mfma_f32_16x16x32_bf16 v[116:119], a[56:59], a[172:175], v[116:119]
    buffer_load_dwordx4 a[152:155], v13, s[8:11], s62 offen offset:0
    ds_read_b64_tr_b16 a[120:121], v30 offset:57344
    v_mfma_f32_16x16x32_bf16 v[120:123], a[60:63], a[168:171], v[120:123]
    ds_read_b64_tr_b16 a[122:123], v30 offset:61440
    ds_read_b64_tr_b16 a[124:125], v31 offset:57344
    v_mfma_f32_16x16x32_bf16 v[124:127], a[60:63], a[172:175], v[124:127]
    ds_read_b64_tr_b16 a[126:127], v31 offset:61440
    v_mfma_f32_16x16x32_bf16 v[64:67], a[32:35], a[168:171], v[64:67]
    buffer_load_dwordx4 a[156:159], v13, s[8:11], s62 offen offset:1024
    v_mfma_f32_16x16x32_bf16 v[68:71], a[32:35], a[172:175], v[68:71]
    v_mfma_f32_16x16x32_bf16 v[72:75], a[36:39], a[168:171], v[72:75]
    v_mfma_f32_16x16x32_bf16 v[76:79], a[36:39], a[172:175], v[76:79]
    v_mfma_f32_16x16x32_bf16 v[80:83], a[40:43], a[168:171], v[80:83]
    v_mfma_f32_16x16x32_bf16 v[84:87], a[40:43], a[172:175], v[84:87]
    s_add_u32 s62, s62, 0x40000
    v_mfma_f32_16x16x32_bf16 v[88:91], a[44:47], a[168:171], v[88:91]
    v_mfma_f32_16x16x32_bf16 v[92:95], a[44:47], a[172:175], v[92:95]
    s_waitcnt vmcnt(12) lgkmcnt(0)
    s_barrier
    v_mfma_f32_16x16x32_bf16 v[96:99], a[80:83], a[176:179], v[96:99]
    s_add_u32 m0, s60, 32768
    ds_read_b64_tr_b16 a[0:1], v24 offset:0
    ds_read_b64_tr_b16 a[2:3], v24 offset:4096
    v_mfma_f32_16x16x32_bf16 v[100:103], a[80:83], a[180:183], v[100:103]
    buffer_load_dwordx4 v16, s[12:15], s61 offen offset:0 lds
    ds_read_b64_tr_b16 a[4:5], v25 offset:0
    v_mfma_f32_16x16x32_bf16 v[104:107], a[84:87], a[176:179], v[104:107]
    ds_read_b64_tr_b16 a[6:7], v25 offset:4096
    ds_read_b64_tr_b16 a[8:9], v26 offset:0
    v_mfma_f32_16x16x32_bf16 v[108:111], a[84:87], a[180:183], v[108:111]
    buffer_load_dwordx4 v17, s[12:15], s61 offen offset:1024 lds
    ds_read_b64_tr_b16 a[10:11], v26 offset:4096
    v_mfma_f32_16x16x32_bf16 v[112:115], a[88:91], a[176:179], v[112:115]
    ds_read_b64_tr_b16 a[12:13], v27 offset:0
    ds_read_b64_tr_b16 a[14:15], v27 offset:4096
    v_mfma_f32_16x16x32_bf16 v[116:119], a[88:91], a[180:183], v[116:119]
    ds_read_b64_tr_b16 a[16:17], v28 offset:0
    v_mfma_f32_16x16x32_bf16 v[120:123], a[92:95], a[176:179], v[120:123]
    ds_read_b64_tr_b16 a[18:19], v28 offset:4096
    v_mfma_f32_16x16x32_bf16 v[124:127], a[92:95], a[180:183], v[124:127]
    buffer_load_dwordx4 v18, s[12:15], s61 offen offset:2048 lds
    ds_read_b64_tr_b16 a[20:21], v29 offset:0
    v_mfma_f32_16x16x32_bf16 v[64:67], a[64:67], a[176:179], v[64:67]
    ds_read_b64_tr_b16 a[22:23], v29 offset:4096
    ds_read_b64_tr_b16 a[24:25], v30 offset:0
    v_mfma_f32_16x16x32_bf16 v[68:71], a[64:67], a[180:183], v[68:71]
    ds_read_b64_tr_b16 a[26:27], v30 offset:4096
    v_mfma_f32_16x16x32_bf16 v[72:75], a[68:71], a[176:179], v[72:75]
    buffer_load_dwordx4 v19, s[12:15], s61 offen offset:3072 lds
    ds_read_b64_tr_b16 a[28:29], v31 offset:0
    v_mfma_f32_16x16x32_bf16 v[76:79], a[68:71], a[180:183], v[76:79]
    ds_read_b64_tr_b16 a[30:31], v31 offset:4096
    ds_read_b64_tr_b16 a[32:33], v24 offset:8192
    v_mfma_f32_16x16x32_bf16 v[80:83], a[72:75], a[176:179], v[80:83]
    ds_read_b64_tr_b16 a[34:35], v24 offset:12288
    v_mfma_f32_16x16x32_bf16 v[84:87], a[72:75], a[180:183], v[84:87]
    ds_read_b64_tr_b16 a[36:37], v25 offset:8192
    v_mfma_f32_16x16x32_bf16 v[88:91], a[76:79], a[176:179], v[88:91]
    buffer_load_dwordx4 a[160:163], v12, s[8:11], s62 offen offset:0
    ds_read_b64_tr_b16 a[38:39], v25 offset:12288
    v_mfma_f32_16x16x32_bf16 v[92:95], a[76:79], a[180:183], v[92:95]
    s_add_u32 s61, s61, 0x20000
    ds_read_b64_tr_b16 a[40:41], v26 offset:8192
    ds_read_b64_tr_b16 a[42:43], v26 offset:12288
    v_mfma_f32_16x16x32_bf16 v[96:99], a[112:115], a[184:187], v[96:99]
    ds_read_b64_tr_b16 a[44:45], v27 offset:8192
    v_mfma_f32_16x16x32_bf16 v[100:103], a[112:115], a[188:191], v[100:103]
    buffer_load_dwordx4 a[164:167], v12, s[8:11], s62 offen offset:1024
    ds_read_b64_tr_b16 a[46:47], v27 offset:12288
    v_mfma_f32_16x16x32_bf16 v[104:107], a[116:119], a[184:187], v[104:107]
    ds_read_b64_tr_b16 a[48:49], v28 offset:8192
    v_mfma_f32_16x16x32_bf16 v[108:111], a[116:119], a[188:191], v[108:111]
    ds_read_b64_tr_b16 a[50:51], v28 offset:12288
    ds_read_b64_tr_b16 a[52:53], v29 offset:8192
    v_mfma_f32_16x16x32_bf16 v[112:115], a[120:123], a[184:187], v[112:115]
    ds_read_b64_tr_b16 a[54:55], v29 offset:12288
    v_mfma_f32_16x16x32_bf16 v[116:119], a[120:123], a[188:191], v[116:119]
    buffer_load_dwordx4 a[168:171], v13, s[8:11], s62 offen offset:0
    ds_read_b64_tr_b16 a[56:57], v30 offset:8192
    v_mfma_f32_16x16x32_bf16 v[120:123], a[124:127], a[184:187], v[120:123]
    ds_read_b64_tr_b16 a[58:59], v30 offset:12288
    ds_read_b64_tr_b16 a[60:61], v31 offset:8192
    v_mfma_f32_16x16x32_bf16 v[124:127], a[124:127], a[188:191], v[124:127]
    ds_read_b64_tr_b16 a[62:63], v31 offset:12288
    v_mfma_f32_16x16x32_bf16 v[64:67], a[96:99], a[184:187], v[64:67]
    buffer_load_dwordx4 a[172:175], v13, s[8:11], s62 offen offset:1024
    v_mfma_f32_16x16x32_bf16 v[68:71], a[96:99], a[188:191], v[68:71]
    v_mfma_f32_16x16x32_bf16 v[72:75], a[100:103], a[184:187], v[72:75]
    v_mfma_f32_16x16x32_bf16 v[76:79], a[100:103], a[188:191], v[76:79]
    v_mfma_f32_16x16x32_bf16 v[80:83], a[104:107], a[184:187], v[80:83]
    v_mfma_f32_16x16x32_bf16 v[84:87], a[104:107], a[188:191], v[84:87]
    s_add_u32 s62, s62, 0x40000
    v_mfma_f32_16x16x32_bf16 v[88:91], a[108:111], a[184:187], v[88:91]
    s_add_u32 s63, s63, 1
    v_mfma_f32_16x16x32_bf16 v[92:95], a[108:111], a[188:191], v[92:95]
    s_waitcnt vmcnt(12) lgkmcnt(0)
    s_barrier
    s_cmp_lt_u32 s63, 8
    s_cbranch_scc1 k3_loop_86
k3_tail:
    s_nop 1
    v_cvt_pk_bf16_f32 v96, v96, v97
    v_cvt_pk_bf16_f32 v97, v98, v99
    v_cvt_pk_bf16_f32 v98, v100, v101
    v_cvt_pk_bf16_f32 v99, v102, v103
    buffer_store_dwordx4 v[96:99], v1, s[36:39], s52 offen offset:0 sc1
    v_cvt_pk_bf16_f32 v104, v104, v105
    v_cvt_pk_bf16_f32 v105, v106, v107
    v_cvt_pk_bf16_f32 v106, v108, v109
    v_cvt_pk_bf16_f32 v107, v110, v111
    buffer_store_dwordx4 v[104:107], v1, s[36:39], s52 offen offset:1024 sc1
    v_cvt_pk_bf16_f32 v112, v112, v113
    v_cvt_pk_bf16_f32 v113, v114, v115
    v_cvt_pk_bf16_f32 v114, v116, v117
    v_cvt_pk_bf16_f32 v115, v118, v119
    buffer_store_dwordx4 v[112:115], v1, s[36:39], s52 offen offset:2048 sc1
    v_cvt_pk_bf16_f32 v120, v120, v121
    v_cvt_pk_bf16_f32 v121, v122, v123
    v_cvt_pk_bf16_f32 v122, v124, v125
    v_cvt_pk_bf16_f32 v123, v126, v127
    buffer_store_dwordx4 v[120:123], v1, s[36:39], s52 offen offset:3072 sc1
    s_waitcnt vmcnt(4)
    v_lshlrev_b32 v58, 16, v128
    v_and_b32 v59, 0xffff0000, v128
    v_pk_add_f32 v[64:65], v[64:65], v[58:59]
    v_lshlrev_b32 v58, 16, v129
    v_and_b32 v59, 0xffff0000, v129
    v_pk_add_f32 v[66:67], v[66:67], v[58:59]
    v_lshlrev_b32 v58, 16, v136
    v_and_b32 v59, 0xffff0000, v136
    v_pk_add_f32 v[68:69], v[68:69], v[58:59]
    v_lshlrev_b32 v58, 16, v137
    v_and_b32 v59, 0xffff0000, v137
    v_pk_add_f32 v[70:71], v[70:71], v[58:59]
    v_lshlrev_b32 v58, 16, v130
    v_and_b32 v59, 0xffff0000, v130
    v_pk_add_f32 v[72:73], v[72:73], v[58:59]
    v_lshlrev_b32 v58, 16, v131
    v_and_b32 v59, 0xffff0000, v131
    v_pk_add_f32 v[74:75], v[74:75], v[58:59]
    v_lshlrev_b32 v58, 16, v138
    v_and_b32 v59, 0xffff0000, v138
    v_pk_add_f32 v[76:77], v[76:77], v[58:59]
    v_lshlrev_b32 v58, 16, v139
    v_and_b32 v59, 0xffff0000, v139
    v_pk_add_f32 v[78:79], v[78:79], v[58:59]
    v_lshlrev_b32 v58, 16, v132
    v_and_b32 v59, 0xffff0000, v132
    v_pk_add_f32 v[80:81], v[80:81], v[58:59]
    v_lshlrev_b32 v58, 16, v133
    v_and_b32 v59, 0xffff0000, v133
    v_pk_add_f32 v[82:83], v[82:83], v[58:59]
    v_lshlrev_b32 v58, 16, v140
    v_and_b32 v59, 0xffff0000, v140
    v_pk_add_f32 v[84:85], v[84:85], v[58:59]
    v_lshlrev_b32 v58, 16, v141
    v_and_b32 v59, 0xffff0000, v141
    v_pk_add_f32 v[86:87], v[86:87], v[58:59]
    v_lshlrev_b32 v58, 16, v134
    v_and_b32 v59, 0xffff0000, v134
    v_pk_add_f32 v[88:89], v[88:89], v[58:59]
    v_lshlrev_b32 v58, 16, v135
    v_and_b32 v59, 0xffff0000, v135
    v_pk_add_f32 v[90:91], v[90:91], v[58:59]
    v_lshlrev_b32 v58, 16, v142
    v_and_b32 v59, 0xffff0000, v142
    v_pk_add_f32 v[92:93], v[92:93], v[58:59]
    v_lshlrev_b32 v58, 16, v143
    v_and_b32 v59, 0xffff0000, v143
    v_pk_add_f32 v[94:95], v[94:95], v[58:59]
    v_and_b32 v58, 1, v20
    v_lshrrev_b32 v59, 1, v20
    v_lshlrev_b32 v58, 5, v58
    v_lshl_add_u32 v58, v59, 4, v58
    v_lshlrev_b32 v59, 3, v20
    v_sub_u32 v58, v58, v59
    v_add_u32 v3, v3, v58
    v_add_u32 v4, v4, v58
    v_lshlrev_b32 v32, 16, v144
    v_and_b32 v33, 0xffff0000, v144
    v_lshlrev_b32 v34, 16, v145
    v_and_b32 v35, 0xffff0000, v145
    v_lshlrev_b32 v36, 16, v146
    v_and_b32 v37, 0xffff0000, v146
    v_lshlrev_b32 v38, 16, v147
    v_and_b32 v39, 0xffff0000, v147
    v_lshlrev_b32 v40, 16, v148
    v_and_b32 v41, 0xffff0000, v148
    v_lshlrev_b32 v42, 16, v149
    v_and_b32 v43, 0xffff0000, v149
    v_lshlrev_b32 v44, 16, v150
    v_and_b32 v45, 0xffff0000, v150
    v_lshlrev_b32 v46, 16, v151
    v_and_b32 v47, 0xffff0000, v151
    s_or_b32 s57, s42, s45
    s_cbranch_scc1 k3_nowr_89
    v_pk_add_f32 v[56:57], v[32:33], v[34:35]
    v_pk_add_f32 v[56:57], v[56:57], v[36:37]
    v_pk_add_f32 v[56:57], v[56:57], v[38:39]
    v_pk_add_f32 v[56:57], v[56:57], v[40:41]
    v_pk_add_f32 v[56:57], v[56:57], v[42:43]
    v_pk_add_f32 v[56:57], v[56:57], v[44:45]
    v_pk_add_f32 v[56:57], v[56:57], v[46:47]
    v_add_f32 v56, v56, v57
    v_mov_b32 v57, v56
    s_nop 1
    v_permlane16_swap_b32 v56, v57
    s_nop 1
    v_add_f32 v56, v56, v57
    v_mov_b32 v57, v56
    s_nop 1
    v_permlane32_swap_b32 v56, v57
    s_nop 1
    v_add_f32 v56, v56, v57
    s_mov_b32 s57, 24704
    s_mov_b32 s34, 24708
    s_mov_b64 exec, 1
    buffer_atomic_add_f32 v56, v5, s[32:35], s57 offen
    s_mov_b64 exec, -1
    s_mov_b32 s34, 24576
k3_nowr_89:
    v_mov_b32 v144, 0
    v_mov_b32 v145, 0
    v_mov_b32 v146, 0
    v_mov_b32 v147, 0
    v_mov_b32 v148, 0
    v_mov_b32 v149, 0
    v_mov_b32 v150, 0
    v_mov_b32 v151, 0
    v_mov_b32 v152, 0
    v_mov_b32 v153, 0
    v_mov_b32 v154, 0
    v_mov_b32 v155, 0
    s_waitcnt vmcnt(0)
    s_barrier
    s_cmp_lg_u32 s45, 0
    s_cbranch_scc1 k3_nopoll_90
    s_mov_b64 exec, 1
    buffer_store_dword v6, v5, s[48:51], s54 offen sc1
    s_mov_b64 exec, -1
    s_mov_b32 s57, 1048576
k3_spin_91:
    buffer_load_dword v7, v5, s[48:51], s55 offen sc1
    s_waitcnt vmcnt(0)
    v_readfirstlane_b32 s58, v7
    s_sub_u32 s57, s57, 1
    s_cselect_b32 s58, 1, s58
    s_cmp_eq_u32 s58, 0
    s_cbranch_scc1 k3_spin_91
k3_nopoll_90:
    s_barrier
    buffer_load_dwordx4 v[96:99], v1, s[36:39], s53 offen offset:0 sc1
    buffer_load_dwordx4 v[100:103], v1, s[36:39], s53 offen offset:1024 sc1
    buffer_load_dwordx4 v[104:107], v1, s[36:39], s53 offen offset:2048 sc1
    buffer_load_dwordx4 v[108:111], v1, s[36:39], s53 offen offset:3072 sc1
    s_waitcnt vmcnt(3)
    v_lshlrev_b32 v56, 16, v96
    v_and_b32 v57, 0xffff0000, v96
    v_lshlrev_b32 v58, 16, v97
    v_and_b32 v59, 0xffff0000, v97
    v_pk_add_f32 v[64:65], v[64:65], v[56:57]
    v_pk_add_f32 v[66:67], v[66:67], v[58:59]
    v_cvt_pk_bf16_f32 v128, v64, v65
    v_cvt_pk_bf16_f32 v129, v66, v67
    v_lshlrev_b32 v64, 16, v128
    v_and_b32 v65, 0xffff0000, v128
    v_lshlrev_b32 v66, 16, v129
    v_and_b32 v67, 0xffff0000, v129
    v_pk_add_f32 v[144:145], v[144:145], v[64:65]
    v_pk_fma_f32 v[146:147], v[64:65], v[64:65], v[146:147]
    v_pk_fma_f32 v[148:149], v[64:65], v[32:33], v[148:149]
    v_pk_add_f32 v[144:145], v[144:145], v[66:67]
    v_pk_fma_f32 v[146:147], v[66:67], v[66:67], v[146:147]
    v_pk_fma_f32 v[148:149], v[66:67], v[34:35], v[148:149]
    v_lshlrev_b32 v56, 16, v98
    v_and_b32 v57, 0xffff0000, v98
    v_lshlrev_b32 v58, 16, v99
    v_and_b32 v59, 0xffff0000, v99
    v_pk_add_f32 v[68:69], v[68:69], v[56:57]
    v_pk_add_f32 v[70:71], v[70:71], v[58:59]
    v_cvt_pk_bf16_f32 v136, v68, v69
    v_cvt_pk_bf16_f32 v137, v70, v71
    v_lshlrev_b32 v68, 16, v136
    v_and_b32 v69, 0xffff0000, v136
    v_lshlrev_b32 v70, 16, v137
    v_and_b32 v71, 0xffff0000, v137
    v_pk_add_f32 v[150:151], v[150:151], v[68:69]
    v_pk_fma_f32 v[152:153], v[68:69], v[68:69], v[152:153]
    v_pk_fma_f32 v[154:155], v[68:69], v[32:33], v[154:155]
    v_pk_add_f32 v[150:151], v[150:151], v[70:71]
    v_pk_fma_f32 v[152:153], v[70:71], v[70:71], v[152:153]
    v_pk_fma_f32 v[154:155], v[70:71], v[34:35], v[154:155]
    s_waitcnt vmcnt(2)
    v_lshlrev_b32 v56, 16, v100
    v_and_b32 v57, 0xffff0000, v100
    v_lshlrev_b32 v58, 16, v101
    v_and_b32 v59, 0xffff0000, v101
    v_pk_add_f32 v[72:73], v[72:73], v[56:57]
    v_pk_add_f32 v[74:75], v[74:75], v[58:59]
    v_cvt_pk_bf16_f32 v130, v72, v73
    v_cvt_pk_bf16_f32 v131, v74, v75
    v_lshlrev_b32 v72, 16, v130
    v_and_b32 v73, 0xffff0000, v130
    v_lshlrev_b32 v74, 16, v131
    v_and_b32 v75, 0xffff0000, v131
    v_permlane16_swap_b32 v128, v130
    v_permlane16_swap_b32 v129, v131
    buffer_store_dwordx4 v[128:131], v3, s[24:27], 0 offen offset:0 sc1
    v_pk_add_f32 v[144:145], v[144:145], v[72:73]
    v_pk_fma_f32 v[146:147], v[72:73], v[72:73], v[146:147]
    v_pk_fma_f32 v[148:149], v[72:73], v[36:37], v[148:149]
    v_pk_add_f32 v[144:145], v[144:145], v[74:75]
    v_pk_fma_f32 v[146:147], v[74:75], v[74:75], v[146:147]
    v_pk_fma_f32 v[148:149], v[74:75], v[38:39], v[148:149]
    v_lshlrev_b32 v56, 16, v102
    v_and_b32 v57, 0xffff0000, v102
    v_lshlrev_b32 v58, 16, v103
    v_and_b32 v59, 0xffff0000, v103
    v_pk_add_f32 v[76:77], v[76:77], v[56:57]
    v_pk_add_f32 v[78:79], v[78:79], v[58:59]
    v_cvt_pk_bf16_f32 v138, v76, v77
    v_cvt_pk_bf16_f32 v139, v78, v79
    v_lshlrev_b32 v76, 16, v138
    v_and_b32 v77, 0xffff0000, v138
    v_lshlrev_b32 v78, 16, v139
    v_and_b32 v79, 0xffff0000, v139
    v_permlane16_swap_b32 v136, v138
    v_permlane16_swap_b32 v137, v139
    buffer_store_dwordx4 v[136:139], v4, s[24:27], 0 offen offset:0 sc1
    v_pk_add_f32 v[150:151], v[150:151], v[76:77]
    v_pk_fma_f32 v[152:153], v[76:77], v[76:77], v[152:153]
    v_pk_fma_f32 v[154:155], v[76:77], v[36:37], v[154:155]
    v_pk_add_f32 v[150:151], v[150:151], v[78:79]
    v_pk_fma_f32 v[152:153], v[78:79], v[78:79], v[152:153]
    v_pk_fma_f32 v[154:155], v[78:79], v[38:39], v[154:155]
    s_waitcnt vmcnt(3)
    v_lshlrev_b32 v56, 16, v104
    v_and_b32 v57, 0xffff0000, v104
    v_lshlrev_b32 v58, 16, v105
    v_and_b32 v59, 0xffff0000, v105
    v_pk_add_f32 v[80:81], v[80:81], v[56:57]
    v_pk_add_f32 v[82:83], v[82:83], v[58:59]
    v_cvt_pk_bf16_f32 v132, v80, v81
    v_cvt_pk_bf16_f32 v133, v82, v83
    v_lshlrev_b32 v80, 16, v132
    v_and_b32 v81, 0xffff0000, v132
    v_lshlrev_b32 v82, 16, v133
    v_and_b32 v83, 0xffff0000, v133
    v_pk_add_f32 v[144:145], v[144:145], v[80:81]
    v_pk_fma_f32 v[146:147], v[80:81], v[80:81], v[146:147]
    v_pk_fma_f32 v[148:149], v[80:81], v[40:41], v[148:149]
    v_pk_add_f32 v[144:145], v[144:145], v[82:83]
    v_pk_fma_f32 v[146:147], v[82:83], v[82:83], v[146:147]
    v_pk_fma_f32 v[148:149], v[82:83], v[42:43], v[148:149]
    v_lshlrev_b32 v56, 16, v106
    v_and_b32 v57, 0xffff0000, v106
    v_lshlrev_b32 v58, 16, v107
    v_and_b32 v59, 0xffff0000, v107
    v_pk_add_f32 v[84:85], v[84:85], v[56:57]
    v_pk_add_f32 v[86:87], v[86:87], v[58:59]
    v_cvt_pk_bf16_f32 v140, v84, v85
    v_cvt_pk_bf16_f32 v141, v86, v87
    v_lshlrev_b32 v84, 16, v140
    v_and_b32 v85, 0xffff0000, v140
    v_lshlrev_b32 v86, 16, v141
    v_and_b32 v87, 0xffff0000, v141
    v_pk_add_f32 v[150:151], v[150:151], v[84:85]
    v_pk_fma_f32 v[152:153], v[84:85], v[84:85], v[152:153]
    v_pk_fma_f32 v[154:155], v[84:85], v[40:41], v[154:155]
    v_pk_add_f32 v[150:151], v[150:151], v[86:87]
    v_pk_fma_f32 v[152:153], v[86:87], v[86:87], v[152:153]
    v_pk_fma_f32 v[154:155], v[86:87], v[42:43], v[154:155]
    s_waitcnt vmcnt(2)
    v_lshlrev_b32 v56, 16, v108
    v_and_b32 v57, 0xffff0000, v108
    v_lshlrev_b32 v58, 16, v109
    v_and_b32 v59, 0xffff0000, v109
    v_pk_add_f32 v[88:89], v[88:89], v[56:57]
    v_pk_add_f32 v[90:91], v[90:91], v[58:59]
    v_cvt_pk_bf16_f32 v134, v88, v89
    v_cvt_pk_bf16_f32 v135, v90, v91
    v_lshlrev_b32 v88, 16, v134
    v_and_b32 v89, 0xffff0000, v134
    v_lshlrev_b32 v90, 16, v135
    v_and_b32 v91, 0xffff0000, v135
    v_permlane16_swap_b32 v132, v134
    v_permlane16_swap_b32 v133, v135
    buffer_store_dwordx4 v[132:135], v3, s[24:27], 0 offen offset:64 sc1
    v_pk_add_f32 v[144:145], v[144:145], v[88:89]
    v_pk_fma_f32 v[146:147], v[88:89], v[88:89], v[146:147]
    v_pk_fma_f32 v[148:149], v[88:89], v[44:45], v[148:149]
    v_pk_add_f32 v[144:145], v[144:145], v[90:91]
    v_pk_fma_f32 v[146:147], v[90:91], v[90:91], v[146:147]
    v_pk_fma_f32 v[148:149], v[90:91], v[46:47], v[148:149]
    v_lshlrev_b32 v56, 16, v110
    v_and_b32 v57, 0xffff0000, v110
    v_lshlrev_b32 v58, 16, v111
    v_and_b32 v59, 0xffff0000, v111
    v_pk_add_f32 v[92:93], v[92:93], v[56:57]
    v_pk_add_f32 v[94:95], v[94:95], v[58:59]
    v_cvt_pk_bf16_f32 v142, v92, v93
    v_cvt_pk_bf16_f32 v143, v94, v95
    v_lshlrev_b32 v92, 16, v142
    v_and_b32 v93, 0xffff0000, v142
    v_lshlrev_b32 v94, 16, v143
    v_and_b32 v95, 0xffff0000, v143
    v_permlane16_swap_b32 v140, v142
    v_permlane16_swap_b32 v141, v143
    buffer_store_dwordx4 v[140:143], v4, s[24:27], 0 offen offset:64 sc1
    v_pk_add_f32 v[150:151], v[150:151], v[92:93]
    v_pk_fma_f32 v[152:153], v[92:93], v[92:93], v[152:153]
    v_pk_fma_f32 v[154:155], v[92:93], v[44:45], v[154:155]
    v_pk_add_f32 v[150:151], v[150:151], v[94:95]
    v_pk_fma_f32 v[152:153], v[94:95], v[94:95], v[152:153]
    v_pk_fma_f32 v[154:155], v[94:95], v[46:47], v[154:155]
    v_add_f32 v48, v144, v145
    v_add_f32 v49, v146, v147
    v_add_f32 v50, v148, v149
    v_add_f32 v52, v150, v151
    v_add_f32 v53, v152, v153
    v_add_f32 v54, v154, v155
    v_mov_b32 v56, v48
    v_mov_b32 v57, v49
    v_mov_b32 v58, v50
    v_mov_b32 v59, v52
    v_mov_b32 v60, v53
    v_mov_b32 v61, v54
    s_nop 1
    v_permlane16_swap_b32 v48, v56
    v_permlane16_swap_b32 v49, v57
    v_permlane16_swap_b32 v50, v58
    v_permlane16_swap_b32 v52, v59
    v_permlane16_swap_b32 v53, v60
    v_permlane16_swap_b32 v54, v61
    s_nop 1
    v_add_f32 v48, v48, v56
    v_add_f32 v49, v49, v57
    v_add_f32 v50, v50, v58
    v_add_f32 v52, v52, v59
    v_add_f32 v53, v53, v60
    v_add_f32 v54, v54, v61
    v_mov_b32 v56, v48
    v_mov_b32 v57, v49
    v_mov_b32 v58, v50
    v_mov_b32 v59, v52
    v_mov_b32 v60, v53
    v_mov_b32 v61, v54
    s_nop 1
    v_permlane32_swap_b32 v48, v56
    v_permlane32_swap_b32 v49, v57
    v_permlane32_swap_b32 v50, v58
    v_permlane32_swap_b32 v52, v59
    v_permlane32_swap_b32 v53, v60
    v_permlane32_swap_b32 v54, v61
    s_nop 1
    v_add_f32 v48, v48, v56
    v_add_f32 v49, v49, v57
    v_add_f32 v50, v50, v58
    v_add_f32 v52, v52, v59
    v_add_f32 v53, v53, v60
    v_add_f32 v54, v54, v61
    v_cmp_eq_u32 s[56:57], 1, v20
    v_cmp_eq_u32 s[58:59], 2, v20
    s_nop 1
    v_cndmask_b32 v48, v48, v49, s[56:57]
    v_cndmask_b32 v48, v48, v50, s[58:59]
    buffer_atomic_add_f32 v48, v2, s[32:35], 0 offen offset:0
    v_cndmask_b32 v52, v52, v53, s[56:57]
    v_cndmask_b32 v52, v52, v54, s[58:59]
    buffer_atomic_add_f32 v52, v2, s[32:35], 0 offen offset:64
k3_end_84:
    s_endpgm
k3_ool_87:
    buffer_load_dwordx2 v[128:129], v3, s[16:19], 0 offen offset:0
    buffer_load_dwordx2 v[130:131], v3, s[16:19], 0 offen offset:32
    buffer_load_dwordx2 v[132:133], v3, s[16:19], 0 offen offset:64
    buffer_load_dwordx2 v[134:135], v3, s[16:19], 0 offen offset:96
    buffer_load_dwordx2 v[136:137], v4, s[16:19], 0 offen offset:0
    buffer_load_dwordx2 v[138:139], v4, s[16:19], 0 offen offset:32
    buffer_load_dwordx2 v[140:141], v4, s[16:19], 0 offen offset:64
    buffer_load_dwordx2 v[142:143], v4, s[16:19], 0 offen offset:96
    buffer_load_dwordx2 v[144:145], v14, s[20:23], 0 offen offset:0
    buffer_load_dwordx2 v[146:147], v14, s[20:23], 0 offen offset:32
    buffer_load_dwordx2 v[148:149], v14, s[20:23], 0 offen offset:64
    buffer_load_dwordx2 v[150:151], v14, s[20:23], 0 offen offset:96
    global_load_dword v7, v[8:9], off
    s_branch k3_oolret_88
.globl k4_kernel
.p2align 8
.type k4_kernel,@function
k4_kernel:
    s_cmp_ge_u32 s2, 256
    s_cbranch_scc1 k4_end_92
    s_load_dwordx8 s[4:11], s[0:1], 56
    s_load_dwordx2 s[12:13], s[0:1], 88
    s_load_dwordx2 s[14:15], s[0:1], 104
    v_lshrrev_b32 v1, 6, v0
    v_and_b32 v2, 63, v0
    v_readfirstlane_b32 s44, v1
    s_and_b32 s45, s2, 7
    s_lshr_b32 s46, s2, 3
    s_mul_i32 s45, s45, 28
    s_add_u32 s45, s45, s46
    v_and_b32 v4, 31, v2
    v_lshrrev_b32 v5, 5, v2
    v_lshlrev_b32 v7, 4, v4
    v_mov_b32 v11, 69632
    v_lshl_add_u32 v12, v2, 2, v11
    v_mov_b32 v13, 0
    ds_write_b32 v12, v13
    s_waitcnt lgkmcnt(0)
    s_barrier
    s_add_u32 s20, s14, 0x4000000
    s_addc_u32 s21, s15, 0
    s_and_b32 s21, s21, 0xffff
    s_mov_b32 s22, 0x400000
    s_mov_b32 s23, 0x00020000
    s_cmp_ge_u32 s44, 4
    s_cbranch_scc1 k4_b_93
    s_setprio 3
    s_add_u32 s16, s14, 0x4800000
    s_addc_u32 s17, s15, 0
    s_and_b32 s17, s17, 0xffff
    s_mov_b32 s18, 0x6084
    s_mov_b32 s19, 0x00020000
    v_lshlrev_b32 v3, 5, v0
    s_mov_b32 s48, 0
    buffer_load_dwordx4 v[16:19], v3, s[16:19], s48 offen
    buffer_load_dwordx4 v[20:23], v3, s[16:19], s48 offen offset:16
    s_mov_b32 s48, 8192
    buffer_load_dwordx4 v[24:27], v3, s[16:19], s48 offen
    buffer_load_dwordx4 v[28:31], v3, s[16:19], s48 offen offset:16
    s_mov_b32 s48, 16384
    buffer_load_dwordx4 v[32:35], v3, s[16:19], s48 offen
    buffer_load_dwordx4 v[36:39], v3, s[16:19], s48 offen offset:16
    s_mov_b32 s48, 24704
    buffer_load_dword v10, v13, s[16:19], s48 offen
    s_mov_b32 s32, s10
    s_and_b32 s33, s11, 0xffff
    s_mov_b32 s34, 0x700000
    s_mov_b32 s35, 0x00020000
    s_cmp_ge_u32 s2, 224
    s_cselect_b32 s34, 0, s34
    s_mov_b32 s52, 0x3a800000
    s_mov_b32 s53, 0x3a800000
    s_mov_b32 s54, 0x7ff
    v_mov_b32 v14, 0x3727c5ac
    v_mov_b32 v15, v14
    v_mov_b32 v8, 0xff800000
    v_mov_b32 v9, v8
    s_waitcnt vmcnt(0)
    v_sub_f32 v10, 0, v10
    v_mov_b32 v11, v10
    v_pk_mul_f32 v[16:17], v[16:17], s[52:53]
    v_pk_fma_f32 v[24:25], v[24:25], s[52:53], v[14:15]
    v_pk_fma_f32 v[32:33], v[16:17], v[10:11], v[32:33]
    v_pk_fma_f32 v[24:25], v[16:17], v[16:17], v[24:25] neg_lo:[1,0,0] neg_hi:[1,0,0]
    v_pk_mul_f32 v[18:19], v[18:19], s[52:53]
    v_pk_fma_f32 v[26:27], v[26:27], s[52:53], v[14:15]
    v_pk_fma_f32 v[34:35], v[18:19], v[10:11], v[34:35]
    v_pk_fma_f32 v[26:27], v[18:19], v[18:19], v[26:27] neg_lo:[1,0,0] neg_hi:[1,0,0]
    v_pk_mul_f32 v[20:21], v[20:21], s[52:53]
    v_pk_fma_f32 v[28:29], v[28:29], s[52:53], v[14:15]
    v_pk_fma_f32 v[36:37], v[20:21], v[10:11], v[36:37]
    v_pk_fma_f32 v[28:29], v[20:21], v[20:21], v[28:29] neg_lo:[1,0,0] neg_hi:[1,0,0]
    v_pk_mul_f32 v[22:23], v[22:23], s[52:53]
    v_pk_fma_f32 v[30:31], v[30:31], s[52:53], v[14:15]
    v_pk_fma_f32 v[38:39], v[22:23], v[10:11], v[38:39]
    v_pk_fma_f32 v[30:31], v[22:23], v[22:23], v[30:31] neg_lo:[1,0,0] neg_hi:[1,0,0]
    v_max_f32 v24, v14, v24
    v_max_f32 v25, v14, v25
    v_max_f32 v26, v14, v26
    v_max_f32 v27, v14, v27
    v_max_f32 v28, v14, v28
    v_max_f32 v29, v14, v29
    v_max_f32 v30, v14, v30
    v_max_f32 v31, v14, v31
    v_rsq_f32 v24, v24
    v_rsq_f32 v25, v25
    v_rsq_f32 v26, v26
    v_rsq_f32 v27, v27
    v_rsq_f32 v28, v28
    v_rsq_f32 v29, v29
    v_rsq_f32 v30, v30
    v_rsq_f32 v31, v31
    v_pk_mul_f32 v[32:33], v[32:33], v[24:25]
    v_pk_mul_f32 v[34:35], v[34:35], v[26:27]
    v_pk_mul_f32 v[36:37], v[36:37], v[28:29]
    v_pk_mul_f32 v[38:39], v[38:39], v[30:31]
    v_bfi_b32 v32, s54, 0, v32
    v_med3_f32 v9, v8, v9, v32
    v_max_f32 v8, v8, v32
    v_bfi_b32 v33, s54, 1, v33
    v_med3_f32 v9, v8, v9, v33
    v_max_f32 v8, v8, v33
    v_bfi_b32 v34, s54, 2, v34
    v_med3_f32 v9, v8, v9, v34
    v_max_f32 v8, v8, v34
    v_bfi_b32 v35, s54, 3, v35
    v_med3_f32 v9, v8, v9, v35
    v_max_f32 v8, v8, v35
    v_bfi_b32 v36, s54, 4, v36
    v_med3_f32 v9, v8, v9, v36
    v_max_f32 v8, v8, v36
    v_bfi_b32 v37, s54, 5, v37
    v_med3_f32 v9, v8, v9, v37
    v_max_f32 v8, v8, v37
    v_bfi_b32 v38, s54, 6, v38
    v_med3_f32 v9, v8, v9, v38
    v_max_f32 v8, v8, v38
    v_bfi_b32 v39, s54, 7, v39
    v_med3_f32 v9, v8, v9, v39
    v_max_f32 v8, v8, v39
    v_lshl_or_b32 v8, v0, 3, v8
    v_lshl_or_b32 v9, v0, 3, v9
    s_nop 1
    v_mov_b32_dpp v10, v8 quad_perm:[1,0,3,2] row_mask:0xf bank_mask:0xf
    v_mov_b32_dpp v11, v9 quad_perm:[1,0,3,2] row_mask:0xf bank_mask:0xf
    v_max_f32 v11, v11, v9
    v_med3_f32 v9, v8, v10, v11
    v_max_f32 v8, v8, v10
    s_nop 1
    v_mov_b32_dpp v10, v8 quad_perm:[2,3,0,1] row_mask:0xf bank_mask:0xf
    v_mov_b32_dpp v11, v9 quad_perm:[2,3,0,1] row_mask:0xf bank_mask:0xf
    v_max_f32 v11, v11, v9
    v_med3_f32 v9, v8, v10, v11
    v_max_f32 v8, v8, v10
    s_nop 1
    v_mov_b32_dpp v10, v8 row_half_mirror row_mask:0xf bank_mask:0xf
    v_mov_b32_dpp v11, v9 row_half_mirror row_mask:0xf bank_mask:0xf
    v_max_f32 v11, v11, v9
    v_med3_f32 v9, v8, v10, v11
    v_max_f32 v8, v8, v10
    s_nop 1
    v_mov_b32_dpp v10, v8 row_mirror row_mask:0xf bank_mask:0xf
    v_mov_b32_dpp v11, v9 row_mirror row_mask:0xf bank_mask:0xf
    v_max_f32 v11, v11, v9
    v_med3_f32 v9, v8, v10, v11
    v_max_f32 v8, v8, v10
    v_mov_b32 v10, v8
    v_mov_b32 v11, v9
    s_nop 1
    v_permlane16_swap_b32 v8, v10
    v_permlane16_swap_b32 v9, v11
    s_nop 1
    v_max_f32 v11, v11, v9
    v_med3_f32 v9, v8, v10, v11
    v_max_f32 v8, v8, v10
    v_mov_b32 v10, v8
    v_mov_b32 v11, v9
    s_nop 1
    v_permlane32_swap_b32 v8, v10
    v_permlane32_swap_b32 v9, v11
    s_nop 1
    v_max_f32 v11, v11, v9
    v_med3_f32 v9, v8, v10, v11
    v_max_f32 v8, v8, v10
    v_mov_b32 v10, 1
    v_mov_b32 v11, 1
    v_lshlrev_b32 v12, 4, v1
    v_add_u32 v12, 69632, v12
    ds_write_b128 v12, v[8:11]
    v_mov_b32 v12, 69632
k4_mail_97:
    ds_read_b128 v[16:19], v12 offset:0
    ds_read_b128 v[20:23], v12 offset:16
    ds_read_b128 v[24:27], v12 offset:32
    ds_read_b128 v[28:31], v12 offset:48
    s_waitcnt lgkmcnt(0)
    v_and_b32 v10, v18, v22
    v_and_b32 v11, v26, v30
    v_and_b32 v10, v10, v11
    v_cmp_eq_u32 vcc, 0, v10
    s_cbranch_vccnz k4_mail_97
    v_max_f32 v21, v21, v17
    v_med3_f32 v17, v16, v20, v21
    v_max_f32 v16, v16, v20
    v_max_f32 v29, v29, v25
    v_med3_f32 v25, v24, v28, v29
    v_max_f32 v24, v24, v28
    v_max_f32 v25, v25, v17
    v_med3_f32 v17, v16, v24, v25
    v_max_f32 v16, v16, v24
    v_cmp_eq_u32 vcc, 0, v5
    s_lshl_b32 s52, s45, 15
    v_lshlrev_b32 v9, 3, v0
    v_cndmask_b32 v11, v17, v16, vcc
    v_and_b32 v15, 0x7ff, v11
    v_lshl_add_u32 v11, v15, 11, v7
    buffer_load_dwordx4 v[40:43], v11, s[20:23], 0 offen offset:0
    buffer_load_dwordx4 v[44:47], v11, s[20:23], 0 offen offset:512
    buffer_load_dwordx4 v[48:51], v11, s[20:23], 0 offen offset:1024
    buffer_load_dwordx4 v[52:55], v11, s[20:23], 0 offen offset:1536
    buffer_load_dwordx2 v[88:89], v9, s[32:35], s52 offen offset:0
    buffer_load_dwordx2 v[90:91], v9, s[32:35], s52 offen offset:2048
    s_add_u32 s52, s52, 4096
    buffer_load_dwordx2 v[92:93], v9, s[32:35], s52 offen offset:0
    buffer_load_dwordx2 v[94:95], v9, s[32:35], s52 offen offset:2048
    s_add_u32 s52, s52, 4096
    buffer_load_dwordx2 v[96:97], v9, s[32:35], s52 offen offset:0
    buffer_load_dwordx2 v[98:99], v9, s[32:35], s52 offen offset:2048
    s_add_u32 s52, s52, 4096
    buffer_load_dwordx2 v[100:101], v9, s[32:35], s52 offen offset:0
    buffer_load_dwordx2 v[102:103], v9, s[32:35], s52 offen offset:2048
    s_add_u32 s52, s52, 4096
    buffer_load_dwordx2 v[104:105], v9, s[32:35], s52 offen offset:0
    buffer_load_dwordx2 v[106:107], v9, s[32:35], s52 offen offset:2048
    s_add_u32 s52, s52, 4096
    buffer_load_dwordx2 v[108:109], v9, s[32:35], s52 offen offset:0
    buffer_load_dwordx2 v[110:111], v9, s[32:35], s52 offen offset:2048
    s_add_u32 s52, s52, 4096
    buffer_load_dwordx2 v[112:113], v9, s[32:35], s52 offen offset:0
    buffer_load_dwordx2 v[114:115], v9, s[32:35], s52 offen offset:2048
    s_add_u32 s52, s52, 4096
    buffer_load_dwordx2 v[116:117], v9, s[32:35], s52 offen offset:0
    buffer_load_dwordx2 v[118:119], v9, s[32:35], s52 offen offset:2048
    s_add_u32 s52, s52, 4096
    s_waitcnt vmcnt(16)
k4_ln_94:
    v_lshlrev_b32 v200, 16, v40
    v_and_b32 v201, 0xffff0000, v40
    v_lshlrev_b32 v202, 16, v41
    v_and_b32 v203, 0xffff0000, v41
    v_lshlrev_b32 v204, 16, v42
    v_and_b32 v205, 0xffff0000, v42
    v_lshlrev_b32 v206, 16, v43
    v_and_b32 v207, 0xffff0000, v43
    v_lshlrev_b32 v208, 16, v44
    v_and_b32 v209, 0xffff0000, v44
    v_lshlrev_b32 v210, 16, v45
    v_and_b32 v211, 0xffff0000, v45
    v_lshlrev_b32 v212, 16, v46
    v_and_b32 v213, 0xffff0000, v46
    v_lshlrev_b32 v214, 16, v47
    v_and_b32 v215, 0xffff0000, v47
    v_lshlrev_b32 v216, 16, v48
    v_and_b32 v217, 0xffff0000, v48
    v_lshlrev_b32 v218, 16, v49
    v_and_b32 v219, 0xffff0000, v49
    v_lshlrev_b32 v220, 16, v50
    v_and_b32 v221, 0xffff0000, v50
    v_lshlrev_b32 v222, 16, v51
    v_and_b32 v223, 0xffff0000, v51
    v_lshlrev_b32 v224, 16, v52
    v_and_b32 v225, 0xffff0000, v52
    v_lshlrev_b32 v226, 16, v53
    v_and_b32 v227, 0xffff0000, v53
    v_lshlrev_b32 v228, 16, v54
    v_and_b32 v229, 0xffff0000, v54
    v_lshlrev_b32 v230, 16, v55
    v_and_b32 v231, 0xffff0000, v55
    v_pk_add_f32 v[192:193], v[200:201], v[202:203]
    v_pk_add_f32 v[194:195], v[204:205], v[206:207]
    v_pk_add_f32 v[192:193], v[192:193], v[208:209]
    v_pk_add_f32 v[194:195], v[194:195], v[210:211]
    v_pk_add_f32 v[192:193], v[192:193], v[212:213]
    v_pk_add_f32 v[194:195], v[194:195], v[214:215]
    v_pk_add_f32 v[192:193], v[192:193], v[216:217]
    v_pk_add_f32 v[194:195], v[194:195], v[218:219]
    v_pk_add_f32 v[192:193], v[192:193], v[220:221]
    v_pk_add_f32 v[194:195], v[194:195], v[222:223]
    v_pk_add_f32 v[192:193], v[192:193], v[224:225]
    v_pk_add_f32 v[194:195], v[194:195], v[226:227]
    v_pk_add_f32 v[192:193], v[192:193], v[228:229]
    v_pk_add_f32 v[194:195], v[194:195], v[230:231]
    v_pk_add_f32 v[192:193], v[192:193], v[194:195]
    v_add_f32 v192, v192, v193
    s_nop 1
    v_add_f32_dpp v192, v192, v192 quad_perm:[1,0,3,2] row_mask:0xf bank_mask:0xf
    s_nop 1
    v_add_f32_dpp v192, v192, v192 quad_perm:[2,3,0,1] row_mask:0xf bank_mask:0xf
    s_nop 1
    v_add_f32_dpp v192, v192, v192 row_half_mirror row_mask:0xf bank_mask:0xf
    s_nop 1
    v_add_f32_dpp v192, v192, v192 row_mirror row_mask:0xf bank_mask:0xf
    v_mov_b32 v194, v192
    s_nop 1
    v_permlane16_swap_b32 v192, v194
    s_nop 1
    v_add_f32 v192, v192, v194
    v_mul_f32 v192, 0xba800000, v192
    v_mov_b32 v193, v192
    v_pk_add_f32 v[194:195], v[200:201], v[192:193]
    v_pk_add_f32 v[198:199], v[202:203], v[192:193]
    v_pk_mul_f32 v[196:197], v[194:195], v[194:195]
    v_pk_fma_f32 v[196:197], v[198:199], v[198:199], v[196:197]
    v_pk_add_f32 v[194:195], v[204:205], v[192:193]
    v_pk_add_f32 v[198:199], v[206:207], v[192:193]
    v_pk_fma_f32 v[196:197], v[194:195], v[194:195], v[196:197]
    v_pk_fma_f32 v[196:197], v[198:199], v[198:199], v[196:197]
    v_pk_add_f32 v[194:195], v[208:209], v[192:193]
    v_pk_add_f32 v[198:199], v[210:211], v[192:193]
    v_pk_fma_f32 v[196:197], v[194:195], v[194:195], v[196:197]
    v_pk_fma_f32 v[196:197], v[198:199], v[198:199], v[196:197]
    v_pk_add_f32 v[194:195], v[212:213], v[192:193]
    v_pk_add_f32 v[198:199], v[214:215], v[192:193]
    v_pk_fma_f32 v[196:197], v[194:195], v[194:195], v[196:197]
    v_pk_fma_f32 v[196:197], v[198:199], v[198:199], v[196:197]
    v_pk_add_f32 v[194:195], v[216:217], v[192:193]
    v_pk_add_f32 v[198:199], v[218:219], v[192:193]
    v_pk_fma_f32 v[196:197], v[194:195], v[194:195], v[196:197]
    v_pk_fma_f32 v[196:197], v[198:199], v[198:199], v[196:197]
    v_pk_add_f32 v[194:195], v[220:221], v[192:193]
    v_pk_add_f32 v[198:199], v[222:223], v[192:193]
    v_pk_fma_f32 v[196:197], v[194:195], v[194:195], v[196:197]
    v_pk_fma_f32 v[196:197], v[198:199], v[198:199], v[196:197]
    v_pk_add_f32 v[194:195], v[224:225], v[192:193]
    v_pk_add_f32 v[198:199], v[226:227], v[192:193]
    v_pk_fma_f32 v[196:197], v[194:195], v[194:195], v[196:197]
    v_pk_fma_f32 v[196:197], v[198:199], v[198:199], v[196:197]
    v_pk_add_f32 v[194:195], v[228:229], v[192:193]
    v_pk_add_f32 v[198:199], v[230:231], v[192:193]
    v_pk_fma_f32 v[196:197], v[194:195], v[194:195], v[196:197]
    v_pk_fma_f32 v[196:197], v[198:199], v[198:199], v[196:197]
    v_add_f32 v196, v196, v197
    s_nop 1
    v_add_f32_dpp v196, v196, v196 quad_perm:[1,0,3,2] row_mask:0xf bank_mask:0xf
    s_nop 1
    v_add_f32_dpp v196, v196, v196 quad_perm:[2,3,0,1] row_mask:0xf bank_mask:0xf
    s_nop 1
    v_add_f32_dpp v196, v196, v196 row_half_mirror row_mask:0xf bank_mask:0xf
    s_nop 1
    v_add_f32_dpp v196, v196, v196 row_mirror row_mask:0xf bank_mask:0xf
    v_mov_b32 v194, v196
    s_nop 1
    v_permlane16_swap_b32 v196, v194
    s_nop 1
    v_add_f32 v196, v196, v194
    v_mul_f32 v196, 0x3a800000, v196
    v_cvt_pk_bf16_f32 v198, v192, v196
    v_and_b32 v196, 0xffff0000, v198
    v_lshlrev_b32 v198, 16, v198
    v_add_f32 v196, 0x3727c5ac, v196
    v_mov_b32 v199, v198
    v_cvt_pk_bf16_f32 v196, v196, v196
    v_and_b32 v196, 0xffff0000, v196
    v_sqrt_f32 v196, v196
    v_pk_add_f32 v[160:161], v[200:201], v[198:199]
    v_pk_add_f32 v[162:163], v[202:203], v[198:199]
    v_pk_add_f32 v[164:165], v[204:205], v[198:199]
    v_pk_add_f32 v[166:167], v[206:207], v[198:199]
    v_pk_add_f32 v[168:169], v[208:209], v[198:199]
    v_pk_add_f32 v[170:171], v[210:211], v[198:199]
    v_pk_add_f32 v[172:173], v[212:213], v[198:199]
    v_pk_add_f32 v[174:175], v[214:215], v[198:199]
    v_pk_add_f32 v[176:177], v[216:217], v[198:199]
    v_pk_add_f32 v[178:179], v[218:219], v[198:199]
    v_pk_add_f32 v[180:181], v[220:221], v[198:199]
    v_pk_add_f32 v[182:183], v[222:223], v[198:199]
    v_pk_add_f32 v[184:185], v[224:225], v[198:199]
    v_pk_add_f32 v[186:187], v[226:227], v[198:199]
    v_pk_add_f32 v[188:189], v[228:229], v[198:199]
    v_pk_add_f32 v[190:191], v[230:231], v[198:199]
    v_cvt_pk_bf16_f32 v196, v196, v196
    v_and_b32 v196, 0xffff0000, v196
    v_rcp_f32 v196, v196
    v_cvt_pk_bf16_f32 v40, v160, v161
    v_cvt_pk_bf16_f32 v41, v162, v163
    v_cvt_pk_bf16_f32 v42, v164, v165
    v_cvt_pk_bf16_f32 v43, v166, v167
    v_cvt_pk_bf16_f32 v44, v168, v169
    v_cvt_pk_bf16_f32 v45, v170, v171
    v_cvt_pk_bf16_f32 v46, v172, v173
    v_cvt_pk_bf16_f32 v47, v174, v175
    v_cvt_pk_bf16_f32 v48, v176, v177
    v_cvt_pk_bf16_f32 v49, v178, v179
    v_cvt_pk_bf16_f32 v50, v180, v181
    v_cvt_pk_bf16_f32 v51, v182, v183
    v_cvt_pk_bf16_f32 v52, v184, v185
    v_cvt_pk_bf16_f32 v53, v186, v187
    v_cvt_pk_bf16_f32 v54, v188, v189
    v_cvt_pk_bf16_f32 v55, v190, v191
    v_mov_b32 v197, v196
    v_lshlrev_b32 v160, 16, v40
    v_and_b32 v161, 0xffff0000, v40
    v_lshlrev_b32 v162, 16, v41
    v_and_b32 v163, 0xffff0000, v41
    v_lshlrev_b32 v164, 16, v42
    v_and_b32 v165, 0xffff0000, v42
    v_lshlrev_b32 v166, 16, v43
    v_and_b32 v167, 0xffff0000, v43
    v_lshlrev_b32 v168, 16, v44
    v_and_b32 v169, 0xffff0000, v44
    v_lshlrev_b32 v170, 16, v45
    v_and_b32 v171, 0xffff0000, v45
    v_lshlrev_b32 v172, 16, v46
    v_and_b32 v173, 0xffff0000, v46
    v_lshlrev_b32 v174, 16, v47
    v_and_b32 v175, 0xffff0000, v47
    v_lshlrev_b32 v176, 16, v48
    v_and_b32 v177, 0xffff0000, v48
    v_lshlrev_b32 v178, 16, v49
    v_and_b32 v179, 0xffff0000, v49
    v_lshlrev_b32 v180, 16, v50
    v_and_b32 v181, 0xffff0000, v50
    v_lshlrev_b32 v182, 16, v51
    v_and_b32 v183, 0xffff0000, v51
    v_lshlrev_b32 v184, 16, v52
    v_and_b32 v185, 0xffff0000, v52
    v_lshlrev_b32 v186, 16, v53
    v_and_b32 v187, 0xffff0000, v53
    v_lshlrev_b32 v188, 16, v54
    v_and_b32 v189, 0xffff0000, v54
    v_lshlrev_b32 v190, 16, v55
    v_and_b32 v191, 0xffff0000, v55
    v_pk_mul_f32 v[160:161], v[160:161], v[196:197]
    v_pk_mul_f32 v[162:163], v[162:163], v[196:197]
    v_pk_mul_f32 v[164:165], v[164:165], v[196:197]
    v_pk_mul_f32 v[166:167], v[166:167], v[196:197]
    v_pk_mul_f32 v[168:169], v[168:169], v[196:197]
    v_pk_mul_f32 v[170:171], v[170:171], v[196:197]
    v_pk_mul_f32 v[172:173], v[172:173], v[196:197]
    v_pk_mul_f32 v[174:175], v[174:175], v[196:197]
    v_pk_mul_f32 v[176:177], v[176:177], v[196:197]
    v_pk_mul_f32 v[178:179], v[178:179], v[196:197]
    v_pk_mul_f32 v[180:181], v[180:181], v[196:197]
    v_pk_mul_f32 v[182:183], v[182:183], v[196:197]
    v_pk_mul_f32 v[184:185], v[184:185], v[196:197]
    v_pk_mul_f32 v[186:187], v[186:187], v[196:197]
    v_pk_mul_f32 v[188:189], v[188:189], v[196:197]
    v_pk_mul_f32 v[190:191], v[190:191], v[196:197]
    v_cvt_pk_bf16_f32 v40, v160, v161
    v_cvt_pk_bf16_f32 v41, v162, v163
    v_cvt_pk_bf16_f32 v42, v164, v165
    v_cvt_pk_bf16_f32 v43, v166, v167
    v_cvt_pk_bf16_f32 v44, v168, v169
    v_cvt_pk_bf16_f32 v45, v170, v171
    v_cvt_pk_bf16_f32 v46, v172, v173
    v_cvt_pk_bf16_f32 v47, v174, v175
    v_cvt_pk_bf16_f32 v48, v176, v177
    v_cvt_pk_bf16_f32 v49, v178, v179
    v_cvt_pk_bf16_f32 v50, v180, v181
    v_cvt_pk_bf16_f32 v51, v182, v183
    v_cvt_pk_bf16_f32 v52, v184, v185
    v_cvt_pk_bf16_f32 v53, v186, v187
    v_cvt_pk_bf16_f32 v54, v188, v189
    v_cvt_pk_bf16_f32 v55, v190, v191
    s_cmp_ge_u32 s44, 4
    s_cbranch_scc1 k4_bout_96
    v_lshl_add_u32 v11, v5, 11, v7
    v_add_u32 v12, 65536, v11
    ds_write_b128 v12, v[40:43] offset:0
    ds_write_b128 v12, v[44:47] offset:512
    ds_write_b128 v12, v[48:51] offset:1024
    ds_write_b128 v12, v[52:55] offset:1536
    v_lshlrev_b32 v12, 2, v5
    v_add_u32 v12, 69760, v12
    ds_write_b32 v12, v15
    s_mov_b32 s54, 0x05040100
    s_mov_b32 s55, 0x07060302
    s_waitcnt vmcnt(0)
    v_perm_b32 v56, v90, v88, s54
    v_perm_b32 v57, v90, v88, s55
    v_perm_b32 v58, v91, v89, s54
    v_perm_b32 v59, v91, v89, s55
    v_perm_b32 v60, v94, v92, s54
    v_perm_b32 v61, v94, v92, s55
    v_perm_b32 v62, v95, v93, s54
    v_perm_b32 v63, v95, v93, s55
    v_perm_b32 v64, v98, v96, s54
    v_perm_b32 v65, v98, v96, s55
    v_perm_b32 v66, v99, v97, s54
    v_perm_b32 v67, v99, v97, s55
    v_perm_b32 v68, v102, v100, s54
    v_perm_b32 v69, v102, v100, s55
    v_perm_b32 v70, v103, v101, s54
    v_perm_b32 v71, v103, v101, s55
    v_perm_b32 v72, v106, v104, s54
    v_perm_b32 v73, v106, v104, s55
    v_perm_b32 v74, v107, v105, s54
    v_perm_b32 v75, v107, v105, s55
    v_perm_b32 v76, v110, v108, s54
    v_perm_b32 v77, v110, v108, s55
    v_perm_b32 v78, v111, v109, s54
    v_perm_b32 v79, v111, v109, s55
    v_perm_b32 v80, v114, v112, s54
    v_perm_b32 v81, v114, v112, s55
    v_perm_b32 v82, v115, v113, s54
    v_perm_b32 v83, v115, v113, s55
    v_perm_b32 v84, v118, v116, s54
    v_perm_b32 v85, v118, v116, s55
    v_perm_b32 v86, v119, v117, s54
    v_perm_b32 v87, v119, v117, s55
    s_add_u32 s56, s14, 0x4900000
    s_addc_u32 s57, s15, 0
    s_and_b32 s57, s57, 0xffff
    s_mov_b32 s58, 0x1c0000
    s_mov_b32 s59, 0x00020000
    s_add_u32 s60, s14, 0x480f000
    s_addc_u32 s61, s15, 0
    s_and_b32 s61, s61, 0xffff
    s_mov_b32 s62, 0x2000
    s_mov_b32 s63, 0x00020000
    s_waitcnt lgkmcnt(0)
k4_mm_95:
    s_barrier
    s_cmp_ge_u32 s2, 224
    s_cbranch_scc1 k4_red_98
    v_lshrrev_b32 v12, 4, v2
    v_and_b32 v13, 1, v2
    v_lshlrev_b32 v13, 11, v13
    v_lshl_add_u32 v13, v12, 3, v13
    s_lshl_b32 s54, s44, 8
    s_add_u32 s54, s54, 65536
    v_add_u32 v13, s54, v13
    v_lshlrev_b32 v14, 3, v2
    s_lshl_b32 s54, s44, 12
    v_add_u32 v14, s54, v14
    ds_read_b64 v[128:129], v13 offset:0
    ds_read_b64 v[130:131], v13 offset:32
    ds_read_b64_tr_b16 v[144:145], v14 offset:0
    ds_read_b64_tr_b16 v[146:147], v14 offset:512
    ds_read_b64_tr_b16 v[160:161], v14 offset:32768
    ds_read_b64_tr_b16 v[162:163], v14 offset:33280
    ds_read_b64 v[132:133], v13 offset:64
    ds_read_b64 v[134:135], v13 offset:96
    ds_read_b64_tr_b16 v[148:149], v14 offset:1024
    ds_read_b64_tr_b16 v[150:151], v14 offset:1536
    ds_read_b64_tr_b16 v[164:165], v14 offset:33792
    ds_read_b64_tr_b16 v[166:167], v14 offset:34304
    ds_read_b64 v[136:137], v13 offset:128
    ds_read_b64 v[138:139], v13 offset:160
    ds_read_b64_tr_b16 v[152:153], v14 offset:2048
    ds_read_b64_tr_b16 v[154:155], v14 offset:2560
    ds_read_b64_tr_b16 v[168:169], v14 offset:34816
    ds_read_b64_tr_b16 v[170:171], v14 offset:35328
    ds_read_b64 v[140:141], v13 offset:192
    ds_read_b64 v[142:143], v13 offset:224
    ds_read_b64_tr_b16 v[156:157], v14 offset:3072
    ds_read_b64_tr_b16 v[158:159], v14 offset:3584
    ds_read_b64_tr_b16 v[172:173], v14 offset:35840
    ds_read_b64_tr_b16 v[174:175], v14 offset:36352
    v_and_b32 v13, 15, v2
    v_lshlrev_b32 v13, 6, v13
    v_lshl_add_u32 v13, v12, 4, v13
    s_lshl_b32 s54, s44, 11
    s_add_u32 s54, s54, 69888
    v_add_u32 v13, s54, v13
    s_waitcnt lgkmcnt(0)
    v_mfma_f32_16x16x32_bf16 v[16:19], v[144:147], v[128:131], 0
    v_mfma_f32_16x16x32_bf16 v[20:23], v[160:163], v[128:131], 0
    v_mfma_f32_16x16x32_bf16 v[16:19], v[148:151], v[132:135], v[16:19]
    v_mfma_f32_16x16x32_bf16 v[20:23], v[164:167], v[132:135], v[20:23]
    v_mfma_f32_16x16x32_bf16 v[16:19], v[152:155], v[136:139], v[16:19]
    v_mfma_f32_16x16x32_bf16 v[20:23], v[168:171], v[136:139], v[20:23]
    v_mfma_f32_16x16x32_bf16 v[16:19], v[156:159], v[140:143], v[16:19]
    v_mfma_f32_16x16x32_bf16 v[20:23], v[172:175], v[140:143], v[20:23]
    s_nop 7
    ds_write_b128 v13, v[16:19]
    ds_write_b128 v13, v[20:23] offset:1024
    s_waitcnt lgkmcnt(0)
    s_barrier
    s_cmp_ge_u32 s44, 4
    s_cbranch_scc1 k4_ln_94
    v_lshlrev_b32 v13, 2, v4
    v_add_u32 v13, 69888, v13
    ds_read2st64_b32 v[16:17], v13 offset0:0 offset1:4
    ds_read2st64_b32 v[18:19], v13 offset0:8 offset1:12
    ds_read2st64_b32 v[20:21], v13 offset0:16 offset1:20
    ds_read2st64_b32 v[22:23], v13 offset0:24 offset1:28
    ds_read2st64_b32 v[24:25], v13 offset0:32 offset1:36
    ds_read2st64_b32 v[26:27], v13 offset0:40 offset1:44
    ds_read2st64_b32 v[28:29], v13 offset0:48 offset1:52
    ds_read2st64_b32 v[30:31], v13 offset0:56 offset1:60
    s_waitcnt lgkmcnt(0)
    v_pk_add_f32 v[16:17], v[16:17], v[24:25]
    v_pk_add_f32 v[18:19], v[18:19], v[26:27]
    v_pk_add_f32 v[20:21], v[20:21], v[28:29]
    v_pk_add_f32 v[22:23], v[22:23], v[30:31]
    v_pk_add_f32 v[16:17], v[16:17], v[20:21]
    v_pk_add_f32 v[18:19], v[18:19], v[22:23]
    v_pk_add_f32 v[16:17], v[16:17], v[18:19]
    v_cvt_pk_bf16_f32 v16, v16, v17
    v_and_b32 v20, 0xffff0000, v16
    v_lshlrev_b32 v16, 16, v16
    v_mul_f32 v17, 0xbfb8aa3b, v16
    v_exp_f32 v17, v17
    s_lshl_b32 s54, s45, 13
    v_add_f32 v17, 1.0, v17
    v_rcp_f32 v17, v17
    s_add_u32 s55, s54, 4096
    v_mul_f32 v16, v16, v17
    v_cvt_pk_bf16_f32 v16, v16, v16
    v_and_b32 v16, 0xffff0000, v16
    v_mul_f32 v16, v16, v20
    s_nop 1
    v_mov_b32_dpp v17, v16 quad_perm:[1,0,3,2] row_mask:0xf bank_mask:0xf
    v_cvt_pk_bf16_f32 v16, v16, v17
    v_lshlrev_b32 v13, 4, v0
    v_readlane_b32 s24, v16, 0
    v_readlane_b32 s25, v16, 2
    v_readlane_b32 s26, v16, 4
    v_readlane_b32 s27, v16, 6
    v_readlane_b32 s28, v16, 8
    v_readlane_b32 s29, v16, 10
    v_readlane_b32 s30, v16, 12
    v_readlane_b32 s31, v16, 14
    v_readlane_b32 s32, v16, 16
    v_readlane_b32 s33, v16, 18
    v_readlane_b32 s34, v16, 20
    v_readlane_b32 s35, v16, 22
    v_readlane_b32 s36, v16, 24
    v_readlane_b32 s37, v16, 26
    v_readlane_b32 s38, v16, 28
    v_readlane_b32 s39, v16, 30
    v_dot2_f32_bf16 v24, v56, s24, 0
    v_dot2_f32_bf16 v25, v57, s24, 0
    v_dot2_f32_bf16 v26, v58, s24, 0
    v_dot2_f32_bf16 v27, v59, s24, 0
    v_dot2_f32_bf16 v24, v60, s25, v24
    v_dot2_f32_bf16 v25, v61, s25, v25
    v_dot2_f32_bf16 v26, v62, s25, v26
    v_dot2_f32_bf16 v27, v63, s25, v27
    v_dot2_f32_bf16 v24, v64, s26, v24
    v_dot2_f32_bf16 v25, v65, s26, v25
    v_dot2_f32_bf16 v26, v66, s26, v26
    v_dot2_f32_bf16 v27, v67, s26, v27
    v_dot2_f32_bf16 v24, v68, s27, v24
    v_dot2_f32_bf16 v25, v69, s27, v25
    v_dot2_f32_bf16 v26, v70, s27, v26
    v_dot2_f32_bf16 v27, v71, s27, v27
    v_dot2_f32_bf16 v24, v72, s28, v24
    v_dot2_f32_bf16 v25, v73, s28, v25
    v_dot2_f32_bf16 v26, v74, s28, v26
    v_dot2_f32_bf16 v27, v75, s28, v27
    v_dot2_f32_bf16 v24, v76, s29, v24
    v_dot2_f32_bf16 v25, v77, s29, v25
    v_dot2_f32_bf16 v26, v78, s29, v26
    v_dot2_f32_bf16 v27, v79, s29, v27
    v_dot2_f32_bf16 v24, v80, s30, v24
    v_dot2_f32_bf16 v25, v81, s30, v25
    v_dot2_f32_bf16 v26, v82, s30, v26
    v_dot2_f32_bf16 v27, v83, s30, v27
    v_dot2_f32_bf16 v24, v84, s31, v24
    v_dot2_f32_bf16 v25, v85, s31, v25
    v_dot2_f32_bf16 v26, v86, s31, v26
    v_dot2_f32_bf16 v27, v87, s31, v27
    v_dot2_f32_bf16 v28, v56, s32, 0
    v_dot2_f32_bf16 v29, v57, s32, 0
    v_dot2_f32_bf16 v30, v58, s32, 0
    v_dot2_f32_bf16 v31, v59, s32, 0
    v_dot2_f32_bf16 v28, v60, s33, v28
    v_dot2_f32_bf16 v29, v61, s33, v29
    v_dot2_f32_bf16 v30, v62, s33, v30
    v_dot2_f32_bf16 v31, v63, s33, v31
    v_dot2_f32_bf16 v28, v64, s34, v28
    v_dot2_f32_bf16 v29, v65, s34, v29
    v_dot2_f32_bf16 v30, v66, s34, v30
    v_dot2_f32_bf16 v31, v67, s34, v31
    v_dot2_f32_bf16 v28, v68, s35, v28
    v_dot2_f32_bf16 v29, v69, s35, v29
    v_dot2_f32_bf16 v30, v70, s35, v30
    v_dot2_f32_bf16 v31, v71, s35, v31
    v_dot2_f32_bf16 v28, v72, s36, v28
    v_dot2_f32_bf16 v29, v73, s36, v29
    v_dot2_f32_bf16 v30, v74, s36, v30
    v_dot2_f32_bf16 v31, v75, s36, v31
    v_dot2_f32_bf16 v28, v76, s37, v28
    v_dot2_f32_bf16 v29, v77, s37, v29
    v_dot2_f32_bf16 v30, v78, s37, v30
    v_dot2_f32_bf16 v31, v79, s37, v31
    v_dot2_f32_bf16 v28, v80, s38, v28
    v_dot2_f32_bf16 v29, v81, s38, v29
    v_dot2_f32_bf16 v30, v82, s38, v30
    v_dot2_f32_bf16 v31, v83, s38, v31
    v_dot2_f32_bf16 v28, v84, s39, v28
    v_dot2_f32_bf16 v29, v85, s39, v29
    v_dot2_f32_bf16 v30, v86, s39, v30
    v_dot2_f32_bf16 v31, v87, s39, v31
    s_and_b32 s52, s45, 15
    s_lshl_b32 s53, s44, 4
    s_add_u32 s52, s52, s53
    s_lshl_b32 s52, s52, 7
    buffer_store_dwordx4 v[24:27], v13, s[56:59], s54 offen sc1
    buffer_store_dwordx4 v[28:31], v13, s[56:59], s55 offen sc1
    v_mov_b32 v12, 0
    v_mov_b32 v13, 1
    s_mov_b64 exec, 1
    s_waitcnt vmcnt(0)
    buffer_atomic_add v13, v12, s[60:63], s52 offen sc1
    s_mov_b64 exec, -1
    s_endpgm
k4_red_98:
    s_cmp_ge_u32 s44, 4
    s_cbranch_scc1 k4_ln_94
    s_sub_u32 s40, s2, 224
    s_lshr_b32 s41, s40, 4
    s_and_b32 s42, s40, 15
    s_mov_b32 s24, s4
    s_and_b32 s25, s5, 0xffff
    s_mov_b32 s26, 0x800
    s_mov_b32 s27, 0x00020000
    s_mov_b32 s28, s12
    s_and_b32 s29, s13, 0xffff
    s_mov_b32 s30, 0x400000
    s_mov_b32 s31, 0x00020000
    buffer_load_dwordx4 v[56:59], v7, s[24:27], 0 offen offset:0
    buffer_load_dwordx4 v[60:63], v7, s[24:27], 0 offen offset:512
    buffer_load_dwordx4 v[64:67], v7, s[24:27], 0 offen offset:1024
    buffer_load_dwordx4 v[68:71], v7, s[24:27], 0 offen offset:1536
    s_lshl_b32 s43, s41, 5
    v_readlane_b32 s46, v15, s43
    v_and_b32 v8, 15, v0
    s_lshl_b32 s47, s42, 7
    v_lshl_add_u32 v9, v8, 3, s47
    s_lshl_b32 s46, s46, 11
    s_lshl_b32 s48, s41, 11
    s_add_u32 s48, s48, 65536
    v_add_u32 v12, s48, v9
    ds_read_b64 v[72:73], v12
    buffer_load_dwordx2 v[74:75], v9, s[20:23], s46 offen
    v_lshrrev_b32 v10, 4, v0
    v_lshlrev_b32 v10, 13, v10
    v_lshl_add_u32 v10, v8, 4, v10
    s_lshl_b32 s49, s40, 8
    s_waitcnt vmcnt(1)
    v_dot2_f32_bf16 v12, v40, v56, 0
    v_dot2_f32_bf16 v12, v41, v57, v12
    v_dot2_f32_bf16 v12, v42, v58, v12
    v_dot2_f32_bf16 v12, v43, v59, v12
    v_dot2_f32_bf16 v12, v44, v60, v12
    v_dot2_f32_bf16 v12, v45, v61, v12
    v_dot2_f32_bf16 v12, v46, v62, v12
    v_dot2_f32_bf16 v12, v47, v63, v12
    v_dot2_f32_bf16 v12, v48, v64, v12
    v_dot2_f32_bf16 v12, v49, v65, v12
    v_dot2_f32_bf16 v12, v50, v66, v12
    v_dot2_f32_bf16 v12, v51, v67, v12
    v_dot2_f32_bf16 v12, v52, v68, v12
    v_dot2_f32_bf16 v12, v53, v69, v12
    v_dot2_f32_bf16 v12, v54, v70, v12
    v_dot2_f32_bf16 v12, v55, v71, v12
    s_nop 2
    s_nop 1
    v_add_f32_dpp v12, v12, v12 quad_perm:[1,0,3,2] row_mask:0xf bank_mask:0xf
    s_nop 1
    v_add_f32_dpp v12, v12, v12 quad_perm:[2,3,0,1] row_mask:0xf bank_mask:0xf
    s_nop 1
    v_add_f32_dpp v12, v12, v12 row_half_mirror row_mask:0xf bank_mask:0xf
    s_nop 1
    v_add_f32_dpp v12, v12, v12 row_mirror row_mask:0xf bank_mask:0xf
    v_mov_b32 v13, v12
    s_nop 1
    v_permlane16_swap_b32 v12, v13
    s_nop 1
    v_add_f32 v12, v12, v13
    v_cvt_pk_bf16_f32 v12, v12, v12
    v_and_b32 v12, 0xffff0000, v12
    v_mul_f32 v12, 0xbfb8aa3b, v12
    v_exp_f32 v12, v12
    v_mov_b32 v3, v8
    v_add_f32 v12, 1.0, v12
    v_rcp_f32 v12, v12
    s_lshr_b32 s50, s42, 2
    v_cvt_pk_bf16_f32 v12, v12, v12
    v_and_b32 v12, 0xffff0000, v12
    s_lshl_b32 s50, s50, 11
    v_readlane_b32 s51, v12, s43
    v_lshlrev_b32 v3, 7, v3
    s_mov_b32 s47, s49
    s_mov_b32 s30, 0
    s_mov_b32 s58, 0
    s_branch k4_go_99
k4_again_101:
    s_mov_b32 s49, s47
    s_mov_b32 s30, 0x400000
    s_mov_b32 s58, 1835008
    s_cmp_lg_u32 s44, 0
    s_cbranch_scc1 k4_go_99
    s_mov_b32 s52, 1048576
k4_poll_100:
    s_sleep 8
    buffer_load_dword v13, v3, s[60:63], s50 offen sc1
    s_sub_u32 s52, s52, 1
    s_cbranch_scc1 k4_go_99
    s_waitcnt vmcnt(0)
    v_cmp_gt_u32 vcc, 14, v13
    s_cbranch_vccnz k4_poll_100
k4_go_99:
    s_barrier
    buffer_load_dwordx4 v[76:79], v10, s[56:59], s49 offen sc1
    s_add_u32 s49, s49, 0x20000
    buffer_load_dwordx4 v[80:83], v10, s[56:59], s49 offen sc1
    s_add_u32 s49, s49, 0x20000
    buffer_load_dwordx4 v[84:87], v10, s[56:59], s49 offen sc1
    s_add_u32 s49, s49, 0x20000
    buffer_load_dwordx4 v[88:91], v10, s[56:59], s49 offen sc1
    s_add_u32 s49, s49, 0x20000
    buffer_load_dwordx4 v[92:95], v10, s[56:59], s49 offen sc1
    s_add_u32 s49, s49, 0x20000
    buffer_load_dwordx4 v[96:99], v10, s[56:59], s49 offen sc1
    s_add_u32 s49, s49, 0x20000
    buffer_load_dwordx4 v[100:103], v10, s[56:59], s49 offen sc1
    s_add_u32 s49, s49, 0x20000
    buffer_load_dwordx4 v[104:107], v10, s[56:59], s49 offen sc1
    s_add_u32 s49, s49, 0x20000
    buffer_load_dwordx4 v[108:111], v10, s[56:59], s49 offen sc1
    s_add_u32 s49, s49, 0x20000
    buffer_load_dwordx4 v[112:115], v10, s[56:59], s49 offen sc1
    s_add_u32 s49, s49, 0x20000
    buffer_load_dwordx4 v[116:119], v10, s[56:59], s49 offen sc1
    s_add_u32 s49, s49, 0x20000
    buffer_load_dwordx4 v[120:123], v10, s[56:59], s49 offen sc1
    s_add_u32 s49, s49, 0x20000
    buffer_load_dwordx4 v[124:127], v10, s[56:59], s49 offen sc1
    s_add_u32 s49, s49, 0x20000
    buffer_load_dwordx4 v[128:131], v10, s[56:59], s49 offen sc1
    s_add_u32 s49, s49, 0x20000
    s_waitcnt vmcnt(12)
    v_pk_add_f32 v[76:77], v[76:77], v[80:81]
    v_pk_add_f32 v[78:79], v[78:79], v[82:83]
    s_waitcnt vmcnt(11)
    v_pk_add_f32 v[76:77], v[76:77], v[84:85]
    v_pk_add_f32 v[78:79], v[78:79], v[86:87]
    s_waitcnt vmcnt(10)
    v_pk_add_f32 v[76:77], v[76:77], v[88:89]
    v_pk_add_f32 v[78:79], v[78:79], v[90:91]
    s_waitcnt vmcnt(9)
    v_pk_add_f32 v[76:77], v[76:77], v[92:93]
    v_pk_add_f32 v[78:79], v[78:79], v[94:95]
    s_waitcnt vmcnt(8)
    v_pk_add_f32 v[76:77], v[76:77], v[96:97]
    v_pk_add_f32 v[78:79], v[78:79], v[98:99]
    s_waitcnt vmcnt(7)
    v_pk_add_f32 v[76:77], v[76:77], v[100:101]
    v_pk_add_f32 v[78:79], v[78:79], v[102:103]
    s_waitcnt vmcnt(6)
    v_pk_add_f32 v[76:77], v[76:77], v[104:105]
    v_pk_add_f32 v[78:79], v[78:79], v[106:107]
    s_waitcnt vmcnt(5)
    v_pk_add_f32 v[76:77], v[76:77], v[108:109]
    v_pk_add_f32 v[78:79], v[78:79], v[110:111]
    s_waitcnt vmcnt(4)
    v_pk_add_f32 v[76:77], v[76:77], v[112:113]
    v_pk_add_f32 v[78:79], v[78:79], v[114:115]
    s_waitcnt vmcnt(3)
    v_pk_add_f32 v[76:77], v[76:77], v[116:117]
    v_pk_add_f32 v[78:79], v[78:79], v[118:119]
    s_waitcnt vmcnt(2)
    v_pk_add_f32 v[76:77], v[76:77], v[120:121]
    v_pk_add_f32 v[78:79], v[78:79], v[122:123]
    s_waitcnt vmcnt(1)
    v_pk_add_f32 v[76:77], v[76:77], v[124:125]
    v_pk_add_f32 v[78:79], v[78:79], v[126:127]
    s_waitcnt vmcnt(0)
    v_pk_add_f32 v[76:77], v[76:77], v[128:129]
    v_pk_add_f32 v[78:79], v[78:79], v[130:131]
    v_mov_b32 v80, v76
    v_mov_b32 v81, v77
    v_mov_b32 v82, v78
    v_mov_b32 v83, v79
    s_nop 1
    v_permlane16_swap_b32 v76, v80
    v_permlane16_swap_b32 v77, v81
    v_permlane16_swap_b32 v78, v82
    v_permlane16_swap_b32 v79, v83
    s_nop 1
    v_add_f32 v76, v76, v80
    v_add_f32 v77, v77, v81
    v_add_f32 v78, v78, v82
    v_add_f32 v79, v79, v83
    v_mov_b32 v80, v76
    v_mov_b32 v81, v77
    v_mov_b32 v82, v78
    v_mov_b32 v83, v79
    s_nop 1
    v_permlane32_swap_b32 v76, v80
    v_permlane32_swap_b32 v77, v81
    v_permlane32_swap_b32 v78, v82
    v_permlane32_swap_b32 v79, v83
    s_nop 1
    v_add_f32 v76, v76, v80
    v_add_f32 v77, v77, v81
    v_add_f32 v78, v78, v82
    v_add_f32 v79, v79, v83
    v_lshlrev_b32 v14, 8, v1
    v_lshl_add_u32 v14, v8, 4, v14
    ds_write_b128 v14, v[76:79]
    s_waitcnt lgkmcnt(0)
    s_barrier
    v_lshlrev_b32 v14, 4, v8
    ds_read_b128 v[76:79], v14 offset:0
    ds_read_b128 v[80:83], v14 offset:256
    ds_read_b128 v[84:87], v14 offset:512
    ds_read_b128 v[88:91], v14 offset:768
    s_waitcnt lgkmcnt(0)
    v_pk_add_f32 v[76:77], v[76:77], v[80:81]
    v_pk_add_f32 v[78:79], v[78:79], v[82:83]
    v_pk_add_f32 v[76:77], v[76:77], v[84:85]
    v_pk_add_f32 v[78:79], v[78:79], v[86:87]
    v_pk_add_f32 v[76:77], v[76:77], v[88:89]
    v_pk_add_f32 v[78:79], v[78:79], v[90:91]
    v_cvt_pk_bf16_f32 v20, v76, v77
    v_lshlrev_b32 v21, 16, v20
    v_and_b32 v22, 0xffff0000, v20
    v_mul_f32 v21, s51, v21
    v_mul_f32 v22, s51, v22
    v_cvt_pk_bf16_f32 v20, v21, v22
    v_lshlrev_b32 v21, 16, v20
    v_and_b32 v22, 0xffff0000, v20
    v_lshlrev_b32 v23, 16, v72
    v_and_b32 v24, 0xffff0000, v72
    v_add_f32 v21, v21, v23
    v_add_f32 v22, v22, v24
    v_cvt_pk_bf16_f32 v20, v21, v22
    v_lshlrev_b32 v21, 16, v20
    v_and_b32 v22, 0xffff0000, v20
    v_lshlrev_b32 v23, 16, v74
    v_and_b32 v24, 0xffff0000, v74
    v_add_f32 v21, v21, v23
    v_add_f32 v22, v22, v24
    v_cvt_pk_bf16_f32 v26, v21, v22
    v_cvt_pk_bf16_f32 v20, v78, v79
    v_lshlrev_b32 v21, 16, v20
    v_and_b32 v22, 0xffff0000, v20
    v_mul_f32 v21, s51, v21
    v_mul_f32 v22, s51, v22
    v_cvt_pk_bf16_f32 v20, v21, v22
    v_lshlrev_b32 v21, 16, v20
    v_and_b32 v22, 0xffff0000, v20
    v_lshlrev_b32 v23, 16, v73
    v_and_b32 v24, 0xffff0000, v73
    v_add_f32 v21, v21, v23
    v_add_f32 v22, v22, v24
    v_cvt_pk_bf16_f32 v20, v21, v22
    v_lshlrev_b32 v21, 16, v20
    v_and_b32 v22, 0xffff0000, v20
    v_lshlrev_b32 v23, 16, v75
    v_and_b32 v24, 0xffff0000, v75
    v_add_f32 v21, v21, v23
    v_add_f32 v22, v22, v24
    v_cvt_pk_bf16_f32 v27, v21, v22
    v_cmp_gt_u32 vcc, 16, v0
    s_and_saveexec_b64 s[52:53], vcc
    s_cbranch_execz k4_skip_102
    buffer_store_dwordx2 v[26:27], v9, s[28:31], s46 offen sc1
k4_skip_102:
    s_mov_b64 exec, s[52:53]
    s_cmp_lg_u32 s30, 0
    s_cbranch_scc1 k4_fin_103
    s_branch k4_again_101
k4_fin_103:
    s_endpgm
k4_b_93:
    v_lshl_add_u32 v6, v1, 1, v5
    s_lshl_b32 s47, s2, 3
    s_sub_u32 s47, s47, 8
    v_add_u32 v6, s47, v6
    v_lshl_add_u32 v6, v6, 11, v7
    s_mov_b32 s36, s12
    s_and_b32 s37, s13, 0xffff
    s_mov_b32 s38, 0x400000
    s_mov_b32 s39, 0x00020000
    s_cmp_ge_u32 s2, 224
    s_cbranch_scc1 k4_noffn_104
    s_mov_b32 s24, s6
    s_and_b32 s25, s7, 0xffff
    s_mov_b32 s26, 0x700000
    s_mov_b32 s27, 0x00020000
    s_mov_b32 s28, s8
    s_and_b32 s29, s9, 0xffff
    s_mov_b32 s30, 0x700000
    s_mov_b32 s31, 0x00020000
    s_and_b32 s50, s44, 3
    v_lshrrev_b32 v8, 1, v2
    s_lshl_b32 s47, s50, 8
    v_add_u32 v8, s47, v8
    v_mul_u32_u24 v8, 7168, v8
    v_and_b32 v9, 1, v2
    v_lshl_add_u32 v8, v9, 4, v8
    s_lshl_b32 s47, s45, 5
    v_add_u32 v8, s47, v8
    s_and_b32 s49, s45, 3
    s_lshl_b32 s49, s49, 1
    s_lshl_b32 s50, s50, 13
    s_mov_b32 s53, 8
k4_dma_105:
    s_mul_i32 s52, s49, 229376
    s_lshl_b32 s51, s49, 10
    s_add_u32 m0, s51, s50
    s_add_u32 s49, s49, 1
    buffer_load_dwordx4 v8, s[24:27], s52 offen lds
    s_add_u32 m0, m0, 32768
    s_and_b32 s49, s49, 7
    buffer_load_dwordx4 v8, s[28:31], s52 offen lds
    s_sub_u32 s53, s53, 1
    s_cmp_lg_u32 s53, 0
    s_cbranch_scc1 k4_dma_105
k4_noffn_104:
    buffer_load_dwordx4 v[40:43], v6, s[20:23], 0 offen offset:0
    buffer_load_dwordx4 v[44:47], v6, s[20:23], 0 offen offset:512
    buffer_load_dwordx4 v[48:51], v6, s[20:23], 0 offen offset:1024
    buffer_load_dwordx4 v[52:55], v6, s[20:23], 0 offen offset:1536
    s_waitcnt vmcnt(0)
    s_branch k4_mm_95
k4_bout_96:
    v_mov_b32 v12, 69760
    ds_read_b64 v[12:13], v12
    v_lshrrev_b32 v14, 11, v6
    v_lshlrev_b32 v160, 16, v40
    v_and_b32 v161, 0xffff0000, v40
    v_lshlrev_b32 v162, 16, v41
    v_and_b32 v163, 0xffff0000, v41
    v_lshlrev_b32 v164, 16, v42
    v_and_b32 v165, 0xffff0000, v42
    v_lshlrev_b32 v166, 16, v43
    v_and_b32 v167, 0xffff0000, v43
    v_lshlrev_b32 v168, 16, v44
    v_and_b32 v169, 0xffff0000, v44
    v_lshlrev_b32 v170, 16, v45
    v_and_b32 v171, 0xffff0000, v45
    v_lshlrev_b32 v172, 16, v46
    v_and_b32 v173, 0xffff0000, v46
    v_lshlrev_b32 v174, 16, v47
    v_and_b32 v175, 0xffff0000, v47
    v_lshlrev_b32 v176, 16, v48
    v_and_b32 v177, 0xffff0000, v48
    v_lshlrev_b32 v178, 16, v49
    v_and_b32 v179, 0xffff0000, v49
    v_lshlrev_b32 v180, 16, v50
    v_and_b32 v181, 0xffff0000, v50
    v_lshlrev_b32 v182, 16, v51
    v_and_b32 v183, 0xffff0000, v51
    v_lshlrev_b32 v184, 16, v52
    v_and_b32 v185, 0xffff0000, v52
    v_lshlrev_b32 v186, 16, v53
    v_and_b32 v187, 0xffff0000, v53
    v_lshlrev_b32 v188, 16, v54
    v_and_b32 v189, 0xffff0000, v54
    v_lshlrev_b32 v190, 16, v55
    v_and_b32 v191, 0xffff0000, v55
    v_pk_add_f32 v[160:161], v[160:161], v[200:201]
    v_pk_add_f32 v[162:163], v[162:163], v[202:203]
    v_pk_add_f32 v[164:165], v[164:165], v[204:205]
    v_pk_add_f32 v[166:167], v[166:167], v[206:207]
    v_pk_add_f32 v[168:169], v[168:169], v[208:209]
    v_pk_add_f32 v[170:171], v[170:171], v[210:211]
    v_pk_add_f32 v[172:173], v[172:173], v[212:213]
    v_pk_add_f32 v[174:175], v[174:175], v[214:215]
    v_pk_add_f32 v[176:177], v[176:177], v[216:217]
    v_pk_add_f32 v[178:179], v[178:179], v[218:219]
    v_pk_add_f32 v[180:181], v[180:181], v[220:221]
    v_pk_add_f32 v[182:183], v[182:183], v[222:223]
    v_pk_add_f32 v[184:185], v[184:185], v[224:225]
    v_pk_add_f32 v[186:187], v[186:187], v[226:227]
    v_pk_add_f32 v[188:189], v[188:189], v[228:229]
    v_pk_add_f32 v[190:191], v[190:191], v[230:231]
    v_cvt_pk_bf16_f32 v40, v160, v161
    v_cvt_pk_bf16_f32 v41, v162, v163
    v_cvt_pk_bf16_f32 v42, v164, v165
    v_cvt_pk_bf16_f32 v43, v166, v167
    v_cvt_pk_bf16_f32 v44, v168, v169
    v_cvt_pk_bf16_f32 v45, v170, v171
    v_cvt_pk_bf16_f32 v46, v172, v173
    v_cvt_pk_bf16_f32 v47, v174, v175
    v_cvt_pk_bf16_f32 v48, v176, v177
    v_cvt_pk_bf16_f32 v49, v178, v179
    v_cvt_pk_bf16_f32 v50, v180, v181
    v_cvt_pk_bf16_f32 v51, v182, v183
    v_cvt_pk_bf16_f32 v52, v184, v185
    v_cvt_pk_bf16_f32 v53, v186, v187
    v_cvt_pk_bf16_f32 v54, v188, v189
    v_cvt_pk_bf16_f32 v55, v190, v191
    s_waitcnt lgkmcnt(0)
    v_cmp_eq_u32 vcc, v12, v14
    v_cmp_eq_u32 s[52:53], v13, v14
    v_mov_b32 v12, 0x7fffffff
    s_or_b64 vcc, vcc, s[52:53]
    v_cndmask_b32 v6, v6, v12, vcc
    buffer_store_dwordx4 v[40:43], v6, s[36:39], 0 offen offset:0 sc1
    buffer_store_dwordx4 v[44:47], v6, s[36:39], 0 offen offset:512 sc1
    buffer_store_dwordx4 v[48:51], v6, s[36:39], 0 offen offset:1024 sc1
    buffer_store_dwordx4 v[52:55], v6, s[36:39], 0 offen offset:1536 sc1
k4_end_92:
    s_endpgm
code_end:
    s_endpgm
.section .rodata,"a"
.p2align 6
.amdhsa_kernel k12_kernel
  .amdhsa_next_free_vgpr 512
  .amdhsa_next_free_sgpr 102
  .amdhsa_accum_offset 256
  .amdhsa_group_segment_fixed_size 0
  .amdhsa_kernarg_size 112
  .amdhsa_user_sgpr_count 2
  .amdhsa_user_sgpr_kernarg_segment_ptr 1
  .amdhsa_system_sgpr_workgroup_id_x 1
.end_amdhsa_kernel
.p2align 6
.amdhsa_kernel k3_kernel
  .amdhsa_next_free_vgpr 348
  .amdhsa_next_free_sgpr 102
  .amdhsa_accum_offset 156
  .amdhsa_group_segment_fixed_size 0
  .amdhsa_kernarg_size 112
  .amdhsa_user_sgpr_count 2
  .amdhsa_user_sgpr_kernarg_segment_ptr 1
  .amdhsa_system_sgpr_workgroup_id_x 1
.end_amdhsa_kernel
.p2align 6
.amdhsa_kernel k4_kernel
  .amdhsa_next_free_vgpr 232
  .amdhsa_next_free_sgpr 102
  .amdhsa_accum_offset 232
  .amdhsa_group_segment_fixed_size 0
  .amdhsa_kernarg_size 112
  .amdhsa_user_sgpr_count 2
  .amdhsa_user_sgpr_kernarg_segment_ptr 1
  .amdhsa_system_sgpr_workgroup_id_x 1
  .amdhsa_float_denorm_mode_32 3
.end_amdhsa_kernel
```

```asm
; @launch kernel=k12_kernel grid=(256,1,1) block=(256,1,1) lds=163840
; @launch kernel=k3_kernel grid=(256,1,1) block=(256,1,1) lds=65536
; @launch kernel=k4_kernel grid=(256,1,1) block=(512,1,1) lds=86272
.amdgcn_target "amdgcn-amd-amdhsa--gfx950"
.text
.globl k12_kernel
.p2align 8
.type k12_kernel,@function
k12_kernel:
    s_cmp_ge_u32 s2, 256
    s_cbranch_scc1 k12_end_1
    s_load_dwordx4 s[36:39], s[0:1], 0
    s_load_dwordx4 s[40:43], s[0:1], 24
    s_load_dwordx2 s[4:5], s[0:1], 16
    s_load_dwordx4 s[60:63], s[0:1], 96
    s_lshr_b32 s59, s2, 3
    s_lshl_b32 s58, s59, 4
    v_add_u32 v6, s58, v0
    v_cmp_gt_u32 vcc, 48, v0
    v_cmp_gt_u32 s[56:57], 64, v0
    s_nop 0
    v_cndmask_b32 v6, v6, v0, vcc
    s_getpc_b64 s[52:53]
pc_2:
    s_add_u32 s52, s52, k12_code0-pc_2
    s_addc_u32 s53, s53, 0
    v_lshlrev_b32 v58, 7, v6
    v_mov_b32 v59, s53
    v_add_co_u32 v58, vcc, s52, v58
    s_nop 1
    v_addc_co_u32 v59, vcc, 0, v59, vcc
k12_code0:
    s_mov_b64 exec, s[56:57]
    s_cbranch_execz k12_nocode_3
    global_load_dword v51, v[58:59], off
k12_nocode_3:
    s_mov_b64 exec, -1
    s_and_b32 s58, s2, 7
    s_lshr_b32 s59, s2, 3
    s_and_b32 s45, s59, 7
    s_lshr_b32 s57, s59, 3
    s_and_b32 s44, s57, 1
    s_lshl_b32 s52, s58, 1
    s_add_u32 s44, s44, s52
    s_lshr_b32 s57, s57, 1
    v_lshrrev_b32 v2, 6, v0
    v_and_b32 v3, 63, v0
    v_readfirstlane_b32 s30, v2
    v_lshlrev_b32 v1, 4, v3
    v_lshrrev_b32 v60, 5, v3
    v_lshl_add_u32 v60, v2, 1, v60
    v_and_b32 v61, 31, v3
    v_lshlrev_b32 v6, 11, v60
    v_lshl_add_u32 v62, v61, 4, v6
    s_lshl_b32 s52, s2, 14
    v_lshrrev_b32 v56, 3, v3
    v_and_b32 v57, 7, v3
    v_lshrrev_b32 v58, 1, v56
    v_xor_b32 v6, v57, v58
    v_xor_b32 v7, 4, v6
    v_lshl_add_u32 v58, v2, 6, v56
    v_lshlrev_b32 v58, 10, v58
    s_lshl_b32 s47, s45, 18
    v_add_u32 v58, s47, v58
    v_lshl_add_u32 v10, v6, 4, v58
    v_lshl_add_u32 v11, v7, 4, v58
    v_add_u32 v17, 54272, v11
    v_add_u32 v16, 47104, v10
    v_add_u32 v15, 39936, v11
    v_add_u32 v14, 32768, v10
    v_add_u32 v13, 21504, v11
    v_add_u32 v12, 14336, v10
    v_add_u32 v11, 7168, v11
    v_add_u32 v10, 0, v10
    v_lshrrev_b32 v6, 5, v3
    v_bfe_u32 v7, v3, 1, 4
    v_and_b32 v59, 1, v3
    v_lshl_add_u32 v58, v2, 4, v6
    v_lshlrev_b32 v58, 13, v58
    v_lshl_add_u32 v58, v59, 4, v58
    s_lshl_b32 s47, s44, 9
    v_add_u32 v58, s47, v58
    v_xor_b32 v7, v7, v6
    v_xor_b32 v6, 0, v7
    v_lshl_add_u32 v6, v6, 5, v58
    v_add_u32 v18, 0, v6
    v_xor_b32 v6, 2, v7
    v_lshl_add_u32 v6, v6, 5, v58
    v_add_u32 v19, 15360, v6
    v_xor_b32 v6, 0, v7
    v_lshl_add_u32 v6, v6, 5, v58
    v_add_u32 v20, 30720, v6
    v_xor_b32 v6, 2, v7
    v_lshl_add_u32 v6, v6, 5, v58
    v_add_u32 v21, 46080, v6
    v_xor_b32 v6, 4, v7
    v_lshl_add_u32 v6, v6, 5, v58
    v_add_u32 v22, 65536, v6
    v_xor_b32 v6, 6, v7
    v_lshl_add_u32 v6, v6, 5, v58
    v_add_u32 v23, 80896, v6
    v_xor_b32 v6, 4, v7
    v_lshl_add_u32 v6, v6, 5, v58
    v_add_u32 v24, 96256, v6
    v_xor_b32 v6, 6, v7
    v_lshl_add_u32 v6, v6, 5, v58
    v_add_u32 v25, 111616, v6
    s_lshl_b32 s48, s30, 13
    s_mov_b32 s49, 0
    s_mov_b32 s50, 0
    s_waitcnt lgkmcnt(0)
    s_mov_b32 s24, s36
    s_and_b32 s25, s37, 0xffff
    s_mov_b32 s26, 0x400000
    s_mov_b32 s27, 0x00020000
    buffer_load_dwordx4 v[64:67], v62, s[24:27], s52 offen offset:0
    buffer_load_dwordx4 v[68:71], v62, s[24:27], s52 offen offset:512
    buffer_load_dwordx4 v[72:75], v62, s[24:27], s52 offen offset:1024
    buffer_load_dwordx4 v[76:79], v62, s[24:27], s52 offen offset:1536
    s_mov_b32 s16, s38
    s_and_b32 s17, s39, 0xffff
    s_mov_b32 s18, 0x200000
    s_mov_b32 s19, 0x00020000
    s_cmp_eq_u32 s57, 0
    s_cselect_b32 s20, s40, s42
    s_cselect_b32 s21, s41, s43
    s_and_b32 s21, s21, 0xffff
    s_mov_b32 s22, 0x400000
    s_mov_b32 s23, 0x00020000
    s_add_u32 m0, s48, 0
    s_nop 0
    buffer_load_dwordx4 v10, s[16:19], s49 offen offset:0 lds
    buffer_load_dwordx4 v11, s[16:19], s49 offen offset:1024 lds
    buffer_load_dwordx4 v12, s[16:19], s49 offen offset:2048 lds
    buffer_load_dwordx4 v13, s[16:19], s49 offen offset:3072 lds
    s_add_u32 m0, s48, 4096
    s_nop 0
    buffer_load_dwordx4 v14, s[16:19], s49 offen offset:0 lds
    buffer_load_dwordx4 v15, s[16:19], s49 offen offset:1024 lds
    buffer_load_dwordx4 v16, s[16:19], s49 offen offset:2048 lds
    buffer_load_dwordx4 v17, s[16:19], s49 offen offset:3072 lds
    s_add_u32 s49, s49, 128
    s_add_u32 m0, s48, 65536
    s_nop 0
    buffer_load_dwordx4 v18, s[20:23], s50 offen offset:0 lds
    buffer_load_dwordx4 v19, s[20:23], s50 offen offset:1024 lds
    buffer_load_dwordx4 v20, s[20:23], s50 offen offset:2048 lds
    buffer_load_dwordx4 v21, s[20:23], s50 offen offset:3072 lds
    s_add_u32 m0, s48, 69632
    s_nop 0
    buffer_load_dwordx4 v22, s[20:23], s50 offen offset:0 lds
    buffer_load_dwordx4 v23, s[20:23], s50 offen offset:1024 lds
    buffer_load_dwordx4 v24, s[20:23], s50 offen offset:2048 lds
    buffer_load_dwordx4 v25, s[20:23], s50 offen offset:3072 lds
    s_add_u32 s50, s50, 0x80000
    s_mov_b64 s[6:7], s[62:63]
    s_add_u32 s8, s6, 0x0
    s_addc_u32 s9, s7, 0
    s_and_b32 s9, s9, 0xffff
    s_mov_b32 s10, 0x400000
    s_mov_b32 s11, 0x00020000
    s_mov_b32 s12, s4
    s_and_b32 s13, s5, 0xffff
    s_mov_b32 s14, 0x800000
    s_mov_b32 s15, 0x00020000
    s_add_u32 s32, s6, 0x1000000
    s_addc_u32 s33, s7, 0
    s_and_b32 s33, s33, 0xffff
    s_mov_b32 s34, 0x2000000
    s_mov_b32 s35, 0x00020000
    s_mov_b32 s24, s60
    s_and_b32 s25, s61, 0xffff
    s_mov_b32 s26, 0x100
    s_mov_b32 s27, 0x00020000
    s_lshl_b32 s28, s58, 2
    s_and_b32 s31, s59, 3
    s_add_u32 s28, s28, s31
    s_lshr_b32 s29, s59, 2
    s_lshl_b32 s42, s29, 7
    s_sub_u32 s43, 1920, s42
    s_lshl_b32 s31, s30, 5
    s_add_u32 s38, s42, s31
    s_add_u32 s39, s43, s31
    s_lshl_b32 s60, s30, 12
    s_mov_b32 s61, 0
    s_mov_b32 s62, 0
    s_lshl_b32 s47, s44, 1
    s_lshr_b32 s52, s30, 1
    s_add_u32 s47, s47, s52
    s_lshl_b32 s47, s47, 14
    s_lshl_b32 s52, s45, 1
    s_and_b32 s53, s30, 1
    s_add_u32 s52, s52, s53
    s_lshl_b32 s52, s52, 20
    s_add_u32 s47, s47, s52
    s_lshl_b32 s52, s57, 24
    s_add_u32 s47, s47, s52
    s_lshl_b32 s54, s44, 8
    s_lshr_b32 s55, s28, 1
    s_lshl_b32 s55, s55, 8
    s_and_b32 s53, s59, 3
    s_add_u32 s53, s53, 1
    s_cmp_eq_u32 s30, 0
    s_cselect_b32 s53, s53, -1
    s_cselect_b32 s46, 6, -1
    v_lshlrev_b32 v6, 13, v56
    v_lshl_add_u32 v50, v57, 7, v6
    s_lshl_b32 s56, s30, 5
    s_add_u32 s56, s56, s59
    s_lshl_b32 s56, s56, 16
    s_lshl_b32 s52, s58, 10
    s_add_u32 s56, s56, s52
    s_lshl_b32 s63, s30, 1
    v_mul_u32_u24 v6, 2064, v60
    v_lshl_add_u32 v6, v61, 4, v6
    v_add_u32 v54, 131072, v6
    v_mul_u32_u24 v7, 2064, v57
    v_lshl_add_u32 v7, v56, 4, v7
    v_lshl_add_u32 v7, v2, 9, v7
    v_add_u32 v55, 131072, v7
    v_lshrrev_b32 v7, 2, v56
    v_lshl_add_u32 v7, v2, 3, v7
    v_lshlrev_b32 v7, 17, v7
    v_and_b32 v6, 3, v56
    v_lshl_add_u32 v7, v6, 8, v7
    v_lshl_add_u32 v7, v57, 4, v7
    s_lshr_b32 s52, s2, 1
    s_lshl_b32 s52, s52, 10
    s_and_b32 s31, s2, 1
    s_lshl_b32 s31, s31, 7
    s_add_u32 s52, s52, s31
    v_add_u32 v53, s52, v7
    v_and_b32 v56, 15, v3
    v_lshrrev_b32 v57, 4, v3
    v_lshrrev_b32 v6, 1, v56
    v_xor_b32 v6, v6, v57
    v_and_b32 v7, 1, v2
    v_lshl_add_u32 v7, v7, 7, v56
    v_lshlrev_b32 v7, 7, v7
    v_lshl_add_u32 v26, v6, 4, v7
    v_xor_b32 v27, 64, v26
    v_lshrrev_b32 v6, 2, v56
    v_and_b32 v58, 1, v57
    v_lshl_add_u32 v58, v58, 2, v6
    v_lshl_add_u32 v59, v57, 3, v6
    v_and_b32 v63, 3, v3
    v_lshlrev_b32 v7, 9, v59
    v_lshrrev_b32 v6, 1, v2
    v_lshl_add_u32 v7, v6, 8, v7
    v_lshl_add_u32 v7, v63, 3, v7
    v_add_u32 v7, 65536, v7
    v_lshlrev_b32 v59, 8, v59
    v_lshl_add_u32 v59, v63, 3, v59
    v_add_u32 v59, 98304, v59
    v_xor_b32 v6, 0, v58
    v_lshl_add_u32 v28, v6, 5, v7
    v_lshl_add_u32 v42, v6, 5, v59
    v_xor_b32 v6, 1, v58
    v_lshl_add_u32 v29, v6, 5, v7
    v_lshl_add_u32 v43, v6, 5, v59
    v_xor_b32 v6, 2, v58
    v_lshl_add_u32 v30, v6, 5, v7
    v_lshl_add_u32 v44, v6, 5, v59
    v_xor_b32 v6, 3, v58
    v_lshl_add_u32 v31, v6, 5, v7
    v_lshl_add_u32 v45, v6, 5, v59
    v_xor_b32 v6, 4, v58
    v_lshl_add_u32 v32, v6, 5, v7
    v_lshl_add_u32 v46, v6, 5, v59
    v_xor_b32 v6, 5, v58
    v_lshl_add_u32 v33, v6, 5, v7
    v_lshl_add_u32 v47, v6, 5, v59
    v_xor_b32 v6, 6, v58
    v_lshl_add_u32 v34, v6, 5, v7
    v_lshl_add_u32 v48, v6, 5, v59
    v_xor_b32 v6, 7, v58
    v_lshl_add_u32 v35, v6, 5, v7
    v_lshl_add_u32 v49, v6, 5, v59
    s_lshl_b32 s31, s38, 6
    v_add_u32 v36, s31, v1
    s_lshl_b32 s31, s39, 6
    v_add_u32 v37, s31, v1
    v_bfe_u32 v6, v3, 1, 3
    v_and_b32 v7, 1, v3
    v_lshl_add_u32 v58, v2, 4, v57
    v_lshlrev_b32 v58, 13, v58
    v_lshl_add_u32 v58, v7, 4, v58
    s_lshl_b32 s31, s28, 8
    v_add_u32 v58, s31, v58
    v_xor_b32 v6, v6, v57
    v_xor_b32 v7, 0, v6
    v_lshl_add_u32 v7, v7, 5, v58
    v_add_u32 v38, 0, v7
    v_xor_b32 v7, 0, v6
    v_lshl_add_u32 v7, v7, 5, v58
    v_add_u32 v39, 31744, v7
    v_xor_b32 v7, 4, v6
    v_lshl_add_u32 v7, v7, 5, v58
    v_add_u32 v40, 63488, v7
    v_xor_b32 v7, 4, v6
    v_lshl_add_u32 v7, v7, 5, v58
    v_add_u32 v41, 95232, v7
    v_lshlrev_b32 v6, 2, v57
    v_sub_u32 v4, v56, v6
    v_mov_b32 v5, 0xff800000
    v_mov_b32 v8, 0
    v_mov_b32 v9, 1
    s_lshl_b32 s52, s59, 2
    s_add_u32 s52, s52, s30
    v_and_b32 v6, 1, v3
    v_lshl_add_u32 v6, s52, 1, v6
    s_getpc_b64 s[40:41]
pc_4:
    s_add_u32 s40, s40, k12_qcode-pc_4
    s_addc_u32 s41, s41, 0
    v_lshlrev_b32 v2, 7, v6
    v_mov_b32 v3, s41
    v_add_co_u32 v2, vcc, s40, v2
    s_nop 1
    v_addc_co_u32 v3, vcc, 0, v3, vcc
    v_mov_b32 v56, 0
    v_mov_b32 v57, 0
    v_mov_b32 v58, 0
    v_mov_b32 v59, 0
    s_nop 1
    v_mfma_f32_32x32x16_bf16 a[128:143], v[56:59], v[56:59], 0
    v_mfma_f32_32x32x16_bf16 a[144:159], v[56:59], v[56:59], 0
    v_mfma_f32_32x32x16_bf16 a[160:175], v[56:59], v[56:59], 0
    v_mfma_f32_32x32x16_bf16 a[176:191], v[56:59], v[56:59], 0
    v_mfma_f32_32x32x16_bf16 v[128:143], v[56:59], v[56:59], 0
    v_mfma_f32_32x32x16_bf16 v[144:159], v[56:59], v[56:59], 0
    v_mfma_f32_32x32x16_bf16 v[160:175], v[56:59], v[56:59], 0
    v_mfma_f32_32x32x16_bf16 v[176:191], v[56:59], v[56:59], 0
    v_mfma_f32_32x32x16_bf16 v[192:207], v[56:59], v[56:59], 0
    v_mfma_f32_32x32x16_bf16 v[208:223], v[56:59], v[56:59], 0
    v_mfma_f32_32x32x16_bf16 v[224:239], v[56:59], v[56:59], 0
    v_mfma_f32_32x32x16_bf16 v[240:255], v[56:59], v[56:59], 0
    s_waitcnt vmcnt(16)
    v_lshlrev_b32 v80, 16, v64
    v_and_b32 v81, 0xffff0000, v64
    v_lshlrev_b32 v82, 16, v65
    v_and_b32 v83, 0xffff0000, v65
    v_lshlrev_b32 v84, 16, v66
    v_and_b32 v85, 0xffff0000, v66
    v_lshlrev_b32 v86, 16, v67
    v_and_b32 v87, 0xffff0000, v67
    v_lshlrev_b32 v88, 16, v68
    v_and_b32 v89, 0xffff0000, v68
    v_lshlrev_b32 v90, 16, v69
    v_and_b32 v91, 0xffff0000, v69
    v_lshlrev_b32 v92, 16, v70
    v_and_b32 v93, 0xffff0000, v70
    v_lshlrev_b32 v94, 16, v71
    v_and_b32 v95, 0xffff0000, v71
    v_lshlrev_b32 v96, 16, v72
    v_and_b32 v97, 0xffff0000, v72
    v_lshlrev_b32 v98, 16, v73
    v_and_b32 v99, 0xffff0000, v73
    v_lshlrev_b32 v100, 16, v74
    v_and_b32 v101, 0xffff0000, v74
    v_lshlrev_b32 v102, 16, v75
    v_and_b32 v103, 0xffff0000, v75
    v_lshlrev_b32 v104, 16, v76
    v_and_b32 v105, 0xffff0000, v76
    v_lshlrev_b32 v106, 16, v77
    v_and_b32 v107, 0xffff0000, v77
    v_lshlrev_b32 v108, 16, v78
    v_and_b32 v109, 0xffff0000, v78
    v_lshlrev_b32 v110, 16, v79
    v_and_b32 v111, 0xffff0000, v79
    v_pk_add_f32 v[112:113], v[80:81], v[82:83]
    v_pk_add_f32 v[114:115], v[84:85], v[86:87]
    v_pk_add_f32 v[112:113], v[112:113], v[88:89]
    v_pk_add_f32 v[114:115], v[114:115], v[90:91]
    v_pk_add_f32 v[112:113], v[112:113], v[92:93]
    v_pk_add_f32 v[114:115], v[114:115], v[94:95]
    v_pk_add_f32 v[112:113], v[112:113], v[96:97]
    v_pk_add_f32 v[114:115], v[114:115], v[98:99]
    v_pk_add_f32 v[112:113], v[112:113], v[100:101]
    v_pk_add_f32 v[114:115], v[114:115], v[102:103]
    v_pk_add_f32 v[112:113], v[112:113], v[104:105]
    v_pk_add_f32 v[114:115], v[114:115], v[106:107]
    v_pk_add_f32 v[112:113], v[112:113], v[108:109]
    v_pk_add_f32 v[114:115], v[114:115], v[110:111]
    v_pk_add_f32 v[112:113], v[112:113], v[114:115]
    v_add_f32 v112, v112, v113
    s_nop 1
    v_add_f32_dpp v112, v112, v112 quad_perm:[1,0,3,2] row_mask:0xf bank_mask:0xf
    s_nop 1
    v_add_f32_dpp v112, v112, v112 quad_perm:[2,3,0,1] row_mask:0xf bank_mask:0xf
    s_nop 1
    v_add_f32_dpp v112, v112, v112 row_half_mirror row_mask:0xf bank_mask:0xf
    s_nop 1
    v_add_f32_dpp v112, v112, v112 row_mirror row_mask:0xf bank_mask:0xf
    v_mov_b32 v114, v112
    s_nop 1
    v_permlane16_swap_b32 v112, v114
    s_nop 1
    v_add_f32 v112, v112, v114
    v_mul_f32 v112, 0xba800000, v112
    v_mov_b32 v113, v112
    v_pk_add_f32 v[114:115], v[80:81], v[112:113]
    v_pk_add_f32 v[118:119], v[82:83], v[112:113]
    v_pk_mul_f32 v[116:117], v[114:115], v[114:115]
    v_pk_fma_f32 v[116:117], v[118:119], v[118:119], v[116:117]
    v_pk_add_f32 v[114:115], v[84:85], v[112:113]
    v_pk_add_f32 v[118:119], v[86:87], v[112:113]
    v_pk_fma_f32 v[116:117], v[114:115], v[114:115], v[116:117]
    v_pk_fma_f32 v[116:117], v[118:119], v[118:119], v[116:117]
    v_pk_add_f32 v[114:115], v[88:89], v[112:113]
    v_pk_add_f32 v[118:119], v[90:91], v[112:113]
    v_pk_fma_f32 v[116:117], v[114:115], v[114:115], v[116:117]
    v_pk_fma_f32 v[116:117], v[118:119], v[118:119], v[116:117]
    v_pk_add_f32 v[114:115], v[92:93], v[112:113]
    v_pk_add_f32 v[118:119], v[94:95], v[112:113]
    v_pk_fma_f32 v[116:117], v[114:115], v[114:115], v[116:117]
    v_pk_fma_f32 v[116:117], v[118:119], v[118:119], v[116:117]
    v_pk_add_f32 v[114:115], v[96:97], v[112:113]
    v_pk_add_f32 v[118:119], v[98:99], v[112:113]
    v_pk_fma_f32 v[116:117], v[114:115], v[114:115], v[116:117]
    v_pk_fma_f32 v[116:117], v[118:119], v[118:119], v[116:117]
    v_pk_add_f32 v[114:115], v[100:101], v[112:113]
    v_pk_add_f32 v[118:119], v[102:103], v[112:113]
    v_pk_fma_f32 v[116:117], v[114:115], v[114:115], v[116:117]
    v_pk_fma_f32 v[116:117], v[118:119], v[118:119], v[116:117]
    v_pk_add_f32 v[114:115], v[104:105], v[112:113]
    v_pk_add_f32 v[118:119], v[106:107], v[112:113]
    v_pk_fma_f32 v[116:117], v[114:115], v[114:115], v[116:117]
    v_pk_fma_f32 v[116:117], v[118:119], v[118:119], v[116:117]
    v_pk_add_f32 v[114:115], v[108:109], v[112:113]
    v_pk_add_f32 v[118:119], v[110:111], v[112:113]
    v_pk_fma_f32 v[116:117], v[114:115], v[114:115], v[116:117]
    v_pk_fma_f32 v[116:117], v[118:119], v[118:119], v[116:117]
    v_add_f32 v116, v116, v117
    s_nop 1
    v_add_f32_dpp v116, v116, v116 quad_perm:[1,0,3,2] row_mask:0xf bank_mask:0xf
    s_nop 1
    v_add_f32_dpp v116, v116, v116 quad_perm:[2,3,0,1] row_mask:0xf bank_mask:0xf
    s_nop 1
    v_add_f32_dpp v116, v116, v116 row_half_mirror row_mask:0xf bank_mask:0xf
    s_nop 1
    v_add_f32_dpp v116, v116, v116 row_mirror row_mask:0xf bank_mask:0xf
    v_mov_b32 v114, v116
    s_nop 1
    v_permlane16_swap_b32 v116, v114
    s_nop 1
    v_add_f32 v116, v116, v114
    v_mul_f32 v116, 0x3a800000, v116
    v_cvt_pk_bf16_f32 v118, v112, v116
    v_and_b32 v116, 0xffff0000, v118
    v_lshlrev_b32 v118, 16, v118
    v_add_f32 v116, 0x3727c5ac, v116
    v_mov_b32 v119, v118
    v_cvt_pk_bf16_f32 v116, v116, v116
    v_and_b32 v116, 0xffff0000, v116
    v_sqrt_f32 v116, v116
    v_pk_add_f32 v[80:81], v[80:81], v[118:119]
    v_pk_add_f32 v[82:83], v[82:83], v[118:119]
    v_pk_add_f32 v[84:85], v[84:85], v[118:119]
    v_pk_add_f32 v[86:87], v[86:87], v[118:119]
    v_pk_add_f32 v[88:89], v[88:89], v[118:119]
    v_pk_add_f32 v[90:91], v[90:91], v[118:119]
    v_pk_add_f32 v[92:93], v[92:93], v[118:119]
    v_pk_add_f32 v[94:95], v[94:95], v[118:119]
    v_pk_add_f32 v[96:97], v[96:97], v[118:119]
    v_pk_add_f32 v[98:99], v[98:99], v[118:119]
    v_pk_add_f32 v[100:101], v[100:101], v[118:119]
    v_pk_add_f32 v[102:103], v[102:103], v[118:119]
    v_pk_add_f32 v[104:105], v[104:105], v[118:119]
    v_pk_add_f32 v[106:107], v[106:107], v[118:119]
    v_pk_add_f32 v[108:109], v[108:109], v[118:119]
    v_pk_add_f32 v[110:111], v[110:111], v[118:119]
    v_cvt_pk_bf16_f32 v116, v116, v116
    v_and_b32 v116, 0xffff0000, v116
    v_rcp_f32 v116, v116
    v_cvt_pk_bf16_f32 v64, v80, v81
    v_cvt_pk_bf16_f32 v65, v82, v83
    v_cvt_pk_bf16_f32 v66, v84, v85
    v_cvt_pk_bf16_f32 v67, v86, v87
    v_cvt_pk_bf16_f32 v68, v88, v89
    v_cvt_pk_bf16_f32 v69, v90, v91
    v_cvt_pk_bf16_f32 v70, v92, v93
    v_cvt_pk_bf16_f32 v71, v94, v95
    v_cvt_pk_bf16_f32 v72, v96, v97
    v_cvt_pk_bf16_f32 v73, v98, v99
    v_cvt_pk_bf16_f32 v74, v100, v101
    v_cvt_pk_bf16_f32 v75, v102, v103
    v_cvt_pk_bf16_f32 v76, v104, v105
    v_cvt_pk_bf16_f32 v77, v106, v107
    v_cvt_pk_bf16_f32 v78, v108, v109
    v_cvt_pk_bf16_f32 v79, v110, v111
    v_mov_b32 v117, v116
    v_lshlrev_b32 v80, 16, v64
    v_and_b32 v81, 0xffff0000, v64
    v_lshlrev_b32 v82, 16, v65
    v_and_b32 v83, 0xffff0000, v65
    v_lshlrev_b32 v84, 16, v66
    v_and_b32 v85, 0xffff0000, v66
    v_lshlrev_b32 v86, 16, v67
    v_and_b32 v87, 0xffff0000, v67
    v_lshlrev_b32 v88, 16, v68
    v_and_b32 v89, 0xffff0000, v68
    v_lshlrev_b32 v90, 16, v69
    v_and_b32 v91, 0xffff0000, v69
    v_lshlrev_b32 v92, 16, v70
    v_and_b32 v93, 0xffff0000, v70
    v_lshlrev_b32 v94, 16, v71
    v_and_b32 v95, 0xffff0000, v71
    v_lshlrev_b32 v96, 16, v72
    v_and_b32 v97, 0xffff0000, v72
    v_lshlrev_b32 v98, 16, v73
    v_and_b32 v99, 0xffff0000, v73
    v_lshlrev_b32 v100, 16, v74
    v_and_b32 v101, 0xffff0000, v74
    v_lshlrev_b32 v102, 16, v75
    v_and_b32 v103, 0xffff0000, v75
    v_lshlrev_b32 v104, 16, v76
    v_and_b32 v105, 0xffff0000, v76
    v_lshlrev_b32 v106, 16, v77
    v_and_b32 v107, 0xffff0000, v77
    v_lshlrev_b32 v108, 16, v78
    v_and_b32 v109, 0xffff0000, v78
    v_lshlrev_b32 v110, 16, v79
    v_and_b32 v111, 0xffff0000, v79
    v_pk_mul_f32 v[80:81], v[80:81], v[116:117]
    v_pk_mul_f32 v[82:83], v[82:83], v[116:117]
    v_pk_mul_f32 v[84:85], v[84:85], v[116:117]
    v_pk_mul_f32 v[86:87], v[86:87], v[116:117]
    v_pk_mul_f32 v[88:89], v[88:89], v[116:117]
    v_pk_mul_f32 v[90:91], v[90:91], v[116:117]
    v_pk_mul_f32 v[92:93], v[92:93], v[116:117]
    v_pk_mul_f32 v[94:95], v[94:95], v[116:117]
    v_pk_mul_f32 v[96:97], v[96:97], v[116:117]
    v_pk_mul_f32 v[98:99], v[98:99], v[116:117]
    v_pk_mul_f32 v[100:101], v[100:101], v[116:117]
    v_pk_mul_f32 v[102:103], v[102:103], v[116:117]
    v_pk_mul_f32 v[104:105], v[104:105], v[116:117]
    v_pk_mul_f32 v[106:107], v[106:107], v[116:117]
    v_pk_mul_f32 v[108:109], v[108:109], v[116:117]
    v_pk_mul_f32 v[110:111], v[110:111], v[116:117]
    v_cvt_pk_bf16_f32 v64, v80, v81
    v_cvt_pk_bf16_f32 v65, v82, v83
    v_cvt_pk_bf16_f32 v66, v84, v85
    v_cvt_pk_bf16_f32 v67, v86, v87
    v_cvt_pk_bf16_f32 v68, v88, v89
    v_cvt_pk_bf16_f32 v69, v90, v91
    v_cvt_pk_bf16_f32 v70, v92, v93
    v_cvt_pk_bf16_f32 v71, v94, v95
    v_cvt_pk_bf16_f32 v72, v96, v97
    v_cvt_pk_bf16_f32 v73, v98, v99
    v_cvt_pk_bf16_f32 v74, v100, v101
    v_cvt_pk_bf16_f32 v75, v102, v103
    v_cvt_pk_bf16_f32 v76, v104, v105
    v_cvt_pk_bf16_f32 v77, v106, v107
    v_cvt_pk_bf16_f32 v78, v108, v109
    v_cvt_pk_bf16_f32 v79, v110, v111
    ds_write_b128 v54, v[64:67] offset:0
    ds_write_b128 v54, v[68:71] offset:512
    ds_write_b128 v54, v[72:75] offset:1024
    ds_write_b128 v54, v[76:79] offset:1536
    s_add_u32 m0, s48, 32768
    s_nop 0
    buffer_load_dwordx4 v10, s[16:19], s49 offen offset:0 lds
    buffer_load_dwordx4 v11, s[16:19], s49 offen offset:1024 lds
    buffer_load_dwordx4 v12, s[16:19], s49 offen offset:2048 lds
    buffer_load_dwordx4 v13, s[16:19], s49 offen offset:3072 lds
    s_add_u32 m0, s48, 36864
    s_nop 0
    buffer_load_dwordx4 v14, s[16:19], s49 offen offset:0 lds
    buffer_load_dwordx4 v15, s[16:19], s49 offen offset:1024 lds
    buffer_load_dwordx4 v16, s[16:19], s49 offen offset:2048 lds
    buffer_load_dwordx4 v17, s[16:19], s49 offen offset:3072 lds
    s_add_u32 s49, s49, 128
    s_add_u32 m0, s48, 98304
    s_nop 0
    buffer_load_dwordx4 v18, s[20:23], s50 offen offset:0 lds
    buffer_load_dwordx4 v19, s[20:23], s50 offen offset:1024 lds
    buffer_load_dwordx4 v20, s[20:23], s50 offen offset:2048 lds
    buffer_load_dwordx4 v21, s[20:23], s50 offen offset:3072 lds
    s_add_u32 m0, s48, 102400
    s_nop 0
    buffer_load_dwordx4 v22, s[20:23], s50 offen offset:0 lds
    buffer_load_dwordx4 v23, s[20:23], s50 offen offset:1024 lds
    buffer_load_dwordx4 v24, s[20:23], s50 offen offset:2048 lds
    buffer_load_dwordx4 v25, s[20:23], s50 offen offset:3072 lds
    s_add_u32 s50, s50, 0x80000
    s_waitcnt vmcnt(16) lgkmcnt(0)
    s_barrier
    ds_read_b128 a[192:195], v55 offset:0
    ds_read_b128 a[196:199], v55 offset:128
    ds_read_b128 a[200:203], v55 offset:256
    ds_read_b128 a[204:207], v55 offset:384
    v_mfma_f32_32x32x16_bf16 v[64:79], v[56:59], v[56:59], 0
    v_mfma_f32_32x32x16_bf16 v[80:95], v[56:59], v[56:59], 0
    v_mfma_f32_32x32x16_bf16 v[96:111], v[56:59], v[56:59], 0
    v_mfma_f32_32x32x16_bf16 v[112:127], v[56:59], v[56:59], 0
    s_cmp_ge_u32 s2, 17
    s_cbranch_scc1 k12_nostat_5
    s_lshl_b32 s52, s2, 12
    s_add_u32 s52, s52, 0x3800000
    s_mov_b32 s34, -1
    v_lshlrev_b32 v6, 4, v0
    buffer_store_dwordx4 v[56:59], v6, s[32:35], s52 offen sc1
    s_mov_b32 s34, 0x2000000
k12_nostat_5:
    ds_read_b128 a[0:3], v26 offset:0
    ds_read_b64_tr_b16 a[32:33], v28 offset:0
    ds_read_b64_tr_b16 a[34:35], v28 offset:2048
    ds_read_b128 a[4:7], v26 offset:2048
    ds_read_b64_tr_b16 a[36:37], v29 offset:0
    ds_read_b64_tr_b16 a[38:39], v29 offset:2048
    ds_read_b128 a[8:11], v26 offset:4096
    ds_read_b64_tr_b16 a[40:41], v30 offset:0
    ds_read_b64_tr_b16 a[42:43], v30 offset:2048
    ds_read_b128 a[12:15], v26 offset:6144
    ds_read_b64_tr_b16 a[44:45], v31 offset:0
    ds_read_b64_tr_b16 a[46:47], v31 offset:2048
    ds_read_b128 a[16:19], v26 offset:8192
    ds_read_b64_tr_b16 a[48:49], v32 offset:0
    ds_read_b64_tr_b16 a[50:51], v32 offset:2048
    ds_read_b128 a[20:23], v26 offset:10240
    ds_read_b64_tr_b16 a[52:53], v33 offset:0
    ds_read_b64_tr_b16 a[54:55], v33 offset:2048
    ds_read_b128 a[24:27], v26 offset:12288
    ds_read_b64_tr_b16 a[56:57], v34 offset:0
    ds_read_b64_tr_b16 a[58:59], v34 offset:2048
    ds_read_b128 a[28:31], v26 offset:14336
    ds_read_b64_tr_b16 a[60:61], v35 offset:0
    ds_read_b64_tr_b16 a[62:63], v35 offset:2048
    s_mov_b32 s51, 0
    s_waitcnt lgkmcnt(15)
    s_mov_b32 s52, 0
    buffer_store_dwordx4 a[192:195], v53, s[8:11], s52 offen sc1
    s_mov_b32 s52, 262144
    buffer_store_dwordx4 a[196:199], v53, s[8:11], s52 offen sc1
    s_mov_b32 s52, 524288
    buffer_store_dwordx4 a[200:203], v53, s[8:11], s52 offen sc1
    s_mov_b32 s52, 786432
    buffer_store_dwordx4 a[204:207], v53, s[8:11], s52 offen sc1
    s_waitcnt lgkmcnt(0)
    s_cmp_lg_u32 s57, 0
    s_cbranch_scc1 k12_v_6
k12_loop_8:
    v_mfma_f32_16x16x32_bf16 v[64:67], a[32:35], a[0:3], v[64:67]
    ds_read_b128 a[64:67], v27 offset:0
    v_mfma_f32_16x16x32_bf16 v[80:83], a[32:35], a[4:7], v[80:83]
    ds_read_b64_tr_b16 a[96:97], v28 offset:16384
    v_mfma_f32_16x16x32_bf16 v[96:99], a[32:35], a[8:11], v[96:99]
    v_mfma_f32_16x16x32_bf16 v[112:115], a[32:35], a[12:15], v[112:115]
    s_cmp_eq_u32 s51, s46
    s_cbranch_scc1 k12_ool_10
k12_oolret_11:
    v_mfma_f32_16x16x32_bf16 v[128:131], a[32:35], a[16:19], v[128:131]
    ds_read_b64_tr_b16 a[98:99], v28 offset:18432
    v_mfma_f32_16x16x32_bf16 v[144:147], a[32:35], a[20:23], v[144:147]
    ds_read_b128 a[68:71], v27 offset:2048
    v_mfma_f32_16x16x32_bf16 a[128:131], a[32:35], a[24:27], a[128:131]
    v_mfma_f32_16x16x32_bf16 a[160:163], a[32:35], a[28:31], a[160:163]
    ds_read_b64_tr_b16 a[100:101], v29 offset:16384
    v_mfma_f32_16x16x32_bf16 v[160:163], a[36:39], a[0:3], v[160:163]
    v_mfma_f32_16x16x32_bf16 v[176:179], a[36:39], a[4:7], v[176:179]
    ds_read_b64_tr_b16 a[102:103], v29 offset:18432
    v_mfma_f32_16x16x32_bf16 v[192:195], a[36:39], a[8:11], v[192:195]
    v_mfma_f32_16x16x32_bf16 v[208:211], a[36:39], a[12:15], v[208:211]
    ds_read_b128 a[72:75], v27 offset:4096
    v_mfma_f32_16x16x32_bf16 v[224:227], a[36:39], a[16:19], v[224:227]
    v_mfma_f32_16x16x32_bf16 v[240:243], a[36:39], a[20:23], v[240:243]
    v_mfma_f32_16x16x32_bf16 a[132:135], a[36:39], a[24:27], a[132:135]
    ds_read_b64_tr_b16 a[104:105], v30 offset:16384
    v_mfma_f32_16x16x32_bf16 a[164:167], a[36:39], a[28:31], a[164:167]
    v_mfma_f32_16x16x32_bf16 v[68:71], a[40:43], a[0:3], v[68:71]
    ds_read_b64_tr_b16 a[106:107], v30 offset:18432
    v_mfma_f32_16x16x32_bf16 v[84:87], a[40:43], a[4:7], v[84:87]
    v_mfma_f32_16x16x32_bf16 v[100:103], a[40:43], a[8:11], v[100:103]
    ds_read_b128 a[76:79], v27 offset:6144
    v_mfma_f32_16x16x32_bf16 v[116:119], a[40:43], a[12:15], v[116:119]
    v_mfma_f32_16x16x32_bf16 v[132:135], a[40:43], a[16:19], v[132:135]
    ds_read_b64_tr_b16 a[108:109], v31 offset:16384
    v_mfma_f32_16x16x32_bf16 v[148:151], a[40:43], a[20:23], v[148:151]
    v_mfma_f32_16x16x32_bf16 a[136:139], a[40:43], a[24:27], a[136:139]
    ds_read_b64_tr_b16 a[110:111], v31 offset:18432
    v_mfma_f32_16x16x32_bf16 a[168:171], a[40:43], a[28:31], a[168:171]
    v_mfma_f32_16x16x32_bf16 v[164:167], a[44:47], a[0:3], v[164:167]
    ds_read_b128 a[80:83], v27 offset:8192
    v_mfma_f32_16x16x32_bf16 v[180:183], a[44:47], a[4:7], v[180:183]
    v_mfma_f32_16x16x32_bf16 v[196:199], a[44:47], a[8:11], v[196:199]
    ds_read_b64_tr_b16 a[112:113], v32 offset:16384
    v_mfma_f32_16x16x32_bf16 v[212:215], a[44:47], a[12:15], v[212:215]
    v_mfma_f32_16x16x32_bf16 v[228:231], a[44:47], a[16:19], v[228:231]
    ds_read_b64_tr_b16 a[114:115], v32 offset:18432
    v_mfma_f32_16x16x32_bf16 v[244:247], a[44:47], a[20:23], v[244:247]
    v_mfma_f32_16x16x32_bf16 a[140:143], a[44:47], a[24:27], a[140:143]
    ds_read_b128 a[84:87], v27 offset:10240
    v_mfma_f32_16x16x32_bf16 a[172:175], a[44:47], a[28:31], a[172:175]
    v_mfma_f32_16x16x32_bf16 v[72:75], a[48:51], a[0:3], v[72:75]
    ds_read_b64_tr_b16 a[116:117], v33 offset:16384
    v_mfma_f32_16x16x32_bf16 v[88:91], a[48:51], a[4:7], v[88:91]
    v_mfma_f32_16x16x32_bf16 v[104:107], a[48:51], a[8:11], v[104:107]
    ds_read_b64_tr_b16 a[118:119], v33 offset:18432
    v_mfma_f32_16x16x32_bf16 v[120:123], a[48:51], a[12:15], v[120:123]
    v_mfma_f32_16x16x32_bf16 v[136:139], a[48:51], a[16:19], v[136:139]
    ds_read_b128 a[88:91], v27 offset:12288
    v_mfma_f32_16x16x32_bf16 v[152:155], a[48:51], a[20:23], v[152:155]
    v_mfma_f32_16x16x32_bf16 a[144:147], a[48:51], a[24:27], a[144:147]
    v_mfma_f32_16x16x32_bf16 a[176:179], a[48:51], a[28:31], a[176:179]
    ds_read_b64_tr_b16 a[120:121], v34 offset:16384
    v_mfma_f32_16x16x32_bf16 v[168:171], a[52:55], a[0:3], v[168:171]
    v_mfma_f32_16x16x32_bf16 v[184:187], a[52:55], a[4:7], v[184:187]
    ds_read_b64_tr_b16 a[122:123], v34 offset:18432
    v_mfma_f32_16x16x32_bf16 v[200:203], a[52:55], a[8:11], v[200:203]
    v_mfma_f32_16x16x32_bf16 v[216:219], a[52:55], a[12:15], v[216:219]
    ds_read_b128 a[92:95], v27 offset:14336
    v_mfma_f32_16x16x32_bf16 v[232:235], a[52:55], a[16:19], v[232:235]
    v_mfma_f32_16x16x32_bf16 v[248:251], a[52:55], a[20:23], v[248:251]
    ds_read_b64_tr_b16 a[124:125], v35 offset:16384
    v_mfma_f32_16x16x32_bf16 a[148:151], a[52:55], a[24:27], a[148:151]
    v_mfma_f32_16x16x32_bf16 a[180:183], a[52:55], a[28:31], a[180:183]
    ds_read_b64_tr_b16 a[126:127], v35 offset:18432
    v_mfma_f32_16x16x32_bf16 v[76:79], a[56:59], a[0:3], v[76:79]
    v_mfma_f32_16x16x32_bf16 v[92:95], a[56:59], a[4:7], v[92:95]
    v_mfma_f32_16x16x32_bf16 v[108:111], a[56:59], a[8:11], v[108:111]
    v_mfma_f32_16x16x32_bf16 v[124:127], a[56:59], a[12:15], v[124:127]
    v_mfma_f32_16x16x32_bf16 v[140:143], a[56:59], a[16:19], v[140:143]
    v_mfma_f32_16x16x32_bf16 v[156:159], a[56:59], a[20:23], v[156:159]
    v_mfma_f32_16x16x32_bf16 a[152:155], a[56:59], a[24:27], a[152:155]
    v_mfma_f32_16x16x32_bf16 a[184:187], a[56:59], a[28:31], a[184:187]
    v_mfma_f32_16x16x32_bf16 v[172:175], a[60:63], a[0:3], v[172:175]
    v_mfma_f32_16x16x32_bf16 v[188:191], a[60:63], a[4:7], v[188:191]
    v_mfma_f32_16x16x32_bf16 v[204:207], a[60:63], a[8:11], v[204:207]
    v_mfma_f32_16x16x32_bf16 v[220:223], a[60:63], a[12:15], v[220:223]
    v_mfma_f32_16x16x32_bf16 v[236:239], a[60:63], a[16:19], v[236:239]
    v_mfma_f32_16x16x32_bf16 v[252:255], a[60:63], a[20:23], v[252:255]
    v_mfma_f32_16x16x32_bf16 a[156:159], a[60:63], a[24:27], a[156:159]
    v_mfma_f32_16x16x32_bf16 a[188:191], a[60:63], a[28:31], a[188:191]
    s_waitcnt vmcnt(0) lgkmcnt(0)
    s_barrier
    v_mfma_f32_16x16x32_bf16 v[64:67], a[96:99], a[64:67], v[64:67]
    s_cmp_ge_u32 s49, 1024
    s_cselect_b32 s18, 0, s18
    s_cselect_b32 s22, 0, s22
    ds_read_b128 a[0:3], v26 offset:32768
    v_mfma_f32_16x16x32_bf16 v[80:83], a[96:99], a[68:71], v[80:83]
    s_add_u32 m0, s48, 0
    ds_read_b64_tr_b16 a[32:33], v28 offset:32768
    v_mfma_f32_16x16x32_bf16 v[96:99], a[96:99], a[72:75], v[96:99]
    buffer_load_dwordx4 v10, s[16:19], s49 offen offset:0 lds
    v_mfma_f32_16x16x32_bf16 v[112:115], a[96:99], a[76:79], v[112:115]
    ds_read_b64_tr_b16 a[34:35], v28 offset:34816
    v_mfma_f32_16x16x32_bf16 v[128:131], a[96:99], a[80:83], v[128:131]
    buffer_load_dwordx4 v11, s[16:19], s49 offen offset:1024 lds
    v_mfma_f32_16x16x32_bf16 v[144:147], a[96:99], a[84:87], v[144:147]
    ds_read_b128 a[4:7], v26 offset:34816
    v_mfma_f32_16x16x32_bf16 a[128:131], a[96:99], a[88:91], a[128:131]
    v_mfma_f32_16x16x32_bf16 a[160:163], a[96:99], a[92:95], a[160:163]
    ds_read_b64_tr_b16 a[36:37], v29 offset:32768
    v_mfma_f32_16x16x32_bf16 v[160:163], a[100:103], a[64:67], v[160:163]
    buffer_load_dwordx4 v12, s[16:19], s49 offen offset:2048 lds
    v_mfma_f32_16x16x32_bf16 v[176:179], a[100:103], a[68:71], v[176:179]
    ds_read_b64_tr_b16 a[38:39], v29 offset:34816
    v_mfma_f32_16x16x32_bf16 v[192:195], a[100:103], a[72:75], v[192:195]
    v_mfma_f32_16x16x32_bf16 v[208:211], a[100:103], a[76:79], v[208:211]
    buffer_load_dwordx4 v13, s[16:19], s49 offen offset:3072 lds
    ds_read_b128 a[8:11], v26 offset:36864
    v_mfma_f32_16x16x32_bf16 v[224:227], a[100:103], a[80:83], v[224:227]
    v_mfma_f32_16x16x32_bf16 v[240:243], a[100:103], a[84:87], v[240:243]
    s_add_u32 m0, s48, 4096
    v_mfma_f32_16x16x32_bf16 a[132:135], a[100:103], a[88:91], a[132:135]
    ds_read_b64_tr_b16 a[40:41], v30 offset:32768
    v_mfma_f32_16x16x32_bf16 a[164:167], a[100:103], a[92:95], a[164:167]
    buffer_load_dwordx4 v14, s[16:19], s49 offen offset:0 lds
    v_mfma_f32_16x16x32_bf16 v[68:71], a[104:107], a[64:67], v[68:71]
    ds_read_b64_tr_b16 a[42:43], v30 offset:34816
    v_mfma_f32_16x16x32_bf16 v[84:87], a[104:107], a[68:71], v[84:87]
    v_mfma_f32_16x16x32_bf16 v[100:103], a[104:107], a[72:75], v[100:103]
    buffer_load_dwordx4 v15, s[16:19], s49 offen offset:1024 lds
    ds_read_b128 a[12:15], v26 offset:38912
    v_mfma_f32_16x16x32_bf16 v[116:119], a[104:107], a[76:79], v[116:119]
    v_mfma_f32_16x16x32_bf16 v[132:135], a[104:107], a[80:83], v[132:135]
    ds_read_b64_tr_b16 a[44:45], v31 offset:32768
    v_mfma_f32_16x16x32_bf16 v[148:151], a[104:107], a[84:87], v[148:151]
    v_mfma_f32_16x16x32_bf16 a[136:139], a[104:107], a[88:91], a[136:139]
    buffer_load_dwordx4 v16, s[16:19], s49 offen offset:2048 lds
    ds_read_b64_tr_b16 a[46:47], v31 offset:34816
    v_mfma_f32_16x16x32_bf16 a[168:171], a[104:107], a[92:95], a[168:171]
    v_mfma_f32_16x16x32_bf16 v[164:167], a[108:111], a[64:67], v[164:167]
    ds_read_b128 a[16:19], v26 offset:40960
    v_mfma_f32_16x16x32_bf16 v[180:183], a[108:111], a[68:71], v[180:183]
    buffer_load_dwordx4 v17, s[16:19], s49 offen offset:3072 lds
    v_mfma_f32_16x16x32_bf16 v[196:199], a[108:111], a[72:75], v[196:199]
    ds_read_b64_tr_b16 a[48:49], v32 offset:32768
    v_mfma_f32_16x16x32_bf16 v[212:215], a[108:111], a[76:79], v[212:215]
    s_add_u32 s49, s49, 128
    v_mfma_f32_16x16x32_bf16 v[228:231], a[108:111], a[80:83], v[228:231]
    s_add_u32 m0, s48, 65536
    ds_read_b64_tr_b16 a[50:51], v32 offset:34816
    v_mfma_f32_16x16x32_bf16 v[244:247], a[108:111], a[84:87], v[244:247]
    buffer_load_dwordx4 v18, s[20:23], s50 offen offset:0 lds
    v_mfma_f32_16x16x32_bf16 a[140:143], a[108:111], a[88:91], a[140:143]
    ds_read_b128 a[20:23], v26 offset:43008
    v_mfma_f32_16x16x32_bf16 a[172:175], a[108:111], a[92:95], a[172:175]
    v_mfma_f32_16x16x32_bf16 v[72:75], a[112:115], a[64:67], v[72:75]
    buffer_load_dwordx4 v19, s[20:23], s50 offen offset:1024 lds
    ds_read_b64_tr_b16 a[52:53], v33 offset:32768
    v_mfma_f32_16x16x32_bf16 v[88:91], a[112:115], a[68:71], v[88:91]
    v_mfma_f32_16x16x32_bf16 v[104:107], a[112:115], a[72:75], v[104:107]
    ds_read_b64_tr_b16 a[54:55], v33 offset:34816
    v_mfma_f32_16x16x32_bf16 v[120:123], a[112:115], a[76:79], v[120:123]
    buffer_load_dwordx4 v20, s[20:23], s50 offen offset:2048 lds
    v_mfma_f32_16x16x32_bf16 v[136:139], a[112:115], a[80:83], v[136:139]
    ds_read_b128 a[24:27], v26 offset:45056
    v_mfma_f32_16x16x32_bf16 v[152:155], a[112:115], a[84:87], v[152:155]
    v_mfma_f32_16x16x32_bf16 a[144:147], a[112:115], a[88:91], a[144:147]
    v_mfma_f32_16x16x32_bf16 a[176:179], a[112:115], a[92:95], a[176:179]
    buffer_load_dwordx4 v21, s[20:23], s50 offen offset:3072 lds
    ds_read_b64_tr_b16 a[56:57], v34 offset:32768
    v_mfma_f32_16x16x32_bf16 v[168:171], a[116:119], a[64:67], v[168:171]
    s_add_u32 m0, s48, 69632
    v_mfma_f32_16x16x32_bf16 v[184:187], a[116:119], a[68:71], v[184:187]
    ds_read_b64_tr_b16 a[58:59], v34 offset:34816
    v_mfma_f32_16x16x32_bf16 v[200:203], a[116:119], a[72:75], v[200:203]
    buffer_load_dwordx4 v22, s[20:23], s50 offen offset:0 lds
    v_mfma_f32_16x16x32_bf16 v[216:219], a[116:119], a[76:79], v[216:219]
    ds_read_b128 a[28:31], v26 offset:47104
    v_mfma_f32_16x16x32_bf16 v[232:235], a[116:119], a[80:83], v[232:235]
    v_mfma_f32_16x16x32_bf16 v[248:251], a[116:119], a[84:87], v[248:251]
    ds_read_b64_tr_b16 a[60:61], v35 offset:32768
    v_mfma_f32_16x16x32_bf16 a[148:151], a[116:119], a[88:91], a[148:151]
    buffer_load_dwordx4 v23, s[20:23], s50 offen offset:1024 lds
    v_mfma_f32_16x16x32_bf16 a[180:183], a[116:119], a[92:95], a[180:183]
    ds_read_b64_tr_b16 a[62:63], v35 offset:34816
    v_mfma_f32_16x16x32_bf16 v[76:79], a[120:123], a[64:67], v[76:79]
    v_mfma_f32_16x16x32_bf16 v[92:95], a[120:123], a[68:71], v[92:95]
    buffer_load_dwordx4 v24, s[20:23], s50 offen offset:2048 lds
    v_mfma_f32_16x16x32_bf16 v[108:111], a[120:123], a[72:75], v[108:111]
    v_mfma_f32_16x16x32_bf16 v[124:127], a[120:123], a[76:79], v[124:127]
    v_mfma_f32_16x16x32_bf16 v[140:143], a[120:123], a[80:83], v[140:143]
    v_mfma_f32_16x16x32_bf16 v[156:159], a[120:123], a[84:87], v[156:159]
    buffer_load_dwordx4 v25, s[20:23], s50 offen offset:3072 lds
    v_mfma_f32_16x16x32_bf16 a[152:155], a[120:123], a[88:91], a[152:155]
    v_mfma_f32_16x16x32_bf16 a[184:187], a[120:123], a[92:95], a[184:187]
    s_add_u32 s50, s50, 0x80000
    v_mfma_f32_16x16x32_bf16 v[172:175], a[124:127], a[64:67], v[172:175]
    v_mfma_f32_16x16x32_bf16 v[188:191], a[124:127], a[68:71], v[188:191]
    s_cmp_eq_u32 s51, s53
    s_cbranch_scc1 k12_ool_12
k12_oolret_13:
    v_mfma_f32_16x16x32_bf16 v[204:207], a[124:127], a[72:75], v[204:207]
    v_mfma_f32_16x16x32_bf16 v[220:223], a[124:127], a[76:79], v[220:223]
    s_cmp_eq_u32 s51, s63
    s_cbranch_scc1 k12_ool_14
k12_oolret_15:
    v_mfma_f32_16x16x32_bf16 v[236:239], a[124:127], a[80:83], v[236:239]
    v_mfma_f32_16x16x32_bf16 v[252:255], a[124:127], a[84:87], v[252:255]
    s_add_u32 s51, s51, 1
    v_mfma_f32_16x16x32_bf16 a[156:159], a[124:127], a[88:91], a[156:159]
    v_mfma_f32_16x16x32_bf16 a[188:191], a[124:127], a[92:95], a[188:191]
    s_waitcnt lgkmcnt(0)
    v_mfma_f32_16x16x32_bf16 v[64:67], a[32:35], a[0:3], v[64:67]
    ds_read_b128 a[64:67], v27 offset:32768
    v_mfma_f32_16x16x32_bf16 v[80:83], a[32:35], a[4:7], v[80:83]
    ds_read_b64_tr_b16 a[96:97], v28 offset:49152
    v_mfma_f32_16x16x32_bf16 v[96:99], a[32:35], a[8:11], v[96:99]
    v_mfma_f32_16x16x32_bf16 v[112:115], a[32:35], a[12:15], v[112:115]
    ds_read_b64_tr_b16 a[98:99], v28 offset:51200
    v_mfma_f32_16x16x32_bf16 v[128:131], a[32:35], a[16:19], v[128:131]
    v_mfma_f32_16x16x32_bf16 v[144:147], a[32:35], a[20:23], v[144:147]
    ds_read_b128 a[68:71], v27 offset:34816
    v_mfma_f32_16x16x32_bf16 a[128:131], a[32:35], a[24:27], a[128:131]
    v_mfma_f32_16x16x32_bf16 a[160:163], a[32:35], a[28:31], a[160:163]
    ds_read_b64_tr_b16 a[100:101], v29 offset:49152
    v_mfma_f32_16x16x32_bf16 v[160:163], a[36:39], a[0:3], v[160:163]
    v_mfma_f32_16x16x32_bf16 v[176:179], a[36:39], a[4:7], v[176:179]
    ds_read_b64_tr_b16 a[102:103], v29 offset:51200
    v_mfma_f32_16x16x32_bf16 v[192:195], a[36:39], a[8:11], v[192:195]
    v_mfma_f32_16x16x32_bf16 v[208:211], a[36:39], a[12:15], v[208:211]
    ds_read_b128 a[72:75], v27 offset:36864
    v_mfma_f32_16x16x32_bf16 v[224:227], a[36:39], a[16:19], v[224:227]
    v_mfma_f32_16x16x32_bf16 v[240:243], a[36:39], a[20:23], v[240:243]
    v_mfma_f32_16x16x32_bf16 a[132:135], a[36:39], a[24:27], a[132:135]
    ds_read_b64_tr_b16 a[104:105], v30 offset:49152
    v_mfma_f32_16x16x32_bf16 a[164:167], a[36:39], a[28:31], a[164:167]
    v_mfma_f32_16x16x32_bf16 v[68:71], a[40:43], a[0:3], v[68:71]
    ds_read_b64_tr_b16 a[106:107], v30 offset:51200
    v_mfma_f32_16x16x32_bf16 v[84:87], a[40:43], a[4:7], v[84:87]
    v_mfma_f32_16x16x32_bf16 v[100:103], a[40:43], a[8:11], v[100:103]
    ds_read_b128 a[76:79], v27 offset:38912
    v_mfma_f32_16x16x32_bf16 v[116:119], a[40:43], a[12:15], v[116:119]
    v_mfma_f32_16x16x32_bf16 v[132:135], a[40:43], a[16:19], v[132:135]
    ds_read_b64_tr_b16 a[108:109], v31 offset:49152
    v_mfma_f32_16x16x32_bf16 v[148:151], a[40:43], a[20:23], v[148:151]
    v_mfma_f32_16x16x32_bf16 a[136:139], a[40:43], a[24:27], a[136:139]
    ds_read_b64_tr_b16 a[110:111], v31 offset:51200
    v_mfma_f32_16x16x32_bf16 a[168:171], a[40:43], a[28:31], a[168:171]
    v_mfma_f32_16x16x32_bf16 v[164:167], a[44:47], a[0:3], v[164:167]
    ds_read_b128 a[80:83], v27 offset:40960
    v_mfma_f32_16x16x32_bf16 v[180:183], a[44:47], a[4:7], v[180:183]
    v_mfma_f32_16x16x32_bf16 v[196:199], a[44:47], a[8:11], v[196:199]
    ds_read_b64_tr_b16 a[112:113], v32 offset:49152
    v_mfma_f32_16x16x32_bf16 v[212:215], a[44:47], a[12:15], v[212:215]
    v_mfma_f32_16x16x32_bf16 v[228:231], a[44:47], a[16:19], v[228:231]
    ds_read_b64_tr_b16 a[114:115], v32 offset:51200
    v_mfma_f32_16x16x32_bf16 v[244:247], a[44:47], a[20:23], v[244:247]
    v_mfma_f32_16x16x32_bf16 a[140:143], a[44:47], a[24:27], a[140:143]
    ds_read_b128 a[84:87], v27 offset:43008
    v_mfma_f32_16x16x32_bf16 a[172:175], a[44:47], a[28:31], a[172:175]
    v_mfma_f32_16x16x32_bf16 v[72:75], a[48:51], a[0:3], v[72:75]
    ds_read_b64_tr_b16 a[116:117], v33 offset:49152
    v_mfma_f32_16x16x32_bf16 v[88:91], a[48:51], a[4:7], v[88:91]
    v_mfma_f32_16x16x32_bf16 v[104:107], a[48:51], a[8:11], v[104:107]
    ds_read_b64_tr_b16 a[118:119], v33 offset:51200
    v_mfma_f32_16x16x32_bf16 v[120:123], a[48:51], a[12:15], v[120:123]
    v_mfma_f32_16x16x32_bf16 v[136:139], a[48:51], a[16:19], v[136:139]
    ds_read_b128 a[88:91], v27 offset:45056
    v_mfma_f32_16x16x32_bf16 v[152:155], a[48:51], a[20:23], v[152:155]
    v_mfma_f32_16x16x32_bf16 a[144:147], a[48:51], a[24:27], a[144:147]
    v_mfma_f32_16x16x32_bf16 a[176:179], a[48:51], a[28:31], a[176:179]
    ds_read_b64_tr_b16 a[120:121], v34 offset:49152
    v_mfma_f32_16x16x32_bf16 v[168:171], a[52:55], a[0:3], v[168:171]
    v_mfma_f32_16x16x32_bf16 v[184:187], a[52:55], a[4:7], v[184:187]
    ds_read_b64_tr_b16 a[122:123], v34 offset:51200
    v_mfma_f32_16x16x32_bf16 v[200:203], a[52:55], a[8:11], v[200:203]
    v_mfma_f32_16x16x32_bf16 v[216:219], a[52:55], a[12:15], v[216:219]
    ds_read_b128 a[92:95], v27 offset:47104
    v_mfma_f32_16x16x32_bf16 v[232:235], a[52:55], a[16:19], v[232:235]
    v_mfma_f32_16x16x32_bf16 v[248:251], a[52:55], a[20:23], v[248:251]
    ds_read_b64_tr_b16 a[124:125], v35 offset:49152
    v_mfma_f32_16x16x32_bf16 a[148:151], a[52:55], a[24:27], a[148:151]
    v_mfma_f32_16x16x32_bf16 a[180:183], a[52:55], a[28:31], a[180:183]
    ds_read_b64_tr_b16 a[126:127], v35 offset:51200
    v_mfma_f32_16x16x32_bf16 v[76:79], a[56:59], a[0:3], v[76:79]
    v_mfma_f32_16x16x32_bf16 v[92:95], a[56:59], a[4:7], v[92:95]
    v_mfma_f32_16x16x32_bf16 v[108:111], a[56:59], a[8:11], v[108:111]
    v_mfma_f32_16x16x32_bf16 v[124:127], a[56:59], a[12:15], v[124:127]
    v_mfma_f32_16x16x32_bf16 v[140:143], a[56:59], a[16:19], v[140:143]
    v_mfma_f32_16x16x32_bf16 v[156:159], a[56:59], a[20:23], v[156:159]
    v_mfma_f32_16x16x32_bf16 a[152:155], a[56:59], a[24:27], a[152:155]
    v_mfma_f32_16x16x32_bf16 a[184:187], a[56:59], a[28:31], a[184:187]
    s_sub_u32 s52, s51, 1
    s_cmp_eq_u32 s52, s46
    s_cbranch_scc1 k12_ool_18
k12_oolret_19:
    v_mfma_f32_16x16x32_bf16 v[172:175], a[60:63], a[0:3], v[172:175]
    v_mfma_f32_16x16x32_bf16 v[188:191], a[60:63], a[4:7], v[188:191]
    v_mfma_f32_16x16x32_bf16 v[204:207], a[60:63], a[8:11], v[204:207]
    v_mfma_f32_16x16x32_bf16 v[220:223], a[60:63], a[12:15], v[220:223]
    v_mfma_f32_16x16x32_bf16 v[236:239], a[60:63], a[16:19], v[236:239]
    v_mfma_f32_16x16x32_bf16 v[252:255], a[60:63], a[20:23], v[252:255]
    v_mfma_f32_16x16x32_bf16 a[156:159], a[60:63], a[24:27], a[156:159]
    v_mfma_f32_16x16x32_bf16 a[188:191], a[60:63], a[28:31], a[188:191]
    s_waitcnt vmcnt(0) lgkmcnt(0)
    s_barrier
    s_cmp_eq_u32 s51, 7
    s_cbranch_scc1 k12_last_9
    v_mfma_f32_16x16x32_bf16 v[64:67], a[96:99], a[64:67], v[64:67]
    ds_read_b128 a[0:3], v26 offset:0
    v_mfma_f32_16x16x32_bf16 v[80:83], a[96:99], a[68:71], v[80:83]
    s_add_u32 m0, s48, 32768
    ds_read_b64_tr_b16 a[32:33], v28 offset:0
    v_mfma_f32_16x16x32_bf16 v[96:99], a[96:99], a[72:75], v[96:99]
    buffer_load_dwordx4 v10, s[16:19], s49 offen offset:0 lds
    v_mfma_f32_16x16x32_bf16 v[112:115], a[96:99], a[76:79], v[112:115]
    ds_read_b64_tr_b16 a[34:35], v28 offset:2048
    v_mfma_f32_16x16x32_bf16 v[128:131], a[96:99], a[80:83], v[128:131]
    buffer_load_dwordx4 v11, s[16:19], s49 offen offset:1024 lds
    v_mfma_f32_16x16x32_bf16 v[144:147], a[96:99], a[84:87], v[144:147]
    ds_read_b128 a[4:7], v26 offset:2048
    v_mfma_f32_16x16x32_bf16 a[128:131], a[96:99], a[88:91], a[128:131]
    v_mfma_f32_16x16x32_bf16 a[160:163], a[96:99], a[92:95], a[160:163]
    ds_read_b64_tr_b16 a[36:37], v29 offset:0
    v_mfma_f32_16x16x32_bf16 v[160:163], a[100:103], a[64:67], v[160:163]
    buffer_load_dwordx4 v12, s[16:19], s49 offen offset:2048 lds
    v_mfma_f32_16x16x32_bf16 v[176:179], a[100:103], a[68:71], v[176:179]
    ds_read_b64_tr_b16 a[38:39], v29 offset:2048
    v_mfma_f32_16x16x32_bf16 v[192:195], a[100:103], a[72:75], v[192:195]
    v_mfma_f32_16x16x32_bf16 v[208:211], a[100:103], a[76:79], v[208:211]
    buffer_load_dwordx4 v13, s[16:19], s49 offen offset:3072 lds
    ds_read_b128 a[8:11], v26 offset:4096
    v_mfma_f32_16x16x32_bf16 v[224:227], a[100:103], a[80:83], v[224:227]
    v_mfma_f32_16x16x32_bf16 v[240:243], a[100:103], a[84:87], v[240:243]
    s_add_u32 m0, s48, 36864
    v_mfma_f32_16x16x32_bf16 a[132:135], a[100:103], a[88:91], a[132:135]
    ds_read_b64_tr_b16 a[40:41], v30 offset:0
    v_mfma_f32_16x16x32_bf16 a[164:167], a[100:103], a[92:95], a[164:167]
    buffer_load_dwordx4 v14, s[16:19], s49 offen offset:0 lds
    v_mfma_f32_16x16x32_bf16 v[68:71], a[104:107], a[64:67], v[68:71]
    ds_read_b64_tr_b16 a[42:43], v30 offset:2048
    v_mfma_f32_16x16x32_bf16 v[84:87], a[104:107], a[68:71], v[84:87]
    v_mfma_f32_16x16x32_bf16 v[100:103], a[104:107], a[72:75], v[100:103]
    buffer_load_dwordx4 v15, s[16:19], s49 offen offset:1024 lds
    ds_read_b128 a[12:15], v26 offset:6144
    v_mfma_f32_16x16x32_bf16 v[116:119], a[104:107], a[76:79], v[116:119]
    v_mfma_f32_16x16x32_bf16 v[132:135], a[104:107], a[80:83], v[132:135]
    ds_read_b64_tr_b16 a[44:45], v31 offset:0
    v_mfma_f32_16x16x32_bf16 v[148:151], a[104:107], a[84:87], v[148:151]
    v_mfma_f32_16x16x32_bf16 a[136:139], a[104:107], a[88:91], a[136:139]
    buffer_load_dwordx4 v16, s[16:19], s49 offen offset:2048 lds
    ds_read_b64_tr_b16 a[46:47], v31 offset:2048
    v_mfma_f32_16x16x32_bf16 a[168:171], a[104:107], a[92:95], a[168:171]
    v_mfma_f32_16x16x32_bf16 v[164:167], a[108:111], a[64:67], v[164:167]
    ds_read_b128 a[16:19], v26 offset:8192
    v_mfma_f32_16x16x32_bf16 v[180:183], a[108:111], a[68:71], v[180:183]
    buffer_load_dwordx4 v17, s[16:19], s49 offen offset:3072 lds
    v_mfma_f32_16x16x32_bf16 v[196:199], a[108:111], a[72:75], v[196:199]
    ds_read_b64_tr_b16 a[48:49], v32 offset:0
    v_mfma_f32_16x16x32_bf16 v[212:215], a[108:111], a[76:79], v[212:215]
    s_add_u32 s49, s49, 128
    v_mfma_f32_16x16x32_bf16 v[228:231], a[108:111], a[80:83], v[228:231]
    s_add_u32 m0, s48, 98304
    ds_read_b64_tr_b16 a[50:51], v32 offset:2048
    v_mfma_f32_16x16x32_bf16 v[244:247], a[108:111], a[84:87], v[244:247]
    buffer_load_dwordx4 v18, s[20:23], s50 offen offset:0 lds
    v_mfma_f32_16x16x32_bf16 a[140:143], a[108:111], a[88:91], a[140:143]
    ds_read_b128 a[20:23], v26 offset:10240
    v_mfma_f32_16x16x32_bf16 a[172:175], a[108:111], a[92:95], a[172:175]
    v_mfma_f32_16x16x32_bf16 v[72:75], a[112:115], a[64:67], v[72:75]
    buffer_load_dwordx4 v19, s[20:23], s50 offen offset:1024 lds
    ds_read_b64_tr_b16 a[52:53], v33 offset:0
    v_mfma_f32_16x16x32_bf16 v[88:91], a[112:115], a[68:71], v[88:91]
    v_mfma_f32_16x16x32_bf16 v[104:107], a[112:115], a[72:75], v[104:107]
    ds_read_b64_tr_b16 a[54:55], v33 offset:2048
    v_mfma_f32_16x16x32_bf16 v[120:123], a[112:115], a[76:79], v[120:123]
    buffer_load_dwordx4 v20, s[20:23], s50 offen offset:2048 lds
    v_mfma_f32_16x16x32_bf16 v[136:139], a[112:115], a[80:83], v[136:139]
    ds_read_b128 a[24:27], v26 offset:12288
    v_mfma_f32_16x16x32_bf16 v[152:155], a[112:115], a[84:87], v[152:155]
    v_mfma_f32_16x16x32_bf16 a[144:147], a[112:115], a[88:91], a[144:147]
    v_mfma_f32_16x16x32_bf16 a[176:179], a[112:115], a[92:95], a[176:179]
    buffer_load_dwordx4 v21, s[20:23], s50 offen offset:3072 lds
    ds_read_b64_tr_b16 a[56:57], v34 offset:0
    v_mfma_f32_16x16x32_bf16 v[168:171], a[116:119], a[64:67], v[168:171]
    s_add_u32 m0, s48, 102400
    v_mfma_f32_16x16x32_bf16 v[184:187], a[116:119], a[68:71], v[184:187]
    ds_read_b64_tr_b16 a[58:59], v34 offset:2048
    v_mfma_f32_16x16x32_bf16 v[200:203], a[116:119], a[72:75], v[200:203]
    buffer_load_dwordx4 v22, s[20:23], s50 offen offset:0 lds
    v_mfma_f32_16x16x32_bf16 v[216:219], a[116:119], a[76:79], v[216:219]
    ds_read_b128 a[28:31], v26 offset:14336
    v_mfma_f32_16x16x32_bf16 v[232:235], a[116:119], a[80:83], v[232:235]
    v_mfma_f32_16x16x32_bf16 v[248:251], a[116:119], a[84:87], v[248:251]
    ds_read_b64_tr_b16 a[60:61], v35 offset:0
    v_mfma_f32_16x16x32_bf16 a[148:151], a[116:119], a[88:91], a[148:151]
    buffer_load_dwordx4 v23, s[20:23], s50 offen offset:1024 lds
    v_mfma_f32_16x16x32_bf16 a[180:183], a[116:119], a[92:95], a[180:183]
    ds_read_b64_tr_b16 a[62:63], v35 offset:2048
    v_mfma_f32_16x16x32_bf16 v[76:79], a[120:123], a[64:67], v[76:79]
    v_mfma_f32_16x16x32_bf16 v[92:95], a[120:123], a[68:71], v[92:95]
    buffer_load_dwordx4 v24, s[20:23], s50 offen offset:2048 lds
    v_mfma_f32_16x16x32_bf16 v[108:111], a[120:123], a[72:75], v[108:111]
    v_mfma_f32_16x16x32_bf16 v[124:127], a[120:123], a[76:79], v[124:127]
    v_mfma_f32_16x16x32_bf16 v[140:143], a[120:123], a[80:83], v[140:143]
    v_mfma_f32_16x16x32_bf16 v[156:159], a[120:123], a[84:87], v[156:159]
    buffer_load_dwordx4 v25, s[20:23], s50 offen offset:3072 lds
    v_mfma_f32_16x16x32_bf16 a[152:155], a[120:123], a[88:91], a[152:155]
    v_mfma_f32_16x16x32_bf16 a[184:187], a[120:123], a[92:95], a[184:187]
    s_add_u32 s50, s50, 0x80000
    v_mfma_f32_16x16x32_bf16 v[172:175], a[124:127], a[64:67], v[172:175]
    v_mfma_f32_16x16x32_bf16 v[188:191], a[124:127], a[68:71], v[188:191]
    s_cmp_eq_u32 s51, s53
    s_cbranch_scc1 k12_ool_20
k12_oolret_21:
    v_mfma_f32_16x16x32_bf16 v[204:207], a[124:127], a[72:75], v[204:207]
    v_mfma_f32_16x16x32_bf16 v[220:223], a[124:127], a[76:79], v[220:223]
    s_cmp_eq_u32 s51, 5
    s_cbranch_scc1 k12_ool_22
k12_oolret_23:
    v_mfma_f32_16x16x32_bf16 v[236:239], a[124:127], a[80:83], v[236:239]
    v_mfma_f32_16x16x32_bf16 v[252:255], a[124:127], a[84:87], v[252:255]
    s_add_u32 s51, s51, 1
    v_mfma_f32_16x16x32_bf16 a[156:159], a[124:127], a[88:91], a[156:159]
    v_mfma_f32_16x16x32_bf16 a[188:191], a[124:127], a[92:95], a[188:191]
    s_waitcnt lgkmcnt(0)
    s_branch k12_loop_8
k12_last_9:
    v_mfma_f32_16x16x32_bf16 v[64:67], a[96:99], a[64:67], v[64:67]
    s_add_u32 m0, s60, 98304
    v_mfma_f32_16x16x32_bf16 v[160:163], a[100:103], a[64:67], v[160:163]
    buffer_load_dwordx4 v38, s[12:15], s61 offen offset:0 lds
    v_mfma_f32_16x16x32_bf16 v[68:71], a[104:107], a[64:67], v[68:71]
    buffer_load_dwordx4 v39, s[12:15], s61 offen offset:1024 lds
    v_mfma_f32_16x16x32_bf16 v[164:167], a[108:111], a[64:67], v[164:167]
    v_mfma_f32_16x16x32_bf16 v[72:75], a[112:115], a[64:67], v[72:75]
    buffer_load_dwordx4 v40, s[12:15], s61 offen offset:2048 lds
    v_mfma_f32_16x16x32_bf16 v[168:171], a[116:119], a[64:67], v[168:171]
    v_cvt_pk_bf16_f32 v64, v64, v65
    v_cvt_pk_bf16_f32 v65, v66, v67
    v_cvt_pk_bf16_f32 v66, v160, v161
    v_mfma_f32_16x16x32_bf16 v[76:79], a[120:123], a[64:67], v[76:79]
    v_cvt_pk_bf16_f32 v67, v162, v163
    v_mfma_f32_16x16x32_bf16 v[172:175], a[124:127], a[64:67], v[172:175]
    v_cvt_pk_bf16_f32 v68, v68, v69
    v_cvt_pk_bf16_f32 v69, v70, v71
    v_cvt_pk_bf16_f32 v70, v164, v165
    v_mfma_f32_16x16x32_bf16 v[80:83], a[96:99], a[68:71], v[80:83]
    buffer_load_dwordx4 v41, s[12:15], s61 offen offset:3072 lds
    v_mfma_f32_16x16x32_bf16 v[176:179], a[100:103], a[68:71], v[176:179]
    s_add_u32 s61, s61, 0x80000
    v_cvt_pk_bf16_f32 v71, v166, v167
    v_cvt_pk_bf16_f32 v72, v72, v73
    v_cvt_pk_bf16_f32 v73, v74, v75
    v_mfma_f32_16x16x32_bf16 v[84:87], a[104:107], a[68:71], v[84:87]
    buffer_load_dwordx4 a[192:195], v36, s[8:11], s62 offen offset:0 sc1
    buffer_load_dwordx4 a[196:199], v36, s[8:11], s62 offen offset:1024 sc1
    v_mfma_f32_16x16x32_bf16 v[180:183], a[108:111], a[68:71], v[180:183]
    v_cvt_pk_bf16_f32 v74, v168, v169
    v_cvt_pk_bf16_f32 v75, v170, v171
    v_cvt_pk_bf16_f32 v76, v76, v77
    v_mfma_f32_16x16x32_bf16 v[88:91], a[112:115], a[68:71], v[88:91]
    v_cvt_pk_bf16_f32 v77, v78, v79
    v_cvt_pk_bf16_f32 v78, v172, v173
    v_cvt_pk_bf16_f32 v79, v174, v175
    v_mfma_f32_16x16x32_bf16 v[184:187], a[116:119], a[68:71], v[184:187]
    v_cvt_pk_bf16_f32 v80, v80, v81
    v_cvt_pk_bf16_f32 v81, v82, v83
    v_cvt_pk_bf16_f32 v82, v176, v177
    v_mfma_f32_16x16x32_bf16 v[92:95], a[120:123], a[68:71], v[92:95]
    buffer_load_dwordx4 a[200:203], v37, s[8:11], s62 offen offset:0 sc1
    buffer_load_dwordx4 a[204:207], v37, s[8:11], s62 offen offset:1024 sc1
    v_mfma_f32_16x16x32_bf16 v[188:191], a[124:127], a[68:71], v[188:191]
    s_add_u32 s62, s62, 0x20000
    v_cvt_pk_bf16_f32 v83, v178, v179
    v_cvt_pk_bf16_f32 v84, v84, v85
    v_cvt_pk_bf16_f32 v85, v86, v87
    v_mfma_f32_16x16x32_bf16 a[128:131], a[96:99], a[88:91], a[128:131]
    v_cvt_pk_bf16_f32 v86, v180, v181
    v_cvt_pk_bf16_f32 v87, v182, v183
    v_mfma_f32_16x16x32_bf16 a[132:135], a[100:103], a[88:91], a[132:135]
    v_cvt_pk_bf16_f32 v88, v88, v89
    v_cvt_pk_bf16_f32 v89, v90, v91
    v_cvt_pk_bf16_f32 v90, v184, v185
    v_mfma_f32_16x16x32_bf16 v[96:99], a[96:99], a[72:75], v[96:99]
    buffer_load_dwordx4 a[208:211], v36, s[8:11], s62 offen offset:0 sc1
    buffer_load_dwordx4 a[212:215], v36, s[8:11], s62 offen offset:1024 sc1
    v_mfma_f32_16x16x32_bf16 v[192:195], a[100:103], a[72:75], v[192:195]
    v_cvt_pk_bf16_f32 v91, v186, v187
    v_cvt_pk_bf16_f32 v92, v92, v93
    v_cvt_pk_bf16_f32 v93, v94, v95
    v_mfma_f32_16x16x32_bf16 v[100:103], a[104:107], a[72:75], v[100:103]
    v_cvt_pk_bf16_f32 v94, v188, v189
    v_cvt_pk_bf16_f32 v95, v190, v191
    v_mfma_f32_16x16x32_bf16 v[196:199], a[108:111], a[72:75], v[196:199]
    v_accvgpr_read_b32 v56, a128
    v_accvgpr_read_b32 v57, a129
    v_accvgpr_read_b32 v58, a130
    v_mfma_f32_16x16x32_bf16 a[136:139], a[104:107], a[88:91], a[136:139]
    buffer_load_dwordx4 a[216:219], v37, s[8:11], s62 offen offset:0 sc1
    buffer_load_dwordx4 a[220:223], v37, s[8:11], s62 offen offset:1024 sc1
    v_mfma_f32_16x16x32_bf16 a[140:143], a[108:111], a[88:91], a[140:143]
    s_add_u32 s62, s62, 0x20000
    v_accvgpr_read_b32 v59, a131
    v_accvgpr_read_b32 v60, a132
    v_cvt_pk_bf16_f32 v96, v96, v97
    v_mfma_f32_16x16x32_bf16 v[104:107], a[112:115], a[72:75], v[104:107]
    s_add_u32 m0, s60, 114688
    v_accvgpr_read_b32 v61, a133
    v_accvgpr_read_b32 v62, a134
    v_cvt_pk_bf16_f32 v97, v98, v99
    v_mfma_f32_16x16x32_bf16 v[200:203], a[116:119], a[72:75], v[200:203]
    v_accvgpr_read_b32 v63, a135
    v_cvt_pk_bf16_f32 v98, v192, v193
    v_cvt_pk_bf16_f32 v160, v56, v57
    v_mfma_f32_16x16x32_bf16 v[108:111], a[120:123], a[72:75], v[108:111]
    v_cvt_pk_bf16_f32 v99, v194, v195
    v_cvt_pk_bf16_f32 v161, v58, v59
    v_cvt_pk_bf16_f32 v100, v100, v101
    v_mfma_f32_16x16x32_bf16 v[204:207], a[124:127], a[72:75], v[204:207]
    buffer_load_dwordx4 v38, s[12:15], s61 offen offset:0 lds
    buffer_load_dwordx4 v39, s[12:15], s61 offen offset:1024 lds
    v_mfma_f32_16x16x32_bf16 a[144:147], a[112:115], a[88:91], a[144:147]
    v_cvt_pk_bf16_f32 v162, v60, v61
    v_cvt_pk_bf16_f32 v101, v102, v103
    v_cvt_pk_bf16_f32 v163, v62, v63
    v_mfma_f32_16x16x32_bf16 a[148:151], a[116:119], a[88:91], a[148:151]
    v_cvt_pk_bf16_f32 v102, v196, v197
    v_cvt_pk_bf16_f32 v103, v198, v199
    v_accvgpr_read_b32 v56, a136
    v_mfma_f32_16x16x32_bf16 v[112:115], a[96:99], a[76:79], v[112:115]
    v_accvgpr_read_b32 v57, a137
    v_accvgpr_read_b32 v58, a138
    v_accvgpr_read_b32 v59, a139
    v_mfma_f32_16x16x32_bf16 v[208:211], a[100:103], a[76:79], v[208:211]
    v_accvgpr_read_b32 v60, a140
    v_cvt_pk_bf16_f32 v104, v104, v105
    v_accvgpr_read_b32 v61, a141
    v_mfma_f32_16x16x32_bf16 v[116:119], a[104:107], a[76:79], v[116:119]
    buffer_load_dwordx4 v40, s[12:15], s61 offen offset:2048 lds
    buffer_load_dwordx4 v41, s[12:15], s61 offen offset:3072 lds
    v_mfma_f32_16x16x32_bf16 v[212:215], a[108:111], a[76:79], v[212:215]
    s_add_u32 s61, s61, 0x80000
    v_accvgpr_read_b32 v62, a142
    v_cvt_pk_bf16_f32 v105, v106, v107
    v_accvgpr_read_b32 v63, a143
    v_mfma_f32_16x16x32_bf16 a[152:155], a[120:123], a[88:91], a[152:155]
    v_cvt_pk_bf16_f32 v106, v200, v201
    v_cvt_pk_bf16_f32 v164, v56, v57
    v_cvt_pk_bf16_f32 v107, v202, v203
    v_mfma_f32_16x16x32_bf16 a[156:159], a[124:127], a[88:91], a[156:159]
    v_cvt_pk_bf16_f32 v165, v58, v59
    v_cvt_pk_bf16_f32 v108, v108, v109
    v_cvt_pk_bf16_f32 v166, v60, v61
    v_mfma_f32_16x16x32_bf16 v[120:123], a[112:115], a[76:79], v[120:123]
    v_cvt_pk_bf16_f32 v109, v110, v111
    v_cvt_pk_bf16_f32 v167, v62, v63
    v_cvt_pk_bf16_f32 v110, v204, v205
    v_mfma_f32_16x16x32_bf16 v[216:219], a[116:119], a[76:79], v[216:219]
    buffer_load_dwordx4 a[224:227], v36, s[8:11], s62 offen offset:0 sc1
    v_cvt_pk_bf16_f32 v111, v206, v207
    v_accvgpr_read_b32 v56, a144
    v_mfma_f32_16x16x32_bf16 v[124:127], a[120:123], a[76:79], v[124:127]
    v_accvgpr_read_b32 v57, a145
    v_accvgpr_read_b32 v58, a146
    v_accvgpr_read_b32 v59, a147
    v_mfma_f32_16x16x32_bf16 v[220:223], a[124:127], a[76:79], v[220:223]
    buffer_load_dwordx4 a[228:231], v36, s[8:11], s62 offen offset:1024 sc1
    v_accvgpr_read_b32 v60, a148
    v_cvt_pk_bf16_f32 v112, v112, v113
    v_mfma_f32_16x16x32_bf16 a[160:163], a[96:99], a[92:95], a[160:163]
    v_accvgpr_read_b32 v61, a149
    v_accvgpr_read_b32 v62, a150
    v_cvt_pk_bf16_f32 v113, v114, v115
    v_mfma_f32_16x16x32_bf16 a[164:167], a[100:103], a[92:95], a[164:167]
    v_accvgpr_read_b32 v63, a151
    v_cvt_pk_bf16_f32 v114, v208, v209
    v_cvt_pk_bf16_f32 v168, v56, v57
    v_mfma_f32_16x16x32_bf16 v[128:131], a[96:99], a[80:83], v[128:131]
    v_cvt_pk_bf16_f32 v115, v210, v211
    v_cvt_pk_bf16_f32 v169, v58, v59
    v_cvt_pk_bf16_f32 v116, v116, v117
    v_mfma_f32_16x16x32_bf16 v[224:227], a[100:103], a[80:83], v[224:227]
    buffer_load_dwordx4 a[232:235], v37, s[8:11], s62 offen offset:0 sc1
    v_cvt_pk_bf16_f32 v170, v60, v61
    v_cvt_pk_bf16_f32 v117, v118, v119
    v_mfma_f32_16x16x32_bf16 v[132:135], a[104:107], a[80:83], v[132:135]
    v_cvt_pk_bf16_f32 v171, v62, v63
    v_cvt_pk_bf16_f32 v118, v212, v213
    v_cvt_pk_bf16_f32 v119, v214, v215
    v_mfma_f32_16x16x32_bf16 v[228:231], a[108:111], a[80:83], v[228:231]
    buffer_load_dwordx4 a[236:239], v37, s[8:11], s62 offen offset:1024 sc1
    v_accvgpr_read_b32 v56, a152
    v_accvgpr_read_b32 v57, a153
    v_mfma_f32_16x16x32_bf16 a[168:171], a[104:107], a[92:95], a[168:171]
    s_add_u32 s62, s62, 0x20000
    v_accvgpr_read_b32 v58, a154
    v_accvgpr_read_b32 v59, a155
    v_accvgpr_read_b32 v60, a156
    v_mfma_f32_16x16x32_bf16 a[172:175], a[108:111], a[92:95], a[172:175]
    s_waitcnt vmcnt(16)
    s_barrier
    v_cvt_pk_bf16_f32 v120, v120, v121
    v_accvgpr_read_b32 v61, a157
    v_accvgpr_read_b32 v62, a158
    v_mfma_f32_16x16x32_bf16 v[136:139], a[112:115], a[80:83], v[136:139]
    v_cvt_pk_bf16_f32 v121, v122, v123
    v_accvgpr_read_b32 v63, a159
    v_cvt_pk_bf16_f32 v122, v216, v217
    v_mfma_f32_16x16x32_bf16 v[232:235], a[116:119], a[80:83], v[232:235]
    v_cvt_pk_bf16_f32 v172, v56, v57
    v_cvt_pk_bf16_f32 v123, v218, v219
    v_cvt_pk_bf16_f32 v173, v58, v59
    v_mfma_f32_16x16x32_bf16 v[140:143], a[120:123], a[80:83], v[140:143]
    v_cvt_pk_bf16_f32 v124, v124, v125
    v_cvt_pk_bf16_f32 v174, v60, v61
    v_cvt_pk_bf16_f32 v125, v126, v127
    v_mfma_f32_16x16x32_bf16 v[236:239], a[124:127], a[80:83], v[236:239]
    v_cvt_pk_bf16_f32 v175, v62, v63
    v_cvt_pk_bf16_f32 v126, v220, v221
    v_cvt_pk_bf16_f32 v127, v222, v223
    v_mfma_f32_16x16x32_bf16 a[176:179], a[112:115], a[92:95], a[176:179]
    ds_read_b64_tr_b16 a[0:1], v42 offset:0
    v_accvgpr_read_b32 v56, a160
    v_accvgpr_read_b32 v57, a161
    v_mfma_f32_16x16x32_bf16 a[180:183], a[116:119], a[92:95], a[180:183]
    ds_read_b64_tr_b16 a[2:3], v42 offset:1024
    v_accvgpr_read_b32 v58, a162
    v_accvgpr_read_b32 v59, a163
    v_mfma_f32_16x16x32_bf16 v[144:147], a[96:99], a[84:87], v[144:147]
    ds_read_b64_tr_b16 a[4:5], v43 offset:0
    v_accvgpr_read_b32 v60, a164
    v_cvt_pk_bf16_f32 v128, v128, v129
    v_mfma_f32_16x16x32_bf16 v[240:243], a[100:103], a[84:87], v[240:243]
    v_accvgpr_read_b32 v61, a165
    v_accvgpr_read_b32 v62, a166
    v_cvt_pk_bf16_f32 v129, v130, v131
    v_mfma_f32_16x16x32_bf16 v[148:151], a[104:107], a[84:87], v[148:151]
    ds_read_b64_tr_b16 a[6:7], v43 offset:1024
    v_accvgpr_read_b32 v63, a167
    v_cvt_pk_bf16_f32 v130, v224, v225
    v_mfma_f32_16x16x32_bf16 v[244:247], a[108:111], a[84:87], v[244:247]
    v_cvt_pk_bf16_f32 v176, v56, v57
    v_cvt_pk_bf16_f32 v131, v226, v227
    v_cvt_pk_bf16_f32 v177, v58, v59
    v_mfma_f32_16x16x32_bf16 a[184:187], a[120:123], a[92:95], a[184:187]
    ds_read_b64_tr_b16 a[8:9], v44 offset:0
    v_cvt_pk_bf16_f32 v132, v132, v133
    v_cvt_pk_bf16_f32 v178, v60, v61
    v_mfma_f32_16x16x32_bf16 a[188:191], a[124:127], a[92:95], a[188:191]
    ds_read_b64_tr_b16 a[10:11], v44 offset:1024
    v_cvt_pk_bf16_f32 v133, v134, v135
    v_cvt_pk_bf16_f32 v179, v62, v63
    v_mfma_f32_16x16x32_bf16 v[152:155], a[112:115], a[84:87], v[152:155]
    ds_read_b64_tr_b16 a[12:13], v45 offset:0
    v_cvt_pk_bf16_f32 v134, v228, v229
    v_cvt_pk_bf16_f32 v135, v230, v231
    v_mfma_f32_16x16x32_bf16 v[248:251], a[116:119], a[84:87], v[248:251]
    ds_read_b64_tr_b16 a[14:15], v45 offset:1024
    v_accvgpr_read_b32 v56, a168
    v_accvgpr_read_b32 v57, a169
    v_mfma_f32_16x16x32_bf16 v[156:159], a[120:123], a[84:87], v[156:159]
    ds_read_b64_tr_b16 a[16:17], v46 offset:0
    v_accvgpr_read_b32 v58, a170
    v_accvgpr_read_b32 v59, a171
    v_mfma_f32_16x16x32_bf16 v[252:255], a[124:127], a[84:87], v[252:255]
    v_accvgpr_read_b32 v60, a172
    v_cvt_pk_bf16_f32 v136, v136, v137
    v_accvgpr_read_b32 v61, a173
    ds_read_b64_tr_b16 a[18:19], v46 offset:1024
    v_accvgpr_read_b32 v62, a174
    v_cvt_pk_bf16_f32 v137, v138, v139
    v_accvgpr_read_b32 v63, a175
    v_cvt_pk_bf16_f32 v138, v232, v233
    v_cvt_pk_bf16_f32 v180, v56, v57
    ds_read_b64_tr_b16 a[20:21], v47 offset:0
    v_cvt_pk_bf16_f32 v139, v234, v235
    v_cvt_pk_bf16_f32 v181, v58, v59
    v_cvt_pk_bf16_f32 v140, v140, v141
    v_cvt_pk_bf16_f32 v182, v60, v61
    ds_read_b64_tr_b16 a[22:23], v47 offset:1024
    v_cvt_pk_bf16_f32 v141, v142, v143
    v_cvt_pk_bf16_f32 v183, v62, v63
    v_cvt_pk_bf16_f32 v142, v236, v237
    ds_read_b64_tr_b16 a[24:25], v48 offset:0
    v_cvt_pk_bf16_f32 v143, v238, v239
    v_accvgpr_read_b32 v56, a176
    ds_read_b64_tr_b16 a[26:27], v48 offset:1024
    v_accvgpr_read_b32 v57, a177
    v_accvgpr_read_b32 v58, a178
    ds_read_b64_tr_b16 a[28:29], v49 offset:0
    v_accvgpr_read_b32 v59, a179
    v_accvgpr_read_b32 v60, a180
    v_cvt_pk_bf16_f32 v144, v144, v145
    ds_read_b64_tr_b16 a[30:31], v49 offset:1024
    v_accvgpr_read_b32 v61, a181
    v_accvgpr_read_b32 v62, a182
    v_cvt_pk_bf16_f32 v145, v146, v147
    v_accvgpr_read_b32 v63, a183
    v_cvt_pk_bf16_f32 v146, v240, v241
    v_cvt_pk_bf16_f32 v184, v56, v57
    v_cvt_pk_bf16_f32 v147, v242, v243
    v_cvt_pk_bf16_f32 v185, v58, v59
    v_cvt_pk_bf16_f32 v148, v148, v149
    v_cvt_pk_bf16_f32 v186, v60, v61
    v_cvt_pk_bf16_f32 v149, v150, v151
    v_cvt_pk_bf16_f32 v187, v62, v63
    v_cvt_pk_bf16_f32 v150, v244, v245
    v_cvt_pk_bf16_f32 v151, v246, v247
    v_accvgpr_read_b32 v56, a184
    v_accvgpr_read_b32 v57, a185
    v_accvgpr_read_b32 v58, a186
    v_accvgpr_read_b32 v59, a187
    v_accvgpr_read_b32 v60, a188
    v_cvt_pk_bf16_f32 v152, v152, v153
    v_accvgpr_read_b32 v61, a189
    v_accvgpr_read_b32 v62, a190
    v_cvt_pk_bf16_f32 v153, v154, v155
    v_accvgpr_read_b32 v63, a191
    v_cvt_pk_bf16_f32 v154, v248, v249
    v_cvt_pk_bf16_f32 v188, v56, v57
    v_cvt_pk_bf16_f32 v155, v250, v251
    v_cvt_pk_bf16_f32 v189, v58, v59
    v_cvt_pk_bf16_f32 v156, v156, v157
    v_cvt_pk_bf16_f32 v190, v60, v61
    v_cvt_pk_bf16_f32 v157, v158, v159
    v_cvt_pk_bf16_f32 v191, v62, v63
    v_cvt_pk_bf16_f32 v158, v252, v253
    v_cvt_pk_bf16_f32 v159, v254, v255
    s_branch k12_join_7
k12_v_6:
k12_loop_24:
    v_mfma_f32_16x16x32_bf16 v[64:67], a[0:3], a[32:35], v[64:67]
    ds_read_b128 a[64:67], v27 offset:0
    v_mfma_f32_16x16x32_bf16 v[68:71], a[0:3], a[36:39], v[68:71]
    ds_read_b64_tr_b16 a[96:97], v28 offset:16384
    v_mfma_f32_16x16x32_bf16 v[72:75], a[0:3], a[40:43], v[72:75]
    v_mfma_f32_16x16x32_bf16 v[76:79], a[0:3], a[44:47], v[76:79]
    s_cmp_eq_u32 s51, s46
    s_cbranch_scc1 k12_ool_26
k12_oolret_27:
    v_mfma_f32_16x16x32_bf16 v[80:83], a[0:3], a[48:51], v[80:83]
    ds_read_b64_tr_b16 a[98:99], v28 offset:18432
    v_mfma_f32_16x16x32_bf16 v[84:87], a[0:3], a[52:55], v[84:87]
    ds_read_b128 a[68:71], v27 offset:2048
    v_mfma_f32_16x16x32_bf16 v[88:91], a[0:3], a[56:59], v[88:91]
    v_mfma_f32_16x16x32_bf16 v[92:95], a[0:3], a[60:63], v[92:95]
    ds_read_b64_tr_b16 a[100:101], v29 offset:16384
    v_mfma_f32_16x16x32_bf16 v[160:163], a[4:7], a[32:35], v[160:163]
    v_mfma_f32_16x16x32_bf16 v[164:167], a[4:7], a[36:39], v[164:167]
    ds_read_b64_tr_b16 a[102:103], v29 offset:18432
    v_mfma_f32_16x16x32_bf16 v[168:171], a[4:7], a[40:43], v[168:171]
    v_mfma_f32_16x16x32_bf16 v[172:175], a[4:7], a[44:47], v[172:175]
    ds_read_b128 a[72:75], v27 offset:4096
    v_mfma_f32_16x16x32_bf16 v[176:179], a[4:7], a[48:51], v[176:179]
    v_mfma_f32_16x16x32_bf16 v[180:183], a[4:7], a[52:55], v[180:183]
    v_mfma_f32_16x16x32_bf16 v[184:187], a[4:7], a[56:59], v[184:187]
    ds_read_b64_tr_b16 a[104:105], v30 offset:16384
    v_mfma_f32_16x16x32_bf16 v[188:191], a[4:7], a[60:63], v[188:191]
    v_mfma_f32_16x16x32_bf16 v[96:99], a[8:11], a[32:35], v[96:99]
    ds_read_b64_tr_b16 a[106:107], v30 offset:18432
    v_mfma_f32_16x16x32_bf16 v[100:103], a[8:11], a[36:39], v[100:103]
    v_mfma_f32_16x16x32_bf16 v[104:107], a[8:11], a[40:43], v[104:107]
    ds_read_b128 a[76:79], v27 offset:6144
    v_mfma_f32_16x16x32_bf16 v[108:111], a[8:11], a[44:47], v[108:111]
    v_mfma_f32_16x16x32_bf16 v[112:115], a[8:11], a[48:51], v[112:115]
    ds_read_b64_tr_b16 a[108:109], v31 offset:16384
    v_mfma_f32_16x16x32_bf16 v[116:119], a[8:11], a[52:55], v[116:119]
    v_mfma_f32_16x16x32_bf16 v[120:123], a[8:11], a[56:59], v[120:123]
    ds_read_b64_tr_b16 a[110:111], v31 offset:18432
    v_mfma_f32_16x16x32_bf16 v[124:127], a[8:11], a[60:63], v[124:127]
    v_mfma_f32_16x16x32_bf16 v[192:195], a[12:15], a[32:35], v[192:195]
    ds_read_b128 a[80:83], v27 offset:8192
    v_mfma_f32_16x16x32_bf16 v[196:199], a[12:15], a[36:39], v[196:199]
    v_mfma_f32_16x16x32_bf16 v[200:203], a[12:15], a[40:43], v[200:203]
    ds_read_b64_tr_b16 a[112:113], v32 offset:16384
    v_mfma_f32_16x16x32_bf16 v[204:207], a[12:15], a[44:47], v[204:207]
    v_mfma_f32_16x16x32_bf16 v[208:211], a[12:15], a[48:51], v[208:211]
    ds_read_b64_tr_b16 a[114:115], v32 offset:18432
    v_mfma_f32_16x16x32_bf16 v[212:215], a[12:15], a[52:55], v[212:215]
    v_mfma_f32_16x16x32_bf16 v[216:219], a[12:15], a[56:59], v[216:219]
    ds_read_b128 a[84:87], v27 offset:10240
    v_mfma_f32_16x16x32_bf16 v[220:223], a[12:15], a[60:63], v[220:223]
    v_mfma_f32_16x16x32_bf16 v[128:131], a[16:19], a[32:35], v[128:131]
    ds_read_b64_tr_b16 a[116:117], v33 offset:16384
    v_mfma_f32_16x16x32_bf16 v[132:135], a[16:19], a[36:39], v[132:135]
    v_mfma_f32_16x16x32_bf16 v[136:139], a[16:19], a[40:43], v[136:139]
    ds_read_b64_tr_b16 a[118:119], v33 offset:18432
    v_mfma_f32_16x16x32_bf16 v[140:143], a[16:19], a[44:47], v[140:143]
    v_mfma_f32_16x16x32_bf16 v[144:147], a[16:19], a[48:51], v[144:147]
    ds_read_b128 a[88:91], v27 offset:12288
    v_mfma_f32_16x16x32_bf16 v[148:151], a[16:19], a[52:55], v[148:151]
    v_mfma_f32_16x16x32_bf16 v[152:155], a[16:19], a[56:59], v[152:155]
    v_mfma_f32_16x16x32_bf16 v[156:159], a[16:19], a[60:63], v[156:159]
    ds_read_b64_tr_b16 a[120:121], v34 offset:16384
    v_mfma_f32_16x16x32_bf16 v[224:227], a[20:23], a[32:35], v[224:227]
    v_mfma_f32_16x16x32_bf16 v[228:231], a[20:23], a[36:39], v[228:231]
    ds_read_b64_tr_b16 a[122:123], v34 offset:18432
    v_mfma_f32_16x16x32_bf16 v[232:235], a[20:23], a[40:43], v[232:235]
    v_mfma_f32_16x16x32_bf16 v[236:239], a[20:23], a[44:47], v[236:239]
    ds_read_b128 a[92:95], v27 offset:14336
    v_mfma_f32_16x16x32_bf16 v[240:243], a[20:23], a[48:51], v[240:243]
    v_mfma_f32_16x16x32_bf16 v[244:247], a[20:23], a[52:55], v[244:247]
    ds_read_b64_tr_b16 a[124:125], v35 offset:16384
    v_mfma_f32_16x16x32_bf16 v[248:251], a[20:23], a[56:59], v[248:251]
    v_mfma_f32_16x16x32_bf16 v[252:255], a[20:23], a[60:63], v[252:255]
    ds_read_b64_tr_b16 a[126:127], v35 offset:18432
    v_mfma_f32_16x16x32_bf16 a[128:131], a[24:27], a[32:35], a[128:131]
    v_mfma_f32_16x16x32_bf16 a[136:139], a[24:27], a[36:39], a[136:139]
    v_mfma_f32_16x16x32_bf16 a[144:147], a[24:27], a[40:43], a[144:147]
    v_mfma_f32_16x16x32_bf16 a[152:155], a[24:27], a[44:47], a[152:155]
    v_mfma_f32_16x16x32_bf16 a[160:163], a[24:27], a[48:51], a[160:163]
    v_mfma_f32_16x16x32_bf16 a[168:171], a[24:27], a[52:55], a[168:171]
    v_mfma_f32_16x16x32_bf16 a[176:179], a[24:27], a[56:59], a[176:179]
    v_mfma_f32_16x16x32_bf16 a[184:187], a[24:27], a[60:63], a[184:187]
    v_mfma_f32_16x16x32_bf16 a[132:135], a[28:31], a[32:35], a[132:135]
    v_mfma_f32_16x16x32_bf16 a[140:143], a[28:31], a[36:39], a[140:143]
    v_mfma_f32_16x16x32_bf16 a[148:151], a[28:31], a[40:43], a[148:151]
    v_mfma_f32_16x16x32_bf16 a[156:159], a[28:31], a[44:47], a[156:159]
    v_mfma_f32_16x16x32_bf16 a[164:167], a[28:31], a[48:51], a[164:167]
    v_mfma_f32_16x16x32_bf16 a[172:175], a[28:31], a[52:55], a[172:175]
    v_mfma_f32_16x16x32_bf16 a[180:183], a[28:31], a[56:59], a[180:183]
    v_mfma_f32_16x16x32_bf16 a[188:191], a[28:31], a[60:63], a[188:191]
    s_waitcnt vmcnt(0) lgkmcnt(0)
    s_barrier
    v_mfma_f32_16x16x32_bf16 v[64:67], a[64:67], a[96:99], v[64:67]
    s_cmp_ge_u32 s49, 1024
    s_cselect_b32 s18, 0, s18
    s_cselect_b32 s22, 0, s22
    ds_read_b128 a[0:3], v26 offset:32768
    v_mfma_f32_16x16x32_bf16 v[68:71], a[64:67], a[100:103], v[68:71]
    s_add_u32 m0, s48, 0
    ds_read_b64_tr_b16 a[32:33], v28 offset:32768
    v_mfma_f32_16x16x32_bf16 v[72:75], a[64:67], a[104:107], v[72:75]
    buffer_load_dwordx4 v10, s[16:19], s49 offen offset:0 lds
    v_mfma_f32_16x16x32_bf16 v[76:79], a[64:67], a[108:111], v[76:79]
    ds_read_b64_tr_b16 a[34:35], v28 offset:34816
    v_mfma_f32_16x16x32_bf16 v[80:83], a[64:67], a[112:115], v[80:83]
    buffer_load_dwordx4 v11, s[16:19], s49 offen offset:1024 lds
    v_mfma_f32_16x16x32_bf16 v[84:87], a[64:67], a[116:119], v[84:87]
    ds_read_b128 a[4:7], v26 offset:34816
    v_mfma_f32_16x16x32_bf16 v[88:91], a[64:67], a[120:123], v[88:91]
    v_mfma_f32_16x16x32_bf16 v[92:95], a[64:67], a[124:127], v[92:95]
    ds_read_b64_tr_b16 a[36:37], v29 offset:32768
    v_mfma_f32_16x16x32_bf16 v[160:163], a[68:71], a[96:99], v[160:163]
    buffer_load_dwordx4 v12, s[16:19], s49 offen offset:2048 lds
    v_mfma_f32_16x16x32_bf16 v[164:167], a[68:71], a[100:103], v[164:167]
    ds_read_b64_tr_b16 a[38:39], v29 offset:34816
    v_mfma_f32_16x16x32_bf16 v[168:171], a[68:71], a[104:107], v[168:171]
    v_mfma_f32_16x16x32_bf16 v[172:175], a[68:71], a[108:111], v[172:175]
    buffer_load_dwordx4 v13, s[16:19], s49 offen offset:3072 lds
    ds_read_b128 a[8:11], v26 offset:36864
    v_mfma_f32_16x16x32_bf16 v[176:179], a[68:71], a[112:115], v[176:179]
    v_mfma_f32_16x16x32_bf16 v[180:183], a[68:71], a[116:119], v[180:183]
    s_add_u32 m0, s48, 4096
    v_mfma_f32_16x16x32_bf16 v[184:187], a[68:71], a[120:123], v[184:187]
    ds_read_b64_tr_b16 a[40:41], v30 offset:32768
    v_mfma_f32_16x16x32_bf16 v[188:191], a[68:71], a[124:127], v[188:191]
    buffer_load_dwordx4 v14, s[16:19], s49 offen offset:0 lds
    v_mfma_f32_16x16x32_bf16 v[96:99], a[72:75], a[96:99], v[96:99]
    ds_read_b64_tr_b16 a[42:43], v30 offset:34816
    v_mfma_f32_16x16x32_bf16 v[100:103], a[72:75], a[100:103], v[100:103]
    v_mfma_f32_16x16x32_bf16 v[104:107], a[72:75], a[104:107], v[104:107]
    buffer_load_dwordx4 v15, s[16:19], s49 offen offset:1024 lds
    ds_read_b128 a[12:15], v26 offset:38912
    v_mfma_f32_16x16x32_bf16 v[108:111], a[72:75], a[108:111], v[108:111]
    v_mfma_f32_16x16x32_bf16 v[112:115], a[72:75], a[112:115], v[112:115]
    ds_read_b64_tr_b16 a[44:45], v31 offset:32768
    v_mfma_f32_16x16x32_bf16 v[116:119], a[72:75], a[116:119], v[116:119]
    v_mfma_f32_16x16x32_bf16 v[120:123], a[72:75], a[120:123], v[120:123]
    buffer_load_dwordx4 v16, s[16:19], s49 offen offset:2048 lds
    ds_read_b64_tr_b16 a[46:47], v31 offset:34816
    v_mfma_f32_16x16x32_bf16 v[124:127], a[72:75], a[124:127], v[124:127]
    v_mfma_f32_16x16x32_bf16 v[192:195], a[76:79], a[96:99], v[192:195]
    ds_read_b128 a[16:19], v26 offset:40960
    v_mfma_f32_16x16x32_bf16 v[196:199], a[76:79], a[100:103], v[196:199]
    buffer_load_dwordx4 v17, s[16:19], s49 offen offset:3072 lds
    v_mfma_f32_16x16x32_bf16 v[200:203], a[76:79], a[104:107], v[200:203]
    ds_read_b64_tr_b16 a[48:49], v32 offset:32768
    v_mfma_f32_16x16x32_bf16 v[204:207], a[76:79], a[108:111], v[204:207]
    s_add_u32 s49, s49, 128
    v_mfma_f32_16x16x32_bf16 v[208:211], a[76:79], a[112:115], v[208:211]
    s_add_u32 m0, s48, 65536
    ds_read_b64_tr_b16 a[50:51], v32 offset:34816
    v_mfma_f32_16x16x32_bf16 v[212:215], a[76:79], a[116:119], v[212:215]
    buffer_load_dwordx4 v18, s[20:23], s50 offen offset:0 lds
    v_mfma_f32_16x16x32_bf16 v[216:219], a[76:79], a[120:123], v[216:219]
    ds_read_b128 a[20:23], v26 offset:43008
    v_mfma_f32_16x16x32_bf16 v[220:223], a[76:79], a[124:127], v[220:223]
    v_mfma_f32_16x16x32_bf16 v[128:131], a[80:83], a[96:99], v[128:131]
    buffer_load_dwordx4 v19, s[20:23], s50 offen offset:1024 lds
    ds_read_b64_tr_b16 a[52:53], v33 offset:32768
    v_mfma_f32_16x16x32_bf16 v[132:135], a[80:83], a[100:103], v[132:135]
    v_mfma_f32_16x16x32_bf16 v[136:139], a[80:83], a[104:107], v[136:139]
    ds_read_b64_tr_b16 a[54:55], v33 offset:34816
    v_mfma_f32_16x16x32_bf16 v[140:143], a[80:83], a[108:111], v[140:143]
    buffer_load_dwordx4 v20, s[20:23], s50 offen offset:2048 lds
    v_mfma_f32_16x16x32_bf16 v[144:147], a[80:83], a[112:115], v[144:147]
    ds_read_b128 a[24:27], v26 offset:45056
    v_mfma_f32_16x16x32_bf16 v[148:151], a[80:83], a[116:119], v[148:151]
    v_mfma_f32_16x16x32_bf16 v[152:155], a[80:83], a[120:123], v[152:155]
    v_mfma_f32_16x16x32_bf16 v[156:159], a[80:83], a[124:127], v[156:159]
    buffer_load_dwordx4 v21, s[20:23], s50 offen offset:3072 lds
    ds_read_b64_tr_b16 a[56:57], v34 offset:32768
    v_mfma_f32_16x16x32_bf16 v[224:227], a[84:87], a[96:99], v[224:227]
    s_add_u32 m0, s48, 69632
    v_mfma_f32_16x16x32_bf16 v[228:231], a[84:87], a[100:103], v[228:231]
    ds_read_b64_tr_b16 a[58:59], v34 offset:34816
    v_mfma_f32_16x16x32_bf16 v[232:235], a[84:87], a[104:107], v[232:235]
    buffer_load_dwordx4 v22, s[20:23], s50 offen offset:0 lds
    v_mfma_f32_16x16x32_bf16 v[236:239], a[84:87], a[108:111], v[236:239]
    ds_read_b128 a[28:31], v26 offset:47104
    v_mfma_f32_16x16x32_bf16 v[240:243], a[84:87], a[112:115], v[240:243]
    v_mfma_f32_16x16x32_bf16 v[244:247], a[84:87], a[116:119], v[244:247]
    ds_read_b64_tr_b16 a[60:61], v35 offset:32768
    v_mfma_f32_16x16x32_bf16 v[248:251], a[84:87], a[120:123], v[248:251]
    buffer_load_dwordx4 v23, s[20:23], s50 offen offset:1024 lds
    v_mfma_f32_16x16x32_bf16 v[252:255], a[84:87], a[124:127], v[252:255]
    ds_read_b64_tr_b16 a[62:63], v35 offset:34816
    v_mfma_f32_16x16x32_bf16 a[128:131], a[88:91], a[96:99], a[128:131]
    v_mfma_f32_16x16x32_bf16 a[136:139], a[88:91], a[100:103], a[136:139]
    buffer_load_dwordx4 v24, s[20:23], s50 offen offset:2048 lds
    v_mfma_f32_16x16x32_bf16 a[144:147], a[88:91], a[104:107], a[144:147]
    v_mfma_f32_16x16x32_bf16 a[152:155], a[88:91], a[108:111], a[152:155]
    v_mfma_f32_16x16x32_bf16 a[160:163], a[88:91], a[112:115], a[160:163]
    v_mfma_f32_16x16x32_bf16 a[168:171], a[88:91], a[116:119], a[168:171]
    buffer_load_dwordx4 v25, s[20:23], s50 offen offset:3072 lds
    v_mfma_f32_16x16x32_bf16 a[176:179], a[88:91], a[120:123], a[176:179]
    v_mfma_f32_16x16x32_bf16 a[184:187], a[88:91], a[124:127], a[184:187]
    s_add_u32 s50, s50, 0x80000
    v_mfma_f32_16x16x32_bf16 a[132:135], a[92:95], a[96:99], a[132:135]
    v_mfma_f32_16x16x32_bf16 a[140:143], a[92:95], a[100:103], a[140:143]
    s_cmp_eq_u32 s51, s53
    s_cbranch_scc1 k12_ool_28
k12_oolret_29:
    v_mfma_f32_16x16x32_bf16 a[148:151], a[92:95], a[104:107], a[148:151]
    v_mfma_f32_16x16x32_bf16 a[156:159], a[92:95], a[108:111], a[156:159]
    s_cmp_eq_u32 s51, s63
    s_cbranch_scc1 k12_ool_30
k12_oolret_31:
    v_mfma_f32_16x16x32_bf16 a[164:167], a[92:95], a[112:115], a[164:167]
    v_mfma_f32_16x16x32_bf16 a[172:175], a[92:95], a[116:119], a[172:175]
    s_add_u32 s51, s51, 1
    v_mfma_f32_16x16x32_bf16 a[180:183], a[92:95], a[120:123], a[180:183]
    v_mfma_f32_16x16x32_bf16 a[188:191], a[92:95], a[124:127], a[188:191]
    s_waitcnt lgkmcnt(0)
    v_mfma_f32_16x16x32_bf16 v[64:67], a[0:3], a[32:35], v[64:67]
    ds_read_b128 a[64:67], v27 offset:32768
    v_mfma_f32_16x16x32_bf16 v[68:71], a[0:3], a[36:39], v[68:71]
    ds_read_b64_tr_b16 a[96:97], v28 offset:49152
    v_mfma_f32_16x16x32_bf16 v[72:75], a[0:3], a[40:43], v[72:75]
    v_mfma_f32_16x16x32_bf16 v[76:79], a[0:3], a[44:47], v[76:79]
    ds_read_b64_tr_b16 a[98:99], v28 offset:51200
    v_mfma_f32_16x16x32_bf16 v[80:83], a[0:3], a[48:51], v[80:83]
    v_mfma_f32_16x16x32_bf16 v[84:87], a[0:3], a[52:55], v[84:87]
    ds_read_b128 a[68:71], v27 offset:34816
    v_mfma_f32_16x16x32_bf16 v[88:91], a[0:3], a[56:59], v[88:91]
    v_mfma_f32_16x16x32_bf16 v[92:95], a[0:3], a[60:63], v[92:95]
    ds_read_b64_tr_b16 a[100:101], v29 offset:49152
    v_mfma_f32_16x16x32_bf16 v[160:163], a[4:7], a[32:35], v[160:163]
    v_mfma_f32_16x16x32_bf16 v[164:167], a[4:7], a[36:39], v[164:167]
    ds_read_b64_tr_b16 a[102:103], v29 offset:51200
    v_mfma_f32_16x16x32_bf16 v[168:171], a[4:7], a[40:43], v[168:171]
    v_mfma_f32_16x16x32_bf16 v[172:175], a[4:7], a[44:47], v[172:175]
    ds_read_b128 a[72:75], v27 offset:36864
    v_mfma_f32_16x16x32_bf16 v[176:179], a[4:7], a[48:51], v[176:179]
    v_mfma_f32_16x16x32_bf16 v[180:183], a[4:7], a[52:55], v[180:183]
    v_mfma_f32_16x16x32_bf16 v[184:187], a[4:7], a[56:59], v[184:187]
    ds_read_b64_tr_b16 a[104:105], v30 offset:49152
    v_mfma_f32_16x16x32_bf16 v[188:191], a[4:7], a[60:63], v[188:191]
    v_mfma_f32_16x16x32_bf16 v[96:99], a[8:11], a[32:35], v[96:99]
    ds_read_b64_tr_b16 a[106:107], v30 offset:51200
    v_mfma_f32_16x16x32_bf16 v[100:103], a[8:11], a[36:39], v[100:103]
    v_mfma_f32_16x16x32_bf16 v[104:107], a[8:11], a[40:43], v[104:107]
    ds_read_b128 a[76:79], v27 offset:38912
    v_mfma_f32_16x16x32_bf16 v[108:111], a[8:11], a[44:47], v[108:111]
    v_mfma_f32_16x16x32_bf16 v[112:115], a[8:11], a[48:51], v[112:115]
    ds_read_b64_tr_b16 a[108:109], v31 offset:49152
    v_mfma_f32_16x16x32_bf16 v[116:119], a[8:11], a[52:55], v[116:119]
    v_mfma_f32_16x16x32_bf16 v[120:123], a[8:11], a[56:59], v[120:123]
    ds_read_b64_tr_b16 a[110:111], v31 offset:51200
    v_mfma_f32_16x16x32_bf16 v[124:127], a[8:11], a[60:63], v[124:127]
    v_mfma_f32_16x16x32_bf16 v[192:195], a[12:15], a[32:35], v[192:195]
    ds_read_b128 a[80:83], v27 offset:40960
    v_mfma_f32_16x16x32_bf16 v[196:199], a[12:15], a[36:39], v[196:199]
    v_mfma_f32_16x16x32_bf16 v[200:203], a[12:15], a[40:43], v[200:203]
    ds_read_b64_tr_b16 a[112:113], v32 offset:49152
    v_mfma_f32_16x16x32_bf16 v[204:207], a[12:15], a[44:47], v[204:207]
    v_mfma_f32_16x16x32_bf16 v[208:211], a[12:15], a[48:51], v[208:211]
    ds_read_b64_tr_b16 a[114:115], v32 offset:51200
    v_mfma_f32_16x16x32_bf16 v[212:215], a[12:15], a[52:55], v[212:215]
    v_mfma_f32_16x16x32_bf16 v[216:219], a[12:15], a[56:59], v[216:219]
    ds_read_b128 a[84:87], v27 offset:43008
    v_mfma_f32_16x16x32_bf16 v[220:223], a[12:15], a[60:63], v[220:223]
    v_mfma_f32_16x16x32_bf16 v[128:131], a[16:19], a[32:35], v[128:131]
    ds_read_b64_tr_b16 a[116:117], v33 offset:49152
    v_mfma_f32_16x16x32_bf16 v[132:135], a[16:19], a[36:39], v[132:135]
    v_mfma_f32_16x16x32_bf16 v[136:139], a[16:19], a[40:43], v[136:139]
    ds_read_b64_tr_b16 a[118:119], v33 offset:51200
    v_mfma_f32_16x16x32_bf16 v[140:143], a[16:19], a[44:47], v[140:143]
    v_mfma_f32_16x16x32_bf16 v[144:147], a[16:19], a[48:51], v[144:147]
    ds_read_b128 a[88:91], v27 offset:45056
    v_mfma_f32_16x16x32_bf16 v[148:151], a[16:19], a[52:55], v[148:151]
    v_mfma_f32_16x16x32_bf16 v[152:155], a[16:19], a[56:59], v[152:155]
    v_mfma_f32_16x16x32_bf16 v[156:159], a[16:19], a[60:63], v[156:159]
    ds_read_b64_tr_b16 a[120:121], v34 offset:49152
    v_mfma_f32_16x16x32_bf16 v[224:227], a[20:23], a[32:35], v[224:227]
    v_mfma_f32_16x16x32_bf16 v[228:231], a[20:23], a[36:39], v[228:231]
    ds_read_b64_tr_b16 a[122:123], v34 offset:51200
    v_mfma_f32_16x16x32_bf16 v[232:235], a[20:23], a[40:43], v[232:235]
    v_mfma_f32_16x16x32_bf16 v[236:239], a[20:23], a[44:47], v[236:239]
    ds_read_b128 a[92:95], v27 offset:47104
    v_mfma_f32_16x16x32_bf16 v[240:243], a[20:23], a[48:51], v[240:243]
    v_mfma_f32_16x16x32_bf16 v[244:247], a[20:23], a[52:55], v[244:247]
    ds_read_b64_tr_b16 a[124:125], v35 offset:49152
    v_mfma_f32_16x16x32_bf16 v[248:251], a[20:23], a[56:59], v[248:251]
    v_mfma_f32_16x16x32_bf16 v[252:255], a[20:23], a[60:63], v[252:255]
    ds_read_b64_tr_b16 a[126:127], v35 offset:51200
    v_mfma_f32_16x16x32_bf16 a[128:131], a[24:27], a[32:35], a[128:131]
    v_mfma_f32_16x16x32_bf16 a[136:139], a[24:27], a[36:39], a[136:139]
    v_mfma_f32_16x16x32_bf16 a[144:147], a[24:27], a[40:43], a[144:147]
    v_mfma_f32_16x16x32_bf16 a[152:155], a[24:27], a[44:47], a[152:155]
    v_mfma_f32_16x16x32_bf16 a[160:163], a[24:27], a[48:51], a[160:163]
    v_mfma_f32_16x16x32_bf16 a[168:171], a[24:27], a[52:55], a[168:171]
    v_mfma_f32_16x16x32_bf16 a[176:179], a[24:27], a[56:59], a[176:179]
    v_mfma_f32_16x16x32_bf16 a[184:187], a[24:27], a[60:63], a[184:187]
    s_sub_u32 s52, s51, 1
    s_cmp_eq_u32 s52, s46
    s_cbranch_scc1 k12_ool_34
k12_oolret_35:
    v_mfma_f32_16x16x32_bf16 a[132:135], a[28:31], a[32:35], a[132:135]
    v_mfma_f32_16x16x32_bf16 a[140:143], a[28:31], a[36:39], a[140:143]
    v_mfma_f32_16x16x32_bf16 a[148:151], a[28:31], a[40:43], a[148:151]
    v_mfma_f32_16x16x32_bf16 a[156:159], a[28:31], a[44:47], a[156:159]
    v_mfma_f32_16x16x32_bf16 a[164:167], a[28:31], a[48:51], a[164:167]
    v_mfma_f32_16x16x32_bf16 a[172:175], a[28:31], a[52:55], a[172:175]
    v_mfma_f32_16x16x32_bf16 a[180:183], a[28:31], a[56:59], a[180:183]
    v_mfma_f32_16x16x32_bf16 a[188:191], a[28:31], a[60:63], a[188:191]
    s_waitcnt vmcnt(0) lgkmcnt(0)
    s_barrier
    s_cmp_eq_u32 s51, 7
    s_cbranch_scc1 k12_last_25
    v_mfma_f32_16x16x32_bf16 v[64:67], a[64:67], a[96:99], v[64:67]
    ds_read_b128 a[0:3], v26 offset:0
    v_mfma_f32_16x16x32_bf16 v[68:71], a[64:67], a[100:103], v[68:71]
    s_add_u32 m0, s48, 32768
    ds_read_b64_tr_b16 a[32:33], v28 offset:0
    v_mfma_f32_16x16x32_bf16 v[72:75], a[64:67], a[104:107], v[72:75]
    buffer_load_dwordx4 v10, s[16:19], s49 offen offset:0 lds
    v_mfma_f32_16x16x32_bf16 v[76:79], a[64:67], a[108:111], v[76:79]
    ds_read_b64_tr_b16 a[34:35], v28 offset:2048
    v_mfma_f32_16x16x32_bf16 v[80:83], a[64:67], a[112:115], v[80:83]
    buffer_load_dwordx4 v11, s[16:19], s49 offen offset:1024 lds
    v_mfma_f32_16x16x32_bf16 v[84:87], a[64:67], a[116:119], v[84:87]
    ds_read_b128 a[4:7], v26 offset:2048
    v_mfma_f32_16x16x32_bf16 v[88:91], a[64:67], a[120:123], v[88:91]
    v_mfma_f32_16x16x32_bf16 v[92:95], a[64:67], a[124:127], v[92:95]
    ds_read_b64_tr_b16 a[36:37], v29 offset:0
    v_mfma_f32_16x16x32_bf16 v[160:163], a[68:71], a[96:99], v[160:163]
    buffer_load_dwordx4 v12, s[16:19], s49 offen offset:2048 lds
    v_mfma_f32_16x16x32_bf16 v[164:167], a[68:71], a[100:103], v[164:167]
    ds_read_b64_tr_b16 a[38:39], v29 offset:2048
    v_mfma_f32_16x16x32_bf16 v[168:171], a[68:71], a[104:107], v[168:171]
    v_mfma_f32_16x16x32_bf16 v[172:175], a[68:71], a[108:111], v[172:175]
    buffer_load_dwordx4 v13, s[16:19], s49 offen offset:3072 lds
    ds_read_b128 a[8:11], v26 offset:4096
    v_mfma_f32_16x16x32_bf16 v[176:179], a[68:71], a[112:115], v[176:179]
    v_mfma_f32_16x16x32_bf16 v[180:183], a[68:71], a[116:119], v[180:183]
    s_add_u32 m0, s48, 36864
    v_mfma_f32_16x16x32_bf16 v[184:187], a[68:71], a[120:123], v[184:187]
    ds_read_b64_tr_b16 a[40:41], v30 offset:0
    v_mfma_f32_16x16x32_bf16 v[188:191], a[68:71], a[124:127], v[188:191]
    buffer_load_dwordx4 v14, s[16:19], s49 offen offset:0 lds
    v_mfma_f32_16x16x32_bf16 v[96:99], a[72:75], a[96:99], v[96:99]
    ds_read_b64_tr_b16 a[42:43], v30 offset:2048
    v_mfma_f32_16x16x32_bf16 v[100:103], a[72:75], a[100:103], v[100:103]
    v_mfma_f32_16x16x32_bf16 v[104:107], a[72:75], a[104:107], v[104:107]
    buffer_load_dwordx4 v15, s[16:19], s49 offen offset:1024 lds
    ds_read_b128 a[12:15], v26 offset:6144
    v_mfma_f32_16x16x32_bf16 v[108:111], a[72:75], a[108:111], v[108:111]
    v_mfma_f32_16x16x32_bf16 v[112:115], a[72:75], a[112:115], v[112:115]
    ds_read_b64_tr_b16 a[44:45], v31 offset:0
    v_mfma_f32_16x16x32_bf16 v[116:119], a[72:75], a[116:119], v[116:119]
    v_mfma_f32_16x16x32_bf16 v[120:123], a[72:75], a[120:123], v[120:123]
    buffer_load_dwordx4 v16, s[16:19], s49 offen offset:2048 lds
    ds_read_b64_tr_b16 a[46:47], v31 offset:2048
    v_mfma_f32_16x16x32_bf16 v[124:127], a[72:75], a[124:127], v[124:127]
    v_mfma_f32_16x16x32_bf16 v[192:195], a[76:79], a[96:99], v[192:195]
    ds_read_b128 a[16:19], v26 offset:8192
    v_mfma_f32_16x16x32_bf16 v[196:199], a[76:79], a[100:103], v[196:199]
    buffer_load_dwordx4 v17, s[16:19], s49 offen offset:3072 lds
    v_mfma_f32_16x16x32_bf16 v[200:203], a[76:79], a[104:107], v[200:203]
    ds_read_b64_tr_b16 a[48:49], v32 offset:0
    v_mfma_f32_16x16x32_bf16 v[204:207], a[76:79], a[108:111], v[204:207]
    s_add_u32 s49, s49, 128
    v_mfma_f32_16x16x32_bf16 v[208:211], a[76:79], a[112:115], v[208:211]
    s_add_u32 m0, s48, 98304
    ds_read_b64_tr_b16 a[50:51], v32 offset:2048
    v_mfma_f32_16x16x32_bf16 v[212:215], a[76:79], a[116:119], v[212:215]
    buffer_load_dwordx4 v18, s[20:23], s50 offen offset:0 lds
    v_mfma_f32_16x16x32_bf16 v[216:219], a[76:79], a[120:123], v[216:219]
    ds_read_b128 a[20:23], v26 offset:10240
    v_mfma_f32_16x16x32_bf16 v[220:223], a[76:79], a[124:127], v[220:223]
    v_mfma_f32_16x16x32_bf16 v[128:131], a[80:83], a[96:99], v[128:131]
    buffer_load_dwordx4 v19, s[20:23], s50 offen offset:1024 lds
    ds_read_b64_tr_b16 a[52:53], v33 offset:0
    v_mfma_f32_16x16x32_bf16 v[132:135], a[80:83], a[100:103], v[132:135]
    v_mfma_f32_16x16x32_bf16 v[136:139], a[80:83], a[104:107], v[136:139]
    ds_read_b64_tr_b16 a[54:55], v33 offset:2048
    v_mfma_f32_16x16x32_bf16 v[140:143], a[80:83], a[108:111], v[140:143]
    buffer_load_dwordx4 v20, s[20:23], s50 offen offset:2048 lds
    v_mfma_f32_16x16x32_bf16 v[144:147], a[80:83], a[112:115], v[144:147]
    ds_read_b128 a[24:27], v26 offset:12288
    v_mfma_f32_16x16x32_bf16 v[148:151], a[80:83], a[116:119], v[148:151]
    v_mfma_f32_16x16x32_bf16 v[152:155], a[80:83], a[120:123], v[152:155]
    v_mfma_f32_16x16x32_bf16 v[156:159], a[80:83], a[124:127], v[156:159]
    buffer_load_dwordx4 v21, s[20:23], s50 offen offset:3072 lds
    ds_read_b64_tr_b16 a[56:57], v34 offset:0
    v_mfma_f32_16x16x32_bf16 v[224:227], a[84:87], a[96:99], v[224:227]
    s_add_u32 m0, s48, 102400
    v_mfma_f32_16x16x32_bf16 v[228:231], a[84:87], a[100:103], v[228:231]
    ds_read_b64_tr_b16 a[58:59], v34 offset:2048
    v_mfma_f32_16x16x32_bf16 v[232:235], a[84:87], a[104:107], v[232:235]
    buffer_load_dwordx4 v22, s[20:23], s50 offen offset:0 lds
    v_mfma_f32_16x16x32_bf16 v[236:239], a[84:87], a[108:111], v[236:239]
    ds_read_b128 a[28:31], v26 offset:14336
    v_mfma_f32_16x16x32_bf16 v[240:243], a[84:87], a[112:115], v[240:243]
    v_mfma_f32_16x16x32_bf16 v[244:247], a[84:87], a[116:119], v[244:247]
    ds_read_b64_tr_b16 a[60:61], v35 offset:0
    v_mfma_f32_16x16x32_bf16 v[248:251], a[84:87], a[120:123], v[248:251]
    buffer_load_dwordx4 v23, s[20:23], s50 offen offset:1024 lds
    v_mfma_f32_16x16x32_bf16 v[252:255], a[84:87], a[124:127], v[252:255]
    ds_read_b64_tr_b16 a[62:63], v35 offset:2048
    v_mfma_f32_16x16x32_bf16 a[128:131], a[88:91], a[96:99], a[128:131]
    v_mfma_f32_16x16x32_bf16 a[136:139], a[88:91], a[100:103], a[136:139]
    buffer_load_dwordx4 v24, s[20:23], s50 offen offset:2048 lds
    v_mfma_f32_16x16x32_bf16 a[144:147], a[88:91], a[104:107], a[144:147]
    v_mfma_f32_16x16x32_bf16 a[152:155], a[88:91], a[108:111], a[152:155]
    v_mfma_f32_16x16x32_bf16 a[160:163], a[88:91], a[112:115], a[160:163]
    v_mfma_f32_16x16x32_bf16 a[168:171], a[88:91], a[116:119], a[168:171]
    buffer_load_dwordx4 v25, s[20:23], s50 offen offset:3072 lds
    v_mfma_f32_16x16x32_bf16 a[176:179], a[88:91], a[120:123], a[176:179]
    v_mfma_f32_16x16x32_bf16 a[184:187], a[88:91], a[124:127], a[184:187]
    s_add_u32 s50, s50, 0x80000
    v_mfma_f32_16x16x32_bf16 a[132:135], a[92:95], a[96:99], a[132:135]
    v_mfma_f32_16x16x32_bf16 a[140:143], a[92:95], a[100:103], a[140:143]
    s_cmp_eq_u32 s51, s53
    s_cbranch_scc1 k12_ool_36
k12_oolret_37:
    v_mfma_f32_16x16x32_bf16 a[148:151], a[92:95], a[104:107], a[148:151]
    v_mfma_f32_16x16x32_bf16 a[156:159], a[92:95], a[108:111], a[156:159]
    s_cmp_eq_u32 s51, 5
    s_cbranch_scc1 k12_ool_38
k12_oolret_39:
    v_mfma_f32_16x16x32_bf16 a[164:167], a[92:95], a[112:115], a[164:167]
    v_mfma_f32_16x16x32_bf16 a[172:175], a[92:95], a[116:119], a[172:175]
    s_add_u32 s51, s51, 1
    v_mfma_f32_16x16x32_bf16 a[180:183], a[92:95], a[120:123], a[180:183]
    v_mfma_f32_16x16x32_bf16 a[188:191], a[92:95], a[124:127], a[188:191]
    s_waitcnt lgkmcnt(0)
    s_branch k12_loop_24
k12_last_25:
    v_mfma_f32_16x16x32_bf16 v[64:67], a[64:67], a[96:99], v[64:67]
    s_add_u32 m0, s60, 98304
    v_mfma_f32_16x16x32_bf16 v[160:163], a[68:71], a[96:99], v[160:163]
    buffer_load_dwordx4 v38, s[12:15], s61 offen offset:0 lds
    v_mfma_f32_16x16x32_bf16 v[68:71], a[64:67], a[100:103], v[68:71]
    buffer_load_dwordx4 v39, s[12:15], s61 offen offset:1024 lds
    v_mfma_f32_16x16x32_bf16 v[164:167], a[68:71], a[100:103], v[164:167]
    v_mfma_f32_16x16x32_bf16 v[72:75], a[64:67], a[104:107], v[72:75]
    buffer_load_dwordx4 v40, s[12:15], s61 offen offset:2048 lds
    v_mfma_f32_16x16x32_bf16 v[168:171], a[68:71], a[104:107], v[168:171]
    v_cvt_pk_bf16_f32 v64, v64, v65
    v_cvt_pk_bf16_f32 v65, v66, v67
    v_cvt_pk_bf16_f32 v66, v160, v161
    v_mfma_f32_16x16x32_bf16 v[76:79], a[64:67], a[108:111], v[76:79]
    v_cvt_pk_bf16_f32 v67, v162, v163
    v_mfma_f32_16x16x32_bf16 v[172:175], a[68:71], a[108:111], v[172:175]
    v_cvt_pk_bf16_f32 v68, v68, v69
    v_cvt_pk_bf16_f32 v69, v70, v71
    v_cvt_pk_bf16_f32 v70, v164, v165
    v_mfma_f32_16x16x32_bf16 v[80:83], a[64:67], a[112:115], v[80:83]
    buffer_load_dwordx4 v41, s[12:15], s61 offen offset:3072 lds
    v_mfma_f32_16x16x32_bf16 v[176:179], a[68:71], a[112:115], v[176:179]
    s_add_u32 s61, s61, 0x80000
    v_cvt_pk_bf16_f32 v71, v166, v167
    v_cvt_pk_bf16_f32 v72, v72, v73
    v_cvt_pk_bf16_f32 v73, v74, v75
    v_mfma_f32_16x16x32_bf16 v[84:87], a[64:67], a[116:119], v[84:87]
    buffer_load_dwordx4 a[192:195], v36, s[8:11], s62 offen offset:0 sc1
    buffer_load_dwordx4 a[196:199], v36, s[8:11], s62 offen offset:1024 sc1
    v_mfma_f32_16x16x32_bf16 v[180:183], a[68:71], a[116:119], v[180:183]
    v_cvt_pk_bf16_f32 v74, v168, v169
    v_cvt_pk_bf16_f32 v75, v170, v171
    v_cvt_pk_bf16_f32 v76, v76, v77
    v_mfma_f32_16x16x32_bf16 v[88:91], a[64:67], a[120:123], v[88:91]
    v_cvt_pk_bf16_f32 v77, v78, v79
    v_cvt_pk_bf16_f32 v78, v172, v173
    v_cvt_pk_bf16_f32 v79, v174, v175
    v_mfma_f32_16x16x32_bf16 v[184:187], a[68:71], a[120:123], v[184:187]
    v_cvt_pk_bf16_f32 v80, v80, v81
    v_cvt_pk_bf16_f32 v81, v82, v83
    v_cvt_pk_bf16_f32 v82, v176, v177
    v_mfma_f32_16x16x32_bf16 v[92:95], a[64:67], a[124:127], v[92:95]
    buffer_load_dwordx4 a[200:203], v37, s[8:11], s62 offen offset:0 sc1
    buffer_load_dwordx4 a[204:207], v37, s[8:11], s62 offen offset:1024 sc1
    v_mfma_f32_16x16x32_bf16 v[188:191], a[68:71], a[124:127], v[188:191]
    s_add_u32 s62, s62, 0x20000
    v_cvt_pk_bf16_f32 v83, v178, v179
    v_cvt_pk_bf16_f32 v84, v84, v85
    v_cvt_pk_bf16_f32 v85, v86, v87
    v_mfma_f32_16x16x32_bf16 a[128:131], a[88:91], a[96:99], a[128:131]
    v_cvt_pk_bf16_f32 v86, v180, v181
    v_cvt_pk_bf16_f32 v87, v182, v183
    v_mfma_f32_16x16x32_bf16 a[132:135], a[92:95], a[96:99], a[132:135]
    v_cvt_pk_bf16_f32 v88, v88, v89
    v_cvt_pk_bf16_f32 v89, v90, v91
    v_cvt_pk_bf16_f32 v90, v184, v185
    v_mfma_f32_16x16x32_bf16 v[96:99], a[72:75], a[96:99], v[96:99]
    buffer_load_dwordx4 a[208:211], v36, s[8:11], s62 offen offset:0 sc1
    buffer_load_dwordx4 a[212:215], v36, s[8:11], s62 offen offset:1024 sc1
    v_mfma_f32_16x16x32_bf16 v[192:195], a[76:79], a[96:99], v[192:195]
    v_cvt_pk_bf16_f32 v91, v186, v187
    v_cvt_pk_bf16_f32 v92, v92, v93
    v_cvt_pk_bf16_f32 v93, v94, v95
    v_mfma_f32_16x16x32_bf16 v[100:103], a[72:75], a[100:103], v[100:103]
    v_cvt_pk_bf16_f32 v94, v188, v189
    v_cvt_pk_bf16_f32 v95, v190, v191
    v_mfma_f32_16x16x32_bf16 v[196:199], a[76:79], a[100:103], v[196:199]
    v_accvgpr_read_b32 v56, a128
    v_accvgpr_read_b32 v57, a129
    v_accvgpr_read_b32 v58, a130
    v_mfma_f32_16x16x32_bf16 a[136:139], a[88:91], a[100:103], a[136:139]
    buffer_load_dwordx4 a[216:219], v37, s[8:11], s62 offen offset:0 sc1
    buffer_load_dwordx4 a[220:223], v37, s[8:11], s62 offen offset:1024 sc1
    v_mfma_f32_16x16x32_bf16 a[140:143], a[92:95], a[100:103], a[140:143]
    s_add_u32 s62, s62, 0x20000
    v_accvgpr_read_b32 v59, a131
    v_accvgpr_read_b32 v60, a132
    v_cvt_pk_bf16_f32 v96, v96, v97
    v_mfma_f32_16x16x32_bf16 v[104:107], a[72:75], a[104:107], v[104:107]
    s_add_u32 m0, s60, 114688
    v_accvgpr_read_b32 v61, a133
    v_accvgpr_read_b32 v62, a134
    v_cvt_pk_bf16_f32 v97, v98, v99
    v_mfma_f32_16x16x32_bf16 v[200:203], a[76:79], a[104:107], v[200:203]
    v_accvgpr_read_b32 v63, a135
    v_cvt_pk_bf16_f32 v98, v192, v193
    v_cvt_pk_bf16_f32 v160, v56, v57
    v_mfma_f32_16x16x32_bf16 v[108:111], a[72:75], a[108:111], v[108:111]
    v_cvt_pk_bf16_f32 v99, v194, v195
    v_cvt_pk_bf16_f32 v161, v58, v59
    v_cvt_pk_bf16_f32 v100, v100, v101
    v_mfma_f32_16x16x32_bf16 v[204:207], a[76:79], a[108:111], v[204:207]
    buffer_load_dwordx4 v38, s[12:15], s61 offen offset:0 lds
    buffer_load_dwordx4 v39, s[12:15], s61 offen offset:1024 lds
    v_mfma_f32_16x16x32_bf16 a[144:147], a[88:91], a[104:107], a[144:147]
    v_cvt_pk_bf16_f32 v162, v60, v61
    v_cvt_pk_bf16_f32 v101, v102, v103
    v_cvt_pk_bf16_f32 v163, v62, v63
    v_mfma_f32_16x16x32_bf16 a[148:151], a[92:95], a[104:107], a[148:151]
    v_cvt_pk_bf16_f32 v102, v196, v197
    v_cvt_pk_bf16_f32 v103, v198, v199
    v_accvgpr_read_b32 v56, a136
    v_mfma_f32_16x16x32_bf16 v[112:115], a[72:75], a[112:115], v[112:115]
    v_accvgpr_read_b32 v57, a137
    v_accvgpr_read_b32 v58, a138
    v_accvgpr_read_b32 v59, a139
    v_mfma_f32_16x16x32_bf16 v[208:211], a[76:79], a[112:115], v[208:211]
    v_accvgpr_read_b32 v60, a140
    v_cvt_pk_bf16_f32 v104, v104, v105
    v_accvgpr_read_b32 v61, a141
    v_mfma_f32_16x16x32_bf16 v[116:119], a[72:75], a[116:119], v[116:119]
    buffer_load_dwordx4 v40, s[12:15], s61 offen offset:2048 lds
    buffer_load_dwordx4 v41, s[12:15], s61 offen offset:3072 lds
    v_mfma_f32_16x16x32_bf16 v[212:215], a[76:79], a[116:119], v[212:215]
    s_add_u32 s61, s61, 0x80000
    v_accvgpr_read_b32 v62, a142
    v_cvt_pk_bf16_f32 v105, v106, v107
    v_accvgpr_read_b32 v63, a143
    v_mfma_f32_16x16x32_bf16 a[152:155], a[88:91], a[108:111], a[152:155]
    v_cvt_pk_bf16_f32 v106, v200, v201
    v_cvt_pk_bf16_f32 v164, v56, v57
    v_cvt_pk_bf16_f32 v107, v202, v203
    v_mfma_f32_16x16x32_bf16 a[156:159], a[92:95], a[108:111], a[156:159]
    v_cvt_pk_bf16_f32 v165, v58, v59
    v_cvt_pk_bf16_f32 v108, v108, v109
    v_cvt_pk_bf16_f32 v166, v60, v61
    v_mfma_f32_16x16x32_bf16 v[120:123], a[72:75], a[120:123], v[120:123]
    v_cvt_pk_bf16_f32 v109, v110, v111
    v_cvt_pk_bf16_f32 v167, v62, v63
    v_cvt_pk_bf16_f32 v110, v204, v205
    v_mfma_f32_16x16x32_bf16 v[216:219], a[76:79], a[120:123], v[216:219]
    buffer_load_dwordx4 a[224:227], v36, s[8:11], s62 offen offset:0 sc1
    v_cvt_pk_bf16_f32 v111, v206, v207
    v_accvgpr_read_b32 v56, a144
    v_mfma_f32_16x16x32_bf16 v[124:127], a[72:75], a[124:127], v[124:127]
    v_accvgpr_read_b32 v57, a145
    v_accvgpr_read_b32 v58, a146
    v_accvgpr_read_b32 v59, a147
    v_mfma_f32_16x16x32_bf16 v[220:223], a[76:79], a[124:127], v[220:223]
    buffer_load_dwordx4 a[228:231], v36, s[8:11], s62 offen offset:1024 sc1
    v_accvgpr_read_b32 v60, a148
    v_cvt_pk_bf16_f32 v112, v112, v113
    v_mfma_f32_16x16x32_bf16 a[160:163], a[88:91], a[112:115], a[160:163]
    v_accvgpr_read_b32 v61, a149
    v_accvgpr_read_b32 v62, a150
    v_cvt_pk_bf16_f32 v113, v114, v115
    v_mfma_f32_16x16x32_bf16 a[164:167], a[92:95], a[112:115], a[164:167]
    v_accvgpr_read_b32 v63, a151
    v_cvt_pk_bf16_f32 v114, v208, v209
    v_cvt_pk_bf16_f32 v168, v56, v57
    v_mfma_f32_16x16x32_bf16 v[128:131], a[80:83], a[96:99], v[128:131]
    v_cvt_pk_bf16_f32 v115, v210, v211
    v_cvt_pk_bf16_f32 v169, v58, v59
    v_cvt_pk_bf16_f32 v116, v116, v117
    v_mfma_f32_16x16x32_bf16 v[224:227], a[84:87], a[96:99], v[224:227]
    buffer_load_dwordx4 a[232:235], v37, s[8:11], s62 offen offset:0 sc1
    v_cvt_pk_bf16_f32 v170, v60, v61
    v_cvt_pk_bf16_f32 v117, v118, v119
    v_mfma_f32_16x16x32_bf16 v[132:135], a[80:83], a[100:103], v[132:135]
    v_cvt_pk_bf16_f32 v171, v62, v63
    v_cvt_pk_bf16_f32 v118, v212, v213
    v_cvt_pk_bf16_f32 v119, v214, v215
    v_mfma_f32_16x16x32_bf16 v[228:231], a[84:87], a[100:103], v[228:231]
    buffer_load_dwordx4 a[236:239], v37, s[8:11], s62 offen offset:1024 sc1
    v_accvgpr_read_b32 v56, a152
    v_accvgpr_read_b32 v57, a153
    v_mfma_f32_16x16x32_bf16 a[168:171], a[88:91], a[116:119], a[168:171]
    s_add_u32 s62, s62, 0x20000
    v_accvgpr_read_b32 v58, a154
    v_accvgpr_read_b32 v59, a155
    v_accvgpr_read_b32 v60, a156
    v_mfma_f32_16x16x32_bf16 a[172:175], a[92:95], a[116:119], a[172:175]
    s_waitcnt vmcnt(16)
    s_barrier
    v_cvt_pk_bf16_f32 v120, v120, v121
    v_accvgpr_read_b32 v61, a157
    v_accvgpr_read_b32 v62, a158
    v_mfma_f32_16x16x32_bf16 v[136:139], a[80:83], a[104:107], v[136:139]
    v_cvt_pk_bf16_f32 v121, v122, v123
    v_accvgpr_read_b32 v63, a159
    v_cvt_pk_bf16_f32 v122, v216, v217
    v_mfma_f32_16x16x32_bf16 v[232:235], a[84:87], a[104:107], v[232:235]
    v_cvt_pk_bf16_f32 v172, v56, v57
    v_cvt_pk_bf16_f32 v123, v218, v219
    v_cvt_pk_bf16_f32 v173, v58, v59
    v_mfma_f32_16x16x32_bf16 v[140:143], a[80:83], a[108:111], v[140:143]
    v_cvt_pk_bf16_f32 v124, v124, v125
    v_cvt_pk_bf16_f32 v174, v60, v61
    v_cvt_pk_bf16_f32 v125, v126, v127
    v_mfma_f32_16x16x32_bf16 v[236:239], a[84:87], a[108:111], v[236:239]
    v_cvt_pk_bf16_f32 v175, v62, v63
    v_cvt_pk_bf16_f32 v126, v220, v221
    v_cvt_pk_bf16_f32 v127, v222, v223
    v_mfma_f32_16x16x32_bf16 a[176:179], a[88:91], a[120:123], a[176:179]
    ds_read_b64_tr_b16 a[0:1], v42 offset:0
    v_accvgpr_read_b32 v56, a160
    v_accvgpr_read_b32 v57, a161
    v_mfma_f32_16x16x32_bf16 a[180:183], a[92:95], a[120:123], a[180:183]
    ds_read_b64_tr_b16 a[2:3], v42 offset:1024
    v_accvgpr_read_b32 v58, a162
    v_accvgpr_read_b32 v59, a163
    v_mfma_f32_16x16x32_bf16 v[144:147], a[80:83], a[112:115], v[144:147]
    ds_read_b64_tr_b16 a[4:5], v43 offset:0
    v_accvgpr_read_b32 v60, a164
    v_cvt_pk_bf16_f32 v128, v128, v129
    v_mfma_f32_16x16x32_bf16 v[240:243], a[84:87], a[112:115], v[240:243]
    v_accvgpr_read_b32 v61, a165
    v_accvgpr_read_b32 v62, a166
    v_cvt_pk_bf16_f32 v129, v130, v131
    v_mfma_f32_16x16x32_bf16 v[148:151], a[80:83], a[116:119], v[148:151]
    ds_read_b64_tr_b16 a[6:7], v43 offset:1024
    v_accvgpr_read_b32 v63, a167
    v_cvt_pk_bf16_f32 v130, v224, v225
    v_mfma_f32_16x16x32_bf16 v[244:247], a[84:87], a[116:119], v[244:247]
    v_cvt_pk_bf16_f32 v176, v56, v57
    v_cvt_pk_bf16_f32 v131, v226, v227
    v_cvt_pk_bf16_f32 v177, v58, v59
    v_mfma_f32_16x16x32_bf16 a[184:187], a[88:91], a[124:127], a[184:187]
    ds_read_b64_tr_b16 a[8:9], v44 offset:0
    v_cvt_pk_bf16_f32 v132, v132, v133
    v_cvt_pk_bf16_f32 v178, v60, v61
    v_mfma_f32_16x16x32_bf16 a[188:191], a[92:95], a[124:127], a[188:191]
    ds_read_b64_tr_b16 a[10:11], v44 offset:1024
    v_cvt_pk_bf16_f32 v133, v134, v135
    v_cvt_pk_bf16_f32 v179, v62, v63
    v_mfma_f32_16x16x32_bf16 v[152:155], a[80:83], a[120:123], v[152:155]
    ds_read_b64_tr_b16 a[12:13], v45 offset:0
    v_cvt_pk_bf16_f32 v134, v228, v229
    v_cvt_pk_bf16_f32 v135, v230, v231
    v_mfma_f32_16x16x32_bf16 v[248:251], a[84:87], a[120:123], v[248:251]
    ds_read_b64_tr_b16 a[14:15], v45 offset:1024
    v_accvgpr_read_b32 v56, a168
    v_accvgpr_read_b32 v57, a169
    v_mfma_f32_16x16x32_bf16 v[156:159], a[80:83], a[124:127], v[156:159]
    ds_read_b64_tr_b16 a[16:17], v46 offset:0
    v_accvgpr_read_b32 v58, a170
    v_accvgpr_read_b32 v59, a171
    v_mfma_f32_16x16x32_bf16 v[252:255], a[84:87], a[124:127], v[252:255]
    v_accvgpr_read_b32 v60, a172
    v_cvt_pk_bf16_f32 v136, v136, v137
    v_accvgpr_read_b32 v61, a173
    ds_read_b64_tr_b16 a[18:19], v46 offset:1024
    v_accvgpr_read_b32 v62, a174
    v_cvt_pk_bf16_f32 v137, v138, v139
    v_accvgpr_read_b32 v63, a175
    v_cvt_pk_bf16_f32 v138, v232, v233
    v_cvt_pk_bf16_f32 v180, v56, v57
    ds_read_b64_tr_b16 a[20:21], v47 offset:0
    v_cvt_pk_bf16_f32 v139, v234, v235
    v_cvt_pk_bf16_f32 v181, v58, v59
    v_cvt_pk_bf16_f32 v140, v140, v141
    v_cvt_pk_bf16_f32 v182, v60, v61
    ds_read_b64_tr_b16 a[22:23], v47 offset:1024
    v_cvt_pk_bf16_f32 v141, v142, v143
    v_cvt_pk_bf16_f32 v183, v62, v63
    v_cvt_pk_bf16_f32 v142, v236, v237
    ds_read_b64_tr_b16 a[24:25], v48 offset:0
    v_cvt_pk_bf16_f32 v143, v238, v239
    v_accvgpr_read_b32 v56, a176
    ds_read_b64_tr_b16 a[26:27], v48 offset:1024
    v_accvgpr_read_b32 v57, a177
    v_accvgpr_read_b32 v58, a178
    ds_read_b64_tr_b16 a[28:29], v49 offset:0
    v_accvgpr_read_b32 v59, a179
    v_accvgpr_read_b32 v60, a180
    v_cvt_pk_bf16_f32 v144, v144, v145
    ds_read_b64_tr_b16 a[30:31], v49 offset:1024
    v_accvgpr_read_b32 v61, a181
    v_accvgpr_read_b32 v62, a182
    v_cvt_pk_bf16_f32 v145, v146, v147
    v_accvgpr_read_b32 v63, a183
    v_cvt_pk_bf16_f32 v146, v240, v241
    v_cvt_pk_bf16_f32 v184, v56, v57
    v_cvt_pk_bf16_f32 v147, v242, v243
    v_cvt_pk_bf16_f32 v185, v58, v59
    v_cvt_pk_bf16_f32 v148, v148, v149
    v_cvt_pk_bf16_f32 v186, v60, v61
    v_cvt_pk_bf16_f32 v149, v150, v151
    v_cvt_pk_bf16_f32 v187, v62, v63
    v_cvt_pk_bf16_f32 v150, v244, v245
    v_cvt_pk_bf16_f32 v151, v246, v247
    v_accvgpr_read_b32 v56, a184
    v_accvgpr_read_b32 v57, a185
    v_accvgpr_read_b32 v58, a186
    v_accvgpr_read_b32 v59, a187
    v_accvgpr_read_b32 v60, a188
    v_cvt_pk_bf16_f32 v152, v152, v153
    v_accvgpr_read_b32 v61, a189
    v_accvgpr_read_b32 v62, a190
    v_cvt_pk_bf16_f32 v153, v154, v155
    v_accvgpr_read_b32 v63, a191
    v_cvt_pk_bf16_f32 v154, v248, v249
    v_cvt_pk_bf16_f32 v188, v56, v57
    v_cvt_pk_bf16_f32 v155, v250, v251
    v_cvt_pk_bf16_f32 v189, v58, v59
    v_cvt_pk_bf16_f32 v156, v156, v157
    v_cvt_pk_bf16_f32 v190, v60, v61
    v_cvt_pk_bf16_f32 v157, v158, v159
    v_cvt_pk_bf16_f32 v191, v62, v63
    v_cvt_pk_bf16_f32 v158, v252, v253
    v_cvt_pk_bf16_f32 v159, v254, v255
k12_join_7:
k12_qcode:
    s_waitcnt vmcnt(12) lgkmcnt(0)
    v_mfma_f32_16x16x32_bf16 v[192:195], a[0:3], a[192:195], 0
    ds_read_b64_tr_b16 a[32:33], v42 offset:8192
    ds_read_b64_tr_b16 a[34:35], v42 offset:9216
    v_mfma_f32_16x16x32_bf16 v[196:199], a[0:3], a[196:199], 0
    buffer_load_dwordx4 a[240:243], v36, s[8:11], s62 offen offset:0 sc1
    v_mfma_f32_16x16x32_bf16 a[64:67], a[0:3], a[200:203], 0
    ds_read_b64_tr_b16 a[36:37], v43 offset:8192
    v_mfma_f32_16x16x32_bf16 a[68:71], a[0:3], a[204:207], 0
    ds_read_b64_tr_b16 a[38:39], v43 offset:9216
    v_mfma_f32_16x16x32_bf16 v[200:203], a[4:7], a[192:195], 0
    ds_read_b64_tr_b16 a[40:41], v44 offset:8192
    v_mfma_f32_16x16x32_bf16 v[204:207], a[4:7], a[196:199], 0
    v_mfma_f32_16x16x32_bf16 a[72:75], a[4:7], a[200:203], 0
    s_lshl_b32 s31, s28, 14
    buffer_load_dwordx4 a[244:247], v36, s[8:11], s62 offen offset:1024 sc1
    ds_read_b64_tr_b16 a[42:43], v44 offset:9216
    v_mfma_f32_16x16x32_bf16 a[76:79], a[4:7], a[204:207], 0
    s_add_u32 s16, s6, s31
    s_addc_u32 s17, s7, 0
    ds_read_b64_tr_b16 a[44:45], v45 offset:8192
    v_mfma_f32_16x16x32_bf16 v[208:211], a[8:11], a[192:195], 0
    v_mfma_f32_16x16x32_bf16 v[212:215], a[8:11], a[196:199], 0
    s_add_u32 s20, s16, 0x2000000
    s_addc_u32 s21, s17, 0
    ds_read_b64_tr_b16 a[46:47], v45 offset:9216
    v_mfma_f32_16x16x32_bf16 a[80:83], a[8:11], a[200:203], 0
    ds_read_b64_tr_b16 a[48:49], v46 offset:8192
    v_mfma_f32_16x16x32_bf16 a[84:87], a[8:11], a[204:207], 0
    s_add_u32 s16, s16, 0x1000000
    s_addc_u32 s17, s17, 0
    ds_read_b64_tr_b16 a[50:51], v46 offset:9216
    v_mfma_f32_16x16x32_bf16 v[216:219], a[12:15], a[192:195], 0
    buffer_load_dwordx4 a[248:251], v37, s[8:11], s62 offen offset:0 sc1
    v_mfma_f32_16x16x32_bf16 v[220:223], a[12:15], a[196:199], 0
    s_and_b32 s17, s17, 0xffff
    ds_read_b64_tr_b16 a[52:53], v47 offset:8192
    v_mfma_f32_16x16x32_bf16 a[88:91], a[12:15], a[200:203], 0
    ds_read_b64_tr_b16 a[54:55], v47 offset:9216
    v_mfma_f32_16x16x32_bf16 a[92:95], a[12:15], a[204:207], 0
    s_and_b32 s21, s21, 0xffff
    ds_read_b64_tr_b16 a[56:57], v48 offset:8192
    v_mfma_f32_16x16x32_bf16 v[224:227], a[16:19], a[192:195], 0
    v_mfma_f32_16x16x32_bf16 v[228:231], a[16:19], a[196:199], 0
    s_lshl_b32 s31, s29, 20
    buffer_load_dwordx4 a[252:255], v37, s[8:11], s62 offen offset:1024 sc1
    ds_read_b64_tr_b16 a[58:59], v48 offset:9216
    v_mfma_f32_16x16x32_bf16 a[96:99], a[16:19], a[200:203], 0
    ds_read_b64_tr_b16 a[60:61], v49 offset:8192
    v_mfma_f32_16x16x32_bf16 a[100:103], a[16:19], a[204:207], 0
    s_sub_u32 s18, 0xf84000, s31
    v_mfma_f32_16x16x32_bf16 v[232:235], a[20:23], a[192:195], 0
    ds_read_b64_tr_b16 a[62:63], v49 offset:9216
    v_mfma_f32_16x16x32_bf16 v[236:239], a[20:23], a[196:199], 0
    s_mov_b32 s22, s18
    v_mfma_f32_16x16x32_bf16 a[104:107], a[20:23], a[200:203], 0
    s_add_u32 s62, s62, 0x20000
    v_mfma_f32_16x16x32_bf16 a[108:111], a[20:23], a[204:207], 0
    s_add_u32 s52, s47, 0
    v_mfma_f32_16x16x32_bf16 v[240:243], a[24:27], a[192:195], 0
    s_add_u32 s24, s6, 0x4806000
    s_addc_u32 s25, s7, 0
    buffer_store_dwordx4 v[64:67], v1, s[32:35], s52 offen offset:0 sc1
    v_mfma_f32_16x16x32_bf16 v[244:247], a[24:27], a[196:199], 0
    s_and_b32 s25, s25, 0xffff
    v_mfma_f32_16x16x32_bf16 a[112:115], a[24:27], a[200:203], 0
    v_mfma_f32_16x16x32_bf16 a[116:119], a[24:27], a[204:207], 0
    s_mov_b32 s26, 4096
    v_mfma_f32_16x16x32_bf16 v[248:251], a[28:31], a[192:195], 0
    v_mfma_f32_16x16x32_bf16 v[252:255], a[28:31], a[196:199], 0
    v_mfma_f32_16x16x32_bf16 a[120:123], a[28:31], a[200:203], 0
    v_mfma_f32_16x16x32_bf16 a[124:127], a[28:31], a[204:207], 0
    s_waitcnt vmcnt(9) lgkmcnt(0)
    s_barrier
    v_mfma_f32_16x16x32_bf16 v[192:195], a[32:35], a[208:211], v[192:195]
    ds_read_b64_tr_b16 a[0:1], v42 offset:16384
    ds_read_b64_tr_b16 a[2:3], v42 offset:17408
    v_mfma_f32_16x16x32_bf16 v[196:199], a[32:35], a[212:215], v[196:199]
    s_add_u32 m0, s60, 131072
    v_mfma_f32_16x16x32_bf16 a[64:67], a[32:35], a[216:219], a[64:67]
    buffer_load_dwordx4 v38, s[12:15], s61 offen offset:0 lds
    ds_read_b64_tr_b16 a[4:5], v43 offset:16384
    v_mfma_f32_16x16x32_bf16 a[68:71], a[32:35], a[220:223], a[68:71]
    ds_read_b64_tr_b16 a[6:7], v43 offset:17408
    v_mfma_f32_16x16x32_bf16 v[200:203], a[36:39], a[208:211], v[200:203]
    buffer_load_dwordx4 v39, s[12:15], s61 offen offset:1024 lds
    ds_read_b64_tr_b16 a[8:9], v44 offset:16384
    v_mfma_f32_16x16x32_bf16 v[204:207], a[36:39], a[212:215], v[204:207]
    v_mfma_f32_16x16x32_bf16 a[72:75], a[36:39], a[216:219], a[72:75]
    buffer_load_dwordx4 v40, s[12:15], s61 offen offset:2048 lds
    ds_read_b64_tr_b16 a[10:11], v44 offset:17408
    v_mfma_f32_16x16x32_bf16 a[76:79], a[36:39], a[220:223], a[76:79]
    ds_read_b64_tr_b16 a[12:13], v45 offset:16384
    v_mfma_f32_16x16x32_bf16 v[208:211], a[40:43], a[208:211], v[208:211]
    v_mfma_f32_16x16x32_bf16 v[212:215], a[40:43], a[212:215], v[212:215]
    buffer_load_dwordx4 v41, s[12:15], s61 offen offset:3072 lds
    ds_read_b64_tr_b16 a[14:15], v45 offset:17408
    v_mfma_f32_16x16x32_bf16 a[80:83], a[40:43], a[216:219], a[80:83]
    ds_read_b64_tr_b16 a[16:17], v46 offset:16384
    v_mfma_f32_16x16x32_bf16 a[84:87], a[40:43], a[220:223], a[84:87]
    s_add_u32 s61, s61, 0x80000
    ds_read_b64_tr_b16 a[18:19], v46 offset:17408
    v_mfma_f32_16x16x32_bf16 v[216:219], a[44:47], a[208:211], v[216:219]
    buffer_load_dwordx4 a[128:131], v36, s[8:11], s62 offen offset:0 sc1
    v_mfma_f32_16x16x32_bf16 v[220:223], a[44:47], a[212:215], v[220:223]
    ds_read_b64_tr_b16 a[20:21], v47 offset:16384
    v_mfma_f32_16x16x32_bf16 a[88:91], a[44:47], a[216:219], a[88:91]
    buffer_load_dwordx4 a[132:135], v36, s[8:11], s62 offen offset:1024 sc1
    ds_read_b64_tr_b16 a[22:23], v47 offset:17408
    v_mfma_f32_16x16x32_bf16 a[92:95], a[44:47], a[220:223], a[92:95]
    ds_read_b64_tr_b16 a[24:25], v48 offset:16384
    v_mfma_f32_16x16x32_bf16 v[224:227], a[48:51], a[208:211], v[224:227]
    v_mfma_f32_16x16x32_bf16 v[228:231], a[48:51], a[212:215], v[228:231]
    buffer_load_dwordx4 a[136:139], v37, s[8:11], s62 offen offset:0 sc1
    ds_read_b64_tr_b16 a[26:27], v48 offset:17408
    v_mfma_f32_16x16x32_bf16 a[96:99], a[48:51], a[216:219], a[96:99]
    ds_read_b64_tr_b16 a[28:29], v49 offset:16384
    v_mfma_f32_16x16x32_bf16 a[100:103], a[48:51], a[220:223], a[100:103]
    v_mfma_f32_16x16x32_bf16 v[232:235], a[52:55], a[208:211], v[232:235]
    buffer_load_dwordx4 a[140:143], v37, s[8:11], s62 offen offset:1024 sc1
    ds_read_b64_tr_b16 a[30:31], v49 offset:17408
    v_mfma_f32_16x16x32_bf16 v[236:239], a[52:55], a[212:215], v[236:239]
    v_mfma_f32_16x16x32_bf16 a[104:107], a[52:55], a[216:219], a[104:107]
    s_add_u32 s62, s62, 0x20000
    v_mfma_f32_16x16x32_bf16 a[108:111], a[52:55], a[220:223], a[108:111]
    s_add_u32 s52, s47, 0
    v_mfma_f32_16x16x32_bf16 v[240:243], a[56:59], a[208:211], v[240:243]
    buffer_store_dwordx4 v[68:71], v1, s[32:35], s52 offen offset:1024 sc1
    v_mfma_f32_16x16x32_bf16 v[244:247], a[56:59], a[212:215], v[244:247]
    s_add_u32 s52, s47, 0
    v_mfma_f32_16x16x32_bf16 a[112:115], a[56:59], a[216:219], a[112:115]
    buffer_store_dwordx4 v[72:75], v1, s[32:35], s52 offen offset:2048 sc1
    v_mfma_f32_16x16x32_bf16 a[116:119], a[56:59], a[220:223], a[116:119]
    v_mfma_f32_16x16x32_bf16 v[248:251], a[60:63], a[208:211], v[248:251]
    v_mfma_f32_16x16x32_bf16 v[252:255], a[60:63], a[212:215], v[252:255]
    v_mfma_f32_16x16x32_bf16 a[120:123], a[60:63], a[216:219], a[120:123]
    v_mfma_f32_16x16x32_bf16 a[124:127], a[60:63], a[220:223], a[124:127]
    s_waitcnt vmcnt(15) lgkmcnt(0)
    v_mfma_f32_16x16x32_bf16 v[192:195], a[0:3], a[224:227], v[192:195]
    ds_read_b64_tr_b16 a[32:33], v42 offset:24576
    ds_read_b64_tr_b16 a[34:35], v42 offset:25600
    v_mfma_f32_16x16x32_bf16 v[196:199], a[0:3], a[228:231], v[196:199]
    buffer_load_dwordx4 a[144:147], v36, s[8:11], s62 offen offset:0 sc1
    v_mfma_f32_16x16x32_bf16 a[64:67], a[0:3], a[232:235], a[64:67]
    ds_read_b64_tr_b16 a[36:37], v43 offset:24576
    v_mfma_f32_16x16x32_bf16 a[68:71], a[0:3], a[236:239], a[68:71]
    ds_read_b64_tr_b16 a[38:39], v43 offset:25600
    v_mfma_f32_16x16x32_bf16 v[200:203], a[4:7], a[224:227], v[200:203]
    ds_read_b64_tr_b16 a[40:41], v44 offset:24576
    v_mfma_f32_16x16x32_bf16 v[204:207], a[4:7], a[228:231], v[204:207]
    v_mfma_f32_16x16x32_bf16 a[72:75], a[4:7], a[232:235], a[72:75]
    buffer_load_dwordx4 a[148:151], v36, s[8:11], s62 offen offset:1024 sc1
    ds_read_b64_tr_b16 a[42:43], v44 offset:25600
    v_mfma_f32_16x16x32_bf16 a[76:79], a[4:7], a[236:239], a[76:79]
    ds_read_b64_tr_b16 a[44:45], v45 offset:24576
    v_mfma_f32_16x16x32_bf16 v[208:211], a[8:11], a[224:227], v[208:211]
    v_mfma_f32_16x16x32_bf16 v[212:215], a[8:11], a[228:231], v[212:215]
    ds_read_b64_tr_b16 a[46:47], v45 offset:25600
    v_mfma_f32_16x16x32_bf16 a[80:83], a[8:11], a[232:235], a[80:83]
    ds_read_b64_tr_b16 a[48:49], v46 offset:24576
    v_mfma_f32_16x16x32_bf16 a[84:87], a[8:11], a[236:239], a[84:87]
    ds_read_b64_tr_b16 a[50:51], v46 offset:25600
    v_mfma_f32_16x16x32_bf16 v[216:219], a[12:15], a[224:227], v[216:219]
    buffer_load_dwordx4 a[152:155], v37, s[8:11], s62 offen offset:0 sc1
    v_mfma_f32_16x16x32_bf16 v[220:223], a[12:15], a[228:231], v[220:223]
    ds_read_b64_tr_b16 a[52:53], v47 offset:24576
    v_mfma_f32_16x16x32_bf16 a[88:91], a[12:15], a[232:235], a[88:91]
    ds_read_b64_tr_b16 a[54:55], v47 offset:25600
    v_mfma_f32_16x16x32_bf16 a[92:95], a[12:15], a[236:239], a[92:95]
    ds_read_b64_tr_b16 a[56:57], v48 offset:24576
    v_mfma_f32_16x16x32_bf16 v[224:227], a[16:19], a[224:227], v[224:227]
    v_mfma_f32_16x16x32_bf16 v[228:231], a[16:19], a[228:231], v[228:231]
    buffer_load_dwordx4 a[156:159], v37, s[8:11], s62 offen offset:1024 sc1
    ds_read_b64_tr_b16 a[58:59], v48 offset:25600
    v_mfma_f32_16x16x32_bf16 a[96:99], a[16:19], a[232:235], a[96:99]
    ds_read_b64_tr_b16 a[60:61], v49 offset:24576
    v_mfma_f32_16x16x32_bf16 a[100:103], a[16:19], a[236:239], a[100:103]
    v_mfma_f32_16x16x32_bf16 v[232:235], a[20:23], a[224:227], v[232:235]
    ds_read_b64_tr_b16 a[62:63], v49 offset:25600
    v_mfma_f32_16x16x32_bf16 v[236:239], a[20:23], a[228:231], v[236:239]
    v_mfma_f32_16x16x32_bf16 a[104:107], a[20:23], a[232:235], a[104:107]
    s_add_u32 s62, s62, 0x20000
    v_mfma_f32_16x16x32_bf16 a[108:111], a[20:23], a[236:239], a[108:111]
    s_add_u32 s52, s47, 0
    v_mfma_f32_16x16x32_bf16 v[240:243], a[24:27], a[224:227], v[240:243]
    buffer_store_dwordx4 v[76:79], v1, s[32:35], s52 offen offset:3072 sc1
    v_mfma_f32_16x16x32_bf16 v[244:247], a[24:27], a[228:231], v[244:247]
    v_mfma_f32_16x16x32_bf16 a[112:115], a[24:27], a[232:235], a[112:115]
    v_mfma_f32_16x16x32_bf16 a[116:119], a[24:27], a[236:239], a[116:119]
    v_mfma_f32_16x16x32_bf16 v[248:251], a[28:31], a[224:227], v[248:251]
    v_mfma_f32_16x16x32_bf16 v[252:255], a[28:31], a[228:231], v[252:255]
    v_mfma_f32_16x16x32_bf16 a[120:123], a[28:31], a[232:235], a[120:123]
    v_mfma_f32_16x16x32_bf16 a[124:127], a[28:31], a[236:239], a[124:127]
    s_waitcnt vmcnt(11) lgkmcnt(0)
    s_barrier
    v_mfma_f32_16x16x32_bf16 v[192:195], a[32:35], a[240:243], v[192:195]
    ds_read_b64_tr_b16 a[0:1], v42 offset:32768
    ds_read_b64_tr_b16 a[2:3], v42 offset:33792
    v_mfma_f32_16x16x32_bf16 v[196:199], a[32:35], a[244:247], v[196:199]
    s_add_u32 m0, s60, 147456
    v_mfma_f32_16x16x32_bf16 a[64:67], a[32:35], a[248:251], a[64:67]
    buffer_load_dwordx4 v38, s[12:15], s61 offen offset:0 lds
    ds_read_b64_tr_b16 a[4:5], v43 offset:32768
    v_mfma_f32_16x16x32_bf16 a[68:71], a[32:35], a[252:255], a[68:71]
    ds_read_b64_tr_b16 a[6:7], v43 offset:33792
    v_mfma_f32_16x16x32_bf16 v[200:203], a[36:39], a[240:243], v[200:203]
    buffer_load_dwordx4 v39, s[12:15], s61 offen offset:1024 lds
    ds_read_b64_tr_b16 a[8:9], v44 offset:32768
    v_mfma_f32_16x16x32_bf16 v[204:207], a[36:39], a[244:247], v[204:207]
    v_mfma_f32_16x16x32_bf16 a[72:75], a[36:39], a[248:251], a[72:75]
    buffer_load_dwordx4 v40, s[12:15], s61 offen offset:2048 lds
    ds_read_b64_tr_b16 a[10:11], v44 offset:33792
    v_mfma_f32_16x16x32_bf16 a[76:79], a[36:39], a[252:255], a[76:79]
    ds_read_b64_tr_b16 a[12:13], v45 offset:32768
    v_mfma_f32_16x16x32_bf16 v[208:211], a[40:43], a[240:243], v[208:211]
    v_mfma_f32_16x16x32_bf16 v[212:215], a[40:43], a[244:247], v[212:215]
    buffer_load_dwordx4 v41, s[12:15], s61 offen offset:3072 lds
    ds_read_b64_tr_b16 a[14:15], v45 offset:33792
    v_mfma_f32_16x16x32_bf16 a[80:83], a[40:43], a[248:251], a[80:83]
    ds_read_b64_tr_b16 a[16:17], v46 offset:32768
    v_mfma_f32_16x16x32_bf16 a[84:87], a[40:43], a[252:255], a[84:87]
    s_add_u32 s61, s61, 0x80000
    ds_read_b64_tr_b16 a[18:19], v46 offset:33792
    v_mfma_f32_16x16x32_bf16 v[216:219], a[44:47], a[240:243], v[216:219]
    buffer_load_dwordx4 a[160:163], v36, s[8:11], s62 offen offset:0 sc1
    v_mfma_f32_16x16x32_bf16 v[220:223], a[44:47], a[244:247], v[220:223]
    ds_read_b64_tr_b16 a[20:21], v47 offset:32768
    v_mfma_f32_16x16x32_bf16 a[88:91], a[44:47], a[248:251], a[88:91]
    buffer_load_dwordx4 a[164:167], v36, s[8:11], s62 offen offset:1024 sc1
    ds_read_b64_tr_b16 a[22:23], v47 offset:33792
    v_mfma_f32_16x16x32_bf16 a[92:95], a[44:47], a[252:255], a[92:95]
    ds_read_b64_tr_b16 a[24:25], v48 offset:32768
    v_mfma_f32_16x16x32_bf16 v[224:227], a[48:51], a[240:243], v[224:227]
    v_mfma_f32_16x16x32_bf16 v[228:231], a[48:51], a[244:247], v[228:231]
    buffer_load_dwordx4 a[168:171], v37, s[8:11], s62 offen offset:0 sc1
    ds_read_b64_tr_b16 a[26:27], v48 offset:33792
    v_mfma_f32_16x16x32_bf16 a[96:99], a[48:51], a[248:251], a[96:99]
    ds_read_b64_tr_b16 a[28:29], v49 offset:32768
    v_mfma_f32_16x16x32_bf16 a[100:103], a[48:51], a[252:255], a[100:103]
    v_mfma_f32_16x16x32_bf16 v[232:235], a[52:55], a[240:243], v[232:235]
    buffer_load_dwordx4 a[172:175], v37, s[8:11], s62 offen offset:1024 sc1
    ds_read_b64_tr_b16 a[30:31], v49 offset:33792
    v_mfma_f32_16x16x32_bf16 v[236:239], a[52:55], a[244:247], v[236:239]
    v_mfma_f32_16x16x32_bf16 a[104:107], a[52:55], a[248:251], a[104:107]
    s_add_u32 s62, s62, 0x20000
    v_mfma_f32_16x16x32_bf16 a[108:111], a[52:55], a[252:255], a[108:111]
    s_add_u32 s52, s47, 4096
    v_mfma_f32_16x16x32_bf16 v[240:243], a[56:59], a[240:243], v[240:243]
    buffer_store_dwordx4 v[80:83], v1, s[32:35], s52 offen offset:0 sc1
    v_mfma_f32_16x16x32_bf16 v[244:247], a[56:59], a[244:247], v[244:247]
    s_add_u32 s52, s47, 4096
    v_mfma_f32_16x16x32_bf16 a[112:115], a[56:59], a[248:251], a[112:115]
    buffer_store_dwordx4 v[84:87], v1, s[32:35], s52 offen offset:1024 sc1
    v_mfma_f32_16x16x32_bf16 a[116:119], a[56:59], a[252:255], a[116:119]
    v_mfma_f32_16x16x32_bf16 v[248:251], a[60:63], a[240:243], v[248:251]
    v_mfma_f32_16x16x32_bf16 v[252:255], a[60:63], a[244:247], v[252:255]
    v_mfma_f32_16x16x32_bf16 a[120:123], a[60:63], a[248:251], a[120:123]
    v_mfma_f32_16x16x32_bf16 a[124:127], a[60:63], a[252:255], a[124:127]
    s_waitcnt vmcnt(17) lgkmcnt(0)
    v_mfma_f32_16x16x32_bf16 v[192:195], a[0:3], a[128:131], v[192:195]
    ds_read_b64_tr_b16 a[32:33], v42 offset:40960
    ds_read_b64_tr_b16 a[34:35], v42 offset:41984
    v_mfma_f32_16x16x32_bf16 v[196:199], a[0:3], a[132:135], v[196:199]
    buffer_load_dwordx4 a[176:179], v36, s[8:11], s62 offen offset:0 sc1
    v_mfma_f32_16x16x32_bf16 a[64:67], a[0:3], a[136:139], a[64:67]
    ds_read_b64_tr_b16 a[36:37], v43 offset:40960
    v_mfma_f32_16x16x32_bf16 a[68:71], a[0:3], a[140:143], a[68:71]
    ds_read_b64_tr_b16 a[38:39], v43 offset:41984
    v_mfma_f32_16x16x32_bf16 v[200:203], a[4:7], a[128:131], v[200:203]
    ds_read_b64_tr_b16 a[40:41], v44 offset:40960
    v_mfma_f32_16x16x32_bf16 v[204:207], a[4:7], a[132:135], v[204:207]
    buffer_load_dwordx4 a[180:183], v36, s[8:11], s62 offen offset:1024 sc1
    v_mfma_f32_16x16x32_bf16 a[72:75], a[4:7], a[136:139], a[72:75]
    ds_read_b64_tr_b16 a[42:43], v44 offset:41984
    v_mfma_f32_16x16x32_bf16 a[76:79], a[4:7], a[140:143], a[76:79]
    ds_read_b64_tr_b16 a[44:45], v45 offset:40960
    v_mfma_f32_16x16x32_bf16 v[208:211], a[8:11], a[128:131], v[208:211]
    v_mfma_f32_16x16x32_bf16 v[212:215], a[8:11], a[132:135], v[212:215]
    ds_read_b64_tr_b16 a[46:47], v45 offset:41984
    v_mfma_f32_16x16x32_bf16 a[80:83], a[8:11], a[136:139], a[80:83]
    buffer_load_dwordx4 a[184:187], v37, s[8:11], s62 offen offset:0 sc1
    ds_read_b64_tr_b16 a[48:49], v46 offset:40960
    v_mfma_f32_16x16x32_bf16 a[84:87], a[8:11], a[140:143], a[84:87]
    ds_read_b64_tr_b16 a[50:51], v46 offset:41984
    v_mfma_f32_16x16x32_bf16 v[216:219], a[12:15], a[128:131], v[216:219]
    v_mfma_f32_16x16x32_bf16 v[220:223], a[12:15], a[132:135], v[220:223]
    ds_read_b64_tr_b16 a[52:53], v47 offset:40960
    v_mfma_f32_16x16x32_bf16 a[88:91], a[12:15], a[136:139], a[88:91]
    buffer_load_dwordx4 a[188:191], v37, s[8:11], s62 offen offset:1024 sc1
    ds_read_b64_tr_b16 a[54:55], v47 offset:41984
    v_mfma_f32_16x16x32_bf16 a[92:95], a[12:15], a[140:143], a[92:95]
    ds_read_b64_tr_b16 a[56:57], v48 offset:40960
    v_mfma_f32_16x16x32_bf16 v[224:227], a[16:19], a[128:131], v[224:227]
    v_mfma_f32_16x16x32_bf16 v[228:231], a[16:19], a[132:135], v[228:231]
    ds_read_b64_tr_b16 a[58:59], v48 offset:41984
    v_mfma_f32_16x16x32_bf16 a[96:99], a[16:19], a[136:139], a[96:99]
    s_add_u32 s62, s62, 0x20000
    ds_read_b64_tr_b16 a[60:61], v49 offset:40960
    v_mfma_f32_16x16x32_bf16 a[100:103], a[16:19], a[140:143], a[100:103]
    s_add_u32 s52, s47, 4096
    v_mfma_f32_16x16x32_bf16 v[232:235], a[20:23], a[128:131], v[232:235]
    buffer_store_dwordx4 v[88:91], v1, s[32:35], s52 offen offset:2048 sc1
    ds_read_b64_tr_b16 a[62:63], v49 offset:41984
    v_mfma_f32_16x16x32_bf16 v[236:239], a[20:23], a[132:135], v[236:239]
    s_add_u32 s52, s47, 4096
    v_mfma_f32_16x16x32_bf16 a[104:107], a[20:23], a[136:139], a[104:107]
    v_mfma_f32_16x16x32_bf16 a[108:111], a[20:23], a[140:143], a[108:111]
    buffer_store_dwordx4 v[92:95], v1, s[32:35], s52 offen offset:3072 sc1
    v_mfma_f32_16x16x32_bf16 v[240:243], a[24:27], a[128:131], v[240:243]
    v_mfma_f32_16x16x32_bf16 v[244:247], a[24:27], a[132:135], v[244:247]
    v_mfma_f32_16x16x32_bf16 a[112:115], a[24:27], a[136:139], a[112:115]
    v_mfma_f32_16x16x32_bf16 a[116:119], a[24:27], a[140:143], a[116:119]
    v_mfma_f32_16x16x32_bf16 v[248:251], a[28:31], a[128:131], v[248:251]
    v_mfma_f32_16x16x32_bf16 v[252:255], a[28:31], a[132:135], v[252:255]
    v_mfma_f32_16x16x32_bf16 a[120:123], a[28:31], a[136:139], a[120:123]
    v_mfma_f32_16x16x32_bf16 a[124:127], a[28:31], a[140:143], a[124:127]
    s_waitcnt vmcnt(12) lgkmcnt(0)
    s_barrier
    v_mfma_f32_16x16x32_bf16 v[192:195], a[32:35], a[144:147], v[192:195]
    ds_read_b64_tr_b16 a[0:1], v42 offset:49152
    ds_read_b64_tr_b16 a[2:3], v42 offset:50176
    v_mfma_f32_16x16x32_bf16 v[196:199], a[32:35], a[148:151], v[196:199]
    s_add_u32 m0, s60, 98304
    v_mfma_f32_16x16x32_bf16 a[64:67], a[32:35], a[152:155], a[64:67]
    buffer_load_dwordx4 v38, s[12:15], s61 offen offset:0 lds
    ds_read_b64_tr_b16 a[4:5], v43 offset:49152
    v_mfma_f32_16x16x32_bf16 a[68:71], a[32:35], a[156:159], a[68:71]
    ds_read_b64_tr_b16 a[6:7], v43 offset:50176
    v_mfma_f32_16x16x32_bf16 v[200:203], a[36:39], a[144:147], v[200:203]
    buffer_load_dwordx4 v39, s[12:15], s61 offen offset:1024 lds
    ds_read_b64_tr_b16 a[8:9], v44 offset:49152
    v_mfma_f32_16x16x32_bf16 v[204:207], a[36:39], a[148:151], v[204:207]
    v_mfma_f32_16x16x32_bf16 a[72:75], a[36:39], a[152:155], a[72:75]
    ds_read_b64_tr_b16 a[10:11], v44 offset:50176
    v_mfma_f32_16x16x32_bf16 a[76:79], a[36:39], a[156:159], a[76:79]
    buffer_load_dwordx4 v40, s[12:15], s61 offen offset:2048 lds
    ds_read_b64_tr_b16 a[12:13], v45 offset:49152
    v_mfma_f32_16x16x32_bf16 v[208:211], a[40:43], a[144:147], v[208:211]
    v_mfma_f32_16x16x32_bf16 v[212:215], a[40:43], a[148:151], v[212:215]
    ds_read_b64_tr_b16 a[14:15], v45 offset:50176
    v_mfma_f32_16x16x32_bf16 a[80:83], a[40:43], a[152:155], a[80:83]
    buffer_load_dwordx4 v41, s[12:15], s61 offen offset:3072 lds
    ds_read_b64_tr_b16 a[16:17], v46 offset:49152
    v_mfma_f32_16x16x32_bf16 a[84:87], a[40:43], a[156:159], a[84:87]
    ds_read_b64_tr_b16 a[18:19], v46 offset:50176
    v_mfma_f32_16x16x32_bf16 v[216:219], a[44:47], a[144:147], v[216:219]
    s_add_u32 s61, s61, 0x80000
    v_mfma_f32_16x16x32_bf16 v[220:223], a[44:47], a[148:151], v[220:223]
    buffer_load_dwordx4 a[192:195], v36, s[8:11], s62 offen offset:0 sc1
    ds_read_b64_tr_b16 a[20:21], v47 offset:49152
    v_mfma_f32_16x16x32_bf16 a[88:91], a[44:47], a[152:155], a[88:91]
    ds_read_b64_tr_b16 a[22:23], v47 offset:50176
    v_mfma_f32_16x16x32_bf16 a[92:95], a[44:47], a[156:159], a[92:95]
    ds_read_b64_tr_b16 a[24:25], v48 offset:49152
    v_mfma_f32_16x16x32_bf16 v[224:227], a[48:51], a[144:147], v[224:227]
    buffer_load_dwordx4 a[196:199], v36, s[8:11], s62 offen offset:1024 sc1
    v_mfma_f32_16x16x32_bf16 v[228:231], a[48:51], a[148:151], v[228:231]
    ds_read_b64_tr_b16 a[26:27], v48 offset:50176
    v_mfma_f32_16x16x32_bf16 a[96:99], a[48:51], a[152:155], a[96:99]
    ds_read_b64_tr_b16 a[28:29], v49 offset:49152
    v_mfma_f32_16x16x32_bf16 a[100:103], a[48:51], a[156:159], a[100:103]
    buffer_load_dwordx4 a[200:203], v37, s[8:11], s62 offen offset:0 sc1
    v_mfma_f32_16x16x32_bf16 v[232:235], a[52:55], a[144:147], v[232:235]
    ds_read_b64_tr_b16 a[30:31], v49 offset:50176
    v_mfma_f32_16x16x32_bf16 v[236:239], a[52:55], a[148:151], v[236:239]
    v_mfma_f32_16x16x32_bf16 a[104:107], a[52:55], a[152:155], a[104:107]
    buffer_load_dwordx4 a[204:207], v37, s[8:11], s62 offen offset:1024 sc1
    v_mfma_f32_16x16x32_bf16 a[108:111], a[52:55], a[156:159], a[108:111]
    v_mfma_f32_16x16x32_bf16 v[240:243], a[56:59], a[144:147], v[240:243]
    s_add_u32 s62, s62, 0x20000
    v_mfma_f32_16x16x32_bf16 v[244:247], a[56:59], a[148:151], v[244:247]
    s_add_u32 s52, s47, 8192
    v_mfma_f32_16x16x32_bf16 a[112:115], a[56:59], a[152:155], a[112:115]
    buffer_store_dwordx4 v[96:99], v1, s[32:35], s52 offen offset:0 sc1
    v_mfma_f32_16x16x32_bf16 a[116:119], a[56:59], a[156:159], a[116:119]
    v_mfma_f32_16x16x32_bf16 v[248:251], a[60:63], a[144:147], v[248:251]
    v_mfma_f32_16x16x32_bf16 v[252:255], a[60:63], a[148:151], v[252:255]
    v_mfma_f32_16x16x32_bf16 a[120:123], a[60:63], a[152:155], a[120:123]
    v_mfma_f32_16x16x32_bf16 a[124:127], a[60:63], a[156:159], a[124:127]
    s_waitcnt vmcnt(17) lgkmcnt(0)
    v_mfma_f32_16x16x32_bf16 v[192:195], a[0:3], a[160:163], v[192:195]
    ds_read_b64_tr_b16 a[32:33], v42 offset:57344
    ds_read_b64_tr_b16 a[34:35], v42 offset:58368
    v_mfma_f32_16x16x32_bf16 v[196:199], a[0:3], a[164:167], v[196:199]
    buffer_load_dwordx4 a[208:211], v36, s[8:11], s62 offen offset:0 sc1
    v_mfma_f32_16x16x32_bf16 a[64:67], a[0:3], a[168:171], a[64:67]
    ds_read_b64_tr_b16 a[36:37], v43 offset:57344
    v_mfma_f32_16x16x32_bf16 a[68:71], a[0:3], a[172:175], a[68:71]
    ds_read_b64_tr_b16 a[38:39], v43 offset:58368
    v_mfma_f32_16x16x32_bf16 v[200:203], a[4:7], a[160:163], v[200:203]
    ds_read_b64_tr_b16 a[40:41], v44 offset:57344
    v_mfma_f32_16x16x32_bf16 v[204:207], a[4:7], a[164:167], v[204:207]
    buffer_load_dwordx4 a[212:215], v36, s[8:11], s62 offen offset:1024 sc1
    v_mfma_f32_16x16x32_bf16 a[72:75], a[4:7], a[168:171], a[72:75]
    ds_read_b64_tr_b16 a[42:43], v44 offset:58368
    v_mfma_f32_16x16x32_bf16 a[76:79], a[4:7], a[172:175], a[76:79]
    ds_read_b64_tr_b16 a[44:45], v45 offset:57344
    v_mfma_f32_16x16x32_bf16 v[208:211], a[8:11], a[160:163], v[208:211]
    v_mfma_f32_16x16x32_bf16 v[212:215], a[8:11], a[164:167], v[212:215]
    ds_read_b64_tr_b16 a[46:47], v45 offset:58368
    v_mfma_f32_16x16x32_bf16 a[80:83], a[8:11], a[168:171], a[80:83]
    buffer_load_dwordx4 a[216:219], v37, s[8:11], s62 offen offset:0 sc1
    ds_read_b64_tr_b16 a[48:49], v46 offset:57344
    v_mfma_f32_16x16x32_bf16 a[84:87], a[8:11], a[172:175], a[84:87]
    ds_read_b64_tr_b16 a[50:51], v46 offset:58368
    v_mfma_f32_16x16x32_bf16 v[216:219], a[12:15], a[160:163], v[216:219]
    v_mfma_f32_16x16x32_bf16 v[220:223], a[12:15], a[164:167], v[220:223]
    ds_read_b64_tr_b16 a[52:53], v47 offset:57344
    v_mfma_f32_16x16x32_bf16 a[88:91], a[12:15], a[168:171], a[88:91]
    buffer_load_dwordx4 a[220:223], v37, s[8:11], s62 offen offset:1024 sc1
    ds_read_b64_tr_b16 a[54:55], v47 offset:58368
    v_mfma_f32_16x16x32_bf16 a[92:95], a[12:15], a[172:175], a[92:95]
    ds_read_b64_tr_b16 a[56:57], v48 offset:57344
    v_mfma_f32_16x16x32_bf16 v[224:227], a[16:19], a[160:163], v[224:227]
    v_mfma_f32_16x16x32_bf16 v[228:231], a[16:19], a[164:167], v[228:231]
    ds_read_b64_tr_b16 a[58:59], v48 offset:58368
    v_mfma_f32_16x16x32_bf16 a[96:99], a[16:19], a[168:171], a[96:99]
    s_add_u32 s62, s62, 0x20000
    ds_read_b64_tr_b16 a[60:61], v49 offset:57344
    v_mfma_f32_16x16x32_bf16 a[100:103], a[16:19], a[172:175], a[100:103]
    s_add_u32 s52, s47, 8192
    v_mfma_f32_16x16x32_bf16 v[232:235], a[20:23], a[160:163], v[232:235]
    buffer_store_dwordx4 v[100:103], v1, s[32:35], s52 offen offset:1024 sc1
    ds_read_b64_tr_b16 a[62:63], v49 offset:58368
    v_mfma_f32_16x16x32_bf16 v[236:239], a[20:23], a[164:167], v[236:239]
    s_add_u32 s52, s47, 8192
    v_mfma_f32_16x16x32_bf16 a[104:107], a[20:23], a[168:171], a[104:107]
    v_mfma_f32_16x16x32_bf16 a[108:111], a[20:23], a[172:175], a[108:111]
    buffer_store_dwordx4 v[104:107], v1, s[32:35], s52 offen offset:2048 sc1
    v_mfma_f32_16x16x32_bf16 v[240:243], a[24:27], a[160:163], v[240:243]
    v_mfma_f32_16x16x32_bf16 v[244:247], a[24:27], a[164:167], v[244:247]
    v_mfma_f32_16x16x32_bf16 a[112:115], a[24:27], a[168:171], a[112:115]
    v_mfma_f32_16x16x32_bf16 a[116:119], a[24:27], a[172:175], a[116:119]
    v_mfma_f32_16x16x32_bf16 v[248:251], a[28:31], a[160:163], v[248:251]
    v_mfma_f32_16x16x32_bf16 v[252:255], a[28:31], a[164:167], v[252:255]
    v_mfma_f32_16x16x32_bf16 a[120:123], a[28:31], a[168:171], a[120:123]
    v_mfma_f32_16x16x32_bf16 a[124:127], a[28:31], a[172:175], a[124:127]
    s_waitcnt vmcnt(11) lgkmcnt(0)
    s_barrier
    v_mfma_f32_16x16x32_bf16 v[192:195], a[32:35], a[176:179], v[192:195]
    ds_read_b64_tr_b16 a[0:1], v42 offset:0
    ds_read_b64_tr_b16 a[2:3], v42 offset:1024
    v_mfma_f32_16x16x32_bf16 v[196:199], a[32:35], a[180:183], v[196:199]
    s_add_u32 m0, s60, 114688
    v_mfma_f32_16x16x32_bf16 a[64:67], a[32:35], a[184:187], a[64:67]
    buffer_load_dwordx4 v38, s[12:15], s61 offen offset:0 lds
    ds_read_b64_tr_b16 a[4:5], v43 offset:0
    v_mfma_f32_16x16x32_bf16 a[68:71], a[32:35], a[188:191], a[68:71]
    ds_read_b64_tr_b16 a[6:7], v43 offset:1024
    v_mfma_f32_16x16x32_bf16 v[200:203], a[36:39], a[176:179], v[200:203]
    buffer_load_dwordx4 v39, s[12:15], s61 offen offset:1024 lds
    ds_read_b64_tr_b16 a[8:9], v44 offset:0
    v_mfma_f32_16x16x32_bf16 v[204:207], a[36:39], a[180:183], v[204:207]
    v_mfma_f32_16x16x32_bf16 a[72:75], a[36:39], a[184:187], a[72:75]
    ds_read_b64_tr_b16 a[10:11], v44 offset:1024
    v_mfma_f32_16x16x32_bf16 a[76:79], a[36:39], a[188:191], a[76:79]
    buffer_load_dwordx4 v40, s[12:15], s61 offen offset:2048 lds
    ds_read_b64_tr_b16 a[12:13], v45 offset:0
    v_mfma_f32_16x16x32_bf16 v[208:211], a[40:43], a[176:179], v[208:211]
    v_mfma_f32_16x16x32_bf16 v[212:215], a[40:43], a[180:183], v[212:215]
    ds_read_b64_tr_b16 a[14:15], v45 offset:1024
    v_mfma_f32_16x16x32_bf16 a[80:83], a[40:43], a[184:187], a[80:83]
    buffer_load_dwordx4 v41, s[12:15], s61 offen offset:3072 lds
    ds_read_b64_tr_b16 a[16:17], v46 offset:0
    v_mfma_f32_16x16x32_bf16 a[84:87], a[40:43], a[188:191], a[84:87]
    ds_read_b64_tr_b16 a[18:19], v46 offset:1024
    v_mfma_f32_16x16x32_bf16 v[216:219], a[44:47], a[176:179], v[216:219]
    s_add_u32 s61, s61, 0x80000
    v_mfma_f32_16x16x32_bf16 v[220:223], a[44:47], a[180:183], v[220:223]
    buffer_load_dwordx4 a[224:227], v36, s[8:11], s62 offen offset:0 sc1
    ds_read_b64_tr_b16 a[20:21], v47 offset:0
    v_mfma_f32_16x16x32_bf16 a[88:91], a[44:47], a[184:187], a[88:91]
    ds_read_b64_tr_b16 a[22:23], v47 offset:1024
    v_mfma_f32_16x16x32_bf16 a[92:95], a[44:47], a[188:191], a[92:95]
    ds_read_b64_tr_b16 a[24:25], v48 offset:0
    v_mfma_f32_16x16x32_bf16 v[224:227], a[48:51], a[176:179], v[224:227]
    buffer_load_dwordx4 a[228:231], v36, s[8:11], s62 offen offset:1024 sc1
    v_mfma_f32_16x16x32_bf16 v[228:231], a[48:51], a[180:183], v[228:231]
    ds_read_b64_tr_b16 a[26:27], v48 offset:1024
    v_mfma_f32_16x16x32_bf16 a[96:99], a[48:51], a[184:187], a[96:99]
    ds_read_b64_tr_b16 a[28:29], v49 offset:0
    v_mfma_f32_16x16x32_bf16 a[100:103], a[48:51], a[188:191], a[100:103]
    buffer_load_dwordx4 a[232:235], v37, s[8:11], s62 offen offset:0 sc1
    v_mfma_f32_16x16x32_bf16 v[232:235], a[52:55], a[176:179], v[232:235]
    ds_read_b64_tr_b16 a[30:31], v49 offset:1024
    v_mfma_f32_16x16x32_bf16 v[236:239], a[52:55], a[180:183], v[236:239]
    v_mfma_f32_16x16x32_bf16 a[104:107], a[52:55], a[184:187], a[104:107]
    buffer_load_dwordx4 a[236:239], v37, s[8:11], s62 offen offset:1024 sc1
    v_mfma_f32_16x16x32_bf16 a[108:111], a[52:55], a[188:191], a[108:111]
    v_mfma_f32_16x16x32_bf16 v[240:243], a[56:59], a[176:179], v[240:243]
    s_add_u32 s62, s62, 0x20000
    v_mfma_f32_16x16x32_bf16 v[244:247], a[56:59], a[180:183], v[244:247]
    s_add_u32 s52, s47, 8192
    v_mfma_f32_16x16x32_bf16 a[112:115], a[56:59], a[184:187], a[112:115]
    buffer_store_dwordx4 v[108:111], v1, s[32:35], s52 offen offset:3072 sc1
    v_mfma_f32_16x16x32_bf16 a[116:119], a[56:59], a[188:191], a[116:119]
    v_mfma_f32_16x16x32_bf16 v[248:251], a[60:63], a[176:179], v[248:251]
    v_mfma_f32_16x16x32_bf16 v[252:255], a[60:63], a[180:183], v[252:255]
    v_mfma_f32_16x16x32_bf16 a[120:123], a[60:63], a[184:187], a[120:123]
    v_mfma_f32_16x16x32_bf16 a[124:127], a[60:63], a[188:191], a[124:127]
    s_waitcnt vmcnt(16) lgkmcnt(0)
    v_mfma_f32_16x16x32_bf16 v[192:195], a[0:3], a[192:195], v[192:195]
    ds_read_b64_tr_b16 a[32:33], v42 offset:8192
    ds_read_b64_tr_b16 a[34:35], v42 offset:9216
    v_mfma_f32_16x16x32_bf16 v[196:199], a[0:3], a[196:199], v[196:199]
    buffer_load_dwordx4 a[240:243], v36, s[8:11], s62 offen offset:0 sc1
    v_mfma_f32_16x16x32_bf16 a[64:67], a[0:3], a[200:203], a[64:67]
    ds_read_b64_tr_b16 a[36:37], v43 offset:8192
    v_mfma_f32_16x16x32_bf16 a[68:71], a[0:3], a[204:207], a[68:71]
    ds_read_b64_tr_b16 a[38:39], v43 offset:9216
    v_mfma_f32_16x16x32_bf16 v[200:203], a[4:7], a[192:195], v[200:203]
    ds_read_b64_tr_b16 a[40:41], v44 offset:8192
    v_mfma_f32_16x16x32_bf16 v[204:207], a[4:7], a[196:199], v[204:207]
    buffer_load_dwordx4 a[244:247], v36, s[8:11], s62 offen offset:1024 sc1
    v_mfma_f32_16x16x32_bf16 a[72:75], a[4:7], a[200:203], a[72:75]
    ds_read_b64_tr_b16 a[42:43], v44 offset:9216
    v_mfma_f32_16x16x32_bf16 a[76:79], a[4:7], a[204:207], a[76:79]
    ds_read_b64_tr_b16 a[44:45], v45 offset:8192
    v_mfma_f32_16x16x32_bf16 v[208:211], a[8:11], a[192:195], v[208:211]
    v_mfma_f32_16x16x32_bf16 v[212:215], a[8:11], a[196:199], v[212:215]
    ds_read_b64_tr_b16 a[46:47], v45 offset:9216
    v_mfma_f32_16x16x32_bf16 a[80:83], a[8:11], a[200:203], a[80:83]
    buffer_load_dwordx4 a[248:251], v37, s[8:11], s62 offen offset:0 sc1
    ds_read_b64_tr_b16 a[48:49], v46 offset:8192
    v_mfma_f32_16x16x32_bf16 a[84:87], a[8:11], a[204:207], a[84:87]
    ds_read_b64_tr_b16 a[50:51], v46 offset:9216
    v_mfma_f32_16x16x32_bf16 v[216:219], a[12:15], a[192:195], v[216:219]
    v_mfma_f32_16x16x32_bf16 v[220:223], a[12:15], a[196:199], v[220:223]
    ds_read_b64_tr_b16 a[52:53], v47 offset:8192
    v_mfma_f32_16x16x32_bf16 a[88:91], a[12:15], a[200:203], a[88:91]
    buffer_load_dwordx4 a[252:255], v37, s[8:11], s62 offen offset:1024 sc1
    ds_read_b64_tr_b16 a[54:55], v47 offset:9216
    v_mfma_f32_16x16x32_bf16 a[92:95], a[12:15], a[204:207], a[92:95]
    ds_read_b64_tr_b16 a[56:57], v48 offset:8192
    v_mfma_f32_16x16x32_bf16 v[224:227], a[16:19], a[192:195], v[224:227]
    v_mfma_f32_16x16x32_bf16 v[228:231], a[16:19], a[196:199], v[228:231]
    ds_read_b64_tr_b16 a[58:59], v48 offset:9216
    v_mfma_f32_16x16x32_bf16 a[96:99], a[16:19], a[200:203], a[96:99]
    s_add_u32 s62, s62, 0x20000
    ds_read_b64_tr_b16 a[60:61], v49 offset:8192
    v_mfma_f32_16x16x32_bf16 a[100:103], a[16:19], a[204:207], a[100:103]
    s_add_u32 s52, s47, 12288
    v_mfma_f32_16x16x32_bf16 v[232:235], a[20:23], a[192:195], v[232:235]
    buffer_store_dwordx4 v[112:115], v1, s[32:35], s52 offen offset:0 sc1
    ds_read_b64_tr_b16 a[62:63], v49 offset:9216
    v_mfma_f32_16x16x32_bf16 v[236:239], a[20:23], a[196:199], v[236:239]
    s_add_u32 s52, s47, 12288
    v_mfma_f32_16x16x32_bf16 a[104:107], a[20:23], a[200:203], a[104:107]
    v_mfma_f32_16x16x32_bf16 a[108:111], a[20:23], a[204:207], a[108:111]
    buffer_store_dwordx4 v[116:119], v1, s[32:35], s52 offen offset:1024 sc1
    v_mfma_f32_16x16x32_bf16 v[240:243], a[24:27], a[192:195], v[240:243]
    v_mfma_f32_16x16x32_bf16 v[244:247], a[24:27], a[196:199], v[244:247]
    v_mfma_f32_16x16x32_bf16 a[112:115], a[24:27], a[200:203], a[112:115]
    v_mfma_f32_16x16x32_bf16 a[116:119], a[24:27], a[204:207], a[116:119]
    v_mfma_f32_16x16x32_bf16 v[248:251], a[28:31], a[192:195], v[248:251]
    v_mfma_f32_16x16x32_bf16 v[252:255], a[28:31], a[196:199], v[252:255]
    v_mfma_f32_16x16x32_bf16 a[120:123], a[28:31], a[200:203], a[120:123]
    v_mfma_f32_16x16x32_bf16 a[124:127], a[28:31], a[204:207], a[124:127]
    s_waitcnt vmcnt(11) lgkmcnt(0)
    s_barrier
    v_mfma_f32_16x16x32_bf16 v[192:195], a[32:35], a[208:211], v[192:195]
    ds_read_b64_tr_b16 a[0:1], v42 offset:16384
    ds_read_b64_tr_b16 a[2:3], v42 offset:17408
    v_mfma_f32_16x16x32_bf16 v[196:199], a[32:35], a[212:215], v[196:199]
    s_add_u32 m0, s60, 131072
    v_mfma_f32_16x16x32_bf16 a[64:67], a[32:35], a[216:219], a[64:67]
    buffer_load_dwordx4 v38, s[12:15], s61 offen offset:0 lds
    ds_read_b64_tr_b16 a[4:5], v43 offset:16384
    v_mfma_f32_16x16x32_bf16 a[68:71], a[32:35], a[220:223], a[68:71]
    ds_read_b64_tr_b16 a[6:7], v43 offset:17408
    v_mfma_f32_16x16x32_bf16 v[200:203], a[36:39], a[208:211], v[200:203]
    buffer_load_dwordx4 v39, s[12:15], s61 offen offset:1024 lds
    ds_read_b64_tr_b16 a[8:9], v44 offset:16384
    v_mfma_f32_16x16x32_bf16 v[204:207], a[36:39], a[212:215], v[204:207]
    v_mfma_f32_16x16x32_bf16 a[72:75], a[36:39], a[216:219], a[72:75]
    buffer_load_dwordx4 v40, s[12:15], s61 offen offset:2048 lds
    ds_read_b64_tr_b16 a[10:11], v44 offset:17408
    v_mfma_f32_16x16x32_bf16 a[76:79], a[36:39], a[220:223], a[76:79]
    ds_read_b64_tr_b16 a[12:13], v45 offset:16384
    v_mfma_f32_16x16x32_bf16 v[208:211], a[40:43], a[208:211], v[208:211]
    v_mfma_f32_16x16x32_bf16 v[212:215], a[40:43], a[212:215], v[212:215]
    buffer_load_dwordx4 v41, s[12:15], s61 offen offset:3072 lds
    ds_read_b64_tr_b16 a[14:15], v45 offset:17408
    v_mfma_f32_16x16x32_bf16 a[80:83], a[40:43], a[216:219], a[80:83]
    ds_read_b64_tr_b16 a[16:17], v46 offset:16384
    v_mfma_f32_16x16x32_bf16 a[84:87], a[40:43], a[220:223], a[84:87]
    s_add_u32 s61, s61, 0x80000
    ds_read_b64_tr_b16 a[18:19], v46 offset:17408
    v_mfma_f32_16x16x32_bf16 v[216:219], a[44:47], a[208:211], v[216:219]
    buffer_load_dwordx4 a[128:131], v36, s[8:11], s62 offen offset:0 sc1
    v_mfma_f32_16x16x32_bf16 v[220:223], a[44:47], a[212:215], v[220:223]
    ds_read_b64_tr_b16 a[20:21], v47 offset:16384
    v_mfma_f32_16x16x32_bf16 a[88:91], a[44:47], a[216:219], a[88:91]
    buffer_load_dwordx4 a[132:135], v36, s[8:11], s62 offen offset:1024 sc1
    ds_read_b64_tr_b16 a[22:23], v47 offset:17408
    v_mfma_f32_16x16x32_bf16 a[92:95], a[44:47], a[220:223], a[92:95]
    ds_read_b64_tr_b16 a[24:25], v48 offset:16384
    v_mfma_f32_16x16x32_bf16 v[224:227], a[48:51], a[208:211], v[224:227]
    v_mfma_f32_16x16x32_bf16 v[228:231], a[48:51], a[212:215], v[228:231]
    buffer_load_dwordx4 a[136:139], v37, s[8:11], s62 offen offset:0 sc1
    ds_read_b64_tr_b16 a[26:27], v48 offset:17408
    v_mfma_f32_16x16x32_bf16 a[96:99], a[48:51], a[216:219], a[96:99]
    ds_read_b64_tr_b16 a[28:29], v49 offset:16384
    v_mfma_f32_16x16x32_bf16 a[100:103], a[48:51], a[220:223], a[100:103]
    v_mfma_f32_16x16x32_bf16 v[232:235], a[52:55], a[208:211], v[232:235]
    buffer_load_dwordx4 a[140:143], v37, s[8:11], s62 offen offset:1024 sc1
    ds_read_b64_tr_b16 a[30:31], v49 offset:17408
    v_mfma_f32_16x16x32_bf16 v[236:239], a[52:55], a[212:215], v[236:239]
    v_mfma_f32_16x16x32_bf16 a[104:107], a[52:55], a[216:219], a[104:107]
    s_add_u32 s62, s62, 0x20000
    v_mfma_f32_16x16x32_bf16 a[108:111], a[52:55], a[220:223], a[108:111]
    s_add_u32 s52, s47, 12288
    v_mfma_f32_16x16x32_bf16 v[240:243], a[56:59], a[208:211], v[240:243]
    buffer_store_dwordx4 v[120:123], v1, s[32:35], s52 offen offset:2048 sc1
    v_mfma_f32_16x16x32_bf16 v[244:247], a[56:59], a[212:215], v[244:247]
    s_add_u32 s52, s47, 12288
    v_mfma_f32_16x16x32_bf16 a[112:115], a[56:59], a[216:219], a[112:115]
    buffer_store_dwordx4 v[124:127], v1, s[32:35], s52 offen offset:3072 sc1
    v_mfma_f32_16x16x32_bf16 a[116:119], a[56:59], a[220:223], a[116:119]
    v_mfma_f32_16x16x32_bf16 v[248:251], a[60:63], a[208:211], v[248:251]
    v_mfma_f32_16x16x32_bf16 v[252:255], a[60:63], a[212:215], v[252:255]
    v_mfma_f32_16x16x32_bf16 a[120:123], a[60:63], a[216:219], a[120:123]
    v_mfma_f32_16x16x32_bf16 a[124:127], a[60:63], a[220:223], a[124:127]
    s_waitcnt vmcnt(17) lgkmcnt(0)
    v_mfma_f32_16x16x32_bf16 v[192:195], a[0:3], a[224:227], v[192:195]
    ds_read_b64_tr_b16 a[32:33], v42 offset:24576
    ds_read_b64_tr_b16 a[34:35], v42 offset:25600
    v_mfma_f32_16x16x32_bf16 v[196:199], a[0:3], a[228:231], v[196:199]
    buffer_load_dwordx4 a[144:147], v36, s[8:11], s62 offen offset:0 sc1
    v_mfma_f32_16x16x32_bf16 a[64:67], a[0:3], a[232:235], a[64:67]
    ds_read_b64_tr_b16 a[36:37], v43 offset:24576
    v_mfma_f32_16x16x32_bf16 a[68:71], a[0:3], a[236:239], a[68:71]
    ds_read_b64_tr_b16 a[38:39], v43 offset:25600
    v_mfma_f32_16x16x32_bf16 v[200:203], a[4:7], a[224:227], v[200:203]
    ds_read_b64_tr_b16 a[40:41], v44 offset:24576
    v_mfma_f32_16x16x32_bf16 v[204:207], a[4:7], a[228:231], v[204:207]
    v_mfma_f32_16x16x32_bf16 a[72:75], a[4:7], a[232:235], a[72:75]
    buffer_load_dwordx4 a[148:151], v36, s[8:11], s62 offen offset:1024 sc1
    ds_read_b64_tr_b16 a[42:43], v44 offset:25600
    v_mfma_f32_16x16x32_bf16 a[76:79], a[4:7], a[236:239], a[76:79]
    ds_read_b64_tr_b16 a[44:45], v45 offset:24576
    v_mfma_f32_16x16x32_bf16 v[208:211], a[8:11], a[224:227], v[208:211]
    v_mfma_f32_16x16x32_bf16 v[212:215], a[8:11], a[228:231], v[212:215]
    ds_read_b64_tr_b16 a[46:47], v45 offset:25600
    v_mfma_f32_16x16x32_bf16 a[80:83], a[8:11], a[232:235], a[80:83]
    ds_read_b64_tr_b16 a[48:49], v46 offset:24576
    v_mfma_f32_16x16x32_bf16 a[84:87], a[8:11], a[236:239], a[84:87]
    ds_read_b64_tr_b16 a[50:51], v46 offset:25600
    v_mfma_f32_16x16x32_bf16 v[216:219], a[12:15], a[224:227], v[216:219]
    buffer_load_dwordx4 a[152:155], v37, s[8:11], s62 offen offset:0 sc1
    v_mfma_f32_16x16x32_bf16 v[220:223], a[12:15], a[228:231], v[220:223]
    ds_read_b64_tr_b16 a[52:53], v47 offset:24576
    v_mfma_f32_16x16x32_bf16 a[88:91], a[12:15], a[232:235], a[88:91]
    ds_read_b64_tr_b16 a[54:55], v47 offset:25600
    v_mfma_f32_16x16x32_bf16 a[92:95], a[12:15], a[236:239], a[92:95]
    ds_read_b64_tr_b16 a[56:57], v48 offset:24576
    v_mfma_f32_16x16x32_bf16 v[224:227], a[16:19], a[224:227], v[224:227]
    v_mfma_f32_16x16x32_bf16 v[228:231], a[16:19], a[228:231], v[228:231]
    buffer_load_dwordx4 a[156:159], v37, s[8:11], s62 offen offset:1024 sc1
    ds_read_b64_tr_b16 a[58:59], v48 offset:25600
    v_mfma_f32_16x16x32_bf16 a[96:99], a[16:19], a[232:235], a[96:99]
    ds_read_b64_tr_b16 a[60:61], v49 offset:24576
    v_mfma_f32_16x16x32_bf16 a[100:103], a[16:19], a[236:239], a[100:103]
    v_mfma_f32_16x16x32_bf16 v[232:235], a[20:23], a[224:227], v[232:235]
    ds_read_b64_tr_b16 a[62:63], v49 offset:25600
    v_mfma_f32_16x16x32_bf16 v[236:239], a[20:23], a[228:231], v[236:239]
    v_mfma_f32_16x16x32_bf16 a[104:107], a[20:23], a[232:235], a[104:107]
    s_add_u32 s62, s62, 0x20000
    v_mfma_f32_16x16x32_bf16 a[108:111], a[20:23], a[236:239], a[108:111]
    s_add_u32 s52, s47, 524288
    v_mfma_f32_16x16x32_bf16 v[240:243], a[24:27], a[224:227], v[240:243]
    buffer_store_dwordx4 v[128:131], v1, s[32:35], s52 offen offset:0 sc1
    v_mfma_f32_16x16x32_bf16 v[244:247], a[24:27], a[228:231], v[244:247]
    v_mfma_f32_16x16x32_bf16 a[112:115], a[24:27], a[232:235], a[112:115]
    v_mfma_f32_16x16x32_bf16 a[116:119], a[24:27], a[236:239], a[116:119]
    v_mfma_f32_16x16x32_bf16 v[248:251], a[28:31], a[224:227], v[248:251]
    v_mfma_f32_16x16x32_bf16 v[252:255], a[28:31], a[228:231], v[252:255]
    v_mfma_f32_16x16x32_bf16 a[120:123], a[28:31], a[232:235], a[120:123]
    v_mfma_f32_16x16x32_bf16 a[124:127], a[28:31], a[236:239], a[124:127]
    s_waitcnt vmcnt(11) lgkmcnt(0)
    s_barrier
    v_mfma_f32_16x16x32_bf16 v[192:195], a[32:35], a[240:243], v[192:195]
    ds_read_b64_tr_b16 a[0:1], v42 offset:32768
    ds_read_b64_tr_b16 a[2:3], v42 offset:33792
    v_mfma_f32_16x16x32_bf16 v[196:199], a[32:35], a[244:247], v[196:199]
    s_add_u32 m0, s60, 147456
    v_mfma_f32_16x16x32_bf16 a[64:67], a[32:35], a[248:251], a[64:67]
    buffer_load_dwordx4 v38, s[12:15], s61 offen offset:0 lds
    ds_read_b64_tr_b16 a[4:5], v43 offset:32768
    v_mfma_f32_16x16x32_bf16 a[68:71], a[32:35], a[252:255], a[68:71]
    ds_read_b64_tr_b16 a[6:7], v43 offset:33792
    v_mfma_f32_16x16x32_bf16 v[200:203], a[36:39], a[240:243], v[200:203]
    buffer_load_dwordx4 v39, s[12:15], s61 offen offset:1024 lds
    ds_read_b64_tr_b16 a[8:9], v44 offset:32768
    v_mfma_f32_16x16x32_bf16 v[204:207], a[36:39], a[244:247], v[204:207]
    v_mfma_f32_16x16x32_bf16 a[72:75], a[36:39], a[248:251], a[72:75]
    buffer_load_dwordx4 v40, s[12:15], s61 offen offset:2048 lds
    ds_read_b64_tr_b16 a[10:11], v44 offset:33792
    v_mfma_f32_16x16x32_bf16 a[76:79], a[36:39], a[252:255], a[76:79]
    ds_read_b64_tr_b16 a[12:13], v45 offset:32768
    v_mfma_f32_16x16x32_bf16 v[208:211], a[40:43], a[240:243], v[208:211]
    v_mfma_f32_16x16x32_bf16 v[212:215], a[40:43], a[244:247], v[212:215]
    buffer_load_dwordx4 v41, s[12:15], s61 offen offset:3072 lds
    ds_read_b64_tr_b16 a[14:15], v45 offset:33792
    v_mfma_f32_16x16x32_bf16 a[80:83], a[40:43], a[248:251], a[80:83]
    ds_read_b64_tr_b16 a[16:17], v46 offset:32768
    v_mfma_f32_16x16x32_bf16 a[84:87], a[40:43], a[252:255], a[84:87]
    s_add_u32 s61, s61, 0x80000
    ds_read_b64_tr_b16 a[18:19], v46 offset:33792
    v_mfma_f32_16x16x32_bf16 v[216:219], a[44:47], a[240:243], v[216:219]
    buffer_load_dwordx4 a[160:163], v36, s[8:11], s62 offen offset:0 sc1
    v_mfma_f32_16x16x32_bf16 v[220:223], a[44:47], a[244:247], v[220:223]
    ds_read_b64_tr_b16 a[20:21], v47 offset:32768
    v_mfma_f32_16x16x32_bf16 a[88:91], a[44:47], a[248:251], a[88:91]
    buffer_load_dwordx4 a[164:167], v36, s[8:11], s62 offen offset:1024 sc1
    ds_read_b64_tr_b16 a[22:23], v47 offset:33792
    v_mfma_f32_16x16x32_bf16 a[92:95], a[44:47], a[252:255], a[92:95]
    ds_read_b64_tr_b16 a[24:25], v48 offset:32768
    v_mfma_f32_16x16x32_bf16 v[224:227], a[48:51], a[240:243], v[224:227]
    v_mfma_f32_16x16x32_bf16 v[228:231], a[48:51], a[244:247], v[228:231]
    buffer_load_dwordx4 a[168:171], v37, s[8:11], s62 offen offset:0 sc1
    ds_read_b64_tr_b16 a[26:27], v48 offset:33792
    v_mfma_f32_16x16x32_bf16 a[96:99], a[48:51], a[248:251], a[96:99]
    ds_read_b64_tr_b16 a[28:29], v49 offset:32768
    v_mfma_f32_16x16x32_bf16 a[100:103], a[48:51], a[252:255], a[100:103]
    v_mfma_f32_16x16x32_bf16 v[232:235], a[52:55], a[240:243], v[232:235]
    buffer_load_dwordx4 a[172:175], v37, s[8:11], s62 offen offset:1024 sc1
    ds_read_b64_tr_b16 a[30:31], v49 offset:33792
    v_mfma_f32_16x16x32_bf16 v[236:239], a[52:55], a[244:247], v[236:239]
    v_mfma_f32_16x16x32_bf16 a[104:107], a[52:55], a[248:251], a[104:107]
    s_add_u32 s62, s62, 0x20000
    v_mfma_f32_16x16x32_bf16 a[108:111], a[52:55], a[252:255], a[108:111]
    s_add_u32 s52, s47, 524288
    v_mfma_f32_16x16x32_bf16 v[240:243], a[56:59], a[240:243], v[240:243]
    buffer_store_dwordx4 v[132:135], v1, s[32:35], s52 offen offset:1024 sc1
    v_mfma_f32_16x16x32_bf16 v[244:247], a[56:59], a[244:247], v[244:247]
    s_add_u32 s52, s47, 524288
    v_mfma_f32_16x16x32_bf16 a[112:115], a[56:59], a[248:251], a[112:115]
    buffer_store_dwordx4 v[136:139], v1, s[32:35], s52 offen offset:2048 sc1
    v_mfma_f32_16x16x32_bf16 a[116:119], a[56:59], a[252:255], a[116:119]
    v_mfma_f32_16x16x32_bf16 v[248:251], a[60:63], a[240:243], v[248:251]
    v_mfma_f32_16x16x32_bf16 v[252:255], a[60:63], a[244:247], v[252:255]
    v_mfma_f32_16x16x32_bf16 a[120:123], a[60:63], a[248:251], a[120:123]
    v_mfma_f32_16x16x32_bf16 a[124:127], a[60:63], a[252:255], a[124:127]
    s_waitcnt vmcnt(17) lgkmcnt(0)
    v_mfma_f32_16x16x32_bf16 v[192:195], a[0:3], a[128:131], v[192:195]
    ds_read_b64_tr_b16 a[32:33], v42 offset:40960
    ds_read_b64_tr_b16 a[34:35], v42 offset:41984
    v_mfma_f32_16x16x32_bf16 v[196:199], a[0:3], a[132:135], v[196:199]
    buffer_load_dwordx4 a[176:179], v36, s[8:11], s62 offen offset:0 sc1
    v_mfma_f32_16x16x32_bf16 a[64:67], a[0:3], a[136:139], a[64:67]
    ds_read_b64_tr_b16 a[36:37], v43 offset:40960
    v_mfma_f32_16x16x32_bf16 a[68:71], a[0:3], a[140:143], a[68:71]
    ds_read_b64_tr_b16 a[38:39], v43 offset:41984
    v_mfma_f32_16x16x32_bf16 v[200:203], a[4:7], a[128:131], v[200:203]
    ds_read_b64_tr_b16 a[40:41], v44 offset:40960
    v_mfma_f32_16x16x32_bf16 v[204:207], a[4:7], a[132:135], v[204:207]
    v_mfma_f32_16x16x32_bf16 a[72:75], a[4:7], a[136:139], a[72:75]
    buffer_load_dwordx4 a[180:183], v36, s[8:11], s62 offen offset:1024 sc1
    ds_read_b64_tr_b16 a[42:43], v44 offset:41984
    v_mfma_f32_16x16x32_bf16 a[76:79], a[4:7], a[140:143], a[76:79]
    ds_read_b64_tr_b16 a[44:45], v45 offset:40960
    v_mfma_f32_16x16x32_bf16 v[208:211], a[8:11], a[128:131], v[208:211]
    v_mfma_f32_16x16x32_bf16 v[212:215], a[8:11], a[132:135], v[212:215]
    ds_read_b64_tr_b16 a[46:47], v45 offset:41984
    v_mfma_f32_16x16x32_bf16 a[80:83], a[8:11], a[136:139], a[80:83]
    ds_read_b64_tr_b16 a[48:49], v46 offset:40960
    v_mfma_f32_16x16x32_bf16 a[84:87], a[8:11], a[140:143], a[84:87]
    ds_read_b64_tr_b16 a[50:51], v46 offset:41984
    v_mfma_f32_16x16x32_bf16 v[216:219], a[12:15], a[128:131], v[216:219]
    buffer_load_dwordx4 a[184:187], v37, s[8:11], s62 offen offset:0 sc1
    v_mfma_f32_16x16x32_bf16 v[220:223], a[12:15], a[132:135], v[220:223]
    ds_read_b64_tr_b16 a[52:53], v47 offset:40960
    v_mfma_f32_16x16x32_bf16 a[88:91], a[12:15], a[136:139], a[88:91]
    ds_read_b64_tr_b16 a[54:55], v47 offset:41984
    v_mfma_f32_16x16x32_bf16 a[92:95], a[12:15], a[140:143], a[92:95]
    ds_read_b64_tr_b16 a[56:57], v48 offset:40960
    v_mfma_f32_16x16x32_bf16 v[224:227], a[16:19], a[128:131], v[224:227]
    v_mfma_f32_16x16x32_bf16 v[228:231], a[16:19], a[132:135], v[228:231]
    buffer_load_dwordx4 a[188:191], v37, s[8:11], s62 offen offset:1024 sc1
    ds_read_b64_tr_b16 a[58:59], v48 offset:41984
    v_mfma_f32_16x16x32_bf16 a[96:99], a[16:19], a[136:139], a[96:99]
    ds_read_b64_tr_b16 a[60:61], v49 offset:40960
    v_mfma_f32_16x16x32_bf16 a[100:103], a[16:19], a[140:143], a[100:103]
    v_mfma_f32_16x16x32_bf16 v[232:235], a[20:23], a[128:131], v[232:235]
    ds_read_b64_tr_b16 a[62:63], v49 offset:41984
    v_mfma_f32_16x16x32_bf16 v[236:239], a[20:23], a[132:135], v[236:239]
    v_mfma_f32_16x16x32_bf16 a[104:107], a[20:23], a[136:139], a[104:107]
    s_add_u32 s62, s62, 0x20000
    v_mfma_f32_16x16x32_bf16 a[108:111], a[20:23], a[140:143], a[108:111]
    s_add_u32 s52, s47, 524288
    v_mfma_f32_16x16x32_bf16 v[240:243], a[24:27], a[128:131], v[240:243]
    buffer_store_dwordx4 v[140:143], v1, s[32:35], s52 offen offset:3072 sc1
    v_mfma_f32_16x16x32_bf16 v[244:247], a[24:27], a[132:135], v[244:247]
    v_mfma_f32_16x16x32_bf16 a[112:115], a[24:27], a[136:139], a[112:115]
    v_mfma_f32_16x16x32_bf16 a[116:119], a[24:27], a[140:143], a[116:119]
    v_mfma_f32_16x16x32_bf16 v[248:251], a[28:31], a[128:131], v[248:251]
    v_mfma_f32_16x16x32_bf16 v[252:255], a[28:31], a[132:135], v[252:255]
    v_mfma_f32_16x16x32_bf16 a[120:123], a[28:31], a[136:139], a[120:123]
    v_mfma_f32_16x16x32_bf16 a[124:127], a[28:31], a[140:143], a[124:127]
    s_waitcnt vmcnt(11) lgkmcnt(0)
    s_barrier
    v_mfma_f32_16x16x32_bf16 v[192:195], a[32:35], a[144:147], v[192:195]
    ds_read_b64_tr_b16 a[0:1], v42 offset:49152
    ds_read_b64_tr_b16 a[2:3], v42 offset:50176
    v_mfma_f32_16x16x32_bf16 v[196:199], a[32:35], a[148:151], v[196:199]
    s_add_u32 m0, s60, 98304
    v_mfma_f32_16x16x32_bf16 a[64:67], a[32:35], a[152:155], a[64:67]
    buffer_load_dwordx4 v38, s[12:15], s61 offen offset:0 lds
    ds_read_b64_tr_b16 a[4:5], v43 offset:49152
    v_mfma_f32_16x16x32_bf16 a[68:71], a[32:35], a[156:159], a[68:71]
    ds_read_b64_tr_b16 a[6:7], v43 offset:50176
    v_mfma_f32_16x16x32_bf16 v[200:203], a[36:39], a[144:147], v[200:203]
    buffer_load_dwordx4 v39, s[12:15], s61 offen offset:1024 lds
    ds_read_b64_tr_b16 a[8:9], v44 offset:49152
    v_mfma_f32_16x16x32_bf16 v[204:207], a[36:39], a[148:151], v[204:207]
    v_mfma_f32_16x16x32_bf16 a[72:75], a[36:39], a[152:155], a[72:75]
    buffer_load_dwordx4 v40, s[12:15], s61 offen offset:2048 lds
    ds_read_b64_tr_b16 a[10:11], v44 offset:50176
    v_mfma_f32_16x16x32_bf16 a[76:79], a[36:39], a[156:159], a[76:79]
    ds_read_b64_tr_b16 a[12:13], v45 offset:49152
    v_mfma_f32_16x16x32_bf16 v[208:211], a[40:43], a[144:147], v[208:211]
    v_mfma_f32_16x16x32_bf16 v[212:215], a[40:43], a[148:151], v[212:215]
    buffer_load_dwordx4 v41, s[12:15], s61 offen offset:3072 lds
    ds_read_b64_tr_b16 a[14:15], v45 offset:50176
    v_mfma_f32_16x16x32_bf16 a[80:83], a[40:43], a[152:155], a[80:83]
    ds_read_b64_tr_b16 a[16:17], v46 offset:49152
    v_mfma_f32_16x16x32_bf16 a[84:87], a[40:43], a[156:159], a[84:87]
    s_add_u32 s61, s61, 0x80000
    ds_read_b64_tr_b16 a[18:19], v46 offset:50176
    v_mfma_f32_16x16x32_bf16 v[216:219], a[44:47], a[144:147], v[216:219]
    buffer_load_dwordx4 a[192:195], v36, s[8:11], s62 offen offset:0 sc1
    v_mfma_f32_16x16x32_bf16 v[220:223], a[44:47], a[148:151], v[220:223]
    ds_read_b64_tr_b16 a[20:21], v47 offset:49152
    v_mfma_f32_16x16x32_bf16 a[88:91], a[44:47], a[152:155], a[88:91]
    buffer_load_dwordx4 a[196:199], v36, s[8:11], s62 offen offset:1024 sc1
    ds_read_b64_tr_b16 a[22:23], v47 offset:50176
    v_mfma_f32_16x16x32_bf16 a[92:95], a[44:47], a[156:159], a[92:95]
    ds_read_b64_tr_b16 a[24:25], v48 offset:49152
    v_mfma_f32_16x16x32_bf16 v[224:227], a[48:51], a[144:147], v[224:227]
    v_mfma_f32_16x16x32_bf16 v[228:231], a[48:51], a[148:151], v[228:231]
    buffer_load_dwordx4 a[200:203], v37, s[8:11], s62 offen offset:0 sc1
    ds_read_b64_tr_b16 a[26:27], v48 offset:50176
    v_mfma_f32_16x16x32_bf16 a[96:99], a[48:51], a[152:155], a[96:99]
    ds_read_b64_tr_b16 a[28:29], v49 offset:49152
    v_mfma_f32_16x16x32_bf16 a[100:103], a[48:51], a[156:159], a[100:103]
    v_mfma_f32_16x16x32_bf16 v[232:235], a[52:55], a[144:147], v[232:235]
    buffer_load_dwordx4 a[204:207], v37, s[8:11], s62 offen offset:1024 sc1
    ds_read_b64_tr_b16 a[30:31], v49 offset:50176
    v_mfma_f32_16x16x32_bf16 v[236:239], a[52:55], a[148:151], v[236:239]
    v_mfma_f32_16x16x32_bf16 a[104:107], a[52:55], a[152:155], a[104:107]
    s_add_u32 s62, s62, 0x20000
    v_mfma_f32_16x16x32_bf16 a[108:111], a[52:55], a[156:159], a[108:111]
    s_add_u32 s52, s47, 528384
    v_mfma_f32_16x16x32_bf16 v[240:243], a[56:59], a[144:147], v[240:243]
    buffer_store_dwordx4 v[144:147], v1, s[32:35], s52 offen offset:0 sc1
    v_mfma_f32_16x16x32_bf16 v[244:247], a[56:59], a[148:151], v[244:247]
    s_add_u32 s52, s47, 528384
    v_mfma_f32_16x16x32_bf16 a[112:115], a[56:59], a[152:155], a[112:115]
    buffer_store_dwordx4 v[148:151], v1, s[32:35], s52 offen offset:1024 sc1
    v_mfma_f32_16x16x32_bf16 a[116:119], a[56:59], a[156:159], a[116:119]
    v_mfma_f32_16x16x32_bf16 v[248:251], a[60:63], a[144:147], v[248:251]
    v_mfma_f32_16x16x32_bf16 v[252:255], a[60:63], a[148:151], v[252:255]
    v_mfma_f32_16x16x32_bf16 a[120:123], a[60:63], a[152:155], a[120:123]
    v_mfma_f32_16x16x32_bf16 a[124:127], a[60:63], a[156:159], a[124:127]
    s_waitcnt vmcnt(17) lgkmcnt(0)
    v_mfma_f32_16x16x32_bf16 v[192:195], a[0:3], a[160:163], v[192:195]
    ds_read_b64_tr_b16 a[32:33], v42 offset:57344
    ds_read_b64_tr_b16 a[34:35], v42 offset:58368
    v_mfma_f32_16x16x32_bf16 v[196:199], a[0:3], a[164:167], v[196:199]
    buffer_load_dwordx4 a[208:211], v36, s[8:11], s62 offen offset:0 sc1
    v_mfma_f32_16x16x32_bf16 a[64:67], a[0:3], a[168:171], a[64:67]
    ds_read_b64_tr_b16 a[36:37], v43 offset:57344
    v_mfma_f32_16x16x32_bf16 a[68:71], a[0:3], a[172:175], a[68:71]
    ds_read_b64_tr_b16 a[38:39], v43 offset:58368
    v_mfma_f32_16x16x32_bf16 v[200:203], a[4:7], a[160:163], v[200:203]
    ds_read_b64_tr_b16 a[40:41], v44 offset:57344
    v_mfma_f32_16x16x32_bf16 v[204:207], a[4:7], a[164:167], v[204:207]
    buffer_load_dwordx4 a[212:215], v36, s[8:11], s62 offen offset:1024 sc1
    v_mfma_f32_16x16x32_bf16 a[72:75], a[4:7], a[168:171], a[72:75]
    ds_read_b64_tr_b16 a[42:43], v44 offset:58368
    v_mfma_f32_16x16x32_bf16 a[76:79], a[4:7], a[172:175], a[76:79]
    ds_read_b64_tr_b16 a[44:45], v45 offset:57344
    v_mfma_f32_16x16x32_bf16 v[208:211], a[8:11], a[160:163], v[208:211]
    v_mfma_f32_16x16x32_bf16 v[212:215], a[8:11], a[164:167], v[212:215]
    ds_read_b64_tr_b16 a[46:47], v45 offset:58368
    v_mfma_f32_16x16x32_bf16 a[80:83], a[8:11], a[168:171], a[80:83]
    buffer_load_dwordx4 a[216:219], v37, s[8:11], s62 offen offset:0 sc1
    ds_read_b64_tr_b16 a[48:49], v46 offset:57344
    v_mfma_f32_16x16x32_bf16 a[84:87], a[8:11], a[172:175], a[84:87]
    ds_read_b64_tr_b16 a[50:51], v46 offset:58368
    v_mfma_f32_16x16x32_bf16 v[216:219], a[12:15], a[160:163], v[216:219]
    v_mfma_f32_16x16x32_bf16 v[220:223], a[12:15], a[164:167], v[220:223]
    ds_read_b64_tr_b16 a[52:53], v47 offset:57344
    v_mfma_f32_16x16x32_bf16 a[88:91], a[12:15], a[168:171], a[88:91]
    buffer_load_dwordx4 a[220:223], v37, s[8:11], s62 offen offset:1024 sc1
    ds_read_b64_tr_b16 a[54:55], v47 offset:58368
    v_mfma_f32_16x16x32_bf16 a[92:95], a[12:15], a[172:175], a[92:95]
    ds_read_b64_tr_b16 a[56:57], v48 offset:57344
    v_mfma_f32_16x16x32_bf16 v[224:227], a[16:19], a[160:163], v[224:227]
    v_mfma_f32_16x16x32_bf16 v[228:231], a[16:19], a[164:167], v[228:231]
    ds_read_b64_tr_b16 a[58:59], v48 offset:58368
    v_mfma_f32_16x16x32_bf16 a[96:99], a[16:19], a[168:171], a[96:99]
    s_add_u32 s62, s62, 0x20000
    ds_read_b64_tr_b16 a[60:61], v49 offset:57344
    v_mfma_f32_16x16x32_bf16 a[100:103], a[16:19], a[172:175], a[100:103]
    s_add_u32 s52, s47, 528384
    v_mfma_f32_16x16x32_bf16 v[232:235], a[20:23], a[160:163], v[232:235]
    buffer_store_dwordx4 v[152:155], v1, s[32:35], s52 offen offset:2048 sc1
    ds_read_b64_tr_b16 a[62:63], v49 offset:58368
    v_mfma_f32_16x16x32_bf16 v[236:239], a[20:23], a[164:167], v[236:239]
    s_add_u32 s52, s47, 528384
    v_mfma_f32_16x16x32_bf16 a[104:107], a[20:23], a[168:171], a[104:107]
    v_mfma_f32_16x16x32_bf16 a[108:111], a[20:23], a[172:175], a[108:111]
    buffer_store_dwordx4 v[156:159], v1, s[32:35], s52 offen offset:3072 sc1
    v_mfma_f32_16x16x32_bf16 v[240:243], a[24:27], a[160:163], v[240:243]
    v_mfma_f32_16x16x32_bf16 v[244:247], a[24:27], a[164:167], v[244:247]
    v_mfma_f32_16x16x32_bf16 a[112:115], a[24:27], a[168:171], a[112:115]
    v_mfma_f32_16x16x32_bf16 a[116:119], a[24:27], a[172:175], a[116:119]
    v_mfma_f32_16x16x32_bf16 v[248:251], a[28:31], a[160:163], v[248:251]
    v_mfma_f32_16x16x32_bf16 v[252:255], a[28:31], a[164:167], v[252:255]
    v_mfma_f32_16x16x32_bf16 a[120:123], a[28:31], a[168:171], a[120:123]
    v_mfma_f32_16x16x32_bf16 a[124:127], a[28:31], a[172:175], a[124:127]
    s_waitcnt vmcnt(12) lgkmcnt(0)
    s_barrier
    v_mfma_f32_16x16x32_bf16 v[192:195], a[32:35], a[176:179], v[192:195]
    ds_read_b64_tr_b16 a[0:1], v42 offset:0
    ds_read_b64_tr_b16 a[2:3], v42 offset:1024
    v_mfma_f32_16x16x32_bf16 v[196:199], a[32:35], a[180:183], v[196:199]
    s_add_u32 m0, s60, 114688
    v_mfma_f32_16x16x32_bf16 a[64:67], a[32:35], a[184:187], a[64:67]
    buffer_load_dwordx4 v38, s[12:15], s61 offen offset:0 lds
    ds_read_b64_tr_b16 a[4:5], v43 offset:0
    v_mfma_f32_16x16x32_bf16 a[68:71], a[32:35], a[188:191], a[68:71]
    ds_read_b64_tr_b16 a[6:7], v43 offset:1024
    v_mfma_f32_16x16x32_bf16 v[200:203], a[36:39], a[176:179], v[200:203]
    buffer_load_dwordx4 v39, s[12:15], s61 offen offset:1024 lds
    ds_read_b64_tr_b16 a[8:9], v44 offset:0
    v_mfma_f32_16x16x32_bf16 v[204:207], a[36:39], a[180:183], v[204:207]
    v_mfma_f32_16x16x32_bf16 a[72:75], a[36:39], a[184:187], a[72:75]
    ds_read_b64_tr_b16 a[10:11], v44 offset:1024
    v_mfma_f32_16x16x32_bf16 a[76:79], a[36:39], a[188:191], a[76:79]
    buffer_load_dwordx4 v40, s[12:15], s61 offen offset:2048 lds
    ds_read_b64_tr_b16 a[12:13], v45 offset:0
    v_mfma_f32_16x16x32_bf16 v[208:211], a[40:43], a[176:179], v[208:211]
    v_mfma_f32_16x16x32_bf16 v[212:215], a[40:43], a[180:183], v[212:215]
    ds_read_b64_tr_b16 a[14:15], v45 offset:1024
    v_mfma_f32_16x16x32_bf16 a[80:83], a[40:43], a[184:187], a[80:83]
    buffer_load_dwordx4 v41, s[12:15], s61 offen offset:3072 lds
    ds_read_b64_tr_b16 a[16:17], v46 offset:0
    v_mfma_f32_16x16x32_bf16 a[84:87], a[40:43], a[188:191], a[84:87]
    ds_read_b64_tr_b16 a[18:19], v46 offset:1024
    v_mfma_f32_16x16x32_bf16 v[216:219], a[44:47], a[176:179], v[216:219]
    s_add_u32 s61, s61, 0x80000
    v_mfma_f32_16x16x32_bf16 v[220:223], a[44:47], a[180:183], v[220:223]
    buffer_load_dwordx4 a[224:227], v36, s[8:11], s62 offen offset:0 sc1
    ds_read_b64_tr_b16 a[20:21], v47 offset:0
    v_mfma_f32_16x16x32_bf16 a[88:91], a[44:47], a[184:187], a[88:91]
    ds_read_b64_tr_b16 a[22:23], v47 offset:1024
    v_mfma_f32_16x16x32_bf16 a[92:95], a[44:47], a[188:191], a[92:95]
    ds_read_b64_tr_b16 a[24:25], v48 offset:0
    v_mfma_f32_16x16x32_bf16 v[224:227], a[48:51], a[176:179], v[224:227]
    buffer_load_dwordx4 a[228:231], v36, s[8:11], s62 offen offset:1024 sc1
    v_mfma_f32_16x16x32_bf16 v[228:231], a[48:51], a[180:183], v[228:231]
    ds_read_b64_tr_b16 a[26:27], v48 offset:1024
    v_mfma_f32_16x16x32_bf16 a[96:99], a[48:51], a[184:187], a[96:99]
    ds_read_b64_tr_b16 a[28:29], v49 offset:0
    v_mfma_f32_16x16x32_bf16 a[100:103], a[48:51], a[188:191], a[100:103]
    buffer_load_dwordx4 a[232:235], v37, s[8:11], s62 offen offset:0 sc1
    v_mfma_f32_16x16x32_bf16 v[232:235], a[52:55], a[176:179], v[232:235]
    ds_read_b64_tr_b16 a[30:31], v49 offset:1024
    v_mfma_f32_16x16x32_bf16 v[236:239], a[52:55], a[180:183], v[236:239]
    v_mfma_f32_16x16x32_bf16 a[104:107], a[52:55], a[184:187], a[104:107]
    buffer_load_dwordx4 a[236:239], v37, s[8:11], s62 offen offset:1024 sc1
    v_mfma_f32_16x16x32_bf16 a[108:111], a[52:55], a[188:191], a[108:111]
    v_mfma_f32_16x16x32_bf16 v[240:243], a[56:59], a[176:179], v[240:243]
    s_add_u32 s62, s62, 0x20000
    v_mfma_f32_16x16x32_bf16 v[244:247], a[56:59], a[180:183], v[244:247]
    s_add_u32 s52, s47, 532480
    v_mfma_f32_16x16x32_bf16 a[112:115], a[56:59], a[184:187], a[112:115]
    buffer_store_dwordx4 v[160:163], v1, s[32:35], s52 offen offset:0 sc1
    v_mfma_f32_16x16x32_bf16 a[116:119], a[56:59], a[188:191], a[116:119]
    v_mfma_f32_16x16x32_bf16 v[248:251], a[60:63], a[176:179], v[248:251]
    v_mfma_f32_16x16x32_bf16 v[252:255], a[60:63], a[180:183], v[252:255]
    v_mfma_f32_16x16x32_bf16 a[120:123], a[60:63], a[184:187], a[120:123]
    v_mfma_f32_16x16x32_bf16 a[124:127], a[60:63], a[188:191], a[124:127]
    s_waitcnt vmcnt(17) lgkmcnt(0)
    v_mfma_f32_16x16x32_bf16 v[192:195], a[0:3], a[192:195], v[192:195]
    ds_read_b64_tr_b16 a[32:33], v42 offset:8192
    ds_read_b64_tr_b16 a[34:35], v42 offset:9216
    v_mfma_f32_16x16x32_bf16 v[196:199], a[0:3], a[196:199], v[196:199]
    buffer_load_dwordx4 a[240:243], v36, s[8:11], s62 offen offset:0 sc1
    v_mfma_f32_16x16x32_bf16 a[64:67], a[0:3], a[200:203], a[64:67]
    ds_read_b64_tr_b16 a[36:37], v43 offset:8192
    v_mfma_f32_16x16x32_bf16 a[68:71], a[0:3], a[204:207], a[68:71]
    ds_read_b64_tr_b16 a[38:39], v43 offset:9216
    v_mfma_f32_16x16x32_bf16 v[200:203], a[4:7], a[192:195], v[200:203]
    ds_read_b64_tr_b16 a[40:41], v44 offset:8192
    v_mfma_f32_16x16x32_bf16 v[204:207], a[4:7], a[196:199], v[204:207]
    buffer_load_dwordx4 a[244:247], v36, s[8:11], s62 offen offset:1024 sc1
    v_mfma_f32_16x16x32_bf16 a[72:75], a[4:7], a[200:203], a[72:75]
    ds_read_b64_tr_b16 a[42:43], v44 offset:9216
    v_mfma_f32_16x16x32_bf16 a[76:79], a[4:7], a[204:207], a[76:79]
    ds_read_b64_tr_b16 a[44:45], v45 offset:8192
    v_mfma_f32_16x16x32_bf16 v[208:211], a[8:11], a[192:195], v[208:211]
    v_mfma_f32_16x16x32_bf16 v[212:215], a[8:11], a[196:199], v[212:215]
    ds_read_b64_tr_b16 a[46:47], v45 offset:9216
    v_mfma_f32_16x16x32_bf16 a[80:83], a[8:11], a[200:203], a[80:83]
    buffer_load_dwordx4 a[248:251], v37, s[8:11], s62 offen offset:0 sc1
    ds_read_b64_tr_b16 a[48:49], v46 offset:8192
    v_mfma_f32_16x16x32_bf16 a[84:87], a[8:11], a[204:207], a[84:87]
    ds_read_b64_tr_b16 a[50:51], v46 offset:9216
    v_mfma_f32_16x16x32_bf16 v[216:219], a[12:15], a[192:195], v[216:219]
    v_mfma_f32_16x16x32_bf16 v[220:223], a[12:15], a[196:199], v[220:223]
    ds_read_b64_tr_b16 a[52:53], v47 offset:8192
    v_mfma_f32_16x16x32_bf16 a[88:91], a[12:15], a[200:203], a[88:91]
    buffer_load_dwordx4 a[252:255], v37, s[8:11], s62 offen offset:1024 sc1
    ds_read_b64_tr_b16 a[54:55], v47 offset:9216
    v_mfma_f32_16x16x32_bf16 a[92:95], a[12:15], a[204:207], a[92:95]
    ds_read_b64_tr_b16 a[56:57], v48 offset:8192
    v_mfma_f32_16x16x32_bf16 v[224:227], a[16:19], a[192:195], v[224:227]
    v_mfma_f32_16x16x32_bf16 v[228:231], a[16:19], a[196:199], v[228:231]
    ds_read_b64_tr_b16 a[58:59], v48 offset:9216
    v_mfma_f32_16x16x32_bf16 a[96:99], a[16:19], a[200:203], a[96:99]
    s_add_u32 s62, s62, 0x20000
    ds_read_b64_tr_b16 a[60:61], v49 offset:8192
    v_mfma_f32_16x16x32_bf16 a[100:103], a[16:19], a[204:207], a[100:103]
    s_add_u32 s52, s47, 532480
    v_mfma_f32_16x16x32_bf16 v[232:235], a[20:23], a[192:195], v[232:235]
    buffer_store_dwordx4 v[164:167], v1, s[32:35], s52 offen offset:1024 sc1
    ds_read_b64_tr_b16 a[62:63], v49 offset:9216
    v_mfma_f32_16x16x32_bf16 v[236:239], a[20:23], a[196:199], v[236:239]
    s_add_u32 s52, s47, 532480
    v_mfma_f32_16x16x32_bf16 a[104:107], a[20:23], a[200:203], a[104:107]
    v_mfma_f32_16x16x32_bf16 a[108:111], a[20:23], a[204:207], a[108:111]
    buffer_store_dwordx4 v[168:171], v1, s[32:35], s52 offen offset:2048 sc1
    v_mfma_f32_16x16x32_bf16 v[240:243], a[24:27], a[192:195], v[240:243]
    v_mfma_f32_16x16x32_bf16 v[244:247], a[24:27], a[196:199], v[244:247]
    v_mfma_f32_16x16x32_bf16 a[112:115], a[24:27], a[200:203], a[112:115]
    v_mfma_f32_16x16x32_bf16 a[116:119], a[24:27], a[204:207], a[116:119]
    v_mfma_f32_16x16x32_bf16 v[248:251], a[28:31], a[192:195], v[248:251]
    v_mfma_f32_16x16x32_bf16 v[252:255], a[28:31], a[196:199], v[252:255]
    v_mfma_f32_16x16x32_bf16 a[120:123], a[28:31], a[200:203], a[120:123]
    v_mfma_f32_16x16x32_bf16 a[124:127], a[28:31], a[204:207], a[124:127]
    s_waitcnt vmcnt(11) lgkmcnt(0)
    s_barrier
    v_mfma_f32_16x16x32_bf16 v[192:195], a[32:35], a[208:211], v[192:195]
    ds_read_b64_tr_b16 a[0:1], v42 offset:16384
    ds_read_b64_tr_b16 a[2:3], v42 offset:17408
    v_mfma_f32_16x16x32_bf16 v[196:199], a[32:35], a[212:215], v[196:199]
    s_add_u32 m0, s60, 131072
    v_mfma_f32_16x16x32_bf16 a[64:67], a[32:35], a[216:219], a[64:67]
    buffer_load_dwordx4 v38, s[12:15], s61 offen offset:0 lds
    ds_read_b64_tr_b16 a[4:5], v43 offset:16384
    v_mfma_f32_16x16x32_bf16 a[68:71], a[32:35], a[220:223], a[68:71]
    ds_read_b64_tr_b16 a[6:7], v43 offset:17408
    v_mfma_f32_16x16x32_bf16 v[200:203], a[36:39], a[208:211], v[200:203]
    buffer_load_dwordx4 v39, s[12:15], s61 offen offset:1024 lds
    ds_read_b64_tr_b16 a[8:9], v44 offset:16384
    v_mfma_f32_16x16x32_bf16 v[204:207], a[36:39], a[212:215], v[204:207]
    v_mfma_f32_16x16x32_bf16 a[72:75], a[36:39], a[216:219], a[72:75]
    ds_read_b64_tr_b16 a[10:11], v44 offset:17408
    v_mfma_f32_16x16x32_bf16 a[76:79], a[36:39], a[220:223], a[76:79]
    buffer_load_dwordx4 v40, s[12:15], s61 offen offset:2048 lds
    ds_read_b64_tr_b16 a[12:13], v45 offset:16384
    v_mfma_f32_16x16x32_bf16 v[208:211], a[40:43], a[208:211], v[208:211]
    v_mfma_f32_16x16x32_bf16 v[212:215], a[40:43], a[212:215], v[212:215]
    ds_read_b64_tr_b16 a[14:15], v45 offset:17408
    v_mfma_f32_16x16x32_bf16 a[80:83], a[40:43], a[216:219], a[80:83]
    buffer_load_dwordx4 v41, s[12:15], s61 offen offset:3072 lds
    ds_read_b64_tr_b16 a[16:17], v46 offset:16384
    v_mfma_f32_16x16x32_bf16 a[84:87], a[40:43], a[220:223], a[84:87]
    ds_read_b64_tr_b16 a[18:19], v46 offset:17408
    v_mfma_f32_16x16x32_bf16 v[216:219], a[44:47], a[208:211], v[216:219]
    s_add_u32 s61, s61, 0x80000
    v_mfma_f32_16x16x32_bf16 v[220:223], a[44:47], a[212:215], v[220:223]
    buffer_load_dwordx4 a[128:131], v36, s[8:11], s62 offen offset:0 sc1
    ds_read_b64_tr_b16 a[20:21], v47 offset:16384
    v_mfma_f32_16x16x32_bf16 a[88:91], a[44:47], a[216:219], a[88:91]
    ds_read_b64_tr_b16 a[22:23], v47 offset:17408
    v_mfma_f32_16x16x32_bf16 a[92:95], a[44:47], a[220:223], a[92:95]
    ds_read_b64_tr_b16 a[24:25], v48 offset:16384
    v_mfma_f32_16x16x32_bf16 v[224:227], a[48:51], a[208:211], v[224:227]
    buffer_load_dwordx4 a[132:135], v36, s[8:11], s62 offen offset:1024 sc1
    v_mfma_f32_16x16x32_bf16 v[228:231], a[48:51], a[212:215], v[228:231]
    ds_read_b64_tr_b16 a[26:27], v48 offset:17408
    v_mfma_f32_16x16x32_bf16 a[96:99], a[48:51], a[216:219], a[96:99]
    ds_read_b64_tr_b16 a[28:29], v49 offset:16384
    v_mfma_f32_16x16x32_bf16 a[100:103], a[48:51], a[220:223], a[100:103]
    buffer_load_dwordx4 a[136:139], v37, s[8:11], s62 offen offset:0 sc1
    v_mfma_f32_16x16x32_bf16 v[232:235], a[52:55], a[208:211], v[232:235]
    ds_read_b64_tr_b16 a[30:31], v49 offset:17408
    v_mfma_f32_16x16x32_bf16 v[236:239], a[52:55], a[212:215], v[236:239]
    v_mfma_f32_16x16x32_bf16 a[104:107], a[52:55], a[216:219], a[104:107]
    buffer_load_dwordx4 a[140:143], v37, s[8:11], s62 offen offset:1024 sc1
    v_mfma_f32_16x16x32_bf16 a[108:111], a[52:55], a[220:223], a[108:111]
    v_mfma_f32_16x16x32_bf16 v[240:243], a[56:59], a[208:211], v[240:243]
    s_add_u32 s62, s62, 0x20000
    v_mfma_f32_16x16x32_bf16 v[244:247], a[56:59], a[212:215], v[244:247]
    s_add_u32 s52, s47, 532480
    v_mfma_f32_16x16x32_bf16 a[112:115], a[56:59], a[216:219], a[112:115]
    buffer_store_dwordx4 v[172:175], v1, s[32:35], s52 offen offset:3072 sc1
    v_mfma_f32_16x16x32_bf16 a[116:119], a[56:59], a[220:223], a[116:119]
    v_mfma_f32_16x16x32_bf16 v[248:251], a[60:63], a[208:211], v[248:251]
    v_mfma_f32_16x16x32_bf16 v[252:255], a[60:63], a[212:215], v[252:255]
    v_mfma_f32_16x16x32_bf16 a[120:123], a[60:63], a[216:219], a[120:123]
    v_mfma_f32_16x16x32_bf16 a[124:127], a[60:63], a[220:223], a[124:127]
    s_waitcnt vmcnt(16) lgkmcnt(0)
    v_mfma_f32_16x16x32_bf16 v[192:195], a[0:3], a[224:227], v[192:195]
    ds_read_b64_tr_b16 a[32:33], v42 offset:24576
    ds_read_b64_tr_b16 a[34:35], v42 offset:25600
    v_mfma_f32_16x16x32_bf16 v[196:199], a[0:3], a[228:231], v[196:199]
    buffer_load_dwordx4 a[144:147], v36, s[8:11], s62 offen offset:0 sc1
    v_mfma_f32_16x16x32_bf16 a[64:67], a[0:3], a[232:235], a[64:67]
    ds_read_b64_tr_b16 a[36:37], v43 offset:24576
    v_mfma_f32_16x16x32_bf16 a[68:71], a[0:3], a[236:239], a[68:71]
    ds_read_b64_tr_b16 a[38:39], v43 offset:25600
    v_mfma_f32_16x16x32_bf16 v[200:203], a[4:7], a[224:227], v[200:203]
    ds_read_b64_tr_b16 a[40:41], v44 offset:24576
    v_mfma_f32_16x16x32_bf16 v[204:207], a[4:7], a[228:231], v[204:207]
    buffer_load_dwordx4 a[148:151], v36, s[8:11], s62 offen offset:1024 sc1
    v_mfma_f32_16x16x32_bf16 a[72:75], a[4:7], a[232:235], a[72:75]
    ds_read_b64_tr_b16 a[42:43], v44 offset:25600
    v_mfma_f32_16x16x32_bf16 a[76:79], a[4:7], a[236:239], a[76:79]
    ds_read_b64_tr_b16 a[44:45], v45 offset:24576
    v_mfma_f32_16x16x32_bf16 v[208:211], a[8:11], a[224:227], v[208:211]
    v_mfma_f32_16x16x32_bf16 v[212:215], a[8:11], a[228:231], v[212:215]
    ds_read_b64_tr_b16 a[46:47], v45 offset:25600
    v_mfma_f32_16x16x32_bf16 a[80:83], a[8:11], a[232:235], a[80:83]
    buffer_load_dwordx4 a[152:155], v37, s[8:11], s62 offen offset:0 sc1
    ds_read_b64_tr_b16 a[48:49], v46 offset:24576
    v_mfma_f32_16x16x32_bf16 a[84:87], a[8:11], a[236:239], a[84:87]
    ds_read_b64_tr_b16 a[50:51], v46 offset:25600
    v_mfma_f32_16x16x32_bf16 v[216:219], a[12:15], a[224:227], v[216:219]
    v_mfma_f32_16x16x32_bf16 v[220:223], a[12:15], a[228:231], v[220:223]
    ds_read_b64_tr_b16 a[52:53], v47 offset:24576
    v_mfma_f32_16x16x32_bf16 a[88:91], a[12:15], a[232:235], a[88:91]
    buffer_load_dwordx4 a[156:159], v37, s[8:11], s62 offen offset:1024 sc1
    ds_read_b64_tr_b16 a[54:55], v47 offset:25600
    v_mfma_f32_16x16x32_bf16 a[92:95], a[12:15], a[236:239], a[92:95]
    ds_read_b64_tr_b16 a[56:57], v48 offset:24576
    v_mfma_f32_16x16x32_bf16 v[224:227], a[16:19], a[224:227], v[224:227]
    v_mfma_f32_16x16x32_bf16 v[228:231], a[16:19], a[228:231], v[228:231]
    ds_read_b64_tr_b16 a[58:59], v48 offset:25600
    v_mfma_f32_16x16x32_bf16 a[96:99], a[16:19], a[232:235], a[96:99]
    s_add_u32 s62, s62, 0x20000
    ds_read_b64_tr_b16 a[60:61], v49 offset:24576
    v_mfma_f32_16x16x32_bf16 a[100:103], a[16:19], a[236:239], a[100:103]
    s_add_u32 s52, s47, 536576
    v_mfma_f32_16x16x32_bf16 v[232:235], a[20:23], a[224:227], v[232:235]
    buffer_store_dwordx4 v[176:179], v1, s[32:35], s52 offen offset:0 sc1
    ds_read_b64_tr_b16 a[62:63], v49 offset:25600
    v_mfma_f32_16x16x32_bf16 v[236:239], a[20:23], a[228:231], v[236:239]
    s_add_u32 s52, s47, 536576
    v_mfma_f32_16x16x32_bf16 a[104:107], a[20:23], a[232:235], a[104:107]
    v_mfma_f32_16x16x32_bf16 a[108:111], a[20:23], a[236:239], a[108:111]
    buffer_store_dwordx4 v[180:183], v1, s[32:35], s52 offen offset:1024 sc1
    v_mfma_f32_16x16x32_bf16 v[240:243], a[24:27], a[224:227], v[240:243]
    v_mfma_f32_16x16x32_bf16 v[244:247], a[24:27], a[228:231], v[244:247]
    v_mfma_f32_16x16x32_bf16 a[112:115], a[24:27], a[232:235], a[112:115]
    v_mfma_f32_16x16x32_bf16 a[116:119], a[24:27], a[236:239], a[116:119]
    v_mfma_f32_16x16x32_bf16 v[248:251], a[28:31], a[224:227], v[248:251]
    v_mfma_f32_16x16x32_bf16 v[252:255], a[28:31], a[228:231], v[252:255]
    v_mfma_f32_16x16x32_bf16 a[120:123], a[28:31], a[232:235], a[120:123]
    v_mfma_f32_16x16x32_bf16 a[124:127], a[28:31], a[236:239], a[124:127]
    s_waitcnt vmcnt(11) lgkmcnt(0)
    s_barrier
    v_mfma_f32_16x16x32_bf16 v[192:195], a[32:35], a[240:243], v[192:195]
    ds_read_b64_tr_b16 a[0:1], v42 offset:32768
    ds_read_b64_tr_b16 a[2:3], v42 offset:33792
    v_mfma_f32_16x16x32_bf16 v[196:199], a[32:35], a[244:247], v[196:199]
    s_add_u32 m0, s60, 147456
    v_mfma_f32_16x16x32_bf16 a[64:67], a[32:35], a[248:251], a[64:67]
    buffer_load_dwordx4 v38, s[12:15], s61 offen offset:0 lds
    ds_read_b64_tr_b16 a[4:5], v43 offset:32768
    v_mfma_f32_16x16x32_bf16 a[68:71], a[32:35], a[252:255], a[68:71]
    ds_read_b64_tr_b16 a[6:7], v43 offset:33792
    v_mfma_f32_16x16x32_bf16 v[200:203], a[36:39], a[240:243], v[200:203]
    buffer_load_dwordx4 v39, s[12:15], s61 offen offset:1024 lds
    ds_read_b64_tr_b16 a[8:9], v44 offset:32768
    v_mfma_f32_16x16x32_bf16 v[204:207], a[36:39], a[244:247], v[204:207]
    v_mfma_f32_16x16x32_bf16 a[72:75], a[36:39], a[248:251], a[72:75]
    buffer_load_dwordx4 v40, s[12:15], s61 offen offset:2048 lds
    ds_read_b64_tr_b16 a[10:11], v44 offset:33792
    v_mfma_f32_16x16x32_bf16 a[76:79], a[36:39], a[252:255], a[76:79]
    ds_read_b64_tr_b16 a[12:13], v45 offset:32768
    v_mfma_f32_16x16x32_bf16 v[208:211], a[40:43], a[240:243], v[208:211]
    v_mfma_f32_16x16x32_bf16 v[212:215], a[40:43], a[244:247], v[212:215]
    buffer_load_dwordx4 v41, s[12:15], s61 offen offset:3072 lds
    ds_read_b64_tr_b16 a[14:15], v45 offset:33792
    v_mfma_f32_16x16x32_bf16 a[80:83], a[40:43], a[248:251], a[80:83]
    ds_read_b64_tr_b16 a[16:17], v46 offset:32768
    v_mfma_f32_16x16x32_bf16 a[84:87], a[40:43], a[252:255], a[84:87]
    s_add_u32 s61, s61, 0x80000
    ds_read_b64_tr_b16 a[18:19], v46 offset:33792
    v_mfma_f32_16x16x32_bf16 v[216:219], a[44:47], a[240:243], v[216:219]
    buffer_load_dwordx4 a[160:163], v36, s[8:11], s62 offen offset:0 sc1
    v_mfma_f32_16x16x32_bf16 v[220:223], a[44:47], a[244:247], v[220:223]
    ds_read_b64_tr_b16 a[20:21], v47 offset:32768
    v_mfma_f32_16x16x32_bf16 a[88:91], a[44:47], a[248:251], a[88:91]
    buffer_load_dwordx4 a[164:167], v36, s[8:11], s62 offen offset:1024 sc1
    ds_read_b64_tr_b16 a[22:23], v47 offset:33792
    v_mfma_f32_16x16x32_bf16 a[92:95], a[44:47], a[252:255], a[92:95]
    ds_read_b64_tr_b16 a[24:25], v48 offset:32768
    v_mfma_f32_16x16x32_bf16 v[224:227], a[48:51], a[240:243], v[224:227]
    v_mfma_f32_16x16x32_bf16 v[228:231], a[48:51], a[244:247], v[228:231]
    buffer_load_dwordx4 a[168:171], v37, s[8:11], s62 offen offset:0 sc1
    ds_read_b64_tr_b16 a[26:27], v48 offset:33792
    v_mfma_f32_16x16x32_bf16 a[96:99], a[48:51], a[248:251], a[96:99]
    ds_read_b64_tr_b16 a[28:29], v49 offset:32768
    v_mfma_f32_16x16x32_bf16 a[100:103], a[48:51], a[252:255], a[100:103]
    v_mfma_f32_16x16x32_bf16 v[232:235], a[52:55], a[240:243], v[232:235]
    buffer_load_dwordx4 a[172:175], v37, s[8:11], s62 offen offset:1024 sc1
    ds_read_b64_tr_b16 a[30:31], v49 offset:33792
    v_mfma_f32_16x16x32_bf16 v[236:239], a[52:55], a[244:247], v[236:239]
    v_mfma_f32_16x16x32_bf16 a[104:107], a[52:55], a[248:251], a[104:107]
    s_add_u32 s62, s62, 0x20000
    v_mfma_f32_16x16x32_bf16 a[108:111], a[52:55], a[252:255], a[108:111]
    s_add_u32 s52, s47, 536576
    v_mfma_f32_16x16x32_bf16 v[240:243], a[56:59], a[240:243], v[240:243]
    buffer_store_dwordx4 v[184:187], v1, s[32:35], s52 offen offset:2048 sc1
    v_mfma_f32_16x16x32_bf16 v[244:247], a[56:59], a[244:247], v[244:247]
    s_add_u32 s52, s47, 536576
    v_mfma_f32_16x16x32_bf16 a[112:115], a[56:59], a[248:251], a[112:115]
    buffer_store_dwordx4 v[188:191], v1, s[32:35], s52 offen offset:3072 sc1
    v_mfma_f32_16x16x32_bf16 a[116:119], a[56:59], a[252:255], a[116:119]
    v_mfma_f32_16x16x32_bf16 v[248:251], a[60:63], a[240:243], v[248:251]
    v_mfma_f32_16x16x32_bf16 v[252:255], a[60:63], a[244:247], v[252:255]
    v_mfma_f32_16x16x32_bf16 a[120:123], a[60:63], a[248:251], a[120:123]
    v_mfma_f32_16x16x32_bf16 a[124:127], a[60:63], a[252:255], a[124:127]
    s_waitcnt vmcnt(17) lgkmcnt(0)
    v_mfma_f32_16x16x32_bf16 v[192:195], a[0:3], a[128:131], v[192:195]
    ds_read_b64_tr_b16 a[32:33], v42 offset:40960
    ds_read_b64_tr_b16 a[34:35], v42 offset:41984
    v_mfma_f32_16x16x32_bf16 v[196:199], a[0:3], a[132:135], v[196:199]
    buffer_load_dwordx4 a[176:179], v36, s[8:11], s62 offen offset:0 sc1
    v_mfma_f32_16x16x32_bf16 a[64:67], a[0:3], a[136:139], a[64:67]
    ds_read_b64_tr_b16 a[36:37], v43 offset:40960
    v_mfma_f32_16x16x32_bf16 a[68:71], a[0:3], a[140:143], a[68:71]
    ds_read_b64_tr_b16 a[38:39], v43 offset:41984
    v_mfma_f32_16x16x32_bf16 v[200:203], a[4:7], a[128:131], v[200:203]
    ds_read_b64_tr_b16 a[40:41], v44 offset:40960
    v_mfma_f32_16x16x32_bf16 v[204:207], a[4:7], a[132:135], v[204:207]
    v_mfma_f32_16x16x32_bf16 a[72:75], a[4:7], a[136:139], a[72:75]
    ds_read_b64_tr_b16 a[42:43], v44 offset:41984
    v_mfma_f32_16x16x32_bf16 a[76:79], a[4:7], a[140:143], a[76:79]
    ds_read_b64_tr_b16 a[44:45], v45 offset:40960
    v_mfma_f32_16x16x32_bf16 v[208:211], a[8:11], a[128:131], v[208:211]
    buffer_load_dwordx4 a[180:183], v36, s[8:11], s62 offen offset:1024 sc1
    v_mfma_f32_16x16x32_bf16 v[212:215], a[8:11], a[132:135], v[212:215]
    ds_read_b64_tr_b16 a[46:47], v45 offset:41984
    v_mfma_f32_16x16x32_bf16 a[80:83], a[8:11], a[136:139], a[80:83]
    ds_read_b64_tr_b16 a[48:49], v46 offset:40960
    v_mfma_f32_16x16x32_bf16 a[84:87], a[8:11], a[140:143], a[84:87]
    ds_read_b64_tr_b16 a[50:51], v46 offset:41984
    v_mfma_f32_16x16x32_bf16 v[216:219], a[12:15], a[128:131], v[216:219]
    v_mfma_f32_16x16x32_bf16 v[220:223], a[12:15], a[132:135], v[220:223]
    ds_read_b64_tr_b16 a[52:53], v47 offset:40960
    v_mfma_f32_16x16x32_bf16 a[88:91], a[12:15], a[136:139], a[88:91]
    buffer_load_dwordx4 a[184:187], v37, s[8:11], s62 offen offset:0 sc1
    ds_read_b64_tr_b16 a[54:55], v47 offset:41984
    v_mfma_f32_16x16x32_bf16 a[92:95], a[12:15], a[140:143], a[92:95]
    ds_read_b64_tr_b16 a[56:57], v48 offset:40960
    v_mfma_f32_16x16x32_bf16 v[224:227], a[16:19], a[128:131], v[224:227]
    v_mfma_f32_16x16x32_bf16 v[228:231], a[16:19], a[132:135], v[228:231]
    ds_read_b64_tr_b16 a[58:59], v48 offset:41984
    v_mfma_f32_16x16x32_bf16 a[96:99], a[16:19], a[136:139], a[96:99]
    ds_read_b64_tr_b16 a[60:61], v49 offset:40960
    v_mfma_f32_16x16x32_bf16 a[100:103], a[16:19], a[140:143], a[100:103]
    v_mfma_f32_16x16x32_bf16 v[232:235], a[20:23], a[128:131], v[232:235]
    ds_read_b64_tr_b16 a[62:63], v49 offset:41984
    v_mfma_f32_16x16x32_bf16 v[236:239], a[20:23], a[132:135], v[236:239]
    buffer_load_dwordx4 a[188:191], v37, s[8:11], s62 offen offset:1024 sc1
    v_mfma_f32_16x16x32_bf16 a[104:107], a[20:23], a[136:139], a[104:107]
    v_mfma_f32_16x16x32_bf16 a[108:111], a[20:23], a[140:143], a[108:111]
    v_mfma_f32_16x16x32_bf16 v[240:243], a[24:27], a[128:131], v[240:243]
    v_mfma_f32_16x16x32_bf16 v[244:247], a[24:27], a[132:135], v[244:247]
    v_mfma_f32_16x16x32_bf16 a[112:115], a[24:27], a[136:139], a[112:115]
    v_mfma_f32_16x16x32_bf16 a[116:119], a[24:27], a[140:143], a[116:119]
    s_add_u32 s62, s62, 0x20000
    v_mfma_f32_16x16x32_bf16 v[248:251], a[28:31], a[128:131], v[248:251]
    v_mfma_f32_16x16x32_bf16 v[252:255], a[28:31], a[132:135], v[252:255]
    v_mfma_f32_16x16x32_bf16 a[120:123], a[28:31], a[136:139], a[120:123]
    v_mfma_f32_16x16x32_bf16 a[124:127], a[28:31], a[140:143], a[124:127]
    s_waitcnt vmcnt(10) lgkmcnt(0)
    s_barrier
    v_mfma_f32_16x16x32_bf16 v[192:195], a[32:35], a[144:147], v[192:195]
    ds_read_b64_tr_b16 a[0:1], v42 offset:49152
    ds_read_b64_tr_b16 a[2:3], v42 offset:50176
    v_mfma_f32_16x16x32_bf16 v[196:199], a[32:35], a[148:151], v[196:199]
    s_add_u32 m0, s60, 98304
    v_mfma_f32_16x16x32_bf16 a[64:67], a[32:35], a[152:155], a[64:67]
    buffer_load_dwordx4 v38, s[12:15], s61 offen offset:0 lds
    ds_read_b64_tr_b16 a[4:5], v43 offset:49152
    v_mfma_f32_16x16x32_bf16 a[68:71], a[32:35], a[156:159], a[68:71]
    ds_read_b64_tr_b16 a[6:7], v43 offset:50176
    v_mfma_f32_16x16x32_bf16 v[200:203], a[36:39], a[144:147], v[200:203]
    buffer_load_dwordx4 v39, s[12:15], s61 offen offset:1024 lds
    ds_read_b64_tr_b16 a[8:9], v44 offset:49152
    v_mfma_f32_16x16x32_bf16 v[204:207], a[36:39], a[148:151], v[204:207]
    v_mfma_f32_16x16x32_bf16 a[72:75], a[36:39], a[152:155], a[72:75]
    ds_read_b64_tr_b16 a[10:11], v44 offset:50176
    v_mfma_f32_16x16x32_bf16 a[76:79], a[36:39], a[156:159], a[76:79]
    ds_read_b64_tr_b16 a[12:13], v45 offset:49152
    v_mfma_f32_16x16x32_bf16 v[208:211], a[40:43], a[144:147], v[208:211]
    buffer_load_dwordx4 v40, s[12:15], s61 offen offset:2048 lds
    v_mfma_f32_16x16x32_bf16 v[212:215], a[40:43], a[148:151], v[212:215]
    ds_read_b64_tr_b16 a[14:15], v45 offset:50176
    v_mfma_f32_16x16x32_bf16 a[80:83], a[40:43], a[152:155], a[80:83]
    ds_read_b64_tr_b16 a[16:17], v46 offset:49152
    v_mfma_f32_16x16x32_bf16 a[84:87], a[40:43], a[156:159], a[84:87]
    buffer_load_dwordx4 v41, s[12:15], s61 offen offset:3072 lds
    ds_read_b64_tr_b16 a[18:19], v46 offset:50176
    v_mfma_f32_16x16x32_bf16 v[216:219], a[44:47], a[144:147], v[216:219]
    v_mfma_f32_16x16x32_bf16 v[220:223], a[44:47], a[148:151], v[220:223]
    s_add_u32 s61, s61, 0x80000
    ds_read_b64_tr_b16 a[20:21], v47 offset:49152
    v_mfma_f32_16x16x32_bf16 a[88:91], a[44:47], a[152:155], a[88:91]
    buffer_load_dwordx4 a[192:195], v36, s[8:11], s62 offen offset:0 sc1
    ds_read_b64_tr_b16 a[22:23], v47 offset:50176
    v_mfma_f32_16x16x32_bf16 a[92:95], a[44:47], a[156:159], a[92:95]
    ds_read_b64_tr_b16 a[24:25], v48 offset:49152
    v_mfma_f32_16x16x32_bf16 v[224:227], a[48:51], a[144:147], v[224:227]
    v_mfma_f32_16x16x32_bf16 v[228:231], a[48:51], a[148:151], v[228:231]
    ds_read_b64_tr_b16 a[26:27], v48 offset:50176
    v_mfma_f32_16x16x32_bf16 a[96:99], a[48:51], a[152:155], a[96:99]
    buffer_load_dwordx4 a[196:199], v36, s[8:11], s62 offen offset:1024 sc1
    ds_read_b64_tr_b16 a[28:29], v49 offset:49152
    v_mfma_f32_16x16x32_bf16 a[100:103], a[48:51], a[156:159], a[100:103]
    v_mfma_f32_16x16x32_bf16 v[232:235], a[52:55], a[144:147], v[232:235]
    ds_read_b64_tr_b16 a[30:31], v49 offset:50176
    v_mfma_f32_16x16x32_bf16 v[236:239], a[52:55], a[148:151], v[236:239]
    buffer_load_dwordx4 a[200:203], v37, s[8:11], s62 offen offset:0 sc1
    v_mfma_f32_16x16x32_bf16 a[104:107], a[52:55], a[152:155], a[104:107]
    v_mfma_f32_16x16x32_bf16 a[108:111], a[52:55], a[156:159], a[108:111]
    v_mfma_f32_16x16x32_bf16 v[240:243], a[56:59], a[144:147], v[240:243]
    v_mfma_f32_16x16x32_bf16 v[244:247], a[56:59], a[148:151], v[244:247]
    buffer_load_dwordx4 a[204:207], v37, s[8:11], s62 offen offset:1024 sc1
    v_mfma_f32_16x16x32_bf16 a[112:115], a[56:59], a[152:155], a[112:115]
    v_mfma_f32_16x16x32_bf16 a[116:119], a[56:59], a[156:159], a[116:119]
    s_add_u32 s62, s62, 0x20000
    v_mfma_f32_16x16x32_bf16 v[248:251], a[60:63], a[144:147], v[248:251]
    v_mfma_f32_16x16x32_bf16 v[252:255], a[60:63], a[148:151], v[252:255]
    v_mfma_f32_16x16x32_bf16 a[120:123], a[60:63], a[152:155], a[120:123]
    v_mfma_f32_16x16x32_bf16 a[124:127], a[60:63], a[156:159], a[124:127]
    s_waitcnt vmcnt(14) lgkmcnt(0)
    v_mfma_f32_16x16x32_bf16 v[192:195], a[0:3], a[160:163], v[192:195]
    ds_read_b64_tr_b16 a[32:33], v42 offset:57344
    ds_read_b64_tr_b16 a[34:35], v42 offset:58368
    v_mfma_f32_16x16x32_bf16 v[196:199], a[0:3], a[164:167], v[196:199]
    buffer_load_dwordx4 a[208:211], v36, s[8:11], s62 offen offset:0 sc1
    v_mfma_f32_16x16x32_bf16 a[64:67], a[0:3], a[168:171], a[64:67]
    ds_read_b64_tr_b16 a[36:37], v43 offset:57344
    v_mfma_f32_16x16x32_bf16 a[68:71], a[0:3], a[172:175], a[68:71]
    ds_read_b64_tr_b16 a[38:39], v43 offset:58368
    v_mfma_f32_16x16x32_bf16 v[200:203], a[4:7], a[160:163], v[200:203]
    ds_read_b64_tr_b16 a[40:41], v44 offset:57344
    v_mfma_f32_16x16x32_bf16 v[204:207], a[4:7], a[164:167], v[204:207]
    v_mfma_f32_16x16x32_bf16 a[72:75], a[4:7], a[168:171], a[72:75]
    ds_read_b64_tr_b16 a[42:43], v44 offset:58368
    v_mfma_f32_16x16x32_bf16 a[76:79], a[4:7], a[172:175], a[76:79]
    ds_read_b64_tr_b16 a[44:45], v45 offset:57344
    v_mfma_f32_16x16x32_bf16 v[208:211], a[8:11], a[160:163], v[208:211]
    buffer_load_dwordx4 a[212:215], v36, s[8:11], s62 offen offset:1024 sc1
    v_mfma_f32_16x16x32_bf16 v[212:215], a[8:11], a[164:167], v[212:215]
    ds_read_b64_tr_b16 a[46:47], v45 offset:58368
    v_mfma_f32_16x16x32_bf16 a[80:83], a[8:11], a[168:171], a[80:83]
    ds_read_b64_tr_b16 a[48:49], v46 offset:57344
    v_mfma_f32_16x16x32_bf16 a[84:87], a[8:11], a[172:175], a[84:87]
    ds_read_b64_tr_b16 a[50:51], v46 offset:58368
    v_mfma_f32_16x16x32_bf16 v[216:219], a[12:15], a[160:163], v[216:219]
    v_mfma_f32_16x16x32_bf16 v[220:223], a[12:15], a[164:167], v[220:223]
    ds_read_b64_tr_b16 a[52:53], v47 offset:57344
    v_mfma_f32_16x16x32_bf16 a[88:91], a[12:15], a[168:171], a[88:91]
    buffer_load_dwordx4 a[216:219], v37, s[8:11], s62 offen offset:0 sc1
    ds_read_b64_tr_b16 a[54:55], v47 offset:58368
    v_mfma_f32_16x16x32_bf16 a[92:95], a[12:15], a[172:175], a[92:95]
    ds_read_b64_tr_b16 a[56:57], v48 offset:57344
    v_mfma_f32_16x16x32_bf16 v[224:227], a[16:19], a[160:163], v[224:227]
    v_mfma_f32_16x16x32_bf16 v[228:231], a[16:19], a[164:167], v[228:231]
    ds_read_b64_tr_b16 a[58:59], v48 offset:58368
    v_mfma_f32_16x16x32_bf16 a[96:99], a[16:19], a[168:171], a[96:99]
    ds_read_b64_tr_b16 a[60:61], v49 offset:57344
    v_mfma_f32_16x16x32_bf16 a[100:103], a[16:19], a[172:175], a[100:103]
    v_mfma_f32_16x16x32_bf16 v[232:235], a[20:23], a[160:163], v[232:235]
    ds_read_b64_tr_b16 a[62:63], v49 offset:58368
    v_mfma_f32_16x16x32_bf16 v[236:239], a[20:23], a[164:167], v[236:239]
    buffer_load_dwordx4 a[220:223], v37, s[8:11], s62 offen offset:1024 sc1
    v_mfma_f32_16x16x32_bf16 a[104:107], a[20:23], a[168:171], a[104:107]
    v_mfma_f32_16x16x32_bf16 a[108:111], a[20:23], a[172:175], a[108:111]
    v_mfma_f32_16x16x32_bf16 v[240:243], a[24:27], a[160:163], v[240:243]
    v_mfma_f32_16x16x32_bf16 v[244:247], a[24:27], a[164:167], v[244:247]
    v_mfma_f32_16x16x32_bf16 a[112:115], a[24:27], a[168:171], a[112:115]
    v_mfma_f32_16x16x32_bf16 a[116:119], a[24:27], a[172:175], a[116:119]
    s_add_u32 s62, s62, 0x20000
    v_mfma_f32_16x16x32_bf16 v[248:251], a[28:31], a[160:163], v[248:251]
    v_mfma_f32_16x16x32_bf16 v[252:255], a[28:31], a[164:167], v[252:255]
    v_mfma_f32_16x16x32_bf16 a[120:123], a[28:31], a[168:171], a[120:123]
    v_mfma_f32_16x16x32_bf16 a[124:127], a[28:31], a[172:175], a[124:127]
    s_waitcnt vmcnt(8) lgkmcnt(0)
    s_barrier
    v_mfma_f32_16x16x32_bf16 v[192:195], a[32:35], a[176:179], v[192:195]
    ds_read_b64_tr_b16 a[0:1], v42 offset:0
    ds_read_b64_tr_b16 a[2:3], v42 offset:1024
    v_mfma_f32_16x16x32_bf16 v[196:199], a[32:35], a[180:183], v[196:199]
    s_cmp_eq_u32 s30, 0
    s_cbranch_scc1 k12_ool_40
k12_oolret_41:
    v_mfma_f32_16x16x32_bf16 a[64:67], a[32:35], a[184:187], a[64:67]
    s_add_u32 m0, s60, 114688
    ds_read_b64_tr_b16 a[4:5], v43 offset:0
    v_mfma_f32_16x16x32_bf16 a[68:71], a[32:35], a[188:191], a[68:71]
    buffer_load_dwordx4 v38, s[12:15], s61 offen offset:0 lds
    ds_read_b64_tr_b16 a[6:7], v43 offset:1024
    v_mfma_f32_16x16x32_bf16 v[200:203], a[36:39], a[176:179], v[200:203]
    buffer_load_dwordx4 v39, s[12:15], s61 offen offset:1024 lds
    ds_read_b64_tr_b16 a[8:9], v44 offset:0
    v_mfma_f32_16x16x32_bf16 v[204:207], a[36:39], a[180:183], v[204:207]
    v_mfma_f32_16x16x32_bf16 a[72:75], a[36:39], a[184:187], a[72:75]
    ds_read_b64_tr_b16 a[10:11], v44 offset:1024
    v_mfma_f32_16x16x32_bf16 a[76:79], a[36:39], a[188:191], a[76:79]
    ds_read_b64_tr_b16 a[12:13], v45 offset:0
    v_mfma_f32_16x16x32_bf16 v[208:211], a[40:43], a[176:179], v[208:211]
    s_mov_b32 s32, s60
    buffer_load_dwordx4 v40, s[12:15], s61 offen offset:2048 lds
    v_mfma_f32_16x16x32_bf16 v[212:215], a[40:43], a[180:183], v[212:215]
    ds_read_b64_tr_b16 a[14:15], v45 offset:1024
    v_mfma_f32_16x16x32_bf16 a[80:83], a[40:43], a[184:187], a[80:83]
    s_mov_b32 s34, s60
    ds_read_b64_tr_b16 a[16:17], v46 offset:0
    v_mfma_f32_16x16x32_bf16 a[84:87], a[40:43], a[188:191], a[84:87]
    buffer_load_dwordx4 v41, s[12:15], s61 offen offset:3072 lds
    ds_read_b64_tr_b16 a[18:19], v46 offset:1024
    v_mfma_f32_16x16x32_bf16 v[216:219], a[44:47], a[176:179], v[216:219]
    v_mfma_f32_16x16x32_bf16 v[220:223], a[44:47], a[180:183], v[220:223]
    s_mov_b32 s33, s60
    ds_read_b64_tr_b16 a[20:21], v47 offset:0
    v_mfma_f32_16x16x32_bf16 a[88:91], a[44:47], a[184:187], a[88:91]
    s_add_u32 s61, s61, 0x80000
    buffer_load_dwordx4 a[224:227], v36, s[8:11], s62 offen offset:0 sc1
    ds_read_b64_tr_b16 a[22:23], v47 offset:1024
    v_mfma_f32_16x16x32_bf16 a[92:95], a[44:47], a[188:191], a[92:95]
    ds_read_b64_tr_b16 a[24:25], v48 offset:0
    v_mfma_f32_16x16x32_bf16 v[224:227], a[48:51], a[176:179], v[224:227]
    s_add_u32 s35, s60, 0x10000
    v_mfma_f32_16x16x32_bf16 v[228:231], a[48:51], a[180:183], v[228:231]
    ds_read_b64_tr_b16 a[26:27], v48 offset:1024
    v_mfma_f32_16x16x32_bf16 a[96:99], a[48:51], a[184:187], a[96:99]
    buffer_load_dwordx4 a[228:231], v36, s[8:11], s62 offen offset:1024 sc1
    ds_read_b64_tr_b16 a[28:29], v49 offset:0
    v_mfma_f32_16x16x32_bf16 a[100:103], a[48:51], a[188:191], a[100:103]
    v_mfma_f32_16x16x32_bf16 v[232:235], a[52:55], a[176:179], v[232:235]
    ds_read_b64_tr_b16 a[30:31], v49 offset:1024
    v_mfma_f32_16x16x32_bf16 v[236:239], a[52:55], a[180:183], v[236:239]
    buffer_load_dwordx4 a[232:235], v37, s[8:11], s62 offen offset:0 sc1
    v_mfma_f32_16x16x32_bf16 a[104:107], a[52:55], a[184:187], a[104:107]
    v_mfma_f32_16x16x32_bf16 a[108:111], a[52:55], a[188:191], a[108:111]
    v_mfma_f32_16x16x32_bf16 v[240:243], a[56:59], a[176:179], v[240:243]
    v_mfma_f32_16x16x32_bf16 v[244:247], a[56:59], a[180:183], v[244:247]
    buffer_load_dwordx4 a[236:239], v37, s[8:11], s62 offen offset:1024 sc1
    v_mfma_f32_16x16x32_bf16 a[112:115], a[56:59], a[184:187], a[112:115]
    v_mfma_f32_16x16x32_bf16 a[116:119], a[56:59], a[188:191], a[116:119]
    s_add_u32 s62, s62, 0x20000
    v_mfma_f32_16x16x32_bf16 v[248:251], a[60:63], a[176:179], v[248:251]
    v_mfma_f32_16x16x32_bf16 v[252:255], a[60:63], a[180:183], v[252:255]
    v_mfma_f32_16x16x32_bf16 a[120:123], a[60:63], a[184:187], a[120:123]
    v_mfma_f32_16x16x32_bf16 a[124:127], a[60:63], a[188:191], a[124:127]
    s_waitcnt vmcnt(12) lgkmcnt(0)
    v_mfma_f32_16x16x32_bf16 v[192:195], a[0:3], a[192:195], v[192:195]
    ds_read_b64_tr_b16 a[32:33], v42 offset:8192
    ds_read_b64_tr_b16 a[34:35], v42 offset:9216
    v_mfma_f32_16x16x32_bf16 v[196:199], a[0:3], a[196:199], v[196:199]
    buffer_load_dwordx4 a[240:243], v36, s[8:11], s62 offen offset:0 sc1
    v_mfma_f32_16x16x32_bf16 a[64:67], a[0:3], a[200:203], a[64:67]
    ds_read_b64_tr_b16 a[36:37], v43 offset:8192
    v_mfma_f32_16x16x32_bf16 a[68:71], a[0:3], a[204:207], a[68:71]
    ds_read_b64_tr_b16 a[38:39], v43 offset:9216
    v_mfma_f32_16x16x32_bf16 v[200:203], a[4:7], a[192:195], v[200:203]
    ds_read_b64_tr_b16 a[40:41], v44 offset:8192
    v_mfma_f32_16x16x32_bf16 v[204:207], a[4:7], a[196:199], v[204:207]
    v_mfma_f32_16x16x32_bf16 a[72:75], a[4:7], a[200:203], a[72:75]
    ds_read_b64_tr_b16 a[42:43], v44 offset:9216
    v_mfma_f32_16x16x32_bf16 a[76:79], a[4:7], a[204:207], a[76:79]
    ds_read_b64_tr_b16 a[44:45], v45 offset:8192
    v_mfma_f32_16x16x32_bf16 v[208:211], a[8:11], a[192:195], v[208:211]
    buffer_load_dwordx4 a[244:247], v36, s[8:11], s62 offen offset:1024 sc1
    v_mfma_f32_16x16x32_bf16 v[212:215], a[8:11], a[196:199], v[212:215]
    ds_read_b64_tr_b16 a[46:47], v45 offset:9216
    v_mfma_f32_16x16x32_bf16 a[80:83], a[8:11], a[200:203], a[80:83]
    ds_read_b64_tr_b16 a[48:49], v46 offset:8192
    v_mfma_f32_16x16x32_bf16 a[84:87], a[8:11], a[204:207], a[84:87]
    ds_read_b64_tr_b16 a[50:51], v46 offset:9216
    v_mfma_f32_16x16x32_bf16 v[216:219], a[12:15], a[192:195], v[216:219]
    v_mfma_f32_16x16x32_bf16 v[220:223], a[12:15], a[196:199], v[220:223]
    ds_read_b64_tr_b16 a[52:53], v47 offset:8192
    v_mfma_f32_16x16x32_bf16 a[88:91], a[12:15], a[200:203], a[88:91]
    buffer_load_dwordx4 a[248:251], v37, s[8:11], s62 offen offset:0 sc1
    ds_read_b64_tr_b16 a[54:55], v47 offset:9216
    v_mfma_f32_16x16x32_bf16 a[92:95], a[12:15], a[204:207], a[92:95]
    ds_read_b64_tr_b16 a[56:57], v48 offset:8192
    v_mfma_f32_16x16x32_bf16 v[224:227], a[16:19], a[192:195], v[224:227]
    v_mfma_f32_16x16x32_bf16 v[228:231], a[16:19], a[196:199], v[228:231]
    ds_read_b64_tr_b16 a[58:59], v48 offset:9216
    v_mfma_f32_16x16x32_bf16 a[96:99], a[16:19], a[200:203], a[96:99]
    ds_read_b64_tr_b16 a[60:61], v49 offset:8192
    v_mfma_f32_16x16x32_bf16 a[100:103], a[16:19], a[204:207], a[100:103]
    v_mfma_f32_16x16x32_bf16 v[232:235], a[20:23], a[192:195], v[232:235]
    ds_read_b64_tr_b16 a[62:63], v49 offset:9216
    v_mfma_f32_16x16x32_bf16 v[236:239], a[20:23], a[196:199], v[236:239]
    buffer_load_dwordx4 a[252:255], v37, s[8:11], s62 offen offset:1024 sc1
    v_mfma_f32_16x16x32_bf16 a[104:107], a[20:23], a[200:203], a[104:107]
    v_mfma_f32_16x16x32_bf16 a[108:111], a[20:23], a[204:207], a[108:111]
    v_mfma_f32_16x16x32_bf16 v[240:243], a[24:27], a[192:195], v[240:243]
    v_mfma_f32_16x16x32_bf16 v[244:247], a[24:27], a[196:199], v[244:247]
    v_mfma_f32_16x16x32_bf16 a[112:115], a[24:27], a[200:203], a[112:115]
    v_mfma_f32_16x16x32_bf16 a[116:119], a[24:27], a[204:207], a[116:119]
    s_add_u32 s62, s62, 0x20000
    v_mfma_f32_16x16x32_bf16 v[248:251], a[28:31], a[192:195], v[248:251]
    v_add_co_u32 v2, vcc, 0x4000, v2
    s_nop 1
    v_addc_co_u32 v3, vcc, 0, v3, vcc
    global_load_dword v51, v[2:3], off
    v_mfma_f32_16x16x32_bf16 v[252:255], a[28:31], a[196:199], v[252:255]
    v_mfma_f32_16x16x32_bf16 a[120:123], a[28:31], a[200:203], a[120:123]
    v_mfma_f32_16x16x32_bf16 a[124:127], a[28:31], a[204:207], a[124:127]
    s_waitcnt vmcnt(8) lgkmcnt(0)
    s_barrier
    v_mfma_f32_16x16x32_bf16 v[192:195], a[32:35], a[208:211], v[192:195]
    ds_read_b64_tr_b16 a[0:1], v42 offset:16384
    ds_read_b64_tr_b16 a[2:3], v42 offset:17408
    v_mfma_f32_16x16x32_bf16 v[196:199], a[32:35], a[212:215], v[196:199]
    s_add_u32 m0, s60, 131072
    v_mfma_f32_16x16x32_bf16 a[64:67], a[32:35], a[216:219], a[64:67]
    buffer_load_dwordx4 v38, s[12:15], s61 offen offset:0 lds
    ds_read_b64_tr_b16 a[4:5], v43 offset:16384
    v_mfma_f32_16x16x32_bf16 a[68:71], a[32:35], a[220:223], a[68:71]
    ds_read_b64_tr_b16 a[6:7], v43 offset:17408
    v_mfma_f32_16x16x32_bf16 v[200:203], a[36:39], a[208:211], v[200:203]
    buffer_load_dwordx4 v39, s[12:15], s61 offen offset:1024 lds
    ds_read_b64_tr_b16 a[8:9], v44 offset:16384
    v_mfma_f32_16x16x32_bf16 v[204:207], a[36:39], a[212:215], v[204:207]
    v_mfma_f32_16x16x32_bf16 a[72:75], a[36:39], a[216:219], a[72:75]
    ds_read_b64_tr_b16 a[10:11], v44 offset:17408
    v_mfma_f32_16x16x32_bf16 a[76:79], a[36:39], a[220:223], a[76:79]
    ds_read_b64_tr_b16 a[12:13], v45 offset:16384
    v_mfma_f32_16x16x32_bf16 v[208:211], a[40:43], a[208:211], v[208:211]
    buffer_load_dwordx4 v40, s[12:15], s61 offen offset:2048 lds
    v_mfma_f32_16x16x32_bf16 v[212:215], a[40:43], a[212:215], v[212:215]
    ds_read_b64_tr_b16 a[14:15], v45 offset:17408
    v_mfma_f32_16x16x32_bf16 a[80:83], a[40:43], a[216:219], a[80:83]
    ds_read_b64_tr_b16 a[16:17], v46 offset:16384
    v_mfma_f32_16x16x32_bf16 a[84:87], a[40:43], a[220:223], a[84:87]
    buffer_load_dwordx4 v41, s[12:15], s61 offen offset:3072 lds
    ds_read_b64_tr_b16 a[18:19], v46 offset:17408
    v_mfma_f32_16x16x32_bf16 v[216:219], a[44:47], a[208:211], v[216:219]
    v_mfma_f32_16x16x32_bf16 v[220:223], a[44:47], a[212:215], v[220:223]
    s_add_u32 s61, s61, 0x80000
    ds_read_b64_tr_b16 a[20:21], v47 offset:16384
    v_mfma_f32_16x16x32_bf16 a[88:91], a[44:47], a[216:219], a[88:91]
    buffer_load_dwordx4 a[128:131], v36, s[8:11], s62 offen offset:0 sc1
    ds_read_b64_tr_b16 a[22:23], v47 offset:17408
    v_mfma_f32_16x16x32_bf16 a[92:95], a[44:47], a[220:223], a[92:95]
    ds_read_b64_tr_b16 a[24:25], v48 offset:16384
    v_mfma_f32_16x16x32_bf16 v[224:227], a[48:51], a[208:211], v[224:227]
    v_mfma_f32_16x16x32_bf16 v[228:231], a[48:51], a[212:215], v[228:231]
    ds_read_b64_tr_b16 a[26:27], v48 offset:17408
    v_mfma_f32_16x16x32_bf16 a[96:99], a[48:51], a[216:219], a[96:99]
    buffer_load_dwordx4 a[132:135], v36, s[8:11], s62 offen offset:1024 sc1
    ds_read_b64_tr_b16 a[28:29], v49 offset:16384
    v_mfma_f32_16x16x32_bf16 a[100:103], a[48:51], a[220:223], a[100:103]
    v_mfma_f32_16x16x32_bf16 v[232:235], a[52:55], a[208:211], v[232:235]
    ds_read_b64_tr_b16 a[30:31], v49 offset:17408
    v_mfma_f32_16x16x32_bf16 v[236:239], a[52:55], a[212:215], v[236:239]
    buffer_load_dwordx4 a[136:139], v37, s[8:11], s62 offen offset:0 sc1
    v_mfma_f32_16x16x32_bf16 a[104:107], a[52:55], a[216:219], a[104:107]
    v_mfma_f32_16x16x32_bf16 a[108:111], a[52:55], a[220:223], a[108:111]
    v_mfma_f32_16x16x32_bf16 v[240:243], a[56:59], a[208:211], v[240:243]
    v_mfma_f32_16x16x32_bf16 v[244:247], a[56:59], a[212:215], v[244:247]
    buffer_load_dwordx4 a[140:143], v37, s[8:11], s62 offen offset:1024 sc1
    v_mfma_f32_16x16x32_bf16 a[112:115], a[56:59], a[216:219], a[112:115]
    v_mfma_f32_16x16x32_bf16 a[116:119], a[56:59], a[220:223], a[116:119]
    s_add_u32 s62, s62, 0x20000
    v_mfma_f32_16x16x32_bf16 v[248:251], a[60:63], a[208:211], v[248:251]
    v_mfma_f32_16x16x32_bf16 v[252:255], a[60:63], a[212:215], v[252:255]
    v_mfma_f32_16x16x32_bf16 a[120:123], a[60:63], a[216:219], a[120:123]
    v_mfma_f32_16x16x32_bf16 a[124:127], a[60:63], a[220:223], a[124:127]
    s_waitcnt vmcnt(12) lgkmcnt(0)
    v_mfma_f32_16x16x32_bf16 v[192:195], a[0:3], a[224:227], v[192:195]
    ds_read_b64_tr_b16 a[32:33], v42 offset:24576
    ds_read_b64_tr_b16 a[34:35], v42 offset:25600
    v_mfma_f32_16x16x32_bf16 v[196:199], a[0:3], a[228:231], v[196:199]
    buffer_load_dwordx4 a[144:147], v36, s[8:11], s62 offen offset:0 sc1
    v_mfma_f32_16x16x32_bf16 a[64:67], a[0:3], a[232:235], a[64:67]
    ds_read_b64_tr_b16 a[36:37], v43 offset:24576
    v_mfma_f32_16x16x32_bf16 a[68:71], a[0:3], a[236:239], a[68:71]
    ds_read_b64_tr_b16 a[38:39], v43 offset:25600
    v_mfma_f32_16x16x32_bf16 v[200:203], a[4:7], a[224:227], v[200:203]
    ds_read_b64_tr_b16 a[40:41], v44 offset:24576
    v_mfma_f32_16x16x32_bf16 v[204:207], a[4:7], a[228:231], v[204:207]
    v_mfma_f32_16x16x32_bf16 a[72:75], a[4:7], a[232:235], a[72:75]
    ds_read_b64_tr_b16 a[42:43], v44 offset:25600
    v_mfma_f32_16x16x32_bf16 a[76:79], a[4:7], a[236:239], a[76:79]
    ds_read_b64_tr_b16 a[44:45], v45 offset:24576
    v_mfma_f32_16x16x32_bf16 v[208:211], a[8:11], a[224:227], v[208:211]
    buffer_load_dwordx4 a[148:151], v36, s[8:11], s62 offen offset:1024 sc1
    v_mfma_f32_16x16x32_bf16 v[212:215], a[8:11], a[228:231], v[212:215]
    ds_read_b64_tr_b16 a[46:47], v45 offset:25600
    v_mfma_f32_16x16x32_bf16 a[80:83], a[8:11], a[232:235], a[80:83]
    ds_read_b64_tr_b16 a[48:49], v46 offset:24576
    v_mfma_f32_16x16x32_bf16 a[84:87], a[8:11], a[236:239], a[84:87]
    ds_read_b64_tr_b16 a[50:51], v46 offset:25600
    v_mfma_f32_16x16x32_bf16 v[216:219], a[12:15], a[224:227], v[216:219]
    v_mfma_f32_16x16x32_bf16 v[220:223], a[12:15], a[228:231], v[220:223]
    ds_read_b64_tr_b16 a[52:53], v47 offset:24576
    v_mfma_f32_16x16x32_bf16 a[88:91], a[12:15], a[232:235], a[88:91]
    buffer_load_dwordx4 a[152:155], v37, s[8:11], s62 offen offset:0 sc1
    ds_read_b64_tr_b16 a[54:55], v47 offset:25600
    v_mfma_f32_16x16x32_bf16 a[92:95], a[12:15], a[236:239], a[92:95]
    ds_read_b64_tr_b16 a[56:57], v48 offset:24576
    v_mfma_f32_16x16x32_bf16 v[224:227], a[16:19], a[224:227], v[224:227]
    v_mfma_f32_16x16x32_bf16 v[228:231], a[16:19], a[228:231], v[228:231]
    ds_read_b64_tr_b16 a[58:59], v48 offset:25600
    v_mfma_f32_16x16x32_bf16 a[96:99], a[16:19], a[232:235], a[96:99]
    ds_read_b64_tr_b16 a[60:61], v49 offset:24576
    v_mfma_f32_16x16x32_bf16 a[100:103], a[16:19], a[236:239], a[100:103]
    v_mfma_f32_16x16x32_bf16 v[232:235], a[20:23], a[224:227], v[232:235]
    ds_read_b64_tr_b16 a[62:63], v49 offset:25600
    v_mfma_f32_16x16x32_bf16 v[236:239], a[20:23], a[228:231], v[236:239]
    buffer_load_dwordx4 a[156:159], v37, s[8:11], s62 offen offset:1024 sc1
    v_mfma_f32_16x16x32_bf16 a[104:107], a[20:23], a[232:235], a[104:107]
    v_mfma_f32_16x16x32_bf16 a[108:111], a[20:23], a[236:239], a[108:111]
    v_mfma_f32_16x16x32_bf16 v[240:243], a[24:27], a[224:227], v[240:243]
    v_mfma_f32_16x16x32_bf16 v[244:247], a[24:27], a[228:231], v[244:247]
    v_mfma_f32_16x16x32_bf16 a[112:115], a[24:27], a[232:235], a[112:115]
    v_mfma_f32_16x16x32_bf16 a[116:119], a[24:27], a[236:239], a[116:119]
    s_add_u32 s62, s62, 0x20000
    v_mfma_f32_16x16x32_bf16 v[248:251], a[28:31], a[224:227], v[248:251]
    v_mfma_f32_16x16x32_bf16 v[252:255], a[28:31], a[228:231], v[252:255]
    v_mfma_f32_16x16x32_bf16 a[120:123], a[28:31], a[232:235], a[120:123]
    v_mfma_f32_16x16x32_bf16 a[124:127], a[28:31], a[236:239], a[124:127]
    s_waitcnt vmcnt(8) lgkmcnt(0)
    s_barrier
    v_mfma_f32_16x16x32_bf16 v[192:195], a[32:35], a[240:243], v[192:195]
    ds_read_b64_tr_b16 a[0:1], v42 offset:32768
    ds_read_b64_tr_b16 a[2:3], v42 offset:33792
    v_mfma_f32_16x16x32_bf16 v[196:199], a[32:35], a[244:247], v[196:199]
    s_cmp_eq_u32 s30, 0
    s_cbranch_scc1 k12_ool_42
k12_oolret_43:
    v_mfma_f32_16x16x32_bf16 a[64:67], a[32:35], a[248:251], a[64:67]
    s_add_u32 m0, s60, 147456
    ds_read_b64_tr_b16 a[4:5], v43 offset:32768
    v_mfma_f32_16x16x32_bf16 a[68:71], a[32:35], a[252:255], a[68:71]
    buffer_load_dwordx4 v38, s[12:15], s61 offen offset:0 lds
    ds_read_b64_tr_b16 a[6:7], v43 offset:33792
    v_mfma_f32_16x16x32_bf16 v[200:203], a[36:39], a[240:243], v[200:203]
    buffer_load_dwordx4 v39, s[12:15], s61 offen offset:1024 lds
    ds_read_b64_tr_b16 a[8:9], v44 offset:32768
    v_mfma_f32_16x16x32_bf16 v[204:207], a[36:39], a[244:247], v[204:207]
    v_mfma_f32_16x16x32_bf16 a[72:75], a[36:39], a[248:251], a[72:75]
    ds_read_b64_tr_b16 a[10:11], v44 offset:33792
    v_mfma_f32_16x16x32_bf16 a[76:79], a[36:39], a[252:255], a[76:79]
    ds_read_b64_tr_b16 a[12:13], v45 offset:32768
    v_mfma_f32_16x16x32_bf16 v[208:211], a[40:43], a[240:243], v[208:211]
    buffer_load_dwordx4 v40, s[12:15], s61 offen offset:2048 lds
    v_mfma_f32_16x16x32_bf16 v[212:215], a[40:43], a[244:247], v[212:215]
    ds_read_b64_tr_b16 a[14:15], v45 offset:33792
    v_mfma_f32_16x16x32_bf16 a[80:83], a[40:43], a[248:251], a[80:83]
    ds_read_b64_tr_b16 a[16:17], v46 offset:32768
    v_mfma_f32_16x16x32_bf16 a[84:87], a[40:43], a[252:255], a[84:87]
    buffer_load_dwordx4 v41, s[12:15], s61 offen offset:3072 lds
    ds_read_b64_tr_b16 a[18:19], v46 offset:33792
    v_mfma_f32_16x16x32_bf16 v[216:219], a[44:47], a[240:243], v[216:219]
    v_mfma_f32_16x16x32_bf16 v[220:223], a[44:47], a[244:247], v[220:223]
    s_add_u32 s61, s61, 0x80000
    ds_read_b64_tr_b16 a[20:21], v47 offset:32768
    v_mfma_f32_16x16x32_bf16 a[88:91], a[44:47], a[248:251], a[88:91]
    buffer_load_dwordx4 a[160:163], v36, s[8:11], s62 offen offset:0 sc1
    ds_read_b64_tr_b16 a[22:23], v47 offset:33792
    v_mfma_f32_16x16x32_bf16 a[92:95], a[44:47], a[252:255], a[92:95]
    ds_read_b64_tr_b16 a[24:25], v48 offset:32768
    v_mfma_f32_16x16x32_bf16 v[224:227], a[48:51], a[240:243], v[224:227]
    v_mfma_f32_16x16x32_bf16 v[228:231], a[48:51], a[244:247], v[228:231]
    ds_read_b64_tr_b16 a[26:27], v48 offset:33792
    v_mfma_f32_16x16x32_bf16 a[96:99], a[48:51], a[248:251], a[96:99]
    buffer_load_dwordx4 a[164:167], v36, s[8:11], s62 offen offset:1024 sc1
    ds_read_b64_tr_b16 a[28:29], v49 offset:32768
    v_mfma_f32_16x16x32_bf16 a[100:103], a[48:51], a[252:255], a[100:103]
    v_mfma_f32_16x16x32_bf16 v[232:235], a[52:55], a[240:243], v[232:235]
    ds_read_b64_tr_b16 a[30:31], v49 offset:33792
    v_mfma_f32_16x16x32_bf16 v[236:239], a[52:55], a[244:247], v[236:239]
    buffer_load_dwordx4 a[168:171], v37, s[8:11], s62 offen offset:0 sc1
    v_mfma_f32_16x16x32_bf16 a[104:107], a[52:55], a[248:251], a[104:107]
    v_mfma_f32_16x16x32_bf16 a[108:111], a[52:55], a[252:255], a[108:111]
    v_mfma_f32_16x16x32_bf16 v[240:243], a[56:59], a[240:243], v[240:243]
    v_mfma_f32_16x16x32_bf16 v[244:247], a[56:59], a[244:247], v[244:247]
    buffer_load_dwordx4 a[172:175], v37, s[8:11], s62 offen offset:1024 sc1
    v_mfma_f32_16x16x32_bf16 a[112:115], a[56:59], a[248:251], a[112:115]
    v_mfma_f32_16x16x32_bf16 a[116:119], a[56:59], a[252:255], a[116:119]
    s_add_u32 s62, s62, 0x20000
    v_mfma_f32_16x16x32_bf16 v[248:251], a[60:63], a[240:243], v[248:251]
    v_mfma_f32_16x16x32_bf16 v[252:255], a[60:63], a[244:247], v[252:255]
    v_mfma_f32_16x16x32_bf16 a[120:123], a[60:63], a[248:251], a[120:123]
    v_mfma_f32_16x16x32_bf16 a[124:127], a[60:63], a[252:255], a[124:127]
    s_waitcnt vmcnt(12) lgkmcnt(0)
    v_mfma_f32_16x16x32_bf16 v[192:195], a[0:3], a[128:131], v[192:195]
    ds_read_b64_tr_b16 a[32:33], v42 offset:40960
    ds_read_b64_tr_b16 a[34:35], v42 offset:41984
    v_mfma_f32_16x16x32_bf16 v[196:199], a[0:3], a[132:135], v[196:199]
    buffer_load_dwordx4 a[176:179], v36, s[8:11], s62 offen offset:0 sc1
    v_mfma_f32_16x16x32_bf16 a[64:67], a[0:3], a[136:139], a[64:67]
    ds_read_b64_tr_b16 a[36:37], v43 offset:40960
    v_mfma_f32_16x16x32_bf16 a[68:71], a[0:3], a[140:143], a[68:71]
    ds_read_b64_tr_b16 a[38:39], v43 offset:41984
    v_mfma_f32_16x16x32_bf16 v[200:203], a[4:7], a[128:131], v[200:203]
    ds_read_b64_tr_b16 a[40:41], v44 offset:40960
    v_mfma_f32_16x16x32_bf16 v[204:207], a[4:7], a[132:135], v[204:207]
    v_mfma_f32_16x16x32_bf16 a[72:75], a[4:7], a[136:139], a[72:75]
    ds_read_b64_tr_b16 a[42:43], v44 offset:41984
    v_mfma_f32_16x16x32_bf16 a[76:79], a[4:7], a[140:143], a[76:79]
    ds_read_b64_tr_b16 a[44:45], v45 offset:40960
    v_mfma_f32_16x16x32_bf16 v[208:211], a[8:11], a[128:131], v[208:211]
    buffer_load_dwordx4 a[180:183], v36, s[8:11], s62 offen offset:1024 sc1
    v_mfma_f32_16x16x32_bf16 v[212:215], a[8:11], a[132:135], v[212:215]
    ds_read_b64_tr_b16 a[46:47], v45 offset:41984
    v_mfma_f32_16x16x32_bf16 a[80:83], a[8:11], a[136:139], a[80:83]
    ds_read_b64_tr_b16 a[48:49], v46 offset:40960
    v_mfma_f32_16x16x32_bf16 a[84:87], a[8:11], a[140:143], a[84:87]
    ds_read_b64_tr_b16 a[50:51], v46 offset:41984
    v_mfma_f32_16x16x32_bf16 v[216:219], a[12:15], a[128:131], v[216:219]
    v_mfma_f32_16x16x32_bf16 v[220:223], a[12:15], a[132:135], v[220:223]
    ds_read_b64_tr_b16 a[52:53], v47 offset:40960
    v_mfma_f32_16x16x32_bf16 a[88:91], a[12:15], a[136:139], a[88:91]
    buffer_load_dwordx4 a[184:187], v37, s[8:11], s62 offen offset:0 sc1
    ds_read_b64_tr_b16 a[54:55], v47 offset:41984
    v_mfma_f32_16x16x32_bf16 a[92:95], a[12:15], a[140:143], a[92:95]
    ds_read_b64_tr_b16 a[56:57], v48 offset:40960
    v_mfma_f32_16x16x32_bf16 v[224:227], a[16:19], a[128:131], v[224:227]
    v_mfma_f32_16x16x32_bf16 v[228:231], a[16:19], a[132:135], v[228:231]
    ds_read_b64_tr_b16 a[58:59], v48 offset:41984
    v_mfma_f32_16x16x32_bf16 a[96:99], a[16:19], a[136:139], a[96:99]
    ds_read_b64_tr_b16 a[60:61], v49 offset:40960
    v_mfma_f32_16x16x32_bf16 a[100:103], a[16:19], a[140:143], a[100:103]
    v_mfma_f32_16x16x32_bf16 v[232:235], a[20:23], a[128:131], v[232:235]
    ds_read_b64_tr_b16 a[62:63], v49 offset:41984
    v_mfma_f32_16x16x32_bf16 v[236:239], a[20:23], a[132:135], v[236:239]
    buffer_load_dwordx4 a[188:191], v37, s[8:11], s62 offen offset:1024 sc1
    v_mfma_f32_16x16x32_bf16 a[104:107], a[20:23], a[136:139], a[104:107]
    v_mfma_f32_16x16x32_bf16 a[108:111], a[20:23], a[140:143], a[108:111]
    v_mfma_f32_16x16x32_bf16 v[240:243], a[24:27], a[128:131], v[240:243]
    v_mfma_f32_16x16x32_bf16 v[244:247], a[24:27], a[132:135], v[244:247]
    v_mfma_f32_16x16x32_bf16 a[112:115], a[24:27], a[136:139], a[112:115]
    v_mfma_f32_16x16x32_bf16 a[116:119], a[24:27], a[140:143], a[116:119]
    s_add_u32 s62, s62, 0x20000
    v_mfma_f32_16x16x32_bf16 v[248:251], a[28:31], a[128:131], v[248:251]
    s_cmp_eq_u32 s30, 0
    s_cbranch_scc1 k12_ool_46
k12_oolret_47:
    v_mfma_f32_16x16x32_bf16 v[252:255], a[28:31], a[132:135], v[252:255]
    v_mfma_f32_16x16x32_bf16 a[120:123], a[28:31], a[136:139], a[120:123]
    v_mfma_f32_16x16x32_bf16 a[124:127], a[28:31], a[140:143], a[124:127]
    s_waitcnt vmcnt(8) lgkmcnt(0)
    s_barrier
    v_mfma_f32_16x16x32_bf16 v[192:195], a[32:35], a[144:147], v[192:195]
    ds_read_b64_tr_b16 a[0:1], v42 offset:49152
    ds_read_b64_tr_b16 a[2:3], v42 offset:50176
    v_mfma_f32_16x16x32_bf16 v[196:199], a[32:35], a[148:151], v[196:199]
    s_mov_b32 m0, s34
    v_mfma_f32_16x16x32_bf16 a[64:67], a[32:35], a[152:155], a[64:67]
    buffer_load_dwordx4 v1, s[16:19], s32 offen offset:0 sc1 lds
    ds_read_b64_tr_b16 a[4:5], v43 offset:49152
    v_mfma_f32_16x16x32_bf16 a[68:71], a[32:35], a[156:159], a[68:71]
    ds_read_b64_tr_b16 a[6:7], v43 offset:50176
    v_mfma_f32_16x16x32_bf16 v[200:203], a[36:39], a[144:147], v[200:203]
    buffer_load_dwordx4 v1, s[16:19], s32 offen offset:1024 sc1 lds
    ds_read_b64_tr_b16 a[8:9], v44 offset:49152
    v_mfma_f32_16x16x32_bf16 v[204:207], a[36:39], a[148:151], v[204:207]
    v_mfma_f32_16x16x32_bf16 a[72:75], a[36:39], a[152:155], a[72:75]
    ds_read_b64_tr_b16 a[10:11], v44 offset:50176
    v_mfma_f32_16x16x32_bf16 a[76:79], a[36:39], a[156:159], a[76:79]
    ds_read_b64_tr_b16 a[12:13], v45 offset:49152
    v_mfma_f32_16x16x32_bf16 v[208:211], a[40:43], a[144:147], v[208:211]
    buffer_load_dwordx4 v1, s[16:19], s32 offen offset:2048 sc1 lds
    v_mfma_f32_16x16x32_bf16 v[212:215], a[40:43], a[148:151], v[212:215]
    ds_read_b64_tr_b16 a[14:15], v45 offset:50176
    v_mfma_f32_16x16x32_bf16 a[80:83], a[40:43], a[152:155], a[80:83]
    ds_read_b64_tr_b16 a[16:17], v46 offset:49152
    v_mfma_f32_16x16x32_bf16 a[84:87], a[40:43], a[156:159], a[84:87]
    buffer_load_dwordx4 v1, s[16:19], s32 offen offset:3072 sc1 lds
    ds_read_b64_tr_b16 a[18:19], v46 offset:50176
    v_mfma_f32_16x16x32_bf16 v[216:219], a[44:47], a[144:147], v[216:219]
    v_mfma_f32_16x16x32_bf16 v[220:223], a[44:47], a[148:151], v[220:223]
    s_add_u32 s32, s32, 0x80000
    ds_read_b64_tr_b16 a[20:21], v47 offset:49152
    v_mfma_f32_16x16x32_bf16 a[88:91], a[44:47], a[152:155], a[88:91]
    s_add_u32 s34, s34, 0x4000
    ds_read_b64_tr_b16 a[22:23], v47 offset:50176
    v_mfma_f32_16x16x32_bf16 a[92:95], a[44:47], a[156:159], a[92:95]
    s_mov_b32 m0, s34
    ds_read_b64_tr_b16 a[24:25], v48 offset:49152
    v_mfma_f32_16x16x32_bf16 v[224:227], a[48:51], a[144:147], v[224:227]
    buffer_load_dwordx4 v1, s[16:19], s32 offen offset:0 sc1 lds
    v_mfma_f32_16x16x32_bf16 v[228:231], a[48:51], a[148:151], v[228:231]
    ds_read_b64_tr_b16 a[26:27], v48 offset:50176
    v_mfma_f32_16x16x32_bf16 a[96:99], a[48:51], a[152:155], a[96:99]
    buffer_load_dwordx4 v1, s[16:19], s32 offen offset:1024 sc1 lds
    ds_read_b64_tr_b16 a[28:29], v49 offset:49152
    v_mfma_f32_16x16x32_bf16 a[100:103], a[48:51], a[156:159], a[100:103]
    v_mfma_f32_16x16x32_bf16 v[232:235], a[52:55], a[144:147], v[232:235]
    ds_read_b64_tr_b16 a[30:31], v49 offset:50176
    v_mfma_f32_16x16x32_bf16 v[236:239], a[52:55], a[148:151], v[236:239]
    buffer_load_dwordx4 v1, s[16:19], s32 offen offset:2048 sc1 lds
    v_mfma_f32_16x16x32_bf16 a[104:107], a[52:55], a[152:155], a[104:107]
    v_mfma_f32_16x16x32_bf16 a[108:111], a[52:55], a[156:159], a[108:111]
    v_mfma_f32_16x16x32_bf16 v[240:243], a[56:59], a[144:147], v[240:243]
    v_mfma_f32_16x16x32_bf16 v[244:247], a[56:59], a[148:151], v[244:247]
    buffer_load_dwordx4 v1, s[16:19], s32 offen offset:3072 sc1 lds
    v_mfma_f32_16x16x32_bf16 a[112:115], a[56:59], a[152:155], a[112:115]
    v_mfma_f32_16x16x32_bf16 a[116:119], a[56:59], a[156:159], a[116:119]
    s_add_u32 s32, s32, 0x80000
    v_mfma_f32_16x16x32_bf16 v[248:251], a[60:63], a[144:147], v[248:251]
    s_add_u32 s34, s34, 0x4000
    v_mfma_f32_16x16x32_bf16 v[252:255], a[60:63], a[148:151], v[252:255]
    v_mfma_f32_16x16x32_bf16 a[120:123], a[60:63], a[152:155], a[120:123]
    v_mfma_f32_16x16x32_bf16 a[124:127], a[60:63], a[156:159], a[124:127]
    s_waitcnt vmcnt(12) lgkmcnt(0)
    v_mfma_f32_16x16x32_bf16 v[192:195], a[0:3], a[160:163], v[192:195]
    ds_read_b64_tr_b16 a[32:33], v42 offset:57344
    ds_read_b64_tr_b16 a[34:35], v42 offset:58368
    v_mfma_f32_16x16x32_bf16 v[196:199], a[0:3], a[164:167], v[196:199]
    s_mov_b32 m0, s35
    v_mfma_f32_16x16x32_bf16 a[64:67], a[0:3], a[168:171], a[64:67]
    buffer_load_dwordx4 v1, s[20:23], s33 offen offset:0 sc1 lds
    ds_read_b64_tr_b16 a[36:37], v43 offset:57344
    v_mfma_f32_16x16x32_bf16 a[68:71], a[0:3], a[172:175], a[68:71]
    ds_read_b64_tr_b16 a[38:39], v43 offset:58368
    v_mfma_f32_16x16x32_bf16 v[200:203], a[4:7], a[160:163], v[200:203]
    buffer_load_dwordx4 v1, s[20:23], s33 offen offset:1024 sc1 lds
    ds_read_b64_tr_b16 a[40:41], v44 offset:57344
    v_mfma_f32_16x16x32_bf16 v[204:207], a[4:7], a[164:167], v[204:207]
    v_mfma_f32_16x16x32_bf16 a[72:75], a[4:7], a[168:171], a[72:75]
    ds_read_b64_tr_b16 a[42:43], v44 offset:58368
    v_mfma_f32_16x16x32_bf16 a[76:79], a[4:7], a[172:175], a[76:79]
    ds_read_b64_tr_b16 a[44:45], v45 offset:57344
    v_mfma_f32_16x16x32_bf16 v[208:211], a[8:11], a[160:163], v[208:211]
    buffer_load_dwordx4 v1, s[20:23], s33 offen offset:2048 sc1 lds
    v_mfma_f32_16x16x32_bf16 v[212:215], a[8:11], a[164:167], v[212:215]
    ds_read_b64_tr_b16 a[46:47], v45 offset:58368
    v_mfma_f32_16x16x32_bf16 a[80:83], a[8:11], a[168:171], a[80:83]
    ds_read_b64_tr_b16 a[48:49], v46 offset:57344
    v_mfma_f32_16x16x32_bf16 a[84:87], a[8:11], a[172:175], a[84:87]
    buffer_load_dwordx4 v1, s[20:23], s33 offen offset:3072 sc1 lds
    ds_read_b64_tr_b16 a[50:51], v46 offset:58368
    v_mfma_f32_16x16x32_bf16 v[216:219], a[12:15], a[160:163], v[216:219]
    v_mfma_f32_16x16x32_bf16 v[220:223], a[12:15], a[164:167], v[220:223]
    s_add_u32 s33, s33, 0x80000
    ds_read_b64_tr_b16 a[52:53], v47 offset:57344
    v_mfma_f32_16x16x32_bf16 a[88:91], a[12:15], a[168:171], a[88:91]
    s_add_u32 s35, s35, 0x4000
    ds_read_b64_tr_b16 a[54:55], v47 offset:58368
    v_mfma_f32_16x16x32_bf16 a[92:95], a[12:15], a[172:175], a[92:95]
    s_mov_b32 m0, s34
    ds_read_b64_tr_b16 a[56:57], v48 offset:57344
    v_mfma_f32_16x16x32_bf16 v[224:227], a[16:19], a[160:163], v[224:227]
    buffer_load_dwordx4 v1, s[16:19], s32 offen offset:0 sc1 lds
    v_mfma_f32_16x16x32_bf16 v[228:231], a[16:19], a[164:167], v[228:231]
    ds_read_b64_tr_b16 a[58:59], v48 offset:58368
    v_mfma_f32_16x16x32_bf16 a[96:99], a[16:19], a[168:171], a[96:99]
    buffer_load_dwordx4 v1, s[16:19], s32 offen offset:1024 sc1 lds
    ds_read_b64_tr_b16 a[60:61], v49 offset:57344
    v_mfma_f32_16x16x32_bf16 a[100:103], a[16:19], a[172:175], a[100:103]
    v_mfma_f32_16x16x32_bf16 v[232:235], a[20:23], a[160:163], v[232:235]
    ds_read_b64_tr_b16 a[62:63], v49 offset:58368
    v_mfma_f32_16x16x32_bf16 v[236:239], a[20:23], a[164:167], v[236:239]
    buffer_load_dwordx4 v1, s[16:19], s32 offen offset:2048 sc1 lds
    v_mfma_f32_16x16x32_bf16 a[104:107], a[20:23], a[168:171], a[104:107]
    v_mfma_f32_16x16x32_bf16 a[108:111], a[20:23], a[172:175], a[108:111]
    v_mfma_f32_16x16x32_bf16 v[240:243], a[24:27], a[160:163], v[240:243]
    v_mfma_f32_16x16x32_bf16 v[244:247], a[24:27], a[164:167], v[244:247]
    buffer_load_dwordx4 v1, s[16:19], s32 offen offset:3072 sc1 lds
    v_mfma_f32_16x16x32_bf16 a[112:115], a[24:27], a[168:171], a[112:115]
    v_mfma_f32_16x16x32_bf16 a[116:119], a[24:27], a[172:175], a[116:119]
    s_add_u32 s32, s32, 0x80000
    v_mfma_f32_16x16x32_bf16 v[248:251], a[28:31], a[160:163], v[248:251]
    s_add_u32 s34, s34, 0x4000
    v_mfma_f32_16x16x32_bf16 v[252:255], a[28:31], a[164:167], v[252:255]
    v_mfma_f32_16x16x32_bf16 a[120:123], a[28:31], a[168:171], a[120:123]
    v_mfma_f32_16x16x32_bf16 a[124:127], a[28:31], a[172:175], a[124:127]
    s_waitcnt vmcnt(16) lgkmcnt(0)
    s_barrier
    v_mfma_f32_16x16x32_bf16 v[192:195], a[32:35], a[176:179], v[192:195]
    v_mfma_f32_16x16x32_bf16 v[196:199], a[32:35], a[180:183], v[196:199]
    s_mov_b32 m0, s35
    v_mfma_f32_16x16x32_bf16 a[64:67], a[32:35], a[184:187], a[64:67]
    buffer_load_dwordx4 v1, s[20:23], s33 offen offset:0 sc1 lds
    v_mfma_f32_16x16x32_bf16 a[68:71], a[32:35], a[188:191], a[68:71]
    v_mfma_f32_16x16x32_bf16 v[200:203], a[36:39], a[176:179], v[200:203]
    v_mfma_f32_16x16x32_bf16 v[204:207], a[36:39], a[180:183], v[204:207]
    v_mfma_f32_16x16x32_bf16 a[72:75], a[36:39], a[184:187], a[72:75]
    v_mfma_f32_16x16x32_bf16 a[76:79], a[36:39], a[188:191], a[76:79]
    v_mfma_f32_16x16x32_bf16 v[208:211], a[40:43], a[176:179], v[208:211]
    buffer_load_dwordx4 v1, s[20:23], s33 offen offset:1024 sc1 lds
    v_mfma_f32_16x16x32_bf16 v[212:215], a[40:43], a[180:183], v[212:215]
    v_mfma_f32_16x16x32_bf16 a[80:83], a[40:43], a[184:187], a[80:83]
    v_mfma_f32_16x16x32_bf16 a[84:87], a[40:43], a[188:191], a[84:87]
    v_mfma_f32_16x16x32_bf16 v[216:219], a[44:47], a[176:179], v[216:219]
    v_mfma_f32_16x16x32_bf16 v[220:223], a[44:47], a[180:183], v[220:223]
    v_mfma_f32_16x16x32_bf16 a[88:91], a[44:47], a[184:187], a[88:91]
    buffer_load_dwordx4 v1, s[20:23], s33 offen offset:2048 sc1 lds
    v_mfma_f32_16x16x32_bf16 a[92:95], a[44:47], a[188:191], a[92:95]
    v_mfma_f32_16x16x32_bf16 v[224:227], a[48:51], a[176:179], v[224:227]
    v_mfma_f32_16x16x32_bf16 v[228:231], a[48:51], a[180:183], v[228:231]
    v_mfma_f32_16x16x32_bf16 a[96:99], a[48:51], a[184:187], a[96:99]
    v_mfma_f32_16x16x32_bf16 a[100:103], a[48:51], a[188:191], a[100:103]
    v_mfma_f32_16x16x32_bf16 v[232:235], a[52:55], a[176:179], v[232:235]
    v_mfma_f32_16x16x32_bf16 v[236:239], a[52:55], a[180:183], v[236:239]
    buffer_load_dwordx4 v1, s[20:23], s33 offen offset:3072 sc1 lds
    v_mfma_f32_16x16x32_bf16 a[104:107], a[52:55], a[184:187], a[104:107]
    v_mfma_f32_16x16x32_bf16 a[108:111], a[52:55], a[188:191], a[108:111]
    v_mfma_f32_16x16x32_bf16 v[240:243], a[56:59], a[176:179], v[240:243]
    v_mfma_f32_16x16x32_bf16 v[244:247], a[56:59], a[180:183], v[244:247]
    v_mfma_f32_16x16x32_bf16 a[112:115], a[56:59], a[184:187], a[112:115]
    v_mfma_f32_16x16x32_bf16 a[116:119], a[56:59], a[188:191], a[116:119]
    s_add_u32 s33, s33, 0x80000
    v_mfma_f32_16x16x32_bf16 v[248:251], a[60:63], a[176:179], v[248:251]
    s_add_u32 s35, s35, 0x4000
    v_mfma_f32_16x16x32_bf16 v[252:255], a[60:63], a[180:183], v[252:255]
    v_mfma_f32_16x16x32_bf16 a[120:123], a[60:63], a[184:187], a[120:123]
    v_mfma_f32_16x16x32_bf16 a[124:127], a[60:63], a[188:191], a[124:127]
    s_add_u32 s24, s6, 0x3000000
    s_addc_u32 s25, s7, 0
    s_and_b32 s25, s25, 0xffff
    s_mov_b32 s26, 0x1000000
    s_mov_b32 s27, 0x00020000
    s_load_dwordx2 s[44:45], s[0:1], 40
    s_load_dwordx2 s[46:47], s[0:1], 64
    s_load_dwordx4 s[48:51], s[0:1], 72
    s_mov_b32 s40, 0x3e0293ee
    s_mov_b32 s41, 0x3e0293ee
    s_mov_b32 m0, s34
    s_nop 0
    buffer_load_dwordx4 v1, s[16:19], s32 offen offset:0 sc1 lds
    buffer_load_dwordx4 v1, s[16:19], s32 offen offset:1024 sc1 lds
    buffer_load_dwordx4 v1, s[16:19], s32 offen offset:2048 sc1 lds
    buffer_load_dwordx4 v1, s[16:19], s32 offen offset:3072 sc1 lds
    s_mov_b32 m0, s35
    s_nop 0
    buffer_load_dwordx4 v1, s[20:23], s33 offen offset:0 sc1 lds
    buffer_load_dwordx4 v1, s[20:23], s33 offen offset:1024 sc1 lds
    buffer_load_dwordx4 v1, s[20:23], s33 offen offset:2048 sc1 lds
    buffer_load_dwordx4 v1, s[20:23], s33 offen offset:3072 sc1 lds
    s_add_u32 s32, s32, 0x80000
    s_add_u32 s33, s33, 0x80000
    s_add_u32 s34, s34, 0x4000
    s_and_b32 s34, s34, 0xffff
    s_add_u32 s35, s35, 0x4000
    s_and_b32 s35, s35, 0xffff
    s_or_b32 s35, s35, 0x10000
    v_mov_b32 v2, v1
    v_or_b32 v3, 0x10000, v1
    v_mov_b32 v56, v3
    s_mov_b32 s52, 0x4000
    s_mov_b32 s53, 0
    s_mul_i32 s62, s28, 63
    s_mul_i32 s31, s29, s29
    s_add_u32 s62, s62, s31
    s_sub_u32 s62, s62, 1
    s_cmp_eq_u32 s30, 0
    s_cselect_b32 s14, 0x800000, 0x0
    s_max_u32 s14, s14, 0x700000
    s_sub_u32 s31, s30, 1
    s_lshl_b32 s4, s31, 23
    s_add_u32 s4, s4, 0x6000000
    s_add_u32 s8, s6, s4
    s_addc_u32 s9, s7, 0
    s_and_b32 s9, s9, 0xffff
    s_mov_b32 s10, 0
    s_mov_b32 s58, 0
    s_mov_b32 s54, 4096
    s_mov_b32 s55, 0x20000
    s_mov_b32 s56, 1024
    s_cmp_lt_u32 s31, 2
    s_cselect_b32 s54, 229376, s54
    s_cselect_b32 s55, 128, s55
    s_cselect_b32 s56, 57344, s56
    s_cselect_b32 s59, 0x700000, 0
    s_cmp_eq_u32 s29, 0
    s_cselect_b32 s14, 0, s14
    s_cselect_b32 s59, 0, s59
    s_cselect_b32 s62, 0, s62
    s_waitcnt vmcnt(16) lgkmcnt(0)
    s_barrier
    ds_read_b128 a[128:131], v2 offset:0
    ds_read_b128 a[132:135], v2 offset:1024
    ds_read_b128 a[136:139], v2 offset:2048
    ds_read_b128 a[140:143], v2 offset:3072
    ds_read_b128 a[144:147], v2 offset:4096
    ds_read_b128 a[148:151], v2 offset:5120
    ds_read_b128 a[152:155], v2 offset:6144
    ds_read_b128 a[156:159], v2 offset:7168
    ds_read_b128 a[160:163], v2 offset:8192
    ds_read_b128 a[164:167], v2 offset:9216
    ds_read_b128 a[168:171], v2 offset:10240
    ds_read_b128 a[172:175], v2 offset:11264
    ds_read_b128 a[176:179], v2 offset:12288
    ds_read_b128 a[180:183], v2 offset:13312
    ds_read_b128 a[184:187], v2 offset:14336
    ds_read_b128 a[188:191], v2 offset:15360
    s_cmp_eq_u32 s30, 1
    s_cselect_b64 s[12:13], s[46:47], s[44:45]
    s_cmp_eq_u32 s30, 2
    s_cselect_b64 s[12:13], s[48:49], s[12:13]
    s_cmp_eq_u32 s30, 3
    s_cselect_b64 s[12:13], s[50:51], s[12:13]
    s_and_b32 s13, s13, 0xffff
    v_accvgpr_read_b32 v128, a64
    v_accvgpr_read_b32 v129, a65
    v_accvgpr_read_b32 v130, a66
    v_accvgpr_read_b32 v131, a67
    v_pk_mul_f32 v[128:129], v[128:129], s[40:41]
    v_pk_mul_f32 v[130:131], v[130:131], s[40:41]
    v_cvt_pk_bf16_f32 v96, v128, v129
    v_cvt_pk_bf16_f32 v97, v130, v131
    v_accvgpr_read_b32 v132, a72
    v_accvgpr_read_b32 v133, a73
    v_accvgpr_read_b32 v134, a74
    v_accvgpr_read_b32 v135, a75
    v_pk_mul_f32 v[132:133], v[132:133], s[40:41]
    v_pk_mul_f32 v[134:135], v[134:135], s[40:41]
    v_cvt_pk_bf16_f32 v98, v132, v133
    v_cvt_pk_bf16_f32 v99, v134, v135
    v_accvgpr_read_b32 v136, a80
    v_accvgpr_read_b32 v137, a81
    v_accvgpr_read_b32 v138, a82
    v_accvgpr_read_b32 v139, a83
    v_pk_mul_f32 v[136:137], v[136:137], s[40:41]
    v_pk_mul_f32 v[138:139], v[138:139], s[40:41]
    v_cvt_pk_bf16_f32 v100, v136, v137
    v_cvt_pk_bf16_f32 v101, v138, v139
    v_accvgpr_read_b32 v140, a88
    v_accvgpr_read_b32 v141, a89
    v_accvgpr_read_b32 v142, a90
    v_accvgpr_read_b32 v143, a91
    v_pk_mul_f32 v[140:141], v[140:141], s[40:41]
    v_pk_mul_f32 v[142:143], v[142:143], s[40:41]
    v_cvt_pk_bf16_f32 v102, v140, v141
    v_cvt_pk_bf16_f32 v103, v142, v143
    v_accvgpr_read_b32 v128, a96
    v_accvgpr_read_b32 v129, a97
    v_accvgpr_read_b32 v130, a98
    v_accvgpr_read_b32 v131, a99
    v_pk_mul_f32 v[128:129], v[128:129], s[40:41]
    v_pk_mul_f32 v[130:131], v[130:131], s[40:41]
    v_cvt_pk_bf16_f32 v104, v128, v129
    v_cvt_pk_bf16_f32 v105, v130, v131
    v_accvgpr_read_b32 v132, a104
    v_accvgpr_read_b32 v133, a105
    v_accvgpr_read_b32 v134, a106
    v_accvgpr_read_b32 v135, a107
    v_pk_mul_f32 v[132:133], v[132:133], s[40:41]
    v_pk_mul_f32 v[134:135], v[134:135], s[40:41]
    v_cvt_pk_bf16_f32 v106, v132, v133
    v_cvt_pk_bf16_f32 v107, v134, v135
    v_accvgpr_read_b32 v136, a112
    v_accvgpr_read_b32 v137, a113
    v_accvgpr_read_b32 v138, a114
    v_accvgpr_read_b32 v139, a115
    v_pk_mul_f32 v[136:137], v[136:137], s[40:41]
    v_pk_mul_f32 v[138:139], v[138:139], s[40:41]
    v_cvt_pk_bf16_f32 v108, v136, v137
    v_cvt_pk_bf16_f32 v109, v138, v139
    v_accvgpr_read_b32 v140, a120
    v_accvgpr_read_b32 v141, a121
    v_accvgpr_read_b32 v142, a122
    v_accvgpr_read_b32 v143, a123
    v_pk_mul_f32 v[140:141], v[140:141], s[40:41]
    v_pk_mul_f32 v[142:143], v[142:143], s[40:41]
    v_cvt_pk_bf16_f32 v110, v140, v141
    v_cvt_pk_bf16_f32 v111, v142, v143
    v_accvgpr_read_b32 v128, a68
    v_accvgpr_read_b32 v129, a69
    v_accvgpr_read_b32 v130, a70
    v_accvgpr_read_b32 v131, a71
    v_pk_mul_f32 v[128:129], v[128:129], s[40:41]
    v_pk_mul_f32 v[130:131], v[130:131], s[40:41]
    v_cvt_pk_bf16_f32 v112, v128, v129
    v_cvt_pk_bf16_f32 v113, v130, v131
    v_accvgpr_read_b32 v132, a76
    v_accvgpr_read_b32 v133, a77
    v_accvgpr_read_b32 v134, a78
    v_accvgpr_read_b32 v135, a79
    v_pk_mul_f32 v[132:133], v[132:133], s[40:41]
    v_pk_mul_f32 v[134:135], v[134:135], s[40:41]
    v_cvt_pk_bf16_f32 v114, v132, v133
    v_cvt_pk_bf16_f32 v115, v134, v135
    v_accvgpr_read_b32 v136, a84
    v_accvgpr_read_b32 v137, a85
    v_accvgpr_read_b32 v138, a86
    v_accvgpr_read_b32 v139, a87
    v_pk_mul_f32 v[136:137], v[136:137], s[40:41]
    v_pk_mul_f32 v[138:139], v[138:139], s[40:41]
    v_cvt_pk_bf16_f32 v116, v136, v137
    v_cvt_pk_bf16_f32 v117, v138, v139
    v_accvgpr_read_b32 v140, a92
    v_accvgpr_read_b32 v141, a93
    v_accvgpr_read_b32 v142, a94
    v_accvgpr_read_b32 v143, a95
    v_pk_mul_f32 v[140:141], v[140:141], s[40:41]
    v_pk_mul_f32 v[142:143], v[142:143], s[40:41]
    v_cvt_pk_bf16_f32 v118, v140, v141
    v_cvt_pk_bf16_f32 v119, v142, v143
    v_accvgpr_read_b32 v128, a100
    v_accvgpr_read_b32 v129, a101
    v_accvgpr_read_b32 v130, a102
    v_accvgpr_read_b32 v131, a103
    v_pk_mul_f32 v[128:129], v[128:129], s[40:41]
    v_pk_mul_f32 v[130:131], v[130:131], s[40:41]
    v_cvt_pk_bf16_f32 v120, v128, v129
    v_cvt_pk_bf16_f32 v121, v130, v131
    v_accvgpr_read_b32 v132, a108
    v_accvgpr_read_b32 v133, a109
    v_accvgpr_read_b32 v134, a110
    v_accvgpr_read_b32 v135, a111
    v_pk_mul_f32 v[132:133], v[132:133], s[40:41]
    v_pk_mul_f32 v[134:135], v[134:135], s[40:41]
    v_cvt_pk_bf16_f32 v122, v132, v133
    v_cvt_pk_bf16_f32 v123, v134, v135
    v_accvgpr_read_b32 v136, a116
    v_accvgpr_read_b32 v137, a117
    v_accvgpr_read_b32 v138, a118
    v_accvgpr_read_b32 v139, a119
    v_pk_mul_f32 v[136:137], v[136:137], s[40:41]
    v_pk_mul_f32 v[138:139], v[138:139], s[40:41]
    v_cvt_pk_bf16_f32 v124, v136, v137
    v_cvt_pk_bf16_f32 v125, v138, v139
    v_accvgpr_read_b32 v140, a124
    v_accvgpr_read_b32 v141, a125
    v_accvgpr_read_b32 v142, a126
    v_accvgpr_read_b32 v143, a127
    v_pk_mul_f32 v[140:141], v[140:141], s[40:41]
    v_pk_mul_f32 v[142:143], v[142:143], s[40:41]
    v_cvt_pk_bf16_f32 v126, v140, v141
    v_cvt_pk_bf16_f32 v127, v142, v143
    v_pk_mul_f32 v[192:193], v[192:193], s[40:41]
    v_pk_mul_f32 v[194:195], v[194:195], s[40:41]
    v_cvt_pk_bf16_f32 v64, v192, v193
    v_cvt_pk_bf16_f32 v65, v194, v195
    v_pk_mul_f32 v[200:201], v[200:201], s[40:41]
    v_pk_mul_f32 v[202:203], v[202:203], s[40:41]
    v_cvt_pk_bf16_f32 v66, v200, v201
    v_cvt_pk_bf16_f32 v67, v202, v203
    v_pk_mul_f32 v[208:209], v[208:209], s[40:41]
    v_pk_mul_f32 v[210:211], v[210:211], s[40:41]
    v_cvt_pk_bf16_f32 v68, v208, v209
    v_cvt_pk_bf16_f32 v69, v210, v211
    v_pk_mul_f32 v[216:217], v[216:217], s[40:41]
    v_pk_mul_f32 v[218:219], v[218:219], s[40:41]
    v_cvt_pk_bf16_f32 v70, v216, v217
    v_cvt_pk_bf16_f32 v71, v218, v219
    v_pk_mul_f32 v[224:225], v[224:225], s[40:41]
    v_pk_mul_f32 v[226:227], v[226:227], s[40:41]
    v_cvt_pk_bf16_f32 v72, v224, v225
    v_cvt_pk_bf16_f32 v73, v226, v227
    v_pk_mul_f32 v[232:233], v[232:233], s[40:41]
    v_pk_mul_f32 v[234:235], v[234:235], s[40:41]
    v_cvt_pk_bf16_f32 v74, v232, v233
    v_cvt_pk_bf16_f32 v75, v234, v235
    v_pk_mul_f32 v[240:241], v[240:241], s[40:41]
    v_pk_mul_f32 v[242:243], v[242:243], s[40:41]
    v_cvt_pk_bf16_f32 v76, v240, v241
    v_cvt_pk_bf16_f32 v77, v242, v243
    v_pk_mul_f32 v[248:249], v[248:249], s[40:41]
    v_pk_mul_f32 v[250:251], v[250:251], s[40:41]
    v_cvt_pk_bf16_f32 v78, v248, v249
    v_cvt_pk_bf16_f32 v79, v250, v251
    v_pk_mul_f32 v[196:197], v[196:197], s[40:41]
    v_pk_mul_f32 v[198:199], v[198:199], s[40:41]
    v_cvt_pk_bf16_f32 v80, v196, v197
    v_cvt_pk_bf16_f32 v81, v198, v199
    v_pk_mul_f32 v[204:205], v[204:205], s[40:41]
    v_pk_mul_f32 v[206:207], v[206:207], s[40:41]
    v_cvt_pk_bf16_f32 v82, v204, v205
    v_cvt_pk_bf16_f32 v83, v206, v207
    v_pk_mul_f32 v[212:213], v[212:213], s[40:41]
    v_pk_mul_f32 v[214:215], v[214:215], s[40:41]
    v_cvt_pk_bf16_f32 v84, v212, v213
    v_cvt_pk_bf16_f32 v85, v214, v215
    v_pk_mul_f32 v[220:221], v[220:221], s[40:41]
    v_pk_mul_f32 v[222:223], v[222:223], s[40:41]
    v_cvt_pk_bf16_f32 v86, v220, v221
    v_cvt_pk_bf16_f32 v87, v222, v223
    v_pk_mul_f32 v[228:229], v[228:229], s[40:41]
    v_pk_mul_f32 v[230:231], v[230:231], s[40:41]
    v_cvt_pk_bf16_f32 v88, v228, v229
    v_cvt_pk_bf16_f32 v89, v230, v231
    v_pk_mul_f32 v[236:237], v[236:237], s[40:41]
    v_pk_mul_f32 v[238:239], v[238:239], s[40:41]
    v_cvt_pk_bf16_f32 v90, v236, v237
    v_cvt_pk_bf16_f32 v91, v238, v239
    v_pk_mul_f32 v[244:245], v[244:245], s[40:41]
    v_pk_mul_f32 v[246:247], v[246:247], s[40:41]
    v_cvt_pk_bf16_f32 v92, v244, v245
    v_cvt_pk_bf16_f32 v93, v246, v247
    v_pk_mul_f32 v[252:253], v[252:253], s[40:41]
    v_pk_mul_f32 v[254:255], v[254:255], s[40:41]
    v_cvt_pk_bf16_f32 v94, v252, v253
    v_cvt_pk_bf16_f32 v95, v254, v255
    v_add_u32 v2, 0x4000, v1
    v_mov_b32 v8, 0
    v_mov_b32 v232, 0
    v_mov_b32 v9, 0
    v_mov_b32 v233, 0
    v_mov_b32 v10, 0
    v_mov_b32 v234, 0
    v_mov_b32 v11, 0
    v_mov_b32 v235, 0
    s_mov_b32 s36, 0
    s_mov_b32 s37, 0x40004000
    v_mfma_f32_32x32x16_bf16 v[16:31], v[232:235], v[232:235], 0
    v_mfma_f32_32x32x16_bf16 v[32:47], v[232:235], v[232:235], 0
    v_and_b32 v6, 0xf0, v1
    v_cmp_eq_u32 vcc, 0, v6
    v_mov_b32 v6, 0x3f803f80
    v_lshrrev_b32 v229, 7, v1
    s_lshr_b32 s4, s56, 3
    v_mul_u32_u24 v228, s4, v229
    v_and_b32 v7, 0x70, v1
    v_add_u32 v228, v228, v7
    v_lshlrev_b32 v229, 5, v229
    v_and_b32 v57, 0x10, v1
    v_add_u32 v229, v229, v57
    v_lshrrev_b32 v7, 5, v7
    v_lshl_add_u32 v229, v7, 15, v229
    v_cndmask_b32 v60, 0, v6, vcc
    v_cndmask_b32 v61, 0, v6, vcc
    v_cndmask_b32 v62, 0, v6, vcc
    v_cndmask_b32 v63, 0, v6, vcc
    v_mov_b32 v12, 0
    v_mov_b32 v13, 0
    v_mov_b32 v14, 0
    v_mov_b32 v15, 0
    v_mov_b32 v48, 0
    v_mov_b32 v49, 0
    v_mov_b32 v50, 0
    v_mov_b32 v51, 0
    v_mov_b32 v248, 0
    v_mov_b32 v249, 0
    v_mov_b32 v250, 0
    v_mov_b32 v251, 0
    v_mov_b32 v252, 0
    v_mov_b32 v253, 0
    v_mov_b32 v254, 0
    v_mov_b32 v255, 0
    s_waitcnt lgkmcnt(0)
    s_cmp_ge_u32 s36, s42
    s_cbranch_scc1 k2_prep_48
k2_prepret_49:
    v_mfma_f32_16x16x32_bf16 v[128:131], a[128:131], v[64:67], v[16:19]
    v_mfma_f32_16x16x32_bf16 v[132:135], a[128:131], v[80:83], v[20:23]
    v_mfma_f32_16x16x32_bf16 v[136:139], a[128:131], v[96:99], v[24:27]
    v_mfma_f32_16x16x32_bf16 v[140:143], a[128:131], v[112:115], v[28:31]
    s_add_u32 s36, s36, 32
    v_mfma_f32_16x16x32_bf16 v[128:131], a[132:135], v[68:71], v[128:131]
    v_mfma_f32_16x16x32_bf16 v[132:135], a[132:135], v[84:87], v[132:135]
    v_mfma_f32_16x16x32_bf16 v[136:139], a[132:135], v[100:103], v[136:139]
    v_mfma_f32_16x16x32_bf16 v[140:143], a[132:135], v[116:119], v[140:143]
    v_mfma_f32_16x16x32_bf16 v[128:131], a[136:139], v[72:75], v[128:131]
    v_mfma_f32_16x16x32_bf16 v[132:135], a[136:139], v[88:91], v[132:135]
    v_mfma_f32_16x16x32_bf16 v[136:139], a[136:139], v[104:107], v[136:139]
    v_mfma_f32_16x16x32_bf16 v[140:143], a[136:139], v[120:123], v[140:143]
    v_mfma_f32_16x16x32_bf16 v[128:131], a[140:143], v[76:79], v[128:131]
    v_mfma_f32_16x16x32_bf16 v[132:135], a[140:143], v[92:95], v[132:135]
    v_mfma_f32_16x16x32_bf16 v[136:139], a[140:143], v[108:111], v[136:139]
    v_mfma_f32_16x16x32_bf16 v[140:143], a[140:143], v[124:127], v[140:143]
    v_mfma_f32_16x16x32_bf16 v[144:147], a[144:147], v[64:67], v[32:35]
    v_mfma_f32_16x16x32_bf16 v[148:151], a[144:147], v[80:83], v[36:39]
    v_mfma_f32_16x16x32_bf16 v[152:155], a[144:147], v[96:99], v[40:43]
    v_mfma_f32_16x16x32_bf16 v[156:159], a[144:147], v[112:115], v[44:47]
    v_mfma_f32_16x16x32_bf16 v[144:147], a[148:151], v[68:71], v[144:147]
    v_mfma_f32_16x16x32_bf16 v[148:151], a[148:151], v[84:87], v[148:151]
    v_mfma_f32_16x16x32_bf16 v[152:155], a[148:151], v[100:103], v[152:155]
    v_mfma_f32_16x16x32_bf16 v[156:159], a[148:151], v[116:119], v[156:159]
    v_mfma_f32_16x16x32_bf16 v[144:147], a[152:155], v[72:75], v[144:147]
    v_mfma_f32_16x16x32_bf16 v[148:151], a[152:155], v[88:91], v[148:151]
    v_mfma_f32_16x16x32_bf16 v[152:155], a[152:155], v[104:107], v[152:155]
    v_mfma_f32_16x16x32_bf16 v[156:159], a[152:155], v[120:123], v[156:159]
    v_mfma_f32_16x16x32_bf16 v[144:147], a[156:159], v[76:79], v[144:147]
    v_mfma_f32_16x16x32_bf16 v[148:151], a[156:159], v[92:95], v[148:151]
    v_mfma_f32_16x16x32_bf16 v[152:155], a[156:159], v[108:111], v[152:155]
    v_mfma_f32_16x16x32_bf16 v[156:159], a[156:159], v[124:127], v[156:159]
    v_mfma_f32_32x32x16_bf16 a[0:15], v[232:235], v[232:235], 0
    v_mfma_f32_32x32x16_bf16 a[16:31], v[232:235], v[232:235], 0
    v_mfma_f32_32x32x16_bf16 a[32:47], v[232:235], v[232:235], 0
    v_mfma_f32_32x32x16_bf16 a[48:63], v[232:235], v[232:235], 0
    v_mfma_f32_32x32x16_bf16 a[64:79], v[232:235], v[232:235], 0
    v_mfma_f32_32x32x16_bf16 a[80:95], v[232:235], v[232:235], 0
    v_mfma_f32_32x32x16_bf16 a[96:111], v[232:235], v[232:235], 0
    v_mfma_f32_32x32x16_bf16 a[112:127], v[232:235], v[232:235], 0
    v_max_f32 v52, v128, v129
    v_max3_f32 v52, v52, v130, v131
    v_max3_f32 v52, v52, v144, v145
    v_max3_f32 v52, v52, v146, v147
    v_max_f32 v53, v132, v133
    v_max3_f32 v53, v53, v134, v135
    v_max3_f32 v53, v53, v148, v149
    v_max3_f32 v53, v53, v150, v151
    v_max_f32 v54, v136, v137
    v_max3_f32 v54, v54, v138, v139
    v_max3_f32 v54, v54, v152, v153
    v_max3_f32 v54, v54, v154, v155
    v_max_f32 v55, v140, v141
    v_max3_f32 v55, v55, v142, v143
    v_max3_f32 v55, v55, v156, v157
    v_max3_f32 v55, v55, v158, v159
    v_mov_b32 v224, v52
    v_mov_b32 v225, v53
    v_mov_b32 v226, v54
    v_mov_b32 v227, v55
    s_nop 1
    v_permlane16_swap_b32 v52, v224
    v_permlane16_swap_b32 v53, v225
    v_permlane16_swap_b32 v54, v226
    v_permlane16_swap_b32 v55, v227
    s_nop 1
    v_max_f32 v52, v52, v224
    v_max_f32 v53, v53, v225
    v_max_f32 v54, v54, v226
    v_max_f32 v55, v55, v227
    v_mov_b32 v224, v52
    v_mov_b32 v225, v53
    v_mov_b32 v226, v54
    v_mov_b32 v227, v55
    s_nop 1
    v_permlane32_swap_b32 v52, v224
    v_permlane32_swap_b32 v53, v225
    v_permlane32_swap_b32 v54, v226
    v_permlane32_swap_b32 v55, v227
    s_nop 1
    v_max_f32 v52, v52, v224
    v_max_f32 v53, v53, v225
    v_max_f32 v54, v54, v226
    v_max_f32 v55, v55, v227
    v_add_f32 v52, 0x41400000, v52
    v_add_f32 v53, 0x41400000, v53
    v_add_f32 v54, 0x41400000, v54
    v_add_f32 v55, 0x41400000, v55
    v_sub_f32 v16, 0, v52
    v_sub_f32 v17, 0, v52
    v_sub_f32 v18, 0, v52
    v_sub_f32 v19, 0, v52
    v_sub_f32 v20, 0, v53
    v_sub_f32 v21, 0, v53
    v_sub_f32 v22, 0, v53
    v_sub_f32 v23, 0, v53
    v_sub_f32 v24, 0, v54
    v_sub_f32 v25, 0, v54
    v_sub_f32 v26, 0, v54
    v_sub_f32 v27, 0, v54
    v_sub_f32 v28, 0, v55
    v_sub_f32 v29, 0, v55
    v_sub_f32 v30, 0, v55
    v_sub_f32 v31, 0, v55
    v_sub_f32 v32, 0, v52
    v_sub_f32 v33, 0, v52
    v_sub_f32 v34, 0, v52
    v_sub_f32 v35, 0, v52
    v_sub_f32 v36, 0, v53
    v_sub_f32 v37, 0, v53
    v_sub_f32 v38, 0, v53
    v_sub_f32 v39, 0, v53
    v_sub_f32 v40, 0, v54
    v_sub_f32 v41, 0, v54
    v_sub_f32 v42, 0, v54
    v_sub_f32 v43, 0, v54
    v_sub_f32 v44, 0, v55
    v_sub_f32 v45, 0, v55
    v_sub_f32 v46, 0, v55
    v_sub_f32 v47, 0, v55
    v_sub_f32 v8, 0, v52
    v_sub_f32 v9, 0, v53
    v_sub_f32 v10, 0, v54
    v_sub_f32 v11, 0, v55
    s_cmp_ge_u32 s36, s42
    s_cbranch_scc1 k2_prep_50
k2_prepret_51:
    v_mfma_f32_16x16x32_bf16 v[160:163], a[160:163], v[64:67], v[16:19]
    v_sub_f32 v128, v128, v52
    v_sub_f32 v129, v129, v52
    v_sub_f32 v130, v130, v52
    v_mfma_f32_16x16x32_bf16 v[164:167], a[160:163], v[80:83], v[20:23]
    v_exp_f32 v232, v128
    v_sub_f32 v131, v131, v52
    v_mfma_f32_16x16x32_bf16 v[168:171], a[160:163], v[96:99], v[24:27]
    v_exp_f32 v233, v129
    v_sub_f32 v144, v144, v52
    v_mfma_f32_16x16x32_bf16 v[172:175], a[160:163], v[112:115], v[28:31]
    s_add_u32 s36, s36, 32
    v_exp_f32 v234, v130
    v_sub_f32 v145, v145, v52
    v_mfma_f32_16x16x32_bf16 v[160:163], a[164:167], v[68:71], v[160:163]
    v_cvt_pk_bf16_f32 v192, v232, v233
    v_exp_f32 v235, v131
    v_mfma_f32_16x16x32_bf16 v[164:167], a[164:167], v[84:87], v[164:167]
    v_exp_f32 v236, v144
    v_sub_f32 v146, v146, v52
    v_mfma_f32_16x16x32_bf16 v[168:171], a[164:167], v[100:103], v[168:171]
    v_sub_f32 v147, v147, v52
    v_cvt_pk_bf16_f32 v193, v234, v235
    v_sub_f32 v132, v132, v53
    v_mfma_f32_16x16x32_bf16 v[172:175], a[164:167], v[116:119], v[172:175]
    v_exp_f32 v237, v145
    v_sub_f32 v133, v133, v53
    v_mfma_f32_16x16x32_bf16 v[160:163], a[168:171], v[72:75], v[160:163]
    v_exp_f32 v238, v146
    v_cvt_pk_bf16_f32 v194, v236, v237
    v_mfma_f32_16x16x32_bf16 v[164:167], a[168:171], v[88:91], v[164:167]
    v_exp_f32 v239, v147
    v_or3_b32 v57, v192, v193, v194
    v_mfma_f32_16x16x32_bf16 v[168:171], a[168:171], v[104:107], v[168:171]
    v_exp_f32 v240, v132
    v_sub_f32 v134, v134, v53
    v_mfma_f32_16x16x32_bf16 v[172:175], a[168:171], v[120:123], v[172:175]
    v_sub_f32 v135, v135, v53
    v_cvt_pk_bf16_f32 v195, v238, v239
    v_sub_f32 v148, v148, v53
    v_mfma_f32_16x16x32_bf16 v[160:163], a[172:175], v[76:79], v[160:163]
    v_exp_f32 v241, v133
    v_sub_f32 v149, v149, v53
    v_mfma_f32_16x16x32_bf16 v[164:167], a[172:175], v[92:95], v[164:167]
    v_exp_f32 v242, v134
    v_cvt_pk_bf16_f32 v196, v240, v241
    v_mfma_f32_16x16x32_bf16 v[168:171], a[172:175], v[108:111], v[168:171]
    v_exp_f32 v243, v135
    v_or3_b32 v57, v57, v195, v196
    v_mfma_f32_16x16x32_bf16 v[172:175], a[172:175], v[124:127], v[172:175]
    v_exp_f32 v244, v148
    v_sub_f32 v150, v150, v53
    v_mfma_f32_16x16x32_bf16 v[176:179], a[176:179], v[64:67], v[32:35]
    v_sub_f32 v151, v151, v53
    v_cvt_pk_bf16_f32 v197, v242, v243
    v_exp_f32 v245, v149
    v_mfma_f32_16x16x32_bf16 v[180:183], a[176:179], v[80:83], v[36:39]
    v_exp_f32 v246, v150
    v_sub_f32 v136, v136, v54
    v_mfma_f32_16x16x32_bf16 v[184:187], a[176:179], v[96:99], v[40:43]
    v_sub_f32 v137, v137, v54
    v_cvt_pk_bf16_f32 v198, v244, v245
    v_exp_f32 v247, v151
    v_mfma_f32_16x16x32_bf16 v[188:191], a[176:179], v[112:115], v[44:47]
    v_or3_b32 v57, v57, v197, v198
    v_exp_f32 v232, v136
    v_mfma_f32_16x16x32_bf16 v[176:179], a[180:183], v[68:71], v[176:179]
    v_sub_f32 v138, v138, v54
    v_sub_f32 v139, v139, v54
    v_cvt_pk_bf16_f32 v199, v246, v247
    v_mfma_f32_16x16x32_bf16 v[180:183], a[180:183], v[84:87], v[180:183]
    ds_read_b128 a[192:195], v3 offset:0
    v_exp_f32 v233, v137
    v_mfma_f32_16x16x32_bf16 v[184:187], a[180:183], v[100:103], v[184:187]
    v_exp_f32 v234, v138
    v_sub_f32 v152, v152, v54
    v_mfma_f32_16x16x32_bf16 v[188:191], a[180:183], v[116:119], v[188:191]
    v_sub_f32 v153, v153, v54
    v_cvt_pk_bf16_f32 v200, v232, v233
    v_exp_f32 v235, v139
    v_mfma_f32_16x16x32_bf16 v[176:179], a[184:187], v[72:75], v[176:179]
    v_or3_b32 v57, v57, v199, v200
    v_exp_f32 v236, v152
    v_mfma_f32_16x16x32_bf16 v[180:183], a[184:187], v[88:91], v[180:183]
    v_sub_f32 v154, v154, v54
    v_sub_f32 v155, v155, v54
    v_cvt_pk_bf16_f32 v201, v234, v235
    v_mfma_f32_16x16x32_bf16 v[184:187], a[184:187], v[104:107], v[184:187]
    ds_read_b128 a[196:199], v3 offset:1024
    v_exp_f32 v237, v153
    v_mfma_f32_16x16x32_bf16 v[188:191], a[184:187], v[120:123], v[188:191]
    v_exp_f32 v238, v154
    v_sub_f32 v140, v140, v55
    v_mfma_f32_16x16x32_bf16 v[176:179], a[188:191], v[76:79], v[176:179]
    v_sub_f32 v141, v141, v55
    v_cvt_pk_bf16_f32 v202, v236, v237
    v_exp_f32 v239, v155
    v_mfma_f32_16x16x32_bf16 v[180:183], a[188:191], v[92:95], v[180:183]
    v_or3_b32 v57, v57, v201, v202
    v_exp_f32 v240, v140
    v_mfma_f32_16x16x32_bf16 v[184:187], a[188:191], v[108:111], v[184:187]
    v_sub_f32 v142, v142, v55
    v_sub_f32 v143, v143, v55
    v_cvt_pk_bf16_f32 v203, v238, v239
    v_mfma_f32_16x16x32_bf16 v[188:191], a[188:191], v[124:127], v[188:191]
    s_waitcnt vmcnt(8)
    s_barrier
    ds_read_b128 a[200:203], v3 offset:2048
    v_exp_f32 v241, v141
    v_exp_f32 v242, v142
    v_sub_f32 v156, v156, v55
    v_sub_f32 v157, v157, v55
    v_cvt_pk_bf16_f32 v204, v240, v241
    v_exp_f32 v243, v143
    v_or3_b32 v57, v57, v203, v204
    v_exp_f32 v244, v156
    v_sub_f32 v158, v158, v55
    v_sub_f32 v159, v159, v55
    v_cvt_pk_bf16_f32 v205, v242, v243
    v_exp_f32 v245, v157
    ds_read_b128 a[204:207], v3 offset:3072
    v_exp_f32 v246, v158
    v_cvt_pk_bf16_f32 v206, v244, v245
    v_exp_f32 v247, v159
    v_or3_b32 v57, v57, v205, v206
    v_cvt_pk_bf16_f32 v207, v246, v247
    v_bitop3_b32 v57, v57, v207, s37 bitop3:0xa8
    v_cmp_ne_u32 vcc, 0, v57
    s_cbranch_vccnz k2_rare_52
k2_ret_53:
    s_lshl_b32 s63, s29, 1
    s_add_u32 s63, s63, 1
k2_dloop_54:
    v_mfma_f32_16x16x32_bf16 v[12:15], v[60:63], v[192:195], v[12:15]
    ds_read_b128 a[208:211], v3 offset:4096
    v_mfma_f32_16x16x32_bf16 v[48:51], v[60:63], v[196:199], v[48:51]
    s_and_b32 s60, s62, 31
    v_exp_f32 v232, v160
    v_mfma_f32_16x16x32_bf16 v[248:251], v[60:63], v[200:203], v[248:251]
    s_add_u32 s53, s53, 8192
    buffer_store_dwordx4 a[224:227], v229, s[8:11], s58 offen offset:0 sc1
    v_mfma_f32_16x16x32_bf16 v[252:255], v[60:63], v[204:207], v[252:255]
    s_waitcnt lgkmcnt(3)
    v_exp_f32 v233, v161
    v_mfma_f32_16x16x32_bf16 a[0:3], a[192:195], v[192:195], a[0:3]
    s_lshr_b32 s61, s62, 5
    ds_read_b128 a[212:215], v3 offset:5120
    v_cvt_pk_bf16_f32 v208, v232, v233
    v_mfma_f32_16x16x32_bf16 a[4:7], a[192:195], v[196:199], a[4:7]
    s_and_b32 s53, s53, 0xffff
    v_exp_f32 v234, v162
    v_mfma_f32_16x16x32_bf16 a[8:11], a[192:195], v[200:203], a[8:11]
    s_mul_i32 s57, s60, s54
    v_exp_f32 v235, v163
    v_mfma_f32_16x16x32_bf16 a[12:15], a[192:195], v[204:207], a[12:15]
    buffer_store_dwordx4 a[228:231], v229, s[8:11], s58 offen offset:256 sc1
    ds_read_b128 a[216:219], v3 offset:6144
    v_mfma_f32_16x16x32_bf16 a[16:19], a[196:199], v[192:195], a[16:19]
    s_mul_i32 s4, s61, s55
    v_exp_f32 v236, v176
    v_mfma_f32_16x16x32_bf16 a[20:23], a[196:199], v[196:199], a[20:23]
    v_cvt_pk_bf16_f32 v209, v234, v235
    v_mfma_f32_16x16x32_bf16 a[24:27], a[196:199], v[200:203], a[24:27]
    s_add_u32 s57, s57, s4
    v_exp_f32 v237, v177
    v_mfma_f32_16x16x32_bf16 a[28:31], a[196:199], v[204:207], a[28:31]
    s_waitcnt lgkmcnt(3)
    buffer_store_dwordx4 a[232:235], v229, s[8:11], s58 offen offset:512 sc1
    ds_read_b128 a[220:223], v3 offset:7168
    v_mfma_f32_16x16x32_bf16 a[32:35], a[200:203], v[192:195], a[32:35]
    v_exp_f32 v238, v178
    v_mfma_f32_16x16x32_bf16 a[36:39], a[200:203], v[196:199], a[36:39]
    s_add_u32 s62, s62, 1
    v_cvt_pk_bf16_f32 v210, v236, v237
    v_or3_b32 v57, v208, v209, v210
    v_mfma_f32_16x16x32_bf16 a[40:43], a[200:203], v[200:203], a[40:43]
    v_exp_f32 v239, v179
    v_mfma_f32_16x16x32_bf16 a[44:47], a[200:203], v[204:207], a[44:47]
    v_exp_f32 v240, v164
    v_mfma_f32_16x16x32_bf16 a[48:51], a[204:207], v[192:195], a[48:51]
    buffer_store_dwordx4 a[236:239], v229, s[8:11], s58 offen offset:768 sc1
    v_mfma_f32_16x16x32_bf16 a[52:55], a[204:207], v[196:199], a[52:55]
    ds_read_b128 a[128:131], v2 offset:0
    v_cvt_pk_bf16_f32 v211, v238, v239
    v_mfma_f32_16x16x32_bf16 a[56:59], a[204:207], v[200:203], a[56:59]
    v_exp_f32 v241, v165
    v_mfma_f32_16x16x32_bf16 a[60:63], a[204:207], v[204:207], a[60:63]
    s_waitcnt lgkmcnt(3)
    v_add_u32 v3, s53, v56
    v_cvt_pk_bf16_f32 v212, v240, v241
    v_mfma_f32_16x16x32_bf16 a[64:67], a[208:211], v[192:195], a[64:67]
    v_exp_f32 v242, v166
    v_mfma_f32_16x16x32_bf16 a[68:71], a[208:211], v[196:199], a[68:71]
    buffer_load_dwordx4 a[224:227], v228, s[12:15], s57 offen
    ds_read_b128 a[132:135], v2 offset:1024
    v_mfma_f32_16x16x32_bf16 a[72:75], a[208:211], v[200:203], a[72:75]
    s_lshl_b32 s58, s61, 17
    v_exp_f32 v243, v167
    v_mfma_f32_16x16x32_bf16 a[76:79], a[208:211], v[204:207], a[76:79]
    s_add_u32 s57, s57, s56
    v_or3_b32 v57, v57, v211, v212
    v_cvt_pk_bf16_f32 v213, v242, v243
    v_mfma_f32_16x16x32_bf16 a[80:83], a[212:215], v[192:195], a[80:83]
    s_lshl_b32 s60, s60, 10
    s_cmp_ge_u32 s36, s42
    s_cbranch_scc1 k2_prep_55
k2_prepret_56:
    v_mfma_f32_16x16x32_bf16 a[84:87], a[212:215], v[196:199], a[84:87]
    v_exp_f32 v244, v180
    v_mfma_f32_16x16x32_bf16 a[88:91], a[212:215], v[200:203], a[88:91]
    buffer_load_dwordx4 a[228:231], v228, s[12:15], s57 offen
    ds_read_b128 a[136:139], v2 offset:2048
    v_mfma_f32_16x16x32_bf16 a[92:95], a[212:215], v[204:207], a[92:95]
    s_waitcnt lgkmcnt(3)
    v_exp_f32 v245, v181
    v_mfma_f32_16x16x32_bf16 a[96:99], a[216:219], v[192:195], a[96:99]
    s_add_u32 s57, s57, s56
    v_exp_f32 v246, v182
    v_mfma_f32_16x16x32_bf16 a[100:103], a[216:219], v[196:199], a[100:103]
    s_add_u32 s58, s58, s60
    ds_read_b128 a[140:143], v2 offset:3072
    v_cvt_pk_bf16_f32 v214, v244, v245
    v_mfma_f32_16x16x32_bf16 a[104:107], a[216:219], v[200:203], a[104:107]
    v_exp_f32 v247, v183
    v_mfma_f32_16x16x32_bf16 a[108:111], a[216:219], v[204:207], a[108:111]
    v_or3_b32 v57, v57, v213, v214
    v_cvt_pk_bf16_f32 v215, v246, v247
    v_mfma_f32_16x16x32_bf16 a[112:115], a[220:223], v[192:195], a[112:115]
    s_mov_b32 s10, s59
    buffer_load_dwordx4 a[232:235], v228, s[12:15], s57 offen
    ds_read_b128 a[144:147], v2 offset:4096
    v_mfma_f32_16x16x32_bf16 a[116:119], a[220:223], v[196:199], a[116:119]
    s_add_u32 s57, s57, s56
    v_exp_f32 v232, v168
    v_mfma_f32_16x16x32_bf16 a[120:123], a[220:223], v[200:203], a[120:123]
    v_exp_f32 v233, v169
    v_mfma_f32_16x16x32_bf16 a[124:127], a[220:223], v[204:207], a[124:127]
    s_waitcnt lgkmcnt(3)
    v_exp_f32 v234, v170
    v_mfma_f32_16x16x32_bf16 v[128:131], a[128:131], v[64:67], v[16:19]
    v_cvt_pk_bf16_f32 v216, v232, v233
    v_mfma_f32_16x16x32_bf16 v[132:135], a[128:131], v[80:83], v[20:23]
    buffer_load_dwordx4 a[236:239], v228, s[12:15], s57 offen
    ds_read_b128 a[148:151], v2 offset:5120
    v_mfma_f32_16x16x32_bf16 v[136:139], a[128:131], v[96:99], v[24:27]
    v_exp_f32 v235, v171
    v_mfma_f32_16x16x32_bf16 v[140:143], a[128:131], v[112:115], v[28:31]
    s_add_u32 s36, s36, 32
    v_or3_b32 v57, v57, v215, v216
    v_cvt_pk_bf16_f32 v217, v234, v235
    v_mfma_f32_16x16x32_bf16 v[128:131], a[132:135], v[68:71], v[128:131]
    v_exp_f32 v236, v184
    v_mfma_f32_16x16x32_bf16 v[132:135], a[132:135], v[84:87], v[132:135]
    ds_read_b128 a[152:155], v2 offset:6144
    v_mfma_f32_16x16x32_bf16 v[136:139], a[132:135], v[100:103], v[136:139]
    s_mov_b32 m0, s34
    v_exp_f32 v237, v185
    v_mfma_f32_16x16x32_bf16 v[140:143], a[132:135], v[116:119], v[140:143]
    s_waitcnt lgkmcnt(3)
    buffer_load_dwordx4 v1, s[16:19], s32 offen offset:0 sc1 lds
    v_mfma_f32_16x16x32_bf16 v[128:131], a[136:139], v[72:75], v[128:131]
    s_add_u32 s52, s52, 8192
    v_exp_f32 v238, v186
    v_mfma_f32_16x16x32_bf16 v[132:135], a[136:139], v[88:91], v[132:135]
    ds_read_b128 a[156:159], v2 offset:7168
    v_cvt_pk_bf16_f32 v218, v236, v237
    v_mfma_f32_16x16x32_bf16 v[136:139], a[136:139], v[104:107], v[136:139]
    s_and_b32 s52, s52, 0xffff
    v_exp_f32 v239, v187
    v_mfma_f32_16x16x32_bf16 v[140:143], a[136:139], v[120:123], v[140:143]
    s_add_u32 s34, s34, 0x4000
    v_or3_b32 v57, v57, v217, v218
    v_cvt_pk_bf16_f32 v219, v238, v239
    v_mfma_f32_16x16x32_bf16 v[128:131], a[140:143], v[76:79], v[128:131]
    v_exp_f32 v240, v172
    v_mfma_f32_16x16x32_bf16 v[132:135], a[140:143], v[92:95], v[132:135]
    buffer_load_dwordx4 v1, s[16:19], s32 offen offset:1024 sc1 lds
    v_mfma_f32_16x16x32_bf16 v[136:139], a[140:143], v[108:111], v[136:139]
    v_exp_f32 v241, v173
    v_mfma_f32_16x16x32_bf16 v[140:143], a[140:143], v[124:127], v[140:143]
    s_waitcnt lgkmcnt(2)
    ds_read_b128 a[192:195], v3 offset:0
    v_cvt_pk_bf16_f32 v220, v240, v241
    v_mfma_f32_16x16x32_bf16 v[144:147], a[144:147], v[64:67], v[32:35]
    s_and_b32 s34, s34, 0xffff
    v_exp_f32 v242, v174
    v_mfma_f32_16x16x32_bf16 v[148:151], a[144:147], v[80:83], v[36:39]
    v_add_u32 v2, s52, v1
    v_or3_b32 v57, v57, v219, v220
    v_mfma_f32_16x16x32_bf16 v[152:155], a[144:147], v[96:99], v[40:43]
    v_exp_f32 v243, v175
    v_mfma_f32_16x16x32_bf16 v[156:159], a[144:147], v[112:115], v[44:47]
    buffer_load_dwordx4 v1, s[16:19], s32 offen offset:2048 sc1 lds
    ds_read_b128 a[196:199], v3 offset:1024
    v_mfma_f32_16x16x32_bf16 v[144:147], a[148:151], v[68:71], v[144:147]
    v_exp_f32 v244, v188
    v_mfma_f32_16x16x32_bf16 v[148:151], a[148:151], v[84:87], v[148:151]
    ds_read_b128 a[200:203], v3 offset:2048
    v_cvt_pk_bf16_f32 v221, v242, v243
    v_mfma_f32_16x16x32_bf16 v[152:155], a[148:151], v[100:103], v[152:155]
    v_exp_f32 v245, v189
    v_mfma_f32_16x16x32_bf16 v[156:159], a[148:151], v[116:119], v[156:159]
    s_waitcnt lgkmcnt(3)
    v_exp_f32 v246, v190
    v_mfma_f32_16x16x32_bf16 v[144:147], a[152:155], v[72:75], v[144:147]
    buffer_load_dwordx4 v1, s[16:19], s32 offen offset:3072 sc1 lds
    v_mfma_f32_16x16x32_bf16 v[148:151], a[152:155], v[88:91], v[148:151]
    s_add_u32 s32, s32, 0x80000
    ds_read_b128 a[204:207], v3 offset:3072
    v_cvt_pk_bf16_f32 v222, v244, v245
    v_mfma_f32_16x16x32_bf16 v[152:155], a[152:155], v[104:107], v[152:155]
    v_exp_f32 v247, v191
    v_mfma_f32_16x16x32_bf16 v[156:159], a[152:155], v[120:123], v[156:159]
    v_or3_b32 v57, v57, v221, v222
    v_cvt_pk_bf16_f32 v223, v246, v247
    v_mfma_f32_16x16x32_bf16 v[144:147], a[156:159], v[76:79], v[144:147]
    v_mfma_f32_16x16x32_bf16 v[148:151], a[156:159], v[92:95], v[148:151]
    v_bitop3_b32 v57, v57, v223, s37 bitop3:0xa8
    v_cmp_ne_u32 vcc, 0, v57
    v_mfma_f32_16x16x32_bf16 v[152:155], a[156:159], v[108:111], v[152:155]
    v_mfma_f32_16x16x32_bf16 v[156:159], a[156:159], v[124:127], v[156:159]
    s_cbranch_vccnz k2_rare_57
k2_ret_58:
    v_mfma_f32_16x16x32_bf16 v[12:15], v[60:63], v[208:211], v[12:15]
    ds_read_b128 a[208:211], v3 offset:4096
    v_mfma_f32_16x16x32_bf16 v[48:51], v[60:63], v[212:215], v[48:51]
    v_exp_f32 v232, v128
    v_mfma_f32_16x16x32_bf16 v[248:251], v[60:63], v[216:219], v[248:251]
    s_mov_b32 m0, s35
    v_exp_f32 v233, v129
    v_mfma_f32_16x16x32_bf16 v[252:255], v[60:63], v[220:223], v[252:255]
    s_waitcnt lgkmcnt(3)
    buffer_load_dwordx4 v1, s[20:23], s33 offen offset:0 sc1 lds
    ds_read_b128 a[212:215], v3 offset:5120
    v_mfma_f32_16x16x32_bf16 a[0:3], a[192:195], v[208:211], a[0:3]
    s_add_u32 s53, s53, 8192
    v_exp_f32 v234, v130
    v_mfma_f32_16x16x32_bf16 a[4:7], a[192:195], v[212:215], a[4:7]
    s_and_b32 s53, s53, 0xffff
    v_cvt_pk_bf16_f32 v192, v232, v233
    v_mfma_f32_16x16x32_bf16 a[8:11], a[192:195], v[216:219], a[8:11]
    v_exp_f32 v235, v131
    v_mfma_f32_16x16x32_bf16 a[12:15], a[192:195], v[220:223], a[12:15]
    ds_read_b128 a[216:219], v3 offset:6144
    v_cvt_pk_bf16_f32 v193, v234, v235
    v_mfma_f32_16x16x32_bf16 a[16:19], a[196:199], v[208:211], a[16:19]
    v_exp_f32 v236, v144
    v_mfma_f32_16x16x32_bf16 a[20:23], a[196:199], v[212:215], a[20:23]
    v_exp_f32 v237, v145
    v_mfma_f32_16x16x32_bf16 a[24:27], a[196:199], v[216:219], a[24:27]
    v_mfma_f32_16x16x32_bf16 a[28:31], a[196:199], v[220:223], a[28:31]
    s_waitcnt lgkmcnt(3)
    ds_read_b128 a[220:223], v3 offset:7168
    v_cvt_pk_bf16_f32 v194, v236, v237
    v_mfma_f32_16x16x32_bf16 a[32:35], a[200:203], v[208:211], a[32:35]
    v_exp_f32 v238, v146
    v_mfma_f32_16x16x32_bf16 a[36:39], a[200:203], v[212:215], a[36:39]
    v_exp_f32 v239, v147
    v_mfma_f32_16x16x32_bf16 a[40:43], a[200:203], v[216:219], a[40:43]
    v_or3_b32 v57, v192, v193, v194
    v_mfma_f32_16x16x32_bf16 a[44:47], a[200:203], v[220:223], a[44:47]
    v_exp_f32 v240, v132
    v_mfma_f32_16x16x32_bf16 a[48:51], a[204:207], v[208:211], a[48:51]
    s_add_u32 s35, s35, 0x4000
    v_cvt_pk_bf16_f32 v195, v238, v239
    v_mfma_f32_16x16x32_bf16 a[52:55], a[204:207], v[212:215], a[52:55]
    buffer_load_dwordx4 v1, s[20:23], s33 offen offset:1024 sc1 lds
    ds_read_b128 a[128:131], v2 offset:0
    v_mfma_f32_16x16x32_bf16 a[56:59], a[204:207], v[216:219], a[56:59]
    v_exp_f32 v241, v133
    v_mfma_f32_16x16x32_bf16 a[60:63], a[204:207], v[220:223], a[60:63]
    s_waitcnt lgkmcnt(3)
    v_add_u32 v3, s53, v56
    v_cvt_pk_bf16_f32 v196, v240, v241
    v_mfma_f32_16x16x32_bf16 a[64:67], a[208:211], v[208:211], a[64:67]
    v_exp_f32 v242, v134
    v_mfma_f32_16x16x32_bf16 a[68:71], a[208:211], v[212:215], a[68:71]
    ds_read_b128 a[132:135], v2 offset:1024
    v_or3_b32 v57, v57, v195, v196
    v_mfma_f32_16x16x32_bf16 a[72:75], a[208:211], v[216:219], a[72:75]
    v_exp_f32 v243, v135
    v_mfma_f32_16x16x32_bf16 a[76:79], a[208:211], v[220:223], a[76:79]
    s_cmp_ge_u32 s36, s42
    s_cbranch_scc1 k2_prep_59
k2_prepret_60:
    v_mfma_f32_16x16x32_bf16 a[80:83], a[212:215], v[208:211], a[80:83]
    v_exp_f32 v244, v148
    v_mfma_f32_16x16x32_bf16 a[84:87], a[212:215], v[212:215], a[84:87]
    ds_read_b128 a[136:139], v2 offset:2048
    v_cvt_pk_bf16_f32 v197, v242, v243
    v_mfma_f32_16x16x32_bf16 a[88:91], a[212:215], v[216:219], a[88:91]
    v_exp_f32 v245, v149
    v_mfma_f32_16x16x32_bf16 a[92:95], a[212:215], v[220:223], a[92:95]
    s_waitcnt lgkmcnt(3)
    v_exp_f32 v246, v150
    v_mfma_f32_16x16x32_bf16 a[96:99], a[216:219], v[208:211], a[96:99]
    ds_read_b128 a[140:143], v2 offset:3072
    v_cvt_pk_bf16_f32 v198, v244, v245
    v_mfma_f32_16x16x32_bf16 a[100:103], a[216:219], v[212:215], a[100:103]
    v_exp_f32 v247, v151
    v_mfma_f32_16x16x32_bf16 a[104:107], a[216:219], v[216:219], a[104:107]
    v_or3_b32 v57, v57, v197, v198
    v_mfma_f32_16x16x32_bf16 a[108:111], a[216:219], v[220:223], a[108:111]
    s_and_b32 s35, s35, 0xffff
    v_exp_f32 v232, v136
    v_mfma_f32_16x16x32_bf16 a[112:115], a[220:223], v[208:211], a[112:115]
    ds_read_b128 a[144:147], v2 offset:4096
    v_cvt_pk_bf16_f32 v199, v246, v247
    v_mfma_f32_16x16x32_bf16 a[116:119], a[220:223], v[212:215], a[116:119]
    buffer_load_dwordx4 v1, s[20:23], s33 offen offset:2048 sc1 lds
    v_mfma_f32_16x16x32_bf16 a[120:123], a[220:223], v[216:219], a[120:123]
    v_exp_f32 v233, v137
    v_mfma_f32_16x16x32_bf16 a[124:127], a[220:223], v[220:223], a[124:127]
    s_waitcnt lgkmcnt(3)
    v_exp_f32 v234, v138
    v_mfma_f32_16x16x32_bf16 v[160:163], a[128:131], v[64:67], v[16:19]
    v_cvt_pk_bf16_f32 v200, v232, v233
    v_mfma_f32_16x16x32_bf16 v[164:167], a[128:131], v[80:83], v[20:23]
    ds_read_b128 a[148:151], v2 offset:5120
    v_or3_b32 v57, v57, v199, v200
    v_mfma_f32_16x16x32_bf16 v[168:171], a[128:131], v[96:99], v[24:27]
    v_exp_f32 v235, v139
    v_mfma_f32_16x16x32_bf16 v[172:175], a[128:131], v[112:115], v[28:31]
    s_add_u32 s36, s36, 32
    v_exp_f32 v236, v152
    v_mfma_f32_16x16x32_bf16 v[160:163], a[132:135], v[68:71], v[160:163]
    s_or_b32 s35, s35, 0x10000
    v_cvt_pk_bf16_f32 v201, v234, v235
    v_mfma_f32_16x16x32_bf16 v[164:167], a[132:135], v[84:87], v[164:167]
    ds_read_b128 a[152:155], v2 offset:6144
    v_mfma_f32_16x16x32_bf16 v[168:171], a[132:135], v[100:103], v[168:171]
    v_exp_f32 v237, v153
    v_mfma_f32_16x16x32_bf16 v[172:175], a[132:135], v[116:119], v[172:175]
    s_waitcnt lgkmcnt(3)
    v_exp_f32 v238, v154
    v_mfma_f32_16x16x32_bf16 v[160:163], a[136:139], v[72:75], v[160:163]
    s_add_u32 s52, s52, 8192
    v_cvt_pk_bf16_f32 v202, v236, v237
    v_mfma_f32_16x16x32_bf16 v[164:167], a[136:139], v[88:91], v[164:167]
    ds_read_b128 a[156:159], v2 offset:7168
    v_or3_b32 v57, v57, v201, v202
    v_mfma_f32_16x16x32_bf16 v[168:171], a[136:139], v[104:107], v[168:171]
    s_and_b32 s52, s52, 0xffff
    v_exp_f32 v239, v155
    v_mfma_f32_16x16x32_bf16 v[172:175], a[136:139], v[120:123], v[172:175]
    v_exp_f32 v240, v140
    v_mfma_f32_16x16x32_bf16 v[160:163], a[140:143], v[76:79], v[160:163]
    v_cvt_pk_bf16_f32 v203, v238, v239
    v_mfma_f32_16x16x32_bf16 v[164:167], a[140:143], v[92:95], v[164:167]
    buffer_load_dwordx4 v1, s[20:23], s33 offen offset:3072 sc1 lds
    v_mfma_f32_16x16x32_bf16 v[168:171], a[140:143], v[108:111], v[168:171]
    s_add_u32 s33, s33, 0x80000
    v_exp_f32 v241, v141
    v_mfma_f32_16x16x32_bf16 v[172:175], a[140:143], v[124:127], v[172:175]
    s_waitcnt lgkmcnt(2)
    ds_read_b128 a[192:195], v3 offset:0
    v_cvt_pk_bf16_f32 v204, v240, v241
    v_mfma_f32_16x16x32_bf16 v[176:179], a[144:147], v[64:67], v[32:35]
    v_exp_f32 v242, v142
    v_mfma_f32_16x16x32_bf16 v[180:183], a[144:147], v[80:83], v[36:39]
    v_add_u32 v2, s52, v1
    v_or3_b32 v57, v57, v203, v204
    v_mfma_f32_16x16x32_bf16 v[184:187], a[144:147], v[96:99], v[40:43]
    v_exp_f32 v243, v143
    v_mfma_f32_16x16x32_bf16 v[188:191], a[144:147], v[112:115], v[44:47]
    ds_read_b128 a[196:199], v3 offset:1024
    v_cvt_pk_bf16_f32 v205, v242, v243
    v_mfma_f32_16x16x32_bf16 v[176:179], a[148:151], v[68:71], v[176:179]
    v_exp_f32 v244, v156
    v_mfma_f32_16x16x32_bf16 v[180:183], a[148:151], v[84:87], v[180:183]
    v_exp_f32 v245, v157
    v_mfma_f32_16x16x32_bf16 v[184:187], a[148:151], v[100:103], v[184:187]
    ds_read_b128 a[200:203], v3 offset:2048
    v_mfma_f32_16x16x32_bf16 v[188:191], a[148:151], v[116:119], v[188:191]
    s_waitcnt lgkmcnt(3)
    v_exp_f32 v246, v158
    v_mfma_f32_16x16x32_bf16 v[176:179], a[152:155], v[72:75], v[176:179]
    s_sub_u32 s63, s63, 1
    v_cvt_pk_bf16_f32 v206, v244, v245
    v_mfma_f32_16x16x32_bf16 v[180:183], a[152:155], v[88:91], v[180:183]
    v_exp_f32 v247, v159
    v_mfma_f32_16x16x32_bf16 v[184:187], a[152:155], v[104:107], v[184:187]
    ds_read_b128 a[204:207], v3 offset:3072
    v_or3_b32 v57, v57, v205, v206
    v_mfma_f32_16x16x32_bf16 v[188:191], a[152:155], v[120:123], v[188:191]
    v_cvt_pk_bf16_f32 v207, v246, v247
    v_mfma_f32_16x16x32_bf16 v[176:179], a[156:159], v[76:79], v[176:179]
    v_mfma_f32_16x16x32_bf16 v[180:183], a[156:159], v[92:95], v[180:183]
    v_bitop3_b32 v57, v57, v207, s37 bitop3:0xa8
    v_cmp_ne_u32 vcc, 0, v57
    v_mfma_f32_16x16x32_bf16 v[184:187], a[156:159], v[108:111], v[184:187]
    v_mfma_f32_16x16x32_bf16 v[188:191], a[156:159], v[124:127], v[188:191]
    s_waitcnt vmcnt(8)
    s_barrier
    s_cbranch_vccnz k2_rare_61
k2_ret_62:
    s_cmp_lg_u32 s63, 0
    s_cbranch_scc1 k2_dloop_54
    v_mfma_f32_16x16x32_bf16 v[12:15], v[60:63], v[192:195], v[12:15]
    ds_read_b128 a[208:211], v3 offset:4096
    v_mfma_f32_16x16x32_bf16 v[48:51], v[60:63], v[196:199], v[48:51]
    v_exp_f32 v232, v160
    v_mfma_f32_16x16x32_bf16 v[248:251], v[60:63], v[200:203], v[248:251]
    s_add_u32 s53, s53, 8192
    buffer_store_dwordx4 a[224:227], v229, s[8:11], s58 offen offset:0 sc1
    v_mfma_f32_16x16x32_bf16 v[252:255], v[60:63], v[204:207], v[252:255]
    s_waitcnt lgkmcnt(3)
    v_exp_f32 v233, v161
    v_mfma_f32_16x16x32_bf16 a[0:3], a[192:195], v[192:195], a[0:3]
    s_and_b32 s53, s53, 0xffff
    ds_read_b128 a[212:215], v3 offset:5120
    v_cvt_pk_bf16_f32 v208, v232, v233
    v_mfma_f32_16x16x32_bf16 a[4:7], a[192:195], v[196:199], a[4:7]
    v_exp_f32 v234, v162
    v_mfma_f32_16x16x32_bf16 a[8:11], a[192:195], v[200:203], a[8:11]
    v_exp_f32 v235, v163
    v_mfma_f32_16x16x32_bf16 a[12:15], a[192:195], v[204:207], a[12:15]
    buffer_store_dwordx4 a[228:231], v229, s[8:11], s58 offen offset:256 sc1
    ds_read_b128 a[216:219], v3 offset:6144
    v_mfma_f32_16x16x32_bf16 a[16:19], a[196:199], v[192:195], a[16:19]
    v_exp_f32 v236, v176
    v_mfma_f32_16x16x32_bf16 a[20:23], a[196:199], v[196:199], a[20:23]
    v_cvt_pk_bf16_f32 v209, v234, v235
    v_mfma_f32_16x16x32_bf16 a[24:27], a[196:199], v[200:203], a[24:27]
    v_exp_f32 v237, v177
    v_mfma_f32_16x16x32_bf16 a[28:31], a[196:199], v[204:207], a[28:31]
    s_waitcnt lgkmcnt(3)
    ds_read_b128 a[220:223], v3 offset:7168
    v_cvt_pk_bf16_f32 v210, v236, v237
    v_mfma_f32_16x16x32_bf16 a[32:35], a[200:203], v[192:195], a[32:35]
    v_exp_f32 v238, v178
    v_mfma_f32_16x16x32_bf16 a[36:39], a[200:203], v[196:199], a[36:39]
    v_exp_f32 v239, v179
    v_mfma_f32_16x16x32_bf16 a[40:43], a[200:203], v[200:203], a[40:43]
    v_or3_b32 v57, v208, v209, v210
    v_mfma_f32_16x16x32_bf16 a[44:47], a[200:203], v[204:207], a[44:47]
    buffer_store_dwordx4 a[232:235], v229, s[8:11], s58 offen offset:512 sc1
    v_mfma_f32_16x16x32_bf16 a[48:51], a[204:207], v[192:195], a[48:51]
    v_exp_f32 v240, v164
    v_mfma_f32_16x16x32_bf16 a[52:55], a[204:207], v[196:199], a[52:55]
    ds_read_b128 a[128:131], v2 offset:0
    v_cvt_pk_bf16_f32 v211, v238, v239
    v_mfma_f32_16x16x32_bf16 a[56:59], a[204:207], v[200:203], a[56:59]
    v_exp_f32 v241, v165
    v_mfma_f32_16x16x32_bf16 a[60:63], a[204:207], v[204:207], a[60:63]
    s_waitcnt lgkmcnt(3)
    ds_read_b128 a[132:135], v2 offset:1024
    v_add_u32 v3, s53, v56
    v_mfma_f32_16x16x32_bf16 a[64:67], a[208:211], v[192:195], a[64:67]
    v_exp_f32 v242, v166
    v_mfma_f32_16x16x32_bf16 a[68:71], a[208:211], v[196:199], a[68:71]
    ds_read_b128 a[136:139], v2 offset:2048
    v_cvt_pk_bf16_f32 v212, v240, v241
    v_mfma_f32_16x16x32_bf16 a[72:75], a[208:211], v[200:203], a[72:75]
    v_exp_f32 v243, v167
    v_mfma_f32_16x16x32_bf16 a[76:79], a[208:211], v[204:207], a[76:79]
    ds_read_b128 a[140:143], v2 offset:3072
    v_or3_b32 v57, v57, v211, v212
    v_mfma_f32_16x16x32_bf16 a[80:83], a[212:215], v[192:195], a[80:83]
    buffer_store_dwordx4 a[236:239], v229, s[8:11], s58 offen offset:768 sc1
    ds_read_b128 a[144:147], v2 offset:4096
    v_mfma_f32_16x16x32_bf16 a[84:87], a[212:215], v[196:199], a[84:87]
    s_branch k2_prep_63
k2_prepret_64:
    v_mfma_f32_16x16x32_bf16 a[88:91], a[212:215], v[200:203], a[88:91]
    v_exp_f32 v244, v180
    v_mfma_f32_16x16x32_bf16 a[92:95], a[212:215], v[204:207], a[92:95]
    s_waitcnt lgkmcnt(5)
    ds_read_b128 a[148:151], v2 offset:5120
    v_cvt_pk_bf16_f32 v213, v242, v243
    v_mfma_f32_16x16x32_bf16 a[96:99], a[216:219], v[192:195], a[96:99]
    v_exp_f32 v245, v181
    v_mfma_f32_16x16x32_bf16 a[100:103], a[216:219], v[196:199], a[100:103]
    v_exp_f32 v246, v182
    v_mfma_f32_16x16x32_bf16 a[104:107], a[216:219], v[200:203], a[104:107]
    s_mov_b32 m0, s34
    ds_read_b128 a[152:155], v2 offset:6144
    v_cvt_pk_bf16_f32 v214, v244, v245
    v_mfma_f32_16x16x32_bf16 a[108:111], a[216:219], v[204:207], a[108:111]
    v_exp_f32 v247, v183
    v_mfma_f32_16x16x32_bf16 a[112:115], a[220:223], v[192:195], a[112:115]
    ds_read_b128 a[156:159], v2 offset:7168
    v_or3_b32 v57, v57, v213, v214
    v_mfma_f32_16x16x32_bf16 a[116:119], a[220:223], v[196:199], a[116:119]
    buffer_load_dwordx4 v1, s[16:19], s32 offen offset:0 sc1 lds
    ds_read_b128 a[160:163], v2 offset:8192
    v_mfma_f32_16x16x32_bf16 a[120:123], a[220:223], v[200:203], a[120:123]
    v_exp_f32 v232, v168
    v_mfma_f32_16x16x32_bf16 a[124:127], a[220:223], v[204:207], a[124:127]
    s_waitcnt lgkmcnt(7)
    ds_read_b128 a[164:167], v2 offset:9216
    v_cvt_pk_bf16_f32 v215, v246, v247
    v_mfma_f32_16x16x32_bf16 v[128:131], a[128:131], v[96:99], v[16:19]
    v_exp_f32 v233, v169
    v_mfma_f32_16x16x32_bf16 v[132:135], a[128:131], v[112:115], v[20:23]
    s_add_u32 s34, s34, 0x4000
    v_exp_f32 v234, v170
    v_mfma_f32_16x16x32_bf16 v[128:131], a[132:135], v[100:103], v[128:131]
    ds_read_b128 a[168:171], v2 offset:10240
    v_cvt_pk_bf16_f32 v216, v232, v233
    v_mfma_f32_16x16x32_bf16 v[132:135], a[132:135], v[116:119], v[132:135]
    s_waitcnt lgkmcnt(7)
    v_exp_f32 v235, v171
    v_mfma_f32_16x16x32_bf16 v[128:131], a[136:139], v[104:107], v[128:131]
    s_add_u32 s36, s36, 64
    ds_read_b128 a[172:175], v2 offset:11264
    v_or3_b32 v57, v57, v215, v216
    v_mfma_f32_16x16x32_bf16 v[132:135], a[136:139], v[120:123], v[132:135]
    buffer_load_dwordx4 v1, s[16:19], s32 offen offset:1024 sc1 lds
    ds_read_b128 a[176:179], v2 offset:12288
    v_mfma_f32_16x16x32_bf16 v[128:131], a[140:143], v[108:111], v[128:131]
    v_exp_f32 v236, v184
    v_mfma_f32_16x16x32_bf16 v[132:135], a[140:143], v[124:127], v[132:135]
    s_waitcnt lgkmcnt(7)
    ds_read_b128 a[180:183], v2 offset:13312
    v_cvt_pk_bf16_f32 v217, v234, v235
    v_mfma_f32_16x16x32_bf16 v[144:147], a[144:147], v[96:99], v[32:35]
    s_add_u32 s52, s52, 16384
    v_exp_f32 v237, v185
    v_mfma_f32_16x16x32_bf16 v[148:151], a[144:147], v[112:115], v[36:39]
    s_and_b32 s34, s34, 0xffff
    v_exp_f32 v238, v186
    v_mfma_f32_16x16x32_bf16 v[144:147], a[148:151], v[100:103], v[144:147]
    s_and_b32 s52, s52, 0xffff
    ds_read_b128 a[184:187], v2 offset:14336
    v_cvt_pk_bf16_f32 v218, v236, v237
    v_mfma_f32_16x16x32_bf16 v[148:151], a[148:151], v[116:119], v[148:151]
    s_waitcnt lgkmcnt(7)
    v_exp_f32 v239, v187
    v_mfma_f32_16x16x32_bf16 v[144:147], a[152:155], v[104:107], v[144:147]
    ds_read_b128 a[188:191], v2 offset:15360
    v_or3_b32 v57, v57, v217, v218
    v_mfma_f32_16x16x32_bf16 v[148:151], a[152:155], v[120:123], v[148:151]
    buffer_load_dwordx4 v1, s[16:19], s32 offen offset:2048 sc1 lds
    v_mfma_f32_16x16x32_bf16 v[144:147], a[156:159], v[108:111], v[144:147]
    v_exp_f32 v240, v172
    v_mfma_f32_16x16x32_bf16 v[148:151], a[156:159], v[124:127], v[148:151]
    s_waitcnt lgkmcnt(6)
    ds_read_b128 a[192:195], v3 offset:0
    v_cvt_pk_bf16_f32 v219, v238, v239
    v_mfma_f32_16x16x32_bf16 v[136:139], a[160:163], v[96:99], v[24:27]
    v_exp_f32 v241, v173
    v_mfma_f32_16x16x32_bf16 v[140:143], a[160:163], v[112:115], v[28:31]
    v_exp_f32 v242, v174
    v_mfma_f32_16x16x32_bf16 v[136:139], a[164:167], v[100:103], v[136:139]
    v_cvt_pk_bf16_f32 v220, v240, v241
    v_add_u32 v2, s52, v1
    v_mfma_f32_16x16x32_bf16 v[140:143], a[164:167], v[116:119], v[140:143]
    s_waitcnt lgkmcnt(5)
    v_exp_f32 v243, v175
    v_mfma_f32_16x16x32_bf16 v[136:139], a[168:171], v[104:107], v[136:139]
    ds_read_b128 a[196:199], v3 offset:1024
    v_or3_b32 v57, v57, v219, v220
    v_mfma_f32_16x16x32_bf16 v[140:143], a[168:171], v[120:123], v[140:143]
    buffer_load_dwordx4 v1, s[16:19], s32 offen offset:3072 sc1 lds
    ds_read_b128 a[200:203], v3 offset:2048
    v_mfma_f32_16x16x32_bf16 v[136:139], a[172:175], v[108:111], v[136:139]
    s_add_u32 s32, s32, 0x80000
    v_exp_f32 v244, v188
    v_mfma_f32_16x16x32_bf16 v[140:143], a[172:175], v[124:127], v[140:143]
    s_waitcnt lgkmcnt(5)
    v_cvt_pk_bf16_f32 v221, v242, v243
    v_mfma_f32_16x16x32_bf16 v[152:155], a[176:179], v[96:99], v[40:43]
    v_exp_f32 v245, v189
    v_mfma_f32_16x16x32_bf16 v[156:159], a[176:179], v[112:115], v[44:47]
    v_exp_f32 v246, v190
    v_mfma_f32_16x16x32_bf16 v[152:155], a[180:183], v[100:103], v[152:155]
    ds_read_b128 a[204:207], v3 offset:3072
    v_cvt_pk_bf16_f32 v222, v244, v245
    v_mfma_f32_16x16x32_bf16 v[156:159], a[180:183], v[116:119], v[156:159]
    s_waitcnt lgkmcnt(4)
    v_exp_f32 v247, v191
    v_mfma_f32_16x16x32_bf16 v[152:155], a[184:187], v[104:107], v[152:155]
    v_or3_b32 v57, v57, v221, v222
    v_cvt_pk_bf16_f32 v223, v246, v247
    v_mfma_f32_16x16x32_bf16 v[156:159], a[184:187], v[120:123], v[156:159]
    v_bitop3_b32 v57, v57, v223, s37 bitop3:0xa8
    v_cmp_ne_u32 vcc, 0, v57
    v_mfma_f32_16x16x32_bf16 v[152:155], a[188:191], v[108:111], v[152:155]
    v_mfma_f32_16x16x32_bf16 v[156:159], a[188:191], v[124:127], v[156:159]
    s_cbranch_vccnz k2_rare_65
k2_ret_66:
    v_mfma_f32_16x16x32_bf16 v[12:15], v[60:63], v[208:211], v[12:15]
    ds_read_b128 a[208:211], v3 offset:4096
    v_mfma_f32_16x16x32_bf16 v[48:51], v[60:63], v[212:215], v[48:51]
    s_mov_b32 m0, s35
    v_exp_f32 v232, v128
    v_mfma_f32_16x16x32_bf16 v[248:251], v[60:63], v[216:219], v[248:251]
    s_add_u32 s53, s53, 8192
    buffer_load_dwordx4 v1, s[20:23], s33 offen offset:0 sc1 lds
    v_mfma_f32_16x16x32_bf16 v[252:255], v[60:63], v[220:223], v[252:255]
    s_waitcnt lgkmcnt(3)
    v_exp_f32 v233, v129
    v_mfma_f32_16x16x32_bf16 a[0:3], a[192:195], v[208:211], a[0:3]
    s_and_b32 s53, s53, 0xffff
    ds_read_b128 a[212:215], v3 offset:5120
    v_cvt_pk_bf16_f32 v192, v232, v233
    v_mfma_f32_16x16x32_bf16 a[4:7], a[192:195], v[212:215], a[4:7]
    v_exp_f32 v234, v130
    v_mfma_f32_16x16x32_bf16 a[8:11], a[192:195], v[216:219], a[8:11]
    v_exp_f32 v235, v131
    v_mfma_f32_16x16x32_bf16 a[12:15], a[192:195], v[220:223], a[12:15]
    ds_read_b128 a[216:219], v3 offset:6144
    v_cvt_pk_bf16_f32 v193, v234, v235
    v_mfma_f32_16x16x32_bf16 a[16:19], a[196:199], v[208:211], a[16:19]
    s_add_u32 s35, s35, 0x4000
    v_exp_f32 v236, v144
    v_mfma_f32_16x16x32_bf16 a[20:23], a[196:199], v[212:215], a[20:23]
    v_exp_f32 v237, v145
    v_mfma_f32_16x16x32_bf16 a[24:27], a[196:199], v[216:219], a[24:27]
    buffer_load_dwordx4 v1, s[20:23], s33 offen offset:1024 sc1 lds
    v_mfma_f32_16x16x32_bf16 a[28:31], a[196:199], v[220:223], a[28:31]
    s_waitcnt lgkmcnt(3)
    ds_read_b128 a[220:223], v3 offset:7168
    v_cvt_pk_bf16_f32 v194, v236, v237
    v_mfma_f32_16x16x32_bf16 a[32:35], a[200:203], v[208:211], a[32:35]
    v_exp_f32 v238, v146
    v_mfma_f32_16x16x32_bf16 a[36:39], a[200:203], v[212:215], a[36:39]
    v_exp_f32 v239, v147
    v_mfma_f32_16x16x32_bf16 a[40:43], a[200:203], v[216:219], a[40:43]
    v_or3_b32 v57, v192, v193, v194
    v_mfma_f32_16x16x32_bf16 a[44:47], a[200:203], v[220:223], a[44:47]
    v_exp_f32 v240, v132
    v_mfma_f32_16x16x32_bf16 a[48:51], a[204:207], v[208:211], a[48:51]
    s_and_b32 s35, s35, 0xffff
    v_cvt_pk_bf16_f32 v195, v238, v239
    v_mfma_f32_16x16x32_bf16 a[52:55], a[204:207], v[212:215], a[52:55]
    buffer_load_dwordx4 v1, s[20:23], s33 offen offset:2048 sc1 lds
    ds_read_b128 a[128:131], v2 offset:0
    v_mfma_f32_16x16x32_bf16 a[56:59], a[204:207], v[216:219], a[56:59]
    v_exp_f32 v241, v133
    v_mfma_f32_16x16x32_bf16 a[60:63], a[204:207], v[220:223], a[60:63]
    s_waitcnt lgkmcnt(3)
    ds_read_b128 a[132:135], v2 offset:1024
    v_add_u32 v3, s53, v56
    v_mfma_f32_16x16x32_bf16 a[64:67], a[208:211], v[208:211], a[64:67]
    v_exp_f32 v242, v134
    v_mfma_f32_16x16x32_bf16 a[68:71], a[208:211], v[212:215], a[68:71]
    s_or_b32 s35, s35, 0x10000
    ds_read_b128 a[136:139], v2 offset:2048
    v_cvt_pk_bf16_f32 v196, v240, v241
    v_mfma_f32_16x16x32_bf16 a[72:75], a[208:211], v[216:219], a[72:75]
    v_exp_f32 v243, v135
    v_mfma_f32_16x16x32_bf16 a[76:79], a[208:211], v[220:223], a[76:79]
    ds_read_b128 a[140:143], v2 offset:3072
    v_or3_b32 v57, v57, v195, v196
    v_mfma_f32_16x16x32_bf16 a[80:83], a[212:215], v[208:211], a[80:83]
    s_cmp_ge_u32 s36, s43
    s_cbranch_scc1 k2_prep_67
k2_prepret_68:
    v_mfma_f32_16x16x32_bf16 a[84:87], a[212:215], v[212:215], a[84:87]
    v_exp_f32 v244, v148
    v_mfma_f32_16x16x32_bf16 a[88:91], a[212:215], v[216:219], a[88:91]
    ds_read_b128 a[144:147], v2 offset:4096
    v_cvt_pk_bf16_f32 v197, v242, v243
    v_mfma_f32_16x16x32_bf16 a[92:95], a[212:215], v[220:223], a[92:95]
    s_waitcnt lgkmcnt(5)
    v_exp_f32 v245, v149
    v_mfma_f32_16x16x32_bf16 a[96:99], a[216:219], v[208:211], a[96:99]
    buffer_load_dwordx4 v1, s[20:23], s33 offen offset:3072 sc1 lds
    ds_read_b128 a[148:151], v2 offset:5120
    v_mfma_f32_16x16x32_bf16 a[100:103], a[216:219], v[212:215], a[100:103]
    s_add_u32 s33, s33, 0x80000
    v_exp_f32 v246, v150
    v_mfma_f32_16x16x32_bf16 a[104:107], a[216:219], v[216:219], a[104:107]
    ds_read_b128 a[152:155], v2 offset:6144
    v_cvt_pk_bf16_f32 v198, v244, v245
    v_mfma_f32_16x16x32_bf16 a[108:111], a[216:219], v[220:223], a[108:111]
    v_exp_f32 v247, v151
    v_mfma_f32_16x16x32_bf16 a[112:115], a[220:223], v[208:211], a[112:115]
    ds_read_b128 a[156:159], v2 offset:7168
    v_or3_b32 v57, v57, v197, v198
    v_mfma_f32_16x16x32_bf16 a[116:119], a[220:223], v[212:215], a[116:119]
    v_exp_f32 v232, v136
    v_mfma_f32_16x16x32_bf16 a[120:123], a[220:223], v[216:219], a[120:123]
    ds_read_b128 a[160:163], v2 offset:8192
    v_cvt_pk_bf16_f32 v199, v246, v247
    v_mfma_f32_16x16x32_bf16 a[124:127], a[220:223], v[220:223], a[124:127]
    s_waitcnt lgkmcnt(7)
    v_exp_f32 v233, v137
    v_mfma_f32_16x16x32_bf16 v[160:163], a[128:131], v[96:99], v[16:19]
    s_waitcnt vmcnt(12)
    s_barrier
    ds_read_b128 a[164:167], v2 offset:9216
    v_cvt_pk_bf16_f32 v200, v232, v233
    v_mfma_f32_16x16x32_bf16 v[164:167], a[128:131], v[112:115], v[20:23]
    s_mov_b32 m0, s34
    v_exp_f32 v234, v138
    v_mfma_f32_16x16x32_bf16 v[160:163], a[132:135], v[100:103], v[160:163]
    buffer_load_dwordx4 v1, s[16:19], s32 offen offset:0 sc1 lds
    ds_read_b128 a[168:171], v2 offset:10240
    v_mfma_f32_16x16x32_bf16 v[164:167], a[132:135], v[116:119], v[164:167]
    s_waitcnt lgkmcnt(7)
    v_exp_f32 v235, v139
    v_mfma_f32_16x16x32_bf16 v[160:163], a[136:139], v[104:107], v[160:163]
    s_add_u32 s36, s36, 64
    ds_read_b128 a[172:175], v2 offset:11264
    v_or3_b32 v57, v57, v199, v200
    v_mfma_f32_16x16x32_bf16 v[164:167], a[136:139], v[120:123], v[164:167]
    v_exp_f32 v236, v152
    v_mfma_f32_16x16x32_bf16 v[160:163], a[140:143], v[108:111], v[160:163]
    ds_read_b128 a[176:179], v2 offset:12288
    v_cvt_pk_bf16_f32 v201, v234, v235
    v_mfma_f32_16x16x32_bf16 v[164:167], a[140:143], v[124:127], v[164:167]
    s_waitcnt lgkmcnt(7)
    v_exp_f32 v237, v153
    v_mfma_f32_16x16x32_bf16 v[176:179], a[144:147], v[96:99], v[32:35]
    s_add_u32 s34, s34, 0x4000
    ds_read_b128 a[180:183], v2 offset:13312
    v_cvt_pk_bf16_f32 v202, v236, v237
    v_mfma_f32_16x16x32_bf16 v[180:183], a[144:147], v[112:115], v[36:39]
    s_add_u32 s52, s52, 16384
    v_exp_f32 v238, v154
    v_mfma_f32_16x16x32_bf16 v[176:179], a[148:151], v[100:103], v[176:179]
    s_and_b32 s52, s52, 0xffff
    buffer_load_dwordx4 v1, s[16:19], s32 offen offset:1024 sc1 lds
    ds_read_b128 a[184:187], v2 offset:14336
    v_mfma_f32_16x16x32_bf16 v[180:183], a[148:151], v[116:119], v[180:183]
    s_waitcnt lgkmcnt(7)
    v_exp_f32 v239, v155
    v_mfma_f32_16x16x32_bf16 v[176:179], a[152:155], v[104:107], v[176:179]
    ds_read_b128 a[188:191], v2 offset:15360
    v_or3_b32 v57, v57, v201, v202
    v_mfma_f32_16x16x32_bf16 v[180:183], a[152:155], v[120:123], v[180:183]
    v_exp_f32 v240, v140
    v_mfma_f32_16x16x32_bf16 v[176:179], a[156:159], v[108:111], v[176:179]
    s_and_b32 s34, s34, 0xffff
    v_cvt_pk_bf16_f32 v203, v238, v239
    v_mfma_f32_16x16x32_bf16 v[180:183], a[156:159], v[124:127], v[180:183]
    s_waitcnt lgkmcnt(6)
    v_exp_f32 v241, v141
    v_mfma_f32_16x16x32_bf16 v[168:171], a[160:163], v[96:99], v[24:27]
    ds_read_b128 a[192:195], v3 offset:0
    v_cvt_pk_bf16_f32 v204, v240, v241
    v_mfma_f32_16x16x32_bf16 v[172:175], a[160:163], v[112:115], v[28:31]
    v_exp_f32 v242, v142
    v_mfma_f32_16x16x32_bf16 v[168:171], a[164:167], v[100:103], v[168:171]
    buffer_load_dwordx4 v1, s[16:19], s32 offen offset:2048 sc1 lds
    ds_read_b128 a[196:199], v3 offset:1024
    v_mfma_f32_16x16x32_bf16 v[172:175], a[164:167], v[116:119], v[172:175]
    s_waitcnt lgkmcnt(6)
    v_add_u32 v2, s52, v1
    v_or3_b32 v57, v57, v203, v204
    v_mfma_f32_16x16x32_bf16 v[168:171], a[168:171], v[104:107], v[168:171]
    v_exp_f32 v243, v143
    v_mfma_f32_16x16x32_bf16 v[172:175], a[168:171], v[120:123], v[172:175]
    ds_read_b128 a[200:203], v3 offset:2048
    v_cvt_pk_bf16_f32 v205, v242, v243
    v_mfma_f32_16x16x32_bf16 v[168:171], a[172:175], v[108:111], v[168:171]
    v_exp_f32 v244, v156
    v_mfma_f32_16x16x32_bf16 v[172:175], a[172:175], v[124:127], v[172:175]
    s_waitcnt lgkmcnt(5)
    ds_read_b128 a[204:207], v3 offset:3072
    ds_read_b128 a[208:211], v3 offset:4096
    v_mfma_f32_16x16x32_bf16 v[184:187], a[176:179], v[96:99], v[40:43]
    v_exp_f32 v245, v157
    v_mfma_f32_16x16x32_bf16 v[188:191], a[176:179], v[112:115], v[44:47]
    buffer_load_dwordx4 v1, s[16:19], s32 offen offset:3072 sc1 lds
    ds_read_b128 a[212:215], v3 offset:5120
    v_mfma_f32_16x16x32_bf16 v[184:187], a[180:183], v[100:103], v[184:187]
    s_add_u32 s32, s32, 0x80000
    v_exp_f32 v246, v158
    v_mfma_f32_16x16x32_bf16 v[188:191], a[180:183], v[116:119], v[188:191]
    s_waitcnt lgkmcnt(6)
    ds_read_b128 a[216:219], v3 offset:6144
    v_cvt_pk_bf16_f32 v206, v244, v245
    v_mfma_f32_16x16x32_bf16 v[184:187], a[184:187], v[104:107], v[184:187]
    v_exp_f32 v247, v159
    v_mfma_f32_16x16x32_bf16 v[188:191], a[184:187], v[120:123], v[188:191]
    ds_read_b128 a[220:223], v3 offset:7168
    v_or3_b32 v57, v57, v205, v206
    v_mfma_f32_16x16x32_bf16 v[184:187], a[188:191], v[108:111], v[184:187]
    v_cvt_pk_bf16_f32 v207, v246, v247
    v_bitop3_b32 v57, v57, v207, s37 bitop3:0xa8
    v_mfma_f32_16x16x32_bf16 v[188:191], a[188:191], v[124:127], v[188:191]
    v_cmp_ne_u32 vcc, 0, v57
    s_cbranch_vccnz k2_rare_69
k2_ret_70:
    s_lshl_b32 s31, s28, 19
    s_lshl_b32 s44, s38, 6
    s_add_u32 s44, s44, s31
    s_add_u32 s45, s44, 131072
    s_add_u32 s46, s44, 262144
    s_add_u32 s47, s44, 393216
    v_mov_b32 v13, v12
    v_mov_b32 v49, v48
    s_nop 1
    v_permlane16_swap_b32 v12, v13
    v_permlane16_swap_b32 v48, v49
    s_nop 1
    v_add_f32 v12, v12, v13
    v_add_f32 v48, v48, v49
    v_mov_b32 v13, v12
    v_mov_b32 v49, v48
    s_nop 1
    v_permlane32_swap_b32 v12, v13
    v_permlane32_swap_b32 v48, v49
    s_nop 1
    v_add_f32 v12, v12, v13
    v_add_f32 v48, v48, v49
    v_rcp_f32 v13, v12
    v_rcp_f32 v49, v48
    v_rcp_f32 v12, v12
    v_rcp_f32 v48, v48
    s_nop 0
    v_accvgpr_read_b32 v68, a0
    v_accvgpr_read_b32 v69, a1
    v_accvgpr_read_b32 v70, a2
    v_accvgpr_read_b32 v71, a3
    v_accvgpr_read_b32 v72, a16
    v_accvgpr_read_b32 v73, a17
    v_accvgpr_read_b32 v74, a18
    v_accvgpr_read_b32 v75, a19
    v_pk_mul_f32 v[68:69], v[68:69], v[12:13]
    v_pk_mul_f32 v[70:71], v[70:71], v[12:13]
    v_pk_mul_f32 v[72:73], v[72:73], v[12:13]
    v_pk_mul_f32 v[74:75], v[74:75], v[12:13]
    v_cvt_pk_bf16_f32 v64, v68, v69
    v_cvt_pk_bf16_f32 v65, v70, v71
    v_cvt_pk_bf16_f32 v66, v72, v73
    v_cvt_pk_bf16_f32 v67, v74, v75
    buffer_store_dwordx4 v[64:67], v1, s[24:27], s44 offen offset:0 sc1
    v_accvgpr_read_b32 v80, a32
    v_accvgpr_read_b32 v81, a33
    v_accvgpr_read_b32 v82, a34
    v_accvgpr_read_b32 v83, a35
    v_accvgpr_read_b32 v84, a48
    v_accvgpr_read_b32 v85, a49
    v_accvgpr_read_b32 v86, a50
    v_accvgpr_read_b32 v87, a51
    v_pk_mul_f32 v[80:81], v[80:81], v[12:13]
    v_pk_mul_f32 v[82:83], v[82:83], v[12:13]
    v_pk_mul_f32 v[84:85], v[84:85], v[12:13]
    v_pk_mul_f32 v[86:87], v[86:87], v[12:13]
    v_cvt_pk_bf16_f32 v76, v80, v81
    v_cvt_pk_bf16_f32 v77, v82, v83
    v_cvt_pk_bf16_f32 v78, v84, v85
    v_cvt_pk_bf16_f32 v79, v86, v87
    buffer_store_dwordx4 v[76:79], v1, s[24:27], s45 offen offset:0 sc1
    v_accvgpr_read_b32 v68, a64
    v_accvgpr_read_b32 v69, a65
    v_accvgpr_read_b32 v70, a66
    v_accvgpr_read_b32 v71, a67
    v_accvgpr_read_b32 v72, a80
    v_accvgpr_read_b32 v73, a81
    v_accvgpr_read_b32 v74, a82
    v_accvgpr_read_b32 v75, a83
    v_pk_mul_f32 v[68:69], v[68:69], v[12:13]
    v_pk_mul_f32 v[70:71], v[70:71], v[12:13]
    v_pk_mul_f32 v[72:73], v[72:73], v[12:13]
    v_pk_mul_f32 v[74:75], v[74:75], v[12:13]
    v_cvt_pk_bf16_f32 v64, v68, v69
    v_cvt_pk_bf16_f32 v65, v70, v71
    v_cvt_pk_bf16_f32 v66, v72, v73
    v_cvt_pk_bf16_f32 v67, v74, v75
    buffer_store_dwordx4 v[64:67], v1, s[24:27], s46 offen offset:0 sc1
    v_accvgpr_read_b32 v80, a96
    v_accvgpr_read_b32 v81, a97
    v_accvgpr_read_b32 v82, a98
    v_accvgpr_read_b32 v83, a99
    v_accvgpr_read_b32 v84, a112
    v_accvgpr_read_b32 v85, a113
    v_accvgpr_read_b32 v86, a114
    v_accvgpr_read_b32 v87, a115
    v_pk_mul_f32 v[80:81], v[80:81], v[12:13]
    v_pk_mul_f32 v[82:83], v[82:83], v[12:13]
    v_pk_mul_f32 v[84:85], v[84:85], v[12:13]
    v_pk_mul_f32 v[86:87], v[86:87], v[12:13]
    v_cvt_pk_bf16_f32 v76, v80, v81
    v_cvt_pk_bf16_f32 v77, v82, v83
    v_cvt_pk_bf16_f32 v78, v84, v85
    v_cvt_pk_bf16_f32 v79, v86, v87
    buffer_store_dwordx4 v[76:79], v1, s[24:27], s47 offen offset:0 sc1
    v_accvgpr_read_b32 v68, a4
    v_accvgpr_read_b32 v69, a5
    v_accvgpr_read_b32 v70, a6
    v_accvgpr_read_b32 v71, a7
    v_accvgpr_read_b32 v72, a20
    v_accvgpr_read_b32 v73, a21
    v_accvgpr_read_b32 v74, a22
    v_accvgpr_read_b32 v75, a23
    v_pk_mul_f32 v[68:69], v[68:69], v[48:49]
    v_pk_mul_f32 v[70:71], v[70:71], v[48:49]
    v_pk_mul_f32 v[72:73], v[72:73], v[48:49]
    v_pk_mul_f32 v[74:75], v[74:75], v[48:49]
    v_cvt_pk_bf16_f32 v64, v68, v69
    v_cvt_pk_bf16_f32 v65, v70, v71
    v_cvt_pk_bf16_f32 v66, v72, v73
    v_cvt_pk_bf16_f32 v67, v74, v75
    buffer_store_dwordx4 v[64:67], v1, s[24:27], s44 offen offset:1024 sc1
    v_accvgpr_read_b32 v80, a36
    v_accvgpr_read_b32 v81, a37
    v_accvgpr_read_b32 v82, a38
    v_accvgpr_read_b32 v83, a39
    v_accvgpr_read_b32 v84, a52
    v_accvgpr_read_b32 v85, a53
    v_accvgpr_read_b32 v86, a54
    v_accvgpr_read_b32 v87, a55
    v_pk_mul_f32 v[80:81], v[80:81], v[48:49]
    v_pk_mul_f32 v[82:83], v[82:83], v[48:49]
    v_pk_mul_f32 v[84:85], v[84:85], v[48:49]
    v_pk_mul_f32 v[86:87], v[86:87], v[48:49]
    v_cvt_pk_bf16_f32 v76, v80, v81
    v_cvt_pk_bf16_f32 v77, v82, v83
    v_cvt_pk_bf16_f32 v78, v84, v85
    v_cvt_pk_bf16_f32 v79, v86, v87
    buffer_store_dwordx4 v[76:79], v1, s[24:27], s45 offen offset:1024 sc1
    v_accvgpr_read_b32 v68, a68
    v_accvgpr_read_b32 v69, a69
    v_accvgpr_read_b32 v70, a70
    v_accvgpr_read_b32 v71, a71
    v_accvgpr_read_b32 v72, a84
    v_accvgpr_read_b32 v73, a85
    v_accvgpr_read_b32 v74, a86
    v_accvgpr_read_b32 v75, a87
    v_pk_mul_f32 v[68:69], v[68:69], v[48:49]
    v_pk_mul_f32 v[70:71], v[70:71], v[48:49]
    v_pk_mul_f32 v[72:73], v[72:73], v[48:49]
    v_pk_mul_f32 v[74:75], v[74:75], v[48:49]
    v_cvt_pk_bf16_f32 v64, v68, v69
    v_cvt_pk_bf16_f32 v65, v70, v71
    v_cvt_pk_bf16_f32 v66, v72, v73
    v_cvt_pk_bf16_f32 v67, v74, v75
    buffer_store_dwordx4 v[64:67], v1, s[24:27], s46 offen offset:1024 sc1
    v_accvgpr_read_b32 v80, a100
    v_accvgpr_read_b32 v81, a101
    v_accvgpr_read_b32 v82, a102
    v_accvgpr_read_b32 v83, a103
    v_accvgpr_read_b32 v84, a116
    v_accvgpr_read_b32 v85, a117
    v_accvgpr_read_b32 v86, a118
    v_accvgpr_read_b32 v87, a119
    v_pk_mul_f32 v[80:81], v[80:81], v[48:49]
    v_pk_mul_f32 v[82:83], v[82:83], v[48:49]
    v_pk_mul_f32 v[84:85], v[84:85], v[48:49]
    v_pk_mul_f32 v[86:87], v[86:87], v[48:49]
    v_cvt_pk_bf16_f32 v76, v80, v81
    v_cvt_pk_bf16_f32 v77, v82, v83
    v_cvt_pk_bf16_f32 v78, v84, v85
    v_cvt_pk_bf16_f32 v79, v86, v87
    buffer_store_dwordx4 v[76:79], v1, s[24:27], s47 offen offset:1024 sc1
    s_lshl_b32 s63, s29, 1
    s_sub_u32 s63, 14, s63
    s_cmp_eq_u32 s63, 0
    s_cbranch_scc1 k2_sdone_72
k2_sloop_71:
    v_mfma_f32_16x16x32_bf16 v[248:251], v[60:63], v[192:195], v[248:251]
    ds_read_b128 a[224:227], v3 offset:8192
    v_mfma_f32_16x16x32_bf16 v[252:255], v[60:63], v[196:199], v[252:255]
    s_mov_b32 m0, s35
    v_exp_f32 v232, v160
    v_mfma_f32_16x16x32_bf16 v[248:251], v[60:63], v[200:203], v[248:251]
    s_add_u32 s53, s53, 16384
    buffer_load_dwordx4 v1, s[20:23], s33 offen offset:0 sc1 lds
    ds_read_b128 a[228:231], v3 offset:9216
    v_mfma_f32_16x16x32_bf16 v[252:255], v[60:63], v[204:207], v[252:255]
    s_waitcnt lgkmcnt(8)
    v_exp_f32 v233, v161
    v_mfma_f32_16x16x32_bf16 a[8:11], a[192:195], v[192:195], a[8:11]
    s_and_b32 s53, s53, 0xffff
    ds_read_b128 a[232:235], v3 offset:10240
    v_cvt_pk_bf16_f32 v208, v232, v233
    v_mfma_f32_16x16x32_bf16 a[12:15], a[192:195], v[196:199], a[12:15]
    v_exp_f32 v234, v162
    v_mfma_f32_16x16x32_bf16 a[24:27], a[196:199], v[192:195], a[24:27]
    ds_read_b128 a[236:239], v3 offset:11264
    v_mfma_f32_16x16x32_bf16 a[28:31], a[196:199], v[196:199], a[28:31]
    s_waitcnt lgkmcnt(8)
    v_exp_f32 v235, v163
    v_mfma_f32_16x16x32_bf16 a[40:43], a[200:203], v[192:195], a[40:43]
    s_add_u32 s35, s35, 0x4000
    ds_read_b128 a[240:243], v3 offset:12288
    v_cvt_pk_bf16_f32 v209, v234, v235
    v_mfma_f32_16x16x32_bf16 a[44:47], a[200:203], v[196:199], a[44:47]
    v_exp_f32 v236, v176
    v_mfma_f32_16x16x32_bf16 a[56:59], a[204:207], v[192:195], a[56:59]
    buffer_load_dwordx4 v1, s[20:23], s33 offen offset:1024 sc1 lds
    ds_read_b128 a[244:247], v3 offset:13312
    v_mfma_f32_16x16x32_bf16 a[60:63], a[204:207], v[196:199], a[60:63]
    s_waitcnt lgkmcnt(8)
    v_exp_f32 v237, v177
    v_mfma_f32_16x16x32_bf16 a[72:75], a[208:211], v[192:195], a[72:75]
    ds_read_b128 a[248:251], v3 offset:14336
    v_cvt_pk_bf16_f32 v210, v236, v237
    v_mfma_f32_16x16x32_bf16 a[76:79], a[208:211], v[196:199], a[76:79]
    v_exp_f32 v238, v178
    v_mfma_f32_16x16x32_bf16 a[88:91], a[212:215], v[192:195], a[88:91]
    ds_read_b128 a[252:255], v3 offset:15360
    v_or3_b32 v57, v208, v209, v210
    v_mfma_f32_16x16x32_bf16 a[92:95], a[212:215], v[196:199], a[92:95]
    s_waitcnt lgkmcnt(8)
    v_exp_f32 v239, v179
    v_mfma_f32_16x16x32_bf16 a[104:107], a[216:219], v[192:195], a[104:107]
    s_and_b32 s35, s35, 0xffff
    v_exp_f32 v240, v164
    v_mfma_f32_16x16x32_bf16 a[108:111], a[216:219], v[196:199], a[108:111]
    ds_read_b128 a[128:131], v2 offset:0
    v_cvt_pk_bf16_f32 v211, v238, v239
    v_mfma_f32_16x16x32_bf16 a[120:123], a[220:223], v[192:195], a[120:123]
    v_exp_f32 v241, v165
    v_mfma_f32_16x16x32_bf16 a[124:127], a[220:223], v[196:199], a[124:127]
    s_waitcnt lgkmcnt(7)
    buffer_load_dwordx4 v1, s[20:23], s33 offen offset:2048 sc1 lds
    ds_read_b128 a[132:135], v2 offset:1024
    v_mfma_f32_16x16x32_bf16 a[8:11], a[224:227], v[200:203], a[8:11]
    v_add_u32 v3, s53, v56
    v_cvt_pk_bf16_f32 v212, v240, v241
    v_mfma_f32_16x16x32_bf16 a[12:15], a[224:227], v[204:207], a[12:15]
    s_or_b32 s35, s35, 0x10000
    v_exp_f32 v242, v166
    v_mfma_f32_16x16x32_bf16 a[24:27], a[228:231], v[200:203], a[24:27]
    ds_read_b128 a[136:139], v2 offset:2048
    v_or3_b32 v57, v57, v211, v212
    v_mfma_f32_16x16x32_bf16 a[28:31], a[228:231], v[204:207], a[28:31]
    s_waitcnt lgkmcnt(7)
    v_exp_f32 v243, v167
    v_mfma_f32_16x16x32_bf16 a[40:43], a[232:235], v[200:203], a[40:43]
    ds_read_b128 a[140:143], v2 offset:3072
    v_cvt_pk_bf16_f32 v213, v242, v243
    v_mfma_f32_16x16x32_bf16 a[44:47], a[232:235], v[204:207], a[44:47]
    s_cmp_ge_u32 s36, s43
    s_cbranch_scc1 k2_prep_73
k2_prepret_74:
    v_mfma_f32_16x16x32_bf16 a[56:59], a[236:239], v[200:203], a[56:59]
    v_exp_f32 v244, v180
    v_mfma_f32_16x16x32_bf16 a[60:63], a[236:239], v[204:207], a[60:63]
    s_waitcnt lgkmcnt(6)
    buffer_load_dwordx4 v1, s[20:23], s33 offen offset:3072 sc1 lds
    ds_read_b128 a[144:147], v2 offset:4096
    v_mfma_f32_16x16x32_bf16 a[72:75], a[240:243], v[200:203], a[72:75]
    s_add_u32 s33, s33, 0x80000
    v_exp_f32 v245, v181
    v_mfma_f32_16x16x32_bf16 a[76:79], a[240:243], v[204:207], a[76:79]
    ds_read_b128 a[148:151], v2 offset:5120
    v_cvt_pk_bf16_f32 v214, v244, v245
    v_mfma_f32_16x16x32_bf16 a[88:91], a[244:247], v[200:203], a[88:91]
    v_exp_f32 v246, v182
    v_mfma_f32_16x16x32_bf16 a[92:95], a[244:247], v[204:207], a[92:95]
    s_waitcnt lgkmcnt(6)
    ds_read_b128 a[152:155], v2 offset:6144
    v_or3_b32 v57, v57, v213, v214
    v_mfma_f32_16x16x32_bf16 a[104:107], a[248:251], v[200:203], a[104:107]
    v_exp_f32 v247, v183
    v_mfma_f32_16x16x32_bf16 a[108:111], a[248:251], v[204:207], a[108:111]
    ds_read_b128 a[156:159], v2 offset:7168
    v_cvt_pk_bf16_f32 v215, v246, v247
    v_mfma_f32_16x16x32_bf16 a[120:123], a[252:255], v[200:203], a[120:123]
    v_exp_f32 v232, v168
    v_mfma_f32_16x16x32_bf16 a[124:127], a[252:255], v[204:207], a[124:127]
    s_waitcnt lgkmcnt(6)
    ds_read_b128 a[160:163], v2 offset:8192
    ds_read_b128 a[164:167], v2 offset:9216
    v_mfma_f32_16x16x32_bf16 v[128:131], a[128:131], v[96:99], v[16:19]
    s_waitcnt vmcnt(12)
    s_barrier
    v_exp_f32 v233, v169
    v_mfma_f32_16x16x32_bf16 v[132:135], a[128:131], v[112:115], v[20:23]
    s_mov_b32 m0, s34
    v_exp_f32 v234, v170
    v_mfma_f32_16x16x32_bf16 v[128:131], a[132:135], v[100:103], v[128:131]
    ds_read_b128 a[168:171], v2 offset:10240
    v_cvt_pk_bf16_f32 v216, v232, v233
    v_mfma_f32_16x16x32_bf16 v[132:135], a[132:135], v[116:119], v[132:135]
    s_waitcnt lgkmcnt(7)
    buffer_load_dwordx4 v1, s[16:19], s32 offen offset:0 sc1 lds
    ds_read_b128 a[172:175], v2 offset:11264
    v_mfma_f32_16x16x32_bf16 v[128:131], a[136:139], v[104:107], v[128:131]
    s_add_u32 s36, s36, 64
    v_exp_f32 v235, v171
    v_mfma_f32_16x16x32_bf16 v[132:135], a[136:139], v[120:123], v[132:135]
    v_or3_b32 v57, v57, v215, v216
    v_cvt_pk_bf16_f32 v217, v234, v235
    v_mfma_f32_16x16x32_bf16 v[128:131], a[140:143], v[108:111], v[128:131]
    v_exp_f32 v236, v184
    v_mfma_f32_16x16x32_bf16 v[132:135], a[140:143], v[124:127], v[132:135]
    s_waitcnt lgkmcnt(6)
    ds_read_b128 a[176:179], v2 offset:12288
    ds_read_b128 a[180:183], v2 offset:13312
    v_mfma_f32_16x16x32_bf16 v[144:147], a[144:147], v[96:99], v[32:35]
    s_add_u32 s34, s34, 0x4000
    v_exp_f32 v237, v185
    v_mfma_f32_16x16x32_bf16 v[148:151], a[144:147], v[112:115], v[36:39]
    s_add_u32 s52, s52, 16384
    v_exp_f32 v238, v186
    v_mfma_f32_16x16x32_bf16 v[144:147], a[148:151], v[100:103], v[144:147]
    s_and_b32 s52, s52, 0xffff
    ds_read_b128 a[184:187], v2 offset:14336
    v_cvt_pk_bf16_f32 v218, v236, v237
    v_mfma_f32_16x16x32_bf16 v[148:151], a[148:151], v[116:119], v[148:151]
    s_waitcnt lgkmcnt(7)
    buffer_load_dwordx4 v1, s[16:19], s32 offen offset:1024 sc1 lds
    ds_read_b128 a[188:191], v2 offset:15360
    v_mfma_f32_16x16x32_bf16 v[144:147], a[152:155], v[104:107], v[144:147]
    v_exp_f32 v239, v187
    v_mfma_f32_16x16x32_bf16 v[148:151], a[152:155], v[120:123], v[148:151]
    v_or3_b32 v57, v57, v217, v218
    v_cvt_pk_bf16_f32 v219, v238, v239
    v_mfma_f32_16x16x32_bf16 v[144:147], a[156:159], v[108:111], v[144:147]
    s_and_b32 s34, s34, 0xffff
    v_exp_f32 v240, v172
    v_mfma_f32_16x16x32_bf16 v[148:151], a[156:159], v[124:127], v[148:151]
    s_waitcnt lgkmcnt(6)
    v_exp_f32 v241, v173
    v_mfma_f32_16x16x32_bf16 v[136:139], a[160:163], v[96:99], v[24:27]
    ds_read_b128 a[192:195], v3 offset:0
    v_cvt_pk_bf16_f32 v220, v240, v241
    v_mfma_f32_16x16x32_bf16 v[140:143], a[160:163], v[112:115], v[28:31]
    v_exp_f32 v242, v174
    v_mfma_f32_16x16x32_bf16 v[136:139], a[164:167], v[100:103], v[136:139]
    buffer_load_dwordx4 v1, s[16:19], s32 offen offset:2048 sc1 lds
    ds_read_b128 a[196:199], v3 offset:1024
    v_mfma_f32_16x16x32_bf16 v[140:143], a[164:167], v[116:119], v[140:143]
    s_waitcnt lgkmcnt(6)
    v_add_u32 v2, s52, v1
    v_or3_b32 v57, v57, v219, v220
    v_mfma_f32_16x16x32_bf16 v[136:139], a[168:171], v[104:107], v[136:139]
    v_exp_f32 v243, v175
    v_mfma_f32_16x16x32_bf16 v[140:143], a[168:171], v[120:123], v[140:143]
    ds_read_b128 a[200:203], v3 offset:2048
    v_cvt_pk_bf16_f32 v221, v242, v243
    v_mfma_f32_16x16x32_bf16 v[136:139], a[172:175], v[108:111], v[136:139]
    v_exp_f32 v244, v188
    v_mfma_f32_16x16x32_bf16 v[140:143], a[172:175], v[124:127], v[140:143]
    s_waitcnt lgkmcnt(5)
    ds_read_b128 a[204:207], v3 offset:3072
    ds_read_b128 a[208:211], v3 offset:4096
    v_mfma_f32_16x16x32_bf16 v[152:155], a[176:179], v[96:99], v[40:43]
    v_exp_f32 v245, v189
    v_mfma_f32_16x16x32_bf16 v[156:159], a[176:179], v[112:115], v[44:47]
    buffer_load_dwordx4 v1, s[16:19], s32 offen offset:3072 sc1 lds
    ds_read_b128 a[212:215], v3 offset:5120
    v_mfma_f32_16x16x32_bf16 v[152:155], a[180:183], v[100:103], v[152:155]
    s_add_u32 s32, s32, 0x80000
    v_exp_f32 v246, v190
    v_mfma_f32_16x16x32_bf16 v[156:159], a[180:183], v[116:119], v[156:159]
    s_waitcnt lgkmcnt(6)
    ds_read_b128 a[216:219], v3 offset:6144
    v_cvt_pk_bf16_f32 v222, v244, v245
    v_mfma_f32_16x16x32_bf16 v[152:155], a[184:187], v[104:107], v[152:155]
    v_exp_f32 v247, v191
    v_mfma_f32_16x16x32_bf16 v[156:159], a[184:187], v[120:123], v[156:159]
    ds_read_b128 a[220:223], v3 offset:7168
    v_or3_b32 v57, v57, v221, v222
    v_mfma_f32_16x16x32_bf16 v[152:155], a[188:191], v[108:111], v[152:155]
    v_cvt_pk_bf16_f32 v223, v246, v247
    v_bitop3_b32 v57, v57, v223, s37 bitop3:0xa8
    v_mfma_f32_16x16x32_bf16 v[156:159], a[188:191], v[124:127], v[156:159]
    v_cmp_ne_u32 vcc, 0, v57
    s_cbranch_vccnz k2_rare_75
k2_ret_76:
    v_mfma_f32_16x16x32_bf16 v[248:251], v[60:63], v[208:211], v[248:251]
    ds_read_b128 a[224:227], v3 offset:8192
    v_mfma_f32_16x16x32_bf16 v[252:255], v[60:63], v[212:215], v[252:255]
    s_mov_b32 m0, s35
    v_exp_f32 v232, v128
    v_mfma_f32_16x16x32_bf16 v[248:251], v[60:63], v[216:219], v[248:251]
    s_add_u32 s53, s53, 16384
    buffer_load_dwordx4 v1, s[20:23], s33 offen offset:0 sc1 lds
    ds_read_b128 a[228:231], v3 offset:9216
    v_mfma_f32_16x16x32_bf16 v[252:255], v[60:63], v[220:223], v[252:255]
    s_waitcnt lgkmcnt(8)
    v_exp_f32 v233, v129
    v_mfma_f32_16x16x32_bf16 a[8:11], a[192:195], v[208:211], a[8:11]
    s_and_b32 s53, s53, 0xffff
    ds_read_b128 a[232:235], v3 offset:10240
    v_cvt_pk_bf16_f32 v192, v232, v233
    v_mfma_f32_16x16x32_bf16 a[12:15], a[192:195], v[212:215], a[12:15]
    v_exp_f32 v234, v130
    v_mfma_f32_16x16x32_bf16 a[24:27], a[196:199], v[208:211], a[24:27]
    ds_read_b128 a[236:239], v3 offset:11264
    v_mfma_f32_16x16x32_bf16 a[28:31], a[196:199], v[212:215], a[28:31]
    s_waitcnt lgkmcnt(8)
    v_exp_f32 v235, v131
    v_mfma_f32_16x16x32_bf16 a[40:43], a[200:203], v[208:211], a[40:43]
    s_add_u32 s35, s35, 0x4000
    ds_read_b128 a[240:243], v3 offset:12288
    v_cvt_pk_bf16_f32 v193, v234, v235
    v_mfma_f32_16x16x32_bf16 a[44:47], a[200:203], v[212:215], a[44:47]
    v_exp_f32 v236, v144
    v_mfma_f32_16x16x32_bf16 a[56:59], a[204:207], v[208:211], a[56:59]
    buffer_load_dwordx4 v1, s[20:23], s33 offen offset:1024 sc1 lds
    ds_read_b128 a[244:247], v3 offset:13312
    v_mfma_f32_16x16x32_bf16 a[60:63], a[204:207], v[212:215], a[60:63]
    s_waitcnt lgkmcnt(8)
    v_exp_f32 v237, v145
    v_mfma_f32_16x16x32_bf16 a[72:75], a[208:211], v[208:211], a[72:75]
    ds_read_b128 a[248:251], v3 offset:14336
    v_cvt_pk_bf16_f32 v194, v236, v237
    v_mfma_f32_16x16x32_bf16 a[76:79], a[208:211], v[212:215], a[76:79]
    v_exp_f32 v238, v146
    v_mfma_f32_16x16x32_bf16 a[88:91], a[212:215], v[208:211], a[88:91]
    ds_read_b128 a[252:255], v3 offset:15360
    v_or3_b32 v57, v192, v193, v194
    v_mfma_f32_16x16x32_bf16 a[92:95], a[212:215], v[212:215], a[92:95]
    s_waitcnt lgkmcnt(8)
    v_exp_f32 v239, v147
    v_mfma_f32_16x16x32_bf16 a[104:107], a[216:219], v[208:211], a[104:107]
    s_and_b32 s35, s35, 0xffff
    v_exp_f32 v240, v132
    v_mfma_f32_16x16x32_bf16 a[108:111], a[216:219], v[212:215], a[108:111]
    ds_read_b128 a[128:131], v2 offset:0
    v_cvt_pk_bf16_f32 v195, v238, v239
    v_mfma_f32_16x16x32_bf16 a[120:123], a[220:223], v[208:211], a[120:123]
    v_exp_f32 v241, v133
    v_mfma_f32_16x16x32_bf16 a[124:127], a[220:223], v[212:215], a[124:127]
    s_waitcnt lgkmcnt(7)
    buffer_load_dwordx4 v1, s[20:23], s33 offen offset:2048 sc1 lds
    ds_read_b128 a[132:135], v2 offset:1024
    v_mfma_f32_16x16x32_bf16 a[8:11], a[224:227], v[216:219], a[8:11]
    v_add_u32 v3, s53, v56
    v_cvt_pk_bf16_f32 v196, v240, v241
    v_mfma_f32_16x16x32_bf16 a[12:15], a[224:227], v[220:223], a[12:15]
    s_or_b32 s35, s35, 0x10000
    v_exp_f32 v242, v134
    v_mfma_f32_16x16x32_bf16 a[24:27], a[228:231], v[216:219], a[24:27]
    ds_read_b128 a[136:139], v2 offset:2048
    v_or3_b32 v57, v57, v195, v196
    v_mfma_f32_16x16x32_bf16 a[28:31], a[228:231], v[220:223], a[28:31]
    s_waitcnt lgkmcnt(7)
    v_exp_f32 v243, v135
    v_mfma_f32_16x16x32_bf16 a[40:43], a[232:235], v[216:219], a[40:43]
    ds_read_b128 a[140:143], v2 offset:3072
    v_cvt_pk_bf16_f32 v197, v242, v243
    v_mfma_f32_16x16x32_bf16 a[44:47], a[232:235], v[220:223], a[44:47]
    s_cmp_ge_u32 s36, s43
    s_cbranch_scc1 k2_prep_77
k2_prepret_78:
    v_mfma_f32_16x16x32_bf16 a[56:59], a[236:239], v[216:219], a[56:59]
    v_exp_f32 v244, v148
    v_mfma_f32_16x16x32_bf16 a[60:63], a[236:239], v[220:223], a[60:63]
    s_waitcnt lgkmcnt(6)
    buffer_load_dwordx4 v1, s[20:23], s33 offen offset:3072 sc1 lds
    ds_read_b128 a[144:147], v2 offset:4096
    v_mfma_f32_16x16x32_bf16 a[72:75], a[240:243], v[216:219], a[72:75]
    s_add_u32 s33, s33, 0x80000
    v_exp_f32 v245, v149
    v_mfma_f32_16x16x32_bf16 a[76:79], a[240:243], v[220:223], a[76:79]
    ds_read_b128 a[148:151], v2 offset:5120
    v_cvt_pk_bf16_f32 v198, v244, v245
    v_mfma_f32_16x16x32_bf16 a[88:91], a[244:247], v[216:219], a[88:91]
    v_exp_f32 v246, v150
    v_mfma_f32_16x16x32_bf16 a[92:95], a[244:247], v[220:223], a[92:95]
    s_waitcnt lgkmcnt(6)
    ds_read_b128 a[152:155], v2 offset:6144
    v_or3_b32 v57, v57, v197, v198
    v_mfma_f32_16x16x32_bf16 a[104:107], a[248:251], v[216:219], a[104:107]
    v_exp_f32 v247, v151
    v_mfma_f32_16x16x32_bf16 a[108:111], a[248:251], v[220:223], a[108:111]
    ds_read_b128 a[156:159], v2 offset:7168
    v_cvt_pk_bf16_f32 v199, v246, v247
    v_mfma_f32_16x16x32_bf16 a[120:123], a[252:255], v[216:219], a[120:123]
    v_exp_f32 v232, v136
    v_mfma_f32_16x16x32_bf16 a[124:127], a[252:255], v[220:223], a[124:127]
    s_waitcnt lgkmcnt(6)
    ds_read_b128 a[160:163], v2 offset:8192
    ds_read_b128 a[164:167], v2 offset:9216
    v_mfma_f32_16x16x32_bf16 v[160:163], a[128:131], v[96:99], v[16:19]
    s_waitcnt vmcnt(12)
    s_barrier
    v_exp_f32 v233, v137
    v_mfma_f32_16x16x32_bf16 v[164:167], a[128:131], v[112:115], v[20:23]
    s_mov_b32 m0, s34
    v_exp_f32 v234, v138
    v_mfma_f32_16x16x32_bf16 v[160:163], a[132:135], v[100:103], v[160:163]
    ds_read_b128 a[168:171], v2 offset:10240
    v_cvt_pk_bf16_f32 v200, v232, v233
    v_mfma_f32_16x16x32_bf16 v[164:167], a[132:135], v[116:119], v[164:167]
    s_waitcnt lgkmcnt(7)
    buffer_load_dwordx4 v1, s[16:19], s32 offen offset:0 sc1 lds
    ds_read_b128 a[172:175], v2 offset:11264
    v_mfma_f32_16x16x32_bf16 v[160:163], a[136:139], v[104:107], v[160:163]
    s_add_u32 s36, s36, 64
    v_exp_f32 v235, v139
    v_mfma_f32_16x16x32_bf16 v[164:167], a[136:139], v[120:123], v[164:167]
    v_or3_b32 v57, v57, v199, v200
    v_cvt_pk_bf16_f32 v201, v234, v235
    v_mfma_f32_16x16x32_bf16 v[160:163], a[140:143], v[108:111], v[160:163]
    v_exp_f32 v236, v152
    v_mfma_f32_16x16x32_bf16 v[164:167], a[140:143], v[124:127], v[164:167]
    s_waitcnt lgkmcnt(6)
    ds_read_b128 a[176:179], v2 offset:12288
    ds_read_b128 a[180:183], v2 offset:13312
    v_mfma_f32_16x16x32_bf16 v[176:179], a[144:147], v[96:99], v[32:35]
    s_add_u32 s34, s34, 0x4000
    v_exp_f32 v237, v153
    v_mfma_f32_16x16x32_bf16 v[180:183], a[144:147], v[112:115], v[36:39]
    s_add_u32 s52, s52, 16384
    v_exp_f32 v238, v154
    v_mfma_f32_16x16x32_bf16 v[176:179], a[148:151], v[100:103], v[176:179]
    s_and_b32 s52, s52, 0xffff
    ds_read_b128 a[184:187], v2 offset:14336
    v_cvt_pk_bf16_f32 v202, v236, v237
    v_mfma_f32_16x16x32_bf16 v[180:183], a[148:151], v[116:119], v[180:183]
    s_waitcnt lgkmcnt(7)
    buffer_load_dwordx4 v1, s[16:19], s32 offen offset:1024 sc1 lds
    ds_read_b128 a[188:191], v2 offset:15360
    v_mfma_f32_16x16x32_bf16 v[176:179], a[152:155], v[104:107], v[176:179]
    v_exp_f32 v239, v155
    v_mfma_f32_16x16x32_bf16 v[180:183], a[152:155], v[120:123], v[180:183]
    v_or3_b32 v57, v57, v201, v202
    v_cvt_pk_bf16_f32 v203, v238, v239
    v_mfma_f32_16x16x32_bf16 v[176:179], a[156:159], v[108:111], v[176:179]
    s_and_b32 s34, s34, 0xffff
    v_exp_f32 v240, v140
    v_mfma_f32_16x16x32_bf16 v[180:183], a[156:159], v[124:127], v[180:183]
    s_waitcnt lgkmcnt(6)
    v_exp_f32 v241, v141
    v_mfma_f32_16x16x32_bf16 v[168:171], a[160:163], v[96:99], v[24:27]
    ds_read_b128 a[192:195], v3 offset:0
    v_cvt_pk_bf16_f32 v204, v240, v241
    v_mfma_f32_16x16x32_bf16 v[172:175], a[160:163], v[112:115], v[28:31]
    v_exp_f32 v242, v142
    v_mfma_f32_16x16x32_bf16 v[168:171], a[164:167], v[100:103], v[168:171]
    buffer_load_dwordx4 v1, s[16:19], s32 offen offset:2048 sc1 lds
    ds_read_b128 a[196:199], v3 offset:1024
    v_mfma_f32_16x16x32_bf16 v[172:175], a[164:167], v[116:119], v[172:175]
    s_waitcnt lgkmcnt(6)
    v_add_u32 v2, s52, v1
    v_or3_b32 v57, v57, v203, v204
    v_mfma_f32_16x16x32_bf16 v[168:171], a[168:171], v[104:107], v[168:171]
    v_exp_f32 v243, v143
    v_mfma_f32_16x16x32_bf16 v[172:175], a[168:171], v[120:123], v[172:175]
    ds_read_b128 a[200:203], v3 offset:2048
    v_cvt_pk_bf16_f32 v205, v242, v243
    v_mfma_f32_16x16x32_bf16 v[168:171], a[172:175], v[108:111], v[168:171]
    v_exp_f32 v244, v156
    v_mfma_f32_16x16x32_bf16 v[172:175], a[172:175], v[124:127], v[172:175]
    s_waitcnt lgkmcnt(5)
    ds_read_b128 a[204:207], v3 offset:3072
    ds_read_b128 a[208:211], v3 offset:4096
    v_mfma_f32_16x16x32_bf16 v[184:187], a[176:179], v[96:99], v[40:43]
    s_sub_u32 s63, s63, 1
    v_exp_f32 v245, v157
    v_mfma_f32_16x16x32_bf16 v[188:191], a[176:179], v[112:115], v[44:47]
    buffer_load_dwordx4 v1, s[16:19], s32 offen offset:3072 sc1 lds
    ds_read_b128 a[212:215], v3 offset:5120
    v_mfma_f32_16x16x32_bf16 v[184:187], a[180:183], v[100:103], v[184:187]
    s_add_u32 s32, s32, 0x80000
    v_exp_f32 v246, v158
    v_mfma_f32_16x16x32_bf16 v[188:191], a[180:183], v[116:119], v[188:191]
    s_waitcnt lgkmcnt(6)
    ds_read_b128 a[216:219], v3 offset:6144
    v_cvt_pk_bf16_f32 v206, v244, v245
    v_mfma_f32_16x16x32_bf16 v[184:187], a[184:187], v[104:107], v[184:187]
    v_exp_f32 v247, v159
    v_mfma_f32_16x16x32_bf16 v[188:191], a[184:187], v[120:123], v[188:191]
    ds_read_b128 a[220:223], v3 offset:7168
    v_or3_b32 v57, v57, v205, v206
    v_mfma_f32_16x16x32_bf16 v[184:187], a[188:191], v[108:111], v[184:187]
    v_cvt_pk_bf16_f32 v207, v246, v247
    v_bitop3_b32 v57, v57, v207, s37 bitop3:0xa8
    v_mfma_f32_16x16x32_bf16 v[188:191], a[188:191], v[124:127], v[188:191]
    v_cmp_ne_u32 vcc, 0, v57
    s_cbranch_vccnz k2_rare_79
k2_ret_80:
    s_cmp_lg_u32 s63, 0
    s_cbranch_scc1 k2_sloop_71
k2_sdone_72:
    v_mfma_f32_16x16x32_bf16 v[248:251], v[60:63], v[192:195], v[248:251]
    s_waitcnt vmcnt(0)
    s_barrier
    ds_read_b128 a[224:227], v3 offset:8192
    v_exp_f32 v232, v160
    v_mfma_f32_16x16x32_bf16 v[252:255], v[60:63], v[196:199], v[252:255]
    ds_read_b128 a[228:231], v3 offset:9216
    v_exp_f32 v233, v161
    v_mfma_f32_16x16x32_bf16 v[248:251], v[60:63], v[200:203], v[248:251]
    s_add_u32 s53, s53, 16384
    v_exp_f32 v234, v162
    v_cvt_pk_bf16_f32 v208, v232, v233
    v_mfma_f32_16x16x32_bf16 v[252:255], v[60:63], v[204:207], v[252:255]
    s_waitcnt lgkmcnt(8)
    ds_read_b128 a[232:235], v3 offset:10240
    v_exp_f32 v235, v163
    v_mfma_f32_16x16x32_bf16 a[8:11], a[192:195], v[192:195], a[8:11]
    s_and_b32 s53, s53, 0xffff
    v_exp_f32 v236, v176
    v_cvt_pk_bf16_f32 v209, v234, v235
    v_mfma_f32_16x16x32_bf16 a[12:15], a[192:195], v[196:199], a[12:15]
    ds_read_b128 a[236:239], v3 offset:11264
    v_exp_f32 v237, v177
    v_mfma_f32_16x16x32_bf16 a[24:27], a[196:199], v[192:195], a[24:27]
    v_exp_f32 v238, v178
    v_cvt_pk_bf16_f32 v210, v236, v237
    v_mfma_f32_16x16x32_bf16 a[28:31], a[196:199], v[196:199], a[28:31]
    s_waitcnt lgkmcnt(8)
    v_exp_f32 v239, v179
    v_or3_b32 v57, v208, v209, v210
    v_mfma_f32_16x16x32_bf16 a[40:43], a[200:203], v[192:195], a[40:43]
    ds_read_b128 a[240:243], v3 offset:12288
    v_exp_f32 v240, v164
    v_mfma_f32_16x16x32_bf16 a[44:47], a[200:203], v[196:199], a[44:47]
    v_cvt_pk_bf16_f32 v211, v238, v239
    v_exp_f32 v241, v165
    v_mfma_f32_16x16x32_bf16 a[56:59], a[204:207], v[192:195], a[56:59]
    ds_read_b128 a[244:247], v3 offset:13312
    v_exp_f32 v242, v166
    v_mfma_f32_16x16x32_bf16 a[60:63], a[204:207], v[196:199], a[60:63]
    s_waitcnt lgkmcnt(8)
    v_cvt_pk_bf16_f32 v212, v240, v241
    v_exp_f32 v243, v167
    v_mfma_f32_16x16x32_bf16 a[72:75], a[208:211], v[192:195], a[72:75]
    ds_read_b128 a[248:251], v3 offset:14336
    v_or3_b32 v57, v57, v211, v212
    v_cvt_pk_bf16_f32 v213, v242, v243
    v_mfma_f32_16x16x32_bf16 a[76:79], a[208:211], v[196:199], a[76:79]
    ds_read_b128 a[252:255], v3 offset:15360
    v_exp_f32 v244, v180
    v_mfma_f32_16x16x32_bf16 a[88:91], a[212:215], v[192:195], a[88:91]
    v_exp_f32 v245, v181
    v_mfma_f32_16x16x32_bf16 a[92:95], a[212:215], v[196:199], a[92:95]
    s_waitcnt lgkmcnt(8)
    v_exp_f32 v246, v182
    v_cvt_pk_bf16_f32 v214, v244, v245
    v_mfma_f32_16x16x32_bf16 a[104:107], a[216:219], v[192:195], a[104:107]
    v_exp_f32 v247, v183
    v_or3_b32 v57, v57, v213, v214
    v_mfma_f32_16x16x32_bf16 a[108:111], a[216:219], v[196:199], a[108:111]
    v_exp_f32 v232, v168
    v_cvt_pk_bf16_f32 v215, v246, v247
    v_mfma_f32_16x16x32_bf16 a[120:123], a[220:223], v[192:195], a[120:123]
    v_exp_f32 v233, v169
    v_mfma_f32_16x16x32_bf16 a[124:127], a[220:223], v[196:199], a[124:127]
    s_waitcnt lgkmcnt(6)
    v_exp_f32 v234, v170
    v_cvt_pk_bf16_f32 v216, v232, v233
    v_mfma_f32_16x16x32_bf16 a[8:11], a[224:227], v[200:203], a[8:11]
    v_exp_f32 v235, v171
    v_or3_b32 v57, v57, v215, v216
    v_mfma_f32_16x16x32_bf16 a[12:15], a[224:227], v[204:207], a[12:15]
    v_add_u32 v3, s53, v56
    ds_read_b128 a[192:195], v3 offset:0
    ds_read_b128 a[196:199], v3 offset:1024
    v_mfma_f32_16x16x32_bf16 a[24:27], a[228:231], v[200:203], a[24:27]
    v_exp_f32 v236, v184
    v_cvt_pk_bf16_f32 v217, v234, v235
    v_mfma_f32_16x16x32_bf16 a[28:31], a[228:231], v[204:207], a[28:31]
    s_waitcnt lgkmcnt(6)
    ds_read_b128 a[200:203], v3 offset:2048
    v_exp_f32 v237, v185
    v_mfma_f32_16x16x32_bf16 a[40:43], a[232:235], v[200:203], a[40:43]
    ds_read_b128 a[204:207], v3 offset:3072
    v_exp_f32 v238, v186
    v_mfma_f32_16x16x32_bf16 a[44:47], a[232:235], v[204:207], a[44:47]
    v_cvt_pk_bf16_f32 v218, v236, v237
    v_exp_f32 v239, v187
    v_mfma_f32_16x16x32_bf16 a[56:59], a[236:239], v[200:203], a[56:59]
    ds_read_b128 a[208:211], v3 offset:4096
    v_or3_b32 v57, v57, v217, v218
    v_cvt_pk_bf16_f32 v219, v238, v239
    v_mfma_f32_16x16x32_bf16 a[60:63], a[236:239], v[204:207], a[60:63]
    s_waitcnt lgkmcnt(7)
    ds_read_b128 a[212:215], v3 offset:5120
    v_exp_f32 v240, v172
    v_mfma_f32_16x16x32_bf16 a[72:75], a[240:243], v[200:203], a[72:75]
    ds_read_b128 a[216:219], v3 offset:6144
    v_exp_f32 v241, v173
    v_mfma_f32_16x16x32_bf16 a[76:79], a[240:243], v[204:207], a[76:79]
    v_exp_f32 v242, v174
    v_cvt_pk_bf16_f32 v220, v240, v241
    v_mfma_f32_16x16x32_bf16 a[88:91], a[244:247], v[200:203], a[88:91]
    v_exp_f32 v243, v175
    v_or3_b32 v57, v57, v219, v220
    v_mfma_f32_16x16x32_bf16 a[92:95], a[244:247], v[204:207], a[92:95]
    s_waitcnt lgkmcnt(7)
    ds_read_b128 a[220:223], v3 offset:7168
    v_exp_f32 v244, v188
    v_mfma_f32_16x16x32_bf16 a[104:107], a[248:251], v[200:203], a[104:107]
    ds_read_b128 a[224:227], v3 offset:8192
    ds_read_b128 a[228:231], v3 offset:9216
    v_cvt_pk_bf16_f32 v221, v242, v243
    v_mfma_f32_16x16x32_bf16 a[108:111], a[248:251], v[204:207], a[108:111]
    ds_read_b128 a[232:235], v3 offset:10240
    v_exp_f32 v245, v189
    v_mfma_f32_16x16x32_bf16 a[120:123], a[252:255], v[200:203], a[120:123]
    v_exp_f32 v246, v190
    v_cvt_pk_bf16_f32 v222, v244, v245
    v_mfma_f32_16x16x32_bf16 a[124:127], a[252:255], v[204:207], a[124:127]
    v_exp_f32 v247, v191
    v_or3_b32 v57, v57, v221, v222
    v_cvt_pk_bf16_f32 v223, v246, v247
    v_bitop3_b32 v57, v57, v223, s37 bitop3:0xa8
    ds_read_b128 a[236:239], v3 offset:11264
    v_cmp_ne_u32 vcc, 0, v57
    ds_read_b128 a[240:243], v3 offset:12288
    ds_read_b128 a[244:247], v3 offset:13312
    ds_read_b128 a[248:251], v3 offset:14336
    ds_read_b128 a[252:255], v3 offset:15360
    s_cbranch_vccnz k2_rare_81
k2_ret_82:
    v_lshrrev_b32 v6, 4, v1
    v_and_b32 v6, 31, v6
    s_getpc_b64 s[40:41]
pc_83:
    s_add_u32 s40, s40, k3_kernel-pc_83
    s_addc_u32 s41, s41, 0
    v_lshlrev_b32 v224, 7, v6
    v_mov_b32 v225, s41
    v_add_co_u32 v224, vcc, s40, v224
    s_nop 1
    v_addc_co_u32 v225, vcc, 0, v225, vcc
    global_load_dword v7, v[224:225], off
    v_mfma_f32_16x16x32_bf16 v[248:251], v[60:63], v[208:211], v[248:251]
    s_lshl_b32 s31, s28, 19
    v_mfma_f32_16x16x32_bf16 v[252:255], v[60:63], v[212:215], v[252:255]
    s_lshl_b32 s44, s39, 6
    v_mfma_f32_16x16x32_bf16 v[248:251], v[60:63], v[216:219], v[248:251]
    s_add_u32 s44, s44, s31
    v_mfma_f32_16x16x32_bf16 v[252:255], v[60:63], v[220:223], v[252:255]
    s_waitcnt lgkmcnt(0)
    v_mfma_f32_16x16x32_bf16 a[8:11], a[192:195], v[208:211], a[8:11]
    s_add_u32 s45, s44, 131072
    v_mfma_f32_16x16x32_bf16 a[12:15], a[192:195], v[212:215], a[12:15]
    s_add_u32 s46, s44, 262144
    v_mfma_f32_16x16x32_bf16 a[8:11], a[224:227], v[216:219], a[8:11]
    s_add_u32 s47, s44, 393216
    v_mfma_f32_16x16x32_bf16 a[12:15], a[224:227], v[220:223], a[12:15]
    v_mfma_f32_16x16x32_bf16 a[24:27], a[196:199], v[208:211], a[24:27]
    v_mov_b32 v249, v248
    v_mov_b32 v253, v252
    s_nop 1
    v_mfma_f32_16x16x32_bf16 a[28:31], a[196:199], v[212:215], a[28:31]
    v_permlane16_swap_b32 v248, v249
    v_permlane16_swap_b32 v252, v253
    s_nop 1
    v_mfma_f32_16x16x32_bf16 a[24:27], a[228:231], v[216:219], a[24:27]
    v_add_f32 v248, v248, v249
    v_add_f32 v252, v252, v253
    v_mov_b32 v249, v248
    v_mfma_f32_16x16x32_bf16 a[28:31], a[228:231], v[220:223], a[28:31]
    v_mov_b32 v253, v252
    s_nop 1
    v_permlane32_swap_b32 v248, v249
    v_mfma_f32_16x16x32_bf16 a[40:43], a[200:203], v[208:211], a[40:43]
    v_permlane32_swap_b32 v252, v253
    s_nop 1
    v_add_f32 v248, v248, v249
    v_mfma_f32_16x16x32_bf16 a[44:47], a[200:203], v[212:215], a[44:47]
    v_add_f32 v252, v252, v253
    v_rcp_f32 v249, v248
    v_rcp_f32 v253, v252
    v_mfma_f32_16x16x32_bf16 a[40:43], a[232:235], v[216:219], a[40:43]
    v_rcp_f32 v248, v248
    v_rcp_f32 v252, v252
    s_nop 0
    v_mfma_f32_16x16x32_bf16 a[44:47], a[232:235], v[220:223], a[44:47]
    v_accvgpr_read_b32 v132, a8
    v_accvgpr_read_b32 v144, a12
    v_accvgpr_read_b32 v133, a9
    v_mfma_f32_16x16x32_bf16 a[56:59], a[204:207], v[208:211], a[56:59]
    v_accvgpr_read_b32 v145, a13
    v_accvgpr_read_b32 v134, a10
    v_accvgpr_read_b32 v146, a14
    v_mfma_f32_16x16x32_bf16 a[60:63], a[204:207], v[212:215], a[60:63]
    v_accvgpr_read_b32 v135, a11
    v_accvgpr_read_b32 v147, a15
    v_accvgpr_read_b32 v136, a24
    v_mfma_f32_16x16x32_bf16 a[56:59], a[236:239], v[216:219], a[56:59]
    v_accvgpr_read_b32 v148, a28
    v_accvgpr_read_b32 v137, a25
    v_accvgpr_read_b32 v149, a29
    v_mfma_f32_16x16x32_bf16 a[60:63], a[236:239], v[220:223], a[60:63]
    v_accvgpr_read_b32 v138, a26
    v_accvgpr_read_b32 v150, a30
    v_accvgpr_read_b32 v139, a27
    v_mfma_f32_16x16x32_bf16 a[72:75], a[208:211], v[208:211], a[72:75]
    v_accvgpr_read_b32 v151, a31
    v_mul_f32 v132, v132, v248
    v_mul_f32 v144, v144, v252
    v_mfma_f32_16x16x32_bf16 a[76:79], a[208:211], v[212:215], a[76:79]
    v_mul_f32 v133, v133, v248
    v_mul_f32 v145, v145, v252
    v_mul_f32 v134, v134, v248
    v_mfma_f32_16x16x32_bf16 a[72:75], a[240:243], v[216:219], a[72:75]
    v_mul_f32 v146, v146, v252
    v_mul_f32 v135, v135, v248
    v_mul_f32 v147, v147, v252
    v_mfma_f32_16x16x32_bf16 a[76:79], a[240:243], v[220:223], a[76:79]
    v_mul_f32 v136, v136, v248
    v_mul_f32 v148, v148, v252
    v_mul_f32 v137, v137, v248
    v_mfma_f32_16x16x32_bf16 a[88:91], a[212:215], v[208:211], a[88:91]
    v_mul_f32 v149, v149, v252
    v_mul_f32 v138, v138, v248
    v_mul_f32 v150, v150, v252
    v_mfma_f32_16x16x32_bf16 a[92:95], a[212:215], v[212:215], a[92:95]
    v_mul_f32 v139, v139, v248
    v_mul_f32 v151, v151, v252
    v_cvt_pk_bf16_f32 v128, v132, v133
    v_mfma_f32_16x16x32_bf16 a[88:91], a[244:247], v[216:219], a[88:91]
    v_cvt_pk_bf16_f32 v140, v144, v145
    v_cvt_pk_bf16_f32 v129, v134, v135
    v_cvt_pk_bf16_f32 v141, v146, v147
    v_mfma_f32_16x16x32_bf16 a[92:95], a[244:247], v[220:223], a[92:95]
    v_cvt_pk_bf16_f32 v130, v136, v137
    v_cvt_pk_bf16_f32 v142, v148, v149
    v_cvt_pk_bf16_f32 v131, v138, v139
    v_mfma_f32_16x16x32_bf16 a[104:107], a[216:219], v[208:211], a[104:107]
    buffer_store_dwordx4 v[128:131], v1, s[24:27], s44 offen offset:0 sc1
    v_cvt_pk_bf16_f32 v143, v150, v151
    buffer_store_dwordx4 v[140:143], v1, s[24:27], s44 offen offset:1024 sc1
    v_mfma_f32_16x16x32_bf16 a[108:111], a[216:219], v[212:215], a[108:111]
    v_accvgpr_read_b32 v156, a40
    v_accvgpr_read_b32 v168, a44
    v_accvgpr_read_b32 v157, a41
    v_mfma_f32_16x16x32_bf16 a[104:107], a[248:251], v[216:219], a[104:107]
    v_accvgpr_read_b32 v169, a45
    v_accvgpr_read_b32 v158, a42
    v_accvgpr_read_b32 v170, a46
    v_mfma_f32_16x16x32_bf16 a[108:111], a[248:251], v[220:223], a[108:111]
    v_accvgpr_read_b32 v159, a43
    v_accvgpr_read_b32 v171, a47
    v_accvgpr_read_b32 v160, a56
    v_mfma_f32_16x16x32_bf16 a[120:123], a[220:223], v[208:211], a[120:123]
    v_accvgpr_read_b32 v172, a60
    v_accvgpr_read_b32 v161, a57
    v_accvgpr_read_b32 v173, a61
    v_mfma_f32_16x16x32_bf16 a[124:127], a[220:223], v[212:215], a[124:127]
    v_accvgpr_read_b32 v162, a58
    v_accvgpr_read_b32 v174, a62
    v_accvgpr_read_b32 v163, a59
    v_mfma_f32_16x16x32_bf16 a[120:123], a[252:255], v[216:219], a[120:123]
    v_accvgpr_read_b32 v175, a63
    v_mul_f32 v156, v156, v248
    v_mul_f32 v168, v168, v252
    v_mfma_f32_16x16x32_bf16 a[124:127], a[252:255], v[220:223], a[124:127]
    v_mul_f32 v157, v157, v248
    v_mul_f32 v169, v169, v252
    v_mul_f32 v158, v158, v248
    v_mul_f32 v170, v170, v252
    v_mul_f32 v159, v159, v248
    v_mul_f32 v171, v171, v252
    v_mul_f32 v160, v160, v248
    v_mul_f32 v172, v172, v252
    v_mul_f32 v161, v161, v248
    v_mul_f32 v173, v173, v252
    v_mul_f32 v162, v162, v248
    v_mul_f32 v174, v174, v252
    v_mul_f32 v163, v163, v248
    v_mul_f32 v175, v175, v252
    v_cvt_pk_bf16_f32 v152, v156, v157
    v_cvt_pk_bf16_f32 v164, v168, v169
    v_cvt_pk_bf16_f32 v153, v158, v159
    v_cvt_pk_bf16_f32 v165, v170, v171
    v_cvt_pk_bf16_f32 v154, v160, v161
    v_cvt_pk_bf16_f32 v166, v172, v173
    v_cvt_pk_bf16_f32 v155, v162, v163
    v_cvt_pk_bf16_f32 v167, v174, v175
    buffer_store_dwordx4 v[152:155], v1, s[24:27], s45 offen offset:0 sc1
    buffer_store_dwordx4 v[164:167], v1, s[24:27], s45 offen offset:1024 sc1
    v_accvgpr_read_b32 v132, a72
    v_accvgpr_read_b32 v144, a76
    v_accvgpr_read_b32 v133, a73
    v_accvgpr_read_b32 v145, a77
    v_accvgpr_read_b32 v134, a74
    v_accvgpr_read_b32 v146, a78
    v_accvgpr_read_b32 v135, a75
    v_accvgpr_read_b32 v147, a79
    v_accvgpr_read_b32 v136, a88
    v_accvgpr_read_b32 v148, a92
    v_accvgpr_read_b32 v137, a89
    v_accvgpr_read_b32 v149, a93
    v_accvgpr_read_b32 v138, a90
    v_accvgpr_read_b32 v150, a94
    v_accvgpr_read_b32 v139, a91
    v_accvgpr_read_b32 v151, a95
    v_mul_f32 v132, v132, v248
    v_mul_f32 v144, v144, v252
    v_mul_f32 v133, v133, v248
    v_mul_f32 v145, v145, v252
    v_mul_f32 v134, v134, v248
    v_mul_f32 v146, v146, v252
    v_mul_f32 v135, v135, v248
    v_mul_f32 v147, v147, v252
    v_mul_f32 v136, v136, v248
    v_mul_f32 v148, v148, v252
    v_mul_f32 v137, v137, v248
    v_mul_f32 v149, v149, v252
    v_mul_f32 v138, v138, v248
    v_mul_f32 v150, v150, v252
    v_mul_f32 v139, v139, v248
    v_mul_f32 v151, v151, v252
    v_cvt_pk_bf16_f32 v128, v132, v133
    v_cvt_pk_bf16_f32 v140, v144, v145
    v_cvt_pk_bf16_f32 v129, v134, v135
    v_cvt_pk_bf16_f32 v141, v146, v147
    v_cvt_pk_bf16_f32 v130, v136, v137
    v_cvt_pk_bf16_f32 v142, v148, v149
    v_cvt_pk_bf16_f32 v131, v138, v139
    v_cvt_pk_bf16_f32 v143, v150, v151
    buffer_store_dwordx4 v[128:131], v1, s[24:27], s46 offen offset:0 sc1
    buffer_store_dwordx4 v[140:143], v1, s[24:27], s46 offen offset:1024 sc1
    v_accvgpr_read_b32 v156, a104
    v_accvgpr_read_b32 v168, a108
    v_accvgpr_read_b32 v157, a105
    v_accvgpr_read_b32 v169, a109
    v_accvgpr_read_b32 v158, a106
    v_accvgpr_read_b32 v170, a110
    v_accvgpr_read_b32 v159, a107
    v_accvgpr_read_b32 v171, a111
    v_accvgpr_read_b32 v160, a120
    v_accvgpr_read_b32 v172, a124
    v_accvgpr_read_b32 v161, a121
    v_accvgpr_read_b32 v173, a125
    v_accvgpr_read_b32 v162, a122
    v_accvgpr_read_b32 v174, a126
    v_accvgpr_read_b32 v163, a123
    v_accvgpr_read_b32 v175, a127
    v_mul_f32 v156, v156, v248
    v_mul_f32 v168, v168, v252
    v_mul_f32 v157, v157, v248
    v_mul_f32 v169, v169, v252
    v_mul_f32 v158, v158, v248
    v_mul_f32 v170, v170, v252
    v_mul_f32 v159, v159, v248
    v_mul_f32 v171, v171, v252
    v_mul_f32 v160, v160, v248
    v_mul_f32 v172, v172, v252
    v_mul_f32 v161, v161, v248
    v_mul_f32 v173, v173, v252
    v_mul_f32 v162, v162, v248
    v_mul_f32 v174, v174, v252
    v_mul_f32 v163, v163, v248
    v_mul_f32 v175, v175, v252
    v_cvt_pk_bf16_f32 v152, v156, v157
    v_cvt_pk_bf16_f32 v164, v168, v169
    v_cvt_pk_bf16_f32 v153, v158, v159
    v_cvt_pk_bf16_f32 v165, v170, v171
    v_cvt_pk_bf16_f32 v154, v160, v161
    v_cvt_pk_bf16_f32 v166, v172, v173
    v_cvt_pk_bf16_f32 v155, v162, v163
    v_cvt_pk_bf16_f32 v167, v174, v175
    buffer_store_dwordx4 v[152:155], v1, s[24:27], s47 offen offset:0 sc1
    buffer_store_dwordx4 v[164:167], v1, s[24:27], s47 offen offset:1024 sc1
k12_end_1:
    s_endpgm
k2_prep_48:
    s_sub_u32 s40, s36, s38
    v_subrev_u32 v6, s40, v4
    v_cmp_gt_i32 s[44:45], -16, v6
    v_cmp_gt_i32 s[46:47], -15, v6
    v_cmp_gt_i32 s[48:49], -14, v6
    v_cmp_gt_i32 s[50:51], -13, v6
    s_nop 1
    v_cndmask_b32 v20, v9, v5, s[44:45]
    v_cndmask_b32 v21, v9, v5, s[46:47]
    v_cndmask_b32 v22, v9, v5, s[48:49]
    v_cndmask_b32 v23, v9, v5, s[50:51]
    v_cmp_gt_i32 s[44:45], 0, v6
    v_cmp_gt_i32 s[46:47], 1, v6
    v_cmp_gt_i32 s[48:49], 2, v6
    v_cmp_gt_i32 s[50:51], 3, v6
    s_nop 1
    v_cndmask_b32 v16, v8, v5, s[44:45]
    v_cndmask_b32 v17, v8, v5, s[46:47]
    v_cndmask_b32 v18, v8, v5, s[48:49]
    v_cndmask_b32 v19, v8, v5, s[50:51]
    v_cndmask_b32 v36, v9, v5, s[44:45]
    v_cndmask_b32 v37, v9, v5, s[46:47]
    v_cndmask_b32 v38, v9, v5, s[48:49]
    v_cndmask_b32 v39, v9, v5, s[50:51]
    v_cmp_gt_i32 s[44:45], 16, v6
    v_cmp_gt_i32 s[46:47], 17, v6
    v_cmp_gt_i32 s[48:49], 18, v6
    v_cmp_gt_i32 s[50:51], 19, v6
    s_nop 1
    v_cndmask_b32 v32, v8, v5, s[44:45]
    v_cndmask_b32 v33, v8, v5, s[46:47]
    v_cndmask_b32 v34, v8, v5, s[48:49]
    v_cndmask_b32 v35, v8, v5, s[50:51]
    s_nop 1
    s_branch k2_prepret_49
k2_prep_50:
    s_sub_u32 s40, s36, s38
    v_subrev_u32 v6, s40, v4
    v_cmp_gt_i32 s[44:45], -16, v6
    v_cmp_gt_i32 s[46:47], -15, v6
    v_cmp_gt_i32 s[48:49], -14, v6
    v_cmp_gt_i32 s[50:51], -13, v6
    s_nop 1
    v_cndmask_b32 v20, v9, v5, s[44:45]
    v_cndmask_b32 v21, v9, v5, s[46:47]
    v_cndmask_b32 v22, v9, v5, s[48:49]
    v_cndmask_b32 v23, v9, v5, s[50:51]
    v_cmp_gt_i32 s[44:45], 0, v6
    v_cmp_gt_i32 s[46:47], 1, v6
    v_cmp_gt_i32 s[48:49], 2, v6
    v_cmp_gt_i32 s[50:51], 3, v6
    s_nop 1
    v_cndmask_b32 v16, v8, v5, s[44:45]
    v_cndmask_b32 v17, v8, v5, s[46:47]
    v_cndmask_b32 v18, v8, v5, s[48:49]
    v_cndmask_b32 v19, v8, v5, s[50:51]
    v_cndmask_b32 v36, v9, v5, s[44:45]
    v_cndmask_b32 v37, v9, v5, s[46:47]
    v_cndmask_b32 v38, v9, v5, s[48:49]
    v_cndmask_b32 v39, v9, v5, s[50:51]
    v_cmp_gt_i32 s[44:45], 16, v6
    v_cmp_gt_i32 s[46:47], 17, v6
    v_cmp_gt_i32 s[48:49], 18, v6
    v_cmp_gt_i32 s[50:51], 19, v6
    s_nop 1
    v_cndmask_b32 v32, v8, v5, s[44:45]
    v_cndmask_b32 v33, v8, v5, s[46:47]
    v_cndmask_b32 v34, v8, v5, s[48:49]
    v_cndmask_b32 v35, v8, v5, s[50:51]
    s_nop 1
    s_branch k2_prepret_51
k2_prep_55:
    s_sub_u32 s40, s36, s38
    v_subrev_u32 v6, s40, v4
    v_cmp_gt_i32 s[44:45], -16, v6
    v_cmp_gt_i32 s[46:47], -15, v6
    v_cmp_gt_i32 s[48:49], -14, v6
    v_cmp_gt_i32 s[50:51], -13, v6
    s_nop 1
    v_cndmask_b32 v20, v9, v5, s[44:45]
    v_cndmask_b32 v21, v9, v5, s[46:47]
    v_cndmask_b32 v22, v9, v5, s[48:49]
    v_cndmask_b32 v23, v9, v5, s[50:51]
    v_cmp_gt_i32 s[44:45], 0, v6
    v_cmp_gt_i32 s[46:47], 1, v6
    v_cmp_gt_i32 s[48:49], 2, v6
    v_cmp_gt_i32 s[50:51], 3, v6
    s_nop 1
    v_cndmask_b32 v16, v8, v5, s[44:45]
    v_cndmask_b32 v17, v8, v5, s[46:47]
    v_cndmask_b32 v18, v8, v5, s[48:49]
    v_cndmask_b32 v19, v8, v5, s[50:51]
    v_cndmask_b32 v36, v9, v5, s[44:45]
    v_cndmask_b32 v37, v9, v5, s[46:47]
    v_cndmask_b32 v38, v9, v5, s[48:49]
    v_cndmask_b32 v39, v9, v5, s[50:51]
    v_cmp_gt_i32 s[44:45], 16, v6
    v_cmp_gt_i32 s[46:47], 17, v6
    v_cmp_gt_i32 s[48:49], 18, v6
    v_cmp_gt_i32 s[50:51], 19, v6
    s_nop 1
    v_cndmask_b32 v32, v8, v5, s[44:45]
    v_cndmask_b32 v33, v8, v5, s[46:47]
    v_cndmask_b32 v34, v8, v5, s[48:49]
    v_cndmask_b32 v35, v8, v5, s[50:51]
    s_nop 1
    s_branch k2_prepret_56
k2_prep_59:
    s_sub_u32 s40, s36, s38
    v_subrev_u32 v6, s40, v4
    v_cmp_gt_i32 s[44:45], -16, v6
    v_cmp_gt_i32 s[46:47], -15, v6
    v_cmp_gt_i32 s[48:49], -14, v6
    v_cmp_gt_i32 s[50:51], -13, v6
    s_nop 1
    v_cndmask_b32 v20, v9, v5, s[44:45]
    v_cndmask_b32 v21, v9, v5, s[46:47]
    v_cndmask_b32 v22, v9, v5, s[48:49]
    v_cndmask_b32 v23, v9, v5, s[50:51]
    v_cmp_gt_i32 s[44:45], 0, v6
    v_cmp_gt_i32 s[46:47], 1, v6
    v_cmp_gt_i32 s[48:49], 2, v6
    v_cmp_gt_i32 s[50:51], 3, v6
    s_nop 1
    v_cndmask_b32 v16, v8, v5, s[44:45]
    v_cndmask_b32 v17, v8, v5, s[46:47]
    v_cndmask_b32 v18, v8, v5, s[48:49]
    v_cndmask_b32 v19, v8, v5, s[50:51]
    v_cndmask_b32 v36, v9, v5, s[44:45]
    v_cndmask_b32 v37, v9, v5, s[46:47]
    v_cndmask_b32 v38, v9, v5, s[48:49]
    v_cndmask_b32 v39, v9, v5, s[50:51]
    v_cmp_gt_i32 s[44:45], 16, v6
    v_cmp_gt_i32 s[46:47], 17, v6
    v_cmp_gt_i32 s[48:49], 18, v6
    v_cmp_gt_i32 s[50:51], 19, v6
    s_nop 1
    v_cndmask_b32 v32, v8, v5, s[44:45]
    v_cndmask_b32 v33, v8, v5, s[46:47]
    v_cndmask_b32 v34, v8, v5, s[48:49]
    v_cndmask_b32 v35, v8, v5, s[50:51]
    s_nop 1
    s_branch k2_prepret_60
k2_prep_63:
    s_sub_u32 s40, s36, s39
    v_subrev_u32 v6, s40, v4
    v_cmp_gt_i32 s[44:45], -16, v6
    v_cmp_gt_i32 s[46:47], -15, v6
    v_cmp_gt_i32 s[48:49], -14, v6
    v_cmp_gt_i32 s[50:51], -13, v6
    s_nop 1
    v_cndmask_b32 v20, v11, v5, s[44:45]
    v_cndmask_b32 v21, v11, v5, s[46:47]
    v_cndmask_b32 v22, v11, v5, s[48:49]
    v_cndmask_b32 v23, v11, v5, s[50:51]
    v_cmp_gt_i32 s[44:45], 0, v6
    v_cmp_gt_i32 s[46:47], 1, v6
    v_cmp_gt_i32 s[48:49], 2, v6
    v_cmp_gt_i32 s[50:51], 3, v6
    s_nop 1
    v_cndmask_b32 v16, v10, v5, s[44:45]
    v_cndmask_b32 v17, v10, v5, s[46:47]
    v_cndmask_b32 v18, v10, v5, s[48:49]
    v_cndmask_b32 v19, v10, v5, s[50:51]
    v_cndmask_b32 v36, v11, v5, s[44:45]
    v_cndmask_b32 v37, v11, v5, s[46:47]
    v_cndmask_b32 v38, v11, v5, s[48:49]
    v_cndmask_b32 v39, v11, v5, s[50:51]
    v_cmp_gt_i32 s[44:45], 16, v6
    v_cmp_gt_i32 s[46:47], 17, v6
    v_cmp_gt_i32 s[48:49], 18, v6
    v_cmp_gt_i32 s[50:51], 19, v6
    s_nop 1
    v_cndmask_b32 v32, v10, v5, s[44:45]
    v_cndmask_b32 v33, v10, v5, s[46:47]
    v_cndmask_b32 v34, v10, v5, s[48:49]
    v_cndmask_b32 v35, v10, v5, s[50:51]
    v_cndmask_b32 v28, v11, v5, s[44:45]
    v_cndmask_b32 v29, v11, v5, s[46:47]
    v_cndmask_b32 v30, v11, v5, s[48:49]
    v_cndmask_b32 v31, v11, v5, s[50:51]
    v_cmp_gt_i32 s[44:45], 32, v6
    v_cmp_gt_i32 s[46:47], 33, v6
    v_cmp_gt_i32 s[48:49], 34, v6
    v_cmp_gt_i32 s[50:51], 35, v6
    s_nop 1
    v_cndmask_b32 v24, v10, v5, s[44:45]
    v_cndmask_b32 v25, v10, v5, s[46:47]
    v_cndmask_b32 v26, v10, v5, s[48:49]
    v_cndmask_b32 v27, v10, v5, s[50:51]
    v_cndmask_b32 v44, v11, v5, s[44:45]
    v_cndmask_b32 v45, v11, v5, s[46:47]
    v_cndmask_b32 v46, v11, v5, s[48:49]
    v_cndmask_b32 v47, v11, v5, s[50:51]
    v_cmp_gt_i32 s[44:45], 48, v6
    v_cmp_gt_i32 s[46:47], 49, v6
    v_cmp_gt_i32 s[48:49], 50, v6
    v_cmp_gt_i32 s[50:51], 51, v6
    s_nop 1
    v_cndmask_b32 v40, v10, v5, s[44:45]
    v_cndmask_b32 v41, v10, v5, s[46:47]
    v_cndmask_b32 v42, v10, v5, s[48:49]
    v_cndmask_b32 v43, v10, v5, s[50:51]
    s_nop 1
    s_branch k2_prepret_64
k2_prep_67:
    s_sub_u32 s40, s36, s39
    v_subrev_u32 v6, s40, v4
    v_cmp_gt_i32 s[44:45], -16, v6
    v_cmp_gt_i32 s[46:47], -15, v6
    v_cmp_gt_i32 s[48:49], -14, v6
    v_cmp_gt_i32 s[50:51], -13, v6
    s_nop 1
    v_cndmask_b32 v20, v11, v5, s[44:45]
    v_cndmask_b32 v21, v11, v5, s[46:47]
    v_cndmask_b32 v22, v11, v5, s[48:49]
    v_cndmask_b32 v23, v11, v5, s[50:51]
    v_cmp_gt_i32 s[44:45], 0, v6
    v_cmp_gt_i32 s[46:47], 1, v6
    v_cmp_gt_i32 s[48:49], 2, v6
    v_cmp_gt_i32 s[50:51], 3, v6
    s_nop 1
    v_cndmask_b32 v16, v10, v5, s[44:45]
    v_cndmask_b32 v17, v10, v5, s[46:47]
    v_cndmask_b32 v18, v10, v5, s[48:49]
    v_cndmask_b32 v19, v10, v5, s[50:51]
    v_cndmask_b32 v36, v11, v5, s[44:45]
    v_cndmask_b32 v37, v11, v5, s[46:47]
    v_cndmask_b32 v38, v11, v5, s[48:49]
    v_cndmask_b32 v39, v11, v5, s[50:51]
    v_cmp_gt_i32 s[44:45], 16, v6
    v_cmp_gt_i32 s[46:47], 17, v6
    v_cmp_gt_i32 s[48:49], 18, v6
    v_cmp_gt_i32 s[50:51], 19, v6
    s_nop 1
    v_cndmask_b32 v32, v10, v5, s[44:45]
    v_cndmask_b32 v33, v10, v5, s[46:47]
    v_cndmask_b32 v34, v10, v5, s[48:49]
    v_cndmask_b32 v35, v10, v5, s[50:51]
    v_cndmask_b32 v28, v11, v5, s[44:45]
    v_cndmask_b32 v29, v11, v5, s[46:47]
    v_cndmask_b32 v30, v11, v5, s[48:49]
    v_cndmask_b32 v31, v11, v5, s[50:51]
    v_cmp_gt_i32 s[44:45], 32, v6
    v_cmp_gt_i32 s[46:47], 33, v6
    v_cmp_gt_i32 s[48:49], 34, v6
    v_cmp_gt_i32 s[50:51], 35, v6
    s_nop 1
    v_cndmask_b32 v24, v10, v5, s[44:45]
    v_cndmask_b32 v25, v10, v5, s[46:47]
    v_cndmask_b32 v26, v10, v5, s[48:49]
    v_cndmask_b32 v27, v10, v5, s[50:51]
    v_cndmask_b32 v44, v11, v5, s[44:45]
    v_cndmask_b32 v45, v11, v5, s[46:47]
    v_cndmask_b32 v46, v11, v5, s[48:49]
    v_cndmask_b32 v47, v11, v5, s[50:51]
    v_cmp_gt_i32 s[44:45], 48, v6
    v_cmp_gt_i32 s[46:47], 49, v6
    v_cmp_gt_i32 s[48:49], 50, v6
    v_cmp_gt_i32 s[50:51], 51, v6
    s_nop 1
    v_cndmask_b32 v40, v10, v5, s[44:45]
    v_cndmask_b32 v41, v10, v5, s[46:47]
    v_cndmask_b32 v42, v10, v5, s[48:49]
    v_cndmask_b32 v43, v10, v5, s[50:51]
    s_nop 1
    s_branch k2_prepret_68
k2_prep_73:
    s_sub_u32 s40, s36, s39
    v_subrev_u32 v6, s40, v4
    v_cmp_gt_i32 s[44:45], -16, v6
    v_cmp_gt_i32 s[46:47], -15, v6
    v_cmp_gt_i32 s[48:49], -14, v6
    v_cmp_gt_i32 s[50:51], -13, v6
    s_nop 1
    v_cndmask_b32 v20, v11, v5, s[44:45]
    v_cndmask_b32 v21, v11, v5, s[46:47]
    v_cndmask_b32 v22, v11, v5, s[48:49]
    v_cndmask_b32 v23, v11, v5, s[50:51]
    v_cmp_gt_i32 s[44:45], 0, v6
    v_cmp_gt_i32 s[46:47], 1, v6
    v_cmp_gt_i32 s[48:49], 2, v6
    v_cmp_gt_i32 s[50:51], 3, v6
    s_nop 1
    v_cndmask_b32 v16, v10, v5, s[44:45]
    v_cndmask_b32 v17, v10, v5, s[46:47]
    v_cndmask_b32 v18, v10, v5, s[48:49]
    v_cndmask_b32 v19, v10, v5, s[50:51]
    v_cndmask_b32 v36, v11, v5, s[44:45]
    v_cndmask_b32 v37, v11, v5, s[46:47]
    v_cndmask_b32 v38, v11, v5, s[48:49]
    v_cndmask_b32 v39, v11, v5, s[50:51]
    v_cmp_gt_i32 s[44:45], 16, v6
    v_cmp_gt_i32 s[46:47], 17, v6
    v_cmp_gt_i32 s[48:49], 18, v6
    v_cmp_gt_i32 s[50:51], 19, v6
    s_nop 1
    v_cndmask_b32 v32, v10, v5, s[44:45]
    v_cndmask_b32 v33, v10, v5, s[46:47]
    v_cndmask_b32 v34, v10, v5, s[48:49]
    v_cndmask_b32 v35, v10, v5, s[50:51]
    v_cndmask_b32 v28, v11, v5, s[44:45]
    v_cndmask_b32 v29, v11, v5, s[46:47]
    v_cndmask_b32 v30, v11, v5, s[48:49]
    v_cndmask_b32 v31, v11, v5, s[50:51]
    v_cmp_gt_i32 s[44:45], 32, v6
    v_cmp_gt_i32 s[46:47], 33, v6
    v_cmp_gt_i32 s[48:49], 34, v6
    v_cmp_gt_i32 s[50:51], 35, v6
    s_nop 1
    v_cndmask_b32 v24, v10, v5, s[44:45]
    v_cndmask_b32 v25, v10, v5, s[46:47]
    v_cndmask_b32 v26, v10, v5, s[48:49]
    v_cndmask_b32 v27, v10, v5, s[50:51]
    v_cndmask_b32 v44, v11, v5, s[44:45]
    v_cndmask_b32 v45, v11, v5, s[46:47]
    v_cndmask_b32 v46, v11, v5, s[48:49]
    v_cndmask_b32 v47, v11, v5, s[50:51]
    v_cmp_gt_i32 s[44:45], 48, v6
    v_cmp_gt_i32 s[46:47], 49, v6
    v_cmp_gt_i32 s[48:49], 50, v6
    v_cmp_gt_i32 s[50:51], 51, v6
    s_nop 1
    v_cndmask_b32 v40, v10, v5, s[44:45]
    v_cndmask_b32 v41, v10, v5, s[46:47]
    v_cndmask_b32 v42, v10, v5, s[48:49]
    v_cndmask_b32 v43, v10, v5, s[50:51]
    s_nop 1
    s_branch k2_prepret_74
k2_prep_77:
    s_sub_u32 s40, s36, s39
    v_subrev_u32 v6, s40, v4
    v_cmp_gt_i32 s[44:45], -16, v6
    v_cmp_gt_i32 s[46:47], -15, v6
    v_cmp_gt_i32 s[48:49], -14, v6
    v_cmp_gt_i32 s[50:51], -13, v6
    s_nop 1
    v_cndmask_b32 v20, v11, v5, s[44:45]
    v_cndmask_b32 v21, v11, v5, s[46:47]
    v_cndmask_b32 v22, v11, v5, s[48:49]
    v_cndmask_b32 v23, v11, v5, s[50:51]
    v_cmp_gt_i32 s[44:45], 0, v6
    v_cmp_gt_i32 s[46:47], 1, v6
    v_cmp_gt_i32 s[48:49], 2, v6
    v_cmp_gt_i32 s[50:51], 3, v6
    s_nop 1
    v_cndmask_b32 v16, v10, v5, s[44:45]
    v_cndmask_b32 v17, v10, v5, s[46:47]
    v_cndmask_b32 v18, v10, v5, s[48:49]
    v_cndmask_b32 v19, v10, v5, s[50:51]
    v_cndmask_b32 v36, v11, v5, s[44:45]
    v_cndmask_b32 v37, v11, v5, s[46:47]
    v_cndmask_b32 v38, v11, v5, s[48:49]
    v_cndmask_b32 v39, v11, v5, s[50:51]
    v_cmp_gt_i32 s[44:45], 16, v6
    v_cmp_gt_i32 s[46:47], 17, v6
    v_cmp_gt_i32 s[48:49], 18, v6
    v_cmp_gt_i32 s[50:51], 19, v6
    s_nop 1
    v_cndmask_b32 v32, v10, v5, s[44:45]
    v_cndmask_b32 v33, v10, v5, s[46:47]
    v_cndmask_b32 v34, v10, v5, s[48:49]
    v_cndmask_b32 v35, v10, v5, s[50:51]
    v_cndmask_b32 v28, v11, v5, s[44:45]
    v_cndmask_b32 v29, v11, v5, s[46:47]
    v_cndmask_b32 v30, v11, v5, s[48:49]
    v_cndmask_b32 v31, v11, v5, s[50:51]
    v_cmp_gt_i32 s[44:45], 32, v6
    v_cmp_gt_i32 s[46:47], 33, v6
    v_cmp_gt_i32 s[48:49], 34, v6
    v_cmp_gt_i32 s[50:51], 35, v6
    s_nop 1
    v_cndmask_b32 v24, v10, v5, s[44:45]
    v_cndmask_b32 v25, v10, v5, s[46:47]
    v_cndmask_b32 v26, v10, v5, s[48:49]
    v_cndmask_b32 v27, v10, v5, s[50:51]
    v_cndmask_b32 v44, v11, v5, s[44:45]
    v_cndmask_b32 v45, v11, v5, s[46:47]
    v_cndmask_b32 v46, v11, v5, s[48:49]
    v_cndmask_b32 v47, v11, v5, s[50:51]
    v_cmp_gt_i32 s[44:45], 48, v6
    v_cmp_gt_i32 s[46:47], 49, v6
    v_cmp_gt_i32 s[48:49], 50, v6
    v_cmp_gt_i32 s[50:51], 51, v6
    s_nop 1
    v_cndmask_b32 v40, v10, v5, s[44:45]
    v_cndmask_b32 v41, v10, v5, s[46:47]
    v_cndmask_b32 v42, v10, v5, s[48:49]
    v_cndmask_b32 v43, v10, v5, s[50:51]
    s_nop 1
    s_branch k2_prepret_78
k12_ool_10:
    buffer_load_dword v52, v8, s[24:27], 0 offen sc1
    s_branch k12_oolret_11
k12_ool_12:
    s_mov_b64 exec, 1
    buffer_atomic_add v9, v8, s[24:27], 0 offen sc1
    s_mov_b64 exec, -1
    s_branch k12_oolret_13
k12_ool_14:
    buffer_load_dword v51, v50, s[12:15], s56 offen
    s_branch k12_oolret_15
k12_ool_18:
    v_readfirstlane_b32 s31, v52
    s_cmp_ge_u32 s31, 256
    s_cbranch_scc1 spin_ok_16
    s_mov_b32 s40, 1048576
spin_17:
    s_sleep 8
    buffer_load_dword v52, v8, s[24:27], 0 offen sc1
    s_waitcnt vmcnt(0)
    v_readfirstlane_b32 s31, v52
    s_sub_u32 s40, s40, 1
    s_cselect_b32 s31, -1, s31
    s_cmp_lt_u32 s31, 256
    s_cbranch_scc1 spin_17
spin_ok_16:
    s_branch k12_oolret_19
k12_ool_20:
    s_mov_b64 exec, 1
    buffer_atomic_add v9, v8, s[24:27], 0 offen sc1
    s_mov_b64 exec, -1
    s_branch k12_oolret_21
k12_ool_22:
    global_load_dword v51, v[2:3], off
    s_branch k12_oolret_23
k12_ool_26:
    buffer_load_dword v52, v8, s[24:27], 0 offen sc1
    s_branch k12_oolret_27
k12_ool_28:
    s_mov_b64 exec, 1
    buffer_atomic_add v9, v8, s[24:27], 0 offen sc1
    s_mov_b64 exec, -1
    s_branch k12_oolret_29
k12_ool_30:
    buffer_load_dword v51, v50, s[12:15], s56 offen
    s_branch k12_oolret_31
k12_ool_34:
    v_readfirstlane_b32 s31, v52
    s_cmp_ge_u32 s31, 256
    s_cbranch_scc1 spin_ok_32
    s_mov_b32 s40, 1048576
spin_33:
    s_sleep 8
    buffer_load_dword v52, v8, s[24:27], 0 offen sc1
    s_waitcnt vmcnt(0)
    v_readfirstlane_b32 s31, v52
    s_sub_u32 s40, s40, 1
    s_cselect_b32 s31, -1, s31
    s_cmp_lt_u32 s31, 256
    s_cbranch_scc1 spin_33
spin_ok_32:
    s_branch k12_oolret_35
k12_ool_36:
    s_mov_b64 exec, 1
    buffer_atomic_add v9, v8, s[24:27], 0 offen sc1
    s_mov_b64 exec, -1
    s_branch k12_oolret_37
k12_ool_38:
    global_load_dword v51, v[2:3], off
    s_branch k12_oolret_39
k12_ool_40:
    s_mov_b64 exec, 1
    buffer_atomic_add v9, v8, s[24:27], s54 offen sc1
    s_mov_b64 exec, -1
    s_branch k12_oolret_41
k12_ool_42:
    buffer_load_dword v52, v8, s[24:27], s55 offen sc1
    s_branch k12_oolret_43
k12_ool_46:
    s_waitcnt vmcnt(12)
    v_readfirstlane_b32 s31, v52
    s_cmp_ge_u32 s31, 16
    s_cbranch_scc1 spin_ok_44
    s_mov_b32 s40, 1048576
spin_45:
    s_sleep 8
    buffer_load_dword v52, v8, s[24:27], s55 offen sc1
    s_waitcnt vmcnt(0)
    v_readfirstlane_b32 s31, v52
    s_sub_u32 s40, s40, 1
    s_cselect_b32 s31, -1, s31
    s_cmp_lt_u32 s31, 16
    s_cbranch_scc1 spin_45
spin_ok_44:
    s_branch k12_oolret_47
k2_rare_52:
    s_nop 7
    v_max_f32 v52, v128, v129
    v_max3_f32 v52, v52, v130, v131
    v_max3_f32 v52, v52, v144, v145
    v_max3_f32 v52, v52, v146, v147
    v_max_f32 v53, v132, v133
    v_max3_f32 v53, v53, v134, v135
    v_max3_f32 v53, v53, v148, v149
    v_max3_f32 v53, v53, v150, v151
    v_max_f32 v54, v136, v137
    v_max3_f32 v54, v54, v138, v139
    v_max3_f32 v54, v54, v152, v153
    v_max3_f32 v54, v54, v154, v155
    v_max_f32 v55, v140, v141
    v_max3_f32 v55, v55, v142, v143
    v_max3_f32 v55, v55, v156, v157
    v_max3_f32 v55, v55, v158, v159
    v_mov_b32 v224, v52
    v_mov_b32 v225, v53
    v_mov_b32 v226, v54
    v_mov_b32 v227, v55
    s_nop 1
    v_permlane16_swap_b32 v52, v224
    v_permlane16_swap_b32 v53, v225
    v_permlane16_swap_b32 v54, v226
    v_permlane16_swap_b32 v55, v227
    s_nop 1
    v_max_f32 v52, v52, v224
    v_max_f32 v53, v53, v225
    v_max_f32 v54, v54, v226
    v_max_f32 v55, v55, v227
    v_mov_b32 v224, v52
    v_mov_b32 v225, v53
    v_mov_b32 v226, v54
    v_mov_b32 v227, v55
    s_nop 1
    v_permlane32_swap_b32 v52, v224
    v_permlane32_swap_b32 v53, v225
    v_permlane32_swap_b32 v54, v226
    v_permlane32_swap_b32 v55, v227
    s_nop 1
    v_max_f32 v52, v52, v224
    v_max_f32 v53, v53, v225
    v_max_f32 v54, v54, v226
    v_max_f32 v55, v55, v227
    v_add_f32 v52, 0x41400000, v52
    v_max_f32 v52, 0, v52
    v_add_f32 v53, 0x41400000, v53
    v_max_f32 v53, 0, v53
    v_add_f32 v54, 0x41400000, v54
    v_max_f32 v54, 0, v54
    v_add_f32 v55, 0x41400000, v55
    v_max_f32 v55, 0, v55
    v_sub_f32 v128, v128, v52
    v_sub_f32 v129, v129, v52
    v_sub_f32 v130, v130, v52
    v_sub_f32 v131, v131, v52
    v_sub_f32 v132, v132, v53
    v_sub_f32 v133, v133, v53
    v_sub_f32 v134, v134, v53
    v_sub_f32 v135, v135, v53
    v_sub_f32 v136, v136, v54
    v_sub_f32 v137, v137, v54
    v_sub_f32 v138, v138, v54
    v_sub_f32 v139, v139, v54
    v_sub_f32 v140, v140, v55
    v_sub_f32 v141, v141, v55
    v_sub_f32 v142, v142, v55
    v_sub_f32 v143, v143, v55
    v_sub_f32 v144, v144, v52
    v_sub_f32 v145, v145, v52
    v_sub_f32 v146, v146, v52
    v_sub_f32 v147, v147, v52
    v_sub_f32 v148, v148, v53
    v_sub_f32 v149, v149, v53
    v_sub_f32 v150, v150, v53
    v_sub_f32 v151, v151, v53
    v_sub_f32 v152, v152, v54
    v_sub_f32 v153, v153, v54
    v_sub_f32 v154, v154, v54
    v_sub_f32 v155, v155, v54
    v_sub_f32 v156, v156, v55
    v_sub_f32 v157, v157, v55
    v_sub_f32 v158, v158, v55
    v_sub_f32 v159, v159, v55
    v_sub_f32 v160, v160, v52
    v_sub_f32 v16, v16, v52
    v_sub_f32 v161, v161, v52
    v_sub_f32 v17, v17, v52
    v_sub_f32 v162, v162, v52
    v_sub_f32 v18, v18, v52
    v_sub_f32 v163, v163, v52
    v_sub_f32 v19, v19, v52
    v_sub_f32 v164, v164, v53
    v_sub_f32 v20, v20, v53
    v_sub_f32 v165, v165, v53
    v_sub_f32 v21, v21, v53
    v_sub_f32 v166, v166, v53
    v_sub_f32 v22, v22, v53
    v_sub_f32 v167, v167, v53
    v_sub_f32 v23, v23, v53
    v_sub_f32 v168, v168, v54
    v_sub_f32 v24, v24, v54
    v_sub_f32 v169, v169, v54
    v_sub_f32 v25, v25, v54
    v_sub_f32 v170, v170, v54
    v_sub_f32 v26, v26, v54
    v_sub_f32 v171, v171, v54
    v_sub_f32 v27, v27, v54
    v_sub_f32 v172, v172, v55
    v_sub_f32 v28, v28, v55
    v_sub_f32 v173, v173, v55
    v_sub_f32 v29, v29, v55
    v_sub_f32 v174, v174, v55
    v_sub_f32 v30, v30, v55
    v_sub_f32 v175, v175, v55
    v_sub_f32 v31, v31, v55
    v_sub_f32 v176, v176, v52
    v_sub_f32 v32, v32, v52
    v_sub_f32 v177, v177, v52
    v_sub_f32 v33, v33, v52
    v_sub_f32 v178, v178, v52
    v_sub_f32 v34, v34, v52
    v_sub_f32 v179, v179, v52
    v_sub_f32 v35, v35, v52
    v_sub_f32 v180, v180, v53
    v_sub_f32 v36, v36, v53
    v_sub_f32 v181, v181, v53
    v_sub_f32 v37, v37, v53
    v_sub_f32 v182, v182, v53
    v_sub_f32 v38, v38, v53
    v_sub_f32 v183, v183, v53
    v_sub_f32 v39, v39, v53
    v_sub_f32 v184, v184, v54
    v_sub_f32 v40, v40, v54
    v_sub_f32 v185, v185, v54
    v_sub_f32 v41, v41, v54
    v_sub_f32 v186, v186, v54
    v_sub_f32 v42, v42, v54
    v_sub_f32 v187, v187, v54
    v_sub_f32 v43, v43, v54
    v_sub_f32 v188, v188, v55
    v_sub_f32 v44, v44, v55
    v_sub_f32 v189, v189, v55
    v_sub_f32 v45, v45, v55
    v_sub_f32 v190, v190, v55
    v_sub_f32 v46, v46, v55
    v_sub_f32 v191, v191, v55
    v_sub_f32 v47, v47, v55
    v_sub_f32 v8, v8, v52
    v_exp_f32 v52, -v52
    v_sub_f32 v9, v9, v53
    v_exp_f32 v53, -v53
    v_sub_f32 v10, v10, v54
    v_exp_f32 v54, -v54
    v_sub_f32 v11, v11, v55
    v_exp_f32 v55, -v55
    s_nop 0
    v_mul_f32 v12, v12, v52
    v_mul_f32 v48, v48, v53
    v_mul_f32 v248, v248, v54
    v_mul_f32 v252, v252, v55
    v_accvgpr_read_b32 v224, a0
    v_accvgpr_read_b32 v225, a1
    v_accvgpr_read_b32 v226, a2
    v_accvgpr_read_b32 v227, a3
    v_mul_f32 v224, v224, v52
    v_mul_f32 v225, v225, v52
    v_mul_f32 v226, v226, v52
    v_mul_f32 v227, v227, v52
    v_accvgpr_write_b32 a0, v224
    v_accvgpr_write_b32 a1, v225
    v_accvgpr_write_b32 a2, v226
    v_accvgpr_write_b32 a3, v227
    v_accvgpr_read_b32 v224, a4
    v_accvgpr_read_b32 v225, a5
    v_accvgpr_read_b32 v226, a6
    v_accvgpr_read_b32 v227, a7
    v_mul_f32 v224, v224, v53
    v_mul_f32 v225, v225, v53
    v_mul_f32 v226, v226, v53
    v_mul_f32 v227, v227, v53
    v_accvgpr_write_b32 a4, v224
    v_accvgpr_write_b32 a5, v225
    v_accvgpr_write_b32 a6, v226
    v_accvgpr_write_b32 a7, v227
    v_accvgpr_read_b32 v224, a8
    v_accvgpr_read_b32 v225, a9
    v_accvgpr_read_b32 v226, a10
    v_accvgpr_read_b32 v227, a11
    v_mul_f32 v224, v224, v54
    v_mul_f32 v225, v225, v54
    v_mul_f32 v226, v226, v54
    v_mul_f32 v227, v227, v54
    v_accvgpr_write_b32 a8, v224
    v_accvgpr_write_b32 a9, v225
    v_accvgpr_write_b32 a10, v226
    v_accvgpr_write_b32 a11, v227
    v_accvgpr_read_b32 v224, a12
    v_accvgpr_read_b32 v225, a13
    v_accvgpr_read_b32 v226, a14
    v_accvgpr_read_b32 v227, a15
    v_mul_f32 v224, v224, v55
    v_mul_f32 v225, v225, v55
    v_mul_f32 v226, v226, v55
    v_mul_f32 v227, v227, v55
    v_accvgpr_write_b32 a12, v224
    v_accvgpr_write_b32 a13, v225
    v_accvgpr_write_b32 a14, v226
    v_accvgpr_write_b32 a15, v227
    v_accvgpr_read_b32 v224, a16
    v_accvgpr_read_b32 v225, a17
    v_accvgpr_read_b32 v226, a18
    v_accvgpr_read_b32 v227, a19
    v_mul_f32 v224, v224, v52
    v_mul_f32 v225, v225, v52
    v_mul_f32 v226, v226, v52
    v_mul_f32 v227, v227, v52
    v_accvgpr_write_b32 a16, v224
    v_accvgpr_write_b32 a17, v225
    v_accvgpr_write_b32 a18, v226
    v_accvgpr_write_b32 a19, v227
    v_accvgpr_read_b32 v224, a20
    v_accvgpr_read_b32 v225, a21
    v_accvgpr_read_b32 v226, a22
    v_accvgpr_read_b32 v227, a23
    v_mul_f32 v224, v224, v53
    v_mul_f32 v225, v225, v53
    v_mul_f32 v226, v226, v53
    v_mul_f32 v227, v227, v53
    v_accvgpr_write_b32 a20, v224
    v_accvgpr_write_b32 a21, v225
    v_accvgpr_write_b32 a22, v226
    v_accvgpr_write_b32 a23, v227
    v_accvgpr_read_b32 v224, a24
    v_accvgpr_read_b32 v225, a25
    v_accvgpr_read_b32 v226, a26
    v_accvgpr_read_b32 v227, a27
    v_mul_f32 v224, v224, v54
    v_mul_f32 v225, v225, v54
    v_mul_f32 v226, v226, v54
    v_mul_f32 v227, v227, v54
    v_accvgpr_write_b32 a24, v224
    v_accvgpr_write_b32 a25, v225
    v_accvgpr_write_b32 a26, v226
    v_accvgpr_write_b32 a27, v227
    v_accvgpr_read_b32 v224, a28
    v_accvgpr_read_b32 v225, a29
    v_accvgpr_read_b32 v226, a30
    v_accvgpr_read_b32 v227, a31
    v_mul_f32 v224, v224, v55
    v_mul_f32 v225, v225, v55
    v_mul_f32 v226, v226, v55
    v_mul_f32 v227, v227, v55
    v_accvgpr_write_b32 a28, v224
    v_accvgpr_write_b32 a29, v225
    v_accvgpr_write_b32 a30, v226
    v_accvgpr_write_b32 a31, v227
    v_accvgpr_read_b32 v224, a32
    v_accvgpr_read_b32 v225, a33
    v_accvgpr_read_b32 v226, a34
    v_accvgpr_read_b32 v227, a35
    v_mul_f32 v224, v224, v52
    v_mul_f32 v225, v225, v52
    v_mul_f32 v226, v226, v52
    v_mul_f32 v227, v227, v52
    v_accvgpr_write_b32 a32, v224
    v_accvgpr_write_b32 a33, v225
    v_accvgpr_write_b32 a34, v226
    v_accvgpr_write_b32 a35, v227
    v_accvgpr_read_b32 v224, a36
    v_accvgpr_read_b32 v225, a37
    v_accvgpr_read_b32 v226, a38
    v_accvgpr_read_b32 v227, a39
    v_mul_f32 v224, v224, v53
    v_mul_f32 v225, v225, v53
    v_mul_f32 v226, v226, v53
    v_mul_f32 v227, v227, v53
    v_accvgpr_write_b32 a36, v224
    v_accvgpr_write_b32 a37, v225
    v_accvgpr_write_b32 a38, v226
    v_accvgpr_write_b32 a39, v227
    v_accvgpr_read_b32 v224, a40
    v_accvgpr_read_b32 v225, a41
    v_accvgpr_read_b32 v226, a42
    v_accvgpr_read_b32 v227, a43
    v_mul_f32 v224, v224, v54
    v_mul_f32 v225, v225, v54
    v_mul_f32 v226, v226, v54
    v_mul_f32 v227, v227, v54
    v_accvgpr_write_b32 a40, v224
    v_accvgpr_write_b32 a41, v225
    v_accvgpr_write_b32 a42, v226
    v_accvgpr_write_b32 a43, v227
    v_accvgpr_read_b32 v224, a44
    v_accvgpr_read_b32 v225, a45
    v_accvgpr_read_b32 v226, a46
    v_accvgpr_read_b32 v227, a47
    v_mul_f32 v224, v224, v55
    v_mul_f32 v225, v225, v55
    v_mul_f32 v226, v226, v55
    v_mul_f32 v227, v227, v55
    v_accvgpr_write_b32 a44, v224
    v_accvgpr_write_b32 a45, v225
    v_accvgpr_write_b32 a46, v226
    v_accvgpr_write_b32 a47, v227
    v_accvgpr_read_b32 v224, a48
    v_accvgpr_read_b32 v225, a49
    v_accvgpr_read_b32 v226, a50
    v_accvgpr_read_b32 v227, a51
    v_mul_f32 v224, v224, v52
    v_mul_f32 v225, v225, v52
    v_mul_f32 v226, v226, v52
    v_mul_f32 v227, v227, v52
    v_accvgpr_write_b32 a48, v224
    v_accvgpr_write_b32 a49, v225
    v_accvgpr_write_b32 a50, v226
    v_accvgpr_write_b32 a51, v227
    v_accvgpr_read_b32 v224, a52
    v_accvgpr_read_b32 v225, a53
    v_accvgpr_read_b32 v226, a54
    v_accvgpr_read_b32 v227, a55
    v_mul_f32 v224, v224, v53
    v_mul_f32 v225, v225, v53
    v_mul_f32 v226, v226, v53
    v_mul_f32 v227, v227, v53
    v_accvgpr_write_b32 a52, v224
    v_accvgpr_write_b32 a53, v225
    v_accvgpr_write_b32 a54, v226
    v_accvgpr_write_b32 a55, v227
    v_accvgpr_read_b32 v224, a56
    v_accvgpr_read_b32 v225, a57
    v_accvgpr_read_b32 v226, a58
    v_accvgpr_read_b32 v227, a59
    v_mul_f32 v224, v224, v54
    v_mul_f32 v225, v225, v54
    v_mul_f32 v226, v226, v54
    v_mul_f32 v227, v227, v54
    v_accvgpr_write_b32 a56, v224
    v_accvgpr_write_b32 a57, v225
    v_accvgpr_write_b32 a58, v226
    v_accvgpr_write_b32 a59, v227
    v_accvgpr_read_b32 v224, a60
    v_accvgpr_read_b32 v225, a61
    v_accvgpr_read_b32 v226, a62
    v_accvgpr_read_b32 v227, a63
    v_mul_f32 v224, v224, v55
    v_mul_f32 v225, v225, v55
    v_mul_f32 v226, v226, v55
    v_mul_f32 v227, v227, v55
    v_accvgpr_write_b32 a60, v224
    v_accvgpr_write_b32 a61, v225
    v_accvgpr_write_b32 a62, v226
    v_accvgpr_write_b32 a63, v227
    v_accvgpr_read_b32 v224, a64
    v_accvgpr_read_b32 v225, a65
    v_accvgpr_read_b32 v226, a66
    v_accvgpr_read_b32 v227, a67
    v_mul_f32 v224, v224, v52
    v_mul_f32 v225, v225, v52
    v_mul_f32 v226, v226, v52
    v_mul_f32 v227, v227, v52
    v_accvgpr_write_b32 a64, v224
    v_accvgpr_write_b32 a65, v225
    v_accvgpr_write_b32 a66, v226
    v_accvgpr_write_b32 a67, v227
    v_accvgpr_read_b32 v224, a68
    v_accvgpr_read_b32 v225, a69
    v_accvgpr_read_b32 v226, a70
    v_accvgpr_read_b32 v227, a71
    v_mul_f32 v224, v224, v53
    v_mul_f32 v225, v225, v53
    v_mul_f32 v226, v226, v53
    v_mul_f32 v227, v227, v53
    v_accvgpr_write_b32 a68, v224
    v_accvgpr_write_b32 a69, v225
    v_accvgpr_write_b32 a70, v226
    v_accvgpr_write_b32 a71, v227
    v_accvgpr_read_b32 v224, a72
    v_accvgpr_read_b32 v225, a73
    v_accvgpr_read_b32 v226, a74
    v_accvgpr_read_b32 v227, a75
    v_mul_f32 v224, v224, v54
    v_mul_f32 v225, v225, v54
    v_mul_f32 v226, v226, v54
    v_mul_f32 v227, v227, v54
    v_accvgpr_write_b32 a72, v224
    v_accvgpr_write_b32 a73, v225
    v_accvgpr_write_b32 a74, v226
    v_accvgpr_write_b32 a75, v227
    v_accvgpr_read_b32 v224, a76
    v_accvgpr_read_b32 v225, a77
    v_accvgpr_read_b32 v226, a78
    v_accvgpr_read_b32 v227, a79
    v_mul_f32 v224, v224, v55
    v_mul_f32 v225, v225, v55
    v_mul_f32 v226, v226, v55
    v_mul_f32 v227, v227, v55
    v_accvgpr_write_b32 a76, v224
    v_accvgpr_write_b32 a77, v225
    v_accvgpr_write_b32 a78, v226
    v_accvgpr_write_b32 a79, v227
    v_accvgpr_read_b32 v224, a80
    v_accvgpr_read_b32 v225, a81
    v_accvgpr_read_b32 v226, a82
    v_accvgpr_read_b32 v227, a83
    v_mul_f32 v224, v224, v52
    v_mul_f32 v225, v225, v52
    v_mul_f32 v226, v226, v52
    v_mul_f32 v227, v227, v52
    v_accvgpr_write_b32 a80, v224
    v_accvgpr_write_b32 a81, v225
    v_accvgpr_write_b32 a82, v226
    v_accvgpr_write_b32 a83, v227
    v_accvgpr_read_b32 v224, a84
    v_accvgpr_read_b32 v225, a85
    v_accvgpr_read_b32 v226, a86
    v_accvgpr_read_b32 v227, a87
    v_mul_f32 v224, v224, v53
    v_mul_f32 v225, v225, v53
    v_mul_f32 v226, v226, v53
    v_mul_f32 v227, v227, v53
    v_accvgpr_write_b32 a84, v224
    v_accvgpr_write_b32 a85, v225
    v_accvgpr_write_b32 a86, v226
    v_accvgpr_write_b32 a87, v227
    v_accvgpr_read_b32 v224, a88
    v_accvgpr_read_b32 v225, a89
    v_accvgpr_read_b32 v226, a90
    v_accvgpr_read_b32 v227, a91
    v_mul_f32 v224, v224, v54
    v_mul_f32 v225, v225, v54
    v_mul_f32 v226, v226, v54
    v_mul_f32 v227, v227, v54
    v_accvgpr_write_b32 a88, v224
    v_accvgpr_write_b32 a89, v225
    v_accvgpr_write_b32 a90, v226
    v_accvgpr_write_b32 a91, v227
    v_accvgpr_read_b32 v224, a92
    v_accvgpr_read_b32 v225, a93
    v_accvgpr_read_b32 v226, a94
    v_accvgpr_read_b32 v227, a95
    v_mul_f32 v224, v224, v55
    v_mul_f32 v225, v225, v55
    v_mul_f32 v226, v226, v55
    v_mul_f32 v227, v227, v55
    v_accvgpr_write_b32 a92, v224
    v_accvgpr_write_b32 a93, v225
    v_accvgpr_write_b32 a94, v226
    v_accvgpr_write_b32 a95, v227
    v_accvgpr_read_b32 v224, a96
    v_accvgpr_read_b32 v225, a97
    v_accvgpr_read_b32 v226, a98
    v_accvgpr_read_b32 v227, a99
    v_mul_f32 v224, v224, v52
    v_mul_f32 v225, v225, v52
    v_mul_f32 v226, v226, v52
    v_mul_f32 v227, v227, v52
    v_accvgpr_write_b32 a96, v224
    v_accvgpr_write_b32 a97, v225
    v_accvgpr_write_b32 a98, v226
    v_accvgpr_write_b32 a99, v227
    v_accvgpr_read_b32 v224, a100
    v_accvgpr_read_b32 v225, a101
    v_accvgpr_read_b32 v226, a102
    v_accvgpr_read_b32 v227, a103
    v_mul_f32 v224, v224, v53
    v_mul_f32 v225, v225, v53
    v_mul_f32 v226, v226, v53
    v_mul_f32 v227, v227, v53
    v_accvgpr_write_b32 a100, v224
    v_accvgpr_write_b32 a101, v225
    v_accvgpr_write_b32 a102, v226
    v_accvgpr_write_b32 a103, v227
    v_accvgpr_read_b32 v224, a104
    v_accvgpr_read_b32 v225, a105
    v_accvgpr_read_b32 v226, a106
    v_accvgpr_read_b32 v227, a107
    v_mul_f32 v224, v224, v54
    v_mul_f32 v225, v225, v54
    v_mul_f32 v226, v226, v54
    v_mul_f32 v227, v227, v54
    v_accvgpr_write_b32 a104, v224
    v_accvgpr_write_b32 a105, v225
    v_accvgpr_write_b32 a106, v226
    v_accvgpr_write_b32 a107, v227
    v_accvgpr_read_b32 v224, a108
    v_accvgpr_read_b32 v225, a109
    v_accvgpr_read_b32 v226, a110
    v_accvgpr_read_b32 v227, a111
    v_mul_f32 v224, v224, v55
    v_mul_f32 v225, v225, v55
    v_mul_f32 v226, v226, v55
    v_mul_f32 v227, v227, v55
    v_accvgpr_write_b32 a108, v224
    v_accvgpr_write_b32 a109, v225
    v_accvgpr_write_b32 a110, v226
    v_accvgpr_write_b32 a111, v227
    v_accvgpr_read_b32 v224, a112
    v_accvgpr_read_b32 v225, a113
    v_accvgpr_read_b32 v226, a114
    v_accvgpr_read_b32 v227, a115
    v_mul_f32 v224, v224, v52
    v_mul_f32 v225, v225, v52
    v_mul_f32 v226, v226, v52
    v_mul_f32 v227, v227, v52
    v_accvgpr_write_b32 a112, v224
    v_accvgpr_write_b32 a113, v225
    v_accvgpr_write_b32 a114, v226
    v_accvgpr_write_b32 a115, v227
    v_accvgpr_read_b32 v224, a116
    v_accvgpr_read_b32 v225, a117
    v_accvgpr_read_b32 v226, a118
    v_accvgpr_read_b32 v227, a119
    v_mul_f32 v224, v224, v53
    v_mul_f32 v225, v225, v53
    v_mul_f32 v226, v226, v53
    v_mul_f32 v227, v227, v53
    v_accvgpr_write_b32 a116, v224
    v_accvgpr_write_b32 a117, v225
    v_accvgpr_write_b32 a118, v226
    v_accvgpr_write_b32 a119, v227
    v_accvgpr_read_b32 v224, a120
    v_accvgpr_read_b32 v225, a121
    v_accvgpr_read_b32 v226, a122
    v_accvgpr_read_b32 v227, a123
    v_mul_f32 v224, v224, v54
    v_mul_f32 v225, v225, v54
    v_mul_f32 v226, v226, v54
    v_mul_f32 v227, v227, v54
    v_accvgpr_write_b32 a120, v224
    v_accvgpr_write_b32 a121, v225
    v_accvgpr_write_b32 a122, v226
    v_accvgpr_write_b32 a123, v227
    v_accvgpr_read_b32 v224, a124
    v_accvgpr_read_b32 v225, a125
    v_accvgpr_read_b32 v226, a126
    v_accvgpr_read_b32 v227, a127
    v_mul_f32 v224, v224, v55
    v_mul_f32 v225, v225, v55
    v_mul_f32 v226, v226, v55
    v_mul_f32 v227, v227, v55
    v_accvgpr_write_b32 a124, v224
    v_accvgpr_write_b32 a125, v225
    v_accvgpr_write_b32 a126, v226
    v_accvgpr_write_b32 a127, v227
    v_exp_f32 v232, v128
    v_exp_f32 v233, v129
    v_exp_f32 v234, v130
    v_exp_f32 v235, v131
    s_nop 0
    v_cvt_pk_bf16_f32 v192, v232, v233
    v_cvt_pk_bf16_f32 v193, v234, v235
    v_exp_f32 v232, v144
    v_exp_f32 v233, v145
    v_exp_f32 v234, v146
    v_exp_f32 v235, v147
    s_nop 0
    v_cvt_pk_bf16_f32 v194, v232, v233
    v_cvt_pk_bf16_f32 v195, v234, v235
    v_exp_f32 v232, v132
    v_exp_f32 v233, v133
    v_exp_f32 v234, v134
    v_exp_f32 v235, v135
    s_nop 0
    v_cvt_pk_bf16_f32 v196, v232, v233
    v_cvt_pk_bf16_f32 v197, v234, v235
    v_exp_f32 v232, v148
    v_exp_f32 v233, v149
    v_exp_f32 v234, v150
    v_exp_f32 v235, v151
    s_nop 0
    v_cvt_pk_bf16_f32 v198, v232, v233
    v_cvt_pk_bf16_f32 v199, v234, v235
    v_exp_f32 v232, v136
    v_exp_f32 v233, v137
    v_exp_f32 v234, v138
    v_exp_f32 v235, v139
    s_nop 0
    v_cvt_pk_bf16_f32 v200, v232, v233
    v_cvt_pk_bf16_f32 v201, v234, v235
    v_exp_f32 v232, v152
    v_exp_f32 v233, v153
    v_exp_f32 v234, v154
    v_exp_f32 v235, v155
    s_nop 0
    v_cvt_pk_bf16_f32 v202, v232, v233
    v_cvt_pk_bf16_f32 v203, v234, v235
    v_exp_f32 v232, v140
    v_exp_f32 v233, v141
    v_exp_f32 v234, v142
    v_exp_f32 v235, v143
    s_nop 0
    v_cvt_pk_bf16_f32 v204, v232, v233
    v_cvt_pk_bf16_f32 v205, v234, v235
    v_exp_f32 v232, v156
    v_exp_f32 v233, v157
    v_exp_f32 v234, v158
    v_exp_f32 v235, v159
    s_nop 0
    v_cvt_pk_bf16_f32 v206, v232, v233
    v_cvt_pk_bf16_f32 v207, v234, v235
    s_nop 1
    s_branch k2_ret_53
k2_rare_57:
    s_nop 7
    v_max_f32 v52, v160, v161
    v_max3_f32 v52, v52, v162, v163
    v_max3_f32 v52, v52, v176, v177
    v_max3_f32 v52, v52, v178, v179
    v_max_f32 v53, v164, v165
    v_max3_f32 v53, v53, v166, v167
    v_max3_f32 v53, v53, v180, v181
    v_max3_f32 v53, v53, v182, v183
    v_max_f32 v54, v168, v169
    v_max3_f32 v54, v54, v170, v171
    v_max3_f32 v54, v54, v184, v185
    v_max3_f32 v54, v54, v186, v187
    v_max_f32 v55, v172, v173
    v_max3_f32 v55, v55, v174, v175
    v_max3_f32 v55, v55, v188, v189
    v_max3_f32 v55, v55, v190, v191
    v_mov_b32 v224, v52
    v_mov_b32 v225, v53
    v_mov_b32 v226, v54
    v_mov_b32 v227, v55
    s_nop 1
    v_permlane16_swap_b32 v52, v224
    v_permlane16_swap_b32 v53, v225
    v_permlane16_swap_b32 v54, v226
    v_permlane16_swap_b32 v55, v227
    s_nop 1
    v_max_f32 v52, v52, v224
    v_max_f32 v53, v53, v225
    v_max_f32 v54, v54, v226
    v_max_f32 v55, v55, v227
    v_mov_b32 v224, v52
    v_mov_b32 v225, v53
    v_mov_b32 v226, v54
    v_mov_b32 v227, v55
    s_nop 1
    v_permlane32_swap_b32 v52, v224
    v_permlane32_swap_b32 v53, v225
    v_permlane32_swap_b32 v54, v226
    v_permlane32_swap_b32 v55, v227
    s_nop 1
    v_max_f32 v52, v52, v224
    v_max_f32 v53, v53, v225
    v_max_f32 v54, v54, v226
    v_max_f32 v55, v55, v227
    v_add_f32 v52, 0x41400000, v52
    v_max_f32 v52, 0, v52
    v_add_f32 v53, 0x41400000, v53
    v_max_f32 v53, 0, v53
    v_add_f32 v54, 0x41400000, v54
    v_max_f32 v54, 0, v54
    v_add_f32 v55, 0x41400000, v55
    v_max_f32 v55, 0, v55
    v_sub_f32 v160, v160, v52
    v_sub_f32 v161, v161, v52
    v_sub_f32 v162, v162, v52
    v_sub_f32 v163, v163, v52
    v_sub_f32 v164, v164, v53
    v_sub_f32 v165, v165, v53
    v_sub_f32 v166, v166, v53
    v_sub_f32 v167, v167, v53
    v_sub_f32 v168, v168, v54
    v_sub_f32 v169, v169, v54
    v_sub_f32 v170, v170, v54
    v_sub_f32 v171, v171, v54
    v_sub_f32 v172, v172, v55
    v_sub_f32 v173, v173, v55
    v_sub_f32 v174, v174, v55
    v_sub_f32 v175, v175, v55
    v_sub_f32 v176, v176, v52
    v_sub_f32 v177, v177, v52
    v_sub_f32 v178, v178, v52
    v_sub_f32 v179, v179, v52
    v_sub_f32 v180, v180, v53
    v_sub_f32 v181, v181, v53
    v_sub_f32 v182, v182, v53
    v_sub_f32 v183, v183, v53
    v_sub_f32 v184, v184, v54
    v_sub_f32 v185, v185, v54
    v_sub_f32 v186, v186, v54
    v_sub_f32 v187, v187, v54
    v_sub_f32 v188, v188, v55
    v_sub_f32 v189, v189, v55
    v_sub_f32 v190, v190, v55
    v_sub_f32 v191, v191, v55
    v_sub_f32 v128, v128, v52
    v_sub_f32 v16, v16, v52
    v_sub_f32 v129, v129, v52
    v_sub_f32 v17, v17, v52
    v_sub_f32 v130, v130, v52
    v_sub_f32 v18, v18, v52
    v_sub_f32 v131, v131, v52
    v_sub_f32 v19, v19, v52
    v_sub_f32 v132, v132, v53
    v_sub_f32 v20, v20, v53
    v_sub_f32 v133, v133, v53
    v_sub_f32 v21, v21, v53
    v_sub_f32 v134, v134, v53
    v_sub_f32 v22, v22, v53
    v_sub_f32 v135, v135, v53
    v_sub_f32 v23, v23, v53
    v_sub_f32 v136, v136, v54
    v_sub_f32 v24, v24, v54
    v_sub_f32 v137, v137, v54
    v_sub_f32 v25, v25, v54
    v_sub_f32 v138, v138, v54
    v_sub_f32 v26, v26, v54
    v_sub_f32 v139, v139, v54
    v_sub_f32 v27, v27, v54
    v_sub_f32 v140, v140, v55
    v_sub_f32 v28, v28, v55
    v_sub_f32 v141, v141, v55
    v_sub_f32 v29, v29, v55
    v_sub_f32 v142, v142, v55
    v_sub_f32 v30, v30, v55
    v_sub_f32 v143, v143, v55
    v_sub_f32 v31, v31, v55
    v_sub_f32 v144, v144, v52
    v_sub_f32 v32, v32, v52
    v_sub_f32 v145, v145, v52
    v_sub_f32 v33, v33, v52
    v_sub_f32 v146, v146, v52
    v_sub_f32 v34, v34, v52
    v_sub_f32 v147, v147, v52
    v_sub_f32 v35, v35, v52
    v_sub_f32 v148, v148, v53
    v_sub_f32 v36, v36, v53
    v_sub_f32 v149, v149, v53
    v_sub_f32 v37, v37, v53
    v_sub_f32 v150, v150, v53
    v_sub_f32 v38, v38, v53
    v_sub_f32 v151, v151, v53
    v_sub_f32 v39, v39, v53
    v_sub_f32 v152, v152, v54
    v_sub_f32 v40, v40, v54
    v_sub_f32 v153, v153, v54
    v_sub_f32 v41, v41, v54
    v_sub_f32 v154, v154, v54
    v_sub_f32 v42, v42, v54
    v_sub_f32 v155, v155, v54
    v_sub_f32 v43, v43, v54
    v_sub_f32 v156, v156, v55
    v_sub_f32 v44, v44, v55
    v_sub_f32 v157, v157, v55
    v_sub_f32 v45, v45, v55
    v_sub_f32 v158, v158, v55
    v_sub_f32 v46, v46, v55
    v_sub_f32 v159, v159, v55
    v_sub_f32 v47, v47, v55
    v_sub_f32 v8, v8, v52
    v_exp_f32 v52, -v52
    v_sub_f32 v9, v9, v53
    v_exp_f32 v53, -v53
    v_sub_f32 v10, v10, v54
    v_exp_f32 v54, -v54
    v_sub_f32 v11, v11, v55
    v_exp_f32 v55, -v55
    s_nop 0
    v_mul_f32 v12, v12, v52
    v_mul_f32 v48, v48, v53
    v_mul_f32 v248, v248, v54
    v_mul_f32 v252, v252, v55
    v_accvgpr_read_b32 v224, a0
    v_accvgpr_read_b32 v225, a1
    v_accvgpr_read_b32 v226, a2
    v_accvgpr_read_b32 v227, a3
    v_mul_f32 v224, v224, v52
    v_mul_f32 v225, v225, v52
    v_mul_f32 v226, v226, v52
    v_mul_f32 v227, v227, v52
    v_accvgpr_write_b32 a0, v224
    v_accvgpr_write_b32 a1, v225
    v_accvgpr_write_b32 a2, v226
    v_accvgpr_write_b32 a3, v227
    v_accvgpr_read_b32 v224, a4
    v_accvgpr_read_b32 v225, a5
    v_accvgpr_read_b32 v226, a6
    v_accvgpr_read_b32 v227, a7
    v_mul_f32 v224, v224, v53
    v_mul_f32 v225, v225, v53
    v_mul_f32 v226, v226, v53
    v_mul_f32 v227, v227, v53
    v_accvgpr_write_b32 a4, v224
    v_accvgpr_write_b32 a5, v225
    v_accvgpr_write_b32 a6, v226
    v_accvgpr_write_b32 a7, v227
    v_accvgpr_read_b32 v224, a8
    v_accvgpr_read_b32 v225, a9
    v_accvgpr_read_b32 v226, a10
    v_accvgpr_read_b32 v227, a11
    v_mul_f32 v224, v224, v54
    v_mul_f32 v225, v225, v54
    v_mul_f32 v226, v226, v54
    v_mul_f32 v227, v227, v54
    v_accvgpr_write_b32 a8, v224
    v_accvgpr_write_b32 a9, v225
    v_accvgpr_write_b32 a10, v226
    v_accvgpr_write_b32 a11, v227
    v_accvgpr_read_b32 v224, a12
    v_accvgpr_read_b32 v225, a13
    v_accvgpr_read_b32 v226, a14
    v_accvgpr_read_b32 v227, a15
    v_mul_f32 v224, v224, v55
    v_mul_f32 v225, v225, v55
    v_mul_f32 v226, v226, v55
    v_mul_f32 v227, v227, v55
    v_accvgpr_write_b32 a12, v224
    v_accvgpr_write_b32 a13, v225
    v_accvgpr_write_b32 a14, v226
    v_accvgpr_write_b32 a15, v227
    v_accvgpr_read_b32 v224, a16
    v_accvgpr_read_b32 v225, a17
    v_accvgpr_read_b32 v226, a18
    v_accvgpr_read_b32 v227, a19
    v_mul_f32 v224, v224, v52
    v_mul_f32 v225, v225, v52
    v_mul_f32 v226, v226, v52
    v_mul_f32 v227, v227, v52
    v_accvgpr_write_b32 a16, v224
    v_accvgpr_write_b32 a17, v225
    v_accvgpr_write_b32 a18, v226
    v_accvgpr_write_b32 a19, v227
    v_accvgpr_read_b32 v224, a20
    v_accvgpr_read_b32 v225, a21
    v_accvgpr_read_b32 v226, a22
    v_accvgpr_read_b32 v227, a23
    v_mul_f32 v224, v224, v53
    v_mul_f32 v225, v225, v53
    v_mul_f32 v226, v226, v53
    v_mul_f32 v227, v227, v53
    v_accvgpr_write_b32 a20, v224
    v_accvgpr_write_b32 a21, v225
    v_accvgpr_write_b32 a22, v226
    v_accvgpr_write_b32 a23, v227
    v_accvgpr_read_b32 v224, a24
    v_accvgpr_read_b32 v225, a25
    v_accvgpr_read_b32 v226, a26
    v_accvgpr_read_b32 v227, a27
    v_mul_f32 v224, v224, v54
    v_mul_f32 v225, v225, v54
    v_mul_f32 v226, v226, v54
    v_mul_f32 v227, v227, v54
    v_accvgpr_write_b32 a24, v224
    v_accvgpr_write_b32 a25, v225
    v_accvgpr_write_b32 a26, v226
    v_accvgpr_write_b32 a27, v227
    v_accvgpr_read_b32 v224, a28
    v_accvgpr_read_b32 v225, a29
    v_accvgpr_read_b32 v226, a30
    v_accvgpr_read_b32 v227, a31
    v_mul_f32 v224, v224, v55
    v_mul_f32 v225, v225, v55
    v_mul_f32 v226, v226, v55
    v_mul_f32 v227, v227, v55
    v_accvgpr_write_b32 a28, v224
    v_accvgpr_write_b32 a29, v225
    v_accvgpr_write_b32 a30, v226
    v_accvgpr_write_b32 a31, v227
    v_accvgpr_read_b32 v224, a32
    v_accvgpr_read_b32 v225, a33
    v_accvgpr_read_b32 v226, a34
    v_accvgpr_read_b32 v227, a35
    v_mul_f32 v224, v224, v52
    v_mul_f32 v225, v225, v52
    v_mul_f32 v226, v226, v52
    v_mul_f32 v227, v227, v52
    v_accvgpr_write_b32 a32, v224
    v_accvgpr_write_b32 a33, v225
    v_accvgpr_write_b32 a34, v226
    v_accvgpr_write_b32 a35, v227
    v_accvgpr_read_b32 v224, a36
    v_accvgpr_read_b32 v225, a37
    v_accvgpr_read_b32 v226, a38
    v_accvgpr_read_b32 v227, a39
    v_mul_f32 v224, v224, v53
    v_mul_f32 v225, v225, v53
    v_mul_f32 v226, v226, v53
    v_mul_f32 v227, v227, v53
    v_accvgpr_write_b32 a36, v224
    v_accvgpr_write_b32 a37, v225
    v_accvgpr_write_b32 a38, v226
    v_accvgpr_write_b32 a39, v227
    v_accvgpr_read_b32 v224, a40
    v_accvgpr_read_b32 v225, a41
    v_accvgpr_read_b32 v226, a42
    v_accvgpr_read_b32 v227, a43
    v_mul_f32 v224, v224, v54
    v_mul_f32 v225, v225, v54
    v_mul_f32 v226, v226, v54
    v_mul_f32 v227, v227, v54
    v_accvgpr_write_b32 a40, v224
    v_accvgpr_write_b32 a41, v225
    v_accvgpr_write_b32 a42, v226
    v_accvgpr_write_b32 a43, v227
    v_accvgpr_read_b32 v224, a44
    v_accvgpr_read_b32 v225, a45
    v_accvgpr_read_b32 v226, a46
    v_accvgpr_read_b32 v227, a47
    v_mul_f32 v224, v224, v55
    v_mul_f32 v225, v225, v55
    v_mul_f32 v226, v226, v55
    v_mul_f32 v227, v227, v55
    v_accvgpr_write_b32 a44, v224
    v_accvgpr_write_b32 a45, v225
    v_accvgpr_write_b32 a46, v226
    v_accvgpr_write_b32 a47, v227
    v_accvgpr_read_b32 v224, a48
    v_accvgpr_read_b32 v225, a49
    v_accvgpr_read_b32 v226, a50
    v_accvgpr_read_b32 v227, a51
    v_mul_f32 v224, v224, v52
    v_mul_f32 v225, v225, v52
    v_mul_f32 v226, v226, v52
    v_mul_f32 v227, v227, v52
    v_accvgpr_write_b32 a48, v224
    v_accvgpr_write_b32 a49, v225
    v_accvgpr_write_b32 a50, v226
    v_accvgpr_write_b32 a51, v227
    v_accvgpr_read_b32 v224, a52
    v_accvgpr_read_b32 v225, a53
    v_accvgpr_read_b32 v226, a54
    v_accvgpr_read_b32 v227, a55
    v_mul_f32 v224, v224, v53
    v_mul_f32 v225, v225, v53
    v_mul_f32 v226, v226, v53
    v_mul_f32 v227, v227, v53
    v_accvgpr_write_b32 a52, v224
    v_accvgpr_write_b32 a53, v225
    v_accvgpr_write_b32 a54, v226
    v_accvgpr_write_b32 a55, v227
    v_accvgpr_read_b32 v224, a56
    v_accvgpr_read_b32 v225, a57
    v_accvgpr_read_b32 v226, a58
    v_accvgpr_read_b32 v227, a59
    v_mul_f32 v224, v224, v54
    v_mul_f32 v225, v225, v54
    v_mul_f32 v226, v226, v54
    v_mul_f32 v227, v227, v54
    v_accvgpr_write_b32 a56, v224
    v_accvgpr_write_b32 a57, v225
    v_accvgpr_write_b32 a58, v226
    v_accvgpr_write_b32 a59, v227
    v_accvgpr_read_b32 v224, a60
    v_accvgpr_read_b32 v225, a61
    v_accvgpr_read_b32 v226, a62
    v_accvgpr_read_b32 v227, a63
    v_mul_f32 v224, v224, v55
    v_mul_f32 v225, v225, v55
    v_mul_f32 v226, v226, v55
    v_mul_f32 v227, v227, v55
    v_accvgpr_write_b32 a60, v224
    v_accvgpr_write_b32 a61, v225
    v_accvgpr_write_b32 a62, v226
    v_accvgpr_write_b32 a63, v227
    v_accvgpr_read_b32 v224, a64
    v_accvgpr_read_b32 v225, a65
    v_accvgpr_read_b32 v226, a66
    v_accvgpr_read_b32 v227, a67
    v_mul_f32 v224, v224, v52
    v_mul_f32 v225, v225, v52
    v_mul_f32 v226, v226, v52
    v_mul_f32 v227, v227, v52
    v_accvgpr_write_b32 a64, v224
    v_accvgpr_write_b32 a65, v225
    v_accvgpr_write_b32 a66, v226
    v_accvgpr_write_b32 a67, v227
    v_accvgpr_read_b32 v224, a68
    v_accvgpr_read_b32 v225, a69
    v_accvgpr_read_b32 v226, a70
    v_accvgpr_read_b32 v227, a71
    v_mul_f32 v224, v224, v53
    v_mul_f32 v225, v225, v53
    v_mul_f32 v226, v226, v53
    v_mul_f32 v227, v227, v53
    v_accvgpr_write_b32 a68, v224
    v_accvgpr_write_b32 a69, v225
    v_accvgpr_write_b32 a70, v226
    v_accvgpr_write_b32 a71, v227
    v_accvgpr_read_b32 v224, a72
    v_accvgpr_read_b32 v225, a73
    v_accvgpr_read_b32 v226, a74
    v_accvgpr_read_b32 v227, a75
    v_mul_f32 v224, v224, v54
    v_mul_f32 v225, v225, v54
    v_mul_f32 v226, v226, v54
    v_mul_f32 v227, v227, v54
    v_accvgpr_write_b32 a72, v224
    v_accvgpr_write_b32 a73, v225
    v_accvgpr_write_b32 a74, v226
    v_accvgpr_write_b32 a75, v227
    v_accvgpr_read_b32 v224, a76
    v_accvgpr_read_b32 v225, a77
    v_accvgpr_read_b32 v226, a78
    v_accvgpr_read_b32 v227, a79
    v_mul_f32 v224, v224, v55
    v_mul_f32 v225, v225, v55
    v_mul_f32 v226, v226, v55
    v_mul_f32 v227, v227, v55
    v_accvgpr_write_b32 a76, v224
    v_accvgpr_write_b32 a77, v225
    v_accvgpr_write_b32 a78, v226
    v_accvgpr_write_b32 a79, v227
    v_accvgpr_read_b32 v224, a80
    v_accvgpr_read_b32 v225, a81
    v_accvgpr_read_b32 v226, a82
    v_accvgpr_read_b32 v227, a83
    v_mul_f32 v224, v224, v52
    v_mul_f32 v225, v225, v52
    v_mul_f32 v226, v226, v52
    v_mul_f32 v227, v227, v52
    v_accvgpr_write_b32 a80, v224
    v_accvgpr_write_b32 a81, v225
    v_accvgpr_write_b32 a82, v226
    v_accvgpr_write_b32 a83, v227
    v_accvgpr_read_b32 v224, a84
    v_accvgpr_read_b32 v225, a85
    v_accvgpr_read_b32 v226, a86
    v_accvgpr_read_b32 v227, a87
    v_mul_f32 v224, v224, v53
    v_mul_f32 v225, v225, v53
    v_mul_f32 v226, v226, v53
    v_mul_f32 v227, v227, v53
    v_accvgpr_write_b32 a84, v224
    v_accvgpr_write_b32 a85, v225
    v_accvgpr_write_b32 a86, v226
    v_accvgpr_write_b32 a87, v227
    v_accvgpr_read_b32 v224, a88
    v_accvgpr_read_b32 v225, a89
    v_accvgpr_read_b32 v226, a90
    v_accvgpr_read_b32 v227, a91
    v_mul_f32 v224, v224, v54
    v_mul_f32 v225, v225, v54
    v_mul_f32 v226, v226, v54
    v_mul_f32 v227, v227, v54
    v_accvgpr_write_b32 a88, v224
    v_accvgpr_write_b32 a89, v225
    v_accvgpr_write_b32 a90, v226
    v_accvgpr_write_b32 a91, v227
    v_accvgpr_read_b32 v224, a92
    v_accvgpr_read_b32 v225, a93
    v_accvgpr_read_b32 v226, a94
    v_accvgpr_read_b32 v227, a95
    v_mul_f32 v224, v224, v55
    v_mul_f32 v225, v225, v55
    v_mul_f32 v226, v226, v55
    v_mul_f32 v227, v227, v55
    v_accvgpr_write_b32 a92, v224
    v_accvgpr_write_b32 a93, v225
    v_accvgpr_write_b32 a94, v226
    v_accvgpr_write_b32 a95, v227
    v_accvgpr_read_b32 v224, a96
    v_accvgpr_read_b32 v225, a97
    v_accvgpr_read_b32 v226, a98
    v_accvgpr_read_b32 v227, a99
    v_mul_f32 v224, v224, v52
    v_mul_f32 v225, v225, v52
    v_mul_f32 v226, v226, v52
    v_mul_f32 v227, v227, v52
    v_accvgpr_write_b32 a96, v224
    v_accvgpr_write_b32 a97, v225
    v_accvgpr_write_b32 a98, v226
    v_accvgpr_write_b32 a99, v227
    v_accvgpr_read_b32 v224, a100
    v_accvgpr_read_b32 v225, a101
    v_accvgpr_read_b32 v226, a102
    v_accvgpr_read_b32 v227, a103
    v_mul_f32 v224, v224, v53
    v_mul_f32 v225, v225, v53
    v_mul_f32 v226, v226, v53
    v_mul_f32 v227, v227, v53
    v_accvgpr_write_b32 a100, v224
    v_accvgpr_write_b32 a101, v225
    v_accvgpr_write_b32 a102, v226
    v_accvgpr_write_b32 a103, v227
    v_accvgpr_read_b32 v224, a104
    v_accvgpr_read_b32 v225, a105
    v_accvgpr_read_b32 v226, a106
    v_accvgpr_read_b32 v227, a107
    v_mul_f32 v224, v224, v54
    v_mul_f32 v225, v225, v54
    v_mul_f32 v226, v226, v54
    v_mul_f32 v227, v227, v54
    v_accvgpr_write_b32 a104, v224
    v_accvgpr_write_b32 a105, v225
    v_accvgpr_write_b32 a106, v226
    v_accvgpr_write_b32 a107, v227
    v_accvgpr_read_b32 v224, a108
    v_accvgpr_read_b32 v225, a109
    v_accvgpr_read_b32 v226, a110
    v_accvgpr_read_b32 v227, a111
    v_mul_f32 v224, v224, v55
    v_mul_f32 v225, v225, v55
    v_mul_f32 v226, v226, v55
    v_mul_f32 v227, v227, v55
    v_accvgpr_write_b32 a108, v224
    v_accvgpr_write_b32 a109, v225
    v_accvgpr_write_b32 a110, v226
    v_accvgpr_write_b32 a111, v227
    v_accvgpr_read_b32 v224, a112
    v_accvgpr_read_b32 v225, a113
    v_accvgpr_read_b32 v226, a114
    v_accvgpr_read_b32 v227, a115
    v_mul_f32 v224, v224, v52
    v_mul_f32 v225, v225, v52
    v_mul_f32 v226, v226, v52
    v_mul_f32 v227, v227, v52
    v_accvgpr_write_b32 a112, v224
    v_accvgpr_write_b32 a113, v225
    v_accvgpr_write_b32 a114, v226
    v_accvgpr_write_b32 a115, v227
    v_accvgpr_read_b32 v224, a116
    v_accvgpr_read_b32 v225, a117
    v_accvgpr_read_b32 v226, a118
    v_accvgpr_read_b32 v227, a119
    v_mul_f32 v224, v224, v53
    v_mul_f32 v225, v225, v53
    v_mul_f32 v226, v226, v53
    v_mul_f32 v227, v227, v53
    v_accvgpr_write_b32 a116, v224
    v_accvgpr_write_b32 a117, v225
    v_accvgpr_write_b32 a118, v226
    v_accvgpr_write_b32 a119, v227
    v_accvgpr_read_b32 v224, a120
    v_accvgpr_read_b32 v225, a121
    v_accvgpr_read_b32 v226, a122
    v_accvgpr_read_b32 v227, a123
    v_mul_f32 v224, v224, v54
    v_mul_f32 v225, v225, v54
    v_mul_f32 v226, v226, v54
    v_mul_f32 v227, v227, v54
    v_accvgpr_write_b32 a120, v224
    v_accvgpr_write_b32 a121, v225
    v_accvgpr_write_b32 a122, v226
    v_accvgpr_write_b32 a123, v227
    v_accvgpr_read_b32 v224, a124
    v_accvgpr_read_b32 v225, a125
    v_accvgpr_read_b32 v226, a126
    v_accvgpr_read_b32 v227, a127
    v_mul_f32 v224, v224, v55
    v_mul_f32 v225, v225, v55
    v_mul_f32 v226, v226, v55
    v_mul_f32 v227, v227, v55
    v_accvgpr_write_b32 a124, v224
    v_accvgpr_write_b32 a125, v225
    v_accvgpr_write_b32 a126, v226
    v_accvgpr_write_b32 a127, v227
    v_exp_f32 v232, v160
    v_exp_f32 v233, v161
    v_exp_f32 v234, v162
    v_exp_f32 v235, v163
    s_nop 0
    v_cvt_pk_bf16_f32 v208, v232, v233
    v_cvt_pk_bf16_f32 v209, v234, v235
    v_exp_f32 v232, v176
    v_exp_f32 v233, v177
    v_exp_f32 v234, v178
    v_exp_f32 v235, v179
    s_nop 0
    v_cvt_pk_bf16_f32 v210, v232, v233
    v_cvt_pk_bf16_f32 v211, v234, v235
    v_exp_f32 v232, v164
    v_exp_f32 v233, v165
    v_exp_f32 v234, v166
    v_exp_f32 v235, v167
    s_nop 0
    v_cvt_pk_bf16_f32 v212, v232, v233
    v_cvt_pk_bf16_f32 v213, v234, v235
    v_exp_f32 v232, v180
    v_exp_f32 v233, v181
    v_exp_f32 v234, v182
    v_exp_f32 v235, v183
    s_nop 0
    v_cvt_pk_bf16_f32 v214, v232, v233
    v_cvt_pk_bf16_f32 v215, v234, v235
    v_exp_f32 v232, v168
    v_exp_f32 v233, v169
    v_exp_f32 v234, v170
    v_exp_f32 v235, v171
    s_nop 0
    v_cvt_pk_bf16_f32 v216, v232, v233
    v_cvt_pk_bf16_f32 v217, v234, v235
    v_exp_f32 v232, v184
    v_exp_f32 v233, v185
    v_exp_f32 v234, v186
    v_exp_f32 v235, v187
    s_nop 0
    v_cvt_pk_bf16_f32 v218, v232, v233
    v_cvt_pk_bf16_f32 v219, v234, v235
    v_exp_f32 v232, v172
    v_exp_f32 v233, v173
    v_exp_f32 v234, v174
    v_exp_f32 v235, v175
    s_nop 0
    v_cvt_pk_bf16_f32 v220, v232, v233
    v_cvt_pk_bf16_f32 v221, v234, v235
    v_exp_f32 v232, v188
    v_exp_f32 v233, v189
    v_exp_f32 v234, v190
    v_exp_f32 v235, v191
    s_nop 0
    v_cvt_pk_bf16_f32 v222, v232, v233
    v_cvt_pk_bf16_f32 v223, v234, v235
    s_nop 1
    s_branch k2_ret_58
k2_rare_61:
    s_nop 7
    v_max_f32 v52, v128, v129
    v_max3_f32 v52, v52, v130, v131
    v_max3_f32 v52, v52, v144, v145
    v_max3_f32 v52, v52, v146, v147
    v_max_f32 v53, v132, v133
    v_max3_f32 v53, v53, v134, v135
    v_max3_f32 v53, v53, v148, v149
    v_max3_f32 v53, v53, v150, v151
    v_max_f32 v54, v136, v137
    v_max3_f32 v54, v54, v138, v139
    v_max3_f32 v54, v54, v152, v153
    v_max3_f32 v54, v54, v154, v155
    v_max_f32 v55, v140, v141
    v_max3_f32 v55, v55, v142, v143
    v_max3_f32 v55, v55, v156, v157
    v_max3_f32 v55, v55, v158, v159
    v_mov_b32 v224, v52
    v_mov_b32 v225, v53
    v_mov_b32 v226, v54
    v_mov_b32 v227, v55
    s_nop 1
    v_permlane16_swap_b32 v52, v224
    v_permlane16_swap_b32 v53, v225
    v_permlane16_swap_b32 v54, v226
    v_permlane16_swap_b32 v55, v227
    s_nop 1
    v_max_f32 v52, v52, v224
    v_max_f32 v53, v53, v225
    v_max_f32 v54, v54, v226
    v_max_f32 v55, v55, v227
    v_mov_b32 v224, v52
    v_mov_b32 v225, v53
    v_mov_b32 v226, v54
    v_mov_b32 v227, v55
    s_nop 1
    v_permlane32_swap_b32 v52, v224
    v_permlane32_swap_b32 v53, v225
    v_permlane32_swap_b32 v54, v226
    v_permlane32_swap_b32 v55, v227
    s_nop 1
    v_max_f32 v52, v52, v224
    v_max_f32 v53, v53, v225
    v_max_f32 v54, v54, v226
    v_max_f32 v55, v55, v227
    v_add_f32 v52, 0x41400000, v52
    v_max_f32 v52, 0, v52
    v_add_f32 v53, 0x41400000, v53
    v_max_f32 v53, 0, v53
    v_add_f32 v54, 0x41400000, v54
    v_max_f32 v54, 0, v54
    v_add_f32 v55, 0x41400000, v55
    v_max_f32 v55, 0, v55
    v_sub_f32 v128, v128, v52
    v_sub_f32 v129, v129, v52
    v_sub_f32 v130, v130, v52
    v_sub_f32 v131, v131, v52
    v_sub_f32 v132, v132, v53
    v_sub_f32 v133, v133, v53
    v_sub_f32 v134, v134, v53
    v_sub_f32 v135, v135, v53
    v_sub_f32 v136, v136, v54
    v_sub_f32 v137, v137, v54
    v_sub_f32 v138, v138, v54
    v_sub_f32 v139, v139, v54
    v_sub_f32 v140, v140, v55
    v_sub_f32 v141, v141, v55
    v_sub_f32 v142, v142, v55
    v_sub_f32 v143, v143, v55
    v_sub_f32 v144, v144, v52
    v_sub_f32 v145, v145, v52
    v_sub_f32 v146, v146, v52
    v_sub_f32 v147, v147, v52
    v_sub_f32 v148, v148, v53
    v_sub_f32 v149, v149, v53
    v_sub_f32 v150, v150, v53
    v_sub_f32 v151, v151, v53
    v_sub_f32 v152, v152, v54
    v_sub_f32 v153, v153, v54
    v_sub_f32 v154, v154, v54
    v_sub_f32 v155, v155, v54
    v_sub_f32 v156, v156, v55
    v_sub_f32 v157, v157, v55
    v_sub_f32 v158, v158, v55
    v_sub_f32 v159, v159, v55
    v_sub_f32 v160, v160, v52
    v_sub_f32 v16, v16, v52
    v_sub_f32 v161, v161, v52
    v_sub_f32 v17, v17, v52
    v_sub_f32 v162, v162, v52
    v_sub_f32 v18, v18, v52
    v_sub_f32 v163, v163, v52
    v_sub_f32 v19, v19, v52
    v_sub_f32 v164, v164, v53
    v_sub_f32 v20, v20, v53
    v_sub_f32 v165, v165, v53
    v_sub_f32 v21, v21, v53
    v_sub_f32 v166, v166, v53
    v_sub_f32 v22, v22, v53
    v_sub_f32 v167, v167, v53
    v_sub_f32 v23, v23, v53
    v_sub_f32 v168, v168, v54
    v_sub_f32 v24, v24, v54
    v_sub_f32 v169, v169, v54
    v_sub_f32 v25, v25, v54
    v_sub_f32 v170, v170, v54
    v_sub_f32 v26, v26, v54
    v_sub_f32 v171, v171, v54
    v_sub_f32 v27, v27, v54
    v_sub_f32 v172, v172, v55
    v_sub_f32 v28, v28, v55
    v_sub_f32 v173, v173, v55
    v_sub_f32 v29, v29, v55
    v_sub_f32 v174, v174, v55
    v_sub_f32 v30, v30, v55
    v_sub_f32 v175, v175, v55
    v_sub_f32 v31, v31, v55
    v_sub_f32 v176, v176, v52
    v_sub_f32 v32, v32, v52
    v_sub_f32 v177, v177, v52
    v_sub_f32 v33, v33, v52
    v_sub_f32 v178, v178, v52
    v_sub_f32 v34, v34, v52
    v_sub_f32 v179, v179, v52
    v_sub_f32 v35, v35, v52
    v_sub_f32 v180, v180, v53
    v_sub_f32 v36, v36, v53
    v_sub_f32 v181, v181, v53
    v_sub_f32 v37, v37, v53
    v_sub_f32 v182, v182, v53
    v_sub_f32 v38, v38, v53
    v_sub_f32 v183, v183, v53
    v_sub_f32 v39, v39, v53
    v_sub_f32 v184, v184, v54
    v_sub_f32 v40, v40, v54
    v_sub_f32 v185, v185, v54
    v_sub_f32 v41, v41, v54
    v_sub_f32 v186, v186, v54
    v_sub_f32 v42, v42, v54
    v_sub_f32 v187, v187, v54
    v_sub_f32 v43, v43, v54
    v_sub_f32 v188, v188, v55
    v_sub_f32 v44, v44, v55
    v_sub_f32 v189, v189, v55
    v_sub_f32 v45, v45, v55
    v_sub_f32 v190, v190, v55
    v_sub_f32 v46, v46, v55
    v_sub_f32 v191, v191, v55
    v_sub_f32 v47, v47, v55
    v_sub_f32 v8, v8, v52
    v_exp_f32 v52, -v52
    v_sub_f32 v9, v9, v53
    v_exp_f32 v53, -v53
    v_sub_f32 v10, v10, v54
    v_exp_f32 v54, -v54
    v_sub_f32 v11, v11, v55
    v_exp_f32 v55, -v55
    s_nop 0
    v_mul_f32 v12, v12, v52
    v_mul_f32 v48, v48, v53
    v_mul_f32 v248, v248, v54
    v_mul_f32 v252, v252, v55
    v_accvgpr_read_b32 v224, a0
    v_accvgpr_read_b32 v225, a1
    v_accvgpr_read_b32 v226, a2
    v_accvgpr_read_b32 v227, a3
    v_mul_f32 v224, v224, v52
    v_mul_f32 v225, v225, v52
    v_mul_f32 v226, v226, v52
    v_mul_f32 v227, v227, v52
    v_accvgpr_write_b32 a0, v224
    v_accvgpr_write_b32 a1, v225
    v_accvgpr_write_b32 a2, v226
    v_accvgpr_write_b32 a3, v227
    v_accvgpr_read_b32 v224, a4
    v_accvgpr_read_b32 v225, a5
    v_accvgpr_read_b32 v226, a6
    v_accvgpr_read_b32 v227, a7
    v_mul_f32 v224, v224, v53
    v_mul_f32 v225, v225, v53
    v_mul_f32 v226, v226, v53
    v_mul_f32 v227, v227, v53
    v_accvgpr_write_b32 a4, v224
    v_accvgpr_write_b32 a5, v225
    v_accvgpr_write_b32 a6, v226
    v_accvgpr_write_b32 a7, v227
    v_accvgpr_read_b32 v224, a8
    v_accvgpr_read_b32 v225, a9
    v_accvgpr_read_b32 v226, a10
    v_accvgpr_read_b32 v227, a11
    v_mul_f32 v224, v224, v54
    v_mul_f32 v225, v225, v54
    v_mul_f32 v226, v226, v54
    v_mul_f32 v227, v227, v54
    v_accvgpr_write_b32 a8, v224
    v_accvgpr_write_b32 a9, v225
    v_accvgpr_write_b32 a10, v226
    v_accvgpr_write_b32 a11, v227
    v_accvgpr_read_b32 v224, a12
    v_accvgpr_read_b32 v225, a13
    v_accvgpr_read_b32 v226, a14
    v_accvgpr_read_b32 v227, a15
    v_mul_f32 v224, v224, v55
    v_mul_f32 v225, v225, v55
    v_mul_f32 v226, v226, v55
    v_mul_f32 v227, v227, v55
    v_accvgpr_write_b32 a12, v224
    v_accvgpr_write_b32 a13, v225
    v_accvgpr_write_b32 a14, v226
    v_accvgpr_write_b32 a15, v227
    v_accvgpr_read_b32 v224, a16
    v_accvgpr_read_b32 v225, a17
    v_accvgpr_read_b32 v226, a18
    v_accvgpr_read_b32 v227, a19
    v_mul_f32 v224, v224, v52
    v_mul_f32 v225, v225, v52
    v_mul_f32 v226, v226, v52
    v_mul_f32 v227, v227, v52
    v_accvgpr_write_b32 a16, v224
    v_accvgpr_write_b32 a17, v225
    v_accvgpr_write_b32 a18, v226
    v_accvgpr_write_b32 a19, v227
    v_accvgpr_read_b32 v224, a20
    v_accvgpr_read_b32 v225, a21
    v_accvgpr_read_b32 v226, a22
    v_accvgpr_read_b32 v227, a23
    v_mul_f32 v224, v224, v53
    v_mul_f32 v225, v225, v53
    v_mul_f32 v226, v226, v53
    v_mul_f32 v227, v227, v53
    v_accvgpr_write_b32 a20, v224
    v_accvgpr_write_b32 a21, v225
    v_accvgpr_write_b32 a22, v226
    v_accvgpr_write_b32 a23, v227
    v_accvgpr_read_b32 v224, a24
    v_accvgpr_read_b32 v225, a25
    v_accvgpr_read_b32 v226, a26
    v_accvgpr_read_b32 v227, a27
    v_mul_f32 v224, v224, v54
    v_mul_f32 v225, v225, v54
    v_mul_f32 v226, v226, v54
    v_mul_f32 v227, v227, v54
    v_accvgpr_write_b32 a24, v224
    v_accvgpr_write_b32 a25, v225
    v_accvgpr_write_b32 a26, v226
    v_accvgpr_write_b32 a27, v227
    v_accvgpr_read_b32 v224, a28
    v_accvgpr_read_b32 v225, a29
    v_accvgpr_read_b32 v226, a30
    v_accvgpr_read_b32 v227, a31
    v_mul_f32 v224, v224, v55
    v_mul_f32 v225, v225, v55
    v_mul_f32 v226, v226, v55
    v_mul_f32 v227, v227, v55
    v_accvgpr_write_b32 a28, v224
    v_accvgpr_write_b32 a29, v225
    v_accvgpr_write_b32 a30, v226
    v_accvgpr_write_b32 a31, v227
    v_accvgpr_read_b32 v224, a32
    v_accvgpr_read_b32 v225, a33
    v_accvgpr_read_b32 v226, a34
    v_accvgpr_read_b32 v227, a35
    v_mul_f32 v224, v224, v52
    v_mul_f32 v225, v225, v52
    v_mul_f32 v226, v226, v52
    v_mul_f32 v227, v227, v52
    v_accvgpr_write_b32 a32, v224
    v_accvgpr_write_b32 a33, v225
    v_accvgpr_write_b32 a34, v226
    v_accvgpr_write_b32 a35, v227
    v_accvgpr_read_b32 v224, a36
    v_accvgpr_read_b32 v225, a37
    v_accvgpr_read_b32 v226, a38
    v_accvgpr_read_b32 v227, a39
    v_mul_f32 v224, v224, v53
    v_mul_f32 v225, v225, v53
    v_mul_f32 v226, v226, v53
    v_mul_f32 v227, v227, v53
    v_accvgpr_write_b32 a36, v224
    v_accvgpr_write_b32 a37, v225
    v_accvgpr_write_b32 a38, v226
    v_accvgpr_write_b32 a39, v227
    v_accvgpr_read_b32 v224, a40
    v_accvgpr_read_b32 v225, a41
    v_accvgpr_read_b32 v226, a42
    v_accvgpr_read_b32 v227, a43
    v_mul_f32 v224, v224, v54
    v_mul_f32 v225, v225, v54
    v_mul_f32 v226, v226, v54
    v_mul_f32 v227, v227, v54
    v_accvgpr_write_b32 a40, v224
    v_accvgpr_write_b32 a41, v225
    v_accvgpr_write_b32 a42, v226
    v_accvgpr_write_b32 a43, v227
    v_accvgpr_read_b32 v224, a44
    v_accvgpr_read_b32 v225, a45
    v_accvgpr_read_b32 v226, a46
    v_accvgpr_read_b32 v227, a47
    v_mul_f32 v224, v224, v55
    v_mul_f32 v225, v225, v55
    v_mul_f32 v226, v226, v55
    v_mul_f32 v227, v227, v55
    v_accvgpr_write_b32 a44, v224
    v_accvgpr_write_b32 a45, v225
    v_accvgpr_write_b32 a46, v226
    v_accvgpr_write_b32 a47, v227
    v_accvgpr_read_b32 v224, a48
    v_accvgpr_read_b32 v225, a49
    v_accvgpr_read_b32 v226, a50
    v_accvgpr_read_b32 v227, a51
    v_mul_f32 v224, v224, v52
    v_mul_f32 v225, v225, v52
    v_mul_f32 v226, v226, v52
    v_mul_f32 v227, v227, v52
    v_accvgpr_write_b32 a48, v224
    v_accvgpr_write_b32 a49, v225
    v_accvgpr_write_b32 a50, v226
    v_accvgpr_write_b32 a51, v227
    v_accvgpr_read_b32 v224, a52
    v_accvgpr_read_b32 v225, a53
    v_accvgpr_read_b32 v226, a54
    v_accvgpr_read_b32 v227, a55
    v_mul_f32 v224, v224, v53
    v_mul_f32 v225, v225, v53
    v_mul_f32 v226, v226, v53
    v_mul_f32 v227, v227, v53
    v_accvgpr_write_b32 a52, v224
    v_accvgpr_write_b32 a53, v225
    v_accvgpr_write_b32 a54, v226
    v_accvgpr_write_b32 a55, v227
    v_accvgpr_read_b32 v224, a56
    v_accvgpr_read_b32 v225, a57
    v_accvgpr_read_b32 v226, a58
    v_accvgpr_read_b32 v227, a59
    v_mul_f32 v224, v224, v54
    v_mul_f32 v225, v225, v54
    v_mul_f32 v226, v226, v54
    v_mul_f32 v227, v227, v54
    v_accvgpr_write_b32 a56, v224
    v_accvgpr_write_b32 a57, v225
    v_accvgpr_write_b32 a58, v226
    v_accvgpr_write_b32 a59, v227
    v_accvgpr_read_b32 v224, a60
    v_accvgpr_read_b32 v225, a61
    v_accvgpr_read_b32 v226, a62
    v_accvgpr_read_b32 v227, a63
    v_mul_f32 v224, v224, v55
    v_mul_f32 v225, v225, v55
    v_mul_f32 v226, v226, v55
    v_mul_f32 v227, v227, v55
    v_accvgpr_write_b32 a60, v224
    v_accvgpr_write_b32 a61, v225
    v_accvgpr_write_b32 a62, v226
    v_accvgpr_write_b32 a63, v227
    v_accvgpr_read_b32 v224, a64
    v_accvgpr_read_b32 v225, a65
    v_accvgpr_read_b32 v226, a66
    v_accvgpr_read_b32 v227, a67
    v_mul_f32 v224, v224, v52
    v_mul_f32 v225, v225, v52
    v_mul_f32 v226, v226, v52
    v_mul_f32 v227, v227, v52
    v_accvgpr_write_b32 a64, v224
    v_accvgpr_write_b32 a65, v225
    v_accvgpr_write_b32 a66, v226
    v_accvgpr_write_b32 a67, v227
    v_accvgpr_read_b32 v224, a68
    v_accvgpr_read_b32 v225, a69
    v_accvgpr_read_b32 v226, a70
    v_accvgpr_read_b32 v227, a71
    v_mul_f32 v224, v224, v53
    v_mul_f32 v225, v225, v53
    v_mul_f32 v226, v226, v53
    v_mul_f32 v227, v227, v53
    v_accvgpr_write_b32 a68, v224
    v_accvgpr_write_b32 a69, v225
    v_accvgpr_write_b32 a70, v226
    v_accvgpr_write_b32 a71, v227
    v_accvgpr_read_b32 v224, a72
    v_accvgpr_read_b32 v225, a73
    v_accvgpr_read_b32 v226, a74
    v_accvgpr_read_b32 v227, a75
    v_mul_f32 v224, v224, v54
    v_mul_f32 v225, v225, v54
    v_mul_f32 v226, v226, v54
    v_mul_f32 v227, v227, v54
    v_accvgpr_write_b32 a72, v224
    v_accvgpr_write_b32 a73, v225
    v_accvgpr_write_b32 a74, v226
    v_accvgpr_write_b32 a75, v227
    v_accvgpr_read_b32 v224, a76
    v_accvgpr_read_b32 v225, a77
    v_accvgpr_read_b32 v226, a78
    v_accvgpr_read_b32 v227, a79
    v_mul_f32 v224, v224, v55
    v_mul_f32 v225, v225, v55
    v_mul_f32 v226, v226, v55
    v_mul_f32 v227, v227, v55
    v_accvgpr_write_b32 a76, v224
    v_accvgpr_write_b32 a77, v225
    v_accvgpr_write_b32 a78, v226
    v_accvgpr_write_b32 a79, v227
    v_accvgpr_read_b32 v224, a80
    v_accvgpr_read_b32 v225, a81
    v_accvgpr_read_b32 v226, a82
    v_accvgpr_read_b32 v227, a83
    v_mul_f32 v224, v224, v52
    v_mul_f32 v225, v225, v52
    v_mul_f32 v226, v226, v52
    v_mul_f32 v227, v227, v52
    v_accvgpr_write_b32 a80, v224
    v_accvgpr_write_b32 a81, v225
    v_accvgpr_write_b32 a82, v226
    v_accvgpr_write_b32 a83, v227
    v_accvgpr_read_b32 v224, a84
    v_accvgpr_read_b32 v225, a85
    v_accvgpr_read_b32 v226, a86
    v_accvgpr_read_b32 v227, a87
    v_mul_f32 v224, v224, v53
    v_mul_f32 v225, v225, v53
    v_mul_f32 v226, v226, v53
    v_mul_f32 v227, v227, v53
    v_accvgpr_write_b32 a84, v224
    v_accvgpr_write_b32 a85, v225
    v_accvgpr_write_b32 a86, v226
    v_accvgpr_write_b32 a87, v227
    v_accvgpr_read_b32 v224, a88
    v_accvgpr_read_b32 v225, a89
    v_accvgpr_read_b32 v226, a90
    v_accvgpr_read_b32 v227, a91
    v_mul_f32 v224, v224, v54
    v_mul_f32 v225, v225, v54
    v_mul_f32 v226, v226, v54
    v_mul_f32 v227, v227, v54
    v_accvgpr_write_b32 a88, v224
    v_accvgpr_write_b32 a89, v225
    v_accvgpr_write_b32 a90, v226
    v_accvgpr_write_b32 a91, v227
    v_accvgpr_read_b32 v224, a92
    v_accvgpr_read_b32 v225, a93
    v_accvgpr_read_b32 v226, a94
    v_accvgpr_read_b32 v227, a95
    v_mul_f32 v224, v224, v55
    v_mul_f32 v225, v225, v55
    v_mul_f32 v226, v226, v55
    v_mul_f32 v227, v227, v55
    v_accvgpr_write_b32 a92, v224
    v_accvgpr_write_b32 a93, v225
    v_accvgpr_write_b32 a94, v226
    v_accvgpr_write_b32 a95, v227
    v_accvgpr_read_b32 v224, a96
    v_accvgpr_read_b32 v225, a97
    v_accvgpr_read_b32 v226, a98
    v_accvgpr_read_b32 v227, a99
    v_mul_f32 v224, v224, v52
    v_mul_f32 v225, v225, v52
    v_mul_f32 v226, v226, v52
    v_mul_f32 v227, v227, v52
    v_accvgpr_write_b32 a96, v224
    v_accvgpr_write_b32 a97, v225
    v_accvgpr_write_b32 a98, v226
    v_accvgpr_write_b32 a99, v227
    v_accvgpr_read_b32 v224, a100
    v_accvgpr_read_b32 v225, a101
    v_accvgpr_read_b32 v226, a102
    v_accvgpr_read_b32 v227, a103
    v_mul_f32 v224, v224, v53
    v_mul_f32 v225, v225, v53
    v_mul_f32 v226, v226, v53
    v_mul_f32 v227, v227, v53
    v_accvgpr_write_b32 a100, v224
    v_accvgpr_write_b32 a101, v225
    v_accvgpr_write_b32 a102, v226
    v_accvgpr_write_b32 a103, v227
    v_accvgpr_read_b32 v224, a104
    v_accvgpr_read_b32 v225, a105
    v_accvgpr_read_b32 v226, a106
    v_accvgpr_read_b32 v227, a107
    v_mul_f32 v224, v224, v54
    v_mul_f32 v225, v225, v54
    v_mul_f32 v226, v226, v54
    v_mul_f32 v227, v227, v54
    v_accvgpr_write_b32 a104, v224
    v_accvgpr_write_b32 a105, v225
    v_accvgpr_write_b32 a106, v226
    v_accvgpr_write_b32 a107, v227
    v_accvgpr_read_b32 v224, a108
    v_accvgpr_read_b32 v225, a109
    v_accvgpr_read_b32 v226, a110
    v_accvgpr_read_b32 v227, a111
    v_mul_f32 v224, v224, v55
    v_mul_f32 v225, v225, v55
    v_mul_f32 v226, v226, v55
    v_mul_f32 v227, v227, v55
    v_accvgpr_write_b32 a108, v224
    v_accvgpr_write_b32 a109, v225
    v_accvgpr_write_b32 a110, v226
    v_accvgpr_write_b32 a111, v227
    v_accvgpr_read_b32 v224, a112
    v_accvgpr_read_b32 v225, a113
    v_accvgpr_read_b32 v226, a114
    v_accvgpr_read_b32 v227, a115
    v_mul_f32 v224, v224, v52
    v_mul_f32 v225, v225, v52
    v_mul_f32 v226, v226, v52
    v_mul_f32 v227, v227, v52
    v_accvgpr_write_b32 a112, v224
    v_accvgpr_write_b32 a113, v225
    v_accvgpr_write_b32 a114, v226
    v_accvgpr_write_b32 a115, v227
    v_accvgpr_read_b32 v224, a116
    v_accvgpr_read_b32 v225, a117
    v_accvgpr_read_b32 v226, a118
    v_accvgpr_read_b32 v227, a119
    v_mul_f32 v224, v224, v53
    v_mul_f32 v225, v225, v53
    v_mul_f32 v226, v226, v53
    v_mul_f32 v227, v227, v53
    v_accvgpr_write_b32 a116, v224
    v_accvgpr_write_b32 a117, v225
    v_accvgpr_write_b32 a118, v226
    v_accvgpr_write_b32 a119, v227
    v_accvgpr_read_b32 v224, a120
    v_accvgpr_read_b32 v225, a121
    v_accvgpr_read_b32 v226, a122
    v_accvgpr_read_b32 v227, a123
    v_mul_f32 v224, v224, v54
    v_mul_f32 v225, v225, v54
    v_mul_f32 v226, v226, v54
    v_mul_f32 v227, v227, v54
    v_accvgpr_write_b32 a120, v224
    v_accvgpr_write_b32 a121, v225
    v_accvgpr_write_b32 a122, v226
    v_accvgpr_write_b32 a123, v227
    v_accvgpr_read_b32 v224, a124
    v_accvgpr_read_b32 v225, a125
    v_accvgpr_read_b32 v226, a126
    v_accvgpr_read_b32 v227, a127
    v_mul_f32 v224, v224, v55
    v_mul_f32 v225, v225, v55
    v_mul_f32 v226, v226, v55
    v_mul_f32 v227, v227, v55
    v_accvgpr_write_b32 a124, v224
    v_accvgpr_write_b32 a125, v225
    v_accvgpr_write_b32 a126, v226
    v_accvgpr_write_b32 a127, v227
    v_exp_f32 v232, v128
    v_exp_f32 v233, v129
    v_exp_f32 v234, v130
    v_exp_f32 v235, v131
    s_nop 0
    v_cvt_pk_bf16_f32 v192, v232, v233
    v_cvt_pk_bf16_f32 v193, v234, v235
    v_exp_f32 v232, v144
    v_exp_f32 v233, v145
    v_exp_f32 v234, v146
    v_exp_f32 v235, v147
    s_nop 0
    v_cvt_pk_bf16_f32 v194, v232, v233
    v_cvt_pk_bf16_f32 v195, v234, v235
    v_exp_f32 v232, v132
    v_exp_f32 v233, v133
    v_exp_f32 v234, v134
    v_exp_f32 v235, v135
    s_nop 0
    v_cvt_pk_bf16_f32 v196, v232, v233
    v_cvt_pk_bf16_f32 v197, v234, v235
    v_exp_f32 v232, v148
    v_exp_f32 v233, v149
    v_exp_f32 v234, v150
    v_exp_f32 v235, v151
    s_nop 0
    v_cvt_pk_bf16_f32 v198, v232, v233
    v_cvt_pk_bf16_f32 v199, v234, v235
    v_exp_f32 v232, v136
    v_exp_f32 v233, v137
    v_exp_f32 v234, v138
    v_exp_f32 v235, v139
    s_nop 0
    v_cvt_pk_bf16_f32 v200, v232, v233
    v_cvt_pk_bf16_f32 v201, v234, v235
    v_exp_f32 v232, v152
    v_exp_f32 v233, v153
    v_exp_f32 v234, v154
    v_exp_f32 v235, v155
    s_nop 0
    v_cvt_pk_bf16_f32 v202, v232, v233
    v_cvt_pk_bf16_f32 v203, v234, v235
    v_exp_f32 v232, v140
    v_exp_f32 v233, v141
    v_exp_f32 v234, v142
    v_exp_f32 v235, v143
    s_nop 0
    v_cvt_pk_bf16_f32 v204, v232, v233
    v_cvt_pk_bf16_f32 v205, v234, v235
    v_exp_f32 v232, v156
    v_exp_f32 v233, v157
    v_exp_f32 v234, v158
    v_exp_f32 v235, v159
    s_nop 0
    v_cvt_pk_bf16_f32 v206, v232, v233
    v_cvt_pk_bf16_f32 v207, v234, v235
    s_nop 1
    s_branch k2_ret_62
k2_rare_65:
    s_nop 7
    v_max_f32 v52, v160, v161
    v_max3_f32 v52, v52, v162, v163
    v_max3_f32 v52, v52, v176, v177
    v_max3_f32 v52, v52, v178, v179
    v_max_f32 v53, v164, v165
    v_max3_f32 v53, v53, v166, v167
    v_max3_f32 v53, v53, v180, v181
    v_max3_f32 v53, v53, v182, v183
    v_max_f32 v54, v168, v169
    v_max3_f32 v54, v54, v170, v171
    v_max3_f32 v54, v54, v184, v185
    v_max3_f32 v54, v54, v186, v187
    v_max_f32 v55, v172, v173
    v_max3_f32 v55, v55, v174, v175
    v_max3_f32 v55, v55, v188, v189
    v_max3_f32 v55, v55, v190, v191
    v_mov_b32 v224, v52
    v_mov_b32 v225, v53
    v_mov_b32 v226, v54
    v_mov_b32 v227, v55
    s_nop 1
    v_permlane16_swap_b32 v52, v224
    v_permlane16_swap_b32 v53, v225
    v_permlane16_swap_b32 v54, v226
    v_permlane16_swap_b32 v55, v227
    s_nop 1
    v_max_f32 v52, v52, v224
    v_max_f32 v53, v53, v225
    v_max_f32 v54, v54, v226
    v_max_f32 v55, v55, v227
    v_mov_b32 v224, v52
    v_mov_b32 v225, v53
    v_mov_b32 v226, v54
    v_mov_b32 v227, v55
    s_nop 1
    v_permlane32_swap_b32 v52, v224
    v_permlane32_swap_b32 v53, v225
    v_permlane32_swap_b32 v54, v226
    v_permlane32_swap_b32 v55, v227
    s_nop 1
    v_max_f32 v52, v52, v224
    v_max_f32 v53, v53, v225
    v_max_f32 v54, v54, v226
    v_max_f32 v55, v55, v227
    v_add_f32 v52, 0x41400000, v52
    v_max_f32 v52, 0, v52
    v_add_f32 v53, 0x41400000, v53
    v_max_f32 v53, 0, v53
    v_add_f32 v54, 0x41400000, v54
    v_max_f32 v54, 0, v54
    v_add_f32 v55, 0x41400000, v55
    v_max_f32 v55, 0, v55
    v_sub_f32 v160, v160, v52
    v_sub_f32 v161, v161, v52
    v_sub_f32 v162, v162, v52
    v_sub_f32 v163, v163, v52
    v_sub_f32 v164, v164, v53
    v_sub_f32 v165, v165, v53
    v_sub_f32 v166, v166, v53
    v_sub_f32 v167, v167, v53
    v_sub_f32 v168, v168, v54
    v_sub_f32 v169, v169, v54
    v_sub_f32 v170, v170, v54
    v_sub_f32 v171, v171, v54
    v_sub_f32 v172, v172, v55
    v_sub_f32 v173, v173, v55
    v_sub_f32 v174, v174, v55
    v_sub_f32 v175, v175, v55
    v_sub_f32 v176, v176, v52
    v_sub_f32 v177, v177, v52
    v_sub_f32 v178, v178, v52
    v_sub_f32 v179, v179, v52
    v_sub_f32 v180, v180, v53
    v_sub_f32 v181, v181, v53
    v_sub_f32 v182, v182, v53
    v_sub_f32 v183, v183, v53
    v_sub_f32 v184, v184, v54
    v_sub_f32 v185, v185, v54
    v_sub_f32 v186, v186, v54
    v_sub_f32 v187, v187, v54
    v_sub_f32 v188, v188, v55
    v_sub_f32 v189, v189, v55
    v_sub_f32 v190, v190, v55
    v_sub_f32 v191, v191, v55
    v_sub_f32 v128, v128, v54
    v_sub_f32 v16, v16, v54
    v_sub_f32 v129, v129, v54
    v_sub_f32 v17, v17, v54
    v_sub_f32 v130, v130, v54
    v_sub_f32 v18, v18, v54
    v_sub_f32 v131, v131, v54
    v_sub_f32 v19, v19, v54
    v_sub_f32 v132, v132, v55
    v_sub_f32 v20, v20, v55
    v_sub_f32 v133, v133, v55
    v_sub_f32 v21, v21, v55
    v_sub_f32 v134, v134, v55
    v_sub_f32 v22, v22, v55
    v_sub_f32 v135, v135, v55
    v_sub_f32 v23, v23, v55
    v_sub_f32 v136, v136, v54
    v_sub_f32 v24, v24, v54
    v_sub_f32 v137, v137, v54
    v_sub_f32 v25, v25, v54
    v_sub_f32 v138, v138, v54
    v_sub_f32 v26, v26, v54
    v_sub_f32 v139, v139, v54
    v_sub_f32 v27, v27, v54
    v_sub_f32 v140, v140, v55
    v_sub_f32 v28, v28, v55
    v_sub_f32 v141, v141, v55
    v_sub_f32 v29, v29, v55
    v_sub_f32 v142, v142, v55
    v_sub_f32 v30, v30, v55
    v_sub_f32 v143, v143, v55
    v_sub_f32 v31, v31, v55
    v_sub_f32 v144, v144, v54
    v_sub_f32 v32, v32, v54
    v_sub_f32 v145, v145, v54
    v_sub_f32 v33, v33, v54
    v_sub_f32 v146, v146, v54
    v_sub_f32 v34, v34, v54
    v_sub_f32 v147, v147, v54
    v_sub_f32 v35, v35, v54
    v_sub_f32 v148, v148, v55
    v_sub_f32 v36, v36, v55
    v_sub_f32 v149, v149, v55
    v_sub_f32 v37, v37, v55
    v_sub_f32 v150, v150, v55
    v_sub_f32 v38, v38, v55
    v_sub_f32 v151, v151, v55
    v_sub_f32 v39, v39, v55
    v_sub_f32 v152, v152, v54
    v_sub_f32 v40, v40, v54
    v_sub_f32 v153, v153, v54
    v_sub_f32 v41, v41, v54
    v_sub_f32 v154, v154, v54
    v_sub_f32 v42, v42, v54
    v_sub_f32 v155, v155, v54
    v_sub_f32 v43, v43, v54
    v_sub_f32 v156, v156, v55
    v_sub_f32 v44, v44, v55
    v_sub_f32 v157, v157, v55
    v_sub_f32 v45, v45, v55
    v_sub_f32 v158, v158, v55
    v_sub_f32 v46, v46, v55
    v_sub_f32 v159, v159, v55
    v_sub_f32 v47, v47, v55
    v_sub_f32 v8, v8, v52
    v_exp_f32 v52, -v52
    v_sub_f32 v9, v9, v53
    v_exp_f32 v53, -v53
    v_sub_f32 v10, v10, v54
    v_exp_f32 v54, -v54
    v_sub_f32 v11, v11, v55
    v_exp_f32 v55, -v55
    s_nop 0
    v_mul_f32 v12, v12, v52
    v_mul_f32 v48, v48, v53
    v_mul_f32 v248, v248, v54
    v_mul_f32 v252, v252, v55
    v_accvgpr_read_b32 v224, a0
    v_accvgpr_read_b32 v225, a1
    v_accvgpr_read_b32 v226, a2
    v_accvgpr_read_b32 v227, a3
    v_mul_f32 v224, v224, v52
    v_mul_f32 v225, v225, v52
    v_mul_f32 v226, v226, v52
    v_mul_f32 v227, v227, v52
    v_accvgpr_write_b32 a0, v224
    v_accvgpr_write_b32 a1, v225
    v_accvgpr_write_b32 a2, v226
    v_accvgpr_write_b32 a3, v227
    v_accvgpr_read_b32 v224, a4
    v_accvgpr_read_b32 v225, a5
    v_accvgpr_read_b32 v226, a6
    v_accvgpr_read_b32 v227, a7
    v_mul_f32 v224, v224, v53
    v_mul_f32 v225, v225, v53
    v_mul_f32 v226, v226, v53
    v_mul_f32 v227, v227, v53
    v_accvgpr_write_b32 a4, v224
    v_accvgpr_write_b32 a5, v225
    v_accvgpr_write_b32 a6, v226
    v_accvgpr_write_b32 a7, v227
    v_accvgpr_read_b32 v224, a8
    v_accvgpr_read_b32 v225, a9
    v_accvgpr_read_b32 v226, a10
    v_accvgpr_read_b32 v227, a11
    v_mul_f32 v224, v224, v54
    v_mul_f32 v225, v225, v54
    v_mul_f32 v226, v226, v54
    v_mul_f32 v227, v227, v54
    v_accvgpr_write_b32 a8, v224
    v_accvgpr_write_b32 a9, v225
    v_accvgpr_write_b32 a10, v226
    v_accvgpr_write_b32 a11, v227
    v_accvgpr_read_b32 v224, a12
    v_accvgpr_read_b32 v225, a13
    v_accvgpr_read_b32 v226, a14
    v_accvgpr_read_b32 v227, a15
    v_mul_f32 v224, v224, v55
    v_mul_f32 v225, v225, v55
    v_mul_f32 v226, v226, v55
    v_mul_f32 v227, v227, v55
    v_accvgpr_write_b32 a12, v224
    v_accvgpr_write_b32 a13, v225
    v_accvgpr_write_b32 a14, v226
    v_accvgpr_write_b32 a15, v227
    v_accvgpr_read_b32 v224, a16
    v_accvgpr_read_b32 v225, a17
    v_accvgpr_read_b32 v226, a18
    v_accvgpr_read_b32 v227, a19
    v_mul_f32 v224, v224, v52
    v_mul_f32 v225, v225, v52
    v_mul_f32 v226, v226, v52
    v_mul_f32 v227, v227, v52
    v_accvgpr_write_b32 a16, v224
    v_accvgpr_write_b32 a17, v225
    v_accvgpr_write_b32 a18, v226
    v_accvgpr_write_b32 a19, v227
    v_accvgpr_read_b32 v224, a20
    v_accvgpr_read_b32 v225, a21
    v_accvgpr_read_b32 v226, a22
    v_accvgpr_read_b32 v227, a23
    v_mul_f32 v224, v224, v53
    v_mul_f32 v225, v225, v53
    v_mul_f32 v226, v226, v53
    v_mul_f32 v227, v227, v53
    v_accvgpr_write_b32 a20, v224
    v_accvgpr_write_b32 a21, v225
    v_accvgpr_write_b32 a22, v226
    v_accvgpr_write_b32 a23, v227
    v_accvgpr_read_b32 v224, a24
    v_accvgpr_read_b32 v225, a25
    v_accvgpr_read_b32 v226, a26
    v_accvgpr_read_b32 v227, a27
    v_mul_f32 v224, v224, v54
    v_mul_f32 v225, v225, v54
    v_mul_f32 v226, v226, v54
    v_mul_f32 v227, v227, v54
    v_accvgpr_write_b32 a24, v224
    v_accvgpr_write_b32 a25, v225
    v_accvgpr_write_b32 a26, v226
    v_accvgpr_write_b32 a27, v227
    v_accvgpr_read_b32 v224, a28
    v_accvgpr_read_b32 v225, a29
    v_accvgpr_read_b32 v226, a30
    v_accvgpr_read_b32 v227, a31
    v_mul_f32 v224, v224, v55
    v_mul_f32 v225, v225, v55
    v_mul_f32 v226, v226, v55
    v_mul_f32 v227, v227, v55
    v_accvgpr_write_b32 a28, v224
    v_accvgpr_write_b32 a29, v225
    v_accvgpr_write_b32 a30, v226
    v_accvgpr_write_b32 a31, v227
    v_accvgpr_read_b32 v224, a32
    v_accvgpr_read_b32 v225, a33
    v_accvgpr_read_b32 v226, a34
    v_accvgpr_read_b32 v227, a35
    v_mul_f32 v224, v224, v52
    v_mul_f32 v225, v225, v52
    v_mul_f32 v226, v226, v52
    v_mul_f32 v227, v227, v52
    v_accvgpr_write_b32 a32, v224
    v_accvgpr_write_b32 a33, v225
    v_accvgpr_write_b32 a34, v226
    v_accvgpr_write_b32 a35, v227
    v_accvgpr_read_b32 v224, a36
    v_accvgpr_read_b32 v225, a37
    v_accvgpr_read_b32 v226, a38
    v_accvgpr_read_b32 v227, a39
    v_mul_f32 v224, v224, v53
    v_mul_f32 v225, v225, v53
    v_mul_f32 v226, v226, v53
    v_mul_f32 v227, v227, v53
    v_accvgpr_write_b32 a36, v224
    v_accvgpr_write_b32 a37, v225
    v_accvgpr_write_b32 a38, v226
    v_accvgpr_write_b32 a39, v227
    v_accvgpr_read_b32 v224, a40
    v_accvgpr_read_b32 v225, a41
    v_accvgpr_read_b32 v226, a42
    v_accvgpr_read_b32 v227, a43
    v_mul_f32 v224, v224, v54
    v_mul_f32 v225, v225, v54
    v_mul_f32 v226, v226, v54
    v_mul_f32 v227, v227, v54
    v_accvgpr_write_b32 a40, v224
    v_accvgpr_write_b32 a41, v225
    v_accvgpr_write_b32 a42, v226
    v_accvgpr_write_b32 a43, v227
    v_accvgpr_read_b32 v224, a44
    v_accvgpr_read_b32 v225, a45
    v_accvgpr_read_b32 v226, a46
    v_accvgpr_read_b32 v227, a47
    v_mul_f32 v224, v224, v55
    v_mul_f32 v225, v225, v55
    v_mul_f32 v226, v226, v55
    v_mul_f32 v227, v227, v55
    v_accvgpr_write_b32 a44, v224
    v_accvgpr_write_b32 a45, v225
    v_accvgpr_write_b32 a46, v226
    v_accvgpr_write_b32 a47, v227
    v_accvgpr_read_b32 v224, a48
    v_accvgpr_read_b32 v225, a49
    v_accvgpr_read_b32 v226, a50
    v_accvgpr_read_b32 v227, a51
    v_mul_f32 v224, v224, v52
    v_mul_f32 v225, v225, v52
    v_mul_f32 v226, v226, v52
    v_mul_f32 v227, v227, v52
    v_accvgpr_write_b32 a48, v224
    v_accvgpr_write_b32 a49, v225
    v_accvgpr_write_b32 a50, v226
    v_accvgpr_write_b32 a51, v227
    v_accvgpr_read_b32 v224, a52
    v_accvgpr_read_b32 v225, a53
    v_accvgpr_read_b32 v226, a54
    v_accvgpr_read_b32 v227, a55
    v_mul_f32 v224, v224, v53
    v_mul_f32 v225, v225, v53
    v_mul_f32 v226, v226, v53
    v_mul_f32 v227, v227, v53
    v_accvgpr_write_b32 a52, v224
    v_accvgpr_write_b32 a53, v225
    v_accvgpr_write_b32 a54, v226
    v_accvgpr_write_b32 a55, v227
    v_accvgpr_read_b32 v224, a56
    v_accvgpr_read_b32 v225, a57
    v_accvgpr_read_b32 v226, a58
    v_accvgpr_read_b32 v227, a59
    v_mul_f32 v224, v224, v54
    v_mul_f32 v225, v225, v54
    v_mul_f32 v226, v226, v54
    v_mul_f32 v227, v227, v54
    v_accvgpr_write_b32 a56, v224
    v_accvgpr_write_b32 a57, v225
    v_accvgpr_write_b32 a58, v226
    v_accvgpr_write_b32 a59, v227
    v_accvgpr_read_b32 v224, a60
    v_accvgpr_read_b32 v225, a61
    v_accvgpr_read_b32 v226, a62
    v_accvgpr_read_b32 v227, a63
    v_mul_f32 v224, v224, v55
    v_mul_f32 v225, v225, v55
    v_mul_f32 v226, v226, v55
    v_mul_f32 v227, v227, v55
    v_accvgpr_write_b32 a60, v224
    v_accvgpr_write_b32 a61, v225
    v_accvgpr_write_b32 a62, v226
    v_accvgpr_write_b32 a63, v227
    v_accvgpr_read_b32 v224, a64
    v_accvgpr_read_b32 v225, a65
    v_accvgpr_read_b32 v226, a66
    v_accvgpr_read_b32 v227, a67
    v_mul_f32 v224, v224, v52
    v_mul_f32 v225, v225, v52
    v_mul_f32 v226, v226, v52
    v_mul_f32 v227, v227, v52
    v_accvgpr_write_b32 a64, v224
    v_accvgpr_write_b32 a65, v225
    v_accvgpr_write_b32 a66, v226
    v_accvgpr_write_b32 a67, v227
    v_accvgpr_read_b32 v224, a68
    v_accvgpr_read_b32 v225, a69
    v_accvgpr_read_b32 v226, a70
    v_accvgpr_read_b32 v227, a71
    v_mul_f32 v224, v224, v53
    v_mul_f32 v225, v225, v53
    v_mul_f32 v226, v226, v53
    v_mul_f32 v227, v227, v53
    v_accvgpr_write_b32 a68, v224
    v_accvgpr_write_b32 a69, v225
    v_accvgpr_write_b32 a70, v226
    v_accvgpr_write_b32 a71, v227
    v_accvgpr_read_b32 v224, a72
    v_accvgpr_read_b32 v225, a73
    v_accvgpr_read_b32 v226, a74
    v_accvgpr_read_b32 v227, a75
    v_mul_f32 v224, v224, v54
    v_mul_f32 v225, v225, v54
    v_mul_f32 v226, v226, v54
    v_mul_f32 v227, v227, v54
    v_accvgpr_write_b32 a72, v224
    v_accvgpr_write_b32 a73, v225
    v_accvgpr_write_b32 a74, v226
    v_accvgpr_write_b32 a75, v227
    v_accvgpr_read_b32 v224, a76
    v_accvgpr_read_b32 v225, a77
    v_accvgpr_read_b32 v226, a78
    v_accvgpr_read_b32 v227, a79
    v_mul_f32 v224, v224, v55
    v_mul_f32 v225, v225, v55
    v_mul_f32 v226, v226, v55
    v_mul_f32 v227, v227, v55
    v_accvgpr_write_b32 a76, v224
    v_accvgpr_write_b32 a77, v225
    v_accvgpr_write_b32 a78, v226
    v_accvgpr_write_b32 a79, v227
    v_accvgpr_read_b32 v224, a80
    v_accvgpr_read_b32 v225, a81
    v_accvgpr_read_b32 v226, a82
    v_accvgpr_read_b32 v227, a83
    v_mul_f32 v224, v224, v52
    v_mul_f32 v225, v225, v52
    v_mul_f32 v226, v226, v52
    v_mul_f32 v227, v227, v52
    v_accvgpr_write_b32 a80, v224
    v_accvgpr_write_b32 a81, v225
    v_accvgpr_write_b32 a82, v226
    v_accvgpr_write_b32 a83, v227
    v_accvgpr_read_b32 v224, a84
    v_accvgpr_read_b32 v225, a85
    v_accvgpr_read_b32 v226, a86
    v_accvgpr_read_b32 v227, a87
    v_mul_f32 v224, v224, v53
    v_mul_f32 v225, v225, v53
    v_mul_f32 v226, v226, v53
    v_mul_f32 v227, v227, v53
    v_accvgpr_write_b32 a84, v224
    v_accvgpr_write_b32 a85, v225
    v_accvgpr_write_b32 a86, v226
    v_accvgpr_write_b32 a87, v227
    v_accvgpr_read_b32 v224, a88
    v_accvgpr_read_b32 v225, a89
    v_accvgpr_read_b32 v226, a90
    v_accvgpr_read_b32 v227, a91
    v_mul_f32 v224, v224, v54
    v_mul_f32 v225, v225, v54
    v_mul_f32 v226, v226, v54
    v_mul_f32 v227, v227, v54
    v_accvgpr_write_b32 a88, v224
    v_accvgpr_write_b32 a89, v225
    v_accvgpr_write_b32 a90, v226
    v_accvgpr_write_b32 a91, v227
    v_accvgpr_read_b32 v224, a92
    v_accvgpr_read_b32 v225, a93
    v_accvgpr_read_b32 v226, a94
    v_accvgpr_read_b32 v227, a95
    v_mul_f32 v224, v224, v55
    v_mul_f32 v225, v225, v55
    v_mul_f32 v226, v226, v55
    v_mul_f32 v227, v227, v55
    v_accvgpr_write_b32 a92, v224
    v_accvgpr_write_b32 a93, v225
    v_accvgpr_write_b32 a94, v226
    v_accvgpr_write_b32 a95, v227
    v_accvgpr_read_b32 v224, a96
    v_accvgpr_read_b32 v225, a97
    v_accvgpr_read_b32 v226, a98
    v_accvgpr_read_b32 v227, a99
    v_mul_f32 v224, v224, v52
    v_mul_f32 v225, v225, v52
    v_mul_f32 v226, v226, v52
    v_mul_f32 v227, v227, v52
    v_accvgpr_write_b32 a96, v224
    v_accvgpr_write_b32 a97, v225
    v_accvgpr_write_b32 a98, v226
    v_accvgpr_write_b32 a99, v227
    v_accvgpr_read_b32 v224, a100
    v_accvgpr_read_b32 v225, a101
    v_accvgpr_read_b32 v226, a102
    v_accvgpr_read_b32 v227, a103
    v_mul_f32 v224, v224, v53
    v_mul_f32 v225, v225, v53
    v_mul_f32 v226, v226, v53
    v_mul_f32 v227, v227, v53
    v_accvgpr_write_b32 a100, v224
    v_accvgpr_write_b32 a101, v225
    v_accvgpr_write_b32 a102, v226
    v_accvgpr_write_b32 a103, v227
    v_accvgpr_read_b32 v224, a104
    v_accvgpr_read_b32 v225, a105
    v_accvgpr_read_b32 v226, a106
    v_accvgpr_read_b32 v227, a107
    v_mul_f32 v224, v224, v54
    v_mul_f32 v225, v225, v54
    v_mul_f32 v226, v226, v54
    v_mul_f32 v227, v227, v54
    v_accvgpr_write_b32 a104, v224
    v_accvgpr_write_b32 a105, v225
    v_accvgpr_write_b32 a106, v226
    v_accvgpr_write_b32 a107, v227
    v_accvgpr_read_b32 v224, a108
    v_accvgpr_read_b32 v225, a109
    v_accvgpr_read_b32 v226, a110
    v_accvgpr_read_b32 v227, a111
    v_mul_f32 v224, v224, v55
    v_mul_f32 v225, v225, v55
    v_mul_f32 v226, v226, v55
    v_mul_f32 v227, v227, v55
    v_accvgpr_write_b32 a108, v224
    v_accvgpr_write_b32 a109, v225
    v_accvgpr_write_b32 a110, v226
    v_accvgpr_write_b32 a111, v227
    v_accvgpr_read_b32 v224, a112
    v_accvgpr_read_b32 v225, a113
    v_accvgpr_read_b32 v226, a114
    v_accvgpr_read_b32 v227, a115
    v_mul_f32 v224, v224, v52
    v_mul_f32 v225, v225, v52
    v_mul_f32 v226, v226, v52
    v_mul_f32 v227, v227, v52
    v_accvgpr_write_b32 a112, v224
    v_accvgpr_write_b32 a113, v225
    v_accvgpr_write_b32 a114, v226
    v_accvgpr_write_b32 a115, v227
    v_accvgpr_read_b32 v224, a116
    v_accvgpr_read_b32 v225, a117
    v_accvgpr_read_b32 v226, a118
    v_accvgpr_read_b32 v227, a119
    v_mul_f32 v224, v224, v53
    v_mul_f32 v225, v225, v53
    v_mul_f32 v226, v226, v53
    v_mul_f32 v227, v227, v53
    v_accvgpr_write_b32 a116, v224
    v_accvgpr_write_b32 a117, v225
    v_accvgpr_write_b32 a118, v226
    v_accvgpr_write_b32 a119, v227
    v_accvgpr_read_b32 v224, a120
    v_accvgpr_read_b32 v225, a121
    v_accvgpr_read_b32 v226, a122
    v_accvgpr_read_b32 v227, a123
    v_mul_f32 v224, v224, v54
    v_mul_f32 v225, v225, v54
    v_mul_f32 v226, v226, v54
    v_mul_f32 v227, v227, v54
    v_accvgpr_write_b32 a120, v224
    v_accvgpr_write_b32 a121, v225
    v_accvgpr_write_b32 a122, v226
    v_accvgpr_write_b32 a123, v227
    v_accvgpr_read_b32 v224, a124
    v_accvgpr_read_b32 v225, a125
    v_accvgpr_read_b32 v226, a126
    v_accvgpr_read_b32 v227, a127
    v_mul_f32 v224, v224, v55
    v_mul_f32 v225, v225, v55
    v_mul_f32 v226, v226, v55
    v_mul_f32 v227, v227, v55
    v_accvgpr_write_b32 a124, v224
    v_accvgpr_write_b32 a125, v225
    v_accvgpr_write_b32 a126, v226
    v_accvgpr_write_b32 a127, v227
    v_exp_f32 v232, v160
    v_exp_f32 v233, v161
    v_exp_f32 v234, v162
    v_exp_f32 v235, v163
    s_nop 0
    v_cvt_pk_bf16_f32 v208, v232, v233
    v_cvt_pk_bf16_f32 v209, v234, v235
    v_exp_f32 v232, v176
    v_exp_f32 v233, v177
    v_exp_f32 v234, v178
    v_exp_f32 v235, v179
    s_nop 0
    v_cvt_pk_bf16_f32 v210, v232, v233
    v_cvt_pk_bf16_f32 v211, v234, v235
    v_exp_f32 v232, v164
    v_exp_f32 v233, v165
    v_exp_f32 v234, v166
    v_exp_f32 v235, v167
    s_nop 0
    v_cvt_pk_bf16_f32 v212, v232, v233
    v_cvt_pk_bf16_f32 v213, v234, v235
    v_exp_f32 v232, v180
    v_exp_f32 v233, v181
    v_exp_f32 v234, v182
    v_exp_f32 v235, v183
    s_nop 0
    v_cvt_pk_bf16_f32 v214, v232, v233
    v_cvt_pk_bf16_f32 v215, v234, v235
    v_exp_f32 v232, v168
    v_exp_f32 v233, v169
    v_exp_f32 v234, v170
    v_exp_f32 v235, v171
    s_nop 0
    v_cvt_pk_bf16_f32 v216, v232, v233
    v_cvt_pk_bf16_f32 v217, v234, v235
    v_exp_f32 v232, v184
    v_exp_f32 v233, v185
    v_exp_f32 v234, v186
    v_exp_f32 v235, v187
    s_nop 0
    v_cvt_pk_bf16_f32 v218, v232, v233
    v_cvt_pk_bf16_f32 v219, v234, v235
    v_exp_f32 v232, v172
    v_exp_f32 v233, v173
    v_exp_f32 v234, v174
    v_exp_f32 v235, v175
    s_nop 0
    v_cvt_pk_bf16_f32 v220, v232, v233
    v_cvt_pk_bf16_f32 v221, v234, v235
    v_exp_f32 v232, v188
    v_exp_f32 v233, v189
    v_exp_f32 v234, v190
    v_exp_f32 v235, v191
    s_nop 0
    v_cvt_pk_bf16_f32 v222, v232, v233
    v_cvt_pk_bf16_f32 v223, v234, v235
    s_nop 1
    s_branch k2_ret_66
k2_rare_69:
    s_nop 7
    v_max_f32 v54, v128, v129
    v_max3_f32 v54, v54, v130, v131
    v_max3_f32 v54, v54, v144, v145
    v_max3_f32 v54, v54, v146, v147
    v_max3_f32 v54, v54, v136, v137
    v_max3_f32 v54, v54, v138, v139
    v_max3_f32 v54, v54, v152, v153
    v_max3_f32 v54, v54, v154, v155
    v_max_f32 v55, v132, v133
    v_max3_f32 v55, v55, v134, v135
    v_max3_f32 v55, v55, v148, v149
    v_max3_f32 v55, v55, v150, v151
    v_max3_f32 v55, v55, v140, v141
    v_max3_f32 v55, v55, v142, v143
    v_max3_f32 v55, v55, v156, v157
    v_max3_f32 v55, v55, v158, v159
    v_mov_b32 v226, v54
    v_mov_b32 v227, v55
    s_nop 1
    v_permlane16_swap_b32 v54, v226
    v_permlane16_swap_b32 v55, v227
    s_nop 1
    v_max_f32 v54, v54, v226
    v_max_f32 v55, v55, v227
    v_mov_b32 v226, v54
    v_mov_b32 v227, v55
    s_nop 1
    v_permlane32_swap_b32 v54, v226
    v_permlane32_swap_b32 v55, v227
    s_nop 1
    v_max_f32 v54, v54, v226
    v_max_f32 v55, v55, v227
    v_add_f32 v54, 0x41400000, v54
    v_max_f32 v54, 0, v54
    v_add_f32 v55, 0x41400000, v55
    v_max_f32 v55, 0, v55
    v_sub_f32 v128, v128, v54
    v_sub_f32 v129, v129, v54
    v_sub_f32 v130, v130, v54
    v_sub_f32 v131, v131, v54
    v_sub_f32 v132, v132, v55
    v_sub_f32 v133, v133, v55
    v_sub_f32 v134, v134, v55
    v_sub_f32 v135, v135, v55
    v_sub_f32 v136, v136, v54
    v_sub_f32 v137, v137, v54
    v_sub_f32 v138, v138, v54
    v_sub_f32 v139, v139, v54
    v_sub_f32 v140, v140, v55
    v_sub_f32 v141, v141, v55
    v_sub_f32 v142, v142, v55
    v_sub_f32 v143, v143, v55
    v_sub_f32 v144, v144, v54
    v_sub_f32 v145, v145, v54
    v_sub_f32 v146, v146, v54
    v_sub_f32 v147, v147, v54
    v_sub_f32 v148, v148, v55
    v_sub_f32 v149, v149, v55
    v_sub_f32 v150, v150, v55
    v_sub_f32 v151, v151, v55
    v_sub_f32 v152, v152, v54
    v_sub_f32 v153, v153, v54
    v_sub_f32 v154, v154, v54
    v_sub_f32 v155, v155, v54
    v_sub_f32 v156, v156, v55
    v_sub_f32 v157, v157, v55
    v_sub_f32 v158, v158, v55
    v_sub_f32 v159, v159, v55
    v_sub_f32 v160, v160, v54
    v_sub_f32 v16, v16, v54
    v_sub_f32 v161, v161, v54
    v_sub_f32 v17, v17, v54
    v_sub_f32 v162, v162, v54
    v_sub_f32 v18, v18, v54
    v_sub_f32 v163, v163, v54
    v_sub_f32 v19, v19, v54
    v_sub_f32 v164, v164, v55
    v_sub_f32 v20, v20, v55
    v_sub_f32 v165, v165, v55
    v_sub_f32 v21, v21, v55
    v_sub_f32 v166, v166, v55
    v_sub_f32 v22, v22, v55
    v_sub_f32 v167, v167, v55
    v_sub_f32 v23, v23, v55
    v_sub_f32 v168, v168, v54
    v_sub_f32 v24, v24, v54
    v_sub_f32 v169, v169, v54
    v_sub_f32 v25, v25, v54
    v_sub_f32 v170, v170, v54
    v_sub_f32 v26, v26, v54
    v_sub_f32 v171, v171, v54
    v_sub_f32 v27, v27, v54
    v_sub_f32 v172, v172, v55
    v_sub_f32 v28, v28, v55
    v_sub_f32 v173, v173, v55
    v_sub_f32 v29, v29, v55
    v_sub_f32 v174, v174, v55
    v_sub_f32 v30, v30, v55
    v_sub_f32 v175, v175, v55
    v_sub_f32 v31, v31, v55
    v_sub_f32 v176, v176, v54
    v_sub_f32 v32, v32, v54
    v_sub_f32 v177, v177, v54
    v_sub_f32 v33, v33, v54
    v_sub_f32 v178, v178, v54
    v_sub_f32 v34, v34, v54
    v_sub_f32 v179, v179, v54
    v_sub_f32 v35, v35, v54
    v_sub_f32 v180, v180, v55
    v_sub_f32 v36, v36, v55
    v_sub_f32 v181, v181, v55
    v_sub_f32 v37, v37, v55
    v_sub_f32 v182, v182, v55
    v_sub_f32 v38, v38, v55
    v_sub_f32 v183, v183, v55
    v_sub_f32 v39, v39, v55
    v_sub_f32 v184, v184, v54
    v_sub_f32 v40, v40, v54
    v_sub_f32 v185, v185, v54
    v_sub_f32 v41, v41, v54
    v_sub_f32 v186, v186, v54
    v_sub_f32 v42, v42, v54
    v_sub_f32 v187, v187, v54
    v_sub_f32 v43, v43, v54
    v_sub_f32 v188, v188, v55
    v_sub_f32 v44, v44, v55
    v_sub_f32 v189, v189, v55
    v_sub_f32 v45, v45, v55
    v_sub_f32 v190, v190, v55
    v_sub_f32 v46, v46, v55
    v_sub_f32 v191, v191, v55
    v_sub_f32 v47, v47, v55
    v_sub_f32 v10, v10, v54
    v_exp_f32 v54, -v54
    v_sub_f32 v11, v11, v55
    v_exp_f32 v55, -v55
    s_nop 0
    v_mul_f32 v248, v248, v54
    v_mul_f32 v252, v252, v55
    v_accvgpr_read_b32 v224, a8
    v_accvgpr_read_b32 v225, a9
    v_accvgpr_read_b32 v226, a10
    v_accvgpr_read_b32 v227, a11
    v_mul_f32 v224, v224, v54
    v_mul_f32 v225, v225, v54
    v_mul_f32 v226, v226, v54
    v_mul_f32 v227, v227, v54
    v_accvgpr_write_b32 a8, v224
    v_accvgpr_write_b32 a9, v225
    v_accvgpr_write_b32 a10, v226
    v_accvgpr_write_b32 a11, v227
    v_accvgpr_read_b32 v224, a12
    v_accvgpr_read_b32 v225, a13
    v_accvgpr_read_b32 v226, a14
    v_accvgpr_read_b32 v227, a15
    v_mul_f32 v224, v224, v55
    v_mul_f32 v225, v225, v55
    v_mul_f32 v226, v226, v55
    v_mul_f32 v227, v227, v55
    v_accvgpr_write_b32 a12, v224
    v_accvgpr_write_b32 a13, v225
    v_accvgpr_write_b32 a14, v226
    v_accvgpr_write_b32 a15, v227
    v_accvgpr_read_b32 v224, a24
    v_accvgpr_read_b32 v225, a25
    v_accvgpr_read_b32 v226, a26
    v_accvgpr_read_b32 v227, a27
    v_mul_f32 v224, v224, v54
    v_mul_f32 v225, v225, v54
    v_mul_f32 v226, v226, v54
    v_mul_f32 v227, v227, v54
    v_accvgpr_write_b32 a24, v224
    v_accvgpr_write_b32 a25, v225
    v_accvgpr_write_b32 a26, v226
    v_accvgpr_write_b32 a27, v227
    v_accvgpr_read_b32 v224, a28
    v_accvgpr_read_b32 v225, a29
    v_accvgpr_read_b32 v226, a30
    v_accvgpr_read_b32 v227, a31
    v_mul_f32 v224, v224, v55
    v_mul_f32 v225, v225, v55
    v_mul_f32 v226, v226, v55
    v_mul_f32 v227, v227, v55
    v_accvgpr_write_b32 a28, v224
    v_accvgpr_write_b32 a29, v225
    v_accvgpr_write_b32 a30, v226
    v_accvgpr_write_b32 a31, v227
    v_accvgpr_read_b32 v224, a40
    v_accvgpr_read_b32 v225, a41
    v_accvgpr_read_b32 v226, a42
    v_accvgpr_read_b32 v227, a43
    v_mul_f32 v224, v224, v54
    v_mul_f32 v225, v225, v54
    v_mul_f32 v226, v226, v54
    v_mul_f32 v227, v227, v54
    v_accvgpr_write_b32 a40, v224
    v_accvgpr_write_b32 a41, v225
    v_accvgpr_write_b32 a42, v226
    v_accvgpr_write_b32 a43, v227
    v_accvgpr_read_b32 v224, a44
    v_accvgpr_read_b32 v225, a45
    v_accvgpr_read_b32 v226, a46
    v_accvgpr_read_b32 v227, a47
    v_mul_f32 v224, v224, v55
    v_mul_f32 v225, v225, v55
    v_mul_f32 v226, v226, v55
    v_mul_f32 v227, v227, v55
    v_accvgpr_write_b32 a44, v224
    v_accvgpr_write_b32 a45, v225
    v_accvgpr_write_b32 a46, v226
    v_accvgpr_write_b32 a47, v227
    v_accvgpr_read_b32 v224, a56
    v_accvgpr_read_b32 v225, a57
    v_accvgpr_read_b32 v226, a58
    v_accvgpr_read_b32 v227, a59
    v_mul_f32 v224, v224, v54
    v_mul_f32 v225, v225, v54
    v_mul_f32 v226, v226, v54
    v_mul_f32 v227, v227, v54
    v_accvgpr_write_b32 a56, v224
    v_accvgpr_write_b32 a57, v225
    v_accvgpr_write_b32 a58, v226
    v_accvgpr_write_b32 a59, v227
    v_accvgpr_read_b32 v224, a60
    v_accvgpr_read_b32 v225, a61
    v_accvgpr_read_b32 v226, a62
    v_accvgpr_read_b32 v227, a63
    v_mul_f32 v224, v224, v55
    v_mul_f32 v225, v225, v55
    v_mul_f32 v226, v226, v55
    v_mul_f32 v227, v227, v55
    v_accvgpr_write_b32 a60, v224
    v_accvgpr_write_b32 a61, v225
    v_accvgpr_write_b32 a62, v226
    v_accvgpr_write_b32 a63, v227
    v_accvgpr_read_b32 v224, a72
    v_accvgpr_read_b32 v225, a73
    v_accvgpr_read_b32 v226, a74
    v_accvgpr_read_b32 v227, a75
    v_mul_f32 v224, v224, v54
    v_mul_f32 v225, v225, v54
    v_mul_f32 v226, v226, v54
    v_mul_f32 v227, v227, v54
    v_accvgpr_write_b32 a72, v224
    v_accvgpr_write_b32 a73, v225
    v_accvgpr_write_b32 a74, v226
    v_accvgpr_write_b32 a75, v227
    v_accvgpr_read_b32 v224, a76
    v_accvgpr_read_b32 v225, a77
    v_accvgpr_read_b32 v226, a78
    v_accvgpr_read_b32 v227, a79
    v_mul_f32 v224, v224, v55
    v_mul_f32 v225, v225, v55
    v_mul_f32 v226, v226, v55
    v_mul_f32 v227, v227, v55
    v_accvgpr_write_b32 a76, v224
    v_accvgpr_write_b32 a77, v225
    v_accvgpr_write_b32 a78, v226
    v_accvgpr_write_b32 a79, v227
    v_accvgpr_read_b32 v224, a88
    v_accvgpr_read_b32 v225, a89
    v_accvgpr_read_b32 v226, a90
    v_accvgpr_read_b32 v227, a91
    v_mul_f32 v224, v224, v54
    v_mul_f32 v225, v225, v54
    v_mul_f32 v226, v226, v54
    v_mul_f32 v227, v227, v54
    v_accvgpr_write_b32 a88, v224
    v_accvgpr_write_b32 a89, v225
    v_accvgpr_write_b32 a90, v226
    v_accvgpr_write_b32 a91, v227
    v_accvgpr_read_b32 v224, a92
    v_accvgpr_read_b32 v225, a93
    v_accvgpr_read_b32 v226, a94
    v_accvgpr_read_b32 v227, a95
    v_mul_f32 v224, v224, v55
    v_mul_f32 v225, v225, v55
    v_mul_f32 v226, v226, v55
    v_mul_f32 v227, v227, v55
    v_accvgpr_write_b32 a92, v224
    v_accvgpr_write_b32 a93, v225
    v_accvgpr_write_b32 a94, v226
    v_accvgpr_write_b32 a95, v227
    v_accvgpr_read_b32 v224, a104
    v_accvgpr_read_b32 v225, a105
    v_accvgpr_read_b32 v226, a106
    v_accvgpr_read_b32 v227, a107
    v_mul_f32 v224, v224, v54
    v_mul_f32 v225, v225, v54
    v_mul_f32 v226, v226, v54
    v_mul_f32 v227, v227, v54
    v_accvgpr_write_b32 a104, v224
    v_accvgpr_write_b32 a105, v225
    v_accvgpr_write_b32 a106, v226
    v_accvgpr_write_b32 a107, v227
    v_accvgpr_read_b32 v224, a108
    v_accvgpr_read_b32 v225, a109
    v_accvgpr_read_b32 v226, a110
    v_accvgpr_read_b32 v227, a111
    v_mul_f32 v224, v224, v55
    v_mul_f32 v225, v225, v55
    v_mul_f32 v226, v226, v55
    v_mul_f32 v227, v227, v55
    v_accvgpr_write_b32 a108, v224
    v_accvgpr_write_b32 a109, v225
    v_accvgpr_write_b32 a110, v226
    v_accvgpr_write_b32 a111, v227
    v_accvgpr_read_b32 v224, a120
    v_accvgpr_read_b32 v225, a121
    v_accvgpr_read_b32 v226, a122
    v_accvgpr_read_b32 v227, a123
    v_mul_f32 v224, v224, v54
    v_mul_f32 v225, v225, v54
    v_mul_f32 v226, v226, v54
    v_mul_f32 v227, v227, v54
    v_accvgpr_write_b32 a120, v224
    v_accvgpr_write_b32 a121, v225
    v_accvgpr_write_b32 a122, v226
    v_accvgpr_write_b32 a123, v227
    v_accvgpr_read_b32 v224, a124
    v_accvgpr_read_b32 v225, a125
    v_accvgpr_read_b32 v226, a126
    v_accvgpr_read_b32 v227, a127
    v_mul_f32 v224, v224, v55
    v_mul_f32 v225, v225, v55
    v_mul_f32 v226, v226, v55
    v_mul_f32 v227, v227, v55
    v_accvgpr_write_b32 a124, v224
    v_accvgpr_write_b32 a125, v225
    v_accvgpr_write_b32 a126, v226
    v_accvgpr_write_b32 a127, v227
    v_exp_f32 v232, v128
    v_exp_f32 v233, v129
    v_exp_f32 v234, v130
    v_exp_f32 v235, v131
    s_nop 0
    v_cvt_pk_bf16_f32 v192, v232, v233
    v_cvt_pk_bf16_f32 v193, v234, v235
    v_exp_f32 v232, v144
    v_exp_f32 v233, v145
    v_exp_f32 v234, v146
    v_exp_f32 v235, v147
    s_nop 0
    v_cvt_pk_bf16_f32 v194, v232, v233
    v_cvt_pk_bf16_f32 v195, v234, v235
    v_exp_f32 v232, v132
    v_exp_f32 v233, v133
    v_exp_f32 v234, v134
    v_exp_f32 v235, v135
    s_nop 0
    v_cvt_pk_bf16_f32 v196, v232, v233
    v_cvt_pk_bf16_f32 v197, v234, v235
    v_exp_f32 v232, v148
    v_exp_f32 v233, v149
    v_exp_f32 v234, v150
    v_exp_f32 v235, v151
    s_nop 0
    v_cvt_pk_bf16_f32 v198, v232, v233
    v_cvt_pk_bf16_f32 v199, v234, v235
    v_exp_f32 v232, v136
    v_exp_f32 v233, v137
    v_exp_f32 v234, v138
    v_exp_f32 v235, v139
    s_nop 0
    v_cvt_pk_bf16_f32 v200, v232, v233
    v_cvt_pk_bf16_f32 v201, v234, v235
    v_exp_f32 v232, v152
    v_exp_f32 v233, v153
    v_exp_f32 v234, v154
    v_exp_f32 v235, v155
    s_nop 0
    v_cvt_pk_bf16_f32 v202, v232, v233
    v_cvt_pk_bf16_f32 v203, v234, v235
    v_exp_f32 v232, v140
    v_exp_f32 v233, v141
    v_exp_f32 v234, v142
    v_exp_f32 v235, v143
    s_nop 0
    v_cvt_pk_bf16_f32 v204, v232, v233
    v_cvt_pk_bf16_f32 v205, v234, v235
    v_exp_f32 v232, v156
    v_exp_f32 v233, v157
    v_exp_f32 v234, v158
    v_exp_f32 v235, v159
    s_nop 0
    v_cvt_pk_bf16_f32 v206, v232, v233
    v_cvt_pk_bf16_f32 v207, v234, v235
    s_nop 1
    s_branch k2_ret_70
k2_rare_75:
    s_nop 7
    v_max_f32 v54, v160, v161
    v_max3_f32 v54, v54, v162, v163
    v_max3_f32 v54, v54, v176, v177
    v_max3_f32 v54, v54, v178, v179
    v_max3_f32 v54, v54, v168, v169
    v_max3_f32 v54, v54, v170, v171
    v_max3_f32 v54, v54, v184, v185
    v_max3_f32 v54, v54, v186, v187
    v_max_f32 v55, v164, v165
    v_max3_f32 v55, v55, v166, v167
    v_max3_f32 v55, v55, v180, v181
    v_max3_f32 v55, v55, v182, v183
    v_max3_f32 v55, v55, v172, v173
    v_max3_f32 v55, v55, v174, v175
    v_max3_f32 v55, v55, v188, v189
    v_max3_f32 v55, v55, v190, v191
    v_mov_b32 v226, v54
    v_mov_b32 v227, v55
    s_nop 1
    v_permlane16_swap_b32 v54, v226
    v_permlane16_swap_b32 v55, v227
    s_nop 1
    v_max_f32 v54, v54, v226
    v_max_f32 v55, v55, v227
    v_mov_b32 v226, v54
    v_mov_b32 v227, v55
    s_nop 1
    v_permlane32_swap_b32 v54, v226
    v_permlane32_swap_b32 v55, v227
    s_nop 1
    v_max_f32 v54, v54, v226
    v_max_f32 v55, v55, v227
    v_add_f32 v54, 0x41400000, v54
    v_max_f32 v54, 0, v54
    v_add_f32 v55, 0x41400000, v55
    v_max_f32 v55, 0, v55
    v_sub_f32 v160, v160, v54
    v_sub_f32 v161, v161, v54
    v_sub_f32 v162, v162, v54
    v_sub_f32 v163, v163, v54
    v_sub_f32 v164, v164, v55
    v_sub_f32 v165, v165, v55
    v_sub_f32 v166, v166, v55
    v_sub_f32 v167, v167, v55
    v_sub_f32 v168, v168, v54
    v_sub_f32 v169, v169, v54
    v_sub_f32 v170, v170, v54
    v_sub_f32 v171, v171, v54
    v_sub_f32 v172, v172, v55
    v_sub_f32 v173, v173, v55
    v_sub_f32 v174, v174, v55
    v_sub_f32 v175, v175, v55
    v_sub_f32 v176, v176, v54
    v_sub_f32 v177, v177, v54
    v_sub_f32 v178, v178, v54
    v_sub_f32 v179, v179, v54
    v_sub_f32 v180, v180, v55
    v_sub_f32 v181, v181, v55
    v_sub_f32 v182, v182, v55
    v_sub_f32 v183, v183, v55
    v_sub_f32 v184, v184, v54
    v_sub_f32 v185, v185, v54
    v_sub_f32 v186, v186, v54
    v_sub_f32 v187, v187, v54
    v_sub_f32 v188, v188, v55
    v_sub_f32 v189, v189, v55
    v_sub_f32 v190, v190, v55
    v_sub_f32 v191, v191, v55
    v_sub_f32 v128, v128, v54
    v_sub_f32 v16, v16, v54
    v_sub_f32 v129, v129, v54
    v_sub_f32 v17, v17, v54
    v_sub_f32 v130, v130, v54
    v_sub_f32 v18, v18, v54
    v_sub_f32 v131, v131, v54
    v_sub_f32 v19, v19, v54
    v_sub_f32 v132, v132, v55
    v_sub_f32 v20, v20, v55
    v_sub_f32 v133, v133, v55
    v_sub_f32 v21, v21, v55
    v_sub_f32 v134, v134, v55
    v_sub_f32 v22, v22, v55
    v_sub_f32 v135, v135, v55
    v_sub_f32 v23, v23, v55
    v_sub_f32 v136, v136, v54
    v_sub_f32 v24, v24, v54
    v_sub_f32 v137, v137, v54
    v_sub_f32 v25, v25, v54
    v_sub_f32 v138, v138, v54
    v_sub_f32 v26, v26, v54
    v_sub_f32 v139, v139, v54
    v_sub_f32 v27, v27, v54
    v_sub_f32 v140, v140, v55
    v_sub_f32 v28, v28, v55
    v_sub_f32 v141, v141, v55
    v_sub_f32 v29, v29, v55
    v_sub_f32 v142, v142, v55
    v_sub_f32 v30, v30, v55
    v_sub_f32 v143, v143, v55
    v_sub_f32 v31, v31, v55
    v_sub_f32 v144, v144, v54
    v_sub_f32 v32, v32, v54
    v_sub_f32 v145, v145, v54
    v_sub_f32 v33, v33, v54
    v_sub_f32 v146, v146, v54
    v_sub_f32 v34, v34, v54
    v_sub_f32 v147, v147, v54
    v_sub_f32 v35, v35, v54
    v_sub_f32 v148, v148, v55
    v_sub_f32 v36, v36, v55
    v_sub_f32 v149, v149, v55
    v_sub_f32 v37, v37, v55
    v_sub_f32 v150, v150, v55
    v_sub_f32 v38, v38, v55
    v_sub_f32 v151, v151, v55
    v_sub_f32 v39, v39, v55
    v_sub_f32 v152, v152, v54
    v_sub_f32 v40, v40, v54
    v_sub_f32 v153, v153, v54
    v_sub_f32 v41, v41, v54
    v_sub_f32 v154, v154, v54
    v_sub_f32 v42, v42, v54
    v_sub_f32 v155, v155, v54
    v_sub_f32 v43, v43, v54
    v_sub_f32 v156, v156, v55
    v_sub_f32 v44, v44, v55
    v_sub_f32 v157, v157, v55
    v_sub_f32 v45, v45, v55
    v_sub_f32 v158, v158, v55
    v_sub_f32 v46, v46, v55
    v_sub_f32 v159, v159, v55
    v_sub_f32 v47, v47, v55
    v_sub_f32 v10, v10, v54
    v_exp_f32 v54, -v54
    v_sub_f32 v11, v11, v55
    v_exp_f32 v55, -v55
    s_nop 0
    v_mul_f32 v248, v248, v54
    v_mul_f32 v252, v252, v55
    v_accvgpr_read_b32 v224, a8
    v_accvgpr_read_b32 v225, a9
    v_accvgpr_read_b32 v226, a10
    v_accvgpr_read_b32 v227, a11
    v_mul_f32 v224, v224, v54
    v_mul_f32 v225, v225, v54
    v_mul_f32 v226, v226, v54
    v_mul_f32 v227, v227, v54
    v_accvgpr_write_b32 a8, v224
    v_accvgpr_write_b32 a9, v225
    v_accvgpr_write_b32 a10, v226
    v_accvgpr_write_b32 a11, v227
    v_accvgpr_read_b32 v224, a12
    v_accvgpr_read_b32 v225, a13
    v_accvgpr_read_b32 v226, a14
    v_accvgpr_read_b32 v227, a15
    v_mul_f32 v224, v224, v55
    v_mul_f32 v225, v225, v55
    v_mul_f32 v226, v226, v55
    v_mul_f32 v227, v227, v55
    v_accvgpr_write_b32 a12, v224
    v_accvgpr_write_b32 a13, v225
    v_accvgpr_write_b32 a14, v226
    v_accvgpr_write_b32 a15, v227
    v_accvgpr_read_b32 v224, a24
    v_accvgpr_read_b32 v225, a25
    v_accvgpr_read_b32 v226, a26
    v_accvgpr_read_b32 v227, a27
    v_mul_f32 v224, v224, v54
    v_mul_f32 v225, v225, v54
    v_mul_f32 v226, v226, v54
    v_mul_f32 v227, v227, v54
    v_accvgpr_write_b32 a24, v224
    v_accvgpr_write_b32 a25, v225
    v_accvgpr_write_b32 a26, v226
    v_accvgpr_write_b32 a27, v227
    v_accvgpr_read_b32 v224, a28
    v_accvgpr_read_b32 v225, a29
    v_accvgpr_read_b32 v226, a30
    v_accvgpr_read_b32 v227, a31
    v_mul_f32 v224, v224, v55
    v_mul_f32 v225, v225, v55
    v_mul_f32 v226, v226, v55
    v_mul_f32 v227, v227, v55
    v_accvgpr_write_b32 a28, v224
    v_accvgpr_write_b32 a29, v225
    v_accvgpr_write_b32 a30, v226
    v_accvgpr_write_b32 a31, v227
    v_accvgpr_read_b32 v224, a40
    v_accvgpr_read_b32 v225, a41
    v_accvgpr_read_b32 v226, a42
    v_accvgpr_read_b32 v227, a43
    v_mul_f32 v224, v224, v54
    v_mul_f32 v225, v225, v54
    v_mul_f32 v226, v226, v54
    v_mul_f32 v227, v227, v54
    v_accvgpr_write_b32 a40, v224
    v_accvgpr_write_b32 a41, v225
    v_accvgpr_write_b32 a42, v226
    v_accvgpr_write_b32 a43, v227
    v_accvgpr_read_b32 v224, a44
    v_accvgpr_read_b32 v225, a45
    v_accvgpr_read_b32 v226, a46
    v_accvgpr_read_b32 v227, a47
    v_mul_f32 v224, v224, v55
    v_mul_f32 v225, v225, v55
    v_mul_f32 v226, v226, v55
    v_mul_f32 v227, v227, v55
    v_accvgpr_write_b32 a44, v224
    v_accvgpr_write_b32 a45, v225
    v_accvgpr_write_b32 a46, v226
    v_accvgpr_write_b32 a47, v227
    v_accvgpr_read_b32 v224, a56
    v_accvgpr_read_b32 v225, a57
    v_accvgpr_read_b32 v226, a58
    v_accvgpr_read_b32 v227, a59
    v_mul_f32 v224, v224, v54
    v_mul_f32 v225, v225, v54
    v_mul_f32 v226, v226, v54
    v_mul_f32 v227, v227, v54
    v_accvgpr_write_b32 a56, v224
    v_accvgpr_write_b32 a57, v225
    v_accvgpr_write_b32 a58, v226
    v_accvgpr_write_b32 a59, v227
    v_accvgpr_read_b32 v224, a60
    v_accvgpr_read_b32 v225, a61
    v_accvgpr_read_b32 v226, a62
    v_accvgpr_read_b32 v227, a63
    v_mul_f32 v224, v224, v55
    v_mul_f32 v225, v225, v55
    v_mul_f32 v226, v226, v55
    v_mul_f32 v227, v227, v55
    v_accvgpr_write_b32 a60, v224
    v_accvgpr_write_b32 a61, v225
    v_accvgpr_write_b32 a62, v226
    v_accvgpr_write_b32 a63, v227
    v_accvgpr_read_b32 v224, a72
    v_accvgpr_read_b32 v225, a73
    v_accvgpr_read_b32 v226, a74
    v_accvgpr_read_b32 v227, a75
    v_mul_f32 v224, v224, v54
    v_mul_f32 v225, v225, v54
    v_mul_f32 v226, v226, v54
    v_mul_f32 v227, v227, v54
    v_accvgpr_write_b32 a72, v224
    v_accvgpr_write_b32 a73, v225
    v_accvgpr_write_b32 a74, v226
    v_accvgpr_write_b32 a75, v227
    v_accvgpr_read_b32 v224, a76
    v_accvgpr_read_b32 v225, a77
    v_accvgpr_read_b32 v226, a78
    v_accvgpr_read_b32 v227, a79
    v_mul_f32 v224, v224, v55
    v_mul_f32 v225, v225, v55
    v_mul_f32 v226, v226, v55
    v_mul_f32 v227, v227, v55
    v_accvgpr_write_b32 a76, v224
    v_accvgpr_write_b32 a77, v225
    v_accvgpr_write_b32 a78, v226
    v_accvgpr_write_b32 a79, v227
    v_accvgpr_read_b32 v224, a88
    v_accvgpr_read_b32 v225, a89
    v_accvgpr_read_b32 v226, a90
    v_accvgpr_read_b32 v227, a91
    v_mul_f32 v224, v224, v54
    v_mul_f32 v225, v225, v54
    v_mul_f32 v226, v226, v54
    v_mul_f32 v227, v227, v54
    v_accvgpr_write_b32 a88, v224
    v_accvgpr_write_b32 a89, v225
    v_accvgpr_write_b32 a90, v226
    v_accvgpr_write_b32 a91, v227
    v_accvgpr_read_b32 v224, a92
    v_accvgpr_read_b32 v225, a93
    v_accvgpr_read_b32 v226, a94
    v_accvgpr_read_b32 v227, a95
    v_mul_f32 v224, v224, v55
    v_mul_f32 v225, v225, v55
    v_mul_f32 v226, v226, v55
    v_mul_f32 v227, v227, v55
    v_accvgpr_write_b32 a92, v224
    v_accvgpr_write_b32 a93, v225
    v_accvgpr_write_b32 a94, v226
    v_accvgpr_write_b32 a95, v227
    v_accvgpr_read_b32 v224, a104
    v_accvgpr_read_b32 v225, a105
    v_accvgpr_read_b32 v226, a106
    v_accvgpr_read_b32 v227, a107
    v_mul_f32 v224, v224, v54
    v_mul_f32 v225, v225, v54
    v_mul_f32 v226, v226, v54
    v_mul_f32 v227, v227, v54
    v_accvgpr_write_b32 a104, v224
    v_accvgpr_write_b32 a105, v225
    v_accvgpr_write_b32 a106, v226
    v_accvgpr_write_b32 a107, v227
    v_accvgpr_read_b32 v224, a108
    v_accvgpr_read_b32 v225, a109
    v_accvgpr_read_b32 v226, a110
    v_accvgpr_read_b32 v227, a111
    v_mul_f32 v224, v224, v55
    v_mul_f32 v225, v225, v55
    v_mul_f32 v226, v226, v55
    v_mul_f32 v227, v227, v55
    v_accvgpr_write_b32 a108, v224
    v_accvgpr_write_b32 a109, v225
    v_accvgpr_write_b32 a110, v226
    v_accvgpr_write_b32 a111, v227
    v_accvgpr_read_b32 v224, a120
    v_accvgpr_read_b32 v225, a121
    v_accvgpr_read_b32 v226, a122
    v_accvgpr_read_b32 v227, a123
    v_mul_f32 v224, v224, v54
    v_mul_f32 v225, v225, v54
    v_mul_f32 v226, v226, v54
    v_mul_f32 v227, v227, v54
    v_accvgpr_write_b32 a120, v224
    v_accvgpr_write_b32 a121, v225
    v_accvgpr_write_b32 a122, v226
    v_accvgpr_write_b32 a123, v227
    v_accvgpr_read_b32 v224, a124
    v_accvgpr_read_b32 v225, a125
    v_accvgpr_read_b32 v226, a126
    v_accvgpr_read_b32 v227, a127
    v_mul_f32 v224, v224, v55
    v_mul_f32 v225, v225, v55
    v_mul_f32 v226, v226, v55
    v_mul_f32 v227, v227, v55
    v_accvgpr_write_b32 a124, v224
    v_accvgpr_write_b32 a125, v225
    v_accvgpr_write_b32 a126, v226
    v_accvgpr_write_b32 a127, v227
    v_exp_f32 v232, v160
    v_exp_f32 v233, v161
    v_exp_f32 v234, v162
    v_exp_f32 v235, v163
    s_nop 0
    v_cvt_pk_bf16_f32 v208, v232, v233
    v_cvt_pk_bf16_f32 v209, v234, v235
    v_exp_f32 v232, v176
    v_exp_f32 v233, v177
    v_exp_f32 v234, v178
    v_exp_f32 v235, v179
    s_nop 0
    v_cvt_pk_bf16_f32 v210, v232, v233
    v_cvt_pk_bf16_f32 v211, v234, v235
    v_exp_f32 v232, v164
    v_exp_f32 v233, v165
    v_exp_f32 v234, v166
    v_exp_f32 v235, v167
    s_nop 0
    v_cvt_pk_bf16_f32 v212, v232, v233
    v_cvt_pk_bf16_f32 v213, v234, v235
    v_exp_f32 v232, v180
    v_exp_f32 v233, v181
    v_exp_f32 v234, v182
    v_exp_f32 v235, v183
    s_nop 0
    v_cvt_pk_bf16_f32 v214, v232, v233
    v_cvt_pk_bf16_f32 v215, v234, v235
    v_exp_f32 v232, v168
    v_exp_f32 v233, v169
    v_exp_f32 v234, v170
    v_exp_f32 v235, v171
    s_nop 0
    v_cvt_pk_bf16_f32 v216, v232, v233
    v_cvt_pk_bf16_f32 v217, v234, v235
    v_exp_f32 v232, v184
    v_exp_f32 v233, v185
    v_exp_f32 v234, v186
    v_exp_f32 v235, v187
    s_nop 0
    v_cvt_pk_bf16_f32 v218, v232, v233
    v_cvt_pk_bf16_f32 v219, v234, v235
    v_exp_f32 v232, v172
    v_exp_f32 v233, v173
    v_exp_f32 v234, v174
    v_exp_f32 v235, v175
    s_nop 0
    v_cvt_pk_bf16_f32 v220, v232, v233
    v_cvt_pk_bf16_f32 v221, v234, v235
    v_exp_f32 v232, v188
    v_exp_f32 v233, v189
    v_exp_f32 v234, v190
    v_exp_f32 v235, v191
    s_nop 0
    v_cvt_pk_bf16_f32 v222, v232, v233
    v_cvt_pk_bf16_f32 v223, v234, v235
    s_nop 1
    s_branch k2_ret_76
k2_rare_79:
    s_nop 7
    v_max_f32 v54, v128, v129
    v_max3_f32 v54, v54, v130, v131
    v_max3_f32 v54, v54, v144, v145
    v_max3_f32 v54, v54, v146, v147
    v_max3_f32 v54, v54, v136, v137
    v_max3_f32 v54, v54, v138, v139
    v_max3_f32 v54, v54, v152, v153
    v_max3_f32 v54, v54, v154, v155
    v_max_f32 v55, v132, v133
    v_max3_f32 v55, v55, v134, v135
    v_max3_f32 v55, v55, v148, v149
    v_max3_f32 v55, v55, v150, v151
    v_max3_f32 v55, v55, v140, v141
    v_max3_f32 v55, v55, v142, v143
    v_max3_f32 v55, v55, v156, v157
    v_max3_f32 v55, v55, v158, v159
    v_mov_b32 v226, v54
    v_mov_b32 v227, v55
    s_nop 1
    v_permlane16_swap_b32 v54, v226
    v_permlane16_swap_b32 v55, v227
    s_nop 1
    v_max_f32 v54, v54, v226
    v_max_f32 v55, v55, v227
    v_mov_b32 v226, v54
    v_mov_b32 v227, v55
    s_nop 1
    v_permlane32_swap_b32 v54, v226
    v_permlane32_swap_b32 v55, v227
    s_nop 1
    v_max_f32 v54, v54, v226
    v_max_f32 v55, v55, v227
    v_add_f32 v54, 0x41400000, v54
    v_max_f32 v54, 0, v54
    v_add_f32 v55, 0x41400000, v55
    v_max_f32 v55, 0, v55
    v_sub_f32 v128, v128, v54
    v_sub_f32 v129, v129, v54
    v_sub_f32 v130, v130, v54
    v_sub_f32 v131, v131, v54
    v_sub_f32 v132, v132, v55
    v_sub_f32 v133, v133, v55
    v_sub_f32 v134, v134, v55
    v_sub_f32 v135, v135, v55
    v_sub_f32 v136, v136, v54
    v_sub_f32 v137, v137, v54
    v_sub_f32 v138, v138, v54
    v_sub_f32 v139, v139, v54
    v_sub_f32 v140, v140, v55
    v_sub_f32 v141, v141, v55
    v_sub_f32 v142, v142, v55
    v_sub_f32 v143, v143, v55
    v_sub_f32 v144, v144, v54
    v_sub_f32 v145, v145, v54
    v_sub_f32 v146, v146, v54
    v_sub_f32 v147, v147, v54
    v_sub_f32 v148, v148, v55
    v_sub_f32 v149, v149, v55
    v_sub_f32 v150, v150, v55
    v_sub_f32 v151, v151, v55
    v_sub_f32 v152, v152, v54
    v_sub_f32 v153, v153, v54
    v_sub_f32 v154, v154, v54
    v_sub_f32 v155, v155, v54
    v_sub_f32 v156, v156, v55
    v_sub_f32 v157, v157, v55
    v_sub_f32 v158, v158, v55
    v_sub_f32 v159, v159, v55
    v_sub_f32 v160, v160, v54
    v_sub_f32 v16, v16, v54
    v_sub_f32 v161, v161, v54
    v_sub_f32 v17, v17, v54
    v_sub_f32 v162, v162, v54
    v_sub_f32 v18, v18, v54
    v_sub_f32 v163, v163, v54
    v_sub_f32 v19, v19, v54
    v_sub_f32 v164, v164, v55
    v_sub_f32 v20, v20, v55
    v_sub_f32 v165, v165, v55
    v_sub_f32 v21, v21, v55
    v_sub_f32 v166, v166, v55
    v_sub_f32 v22, v22, v55
    v_sub_f32 v167, v167, v55
    v_sub_f32 v23, v23, v55
    v_sub_f32 v168, v168, v54
    v_sub_f32 v24, v24, v54
    v_sub_f32 v169, v169, v54
    v_sub_f32 v25, v25, v54
    v_sub_f32 v170, v170, v54
    v_sub_f32 v26, v26, v54
    v_sub_f32 v171, v171, v54
    v_sub_f32 v27, v27, v54
    v_sub_f32 v172, v172, v55
    v_sub_f32 v28, v28, v55
    v_sub_f32 v173, v173, v55
    v_sub_f32 v29, v29, v55
    v_sub_f32 v174, v174, v55
    v_sub_f32 v30, v30, v55
    v_sub_f32 v175, v175, v55
    v_sub_f32 v31, v31, v55
    v_sub_f32 v176, v176, v54
    v_sub_f32 v32, v32, v54
    v_sub_f32 v177, v177, v54
    v_sub_f32 v33, v33, v54
    v_sub_f32 v178, v178, v54
    v_sub_f32 v34, v34, v54
    v_sub_f32 v179, v179, v54
    v_sub_f32 v35, v35, v54
    v_sub_f32 v180, v180, v55
    v_sub_f32 v36, v36, v55
    v_sub_f32 v181, v181, v55
    v_sub_f32 v37, v37, v55
    v_sub_f32 v182, v182, v55
    v_sub_f32 v38, v38, v55
    v_sub_f32 v183, v183, v55
    v_sub_f32 v39, v39, v55
    v_sub_f32 v184, v184, v54
    v_sub_f32 v40, v40, v54
    v_sub_f32 v185, v185, v54
    v_sub_f32 v41, v41, v54
    v_sub_f32 v186, v186, v54
    v_sub_f32 v42, v42, v54
    v_sub_f32 v187, v187, v54
    v_sub_f32 v43, v43, v54
    v_sub_f32 v188, v188, v55
    v_sub_f32 v44, v44, v55
    v_sub_f32 v189, v189, v55
    v_sub_f32 v45, v45, v55
    v_sub_f32 v190, v190, v55
    v_sub_f32 v46, v46, v55
    v_sub_f32 v191, v191, v55
    v_sub_f32 v47, v47, v55
    v_sub_f32 v10, v10, v54
    v_exp_f32 v54, -v54
    v_sub_f32 v11, v11, v55
    v_exp_f32 v55, -v55
    s_nop 0
    v_mul_f32 v248, v248, v54
    v_mul_f32 v252, v252, v55
    v_accvgpr_read_b32 v224, a8
    v_accvgpr_read_b32 v225, a9
    v_accvgpr_read_b32 v226, a10
    v_accvgpr_read_b32 v227, a11
    v_mul_f32 v224, v224, v54
    v_mul_f32 v225, v225, v54
    v_mul_f32 v226, v226, v54
    v_mul_f32 v227, v227, v54
    v_accvgpr_write_b32 a8, v224
    v_accvgpr_write_b32 a9, v225
    v_accvgpr_write_b32 a10, v226
    v_accvgpr_write_b32 a11, v227
    v_accvgpr_read_b32 v224, a12
    v_accvgpr_read_b32 v225, a13
    v_accvgpr_read_b32 v226, a14
    v_accvgpr_read_b32 v227, a15
    v_mul_f32 v224, v224, v55
    v_mul_f32 v225, v225, v55
    v_mul_f32 v226, v226, v55
    v_mul_f32 v227, v227, v55
    v_accvgpr_write_b32 a12, v224
    v_accvgpr_write_b32 a13, v225
    v_accvgpr_write_b32 a14, v226
    v_accvgpr_write_b32 a15, v227
    v_accvgpr_read_b32 v224, a24
    v_accvgpr_read_b32 v225, a25
    v_accvgpr_read_b32 v226, a26
    v_accvgpr_read_b32 v227, a27
    v_mul_f32 v224, v224, v54
    v_mul_f32 v225, v225, v54
    v_mul_f32 v226, v226, v54
    v_mul_f32 v227, v227, v54
    v_accvgpr_write_b32 a24, v224
    v_accvgpr_write_b32 a25, v225
    v_accvgpr_write_b32 a26, v226
    v_accvgpr_write_b32 a27, v227
    v_accvgpr_read_b32 v224, a28
    v_accvgpr_read_b32 v225, a29
    v_accvgpr_read_b32 v226, a30
    v_accvgpr_read_b32 v227, a31
    v_mul_f32 v224, v224, v55
    v_mul_f32 v225, v225, v55
    v_mul_f32 v226, v226, v55
    v_mul_f32 v227, v227, v55
    v_accvgpr_write_b32 a28, v224
    v_accvgpr_write_b32 a29, v225
    v_accvgpr_write_b32 a30, v226
    v_accvgpr_write_b32 a31, v227
    v_accvgpr_read_b32 v224, a40
    v_accvgpr_read_b32 v225, a41
    v_accvgpr_read_b32 v226, a42
    v_accvgpr_read_b32 v227, a43
    v_mul_f32 v224, v224, v54
    v_mul_f32 v225, v225, v54
    v_mul_f32 v226, v226, v54
    v_mul_f32 v227, v227, v54
    v_accvgpr_write_b32 a40, v224
    v_accvgpr_write_b32 a41, v225
    v_accvgpr_write_b32 a42, v226
    v_accvgpr_write_b32 a43, v227
    v_accvgpr_read_b32 v224, a44
    v_accvgpr_read_b32 v225, a45
    v_accvgpr_read_b32 v226, a46
    v_accvgpr_read_b32 v227, a47
    v_mul_f32 v224, v224, v55
    v_mul_f32 v225, v225, v55
    v_mul_f32 v226, v226, v55
    v_mul_f32 v227, v227, v55
    v_accvgpr_write_b32 a44, v224
    v_accvgpr_write_b32 a45, v225
    v_accvgpr_write_b32 a46, v226
    v_accvgpr_write_b32 a47, v227
    v_accvgpr_read_b32 v224, a56
    v_accvgpr_read_b32 v225, a57
    v_accvgpr_read_b32 v226, a58
    v_accvgpr_read_b32 v227, a59
    v_mul_f32 v224, v224, v54
    v_mul_f32 v225, v225, v54
    v_mul_f32 v226, v226, v54
    v_mul_f32 v227, v227, v54
    v_accvgpr_write_b32 a56, v224
    v_accvgpr_write_b32 a57, v225
    v_accvgpr_write_b32 a58, v226
    v_accvgpr_write_b32 a59, v227
    v_accvgpr_read_b32 v224, a60
    v_accvgpr_read_b32 v225, a61
    v_accvgpr_read_b32 v226, a62
    v_accvgpr_read_b32 v227, a63
    v_mul_f32 v224, v224, v55
    v_mul_f32 v225, v225, v55
    v_mul_f32 v226, v226, v55
    v_mul_f32 v227, v227, v55
    v_accvgpr_write_b32 a60, v224
    v_accvgpr_write_b32 a61, v225
    v_accvgpr_write_b32 a62, v226
    v_accvgpr_write_b32 a63, v227
    v_accvgpr_read_b32 v224, a72
    v_accvgpr_read_b32 v225, a73
    v_accvgpr_read_b32 v226, a74
    v_accvgpr_read_b32 v227, a75
    v_mul_f32 v224, v224, v54
    v_mul_f32 v225, v225, v54
    v_mul_f32 v226, v226, v54
    v_mul_f32 v227, v227, v54
    v_accvgpr_write_b32 a72, v224
    v_accvgpr_write_b32 a73, v225
    v_accvgpr_write_b32 a74, v226
    v_accvgpr_write_b32 a75, v227
    v_accvgpr_read_b32 v224, a76
    v_accvgpr_read_b32 v225, a77
    v_accvgpr_read_b32 v226, a78
    v_accvgpr_read_b32 v227, a79
    v_mul_f32 v224, v224, v55
    v_mul_f32 v225, v225, v55
    v_mul_f32 v226, v226, v55
    v_mul_f32 v227, v227, v55
    v_accvgpr_write_b32 a76, v224
    v_accvgpr_write_b32 a77, v225
    v_accvgpr_write_b32 a78, v226
    v_accvgpr_write_b32 a79, v227
    v_accvgpr_read_b32 v224, a88
    v_accvgpr_read_b32 v225, a89
    v_accvgpr_read_b32 v226, a90
    v_accvgpr_read_b32 v227, a91
    v_mul_f32 v224, v224, v54
    v_mul_f32 v225, v225, v54
    v_mul_f32 v226, v226, v54
    v_mul_f32 v227, v227, v54
    v_accvgpr_write_b32 a88, v224
    v_accvgpr_write_b32 a89, v225
    v_accvgpr_write_b32 a90, v226
    v_accvgpr_write_b32 a91, v227
    v_accvgpr_read_b32 v224, a92
    v_accvgpr_read_b32 v225, a93
    v_accvgpr_read_b32 v226, a94
    v_accvgpr_read_b32 v227, a95
    v_mul_f32 v224, v224, v55
    v_mul_f32 v225, v225, v55
    v_mul_f32 v226, v226, v55
    v_mul_f32 v227, v227, v55
    v_accvgpr_write_b32 a92, v224
    v_accvgpr_write_b32 a93, v225
    v_accvgpr_write_b32 a94, v226
    v_accvgpr_write_b32 a95, v227
    v_accvgpr_read_b32 v224, a104
    v_accvgpr_read_b32 v225, a105
    v_accvgpr_read_b32 v226, a106
    v_accvgpr_read_b32 v227, a107
    v_mul_f32 v224, v224, v54
    v_mul_f32 v225, v225, v54
    v_mul_f32 v226, v226, v54
    v_mul_f32 v227, v227, v54
    v_accvgpr_write_b32 a104, v224
    v_accvgpr_write_b32 a105, v225
    v_accvgpr_write_b32 a106, v226
    v_accvgpr_write_b32 a107, v227
    v_accvgpr_read_b32 v224, a108
    v_accvgpr_read_b32 v225, a109
    v_accvgpr_read_b32 v226, a110
    v_accvgpr_read_b32 v227, a111
    v_mul_f32 v224, v224, v55
    v_mul_f32 v225, v225, v55
    v_mul_f32 v226, v226, v55
    v_mul_f32 v227, v227, v55
    v_accvgpr_write_b32 a108, v224
    v_accvgpr_write_b32 a109, v225
    v_accvgpr_write_b32 a110, v226
    v_accvgpr_write_b32 a111, v227
    v_accvgpr_read_b32 v224, a120
    v_accvgpr_read_b32 v225, a121
    v_accvgpr_read_b32 v226, a122
    v_accvgpr_read_b32 v227, a123
    v_mul_f32 v224, v224, v54
    v_mul_f32 v225, v225, v54
    v_mul_f32 v226, v226, v54
    v_mul_f32 v227, v227, v54
    v_accvgpr_write_b32 a120, v224
    v_accvgpr_write_b32 a121, v225
    v_accvgpr_write_b32 a122, v226
    v_accvgpr_write_b32 a123, v227
    v_accvgpr_read_b32 v224, a124
    v_accvgpr_read_b32 v225, a125
    v_accvgpr_read_b32 v226, a126
    v_accvgpr_read_b32 v227, a127
    v_mul_f32 v224, v224, v55
    v_mul_f32 v225, v225, v55
    v_mul_f32 v226, v226, v55
    v_mul_f32 v227, v227, v55
    v_accvgpr_write_b32 a124, v224
    v_accvgpr_write_b32 a125, v225
    v_accvgpr_write_b32 a126, v226
    v_accvgpr_write_b32 a127, v227
    v_exp_f32 v232, v128
    v_exp_f32 v233, v129
    v_exp_f32 v234, v130
    v_exp_f32 v235, v131
    s_nop 0
    v_cvt_pk_bf16_f32 v192, v232, v233
    v_cvt_pk_bf16_f32 v193, v234, v235
    v_exp_f32 v232, v144
    v_exp_f32 v233, v145
    v_exp_f32 v234, v146
    v_exp_f32 v235, v147
    s_nop 0
    v_cvt_pk_bf16_f32 v194, v232, v233
    v_cvt_pk_bf16_f32 v195, v234, v235
    v_exp_f32 v232, v132
    v_exp_f32 v233, v133
    v_exp_f32 v234, v134
    v_exp_f32 v235, v135
    s_nop 0
    v_cvt_pk_bf16_f32 v196, v232, v233
    v_cvt_pk_bf16_f32 v197, v234, v235
    v_exp_f32 v232, v148
    v_exp_f32 v233, v149
    v_exp_f32 v234, v150
    v_exp_f32 v235, v151
    s_nop 0
    v_cvt_pk_bf16_f32 v198, v232, v233
    v_cvt_pk_bf16_f32 v199, v234, v235
    v_exp_f32 v232, v136
    v_exp_f32 v233, v137
    v_exp_f32 v234, v138
    v_exp_f32 v235, v139
    s_nop 0
    v_cvt_pk_bf16_f32 v200, v232, v233
    v_cvt_pk_bf16_f32 v201, v234, v235
    v_exp_f32 v232, v152
    v_exp_f32 v233, v153
    v_exp_f32 v234, v154
    v_exp_f32 v235, v155
    s_nop 0
    v_cvt_pk_bf16_f32 v202, v232, v233
    v_cvt_pk_bf16_f32 v203, v234, v235
    v_exp_f32 v232, v140
    v_exp_f32 v233, v141
    v_exp_f32 v234, v142
    v_exp_f32 v235, v143
    s_nop 0
    v_cvt_pk_bf16_f32 v204, v232, v233
    v_cvt_pk_bf16_f32 v205, v234, v235
    v_exp_f32 v232, v156
    v_exp_f32 v233, v157
    v_exp_f32 v234, v158
    v_exp_f32 v235, v159
    s_nop 0
    v_cvt_pk_bf16_f32 v206, v232, v233
    v_cvt_pk_bf16_f32 v207, v234, v235
    s_nop 1
    s_branch k2_ret_80
k2_rare_81:
    s_nop 7
    v_max_f32 v54, v160, v161
    v_max3_f32 v54, v54, v162, v163
    v_max3_f32 v54, v54, v176, v177
    v_max3_f32 v54, v54, v178, v179
    v_max3_f32 v54, v54, v168, v169
    v_max3_f32 v54, v54, v170, v171
    v_max3_f32 v54, v54, v184, v185
    v_max3_f32 v54, v54, v186, v187
    v_max_f32 v55, v164, v165
    v_max3_f32 v55, v55, v166, v167
    v_max3_f32 v55, v55, v180, v181
    v_max3_f32 v55, v55, v182, v183
    v_max3_f32 v55, v55, v172, v173
    v_max3_f32 v55, v55, v174, v175
    v_max3_f32 v55, v55, v188, v189
    v_max3_f32 v55, v55, v190, v191
    v_mov_b32 v226, v54
    v_mov_b32 v227, v55
    s_nop 1
    v_permlane16_swap_b32 v54, v226
    v_permlane16_swap_b32 v55, v227
    s_nop 1
    v_max_f32 v54, v54, v226
    v_max_f32 v55, v55, v227
    v_mov_b32 v226, v54
    v_mov_b32 v227, v55
    s_nop 1
    v_permlane32_swap_b32 v54, v226
    v_permlane32_swap_b32 v55, v227
    s_nop 1
    v_max_f32 v54, v54, v226
    v_max_f32 v55, v55, v227
    v_add_f32 v54, 0x41400000, v54
    v_max_f32 v54, 0, v54
    v_add_f32 v55, 0x41400000, v55
    v_max_f32 v55, 0, v55
    v_sub_f32 v160, v160, v54
    v_sub_f32 v161, v161, v54
    v_sub_f32 v162, v162, v54
    v_sub_f32 v163, v163, v54
    v_sub_f32 v164, v164, v55
    v_sub_f32 v165, v165, v55
    v_sub_f32 v166, v166, v55
    v_sub_f32 v167, v167, v55
    v_sub_f32 v168, v168, v54
    v_sub_f32 v169, v169, v54
    v_sub_f32 v170, v170, v54
    v_sub_f32 v171, v171, v54
    v_sub_f32 v172, v172, v55
    v_sub_f32 v173, v173, v55
    v_sub_f32 v174, v174, v55
    v_sub_f32 v175, v175, v55
    v_sub_f32 v176, v176, v54
    v_sub_f32 v177, v177, v54
    v_sub_f32 v178, v178, v54
    v_sub_f32 v179, v179, v54
    v_sub_f32 v180, v180, v55
    v_sub_f32 v181, v181, v55
    v_sub_f32 v182, v182, v55
    v_sub_f32 v183, v183, v55
    v_sub_f32 v184, v184, v54
    v_sub_f32 v185, v185, v54
    v_sub_f32 v186, v186, v54
    v_sub_f32 v187, v187, v54
    v_sub_f32 v188, v188, v55
    v_sub_f32 v189, v189, v55
    v_sub_f32 v190, v190, v55
    v_sub_f32 v191, v191, v55
    v_sub_f32 v10, v10, v54
    v_exp_f32 v54, -v54
    v_sub_f32 v11, v11, v55
    v_exp_f32 v55, -v55
    s_nop 0
    v_mul_f32 v248, v248, v54
    v_mul_f32 v252, v252, v55
    v_accvgpr_read_b32 v224, a8
    v_accvgpr_read_b32 v225, a9
    v_accvgpr_read_b32 v226, a10
    v_accvgpr_read_b32 v227, a11
    v_mul_f32 v224, v224, v54
    v_mul_f32 v225, v225, v54
    v_mul_f32 v226, v226, v54
    v_mul_f32 v227, v227, v54
    v_accvgpr_write_b32 a8, v224
    v_accvgpr_write_b32 a9, v225
    v_accvgpr_write_b32 a10, v226
    v_accvgpr_write_b32 a11, v227
    v_accvgpr_read_b32 v224, a12
    v_accvgpr_read_b32 v225, a13
    v_accvgpr_read_b32 v226, a14
    v_accvgpr_read_b32 v227, a15
    v_mul_f32 v224, v224, v55
    v_mul_f32 v225, v225, v55
    v_mul_f32 v226, v226, v55
    v_mul_f32 v227, v227, v55
    v_accvgpr_write_b32 a12, v224
    v_accvgpr_write_b32 a13, v225
    v_accvgpr_write_b32 a14, v226
    v_accvgpr_write_b32 a15, v227
    v_accvgpr_read_b32 v224, a24
    v_accvgpr_read_b32 v225, a25
    v_accvgpr_read_b32 v226, a26
    v_accvgpr_read_b32 v227, a27
    v_mul_f32 v224, v224, v54
    v_mul_f32 v225, v225, v54
    v_mul_f32 v226, v226, v54
    v_mul_f32 v227, v227, v54
    v_accvgpr_write_b32 a24, v224
    v_accvgpr_write_b32 a25, v225
    v_accvgpr_write_b32 a26, v226
    v_accvgpr_write_b32 a27, v227
    v_accvgpr_read_b32 v224, a28
    v_accvgpr_read_b32 v225, a29
    v_accvgpr_read_b32 v226, a30
    v_accvgpr_read_b32 v227, a31
    v_mul_f32 v224, v224, v55
    v_mul_f32 v225, v225, v55
    v_mul_f32 v226, v226, v55
    v_mul_f32 v227, v227, v55
    v_accvgpr_write_b32 a28, v224
    v_accvgpr_write_b32 a29, v225
    v_accvgpr_write_b32 a30, v226
    v_accvgpr_write_b32 a31, v227
    v_accvgpr_read_b32 v224, a40
    v_accvgpr_read_b32 v225, a41
    v_accvgpr_read_b32 v226, a42
    v_accvgpr_read_b32 v227, a43
    v_mul_f32 v224, v224, v54
    v_mul_f32 v225, v225, v54
    v_mul_f32 v226, v226, v54
    v_mul_f32 v227, v227, v54
    v_accvgpr_write_b32 a40, v224
    v_accvgpr_write_b32 a41, v225
    v_accvgpr_write_b32 a42, v226
    v_accvgpr_write_b32 a43, v227
    v_accvgpr_read_b32 v224, a44
    v_accvgpr_read_b32 v225, a45
    v_accvgpr_read_b32 v226, a46
    v_accvgpr_read_b32 v227, a47
    v_mul_f32 v224, v224, v55
    v_mul_f32 v225, v225, v55
    v_mul_f32 v226, v226, v55
    v_mul_f32 v227, v227, v55
    v_accvgpr_write_b32 a44, v224
    v_accvgpr_write_b32 a45, v225
    v_accvgpr_write_b32 a46, v226
    v_accvgpr_write_b32 a47, v227
    v_accvgpr_read_b32 v224, a56
    v_accvgpr_read_b32 v225, a57
    v_accvgpr_read_b32 v226, a58
    v_accvgpr_read_b32 v227, a59
    v_mul_f32 v224, v224, v54
    v_mul_f32 v225, v225, v54
    v_mul_f32 v226, v226, v54
    v_mul_f32 v227, v227, v54
    v_accvgpr_write_b32 a56, v224
    v_accvgpr_write_b32 a57, v225
    v_accvgpr_write_b32 a58, v226
    v_accvgpr_write_b32 a59, v227
    v_accvgpr_read_b32 v224, a60
    v_accvgpr_read_b32 v225, a61
    v_accvgpr_read_b32 v226, a62
    v_accvgpr_read_b32 v227, a63
    v_mul_f32 v224, v224, v55
    v_mul_f32 v225, v225, v55
    v_mul_f32 v226, v226, v55
    v_mul_f32 v227, v227, v55
    v_accvgpr_write_b32 a60, v224
    v_accvgpr_write_b32 a61, v225
    v_accvgpr_write_b32 a62, v226
    v_accvgpr_write_b32 a63, v227
    v_accvgpr_read_b32 v224, a72
    v_accvgpr_read_b32 v225, a73
    v_accvgpr_read_b32 v226, a74
    v_accvgpr_read_b32 v227, a75
    v_mul_f32 v224, v224, v54
    v_mul_f32 v225, v225, v54
    v_mul_f32 v226, v226, v54
    v_mul_f32 v227, v227, v54
    v_accvgpr_write_b32 a72, v224
    v_accvgpr_write_b32 a73, v225
    v_accvgpr_write_b32 a74, v226
    v_accvgpr_write_b32 a75, v227
    v_accvgpr_read_b32 v224, a76
    v_accvgpr_read_b32 v225, a77
    v_accvgpr_read_b32 v226, a78
    v_accvgpr_read_b32 v227, a79
    v_mul_f32 v224, v224, v55
    v_mul_f32 v225, v225, v55
    v_mul_f32 v226, v226, v55
    v_mul_f32 v227, v227, v55
    v_accvgpr_write_b32 a76, v224
    v_accvgpr_write_b32 a77, v225
    v_accvgpr_write_b32 a78, v226
    v_accvgpr_write_b32 a79, v227
    v_accvgpr_read_b32 v224, a88
    v_accvgpr_read_b32 v225, a89
    v_accvgpr_read_b32 v226, a90
    v_accvgpr_read_b32 v227, a91
    v_mul_f32 v224, v224, v54
    v_mul_f32 v225, v225, v54
    v_mul_f32 v226, v226, v54
    v_mul_f32 v227, v227, v54
    v_accvgpr_write_b32 a88, v224
    v_accvgpr_write_b32 a89, v225
    v_accvgpr_write_b32 a90, v226
    v_accvgpr_write_b32 a91, v227
    v_accvgpr_read_b32 v224, a92
    v_accvgpr_read_b32 v225, a93
    v_accvgpr_read_b32 v226, a94
    v_accvgpr_read_b32 v227, a95
    v_mul_f32 v224, v224, v55
    v_mul_f32 v225, v225, v55
    v_mul_f32 v226, v226, v55
    v_mul_f32 v227, v227, v55
    v_accvgpr_write_b32 a92, v224
    v_accvgpr_write_b32 a93, v225
    v_accvgpr_write_b32 a94, v226
    v_accvgpr_write_b32 a95, v227
    v_accvgpr_read_b32 v224, a104
    v_accvgpr_read_b32 v225, a105
    v_accvgpr_read_b32 v226, a106
    v_accvgpr_read_b32 v227, a107
    v_mul_f32 v224, v224, v54
    v_mul_f32 v225, v225, v54
    v_mul_f32 v226, v226, v54
    v_mul_f32 v227, v227, v54
    v_accvgpr_write_b32 a104, v224
    v_accvgpr_write_b32 a105, v225
    v_accvgpr_write_b32 a106, v226
    v_accvgpr_write_b32 a107, v227
    v_accvgpr_read_b32 v224, a108
    v_accvgpr_read_b32 v225, a109
    v_accvgpr_read_b32 v226, a110
    v_accvgpr_read_b32 v227, a111
    v_mul_f32 v224, v224, v55
    v_mul_f32 v225, v225, v55
    v_mul_f32 v226, v226, v55
    v_mul_f32 v227, v227, v55
    v_accvgpr_write_b32 a108, v224
    v_accvgpr_write_b32 a109, v225
    v_accvgpr_write_b32 a110, v226
    v_accvgpr_write_b32 a111, v227
    v_accvgpr_read_b32 v224, a120
    v_accvgpr_read_b32 v225, a121
    v_accvgpr_read_b32 v226, a122
    v_accvgpr_read_b32 v227, a123
    v_mul_f32 v224, v224, v54
    v_mul_f32 v225, v225, v54
    v_mul_f32 v226, v226, v54
    v_mul_f32 v227, v227, v54
    v_accvgpr_write_b32 a120, v224
    v_accvgpr_write_b32 a121, v225
    v_accvgpr_write_b32 a122, v226
    v_accvgpr_write_b32 a123, v227
    v_accvgpr_read_b32 v224, a124
    v_accvgpr_read_b32 v225, a125
    v_accvgpr_read_b32 v226, a126
    v_accvgpr_read_b32 v227, a127
    v_mul_f32 v224, v224, v55
    v_mul_f32 v225, v225, v55
    v_mul_f32 v226, v226, v55
    v_mul_f32 v227, v227, v55
    v_accvgpr_write_b32 a124, v224
    v_accvgpr_write_b32 a125, v225
    v_accvgpr_write_b32 a126, v226
    v_accvgpr_write_b32 a127, v227
    v_exp_f32 v232, v160
    v_exp_f32 v233, v161
    v_exp_f32 v234, v162
    v_exp_f32 v235, v163
    s_nop 0
    v_cvt_pk_bf16_f32 v208, v232, v233
    v_cvt_pk_bf16_f32 v209, v234, v235
    v_exp_f32 v232, v176
    v_exp_f32 v233, v177
    v_exp_f32 v234, v178
    v_exp_f32 v235, v179
    s_nop 0
    v_cvt_pk_bf16_f32 v210, v232, v233
    v_cvt_pk_bf16_f32 v211, v234, v235
    v_exp_f32 v232, v164
    v_exp_f32 v233, v165
    v_exp_f32 v234, v166
    v_exp_f32 v235, v167
    s_nop 0
    v_cvt_pk_bf16_f32 v212, v232, v233
    v_cvt_pk_bf16_f32 v213, v234, v235
    v_exp_f32 v232, v180
    v_exp_f32 v233, v181
    v_exp_f32 v234, v182
    v_exp_f32 v235, v183
    s_nop 0
    v_cvt_pk_bf16_f32 v214, v232, v233
    v_cvt_pk_bf16_f32 v215, v234, v235
    v_exp_f32 v232, v168
    v_exp_f32 v233, v169
    v_exp_f32 v234, v170
    v_exp_f32 v235, v171
    s_nop 0
    v_cvt_pk_bf16_f32 v216, v232, v233
    v_cvt_pk_bf16_f32 v217, v234, v235
    v_exp_f32 v232, v184
    v_exp_f32 v233, v185
    v_exp_f32 v234, v186
    v_exp_f32 v235, v187
    s_nop 0
    v_cvt_pk_bf16_f32 v218, v232, v233
    v_cvt_pk_bf16_f32 v219, v234, v235
    v_exp_f32 v232, v172
    v_exp_f32 v233, v173
    v_exp_f32 v234, v174
    v_exp_f32 v235, v175
    s_nop 0
    v_cvt_pk_bf16_f32 v220, v232, v233
    v_cvt_pk_bf16_f32 v221, v234, v235
    v_exp_f32 v232, v188
    v_exp_f32 v233, v189
    v_exp_f32 v234, v190
    v_exp_f32 v235, v191
    s_nop 0
    v_cvt_pk_bf16_f32 v222, v232, v233
    v_cvt_pk_bf16_f32 v223, v234, v235
    s_nop 1
    s_branch k2_ret_82
.globl k3_kernel
.p2align 8
.type k3_kernel,@function
k3_kernel:
    s_cmp_ge_u32 s2, 256
    s_cbranch_scc1 k3_end_84
    s_load_dwordx2 s[4:5], s[0:1], 40
    s_load_dwordx2 s[6:7], s[0:1], 104
    s_load_dwordx2 s[28:29], s[0:1], 0
    s_load_dwordx2 s[30:31], s[0:1], 56
    s_lshr_b32 s41, s2, 3
    s_bfe_u32 s44, s2, 0x10002
    s_and_b32 s42, s2, 1
    s_lshl_b32 s42, s42, 3
    s_and_b32 s43, s41, 7
    s_add_u32 s42, s42, s43
    s_and_b32 s43, s2, 2
    s_lshl_b32 s43, s43, 1
    s_lshr_b32 s40, s41, 3
    s_add_u32 s43, s43, s40
    v_lshrrev_b32 v10, 6, v0
    v_and_b32 v11, 63, v0
    v_readfirstlane_b32 s45, v10
    v_lshlrev_b32 v1, 4, v11
    s_lshl_b32 s46, s42, 7
    s_lshl_b32 s47, s45, 5
    s_add_u32 s46, s46, s47
    s_lshl_b32 s47, s46, 6
    v_add_u32 v12, s47, v1
    v_add_u32 v13, 0x20000, v12
    v_lshrrev_b32 v20, 4, v11
    v_bfe_u32 v21, v11, 1, 3
    v_xor_b32 v21, v21, v20
    v_and_b32 v22, 1, v11
    v_lshl_add_u32 v23, v10, 4, v20
    v_lshlrev_b32 v23, 11, v23
    v_lshl_add_u32 v23, v22, 4, v23
    s_lshl_b32 s47, s43, 8
    v_add_u32 v23, s47, v23
    v_xor_b32 v22, 0, v21
    v_lshl_add_u32 v22, v22, 5, v23
    v_add_u32 v16, 0, v22
    v_xor_b32 v22, 4, v21
    v_lshl_add_u32 v22, v22, 5, v23
    v_add_u32 v17, 7168, v22
    v_xor_b32 v22, 0, v21
    v_lshl_add_u32 v22, v22, 5, v23
    v_add_u32 v18, 14336, v22
    v_xor_b32 v22, 4, v21
    v_lshl_add_u32 v22, v22, 5, v23
    v_add_u32 v19, 21504, v22
    s_lshl_b32 s60, s45, 12
    s_lshl_b32 s61, s44, 22
    s_lshl_b32 s62, s44, 23
    s_waitcnt lgkmcnt(0)
    s_add_u32 s8, s6, 0x3000000
    s_addc_u32 s9, s7, 0
    s_and_b32 s9, s9, 0xffff
    s_mov_b32 s10, 0x1000000
    s_mov_b32 s11, 0x00020000
    s_mov_b32 s12, s4
    s_and_b32 s13, s5, 0xffff
    s_mov_b32 s14, 0x800000
    s_mov_b32 s15, 0x00020000
    s_add_u32 s10, s62, 0x800000
    s_add_u32 s14, s61, 0x400000
    s_add_u32 m0, s60, 0
    s_nop 0
    buffer_load_dwordx4 v16, s[12:15], s61 offen offset:0 lds
    buffer_load_dwordx4 v17, s[12:15], s61 offen offset:1024 lds
    buffer_load_dwordx4 v18, s[12:15], s61 offen offset:2048 lds
    buffer_load_dwordx4 v19, s[12:15], s61 offen offset:3072 lds
    s_add_u32 s61, s61, 0x20000
    buffer_load_dwordx4 a[128:131], v12, s[8:11], s62 offen offset:0
    buffer_load_dwordx4 a[132:135], v12, s[8:11], s62 offen offset:1024
    buffer_load_dwordx4 a[136:139], v13, s[8:11], s62 offen offset:0
    buffer_load_dwordx4 a[140:143], v13, s[8:11], s62 offen offset:1024
    s_add_u32 s62, s62, 0x40000
    s_add_u32 m0, s60, 16384
    s_nop 0
    buffer_load_dwordx4 v16, s[12:15], s61 offen offset:0 lds
    buffer_load_dwordx4 v17, s[12:15], s61 offen offset:1024 lds
    buffer_load_dwordx4 v18, s[12:15], s61 offen offset:2048 lds
    buffer_load_dwordx4 v19, s[12:15], s61 offen offset:3072 lds
    s_add_u32 s61, s61, 0x20000
    buffer_load_dwordx4 a[144:147], v12, s[8:11], s62 offen offset:0
    buffer_load_dwordx4 a[148:151], v12, s[8:11], s62 offen offset:1024
    buffer_load_dwordx4 a[152:155], v13, s[8:11], s62 offen offset:0
    buffer_load_dwordx4 a[156:159], v13, s[8:11], s62 offen offset:1024
    s_add_u32 s62, s62, 0x40000
    s_add_u32 m0, s60, 32768
    s_nop 0
    buffer_load_dwordx4 v16, s[12:15], s61 offen offset:0 lds
    buffer_load_dwordx4 v17, s[12:15], s61 offen offset:1024 lds
    buffer_load_dwordx4 v18, s[12:15], s61 offen offset:2048 lds
    buffer_load_dwordx4 v19, s[12:15], s61 offen offset:3072 lds
    s_add_u32 s61, s61, 0x20000
    buffer_load_dwordx4 a[160:163], v12, s[8:11], s62 offen offset:0
    buffer_load_dwordx4 a[164:167], v12, s[8:11], s62 offen offset:1024
    buffer_load_dwordx4 a[168:171], v13, s[8:11], s62 offen offset:0
    buffer_load_dwordx4 a[172:175], v13, s[8:11], s62 offen offset:1024
    s_add_u32 s62, s62, 0x40000
    s_mov_b32 s16, s28
    s_and_b32 s17, s29, 0xffff
    s_mov_b32 s18, 0x400000
    s_mov_b32 s19, 0x00020000
    s_mov_b32 s20, s30
    s_and_b32 s21, s31, 0xffff
    s_mov_b32 s22, 0x800
    s_mov_b32 s23, 0x00020000
    s_add_u32 s24, s6, 0x4000000
    s_addc_u32 s25, s7, 0
    s_and_b32 s25, s25, 0xffff
    s_mov_b32 s26, 0x400000
    s_mov_b32 s27, 0x00020000
    s_add_u32 s32, s6, 0x4800000
    s_addc_u32 s33, s7, 0
    s_and_b32 s33, s33, 0xffff
    s_mov_b32 s34, 0x6000
    s_mov_b32 s35, 0x00020000
    s_add_u32 s36, s6, 0x5000000
    s_addc_u32 s37, s7, 0
    s_and_b32 s37, s37, 0xffff
    s_mov_b32 s38, 0x800000
    s_mov_b32 s39, 0x00020000
    s_add_u32 s48, s6, 0x4807000
    s_addc_u32 s49, s7, 0
    s_and_b32 s49, s49, 0xffff
    s_mov_b32 s50, 0x8000
    s_mov_b32 s51, 0x00020000
    v_and_b32 v21, 15, v11
    v_add_u32 v22, s46, v21
    v_lshlrev_b32 v2, 2, v22
    v_lshl_add_u32 v2, v20, 13, v2
    v_lshlrev_b32 v22, 11, v22
    s_lshl_b32 s52, s44, 7
    s_add_u32 s47, s47, s52
    v_lshl_add_u32 v14, v20, 3, s47
    v_add_u32 v3, v22, v14
    v_add_u32 v4, 0x8000, v3
    s_lshl_b32 s52, s2, 14
    s_add_u32 s52, s52, s60
    s_xor_b32 s53, s52, 0x10000
    s_lshl_b32 s54, s2, 7
    s_xor_b32 s55, s54, 0x200
    v_mov_b32 v5, 0
    v_mov_b32 v6, 1
    v_lshrrev_b32 v22, 2, v21
    v_lshl_add_u32 v22, v20, 2, v22
    v_and_b32 v23, 7, v22
    s_lshl_b32 s56, s44, 2
    v_xor_b32 v23, s56, v23
    v_lshlrev_b32 v22, 8, v22
    v_and_b32 v32, 3, v11
    v_lshl_add_u32 v22, v32, 3, v22
    v_xor_b32 v32, 0, v23
    v_lshl_add_u32 v24, v32, 5, v22
    v_xor_b32 v32, 1, v23
    v_lshl_add_u32 v25, v32, 5, v22
    v_xor_b32 v32, 2, v23
    v_lshl_add_u32 v26, v32, 5, v22
    v_xor_b32 v32, 3, v23
    v_lshl_add_u32 v27, v32, 5, v22
    v_xor_b32 v32, 4, v23
    v_lshl_add_u32 v28, v32, 5, v22
    v_xor_b32 v32, 5, v23
    v_lshl_add_u32 v29, v32, 5, v22
    v_xor_b32 v32, 6, v23
    v_lshl_add_u32 v30, v32, 5, v22
    v_xor_b32 v32, 7, v23
    v_lshl_add_u32 v31, v32, 5, v22
    s_mov_b32 s57, (code_end-k3_tail)/128
    v_mov_b32 v56, 0
    v_mov_b32 v57, 0
    v_mov_b32 v58, 0
    v_mov_b32 v59, 0
    s_nop 1
    v_mfma_f32_32x32x16_bf16 v[64:79], v[56:59], v[56:59], 0
    v_mfma_f32_32x32x16_bf16 v[80:95], v[56:59], v[56:59], 0
    v_mfma_f32_32x32x16_bf16 v[96:111], v[56:59], v[56:59], 0
    v_mfma_f32_32x32x16_bf16 v[112:127], v[56:59], v[56:59], 0
    v_min_u32 v33, s57, v0
    s_getpc_b64 s[58:59]
pc_85:
    s_add_u32 s58, s58, k3_tail-pc_85
    s_addc_u32 s59, s59, 0
    v_lshlrev_b32 v8, 7, v33
    v_mov_b32 v9, s59
    v_add_co_u32 v8, vcc, s58, v8
    s_nop 1
    v_addc_co_u32 v9, vcc, 0, v9, vcc
    s_lshl_b32 s56, s41, 2
    s_add_u32 s56, s56, s45
    s_and_b32 s57, s2, 7
    v_lshrrev_b32 v34, 3, v11
    v_and_b32 v35, 7, v11
    v_min_u32 v35, 6, v35
    v_mul_u32_u24 v34, 7168, v34
    v_lshl_add_u32 v34, v35, 7, v34
    s_mul_i32 s58, s56, 57344
    s_mul_i32 s59, s57, 896
    s_add_u32 s58, s58, s59
    v_add_u32 v34, s58, v34
    v_min_u32 v35, 55, v11
    v_lshlrev_b32 v35, 7, v35
    s_mul_i32 s58, s56, 7168
    s_mul_i32 s59, s57, 917504
    s_add_u32 s58, s58, s59
    v_add_u32 v35, s58, v35
    s_waitcnt vmcnt(20)
    s_barrier
    ds_read_b64_tr_b16 a[0:1], v24 offset:0
    ds_read_b64_tr_b16 a[2:3], v24 offset:4096
    ds_read_b64_tr_b16 a[4:5], v25 offset:0
    ds_read_b64_tr_b16 a[6:7], v25 offset:4096
    ds_read_b64_tr_b16 a[8:9], v26 offset:0
    ds_read_b64_tr_b16 a[10:11], v26 offset:4096
    ds_read_b64_tr_b16 a[12:13], v27 offset:0
    ds_read_b64_tr_b16 a[14:15], v27 offset:4096
    ds_read_b64_tr_b16 a[16:17], v28 offset:0
    ds_read_b64_tr_b16 a[18:19], v28 offset:4096
    ds_read_b64_tr_b16 a[20:21], v29 offset:0
    ds_read_b64_tr_b16 a[22:23], v29 offset:4096
    ds_read_b64_tr_b16 a[24:25], v30 offset:0
    ds_read_b64_tr_b16 a[26:27], v30 offset:4096
    ds_read_b64_tr_b16 a[28:29], v31 offset:0
    ds_read_b64_tr_b16 a[30:31], v31 offset:4096
    ds_read_b64_tr_b16 a[32:33], v24 offset:8192
    ds_read_b64_tr_b16 a[34:35], v24 offset:12288
    ds_read_b64_tr_b16 a[36:37], v25 offset:8192
    ds_read_b64_tr_b16 a[38:39], v25 offset:12288
    ds_read_b64_tr_b16 a[40:41], v26 offset:8192
    ds_read_b64_tr_b16 a[42:43], v26 offset:12288
    ds_read_b64_tr_b16 a[44:45], v27 offset:8192
    ds_read_b64_tr_b16 a[46:47], v27 offset:12288
    ds_read_b64_tr_b16 a[48:49], v28 offset:8192
    ds_read_b64_tr_b16 a[50:51], v28 offset:12288
    ds_read_b64_tr_b16 a[52:53], v29 offset:8192
    ds_read_b64_tr_b16 a[54:55], v29 offset:12288
    ds_read_b64_tr_b16 a[56:57], v30 offset:8192
    ds_read_b64_tr_b16 a[58:59], v30 offset:12288
    ds_read_b64_tr_b16 a[60:61], v31 offset:8192
    ds_read_b64_tr_b16 a[62:63], v31 offset:12288
    s_mov_b32 s63, 0
    s_waitcnt vmcnt(12) lgkmcnt(0)
    s_barrier
k3_loop_86:
    v_mfma_f32_16x16x32_bf16 v[96:99], a[16:19], a[128:131], v[96:99]
    s_add_u32 m0, s60, 49152
    ds_read_b64_tr_b16 a[64:65], v24 offset:16384
    ds_read_b64_tr_b16 a[66:67], v24 offset:20480
    v_mfma_f32_16x16x32_bf16 v[100:103], a[16:19], a[132:135], v[100:103]
    buffer_load_dwordx4 v16, s[12:15], s61 offen offset:0 lds
    ds_read_b64_tr_b16 a[68:69], v25 offset:16384
    v_mfma_f32_16x16x32_bf16 v[104:107], a[20:23], a[128:131], v[104:107]
    ds_read_b64_tr_b16 a[70:71], v25 offset:20480
    ds_read_b64_tr_b16 a[72:73], v26 offset:16384
    v_mfma_f32_16x16x32_bf16 v[108:111], a[20:23], a[132:135], v[108:111]
    buffer_load_dwordx4 v17, s[12:15], s61 offen offset:1024 lds
    ds_read_b64_tr_b16 a[74:75], v26 offset:20480
    v_mfma_f32_16x16x32_bf16 v[112:115], a[24:27], a[128:131], v[112:115]
    ds_read_b64_tr_b16 a[76:77], v27 offset:16384
    ds_read_b64_tr_b16 a[78:79], v27 offset:20480
    v_mfma_f32_16x16x32_bf16 v[116:119], a[24:27], a[132:135], v[116:119]
    ds_read_b64_tr_b16 a[80:81], v28 offset:16384
    v_mfma_f32_16x16x32_bf16 v[120:123], a[28:31], a[128:131], v[120:123]
    ds_read_b64_tr_b16 a[82:83], v28 offset:20480
    v_mfma_f32_16x16x32_bf16 v[124:127], a[28:31], a[132:135], v[124:127]
    buffer_load_dwordx4 v18, s[12:15], s61 offen offset:2048 lds
    ds_read_b64_tr_b16 a[84:85], v29 offset:16384
    v_mfma_f32_16x16x32_bf16 v[64:67], a[0:3], a[128:131], v[64:67]
    ds_read_b64_tr_b16 a[86:87], v29 offset:20480
    ds_read_b64_tr_b16 a[88:89], v30 offset:16384
    v_mfma_f32_16x16x32_bf16 v[68:71], a[0:3], a[132:135], v[68:71]
    ds_read_b64_tr_b16 a[90:91], v30 offset:20480
    v_mfma_f32_16x16x32_bf16 v[72:75], a[4:7], a[128:131], v[72:75]
    buffer_load_dwordx4 v19, s[12:15], s61 offen offset:3072 lds
    ds_read_b64_tr_b16 a[92:93], v31 offset:16384
    v_mfma_f32_16x16x32_bf16 v[76:79], a[4:7], a[132:135], v[76:79]
    ds_read_b64_tr_b16 a[94:95], v31 offset:20480
    ds_read_b64_tr_b16 a[96:97], v24 offset:24576
    v_mfma_f32_16x16x32_bf16 v[80:83], a[8:11], a[128:131], v[80:83]
    ds_read_b64_tr_b16 a[98:99], v24 offset:28672
    v_mfma_f32_16x16x32_bf16 v[84:87], a[8:11], a[132:135], v[84:87]
    ds_read_b64_tr_b16 a[100:101], v25 offset:24576
    v_mfma_f32_16x16x32_bf16 v[88:91], a[12:15], a[128:131], v[88:91]
    buffer_load_dwordx4 a[176:179], v12, s[8:11], s62 offen offset:0
    ds_read_b64_tr_b16 a[102:103], v25 offset:28672
    v_mfma_f32_16x16x32_bf16 v[92:95], a[12:15], a[132:135], v[92:95]
    s_add_u32 s61, s61, 0x20000
    ds_read_b64_tr_b16 a[104:105], v26 offset:24576
    ds_read_b64_tr_b16 a[106:107], v26 offset:28672
    v_mfma_f32_16x16x32_bf16 v[96:99], a[48:51], a[136:139], v[96:99]
    ds_read_b64_tr_b16 a[108:109], v27 offset:24576
    v_mfma_f32_16x16x32_bf16 v[100:103], a[48:51], a[140:143], v[100:103]
    buffer_load_dwordx4 a[180:183], v12, s[8:11], s62 offen offset:1024
    ds_read_b64_tr_b16 a[110:111], v27 offset:28672
    v_mfma_f32_16x16x32_bf16 v[104:107], a[52:55], a[136:139], v[104:107]
    ds_read_b64_tr_b16 a[112:113], v28 offset:24576
    v_mfma_f32_16x16x32_bf16 v[108:111], a[52:55], a[140:143], v[108:111]
    ds_read_b64_tr_b16 a[114:115], v28 offset:28672
    ds_read_b64_tr_b16 a[116:117], v29 offset:24576
    v_mfma_f32_16x16x32_bf16 v[112:115], a[56:59], a[136:139], v[112:115]
    ds_read_b64_tr_b16 a[118:119], v29 offset:28672
    v_mfma_f32_16x16x32_bf16 v[116:119], a[56:59], a[140:143], v[116:119]
    buffer_load_dwordx4 a[184:187], v13, s[8:11], s62 offen offset:0
    ds_read_b64_tr_b16 a[120:121], v30 offset:24576
    v_mfma_f32_16x16x32_bf16 v[120:123], a[60:63], a[136:139], v[120:123]
    ds_read_b64_tr_b16 a[122:123], v30 offset:28672
    ds_read_b64_tr_b16 a[124:125], v31 offset:24576
    v_mfma_f32_16x16x32_bf16 v[124:127], a[60:63], a[140:143], v[124:127]
    ds_read_b64_tr_b16 a[126:127], v31 offset:28672
    v_mfma_f32_16x16x32_bf16 v[64:67], a[32:35], a[136:139], v[64:67]
    buffer_load_dwordx4 a[188:191], v13, s[8:11], s62 offen offset:1024
    v_mfma_f32_16x16x32_bf16 v[68:71], a[32:35], a[140:143], v[68:71]
    v_mfma_f32_16x16x32_bf16 v[72:75], a[36:39], a[136:139], v[72:75]
    v_mfma_f32_16x16x32_bf16 v[76:79], a[36:39], a[140:143], v[76:79]
    v_mfma_f32_16x16x32_bf16 v[80:83], a[40:43], a[136:139], v[80:83]
    s_cmp_eq_u32 s63, 7
    s_cbranch_scc1 k3_ool_87
k3_oolret_88:
    v_mfma_f32_16x16x32_bf16 v[84:87], a[40:43], a[140:143], v[84:87]
    s_add_u32 s62, s62, 0x40000
    v_mfma_f32_16x16x32_bf16 v[88:91], a[44:47], a[136:139], v[88:91]
    v_mfma_f32_16x16x32_bf16 v[92:95], a[44:47], a[140:143], v[92:95]
    s_waitcnt vmcnt(12) lgkmcnt(0)
    s_barrier
    v_mfma_f32_16x16x32_bf16 v[96:99], a[80:83], a[144:147], v[96:99]
    s_add_u32 m0, s60, 0
    ds_read_b64_tr_b16 a[0:1], v24 offset:32768
    ds_read_b64_tr_b16 a[2:3], v24 offset:36864
    v_mfma_f32_16x16x32_bf16 v[100:103], a[80:83], a[148:151], v[100:103]
    buffer_load_dwordx4 v16, s[12:15], s61 offen offset:0 lds
    ds_read_b64_tr_b16 a[4:5], v25 offset:32768
    v_mfma_f32_16x16x32_bf16 v[104:107], a[84:87], a[144:147], v[104:107]
    ds_read_b64_tr_b16 a[6:7], v25 offset:36864
    ds_read_b64_tr_b16 a[8:9], v26 offset:32768
    v_mfma_f32_16x16x32_bf16 v[108:111], a[84:87], a[148:151], v[108:111]
    buffer_load_dwordx4 v17, s[12:15], s61 offen offset:1024 lds
    ds_read_b64_tr_b16 a[10:11], v26 offset:36864
    v_mfma_f32_16x16x32_bf16 v[112:115], a[88:91], a[144:147], v[112:115]
    ds_read_b64_tr_b16 a[12:13], v27 offset:32768
    ds_read_b64_tr_b16 a[14:15], v27 offset:36864
    v_mfma_f32_16x16x32_bf16 v[116:119], a[88:91], a[148:151], v[116:119]
    ds_read_b64_tr_b16 a[16:17], v28 offset:32768
    v_mfma_f32_16x16x32_bf16 v[120:123], a[92:95], a[144:147], v[120:123]
    ds_read_b64_tr_b16 a[18:19], v28 offset:36864
    v_mfma_f32_16x16x32_bf16 v[124:127], a[92:95], a[148:151], v[124:127]
    buffer_load_dwordx4 v18, s[12:15], s61 offen offset:2048 lds
    ds_read_b64_tr_b16 a[20:21], v29 offset:32768
    v_mfma_f32_16x16x32_bf16 v[64:67], a[64:67], a[144:147], v[64:67]
    ds_read_b64_tr_b16 a[22:23], v29 offset:36864
    ds_read_b64_tr_b16 a[24:25], v30 offset:32768
    v_mfma_f32_16x16x32_bf16 v[68:71], a[64:67], a[148:151], v[68:71]
    ds_read_b64_tr_b16 a[26:27], v30 offset:36864
    v_mfma_f32_16x16x32_bf16 v[72:75], a[68:71], a[144:147], v[72:75]
    buffer_load_dwordx4 v19, s[12:15], s61 offen offset:3072 lds
    ds_read_b64_tr_b16 a[28:29], v31 offset:32768
    v_mfma_f32_16x16x32_bf16 v[76:79], a[68:71], a[148:151], v[76:79]
    ds_read_b64_tr_b16 a[30:31], v31 offset:36864
    ds_read_b64_tr_b16 a[32:33], v24 offset:40960
    v_mfma_f32_16x16x32_bf16 v[80:83], a[72:75], a[144:147], v[80:83]
    ds_read_b64_tr_b16 a[34:35], v24 offset:45056
    v_mfma_f32_16x16x32_bf16 v[84:87], a[72:75], a[148:151], v[84:87]
    ds_read_b64_tr_b16 a[36:37], v25 offset:40960
    v_mfma_f32_16x16x32_bf16 v[88:91], a[76:79], a[144:147], v[88:91]
    buffer_load_dwordx4 a[128:131], v12, s[8:11], s62 offen offset:0
    ds_read_b64_tr_b16 a[38:39], v25 offset:45056
    v_mfma_f32_16x16x32_bf16 v[92:95], a[76:79], a[148:151], v[92:95]
    s_add_u32 s61, s61, 0x20000
    ds_read_b64_tr_b16 a[40:41], v26 offset:40960
    ds_read_b64_tr_b16 a[42:43], v26 offset:45056
    v_mfma_f32_16x16x32_bf16 v[96:99], a[112:115], a[152:155], v[96:99]
    ds_read_b64_tr_b16 a[44:45], v27 offset:40960
    v_mfma_f32_16x16x32_bf16 v[100:103], a[112:115], a[156:159], v[100:103]
    buffer_load_dwordx4 a[132:135], v12, s[8:11], s62 offen offset:1024
    ds_read_b64_tr_b16 a[46:47], v27 offset:45056
    v_mfma_f32_16x16x32_bf16 v[104:107], a[116:119], a[152:155], v[104:107]
    ds_read_b64_tr_b16 a[48:49], v28 offset:40960
    v_mfma_f32_16x16x32_bf16 v[108:111], a[116:119], a[156:159], v[108:111]
    ds_read_b64_tr_b16 a[50:51], v28 offset:45056
    ds_read_b64_tr_b16 a[52:53], v29 offset:40960
    v_mfma_f32_16x16x32_bf16 v[112:115], a[120:123], a[152:155], v[112:115]
    ds_read_b64_tr_b16 a[54:55], v29 offset:45056
    v_mfma_f32_16x16x32_bf16 v[116:119], a[120:123], a[156:159], v[116:119]
    buffer_load_dwordx4 a[136:139], v13, s[8:11], s62 offen offset:0
    ds_read_b64_tr_b16 a[56:57], v30 offset:40960
    v_mfma_f32_16x16x32_bf16 v[120:123], a[124:127], a[152:155], v[120:123]
    ds_read_b64_tr_b16 a[58:59], v30 offset:45056
    ds_read_b64_tr_b16 a[60:61], v31 offset:40960
    v_mfma_f32_16x16x32_bf16 v[124:127], a[124:127], a[156:159], v[124:127]
    ds_read_b64_tr_b16 a[62:63], v31 offset:45056
    v_mfma_f32_16x16x32_bf16 v[64:67], a[96:99], a[152:155], v[64:67]
    buffer_load_dwordx4 a[140:143], v13, s[8:11], s62 offen offset:1024
    v_mfma_f32_16x16x32_bf16 v[68:71], a[96:99], a[156:159], v[68:71]
    v_mfma_f32_16x16x32_bf16 v[72:75], a[100:103], a[152:155], v[72:75]
    v_mfma_f32_16x16x32_bf16 v[76:79], a[100:103], a[156:159], v[76:79]
    v_mfma_f32_16x16x32_bf16 v[80:83], a[104:107], a[152:155], v[80:83]
    v_mfma_f32_16x16x32_bf16 v[84:87], a[104:107], a[156:159], v[84:87]
    s_add_u32 s62, s62, 0x40000
    v_mfma_f32_16x16x32_bf16 v[88:91], a[108:111], a[152:155], v[88:91]
    v_mfma_f32_16x16x32_bf16 v[92:95], a[108:111], a[156:159], v[92:95]
    s_waitcnt vmcnt(12) lgkmcnt(0)
    s_barrier
    v_mfma_f32_16x16x32_bf16 v[96:99], a[16:19], a[160:163], v[96:99]
    s_add_u32 m0, s60, 16384
    ds_read_b64_tr_b16 a[64:65], v24 offset:49152
    ds_read_b64_tr_b16 a[66:67], v24 offset:53248
    v_mfma_f32_16x16x32_bf16 v[100:103], a[16:19], a[164:167], v[100:103]
    buffer_load_dwordx4 v16, s[12:15], s61 offen offset:0 lds
    ds_read_b64_tr_b16 a[68:69], v25 offset:49152
    v_mfma_f32_16x16x32_bf16 v[104:107], a[20:23], a[160:163], v[104:107]
    ds_read_b64_tr_b16 a[70:71], v25 offset:53248
    ds_read_b64_tr_b16 a[72:73], v26 offset:49152
    v_mfma_f32_16x16x32_bf16 v[108:111], a[20:23], a[164:167], v[108:111]
    buffer_load_dwordx4 v17, s[12:15], s61 offen offset:1024 lds
    ds_read_b64_tr_b16 a[74:75], v26 offset:53248
    v_mfma_f32_16x16x32_bf16 v[112:115], a[24:27], a[160:163], v[112:115]
    ds_read_b64_tr_b16 a[76:77], v27 offset:49152
    ds_read_b64_tr_b16 a[78:79], v27 offset:53248
    v_mfma_f32_16x16x32_bf16 v[116:119], a[24:27], a[164:167], v[116:119]
    ds_read_b64_tr_b16 a[80:81], v28 offset:49152
    v_mfma_f32_16x16x32_bf16 v[120:123], a[28:31], a[160:163], v[120:123]
    ds_read_b64_tr_b16 a[82:83], v28 offset:53248
    v_mfma_f32_16x16x32_bf16 v[124:127], a[28:31], a[164:167], v[124:127]
    buffer_load_dwordx4 v18, s[12:15], s61 offen offset:2048 lds
    ds_read_b64_tr_b16 a[84:85], v29 offset:49152
    v_mfma_f32_16x16x32_bf16 v[64:67], a[0:3], a[160:163], v[64:67]
    ds_read_b64_tr_b16 a[86:87], v29 offset:53248
    ds_read_b64_tr_b16 a[88:89], v30 offset:49152
    v_mfma_f32_16x16x32_bf16 v[68:71], a[0:3], a[164:167], v[68:71]
    ds_read_b64_tr_b16 a[90:91], v30 offset:53248
    v_mfma_f32_16x16x32_bf16 v[72:75], a[4:7], a[160:163], v[72:75]
    buffer_load_dwordx4 v19, s[12:15], s61 offen offset:3072 lds
    ds_read_b64_tr_b16 a[92:93], v31 offset:49152
    v_mfma_f32_16x16x32_bf16 v[76:79], a[4:7], a[164:167], v[76:79]
    ds_read_b64_tr_b16 a[94:95], v31 offset:53248
    ds_read_b64_tr_b16 a[96:97], v24 offset:57344
    v_mfma_f32_16x16x32_bf16 v[80:83], a[8:11], a[160:163], v[80:83]
    ds_read_b64_tr_b16 a[98:99], v24 offset:61440
    v_mfma_f32_16x16x32_bf16 v[84:87], a[8:11], a[164:167], v[84:87]
    ds_read_b64_tr_b16 a[100:101], v25 offset:57344
    v_mfma_f32_16x16x32_bf16 v[88:91], a[12:15], a[160:163], v[88:91]
    buffer_load_dwordx4 a[144:147], v12, s[8:11], s62 offen offset:0
    ds_read_b64_tr_b16 a[102:103], v25 offset:61440
    v_mfma_f32_16x16x32_bf16 v[92:95], a[12:15], a[164:167], v[92:95]
    s_add_u32 s61, s61, 0x20000
    ds_read_b64_tr_b16 a[104:105], v26 offset:57344
    ds_read_b64_tr_b16 a[106:107], v26 offset:61440
    v_mfma_f32_16x16x32_bf16 v[96:99], a[48:51], a[168:171], v[96:99]
    ds_read_b64_tr_b16 a[108:109], v27 offset:57344
    v_mfma_f32_16x16x32_bf16 v[100:103], a[48:51], a[172:175], v[100:103]
    buffer_load_dwordx4 a[148:151], v12, s[8:11], s62 offen offset:1024
    ds_read_b64_tr_b16 a[110:111], v27 offset:61440
    v_mfma_f32_16x16x32_bf16 v[104:107], a[52:55], a[168:171], v[104:107]
    ds_read_b64_tr_b16 a[112:113], v28 offset:57344
    v_mfma_f32_16x16x32_bf16 v[108:111], a[52:55], a[172:175], v[108:111]
    ds_read_b64_tr_b16 a[114:115], v28 offset:61440
    ds_read_b64_tr_b16 a[116:117], v29 offset:57344
    v_mfma_f32_16x16x32_bf16 v[112:115], a[56:59], a[168:171], v[112:115]
    ds_read_b64_tr_b16 a[118:119], v29 offset:61440
    v_mfma_f32_16x16x32_bf16 v[116:119], a[56:59], a[172:175], v[116:119]
    buffer_load_dwordx4 a[152:155], v13, s[8:11], s62 offen offset:0
    ds_read_b64_tr_b16 a[120:121], v30 offset:57344
    v_mfma_f32_16x16x32_bf16 v[120:123], a[60:63], a[168:171], v[120:123]
    ds_read_b64_tr_b16 a[122:123], v30 offset:61440
    ds_read_b64_tr_b16 a[124:125], v31 offset:57344
    v_mfma_f32_16x16x32_bf16 v[124:127], a[60:63], a[172:175], v[124:127]
    ds_read_b64_tr_b16 a[126:127], v31 offset:61440
    v_mfma_f32_16x16x32_bf16 v[64:67], a[32:35], a[168:171], v[64:67]
    buffer_load_dwordx4 a[156:159], v13, s[8:11], s62 offen offset:1024
    v_mfma_f32_16x16x32_bf16 v[68:71], a[32:35], a[172:175], v[68:71]
    v_mfma_f32_16x16x32_bf16 v[72:75], a[36:39], a[168:171], v[72:75]
    v_mfma_f32_16x16x32_bf16 v[76:79], a[36:39], a[172:175], v[76:79]
    v_mfma_f32_16x16x32_bf16 v[80:83], a[40:43], a[168:171], v[80:83]
    v_mfma_f32_16x16x32_bf16 v[84:87], a[40:43], a[172:175], v[84:87]
    s_add_u32 s62, s62, 0x40000
    v_mfma_f32_16x16x32_bf16 v[88:91], a[44:47], a[168:171], v[88:91]
    v_mfma_f32_16x16x32_bf16 v[92:95], a[44:47], a[172:175], v[92:95]
    s_waitcnt vmcnt(12) lgkmcnt(0)
    s_barrier
    v_mfma_f32_16x16x32_bf16 v[96:99], a[80:83], a[176:179], v[96:99]
    s_add_u32 m0, s60, 32768
    ds_read_b64_tr_b16 a[0:1], v24 offset:0
    ds_read_b64_tr_b16 a[2:3], v24 offset:4096
    v_mfma_f32_16x16x32_bf16 v[100:103], a[80:83], a[180:183], v[100:103]
    buffer_load_dwordx4 v16, s[12:15], s61 offen offset:0 lds
    ds_read_b64_tr_b16 a[4:5], v25 offset:0
    v_mfma_f32_16x16x32_bf16 v[104:107], a[84:87], a[176:179], v[104:107]
    ds_read_b64_tr_b16 a[6:7], v25 offset:4096
    ds_read_b64_tr_b16 a[8:9], v26 offset:0
    v_mfma_f32_16x16x32_bf16 v[108:111], a[84:87], a[180:183], v[108:111]
    buffer_load_dwordx4 v17, s[12:15], s61 offen offset:1024 lds
    ds_read_b64_tr_b16 a[10:11], v26 offset:4096
    v_mfma_f32_16x16x32_bf16 v[112:115], a[88:91], a[176:179], v[112:115]
    ds_read_b64_tr_b16 a[12:13], v27 offset:0
    ds_read_b64_tr_b16 a[14:15], v27 offset:4096
    v_mfma_f32_16x16x32_bf16 v[116:119], a[88:91], a[180:183], v[116:119]
    ds_read_b64_tr_b16 a[16:17], v28 offset:0
    v_mfma_f32_16x16x32_bf16 v[120:123], a[92:95], a[176:179], v[120:123]
    ds_read_b64_tr_b16 a[18:19], v28 offset:4096
    v_mfma_f32_16x16x32_bf16 v[124:127], a[92:95], a[180:183], v[124:127]
    buffer_load_dwordx4 v18, s[12:15], s61 offen offset:2048 lds
    ds_read_b64_tr_b16 a[20:21], v29 offset:0
    v_mfma_f32_16x16x32_bf16 v[64:67], a[64:67], a[176:179], v[64:67]
    ds_read_b64_tr_b16 a[22:23], v29 offset:4096
    ds_read_b64_tr_b16 a[24:25], v30 offset:0
    v_mfma_f32_16x16x32_bf16 v[68:71], a[64:67], a[180:183], v[68:71]
    ds_read_b64_tr_b16 a[26:27], v30 offset:4096
    v_mfma_f32_16x16x32_bf16 v[72:75], a[68:71], a[176:179], v[72:75]
    buffer_load_dwordx4 v19, s[12:15], s61 offen offset:3072 lds
    ds_read_b64_tr_b16 a[28:29], v31 offset:0
    v_mfma_f32_16x16x32_bf16 v[76:79], a[68:71], a[180:183], v[76:79]
    ds_read_b64_tr_b16 a[30:31], v31 offset:4096
    ds_read_b64_tr_b16 a[32:33], v24 offset:8192
    v_mfma_f32_16x16x32_bf16 v[80:83], a[72:75], a[176:179], v[80:83]
    ds_read_b64_tr_b16 a[34:35], v24 offset:12288
    v_mfma_f32_16x16x32_bf16 v[84:87], a[72:75], a[180:183], v[84:87]
    ds_read_b64_tr_b16 a[36:37], v25 offset:8192
    v_mfma_f32_16x16x32_bf16 v[88:91], a[76:79], a[176:179], v[88:91]
    buffer_load_dwordx4 a[160:163], v12, s[8:11], s62 offen offset:0
    ds_read_b64_tr_b16 a[38:39], v25 offset:12288
    v_mfma_f32_16x16x32_bf16 v[92:95], a[76:79], a[180:183], v[92:95]
    s_add_u32 s61, s61, 0x20000
    ds_read_b64_tr_b16 a[40:41], v26 offset:8192
    ds_read_b64_tr_b16 a[42:43], v26 offset:12288
    v_mfma_f32_16x16x32_bf16 v[96:99], a[112:115], a[184:187], v[96:99]
    ds_read_b64_tr_b16 a[44:45], v27 offset:8192
    v_mfma_f32_16x16x32_bf16 v[100:103], a[112:115], a[188:191], v[100:103]
    buffer_load_dwordx4 a[164:167], v12, s[8:11], s62 offen offset:1024
    ds_read_b64_tr_b16 a[46:47], v27 offset:12288
    v_mfma_f32_16x16x32_bf16 v[104:107], a[116:119], a[184:187], v[104:107]
    ds_read_b64_tr_b16 a[48:49], v28 offset:8192
    v_mfma_f32_16x16x32_bf16 v[108:111], a[116:119], a[188:191], v[108:111]
    ds_read_b64_tr_b16 a[50:51], v28 offset:12288
    ds_read_b64_tr_b16 a[52:53], v29 offset:8192
    v_mfma_f32_16x16x32_bf16 v[112:115], a[120:123], a[184:187], v[112:115]
    ds_read_b64_tr_b16 a[54:55], v29 offset:12288
    v_mfma_f32_16x16x32_bf16 v[116:119], a[120:123], a[188:191], v[116:119]
    buffer_load_dwordx4 a[168:171], v13, s[8:11], s62 offen offset:0
    ds_read_b64_tr_b16 a[56:57], v30 offset:8192
    v_mfma_f32_16x16x32_bf16 v[120:123], a[124:127], a[184:187], v[120:123]
    ds_read_b64_tr_b16 a[58:59], v30 offset:12288
    ds_read_b64_tr_b16 a[60:61], v31 offset:8192
    v_mfma_f32_16x16x32_bf16 v[124:127], a[124:127], a[188:191], v[124:127]
    ds_read_b64_tr_b16 a[62:63], v31 offset:12288
    v_mfma_f32_16x16x32_bf16 v[64:67], a[96:99], a[184:187], v[64:67]
    buffer_load_dwordx4 a[172:175], v13, s[8:11], s62 offen offset:1024
    v_mfma_f32_16x16x32_bf16 v[68:71], a[96:99], a[188:191], v[68:71]
    v_mfma_f32_16x16x32_bf16 v[72:75], a[100:103], a[184:187], v[72:75]
    v_mfma_f32_16x16x32_bf16 v[76:79], a[100:103], a[188:191], v[76:79]
    v_mfma_f32_16x16x32_bf16 v[80:83], a[104:107], a[184:187], v[80:83]
    v_mfma_f32_16x16x32_bf16 v[84:87], a[104:107], a[188:191], v[84:87]
    s_add_u32 s62, s62, 0x40000
    v_mfma_f32_16x16x32_bf16 v[88:91], a[108:111], a[184:187], v[88:91]
    s_add_u32 s63, s63, 1
    v_mfma_f32_16x16x32_bf16 v[92:95], a[108:111], a[188:191], v[92:95]
    s_waitcnt vmcnt(12) lgkmcnt(0)
    s_barrier
    s_cmp_lt_u32 s63, 8
    s_cbranch_scc1 k3_loop_86
k3_tail:
    s_nop 1
    v_cvt_pk_bf16_f32 v96, v96, v97
    v_cvt_pk_bf16_f32 v97, v98, v99
    v_cvt_pk_bf16_f32 v98, v100, v101
    v_cvt_pk_bf16_f32 v99, v102, v103
    buffer_store_dwordx4 v[96:99], v1, s[36:39], s52 offen offset:0 sc1
    v_cvt_pk_bf16_f32 v104, v104, v105
    v_cvt_pk_bf16_f32 v105, v106, v107
    v_cvt_pk_bf16_f32 v106, v108, v109
    v_cvt_pk_bf16_f32 v107, v110, v111
    buffer_store_dwordx4 v[104:107], v1, s[36:39], s52 offen offset:1024 sc1
    v_cvt_pk_bf16_f32 v112, v112, v113
    v_cvt_pk_bf16_f32 v113, v114, v115
    v_cvt_pk_bf16_f32 v114, v116, v117
    v_cvt_pk_bf16_f32 v115, v118, v119
    buffer_store_dwordx4 v[112:115], v1, s[36:39], s52 offen offset:2048 sc1
    v_cvt_pk_bf16_f32 v120, v120, v121
    v_cvt_pk_bf16_f32 v121, v122, v123
    v_cvt_pk_bf16_f32 v122, v124, v125
    v_cvt_pk_bf16_f32 v123, v126, v127
    buffer_store_dwordx4 v[120:123], v1, s[36:39], s52 offen offset:3072 sc1
    s_waitcnt vmcnt(4)
    v_lshlrev_b32 v58, 16, v128
    v_and_b32 v59, 0xffff0000, v128
    v_pk_add_f32 v[64:65], v[64:65], v[58:59]
    v_lshlrev_b32 v58, 16, v129
    v_and_b32 v59, 0xffff0000, v129
    v_pk_add_f32 v[66:67], v[66:67], v[58:59]
    v_lshlrev_b32 v58, 16, v136
    v_and_b32 v59, 0xffff0000, v136
    v_pk_add_f32 v[68:69], v[68:69], v[58:59]
    v_lshlrev_b32 v58, 16, v137
    v_and_b32 v59, 0xffff0000, v137
    v_pk_add_f32 v[70:71], v[70:71], v[58:59]
    v_lshlrev_b32 v58, 16, v130
    v_and_b32 v59, 0xffff0000, v130
    v_pk_add_f32 v[72:73], v[72:73], v[58:59]
    v_lshlrev_b32 v58, 16, v131
    v_and_b32 v59, 0xffff0000, v131
    v_pk_add_f32 v[74:75], v[74:75], v[58:59]
    v_lshlrev_b32 v58, 16, v138
    v_and_b32 v59, 0xffff0000, v138
    v_pk_add_f32 v[76:77], v[76:77], v[58:59]
    v_lshlrev_b32 v58, 16, v139
    v_and_b32 v59, 0xffff0000, v139
    v_pk_add_f32 v[78:79], v[78:79], v[58:59]
    v_lshlrev_b32 v58, 16, v132
    v_and_b32 v59, 0xffff0000, v132
    v_pk_add_f32 v[80:81], v[80:81], v[58:59]
    v_lshlrev_b32 v58, 16, v133
    v_and_b32 v59, 0xffff0000, v133
    v_pk_add_f32 v[82:83], v[82:83], v[58:59]
    v_lshlrev_b32 v58, 16, v140
    v_and_b32 v59, 0xffff0000, v140
    v_pk_add_f32 v[84:85], v[84:85], v[58:59]
    v_lshlrev_b32 v58, 16, v141
    v_and_b32 v59, 0xffff0000, v141
    v_pk_add_f32 v[86:87], v[86:87], v[58:59]
    v_lshlrev_b32 v58, 16, v134
    v_and_b32 v59, 0xffff0000, v134
    v_pk_add_f32 v[88:89], v[88:89], v[58:59]
    v_lshlrev_b32 v58, 16, v135
    v_and_b32 v59, 0xffff0000, v135
    v_pk_add_f32 v[90:91], v[90:91], v[58:59]
    v_lshlrev_b32 v58, 16, v142
    v_and_b32 v59, 0xffff0000, v142
    v_pk_add_f32 v[92:93], v[92:93], v[58:59]
    v_lshlrev_b32 v58, 16, v143
    v_and_b32 v59, 0xffff0000, v143
    v_pk_add_f32 v[94:95], v[94:95], v[58:59]
    v_and_b32 v58, 1, v20
    v_lshrrev_b32 v59, 1, v20
    v_lshlrev_b32 v58, 5, v58
    v_lshl_add_u32 v58, v59, 4, v58
    v_lshlrev_b32 v59, 3, v20
    v_sub_u32 v58, v58, v59
    v_add_u32 v3, v3, v58
    v_add_u32 v4, v4, v58
    v_lshlrev_b32 v32, 16, v144
    v_and_b32 v33, 0xffff0000, v144
    v_lshlrev_b32 v34, 16, v145
    v_and_b32 v35, 0xffff0000, v145
    v_lshlrev_b32 v36, 16, v146
    v_and_b32 v37, 0xffff0000, v146
    v_lshlrev_b32 v38, 16, v147
    v_and_b32 v39, 0xffff0000, v147
    v_lshlrev_b32 v40, 16, v148
    v_and_b32 v41, 0xffff0000, v148
    v_lshlrev_b32 v42, 16, v149
    v_and_b32 v43, 0xffff0000, v149
    v_lshlrev_b32 v44, 16, v150
    v_and_b32 v45, 0xffff0000, v150
    v_lshlrev_b32 v46, 16, v151
    v_and_b32 v47, 0xffff0000, v151
    s_or_b32 s57, s42, s45
    s_cbranch_scc1 k3_nowr_89
    v_pk_add_f32 v[56:57], v[32:33], v[34:35]
    v_pk_add_f32 v[56:57], v[56:57], v[36:37]
    v_pk_add_f32 v[56:57], v[56:57], v[38:39]
    v_pk_add_f32 v[56:57], v[56:57], v[40:41]
    v_pk_add_f32 v[56:57], v[56:57], v[42:43]
    v_pk_add_f32 v[56:57], v[56:57], v[44:45]
    v_pk_add_f32 v[56:57], v[56:57], v[46:47]
    v_add_f32 v56, v56, v57
    v_mov_b32 v57, v56
    s_nop 1
    v_permlane16_swap_b32 v56, v57
    s_nop 1
    v_add_f32 v56, v56, v57
    v_mov_b32 v57, v56
    s_nop 1
    v_permlane32_swap_b32 v56, v57
    s_nop 1
    v_add_f32 v56, v56, v57
    s_mov_b32 s57, 24704
    s_mov_b32 s34, 24708
    s_mov_b64 exec, 1
    buffer_atomic_add_f32 v56, v5, s[32:35], s57 offen
    s_mov_b64 exec, -1
    s_mov_b32 s34, 24576
k3_nowr_89:
    v_mov_b32 v144, 0
    v_mov_b32 v145, 0
    v_mov_b32 v146, 0
    v_mov_b32 v147, 0
    v_mov_b32 v148, 0
    v_mov_b32 v149, 0
    v_mov_b32 v150, 0
    v_mov_b32 v151, 0
    v_mov_b32 v152, 0
    v_mov_b32 v153, 0
    v_mov_b32 v154, 0
    v_mov_b32 v155, 0
    s_waitcnt vmcnt(0)
    s_barrier
    s_cmp_lg_u32 s45, 0
    s_cbranch_scc1 k3_nopoll_90
    s_mov_b64 exec, 1
    buffer_store_dword v6, v5, s[48:51], s54 offen sc1
    s_mov_b64 exec, -1
    s_mov_b32 s57, 1048576
k3_spin_91:
    buffer_load_dword v7, v5, s[48:51], s55 offen sc1
    s_waitcnt vmcnt(0)
    v_readfirstlane_b32 s58, v7
    s_sub_u32 s57, s57, 1
    s_cselect_b32 s58, 1, s58
    s_cmp_eq_u32 s58, 0
    s_cbranch_scc1 k3_spin_91
k3_nopoll_90:
    s_barrier
    buffer_load_dwordx4 v[96:99], v1, s[36:39], s53 offen offset:0 sc1
    buffer_load_dwordx4 v[100:103], v1, s[36:39], s53 offen offset:1024 sc1
    buffer_load_dwordx4 v[104:107], v1, s[36:39], s53 offen offset:2048 sc1
    buffer_load_dwordx4 v[108:111], v1, s[36:39], s53 offen offset:3072 sc1
    s_waitcnt vmcnt(3)
    v_lshlrev_b32 v56, 16, v96
    v_and_b32 v57, 0xffff0000, v96
    v_lshlrev_b32 v58, 16, v97
    v_and_b32 v59, 0xffff0000, v97
    v_pk_add_f32 v[64:65], v[64:65], v[56:57]
    v_pk_add_f32 v[66:67], v[66:67], v[58:59]
    v_cvt_pk_bf16_f32 v128, v64, v65
    v_cvt_pk_bf16_f32 v129, v66, v67
    v_lshlrev_b32 v64, 16, v128
    v_and_b32 v65, 0xffff0000, v128
    v_lshlrev_b32 v66, 16, v129
    v_and_b32 v67, 0xffff0000, v129
    v_pk_add_f32 v[144:145], v[144:145], v[64:65]
    v_pk_fma_f32 v[146:147], v[64:65], v[64:65], v[146:147]
    v_pk_fma_f32 v[148:149], v[64:65], v[32:33], v[148:149]
    v_pk_add_f32 v[144:145], v[144:145], v[66:67]
    v_pk_fma_f32 v[146:147], v[66:67], v[66:67], v[146:147]
    v_pk_fma_f32 v[148:149], v[66:67], v[34:35], v[148:149]
    v_lshlrev_b32 v56, 16, v98
    v_and_b32 v57, 0xffff0000, v98
    v_lshlrev_b32 v58, 16, v99
    v_and_b32 v59, 0xffff0000, v99
    v_pk_add_f32 v[68:69], v[68:69], v[56:57]
    v_pk_add_f32 v[70:71], v[70:71], v[58:59]
    v_cvt_pk_bf16_f32 v136, v68, v69
    v_cvt_pk_bf16_f32 v137, v70, v71
    v_lshlrev_b32 v68, 16, v136
    v_and_b32 v69, 0xffff0000, v136
    v_lshlrev_b32 v70, 16, v137
    v_and_b32 v71, 0xffff0000, v137
    v_pk_add_f32 v[150:151], v[150:151], v[68:69]
    v_pk_fma_f32 v[152:153], v[68:69], v[68:69], v[152:153]
    v_pk_fma_f32 v[154:155], v[68:69], v[32:33], v[154:155]
    v_pk_add_f32 v[150:151], v[150:151], v[70:71]
    v_pk_fma_f32 v[152:153], v[70:71], v[70:71], v[152:153]
    v_pk_fma_f32 v[154:155], v[70:71], v[34:35], v[154:155]
    s_waitcnt vmcnt(2)
    v_lshlrev_b32 v56, 16, v100
    v_and_b32 v57, 0xffff0000, v100
    v_lshlrev_b32 v58, 16, v101
    v_and_b32 v59, 0xffff0000, v101
    v_pk_add_f32 v[72:73], v[72:73], v[56:57]
    v_pk_add_f32 v[74:75], v[74:75], v[58:59]
    v_cvt_pk_bf16_f32 v130, v72, v73
    v_cvt_pk_bf16_f32 v131, v74, v75
    v_lshlrev_b32 v72, 16, v130
    v_and_b32 v73, 0xffff0000, v130
    v_lshlrev_b32 v74, 16, v131
    v_and_b32 v75, 0xffff0000, v131
    v_permlane16_swap_b32 v128, v130
    v_permlane16_swap_b32 v129, v131
    buffer_store_dwordx4 v[128:131], v3, s[24:27], 0 offen offset:0 sc1
    v_pk_add_f32 v[144:145], v[144:145], v[72:73]
    v_pk_fma_f32 v[146:147], v[72:73], v[72:73], v[146:147]
    v_pk_fma_f32 v[148:149], v[72:73], v[36:37], v[148:149]
    v_pk_add_f32 v[144:145], v[144:145], v[74:75]
    v_pk_fma_f32 v[146:147], v[74:75], v[74:75], v[146:147]
    v_pk_fma_f32 v[148:149], v[74:75], v[38:39], v[148:149]
    v_lshlrev_b32 v56, 16, v102
    v_and_b32 v57, 0xffff0000, v102
    v_lshlrev_b32 v58, 16, v103
    v_and_b32 v59, 0xffff0000, v103
    v_pk_add_f32 v[76:77], v[76:77], v[56:57]
    v_pk_add_f32 v[78:79], v[78:79], v[58:59]
    v_cvt_pk_bf16_f32 v138, v76, v77
    v_cvt_pk_bf16_f32 v139, v78, v79
    v_lshlrev_b32 v76, 16, v138
    v_and_b32 v77, 0xffff0000, v138
    v_lshlrev_b32 v78, 16, v139
    v_and_b32 v79, 0xffff0000, v139
    v_permlane16_swap_b32 v136, v138
    v_permlane16_swap_b32 v137, v139
    buffer_store_dwordx4 v[136:139], v4, s[24:27], 0 offen offset:0 sc1
    v_pk_add_f32 v[150:151], v[150:151], v[76:77]
    v_pk_fma_f32 v[152:153], v[76:77], v[76:77], v[152:153]
    v_pk_fma_f32 v[154:155], v[76:77], v[36:37], v[154:155]
    v_pk_add_f32 v[150:151], v[150:151], v[78:79]
    v_pk_fma_f32 v[152:153], v[78:79], v[78:79], v[152:153]
    v_pk_fma_f32 v[154:155], v[78:79], v[38:39], v[154:155]
    s_waitcnt vmcnt(3)
    v_lshlrev_b32 v56, 16, v104
    v_and_b32 v57, 0xffff0000, v104
    v_lshlrev_b32 v58, 16, v105
    v_and_b32 v59, 0xffff0000, v105
    v_pk_add_f32 v[80:81], v[80:81], v[56:57]
    v_pk_add_f32 v[82:83], v[82:83], v[58:59]
    v_cvt_pk_bf16_f32 v132, v80, v81
    v_cvt_pk_bf16_f32 v133, v82, v83
    v_lshlrev_b32 v80, 16, v132
    v_and_b32 v81, 0xffff0000, v132
    v_lshlrev_b32 v82, 16, v133
    v_and_b32 v83, 0xffff0000, v133
    v_pk_add_f32 v[144:145], v[144:145], v[80:81]
    v_pk_fma_f32 v[146:147], v[80:81], v[80:81], v[146:147]
    v_pk_fma_f32 v[148:149], v[80:81], v[40:41], v[148:149]
    v_pk_add_f32 v[144:145], v[144:145], v[82:83]
    v_pk_fma_f32 v[146:147], v[82:83], v[82:83], v[146:147]
    v_pk_fma_f32 v[148:149], v[82:83], v[42:43], v[148:149]
    v_lshlrev_b32 v56, 16, v106
    v_and_b32 v57, 0xffff0000, v106
    v_lshlrev_b32 v58, 16, v107
    v_and_b32 v59, 0xffff0000, v107
    v_pk_add_f32 v[84:85], v[84:85], v[56:57]
    v_pk_add_f32 v[86:87], v[86:87], v[58:59]
    v_cvt_pk_bf16_f32 v140, v84, v85
    v_cvt_pk_bf16_f32 v141, v86, v87
    v_lshlrev_b32 v84, 16, v140
    v_and_b32 v85, 0xffff0000, v140
    v_lshlrev_b32 v86, 16, v141
    v_and_b32 v87, 0xffff0000, v141
    v_pk_add_f32 v[150:151], v[150:151], v[84:85]
    v_pk_fma_f32 v[152:153], v[84:85], v[84:85], v[152:153]
    v_pk_fma_f32 v[154:155], v[84:85], v[40:41], v[154:155]
    v_pk_add_f32 v[150:151], v[150:151], v[86:87]
    v_pk_fma_f32 v[152:153], v[86:87], v[86:87], v[152:153]
    v_pk_fma_f32 v[154:155], v[86:87], v[42:43], v[154:155]
    s_waitcnt vmcnt(2)
    v_lshlrev_b32 v56, 16, v108
    v_and_b32 v57, 0xffff0000, v108
    v_lshlrev_b32 v58, 16, v109
    v_and_b32 v59, 0xffff0000, v109
    v_pk_add_f32 v[88:89], v[88:89], v[56:57]
    v_pk_add_f32 v[90:91], v[90:91], v[58:59]
    v_cvt_pk_bf16_f32 v134, v88, v89
    v_cvt_pk_bf16_f32 v135, v90, v91
    v_lshlrev_b32 v88, 16, v134
    v_and_b32 v89, 0xffff0000, v134
    v_lshlrev_b32 v90, 16, v135
    v_and_b32 v91, 0xffff0000, v135
    v_permlane16_swap_b32 v132, v134
    v_permlane16_swap_b32 v133, v135
    buffer_store_dwordx4 v[132:135], v3, s[24:27], 0 offen offset:64 sc1
    v_pk_add_f32 v[144:145], v[144:145], v[88:89]
    v_pk_fma_f32 v[146:147], v[88:89], v[88:89], v[146:147]
    v_pk_fma_f32 v[148:149], v[88:89], v[44:45], v[148:149]
    v_pk_add_f32 v[144:145], v[144:145], v[90:91]
    v_pk_fma_f32 v[146:147], v[90:91], v[90:91], v[146:147]
    v_pk_fma_f32 v[148:149], v[90:91], v[46:47], v[148:149]
    v_lshlrev_b32 v56, 16, v110
    v_and_b32 v57, 0xffff0000, v110
    v_lshlrev_b32 v58, 16, v111
    v_and_b32 v59, 0xffff0000, v111
    v_pk_add_f32 v[92:93], v[92:93], v[56:57]
    v_pk_add_f32 v[94:95], v[94:95], v[58:59]
    v_cvt_pk_bf16_f32 v142, v92, v93
    v_cvt_pk_bf16_f32 v143, v94, v95
    v_lshlrev_b32 v92, 16, v142
    v_and_b32 v93, 0xffff0000, v142
    v_lshlrev_b32 v94, 16, v143
    v_and_b32 v95, 0xffff0000, v143
    v_permlane16_swap_b32 v140, v142
    v_permlane16_swap_b32 v141, v143
    buffer_store_dwordx4 v[140:143], v4, s[24:27], 0 offen offset:64 sc1
    v_pk_add_f32 v[150:151], v[150:151], v[92:93]
    v_pk_fma_f32 v[152:153], v[92:93], v[92:93], v[152:153]
    v_pk_fma_f32 v[154:155], v[92:93], v[44:45], v[154:155]
    v_pk_add_f32 v[150:151], v[150:151], v[94:95]
    v_pk_fma_f32 v[152:153], v[94:95], v[94:95], v[152:153]
    v_pk_fma_f32 v[154:155], v[94:95], v[46:47], v[154:155]
    v_add_f32 v48, v144, v145
    v_add_f32 v49, v146, v147
    v_add_f32 v50, v148, v149
    v_add_f32 v52, v150, v151
    v_add_f32 v53, v152, v153
    v_add_f32 v54, v154, v155
    v_mov_b32 v56, v48
    v_mov_b32 v57, v49
    v_mov_b32 v58, v50
    v_mov_b32 v59, v52
    v_mov_b32 v60, v53
    v_mov_b32 v61, v54
    s_nop 1
    v_permlane16_swap_b32 v48, v56
    v_permlane16_swap_b32 v49, v57
    v_permlane16_swap_b32 v50, v58
    v_permlane16_swap_b32 v52, v59
    v_permlane16_swap_b32 v53, v60
    v_permlane16_swap_b32 v54, v61
    s_nop 1
    v_add_f32 v48, v48, v56
    v_add_f32 v49, v49, v57
    v_add_f32 v50, v50, v58
    v_add_f32 v52, v52, v59
    v_add_f32 v53, v53, v60
    v_add_f32 v54, v54, v61
    v_mov_b32 v56, v48
    v_mov_b32 v57, v49
    v_mov_b32 v58, v50
    v_mov_b32 v59, v52
    v_mov_b32 v60, v53
    v_mov_b32 v61, v54
    s_nop 1
    v_permlane32_swap_b32 v48, v56
    v_permlane32_swap_b32 v49, v57
    v_permlane32_swap_b32 v50, v58
    v_permlane32_swap_b32 v52, v59
    v_permlane32_swap_b32 v53, v60
    v_permlane32_swap_b32 v54, v61
    s_nop 1
    v_add_f32 v48, v48, v56
    v_add_f32 v49, v49, v57
    v_add_f32 v50, v50, v58
    v_add_f32 v52, v52, v59
    v_add_f32 v53, v53, v60
    v_add_f32 v54, v54, v61
    v_cmp_eq_u32 s[56:57], 1, v20
    v_cmp_eq_u32 s[58:59], 2, v20
    s_nop 1
    v_cndmask_b32 v48, v48, v49, s[56:57]
    v_cndmask_b32 v48, v48, v50, s[58:59]
    buffer_atomic_add_f32 v48, v2, s[32:35], 0 offen offset:0
    v_cndmask_b32 v52, v52, v53, s[56:57]
    v_cndmask_b32 v52, v52, v54, s[58:59]
    buffer_atomic_add_f32 v52, v2, s[32:35], 0 offen offset:64
k3_end_84:
    s_endpgm
k3_ool_87:
    buffer_load_dwordx2 v[128:129], v3, s[16:19], 0 offen offset:0
    buffer_load_dwordx2 v[130:131], v3, s[16:19], 0 offen offset:32
    buffer_load_dwordx2 v[132:133], v3, s[16:19], 0 offen offset:64
    buffer_load_dwordx2 v[134:135], v3, s[16:19], 0 offen offset:96
    buffer_load_dwordx2 v[136:137], v4, s[16:19], 0 offen offset:0
    buffer_load_dwordx2 v[138:139], v4, s[16:19], 0 offen offset:32
    buffer_load_dwordx2 v[140:141], v4, s[16:19], 0 offen offset:64
    buffer_load_dwordx2 v[142:143], v4, s[16:19], 0 offen offset:96
    buffer_load_dwordx2 v[144:145], v14, s[20:23], 0 offen offset:0
    buffer_load_dwordx2 v[146:147], v14, s[20:23], 0 offen offset:32
    buffer_load_dwordx2 v[148:149], v14, s[20:23], 0 offen offset:64
    buffer_load_dwordx2 v[150:151], v14, s[20:23], 0 offen offset:96
    global_load_dword v7, v[8:9], off
    s_branch k3_oolret_88
.globl k4_kernel
.p2align 8
.type k4_kernel,@function
k4_kernel:
    s_cmp_ge_u32 s2, 256
    s_cbranch_scc1 k4_end_92
    s_load_dwordx8 s[4:11], s[0:1], 56
    s_load_dwordx2 s[12:13], s[0:1], 88
    s_load_dwordx2 s[14:15], s[0:1], 104
    v_lshrrev_b32 v1, 6, v0
    v_and_b32 v2, 63, v0
    v_readfirstlane_b32 s44, v1
    s_and_b32 s45, s2, 7
    s_lshr_b32 s46, s2, 3
    s_mul_i32 s45, s45, 28
    s_add_u32 s45, s45, s46
    v_and_b32 v4, 31, v2
    v_lshrrev_b32 v5, 5, v2
    v_lshlrev_b32 v7, 4, v4
    v_mov_b32 v11, 69632
    v_lshl_add_u32 v12, v2, 2, v11
    v_mov_b32 v13, 0
    ds_write_b32 v12, v13
    s_waitcnt lgkmcnt(0)
    s_barrier
    s_add_u32 s20, s14, 0x4000000
    s_addc_u32 s21, s15, 0
    s_and_b32 s21, s21, 0xffff
    s_mov_b32 s22, 0x400000
    s_mov_b32 s23, 0x00020000
    s_cmp_ge_u32 s44, 4
    s_cbranch_scc1 k4_b_93
    s_setprio 3
    s_add_u32 s16, s14, 0x4800000
    s_addc_u32 s17, s15, 0
    s_and_b32 s17, s17, 0xffff
    s_mov_b32 s18, 0x6084
    s_mov_b32 s19, 0x00020000
    v_lshlrev_b32 v3, 5, v0
    s_mov_b32 s48, 0
    buffer_load_dwordx4 v[16:19], v3, s[16:19], s48 offen
    buffer_load_dwordx4 v[20:23], v3, s[16:19], s48 offen offset:16
    s_mov_b32 s48, 8192
    buffer_load_dwordx4 v[24:27], v3, s[16:19], s48 offen
    buffer_load_dwordx4 v[28:31], v3, s[16:19], s48 offen offset:16
    s_mov_b32 s48, 16384
    buffer_load_dwordx4 v[32:35], v3, s[16:19], s48 offen
    buffer_load_dwordx4 v[36:39], v3, s[16:19], s48 offen offset:16
    s_mov_b32 s48, 24704
    buffer_load_dword v10, v13, s[16:19], s48 offen
    s_mov_b32 s32, s10
    s_and_b32 s33, s11, 0xffff
    s_mov_b32 s34, 0x700000
    s_mov_b32 s35, 0x00020000
    s_cmp_ge_u32 s2, 224
    s_cselect_b32 s34, 0, s34
    s_mov_b32 s52, 0x3a800000
    s_mov_b32 s53, 0x3a800000
    s_mov_b32 s54, 0x7ff
    v_mov_b32 v14, 0x3727c5ac
    v_mov_b32 v15, v14
    v_mov_b32 v8, 0xff800000
    v_mov_b32 v9, v8
    s_waitcnt vmcnt(0)
    v_sub_f32 v10, 0, v10
    v_mov_b32 v11, v10
    v_pk_mul_f32 v[16:17], v[16:17], s[52:53]
    v_pk_fma_f32 v[24:25], v[24:25], s[52:53], v[14:15]
    v_pk_fma_f32 v[32:33], v[16:17], v[10:11], v[32:33]
    v_pk_fma_f32 v[24:25], v[16:17], v[16:17], v[24:25] neg_lo:[1,0,0] neg_hi:[1,0,0]
    v_pk_mul_f32 v[18:19], v[18:19], s[52:53]
    v_pk_fma_f32 v[26:27], v[26:27], s[52:53], v[14:15]
    v_pk_fma_f32 v[34:35], v[18:19], v[10:11], v[34:35]
    v_pk_fma_f32 v[26:27], v[18:19], v[18:19], v[26:27] neg_lo:[1,0,0] neg_hi:[1,0,0]
    v_pk_mul_f32 v[20:21], v[20:21], s[52:53]
    v_pk_fma_f32 v[28:29], v[28:29], s[52:53], v[14:15]
    v_pk_fma_f32 v[36:37], v[20:21], v[10:11], v[36:37]
    v_pk_fma_f32 v[28:29], v[20:21], v[20:21], v[28:29] neg_lo:[1,0,0] neg_hi:[1,0,0]
    v_pk_mul_f32 v[22:23], v[22:23], s[52:53]
    v_pk_fma_f32 v[30:31], v[30:31], s[52:53], v[14:15]
    v_pk_fma_f32 v[38:39], v[22:23], v[10:11], v[38:39]
    v_pk_fma_f32 v[30:31], v[22:23], v[22:23], v[30:31] neg_lo:[1,0,0] neg_hi:[1,0,0]
    v_max_f32 v24, v14, v24
    v_max_f32 v25, v14, v25
    v_max_f32 v26, v14, v26
    v_max_f32 v27, v14, v27
    v_max_f32 v28, v14, v28
    v_max_f32 v29, v14, v29
    v_max_f32 v30, v14, v30
    v_max_f32 v31, v14, v31
    v_rsq_f32 v24, v24
    v_rsq_f32 v25, v25
    v_rsq_f32 v26, v26
    v_rsq_f32 v27, v27
    v_rsq_f32 v28, v28
    v_rsq_f32 v29, v29
    v_rsq_f32 v30, v30
    v_rsq_f32 v31, v31
    v_pk_mul_f32 v[32:33], v[32:33], v[24:25]
    v_pk_mul_f32 v[34:35], v[34:35], v[26:27]
    v_pk_mul_f32 v[36:37], v[36:37], v[28:29]
    v_pk_mul_f32 v[38:39], v[38:39], v[30:31]
    v_bfi_b32 v32, s54, 0, v32
    v_med3_f32 v9, v8, v9, v32
    v_max_f32 v8, v8, v32
    v_bfi_b32 v33, s54, 1, v33
    v_med3_f32 v9, v8, v9, v33
    v_max_f32 v8, v8, v33
    v_bfi_b32 v34, s54, 2, v34
    v_med3_f32 v9, v8, v9, v34
    v_max_f32 v8, v8, v34
    v_bfi_b32 v35, s54, 3, v35
    v_med3_f32 v9, v8, v9, v35
    v_max_f32 v8, v8, v35
    v_bfi_b32 v36, s54, 4, v36
    v_med3_f32 v9, v8, v9, v36
    v_max_f32 v8, v8, v36
    v_bfi_b32 v37, s54, 5, v37
    v_med3_f32 v9, v8, v9, v37
    v_max_f32 v8, v8, v37
    v_bfi_b32 v38, s54, 6, v38
    v_med3_f32 v9, v8, v9, v38
    v_max_f32 v8, v8, v38
    v_bfi_b32 v39, s54, 7, v39
    v_med3_f32 v9, v8, v9, v39
    v_max_f32 v8, v8, v39
    v_lshl_or_b32 v8, v0, 3, v8
    v_lshl_or_b32 v9, v0, 3, v9
    s_nop 1
    v_mov_b32_dpp v10, v8 quad_perm:[1,0,3,2] row_mask:0xf bank_mask:0xf
    v_mov_b32_dpp v11, v9 quad_perm:[1,0,3,2] row_mask:0xf bank_mask:0xf
    v_max_f32 v11, v11, v9
    v_med3_f32 v9, v8, v10, v11
    v_max_f32 v8, v8, v10
    s_nop 1
    v_mov_b32_dpp v10, v8 quad_perm:[2,3,0,1] row_mask:0xf bank_mask:0xf
    v_mov_b32_dpp v11, v9 quad_perm:[2,3,0,1] row_mask:0xf bank_mask:0xf
    v_max_f32 v11, v11, v9
    v_med3_f32 v9, v8, v10, v11
    v_max_f32 v8, v8, v10
    s_nop 1
    v_mov_b32_dpp v10, v8 row_half_mirror row_mask:0xf bank_mask:0xf
    v_mov_b32_dpp v11, v9 row_half_mirror row_mask:0xf bank_mask:0xf
    v_max_f32 v11, v11, v9
    v_med3_f32 v9, v8, v10, v11
    v_max_f32 v8, v8, v10
    s_nop 1
    v_mov_b32_dpp v10, v8 row_mirror row_mask:0xf bank_mask:0xf
    v_mov_b32_dpp v11, v9 row_mirror row_mask:0xf bank_mask:0xf
    v_max_f32 v11, v11, v9
    v_med3_f32 v9, v8, v10, v11
    v_max_f32 v8, v8, v10
    v_mov_b32 v10, v8
    v_mov_b32 v11, v9
    s_nop 1
    v_permlane16_swap_b32 v8, v10
    v_permlane16_swap_b32 v9, v11
    s_nop 1
    v_max_f32 v11, v11, v9
    v_med3_f32 v9, v8, v10, v11
    v_max_f32 v8, v8, v10
    v_mov_b32 v10, v8
    v_mov_b32 v11, v9
    s_nop 1
    v_permlane32_swap_b32 v8, v10
    v_permlane32_swap_b32 v9, v11
    s_nop 1
    v_max_f32 v11, v11, v9
    v_med3_f32 v9, v8, v10, v11
    v_max_f32 v8, v8, v10
    v_mov_b32 v10, 1
    v_mov_b32 v11, 1
    v_lshlrev_b32 v12, 4, v1
    v_add_u32 v12, 69632, v12
    ds_write_b128 v12, v[8:11]
    v_mov_b32 v12, 69632
k4_mail_97:
    ds_read_b128 v[16:19], v12 offset:0
    ds_read_b128 v[20:23], v12 offset:16
    ds_read_b128 v[24:27], v12 offset:32
    ds_read_b128 v[28:31], v12 offset:48
    s_waitcnt lgkmcnt(0)
    v_and_b32 v10, v18, v22
    v_and_b32 v11, v26, v30
    v_and_b32 v10, v10, v11
    v_cmp_eq_u32 vcc, 0, v10
    s_cbranch_vccnz k4_mail_97
    v_max_f32 v21, v21, v17
    v_med3_f32 v17, v16, v20, v21
    v_max_f32 v16, v16, v20
    v_max_f32 v29, v29, v25
    v_med3_f32 v25, v24, v28, v29
    v_max_f32 v24, v24, v28
    v_max_f32 v25, v25, v17
    v_med3_f32 v17, v16, v24, v25
    v_max_f32 v16, v16, v24
    v_cmp_eq_u32 vcc, 0, v5
    s_lshl_b32 s52, s45, 15
    v_lshlrev_b32 v9, 3, v0
    v_cndmask_b32 v11, v17, v16, vcc
    v_and_b32 v15, 0x7ff, v11
    v_lshl_add_u32 v11, v15, 11, v7
    buffer_load_dwordx4 v[40:43], v11, s[20:23], 0 offen offset:0
    buffer_load_dwordx4 v[44:47], v11, s[20:23], 0 offen offset:512
    buffer_load_dwordx4 v[48:51], v11, s[20:23], 0 offen offset:1024
    buffer_load_dwordx4 v[52:55], v11, s[20:23], 0 offen offset:1536
    buffer_load_dwordx2 v[88:89], v9, s[32:35], s52 offen offset:0
    buffer_load_dwordx2 v[90:91], v9, s[32:35], s52 offen offset:2048
    s_add_u32 s52, s52, 4096
    buffer_load_dwordx2 v[92:93], v9, s[32:35], s52 offen offset:0
    buffer_load_dwordx2 v[94:95], v9, s[32:35], s52 offen offset:2048
    s_add_u32 s52, s52, 4096
    buffer_load_dwordx2 v[96:97], v9, s[32:35], s52 offen offset:0
    buffer_load_dwordx2 v[98:99], v9, s[32:35], s52 offen offset:2048
    s_add_u32 s52, s52, 4096
    buffer_load_dwordx2 v[100:101], v9, s[32:35], s52 offen offset:0
    buffer_load_dwordx2 v[102:103], v9, s[32:35], s52 offen offset:2048
    s_add_u32 s52, s52, 4096
    buffer_load_dwordx2 v[104:105], v9, s[32:35], s52 offen offset:0
    buffer_load_dwordx2 v[106:107], v9, s[32:35], s52 offen offset:2048
    s_add_u32 s52, s52, 4096
    buffer_load_dwordx2 v[108:109], v9, s[32:35], s52 offen offset:0
    buffer_load_dwordx2 v[110:111], v9, s[32:35], s52 offen offset:2048
    s_add_u32 s52, s52, 4096
    buffer_load_dwordx2 v[112:113], v9, s[32:35], s52 offen offset:0
    buffer_load_dwordx2 v[114:115], v9, s[32:35], s52 offen offset:2048
    s_add_u32 s52, s52, 4096
    buffer_load_dwordx2 v[116:117], v9, s[32:35], s52 offen offset:0
    buffer_load_dwordx2 v[118:119], v9, s[32:35], s52 offen offset:2048
    s_add_u32 s52, s52, 4096
    s_waitcnt vmcnt(16)
k4_ln_94:
    v_lshlrev_b32 v200, 16, v40
    v_and_b32 v201, 0xffff0000, v40
    v_lshlrev_b32 v202, 16, v41
    v_and_b32 v203, 0xffff0000, v41
    v_lshlrev_b32 v204, 16, v42
    v_and_b32 v205, 0xffff0000, v42
    v_lshlrev_b32 v206, 16, v43
    v_and_b32 v207, 0xffff0000, v43
    v_lshlrev_b32 v208, 16, v44
    v_and_b32 v209, 0xffff0000, v44
    v_lshlrev_b32 v210, 16, v45
    v_and_b32 v211, 0xffff0000, v45
    v_lshlrev_b32 v212, 16, v46
    v_and_b32 v213, 0xffff0000, v46
    v_lshlrev_b32 v214, 16, v47
    v_and_b32 v215, 0xffff0000, v47
    v_lshlrev_b32 v216, 16, v48
    v_and_b32 v217, 0xffff0000, v48
    v_lshlrev_b32 v218, 16, v49
    v_and_b32 v219, 0xffff0000, v49
    v_lshlrev_b32 v220, 16, v50
    v_and_b32 v221, 0xffff0000, v50
    v_lshlrev_b32 v222, 16, v51
    v_and_b32 v223, 0xffff0000, v51
    v_lshlrev_b32 v224, 16, v52
    v_and_b32 v225, 0xffff0000, v52
    v_lshlrev_b32 v226, 16, v53
    v_and_b32 v227, 0xffff0000, v53
    v_lshlrev_b32 v228, 16, v54
    v_and_b32 v229, 0xffff0000, v54
    v_lshlrev_b32 v230, 16, v55
    v_and_b32 v231, 0xffff0000, v55
    v_pk_add_f32 v[192:193], v[200:201], v[202:203]
    v_pk_add_f32 v[194:195], v[204:205], v[206:207]
    v_pk_add_f32 v[192:193], v[192:193], v[208:209]
    v_pk_add_f32 v[194:195], v[194:195], v[210:211]
    v_pk_add_f32 v[192:193], v[192:193], v[212:213]
    v_pk_add_f32 v[194:195], v[194:195], v[214:215]
    v_pk_add_f32 v[192:193], v[192:193], v[216:217]
    v_pk_add_f32 v[194:195], v[194:195], v[218:219]
    v_pk_add_f32 v[192:193], v[192:193], v[220:221]
    v_pk_add_f32 v[194:195], v[194:195], v[222:223]
    v_pk_add_f32 v[192:193], v[192:193], v[224:225]
    v_pk_add_f32 v[194:195], v[194:195], v[226:227]
    v_pk_add_f32 v[192:193], v[192:193], v[228:229]
    v_pk_add_f32 v[194:195], v[194:195], v[230:231]
    v_pk_add_f32 v[192:193], v[192:193], v[194:195]
    v_add_f32 v192, v192, v193
    s_nop 1
    v_add_f32_dpp v192, v192, v192 quad_perm:[1,0,3,2] row_mask:0xf bank_mask:0xf
    s_nop 1
    v_add_f32_dpp v192, v192, v192 quad_perm:[2,3,0,1] row_mask:0xf bank_mask:0xf
    s_nop 1
    v_add_f32_dpp v192, v192, v192 row_half_mirror row_mask:0xf bank_mask:0xf
    s_nop 1
    v_add_f32_dpp v192, v192, v192 row_mirror row_mask:0xf bank_mask:0xf
    v_mov_b32 v194, v192
    s_nop 1
    v_permlane16_swap_b32 v192, v194
    s_nop 1
    v_add_f32 v192, v192, v194
    v_mul_f32 v192, 0xba800000, v192
    v_mov_b32 v193, v192
    v_pk_add_f32 v[194:195], v[200:201], v[192:193]
    v_pk_add_f32 v[198:199], v[202:203], v[192:193]
    v_pk_mul_f32 v[196:197], v[194:195], v[194:195]
    v_pk_fma_f32 v[196:197], v[198:199], v[198:199], v[196:197]
    v_pk_add_f32 v[194:195], v[204:205], v[192:193]
    v_pk_add_f32 v[198:199], v[206:207], v[192:193]
    v_pk_fma_f32 v[196:197], v[194:195], v[194:195], v[196:197]
    v_pk_fma_f32 v[196:197], v[198:199], v[198:199], v[196:197]
    v_pk_add_f32 v[194:195], v[208:209], v[192:193]
    v_pk_add_f32 v[198:199], v[210:211], v[192:193]
    v_pk_fma_f32 v[196:197], v[194:195], v[194:195], v[196:197]
    v_pk_fma_f32 v[196:197], v[198:199], v[198:199], v[196:197]
    v_pk_add_f32 v[194:195], v[212:213], v[192:193]
    v_pk_add_f32 v[198:199], v[214:215], v[192:193]
    v_pk_fma_f32 v[196:197], v[194:195], v[194:195], v[196:197]
    v_pk_fma_f32 v[196:197], v[198:199], v[198:199], v[196:197]
    v_pk_add_f32 v[194:195], v[216:217], v[192:193]
    v_pk_add_f32 v[198:199], v[218:219], v[192:193]
    v_pk_fma_f32 v[196:197], v[194:195], v[194:195], v[196:197]
    v_pk_fma_f32 v[196:197], v[198:199], v[198:199], v[196:197]
    v_pk_add_f32 v[194:195], v[220:221], v[192:193]
    v_pk_add_f32 v[198:199], v[222:223], v[192:193]
    v_pk_fma_f32 v[196:197], v[194:195], v[194:195], v[196:197]
    v_pk_fma_f32 v[196:197], v[198:199], v[198:199], v[196:197]
    v_pk_add_f32 v[194:195], v[224:225], v[192:193]
    v_pk_add_f32 v[198:199], v[226:227], v[192:193]
    v_pk_fma_f32 v[196:197], v[194:195], v[194:195], v[196:197]
    v_pk_fma_f32 v[196:197], v[198:199], v[198:199], v[196:197]
    v_pk_add_f32 v[194:195], v[228:229], v[192:193]
    v_pk_add_f32 v[198:199], v[230:231], v[192:193]
    v_pk_fma_f32 v[196:197], v[194:195], v[194:195], v[196:197]
    v_pk_fma_f32 v[196:197], v[198:199], v[198:199], v[196:197]
    v_add_f32 v196, v196, v197
    s_nop 1
    v_add_f32_dpp v196, v196, v196 quad_perm:[1,0,3,2] row_mask:0xf bank_mask:0xf
    s_nop 1
    v_add_f32_dpp v196, v196, v196 quad_perm:[2,3,0,1] row_mask:0xf bank_mask:0xf
    s_nop 1
    v_add_f32_dpp v196, v196, v196 row_half_mirror row_mask:0xf bank_mask:0xf
    s_nop 1
    v_add_f32_dpp v196, v196, v196 row_mirror row_mask:0xf bank_mask:0xf
    v_mov_b32 v194, v196
    s_nop 1
    v_permlane16_swap_b32 v196, v194
    s_nop 1
    v_add_f32 v196, v196, v194
    v_mul_f32 v196, 0x3a800000, v196
    v_cvt_pk_bf16_f32 v198, v192, v196
    v_and_b32 v196, 0xffff0000, v198
    v_lshlrev_b32 v198, 16, v198
    v_add_f32 v196, 0x3727c5ac, v196
    v_mov_b32 v199, v198
    v_cvt_pk_bf16_f32 v196, v196, v196
    v_and_b32 v196, 0xffff0000, v196
    v_sqrt_f32 v196, v196
    v_pk_add_f32 v[160:161], v[200:201], v[198:199]
    v_pk_add_f32 v[162:163], v[202:203], v[198:199]
    v_pk_add_f32 v[164:165], v[204:205], v[198:199]
    v_pk_add_f32 v[166:167], v[206:207], v[198:199]
    v_pk_add_f32 v[168:169], v[208:209], v[198:199]
    v_pk_add_f32 v[170:171], v[210:211], v[198:199]
    v_pk_add_f32 v[172:173], v[212:213], v[198:199]
    v_pk_add_f32 v[174:175], v[214:215], v[198:199]
    v_pk_add_f32 v[176:177], v[216:217], v[198:199]
    v_pk_add_f32 v[178:179], v[218:219], v[198:199]
    v_pk_add_f32 v[180:181], v[220:221], v[198:199]
    v_pk_add_f32 v[182:183], v[222:223], v[198:199]
    v_pk_add_f32 v[184:185], v[224:225], v[198:199]
    v_pk_add_f32 v[186:187], v[226:227], v[198:199]
    v_pk_add_f32 v[188:189], v[228:229], v[198:199]
    v_pk_add_f32 v[190:191], v[230:231], v[198:199]
    v_cvt_pk_bf16_f32 v196, v196, v196
    v_and_b32 v196, 0xffff0000, v196
    v_rcp_f32 v196, v196
    v_cvt_pk_bf16_f32 v40, v160, v161
    v_cvt_pk_bf16_f32 v41, v162, v163
    v_cvt_pk_bf16_f32 v42, v164, v165
    v_cvt_pk_bf16_f32 v43, v166, v167
    v_cvt_pk_bf16_f32 v44, v168, v169
    v_cvt_pk_bf16_f32 v45, v170, v171
    v_cvt_pk_bf16_f32 v46, v172, v173
    v_cvt_pk_bf16_f32 v47, v174, v175
    v_cvt_pk_bf16_f32 v48, v176, v177
    v_cvt_pk_bf16_f32 v49, v178, v179
    v_cvt_pk_bf16_f32 v50, v180, v181
    v_cvt_pk_bf16_f32 v51, v182, v183
    v_cvt_pk_bf16_f32 v52, v184, v185
    v_cvt_pk_bf16_f32 v53, v186, v187
    v_cvt_pk_bf16_f32 v54, v188, v189
    v_cvt_pk_bf16_f32 v55, v190, v191
    v_mov_b32 v197, v196
    v_lshlrev_b32 v160, 16, v40
    v_and_b32 v161, 0xffff0000, v40
    v_lshlrev_b32 v162, 16, v41
    v_and_b32 v163, 0xffff0000, v41
    v_lshlrev_b32 v164, 16, v42
    v_and_b32 v165, 0xffff0000, v42
    v_lshlrev_b32 v166, 16, v43
    v_and_b32 v167, 0xffff0000, v43
    v_lshlrev_b32 v168, 16, v44
    v_and_b32 v169, 0xffff0000, v44
    v_lshlrev_b32 v170, 16, v45
    v_and_b32 v171, 0xffff0000, v45
    v_lshlrev_b32 v172, 16, v46
    v_and_b32 v173, 0xffff0000, v46
    v_lshlrev_b32 v174, 16, v47
    v_and_b32 v175, 0xffff0000, v47
    v_lshlrev_b32 v176, 16, v48
    v_and_b32 v177, 0xffff0000, v48
    v_lshlrev_b32 v178, 16, v49
    v_and_b32 v179, 0xffff0000, v49
    v_lshlrev_b32 v180, 16, v50
    v_and_b32 v181, 0xffff0000, v50
    v_lshlrev_b32 v182, 16, v51
    v_and_b32 v183, 0xffff0000, v51
    v_lshlrev_b32 v184, 16, v52
    v_and_b32 v185, 0xffff0000, v52
    v_lshlrev_b32 v186, 16, v53
    v_and_b32 v187, 0xffff0000, v53
    v_lshlrev_b32 v188, 16, v54
    v_and_b32 v189, 0xffff0000, v54
    v_lshlrev_b32 v190, 16, v55
    v_and_b32 v191, 0xffff0000, v55
    v_pk_mul_f32 v[160:161], v[160:161], v[196:197]
    v_pk_mul_f32 v[162:163], v[162:163], v[196:197]
    v_pk_mul_f32 v[164:165], v[164:165], v[196:197]
    v_pk_mul_f32 v[166:167], v[166:167], v[196:197]
    v_pk_mul_f32 v[168:169], v[168:169], v[196:197]
    v_pk_mul_f32 v[170:171], v[170:171], v[196:197]
    v_pk_mul_f32 v[172:173], v[172:173], v[196:197]
    v_pk_mul_f32 v[174:175], v[174:175], v[196:197]
    v_pk_mul_f32 v[176:177], v[176:177], v[196:197]
    v_pk_mul_f32 v[178:179], v[178:179], v[196:197]
    v_pk_mul_f32 v[180:181], v[180:181], v[196:197]
    v_pk_mul_f32 v[182:183], v[182:183], v[196:197]
    v_pk_mul_f32 v[184:185], v[184:185], v[196:197]
    v_pk_mul_f32 v[186:187], v[186:187], v[196:197]
    v_pk_mul_f32 v[188:189], v[188:189], v[196:197]
    v_pk_mul_f32 v[190:191], v[190:191], v[196:197]
    v_cvt_pk_bf16_f32 v40, v160, v161
    v_cvt_pk_bf16_f32 v41, v162, v163
    v_cvt_pk_bf16_f32 v42, v164, v165
    v_cvt_pk_bf16_f32 v43, v166, v167
    v_cvt_pk_bf16_f32 v44, v168, v169
    v_cvt_pk_bf16_f32 v45, v170, v171
    v_cvt_pk_bf16_f32 v46, v172, v173
    v_cvt_pk_bf16_f32 v47, v174, v175
    v_cvt_pk_bf16_f32 v48, v176, v177
    v_cvt_pk_bf16_f32 v49, v178, v179
    v_cvt_pk_bf16_f32 v50, v180, v181
    v_cvt_pk_bf16_f32 v51, v182, v183
    v_cvt_pk_bf16_f32 v52, v184, v185
    v_cvt_pk_bf16_f32 v53, v186, v187
    v_cvt_pk_bf16_f32 v54, v188, v189
    v_cvt_pk_bf16_f32 v55, v190, v191
    s_cmp_ge_u32 s44, 4
    s_cbranch_scc1 k4_bout_96
    v_lshl_add_u32 v11, v5, 11, v7
    v_add_u32 v12, 65536, v11
    ds_write_b128 v12, v[40:43] offset:0
    ds_write_b128 v12, v[44:47] offset:512
    ds_write_b128 v12, v[48:51] offset:1024
    ds_write_b128 v12, v[52:55] offset:1536
    v_lshlrev_b32 v12, 2, v5
    v_add_u32 v12, 69760, v12
    ds_write_b32 v12, v15
    s_mov_b32 s54, 0x05040100
    s_mov_b32 s55, 0x07060302
    s_waitcnt vmcnt(0)
    v_perm_b32 v56, v90, v88, s54
    v_perm_b32 v57, v90, v88, s55
    v_perm_b32 v58, v91, v89, s54
    v_perm_b32 v59, v91, v89, s55
    v_perm_b32 v60, v94, v92, s54
    v_perm_b32 v61, v94, v92, s55
    v_perm_b32 v62, v95, v93, s54
    v_perm_b32 v63, v95, v93, s55
    v_perm_b32 v64, v98, v96, s54
    v_perm_b32 v65, v98, v96, s55
    v_perm_b32 v66, v99, v97, s54
    v_perm_b32 v67, v99, v97, s55
    v_perm_b32 v68, v102, v100, s54
    v_perm_b32 v69, v102, v100, s55
    v_perm_b32 v70, v103, v101, s54
    v_perm_b32 v71, v103, v101, s55
    v_perm_b32 v72, v106, v104, s54
    v_perm_b32 v73, v106, v104, s55
    v_perm_b32 v74, v107, v105, s54
    v_perm_b32 v75, v107, v105, s55
    v_perm_b32 v76, v110, v108, s54
    v_perm_b32 v77, v110, v108, s55
    v_perm_b32 v78, v111, v109, s54
    v_perm_b32 v79, v111, v109, s55
    v_perm_b32 v80, v114, v112, s54
    v_perm_b32 v81, v114, v112, s55
    v_perm_b32 v82, v115, v113, s54
    v_perm_b32 v83, v115, v113, s55
    v_perm_b32 v84, v118, v116, s54
    v_perm_b32 v85, v118, v116, s55
    v_perm_b32 v86, v119, v117, s54
    v_perm_b32 v87, v119, v117, s55
    s_add_u32 s56, s14, 0x4900000
    s_addc_u32 s57, s15, 0
    s_and_b32 s57, s57, 0xffff
    s_mov_b32 s58, 0x1c0000
    s_mov_b32 s59, 0x00020000
    s_add_u32 s60, s14, 0x480f000
    s_addc_u32 s61, s15, 0
    s_and_b32 s61, s61, 0xffff
    s_mov_b32 s62, 0x2000
    s_mov_b32 s63, 0x00020000
    s_waitcnt lgkmcnt(0)
k4_mm_95:
    s_barrier
    s_cmp_ge_u32 s2, 224
    s_cbranch_scc1 k4_red_98
    v_lshrrev_b32 v12, 4, v2
    v_and_b32 v13, 1, v2
    v_lshlrev_b32 v13, 11, v13
    v_lshl_add_u32 v13, v12, 3, v13
    s_lshl_b32 s54, s44, 8
    s_add_u32 s54, s54, 65536
    v_add_u32 v13, s54, v13
    v_lshlrev_b32 v14, 3, v2
    s_lshl_b32 s54, s44, 12
    v_add_u32 v14, s54, v14
    ds_read_b64 v[128:129], v13 offset:0
    ds_read_b64 v[130:131], v13 offset:32
    ds_read_b64_tr_b16 v[144:145], v14 offset:0
    ds_read_b64_tr_b16 v[146:147], v14 offset:512
    ds_read_b64_tr_b16 v[160:161], v14 offset:32768
    ds_read_b64_tr_b16 v[162:163], v14 offset:33280
    ds_read_b64 v[132:133], v13 offset:64
    ds_read_b64 v[134:135], v13 offset:96
    ds_read_b64_tr_b16 v[148:149], v14 offset:1024
    ds_read_b64_tr_b16 v[150:151], v14 offset:1536
    ds_read_b64_tr_b16 v[164:165], v14 offset:33792
    ds_read_b64_tr_b16 v[166:167], v14 offset:34304
    ds_read_b64 v[136:137], v13 offset:128
    ds_read_b64 v[138:139], v13 offset:160
    ds_read_b64_tr_b16 v[152:153], v14 offset:2048
    ds_read_b64_tr_b16 v[154:155], v14 offset:2560
    ds_read_b64_tr_b16 v[168:169], v14 offset:34816
    ds_read_b64_tr_b16 v[170:171], v14 offset:35328
    ds_read_b64 v[140:141], v13 offset:192
    ds_read_b64 v[142:143], v13 offset:224
    ds_read_b64_tr_b16 v[156:157], v14 offset:3072
    ds_read_b64_tr_b16 v[158:159], v14 offset:3584
    ds_read_b64_tr_b16 v[172:173], v14 offset:35840
    ds_read_b64_tr_b16 v[174:175], v14 offset:36352
    v_and_b32 v13, 15, v2
    v_lshlrev_b32 v13, 6, v13
    v_lshl_add_u32 v13, v12, 4, v13
    s_lshl_b32 s54, s44, 11
    s_add_u32 s54, s54, 69888
    v_add_u32 v13, s54, v13
    s_waitcnt lgkmcnt(0)
    v_mfma_f32_16x16x32_bf16 v[16:19], v[144:147], v[128:131], 0
    v_mfma_f32_16x16x32_bf16 v[20:23], v[160:163], v[128:131], 0
    v_mfma_f32_16x16x32_bf16 v[16:19], v[148:151], v[132:135], v[16:19]
    v_mfma_f32_16x16x32_bf16 v[20:23], v[164:167], v[132:135], v[20:23]
    v_mfma_f32_16x16x32_bf16 v[16:19], v[152:155], v[136:139], v[16:19]
    v_mfma_f32_16x16x32_bf16 v[20:23], v[168:171], v[136:139], v[20:23]
    v_mfma_f32_16x16x32_bf16 v[16:19], v[156:159], v[140:143], v[16:19]
    v_mfma_f32_16x16x32_bf16 v[20:23], v[172:175], v[140:143], v[20:23]
    s_nop 7
    ds_write_b128 v13, v[16:19]
    ds_write_b128 v13, v[20:23] offset:1024
    s_waitcnt lgkmcnt(0)
    s_barrier
    s_cmp_ge_u32 s44, 4
    s_cbranch_scc1 k4_ln_94
    v_lshlrev_b32 v13, 2, v4
    v_add_u32 v13, 69888, v13
    ds_read2st64_b32 v[16:17], v13 offset0:0 offset1:4
    ds_read2st64_b32 v[18:19], v13 offset0:8 offset1:12
    ds_read2st64_b32 v[20:21], v13 offset0:16 offset1:20
    ds_read2st64_b32 v[22:23], v13 offset0:24 offset1:28
    ds_read2st64_b32 v[24:25], v13 offset0:32 offset1:36
    ds_read2st64_b32 v[26:27], v13 offset0:40 offset1:44
    ds_read2st64_b32 v[28:29], v13 offset0:48 offset1:52
    ds_read2st64_b32 v[30:31], v13 offset0:56 offset1:60
    s_waitcnt lgkmcnt(0)
    v_pk_add_f32 v[16:17], v[16:17], v[24:25]
    v_pk_add_f32 v[18:19], v[18:19], v[26:27]
    v_pk_add_f32 v[20:21], v[20:21], v[28:29]
    v_pk_add_f32 v[22:23], v[22:23], v[30:31]
    v_pk_add_f32 v[16:17], v[16:17], v[20:21]
    v_pk_add_f32 v[18:19], v[18:19], v[22:23]
    v_pk_add_f32 v[16:17], v[16:17], v[18:19]
    v_cvt_pk_bf16_f32 v16, v16, v17
    v_and_b32 v20, 0xffff0000, v16
    v_lshlrev_b32 v16, 16, v16
    v_mul_f32 v17, 0xbfb8aa3b, v16
    v_exp_f32 v17, v17
    s_lshl_b32 s54, s45, 13
    v_add_f32 v17, 1.0, v17
    v_rcp_f32 v17, v17
    s_add_u32 s55, s54, 4096
    v_mul_f32 v16, v16, v17
    v_cvt_pk_bf16_f32 v16, v16, v16
    v_and_b32 v16, 0xffff0000, v16
    v_mul_f32 v16, v16, v20
    s_nop 1
    v_mov_b32_dpp v17, v16 quad_perm:[1,0,3,2] row_mask:0xf bank_mask:0xf
    v_cvt_pk_bf16_f32 v16, v16, v17
    v_lshlrev_b32 v13, 4, v0
    v_readlane_b32 s24, v16, 0
    v_readlane_b32 s25, v16, 2
    v_readlane_b32 s26, v16, 4
    v_readlane_b32 s27, v16, 6
    v_readlane_b32 s28, v16, 8
    v_readlane_b32 s29, v16, 10
    v_readlane_b32 s30, v16, 12
    v_readlane_b32 s31, v16, 14
    v_readlane_b32 s32, v16, 16
    v_readlane_b32 s33, v16, 18
    v_readlane_b32 s34, v16, 20
    v_readlane_b32 s35, v16, 22
    v_readlane_b32 s36, v16, 24
    v_readlane_b32 s37, v16, 26
    v_readlane_b32 s38, v16, 28
    v_readlane_b32 s39, v16, 30
    v_dot2_f32_bf16 v24, v56, s24, 0
    v_dot2_f32_bf16 v25, v57, s24, 0
    v_dot2_f32_bf16 v26, v58, s24, 0
    v_dot2_f32_bf16 v27, v59, s24, 0
    v_dot2_f32_bf16 v24, v60, s25, v24
    v_dot2_f32_bf16 v25, v61, s25, v25
    v_dot2_f32_bf16 v26, v62, s25, v26
    v_dot2_f32_bf16 v27, v63, s25, v27
    v_dot2_f32_bf16 v24, v64, s26, v24
    v_dot2_f32_bf16 v25, v65, s26, v25
    v_dot2_f32_bf16 v26, v66, s26, v26
    v_dot2_f32_bf16 v27, v67, s26, v27
    v_dot2_f32_bf16 v24, v68, s27, v24
    v_dot2_f32_bf16 v25, v69, s27, v25
    v_dot2_f32_bf16 v26, v70, s27, v26
    v_dot2_f32_bf16 v27, v71, s27, v27
    v_dot2_f32_bf16 v24, v72, s28, v24
    v_dot2_f32_bf16 v25, v73, s28, v25
    v_dot2_f32_bf16 v26, v74, s28, v26
    v_dot2_f32_bf16 v27, v75, s28, v27
    v_dot2_f32_bf16 v24, v76, s29, v24
    v_dot2_f32_bf16 v25, v77, s29, v25
    v_dot2_f32_bf16 v26, v78, s29, v26
    v_dot2_f32_bf16 v27, v79, s29, v27
    v_dot2_f32_bf16 v24, v80, s30, v24
    v_dot2_f32_bf16 v25, v81, s30, v25
    v_dot2_f32_bf16 v26, v82, s30, v26
    v_dot2_f32_bf16 v27, v83, s30, v27
    v_dot2_f32_bf16 v24, v84, s31, v24
    v_dot2_f32_bf16 v25, v85, s31, v25
    v_dot2_f32_bf16 v26, v86, s31, v26
    v_dot2_f32_bf16 v27, v87, s31, v27
    v_dot2_f32_bf16 v28, v56, s32, 0
    v_dot2_f32_bf16 v29, v57, s32, 0
    v_dot2_f32_bf16 v30, v58, s32, 0
    v_dot2_f32_bf16 v31, v59, s32, 0
    v_dot2_f32_bf16 v28, v60, s33, v28
    v_dot2_f32_bf16 v29, v61, s33, v29
    v_dot2_f32_bf16 v30, v62, s33, v30
    v_dot2_f32_bf16 v31, v63, s33, v31
    v_dot2_f32_bf16 v28, v64, s34, v28
    v_dot2_f32_bf16 v29, v65, s34, v29
    v_dot2_f32_bf16 v30, v66, s34, v30
    v_dot2_f32_bf16 v31, v67, s34, v31
    v_dot2_f32_bf16 v28, v68, s35, v28
    v_dot2_f32_bf16 v29, v69, s35, v29
    v_dot2_f32_bf16 v30, v70, s35, v30
    v_dot2_f32_bf16 v31, v71, s35, v31
    v_dot2_f32_bf16 v28, v72, s36, v28
    v_dot2_f32_bf16 v29, v73, s36, v29
    v_dot2_f32_bf16 v30, v74, s36, v30
    v_dot2_f32_bf16 v31, v75, s36, v31
    v_dot2_f32_bf16 v28, v76, s37, v28
    v_dot2_f32_bf16 v29, v77, s37, v29
    v_dot2_f32_bf16 v30, v78, s37, v30
    v_dot2_f32_bf16 v31, v79, s37, v31
    v_dot2_f32_bf16 v28, v80, s38, v28
    v_dot2_f32_bf16 v29, v81, s38, v29
    v_dot2_f32_bf16 v30, v82, s38, v30
    v_dot2_f32_bf16 v31, v83, s38, v31
    v_dot2_f32_bf16 v28, v84, s39, v28
    v_dot2_f32_bf16 v29, v85, s39, v29
    v_dot2_f32_bf16 v30, v86, s39, v30
    v_dot2_f32_bf16 v31, v87, s39, v31
    s_and_b32 s52, s45, 15
    s_lshl_b32 s53, s44, 4
    s_add_u32 s52, s52, s53
    s_lshl_b32 s52, s52, 7
    buffer_store_dwordx4 v[24:27], v13, s[56:59], s54 offen sc1
    buffer_store_dwordx4 v[28:31], v13, s[56:59], s55 offen sc1
    v_mov_b32 v12, 0
    v_mov_b32 v13, 1
    s_mov_b64 exec, 1
    s_waitcnt vmcnt(0)
    buffer_atomic_add v13, v12, s[60:63], s52 offen sc1
    s_mov_b64 exec, -1
    s_endpgm
k4_red_98:
    s_cmp_ge_u32 s44, 4
    s_cbranch_scc1 k4_ln_94
    s_sub_u32 s40, s2, 224
    s_lshr_b32 s41, s40, 4
    s_and_b32 s42, s40, 15
    s_mov_b32 s24, s4
    s_and_b32 s25, s5, 0xffff
    s_mov_b32 s26, 0x800
    s_mov_b32 s27, 0x00020000
    s_mov_b32 s28, s12
    s_and_b32 s29, s13, 0xffff
    s_mov_b32 s30, 0x400000
    s_mov_b32 s31, 0x00020000
    buffer_load_dwordx4 v[56:59], v7, s[24:27], 0 offen offset:0
    buffer_load_dwordx4 v[60:63], v7, s[24:27], 0 offen offset:512
    buffer_load_dwordx4 v[64:67], v7, s[24:27], 0 offen offset:1024
    buffer_load_dwordx4 v[68:71], v7, s[24:27], 0 offen offset:1536
    s_lshl_b32 s43, s41, 5
    v_readlane_b32 s46, v15, s43
    v_and_b32 v8, 15, v0
    s_lshl_b32 s47, s42, 7
    v_lshl_add_u32 v9, v8, 3, s47
    s_lshl_b32 s46, s46, 11
    s_lshl_b32 s48, s41, 11
    s_add_u32 s48, s48, 65536
    v_add_u32 v12, s48, v9
    ds_read_b64 v[72:73], v12
    buffer_load_dwordx2 v[74:75], v9, s[20:23], s46 offen
    v_lshrrev_b32 v10, 4, v0
    v_lshlrev_b32 v10, 13, v10
    v_lshl_add_u32 v10, v8, 4, v10
    s_lshl_b32 s49, s40, 8
    s_waitcnt vmcnt(1)
    v_dot2_f32_bf16 v12, v40, v56, 0
    v_dot2_f32_bf16 v12, v41, v57, v12
    v_dot2_f32_bf16 v12, v42, v58, v12
    v_dot2_f32_bf16 v12, v43, v59, v12
    v_dot2_f32_bf16 v12, v44, v60, v12
    v_dot2_f32_bf16 v12, v45, v61, v12
    v_dot2_f32_bf16 v12, v46, v62, v12
    v_dot2_f32_bf16 v12, v47, v63, v12
    v_dot2_f32_bf16 v12, v48, v64, v12
    v_dot2_f32_bf16 v12, v49, v65, v12
    v_dot2_f32_bf16 v12, v50, v66, v12
    v_dot2_f32_bf16 v12, v51, v67, v12
    v_dot2_f32_bf16 v12, v52, v68, v12
    v_dot2_f32_bf16 v12, v53, v69, v12
    v_dot2_f32_bf16 v12, v54, v70, v12
    v_dot2_f32_bf16 v12, v55, v71, v12
    s_nop 2
    s_nop 1
    v_add_f32_dpp v12, v12, v12 quad_perm:[1,0,3,2] row_mask:0xf bank_mask:0xf
    s_nop 1
    v_add_f32_dpp v12, v12, v12 quad_perm:[2,3,0,1] row_mask:0xf bank_mask:0xf
    s_nop 1
    v_add_f32_dpp v12, v12, v12 row_half_mirror row_mask:0xf bank_mask:0xf
    s_nop 1
    v_add_f32_dpp v12, v12, v12 row_mirror row_mask:0xf bank_mask:0xf
    v_mov_b32 v13, v12
    s_nop 1
    v_permlane16_swap_b32 v12, v13
    s_nop 1
    v_add_f32 v12, v12, v13
    v_cvt_pk_bf16_f32 v12, v12, v12
    v_and_b32 v12, 0xffff0000, v12
    v_mul_f32 v12, 0xbfb8aa3b, v12
    v_exp_f32 v12, v12
    v_mov_b32 v3, v8
    v_add_f32 v12, 1.0, v12
    v_rcp_f32 v12, v12
    s_lshr_b32 s50, s42, 2
    v_cvt_pk_bf16_f32 v12, v12, v12
    v_and_b32 v12, 0xffff0000, v12
    s_lshl_b32 s50, s50, 11
    v_readlane_b32 s51, v12, s43
    v_lshlrev_b32 v3, 7, v3
    s_mov_b32 s47, s49
    s_mov_b32 s30, 0
    s_mov_b32 s58, 0
    s_branch k4_go_99
k4_again_101:
    s_mov_b32 s49, s47
    s_mov_b32 s30, 0x400000
    s_mov_b32 s58, 1835008
    s_cmp_lg_u32 s44, 0
    s_cbranch_scc1 k4_go_99
    s_mov_b32 s52, 1048576
k4_poll_100:
    s_sleep 8
    buffer_load_dword v13, v3, s[60:63], s50 offen sc1
    s_sub_u32 s52, s52, 1
    s_cbranch_scc1 k4_go_99
    s_waitcnt vmcnt(0)
    v_cmp_gt_u32 vcc, 14, v13
    s_cbranch_vccnz k4_poll_100
k4_go_99:
    s_barrier
    buffer_load_dwordx4 v[76:79], v10, s[56:59], s49 offen sc1
    s_add_u32 s49, s49, 0x20000
    buffer_load_dwordx4 v[80:83], v10, s[56:59], s49 offen sc1
    s_add_u32 s49, s49, 0x20000
    buffer_load_dwordx4 v[84:87], v10, s[56:59], s49 offen sc1
    s_add_u32 s49, s49, 0x20000
    buffer_load_dwordx4 v[88:91], v10, s[56:59], s49 offen sc1
    s_add_u32 s49, s49, 0x20000
    buffer_load_dwordx4 v[92:95], v10, s[56:59], s49 offen sc1
    s_add_u32 s49, s49, 0x20000
    buffer_load_dwordx4 v[96:99], v10, s[56:59], s49 offen sc1
    s_add_u32 s49, s49, 0x20000
    buffer_load_dwordx4 v[100:103], v10, s[56:59], s49 offen sc1
    s_add_u32 s49, s49, 0x20000
    buffer_load_dwordx4 v[104:107], v10, s[56:59], s49 offen sc1
    s_add_u32 s49, s49, 0x20000
    buffer_load_dwordx4 v[108:111], v10, s[56:59], s49 offen sc1
    s_add_u32 s49, s49, 0x20000
    buffer_load_dwordx4 v[112:115], v10, s[56:59], s49 offen sc1
    s_add_u32 s49, s49, 0x20000
    buffer_load_dwordx4 v[116:119], v10, s[56:59], s49 offen sc1
    s_add_u32 s49, s49, 0x20000
    buffer_load_dwordx4 v[120:123], v10, s[56:59], s49 offen sc1
    s_add_u32 s49, s49, 0x20000
    buffer_load_dwordx4 v[124:127], v10, s[56:59], s49 offen sc1
    s_add_u32 s49, s49, 0x20000
    buffer_load_dwordx4 v[128:131], v10, s[56:59], s49 offen sc1
    s_add_u32 s49, s49, 0x20000
    s_waitcnt vmcnt(12)
    v_pk_add_f32 v[76:77], v[76:77], v[80:81]
    v_pk_add_f32 v[78:79], v[78:79], v[82:83]
    s_waitcnt vmcnt(11)
    v_pk_add_f32 v[76:77], v[76:77], v[84:85]
    v_pk_add_f32 v[78:79], v[78:79], v[86:87]
    s_waitcnt vmcnt(10)
    v_pk_add_f32 v[76:77], v[76:77], v[88:89]
    v_pk_add_f32 v[78:79], v[78:79], v[90:91]
    s_waitcnt vmcnt(9)
    v_pk_add_f32 v[76:77], v[76:77], v[92:93]
    v_pk_add_f32 v[78:79], v[78:79], v[94:95]
    s_waitcnt vmcnt(8)
    v_pk_add_f32 v[76:77], v[76:77], v[96:97]
    v_pk_add_f32 v[78:79], v[78:79], v[98:99]
    s_waitcnt vmcnt(7)
    v_pk_add_f32 v[76:77], v[76:77], v[100:101]
    v_pk_add_f32 v[78:79], v[78:79], v[102:103]
    s_waitcnt vmcnt(6)
    v_pk_add_f32 v[76:77], v[76:77], v[104:105]
    v_pk_add_f32 v[78:79], v[78:79], v[106:107]
    s_waitcnt vmcnt(5)
    v_pk_add_f32 v[76:77], v[76:77], v[108:109]
    v_pk_add_f32 v[78:79], v[78:79], v[110:111]
    s_waitcnt vmcnt(4)
    v_pk_add_f32 v[76:77], v[76:77], v[112:113]
    v_pk_add_f32 v[78:79], v[78:79], v[114:115]
    s_waitcnt vmcnt(3)
    v_pk_add_f32 v[76:77], v[76:77], v[116:117]
    v_pk_add_f32 v[78:79], v[78:79], v[118:119]
    s_waitcnt vmcnt(2)
    v_pk_add_f32 v[76:77], v[76:77], v[120:121]
    v_pk_add_f32 v[78:79], v[78:79], v[122:123]
    s_waitcnt vmcnt(1)
    v_pk_add_f32 v[76:77], v[76:77], v[124:125]
    v_pk_add_f32 v[78:79], v[78:79], v[126:127]
    s_waitcnt vmcnt(0)
    v_pk_add_f32 v[76:77], v[76:77], v[128:129]
    v_pk_add_f32 v[78:79], v[78:79], v[130:131]
    v_mov_b32 v80, v76
    v_mov_b32 v81, v77
    v_mov_b32 v82, v78
    v_mov_b32 v83, v79
    s_nop 1
    v_permlane16_swap_b32 v76, v80
    v_permlane16_swap_b32 v77, v81
    v_permlane16_swap_b32 v78, v82
    v_permlane16_swap_b32 v79, v83
    s_nop 1
    v_add_f32 v76, v76, v80
    v_add_f32 v77, v77, v81
    v_add_f32 v78, v78, v82
    v_add_f32 v79, v79, v83
    v_mov_b32 v80, v76
    v_mov_b32 v81, v77
    v_mov_b32 v82, v78
    v_mov_b32 v83, v79
    s_nop 1
    v_permlane32_swap_b32 v76, v80
    v_permlane32_swap_b32 v77, v81
    v_permlane32_swap_b32 v78, v82
    v_permlane32_swap_b32 v79, v83
    s_nop 1
    v_add_f32 v76, v76, v80
    v_add_f32 v77, v77, v81
    v_add_f32 v78, v78, v82
    v_add_f32 v79, v79, v83
    v_lshlrev_b32 v14, 8, v1
    v_lshl_add_u32 v14, v8, 4, v14
    ds_write_b128 v14, v[76:79]
    s_waitcnt lgkmcnt(0)
    s_barrier
    v_lshlrev_b32 v14, 4, v8
    ds_read_b128 v[76:79], v14 offset:0
    ds_read_b128 v[80:83], v14 offset:256
    ds_read_b128 v[84:87], v14 offset:512
    ds_read_b128 v[88:91], v14 offset:768
    s_waitcnt lgkmcnt(0)
    v_pk_add_f32 v[76:77], v[76:77], v[80:81]
    v_pk_add_f32 v[78:79], v[78:79], v[82:83]
    v_pk_add_f32 v[76:77], v[76:77], v[84:85]
    v_pk_add_f32 v[78:79], v[78:79], v[86:87]
    v_pk_add_f32 v[76:77], v[76:77], v[88:89]
    v_pk_add_f32 v[78:79], v[78:79], v[90:91]
    v_cvt_pk_bf16_f32 v20, v76, v77
    v_lshlrev_b32 v21, 16, v20
    v_and_b32 v22, 0xffff0000, v20
    v_mul_f32 v21, s51, v21
    v_mul_f32 v22, s51, v22
    v_cvt_pk_bf16_f32 v20, v21, v22
    v_lshlrev_b32 v21, 16, v20
    v_and_b32 v22, 0xffff0000, v20
    v_lshlrev_b32 v23, 16, v72
    v_and_b32 v24, 0xffff0000, v72
    v_add_f32 v21, v21, v23
    v_add_f32 v22, v22, v24
    v_cvt_pk_bf16_f32 v20, v21, v22
    v_lshlrev_b32 v21, 16, v20
    v_and_b32 v22, 0xffff0000, v20
    v_lshlrev_b32 v23, 16, v74
    v_and_b32 v24, 0xffff0000, v74
    v_add_f32 v21, v21, v23
    v_add_f32 v22, v22, v24
    v_cvt_pk_bf16_f32 v26, v21, v22
    v_cvt_pk_bf16_f32 v20, v78, v79
    v_lshlrev_b32 v21, 16, v20
    v_and_b32 v22, 0xffff0000, v20
    v_mul_f32 v21, s51, v21
    v_mul_f32 v22, s51, v22
    v_cvt_pk_bf16_f32 v20, v21, v22
    v_lshlrev_b32 v21, 16, v20
    v_and_b32 v22, 0xffff0000, v20
    v_lshlrev_b32 v23, 16, v73
    v_and_b32 v24, 0xffff0000, v73
    v_add_f32 v21, v21, v23
    v_add_f32 v22, v22, v24
    v_cvt_pk_bf16_f32 v20, v21, v22
    v_lshlrev_b32 v21, 16, v20
    v_and_b32 v22, 0xffff0000, v20
    v_lshlrev_b32 v23, 16, v75
    v_and_b32 v24, 0xffff0000, v75
    v_add_f32 v21, v21, v23
    v_add_f32 v22, v22, v24
    v_cvt_pk_bf16_f32 v27, v21, v22
    v_cmp_gt_u32 vcc, 16, v0
    s_and_saveexec_b64 s[52:53], vcc
    s_cbranch_execz k4_skip_102
    buffer_store_dwordx2 v[26:27], v9, s[28:31], s46 offen sc1
k4_skip_102:
    s_mov_b64 exec, s[52:53]
    s_cmp_lg_u32 s30, 0
    s_cbranch_scc1 k4_fin_103
    s_branch k4_again_101
k4_fin_103:
    s_endpgm
k4_b_93:
    v_lshl_add_u32 v6, v1, 1, v5
    s_lshl_b32 s47, s2, 3
    s_sub_u32 s47, s47, 8
    v_add_u32 v6, s47, v6
    v_lshl_add_u32 v6, v6, 11, v7
    s_mov_b32 s36, s12
    s_and_b32 s37, s13, 0xffff
    s_mov_b32 s38, 0x400000
    s_mov_b32 s39, 0x00020000
    s_cmp_ge_u32 s2, 224
    s_cbranch_scc1 k4_noffn_104
    s_add_u32 s24, s14, 0x6000000
    s_addc_u32 s25, s15, 0
    s_and_b32 s25, s25, 0xffff
    s_mov_b32 s26, 0x1000000
    s_mov_b32 s27, 0x00020000
    s_and_b32 s50, s44, 3
    s_lshl_b32 s50, s50, 13
    s_lshl_b32 s52, s45, 15
    s_add_u32 s52, s52, s50
    v_lshlrev_b32 v8, 4, v2
    s_add_u32 m0, s50, 0
    s_add_u32 s53, s52, 0
    buffer_load_dwordx4 v8, s[24:27], s53 offen offset:0 lds
    buffer_load_dwordx4 v8, s[24:27], s53 offen offset:1024 lds
    buffer_load_dwordx4 v8, s[24:27], s53 offen offset:2048 lds
    buffer_load_dwordx4 v8, s[24:27], s53 offen offset:3072 lds
    s_add_u32 m0, s50, 4096
    s_add_u32 s53, s52, 4096
    buffer_load_dwordx4 v8, s[24:27], s53 offen offset:0 lds
    buffer_load_dwordx4 v8, s[24:27], s53 offen offset:1024 lds
    buffer_load_dwordx4 v8, s[24:27], s53 offen offset:2048 lds
    buffer_load_dwordx4 v8, s[24:27], s53 offen offset:3072 lds
    s_add_u32 m0, s50, 32768
    s_add_u32 s53, s52, 8388608
    buffer_load_dwordx4 v8, s[24:27], s53 offen offset:0 lds
    buffer_load_dwordx4 v8, s[24:27], s53 offen offset:1024 lds
    buffer_load_dwordx4 v8, s[24:27], s53 offen offset:2048 lds
    buffer_load_dwordx4 v8, s[24:27], s53 offen offset:3072 lds
    s_add_u32 m0, s50, 36864
    s_add_u32 s53, s52, 8392704
    buffer_load_dwordx4 v8, s[24:27], s53 offen offset:0 lds
    buffer_load_dwordx4 v8, s[24:27], s53 offen offset:1024 lds
    buffer_load_dwordx4 v8, s[24:27], s53 offen offset:2048 lds
    buffer_load_dwordx4 v8, s[24:27], s53 offen offset:3072 lds
k4_noffn_104:
    buffer_load_dwordx4 v[40:43], v6, s[20:23], 0 offen offset:0
    buffer_load_dwordx4 v[44:47], v6, s[20:23], 0 offen offset:512
    buffer_load_dwordx4 v[48:51], v6, s[20:23], 0 offen offset:1024
    buffer_load_dwordx4 v[52:55], v6, s[20:23], 0 offen offset:1536
    s_waitcnt vmcnt(0)
    s_branch k4_mm_95
k4_bout_96:
    v_mov_b32 v12, 69760
    ds_read_b64 v[12:13], v12
    v_lshrrev_b32 v14, 11, v6
    v_lshlrev_b32 v160, 16, v40
    v_and_b32 v161, 0xffff0000, v40
    v_lshlrev_b32 v162, 16, v41
    v_and_b32 v163, 0xffff0000, v41
    v_lshlrev_b32 v164, 16, v42
    v_and_b32 v165, 0xffff0000, v42
    v_lshlrev_b32 v166, 16, v43
    v_and_b32 v167, 0xffff0000, v43
    v_lshlrev_b32 v168, 16, v44
    v_and_b32 v169, 0xffff0000, v44
    v_lshlrev_b32 v170, 16, v45
    v_and_b32 v171, 0xffff0000, v45
    v_lshlrev_b32 v172, 16, v46
    v_and_b32 v173, 0xffff0000, v46
    v_lshlrev_b32 v174, 16, v47
    v_and_b32 v175, 0xffff0000, v47
    v_lshlrev_b32 v176, 16, v48
    v_and_b32 v177, 0xffff0000, v48
    v_lshlrev_b32 v178, 16, v49
    v_and_b32 v179, 0xffff0000, v49
    v_lshlrev_b32 v180, 16, v50
    v_and_b32 v181, 0xffff0000, v50
    v_lshlrev_b32 v182, 16, v51
    v_and_b32 v183, 0xffff0000, v51
    v_lshlrev_b32 v184, 16, v52
    v_and_b32 v185, 0xffff0000, v52
    v_lshlrev_b32 v186, 16, v53
    v_and_b32 v187, 0xffff0000, v53
    v_lshlrev_b32 v188, 16, v54
    v_and_b32 v189, 0xffff0000, v54
    v_lshlrev_b32 v190, 16, v55
    v_and_b32 v191, 0xffff0000, v55
    v_pk_add_f32 v[160:161], v[160:161], v[200:201]
    v_pk_add_f32 v[162:163], v[162:163], v[202:203]
    v_pk_add_f32 v[164:165], v[164:165], v[204:205]
    v_pk_add_f32 v[166:167], v[166:167], v[206:207]
    v_pk_add_f32 v[168:169], v[168:169], v[208:209]
    v_pk_add_f32 v[170:171], v[170:171], v[210:211]
    v_pk_add_f32 v[172:173], v[172:173], v[212:213]
    v_pk_add_f32 v[174:175], v[174:175], v[214:215]
    v_pk_add_f32 v[176:177], v[176:177], v[216:217]
    v_pk_add_f32 v[178:179], v[178:179], v[218:219]
    v_pk_add_f32 v[180:181], v[180:181], v[220:221]
    v_pk_add_f32 v[182:183], v[182:183], v[222:223]
    v_pk_add_f32 v[184:185], v[184:185], v[224:225]
    v_pk_add_f32 v[186:187], v[186:187], v[226:227]
    v_pk_add_f32 v[188:189], v[188:189], v[228:229]
    v_pk_add_f32 v[190:191], v[190:191], v[230:231]
    v_cvt_pk_bf16_f32 v40, v160, v161
    v_cvt_pk_bf16_f32 v41, v162, v163
    v_cvt_pk_bf16_f32 v42, v164, v165
    v_cvt_pk_bf16_f32 v43, v166, v167
    v_cvt_pk_bf16_f32 v44, v168, v169
    v_cvt_pk_bf16_f32 v45, v170, v171
    v_cvt_pk_bf16_f32 v46, v172, v173
    v_cvt_pk_bf16_f32 v47, v174, v175
    v_cvt_pk_bf16_f32 v48, v176, v177
    v_cvt_pk_bf16_f32 v49, v178, v179
    v_cvt_pk_bf16_f32 v50, v180, v181
    v_cvt_pk_bf16_f32 v51, v182, v183
    v_cvt_pk_bf16_f32 v52, v184, v185
    v_cvt_pk_bf16_f32 v53, v186, v187
    v_cvt_pk_bf16_f32 v54, v188, v189
    v_cvt_pk_bf16_f32 v55, v190, v191
    s_waitcnt lgkmcnt(0)
    v_cmp_eq_u32 vcc, v12, v14
    v_cmp_eq_u32 s[52:53], v13, v14
    v_mov_b32 v12, 0x7fffffff
    s_or_b64 vcc, vcc, s[52:53]
    v_cndmask_b32 v6, v6, v12, vcc
    buffer_store_dwordx4 v[40:43], v6, s[36:39], 0 offen offset:0 sc1
    buffer_store_dwordx4 v[44:47], v6, s[36:39], 0 offen offset:512 sc1
    buffer_store_dwordx4 v[48:51], v6, s[36:39], 0 offen offset:1024 sc1
    buffer_store_dwordx4 v[52:55], v6, s[36:39], 0 offen offset:1536 sc1
k4_end_92:
    s_endpgm
code_end:
    s_endpgm
.section .rodata,"a"
.p2align 6
.amdhsa_kernel k12_kernel
  .amdhsa_next_free_vgpr 512
  .amdhsa_next_free_sgpr 102
  .amdhsa_accum_offset 256
  .amdhsa_group_segment_fixed_size 0
  .amdhsa_kernarg_size 112
  .amdhsa_user_sgpr_count 2
  .amdhsa_user_sgpr_kernarg_segment_ptr 1
  .amdhsa_system_sgpr_workgroup_id_x 1
.end_amdhsa_kernel
.p2align 6
.amdhsa_kernel k3_kernel
  .amdhsa_next_free_vgpr 348
  .amdhsa_next_free_sgpr 102
  .amdhsa_accum_offset 156
  .amdhsa_group_segment_fixed_size 0
  .amdhsa_kernarg_size 112
  .amdhsa_user_sgpr_count 2
  .amdhsa_user_sgpr_kernarg_segment_ptr 1
  .amdhsa_system_sgpr_workgroup_id_x 1
.end_amdhsa_kernel
.p2align 6
.amdhsa_kernel k4_kernel
  .amdhsa_next_free_vgpr 232
  .amdhsa_next_free_sgpr 102
  .amdhsa_accum_offset 232
  .amdhsa_group_segment_fixed_size 0
  .amdhsa_kernarg_size 112
  .amdhsa_user_sgpr_count 2
  .amdhsa_user_sgpr_kernarg_segment_ptr 1
  .amdhsa_system_sgpr_workgroup_id_x 1
  .amdhsa_float_denorm_mode_32 3
.end_amdhsa_kernel
```

```asm
; @launch kernel=k12_kernel grid=(256,1,1) block=(256,1,1) lds=163840
; @launch kernel=k3_kernel grid=(256,1,1) block=(256,1,1) lds=65536
; @launch kernel=k4_kernel grid=(256,1,1) block=(512,1,1) lds=86272
.amdgcn_target "amdgcn-amd-amdhsa--gfx950"
.text
.globl k12_kernel
.p2align 8
.type k12_kernel,@function
k12_kernel:
    s_cmp_ge_u32 s2, 256
    s_cbranch_scc1 k12_end_1
    s_load_dwordx4 s[36:39], s[0:1], 0
    s_load_dwordx4 s[40:43], s[0:1], 24
    s_load_dwordx2 s[4:5], s[0:1], 16
    s_load_dwordx4 s[60:63], s[0:1], 96
    s_lshr_b32 s59, s2, 3
    s_lshl_b32 s58, s59, 4
    v_add_u32 v6, s58, v0
    v_cmp_gt_u32 vcc, 48, v0
    v_cmp_gt_u32 s[56:57], 64, v0
    s_nop 0
    v_cndmask_b32 v6, v6, v0, vcc
    s_getpc_b64 s[52:53]
pc_2:
    s_add_u32 s52, s52, k12_code0-pc_2
    s_addc_u32 s53, s53, 0
    v_lshlrev_b32 v58, 7, v6
    v_mov_b32 v59, s53
    v_add_co_u32 v58, vcc, s52, v58
    s_nop 1
    v_addc_co_u32 v59, vcc, 0, v59, vcc
k12_code0:
    s_mov_b64 exec, s[56:57]
    s_cbranch_execz k12_nocode_3
    global_load_dword v51, v[58:59], off
k12_nocode_3:
    s_mov_b64 exec, -1
    s_and_b32 s58, s2, 7
    s_lshr_b32 s59, s2, 3
    s_and_b32 s45, s59, 7
    s_lshr_b32 s57, s59, 3
    s_and_b32 s44, s57, 1
    s_lshl_b32 s52, s58, 1
    s_add_u32 s44, s44, s52
    s_lshr_b32 s57, s57, 1
    v_lshrrev_b32 v2, 6, v0
    v_and_b32 v3, 63, v0
    v_readfirstlane_b32 s30, v2
    v_lshlrev_b32 v1, 4, v3
    v_lshrrev_b32 v60, 5, v3
    v_lshl_add_u32 v60, v2, 1, v60
    v_and_b32 v61, 31, v3
    v_lshlrev_b32 v6, 11, v60
    v_lshl_add_u32 v62, v61, 4, v6
    s_lshl_b32 s52, s2, 14
    v_lshrrev_b32 v56, 3, v3
    v_and_b32 v57, 7, v3
    v_lshrrev_b32 v58, 1, v56
    v_xor_b32 v6, v57, v58
    v_xor_b32 v7, 4, v6
    v_lshl_add_u32 v58, v2, 6, v56
    v_lshlrev_b32 v58, 10, v58
    s_lshl_b32 s47, s45, 18
    v_add_u32 v58, s47, v58
    v_lshl_add_u32 v10, v6, 4, v58
    v_lshl_add_u32 v11, v7, 4, v58
    v_add_u32 v17, 54272, v11
    v_add_u32 v16, 47104, v10
    v_add_u32 v15, 39936, v11
    v_add_u32 v14, 32768, v10
    v_add_u32 v13, 21504, v11
    v_add_u32 v12, 14336, v10
    v_add_u32 v11, 7168, v11
    v_add_u32 v10, 0, v10
    v_lshrrev_b32 v6, 5, v3
    v_bfe_u32 v7, v3, 1, 4
    v_and_b32 v59, 1, v3
    v_lshl_add_u32 v58, v2, 4, v6
    v_lshlrev_b32 v58, 13, v58
    v_lshl_add_u32 v58, v59, 4, v58
    s_lshl_b32 s47, s44, 9
    v_add_u32 v58, s47, v58
    v_xor_b32 v7, v7, v6
    v_xor_b32 v6, 0, v7
    v_lshl_add_u32 v6, v6, 5, v58
    v_add_u32 v18, 0, v6
    v_xor_b32 v6, 2, v7
    v_lshl_add_u32 v6, v6, 5, v58
    v_add_u32 v19, 15360, v6
    v_xor_b32 v6, 0, v7
    v_lshl_add_u32 v6, v6, 5, v58
    v_add_u32 v20, 30720, v6
    v_xor_b32 v6, 2, v7
    v_lshl_add_u32 v6, v6, 5, v58
    v_add_u32 v21, 46080, v6
    v_xor_b32 v6, 4, v7
    v_lshl_add_u32 v6, v6, 5, v58
    v_add_u32 v22, 65536, v6
    v_xor_b32 v6, 6, v7
    v_lshl_add_u32 v6, v6, 5, v58
    v_add_u32 v23, 80896, v6
    v_xor_b32 v6, 4, v7
    v_lshl_add_u32 v6, v6, 5, v58
    v_add_u32 v24, 96256, v6
    v_xor_b32 v6, 6, v7
    v_lshl_add_u32 v6, v6, 5, v58
    v_add_u32 v25, 111616, v6
    s_lshl_b32 s48, s30, 13
    s_mov_b32 s49, 0
    s_mov_b32 s50, 0
    s_waitcnt lgkmcnt(0)
    s_mov_b32 s24, s36
    s_and_b32 s25, s37, 0xffff
    s_mov_b32 s26, 0x400000
    s_mov_b32 s27, 0x00020000
    buffer_load_dwordx4 v[64:67], v62, s[24:27], s52 offen offset:0
    buffer_load_dwordx4 v[68:71], v62, s[24:27], s52 offen offset:512
    buffer_load_dwordx4 v[72:75], v62, s[24:27], s52 offen offset:1024
    buffer_load_dwordx4 v[76:79], v62, s[24:27], s52 offen offset:1536
    s_mov_b32 s16, s38
    s_and_b32 s17, s39, 0xffff
    s_mov_b32 s18, 0x200000
    s_mov_b32 s19, 0x00020000
    s_cmp_eq_u32 s57, 0
    s_cselect_b32 s20, s40, s42
    s_cselect_b32 s21, s41, s43
    s_and_b32 s21, s21, 0xffff
    s_mov_b32 s22, 0x400000
    s_mov_b32 s23, 0x00020000
    s_add_u32 m0, s48, 0
    s_nop 0
    buffer_load_dwordx4 v10, s[16:19], s49 offen offset:0 lds
    buffer_load_dwordx4 v11, s[16:19], s49 offen offset:1024 lds
    buffer_load_dwordx4 v12, s[16:19], s49 offen offset:2048 lds
    buffer_load_dwordx4 v13, s[16:19], s49 offen offset:3072 lds
    s_add_u32 m0, s48, 65536
    s_nop 0
    buffer_load_dwordx4 v18, s[20:23], s50 offen offset:0 lds
    buffer_load_dwordx4 v19, s[20:23], s50 offen offset:1024 lds
    buffer_load_dwordx4 v20, s[20:23], s50 offen offset:2048 lds
    buffer_load_dwordx4 v21, s[20:23], s50 offen offset:3072 lds
    s_mov_b64 s[6:7], s[62:63]
    s_add_u32 s8, s6, 0x0
    s_addc_u32 s9, s7, 0
    s_and_b32 s9, s9, 0xffff
    s_mov_b32 s10, 0x400000
    s_mov_b32 s11, 0x00020000
    s_mov_b32 s12, s4
    s_and_b32 s13, s5, 0xffff
    s_mov_b32 s14, 0x800000
    s_mov_b32 s15, 0x00020000
    s_add_u32 s32, s6, 0x1000000
    s_addc_u32 s33, s7, 0
    s_and_b32 s33, s33, 0xffff
    s_mov_b32 s34, 0x2000000
    s_mov_b32 s35, 0x00020000
    s_mov_b32 s24, s60
    s_and_b32 s25, s61, 0xffff
    s_mov_b32 s26, 0x100
    s_mov_b32 s27, 0x00020000
    s_lshl_b32 s28, s58, 2
    s_and_b32 s31, s59, 3
    s_add_u32 s28, s28, s31
    s_lshr_b32 s29, s59, 2
    s_lshl_b32 s42, s29, 7
    s_sub_u32 s43, 1920, s42
    s_lshl_b32 s31, s30, 5
    s_add_u32 s38, s42, s31
    s_add_u32 s39, s43, s31
    s_lshl_b32 s60, s30, 12
    s_mov_b32 s61, 0
    s_mov_b32 s62, 0
    s_lshl_b32 s47, s44, 1
    s_lshr_b32 s52, s30, 1
    s_add_u32 s47, s47, s52
    s_lshl_b32 s47, s47, 14
    s_lshl_b32 s52, s45, 1
    s_and_b32 s53, s30, 1
    s_add_u32 s52, s52, s53
    s_lshl_b32 s52, s52, 20
    s_add_u32 s47, s47, s52
    s_lshl_b32 s52, s57, 24
    s_add_u32 s47, s47, s52
    s_lshl_b32 s54, s44, 8
    s_lshr_b32 s55, s28, 1
    s_lshl_b32 s55, s55, 8
    s_and_b32 s53, s59, 3
    s_add_u32 s53, s53, 1
    s_cmp_eq_u32 s30, 0
    s_cselect_b32 s53, s53, -1
    s_cselect_b32 s46, 6, -1
    v_lshlrev_b32 v6, 13, v56
    v_lshl_add_u32 v50, v57, 7, v6
    s_lshl_b32 s56, s30, 5
    s_add_u32 s56, s56, s59
    s_lshl_b32 s56, s56, 16
    s_lshl_b32 s52, s58, 10
    s_add_u32 s56, s56, s52
    s_lshl_b32 s63, s30, 1
    v_mul_u32_u24 v6, 2064, v60
    v_lshl_add_u32 v6, v61, 4, v6
    v_add_u32 v54, 131072, v6
    v_mul_u32_u24 v7, 2064, v57
    v_lshl_add_u32 v7, v56, 4, v7
    v_lshl_add_u32 v7, v2, 9, v7
    v_add_u32 v55, 131072, v7
    v_lshrrev_b32 v7, 2, v56
    v_lshl_add_u32 v7, v2, 3, v7
    v_lshlrev_b32 v7, 17, v7
    v_and_b32 v6, 3, v56
    v_lshl_add_u32 v7, v6, 8, v7
    v_lshl_add_u32 v7, v57, 4, v7
    s_lshr_b32 s52, s2, 1
    s_lshl_b32 s52, s52, 10
    s_and_b32 s31, s2, 1
    s_lshl_b32 s31, s31, 7
    s_add_u32 s52, s52, s31
    v_add_u32 v53, s52, v7
    v_and_b32 v56, 15, v3
    v_lshrrev_b32 v57, 4, v3
    v_lshrrev_b32 v6, 1, v56
    v_xor_b32 v6, v6, v57
    v_and_b32 v7, 1, v2
    v_lshl_add_u32 v7, v7, 7, v56
    v_lshlrev_b32 v7, 7, v7
    v_lshl_add_u32 v26, v6, 4, v7
    v_xor_b32 v27, 64, v26
    v_lshrrev_b32 v6, 2, v56
    v_and_b32 v58, 1, v57
    v_lshl_add_u32 v58, v58, 2, v6
    v_lshl_add_u32 v59, v57, 3, v6
    v_and_b32 v63, 3, v3
    v_lshlrev_b32 v7, 9, v59
    v_lshrrev_b32 v6, 1, v2
    v_lshl_add_u32 v7, v6, 8, v7
    v_lshl_add_u32 v7, v63, 3, v7
    v_add_u32 v7, 65536, v7
    v_lshlrev_b32 v59, 8, v59
    v_lshl_add_u32 v59, v63, 3, v59
    v_add_u32 v59, 98304, v59
    v_xor_b32 v6, 0, v58
    v_lshl_add_u32 v28, v6, 5, v7
    v_lshl_add_u32 v42, v6, 5, v59
    v_xor_b32 v6, 1, v58
    v_lshl_add_u32 v29, v6, 5, v7
    v_lshl_add_u32 v43, v6, 5, v59
    v_xor_b32 v6, 2, v58
    v_lshl_add_u32 v30, v6, 5, v7
    v_lshl_add_u32 v44, v6, 5, v59
    v_xor_b32 v6, 3, v58
    v_lshl_add_u32 v31, v6, 5, v7
    v_lshl_add_u32 v45, v6, 5, v59
    v_xor_b32 v6, 4, v58
    v_lshl_add_u32 v32, v6, 5, v7
    v_lshl_add_u32 v46, v6, 5, v59
    v_xor_b32 v6, 5, v58
    v_lshl_add_u32 v33, v6, 5, v7
    v_lshl_add_u32 v47, v6, 5, v59
    v_xor_b32 v6, 6, v58
    v_lshl_add_u32 v34, v6, 5, v7
    v_lshl_add_u32 v48, v6, 5, v59
    v_xor_b32 v6, 7, v58
    v_lshl_add_u32 v35, v6, 5, v7
    v_lshl_add_u32 v49, v6, 5, v59
    s_lshl_b32 s31, s38, 6
    v_add_u32 v36, s31, v1
    s_lshl_b32 s31, s39, 6
    v_add_u32 v37, s31, v1
    v_bfe_u32 v6, v3, 1, 3
    v_and_b32 v7, 1, v3
    v_lshl_add_u32 v58, v2, 4, v57
    v_lshlrev_b32 v58, 13, v58
    v_lshl_add_u32 v58, v7, 4, v58
    s_lshl_b32 s31, s28, 8
    v_add_u32 v58, s31, v58
    v_xor_b32 v6, v6, v57
    v_xor_b32 v7, 0, v6
    v_lshl_add_u32 v7, v7, 5, v58
    v_add_u32 v38, 0, v7
    v_xor_b32 v7, 0, v6
    v_lshl_add_u32 v7, v7, 5, v58
    v_add_u32 v39, 31744, v7
    v_xor_b32 v7, 4, v6
    v_lshl_add_u32 v7, v7, 5, v58
    v_add_u32 v40, 63488, v7
    v_xor_b32 v7, 4, v6
    v_lshl_add_u32 v7, v7, 5, v58
    v_add_u32 v41, 95232, v7
    v_lshlrev_b32 v6, 2, v57
    v_sub_u32 v4, v56, v6
    v_mov_b32 v5, 0xff800000
    v_mov_b32 v8, 0
    v_mov_b32 v9, 1
    s_lshl_b32 s52, s59, 2
    s_add_u32 s52, s52, s30
    v_and_b32 v6, 1, v3
    v_lshl_add_u32 v6, s52, 1, v6
    s_getpc_b64 s[40:41]
pc_4:
    s_add_u32 s40, s40, k12_qcode-pc_4
    s_addc_u32 s41, s41, 0
    v_lshlrev_b32 v2, 7, v6
    v_mov_b32 v3, s41
    v_add_co_u32 v2, vcc, s40, v2
    s_nop 1
    v_addc_co_u32 v3, vcc, 0, v3, vcc
    v_mov_b32 v56, 0
    v_mov_b32 v57, 0
    v_mov_b32 v58, 0
    v_mov_b32 v59, 0
    s_nop 1
    v_mfma_f32_32x32x16_bf16 a[128:143], v[56:59], v[56:59], 0
    v_mfma_f32_32x32x16_bf16 a[144:159], v[56:59], v[56:59], 0
    v_mfma_f32_32x32x16_bf16 a[160:175], v[56:59], v[56:59], 0
    v_mfma_f32_32x32x16_bf16 a[176:191], v[56:59], v[56:59], 0
    v_mfma_f32_32x32x16_bf16 v[128:143], v[56:59], v[56:59], 0
    v_mfma_f32_32x32x16_bf16 v[144:159], v[56:59], v[56:59], 0
    v_mfma_f32_32x32x16_bf16 v[160:175], v[56:59], v[56:59], 0
    v_mfma_f32_32x32x16_bf16 v[176:191], v[56:59], v[56:59], 0
    v_mfma_f32_32x32x16_bf16 v[192:207], v[56:59], v[56:59], 0
    v_mfma_f32_32x32x16_bf16 v[208:223], v[56:59], v[56:59], 0
    v_mfma_f32_32x32x16_bf16 v[224:239], v[56:59], v[56:59], 0
    v_mfma_f32_32x32x16_bf16 v[240:255], v[56:59], v[56:59], 0
    s_add_u32 m0, s48, 4096
    s_nop 0
    buffer_load_dwordx4 v14, s[16:19], s49 offen offset:0 lds
    buffer_load_dwordx4 v15, s[16:19], s49 offen offset:1024 lds
    buffer_load_dwordx4 v16, s[16:19], s49 offen offset:2048 lds
    buffer_load_dwordx4 v17, s[16:19], s49 offen offset:3072 lds
    s_add_u32 s49, s49, 128
    s_add_u32 m0, s48, 69632
    s_nop 0
    buffer_load_dwordx4 v22, s[20:23], s50 offen offset:0 lds
    buffer_load_dwordx4 v23, s[20:23], s50 offen offset:1024 lds
    buffer_load_dwordx4 v24, s[20:23], s50 offen offset:2048 lds
    buffer_load_dwordx4 v25, s[20:23], s50 offen offset:3072 lds
    s_add_u32 s50, s50, 0x80000
    s_waitcnt vmcnt(16)
    v_lshlrev_b32 v80, 16, v64
    v_and_b32 v81, 0xffff0000, v64
    v_lshlrev_b32 v82, 16, v65
    v_and_b32 v83, 0xffff0000, v65
    v_lshlrev_b32 v84, 16, v66
    v_and_b32 v85, 0xffff0000, v66
    v_lshlrev_b32 v86, 16, v67
    v_and_b32 v87, 0xffff0000, v67
    v_lshlrev_b32 v88, 16, v68
    v_and_b32 v89, 0xffff0000, v68
    v_lshlrev_b32 v90, 16, v69
    v_and_b32 v91, 0xffff0000, v69
    v_lshlrev_b32 v92, 16, v70
    v_and_b32 v93, 0xffff0000, v70
    v_lshlrev_b32 v94, 16, v71
    v_and_b32 v95, 0xffff0000, v71
    v_lshlrev_b32 v96, 16, v72
    v_and_b32 v97, 0xffff0000, v72
    v_lshlrev_b32 v98, 16, v73
    v_and_b32 v99, 0xffff0000, v73
    v_lshlrev_b32 v100, 16, v74
    v_and_b32 v101, 0xffff0000, v74
    v_lshlrev_b32 v102, 16, v75
    v_and_b32 v103, 0xffff0000, v75
    v_lshlrev_b32 v104, 16, v76
    v_and_b32 v105, 0xffff0000, v76
    v_lshlrev_b32 v106, 16, v77
    v_and_b32 v107, 0xffff0000, v77
    v_lshlrev_b32 v108, 16, v78
    v_and_b32 v109, 0xffff0000, v78
    v_lshlrev_b32 v110, 16, v79
    v_and_b32 v111, 0xffff0000, v79
    v_pk_add_f32 v[112:113], v[80:81], v[82:83]
    v_pk_add_f32 v[114:115], v[84:85], v[86:87]
    v_pk_add_f32 v[112:113], v[112:113], v[88:89]
    v_pk_add_f32 v[114:115], v[114:115], v[90:91]
    v_pk_add_f32 v[112:113], v[112:113], v[92:93]
    v_pk_add_f32 v[114:115], v[114:115], v[94:95]
    v_pk_add_f32 v[112:113], v[112:113], v[96:97]
    v_pk_add_f32 v[114:115], v[114:115], v[98:99]
    v_pk_add_f32 v[112:113], v[112:113], v[100:101]
    v_pk_add_f32 v[114:115], v[114:115], v[102:103]
    v_pk_add_f32 v[112:113], v[112:113], v[104:105]
    v_pk_add_f32 v[114:115], v[114:115], v[106:107]
    s_add_u32 m0, s48, 32768
    s_nop 0
    buffer_load_dwordx4 v10, s[16:19], s49 offen offset:0 lds
    buffer_load_dwordx4 v11, s[16:19], s49 offen offset:1024 lds
    buffer_load_dwordx4 v12, s[16:19], s49 offen offset:2048 lds
    buffer_load_dwordx4 v13, s[16:19], s49 offen offset:3072 lds
    v_pk_add_f32 v[112:113], v[112:113], v[108:109]
    v_pk_add_f32 v[114:115], v[114:115], v[110:111]
    v_pk_add_f32 v[112:113], v[112:113], v[114:115]
    v_add_f32 v112, v112, v113
    s_nop 1
    v_add_f32_dpp v112, v112, v112 quad_perm:[1,0,3,2] row_mask:0xf bank_mask:0xf
    s_nop 1
    v_add_f32_dpp v112, v112, v112 quad_perm:[2,3,0,1] row_mask:0xf bank_mask:0xf
    s_nop 1
    v_add_f32_dpp v112, v112, v112 row_half_mirror row_mask:0xf bank_mask:0xf
    s_nop 1
    v_add_f32_dpp v112, v112, v112 row_mirror row_mask:0xf bank_mask:0xf
    v_mov_b32 v114, v112
    s_nop 1
    v_permlane16_swap_b32 v112, v114
    s_nop 1
    v_add_f32 v112, v112, v114
    v_mul_f32 v112, 0xba800000, v112
    v_mov_b32 v113, v112
    v_pk_add_f32 v[114:115], v[80:81], v[112:113]
    v_pk_add_f32 v[118:119], v[82:83], v[112:113]
    v_pk_mul_f32 v[116:117], v[114:115], v[114:115]
    v_pk_fma_f32 v[116:117], v[118:119], v[118:119], v[116:117]
    v_pk_add_f32 v[114:115], v[84:85], v[112:113]
    v_pk_add_f32 v[118:119], v[86:87], v[112:113]
    v_pk_fma_f32 v[116:117], v[114:115], v[114:115], v[116:117]
    v_pk_fma_f32 v[116:117], v[118:119], v[118:119], v[116:117]
    v_pk_add_f32 v[114:115], v[88:89], v[112:113]
    v_pk_add_f32 v[118:119], v[90:91], v[112:113]
    v_pk_fma_f32 v[116:117], v[114:115], v[114:115], v[116:117]
    v_pk_fma_f32 v[116:117], v[118:119], v[118:119], v[116:117]
    v_pk_add_f32 v[114:115], v[92:93], v[112:113]
    v_pk_add_f32 v[118:119], v[94:95], v[112:113]
    v_pk_fma_f32 v[116:117], v[114:115], v[114:115], v[116:117]
    v_pk_fma_f32 v[116:117], v[118:119], v[118:119], v[116:117]
    v_pk_add_f32 v[114:115], v[96:97], v[112:113]
    v_pk_add_f32 v[118:119], v[98:99], v[112:113]
    v_pk_fma_f32 v[116:117], v[114:115], v[114:115], v[116:117]
    v_pk_fma_f32 v[116:117], v[118:119], v[118:119], v[116:117]
    v_pk_add_f32 v[114:115], v[100:101], v[112:113]
    v_pk_add_f32 v[118:119], v[102:103], v[112:113]
    v_pk_fma_f32 v[116:117], v[114:115], v[114:115], v[116:117]
    v_pk_fma_f32 v[116:117], v[118:119], v[118:119], v[116:117]
    v_pk_add_f32 v[114:115], v[104:105], v[112:113]
    s_add_u32 m0, s48, 98304
    s_nop 0
    buffer_load_dwordx4 v18, s[20:23], s50 offen offset:0 lds
    buffer_load_dwordx4 v19, s[20:23], s50 offen offset:1024 lds
    buffer_load_dwordx4 v20, s[20:23], s50 offen offset:2048 lds
    buffer_load_dwordx4 v21, s[20:23], s50 offen offset:3072 lds
    v_pk_add_f32 v[118:119], v[106:107], v[112:113]
    v_pk_fma_f32 v[116:117], v[114:115], v[114:115], v[116:117]
    v_pk_fma_f32 v[116:117], v[118:119], v[118:119], v[116:117]
    v_pk_add_f32 v[114:115], v[108:109], v[112:113]
    v_pk_add_f32 v[118:119], v[110:111], v[112:113]
    v_pk_fma_f32 v[116:117], v[114:115], v[114:115], v[116:117]
    v_pk_fma_f32 v[116:117], v[118:119], v[118:119], v[116:117]
    v_add_f32 v116, v116, v117
    s_nop 1
    v_add_f32_dpp v116, v116, v116 quad_perm:[1,0,3,2] row_mask:0xf bank_mask:0xf
    s_nop 1
    v_add_f32_dpp v116, v116, v116 quad_perm:[2,3,0,1] row_mask:0xf bank_mask:0xf
    s_nop 1
    v_add_f32_dpp v116, v116, v116 row_half_mirror row_mask:0xf bank_mask:0xf
    s_nop 1
    v_add_f32_dpp v116, v116, v116 row_mirror row_mask:0xf bank_mask:0xf
    v_mov_b32 v114, v116
    s_nop 1
    v_permlane16_swap_b32 v116, v114
    s_nop 1
    v_add_f32 v116, v116, v114
    v_mul_f32 v116, 0x3a800000, v116
    v_cvt_pk_bf16_f32 v118, v112, v116
    v_and_b32 v116, 0xffff0000, v118
    v_lshlrev_b32 v118, 16, v118
    v_add_f32 v116, 0x3727c5ac, v116
    v_mov_b32 v119, v118
    v_cvt_pk_bf16_f32 v116, v116, v116
    v_and_b32 v116, 0xffff0000, v116
    v_sqrt_f32 v116, v116
    v_pk_add_f32 v[80:81], v[80:81], v[118:119]
    v_pk_add_f32 v[82:83], v[82:83], v[118:119]
    v_pk_add_f32 v[84:85], v[84:85], v[118:119]
    v_pk_add_f32 v[86:87], v[86:87], v[118:119]
    v_pk_add_f32 v[88:89], v[88:89], v[118:119]
    v_pk_add_f32 v[90:91], v[90:91], v[118:119]
    v_pk_add_f32 v[92:93], v[92:93], v[118:119]
    v_pk_add_f32 v[94:95], v[94:95], v[118:119]
    v_pk_add_f32 v[96:97], v[96:97], v[118:119]
    v_pk_add_f32 v[98:99], v[98:99], v[118:119]
    v_pk_add_f32 v[100:101], v[100:101], v[118:119]
    v_pk_add_f32 v[102:103], v[102:103], v[118:119]
    v_pk_add_f32 v[104:105], v[104:105], v[118:119]
    s_add_u32 m0, s48, 36864
    s_nop 0
    buffer_load_dwordx4 v14, s[16:19], s49 offen offset:0 lds
    buffer_load_dwordx4 v15, s[16:19], s49 offen offset:1024 lds
    buffer_load_dwordx4 v16, s[16:19], s49 offen offset:2048 lds
    buffer_load_dwordx4 v17, s[16:19], s49 offen offset:3072 lds
    s_add_u32 s49, s49, 128
    v_pk_add_f32 v[106:107], v[106:107], v[118:119]
    v_pk_add_f32 v[108:109], v[108:109], v[118:119]
    v_pk_add_f32 v[110:111], v[110:111], v[118:119]
    v_cvt_pk_bf16_f32 v116, v116, v116
    v_and_b32 v116, 0xffff0000, v116
    v_rcp_f32 v116, v116
    v_cvt_pk_bf16_f32 v64, v80, v81
    v_cvt_pk_bf16_f32 v65, v82, v83
    v_cvt_pk_bf16_f32 v66, v84, v85
    v_cvt_pk_bf16_f32 v67, v86, v87
    v_cvt_pk_bf16_f32 v68, v88, v89
    v_cvt_pk_bf16_f32 v69, v90, v91
    v_cvt_pk_bf16_f32 v70, v92, v93
    v_cvt_pk_bf16_f32 v71, v94, v95
    v_cvt_pk_bf16_f32 v72, v96, v97
    v_cvt_pk_bf16_f32 v73, v98, v99
    v_cvt_pk_bf16_f32 v74, v100, v101
    v_cvt_pk_bf16_f32 v75, v102, v103
    v_cvt_pk_bf16_f32 v76, v104, v105
    v_cvt_pk_bf16_f32 v77, v106, v107
    v_cvt_pk_bf16_f32 v78, v108, v109
    v_cvt_pk_bf16_f32 v79, v110, v111
    v_mov_b32 v117, v116
    v_lshlrev_b32 v80, 16, v64
    v_and_b32 v81, 0xffff0000, v64
    v_lshlrev_b32 v82, 16, v65
    v_and_b32 v83, 0xffff0000, v65
    v_lshlrev_b32 v84, 16, v66
    v_and_b32 v85, 0xffff0000, v66
    v_lshlrev_b32 v86, 16, v67
    v_and_b32 v87, 0xffff0000, v67
    v_lshlrev_b32 v88, 16, v68
    v_and_b32 v89, 0xffff0000, v68
    v_lshlrev_b32 v90, 16, v69
    v_and_b32 v91, 0xffff0000, v69
    v_lshlrev_b32 v92, 16, v70
    v_and_b32 v93, 0xffff0000, v70
    v_lshlrev_b32 v94, 16, v71
    v_and_b32 v95, 0xffff0000, v71
    v_lshlrev_b32 v96, 16, v72
    v_and_b32 v97, 0xffff0000, v72
    v_lshlrev_b32 v98, 16, v73
    v_and_b32 v99, 0xffff0000, v73
    v_lshlrev_b32 v100, 16, v74
    s_add_u32 m0, s48, 102400
    s_nop 0
    buffer_load_dwordx4 v22, s[20:23], s50 offen offset:0 lds
    buffer_load_dwordx4 v23, s[20:23], s50 offen offset:1024 lds
    buffer_load_dwordx4 v24, s[20:23], s50 offen offset:2048 lds
    buffer_load_dwordx4 v25, s[20:23], s50 offen offset:3072 lds
    s_add_u32 s50, s50, 0x80000
    v_and_b32 v101, 0xffff0000, v74
    v_lshlrev_b32 v102, 16, v75
    v_and_b32 v103, 0xffff0000, v75
    v_lshlrev_b32 v104, 16, v76
    v_and_b32 v105, 0xffff0000, v76
    v_lshlrev_b32 v106, 16, v77
    v_and_b32 v107, 0xffff0000, v77
    v_lshlrev_b32 v108, 16, v78
    v_and_b32 v109, 0xffff0000, v78
    v_lshlrev_b32 v110, 16, v79
    v_and_b32 v111, 0xffff0000, v79
    v_pk_mul_f32 v[80:81], v[80:81], v[116:117]
    v_pk_mul_f32 v[82:83], v[82:83], v[116:117]
    v_pk_mul_f32 v[84:85], v[84:85], v[116:117]
    v_pk_mul_f32 v[86:87], v[86:87], v[116:117]
    v_pk_mul_f32 v[88:89], v[88:89], v[116:117]
    v_pk_mul_f32 v[90:91], v[90:91], v[116:117]
    v_pk_mul_f32 v[92:93], v[92:93], v[116:117]
    v_pk_mul_f32 v[94:95], v[94:95], v[116:117]
    v_pk_mul_f32 v[96:97], v[96:97], v[116:117]
    v_pk_mul_f32 v[98:99], v[98:99], v[116:117]
    v_pk_mul_f32 v[100:101], v[100:101], v[116:117]
    v_pk_mul_f32 v[102:103], v[102:103], v[116:117]
    v_pk_mul_f32 v[104:105], v[104:105], v[116:117]
    v_pk_mul_f32 v[106:107], v[106:107], v[116:117]
    v_pk_mul_f32 v[108:109], v[108:109], v[116:117]
    v_pk_mul_f32 v[110:111], v[110:111], v[116:117]
    v_cvt_pk_bf16_f32 v64, v80, v81
    v_cvt_pk_bf16_f32 v65, v82, v83
    v_cvt_pk_bf16_f32 v66, v84, v85
    v_cvt_pk_bf16_f32 v67, v86, v87
    v_cvt_pk_bf16_f32 v68, v88, v89
    v_cvt_pk_bf16_f32 v69, v90, v91
    v_cvt_pk_bf16_f32 v70, v92, v93
    v_cvt_pk_bf16_f32 v71, v94, v95
    v_cvt_pk_bf16_f32 v72, v96, v97
    v_cvt_pk_bf16_f32 v73, v98, v99
    v_cvt_pk_bf16_f32 v74, v100, v101
    v_cvt_pk_bf16_f32 v75, v102, v103
    v_cvt_pk_bf16_f32 v76, v104, v105
    v_cvt_pk_bf16_f32 v77, v106, v107
    v_cvt_pk_bf16_f32 v78, v108, v109
    v_cvt_pk_bf16_f32 v79, v110, v111
    ds_write_b128 v54, v[64:67] offset:0
    ds_write_b128 v54, v[68:71] offset:512
    ds_write_b128 v54, v[72:75] offset:1024
    ds_write_b128 v54, v[76:79] offset:1536
    s_waitcnt vmcnt(16) lgkmcnt(0)
    s_barrier
    ds_read_b128 a[192:195], v55 offset:0
    ds_read_b128 a[196:199], v55 offset:128
    ds_read_b128 a[200:203], v55 offset:256
    ds_read_b128 a[204:207], v55 offset:384
    v_mfma_f32_32x32x16_bf16 v[64:79], v[56:59], v[56:59], 0
    v_mfma_f32_32x32x16_bf16 v[80:95], v[56:59], v[56:59], 0
    v_mfma_f32_32x32x16_bf16 v[96:111], v[56:59], v[56:59], 0
    v_mfma_f32_32x32x16_bf16 v[112:127], v[56:59], v[56:59], 0
    s_cmp_ge_u32 s2, 17
    s_cbranch_scc1 k12_nostat_5
    s_lshl_b32 s52, s2, 12
    s_add_u32 s52, s52, 0x3800000
    s_mov_b32 s34, -1
    v_lshlrev_b32 v6, 4, v0
    buffer_store_dwordx4 v[56:59], v6, s[32:35], s52 offen sc1
    s_mov_b32 s34, 0x2000000
k12_nostat_5:
    ds_read_b128 a[0:3], v26 offset:0
    ds_read_b64_tr_b16 a[32:33], v28 offset:0
    ds_read_b64_tr_b16 a[34:35], v28 offset:2048
    ds_read_b128 a[4:7], v26 offset:2048
    ds_read_b64_tr_b16 a[36:37], v29 offset:0
    ds_read_b64_tr_b16 a[38:39], v29 offset:2048
    ds_read_b128 a[8:11], v26 offset:4096
    ds_read_b64_tr_b16 a[40:41], v30 offset:0
    ds_read_b64_tr_b16 a[42:43], v30 offset:2048
    ds_read_b128 a[12:15], v26 offset:6144
    ds_read_b64_tr_b16 a[44:45], v31 offset:0
    ds_read_b64_tr_b16 a[46:47], v31 offset:2048
    ds_read_b128 a[16:19], v26 offset:8192
    ds_read_b64_tr_b16 a[48:49], v32 offset:0
    ds_read_b64_tr_b16 a[50:51], v32 offset:2048
    ds_read_b128 a[20:23], v26 offset:10240
    ds_read_b64_tr_b16 a[52:53], v33 offset:0
    ds_read_b64_tr_b16 a[54:55], v33 offset:2048
    ds_read_b128 a[24:27], v26 offset:12288
    ds_read_b64_tr_b16 a[56:57], v34 offset:0
    ds_read_b64_tr_b16 a[58:59], v34 offset:2048
    ds_read_b128 a[28:31], v26 offset:14336
    ds_read_b64_tr_b16 a[60:61], v35 offset:0
    ds_read_b64_tr_b16 a[62:63], v35 offset:2048
    s_mov_b32 s51, 0
    s_waitcnt lgkmcnt(15)
    s_mov_b32 s52, 0
    buffer_store_dwordx4 a[192:195], v53, s[8:11], s52 offen sc1
    s_mov_b32 s52, 262144
    buffer_store_dwordx4 a[196:199], v53, s[8:11], s52 offen sc1
    s_mov_b32 s52, 524288
    buffer_store_dwordx4 a[200:203], v53, s[8:11], s52 offen sc1
    s_mov_b32 s52, 786432
    buffer_store_dwordx4 a[204:207], v53, s[8:11], s52 offen sc1
    s_waitcnt lgkmcnt(0)
    s_cmp_lg_u32 s57, 0
    s_cbranch_scc1 k12_v_6
k12_loop_8:
    v_mfma_f32_16x16x32_bf16 v[64:67], a[32:35], a[0:3], v[64:67]
    ds_read_b128 a[64:67], v27 offset:0
    v_mfma_f32_16x16x32_bf16 v[80:83], a[32:35], a[4:7], v[80:83]
    ds_read_b64_tr_b16 a[96:97], v28 offset:16384
    v_mfma_f32_16x16x32_bf16 v[96:99], a[32:35], a[8:11], v[96:99]
    v_mfma_f32_16x16x32_bf16 v[112:115], a[32:35], a[12:15], v[112:115]
    s_cmp_eq_u32 s51, s46
    s_cbranch_scc1 k12_ool_10
k12_oolret_11:
    v_mfma_f32_16x16x32_bf16 v[128:131], a[32:35], a[16:19], v[128:131]
    ds_read_b64_tr_b16 a[98:99], v28 offset:18432
    v_mfma_f32_16x16x32_bf16 v[144:147], a[32:35], a[20:23], v[144:147]
    ds_read_b128 a[68:71], v27 offset:2048
    v_mfma_f32_16x16x32_bf16 a[128:131], a[32:35], a[24:27], a[128:131]
    v_mfma_f32_16x16x32_bf16 a[160:163], a[32:35], a[28:31], a[160:163]
    ds_read_b64_tr_b16 a[100:101], v29 offset:16384
    v_mfma_f32_16x16x32_bf16 v[160:163], a[36:39], a[0:3], v[160:163]
    v_mfma_f32_16x16x32_bf16 v[176:179], a[36:39], a[4:7], v[176:179]
    ds_read_b64_tr_b16 a[102:103], v29 offset:18432
    v_mfma_f32_16x16x32_bf16 v[192:195], a[36:39], a[8:11], v[192:195]
    v_mfma_f32_16x16x32_bf16 v[208:211], a[36:39], a[12:15], v[208:211]
    ds_read_b128 a[72:75], v27 offset:4096
    v_mfma_f32_16x16x32_bf16 v[224:227], a[36:39], a[16:19], v[224:227]
    v_mfma_f32_16x16x32_bf16 v[240:243], a[36:39], a[20:23], v[240:243]
    v_mfma_f32_16x16x32_bf16 a[132:135], a[36:39], a[24:27], a[132:135]
    ds_read_b64_tr_b16 a[104:105], v30 offset:16384
    v_mfma_f32_16x16x32_bf16 a[164:167], a[36:39], a[28:31], a[164:167]
    v_mfma_f32_16x16x32_bf16 v[68:71], a[40:43], a[0:3], v[68:71]
    ds_read_b64_tr_b16 a[106:107], v30 offset:18432
    v_mfma_f32_16x16x32_bf16 v[84:87], a[40:43], a[4:7], v[84:87]
    v_mfma_f32_16x16x32_bf16 v[100:103], a[40:43], a[8:11], v[100:103]
    ds_read_b128 a[76:79], v27 offset:6144
    v_mfma_f32_16x16x32_bf16 v[116:119], a[40:43], a[12:15], v[116:119]
    v_mfma_f32_16x16x32_bf16 v[132:135], a[40:43], a[16:19], v[132:135]
    ds_read_b64_tr_b16 a[108:109], v31 offset:16384
    v_mfma_f32_16x16x32_bf16 v[148:151], a[40:43], a[20:23], v[148:151]
    v_mfma_f32_16x16x32_bf16 a[136:139], a[40:43], a[24:27], a[136:139]
    ds_read_b64_tr_b16 a[110:111], v31 offset:18432
    v_mfma_f32_16x16x32_bf16 a[168:171], a[40:43], a[28:31], a[168:171]
    v_mfma_f32_16x16x32_bf16 v[164:167], a[44:47], a[0:3], v[164:167]
    ds_read_b128 a[80:83], v27 offset:8192
    v_mfma_f32_16x16x32_bf16 v[180:183], a[44:47], a[4:7], v[180:183]
    v_mfma_f32_16x16x32_bf16 v[196:199], a[44:47], a[8:11], v[196:199]
    ds_read_b64_tr_b16 a[112:113], v32 offset:16384
    v_mfma_f32_16x16x32_bf16 v[212:215], a[44:47], a[12:15], v[212:215]
    v_mfma_f32_16x16x32_bf16 v[228:231], a[44:47], a[16:19], v[228:231]
    ds_read_b64_tr_b16 a[114:115], v32 offset:18432
    v_mfma_f32_16x16x32_bf16 v[244:247], a[44:47], a[20:23], v[244:247]
    v_mfma_f32_16x16x32_bf16 a[140:143], a[44:47], a[24:27], a[140:143]
    ds_read_b128 a[84:87], v27 offset:10240
    v_mfma_f32_16x16x32_bf16 a[172:175], a[44:47], a[28:31], a[172:175]
    v_mfma_f32_16x16x32_bf16 v[72:75], a[48:51], a[0:3], v[72:75]
    ds_read_b64_tr_b16 a[116:117], v33 offset:16384
    v_mfma_f32_16x16x32_bf16 v[88:91], a[48:51], a[4:7], v[88:91]
    v_mfma_f32_16x16x32_bf16 v[104:107], a[48:51], a[8:11], v[104:107]
    ds_read_b64_tr_b16 a[118:119], v33 offset:18432
    v_mfma_f32_16x16x32_bf16 v[120:123], a[48:51], a[12:15], v[120:123]
    v_mfma_f32_16x16x32_bf16 v[136:139], a[48:51], a[16:19], v[136:139]
    ds_read_b128 a[88:91], v27 offset:12288
    v_mfma_f32_16x16x32_bf16 v[152:155], a[48:51], a[20:23], v[152:155]
    v_mfma_f32_16x16x32_bf16 a[144:147], a[48:51], a[24:27], a[144:147]
    v_mfma_f32_16x16x32_bf16 a[176:179], a[48:51], a[28:31], a[176:179]
    ds_read_b64_tr_b16 a[120:121], v34 offset:16384
    v_mfma_f32_16x16x32_bf16 v[168:171], a[52:55], a[0:3], v[168:171]
    v_mfma_f32_16x16x32_bf16 v[184:187], a[52:55], a[4:7], v[184:187]
    ds_read_b64_tr_b16 a[122:123], v34 offset:18432
    v_mfma_f32_16x16x32_bf16 v[200:203], a[52:55], a[8:11], v[200:203]
    v_mfma_f32_16x16x32_bf16 v[216:219], a[52:55], a[12:15], v[216:219]
    ds_read_b128 a[92:95], v27 offset:14336
    v_mfma_f32_16x16x32_bf16 v[232:235], a[52:55], a[16:19], v[232:235]
    v_mfma_f32_16x16x32_bf16 v[248:251], a[52:55], a[20:23], v[248:251]
    ds_read_b64_tr_b16 a[124:125], v35 offset:16384
    v_mfma_f32_16x16x32_bf16 a[148:151], a[52:55], a[24:27], a[148:151]
    v_mfma_f32_16x16x32_bf16 a[180:183], a[52:55], a[28:31], a[180:183]
    ds_read_b64_tr_b16 a[126:127], v35 offset:18432
    v_mfma_f32_16x16x32_bf16 v[76:79], a[56:59], a[0:3], v[76:79]
    v_mfma_f32_16x16x32_bf16 v[92:95], a[56:59], a[4:7], v[92:95]
    v_mfma_f32_16x16x32_bf16 v[108:111], a[56:59], a[8:11], v[108:111]
    v_mfma_f32_16x16x32_bf16 v[124:127], a[56:59], a[12:15], v[124:127]
    v_mfma_f32_16x16x32_bf16 v[140:143], a[56:59], a[16:19], v[140:143]
    v_mfma_f32_16x16x32_bf16 v[156:159], a[56:59], a[20:23], v[156:159]
    v_mfma_f32_16x16x32_bf16 a[152:155], a[56:59], a[24:27], a[152:155]
    v_mfma_f32_16x16x32_bf16 a[184:187], a[56:59], a[28:31], a[184:187]
    v_mfma_f32_16x16x32_bf16 v[172:175], a[60:63], a[0:3], v[172:175]
    v_mfma_f32_16x16x32_bf16 v[188:191], a[60:63], a[4:7], v[188:191]
    v_mfma_f32_16x16x32_bf16 v[204:207], a[60:63], a[8:11], v[204:207]
    v_mfma_f32_16x16x32_bf16 v[220:223], a[60:63], a[12:15], v[220:223]
    v_mfma_f32_16x16x32_bf16 v[236:239], a[60:63], a[16:19], v[236:239]
    v_mfma_f32_16x16x32_bf16 v[252:255], a[60:63], a[20:23], v[252:255]
    v_mfma_f32_16x16x32_bf16 a[156:159], a[60:63], a[24:27], a[156:159]
    v_mfma_f32_16x16x32_bf16 a[188:191], a[60:63], a[28:31], a[188:191]
    s_waitcnt vmcnt(0) lgkmcnt(0)
    s_barrier
    v_mfma_f32_16x16x32_bf16 v[64:67], a[96:99], a[64:67], v[64:67]
    s_cmp_ge_u32 s49, 1024
    s_cselect_b32 s18, 0, s18
    s_cselect_b32 s22, 0, s22
    ds_read_b128 a[0:3], v26 offset:32768
    v_mfma_f32_16x16x32_bf16 v[80:83], a[96:99], a[68:71], v[80:83]
    s_add_u32 m0, s48, 0
    ds_read_b64_tr_b16 a[32:33], v28 offset:32768
    v_mfma_f32_16x16x32_bf16 v[96:99], a[96:99], a[72:75], v[96:99]
    buffer_load_dwordx4 v10, s[16:19], s49 offen offset:0 lds
    v_mfma_f32_16x16x32_bf16 v[112:115], a[96:99], a[76:79], v[112:115]
    ds_read_b64_tr_b16 a[34:35], v28 offset:34816
    v_mfma_f32_16x16x32_bf16 v[128:131], a[96:99], a[80:83], v[128:131]
    buffer_load_dwordx4 v11, s[16:19], s49 offen offset:1024 lds
    v_mfma_f32_16x16x32_bf16 v[144:147], a[96:99], a[84:87], v[144:147]
    ds_read_b128 a[4:7], v26 offset:34816
    v_mfma_f32_16x16x32_bf16 a[128:131], a[96:99], a[88:91], a[128:131]
    v_mfma_f32_16x16x32_bf16 a[160:163], a[96:99], a[92:95], a[160:163]
    ds_read_b64_tr_b16 a[36:37], v29 offset:32768
    v_mfma_f32_16x16x32_bf16 v[160:163], a[100:103], a[64:67], v[160:163]
    buffer_load_dwordx4 v12, s[16:19], s49 offen offset:2048 lds
    v_mfma_f32_16x16x32_bf16 v[176:179], a[100:103], a[68:71], v[176:179]
    ds_read_b64_tr_b16 a[38:39], v29 offset:34816
    v_mfma_f32_16x16x32_bf16 v[192:195], a[100:103], a[72:75], v[192:195]
    v_mfma_f32_16x16x32_bf16 v[208:211], a[100:103], a[76:79], v[208:211]
    buffer_load_dwordx4 v13, s[16:19], s49 offen offset:3072 lds
    ds_read_b128 a[8:11], v26 offset:36864
    v_mfma_f32_16x16x32_bf16 v[224:227], a[100:103], a[80:83], v[224:227]
    v_mfma_f32_16x16x32_bf16 v[240:243], a[100:103], a[84:87], v[240:243]
    s_add_u32 m0, s48, 4096
    v_mfma_f32_16x16x32_bf16 a[132:135], a[100:103], a[88:91], a[132:135]
    ds_read_b64_tr_b16 a[40:41], v30 offset:32768
    v_mfma_f32_16x16x32_bf16 a[164:167], a[100:103], a[92:95], a[164:167]
    buffer_load_dwordx4 v14, s[16:19], s49 offen offset:0 lds
    v_mfma_f32_16x16x32_bf16 v[68:71], a[104:107], a[64:67], v[68:71]
    ds_read_b64_tr_b16 a[42:43], v30 offset:34816
    v_mfma_f32_16x16x32_bf16 v[84:87], a[104:107], a[68:71], v[84:87]
    v_mfma_f32_16x16x32_bf16 v[100:103], a[104:107], a[72:75], v[100:103]
    buffer_load_dwordx4 v15, s[16:19], s49 offen offset:1024 lds
    ds_read_b128 a[12:15], v26 offset:38912
    v_mfma_f32_16x16x32_bf16 v[116:119], a[104:107], a[76:79], v[116:119]
    v_mfma_f32_16x16x32_bf16 v[132:135], a[104:107], a[80:83], v[132:135]
    ds_read_b64_tr_b16 a[44:45], v31 offset:32768
    v_mfma_f32_16x16x32_bf16 v[148:151], a[104:107], a[84:87], v[148:151]
    v_mfma_f32_16x16x32_bf16 a[136:139], a[104:107], a[88:91], a[136:139]
    buffer_load_dwordx4 v16, s[16:19], s49 offen offset:2048 lds
    ds_read_b64_tr_b16 a[46:47], v31 offset:34816
    v_mfma_f32_16x16x32_bf16 a[168:171], a[104:107], a[92:95], a[168:171]
    v_mfma_f32_16x16x32_bf16 v[164:167], a[108:111], a[64:67], v[164:167]
    ds_read_b128 a[16:19], v26 offset:40960
    v_mfma_f32_16x16x32_bf16 v[180:183], a[108:111], a[68:71], v[180:183]
    buffer_load_dwordx4 v17, s[16:19], s49 offen offset:3072 lds
    v_mfma_f32_16x16x32_bf16 v[196:199], a[108:111], a[72:75], v[196:199]
    ds_read_b64_tr_b16 a[48:49], v32 offset:32768
    v_mfma_f32_16x16x32_bf16 v[212:215], a[108:111], a[76:79], v[212:215]
    s_add_u32 s49, s49, 128
    v_mfma_f32_16x16x32_bf16 v[228:231], a[108:111], a[80:83], v[228:231]
    s_add_u32 m0, s48, 65536
    ds_read_b64_tr_b16 a[50:51], v32 offset:34816
    v_mfma_f32_16x16x32_bf16 v[244:247], a[108:111], a[84:87], v[244:247]
    buffer_load_dwordx4 v18, s[20:23], s50 offen offset:0 lds
    v_mfma_f32_16x16x32_bf16 a[140:143], a[108:111], a[88:91], a[140:143]
    ds_read_b128 a[20:23], v26 offset:43008
    v_mfma_f32_16x16x32_bf16 a[172:175], a[108:111], a[92:95], a[172:175]
    v_mfma_f32_16x16x32_bf16 v[72:75], a[112:115], a[64:67], v[72:75]
    buffer_load_dwordx4 v19, s[20:23], s50 offen offset:1024 lds
    ds_read_b64_tr_b16 a[52:53], v33 offset:32768
    v_mfma_f32_16x16x32_bf16 v[88:91], a[112:115], a[68:71], v[88:91]
    v_mfma_f32_16x16x32_bf16 v[104:107], a[112:115], a[72:75], v[104:107]
    ds_read_b64_tr_b16 a[54:55], v33 offset:34816
    v_mfma_f32_16x16x32_bf16 v[120:123], a[112:115], a[76:79], v[120:123]
    buffer_load_dwordx4 v20, s[20:23], s50 offen offset:2048 lds
    v_mfma_f32_16x16x32_bf16 v[136:139], a[112:115], a[80:83], v[136:139]
    ds_read_b128 a[24:27], v26 offset:45056
    v_mfma_f32_16x16x32_bf16 v[152:155], a[112:115], a[84:87], v[152:155]
    v_mfma_f32_16x16x32_bf16 a[144:147], a[112:115], a[88:91], a[144:147]
    v_mfma_f32_16x16x32_bf16 a[176:179], a[112:115], a[92:95], a[176:179]
    buffer_load_dwordx4 v21, s[20:23], s50 offen offset:3072 lds
    ds_read_b64_tr_b16 a[56:57], v34 offset:32768
    v_mfma_f32_16x16x32_bf16 v[168:171], a[116:119], a[64:67], v[168:171]
    s_add_u32 m0, s48, 69632
    v_mfma_f32_16x16x32_bf16 v[184:187], a[116:119], a[68:71], v[184:187]
    ds_read_b64_tr_b16 a[58:59], v34 offset:34816
    v_mfma_f32_16x16x32_bf16 v[200:203], a[116:119], a[72:75], v[200:203]
    buffer_load_dwordx4 v22, s[20:23], s50 offen offset:0 lds
    v_mfma_f32_16x16x32_bf16 v[216:219], a[116:119], a[76:79], v[216:219]
    ds_read_b128 a[28:31], v26 offset:47104
    v_mfma_f32_16x16x32_bf16 v[232:235], a[116:119], a[80:83], v[232:235]
    v_mfma_f32_16x16x32_bf16 v[248:251], a[116:119], a[84:87], v[248:251]
    ds_read_b64_tr_b16 a[60:61], v35 offset:32768
    v_mfma_f32_16x16x32_bf16 a[148:151], a[116:119], a[88:91], a[148:151]
    buffer_load_dwordx4 v23, s[20:23], s50 offen offset:1024 lds
    v_mfma_f32_16x16x32_bf16 a[180:183], a[116:119], a[92:95], a[180:183]
    ds_read_b64_tr_b16 a[62:63], v35 offset:34816
    v_mfma_f32_16x16x32_bf16 v[76:79], a[120:123], a[64:67], v[76:79]
    v_mfma_f32_16x16x32_bf16 v[92:95], a[120:123], a[68:71], v[92:95]
    buffer_load_dwordx4 v24, s[20:23], s50 offen offset:2048 lds
    v_mfma_f32_16x16x32_bf16 v[108:111], a[120:123], a[72:75], v[108:111]
    v_mfma_f32_16x16x32_bf16 v[124:127], a[120:123], a[76:79], v[124:127]
    v_mfma_f32_16x16x32_bf16 v[140:143], a[120:123], a[80:83], v[140:143]
    v_mfma_f32_16x16x32_bf16 v[156:159], a[120:123], a[84:87], v[156:159]
    buffer_load_dwordx4 v25, s[20:23], s50 offen offset:3072 lds
    v_mfma_f32_16x16x32_bf16 a[152:155], a[120:123], a[88:91], a[152:155]
    v_mfma_f32_16x16x32_bf16 a[184:187], a[120:123], a[92:95], a[184:187]
    s_add_u32 s50, s50, 0x80000
    v_mfma_f32_16x16x32_bf16 v[172:175], a[124:127], a[64:67], v[172:175]
    v_mfma_f32_16x16x32_bf16 v[188:191], a[124:127], a[68:71], v[188:191]
    s_cmp_eq_u32 s51, s53
    s_cbranch_scc1 k12_ool_12
k12_oolret_13:
    v_mfma_f32_16x16x32_bf16 v[204:207], a[124:127], a[72:75], v[204:207]
    v_mfma_f32_16x16x32_bf16 v[220:223], a[124:127], a[76:79], v[220:223]
    s_cmp_eq_u32 s51, s63
    s_cbranch_scc1 k12_ool_14
k12_oolret_15:
    v_mfma_f32_16x16x32_bf16 v[236:239], a[124:127], a[80:83], v[236:239]
    v_mfma_f32_16x16x32_bf16 v[252:255], a[124:127], a[84:87], v[252:255]
    s_add_u32 s51, s51, 1
    v_mfma_f32_16x16x32_bf16 a[156:159], a[124:127], a[88:91], a[156:159]
    v_mfma_f32_16x16x32_bf16 a[188:191], a[124:127], a[92:95], a[188:191]
    s_waitcnt lgkmcnt(0)
    v_mfma_f32_16x16x32_bf16 v[64:67], a[32:35], a[0:3], v[64:67]
    ds_read_b128 a[64:67], v27 offset:32768
    v_mfma_f32_16x16x32_bf16 v[80:83], a[32:35], a[4:7], v[80:83]
    ds_read_b64_tr_b16 a[96:97], v28 offset:49152
    v_mfma_f32_16x16x32_bf16 v[96:99], a[32:35], a[8:11], v[96:99]
    v_mfma_f32_16x16x32_bf16 v[112:115], a[32:35], a[12:15], v[112:115]
    ds_read_b64_tr_b16 a[98:99], v28 offset:51200
    v_mfma_f32_16x16x32_bf16 v[128:131], a[32:35], a[16:19], v[128:131]
    v_mfma_f32_16x16x32_bf16 v[144:147], a[32:35], a[20:23], v[144:147]
    ds_read_b128 a[68:71], v27 offset:34816
    v_mfma_f32_16x16x32_bf16 a[128:131], a[32:35], a[24:27], a[128:131]
    v_mfma_f32_16x16x32_bf16 a[160:163], a[32:35], a[28:31], a[160:163]
    ds_read_b64_tr_b16 a[100:101], v29 offset:49152
    v_mfma_f32_16x16x32_bf16 v[160:163], a[36:39], a[0:3], v[160:163]
    v_mfma_f32_16x16x32_bf16 v[176:179], a[36:39], a[4:7], v[176:179]
    ds_read_b64_tr_b16 a[102:103], v29 offset:51200
    v_mfma_f32_16x16x32_bf16 v[192:195], a[36:39], a[8:11], v[192:195]
    v_mfma_f32_16x16x32_bf16 v[208:211], a[36:39], a[12:15], v[208:211]
    ds_read_b128 a[72:75], v27 offset:36864
    v_mfma_f32_16x16x32_bf16 v[224:227], a[36:39], a[16:19], v[224:227]
    v_mfma_f32_16x16x32_bf16 v[240:243], a[36:39], a[20:23], v[240:243]
    v_mfma_f32_16x16x32_bf16 a[132:135], a[36:39], a[24:27], a[132:135]
    ds_read_b64_tr_b16 a[104:105], v30 offset:49152
    v_mfma_f32_16x16x32_bf16 a[164:167], a[36:39], a[28:31], a[164:167]
    v_mfma_f32_16x16x32_bf16 v[68:71], a[40:43], a[0:3], v[68:71]
    ds_read_b64_tr_b16 a[106:107], v30 offset:51200
    v_mfma_f32_16x16x32_bf16 v[84:87], a[40:43], a[4:7], v[84:87]
    v_mfma_f32_16x16x32_bf16 v[100:103], a[40:43], a[8:11], v[100:103]
    ds_read_b128 a[76:79], v27 offset:38912
    v_mfma_f32_16x16x32_bf16 v[116:119], a[40:43], a[12:15], v[116:119]
    v_mfma_f32_16x16x32_bf16 v[132:135], a[40:43], a[16:19], v[132:135]
    ds_read_b64_tr_b16 a[108:109], v31 offset:49152
    v_mfma_f32_16x16x32_bf16 v[148:151], a[40:43], a[20:23], v[148:151]
    v_mfma_f32_16x16x32_bf16 a[136:139], a[40:43], a[24:27], a[136:139]
    ds_read_b64_tr_b16 a[110:111], v31 offset:51200
    v_mfma_f32_16x16x32_bf16 a[168:171], a[40:43], a[28:31], a[168:171]
    v_mfma_f32_16x16x32_bf16 v[164:167], a[44:47], a[0:3], v[164:167]
    ds_read_b128 a[80:83], v27 offset:40960
    v_mfma_f32_16x16x32_bf16 v[180:183], a[44:47], a[4:7], v[180:183]
    v_mfma_f32_16x16x32_bf16 v[196:199], a[44:47], a[8:11], v[196:199]
    ds_read_b64_tr_b16 a[112:113], v32 offset:49152
    v_mfma_f32_16x16x32_bf16 v[212:215], a[44:47], a[12:15], v[212:215]
    v_mfma_f32_16x16x32_bf16 v[228:231], a[44:47], a[16:19], v[228:231]
    ds_read_b64_tr_b16 a[114:115], v32 offset:51200
    v_mfma_f32_16x16x32_bf16 v[244:247], a[44:47], a[20:23], v[244:247]
    v_mfma_f32_16x16x32_bf16 a[140:143], a[44:47], a[24:27], a[140:143]
    ds_read_b128 a[84:87], v27 offset:43008
    v_mfma_f32_16x16x32_bf16 a[172:175], a[44:47], a[28:31], a[172:175]
    v_mfma_f32_16x16x32_bf16 v[72:75], a[48:51], a[0:3], v[72:75]
    ds_read_b64_tr_b16 a[116:117], v33 offset:49152
    v_mfma_f32_16x16x32_bf16 v[88:91], a[48:51], a[4:7], v[88:91]
    v_mfma_f32_16x16x32_bf16 v[104:107], a[48:51], a[8:11], v[104:107]
    ds_read_b64_tr_b16 a[118:119], v33 offset:51200
    v_mfma_f32_16x16x32_bf16 v[120:123], a[48:51], a[12:15], v[120:123]
    v_mfma_f32_16x16x32_bf16 v[136:139], a[48:51], a[16:19], v[136:139]
    ds_read_b128 a[88:91], v27 offset:45056
    v_mfma_f32_16x16x32_bf16 v[152:155], a[48:51], a[20:23], v[152:155]
    v_mfma_f32_16x16x32_bf16 a[144:147], a[48:51], a[24:27], a[144:147]
    v_mfma_f32_16x16x32_bf16 a[176:179], a[48:51], a[28:31], a[176:179]
    ds_read_b64_tr_b16 a[120:121], v34 offset:49152
    v_mfma_f32_16x16x32_bf16 v[168:171], a[52:55], a[0:3], v[168:171]
    v_mfma_f32_16x16x32_bf16 v[184:187], a[52:55], a[4:7], v[184:187]
    ds_read_b64_tr_b16 a[122:123], v34 offset:51200
    v_mfma_f32_16x16x32_bf16 v[200:203], a[52:55], a[8:11], v[200:203]
    v_mfma_f32_16x16x32_bf16 v[216:219], a[52:55], a[12:15], v[216:219]
    ds_read_b128 a[92:95], v27 offset:47104
    v_mfma_f32_16x16x32_bf16 v[232:235], a[52:55], a[16:19], v[232:235]
    v_mfma_f32_16x16x32_bf16 v[248:251], a[52:55], a[20:23], v[248:251]
    ds_read_b64_tr_b16 a[124:125], v35 offset:49152
    v_mfma_f32_16x16x32_bf16 a[148:151], a[52:55], a[24:27], a[148:151]
    v_mfma_f32_16x16x32_bf16 a[180:183], a[52:55], a[28:31], a[180:183]
    ds_read_b64_tr_b16 a[126:127], v35 offset:51200
    v_mfma_f32_16x16x32_bf16 v[76:79], a[56:59], a[0:3], v[76:79]
    v_mfma_f32_16x16x32_bf16 v[92:95], a[56:59], a[4:7], v[92:95]
    v_mfma_f32_16x16x32_bf16 v[108:111], a[56:59], a[8:11], v[108:111]
    v_mfma_f32_16x16x32_bf16 v[124:127], a[56:59], a[12:15], v[124:127]
    v_mfma_f32_16x16x32_bf16 v[140:143], a[56:59], a[16:19], v[140:143]
    v_mfma_f32_16x16x32_bf16 v[156:159], a[56:59], a[20:23], v[156:159]
    v_mfma_f32_16x16x32_bf16 a[152:155], a[56:59], a[24:27], a[152:155]
    v_mfma_f32_16x16x32_bf16 a[184:187], a[56:59], a[28:31], a[184:187]
    s_sub_u32 s52, s51, 1
    s_cmp_eq_u32 s52, s46
    s_cbranch_scc1 k12_ool_18
k12_oolret_19:
    v_mfma_f32_16x16x32_bf16 v[172:175], a[60:63], a[0:3], v[172:175]
    v_mfma_f32_16x16x32_bf16 v[188:191], a[60:63], a[4:7], v[188:191]
    v_mfma_f32_16x16x32_bf16 v[204:207], a[60:63], a[8:11], v[204:207]
    v_mfma_f32_16x16x32_bf16 v[220:223], a[60:63], a[12:15], v[220:223]
    v_mfma_f32_16x16x32_bf16 v[236:239], a[60:63], a[16:19], v[236:239]
    v_mfma_f32_16x16x32_bf16 v[252:255], a[60:63], a[20:23], v[252:255]
    v_mfma_f32_16x16x32_bf16 a[156:159], a[60:63], a[24:27], a[156:159]
    v_mfma_f32_16x16x32_bf16 a[188:191], a[60:63], a[28:31], a[188:191]
    s_waitcnt vmcnt(0) lgkmcnt(0)
    s_barrier
    s_cmp_eq_u32 s51, 7
    s_cbranch_scc1 k12_last_9
    v_mfma_f32_16x16x32_bf16 v[64:67], a[96:99], a[64:67], v[64:67]
    ds_read_b128 a[0:3], v26 offset:0
    v_mfma_f32_16x16x32_bf16 v[80:83], a[96:99], a[68:71], v[80:83]
    s_add_u32 m0, s48, 32768
    ds_read_b64_tr_b16 a[32:33], v28 offset:0
    v_mfma_f32_16x16x32_bf16 v[96:99], a[96:99], a[72:75], v[96:99]
    buffer_load_dwordx4 v10, s[16:19], s49 offen offset:0 lds
    v_mfma_f32_16x16x32_bf16 v[112:115], a[96:99], a[76:79], v[112:115]
    ds_read_b64_tr_b16 a[34:35], v28 offset:2048
    v_mfma_f32_16x16x32_bf16 v[128:131], a[96:99], a[80:83], v[128:131]
    buffer_load_dwordx4 v11, s[16:19], s49 offen offset:1024 lds
    v_mfma_f32_16x16x32_bf16 v[144:147], a[96:99], a[84:87], v[144:147]
    ds_read_b128 a[4:7], v26 offset:2048
    v_mfma_f32_16x16x32_bf16 a[128:131], a[96:99], a[88:91], a[128:131]
    v_mfma_f32_16x16x32_bf16 a[160:163], a[96:99], a[92:95], a[160:163]
    ds_read_b64_tr_b16 a[36:37], v29 offset:0
    v_mfma_f32_16x16x32_bf16 v[160:163], a[100:103], a[64:67], v[160:163]
    buffer_load_dwordx4 v12, s[16:19], s49 offen offset:2048 lds
    v_mfma_f32_16x16x32_bf16 v[176:179], a[100:103], a[68:71], v[176:179]
    ds_read_b64_tr_b16 a[38:39], v29 offset:2048
    v_mfma_f32_16x16x32_bf16 v[192:195], a[100:103], a[72:75], v[192:195]
    v_mfma_f32_16x16x32_bf16 v[208:211], a[100:103], a[76:79], v[208:211]
    buffer_load_dwordx4 v13, s[16:19], s49 offen offset:3072 lds
    ds_read_b128 a[8:11], v26 offset:4096
    v_mfma_f32_16x16x32_bf16 v[224:227], a[100:103], a[80:83], v[224:227]
    v_mfma_f32_16x16x32_bf16 v[240:243], a[100:103], a[84:87], v[240:243]
    s_add_u32 m0, s48, 36864
    v_mfma_f32_16x16x32_bf16 a[132:135], a[100:103], a[88:91], a[132:135]
    ds_read_b64_tr_b16 a[40:41], v30 offset:0
    v_mfma_f32_16x16x32_bf16 a[164:167], a[100:103], a[92:95], a[164:167]
    buffer_load_dwordx4 v14, s[16:19], s49 offen offset:0 lds
    v_mfma_f32_16x16x32_bf16 v[68:71], a[104:107], a[64:67], v[68:71]
    ds_read_b64_tr_b16 a[42:43], v30 offset:2048
    v_mfma_f32_16x16x32_bf16 v[84:87], a[104:107], a[68:71], v[84:87]
    v_mfma_f32_16x16x32_bf16 v[100:103], a[104:107], a[72:75], v[100:103]
    buffer_load_dwordx4 v15, s[16:19], s49 offen offset:1024 lds
    ds_read_b128 a[12:15], v26 offset:6144
    v_mfma_f32_16x16x32_bf16 v[116:119], a[104:107], a[76:79], v[116:119]
    v_mfma_f32_16x16x32_bf16 v[132:135], a[104:107], a[80:83], v[132:135]
    ds_read_b64_tr_b16 a[44:45], v31 offset:0
    v_mfma_f32_16x16x32_bf16 v[148:151], a[104:107], a[84:87], v[148:151]
    v_mfma_f32_16x16x32_bf16 a[136:139], a[104:107], a[88:91], a[136:139]
    buffer_load_dwordx4 v16, s[16:19], s49 offen offset:2048 lds
    ds_read_b64_tr_b16 a[46:47], v31 offset:2048
    v_mfma_f32_16x16x32_bf16 a[168:171], a[104:107], a[92:95], a[168:171]
    v_mfma_f32_16x16x32_bf16 v[164:167], a[108:111], a[64:67], v[164:167]
    ds_read_b128 a[16:19], v26 offset:8192
    v_mfma_f32_16x16x32_bf16 v[180:183], a[108:111], a[68:71], v[180:183]
    buffer_load_dwordx4 v17, s[16:19], s49 offen offset:3072 lds
    v_mfma_f32_16x16x32_bf16 v[196:199], a[108:111], a[72:75], v[196:199]
    ds_read_b64_tr_b16 a[48:49], v32 offset:0
    v_mfma_f32_16x16x32_bf16 v[212:215], a[108:111], a[76:79], v[212:215]
    s_add_u32 s49, s49, 128
    v_mfma_f32_16x16x32_bf16 v[228:231], a[108:111], a[80:83], v[228:231]
    s_add_u32 m0, s48, 98304
    ds_read_b64_tr_b16 a[50:51], v32 offset:2048
    v_mfma_f32_16x16x32_bf16 v[244:247], a[108:111], a[84:87], v[244:247]
    buffer_load_dwordx4 v18, s[20:23], s50 offen offset:0 lds
    v_mfma_f32_16x16x32_bf16 a[140:143], a[108:111], a[88:91], a[140:143]
    ds_read_b128 a[20:23], v26 offset:10240
    v_mfma_f32_16x16x32_bf16 a[172:175], a[108:111], a[92:95], a[172:175]
    v_mfma_f32_16x16x32_bf16 v[72:75], a[112:115], a[64:67], v[72:75]
    buffer_load_dwordx4 v19, s[20:23], s50 offen offset:1024 lds
    ds_read_b64_tr_b16 a[52:53], v33 offset:0
    v_mfma_f32_16x16x32_bf16 v[88:91], a[112:115], a[68:71], v[88:91]
    v_mfma_f32_16x16x32_bf16 v[104:107], a[112:115], a[72:75], v[104:107]
    ds_read_b64_tr_b16 a[54:55], v33 offset:2048
    v_mfma_f32_16x16x32_bf16 v[120:123], a[112:115], a[76:79], v[120:123]
    buffer_load_dwordx4 v20, s[20:23], s50 offen offset:2048 lds
    v_mfma_f32_16x16x32_bf16 v[136:139], a[112:115], a[80:83], v[136:139]
    ds_read_b128 a[24:27], v26 offset:12288
    v_mfma_f32_16x16x32_bf16 v[152:155], a[112:115], a[84:87], v[152:155]
    v_mfma_f32_16x16x32_bf16 a[144:147], a[112:115], a[88:91], a[144:147]
    v_mfma_f32_16x16x32_bf16 a[176:179], a[112:115], a[92:95], a[176:179]
    buffer_load_dwordx4 v21, s[20:23], s50 offen offset:3072 lds
    ds_read_b64_tr_b16 a[56:57], v34 offset:0
    v_mfma_f32_16x16x32_bf16 v[168:171], a[116:119], a[64:67], v[168:171]
    s_add_u32 m0, s48, 102400
    v_mfma_f32_16x16x32_bf16 v[184:187], a[116:119], a[68:71], v[184:187]
    ds_read_b64_tr_b16 a[58:59], v34 offset:2048
    v_mfma_f32_16x16x32_bf16 v[200:203], a[116:119], a[72:75], v[200:203]
    buffer_load_dwordx4 v22, s[20:23], s50 offen offset:0 lds
    v_mfma_f32_16x16x32_bf16 v[216:219], a[116:119], a[76:79], v[216:219]
    ds_read_b128 a[28:31], v26 offset:14336
    v_mfma_f32_16x16x32_bf16 v[232:235], a[116:119], a[80:83], v[232:235]
    v_mfma_f32_16x16x32_bf16 v[248:251], a[116:119], a[84:87], v[248:251]
    ds_read_b64_tr_b16 a[60:61], v35 offset:0
    v_mfma_f32_16x16x32_bf16 a[148:151], a[116:119], a[88:91], a[148:151]
    buffer_load_dwordx4 v23, s[20:23], s50 offen offset:1024 lds
    v_mfma_f32_16x16x32_bf16 a[180:183], a[116:119], a[92:95], a[180:183]
    ds_read_b64_tr_b16 a[62:63], v35 offset:2048
    v_mfma_f32_16x16x32_bf16 v[76:79], a[120:123], a[64:67], v[76:79]
    v_mfma_f32_16x16x32_bf16 v[92:95], a[120:123], a[68:71], v[92:95]
    buffer_load_dwordx4 v24, s[20:23], s50 offen offset:2048 lds
    v_mfma_f32_16x16x32_bf16 v[108:111], a[120:123], a[72:75], v[108:111]
    v_mfma_f32_16x16x32_bf16 v[124:127], a[120:123], a[76:79], v[124:127]
    v_mfma_f32_16x16x32_bf16 v[140:143], a[120:123], a[80:83], v[140:143]
    v_mfma_f32_16x16x32_bf16 v[156:159], a[120:123], a[84:87], v[156:159]
    buffer_load_dwordx4 v25, s[20:23], s50 offen offset:3072 lds
    v_mfma_f32_16x16x32_bf16 a[152:155], a[120:123], a[88:91], a[152:155]
    v_mfma_f32_16x16x32_bf16 a[184:187], a[120:123], a[92:95], a[184:187]
    s_add_u32 s50, s50, 0x80000
    v_mfma_f32_16x16x32_bf16 v[172:175], a[124:127], a[64:67], v[172:175]
    v_mfma_f32_16x16x32_bf16 v[188:191], a[124:127], a[68:71], v[188:191]
    s_cmp_eq_u32 s51, s53
    s_cbranch_scc1 k12_ool_20
k12_oolret_21:
    v_mfma_f32_16x16x32_bf16 v[204:207], a[124:127], a[72:75], v[204:207]
    v_mfma_f32_16x16x32_bf16 v[220:223], a[124:127], a[76:79], v[220:223]
    s_cmp_eq_u32 s51, 5
    s_cbranch_scc1 k12_ool_22
k12_oolret_23:
    v_mfma_f32_16x16x32_bf16 v[236:239], a[124:127], a[80:83], v[236:239]
    v_mfma_f32_16x16x32_bf16 v[252:255], a[124:127], a[84:87], v[252:255]
    s_add_u32 s51, s51, 1
    v_mfma_f32_16x16x32_bf16 a[156:159], a[124:127], a[88:91], a[156:159]
    v_mfma_f32_16x16x32_bf16 a[188:191], a[124:127], a[92:95], a[188:191]
    s_waitcnt lgkmcnt(0)
    s_branch k12_loop_8
k12_last_9:
    v_mfma_f32_16x16x32_bf16 v[64:67], a[96:99], a[64:67], v[64:67]
    s_add_u32 m0, s60, 98304
    v_mfma_f32_16x16x32_bf16 v[160:163], a[100:103], a[64:67], v[160:163]
    buffer_load_dwordx4 v38, s[12:15], s61 offen offset:0 lds
    v_mfma_f32_16x16x32_bf16 v[68:71], a[104:107], a[64:67], v[68:71]
    buffer_load_dwordx4 v39, s[12:15], s61 offen offset:1024 lds
    v_mfma_f32_16x16x32_bf16 v[164:167], a[108:111], a[64:67], v[164:167]
    v_mfma_f32_16x16x32_bf16 v[72:75], a[112:115], a[64:67], v[72:75]
    buffer_load_dwordx4 v40, s[12:15], s61 offen offset:2048 lds
    v_mfma_f32_16x16x32_bf16 v[168:171], a[116:119], a[64:67], v[168:171]
    v_cvt_pk_bf16_f32 v64, v64, v65
    v_cvt_pk_bf16_f32 v65, v66, v67
    v_cvt_pk_bf16_f32 v66, v160, v161
    v_mfma_f32_16x16x32_bf16 v[76:79], a[120:123], a[64:67], v[76:79]
    v_cvt_pk_bf16_f32 v67, v162, v163
    v_mfma_f32_16x16x32_bf16 v[172:175], a[124:127], a[64:67], v[172:175]
    v_cvt_pk_bf16_f32 v68, v68, v69
    v_cvt_pk_bf16_f32 v69, v70, v71
    v_cvt_pk_bf16_f32 v70, v164, v165
    v_mfma_f32_16x16x32_bf16 v[80:83], a[96:99], a[68:71], v[80:83]
    buffer_load_dwordx4 v41, s[12:15], s61 offen offset:3072 lds
    v_mfma_f32_16x16x32_bf16 v[176:179], a[100:103], a[68:71], v[176:179]
    s_add_u32 s61, s61, 0x80000
    v_cvt_pk_bf16_f32 v71, v166, v167
    v_cvt_pk_bf16_f32 v72, v72, v73
    v_cvt_pk_bf16_f32 v73, v74, v75
    v_mfma_f32_16x16x32_bf16 v[84:87], a[104:107], a[68:71], v[84:87]
    buffer_load_dwordx4 a[192:195], v36, s[8:11], s62 offen offset:0 sc1
    buffer_load_dwordx4 a[196:199], v36, s[8:11], s62 offen offset:1024 sc1
    v_mfma_f32_16x16x32_bf16 v[180:183], a[108:111], a[68:71], v[180:183]
    v_cvt_pk_bf16_f32 v74, v168, v169
    v_cvt_pk_bf16_f32 v75, v170, v171
    v_cvt_pk_bf16_f32 v76, v76, v77
    v_mfma_f32_16x16x32_bf16 v[88:91], a[112:115], a[68:71], v[88:91]
    v_cvt_pk_bf16_f32 v77, v78, v79
    v_cvt_pk_bf16_f32 v78, v172, v173
    v_cvt_pk_bf16_f32 v79, v174, v175
    v_mfma_f32_16x16x32_bf16 v[184:187], a[116:119], a[68:71], v[184:187]
    v_cvt_pk_bf16_f32 v80, v80, v81
    v_cvt_pk_bf16_f32 v81, v82, v83
    v_cvt_pk_bf16_f32 v82, v176, v177
    v_mfma_f32_16x16x32_bf16 v[92:95], a[120:123], a[68:71], v[92:95]
    buffer_load_dwordx4 a[200:203], v37, s[8:11], s62 offen offset:0 sc1
    buffer_load_dwordx4 a[204:207], v37, s[8:11], s62 offen offset:1024 sc1
    v_mfma_f32_16x16x32_bf16 v[188:191], a[124:127], a[68:71], v[188:191]
    s_add_u32 s62, s62, 0x20000
    v_cvt_pk_bf16_f32 v83, v178, v179
    v_cvt_pk_bf16_f32 v84, v84, v85
    v_cvt_pk_bf16_f32 v85, v86, v87
    v_mfma_f32_16x16x32_bf16 a[128:131], a[96:99], a[88:91], a[128:131]
    v_cvt_pk_bf16_f32 v86, v180, v181
    v_cvt_pk_bf16_f32 v87, v182, v183
    v_mfma_f32_16x16x32_bf16 a[132:135], a[100:103], a[88:91], a[132:135]
    v_cvt_pk_bf16_f32 v88, v88, v89
    v_cvt_pk_bf16_f32 v89, v90, v91
    v_cvt_pk_bf16_f32 v90, v184, v185
    v_mfma_f32_16x16x32_bf16 v[96:99], a[96:99], a[72:75], v[96:99]
    buffer_load_dwordx4 a[208:211], v36, s[8:11], s62 offen offset:0 sc1
    buffer_load_dwordx4 a[212:215], v36, s[8:11], s62 offen offset:1024 sc1
    v_mfma_f32_16x16x32_bf16 v[192:195], a[100:103], a[72:75], v[192:195]
    v_cvt_pk_bf16_f32 v91, v186, v187
    v_cvt_pk_bf16_f32 v92, v92, v93
    v_cvt_pk_bf16_f32 v93, v94, v95
    v_mfma_f32_16x16x32_bf16 v[100:103], a[104:107], a[72:75], v[100:103]
    v_cvt_pk_bf16_f32 v94, v188, v189
    v_cvt_pk_bf16_f32 v95, v190, v191
    v_mfma_f32_16x16x32_bf16 v[196:199], a[108:111], a[72:75], v[196:199]
    v_accvgpr_read_b32 v56, a128
    v_accvgpr_read_b32 v57, a129
    v_accvgpr_read_b32 v58, a130
    v_mfma_f32_16x16x32_bf16 a[136:139], a[104:107], a[88:91], a[136:139]
    buffer_load_dwordx4 a[216:219], v37, s[8:11], s62 offen offset:0 sc1
    buffer_load_dwordx4 a[220:223], v37, s[8:11], s62 offen offset:1024 sc1
    v_mfma_f32_16x16x32_bf16 a[140:143], a[108:111], a[88:91], a[140:143]
    s_add_u32 s62, s62, 0x20000
    v_accvgpr_read_b32 v59, a131
    v_accvgpr_read_b32 v60, a132
    v_cvt_pk_bf16_f32 v96, v96, v97
    v_mfma_f32_16x16x32_bf16 v[104:107], a[112:115], a[72:75], v[104:107]
    s_add_u32 m0, s60, 114688
    v_accvgpr_read_b32 v61, a133
    v_accvgpr_read_b32 v62, a134
    v_cvt_pk_bf16_f32 v97, v98, v99
    v_mfma_f32_16x16x32_bf16 v[200:203], a[116:119], a[72:75], v[200:203]
    v_accvgpr_read_b32 v63, a135
    v_cvt_pk_bf16_f32 v98, v192, v193
    v_cvt_pk_bf16_f32 v160, v56, v57
    v_mfma_f32_16x16x32_bf16 v[108:111], a[120:123], a[72:75], v[108:111]
    v_cvt_pk_bf16_f32 v99, v194, v195
    v_cvt_pk_bf16_f32 v161, v58, v59
    v_cvt_pk_bf16_f32 v100, v100, v101
    v_mfma_f32_16x16x32_bf16 v[204:207], a[124:127], a[72:75], v[204:207]
    buffer_load_dwordx4 v38, s[12:15], s61 offen offset:0 lds
    buffer_load_dwordx4 v39, s[12:15], s61 offen offset:1024 lds
    v_mfma_f32_16x16x32_bf16 a[144:147], a[112:115], a[88:91], a[144:147]
    v_cvt_pk_bf16_f32 v162, v60, v61
    v_cvt_pk_bf16_f32 v101, v102, v103
    v_cvt_pk_bf16_f32 v163, v62, v63
    v_mfma_f32_16x16x32_bf16 a[148:151], a[116:119], a[88:91], a[148:151]
    v_cvt_pk_bf16_f32 v102, v196, v197
    v_cvt_pk_bf16_f32 v103, v198, v199
    v_accvgpr_read_b32 v56, a136
    v_mfma_f32_16x16x32_bf16 v[112:115], a[96:99], a[76:79], v[112:115]
    v_accvgpr_read_b32 v57, a137
    v_accvgpr_read_b32 v58, a138
    v_accvgpr_read_b32 v59, a139
    v_mfma_f32_16x16x32_bf16 v[208:211], a[100:103], a[76:79], v[208:211]
    v_accvgpr_read_b32 v60, a140
    v_cvt_pk_bf16_f32 v104, v104, v105
    v_accvgpr_read_b32 v61, a141
    v_mfma_f32_16x16x32_bf16 v[116:119], a[104:107], a[76:79], v[116:119]
    buffer_load_dwordx4 v40, s[12:15], s61 offen offset:2048 lds
    buffer_load_dwordx4 v41, s[12:15], s61 offen offset:3072 lds
    v_mfma_f32_16x16x32_bf16 v[212:215], a[108:111], a[76:79], v[212:215]
    s_add_u32 s61, s61, 0x80000
    v_accvgpr_read_b32 v62, a142
    v_cvt_pk_bf16_f32 v105, v106, v107
    v_accvgpr_read_b32 v63, a143
    v_mfma_f32_16x16x32_bf16 a[152:155], a[120:123], a[88:91], a[152:155]
    v_cvt_pk_bf16_f32 v106, v200, v201
    v_cvt_pk_bf16_f32 v164, v56, v57
    v_cvt_pk_bf16_f32 v107, v202, v203
    v_mfma_f32_16x16x32_bf16 a[156:159], a[124:127], a[88:91], a[156:159]
    v_cvt_pk_bf16_f32 v165, v58, v59
    v_cvt_pk_bf16_f32 v108, v108, v109
    v_cvt_pk_bf16_f32 v166, v60, v61
    v_mfma_f32_16x16x32_bf16 v[120:123], a[112:115], a[76:79], v[120:123]
    v_cvt_pk_bf16_f32 v109, v110, v111
    v_cvt_pk_bf16_f32 v167, v62, v63
    v_cvt_pk_bf16_f32 v110, v204, v205
    v_mfma_f32_16x16x32_bf16 v[216:219], a[116:119], a[76:79], v[216:219]
    buffer_load_dwordx4 a[224:227], v36, s[8:11], s62 offen offset:0 sc1
    v_cvt_pk_bf16_f32 v111, v206, v207
    v_accvgpr_read_b32 v56, a144
    v_mfma_f32_16x16x32_bf16 v[124:127], a[120:123], a[76:79], v[124:127]
    v_accvgpr_read_b32 v57, a145
    v_accvgpr_read_b32 v58, a146
    v_accvgpr_read_b32 v59, a147
    v_mfma_f32_16x16x32_bf16 v[220:223], a[124:127], a[76:79], v[220:223]
    buffer_load_dwordx4 a[228:231], v36, s[8:11], s62 offen offset:1024 sc1
    v_accvgpr_read_b32 v60, a148
    v_cvt_pk_bf16_f32 v112, v112, v113
    v_mfma_f32_16x16x32_bf16 a[160:163], a[96:99], a[92:95], a[160:163]
    v_accvgpr_read_b32 v61, a149
    v_accvgpr_read_b32 v62, a150
    v_cvt_pk_bf16_f32 v113, v114, v115
    v_mfma_f32_16x16x32_bf16 a[164:167], a[100:103], a[92:95], a[164:167]
    v_accvgpr_read_b32 v63, a151
    v_cvt_pk_bf16_f32 v114, v208, v209
    v_cvt_pk_bf16_f32 v168, v56, v57
    v_mfma_f32_16x16x32_bf16 v[128:131], a[96:99], a[80:83], v[128:131]
    v_cvt_pk_bf16_f32 v115, v210, v211
    v_cvt_pk_bf16_f32 v169, v58, v59
    v_cvt_pk_bf16_f32 v116, v116, v117
    v_mfma_f32_16x16x32_bf16 v[224:227], a[100:103], a[80:83], v[224:227]
    buffer_load_dwordx4 a[232:235], v37, s[8:11], s62 offen offset:0 sc1
    v_cvt_pk_bf16_f32 v170, v60, v61
    v_cvt_pk_bf16_f32 v117, v118, v119
    v_mfma_f32_16x16x32_bf16 v[132:135], a[104:107], a[80:83], v[132:135]
    v_cvt_pk_bf16_f32 v171, v62, v63
    v_cvt_pk_bf16_f32 v118, v212, v213
    v_cvt_pk_bf16_f32 v119, v214, v215
    v_mfma_f32_16x16x32_bf16 v[228:231], a[108:111], a[80:83], v[228:231]
    buffer_load_dwordx4 a[236:239], v37, s[8:11], s62 offen offset:1024 sc1
    v_accvgpr_read_b32 v56, a152
    v_accvgpr_read_b32 v57, a153
    v_mfma_f32_16x16x32_bf16 a[168:171], a[104:107], a[92:95], a[168:171]
    s_add_u32 s62, s62, 0x20000
    v_accvgpr_read_b32 v58, a154
    v_accvgpr_read_b32 v59, a155
    v_accvgpr_read_b32 v60, a156
    v_mfma_f32_16x16x32_bf16 a[172:175], a[108:111], a[92:95], a[172:175]
    s_waitcnt vmcnt(16)
    s_barrier
    v_cvt_pk_bf16_f32 v120, v120, v121
    v_accvgpr_read_b32 v61, a157
    v_accvgpr_read_b32 v62, a158
    v_mfma_f32_16x16x32_bf16 v[136:139], a[112:115], a[80:83], v[136:139]
    v_cvt_pk_bf16_f32 v121, v122, v123
    v_accvgpr_read_b32 v63, a159
    v_cvt_pk_bf16_f32 v122, v216, v217
    v_mfma_f32_16x16x32_bf16 v[232:235], a[116:119], a[80:83], v[232:235]
    v_cvt_pk_bf16_f32 v172, v56, v57
    v_cvt_pk_bf16_f32 v123, v218, v219
    v_cvt_pk_bf16_f32 v173, v58, v59
    v_mfma_f32_16x16x32_bf16 v[140:143], a[120:123], a[80:83], v[140:143]
    v_cvt_pk_bf16_f32 v124, v124, v125
    v_cvt_pk_bf16_f32 v174, v60, v61
    v_cvt_pk_bf16_f32 v125, v126, v127
    v_mfma_f32_16x16x32_bf16 v[236:239], a[124:127], a[80:83], v[236:239]
    v_cvt_pk_bf16_f32 v175, v62, v63
    v_cvt_pk_bf16_f32 v126, v220, v221
    v_cvt_pk_bf16_f32 v127, v222, v223
    v_mfma_f32_16x16x32_bf16 a[176:179], a[112:115], a[92:95], a[176:179]
    ds_read_b64_tr_b16 a[0:1], v42 offset:0
    v_accvgpr_read_b32 v56, a160
    v_accvgpr_read_b32 v57, a161
    v_mfma_f32_16x16x32_bf16 a[180:183], a[116:119], a[92:95], a[180:183]
    ds_read_b64_tr_b16 a[2:3], v42 offset:1024
    v_accvgpr_read_b32 v58, a162
    v_accvgpr_read_b32 v59, a163
    v_mfma_f32_16x16x32_bf16 v[144:147], a[96:99], a[84:87], v[144:147]
    ds_read_b64_tr_b16 a[4:5], v43 offset:0
    v_accvgpr_read_b32 v60, a164
    v_cvt_pk_bf16_f32 v128, v128, v129
    v_mfma_f32_16x16x32_bf16 v[240:243], a[100:103], a[84:87], v[240:243]
    v_accvgpr_read_b32 v61, a165
    v_accvgpr_read_b32 v62, a166
    v_cvt_pk_bf16_f32 v129, v130, v131
    v_mfma_f32_16x16x32_bf16 v[148:151], a[104:107], a[84:87], v[148:151]
    ds_read_b64_tr_b16 a[6:7], v43 offset:1024
    v_accvgpr_read_b32 v63, a167
    v_cvt_pk_bf16_f32 v130, v224, v225
    v_mfma_f32_16x16x32_bf16 v[244:247], a[108:111], a[84:87], v[244:247]
    v_cvt_pk_bf16_f32 v176, v56, v57
    v_cvt_pk_bf16_f32 v131, v226, v227
    v_cvt_pk_bf16_f32 v177, v58, v59
    v_mfma_f32_16x16x32_bf16 a[184:187], a[120:123], a[92:95], a[184:187]
    ds_read_b64_tr_b16 a[8:9], v44 offset:0
    v_cvt_pk_bf16_f32 v132, v132, v133
    v_cvt_pk_bf16_f32 v178, v60, v61
    v_mfma_f32_16x16x32_bf16 a[188:191], a[124:127], a[92:95], a[188:191]
    ds_read_b64_tr_b16 a[10:11], v44 offset:1024
    v_cvt_pk_bf16_f32 v133, v134, v135
    v_cvt_pk_bf16_f32 v179, v62, v63
    v_mfma_f32_16x16x32_bf16 v[152:155], a[112:115], a[84:87], v[152:155]
    ds_read_b64_tr_b16 a[12:13], v45 offset:0
    v_cvt_pk_bf16_f32 v134, v228, v229
    v_cvt_pk_bf16_f32 v135, v230, v231
    v_mfma_f32_16x16x32_bf16 v[248:251], a[116:119], a[84:87], v[248:251]
    ds_read_b64_tr_b16 a[14:15], v45 offset:1024
    v_accvgpr_read_b32 v56, a168
    v_accvgpr_read_b32 v57, a169
    v_mfma_f32_16x16x32_bf16 v[156:159], a[120:123], a[84:87], v[156:159]
    ds_read_b64_tr_b16 a[16:17], v46 offset:0
    v_accvgpr_read_b32 v58, a170
    v_accvgpr_read_b32 v59, a171
    v_mfma_f32_16x16x32_bf16 v[252:255], a[124:127], a[84:87], v[252:255]
    v_accvgpr_read_b32 v60, a172
    v_cvt_pk_bf16_f32 v136, v136, v137
    v_accvgpr_read_b32 v61, a173
    ds_read_b64_tr_b16 a[18:19], v46 offset:1024
    v_accvgpr_read_b32 v62, a174
    v_cvt_pk_bf16_f32 v137, v138, v139
    v_accvgpr_read_b32 v63, a175
    v_cvt_pk_bf16_f32 v138, v232, v233
    v_cvt_pk_bf16_f32 v180, v56, v57
    ds_read_b64_tr_b16 a[20:21], v47 offset:0
    v_cvt_pk_bf16_f32 v139, v234, v235
    v_cvt_pk_bf16_f32 v181, v58, v59
    v_cvt_pk_bf16_f32 v140, v140, v141
    v_cvt_pk_bf16_f32 v182, v60, v61
    ds_read_b64_tr_b16 a[22:23], v47 offset:1024
    v_cvt_pk_bf16_f32 v141, v142, v143
    v_cvt_pk_bf16_f32 v183, v62, v63
    v_cvt_pk_bf16_f32 v142, v236, v237
    ds_read_b64_tr_b16 a[24:25], v48 offset:0
    v_cvt_pk_bf16_f32 v143, v238, v239
    v_accvgpr_read_b32 v56, a176
    ds_read_b64_tr_b16 a[26:27], v48 offset:1024
    v_accvgpr_read_b32 v57, a177
    v_accvgpr_read_b32 v58, a178
    ds_read_b64_tr_b16 a[28:29], v49 offset:0
    v_accvgpr_read_b32 v59, a179
    v_accvgpr_read_b32 v60, a180
    v_cvt_pk_bf16_f32 v144, v144, v145
    ds_read_b64_tr_b16 a[30:31], v49 offset:1024
    v_accvgpr_read_b32 v61, a181
    v_accvgpr_read_b32 v62, a182
    v_cvt_pk_bf16_f32 v145, v146, v147
    v_accvgpr_read_b32 v63, a183
    v_cvt_pk_bf16_f32 v146, v240, v241
    v_cvt_pk_bf16_f32 v184, v56, v57
    v_cvt_pk_bf16_f32 v147, v242, v243
    v_cvt_pk_bf16_f32 v185, v58, v59
    v_cvt_pk_bf16_f32 v148, v148, v149
    v_cvt_pk_bf16_f32 v186, v60, v61
    v_cvt_pk_bf16_f32 v149, v150, v151
    v_cvt_pk_bf16_f32 v187, v62, v63
    v_cvt_pk_bf16_f32 v150, v244, v245
    v_cvt_pk_bf16_f32 v151, v246, v247
    v_accvgpr_read_b32 v56, a184
    v_accvgpr_read_b32 v57, a185
    v_accvgpr_read_b32 v58, a186
    v_accvgpr_read_b32 v59, a187
    v_accvgpr_read_b32 v60, a188
    v_cvt_pk_bf16_f32 v152, v152, v153
    v_accvgpr_read_b32 v61, a189
    v_accvgpr_read_b32 v62, a190
    v_cvt_pk_bf16_f32 v153, v154, v155
    v_accvgpr_read_b32 v63, a191
    v_cvt_pk_bf16_f32 v154, v248, v249
    v_cvt_pk_bf16_f32 v188, v56, v57
    v_cvt_pk_bf16_f32 v155, v250, v251
    v_cvt_pk_bf16_f32 v189, v58, v59
    v_cvt_pk_bf16_f32 v156, v156, v157
    v_cvt_pk_bf16_f32 v190, v60, v61
    v_cvt_pk_bf16_f32 v157, v158, v159
    v_cvt_pk_bf16_f32 v191, v62, v63
    v_cvt_pk_bf16_f32 v158, v252, v253
    v_cvt_pk_bf16_f32 v159, v254, v255
    s_branch k12_join_7
k12_v_6:
k12_loop_24:
    v_mfma_f32_16x16x32_bf16 v[64:67], a[0:3], a[32:35], v[64:67]
    ds_read_b128 a[64:67], v27 offset:0
    v_mfma_f32_16x16x32_bf16 v[68:71], a[0:3], a[36:39], v[68:71]
    ds_read_b64_tr_b16 a[96:97], v28 offset:16384
    v_mfma_f32_16x16x32_bf16 v[72:75], a[0:3], a[40:43], v[72:75]
    v_mfma_f32_16x16x32_bf16 v[76:79], a[0:3], a[44:47], v[76:79]
    s_cmp_eq_u32 s51, s46
    s_cbranch_scc1 k12_ool_26
k12_oolret_27:
    v_mfma_f32_16x16x32_bf16 v[80:83], a[0:3], a[48:51], v[80:83]
    ds_read_b64_tr_b16 a[98:99], v28 offset:18432
    v_mfma_f32_16x16x32_bf16 v[84:87], a[0:3], a[52:55], v[84:87]
    ds_read_b128 a[68:71], v27 offset:2048
    v_mfma_f32_16x16x32_bf16 v[88:91], a[0:3], a[56:59], v[88:91]
    v_mfma_f32_16x16x32_bf16 v[92:95], a[0:3], a[60:63], v[92:95]
    ds_read_b64_tr_b16 a[100:101], v29 offset:16384
    v_mfma_f32_16x16x32_bf16 v[160:163], a[4:7], a[32:35], v[160:163]
    v_mfma_f32_16x16x32_bf16 v[164:167], a[4:7], a[36:39], v[164:167]
    ds_read_b64_tr_b16 a[102:103], v29 offset:18432
    v_mfma_f32_16x16x32_bf16 v[168:171], a[4:7], a[40:43], v[168:171]
    v_mfma_f32_16x16x32_bf16 v[172:175], a[4:7], a[44:47], v[172:175]
    ds_read_b128 a[72:75], v27 offset:4096
    v_mfma_f32_16x16x32_bf16 v[176:179], a[4:7], a[48:51], v[176:179]
    v_mfma_f32_16x16x32_bf16 v[180:183], a[4:7], a[52:55], v[180:183]
    v_mfma_f32_16x16x32_bf16 v[184:187], a[4:7], a[56:59], v[184:187]
    ds_read_b64_tr_b16 a[104:105], v30 offset:16384
    v_mfma_f32_16x16x32_bf16 v[188:191], a[4:7], a[60:63], v[188:191]
    v_mfma_f32_16x16x32_bf16 v[96:99], a[8:11], a[32:35], v[96:99]
    ds_read_b64_tr_b16 a[106:107], v30 offset:18432
    v_mfma_f32_16x16x32_bf16 v[100:103], a[8:11], a[36:39], v[100:103]
    v_mfma_f32_16x16x32_bf16 v[104:107], a[8:11], a[40:43], v[104:107]
    ds_read_b128 a[76:79], v27 offset:6144
    v_mfma_f32_16x16x32_bf16 v[108:111], a[8:11], a[44:47], v[108:111]
    v_mfma_f32_16x16x32_bf16 v[112:115], a[8:11], a[48:51], v[112:115]
    ds_read_b64_tr_b16 a[108:109], v31 offset:16384
    v_mfma_f32_16x16x32_bf16 v[116:119], a[8:11], a[52:55], v[116:119]
    v_mfma_f32_16x16x32_bf16 v[120:123], a[8:11], a[56:59], v[120:123]
    ds_read_b64_tr_b16 a[110:111], v31 offset:18432
    v_mfma_f32_16x16x32_bf16 v[124:127], a[8:11], a[60:63], v[124:127]
    v_mfma_f32_16x16x32_bf16 v[192:195], a[12:15], a[32:35], v[192:195]
    ds_read_b128 a[80:83], v27 offset:8192
    v_mfma_f32_16x16x32_bf16 v[196:199], a[12:15], a[36:39], v[196:199]
    v_mfma_f32_16x16x32_bf16 v[200:203], a[12:15], a[40:43], v[200:203]
    ds_read_b64_tr_b16 a[112:113], v32 offset:16384
    v_mfma_f32_16x16x32_bf16 v[204:207], a[12:15], a[44:47], v[204:207]
    v_mfma_f32_16x16x32_bf16 v[208:211], a[12:15], a[48:51], v[208:211]
    ds_read_b64_tr_b16 a[114:115], v32 offset:18432
    v_mfma_f32_16x16x32_bf16 v[212:215], a[12:15], a[52:55], v[212:215]
    v_mfma_f32_16x16x32_bf16 v[216:219], a[12:15], a[56:59], v[216:219]
    ds_read_b128 a[84:87], v27 offset:10240
    v_mfma_f32_16x16x32_bf16 v[220:223], a[12:15], a[60:63], v[220:223]
    v_mfma_f32_16x16x32_bf16 v[128:131], a[16:19], a[32:35], v[128:131]
    ds_read_b64_tr_b16 a[116:117], v33 offset:16384
    v_mfma_f32_16x16x32_bf16 v[132:135], a[16:19], a[36:39], v[132:135]
    v_mfma_f32_16x16x32_bf16 v[136:139], a[16:19], a[40:43], v[136:139]
    ds_read_b64_tr_b16 a[118:119], v33 offset:18432
    v_mfma_f32_16x16x32_bf16 v[140:143], a[16:19], a[44:47], v[140:143]
    v_mfma_f32_16x16x32_bf16 v[144:147], a[16:19], a[48:51], v[144:147]
    ds_read_b128 a[88:91], v27 offset:12288
    v_mfma_f32_16x16x32_bf16 v[148:151], a[16:19], a[52:55], v[148:151]
    v_mfma_f32_16x16x32_bf16 v[152:155], a[16:19], a[56:59], v[152:155]
    v_mfma_f32_16x16x32_bf16 v[156:159], a[16:19], a[60:63], v[156:159]
    ds_read_b64_tr_b16 a[120:121], v34 offset:16384
    v_mfma_f32_16x16x32_bf16 v[224:227], a[20:23], a[32:35], v[224:227]
    v_mfma_f32_16x16x32_bf16 v[228:231], a[20:23], a[36:39], v[228:231]
    ds_read_b64_tr_b16 a[122:123], v34 offset:18432
    v_mfma_f32_16x16x32_bf16 v[232:235], a[20:23], a[40:43], v[232:235]
    v_mfma_f32_16x16x32_bf16 v[236:239], a[20:23], a[44:47], v[236:239]
    ds_read_b128 a[92:95], v27 offset:14336
    v_mfma_f32_16x16x32_bf16 v[240:243], a[20:23], a[48:51], v[240:243]
    v_mfma_f32_16x16x32_bf16 v[244:247], a[20:23], a[52:55], v[244:247]
    ds_read_b64_tr_b16 a[124:125], v35 offset:16384
    v_mfma_f32_16x16x32_bf16 v[248:251], a[20:23], a[56:59], v[248:251]
    v_mfma_f32_16x16x32_bf16 v[252:255], a[20:23], a[60:63], v[252:255]
    ds_read_b64_tr_b16 a[126:127], v35 offset:18432
    v_mfma_f32_16x16x32_bf16 a[128:131], a[24:27], a[32:35], a[128:131]
    v_mfma_f32_16x16x32_bf16 a[136:139], a[24:27], a[36:39], a[136:139]
    v_mfma_f32_16x16x32_bf16 a[144:147], a[24:27], a[40:43], a[144:147]
    v_mfma_f32_16x16x32_bf16 a[152:155], a[24:27], a[44:47], a[152:155]
    v_mfma_f32_16x16x32_bf16 a[160:163], a[24:27], a[48:51], a[160:163]
    v_mfma_f32_16x16x32_bf16 a[168:171], a[24:27], a[52:55], a[168:171]
    v_mfma_f32_16x16x32_bf16 a[176:179], a[24:27], a[56:59], a[176:179]
    v_mfma_f32_16x16x32_bf16 a[184:187], a[24:27], a[60:63], a[184:187]
    v_mfma_f32_16x16x32_bf16 a[132:135], a[28:31], a[32:35], a[132:135]
    v_mfma_f32_16x16x32_bf16 a[140:143], a[28:31], a[36:39], a[140:143]
    v_mfma_f32_16x16x32_bf16 a[148:151], a[28:31], a[40:43], a[148:151]
    v_mfma_f32_16x16x32_bf16 a[156:159], a[28:31], a[44:47], a[156:159]
    v_mfma_f32_16x16x32_bf16 a[164:167], a[28:31], a[48:51], a[164:167]
    v_mfma_f32_16x16x32_bf16 a[172:175], a[28:31], a[52:55], a[172:175]
    v_mfma_f32_16x16x32_bf16 a[180:183], a[28:31], a[56:59], a[180:183]
    v_mfma_f32_16x16x32_bf16 a[188:191], a[28:31], a[60:63], a[188:191]
    s_waitcnt vmcnt(0) lgkmcnt(0)
    s_barrier
    v_mfma_f32_16x16x32_bf16 v[64:67], a[64:67], a[96:99], v[64:67]
    s_cmp_ge_u32 s49, 1024
    s_cselect_b32 s18, 0, s18
    s_cselect_b32 s22, 0, s22
    ds_read_b128 a[0:3], v26 offset:32768
    v_mfma_f32_16x16x32_bf16 v[68:71], a[64:67], a[100:103], v[68:71]
    s_add_u32 m0, s48, 0
    ds_read_b64_tr_b16 a[32:33], v28 offset:32768
    v_mfma_f32_16x16x32_bf16 v[72:75], a[64:67], a[104:107], v[72:75]
    buffer_load_dwordx4 v10, s[16:19], s49 offen offset:0 lds
    v_mfma_f32_16x16x32_bf16 v[76:79], a[64:67], a[108:111], v[76:79]
    ds_read_b64_tr_b16 a[34:35], v28 offset:34816
    v_mfma_f32_16x16x32_bf16 v[80:83], a[64:67], a[112:115], v[80:83]
    buffer_load_dwordx4 v11, s[16:19], s49 offen offset:1024 lds
    v_mfma_f32_16x16x32_bf16 v[84:87], a[64:67], a[116:119], v[84:87]
    ds_read_b128 a[4:7], v26 offset:34816
    v_mfma_f32_16x16x32_bf16 v[88:91], a[64:67], a[120:123], v[88:91]
    v_mfma_f32_16x16x32_bf16 v[92:95], a[64:67], a[124:127], v[92:95]
    ds_read_b64_tr_b16 a[36:37], v29 offset:32768
    v_mfma_f32_16x16x32_bf16 v[160:163], a[68:71], a[96:99], v[160:163]
    buffer_load_dwordx4 v12, s[16:19], s49 offen offset:2048 lds
    v_mfma_f32_16x16x32_bf16 v[164:167], a[68:71], a[100:103], v[164:167]
    ds_read_b64_tr_b16 a[38:39], v29 offset:34816
    v_mfma_f32_16x16x32_bf16 v[168:171], a[68:71], a[104:107], v[168:171]
    v_mfma_f32_16x16x32_bf16 v[172:175], a[68:71], a[108:111], v[172:175]
    buffer_load_dwordx4 v13, s[16:19], s49 offen offset:3072 lds
    ds_read_b128 a[8:11], v26 offset:36864
    v_mfma_f32_16x16x32_bf16 v[176:179], a[68:71], a[112:115], v[176:179]
    v_mfma_f32_16x16x32_bf16 v[180:183], a[68:71], a[116:119], v[180:183]
    s_add_u32 m0, s48, 4096
    v_mfma_f32_16x16x32_bf16 v[184:187], a[68:71], a[120:123], v[184:187]
    ds_read_b64_tr_b16 a[40:41], v30 offset:32768
    v_mfma_f32_16x16x32_bf16 v[188:191], a[68:71], a[124:127], v[188:191]
    buffer_load_dwordx4 v14, s[16:19], s49 offen offset:0 lds
    v_mfma_f32_16x16x32_bf16 v[96:99], a[72:75], a[96:99], v[96:99]
    ds_read_b64_tr_b16 a[42:43], v30 offset:34816
    v_mfma_f32_16x16x32_bf16 v[100:103], a[72:75], a[100:103], v[100:103]
    v_mfma_f32_16x16x32_bf16 v[104:107], a[72:75], a[104:107], v[104:107]
    buffer_load_dwordx4 v15, s[16:19], s49 offen offset:1024 lds
    ds_read_b128 a[12:15], v26 offset:38912
    v_mfma_f32_16x16x32_bf16 v[108:111], a[72:75], a[108:111], v[108:111]
    v_mfma_f32_16x16x32_bf16 v[112:115], a[72:75], a[112:115], v[112:115]
    ds_read_b64_tr_b16 a[44:45], v31 offset:32768
    v_mfma_f32_16x16x32_bf16 v[116:119], a[72:75], a[116:119], v[116:119]
    v_mfma_f32_16x16x32_bf16 v[120:123], a[72:75], a[120:123], v[120:123]
    buffer_load_dwordx4 v16, s[16:19], s49 offen offset:2048 lds
    ds_read_b64_tr_b16 a[46:47], v31 offset:34816
    v_mfma_f32_16x16x32_bf16 v[124:127], a[72:75], a[124:127], v[124:127]
    v_mfma_f32_16x16x32_bf16 v[192:195], a[76:79], a[96:99], v[192:195]
    ds_read_b128 a[16:19], v26 offset:40960
    v_mfma_f32_16x16x32_bf16 v[196:199], a[76:79], a[100:103], v[196:199]
    buffer_load_dwordx4 v17, s[16:19], s49 offen offset:3072 lds
    v_mfma_f32_16x16x32_bf16 v[200:203], a[76:79], a[104:107], v[200:203]
    ds_read_b64_tr_b16 a[48:49], v32 offset:32768
    v_mfma_f32_16x16x32_bf16 v[204:207], a[76:79], a[108:111], v[204:207]
    s_add_u32 s49, s49, 128
    v_mfma_f32_16x16x32_bf16 v[208:211], a[76:79], a[112:115], v[208:211]
    s_add_u32 m0, s48, 65536
    ds_read_b64_tr_b16 a[50:51], v32 offset:34816
    v_mfma_f32_16x16x32_bf16 v[212:215], a[76:79], a[116:119], v[212:215]
    buffer_load_dwordx4 v18, s[20:23], s50 offen offset:0 lds
    v_mfma_f32_16x16x32_bf16 v[216:219], a[76:79], a[120:123], v[216:219]
    ds_read_b128 a[20:23], v26 offset:43008
    v_mfma_f32_16x16x32_bf16 v[220:223], a[76:79], a[124:127], v[220:223]
    v_mfma_f32_16x16x32_bf16 v[128:131], a[80:83], a[96:99], v[128:131]
    buffer_load_dwordx4 v19, s[20:23], s50 offen offset:1024 lds
    ds_read_b64_tr_b16 a[52:53], v33 offset:32768
    v_mfma_f32_16x16x32_bf16 v[132:135], a[80:83], a[100:103], v[132:135]
    v_mfma_f32_16x16x32_bf16 v[136:139], a[80:83], a[104:107], v[136:139]
    ds_read_b64_tr_b16 a[54:55], v33 offset:34816
    v_mfma_f32_16x16x32_bf16 v[140:143], a[80:83], a[108:111], v[140:143]
    buffer_load_dwordx4 v20, s[20:23], s50 offen offset:2048 lds
    v_mfma_f32_16x16x32_bf16 v[144:147], a[80:83], a[112:115], v[144:147]
    ds_read_b128 a[24:27], v26 offset:45056
    v_mfma_f32_16x16x32_bf16 v[148:151], a[80:83], a[116:119], v[148:151]
    v_mfma_f32_16x16x32_bf16 v[152:155], a[80:83], a[120:123], v[152:155]
    v_mfma_f32_16x16x32_bf16 v[156:159], a[80:83], a[124:127], v[156:159]
    buffer_load_dwordx4 v21, s[20:23], s50 offen offset:3072 lds
    ds_read_b64_tr_b16 a[56:57], v34 offset:32768
    v_mfma_f32_16x16x32_bf16 v[224:227], a[84:87], a[96:99], v[224:227]
    s_add_u32 m0, s48, 69632
    v_mfma_f32_16x16x32_bf16 v[228:231], a[84:87], a[100:103], v[228:231]
    ds_read_b64_tr_b16 a[58:59], v34 offset:34816
    v_mfma_f32_16x16x32_bf16 v[232:235], a[84:87], a[104:107], v[232:235]
    buffer_load_dwordx4 v22, s[20:23], s50 offen offset:0 lds
    v_mfma_f32_16x16x32_bf16 v[236:239], a[84:87], a[108:111], v[236:239]
    ds_read_b128 a[28:31], v26 offset:47104
    v_mfma_f32_16x16x32_bf16 v[240:243], a[84:87], a[112:115], v[240:243]
    v_mfma_f32_16x16x32_bf16 v[244:247], a[84:87], a[116:119], v[244:247]
    ds_read_b64_tr_b16 a[60:61], v35 offset:32768
    v_mfma_f32_16x16x32_bf16 v[248:251], a[84:87], a[120:123], v[248:251]
    buffer_load_dwordx4 v23, s[20:23], s50 offen offset:1024 lds
    v_mfma_f32_16x16x32_bf16 v[252:255], a[84:87], a[124:127], v[252:255]
    ds_read_b64_tr_b16 a[62:63], v35 offset:34816
    v_mfma_f32_16x16x32_bf16 a[128:131], a[88:91], a[96:99], a[128:131]
    v_mfma_f32_16x16x32_bf16 a[136:139], a[88:91], a[100:103], a[136:139]
    buffer_load_dwordx4 v24, s[20:23], s50 offen offset:2048 lds
    v_mfma_f32_16x16x32_bf16 a[144:147], a[88:91], a[104:107], a[144:147]
    v_mfma_f32_16x16x32_bf16 a[152:155], a[88:91], a[108:111], a[152:155]
    v_mfma_f32_16x16x32_bf16 a[160:163], a[88:91], a[112:115], a[160:163]
    v_mfma_f32_16x16x32_bf16 a[168:171], a[88:91], a[116:119], a[168:171]
    buffer_load_dwordx4 v25, s[20:23], s50 offen offset:3072 lds
    v_mfma_f32_16x16x32_bf16 a[176:179], a[88:91], a[120:123], a[176:179]
    v_mfma_f32_16x16x32_bf16 a[184:187], a[88:91], a[124:127], a[184:187]
    s_add_u32 s50, s50, 0x80000
    v_mfma_f32_16x16x32_bf16 a[132:135], a[92:95], a[96:99], a[132:135]
    v_mfma_f32_16x16x32_bf16 a[140:143], a[92:95], a[100:103], a[140:143]
    s_cmp_eq_u32 s51, s53
    s_cbranch_scc1 k12_ool_28
k12_oolret_29:
    v_mfma_f32_16x16x32_bf16 a[148:151], a[92:95], a[104:107], a[148:151]
    v_mfma_f32_16x16x32_bf16 a[156:159], a[92:95], a[108:111], a[156:159]
    s_cmp_eq_u32 s51, s63
    s_cbranch_scc1 k12_ool_30
k12_oolret_31:
    v_mfma_f32_16x16x32_bf16 a[164:167], a[92:95], a[112:115], a[164:167]
    v_mfma_f32_16x16x32_bf16 a[172:175], a[92:95], a[116:119], a[172:175]
    s_add_u32 s51, s51, 1
    v_mfma_f32_16x16x32_bf16 a[180:183], a[92:95], a[120:123], a[180:183]
    v_mfma_f32_16x16x32_bf16 a[188:191], a[92:95], a[124:127], a[188:191]
    s_waitcnt lgkmcnt(0)
    v_mfma_f32_16x16x32_bf16 v[64:67], a[0:3], a[32:35], v[64:67]
    ds_read_b128 a[64:67], v27 offset:32768
    v_mfma_f32_16x16x32_bf16 v[68:71], a[0:3], a[36:39], v[68:71]
    ds_read_b64_tr_b16 a[96:97], v28 offset:49152
    v_mfma_f32_16x16x32_bf16 v[72:75], a[0:3], a[40:43], v[72:75]
    v_mfma_f32_16x16x32_bf16 v[76:79], a[0:3], a[44:47], v[76:79]
    ds_read_b64_tr_b16 a[98:99], v28 offset:51200
    v_mfma_f32_16x16x32_bf16 v[80:83], a[0:3], a[48:51], v[80:83]
    v_mfma_f32_16x16x32_bf16 v[84:87], a[0:3], a[52:55], v[84:87]
    ds_read_b128 a[68:71], v27 offset:34816
    v_mfma_f32_16x16x32_bf16 v[88:91], a[0:3], a[56:59], v[88:91]
    v_mfma_f32_16x16x32_bf16 v[92:95], a[0:3], a[60:63], v[92:95]
    ds_read_b64_tr_b16 a[100:101], v29 offset:49152
    v_mfma_f32_16x16x32_bf16 v[160:163], a[4:7], a[32:35], v[160:163]
    v_mfma_f32_16x16x32_bf16 v[164:167], a[4:7], a[36:39], v[164:167]
    ds_read_b64_tr_b16 a[102:103], v29 offset:51200
    v_mfma_f32_16x16x32_bf16 v[168:171], a[4:7], a[40:43], v[168:171]
    v_mfma_f32_16x16x32_bf16 v[172:175], a[4:7], a[44:47], v[172:175]
    ds_read_b128 a[72:75], v27 offset:36864
    v_mfma_f32_16x16x32_bf16 v[176:179], a[4:7], a[48:51], v[176:179]
    v_mfma_f32_16x16x32_bf16 v[180:183], a[4:7], a[52:55], v[180:183]
    v_mfma_f32_16x16x32_bf16 v[184:187], a[4:7], a[56:59], v[184:187]
    ds_read_b64_tr_b16 a[104:105], v30 offset:49152
    v_mfma_f32_16x16x32_bf16 v[188:191], a[4:7], a[60:63], v[188:191]
    v_mfma_f32_16x16x32_bf16 v[96:99], a[8:11], a[32:35], v[96:99]
    ds_read_b64_tr_b16 a[106:107], v30 offset:51200
    v_mfma_f32_16x16x32_bf16 v[100:103], a[8:11], a[36:39], v[100:103]
    v_mfma_f32_16x16x32_bf16 v[104:107], a[8:11], a[40:43], v[104:107]
    ds_read_b128 a[76:79], v27 offset:38912
    v_mfma_f32_16x16x32_bf16 v[108:111], a[8:11], a[44:47], v[108:111]
    v_mfma_f32_16x16x32_bf16 v[112:115], a[8:11], a[48:51], v[112:115]
    ds_read_b64_tr_b16 a[108:109], v31 offset:49152
    v_mfma_f32_16x16x32_bf16 v[116:119], a[8:11], a[52:55], v[116:119]
    v_mfma_f32_16x16x32_bf16 v[120:123], a[8:11], a[56:59], v[120:123]
    ds_read_b64_tr_b16 a[110:111], v31 offset:51200
    v_mfma_f32_16x16x32_bf16 v[124:127], a[8:11], a[60:63], v[124:127]
    v_mfma_f32_16x16x32_bf16 v[192:195], a[12:15], a[32:35], v[192:195]
    ds_read_b128 a[80:83], v27 offset:40960
    v_mfma_f32_16x16x32_bf16 v[196:199], a[12:15], a[36:39], v[196:199]
    v_mfma_f32_16x16x32_bf16 v[200:203], a[12:15], a[40:43], v[200:203]
    ds_read_b64_tr_b16 a[112:113], v32 offset:49152
    v_mfma_f32_16x16x32_bf16 v[204:207], a[12:15], a[44:47], v[204:207]
    v_mfma_f32_16x16x32_bf16 v[208:211], a[12:15], a[48:51], v[208:211]
    ds_read_b64_tr_b16 a[114:115], v32 offset:51200
    v_mfma_f32_16x16x32_bf16 v[212:215], a[12:15], a[52:55], v[212:215]
    v_mfma_f32_16x16x32_bf16 v[216:219], a[12:15], a[56:59], v[216:219]
    ds_read_b128 a[84:87], v27 offset:43008
    v_mfma_f32_16x16x32_bf16 v[220:223], a[12:15], a[60:63], v[220:223]
    v_mfma_f32_16x16x32_bf16 v[128:131], a[16:19], a[32:35], v[128:131]
    ds_read_b64_tr_b16 a[116:117], v33 offset:49152
    v_mfma_f32_16x16x32_bf16 v[132:135], a[16:19], a[36:39], v[132:135]
    v_mfma_f32_16x16x32_bf16 v[136:139], a[16:19], a[40:43], v[136:139]
    ds_read_b64_tr_b16 a[118:119], v33 offset:51200
    v_mfma_f32_16x16x32_bf16 v[140:143], a[16:19], a[44:47], v[140:143]
    v_mfma_f32_16x16x32_bf16 v[144:147], a[16:19], a[48:51], v[144:147]
    ds_read_b128 a[88:91], v27 offset:45056
    v_mfma_f32_16x16x32_bf16 v[148:151], a[16:19], a[52:55], v[148:151]
    v_mfma_f32_16x16x32_bf16 v[152:155], a[16:19], a[56:59], v[152:155]
    v_mfma_f32_16x16x32_bf16 v[156:159], a[16:19], a[60:63], v[156:159]
    ds_read_b64_tr_b16 a[120:121], v34 offset:49152
    v_mfma_f32_16x16x32_bf16 v[224:227], a[20:23], a[32:35], v[224:227]
    v_mfma_f32_16x16x32_bf16 v[228:231], a[20:23], a[36:39], v[228:231]
    ds_read_b64_tr_b16 a[122:123], v34 offset:51200
    v_mfma_f32_16x16x32_bf16 v[232:235], a[20:23], a[40:43], v[232:235]
    v_mfma_f32_16x16x32_bf16 v[236:239], a[20:23], a[44:47], v[236:239]
    ds_read_b128 a[92:95], v27 offset:47104
    v_mfma_f32_16x16x32_bf16 v[240:243], a[20:23], a[48:51], v[240:243]
    v_mfma_f32_16x16x32_bf16 v[244:247], a[20:23], a[52:55], v[244:247]
    ds_read_b64_tr_b16 a[124:125], v35 offset:49152
    v_mfma_f32_16x16x32_bf16 v[248:251], a[20:23], a[56:59], v[248:251]
    v_mfma_f32_16x16x32_bf16 v[252:255], a[20:23], a[60:63], v[252:255]
    ds_read_b64_tr_b16 a[126:127], v35 offset:51200
    v_mfma_f32_16x16x32_bf16 a[128:131], a[24:27], a[32:35], a[128:131]
    v_mfma_f32_16x16x32_bf16 a[136:139], a[24:27], a[36:39], a[136:139]
    v_mfma_f32_16x16x32_bf16 a[144:147], a[24:27], a[40:43], a[144:147]
    v_mfma_f32_16x16x32_bf16 a[152:155], a[24:27], a[44:47], a[152:155]
    v_mfma_f32_16x16x32_bf16 a[160:163], a[24:27], a[48:51], a[160:163]
    v_mfma_f32_16x16x32_bf16 a[168:171], a[24:27], a[52:55], a[168:171]
    v_mfma_f32_16x16x32_bf16 a[176:179], a[24:27], a[56:59], a[176:179]
    v_mfma_f32_16x16x32_bf16 a[184:187], a[24:27], a[60:63], a[184:187]
    s_sub_u32 s52, s51, 1
    s_cmp_eq_u32 s52, s46
    s_cbranch_scc1 k12_ool_34
k12_oolret_35:
    v_mfma_f32_16x16x32_bf16 a[132:135], a[28:31], a[32:35], a[132:135]
    v_mfma_f32_16x16x32_bf16 a[140:143], a[28:31], a[36:39], a[140:143]
    v_mfma_f32_16x16x32_bf16 a[148:151], a[28:31], a[40:43], a[148:151]
    v_mfma_f32_16x16x32_bf16 a[156:159], a[28:31], a[44:47], a[156:159]
    v_mfma_f32_16x16x32_bf16 a[164:167], a[28:31], a[48:51], a[164:167]
    v_mfma_f32_16x16x32_bf16 a[172:175], a[28:31], a[52:55], a[172:175]
    v_mfma_f32_16x16x32_bf16 a[180:183], a[28:31], a[56:59], a[180:183]
    v_mfma_f32_16x16x32_bf16 a[188:191], a[28:31], a[60:63], a[188:191]
    s_waitcnt vmcnt(0) lgkmcnt(0)
    s_barrier
    s_cmp_eq_u32 s51, 7
    s_cbranch_scc1 k12_last_25
    v_mfma_f32_16x16x32_bf16 v[64:67], a[64:67], a[96:99], v[64:67]
    ds_read_b128 a[0:3], v26 offset:0
    v_mfma_f32_16x16x32_bf16 v[68:71], a[64:67], a[100:103], v[68:71]
    s_add_u32 m0, s48, 32768
    ds_read_b64_tr_b16 a[32:33], v28 offset:0
    v_mfma_f32_16x16x32_bf16 v[72:75], a[64:67], a[104:107], v[72:75]
    buffer_load_dwordx4 v10, s[16:19], s49 offen offset:0 lds
    v_mfma_f32_16x16x32_bf16 v[76:79], a[64:67], a[108:111], v[76:79]
    ds_read_b64_tr_b16 a[34:35], v28 offset:2048
    v_mfma_f32_16x16x32_bf16 v[80:83], a[64:67], a[112:115], v[80:83]
    buffer_load_dwordx4 v11, s[16:19], s49 offen offset:1024 lds
    v_mfma_f32_16x16x32_bf16 v[84:87], a[64:67], a[116:119], v[84:87]
    ds_read_b128 a[4:7], v26 offset:2048
    v_mfma_f32_16x16x32_bf16 v[88:91], a[64:67], a[120:123], v[88:91]
    v_mfma_f32_16x16x32_bf16 v[92:95], a[64:67], a[124:127], v[92:95]
    ds_read_b64_tr_b16 a[36:37], v29 offset:0
    v_mfma_f32_16x16x32_bf16 v[160:163], a[68:71], a[96:99], v[160:163]
    buffer_load_dwordx4 v12, s[16:19], s49 offen offset:2048 lds
    v_mfma_f32_16x16x32_bf16 v[164:167], a[68:71], a[100:103], v[164:167]
    ds_read_b64_tr_b16 a[38:39], v29 offset:2048
    v_mfma_f32_16x16x32_bf16 v[168:171], a[68:71], a[104:107], v[168:171]
    v_mfma_f32_16x16x32_bf16 v[172:175], a[68:71], a[108:111], v[172:175]
    buffer_load_dwordx4 v13, s[16:19], s49 offen offset:3072 lds
    ds_read_b128 a[8:11], v26 offset:4096
    v_mfma_f32_16x16x32_bf16 v[176:179], a[68:71], a[112:115], v[176:179]
    v_mfma_f32_16x16x32_bf16 v[180:183], a[68:71], a[116:119], v[180:183]
    s_add_u32 m0, s48, 36864
    v_mfma_f32_16x16x32_bf16 v[184:187], a[68:71], a[120:123], v[184:187]
    ds_read_b64_tr_b16 a[40:41], v30 offset:0
    v_mfma_f32_16x16x32_bf16 v[188:191], a[68:71], a[124:127], v[188:191]
    buffer_load_dwordx4 v14, s[16:19], s49 offen offset:0 lds
    v_mfma_f32_16x16x32_bf16 v[96:99], a[72:75], a[96:99], v[96:99]
    ds_read_b64_tr_b16 a[42:43], v30 offset:2048
    v_mfma_f32_16x16x32_bf16 v[100:103], a[72:75], a[100:103], v[100:103]
    v_mfma_f32_16x16x32_bf16 v[104:107], a[72:75], a[104:107], v[104:107]
    buffer_load_dwordx4 v15, s[16:19], s49 offen offset:1024 lds
    ds_read_b128 a[12:15], v26 offset:6144
    v_mfma_f32_16x16x32_bf16 v[108:111], a[72:75], a[108:111], v[108:111]
    v_mfma_f32_16x16x32_bf16 v[112:115], a[72:75], a[112:115], v[112:115]
    ds_read_b64_tr_b16 a[44:45], v31 offset:0
    v_mfma_f32_16x16x32_bf16 v[116:119], a[72:75], a[116:119], v[116:119]
    v_mfma_f32_16x16x32_bf16 v[120:123], a[72:75], a[120:123], v[120:123]
    buffer_load_dwordx4 v16, s[16:19], s49 offen offset:2048 lds
    ds_read_b64_tr_b16 a[46:47], v31 offset:2048
    v_mfma_f32_16x16x32_bf16 v[124:127], a[72:75], a[124:127], v[124:127]
    v_mfma_f32_16x16x32_bf16 v[192:195], a[76:79], a[96:99], v[192:195]
    ds_read_b128 a[16:19], v26 offset:8192
    v_mfma_f32_16x16x32_bf16 v[196:199], a[76:79], a[100:103], v[196:199]
    buffer_load_dwordx4 v17, s[16:19], s49 offen offset:3072 lds
    v_mfma_f32_16x16x32_bf16 v[200:203], a[76:79], a[104:107], v[200:203]
    ds_read_b64_tr_b16 a[48:49], v32 offset:0
    v_mfma_f32_16x16x32_bf16 v[204:207], a[76:79], a[108:111], v[204:207]
    s_add_u32 s49, s49, 128
    v_mfma_f32_16x16x32_bf16 v[208:211], a[76:79], a[112:115], v[208:211]
    s_add_u32 m0, s48, 98304
    ds_read_b64_tr_b16 a[50:51], v32 offset:2048
    v_mfma_f32_16x16x32_bf16 v[212:215], a[76:79], a[116:119], v[212:215]
    buffer_load_dwordx4 v18, s[20:23], s50 offen offset:0 lds
    v_mfma_f32_16x16x32_bf16 v[216:219], a[76:79], a[120:123], v[216:219]
    ds_read_b128 a[20:23], v26 offset:10240
    v_mfma_f32_16x16x32_bf16 v[220:223], a[76:79], a[124:127], v[220:223]
    v_mfma_f32_16x16x32_bf16 v[128:131], a[80:83], a[96:99], v[128:131]
    buffer_load_dwordx4 v19, s[20:23], s50 offen offset:1024 lds
    ds_read_b64_tr_b16 a[52:53], v33 offset:0
    v_mfma_f32_16x16x32_bf16 v[132:135], a[80:83], a[100:103], v[132:135]
    v_mfma_f32_16x16x32_bf16 v[136:139], a[80:83], a[104:107], v[136:139]
    ds_read_b64_tr_b16 a[54:55], v33 offset:2048
    v_mfma_f32_16x16x32_bf16 v[140:143], a[80:83], a[108:111], v[140:143]
    buffer_load_dwordx4 v20, s[20:23], s50 offen offset:2048 lds
    v_mfma_f32_16x16x32_bf16 v[144:147], a[80:83], a[112:115], v[144:147]
    ds_read_b128 a[24:27], v26 offset:12288
    v_mfma_f32_16x16x32_bf16 v[148:151], a[80:83], a[116:119], v[148:151]
    v_mfma_f32_16x16x32_bf16 v[152:155], a[80:83], a[120:123], v[152:155]
    v_mfma_f32_16x16x32_bf16 v[156:159], a[80:83], a[124:127], v[156:159]
    buffer_load_dwordx4 v21, s[20:23], s50 offen offset:3072 lds
    ds_read_b64_tr_b16 a[56:57], v34 offset:0
    v_mfma_f32_16x16x32_bf16 v[224:227], a[84:87], a[96:99], v[224:227]
    s_add_u32 m0, s48, 102400
    v_mfma_f32_16x16x32_bf16 v[228:231], a[84:87], a[100:103], v[228:231]
    ds_read_b64_tr_b16 a[58:59], v34 offset:2048
    v_mfma_f32_16x16x32_bf16 v[232:235], a[84:87], a[104:107], v[232:235]
    buffer_load_dwordx4 v22, s[20:23], s50 offen offset:0 lds
    v_mfma_f32_16x16x32_bf16 v[236:239], a[84:87], a[108:111], v[236:239]
    ds_read_b128 a[28:31], v26 offset:14336
    v_mfma_f32_16x16x32_bf16 v[240:243], a[84:87], a[112:115], v[240:243]
    v_mfma_f32_16x16x32_bf16 v[244:247], a[84:87], a[116:119], v[244:247]
    ds_read_b64_tr_b16 a[60:61], v35 offset:0
    v_mfma_f32_16x16x32_bf16 v[248:251], a[84:87], a[120:123], v[248:251]
    buffer_load_dwordx4 v23, s[20:23], s50 offen offset:1024 lds
    v_mfma_f32_16x16x32_bf16 v[252:255], a[84:87], a[124:127], v[252:255]
    ds_read_b64_tr_b16 a[62:63], v35 offset:2048
    v_mfma_f32_16x16x32_bf16 a[128:131], a[88:91], a[96:99], a[128:131]
    v_mfma_f32_16x16x32_bf16 a[136:139], a[88:91], a[100:103], a[136:139]
    buffer_load_dwordx4 v24, s[20:23], s50 offen offset:2048 lds
    v_mfma_f32_16x16x32_bf16 a[144:147], a[88:91], a[104:107], a[144:147]
    v_mfma_f32_16x16x32_bf16 a[152:155], a[88:91], a[108:111], a[152:155]
    v_mfma_f32_16x16x32_bf16 a[160:163], a[88:91], a[112:115], a[160:163]
    v_mfma_f32_16x16x32_bf16 a[168:171], a[88:91], a[116:119], a[168:171]
    buffer_load_dwordx4 v25, s[20:23], s50 offen offset:3072 lds
    v_mfma_f32_16x16x32_bf16 a[176:179], a[88:91], a[120:123], a[176:179]
    v_mfma_f32_16x16x32_bf16 a[184:187], a[88:91], a[124:127], a[184:187]
    s_add_u32 s50, s50, 0x80000
    v_mfma_f32_16x16x32_bf16 a[132:135], a[92:95], a[96:99], a[132:135]
    v_mfma_f32_16x16x32_bf16 a[140:143], a[92:95], a[100:103], a[140:143]
    s_cmp_eq_u32 s51, s53
    s_cbranch_scc1 k12_ool_36
k12_oolret_37:
    v_mfma_f32_16x16x32_bf16 a[148:151], a[92:95], a[104:107], a[148:151]
    v_mfma_f32_16x16x32_bf16 a[156:159], a[92:95], a[108:111], a[156:159]
    s_cmp_eq_u32 s51, 5
    s_cbranch_scc1 k12_ool_38
k12_oolret_39:
    v_mfma_f32_16x16x32_bf16 a[164:167], a[92:95], a[112:115], a[164:167]
    v_mfma_f32_16x16x32_bf16 a[172:175], a[92:95], a[116:119], a[172:175]
    s_add_u32 s51, s51, 1
    v_mfma_f32_16x16x32_bf16 a[180:183], a[92:95], a[120:123], a[180:183]
    v_mfma_f32_16x16x32_bf16 a[188:191], a[92:95], a[124:127], a[188:191]
    s_waitcnt lgkmcnt(0)
    s_branch k12_loop_24
k12_last_25:
    v_mfma_f32_16x16x32_bf16 v[64:67], a[64:67], a[96:99], v[64:67]
    s_add_u32 m0, s60, 98304
    v_mfma_f32_16x16x32_bf16 v[160:163], a[68:71], a[96:99], v[160:163]
    buffer_load_dwordx4 v38, s[12:15], s61 offen offset:0 lds
    v_mfma_f32_16x16x32_bf16 v[68:71], a[64:67], a[100:103], v[68:71]
    buffer_load_dwordx4 v39, s[12:15], s61 offen offset:1024 lds
    v_mfma_f32_16x16x32_bf16 v[164:167], a[68:71], a[100:103], v[164:167]
    v_mfma_f32_16x16x32_bf16 v[72:75], a[64:67], a[104:107], v[72:75]
    buffer_load_dwordx4 v40, s[12:15], s61 offen offset:2048 lds
    v_mfma_f32_16x16x32_bf16 v[168:171], a[68:71], a[104:107], v[168:171]
    v_cvt_pk_bf16_f32 v64, v64, v65
    v_cvt_pk_bf16_f32 v65, v66, v67
    v_cvt_pk_bf16_f32 v66, v160, v161
    v_mfma_f32_16x16x32_bf16 v[76:79], a[64:67], a[108:111], v[76:79]
    v_cvt_pk_bf16_f32 v67, v162, v163
    v_mfma_f32_16x16x32_bf16 v[172:175], a[68:71], a[108:111], v[172:175]
    v_cvt_pk_bf16_f32 v68, v68, v69
    v_cvt_pk_bf16_f32 v69, v70, v71
    v_cvt_pk_bf16_f32 v70, v164, v165
    v_mfma_f32_16x16x32_bf16 v[80:83], a[64:67], a[112:115], v[80:83]
    buffer_load_dwordx4 v41, s[12:15], s61 offen offset:3072 lds
    v_mfma_f32_16x16x32_bf16 v[176:179], a[68:71], a[112:115], v[176:179]
    s_add_u32 s61, s61, 0x80000
    v_cvt_pk_bf16_f32 v71, v166, v167
    v_cvt_pk_bf16_f32 v72, v72, v73
    v_cvt_pk_bf16_f32 v73, v74, v75
    v_mfma_f32_16x16x32_bf16 v[84:87], a[64:67], a[116:119], v[84:87]
    buffer_load_dwordx4 a[192:195], v36, s[8:11], s62 offen offset:0 sc1
    buffer_load_dwordx4 a[196:199], v36, s[8:11], s62 offen offset:1024 sc1
    v_mfma_f32_16x16x32_bf16 v[180:183], a[68:71], a[116:119], v[180:183]
    v_cvt_pk_bf16_f32 v74, v168, v169
    v_cvt_pk_bf16_f32 v75, v170, v171
    v_cvt_pk_bf16_f32 v76, v76, v77
    v_mfma_f32_16x16x32_bf16 v[88:91], a[64:67], a[120:123], v[88:91]
    v_cvt_pk_bf16_f32 v77, v78, v79
    v_cvt_pk_bf16_f32 v78, v172, v173
    v_cvt_pk_bf16_f32 v79, v174, v175
    v_mfma_f32_16x16x32_bf16 v[184:187], a[68:71], a[120:123], v[184:187]
    v_cvt_pk_bf16_f32 v80, v80, v81
    v_cvt_pk_bf16_f32 v81, v82, v83
    v_cvt_pk_bf16_f32 v82, v176, v177
    v_mfma_f32_16x16x32_bf16 v[92:95], a[64:67], a[124:127], v[92:95]
    buffer_load_dwordx4 a[200:203], v37, s[8:11], s62 offen offset:0 sc1
    buffer_load_dwordx4 a[204:207], v37, s[8:11], s62 offen offset:1024 sc1
    v_mfma_f32_16x16x32_bf16 v[188:191], a[68:71], a[124:127], v[188:191]
    s_add_u32 s62, s62, 0x20000
    v_cvt_pk_bf16_f32 v83, v178, v179
    v_cvt_pk_bf16_f32 v84, v84, v85
    v_cvt_pk_bf16_f32 v85, v86, v87
    v_mfma_f32_16x16x32_bf16 a[128:131], a[88:91], a[96:99], a[128:131]
    v_cvt_pk_bf16_f32 v86, v180, v181
    v_cvt_pk_bf16_f32 v87, v182, v183
    v_mfma_f32_16x16x32_bf16 a[132:135], a[92:95], a[96:99], a[132:135]
    v_cvt_pk_bf16_f32 v88, v88, v89
    v_cvt_pk_bf16_f32 v89, v90, v91
    v_cvt_pk_bf16_f32 v90, v184, v185
    v_mfma_f32_16x16x32_bf16 v[96:99], a[72:75], a[96:99], v[96:99]
    buffer_load_dwordx4 a[208:211], v36, s[8:11], s62 offen offset:0 sc1
    buffer_load_dwordx4 a[212:215], v36, s[8:11], s62 offen offset:1024 sc1
    v_mfma_f32_16x16x32_bf16 v[192:195], a[76:79], a[96:99], v[192:195]
    v_cvt_pk_bf16_f32 v91, v186, v187
    v_cvt_pk_bf16_f32 v92, v92, v93
    v_cvt_pk_bf16_f32 v93, v94, v95
    v_mfma_f32_16x16x32_bf16 v[100:103], a[72:75], a[100:103], v[100:103]
    v_cvt_pk_bf16_f32 v94, v188, v189
    v_cvt_pk_bf16_f32 v95, v190, v191
    v_mfma_f32_16x16x32_bf16 v[196:199], a[76:79], a[100:103], v[196:199]
    v_accvgpr_read_b32 v56, a128
    v_accvgpr_read_b32 v57, a129
    v_accvgpr_read_b32 v58, a130
    v_mfma_f32_16x16x32_bf16 a[136:139], a[88:91], a[100:103], a[136:139]
    buffer_load_dwordx4 a[216:219], v37, s[8:11], s62 offen offset:0 sc1
    buffer_load_dwordx4 a[220:223], v37, s[8:11], s62 offen offset:1024 sc1
    v_mfma_f32_16x16x32_bf16 a[140:143], a[92:95], a[100:103], a[140:143]
    s_add_u32 s62, s62, 0x20000
    v_accvgpr_read_b32 v59, a131
    v_accvgpr_read_b32 v60, a132
    v_cvt_pk_bf16_f32 v96, v96, v97
    v_mfma_f32_16x16x32_bf16 v[104:107], a[72:75], a[104:107], v[104:107]
    s_add_u32 m0, s60, 114688
    v_accvgpr_read_b32 v61, a133
    v_accvgpr_read_b32 v62, a134
    v_cvt_pk_bf16_f32 v97, v98, v99
    v_mfma_f32_16x16x32_bf16 v[200:203], a[76:79], a[104:107], v[200:203]
    v_accvgpr_read_b32 v63, a135
    v_cvt_pk_bf16_f32 v98, v192, v193
    v_cvt_pk_bf16_f32 v160, v56, v57
    v_mfma_f32_16x16x32_bf16 v[108:111], a[72:75], a[108:111], v[108:111]
    v_cvt_pk_bf16_f32 v99, v194, v195
    v_cvt_pk_bf16_f32 v161, v58, v59
    v_cvt_pk_bf16_f32 v100, v100, v101
    v_mfma_f32_16x16x32_bf16 v[204:207], a[76:79], a[108:111], v[204:207]
    buffer_load_dwordx4 v38, s[12:15], s61 offen offset:0 lds
    buffer_load_dwordx4 v39, s[12:15], s61 offen offset:1024 lds
    v_mfma_f32_16x16x32_bf16 a[144:147], a[88:91], a[104:107], a[144:147]
    v_cvt_pk_bf16_f32 v162, v60, v61
    v_cvt_pk_bf16_f32 v101, v102, v103
    v_cvt_pk_bf16_f32 v163, v62, v63
    v_mfma_f32_16x16x32_bf16 a[148:151], a[92:95], a[104:107], a[148:151]
    v_cvt_pk_bf16_f32 v102, v196, v197
    v_cvt_pk_bf16_f32 v103, v198, v199
    v_accvgpr_read_b32 v56, a136
    v_mfma_f32_16x16x32_bf16 v[112:115], a[72:75], a[112:115], v[112:115]
    v_accvgpr_read_b32 v57, a137
    v_accvgpr_read_b32 v58, a138
    v_accvgpr_read_b32 v59, a139
    v_mfma_f32_16x16x32_bf16 v[208:211], a[76:79], a[112:115], v[208:211]
    v_accvgpr_read_b32 v60, a140
    v_cvt_pk_bf16_f32 v104, v104, v105
    v_accvgpr_read_b32 v61, a141
    v_mfma_f32_16x16x32_bf16 v[116:119], a[72:75], a[116:119], v[116:119]
    buffer_load_dwordx4 v40, s[12:15], s61 offen offset:2048 lds
    buffer_load_dwordx4 v41, s[12:15], s61 offen offset:3072 lds
    v_mfma_f32_16x16x32_bf16 v[212:215], a[76:79], a[116:119], v[212:215]
    s_add_u32 s61, s61, 0x80000
    v_accvgpr_read_b32 v62, a142
    v_cvt_pk_bf16_f32 v105, v106, v107
    v_accvgpr_read_b32 v63, a143
    v_mfma_f32_16x16x32_bf16 a[152:155], a[88:91], a[108:111], a[152:155]
    v_cvt_pk_bf16_f32 v106, v200, v201
    v_cvt_pk_bf16_f32 v164, v56, v57
    v_cvt_pk_bf16_f32 v107, v202, v203
    v_mfma_f32_16x16x32_bf16 a[156:159], a[92:95], a[108:111], a[156:159]
    v_cvt_pk_bf16_f32 v165, v58, v59
    v_cvt_pk_bf16_f32 v108, v108, v109
    v_cvt_pk_bf16_f32 v166, v60, v61
    v_mfma_f32_16x16x32_bf16 v[120:123], a[72:75], a[120:123], v[120:123]
    v_cvt_pk_bf16_f32 v109, v110, v111
    v_cvt_pk_bf16_f32 v167, v62, v63
    v_cvt_pk_bf16_f32 v110, v204, v205
    v_mfma_f32_16x16x32_bf16 v[216:219], a[76:79], a[120:123], v[216:219]
    buffer_load_dwordx4 a[224:227], v36, s[8:11], s62 offen offset:0 sc1
    v_cvt_pk_bf16_f32 v111, v206, v207
    v_accvgpr_read_b32 v56, a144
    v_mfma_f32_16x16x32_bf16 v[124:127], a[72:75], a[124:127], v[124:127]
    v_accvgpr_read_b32 v57, a145
    v_accvgpr_read_b32 v58, a146
    v_accvgpr_read_b32 v59, a147
    v_mfma_f32_16x16x32_bf16 v[220:223], a[76:79], a[124:127], v[220:223]
    buffer_load_dwordx4 a[228:231], v36, s[8:11], s62 offen offset:1024 sc1
    v_accvgpr_read_b32 v60, a148
    v_cvt_pk_bf16_f32 v112, v112, v113
    v_mfma_f32_16x16x32_bf16 a[160:163], a[88:91], a[112:115], a[160:163]
    v_accvgpr_read_b32 v61, a149
    v_accvgpr_read_b32 v62, a150
    v_cvt_pk_bf16_f32 v113, v114, v115
    v_mfma_f32_16x16x32_bf16 a[164:167], a[92:95], a[112:115], a[164:167]
    v_accvgpr_read_b32 v63, a151
    v_cvt_pk_bf16_f32 v114, v208, v209
    v_cvt_pk_bf16_f32 v168, v56, v57
    v_mfma_f32_16x16x32_bf16 v[128:131], a[80:83], a[96:99], v[128:131]
    v_cvt_pk_bf16_f32 v115, v210, v211
    v_cvt_pk_bf16_f32 v169, v58, v59
    v_cvt_pk_bf16_f32 v116, v116, v117
    v_mfma_f32_16x16x32_bf16 v[224:227], a[84:87], a[96:99], v[224:227]
    buffer_load_dwordx4 a[232:235], v37, s[8:11], s62 offen offset:0 sc1
    v_cvt_pk_bf16_f32 v170, v60, v61
    v_cvt_pk_bf16_f32 v117, v118, v119
    v_mfma_f32_16x16x32_bf16 v[132:135], a[80:83], a[100:103], v[132:135]
    v_cvt_pk_bf16_f32 v171, v62, v63
    v_cvt_pk_bf16_f32 v118, v212, v213
    v_cvt_pk_bf16_f32 v119, v214, v215
    v_mfma_f32_16x16x32_bf16 v[228:231], a[84:87], a[100:103], v[228:231]
    buffer_load_dwordx4 a[236:239], v37, s[8:11], s62 offen offset:1024 sc1
    v_accvgpr_read_b32 v56, a152
    v_accvgpr_read_b32 v57, a153
    v_mfma_f32_16x16x32_bf16 a[168:171], a[88:91], a[116:119], a[168:171]
    s_add_u32 s62, s62, 0x20000
    v_accvgpr_read_b32 v58, a154
    v_accvgpr_read_b32 v59, a155
    v_accvgpr_read_b32 v60, a156
    v_mfma_f32_16x16x32_bf16 a[172:175], a[92:95], a[116:119], a[172:175]
    s_waitcnt vmcnt(16)
    s_barrier
    v_cvt_pk_bf16_f32 v120, v120, v121
    v_accvgpr_read_b32 v61, a157
    v_accvgpr_read_b32 v62, a158
    v_mfma_f32_16x16x32_bf16 v[136:139], a[80:83], a[104:107], v[136:139]
    v_cvt_pk_bf16_f32 v121, v122, v123
    v_accvgpr_read_b32 v63, a159
    v_cvt_pk_bf16_f32 v122, v216, v217
    v_mfma_f32_16x16x32_bf16 v[232:235], a[84:87], a[104:107], v[232:235]
    v_cvt_pk_bf16_f32 v172, v56, v57
    v_cvt_pk_bf16_f32 v123, v218, v219
    v_cvt_pk_bf16_f32 v173, v58, v59
    v_mfma_f32_16x16x32_bf16 v[140:143], a[80:83], a[108:111], v[140:143]
    v_cvt_pk_bf16_f32 v124, v124, v125
    v_cvt_pk_bf16_f32 v174, v60, v61
    v_cvt_pk_bf16_f32 v125, v126, v127
    v_mfma_f32_16x16x32_bf16 v[236:239], a[84:87], a[108:111], v[236:239]
    v_cvt_pk_bf16_f32 v175, v62, v63
    v_cvt_pk_bf16_f32 v126, v220, v221
    v_cvt_pk_bf16_f32 v127, v222, v223
    v_mfma_f32_16x16x32_bf16 a[176:179], a[88:91], a[120:123], a[176:179]
    ds_read_b64_tr_b16 a[0:1], v42 offset:0
    v_accvgpr_read_b32 v56, a160
    v_accvgpr_read_b32 v57, a161
    v_mfma_f32_16x16x32_bf16 a[180:183], a[92:95], a[120:123], a[180:183]
    ds_read_b64_tr_b16 a[2:3], v42 offset:1024
    v_accvgpr_read_b32 v58, a162
    v_accvgpr_read_b32 v59, a163
    v_mfma_f32_16x16x32_bf16 v[144:147], a[80:83], a[112:115], v[144:147]
    ds_read_b64_tr_b16 a[4:5], v43 offset:0
    v_accvgpr_read_b32 v60, a164
    v_cvt_pk_bf16_f32 v128, v128, v129
    v_mfma_f32_16x16x32_bf16 v[240:243], a[84:87], a[112:115], v[240:243]
    v_accvgpr_read_b32 v61, a165
    v_accvgpr_read_b32 v62, a166
    v_cvt_pk_bf16_f32 v129, v130, v131
    v_mfma_f32_16x16x32_bf16 v[148:151], a[80:83], a[116:119], v[148:151]
    ds_read_b64_tr_b16 a[6:7], v43 offset:1024
    v_accvgpr_read_b32 v63, a167
    v_cvt_pk_bf16_f32 v130, v224, v225
    v_mfma_f32_16x16x32_bf16 v[244:247], a[84:87], a[116:119], v[244:247]
    v_cvt_pk_bf16_f32 v176, v56, v57
    v_cvt_pk_bf16_f32 v131, v226, v227
    v_cvt_pk_bf16_f32 v177, v58, v59
    v_mfma_f32_16x16x32_bf16 a[184:187], a[88:91], a[124:127], a[184:187]
    ds_read_b64_tr_b16 a[8:9], v44 offset:0
    v_cvt_pk_bf16_f32 v132, v132, v133
    v_cvt_pk_bf16_f32 v178, v60, v61
    v_mfma_f32_16x16x32_bf16 a[188:191], a[92:95], a[124:127], a[188:191]
    ds_read_b64_tr_b16 a[10:11], v44 offset:1024
    v_cvt_pk_bf16_f32 v133, v134, v135
    v_cvt_pk_bf16_f32 v179, v62, v63
    v_mfma_f32_16x16x32_bf16 v[152:155], a[80:83], a[120:123], v[152:155]
    ds_read_b64_tr_b16 a[12:13], v45 offset:0
    v_cvt_pk_bf16_f32 v134, v228, v229
    v_cvt_pk_bf16_f32 v135, v230, v231
    v_mfma_f32_16x16x32_bf16 v[248:251], a[84:87], a[120:123], v[248:251]
    ds_read_b64_tr_b16 a[14:15], v45 offset:1024
    v_accvgpr_read_b32 v56, a168
    v_accvgpr_read_b32 v57, a169
    v_mfma_f32_16x16x32_bf16 v[156:159], a[80:83], a[124:127], v[156:159]
    ds_read_b64_tr_b16 a[16:17], v46 offset:0
    v_accvgpr_read_b32 v58, a170
    v_accvgpr_read_b32 v59, a171
    v_mfma_f32_16x16x32_bf16 v[252:255], a[84:87], a[124:127], v[252:255]
    v_accvgpr_read_b32 v60, a172
    v_cvt_pk_bf16_f32 v136, v136, v137
    v_accvgpr_read_b32 v61, a173
    ds_read_b64_tr_b16 a[18:19], v46 offset:1024
    v_accvgpr_read_b32 v62, a174
    v_cvt_pk_bf16_f32 v137, v138, v139
    v_accvgpr_read_b32 v63, a175
    v_cvt_pk_bf16_f32 v138, v232, v233
    v_cvt_pk_bf16_f32 v180, v56, v57
    ds_read_b64_tr_b16 a[20:21], v47 offset:0
    v_cvt_pk_bf16_f32 v139, v234, v235
    v_cvt_pk_bf16_f32 v181, v58, v59
    v_cvt_pk_bf16_f32 v140, v140, v141
    v_cvt_pk_bf16_f32 v182, v60, v61
    ds_read_b64_tr_b16 a[22:23], v47 offset:1024
    v_cvt_pk_bf16_f32 v141, v142, v143
    v_cvt_pk_bf16_f32 v183, v62, v63
    v_cvt_pk_bf16_f32 v142, v236, v237
    ds_read_b64_tr_b16 a[24:25], v48 offset:0
    v_cvt_pk_bf16_f32 v143, v238, v239
    v_accvgpr_read_b32 v56, a176
    ds_read_b64_tr_b16 a[26:27], v48 offset:1024
    v_accvgpr_read_b32 v57, a177
    v_accvgpr_read_b32 v58, a178
    ds_read_b64_tr_b16 a[28:29], v49 offset:0
    v_accvgpr_read_b32 v59, a179
    v_accvgpr_read_b32 v60, a180
    v_cvt_pk_bf16_f32 v144, v144, v145
    ds_read_b64_tr_b16 a[30:31], v49 offset:1024
    v_accvgpr_read_b32 v61, a181
    v_accvgpr_read_b32 v62, a182
    v_cvt_pk_bf16_f32 v145, v146, v147
    v_accvgpr_read_b32 v63, a183
    v_cvt_pk_bf16_f32 v146, v240, v241
    v_cvt_pk_bf16_f32 v184, v56, v57
    v_cvt_pk_bf16_f32 v147, v242, v243
    v_cvt_pk_bf16_f32 v185, v58, v59
    v_cvt_pk_bf16_f32 v148, v148, v149
    v_cvt_pk_bf16_f32 v186, v60, v61
    v_cvt_pk_bf16_f32 v149, v150, v151
    v_cvt_pk_bf16_f32 v187, v62, v63
    v_cvt_pk_bf16_f32 v150, v244, v245
    v_cvt_pk_bf16_f32 v151, v246, v247
    v_accvgpr_read_b32 v56, a184
    v_accvgpr_read_b32 v57, a185
    v_accvgpr_read_b32 v58, a186
    v_accvgpr_read_b32 v59, a187
    v_accvgpr_read_b32 v60, a188
    v_cvt_pk_bf16_f32 v152, v152, v153
    v_accvgpr_read_b32 v61, a189
    v_accvgpr_read_b32 v62, a190
    v_cvt_pk_bf16_f32 v153, v154, v155
    v_accvgpr_read_b32 v63, a191
    v_cvt_pk_bf16_f32 v154, v248, v249
    v_cvt_pk_bf16_f32 v188, v56, v57
    v_cvt_pk_bf16_f32 v155, v250, v251
    v_cvt_pk_bf16_f32 v189, v58, v59
    v_cvt_pk_bf16_f32 v156, v156, v157
    v_cvt_pk_bf16_f32 v190, v60, v61
    v_cvt_pk_bf16_f32 v157, v158, v159
    v_cvt_pk_bf16_f32 v191, v62, v63
    v_cvt_pk_bf16_f32 v158, v252, v253
    v_cvt_pk_bf16_f32 v159, v254, v255
k12_join_7:
k12_qcode:
    s_mov_b64 s[48:49], s[32:33]
    s_mov_b32 s51, 0x00020000
    s_cmp_eq_u32 s45, 0
    s_mov_b32 s50, s34
    s_cselect_b32 s56, s30, -1
    s_cselect_b32 s57, -1, s30
    s_waitcnt vmcnt(12) lgkmcnt(0)
    v_mfma_f32_16x16x32_bf16 v[192:195], a[0:3], a[192:195], 0
    ds_read_b64_tr_b16 a[32:33], v42 offset:8192
    ds_read_b64_tr_b16 a[34:35], v42 offset:9216
    v_mfma_f32_16x16x32_bf16 v[196:199], a[0:3], a[196:199], 0
    buffer_load_dwordx4 a[240:243], v36, s[8:11], s62 offen offset:0 sc1
    v_mfma_f32_16x16x32_bf16 a[64:67], a[0:3], a[200:203], 0
    ds_read_b64_tr_b16 a[36:37], v43 offset:8192
    v_mfma_f32_16x16x32_bf16 a[68:71], a[0:3], a[204:207], 0
    ds_read_b64_tr_b16 a[38:39], v43 offset:9216
    v_mfma_f32_16x16x32_bf16 v[200:203], a[4:7], a[192:195], 0
    ds_read_b64_tr_b16 a[40:41], v44 offset:8192
    v_mfma_f32_16x16x32_bf16 v[204:207], a[4:7], a[196:199], 0
    buffer_load_dwordx4 a[244:247], v36, s[8:11], s62 offen offset:1024 sc1
    v_mfma_f32_16x16x32_bf16 a[72:75], a[4:7], a[200:203], 0
    s_lshl_b32 s31, s28, 14
    ds_read_b64_tr_b16 a[42:43], v44 offset:9216
    v_mfma_f32_16x16x32_bf16 a[76:79], a[4:7], a[204:207], 0
    s_add_u32 s16, s6, s31
    s_addc_u32 s17, s7, 0
    ds_read_b64_tr_b16 a[44:45], v45 offset:8192
    v_mfma_f32_16x16x32_bf16 v[208:211], a[8:11], a[192:195], 0
    v_mfma_f32_16x16x32_bf16 v[212:215], a[8:11], a[196:199], 0
    s_add_u32 s20, s16, 0x2000000
    s_addc_u32 s21, s17, 0
    ds_read_b64_tr_b16 a[46:47], v45 offset:9216
    v_mfma_f32_16x16x32_bf16 a[80:83], a[8:11], a[200:203], 0
    buffer_load_dwordx4 a[248:251], v37, s[8:11], s62 offen offset:0 sc1
    ds_read_b64_tr_b16 a[48:49], v46 offset:8192
    v_mfma_f32_16x16x32_bf16 a[84:87], a[8:11], a[204:207], 0
    s_add_u32 s16, s16, 0x1000000
    s_addc_u32 s17, s17, 0
    ds_read_b64_tr_b16 a[50:51], v46 offset:9216
    v_mfma_f32_16x16x32_bf16 v[216:219], a[12:15], a[192:195], 0
    v_mfma_f32_16x16x32_bf16 v[220:223], a[12:15], a[196:199], 0
    s_and_b32 s17, s17, 0xffff
    ds_read_b64_tr_b16 a[52:53], v47 offset:8192
    v_mfma_f32_16x16x32_bf16 a[88:91], a[12:15], a[200:203], 0
    buffer_load_dwordx4 a[252:255], v37, s[8:11], s62 offen offset:1024 sc1
    ds_read_b64_tr_b16 a[54:55], v47 offset:9216
    v_mfma_f32_16x16x32_bf16 a[92:95], a[12:15], a[204:207], 0
    s_and_b32 s21, s21, 0xffff
    ds_read_b64_tr_b16 a[56:57], v48 offset:8192
    v_mfma_f32_16x16x32_bf16 v[224:227], a[16:19], a[192:195], 0
    v_mfma_f32_16x16x32_bf16 v[228:231], a[16:19], a[196:199], 0
    s_lshl_b32 s31, s29, 20
    ds_read_b64_tr_b16 a[58:59], v48 offset:9216
    v_mfma_f32_16x16x32_bf16 a[96:99], a[16:19], a[200:203], 0
    s_add_u32 s62, s62, 0x20000
    ds_read_b64_tr_b16 a[60:61], v49 offset:8192
    v_mfma_f32_16x16x32_bf16 a[100:103], a[16:19], a[204:207], 0
    s_add_u32 s52, s47, 0
    v_mfma_f32_16x16x32_bf16 v[232:235], a[20:23], a[192:195], 0
    s_sub_u32 s18, 0xf84000, s31
    buffer_store_dwordx4 v[64:67], v1, s[48:51], s52 offen offset:0 sc1
    ds_read_b64_tr_b16 a[62:63], v49 offset:9216
    v_mfma_f32_16x16x32_bf16 v[236:239], a[20:23], a[196:199], 0
    s_add_u32 s52, s47, 0
    v_mfma_f32_16x16x32_bf16 a[104:107], a[20:23], a[200:203], 0
    s_mov_b32 s22, s18
    v_mfma_f32_16x16x32_bf16 a[108:111], a[20:23], a[204:207], 0
    s_add_u32 s24, s6, 0x4806000
    s_addc_u32 s25, s7, 0
    buffer_store_dwordx4 v[68:71], v1, s[48:51], s52 offen offset:1024 sc1
    v_mfma_f32_16x16x32_bf16 v[240:243], a[24:27], a[192:195], 0
    v_mfma_f32_16x16x32_bf16 v[244:247], a[24:27], a[196:199], 0
    s_and_b32 s25, s25, 0xffff
    v_mfma_f32_16x16x32_bf16 a[112:115], a[24:27], a[200:203], 0
    v_mfma_f32_16x16x32_bf16 a[116:119], a[24:27], a[204:207], 0
    s_mov_b32 s26, 4096
    v_mfma_f32_16x16x32_bf16 v[248:251], a[28:31], a[192:195], 0
    s_cmp_eq_u32 s45, 0
    s_cbranch_scc1 k12_ool_40
k12_oolret_41:
    v_mfma_f32_16x16x32_bf16 v[252:255], a[28:31], a[196:199], 0
    v_mfma_f32_16x16x32_bf16 a[120:123], a[28:31], a[200:203], 0
    v_mfma_f32_16x16x32_bf16 a[124:127], a[28:31], a[204:207], 0
    s_waitcnt vmcnt(10) lgkmcnt(0)
    s_barrier
    v_mfma_f32_16x16x32_bf16 v[192:195], a[32:35], a[208:211], v[192:195]
    ds_read_b64_tr_b16 a[0:1], v42 offset:16384
    ds_read_b64_tr_b16 a[2:3], v42 offset:17408
    v_mfma_f32_16x16x32_bf16 v[196:199], a[32:35], a[212:215], v[196:199]
    s_add_u32 m0, s60, 131072
    v_mfma_f32_16x16x32_bf16 a[64:67], a[32:35], a[216:219], a[64:67]
    buffer_load_dwordx4 v38, s[12:15], s61 offen offset:0 lds
    ds_read_b64_tr_b16 a[4:5], v43 offset:16384
    v_mfma_f32_16x16x32_bf16 a[68:71], a[32:35], a[220:223], a[68:71]
    ds_read_b64_tr_b16 a[6:7], v43 offset:17408
    v_mfma_f32_16x16x32_bf16 v[200:203], a[36:39], a[208:211], v[200:203]
    buffer_load_dwordx4 v39, s[12:15], s61 offen offset:1024 lds
    ds_read_b64_tr_b16 a[8:9], v44 offset:16384
    v_mfma_f32_16x16x32_bf16 v[204:207], a[36:39], a[212:215], v[204:207]
    v_mfma_f32_16x16x32_bf16 a[72:75], a[36:39], a[216:219], a[72:75]
    ds_read_b64_tr_b16 a[10:11], v44 offset:17408
    v_mfma_f32_16x16x32_bf16 a[76:79], a[36:39], a[220:223], a[76:79]
    buffer_load_dwordx4 v40, s[12:15], s61 offen offset:2048 lds
    ds_read_b64_tr_b16 a[12:13], v45 offset:16384
    v_mfma_f32_16x16x32_bf16 v[208:211], a[40:43], a[208:211], v[208:211]
    v_mfma_f32_16x16x32_bf16 v[212:215], a[40:43], a[212:215], v[212:215]
    ds_read_b64_tr_b16 a[14:15], v45 offset:17408
    v_mfma_f32_16x16x32_bf16 a[80:83], a[40:43], a[216:219], a[80:83]
    buffer_load_dwordx4 v41, s[12:15], s61 offen offset:3072 lds
    ds_read_b64_tr_b16 a[16:17], v46 offset:16384
    v_mfma_f32_16x16x32_bf16 a[84:87], a[40:43], a[220:223], a[84:87]
    ds_read_b64_tr_b16 a[18:19], v46 offset:17408
    v_mfma_f32_16x16x32_bf16 v[216:219], a[44:47], a[208:211], v[216:219]
    s_add_u32 s61, s61, 0x80000
    v_mfma_f32_16x16x32_bf16 v[220:223], a[44:47], a[212:215], v[220:223]
    buffer_load_dwordx4 a[128:131], v36, s[8:11], s62 offen offset:0 sc1
    ds_read_b64_tr_b16 a[20:21], v47 offset:16384
    v_mfma_f32_16x16x32_bf16 a[88:91], a[44:47], a[216:219], a[88:91]
    ds_read_b64_tr_b16 a[22:23], v47 offset:17408
    v_mfma_f32_16x16x32_bf16 a[92:95], a[44:47], a[220:223], a[92:95]
    buffer_load_dwordx4 a[132:135], v36, s[8:11], s62 offen offset:1024 sc1
    ds_read_b64_tr_b16 a[24:25], v48 offset:16384
    v_mfma_f32_16x16x32_bf16 v[224:227], a[48:51], a[208:211], v[224:227]
    v_mfma_f32_16x16x32_bf16 v[228:231], a[48:51], a[212:215], v[228:231]
    ds_read_b64_tr_b16 a[26:27], v48 offset:17408
    v_mfma_f32_16x16x32_bf16 a[96:99], a[48:51], a[216:219], a[96:99]
    buffer_load_dwordx4 a[136:139], v37, s[8:11], s62 offen offset:0 sc1
    ds_read_b64_tr_b16 a[28:29], v49 offset:16384
    v_mfma_f32_16x16x32_bf16 a[100:103], a[48:51], a[220:223], a[100:103]
    v_mfma_f32_16x16x32_bf16 v[232:235], a[52:55], a[208:211], v[232:235]
    ds_read_b64_tr_b16 a[30:31], v49 offset:17408
    v_mfma_f32_16x16x32_bf16 v[236:239], a[52:55], a[212:215], v[236:239]
    buffer_load_dwordx4 a[140:143], v37, s[8:11], s62 offen offset:1024 sc1
    v_mfma_f32_16x16x32_bf16 a[104:107], a[52:55], a[216:219], a[104:107]
    v_mfma_f32_16x16x32_bf16 a[108:111], a[52:55], a[220:223], a[108:111]
    s_add_u32 s62, s62, 0x20000
    v_mfma_f32_16x16x32_bf16 v[240:243], a[56:59], a[208:211], v[240:243]
    s_add_u32 s52, s47, 0
    v_mfma_f32_16x16x32_bf16 v[244:247], a[56:59], a[212:215], v[244:247]
    buffer_store_dwordx4 v[72:75], v1, s[48:51], s52 offen offset:2048 sc1
    v_mfma_f32_16x16x32_bf16 a[112:115], a[56:59], a[216:219], a[112:115]
    v_mfma_f32_16x16x32_bf16 a[116:119], a[56:59], a[220:223], a[116:119]
    v_mfma_f32_16x16x32_bf16 v[248:251], a[60:63], a[208:211], v[248:251]
    v_mfma_f32_16x16x32_bf16 v[252:255], a[60:63], a[212:215], v[252:255]
    v_mfma_f32_16x16x32_bf16 a[120:123], a[60:63], a[216:219], a[120:123]
    v_mfma_f32_16x16x32_bf16 a[124:127], a[60:63], a[220:223], a[124:127]
    s_waitcnt vmcnt(15) lgkmcnt(0)
    v_mfma_f32_16x16x32_bf16 v[192:195], a[0:3], a[224:227], v[192:195]
    ds_read_b64_tr_b16 a[32:33], v42 offset:24576
    ds_read_b64_tr_b16 a[34:35], v42 offset:25600
    v_mfma_f32_16x16x32_bf16 v[196:199], a[0:3], a[228:231], v[196:199]
    buffer_load_dwordx4 a[144:147], v36, s[8:11], s62 offen offset:0 sc1
    v_mfma_f32_16x16x32_bf16 a[64:67], a[0:3], a[232:235], a[64:67]
    ds_read_b64_tr_b16 a[36:37], v43 offset:24576
    v_mfma_f32_16x16x32_bf16 a[68:71], a[0:3], a[236:239], a[68:71]
    ds_read_b64_tr_b16 a[38:39], v43 offset:25600
    v_mfma_f32_16x16x32_bf16 v[200:203], a[4:7], a[224:227], v[200:203]
    ds_read_b64_tr_b16 a[40:41], v44 offset:24576
    v_mfma_f32_16x16x32_bf16 v[204:207], a[4:7], a[228:231], v[204:207]
    v_mfma_f32_16x16x32_bf16 a[72:75], a[4:7], a[232:235], a[72:75]
    buffer_load_dwordx4 a[148:151], v36, s[8:11], s62 offen offset:1024 sc1
    ds_read_b64_tr_b16 a[42:43], v44 offset:25600
    v_mfma_f32_16x16x32_bf16 a[76:79], a[4:7], a[236:239], a[76:79]
    ds_read_b64_tr_b16 a[44:45], v45 offset:24576
    v_mfma_f32_16x16x32_bf16 v[208:211], a[8:11], a[224:227], v[208:211]
    v_mfma_f32_16x16x32_bf16 v[212:215], a[8:11], a[228:231], v[212:215]
    ds_read_b64_tr_b16 a[46:47], v45 offset:25600
    v_mfma_f32_16x16x32_bf16 a[80:83], a[8:11], a[232:235], a[80:83]
    ds_read_b64_tr_b16 a[48:49], v46 offset:24576
    v_mfma_f32_16x16x32_bf16 a[84:87], a[8:11], a[236:239], a[84:87]
    buffer_load_dwordx4 a[152:155], v37, s[8:11], s62 offen offset:0 sc1
    ds_read_b64_tr_b16 a[50:51], v46 offset:25600
    v_mfma_f32_16x16x32_bf16 v[216:219], a[12:15], a[224:227], v[216:219]
    v_mfma_f32_16x16x32_bf16 v[220:223], a[12:15], a[228:231], v[220:223]
    ds_read_b64_tr_b16 a[52:53], v47 offset:24576
    v_mfma_f32_16x16x32_bf16 a[88:91], a[12:15], a[232:235], a[88:91]
    ds_read_b64_tr_b16 a[54:55], v47 offset:25600
    v_mfma_f32_16x16x32_bf16 a[92:95], a[12:15], a[236:239], a[92:95]
    ds_read_b64_tr_b16 a[56:57], v48 offset:24576
    v_mfma_f32_16x16x32_bf16 v[224:227], a[16:19], a[224:227], v[224:227]
    v_mfma_f32_16x16x32_bf16 v[228:231], a[16:19], a[228:231], v[228:231]
    buffer_load_dwordx4 a[156:159], v37, s[8:11], s62 offen offset:1024 sc1
    ds_read_b64_tr_b16 a[58:59], v48 offset:25600
    v_mfma_f32_16x16x32_bf16 a[96:99], a[16:19], a[232:235], a[96:99]
    ds_read_b64_tr_b16 a[60:61], v49 offset:24576
    v_mfma_f32_16x16x32_bf16 a[100:103], a[16:19], a[236:239], a[100:103]
    v_mfma_f32_16x16x32_bf16 v[232:235], a[20:23], a[224:227], v[232:235]
    ds_read_b64_tr_b16 a[62:63], v49 offset:25600
    v_mfma_f32_16x16x32_bf16 v[236:239], a[20:23], a[228:231], v[236:239]
    s_add_u32 s62, s62, 0x20000
    v_mfma_f32_16x16x32_bf16 a[104:107], a[20:23], a[232:235], a[104:107]
    s_add_u32 s52, s47, 0
    v_mfma_f32_16x16x32_bf16 a[108:111], a[20:23], a[236:239], a[108:111]
    buffer_store_dwordx4 v[76:79], v1, s[48:51], s52 offen offset:3072 sc1
    v_mfma_f32_16x16x32_bf16 v[240:243], a[24:27], a[224:227], v[240:243]
    v_mfma_f32_16x16x32_bf16 v[244:247], a[24:27], a[228:231], v[244:247]
    v_mfma_f32_16x16x32_bf16 a[112:115], a[24:27], a[232:235], a[112:115]
    v_mfma_f32_16x16x32_bf16 a[116:119], a[24:27], a[236:239], a[116:119]
    v_mfma_f32_16x16x32_bf16 v[248:251], a[28:31], a[224:227], v[248:251]
    s_cmp_eq_u32 s45, 0
    s_cbranch_scc1 k12_ool_42
k12_oolret_43:
    v_mfma_f32_16x16x32_bf16 v[252:255], a[28:31], a[228:231], v[252:255]
    v_mfma_f32_16x16x32_bf16 a[120:123], a[28:31], a[232:235], a[120:123]
    v_mfma_f32_16x16x32_bf16 a[124:127], a[28:31], a[236:239], a[124:127]
    s_waitcnt vmcnt(10) lgkmcnt(0)
    s_barrier
    v_mfma_f32_16x16x32_bf16 v[192:195], a[32:35], a[240:243], v[192:195]
    ds_read_b64_tr_b16 a[0:1], v42 offset:32768
    ds_read_b64_tr_b16 a[2:3], v42 offset:33792
    v_mfma_f32_16x16x32_bf16 v[196:199], a[32:35], a[244:247], v[196:199]
    s_add_u32 m0, s60, 147456
    v_mfma_f32_16x16x32_bf16 a[64:67], a[32:35], a[248:251], a[64:67]
    buffer_load_dwordx4 v38, s[12:15], s61 offen offset:0 lds
    ds_read_b64_tr_b16 a[4:5], v43 offset:32768
    v_mfma_f32_16x16x32_bf16 a[68:71], a[32:35], a[252:255], a[68:71]
    ds_read_b64_tr_b16 a[6:7], v43 offset:33792
    v_mfma_f32_16x16x32_bf16 v[200:203], a[36:39], a[240:243], v[200:203]
    buffer_load_dwordx4 v39, s[12:15], s61 offen offset:1024 lds
    ds_read_b64_tr_b16 a[8:9], v44 offset:32768
    v_mfma_f32_16x16x32_bf16 v[204:207], a[36:39], a[244:247], v[204:207]
    v_mfma_f32_16x16x32_bf16 a[72:75], a[36:39], a[248:251], a[72:75]
    ds_read_b64_tr_b16 a[10:11], v44 offset:33792
    v_mfma_f32_16x16x32_bf16 a[76:79], a[36:39], a[252:255], a[76:79]
    buffer_load_dwordx4 v40, s[12:15], s61 offen offset:2048 lds
    ds_read_b64_tr_b16 a[12:13], v45 offset:32768
    v_mfma_f32_16x16x32_bf16 v[208:211], a[40:43], a[240:243], v[208:211]
    v_mfma_f32_16x16x32_bf16 v[212:215], a[40:43], a[244:247], v[212:215]
    ds_read_b64_tr_b16 a[14:15], v45 offset:33792
    v_mfma_f32_16x16x32_bf16 a[80:83], a[40:43], a[248:251], a[80:83]
    buffer_load_dwordx4 v41, s[12:15], s61 offen offset:3072 lds
    ds_read_b64_tr_b16 a[16:17], v46 offset:32768
    v_mfma_f32_16x16x32_bf16 a[84:87], a[40:43], a[252:255], a[84:87]
    ds_read_b64_tr_b16 a[18:19], v46 offset:33792
    v_mfma_f32_16x16x32_bf16 v[216:219], a[44:47], a[240:243], v[216:219]
    s_add_u32 s61, s61, 0x80000
    v_mfma_f32_16x16x32_bf16 v[220:223], a[44:47], a[244:247], v[220:223]
    buffer_load_dwordx4 a[160:163], v36, s[8:11], s62 offen offset:0 sc1
    ds_read_b64_tr_b16 a[20:21], v47 offset:32768
    v_mfma_f32_16x16x32_bf16 a[88:91], a[44:47], a[248:251], a[88:91]
    ds_read_b64_tr_b16 a[22:23], v47 offset:33792
    v_mfma_f32_16x16x32_bf16 a[92:95], a[44:47], a[252:255], a[92:95]
    buffer_load_dwordx4 a[164:167], v36, s[8:11], s62 offen offset:1024 sc1
    ds_read_b64_tr_b16 a[24:25], v48 offset:32768
    v_mfma_f32_16x16x32_bf16 v[224:227], a[48:51], a[240:243], v[224:227]
    v_mfma_f32_16x16x32_bf16 v[228:231], a[48:51], a[244:247], v[228:231]
    ds_read_b64_tr_b16 a[26:27], v48 offset:33792
    v_mfma_f32_16x16x32_bf16 a[96:99], a[48:51], a[248:251], a[96:99]
    buffer_load_dwordx4 a[168:171], v37, s[8:11], s62 offen offset:0 sc1
    ds_read_b64_tr_b16 a[28:29], v49 offset:32768
    v_mfma_f32_16x16x32_bf16 a[100:103], a[48:51], a[252:255], a[100:103]
    v_mfma_f32_16x16x32_bf16 v[232:235], a[52:55], a[240:243], v[232:235]
    ds_read_b64_tr_b16 a[30:31], v49 offset:33792
    v_mfma_f32_16x16x32_bf16 v[236:239], a[52:55], a[244:247], v[236:239]
    buffer_load_dwordx4 a[172:175], v37, s[8:11], s62 offen offset:1024 sc1
    v_mfma_f32_16x16x32_bf16 a[104:107], a[52:55], a[248:251], a[104:107]
    v_mfma_f32_16x16x32_bf16 a[108:111], a[52:55], a[252:255], a[108:111]
    s_add_u32 s62, s62, 0x20000
    v_mfma_f32_16x16x32_bf16 v[240:243], a[56:59], a[240:243], v[240:243]
    s_add_u32 s52, s47, 4096
    v_mfma_f32_16x16x32_bf16 v[244:247], a[56:59], a[244:247], v[244:247]
    buffer_store_dwordx4 v[80:83], v1, s[48:51], s52 offen offset:0 sc1
    v_mfma_f32_16x16x32_bf16 a[112:115], a[56:59], a[248:251], a[112:115]
    v_mfma_f32_16x16x32_bf16 a[116:119], a[56:59], a[252:255], a[116:119]
    v_mfma_f32_16x16x32_bf16 v[248:251], a[60:63], a[240:243], v[248:251]
    v_mfma_f32_16x16x32_bf16 v[252:255], a[60:63], a[244:247], v[252:255]
    v_mfma_f32_16x16x32_bf16 a[120:123], a[60:63], a[248:251], a[120:123]
    v_mfma_f32_16x16x32_bf16 a[124:127], a[60:63], a[252:255], a[124:127]
    s_waitcnt vmcnt(15) lgkmcnt(0)
    v_mfma_f32_16x16x32_bf16 v[192:195], a[0:3], a[128:131], v[192:195]
    ds_read_b64_tr_b16 a[32:33], v42 offset:40960
    ds_read_b64_tr_b16 a[34:35], v42 offset:41984
    v_mfma_f32_16x16x32_bf16 v[196:199], a[0:3], a[132:135], v[196:199]
    buffer_load_dwordx4 a[176:179], v36, s[8:11], s62 offen offset:0 sc1
    v_mfma_f32_16x16x32_bf16 a[64:67], a[0:3], a[136:139], a[64:67]
    ds_read_b64_tr_b16 a[36:37], v43 offset:40960
    v_mfma_f32_16x16x32_bf16 a[68:71], a[0:3], a[140:143], a[68:71]
    ds_read_b64_tr_b16 a[38:39], v43 offset:41984
    v_mfma_f32_16x16x32_bf16 v[200:203], a[4:7], a[128:131], v[200:203]
    ds_read_b64_tr_b16 a[40:41], v44 offset:40960
    v_mfma_f32_16x16x32_bf16 v[204:207], a[4:7], a[132:135], v[204:207]
    v_mfma_f32_16x16x32_bf16 a[72:75], a[4:7], a[136:139], a[72:75]
    buffer_load_dwordx4 a[180:183], v36, s[8:11], s62 offen offset:1024 sc1
    ds_read_b64_tr_b16 a[42:43], v44 offset:41984
    v_mfma_f32_16x16x32_bf16 a[76:79], a[4:7], a[140:143], a[76:79]
    ds_read_b64_tr_b16 a[44:45], v45 offset:40960
    v_mfma_f32_16x16x32_bf16 v[208:211], a[8:11], a[128:131], v[208:211]
    v_mfma_f32_16x16x32_bf16 v[212:215], a[8:11], a[132:135], v[212:215]
    ds_read_b64_tr_b16 a[46:47], v45 offset:41984
    v_mfma_f32_16x16x32_bf16 a[80:83], a[8:11], a[136:139], a[80:83]
    ds_read_b64_tr_b16 a[48:49], v46 offset:40960
    v_mfma_f32_16x16x32_bf16 a[84:87], a[8:11], a[140:143], a[84:87]
    buffer_load_dwordx4 a[184:187], v37, s[8:11], s62 offen offset:0 sc1
    ds_read_b64_tr_b16 a[50:51], v46 offset:41984
    v_mfma_f32_16x16x32_bf16 v[216:219], a[12:15], a[128:131], v[216:219]
    v_mfma_f32_16x16x32_bf16 v[220:223], a[12:15], a[132:135], v[220:223]
    ds_read_b64_tr_b16 a[52:53], v47 offset:40960
    v_mfma_f32_16x16x32_bf16 a[88:91], a[12:15], a[136:139], a[88:91]
    ds_read_b64_tr_b16 a[54:55], v47 offset:41984
    v_mfma_f32_16x16x32_bf16 a[92:95], a[12:15], a[140:143], a[92:95]
    ds_read_b64_tr_b16 a[56:57], v48 offset:40960
    v_mfma_f32_16x16x32_bf16 v[224:227], a[16:19], a[128:131], v[224:227]
    v_mfma_f32_16x16x32_bf16 v[228:231], a[16:19], a[132:135], v[228:231]
    buffer_load_dwordx4 a[188:191], v37, s[8:11], s62 offen offset:1024 sc1
    ds_read_b64_tr_b16 a[58:59], v48 offset:41984
    v_mfma_f32_16x16x32_bf16 a[96:99], a[16:19], a[136:139], a[96:99]
    ds_read_b64_tr_b16 a[60:61], v49 offset:40960
    v_mfma_f32_16x16x32_bf16 a[100:103], a[16:19], a[140:143], a[100:103]
    v_mfma_f32_16x16x32_bf16 v[232:235], a[20:23], a[128:131], v[232:235]
    ds_read_b64_tr_b16 a[62:63], v49 offset:41984
    v_mfma_f32_16x16x32_bf16 v[236:239], a[20:23], a[132:135], v[236:239]
    s_add_u32 s62, s62, 0x20000
    v_mfma_f32_16x16x32_bf16 a[104:107], a[20:23], a[136:139], a[104:107]
    s_add_u32 s52, s47, 4096
    v_mfma_f32_16x16x32_bf16 a[108:111], a[20:23], a[140:143], a[108:111]
    buffer_store_dwordx4 v[84:87], v1, s[48:51], s52 offen offset:1024 sc1
    v_mfma_f32_16x16x32_bf16 v[240:243], a[24:27], a[128:131], v[240:243]
    v_mfma_f32_16x16x32_bf16 v[244:247], a[24:27], a[132:135], v[244:247]
    v_mfma_f32_16x16x32_bf16 a[112:115], a[24:27], a[136:139], a[112:115]
    v_mfma_f32_16x16x32_bf16 a[116:119], a[24:27], a[140:143], a[116:119]
    v_mfma_f32_16x16x32_bf16 v[248:251], a[28:31], a[128:131], v[248:251]
    s_cmp_eq_u32 s45, 0
    s_cbranch_scc1 k12_ool_44
k12_oolret_45:
    v_mfma_f32_16x16x32_bf16 v[252:255], a[28:31], a[132:135], v[252:255]
    v_mfma_f32_16x16x32_bf16 a[120:123], a[28:31], a[136:139], a[120:123]
    v_mfma_f32_16x16x32_bf16 a[124:127], a[28:31], a[140:143], a[124:127]
    s_waitcnt vmcnt(10) lgkmcnt(0)
    s_barrier
    v_mfma_f32_16x16x32_bf16 v[192:195], a[32:35], a[144:147], v[192:195]
    ds_read_b64_tr_b16 a[0:1], v42 offset:49152
    ds_read_b64_tr_b16 a[2:3], v42 offset:50176
    v_mfma_f32_16x16x32_bf16 v[196:199], a[32:35], a[148:151], v[196:199]
    s_add_u32 m0, s60, 98304
    v_mfma_f32_16x16x32_bf16 a[64:67], a[32:35], a[152:155], a[64:67]
    buffer_load_dwordx4 v38, s[12:15], s61 offen offset:0 lds
    ds_read_b64_tr_b16 a[4:5], v43 offset:49152
    v_mfma_f32_16x16x32_bf16 a[68:71], a[32:35], a[156:159], a[68:71]
    ds_read_b64_tr_b16 a[6:7], v43 offset:50176
    v_mfma_f32_16x16x32_bf16 v[200:203], a[36:39], a[144:147], v[200:203]
    buffer_load_dwordx4 v39, s[12:15], s61 offen offset:1024 lds
    ds_read_b64_tr_b16 a[8:9], v44 offset:49152
    v_mfma_f32_16x16x32_bf16 v[204:207], a[36:39], a[148:151], v[204:207]
    v_mfma_f32_16x16x32_bf16 a[72:75], a[36:39], a[152:155], a[72:75]
    ds_read_b64_tr_b16 a[10:11], v44 offset:50176
    v_mfma_f32_16x16x32_bf16 a[76:79], a[36:39], a[156:159], a[76:79]
    buffer_load_dwordx4 v40, s[12:15], s61 offen offset:2048 lds
    ds_read_b64_tr_b16 a[12:13], v45 offset:49152
    v_mfma_f32_16x16x32_bf16 v[208:211], a[40:43], a[144:147], v[208:211]
    v_mfma_f32_16x16x32_bf16 v[212:215], a[40:43], a[148:151], v[212:215]
    ds_read_b64_tr_b16 a[14:15], v45 offset:50176
    v_mfma_f32_16x16x32_bf16 a[80:83], a[40:43], a[152:155], a[80:83]
    buffer_load_dwordx4 v41, s[12:15], s61 offen offset:3072 lds
    ds_read_b64_tr_b16 a[16:17], v46 offset:49152
    v_mfma_f32_16x16x32_bf16 a[84:87], a[40:43], a[156:159], a[84:87]
    ds_read_b64_tr_b16 a[18:19], v46 offset:50176
    v_mfma_f32_16x16x32_bf16 v[216:219], a[44:47], a[144:147], v[216:219]
    s_add_u32 s61, s61, 0x80000
    v_mfma_f32_16x16x32_bf16 v[220:223], a[44:47], a[148:151], v[220:223]
    buffer_load_dwordx4 a[192:195], v36, s[8:11], s62 offen offset:0 sc1
    ds_read_b64_tr_b16 a[20:21], v47 offset:49152
    v_mfma_f32_16x16x32_bf16 a[88:91], a[44:47], a[152:155], a[88:91]
    ds_read_b64_tr_b16 a[22:23], v47 offset:50176
    v_mfma_f32_16x16x32_bf16 a[92:95], a[44:47], a[156:159], a[92:95]
    buffer_load_dwordx4 a[196:199], v36, s[8:11], s62 offen offset:1024 sc1
    ds_read_b64_tr_b16 a[24:25], v48 offset:49152
    v_mfma_f32_16x16x32_bf16 v[224:227], a[48:51], a[144:147], v[224:227]
    v_mfma_f32_16x16x32_bf16 v[228:231], a[48:51], a[148:151], v[228:231]
    ds_read_b64_tr_b16 a[26:27], v48 offset:50176
    v_mfma_f32_16x16x32_bf16 a[96:99], a[48:51], a[152:155], a[96:99]
    buffer_load_dwordx4 a[200:203], v37, s[8:11], s62 offen offset:0 sc1
    ds_read_b64_tr_b16 a[28:29], v49 offset:49152
    v_mfma_f32_16x16x32_bf16 a[100:103], a[48:51], a[156:159], a[100:103]
    v_mfma_f32_16x16x32_bf16 v[232:235], a[52:55], a[144:147], v[232:235]
    ds_read_b64_tr_b16 a[30:31], v49 offset:50176
    v_mfma_f32_16x16x32_bf16 v[236:239], a[52:55], a[148:151], v[236:239]
    buffer_load_dwordx4 a[204:207], v37, s[8:11], s62 offen offset:1024 sc1
    v_mfma_f32_16x16x32_bf16 a[104:107], a[52:55], a[152:155], a[104:107]
    v_mfma_f32_16x16x32_bf16 a[108:111], a[52:55], a[156:159], a[108:111]
    s_add_u32 s62, s62, 0x20000
    v_mfma_f32_16x16x32_bf16 v[240:243], a[56:59], a[144:147], v[240:243]
    s_add_u32 s52, s47, 4096
    v_mfma_f32_16x16x32_bf16 v[244:247], a[56:59], a[148:151], v[244:247]
    buffer_store_dwordx4 v[88:91], v1, s[48:51], s52 offen offset:2048 sc1
    v_mfma_f32_16x16x32_bf16 a[112:115], a[56:59], a[152:155], a[112:115]
    v_mfma_f32_16x16x32_bf16 a[116:119], a[56:59], a[156:159], a[116:119]
    v_mfma_f32_16x16x32_bf16 v[248:251], a[60:63], a[144:147], v[248:251]
    v_mfma_f32_16x16x32_bf16 v[252:255], a[60:63], a[148:151], v[252:255]
    v_mfma_f32_16x16x32_bf16 a[120:123], a[60:63], a[152:155], a[120:123]
    v_mfma_f32_16x16x32_bf16 a[124:127], a[60:63], a[156:159], a[124:127]
    s_waitcnt vmcnt(15) lgkmcnt(0)
    v_mfma_f32_16x16x32_bf16 v[192:195], a[0:3], a[160:163], v[192:195]
    ds_read_b64_tr_b16 a[32:33], v42 offset:57344
    ds_read_b64_tr_b16 a[34:35], v42 offset:58368
    v_mfma_f32_16x16x32_bf16 v[196:199], a[0:3], a[164:167], v[196:199]
    buffer_load_dwordx4 a[208:211], v36, s[8:11], s62 offen offset:0 sc1
    v_mfma_f32_16x16x32_bf16 a[64:67], a[0:3], a[168:171], a[64:67]
    ds_read_b64_tr_b16 a[36:37], v43 offset:57344
    v_mfma_f32_16x16x32_bf16 a[68:71], a[0:3], a[172:175], a[68:71]
    ds_read_b64_tr_b16 a[38:39], v43 offset:58368
    v_mfma_f32_16x16x32_bf16 v[200:203], a[4:7], a[160:163], v[200:203]
    ds_read_b64_tr_b16 a[40:41], v44 offset:57344
    v_mfma_f32_16x16x32_bf16 v[204:207], a[4:7], a[164:167], v[204:207]
    v_mfma_f32_16x16x32_bf16 a[72:75], a[4:7], a[168:171], a[72:75]
    buffer_load_dwordx4 a[212:215], v36, s[8:11], s62 offen offset:1024 sc1
    ds_read_b64_tr_b16 a[42:43], v44 offset:58368
    v_mfma_f32_16x16x32_bf16 a[76:79], a[4:7], a[172:175], a[76:79]
    ds_read_b64_tr_b16 a[44:45], v45 offset:57344
    v_mfma_f32_16x16x32_bf16 v[208:211], a[8:11], a[160:163], v[208:211]
    v_mfma_f32_16x16x32_bf16 v[212:215], a[8:11], a[164:167], v[212:215]
    ds_read_b64_tr_b16 a[46:47], v45 offset:58368
    v_mfma_f32_16x16x32_bf16 a[80:83], a[8:11], a[168:171], a[80:83]
    ds_read_b64_tr_b16 a[48:49], v46 offset:57344
    v_mfma_f32_16x16x32_bf16 a[84:87], a[8:11], a[172:175], a[84:87]
    buffer_load_dwordx4 a[216:219], v37, s[8:11], s62 offen offset:0 sc1
    ds_read_b64_tr_b16 a[50:51], v46 offset:58368
    v_mfma_f32_16x16x32_bf16 v[216:219], a[12:15], a[160:163], v[216:219]
    v_mfma_f32_16x16x32_bf16 v[220:223], a[12:15], a[164:167], v[220:223]
    ds_read_b64_tr_b16 a[52:53], v47 offset:57344
    v_mfma_f32_16x16x32_bf16 a[88:91], a[12:15], a[168:171], a[88:91]
    ds_read_b64_tr_b16 a[54:55], v47 offset:58368
    v_mfma_f32_16x16x32_bf16 a[92:95], a[12:15], a[172:175], a[92:95]
    ds_read_b64_tr_b16 a[56:57], v48 offset:57344
    v_mfma_f32_16x16x32_bf16 v[224:227], a[16:19], a[160:163], v[224:227]
    v_mfma_f32_16x16x32_bf16 v[228:231], a[16:19], a[164:167], v[228:231]
    buffer_load_dwordx4 a[220:223], v37, s[8:11], s62 offen offset:1024 sc1
    ds_read_b64_tr_b16 a[58:59], v48 offset:58368
    v_mfma_f32_16x16x32_bf16 a[96:99], a[16:19], a[168:171], a[96:99]
    ds_read_b64_tr_b16 a[60:61], v49 offset:57344
    v_mfma_f32_16x16x32_bf16 a[100:103], a[16:19], a[172:175], a[100:103]
    v_mfma_f32_16x16x32_bf16 v[232:235], a[20:23], a[160:163], v[232:235]
    ds_read_b64_tr_b16 a[62:63], v49 offset:58368
    v_mfma_f32_16x16x32_bf16 v[236:239], a[20:23], a[164:167], v[236:239]
    s_add_u32 s62, s62, 0x20000
    v_mfma_f32_16x16x32_bf16 a[104:107], a[20:23], a[168:171], a[104:107]
    s_add_u32 s52, s47, 4096
    v_mfma_f32_16x16x32_bf16 a[108:111], a[20:23], a[172:175], a[108:111]
    buffer_store_dwordx4 v[92:95], v1, s[48:51], s52 offen offset:3072 sc1
    v_mfma_f32_16x16x32_bf16 v[240:243], a[24:27], a[160:163], v[240:243]
    v_mfma_f32_16x16x32_bf16 v[244:247], a[24:27], a[164:167], v[244:247]
    v_mfma_f32_16x16x32_bf16 a[112:115], a[24:27], a[168:171], a[112:115]
    v_mfma_f32_16x16x32_bf16 a[116:119], a[24:27], a[172:175], a[116:119]
    v_mfma_f32_16x16x32_bf16 v[248:251], a[28:31], a[160:163], v[248:251]
    s_cmp_eq_u32 s45, 0
    s_cbranch_scc1 k12_ool_46
k12_oolret_47:
    v_mfma_f32_16x16x32_bf16 v[252:255], a[28:31], a[164:167], v[252:255]
    v_mfma_f32_16x16x32_bf16 a[120:123], a[28:31], a[168:171], a[120:123]
    v_mfma_f32_16x16x32_bf16 a[124:127], a[28:31], a[172:175], a[124:127]
    s_waitcnt vmcnt(10) lgkmcnt(0)
    s_barrier
    v_mfma_f32_16x16x32_bf16 v[192:195], a[32:35], a[176:179], v[192:195]
    ds_read_b64_tr_b16 a[0:1], v42 offset:0
    ds_read_b64_tr_b16 a[2:3], v42 offset:1024
    v_mfma_f32_16x16x32_bf16 v[196:199], a[32:35], a[180:183], v[196:199]
    s_add_u32 m0, s60, 114688
    v_mfma_f32_16x16x32_bf16 a[64:67], a[32:35], a[184:187], a[64:67]
    buffer_load_dwordx4 v38, s[12:15], s61 offen offset:0 lds
    ds_read_b64_tr_b16 a[4:5], v43 offset:0
    v_mfma_f32_16x16x32_bf16 a[68:71], a[32:35], a[188:191], a[68:71]
    ds_read_b64_tr_b16 a[6:7], v43 offset:1024
    v_mfma_f32_16x16x32_bf16 v[200:203], a[36:39], a[176:179], v[200:203]
    buffer_load_dwordx4 v39, s[12:15], s61 offen offset:1024 lds
    ds_read_b64_tr_b16 a[8:9], v44 offset:0
    v_mfma_f32_16x16x32_bf16 v[204:207], a[36:39], a[180:183], v[204:207]
    v_mfma_f32_16x16x32_bf16 a[72:75], a[36:39], a[184:187], a[72:75]
    ds_read_b64_tr_b16 a[10:11], v44 offset:1024
    v_mfma_f32_16x16x32_bf16 a[76:79], a[36:39], a[188:191], a[76:79]
    buffer_load_dwordx4 v40, s[12:15], s61 offen offset:2048 lds
    ds_read_b64_tr_b16 a[12:13], v45 offset:0
    v_mfma_f32_16x16x32_bf16 v[208:211], a[40:43], a[176:179], v[208:211]
    v_mfma_f32_16x16x32_bf16 v[212:215], a[40:43], a[180:183], v[212:215]
    ds_read_b64_tr_b16 a[14:15], v45 offset:1024
    v_mfma_f32_16x16x32_bf16 a[80:83], a[40:43], a[184:187], a[80:83]
    buffer_load_dwordx4 v41, s[12:15], s61 offen offset:3072 lds
    ds_read_b64_tr_b16 a[16:17], v46 offset:0
    v_mfma_f32_16x16x32_bf16 a[84:87], a[40:43], a[188:191], a[84:87]
    ds_read_b64_tr_b16 a[18:19], v46 offset:1024
    v_mfma_f32_16x16x32_bf16 v[216:219], a[44:47], a[176:179], v[216:219]
    s_add_u32 s61, s61, 0x80000
    v_mfma_f32_16x16x32_bf16 v[220:223], a[44:47], a[180:183], v[220:223]
    buffer_load_dwordx4 a[224:227], v36, s[8:11], s62 offen offset:0 sc1
    ds_read_b64_tr_b16 a[20:21], v47 offset:0
    v_mfma_f32_16x16x32_bf16 a[88:91], a[44:47], a[184:187], a[88:91]
    ds_read_b64_tr_b16 a[22:23], v47 offset:1024
    v_mfma_f32_16x16x32_bf16 a[92:95], a[44:47], a[188:191], a[92:95]
    buffer_load_dwordx4 a[228:231], v36, s[8:11], s62 offen offset:1024 sc1
    ds_read_b64_tr_b16 a[24:25], v48 offset:0
    v_mfma_f32_16x16x32_bf16 v[224:227], a[48:51], a[176:179], v[224:227]
    v_mfma_f32_16x16x32_bf16 v[228:231], a[48:51], a[180:183], v[228:231]
    ds_read_b64_tr_b16 a[26:27], v48 offset:1024
    v_mfma_f32_16x16x32_bf16 a[96:99], a[48:51], a[184:187], a[96:99]
    buffer_load_dwordx4 a[232:235], v37, s[8:11], s62 offen offset:0 sc1
    ds_read_b64_tr_b16 a[28:29], v49 offset:0
    v_mfma_f32_16x16x32_bf16 a[100:103], a[48:51], a[188:191], a[100:103]
    v_mfma_f32_16x16x32_bf16 v[232:235], a[52:55], a[176:179], v[232:235]
    ds_read_b64_tr_b16 a[30:31], v49 offset:1024
    v_mfma_f32_16x16x32_bf16 v[236:239], a[52:55], a[180:183], v[236:239]
    buffer_load_dwordx4 a[236:239], v37, s[8:11], s62 offen offset:1024 sc1
    v_mfma_f32_16x16x32_bf16 a[104:107], a[52:55], a[184:187], a[104:107]
    v_mfma_f32_16x16x32_bf16 a[108:111], a[52:55], a[188:191], a[108:111]
    s_add_u32 s62, s62, 0x20000
    v_mfma_f32_16x16x32_bf16 v[240:243], a[56:59], a[176:179], v[240:243]
    s_add_u32 s52, s47, 8192
    v_mfma_f32_16x16x32_bf16 v[244:247], a[56:59], a[180:183], v[244:247]
    buffer_store_dwordx4 v[96:99], v1, s[48:51], s52 offen offset:0 sc1
    v_mfma_f32_16x16x32_bf16 a[112:115], a[56:59], a[184:187], a[112:115]
    v_mfma_f32_16x16x32_bf16 a[116:119], a[56:59], a[188:191], a[116:119]
    v_mfma_f32_16x16x32_bf16 v[248:251], a[60:63], a[176:179], v[248:251]
    v_mfma_f32_16x16x32_bf16 v[252:255], a[60:63], a[180:183], v[252:255]
    v_mfma_f32_16x16x32_bf16 a[120:123], a[60:63], a[184:187], a[120:123]
    v_mfma_f32_16x16x32_bf16 a[124:127], a[60:63], a[188:191], a[124:127]
    s_waitcnt vmcnt(15) lgkmcnt(0)
    v_mfma_f32_16x16x32_bf16 v[192:195], a[0:3], a[192:195], v[192:195]
    ds_read_b64_tr_b16 a[32:33], v42 offset:8192
    ds_read_b64_tr_b16 a[34:35], v42 offset:9216
    v_mfma_f32_16x16x32_bf16 v[196:199], a[0:3], a[196:199], v[196:199]
    buffer_load_dwordx4 a[240:243], v36, s[8:11], s62 offen offset:0 sc1
    v_mfma_f32_16x16x32_bf16 a[64:67], a[0:3], a[200:203], a[64:67]
    ds_read_b64_tr_b16 a[36:37], v43 offset:8192
    v_mfma_f32_16x16x32_bf16 a[68:71], a[0:3], a[204:207], a[68:71]
    ds_read_b64_tr_b16 a[38:39], v43 offset:9216
    v_mfma_f32_16x16x32_bf16 v[200:203], a[4:7], a[192:195], v[200:203]
    ds_read_b64_tr_b16 a[40:41], v44 offset:8192
    v_mfma_f32_16x16x32_bf16 v[204:207], a[4:7], a[196:199], v[204:207]
    v_mfma_f32_16x16x32_bf16 a[72:75], a[4:7], a[200:203], a[72:75]
    buffer_load_dwordx4 a[244:247], v36, s[8:11], s62 offen offset:1024 sc1
    ds_read_b64_tr_b16 a[42:43], v44 offset:9216
    v_mfma_f32_16x16x32_bf16 a[76:79], a[4:7], a[204:207], a[76:79]
    ds_read_b64_tr_b16 a[44:45], v45 offset:8192
    v_mfma_f32_16x16x32_bf16 v[208:211], a[8:11], a[192:195], v[208:211]
    v_mfma_f32_16x16x32_bf16 v[212:215], a[8:11], a[196:199], v[212:215]
    ds_read_b64_tr_b16 a[46:47], v45 offset:9216
    v_mfma_f32_16x16x32_bf16 a[80:83], a[8:11], a[200:203], a[80:83]
    ds_read_b64_tr_b16 a[48:49], v46 offset:8192
    v_mfma_f32_16x16x32_bf16 a[84:87], a[8:11], a[204:207], a[84:87]
    buffer_load_dwordx4 a[248:251], v37, s[8:11], s62 offen offset:0 sc1
    ds_read_b64_tr_b16 a[50:51], v46 offset:9216
    v_mfma_f32_16x16x32_bf16 v[216:219], a[12:15], a[192:195], v[216:219]
    v_mfma_f32_16x16x32_bf16 v[220:223], a[12:15], a[196:199], v[220:223]
    ds_read_b64_tr_b16 a[52:53], v47 offset:8192
    v_mfma_f32_16x16x32_bf16 a[88:91], a[12:15], a[200:203], a[88:91]
    ds_read_b64_tr_b16 a[54:55], v47 offset:9216
    v_mfma_f32_16x16x32_bf16 a[92:95], a[12:15], a[204:207], a[92:95]
    ds_read_b64_tr_b16 a[56:57], v48 offset:8192
    v_mfma_f32_16x16x32_bf16 v[224:227], a[16:19], a[192:195], v[224:227]
    v_mfma_f32_16x16x32_bf16 v[228:231], a[16:19], a[196:199], v[228:231]
    buffer_load_dwordx4 a[252:255], v37, s[8:11], s62 offen offset:1024 sc1
    ds_read_b64_tr_b16 a[58:59], v48 offset:9216
    v_mfma_f32_16x16x32_bf16 a[96:99], a[16:19], a[200:203], a[96:99]
    ds_read_b64_tr_b16 a[60:61], v49 offset:8192
    v_mfma_f32_16x16x32_bf16 a[100:103], a[16:19], a[204:207], a[100:103]
    v_mfma_f32_16x16x32_bf16 v[232:235], a[20:23], a[192:195], v[232:235]
    ds_read_b64_tr_b16 a[62:63], v49 offset:9216
    v_mfma_f32_16x16x32_bf16 v[236:239], a[20:23], a[196:199], v[236:239]
    s_add_u32 s62, s62, 0x20000
    v_mfma_f32_16x16x32_bf16 a[104:107], a[20:23], a[200:203], a[104:107]
    s_add_u32 s52, s47, 8192
    v_mfma_f32_16x16x32_bf16 a[108:111], a[20:23], a[204:207], a[108:111]
    buffer_store_dwordx4 v[100:103], v1, s[48:51], s52 offen offset:1024 sc1
    v_mfma_f32_16x16x32_bf16 v[240:243], a[24:27], a[192:195], v[240:243]
    v_mfma_f32_16x16x32_bf16 v[244:247], a[24:27], a[196:199], v[244:247]
    v_mfma_f32_16x16x32_bf16 a[112:115], a[24:27], a[200:203], a[112:115]
    v_mfma_f32_16x16x32_bf16 a[116:119], a[24:27], a[204:207], a[116:119]
    v_mfma_f32_16x16x32_bf16 v[248:251], a[28:31], a[192:195], v[248:251]
    s_cmp_eq_u32 s45, 0
    s_cbranch_scc1 k12_ool_48
k12_oolret_49:
    v_mfma_f32_16x16x32_bf16 v[252:255], a[28:31], a[196:199], v[252:255]
    v_mfma_f32_16x16x32_bf16 a[120:123], a[28:31], a[200:203], a[120:123]
    v_mfma_f32_16x16x32_bf16 a[124:127], a[28:31], a[204:207], a[124:127]
    s_waitcnt vmcnt(10) lgkmcnt(0)
    s_barrier
    v_mfma_f32_16x16x32_bf16 v[192:195], a[32:35], a[208:211], v[192:195]
    ds_read_b64_tr_b16 a[0:1], v42 offset:16384
    ds_read_b64_tr_b16 a[2:3], v42 offset:17408
    v_mfma_f32_16x16x32_bf16 v[196:199], a[32:35], a[212:215], v[196:199]
    s_add_u32 m0, s60, 131072
    v_mfma_f32_16x16x32_bf16 a[64:67], a[32:35], a[216:219], a[64:67]
    buffer_load_dwordx4 v38, s[12:15], s61 offen offset:0 lds
    ds_read_b64_tr_b16 a[4:5], v43 offset:16384
    v_mfma_f32_16x16x32_bf16 a[68:71], a[32:35], a[220:223], a[68:71]
    ds_read_b64_tr_b16 a[6:7], v43 offset:17408
    v_mfma_f32_16x16x32_bf16 v[200:203], a[36:39], a[208:211], v[200:203]
    buffer_load_dwordx4 v39, s[12:15], s61 offen offset:1024 lds
    ds_read_b64_tr_b16 a[8:9], v44 offset:16384
    v_mfma_f32_16x16x32_bf16 v[204:207], a[36:39], a[212:215], v[204:207]
    v_mfma_f32_16x16x32_bf16 a[72:75], a[36:39], a[216:219], a[72:75]
    buffer_load_dwordx4 v40, s[12:15], s61 offen offset:2048 lds
    ds_read_b64_tr_b16 a[10:11], v44 offset:17408
    v_mfma_f32_16x16x32_bf16 a[76:79], a[36:39], a[220:223], a[76:79]
    ds_read_b64_tr_b16 a[12:13], v45 offset:16384
    v_mfma_f32_16x16x32_bf16 v[208:211], a[40:43], a[208:211], v[208:211]
    v_mfma_f32_16x16x32_bf16 v[212:215], a[40:43], a[212:215], v[212:215]
    buffer_load_dwordx4 v41, s[12:15], s61 offen offset:3072 lds
    ds_read_b64_tr_b16 a[14:15], v45 offset:17408
    v_mfma_f32_16x16x32_bf16 a[80:83], a[40:43], a[216:219], a[80:83]
    s_add_u32 s61, s61, 0x80000
    ds_read_b64_tr_b16 a[16:17], v46 offset:16384
    v_mfma_f32_16x16x32_bf16 a[84:87], a[40:43], a[220:223], a[84:87]
    buffer_load_dwordx4 a[128:131], v36, s[8:11], s62 offen offset:0 sc1
    ds_read_b64_tr_b16 a[18:19], v46 offset:17408
    v_mfma_f32_16x16x32_bf16 v[216:219], a[44:47], a[208:211], v[216:219]
    v_mfma_f32_16x16x32_bf16 v[220:223], a[44:47], a[212:215], v[220:223]
    ds_read_b64_tr_b16 a[20:21], v47 offset:16384
    v_mfma_f32_16x16x32_bf16 a[88:91], a[44:47], a[216:219], a[88:91]
    buffer_load_dwordx4 a[132:135], v36, s[8:11], s62 offen offset:1024 sc1
    ds_read_b64_tr_b16 a[22:23], v47 offset:17408
    v_mfma_f32_16x16x32_bf16 a[92:95], a[44:47], a[220:223], a[92:95]
    ds_read_b64_tr_b16 a[24:25], v48 offset:16384
    v_mfma_f32_16x16x32_bf16 v[224:227], a[48:51], a[208:211], v[224:227]
    v_mfma_f32_16x16x32_bf16 v[228:231], a[48:51], a[212:215], v[228:231]
    buffer_load_dwordx4 a[136:139], v37, s[8:11], s62 offen offset:0 sc1
    ds_read_b64_tr_b16 a[26:27], v48 offset:17408
    v_mfma_f32_16x16x32_bf16 a[96:99], a[48:51], a[216:219], a[96:99]
    ds_read_b64_tr_b16 a[28:29], v49 offset:16384
    v_mfma_f32_16x16x32_bf16 a[100:103], a[48:51], a[220:223], a[100:103]
    buffer_load_dwordx4 a[140:143], v37, s[8:11], s62 offen offset:1024 sc1
    v_mfma_f32_16x16x32_bf16 v[232:235], a[52:55], a[208:211], v[232:235]
    ds_read_b64_tr_b16 a[30:31], v49 offset:17408
    v_mfma_f32_16x16x32_bf16 v[236:239], a[52:55], a[212:215], v[236:239]
    s_add_u32 s62, s62, 0x20000
    v_mfma_f32_16x16x32_bf16 a[104:107], a[52:55], a[216:219], a[104:107]
    s_add_u32 s52, s47, 8192
    v_mfma_f32_16x16x32_bf16 a[108:111], a[52:55], a[220:223], a[108:111]
    buffer_store_dwordx4 v[104:107], v1, s[48:51], s52 offen offset:2048 sc1
    v_mfma_f32_16x16x32_bf16 v[240:243], a[56:59], a[208:211], v[240:243]
    s_add_u32 s52, s47, 8192
    v_mfma_f32_16x16x32_bf16 v[244:247], a[56:59], a[212:215], v[244:247]
    buffer_store_dwordx4 v[108:111], v1, s[48:51], s52 offen offset:3072 sc1
    v_mfma_f32_16x16x32_bf16 a[112:115], a[56:59], a[216:219], a[112:115]
    v_mfma_f32_16x16x32_bf16 a[116:119], a[56:59], a[220:223], a[116:119]
    v_mfma_f32_16x16x32_bf16 v[248:251], a[60:63], a[208:211], v[248:251]
    v_mfma_f32_16x16x32_bf16 v[252:255], a[60:63], a[212:215], v[252:255]
    v_mfma_f32_16x16x32_bf16 a[120:123], a[60:63], a[216:219], a[120:123]
    v_mfma_f32_16x16x32_bf16 a[124:127], a[60:63], a[220:223], a[124:127]
    s_waitcnt vmcnt(16) lgkmcnt(0)
    v_mfma_f32_16x16x32_bf16 v[192:195], a[0:3], a[224:227], v[192:195]
    ds_read_b64_tr_b16 a[32:33], v42 offset:24576
    ds_read_b64_tr_b16 a[34:35], v42 offset:25600
    v_mfma_f32_16x16x32_bf16 v[196:199], a[0:3], a[228:231], v[196:199]
    buffer_load_dwordx4 a[144:147], v36, s[8:11], s62 offen offset:0 sc1
    v_mfma_f32_16x16x32_bf16 a[64:67], a[0:3], a[232:235], a[64:67]
    ds_read_b64_tr_b16 a[36:37], v43 offset:24576
    v_mfma_f32_16x16x32_bf16 a[68:71], a[0:3], a[236:239], a[68:71]
    ds_read_b64_tr_b16 a[38:39], v43 offset:25600
    v_mfma_f32_16x16x32_bf16 v[200:203], a[4:7], a[224:227], v[200:203]
    ds_read_b64_tr_b16 a[40:41], v44 offset:24576
    v_mfma_f32_16x16x32_bf16 v[204:207], a[4:7], a[228:231], v[204:207]
    v_mfma_f32_16x16x32_bf16 a[72:75], a[4:7], a[232:235], a[72:75]
    buffer_load_dwordx4 a[148:151], v36, s[8:11], s62 offen offset:1024 sc1
    ds_read_b64_tr_b16 a[42:43], v44 offset:25600
    v_mfma_f32_16x16x32_bf16 a[76:79], a[4:7], a[236:239], a[76:79]
    ds_read_b64_tr_b16 a[44:45], v45 offset:24576
    v_mfma_f32_16x16x32_bf16 v[208:211], a[8:11], a[224:227], v[208:211]
    v_mfma_f32_16x16x32_bf16 v[212:215], a[8:11], a[228:231], v[212:215]
    ds_read_b64_tr_b16 a[46:47], v45 offset:25600
    v_mfma_f32_16x16x32_bf16 a[80:83], a[8:11], a[232:235], a[80:83]
    ds_read_b64_tr_b16 a[48:49], v46 offset:24576
    v_mfma_f32_16x16x32_bf16 a[84:87], a[8:11], a[236:239], a[84:87]
    buffer_load_dwordx4 a[152:155], v37, s[8:11], s62 offen offset:0 sc1
    ds_read_b64_tr_b16 a[50:51], v46 offset:25600
    v_mfma_f32_16x16x32_bf16 v[216:219], a[12:15], a[224:227], v[216:219]
    v_mfma_f32_16x16x32_bf16 v[220:223], a[12:15], a[228:231], v[220:223]
    ds_read_b64_tr_b16 a[52:53], v47 offset:24576
    v_mfma_f32_16x16x32_bf16 a[88:91], a[12:15], a[232:235], a[88:91]
    ds_read_b64_tr_b16 a[54:55], v47 offset:25600
    v_mfma_f32_16x16x32_bf16 a[92:95], a[12:15], a[236:239], a[92:95]
    ds_read_b64_tr_b16 a[56:57], v48 offset:24576
    v_mfma_f32_16x16x32_bf16 v[224:227], a[16:19], a[224:227], v[224:227]
    v_mfma_f32_16x16x32_bf16 v[228:231], a[16:19], a[228:231], v[228:231]
    buffer_load_dwordx4 a[156:159], v37, s[8:11], s62 offen offset:1024 sc1
    ds_read_b64_tr_b16 a[58:59], v48 offset:25600
    v_mfma_f32_16x16x32_bf16 a[96:99], a[16:19], a[232:235], a[96:99]
    ds_read_b64_tr_b16 a[60:61], v49 offset:24576
    v_mfma_f32_16x16x32_bf16 a[100:103], a[16:19], a[236:239], a[100:103]
    v_mfma_f32_16x16x32_bf16 v[232:235], a[20:23], a[224:227], v[232:235]
    ds_read_b64_tr_b16 a[62:63], v49 offset:25600
    v_mfma_f32_16x16x32_bf16 v[236:239], a[20:23], a[228:231], v[236:239]
    s_add_u32 s62, s62, 0x20000
    v_mfma_f32_16x16x32_bf16 a[104:107], a[20:23], a[232:235], a[104:107]
    s_add_u32 s52, s47, 12288
    v_mfma_f32_16x16x32_bf16 a[108:111], a[20:23], a[236:239], a[108:111]
    buffer_store_dwordx4 v[112:115], v1, s[48:51], s52 offen offset:0 sc1
    v_mfma_f32_16x16x32_bf16 v[240:243], a[24:27], a[224:227], v[240:243]
    v_mfma_f32_16x16x32_bf16 v[244:247], a[24:27], a[228:231], v[244:247]
    v_mfma_f32_16x16x32_bf16 a[112:115], a[24:27], a[232:235], a[112:115]
    v_mfma_f32_16x16x32_bf16 a[116:119], a[24:27], a[236:239], a[116:119]
    v_mfma_f32_16x16x32_bf16 v[248:251], a[28:31], a[224:227], v[248:251]
    v_mfma_f32_16x16x32_bf16 v[252:255], a[28:31], a[228:231], v[252:255]
    v_mfma_f32_16x16x32_bf16 a[120:123], a[28:31], a[232:235], a[120:123]
    v_mfma_f32_16x16x32_bf16 a[124:127], a[28:31], a[236:239], a[124:127]
    s_waitcnt vmcnt(11) lgkmcnt(0)
    s_barrier
    v_mfma_f32_16x16x32_bf16 v[192:195], a[32:35], a[240:243], v[192:195]
    ds_read_b64_tr_b16 a[0:1], v42 offset:32768
    ds_read_b64_tr_b16 a[2:3], v42 offset:33792
    v_mfma_f32_16x16x32_bf16 v[196:199], a[32:35], a[244:247], v[196:199]
    s_add_u32 m0, s60, 147456
    v_mfma_f32_16x16x32_bf16 a[64:67], a[32:35], a[248:251], a[64:67]
    buffer_load_dwordx4 v38, s[12:15], s61 offen offset:0 lds
    ds_read_b64_tr_b16 a[4:5], v43 offset:32768
    v_mfma_f32_16x16x32_bf16 a[68:71], a[32:35], a[252:255], a[68:71]
    ds_read_b64_tr_b16 a[6:7], v43 offset:33792
    v_mfma_f32_16x16x32_bf16 v[200:203], a[36:39], a[240:243], v[200:203]
    buffer_load_dwordx4 v39, s[12:15], s61 offen offset:1024 lds
    ds_read_b64_tr_b16 a[8:9], v44 offset:32768
    v_mfma_f32_16x16x32_bf16 v[204:207], a[36:39], a[244:247], v[204:207]
    v_mfma_f32_16x16x32_bf16 a[72:75], a[36:39], a[248:251], a[72:75]
    ds_read_b64_tr_b16 a[10:11], v44 offset:33792
    v_mfma_f32_16x16x32_bf16 a[76:79], a[36:39], a[252:255], a[76:79]
    buffer_load_dwordx4 v40, s[12:15], s61 offen offset:2048 lds
    ds_read_b64_tr_b16 a[12:13], v45 offset:32768
    v_mfma_f32_16x16x32_bf16 v[208:211], a[40:43], a[240:243], v[208:211]
    v_mfma_f32_16x16x32_bf16 v[212:215], a[40:43], a[244:247], v[212:215]
    ds_read_b64_tr_b16 a[14:15], v45 offset:33792
    v_mfma_f32_16x16x32_bf16 a[80:83], a[40:43], a[248:251], a[80:83]
    buffer_load_dwordx4 v41, s[12:15], s61 offen offset:3072 lds
    ds_read_b64_tr_b16 a[16:17], v46 offset:32768
    v_mfma_f32_16x16x32_bf16 a[84:87], a[40:43], a[252:255], a[84:87]
    ds_read_b64_tr_b16 a[18:19], v46 offset:33792
    v_mfma_f32_16x16x32_bf16 v[216:219], a[44:47], a[240:243], v[216:219]
    s_add_u32 s61, s61, 0x80000
    v_mfma_f32_16x16x32_bf16 v[220:223], a[44:47], a[244:247], v[220:223]
    buffer_load_dwordx4 a[160:163], v36, s[8:11], s62 offen offset:0 sc1
    ds_read_b64_tr_b16 a[20:21], v47 offset:32768
    v_mfma_f32_16x16x32_bf16 a[88:91], a[44:47], a[248:251], a[88:91]
    ds_read_b64_tr_b16 a[22:23], v47 offset:33792
    v_mfma_f32_16x16x32_bf16 a[92:95], a[44:47], a[252:255], a[92:95]
    buffer_load_dwordx4 a[164:167], v36, s[8:11], s62 offen offset:1024 sc1
    ds_read_b64_tr_b16 a[24:25], v48 offset:32768
    v_mfma_f32_16x16x32_bf16 v[224:227], a[48:51], a[240:243], v[224:227]
    v_mfma_f32_16x16x32_bf16 v[228:231], a[48:51], a[244:247], v[228:231]
    ds_read_b64_tr_b16 a[26:27], v48 offset:33792
    v_mfma_f32_16x16x32_bf16 a[96:99], a[48:51], a[248:251], a[96:99]
    buffer_load_dwordx4 a[168:171], v37, s[8:11], s62 offen offset:0 sc1
    ds_read_b64_tr_b16 a[28:29], v49 offset:32768
    v_mfma_f32_16x16x32_bf16 a[100:103], a[48:51], a[252:255], a[100:103]
    v_mfma_f32_16x16x32_bf16 v[232:235], a[52:55], a[240:243], v[232:235]
    ds_read_b64_tr_b16 a[30:31], v49 offset:33792
    v_mfma_f32_16x16x32_bf16 v[236:239], a[52:55], a[244:247], v[236:239]
    buffer_load_dwordx4 a[172:175], v37, s[8:11], s62 offen offset:1024 sc1
    v_mfma_f32_16x16x32_bf16 a[104:107], a[52:55], a[248:251], a[104:107]
    v_mfma_f32_16x16x32_bf16 a[108:111], a[52:55], a[252:255], a[108:111]
    s_add_u32 s62, s62, 0x20000
    v_mfma_f32_16x16x32_bf16 v[240:243], a[56:59], a[240:243], v[240:243]
    s_add_u32 s52, s47, 12288
    v_mfma_f32_16x16x32_bf16 v[244:247], a[56:59], a[244:247], v[244:247]
    buffer_store_dwordx4 v[116:119], v1, s[48:51], s52 offen offset:1024 sc1
    v_mfma_f32_16x16x32_bf16 a[112:115], a[56:59], a[248:251], a[112:115]
    v_mfma_f32_16x16x32_bf16 a[116:119], a[56:59], a[252:255], a[116:119]
    v_mfma_f32_16x16x32_bf16 v[248:251], a[60:63], a[240:243], v[248:251]
    s_cmp_eq_u32 s45, 0
    s_cbranch_scc1 k12_ool_50
k12_oolret_51:
    v_mfma_f32_16x16x32_bf16 v[252:255], a[60:63], a[244:247], v[252:255]
    v_mfma_f32_16x16x32_bf16 a[120:123], a[60:63], a[248:251], a[120:123]
    v_mfma_f32_16x16x32_bf16 a[124:127], a[60:63], a[252:255], a[124:127]
    s_waitcnt vmcnt(16) lgkmcnt(0)
    v_mfma_f32_16x16x32_bf16 v[192:195], a[0:3], a[128:131], v[192:195]
    ds_read_b64_tr_b16 a[32:33], v42 offset:40960
    ds_read_b64_tr_b16 a[34:35], v42 offset:41984
    v_mfma_f32_16x16x32_bf16 v[196:199], a[0:3], a[132:135], v[196:199]
    buffer_load_dwordx4 a[176:179], v36, s[8:11], s62 offen offset:0 sc1
    v_mfma_f32_16x16x32_bf16 a[64:67], a[0:3], a[136:139], a[64:67]
    ds_read_b64_tr_b16 a[36:37], v43 offset:40960
    v_mfma_f32_16x16x32_bf16 a[68:71], a[0:3], a[140:143], a[68:71]
    ds_read_b64_tr_b16 a[38:39], v43 offset:41984
    v_mfma_f32_16x16x32_bf16 v[200:203], a[4:7], a[128:131], v[200:203]
    ds_read_b64_tr_b16 a[40:41], v44 offset:40960
    v_mfma_f32_16x16x32_bf16 v[204:207], a[4:7], a[132:135], v[204:207]
    v_mfma_f32_16x16x32_bf16 a[72:75], a[4:7], a[136:139], a[72:75]
    buffer_load_dwordx4 a[180:183], v36, s[8:11], s62 offen offset:1024 sc1
    ds_read_b64_tr_b16 a[42:43], v44 offset:41984
    v_mfma_f32_16x16x32_bf16 a[76:79], a[4:7], a[140:143], a[76:79]
    ds_read_b64_tr_b16 a[44:45], v45 offset:40960
    v_mfma_f32_16x16x32_bf16 v[208:211], a[8:11], a[128:131], v[208:211]
    v_mfma_f32_16x16x32_bf16 v[212:215], a[8:11], a[132:135], v[212:215]
    ds_read_b64_tr_b16 a[46:47], v45 offset:41984
    v_mfma_f32_16x16x32_bf16 a[80:83], a[8:11], a[136:139], a[80:83]
    ds_read_b64_tr_b16 a[48:49], v46 offset:40960
    v_mfma_f32_16x16x32_bf16 a[84:87], a[8:11], a[140:143], a[84:87]
    buffer_load_dwordx4 a[184:187], v37, s[8:11], s62 offen offset:0 sc1
    ds_read_b64_tr_b16 a[50:51], v46 offset:41984
    v_mfma_f32_16x16x32_bf16 v[216:219], a[12:15], a[128:131], v[216:219]
    v_mfma_f32_16x16x32_bf16 v[220:223], a[12:15], a[132:135], v[220:223]
    ds_read_b64_tr_b16 a[52:53], v47 offset:40960
    v_mfma_f32_16x16x32_bf16 a[88:91], a[12:15], a[136:139], a[88:91]
    ds_read_b64_tr_b16 a[54:55], v47 offset:41984
    v_mfma_f32_16x16x32_bf16 a[92:95], a[12:15], a[140:143], a[92:95]
    ds_read_b64_tr_b16 a[56:57], v48 offset:40960
    v_mfma_f32_16x16x32_bf16 v[224:227], a[16:19], a[128:131], v[224:227]
    v_mfma_f32_16x16x32_bf16 v[228:231], a[16:19], a[132:135], v[228:231]
    buffer_load_dwordx4 a[188:191], v37, s[8:11], s62 offen offset:1024 sc1
    ds_read_b64_tr_b16 a[58:59], v48 offset:41984
    v_mfma_f32_16x16x32_bf16 a[96:99], a[16:19], a[136:139], a[96:99]
    ds_read_b64_tr_b16 a[60:61], v49 offset:40960
    v_mfma_f32_16x16x32_bf16 a[100:103], a[16:19], a[140:143], a[100:103]
    v_mfma_f32_16x16x32_bf16 v[232:235], a[20:23], a[128:131], v[232:235]
    ds_read_b64_tr_b16 a[62:63], v49 offset:41984
    v_mfma_f32_16x16x32_bf16 v[236:239], a[20:23], a[132:135], v[236:239]
    s_add_u32 s62, s62, 0x20000
    v_mfma_f32_16x16x32_bf16 a[104:107], a[20:23], a[136:139], a[104:107]
    s_add_u32 s52, s47, 12288
    v_mfma_f32_16x16x32_bf16 a[108:111], a[20:23], a[140:143], a[108:111]
    buffer_store_dwordx4 v[120:123], v1, s[48:51], s52 offen offset:2048 sc1
    v_mfma_f32_16x16x32_bf16 v[240:243], a[24:27], a[128:131], v[240:243]
    v_mfma_f32_16x16x32_bf16 v[244:247], a[24:27], a[132:135], v[244:247]
    v_mfma_f32_16x16x32_bf16 a[112:115], a[24:27], a[136:139], a[112:115]
    v_mfma_f32_16x16x32_bf16 a[116:119], a[24:27], a[140:143], a[116:119]
    v_mfma_f32_16x16x32_bf16 v[248:251], a[28:31], a[128:131], v[248:251]
    v_mfma_f32_16x16x32_bf16 v[252:255], a[28:31], a[132:135], v[252:255]
    v_mfma_f32_16x16x32_bf16 a[120:123], a[28:31], a[136:139], a[120:123]
    v_mfma_f32_16x16x32_bf16 a[124:127], a[28:31], a[140:143], a[124:127]
    s_waitcnt vmcnt(10) lgkmcnt(0)
    s_barrier
    v_mfma_f32_16x16x32_bf16 v[192:195], a[32:35], a[144:147], v[192:195]
    ds_read_b64_tr_b16 a[0:1], v42 offset:49152
    ds_read_b64_tr_b16 a[2:3], v42 offset:50176
    v_mfma_f32_16x16x32_bf16 v[196:199], a[32:35], a[148:151], v[196:199]
    s_add_u32 m0, s60, 98304
    v_mfma_f32_16x16x32_bf16 a[64:67], a[32:35], a[152:155], a[64:67]
    buffer_load_dwordx4 v38, s[12:15], s61 offen offset:0 lds
    ds_read_b64_tr_b16 a[4:5], v43 offset:49152
    v_mfma_f32_16x16x32_bf16 a[68:71], a[32:35], a[156:159], a[68:71]
    ds_read_b64_tr_b16 a[6:7], v43 offset:50176
    v_mfma_f32_16x16x32_bf16 v[200:203], a[36:39], a[144:147], v[200:203]
    buffer_load_dwordx4 v39, s[12:15], s61 offen offset:1024 lds
    ds_read_b64_tr_b16 a[8:9], v44 offset:49152
    v_mfma_f32_16x16x32_bf16 v[204:207], a[36:39], a[148:151], v[204:207]
    v_mfma_f32_16x16x32_bf16 a[72:75], a[36:39], a[152:155], a[72:75]
    ds_read_b64_tr_b16 a[10:11], v44 offset:50176
    v_mfma_f32_16x16x32_bf16 a[76:79], a[36:39], a[156:159], a[76:79]
    buffer_load_dwordx4 v40, s[12:15], s61 offen offset:2048 lds
    ds_read_b64_tr_b16 a[12:13], v45 offset:49152
    v_mfma_f32_16x16x32_bf16 v[208:211], a[40:43], a[144:147], v[208:211]
    v_mfma_f32_16x16x32_bf16 v[212:215], a[40:43], a[148:151], v[212:215]
    ds_read_b64_tr_b16 a[14:15], v45 offset:50176
    v_mfma_f32_16x16x32_bf16 a[80:83], a[40:43], a[152:155], a[80:83]
    buffer_load_dwordx4 v41, s[12:15], s61 offen offset:3072 lds
    ds_read_b64_tr_b16 a[16:17], v46 offset:49152
    v_mfma_f32_16x16x32_bf16 a[84:87], a[40:43], a[156:159], a[84:87]
    ds_read_b64_tr_b16 a[18:19], v46 offset:50176
    v_mfma_f32_16x16x32_bf16 v[216:219], a[44:47], a[144:147], v[216:219]
    s_add_u32 s61, s61, 0x80000
    v_mfma_f32_16x16x32_bf16 v[220:223], a[44:47], a[148:151], v[220:223]
    buffer_load_dwordx4 a[192:195], v36, s[8:11], s62 offen offset:0 sc1
    ds_read_b64_tr_b16 a[20:21], v47 offset:49152
    v_mfma_f32_16x16x32_bf16 a[88:91], a[44:47], a[152:155], a[88:91]
    ds_read_b64_tr_b16 a[22:23], v47 offset:50176
    v_mfma_f32_16x16x32_bf16 a[92:95], a[44:47], a[156:159], a[92:95]
    buffer_load_dwordx4 a[196:199], v36, s[8:11], s62 offen offset:1024 sc1
    ds_read_b64_tr_b16 a[24:25], v48 offset:49152
    v_mfma_f32_16x16x32_bf16 v[224:227], a[48:51], a[144:147], v[224:227]
    v_mfma_f32_16x16x32_bf16 v[228:231], a[48:51], a[148:151], v[228:231]
    ds_read_b64_tr_b16 a[26:27], v48 offset:50176
    v_mfma_f32_16x16x32_bf16 a[96:99], a[48:51], a[152:155], a[96:99]
    buffer_load_dwordx4 a[200:203], v37, s[8:11], s62 offen offset:0 sc1
    ds_read_b64_tr_b16 a[28:29], v49 offset:49152
    v_mfma_f32_16x16x32_bf16 a[100:103], a[48:51], a[156:159], a[100:103]
    v_mfma_f32_16x16x32_bf16 v[232:235], a[52:55], a[144:147], v[232:235]
    ds_read_b64_tr_b16 a[30:31], v49 offset:50176
    v_mfma_f32_16x16x32_bf16 v[236:239], a[52:55], a[148:151], v[236:239]
    buffer_load_dwordx4 a[204:207], v37, s[8:11], s62 offen offset:1024 sc1
    v_mfma_f32_16x16x32_bf16 a[104:107], a[52:55], a[152:155], a[104:107]
    v_mfma_f32_16x16x32_bf16 a[108:111], a[52:55], a[156:159], a[108:111]
    s_add_u32 s62, s62, 0x20000
    v_mfma_f32_16x16x32_bf16 v[240:243], a[56:59], a[144:147], v[240:243]
    s_add_u32 s52, s47, 12288
    v_mfma_f32_16x16x32_bf16 v[244:247], a[56:59], a[148:151], v[244:247]
    buffer_store_dwordx4 v[124:127], v1, s[48:51], s52 offen offset:3072 sc1
    v_mfma_f32_16x16x32_bf16 a[112:115], a[56:59], a[152:155], a[112:115]
    v_mfma_f32_16x16x32_bf16 a[116:119], a[56:59], a[156:159], a[116:119]
    v_mfma_f32_16x16x32_bf16 v[248:251], a[60:63], a[144:147], v[248:251]
    s_cmp_eq_u32 s45, 0
    s_cbranch_scc1 k12_ool_52
k12_oolret_53:
    v_mfma_f32_16x16x32_bf16 v[252:255], a[60:63], a[148:151], v[252:255]
    v_mfma_f32_16x16x32_bf16 a[120:123], a[60:63], a[152:155], a[120:123]
    v_mfma_f32_16x16x32_bf16 a[124:127], a[60:63], a[156:159], a[124:127]
    s_waitcnt vmcnt(15) lgkmcnt(0)
    v_mfma_f32_16x16x32_bf16 v[192:195], a[0:3], a[160:163], v[192:195]
    ds_read_b64_tr_b16 a[32:33], v42 offset:57344
    ds_read_b64_tr_b16 a[34:35], v42 offset:58368
    v_mfma_f32_16x16x32_bf16 v[196:199], a[0:3], a[164:167], v[196:199]
    buffer_load_dwordx4 a[208:211], v36, s[8:11], s62 offen offset:0 sc1
    v_mfma_f32_16x16x32_bf16 a[64:67], a[0:3], a[168:171], a[64:67]
    ds_read_b64_tr_b16 a[36:37], v43 offset:57344
    v_mfma_f32_16x16x32_bf16 a[68:71], a[0:3], a[172:175], a[68:71]
    ds_read_b64_tr_b16 a[38:39], v43 offset:58368
    v_mfma_f32_16x16x32_bf16 v[200:203], a[4:7], a[160:163], v[200:203]
    ds_read_b64_tr_b16 a[40:41], v44 offset:57344
    v_mfma_f32_16x16x32_bf16 v[204:207], a[4:7], a[164:167], v[204:207]
    v_mfma_f32_16x16x32_bf16 a[72:75], a[4:7], a[168:171], a[72:75]
    buffer_load_dwordx4 a[212:215], v36, s[8:11], s62 offen offset:1024 sc1
    ds_read_b64_tr_b16 a[42:43], v44 offset:58368
    v_mfma_f32_16x16x32_bf16 a[76:79], a[4:7], a[172:175], a[76:79]
    ds_read_b64_tr_b16 a[44:45], v45 offset:57344
    v_mfma_f32_16x16x32_bf16 v[208:211], a[8:11], a[160:163], v[208:211]
    v_mfma_f32_16x16x32_bf16 v[212:215], a[8:11], a[164:167], v[212:215]
    ds_read_b64_tr_b16 a[46:47], v45 offset:58368
    v_mfma_f32_16x16x32_bf16 a[80:83], a[8:11], a[168:171], a[80:83]
    ds_read_b64_tr_b16 a[48:49], v46 offset:57344
    v_mfma_f32_16x16x32_bf16 a[84:87], a[8:11], a[172:175], a[84:87]
    buffer_load_dwordx4 a[216:219], v37, s[8:11], s62 offen offset:0 sc1
    ds_read_b64_tr_b16 a[50:51], v46 offset:58368
    v_mfma_f32_16x16x32_bf16 v[216:219], a[12:15], a[160:163], v[216:219]
    v_mfma_f32_16x16x32_bf16 v[220:223], a[12:15], a[164:167], v[220:223]
    ds_read_b64_tr_b16 a[52:53], v47 offset:57344
    v_mfma_f32_16x16x32_bf16 a[88:91], a[12:15], a[168:171], a[88:91]
    ds_read_b64_tr_b16 a[54:55], v47 offset:58368
    v_mfma_f32_16x16x32_bf16 a[92:95], a[12:15], a[172:175], a[92:95]
    ds_read_b64_tr_b16 a[56:57], v48 offset:57344
    v_mfma_f32_16x16x32_bf16 v[224:227], a[16:19], a[160:163], v[224:227]
    v_mfma_f32_16x16x32_bf16 v[228:231], a[16:19], a[164:167], v[228:231]
    buffer_load_dwordx4 a[220:223], v37, s[8:11], s62 offen offset:1024 sc1
    ds_read_b64_tr_b16 a[58:59], v48 offset:58368
    v_mfma_f32_16x16x32_bf16 a[96:99], a[16:19], a[168:171], a[96:99]
    ds_read_b64_tr_b16 a[60:61], v49 offset:57344
    v_mfma_f32_16x16x32_bf16 a[100:103], a[16:19], a[172:175], a[100:103]
    v_mfma_f32_16x16x32_bf16 v[232:235], a[20:23], a[160:163], v[232:235]
    ds_read_b64_tr_b16 a[62:63], v49 offset:58368
    v_mfma_f32_16x16x32_bf16 v[236:239], a[20:23], a[164:167], v[236:239]
    s_add_u32 s62, s62, 0x20000
    v_mfma_f32_16x16x32_bf16 a[104:107], a[20:23], a[168:171], a[104:107]
    s_add_u32 s52, s47, 524288
    v_mfma_f32_16x16x32_bf16 a[108:111], a[20:23], a[172:175], a[108:111]
    buffer_store_dwordx4 v[128:131], v1, s[48:51], s52 offen offset:0 sc1
    v_mfma_f32_16x16x32_bf16 v[240:243], a[24:27], a[160:163], v[240:243]
    v_mfma_f32_16x16x32_bf16 v[244:247], a[24:27], a[164:167], v[244:247]
    v_mfma_f32_16x16x32_bf16 a[112:115], a[24:27], a[168:171], a[112:115]
    v_mfma_f32_16x16x32_bf16 a[116:119], a[24:27], a[172:175], a[116:119]
    v_mfma_f32_16x16x32_bf16 v[248:251], a[28:31], a[160:163], v[248:251]
    v_mfma_f32_16x16x32_bf16 v[252:255], a[28:31], a[164:167], v[252:255]
    v_mfma_f32_16x16x32_bf16 a[120:123], a[28:31], a[168:171], a[120:123]
    v_mfma_f32_16x16x32_bf16 a[124:127], a[28:31], a[172:175], a[124:127]
    s_waitcnt vmcnt(10) lgkmcnt(0)
    s_barrier
    v_mfma_f32_16x16x32_bf16 v[192:195], a[32:35], a[176:179], v[192:195]
    ds_read_b64_tr_b16 a[0:1], v42 offset:0
    ds_read_b64_tr_b16 a[2:3], v42 offset:1024
    v_mfma_f32_16x16x32_bf16 v[196:199], a[32:35], a[180:183], v[196:199]
    s_add_u32 m0, s60, 114688
    v_mfma_f32_16x16x32_bf16 a[64:67], a[32:35], a[184:187], a[64:67]
    buffer_load_dwordx4 v38, s[12:15], s61 offen offset:0 lds
    ds_read_b64_tr_b16 a[4:5], v43 offset:0
    v_mfma_f32_16x16x32_bf16 a[68:71], a[32:35], a[188:191], a[68:71]
    ds_read_b64_tr_b16 a[6:7], v43 offset:1024
    v_mfma_f32_16x16x32_bf16 v[200:203], a[36:39], a[176:179], v[200:203]
    buffer_load_dwordx4 v39, s[12:15], s61 offen offset:1024 lds
    ds_read_b64_tr_b16 a[8:9], v44 offset:0
    v_mfma_f32_16x16x32_bf16 v[204:207], a[36:39], a[180:183], v[204:207]
    v_mfma_f32_16x16x32_bf16 a[72:75], a[36:39], a[184:187], a[72:75]
    ds_read_b64_tr_b16 a[10:11], v44 offset:1024
    v_mfma_f32_16x16x32_bf16 a[76:79], a[36:39], a[188:191], a[76:79]
    buffer_load_dwordx4 v40, s[12:15], s61 offen offset:2048 lds
    ds_read_b64_tr_b16 a[12:13], v45 offset:0
    v_mfma_f32_16x16x32_bf16 v[208:211], a[40:43], a[176:179], v[208:211]
    v_mfma_f32_16x16x32_bf16 v[212:215], a[40:43], a[180:183], v[212:215]
    ds_read_b64_tr_b16 a[14:15], v45 offset:1024
    v_mfma_f32_16x16x32_bf16 a[80:83], a[40:43], a[184:187], a[80:83]
    buffer_load_dwordx4 v41, s[12:15], s61 offen offset:3072 lds
    ds_read_b64_tr_b16 a[16:17], v46 offset:0
    v_mfma_f32_16x16x32_bf16 a[84:87], a[40:43], a[188:191], a[84:87]
    ds_read_b64_tr_b16 a[18:19], v46 offset:1024
    v_mfma_f32_16x16x32_bf16 v[216:219], a[44:47], a[176:179], v[216:219]
    s_add_u32 s61, s61, 0x80000
    v_mfma_f32_16x16x32_bf16 v[220:223], a[44:47], a[180:183], v[220:223]
    buffer_load_dwordx4 a[224:227], v36, s[8:11], s62 offen offset:0 sc1
    ds_read_b64_tr_b16 a[20:21], v47 offset:0
    v_mfma_f32_16x16x32_bf16 a[88:91], a[44:47], a[184:187], a[88:91]
    ds_read_b64_tr_b16 a[22:23], v47 offset:1024
    v_mfma_f32_16x16x32_bf16 a[92:95], a[44:47], a[188:191], a[92:95]
    buffer_load_dwordx4 a[228:231], v36, s[8:11], s62 offen offset:1024 sc1
    ds_read_b64_tr_b16 a[24:25], v48 offset:0
    v_mfma_f32_16x16x32_bf16 v[224:227], a[48:51], a[176:179], v[224:227]
    v_mfma_f32_16x16x32_bf16 v[228:231], a[48:51], a[180:183], v[228:231]
    ds_read_b64_tr_b16 a[26:27], v48 offset:1024
    v_mfma_f32_16x16x32_bf16 a[96:99], a[48:51], a[184:187], a[96:99]
    buffer_load_dwordx4 a[232:235], v37, s[8:11], s62 offen offset:0 sc1
    ds_read_b64_tr_b16 a[28:29], v49 offset:0
    v_mfma_f32_16x16x32_bf16 a[100:103], a[48:51], a[188:191], a[100:103]
    v_mfma_f32_16x16x32_bf16 v[232:235], a[52:55], a[176:179], v[232:235]
    ds_read_b64_tr_b16 a[30:31], v49 offset:1024
    v_mfma_f32_16x16x32_bf16 v[236:239], a[52:55], a[180:183], v[236:239]
    buffer_load_dwordx4 a[236:239], v37, s[8:11], s62 offen offset:1024 sc1
    v_mfma_f32_16x16x32_bf16 a[104:107], a[52:55], a[184:187], a[104:107]
    v_mfma_f32_16x16x32_bf16 a[108:111], a[52:55], a[188:191], a[108:111]
    s_add_u32 s62, s62, 0x20000
    v_mfma_f32_16x16x32_bf16 v[240:243], a[56:59], a[176:179], v[240:243]
    s_add_u32 s52, s47, 524288
    v_mfma_f32_16x16x32_bf16 v[244:247], a[56:59], a[180:183], v[244:247]
    buffer_store_dwordx4 v[132:135], v1, s[48:51], s52 offen offset:1024 sc1
    v_mfma_f32_16x16x32_bf16 a[112:115], a[56:59], a[184:187], a[112:115]
    v_mfma_f32_16x16x32_bf16 a[116:119], a[56:59], a[188:191], a[116:119]
    v_mfma_f32_16x16x32_bf16 v[248:251], a[60:63], a[176:179], v[248:251]
    s_cmp_eq_u32 s45, 0
    s_cbranch_scc1 k12_ool_54
k12_oolret_55:
    v_mfma_f32_16x16x32_bf16 v[252:255], a[60:63], a[180:183], v[252:255]
    v_mfma_f32_16x16x32_bf16 a[120:123], a[60:63], a[184:187], a[120:123]
    v_mfma_f32_16x16x32_bf16 a[124:127], a[60:63], a[188:191], a[124:127]
    s_waitcnt vmcnt(15) lgkmcnt(0)
    v_mfma_f32_16x16x32_bf16 v[192:195], a[0:3], a[192:195], v[192:195]
    ds_read_b64_tr_b16 a[32:33], v42 offset:8192
    ds_read_b64_tr_b16 a[34:35], v42 offset:9216
    v_mfma_f32_16x16x32_bf16 v[196:199], a[0:3], a[196:199], v[196:199]
    buffer_load_dwordx4 a[240:243], v36, s[8:11], s62 offen offset:0 sc1
    v_mfma_f32_16x16x32_bf16 a[64:67], a[0:3], a[200:203], a[64:67]
    ds_read_b64_tr_b16 a[36:37], v43 offset:8192
    v_mfma_f32_16x16x32_bf16 a[68:71], a[0:3], a[204:207], a[68:71]
    ds_read_b64_tr_b16 a[38:39], v43 offset:9216
    v_mfma_f32_16x16x32_bf16 v[200:203], a[4:7], a[192:195], v[200:203]
    ds_read_b64_tr_b16 a[40:41], v44 offset:8192
    v_mfma_f32_16x16x32_bf16 v[204:207], a[4:7], a[196:199], v[204:207]
    v_mfma_f32_16x16x32_bf16 a[72:75], a[4:7], a[200:203], a[72:75]
    buffer_load_dwordx4 a[244:247], v36, s[8:11], s62 offen offset:1024 sc1
    ds_read_b64_tr_b16 a[42:43], v44 offset:9216
    v_mfma_f32_16x16x32_bf16 a[76:79], a[4:7], a[204:207], a[76:79]
    ds_read_b64_tr_b16 a[44:45], v45 offset:8192
    v_mfma_f32_16x16x32_bf16 v[208:211], a[8:11], a[192:195], v[208:211]
    v_mfma_f32_16x16x32_bf16 v[212:215], a[8:11], a[196:199], v[212:215]
    ds_read_b64_tr_b16 a[46:47], v45 offset:9216
    v_mfma_f32_16x16x32_bf16 a[80:83], a[8:11], a[200:203], a[80:83]
    ds_read_b64_tr_b16 a[48:49], v46 offset:8192
    v_mfma_f32_16x16x32_bf16 a[84:87], a[8:11], a[204:207], a[84:87]
    buffer_load_dwordx4 a[248:251], v37, s[8:11], s62 offen offset:0 sc1
    ds_read_b64_tr_b16 a[50:51], v46 offset:9216
    v_mfma_f32_16x16x32_bf16 v[216:219], a[12:15], a[192:195], v[216:219]
    v_mfma_f32_16x16x32_bf16 v[220:223], a[12:15], a[196:199], v[220:223]
    ds_read_b64_tr_b16 a[52:53], v47 offset:8192
    v_mfma_f32_16x16x32_bf16 a[88:91], a[12:15], a[200:203], a[88:91]
    ds_read_b64_tr_b16 a[54:55], v47 offset:9216
    v_mfma_f32_16x16x32_bf16 a[92:95], a[12:15], a[204:207], a[92:95]
    ds_read_b64_tr_b16 a[56:57], v48 offset:8192
    v_mfma_f32_16x16x32_bf16 v[224:227], a[16:19], a[192:195], v[224:227]
    v_mfma_f32_16x16x32_bf16 v[228:231], a[16:19], a[196:199], v[228:231]
    buffer_load_dwordx4 a[252:255], v37, s[8:11], s62 offen offset:1024 sc1
    ds_read_b64_tr_b16 a[58:59], v48 offset:9216
    v_mfma_f32_16x16x32_bf16 a[96:99], a[16:19], a[200:203], a[96:99]
    ds_read_b64_tr_b16 a[60:61], v49 offset:8192
    v_mfma_f32_16x16x32_bf16 a[100:103], a[16:19], a[204:207], a[100:103]
    v_mfma_f32_16x16x32_bf16 v[232:235], a[20:23], a[192:195], v[232:235]
    ds_read_b64_tr_b16 a[62:63], v49 offset:9216
    v_mfma_f32_16x16x32_bf16 v[236:239], a[20:23], a[196:199], v[236:239]
    s_add_u32 s62, s62, 0x20000
    v_mfma_f32_16x16x32_bf16 a[104:107], a[20:23], a[200:203], a[104:107]
    s_add_u32 s52, s47, 524288
    v_mfma_f32_16x16x32_bf16 a[108:111], a[20:23], a[204:207], a[108:111]
    buffer_store_dwordx4 v[136:139], v1, s[48:51], s52 offen offset:2048 sc1
    v_mfma_f32_16x16x32_bf16 v[240:243], a[24:27], a[192:195], v[240:243]
    v_mfma_f32_16x16x32_bf16 v[244:247], a[24:27], a[196:199], v[244:247]
    v_mfma_f32_16x16x32_bf16 a[112:115], a[24:27], a[200:203], a[112:115]
    v_mfma_f32_16x16x32_bf16 a[116:119], a[24:27], a[204:207], a[116:119]
    v_mfma_f32_16x16x32_bf16 v[248:251], a[28:31], a[192:195], v[248:251]
    v_mfma_f32_16x16x32_bf16 v[252:255], a[28:31], a[196:199], v[252:255]
    v_mfma_f32_16x16x32_bf16 a[120:123], a[28:31], a[200:203], a[120:123]
    v_mfma_f32_16x16x32_bf16 a[124:127], a[28:31], a[204:207], a[124:127]
    s_waitcnt vmcnt(10) lgkmcnt(0)
    s_barrier
    v_mfma_f32_16x16x32_bf16 v[192:195], a[32:35], a[208:211], v[192:195]
    ds_read_b64_tr_b16 a[0:1], v42 offset:16384
    ds_read_b64_tr_b16 a[2:3], v42 offset:17408
    v_mfma_f32_16x16x32_bf16 v[196:199], a[32:35], a[212:215], v[196:199]
    s_add_u32 m0, s60, 131072
    v_mfma_f32_16x16x32_bf16 a[64:67], a[32:35], a[216:219], a[64:67]
    buffer_load_dwordx4 v38, s[12:15], s61 offen offset:0 lds
    ds_read_b64_tr_b16 a[4:5], v43 offset:16384
    v_mfma_f32_16x16x32_bf16 a[68:71], a[32:35], a[220:223], a[68:71]
    ds_read_b64_tr_b16 a[6:7], v43 offset:17408
    v_mfma_f32_16x16x32_bf16 v[200:203], a[36:39], a[208:211], v[200:203]
    buffer_load_dwordx4 v39, s[12:15], s61 offen offset:1024 lds
    ds_read_b64_tr_b16 a[8:9], v44 offset:16384
    v_mfma_f32_16x16x32_bf16 v[204:207], a[36:39], a[212:215], v[204:207]
    v_mfma_f32_16x16x32_bf16 a[72:75], a[36:39], a[216:219], a[72:75]
    ds_read_b64_tr_b16 a[10:11], v44 offset:17408
    v_mfma_f32_16x16x32_bf16 a[76:79], a[36:39], a[220:223], a[76:79]
    buffer_load_dwordx4 v40, s[12:15], s61 offen offset:2048 lds
    ds_read_b64_tr_b16 a[12:13], v45 offset:16384
    v_mfma_f32_16x16x32_bf16 v[208:211], a[40:43], a[208:211], v[208:211]
    v_mfma_f32_16x16x32_bf16 v[212:215], a[40:43], a[212:215], v[212:215]
    ds_read_b64_tr_b16 a[14:15], v45 offset:17408
    v_mfma_f32_16x16x32_bf16 a[80:83], a[40:43], a[216:219], a[80:83]
    buffer_load_dwordx4 v41, s[12:15], s61 offen offset:3072 lds
    ds_read_b64_tr_b16 a[16:17], v46 offset:16384
    v_mfma_f32_16x16x32_bf16 a[84:87], a[40:43], a[220:223], a[84:87]
    ds_read_b64_tr_b16 a[18:19], v46 offset:17408
    v_mfma_f32_16x16x32_bf16 v[216:219], a[44:47], a[208:211], v[216:219]
    s_add_u32 s61, s61, 0x80000
    v_mfma_f32_16x16x32_bf16 v[220:223], a[44:47], a[212:215], v[220:223]
    buffer_load_dwordx4 a[128:131], v36, s[8:11], s62 offen offset:0 sc1
    ds_read_b64_tr_b16 a[20:21], v47 offset:16384
    v_mfma_f32_16x16x32_bf16 a[88:91], a[44:47], a[216:219], a[88:91]
    ds_read_b64_tr_b16 a[22:23], v47 offset:17408
    v_mfma_f32_16x16x32_bf16 a[92:95], a[44:47], a[220:223], a[92:95]
    buffer_load_dwordx4 a[132:135], v36, s[8:11], s62 offen offset:1024 sc1
    ds_read_b64_tr_b16 a[24:25], v48 offset:16384
    v_mfma_f32_16x16x32_bf16 v[224:227], a[48:51], a[208:211], v[224:227]
    v_mfma_f32_16x16x32_bf16 v[228:231], a[48:51], a[212:215], v[228:231]
    ds_read_b64_tr_b16 a[26:27], v48 offset:17408
    v_mfma_f32_16x16x32_bf16 a[96:99], a[48:51], a[216:219], a[96:99]
    buffer_load_dwordx4 a[136:139], v37, s[8:11], s62 offen offset:0 sc1
    ds_read_b64_tr_b16 a[28:29], v49 offset:16384
    v_mfma_f32_16x16x32_bf16 a[100:103], a[48:51], a[220:223], a[100:103]
    v_mfma_f32_16x16x32_bf16 v[232:235], a[52:55], a[208:211], v[232:235]
    ds_read_b64_tr_b16 a[30:31], v49 offset:17408
    v_mfma_f32_16x16x32_bf16 v[236:239], a[52:55], a[212:215], v[236:239]
    buffer_load_dwordx4 a[140:143], v37, s[8:11], s62 offen offset:1024 sc1
    v_mfma_f32_16x16x32_bf16 a[104:107], a[52:55], a[216:219], a[104:107]
    v_mfma_f32_16x16x32_bf16 a[108:111], a[52:55], a[220:223], a[108:111]
    s_add_u32 s62, s62, 0x20000
    v_mfma_f32_16x16x32_bf16 v[240:243], a[56:59], a[208:211], v[240:243]
    s_add_u32 s52, s47, 524288
    v_mfma_f32_16x16x32_bf16 v[244:247], a[56:59], a[212:215], v[244:247]
    buffer_store_dwordx4 v[140:143], v1, s[48:51], s52 offen offset:3072 sc1
    v_mfma_f32_16x16x32_bf16 a[112:115], a[56:59], a[216:219], a[112:115]
    v_mfma_f32_16x16x32_bf16 a[116:119], a[56:59], a[220:223], a[116:119]
    v_mfma_f32_16x16x32_bf16 v[248:251], a[60:63], a[208:211], v[248:251]
    s_cmp_eq_u32 s45, 0
    s_cbranch_scc1 k12_ool_56
k12_oolret_57:
    v_mfma_f32_16x16x32_bf16 v[252:255], a[60:63], a[212:215], v[252:255]
    v_mfma_f32_16x16x32_bf16 a[120:123], a[60:63], a[216:219], a[120:123]
    v_mfma_f32_16x16x32_bf16 a[124:127], a[60:63], a[220:223], a[124:127]
    s_waitcnt vmcnt(15) lgkmcnt(0)
    v_mfma_f32_16x16x32_bf16 v[192:195], a[0:3], a[224:227], v[192:195]
    ds_read_b64_tr_b16 a[32:33], v42 offset:24576
    ds_read_b64_tr_b16 a[34:35], v42 offset:25600
    v_mfma_f32_16x16x32_bf16 v[196:199], a[0:3], a[228:231], v[196:199]
    buffer_load_dwordx4 a[144:147], v36, s[8:11], s62 offen offset:0 sc1
    v_mfma_f32_16x16x32_bf16 a[64:67], a[0:3], a[232:235], a[64:67]
    ds_read_b64_tr_b16 a[36:37], v43 offset:24576
    v_mfma_f32_16x16x32_bf16 a[68:71], a[0:3], a[236:239], a[68:71]
    ds_read_b64_tr_b16 a[38:39], v43 offset:25600
    v_mfma_f32_16x16x32_bf16 v[200:203], a[4:7], a[224:227], v[200:203]
    ds_read_b64_tr_b16 a[40:41], v44 offset:24576
    v_mfma_f32_16x16x32_bf16 v[204:207], a[4:7], a[228:231], v[204:207]
    v_mfma_f32_16x16x32_bf16 a[72:75], a[4:7], a[232:235], a[72:75]
    buffer_load_dwordx4 a[148:151], v36, s[8:11], s62 offen offset:1024 sc1
    ds_read_b64_tr_b16 a[42:43], v44 offset:25600
    v_mfma_f32_16x16x32_bf16 a[76:79], a[4:7], a[236:239], a[76:79]
    ds_read_b64_tr_b16 a[44:45], v45 offset:24576
    v_mfma_f32_16x16x32_bf16 v[208:211], a[8:11], a[224:227], v[208:211]
    v_mfma_f32_16x16x32_bf16 v[212:215], a[8:11], a[228:231], v[212:215]
    ds_read_b64_tr_b16 a[46:47], v45 offset:25600
    v_mfma_f32_16x16x32_bf16 a[80:83], a[8:11], a[232:235], a[80:83]
    ds_read_b64_tr_b16 a[48:49], v46 offset:24576
    v_mfma_f32_16x16x32_bf16 a[84:87], a[8:11], a[236:239], a[84:87]
    buffer_load_dwordx4 a[152:155], v37, s[8:11], s62 offen offset:0 sc1
    ds_read_b64_tr_b16 a[50:51], v46 offset:25600
    v_mfma_f32_16x16x32_bf16 v[216:219], a[12:15], a[224:227], v[216:219]
    v_mfma_f32_16x16x32_bf16 v[220:223], a[12:15], a[228:231], v[220:223]
    ds_read_b64_tr_b16 a[52:53], v47 offset:24576
    v_mfma_f32_16x16x32_bf16 a[88:91], a[12:15], a[232:235], a[88:91]
    ds_read_b64_tr_b16 a[54:55], v47 offset:25600
    v_mfma_f32_16x16x32_bf16 a[92:95], a[12:15], a[236:239], a[92:95]
    ds_read_b64_tr_b16 a[56:57], v48 offset:24576
    v_mfma_f32_16x16x32_bf16 v[224:227], a[16:19], a[224:227], v[224:227]
    v_mfma_f32_16x16x32_bf16 v[228:231], a[16:19], a[228:231], v[228:231]
    buffer_load_dwordx4 a[156:159], v37, s[8:11], s62 offen offset:1024 sc1
    ds_read_b64_tr_b16 a[58:59], v48 offset:25600
    v_mfma_f32_16x16x32_bf16 a[96:99], a[16:19], a[232:235], a[96:99]
    ds_read_b64_tr_b16 a[60:61], v49 offset:24576
    v_mfma_f32_16x16x32_bf16 a[100:103], a[16:19], a[236:239], a[100:103]
    v_mfma_f32_16x16x32_bf16 v[232:235], a[20:23], a[224:227], v[232:235]
    ds_read_b64_tr_b16 a[62:63], v49 offset:25600
    v_mfma_f32_16x16x32_bf16 v[236:239], a[20:23], a[228:231], v[236:239]
    s_add_u32 s62, s62, 0x20000
    v_mfma_f32_16x16x32_bf16 a[104:107], a[20:23], a[232:235], a[104:107]
    s_add_u32 s52, s47, 528384
    v_mfma_f32_16x16x32_bf16 a[108:111], a[20:23], a[236:239], a[108:111]
    buffer_store_dwordx4 v[144:147], v1, s[48:51], s52 offen offset:0 sc1
    v_mfma_f32_16x16x32_bf16 v[240:243], a[24:27], a[224:227], v[240:243]
    v_mfma_f32_16x16x32_bf16 v[244:247], a[24:27], a[228:231], v[244:247]
    v_mfma_f32_16x16x32_bf16 a[112:115], a[24:27], a[232:235], a[112:115]
    v_mfma_f32_16x16x32_bf16 a[116:119], a[24:27], a[236:239], a[116:119]
    v_mfma_f32_16x16x32_bf16 v[248:251], a[28:31], a[224:227], v[248:251]
    v_mfma_f32_16x16x32_bf16 v[252:255], a[28:31], a[228:231], v[252:255]
    v_mfma_f32_16x16x32_bf16 a[120:123], a[28:31], a[232:235], a[120:123]
    v_mfma_f32_16x16x32_bf16 a[124:127], a[28:31], a[236:239], a[124:127]
    s_waitcnt vmcnt(10) lgkmcnt(0)
    s_barrier
    v_mfma_f32_16x16x32_bf16 v[192:195], a[32:35], a[240:243], v[192:195]
    ds_read_b64_tr_b16 a[0:1], v42 offset:32768
    ds_read_b64_tr_b16 a[2:3], v42 offset:33792
    v_mfma_f32_16x16x32_bf16 v[196:199], a[32:35], a[244:247], v[196:199]
    s_add_u32 m0, s60, 147456
    v_mfma_f32_16x16x32_bf16 a[64:67], a[32:35], a[248:251], a[64:67]
    buffer_load_dwordx4 v38, s[12:15], s61 offen offset:0 lds
    ds_read_b64_tr_b16 a[4:5], v43 offset:32768
    v_mfma_f32_16x16x32_bf16 a[68:71], a[32:35], a[252:255], a[68:71]
    ds_read_b64_tr_b16 a[6:7], v43 offset:33792
    v_mfma_f32_16x16x32_bf16 v[200:203], a[36:39], a[240:243], v[200:203]
    buffer_load_dwordx4 v39, s[12:15], s61 offen offset:1024 lds
    ds_read_b64_tr_b16 a[8:9], v44 offset:32768
    v_mfma_f32_16x16x32_bf16 v[204:207], a[36:39], a[244:247], v[204:207]
    v_mfma_f32_16x16x32_bf16 a[72:75], a[36:39], a[248:251], a[72:75]
    buffer_load_dwordx4 v40, s[12:15], s61 offen offset:2048 lds
    ds_read_b64_tr_b16 a[10:11], v44 offset:33792
    v_mfma_f32_16x16x32_bf16 a[76:79], a[36:39], a[252:255], a[76:79]
    ds_read_b64_tr_b16 a[12:13], v45 offset:32768
    v_mfma_f32_16x16x32_bf16 v[208:211], a[40:43], a[240:243], v[208:211]
    v_mfma_f32_16x16x32_bf16 v[212:215], a[40:43], a[244:247], v[212:215]
    buffer_load_dwordx4 v41, s[12:15], s61 offen offset:3072 lds
    ds_read_b64_tr_b16 a[14:15], v45 offset:33792
    v_mfma_f32_16x16x32_bf16 a[80:83], a[40:43], a[248:251], a[80:83]
    s_add_u32 s61, s61, 0x80000
    ds_read_b64_tr_b16 a[16:17], v46 offset:32768
    v_mfma_f32_16x16x32_bf16 a[84:87], a[40:43], a[252:255], a[84:87]
    buffer_load_dwordx4 a[160:163], v36, s[8:11], s62 offen offset:0 sc1
    ds_read_b64_tr_b16 a[18:19], v46 offset:33792
    v_mfma_f32_16x16x32_bf16 v[216:219], a[44:47], a[240:243], v[216:219]
    v_mfma_f32_16x16x32_bf16 v[220:223], a[44:47], a[244:247], v[220:223]
    ds_read_b64_tr_b16 a[20:21], v47 offset:32768
    v_mfma_f32_16x16x32_bf16 a[88:91], a[44:47], a[248:251], a[88:91]
    buffer_load_dwordx4 a[164:167], v36, s[8:11], s62 offen offset:1024 sc1
    ds_read_b64_tr_b16 a[22:23], v47 offset:33792
    v_mfma_f32_16x16x32_bf16 a[92:95], a[44:47], a[252:255], a[92:95]
    ds_read_b64_tr_b16 a[24:25], v48 offset:32768
    v_mfma_f32_16x16x32_bf16 v[224:227], a[48:51], a[240:243], v[224:227]
    v_mfma_f32_16x16x32_bf16 v[228:231], a[48:51], a[244:247], v[228:231]
    buffer_load_dwordx4 a[168:171], v37, s[8:11], s62 offen offset:0 sc1
    ds_read_b64_tr_b16 a[26:27], v48 offset:33792
    v_mfma_f32_16x16x32_bf16 a[96:99], a[48:51], a[248:251], a[96:99]
    ds_read_b64_tr_b16 a[28:29], v49 offset:32768
    v_mfma_f32_16x16x32_bf16 a[100:103], a[48:51], a[252:255], a[100:103]
    buffer_load_dwordx4 a[172:175], v37, s[8:11], s62 offen offset:1024 sc1
    v_mfma_f32_16x16x32_bf16 v[232:235], a[52:55], a[240:243], v[232:235]
    ds_read_b64_tr_b16 a[30:31], v49 offset:33792
    v_mfma_f32_16x16x32_bf16 v[236:239], a[52:55], a[244:247], v[236:239]
    s_add_u32 s62, s62, 0x20000
    v_mfma_f32_16x16x32_bf16 a[104:107], a[52:55], a[248:251], a[104:107]
    s_add_u32 s52, s47, 528384
    v_mfma_f32_16x16x32_bf16 a[108:111], a[52:55], a[252:255], a[108:111]
    buffer_store_dwordx4 v[148:151], v1, s[48:51], s52 offen offset:1024 sc1
    v_mfma_f32_16x16x32_bf16 v[240:243], a[56:59], a[240:243], v[240:243]
    s_add_u32 s52, s47, 528384
    v_mfma_f32_16x16x32_bf16 v[244:247], a[56:59], a[244:247], v[244:247]
    buffer_store_dwordx4 v[152:155], v1, s[48:51], s52 offen offset:2048 sc1
    v_mfma_f32_16x16x32_bf16 a[112:115], a[56:59], a[248:251], a[112:115]
    v_mfma_f32_16x16x32_bf16 a[116:119], a[56:59], a[252:255], a[116:119]
    v_mfma_f32_16x16x32_bf16 v[248:251], a[60:63], a[240:243], v[248:251]
    s_cmp_eq_u32 s45, 0
    s_cbranch_scc1 k12_ool_58
k12_oolret_59:
    v_mfma_f32_16x16x32_bf16 v[252:255], a[60:63], a[244:247], v[252:255]
    v_mfma_f32_16x16x32_bf16 a[120:123], a[60:63], a[248:251], a[120:123]
    v_mfma_f32_16x16x32_bf16 a[124:127], a[60:63], a[252:255], a[124:127]
    s_waitcnt vmcnt(16) lgkmcnt(0)
    v_mfma_f32_16x16x32_bf16 v[192:195], a[0:3], a[128:131], v[192:195]
    ds_read_b64_tr_b16 a[32:33], v42 offset:40960
    ds_read_b64_tr_b16 a[34:35], v42 offset:41984
    v_mfma_f32_16x16x32_bf16 v[196:199], a[0:3], a[132:135], v[196:199]
    buffer_load_dwordx4 a[176:179], v36, s[8:11], s62 offen offset:0 sc1
    v_mfma_f32_16x16x32_bf16 a[64:67], a[0:3], a[136:139], a[64:67]
    ds_read_b64_tr_b16 a[36:37], v43 offset:40960
    v_mfma_f32_16x16x32_bf16 a[68:71], a[0:3], a[140:143], a[68:71]
    ds_read_b64_tr_b16 a[38:39], v43 offset:41984
    v_mfma_f32_16x16x32_bf16 v[200:203], a[4:7], a[128:131], v[200:203]
    ds_read_b64_tr_b16 a[40:41], v44 offset:40960
    v_mfma_f32_16x16x32_bf16 v[204:207], a[4:7], a[132:135], v[204:207]
    v_mfma_f32_16x16x32_bf16 a[72:75], a[4:7], a[136:139], a[72:75]
    buffer_load_dwordx4 a[180:183], v36, s[8:11], s62 offen offset:1024 sc1
    ds_read_b64_tr_b16 a[42:43], v44 offset:41984
    v_mfma_f32_16x16x32_bf16 a[76:79], a[4:7], a[140:143], a[76:79]
    ds_read_b64_tr_b16 a[44:45], v45 offset:40960
    v_mfma_f32_16x16x32_bf16 v[208:211], a[8:11], a[128:131], v[208:211]
    v_mfma_f32_16x16x32_bf16 v[212:215], a[8:11], a[132:135], v[212:215]
    ds_read_b64_tr_b16 a[46:47], v45 offset:41984
    v_mfma_f32_16x16x32_bf16 a[80:83], a[8:11], a[136:139], a[80:83]
    ds_read_b64_tr_b16 a[48:49], v46 offset:40960
    v_mfma_f32_16x16x32_bf16 a[84:87], a[8:11], a[140:143], a[84:87]
    buffer_load_dwordx4 a[184:187], v37, s[8:11], s62 offen offset:0 sc1
    ds_read_b64_tr_b16 a[50:51], v46 offset:41984
    v_mfma_f32_16x16x32_bf16 v[216:219], a[12:15], a[128:131], v[216:219]
    v_mfma_f32_16x16x32_bf16 v[220:223], a[12:15], a[132:135], v[220:223]
    ds_read_b64_tr_b16 a[52:53], v47 offset:40960
    v_mfma_f32_16x16x32_bf16 a[88:91], a[12:15], a[136:139], a[88:91]
    ds_read_b64_tr_b16 a[54:55], v47 offset:41984
    v_mfma_f32_16x16x32_bf16 a[92:95], a[12:15], a[140:143], a[92:95]
    ds_read_b64_tr_b16 a[56:57], v48 offset:40960
    v_mfma_f32_16x16x32_bf16 v[224:227], a[16:19], a[128:131], v[224:227]
    v_mfma_f32_16x16x32_bf16 v[228:231], a[16:19], a[132:135], v[228:231]
    buffer_load_dwordx4 a[188:191], v37, s[8:11], s62 offen offset:1024 sc1
    ds_read_b64_tr_b16 a[58:59], v48 offset:41984
    v_mfma_f32_16x16x32_bf16 a[96:99], a[16:19], a[136:139], a[96:99]
    ds_read_b64_tr_b16 a[60:61], v49 offset:40960
    v_mfma_f32_16x16x32_bf16 a[100:103], a[16:19], a[140:143], a[100:103]
    v_mfma_f32_16x16x32_bf16 v[232:235], a[20:23], a[128:131], v[232:235]
    ds_read_b64_tr_b16 a[62:63], v49 offset:41984
    v_mfma_f32_16x16x32_bf16 v[236:239], a[20:23], a[132:135], v[236:239]
    s_add_u32 s62, s62, 0x20000
    v_mfma_f32_16x16x32_bf16 a[104:107], a[20:23], a[136:139], a[104:107]
    s_add_u32 s52, s47, 528384
    v_mfma_f32_16x16x32_bf16 a[108:111], a[20:23], a[140:143], a[108:111]
    buffer_store_dwordx4 v[156:159], v1, s[48:51], s52 offen offset:3072 sc1
    v_mfma_f32_16x16x32_bf16 v[240:243], a[24:27], a[128:131], v[240:243]
    v_mfma_f32_16x16x32_bf16 v[244:247], a[24:27], a[132:135], v[244:247]
    v_mfma_f32_16x16x32_bf16 a[112:115], a[24:27], a[136:139], a[112:115]
    v_mfma_f32_16x16x32_bf16 a[116:119], a[24:27], a[140:143], a[116:119]
    v_mfma_f32_16x16x32_bf16 v[248:251], a[28:31], a[128:131], v[248:251]
    v_mfma_f32_16x16x32_bf16 v[252:255], a[28:31], a[132:135], v[252:255]
    v_mfma_f32_16x16x32_bf16 a[120:123], a[28:31], a[136:139], a[120:123]
    v_mfma_f32_16x16x32_bf16 a[124:127], a[28:31], a[140:143], a[124:127]
    s_waitcnt vmcnt(11) lgkmcnt(0)
    s_barrier
    v_mfma_f32_16x16x32_bf16 v[192:195], a[32:35], a[144:147], v[192:195]
    ds_read_b64_tr_b16 a[0:1], v42 offset:49152
    ds_read_b64_tr_b16 a[2:3], v42 offset:50176
    v_mfma_f32_16x16x32_bf16 v[196:199], a[32:35], a[148:151], v[196:199]
    s_add_u32 m0, s60, 98304
    v_mfma_f32_16x16x32_bf16 a[64:67], a[32:35], a[152:155], a[64:67]
    buffer_load_dwordx4 v38, s[12:15], s61 offen offset:0 lds
    ds_read_b64_tr_b16 a[4:5], v43 offset:49152
    v_mfma_f32_16x16x32_bf16 a[68:71], a[32:35], a[156:159], a[68:71]
    ds_read_b64_tr_b16 a[6:7], v43 offset:50176
    v_mfma_f32_16x16x32_bf16 v[200:203], a[36:39], a[144:147], v[200:203]
    buffer_load_dwordx4 v39, s[12:15], s61 offen offset:1024 lds
    ds_read_b64_tr_b16 a[8:9], v44 offset:49152
    v_mfma_f32_16x16x32_bf16 v[204:207], a[36:39], a[148:151], v[204:207]
    v_mfma_f32_16x16x32_bf16 a[72:75], a[36:39], a[152:155], a[72:75]
    ds_read_b64_tr_b16 a[10:11], v44 offset:50176
    v_mfma_f32_16x16x32_bf16 a[76:79], a[36:39], a[156:159], a[76:79]
    buffer_load_dwordx4 v40, s[12:15], s61 offen offset:2048 lds
    ds_read_b64_tr_b16 a[12:13], v45 offset:49152
    v_mfma_f32_16x16x32_bf16 v[208:211], a[40:43], a[144:147], v[208:211]
    v_mfma_f32_16x16x32_bf16 v[212:215], a[40:43], a[148:151], v[212:215]
    ds_read_b64_tr_b16 a[14:15], v45 offset:50176
    v_mfma_f32_16x16x32_bf16 a[80:83], a[40:43], a[152:155], a[80:83]
    buffer_load_dwordx4 v41, s[12:15], s61 offen offset:3072 lds
    ds_read_b64_tr_b16 a[16:17], v46 offset:49152
    v_mfma_f32_16x16x32_bf16 a[84:87], a[40:43], a[156:159], a[84:87]
    ds_read_b64_tr_b16 a[18:19], v46 offset:50176
    v_mfma_f32_16x16x32_bf16 v[216:219], a[44:47], a[144:147], v[216:219]
    s_add_u32 s61, s61, 0x80000
    v_mfma_f32_16x16x32_bf16 v[220:223], a[44:47], a[148:151], v[220:223]
    buffer_load_dwordx4 a[192:195], v36, s[8:11], s62 offen offset:0 sc1
    ds_read_b64_tr_b16 a[20:21], v47 offset:49152
    v_mfma_f32_16x16x32_bf16 a[88:91], a[44:47], a[152:155], a[88:91]
    ds_read_b64_tr_b16 a[22:23], v47 offset:50176
    v_mfma_f32_16x16x32_bf16 a[92:95], a[44:47], a[156:159], a[92:95]
    buffer_load_dwordx4 a[196:199], v36, s[8:11], s62 offen offset:1024 sc1
    ds_read_b64_tr_b16 a[24:25], v48 offset:49152
    v_mfma_f32_16x16x32_bf16 v[224:227], a[48:51], a[144:147], v[224:227]
    v_mfma_f32_16x16x32_bf16 v[228:231], a[48:51], a[148:151], v[228:231]
    ds_read_b64_tr_b16 a[26:27], v48 offset:50176
    v_mfma_f32_16x16x32_bf16 a[96:99], a[48:51], a[152:155], a[96:99]
    buffer_load_dwordx4 a[200:203], v37, s[8:11], s62 offen offset:0 sc1
    ds_read_b64_tr_b16 a[28:29], v49 offset:49152
    v_mfma_f32_16x16x32_bf16 a[100:103], a[48:51], a[156:159], a[100:103]
    v_mfma_f32_16x16x32_bf16 v[232:235], a[52:55], a[144:147], v[232:235]
    ds_read_b64_tr_b16 a[30:31], v49 offset:50176
    v_mfma_f32_16x16x32_bf16 v[236:239], a[52:55], a[148:151], v[236:239]
    buffer_load_dwordx4 a[204:207], v37, s[8:11], s62 offen offset:1024 sc1
    v_mfma_f32_16x16x32_bf16 a[104:107], a[52:55], a[152:155], a[104:107]
    v_mfma_f32_16x16x32_bf16 a[108:111], a[52:55], a[156:159], a[108:111]
    s_add_u32 s62, s62, 0x20000
    v_mfma_f32_16x16x32_bf16 v[240:243], a[56:59], a[144:147], v[240:243]
    s_add_u32 s52, s47, 532480
    v_mfma_f32_16x16x32_bf16 v[244:247], a[56:59], a[148:151], v[244:247]
    buffer_store_dwordx4 v[160:163], v1, s[48:51], s52 offen offset:0 sc1
    v_mfma_f32_16x16x32_bf16 a[112:115], a[56:59], a[152:155], a[112:115]
    v_mfma_f32_16x16x32_bf16 a[116:119], a[56:59], a[156:159], a[116:119]
    v_mfma_f32_16x16x32_bf16 v[248:251], a[60:63], a[144:147], v[248:251]
    v_mfma_f32_16x16x32_bf16 v[252:255], a[60:63], a[148:151], v[252:255]
    v_mfma_f32_16x16x32_bf16 a[120:123], a[60:63], a[152:155], a[120:123]
    v_mfma_f32_16x16x32_bf16 a[124:127], a[60:63], a[156:159], a[124:127]
    s_waitcnt vmcnt(16) lgkmcnt(0)
    v_mfma_f32_16x16x32_bf16 v[192:195], a[0:3], a[160:163], v[192:195]
    ds_read_b64_tr_b16 a[32:33], v42 offset:57344
    ds_read_b64_tr_b16 a[34:35], v42 offset:58368
    v_mfma_f32_16x16x32_bf16 v[196:199], a[0:3], a[164:167], v[196:199]
    buffer_load_dwordx4 a[208:211], v36, s[8:11], s62 offen offset:0 sc1
    v_mfma_f32_16x16x32_bf16 a[64:67], a[0:3], a[168:171], a[64:67]
    ds_read_b64_tr_b16 a[36:37], v43 offset:57344
    v_mfma_f32_16x16x32_bf16 a[68:71], a[0:3], a[172:175], a[68:71]
    ds_read_b64_tr_b16 a[38:39], v43 offset:58368
    v_mfma_f32_16x16x32_bf16 v[200:203], a[4:7], a[160:163], v[200:203]
    ds_read_b64_tr_b16 a[40:41], v44 offset:57344
    v_mfma_f32_16x16x32_bf16 v[204:207], a[4:7], a[164:167], v[204:207]
    v_mfma_f32_16x16x32_bf16 a[72:75], a[4:7], a[168:171], a[72:75]
    buffer_load_dwordx4 a[212:215], v36, s[8:11], s62 offen offset:1024 sc1
    ds_read_b64_tr_b16 a[42:43], v44 offset:58368
    v_mfma_f32_16x16x32_bf16 a[76:79], a[4:7], a[172:175], a[76:79]
    ds_read_b64_tr_b16 a[44:45], v45 offset:57344
    v_mfma_f32_16x16x32_bf16 v[208:211], a[8:11], a[160:163], v[208:211]
    v_mfma_f32_16x16x32_bf16 v[212:215], a[8:11], a[164:167], v[212:215]
    ds_read_b64_tr_b16 a[46:47], v45 offset:58368
    v_mfma_f32_16x16x32_bf16 a[80:83], a[8:11], a[168:171], a[80:83]
    ds_read_b64_tr_b16 a[48:49], v46 offset:57344
    v_mfma_f32_16x16x32_bf16 a[84:87], a[8:11], a[172:175], a[84:87]
    buffer_load_dwordx4 a[216:219], v37, s[8:11], s62 offen offset:0 sc1
    ds_read_b64_tr_b16 a[50:51], v46 offset:58368
    v_mfma_f32_16x16x32_bf16 v[216:219], a[12:15], a[160:163], v[216:219]
    v_mfma_f32_16x16x32_bf16 v[220:223], a[12:15], a[164:167], v[220:223]
    ds_read_b64_tr_b16 a[52:53], v47 offset:57344
    v_mfma_f32_16x16x32_bf16 a[88:91], a[12:15], a[168:171], a[88:91]
    ds_read_b64_tr_b16 a[54:55], v47 offset:58368
    v_mfma_f32_16x16x32_bf16 a[92:95], a[12:15], a[172:175], a[92:95]
    ds_read_b64_tr_b16 a[56:57], v48 offset:57344
    v_mfma_f32_16x16x32_bf16 v[224:227], a[16:19], a[160:163], v[224:227]
    v_mfma_f32_16x16x32_bf16 v[228:231], a[16:19], a[164:167], v[228:231]
    buffer_load_dwordx4 a[220:223], v37, s[8:11], s62 offen offset:1024 sc1
    ds_read_b64_tr_b16 a[58:59], v48 offset:58368
    v_mfma_f32_16x16x32_bf16 a[96:99], a[16:19], a[168:171], a[96:99]
    ds_read_b64_tr_b16 a[60:61], v49 offset:57344
    v_mfma_f32_16x16x32_bf16 a[100:103], a[16:19], a[172:175], a[100:103]
    v_mfma_f32_16x16x32_bf16 v[232:235], a[20:23], a[160:163], v[232:235]
    ds_read_b64_tr_b16 a[62:63], v49 offset:58368
    v_mfma_f32_16x16x32_bf16 v[236:239], a[20:23], a[164:167], v[236:239]
    s_add_u32 s62, s62, 0x20000
    v_mfma_f32_16x16x32_bf16 a[104:107], a[20:23], a[168:171], a[104:107]
    s_add_u32 s52, s47, 532480
    v_mfma_f32_16x16x32_bf16 a[108:111], a[20:23], a[172:175], a[108:111]
    buffer_store_dwordx4 v[164:167], v1, s[48:51], s52 offen offset:1024 sc1
    v_mfma_f32_16x16x32_bf16 v[240:243], a[24:27], a[160:163], v[240:243]
    v_mfma_f32_16x16x32_bf16 v[244:247], a[24:27], a[164:167], v[244:247]
    v_mfma_f32_16x16x32_bf16 a[112:115], a[24:27], a[168:171], a[112:115]
    v_mfma_f32_16x16x32_bf16 a[116:119], a[24:27], a[172:175], a[116:119]
    v_mfma_f32_16x16x32_bf16 v[248:251], a[28:31], a[160:163], v[248:251]
    v_mfma_f32_16x16x32_bf16 v[252:255], a[28:31], a[164:167], v[252:255]
    v_mfma_f32_16x16x32_bf16 a[120:123], a[28:31], a[168:171], a[120:123]
    v_mfma_f32_16x16x32_bf16 a[124:127], a[28:31], a[172:175], a[124:127]
    s_waitcnt vmcnt(10) lgkmcnt(0)
    s_barrier
    v_mfma_f32_16x16x32_bf16 v[192:195], a[32:35], a[176:179], v[192:195]
    ds_read_b64_tr_b16 a[0:1], v42 offset:0
    ds_read_b64_tr_b16 a[2:3], v42 offset:1024
    v_mfma_f32_16x16x32_bf16 v[196:199], a[32:35], a[180:183], v[196:199]
    s_cmp_eq_u32 s56, 0
    s_cbranch_scc1 k12_ool_60
k12_oolret_61:
    v_mfma_f32_16x16x32_bf16 a[64:67], a[32:35], a[184:187], a[64:67]
    s_add_u32 m0, s60, 114688
    ds_read_b64_tr_b16 a[4:5], v43 offset:0
    v_mfma_f32_16x16x32_bf16 a[68:71], a[32:35], a[188:191], a[68:71]
    buffer_load_dwordx4 v38, s[12:15], s61 offen offset:0 lds
    ds_read_b64_tr_b16 a[6:7], v43 offset:1024
    v_mfma_f32_16x16x32_bf16 v[200:203], a[36:39], a[176:179], v[200:203]
    buffer_load_dwordx4 v39, s[12:15], s61 offen offset:1024 lds
    ds_read_b64_tr_b16 a[8:9], v44 offset:0
    v_mfma_f32_16x16x32_bf16 v[204:207], a[36:39], a[180:183], v[204:207]
    v_mfma_f32_16x16x32_bf16 a[72:75], a[36:39], a[184:187], a[72:75]
    ds_read_b64_tr_b16 a[10:11], v44 offset:1024
    v_mfma_f32_16x16x32_bf16 a[76:79], a[36:39], a[188:191], a[76:79]
    buffer_load_dwordx4 v40, s[12:15], s61 offen offset:2048 lds
    ds_read_b64_tr_b16 a[12:13], v45 offset:0
    v_mfma_f32_16x16x32_bf16 v[208:211], a[40:43], a[176:179], v[208:211]
    s_mov_b32 s32, s60
    v_mfma_f32_16x16x32_bf16 v[212:215], a[40:43], a[180:183], v[212:215]
    ds_read_b64_tr_b16 a[14:15], v45 offset:1024
    v_mfma_f32_16x16x32_bf16 a[80:83], a[40:43], a[184:187], a[80:83]
    s_mov_b32 s34, s60
    buffer_load_dwordx4 v41, s[12:15], s61 offen offset:3072 lds
    ds_read_b64_tr_b16 a[16:17], v46 offset:0
    v_mfma_f32_16x16x32_bf16 a[84:87], a[40:43], a[188:191], a[84:87]
    ds_read_b64_tr_b16 a[18:19], v46 offset:1024
    v_mfma_f32_16x16x32_bf16 v[216:219], a[44:47], a[176:179], v[216:219]
    s_add_u32 s61, s61, 0x80000
    v_mfma_f32_16x16x32_bf16 v[220:223], a[44:47], a[180:183], v[220:223]
    s_mov_b32 s33, s60
    buffer_load_dwordx4 a[224:227], v36, s[8:11], s62 offen offset:0 sc1
    ds_read_b64_tr_b16 a[20:21], v47 offset:0
    v_mfma_f32_16x16x32_bf16 a[88:91], a[44:47], a[184:187], a[88:91]
    ds_read_b64_tr_b16 a[22:23], v47 offset:1024
    v_mfma_f32_16x16x32_bf16 a[92:95], a[44:47], a[188:191], a[92:95]
    buffer_load_dwordx4 a[228:231], v36, s[8:11], s62 offen offset:1024 sc1
    ds_read_b64_tr_b16 a[24:25], v48 offset:0
    v_mfma_f32_16x16x32_bf16 v[224:227], a[48:51], a[176:179], v[224:227]
    s_add_u32 s35, s60, 0x10000
    v_mfma_f32_16x16x32_bf16 v[228:231], a[48:51], a[180:183], v[228:231]
    ds_read_b64_tr_b16 a[26:27], v48 offset:1024
    v_mfma_f32_16x16x32_bf16 a[96:99], a[48:51], a[184:187], a[96:99]
    buffer_load_dwordx4 a[232:235], v37, s[8:11], s62 offen offset:0 sc1
    ds_read_b64_tr_b16 a[28:29], v49 offset:0
    v_mfma_f32_16x16x32_bf16 a[100:103], a[48:51], a[188:191], a[100:103]
    v_mfma_f32_16x16x32_bf16 v[232:235], a[52:55], a[176:179], v[232:235]
    ds_read_b64_tr_b16 a[30:31], v49 offset:1024
    v_mfma_f32_16x16x32_bf16 v[236:239], a[52:55], a[180:183], v[236:239]
    buffer_load_dwordx4 a[236:239], v37, s[8:11], s62 offen offset:1024 sc1
    v_mfma_f32_16x16x32_bf16 a[104:107], a[52:55], a[184:187], a[104:107]
    v_mfma_f32_16x16x32_bf16 a[108:111], a[52:55], a[188:191], a[108:111]
    s_add_u32 s62, s62, 0x20000
    v_mfma_f32_16x16x32_bf16 v[240:243], a[56:59], a[176:179], v[240:243]
    s_add_u32 s52, s47, 532480
    v_mfma_f32_16x16x32_bf16 v[244:247], a[56:59], a[180:183], v[244:247]
    buffer_store_dwordx4 v[168:171], v1, s[48:51], s52 offen offset:2048 sc1
    v_mfma_f32_16x16x32_bf16 a[112:115], a[56:59], a[184:187], a[112:115]
    v_mfma_f32_16x16x32_bf16 a[116:119], a[56:59], a[188:191], a[116:119]
    v_mfma_f32_16x16x32_bf16 v[248:251], a[60:63], a[176:179], v[248:251]
    v_mfma_f32_16x16x32_bf16 v[252:255], a[60:63], a[180:183], v[252:255]
    v_mfma_f32_16x16x32_bf16 a[120:123], a[60:63], a[184:187], a[120:123]
    v_mfma_f32_16x16x32_bf16 a[124:127], a[60:63], a[188:191], a[124:127]
    s_waitcnt vmcnt(15) lgkmcnt(0)
    v_mfma_f32_16x16x32_bf16 v[192:195], a[0:3], a[192:195], v[192:195]
    ds_read_b64_tr_b16 a[32:33], v42 offset:8192
    ds_read_b64_tr_b16 a[34:35], v42 offset:9216
    v_mfma_f32_16x16x32_bf16 v[196:199], a[0:3], a[196:199], v[196:199]
    buffer_load_dwordx4 a[240:243], v36, s[8:11], s62 offen offset:0 sc1
    v_mfma_f32_16x16x32_bf16 a[64:67], a[0:3], a[200:203], a[64:67]
    ds_read_b64_tr_b16 a[36:37], v43 offset:8192
    v_mfma_f32_16x16x32_bf16 a[68:71], a[0:3], a[204:207], a[68:71]
    ds_read_b64_tr_b16 a[38:39], v43 offset:9216
    v_mfma_f32_16x16x32_bf16 v[200:203], a[4:7], a[192:195], v[200:203]
    ds_read_b64_tr_b16 a[40:41], v44 offset:8192
    v_mfma_f32_16x16x32_bf16 v[204:207], a[4:7], a[196:199], v[204:207]
    v_mfma_f32_16x16x32_bf16 a[72:75], a[4:7], a[200:203], a[72:75]
    buffer_load_dwordx4 a[244:247], v36, s[8:11], s62 offen offset:1024 sc1
    ds_read_b64_tr_b16 a[42:43], v44 offset:9216
    v_mfma_f32_16x16x32_bf16 a[76:79], a[4:7], a[204:207], a[76:79]
    ds_read_b64_tr_b16 a[44:45], v45 offset:8192
    v_mfma_f32_16x16x32_bf16 v[208:211], a[8:11], a[192:195], v[208:211]
    v_mfma_f32_16x16x32_bf16 v[212:215], a[8:11], a[196:199], v[212:215]
    ds_read_b64_tr_b16 a[46:47], v45 offset:9216
    v_mfma_f32_16x16x32_bf16 a[80:83], a[8:11], a[200:203], a[80:83]
    ds_read_b64_tr_b16 a[48:49], v46 offset:8192
    v_mfma_f32_16x16x32_bf16 a[84:87], a[8:11], a[204:207], a[84:87]
    buffer_load_dwordx4 a[248:251], v37, s[8:11], s62 offen offset:0 sc1
    ds_read_b64_tr_b16 a[50:51], v46 offset:9216
    v_mfma_f32_16x16x32_bf16 v[216:219], a[12:15], a[192:195], v[216:219]
    v_mfma_f32_16x16x32_bf16 v[220:223], a[12:15], a[196:199], v[220:223]
    ds_read_b64_tr_b16 a[52:53], v47 offset:8192
    v_mfma_f32_16x16x32_bf16 a[88:91], a[12:15], a[200:203], a[88:91]
    ds_read_b64_tr_b16 a[54:55], v47 offset:9216
    v_mfma_f32_16x16x32_bf16 a[92:95], a[12:15], a[204:207], a[92:95]
    ds_read_b64_tr_b16 a[56:57], v48 offset:8192
    v_mfma_f32_16x16x32_bf16 v[224:227], a[16:19], a[192:195], v[224:227]
    v_mfma_f32_16x16x32_bf16 v[228:231], a[16:19], a[196:199], v[228:231]
    buffer_load_dwordx4 a[252:255], v37, s[8:11], s62 offen offset:1024 sc1
    ds_read_b64_tr_b16 a[58:59], v48 offset:9216
    v_mfma_f32_16x16x32_bf16 a[96:99], a[16:19], a[200:203], a[96:99]
    ds_read_b64_tr_b16 a[60:61], v49 offset:8192
    v_mfma_f32_16x16x32_bf16 a[100:103], a[16:19], a[204:207], a[100:103]
    v_mfma_f32_16x16x32_bf16 v[232:235], a[20:23], a[192:195], v[232:235]
    ds_read_b64_tr_b16 a[62:63], v49 offset:9216
    v_mfma_f32_16x16x32_bf16 v[236:239], a[20:23], a[196:199], v[236:239]
    s_add_u32 s62, s62, 0x20000
    v_mfma_f32_16x16x32_bf16 a[104:107], a[20:23], a[200:203], a[104:107]
    s_add_u32 s52, s47, 532480
    v_mfma_f32_16x16x32_bf16 a[108:111], a[20:23], a[204:207], a[108:111]
    buffer_store_dwordx4 v[172:175], v1, s[48:51], s52 offen offset:3072 sc1
    v_mfma_f32_16x16x32_bf16 v[240:243], a[24:27], a[192:195], v[240:243]
    v_mfma_f32_16x16x32_bf16 v[244:247], a[24:27], a[196:199], v[244:247]
    v_mfma_f32_16x16x32_bf16 a[112:115], a[24:27], a[200:203], a[112:115]
    v_mfma_f32_16x16x32_bf16 a[116:119], a[24:27], a[204:207], a[116:119]
    v_mfma_f32_16x16x32_bf16 v[248:251], a[28:31], a[192:195], v[248:251]
    v_add_co_u32 v2, vcc, 0x4000, v2
    s_nop 1
    v_addc_co_u32 v3, vcc, 0, v3, vcc
    global_load_dword v51, v[2:3], off
    v_mfma_f32_16x16x32_bf16 v[252:255], a[28:31], a[196:199], v[252:255]
    v_mfma_f32_16x16x32_bf16 a[120:123], a[28:31], a[200:203], a[120:123]
    v_mfma_f32_16x16x32_bf16 a[124:127], a[28:31], a[204:207], a[124:127]
    s_waitcnt vmcnt(10) lgkmcnt(0)
    s_barrier
    v_mfma_f32_16x16x32_bf16 v[192:195], a[32:35], a[208:211], v[192:195]
    ds_read_b64_tr_b16 a[0:1], v42 offset:16384
    ds_read_b64_tr_b16 a[2:3], v42 offset:17408
    v_mfma_f32_16x16x32_bf16 v[196:199], a[32:35], a[212:215], v[196:199]
    s_add_u32 m0, s60, 131072
    v_mfma_f32_16x16x32_bf16 a[64:67], a[32:35], a[216:219], a[64:67]
    buffer_load_dwordx4 v38, s[12:15], s61 offen offset:0 lds
    ds_read_b64_tr_b16 a[4:5], v43 offset:16384
    v_mfma_f32_16x16x32_bf16 a[68:71], a[32:35], a[220:223], a[68:71]
    ds_read_b64_tr_b16 a[6:7], v43 offset:17408
    v_mfma_f32_16x16x32_bf16 v[200:203], a[36:39], a[208:211], v[200:203]
    buffer_load_dwordx4 v39, s[12:15], s61 offen offset:1024 lds
    ds_read_b64_tr_b16 a[8:9], v44 offset:16384
    v_mfma_f32_16x16x32_bf16 v[204:207], a[36:39], a[212:215], v[204:207]
    v_mfma_f32_16x16x32_bf16 a[72:75], a[36:39], a[216:219], a[72:75]
    ds_read_b64_tr_b16 a[10:11], v44 offset:17408
    v_mfma_f32_16x16x32_bf16 a[76:79], a[36:39], a[220:223], a[76:79]
    buffer_load_dwordx4 v40, s[12:15], s61 offen offset:2048 lds
    ds_read_b64_tr_b16 a[12:13], v45 offset:16384
    v_mfma_f32_16x16x32_bf16 v[208:211], a[40:43], a[208:211], v[208:211]
    v_mfma_f32_16x16x32_bf16 v[212:215], a[40:43], a[212:215], v[212:215]
    ds_read_b64_tr_b16 a[14:15], v45 offset:17408
    v_mfma_f32_16x16x32_bf16 a[80:83], a[40:43], a[216:219], a[80:83]
    buffer_load_dwordx4 v41, s[12:15], s61 offen offset:3072 lds
    ds_read_b64_tr_b16 a[16:17], v46 offset:16384
    v_mfma_f32_16x16x32_bf16 a[84:87], a[40:43], a[220:223], a[84:87]
    ds_read_b64_tr_b16 a[18:19], v46 offset:17408
    v_mfma_f32_16x16x32_bf16 v[216:219], a[44:47], a[208:211], v[216:219]
    s_add_u32 s61, s61, 0x80000
    v_mfma_f32_16x16x32_bf16 v[220:223], a[44:47], a[212:215], v[220:223]
    buffer_load_dwordx4 a[128:131], v36, s[8:11], s62 offen offset:0 sc1
    ds_read_b64_tr_b16 a[20:21], v47 offset:16384
    v_mfma_f32_16x16x32_bf16 a[88:91], a[44:47], a[216:219], a[88:91]
    ds_read_b64_tr_b16 a[22:23], v47 offset:17408
    v_mfma_f32_16x16x32_bf16 a[92:95], a[44:47], a[220:223], a[92:95]
    buffer_load_dwordx4 a[132:135], v36, s[8:11], s62 offen offset:1024 sc1
    ds_read_b64_tr_b16 a[24:25], v48 offset:16384
    v_mfma_f32_16x16x32_bf16 v[224:227], a[48:51], a[208:211], v[224:227]
    v_mfma_f32_16x16x32_bf16 v[228:231], a[48:51], a[212:215], v[228:231]
    ds_read_b64_tr_b16 a[26:27], v48 offset:17408
    v_mfma_f32_16x16x32_bf16 a[96:99], a[48:51], a[216:219], a[96:99]
    buffer_load_dwordx4 a[136:139], v37, s[8:11], s62 offen offset:0 sc1
    ds_read_b64_tr_b16 a[28:29], v49 offset:16384
    v_mfma_f32_16x16x32_bf16 a[100:103], a[48:51], a[220:223], a[100:103]
    v_mfma_f32_16x16x32_bf16 v[232:235], a[52:55], a[208:211], v[232:235]
    ds_read_b64_tr_b16 a[30:31], v49 offset:17408
    v_mfma_f32_16x16x32_bf16 v[236:239], a[52:55], a[212:215], v[236:239]
    buffer_load_dwordx4 a[140:143], v37, s[8:11], s62 offen offset:1024 sc1
    v_mfma_f32_16x16x32_bf16 a[104:107], a[52:55], a[216:219], a[104:107]
    v_mfma_f32_16x16x32_bf16 a[108:111], a[52:55], a[220:223], a[108:111]
    s_add_u32 s62, s62, 0x20000
    v_mfma_f32_16x16x32_bf16 v[240:243], a[56:59], a[208:211], v[240:243]
    s_add_u32 s52, s47, 536576
    v_mfma_f32_16x16x32_bf16 v[244:247], a[56:59], a[212:215], v[244:247]
    buffer_store_dwordx4 v[176:179], v1, s[48:51], s52 offen offset:0 sc1
    v_mfma_f32_16x16x32_bf16 a[112:115], a[56:59], a[216:219], a[112:115]
    v_mfma_f32_16x16x32_bf16 a[116:119], a[56:59], a[220:223], a[116:119]
    v_mfma_f32_16x16x32_bf16 v[248:251], a[60:63], a[208:211], v[248:251]
    v_mfma_f32_16x16x32_bf16 v[252:255], a[60:63], a[212:215], v[252:255]
    v_mfma_f32_16x16x32_bf16 a[120:123], a[60:63], a[216:219], a[120:123]
    v_mfma_f32_16x16x32_bf16 a[124:127], a[60:63], a[220:223], a[124:127]
    s_waitcnt vmcnt(15) lgkmcnt(0)
    v_mfma_f32_16x16x32_bf16 v[192:195], a[0:3], a[224:227], v[192:195]
    ds_read_b64_tr_b16 a[32:33], v42 offset:24576
    ds_read_b64_tr_b16 a[34:35], v42 offset:25600
    v_mfma_f32_16x16x32_bf16 v[196:199], a[0:3], a[228:231], v[196:199]
    buffer_load_dwordx4 a[144:147], v36, s[8:11], s62 offen offset:0 sc1
    v_mfma_f32_16x16x32_bf16 a[64:67], a[0:3], a[232:235], a[64:67]
    ds_read_b64_tr_b16 a[36:37], v43 offset:24576
    v_mfma_f32_16x16x32_bf16 a[68:71], a[0:3], a[236:239], a[68:71]
    ds_read_b64_tr_b16 a[38:39], v43 offset:25600
    v_mfma_f32_16x16x32_bf16 v[200:203], a[4:7], a[224:227], v[200:203]
    ds_read_b64_tr_b16 a[40:41], v44 offset:24576
    v_mfma_f32_16x16x32_bf16 v[204:207], a[4:7], a[228:231], v[204:207]
    v_mfma_f32_16x16x32_bf16 a[72:75], a[4:7], a[232:235], a[72:75]
    buffer_load_dwordx4 a[148:151], v36, s[8:11], s62 offen offset:1024 sc1
    ds_read_b64_tr_b16 a[42:43], v44 offset:25600
    v_mfma_f32_16x16x32_bf16 a[76:79], a[4:7], a[236:239], a[76:79]
    ds_read_b64_tr_b16 a[44:45], v45 offset:24576
    v_mfma_f32_16x16x32_bf16 v[208:211], a[8:11], a[224:227], v[208:211]
    v_mfma_f32_16x16x32_bf16 v[212:215], a[8:11], a[228:231], v[212:215]
    ds_read_b64_tr_b16 a[46:47], v45 offset:25600
    v_mfma_f32_16x16x32_bf16 a[80:83], a[8:11], a[232:235], a[80:83]
    ds_read_b64_tr_b16 a[48:49], v46 offset:24576
    v_mfma_f32_16x16x32_bf16 a[84:87], a[8:11], a[236:239], a[84:87]
    buffer_load_dwordx4 a[152:155], v37, s[8:11], s62 offen offset:0 sc1
    ds_read_b64_tr_b16 a[50:51], v46 offset:25600
    v_mfma_f32_16x16x32_bf16 v[216:219], a[12:15], a[224:227], v[216:219]
    v_mfma_f32_16x16x32_bf16 v[220:223], a[12:15], a[228:231], v[220:223]
    ds_read_b64_tr_b16 a[52:53], v47 offset:24576
    v_mfma_f32_16x16x32_bf16 a[88:91], a[12:15], a[232:235], a[88:91]
    ds_read_b64_tr_b16 a[54:55], v47 offset:25600
    v_mfma_f32_16x16x32_bf16 a[92:95], a[12:15], a[236:239], a[92:95]
    ds_read_b64_tr_b16 a[56:57], v48 offset:24576
    v_mfma_f32_16x16x32_bf16 v[224:227], a[16:19], a[224:227], v[224:227]
    v_mfma_f32_16x16x32_bf16 v[228:231], a[16:19], a[228:231], v[228:231]
    buffer_load_dwordx4 a[156:159], v37, s[8:11], s62 offen offset:1024 sc1
    ds_read_b64_tr_b16 a[58:59], v48 offset:25600
    v_mfma_f32_16x16x32_bf16 a[96:99], a[16:19], a[232:235], a[96:99]
    ds_read_b64_tr_b16 a[60:61], v49 offset:24576
    v_mfma_f32_16x16x32_bf16 a[100:103], a[16:19], a[236:239], a[100:103]
    v_mfma_f32_16x16x32_bf16 v[232:235], a[20:23], a[224:227], v[232:235]
    ds_read_b64_tr_b16 a[62:63], v49 offset:25600
    v_mfma_f32_16x16x32_bf16 v[236:239], a[20:23], a[228:231], v[236:239]
    s_add_u32 s62, s62, 0x20000
    v_mfma_f32_16x16x32_bf16 a[104:107], a[20:23], a[232:235], a[104:107]
    s_add_u32 s52, s47, 536576
    v_mfma_f32_16x16x32_bf16 a[108:111], a[20:23], a[236:239], a[108:111]
    buffer_store_dwordx4 v[180:183], v1, s[48:51], s52 offen offset:1024 sc1
    v_mfma_f32_16x16x32_bf16 v[240:243], a[24:27], a[224:227], v[240:243]
    v_mfma_f32_16x16x32_bf16 v[244:247], a[24:27], a[228:231], v[244:247]
    v_mfma_f32_16x16x32_bf16 a[112:115], a[24:27], a[232:235], a[112:115]
    v_mfma_f32_16x16x32_bf16 a[116:119], a[24:27], a[236:239], a[116:119]
    v_mfma_f32_16x16x32_bf16 v[248:251], a[28:31], a[224:227], v[248:251]
    v_mfma_f32_16x16x32_bf16 v[252:255], a[28:31], a[228:231], v[252:255]
    v_mfma_f32_16x16x32_bf16 a[120:123], a[28:31], a[232:235], a[120:123]
    v_mfma_f32_16x16x32_bf16 a[124:127], a[28:31], a[236:239], a[124:127]
    s_waitcnt vmcnt(10) lgkmcnt(0)
    s_barrier
    v_mfma_f32_16x16x32_bf16 v[192:195], a[32:35], a[240:243], v[192:195]
    ds_read_b64_tr_b16 a[0:1], v42 offset:32768
    ds_read_b64_tr_b16 a[2:3], v42 offset:33792
    v_mfma_f32_16x16x32_bf16 v[196:199], a[32:35], a[244:247], v[196:199]
    s_cmp_eq_u32 s30, 0
    s_cbranch_scc1 k12_ool_62
k12_oolret_63:
    v_mfma_f32_16x16x32_bf16 a[64:67], a[32:35], a[248:251], a[64:67]
    s_add_u32 m0, s60, 147456
    ds_read_b64_tr_b16 a[4:5], v43 offset:32768
    v_mfma_f32_16x16x32_bf16 a[68:71], a[32:35], a[252:255], a[68:71]
    buffer_load_dwordx4 v38, s[12:15], s61 offen offset:0 lds
    ds_read_b64_tr_b16 a[6:7], v43 offset:33792
    v_mfma_f32_16x16x32_bf16 v[200:203], a[36:39], a[240:243], v[200:203]
    buffer_load_dwordx4 v39, s[12:15], s61 offen offset:1024 lds
    ds_read_b64_tr_b16 a[8:9], v44 offset:32768
    v_mfma_f32_16x16x32_bf16 v[204:207], a[36:39], a[244:247], v[204:207]
    v_mfma_f32_16x16x32_bf16 a[72:75], a[36:39], a[248:251], a[72:75]
    ds_read_b64_tr_b16 a[10:11], v44 offset:33792
    v_mfma_f32_16x16x32_bf16 a[76:79], a[36:39], a[252:255], a[76:79]
    buffer_load_dwordx4 v40, s[12:15], s61 offen offset:2048 lds
    ds_read_b64_tr_b16 a[12:13], v45 offset:32768
    v_mfma_f32_16x16x32_bf16 v[208:211], a[40:43], a[240:243], v[208:211]
    v_mfma_f32_16x16x32_bf16 v[212:215], a[40:43], a[244:247], v[212:215]
    ds_read_b64_tr_b16 a[14:15], v45 offset:33792
    v_mfma_f32_16x16x32_bf16 a[80:83], a[40:43], a[248:251], a[80:83]
    buffer_load_dwordx4 v41, s[12:15], s61 offen offset:3072 lds
    ds_read_b64_tr_b16 a[16:17], v46 offset:32768
    v_mfma_f32_16x16x32_bf16 a[84:87], a[40:43], a[252:255], a[84:87]
    ds_read_b64_tr_b16 a[18:19], v46 offset:33792
    v_mfma_f32_16x16x32_bf16 v[216:219], a[44:47], a[240:243], v[216:219]
    s_add_u32 s61, s61, 0x80000
    v_mfma_f32_16x16x32_bf16 v[220:223], a[44:47], a[244:247], v[220:223]
    buffer_load_dwordx4 a[160:163], v36, s[8:11], s62 offen offset:0 sc1
    ds_read_b64_tr_b16 a[20:21], v47 offset:32768
    v_mfma_f32_16x16x32_bf16 a[88:91], a[44:47], a[248:251], a[88:91]
    ds_read_b64_tr_b16 a[22:23], v47 offset:33792
    v_mfma_f32_16x16x32_bf16 a[92:95], a[44:47], a[252:255], a[92:95]
    buffer_load_dwordx4 a[164:167], v36, s[8:11], s62 offen offset:1024 sc1
    ds_read_b64_tr_b16 a[24:25], v48 offset:32768
    v_mfma_f32_16x16x32_bf16 v[224:227], a[48:51], a[240:243], v[224:227]
    v_mfma_f32_16x16x32_bf16 v[228:231], a[48:51], a[244:247], v[228:231]
    ds_read_b64_tr_b16 a[26:27], v48 offset:33792
    v_mfma_f32_16x16x32_bf16 a[96:99], a[48:51], a[248:251], a[96:99]
    buffer_load_dwordx4 a[168:171], v37, s[8:11], s62 offen offset:0 sc1
    ds_read_b64_tr_b16 a[28:29], v49 offset:32768
    v_mfma_f32_16x16x32_bf16 a[100:103], a[48:51], a[252:255], a[100:103]
    v_mfma_f32_16x16x32_bf16 v[232:235], a[52:55], a[240:243], v[232:235]
    ds_read_b64_tr_b16 a[30:31], v49 offset:33792
    v_mfma_f32_16x16x32_bf16 v[236:239], a[52:55], a[244:247], v[236:239]
    buffer_load_dwordx4 a[172:175], v37, s[8:11], s62 offen offset:1024 sc1
    v_mfma_f32_16x16x32_bf16 a[104:107], a[52:55], a[248:251], a[104:107]
    v_mfma_f32_16x16x32_bf16 a[108:111], a[52:55], a[252:255], a[108:111]
    s_add_u32 s62, s62, 0x20000
    v_mfma_f32_16x16x32_bf16 v[240:243], a[56:59], a[240:243], v[240:243]
    s_add_u32 s52, s47, 536576
    v_mfma_f32_16x16x32_bf16 v[244:247], a[56:59], a[244:247], v[244:247]
    buffer_store_dwordx4 v[184:187], v1, s[48:51], s52 offen offset:2048 sc1
    v_mfma_f32_16x16x32_bf16 a[112:115], a[56:59], a[248:251], a[112:115]
    v_mfma_f32_16x16x32_bf16 a[116:119], a[56:59], a[252:255], a[116:119]
    v_mfma_f32_16x16x32_bf16 v[248:251], a[60:63], a[240:243], v[248:251]
    v_mfma_f32_16x16x32_bf16 v[252:255], a[60:63], a[244:247], v[252:255]
    v_mfma_f32_16x16x32_bf16 a[120:123], a[60:63], a[248:251], a[120:123]
    v_mfma_f32_16x16x32_bf16 a[124:127], a[60:63], a[252:255], a[124:127]
    s_waitcnt vmcnt(15) lgkmcnt(0)
    v_mfma_f32_16x16x32_bf16 v[192:195], a[0:3], a[128:131], v[192:195]
    ds_read_b64_tr_b16 a[32:33], v42 offset:40960
    ds_read_b64_tr_b16 a[34:35], v42 offset:41984
    v_mfma_f32_16x16x32_bf16 v[196:199], a[0:3], a[132:135], v[196:199]
    buffer_load_dwordx4 a[176:179], v36, s[8:11], s62 offen offset:0 sc1
    v_mfma_f32_16x16x32_bf16 a[64:67], a[0:3], a[136:139], a[64:67]
    ds_read_b64_tr_b16 a[36:37], v43 offset:40960
    v_mfma_f32_16x16x32_bf16 a[68:71], a[0:3], a[140:143], a[68:71]
    ds_read_b64_tr_b16 a[38:39], v43 offset:41984
    v_mfma_f32_16x16x32_bf16 v[200:203], a[4:7], a[128:131], v[200:203]
    ds_read_b64_tr_b16 a[40:41], v44 offset:40960
    v_mfma_f32_16x16x32_bf16 v[204:207], a[4:7], a[132:135], v[204:207]
    v_mfma_f32_16x16x32_bf16 a[72:75], a[4:7], a[136:139], a[72:75]
    buffer_load_dwordx4 a[180:183], v36, s[8:11], s62 offen offset:1024 sc1
    ds_read_b64_tr_b16 a[42:43], v44 offset:41984
    v_mfma_f32_16x16x32_bf16 a[76:79], a[4:7], a[140:143], a[76:79]
    ds_read_b64_tr_b16 a[44:45], v45 offset:40960
    v_mfma_f32_16x16x32_bf16 v[208:211], a[8:11], a[128:131], v[208:211]
    v_mfma_f32_16x16x32_bf16 v[212:215], a[8:11], a[132:135], v[212:215]
    ds_read_b64_tr_b16 a[46:47], v45 offset:41984
    v_mfma_f32_16x16x32_bf16 a[80:83], a[8:11], a[136:139], a[80:83]
    ds_read_b64_tr_b16 a[48:49], v46 offset:40960
    v_mfma_f32_16x16x32_bf16 a[84:87], a[8:11], a[140:143], a[84:87]
    buffer_load_dwordx4 a[184:187], v37, s[8:11], s62 offen offset:0 sc1
    ds_read_b64_tr_b16 a[50:51], v46 offset:41984
    v_mfma_f32_16x16x32_bf16 v[216:219], a[12:15], a[128:131], v[216:219]
    v_mfma_f32_16x16x32_bf16 v[220:223], a[12:15], a[132:135], v[220:223]
    ds_read_b64_tr_b16 a[52:53], v47 offset:40960
    v_mfma_f32_16x16x32_bf16 a[88:91], a[12:15], a[136:139], a[88:91]
    ds_read_b64_tr_b16 a[54:55], v47 offset:41984
    v_mfma_f32_16x16x32_bf16 a[92:95], a[12:15], a[140:143], a[92:95]
    ds_read_b64_tr_b16 a[56:57], v48 offset:40960
    v_mfma_f32_16x16x32_bf16 v[224:227], a[16:19], a[128:131], v[224:227]
    v_mfma_f32_16x16x32_bf16 v[228:231], a[16:19], a[132:135], v[228:231]
    buffer_load_dwordx4 a[188:191], v37, s[8:11], s62 offen offset:1024 sc1
    ds_read_b64_tr_b16 a[58:59], v48 offset:41984
    v_mfma_f32_16x16x32_bf16 a[96:99], a[16:19], a[136:139], a[96:99]
    ds_read_b64_tr_b16 a[60:61], v49 offset:40960
    v_mfma_f32_16x16x32_bf16 a[100:103], a[16:19], a[140:143], a[100:103]
    v_mfma_f32_16x16x32_bf16 v[232:235], a[20:23], a[128:131], v[232:235]
    ds_read_b64_tr_b16 a[62:63], v49 offset:41984
    v_mfma_f32_16x16x32_bf16 v[236:239], a[20:23], a[132:135], v[236:239]
    s_add_u32 s62, s62, 0x20000
    v_mfma_f32_16x16x32_bf16 a[104:107], a[20:23], a[136:139], a[104:107]
    s_add_u32 s52, s47, 536576
    v_mfma_f32_16x16x32_bf16 a[108:111], a[20:23], a[140:143], a[108:111]
    buffer_store_dwordx4 v[188:191], v1, s[48:51], s52 offen offset:3072 sc1
    v_mfma_f32_16x16x32_bf16 v[240:243], a[24:27], a[128:131], v[240:243]
    v_mfma_f32_16x16x32_bf16 v[244:247], a[24:27], a[132:135], v[244:247]
    v_mfma_f32_16x16x32_bf16 a[112:115], a[24:27], a[136:139], a[112:115]
    v_mfma_f32_16x16x32_bf16 a[116:119], a[24:27], a[140:143], a[116:119]
    v_mfma_f32_16x16x32_bf16 v[248:251], a[28:31], a[128:131], v[248:251]
    s_cmp_eq_u32 s30, 0
    s_cbranch_scc1 k12_ool_66
k12_oolret_67:
    v_mfma_f32_16x16x32_bf16 v[252:255], a[28:31], a[132:135], v[252:255]
    v_mfma_f32_16x16x32_bf16 a[120:123], a[28:31], a[136:139], a[120:123]
    v_mfma_f32_16x16x32_bf16 a[124:127], a[28:31], a[140:143], a[124:127]
    s_waitcnt vmcnt(10) lgkmcnt(0)
    s_barrier
    v_mfma_f32_16x16x32_bf16 v[192:195], a[32:35], a[144:147], v[192:195]
    ds_read_b64_tr_b16 a[0:1], v42 offset:49152
    ds_read_b64_tr_b16 a[2:3], v42 offset:50176
    v_mfma_f32_16x16x32_bf16 v[196:199], a[32:35], a[148:151], v[196:199]
    s_mov_b32 m0, s34
    v_mfma_f32_16x16x32_bf16 a[64:67], a[32:35], a[152:155], a[64:67]
    buffer_load_dwordx4 v1, s[16:19], s32 offen offset:0 sc1 lds
    ds_read_b64_tr_b16 a[4:5], v43 offset:49152
    v_mfma_f32_16x16x32_bf16 a[68:71], a[32:35], a[156:159], a[68:71]
    ds_read_b64_tr_b16 a[6:7], v43 offset:50176
    v_mfma_f32_16x16x32_bf16 v[200:203], a[36:39], a[144:147], v[200:203]
    buffer_load_dwordx4 v1, s[16:19], s32 offen offset:1024 sc1 lds
    ds_read_b64_tr_b16 a[8:9], v44 offset:49152
    v_mfma_f32_16x16x32_bf16 v[204:207], a[36:39], a[148:151], v[204:207]
    v_mfma_f32_16x16x32_bf16 a[72:75], a[36:39], a[152:155], a[72:75]
    ds_read_b64_tr_b16 a[10:11], v44 offset:50176
    v_mfma_f32_16x16x32_bf16 a[76:79], a[36:39], a[156:159], a[76:79]
    buffer_load_dwordx4 v1, s[16:19], s32 offen offset:2048 sc1 lds
    ds_read_b64_tr_b16 a[12:13], v45 offset:49152
    v_mfma_f32_16x16x32_bf16 v[208:211], a[40:43], a[144:147], v[208:211]
    v_mfma_f32_16x16x32_bf16 v[212:215], a[40:43], a[148:151], v[212:215]
    ds_read_b64_tr_b16 a[14:15], v45 offset:50176
    v_mfma_f32_16x16x32_bf16 a[80:83], a[40:43], a[152:155], a[80:83]
    ds_read_b64_tr_b16 a[16:17], v46 offset:49152
    v_mfma_f32_16x16x32_bf16 a[84:87], a[40:43], a[156:159], a[84:87]
    buffer_load_dwordx4 v1, s[16:19], s32 offen offset:3072 sc1 lds
    ds_read_b64_tr_b16 a[18:19], v46 offset:50176
    v_mfma_f32_16x16x32_bf16 v[216:219], a[44:47], a[144:147], v[216:219]
    v_mfma_f32_16x16x32_bf16 v[220:223], a[44:47], a[148:151], v[220:223]
    s_add_u32 s32, s32, 0x80000
    ds_read_b64_tr_b16 a[20:21], v47 offset:49152
    v_mfma_f32_16x16x32_bf16 a[88:91], a[44:47], a[152:155], a[88:91]
    s_add_u32 s34, s34, 0x4000
    ds_read_b64_tr_b16 a[22:23], v47 offset:50176
    s_mov_b32 m0, s34
    v_mfma_f32_16x16x32_bf16 a[92:95], a[44:47], a[156:159], a[92:95]
    buffer_load_dwordx4 v1, s[16:19], s32 offen offset:0 sc1 lds
    ds_read_b64_tr_b16 a[24:25], v48 offset:49152
    v_mfma_f32_16x16x32_bf16 v[224:227], a[48:51], a[144:147], v[224:227]
    v_mfma_f32_16x16x32_bf16 v[228:231], a[48:51], a[148:151], v[228:231]
    buffer_load_dwordx4 v1, s[16:19], s32 offen offset:1024 sc1 lds
    ds_read_b64_tr_b16 a[26:27], v48 offset:50176
    v_mfma_f32_16x16x32_bf16 a[96:99], a[48:51], a[152:155], a[96:99]
    ds_read_b64_tr_b16 a[28:29], v49 offset:49152
    v_mfma_f32_16x16x32_bf16 a[100:103], a[48:51], a[156:159], a[100:103]
    v_mfma_f32_16x16x32_bf16 v[232:235], a[52:55], a[144:147], v[232:235]
    buffer_load_dwordx4 v1, s[16:19], s32 offen offset:2048 sc1 lds
    ds_read_b64_tr_b16 a[30:31], v49 offset:50176
    v_mfma_f32_16x16x32_bf16 v[236:239], a[52:55], a[148:151], v[236:239]
    v_mfma_f32_16x16x32_bf16 a[104:107], a[52:55], a[152:155], a[104:107]
    v_mfma_f32_16x16x32_bf16 a[108:111], a[52:55], a[156:159], a[108:111]
    v_mfma_f32_16x16x32_bf16 v[240:243], a[56:59], a[144:147], v[240:243]
    buffer_load_dwordx4 v1, s[16:19], s32 offen offset:3072 sc1 lds
    v_mfma_f32_16x16x32_bf16 v[244:247], a[56:59], a[148:151], v[244:247]
    v_mfma_f32_16x16x32_bf16 a[112:115], a[56:59], a[152:155], a[112:115]
    s_add_u32 s32, s32, 0x80000
    v_mfma_f32_16x16x32_bf16 a[116:119], a[56:59], a[156:159], a[116:119]
    s_add_u32 s34, s34, 0x4000
    v_mfma_f32_16x16x32_bf16 v[248:251], a[60:63], a[144:147], v[248:251]
    v_mfma_f32_16x16x32_bf16 v[252:255], a[60:63], a[148:151], v[252:255]
    v_mfma_f32_16x16x32_bf16 a[120:123], a[60:63], a[152:155], a[120:123]
    v_mfma_f32_16x16x32_bf16 a[124:127], a[60:63], a[156:159], a[124:127]
    s_waitcnt vmcnt(14) lgkmcnt(0)
    v_mfma_f32_16x16x32_bf16 v[192:195], a[0:3], a[160:163], v[192:195]
    ds_read_b64_tr_b16 a[32:33], v42 offset:57344
    ds_read_b64_tr_b16 a[34:35], v42 offset:58368
    v_mfma_f32_16x16x32_bf16 v[196:199], a[0:3], a[164:167], v[196:199]
    s_mov_b32 m0, s35
    v_mfma_f32_16x16x32_bf16 a[64:67], a[0:3], a[168:171], a[64:67]
    buffer_load_dwordx4 v1, s[20:23], s33 offen offset:0 sc1 lds
    ds_read_b64_tr_b16 a[36:37], v43 offset:57344
    v_mfma_f32_16x16x32_bf16 a[68:71], a[0:3], a[172:175], a[68:71]
    ds_read_b64_tr_b16 a[38:39], v43 offset:58368
    v_mfma_f32_16x16x32_bf16 v[200:203], a[4:7], a[160:163], v[200:203]
    buffer_load_dwordx4 v1, s[20:23], s33 offen offset:1024 sc1 lds
    ds_read_b64_tr_b16 a[40:41], v44 offset:57344
    v_mfma_f32_16x16x32_bf16 v[204:207], a[4:7], a[164:167], v[204:207]
    v_mfma_f32_16x16x32_bf16 a[72:75], a[4:7], a[168:171], a[72:75]
    ds_read_b64_tr_b16 a[42:43], v44 offset:58368
    v_mfma_f32_16x16x32_bf16 a[76:79], a[4:7], a[172:175], a[76:79]
    buffer_load_dwordx4 v1, s[20:23], s33 offen offset:2048 sc1 lds
    ds_read_b64_tr_b16 a[44:45], v45 offset:57344
    v_mfma_f32_16x16x32_bf16 v[208:211], a[8:11], a[160:163], v[208:211]
    v_mfma_f32_16x16x32_bf16 v[212:215], a[8:11], a[164:167], v[212:215]
    ds_read_b64_tr_b16 a[46:47], v45 offset:58368
    v_mfma_f32_16x16x32_bf16 a[80:83], a[8:11], a[168:171], a[80:83]
    ds_read_b64_tr_b16 a[48:49], v46 offset:57344
    v_mfma_f32_16x16x32_bf16 a[84:87], a[8:11], a[172:175], a[84:87]
    buffer_load_dwordx4 v1, s[20:23], s33 offen offset:3072 sc1 lds
    ds_read_b64_tr_b16 a[50:51], v46 offset:58368
    v_mfma_f32_16x16x32_bf16 v[216:219], a[12:15], a[160:163], v[216:219]
    v_mfma_f32_16x16x32_bf16 v[220:223], a[12:15], a[164:167], v[220:223]
    s_add_u32 s33, s33, 0x80000
    ds_read_b64_tr_b16 a[52:53], v47 offset:57344
    v_mfma_f32_16x16x32_bf16 a[88:91], a[12:15], a[168:171], a[88:91]
    s_add_u32 s35, s35, 0x4000
    ds_read_b64_tr_b16 a[54:55], v47 offset:58368
    s_mov_b32 m0, s34
    v_mfma_f32_16x16x32_bf16 a[92:95], a[12:15], a[172:175], a[92:95]
    buffer_load_dwordx4 v1, s[16:19], s32 offen offset:0 sc1 lds
    ds_read_b64_tr_b16 a[56:57], v48 offset:57344
    v_mfma_f32_16x16x32_bf16 v[224:227], a[16:19], a[160:163], v[224:227]
    v_mfma_f32_16x16x32_bf16 v[228:231], a[16:19], a[164:167], v[228:231]
    buffer_load_dwordx4 v1, s[16:19], s32 offen offset:1024 sc1 lds
    ds_read_b64_tr_b16 a[58:59], v48 offset:58368
    v_mfma_f32_16x16x32_bf16 a[96:99], a[16:19], a[168:171], a[96:99]
    ds_read_b64_tr_b16 a[60:61], v49 offset:57344
    v_mfma_f32_16x16x32_bf16 a[100:103], a[16:19], a[172:175], a[100:103]
    v_mfma_f32_16x16x32_bf16 v[232:235], a[20:23], a[160:163], v[232:235]
    buffer_load_dwordx4 v1, s[16:19], s32 offen offset:2048 sc1 lds
    ds_read_b64_tr_b16 a[62:63], v49 offset:58368
    v_mfma_f32_16x16x32_bf16 v[236:239], a[20:23], a[164:167], v[236:239]
    v_mfma_f32_16x16x32_bf16 a[104:107], a[20:23], a[168:171], a[104:107]
    v_mfma_f32_16x16x32_bf16 a[108:111], a[20:23], a[172:175], a[108:111]
    v_mfma_f32_16x16x32_bf16 v[240:243], a[24:27], a[160:163], v[240:243]
    buffer_load_dwordx4 v1, s[16:19], s32 offen offset:3072 sc1 lds
    v_mfma_f32_16x16x32_bf16 v[244:247], a[24:27], a[164:167], v[244:247]
    v_mfma_f32_16x16x32_bf16 a[112:115], a[24:27], a[168:171], a[112:115]
    s_add_u32 s32, s32, 0x80000
    v_mfma_f32_16x16x32_bf16 a[116:119], a[24:27], a[172:175], a[116:119]
    s_add_u32 s34, s34, 0x4000
    v_mfma_f32_16x16x32_bf16 v[248:251], a[28:31], a[160:163], v[248:251]
    v_mfma_f32_16x16x32_bf16 v[252:255], a[28:31], a[164:167], v[252:255]
    v_mfma_f32_16x16x32_bf16 a[120:123], a[28:31], a[168:171], a[120:123]
    v_mfma_f32_16x16x32_bf16 a[124:127], a[28:31], a[172:175], a[124:127]
    s_waitcnt vmcnt(17) lgkmcnt(0)
    s_barrier
    v_mfma_f32_16x16x32_bf16 v[192:195], a[32:35], a[176:179], v[192:195]
    v_mfma_f32_16x16x32_bf16 v[196:199], a[32:35], a[180:183], v[196:199]
    s_mov_b32 m0, s35
    v_mfma_f32_16x16x32_bf16 a[64:67], a[32:35], a[184:187], a[64:67]
    buffer_load_dwordx4 v1, s[20:23], s33 offen offset:0 sc1 lds
    v_mfma_f32_16x16x32_bf16 a[68:71], a[32:35], a[188:191], a[68:71]
    v_mfma_f32_16x16x32_bf16 v[200:203], a[36:39], a[176:179], v[200:203]
    v_mfma_f32_16x16x32_bf16 v[204:207], a[36:39], a[180:183], v[204:207]
    v_mfma_f32_16x16x32_bf16 a[72:75], a[36:39], a[184:187], a[72:75]
    v_mfma_f32_16x16x32_bf16 a[76:79], a[36:39], a[188:191], a[76:79]
    buffer_load_dwordx4 v1, s[20:23], s33 offen offset:1024 sc1 lds
    v_mfma_f32_16x16x32_bf16 v[208:211], a[40:43], a[176:179], v[208:211]
    v_mfma_f32_16x16x32_bf16 v[212:215], a[40:43], a[180:183], v[212:215]
    v_mfma_f32_16x16x32_bf16 a[80:83], a[40:43], a[184:187], a[80:83]
    v_mfma_f32_16x16x32_bf16 a[84:87], a[40:43], a[188:191], a[84:87]
    v_mfma_f32_16x16x32_bf16 v[216:219], a[44:47], a[176:179], v[216:219]
    v_mfma_f32_16x16x32_bf16 v[220:223], a[44:47], a[180:183], v[220:223]
    v_mfma_f32_16x16x32_bf16 a[88:91], a[44:47], a[184:187], a[88:91]
    buffer_load_dwordx4 v1, s[20:23], s33 offen offset:2048 sc1 lds
    v_mfma_f32_16x16x32_bf16 a[92:95], a[44:47], a[188:191], a[92:95]
    v_mfma_f32_16x16x32_bf16 v[224:227], a[48:51], a[176:179], v[224:227]
    v_mfma_f32_16x16x32_bf16 v[228:231], a[48:51], a[180:183], v[228:231]
    v_mfma_f32_16x16x32_bf16 a[96:99], a[48:51], a[184:187], a[96:99]
    v_mfma_f32_16x16x32_bf16 a[100:103], a[48:51], a[188:191], a[100:103]
    v_mfma_f32_16x16x32_bf16 v[232:235], a[52:55], a[176:179], v[232:235]
    buffer_load_dwordx4 v1, s[20:23], s33 offen offset:3072 sc1 lds
    v_mfma_f32_16x16x32_bf16 v[236:239], a[52:55], a[180:183], v[236:239]
    v_mfma_f32_16x16x32_bf16 a[104:107], a[52:55], a[184:187], a[104:107]
    v_mfma_f32_16x16x32_bf16 a[108:111], a[52:55], a[188:191], a[108:111]
    v_mfma_f32_16x16x32_bf16 v[240:243], a[56:59], a[176:179], v[240:243]
    v_mfma_f32_16x16x32_bf16 v[244:247], a[56:59], a[180:183], v[244:247]
    v_mfma_f32_16x16x32_bf16 a[112:115], a[56:59], a[184:187], a[112:115]
    s_add_u32 s33, s33, 0x80000
    v_mfma_f32_16x16x32_bf16 a[116:119], a[56:59], a[188:191], a[116:119]
    s_add_u32 s35, s35, 0x4000
    v_mfma_f32_16x16x32_bf16 v[248:251], a[60:63], a[176:179], v[248:251]
    v_mfma_f32_16x16x32_bf16 v[252:255], a[60:63], a[180:183], v[252:255]
    v_mfma_f32_16x16x32_bf16 a[120:123], a[60:63], a[184:187], a[120:123]
    v_mfma_f32_16x16x32_bf16 a[124:127], a[60:63], a[188:191], a[124:127]
    s_add_u32 s3, s54, 64
    s_add_u32 s5, s55, 64
    s_mov_b32 s63, s57
    s_load_dwordx2 s[44:45], s[0:1], 40
    s_load_dwordx2 s[46:47], s[0:1], 64
    s_load_dwordx4 s[48:51], s[0:1], 72
    s_mov_b32 s40, 0x3e0293ee
    s_mov_b32 s41, 0x3e0293ee
    s_mov_b32 m0, s34
    s_nop 0
    buffer_load_dwordx4 v1, s[16:19], s32 offen offset:0 sc1 lds
    buffer_load_dwordx4 v1, s[16:19], s32 offen offset:1024 sc1 lds
    buffer_load_dwordx4 v1, s[16:19], s32 offen offset:2048 sc1 lds
    buffer_load_dwordx4 v1, s[16:19], s32 offen offset:3072 sc1 lds
    s_mov_b32 m0, s35
    s_nop 0
    buffer_load_dwordx4 v1, s[20:23], s33 offen offset:0 sc1 lds
    buffer_load_dwordx4 v1, s[20:23], s33 offen offset:1024 sc1 lds
    buffer_load_dwordx4 v1, s[20:23], s33 offen offset:2048 sc1 lds
    buffer_load_dwordx4 v1, s[20:23], s33 offen offset:3072 sc1 lds
    s_add_u32 s32, s32, 0x80000
    s_add_u32 s33, s33, 0x80000
    s_add_u32 s34, s34, 0x4000
    s_and_b32 s34, s34, 0xffff
    s_add_u32 s35, s35, 0x4000
    s_and_b32 s35, s35, 0xffff
    s_or_b32 s35, s35, 0x10000
    v_mov_b32 v2, v1
    v_or_b32 v3, 0x10000, v1
    v_mov_b32 v56, v3
    s_mov_b32 s52, 0x4000
    s_mov_b32 s53, 0
    s_mul_i32 s62, s28, 63
    s_mul_i32 s31, s29, s29
    s_add_u32 s62, s62, s31
    s_sub_u32 s62, s62, 1
    s_cmp_eq_u32 s30, 0
    s_cselect_b32 s14, 0x800000, 0x0
    s_max_u32 s14, s14, 0x700000
    s_sub_u32 s31, s30, 1
    s_lshl_b32 s4, s31, 23
    s_add_u32 s4, s4, 0x6000000
    s_add_u32 s8, s6, s4
    s_addc_u32 s9, s7, 0
    s_and_b32 s9, s9, 0xffff
    s_mov_b32 s10, 0
    s_mov_b32 s58, 0
    s_mov_b32 s54, 4096
    s_mov_b32 s55, 0x20000
    s_mov_b32 s56, 1024
    s_cmp_lt_u32 s31, 2
    s_cselect_b32 s54, 229376, s54
    s_cselect_b32 s55, 128, s55
    s_cselect_b32 s56, 57344, s56
    s_cselect_b32 s59, 0x700000, 0
    s_cmp_eq_u32 s29, 0
    s_cselect_b32 s14, 0, s14
    s_cselect_b32 s59, 0, s59
    s_cselect_b32 s62, 0, s62
    s_waitcnt vmcnt(16) lgkmcnt(0)
    s_barrier
    s_cmp_eq_u32 s63, 0
    s_cbranch_scc1 k12_ool_68
k12_oolret_69:
    v_mov_b32 v59, 0
    ds_read_b128 a[128:131], v2 offset:0
    ds_read_b128 a[132:135], v2 offset:1024
    ds_read_b128 a[136:139], v2 offset:2048
    ds_read_b128 a[140:143], v2 offset:3072
    ds_read_b128 a[144:147], v2 offset:4096
    ds_read_b128 a[148:151], v2 offset:5120
    ds_read_b128 a[152:155], v2 offset:6144
    ds_read_b128 a[156:159], v2 offset:7168
    ds_read_b128 a[160:163], v2 offset:8192
    ds_read_b128 a[164:167], v2 offset:9216
    ds_read_b128 a[168:171], v2 offset:10240
    ds_read_b128 a[172:175], v2 offset:11264
    ds_read_b128 a[176:179], v2 offset:12288
    ds_read_b128 a[180:183], v2 offset:13312
    ds_read_b128 a[184:187], v2 offset:14336
    ds_read_b128 a[188:191], v2 offset:15360
    s_cmp_eq_u32 s30, 1
    s_cselect_b64 s[12:13], s[46:47], s[44:45]
    s_cmp_eq_u32 s30, 2
    s_cselect_b64 s[12:13], s[48:49], s[12:13]
    s_cmp_eq_u32 s30, 3
    s_cselect_b64 s[12:13], s[50:51], s[12:13]
    s_and_b32 s13, s13, 0xffff
    v_accvgpr_read_b32 v128, a64
    v_accvgpr_read_b32 v129, a65
    v_accvgpr_read_b32 v130, a66
    v_accvgpr_read_b32 v131, a67
    v_pk_mul_f32 v[128:129], v[128:129], s[40:41]
    v_pk_mul_f32 v[130:131], v[130:131], s[40:41]
    v_cvt_pk_bf16_f32 v96, v128, v129
    v_cvt_pk_bf16_f32 v97, v130, v131
    v_accvgpr_read_b32 v132, a72
    v_accvgpr_read_b32 v133, a73
    v_accvgpr_read_b32 v134, a74
    v_accvgpr_read_b32 v135, a75
    v_pk_mul_f32 v[132:133], v[132:133], s[40:41]
    v_pk_mul_f32 v[134:135], v[134:135], s[40:41]
    v_cvt_pk_bf16_f32 v98, v132, v133
    v_cvt_pk_bf16_f32 v99, v134, v135
    v_accvgpr_read_b32 v136, a80
    v_accvgpr_read_b32 v137, a81
    v_accvgpr_read_b32 v138, a82
    v_accvgpr_read_b32 v139, a83
    v_pk_mul_f32 v[136:137], v[136:137], s[40:41]
    v_pk_mul_f32 v[138:139], v[138:139], s[40:41]
    v_cvt_pk_bf16_f32 v100, v136, v137
    v_cvt_pk_bf16_f32 v101, v138, v139
    v_accvgpr_read_b32 v140, a88
    v_accvgpr_read_b32 v141, a89
    v_accvgpr_read_b32 v142, a90
    v_accvgpr_read_b32 v143, a91
    v_pk_mul_f32 v[140:141], v[140:141], s[40:41]
    v_pk_mul_f32 v[142:143], v[142:143], s[40:41]
    v_cvt_pk_bf16_f32 v102, v140, v141
    v_cvt_pk_bf16_f32 v103, v142, v143
    v_accvgpr_read_b32 v128, a96
    v_accvgpr_read_b32 v129, a97
    v_accvgpr_read_b32 v130, a98
    v_accvgpr_read_b32 v131, a99
    v_pk_mul_f32 v[128:129], v[128:129], s[40:41]
    v_pk_mul_f32 v[130:131], v[130:131], s[40:41]
    v_cvt_pk_bf16_f32 v104, v128, v129
    v_cvt_pk_bf16_f32 v105, v130, v131
    v_accvgpr_read_b32 v132, a104
    v_accvgpr_read_b32 v133, a105
    v_accvgpr_read_b32 v134, a106
    v_accvgpr_read_b32 v135, a107
    v_pk_mul_f32 v[132:133], v[132:133], s[40:41]
    v_pk_mul_f32 v[134:135], v[134:135], s[40:41]
    v_cvt_pk_bf16_f32 v106, v132, v133
    v_cvt_pk_bf16_f32 v107, v134, v135
    v_accvgpr_read_b32 v136, a112
    v_accvgpr_read_b32 v137, a113
    v_accvgpr_read_b32 v138, a114
    v_accvgpr_read_b32 v139, a115
    v_pk_mul_f32 v[136:137], v[136:137], s[40:41]
    v_pk_mul_f32 v[138:139], v[138:139], s[40:41]
    v_cvt_pk_bf16_f32 v108, v136, v137
    v_cvt_pk_bf16_f32 v109, v138, v139
    v_accvgpr_read_b32 v140, a120
    v_accvgpr_read_b32 v141, a121
    v_accvgpr_read_b32 v142, a122
    v_accvgpr_read_b32 v143, a123
    v_pk_mul_f32 v[140:141], v[140:141], s[40:41]
    v_pk_mul_f32 v[142:143], v[142:143], s[40:41]
    v_cvt_pk_bf16_f32 v110, v140, v141
    v_cvt_pk_bf16_f32 v111, v142, v143
    v_accvgpr_read_b32 v128, a68
    v_accvgpr_read_b32 v129, a69
    v_accvgpr_read_b32 v130, a70
    v_accvgpr_read_b32 v131, a71
    v_pk_mul_f32 v[128:129], v[128:129], s[40:41]
    v_pk_mul_f32 v[130:131], v[130:131], s[40:41]
    v_cvt_pk_bf16_f32 v112, v128, v129
    v_cvt_pk_bf16_f32 v113, v130, v131
    v_accvgpr_read_b32 v132, a76
    v_accvgpr_read_b32 v133, a77
    v_accvgpr_read_b32 v134, a78
    v_accvgpr_read_b32 v135, a79
    v_pk_mul_f32 v[132:133], v[132:133], s[40:41]
    v_pk_mul_f32 v[134:135], v[134:135], s[40:41]
    v_cvt_pk_bf16_f32 v114, v132, v133
    v_cvt_pk_bf16_f32 v115, v134, v135
    v_accvgpr_read_b32 v136, a84
    v_accvgpr_read_b32 v137, a85
    v_accvgpr_read_b32 v138, a86
    v_accvgpr_read_b32 v139, a87
    v_pk_mul_f32 v[136:137], v[136:137], s[40:41]
    v_pk_mul_f32 v[138:139], v[138:139], s[40:41]
    v_cvt_pk_bf16_f32 v116, v136, v137
    v_cvt_pk_bf16_f32 v117, v138, v139
    v_accvgpr_read_b32 v140, a92
    v_accvgpr_read_b32 v141, a93
    v_accvgpr_read_b32 v142, a94
    v_accvgpr_read_b32 v143, a95
    v_pk_mul_f32 v[140:141], v[140:141], s[40:41]
    v_pk_mul_f32 v[142:143], v[142:143], s[40:41]
    v_cvt_pk_bf16_f32 v118, v140, v141
    v_cvt_pk_bf16_f32 v119, v142, v143
    v_accvgpr_read_b32 v128, a100
    v_accvgpr_read_b32 v129, a101
    v_accvgpr_read_b32 v130, a102
    v_accvgpr_read_b32 v131, a103
    v_pk_mul_f32 v[128:129], v[128:129], s[40:41]
    v_pk_mul_f32 v[130:131], v[130:131], s[40:41]
    v_cvt_pk_bf16_f32 v120, v128, v129
    v_cvt_pk_bf16_f32 v121, v130, v131
    v_accvgpr_read_b32 v132, a108
    v_accvgpr_read_b32 v133, a109
    v_accvgpr_read_b32 v134, a110
    v_accvgpr_read_b32 v135, a111
    v_pk_mul_f32 v[132:133], v[132:133], s[40:41]
    v_pk_mul_f32 v[134:135], v[134:135], s[40:41]
    v_cvt_pk_bf16_f32 v122, v132, v133
    v_cvt_pk_bf16_f32 v123, v134, v135
    v_accvgpr_read_b32 v136, a116
    v_accvgpr_read_b32 v137, a117
    v_accvgpr_read_b32 v138, a118
    v_accvgpr_read_b32 v139, a119
    v_pk_mul_f32 v[136:137], v[136:137], s[40:41]
    v_pk_mul_f32 v[138:139], v[138:139], s[40:41]
    v_cvt_pk_bf16_f32 v124, v136, v137
    v_cvt_pk_bf16_f32 v125, v138, v139
    v_accvgpr_read_b32 v140, a124
    v_accvgpr_read_b32 v141, a125
    v_accvgpr_read_b32 v142, a126
    v_accvgpr_read_b32 v143, a127
    v_pk_mul_f32 v[140:141], v[140:141], s[40:41]
    v_pk_mul_f32 v[142:143], v[142:143], s[40:41]
    v_cvt_pk_bf16_f32 v126, v140, v141
    v_cvt_pk_bf16_f32 v127, v142, v143
    v_pk_mul_f32 v[192:193], v[192:193], s[40:41]
    v_pk_mul_f32 v[194:195], v[194:195], s[40:41]
    v_cvt_pk_bf16_f32 v64, v192, v193
    v_cvt_pk_bf16_f32 v65, v194, v195
    v_pk_mul_f32 v[200:201], v[200:201], s[40:41]
    v_pk_mul_f32 v[202:203], v[202:203], s[40:41]
    v_cvt_pk_bf16_f32 v66, v200, v201
    v_cvt_pk_bf16_f32 v67, v202, v203
    v_pk_mul_f32 v[208:209], v[208:209], s[40:41]
    v_pk_mul_f32 v[210:211], v[210:211], s[40:41]
    v_cvt_pk_bf16_f32 v68, v208, v209
    v_cvt_pk_bf16_f32 v69, v210, v211
    v_pk_mul_f32 v[216:217], v[216:217], s[40:41]
    v_pk_mul_f32 v[218:219], v[218:219], s[40:41]
    v_cvt_pk_bf16_f32 v70, v216, v217
    v_cvt_pk_bf16_f32 v71, v218, v219
    v_pk_mul_f32 v[224:225], v[224:225], s[40:41]
    v_pk_mul_f32 v[226:227], v[226:227], s[40:41]
    v_cvt_pk_bf16_f32 v72, v224, v225
    v_cvt_pk_bf16_f32 v73, v226, v227
    v_pk_mul_f32 v[232:233], v[232:233], s[40:41]
    v_pk_mul_f32 v[234:235], v[234:235], s[40:41]
    v_cvt_pk_bf16_f32 v74, v232, v233
    v_cvt_pk_bf16_f32 v75, v234, v235
    v_pk_mul_f32 v[240:241], v[240:241], s[40:41]
    v_pk_mul_f32 v[242:243], v[242:243], s[40:41]
    v_cvt_pk_bf16_f32 v76, v240, v241
    v_cvt_pk_bf16_f32 v77, v242, v243
    v_pk_mul_f32 v[248:249], v[248:249], s[40:41]
    v_pk_mul_f32 v[250:251], v[250:251], s[40:41]
    v_cvt_pk_bf16_f32 v78, v248, v249
    v_cvt_pk_bf16_f32 v79, v250, v251
    v_pk_mul_f32 v[196:197], v[196:197], s[40:41]
    v_pk_mul_f32 v[198:199], v[198:199], s[40:41]
    v_cvt_pk_bf16_f32 v80, v196, v197
    v_cvt_pk_bf16_f32 v81, v198, v199
    v_pk_mul_f32 v[204:205], v[204:205], s[40:41]
    v_pk_mul_f32 v[206:207], v[206:207], s[40:41]
    v_cvt_pk_bf16_f32 v82, v204, v205
    v_cvt_pk_bf16_f32 v83, v206, v207
    v_pk_mul_f32 v[212:213], v[212:213], s[40:41]
    v_pk_mul_f32 v[214:215], v[214:215], s[40:41]
    v_cvt_pk_bf16_f32 v84, v212, v213
    v_cvt_pk_bf16_f32 v85, v214, v215
    v_pk_mul_f32 v[220:221], v[220:221], s[40:41]
    v_pk_mul_f32 v[222:223], v[222:223], s[40:41]
    v_cvt_pk_bf16_f32 v86, v220, v221
    v_cvt_pk_bf16_f32 v87, v222, v223
    v_pk_mul_f32 v[228:229], v[228:229], s[40:41]
    v_pk_mul_f32 v[230:231], v[230:231], s[40:41]
    v_cvt_pk_bf16_f32 v88, v228, v229
    v_cvt_pk_bf16_f32 v89, v230, v231
    v_pk_mul_f32 v[236:237], v[236:237], s[40:41]
    v_pk_mul_f32 v[238:239], v[238:239], s[40:41]
    v_cvt_pk_bf16_f32 v90, v236, v237
    v_cvt_pk_bf16_f32 v91, v238, v239
    v_pk_mul_f32 v[244:245], v[244:245], s[40:41]
    v_pk_mul_f32 v[246:247], v[246:247], s[40:41]
    v_cvt_pk_bf16_f32 v92, v244, v245
    v_cvt_pk_bf16_f32 v93, v246, v247
    v_pk_mul_f32 v[252:253], v[252:253], s[40:41]
    v_pk_mul_f32 v[254:255], v[254:255], s[40:41]
    v_cvt_pk_bf16_f32 v94, v252, v253
    v_cvt_pk_bf16_f32 v95, v254, v255
    v_add_u32 v2, 0x4000, v1
    v_mov_b32 v8, 0
    v_mov_b32 v232, 0
    v_mov_b32 v9, 0
    v_mov_b32 v233, 0
    v_mov_b32 v10, 0
    v_mov_b32 v234, 0
    v_mov_b32 v11, 0
    v_mov_b32 v235, 0
    s_mov_b32 s36, 0
    s_mov_b32 s37, 0x40004000
    v_mfma_f32_32x32x16_bf16 v[16:31], v[232:235], v[232:235], 0
    v_mfma_f32_32x32x16_bf16 v[32:47], v[232:235], v[232:235], 0
    v_and_b32 v6, 0xf0, v1
    v_cmp_eq_u32 vcc, 0, v6
    v_mov_b32 v6, 0x3f803f80
    v_lshrrev_b32 v229, 7, v1
    s_lshr_b32 s4, s56, 3
    v_mul_u32_u24 v228, s4, v229
    v_and_b32 v7, 0x70, v1
    v_add_u32 v228, v228, v7
    v_lshlrev_b32 v229, 5, v229
    v_and_b32 v57, 0x10, v1
    v_add_u32 v229, v229, v57
    v_lshrrev_b32 v7, 5, v7
    v_lshl_add_u32 v229, v7, 15, v229
    v_cndmask_b32 v60, 0, v6, vcc
    v_cndmask_b32 v61, 0, v6, vcc
    v_cndmask_b32 v62, 0, v6, vcc
    v_cndmask_b32 v63, 0, v6, vcc
    v_mov_b32 v12, 0
    v_mov_b32 v13, 0
    v_mov_b32 v14, 0
    v_mov_b32 v15, 0
    v_mov_b32 v48, 0
    v_mov_b32 v49, 0
    v_mov_b32 v50, 0
    v_mov_b32 v51, 0
    v_mov_b32 v248, 0
    v_mov_b32 v249, 0
    v_mov_b32 v250, 0
    v_mov_b32 v251, 0
    v_mov_b32 v252, 0
    v_mov_b32 v253, 0
    v_mov_b32 v254, 0
    v_mov_b32 v255, 0
    s_waitcnt lgkmcnt(0)
    s_cmp_ge_u32 s36, s42
    s_cbranch_scc1 k2_prep_70
k2_prepret_71:
    v_mfma_f32_16x16x32_bf16 v[128:131], a[128:131], v[64:67], v[16:19]
    v_mfma_f32_16x16x32_bf16 v[132:135], a[128:131], v[80:83], v[20:23]
    v_mfma_f32_16x16x32_bf16 v[136:139], a[128:131], v[96:99], v[24:27]
    v_mfma_f32_16x16x32_bf16 v[140:143], a[128:131], v[112:115], v[28:31]
    s_add_u32 s36, s36, 32
    v_mfma_f32_16x16x32_bf16 v[128:131], a[132:135], v[68:71], v[128:131]
    v_mfma_f32_16x16x32_bf16 v[132:135], a[132:135], v[84:87], v[132:135]
    v_mfma_f32_16x16x32_bf16 v[136:139], a[132:135], v[100:103], v[136:139]
    v_mfma_f32_16x16x32_bf16 v[140:143], a[132:135], v[116:119], v[140:143]
    v_mfma_f32_16x16x32_bf16 v[128:131], a[136:139], v[72:75], v[128:131]
    v_mfma_f32_16x16x32_bf16 v[132:135], a[136:139], v[88:91], v[132:135]
    v_mfma_f32_16x16x32_bf16 v[136:139], a[136:139], v[104:107], v[136:139]
    v_mfma_f32_16x16x32_bf16 v[140:143], a[136:139], v[120:123], v[140:143]
    v_mfma_f32_16x16x32_bf16 v[128:131], a[140:143], v[76:79], v[128:131]
    v_mfma_f32_16x16x32_bf16 v[132:135], a[140:143], v[92:95], v[132:135]
    v_mfma_f32_16x16x32_bf16 v[136:139], a[140:143], v[108:111], v[136:139]
    v_mfma_f32_16x16x32_bf16 v[140:143], a[140:143], v[124:127], v[140:143]
    v_mfma_f32_16x16x32_bf16 v[144:147], a[144:147], v[64:67], v[32:35]
    v_mfma_f32_16x16x32_bf16 v[148:151], a[144:147], v[80:83], v[36:39]
    v_mfma_f32_16x16x32_bf16 v[152:155], a[144:147], v[96:99], v[40:43]
    v_mfma_f32_16x16x32_bf16 v[156:159], a[144:147], v[112:115], v[44:47]
    v_mfma_f32_16x16x32_bf16 v[144:147], a[148:151], v[68:71], v[144:147]
    v_mfma_f32_16x16x32_bf16 v[148:151], a[148:151], v[84:87], v[148:151]
    v_mfma_f32_16x16x32_bf16 v[152:155], a[148:151], v[100:103], v[152:155]
    v_mfma_f32_16x16x32_bf16 v[156:159], a[148:151], v[116:119], v[156:159]
    v_mfma_f32_16x16x32_bf16 v[144:147], a[152:155], v[72:75], v[144:147]
    v_mfma_f32_16x16x32_bf16 v[148:151], a[152:155], v[88:91], v[148:151]
    v_mfma_f32_16x16x32_bf16 v[152:155], a[152:155], v[104:107], v[152:155]
    v_mfma_f32_16x16x32_bf16 v[156:159], a[152:155], v[120:123], v[156:159]
    v_mfma_f32_16x16x32_bf16 v[144:147], a[156:159], v[76:79], v[144:147]
    v_mfma_f32_16x16x32_bf16 v[148:151], a[156:159], v[92:95], v[148:151]
    v_mfma_f32_16x16x32_bf16 v[152:155], a[156:159], v[108:111], v[152:155]
    v_mfma_f32_16x16x32_bf16 v[156:159], a[156:159], v[124:127], v[156:159]
    v_mfma_f32_32x32x16_bf16 a[0:15], v[232:235], v[232:235], 0
    v_mfma_f32_32x32x16_bf16 a[16:31], v[232:235], v[232:235], 0
    v_mfma_f32_32x32x16_bf16 a[32:47], v[232:235], v[232:235], 0
    v_mfma_f32_32x32x16_bf16 a[48:63], v[232:235], v[232:235], 0
    v_mfma_f32_32x32x16_bf16 a[64:79], v[232:235], v[232:235], 0
    v_mfma_f32_32x32x16_bf16 a[80:95], v[232:235], v[232:235], 0
    v_mfma_f32_32x32x16_bf16 a[96:111], v[232:235], v[232:235], 0
    v_mfma_f32_32x32x16_bf16 a[112:127], v[232:235], v[232:235], 0
    v_max_f32 v52, v128, v129
    v_max3_f32 v52, v52, v130, v131
    v_max3_f32 v52, v52, v144, v145
    v_max3_f32 v52, v52, v146, v147
    v_max_f32 v53, v132, v133
    v_max3_f32 v53, v53, v134, v135
    v_max3_f32 v53, v53, v148, v149
    v_max3_f32 v53, v53, v150, v151
    v_max_f32 v54, v136, v137
    v_max3_f32 v54, v54, v138, v139
    v_max3_f32 v54, v54, v152, v153
    v_max3_f32 v54, v54, v154, v155
    v_max_f32 v55, v140, v141
    v_max3_f32 v55, v55, v142, v143
    v_max3_f32 v55, v55, v156, v157
    v_max3_f32 v55, v55, v158, v159
    v_mov_b32 v224, v52
    v_mov_b32 v225, v53
    v_mov_b32 v226, v54
    v_mov_b32 v227, v55
    s_nop 1
    v_permlane16_swap_b32 v52, v224
    v_permlane16_swap_b32 v53, v225
    v_permlane16_swap_b32 v54, v226
    v_permlane16_swap_b32 v55, v227
    s_nop 1
    v_max_f32 v52, v52, v224
    v_max_f32 v53, v53, v225
    v_max_f32 v54, v54, v226
    v_max_f32 v55, v55, v227
    v_mov_b32 v224, v52
    v_mov_b32 v225, v53
    v_mov_b32 v226, v54
    v_mov_b32 v227, v55
    s_nop 1
    v_permlane32_swap_b32 v52, v224
    v_permlane32_swap_b32 v53, v225
    v_permlane32_swap_b32 v54, v226
    v_permlane32_swap_b32 v55, v227
    s_nop 1
    v_max_f32 v52, v52, v224
    v_max_f32 v53, v53, v225
    v_max_f32 v54, v54, v226
    v_max_f32 v55, v55, v227
    v_add_f32 v52, 0x41400000, v52
    v_add_f32 v53, 0x41400000, v53
    v_add_f32 v54, 0x41400000, v54
    v_add_f32 v55, 0x41400000, v55
    v_sub_f32 v16, 0, v52
    v_sub_f32 v17, 0, v52
    v_sub_f32 v18, 0, v52
    v_sub_f32 v19, 0, v52
    v_sub_f32 v20, 0, v53
    v_sub_f32 v21, 0, v53
    v_sub_f32 v22, 0, v53
    v_sub_f32 v23, 0, v53
    v_sub_f32 v24, 0, v54
    v_sub_f32 v25, 0, v54
    v_sub_f32 v26, 0, v54
    v_sub_f32 v27, 0, v54
    v_sub_f32 v28, 0, v55
    v_sub_f32 v29, 0, v55
    v_sub_f32 v30, 0, v55
    v_sub_f32 v31, 0, v55
    v_sub_f32 v32, 0, v52
    v_sub_f32 v33, 0, v52
    v_sub_f32 v34, 0, v52
    v_sub_f32 v35, 0, v52
    v_sub_f32 v36, 0, v53
    v_sub_f32 v37, 0, v53
    v_sub_f32 v38, 0, v53
    v_sub_f32 v39, 0, v53
    v_sub_f32 v40, 0, v54
    v_sub_f32 v41, 0, v54
    v_sub_f32 v42, 0, v54
    v_sub_f32 v43, 0, v54
    v_sub_f32 v44, 0, v55
    v_sub_f32 v45, 0, v55
    v_sub_f32 v46, 0, v55
    v_sub_f32 v47, 0, v55
    v_sub_f32 v8, 0, v52
    v_sub_f32 v9, 0, v53
    v_sub_f32 v10, 0, v54
    v_sub_f32 v11, 0, v55
    s_cmp_ge_u32 s36, s42
    s_cbranch_scc1 k2_prep_78
k2_prepret_79:
    v_mfma_f32_16x16x32_bf16 v[160:163], a[160:163], v[64:67], v[16:19]
    v_sub_f32 v128, v128, v52
    v_sub_f32 v129, v129, v52
    v_sub_f32 v130, v130, v52
    v_mfma_f32_16x16x32_bf16 v[164:167], a[160:163], v[80:83], v[20:23]
    v_exp_f32 v232, v128
    v_sub_f32 v131, v131, v52
    v_mfma_f32_16x16x32_bf16 v[168:171], a[160:163], v[96:99], v[24:27]
    v_exp_f32 v233, v129
    v_sub_f32 v144, v144, v52
    v_mfma_f32_16x16x32_bf16 v[172:175], a[160:163], v[112:115], v[28:31]
    s_add_u32 s36, s36, 32
    s_cmp_eq_u32 s30, 0
    s_cbranch_scc1 k12_ool_72
k12_oolret_73:
    v_sub_f32 v145, v145, v52
    v_mfma_f32_16x16x32_bf16 v[160:163], a[164:167], v[68:71], v[160:163]
    v_exp_f32 v234, v130
    v_cvt_pk_bf16_f32 v192, v232, v233
    v_mfma_f32_16x16x32_bf16 v[164:167], a[164:167], v[84:87], v[164:167]
    v_exp_f32 v235, v131
    v_sub_f32 v146, v146, v52
    v_mfma_f32_16x16x32_bf16 v[168:171], a[164:167], v[100:103], v[168:171]
    v_exp_f32 v236, v144
    v_sub_f32 v147, v147, v52
    v_mfma_f32_16x16x32_bf16 v[172:175], a[164:167], v[116:119], v[172:175]
    v_cvt_pk_bf16_f32 v193, v234, v235
    v_exp_f32 v237, v145
    v_mfma_f32_16x16x32_bf16 v[160:163], a[168:171], v[72:75], v[160:163]
    v_exp_f32 v238, v146
    v_sub_f32 v132, v132, v53
    v_mfma_f32_16x16x32_bf16 v[164:167], a[168:171], v[88:91], v[164:167]
    v_sub_f32 v133, v133, v53
    v_cvt_pk_bf16_f32 v194, v236, v237
    v_or3_b32 v57, v192, v193, v194
    v_mfma_f32_16x16x32_bf16 v[168:171], a[168:171], v[104:107], v[168:171]
    v_exp_f32 v239, v147
    v_sub_f32 v134, v134, v53
    v_mfma_f32_16x16x32_bf16 v[172:175], a[168:171], v[120:123], v[172:175]
    v_exp_f32 v240, v132
    v_sub_f32 v135, v135, v53
    v_mfma_f32_16x16x32_bf16 v[160:163], a[172:175], v[76:79], v[160:163]
    v_cvt_pk_bf16_f32 v195, v238, v239
    v_exp_f32 v241, v133
    v_mfma_f32_16x16x32_bf16 v[164:167], a[172:175], v[92:95], v[164:167]
    v_exp_f32 v242, v134
    v_sub_f32 v148, v148, v53
    v_mfma_f32_16x16x32_bf16 v[168:171], a[172:175], v[108:111], v[168:171]
    v_sub_f32 v149, v149, v53
    v_cvt_pk_bf16_f32 v196, v240, v241
    v_exp_f32 v243, v135
    v_mfma_f32_16x16x32_bf16 v[172:175], a[172:175], v[124:127], v[172:175]
    v_or3_b32 v57, v57, v195, v196
    v_exp_f32 v244, v148
    v_mfma_f32_16x16x32_bf16 v[176:179], a[176:179], v[64:67], v[32:35]
    v_sub_f32 v150, v150, v53
    v_sub_f32 v151, v151, v53
    v_cvt_pk_bf16_f32 v197, v242, v243
    v_mfma_f32_16x16x32_bf16 v[180:183], a[176:179], v[80:83], v[36:39]
    v_exp_f32 v245, v149
    v_exp_f32 v246, v150
    v_mfma_f32_16x16x32_bf16 v[184:187], a[176:179], v[96:99], v[40:43]
    v_sub_f32 v136, v136, v54
    v_sub_f32 v137, v137, v54
    v_cvt_pk_bf16_f32 v198, v244, v245
    v_mfma_f32_16x16x32_bf16 v[188:191], a[176:179], v[112:115], v[44:47]
    v_exp_f32 v247, v151
    v_or3_b32 v57, v57, v197, v198
    v_mfma_f32_16x16x32_bf16 v[176:179], a[180:183], v[68:71], v[176:179]
    v_exp_f32 v232, v136
    v_sub_f32 v138, v138, v54
    v_mfma_f32_16x16x32_bf16 v[180:183], a[180:183], v[84:87], v[180:183]
    ds_read_b128 a[192:195], v3 offset:0
    v_sub_f32 v139, v139, v54
    v_cvt_pk_bf16_f32 v199, v246, v247
    v_mfma_f32_16x16x32_bf16 v[184:187], a[180:183], v[100:103], v[184:187]
    v_exp_f32 v233, v137
    v_exp_f32 v234, v138
    v_mfma_f32_16x16x32_bf16 v[188:191], a[180:183], v[116:119], v[188:191]
    v_sub_f32 v152, v152, v54
    v_sub_f32 v153, v153, v54
    v_cvt_pk_bf16_f32 v200, v232, v233
    v_mfma_f32_16x16x32_bf16 v[176:179], a[184:187], v[72:75], v[176:179]
    v_exp_f32 v235, v139
    v_or3_b32 v57, v57, v199, v200
    v_mfma_f32_16x16x32_bf16 v[180:183], a[184:187], v[88:91], v[180:183]
    v_exp_f32 v236, v152
    v_sub_f32 v154, v154, v54
    v_mfma_f32_16x16x32_bf16 v[184:187], a[184:187], v[104:107], v[184:187]
    v_sub_f32 v155, v155, v54
    v_cvt_pk_bf16_f32 v201, v234, v235
    v_exp_f32 v237, v153
    v_mfma_f32_16x16x32_bf16 v[188:191], a[184:187], v[120:123], v[188:191]
    ds_read_b128 a[196:199], v3 offset:1024
    v_exp_f32 v238, v154
    v_mfma_f32_16x16x32_bf16 v[176:179], a[188:191], v[76:79], v[176:179]
    v_sub_f32 v140, v140, v55
    v_sub_f32 v141, v141, v55
    v_cvt_pk_bf16_f32 v202, v236, v237
    v_mfma_f32_16x16x32_bf16 v[180:183], a[188:191], v[92:95], v[180:183]
    v_exp_f32 v239, v155
    v_or3_b32 v57, v57, v201, v202
    v_mfma_f32_16x16x32_bf16 v[184:187], a[188:191], v[108:111], v[184:187]
    s_cmp_eq_u32 s30, 0
    s_cbranch_scc1 k12_ool_76
k12_oolret_77:
    v_exp_f32 v240, v140
    v_mfma_f32_16x16x32_bf16 v[188:191], a[188:191], v[124:127], v[188:191]
    s_waitcnt vmcnt(8)
    s_barrier
    v_sub_f32 v142, v142, v55
    v_sub_f32 v143, v143, v55
    v_cvt_pk_bf16_f32 v203, v238, v239
    v_exp_f32 v241, v141
    ds_read_b128 a[200:203], v3 offset:2048
    v_exp_f32 v242, v142
    v_sub_f32 v156, v156, v55
    v_sub_f32 v157, v157, v55
    v_cvt_pk_bf16_f32 v204, v240, v241
    v_exp_f32 v243, v143
    v_or3_b32 v57, v57, v203, v204
    v_exp_f32 v244, v156
    v_sub_f32 v158, v158, v55
    v_sub_f32 v159, v159, v55
    v_cvt_pk_bf16_f32 v205, v242, v243
    v_exp_f32 v245, v157
    ds_read_b128 a[204:207], v3 offset:3072
    v_exp_f32 v246, v158
    v_cvt_pk_bf16_f32 v206, v244, v245
    v_exp_f32 v247, v159
    v_or3_b32 v57, v57, v205, v206
    v_cvt_pk_bf16_f32 v207, v246, v247
    v_bitop3_b32 v57, v57, v207, s37 bitop3:0xa8
    v_cmp_ne_u32 vcc, 0, v57
    s_cbranch_vccnz k2_rare_80
k2_ret_81:
    s_add_u32 s24, s6, 0x3000000
    s_addc_u32 s25, s7, 0
    s_and_b32 s25, s25, 0xffff
    s_mov_b32 s26, 0x1000000
    s_mov_b32 s27, 0x00020000
    s_lshl_b32 s63, s29, 1
    s_add_u32 s63, s63, 1
k2_dloop_82:
    v_mfma_f32_16x16x32_bf16 v[12:15], v[60:63], v[192:195], v[12:15]
    ds_read_b128 a[208:211], v3 offset:4096
    v_mfma_f32_16x16x32_bf16 v[48:51], v[60:63], v[196:199], v[48:51]
    s_and_b32 s60, s62, 31
    v_exp_f32 v232, v160
    v_mfma_f32_16x16x32_bf16 v[248:251], v[60:63], v[200:203], v[248:251]
    s_add_u32 s53, s53, 8192
    buffer_store_dwordx4 a[224:227], v229, s[8:11], s58 offen offset:0 sc1
    v_mfma_f32_16x16x32_bf16 v[252:255], v[60:63], v[204:207], v[252:255]
    s_waitcnt lgkmcnt(3)
    v_exp_f32 v233, v161
    v_mfma_f32_16x16x32_bf16 a[0:3], a[192:195], v[192:195], a[0:3]
    s_lshr_b32 s61, s62, 5
    ds_read_b128 a[212:215], v3 offset:5120
    v_cvt_pk_bf16_f32 v208, v232, v233
    v_mfma_f32_16x16x32_bf16 a[4:7], a[192:195], v[196:199], a[4:7]
    s_and_b32 s53, s53, 0xffff
    v_exp_f32 v234, v162
    v_mfma_f32_16x16x32_bf16 a[8:11], a[192:195], v[200:203], a[8:11]
    s_mul_i32 s57, s60, s54
    v_exp_f32 v235, v163
    v_mfma_f32_16x16x32_bf16 a[12:15], a[192:195], v[204:207], a[12:15]
    buffer_store_dwordx4 a[228:231], v229, s[8:11], s58 offen offset:256 sc1
    ds_read_b128 a[216:219], v3 offset:6144
    v_mfma_f32_16x16x32_bf16 a[16:19], a[196:199], v[192:195], a[16:19]
    s_mul_i32 s4, s61, s55
    v_exp_f32 v236, v176
    v_mfma_f32_16x16x32_bf16 a[20:23], a[196:199], v[196:199], a[20:23]
    v_cvt_pk_bf16_f32 v209, v234, v235
    v_mfma_f32_16x16x32_bf16 a[24:27], a[196:199], v[200:203], a[24:27]
    s_add_u32 s57, s57, s4
    v_exp_f32 v237, v177
    v_mfma_f32_16x16x32_bf16 a[28:31], a[196:199], v[204:207], a[28:31]
    s_waitcnt lgkmcnt(3)
    buffer_store_dwordx4 a[232:235], v229, s[8:11], s58 offen offset:512 sc1
    ds_read_b128 a[220:223], v3 offset:7168
    v_mfma_f32_16x16x32_bf16 a[32:35], a[200:203], v[192:195], a[32:35]
    v_exp_f32 v238, v178
    v_mfma_f32_16x16x32_bf16 a[36:39], a[200:203], v[196:199], a[36:39]
    s_add_u32 s62, s62, 1
    v_cvt_pk_bf16_f32 v210, v236, v237
    v_or3_b32 v57, v208, v209, v210
    v_mfma_f32_16x16x32_bf16 a[40:43], a[200:203], v[200:203], a[40:43]
    v_exp_f32 v239, v179
    v_mfma_f32_16x16x32_bf16 a[44:47], a[200:203], v[204:207], a[44:47]
    v_exp_f32 v240, v164
    v_mfma_f32_16x16x32_bf16 a[48:51], a[204:207], v[192:195], a[48:51]
    buffer_store_dwordx4 a[236:239], v229, s[8:11], s58 offen offset:768 sc1
    v_mfma_f32_16x16x32_bf16 a[52:55], a[204:207], v[196:199], a[52:55]
    ds_read_b128 a[128:131], v2 offset:0
    v_cvt_pk_bf16_f32 v211, v238, v239
    v_mfma_f32_16x16x32_bf16 a[56:59], a[204:207], v[200:203], a[56:59]
    v_exp_f32 v241, v165
    v_mfma_f32_16x16x32_bf16 a[60:63], a[204:207], v[204:207], a[60:63]
    s_waitcnt lgkmcnt(3)
    v_add_u32 v3, s53, v56
    v_cvt_pk_bf16_f32 v212, v240, v241
    v_mfma_f32_16x16x32_bf16 a[64:67], a[208:211], v[192:195], a[64:67]
    v_exp_f32 v242, v166
    v_mfma_f32_16x16x32_bf16 a[68:71], a[208:211], v[196:199], a[68:71]
    buffer_load_dwordx4 a[224:227], v228, s[12:15], s57 offen
    ds_read_b128 a[132:135], v2 offset:1024
    v_mfma_f32_16x16x32_bf16 a[72:75], a[208:211], v[200:203], a[72:75]
    s_lshl_b32 s58, s61, 17
    v_exp_f32 v243, v167
    v_mfma_f32_16x16x32_bf16 a[76:79], a[208:211], v[204:207], a[76:79]
    s_add_u32 s57, s57, s56
    v_or3_b32 v57, v57, v211, v212
    v_cvt_pk_bf16_f32 v213, v242, v243
    v_mfma_f32_16x16x32_bf16 a[80:83], a[212:215], v[192:195], a[80:83]
    s_lshl_b32 s60, s60, 10
    s_cmp_ge_u32 s36, s42
    s_cbranch_scc1 k2_prep_83
k2_prepret_84:
    v_mfma_f32_16x16x32_bf16 a[84:87], a[212:215], v[196:199], a[84:87]
    v_exp_f32 v244, v180
    v_mfma_f32_16x16x32_bf16 a[88:91], a[212:215], v[200:203], a[88:91]
    buffer_load_dwordx4 a[228:231], v228, s[12:15], s57 offen
    ds_read_b128 a[136:139], v2 offset:2048
    v_mfma_f32_16x16x32_bf16 a[92:95], a[212:215], v[204:207], a[92:95]
    s_waitcnt lgkmcnt(3)
    v_exp_f32 v245, v181
    v_mfma_f32_16x16x32_bf16 a[96:99], a[216:219], v[192:195], a[96:99]
    s_add_u32 s57, s57, s56
    v_exp_f32 v246, v182
    v_mfma_f32_16x16x32_bf16 a[100:103], a[216:219], v[196:199], a[100:103]
    s_add_u32 s58, s58, s60
    ds_read_b128 a[140:143], v2 offset:3072
    v_cvt_pk_bf16_f32 v214, v244, v245
    v_mfma_f32_16x16x32_bf16 a[104:107], a[216:219], v[200:203], a[104:107]
    v_exp_f32 v247, v183
    v_mfma_f32_16x16x32_bf16 a[108:111], a[216:219], v[204:207], a[108:111]
    v_or3_b32 v57, v57, v213, v214
    v_cvt_pk_bf16_f32 v215, v246, v247
    v_mfma_f32_16x16x32_bf16 a[112:115], a[220:223], v[192:195], a[112:115]
    s_mov_b32 s10, s59
    buffer_load_dwordx4 a[232:235], v228, s[12:15], s57 offen
    ds_read_b128 a[144:147], v2 offset:4096
    v_mfma_f32_16x16x32_bf16 a[116:119], a[220:223], v[196:199], a[116:119]
    s_add_u32 s57, s57, s56
    v_exp_f32 v232, v168
    v_mfma_f32_16x16x32_bf16 a[120:123], a[220:223], v[200:203], a[120:123]
    v_exp_f32 v233, v169
    v_mfma_f32_16x16x32_bf16 a[124:127], a[220:223], v[204:207], a[124:127]
    s_waitcnt lgkmcnt(3)
    v_exp_f32 v234, v170
    v_mfma_f32_16x16x32_bf16 v[128:131], a[128:131], v[64:67], v[16:19]
    v_cvt_pk_bf16_f32 v216, v232, v233
    v_mfma_f32_16x16x32_bf16 v[132:135], a[128:131], v[80:83], v[20:23]
    buffer_load_dwordx4 a[236:239], v228, s[12:15], s57 offen
    ds_read_b128 a[148:151], v2 offset:5120
    v_mfma_f32_16x16x32_bf16 v[136:139], a[128:131], v[96:99], v[24:27]
    v_exp_f32 v235, v171
    v_mfma_f32_16x16x32_bf16 v[140:143], a[128:131], v[112:115], v[28:31]
    s_add_u32 s36, s36, 32
    v_or3_b32 v57, v57, v215, v216
    v_cvt_pk_bf16_f32 v217, v234, v235
    v_mfma_f32_16x16x32_bf16 v[128:131], a[132:135], v[68:71], v[128:131]
    v_exp_f32 v236, v184
    v_mfma_f32_16x16x32_bf16 v[132:135], a[132:135], v[84:87], v[132:135]
    ds_read_b128 a[152:155], v2 offset:6144
    v_mfma_f32_16x16x32_bf16 v[136:139], a[132:135], v[100:103], v[136:139]
    s_mov_b32 m0, s34
    v_exp_f32 v237, v185
    v_mfma_f32_16x16x32_bf16 v[140:143], a[132:135], v[116:119], v[140:143]
    s_waitcnt lgkmcnt(3)
    buffer_load_dwordx4 v1, s[16:19], s32 offen offset:0 sc1 lds
    v_mfma_f32_16x16x32_bf16 v[128:131], a[136:139], v[72:75], v[128:131]
    s_add_u32 s52, s52, 8192
    v_exp_f32 v238, v186
    v_mfma_f32_16x16x32_bf16 v[132:135], a[136:139], v[88:91], v[132:135]
    ds_read_b128 a[156:159], v2 offset:7168
    v_cvt_pk_bf16_f32 v218, v236, v237
    v_mfma_f32_16x16x32_bf16 v[136:139], a[136:139], v[104:107], v[136:139]
    s_and_b32 s52, s52, 0xffff
    v_exp_f32 v239, v187
    v_mfma_f32_16x16x32_bf16 v[140:143], a[136:139], v[120:123], v[140:143]
    s_add_u32 s34, s34, 0x4000
    v_or3_b32 v57, v57, v217, v218
    v_cvt_pk_bf16_f32 v219, v238, v239
    v_mfma_f32_16x16x32_bf16 v[128:131], a[140:143], v[76:79], v[128:131]
    v_exp_f32 v240, v172
    v_mfma_f32_16x16x32_bf16 v[132:135], a[140:143], v[92:95], v[132:135]
    buffer_load_dwordx4 v1, s[16:19], s32 offen offset:1024 sc1 lds
    v_mfma_f32_16x16x32_bf16 v[136:139], a[140:143], v[108:111], v[136:139]
    v_exp_f32 v241, v173
    v_mfma_f32_16x16x32_bf16 v[140:143], a[140:143], v[124:127], v[140:143]
    s_waitcnt lgkmcnt(2)
    ds_read_b128 a[192:195], v3 offset:0
    v_cvt_pk_bf16_f32 v220, v240, v241
    v_mfma_f32_16x16x32_bf16 v[144:147], a[144:147], v[64:67], v[32:35]
    s_and_b32 s34, s34, 0xffff
    v_exp_f32 v242, v174
    v_mfma_f32_16x16x32_bf16 v[148:151], a[144:147], v[80:83], v[36:39]
    v_add_u32 v2, s52, v1
    v_or3_b32 v57, v57, v219, v220
    v_mfma_f32_16x16x32_bf16 v[152:155], a[144:147], v[96:99], v[40:43]
    v_exp_f32 v243, v175
    v_mfma_f32_16x16x32_bf16 v[156:159], a[144:147], v[112:115], v[44:47]
    buffer_load_dwordx4 v1, s[16:19], s32 offen offset:2048 sc1 lds
    ds_read_b128 a[196:199], v3 offset:1024
    v_mfma_f32_16x16x32_bf16 v[144:147], a[148:151], v[68:71], v[144:147]
    v_exp_f32 v244, v188
    v_mfma_f32_16x16x32_bf16 v[148:151], a[148:151], v[84:87], v[148:151]
    ds_read_b128 a[200:203], v3 offset:2048
    v_cvt_pk_bf16_f32 v221, v242, v243
    v_mfma_f32_16x16x32_bf16 v[152:155], a[148:151], v[100:103], v[152:155]
    v_exp_f32 v245, v189
    v_mfma_f32_16x16x32_bf16 v[156:159], a[148:151], v[116:119], v[156:159]
    s_waitcnt lgkmcnt(3)
    v_exp_f32 v246, v190
    v_mfma_f32_16x16x32_bf16 v[144:147], a[152:155], v[72:75], v[144:147]
    buffer_load_dwordx4 v1, s[16:19], s32 offen offset:3072 sc1 lds
    v_mfma_f32_16x16x32_bf16 v[148:151], a[152:155], v[88:91], v[148:151]
    s_add_u32 s32, s32, 0x80000
    ds_read_b128 a[204:207], v3 offset:3072
    v_cvt_pk_bf16_f32 v222, v244, v245
    v_mfma_f32_16x16x32_bf16 v[152:155], a[152:155], v[104:107], v[152:155]
    v_exp_f32 v247, v191
    v_mfma_f32_16x16x32_bf16 v[156:159], a[152:155], v[120:123], v[156:159]
    v_or3_b32 v57, v57, v221, v222
    v_cvt_pk_bf16_f32 v223, v246, v247
    v_mfma_f32_16x16x32_bf16 v[144:147], a[156:159], v[76:79], v[144:147]
    v_mfma_f32_16x16x32_bf16 v[148:151], a[156:159], v[92:95], v[148:151]
    v_bitop3_b32 v57, v57, v223, s37 bitop3:0xa8
    v_cmp_ne_u32 vcc, 0, v57
    v_mfma_f32_16x16x32_bf16 v[152:155], a[156:159], v[108:111], v[152:155]
    v_mfma_f32_16x16x32_bf16 v[156:159], a[156:159], v[124:127], v[156:159]
    s_cbranch_vccnz k2_rare_85
k2_ret_86:
    v_mfma_f32_16x16x32_bf16 v[12:15], v[60:63], v[208:211], v[12:15]
    ds_read_b128 a[208:211], v3 offset:4096
    v_mfma_f32_16x16x32_bf16 v[48:51], v[60:63], v[212:215], v[48:51]
    v_exp_f32 v232, v128
    v_mfma_f32_16x16x32_bf16 v[248:251], v[60:63], v[216:219], v[248:251]
    s_mov_b32 m0, s35
    v_exp_f32 v233, v129
    v_mfma_f32_16x16x32_bf16 v[252:255], v[60:63], v[220:223], v[252:255]
    s_waitcnt lgkmcnt(3)
    buffer_load_dwordx4 v1, s[20:23], s33 offen offset:0 sc1 lds
    ds_read_b128 a[212:215], v3 offset:5120
    v_mfma_f32_16x16x32_bf16 a[0:3], a[192:195], v[208:211], a[0:3]
    s_add_u32 s53, s53, 8192
    v_exp_f32 v234, v130
    v_mfma_f32_16x16x32_bf16 a[4:7], a[192:195], v[212:215], a[4:7]
    s_and_b32 s53, s53, 0xffff
    v_cvt_pk_bf16_f32 v192, v232, v233
    v_mfma_f32_16x16x32_bf16 a[8:11], a[192:195], v[216:219], a[8:11]
    v_exp_f32 v235, v131
    v_mfma_f32_16x16x32_bf16 a[12:15], a[192:195], v[220:223], a[12:15]
    ds_read_b128 a[216:219], v3 offset:6144
    v_cvt_pk_bf16_f32 v193, v234, v235
    v_mfma_f32_16x16x32_bf16 a[16:19], a[196:199], v[208:211], a[16:19]
    v_exp_f32 v236, v144
    v_mfma_f32_16x16x32_bf16 a[20:23], a[196:199], v[212:215], a[20:23]
    v_exp_f32 v237, v145
    v_mfma_f32_16x16x32_bf16 a[24:27], a[196:199], v[216:219], a[24:27]
    v_mfma_f32_16x16x32_bf16 a[28:31], a[196:199], v[220:223], a[28:31]
    s_waitcnt lgkmcnt(3)
    ds_read_b128 a[220:223], v3 offset:7168
    v_cvt_pk_bf16_f32 v194, v236, v237
    v_mfma_f32_16x16x32_bf16 a[32:35], a[200:203], v[208:211], a[32:35]
    v_exp_f32 v238, v146
    v_mfma_f32_16x16x32_bf16 a[36:39], a[200:203], v[212:215], a[36:39]
    v_exp_f32 v239, v147
    v_mfma_f32_16x16x32_bf16 a[40:43], a[200:203], v[216:219], a[40:43]
    v_or3_b32 v57, v192, v193, v194
    v_mfma_f32_16x16x32_bf16 a[44:47], a[200:203], v[220:223], a[44:47]
    v_exp_f32 v240, v132
    v_mfma_f32_16x16x32_bf16 a[48:51], a[204:207], v[208:211], a[48:51]
    s_add_u32 s35, s35, 0x4000
    v_cvt_pk_bf16_f32 v195, v238, v239
    v_mfma_f32_16x16x32_bf16 a[52:55], a[204:207], v[212:215], a[52:55]
    buffer_load_dwordx4 v1, s[20:23], s33 offen offset:1024 sc1 lds
    ds_read_b128 a[128:131], v2 offset:0
    v_mfma_f32_16x16x32_bf16 a[56:59], a[204:207], v[216:219], a[56:59]
    v_exp_f32 v241, v133
    v_mfma_f32_16x16x32_bf16 a[60:63], a[204:207], v[220:223], a[60:63]
    s_waitcnt lgkmcnt(3)
    v_add_u32 v3, s53, v56
    v_cvt_pk_bf16_f32 v196, v240, v241
    v_mfma_f32_16x16x32_bf16 a[64:67], a[208:211], v[208:211], a[64:67]
    v_exp_f32 v242, v134
    v_mfma_f32_16x16x32_bf16 a[68:71], a[208:211], v[212:215], a[68:71]
    ds_read_b128 a[132:135], v2 offset:1024
    v_or3_b32 v57, v57, v195, v196
    v_mfma_f32_16x16x32_bf16 a[72:75], a[208:211], v[216:219], a[72:75]
    v_exp_f32 v243, v135
    v_mfma_f32_16x16x32_bf16 a[76:79], a[208:211], v[220:223], a[76:79]
    s_cmp_ge_u32 s36, s42
    s_cbranch_scc1 k2_prep_87
k2_prepret_88:
    v_mfma_f32_16x16x32_bf16 a[80:83], a[212:215], v[208:211], a[80:83]
    v_exp_f32 v244, v148
    v_mfma_f32_16x16x32_bf16 a[84:87], a[212:215], v[212:215], a[84:87]
    ds_read_b128 a[136:139], v2 offset:2048
    v_cvt_pk_bf16_f32 v197, v242, v243
    v_mfma_f32_16x16x32_bf16 a[88:91], a[212:215], v[216:219], a[88:91]
    v_exp_f32 v245, v149
    v_mfma_f32_16x16x32_bf16 a[92:95], a[212:215], v[220:223], a[92:95]
    s_waitcnt lgkmcnt(3)
    v_exp_f32 v246, v150
    v_mfma_f32_16x16x32_bf16 a[96:99], a[216:219], v[208:211], a[96:99]
    ds_read_b128 a[140:143], v2 offset:3072
    v_cvt_pk_bf16_f32 v198, v244, v245
    v_mfma_f32_16x16x32_bf16 a[100:103], a[216:219], v[212:215], a[100:103]
    v_exp_f32 v247, v151
    v_mfma_f32_16x16x32_bf16 a[104:107], a[216:219], v[216:219], a[104:107]
    v_or3_b32 v57, v57, v197, v198
    v_mfma_f32_16x16x32_bf16 a[108:111], a[216:219], v[220:223], a[108:111]
    s_and_b32 s35, s35, 0xffff
    v_exp_f32 v232, v136
    v_mfma_f32_16x16x32_bf16 a[112:115], a[220:223], v[208:211], a[112:115]
    ds_read_b128 a[144:147], v2 offset:4096
    v_cvt_pk_bf16_f32 v199, v246, v247
    v_mfma_f32_16x16x32_bf16 a[116:119], a[220:223], v[212:215], a[116:119]
    buffer_load_dwordx4 v1, s[20:23], s33 offen offset:2048 sc1 lds
    v_mfma_f32_16x16x32_bf16 a[120:123], a[220:223], v[216:219], a[120:123]
    v_exp_f32 v233, v137
    v_mfma_f32_16x16x32_bf16 a[124:127], a[220:223], v[220:223], a[124:127]
    s_waitcnt lgkmcnt(3)
    v_exp_f32 v234, v138
    v_mfma_f32_16x16x32_bf16 v[160:163], a[128:131], v[64:67], v[16:19]
    v_cvt_pk_bf16_f32 v200, v232, v233
    v_mfma_f32_16x16x32_bf16 v[164:167], a[128:131], v[80:83], v[20:23]
    ds_read_b128 a[148:151], v2 offset:5120
    v_or3_b32 v57, v57, v199, v200
    v_mfma_f32_16x16x32_bf16 v[168:171], a[128:131], v[96:99], v[24:27]
    v_exp_f32 v235, v139
    v_mfma_f32_16x16x32_bf16 v[172:175], a[128:131], v[112:115], v[28:31]
    s_add_u32 s36, s36, 32
    v_exp_f32 v236, v152
    v_mfma_f32_16x16x32_bf16 v[160:163], a[132:135], v[68:71], v[160:163]
    s_or_b32 s35, s35, 0x10000
    v_cvt_pk_bf16_f32 v201, v234, v235
    v_mfma_f32_16x16x32_bf16 v[164:167], a[132:135], v[84:87], v[164:167]
    ds_read_b128 a[152:155], v2 offset:6144
    v_mfma_f32_16x16x32_bf16 v[168:171], a[132:135], v[100:103], v[168:171]
    v_exp_f32 v237, v153
    v_mfma_f32_16x16x32_bf16 v[172:175], a[132:135], v[116:119], v[172:175]
    s_waitcnt lgkmcnt(3)
    v_exp_f32 v238, v154
    v_mfma_f32_16x16x32_bf16 v[160:163], a[136:139], v[72:75], v[160:163]
    s_add_u32 s52, s52, 8192
    v_cvt_pk_bf16_f32 v202, v236, v237
    v_mfma_f32_16x16x32_bf16 v[164:167], a[136:139], v[88:91], v[164:167]
    ds_read_b128 a[156:159], v2 offset:7168
    v_or3_b32 v57, v57, v201, v202
    v_mfma_f32_16x16x32_bf16 v[168:171], a[136:139], v[104:107], v[168:171]
    s_and_b32 s52, s52, 0xffff
    v_exp_f32 v239, v155
    v_mfma_f32_16x16x32_bf16 v[172:175], a[136:139], v[120:123], v[172:175]
    v_exp_f32 v240, v140
    v_mfma_f32_16x16x32_bf16 v[160:163], a[140:143], v[76:79], v[160:163]
    v_cvt_pk_bf16_f32 v203, v238, v239
    v_mfma_f32_16x16x32_bf16 v[164:167], a[140:143], v[92:95], v[164:167]
    buffer_load_dwordx4 v1, s[20:23], s33 offen offset:3072 sc1 lds
    v_mfma_f32_16x16x32_bf16 v[168:171], a[140:143], v[108:111], v[168:171]
    s_add_u32 s33, s33, 0x80000
    v_exp_f32 v241, v141
    v_mfma_f32_16x16x32_bf16 v[172:175], a[140:143], v[124:127], v[172:175]
    s_waitcnt lgkmcnt(2)
    ds_read_b128 a[192:195], v3 offset:0
    v_cvt_pk_bf16_f32 v204, v240, v241
    v_mfma_f32_16x16x32_bf16 v[176:179], a[144:147], v[64:67], v[32:35]
    v_exp_f32 v242, v142
    v_mfma_f32_16x16x32_bf16 v[180:183], a[144:147], v[80:83], v[36:39]
    v_add_u32 v2, s52, v1
    v_or3_b32 v57, v57, v203, v204
    v_mfma_f32_16x16x32_bf16 v[184:187], a[144:147], v[96:99], v[40:43]
    v_exp_f32 v243, v143
    v_mfma_f32_16x16x32_bf16 v[188:191], a[144:147], v[112:115], v[44:47]
    ds_read_b128 a[196:199], v3 offset:1024
    v_cvt_pk_bf16_f32 v205, v242, v243
    v_mfma_f32_16x16x32_bf16 v[176:179], a[148:151], v[68:71], v[176:179]
    v_exp_f32 v244, v156
    v_mfma_f32_16x16x32_bf16 v[180:183], a[148:151], v[84:87], v[180:183]
    v_exp_f32 v245, v157
    v_mfma_f32_16x16x32_bf16 v[184:187], a[148:151], v[100:103], v[184:187]
    ds_read_b128 a[200:203], v3 offset:2048
    v_mfma_f32_16x16x32_bf16 v[188:191], a[148:151], v[116:119], v[188:191]
    s_waitcnt lgkmcnt(3)
    v_exp_f32 v246, v158
    v_mfma_f32_16x16x32_bf16 v[176:179], a[152:155], v[72:75], v[176:179]
    s_sub_u32 s63, s63, 1
    v_cvt_pk_bf16_f32 v206, v244, v245
    v_mfma_f32_16x16x32_bf16 v[180:183], a[152:155], v[88:91], v[180:183]
    v_exp_f32 v247, v159
    v_mfma_f32_16x16x32_bf16 v[184:187], a[152:155], v[104:107], v[184:187]
    ds_read_b128 a[204:207], v3 offset:3072
    v_or3_b32 v57, v57, v205, v206
    v_mfma_f32_16x16x32_bf16 v[188:191], a[152:155], v[120:123], v[188:191]
    v_cvt_pk_bf16_f32 v207, v246, v247
    v_mfma_f32_16x16x32_bf16 v[176:179], a[156:159], v[76:79], v[176:179]
    v_mfma_f32_16x16x32_bf16 v[180:183], a[156:159], v[92:95], v[180:183]
    v_bitop3_b32 v57, v57, v207, s37 bitop3:0xa8
    v_cmp_ne_u32 vcc, 0, v57
    v_mfma_f32_16x16x32_bf16 v[184:187], a[156:159], v[108:111], v[184:187]
    v_mfma_f32_16x16x32_bf16 v[188:191], a[156:159], v[124:127], v[188:191]
    s_waitcnt vmcnt(8)
    s_barrier
    s_cbranch_vccnz k2_rare_89
k2_ret_90:
    s_cmp_lg_u32 s63, 0
    s_cbranch_scc1 k2_dloop_82
    v_mfma_f32_16x16x32_bf16 v[12:15], v[60:63], v[192:195], v[12:15]
    ds_read_b128 a[208:211], v3 offset:4096
    v_mfma_f32_16x16x32_bf16 v[48:51], v[60:63], v[196:199], v[48:51]
    v_exp_f32 v232, v160
    v_mfma_f32_16x16x32_bf16 v[248:251], v[60:63], v[200:203], v[248:251]
    s_add_u32 s53, s53, 8192
    buffer_store_dwordx4 a[224:227], v229, s[8:11], s58 offen offset:0 sc1
    v_mfma_f32_16x16x32_bf16 v[252:255], v[60:63], v[204:207], v[252:255]
    s_waitcnt lgkmcnt(3)
    v_exp_f32 v233, v161
    v_mfma_f32_16x16x32_bf16 a[0:3], a[192:195], v[192:195], a[0:3]
    s_and_b32 s53, s53, 0xffff
    ds_read_b128 a[212:215], v3 offset:5120
    v_cvt_pk_bf16_f32 v208, v232, v233
    v_mfma_f32_16x16x32_bf16 a[4:7], a[192:195], v[196:199], a[4:7]
    v_exp_f32 v234, v162
    v_mfma_f32_16x16x32_bf16 a[8:11], a[192:195], v[200:203], a[8:11]
    v_exp_f32 v235, v163
    v_mfma_f32_16x16x32_bf16 a[12:15], a[192:195], v[204:207], a[12:15]
    buffer_store_dwordx4 a[228:231], v229, s[8:11], s58 offen offset:256 sc1
    ds_read_b128 a[216:219], v3 offset:6144
    v_mfma_f32_16x16x32_bf16 a[16:19], a[196:199], v[192:195], a[16:19]
    v_exp_f32 v236, v176
    v_mfma_f32_16x16x32_bf16 a[20:23], a[196:199], v[196:199], a[20:23]
    v_cvt_pk_bf16_f32 v209, v234, v235
    v_mfma_f32_16x16x32_bf16 a[24:27], a[196:199], v[200:203], a[24:27]
    v_exp_f32 v237, v177
    v_mfma_f32_16x16x32_bf16 a[28:31], a[196:199], v[204:207], a[28:31]
    s_waitcnt lgkmcnt(3)
    ds_read_b128 a[220:223], v3 offset:7168
    v_cvt_pk_bf16_f32 v210, v236, v237
    v_mfma_f32_16x16x32_bf16 a[32:35], a[200:203], v[192:195], a[32:35]
    v_exp_f32 v238, v178
    v_mfma_f32_16x16x32_bf16 a[36:39], a[200:203], v[196:199], a[36:39]
    v_exp_f32 v239, v179
    v_mfma_f32_16x16x32_bf16 a[40:43], a[200:203], v[200:203], a[40:43]
    v_or3_b32 v57, v208, v209, v210
    v_mfma_f32_16x16x32_bf16 a[44:47], a[200:203], v[204:207], a[44:47]
    buffer_store_dwordx4 a[232:235], v229, s[8:11], s58 offen offset:512 sc1
    v_mfma_f32_16x16x32_bf16 a[48:51], a[204:207], v[192:195], a[48:51]
    v_exp_f32 v240, v164
    v_mfma_f32_16x16x32_bf16 a[52:55], a[204:207], v[196:199], a[52:55]
    ds_read_b128 a[128:131], v2 offset:0
    v_cvt_pk_bf16_f32 v211, v238, v239
    v_mfma_f32_16x16x32_bf16 a[56:59], a[204:207], v[200:203], a[56:59]
    v_exp_f32 v241, v165
    v_mfma_f32_16x16x32_bf16 a[60:63], a[204:207], v[204:207], a[60:63]
    s_waitcnt lgkmcnt(3)
    ds_read_b128 a[132:135], v2 offset:1024
    v_add_u32 v3, s53, v56
    v_mfma_f32_16x16x32_bf16 a[64:67], a[208:211], v[192:195], a[64:67]
    v_exp_f32 v242, v166
    v_mfma_f32_16x16x32_bf16 a[68:71], a[208:211], v[196:199], a[68:71]
    ds_read_b128 a[136:139], v2 offset:2048
    v_cvt_pk_bf16_f32 v212, v240, v241
    v_mfma_f32_16x16x32_bf16 a[72:75], a[208:211], v[200:203], a[72:75]
    v_exp_f32 v243, v167
    v_mfma_f32_16x16x32_bf16 a[76:79], a[208:211], v[204:207], a[76:79]
    ds_read_b128 a[140:143], v2 offset:3072
    v_or3_b32 v57, v57, v211, v212
    v_mfma_f32_16x16x32_bf16 a[80:83], a[212:215], v[192:195], a[80:83]
    buffer_store_dwordx4 a[236:239], v229, s[8:11], s58 offen offset:768 sc1
    ds_read_b128 a[144:147], v2 offset:4096
    v_mfma_f32_16x16x32_bf16 a[84:87], a[212:215], v[196:199], a[84:87]
    s_branch k2_prep_91
k2_prepret_92:
    v_mfma_f32_16x16x32_bf16 a[88:91], a[212:215], v[200:203], a[88:91]
    v_exp_f32 v244, v180
    v_mfma_f32_16x16x32_bf16 a[92:95], a[212:215], v[204:207], a[92:95]
    s_waitcnt lgkmcnt(5)
    ds_read_b128 a[148:151], v2 offset:5120
    v_cvt_pk_bf16_f32 v213, v242, v243
    v_mfma_f32_16x16x32_bf16 a[96:99], a[216:219], v[192:195], a[96:99]
    v_exp_f32 v245, v181
    v_mfma_f32_16x16x32_bf16 a[100:103], a[216:219], v[196:199], a[100:103]
    v_exp_f32 v246, v182
    v_mfma_f32_16x16x32_bf16 a[104:107], a[216:219], v[200:203], a[104:107]
    s_mov_b32 m0, s34
    ds_read_b128 a[152:155], v2 offset:6144
    v_cvt_pk_bf16_f32 v214, v244, v245
    v_mfma_f32_16x16x32_bf16 a[108:111], a[216:219], v[204:207], a[108:111]
    v_exp_f32 v247, v183
    v_mfma_f32_16x16x32_bf16 a[112:115], a[220:223], v[192:195], a[112:115]
    ds_read_b128 a[156:159], v2 offset:7168
    v_or3_b32 v57, v57, v213, v214
    v_mfma_f32_16x16x32_bf16 a[116:119], a[220:223], v[196:199], a[116:119]
    buffer_load_dwordx4 v1, s[16:19], s32 offen offset:0 sc1 lds
    ds_read_b128 a[160:163], v2 offset:8192
    v_mfma_f32_16x16x32_bf16 a[120:123], a[220:223], v[200:203], a[120:123]
    v_exp_f32 v232, v168
    v_mfma_f32_16x16x32_bf16 a[124:127], a[220:223], v[204:207], a[124:127]
    s_waitcnt lgkmcnt(7)
    ds_read_b128 a[164:167], v2 offset:9216
    v_cvt_pk_bf16_f32 v215, v246, v247
    v_mfma_f32_16x16x32_bf16 v[128:131], a[128:131], v[96:99], v[16:19]
    v_exp_f32 v233, v169
    v_mfma_f32_16x16x32_bf16 v[132:135], a[128:131], v[112:115], v[20:23]
    s_add_u32 s34, s34, 0x4000
    v_exp_f32 v234, v170
    v_mfma_f32_16x16x32_bf16 v[128:131], a[132:135], v[100:103], v[128:131]
    ds_read_b128 a[168:171], v2 offset:10240
    v_cvt_pk_bf16_f32 v216, v232, v233
    v_mfma_f32_16x16x32_bf16 v[132:135], a[132:135], v[116:119], v[132:135]
    s_waitcnt lgkmcnt(7)
    v_exp_f32 v235, v171
    v_mfma_f32_16x16x32_bf16 v[128:131], a[136:139], v[104:107], v[128:131]
    s_add_u32 s36, s36, 64
    ds_read_b128 a[172:175], v2 offset:11264
    v_or3_b32 v57, v57, v215, v216
    v_mfma_f32_16x16x32_bf16 v[132:135], a[136:139], v[120:123], v[132:135]
    buffer_load_dwordx4 v1, s[16:19], s32 offen offset:1024 sc1 lds
    ds_read_b128 a[176:179], v2 offset:12288
    v_mfma_f32_16x16x32_bf16 v[128:131], a[140:143], v[108:111], v[128:131]
    v_exp_f32 v236, v184
    v_mfma_f32_16x16x32_bf16 v[132:135], a[140:143], v[124:127], v[132:135]
    s_waitcnt lgkmcnt(7)
    ds_read_b128 a[180:183], v2 offset:13312
    v_cvt_pk_bf16_f32 v217, v234, v235
    v_mfma_f32_16x16x32_bf16 v[144:147], a[144:147], v[96:99], v[32:35]
    s_add_u32 s52, s52, 16384
    v_exp_f32 v237, v185
    v_mfma_f32_16x16x32_bf16 v[148:151], a[144:147], v[112:115], v[36:39]
    s_and_b32 s34, s34, 0xffff
    v_exp_f32 v238, v186
    v_mfma_f32_16x16x32_bf16 v[144:147], a[148:151], v[100:103], v[144:147]
    s_and_b32 s52, s52, 0xffff
    ds_read_b128 a[184:187], v2 offset:14336
    v_cvt_pk_bf16_f32 v218, v236, v237
    v_mfma_f32_16x16x32_bf16 v[148:151], a[148:151], v[116:119], v[148:151]
    s_waitcnt lgkmcnt(7)
    v_exp_f32 v239, v187
    v_mfma_f32_16x16x32_bf16 v[144:147], a[152:155], v[104:107], v[144:147]
    ds_read_b128 a[188:191], v2 offset:15360
    v_or3_b32 v57, v57, v217, v218
    v_mfma_f32_16x16x32_bf16 v[148:151], a[152:155], v[120:123], v[148:151]
    buffer_load_dwordx4 v1, s[16:19], s32 offen offset:2048 sc1 lds
    v_mfma_f32_16x16x32_bf16 v[144:147], a[156:159], v[108:111], v[144:147]
    v_exp_f32 v240, v172
    v_mfma_f32_16x16x32_bf16 v[148:151], a[156:159], v[124:127], v[148:151]
    s_waitcnt lgkmcnt(6)
    ds_read_b128 a[192:195], v3 offset:0
    v_cvt_pk_bf16_f32 v219, v238, v239
    v_mfma_f32_16x16x32_bf16 v[136:139], a[160:163], v[96:99], v[24:27]
    v_exp_f32 v241, v173
    v_mfma_f32_16x16x32_bf16 v[140:143], a[160:163], v[112:115], v[28:31]
    v_exp_f32 v242, v174
    v_mfma_f32_16x16x32_bf16 v[136:139], a[164:167], v[100:103], v[136:139]
    v_cvt_pk_bf16_f32 v220, v240, v241
    v_add_u32 v2, s52, v1
    v_mfma_f32_16x16x32_bf16 v[140:143], a[164:167], v[116:119], v[140:143]
    s_waitcnt lgkmcnt(5)
    v_exp_f32 v243, v175
    v_mfma_f32_16x16x32_bf16 v[136:139], a[168:171], v[104:107], v[136:139]
    ds_read_b128 a[196:199], v3 offset:1024
    v_or3_b32 v57, v57, v219, v220
    v_mfma_f32_16x16x32_bf16 v[140:143], a[168:171], v[120:123], v[140:143]
    buffer_load_dwordx4 v1, s[16:19], s32 offen offset:3072 sc1 lds
    ds_read_b128 a[200:203], v3 offset:2048
    v_mfma_f32_16x16x32_bf16 v[136:139], a[172:175], v[108:111], v[136:139]
    s_add_u32 s32, s32, 0x80000
    v_exp_f32 v244, v188
    v_mfma_f32_16x16x32_bf16 v[140:143], a[172:175], v[124:127], v[140:143]
    s_waitcnt lgkmcnt(5)
    v_cvt_pk_bf16_f32 v221, v242, v243
    v_mfma_f32_16x16x32_bf16 v[152:155], a[176:179], v[96:99], v[40:43]
    v_exp_f32 v245, v189
    v_mfma_f32_16x16x32_bf16 v[156:159], a[176:179], v[112:115], v[44:47]
    v_exp_f32 v246, v190
    v_mfma_f32_16x16x32_bf16 v[152:155], a[180:183], v[100:103], v[152:155]
    ds_read_b128 a[204:207], v3 offset:3072
    v_cvt_pk_bf16_f32 v222, v244, v245
    v_mfma_f32_16x16x32_bf16 v[156:159], a[180:183], v[116:119], v[156:159]
    s_waitcnt lgkmcnt(4)
    v_exp_f32 v247, v191
    v_mfma_f32_16x16x32_bf16 v[152:155], a[184:187], v[104:107], v[152:155]
    v_or3_b32 v57, v57, v221, v222
    v_cvt_pk_bf16_f32 v223, v246, v247
    v_mfma_f32_16x16x32_bf16 v[156:159], a[184:187], v[120:123], v[156:159]
    v_bitop3_b32 v57, v57, v223, s37 bitop3:0xa8
    v_cmp_ne_u32 vcc, 0, v57
    v_mfma_f32_16x16x32_bf16 v[152:155], a[188:191], v[108:111], v[152:155]
    v_mfma_f32_16x16x32_bf16 v[156:159], a[188:191], v[124:127], v[156:159]
    s_cbranch_vccnz k2_rare_93
k2_ret_94:
    v_mfma_f32_16x16x32_bf16 v[12:15], v[60:63], v[208:211], v[12:15]
    ds_read_b128 a[208:211], v3 offset:4096
    v_mfma_f32_16x16x32_bf16 v[48:51], v[60:63], v[212:215], v[48:51]
    s_mov_b32 m0, s35
    v_exp_f32 v232, v128
    v_mfma_f32_16x16x32_bf16 v[248:251], v[60:63], v[216:219], v[248:251]
    s_add_u32 s53, s53, 8192
    buffer_load_dwordx4 v1, s[20:23], s33 offen offset:0 sc1 lds
    v_mfma_f32_16x16x32_bf16 v[252:255], v[60:63], v[220:223], v[252:255]
    s_waitcnt lgkmcnt(3)
    v_exp_f32 v233, v129
    v_mfma_f32_16x16x32_bf16 a[0:3], a[192:195], v[208:211], a[0:3]
    s_and_b32 s53, s53, 0xffff
    ds_read_b128 a[212:215], v3 offset:5120
    v_cvt_pk_bf16_f32 v192, v232, v233
    v_mfma_f32_16x16x32_bf16 a[4:7], a[192:195], v[212:215], a[4:7]
    v_exp_f32 v234, v130
    v_mfma_f32_16x16x32_bf16 a[8:11], a[192:195], v[216:219], a[8:11]
    v_exp_f32 v235, v131
    v_mfma_f32_16x16x32_bf16 a[12:15], a[192:195], v[220:223], a[12:15]
    ds_read_b128 a[216:219], v3 offset:6144
    v_cvt_pk_bf16_f32 v193, v234, v235
    v_mfma_f32_16x16x32_bf16 a[16:19], a[196:199], v[208:211], a[16:19]
    s_add_u32 s35, s35, 0x4000
    v_exp_f32 v236, v144
    v_mfma_f32_16x16x32_bf16 a[20:23], a[196:199], v[212:215], a[20:23]
    v_exp_f32 v237, v145
    v_mfma_f32_16x16x32_bf16 a[24:27], a[196:199], v[216:219], a[24:27]
    buffer_load_dwordx4 v1, s[20:23], s33 offen offset:1024 sc1 lds
    v_mfma_f32_16x16x32_bf16 a[28:31], a[196:199], v[220:223], a[28:31]
    s_waitcnt lgkmcnt(3)
    ds_read_b128 a[220:223], v3 offset:7168
    v_cvt_pk_bf16_f32 v194, v236, v237
    v_mfma_f32_16x16x32_bf16 a[32:35], a[200:203], v[208:211], a[32:35]
    v_exp_f32 v238, v146
    v_mfma_f32_16x16x32_bf16 a[36:39], a[200:203], v[212:215], a[36:39]
    v_exp_f32 v239, v147
    v_mfma_f32_16x16x32_bf16 a[40:43], a[200:203], v[216:219], a[40:43]
    v_or3_b32 v57, v192, v193, v194
    v_mfma_f32_16x16x32_bf16 a[44:47], a[200:203], v[220:223], a[44:47]
    v_exp_f32 v240, v132
    v_mfma_f32_16x16x32_bf16 a[48:51], a[204:207], v[208:211], a[48:51]
    s_and_b32 s35, s35, 0xffff
    v_cvt_pk_bf16_f32 v195, v238, v239
    v_mfma_f32_16x16x32_bf16 a[52:55], a[204:207], v[212:215], a[52:55]
    buffer_load_dwordx4 v1, s[20:23], s33 offen offset:2048 sc1 lds
    ds_read_b128 a[128:131], v2 offset:0
    v_mfma_f32_16x16x32_bf16 a[56:59], a[204:207], v[216:219], a[56:59]
    v_exp_f32 v241, v133
    v_mfma_f32_16x16x32_bf16 a[60:63], a[204:207], v[220:223], a[60:63]
    s_waitcnt lgkmcnt(3)
    ds_read_b128 a[132:135], v2 offset:1024
    v_add_u32 v3, s53, v56
    v_mfma_f32_16x16x32_bf16 a[64:67], a[208:211], v[208:211], a[64:67]
    v_exp_f32 v242, v134
    v_mfma_f32_16x16x32_bf16 a[68:71], a[208:211], v[212:215], a[68:71]
    s_or_b32 s35, s35, 0x10000
    ds_read_b128 a[136:139], v2 offset:2048
    v_cvt_pk_bf16_f32 v196, v240, v241
    v_mfma_f32_16x16x32_bf16 a[72:75], a[208:211], v[216:219], a[72:75]
    v_exp_f32 v243, v135
    v_mfma_f32_16x16x32_bf16 a[76:79], a[208:211], v[220:223], a[76:79]
    ds_read_b128 a[140:143], v2 offset:3072
    v_or3_b32 v57, v57, v195, v196
    v_mfma_f32_16x16x32_bf16 a[80:83], a[212:215], v[208:211], a[80:83]
    s_cmp_ge_u32 s36, s43
    s_cbranch_scc1 k2_prep_95
k2_prepret_96:
    v_mfma_f32_16x16x32_bf16 a[84:87], a[212:215], v[212:215], a[84:87]
    v_exp_f32 v244, v148
    v_mfma_f32_16x16x32_bf16 a[88:91], a[212:215], v[216:219], a[88:91]
    ds_read_b128 a[144:147], v2 offset:4096
    v_cvt_pk_bf16_f32 v197, v242, v243
    v_mfma_f32_16x16x32_bf16 a[92:95], a[212:215], v[220:223], a[92:95]
    s_waitcnt lgkmcnt(5)
    v_exp_f32 v245, v149
    v_mfma_f32_16x16x32_bf16 a[96:99], a[216:219], v[208:211], a[96:99]
    buffer_load_dwordx4 v1, s[20:23], s33 offen offset:3072 sc1 lds
    ds_read_b128 a[148:151], v2 offset:5120
    v_mfma_f32_16x16x32_bf16 a[100:103], a[216:219], v[212:215], a[100:103]
    s_add_u32 s33, s33, 0x80000
    v_exp_f32 v246, v150
    v_mfma_f32_16x16x32_bf16 a[104:107], a[216:219], v[216:219], a[104:107]
    ds_read_b128 a[152:155], v2 offset:6144
    v_cvt_pk_bf16_f32 v198, v244, v245
    v_mfma_f32_16x16x32_bf16 a[108:111], a[216:219], v[220:223], a[108:111]
    v_exp_f32 v247, v151
    v_mfma_f32_16x16x32_bf16 a[112:115], a[220:223], v[208:211], a[112:115]
    ds_read_b128 a[156:159], v2 offset:7168
    v_or3_b32 v57, v57, v197, v198
    v_mfma_f32_16x16x32_bf16 a[116:119], a[220:223], v[212:215], a[116:119]
    v_exp_f32 v232, v136
    v_mfma_f32_16x16x32_bf16 a[120:123], a[220:223], v[216:219], a[120:123]
    ds_read_b128 a[160:163], v2 offset:8192
    v_cvt_pk_bf16_f32 v199, v246, v247
    v_mfma_f32_16x16x32_bf16 a[124:127], a[220:223], v[220:223], a[124:127]
    s_waitcnt lgkmcnt(7)
    v_exp_f32 v233, v137
    v_mfma_f32_16x16x32_bf16 v[160:163], a[128:131], v[96:99], v[16:19]
    s_waitcnt vmcnt(12)
    s_barrier
    ds_read_b128 a[164:167], v2 offset:9216
    v_cvt_pk_bf16_f32 v200, v232, v233
    v_mfma_f32_16x16x32_bf16 v[164:167], a[128:131], v[112:115], v[20:23]
    s_mov_b32 m0, s34
    v_exp_f32 v234, v138
    v_mfma_f32_16x16x32_bf16 v[160:163], a[132:135], v[100:103], v[160:163]
    buffer_load_dwordx4 v1, s[16:19], s32 offen offset:0 sc1 lds
    ds_read_b128 a[168:171], v2 offset:10240
    v_mfma_f32_16x16x32_bf16 v[164:167], a[132:135], v[116:119], v[164:167]
    s_waitcnt lgkmcnt(7)
    v_exp_f32 v235, v139
    v_mfma_f32_16x16x32_bf16 v[160:163], a[136:139], v[104:107], v[160:163]
    s_add_u32 s36, s36, 64
    ds_read_b128 a[172:175], v2 offset:11264
    v_or3_b32 v57, v57, v199, v200
    v_mfma_f32_16x16x32_bf16 v[164:167], a[136:139], v[120:123], v[164:167]
    v_exp_f32 v236, v152
    v_mfma_f32_16x16x32_bf16 v[160:163], a[140:143], v[108:111], v[160:163]
    ds_read_b128 a[176:179], v2 offset:12288
    v_cvt_pk_bf16_f32 v201, v234, v235
    v_mfma_f32_16x16x32_bf16 v[164:167], a[140:143], v[124:127], v[164:167]
    s_waitcnt lgkmcnt(7)
    v_exp_f32 v237, v153
    v_mfma_f32_16x16x32_bf16 v[176:179], a[144:147], v[96:99], v[32:35]
    s_add_u32 s34, s34, 0x4000
    ds_read_b128 a[180:183], v2 offset:13312
    v_cvt_pk_bf16_f32 v202, v236, v237
    v_mfma_f32_16x16x32_bf16 v[180:183], a[144:147], v[112:115], v[36:39]
    s_add_u32 s52, s52, 16384
    v_exp_f32 v238, v154
    v_mfma_f32_16x16x32_bf16 v[176:179], a[148:151], v[100:103], v[176:179]
    s_and_b32 s52, s52, 0xffff
    buffer_load_dwordx4 v1, s[16:19], s32 offen offset:1024 sc1 lds
    ds_read_b128 a[184:187], v2 offset:14336
    v_mfma_f32_16x16x32_bf16 v[180:183], a[148:151], v[116:119], v[180:183]
    s_waitcnt lgkmcnt(7)
    v_exp_f32 v239, v155
    v_mfma_f32_16x16x32_bf16 v[176:179], a[152:155], v[104:107], v[176:179]
    ds_read_b128 a[188:191], v2 offset:15360
    v_or3_b32 v57, v57, v201, v202
    v_mfma_f32_16x16x32_bf16 v[180:183], a[152:155], v[120:123], v[180:183]
    v_exp_f32 v240, v140
    v_mfma_f32_16x16x32_bf16 v[176:179], a[156:159], v[108:111], v[176:179]
    s_and_b32 s34, s34, 0xffff
    v_cvt_pk_bf16_f32 v203, v238, v239
    v_mfma_f32_16x16x32_bf16 v[180:183], a[156:159], v[124:127], v[180:183]
    s_waitcnt lgkmcnt(6)
    v_exp_f32 v241, v141
    v_mfma_f32_16x16x32_bf16 v[168:171], a[160:163], v[96:99], v[24:27]
    ds_read_b128 a[192:195], v3 offset:0
    v_cvt_pk_bf16_f32 v204, v240, v241
    v_mfma_f32_16x16x32_bf16 v[172:175], a[160:163], v[112:115], v[28:31]
    v_exp_f32 v242, v142
    v_mfma_f32_16x16x32_bf16 v[168:171], a[164:167], v[100:103], v[168:171]
    buffer_load_dwordx4 v1, s[16:19], s32 offen offset:2048 sc1 lds
    ds_read_b128 a[196:199], v3 offset:1024
    v_mfma_f32_16x16x32_bf16 v[172:175], a[164:167], v[116:119], v[172:175]
    s_waitcnt lgkmcnt(6)
    v_add_u32 v2, s52, v1
    v_or3_b32 v57, v57, v203, v204
    v_mfma_f32_16x16x32_bf16 v[168:171], a[168:171], v[104:107], v[168:171]
    v_exp_f32 v243, v143
    v_mfma_f32_16x16x32_bf16 v[172:175], a[168:171], v[120:123], v[172:175]
    ds_read_b128 a[200:203], v3 offset:2048
    v_cvt_pk_bf16_f32 v205, v242, v243
    v_mfma_f32_16x16x32_bf16 v[168:171], a[172:175], v[108:111], v[168:171]
    v_exp_f32 v244, v156
    v_mfma_f32_16x16x32_bf16 v[172:175], a[172:175], v[124:127], v[172:175]
    s_waitcnt lgkmcnt(5)
    ds_read_b128 a[204:207], v3 offset:3072
    ds_read_b128 a[208:211], v3 offset:4096
    v_mfma_f32_16x16x32_bf16 v[184:187], a[176:179], v[96:99], v[40:43]
    v_exp_f32 v245, v157
    v_mfma_f32_16x16x32_bf16 v[188:191], a[176:179], v[112:115], v[44:47]
    buffer_load_dwordx4 v1, s[16:19], s32 offen offset:3072 sc1 lds
    ds_read_b128 a[212:215], v3 offset:5120
    v_mfma_f32_16x16x32_bf16 v[184:187], a[180:183], v[100:103], v[184:187]
    s_add_u32 s32, s32, 0x80000
    v_exp_f32 v246, v158
    v_mfma_f32_16x16x32_bf16 v[188:191], a[180:183], v[116:119], v[188:191]
    s_waitcnt lgkmcnt(6)
    ds_read_b128 a[216:219], v3 offset:6144
    v_cvt_pk_bf16_f32 v206, v244, v245
    v_mfma_f32_16x16x32_bf16 v[184:187], a[184:187], v[104:107], v[184:187]
    v_exp_f32 v247, v159
    v_mfma_f32_16x16x32_bf16 v[188:191], a[184:187], v[120:123], v[188:191]
    ds_read_b128 a[220:223], v3 offset:7168
    v_or3_b32 v57, v57, v205, v206
    v_mfma_f32_16x16x32_bf16 v[184:187], a[188:191], v[108:111], v[184:187]
    v_cvt_pk_bf16_f32 v207, v246, v247
    v_bitop3_b32 v57, v57, v207, s37 bitop3:0xa8
    v_mfma_f32_16x16x32_bf16 v[188:191], a[188:191], v[124:127], v[188:191]
    v_cmp_ne_u32 vcc, 0, v57
    s_cbranch_vccnz k2_rare_97
k2_ret_98:
    s_lshl_b32 s31, s28, 19
    s_lshl_b32 s44, s38, 6
    s_add_u32 s44, s44, s31
    s_add_u32 s45, s44, 131072
    s_add_u32 s46, s44, 262144
    s_add_u32 s47, s44, 393216
    v_mov_b32 v13, v12
    v_mov_b32 v49, v48
    s_nop 1
    v_permlane16_swap_b32 v12, v13
    v_permlane16_swap_b32 v48, v49
    s_nop 1
    v_add_f32 v12, v12, v13
    v_add_f32 v48, v48, v49
    v_mov_b32 v13, v12
    v_mov_b32 v49, v48
    s_nop 1
    v_permlane32_swap_b32 v12, v13
    v_permlane32_swap_b32 v48, v49
    s_nop 1
    v_add_f32 v12, v12, v13
    v_add_f32 v48, v48, v49
    v_rcp_f32 v13, v12
    v_rcp_f32 v49, v48
    v_rcp_f32 v12, v12
    v_rcp_f32 v48, v48
    s_nop 0
    v_accvgpr_read_b32 v68, a0
    v_accvgpr_read_b32 v69, a1
    v_accvgpr_read_b32 v70, a2
    v_accvgpr_read_b32 v71, a3
    v_accvgpr_read_b32 v72, a16
    v_accvgpr_read_b32 v73, a17
    v_accvgpr_read_b32 v74, a18
    v_accvgpr_read_b32 v75, a19
    v_pk_mul_f32 v[68:69], v[68:69], v[12:13]
    v_pk_mul_f32 v[70:71], v[70:71], v[12:13]
    v_pk_mul_f32 v[72:73], v[72:73], v[12:13]
    v_pk_mul_f32 v[74:75], v[74:75], v[12:13]
    v_cvt_pk_bf16_f32 v64, v68, v69
    v_cvt_pk_bf16_f32 v65, v70, v71
    v_cvt_pk_bf16_f32 v66, v72, v73
    v_cvt_pk_bf16_f32 v67, v74, v75
    buffer_store_dwordx4 v[64:67], v1, s[24:27], s44 offen offset:0 sc1
    v_accvgpr_read_b32 v80, a32
    v_accvgpr_read_b32 v81, a33
    v_accvgpr_read_b32 v82, a34
    v_accvgpr_read_b32 v83, a35
    v_accvgpr_read_b32 v84, a48
    v_accvgpr_read_b32 v85, a49
    v_accvgpr_read_b32 v86, a50
    v_accvgpr_read_b32 v87, a51
    v_pk_mul_f32 v[80:81], v[80:81], v[12:13]
    v_pk_mul_f32 v[82:83], v[82:83], v[12:13]
    v_pk_mul_f32 v[84:85], v[84:85], v[12:13]
    v_pk_mul_f32 v[86:87], v[86:87], v[12:13]
    v_cvt_pk_bf16_f32 v76, v80, v81
    v_cvt_pk_bf16_f32 v77, v82, v83
    v_cvt_pk_bf16_f32 v78, v84, v85
    v_cvt_pk_bf16_f32 v79, v86, v87
    buffer_store_dwordx4 v[76:79], v1, s[24:27], s45 offen offset:0 sc1
    v_accvgpr_read_b32 v68, a64
    v_accvgpr_read_b32 v69, a65
    v_accvgpr_read_b32 v70, a66
    v_accvgpr_read_b32 v71, a67
    v_accvgpr_read_b32 v72, a80
    v_accvgpr_read_b32 v73, a81
    v_accvgpr_read_b32 v74, a82
    v_accvgpr_read_b32 v75, a83
    v_pk_mul_f32 v[68:69], v[68:69], v[12:13]
    v_pk_mul_f32 v[70:71], v[70:71], v[12:13]
    v_pk_mul_f32 v[72:73], v[72:73], v[12:13]
    v_pk_mul_f32 v[74:75], v[74:75], v[12:13]
    v_cvt_pk_bf16_f32 v64, v68, v69
    v_cvt_pk_bf16_f32 v65, v70, v71
    v_cvt_pk_bf16_f32 v66, v72, v73
    v_cvt_pk_bf16_f32 v67, v74, v75
    buffer_store_dwordx4 v[64:67], v1, s[24:27], s46 offen offset:0 sc1
    v_accvgpr_read_b32 v80, a96
    v_accvgpr_read_b32 v81, a97
    v_accvgpr_read_b32 v82, a98
    v_accvgpr_read_b32 v83, a99
    v_accvgpr_read_b32 v84, a112
    v_accvgpr_read_b32 v85, a113
    v_accvgpr_read_b32 v86, a114
    v_accvgpr_read_b32 v87, a115
    v_pk_mul_f32 v[80:81], v[80:81], v[12:13]
    v_pk_mul_f32 v[82:83], v[82:83], v[12:13]
    v_pk_mul_f32 v[84:85], v[84:85], v[12:13]
    v_pk_mul_f32 v[86:87], v[86:87], v[12:13]
    v_cvt_pk_bf16_f32 v76, v80, v81
    v_cvt_pk_bf16_f32 v77, v82, v83
    v_cvt_pk_bf16_f32 v78, v84, v85
    v_cvt_pk_bf16_f32 v79, v86, v87
    buffer_store_dwordx4 v[76:79], v1, s[24:27], s47 offen offset:0 sc1
    v_accvgpr_read_b32 v68, a4
    v_accvgpr_read_b32 v69, a5
    v_accvgpr_read_b32 v70, a6
    v_accvgpr_read_b32 v71, a7
    v_accvgpr_read_b32 v72, a20
    v_accvgpr_read_b32 v73, a21
    v_accvgpr_read_b32 v74, a22
    v_accvgpr_read_b32 v75, a23
    v_pk_mul_f32 v[68:69], v[68:69], v[48:49]
    v_pk_mul_f32 v[70:71], v[70:71], v[48:49]
    v_pk_mul_f32 v[72:73], v[72:73], v[48:49]
    v_pk_mul_f32 v[74:75], v[74:75], v[48:49]
    v_cvt_pk_bf16_f32 v64, v68, v69
    v_cvt_pk_bf16_f32 v65, v70, v71
    v_cvt_pk_bf16_f32 v66, v72, v73
    v_cvt_pk_bf16_f32 v67, v74, v75
    buffer_store_dwordx4 v[64:67], v1, s[24:27], s44 offen offset:1024 sc1
    v_accvgpr_read_b32 v80, a36
    v_accvgpr_read_b32 v81, a37
    v_accvgpr_read_b32 v82, a38
    v_accvgpr_read_b32 v83, a39
    v_accvgpr_read_b32 v84, a52
    v_accvgpr_read_b32 v85, a53
    v_accvgpr_read_b32 v86, a54
    v_accvgpr_read_b32 v87, a55
    v_pk_mul_f32 v[80:81], v[80:81], v[48:49]
    v_pk_mul_f32 v[82:83], v[82:83], v[48:49]
    v_pk_mul_f32 v[84:85], v[84:85], v[48:49]
    v_pk_mul_f32 v[86:87], v[86:87], v[48:49]
    v_cvt_pk_bf16_f32 v76, v80, v81
    v_cvt_pk_bf16_f32 v77, v82, v83
    v_cvt_pk_bf16_f32 v78, v84, v85
    v_cvt_pk_bf16_f32 v79, v86, v87
    buffer_store_dwordx4 v[76:79], v1, s[24:27], s45 offen offset:1024 sc1
    v_accvgpr_read_b32 v68, a68
    v_accvgpr_read_b32 v69, a69
    v_accvgpr_read_b32 v70, a70
    v_accvgpr_read_b32 v71, a71
    v_accvgpr_read_b32 v72, a84
    v_accvgpr_read_b32 v73, a85
    v_accvgpr_read_b32 v74, a86
    v_accvgpr_read_b32 v75, a87
    v_pk_mul_f32 v[68:69], v[68:69], v[48:49]
    v_pk_mul_f32 v[70:71], v[70:71], v[48:49]
    v_pk_mul_f32 v[72:73], v[72:73], v[48:49]
    v_pk_mul_f32 v[74:75], v[74:75], v[48:49]
    v_cvt_pk_bf16_f32 v64, v68, v69
    v_cvt_pk_bf16_f32 v65, v70, v71
    v_cvt_pk_bf16_f32 v66, v72, v73
    v_cvt_pk_bf16_f32 v67, v74, v75
    buffer_store_dwordx4 v[64:67], v1, s[24:27], s46 offen offset:1024 sc1
    v_accvgpr_read_b32 v80, a100
    v_accvgpr_read_b32 v81, a101
    v_accvgpr_read_b32 v82, a102
    v_accvgpr_read_b32 v83, a103
    v_accvgpr_read_b32 v84, a116
    v_accvgpr_read_b32 v85, a117
    v_accvgpr_read_b32 v86, a118
    v_accvgpr_read_b32 v87, a119
    v_pk_mul_f32 v[80:81], v[80:81], v[48:49]
    v_pk_mul_f32 v[82:83], v[82:83], v[48:49]
    v_pk_mul_f32 v[84:85], v[84:85], v[48:49]
    v_pk_mul_f32 v[86:87], v[86:87], v[48:49]
    v_cvt_pk_bf16_f32 v76, v80, v81
    v_cvt_pk_bf16_f32 v77, v82, v83
    v_cvt_pk_bf16_f32 v78, v84, v85
    v_cvt_pk_bf16_f32 v79, v86, v87
    buffer_store_dwordx4 v[76:79], v1, s[24:27], s47 offen offset:1024 sc1
    s_lshl_b32 s63, s29, 1
    s_sub_u32 s63, 14, s63
    s_cmp_eq_u32 s63, 0
    s_cbranch_scc1 k2_sdone_100
k2_sloop_99:
    v_mfma_f32_16x16x32_bf16 v[248:251], v[60:63], v[192:195], v[248:251]
    ds_read_b128 a[224:227], v3 offset:8192
    v_mfma_f32_16x16x32_bf16 v[252:255], v[60:63], v[196:199], v[252:255]
    s_mov_b32 m0, s35
    v_exp_f32 v232, v160
    v_mfma_f32_16x16x32_bf16 v[248:251], v[60:63], v[200:203], v[248:251]
    s_add_u32 s53, s53, 16384
    buffer_load_dwordx4 v1, s[20:23], s33 offen offset:0 sc1 lds
    ds_read_b128 a[228:231], v3 offset:9216
    v_mfma_f32_16x16x32_bf16 v[252:255], v[60:63], v[204:207], v[252:255]
    s_waitcnt lgkmcnt(8)
    v_exp_f32 v233, v161
    v_mfma_f32_16x16x32_bf16 a[8:11], a[192:195], v[192:195], a[8:11]
    s_and_b32 s53, s53, 0xffff
    ds_read_b128 a[232:235], v3 offset:10240
    v_cvt_pk_bf16_f32 v208, v232, v233
    v_mfma_f32_16x16x32_bf16 a[12:15], a[192:195], v[196:199], a[12:15]
    v_exp_f32 v234, v162
    v_mfma_f32_16x16x32_bf16 a[24:27], a[196:199], v[192:195], a[24:27]
    ds_read_b128 a[236:239], v3 offset:11264
    v_mfma_f32_16x16x32_bf16 a[28:31], a[196:199], v[196:199], a[28:31]
    s_waitcnt lgkmcnt(8)
    v_exp_f32 v235, v163
    v_mfma_f32_16x16x32_bf16 a[40:43], a[200:203], v[192:195], a[40:43]
    s_add_u32 s35, s35, 0x4000
    ds_read_b128 a[240:243], v3 offset:12288
    v_cvt_pk_bf16_f32 v209, v234, v235
    v_mfma_f32_16x16x32_bf16 a[44:47], a[200:203], v[196:199], a[44:47]
    v_exp_f32 v236, v176
    v_mfma_f32_16x16x32_bf16 a[56:59], a[204:207], v[192:195], a[56:59]
    buffer_load_dwordx4 v1, s[20:23], s33 offen offset:1024 sc1 lds
    ds_read_b128 a[244:247], v3 offset:13312
    v_mfma_f32_16x16x32_bf16 a[60:63], a[204:207], v[196:199], a[60:63]
    s_waitcnt lgkmcnt(8)
    v_exp_f32 v237, v177
    v_mfma_f32_16x16x32_bf16 a[72:75], a[208:211], v[192:195], a[72:75]
    ds_read_b128 a[248:251], v3 offset:14336
    v_cvt_pk_bf16_f32 v210, v236, v237
    v_mfma_f32_16x16x32_bf16 a[76:79], a[208:211], v[196:199], a[76:79]
    v_exp_f32 v238, v178
    v_mfma_f32_16x16x32_bf16 a[88:91], a[212:215], v[192:195], a[88:91]
    ds_read_b128 a[252:255], v3 offset:15360
    v_or3_b32 v57, v208, v209, v210
    v_mfma_f32_16x16x32_bf16 a[92:95], a[212:215], v[196:199], a[92:95]
    s_waitcnt lgkmcnt(8)
    v_exp_f32 v239, v179
    v_mfma_f32_16x16x32_bf16 a[104:107], a[216:219], v[192:195], a[104:107]
    s_and_b32 s35, s35, 0xffff
    v_exp_f32 v240, v164
    v_mfma_f32_16x16x32_bf16 a[108:111], a[216:219], v[196:199], a[108:111]
    ds_read_b128 a[128:131], v2 offset:0
    v_cvt_pk_bf16_f32 v211, v238, v239
    v_mfma_f32_16x16x32_bf16 a[120:123], a[220:223], v[192:195], a[120:123]
    v_exp_f32 v241, v165
    v_mfma_f32_16x16x32_bf16 a[124:127], a[220:223], v[196:199], a[124:127]
    s_waitcnt lgkmcnt(7)
    buffer_load_dwordx4 v1, s[20:23], s33 offen offset:2048 sc1 lds
    ds_read_b128 a[132:135], v2 offset:1024
    v_mfma_f32_16x16x32_bf16 a[8:11], a[224:227], v[200:203], a[8:11]
    v_add_u32 v3, s53, v56
    v_cvt_pk_bf16_f32 v212, v240, v241
    v_mfma_f32_16x16x32_bf16 a[12:15], a[224:227], v[204:207], a[12:15]
    s_or_b32 s35, s35, 0x10000
    v_exp_f32 v242, v166
    v_mfma_f32_16x16x32_bf16 a[24:27], a[228:231], v[200:203], a[24:27]
    ds_read_b128 a[136:139], v2 offset:2048
    v_or3_b32 v57, v57, v211, v212
    v_mfma_f32_16x16x32_bf16 a[28:31], a[228:231], v[204:207], a[28:31]
    s_waitcnt lgkmcnt(7)
    v_exp_f32 v243, v167
    v_mfma_f32_16x16x32_bf16 a[40:43], a[232:235], v[200:203], a[40:43]
    ds_read_b128 a[140:143], v2 offset:3072
    v_cvt_pk_bf16_f32 v213, v242, v243
    v_mfma_f32_16x16x32_bf16 a[44:47], a[232:235], v[204:207], a[44:47]
    s_cmp_ge_u32 s36, s43
    s_cbranch_scc1 k2_prep_101
k2_prepret_102:
    v_mfma_f32_16x16x32_bf16 a[56:59], a[236:239], v[200:203], a[56:59]
    v_exp_f32 v244, v180
    v_mfma_f32_16x16x32_bf16 a[60:63], a[236:239], v[204:207], a[60:63]
    s_waitcnt lgkmcnt(6)
    buffer_load_dwordx4 v1, s[20:23], s33 offen offset:3072 sc1 lds
    ds_read_b128 a[144:147], v2 offset:4096
    v_mfma_f32_16x16x32_bf16 a[72:75], a[240:243], v[200:203], a[72:75]
    s_add_u32 s33, s33, 0x80000
    v_exp_f32 v245, v181
    v_mfma_f32_16x16x32_bf16 a[76:79], a[240:243], v[204:207], a[76:79]
    ds_read_b128 a[148:151], v2 offset:5120
    v_cvt_pk_bf16_f32 v214, v244, v245
    v_mfma_f32_16x16x32_bf16 a[88:91], a[244:247], v[200:203], a[88:91]
    v_exp_f32 v246, v182
    v_mfma_f32_16x16x32_bf16 a[92:95], a[244:247], v[204:207], a[92:95]
    s_waitcnt lgkmcnt(6)
    ds_read_b128 a[152:155], v2 offset:6144
    v_or3_b32 v57, v57, v213, v214
    v_mfma_f32_16x16x32_bf16 a[104:107], a[248:251], v[200:203], a[104:107]
    v_exp_f32 v247, v183
    v_mfma_f32_16x16x32_bf16 a[108:111], a[248:251], v[204:207], a[108:111]
    ds_read_b128 a[156:159], v2 offset:7168
    v_cvt_pk_bf16_f32 v215, v246, v247
    v_mfma_f32_16x16x32_bf16 a[120:123], a[252:255], v[200:203], a[120:123]
    v_exp_f32 v232, v168
    v_mfma_f32_16x16x32_bf16 a[124:127], a[252:255], v[204:207], a[124:127]
    s_waitcnt lgkmcnt(6)
    ds_read_b128 a[160:163], v2 offset:8192
    ds_read_b128 a[164:167], v2 offset:9216
    v_mfma_f32_16x16x32_bf16 v[128:131], a[128:131], v[96:99], v[16:19]
    s_waitcnt vmcnt(12)
    s_barrier
    v_exp_f32 v233, v169
    v_mfma_f32_16x16x32_bf16 v[132:135], a[128:131], v[112:115], v[20:23]
    s_mov_b32 m0, s34
    v_exp_f32 v234, v170
    v_mfma_f32_16x16x32_bf16 v[128:131], a[132:135], v[100:103], v[128:131]
    ds_read_b128 a[168:171], v2 offset:10240
    v_cvt_pk_bf16_f32 v216, v232, v233
    v_mfma_f32_16x16x32_bf16 v[132:135], a[132:135], v[116:119], v[132:135]
    s_waitcnt lgkmcnt(7)
    buffer_load_dwordx4 v1, s[16:19], s32 offen offset:0 sc1 lds
    ds_read_b128 a[172:175], v2 offset:11264
    v_mfma_f32_16x16x32_bf16 v[128:131], a[136:139], v[104:107], v[128:131]
    s_add_u32 s36, s36, 64
    v_exp_f32 v235, v171
    v_mfma_f32_16x16x32_bf16 v[132:135], a[136:139], v[120:123], v[132:135]
    v_or3_b32 v57, v57, v215, v216
    v_cvt_pk_bf16_f32 v217, v234, v235
    v_mfma_f32_16x16x32_bf16 v[128:131], a[140:143], v[108:111], v[128:131]
    v_exp_f32 v236, v184
    v_mfma_f32_16x16x32_bf16 v[132:135], a[140:143], v[124:127], v[132:135]
    s_waitcnt lgkmcnt(6)
    ds_read_b128 a[176:179], v2 offset:12288
    ds_read_b128 a[180:183], v2 offset:13312
    v_mfma_f32_16x16x32_bf16 v[144:147], a[144:147], v[96:99], v[32:35]
    s_add_u32 s34, s34, 0x4000
    v_exp_f32 v237, v185
    v_mfma_f32_16x16x32_bf16 v[148:151], a[144:147], v[112:115], v[36:39]
    s_add_u32 s52, s52, 16384
    v_exp_f32 v238, v186
    v_mfma_f32_16x16x32_bf16 v[144:147], a[148:151], v[100:103], v[144:147]
    s_and_b32 s52, s52, 0xffff
    ds_read_b128 a[184:187], v2 offset:14336
    v_cvt_pk_bf16_f32 v218, v236, v237
    v_mfma_f32_16x16x32_bf16 v[148:151], a[148:151], v[116:119], v[148:151]
    s_waitcnt lgkmcnt(7)
    buffer_load_dwordx4 v1, s[16:19], s32 offen offset:1024 sc1 lds
    ds_read_b128 a[188:191], v2 offset:15360
    v_mfma_f32_16x16x32_bf16 v[144:147], a[152:155], v[104:107], v[144:147]
    v_exp_f32 v239, v187
    v_mfma_f32_16x16x32_bf16 v[148:151], a[152:155], v[120:123], v[148:151]
    v_or3_b32 v57, v57, v217, v218
    v_cvt_pk_bf16_f32 v219, v238, v239
    v_mfma_f32_16x16x32_bf16 v[144:147], a[156:159], v[108:111], v[144:147]
    s_and_b32 s34, s34, 0xffff
    v_exp_f32 v240, v172
    v_mfma_f32_16x16x32_bf16 v[148:151], a[156:159], v[124:127], v[148:151]
    s_waitcnt lgkmcnt(6)
    v_exp_f32 v241, v173
    v_mfma_f32_16x16x32_bf16 v[136:139], a[160:163], v[96:99], v[24:27]
    ds_read_b128 a[192:195], v3 offset:0
    v_cvt_pk_bf16_f32 v220, v240, v241
    v_mfma_f32_16x16x32_bf16 v[140:143], a[160:163], v[112:115], v[28:31]
    v_exp_f32 v242, v174
    v_mfma_f32_16x16x32_bf16 v[136:139], a[164:167], v[100:103], v[136:139]
    buffer_load_dwordx4 v1, s[16:19], s32 offen offset:2048 sc1 lds
    ds_read_b128 a[196:199], v3 offset:1024
    v_mfma_f32_16x16x32_bf16 v[140:143], a[164:167], v[116:119], v[140:143]
    s_waitcnt lgkmcnt(6)
    v_add_u32 v2, s52, v1
    v_or3_b32 v57, v57, v219, v220
    v_mfma_f32_16x16x32_bf16 v[136:139], a[168:171], v[104:107], v[136:139]
    v_exp_f32 v243, v175
    v_mfma_f32_16x16x32_bf16 v[140:143], a[168:171], v[120:123], v[140:143]
    ds_read_b128 a[200:203], v3 offset:2048
    v_cvt_pk_bf16_f32 v221, v242, v243
    v_mfma_f32_16x16x32_bf16 v[136:139], a[172:175], v[108:111], v[136:139]
    v_exp_f32 v244, v188
    v_mfma_f32_16x16x32_bf16 v[140:143], a[172:175], v[124:127], v[140:143]
    s_waitcnt lgkmcnt(5)
    ds_read_b128 a[204:207], v3 offset:3072
    ds_read_b128 a[208:211], v3 offset:4096
    v_mfma_f32_16x16x32_bf16 v[152:155], a[176:179], v[96:99], v[40:43]
    v_exp_f32 v245, v189
    v_mfma_f32_16x16x32_bf16 v[156:159], a[176:179], v[112:115], v[44:47]
    buffer_load_dwordx4 v1, s[16:19], s32 offen offset:3072 sc1 lds
    ds_read_b128 a[212:215], v3 offset:5120
    v_mfma_f32_16x16x32_bf16 v[152:155], a[180:183], v[100:103], v[152:155]
    s_add_u32 s32, s32, 0x80000
    v_exp_f32 v246, v190
    v_mfma_f32_16x16x32_bf16 v[156:159], a[180:183], v[116:119], v[156:159]
    s_waitcnt lgkmcnt(6)
    ds_read_b128 a[216:219], v3 offset:6144
    v_cvt_pk_bf16_f32 v222, v244, v245
    v_mfma_f32_16x16x32_bf16 v[152:155], a[184:187], v[104:107], v[152:155]
    v_exp_f32 v247, v191
    v_mfma_f32_16x16x32_bf16 v[156:159], a[184:187], v[120:123], v[156:159]
    ds_read_b128 a[220:223], v3 offset:7168
    v_or3_b32 v57, v57, v221, v222
    v_mfma_f32_16x16x32_bf16 v[152:155], a[188:191], v[108:111], v[152:155]
    v_cvt_pk_bf16_f32 v223, v246, v247
    v_bitop3_b32 v57, v57, v223, s37 bitop3:0xa8
    v_mfma_f32_16x16x32_bf16 v[156:159], a[188:191], v[124:127], v[156:159]
    v_cmp_ne_u32 vcc, 0, v57
    s_cbranch_vccnz k2_rare_103
k2_ret_104:
    v_mfma_f32_16x16x32_bf16 v[248:251], v[60:63], v[208:211], v[248:251]
    ds_read_b128 a[224:227], v3 offset:8192
    v_mfma_f32_16x16x32_bf16 v[252:255], v[60:63], v[212:215], v[252:255]
    s_mov_b32 m0, s35
    v_exp_f32 v232, v128
    v_mfma_f32_16x16x32_bf16 v[248:251], v[60:63], v[216:219], v[248:251]
    s_add_u32 s53, s53, 16384
    buffer_load_dwordx4 v1, s[20:23], s33 offen offset:0 sc1 lds
    ds_read_b128 a[228:231], v3 offset:9216
    v_mfma_f32_16x16x32_bf16 v[252:255], v[60:63], v[220:223], v[252:255]
    s_waitcnt lgkmcnt(8)
    v_exp_f32 v233, v129
    v_mfma_f32_16x16x32_bf16 a[8:11], a[192:195], v[208:211], a[8:11]
    s_and_b32 s53, s53, 0xffff
    ds_read_b128 a[232:235], v3 offset:10240
    v_cvt_pk_bf16_f32 v192, v232, v233
    v_mfma_f32_16x16x32_bf16 a[12:15], a[192:195], v[212:215], a[12:15]
    v_exp_f32 v234, v130
    v_mfma_f32_16x16x32_bf16 a[24:27], a[196:199], v[208:211], a[24:27]
    ds_read_b128 a[236:239], v3 offset:11264
    v_mfma_f32_16x16x32_bf16 a[28:31], a[196:199], v[212:215], a[28:31]
    s_waitcnt lgkmcnt(8)
    v_exp_f32 v235, v131
    v_mfma_f32_16x16x32_bf16 a[40:43], a[200:203], v[208:211], a[40:43]
    s_add_u32 s35, s35, 0x4000
    ds_read_b128 a[240:243], v3 offset:12288
    v_cvt_pk_bf16_f32 v193, v234, v235
    v_mfma_f32_16x16x32_bf16 a[44:47], a[200:203], v[212:215], a[44:47]
    v_exp_f32 v236, v144
    v_mfma_f32_16x16x32_bf16 a[56:59], a[204:207], v[208:211], a[56:59]
    buffer_load_dwordx4 v1, s[20:23], s33 offen offset:1024 sc1 lds
    ds_read_b128 a[244:247], v3 offset:13312
    v_mfma_f32_16x16x32_bf16 a[60:63], a[204:207], v[212:215], a[60:63]
    s_waitcnt lgkmcnt(8)
    v_exp_f32 v237, v145
    v_mfma_f32_16x16x32_bf16 a[72:75], a[208:211], v[208:211], a[72:75]
    ds_read_b128 a[248:251], v3 offset:14336
    v_cvt_pk_bf16_f32 v194, v236, v237
    v_mfma_f32_16x16x32_bf16 a[76:79], a[208:211], v[212:215], a[76:79]
    v_exp_f32 v238, v146
    v_mfma_f32_16x16x32_bf16 a[88:91], a[212:215], v[208:211], a[88:91]
    ds_read_b128 a[252:255], v3 offset:15360
    v_or3_b32 v57, v192, v193, v194
    v_mfma_f32_16x16x32_bf16 a[92:95], a[212:215], v[212:215], a[92:95]
    s_waitcnt lgkmcnt(8)
    v_exp_f32 v239, v147
    v_mfma_f32_16x16x32_bf16 a[104:107], a[216:219], v[208:211], a[104:107]
    s_and_b32 s35, s35, 0xffff
    v_exp_f32 v240, v132
    v_mfma_f32_16x16x32_bf16 a[108:111], a[216:219], v[212:215], a[108:111]
    ds_read_b128 a[128:131], v2 offset:0
    v_cvt_pk_bf16_f32 v195, v238, v239
    v_mfma_f32_16x16x32_bf16 a[120:123], a[220:223], v[208:211], a[120:123]
    v_exp_f32 v241, v133
    v_mfma_f32_16x16x32_bf16 a[124:127], a[220:223], v[212:215], a[124:127]
    s_waitcnt lgkmcnt(7)
    buffer_load_dwordx4 v1, s[20:23], s33 offen offset:2048 sc1 lds
    ds_read_b128 a[132:135], v2 offset:1024
    v_mfma_f32_16x16x32_bf16 a[8:11], a[224:227], v[216:219], a[8:11]
    v_add_u32 v3, s53, v56
    v_cvt_pk_bf16_f32 v196, v240, v241
    v_mfma_f32_16x16x32_bf16 a[12:15], a[224:227], v[220:223], a[12:15]
    s_or_b32 s35, s35, 0x10000
    v_exp_f32 v242, v134
    v_mfma_f32_16x16x32_bf16 a[24:27], a[228:231], v[216:219], a[24:27]
    ds_read_b128 a[136:139], v2 offset:2048
    v_or3_b32 v57, v57, v195, v196
    v_mfma_f32_16x16x32_bf16 a[28:31], a[228:231], v[220:223], a[28:31]
    s_waitcnt lgkmcnt(7)
    v_exp_f32 v243, v135
    v_mfma_f32_16x16x32_bf16 a[40:43], a[232:235], v[216:219], a[40:43]
    ds_read_b128 a[140:143], v2 offset:3072
    v_cvt_pk_bf16_f32 v197, v242, v243
    v_mfma_f32_16x16x32_bf16 a[44:47], a[232:235], v[220:223], a[44:47]
    s_cmp_ge_u32 s36, s43
    s_cbranch_scc1 k2_prep_105
k2_prepret_106:
    v_mfma_f32_16x16x32_bf16 a[56:59], a[236:239], v[216:219], a[56:59]
    v_exp_f32 v244, v148
    v_mfma_f32_16x16x32_bf16 a[60:63], a[236:239], v[220:223], a[60:63]
    s_waitcnt lgkmcnt(6)
    buffer_load_dwordx4 v1, s[20:23], s33 offen offset:3072 sc1 lds
    ds_read_b128 a[144:147], v2 offset:4096
    v_mfma_f32_16x16x32_bf16 a[72:75], a[240:243], v[216:219], a[72:75]
    s_add_u32 s33, s33, 0x80000
    v_exp_f32 v245, v149
    v_mfma_f32_16x16x32_bf16 a[76:79], a[240:243], v[220:223], a[76:79]
    ds_read_b128 a[148:151], v2 offset:5120
    v_cvt_pk_bf16_f32 v198, v244, v245
    v_mfma_f32_16x16x32_bf16 a[88:91], a[244:247], v[216:219], a[88:91]
    v_exp_f32 v246, v150
    v_mfma_f32_16x16x32_bf16 a[92:95], a[244:247], v[220:223], a[92:95]
    s_waitcnt lgkmcnt(6)
    ds_read_b128 a[152:155], v2 offset:6144
    v_or3_b32 v57, v57, v197, v198
    v_mfma_f32_16x16x32_bf16 a[104:107], a[248:251], v[216:219], a[104:107]
    v_exp_f32 v247, v151
    v_mfma_f32_16x16x32_bf16 a[108:111], a[248:251], v[220:223], a[108:111]
    ds_read_b128 a[156:159], v2 offset:7168
    v_cvt_pk_bf16_f32 v199, v246, v247
    v_mfma_f32_16x16x32_bf16 a[120:123], a[252:255], v[216:219], a[120:123]
    v_exp_f32 v232, v136
    v_mfma_f32_16x16x32_bf16 a[124:127], a[252:255], v[220:223], a[124:127]
    s_waitcnt lgkmcnt(6)
    ds_read_b128 a[160:163], v2 offset:8192
    ds_read_b128 a[164:167], v2 offset:9216
    v_mfma_f32_16x16x32_bf16 v[160:163], a[128:131], v[96:99], v[16:19]
    s_waitcnt vmcnt(12)
    s_barrier
    v_exp_f32 v233, v137
    v_mfma_f32_16x16x32_bf16 v[164:167], a[128:131], v[112:115], v[20:23]
    s_mov_b32 m0, s34
    v_exp_f32 v234, v138
    v_mfma_f32_16x16x32_bf16 v[160:163], a[132:135], v[100:103], v[160:163]
    ds_read_b128 a[168:171], v2 offset:10240
    v_cvt_pk_bf16_f32 v200, v232, v233
    v_mfma_f32_16x16x32_bf16 v[164:167], a[132:135], v[116:119], v[164:167]
    s_waitcnt lgkmcnt(7)
    buffer_load_dwordx4 v1, s[16:19], s32 offen offset:0 sc1 lds
    ds_read_b128 a[172:175], v2 offset:11264
    v_mfma_f32_16x16x32_bf16 v[160:163], a[136:139], v[104:107], v[160:163]
    s_add_u32 s36, s36, 64
    v_exp_f32 v235, v139
    v_mfma_f32_16x16x32_bf16 v[164:167], a[136:139], v[120:123], v[164:167]
    v_or3_b32 v57, v57, v199, v200
    v_cvt_pk_bf16_f32 v201, v234, v235
    v_mfma_f32_16x16x32_bf16 v[160:163], a[140:143], v[108:111], v[160:163]
    v_exp_f32 v236, v152
    v_mfma_f32_16x16x32_bf16 v[164:167], a[140:143], v[124:127], v[164:167]
    s_waitcnt lgkmcnt(6)
    ds_read_b128 a[176:179], v2 offset:12288
    ds_read_b128 a[180:183], v2 offset:13312
    v_mfma_f32_16x16x32_bf16 v[176:179], a[144:147], v[96:99], v[32:35]
    s_add_u32 s34, s34, 0x4000
    v_exp_f32 v237, v153
    v_mfma_f32_16x16x32_bf16 v[180:183], a[144:147], v[112:115], v[36:39]
    s_add_u32 s52, s52, 16384
    v_exp_f32 v238, v154
    v_mfma_f32_16x16x32_bf16 v[176:179], a[148:151], v[100:103], v[176:179]
    s_and_b32 s52, s52, 0xffff
    ds_read_b128 a[184:187], v2 offset:14336
    v_cvt_pk_bf16_f32 v202, v236, v237
    v_mfma_f32_16x16x32_bf16 v[180:183], a[148:151], v[116:119], v[180:183]
    s_waitcnt lgkmcnt(7)
    buffer_load_dwordx4 v1, s[16:19], s32 offen offset:1024 sc1 lds
    ds_read_b128 a[188:191], v2 offset:15360
    v_mfma_f32_16x16x32_bf16 v[176:179], a[152:155], v[104:107], v[176:179]
    v_exp_f32 v239, v155
    v_mfma_f32_16x16x32_bf16 v[180:183], a[152:155], v[120:123], v[180:183]
    v_or3_b32 v57, v57, v201, v202
    v_cvt_pk_bf16_f32 v203, v238, v239
    v_mfma_f32_16x16x32_bf16 v[176:179], a[156:159], v[108:111], v[176:179]
    s_and_b32 s34, s34, 0xffff
    v_exp_f32 v240, v140
    v_mfma_f32_16x16x32_bf16 v[180:183], a[156:159], v[124:127], v[180:183]
    s_waitcnt lgkmcnt(6)
    v_exp_f32 v241, v141
    v_mfma_f32_16x16x32_bf16 v[168:171], a[160:163], v[96:99], v[24:27]
    ds_read_b128 a[192:195], v3 offset:0
    v_cvt_pk_bf16_f32 v204, v240, v241
    v_mfma_f32_16x16x32_bf16 v[172:175], a[160:163], v[112:115], v[28:31]
    v_exp_f32 v242, v142
    v_mfma_f32_16x16x32_bf16 v[168:171], a[164:167], v[100:103], v[168:171]
    buffer_load_dwordx4 v1, s[16:19], s32 offen offset:2048 sc1 lds
    ds_read_b128 a[196:199], v3 offset:1024
    v_mfma_f32_16x16x32_bf16 v[172:175], a[164:167], v[116:119], v[172:175]
    s_waitcnt lgkmcnt(6)
    v_add_u32 v2, s52, v1
    v_or3_b32 v57, v57, v203, v204
    v_mfma_f32_16x16x32_bf16 v[168:171], a[168:171], v[104:107], v[168:171]
    v_exp_f32 v243, v143
    v_mfma_f32_16x16x32_bf16 v[172:175], a[168:171], v[120:123], v[172:175]
    ds_read_b128 a[200:203], v3 offset:2048
    v_cvt_pk_bf16_f32 v205, v242, v243
    v_mfma_f32_16x16x32_bf16 v[168:171], a[172:175], v[108:111], v[168:171]
    v_exp_f32 v244, v156
    v_mfma_f32_16x16x32_bf16 v[172:175], a[172:175], v[124:127], v[172:175]
    s_waitcnt lgkmcnt(5)
    ds_read_b128 a[204:207], v3 offset:3072
    ds_read_b128 a[208:211], v3 offset:4096
    v_mfma_f32_16x16x32_bf16 v[184:187], a[176:179], v[96:99], v[40:43]
    s_sub_u32 s63, s63, 1
    v_exp_f32 v245, v157
    v_mfma_f32_16x16x32_bf16 v[188:191], a[176:179], v[112:115], v[44:47]
    buffer_load_dwordx4 v1, s[16:19], s32 offen offset:3072 sc1 lds
    ds_read_b128 a[212:215], v3 offset:5120
    v_mfma_f32_16x16x32_bf16 v[184:187], a[180:183], v[100:103], v[184:187]
    s_add_u32 s32, s32, 0x80000
    v_exp_f32 v246, v158
    v_mfma_f32_16x16x32_bf16 v[188:191], a[180:183], v[116:119], v[188:191]
    s_waitcnt lgkmcnt(6)
    ds_read_b128 a[216:219], v3 offset:6144
    v_cvt_pk_bf16_f32 v206, v244, v245
    v_mfma_f32_16x16x32_bf16 v[184:187], a[184:187], v[104:107], v[184:187]
    v_exp_f32 v247, v159
    v_mfma_f32_16x16x32_bf16 v[188:191], a[184:187], v[120:123], v[188:191]
    ds_read_b128 a[220:223], v3 offset:7168
    v_or3_b32 v57, v57, v205, v206
    v_mfma_f32_16x16x32_bf16 v[184:187], a[188:191], v[108:111], v[184:187]
    v_cvt_pk_bf16_f32 v207, v246, v247
    v_bitop3_b32 v57, v57, v207, s37 bitop3:0xa8
    v_mfma_f32_16x16x32_bf16 v[188:191], a[188:191], v[124:127], v[188:191]
    v_cmp_ne_u32 vcc, 0, v57
    s_cbranch_vccnz k2_rare_107
k2_ret_108:
    s_cmp_lg_u32 s63, 0
    s_cbranch_scc1 k2_sloop_99
k2_sdone_100:
    v_mfma_f32_16x16x32_bf16 v[248:251], v[60:63], v[192:195], v[248:251]
    s_waitcnt vmcnt(0)
    s_barrier
    ds_read_b128 a[224:227], v3 offset:8192
    v_exp_f32 v232, v160
    v_mfma_f32_16x16x32_bf16 v[252:255], v[60:63], v[196:199], v[252:255]
    ds_read_b128 a[228:231], v3 offset:9216
    v_exp_f32 v233, v161
    v_mfma_f32_16x16x32_bf16 v[248:251], v[60:63], v[200:203], v[248:251]
    s_add_u32 s53, s53, 16384
    v_exp_f32 v234, v162
    v_cvt_pk_bf16_f32 v208, v232, v233
    v_mfma_f32_16x16x32_bf16 v[252:255], v[60:63], v[204:207], v[252:255]
    s_waitcnt lgkmcnt(8)
    ds_read_b128 a[232:235], v3 offset:10240
    v_exp_f32 v235, v163
    v_mfma_f32_16x16x32_bf16 a[8:11], a[192:195], v[192:195], a[8:11]
    s_and_b32 s53, s53, 0xffff
    v_exp_f32 v236, v176
    v_cvt_pk_bf16_f32 v209, v234, v235
    v_mfma_f32_16x16x32_bf16 a[12:15], a[192:195], v[196:199], a[12:15]
    ds_read_b128 a[236:239], v3 offset:11264
    v_exp_f32 v237, v177
    v_mfma_f32_16x16x32_bf16 a[24:27], a[196:199], v[192:195], a[24:27]
    v_exp_f32 v238, v178
    v_cvt_pk_bf16_f32 v210, v236, v237
    v_mfma_f32_16x16x32_bf16 a[28:31], a[196:199], v[196:199], a[28:31]
    s_waitcnt lgkmcnt(8)
    v_exp_f32 v239, v179
    v_or3_b32 v57, v208, v209, v210
    v_mfma_f32_16x16x32_bf16 a[40:43], a[200:203], v[192:195], a[40:43]
    ds_read_b128 a[240:243], v3 offset:12288
    v_exp_f32 v240, v164
    v_mfma_f32_16x16x32_bf16 a[44:47], a[200:203], v[196:199], a[44:47]
    v_cvt_pk_bf16_f32 v211, v238, v239
    v_exp_f32 v241, v165
    v_mfma_f32_16x16x32_bf16 a[56:59], a[204:207], v[192:195], a[56:59]
    ds_read_b128 a[244:247], v3 offset:13312
    v_exp_f32 v242, v166
    v_mfma_f32_16x16x32_bf16 a[60:63], a[204:207], v[196:199], a[60:63]
    s_waitcnt lgkmcnt(8)
    v_cvt_pk_bf16_f32 v212, v240, v241
    v_exp_f32 v243, v167
    v_mfma_f32_16x16x32_bf16 a[72:75], a[208:211], v[192:195], a[72:75]
    ds_read_b128 a[248:251], v3 offset:14336
    v_or3_b32 v57, v57, v211, v212
    v_cvt_pk_bf16_f32 v213, v242, v243
    v_mfma_f32_16x16x32_bf16 a[76:79], a[208:211], v[196:199], a[76:79]
    ds_read_b128 a[252:255], v3 offset:15360
    v_exp_f32 v244, v180
    v_mfma_f32_16x16x32_bf16 a[88:91], a[212:215], v[192:195], a[88:91]
    v_exp_f32 v245, v181
    v_mfma_f32_16x16x32_bf16 a[92:95], a[212:215], v[196:199], a[92:95]
    s_waitcnt lgkmcnt(8)
    v_exp_f32 v246, v182
    v_cvt_pk_bf16_f32 v214, v244, v245
    v_mfma_f32_16x16x32_bf16 a[104:107], a[216:219], v[192:195], a[104:107]
    v_exp_f32 v247, v183
    v_or3_b32 v57, v57, v213, v214
    v_mfma_f32_16x16x32_bf16 a[108:111], a[216:219], v[196:199], a[108:111]
    v_exp_f32 v232, v168
    v_cvt_pk_bf16_f32 v215, v246, v247
    v_mfma_f32_16x16x32_bf16 a[120:123], a[220:223], v[192:195], a[120:123]
    v_exp_f32 v233, v169
    v_mfma_f32_16x16x32_bf16 a[124:127], a[220:223], v[196:199], a[124:127]
    s_waitcnt lgkmcnt(6)
    v_exp_f32 v234, v170
    v_cvt_pk_bf16_f32 v216, v232, v233
    v_mfma_f32_16x16x32_bf16 a[8:11], a[224:227], v[200:203], a[8:11]
    v_exp_f32 v235, v171
    v_or3_b32 v57, v57, v215, v216
    v_mfma_f32_16x16x32_bf16 a[12:15], a[224:227], v[204:207], a[12:15]
    v_add_u32 v3, s53, v56
    ds_read_b128 a[192:195], v3 offset:0
    ds_read_b128 a[196:199], v3 offset:1024
    v_mfma_f32_16x16x32_bf16 a[24:27], a[228:231], v[200:203], a[24:27]
    v_exp_f32 v236, v184
    v_cvt_pk_bf16_f32 v217, v234, v235
    v_mfma_f32_16x16x32_bf16 a[28:31], a[228:231], v[204:207], a[28:31]
    s_waitcnt lgkmcnt(6)
    ds_read_b128 a[200:203], v3 offset:2048
    v_exp_f32 v237, v185
    v_mfma_f32_16x16x32_bf16 a[40:43], a[232:235], v[200:203], a[40:43]
    ds_read_b128 a[204:207], v3 offset:3072
    v_exp_f32 v238, v186
    v_mfma_f32_16x16x32_bf16 a[44:47], a[232:235], v[204:207], a[44:47]
    v_cvt_pk_bf16_f32 v218, v236, v237
    v_exp_f32 v239, v187
    v_mfma_f32_16x16x32_bf16 a[56:59], a[236:239], v[200:203], a[56:59]
    ds_read_b128 a[208:211], v3 offset:4096
    v_or3_b32 v57, v57, v217, v218
    v_cvt_pk_bf16_f32 v219, v238, v239
    v_mfma_f32_16x16x32_bf16 a[60:63], a[236:239], v[204:207], a[60:63]
    s_waitcnt lgkmcnt(7)
    ds_read_b128 a[212:215], v3 offset:5120
    v_exp_f32 v240, v172
    v_mfma_f32_16x16x32_bf16 a[72:75], a[240:243], v[200:203], a[72:75]
    ds_read_b128 a[216:219], v3 offset:6144
    v_exp_f32 v241, v173
    v_mfma_f32_16x16x32_bf16 a[76:79], a[240:243], v[204:207], a[76:79]
    v_exp_f32 v242, v174
    v_cvt_pk_bf16_f32 v220, v240, v241
    v_mfma_f32_16x16x32_bf16 a[88:91], a[244:247], v[200:203], a[88:91]
    v_exp_f32 v243, v175
    v_or3_b32 v57, v57, v219, v220
    v_mfma_f32_16x16x32_bf16 a[92:95], a[244:247], v[204:207], a[92:95]
    s_waitcnt lgkmcnt(7)
    ds_read_b128 a[220:223], v3 offset:7168
    v_exp_f32 v244, v188
    v_mfma_f32_16x16x32_bf16 a[104:107], a[248:251], v[200:203], a[104:107]
    ds_read_b128 a[224:227], v3 offset:8192
    ds_read_b128 a[228:231], v3 offset:9216
    v_cvt_pk_bf16_f32 v221, v242, v243
    v_mfma_f32_16x16x32_bf16 a[108:111], a[248:251], v[204:207], a[108:111]
    ds_read_b128 a[232:235], v3 offset:10240
    v_exp_f32 v245, v189
    v_mfma_f32_16x16x32_bf16 a[120:123], a[252:255], v[200:203], a[120:123]
    v_exp_f32 v246, v190
    v_cvt_pk_bf16_f32 v222, v244, v245
    v_mfma_f32_16x16x32_bf16 a[124:127], a[252:255], v[204:207], a[124:127]
    v_exp_f32 v247, v191
    v_or3_b32 v57, v57, v221, v222
    v_cvt_pk_bf16_f32 v223, v246, v247
    v_bitop3_b32 v57, v57, v223, s37 bitop3:0xa8
    ds_read_b128 a[236:239], v3 offset:11264
    v_cmp_ne_u32 vcc, 0, v57
    ds_read_b128 a[240:243], v3 offset:12288
    ds_read_b128 a[244:247], v3 offset:13312
    ds_read_b128 a[248:251], v3 offset:14336
    ds_read_b128 a[252:255], v3 offset:15360
    s_cbranch_vccnz k2_rare_109
k2_ret_110:
    v_lshrrev_b32 v6, 4, v1
    v_and_b32 v6, 31, v6
    s_getpc_b64 s[40:41]
pc_111:
    s_add_u32 s40, s40, k3_kernel-pc_111
    s_addc_u32 s41, s41, 0
    v_lshlrev_b32 v224, 7, v6
    v_mov_b32 v225, s41
    v_add_co_u32 v224, vcc, s40, v224
    s_nop 1
    v_addc_co_u32 v225, vcc, 0, v225, vcc
    global_load_dword v7, v[224:225], off
    v_mfma_f32_16x16x32_bf16 v[248:251], v[60:63], v[208:211], v[248:251]
    s_lshl_b32 s31, s28, 19
    v_mfma_f32_16x16x32_bf16 v[252:255], v[60:63], v[212:215], v[252:255]
    s_lshl_b32 s44, s39, 6
    v_mfma_f32_16x16x32_bf16 v[248:251], v[60:63], v[216:219], v[248:251]
    s_add_u32 s44, s44, s31
    v_mfma_f32_16x16x32_bf16 v[252:255], v[60:63], v[220:223], v[252:255]
    s_waitcnt lgkmcnt(0)
    v_mfma_f32_16x16x32_bf16 a[8:11], a[192:195], v[208:211], a[8:11]
    s_add_u32 s45, s44, 131072
    v_mfma_f32_16x16x32_bf16 a[12:15], a[192:195], v[212:215], a[12:15]
    s_add_u32 s46, s44, 262144
    v_mfma_f32_16x16x32_bf16 a[8:11], a[224:227], v[216:219], a[8:11]
    s_add_u32 s47, s44, 393216
    v_mfma_f32_16x16x32_bf16 a[12:15], a[224:227], v[220:223], a[12:15]
    v_mfma_f32_16x16x32_bf16 a[24:27], a[196:199], v[208:211], a[24:27]
    v_mov_b32 v249, v248
    v_mov_b32 v253, v252
    s_nop 1
    v_mfma_f32_16x16x32_bf16 a[28:31], a[196:199], v[212:215], a[28:31]
    v_permlane16_swap_b32 v248, v249
    v_permlane16_swap_b32 v252, v253
    s_nop 1
    v_mfma_f32_16x16x32_bf16 a[24:27], a[228:231], v[216:219], a[24:27]
    v_add_f32 v248, v248, v249
    v_add_f32 v252, v252, v253
    v_mov_b32 v249, v248
    v_mfma_f32_16x16x32_bf16 a[28:31], a[228:231], v[220:223], a[28:31]
    v_mov_b32 v253, v252
    s_nop 1
    v_permlane32_swap_b32 v248, v249
    v_mfma_f32_16x16x32_bf16 a[40:43], a[200:203], v[208:211], a[40:43]
    v_permlane32_swap_b32 v252, v253
    s_nop 1
    v_add_f32 v248, v248, v249
    v_mfma_f32_16x16x32_bf16 a[44:47], a[200:203], v[212:215], a[44:47]
    v_add_f32 v252, v252, v253
    v_rcp_f32 v249, v248
    v_rcp_f32 v253, v252
    v_mfma_f32_16x16x32_bf16 a[40:43], a[232:235], v[216:219], a[40:43]
    v_rcp_f32 v248, v248
    v_rcp_f32 v252, v252
    s_nop 0
    v_mfma_f32_16x16x32_bf16 a[44:47], a[232:235], v[220:223], a[44:47]
    v_accvgpr_read_b32 v132, a8
    v_accvgpr_read_b32 v144, a12
    v_accvgpr_read_b32 v133, a9
    v_mfma_f32_16x16x32_bf16 a[56:59], a[204:207], v[208:211], a[56:59]
    v_accvgpr_read_b32 v145, a13
    v_accvgpr_read_b32 v134, a10
    v_accvgpr_read_b32 v146, a14
    v_mfma_f32_16x16x32_bf16 a[60:63], a[204:207], v[212:215], a[60:63]
    v_accvgpr_read_b32 v135, a11
    v_accvgpr_read_b32 v147, a15
    v_accvgpr_read_b32 v136, a24
    v_mfma_f32_16x16x32_bf16 a[56:59], a[236:239], v[216:219], a[56:59]
    v_accvgpr_read_b32 v148, a28
    v_accvgpr_read_b32 v137, a25
    v_accvgpr_read_b32 v149, a29
    v_mfma_f32_16x16x32_bf16 a[60:63], a[236:239], v[220:223], a[60:63]
    v_accvgpr_read_b32 v138, a26
    v_accvgpr_read_b32 v150, a30
    v_accvgpr_read_b32 v139, a27
    v_mfma_f32_16x16x32_bf16 a[72:75], a[208:211], v[208:211], a[72:75]
    v_accvgpr_read_b32 v151, a31
    v_mul_f32 v132, v132, v248
    v_mul_f32 v144, v144, v252
    v_mfma_f32_16x16x32_bf16 a[76:79], a[208:211], v[212:215], a[76:79]
    v_mul_f32 v133, v133, v248
    v_mul_f32 v145, v145, v252
    v_mul_f32 v134, v134, v248
    v_mfma_f32_16x16x32_bf16 a[72:75], a[240:243], v[216:219], a[72:75]
    v_mul_f32 v146, v146, v252
    v_mul_f32 v135, v135, v248
    v_mul_f32 v147, v147, v252
    v_mfma_f32_16x16x32_bf16 a[76:79], a[240:243], v[220:223], a[76:79]
    v_mul_f32 v136, v136, v248
    v_mul_f32 v148, v148, v252
    v_mul_f32 v137, v137, v248
    v_mfma_f32_16x16x32_bf16 a[88:91], a[212:215], v[208:211], a[88:91]
    v_mul_f32 v149, v149, v252
    v_mul_f32 v138, v138, v248
    v_mul_f32 v150, v150, v252
    v_mfma_f32_16x16x32_bf16 a[92:95], a[212:215], v[212:215], a[92:95]
    v_mul_f32 v139, v139, v248
    v_mul_f32 v151, v151, v252
    v_cvt_pk_bf16_f32 v128, v132, v133
    v_mfma_f32_16x16x32_bf16 a[88:91], a[244:247], v[216:219], a[88:91]
    v_cvt_pk_bf16_f32 v140, v144, v145
    v_cvt_pk_bf16_f32 v129, v134, v135
    v_cvt_pk_bf16_f32 v141, v146, v147
    v_mfma_f32_16x16x32_bf16 a[92:95], a[244:247], v[220:223], a[92:95]
    v_cvt_pk_bf16_f32 v130, v136, v137
    v_cvt_pk_bf16_f32 v142, v148, v149
    v_cvt_pk_bf16_f32 v131, v138, v139
    v_mfma_f32_16x16x32_bf16 a[104:107], a[216:219], v[208:211], a[104:107]
    buffer_store_dwordx4 v[128:131], v1, s[24:27], s44 offen offset:0 sc1
    v_cvt_pk_bf16_f32 v143, v150, v151
    buffer_store_dwordx4 v[140:143], v1, s[24:27], s44 offen offset:1024 sc1
    v_mfma_f32_16x16x32_bf16 a[108:111], a[216:219], v[212:215], a[108:111]
    v_accvgpr_read_b32 v156, a40
    v_accvgpr_read_b32 v168, a44
    v_accvgpr_read_b32 v157, a41
    v_mfma_f32_16x16x32_bf16 a[104:107], a[248:251], v[216:219], a[104:107]
    v_accvgpr_read_b32 v169, a45
    v_accvgpr_read_b32 v158, a42
    v_accvgpr_read_b32 v170, a46
    v_mfma_f32_16x16x32_bf16 a[108:111], a[248:251], v[220:223], a[108:111]
    v_accvgpr_read_b32 v159, a43
    v_accvgpr_read_b32 v171, a47
    v_accvgpr_read_b32 v160, a56
    v_mfma_f32_16x16x32_bf16 a[120:123], a[220:223], v[208:211], a[120:123]
    v_accvgpr_read_b32 v172, a60
    v_accvgpr_read_b32 v161, a57
    v_accvgpr_read_b32 v173, a61
    v_mfma_f32_16x16x32_bf16 a[124:127], a[220:223], v[212:215], a[124:127]
    v_accvgpr_read_b32 v162, a58
    v_accvgpr_read_b32 v174, a62
    v_accvgpr_read_b32 v163, a59
    v_mfma_f32_16x16x32_bf16 a[120:123], a[252:255], v[216:219], a[120:123]
    v_accvgpr_read_b32 v175, a63
    v_mul_f32 v156, v156, v248
    v_mul_f32 v168, v168, v252
    v_mfma_f32_16x16x32_bf16 a[124:127], a[252:255], v[220:223], a[124:127]
    v_mul_f32 v157, v157, v248
    v_mul_f32 v169, v169, v252
    v_mul_f32 v158, v158, v248
    v_mul_f32 v170, v170, v252
    v_mul_f32 v159, v159, v248
    v_mul_f32 v171, v171, v252
    v_mul_f32 v160, v160, v248
    v_mul_f32 v172, v172, v252
    v_mul_f32 v161, v161, v248
    v_mul_f32 v173, v173, v252
    v_mul_f32 v162, v162, v248
    v_mul_f32 v174, v174, v252
    v_mul_f32 v163, v163, v248
    v_mul_f32 v175, v175, v252
    v_cvt_pk_bf16_f32 v152, v156, v157
    v_cvt_pk_bf16_f32 v164, v168, v169
    v_cvt_pk_bf16_f32 v153, v158, v159
    v_cvt_pk_bf16_f32 v165, v170, v171
    v_cvt_pk_bf16_f32 v154, v160, v161
    v_cvt_pk_bf16_f32 v166, v172, v173
    v_cvt_pk_bf16_f32 v155, v162, v163
    v_cvt_pk_bf16_f32 v167, v174, v175
    buffer_store_dwordx4 v[152:155], v1, s[24:27], s45 offen offset:0 sc1
    buffer_store_dwordx4 v[164:167], v1, s[24:27], s45 offen offset:1024 sc1
    v_accvgpr_read_b32 v132, a72
    v_accvgpr_read_b32 v144, a76
    v_accvgpr_read_b32 v133, a73
    v_accvgpr_read_b32 v145, a77
    v_accvgpr_read_b32 v134, a74
    v_accvgpr_read_b32 v146, a78
    v_accvgpr_read_b32 v135, a75
    v_accvgpr_read_b32 v147, a79
    v_accvgpr_read_b32 v136, a88
    v_accvgpr_read_b32 v148, a92
    v_accvgpr_read_b32 v137, a89
    v_accvgpr_read_b32 v149, a93
    v_accvgpr_read_b32 v138, a90
    v_accvgpr_read_b32 v150, a94
    v_accvgpr_read_b32 v139, a91
    v_accvgpr_read_b32 v151, a95
    v_mul_f32 v132, v132, v248
    v_mul_f32 v144, v144, v252
    v_mul_f32 v133, v133, v248
    v_mul_f32 v145, v145, v252
    v_mul_f32 v134, v134, v248
    v_mul_f32 v146, v146, v252
    v_mul_f32 v135, v135, v248
    v_mul_f32 v147, v147, v252
    v_mul_f32 v136, v136, v248
    v_mul_f32 v148, v148, v252
    v_mul_f32 v137, v137, v248
    v_mul_f32 v149, v149, v252
    v_mul_f32 v138, v138, v248
    v_mul_f32 v150, v150, v252
    v_mul_f32 v139, v139, v248
    v_mul_f32 v151, v151, v252
    v_cvt_pk_bf16_f32 v128, v132, v133
    v_cvt_pk_bf16_f32 v140, v144, v145
    v_cvt_pk_bf16_f32 v129, v134, v135
    v_cvt_pk_bf16_f32 v141, v146, v147
    v_cvt_pk_bf16_f32 v130, v136, v137
    v_cvt_pk_bf16_f32 v142, v148, v149
    v_cvt_pk_bf16_f32 v131, v138, v139
    v_cvt_pk_bf16_f32 v143, v150, v151
    buffer_store_dwordx4 v[128:131], v1, s[24:27], s46 offen offset:0 sc1
    buffer_store_dwordx4 v[140:143], v1, s[24:27], s46 offen offset:1024 sc1
    v_accvgpr_read_b32 v156, a104
    v_accvgpr_read_b32 v168, a108
    v_accvgpr_read_b32 v157, a105
    v_accvgpr_read_b32 v169, a109
    v_accvgpr_read_b32 v158, a106
    v_accvgpr_read_b32 v170, a110
    v_accvgpr_read_b32 v159, a107
    v_accvgpr_read_b32 v171, a111
    v_accvgpr_read_b32 v160, a120
    v_accvgpr_read_b32 v172, a124
    v_accvgpr_read_b32 v161, a121
    v_accvgpr_read_b32 v173, a125
    v_accvgpr_read_b32 v162, a122
    v_accvgpr_read_b32 v174, a126
    v_accvgpr_read_b32 v163, a123
    v_accvgpr_read_b32 v175, a127
    v_mul_f32 v156, v156, v248
    v_mul_f32 v168, v168, v252
    v_mul_f32 v157, v157, v248
    v_mul_f32 v169, v169, v252
    v_mul_f32 v158, v158, v248
    v_mul_f32 v170, v170, v252
    v_mul_f32 v159, v159, v248
    v_mul_f32 v171, v171, v252
    v_mul_f32 v160, v160, v248
    v_mul_f32 v172, v172, v252
    v_mul_f32 v161, v161, v248
    v_mul_f32 v173, v173, v252
    v_mul_f32 v162, v162, v248
    v_mul_f32 v174, v174, v252
    v_mul_f32 v163, v163, v248
    v_mul_f32 v175, v175, v252
    v_cvt_pk_bf16_f32 v152, v156, v157
    v_cvt_pk_bf16_f32 v164, v168, v169
    v_cvt_pk_bf16_f32 v153, v158, v159
    v_cvt_pk_bf16_f32 v165, v170, v171
    v_cvt_pk_bf16_f32 v154, v160, v161
    v_cvt_pk_bf16_f32 v166, v172, v173
    v_cvt_pk_bf16_f32 v155, v162, v163
    v_cvt_pk_bf16_f32 v167, v174, v175
    buffer_store_dwordx4 v[152:155], v1, s[24:27], s47 offen offset:0 sc1
    buffer_store_dwordx4 v[164:167], v1, s[24:27], s47 offen offset:1024 sc1
k12_end_1:
    s_endpgm
k2_prep_70:
    s_sub_u32 s40, s36, s38
    v_subrev_u32 v6, s40, v4
    v_cmp_gt_i32 s[44:45], -16, v6
    v_cmp_gt_i32 s[46:47], -15, v6
    v_cmp_gt_i32 s[48:49], -14, v6
    v_cmp_gt_i32 s[50:51], -13, v6
    s_nop 1
    v_cndmask_b32 v20, v9, v5, s[44:45]
    v_cndmask_b32 v21, v9, v5, s[46:47]
    v_cndmask_b32 v22, v9, v5, s[48:49]
    v_cndmask_b32 v23, v9, v5, s[50:51]
    v_cmp_gt_i32 s[44:45], 0, v6
    v_cmp_gt_i32 s[46:47], 1, v6
    v_cmp_gt_i32 s[48:49], 2, v6
    v_cmp_gt_i32 s[50:51], 3, v6
    s_nop 1
    v_cndmask_b32 v16, v8, v5, s[44:45]
    v_cndmask_b32 v17, v8, v5, s[46:47]
    v_cndmask_b32 v18, v8, v5, s[48:49]
    v_cndmask_b32 v19, v8, v5, s[50:51]
    v_cndmask_b32 v36, v9, v5, s[44:45]
    v_cndmask_b32 v37, v9, v5, s[46:47]
    v_cndmask_b32 v38, v9, v5, s[48:49]
    v_cndmask_b32 v39, v9, v5, s[50:51]
    v_cmp_gt_i32 s[44:45], 16, v6
    v_cmp_gt_i32 s[46:47], 17, v6
    v_cmp_gt_i32 s[48:49], 18, v6
    v_cmp_gt_i32 s[50:51], 19, v6
    s_nop 1
    v_cndmask_b32 v32, v8, v5, s[44:45]
    v_cndmask_b32 v33, v8, v5, s[46:47]
    v_cndmask_b32 v34, v8, v5, s[48:49]
    v_cndmask_b32 v35, v8, v5, s[50:51]
    s_nop 1
    s_branch k2_prepret_71
k2_prep_78:
    s_sub_u32 s40, s36, s38
    v_subrev_u32 v6, s40, v4
    v_cmp_gt_i32 s[44:45], -16, v6
    v_cmp_gt_i32 s[46:47], -15, v6
    v_cmp_gt_i32 s[48:49], -14, v6
    v_cmp_gt_i32 s[50:51], -13, v6
    s_nop 1
    v_cndmask_b32 v20, v9, v5, s[44:45]
    v_cndmask_b32 v21, v9, v5, s[46:47]
    v_cndmask_b32 v22, v9, v5, s[48:49]
    v_cndmask_b32 v23, v9, v5, s[50:51]
    v_cmp_gt_i32 s[44:45], 0, v6
    v_cmp_gt_i32 s[46:47], 1, v6
    v_cmp_gt_i32 s[48:49], 2, v6
    v_cmp_gt_i32 s[50:51], 3, v6
    s_nop 1
    v_cndmask_b32 v16, v8, v5, s[44:45]
    v_cndmask_b32 v17, v8, v5, s[46:47]
    v_cndmask_b32 v18, v8, v5, s[48:49]
    v_cndmask_b32 v19, v8, v5, s[50:51]
    v_cndmask_b32 v36, v9, v5, s[44:45]
    v_cndmask_b32 v37, v9, v5, s[46:47]
    v_cndmask_b32 v38, v9, v5, s[48:49]
    v_cndmask_b32 v39, v9, v5, s[50:51]
    v_cmp_gt_i32 s[44:45], 16, v6
    v_cmp_gt_i32 s[46:47], 17, v6
    v_cmp_gt_i32 s[48:49], 18, v6
    v_cmp_gt_i32 s[50:51], 19, v6
    s_nop 1
    v_cndmask_b32 v32, v8, v5, s[44:45]
    v_cndmask_b32 v33, v8, v5, s[46:47]
    v_cndmask_b32 v34, v8, v5, s[48:49]
    v_cndmask_b32 v35, v8, v5, s[50:51]
    s_nop 1
    s_branch k2_prepret_79
k2_prep_83:
    s_sub_u32 s40, s36, s38
    v_subrev_u32 v6, s40, v4
    v_cmp_gt_i32 s[44:45], -16, v6
    v_cmp_gt_i32 s[46:47], -15, v6
    v_cmp_gt_i32 s[48:49], -14, v6
    v_cmp_gt_i32 s[50:51], -13, v6
    s_nop 1
    v_cndmask_b32 v20, v9, v5, s[44:45]
    v_cndmask_b32 v21, v9, v5, s[46:47]
    v_cndmask_b32 v22, v9, v5, s[48:49]
    v_cndmask_b32 v23, v9, v5, s[50:51]
    v_cmp_gt_i32 s[44:45], 0, v6
    v_cmp_gt_i32 s[46:47], 1, v6
    v_cmp_gt_i32 s[48:49], 2, v6
    v_cmp_gt_i32 s[50:51], 3, v6
    s_nop 1
    v_cndmask_b32 v16, v8, v5, s[44:45]
    v_cndmask_b32 v17, v8, v5, s[46:47]
    v_cndmask_b32 v18, v8, v5, s[48:49]
    v_cndmask_b32 v19, v8, v5, s[50:51]
    v_cndmask_b32 v36, v9, v5, s[44:45]
    v_cndmask_b32 v37, v9, v5, s[46:47]
    v_cndmask_b32 v38, v9, v5, s[48:49]
    v_cndmask_b32 v39, v9, v5, s[50:51]
    v_cmp_gt_i32 s[44:45], 16, v6
    v_cmp_gt_i32 s[46:47], 17, v6
    v_cmp_gt_i32 s[48:49], 18, v6
    v_cmp_gt_i32 s[50:51], 19, v6
    s_nop 1
    v_cndmask_b32 v32, v8, v5, s[44:45]
    v_cndmask_b32 v33, v8, v5, s[46:47]
    v_cndmask_b32 v34, v8, v5, s[48:49]
    v_cndmask_b32 v35, v8, v5, s[50:51]
    s_nop 1
    s_branch k2_prepret_84
k2_prep_87:
    s_sub_u32 s40, s36, s38
    v_subrev_u32 v6, s40, v4
    v_cmp_gt_i32 s[44:45], -16, v6
    v_cmp_gt_i32 s[46:47], -15, v6
    v_cmp_gt_i32 s[48:49], -14, v6
    v_cmp_gt_i32 s[50:51], -13, v6
    s_nop 1
    v_cndmask_b32 v20, v9, v5, s[44:45]
    v_cndmask_b32 v21, v9, v5, s[46:47]
    v_cndmask_b32 v22, v9, v5, s[48:49]
    v_cndmask_b32 v23, v9, v5, s[50:51]
    v_cmp_gt_i32 s[44:45], 0, v6
    v_cmp_gt_i32 s[46:47], 1, v6
    v_cmp_gt_i32 s[48:49], 2, v6
    v_cmp_gt_i32 s[50:51], 3, v6
    s_nop 1
    v_cndmask_b32 v16, v8, v5, s[44:45]
    v_cndmask_b32 v17, v8, v5, s[46:47]
    v_cndmask_b32 v18, v8, v5, s[48:49]
    v_cndmask_b32 v19, v8, v5, s[50:51]
    v_cndmask_b32 v36, v9, v5, s[44:45]
    v_cndmask_b32 v37, v9, v5, s[46:47]
    v_cndmask_b32 v38, v9, v5, s[48:49]
    v_cndmask_b32 v39, v9, v5, s[50:51]
    v_cmp_gt_i32 s[44:45], 16, v6
    v_cmp_gt_i32 s[46:47], 17, v6
    v_cmp_gt_i32 s[48:49], 18, v6
    v_cmp_gt_i32 s[50:51], 19, v6
    s_nop 1
    v_cndmask_b32 v32, v8, v5, s[44:45]
    v_cndmask_b32 v33, v8, v5, s[46:47]
    v_cndmask_b32 v34, v8, v5, s[48:49]
    v_cndmask_b32 v35, v8, v5, s[50:51]
    s_nop 1
    s_branch k2_prepret_88
k2_prep_91:
    s_sub_u32 s40, s36, s39
    v_subrev_u32 v6, s40, v4
    v_cmp_gt_i32 s[44:45], -16, v6
    v_cmp_gt_i32 s[46:47], -15, v6
    v_cmp_gt_i32 s[48:49], -14, v6
    v_cmp_gt_i32 s[50:51], -13, v6
    s_nop 1
    v_cndmask_b32 v20, v11, v5, s[44:45]
    v_cndmask_b32 v21, v11, v5, s[46:47]
    v_cndmask_b32 v22, v11, v5, s[48:49]
    v_cndmask_b32 v23, v11, v5, s[50:51]
    v_cmp_gt_i32 s[44:45], 0, v6
    v_cmp_gt_i32 s[46:47], 1, v6
    v_cmp_gt_i32 s[48:49], 2, v6
    v_cmp_gt_i32 s[50:51], 3, v6
    s_nop 1
    v_cndmask_b32 v16, v10, v5, s[44:45]
    v_cndmask_b32 v17, v10, v5, s[46:47]
    v_cndmask_b32 v18, v10, v5, s[48:49]
    v_cndmask_b32 v19, v10, v5, s[50:51]
    v_cndmask_b32 v36, v11, v5, s[44:45]
    v_cndmask_b32 v37, v11, v5, s[46:47]
    v_cndmask_b32 v38, v11, v5, s[48:49]
    v_cndmask_b32 v39, v11, v5, s[50:51]
    v_cmp_gt_i32 s[44:45], 16, v6
    v_cmp_gt_i32 s[46:47], 17, v6
    v_cmp_gt_i32 s[48:49], 18, v6
    v_cmp_gt_i32 s[50:51], 19, v6
    s_nop 1
    v_cndmask_b32 v32, v10, v5, s[44:45]
    v_cndmask_b32 v33, v10, v5, s[46:47]
    v_cndmask_b32 v34, v10, v5, s[48:49]
    v_cndmask_b32 v35, v10, v5, s[50:51]
    v_cndmask_b32 v28, v11, v5, s[44:45]
    v_cndmask_b32 v29, v11, v5, s[46:47]
    v_cndmask_b32 v30, v11, v5, s[48:49]
    v_cndmask_b32 v31, v11, v5, s[50:51]
    v_cmp_gt_i32 s[44:45], 32, v6
    v_cmp_gt_i32 s[46:47], 33, v6
    v_cmp_gt_i32 s[48:49], 34, v6
    v_cmp_gt_i32 s[50:51], 35, v6
    s_nop 1
    v_cndmask_b32 v24, v10, v5, s[44:45]
    v_cndmask_b32 v25, v10, v5, s[46:47]
    v_cndmask_b32 v26, v10, v5, s[48:49]
    v_cndmask_b32 v27, v10, v5, s[50:51]
    v_cndmask_b32 v44, v11, v5, s[44:45]
    v_cndmask_b32 v45, v11, v5, s[46:47]
    v_cndmask_b32 v46, v11, v5, s[48:49]
    v_cndmask_b32 v47, v11, v5, s[50:51]
    v_cmp_gt_i32 s[44:45], 48, v6
    v_cmp_gt_i32 s[46:47], 49, v6
    v_cmp_gt_i32 s[48:49], 50, v6
    v_cmp_gt_i32 s[50:51], 51, v6
    s_nop 1
    v_cndmask_b32 v40, v10, v5, s[44:45]
    v_cndmask_b32 v41, v10, v5, s[46:47]
    v_cndmask_b32 v42, v10, v5, s[48:49]
    v_cndmask_b32 v43, v10, v5, s[50:51]
    s_nop 1
    s_branch k2_prepret_92
k2_prep_95:
    s_sub_u32 s40, s36, s39
    v_subrev_u32 v6, s40, v4
    v_cmp_gt_i32 s[44:45], -16, v6
    v_cmp_gt_i32 s[46:47], -15, v6
    v_cmp_gt_i32 s[48:49], -14, v6
    v_cmp_gt_i32 s[50:51], -13, v6
    s_nop 1
    v_cndmask_b32 v20, v11, v5, s[44:45]
    v_cndmask_b32 v21, v11, v5, s[46:47]
    v_cndmask_b32 v22, v11, v5, s[48:49]
    v_cndmask_b32 v23, v11, v5, s[50:51]
    v_cmp_gt_i32 s[44:45], 0, v6
    v_cmp_gt_i32 s[46:47], 1, v6
    v_cmp_gt_i32 s[48:49], 2, v6
    v_cmp_gt_i32 s[50:51], 3, v6
    s_nop 1
    v_cndmask_b32 v16, v10, v5, s[44:45]
    v_cndmask_b32 v17, v10, v5, s[46:47]
    v_cndmask_b32 v18, v10, v5, s[48:49]
    v_cndmask_b32 v19, v10, v5, s[50:51]
    v_cndmask_b32 v36, v11, v5, s[44:45]
    v_cndmask_b32 v37, v11, v5, s[46:47]
    v_cndmask_b32 v38, v11, v5, s[48:49]
    v_cndmask_b32 v39, v11, v5, s[50:51]
    v_cmp_gt_i32 s[44:45], 16, v6
    v_cmp_gt_i32 s[46:47], 17, v6
    v_cmp_gt_i32 s[48:49], 18, v6
    v_cmp_gt_i32 s[50:51], 19, v6
    s_nop 1
    v_cndmask_b32 v32, v10, v5, s[44:45]
    v_cndmask_b32 v33, v10, v5, s[46:47]
    v_cndmask_b32 v34, v10, v5, s[48:49]
    v_cndmask_b32 v35, v10, v5, s[50:51]
    v_cndmask_b32 v28, v11, v5, s[44:45]
    v_cndmask_b32 v29, v11, v5, s[46:47]
    v_cndmask_b32 v30, v11, v5, s[48:49]
    v_cndmask_b32 v31, v11, v5, s[50:51]
    v_cmp_gt_i32 s[44:45], 32, v6
    v_cmp_gt_i32 s[46:47], 33, v6
    v_cmp_gt_i32 s[48:49], 34, v6
    v_cmp_gt_i32 s[50:51], 35, v6
    s_nop 1
    v_cndmask_b32 v24, v10, v5, s[44:45]
    v_cndmask_b32 v25, v10, v5, s[46:47]
    v_cndmask_b32 v26, v10, v5, s[48:49]
    v_cndmask_b32 v27, v10, v5, s[50:51]
    v_cndmask_b32 v44, v11, v5, s[44:45]
    v_cndmask_b32 v45, v11, v5, s[46:47]
    v_cndmask_b32 v46, v11, v5, s[48:49]
    v_cndmask_b32 v47, v11, v5, s[50:51]
    v_cmp_gt_i32 s[44:45], 48, v6
    v_cmp_gt_i32 s[46:47], 49, v6
    v_cmp_gt_i32 s[48:49], 50, v6
    v_cmp_gt_i32 s[50:51], 51, v6
    s_nop 1
    v_cndmask_b32 v40, v10, v5, s[44:45]
    v_cndmask_b32 v41, v10, v5, s[46:47]
    v_cndmask_b32 v42, v10, v5, s[48:49]
    v_cndmask_b32 v43, v10, v5, s[50:51]
    s_nop 1
    s_branch k2_prepret_96
k2_prep_101:
    s_sub_u32 s40, s36, s39
    v_subrev_u32 v6, s40, v4
    v_cmp_gt_i32 s[44:45], -16, v6
    v_cmp_gt_i32 s[46:47], -15, v6
    v_cmp_gt_i32 s[48:49], -14, v6
    v_cmp_gt_i32 s[50:51], -13, v6
    s_nop 1
    v_cndmask_b32 v20, v11, v5, s[44:45]
    v_cndmask_b32 v21, v11, v5, s[46:47]
    v_cndmask_b32 v22, v11, v5, s[48:49]
    v_cndmask_b32 v23, v11, v5, s[50:51]
    v_cmp_gt_i32 s[44:45], 0, v6
    v_cmp_gt_i32 s[46:47], 1, v6
    v_cmp_gt_i32 s[48:49], 2, v6
    v_cmp_gt_i32 s[50:51], 3, v6
    s_nop 1
    v_cndmask_b32 v16, v10, v5, s[44:45]
    v_cndmask_b32 v17, v10, v5, s[46:47]
    v_cndmask_b32 v18, v10, v5, s[48:49]
    v_cndmask_b32 v19, v10, v5, s[50:51]
    v_cndmask_b32 v36, v11, v5, s[44:45]
    v_cndmask_b32 v37, v11, v5, s[46:47]
    v_cndmask_b32 v38, v11, v5, s[48:49]
    v_cndmask_b32 v39, v11, v5, s[50:51]
    v_cmp_gt_i32 s[44:45], 16, v6
    v_cmp_gt_i32 s[46:47], 17, v6
    v_cmp_gt_i32 s[48:49], 18, v6
    v_cmp_gt_i32 s[50:51], 19, v6
    s_nop 1
    v_cndmask_b32 v32, v10, v5, s[44:45]
    v_cndmask_b32 v33, v10, v5, s[46:47]
    v_cndmask_b32 v34, v10, v5, s[48:49]
    v_cndmask_b32 v35, v10, v5, s[50:51]
    v_cndmask_b32 v28, v11, v5, s[44:45]
    v_cndmask_b32 v29, v11, v5, s[46:47]
    v_cndmask_b32 v30, v11, v5, s[48:49]
    v_cndmask_b32 v31, v11, v5, s[50:51]
    v_cmp_gt_i32 s[44:45], 32, v6
    v_cmp_gt_i32 s[46:47], 33, v6
    v_cmp_gt_i32 s[48:49], 34, v6
    v_cmp_gt_i32 s[50:51], 35, v6
    s_nop 1
    v_cndmask_b32 v24, v10, v5, s[44:45]
    v_cndmask_b32 v25, v10, v5, s[46:47]
    v_cndmask_b32 v26, v10, v5, s[48:49]
    v_cndmask_b32 v27, v10, v5, s[50:51]
    v_cndmask_b32 v44, v11, v5, s[44:45]
    v_cndmask_b32 v45, v11, v5, s[46:47]
    v_cndmask_b32 v46, v11, v5, s[48:49]
    v_cndmask_b32 v47, v11, v5, s[50:51]
    v_cmp_gt_i32 s[44:45], 48, v6
    v_cmp_gt_i32 s[46:47], 49, v6
    v_cmp_gt_i32 s[48:49], 50, v6
    v_cmp_gt_i32 s[50:51], 51, v6
    s_nop 1
    v_cndmask_b32 v40, v10, v5, s[44:45]
    v_cndmask_b32 v41, v10, v5, s[46:47]
    v_cndmask_b32 v42, v10, v5, s[48:49]
    v_cndmask_b32 v43, v10, v5, s[50:51]
    s_nop 1
    s_branch k2_prepret_102
k2_prep_105:
    s_sub_u32 s40, s36, s39
    v_subrev_u32 v6, s40, v4
    v_cmp_gt_i32 s[44:45], -16, v6
    v_cmp_gt_i32 s[46:47], -15, v6
    v_cmp_gt_i32 s[48:49], -14, v6
    v_cmp_gt_i32 s[50:51], -13, v6
    s_nop 1
    v_cndmask_b32 v20, v11, v5, s[44:45]
    v_cndmask_b32 v21, v11, v5, s[46:47]
    v_cndmask_b32 v22, v11, v5, s[48:49]
    v_cndmask_b32 v23, v11, v5, s[50:51]
    v_cmp_gt_i32 s[44:45], 0, v6
    v_cmp_gt_i32 s[46:47], 1, v6
    v_cmp_gt_i32 s[48:49], 2, v6
    v_cmp_gt_i32 s[50:51], 3, v6
    s_nop 1
    v_cndmask_b32 v16, v10, v5, s[44:45]
    v_cndmask_b32 v17, v10, v5, s[46:47]
    v_cndmask_b32 v18, v10, v5, s[48:49]
    v_cndmask_b32 v19, v10, v5, s[50:51]
    v_cndmask_b32 v36, v11, v5, s[44:45]
    v_cndmask_b32 v37, v11, v5, s[46:47]
    v_cndmask_b32 v38, v11, v5, s[48:49]
    v_cndmask_b32 v39, v11, v5, s[50:51]
    v_cmp_gt_i32 s[44:45], 16, v6
    v_cmp_gt_i32 s[46:47], 17, v6
    v_cmp_gt_i32 s[48:49], 18, v6
    v_cmp_gt_i32 s[50:51], 19, v6
    s_nop 1
    v_cndmask_b32 v32, v10, v5, s[44:45]
    v_cndmask_b32 v33, v10, v5, s[46:47]
    v_cndmask_b32 v34, v10, v5, s[48:49]
    v_cndmask_b32 v35, v10, v5, s[50:51]
    v_cndmask_b32 v28, v11, v5, s[44:45]
    v_cndmask_b32 v29, v11, v5, s[46:47]
    v_cndmask_b32 v30, v11, v5, s[48:49]
    v_cndmask_b32 v31, v11, v5, s[50:51]
    v_cmp_gt_i32 s[44:45], 32, v6
    v_cmp_gt_i32 s[46:47], 33, v6
    v_cmp_gt_i32 s[48:49], 34, v6
    v_cmp_gt_i32 s[50:51], 35, v6
    s_nop 1
    v_cndmask_b32 v24, v10, v5, s[44:45]
    v_cndmask_b32 v25, v10, v5, s[46:47]
    v_cndmask_b32 v26, v10, v5, s[48:49]
    v_cndmask_b32 v27, v10, v5, s[50:51]
    v_cndmask_b32 v44, v11, v5, s[44:45]
    v_cndmask_b32 v45, v11, v5, s[46:47]
    v_cndmask_b32 v46, v11, v5, s[48:49]
    v_cndmask_b32 v47, v11, v5, s[50:51]
    v_cmp_gt_i32 s[44:45], 48, v6
    v_cmp_gt_i32 s[46:47], 49, v6
    v_cmp_gt_i32 s[48:49], 50, v6
    v_cmp_gt_i32 s[50:51], 51, v6
    s_nop 1
    v_cndmask_b32 v40, v10, v5, s[44:45]
    v_cndmask_b32 v41, v10, v5, s[46:47]
    v_cndmask_b32 v42, v10, v5, s[48:49]
    v_cndmask_b32 v43, v10, v5, s[50:51]
    s_nop 1
    s_branch k2_prepret_106
k12_ool_10:
    buffer_load_dword v52, v8, s[24:27], 0 offen sc1
    s_branch k12_oolret_11
k12_ool_12:
    s_mov_b64 exec, 1
    buffer_atomic_add v9, v8, s[24:27], 0 offen sc1
    s_mov_b64 exec, -1
    s_branch k12_oolret_13
k12_ool_14:
    buffer_load_dword v51, v50, s[12:15], s56 offen
    s_branch k12_oolret_15
k12_ool_18:
    v_readfirstlane_b32 s31, v52
    s_cmp_ge_u32 s31, 256
    s_cbranch_scc1 spin_ok_16
    s_mov_b32 s40, 1048576
spin_17:
    s_sleep 8
    buffer_load_dword v52, v8, s[24:27], 0 offen sc1
    s_waitcnt vmcnt(0)
    v_readfirstlane_b32 s31, v52
    s_sub_u32 s40, s40, 1
    s_cselect_b32 s31, -1, s31
    s_cmp_lt_u32 s31, 256
    s_cbranch_scc1 spin_17
spin_ok_16:
    s_branch k12_oolret_19
k12_ool_20:
    s_mov_b64 exec, 1
    buffer_atomic_add v9, v8, s[24:27], 0 offen sc1
    s_mov_b64 exec, -1
    s_branch k12_oolret_21
k12_ool_22:
    global_load_dword v51, v[2:3], off
    s_branch k12_oolret_23
k12_ool_26:
    buffer_load_dword v52, v8, s[24:27], 0 offen sc1
    s_branch k12_oolret_27
k12_ool_28:
    s_mov_b64 exec, 1
    buffer_atomic_add v9, v8, s[24:27], 0 offen sc1
    s_mov_b64 exec, -1
    s_branch k12_oolret_29
k12_ool_30:
    buffer_load_dword v51, v50, s[12:15], s56 offen
    s_branch k12_oolret_31
k12_ool_34:
    v_readfirstlane_b32 s31, v52
    s_cmp_ge_u32 s31, 256
    s_cbranch_scc1 spin_ok_32
    s_mov_b32 s40, 1048576
spin_33:
    s_sleep 8
    buffer_load_dword v52, v8, s[24:27], 0 offen sc1
    s_waitcnt vmcnt(0)
    v_readfirstlane_b32 s31, v52
    s_sub_u32 s40, s40, 1
    s_cselect_b32 s31, -1, s31
    s_cmp_lt_u32 s31, 256
    s_cbranch_scc1 spin_33
spin_ok_32:
    s_branch k12_oolret_35
k12_ool_36:
    s_mov_b64 exec, 1
    buffer_atomic_add v9, v8, s[24:27], 0 offen sc1
    s_mov_b64 exec, -1
    s_branch k12_oolret_37
k12_ool_38:
    global_load_dword v51, v[2:3], off
    s_branch k12_oolret_39
k12_ool_40:
    s_add_u32 s52, s47, 528384
    buffer_store_dwordx4 v[156:159], v1, s[48:51], s52 offen offset:3072 sc1
    s_branch k12_oolret_41
k12_ool_42:
    s_add_u32 s52, s47, 532480
    buffer_store_dwordx4 v[160:163], v1, s[48:51], s52 offen offset:0 sc1
    s_branch k12_oolret_43
k12_ool_44:
    s_add_u32 s52, s47, 532480
    buffer_store_dwordx4 v[164:167], v1, s[48:51], s52 offen offset:1024 sc1
    s_branch k12_oolret_45
k12_ool_46:
    s_add_u32 s52, s47, 532480
    buffer_store_dwordx4 v[168:171], v1, s[48:51], s52 offen offset:2048 sc1
    s_branch k12_oolret_47
k12_ool_48:
    s_add_u32 s52, s47, 532480
    buffer_store_dwordx4 v[172:175], v1, s[48:51], s52 offen offset:3072 sc1
    s_branch k12_oolret_49
k12_ool_50:
    s_add_u32 s52, s47, 536576
    buffer_store_dwordx4 v[176:179], v1, s[48:51], s52 offen offset:0 sc1
    s_branch k12_oolret_51
k12_ool_52:
    s_add_u32 s52, s47, 536576
    buffer_store_dwordx4 v[180:183], v1, s[48:51], s52 offen offset:1024 sc1
    s_branch k12_oolret_53
k12_ool_54:
    s_add_u32 s52, s47, 536576
    buffer_store_dwordx4 v[184:187], v1, s[48:51], s52 offen offset:2048 sc1
    s_branch k12_oolret_55
k12_ool_56:
    s_add_u32 s52, s47, 536576
    buffer_store_dwordx4 v[188:191], v1, s[48:51], s52 offen offset:3072 sc1
    s_branch k12_oolret_57
k12_ool_58:
    s_mov_b32 s50, 0
    s_branch k12_oolret_59
k12_ool_60:
    s_mov_b64 exec, 1
    buffer_atomic_add v9, v8, s[24:27], s54 offen sc1
    s_mov_b64 exec, -1
    s_branch k12_oolret_61
k12_ool_62:
    buffer_load_dword v52, v8, s[24:27], s55 offen sc1
    s_branch k12_oolret_63
k12_ool_66:
    s_waitcnt vmcnt(14)
    v_readfirstlane_b32 s31, v52
    s_cmp_ge_u32 s31, 2
    s_cbranch_scc1 spin_ok_64
    s_mov_b32 s40, 1048576
spin_65:
    s_sleep 8
    buffer_load_dword v52, v8, s[24:27], s55 offen sc1
    s_waitcnt vmcnt(0)
    v_readfirstlane_b32 s31, v52
    s_sub_u32 s40, s40, 1
    s_cselect_b32 s31, -1, s31
    s_cmp_lt_u32 s31, 2
    s_cbranch_scc1 spin_65
spin_ok_64:
    s_branch k12_oolret_67
k12_ool_68:
    s_mov_b64 exec, 1
    buffer_atomic_add v9, v8, s[24:27], s3 offen sc1
    s_mov_b64 exec, -1
    s_branch k12_oolret_69
k12_ool_72:
    buffer_load_dword v58, v59, s[24:27], s5 offen sc1
    s_branch k12_oolret_73
k12_ool_76:
    s_waitcnt vmcnt(0)
    v_readfirstlane_b32 s31, v58
    s_cmp_ge_u32 s31, 14
    s_cbranch_scc1 spin_ok_74
    s_mov_b32 s40, 1048576
spin_75:
    s_sleep 8
    buffer_load_dword v58, v59, s[24:27], s5 offen sc1
    s_waitcnt vmcnt(0)
    v_readfirstlane_b32 s31, v58
    s_sub_u32 s40, s40, 1
    s_cselect_b32 s31, -1, s31
    s_cmp_lt_u32 s31, 14
    s_cbranch_scc1 spin_75
spin_ok_74:
    s_branch k12_oolret_77
k2_rare_80:
    s_nop 7
    v_max_f32 v52, v128, v129
    v_max3_f32 v52, v52, v130, v131
    v_max3_f32 v52, v52, v144, v145
    v_max3_f32 v52, v52, v146, v147
    v_max_f32 v53, v132, v133
    v_max3_f32 v53, v53, v134, v135
    v_max3_f32 v53, v53, v148, v149
    v_max3_f32 v53, v53, v150, v151
    v_max_f32 v54, v136, v137
    v_max3_f32 v54, v54, v138, v139
    v_max3_f32 v54, v54, v152, v153
    v_max3_f32 v54, v54, v154, v155
    v_max_f32 v55, v140, v141
    v_max3_f32 v55, v55, v142, v143
    v_max3_f32 v55, v55, v156, v157
    v_max3_f32 v55, v55, v158, v159
    v_mov_b32 v224, v52
    v_mov_b32 v225, v53
    v_mov_b32 v226, v54
    v_mov_b32 v227, v55
    s_nop 1
    v_permlane16_swap_b32 v52, v224
    v_permlane16_swap_b32 v53, v225
    v_permlane16_swap_b32 v54, v226
    v_permlane16_swap_b32 v55, v227
    s_nop 1
    v_max_f32 v52, v52, v224
    v_max_f32 v53, v53, v225
    v_max_f32 v54, v54, v226
    v_max_f32 v55, v55, v227
    v_mov_b32 v224, v52
    v_mov_b32 v225, v53
    v_mov_b32 v226, v54
    v_mov_b32 v227, v55
    s_nop 1
    v_permlane32_swap_b32 v52, v224
    v_permlane32_swap_b32 v53, v225
    v_permlane32_swap_b32 v54, v226
    v_permlane32_swap_b32 v55, v227
    s_nop 1
    v_max_f32 v52, v52, v224
    v_max_f32 v53, v53, v225
    v_max_f32 v54, v54, v226
    v_max_f32 v55, v55, v227
    v_add_f32 v52, 0x41400000, v52
    v_max_f32 v52, 0, v52
    v_add_f32 v53, 0x41400000, v53
    v_max_f32 v53, 0, v53
    v_add_f32 v54, 0x41400000, v54
    v_max_f32 v54, 0, v54
    v_add_f32 v55, 0x41400000, v55
    v_max_f32 v55, 0, v55
    v_sub_f32 v128, v128, v52
    v_sub_f32 v129, v129, v52
    v_sub_f32 v130, v130, v52
    v_sub_f32 v131, v131, v52
    v_sub_f32 v132, v132, v53
    v_sub_f32 v133, v133, v53
    v_sub_f32 v134, v134, v53
    v_sub_f32 v135, v135, v53
    v_sub_f32 v136, v136, v54
    v_sub_f32 v137, v137, v54
    v_sub_f32 v138, v138, v54
    v_sub_f32 v139, v139, v54
    v_sub_f32 v140, v140, v55
    v_sub_f32 v141, v141, v55
    v_sub_f32 v142, v142, v55
    v_sub_f32 v143, v143, v55
    v_sub_f32 v144, v144, v52
    v_sub_f32 v145, v145, v52
    v_sub_f32 v146, v146, v52
    v_sub_f32 v147, v147, v52
    v_sub_f32 v148, v148, v53
    v_sub_f32 v149, v149, v53
    v_sub_f32 v150, v150, v53
    v_sub_f32 v151, v151, v53
    v_sub_f32 v152, v152, v54
    v_sub_f32 v153, v153, v54
    v_sub_f32 v154, v154, v54
    v_sub_f32 v155, v155, v54
    v_sub_f32 v156, v156, v55
    v_sub_f32 v157, v157, v55
    v_sub_f32 v158, v158, v55
    v_sub_f32 v159, v159, v55
    v_sub_f32 v160, v160, v52
    v_sub_f32 v16, v16, v52
    v_sub_f32 v161, v161, v52
    v_sub_f32 v17, v17, v52
    v_sub_f32 v162, v162, v52
    v_sub_f32 v18, v18, v52
    v_sub_f32 v163, v163, v52
    v_sub_f32 v19, v19, v52
    v_sub_f32 v164, v164, v53
    v_sub_f32 v20, v20, v53
    v_sub_f32 v165, v165, v53
    v_sub_f32 v21, v21, v53
    v_sub_f32 v166, v166, v53
    v_sub_f32 v22, v22, v53
    v_sub_f32 v167, v167, v53
    v_sub_f32 v23, v23, v53
    v_sub_f32 v168, v168, v54
    v_sub_f32 v24, v24, v54
    v_sub_f32 v169, v169, v54
    v_sub_f32 v25, v25, v54
    v_sub_f32 v170, v170, v54
    v_sub_f32 v26, v26, v54
    v_sub_f32 v171, v171, v54
    v_sub_f32 v27, v27, v54
    v_sub_f32 v172, v172, v55
    v_sub_f32 v28, v28, v55
    v_sub_f32 v173, v173, v55
    v_sub_f32 v29, v29, v55
    v_sub_f32 v174, v174, v55
    v_sub_f32 v30, v30, v55
    v_sub_f32 v175, v175, v55
    v_sub_f32 v31, v31, v55
    v_sub_f32 v176, v176, v52
    v_sub_f32 v32, v32, v52
    v_sub_f32 v177, v177, v52
    v_sub_f32 v33, v33, v52
    v_sub_f32 v178, v178, v52
    v_sub_f32 v34, v34, v52
    v_sub_f32 v179, v179, v52
    v_sub_f32 v35, v35, v52
    v_sub_f32 v180, v180, v53
    v_sub_f32 v36, v36, v53
    v_sub_f32 v181, v181, v53
    v_sub_f32 v37, v37, v53
    v_sub_f32 v182, v182, v53
    v_sub_f32 v38, v38, v53
    v_sub_f32 v183, v183, v53
    v_sub_f32 v39, v39, v53
    v_sub_f32 v184, v184, v54
    v_sub_f32 v40, v40, v54
    v_sub_f32 v185, v185, v54
    v_sub_f32 v41, v41, v54
    v_sub_f32 v186, v186, v54
    v_sub_f32 v42, v42, v54
    v_sub_f32 v187, v187, v54
    v_sub_f32 v43, v43, v54
    v_sub_f32 v188, v188, v55
    v_sub_f32 v44, v44, v55
    v_sub_f32 v189, v189, v55
    v_sub_f32 v45, v45, v55
    v_sub_f32 v190, v190, v55
    v_sub_f32 v46, v46, v55
    v_sub_f32 v191, v191, v55
    v_sub_f32 v47, v47, v55
    v_sub_f32 v8, v8, v52
    v_exp_f32 v52, -v52
    v_sub_f32 v9, v9, v53
    v_exp_f32 v53, -v53
    v_sub_f32 v10, v10, v54
    v_exp_f32 v54, -v54
    v_sub_f32 v11, v11, v55
    v_exp_f32 v55, -v55
    s_nop 0
    v_mul_f32 v12, v12, v52
    v_mul_f32 v48, v48, v53
    v_mul_f32 v248, v248, v54
    v_mul_f32 v252, v252, v55
    v_accvgpr_read_b32 v224, a0
    v_accvgpr_read_b32 v225, a1
    v_accvgpr_read_b32 v226, a2
    v_accvgpr_read_b32 v227, a3
    v_mul_f32 v224, v224, v52
    v_mul_f32 v225, v225, v52
    v_mul_f32 v226, v226, v52
    v_mul_f32 v227, v227, v52
    v_accvgpr_write_b32 a0, v224
    v_accvgpr_write_b32 a1, v225
    v_accvgpr_write_b32 a2, v226
    v_accvgpr_write_b32 a3, v227
    v_accvgpr_read_b32 v224, a4
    v_accvgpr_read_b32 v225, a5
    v_accvgpr_read_b32 v226, a6
    v_accvgpr_read_b32 v227, a7
    v_mul_f32 v224, v224, v53
    v_mul_f32 v225, v225, v53
    v_mul_f32 v226, v226, v53
    v_mul_f32 v227, v227, v53
    v_accvgpr_write_b32 a4, v224
    v_accvgpr_write_b32 a5, v225
    v_accvgpr_write_b32 a6, v226
    v_accvgpr_write_b32 a7, v227
    v_accvgpr_read_b32 v224, a8
    v_accvgpr_read_b32 v225, a9
    v_accvgpr_read_b32 v226, a10
    v_accvgpr_read_b32 v227, a11
    v_mul_f32 v224, v224, v54
    v_mul_f32 v225, v225, v54
    v_mul_f32 v226, v226, v54
    v_mul_f32 v227, v227, v54
    v_accvgpr_write_b32 a8, v224
    v_accvgpr_write_b32 a9, v225
    v_accvgpr_write_b32 a10, v226
    v_accvgpr_write_b32 a11, v227
    v_accvgpr_read_b32 v224, a12
    v_accvgpr_read_b32 v225, a13
    v_accvgpr_read_b32 v226, a14
    v_accvgpr_read_b32 v227, a15
    v_mul_f32 v224, v224, v55
    v_mul_f32 v225, v225, v55
    v_mul_f32 v226, v226, v55
    v_mul_f32 v227, v227, v55
    v_accvgpr_write_b32 a12, v224
    v_accvgpr_write_b32 a13, v225
    v_accvgpr_write_b32 a14, v226
    v_accvgpr_write_b32 a15, v227
    v_accvgpr_read_b32 v224, a16
    v_accvgpr_read_b32 v225, a17
    v_accvgpr_read_b32 v226, a18
    v_accvgpr_read_b32 v227, a19
    v_mul_f32 v224, v224, v52
    v_mul_f32 v225, v225, v52
    v_mul_f32 v226, v226, v52
    v_mul_f32 v227, v227, v52
    v_accvgpr_write_b32 a16, v224
    v_accvgpr_write_b32 a17, v225
    v_accvgpr_write_b32 a18, v226
    v_accvgpr_write_b32 a19, v227
    v_accvgpr_read_b32 v224, a20
    v_accvgpr_read_b32 v225, a21
    v_accvgpr_read_b32 v226, a22
    v_accvgpr_read_b32 v227, a23
    v_mul_f32 v224, v224, v53
    v_mul_f32 v225, v225, v53
    v_mul_f32 v226, v226, v53
    v_mul_f32 v227, v227, v53
    v_accvgpr_write_b32 a20, v224
    v_accvgpr_write_b32 a21, v225
    v_accvgpr_write_b32 a22, v226
    v_accvgpr_write_b32 a23, v227
    v_accvgpr_read_b32 v224, a24
    v_accvgpr_read_b32 v225, a25
    v_accvgpr_read_b32 v226, a26
    v_accvgpr_read_b32 v227, a27
    v_mul_f32 v224, v224, v54
    v_mul_f32 v225, v225, v54
    v_mul_f32 v226, v226, v54
    v_mul_f32 v227, v227, v54
    v_accvgpr_write_b32 a24, v224
    v_accvgpr_write_b32 a25, v225
    v_accvgpr_write_b32 a26, v226
    v_accvgpr_write_b32 a27, v227
    v_accvgpr_read_b32 v224, a28
    v_accvgpr_read_b32 v225, a29
    v_accvgpr_read_b32 v226, a30
    v_accvgpr_read_b32 v227, a31
    v_mul_f32 v224, v224, v55
    v_mul_f32 v225, v225, v55
    v_mul_f32 v226, v226, v55
    v_mul_f32 v227, v227, v55
    v_accvgpr_write_b32 a28, v224
    v_accvgpr_write_b32 a29, v225
    v_accvgpr_write_b32 a30, v226
    v_accvgpr_write_b32 a31, v227
    v_accvgpr_read_b32 v224, a32
    v_accvgpr_read_b32 v225, a33
    v_accvgpr_read_b32 v226, a34
    v_accvgpr_read_b32 v227, a35
    v_mul_f32 v224, v224, v52
    v_mul_f32 v225, v225, v52
    v_mul_f32 v226, v226, v52
    v_mul_f32 v227, v227, v52
    v_accvgpr_write_b32 a32, v224
    v_accvgpr_write_b32 a33, v225
    v_accvgpr_write_b32 a34, v226
    v_accvgpr_write_b32 a35, v227
    v_accvgpr_read_b32 v224, a36
    v_accvgpr_read_b32 v225, a37
    v_accvgpr_read_b32 v226, a38
    v_accvgpr_read_b32 v227, a39
    v_mul_f32 v224, v224, v53
    v_mul_f32 v225, v225, v53
    v_mul_f32 v226, v226, v53
    v_mul_f32 v227, v227, v53
    v_accvgpr_write_b32 a36, v224
    v_accvgpr_write_b32 a37, v225
    v_accvgpr_write_b32 a38, v226
    v_accvgpr_write_b32 a39, v227
    v_accvgpr_read_b32 v224, a40
    v_accvgpr_read_b32 v225, a41
    v_accvgpr_read_b32 v226, a42
    v_accvgpr_read_b32 v227, a43
    v_mul_f32 v224, v224, v54
    v_mul_f32 v225, v225, v54
    v_mul_f32 v226, v226, v54
    v_mul_f32 v227, v227, v54
    v_accvgpr_write_b32 a40, v224
    v_accvgpr_write_b32 a41, v225
    v_accvgpr_write_b32 a42, v226
    v_accvgpr_write_b32 a43, v227
    v_accvgpr_read_b32 v224, a44
    v_accvgpr_read_b32 v225, a45
    v_accvgpr_read_b32 v226, a46
    v_accvgpr_read_b32 v227, a47
    v_mul_f32 v224, v224, v55
    v_mul_f32 v225, v225, v55
    v_mul_f32 v226, v226, v55
    v_mul_f32 v227, v227, v55
    v_accvgpr_write_b32 a44, v224
    v_accvgpr_write_b32 a45, v225
    v_accvgpr_write_b32 a46, v226
    v_accvgpr_write_b32 a47, v227
    v_accvgpr_read_b32 v224, a48
    v_accvgpr_read_b32 v225, a49
    v_accvgpr_read_b32 v226, a50
    v_accvgpr_read_b32 v227, a51
    v_mul_f32 v224, v224, v52
    v_mul_f32 v225, v225, v52
    v_mul_f32 v226, v226, v52
    v_mul_f32 v227, v227, v52
    v_accvgpr_write_b32 a48, v224
    v_accvgpr_write_b32 a49, v225
    v_accvgpr_write_b32 a50, v226
    v_accvgpr_write_b32 a51, v227
    v_accvgpr_read_b32 v224, a52
    v_accvgpr_read_b32 v225, a53
    v_accvgpr_read_b32 v226, a54
    v_accvgpr_read_b32 v227, a55
    v_mul_f32 v224, v224, v53
    v_mul_f32 v225, v225, v53
    v_mul_f32 v226, v226, v53
    v_mul_f32 v227, v227, v53
    v_accvgpr_write_b32 a52, v224
    v_accvgpr_write_b32 a53, v225
    v_accvgpr_write_b32 a54, v226
    v_accvgpr_write_b32 a55, v227
    v_accvgpr_read_b32 v224, a56
    v_accvgpr_read_b32 v225, a57
    v_accvgpr_read_b32 v226, a58
    v_accvgpr_read_b32 v227, a59
    v_mul_f32 v224, v224, v54
    v_mul_f32 v225, v225, v54
    v_mul_f32 v226, v226, v54
    v_mul_f32 v227, v227, v54
    v_accvgpr_write_b32 a56, v224
    v_accvgpr_write_b32 a57, v225
    v_accvgpr_write_b32 a58, v226
    v_accvgpr_write_b32 a59, v227
    v_accvgpr_read_b32 v224, a60
    v_accvgpr_read_b32 v225, a61
    v_accvgpr_read_b32 v226, a62
    v_accvgpr_read_b32 v227, a63
    v_mul_f32 v224, v224, v55
    v_mul_f32 v225, v225, v55
    v_mul_f32 v226, v226, v55
    v_mul_f32 v227, v227, v55
    v_accvgpr_write_b32 a60, v224
    v_accvgpr_write_b32 a61, v225
    v_accvgpr_write_b32 a62, v226
    v_accvgpr_write_b32 a63, v227
    v_accvgpr_read_b32 v224, a64
    v_accvgpr_read_b32 v225, a65
    v_accvgpr_read_b32 v226, a66
    v_accvgpr_read_b32 v227, a67
    v_mul_f32 v224, v224, v52
    v_mul_f32 v225, v225, v52
    v_mul_f32 v226, v226, v52
    v_mul_f32 v227, v227, v52
    v_accvgpr_write_b32 a64, v224
    v_accvgpr_write_b32 a65, v225
    v_accvgpr_write_b32 a66, v226
    v_accvgpr_write_b32 a67, v227
    v_accvgpr_read_b32 v224, a68
    v_accvgpr_read_b32 v225, a69
    v_accvgpr_read_b32 v226, a70
    v_accvgpr_read_b32 v227, a71
    v_mul_f32 v224, v224, v53
    v_mul_f32 v225, v225, v53
    v_mul_f32 v226, v226, v53
    v_mul_f32 v227, v227, v53
    v_accvgpr_write_b32 a68, v224
    v_accvgpr_write_b32 a69, v225
    v_accvgpr_write_b32 a70, v226
    v_accvgpr_write_b32 a71, v227
    v_accvgpr_read_b32 v224, a72
    v_accvgpr_read_b32 v225, a73
    v_accvgpr_read_b32 v226, a74
    v_accvgpr_read_b32 v227, a75
    v_mul_f32 v224, v224, v54
    v_mul_f32 v225, v225, v54
    v_mul_f32 v226, v226, v54
    v_mul_f32 v227, v227, v54
    v_accvgpr_write_b32 a72, v224
    v_accvgpr_write_b32 a73, v225
    v_accvgpr_write_b32 a74, v226
    v_accvgpr_write_b32 a75, v227
    v_accvgpr_read_b32 v224, a76
    v_accvgpr_read_b32 v225, a77
    v_accvgpr_read_b32 v226, a78
    v_accvgpr_read_b32 v227, a79
    v_mul_f32 v224, v224, v55
    v_mul_f32 v225, v225, v55
    v_mul_f32 v226, v226, v55
    v_mul_f32 v227, v227, v55
    v_accvgpr_write_b32 a76, v224
    v_accvgpr_write_b32 a77, v225
    v_accvgpr_write_b32 a78, v226
    v_accvgpr_write_b32 a79, v227
    v_accvgpr_read_b32 v224, a80
    v_accvgpr_read_b32 v225, a81
    v_accvgpr_read_b32 v226, a82
    v_accvgpr_read_b32 v227, a83
    v_mul_f32 v224, v224, v52
    v_mul_f32 v225, v225, v52
    v_mul_f32 v226, v226, v52
    v_mul_f32 v227, v227, v52
    v_accvgpr_write_b32 a80, v224
    v_accvgpr_write_b32 a81, v225
    v_accvgpr_write_b32 a82, v226
    v_accvgpr_write_b32 a83, v227
    v_accvgpr_read_b32 v224, a84
    v_accvgpr_read_b32 v225, a85
    v_accvgpr_read_b32 v226, a86
    v_accvgpr_read_b32 v227, a87
    v_mul_f32 v224, v224, v53
    v_mul_f32 v225, v225, v53
    v_mul_f32 v226, v226, v53
    v_mul_f32 v227, v227, v53
    v_accvgpr_write_b32 a84, v224
    v_accvgpr_write_b32 a85, v225
    v_accvgpr_write_b32 a86, v226
    v_accvgpr_write_b32 a87, v227
    v_accvgpr_read_b32 v224, a88
    v_accvgpr_read_b32 v225, a89
    v_accvgpr_read_b32 v226, a90
    v_accvgpr_read_b32 v227, a91
    v_mul_f32 v224, v224, v54
    v_mul_f32 v225, v225, v54
    v_mul_f32 v226, v226, v54
    v_mul_f32 v227, v227, v54
    v_accvgpr_write_b32 a88, v224
    v_accvgpr_write_b32 a89, v225
    v_accvgpr_write_b32 a90, v226
    v_accvgpr_write_b32 a91, v227
    v_accvgpr_read_b32 v224, a92
    v_accvgpr_read_b32 v225, a93
    v_accvgpr_read_b32 v226, a94
    v_accvgpr_read_b32 v227, a95
    v_mul_f32 v224, v224, v55
    v_mul_f32 v225, v225, v55
    v_mul_f32 v226, v226, v55
    v_mul_f32 v227, v227, v55
    v_accvgpr_write_b32 a92, v224
    v_accvgpr_write_b32 a93, v225
    v_accvgpr_write_b32 a94, v226
    v_accvgpr_write_b32 a95, v227
    v_accvgpr_read_b32 v224, a96
    v_accvgpr_read_b32 v225, a97
    v_accvgpr_read_b32 v226, a98
    v_accvgpr_read_b32 v227, a99
    v_mul_f32 v224, v224, v52
    v_mul_f32 v225, v225, v52
    v_mul_f32 v226, v226, v52
    v_mul_f32 v227, v227, v52
    v_accvgpr_write_b32 a96, v224
    v_accvgpr_write_b32 a97, v225
    v_accvgpr_write_b32 a98, v226
    v_accvgpr_write_b32 a99, v227
    v_accvgpr_read_b32 v224, a100
    v_accvgpr_read_b32 v225, a101
    v_accvgpr_read_b32 v226, a102
    v_accvgpr_read_b32 v227, a103
    v_mul_f32 v224, v224, v53
    v_mul_f32 v225, v225, v53
    v_mul_f32 v226, v226, v53
    v_mul_f32 v227, v227, v53
    v_accvgpr_write_b32 a100, v224
    v_accvgpr_write_b32 a101, v225
    v_accvgpr_write_b32 a102, v226
    v_accvgpr_write_b32 a103, v227
    v_accvgpr_read_b32 v224, a104
    v_accvgpr_read_b32 v225, a105
    v_accvgpr_read_b32 v226, a106
    v_accvgpr_read_b32 v227, a107
    v_mul_f32 v224, v224, v54
    v_mul_f32 v225, v225, v54
    v_mul_f32 v226, v226, v54
    v_mul_f32 v227, v227, v54
    v_accvgpr_write_b32 a104, v224
    v_accvgpr_write_b32 a105, v225
    v_accvgpr_write_b32 a106, v226
    v_accvgpr_write_b32 a107, v227
    v_accvgpr_read_b32 v224, a108
    v_accvgpr_read_b32 v225, a109
    v_accvgpr_read_b32 v226, a110
    v_accvgpr_read_b32 v227, a111
    v_mul_f32 v224, v224, v55
    v_mul_f32 v225, v225, v55
    v_mul_f32 v226, v226, v55
    v_mul_f32 v227, v227, v55
    v_accvgpr_write_b32 a108, v224
    v_accvgpr_write_b32 a109, v225
    v_accvgpr_write_b32 a110, v226
    v_accvgpr_write_b32 a111, v227
    v_accvgpr_read_b32 v224, a112
    v_accvgpr_read_b32 v225, a113
    v_accvgpr_read_b32 v226, a114
    v_accvgpr_read_b32 v227, a115
    v_mul_f32 v224, v224, v52
    v_mul_f32 v225, v225, v52
    v_mul_f32 v226, v226, v52
    v_mul_f32 v227, v227, v52
    v_accvgpr_write_b32 a112, v224
    v_accvgpr_write_b32 a113, v225
    v_accvgpr_write_b32 a114, v226
    v_accvgpr_write_b32 a115, v227
    v_accvgpr_read_b32 v224, a116
    v_accvgpr_read_b32 v225, a117
    v_accvgpr_read_b32 v226, a118
    v_accvgpr_read_b32 v227, a119
    v_mul_f32 v224, v224, v53
    v_mul_f32 v225, v225, v53
    v_mul_f32 v226, v226, v53
    v_mul_f32 v227, v227, v53
    v_accvgpr_write_b32 a116, v224
    v_accvgpr_write_b32 a117, v225
    v_accvgpr_write_b32 a118, v226
    v_accvgpr_write_b32 a119, v227
    v_accvgpr_read_b32 v224, a120
    v_accvgpr_read_b32 v225, a121
    v_accvgpr_read_b32 v226, a122
    v_accvgpr_read_b32 v227, a123
    v_mul_f32 v224, v224, v54
    v_mul_f32 v225, v225, v54
    v_mul_f32 v226, v226, v54
    v_mul_f32 v227, v227, v54
    v_accvgpr_write_b32 a120, v224
    v_accvgpr_write_b32 a121, v225
    v_accvgpr_write_b32 a122, v226
    v_accvgpr_write_b32 a123, v227
    v_accvgpr_read_b32 v224, a124
    v_accvgpr_read_b32 v225, a125
    v_accvgpr_read_b32 v226, a126
    v_accvgpr_read_b32 v227, a127
    v_mul_f32 v224, v224, v55
    v_mul_f32 v225, v225, v55
    v_mul_f32 v226, v226, v55
    v_mul_f32 v227, v227, v55
    v_accvgpr_write_b32 a124, v224
    v_accvgpr_write_b32 a125, v225
    v_accvgpr_write_b32 a126, v226
    v_accvgpr_write_b32 a127, v227
    v_exp_f32 v232, v128
    v_exp_f32 v233, v129
    v_exp_f32 v234, v130
    v_exp_f32 v235, v131
    s_nop 0
    v_cvt_pk_bf16_f32 v192, v232, v233
    v_cvt_pk_bf16_f32 v193, v234, v235
    v_exp_f32 v232, v144
    v_exp_f32 v233, v145
    v_exp_f32 v234, v146
    v_exp_f32 v235, v147
    s_nop 0
    v_cvt_pk_bf16_f32 v194, v232, v233
    v_cvt_pk_bf16_f32 v195, v234, v235
    v_exp_f32 v232, v132
    v_exp_f32 v233, v133
    v_exp_f32 v234, v134
    v_exp_f32 v235, v135
    s_nop 0
    v_cvt_pk_bf16_f32 v196, v232, v233
    v_cvt_pk_bf16_f32 v197, v234, v235
    v_exp_f32 v232, v148
    v_exp_f32 v233, v149
    v_exp_f32 v234, v150
    v_exp_f32 v235, v151
    s_nop 0
    v_cvt_pk_bf16_f32 v198, v232, v233
    v_cvt_pk_bf16_f32 v199, v234, v235
    v_exp_f32 v232, v136
    v_exp_f32 v233, v137
    v_exp_f32 v234, v138
    v_exp_f32 v235, v139
    s_nop 0
    v_cvt_pk_bf16_f32 v200, v232, v233
    v_cvt_pk_bf16_f32 v201, v234, v235
    v_exp_f32 v232, v152
    v_exp_f32 v233, v153
    v_exp_f32 v234, v154
    v_exp_f32 v235, v155
    s_nop 0
    v_cvt_pk_bf16_f32 v202, v232, v233
    v_cvt_pk_bf16_f32 v203, v234, v235
    v_exp_f32 v232, v140
    v_exp_f32 v233, v141
    v_exp_f32 v234, v142
    v_exp_f32 v235, v143
    s_nop 0
    v_cvt_pk_bf16_f32 v204, v232, v233
    v_cvt_pk_bf16_f32 v205, v234, v235
    v_exp_f32 v232, v156
    v_exp_f32 v233, v157
    v_exp_f32 v234, v158
    v_exp_f32 v235, v159
    s_nop 0
    v_cvt_pk_bf16_f32 v206, v232, v233
    v_cvt_pk_bf16_f32 v207, v234, v235
    s_nop 1
    s_branch k2_ret_81
k2_rare_85:
    s_nop 7
    v_max_f32 v52, v160, v161
    v_max3_f32 v52, v52, v162, v163
    v_max3_f32 v52, v52, v176, v177
    v_max3_f32 v52, v52, v178, v179
    v_max_f32 v53, v164, v165
    v_max3_f32 v53, v53, v166, v167
    v_max3_f32 v53, v53, v180, v181
    v_max3_f32 v53, v53, v182, v183
    v_max_f32 v54, v168, v169
    v_max3_f32 v54, v54, v170, v171
    v_max3_f32 v54, v54, v184, v185
    v_max3_f32 v54, v54, v186, v187
    v_max_f32 v55, v172, v173
    v_max3_f32 v55, v55, v174, v175
    v_max3_f32 v55, v55, v188, v189
    v_max3_f32 v55, v55, v190, v191
    v_mov_b32 v224, v52
    v_mov_b32 v225, v53
    v_mov_b32 v226, v54
    v_mov_b32 v227, v55
    s_nop 1
    v_permlane16_swap_b32 v52, v224
    v_permlane16_swap_b32 v53, v225
    v_permlane16_swap_b32 v54, v226
    v_permlane16_swap_b32 v55, v227
    s_nop 1
    v_max_f32 v52, v52, v224
    v_max_f32 v53, v53, v225
    v_max_f32 v54, v54, v226
    v_max_f32 v55, v55, v227
    v_mov_b32 v224, v52
    v_mov_b32 v225, v53
    v_mov_b32 v226, v54
    v_mov_b32 v227, v55
    s_nop 1
    v_permlane32_swap_b32 v52, v224
    v_permlane32_swap_b32 v53, v225
    v_permlane32_swap_b32 v54, v226
    v_permlane32_swap_b32 v55, v227
    s_nop 1
    v_max_f32 v52, v52, v224
    v_max_f32 v53, v53, v225
    v_max_f32 v54, v54, v226
    v_max_f32 v55, v55, v227
    v_add_f32 v52, 0x41400000, v52
    v_max_f32 v52, 0, v52
    v_add_f32 v53, 0x41400000, v53
    v_max_f32 v53, 0, v53
    v_add_f32 v54, 0x41400000, v54
    v_max_f32 v54, 0, v54
    v_add_f32 v55, 0x41400000, v55
    v_max_f32 v55, 0, v55
    v_sub_f32 v160, v160, v52
    v_sub_f32 v161, v161, v52
    v_sub_f32 v162, v162, v52
    v_sub_f32 v163, v163, v52
    v_sub_f32 v164, v164, v53
    v_sub_f32 v165, v165, v53
    v_sub_f32 v166, v166, v53
    v_sub_f32 v167, v167, v53
    v_sub_f32 v168, v168, v54
    v_sub_f32 v169, v169, v54
    v_sub_f32 v170, v170, v54
    v_sub_f32 v171, v171, v54
    v_sub_f32 v172, v172, v55
    v_sub_f32 v173, v173, v55
    v_sub_f32 v174, v174, v55
    v_sub_f32 v175, v175, v55
    v_sub_f32 v176, v176, v52
    v_sub_f32 v177, v177, v52
    v_sub_f32 v178, v178, v52
    v_sub_f32 v179, v179, v52
    v_sub_f32 v180, v180, v53
    v_sub_f32 v181, v181, v53
    v_sub_f32 v182, v182, v53
    v_sub_f32 v183, v183, v53
    v_sub_f32 v184, v184, v54
    v_sub_f32 v185, v185, v54
    v_sub_f32 v186, v186, v54
    v_sub_f32 v187, v187, v54
    v_sub_f32 v188, v188, v55
    v_sub_f32 v189, v189, v55
    v_sub_f32 v190, v190, v55
    v_sub_f32 v191, v191, v55
    v_sub_f32 v128, v128, v52
    v_sub_f32 v16, v16, v52
    v_sub_f32 v129, v129, v52
    v_sub_f32 v17, v17, v52
    v_sub_f32 v130, v130, v52
    v_sub_f32 v18, v18, v52
    v_sub_f32 v131, v131, v52
    v_sub_f32 v19, v19, v52
    v_sub_f32 v132, v132, v53
    v_sub_f32 v20, v20, v53
    v_sub_f32 v133, v133, v53
    v_sub_f32 v21, v21, v53
    v_sub_f32 v134, v134, v53
    v_sub_f32 v22, v22, v53
    v_sub_f32 v135, v135, v53
    v_sub_f32 v23, v23, v53
    v_sub_f32 v136, v136, v54
    v_sub_f32 v24, v24, v54
    v_sub_f32 v137, v137, v54
    v_sub_f32 v25, v25, v54
    v_sub_f32 v138, v138, v54
    v_sub_f32 v26, v26, v54
    v_sub_f32 v139, v139, v54
    v_sub_f32 v27, v27, v54
    v_sub_f32 v140, v140, v55
    v_sub_f32 v28, v28, v55
    v_sub_f32 v141, v141, v55
    v_sub_f32 v29, v29, v55
    v_sub_f32 v142, v142, v55
    v_sub_f32 v30, v30, v55
    v_sub_f32 v143, v143, v55
    v_sub_f32 v31, v31, v55
    v_sub_f32 v144, v144, v52
    v_sub_f32 v32, v32, v52
    v_sub_f32 v145, v145, v52
    v_sub_f32 v33, v33, v52
    v_sub_f32 v146, v146, v52
    v_sub_f32 v34, v34, v52
    v_sub_f32 v147, v147, v52
    v_sub_f32 v35, v35, v52
    v_sub_f32 v148, v148, v53
    v_sub_f32 v36, v36, v53
    v_sub_f32 v149, v149, v53
    v_sub_f32 v37, v37, v53
    v_sub_f32 v150, v150, v53
    v_sub_f32 v38, v38, v53
    v_sub_f32 v151, v151, v53
    v_sub_f32 v39, v39, v53
    v_sub_f32 v152, v152, v54
    v_sub_f32 v40, v40, v54
    v_sub_f32 v153, v153, v54
    v_sub_f32 v41, v41, v54
    v_sub_f32 v154, v154, v54
    v_sub_f32 v42, v42, v54
    v_sub_f32 v155, v155, v54
    v_sub_f32 v43, v43, v54
    v_sub_f32 v156, v156, v55
    v_sub_f32 v44, v44, v55
    v_sub_f32 v157, v157, v55
    v_sub_f32 v45, v45, v55
    v_sub_f32 v158, v158, v55
    v_sub_f32 v46, v46, v55
    v_sub_f32 v159, v159, v55
    v_sub_f32 v47, v47, v55
    v_sub_f32 v8, v8, v52
    v_exp_f32 v52, -v52
    v_sub_f32 v9, v9, v53
    v_exp_f32 v53, -v53
    v_sub_f32 v10, v10, v54
    v_exp_f32 v54, -v54
    v_sub_f32 v11, v11, v55
    v_exp_f32 v55, -v55
    s_nop 0
    v_mul_f32 v12, v12, v52
    v_mul_f32 v48, v48, v53
    v_mul_f32 v248, v248, v54
    v_mul_f32 v252, v252, v55
    v_accvgpr_read_b32 v224, a0
    v_accvgpr_read_b32 v225, a1
    v_accvgpr_read_b32 v226, a2
    v_accvgpr_read_b32 v227, a3
    v_mul_f32 v224, v224, v52
    v_mul_f32 v225, v225, v52
    v_mul_f32 v226, v226, v52
    v_mul_f32 v227, v227, v52
    v_accvgpr_write_b32 a0, v224
    v_accvgpr_write_b32 a1, v225
    v_accvgpr_write_b32 a2, v226
    v_accvgpr_write_b32 a3, v227
    v_accvgpr_read_b32 v224, a4
    v_accvgpr_read_b32 v225, a5
    v_accvgpr_read_b32 v226, a6
    v_accvgpr_read_b32 v227, a7
    v_mul_f32 v224, v224, v53
    v_mul_f32 v225, v225, v53
    v_mul_f32 v226, v226, v53
    v_mul_f32 v227, v227, v53
    v_accvgpr_write_b32 a4, v224
    v_accvgpr_write_b32 a5, v225
    v_accvgpr_write_b32 a6, v226
    v_accvgpr_write_b32 a7, v227
    v_accvgpr_read_b32 v224, a8
    v_accvgpr_read_b32 v225, a9
    v_accvgpr_read_b32 v226, a10
    v_accvgpr_read_b32 v227, a11
    v_mul_f32 v224, v224, v54
    v_mul_f32 v225, v225, v54
    v_mul_f32 v226, v226, v54
    v_mul_f32 v227, v227, v54
    v_accvgpr_write_b32 a8, v224
    v_accvgpr_write_b32 a9, v225
    v_accvgpr_write_b32 a10, v226
    v_accvgpr_write_b32 a11, v227
    v_accvgpr_read_b32 v224, a12
    v_accvgpr_read_b32 v225, a13
    v_accvgpr_read_b32 v226, a14
    v_accvgpr_read_b32 v227, a15
    v_mul_f32 v224, v224, v55
    v_mul_f32 v225, v225, v55
    v_mul_f32 v226, v226, v55
    v_mul_f32 v227, v227, v55
    v_accvgpr_write_b32 a12, v224
    v_accvgpr_write_b32 a13, v225
    v_accvgpr_write_b32 a14, v226
    v_accvgpr_write_b32 a15, v227
    v_accvgpr_read_b32 v224, a16
    v_accvgpr_read_b32 v225, a17
    v_accvgpr_read_b32 v226, a18
    v_accvgpr_read_b32 v227, a19
    v_mul_f32 v224, v224, v52
    v_mul_f32 v225, v225, v52
    v_mul_f32 v226, v226, v52
    v_mul_f32 v227, v227, v52
    v_accvgpr_write_b32 a16, v224
    v_accvgpr_write_b32 a17, v225
    v_accvgpr_write_b32 a18, v226
    v_accvgpr_write_b32 a19, v227
    v_accvgpr_read_b32 v224, a20
    v_accvgpr_read_b32 v225, a21
    v_accvgpr_read_b32 v226, a22
    v_accvgpr_read_b32 v227, a23
    v_mul_f32 v224, v224, v53
    v_mul_f32 v225, v225, v53
    v_mul_f32 v226, v226, v53
    v_mul_f32 v227, v227, v53
    v_accvgpr_write_b32 a20, v224
    v_accvgpr_write_b32 a21, v225
    v_accvgpr_write_b32 a22, v226
    v_accvgpr_write_b32 a23, v227
    v_accvgpr_read_b32 v224, a24
    v_accvgpr_read_b32 v225, a25
    v_accvgpr_read_b32 v226, a26
    v_accvgpr_read_b32 v227, a27
    v_mul_f32 v224, v224, v54
    v_mul_f32 v225, v225, v54
    v_mul_f32 v226, v226, v54
    v_mul_f32 v227, v227, v54
    v_accvgpr_write_b32 a24, v224
    v_accvgpr_write_b32 a25, v225
    v_accvgpr_write_b32 a26, v226
    v_accvgpr_write_b32 a27, v227
    v_accvgpr_read_b32 v224, a28
    v_accvgpr_read_b32 v225, a29
    v_accvgpr_read_b32 v226, a30
    v_accvgpr_read_b32 v227, a31
    v_mul_f32 v224, v224, v55
    v_mul_f32 v225, v225, v55
    v_mul_f32 v226, v226, v55
    v_mul_f32 v227, v227, v55
    v_accvgpr_write_b32 a28, v224
    v_accvgpr_write_b32 a29, v225
    v_accvgpr_write_b32 a30, v226
    v_accvgpr_write_b32 a31, v227
    v_accvgpr_read_b32 v224, a32
    v_accvgpr_read_b32 v225, a33
    v_accvgpr_read_b32 v226, a34
    v_accvgpr_read_b32 v227, a35
    v_mul_f32 v224, v224, v52
    v_mul_f32 v225, v225, v52
    v_mul_f32 v226, v226, v52
    v_mul_f32 v227, v227, v52
    v_accvgpr_write_b32 a32, v224
    v_accvgpr_write_b32 a33, v225
    v_accvgpr_write_b32 a34, v226
    v_accvgpr_write_b32 a35, v227
    v_accvgpr_read_b32 v224, a36
    v_accvgpr_read_b32 v225, a37
    v_accvgpr_read_b32 v226, a38
    v_accvgpr_read_b32 v227, a39
    v_mul_f32 v224, v224, v53
    v_mul_f32 v225, v225, v53
    v_mul_f32 v226, v226, v53
    v_mul_f32 v227, v227, v53
    v_accvgpr_write_b32 a36, v224
    v_accvgpr_write_b32 a37, v225
    v_accvgpr_write_b32 a38, v226
    v_accvgpr_write_b32 a39, v227
    v_accvgpr_read_b32 v224, a40
    v_accvgpr_read_b32 v225, a41
    v_accvgpr_read_b32 v226, a42
    v_accvgpr_read_b32 v227, a43
    v_mul_f32 v224, v224, v54
    v_mul_f32 v225, v225, v54
    v_mul_f32 v226, v226, v54
    v_mul_f32 v227, v227, v54
    v_accvgpr_write_b32 a40, v224
    v_accvgpr_write_b32 a41, v225
    v_accvgpr_write_b32 a42, v226
    v_accvgpr_write_b32 a43, v227
    v_accvgpr_read_b32 v224, a44
    v_accvgpr_read_b32 v225, a45
    v_accvgpr_read_b32 v226, a46
    v_accvgpr_read_b32 v227, a47
    v_mul_f32 v224, v224, v55
    v_mul_f32 v225, v225, v55
    v_mul_f32 v226, v226, v55
    v_mul_f32 v227, v227, v55
    v_accvgpr_write_b32 a44, v224
    v_accvgpr_write_b32 a45, v225
    v_accvgpr_write_b32 a46, v226
    v_accvgpr_write_b32 a47, v227
    v_accvgpr_read_b32 v224, a48
    v_accvgpr_read_b32 v225, a49
    v_accvgpr_read_b32 v226, a50
    v_accvgpr_read_b32 v227, a51
    v_mul_f32 v224, v224, v52
    v_mul_f32 v225, v225, v52
    v_mul_f32 v226, v226, v52
    v_mul_f32 v227, v227, v52
    v_accvgpr_write_b32 a48, v224
    v_accvgpr_write_b32 a49, v225
    v_accvgpr_write_b32 a50, v226
    v_accvgpr_write_b32 a51, v227
    v_accvgpr_read_b32 v224, a52
    v_accvgpr_read_b32 v225, a53
    v_accvgpr_read_b32 v226, a54
    v_accvgpr_read_b32 v227, a55
    v_mul_f32 v224, v224, v53
    v_mul_f32 v225, v225, v53
    v_mul_f32 v226, v226, v53
    v_mul_f32 v227, v227, v53
    v_accvgpr_write_b32 a52, v224
    v_accvgpr_write_b32 a53, v225
    v_accvgpr_write_b32 a54, v226
    v_accvgpr_write_b32 a55, v227
    v_accvgpr_read_b32 v224, a56
    v_accvgpr_read_b32 v225, a57
    v_accvgpr_read_b32 v226, a58
    v_accvgpr_read_b32 v227, a59
    v_mul_f32 v224, v224, v54
    v_mul_f32 v225, v225, v54
    v_mul_f32 v226, v226, v54
    v_mul_f32 v227, v227, v54
    v_accvgpr_write_b32 a56, v224
    v_accvgpr_write_b32 a57, v225
    v_accvgpr_write_b32 a58, v226
    v_accvgpr_write_b32 a59, v227
    v_accvgpr_read_b32 v224, a60
    v_accvgpr_read_b32 v225, a61
    v_accvgpr_read_b32 v226, a62
    v_accvgpr_read_b32 v227, a63
    v_mul_f32 v224, v224, v55
    v_mul_f32 v225, v225, v55
    v_mul_f32 v226, v226, v55
    v_mul_f32 v227, v227, v55
    v_accvgpr_write_b32 a60, v224
    v_accvgpr_write_b32 a61, v225
    v_accvgpr_write_b32 a62, v226
    v_accvgpr_write_b32 a63, v227
    v_accvgpr_read_b32 v224, a64
    v_accvgpr_read_b32 v225, a65
    v_accvgpr_read_b32 v226, a66
    v_accvgpr_read_b32 v227, a67
    v_mul_f32 v224, v224, v52
    v_mul_f32 v225, v225, v52
    v_mul_f32 v226, v226, v52
    v_mul_f32 v227, v227, v52
    v_accvgpr_write_b32 a64, v224
    v_accvgpr_write_b32 a65, v225
    v_accvgpr_write_b32 a66, v226
    v_accvgpr_write_b32 a67, v227
    v_accvgpr_read_b32 v224, a68
    v_accvgpr_read_b32 v225, a69
    v_accvgpr_read_b32 v226, a70
    v_accvgpr_read_b32 v227, a71
    v_mul_f32 v224, v224, v53
    v_mul_f32 v225, v225, v53
    v_mul_f32 v226, v226, v53
    v_mul_f32 v227, v227, v53
    v_accvgpr_write_b32 a68, v224
    v_accvgpr_write_b32 a69, v225
    v_accvgpr_write_b32 a70, v226
    v_accvgpr_write_b32 a71, v227
    v_accvgpr_read_b32 v224, a72
    v_accvgpr_read_b32 v225, a73
    v_accvgpr_read_b32 v226, a74
    v_accvgpr_read_b32 v227, a75
    v_mul_f32 v224, v224, v54
    v_mul_f32 v225, v225, v54
    v_mul_f32 v226, v226, v54
    v_mul_f32 v227, v227, v54
    v_accvgpr_write_b32 a72, v224
    v_accvgpr_write_b32 a73, v225
    v_accvgpr_write_b32 a74, v226
    v_accvgpr_write_b32 a75, v227
    v_accvgpr_read_b32 v224, a76
    v_accvgpr_read_b32 v225, a77
    v_accvgpr_read_b32 v226, a78
    v_accvgpr_read_b32 v227, a79
    v_mul_f32 v224, v224, v55
    v_mul_f32 v225, v225, v55
    v_mul_f32 v226, v226, v55
    v_mul_f32 v227, v227, v55
    v_accvgpr_write_b32 a76, v224
    v_accvgpr_write_b32 a77, v225
    v_accvgpr_write_b32 a78, v226
    v_accvgpr_write_b32 a79, v227
    v_accvgpr_read_b32 v224, a80
    v_accvgpr_read_b32 v225, a81
    v_accvgpr_read_b32 v226, a82
    v_accvgpr_read_b32 v227, a83
    v_mul_f32 v224, v224, v52
    v_mul_f32 v225, v225, v52
    v_mul_f32 v226, v226, v52
    v_mul_f32 v227, v227, v52
    v_accvgpr_write_b32 a80, v224
    v_accvgpr_write_b32 a81, v225
    v_accvgpr_write_b32 a82, v226
    v_accvgpr_write_b32 a83, v227
    v_accvgpr_read_b32 v224, a84
    v_accvgpr_read_b32 v225, a85
    v_accvgpr_read_b32 v226, a86
    v_accvgpr_read_b32 v227, a87
    v_mul_f32 v224, v224, v53
    v_mul_f32 v225, v225, v53
    v_mul_f32 v226, v226, v53
    v_mul_f32 v227, v227, v53
    v_accvgpr_write_b32 a84, v224
    v_accvgpr_write_b32 a85, v225
    v_accvgpr_write_b32 a86, v226
    v_accvgpr_write_b32 a87, v227
    v_accvgpr_read_b32 v224, a88
    v_accvgpr_read_b32 v225, a89
    v_accvgpr_read_b32 v226, a90
    v_accvgpr_read_b32 v227, a91
    v_mul_f32 v224, v224, v54
    v_mul_f32 v225, v225, v54
    v_mul_f32 v226, v226, v54
    v_mul_f32 v227, v227, v54
    v_accvgpr_write_b32 a88, v224
    v_accvgpr_write_b32 a89, v225
    v_accvgpr_write_b32 a90, v226
    v_accvgpr_write_b32 a91, v227
    v_accvgpr_read_b32 v224, a92
    v_accvgpr_read_b32 v225, a93
    v_accvgpr_read_b32 v226, a94
    v_accvgpr_read_b32 v227, a95
    v_mul_f32 v224, v224, v55
    v_mul_f32 v225, v225, v55
    v_mul_f32 v226, v226, v55
    v_mul_f32 v227, v227, v55
    v_accvgpr_write_b32 a92, v224
    v_accvgpr_write_b32 a93, v225
    v_accvgpr_write_b32 a94, v226
    v_accvgpr_write_b32 a95, v227
    v_accvgpr_read_b32 v224, a96
    v_accvgpr_read_b32 v225, a97
    v_accvgpr_read_b32 v226, a98
    v_accvgpr_read_b32 v227, a99
    v_mul_f32 v224, v224, v52
    v_mul_f32 v225, v225, v52
    v_mul_f32 v226, v226, v52
    v_mul_f32 v227, v227, v52
    v_accvgpr_write_b32 a96, v224
    v_accvgpr_write_b32 a97, v225
    v_accvgpr_write_b32 a98, v226
    v_accvgpr_write_b32 a99, v227
    v_accvgpr_read_b32 v224, a100
    v_accvgpr_read_b32 v225, a101
    v_accvgpr_read_b32 v226, a102
    v_accvgpr_read_b32 v227, a103
    v_mul_f32 v224, v224, v53
    v_mul_f32 v225, v225, v53
    v_mul_f32 v226, v226, v53
    v_mul_f32 v227, v227, v53
    v_accvgpr_write_b32 a100, v224
    v_accvgpr_write_b32 a101, v225
    v_accvgpr_write_b32 a102, v226
    v_accvgpr_write_b32 a103, v227
    v_accvgpr_read_b32 v224, a104
    v_accvgpr_read_b32 v225, a105
    v_accvgpr_read_b32 v226, a106
    v_accvgpr_read_b32 v227, a107
    v_mul_f32 v224, v224, v54
    v_mul_f32 v225, v225, v54
    v_mul_f32 v226, v226, v54
    v_mul_f32 v227, v227, v54
    v_accvgpr_write_b32 a104, v224
    v_accvgpr_write_b32 a105, v225
    v_accvgpr_write_b32 a106, v226
    v_accvgpr_write_b32 a107, v227
    v_accvgpr_read_b32 v224, a108
    v_accvgpr_read_b32 v225, a109
    v_accvgpr_read_b32 v226, a110
    v_accvgpr_read_b32 v227, a111
    v_mul_f32 v224, v224, v55
    v_mul_f32 v225, v225, v55
    v_mul_f32 v226, v226, v55
    v_mul_f32 v227, v227, v55
    v_accvgpr_write_b32 a108, v224
    v_accvgpr_write_b32 a109, v225
    v_accvgpr_write_b32 a110, v226
    v_accvgpr_write_b32 a111, v227
    v_accvgpr_read_b32 v224, a112
    v_accvgpr_read_b32 v225, a113
    v_accvgpr_read_b32 v226, a114
    v_accvgpr_read_b32 v227, a115
    v_mul_f32 v224, v224, v52
    v_mul_f32 v225, v225, v52
    v_mul_f32 v226, v226, v52
    v_mul_f32 v227, v227, v52
    v_accvgpr_write_b32 a112, v224
    v_accvgpr_write_b32 a113, v225
    v_accvgpr_write_b32 a114, v226
    v_accvgpr_write_b32 a115, v227
    v_accvgpr_read_b32 v224, a116
    v_accvgpr_read_b32 v225, a117
    v_accvgpr_read_b32 v226, a118
    v_accvgpr_read_b32 v227, a119
    v_mul_f32 v224, v224, v53
    v_mul_f32 v225, v225, v53
    v_mul_f32 v226, v226, v53
    v_mul_f32 v227, v227, v53
    v_accvgpr_write_b32 a116, v224
    v_accvgpr_write_b32 a117, v225
    v_accvgpr_write_b32 a118, v226
    v_accvgpr_write_b32 a119, v227
    v_accvgpr_read_b32 v224, a120
    v_accvgpr_read_b32 v225, a121
    v_accvgpr_read_b32 v226, a122
    v_accvgpr_read_b32 v227, a123
    v_mul_f32 v224, v224, v54
    v_mul_f32 v225, v225, v54
    v_mul_f32 v226, v226, v54
    v_mul_f32 v227, v227, v54
    v_accvgpr_write_b32 a120, v224
    v_accvgpr_write_b32 a121, v225
    v_accvgpr_write_b32 a122, v226
    v_accvgpr_write_b32 a123, v227
    v_accvgpr_read_b32 v224, a124
    v_accvgpr_read_b32 v225, a125
    v_accvgpr_read_b32 v226, a126
    v_accvgpr_read_b32 v227, a127
    v_mul_f32 v224, v224, v55
    v_mul_f32 v225, v225, v55
    v_mul_f32 v226, v226, v55
    v_mul_f32 v227, v227, v55
    v_accvgpr_write_b32 a124, v224
    v_accvgpr_write_b32 a125, v225
    v_accvgpr_write_b32 a126, v226
    v_accvgpr_write_b32 a127, v227
    v_exp_f32 v232, v160
    v_exp_f32 v233, v161
    v_exp_f32 v234, v162
    v_exp_f32 v235, v163
    s_nop 0
    v_cvt_pk_bf16_f32 v208, v232, v233
    v_cvt_pk_bf16_f32 v209, v234, v235
    v_exp_f32 v232, v176
    v_exp_f32 v233, v177
    v_exp_f32 v234, v178
    v_exp_f32 v235, v179
    s_nop 0
    v_cvt_pk_bf16_f32 v210, v232, v233
    v_cvt_pk_bf16_f32 v211, v234, v235
    v_exp_f32 v232, v164
    v_exp_f32 v233, v165
    v_exp_f32 v234, v166
    v_exp_f32 v235, v167
    s_nop 0
    v_cvt_pk_bf16_f32 v212, v232, v233
    v_cvt_pk_bf16_f32 v213, v234, v235
    v_exp_f32 v232, v180
    v_exp_f32 v233, v181
    v_exp_f32 v234, v182
    v_exp_f32 v235, v183
    s_nop 0
    v_cvt_pk_bf16_f32 v214, v232, v233
    v_cvt_pk_bf16_f32 v215, v234, v235
    v_exp_f32 v232, v168
    v_exp_f32 v233, v169
    v_exp_f32 v234, v170
    v_exp_f32 v235, v171
    s_nop 0
    v_cvt_pk_bf16_f32 v216, v232, v233
    v_cvt_pk_bf16_f32 v217, v234, v235
    v_exp_f32 v232, v184
    v_exp_f32 v233, v185
    v_exp_f32 v234, v186
    v_exp_f32 v235, v187
    s_nop 0
    v_cvt_pk_bf16_f32 v218, v232, v233
    v_cvt_pk_bf16_f32 v219, v234, v235
    v_exp_f32 v232, v172
    v_exp_f32 v233, v173
    v_exp_f32 v234, v174
    v_exp_f32 v235, v175
    s_nop 0
    v_cvt_pk_bf16_f32 v220, v232, v233
    v_cvt_pk_bf16_f32 v221, v234, v235
    v_exp_f32 v232, v188
    v_exp_f32 v233, v189
    v_exp_f32 v234, v190
    v_exp_f32 v235, v191
    s_nop 0
    v_cvt_pk_bf16_f32 v222, v232, v233
    v_cvt_pk_bf16_f32 v223, v234, v235
    s_nop 1
    s_branch k2_ret_86
k2_rare_89:
    s_nop 7
    v_max_f32 v52, v128, v129
    v_max3_f32 v52, v52, v130, v131
    v_max3_f32 v52, v52, v144, v145
    v_max3_f32 v52, v52, v146, v147
    v_max_f32 v53, v132, v133
    v_max3_f32 v53, v53, v134, v135
    v_max3_f32 v53, v53, v148, v149
    v_max3_f32 v53, v53, v150, v151
    v_max_f32 v54, v136, v137
    v_max3_f32 v54, v54, v138, v139
    v_max3_f32 v54, v54, v152, v153
    v_max3_f32 v54, v54, v154, v155
    v_max_f32 v55, v140, v141
    v_max3_f32 v55, v55, v142, v143
    v_max3_f32 v55, v55, v156, v157
    v_max3_f32 v55, v55, v158, v159
    v_mov_b32 v224, v52
    v_mov_b32 v225, v53
    v_mov_b32 v226, v54
    v_mov_b32 v227, v55
    s_nop 1
    v_permlane16_swap_b32 v52, v224
    v_permlane16_swap_b32 v53, v225
    v_permlane16_swap_b32 v54, v226
    v_permlane16_swap_b32 v55, v227
    s_nop 1
    v_max_f32 v52, v52, v224
    v_max_f32 v53, v53, v225
    v_max_f32 v54, v54, v226
    v_max_f32 v55, v55, v227
    v_mov_b32 v224, v52
    v_mov_b32 v225, v53
    v_mov_b32 v226, v54
    v_mov_b32 v227, v55
    s_nop 1
    v_permlane32_swap_b32 v52, v224
    v_permlane32_swap_b32 v53, v225
    v_permlane32_swap_b32 v54, v226
    v_permlane32_swap_b32 v55, v227
    s_nop 1
    v_max_f32 v52, v52, v224
    v_max_f32 v53, v53, v225
    v_max_f32 v54, v54, v226
    v_max_f32 v55, v55, v227
    v_add_f32 v52, 0x41400000, v52
    v_max_f32 v52, 0, v52
    v_add_f32 v53, 0x41400000, v53
    v_max_f32 v53, 0, v53
    v_add_f32 v54, 0x41400000, v54
    v_max_f32 v54, 0, v54
    v_add_f32 v55, 0x41400000, v55
    v_max_f32 v55, 0, v55
    v_sub_f32 v128, v128, v52
    v_sub_f32 v129, v129, v52
    v_sub_f32 v130, v130, v52
    v_sub_f32 v131, v131, v52
    v_sub_f32 v132, v132, v53
    v_sub_f32 v133, v133, v53
    v_sub_f32 v134, v134, v53
    v_sub_f32 v135, v135, v53
    v_sub_f32 v136, v136, v54
    v_sub_f32 v137, v137, v54
    v_sub_f32 v138, v138, v54
    v_sub_f32 v139, v139, v54
    v_sub_f32 v140, v140, v55
    v_sub_f32 v141, v141, v55
    v_sub_f32 v142, v142, v55
    v_sub_f32 v143, v143, v55
    v_sub_f32 v144, v144, v52
    v_sub_f32 v145, v145, v52
    v_sub_f32 v146, v146, v52
    v_sub_f32 v147, v147, v52
    v_sub_f32 v148, v148, v53
    v_sub_f32 v149, v149, v53
    v_sub_f32 v150, v150, v53
    v_sub_f32 v151, v151, v53
    v_sub_f32 v152, v152, v54
    v_sub_f32 v153, v153, v54
    v_sub_f32 v154, v154, v54
    v_sub_f32 v155, v155, v54
    v_sub_f32 v156, v156, v55
    v_sub_f32 v157, v157, v55
    v_sub_f32 v158, v158, v55
    v_sub_f32 v159, v159, v55
    v_sub_f32 v160, v160, v52
    v_sub_f32 v16, v16, v52
    v_sub_f32 v161, v161, v52
    v_sub_f32 v17, v17, v52
    v_sub_f32 v162, v162, v52
    v_sub_f32 v18, v18, v52
    v_sub_f32 v163, v163, v52
    v_sub_f32 v19, v19, v52
    v_sub_f32 v164, v164, v53
    v_sub_f32 v20, v20, v53
    v_sub_f32 v165, v165, v53
    v_sub_f32 v21, v21, v53
    v_sub_f32 v166, v166, v53
    v_sub_f32 v22, v22, v53
    v_sub_f32 v167, v167, v53
    v_sub_f32 v23, v23, v53
    v_sub_f32 v168, v168, v54
    v_sub_f32 v24, v24, v54
    v_sub_f32 v169, v169, v54
    v_sub_f32 v25, v25, v54
    v_sub_f32 v170, v170, v54
    v_sub_f32 v26, v26, v54
    v_sub_f32 v171, v171, v54
    v_sub_f32 v27, v27, v54
    v_sub_f32 v172, v172, v55
    v_sub_f32 v28, v28, v55
    v_sub_f32 v173, v173, v55
    v_sub_f32 v29, v29, v55
    v_sub_f32 v174, v174, v55
    v_sub_f32 v30, v30, v55
    v_sub_f32 v175, v175, v55
    v_sub_f32 v31, v31, v55
    v_sub_f32 v176, v176, v52
    v_sub_f32 v32, v32, v52
    v_sub_f32 v177, v177, v52
    v_sub_f32 v33, v33, v52
    v_sub_f32 v178, v178, v52
    v_sub_f32 v34, v34, v52
    v_sub_f32 v179, v179, v52
    v_sub_f32 v35, v35, v52
    v_sub_f32 v180, v180, v53
    v_sub_f32 v36, v36, v53
    v_sub_f32 v181, v181, v53
    v_sub_f32 v37, v37, v53
    v_sub_f32 v182, v182, v53
    v_sub_f32 v38, v38, v53
    v_sub_f32 v183, v183, v53
    v_sub_f32 v39, v39, v53
    v_sub_f32 v184, v184, v54
    v_sub_f32 v40, v40, v54
    v_sub_f32 v185, v185, v54
    v_sub_f32 v41, v41, v54
    v_sub_f32 v186, v186, v54
    v_sub_f32 v42, v42, v54
    v_sub_f32 v187, v187, v54
    v_sub_f32 v43, v43, v54
    v_sub_f32 v188, v188, v55
    v_sub_f32 v44, v44, v55
    v_sub_f32 v189, v189, v55
    v_sub_f32 v45, v45, v55
    v_sub_f32 v190, v190, v55
    v_sub_f32 v46, v46, v55
    v_sub_f32 v191, v191, v55
    v_sub_f32 v47, v47, v55
    v_sub_f32 v8, v8, v52
    v_exp_f32 v52, -v52
    v_sub_f32 v9, v9, v53
    v_exp_f32 v53, -v53
    v_sub_f32 v10, v10, v54
    v_exp_f32 v54, -v54
    v_sub_f32 v11, v11, v55
    v_exp_f32 v55, -v55
    s_nop 0
    v_mul_f32 v12, v12, v52
    v_mul_f32 v48, v48, v53
    v_mul_f32 v248, v248, v54
    v_mul_f32 v252, v252, v55
    v_accvgpr_read_b32 v224, a0
    v_accvgpr_read_b32 v225, a1
    v_accvgpr_read_b32 v226, a2
    v_accvgpr_read_b32 v227, a3
    v_mul_f32 v224, v224, v52
    v_mul_f32 v225, v225, v52
    v_mul_f32 v226, v226, v52
    v_mul_f32 v227, v227, v52
    v_accvgpr_write_b32 a0, v224
    v_accvgpr_write_b32 a1, v225
    v_accvgpr_write_b32 a2, v226
    v_accvgpr_write_b32 a3, v227
    v_accvgpr_read_b32 v224, a4
    v_accvgpr_read_b32 v225, a5
    v_accvgpr_read_b32 v226, a6
    v_accvgpr_read_b32 v227, a7
    v_mul_f32 v224, v224, v53
    v_mul_f32 v225, v225, v53
    v_mul_f32 v226, v226, v53
    v_mul_f32 v227, v227, v53
    v_accvgpr_write_b32 a4, v224
    v_accvgpr_write_b32 a5, v225
    v_accvgpr_write_b32 a6, v226
    v_accvgpr_write_b32 a7, v227
    v_accvgpr_read_b32 v224, a8
    v_accvgpr_read_b32 v225, a9
    v_accvgpr_read_b32 v226, a10
    v_accvgpr_read_b32 v227, a11
    v_mul_f32 v224, v224, v54
    v_mul_f32 v225, v225, v54
    v_mul_f32 v226, v226, v54
    v_mul_f32 v227, v227, v54
    v_accvgpr_write_b32 a8, v224
    v_accvgpr_write_b32 a9, v225
    v_accvgpr_write_b32 a10, v226
    v_accvgpr_write_b32 a11, v227
    v_accvgpr_read_b32 v224, a12
    v_accvgpr_read_b32 v225, a13
    v_accvgpr_read_b32 v226, a14
    v_accvgpr_read_b32 v227, a15
    v_mul_f32 v224, v224, v55
    v_mul_f32 v225, v225, v55
    v_mul_f32 v226, v226, v55
    v_mul_f32 v227, v227, v55
    v_accvgpr_write_b32 a12, v224
    v_accvgpr_write_b32 a13, v225
    v_accvgpr_write_b32 a14, v226
    v_accvgpr_write_b32 a15, v227
    v_accvgpr_read_b32 v224, a16
    v_accvgpr_read_b32 v225, a17
    v_accvgpr_read_b32 v226, a18
    v_accvgpr_read_b32 v227, a19
    v_mul_f32 v224, v224, v52
    v_mul_f32 v225, v225, v52
    v_mul_f32 v226, v226, v52
    v_mul_f32 v227, v227, v52
    v_accvgpr_write_b32 a16, v224
    v_accvgpr_write_b32 a17, v225
    v_accvgpr_write_b32 a18, v226
    v_accvgpr_write_b32 a19, v227
    v_accvgpr_read_b32 v224, a20
    v_accvgpr_read_b32 v225, a21
    v_accvgpr_read_b32 v226, a22
    v_accvgpr_read_b32 v227, a23
    v_mul_f32 v224, v224, v53
    v_mul_f32 v225, v225, v53
    v_mul_f32 v226, v226, v53
    v_mul_f32 v227, v227, v53
    v_accvgpr_write_b32 a20, v224
    v_accvgpr_write_b32 a21, v225
    v_accvgpr_write_b32 a22, v226
    v_accvgpr_write_b32 a23, v227
    v_accvgpr_read_b32 v224, a24
    v_accvgpr_read_b32 v225, a25
    v_accvgpr_read_b32 v226, a26
    v_accvgpr_read_b32 v227, a27
    v_mul_f32 v224, v224, v54
    v_mul_f32 v225, v225, v54
    v_mul_f32 v226, v226, v54
    v_mul_f32 v227, v227, v54
    v_accvgpr_write_b32 a24, v224
    v_accvgpr_write_b32 a25, v225
    v_accvgpr_write_b32 a26, v226
    v_accvgpr_write_b32 a27, v227
    v_accvgpr_read_b32 v224, a28
    v_accvgpr_read_b32 v225, a29
    v_accvgpr_read_b32 v226, a30
    v_accvgpr_read_b32 v227, a31
    v_mul_f32 v224, v224, v55
    v_mul_f32 v225, v225, v55
    v_mul_f32 v226, v226, v55
    v_mul_f32 v227, v227, v55
    v_accvgpr_write_b32 a28, v224
    v_accvgpr_write_b32 a29, v225
    v_accvgpr_write_b32 a30, v226
    v_accvgpr_write_b32 a31, v227
    v_accvgpr_read_b32 v224, a32
    v_accvgpr_read_b32 v225, a33
    v_accvgpr_read_b32 v226, a34
    v_accvgpr_read_b32 v227, a35
    v_mul_f32 v224, v224, v52
    v_mul_f32 v225, v225, v52
    v_mul_f32 v226, v226, v52
    v_mul_f32 v227, v227, v52
    v_accvgpr_write_b32 a32, v224
    v_accvgpr_write_b32 a33, v225
    v_accvgpr_write_b32 a34, v226
    v_accvgpr_write_b32 a35, v227
    v_accvgpr_read_b32 v224, a36
    v_accvgpr_read_b32 v225, a37
    v_accvgpr_read_b32 v226, a38
    v_accvgpr_read_b32 v227, a39
    v_mul_f32 v224, v224, v53
    v_mul_f32 v225, v225, v53
    v_mul_f32 v226, v226, v53
    v_mul_f32 v227, v227, v53
    v_accvgpr_write_b32 a36, v224
    v_accvgpr_write_b32 a37, v225
    v_accvgpr_write_b32 a38, v226
    v_accvgpr_write_b32 a39, v227
    v_accvgpr_read_b32 v224, a40
    v_accvgpr_read_b32 v225, a41
    v_accvgpr_read_b32 v226, a42
    v_accvgpr_read_b32 v227, a43
    v_mul_f32 v224, v224, v54
    v_mul_f32 v225, v225, v54
    v_mul_f32 v226, v226, v54
    v_mul_f32 v227, v227, v54
    v_accvgpr_write_b32 a40, v224
    v_accvgpr_write_b32 a41, v225
    v_accvgpr_write_b32 a42, v226
    v_accvgpr_write_b32 a43, v227
    v_accvgpr_read_b32 v224, a44
    v_accvgpr_read_b32 v225, a45
    v_accvgpr_read_b32 v226, a46
    v_accvgpr_read_b32 v227, a47
    v_mul_f32 v224, v224, v55
    v_mul_f32 v225, v225, v55
    v_mul_f32 v226, v226, v55
    v_mul_f32 v227, v227, v55
    v_accvgpr_write_b32 a44, v224
    v_accvgpr_write_b32 a45, v225
    v_accvgpr_write_b32 a46, v226
    v_accvgpr_write_b32 a47, v227
    v_accvgpr_read_b32 v224, a48
    v_accvgpr_read_b32 v225, a49
    v_accvgpr_read_b32 v226, a50
    v_accvgpr_read_b32 v227, a51
    v_mul_f32 v224, v224, v52
    v_mul_f32 v225, v225, v52
    v_mul_f32 v226, v226, v52
    v_mul_f32 v227, v227, v52
    v_accvgpr_write_b32 a48, v224
    v_accvgpr_write_b32 a49, v225
    v_accvgpr_write_b32 a50, v226
    v_accvgpr_write_b32 a51, v227
    v_accvgpr_read_b32 v224, a52
    v_accvgpr_read_b32 v225, a53
    v_accvgpr_read_b32 v226, a54
    v_accvgpr_read_b32 v227, a55
    v_mul_f32 v224, v224, v53
    v_mul_f32 v225, v225, v53
    v_mul_f32 v226, v226, v53
    v_mul_f32 v227, v227, v53
    v_accvgpr_write_b32 a52, v224
    v_accvgpr_write_b32 a53, v225
    v_accvgpr_write_b32 a54, v226
    v_accvgpr_write_b32 a55, v227
    v_accvgpr_read_b32 v224, a56
    v_accvgpr_read_b32 v225, a57
    v_accvgpr_read_b32 v226, a58
    v_accvgpr_read_b32 v227, a59
    v_mul_f32 v224, v224, v54
    v_mul_f32 v225, v225, v54
    v_mul_f32 v226, v226, v54
    v_mul_f32 v227, v227, v54
    v_accvgpr_write_b32 a56, v224
    v_accvgpr_write_b32 a57, v225
    v_accvgpr_write_b32 a58, v226
    v_accvgpr_write_b32 a59, v227
    v_accvgpr_read_b32 v224, a60
    v_accvgpr_read_b32 v225, a61
    v_accvgpr_read_b32 v226, a62
    v_accvgpr_read_b32 v227, a63
    v_mul_f32 v224, v224, v55
    v_mul_f32 v225, v225, v55
    v_mul_f32 v226, v226, v55
    v_mul_f32 v227, v227, v55
    v_accvgpr_write_b32 a60, v224
    v_accvgpr_write_b32 a61, v225
    v_accvgpr_write_b32 a62, v226
    v_accvgpr_write_b32 a63, v227
    v_accvgpr_read_b32 v224, a64
    v_accvgpr_read_b32 v225, a65
    v_accvgpr_read_b32 v226, a66
    v_accvgpr_read_b32 v227, a67
    v_mul_f32 v224, v224, v52
    v_mul_f32 v225, v225, v52
    v_mul_f32 v226, v226, v52
    v_mul_f32 v227, v227, v52
    v_accvgpr_write_b32 a64, v224
    v_accvgpr_write_b32 a65, v225
    v_accvgpr_write_b32 a66, v226
    v_accvgpr_write_b32 a67, v227
    v_accvgpr_read_b32 v224, a68
    v_accvgpr_read_b32 v225, a69
    v_accvgpr_read_b32 v226, a70
    v_accvgpr_read_b32 v227, a71
    v_mul_f32 v224, v224, v53
    v_mul_f32 v225, v225, v53
    v_mul_f32 v226, v226, v53
    v_mul_f32 v227, v227, v53
    v_accvgpr_write_b32 a68, v224
    v_accvgpr_write_b32 a69, v225
    v_accvgpr_write_b32 a70, v226
    v_accvgpr_write_b32 a71, v227
    v_accvgpr_read_b32 v224, a72
    v_accvgpr_read_b32 v225, a73
    v_accvgpr_read_b32 v226, a74
    v_accvgpr_read_b32 v227, a75
    v_mul_f32 v224, v224, v54
    v_mul_f32 v225, v225, v54
    v_mul_f32 v226, v226, v54
    v_mul_f32 v227, v227, v54
    v_accvgpr_write_b32 a72, v224
    v_accvgpr_write_b32 a73, v225
    v_accvgpr_write_b32 a74, v226
    v_accvgpr_write_b32 a75, v227
    v_accvgpr_read_b32 v224, a76
    v_accvgpr_read_b32 v225, a77
    v_accvgpr_read_b32 v226, a78
    v_accvgpr_read_b32 v227, a79
    v_mul_f32 v224, v224, v55
    v_mul_f32 v225, v225, v55
    v_mul_f32 v226, v226, v55
    v_mul_f32 v227, v227, v55
    v_accvgpr_write_b32 a76, v224
    v_accvgpr_write_b32 a77, v225
    v_accvgpr_write_b32 a78, v226
    v_accvgpr_write_b32 a79, v227
    v_accvgpr_read_b32 v224, a80
    v_accvgpr_read_b32 v225, a81
    v_accvgpr_read_b32 v226, a82
    v_accvgpr_read_b32 v227, a83
    v_mul_f32 v224, v224, v52
    v_mul_f32 v225, v225, v52
    v_mul_f32 v226, v226, v52
    v_mul_f32 v227, v227, v52
    v_accvgpr_write_b32 a80, v224
    v_accvgpr_write_b32 a81, v225
    v_accvgpr_write_b32 a82, v226
    v_accvgpr_write_b32 a83, v227
    v_accvgpr_read_b32 v224, a84
    v_accvgpr_read_b32 v225, a85
    v_accvgpr_read_b32 v226, a86
    v_accvgpr_read_b32 v227, a87
    v_mul_f32 v224, v224, v53
    v_mul_f32 v225, v225, v53
    v_mul_f32 v226, v226, v53
    v_mul_f32 v227, v227, v53
    v_accvgpr_write_b32 a84, v224
    v_accvgpr_write_b32 a85, v225
    v_accvgpr_write_b32 a86, v226
    v_accvgpr_write_b32 a87, v227
    v_accvgpr_read_b32 v224, a88
    v_accvgpr_read_b32 v225, a89
    v_accvgpr_read_b32 v226, a90
    v_accvgpr_read_b32 v227, a91
    v_mul_f32 v224, v224, v54
    v_mul_f32 v225, v225, v54
    v_mul_f32 v226, v226, v54
    v_mul_f32 v227, v227, v54
    v_accvgpr_write_b32 a88, v224
    v_accvgpr_write_b32 a89, v225
    v_accvgpr_write_b32 a90, v226
    v_accvgpr_write_b32 a91, v227
    v_accvgpr_read_b32 v224, a92
    v_accvgpr_read_b32 v225, a93
    v_accvgpr_read_b32 v226, a94
    v_accvgpr_read_b32 v227, a95
    v_mul_f32 v224, v224, v55
    v_mul_f32 v225, v225, v55
    v_mul_f32 v226, v226, v55
    v_mul_f32 v227, v227, v55
    v_accvgpr_write_b32 a92, v224
    v_accvgpr_write_b32 a93, v225
    v_accvgpr_write_b32 a94, v226
    v_accvgpr_write_b32 a95, v227
    v_accvgpr_read_b32 v224, a96
    v_accvgpr_read_b32 v225, a97
    v_accvgpr_read_b32 v226, a98
    v_accvgpr_read_b32 v227, a99
    v_mul_f32 v224, v224, v52
    v_mul_f32 v225, v225, v52
    v_mul_f32 v226, v226, v52
    v_mul_f32 v227, v227, v52
    v_accvgpr_write_b32 a96, v224
    v_accvgpr_write_b32 a97, v225
    v_accvgpr_write_b32 a98, v226
    v_accvgpr_write_b32 a99, v227
    v_accvgpr_read_b32 v224, a100
    v_accvgpr_read_b32 v225, a101
    v_accvgpr_read_b32 v226, a102
    v_accvgpr_read_b32 v227, a103
    v_mul_f32 v224, v224, v53
    v_mul_f32 v225, v225, v53
    v_mul_f32 v226, v226, v53
    v_mul_f32 v227, v227, v53
    v_accvgpr_write_b32 a100, v224
    v_accvgpr_write_b32 a101, v225
    v_accvgpr_write_b32 a102, v226
    v_accvgpr_write_b32 a103, v227
    v_accvgpr_read_b32 v224, a104
    v_accvgpr_read_b32 v225, a105
    v_accvgpr_read_b32 v226, a106
    v_accvgpr_read_b32 v227, a107
    v_mul_f32 v224, v224, v54
    v_mul_f32 v225, v225, v54
    v_mul_f32 v226, v226, v54
    v_mul_f32 v227, v227, v54
    v_accvgpr_write_b32 a104, v224
    v_accvgpr_write_b32 a105, v225
    v_accvgpr_write_b32 a106, v226
    v_accvgpr_write_b32 a107, v227
    v_accvgpr_read_b32 v224, a108
    v_accvgpr_read_b32 v225, a109
    v_accvgpr_read_b32 v226, a110
    v_accvgpr_read_b32 v227, a111
    v_mul_f32 v224, v224, v55
    v_mul_f32 v225, v225, v55
    v_mul_f32 v226, v226, v55
    v_mul_f32 v227, v227, v55
    v_accvgpr_write_b32 a108, v224
    v_accvgpr_write_b32 a109, v225
    v_accvgpr_write_b32 a110, v226
    v_accvgpr_write_b32 a111, v227
    v_accvgpr_read_b32 v224, a112
    v_accvgpr_read_b32 v225, a113
    v_accvgpr_read_b32 v226, a114
    v_accvgpr_read_b32 v227, a115
    v_mul_f32 v224, v224, v52
    v_mul_f32 v225, v225, v52
    v_mul_f32 v226, v226, v52
    v_mul_f32 v227, v227, v52
    v_accvgpr_write_b32 a112, v224
    v_accvgpr_write_b32 a113, v225
    v_accvgpr_write_b32 a114, v226
    v_accvgpr_write_b32 a115, v227
    v_accvgpr_read_b32 v224, a116
    v_accvgpr_read_b32 v225, a117
    v_accvgpr_read_b32 v226, a118
    v_accvgpr_read_b32 v227, a119
    v_mul_f32 v224, v224, v53
    v_mul_f32 v225, v225, v53
    v_mul_f32 v226, v226, v53
    v_mul_f32 v227, v227, v53
    v_accvgpr_write_b32 a116, v224
    v_accvgpr_write_b32 a117, v225
    v_accvgpr_write_b32 a118, v226
    v_accvgpr_write_b32 a119, v227
    v_accvgpr_read_b32 v224, a120
    v_accvgpr_read_b32 v225, a121
    v_accvgpr_read_b32 v226, a122
    v_accvgpr_read_b32 v227, a123
    v_mul_f32 v224, v224, v54
    v_mul_f32 v225, v225, v54
    v_mul_f32 v226, v226, v54
    v_mul_f32 v227, v227, v54
    v_accvgpr_write_b32 a120, v224
    v_accvgpr_write_b32 a121, v225
    v_accvgpr_write_b32 a122, v226
    v_accvgpr_write_b32 a123, v227
    v_accvgpr_read_b32 v224, a124
    v_accvgpr_read_b32 v225, a125
    v_accvgpr_read_b32 v226, a126
    v_accvgpr_read_b32 v227, a127
    v_mul_f32 v224, v224, v55
    v_mul_f32 v225, v225, v55
    v_mul_f32 v226, v226, v55
    v_mul_f32 v227, v227, v55
    v_accvgpr_write_b32 a124, v224
    v_accvgpr_write_b32 a125, v225
    v_accvgpr_write_b32 a126, v226
    v_accvgpr_write_b32 a127, v227
    v_exp_f32 v232, v128
    v_exp_f32 v233, v129
    v_exp_f32 v234, v130
    v_exp_f32 v235, v131
    s_nop 0
    v_cvt_pk_bf16_f32 v192, v232, v233
    v_cvt_pk_bf16_f32 v193, v234, v235
    v_exp_f32 v232, v144
    v_exp_f32 v233, v145
    v_exp_f32 v234, v146
    v_exp_f32 v235, v147
    s_nop 0
    v_cvt_pk_bf16_f32 v194, v232, v233
    v_cvt_pk_bf16_f32 v195, v234, v235
    v_exp_f32 v232, v132
    v_exp_f32 v233, v133
    v_exp_f32 v234, v134
    v_exp_f32 v235, v135
    s_nop 0
    v_cvt_pk_bf16_f32 v196, v232, v233
    v_cvt_pk_bf16_f32 v197, v234, v235
    v_exp_f32 v232, v148
    v_exp_f32 v233, v149
    v_exp_f32 v234, v150
    v_exp_f32 v235, v151
    s_nop 0
    v_cvt_pk_bf16_f32 v198, v232, v233
    v_cvt_pk_bf16_f32 v199, v234, v235
    v_exp_f32 v232, v136
    v_exp_f32 v233, v137
    v_exp_f32 v234, v138
    v_exp_f32 v235, v139
    s_nop 0
    v_cvt_pk_bf16_f32 v200, v232, v233
    v_cvt_pk_bf16_f32 v201, v234, v235
    v_exp_f32 v232, v152
    v_exp_f32 v233, v153
    v_exp_f32 v234, v154
    v_exp_f32 v235, v155
    s_nop 0
    v_cvt_pk_bf16_f32 v202, v232, v233
    v_cvt_pk_bf16_f32 v203, v234, v235
    v_exp_f32 v232, v140
    v_exp_f32 v233, v141
    v_exp_f32 v234, v142
    v_exp_f32 v235, v143
    s_nop 0
    v_cvt_pk_bf16_f32 v204, v232, v233
    v_cvt_pk_bf16_f32 v205, v234, v235
    v_exp_f32 v232, v156
    v_exp_f32 v233, v157
    v_exp_f32 v234, v158
    v_exp_f32 v235, v159
    s_nop 0
    v_cvt_pk_bf16_f32 v206, v232, v233
    v_cvt_pk_bf16_f32 v207, v234, v235
    s_nop 1
    s_branch k2_ret_90
k2_rare_93:
    s_nop 7
    v_max_f32 v52, v160, v161
    v_max3_f32 v52, v52, v162, v163
    v_max3_f32 v52, v52, v176, v177
    v_max3_f32 v52, v52, v178, v179
    v_max_f32 v53, v164, v165
    v_max3_f32 v53, v53, v166, v167
    v_max3_f32 v53, v53, v180, v181
    v_max3_f32 v53, v53, v182, v183
    v_max_f32 v54, v168, v169
    v_max3_f32 v54, v54, v170, v171
    v_max3_f32 v54, v54, v184, v185
    v_max3_f32 v54, v54, v186, v187
    v_max_f32 v55, v172, v173
    v_max3_f32 v55, v55, v174, v175
    v_max3_f32 v55, v55, v188, v189
    v_max3_f32 v55, v55, v190, v191
    v_mov_b32 v224, v52
    v_mov_b32 v225, v53
    v_mov_b32 v226, v54
    v_mov_b32 v227, v55
    s_nop 1
    v_permlane16_swap_b32 v52, v224
    v_permlane16_swap_b32 v53, v225
    v_permlane16_swap_b32 v54, v226
    v_permlane16_swap_b32 v55, v227
    s_nop 1
    v_max_f32 v52, v52, v224
    v_max_f32 v53, v53, v225
    v_max_f32 v54, v54, v226
    v_max_f32 v55, v55, v227
    v_mov_b32 v224, v52
    v_mov_b32 v225, v53
    v_mov_b32 v226, v54
    v_mov_b32 v227, v55
    s_nop 1
    v_permlane32_swap_b32 v52, v224
    v_permlane32_swap_b32 v53, v225
    v_permlane32_swap_b32 v54, v226
    v_permlane32_swap_b32 v55, v227
    s_nop 1
    v_max_f32 v52, v52, v224
    v_max_f32 v53, v53, v225
    v_max_f32 v54, v54, v226
    v_max_f32 v55, v55, v227
    v_add_f32 v52, 0x41400000, v52
    v_max_f32 v52, 0, v52
    v_add_f32 v53, 0x41400000, v53
    v_max_f32 v53, 0, v53
    v_add_f32 v54, 0x41400000, v54
    v_max_f32 v54, 0, v54
    v_add_f32 v55, 0x41400000, v55
    v_max_f32 v55, 0, v55
    v_sub_f32 v160, v160, v52
    v_sub_f32 v161, v161, v52
    v_sub_f32 v162, v162, v52
    v_sub_f32 v163, v163, v52
    v_sub_f32 v164, v164, v53
    v_sub_f32 v165, v165, v53
    v_sub_f32 v166, v166, v53
    v_sub_f32 v167, v167, v53
    v_sub_f32 v168, v168, v54
    v_sub_f32 v169, v169, v54
    v_sub_f32 v170, v170, v54
    v_sub_f32 v171, v171, v54
    v_sub_f32 v172, v172, v55
    v_sub_f32 v173, v173, v55
    v_sub_f32 v174, v174, v55
    v_sub_f32 v175, v175, v55
    v_sub_f32 v176, v176, v52
    v_sub_f32 v177, v177, v52
    v_sub_f32 v178, v178, v52
    v_sub_f32 v179, v179, v52
    v_sub_f32 v180, v180, v53
    v_sub_f32 v181, v181, v53
    v_sub_f32 v182, v182, v53
    v_sub_f32 v183, v183, v53
    v_sub_f32 v184, v184, v54
    v_sub_f32 v185, v185, v54
    v_sub_f32 v186, v186, v54
    v_sub_f32 v187, v187, v54
    v_sub_f32 v188, v188, v55
    v_sub_f32 v189, v189, v55
    v_sub_f32 v190, v190, v55
    v_sub_f32 v191, v191, v55
    v_sub_f32 v128, v128, v54
    v_sub_f32 v16, v16, v54
    v_sub_f32 v129, v129, v54
    v_sub_f32 v17, v17, v54
    v_sub_f32 v130, v130, v54
    v_sub_f32 v18, v18, v54
    v_sub_f32 v131, v131, v54
    v_sub_f32 v19, v19, v54
    v_sub_f32 v132, v132, v55
    v_sub_f32 v20, v20, v55
    v_sub_f32 v133, v133, v55
    v_sub_f32 v21, v21, v55
    v_sub_f32 v134, v134, v55
    v_sub_f32 v22, v22, v55
    v_sub_f32 v135, v135, v55
    v_sub_f32 v23, v23, v55
    v_sub_f32 v136, v136, v54
    v_sub_f32 v24, v24, v54
    v_sub_f32 v137, v137, v54
    v_sub_f32 v25, v25, v54
    v_sub_f32 v138, v138, v54
    v_sub_f32 v26, v26, v54
    v_sub_f32 v139, v139, v54
    v_sub_f32 v27, v27, v54
    v_sub_f32 v140, v140, v55
    v_sub_f32 v28, v28, v55
    v_sub_f32 v141, v141, v55
    v_sub_f32 v29, v29, v55
    v_sub_f32 v142, v142, v55
    v_sub_f32 v30, v30, v55
    v_sub_f32 v143, v143, v55
    v_sub_f32 v31, v31, v55
    v_sub_f32 v144, v144, v54
    v_sub_f32 v32, v32, v54
    v_sub_f32 v145, v145, v54
    v_sub_f32 v33, v33, v54
    v_sub_f32 v146, v146, v54
    v_sub_f32 v34, v34, v54
    v_sub_f32 v147, v147, v54
    v_sub_f32 v35, v35, v54
    v_sub_f32 v148, v148, v55
    v_sub_f32 v36, v36, v55
    v_sub_f32 v149, v149, v55
    v_sub_f32 v37, v37, v55
    v_sub_f32 v150, v150, v55
    v_sub_f32 v38, v38, v55
    v_sub_f32 v151, v151, v55
    v_sub_f32 v39, v39, v55
    v_sub_f32 v152, v152, v54
    v_sub_f32 v40, v40, v54
    v_sub_f32 v153, v153, v54
    v_sub_f32 v41, v41, v54
    v_sub_f32 v154, v154, v54
    v_sub_f32 v42, v42, v54
    v_sub_f32 v155, v155, v54
    v_sub_f32 v43, v43, v54
    v_sub_f32 v156, v156, v55
    v_sub_f32 v44, v44, v55
    v_sub_f32 v157, v157, v55
    v_sub_f32 v45, v45, v55
    v_sub_f32 v158, v158, v55
    v_sub_f32 v46, v46, v55
    v_sub_f32 v159, v159, v55
    v_sub_f32 v47, v47, v55
    v_sub_f32 v8, v8, v52
    v_exp_f32 v52, -v52
    v_sub_f32 v9, v9, v53
    v_exp_f32 v53, -v53
    v_sub_f32 v10, v10, v54
    v_exp_f32 v54, -v54
    v_sub_f32 v11, v11, v55
    v_exp_f32 v55, -v55
    s_nop 0
    v_mul_f32 v12, v12, v52
    v_mul_f32 v48, v48, v53
    v_mul_f32 v248, v248, v54
    v_mul_f32 v252, v252, v55
    v_accvgpr_read_b32 v224, a0
    v_accvgpr_read_b32 v225, a1
    v_accvgpr_read_b32 v226, a2
    v_accvgpr_read_b32 v227, a3
    v_mul_f32 v224, v224, v52
    v_mul_f32 v225, v225, v52
    v_mul_f32 v226, v226, v52
    v_mul_f32 v227, v227, v52
    v_accvgpr_write_b32 a0, v224
    v_accvgpr_write_b32 a1, v225
    v_accvgpr_write_b32 a2, v226
    v_accvgpr_write_b32 a3, v227
    v_accvgpr_read_b32 v224, a4
    v_accvgpr_read_b32 v225, a5
    v_accvgpr_read_b32 v226, a6
    v_accvgpr_read_b32 v227, a7
    v_mul_f32 v224, v224, v53
    v_mul_f32 v225, v225, v53
    v_mul_f32 v226, v226, v53
    v_mul_f32 v227, v227, v53
    v_accvgpr_write_b32 a4, v224
    v_accvgpr_write_b32 a5, v225
    v_accvgpr_write_b32 a6, v226
    v_accvgpr_write_b32 a7, v227
    v_accvgpr_read_b32 v224, a8
    v_accvgpr_read_b32 v225, a9
    v_accvgpr_read_b32 v226, a10
    v_accvgpr_read_b32 v227, a11
    v_mul_f32 v224, v224, v54
    v_mul_f32 v225, v225, v54
    v_mul_f32 v226, v226, v54
    v_mul_f32 v227, v227, v54
    v_accvgpr_write_b32 a8, v224
    v_accvgpr_write_b32 a9, v225
    v_accvgpr_write_b32 a10, v226
    v_accvgpr_write_b32 a11, v227
    v_accvgpr_read_b32 v224, a12
    v_accvgpr_read_b32 v225, a13
    v_accvgpr_read_b32 v226, a14
    v_accvgpr_read_b32 v227, a15
    v_mul_f32 v224, v224, v55
    v_mul_f32 v225, v225, v55
    v_mul_f32 v226, v226, v55
    v_mul_f32 v227, v227, v55
    v_accvgpr_write_b32 a12, v224
    v_accvgpr_write_b32 a13, v225
    v_accvgpr_write_b32 a14, v226
    v_accvgpr_write_b32 a15, v227
    v_accvgpr_read_b32 v224, a16
    v_accvgpr_read_b32 v225, a17
    v_accvgpr_read_b32 v226, a18
    v_accvgpr_read_b32 v227, a19
    v_mul_f32 v224, v224, v52
    v_mul_f32 v225, v225, v52
    v_mul_f32 v226, v226, v52
    v_mul_f32 v227, v227, v52
    v_accvgpr_write_b32 a16, v224
    v_accvgpr_write_b32 a17, v225
    v_accvgpr_write_b32 a18, v226
    v_accvgpr_write_b32 a19, v227
    v_accvgpr_read_b32 v224, a20
    v_accvgpr_read_b32 v225, a21
    v_accvgpr_read_b32 v226, a22
    v_accvgpr_read_b32 v227, a23
    v_mul_f32 v224, v224, v53
    v_mul_f32 v225, v225, v53
    v_mul_f32 v226, v226, v53
    v_mul_f32 v227, v227, v53
    v_accvgpr_write_b32 a20, v224
    v_accvgpr_write_b32 a21, v225
    v_accvgpr_write_b32 a22, v226
    v_accvgpr_write_b32 a23, v227
    v_accvgpr_read_b32 v224, a24
    v_accvgpr_read_b32 v225, a25
    v_accvgpr_read_b32 v226, a26
    v_accvgpr_read_b32 v227, a27
    v_mul_f32 v224, v224, v54
    v_mul_f32 v225, v225, v54
    v_mul_f32 v226, v226, v54
    v_mul_f32 v227, v227, v54
    v_accvgpr_write_b32 a24, v224
    v_accvgpr_write_b32 a25, v225
    v_accvgpr_write_b32 a26, v226
    v_accvgpr_write_b32 a27, v227
    v_accvgpr_read_b32 v224, a28
    v_accvgpr_read_b32 v225, a29
    v_accvgpr_read_b32 v226, a30
    v_accvgpr_read_b32 v227, a31
    v_mul_f32 v224, v224, v55
    v_mul_f32 v225, v225, v55
    v_mul_f32 v226, v226, v55
    v_mul_f32 v227, v227, v55
    v_accvgpr_write_b32 a28, v224
    v_accvgpr_write_b32 a29, v225
    v_accvgpr_write_b32 a30, v226
    v_accvgpr_write_b32 a31, v227
    v_accvgpr_read_b32 v224, a32
    v_accvgpr_read_b32 v225, a33
    v_accvgpr_read_b32 v226, a34
    v_accvgpr_read_b32 v227, a35
    v_mul_f32 v224, v224, v52
    v_mul_f32 v225, v225, v52
    v_mul_f32 v226, v226, v52
    v_mul_f32 v227, v227, v52
    v_accvgpr_write_b32 a32, v224
    v_accvgpr_write_b32 a33, v225
    v_accvgpr_write_b32 a34, v226
    v_accvgpr_write_b32 a35, v227
    v_accvgpr_read_b32 v224, a36
    v_accvgpr_read_b32 v225, a37
    v_accvgpr_read_b32 v226, a38
    v_accvgpr_read_b32 v227, a39
    v_mul_f32 v224, v224, v53
    v_mul_f32 v225, v225, v53
    v_mul_f32 v226, v226, v53
    v_mul_f32 v227, v227, v53
    v_accvgpr_write_b32 a36, v224
    v_accvgpr_write_b32 a37, v225
    v_accvgpr_write_b32 a38, v226
    v_accvgpr_write_b32 a39, v227
    v_accvgpr_read_b32 v224, a40
    v_accvgpr_read_b32 v225, a41
    v_accvgpr_read_b32 v226, a42
    v_accvgpr_read_b32 v227, a43
    v_mul_f32 v224, v224, v54
    v_mul_f32 v225, v225, v54
    v_mul_f32 v226, v226, v54
    v_mul_f32 v227, v227, v54
    v_accvgpr_write_b32 a40, v224
    v_accvgpr_write_b32 a41, v225
    v_accvgpr_write_b32 a42, v226
    v_accvgpr_write_b32 a43, v227
    v_accvgpr_read_b32 v224, a44
    v_accvgpr_read_b32 v225, a45
    v_accvgpr_read_b32 v226, a46
    v_accvgpr_read_b32 v227, a47
    v_mul_f32 v224, v224, v55
    v_mul_f32 v225, v225, v55
    v_mul_f32 v226, v226, v55
    v_mul_f32 v227, v227, v55
    v_accvgpr_write_b32 a44, v224
    v_accvgpr_write_b32 a45, v225
    v_accvgpr_write_b32 a46, v226
    v_accvgpr_write_b32 a47, v227
    v_accvgpr_read_b32 v224, a48
    v_accvgpr_read_b32 v225, a49
    v_accvgpr_read_b32 v226, a50
    v_accvgpr_read_b32 v227, a51
    v_mul_f32 v224, v224, v52
    v_mul_f32 v225, v225, v52
    v_mul_f32 v226, v226, v52
    v_mul_f32 v227, v227, v52
    v_accvgpr_write_b32 a48, v224
    v_accvgpr_write_b32 a49, v225
    v_accvgpr_write_b32 a50, v226
    v_accvgpr_write_b32 a51, v227
    v_accvgpr_read_b32 v224, a52
    v_accvgpr_read_b32 v225, a53
    v_accvgpr_read_b32 v226, a54
    v_accvgpr_read_b32 v227, a55
    v_mul_f32 v224, v224, v53
    v_mul_f32 v225, v225, v53
    v_mul_f32 v226, v226, v53
    v_mul_f32 v227, v227, v53
    v_accvgpr_write_b32 a52, v224
    v_accvgpr_write_b32 a53, v225
    v_accvgpr_write_b32 a54, v226
    v_accvgpr_write_b32 a55, v227
    v_accvgpr_read_b32 v224, a56
    v_accvgpr_read_b32 v225, a57
    v_accvgpr_read_b32 v226, a58
    v_accvgpr_read_b32 v227, a59
    v_mul_f32 v224, v224, v54
    v_mul_f32 v225, v225, v54
    v_mul_f32 v226, v226, v54
    v_mul_f32 v227, v227, v54
    v_accvgpr_write_b32 a56, v224
    v_accvgpr_write_b32 a57, v225
    v_accvgpr_write_b32 a58, v226
    v_accvgpr_write_b32 a59, v227
    v_accvgpr_read_b32 v224, a60
    v_accvgpr_read_b32 v225, a61
    v_accvgpr_read_b32 v226, a62
    v_accvgpr_read_b32 v227, a63
    v_mul_f32 v224, v224, v55
    v_mul_f32 v225, v225, v55
    v_mul_f32 v226, v226, v55
    v_mul_f32 v227, v227, v55
    v_accvgpr_write_b32 a60, v224
    v_accvgpr_write_b32 a61, v225
    v_accvgpr_write_b32 a62, v226
    v_accvgpr_write_b32 a63, v227
    v_accvgpr_read_b32 v224, a64
    v_accvgpr_read_b32 v225, a65
    v_accvgpr_read_b32 v226, a66
    v_accvgpr_read_b32 v227, a67
    v_mul_f32 v224, v224, v52
    v_mul_f32 v225, v225, v52
    v_mul_f32 v226, v226, v52
    v_mul_f32 v227, v227, v52
    v_accvgpr_write_b32 a64, v224
    v_accvgpr_write_b32 a65, v225
    v_accvgpr_write_b32 a66, v226
    v_accvgpr_write_b32 a67, v227
    v_accvgpr_read_b32 v224, a68
    v_accvgpr_read_b32 v225, a69
    v_accvgpr_read_b32 v226, a70
    v_accvgpr_read_b32 v227, a71
    v_mul_f32 v224, v224, v53
    v_mul_f32 v225, v225, v53
    v_mul_f32 v226, v226, v53
    v_mul_f32 v227, v227, v53
    v_accvgpr_write_b32 a68, v224
    v_accvgpr_write_b32 a69, v225
    v_accvgpr_write_b32 a70, v226
    v_accvgpr_write_b32 a71, v227
    v_accvgpr_read_b32 v224, a72
    v_accvgpr_read_b32 v225, a73
    v_accvgpr_read_b32 v226, a74
    v_accvgpr_read_b32 v227, a75
    v_mul_f32 v224, v224, v54
    v_mul_f32 v225, v225, v54
    v_mul_f32 v226, v226, v54
    v_mul_f32 v227, v227, v54
    v_accvgpr_write_b32 a72, v224
    v_accvgpr_write_b32 a73, v225
    v_accvgpr_write_b32 a74, v226
    v_accvgpr_write_b32 a75, v227
    v_accvgpr_read_b32 v224, a76
    v_accvgpr_read_b32 v225, a77
    v_accvgpr_read_b32 v226, a78
    v_accvgpr_read_b32 v227, a79
    v_mul_f32 v224, v224, v55
    v_mul_f32 v225, v225, v55
    v_mul_f32 v226, v226, v55
    v_mul_f32 v227, v227, v55
    v_accvgpr_write_b32 a76, v224
    v_accvgpr_write_b32 a77, v225
    v_accvgpr_write_b32 a78, v226
    v_accvgpr_write_b32 a79, v227
    v_accvgpr_read_b32 v224, a80
    v_accvgpr_read_b32 v225, a81
    v_accvgpr_read_b32 v226, a82
    v_accvgpr_read_b32 v227, a83
    v_mul_f32 v224, v224, v52
    v_mul_f32 v225, v225, v52
    v_mul_f32 v226, v226, v52
    v_mul_f32 v227, v227, v52
    v_accvgpr_write_b32 a80, v224
    v_accvgpr_write_b32 a81, v225
    v_accvgpr_write_b32 a82, v226
    v_accvgpr_write_b32 a83, v227
    v_accvgpr_read_b32 v224, a84
    v_accvgpr_read_b32 v225, a85
    v_accvgpr_read_b32 v226, a86
    v_accvgpr_read_b32 v227, a87
    v_mul_f32 v224, v224, v53
    v_mul_f32 v225, v225, v53
    v_mul_f32 v226, v226, v53
    v_mul_f32 v227, v227, v53
    v_accvgpr_write_b32 a84, v224
    v_accvgpr_write_b32 a85, v225
    v_accvgpr_write_b32 a86, v226
    v_accvgpr_write_b32 a87, v227
    v_accvgpr_read_b32 v224, a88
    v_accvgpr_read_b32 v225, a89
    v_accvgpr_read_b32 v226, a90
    v_accvgpr_read_b32 v227, a91
    v_mul_f32 v224, v224, v54
    v_mul_f32 v225, v225, v54
    v_mul_f32 v226, v226, v54
    v_mul_f32 v227, v227, v54
    v_accvgpr_write_b32 a88, v224
    v_accvgpr_write_b32 a89, v225
    v_accvgpr_write_b32 a90, v226
    v_accvgpr_write_b32 a91, v227
    v_accvgpr_read_b32 v224, a92
    v_accvgpr_read_b32 v225, a93
    v_accvgpr_read_b32 v226, a94
    v_accvgpr_read_b32 v227, a95
    v_mul_f32 v224, v224, v55
    v_mul_f32 v225, v225, v55
    v_mul_f32 v226, v226, v55
    v_mul_f32 v227, v227, v55
    v_accvgpr_write_b32 a92, v224
    v_accvgpr_write_b32 a93, v225
    v_accvgpr_write_b32 a94, v226
    v_accvgpr_write_b32 a95, v227
    v_accvgpr_read_b32 v224, a96
    v_accvgpr_read_b32 v225, a97
    v_accvgpr_read_b32 v226, a98
    v_accvgpr_read_b32 v227, a99
    v_mul_f32 v224, v224, v52
    v_mul_f32 v225, v225, v52
    v_mul_f32 v226, v226, v52
    v_mul_f32 v227, v227, v52
    v_accvgpr_write_b32 a96, v224
    v_accvgpr_write_b32 a97, v225
    v_accvgpr_write_b32 a98, v226
    v_accvgpr_write_b32 a99, v227
    v_accvgpr_read_b32 v224, a100
    v_accvgpr_read_b32 v225, a101
    v_accvgpr_read_b32 v226, a102
    v_accvgpr_read_b32 v227, a103
    v_mul_f32 v224, v224, v53
    v_mul_f32 v225, v225, v53
    v_mul_f32 v226, v226, v53
    v_mul_f32 v227, v227, v53
    v_accvgpr_write_b32 a100, v224
    v_accvgpr_write_b32 a101, v225
    v_accvgpr_write_b32 a102, v226
    v_accvgpr_write_b32 a103, v227
    v_accvgpr_read_b32 v224, a104
    v_accvgpr_read_b32 v225, a105
    v_accvgpr_read_b32 v226, a106
    v_accvgpr_read_b32 v227, a107
    v_mul_f32 v224, v224, v54
    v_mul_f32 v225, v225, v54
    v_mul_f32 v226, v226, v54
    v_mul_f32 v227, v227, v54
    v_accvgpr_write_b32 a104, v224
    v_accvgpr_write_b32 a105, v225
    v_accvgpr_write_b32 a106, v226
    v_accvgpr_write_b32 a107, v227
    v_accvgpr_read_b32 v224, a108
    v_accvgpr_read_b32 v225, a109
    v_accvgpr_read_b32 v226, a110
    v_accvgpr_read_b32 v227, a111
    v_mul_f32 v224, v224, v55
    v_mul_f32 v225, v225, v55
    v_mul_f32 v226, v226, v55
    v_mul_f32 v227, v227, v55
    v_accvgpr_write_b32 a108, v224
    v_accvgpr_write_b32 a109, v225
    v_accvgpr_write_b32 a110, v226
    v_accvgpr_write_b32 a111, v227
    v_accvgpr_read_b32 v224, a112
    v_accvgpr_read_b32 v225, a113
    v_accvgpr_read_b32 v226, a114
    v_accvgpr_read_b32 v227, a115
    v_mul_f32 v224, v224, v52
    v_mul_f32 v225, v225, v52
    v_mul_f32 v226, v226, v52
    v_mul_f32 v227, v227, v52
    v_accvgpr_write_b32 a112, v224
    v_accvgpr_write_b32 a113, v225
    v_accvgpr_write_b32 a114, v226
    v_accvgpr_write_b32 a115, v227
    v_accvgpr_read_b32 v224, a116
    v_accvgpr_read_b32 v225, a117
    v_accvgpr_read_b32 v226, a118
    v_accvgpr_read_b32 v227, a119
    v_mul_f32 v224, v224, v53
    v_mul_f32 v225, v225, v53
    v_mul_f32 v226, v226, v53
    v_mul_f32 v227, v227, v53
    v_accvgpr_write_b32 a116, v224
    v_accvgpr_write_b32 a117, v225
    v_accvgpr_write_b32 a118, v226
    v_accvgpr_write_b32 a119, v227
    v_accvgpr_read_b32 v224, a120
    v_accvgpr_read_b32 v225, a121
    v_accvgpr_read_b32 v226, a122
    v_accvgpr_read_b32 v227, a123
    v_mul_f32 v224, v224, v54
    v_mul_f32 v225, v225, v54
    v_mul_f32 v226, v226, v54
    v_mul_f32 v227, v227, v54
    v_accvgpr_write_b32 a120, v224
    v_accvgpr_write_b32 a121, v225
    v_accvgpr_write_b32 a122, v226
    v_accvgpr_write_b32 a123, v227
    v_accvgpr_read_b32 v224, a124
    v_accvgpr_read_b32 v225, a125
    v_accvgpr_read_b32 v226, a126
    v_accvgpr_read_b32 v227, a127
    v_mul_f32 v224, v224, v55
    v_mul_f32 v225, v225, v55
    v_mul_f32 v226, v226, v55
    v_mul_f32 v227, v227, v55
    v_accvgpr_write_b32 a124, v224
    v_accvgpr_write_b32 a125, v225
    v_accvgpr_write_b32 a126, v226
    v_accvgpr_write_b32 a127, v227
    v_exp_f32 v232, v160
    v_exp_f32 v233, v161
    v_exp_f32 v234, v162
    v_exp_f32 v235, v163
    s_nop 0
    v_cvt_pk_bf16_f32 v208, v232, v233
    v_cvt_pk_bf16_f32 v209, v234, v235
    v_exp_f32 v232, v176
    v_exp_f32 v233, v177
    v_exp_f32 v234, v178
    v_exp_f32 v235, v179
    s_nop 0
    v_cvt_pk_bf16_f32 v210, v232, v233
    v_cvt_pk_bf16_f32 v211, v234, v235
    v_exp_f32 v232, v164
    v_exp_f32 v233, v165
    v_exp_f32 v234, v166
    v_exp_f32 v235, v167
    s_nop 0
    v_cvt_pk_bf16_f32 v212, v232, v233
    v_cvt_pk_bf16_f32 v213, v234, v235
    v_exp_f32 v232, v180
    v_exp_f32 v233, v181
    v_exp_f32 v234, v182
    v_exp_f32 v235, v183
    s_nop 0
    v_cvt_pk_bf16_f32 v214, v232, v233
    v_cvt_pk_bf16_f32 v215, v234, v235
    v_exp_f32 v232, v168
    v_exp_f32 v233, v169
    v_exp_f32 v234, v170
    v_exp_f32 v235, v171
    s_nop 0
    v_cvt_pk_bf16_f32 v216, v232, v233
    v_cvt_pk_bf16_f32 v217, v234, v235
    v_exp_f32 v232, v184
    v_exp_f32 v233, v185
    v_exp_f32 v234, v186
    v_exp_f32 v235, v187
    s_nop 0
    v_cvt_pk_bf16_f32 v218, v232, v233
    v_cvt_pk_bf16_f32 v219, v234, v235
    v_exp_f32 v232, v172
    v_exp_f32 v233, v173
    v_exp_f32 v234, v174
    v_exp_f32 v235, v175
    s_nop 0
    v_cvt_pk_bf16_f32 v220, v232, v233
    v_cvt_pk_bf16_f32 v221, v234, v235
    v_exp_f32 v232, v188
    v_exp_f32 v233, v189
    v_exp_f32 v234, v190
    v_exp_f32 v235, v191
    s_nop 0
    v_cvt_pk_bf16_f32 v222, v232, v233
    v_cvt_pk_bf16_f32 v223, v234, v235
    s_nop 1
    s_branch k2_ret_94
k2_rare_97:
    s_nop 7
    v_max_f32 v54, v128, v129
    v_max3_f32 v54, v54, v130, v131
    v_max3_f32 v54, v54, v144, v145
    v_max3_f32 v54, v54, v146, v147
    v_max3_f32 v54, v54, v136, v137
    v_max3_f32 v54, v54, v138, v139
    v_max3_f32 v54, v54, v152, v153
    v_max3_f32 v54, v54, v154, v155
    v_max_f32 v55, v132, v133
    v_max3_f32 v55, v55, v134, v135
    v_max3_f32 v55, v55, v148, v149
    v_max3_f32 v55, v55, v150, v151
    v_max3_f32 v55, v55, v140, v141
    v_max3_f32 v55, v55, v142, v143
    v_max3_f32 v55, v55, v156, v157
    v_max3_f32 v55, v55, v158, v159
    v_mov_b32 v226, v54
    v_mov_b32 v227, v55
    s_nop 1
    v_permlane16_swap_b32 v54, v226
    v_permlane16_swap_b32 v55, v227
    s_nop 1
    v_max_f32 v54, v54, v226
    v_max_f32 v55, v55, v227
    v_mov_b32 v226, v54
    v_mov_b32 v227, v55
    s_nop 1
    v_permlane32_swap_b32 v54, v226
    v_permlane32_swap_b32 v55, v227
    s_nop 1
    v_max_f32 v54, v54, v226
    v_max_f32 v55, v55, v227
    v_add_f32 v54, 0x41400000, v54
    v_max_f32 v54, 0, v54
    v_add_f32 v55, 0x41400000, v55
    v_max_f32 v55, 0, v55
    v_sub_f32 v128, v128, v54
    v_sub_f32 v129, v129, v54
    v_sub_f32 v130, v130, v54
    v_sub_f32 v131, v131, v54
    v_sub_f32 v132, v132, v55
    v_sub_f32 v133, v133, v55
    v_sub_f32 v134, v134, v55
    v_sub_f32 v135, v135, v55
    v_sub_f32 v136, v136, v54
    v_sub_f32 v137, v137, v54
    v_sub_f32 v138, v138, v54
    v_sub_f32 v139, v139, v54
    v_sub_f32 v140, v140, v55
    v_sub_f32 v141, v141, v55
    v_sub_f32 v142, v142, v55
    v_sub_f32 v143, v143, v55
    v_sub_f32 v144, v144, v54
    v_sub_f32 v145, v145, v54
    v_sub_f32 v146, v146, v54
    v_sub_f32 v147, v147, v54
    v_sub_f32 v148, v148, v55
    v_sub_f32 v149, v149, v55
    v_sub_f32 v150, v150, v55
    v_sub_f32 v151, v151, v55
    v_sub_f32 v152, v152, v54
    v_sub_f32 v153, v153, v54
    v_sub_f32 v154, v154, v54
    v_sub_f32 v155, v155, v54
    v_sub_f32 v156, v156, v55
    v_sub_f32 v157, v157, v55
    v_sub_f32 v158, v158, v55
    v_sub_f32 v159, v159, v55
    v_sub_f32 v160, v160, v54
    v_sub_f32 v16, v16, v54
    v_sub_f32 v161, v161, v54
    v_sub_f32 v17, v17, v54
    v_sub_f32 v162, v162, v54
    v_sub_f32 v18, v18, v54
    v_sub_f32 v163, v163, v54
    v_sub_f32 v19, v19, v54
    v_sub_f32 v164, v164, v55
    v_sub_f32 v20, v20, v55
    v_sub_f32 v165, v165, v55
    v_sub_f32 v21, v21, v55
    v_sub_f32 v166, v166, v55
    v_sub_f32 v22, v22, v55
    v_sub_f32 v167, v167, v55
    v_sub_f32 v23, v23, v55
    v_sub_f32 v168, v168, v54
    v_sub_f32 v24, v24, v54
    v_sub_f32 v169, v169, v54
    v_sub_f32 v25, v25, v54
    v_sub_f32 v170, v170, v54
    v_sub_f32 v26, v26, v54
    v_sub_f32 v171, v171, v54
    v_sub_f32 v27, v27, v54
    v_sub_f32 v172, v172, v55
    v_sub_f32 v28, v28, v55
    v_sub_f32 v173, v173, v55
    v_sub_f32 v29, v29, v55
    v_sub_f32 v174, v174, v55
    v_sub_f32 v30, v30, v55
    v_sub_f32 v175, v175, v55
    v_sub_f32 v31, v31, v55
    v_sub_f32 v176, v176, v54
    v_sub_f32 v32, v32, v54
    v_sub_f32 v177, v177, v54
    v_sub_f32 v33, v33, v54
    v_sub_f32 v178, v178, v54
    v_sub_f32 v34, v34, v54
    v_sub_f32 v179, v179, v54
    v_sub_f32 v35, v35, v54
    v_sub_f32 v180, v180, v55
    v_sub_f32 v36, v36, v55
    v_sub_f32 v181, v181, v55
    v_sub_f32 v37, v37, v55
    v_sub_f32 v182, v182, v55
    v_sub_f32 v38, v38, v55
    v_sub_f32 v183, v183, v55
    v_sub_f32 v39, v39, v55
    v_sub_f32 v184, v184, v54
    v_sub_f32 v40, v40, v54
    v_sub_f32 v185, v185, v54
    v_sub_f32 v41, v41, v54
    v_sub_f32 v186, v186, v54
    v_sub_f32 v42, v42, v54
    v_sub_f32 v187, v187, v54
    v_sub_f32 v43, v43, v54
    v_sub_f32 v188, v188, v55
    v_sub_f32 v44, v44, v55
    v_sub_f32 v189, v189, v55
    v_sub_f32 v45, v45, v55
    v_sub_f32 v190, v190, v55
    v_sub_f32 v46, v46, v55
    v_sub_f32 v191, v191, v55
    v_sub_f32 v47, v47, v55
    v_sub_f32 v10, v10, v54
    v_exp_f32 v54, -v54
    v_sub_f32 v11, v11, v55
    v_exp_f32 v55, -v55
    s_nop 0
    v_mul_f32 v248, v248, v54
    v_mul_f32 v252, v252, v55
    v_accvgpr_read_b32 v224, a8
    v_accvgpr_read_b32 v225, a9
    v_accvgpr_read_b32 v226, a10
    v_accvgpr_read_b32 v227, a11
    v_mul_f32 v224, v224, v54
    v_mul_f32 v225, v225, v54
    v_mul_f32 v226, v226, v54
    v_mul_f32 v227, v227, v54
    v_accvgpr_write_b32 a8, v224
    v_accvgpr_write_b32 a9, v225
    v_accvgpr_write_b32 a10, v226
    v_accvgpr_write_b32 a11, v227
    v_accvgpr_read_b32 v224, a12
    v_accvgpr_read_b32 v225, a13
    v_accvgpr_read_b32 v226, a14
    v_accvgpr_read_b32 v227, a15
    v_mul_f32 v224, v224, v55
    v_mul_f32 v225, v225, v55
    v_mul_f32 v226, v226, v55
    v_mul_f32 v227, v227, v55
    v_accvgpr_write_b32 a12, v224
    v_accvgpr_write_b32 a13, v225
    v_accvgpr_write_b32 a14, v226
    v_accvgpr_write_b32 a15, v227
    v_accvgpr_read_b32 v224, a24
    v_accvgpr_read_b32 v225, a25
    v_accvgpr_read_b32 v226, a26
    v_accvgpr_read_b32 v227, a27
    v_mul_f32 v224, v224, v54
    v_mul_f32 v225, v225, v54
    v_mul_f32 v226, v226, v54
    v_mul_f32 v227, v227, v54
    v_accvgpr_write_b32 a24, v224
    v_accvgpr_write_b32 a25, v225
    v_accvgpr_write_b32 a26, v226
    v_accvgpr_write_b32 a27, v227
    v_accvgpr_read_b32 v224, a28
    v_accvgpr_read_b32 v225, a29
    v_accvgpr_read_b32 v226, a30
    v_accvgpr_read_b32 v227, a31
    v_mul_f32 v224, v224, v55
    v_mul_f32 v225, v225, v55
    v_mul_f32 v226, v226, v55
    v_mul_f32 v227, v227, v55
    v_accvgpr_write_b32 a28, v224
    v_accvgpr_write_b32 a29, v225
    v_accvgpr_write_b32 a30, v226
    v_accvgpr_write_b32 a31, v227
    v_accvgpr_read_b32 v224, a40
    v_accvgpr_read_b32 v225, a41
    v_accvgpr_read_b32 v226, a42
    v_accvgpr_read_b32 v227, a43
    v_mul_f32 v224, v224, v54
    v_mul_f32 v225, v225, v54
    v_mul_f32 v226, v226, v54
    v_mul_f32 v227, v227, v54
    v_accvgpr_write_b32 a40, v224
    v_accvgpr_write_b32 a41, v225
    v_accvgpr_write_b32 a42, v226
    v_accvgpr_write_b32 a43, v227
    v_accvgpr_read_b32 v224, a44
    v_accvgpr_read_b32 v225, a45
    v_accvgpr_read_b32 v226, a46
    v_accvgpr_read_b32 v227, a47
    v_mul_f32 v224, v224, v55
    v_mul_f32 v225, v225, v55
    v_mul_f32 v226, v226, v55
    v_mul_f32 v227, v227, v55
    v_accvgpr_write_b32 a44, v224
    v_accvgpr_write_b32 a45, v225
    v_accvgpr_write_b32 a46, v226
    v_accvgpr_write_b32 a47, v227
    v_accvgpr_read_b32 v224, a56
    v_accvgpr_read_b32 v225, a57
    v_accvgpr_read_b32 v226, a58
    v_accvgpr_read_b32 v227, a59
    v_mul_f32 v224, v224, v54
    v_mul_f32 v225, v225, v54
    v_mul_f32 v226, v226, v54
    v_mul_f32 v227, v227, v54
    v_accvgpr_write_b32 a56, v224
    v_accvgpr_write_b32 a57, v225
    v_accvgpr_write_b32 a58, v226
    v_accvgpr_write_b32 a59, v227
    v_accvgpr_read_b32 v224, a60
    v_accvgpr_read_b32 v225, a61
    v_accvgpr_read_b32 v226, a62
    v_accvgpr_read_b32 v227, a63
    v_mul_f32 v224, v224, v55
    v_mul_f32 v225, v225, v55
    v_mul_f32 v226, v226, v55
    v_mul_f32 v227, v227, v55
    v_accvgpr_write_b32 a60, v224
    v_accvgpr_write_b32 a61, v225
    v_accvgpr_write_b32 a62, v226
    v_accvgpr_write_b32 a63, v227
    v_accvgpr_read_b32 v224, a72
    v_accvgpr_read_b32 v225, a73
    v_accvgpr_read_b32 v226, a74
    v_accvgpr_read_b32 v227, a75
    v_mul_f32 v224, v224, v54
    v_mul_f32 v225, v225, v54
    v_mul_f32 v226, v226, v54
    v_mul_f32 v227, v227, v54
    v_accvgpr_write_b32 a72, v224
    v_accvgpr_write_b32 a73, v225
    v_accvgpr_write_b32 a74, v226
    v_accvgpr_write_b32 a75, v227
    v_accvgpr_read_b32 v224, a76
    v_accvgpr_read_b32 v225, a77
    v_accvgpr_read_b32 v226, a78
    v_accvgpr_read_b32 v227, a79
    v_mul_f32 v224, v224, v55
    v_mul_f32 v225, v225, v55
    v_mul_f32 v226, v226, v55
    v_mul_f32 v227, v227, v55
    v_accvgpr_write_b32 a76, v224
    v_accvgpr_write_b32 a77, v225
    v_accvgpr_write_b32 a78, v226
    v_accvgpr_write_b32 a79, v227
    v_accvgpr_read_b32 v224, a88
    v_accvgpr_read_b32 v225, a89
    v_accvgpr_read_b32 v226, a90
    v_accvgpr_read_b32 v227, a91
    v_mul_f32 v224, v224, v54
    v_mul_f32 v225, v225, v54
    v_mul_f32 v226, v226, v54
    v_mul_f32 v227, v227, v54
    v_accvgpr_write_b32 a88, v224
    v_accvgpr_write_b32 a89, v225
    v_accvgpr_write_b32 a90, v226
    v_accvgpr_write_b32 a91, v227
    v_accvgpr_read_b32 v224, a92
    v_accvgpr_read_b32 v225, a93
    v_accvgpr_read_b32 v226, a94
    v_accvgpr_read_b32 v227, a95
    v_mul_f32 v224, v224, v55
    v_mul_f32 v225, v225, v55
    v_mul_f32 v226, v226, v55
    v_mul_f32 v227, v227, v55
    v_accvgpr_write_b32 a92, v224
    v_accvgpr_write_b32 a93, v225
    v_accvgpr_write_b32 a94, v226
    v_accvgpr_write_b32 a95, v227
    v_accvgpr_read_b32 v224, a104
    v_accvgpr_read_b32 v225, a105
    v_accvgpr_read_b32 v226, a106
    v_accvgpr_read_b32 v227, a107
    v_mul_f32 v224, v224, v54
    v_mul_f32 v225, v225, v54
    v_mul_f32 v226, v226, v54
    v_mul_f32 v227, v227, v54
    v_accvgpr_write_b32 a104, v224
    v_accvgpr_write_b32 a105, v225
    v_accvgpr_write_b32 a106, v226
    v_accvgpr_write_b32 a107, v227
    v_accvgpr_read_b32 v224, a108
    v_accvgpr_read_b32 v225, a109
    v_accvgpr_read_b32 v226, a110
    v_accvgpr_read_b32 v227, a111
    v_mul_f32 v224, v224, v55
    v_mul_f32 v225, v225, v55
    v_mul_f32 v226, v226, v55
    v_mul_f32 v227, v227, v55
    v_accvgpr_write_b32 a108, v224
    v_accvgpr_write_b32 a109, v225
    v_accvgpr_write_b32 a110, v226
    v_accvgpr_write_b32 a111, v227
    v_accvgpr_read_b32 v224, a120
    v_accvgpr_read_b32 v225, a121
    v_accvgpr_read_b32 v226, a122
    v_accvgpr_read_b32 v227, a123
    v_mul_f32 v224, v224, v54
    v_mul_f32 v225, v225, v54
    v_mul_f32 v226, v226, v54
    v_mul_f32 v227, v227, v54
    v_accvgpr_write_b32 a120, v224
    v_accvgpr_write_b32 a121, v225
    v_accvgpr_write_b32 a122, v226
    v_accvgpr_write_b32 a123, v227
    v_accvgpr_read_b32 v224, a124
    v_accvgpr_read_b32 v225, a125
    v_accvgpr_read_b32 v226, a126
    v_accvgpr_read_b32 v227, a127
    v_mul_f32 v224, v224, v55
    v_mul_f32 v225, v225, v55
    v_mul_f32 v226, v226, v55
    v_mul_f32 v227, v227, v55
    v_accvgpr_write_b32 a124, v224
    v_accvgpr_write_b32 a125, v225
    v_accvgpr_write_b32 a126, v226
    v_accvgpr_write_b32 a127, v227
    v_exp_f32 v232, v128
    v_exp_f32 v233, v129
    v_exp_f32 v234, v130
    v_exp_f32 v235, v131
    s_nop 0
    v_cvt_pk_bf16_f32 v192, v232, v233
    v_cvt_pk_bf16_f32 v193, v234, v235
    v_exp_f32 v232, v144
    v_exp_f32 v233, v145
    v_exp_f32 v234, v146
    v_exp_f32 v235, v147
    s_nop 0
    v_cvt_pk_bf16_f32 v194, v232, v233
    v_cvt_pk_bf16_f32 v195, v234, v235
    v_exp_f32 v232, v132
    v_exp_f32 v233, v133
    v_exp_f32 v234, v134
    v_exp_f32 v235, v135
    s_nop 0
    v_cvt_pk_bf16_f32 v196, v232, v233
    v_cvt_pk_bf16_f32 v197, v234, v235
    v_exp_f32 v232, v148
    v_exp_f32 v233, v149
    v_exp_f32 v234, v150
    v_exp_f32 v235, v151
    s_nop 0
    v_cvt_pk_bf16_f32 v198, v232, v233
    v_cvt_pk_bf16_f32 v199, v234, v235
    v_exp_f32 v232, v136
    v_exp_f32 v233, v137
    v_exp_f32 v234, v138
    v_exp_f32 v235, v139
    s_nop 0
    v_cvt_pk_bf16_f32 v200, v232, v233
    v_cvt_pk_bf16_f32 v201, v234, v235
    v_exp_f32 v232, v152
    v_exp_f32 v233, v153
    v_exp_f32 v234, v154
    v_exp_f32 v235, v155
    s_nop 0
    v_cvt_pk_bf16_f32 v202, v232, v233
    v_cvt_pk_bf16_f32 v203, v234, v235
    v_exp_f32 v232, v140
    v_exp_f32 v233, v141
    v_exp_f32 v234, v142
    v_exp_f32 v235, v143
    s_nop 0
    v_cvt_pk_bf16_f32 v204, v232, v233
    v_cvt_pk_bf16_f32 v205, v234, v235
    v_exp_f32 v232, v156
    v_exp_f32 v233, v157
    v_exp_f32 v234, v158
    v_exp_f32 v235, v159
    s_nop 0
    v_cvt_pk_bf16_f32 v206, v232, v233
    v_cvt_pk_bf16_f32 v207, v234, v235
    s_nop 1
    s_branch k2_ret_98
k2_rare_103:
    s_nop 7
    v_max_f32 v54, v160, v161
    v_max3_f32 v54, v54, v162, v163
    v_max3_f32 v54, v54, v176, v177
    v_max3_f32 v54, v54, v178, v179
    v_max3_f32 v54, v54, v168, v169
    v_max3_f32 v54, v54, v170, v171
    v_max3_f32 v54, v54, v184, v185
    v_max3_f32 v54, v54, v186, v187
    v_max_f32 v55, v164, v165
    v_max3_f32 v55, v55, v166, v167
    v_max3_f32 v55, v55, v180, v181
    v_max3_f32 v55, v55, v182, v183
    v_max3_f32 v55, v55, v172, v173
    v_max3_f32 v55, v55, v174, v175
    v_max3_f32 v55, v55, v188, v189
    v_max3_f32 v55, v55, v190, v191
    v_mov_b32 v226, v54
    v_mov_b32 v227, v55
    s_nop 1
    v_permlane16_swap_b32 v54, v226
    v_permlane16_swap_b32 v55, v227
    s_nop 1
    v_max_f32 v54, v54, v226
    v_max_f32 v55, v55, v227
    v_mov_b32 v226, v54
    v_mov_b32 v227, v55
    s_nop 1
    v_permlane32_swap_b32 v54, v226
    v_permlane32_swap_b32 v55, v227
    s_nop 1
    v_max_f32 v54, v54, v226
    v_max_f32 v55, v55, v227
    v_add_f32 v54, 0x41400000, v54
    v_max_f32 v54, 0, v54
    v_add_f32 v55, 0x41400000, v55
    v_max_f32 v55, 0, v55
    v_sub_f32 v160, v160, v54
    v_sub_f32 v161, v161, v54
    v_sub_f32 v162, v162, v54
    v_sub_f32 v163, v163, v54
    v_sub_f32 v164, v164, v55
    v_sub_f32 v165, v165, v55
    v_sub_f32 v166, v166, v55
    v_sub_f32 v167, v167, v55
    v_sub_f32 v168, v168, v54
    v_sub_f32 v169, v169, v54
    v_sub_f32 v170, v170, v54
    v_sub_f32 v171, v171, v54
    v_sub_f32 v172, v172, v55
    v_sub_f32 v173, v173, v55
    v_sub_f32 v174, v174, v55
    v_sub_f32 v175, v175, v55
    v_sub_f32 v176, v176, v54
    v_sub_f32 v177, v177, v54
    v_sub_f32 v178, v178, v54
    v_sub_f32 v179, v179, v54
    v_sub_f32 v180, v180, v55
    v_sub_f32 v181, v181, v55
    v_sub_f32 v182, v182, v55
    v_sub_f32 v183, v183, v55
    v_sub_f32 v184, v184, v54
    v_sub_f32 v185, v185, v54
    v_sub_f32 v186, v186, v54
    v_sub_f32 v187, v187, v54
    v_sub_f32 v188, v188, v55
    v_sub_f32 v189, v189, v55
    v_sub_f32 v190, v190, v55
    v_sub_f32 v191, v191, v55
    v_sub_f32 v128, v128, v54
    v_sub_f32 v16, v16, v54
    v_sub_f32 v129, v129, v54
    v_sub_f32 v17, v17, v54
    v_sub_f32 v130, v130, v54
    v_sub_f32 v18, v18, v54
    v_sub_f32 v131, v131, v54
    v_sub_f32 v19, v19, v54
    v_sub_f32 v132, v132, v55
    v_sub_f32 v20, v20, v55
    v_sub_f32 v133, v133, v55
    v_sub_f32 v21, v21, v55
    v_sub_f32 v134, v134, v55
    v_sub_f32 v22, v22, v55
    v_sub_f32 v135, v135, v55
    v_sub_f32 v23, v23, v55
    v_sub_f32 v136, v136, v54
    v_sub_f32 v24, v24, v54
    v_sub_f32 v137, v137, v54
    v_sub_f32 v25, v25, v54
    v_sub_f32 v138, v138, v54
    v_sub_f32 v26, v26, v54
    v_sub_f32 v139, v139, v54
    v_sub_f32 v27, v27, v54
    v_sub_f32 v140, v140, v55
    v_sub_f32 v28, v28, v55
    v_sub_f32 v141, v141, v55
    v_sub_f32 v29, v29, v55
    v_sub_f32 v142, v142, v55
    v_sub_f32 v30, v30, v55
    v_sub_f32 v143, v143, v55
    v_sub_f32 v31, v31, v55
    v_sub_f32 v144, v144, v54
    v_sub_f32 v32, v32, v54
    v_sub_f32 v145, v145, v54
    v_sub_f32 v33, v33, v54
    v_sub_f32 v146, v146, v54
    v_sub_f32 v34, v34, v54
    v_sub_f32 v147, v147, v54
    v_sub_f32 v35, v35, v54
    v_sub_f32 v148, v148, v55
    v_sub_f32 v36, v36, v55
    v_sub_f32 v149, v149, v55
    v_sub_f32 v37, v37, v55
    v_sub_f32 v150, v150, v55
    v_sub_f32 v38, v38, v55
    v_sub_f32 v151, v151, v55
    v_sub_f32 v39, v39, v55
    v_sub_f32 v152, v152, v54
    v_sub_f32 v40, v40, v54
    v_sub_f32 v153, v153, v54
    v_sub_f32 v41, v41, v54
    v_sub_f32 v154, v154, v54
    v_sub_f32 v42, v42, v54
    v_sub_f32 v155, v155, v54
    v_sub_f32 v43, v43, v54
    v_sub_f32 v156, v156, v55
    v_sub_f32 v44, v44, v55
    v_sub_f32 v157, v157, v55
    v_sub_f32 v45, v45, v55
    v_sub_f32 v158, v158, v55
    v_sub_f32 v46, v46, v55
    v_sub_f32 v159, v159, v55
    v_sub_f32 v47, v47, v55
    v_sub_f32 v10, v10, v54
    v_exp_f32 v54, -v54
    v_sub_f32 v11, v11, v55
    v_exp_f32 v55, -v55
    s_nop 0
    v_mul_f32 v248, v248, v54
    v_mul_f32 v252, v252, v55
    v_accvgpr_read_b32 v224, a8
    v_accvgpr_read_b32 v225, a9
    v_accvgpr_read_b32 v226, a10
    v_accvgpr_read_b32 v227, a11
    v_mul_f32 v224, v224, v54
    v_mul_f32 v225, v225, v54
    v_mul_f32 v226, v226, v54
    v_mul_f32 v227, v227, v54
    v_accvgpr_write_b32 a8, v224
    v_accvgpr_write_b32 a9, v225
    v_accvgpr_write_b32 a10, v226
    v_accvgpr_write_b32 a11, v227
    v_accvgpr_read_b32 v224, a12
    v_accvgpr_read_b32 v225, a13
    v_accvgpr_read_b32 v226, a14
    v_accvgpr_read_b32 v227, a15
    v_mul_f32 v224, v224, v55
    v_mul_f32 v225, v225, v55
    v_mul_f32 v226, v226, v55
    v_mul_f32 v227, v227, v55
    v_accvgpr_write_b32 a12, v224
    v_accvgpr_write_b32 a13, v225
    v_accvgpr_write_b32 a14, v226
    v_accvgpr_write_b32 a15, v227
    v_accvgpr_read_b32 v224, a24
    v_accvgpr_read_b32 v225, a25
    v_accvgpr_read_b32 v226, a26
    v_accvgpr_read_b32 v227, a27
    v_mul_f32 v224, v224, v54
    v_mul_f32 v225, v225, v54
    v_mul_f32 v226, v226, v54
    v_mul_f32 v227, v227, v54
    v_accvgpr_write_b32 a24, v224
    v_accvgpr_write_b32 a25, v225
    v_accvgpr_write_b32 a26, v226
    v_accvgpr_write_b32 a27, v227
    v_accvgpr_read_b32 v224, a28
    v_accvgpr_read_b32 v225, a29
    v_accvgpr_read_b32 v226, a30
    v_accvgpr_read_b32 v227, a31
    v_mul_f32 v224, v224, v55
    v_mul_f32 v225, v225, v55
    v_mul_f32 v226, v226, v55
    v_mul_f32 v227, v227, v55
    v_accvgpr_write_b32 a28, v224
    v_accvgpr_write_b32 a29, v225
    v_accvgpr_write_b32 a30, v226
    v_accvgpr_write_b32 a31, v227
    v_accvgpr_read_b32 v224, a40
    v_accvgpr_read_b32 v225, a41
    v_accvgpr_read_b32 v226, a42
    v_accvgpr_read_b32 v227, a43
    v_mul_f32 v224, v224, v54
    v_mul_f32 v225, v225, v54
    v_mul_f32 v226, v226, v54
    v_mul_f32 v227, v227, v54
    v_accvgpr_write_b32 a40, v224
    v_accvgpr_write_b32 a41, v225
    v_accvgpr_write_b32 a42, v226
    v_accvgpr_write_b32 a43, v227
    v_accvgpr_read_b32 v224, a44
    v_accvgpr_read_b32 v225, a45
    v_accvgpr_read_b32 v226, a46
    v_accvgpr_read_b32 v227, a47
    v_mul_f32 v224, v224, v55
    v_mul_f32 v225, v225, v55
    v_mul_f32 v226, v226, v55
    v_mul_f32 v227, v227, v55
    v_accvgpr_write_b32 a44, v224
    v_accvgpr_write_b32 a45, v225
    v_accvgpr_write_b32 a46, v226
    v_accvgpr_write_b32 a47, v227
    v_accvgpr_read_b32 v224, a56
    v_accvgpr_read_b32 v225, a57
    v_accvgpr_read_b32 v226, a58
    v_accvgpr_read_b32 v227, a59
    v_mul_f32 v224, v224, v54
    v_mul_f32 v225, v225, v54
    v_mul_f32 v226, v226, v54
    v_mul_f32 v227, v227, v54
    v_accvgpr_write_b32 a56, v224
    v_accvgpr_write_b32 a57, v225
    v_accvgpr_write_b32 a58, v226
    v_accvgpr_write_b32 a59, v227
    v_accvgpr_read_b32 v224, a60
    v_accvgpr_read_b32 v225, a61
    v_accvgpr_read_b32 v226, a62
    v_accvgpr_read_b32 v227, a63
    v_mul_f32 v224, v224, v55
    v_mul_f32 v225, v225, v55
    v_mul_f32 v226, v226, v55
    v_mul_f32 v227, v227, v55
    v_accvgpr_write_b32 a60, v224
    v_accvgpr_write_b32 a61, v225
    v_accvgpr_write_b32 a62, v226
    v_accvgpr_write_b32 a63, v227
    v_accvgpr_read_b32 v224, a72
    v_accvgpr_read_b32 v225, a73
    v_accvgpr_read_b32 v226, a74
    v_accvgpr_read_b32 v227, a75
    v_mul_f32 v224, v224, v54
    v_mul_f32 v225, v225, v54
    v_mul_f32 v226, v226, v54
    v_mul_f32 v227, v227, v54
    v_accvgpr_write_b32 a72, v224
    v_accvgpr_write_b32 a73, v225
    v_accvgpr_write_b32 a74, v226
    v_accvgpr_write_b32 a75, v227
    v_accvgpr_read_b32 v224, a76
    v_accvgpr_read_b32 v225, a77
    v_accvgpr_read_b32 v226, a78
    v_accvgpr_read_b32 v227, a79
    v_mul_f32 v224, v224, v55
    v_mul_f32 v225, v225, v55
    v_mul_f32 v226, v226, v55
    v_mul_f32 v227, v227, v55
    v_accvgpr_write_b32 a76, v224
    v_accvgpr_write_b32 a77, v225
    v_accvgpr_write_b32 a78, v226
    v_accvgpr_write_b32 a79, v227
    v_accvgpr_read_b32 v224, a88
    v_accvgpr_read_b32 v225, a89
    v_accvgpr_read_b32 v226, a90
    v_accvgpr_read_b32 v227, a91
    v_mul_f32 v224, v224, v54
    v_mul_f32 v225, v225, v54
    v_mul_f32 v226, v226, v54
    v_mul_f32 v227, v227, v54
    v_accvgpr_write_b32 a88, v224
    v_accvgpr_write_b32 a89, v225
    v_accvgpr_write_b32 a90, v226
    v_accvgpr_write_b32 a91, v227
    v_accvgpr_read_b32 v224, a92
    v_accvgpr_read_b32 v225, a93
    v_accvgpr_read_b32 v226, a94
    v_accvgpr_read_b32 v227, a95
    v_mul_f32 v224, v224, v55
    v_mul_f32 v225, v225, v55
    v_mul_f32 v226, v226, v55
    v_mul_f32 v227, v227, v55
    v_accvgpr_write_b32 a92, v224
    v_accvgpr_write_b32 a93, v225
    v_accvgpr_write_b32 a94, v226
    v_accvgpr_write_b32 a95, v227
    v_accvgpr_read_b32 v224, a104
    v_accvgpr_read_b32 v225, a105
    v_accvgpr_read_b32 v226, a106
    v_accvgpr_read_b32 v227, a107
    v_mul_f32 v224, v224, v54
    v_mul_f32 v225, v225, v54
    v_mul_f32 v226, v226, v54
    v_mul_f32 v227, v227, v54
    v_accvgpr_write_b32 a104, v224
    v_accvgpr_write_b32 a105, v225
    v_accvgpr_write_b32 a106, v226
    v_accvgpr_write_b32 a107, v227
    v_accvgpr_read_b32 v224, a108
    v_accvgpr_read_b32 v225, a109
    v_accvgpr_read_b32 v226, a110
    v_accvgpr_read_b32 v227, a111
    v_mul_f32 v224, v224, v55
    v_mul_f32 v225, v225, v55
    v_mul_f32 v226, v226, v55
    v_mul_f32 v227, v227, v55
    v_accvgpr_write_b32 a108, v224
    v_accvgpr_write_b32 a109, v225
    v_accvgpr_write_b32 a110, v226
    v_accvgpr_write_b32 a111, v227
    v_accvgpr_read_b32 v224, a120
    v_accvgpr_read_b32 v225, a121
    v_accvgpr_read_b32 v226, a122
    v_accvgpr_read_b32 v227, a123
    v_mul_f32 v224, v224, v54
    v_mul_f32 v225, v225, v54
    v_mul_f32 v226, v226, v54
    v_mul_f32 v227, v227, v54
    v_accvgpr_write_b32 a120, v224
    v_accvgpr_write_b32 a121, v225
    v_accvgpr_write_b32 a122, v226
    v_accvgpr_write_b32 a123, v227
    v_accvgpr_read_b32 v224, a124
    v_accvgpr_read_b32 v225, a125
    v_accvgpr_read_b32 v226, a126
    v_accvgpr_read_b32 v227, a127
    v_mul_f32 v224, v224, v55
    v_mul_f32 v225, v225, v55
    v_mul_f32 v226, v226, v55
    v_mul_f32 v227, v227, v55
    v_accvgpr_write_b32 a124, v224
    v_accvgpr_write_b32 a125, v225
    v_accvgpr_write_b32 a126, v226
    v_accvgpr_write_b32 a127, v227
    v_exp_f32 v232, v160
    v_exp_f32 v233, v161
    v_exp_f32 v234, v162
    v_exp_f32 v235, v163
    s_nop 0
    v_cvt_pk_bf16_f32 v208, v232, v233
    v_cvt_pk_bf16_f32 v209, v234, v235
    v_exp_f32 v232, v176
    v_exp_f32 v233, v177
    v_exp_f32 v234, v178
    v_exp_f32 v235, v179
    s_nop 0
    v_cvt_pk_bf16_f32 v210, v232, v233
    v_cvt_pk_bf16_f32 v211, v234, v235
    v_exp_f32 v232, v164
    v_exp_f32 v233, v165
    v_exp_f32 v234, v166
    v_exp_f32 v235, v167
    s_nop 0
    v_cvt_pk_bf16_f32 v212, v232, v233
    v_cvt_pk_bf16_f32 v213, v234, v235
    v_exp_f32 v232, v180
    v_exp_f32 v233, v181
    v_exp_f32 v234, v182
    v_exp_f32 v235, v183
    s_nop 0
    v_cvt_pk_bf16_f32 v214, v232, v233
    v_cvt_pk_bf16_f32 v215, v234, v235
    v_exp_f32 v232, v168
    v_exp_f32 v233, v169
    v_exp_f32 v234, v170
    v_exp_f32 v235, v171
    s_nop 0
    v_cvt_pk_bf16_f32 v216, v232, v233
    v_cvt_pk_bf16_f32 v217, v234, v235
    v_exp_f32 v232, v184
    v_exp_f32 v233, v185
    v_exp_f32 v234, v186
    v_exp_f32 v235, v187
    s_nop 0
    v_cvt_pk_bf16_f32 v218, v232, v233
    v_cvt_pk_bf16_f32 v219, v234, v235
    v_exp_f32 v232, v172
    v_exp_f32 v233, v173
    v_exp_f32 v234, v174
    v_exp_f32 v235, v175
    s_nop 0
    v_cvt_pk_bf16_f32 v220, v232, v233
    v_cvt_pk_bf16_f32 v221, v234, v235
    v_exp_f32 v232, v188
    v_exp_f32 v233, v189
    v_exp_f32 v234, v190
    v_exp_f32 v235, v191
    s_nop 0
    v_cvt_pk_bf16_f32 v222, v232, v233
    v_cvt_pk_bf16_f32 v223, v234, v235
    s_nop 1
    s_branch k2_ret_104
k2_rare_107:
    s_nop 7
    v_max_f32 v54, v128, v129
    v_max3_f32 v54, v54, v130, v131
    v_max3_f32 v54, v54, v144, v145
    v_max3_f32 v54, v54, v146, v147
    v_max3_f32 v54, v54, v136, v137
    v_max3_f32 v54, v54, v138, v139
    v_max3_f32 v54, v54, v152, v153
    v_max3_f32 v54, v54, v154, v155
    v_max_f32 v55, v132, v133
    v_max3_f32 v55, v55, v134, v135
    v_max3_f32 v55, v55, v148, v149
    v_max3_f32 v55, v55, v150, v151
    v_max3_f32 v55, v55, v140, v141
    v_max3_f32 v55, v55, v142, v143
    v_max3_f32 v55, v55, v156, v157
    v_max3_f32 v55, v55, v158, v159
    v_mov_b32 v226, v54
    v_mov_b32 v227, v55
    s_nop 1
    v_permlane16_swap_b32 v54, v226
    v_permlane16_swap_b32 v55, v227
    s_nop 1
    v_max_f32 v54, v54, v226
    v_max_f32 v55, v55, v227
    v_mov_b32 v226, v54
    v_mov_b32 v227, v55
    s_nop 1
    v_permlane32_swap_b32 v54, v226
    v_permlane32_swap_b32 v55, v227
    s_nop 1
    v_max_f32 v54, v54, v226
    v_max_f32 v55, v55, v227
    v_add_f32 v54, 0x41400000, v54
    v_max_f32 v54, 0, v54
    v_add_f32 v55, 0x41400000, v55
    v_max_f32 v55, 0, v55
    v_sub_f32 v128, v128, v54
    v_sub_f32 v129, v129, v54
    v_sub_f32 v130, v130, v54
    v_sub_f32 v131, v131, v54
    v_sub_f32 v132, v132, v55
    v_sub_f32 v133, v133, v55
    v_sub_f32 v134, v134, v55
    v_sub_f32 v135, v135, v55
    v_sub_f32 v136, v136, v54
    v_sub_f32 v137, v137, v54
    v_sub_f32 v138, v138, v54
    v_sub_f32 v139, v139, v54
    v_sub_f32 v140, v140, v55
    v_sub_f32 v141, v141, v55
    v_sub_f32 v142, v142, v55
    v_sub_f32 v143, v143, v55
    v_sub_f32 v144, v144, v54
    v_sub_f32 v145, v145, v54
    v_sub_f32 v146, v146, v54
    v_sub_f32 v147, v147, v54
    v_sub_f32 v148, v148, v55
    v_sub_f32 v149, v149, v55
    v_sub_f32 v150, v150, v55
    v_sub_f32 v151, v151, v55
    v_sub_f32 v152, v152, v54
    v_sub_f32 v153, v153, v54
    v_sub_f32 v154, v154, v54
    v_sub_f32 v155, v155, v54
    v_sub_f32 v156, v156, v55
    v_sub_f32 v157, v157, v55
    v_sub_f32 v158, v158, v55
    v_sub_f32 v159, v159, v55
    v_sub_f32 v160, v160, v54
    v_sub_f32 v16, v16, v54
    v_sub_f32 v161, v161, v54
    v_sub_f32 v17, v17, v54
    v_sub_f32 v162, v162, v54
    v_sub_f32 v18, v18, v54
    v_sub_f32 v163, v163, v54
    v_sub_f32 v19, v19, v54
    v_sub_f32 v164, v164, v55
    v_sub_f32 v20, v20, v55
    v_sub_f32 v165, v165, v55
    v_sub_f32 v21, v21, v55
    v_sub_f32 v166, v166, v55
    v_sub_f32 v22, v22, v55
    v_sub_f32 v167, v167, v55
    v_sub_f32 v23, v23, v55
    v_sub_f32 v168, v168, v54
    v_sub_f32 v24, v24, v54
    v_sub_f32 v169, v169, v54
    v_sub_f32 v25, v25, v54
    v_sub_f32 v170, v170, v54
    v_sub_f32 v26, v26, v54
    v_sub_f32 v171, v171, v54
    v_sub_f32 v27, v27, v54
    v_sub_f32 v172, v172, v55
    v_sub_f32 v28, v28, v55
    v_sub_f32 v173, v173, v55
    v_sub_f32 v29, v29, v55
    v_sub_f32 v174, v174, v55
    v_sub_f32 v30, v30, v55
    v_sub_f32 v175, v175, v55
    v_sub_f32 v31, v31, v55
    v_sub_f32 v176, v176, v54
    v_sub_f32 v32, v32, v54
    v_sub_f32 v177, v177, v54
    v_sub_f32 v33, v33, v54
    v_sub_f32 v178, v178, v54
    v_sub_f32 v34, v34, v54
    v_sub_f32 v179, v179, v54
    v_sub_f32 v35, v35, v54
    v_sub_f32 v180, v180, v55
    v_sub_f32 v36, v36, v55
    v_sub_f32 v181, v181, v55
    v_sub_f32 v37, v37, v55
    v_sub_f32 v182, v182, v55
    v_sub_f32 v38, v38, v55
    v_sub_f32 v183, v183, v55
    v_sub_f32 v39, v39, v55
    v_sub_f32 v184, v184, v54
    v_sub_f32 v40, v40, v54
    v_sub_f32 v185, v185, v54
    v_sub_f32 v41, v41, v54
    v_sub_f32 v186, v186, v54
    v_sub_f32 v42, v42, v54
    v_sub_f32 v187, v187, v54
    v_sub_f32 v43, v43, v54
    v_sub_f32 v188, v188, v55
    v_sub_f32 v44, v44, v55
    v_sub_f32 v189, v189, v55
    v_sub_f32 v45, v45, v55
    v_sub_f32 v190, v190, v55
    v_sub_f32 v46, v46, v55
    v_sub_f32 v191, v191, v55
    v_sub_f32 v47, v47, v55
    v_sub_f32 v10, v10, v54
    v_exp_f32 v54, -v54
    v_sub_f32 v11, v11, v55
    v_exp_f32 v55, -v55
    s_nop 0
    v_mul_f32 v248, v248, v54
    v_mul_f32 v252, v252, v55
    v_accvgpr_read_b32 v224, a8
    v_accvgpr_read_b32 v225, a9
    v_accvgpr_read_b32 v226, a10
    v_accvgpr_read_b32 v227, a11
    v_mul_f32 v224, v224, v54
    v_mul_f32 v225, v225, v54
    v_mul_f32 v226, v226, v54
    v_mul_f32 v227, v227, v54
    v_accvgpr_write_b32 a8, v224
    v_accvgpr_write_b32 a9, v225
    v_accvgpr_write_b32 a10, v226
    v_accvgpr_write_b32 a11, v227
    v_accvgpr_read_b32 v224, a12
    v_accvgpr_read_b32 v225, a13
    v_accvgpr_read_b32 v226, a14
    v_accvgpr_read_b32 v227, a15
    v_mul_f32 v224, v224, v55
    v_mul_f32 v225, v225, v55
    v_mul_f32 v226, v226, v55
    v_mul_f32 v227, v227, v55
    v_accvgpr_write_b32 a12, v224
    v_accvgpr_write_b32 a13, v225
    v_accvgpr_write_b32 a14, v226
    v_accvgpr_write_b32 a15, v227
    v_accvgpr_read_b32 v224, a24
    v_accvgpr_read_b32 v225, a25
    v_accvgpr_read_b32 v226, a26
    v_accvgpr_read_b32 v227, a27
    v_mul_f32 v224, v224, v54
    v_mul_f32 v225, v225, v54
    v_mul_f32 v226, v226, v54
    v_mul_f32 v227, v227, v54
    v_accvgpr_write_b32 a24, v224
    v_accvgpr_write_b32 a25, v225
    v_accvgpr_write_b32 a26, v226
    v_accvgpr_write_b32 a27, v227
    v_accvgpr_read_b32 v224, a28
    v_accvgpr_read_b32 v225, a29
    v_accvgpr_read_b32 v226, a30
    v_accvgpr_read_b32 v227, a31
    v_mul_f32 v224, v224, v55
    v_mul_f32 v225, v225, v55
    v_mul_f32 v226, v226, v55
    v_mul_f32 v227, v227, v55
    v_accvgpr_write_b32 a28, v224
    v_accvgpr_write_b32 a29, v225
    v_accvgpr_write_b32 a30, v226
    v_accvgpr_write_b32 a31, v227
    v_accvgpr_read_b32 v224, a40
    v_accvgpr_read_b32 v225, a41
    v_accvgpr_read_b32 v226, a42
    v_accvgpr_read_b32 v227, a43
    v_mul_f32 v224, v224, v54
    v_mul_f32 v225, v225, v54
    v_mul_f32 v226, v226, v54
    v_mul_f32 v227, v227, v54
    v_accvgpr_write_b32 a40, v224
    v_accvgpr_write_b32 a41, v225
    v_accvgpr_write_b32 a42, v226
    v_accvgpr_write_b32 a43, v227
    v_accvgpr_read_b32 v224, a44
    v_accvgpr_read_b32 v225, a45
    v_accvgpr_read_b32 v226, a46
    v_accvgpr_read_b32 v227, a47
    v_mul_f32 v224, v224, v55
    v_mul_f32 v225, v225, v55
    v_mul_f32 v226, v226, v55
    v_mul_f32 v227, v227, v55
    v_accvgpr_write_b32 a44, v224
    v_accvgpr_write_b32 a45, v225
    v_accvgpr_write_b32 a46, v226
    v_accvgpr_write_b32 a47, v227
    v_accvgpr_read_b32 v224, a56
    v_accvgpr_read_b32 v225, a57
    v_accvgpr_read_b32 v226, a58
    v_accvgpr_read_b32 v227, a59
    v_mul_f32 v224, v224, v54
    v_mul_f32 v225, v225, v54
    v_mul_f32 v226, v226, v54
    v_mul_f32 v227, v227, v54
    v_accvgpr_write_b32 a56, v224
    v_accvgpr_write_b32 a57, v225
    v_accvgpr_write_b32 a58, v226
    v_accvgpr_write_b32 a59, v227
    v_accvgpr_read_b32 v224, a60
    v_accvgpr_read_b32 v225, a61
    v_accvgpr_read_b32 v226, a62
    v_accvgpr_read_b32 v227, a63
    v_mul_f32 v224, v224, v55
    v_mul_f32 v225, v225, v55
    v_mul_f32 v226, v226, v55
    v_mul_f32 v227, v227, v55
    v_accvgpr_write_b32 a60, v224
    v_accvgpr_write_b32 a61, v225
    v_accvgpr_write_b32 a62, v226
    v_accvgpr_write_b32 a63, v227
    v_accvgpr_read_b32 v224, a72
    v_accvgpr_read_b32 v225, a73
    v_accvgpr_read_b32 v226, a74
    v_accvgpr_read_b32 v227, a75
    v_mul_f32 v224, v224, v54
    v_mul_f32 v225, v225, v54
    v_mul_f32 v226, v226, v54
    v_mul_f32 v227, v227, v54
    v_accvgpr_write_b32 a72, v224
    v_accvgpr_write_b32 a73, v225
    v_accvgpr_write_b32 a74, v226
    v_accvgpr_write_b32 a75, v227
    v_accvgpr_read_b32 v224, a76
    v_accvgpr_read_b32 v225, a77
    v_accvgpr_read_b32 v226, a78
    v_accvgpr_read_b32 v227, a79
    v_mul_f32 v224, v224, v55
    v_mul_f32 v225, v225, v55
    v_mul_f32 v226, v226, v55
    v_mul_f32 v227, v227, v55
    v_accvgpr_write_b32 a76, v224
    v_accvgpr_write_b32 a77, v225
    v_accvgpr_write_b32 a78, v226
    v_accvgpr_write_b32 a79, v227
    v_accvgpr_read_b32 v224, a88
    v_accvgpr_read_b32 v225, a89
    v_accvgpr_read_b32 v226, a90
    v_accvgpr_read_b32 v227, a91
    v_mul_f32 v224, v224, v54
    v_mul_f32 v225, v225, v54
    v_mul_f32 v226, v226, v54
    v_mul_f32 v227, v227, v54
    v_accvgpr_write_b32 a88, v224
    v_accvgpr_write_b32 a89, v225
    v_accvgpr_write_b32 a90, v226
    v_accvgpr_write_b32 a91, v227
    v_accvgpr_read_b32 v224, a92
    v_accvgpr_read_b32 v225, a93
    v_accvgpr_read_b32 v226, a94
    v_accvgpr_read_b32 v227, a95
    v_mul_f32 v224, v224, v55
    v_mul_f32 v225, v225, v55
    v_mul_f32 v226, v226, v55
    v_mul_f32 v227, v227, v55
    v_accvgpr_write_b32 a92, v224
    v_accvgpr_write_b32 a93, v225
    v_accvgpr_write_b32 a94, v226
    v_accvgpr_write_b32 a95, v227
    v_accvgpr_read_b32 v224, a104
    v_accvgpr_read_b32 v225, a105
    v_accvgpr_read_b32 v226, a106
    v_accvgpr_read_b32 v227, a107
    v_mul_f32 v224, v224, v54
    v_mul_f32 v225, v225, v54
    v_mul_f32 v226, v226, v54
    v_mul_f32 v227, v227, v54
    v_accvgpr_write_b32 a104, v224
    v_accvgpr_write_b32 a105, v225
    v_accvgpr_write_b32 a106, v226
    v_accvgpr_write_b32 a107, v227
    v_accvgpr_read_b32 v224, a108
    v_accvgpr_read_b32 v225, a109
    v_accvgpr_read_b32 v226, a110
    v_accvgpr_read_b32 v227, a111
    v_mul_f32 v224, v224, v55
    v_mul_f32 v225, v225, v55
    v_mul_f32 v226, v226, v55
    v_mul_f32 v227, v227, v55
    v_accvgpr_write_b32 a108, v224
    v_accvgpr_write_b32 a109, v225
    v_accvgpr_write_b32 a110, v226
    v_accvgpr_write_b32 a111, v227
    v_accvgpr_read_b32 v224, a120
    v_accvgpr_read_b32 v225, a121
    v_accvgpr_read_b32 v226, a122
    v_accvgpr_read_b32 v227, a123
    v_mul_f32 v224, v224, v54
    v_mul_f32 v225, v225, v54
    v_mul_f32 v226, v226, v54
    v_mul_f32 v227, v227, v54
    v_accvgpr_write_b32 a120, v224
    v_accvgpr_write_b32 a121, v225
    v_accvgpr_write_b32 a122, v226
    v_accvgpr_write_b32 a123, v227
    v_accvgpr_read_b32 v224, a124
    v_accvgpr_read_b32 v225, a125
    v_accvgpr_read_b32 v226, a126
    v_accvgpr_read_b32 v227, a127
    v_mul_f32 v224, v224, v55
    v_mul_f32 v225, v225, v55
    v_mul_f32 v226, v226, v55
    v_mul_f32 v227, v227, v55
    v_accvgpr_write_b32 a124, v224
    v_accvgpr_write_b32 a125, v225
    v_accvgpr_write_b32 a126, v226
    v_accvgpr_write_b32 a127, v227
    v_exp_f32 v232, v128
    v_exp_f32 v233, v129
    v_exp_f32 v234, v130
    v_exp_f32 v235, v131
    s_nop 0
    v_cvt_pk_bf16_f32 v192, v232, v233
    v_cvt_pk_bf16_f32 v193, v234, v235
    v_exp_f32 v232, v144
    v_exp_f32 v233, v145
    v_exp_f32 v234, v146
    v_exp_f32 v235, v147
    s_nop 0
    v_cvt_pk_bf16_f32 v194, v232, v233
    v_cvt_pk_bf16_f32 v195, v234, v235
    v_exp_f32 v232, v132
    v_exp_f32 v233, v133
    v_exp_f32 v234, v134
    v_exp_f32 v235, v135
    s_nop 0
    v_cvt_pk_bf16_f32 v196, v232, v233
    v_cvt_pk_bf16_f32 v197, v234, v235
    v_exp_f32 v232, v148
    v_exp_f32 v233, v149
    v_exp_f32 v234, v150
    v_exp_f32 v235, v151
    s_nop 0
    v_cvt_pk_bf16_f32 v198, v232, v233
    v_cvt_pk_bf16_f32 v199, v234, v235
    v_exp_f32 v232, v136
    v_exp_f32 v233, v137
    v_exp_f32 v234, v138
    v_exp_f32 v235, v139
    s_nop 0
    v_cvt_pk_bf16_f32 v200, v232, v233
    v_cvt_pk_bf16_f32 v201, v234, v235
    v_exp_f32 v232, v152
    v_exp_f32 v233, v153
    v_exp_f32 v234, v154
    v_exp_f32 v235, v155
    s_nop 0
    v_cvt_pk_bf16_f32 v202, v232, v233
    v_cvt_pk_bf16_f32 v203, v234, v235
    v_exp_f32 v232, v140
    v_exp_f32 v233, v141
    v_exp_f32 v234, v142
    v_exp_f32 v235, v143
    s_nop 0
    v_cvt_pk_bf16_f32 v204, v232, v233
    v_cvt_pk_bf16_f32 v205, v234, v235
    v_exp_f32 v232, v156
    v_exp_f32 v233, v157
    v_exp_f32 v234, v158
    v_exp_f32 v235, v159
    s_nop 0
    v_cvt_pk_bf16_f32 v206, v232, v233
    v_cvt_pk_bf16_f32 v207, v234, v235
    s_nop 1
    s_branch k2_ret_108
k2_rare_109:
    s_nop 7
    v_max_f32 v54, v160, v161
    v_max3_f32 v54, v54, v162, v163
    v_max3_f32 v54, v54, v176, v177
    v_max3_f32 v54, v54, v178, v179
    v_max3_f32 v54, v54, v168, v169
    v_max3_f32 v54, v54, v170, v171
    v_max3_f32 v54, v54, v184, v185
    v_max3_f32 v54, v54, v186, v187
    v_max_f32 v55, v164, v165
    v_max3_f32 v55, v55, v166, v167
    v_max3_f32 v55, v55, v180, v181
    v_max3_f32 v55, v55, v182, v183
    v_max3_f32 v55, v55, v172, v173
    v_max3_f32 v55, v55, v174, v175
    v_max3_f32 v55, v55, v188, v189
    v_max3_f32 v55, v55, v190, v191
    v_mov_b32 v226, v54
    v_mov_b32 v227, v55
    s_nop 1
    v_permlane16_swap_b32 v54, v226
    v_permlane16_swap_b32 v55, v227
    s_nop 1
    v_max_f32 v54, v54, v226
    v_max_f32 v55, v55, v227
    v_mov_b32 v226, v54
    v_mov_b32 v227, v55
    s_nop 1
    v_permlane32_swap_b32 v54, v226
    v_permlane32_swap_b32 v55, v227
    s_nop 1
    v_max_f32 v54, v54, v226
    v_max_f32 v55, v55, v227
    v_add_f32 v54, 0x41400000, v54
    v_max_f32 v54, 0, v54
    v_add_f32 v55, 0x41400000, v55
    v_max_f32 v55, 0, v55
    v_sub_f32 v160, v160, v54
    v_sub_f32 v161, v161, v54
    v_sub_f32 v162, v162, v54
    v_sub_f32 v163, v163, v54
    v_sub_f32 v164, v164, v55
    v_sub_f32 v165, v165, v55
    v_sub_f32 v166, v166, v55
    v_sub_f32 v167, v167, v55
    v_sub_f32 v168, v168, v54
    v_sub_f32 v169, v169, v54
    v_sub_f32 v170, v170, v54
    v_sub_f32 v171, v171, v54
    v_sub_f32 v172, v172, v55
    v_sub_f32 v173, v173, v55
    v_sub_f32 v174, v174, v55
    v_sub_f32 v175, v175, v55
    v_sub_f32 v176, v176, v54
    v_sub_f32 v177, v177, v54
    v_sub_f32 v178, v178, v54
    v_sub_f32 v179, v179, v54
    v_sub_f32 v180, v180, v55
    v_sub_f32 v181, v181, v55
    v_sub_f32 v182, v182, v55
    v_sub_f32 v183, v183, v55
    v_sub_f32 v184, v184, v54
    v_sub_f32 v185, v185, v54
    v_sub_f32 v186, v186, v54
    v_sub_f32 v187, v187, v54
    v_sub_f32 v188, v188, v55
    v_sub_f32 v189, v189, v55
    v_sub_f32 v190, v190, v55
    v_sub_f32 v191, v191, v55
    v_sub_f32 v10, v10, v54
    v_exp_f32 v54, -v54
    v_sub_f32 v11, v11, v55
    v_exp_f32 v55, -v55
    s_nop 0
    v_mul_f32 v248, v248, v54
    v_mul_f32 v252, v252, v55
    v_accvgpr_read_b32 v224, a8
    v_accvgpr_read_b32 v225, a9
    v_accvgpr_read_b32 v226, a10
    v_accvgpr_read_b32 v227, a11
    v_mul_f32 v224, v224, v54
    v_mul_f32 v225, v225, v54
    v_mul_f32 v226, v226, v54
    v_mul_f32 v227, v227, v54
    v_accvgpr_write_b32 a8, v224
    v_accvgpr_write_b32 a9, v225
    v_accvgpr_write_b32 a10, v226
    v_accvgpr_write_b32 a11, v227
    v_accvgpr_read_b32 v224, a12
    v_accvgpr_read_b32 v225, a13
    v_accvgpr_read_b32 v226, a14
    v_accvgpr_read_b32 v227, a15
    v_mul_f32 v224, v224, v55
    v_mul_f32 v225, v225, v55
    v_mul_f32 v226, v226, v55
    v_mul_f32 v227, v227, v55
    v_accvgpr_write_b32 a12, v224
    v_accvgpr_write_b32 a13, v225
    v_accvgpr_write_b32 a14, v226
    v_accvgpr_write_b32 a15, v227
    v_accvgpr_read_b32 v224, a24
    v_accvgpr_read_b32 v225, a25
    v_accvgpr_read_b32 v226, a26
    v_accvgpr_read_b32 v227, a27
    v_mul_f32 v224, v224, v54
    v_mul_f32 v225, v225, v54
    v_mul_f32 v226, v226, v54
    v_mul_f32 v227, v227, v54
    v_accvgpr_write_b32 a24, v224
    v_accvgpr_write_b32 a25, v225
    v_accvgpr_write_b32 a26, v226
    v_accvgpr_write_b32 a27, v227
    v_accvgpr_read_b32 v224, a28
    v_accvgpr_read_b32 v225, a29
    v_accvgpr_read_b32 v226, a30
    v_accvgpr_read_b32 v227, a31
    v_mul_f32 v224, v224, v55
    v_mul_f32 v225, v225, v55
    v_mul_f32 v226, v226, v55
    v_mul_f32 v227, v227, v55
    v_accvgpr_write_b32 a28, v224
    v_accvgpr_write_b32 a29, v225
    v_accvgpr_write_b32 a30, v226
    v_accvgpr_write_b32 a31, v227
    v_accvgpr_read_b32 v224, a40
    v_accvgpr_read_b32 v225, a41
    v_accvgpr_read_b32 v226, a42
    v_accvgpr_read_b32 v227, a43
    v_mul_f32 v224, v224, v54
    v_mul_f32 v225, v225, v54
    v_mul_f32 v226, v226, v54
    v_mul_f32 v227, v227, v54
    v_accvgpr_write_b32 a40, v224
    v_accvgpr_write_b32 a41, v225
    v_accvgpr_write_b32 a42, v226
    v_accvgpr_write_b32 a43, v227
    v_accvgpr_read_b32 v224, a44
    v_accvgpr_read_b32 v225, a45
    v_accvgpr_read_b32 v226, a46
    v_accvgpr_read_b32 v227, a47
    v_mul_f32 v224, v224, v55
    v_mul_f32 v225, v225, v55
    v_mul_f32 v226, v226, v55
    v_mul_f32 v227, v227, v55
    v_accvgpr_write_b32 a44, v224
    v_accvgpr_write_b32 a45, v225
    v_accvgpr_write_b32 a46, v226
    v_accvgpr_write_b32 a47, v227
    v_accvgpr_read_b32 v224, a56
    v_accvgpr_read_b32 v225, a57
    v_accvgpr_read_b32 v226, a58
    v_accvgpr_read_b32 v227, a59
    v_mul_f32 v224, v224, v54
    v_mul_f32 v225, v225, v54
    v_mul_f32 v226, v226, v54
    v_mul_f32 v227, v227, v54
    v_accvgpr_write_b32 a56, v224
    v_accvgpr_write_b32 a57, v225
    v_accvgpr_write_b32 a58, v226
    v_accvgpr_write_b32 a59, v227
    v_accvgpr_read_b32 v224, a60
    v_accvgpr_read_b32 v225, a61
    v_accvgpr_read_b32 v226, a62
    v_accvgpr_read_b32 v227, a63
    v_mul_f32 v224, v224, v55
    v_mul_f32 v225, v225, v55
    v_mul_f32 v226, v226, v55
    v_mul_f32 v227, v227, v55
    v_accvgpr_write_b32 a60, v224
    v_accvgpr_write_b32 a61, v225
    v_accvgpr_write_b32 a62, v226
    v_accvgpr_write_b32 a63, v227
    v_accvgpr_read_b32 v224, a72
    v_accvgpr_read_b32 v225, a73
    v_accvgpr_read_b32 v226, a74
    v_accvgpr_read_b32 v227, a75
    v_mul_f32 v224, v224, v54
    v_mul_f32 v225, v225, v54
    v_mul_f32 v226, v226, v54
    v_mul_f32 v227, v227, v54
    v_accvgpr_write_b32 a72, v224
    v_accvgpr_write_b32 a73, v225
    v_accvgpr_write_b32 a74, v226
    v_accvgpr_write_b32 a75, v227
    v_accvgpr_read_b32 v224, a76
    v_accvgpr_read_b32 v225, a77
    v_accvgpr_read_b32 v226, a78
    v_accvgpr_read_b32 v227, a79
    v_mul_f32 v224, v224, v55
    v_mul_f32 v225, v225, v55
    v_mul_f32 v226, v226, v55
    v_mul_f32 v227, v227, v55
    v_accvgpr_write_b32 a76, v224
    v_accvgpr_write_b32 a77, v225
    v_accvgpr_write_b32 a78, v226
    v_accvgpr_write_b32 a79, v227
    v_accvgpr_read_b32 v224, a88
    v_accvgpr_read_b32 v225, a89
    v_accvgpr_read_b32 v226, a90
    v_accvgpr_read_b32 v227, a91
    v_mul_f32 v224, v224, v54
    v_mul_f32 v225, v225, v54
    v_mul_f32 v226, v226, v54
    v_mul_f32 v227, v227, v54
    v_accvgpr_write_b32 a88, v224
    v_accvgpr_write_b32 a89, v225
    v_accvgpr_write_b32 a90, v226
    v_accvgpr_write_b32 a91, v227
    v_accvgpr_read_b32 v224, a92
    v_accvgpr_read_b32 v225, a93
    v_accvgpr_read_b32 v226, a94
    v_accvgpr_read_b32 v227, a95
    v_mul_f32 v224, v224, v55
    v_mul_f32 v225, v225, v55
    v_mul_f32 v226, v226, v55
    v_mul_f32 v227, v227, v55
    v_accvgpr_write_b32 a92, v224
    v_accvgpr_write_b32 a93, v225
    v_accvgpr_write_b32 a94, v226
    v_accvgpr_write_b32 a95, v227
    v_accvgpr_read_b32 v224, a104
    v_accvgpr_read_b32 v225, a105
    v_accvgpr_read_b32 v226, a106
    v_accvgpr_read_b32 v227, a107
    v_mul_f32 v224, v224, v54
    v_mul_f32 v225, v225, v54
    v_mul_f32 v226, v226, v54
    v_mul_f32 v227, v227, v54
    v_accvgpr_write_b32 a104, v224
    v_accvgpr_write_b32 a105, v225
    v_accvgpr_write_b32 a106, v226
    v_accvgpr_write_b32 a107, v227
    v_accvgpr_read_b32 v224, a108
    v_accvgpr_read_b32 v225, a109
    v_accvgpr_read_b32 v226, a110
    v_accvgpr_read_b32 v227, a111
    v_mul_f32 v224, v224, v55
    v_mul_f32 v225, v225, v55
    v_mul_f32 v226, v226, v55
    v_mul_f32 v227, v227, v55
    v_accvgpr_write_b32 a108, v224
    v_accvgpr_write_b32 a109, v225
    v_accvgpr_write_b32 a110, v226
    v_accvgpr_write_b32 a111, v227
    v_accvgpr_read_b32 v224, a120
    v_accvgpr_read_b32 v225, a121
    v_accvgpr_read_b32 v226, a122
    v_accvgpr_read_b32 v227, a123
    v_mul_f32 v224, v224, v54
    v_mul_f32 v225, v225, v54
    v_mul_f32 v226, v226, v54
    v_mul_f32 v227, v227, v54
    v_accvgpr_write_b32 a120, v224
    v_accvgpr_write_b32 a121, v225
    v_accvgpr_write_b32 a122, v226
    v_accvgpr_write_b32 a123, v227
    v_accvgpr_read_b32 v224, a124
    v_accvgpr_read_b32 v225, a125
    v_accvgpr_read_b32 v226, a126
    v_accvgpr_read_b32 v227, a127
    v_mul_f32 v224, v224, v55
    v_mul_f32 v225, v225, v55
    v_mul_f32 v226, v226, v55
    v_mul_f32 v227, v227, v55
    v_accvgpr_write_b32 a124, v224
    v_accvgpr_write_b32 a125, v225
    v_accvgpr_write_b32 a126, v226
    v_accvgpr_write_b32 a127, v227
    v_exp_f32 v232, v160
    v_exp_f32 v233, v161
    v_exp_f32 v234, v162
    v_exp_f32 v235, v163
    s_nop 0
    v_cvt_pk_bf16_f32 v208, v232, v233
    v_cvt_pk_bf16_f32 v209, v234, v235
    v_exp_f32 v232, v176
    v_exp_f32 v233, v177
    v_exp_f32 v234, v178
    v_exp_f32 v235, v179
    s_nop 0
    v_cvt_pk_bf16_f32 v210, v232, v233
    v_cvt_pk_bf16_f32 v211, v234, v235
    v_exp_f32 v232, v164
    v_exp_f32 v233, v165
    v_exp_f32 v234, v166
    v_exp_f32 v235, v167
    s_nop 0
    v_cvt_pk_bf16_f32 v212, v232, v233
    v_cvt_pk_bf16_f32 v213, v234, v235
    v_exp_f32 v232, v180
    v_exp_f32 v233, v181
    v_exp_f32 v234, v182
    v_exp_f32 v235, v183
    s_nop 0
    v_cvt_pk_bf16_f32 v214, v232, v233
    v_cvt_pk_bf16_f32 v215, v234, v235
    v_exp_f32 v232, v168
    v_exp_f32 v233, v169
    v_exp_f32 v234, v170
    v_exp_f32 v235, v171
    s_nop 0
    v_cvt_pk_bf16_f32 v216, v232, v233
    v_cvt_pk_bf16_f32 v217, v234, v235
    v_exp_f32 v232, v184
    v_exp_f32 v233, v185
    v_exp_f32 v234, v186
    v_exp_f32 v235, v187
    s_nop 0
    v_cvt_pk_bf16_f32 v218, v232, v233
    v_cvt_pk_bf16_f32 v219, v234, v235
    v_exp_f32 v232, v172
    v_exp_f32 v233, v173
    v_exp_f32 v234, v174
    v_exp_f32 v235, v175
    s_nop 0
    v_cvt_pk_bf16_f32 v220, v232, v233
    v_cvt_pk_bf16_f32 v221, v234, v235
    v_exp_f32 v232, v188
    v_exp_f32 v233, v189
    v_exp_f32 v234, v190
    v_exp_f32 v235, v191
    s_nop 0
    v_cvt_pk_bf16_f32 v222, v232, v233
    v_cvt_pk_bf16_f32 v223, v234, v235
    s_nop 1
    s_branch k2_ret_110
.globl k3_kernel
.p2align 8
.type k3_kernel,@function
k3_kernel:
    s_cmp_ge_u32 s2, 256
    s_cbranch_scc1 k3_end_112
    s_load_dwordx2 s[4:5], s[0:1], 40
    s_load_dwordx2 s[6:7], s[0:1], 104
    s_load_dwordx2 s[28:29], s[0:1], 0
    s_load_dwordx2 s[30:31], s[0:1], 56
    s_lshr_b32 s41, s2, 3
    s_bfe_u32 s44, s2, 0x10002
    s_and_b32 s42, s2, 1
    s_lshl_b32 s42, s42, 3
    s_and_b32 s43, s41, 7
    s_add_u32 s42, s42, s43
    s_and_b32 s43, s2, 2
    s_lshl_b32 s43, s43, 1
    s_lshr_b32 s40, s41, 3
    s_add_u32 s43, s43, s40
    v_lshrrev_b32 v10, 6, v0
    v_and_b32 v11, 63, v0
    v_readfirstlane_b32 s45, v10
    v_lshlrev_b32 v1, 4, v11
    s_lshl_b32 s46, s42, 7
    s_lshl_b32 s47, s45, 5
    s_add_u32 s46, s46, s47
    s_lshl_b32 s47, s46, 6
    v_add_u32 v12, s47, v1
    v_add_u32 v13, 0x20000, v12
    v_lshrrev_b32 v20, 4, v11
    v_bfe_u32 v21, v11, 1, 3
    v_xor_b32 v21, v21, v20
    v_and_b32 v22, 1, v11
    v_lshl_add_u32 v23, v10, 4, v20
    v_lshlrev_b32 v23, 11, v23
    v_lshl_add_u32 v23, v22, 4, v23
    s_lshl_b32 s47, s43, 8
    v_add_u32 v23, s47, v23
    v_xor_b32 v22, 0, v21
    v_lshl_add_u32 v22, v22, 5, v23
    v_add_u32 v16, 0, v22
    v_xor_b32 v22, 4, v21
    v_lshl_add_u32 v22, v22, 5, v23
    v_add_u32 v17, 7168, v22
    v_xor_b32 v22, 0, v21
    v_lshl_add_u32 v22, v22, 5, v23
    v_add_u32 v18, 14336, v22
    v_xor_b32 v22, 4, v21
    v_lshl_add_u32 v22, v22, 5, v23
    v_add_u32 v19, 21504, v22
    s_lshl_b32 s60, s45, 12
    s_lshl_b32 s61, s44, 22
    s_lshl_b32 s62, s44, 23
    s_waitcnt lgkmcnt(0)
    s_add_u32 s8, s6, 0x3000000
    s_addc_u32 s9, s7, 0
    s_and_b32 s9, s9, 0xffff
    s_mov_b32 s10, 0x1000000
    s_mov_b32 s11, 0x00020000
    s_mov_b32 s12, s4
    s_and_b32 s13, s5, 0xffff
    s_mov_b32 s14, 0x800000
    s_mov_b32 s15, 0x00020000
    s_add_u32 s10, s62, 0x800000
    s_add_u32 s14, s61, 0x400000
    s_add_u32 m0, s60, 0
    s_nop 0
    buffer_load_dwordx4 v16, s[12:15], s61 offen offset:0 lds
    buffer_load_dwordx4 v17, s[12:15], s61 offen offset:1024 lds
    buffer_load_dwordx4 v18, s[12:15], s61 offen offset:2048 lds
    buffer_load_dwordx4 v19, s[12:15], s61 offen offset:3072 lds
    s_add_u32 s61, s61, 0x20000
    buffer_load_dwordx4 a[128:131], v12, s[8:11], s62 offen offset:0
    buffer_load_dwordx4 a[132:135], v12, s[8:11], s62 offen offset:1024
    buffer_load_dwordx4 a[136:139], v13, s[8:11], s62 offen offset:0
    buffer_load_dwordx4 a[140:143], v13, s[8:11], s62 offen offset:1024
    s_add_u32 s62, s62, 0x40000
    s_add_u32 m0, s60, 16384
    s_nop 0
    buffer_load_dwordx4 v16, s[12:15], s61 offen offset:0 lds
    buffer_load_dwordx4 v17, s[12:15], s61 offen offset:1024 lds
    buffer_load_dwordx4 v18, s[12:15], s61 offen offset:2048 lds
    buffer_load_dwordx4 v19, s[12:15], s61 offen offset:3072 lds
    s_add_u32 s61, s61, 0x20000
    buffer_load_dwordx4 a[144:147], v12, s[8:11], s62 offen offset:0
    buffer_load_dwordx4 a[148:151], v12, s[8:11], s62 offen offset:1024
    buffer_load_dwordx4 a[152:155], v13, s[8:11], s62 offen offset:0
    buffer_load_dwordx4 a[156:159], v13, s[8:11], s62 offen offset:1024
    s_add_u32 s62, s62, 0x40000
    s_add_u32 m0, s60, 32768
    s_nop 0
    buffer_load_dwordx4 v16, s[12:15], s61 offen offset:0 lds
    buffer_load_dwordx4 v17, s[12:15], s61 offen offset:1024 lds
    buffer_load_dwordx4 v18, s[12:15], s61 offen offset:2048 lds
    buffer_load_dwordx4 v19, s[12:15], s61 offen offset:3072 lds
    s_add_u32 s61, s61, 0x20000
    buffer_load_dwordx4 a[160:163], v12, s[8:11], s62 offen offset:0
    buffer_load_dwordx4 a[164:167], v12, s[8:11], s62 offen offset:1024
    buffer_load_dwordx4 a[168:171], v13, s[8:11], s62 offen offset:0
    buffer_load_dwordx4 a[172:175], v13, s[8:11], s62 offen offset:1024
    s_add_u32 s62, s62, 0x40000
    s_mov_b32 s16, s28
    s_and_b32 s17, s29, 0xffff
    s_mov_b32 s18, 0x400000
    s_mov_b32 s19, 0x00020000
    s_mov_b32 s20, s30
    s_and_b32 s21, s31, 0xffff
    s_mov_b32 s22, 0x800
    s_mov_b32 s23, 0x00020000
    s_add_u32 s24, s6, 0x4000000
    s_addc_u32 s25, s7, 0
    s_and_b32 s25, s25, 0xffff
    s_mov_b32 s26, 0x400000
    s_mov_b32 s27, 0x00020000
    s_add_u32 s32, s6, 0x4800000
    s_addc_u32 s33, s7, 0
    s_and_b32 s33, s33, 0xffff
    s_mov_b32 s34, 0x6000
    s_mov_b32 s35, 0x00020000
    s_add_u32 s36, s6, 0x5000000
    s_addc_u32 s37, s7, 0
    s_and_b32 s37, s37, 0xffff
    s_mov_b32 s38, 0x800000
    s_mov_b32 s39, 0x00020000
    s_add_u32 s48, s6, 0x4807000
    s_addc_u32 s49, s7, 0
    s_and_b32 s49, s49, 0xffff
    s_mov_b32 s50, 0x8000
    s_mov_b32 s51, 0x00020000
    v_and_b32 v21, 15, v11
    v_add_u32 v22, s46, v21
    v_lshlrev_b32 v2, 2, v22
    v_lshl_add_u32 v2, v20, 13, v2
    v_lshlrev_b32 v22, 11, v22
    s_lshl_b32 s52, s44, 7
    s_add_u32 s47, s47, s52
    v_lshl_add_u32 v14, v20, 3, s47
    v_add_u32 v3, v22, v14
    v_add_u32 v4, 0x8000, v3
    s_lshl_b32 s52, s2, 14
    s_add_u32 s52, s52, s60
    s_xor_b32 s53, s52, 0x10000
    s_lshl_b32 s54, s2, 7
    s_xor_b32 s55, s54, 0x200
    v_mov_b32 v5, 0
    v_mov_b32 v6, 1
    v_lshrrev_b32 v22, 2, v21
    v_lshl_add_u32 v22, v20, 2, v22
    v_and_b32 v23, 7, v22
    s_lshl_b32 s56, s44, 2
    v_xor_b32 v23, s56, v23
    v_lshlrev_b32 v22, 8, v22
    v_and_b32 v32, 3, v11
    v_lshl_add_u32 v22, v32, 3, v22
    v_xor_b32 v32, 0, v23
    v_lshl_add_u32 v24, v32, 5, v22
    v_xor_b32 v32, 1, v23
    v_lshl_add_u32 v25, v32, 5, v22
    v_xor_b32 v32, 2, v23
    v_lshl_add_u32 v26, v32, 5, v22
    v_xor_b32 v32, 3, v23
    v_lshl_add_u32 v27, v32, 5, v22
    v_xor_b32 v32, 4, v23
    v_lshl_add_u32 v28, v32, 5, v22
    v_xor_b32 v32, 5, v23
    v_lshl_add_u32 v29, v32, 5, v22
    v_xor_b32 v32, 6, v23
    v_lshl_add_u32 v30, v32, 5, v22
    v_xor_b32 v32, 7, v23
    v_lshl_add_u32 v31, v32, 5, v22
    s_mov_b32 s57, (code_end-k3_tail)/128
    v_mov_b32 v56, 0
    v_mov_b32 v57, 0
    v_mov_b32 v58, 0
    v_mov_b32 v59, 0
    s_nop 1
    v_mfma_f32_32x32x16_bf16 v[64:79], v[56:59], v[56:59], 0
    v_mfma_f32_32x32x16_bf16 v[80:95], v[56:59], v[56:59], 0
    v_mfma_f32_32x32x16_bf16 v[96:111], v[56:59], v[56:59], 0
    v_mfma_f32_32x32x16_bf16 v[112:127], v[56:59], v[56:59], 0
    v_min_u32 v33, s57, v0
    s_getpc_b64 s[58:59]
pc_113:
    s_add_u32 s58, s58, k3_tail-pc_113
    s_addc_u32 s59, s59, 0
    v_lshlrev_b32 v8, 7, v33
    v_mov_b32 v9, s59
    v_add_co_u32 v8, vcc, s58, v8
    s_nop 1
    v_addc_co_u32 v9, vcc, 0, v9, vcc
    s_lshl_b32 s56, s41, 2
    s_add_u32 s56, s56, s45
    s_and_b32 s57, s2, 7
    v_lshrrev_b32 v34, 3, v11
    v_and_b32 v35, 7, v11
    v_min_u32 v35, 6, v35
    v_mul_u32_u24 v34, 7168, v34
    v_lshl_add_u32 v34, v35, 7, v34
    s_mul_i32 s58, s56, 57344
    s_mul_i32 s59, s57, 896
    s_add_u32 s58, s58, s59
    v_add_u32 v34, s58, v34
    v_min_u32 v35, 55, v11
    v_lshlrev_b32 v35, 7, v35
    s_mul_i32 s58, s56, 7168
    s_mul_i32 s59, s57, 917504
    s_add_u32 s58, s58, s59
    v_add_u32 v35, s58, v35
    s_waitcnt vmcnt(20)
    s_barrier
    ds_read_b64_tr_b16 a[0:1], v24 offset:0
    ds_read_b64_tr_b16 a[2:3], v24 offset:4096
    ds_read_b64_tr_b16 a[4:5], v25 offset:0
    ds_read_b64_tr_b16 a[6:7], v25 offset:4096
    ds_read_b64_tr_b16 a[8:9], v26 offset:0
    ds_read_b64_tr_b16 a[10:11], v26 offset:4096
    ds_read_b64_tr_b16 a[12:13], v27 offset:0
    ds_read_b64_tr_b16 a[14:15], v27 offset:4096
    ds_read_b64_tr_b16 a[16:17], v28 offset:0
    ds_read_b64_tr_b16 a[18:19], v28 offset:4096
    ds_read_b64_tr_b16 a[20:21], v29 offset:0
    ds_read_b64_tr_b16 a[22:23], v29 offset:4096
    ds_read_b64_tr_b16 a[24:25], v30 offset:0
    ds_read_b64_tr_b16 a[26:27], v30 offset:4096
    ds_read_b64_tr_b16 a[28:29], v31 offset:0
    ds_read_b64_tr_b16 a[30:31], v31 offset:4096
    ds_read_b64_tr_b16 a[32:33], v24 offset:8192
    ds_read_b64_tr_b16 a[34:35], v24 offset:12288
    ds_read_b64_tr_b16 a[36:37], v25 offset:8192
    ds_read_b64_tr_b16 a[38:39], v25 offset:12288
    ds_read_b64_tr_b16 a[40:41], v26 offset:8192
    ds_read_b64_tr_b16 a[42:43], v26 offset:12288
    ds_read_b64_tr_b16 a[44:45], v27 offset:8192
    ds_read_b64_tr_b16 a[46:47], v27 offset:12288
    ds_read_b64_tr_b16 a[48:49], v28 offset:8192
    ds_read_b64_tr_b16 a[50:51], v28 offset:12288
    ds_read_b64_tr_b16 a[52:53], v29 offset:8192
    ds_read_b64_tr_b16 a[54:55], v29 offset:12288
    ds_read_b64_tr_b16 a[56:57], v30 offset:8192
    ds_read_b64_tr_b16 a[58:59], v30 offset:12288
    ds_read_b64_tr_b16 a[60:61], v31 offset:8192
    ds_read_b64_tr_b16 a[62:63], v31 offset:12288
    s_mov_b32 s63, 0
    s_waitcnt vmcnt(12) lgkmcnt(0)
    s_barrier
k3_loop_114:
    v_mfma_f32_16x16x32_bf16 v[96:99], a[16:19], a[128:131], v[96:99]
    s_add_u32 m0, s60, 49152
    ds_read_b64_tr_b16 a[64:65], v24 offset:16384
    ds_read_b64_tr_b16 a[66:67], v24 offset:20480
    v_mfma_f32_16x16x32_bf16 v[100:103], a[16:19], a[132:135], v[100:103]
    buffer_load_dwordx4 v16, s[12:15], s61 offen offset:0 lds
    ds_read_b64_tr_b16 a[68:69], v25 offset:16384
    v_mfma_f32_16x16x32_bf16 v[104:107], a[20:23], a[128:131], v[104:107]
    ds_read_b64_tr_b16 a[70:71], v25 offset:20480
    ds_read_b64_tr_b16 a[72:73], v26 offset:16384
    v_mfma_f32_16x16x32_bf16 v[108:111], a[20:23], a[132:135], v[108:111]
    buffer_load_dwordx4 v17, s[12:15], s61 offen offset:1024 lds
    ds_read_b64_tr_b16 a[74:75], v26 offset:20480
    v_mfma_f32_16x16x32_bf16 v[112:115], a[24:27], a[128:131], v[112:115]
    ds_read_b64_tr_b16 a[76:77], v27 offset:16384
    ds_read_b64_tr_b16 a[78:79], v27 offset:20480
    v_mfma_f32_16x16x32_bf16 v[116:119], a[24:27], a[132:135], v[116:119]
    ds_read_b64_tr_b16 a[80:81], v28 offset:16384
    v_mfma_f32_16x16x32_bf16 v[120:123], a[28:31], a[128:131], v[120:123]
    ds_read_b64_tr_b16 a[82:83], v28 offset:20480
    v_mfma_f32_16x16x32_bf16 v[124:127], a[28:31], a[132:135], v[124:127]
    buffer_load_dwordx4 v18, s[12:15], s61 offen offset:2048 lds
    ds_read_b64_tr_b16 a[84:85], v29 offset:16384
    v_mfma_f32_16x16x32_bf16 v[64:67], a[0:3], a[128:131], v[64:67]
    ds_read_b64_tr_b16 a[86:87], v29 offset:20480
    ds_read_b64_tr_b16 a[88:89], v30 offset:16384
    v_mfma_f32_16x16x32_bf16 v[68:71], a[0:3], a[132:135], v[68:71]
    ds_read_b64_tr_b16 a[90:91], v30 offset:20480
    v_mfma_f32_16x16x32_bf16 v[72:75], a[4:7], a[128:131], v[72:75]
    buffer_load_dwordx4 v19, s[12:15], s61 offen offset:3072 lds
    ds_read_b64_tr_b16 a[92:93], v31 offset:16384
    v_mfma_f32_16x16x32_bf16 v[76:79], a[4:7], a[132:135], v[76:79]
    ds_read_b64_tr_b16 a[94:95], v31 offset:20480
    ds_read_b64_tr_b16 a[96:97], v24 offset:24576
    v_mfma_f32_16x16x32_bf16 v[80:83], a[8:11], a[128:131], v[80:83]
    ds_read_b64_tr_b16 a[98:99], v24 offset:28672
    v_mfma_f32_16x16x32_bf16 v[84:87], a[8:11], a[132:135], v[84:87]
    ds_read_b64_tr_b16 a[100:101], v25 offset:24576
    v_mfma_f32_16x16x32_bf16 v[88:91], a[12:15], a[128:131], v[88:91]
    buffer_load_dwordx4 a[176:179], v12, s[8:11], s62 offen offset:0
    ds_read_b64_tr_b16 a[102:103], v25 offset:28672
    v_mfma_f32_16x16x32_bf16 v[92:95], a[12:15], a[132:135], v[92:95]
    s_add_u32 s61, s61, 0x20000
    ds_read_b64_tr_b16 a[104:105], v26 offset:24576
    ds_read_b64_tr_b16 a[106:107], v26 offset:28672
    v_mfma_f32_16x16x32_bf16 v[96:99], a[48:51], a[136:139], v[96:99]
    ds_read_b64_tr_b16 a[108:109], v27 offset:24576
    v_mfma_f32_16x16x32_bf16 v[100:103], a[48:51], a[140:143], v[100:103]
    buffer_load_dwordx4 a[180:183], v12, s[8:11], s62 offen offset:1024
    ds_read_b64_tr_b16 a[110:111], v27 offset:28672
    v_mfma_f32_16x16x32_bf16 v[104:107], a[52:55], a[136:139], v[104:107]
    ds_read_b64_tr_b16 a[112:113], v28 offset:24576
    v_mfma_f32_16x16x32_bf16 v[108:111], a[52:55], a[140:143], v[108:111]
    ds_read_b64_tr_b16 a[114:115], v28 offset:28672
    ds_read_b64_tr_b16 a[116:117], v29 offset:24576
    v_mfma_f32_16x16x32_bf16 v[112:115], a[56:59], a[136:139], v[112:115]
    ds_read_b64_tr_b16 a[118:119], v29 offset:28672
    v_mfma_f32_16x16x32_bf16 v[116:119], a[56:59], a[140:143], v[116:119]
    buffer_load_dwordx4 a[184:187], v13, s[8:11], s62 offen offset:0
    ds_read_b64_tr_b16 a[120:121], v30 offset:24576
    v_mfma_f32_16x16x32_bf16 v[120:123], a[60:63], a[136:139], v[120:123]
    ds_read_b64_tr_b16 a[122:123], v30 offset:28672
    ds_read_b64_tr_b16 a[124:125], v31 offset:24576
    v_mfma_f32_16x16x32_bf16 v[124:127], a[60:63], a[140:143], v[124:127]
    ds_read_b64_tr_b16 a[126:127], v31 offset:28672
    v_mfma_f32_16x16x32_bf16 v[64:67], a[32:35], a[136:139], v[64:67]
    buffer_load_dwordx4 a[188:191], v13, s[8:11], s62 offen offset:1024
    v_mfma_f32_16x16x32_bf16 v[68:71], a[32:35], a[140:143], v[68:71]
    v_mfma_f32_16x16x32_bf16 v[72:75], a[36:39], a[136:139], v[72:75]
    v_mfma_f32_16x16x32_bf16 v[76:79], a[36:39], a[140:143], v[76:79]
    v_mfma_f32_16x16x32_bf16 v[80:83], a[40:43], a[136:139], v[80:83]
    s_cmp_eq_u32 s63, 7
    s_cbranch_scc1 k3_ool_115
k3_oolret_116:
    v_mfma_f32_16x16x32_bf16 v[84:87], a[40:43], a[140:143], v[84:87]
    s_add_u32 s62, s62, 0x40000
    v_mfma_f32_16x16x32_bf16 v[88:91], a[44:47], a[136:139], v[88:91]
    v_mfma_f32_16x16x32_bf16 v[92:95], a[44:47], a[140:143], v[92:95]
    s_waitcnt vmcnt(12) lgkmcnt(0)
    s_barrier
    v_mfma_f32_16x16x32_bf16 v[96:99], a[80:83], a[144:147], v[96:99]
    s_add_u32 m0, s60, 0
    ds_read_b64_tr_b16 a[0:1], v24 offset:32768
    ds_read_b64_tr_b16 a[2:3], v24 offset:36864
    v_mfma_f32_16x16x32_bf16 v[100:103], a[80:83], a[148:151], v[100:103]
    buffer_load_dwordx4 v16, s[12:15], s61 offen offset:0 lds
    ds_read_b64_tr_b16 a[4:5], v25 offset:32768
    v_mfma_f32_16x16x32_bf16 v[104:107], a[84:87], a[144:147], v[104:107]
    ds_read_b64_tr_b16 a[6:7], v25 offset:36864
    ds_read_b64_tr_b16 a[8:9], v26 offset:32768
    v_mfma_f32_16x16x32_bf16 v[108:111], a[84:87], a[148:151], v[108:111]
    buffer_load_dwordx4 v17, s[12:15], s61 offen offset:1024 lds
    ds_read_b64_tr_b16 a[10:11], v26 offset:36864
    v_mfma_f32_16x16x32_bf16 v[112:115], a[88:91], a[144:147], v[112:115]
    ds_read_b64_tr_b16 a[12:13], v27 offset:32768
    ds_read_b64_tr_b16 a[14:15], v27 offset:36864
    v_mfma_f32_16x16x32_bf16 v[116:119], a[88:91], a[148:151], v[116:119]
    ds_read_b64_tr_b16 a[16:17], v28 offset:32768
    v_mfma_f32_16x16x32_bf16 v[120:123], a[92:95], a[144:147], v[120:123]
    ds_read_b64_tr_b16 a[18:19], v28 offset:36864
    v_mfma_f32_16x16x32_bf16 v[124:127], a[92:95], a[148:151], v[124:127]
    buffer_load_dwordx4 v18, s[12:15], s61 offen offset:2048 lds
    ds_read_b64_tr_b16 a[20:21], v29 offset:32768
    v_mfma_f32_16x16x32_bf16 v[64:67], a[64:67], a[144:147], v[64:67]
    ds_read_b64_tr_b16 a[22:23], v29 offset:36864
    ds_read_b64_tr_b16 a[24:25], v30 offset:32768
    v_mfma_f32_16x16x32_bf16 v[68:71], a[64:67], a[148:151], v[68:71]
    ds_read_b64_tr_b16 a[26:27], v30 offset:36864
    v_mfma_f32_16x16x32_bf16 v[72:75], a[68:71], a[144:147], v[72:75]
    buffer_load_dwordx4 v19, s[12:15], s61 offen offset:3072 lds
    ds_read_b64_tr_b16 a[28:29], v31 offset:32768
    v_mfma_f32_16x16x32_bf16 v[76:79], a[68:71], a[148:151], v[76:79]
    ds_read_b64_tr_b16 a[30:31], v31 offset:36864
    ds_read_b64_tr_b16 a[32:33], v24 offset:40960
    v_mfma_f32_16x16x32_bf16 v[80:83], a[72:75], a[144:147], v[80:83]
    ds_read_b64_tr_b16 a[34:35], v24 offset:45056
    v_mfma_f32_16x16x32_bf16 v[84:87], a[72:75], a[148:151], v[84:87]
    ds_read_b64_tr_b16 a[36:37], v25 offset:40960
    v_mfma_f32_16x16x32_bf16 v[88:91], a[76:79], a[144:147], v[88:91]
    buffer_load_dwordx4 a[128:131], v12, s[8:11], s62 offen offset:0
    ds_read_b64_tr_b16 a[38:39], v25 offset:45056
    v_mfma_f32_16x16x32_bf16 v[92:95], a[76:79], a[148:151], v[92:95]
    s_add_u32 s61, s61, 0x20000
    ds_read_b64_tr_b16 a[40:41], v26 offset:40960
    ds_read_b64_tr_b16 a[42:43], v26 offset:45056
    v_mfma_f32_16x16x32_bf16 v[96:99], a[112:115], a[152:155], v[96:99]
    ds_read_b64_tr_b16 a[44:45], v27 offset:40960
    v_mfma_f32_16x16x32_bf16 v[100:103], a[112:115], a[156:159], v[100:103]
    buffer_load_dwordx4 a[132:135], v12, s[8:11], s62 offen offset:1024
    ds_read_b64_tr_b16 a[46:47], v27 offset:45056
    v_mfma_f32_16x16x32_bf16 v[104:107], a[116:119], a[152:155], v[104:107]
    ds_read_b64_tr_b16 a[48:49], v28 offset:40960
    v_mfma_f32_16x16x32_bf16 v[108:111], a[116:119], a[156:159], v[108:111]
    ds_read_b64_tr_b16 a[50:51], v28 offset:45056
    ds_read_b64_tr_b16 a[52:53], v29 offset:40960
    v_mfma_f32_16x16x32_bf16 v[112:115], a[120:123], a[152:155], v[112:115]
    ds_read_b64_tr_b16 a[54:55], v29 offset:45056
    v_mfma_f32_16x16x32_bf16 v[116:119], a[120:123], a[156:159], v[116:119]
    buffer_load_dwordx4 a[136:139], v13, s[8:11], s62 offen offset:0
    ds_read_b64_tr_b16 a[56:57], v30 offset:40960
    v_mfma_f32_16x16x32_bf16 v[120:123], a[124:127], a[152:155], v[120:123]
    ds_read_b64_tr_b16 a[58:59], v30 offset:45056
    ds_read_b64_tr_b16 a[60:61], v31 offset:40960
    v_mfma_f32_16x16x32_bf16 v[124:127], a[124:127], a[156:159], v[124:127]
    ds_read_b64_tr_b16 a[62:63], v31 offset:45056
    v_mfma_f32_16x16x32_bf16 v[64:67], a[96:99], a[152:155], v[64:67]
    buffer_load_dwordx4 a[140:143], v13, s[8:11], s62 offen offset:1024
    v_mfma_f32_16x16x32_bf16 v[68:71], a[96:99], a[156:159], v[68:71]
    v_mfma_f32_16x16x32_bf16 v[72:75], a[100:103], a[152:155], v[72:75]
    v_mfma_f32_16x16x32_bf16 v[76:79], a[100:103], a[156:159], v[76:79]
    v_mfma_f32_16x16x32_bf16 v[80:83], a[104:107], a[152:155], v[80:83]
    v_mfma_f32_16x16x32_bf16 v[84:87], a[104:107], a[156:159], v[84:87]
    s_add_u32 s62, s62, 0x40000
    v_mfma_f32_16x16x32_bf16 v[88:91], a[108:111], a[152:155], v[88:91]
    v_mfma_f32_16x16x32_bf16 v[92:95], a[108:111], a[156:159], v[92:95]
    s_waitcnt vmcnt(12) lgkmcnt(0)
    s_barrier
    v_mfma_f32_16x16x32_bf16 v[96:99], a[16:19], a[160:163], v[96:99]
    s_add_u32 m0, s60, 16384
    ds_read_b64_tr_b16 a[64:65], v24 offset:49152
    ds_read_b64_tr_b16 a[66:67], v24 offset:53248
    v_mfma_f32_16x16x32_bf16 v[100:103], a[16:19], a[164:167], v[100:103]
    buffer_load_dwordx4 v16, s[12:15], s61 offen offset:0 lds
    ds_read_b64_tr_b16 a[68:69], v25 offset:49152
    v_mfma_f32_16x16x32_bf16 v[104:107], a[20:23], a[160:163], v[104:107]
    ds_read_b64_tr_b16 a[70:71], v25 offset:53248
    ds_read_b64_tr_b16 a[72:73], v26 offset:49152
    v_mfma_f32_16x16x32_bf16 v[108:111], a[20:23], a[164:167], v[108:111]
    buffer_load_dwordx4 v17, s[12:15], s61 offen offset:1024 lds
    ds_read_b64_tr_b16 a[74:75], v26 offset:53248
    v_mfma_f32_16x16x32_bf16 v[112:115], a[24:27], a[160:163], v[112:115]
    ds_read_b64_tr_b16 a[76:77], v27 offset:49152
    ds_read_b64_tr_b16 a[78:79], v27 offset:53248
    v_mfma_f32_16x16x32_bf16 v[116:119], a[24:27], a[164:167], v[116:119]
    ds_read_b64_tr_b16 a[80:81], v28 offset:49152
    v_mfma_f32_16x16x32_bf16 v[120:123], a[28:31], a[160:163], v[120:123]
    ds_read_b64_tr_b16 a[82:83], v28 offset:53248
    v_mfma_f32_16x16x32_bf16 v[124:127], a[28:31], a[164:167], v[124:127]
    buffer_load_dwordx4 v18, s[12:15], s61 offen offset:2048 lds
    ds_read_b64_tr_b16 a[84:85], v29 offset:49152
    v_mfma_f32_16x16x32_bf16 v[64:67], a[0:3], a[160:163], v[64:67]
    ds_read_b64_tr_b16 a[86:87], v29 offset:53248
    ds_read_b64_tr_b16 a[88:89], v30 offset:49152
    v_mfma_f32_16x16x32_bf16 v[68:71], a[0:3], a[164:167], v[68:71]
    ds_read_b64_tr_b16 a[90:91], v30 offset:53248
    v_mfma_f32_16x16x32_bf16 v[72:75], a[4:7], a[160:163], v[72:75]
    buffer_load_dwordx4 v19, s[12:15], s61 offen offset:3072 lds
    ds_read_b64_tr_b16 a[92:93], v31 offset:49152
    v_mfma_f32_16x16x32_bf16 v[76:79], a[4:7], a[164:167], v[76:79]
    ds_read_b64_tr_b16 a[94:95], v31 offset:53248
    ds_read_b64_tr_b16 a[96:97], v24 offset:57344
    v_mfma_f32_16x16x32_bf16 v[80:83], a[8:11], a[160:163], v[80:83]
    ds_read_b64_tr_b16 a[98:99], v24 offset:61440
    v_mfma_f32_16x16x32_bf16 v[84:87], a[8:11], a[164:167], v[84:87]
    ds_read_b64_tr_b16 a[100:101], v25 offset:57344
    v_mfma_f32_16x16x32_bf16 v[88:91], a[12:15], a[160:163], v[88:91]
    buffer_load_dwordx4 a[144:147], v12, s[8:11], s62 offen offset:0
    ds_read_b64_tr_b16 a[102:103], v25 offset:61440
    v_mfma_f32_16x16x32_bf16 v[92:95], a[12:15], a[164:167], v[92:95]
    s_add_u32 s61, s61, 0x20000
    ds_read_b64_tr_b16 a[104:105], v26 offset:57344
    ds_read_b64_tr_b16 a[106:107], v26 offset:61440
    v_mfma_f32_16x16x32_bf16 v[96:99], a[48:51], a[168:171], v[96:99]
    ds_read_b64_tr_b16 a[108:109], v27 offset:57344
    v_mfma_f32_16x16x32_bf16 v[100:103], a[48:51], a[172:175], v[100:103]
    buffer_load_dwordx4 a[148:151], v12, s[8:11], s62 offen offset:1024
    ds_read_b64_tr_b16 a[110:111], v27 offset:61440
    v_mfma_f32_16x16x32_bf16 v[104:107], a[52:55], a[168:171], v[104:107]
    ds_read_b64_tr_b16 a[112:113], v28 offset:57344
    v_mfma_f32_16x16x32_bf16 v[108:111], a[52:55], a[172:175], v[108:111]
    ds_read_b64_tr_b16 a[114:115], v28 offset:61440
    ds_read_b64_tr_b16 a[116:117], v29 offset:57344
    v_mfma_f32_16x16x32_bf16 v[112:115], a[56:59], a[168:171], v[112:115]
    ds_read_b64_tr_b16 a[118:119], v29 offset:61440
    v_mfma_f32_16x16x32_bf16 v[116:119], a[56:59], a[172:175], v[116:119]
    buffer_load_dwordx4 a[152:155], v13, s[8:11], s62 offen offset:0
    ds_read_b64_tr_b16 a[120:121], v30 offset:57344
    v_mfma_f32_16x16x32_bf16 v[120:123], a[60:63], a[168:171], v[120:123]
    ds_read_b64_tr_b16 a[122:123], v30 offset:61440
    ds_read_b64_tr_b16 a[124:125], v31 offset:57344
    v_mfma_f32_16x16x32_bf16 v[124:127], a[60:63], a[172:175], v[124:127]
    ds_read_b64_tr_b16 a[126:127], v31 offset:61440
    v_mfma_f32_16x16x32_bf16 v[64:67], a[32:35], a[168:171], v[64:67]
    buffer_load_dwordx4 a[156:159], v13, s[8:11], s62 offen offset:1024
    v_mfma_f32_16x16x32_bf16 v[68:71], a[32:35], a[172:175], v[68:71]
    v_mfma_f32_16x16x32_bf16 v[72:75], a[36:39], a[168:171], v[72:75]
    v_mfma_f32_16x16x32_bf16 v[76:79], a[36:39], a[172:175], v[76:79]
    v_mfma_f32_16x16x32_bf16 v[80:83], a[40:43], a[168:171], v[80:83]
    v_mfma_f32_16x16x32_bf16 v[84:87], a[40:43], a[172:175], v[84:87]
    s_add_u32 s62, s62, 0x40000
    v_mfma_f32_16x16x32_bf16 v[88:91], a[44:47], a[168:171], v[88:91]
    v_mfma_f32_16x16x32_bf16 v[92:95], a[44:47], a[172:175], v[92:95]
    s_waitcnt vmcnt(12) lgkmcnt(0)
    s_barrier
    v_mfma_f32_16x16x32_bf16 v[96:99], a[80:83], a[176:179], v[96:99]
    s_add_u32 m0, s60, 32768
    ds_read_b64_tr_b16 a[0:1], v24 offset:0
    ds_read_b64_tr_b16 a[2:3], v24 offset:4096
    v_mfma_f32_16x16x32_bf16 v[100:103], a[80:83], a[180:183], v[100:103]
    buffer_load_dwordx4 v16, s[12:15], s61 offen offset:0 lds
    ds_read_b64_tr_b16 a[4:5], v25 offset:0
    v_mfma_f32_16x16x32_bf16 v[104:107], a[84:87], a[176:179], v[104:107]
    ds_read_b64_tr_b16 a[6:7], v25 offset:4096
    ds_read_b64_tr_b16 a[8:9], v26 offset:0
    v_mfma_f32_16x16x32_bf16 v[108:111], a[84:87], a[180:183], v[108:111]
    buffer_load_dwordx4 v17, s[12:15], s61 offen offset:1024 lds
    ds_read_b64_tr_b16 a[10:11], v26 offset:4096
    v_mfma_f32_16x16x32_bf16 v[112:115], a[88:91], a[176:179], v[112:115]
    ds_read_b64_tr_b16 a[12:13], v27 offset:0
    ds_read_b64_tr_b16 a[14:15], v27 offset:4096
    v_mfma_f32_16x16x32_bf16 v[116:119], a[88:91], a[180:183], v[116:119]
    ds_read_b64_tr_b16 a[16:17], v28 offset:0
    v_mfma_f32_16x16x32_bf16 v[120:123], a[92:95], a[176:179], v[120:123]
    ds_read_b64_tr_b16 a[18:19], v28 offset:4096
    v_mfma_f32_16x16x32_bf16 v[124:127], a[92:95], a[180:183], v[124:127]
    buffer_load_dwordx4 v18, s[12:15], s61 offen offset:2048 lds
    ds_read_b64_tr_b16 a[20:21], v29 offset:0
    v_mfma_f32_16x16x32_bf16 v[64:67], a[64:67], a[176:179], v[64:67]
    ds_read_b64_tr_b16 a[22:23], v29 offset:4096
    ds_read_b64_tr_b16 a[24:25], v30 offset:0
    v_mfma_f32_16x16x32_bf16 v[68:71], a[64:67], a[180:183], v[68:71]
    ds_read_b64_tr_b16 a[26:27], v30 offset:4096
    v_mfma_f32_16x16x32_bf16 v[72:75], a[68:71], a[176:179], v[72:75]
    buffer_load_dwordx4 v19, s[12:15], s61 offen offset:3072 lds
    ds_read_b64_tr_b16 a[28:29], v31 offset:0
    v_mfma_f32_16x16x32_bf16 v[76:79], a[68:71], a[180:183], v[76:79]
    ds_read_b64_tr_b16 a[30:31], v31 offset:4096
    ds_read_b64_tr_b16 a[32:33], v24 offset:8192
    v_mfma_f32_16x16x32_bf16 v[80:83], a[72:75], a[176:179], v[80:83]
    ds_read_b64_tr_b16 a[34:35], v24 offset:12288
    v_mfma_f32_16x16x32_bf16 v[84:87], a[72:75], a[180:183], v[84:87]
    ds_read_b64_tr_b16 a[36:37], v25 offset:8192
    v_mfma_f32_16x16x32_bf16 v[88:91], a[76:79], a[176:179], v[88:91]
    buffer_load_dwordx4 a[160:163], v12, s[8:11], s62 offen offset:0
    ds_read_b64_tr_b16 a[38:39], v25 offset:12288
    v_mfma_f32_16x16x32_bf16 v[92:95], a[76:79], a[180:183], v[92:95]
    s_add_u32 s61, s61, 0x20000
    ds_read_b64_tr_b16 a[40:41], v26 offset:8192
    ds_read_b64_tr_b16 a[42:43], v26 offset:12288
    v_mfma_f32_16x16x32_bf16 v[96:99], a[112:115], a[184:187], v[96:99]
    ds_read_b64_tr_b16 a[44:45], v27 offset:8192
    v_mfma_f32_16x16x32_bf16 v[100:103], a[112:115], a[188:191], v[100:103]
    buffer_load_dwordx4 a[164:167], v12, s[8:11], s62 offen offset:1024
    ds_read_b64_tr_b16 a[46:47], v27 offset:12288
    v_mfma_f32_16x16x32_bf16 v[104:107], a[116:119], a[184:187], v[104:107]
    ds_read_b64_tr_b16 a[48:49], v28 offset:8192
    v_mfma_f32_16x16x32_bf16 v[108:111], a[116:119], a[188:191], v[108:111]
    ds_read_b64_tr_b16 a[50:51], v28 offset:12288
    ds_read_b64_tr_b16 a[52:53], v29 offset:8192
    v_mfma_f32_16x16x32_bf16 v[112:115], a[120:123], a[184:187], v[112:115]
    ds_read_b64_tr_b16 a[54:55], v29 offset:12288
    v_mfma_f32_16x16x32_bf16 v[116:119], a[120:123], a[188:191], v[116:119]
    buffer_load_dwordx4 a[168:171], v13, s[8:11], s62 offen offset:0
    ds_read_b64_tr_b16 a[56:57], v30 offset:8192
    v_mfma_f32_16x16x32_bf16 v[120:123], a[124:127], a[184:187], v[120:123]
    ds_read_b64_tr_b16 a[58:59], v30 offset:12288
    ds_read_b64_tr_b16 a[60:61], v31 offset:8192
    v_mfma_f32_16x16x32_bf16 v[124:127], a[124:127], a[188:191], v[124:127]
    ds_read_b64_tr_b16 a[62:63], v31 offset:12288
    v_mfma_f32_16x16x32_bf16 v[64:67], a[96:99], a[184:187], v[64:67]
    buffer_load_dwordx4 a[172:175], v13, s[8:11], s62 offen offset:1024
    v_mfma_f32_16x16x32_bf16 v[68:71], a[96:99], a[188:191], v[68:71]
    v_mfma_f32_16x16x32_bf16 v[72:75], a[100:103], a[184:187], v[72:75]
    v_mfma_f32_16x16x32_bf16 v[76:79], a[100:103], a[188:191], v[76:79]
    v_mfma_f32_16x16x32_bf16 v[80:83], a[104:107], a[184:187], v[80:83]
    v_mfma_f32_16x16x32_bf16 v[84:87], a[104:107], a[188:191], v[84:87]
    s_add_u32 s62, s62, 0x40000
    v_mfma_f32_16x16x32_bf16 v[88:91], a[108:111], a[184:187], v[88:91]
    s_add_u32 s63, s63, 1
    v_mfma_f32_16x16x32_bf16 v[92:95], a[108:111], a[188:191], v[92:95]
    s_waitcnt vmcnt(12) lgkmcnt(0)
    s_barrier
    s_cmp_lt_u32 s63, 8
    s_cbranch_scc1 k3_loop_114
k3_tail:
    s_nop 1
    v_cvt_pk_bf16_f32 v96, v96, v97
    v_cvt_pk_bf16_f32 v97, v98, v99
    v_cvt_pk_bf16_f32 v98, v100, v101
    v_cvt_pk_bf16_f32 v99, v102, v103
    buffer_store_dwordx4 v[96:99], v1, s[36:39], s52 offen offset:0 sc1
    v_cvt_pk_bf16_f32 v104, v104, v105
    v_cvt_pk_bf16_f32 v105, v106, v107
    v_cvt_pk_bf16_f32 v106, v108, v109
    v_cvt_pk_bf16_f32 v107, v110, v111
    buffer_store_dwordx4 v[104:107], v1, s[36:39], s52 offen offset:1024 sc1
    v_cvt_pk_bf16_f32 v112, v112, v113
    v_cvt_pk_bf16_f32 v113, v114, v115
    v_cvt_pk_bf16_f32 v114, v116, v117
    v_cvt_pk_bf16_f32 v115, v118, v119
    buffer_store_dwordx4 v[112:115], v1, s[36:39], s52 offen offset:2048 sc1
    v_cvt_pk_bf16_f32 v120, v120, v121
    v_cvt_pk_bf16_f32 v121, v122, v123
    v_cvt_pk_bf16_f32 v122, v124, v125
    v_cvt_pk_bf16_f32 v123, v126, v127
    buffer_store_dwordx4 v[120:123], v1, s[36:39], s52 offen offset:3072 sc1
    s_waitcnt vmcnt(4)
    v_lshlrev_b32 v58, 16, v128
    v_and_b32 v59, 0xffff0000, v128
    v_pk_add_f32 v[64:65], v[64:65], v[58:59]
    v_lshlrev_b32 v58, 16, v129
    v_and_b32 v59, 0xffff0000, v129
    v_pk_add_f32 v[66:67], v[66:67], v[58:59]
    v_lshlrev_b32 v58, 16, v136
    v_and_b32 v59, 0xffff0000, v136
    v_pk_add_f32 v[68:69], v[68:69], v[58:59]
    v_lshlrev_b32 v58, 16, v137
    v_and_b32 v59, 0xffff0000, v137
    v_pk_add_f32 v[70:71], v[70:71], v[58:59]
    v_lshlrev_b32 v58, 16, v130
    v_and_b32 v59, 0xffff0000, v130
    v_pk_add_f32 v[72:73], v[72:73], v[58:59]
    v_lshlrev_b32 v58, 16, v131
    v_and_b32 v59, 0xffff0000, v131
    v_pk_add_f32 v[74:75], v[74:75], v[58:59]
    v_lshlrev_b32 v58, 16, v138
    v_and_b32 v59, 0xffff0000, v138
    v_pk_add_f32 v[76:77], v[76:77], v[58:59]
    v_lshlrev_b32 v58, 16, v139
    v_and_b32 v59, 0xffff0000, v139
    v_pk_add_f32 v[78:79], v[78:79], v[58:59]
    v_lshlrev_b32 v58, 16, v132
    v_and_b32 v59, 0xffff0000, v132
    v_pk_add_f32 v[80:81], v[80:81], v[58:59]
    v_lshlrev_b32 v58, 16, v133
    v_and_b32 v59, 0xffff0000, v133
    v_pk_add_f32 v[82:83], v[82:83], v[58:59]
    v_lshlrev_b32 v58, 16, v140
    v_and_b32 v59, 0xffff0000, v140
    v_pk_add_f32 v[84:85], v[84:85], v[58:59]
    v_lshlrev_b32 v58, 16, v141
    v_and_b32 v59, 0xffff0000, v141
    v_pk_add_f32 v[86:87], v[86:87], v[58:59]
    v_lshlrev_b32 v58, 16, v134
    v_and_b32 v59, 0xffff0000, v134
    v_pk_add_f32 v[88:89], v[88:89], v[58:59]
    v_lshlrev_b32 v58, 16, v135
    v_and_b32 v59, 0xffff0000, v135
    v_pk_add_f32 v[90:91], v[90:91], v[58:59]
    v_lshlrev_b32 v58, 16, v142
    v_and_b32 v59, 0xffff0000, v142
    v_pk_add_f32 v[92:93], v[92:93], v[58:59]
    v_lshlrev_b32 v58, 16, v143
    v_and_b32 v59, 0xffff0000, v143
    v_pk_add_f32 v[94:95], v[94:95], v[58:59]
    v_and_b32 v58, 1, v20
    v_lshrrev_b32 v59, 1, v20
    v_lshlrev_b32 v58, 5, v58
    v_lshl_add_u32 v58, v59, 4, v58
    v_lshlrev_b32 v59, 3, v20
    v_sub_u32 v58, v58, v59
    v_add_u32 v3, v3, v58
    v_add_u32 v4, v4, v58
    v_lshlrev_b32 v32, 16, v144
    v_and_b32 v33, 0xffff0000, v144
    v_lshlrev_b32 v34, 16, v145
    v_and_b32 v35, 0xffff0000, v145
    v_lshlrev_b32 v36, 16, v146
    v_and_b32 v37, 0xffff0000, v146
    v_lshlrev_b32 v38, 16, v147
    v_and_b32 v39, 0xffff0000, v147
    v_lshlrev_b32 v40, 16, v148
    v_and_b32 v41, 0xffff0000, v148
    v_lshlrev_b32 v42, 16, v149
    v_and_b32 v43, 0xffff0000, v149
    v_lshlrev_b32 v44, 16, v150
    v_and_b32 v45, 0xffff0000, v150
    v_lshlrev_b32 v46, 16, v151
    v_and_b32 v47, 0xffff0000, v151
    s_or_b32 s57, s42, s45
    s_cbranch_scc1 k3_nowr_117
    v_pk_add_f32 v[56:57], v[32:33], v[34:35]
    v_pk_add_f32 v[56:57], v[56:57], v[36:37]
    v_pk_add_f32 v[56:57], v[56:57], v[38:39]
    v_pk_add_f32 v[56:57], v[56:57], v[40:41]
    v_pk_add_f32 v[56:57], v[56:57], v[42:43]
    v_pk_add_f32 v[56:57], v[56:57], v[44:45]
    v_pk_add_f32 v[56:57], v[56:57], v[46:47]
    v_add_f32 v56, v56, v57
    v_mov_b32 v57, v56
    s_nop 1
    v_permlane16_swap_b32 v56, v57
    s_nop 1
    v_add_f32 v56, v56, v57
    v_mov_b32 v57, v56
    s_nop 1
    v_permlane32_swap_b32 v56, v57
    s_nop 1
    v_add_f32 v56, v56, v57
    s_mov_b32 s57, 24704
    s_mov_b32 s34, 24708
    s_mov_b64 exec, 1
    buffer_atomic_add_f32 v56, v5, s[32:35], s57 offen
    s_mov_b64 exec, -1
    s_mov_b32 s34, 24576
k3_nowr_117:
    v_mov_b32 v144, 0
    v_mov_b32 v145, 0
    v_mov_b32 v146, 0
    v_mov_b32 v147, 0
    v_mov_b32 v148, 0
    v_mov_b32 v149, 0
    v_mov_b32 v150, 0
    v_mov_b32 v151, 0
    v_mov_b32 v152, 0
    v_mov_b32 v153, 0
    v_mov_b32 v154, 0
    v_mov_b32 v155, 0
    s_waitcnt vmcnt(0)
    s_barrier
    s_cmp_lg_u32 s45, 0
    s_cbranch_scc1 k3_nopoll_118
    s_mov_b64 exec, 1
    buffer_store_dword v6, v5, s[48:51], s54 offen sc1
    s_mov_b64 exec, -1
    s_mov_b32 s57, 1048576
k3_spin_119:
    buffer_load_dword v7, v5, s[48:51], s55 offen sc1
    s_waitcnt vmcnt(0)
    v_readfirstlane_b32 s58, v7
    s_sub_u32 s57, s57, 1
    s_cselect_b32 s58, 1, s58
    s_cmp_eq_u32 s58, 0
    s_cbranch_scc1 k3_spin_119
k3_nopoll_118:
    s_barrier
    buffer_load_dwordx4 v[96:99], v1, s[36:39], s53 offen offset:0 sc1
    buffer_load_dwordx4 v[100:103], v1, s[36:39], s53 offen offset:1024 sc1
    buffer_load_dwordx4 v[104:107], v1, s[36:39], s53 offen offset:2048 sc1
    buffer_load_dwordx4 v[108:111], v1, s[36:39], s53 offen offset:3072 sc1
    s_waitcnt vmcnt(3)
    v_lshlrev_b32 v56, 16, v96
    v_and_b32 v57, 0xffff0000, v96
    v_lshlrev_b32 v58, 16, v97
    v_and_b32 v59, 0xffff0000, v97
    v_pk_add_f32 v[64:65], v[64:65], v[56:57]
    v_pk_add_f32 v[66:67], v[66:67], v[58:59]
    v_cvt_pk_bf16_f32 v128, v64, v65
    v_cvt_pk_bf16_f32 v129, v66, v67
    v_lshlrev_b32 v64, 16, v128
    v_and_b32 v65, 0xffff0000, v128
    v_lshlrev_b32 v66, 16, v129
    v_and_b32 v67, 0xffff0000, v129
    v_pk_add_f32 v[144:145], v[144:145], v[64:65]
    v_pk_fma_f32 v[146:147], v[64:65], v[64:65], v[146:147]
    v_pk_fma_f32 v[148:149], v[64:65], v[32:33], v[148:149]
    v_pk_add_f32 v[144:145], v[144:145], v[66:67]
    v_pk_fma_f32 v[146:147], v[66:67], v[66:67], v[146:147]
    v_pk_fma_f32 v[148:149], v[66:67], v[34:35], v[148:149]
    v_lshlrev_b32 v56, 16, v98
    v_and_b32 v57, 0xffff0000, v98
    v_lshlrev_b32 v58, 16, v99
    v_and_b32 v59, 0xffff0000, v99
    v_pk_add_f32 v[68:69], v[68:69], v[56:57]
    v_pk_add_f32 v[70:71], v[70:71], v[58:59]
    v_cvt_pk_bf16_f32 v136, v68, v69
    v_cvt_pk_bf16_f32 v137, v70, v71
    v_lshlrev_b32 v68, 16, v136
    v_and_b32 v69, 0xffff0000, v136
    v_lshlrev_b32 v70, 16, v137
    v_and_b32 v71, 0xffff0000, v137
    v_pk_add_f32 v[150:151], v[150:151], v[68:69]
    v_pk_fma_f32 v[152:153], v[68:69], v[68:69], v[152:153]
    v_pk_fma_f32 v[154:155], v[68:69], v[32:33], v[154:155]
    v_pk_add_f32 v[150:151], v[150:151], v[70:71]
    v_pk_fma_f32 v[152:153], v[70:71], v[70:71], v[152:153]
    v_pk_fma_f32 v[154:155], v[70:71], v[34:35], v[154:155]
    s_waitcnt vmcnt(2)
    v_lshlrev_b32 v56, 16, v100
    v_and_b32 v57, 0xffff0000, v100
    v_lshlrev_b32 v58, 16, v101
    v_and_b32 v59, 0xffff0000, v101
    v_pk_add_f32 v[72:73], v[72:73], v[56:57]
    v_pk_add_f32 v[74:75], v[74:75], v[58:59]
    v_cvt_pk_bf16_f32 v130, v72, v73
    v_cvt_pk_bf16_f32 v131, v74, v75
    v_lshlrev_b32 v72, 16, v130
    v_and_b32 v73, 0xffff0000, v130
    v_lshlrev_b32 v74, 16, v131
    v_and_b32 v75, 0xffff0000, v131
    v_permlane16_swap_b32 v128, v130
    v_permlane16_swap_b32 v129, v131
    buffer_store_dwordx4 v[128:131], v3, s[24:27], 0 offen offset:0 sc1
    v_pk_add_f32 v[144:145], v[144:145], v[72:73]
    v_pk_fma_f32 v[146:147], v[72:73], v[72:73], v[146:147]
    v_pk_fma_f32 v[148:149], v[72:73], v[36:37], v[148:149]
    v_pk_add_f32 v[144:145], v[144:145], v[74:75]
    v_pk_fma_f32 v[146:147], v[74:75], v[74:75], v[146:147]
    v_pk_fma_f32 v[148:149], v[74:75], v[38:39], v[148:149]
    v_lshlrev_b32 v56, 16, v102
    v_and_b32 v57, 0xffff0000, v102
    v_lshlrev_b32 v58, 16, v103
    v_and_b32 v59, 0xffff0000, v103
    v_pk_add_f32 v[76:77], v[76:77], v[56:57]
    v_pk_add_f32 v[78:79], v[78:79], v[58:59]
    v_cvt_pk_bf16_f32 v138, v76, v77
    v_cvt_pk_bf16_f32 v139, v78, v79
    v_lshlrev_b32 v76, 16, v138
    v_and_b32 v77, 0xffff0000, v138
    v_lshlrev_b32 v78, 16, v139
    v_and_b32 v79, 0xffff0000, v139
    v_permlane16_swap_b32 v136, v138
    v_permlane16_swap_b32 v137, v139
    buffer_store_dwordx4 v[136:139], v4, s[24:27], 0 offen offset:0 sc1
    v_pk_add_f32 v[150:151], v[150:151], v[76:77]
    v_pk_fma_f32 v[152:153], v[76:77], v[76:77], v[152:153]
    v_pk_fma_f32 v[154:155], v[76:77], v[36:37], v[154:155]
    v_pk_add_f32 v[150:151], v[150:151], v[78:79]
    v_pk_fma_f32 v[152:153], v[78:79], v[78:79], v[152:153]
    v_pk_fma_f32 v[154:155], v[78:79], v[38:39], v[154:155]
    s_waitcnt vmcnt(3)
    v_lshlrev_b32 v56, 16, v104
    v_and_b32 v57, 0xffff0000, v104
    v_lshlrev_b32 v58, 16, v105
    v_and_b32 v59, 0xffff0000, v105
    v_pk_add_f32 v[80:81], v[80:81], v[56:57]
    v_pk_add_f32 v[82:83], v[82:83], v[58:59]
    v_cvt_pk_bf16_f32 v132, v80, v81
    v_cvt_pk_bf16_f32 v133, v82, v83
    v_lshlrev_b32 v80, 16, v132
    v_and_b32 v81, 0xffff0000, v132
    v_lshlrev_b32 v82, 16, v133
    v_and_b32 v83, 0xffff0000, v133
    v_pk_add_f32 v[144:145], v[144:145], v[80:81]
    v_pk_fma_f32 v[146:147], v[80:81], v[80:81], v[146:147]
    v_pk_fma_f32 v[148:149], v[80:81], v[40:41], v[148:149]
    v_pk_add_f32 v[144:145], v[144:145], v[82:83]
    v_pk_fma_f32 v[146:147], v[82:83], v[82:83], v[146:147]
    v_pk_fma_f32 v[148:149], v[82:83], v[42:43], v[148:149]
    v_lshlrev_b32 v56, 16, v106
    v_and_b32 v57, 0xffff0000, v106
    v_lshlrev_b32 v58, 16, v107
    v_and_b32 v59, 0xffff0000, v107
    v_pk_add_f32 v[84:85], v[84:85], v[56:57]
    v_pk_add_f32 v[86:87], v[86:87], v[58:59]
    v_cvt_pk_bf16_f32 v140, v84, v85
    v_cvt_pk_bf16_f32 v141, v86, v87
    v_lshlrev_b32 v84, 16, v140
    v_and_b32 v85, 0xffff0000, v140
    v_lshlrev_b32 v86, 16, v141
    v_and_b32 v87, 0xffff0000, v141
    v_pk_add_f32 v[150:151], v[150:151], v[84:85]
    v_pk_fma_f32 v[152:153], v[84:85], v[84:85], v[152:153]
    v_pk_fma_f32 v[154:155], v[84:85], v[40:41], v[154:155]
    v_pk_add_f32 v[150:151], v[150:151], v[86:87]
    v_pk_fma_f32 v[152:153], v[86:87], v[86:87], v[152:153]
    v_pk_fma_f32 v[154:155], v[86:87], v[42:43], v[154:155]
    s_waitcnt vmcnt(2)
    v_lshlrev_b32 v56, 16, v108
    v_and_b32 v57, 0xffff0000, v108
    v_lshlrev_b32 v58, 16, v109
    v_and_b32 v59, 0xffff0000, v109
    v_pk_add_f32 v[88:89], v[88:89], v[56:57]
    v_pk_add_f32 v[90:91], v[90:91], v[58:59]
    v_cvt_pk_bf16_f32 v134, v88, v89
    v_cvt_pk_bf16_f32 v135, v90, v91
    v_lshlrev_b32 v88, 16, v134
    v_and_b32 v89, 0xffff0000, v134
    v_lshlrev_b32 v90, 16, v135
    v_and_b32 v91, 0xffff0000, v135
    v_permlane16_swap_b32 v132, v134
    v_permlane16_swap_b32 v133, v135
    buffer_store_dwordx4 v[132:135], v3, s[24:27], 0 offen offset:64 sc1
    v_pk_add_f32 v[144:145], v[144:145], v[88:89]
    v_pk_fma_f32 v[146:147], v[88:89], v[88:89], v[146:147]
    v_pk_fma_f32 v[148:149], v[88:89], v[44:45], v[148:149]
    v_pk_add_f32 v[144:145], v[144:145], v[90:91]
    v_pk_fma_f32 v[146:147], v[90:91], v[90:91], v[146:147]
    v_pk_fma_f32 v[148:149], v[90:91], v[46:47], v[148:149]
    v_lshlrev_b32 v56, 16, v110
    v_and_b32 v57, 0xffff0000, v110
    v_lshlrev_b32 v58, 16, v111
    v_and_b32 v59, 0xffff0000, v111
    v_pk_add_f32 v[92:93], v[92:93], v[56:57]
    v_pk_add_f32 v[94:95], v[94:95], v[58:59]
    v_cvt_pk_bf16_f32 v142, v92, v93
    v_cvt_pk_bf16_f32 v143, v94, v95
    v_lshlrev_b32 v92, 16, v142
    v_and_b32 v93, 0xffff0000, v142
    v_lshlrev_b32 v94, 16, v143
    v_and_b32 v95, 0xffff0000, v143
    v_permlane16_swap_b32 v140, v142
    v_permlane16_swap_b32 v141, v143
    buffer_store_dwordx4 v[140:143], v4, s[24:27], 0 offen offset:64 sc1
    v_pk_add_f32 v[150:151], v[150:151], v[92:93]
    v_pk_fma_f32 v[152:153], v[92:93], v[92:93], v[152:153]
    v_pk_fma_f32 v[154:155], v[92:93], v[44:45], v[154:155]
    v_pk_add_f32 v[150:151], v[150:151], v[94:95]
    v_pk_fma_f32 v[152:153], v[94:95], v[94:95], v[152:153]
    v_pk_fma_f32 v[154:155], v[94:95], v[46:47], v[154:155]
    v_add_f32 v48, v144, v145
    v_add_f32 v49, v146, v147
    v_add_f32 v50, v148, v149
    v_add_f32 v52, v150, v151
    v_add_f32 v53, v152, v153
    v_add_f32 v54, v154, v155
    v_mov_b32 v56, v48
    v_mov_b32 v57, v49
    v_mov_b32 v58, v50
    v_mov_b32 v59, v52
    v_mov_b32 v60, v53
    v_mov_b32 v61, v54
    s_nop 1
    v_permlane16_swap_b32 v48, v56
    v_permlane16_swap_b32 v49, v57
    v_permlane16_swap_b32 v50, v58
    v_permlane16_swap_b32 v52, v59
    v_permlane16_swap_b32 v53, v60
    v_permlane16_swap_b32 v54, v61
    s_nop 1
    v_add_f32 v48, v48, v56
    v_add_f32 v49, v49, v57
    v_add_f32 v50, v50, v58
    v_add_f32 v52, v52, v59
    v_add_f32 v53, v53, v60
    v_add_f32 v54, v54, v61
    v_mov_b32 v56, v48
    v_mov_b32 v57, v49
    v_mov_b32 v58, v50
    v_mov_b32 v59, v52
    v_mov_b32 v60, v53
    v_mov_b32 v61, v54
    s_nop 1
    v_permlane32_swap_b32 v48, v56
    v_permlane32_swap_b32 v49, v57
    v_permlane32_swap_b32 v50, v58
    v_permlane32_swap_b32 v52, v59
    v_permlane32_swap_b32 v53, v60
    v_permlane32_swap_b32 v54, v61
    s_nop 1
    v_add_f32 v48, v48, v56
    v_add_f32 v49, v49, v57
    v_add_f32 v50, v50, v58
    v_add_f32 v52, v52, v59
    v_add_f32 v53, v53, v60
    v_add_f32 v54, v54, v61
    v_cmp_eq_u32 s[56:57], 1, v20
    v_cmp_eq_u32 s[58:59], 2, v20
    s_nop 1
    v_cndmask_b32 v48, v48, v49, s[56:57]
    v_cndmask_b32 v48, v48, v50, s[58:59]
    buffer_atomic_add_f32 v48, v2, s[32:35], 0 offen offset:0
    v_cndmask_b32 v52, v52, v53, s[56:57]
    v_cndmask_b32 v52, v52, v54, s[58:59]
    buffer_atomic_add_f32 v52, v2, s[32:35], 0 offen offset:64
k3_end_112:
    s_endpgm
k3_ool_115:
    buffer_load_dwordx2 v[128:129], v3, s[16:19], 0 offen offset:0
    buffer_load_dwordx2 v[130:131], v3, s[16:19], 0 offen offset:32
    buffer_load_dwordx2 v[132:133], v3, s[16:19], 0 offen offset:64
    buffer_load_dwordx2 v[134:135], v3, s[16:19], 0 offen offset:96
    buffer_load_dwordx2 v[136:137], v4, s[16:19], 0 offen offset:0
    buffer_load_dwordx2 v[138:139], v4, s[16:19], 0 offen offset:32
    buffer_load_dwordx2 v[140:141], v4, s[16:19], 0 offen offset:64
    buffer_load_dwordx2 v[142:143], v4, s[16:19], 0 offen offset:96
    buffer_load_dwordx2 v[144:145], v14, s[20:23], 0 offen offset:0
    buffer_load_dwordx2 v[146:147], v14, s[20:23], 0 offen offset:32
    buffer_load_dwordx2 v[148:149], v14, s[20:23], 0 offen offset:64
    buffer_load_dwordx2 v[150:151], v14, s[20:23], 0 offen offset:96
    global_load_dword v7, v[8:9], off
    s_branch k3_oolret_116
.globl k4_kernel
.p2align 8
.type k4_kernel,@function
k4_kernel:
    s_cmp_ge_u32 s2, 256
    s_cbranch_scc1 k4_end_120
    s_load_dwordx8 s[4:11], s[0:1], 56
    s_load_dwordx2 s[12:13], s[0:1], 88
    s_load_dwordx2 s[14:15], s[0:1], 104
    v_lshrrev_b32 v1, 6, v0
    v_and_b32 v2, 63, v0
    v_readfirstlane_b32 s44, v1
    s_and_b32 s45, s2, 7
    s_lshr_b32 s46, s2, 3
    s_mul_i32 s45, s45, 28
    s_add_u32 s45, s45, s46
    v_and_b32 v4, 31, v2
    v_lshrrev_b32 v5, 5, v2
    v_lshlrev_b32 v7, 4, v4
    v_mov_b32 v11, 69632
    v_lshl_add_u32 v12, v2, 2, v11
    v_mov_b32 v13, 0
    ds_write_b32 v12, v13
    s_waitcnt lgkmcnt(0)
    s_barrier
    s_add_u32 s20, s14, 0x4000000
    s_addc_u32 s21, s15, 0
    s_and_b32 s21, s21, 0xffff
    s_mov_b32 s22, 0x400000
    s_mov_b32 s23, 0x00020000
    s_cmp_ge_u32 s44, 4
    s_cbranch_scc1 k4_b_121
    s_setprio 3
    s_add_u32 s16, s14, 0x4800000
    s_addc_u32 s17, s15, 0
    s_and_b32 s17, s17, 0xffff
    s_mov_b32 s18, 0x6084
    s_mov_b32 s19, 0x00020000
    v_lshlrev_b32 v3, 5, v0
    s_mov_b32 s48, 0
    buffer_load_dwordx4 v[16:19], v3, s[16:19], s48 offen
    buffer_load_dwordx4 v[20:23], v3, s[16:19], s48 offen offset:16
    s_mov_b32 s48, 8192
    buffer_load_dwordx4 v[24:27], v3, s[16:19], s48 offen
    buffer_load_dwordx4 v[28:31], v3, s[16:19], s48 offen offset:16
    s_mov_b32 s48, 16384
    buffer_load_dwordx4 v[32:35], v3, s[16:19], s48 offen
    buffer_load_dwordx4 v[36:39], v3, s[16:19], s48 offen offset:16
    s_mov_b32 s48, 24704
    buffer_load_dword v10, v13, s[16:19], s48 offen
    s_mov_b32 s32, s10
    s_and_b32 s33, s11, 0xffff
    s_mov_b32 s34, 0x700000
    s_mov_b32 s35, 0x00020000
    s_cmp_ge_u32 s2, 224
    s_cselect_b32 s34, 0, s34
    s_mov_b32 s52, 0x3a800000
    s_mov_b32 s53, 0x3a800000
    s_mov_b32 s54, 0x7ff
    v_mov_b32 v14, 0x3727c5ac
    v_mov_b32 v15, v14
    v_mov_b32 v8, 0xff800000
    v_mov_b32 v9, v8
    s_waitcnt vmcnt(0)
    v_sub_f32 v10, 0, v10
    v_mov_b32 v11, v10
    v_pk_mul_f32 v[16:17], v[16:17], s[52:53]
    v_pk_fma_f32 v[24:25], v[24:25], s[52:53], v[14:15]
    v_pk_fma_f32 v[32:33], v[16:17], v[10:11], v[32:33]
    v_pk_fma_f32 v[24:25], v[16:17], v[16:17], v[24:25] neg_lo:[1,0,0] neg_hi:[1,0,0]
    v_pk_mul_f32 v[18:19], v[18:19], s[52:53]
    v_pk_fma_f32 v[26:27], v[26:27], s[52:53], v[14:15]
    v_pk_fma_f32 v[34:35], v[18:19], v[10:11], v[34:35]
    v_pk_fma_f32 v[26:27], v[18:19], v[18:19], v[26:27] neg_lo:[1,0,0] neg_hi:[1,0,0]
    v_pk_mul_f32 v[20:21], v[20:21], s[52:53]
    v_pk_fma_f32 v[28:29], v[28:29], s[52:53], v[14:15]
    v_pk_fma_f32 v[36:37], v[20:21], v[10:11], v[36:37]
    v_pk_fma_f32 v[28:29], v[20:21], v[20:21], v[28:29] neg_lo:[1,0,0] neg_hi:[1,0,0]
    v_pk_mul_f32 v[22:23], v[22:23], s[52:53]
    v_pk_fma_f32 v[30:31], v[30:31], s[52:53], v[14:15]
    v_pk_fma_f32 v[38:39], v[22:23], v[10:11], v[38:39]
    v_pk_fma_f32 v[30:31], v[22:23], v[22:23], v[30:31] neg_lo:[1,0,0] neg_hi:[1,0,0]
    v_max_f32 v24, v14, v24
    v_max_f32 v25, v14, v25
    v_max_f32 v26, v14, v26
    v_max_f32 v27, v14, v27
    v_max_f32 v28, v14, v28
    v_max_f32 v29, v14, v29
    v_max_f32 v30, v14, v30
    v_max_f32 v31, v14, v31
    v_rsq_f32 v24, v24
    v_rsq_f32 v25, v25
    v_rsq_f32 v26, v26
    v_rsq_f32 v27, v27
    v_rsq_f32 v28, v28
    v_rsq_f32 v29, v29
    v_rsq_f32 v30, v30
    v_rsq_f32 v31, v31
    v_pk_mul_f32 v[32:33], v[32:33], v[24:25]
    v_pk_mul_f32 v[34:35], v[34:35], v[26:27]
    v_pk_mul_f32 v[36:37], v[36:37], v[28:29]
    v_pk_mul_f32 v[38:39], v[38:39], v[30:31]
    v_bfi_b32 v32, s54, 0, v32
    v_med3_f32 v9, v8, v9, v32
    v_max_f32 v8, v8, v32
    v_bfi_b32 v33, s54, 1, v33
    v_med3_f32 v9, v8, v9, v33
    v_max_f32 v8, v8, v33
    v_bfi_b32 v34, s54, 2, v34
    v_med3_f32 v9, v8, v9, v34
    v_max_f32 v8, v8, v34
    v_bfi_b32 v35, s54, 3, v35
    v_med3_f32 v9, v8, v9, v35
    v_max_f32 v8, v8, v35
    v_bfi_b32 v36, s54, 4, v36
    v_med3_f32 v9, v8, v9, v36
    v_max_f32 v8, v8, v36
    v_bfi_b32 v37, s54, 5, v37
    v_med3_f32 v9, v8, v9, v37
    v_max_f32 v8, v8, v37
    v_bfi_b32 v38, s54, 6, v38
    v_med3_f32 v9, v8, v9, v38
    v_max_f32 v8, v8, v38
    v_bfi_b32 v39, s54, 7, v39
    v_med3_f32 v9, v8, v9, v39
    v_max_f32 v8, v8, v39
    v_lshl_or_b32 v8, v0, 3, v8
    v_lshl_or_b32 v9, v0, 3, v9
    s_nop 1
    v_mov_b32_dpp v10, v8 quad_perm:[1,0,3,2] row_mask:0xf bank_mask:0xf
    v_mov_b32_dpp v11, v9 quad_perm:[1,0,3,2] row_mask:0xf bank_mask:0xf
    v_max_f32 v11, v11, v9
    v_med3_f32 v9, v8, v10, v11
    v_max_f32 v8, v8, v10
    s_nop 1
    v_mov_b32_dpp v10, v8 quad_perm:[2,3,0,1] row_mask:0xf bank_mask:0xf
    v_mov_b32_dpp v11, v9 quad_perm:[2,3,0,1] row_mask:0xf bank_mask:0xf
    v_max_f32 v11, v11, v9
    v_med3_f32 v9, v8, v10, v11
    v_max_f32 v8, v8, v10
    s_nop 1
    v_mov_b32_dpp v10, v8 row_half_mirror row_mask:0xf bank_mask:0xf
    v_mov_b32_dpp v11, v9 row_half_mirror row_mask:0xf bank_mask:0xf
    v_max_f32 v11, v11, v9
    v_med3_f32 v9, v8, v10, v11
    v_max_f32 v8, v8, v10
    s_nop 1
    v_mov_b32_dpp v10, v8 row_mirror row_mask:0xf bank_mask:0xf
    v_mov_b32_dpp v11, v9 row_mirror row_mask:0xf bank_mask:0xf
    v_max_f32 v11, v11, v9
    v_med3_f32 v9, v8, v10, v11
    v_max_f32 v8, v8, v10
    v_mov_b32 v10, v8
    v_mov_b32 v11, v9
    s_nop 1
    v_permlane16_swap_b32 v8, v10
    v_permlane16_swap_b32 v9, v11
    s_nop 1
    v_max_f32 v11, v11, v9
    v_med3_f32 v9, v8, v10, v11
    v_max_f32 v8, v8, v10
    v_mov_b32 v10, v8
    v_mov_b32 v11, v9
    s_nop 1
    v_permlane32_swap_b32 v8, v10
    v_permlane32_swap_b32 v9, v11
    s_nop 1
    v_max_f32 v11, v11, v9
    v_med3_f32 v9, v8, v10, v11
    v_max_f32 v8, v8, v10
    v_mov_b32 v10, 1
    v_mov_b32 v11, 1
    v_lshlrev_b32 v12, 4, v1
    v_add_u32 v12, 69632, v12
    ds_write_b128 v12, v[8:11]
    v_mov_b32 v12, 69632
k4_mail_125:
    ds_read_b128 v[16:19], v12 offset:0
    ds_read_b128 v[20:23], v12 offset:16
    ds_read_b128 v[24:27], v12 offset:32
    ds_read_b128 v[28:31], v12 offset:48
    s_waitcnt lgkmcnt(0)
    v_and_b32 v10, v18, v22
    v_and_b32 v11, v26, v30
    v_and_b32 v10, v10, v11
    v_cmp_eq_u32 vcc, 0, v10
    s_cbranch_vccnz k4_mail_125
    v_max_f32 v21, v21, v17
    v_med3_f32 v17, v16, v20, v21
    v_max_f32 v16, v16, v20
    v_max_f32 v29, v29, v25
    v_med3_f32 v25, v24, v28, v29
    v_max_f32 v24, v24, v28
    v_max_f32 v25, v25, v17
    v_med3_f32 v17, v16, v24, v25
    v_max_f32 v16, v16, v24
    v_cmp_eq_u32 vcc, 0, v5
    s_lshl_b32 s52, s45, 15
    v_lshlrev_b32 v9, 3, v0
    v_cndmask_b32 v11, v17, v16, vcc
    v_and_b32 v15, 0x7ff, v11
    v_lshl_add_u32 v11, v15, 11, v7
    buffer_load_dwordx4 v[40:43], v11, s[20:23], 0 offen offset:0
    buffer_load_dwordx4 v[44:47], v11, s[20:23], 0 offen offset:512
    buffer_load_dwordx4 v[48:51], v11, s[20:23], 0 offen offset:1024
    buffer_load_dwordx4 v[52:55], v11, s[20:23], 0 offen offset:1536
    buffer_load_dwordx2 v[88:89], v9, s[32:35], s52 offen offset:0
    buffer_load_dwordx2 v[90:91], v9, s[32:35], s52 offen offset:2048
    s_add_u32 s52, s52, 4096
    buffer_load_dwordx2 v[92:93], v9, s[32:35], s52 offen offset:0
    buffer_load_dwordx2 v[94:95], v9, s[32:35], s52 offen offset:2048
    s_add_u32 s52, s52, 4096
    buffer_load_dwordx2 v[96:97], v9, s[32:35], s52 offen offset:0
    buffer_load_dwordx2 v[98:99], v9, s[32:35], s52 offen offset:2048
    s_add_u32 s52, s52, 4096
    buffer_load_dwordx2 v[100:101], v9, s[32:35], s52 offen offset:0
    buffer_load_dwordx2 v[102:103], v9, s[32:35], s52 offen offset:2048
    s_add_u32 s52, s52, 4096
    buffer_load_dwordx2 v[104:105], v9, s[32:35], s52 offen offset:0
    buffer_load_dwordx2 v[106:107], v9, s[32:35], s52 offen offset:2048
    s_add_u32 s52, s52, 4096
    buffer_load_dwordx2 v[108:109], v9, s[32:35], s52 offen offset:0
    buffer_load_dwordx2 v[110:111], v9, s[32:35], s52 offen offset:2048
    s_add_u32 s52, s52, 4096
    buffer_load_dwordx2 v[112:113], v9, s[32:35], s52 offen offset:0
    buffer_load_dwordx2 v[114:115], v9, s[32:35], s52 offen offset:2048
    s_add_u32 s52, s52, 4096
    buffer_load_dwordx2 v[116:117], v9, s[32:35], s52 offen offset:0
    buffer_load_dwordx2 v[118:119], v9, s[32:35], s52 offen offset:2048
    s_add_u32 s52, s52, 4096
    s_waitcnt vmcnt(16)
k4_ln_122:
    v_lshlrev_b32 v200, 16, v40
    v_and_b32 v201, 0xffff0000, v40
    v_lshlrev_b32 v202, 16, v41
    v_and_b32 v203, 0xffff0000, v41
    v_lshlrev_b32 v204, 16, v42
    v_and_b32 v205, 0xffff0000, v42
    v_lshlrev_b32 v206, 16, v43
    v_and_b32 v207, 0xffff0000, v43
    v_lshlrev_b32 v208, 16, v44
    v_and_b32 v209, 0xffff0000, v44
    v_lshlrev_b32 v210, 16, v45
    v_and_b32 v211, 0xffff0000, v45
    v_lshlrev_b32 v212, 16, v46
    v_and_b32 v213, 0xffff0000, v46
    v_lshlrev_b32 v214, 16, v47
    v_and_b32 v215, 0xffff0000, v47
    v_lshlrev_b32 v216, 16, v48
    v_and_b32 v217, 0xffff0000, v48
    v_lshlrev_b32 v218, 16, v49
    v_and_b32 v219, 0xffff0000, v49
    v_lshlrev_b32 v220, 16, v50
    v_and_b32 v221, 0xffff0000, v50
    v_lshlrev_b32 v222, 16, v51
    v_and_b32 v223, 0xffff0000, v51
    v_lshlrev_b32 v224, 16, v52
    v_and_b32 v225, 0xffff0000, v52
    v_lshlrev_b32 v226, 16, v53
    v_and_b32 v227, 0xffff0000, v53
    v_lshlrev_b32 v228, 16, v54
    v_and_b32 v229, 0xffff0000, v54
    v_lshlrev_b32 v230, 16, v55
    v_and_b32 v231, 0xffff0000, v55
    v_pk_add_f32 v[192:193], v[200:201], v[202:203]
    v_pk_add_f32 v[194:195], v[204:205], v[206:207]
    v_pk_add_f32 v[192:193], v[192:193], v[208:209]
    v_pk_add_f32 v[194:195], v[194:195], v[210:211]
    v_pk_add_f32 v[192:193], v[192:193], v[212:213]
    v_pk_add_f32 v[194:195], v[194:195], v[214:215]
    v_pk_add_f32 v[192:193], v[192:193], v[216:217]
    v_pk_add_f32 v[194:195], v[194:195], v[218:219]
    v_pk_add_f32 v[192:193], v[192:193], v[220:221]
    v_pk_add_f32 v[194:195], v[194:195], v[222:223]
    v_pk_add_f32 v[192:193], v[192:193], v[224:225]
    v_pk_add_f32 v[194:195], v[194:195], v[226:227]
    v_pk_add_f32 v[192:193], v[192:193], v[228:229]
    v_pk_add_f32 v[194:195], v[194:195], v[230:231]
    v_pk_add_f32 v[192:193], v[192:193], v[194:195]
    v_add_f32 v192, v192, v193
    s_nop 1
    v_add_f32_dpp v192, v192, v192 quad_perm:[1,0,3,2] row_mask:0xf bank_mask:0xf
    s_nop 1
    v_add_f32_dpp v192, v192, v192 quad_perm:[2,3,0,1] row_mask:0xf bank_mask:0xf
    s_nop 1
    v_add_f32_dpp v192, v192, v192 row_half_mirror row_mask:0xf bank_mask:0xf
    s_nop 1
    v_add_f32_dpp v192, v192, v192 row_mirror row_mask:0xf bank_mask:0xf
    v_mov_b32 v194, v192
    s_nop 1
    v_permlane16_swap_b32 v192, v194
    s_nop 1
    v_add_f32 v192, v192, v194
    v_mul_f32 v192, 0xba800000, v192
    v_mov_b32 v193, v192
    v_pk_add_f32 v[194:195], v[200:201], v[192:193]
    v_pk_add_f32 v[198:199], v[202:203], v[192:193]
    v_pk_mul_f32 v[196:197], v[194:195], v[194:195]
    v_pk_fma_f32 v[196:197], v[198:199], v[198:199], v[196:197]
    v_pk_add_f32 v[194:195], v[204:205], v[192:193]
    v_pk_add_f32 v[198:199], v[206:207], v[192:193]
    v_pk_fma_f32 v[196:197], v[194:195], v[194:195], v[196:197]
    v_pk_fma_f32 v[196:197], v[198:199], v[198:199], v[196:197]
    v_pk_add_f32 v[194:195], v[208:209], v[192:193]
    v_pk_add_f32 v[198:199], v[210:211], v[192:193]
    v_pk_fma_f32 v[196:197], v[194:195], v[194:195], v[196:197]
    v_pk_fma_f32 v[196:197], v[198:199], v[198:199], v[196:197]
    v_pk_add_f32 v[194:195], v[212:213], v[192:193]
    v_pk_add_f32 v[198:199], v[214:215], v[192:193]
    v_pk_fma_f32 v[196:197], v[194:195], v[194:195], v[196:197]
    v_pk_fma_f32 v[196:197], v[198:199], v[198:199], v[196:197]
    v_pk_add_f32 v[194:195], v[216:217], v[192:193]
    v_pk_add_f32 v[198:199], v[218:219], v[192:193]
    v_pk_fma_f32 v[196:197], v[194:195], v[194:195], v[196:197]
    v_pk_fma_f32 v[196:197], v[198:199], v[198:199], v[196:197]
    v_pk_add_f32 v[194:195], v[220:221], v[192:193]
    v_pk_add_f32 v[198:199], v[222:223], v[192:193]
    v_pk_fma_f32 v[196:197], v[194:195], v[194:195], v[196:197]
    v_pk_fma_f32 v[196:197], v[198:199], v[198:199], v[196:197]
    v_pk_add_f32 v[194:195], v[224:225], v[192:193]
    v_pk_add_f32 v[198:199], v[226:227], v[192:193]
    v_pk_fma_f32 v[196:197], v[194:195], v[194:195], v[196:197]
    v_pk_fma_f32 v[196:197], v[198:199], v[198:199], v[196:197]
    v_pk_add_f32 v[194:195], v[228:229], v[192:193]
    v_pk_add_f32 v[198:199], v[230:231], v[192:193]
    v_pk_fma_f32 v[196:197], v[194:195], v[194:195], v[196:197]
    v_pk_fma_f32 v[196:197], v[198:199], v[198:199], v[196:197]
    v_add_f32 v196, v196, v197
    s_nop 1
    v_add_f32_dpp v196, v196, v196 quad_perm:[1,0,3,2] row_mask:0xf bank_mask:0xf
    s_nop 1
    v_add_f32_dpp v196, v196, v196 quad_perm:[2,3,0,1] row_mask:0xf bank_mask:0xf
    s_nop 1
    v_add_f32_dpp v196, v196, v196 row_half_mirror row_mask:0xf bank_mask:0xf
    s_nop 1
    v_add_f32_dpp v196, v196, v196 row_mirror row_mask:0xf bank_mask:0xf
    v_mov_b32 v194, v196
    s_nop 1
    v_permlane16_swap_b32 v196, v194
    s_nop 1
    v_add_f32 v196, v196, v194
    v_mul_f32 v196, 0x3a800000, v196
    v_cvt_pk_bf16_f32 v198, v192, v196
    v_and_b32 v196, 0xffff0000, v198
    v_lshlrev_b32 v198, 16, v198
    v_add_f32 v196, 0x3727c5ac, v196
    v_mov_b32 v199, v198
    v_cvt_pk_bf16_f32 v196, v196, v196
    v_and_b32 v196, 0xffff0000, v196
    v_sqrt_f32 v196, v196
    v_pk_add_f32 v[160:161], v[200:201], v[198:199]
    v_pk_add_f32 v[162:163], v[202:203], v[198:199]
    v_pk_add_f32 v[164:165], v[204:205], v[198:199]
    v_pk_add_f32 v[166:167], v[206:207], v[198:199]
    v_pk_add_f32 v[168:169], v[208:209], v[198:199]
    v_pk_add_f32 v[170:171], v[210:211], v[198:199]
    v_pk_add_f32 v[172:173], v[212:213], v[198:199]
    v_pk_add_f32 v[174:175], v[214:215], v[198:199]
    v_pk_add_f32 v[176:177], v[216:217], v[198:199]
    v_pk_add_f32 v[178:179], v[218:219], v[198:199]
    v_pk_add_f32 v[180:181], v[220:221], v[198:199]
    v_pk_add_f32 v[182:183], v[222:223], v[198:199]
    v_pk_add_f32 v[184:185], v[224:225], v[198:199]
    v_pk_add_f32 v[186:187], v[226:227], v[198:199]
    v_pk_add_f32 v[188:189], v[228:229], v[198:199]
    v_pk_add_f32 v[190:191], v[230:231], v[198:199]
    v_cvt_pk_bf16_f32 v196, v196, v196
    v_and_b32 v196, 0xffff0000, v196
    v_rcp_f32 v196, v196
    v_cvt_pk_bf16_f32 v40, v160, v161
    v_cvt_pk_bf16_f32 v41, v162, v163
    v_cvt_pk_bf16_f32 v42, v164, v165
    v_cvt_pk_bf16_f32 v43, v166, v167
    v_cvt_pk_bf16_f32 v44, v168, v169
    v_cvt_pk_bf16_f32 v45, v170, v171
    v_cvt_pk_bf16_f32 v46, v172, v173
    v_cvt_pk_bf16_f32 v47, v174, v175
    v_cvt_pk_bf16_f32 v48, v176, v177
    v_cvt_pk_bf16_f32 v49, v178, v179
    v_cvt_pk_bf16_f32 v50, v180, v181
    v_cvt_pk_bf16_f32 v51, v182, v183
    v_cvt_pk_bf16_f32 v52, v184, v185
    v_cvt_pk_bf16_f32 v53, v186, v187
    v_cvt_pk_bf16_f32 v54, v188, v189
    v_cvt_pk_bf16_f32 v55, v190, v191
    v_mov_b32 v197, v196
    v_lshlrev_b32 v160, 16, v40
    v_and_b32 v161, 0xffff0000, v40
    v_lshlrev_b32 v162, 16, v41
    v_and_b32 v163, 0xffff0000, v41
    v_lshlrev_b32 v164, 16, v42
    v_and_b32 v165, 0xffff0000, v42
    v_lshlrev_b32 v166, 16, v43
    v_and_b32 v167, 0xffff0000, v43
    v_lshlrev_b32 v168, 16, v44
    v_and_b32 v169, 0xffff0000, v44
    v_lshlrev_b32 v170, 16, v45
    v_and_b32 v171, 0xffff0000, v45
    v_lshlrev_b32 v172, 16, v46
    v_and_b32 v173, 0xffff0000, v46
    v_lshlrev_b32 v174, 16, v47
    v_and_b32 v175, 0xffff0000, v47
    v_lshlrev_b32 v176, 16, v48
    v_and_b32 v177, 0xffff0000, v48
    v_lshlrev_b32 v178, 16, v49
    v_and_b32 v179, 0xffff0000, v49
    v_lshlrev_b32 v180, 16, v50
    v_and_b32 v181, 0xffff0000, v50
    v_lshlrev_b32 v182, 16, v51
    v_and_b32 v183, 0xffff0000, v51
    v_lshlrev_b32 v184, 16, v52
    v_and_b32 v185, 0xffff0000, v52
    v_lshlrev_b32 v186, 16, v53
    v_and_b32 v187, 0xffff0000, v53
    v_lshlrev_b32 v188, 16, v54
    v_and_b32 v189, 0xffff0000, v54
    v_lshlrev_b32 v190, 16, v55
    v_and_b32 v191, 0xffff0000, v55
    v_pk_mul_f32 v[160:161], v[160:161], v[196:197]
    v_pk_mul_f32 v[162:163], v[162:163], v[196:197]
    v_pk_mul_f32 v[164:165], v[164:165], v[196:197]
    v_pk_mul_f32 v[166:167], v[166:167], v[196:197]
    v_pk_mul_f32 v[168:169], v[168:169], v[196:197]
    v_pk_mul_f32 v[170:171], v[170:171], v[196:197]
    v_pk_mul_f32 v[172:173], v[172:173], v[196:197]
    v_pk_mul_f32 v[174:175], v[174:175], v[196:197]
    v_pk_mul_f32 v[176:177], v[176:177], v[196:197]
    v_pk_mul_f32 v[178:179], v[178:179], v[196:197]
    v_pk_mul_f32 v[180:181], v[180:181], v[196:197]
    v_pk_mul_f32 v[182:183], v[182:183], v[196:197]
    v_pk_mul_f32 v[184:185], v[184:185], v[196:197]
    v_pk_mul_f32 v[186:187], v[186:187], v[196:197]
    v_pk_mul_f32 v[188:189], v[188:189], v[196:197]
    v_pk_mul_f32 v[190:191], v[190:191], v[196:197]
    v_cvt_pk_bf16_f32 v40, v160, v161
    v_cvt_pk_bf16_f32 v41, v162, v163
    v_cvt_pk_bf16_f32 v42, v164, v165
    v_cvt_pk_bf16_f32 v43, v166, v167
    v_cvt_pk_bf16_f32 v44, v168, v169
    v_cvt_pk_bf16_f32 v45, v170, v171
    v_cvt_pk_bf16_f32 v46, v172, v173
    v_cvt_pk_bf16_f32 v47, v174, v175
    v_cvt_pk_bf16_f32 v48, v176, v177
    v_cvt_pk_bf16_f32 v49, v178, v179
    v_cvt_pk_bf16_f32 v50, v180, v181
    v_cvt_pk_bf16_f32 v51, v182, v183
    v_cvt_pk_bf16_f32 v52, v184, v185
    v_cvt_pk_bf16_f32 v53, v186, v187
    v_cvt_pk_bf16_f32 v54, v188, v189
    v_cvt_pk_bf16_f32 v55, v190, v191
    s_cmp_ge_u32 s44, 4
    s_cbranch_scc1 k4_bout_124
    v_lshl_add_u32 v11, v5, 11, v7
    v_add_u32 v12, 65536, v11
    ds_write_b128 v12, v[40:43] offset:0
    ds_write_b128 v12, v[44:47] offset:512
    ds_write_b128 v12, v[48:51] offset:1024
    ds_write_b128 v12, v[52:55] offset:1536
    v_lshlrev_b32 v12, 2, v5
    v_add_u32 v12, 69760, v12
    ds_write_b32 v12, v15
    s_mov_b32 s54, 0x05040100
    s_mov_b32 s55, 0x07060302
    s_waitcnt vmcnt(0)
    v_perm_b32 v56, v90, v88, s54
    v_perm_b32 v57, v90, v88, s55
    v_perm_b32 v58, v91, v89, s54
    v_perm_b32 v59, v91, v89, s55
    v_perm_b32 v60, v94, v92, s54
    v_perm_b32 v61, v94, v92, s55
    v_perm_b32 v62, v95, v93, s54
    v_perm_b32 v63, v95, v93, s55
    v_perm_b32 v64, v98, v96, s54
    v_perm_b32 v65, v98, v96, s55
    v_perm_b32 v66, v99, v97, s54
    v_perm_b32 v67, v99, v97, s55
    v_perm_b32 v68, v102, v100, s54
    v_perm_b32 v69, v102, v100, s55
    v_perm_b32 v70, v103, v101, s54
    v_perm_b32 v71, v103, v101, s55
    v_perm_b32 v72, v106, v104, s54
    v_perm_b32 v73, v106, v104, s55
    v_perm_b32 v74, v107, v105, s54
    v_perm_b32 v75, v107, v105, s55
    v_perm_b32 v76, v110, v108, s54
    v_perm_b32 v77, v110, v108, s55
    v_perm_b32 v78, v111, v109, s54
    v_perm_b32 v79, v111, v109, s55
    v_perm_b32 v80, v114, v112, s54
    v_perm_b32 v81, v114, v112, s55
    v_perm_b32 v82, v115, v113, s54
    v_perm_b32 v83, v115, v113, s55
    v_perm_b32 v84, v118, v116, s54
    v_perm_b32 v85, v118, v116, s55
    v_perm_b32 v86, v119, v117, s54
    v_perm_b32 v87, v119, v117, s55
    s_add_u32 s56, s14, 0x4900000
    s_addc_u32 s57, s15, 0
    s_and_b32 s57, s57, 0xffff
    s_mov_b32 s58, 0x1c0000
    s_mov_b32 s59, 0x00020000
    s_add_u32 s60, s14, 0x480f000
    s_addc_u32 s61, s15, 0
    s_and_b32 s61, s61, 0xffff
    s_mov_b32 s62, 0x2000
    s_mov_b32 s63, 0x00020000
    s_waitcnt lgkmcnt(0)
k4_mm_123:
    s_barrier
    s_cmp_ge_u32 s2, 224
    s_cbranch_scc1 k4_red_126
    v_lshrrev_b32 v12, 4, v2
    v_and_b32 v13, 1, v2
    v_lshlrev_b32 v13, 11, v13
    v_lshl_add_u32 v13, v12, 3, v13
    s_lshl_b32 s54, s44, 8
    s_add_u32 s54, s54, 65536
    v_add_u32 v13, s54, v13
    v_lshlrev_b32 v14, 3, v2
    s_lshl_b32 s54, s44, 12
    v_add_u32 v14, s54, v14
    ds_read_b64 v[128:129], v13 offset:0
    ds_read_b64 v[130:131], v13 offset:32
    ds_read_b64_tr_b16 v[144:145], v14 offset:0
    ds_read_b64_tr_b16 v[146:147], v14 offset:512
    ds_read_b64_tr_b16 v[160:161], v14 offset:32768
    ds_read_b64_tr_b16 v[162:163], v14 offset:33280
    ds_read_b64 v[132:133], v13 offset:64
    ds_read_b64 v[134:135], v13 offset:96
    ds_read_b64_tr_b16 v[148:149], v14 offset:1024
    ds_read_b64_tr_b16 v[150:151], v14 offset:1536
    ds_read_b64_tr_b16 v[164:165], v14 offset:33792
    ds_read_b64_tr_b16 v[166:167], v14 offset:34304
    ds_read_b64 v[136:137], v13 offset:128
    ds_read_b64 v[138:139], v13 offset:160
    ds_read_b64_tr_b16 v[152:153], v14 offset:2048
    ds_read_b64_tr_b16 v[154:155], v14 offset:2560
    ds_read_b64_tr_b16 v[168:169], v14 offset:34816
    ds_read_b64_tr_b16 v[170:171], v14 offset:35328
    ds_read_b64 v[140:141], v13 offset:192
    ds_read_b64 v[142:143], v13 offset:224
    ds_read_b64_tr_b16 v[156:157], v14 offset:3072
    ds_read_b64_tr_b16 v[158:159], v14 offset:3584
    ds_read_b64_tr_b16 v[172:173], v14 offset:35840
    ds_read_b64_tr_b16 v[174:175], v14 offset:36352
    v_and_b32 v13, 15, v2
    v_lshlrev_b32 v13, 6, v13
    v_lshl_add_u32 v13, v12, 4, v13
    s_lshl_b32 s54, s44, 11
    s_add_u32 s54, s54, 69888
    v_add_u32 v13, s54, v13
    s_waitcnt lgkmcnt(0)
    v_mfma_f32_16x16x32_bf16 v[16:19], v[144:147], v[128:131], 0
    v_mfma_f32_16x16x32_bf16 v[20:23], v[160:163], v[128:131], 0
    v_mfma_f32_16x16x32_bf16 v[16:19], v[148:151], v[132:135], v[16:19]
    v_mfma_f32_16x16x32_bf16 v[20:23], v[164:167], v[132:135], v[20:23]
    v_mfma_f32_16x16x32_bf16 v[16:19], v[152:155], v[136:139], v[16:19]
    v_mfma_f32_16x16x32_bf16 v[20:23], v[168:171], v[136:139], v[20:23]
    v_mfma_f32_16x16x32_bf16 v[16:19], v[156:159], v[140:143], v[16:19]
    v_mfma_f32_16x16x32_bf16 v[20:23], v[172:175], v[140:143], v[20:23]
    s_nop 7
    ds_write_b128 v13, v[16:19]
    ds_write_b128 v13, v[20:23] offset:1024
    s_waitcnt lgkmcnt(0)
    s_barrier
    s_cmp_ge_u32 s44, 4
    s_cbranch_scc1 k4_ln_122
    v_lshlrev_b32 v13, 2, v4
    v_add_u32 v13, 69888, v13
    ds_read2st64_b32 v[16:17], v13 offset0:0 offset1:4
    ds_read2st64_b32 v[18:19], v13 offset0:8 offset1:12
    ds_read2st64_b32 v[20:21], v13 offset0:16 offset1:20
    ds_read2st64_b32 v[22:23], v13 offset0:24 offset1:28
    ds_read2st64_b32 v[24:25], v13 offset0:32 offset1:36
    ds_read2st64_b32 v[26:27], v13 offset0:40 offset1:44
    ds_read2st64_b32 v[28:29], v13 offset0:48 offset1:52
    ds_read2st64_b32 v[30:31], v13 offset0:56 offset1:60
    s_waitcnt lgkmcnt(0)
    v_pk_add_f32 v[16:17], v[16:17], v[24:25]
    v_pk_add_f32 v[18:19], v[18:19], v[26:27]
    v_pk_add_f32 v[20:21], v[20:21], v[28:29]
    v_pk_add_f32 v[22:23], v[22:23], v[30:31]
    v_pk_add_f32 v[16:17], v[16:17], v[20:21]
    v_pk_add_f32 v[18:19], v[18:19], v[22:23]
    v_pk_add_f32 v[16:17], v[16:17], v[18:19]
    v_cvt_pk_bf16_f32 v16, v16, v17
    v_and_b32 v20, 0xffff0000, v16
    v_lshlrev_b32 v16, 16, v16
    v_mul_f32 v17, 0xbfb8aa3b, v16
    v_exp_f32 v17, v17
    s_lshl_b32 s54, s45, 13
    v_add_f32 v17, 1.0, v17
    v_rcp_f32 v17, v17
    s_add_u32 s55, s54, 4096
    v_mul_f32 v16, v16, v17
    v_cvt_pk_bf16_f32 v16, v16, v16
    v_and_b32 v16, 0xffff0000, v16
    v_mul_f32 v16, v16, v20
    s_nop 1
    v_mov_b32_dpp v17, v16 quad_perm:[1,0,3,2] row_mask:0xf bank_mask:0xf
    v_cvt_pk_bf16_f32 v16, v16, v17
    v_lshlrev_b32 v13, 4, v0
    v_readlane_b32 s24, v16, 0
    v_readlane_b32 s25, v16, 2
    v_readlane_b32 s26, v16, 4
    v_readlane_b32 s27, v16, 6
    v_readlane_b32 s28, v16, 8
    v_readlane_b32 s29, v16, 10
    v_readlane_b32 s30, v16, 12
    v_readlane_b32 s31, v16, 14
    v_readlane_b32 s32, v16, 16
    v_readlane_b32 s33, v16, 18
    v_readlane_b32 s34, v16, 20
    v_readlane_b32 s35, v16, 22
    v_readlane_b32 s36, v16, 24
    v_readlane_b32 s37, v16, 26
    v_readlane_b32 s38, v16, 28
    v_readlane_b32 s39, v16, 30
    v_dot2_f32_bf16 v24, v56, s24, 0
    v_dot2_f32_bf16 v25, v57, s24, 0
    v_dot2_f32_bf16 v26, v58, s24, 0
    v_dot2_f32_bf16 v27, v59, s24, 0
    v_dot2_f32_bf16 v24, v60, s25, v24
    v_dot2_f32_bf16 v25, v61, s25, v25
    v_dot2_f32_bf16 v26, v62, s25, v26
    v_dot2_f32_bf16 v27, v63, s25, v27
    v_dot2_f32_bf16 v24, v64, s26, v24
    v_dot2_f32_bf16 v25, v65, s26, v25
    v_dot2_f32_bf16 v26, v66, s26, v26
    v_dot2_f32_bf16 v27, v67, s26, v27
    v_dot2_f32_bf16 v24, v68, s27, v24
    v_dot2_f32_bf16 v25, v69, s27, v25
    v_dot2_f32_bf16 v26, v70, s27, v26
    v_dot2_f32_bf16 v27, v71, s27, v27
    v_dot2_f32_bf16 v24, v72, s28, v24
    v_dot2_f32_bf16 v25, v73, s28, v25
    v_dot2_f32_bf16 v26, v74, s28, v26
    v_dot2_f32_bf16 v27, v75, s28, v27
    v_dot2_f32_bf16 v24, v76, s29, v24
    v_dot2_f32_bf16 v25, v77, s29, v25
    v_dot2_f32_bf16 v26, v78, s29, v26
    v_dot2_f32_bf16 v27, v79, s29, v27
    v_dot2_f32_bf16 v24, v80, s30, v24
    v_dot2_f32_bf16 v25, v81, s30, v25
    v_dot2_f32_bf16 v26, v82, s30, v26
    v_dot2_f32_bf16 v27, v83, s30, v27
    v_dot2_f32_bf16 v24, v84, s31, v24
    v_dot2_f32_bf16 v25, v85, s31, v25
    v_dot2_f32_bf16 v26, v86, s31, v26
    v_dot2_f32_bf16 v27, v87, s31, v27
    v_dot2_f32_bf16 v28, v56, s32, 0
    v_dot2_f32_bf16 v29, v57, s32, 0
    v_dot2_f32_bf16 v30, v58, s32, 0
    v_dot2_f32_bf16 v31, v59, s32, 0
    v_dot2_f32_bf16 v28, v60, s33, v28
    v_dot2_f32_bf16 v29, v61, s33, v29
    v_dot2_f32_bf16 v30, v62, s33, v30
    v_dot2_f32_bf16 v31, v63, s33, v31
    v_dot2_f32_bf16 v28, v64, s34, v28
    v_dot2_f32_bf16 v29, v65, s34, v29
    v_dot2_f32_bf16 v30, v66, s34, v30
    v_dot2_f32_bf16 v31, v67, s34, v31
    v_dot2_f32_bf16 v28, v68, s35, v28
    v_dot2_f32_bf16 v29, v69, s35, v29
    v_dot2_f32_bf16 v30, v70, s35, v30
    v_dot2_f32_bf16 v31, v71, s35, v31
    v_dot2_f32_bf16 v28, v72, s36, v28
    v_dot2_f32_bf16 v29, v73, s36, v29
    v_dot2_f32_bf16 v30, v74, s36, v30
    v_dot2_f32_bf16 v31, v75, s36, v31
    v_dot2_f32_bf16 v28, v76, s37, v28
    v_dot2_f32_bf16 v29, v77, s37, v29
    v_dot2_f32_bf16 v30, v78, s37, v30
    v_dot2_f32_bf16 v31, v79, s37, v31
    v_dot2_f32_bf16 v28, v80, s38, v28
    v_dot2_f32_bf16 v29, v81, s38, v29
    v_dot2_f32_bf16 v30, v82, s38, v30
    v_dot2_f32_bf16 v31, v83, s38, v31
    v_dot2_f32_bf16 v28, v84, s39, v28
    v_dot2_f32_bf16 v29, v85, s39, v29
    v_dot2_f32_bf16 v30, v86, s39, v30
    v_dot2_f32_bf16 v31, v87, s39, v31
    s_and_b32 s52, s45, 15
    s_lshl_b32 s53, s44, 4
    s_add_u32 s52, s52, s53
    s_lshl_b32 s52, s52, 7
    buffer_store_dwordx4 v[24:27], v13, s[56:59], s54 offen sc1
    buffer_store_dwordx4 v[28:31], v13, s[56:59], s55 offen sc1
    v_mov_b32 v12, 0
    v_mov_b32 v13, 1
    s_mov_b64 exec, 1
    s_waitcnt vmcnt(0)
    buffer_atomic_add v13, v12, s[60:63], s52 offen sc1
    s_mov_b64 exec, -1
    s_endpgm
k4_red_126:
    s_cmp_ge_u32 s44, 4
    s_cbranch_scc1 k4_ln_122
    s_sub_u32 s40, s2, 224
    s_lshr_b32 s41, s40, 4
    s_and_b32 s42, s40, 15
    s_mov_b32 s24, s4
    s_and_b32 s25, s5, 0xffff
    s_mov_b32 s26, 0x800
    s_mov_b32 s27, 0x00020000
    s_mov_b32 s28, s12
    s_and_b32 s29, s13, 0xffff
    s_mov_b32 s30, 0x400000
    s_mov_b32 s31, 0x00020000
    buffer_load_dwordx4 v[56:59], v7, s[24:27], 0 offen offset:0
    buffer_load_dwordx4 v[60:63], v7, s[24:27], 0 offen offset:512
    buffer_load_dwordx4 v[64:67], v7, s[24:27], 0 offen offset:1024
    buffer_load_dwordx4 v[68:71], v7, s[24:27], 0 offen offset:1536
    s_lshl_b32 s43, s41, 5
    v_readlane_b32 s46, v15, s43
    v_and_b32 v8, 15, v0
    s_lshl_b32 s47, s42, 7
    v_lshl_add_u32 v9, v8, 3, s47
    s_lshl_b32 s46, s46, 11
    s_lshl_b32 s48, s41, 11
    s_add_u32 s48, s48, 65536
    v_add_u32 v12, s48, v9
    ds_read_b64 v[72:73], v12
    buffer_load_dwordx2 v[74:75], v9, s[20:23], s46 offen
    v_lshrrev_b32 v10, 4, v0
    v_lshlrev_b32 v10, 13, v10
    v_lshl_add_u32 v10, v8, 4, v10
    s_lshl_b32 s49, s40, 8
    s_waitcnt vmcnt(1)
    v_dot2_f32_bf16 v12, v40, v56, 0
    v_dot2_f32_bf16 v12, v41, v57, v12
    v_dot2_f32_bf16 v12, v42, v58, v12
    v_dot2_f32_bf16 v12, v43, v59, v12
    v_dot2_f32_bf16 v12, v44, v60, v12
    v_dot2_f32_bf16 v12, v45, v61, v12
    v_dot2_f32_bf16 v12, v46, v62, v12
    v_dot2_f32_bf16 v12, v47, v63, v12
    v_dot2_f32_bf16 v12, v48, v64, v12
    v_dot2_f32_bf16 v12, v49, v65, v12
    v_dot2_f32_bf16 v12, v50, v66, v12
    v_dot2_f32_bf16 v12, v51, v67, v12
    v_dot2_f32_bf16 v12, v52, v68, v12
    v_dot2_f32_bf16 v12, v53, v69, v12
    v_dot2_f32_bf16 v12, v54, v70, v12
    v_dot2_f32_bf16 v12, v55, v71, v12
    s_nop 2
    s_nop 1
    v_add_f32_dpp v12, v12, v12 quad_perm:[1,0,3,2] row_mask:0xf bank_mask:0xf
    s_nop 1
    v_add_f32_dpp v12, v12, v12 quad_perm:[2,3,0,1] row_mask:0xf bank_mask:0xf
    s_nop 1
    v_add_f32_dpp v12, v12, v12 row_half_mirror row_mask:0xf bank_mask:0xf
    s_nop 1
    v_add_f32_dpp v12, v12, v12 row_mirror row_mask:0xf bank_mask:0xf
    v_mov_b32 v13, v12
    s_nop 1
    v_permlane16_swap_b32 v12, v13
    s_nop 1
    v_add_f32 v12, v12, v13
    v_cvt_pk_bf16_f32 v12, v12, v12
    v_and_b32 v12, 0xffff0000, v12
    v_mul_f32 v12, 0xbfb8aa3b, v12
    v_exp_f32 v12, v12
    v_mov_b32 v3, v8
    v_add_f32 v12, 1.0, v12
    v_rcp_f32 v12, v12
    s_lshr_b32 s50, s42, 2
    v_cvt_pk_bf16_f32 v12, v12, v12
    v_and_b32 v12, 0xffff0000, v12
    s_lshl_b32 s50, s50, 11
    v_readlane_b32 s51, v12, s43
    v_lshlrev_b32 v3, 7, v3
    s_mov_b32 s47, s49
    s_mov_b32 s30, 0
    s_mov_b32 s58, 0
    s_branch k4_go_127
k4_again_129:
    s_mov_b32 s49, s47
    s_mov_b32 s30, 0x400000
    s_mov_b32 s58, 1835008
    s_cmp_lg_u32 s44, 0
    s_cbranch_scc1 k4_go_127
    s_mov_b32 s52, 1048576
k4_poll_128:
    s_sleep 8
    buffer_load_dword v13, v3, s[60:63], s50 offen sc1
    s_sub_u32 s52, s52, 1
    s_cbranch_scc1 k4_go_127
    s_waitcnt vmcnt(0)
    v_cmp_gt_u32 vcc, 14, v13
    s_cbranch_vccnz k4_poll_128
k4_go_127:
    s_barrier
    buffer_load_dwordx4 v[76:79], v10, s[56:59], s49 offen sc1
    s_add_u32 s49, s49, 0x20000
    buffer_load_dwordx4 v[80:83], v10, s[56:59], s49 offen sc1
    s_add_u32 s49, s49, 0x20000
    buffer_load_dwordx4 v[84:87], v10, s[56:59], s49 offen sc1
    s_add_u32 s49, s49, 0x20000
    buffer_load_dwordx4 v[88:91], v10, s[56:59], s49 offen sc1
    s_add_u32 s49, s49, 0x20000
    buffer_load_dwordx4 v[92:95], v10, s[56:59], s49 offen sc1
    s_add_u32 s49, s49, 0x20000
    buffer_load_dwordx4 v[96:99], v10, s[56:59], s49 offen sc1
    s_add_u32 s49, s49, 0x20000
    buffer_load_dwordx4 v[100:103], v10, s[56:59], s49 offen sc1
    s_add_u32 s49, s49, 0x20000
    buffer_load_dwordx4 v[104:107], v10, s[56:59], s49 offen sc1
    s_add_u32 s49, s49, 0x20000
    buffer_load_dwordx4 v[108:111], v10, s[56:59], s49 offen sc1
    s_add_u32 s49, s49, 0x20000
    buffer_load_dwordx4 v[112:115], v10, s[56:59], s49 offen sc1
    s_add_u32 s49, s49, 0x20000
    buffer_load_dwordx4 v[116:119], v10, s[56:59], s49 offen sc1
    s_add_u32 s49, s49, 0x20000
    buffer_load_dwordx4 v[120:123], v10, s[56:59], s49 offen sc1
    s_add_u32 s49, s49, 0x20000
    buffer_load_dwordx4 v[124:127], v10, s[56:59], s49 offen sc1
    s_add_u32 s49, s49, 0x20000
    buffer_load_dwordx4 v[128:131], v10, s[56:59], s49 offen sc1
    s_add_u32 s49, s49, 0x20000
    s_waitcnt vmcnt(12)
    v_pk_add_f32 v[76:77], v[76:77], v[80:81]
    v_pk_add_f32 v[78:79], v[78:79], v[82:83]
    s_waitcnt vmcnt(11)
    v_pk_add_f32 v[76:77], v[76:77], v[84:85]
    v_pk_add_f32 v[78:79], v[78:79], v[86:87]
    s_waitcnt vmcnt(10)
    v_pk_add_f32 v[76:77], v[76:77], v[88:89]
    v_pk_add_f32 v[78:79], v[78:79], v[90:91]
    s_waitcnt vmcnt(9)
    v_pk_add_f32 v[76:77], v[76:77], v[92:93]
    v_pk_add_f32 v[78:79], v[78:79], v[94:95]
    s_waitcnt vmcnt(8)
    v_pk_add_f32 v[76:77], v[76:77], v[96:97]
    v_pk_add_f32 v[78:79], v[78:79], v[98:99]
    s_waitcnt vmcnt(7)
    v_pk_add_f32 v[76:77], v[76:77], v[100:101]
    v_pk_add_f32 v[78:79], v[78:79], v[102:103]
    s_waitcnt vmcnt(6)
    v_pk_add_f32 v[76:77], v[76:77], v[104:105]
    v_pk_add_f32 v[78:79], v[78:79], v[106:107]
    s_waitcnt vmcnt(5)
    v_pk_add_f32 v[76:77], v[76:77], v[108:109]
    v_pk_add_f32 v[78:79], v[78:79], v[110:111]
    s_waitcnt vmcnt(4)
    v_pk_add_f32 v[76:77], v[76:77], v[112:113]
    v_pk_add_f32 v[78:79], v[78:79], v[114:115]
    s_waitcnt vmcnt(3)
    v_pk_add_f32 v[76:77], v[76:77], v[116:117]
    v_pk_add_f32 v[78:79], v[78:79], v[118:119]
    s_waitcnt vmcnt(2)
    v_pk_add_f32 v[76:77], v[76:77], v[120:121]
    v_pk_add_f32 v[78:79], v[78:79], v[122:123]
    s_waitcnt vmcnt(1)
    v_pk_add_f32 v[76:77], v[76:77], v[124:125]
    v_pk_add_f32 v[78:79], v[78:79], v[126:127]
    s_waitcnt vmcnt(0)
    v_pk_add_f32 v[76:77], v[76:77], v[128:129]
    v_pk_add_f32 v[78:79], v[78:79], v[130:131]
    v_mov_b32 v80, v76
    v_mov_b32 v81, v77
    v_mov_b32 v82, v78
    v_mov_b32 v83, v79
    s_nop 1
    v_permlane16_swap_b32 v76, v80
    v_permlane16_swap_b32 v77, v81
    v_permlane16_swap_b32 v78, v82
    v_permlane16_swap_b32 v79, v83
    s_nop 1
    v_add_f32 v76, v76, v80
    v_add_f32 v77, v77, v81
    v_add_f32 v78, v78, v82
    v_add_f32 v79, v79, v83
    v_mov_b32 v80, v76
    v_mov_b32 v81, v77
    v_mov_b32 v82, v78
    v_mov_b32 v83, v79
    s_nop 1
    v_permlane32_swap_b32 v76, v80
    v_permlane32_swap_b32 v77, v81
    v_permlane32_swap_b32 v78, v82
    v_permlane32_swap_b32 v79, v83
    s_nop 1
    v_add_f32 v76, v76, v80
    v_add_f32 v77, v77, v81
    v_add_f32 v78, v78, v82
    v_add_f32 v79, v79, v83
    v_lshlrev_b32 v14, 8, v1
    v_lshl_add_u32 v14, v8, 4, v14
    ds_write_b128 v14, v[76:79]
    s_waitcnt lgkmcnt(0)
    s_barrier
    v_lshlrev_b32 v14, 4, v8
    ds_read_b128 v[76:79], v14 offset:0
    ds_read_b128 v[80:83], v14 offset:256
    ds_read_b128 v[84:87], v14 offset:512
    ds_read_b128 v[88:91], v14 offset:768
    s_waitcnt lgkmcnt(0)
    v_pk_add_f32 v[76:77], v[76:77], v[80:81]
    v_pk_add_f32 v[78:79], v[78:79], v[82:83]
    v_pk_add_f32 v[76:77], v[76:77], v[84:85]
    v_pk_add_f32 v[78:79], v[78:79], v[86:87]
    v_pk_add_f32 v[76:77], v[76:77], v[88:89]
    v_pk_add_f32 v[78:79], v[78:79], v[90:91]
    v_cvt_pk_bf16_f32 v20, v76, v77
    v_lshlrev_b32 v21, 16, v20
    v_and_b32 v22, 0xffff0000, v20
    v_mul_f32 v21, s51, v21
    v_mul_f32 v22, s51, v22
    v_cvt_pk_bf16_f32 v20, v21, v22
    v_lshlrev_b32 v21, 16, v20
    v_and_b32 v22, 0xffff0000, v20
    v_lshlrev_b32 v23, 16, v72
    v_and_b32 v24, 0xffff0000, v72
    v_add_f32 v21, v21, v23
    v_add_f32 v22, v22, v24
    v_cvt_pk_bf16_f32 v20, v21, v22
    v_lshlrev_b32 v21, 16, v20
    v_and_b32 v22, 0xffff0000, v20
    v_lshlrev_b32 v23, 16, v74
    v_and_b32 v24, 0xffff0000, v74
    v_add_f32 v21, v21, v23
    v_add_f32 v22, v22, v24
    v_cvt_pk_bf16_f32 v26, v21, v22
    v_cvt_pk_bf16_f32 v20, v78, v79
    v_lshlrev_b32 v21, 16, v20
    v_and_b32 v22, 0xffff0000, v20
    v_mul_f32 v21, s51, v21
    v_mul_f32 v22, s51, v22
    v_cvt_pk_bf16_f32 v20, v21, v22
    v_lshlrev_b32 v21, 16, v20
    v_and_b32 v22, 0xffff0000, v20
    v_lshlrev_b32 v23, 16, v73
    v_and_b32 v24, 0xffff0000, v73
    v_add_f32 v21, v21, v23
    v_add_f32 v22, v22, v24
    v_cvt_pk_bf16_f32 v20, v21, v22
    v_lshlrev_b32 v21, 16, v20
    v_and_b32 v22, 0xffff0000, v20
    v_lshlrev_b32 v23, 16, v75
    v_and_b32 v24, 0xffff0000, v75
    v_add_f32 v21, v21, v23
    v_add_f32 v22, v22, v24
    v_cvt_pk_bf16_f32 v27, v21, v22
    v_cmp_gt_u32 vcc, 16, v0
    s_and_saveexec_b64 s[52:53], vcc
    s_cbranch_execz k4_skip_130
    buffer_store_dwordx2 v[26:27], v9, s[28:31], s46 offen sc1
k4_skip_130:
    s_mov_b64 exec, s[52:53]
    s_cmp_lg_u32 s30, 0
    s_cbranch_scc1 k4_fin_131
    s_branch k4_again_129
k4_fin_131:
    s_endpgm
k4_b_121:
    v_lshl_add_u32 v6, v1, 1, v5
    s_lshl_b32 s47, s2, 3
    s_sub_u32 s47, s47, 8
    v_add_u32 v6, s47, v6
    v_lshl_add_u32 v6, v6, 11, v7
    s_mov_b32 s36, s12
    s_and_b32 s37, s13, 0xffff
    s_mov_b32 s38, 0x400000
    s_mov_b32 s39, 0x00020000
    s_cmp_ge_u32 s2, 224
    s_cbranch_scc1 k4_noffn_132
    s_add_u32 s24, s14, 0x6000000
    s_addc_u32 s25, s15, 0
    s_and_b32 s25, s25, 0xffff
    s_mov_b32 s26, 0x1000000
    s_mov_b32 s27, 0x00020000
    s_and_b32 s50, s44, 3
    s_lshl_b32 s50, s50, 13
    s_lshl_b32 s52, s45, 15
    s_add_u32 s52, s52, s50
    v_lshlrev_b32 v8, 4, v2
    s_add_u32 m0, s50, 0
    s_add_u32 s53, s52, 0
    buffer_load_dwordx4 v8, s[24:27], s53 offen offset:0 lds
    buffer_load_dwordx4 v8, s[24:27], s53 offen offset:1024 lds
    buffer_load_dwordx4 v8, s[24:27], s53 offen offset:2048 lds
    buffer_load_dwordx4 v8, s[24:27], s53 offen offset:3072 lds
    s_add_u32 m0, s50, 4096
    s_add_u32 s53, s52, 4096
    buffer_load_dwordx4 v8, s[24:27], s53 offen offset:0 lds
    buffer_load_dwordx4 v8, s[24:27], s53 offen offset:1024 lds
    buffer_load_dwordx4 v8, s[24:27], s53 offen offset:2048 lds
    buffer_load_dwordx4 v8, s[24:27], s53 offen offset:3072 lds
    s_add_u32 m0, s50, 32768
    s_add_u32 s53, s52, 8388608
    buffer_load_dwordx4 v8, s[24:27], s53 offen offset:0 lds
    buffer_load_dwordx4 v8, s[24:27], s53 offen offset:1024 lds
    buffer_load_dwordx4 v8, s[24:27], s53 offen offset:2048 lds
    buffer_load_dwordx4 v8, s[24:27], s53 offen offset:3072 lds
    s_add_u32 m0, s50, 36864
    s_add_u32 s53, s52, 8392704
    buffer_load_dwordx4 v8, s[24:27], s53 offen offset:0 lds
    buffer_load_dwordx4 v8, s[24:27], s53 offen offset:1024 lds
    buffer_load_dwordx4 v8, s[24:27], s53 offen offset:2048 lds
    buffer_load_dwordx4 v8, s[24:27], s53 offen offset:3072 lds
k4_noffn_132:
    buffer_load_dwordx4 v[40:43], v6, s[20:23], 0 offen offset:0
    buffer_load_dwordx4 v[44:47], v6, s[20:23], 0 offen offset:512
    buffer_load_dwordx4 v[48:51], v6, s[20:23], 0 offen offset:1024
    buffer_load_dwordx4 v[52:55], v6, s[20:23], 0 offen offset:1536
    s_waitcnt vmcnt(0)
    s_branch k4_mm_123
k4_bout_124:
    v_mov_b32 v12, 69760
    ds_read_b64 v[12:13], v12
    v_lshrrev_b32 v14, 11, v6
    v_lshlrev_b32 v160, 16, v40
    v_and_b32 v161, 0xffff0000, v40
    v_lshlrev_b32 v162, 16, v41
    v_and_b32 v163, 0xffff0000, v41
    v_lshlrev_b32 v164, 16, v42
    v_and_b32 v165, 0xffff0000, v42
    v_lshlrev_b32 v166, 16, v43
    v_and_b32 v167, 0xffff0000, v43
    v_lshlrev_b32 v168, 16, v44
    v_and_b32 v169, 0xffff0000, v44
    v_lshlrev_b32 v170, 16, v45
    v_and_b32 v171, 0xffff0000, v45
    v_lshlrev_b32 v172, 16, v46
    v_and_b32 v173, 0xffff0000, v46
    v_lshlrev_b32 v174, 16, v47
    v_and_b32 v175, 0xffff0000, v47
    v_lshlrev_b32 v176, 16, v48
    v_and_b32 v177, 0xffff0000, v48
    v_lshlrev_b32 v178, 16, v49
    v_and_b32 v179, 0xffff0000, v49
    v_lshlrev_b32 v180, 16, v50
    v_and_b32 v181, 0xffff0000, v50
    v_lshlrev_b32 v182, 16, v51
    v_and_b32 v183, 0xffff0000, v51
    v_lshlrev_b32 v184, 16, v52
    v_and_b32 v185, 0xffff0000, v52
    v_lshlrev_b32 v186, 16, v53
    v_and_b32 v187, 0xffff0000, v53
    v_lshlrev_b32 v188, 16, v54
    v_and_b32 v189, 0xffff0000, v54
    v_lshlrev_b32 v190, 16, v55
    v_and_b32 v191, 0xffff0000, v55
    v_pk_add_f32 v[160:161], v[160:161], v[200:201]
    v_pk_add_f32 v[162:163], v[162:163], v[202:203]
    v_pk_add_f32 v[164:165], v[164:165], v[204:205]
    v_pk_add_f32 v[166:167], v[166:167], v[206:207]
    v_pk_add_f32 v[168:169], v[168:169], v[208:209]
    v_pk_add_f32 v[170:171], v[170:171], v[210:211]
    v_pk_add_f32 v[172:173], v[172:173], v[212:213]
    v_pk_add_f32 v[174:175], v[174:175], v[214:215]
    v_pk_add_f32 v[176:177], v[176:177], v[216:217]
    v_pk_add_f32 v[178:179], v[178:179], v[218:219]
    v_pk_add_f32 v[180:181], v[180:181], v[220:221]
    v_pk_add_f32 v[182:183], v[182:183], v[222:223]
    v_pk_add_f32 v[184:185], v[184:185], v[224:225]
    v_pk_add_f32 v[186:187], v[186:187], v[226:227]
    v_pk_add_f32 v[188:189], v[188:189], v[228:229]
    v_pk_add_f32 v[190:191], v[190:191], v[230:231]
    v_cvt_pk_bf16_f32 v40, v160, v161
    v_cvt_pk_bf16_f32 v41, v162, v163
    v_cvt_pk_bf16_f32 v42, v164, v165
    v_cvt_pk_bf16_f32 v43, v166, v167
    v_cvt_pk_bf16_f32 v44, v168, v169
    v_cvt_pk_bf16_f32 v45, v170, v171
    v_cvt_pk_bf16_f32 v46, v172, v173
    v_cvt_pk_bf16_f32 v47, v174, v175
    v_cvt_pk_bf16_f32 v48, v176, v177
    v_cvt_pk_bf16_f32 v49, v178, v179
    v_cvt_pk_bf16_f32 v50, v180, v181
    v_cvt_pk_bf16_f32 v51, v182, v183
    v_cvt_pk_bf16_f32 v52, v184, v185
    v_cvt_pk_bf16_f32 v53, v186, v187
    v_cvt_pk_bf16_f32 v54, v188, v189
    v_cvt_pk_bf16_f32 v55, v190, v191
    s_waitcnt lgkmcnt(0)
    v_cmp_eq_u32 vcc, v12, v14
    v_cmp_eq_u32 s[52:53], v13, v14
    v_mov_b32 v12, 0x7fffffff
    s_or_b64 vcc, vcc, s[52:53]
    v_cndmask_b32 v6, v6, v12, vcc
    buffer_store_dwordx4 v[40:43], v6, s[36:39], 0 offen offset:0 sc1
    buffer_store_dwordx4 v[44:47], v6, s[36:39], 0 offen offset:512 sc1
    buffer_store_dwordx4 v[48:51], v6, s[36:39], 0 offen offset:1024 sc1
    buffer_store_dwordx4 v[52:55], v6, s[36:39], 0 offen offset:1536 sc1
k4_end_120:
    s_endpgm
code_end:
    s_endpgm
.section .rodata,"a"
.p2align 6
.amdhsa_kernel k12_kernel
  .amdhsa_next_free_vgpr 512
  .amdhsa_next_free_sgpr 102
  .amdhsa_accum_offset 256
  .amdhsa_group_segment_fixed_size 0
  .amdhsa_kernarg_size 112
  .amdhsa_user_sgpr_count 2
  .amdhsa_user_sgpr_kernarg_segment_ptr 1
  .amdhsa_system_sgpr_workgroup_id_x 1
.end_amdhsa_kernel
.p2align 6
.amdhsa_kernel k3_kernel
  .amdhsa_next_free_vgpr 348
  .amdhsa_next_free_sgpr 102
  .amdhsa_accum_offset 156
  .amdhsa_group_segment_fixed_size 0
  .amdhsa_kernarg_size 112
  .amdhsa_user_sgpr_count 2
  .amdhsa_user_sgpr_kernarg_segment_ptr 1
  .amdhsa_system_sgpr_workgroup_id_x 1
.end_amdhsa_kernel
.p2align 6
.amdhsa_kernel k4_kernel
  .amdhsa_next_free_vgpr 232
  .amdhsa_next_free_sgpr 102
  .amdhsa_accum_offset 232
  .amdhsa_group_segment_fixed_size 0
  .amdhsa_kernarg_size 112
  .amdhsa_user_sgpr_count 2
  .amdhsa_user_sgpr_kernarg_segment_ptr 1
  .amdhsa_system_sgpr_workgroup_id_x 1
  .amdhsa_float_denorm_mode_32 3
.end_amdhsa_kernel
```

```asm
; @launch kernel=k12_kernel grid=(256,1,1) block=(256,1,1) lds=163840
; @launch kernel=k3_kernel grid=(256,1,1) block=(256,1,1) lds=65536
; @launch kernel=k4_kernel grid=(256,1,1) block=(512,1,1) lds=86272
.amdgcn_target "amdgcn-amd-amdhsa--gfx950"
.text
.globl k12_kernel
.p2align 8
.type k12_kernel,@function
k12_kernel:
    s_cmp_ge_u32 s2, 256
    s_cbranch_scc1 k12_end_1
    s_load_dwordx4 s[36:39], s[0:1], 0
    s_load_dwordx4 s[40:43], s[0:1], 24
    s_load_dwordx2 s[4:5], s[0:1], 16
    s_load_dwordx4 s[60:63], s[0:1], 96
    s_lshr_b32 s59, s2, 3
    s_lshl_b32 s58, s59, 4
    v_add_u32 v6, s58, v0
    v_cmp_gt_u32 vcc, 48, v0
    v_cmp_gt_u32 s[56:57], 64, v0
    s_nop 0
    v_cndmask_b32 v6, v6, v0, vcc
    s_getpc_b64 s[52:53]
pc_2:
    s_add_u32 s52, s52, k12_code0-pc_2
    s_addc_u32 s53, s53, 0
    v_lshlrev_b32 v58, 7, v6
    v_mov_b32 v59, s53
    v_add_co_u32 v58, vcc, s52, v58
    s_nop 1
    v_addc_co_u32 v59, vcc, 0, v59, vcc
k12_code0:
    s_mov_b64 exec, s[56:57]
    s_cbranch_execz k12_nocode_3
    global_load_dword v51, v[58:59], off
k12_nocode_3:
    s_mov_b64 exec, -1
    s_and_b32 s58, s2, 7
    s_lshr_b32 s59, s2, 3
    s_and_b32 s45, s59, 7
    s_lshr_b32 s57, s59, 3
    s_and_b32 s44, s57, 1
    s_lshl_b32 s52, s58, 1
    s_add_u32 s44, s44, s52
    s_lshr_b32 s57, s57, 1
    v_lshrrev_b32 v2, 6, v0
    v_and_b32 v3, 63, v0
    v_readfirstlane_b32 s30, v2
    v_lshlrev_b32 v1, 4, v3
    v_lshrrev_b32 v60, 5, v3
    v_lshl_add_u32 v60, v2, 1, v60
    v_and_b32 v61, 31, v3
    v_lshlrev_b32 v6, 11, v60
    v_lshl_add_u32 v62, v61, 4, v6
    s_lshl_b32 s52, s2, 14
    v_lshrrev_b32 v56, 3, v3
    v_and_b32 v57, 7, v3
    v_lshrrev_b32 v58, 1, v56
    v_xor_b32 v6, v57, v58
    v_xor_b32 v7, 4, v6
    v_lshl_add_u32 v58, v2, 6, v56
    v_lshlrev_b32 v58, 10, v58
    s_lshl_b32 s47, s45, 18
    v_add_u32 v58, s47, v58
    v_lshl_add_u32 v10, v6, 4, v58
    v_lshl_add_u32 v11, v7, 4, v58
    v_add_u32 v17, 54272, v11
    v_add_u32 v16, 47104, v10
    v_add_u32 v15, 39936, v11
    v_add_u32 v14, 32768, v10
    v_add_u32 v13, 21504, v11
    v_add_u32 v12, 14336, v10
    v_add_u32 v11, 7168, v11
    v_add_u32 v10, 0, v10
    v_lshrrev_b32 v6, 5, v3
    v_bfe_u32 v7, v3, 1, 4
    v_and_b32 v59, 1, v3
    v_lshl_add_u32 v58, v2, 4, v6
    v_lshlrev_b32 v58, 13, v58
    v_lshl_add_u32 v58, v59, 4, v58
    s_lshl_b32 s47, s44, 9
    v_add_u32 v58, s47, v58
    v_xor_b32 v7, v7, v6
    v_xor_b32 v6, 0, v7
    v_lshl_add_u32 v6, v6, 5, v58
    v_add_u32 v18, 0, v6
    v_xor_b32 v6, 2, v7
    v_lshl_add_u32 v6, v6, 5, v58
    v_add_u32 v19, 15360, v6
    v_xor_b32 v6, 0, v7
    v_lshl_add_u32 v6, v6, 5, v58
    v_add_u32 v20, 30720, v6
    v_xor_b32 v6, 2, v7
    v_lshl_add_u32 v6, v6, 5, v58
    v_add_u32 v21, 46080, v6
    v_xor_b32 v6, 4, v7
    v_lshl_add_u32 v6, v6, 5, v58
    v_add_u32 v22, 65536, v6
    v_xor_b32 v6, 6, v7
    v_lshl_add_u32 v6, v6, 5, v58
    v_add_u32 v23, 80896, v6
    v_xor_b32 v6, 4, v7
    v_lshl_add_u32 v6, v6, 5, v58
    v_add_u32 v24, 96256, v6
    v_xor_b32 v6, 6, v7
    v_lshl_add_u32 v6, v6, 5, v58
    v_add_u32 v25, 111616, v6
    s_lshl_b32 s48, s30, 13
    s_mov_b32 s49, 0
    s_mov_b32 s50, 0
    s_waitcnt lgkmcnt(0)
    s_mov_b32 s24, s36
    s_and_b32 s25, s37, 0xffff
    s_mov_b32 s26, 0x400000
    s_mov_b32 s27, 0x00020000
    buffer_load_dwordx4 v[64:67], v62, s[24:27], s52 offen offset:0
    buffer_load_dwordx4 v[68:71], v62, s[24:27], s52 offen offset:512
    buffer_load_dwordx4 v[72:75], v62, s[24:27], s52 offen offset:1024
    buffer_load_dwordx4 v[76:79], v62, s[24:27], s52 offen offset:1536
    s_mov_b32 s16, s38
    s_and_b32 s17, s39, 0xffff
    s_mov_b32 s18, 0x200000
    s_mov_b32 s19, 0x00020000
    s_cmp_eq_u32 s57, 0
    s_cselect_b32 s20, s40, s42
    s_cselect_b32 s21, s41, s43
    s_and_b32 s21, s21, 0xffff
    s_mov_b32 s22, 0x400000
    s_mov_b32 s23, 0x00020000
    s_add_u32 m0, s48, 0
    s_nop 0
    buffer_load_dwordx4 v10, s[16:19], s49 offen offset:0 lds
    buffer_load_dwordx4 v11, s[16:19], s49 offen offset:1024 lds
    buffer_load_dwordx4 v12, s[16:19], s49 offen offset:2048 lds
    buffer_load_dwordx4 v13, s[16:19], s49 offen offset:3072 lds
    s_add_u32 m0, s48, 65536
    s_nop 0
    buffer_load_dwordx4 v18, s[20:23], s50 offen offset:0 lds
    buffer_load_dwordx4 v19, s[20:23], s50 offen offset:1024 lds
    buffer_load_dwordx4 v20, s[20:23], s50 offen offset:2048 lds
    buffer_load_dwordx4 v21, s[20:23], s50 offen offset:3072 lds
    s_mov_b64 s[6:7], s[62:63]
    s_add_u32 s8, s6, 0x0
    s_addc_u32 s9, s7, 0
    s_and_b32 s9, s9, 0xffff
    s_mov_b32 s10, 0x400000
    s_mov_b32 s11, 0x00020000
    s_mov_b32 s12, s4
    s_and_b32 s13, s5, 0xffff
    s_mov_b32 s14, 0x800000
    s_mov_b32 s15, 0x00020000
    s_add_u32 s32, s6, 0x1000000
    s_addc_u32 s33, s7, 0
    s_and_b32 s33, s33, 0xffff
    s_mov_b32 s34, 0x2000000
    s_mov_b32 s35, 0x00020000
    s_mov_b32 s24, s60
    s_and_b32 s25, s61, 0xffff
    s_mov_b32 s26, 0x100
    s_mov_b32 s27, 0x00020000
    s_lshl_b32 s28, s58, 2
    s_and_b32 s31, s59, 3
    s_add_u32 s28, s28, s31
    s_lshr_b32 s29, s59, 2
    s_lshl_b32 s42, s29, 7
    s_sub_u32 s43, 1920, s42
    s_lshl_b32 s31, s30, 5
    s_add_u32 s38, s42, s31
    s_add_u32 s39, s43, s31
    s_lshl_b32 s60, s30, 12
    s_mov_b32 s61, 0
    s_mov_b32 s62, 0
    s_lshl_b32 s47, s44, 1
    s_lshr_b32 s52, s30, 1
    s_add_u32 s47, s47, s52
    s_lshl_b32 s47, s47, 14
    s_lshl_b32 s52, s45, 1
    s_and_b32 s53, s30, 1
    s_add_u32 s52, s52, s53
    s_lshl_b32 s52, s52, 20
    s_add_u32 s47, s47, s52
    s_lshl_b32 s52, s57, 24
    s_add_u32 s47, s47, s52
    s_lshl_b32 s54, s44, 8
    s_lshr_b32 s55, s28, 1
    s_lshl_b32 s55, s55, 8
    s_and_b32 s53, s59, 3
    s_add_u32 s53, s53, 1
    s_cmp_eq_u32 s30, 0
    s_cselect_b32 s53, s53, -1
    s_cselect_b32 s46, 6, -1
    v_lshlrev_b32 v6, 13, v56
    v_lshl_add_u32 v50, v57, 7, v6
    s_lshl_b32 s56, s30, 5
    s_add_u32 s56, s56, s59
    s_lshl_b32 s56, s56, 16
    s_lshl_b32 s52, s58, 10
    s_add_u32 s56, s56, s52
    s_lshl_b32 s63, s30, 1
    v_mul_u32_u24 v6, 2064, v60
    v_lshl_add_u32 v6, v61, 4, v6
    v_add_u32 v54, 131072, v6
    v_mul_u32_u24 v7, 2064, v57
    v_lshl_add_u32 v7, v56, 4, v7
    v_lshl_add_u32 v7, v2, 9, v7
    v_add_u32 v55, 131072, v7
    v_lshrrev_b32 v7, 2, v56
    v_lshl_add_u32 v7, v2, 3, v7
    v_lshlrev_b32 v7, 17, v7
    v_and_b32 v6, 3, v56
    v_lshl_add_u32 v7, v6, 8, v7
    v_lshl_add_u32 v7, v57, 4, v7
    s_lshr_b32 s52, s2, 1
    s_lshl_b32 s52, s52, 10
    s_and_b32 s31, s2, 1
    s_lshl_b32 s31, s31, 7
    s_add_u32 s52, s52, s31
    v_add_u32 v53, s52, v7
    v_and_b32 v56, 15, v3
    v_lshrrev_b32 v57, 4, v3
    v_lshrrev_b32 v6, 1, v56
    v_xor_b32 v6, v6, v57
    v_and_b32 v7, 1, v2
    v_lshl_add_u32 v7, v7, 7, v56
    v_lshlrev_b32 v7, 7, v7
    v_lshl_add_u32 v26, v6, 4, v7
    v_xor_b32 v27, 64, v26
    v_lshrrev_b32 v6, 2, v56
    v_and_b32 v58, 1, v57
    v_lshl_add_u32 v58, v58, 2, v6
    v_lshl_add_u32 v59, v57, 3, v6
    v_and_b32 v63, 3, v3
    v_lshlrev_b32 v7, 9, v59
    v_lshrrev_b32 v6, 1, v2
    v_lshl_add_u32 v7, v6, 8, v7
    v_lshl_add_u32 v7, v63, 3, v7
    v_add_u32 v7, 65536, v7
    v_lshlrev_b32 v59, 8, v59
    v_lshl_add_u32 v59, v63, 3, v59
    v_add_u32 v59, 98304, v59
    v_xor_b32 v6, 0, v58
    v_lshl_add_u32 v28, v6, 5, v7
    v_lshl_add_u32 v42, v6, 5, v59
    v_xor_b32 v6, 1, v58
    v_lshl_add_u32 v29, v6, 5, v7
    v_lshl_add_u32 v43, v6, 5, v59
    v_xor_b32 v6, 2, v58
    v_lshl_add_u32 v30, v6, 5, v7
    v_lshl_add_u32 v44, v6, 5, v59
    v_xor_b32 v6, 3, v58
    v_lshl_add_u32 v31, v6, 5, v7
    v_lshl_add_u32 v45, v6, 5, v59
    v_xor_b32 v6, 4, v58
    v_lshl_add_u32 v32, v6, 5, v7
    v_lshl_add_u32 v46, v6, 5, v59
    v_xor_b32 v6, 5, v58
    v_lshl_add_u32 v33, v6, 5, v7
    v_lshl_add_u32 v47, v6, 5, v59
    v_xor_b32 v6, 6, v58
    v_lshl_add_u32 v34, v6, 5, v7
    v_lshl_add_u32 v48, v6, 5, v59
    v_xor_b32 v6, 7, v58
    v_lshl_add_u32 v35, v6, 5, v7
    v_lshl_add_u32 v49, v6, 5, v59
    s_lshl_b32 s31, s38, 6
    v_add_u32 v36, s31, v1
    s_lshl_b32 s31, s39, 6
    v_add_u32 v37, s31, v1
    v_bfe_u32 v6, v3, 1, 3
    v_and_b32 v7, 1, v3
    v_lshl_add_u32 v58, v2, 4, v57
    v_lshlrev_b32 v58, 13, v58
    v_lshl_add_u32 v58, v7, 4, v58
    s_lshl_b32 s31, s28, 8
    v_add_u32 v58, s31, v58
    v_xor_b32 v6, v6, v57
    v_xor_b32 v7, 0, v6
    v_lshl_add_u32 v7, v7, 5, v58
    v_add_u32 v38, 0, v7
    v_xor_b32 v7, 0, v6
    v_lshl_add_u32 v7, v7, 5, v58
    v_add_u32 v39, 31744, v7
    v_xor_b32 v7, 4, v6
    v_lshl_add_u32 v7, v7, 5, v58
    v_add_u32 v40, 63488, v7
    v_xor_b32 v7, 4, v6
    v_lshl_add_u32 v7, v7, 5, v58
    v_add_u32 v41, 95232, v7
    v_lshlrev_b32 v6, 2, v57
    v_sub_u32 v4, v56, v6
    v_mov_b32 v5, 0xff800000
    v_mov_b32 v8, 0
    v_mov_b32 v9, 1
    s_lshl_b32 s52, s59, 2
    s_add_u32 s52, s52, s30
    v_and_b32 v6, 1, v3
    v_lshl_add_u32 v6, s52, 1, v6
    s_getpc_b64 s[40:41]
pc_4:
    s_add_u32 s40, s40, k12_qcode-pc_4
    s_addc_u32 s41, s41, 0
    v_lshlrev_b32 v2, 7, v6
    v_mov_b32 v3, s41
    v_add_co_u32 v2, vcc, s40, v2
    s_nop 1
    v_addc_co_u32 v3, vcc, 0, v3, vcc
    v_mov_b32 v56, 0
    v_mov_b32 v57, 0
    v_mov_b32 v58, 0
    v_mov_b32 v59, 0
    s_nop 1
    v_mfma_f32_32x32x16_bf16 a[128:143], v[56:59], v[56:59], 0
    v_mfma_f32_32x32x16_bf16 a[144:159], v[56:59], v[56:59], 0
    v_mfma_f32_32x32x16_bf16 a[160:175], v[56:59], v[56:59], 0
    v_mfma_f32_32x32x16_bf16 a[176:191], v[56:59], v[56:59], 0
    v_mfma_f32_32x32x16_bf16 v[128:143], v[56:59], v[56:59], 0
    v_mfma_f32_32x32x16_bf16 v[144:159], v[56:59], v[56:59], 0
    v_mfma_f32_32x32x16_bf16 v[160:175], v[56:59], v[56:59], 0
    v_mfma_f32_32x32x16_bf16 v[176:191], v[56:59], v[56:59], 0
    v_mfma_f32_32x32x16_bf16 v[192:207], v[56:59], v[56:59], 0
    v_mfma_f32_32x32x16_bf16 v[208:223], v[56:59], v[56:59], 0
    v_mfma_f32_32x32x16_bf16 v[224:239], v[56:59], v[56:59], 0
    v_mfma_f32_32x32x16_bf16 v[240:255], v[56:59], v[56:59], 0
    s_add_u32 m0, s48, 4096
    s_nop 0
    buffer_load_dwordx4 v14, s[16:19], s49 offen offset:0 lds
    buffer_load_dwordx4 v15, s[16:19], s49 offen offset:1024 lds
    buffer_load_dwordx4 v16, s[16:19], s49 offen offset:2048 lds
    buffer_load_dwordx4 v17, s[16:19], s49 offen offset:3072 lds
    s_add_u32 s49, s49, 128
    s_add_u32 m0, s48, 69632
    s_nop 0
    buffer_load_dwordx4 v22, s[20:23], s50 offen offset:0 lds
    buffer_load_dwordx4 v23, s[20:23], s50 offen offset:1024 lds
    buffer_load_dwordx4 v24, s[20:23], s50 offen offset:2048 lds
    buffer_load_dwordx4 v25, s[20:23], s50 offen offset:3072 lds
    s_add_u32 s50, s50, 0x80000
    s_waitcnt vmcnt(16)
    v_lshlrev_b32 v80, 16, v64
    v_and_b32 v81, 0xffff0000, v64
    v_lshlrev_b32 v82, 16, v65
    v_and_b32 v83, 0xffff0000, v65
    v_lshlrev_b32 v84, 16, v66
    v_and_b32 v85, 0xffff0000, v66
    v_lshlrev_b32 v86, 16, v67
    v_and_b32 v87, 0xffff0000, v67
    v_lshlrev_b32 v88, 16, v68
    v_and_b32 v89, 0xffff0000, v68
    v_lshlrev_b32 v90, 16, v69
    v_and_b32 v91, 0xffff0000, v69
    v_lshlrev_b32 v92, 16, v70
    v_and_b32 v93, 0xffff0000, v70
    v_lshlrev_b32 v94, 16, v71
    v_and_b32 v95, 0xffff0000, v71
    v_lshlrev_b32 v96, 16, v72
    v_and_b32 v97, 0xffff0000, v72
    v_lshlrev_b32 v98, 16, v73
    v_and_b32 v99, 0xffff0000, v73
    v_lshlrev_b32 v100, 16, v74
    v_and_b32 v101, 0xffff0000, v74
    v_lshlrev_b32 v102, 16, v75
    v_and_b32 v103, 0xffff0000, v75
    v_lshlrev_b32 v104, 16, v76
    v_and_b32 v105, 0xffff0000, v76
    v_lshlrev_b32 v106, 16, v77
    v_and_b32 v107, 0xffff0000, v77
    v_lshlrev_b32 v108, 16, v78
    v_and_b32 v109, 0xffff0000, v78
    v_lshlrev_b32 v110, 16, v79
    v_and_b32 v111, 0xffff0000, v79
    v_pk_add_f32 v[112:113], v[80:81], v[82:83]
    v_pk_add_f32 v[114:115], v[84:85], v[86:87]
    v_pk_add_f32 v[112:113], v[112:113], v[88:89]
    v_pk_add_f32 v[114:115], v[114:115], v[90:91]
    v_pk_add_f32 v[112:113], v[112:113], v[92:93]
    v_pk_add_f32 v[114:115], v[114:115], v[94:95]
    v_pk_add_f32 v[112:113], v[112:113], v[96:97]
    v_pk_add_f32 v[114:115], v[114:115], v[98:99]
    v_pk_add_f32 v[112:113], v[112:113], v[100:101]
    v_pk_add_f32 v[114:115], v[114:115], v[102:103]
    v_pk_add_f32 v[112:113], v[112:113], v[104:105]
    v_pk_add_f32 v[114:115], v[114:115], v[106:107]
    s_add_u32 m0, s48, 32768
    s_nop 0
    buffer_load_dwordx4 v10, s[16:19], s49 offen offset:0 lds
    buffer_load_dwordx4 v11, s[16:19], s49 offen offset:1024 lds
    buffer_load_dwordx4 v12, s[16:19], s49 offen offset:2048 lds
    buffer_load_dwordx4 v13, s[16:19], s49 offen offset:3072 lds
    v_pk_add_f32 v[112:113], v[112:113], v[108:109]
    v_pk_add_f32 v[114:115], v[114:115], v[110:111]
    v_pk_add_f32 v[112:113], v[112:113], v[114:115]
    v_add_f32 v112, v112, v113
    s_nop 1
    v_add_f32_dpp v112, v112, v112 quad_perm:[1,0,3,2] row_mask:0xf bank_mask:0xf
    s_nop 1
    v_add_f32_dpp v112, v112, v112 quad_perm:[2,3,0,1] row_mask:0xf bank_mask:0xf
    s_nop 1
    v_add_f32_dpp v112, v112, v112 row_half_mirror row_mask:0xf bank_mask:0xf
    s_nop 1
    v_add_f32_dpp v112, v112, v112 row_mirror row_mask:0xf bank_mask:0xf
    v_mov_b32 v114, v112
    s_nop 1
    v_permlane16_swap_b32 v112, v114
    s_nop 1
    v_add_f32 v112, v112, v114
    v_mul_f32 v112, 0xba800000, v112
    v_mov_b32 v113, v112
    v_pk_add_f32 v[114:115], v[80:81], v[112:113]
    v_pk_add_f32 v[118:119], v[82:83], v[112:113]
    v_pk_mul_f32 v[116:117], v[114:115], v[114:115]
    v_pk_fma_f32 v[116:117], v[118:119], v[118:119], v[116:117]
    v_pk_add_f32 v[114:115], v[84:85], v[112:113]
    v_pk_add_f32 v[118:119], v[86:87], v[112:113]
    v_pk_fma_f32 v[116:117], v[114:115], v[114:115], v[116:117]
    v_pk_fma_f32 v[116:117], v[118:119], v[118:119], v[116:117]
    v_pk_add_f32 v[114:115], v[88:89], v[112:113]
    v_pk_add_f32 v[118:119], v[90:91], v[112:113]
    v_pk_fma_f32 v[116:117], v[114:115], v[114:115], v[116:117]
    v_pk_fma_f32 v[116:117], v[118:119], v[118:119], v[116:117]
    v_pk_add_f32 v[114:115], v[92:93], v[112:113]
    v_pk_add_f32 v[118:119], v[94:95], v[112:113]
    v_pk_fma_f32 v[116:117], v[114:115], v[114:115], v[116:117]
    v_pk_fma_f32 v[116:117], v[118:119], v[118:119], v[116:117]
    v_pk_add_f32 v[114:115], v[96:97], v[112:113]
    v_pk_add_f32 v[118:119], v[98:99], v[112:113]
    v_pk_fma_f32 v[116:117], v[114:115], v[114:115], v[116:117]
    v_pk_fma_f32 v[116:117], v[118:119], v[118:119], v[116:117]
    v_pk_add_f32 v[114:115], v[100:101], v[112:113]
    v_pk_add_f32 v[118:119], v[102:103], v[112:113]
    v_pk_fma_f32 v[116:117], v[114:115], v[114:115], v[116:117]
    v_pk_fma_f32 v[116:117], v[118:119], v[118:119], v[116:117]
    v_pk_add_f32 v[114:115], v[104:105], v[112:113]
    s_add_u32 m0, s48, 98304
    s_nop 0
    buffer_load_dwordx4 v18, s[20:23], s50 offen offset:0 lds
    buffer_load_dwordx4 v19, s[20:23], s50 offen offset:1024 lds
    buffer_load_dwordx4 v20, s[20:23], s50 offen offset:2048 lds
    buffer_load_dwordx4 v21, s[20:23], s50 offen offset:3072 lds
    v_pk_add_f32 v[118:119], v[106:107], v[112:113]
    v_pk_fma_f32 v[116:117], v[114:115], v[114:115], v[116:117]
    v_pk_fma_f32 v[116:117], v[118:119], v[118:119], v[116:117]
    v_pk_add_f32 v[114:115], v[108:109], v[112:113]
    v_pk_add_f32 v[118:119], v[110:111], v[112:113]
    v_pk_fma_f32 v[116:117], v[114:115], v[114:115], v[116:117]
    v_pk_fma_f32 v[116:117], v[118:119], v[118:119], v[116:117]
    v_add_f32 v116, v116, v117
    s_nop 1
    v_add_f32_dpp v116, v116, v116 quad_perm:[1,0,3,2] row_mask:0xf bank_mask:0xf
    s_nop 1
    v_add_f32_dpp v116, v116, v116 quad_perm:[2,3,0,1] row_mask:0xf bank_mask:0xf
    s_nop 1
    v_add_f32_dpp v116, v116, v116 row_half_mirror row_mask:0xf bank_mask:0xf
    s_nop 1
    v_add_f32_dpp v116, v116, v116 row_mirror row_mask:0xf bank_mask:0xf
    v_mov_b32 v114, v116
    s_nop 1
    v_permlane16_swap_b32 v116, v114
    s_nop 1
    v_add_f32 v116, v116, v114
    v_mul_f32 v116, 0x3a800000, v116
    v_cvt_pk_bf16_f32 v118, v112, v116
    v_and_b32 v116, 0xffff0000, v118
    v_lshlrev_b32 v118, 16, v118
    v_add_f32 v116, 0x3727c5ac, v116
    v_mov_b32 v119, v118
    v_cvt_pk_bf16_f32 v116, v116, v116
    v_and_b32 v116, 0xffff0000, v116
    v_sqrt_f32 v116, v116
    v_pk_add_f32 v[80:81], v[80:81], v[118:119]
    v_pk_add_f32 v[82:83], v[82:83], v[118:119]
    v_pk_add_f32 v[84:85], v[84:85], v[118:119]
    v_pk_add_f32 v[86:87], v[86:87], v[118:119]
    v_pk_add_f32 v[88:89], v[88:89], v[118:119]
    v_pk_add_f32 v[90:91], v[90:91], v[118:119]
    v_pk_add_f32 v[92:93], v[92:93], v[118:119]
    v_pk_add_f32 v[94:95], v[94:95], v[118:119]
    v_pk_add_f32 v[96:97], v[96:97], v[118:119]
    v_pk_add_f32 v[98:99], v[98:99], v[118:119]
    v_pk_add_f32 v[100:101], v[100:101], v[118:119]
    v_pk_add_f32 v[102:103], v[102:103], v[118:119]
    v_pk_add_f32 v[104:105], v[104:105], v[118:119]
    s_add_u32 m0, s48, 36864
    s_nop 0
    buffer_load_dwordx4 v14, s[16:19], s49 offen offset:0 lds
    buffer_load_dwordx4 v15, s[16:19], s49 offen offset:1024 lds
    buffer_load_dwordx4 v16, s[16:19], s49 offen offset:2048 lds
    buffer_load_dwordx4 v17, s[16:19], s49 offen offset:3072 lds
    s_add_u32 s49, s49, 128
    v_pk_add_f32 v[106:107], v[106:107], v[118:119]
    v_pk_add_f32 v[108:109], v[108:109], v[118:119]
    v_pk_add_f32 v[110:111], v[110:111], v[118:119]
    v_cvt_pk_bf16_f32 v116, v116, v116
    v_and_b32 v116, 0xffff0000, v116
    v_rcp_f32 v116, v116
    v_cvt_pk_bf16_f32 v64, v80, v81
    v_cvt_pk_bf16_f32 v65, v82, v83
    v_cvt_pk_bf16_f32 v66, v84, v85
    v_cvt_pk_bf16_f32 v67, v86, v87
    v_cvt_pk_bf16_f32 v68, v88, v89
    v_cvt_pk_bf16_f32 v69, v90, v91
    v_cvt_pk_bf16_f32 v70, v92, v93
    v_cvt_pk_bf16_f32 v71, v94, v95
    v_cvt_pk_bf16_f32 v72, v96, v97
    v_cvt_pk_bf16_f32 v73, v98, v99
    v_cvt_pk_bf16_f32 v74, v100, v101
    v_cvt_pk_bf16_f32 v75, v102, v103
    v_cvt_pk_bf16_f32 v76, v104, v105
    v_cvt_pk_bf16_f32 v77, v106, v107
    v_cvt_pk_bf16_f32 v78, v108, v109
    v_cvt_pk_bf16_f32 v79, v110, v111
    v_mov_b32 v117, v116
    v_lshlrev_b32 v80, 16, v64
    v_and_b32 v81, 0xffff0000, v64
    v_lshlrev_b32 v82, 16, v65
    v_and_b32 v83, 0xffff0000, v65
    v_lshlrev_b32 v84, 16, v66
    v_and_b32 v85, 0xffff0000, v66
    v_lshlrev_b32 v86, 16, v67
    v_and_b32 v87, 0xffff0000, v67
    v_lshlrev_b32 v88, 16, v68
    v_and_b32 v89, 0xffff0000, v68
    v_lshlrev_b32 v90, 16, v69
    v_and_b32 v91, 0xffff0000, v69
    v_lshlrev_b32 v92, 16, v70
    v_and_b32 v93, 0xffff0000, v70
    v_lshlrev_b32 v94, 16, v71
    v_and_b32 v95, 0xffff0000, v71
    v_lshlrev_b32 v96, 16, v72
    v_and_b32 v97, 0xffff0000, v72
    v_lshlrev_b32 v98, 16, v73
    v_and_b32 v99, 0xffff0000, v73
    v_lshlrev_b32 v100, 16, v74
    s_add_u32 m0, s48, 102400
    s_nop 0
    buffer_load_dwordx4 v22, s[20:23], s50 offen offset:0 lds
    buffer_load_dwordx4 v23, s[20:23], s50 offen offset:1024 lds
    buffer_load_dwordx4 v24, s[20:23], s50 offen offset:2048 lds
    buffer_load_dwordx4 v25, s[20:23], s50 offen offset:3072 lds
    s_add_u32 s50, s50, 0x80000
    v_and_b32 v101, 0xffff0000, v74
    v_lshlrev_b32 v102, 16, v75
    v_and_b32 v103, 0xffff0000, v75
    v_lshlrev_b32 v104, 16, v76
    v_and_b32 v105, 0xffff0000, v76
    v_lshlrev_b32 v106, 16, v77
    v_and_b32 v107, 0xffff0000, v77
    v_lshlrev_b32 v108, 16, v78
    v_and_b32 v109, 0xffff0000, v78
    v_lshlrev_b32 v110, 16, v79
    v_and_b32 v111, 0xffff0000, v79
    v_pk_mul_f32 v[80:81], v[80:81], v[116:117]
    v_pk_mul_f32 v[82:83], v[82:83], v[116:117]
    v_pk_mul_f32 v[84:85], v[84:85], v[116:117]
    v_pk_mul_f32 v[86:87], v[86:87], v[116:117]
    v_pk_mul_f32 v[88:89], v[88:89], v[116:117]
    v_pk_mul_f32 v[90:91], v[90:91], v[116:117]
    v_pk_mul_f32 v[92:93], v[92:93], v[116:117]
    v_pk_mul_f32 v[94:95], v[94:95], v[116:117]
    v_pk_mul_f32 v[96:97], v[96:97], v[116:117]
    v_pk_mul_f32 v[98:99], v[98:99], v[116:117]
    v_pk_mul_f32 v[100:101], v[100:101], v[116:117]
    v_pk_mul_f32 v[102:103], v[102:103], v[116:117]
    v_pk_mul_f32 v[104:105], v[104:105], v[116:117]
    v_pk_mul_f32 v[106:107], v[106:107], v[116:117]
    v_pk_mul_f32 v[108:109], v[108:109], v[116:117]
    v_pk_mul_f32 v[110:111], v[110:111], v[116:117]
    v_cvt_pk_bf16_f32 v64, v80, v81
    v_cvt_pk_bf16_f32 v65, v82, v83
    v_cvt_pk_bf16_f32 v66, v84, v85
    v_cvt_pk_bf16_f32 v67, v86, v87
    v_cvt_pk_bf16_f32 v68, v88, v89
    v_cvt_pk_bf16_f32 v69, v90, v91
    v_cvt_pk_bf16_f32 v70, v92, v93
    v_cvt_pk_bf16_f32 v71, v94, v95
    v_cvt_pk_bf16_f32 v72, v96, v97
    v_cvt_pk_bf16_f32 v73, v98, v99
    v_cvt_pk_bf16_f32 v74, v100, v101
    v_cvt_pk_bf16_f32 v75, v102, v103
    v_cvt_pk_bf16_f32 v76, v104, v105
    v_cvt_pk_bf16_f32 v77, v106, v107
    v_cvt_pk_bf16_f32 v78, v108, v109
    v_cvt_pk_bf16_f32 v79, v110, v111
    ds_write_b128 v54, v[64:67] offset:0
    ds_write_b128 v54, v[68:71] offset:512
    ds_write_b128 v54, v[72:75] offset:1024
    ds_write_b128 v54, v[76:79] offset:1536
    s_waitcnt vmcnt(16) lgkmcnt(0)
    s_barrier
    ds_read_b128 a[192:195], v55 offset:0
    ds_read_b128 a[196:199], v55 offset:128
    ds_read_b128 a[200:203], v55 offset:256
    ds_read_b128 a[204:207], v55 offset:384
    v_mfma_f32_32x32x16_bf16 v[64:79], v[56:59], v[56:59], 0
    v_mfma_f32_32x32x16_bf16 v[80:95], v[56:59], v[56:59], 0
    v_mfma_f32_32x32x16_bf16 v[96:111], v[56:59], v[56:59], 0
    v_mfma_f32_32x32x16_bf16 v[112:127], v[56:59], v[56:59], 0
    s_cmp_ge_u32 s2, 17
    s_cbranch_scc1 k12_nostat_5
    s_lshl_b32 s52, s2, 12
    s_add_u32 s52, s52, 0x3800000
    s_mov_b32 s34, -1
    v_lshlrev_b32 v6, 4, v0
    buffer_store_dwordx4 v[56:59], v6, s[32:35], s52 offen sc1
    s_mov_b32 s34, 0x2000000
k12_nostat_5:
    ds_read_b128 a[0:3], v26 offset:0
    ds_read_b64_tr_b16 a[32:33], v28 offset:0
    ds_read_b64_tr_b16 a[34:35], v28 offset:2048
    ds_read_b128 a[4:7], v26 offset:2048
    ds_read_b64_tr_b16 a[36:37], v29 offset:0
    ds_read_b64_tr_b16 a[38:39], v29 offset:2048
    ds_read_b128 a[8:11], v26 offset:4096
    ds_read_b64_tr_b16 a[40:41], v30 offset:0
    ds_read_b64_tr_b16 a[42:43], v30 offset:2048
    ds_read_b128 a[12:15], v26 offset:6144
    ds_read_b64_tr_b16 a[44:45], v31 offset:0
    ds_read_b64_tr_b16 a[46:47], v31 offset:2048
    ds_read_b128 a[16:19], v26 offset:8192
    ds_read_b64_tr_b16 a[48:49], v32 offset:0
    ds_read_b64_tr_b16 a[50:51], v32 offset:2048
    ds_read_b128 a[20:23], v26 offset:10240
    ds_read_b64_tr_b16 a[52:53], v33 offset:0
    ds_read_b64_tr_b16 a[54:55], v33 offset:2048
    ds_read_b128 a[24:27], v26 offset:12288
    ds_read_b64_tr_b16 a[56:57], v34 offset:0
    ds_read_b64_tr_b16 a[58:59], v34 offset:2048
    ds_read_b128 a[28:31], v26 offset:14336
    ds_read_b64_tr_b16 a[60:61], v35 offset:0
    ds_read_b64_tr_b16 a[62:63], v35 offset:2048
    s_mov_b32 s51, 0
    s_waitcnt lgkmcnt(15)
    s_mov_b32 s52, 0
    buffer_store_dwordx4 a[192:195], v53, s[8:11], s52 offen sc1
    s_mov_b32 s52, 262144
    buffer_store_dwordx4 a[196:199], v53, s[8:11], s52 offen sc1
    s_mov_b32 s52, 524288
    buffer_store_dwordx4 a[200:203], v53, s[8:11], s52 offen sc1
    s_mov_b32 s52, 786432
    buffer_store_dwordx4 a[204:207], v53, s[8:11], s52 offen sc1
    s_waitcnt lgkmcnt(0)
    s_cmp_lg_u32 s57, 0
    s_cbranch_scc1 k12_v_6
k12_loop_8:
    v_mfma_f32_16x16x32_bf16 v[64:67], a[32:35], a[0:3], v[64:67]
    ds_read_b128 a[64:67], v27 offset:0
    v_mfma_f32_16x16x32_bf16 v[80:83], a[32:35], a[4:7], v[80:83]
    ds_read_b64_tr_b16 a[96:97], v28 offset:16384
    v_mfma_f32_16x16x32_bf16 v[96:99], a[32:35], a[8:11], v[96:99]
    v_mfma_f32_16x16x32_bf16 v[112:115], a[32:35], a[12:15], v[112:115]
    s_cmp_eq_u32 s51, s46
    s_cbranch_scc1 k12_ool_10
k12_oolret_11:
    v_mfma_f32_16x16x32_bf16 v[128:131], a[32:35], a[16:19], v[128:131]
    ds_read_b64_tr_b16 a[98:99], v28 offset:18432
    v_mfma_f32_16x16x32_bf16 v[144:147], a[32:35], a[20:23], v[144:147]
    ds_read_b128 a[68:71], v27 offset:2048
    v_mfma_f32_16x16x32_bf16 a[128:131], a[32:35], a[24:27], a[128:131]
    v_mfma_f32_16x16x32_bf16 a[160:163], a[32:35], a[28:31], a[160:163]
    ds_read_b64_tr_b16 a[100:101], v29 offset:16384
    v_mfma_f32_16x16x32_bf16 v[160:163], a[36:39], a[0:3], v[160:163]
    v_mfma_f32_16x16x32_bf16 v[176:179], a[36:39], a[4:7], v[176:179]
    ds_read_b64_tr_b16 a[102:103], v29 offset:18432
    v_mfma_f32_16x16x32_bf16 v[192:195], a[36:39], a[8:11], v[192:195]
    v_mfma_f32_16x16x32_bf16 v[208:211], a[36:39], a[12:15], v[208:211]
    ds_read_b128 a[72:75], v27 offset:4096
    v_mfma_f32_16x16x32_bf16 v[224:227], a[36:39], a[16:19], v[224:227]
    v_mfma_f32_16x16x32_bf16 v[240:243], a[36:39], a[20:23], v[240:243]
    v_mfma_f32_16x16x32_bf16 a[132:135], a[36:39], a[24:27], a[132:135]
    ds_read_b64_tr_b16 a[104:105], v30 offset:16384
    v_mfma_f32_16x16x32_bf16 a[164:167], a[36:39], a[28:31], a[164:167]
    v_mfma_f32_16x16x32_bf16 v[68:71], a[40:43], a[0:3], v[68:71]
    ds_read_b64_tr_b16 a[106:107], v30 offset:18432
    v_mfma_f32_16x16x32_bf16 v[84:87], a[40:43], a[4:7], v[84:87]
    v_mfma_f32_16x16x32_bf16 v[100:103], a[40:43], a[8:11], v[100:103]
    ds_read_b128 a[76:79], v27 offset:6144
    v_mfma_f32_16x16x32_bf16 v[116:119], a[40:43], a[12:15], v[116:119]
    v_mfma_f32_16x16x32_bf16 v[132:135], a[40:43], a[16:19], v[132:135]
    ds_read_b64_tr_b16 a[108:109], v31 offset:16384
    v_mfma_f32_16x16x32_bf16 v[148:151], a[40:43], a[20:23], v[148:151]
    v_mfma_f32_16x16x32_bf16 a[136:139], a[40:43], a[24:27], a[136:139]
    ds_read_b64_tr_b16 a[110:111], v31 offset:18432
    v_mfma_f32_16x16x32_bf16 a[168:171], a[40:43], a[28:31], a[168:171]
    v_mfma_f32_16x16x32_bf16 v[164:167], a[44:47], a[0:3], v[164:167]
    ds_read_b128 a[80:83], v27 offset:8192
    v_mfma_f32_16x16x32_bf16 v[180:183], a[44:47], a[4:7], v[180:183]
    v_mfma_f32_16x16x32_bf16 v[196:199], a[44:47], a[8:11], v[196:199]
    ds_read_b64_tr_b16 a[112:113], v32 offset:16384
    v_mfma_f32_16x16x32_bf16 v[212:215], a[44:47], a[12:15], v[212:215]
    v_mfma_f32_16x16x32_bf16 v[228:231], a[44:47], a[16:19], v[228:231]
    ds_read_b64_tr_b16 a[114:115], v32 offset:18432
    v_mfma_f32_16x16x32_bf16 v[244:247], a[44:47], a[20:23], v[244:247]
    v_mfma_f32_16x16x32_bf16 a[140:143], a[44:47], a[24:27], a[140:143]
    ds_read_b128 a[84:87], v27 offset:10240
    v_mfma_f32_16x16x32_bf16 a[172:175], a[44:47], a[28:31], a[172:175]
    v_mfma_f32_16x16x32_bf16 v[72:75], a[48:51], a[0:3], v[72:75]
    ds_read_b64_tr_b16 a[116:117], v33 offset:16384
    v_mfma_f32_16x16x32_bf16 v[88:91], a[48:51], a[4:7], v[88:91]
    v_mfma_f32_16x16x32_bf16 v[104:107], a[48:51], a[8:11], v[104:107]
    ds_read_b64_tr_b16 a[118:119], v33 offset:18432
    v_mfma_f32_16x16x32_bf16 v[120:123], a[48:51], a[12:15], v[120:123]
    v_mfma_f32_16x16x32_bf16 v[136:139], a[48:51], a[16:19], v[136:139]
    ds_read_b128 a[88:91], v27 offset:12288
    v_mfma_f32_16x16x32_bf16 v[152:155], a[48:51], a[20:23], v[152:155]
    v_mfma_f32_16x16x32_bf16 a[144:147], a[48:51], a[24:27], a[144:147]
    v_mfma_f32_16x16x32_bf16 a[176:179], a[48:51], a[28:31], a[176:179]
    ds_read_b64_tr_b16 a[120:121], v34 offset:16384
    v_mfma_f32_16x16x32_bf16 v[168:171], a[52:55], a[0:3], v[168:171]
    v_mfma_f32_16x16x32_bf16 v[184:187], a[52:55], a[4:7], v[184:187]
    ds_read_b64_tr_b16 a[122:123], v34 offset:18432
    v_mfma_f32_16x16x32_bf16 v[200:203], a[52:55], a[8:11], v[200:203]
    v_mfma_f32_16x16x32_bf16 v[216:219], a[52:55], a[12:15], v[216:219]
    ds_read_b128 a[92:95], v27 offset:14336
    v_mfma_f32_16x16x32_bf16 v[232:235], a[52:55], a[16:19], v[232:235]
    v_mfma_f32_16x16x32_bf16 v[248:251], a[52:55], a[20:23], v[248:251]
    ds_read_b64_tr_b16 a[124:125], v35 offset:16384
    v_mfma_f32_16x16x32_bf16 a[148:151], a[52:55], a[24:27], a[148:151]
    v_mfma_f32_16x16x32_bf16 a[180:183], a[52:55], a[28:31], a[180:183]
    ds_read_b64_tr_b16 a[126:127], v35 offset:18432
    v_mfma_f32_16x16x32_bf16 v[76:79], a[56:59], a[0:3], v[76:79]
    v_mfma_f32_16x16x32_bf16 v[92:95], a[56:59], a[4:7], v[92:95]
    v_mfma_f32_16x16x32_bf16 v[108:111], a[56:59], a[8:11], v[108:111]
    v_mfma_f32_16x16x32_bf16 v[124:127], a[56:59], a[12:15], v[124:127]
    v_mfma_f32_16x16x32_bf16 v[140:143], a[56:59], a[16:19], v[140:143]
    v_mfma_f32_16x16x32_bf16 v[156:159], a[56:59], a[20:23], v[156:159]
    v_mfma_f32_16x16x32_bf16 a[152:155], a[56:59], a[24:27], a[152:155]
    v_mfma_f32_16x16x32_bf16 a[184:187], a[56:59], a[28:31], a[184:187]
    v_mfma_f32_16x16x32_bf16 v[172:175], a[60:63], a[0:3], v[172:175]
    v_mfma_f32_16x16x32_bf16 v[188:191], a[60:63], a[4:7], v[188:191]
    v_mfma_f32_16x16x32_bf16 v[204:207], a[60:63], a[8:11], v[204:207]
    v_mfma_f32_16x16x32_bf16 v[220:223], a[60:63], a[12:15], v[220:223]
    v_mfma_f32_16x16x32_bf16 v[236:239], a[60:63], a[16:19], v[236:239]
    v_mfma_f32_16x16x32_bf16 v[252:255], a[60:63], a[20:23], v[252:255]
    v_mfma_f32_16x16x32_bf16 a[156:159], a[60:63], a[24:27], a[156:159]
    v_mfma_f32_16x16x32_bf16 a[188:191], a[60:63], a[28:31], a[188:191]
    s_waitcnt vmcnt(0) lgkmcnt(0)
    s_barrier
    v_mfma_f32_16x16x32_bf16 v[64:67], a[96:99], a[64:67], v[64:67]
    s_cmp_ge_u32 s49, 1024
    s_cselect_b32 s18, 0, s18
    s_cselect_b32 s22, 0, s22
    ds_read_b128 a[0:3], v26 offset:32768
    v_mfma_f32_16x16x32_bf16 v[80:83], a[96:99], a[68:71], v[80:83]
    s_add_u32 m0, s48, 0
    ds_read_b64_tr_b16 a[32:33], v28 offset:32768
    v_mfma_f32_16x16x32_bf16 v[96:99], a[96:99], a[72:75], v[96:99]
    buffer_load_dwordx4 v10, s[16:19], s49 offen offset:0 lds
    v_mfma_f32_16x16x32_bf16 v[112:115], a[96:99], a[76:79], v[112:115]
    ds_read_b64_tr_b16 a[34:35], v28 offset:34816
    v_mfma_f32_16x16x32_bf16 v[128:131], a[96:99], a[80:83], v[128:131]
    buffer_load_dwordx4 v11, s[16:19], s49 offen offset:1024 lds
    v_mfma_f32_16x16x32_bf16 v[144:147], a[96:99], a[84:87], v[144:147]
    ds_read_b128 a[4:7], v26 offset:34816
    v_mfma_f32_16x16x32_bf16 a[128:131], a[96:99], a[88:91], a[128:131]
    v_mfma_f32_16x16x32_bf16 a[160:163], a[96:99], a[92:95], a[160:163]
    ds_read_b64_tr_b16 a[36:37], v29 offset:32768
    v_mfma_f32_16x16x32_bf16 v[160:163], a[100:103], a[64:67], v[160:163]
    buffer_load_dwordx4 v12, s[16:19], s49 offen offset:2048 lds
    v_mfma_f32_16x16x32_bf16 v[176:179], a[100:103], a[68:71], v[176:179]
    ds_read_b64_tr_b16 a[38:39], v29 offset:34816
    v_mfma_f32_16x16x32_bf16 v[192:195], a[100:103], a[72:75], v[192:195]
    v_mfma_f32_16x16x32_bf16 v[208:211], a[100:103], a[76:79], v[208:211]
    buffer_load_dwordx4 v13, s[16:19], s49 offen offset:3072 lds
    ds_read_b128 a[8:11], v26 offset:36864
    v_mfma_f32_16x16x32_bf16 v[224:227], a[100:103], a[80:83], v[224:227]
    v_mfma_f32_16x16x32_bf16 v[240:243], a[100:103], a[84:87], v[240:243]
    s_add_u32 m0, s48, 4096
    v_mfma_f32_16x16x32_bf16 a[132:135], a[100:103], a[88:91], a[132:135]
    ds_read_b64_tr_b16 a[40:41], v30 offset:32768
    v_mfma_f32_16x16x32_bf16 a[164:167], a[100:103], a[92:95], a[164:167]
    buffer_load_dwordx4 v14, s[16:19], s49 offen offset:0 lds
    v_mfma_f32_16x16x32_bf16 v[68:71], a[104:107], a[64:67], v[68:71]
    ds_read_b64_tr_b16 a[42:43], v30 offset:34816
    v_mfma_f32_16x16x32_bf16 v[84:87], a[104:107], a[68:71], v[84:87]
    v_mfma_f32_16x16x32_bf16 v[100:103], a[104:107], a[72:75], v[100:103]
    buffer_load_dwordx4 v15, s[16:19], s49 offen offset:1024 lds
    ds_read_b128 a[12:15], v26 offset:38912
    v_mfma_f32_16x16x32_bf16 v[116:119], a[104:107], a[76:79], v[116:119]
    v_mfma_f32_16x16x32_bf16 v[132:135], a[104:107], a[80:83], v[132:135]
    ds_read_b64_tr_b16 a[44:45], v31 offset:32768
    v_mfma_f32_16x16x32_bf16 v[148:151], a[104:107], a[84:87], v[148:151]
    v_mfma_f32_16x16x32_bf16 a[136:139], a[104:107], a[88:91], a[136:139]
    buffer_load_dwordx4 v16, s[16:19], s49 offen offset:2048 lds
    ds_read_b64_tr_b16 a[46:47], v31 offset:34816
    v_mfma_f32_16x16x32_bf16 a[168:171], a[104:107], a[92:95], a[168:171]
    v_mfma_f32_16x16x32_bf16 v[164:167], a[108:111], a[64:67], v[164:167]
    ds_read_b128 a[16:19], v26 offset:40960
    v_mfma_f32_16x16x32_bf16 v[180:183], a[108:111], a[68:71], v[180:183]
    buffer_load_dwordx4 v17, s[16:19], s49 offen offset:3072 lds
    v_mfma_f32_16x16x32_bf16 v[196:199], a[108:111], a[72:75], v[196:199]
    ds_read_b64_tr_b16 a[48:49], v32 offset:32768
    v_mfma_f32_16x16x32_bf16 v[212:215], a[108:111], a[76:79], v[212:215]
    s_add_u32 s49, s49, 128
    v_mfma_f32_16x16x32_bf16 v[228:231], a[108:111], a[80:83], v[228:231]
    s_add_u32 m0, s48, 65536
    ds_read_b64_tr_b16 a[50:51], v32 offset:34816
    v_mfma_f32_16x16x32_bf16 v[244:247], a[108:111], a[84:87], v[244:247]
    buffer_load_dwordx4 v18, s[20:23], s50 offen offset:0 lds
    v_mfma_f32_16x16x32_bf16 a[140:143], a[108:111], a[88:91], a[140:143]
    ds_read_b128 a[20:23], v26 offset:43008
    v_mfma_f32_16x16x32_bf16 a[172:175], a[108:111], a[92:95], a[172:175]
    v_mfma_f32_16x16x32_bf16 v[72:75], a[112:115], a[64:67], v[72:75]
    buffer_load_dwordx4 v19, s[20:23], s50 offen offset:1024 lds
    ds_read_b64_tr_b16 a[52:53], v33 offset:32768
    v_mfma_f32_16x16x32_bf16 v[88:91], a[112:115], a[68:71], v[88:91]
    v_mfma_f32_16x16x32_bf16 v[104:107], a[112:115], a[72:75], v[104:107]
    ds_read_b64_tr_b16 a[54:55], v33 offset:34816
    v_mfma_f32_16x16x32_bf16 v[120:123], a[112:115], a[76:79], v[120:123]
    buffer_load_dwordx4 v20, s[20:23], s50 offen offset:2048 lds
    v_mfma_f32_16x16x32_bf16 v[136:139], a[112:115], a[80:83], v[136:139]
    ds_read_b128 a[24:27], v26 offset:45056
    v_mfma_f32_16x16x32_bf16 v[152:155], a[112:115], a[84:87], v[152:155]
    v_mfma_f32_16x16x32_bf16 a[144:147], a[112:115], a[88:91], a[144:147]
    v_mfma_f32_16x16x32_bf16 a[176:179], a[112:115], a[92:95], a[176:179]
    buffer_load_dwordx4 v21, s[20:23], s50 offen offset:3072 lds
    ds_read_b64_tr_b16 a[56:57], v34 offset:32768
    v_mfma_f32_16x16x32_bf16 v[168:171], a[116:119], a[64:67], v[168:171]
    s_add_u32 m0, s48, 69632
    v_mfma_f32_16x16x32_bf16 v[184:187], a[116:119], a[68:71], v[184:187]
    ds_read_b64_tr_b16 a[58:59], v34 offset:34816
    v_mfma_f32_16x16x32_bf16 v[200:203], a[116:119], a[72:75], v[200:203]
    buffer_load_dwordx4 v22, s[20:23], s50 offen offset:0 lds
    v_mfma_f32_16x16x32_bf16 v[216:219], a[116:119], a[76:79], v[216:219]
    ds_read_b128 a[28:31], v26 offset:47104
    v_mfma_f32_16x16x32_bf16 v[232:235], a[116:119], a[80:83], v[232:235]
    v_mfma_f32_16x16x32_bf16 v[248:251], a[116:119], a[84:87], v[248:251]
    ds_read_b64_tr_b16 a[60:61], v35 offset:32768
    v_mfma_f32_16x16x32_bf16 a[148:151], a[116:119], a[88:91], a[148:151]
    buffer_load_dwordx4 v23, s[20:23], s50 offen offset:1024 lds
    v_mfma_f32_16x16x32_bf16 a[180:183], a[116:119], a[92:95], a[180:183]
    ds_read_b64_tr_b16 a[62:63], v35 offset:34816
    v_mfma_f32_16x16x32_bf16 v[76:79], a[120:123], a[64:67], v[76:79]
    v_mfma_f32_16x16x32_bf16 v[92:95], a[120:123], a[68:71], v[92:95]
    buffer_load_dwordx4 v24, s[20:23], s50 offen offset:2048 lds
    v_mfma_f32_16x16x32_bf16 v[108:111], a[120:123], a[72:75], v[108:111]
    v_mfma_f32_16x16x32_bf16 v[124:127], a[120:123], a[76:79], v[124:127]
    v_mfma_f32_16x16x32_bf16 v[140:143], a[120:123], a[80:83], v[140:143]
    v_mfma_f32_16x16x32_bf16 v[156:159], a[120:123], a[84:87], v[156:159]
    buffer_load_dwordx4 v25, s[20:23], s50 offen offset:3072 lds
    v_mfma_f32_16x16x32_bf16 a[152:155], a[120:123], a[88:91], a[152:155]
    v_mfma_f32_16x16x32_bf16 a[184:187], a[120:123], a[92:95], a[184:187]
    s_add_u32 s50, s50, 0x80000
    v_mfma_f32_16x16x32_bf16 v[172:175], a[124:127], a[64:67], v[172:175]
    v_mfma_f32_16x16x32_bf16 v[188:191], a[124:127], a[68:71], v[188:191]
    s_cmp_eq_u32 s51, s53
    s_cbranch_scc1 k12_ool_12
k12_oolret_13:
    v_mfma_f32_16x16x32_bf16 v[204:207], a[124:127], a[72:75], v[204:207]
    v_mfma_f32_16x16x32_bf16 v[220:223], a[124:127], a[76:79], v[220:223]
    s_cmp_eq_u32 s51, s63
    s_cbranch_scc1 k12_ool_14
k12_oolret_15:
    v_mfma_f32_16x16x32_bf16 v[236:239], a[124:127], a[80:83], v[236:239]
    v_mfma_f32_16x16x32_bf16 v[252:255], a[124:127], a[84:87], v[252:255]
    s_add_u32 s51, s51, 1
    v_mfma_f32_16x16x32_bf16 a[156:159], a[124:127], a[88:91], a[156:159]
    v_mfma_f32_16x16x32_bf16 a[188:191], a[124:127], a[92:95], a[188:191]
    s_waitcnt lgkmcnt(0)
    v_mfma_f32_16x16x32_bf16 v[64:67], a[32:35], a[0:3], v[64:67]
    ds_read_b128 a[64:67], v27 offset:32768
    v_mfma_f32_16x16x32_bf16 v[80:83], a[32:35], a[4:7], v[80:83]
    ds_read_b64_tr_b16 a[96:97], v28 offset:49152
    v_mfma_f32_16x16x32_bf16 v[96:99], a[32:35], a[8:11], v[96:99]
    v_mfma_f32_16x16x32_bf16 v[112:115], a[32:35], a[12:15], v[112:115]
    ds_read_b64_tr_b16 a[98:99], v28 offset:51200
    v_mfma_f32_16x16x32_bf16 v[128:131], a[32:35], a[16:19], v[128:131]
    v_mfma_f32_16x16x32_bf16 v[144:147], a[32:35], a[20:23], v[144:147]
    ds_read_b128 a[68:71], v27 offset:34816
    v_mfma_f32_16x16x32_bf16 a[128:131], a[32:35], a[24:27], a[128:131]
    v_mfma_f32_16x16x32_bf16 a[160:163], a[32:35], a[28:31], a[160:163]
    ds_read_b64_tr_b16 a[100:101], v29 offset:49152
    v_mfma_f32_16x16x32_bf16 v[160:163], a[36:39], a[0:3], v[160:163]
    v_mfma_f32_16x16x32_bf16 v[176:179], a[36:39], a[4:7], v[176:179]
    ds_read_b64_tr_b16 a[102:103], v29 offset:51200
    v_mfma_f32_16x16x32_bf16 v[192:195], a[36:39], a[8:11], v[192:195]
    v_mfma_f32_16x16x32_bf16 v[208:211], a[36:39], a[12:15], v[208:211]
    ds_read_b128 a[72:75], v27 offset:36864
    v_mfma_f32_16x16x32_bf16 v[224:227], a[36:39], a[16:19], v[224:227]
    v_mfma_f32_16x16x32_bf16 v[240:243], a[36:39], a[20:23], v[240:243]
    v_mfma_f32_16x16x32_bf16 a[132:135], a[36:39], a[24:27], a[132:135]
    ds_read_b64_tr_b16 a[104:105], v30 offset:49152
    v_mfma_f32_16x16x32_bf16 a[164:167], a[36:39], a[28:31], a[164:167]
    v_mfma_f32_16x16x32_bf16 v[68:71], a[40:43], a[0:3], v[68:71]
    ds_read_b64_tr_b16 a[106:107], v30 offset:51200
    v_mfma_f32_16x16x32_bf16 v[84:87], a[40:43], a[4:7], v[84:87]
    v_mfma_f32_16x16x32_bf16 v[100:103], a[40:43], a[8:11], v[100:103]
    ds_read_b128 a[76:79], v27 offset:38912
    v_mfma_f32_16x16x32_bf16 v[116:119], a[40:43], a[12:15], v[116:119]
    v_mfma_f32_16x16x32_bf16 v[132:135], a[40:43], a[16:19], v[132:135]
    ds_read_b64_tr_b16 a[108:109], v31 offset:49152
    v_mfma_f32_16x16x32_bf16 v[148:151], a[40:43], a[20:23], v[148:151]
    v_mfma_f32_16x16x32_bf16 a[136:139], a[40:43], a[24:27], a[136:139]
    ds_read_b64_tr_b16 a[110:111], v31 offset:51200
    v_mfma_f32_16x16x32_bf16 a[168:171], a[40:43], a[28:31], a[168:171]
    v_mfma_f32_16x16x32_bf16 v[164:167], a[44:47], a[0:3], v[164:167]
    ds_read_b128 a[80:83], v27 offset:40960
    v_mfma_f32_16x16x32_bf16 v[180:183], a[44:47], a[4:7], v[180:183]
    v_mfma_f32_16x16x32_bf16 v[196:199], a[44:47], a[8:11], v[196:199]
    ds_read_b64_tr_b16 a[112:113], v32 offset:49152
    v_mfma_f32_16x16x32_bf16 v[212:215], a[44:47], a[12:15], v[212:215]
    v_mfma_f32_16x16x32_bf16 v[228:231], a[44:47], a[16:19], v[228:231]
    ds_read_b64_tr_b16 a[114:115], v32 offset:51200
    v_mfma_f32_16x16x32_bf16 v[244:247], a[44:47], a[20:23], v[244:247]
    v_mfma_f32_16x16x32_bf16 a[140:143], a[44:47], a[24:27], a[140:143]
    ds_read_b128 a[84:87], v27 offset:43008
    v_mfma_f32_16x16x32_bf16 a[172:175], a[44:47], a[28:31], a[172:175]
    v_mfma_f32_16x16x32_bf16 v[72:75], a[48:51], a[0:3], v[72:75]
    ds_read_b64_tr_b16 a[116:117], v33 offset:49152
    v_mfma_f32_16x16x32_bf16 v[88:91], a[48:51], a[4:7], v[88:91]
    v_mfma_f32_16x16x32_bf16 v[104:107], a[48:51], a[8:11], v[104:107]
    ds_read_b64_tr_b16 a[118:119], v33 offset:51200
    v_mfma_f32_16x16x32_bf16 v[120:123], a[48:51], a[12:15], v[120:123]
    v_mfma_f32_16x16x32_bf16 v[136:139], a[48:51], a[16:19], v[136:139]
    ds_read_b128 a[88:91], v27 offset:45056
    v_mfma_f32_16x16x32_bf16 v[152:155], a[48:51], a[20:23], v[152:155]
    v_mfma_f32_16x16x32_bf16 a[144:147], a[48:51], a[24:27], a[144:147]
    v_mfma_f32_16x16x32_bf16 a[176:179], a[48:51], a[28:31], a[176:179]
    ds_read_b64_tr_b16 a[120:121], v34 offset:49152
    v_mfma_f32_16x16x32_bf16 v[168:171], a[52:55], a[0:3], v[168:171]
    v_mfma_f32_16x16x32_bf16 v[184:187], a[52:55], a[4:7], v[184:187]
    ds_read_b64_tr_b16 a[122:123], v34 offset:51200
    v_mfma_f32_16x16x32_bf16 v[200:203], a[52:55], a[8:11], v[200:203]
    v_mfma_f32_16x16x32_bf16 v[216:219], a[52:55], a[12:15], v[216:219]
    ds_read_b128 a[92:95], v27 offset:47104
    v_mfma_f32_16x16x32_bf16 v[232:235], a[52:55], a[16:19], v[232:235]
    v_mfma_f32_16x16x32_bf16 v[248:251], a[52:55], a[20:23], v[248:251]
    ds_read_b64_tr_b16 a[124:125], v35 offset:49152
    v_mfma_f32_16x16x32_bf16 a[148:151], a[52:55], a[24:27], a[148:151]
    v_mfma_f32_16x16x32_bf16 a[180:183], a[52:55], a[28:31], a[180:183]
    ds_read_b64_tr_b16 a[126:127], v35 offset:51200
    v_mfma_f32_16x16x32_bf16 v[76:79], a[56:59], a[0:3], v[76:79]
    v_mfma_f32_16x16x32_bf16 v[92:95], a[56:59], a[4:7], v[92:95]
    v_mfma_f32_16x16x32_bf16 v[108:111], a[56:59], a[8:11], v[108:111]
    v_mfma_f32_16x16x32_bf16 v[124:127], a[56:59], a[12:15], v[124:127]
    v_mfma_f32_16x16x32_bf16 v[140:143], a[56:59], a[16:19], v[140:143]
    v_mfma_f32_16x16x32_bf16 v[156:159], a[56:59], a[20:23], v[156:159]
    v_mfma_f32_16x16x32_bf16 a[152:155], a[56:59], a[24:27], a[152:155]
    v_mfma_f32_16x16x32_bf16 a[184:187], a[56:59], a[28:31], a[184:187]
    s_sub_u32 s52, s51, 1
    s_cmp_eq_u32 s52, s46
    s_cbranch_scc1 k12_ool_18
k12_oolret_19:
    v_mfma_f32_16x16x32_bf16 v[172:175], a[60:63], a[0:3], v[172:175]
    v_mfma_f32_16x16x32_bf16 v[188:191], a[60:63], a[4:7], v[188:191]
    v_mfma_f32_16x16x32_bf16 v[204:207], a[60:63], a[8:11], v[204:207]
    v_mfma_f32_16x16x32_bf16 v[220:223], a[60:63], a[12:15], v[220:223]
    v_mfma_f32_16x16x32_bf16 v[236:239], a[60:63], a[16:19], v[236:239]
    v_mfma_f32_16x16x32_bf16 v[252:255], a[60:63], a[20:23], v[252:255]
    v_mfma_f32_16x16x32_bf16 a[156:159], a[60:63], a[24:27], a[156:159]
    v_mfma_f32_16x16x32_bf16 a[188:191], a[60:63], a[28:31], a[188:191]
    s_waitcnt vmcnt(0) lgkmcnt(0)
    s_barrier
    s_cmp_eq_u32 s51, 7
    s_cbranch_scc1 k12_last_9
    v_mfma_f32_16x16x32_bf16 v[64:67], a[96:99], a[64:67], v[64:67]
    ds_read_b128 a[0:3], v26 offset:0
    v_mfma_f32_16x16x32_bf16 v[80:83], a[96:99], a[68:71], v[80:83]
    s_add_u32 m0, s48, 32768
    ds_read_b64_tr_b16 a[32:33], v28 offset:0
    v_mfma_f32_16x16x32_bf16 v[96:99], a[96:99], a[72:75], v[96:99]
    buffer_load_dwordx4 v10, s[16:19], s49 offen offset:0 lds
    v_mfma_f32_16x16x32_bf16 v[112:115], a[96:99], a[76:79], v[112:115]
    ds_read_b64_tr_b16 a[34:35], v28 offset:2048
    v_mfma_f32_16x16x32_bf16 v[128:131], a[96:99], a[80:83], v[128:131]
    buffer_load_dwordx4 v11, s[16:19], s49 offen offset:1024 lds
    v_mfma_f32_16x16x32_bf16 v[144:147], a[96:99], a[84:87], v[144:147]
    ds_read_b128 a[4:7], v26 offset:2048
    v_mfma_f32_16x16x32_bf16 a[128:131], a[96:99], a[88:91], a[128:131]
    v_mfma_f32_16x16x32_bf16 a[160:163], a[96:99], a[92:95], a[160:163]
    ds_read_b64_tr_b16 a[36:37], v29 offset:0
    v_mfma_f32_16x16x32_bf16 v[160:163], a[100:103], a[64:67], v[160:163]
    buffer_load_dwordx4 v12, s[16:19], s49 offen offset:2048 lds
    v_mfma_f32_16x16x32_bf16 v[176:179], a[100:103], a[68:71], v[176:179]
    ds_read_b64_tr_b16 a[38:39], v29 offset:2048
    v_mfma_f32_16x16x32_bf16 v[192:195], a[100:103], a[72:75], v[192:195]
    v_mfma_f32_16x16x32_bf16 v[208:211], a[100:103], a[76:79], v[208:211]
    buffer_load_dwordx4 v13, s[16:19], s49 offen offset:3072 lds
    ds_read_b128 a[8:11], v26 offset:4096
    v_mfma_f32_16x16x32_bf16 v[224:227], a[100:103], a[80:83], v[224:227]
    v_mfma_f32_16x16x32_bf16 v[240:243], a[100:103], a[84:87], v[240:243]
    s_add_u32 m0, s48, 36864
    v_mfma_f32_16x16x32_bf16 a[132:135], a[100:103], a[88:91], a[132:135]
    ds_read_b64_tr_b16 a[40:41], v30 offset:0
    v_mfma_f32_16x16x32_bf16 a[164:167], a[100:103], a[92:95], a[164:167]
    buffer_load_dwordx4 v14, s[16:19], s49 offen offset:0 lds
    v_mfma_f32_16x16x32_bf16 v[68:71], a[104:107], a[64:67], v[68:71]
    ds_read_b64_tr_b16 a[42:43], v30 offset:2048
    v_mfma_f32_16x16x32_bf16 v[84:87], a[104:107], a[68:71], v[84:87]
    v_mfma_f32_16x16x32_bf16 v[100:103], a[104:107], a[72:75], v[100:103]
    buffer_load_dwordx4 v15, s[16:19], s49 offen offset:1024 lds
    ds_read_b128 a[12:15], v26 offset:6144
    v_mfma_f32_16x16x32_bf16 v[116:119], a[104:107], a[76:79], v[116:119]
    v_mfma_f32_16x16x32_bf16 v[132:135], a[104:107], a[80:83], v[132:135]
    ds_read_b64_tr_b16 a[44:45], v31 offset:0
    v_mfma_f32_16x16x32_bf16 v[148:151], a[104:107], a[84:87], v[148:151]
    v_mfma_f32_16x16x32_bf16 a[136:139], a[104:107], a[88:91], a[136:139]
    buffer_load_dwordx4 v16, s[16:19], s49 offen offset:2048 lds
    ds_read_b64_tr_b16 a[46:47], v31 offset:2048
    v_mfma_f32_16x16x32_bf16 a[168:171], a[104:107], a[92:95], a[168:171]
    v_mfma_f32_16x16x32_bf16 v[164:167], a[108:111], a[64:67], v[164:167]
    ds_read_b128 a[16:19], v26 offset:8192
    v_mfma_f32_16x16x32_bf16 v[180:183], a[108:111], a[68:71], v[180:183]
    buffer_load_dwordx4 v17, s[16:19], s49 offen offset:3072 lds
    v_mfma_f32_16x16x32_bf16 v[196:199], a[108:111], a[72:75], v[196:199]
    ds_read_b64_tr_b16 a[48:49], v32 offset:0
    v_mfma_f32_16x16x32_bf16 v[212:215], a[108:111], a[76:79], v[212:215]
    s_add_u32 s49, s49, 128
    v_mfma_f32_16x16x32_bf16 v[228:231], a[108:111], a[80:83], v[228:231]
    s_add_u32 m0, s48, 98304
    ds_read_b64_tr_b16 a[50:51], v32 offset:2048
    v_mfma_f32_16x16x32_bf16 v[244:247], a[108:111], a[84:87], v[244:247]
    buffer_load_dwordx4 v18, s[20:23], s50 offen offset:0 lds
    v_mfma_f32_16x16x32_bf16 a[140:143], a[108:111], a[88:91], a[140:143]
    ds_read_b128 a[20:23], v26 offset:10240
    v_mfma_f32_16x16x32_bf16 a[172:175], a[108:111], a[92:95], a[172:175]
    v_mfma_f32_16x16x32_bf16 v[72:75], a[112:115], a[64:67], v[72:75]
    buffer_load_dwordx4 v19, s[20:23], s50 offen offset:1024 lds
    ds_read_b64_tr_b16 a[52:53], v33 offset:0
    v_mfma_f32_16x16x32_bf16 v[88:91], a[112:115], a[68:71], v[88:91]
    v_mfma_f32_16x16x32_bf16 v[104:107], a[112:115], a[72:75], v[104:107]
    ds_read_b64_tr_b16 a[54:55], v33 offset:2048
    v_mfma_f32_16x16x32_bf16 v[120:123], a[112:115], a[76:79], v[120:123]
    buffer_load_dwordx4 v20, s[20:23], s50 offen offset:2048 lds
    v_mfma_f32_16x16x32_bf16 v[136:139], a[112:115], a[80:83], v[136:139]
    ds_read_b128 a[24:27], v26 offset:12288
    v_mfma_f32_16x16x32_bf16 v[152:155], a[112:115], a[84:87], v[152:155]
    v_mfma_f32_16x16x32_bf16 a[144:147], a[112:115], a[88:91], a[144:147]
    v_mfma_f32_16x16x32_bf16 a[176:179], a[112:115], a[92:95], a[176:179]
    buffer_load_dwordx4 v21, s[20:23], s50 offen offset:3072 lds
    ds_read_b64_tr_b16 a[56:57], v34 offset:0
    v_mfma_f32_16x16x32_bf16 v[168:171], a[116:119], a[64:67], v[168:171]
    s_add_u32 m0, s48, 102400
    v_mfma_f32_16x16x32_bf16 v[184:187], a[116:119], a[68:71], v[184:187]
    ds_read_b64_tr_b16 a[58:59], v34 offset:2048
    v_mfma_f32_16x16x32_bf16 v[200:203], a[116:119], a[72:75], v[200:203]
    buffer_load_dwordx4 v22, s[20:23], s50 offen offset:0 lds
    v_mfma_f32_16x16x32_bf16 v[216:219], a[116:119], a[76:79], v[216:219]
    ds_read_b128 a[28:31], v26 offset:14336
    v_mfma_f32_16x16x32_bf16 v[232:235], a[116:119], a[80:83], v[232:235]
    v_mfma_f32_16x16x32_bf16 v[248:251], a[116:119], a[84:87], v[248:251]
    ds_read_b64_tr_b16 a[60:61], v35 offset:0
    v_mfma_f32_16x16x32_bf16 a[148:151], a[116:119], a[88:91], a[148:151]
    buffer_load_dwordx4 v23, s[20:23], s50 offen offset:1024 lds
    v_mfma_f32_16x16x32_bf16 a[180:183], a[116:119], a[92:95], a[180:183]
    ds_read_b64_tr_b16 a[62:63], v35 offset:2048
    v_mfma_f32_16x16x32_bf16 v[76:79], a[120:123], a[64:67], v[76:79]
    v_mfma_f32_16x16x32_bf16 v[92:95], a[120:123], a[68:71], v[92:95]
    buffer_load_dwordx4 v24, s[20:23], s50 offen offset:2048 lds
    v_mfma_f32_16x16x32_bf16 v[108:111], a[120:123], a[72:75], v[108:111]
    v_mfma_f32_16x16x32_bf16 v[124:127], a[120:123], a[76:79], v[124:127]
    v_mfma_f32_16x16x32_bf16 v[140:143], a[120:123], a[80:83], v[140:143]
    v_mfma_f32_16x16x32_bf16 v[156:159], a[120:123], a[84:87], v[156:159]
    buffer_load_dwordx4 v25, s[20:23], s50 offen offset:3072 lds
    v_mfma_f32_16x16x32_bf16 a[152:155], a[120:123], a[88:91], a[152:155]
    v_mfma_f32_16x16x32_bf16 a[184:187], a[120:123], a[92:95], a[184:187]
    s_add_u32 s50, s50, 0x80000
    v_mfma_f32_16x16x32_bf16 v[172:175], a[124:127], a[64:67], v[172:175]
    v_mfma_f32_16x16x32_bf16 v[188:191], a[124:127], a[68:71], v[188:191]
    s_cmp_eq_u32 s51, s53
    s_cbranch_scc1 k12_ool_20
k12_oolret_21:
    v_mfma_f32_16x16x32_bf16 v[204:207], a[124:127], a[72:75], v[204:207]
    v_mfma_f32_16x16x32_bf16 v[220:223], a[124:127], a[76:79], v[220:223]
    s_cmp_eq_u32 s51, 5
    s_cbranch_scc1 k12_ool_22
k12_oolret_23:
    v_mfma_f32_16x16x32_bf16 v[236:239], a[124:127], a[80:83], v[236:239]
    v_mfma_f32_16x16x32_bf16 v[252:255], a[124:127], a[84:87], v[252:255]
    s_add_u32 s51, s51, 1
    v_mfma_f32_16x16x32_bf16 a[156:159], a[124:127], a[88:91], a[156:159]
    v_mfma_f32_16x16x32_bf16 a[188:191], a[124:127], a[92:95], a[188:191]
    s_waitcnt lgkmcnt(0)
    s_branch k12_loop_8
k12_last_9:
    v_mfma_f32_16x16x32_bf16 v[64:67], a[96:99], a[64:67], v[64:67]
    s_add_u32 m0, s60, 98304
    v_mfma_f32_16x16x32_bf16 v[160:163], a[100:103], a[64:67], v[160:163]
    buffer_load_dwordx4 v38, s[12:15], s61 offen offset:0 lds
    v_mfma_f32_16x16x32_bf16 v[68:71], a[104:107], a[64:67], v[68:71]
    buffer_load_dwordx4 v39, s[12:15], s61 offen offset:1024 lds
    v_mfma_f32_16x16x32_bf16 v[164:167], a[108:111], a[64:67], v[164:167]
    v_mfma_f32_16x16x32_bf16 v[72:75], a[112:115], a[64:67], v[72:75]
    buffer_load_dwordx4 v40, s[12:15], s61 offen offset:2048 lds
    v_mfma_f32_16x16x32_bf16 v[168:171], a[116:119], a[64:67], v[168:171]
    v_cvt_pk_bf16_f32 v64, v64, v65
    v_cvt_pk_bf16_f32 v65, v66, v67
    v_cvt_pk_bf16_f32 v66, v160, v161
    v_mfma_f32_16x16x32_bf16 v[76:79], a[120:123], a[64:67], v[76:79]
    v_cvt_pk_bf16_f32 v67, v162, v163
    v_mfma_f32_16x16x32_bf16 v[172:175], a[124:127], a[64:67], v[172:175]
    v_cvt_pk_bf16_f32 v68, v68, v69
    v_cvt_pk_bf16_f32 v69, v70, v71
    v_cvt_pk_bf16_f32 v70, v164, v165
    v_mfma_f32_16x16x32_bf16 v[80:83], a[96:99], a[68:71], v[80:83]
    buffer_load_dwordx4 v41, s[12:15], s61 offen offset:3072 lds
    v_mfma_f32_16x16x32_bf16 v[176:179], a[100:103], a[68:71], v[176:179]
    s_add_u32 s61, s61, 0x80000
    v_cvt_pk_bf16_f32 v71, v166, v167
    v_cvt_pk_bf16_f32 v72, v72, v73
    v_cvt_pk_bf16_f32 v73, v74, v75
    v_mfma_f32_16x16x32_bf16 v[84:87], a[104:107], a[68:71], v[84:87]
    buffer_load_dwordx4 a[192:195], v36, s[8:11], s62 offen offset:0 sc1
    buffer_load_dwordx4 a[196:199], v36, s[8:11], s62 offen offset:1024 sc1
    v_mfma_f32_16x16x32_bf16 v[180:183], a[108:111], a[68:71], v[180:183]
    v_cvt_pk_bf16_f32 v74, v168, v169
    v_cvt_pk_bf16_f32 v75, v170, v171
    v_cvt_pk_bf16_f32 v76, v76, v77
    v_mfma_f32_16x16x32_bf16 v[88:91], a[112:115], a[68:71], v[88:91]
    v_cvt_pk_bf16_f32 v77, v78, v79
    v_cvt_pk_bf16_f32 v78, v172, v173
    v_cvt_pk_bf16_f32 v79, v174, v175
    v_mfma_f32_16x16x32_bf16 v[184:187], a[116:119], a[68:71], v[184:187]
    v_cvt_pk_bf16_f32 v80, v80, v81
    v_cvt_pk_bf16_f32 v81, v82, v83
    v_cvt_pk_bf16_f32 v82, v176, v177
    v_mfma_f32_16x16x32_bf16 v[92:95], a[120:123], a[68:71], v[92:95]
    buffer_load_dwordx4 a[200:203], v37, s[8:11], s62 offen offset:0 sc1
    buffer_load_dwordx4 a[204:207], v37, s[8:11], s62 offen offset:1024 sc1
    v_mfma_f32_16x16x32_bf16 v[188:191], a[124:127], a[68:71], v[188:191]
    s_add_u32 s62, s62, 0x20000
    v_cvt_pk_bf16_f32 v83, v178, v179
    v_cvt_pk_bf16_f32 v84, v84, v85
    v_cvt_pk_bf16_f32 v85, v86, v87
    v_mfma_f32_16x16x32_bf16 a[128:131], a[96:99], a[88:91], a[128:131]
    v_cvt_pk_bf16_f32 v86, v180, v181
    v_cvt_pk_bf16_f32 v87, v182, v183
    v_mfma_f32_16x16x32_bf16 a[132:135], a[100:103], a[88:91], a[132:135]
    v_cvt_pk_bf16_f32 v88, v88, v89
    v_cvt_pk_bf16_f32 v89, v90, v91
    v_cvt_pk_bf16_f32 v90, v184, v185
    v_mfma_f32_16x16x32_bf16 v[96:99], a[96:99], a[72:75], v[96:99]
    buffer_load_dwordx4 a[208:211], v36, s[8:11], s62 offen offset:0 sc1
    buffer_load_dwordx4 a[212:215], v36, s[8:11], s62 offen offset:1024 sc1
    v_mfma_f32_16x16x32_bf16 v[192:195], a[100:103], a[72:75], v[192:195]
    v_cvt_pk_bf16_f32 v91, v186, v187
    v_cvt_pk_bf16_f32 v92, v92, v93
    v_cvt_pk_bf16_f32 v93, v94, v95
    v_mfma_f32_16x16x32_bf16 v[100:103], a[104:107], a[72:75], v[100:103]
    v_cvt_pk_bf16_f32 v94, v188, v189
    v_cvt_pk_bf16_f32 v95, v190, v191
    v_mfma_f32_16x16x32_bf16 v[196:199], a[108:111], a[72:75], v[196:199]
    v_accvgpr_read_b32 v56, a128
    v_accvgpr_read_b32 v57, a129
    v_accvgpr_read_b32 v58, a130
    v_mfma_f32_16x16x32_bf16 a[136:139], a[104:107], a[88:91], a[136:139]
    buffer_load_dwordx4 a[216:219], v37, s[8:11], s62 offen offset:0 sc1
    buffer_load_dwordx4 a[220:223], v37, s[8:11], s62 offen offset:1024 sc1
    v_mfma_f32_16x16x32_bf16 a[140:143], a[108:111], a[88:91], a[140:143]
    s_add_u32 s62, s62, 0x20000
    v_accvgpr_read_b32 v59, a131
    v_accvgpr_read_b32 v60, a132
    v_cvt_pk_bf16_f32 v96, v96, v97
    v_mfma_f32_16x16x32_bf16 v[104:107], a[112:115], a[72:75], v[104:107]
    s_add_u32 m0, s60, 114688
    v_accvgpr_read_b32 v61, a133
    v_accvgpr_read_b32 v62, a134
    v_cvt_pk_bf16_f32 v97, v98, v99
    v_mfma_f32_16x16x32_bf16 v[200:203], a[116:119], a[72:75], v[200:203]
    v_accvgpr_read_b32 v63, a135
    v_cvt_pk_bf16_f32 v98, v192, v193
    v_cvt_pk_bf16_f32 v160, v56, v57
    v_mfma_f32_16x16x32_bf16 v[108:111], a[120:123], a[72:75], v[108:111]
    v_cvt_pk_bf16_f32 v99, v194, v195
    v_cvt_pk_bf16_f32 v161, v58, v59
    v_cvt_pk_bf16_f32 v100, v100, v101
    v_mfma_f32_16x16x32_bf16 v[204:207], a[124:127], a[72:75], v[204:207]
    buffer_load_dwordx4 v38, s[12:15], s61 offen offset:0 lds
    buffer_load_dwordx4 v39, s[12:15], s61 offen offset:1024 lds
    v_mfma_f32_16x16x32_bf16 a[144:147], a[112:115], a[88:91], a[144:147]
    v_cvt_pk_bf16_f32 v162, v60, v61
    v_cvt_pk_bf16_f32 v101, v102, v103
    v_cvt_pk_bf16_f32 v163, v62, v63
    v_mfma_f32_16x16x32_bf16 a[148:151], a[116:119], a[88:91], a[148:151]
    v_cvt_pk_bf16_f32 v102, v196, v197
    v_cvt_pk_bf16_f32 v103, v198, v199
    v_accvgpr_read_b32 v56, a136
    v_mfma_f32_16x16x32_bf16 v[112:115], a[96:99], a[76:79], v[112:115]
    v_accvgpr_read_b32 v57, a137
    v_accvgpr_read_b32 v58, a138
    v_accvgpr_read_b32 v59, a139
    v_mfma_f32_16x16x32_bf16 v[208:211], a[100:103], a[76:79], v[208:211]
    v_accvgpr_read_b32 v60, a140
    v_cvt_pk_bf16_f32 v104, v104, v105
    v_accvgpr_read_b32 v61, a141
    v_mfma_f32_16x16x32_bf16 v[116:119], a[104:107], a[76:79], v[116:119]
    buffer_load_dwordx4 v40, s[12:15], s61 offen offset:2048 lds
    buffer_load_dwordx4 v41, s[12:15], s61 offen offset:3072 lds
    v_mfma_f32_16x16x32_bf16 v[212:215], a[108:111], a[76:79], v[212:215]
    s_add_u32 s61, s61, 0x80000
    v_accvgpr_read_b32 v62, a142
    v_cvt_pk_bf16_f32 v105, v106, v107
    v_accvgpr_read_b32 v63, a143
    v_mfma_f32_16x16x32_bf16 a[152:155], a[120:123], a[88:91], a[152:155]
    v_cvt_pk_bf16_f32 v106, v200, v201
    v_cvt_pk_bf16_f32 v164, v56, v57
    v_cvt_pk_bf16_f32 v107, v202, v203
    v_mfma_f32_16x16x32_bf16 a[156:159], a[124:127], a[88:91], a[156:159]
    v_cvt_pk_bf16_f32 v165, v58, v59
    v_cvt_pk_bf16_f32 v108, v108, v109
    v_cvt_pk_bf16_f32 v166, v60, v61
    v_mfma_f32_16x16x32_bf16 v[120:123], a[112:115], a[76:79], v[120:123]
    v_cvt_pk_bf16_f32 v109, v110, v111
    v_cvt_pk_bf16_f32 v167, v62, v63
    v_cvt_pk_bf16_f32 v110, v204, v205
    v_mfma_f32_16x16x32_bf16 v[216:219], a[116:119], a[76:79], v[216:219]
    buffer_load_dwordx4 a[224:227], v36, s[8:11], s62 offen offset:0 sc1
    v_cvt_pk_bf16_f32 v111, v206, v207
    v_accvgpr_read_b32 v56, a144
    v_mfma_f32_16x16x32_bf16 v[124:127], a[120:123], a[76:79], v[124:127]
    v_accvgpr_read_b32 v57, a145
    v_accvgpr_read_b32 v58, a146
    v_accvgpr_read_b32 v59, a147
    v_mfma_f32_16x16x32_bf16 v[220:223], a[124:127], a[76:79], v[220:223]
    buffer_load_dwordx4 a[228:231], v36, s[8:11], s62 offen offset:1024 sc1
    v_accvgpr_read_b32 v60, a148
    v_cvt_pk_bf16_f32 v112, v112, v113
    v_mfma_f32_16x16x32_bf16 a[160:163], a[96:99], a[92:95], a[160:163]
    v_accvgpr_read_b32 v61, a149
    v_accvgpr_read_b32 v62, a150
    v_cvt_pk_bf16_f32 v113, v114, v115
    v_mfma_f32_16x16x32_bf16 a[164:167], a[100:103], a[92:95], a[164:167]
    v_accvgpr_read_b32 v63, a151
    v_cvt_pk_bf16_f32 v114, v208, v209
    v_cvt_pk_bf16_f32 v168, v56, v57
    v_mfma_f32_16x16x32_bf16 v[128:131], a[96:99], a[80:83], v[128:131]
    v_cvt_pk_bf16_f32 v115, v210, v211
    v_cvt_pk_bf16_f32 v169, v58, v59
    v_cvt_pk_bf16_f32 v116, v116, v117
    v_mfma_f32_16x16x32_bf16 v[224:227], a[100:103], a[80:83], v[224:227]
    buffer_load_dwordx4 a[232:235], v37, s[8:11], s62 offen offset:0 sc1
    v_cvt_pk_bf16_f32 v170, v60, v61
    v_cvt_pk_bf16_f32 v117, v118, v119
    v_mfma_f32_16x16x32_bf16 v[132:135], a[104:107], a[80:83], v[132:135]
    v_cvt_pk_bf16_f32 v171, v62, v63
    v_cvt_pk_bf16_f32 v118, v212, v213
    v_cvt_pk_bf16_f32 v119, v214, v215
    v_mfma_f32_16x16x32_bf16 v[228:231], a[108:111], a[80:83], v[228:231]
    buffer_load_dwordx4 a[236:239], v37, s[8:11], s62 offen offset:1024 sc1
    v_accvgpr_read_b32 v56, a152
    v_accvgpr_read_b32 v57, a153
    v_mfma_f32_16x16x32_bf16 a[168:171], a[104:107], a[92:95], a[168:171]
    s_add_u32 s62, s62, 0x20000
    v_accvgpr_read_b32 v58, a154
    v_accvgpr_read_b32 v59, a155
    v_accvgpr_read_b32 v60, a156
    v_mfma_f32_16x16x32_bf16 a[172:175], a[108:111], a[92:95], a[172:175]
    s_waitcnt vmcnt(16)
    s_barrier
    v_cvt_pk_bf16_f32 v120, v120, v121
    v_accvgpr_read_b32 v61, a157
    v_accvgpr_read_b32 v62, a158
    v_mfma_f32_16x16x32_bf16 v[136:139], a[112:115], a[80:83], v[136:139]
    v_cvt_pk_bf16_f32 v121, v122, v123
    v_accvgpr_read_b32 v63, a159
    v_cvt_pk_bf16_f32 v122, v216, v217
    v_mfma_f32_16x16x32_bf16 v[232:235], a[116:119], a[80:83], v[232:235]
    v_cvt_pk_bf16_f32 v172, v56, v57
    v_cvt_pk_bf16_f32 v123, v218, v219
    v_cvt_pk_bf16_f32 v173, v58, v59
    v_mfma_f32_16x16x32_bf16 v[140:143], a[120:123], a[80:83], v[140:143]
    v_cvt_pk_bf16_f32 v124, v124, v125
    v_cvt_pk_bf16_f32 v174, v60, v61
    v_cvt_pk_bf16_f32 v125, v126, v127
    v_mfma_f32_16x16x32_bf16 v[236:239], a[124:127], a[80:83], v[236:239]
    v_cvt_pk_bf16_f32 v175, v62, v63
    v_cvt_pk_bf16_f32 v126, v220, v221
    v_cvt_pk_bf16_f32 v127, v222, v223
    v_mfma_f32_16x16x32_bf16 a[176:179], a[112:115], a[92:95], a[176:179]
    ds_read_b64_tr_b16 a[0:1], v42 offset:0
    v_accvgpr_read_b32 v56, a160
    v_accvgpr_read_b32 v57, a161
    v_mfma_f32_16x16x32_bf16 a[180:183], a[116:119], a[92:95], a[180:183]
    ds_read_b64_tr_b16 a[2:3], v42 offset:1024
    v_accvgpr_read_b32 v58, a162
    v_accvgpr_read_b32 v59, a163
    v_mfma_f32_16x16x32_bf16 v[144:147], a[96:99], a[84:87], v[144:147]
    ds_read_b64_tr_b16 a[4:5], v43 offset:0
    v_accvgpr_read_b32 v60, a164
    v_cvt_pk_bf16_f32 v128, v128, v129
    v_mfma_f32_16x16x32_bf16 v[240:243], a[100:103], a[84:87], v[240:243]
    v_accvgpr_read_b32 v61, a165
    v_accvgpr_read_b32 v62, a166
    v_cvt_pk_bf16_f32 v129, v130, v131
    v_mfma_f32_16x16x32_bf16 v[148:151], a[104:107], a[84:87], v[148:151]
    ds_read_b64_tr_b16 a[6:7], v43 offset:1024
    v_accvgpr_read_b32 v63, a167
    v_cvt_pk_bf16_f32 v130, v224, v225
    v_mfma_f32_16x16x32_bf16 v[244:247], a[108:111], a[84:87], v[244:247]
    v_cvt_pk_bf16_f32 v176, v56, v57
    v_cvt_pk_bf16_f32 v131, v226, v227
    v_cvt_pk_bf16_f32 v177, v58, v59
    v_mfma_f32_16x16x32_bf16 a[184:187], a[120:123], a[92:95], a[184:187]
    ds_read_b64_tr_b16 a[8:9], v44 offset:0
    v_cvt_pk_bf16_f32 v132, v132, v133
    v_cvt_pk_bf16_f32 v178, v60, v61
    v_mfma_f32_16x16x32_bf16 a[188:191], a[124:127], a[92:95], a[188:191]
    ds_read_b64_tr_b16 a[10:11], v44 offset:1024
    v_cvt_pk_bf16_f32 v133, v134, v135
    v_cvt_pk_bf16_f32 v179, v62, v63
    v_mfma_f32_16x16x32_bf16 v[152:155], a[112:115], a[84:87], v[152:155]
    ds_read_b64_tr_b16 a[12:13], v45 offset:0
    v_cvt_pk_bf16_f32 v134, v228, v229
    v_cvt_pk_bf16_f32 v135, v230, v231
    v_mfma_f32_16x16x32_bf16 v[248:251], a[116:119], a[84:87], v[248:251]
    ds_read_b64_tr_b16 a[14:15], v45 offset:1024
    v_accvgpr_read_b32 v56, a168
    v_accvgpr_read_b32 v57, a169
    v_mfma_f32_16x16x32_bf16 v[156:159], a[120:123], a[84:87], v[156:159]
    ds_read_b64_tr_b16 a[16:17], v46 offset:0
    v_accvgpr_read_b32 v58, a170
    v_accvgpr_read_b32 v59, a171
    v_mfma_f32_16x16x32_bf16 v[252:255], a[124:127], a[84:87], v[252:255]
    v_accvgpr_read_b32 v60, a172
    v_cvt_pk_bf16_f32 v136, v136, v137
    v_accvgpr_read_b32 v61, a173
    ds_read_b64_tr_b16 a[18:19], v46 offset:1024
    v_accvgpr_read_b32 v62, a174
    v_cvt_pk_bf16_f32 v137, v138, v139
    v_accvgpr_read_b32 v63, a175
    v_cvt_pk_bf16_f32 v138, v232, v233
    v_cvt_pk_bf16_f32 v180, v56, v57
    ds_read_b64_tr_b16 a[20:21], v47 offset:0
    v_cvt_pk_bf16_f32 v139, v234, v235
    v_cvt_pk_bf16_f32 v181, v58, v59
    v_cvt_pk_bf16_f32 v140, v140, v141
    v_cvt_pk_bf16_f32 v182, v60, v61
    ds_read_b64_tr_b16 a[22:23], v47 offset:1024
    v_cvt_pk_bf16_f32 v141, v142, v143
    v_cvt_pk_bf16_f32 v183, v62, v63
    v_cvt_pk_bf16_f32 v142, v236, v237
    ds_read_b64_tr_b16 a[24:25], v48 offset:0
    v_cvt_pk_bf16_f32 v143, v238, v239
    v_accvgpr_read_b32 v56, a176
    ds_read_b64_tr_b16 a[26:27], v48 offset:1024
    v_accvgpr_read_b32 v57, a177
    v_accvgpr_read_b32 v58, a178
    ds_read_b64_tr_b16 a[28:29], v49 offset:0
    v_accvgpr_read_b32 v59, a179
    v_accvgpr_read_b32 v60, a180
    v_cvt_pk_bf16_f32 v144, v144, v145
    ds_read_b64_tr_b16 a[30:31], v49 offset:1024
    v_accvgpr_read_b32 v61, a181
    v_accvgpr_read_b32 v62, a182
    v_cvt_pk_bf16_f32 v145, v146, v147
    v_accvgpr_read_b32 v63, a183
    v_cvt_pk_bf16_f32 v146, v240, v241
    v_cvt_pk_bf16_f32 v184, v56, v57
    v_cvt_pk_bf16_f32 v147, v242, v243
    v_cvt_pk_bf16_f32 v185, v58, v59
    v_cvt_pk_bf16_f32 v148, v148, v149
    v_cvt_pk_bf16_f32 v186, v60, v61
    v_cvt_pk_bf16_f32 v149, v150, v151
    v_cvt_pk_bf16_f32 v187, v62, v63
    v_cvt_pk_bf16_f32 v150, v244, v245
    v_cvt_pk_bf16_f32 v151, v246, v247
    v_accvgpr_read_b32 v56, a184
    v_accvgpr_read_b32 v57, a185
    v_accvgpr_read_b32 v58, a186
    v_accvgpr_read_b32 v59, a187
    v_accvgpr_read_b32 v60, a188
    v_cvt_pk_bf16_f32 v152, v152, v153
    v_accvgpr_read_b32 v61, a189
    v_accvgpr_read_b32 v62, a190
    v_cvt_pk_bf16_f32 v153, v154, v155
    v_accvgpr_read_b32 v63, a191
    v_cvt_pk_bf16_f32 v154, v248, v249
    v_cvt_pk_bf16_f32 v188, v56, v57
    v_cvt_pk_bf16_f32 v155, v250, v251
    v_cvt_pk_bf16_f32 v189, v58, v59
    v_cvt_pk_bf16_f32 v156, v156, v157
    v_cvt_pk_bf16_f32 v190, v60, v61
    v_cvt_pk_bf16_f32 v157, v158, v159
    v_cvt_pk_bf16_f32 v191, v62, v63
    v_cvt_pk_bf16_f32 v158, v252, v253
    v_cvt_pk_bf16_f32 v159, v254, v255
    s_branch k12_join_7
k12_v_6:
k12_loop_24:
    v_mfma_f32_16x16x32_bf16 v[64:67], a[0:3], a[32:35], v[64:67]
    ds_read_b128 a[64:67], v27 offset:0
    v_mfma_f32_16x16x32_bf16 v[68:71], a[0:3], a[36:39], v[68:71]
    ds_read_b64_tr_b16 a[96:97], v28 offset:16384
    v_mfma_f32_16x16x32_bf16 v[72:75], a[0:3], a[40:43], v[72:75]
    v_mfma_f32_16x16x32_bf16 v[76:79], a[0:3], a[44:47], v[76:79]
    s_cmp_eq_u32 s51, s46
    s_cbranch_scc1 k12_ool_26
k12_oolret_27:
    v_mfma_f32_16x16x32_bf16 v[80:83], a[0:3], a[48:51], v[80:83]
    ds_read_b64_tr_b16 a[98:99], v28 offset:18432
    v_mfma_f32_16x16x32_bf16 v[84:87], a[0:3], a[52:55], v[84:87]
    ds_read_b128 a[68:71], v27 offset:2048
    v_mfma_f32_16x16x32_bf16 v[88:91], a[0:3], a[56:59], v[88:91]
    v_mfma_f32_16x16x32_bf16 v[92:95], a[0:3], a[60:63], v[92:95]
    ds_read_b64_tr_b16 a[100:101], v29 offset:16384
    v_mfma_f32_16x16x32_bf16 v[160:163], a[4:7], a[32:35], v[160:163]
    v_mfma_f32_16x16x32_bf16 v[164:167], a[4:7], a[36:39], v[164:167]
    ds_read_b64_tr_b16 a[102:103], v29 offset:18432
    v_mfma_f32_16x16x32_bf16 v[168:171], a[4:7], a[40:43], v[168:171]
    v_mfma_f32_16x16x32_bf16 v[172:175], a[4:7], a[44:47], v[172:175]
    ds_read_b128 a[72:75], v27 offset:4096
    v_mfma_f32_16x16x32_bf16 v[176:179], a[4:7], a[48:51], v[176:179]
    v_mfma_f32_16x16x32_bf16 v[180:183], a[4:7], a[52:55], v[180:183]
    v_mfma_f32_16x16x32_bf16 v[184:187], a[4:7], a[56:59], v[184:187]
    ds_read_b64_tr_b16 a[104:105], v30 offset:16384
    v_mfma_f32_16x16x32_bf16 v[188:191], a[4:7], a[60:63], v[188:191]
    v_mfma_f32_16x16x32_bf16 v[96:99], a[8:11], a[32:35], v[96:99]
    ds_read_b64_tr_b16 a[106:107], v30 offset:18432
    v_mfma_f32_16x16x32_bf16 v[100:103], a[8:11], a[36:39], v[100:103]
    v_mfma_f32_16x16x32_bf16 v[104:107], a[8:11], a[40:43], v[104:107]
    ds_read_b128 a[76:79], v27 offset:6144
    v_mfma_f32_16x16x32_bf16 v[108:111], a[8:11], a[44:47], v[108:111]
    v_mfma_f32_16x16x32_bf16 v[112:115], a[8:11], a[48:51], v[112:115]
    ds_read_b64_tr_b16 a[108:109], v31 offset:16384
    v_mfma_f32_16x16x32_bf16 v[116:119], a[8:11], a[52:55], v[116:119]
    v_mfma_f32_16x16x32_bf16 v[120:123], a[8:11], a[56:59], v[120:123]
    ds_read_b64_tr_b16 a[110:111], v31 offset:18432
    v_mfma_f32_16x16x32_bf16 v[124:127], a[8:11], a[60:63], v[124:127]
    v_mfma_f32_16x16x32_bf16 v[192:195], a[12:15], a[32:35], v[192:195]
    ds_read_b128 a[80:83], v27 offset:8192
    v_mfma_f32_16x16x32_bf16 v[196:199], a[12:15], a[36:39], v[196:199]
    v_mfma_f32_16x16x32_bf16 v[200:203], a[12:15], a[40:43], v[200:203]
    ds_read_b64_tr_b16 a[112:113], v32 offset:16384
    v_mfma_f32_16x16x32_bf16 v[204:207], a[12:15], a[44:47], v[204:207]
    v_mfma_f32_16x16x32_bf16 v[208:211], a[12:15], a[48:51], v[208:211]
    ds_read_b64_tr_b16 a[114:115], v32 offset:18432
    v_mfma_f32_16x16x32_bf16 v[212:215], a[12:15], a[52:55], v[212:215]
    v_mfma_f32_16x16x32_bf16 v[216:219], a[12:15], a[56:59], v[216:219]
    ds_read_b128 a[84:87], v27 offset:10240
    v_mfma_f32_16x16x32_bf16 v[220:223], a[12:15], a[60:63], v[220:223]
    v_mfma_f32_16x16x32_bf16 v[128:131], a[16:19], a[32:35], v[128:131]
    ds_read_b64_tr_b16 a[116:117], v33 offset:16384
    v_mfma_f32_16x16x32_bf16 v[132:135], a[16:19], a[36:39], v[132:135]
    v_mfma_f32_16x16x32_bf16 v[136:139], a[16:19], a[40:43], v[136:139]
    ds_read_b64_tr_b16 a[118:119], v33 offset:18432
    v_mfma_f32_16x16x32_bf16 v[140:143], a[16:19], a[44:47], v[140:143]
    v_mfma_f32_16x16x32_bf16 v[144:147], a[16:19], a[48:51], v[144:147]
    ds_read_b128 a[88:91], v27 offset:12288
    v_mfma_f32_16x16x32_bf16 v[148:151], a[16:19], a[52:55], v[148:151]
    v_mfma_f32_16x16x32_bf16 v[152:155], a[16:19], a[56:59], v[152:155]
    v_mfma_f32_16x16x32_bf16 v[156:159], a[16:19], a[60:63], v[156:159]
    ds_read_b64_tr_b16 a[120:121], v34 offset:16384
    v_mfma_f32_16x16x32_bf16 v[224:227], a[20:23], a[32:35], v[224:227]
    v_mfma_f32_16x16x32_bf16 v[228:231], a[20:23], a[36:39], v[228:231]
    ds_read_b64_tr_b16 a[122:123], v34 offset:18432
    v_mfma_f32_16x16x32_bf16 v[232:235], a[20:23], a[40:43], v[232:235]
    v_mfma_f32_16x16x32_bf16 v[236:239], a[20:23], a[44:47], v[236:239]
    ds_read_b128 a[92:95], v27 offset:14336
    v_mfma_f32_16x16x32_bf16 v[240:243], a[20:23], a[48:51], v[240:243]
    v_mfma_f32_16x16x32_bf16 v[244:247], a[20:23], a[52:55], v[244:247]
    ds_read_b64_tr_b16 a[124:125], v35 offset:16384
    v_mfma_f32_16x16x32_bf16 v[248:251], a[20:23], a[56:59], v[248:251]
    v_mfma_f32_16x16x32_bf16 v[252:255], a[20:23], a[60:63], v[252:255]
    ds_read_b64_tr_b16 a[126:127], v35 offset:18432
    v_mfma_f32_16x16x32_bf16 a[128:131], a[24:27], a[32:35], a[128:131]
    v_mfma_f32_16x16x32_bf16 a[136:139], a[24:27], a[36:39], a[136:139]
    v_mfma_f32_16x16x32_bf16 a[144:147], a[24:27], a[40:43], a[144:147]
    v_mfma_f32_16x16x32_bf16 a[152:155], a[24:27], a[44:47], a[152:155]
    v_mfma_f32_16x16x32_bf16 a[160:163], a[24:27], a[48:51], a[160:163]
    v_mfma_f32_16x16x32_bf16 a[168:171], a[24:27], a[52:55], a[168:171]
    v_mfma_f32_16x16x32_bf16 a[176:179], a[24:27], a[56:59], a[176:179]
    v_mfma_f32_16x16x32_bf16 a[184:187], a[24:27], a[60:63], a[184:187]
    v_mfma_f32_16x16x32_bf16 a[132:135], a[28:31], a[32:35], a[132:135]
    v_mfma_f32_16x16x32_bf16 a[140:143], a[28:31], a[36:39], a[140:143]
    v_mfma_f32_16x16x32_bf16 a[148:151], a[28:31], a[40:43], a[148:151]
    v_mfma_f32_16x16x32_bf16 a[156:159], a[28:31], a[44:47], a[156:159]
    v_mfma_f32_16x16x32_bf16 a[164:167], a[28:31], a[48:51], a[164:167]
    v_mfma_f32_16x16x32_bf16 a[172:175], a[28:31], a[52:55], a[172:175]
    v_mfma_f32_16x16x32_bf16 a[180:183], a[28:31], a[56:59], a[180:183]
    v_mfma_f32_16x16x32_bf16 a[188:191], a[28:31], a[60:63], a[188:191]
    s_waitcnt vmcnt(0) lgkmcnt(0)
    s_barrier
    v_mfma_f32_16x16x32_bf16 v[64:67], a[64:67], a[96:99], v[64:67]
    s_cmp_ge_u32 s49, 1024
    s_cselect_b32 s18, 0, s18
    s_cselect_b32 s22, 0, s22
    ds_read_b128 a[0:3], v26 offset:32768
    v_mfma_f32_16x16x32_bf16 v[68:71], a[64:67], a[100:103], v[68:71]
    s_add_u32 m0, s48, 0
    ds_read_b64_tr_b16 a[32:33], v28 offset:32768
    v_mfma_f32_16x16x32_bf16 v[72:75], a[64:67], a[104:107], v[72:75]
    buffer_load_dwordx4 v10, s[16:19], s49 offen offset:0 lds
    v_mfma_f32_16x16x32_bf16 v[76:79], a[64:67], a[108:111], v[76:79]
    ds_read_b64_tr_b16 a[34:35], v28 offset:34816
    v_mfma_f32_16x16x32_bf16 v[80:83], a[64:67], a[112:115], v[80:83]
    buffer_load_dwordx4 v11, s[16:19], s49 offen offset:1024 lds
    v_mfma_f32_16x16x32_bf16 v[84:87], a[64:67], a[116:119], v[84:87]
    ds_read_b128 a[4:7], v26 offset:34816
    v_mfma_f32_16x16x32_bf16 v[88:91], a[64:67], a[120:123], v[88:91]
    v_mfma_f32_16x16x32_bf16 v[92:95], a[64:67], a[124:127], v[92:95]
    ds_read_b64_tr_b16 a[36:37], v29 offset:32768
    v_mfma_f32_16x16x32_bf16 v[160:163], a[68:71], a[96:99], v[160:163]
    buffer_load_dwordx4 v12, s[16:19], s49 offen offset:2048 lds
    v_mfma_f32_16x16x32_bf16 v[164:167], a[68:71], a[100:103], v[164:167]
    ds_read_b64_tr_b16 a[38:39], v29 offset:34816
    v_mfma_f32_16x16x32_bf16 v[168:171], a[68:71], a[104:107], v[168:171]
    v_mfma_f32_16x16x32_bf16 v[172:175], a[68:71], a[108:111], v[172:175]
    buffer_load_dwordx4 v13, s[16:19], s49 offen offset:3072 lds
    ds_read_b128 a[8:11], v26 offset:36864
    v_mfma_f32_16x16x32_bf16 v[176:179], a[68:71], a[112:115], v[176:179]
    v_mfma_f32_16x16x32_bf16 v[180:183], a[68:71], a[116:119], v[180:183]
    s_add_u32 m0, s48, 4096
    v_mfma_f32_16x16x32_bf16 v[184:187], a[68:71], a[120:123], v[184:187]
    ds_read_b64_tr_b16 a[40:41], v30 offset:32768
    v_mfma_f32_16x16x32_bf16 v[188:191], a[68:71], a[124:127], v[188:191]
    buffer_load_dwordx4 v14, s[16:19], s49 offen offset:0 lds
    v_mfma_f32_16x16x32_bf16 v[96:99], a[72:75], a[96:99], v[96:99]
    ds_read_b64_tr_b16 a[42:43], v30 offset:34816
    v_mfma_f32_16x16x32_bf16 v[100:103], a[72:75], a[100:103], v[100:103]
    v_mfma_f32_16x16x32_bf16 v[104:107], a[72:75], a[104:107], v[104:107]
    buffer_load_dwordx4 v15, s[16:19], s49 offen offset:1024 lds
    ds_read_b128 a[12:15], v26 offset:38912
    v_mfma_f32_16x16x32_bf16 v[108:111], a[72:75], a[108:111], v[108:111]
    v_mfma_f32_16x16x32_bf16 v[112:115], a[72:75], a[112:115], v[112:115]
    ds_read_b64_tr_b16 a[44:45], v31 offset:32768
    v_mfma_f32_16x16x32_bf16 v[116:119], a[72:75], a[116:119], v[116:119]
    v_mfma_f32_16x16x32_bf16 v[120:123], a[72:75], a[120:123], v[120:123]
    buffer_load_dwordx4 v16, s[16:19], s49 offen offset:2048 lds
    ds_read_b64_tr_b16 a[46:47], v31 offset:34816
    v_mfma_f32_16x16x32_bf16 v[124:127], a[72:75], a[124:127], v[124:127]
    v_mfma_f32_16x16x32_bf16 v[192:195], a[76:79], a[96:99], v[192:195]
    ds_read_b128 a[16:19], v26 offset:40960
    v_mfma_f32_16x16x32_bf16 v[196:199], a[76:79], a[100:103], v[196:199]
    buffer_load_dwordx4 v17, s[16:19], s49 offen offset:3072 lds
    v_mfma_f32_16x16x32_bf16 v[200:203], a[76:79], a[104:107], v[200:203]
    ds_read_b64_tr_b16 a[48:49], v32 offset:32768
    v_mfma_f32_16x16x32_bf16 v[204:207], a[76:79], a[108:111], v[204:207]
    s_add_u32 s49, s49, 128
    v_mfma_f32_16x16x32_bf16 v[208:211], a[76:79], a[112:115], v[208:211]
    s_add_u32 m0, s48, 65536
    ds_read_b64_tr_b16 a[50:51], v32 offset:34816
    v_mfma_f32_16x16x32_bf16 v[212:215], a[76:79], a[116:119], v[212:215]
    buffer_load_dwordx4 v18, s[20:23], s50 offen offset:0 lds
    v_mfma_f32_16x16x32_bf16 v[216:219], a[76:79], a[120:123], v[216:219]
    ds_read_b128 a[20:23], v26 offset:43008
    v_mfma_f32_16x16x32_bf16 v[220:223], a[76:79], a[124:127], v[220:223]
    v_mfma_f32_16x16x32_bf16 v[128:131], a[80:83], a[96:99], v[128:131]
    buffer_load_dwordx4 v19, s[20:23], s50 offen offset:1024 lds
    ds_read_b64_tr_b16 a[52:53], v33 offset:32768
    v_mfma_f32_16x16x32_bf16 v[132:135], a[80:83], a[100:103], v[132:135]
    v_mfma_f32_16x16x32_bf16 v[136:139], a[80:83], a[104:107], v[136:139]
    ds_read_b64_tr_b16 a[54:55], v33 offset:34816
    v_mfma_f32_16x16x32_bf16 v[140:143], a[80:83], a[108:111], v[140:143]
    buffer_load_dwordx4 v20, s[20:23], s50 offen offset:2048 lds
    v_mfma_f32_16x16x32_bf16 v[144:147], a[80:83], a[112:115], v[144:147]
    ds_read_b128 a[24:27], v26 offset:45056
    v_mfma_f32_16x16x32_bf16 v[148:151], a[80:83], a[116:119], v[148:151]
    v_mfma_f32_16x16x32_bf16 v[152:155], a[80:83], a[120:123], v[152:155]
    v_mfma_f32_16x16x32_bf16 v[156:159], a[80:83], a[124:127], v[156:159]
    buffer_load_dwordx4 v21, s[20:23], s50 offen offset:3072 lds
    ds_read_b64_tr_b16 a[56:57], v34 offset:32768
    v_mfma_f32_16x16x32_bf16 v[224:227], a[84:87], a[96:99], v[224:227]
    s_add_u32 m0, s48, 69632
    v_mfma_f32_16x16x32_bf16 v[228:231], a[84:87], a[100:103], v[228:231]
    ds_read_b64_tr_b16 a[58:59], v34 offset:34816
    v_mfma_f32_16x16x32_bf16 v[232:235], a[84:87], a[104:107], v[232:235]
    buffer_load_dwordx4 v22, s[20:23], s50 offen offset:0 lds
    v_mfma_f32_16x16x32_bf16 v[236:239], a[84:87], a[108:111], v[236:239]
    ds_read_b128 a[28:31], v26 offset:47104
    v_mfma_f32_16x16x32_bf16 v[240:243], a[84:87], a[112:115], v[240:243]
    v_mfma_f32_16x16x32_bf16 v[244:247], a[84:87], a[116:119], v[244:247]
    ds_read_b64_tr_b16 a[60:61], v35 offset:32768
    v_mfma_f32_16x16x32_bf16 v[248:251], a[84:87], a[120:123], v[248:251]
    buffer_load_dwordx4 v23, s[20:23], s50 offen offset:1024 lds
    v_mfma_f32_16x16x32_bf16 v[252:255], a[84:87], a[124:127], v[252:255]
    ds_read_b64_tr_b16 a[62:63], v35 offset:34816
    v_mfma_f32_16x16x32_bf16 a[128:131], a[88:91], a[96:99], a[128:131]
    v_mfma_f32_16x16x32_bf16 a[136:139], a[88:91], a[100:103], a[136:139]
    buffer_load_dwordx4 v24, s[20:23], s50 offen offset:2048 lds
    v_mfma_f32_16x16x32_bf16 a[144:147], a[88:91], a[104:107], a[144:147]
    v_mfma_f32_16x16x32_bf16 a[152:155], a[88:91], a[108:111], a[152:155]
    v_mfma_f32_16x16x32_bf16 a[160:163], a[88:91], a[112:115], a[160:163]
    v_mfma_f32_16x16x32_bf16 a[168:171], a[88:91], a[116:119], a[168:171]
    buffer_load_dwordx4 v25, s[20:23], s50 offen offset:3072 lds
    v_mfma_f32_16x16x32_bf16 a[176:179], a[88:91], a[120:123], a[176:179]
    v_mfma_f32_16x16x32_bf16 a[184:187], a[88:91], a[124:127], a[184:187]
    s_add_u32 s50, s50, 0x80000
    v_mfma_f32_16x16x32_bf16 a[132:135], a[92:95], a[96:99], a[132:135]
    v_mfma_f32_16x16x32_bf16 a[140:143], a[92:95], a[100:103], a[140:143]
    s_cmp_eq_u32 s51, s53
    s_cbranch_scc1 k12_ool_28
k12_oolret_29:
    v_mfma_f32_16x16x32_bf16 a[148:151], a[92:95], a[104:107], a[148:151]
    v_mfma_f32_16x16x32_bf16 a[156:159], a[92:95], a[108:111], a[156:159]
    s_cmp_eq_u32 s51, s63
    s_cbranch_scc1 k12_ool_30
k12_oolret_31:
    v_mfma_f32_16x16x32_bf16 a[164:167], a[92:95], a[112:115], a[164:167]
    v_mfma_f32_16x16x32_bf16 a[172:175], a[92:95], a[116:119], a[172:175]
    s_add_u32 s51, s51, 1
    v_mfma_f32_16x16x32_bf16 a[180:183], a[92:95], a[120:123], a[180:183]
    v_mfma_f32_16x16x32_bf16 a[188:191], a[92:95], a[124:127], a[188:191]
    s_waitcnt lgkmcnt(0)
    v_mfma_f32_16x16x32_bf16 v[64:67], a[0:3], a[32:35], v[64:67]
    ds_read_b128 a[64:67], v27 offset:32768
    v_mfma_f32_16x16x32_bf16 v[68:71], a[0:3], a[36:39], v[68:71]
    ds_read_b64_tr_b16 a[96:97], v28 offset:49152
    v_mfma_f32_16x16x32_bf16 v[72:75], a[0:3], a[40:43], v[72:75]
    v_mfma_f32_16x16x32_bf16 v[76:79], a[0:3], a[44:47], v[76:79]
    ds_read_b64_tr_b16 a[98:99], v28 offset:51200
    v_mfma_f32_16x16x32_bf16 v[80:83], a[0:3], a[48:51], v[80:83]
    v_mfma_f32_16x16x32_bf16 v[84:87], a[0:3], a[52:55], v[84:87]
    ds_read_b128 a[68:71], v27 offset:34816
    v_mfma_f32_16x16x32_bf16 v[88:91], a[0:3], a[56:59], v[88:91]
    v_mfma_f32_16x16x32_bf16 v[92:95], a[0:3], a[60:63], v[92:95]
    ds_read_b64_tr_b16 a[100:101], v29 offset:49152
    v_mfma_f32_16x16x32_bf16 v[160:163], a[4:7], a[32:35], v[160:163]
    v_mfma_f32_16x16x32_bf16 v[164:167], a[4:7], a[36:39], v[164:167]
    ds_read_b64_tr_b16 a[102:103], v29 offset:51200
    v_mfma_f32_16x16x32_bf16 v[168:171], a[4:7], a[40:43], v[168:171]
    v_mfma_f32_16x16x32_bf16 v[172:175], a[4:7], a[44:47], v[172:175]
    ds_read_b128 a[72:75], v27 offset:36864
    v_mfma_f32_16x16x32_bf16 v[176:179], a[4:7], a[48:51], v[176:179]
    v_mfma_f32_16x16x32_bf16 v[180:183], a[4:7], a[52:55], v[180:183]
    v_mfma_f32_16x16x32_bf16 v[184:187], a[4:7], a[56:59], v[184:187]
    ds_read_b64_tr_b16 a[104:105], v30 offset:49152
    v_mfma_f32_16x16x32_bf16 v[188:191], a[4:7], a[60:63], v[188:191]
    v_mfma_f32_16x16x32_bf16 v[96:99], a[8:11], a[32:35], v[96:99]
    ds_read_b64_tr_b16 a[106:107], v30 offset:51200
    v_mfma_f32_16x16x32_bf16 v[100:103], a[8:11], a[36:39], v[100:103]
    v_mfma_f32_16x16x32_bf16 v[104:107], a[8:11], a[40:43], v[104:107]
    ds_read_b128 a[76:79], v27 offset:38912
    v_mfma_f32_16x16x32_bf16 v[108:111], a[8:11], a[44:47], v[108:111]
    v_mfma_f32_16x16x32_bf16 v[112:115], a[8:11], a[48:51], v[112:115]
    ds_read_b64_tr_b16 a[108:109], v31 offset:49152
    v_mfma_f32_16x16x32_bf16 v[116:119], a[8:11], a[52:55], v[116:119]
    v_mfma_f32_16x16x32_bf16 v[120:123], a[8:11], a[56:59], v[120:123]
    ds_read_b64_tr_b16 a[110:111], v31 offset:51200
    v_mfma_f32_16x16x32_bf16 v[124:127], a[8:11], a[60:63], v[124:127]
    v_mfma_f32_16x16x32_bf16 v[192:195], a[12:15], a[32:35], v[192:195]
    ds_read_b128 a[80:83], v27 offset:40960
    v_mfma_f32_16x16x32_bf16 v[196:199], a[12:15], a[36:39], v[196:199]
    v_mfma_f32_16x16x32_bf16 v[200:203], a[12:15], a[40:43], v[200:203]
    ds_read_b64_tr_b16 a[112:113], v32 offset:49152
    v_mfma_f32_16x16x32_bf16 v[204:207], a[12:15], a[44:47], v[204:207]
    v_mfma_f32_16x16x32_bf16 v[208:211], a[12:15], a[48:51], v[208:211]
    ds_read_b64_tr_b16 a[114:115], v32 offset:51200
    v_mfma_f32_16x16x32_bf16 v[212:215], a[12:15], a[52:55], v[212:215]
    v_mfma_f32_16x16x32_bf16 v[216:219], a[12:15], a[56:59], v[216:219]
    ds_read_b128 a[84:87], v27 offset:43008
    v_mfma_f32_16x16x32_bf16 v[220:223], a[12:15], a[60:63], v[220:223]
    v_mfma_f32_16x16x32_bf16 v[128:131], a[16:19], a[32:35], v[128:131]
    ds_read_b64_tr_b16 a[116:117], v33 offset:49152
    v_mfma_f32_16x16x32_bf16 v[132:135], a[16:19], a[36:39], v[132:135]
    v_mfma_f32_16x16x32_bf16 v[136:139], a[16:19], a[40:43], v[136:139]
    ds_read_b64_tr_b16 a[118:119], v33 offset:51200
    v_mfma_f32_16x16x32_bf16 v[140:143], a[16:19], a[44:47], v[140:143]
    v_mfma_f32_16x16x32_bf16 v[144:147], a[16:19], a[48:51], v[144:147]
    ds_read_b128 a[88:91], v27 offset:45056
    v_mfma_f32_16x16x32_bf16 v[148:151], a[16:19], a[52:55], v[148:151]
    v_mfma_f32_16x16x32_bf16 v[152:155], a[16:19], a[56:59], v[152:155]
    v_mfma_f32_16x16x32_bf16 v[156:159], a[16:19], a[60:63], v[156:159]
    ds_read_b64_tr_b16 a[120:121], v34 offset:49152
    v_mfma_f32_16x16x32_bf16 v[224:227], a[20:23], a[32:35], v[224:227]
    v_mfma_f32_16x16x32_bf16 v[228:231], a[20:23], a[36:39], v[228:231]
    ds_read_b64_tr_b16 a[122:123], v34 offset:51200
    v_mfma_f32_16x16x32_bf16 v[232:235], a[20:23], a[40:43], v[232:235]
    v_mfma_f32_16x16x32_bf16 v[236:239], a[20:23], a[44:47], v[236:239]
    ds_read_b128 a[92:95], v27 offset:47104
    v_mfma_f32_16x16x32_bf16 v[240:243], a[20:23], a[48:51], v[240:243]
    v_mfma_f32_16x16x32_bf16 v[244:247], a[20:23], a[52:55], v[244:247]
    ds_read_b64_tr_b16 a[124:125], v35 offset:49152
    v_mfma_f32_16x16x32_bf16 v[248:251], a[20:23], a[56:59], v[248:251]
    v_mfma_f32_16x16x32_bf16 v[252:255], a[20:23], a[60:63], v[252:255]
    ds_read_b64_tr_b16 a[126:127], v35 offset:51200
    v_mfma_f32_16x16x32_bf16 a[128:131], a[24:27], a[32:35], a[128:131]
    v_mfma_f32_16x16x32_bf16 a[136:139], a[24:27], a[36:39], a[136:139]
    v_mfma_f32_16x16x32_bf16 a[144:147], a[24:27], a[40:43], a[144:147]
    v_mfma_f32_16x16x32_bf16 a[152:155], a[24:27], a[44:47], a[152:155]
    v_mfma_f32_16x16x32_bf16 a[160:163], a[24:27], a[48:51], a[160:163]
    v_mfma_f32_16x16x32_bf16 a[168:171], a[24:27], a[52:55], a[168:171]
    v_mfma_f32_16x16x32_bf16 a[176:179], a[24:27], a[56:59], a[176:179]
    v_mfma_f32_16x16x32_bf16 a[184:187], a[24:27], a[60:63], a[184:187]
    s_sub_u32 s52, s51, 1
    s_cmp_eq_u32 s52, s46
    s_cbranch_scc1 k12_ool_34
k12_oolret_35:
    v_mfma_f32_16x16x32_bf16 a[132:135], a[28:31], a[32:35], a[132:135]
    v_mfma_f32_16x16x32_bf16 a[140:143], a[28:31], a[36:39], a[140:143]
    v_mfma_f32_16x16x32_bf16 a[148:151], a[28:31], a[40:43], a[148:151]
    v_mfma_f32_16x16x32_bf16 a[156:159], a[28:31], a[44:47], a[156:159]
    v_mfma_f32_16x16x32_bf16 a[164:167], a[28:31], a[48:51], a[164:167]
    v_mfma_f32_16x16x32_bf16 a[172:175], a[28:31], a[52:55], a[172:175]
    v_mfma_f32_16x16x32_bf16 a[180:183], a[28:31], a[56:59], a[180:183]
    v_mfma_f32_16x16x32_bf16 a[188:191], a[28:31], a[60:63], a[188:191]
    s_waitcnt vmcnt(0) lgkmcnt(0)
    s_barrier
    s_cmp_eq_u32 s51, 7
    s_cbranch_scc1 k12_last_25
    v_mfma_f32_16x16x32_bf16 v[64:67], a[64:67], a[96:99], v[64:67]
    ds_read_b128 a[0:3], v26 offset:0
    v_mfma_f32_16x16x32_bf16 v[68:71], a[64:67], a[100:103], v[68:71]
    s_add_u32 m0, s48, 32768
    ds_read_b64_tr_b16 a[32:33], v28 offset:0
    v_mfma_f32_16x16x32_bf16 v[72:75], a[64:67], a[104:107], v[72:75]
    buffer_load_dwordx4 v10, s[16:19], s49 offen offset:0 lds
    v_mfma_f32_16x16x32_bf16 v[76:79], a[64:67], a[108:111], v[76:79]
    ds_read_b64_tr_b16 a[34:35], v28 offset:2048
    v_mfma_f32_16x16x32_bf16 v[80:83], a[64:67], a[112:115], v[80:83]
    buffer_load_dwordx4 v11, s[16:19], s49 offen offset:1024 lds
    v_mfma_f32_16x16x32_bf16 v[84:87], a[64:67], a[116:119], v[84:87]
    ds_read_b128 a[4:7], v26 offset:2048
    v_mfma_f32_16x16x32_bf16 v[88:91], a[64:67], a[120:123], v[88:91]
    v_mfma_f32_16x16x32_bf16 v[92:95], a[64:67], a[124:127], v[92:95]
    ds_read_b64_tr_b16 a[36:37], v29 offset:0
    v_mfma_f32_16x16x32_bf16 v[160:163], a[68:71], a[96:99], v[160:163]
    buffer_load_dwordx4 v12, s[16:19], s49 offen offset:2048 lds
    v_mfma_f32_16x16x32_bf16 v[164:167], a[68:71], a[100:103], v[164:167]
    ds_read_b64_tr_b16 a[38:39], v29 offset:2048
    v_mfma_f32_16x16x32_bf16 v[168:171], a[68:71], a[104:107], v[168:171]
    v_mfma_f32_16x16x32_bf16 v[172:175], a[68:71], a[108:111], v[172:175]
    buffer_load_dwordx4 v13, s[16:19], s49 offen offset:3072 lds
    ds_read_b128 a[8:11], v26 offset:4096
    v_mfma_f32_16x16x32_bf16 v[176:179], a[68:71], a[112:115], v[176:179]
    v_mfma_f32_16x16x32_bf16 v[180:183], a[68:71], a[116:119], v[180:183]
    s_add_u32 m0, s48, 36864
    v_mfma_f32_16x16x32_bf16 v[184:187], a[68:71], a[120:123], v[184:187]
    ds_read_b64_tr_b16 a[40:41], v30 offset:0
    v_mfma_f32_16x16x32_bf16 v[188:191], a[68:71], a[124:127], v[188:191]
    buffer_load_dwordx4 v14, s[16:19], s49 offen offset:0 lds
    v_mfma_f32_16x16x32_bf16 v[96:99], a[72:75], a[96:99], v[96:99]
    ds_read_b64_tr_b16 a[42:43], v30 offset:2048
    v_mfma_f32_16x16x32_bf16 v[100:103], a[72:75], a[100:103], v[100:103]
    v_mfma_f32_16x16x32_bf16 v[104:107], a[72:75], a[104:107], v[104:107]
    buffer_load_dwordx4 v15, s[16:19], s49 offen offset:1024 lds
    ds_read_b128 a[12:15], v26 offset:6144
    v_mfma_f32_16x16x32_bf16 v[108:111], a[72:75], a[108:111], v[108:111]
    v_mfma_f32_16x16x32_bf16 v[112:115], a[72:75], a[112:115], v[112:115]
    ds_read_b64_tr_b16 a[44:45], v31 offset:0
    v_mfma_f32_16x16x32_bf16 v[116:119], a[72:75], a[116:119], v[116:119]
    v_mfma_f32_16x16x32_bf16 v[120:123], a[72:75], a[120:123], v[120:123]
    buffer_load_dwordx4 v16, s[16:19], s49 offen offset:2048 lds
    ds_read_b64_tr_b16 a[46:47], v31 offset:2048
    v_mfma_f32_16x16x32_bf16 v[124:127], a[72:75], a[124:127], v[124:127]
    v_mfma_f32_16x16x32_bf16 v[192:195], a[76:79], a[96:99], v[192:195]
    ds_read_b128 a[16:19], v26 offset:8192
    v_mfma_f32_16x16x32_bf16 v[196:199], a[76:79], a[100:103], v[196:199]
    buffer_load_dwordx4 v17, s[16:19], s49 offen offset:3072 lds
    v_mfma_f32_16x16x32_bf16 v[200:203], a[76:79], a[104:107], v[200:203]
    ds_read_b64_tr_b16 a[48:49], v32 offset:0
    v_mfma_f32_16x16x32_bf16 v[204:207], a[76:79], a[108:111], v[204:207]
    s_add_u32 s49, s49, 128
    v_mfma_f32_16x16x32_bf16 v[208:211], a[76:79], a[112:115], v[208:211]
    s_add_u32 m0, s48, 98304
    ds_read_b64_tr_b16 a[50:51], v32 offset:2048
    v_mfma_f32_16x16x32_bf16 v[212:215], a[76:79], a[116:119], v[212:215]
    buffer_load_dwordx4 v18, s[20:23], s50 offen offset:0 lds
    v_mfma_f32_16x16x32_bf16 v[216:219], a[76:79], a[120:123], v[216:219]
    ds_read_b128 a[20:23], v26 offset:10240
    v_mfma_f32_16x16x32_bf16 v[220:223], a[76:79], a[124:127], v[220:223]
    v_mfma_f32_16x16x32_bf16 v[128:131], a[80:83], a[96:99], v[128:131]
    buffer_load_dwordx4 v19, s[20:23], s50 offen offset:1024 lds
    ds_read_b64_tr_b16 a[52:53], v33 offset:0
    v_mfma_f32_16x16x32_bf16 v[132:135], a[80:83], a[100:103], v[132:135]
    v_mfma_f32_16x16x32_bf16 v[136:139], a[80:83], a[104:107], v[136:139]
    ds_read_b64_tr_b16 a[54:55], v33 offset:2048
    v_mfma_f32_16x16x32_bf16 v[140:143], a[80:83], a[108:111], v[140:143]
    buffer_load_dwordx4 v20, s[20:23], s50 offen offset:2048 lds
    v_mfma_f32_16x16x32_bf16 v[144:147], a[80:83], a[112:115], v[144:147]
    ds_read_b128 a[24:27], v26 offset:12288
    v_mfma_f32_16x16x32_bf16 v[148:151], a[80:83], a[116:119], v[148:151]
    v_mfma_f32_16x16x32_bf16 v[152:155], a[80:83], a[120:123], v[152:155]
    v_mfma_f32_16x16x32_bf16 v[156:159], a[80:83], a[124:127], v[156:159]
    buffer_load_dwordx4 v21, s[20:23], s50 offen offset:3072 lds
    ds_read_b64_tr_b16 a[56:57], v34 offset:0
    v_mfma_f32_16x16x32_bf16 v[224:227], a[84:87], a[96:99], v[224:227]
    s_add_u32 m0, s48, 102400
    v_mfma_f32_16x16x32_bf16 v[228:231], a[84:87], a[100:103], v[228:231]
    ds_read_b64_tr_b16 a[58:59], v34 offset:2048
    v_mfma_f32_16x16x32_bf16 v[232:235], a[84:87], a[104:107], v[232:235]
    buffer_load_dwordx4 v22, s[20:23], s50 offen offset:0 lds
    v_mfma_f32_16x16x32_bf16 v[236:239], a[84:87], a[108:111], v[236:239]
    ds_read_b128 a[28:31], v26 offset:14336
    v_mfma_f32_16x16x32_bf16 v[240:243], a[84:87], a[112:115], v[240:243]
    v_mfma_f32_16x16x32_bf16 v[244:247], a[84:87], a[116:119], v[244:247]
    ds_read_b64_tr_b16 a[60:61], v35 offset:0
    v_mfma_f32_16x16x32_bf16 v[248:251], a[84:87], a[120:123], v[248:251]
    buffer_load_dwordx4 v23, s[20:23], s50 offen offset:1024 lds
    v_mfma_f32_16x16x32_bf16 v[252:255], a[84:87], a[124:127], v[252:255]
    ds_read_b64_tr_b16 a[62:63], v35 offset:2048
    v_mfma_f32_16x16x32_bf16 a[128:131], a[88:91], a[96:99], a[128:131]
    v_mfma_f32_16x16x32_bf16 a[136:139], a[88:91], a[100:103], a[136:139]
    buffer_load_dwordx4 v24, s[20:23], s50 offen offset:2048 lds
    v_mfma_f32_16x16x32_bf16 a[144:147], a[88:91], a[104:107], a[144:147]
    v_mfma_f32_16x16x32_bf16 a[152:155], a[88:91], a[108:111], a[152:155]
    v_mfma_f32_16x16x32_bf16 a[160:163], a[88:91], a[112:115], a[160:163]
    v_mfma_f32_16x16x32_bf16 a[168:171], a[88:91], a[116:119], a[168:171]
    buffer_load_dwordx4 v25, s[20:23], s50 offen offset:3072 lds
    v_mfma_f32_16x16x32_bf16 a[176:179], a[88:91], a[120:123], a[176:179]
    v_mfma_f32_16x16x32_bf16 a[184:187], a[88:91], a[124:127], a[184:187]
    s_add_u32 s50, s50, 0x80000
    v_mfma_f32_16x16x32_bf16 a[132:135], a[92:95], a[96:99], a[132:135]
    v_mfma_f32_16x16x32_bf16 a[140:143], a[92:95], a[100:103], a[140:143]
    s_cmp_eq_u32 s51, s53
    s_cbranch_scc1 k12_ool_36
k12_oolret_37:
    v_mfma_f32_16x16x32_bf16 a[148:151], a[92:95], a[104:107], a[148:151]
    v_mfma_f32_16x16x32_bf16 a[156:159], a[92:95], a[108:111], a[156:159]
    s_cmp_eq_u32 s51, 5
    s_cbranch_scc1 k12_ool_38
k12_oolret_39:
    v_mfma_f32_16x16x32_bf16 a[164:167], a[92:95], a[112:115], a[164:167]
    v_mfma_f32_16x16x32_bf16 a[172:175], a[92:95], a[116:119], a[172:175]
    s_add_u32 s51, s51, 1
    v_mfma_f32_16x16x32_bf16 a[180:183], a[92:95], a[120:123], a[180:183]
    v_mfma_f32_16x16x32_bf16 a[188:191], a[92:95], a[124:127], a[188:191]
    s_waitcnt lgkmcnt(0)
    s_branch k12_loop_24
k12_last_25:
    v_mfma_f32_16x16x32_bf16 v[64:67], a[64:67], a[96:99], v[64:67]
    s_add_u32 m0, s60, 98304
    v_mfma_f32_16x16x32_bf16 v[160:163], a[68:71], a[96:99], v[160:163]
    buffer_load_dwordx4 v38, s[12:15], s61 offen offset:0 lds
    v_mfma_f32_16x16x32_bf16 v[68:71], a[64:67], a[100:103], v[68:71]
    buffer_load_dwordx4 v39, s[12:15], s61 offen offset:1024 lds
    v_mfma_f32_16x16x32_bf16 v[164:167], a[68:71], a[100:103], v[164:167]
    v_mfma_f32_16x16x32_bf16 v[72:75], a[64:67], a[104:107], v[72:75]
    buffer_load_dwordx4 v40, s[12:15], s61 offen offset:2048 lds
    v_mfma_f32_16x16x32_bf16 v[168:171], a[68:71], a[104:107], v[168:171]
    v_cvt_pk_bf16_f32 v64, v64, v65
    v_cvt_pk_bf16_f32 v65, v66, v67
    v_cvt_pk_bf16_f32 v66, v160, v161
    v_mfma_f32_16x16x32_bf16 v[76:79], a[64:67], a[108:111], v[76:79]
    v_cvt_pk_bf16_f32 v67, v162, v163
    v_mfma_f32_16x16x32_bf16 v[172:175], a[68:71], a[108:111], v[172:175]
    v_cvt_pk_bf16_f32 v68, v68, v69
    v_cvt_pk_bf16_f32 v69, v70, v71
    v_cvt_pk_bf16_f32 v70, v164, v165
    v_mfma_f32_16x16x32_bf16 v[80:83], a[64:67], a[112:115], v[80:83]
    buffer_load_dwordx4 v41, s[12:15], s61 offen offset:3072 lds
    v_mfma_f32_16x16x32_bf16 v[176:179], a[68:71], a[112:115], v[176:179]
    s_add_u32 s61, s61, 0x80000
    v_cvt_pk_bf16_f32 v71, v166, v167
    v_cvt_pk_bf16_f32 v72, v72, v73
    v_cvt_pk_bf16_f32 v73, v74, v75
    v_mfma_f32_16x16x32_bf16 v[84:87], a[64:67], a[116:119], v[84:87]
    buffer_load_dwordx4 a[192:195], v36, s[8:11], s62 offen offset:0 sc1
    buffer_load_dwordx4 a[196:199], v36, s[8:11], s62 offen offset:1024 sc1
    v_mfma_f32_16x16x32_bf16 v[180:183], a[68:71], a[116:119], v[180:183]
    v_cvt_pk_bf16_f32 v74, v168, v169
    v_cvt_pk_bf16_f32 v75, v170, v171
    v_cvt_pk_bf16_f32 v76, v76, v77
    v_mfma_f32_16x16x32_bf16 v[88:91], a[64:67], a[120:123], v[88:91]
    v_cvt_pk_bf16_f32 v77, v78, v79
    v_cvt_pk_bf16_f32 v78, v172, v173
    v_cvt_pk_bf16_f32 v79, v174, v175
    v_mfma_f32_16x16x32_bf16 v[184:187], a[68:71], a[120:123], v[184:187]
    v_cvt_pk_bf16_f32 v80, v80, v81
    v_cvt_pk_bf16_f32 v81, v82, v83
    v_cvt_pk_bf16_f32 v82, v176, v177
    v_mfma_f32_16x16x32_bf16 v[92:95], a[64:67], a[124:127], v[92:95]
    buffer_load_dwordx4 a[200:203], v37, s[8:11], s62 offen offset:0 sc1
    buffer_load_dwordx4 a[204:207], v37, s[8:11], s62 offen offset:1024 sc1
    v_mfma_f32_16x16x32_bf16 v[188:191], a[68:71], a[124:127], v[188:191]
    s_add_u32 s62, s62, 0x20000
    v_cvt_pk_bf16_f32 v83, v178, v179
    v_cvt_pk_bf16_f32 v84, v84, v85
    v_cvt_pk_bf16_f32 v85, v86, v87
    v_mfma_f32_16x16x32_bf16 a[128:131], a[88:91], a[96:99], a[128:131]
    v_cvt_pk_bf16_f32 v86, v180, v181
    v_cvt_pk_bf16_f32 v87, v182, v183
    v_mfma_f32_16x16x32_bf16 a[132:135], a[92:95], a[96:99], a[132:135]
    v_cvt_pk_bf16_f32 v88, v88, v89
    v_cvt_pk_bf16_f32 v89, v90, v91
    v_cvt_pk_bf16_f32 v90, v184, v185
    v_mfma_f32_16x16x32_bf16 v[96:99], a[72:75], a[96:99], v[96:99]
    buffer_load_dwordx4 a[208:211], v36, s[8:11], s62 offen offset:0 sc1
    buffer_load_dwordx4 a[212:215], v36, s[8:11], s62 offen offset:1024 sc1
    v_mfma_f32_16x16x32_bf16 v[192:195], a[76:79], a[96:99], v[192:195]
    v_cvt_pk_bf16_f32 v91, v186, v187
    v_cvt_pk_bf16_f32 v92, v92, v93
    v_cvt_pk_bf16_f32 v93, v94, v95
    v_mfma_f32_16x16x32_bf16 v[100:103], a[72:75], a[100:103], v[100:103]
    v_cvt_pk_bf16_f32 v94, v188, v189
    v_cvt_pk_bf16_f32 v95, v190, v191
    v_mfma_f32_16x16x32_bf16 v[196:199], a[76:79], a[100:103], v[196:199]
    v_accvgpr_read_b32 v56, a128
    v_accvgpr_read_b32 v57, a129
    v_accvgpr_read_b32 v58, a130
    v_mfma_f32_16x16x32_bf16 a[136:139], a[88:91], a[100:103], a[136:139]
    buffer_load_dwordx4 a[216:219], v37, s[8:11], s62 offen offset:0 sc1
    buffer_load_dwordx4 a[220:223], v37, s[8:11], s62 offen offset:1024 sc1
    v_mfma_f32_16x16x32_bf16 a[140:143], a[92:95], a[100:103], a[140:143]
    s_add_u32 s62, s62, 0x20000
    v_accvgpr_read_b32 v59, a131
    v_accvgpr_read_b32 v60, a132
    v_cvt_pk_bf16_f32 v96, v96, v97
    v_mfma_f32_16x16x32_bf16 v[104:107], a[72:75], a[104:107], v[104:107]
    s_add_u32 m0, s60, 114688
    v_accvgpr_read_b32 v61, a133
    v_accvgpr_read_b32 v62, a134
    v_cvt_pk_bf16_f32 v97, v98, v99
    v_mfma_f32_16x16x32_bf16 v[200:203], a[76:79], a[104:107], v[200:203]
    v_accvgpr_read_b32 v63, a135
    v_cvt_pk_bf16_f32 v98, v192, v193
    v_cvt_pk_bf16_f32 v160, v56, v57
    v_mfma_f32_16x16x32_bf16 v[108:111], a[72:75], a[108:111], v[108:111]
    v_cvt_pk_bf16_f32 v99, v194, v195
    v_cvt_pk_bf16_f32 v161, v58, v59
    v_cvt_pk_bf16_f32 v100, v100, v101
    v_mfma_f32_16x16x32_bf16 v[204:207], a[76:79], a[108:111], v[204:207]
    buffer_load_dwordx4 v38, s[12:15], s61 offen offset:0 lds
    buffer_load_dwordx4 v39, s[12:15], s61 offen offset:1024 lds
    v_mfma_f32_16x16x32_bf16 a[144:147], a[88:91], a[104:107], a[144:147]
    v_cvt_pk_bf16_f32 v162, v60, v61
    v_cvt_pk_bf16_f32 v101, v102, v103
    v_cvt_pk_bf16_f32 v163, v62, v63
    v_mfma_f32_16x16x32_bf16 a[148:151], a[92:95], a[104:107], a[148:151]
    v_cvt_pk_bf16_f32 v102, v196, v197
    v_cvt_pk_bf16_f32 v103, v198, v199
    v_accvgpr_read_b32 v56, a136
    v_mfma_f32_16x16x32_bf16 v[112:115], a[72:75], a[112:115], v[112:115]
    v_accvgpr_read_b32 v57, a137
    v_accvgpr_read_b32 v58, a138
    v_accvgpr_read_b32 v59, a139
    v_mfma_f32_16x16x32_bf16 v[208:211], a[76:79], a[112:115], v[208:211]
    v_accvgpr_read_b32 v60, a140
    v_cvt_pk_bf16_f32 v104, v104, v105
    v_accvgpr_read_b32 v61, a141
    v_mfma_f32_16x16x32_bf16 v[116:119], a[72:75], a[116:119], v[116:119]
    buffer_load_dwordx4 v40, s[12:15], s61 offen offset:2048 lds
    buffer_load_dwordx4 v41, s[12:15], s61 offen offset:3072 lds
    v_mfma_f32_16x16x32_bf16 v[212:215], a[76:79], a[116:119], v[212:215]
    s_add_u32 s61, s61, 0x80000
    v_accvgpr_read_b32 v62, a142
    v_cvt_pk_bf16_f32 v105, v106, v107
    v_accvgpr_read_b32 v63, a143
    v_mfma_f32_16x16x32_bf16 a[152:155], a[88:91], a[108:111], a[152:155]
    v_cvt_pk_bf16_f32 v106, v200, v201
    v_cvt_pk_bf16_f32 v164, v56, v57
    v_cvt_pk_bf16_f32 v107, v202, v203
    v_mfma_f32_16x16x32_bf16 a[156:159], a[92:95], a[108:111], a[156:159]
    v_cvt_pk_bf16_f32 v165, v58, v59
    v_cvt_pk_bf16_f32 v108, v108, v109
    v_cvt_pk_bf16_f32 v166, v60, v61
    v_mfma_f32_16x16x32_bf16 v[120:123], a[72:75], a[120:123], v[120:123]
    v_cvt_pk_bf16_f32 v109, v110, v111
    v_cvt_pk_bf16_f32 v167, v62, v63
    v_cvt_pk_bf16_f32 v110, v204, v205
    v_mfma_f32_16x16x32_bf16 v[216:219], a[76:79], a[120:123], v[216:219]
    buffer_load_dwordx4 a[224:227], v36, s[8:11], s62 offen offset:0 sc1
    v_cvt_pk_bf16_f32 v111, v206, v207
    v_accvgpr_read_b32 v56, a144
    v_mfma_f32_16x16x32_bf16 v[124:127], a[72:75], a[124:127], v[124:127]
    v_accvgpr_read_b32 v57, a145
    v_accvgpr_read_b32 v58, a146
    v_accvgpr_read_b32 v59, a147
    v_mfma_f32_16x16x32_bf16 v[220:223], a[76:79], a[124:127], v[220:223]
    buffer_load_dwordx4 a[228:231], v36, s[8:11], s62 offen offset:1024 sc1
    v_accvgpr_read_b32 v60, a148
    v_cvt_pk_bf16_f32 v112, v112, v113
    v_mfma_f32_16x16x32_bf16 a[160:163], a[88:91], a[112:115], a[160:163]
    v_accvgpr_read_b32 v61, a149
    v_accvgpr_read_b32 v62, a150
    v_cvt_pk_bf16_f32 v113, v114, v115
    v_mfma_f32_16x16x32_bf16 a[164:167], a[92:95], a[112:115], a[164:167]
    v_accvgpr_read_b32 v63, a151
    v_cvt_pk_bf16_f32 v114, v208, v209
    v_cvt_pk_bf16_f32 v168, v56, v57
    v_mfma_f32_16x16x32_bf16 v[128:131], a[80:83], a[96:99], v[128:131]
    v_cvt_pk_bf16_f32 v115, v210, v211
    v_cvt_pk_bf16_f32 v169, v58, v59
    v_cvt_pk_bf16_f32 v116, v116, v117
    v_mfma_f32_16x16x32_bf16 v[224:227], a[84:87], a[96:99], v[224:227]
    buffer_load_dwordx4 a[232:235], v37, s[8:11], s62 offen offset:0 sc1
    v_cvt_pk_bf16_f32 v170, v60, v61
    v_cvt_pk_bf16_f32 v117, v118, v119
    v_mfma_f32_16x16x32_bf16 v[132:135], a[80:83], a[100:103], v[132:135]
    v_cvt_pk_bf16_f32 v171, v62, v63
    v_cvt_pk_bf16_f32 v118, v212, v213
    v_cvt_pk_bf16_f32 v119, v214, v215
    v_mfma_f32_16x16x32_bf16 v[228:231], a[84:87], a[100:103], v[228:231]
    buffer_load_dwordx4 a[236:239], v37, s[8:11], s62 offen offset:1024 sc1
    v_accvgpr_read_b32 v56, a152
    v_accvgpr_read_b32 v57, a153
    v_mfma_f32_16x16x32_bf16 a[168:171], a[88:91], a[116:119], a[168:171]
    s_add_u32 s62, s62, 0x20000
    v_accvgpr_read_b32 v58, a154
    v_accvgpr_read_b32 v59, a155
    v_accvgpr_read_b32 v60, a156
    v_mfma_f32_16x16x32_bf16 a[172:175], a[92:95], a[116:119], a[172:175]
    s_waitcnt vmcnt(16)
    s_barrier
    v_cvt_pk_bf16_f32 v120, v120, v121
    v_accvgpr_read_b32 v61, a157
    v_accvgpr_read_b32 v62, a158
    v_mfma_f32_16x16x32_bf16 v[136:139], a[80:83], a[104:107], v[136:139]
    v_cvt_pk_bf16_f32 v121, v122, v123
    v_accvgpr_read_b32 v63, a159
    v_cvt_pk_bf16_f32 v122, v216, v217
    v_mfma_f32_16x16x32_bf16 v[232:235], a[84:87], a[104:107], v[232:235]
    v_cvt_pk_bf16_f32 v172, v56, v57
    v_cvt_pk_bf16_f32 v123, v218, v219
    v_cvt_pk_bf16_f32 v173, v58, v59
    v_mfma_f32_16x16x32_bf16 v[140:143], a[80:83], a[108:111], v[140:143]
    v_cvt_pk_bf16_f32 v124, v124, v125
    v_cvt_pk_bf16_f32 v174, v60, v61
    v_cvt_pk_bf16_f32 v125, v126, v127
    v_mfma_f32_16x16x32_bf16 v[236:239], a[84:87], a[108:111], v[236:239]
    v_cvt_pk_bf16_f32 v175, v62, v63
    v_cvt_pk_bf16_f32 v126, v220, v221
    v_cvt_pk_bf16_f32 v127, v222, v223
    v_mfma_f32_16x16x32_bf16 a[176:179], a[88:91], a[120:123], a[176:179]
    ds_read_b64_tr_b16 a[0:1], v42 offset:0
    v_accvgpr_read_b32 v56, a160
    v_accvgpr_read_b32 v57, a161
    v_mfma_f32_16x16x32_bf16 a[180:183], a[92:95], a[120:123], a[180:183]
    ds_read_b64_tr_b16 a[2:3], v42 offset:1024
    v_accvgpr_read_b32 v58, a162
    v_accvgpr_read_b32 v59, a163
    v_mfma_f32_16x16x32_bf16 v[144:147], a[80:83], a[112:115], v[144:147]
    ds_read_b64_tr_b16 a[4:5], v43 offset:0
    v_accvgpr_read_b32 v60, a164
    v_cvt_pk_bf16_f32 v128, v128, v129
    v_mfma_f32_16x16x32_bf16 v[240:243], a[84:87], a[112:115], v[240:243]
    v_accvgpr_read_b32 v61, a165
    v_accvgpr_read_b32 v62, a166
    v_cvt_pk_bf16_f32 v129, v130, v131
    v_mfma_f32_16x16x32_bf16 v[148:151], a[80:83], a[116:119], v[148:151]
    ds_read_b64_tr_b16 a[6:7], v43 offset:1024
    v_accvgpr_read_b32 v63, a167
    v_cvt_pk_bf16_f32 v130, v224, v225
    v_mfma_f32_16x16x32_bf16 v[244:247], a[84:87], a[116:119], v[244:247]
    v_cvt_pk_bf16_f32 v176, v56, v57
    v_cvt_pk_bf16_f32 v131, v226, v227
    v_cvt_pk_bf16_f32 v177, v58, v59
    v_mfma_f32_16x16x32_bf16 a[184:187], a[88:91], a[124:127], a[184:187]
    ds_read_b64_tr_b16 a[8:9], v44 offset:0
    v_cvt_pk_bf16_f32 v132, v132, v133
    v_cvt_pk_bf16_f32 v178, v60, v61
    v_mfma_f32_16x16x32_bf16 a[188:191], a[92:95], a[124:127], a[188:191]
    ds_read_b64_tr_b16 a[10:11], v44 offset:1024
    v_cvt_pk_bf16_f32 v133, v134, v135
    v_cvt_pk_bf16_f32 v179, v62, v63
    v_mfma_f32_16x16x32_bf16 v[152:155], a[80:83], a[120:123], v[152:155]
    ds_read_b64_tr_b16 a[12:13], v45 offset:0
    v_cvt_pk_bf16_f32 v134, v228, v229
    v_cvt_pk_bf16_f32 v135, v230, v231
    v_mfma_f32_16x16x32_bf16 v[248:251], a[84:87], a[120:123], v[248:251]
    ds_read_b64_tr_b16 a[14:15], v45 offset:1024
    v_accvgpr_read_b32 v56, a168
    v_accvgpr_read_b32 v57, a169
    v_mfma_f32_16x16x32_bf16 v[156:159], a[80:83], a[124:127], v[156:159]
    ds_read_b64_tr_b16 a[16:17], v46 offset:0
    v_accvgpr_read_b32 v58, a170
    v_accvgpr_read_b32 v59, a171
    v_mfma_f32_16x16x32_bf16 v[252:255], a[84:87], a[124:127], v[252:255]
    v_accvgpr_read_b32 v60, a172
    v_cvt_pk_bf16_f32 v136, v136, v137
    v_accvgpr_read_b32 v61, a173
    ds_read_b64_tr_b16 a[18:19], v46 offset:1024
    v_accvgpr_read_b32 v62, a174
    v_cvt_pk_bf16_f32 v137, v138, v139
    v_accvgpr_read_b32 v63, a175
    v_cvt_pk_bf16_f32 v138, v232, v233
    v_cvt_pk_bf16_f32 v180, v56, v57
    ds_read_b64_tr_b16 a[20:21], v47 offset:0
    v_cvt_pk_bf16_f32 v139, v234, v235
    v_cvt_pk_bf16_f32 v181, v58, v59
    v_cvt_pk_bf16_f32 v140, v140, v141
    v_cvt_pk_bf16_f32 v182, v60, v61
    ds_read_b64_tr_b16 a[22:23], v47 offset:1024
    v_cvt_pk_bf16_f32 v141, v142, v143
    v_cvt_pk_bf16_f32 v183, v62, v63
    v_cvt_pk_bf16_f32 v142, v236, v237
    ds_read_b64_tr_b16 a[24:25], v48 offset:0
    v_cvt_pk_bf16_f32 v143, v238, v239
    v_accvgpr_read_b32 v56, a176
    ds_read_b64_tr_b16 a[26:27], v48 offset:1024
    v_accvgpr_read_b32 v57, a177
    v_accvgpr_read_b32 v58, a178
    ds_read_b64_tr_b16 a[28:29], v49 offset:0
    v_accvgpr_read_b32 v59, a179
    v_accvgpr_read_b32 v60, a180
    v_cvt_pk_bf16_f32 v144, v144, v145
    ds_read_b64_tr_b16 a[30:31], v49 offset:1024
    v_accvgpr_read_b32 v61, a181
    v_accvgpr_read_b32 v62, a182
    v_cvt_pk_bf16_f32 v145, v146, v147
    v_accvgpr_read_b32 v63, a183
    v_cvt_pk_bf16_f32 v146, v240, v241
    v_cvt_pk_bf16_f32 v184, v56, v57
    v_cvt_pk_bf16_f32 v147, v242, v243
    v_cvt_pk_bf16_f32 v185, v58, v59
    v_cvt_pk_bf16_f32 v148, v148, v149
    v_cvt_pk_bf16_f32 v186, v60, v61
    v_cvt_pk_bf16_f32 v149, v150, v151
    v_cvt_pk_bf16_f32 v187, v62, v63
    v_cvt_pk_bf16_f32 v150, v244, v245
    v_cvt_pk_bf16_f32 v151, v246, v247
    v_accvgpr_read_b32 v56, a184
    v_accvgpr_read_b32 v57, a185
    v_accvgpr_read_b32 v58, a186
    v_accvgpr_read_b32 v59, a187
    v_accvgpr_read_b32 v60, a188
    v_cvt_pk_bf16_f32 v152, v152, v153
    v_accvgpr_read_b32 v61, a189
    v_accvgpr_read_b32 v62, a190
    v_cvt_pk_bf16_f32 v153, v154, v155
    v_accvgpr_read_b32 v63, a191
    v_cvt_pk_bf16_f32 v154, v248, v249
    v_cvt_pk_bf16_f32 v188, v56, v57
    v_cvt_pk_bf16_f32 v155, v250, v251
    v_cvt_pk_bf16_f32 v189, v58, v59
    v_cvt_pk_bf16_f32 v156, v156, v157
    v_cvt_pk_bf16_f32 v190, v60, v61
    v_cvt_pk_bf16_f32 v157, v158, v159
    v_cvt_pk_bf16_f32 v191, v62, v63
    v_cvt_pk_bf16_f32 v158, v252, v253
    v_cvt_pk_bf16_f32 v159, v254, v255
k12_join_7:
k12_qcode:
    s_mov_b64 s[48:49], s[32:33]
    s_mov_b32 s51, 0x00020000
    s_cmp_eq_u32 s45, 0
    s_mov_b32 s50, s34
    s_cselect_b32 s56, s30, -1
    s_cselect_b32 s57, -1, s30
    s_waitcnt vmcnt(12) lgkmcnt(0)
    v_mfma_f32_16x16x32_bf16 v[192:195], a[0:3], a[192:195], 0
    ds_read_b64_tr_b16 a[32:33], v42 offset:8192
    ds_read_b64_tr_b16 a[34:35], v42 offset:9216
    v_mfma_f32_16x16x32_bf16 v[196:199], a[0:3], a[196:199], 0
    buffer_load_dwordx4 a[240:243], v36, s[8:11], s62 offen offset:0 sc1
    v_mfma_f32_16x16x32_bf16 a[64:67], a[0:3], a[200:203], 0
    ds_read_b64_tr_b16 a[36:37], v43 offset:8192
    v_mfma_f32_16x16x32_bf16 a[68:71], a[0:3], a[204:207], 0
    ds_read_b64_tr_b16 a[38:39], v43 offset:9216
    v_mfma_f32_16x16x32_bf16 v[200:203], a[4:7], a[192:195], 0
    ds_read_b64_tr_b16 a[40:41], v44 offset:8192
    v_mfma_f32_16x16x32_bf16 v[204:207], a[4:7], a[196:199], 0
    buffer_load_dwordx4 a[244:247], v36, s[8:11], s62 offen offset:1024 sc1
    v_mfma_f32_16x16x32_bf16 a[72:75], a[4:7], a[200:203], 0
    s_lshl_b32 s31, s28, 14
    ds_read_b64_tr_b16 a[42:43], v44 offset:9216
    v_mfma_f32_16x16x32_bf16 a[76:79], a[4:7], a[204:207], 0
    s_add_u32 s16, s6, s31
    s_addc_u32 s17, s7, 0
    ds_read_b64_tr_b16 a[44:45], v45 offset:8192
    v_mfma_f32_16x16x32_bf16 v[208:211], a[8:11], a[192:195], 0
    v_mfma_f32_16x16x32_bf16 v[212:215], a[8:11], a[196:199], 0
    s_add_u32 s20, s16, 0x2000000
    s_addc_u32 s21, s17, 0
    ds_read_b64_tr_b16 a[46:47], v45 offset:9216
    v_mfma_f32_16x16x32_bf16 a[80:83], a[8:11], a[200:203], 0
    buffer_load_dwordx4 a[248:251], v37, s[8:11], s62 offen offset:0 sc1
    ds_read_b64_tr_b16 a[48:49], v46 offset:8192
    v_mfma_f32_16x16x32_bf16 a[84:87], a[8:11], a[204:207], 0
    s_add_u32 s16, s16, 0x1000000
    s_addc_u32 s17, s17, 0
    ds_read_b64_tr_b16 a[50:51], v46 offset:9216
    v_mfma_f32_16x16x32_bf16 v[216:219], a[12:15], a[192:195], 0
    v_mfma_f32_16x16x32_bf16 v[220:223], a[12:15], a[196:199], 0
    s_and_b32 s17, s17, 0xffff
    ds_read_b64_tr_b16 a[52:53], v47 offset:8192
    v_mfma_f32_16x16x32_bf16 a[88:91], a[12:15], a[200:203], 0
    buffer_load_dwordx4 a[252:255], v37, s[8:11], s62 offen offset:1024 sc1
    ds_read_b64_tr_b16 a[54:55], v47 offset:9216
    v_mfma_f32_16x16x32_bf16 a[92:95], a[12:15], a[204:207], 0
    s_and_b32 s21, s21, 0xffff
    ds_read_b64_tr_b16 a[56:57], v48 offset:8192
    v_mfma_f32_16x16x32_bf16 v[224:227], a[16:19], a[192:195], 0
    v_mfma_f32_16x16x32_bf16 v[228:231], a[16:19], a[196:199], 0
    s_lshl_b32 s31, s29, 20
    ds_read_b64_tr_b16 a[58:59], v48 offset:9216
    v_mfma_f32_16x16x32_bf16 a[96:99], a[16:19], a[200:203], 0
    s_add_u32 s62, s62, 0x20000
    ds_read_b64_tr_b16 a[60:61], v49 offset:8192
    v_mfma_f32_16x16x32_bf16 a[100:103], a[16:19], a[204:207], 0
    s_add_u32 s52, s47, 0
    v_mfma_f32_16x16x32_bf16 v[232:235], a[20:23], a[192:195], 0
    s_sub_u32 s18, 0xf84000, s31
    buffer_store_dwordx4 v[64:67], v1, s[48:51], s52 offen offset:0 sc1
    ds_read_b64_tr_b16 a[62:63], v49 offset:9216
    v_mfma_f32_16x16x32_bf16 v[236:239], a[20:23], a[196:199], 0
    s_add_u32 s52, s47, 0
    v_mfma_f32_16x16x32_bf16 a[104:107], a[20:23], a[200:203], 0
    s_mov_b32 s22, s18
    v_mfma_f32_16x16x32_bf16 a[108:111], a[20:23], a[204:207], 0
    s_add_u32 s24, s6, 0x4806000
    s_addc_u32 s25, s7, 0
    buffer_store_dwordx4 v[68:71], v1, s[48:51], s52 offen offset:1024 sc1
    v_mfma_f32_16x16x32_bf16 v[240:243], a[24:27], a[192:195], 0
    v_mfma_f32_16x16x32_bf16 v[244:247], a[24:27], a[196:199], 0
    s_and_b32 s25, s25, 0xffff
    v_mfma_f32_16x16x32_bf16 a[112:115], a[24:27], a[200:203], 0
    v_mfma_f32_16x16x32_bf16 a[116:119], a[24:27], a[204:207], 0
    s_mov_b32 s26, 4096
    v_mfma_f32_16x16x32_bf16 v[248:251], a[28:31], a[192:195], 0
    s_cmp_eq_u32 s45, 0
    s_cbranch_scc1 k12_ool_40
k12_oolret_41:
    v_mfma_f32_16x16x32_bf16 v[252:255], a[28:31], a[196:199], 0
    v_mfma_f32_16x16x32_bf16 a[120:123], a[28:31], a[200:203], 0
    v_mfma_f32_16x16x32_bf16 a[124:127], a[28:31], a[204:207], 0
    s_waitcnt vmcnt(10) lgkmcnt(0)
    s_barrier
    v_mfma_f32_16x16x32_bf16 v[192:195], a[32:35], a[208:211], v[192:195]
    ds_read_b64_tr_b16 a[0:1], v42 offset:16384
    ds_read_b64_tr_b16 a[2:3], v42 offset:17408
    v_mfma_f32_16x16x32_bf16 v[196:199], a[32:35], a[212:215], v[196:199]
    s_add_u32 m0, s60, 131072
    v_mfma_f32_16x16x32_bf16 a[64:67], a[32:35], a[216:219], a[64:67]
    buffer_load_dwordx4 v38, s[12:15], s61 offen offset:0 lds
    ds_read_b64_tr_b16 a[4:5], v43 offset:16384
    v_mfma_f32_16x16x32_bf16 a[68:71], a[32:35], a[220:223], a[68:71]
    ds_read_b64_tr_b16 a[6:7], v43 offset:17408
    v_mfma_f32_16x16x32_bf16 v[200:203], a[36:39], a[208:211], v[200:203]
    buffer_load_dwordx4 v39, s[12:15], s61 offen offset:1024 lds
    ds_read_b64_tr_b16 a[8:9], v44 offset:16384
    v_mfma_f32_16x16x32_bf16 v[204:207], a[36:39], a[212:215], v[204:207]
    v_mfma_f32_16x16x32_bf16 a[72:75], a[36:39], a[216:219], a[72:75]
    ds_read_b64_tr_b16 a[10:11], v44 offset:17408
    v_mfma_f32_16x16x32_bf16 a[76:79], a[36:39], a[220:223], a[76:79]
    buffer_load_dwordx4 v40, s[12:15], s61 offen offset:2048 lds
    ds_read_b64_tr_b16 a[12:13], v45 offset:16384
    v_mfma_f32_16x16x32_bf16 v[208:211], a[40:43], a[208:211], v[208:211]
    v_mfma_f32_16x16x32_bf16 v[212:215], a[40:43], a[212:215], v[212:215]
    ds_read_b64_tr_b16 a[14:15], v45 offset:17408
    v_mfma_f32_16x16x32_bf16 a[80:83], a[40:43], a[216:219], a[80:83]
    buffer_load_dwordx4 v41, s[12:15], s61 offen offset:3072 lds
    ds_read_b64_tr_b16 a[16:17], v46 offset:16384
    v_mfma_f32_16x16x32_bf16 a[84:87], a[40:43], a[220:223], a[84:87]
    ds_read_b64_tr_b16 a[18:19], v46 offset:17408
    v_mfma_f32_16x16x32_bf16 v[216:219], a[44:47], a[208:211], v[216:219]
    s_add_u32 s61, s61, 0x80000
    v_mfma_f32_16x16x32_bf16 v[220:223], a[44:47], a[212:215], v[220:223]
    buffer_load_dwordx4 a[128:131], v36, s[8:11], s62 offen offset:0 sc1
    ds_read_b64_tr_b16 a[20:21], v47 offset:16384
    v_mfma_f32_16x16x32_bf16 a[88:91], a[44:47], a[216:219], a[88:91]
    ds_read_b64_tr_b16 a[22:23], v47 offset:17408
    v_mfma_f32_16x16x32_bf16 a[92:95], a[44:47], a[220:223], a[92:95]
    buffer_load_dwordx4 a[132:135], v36, s[8:11], s62 offen offset:1024 sc1
    ds_read_b64_tr_b16 a[24:25], v48 offset:16384
    v_mfma_f32_16x16x32_bf16 v[224:227], a[48:51], a[208:211], v[224:227]
    v_mfma_f32_16x16x32_bf16 v[228:231], a[48:51], a[212:215], v[228:231]
    ds_read_b64_tr_b16 a[26:27], v48 offset:17408
    v_mfma_f32_16x16x32_bf16 a[96:99], a[48:51], a[216:219], a[96:99]
    buffer_load_dwordx4 a[136:139], v37, s[8:11], s62 offen offset:0 sc1
    ds_read_b64_tr_b16 a[28:29], v49 offset:16384
    v_mfma_f32_16x16x32_bf16 a[100:103], a[48:51], a[220:223], a[100:103]
    v_mfma_f32_16x16x32_bf16 v[232:235], a[52:55], a[208:211], v[232:235]
    ds_read_b64_tr_b16 a[30:31], v49 offset:17408
    v_mfma_f32_16x16x32_bf16 v[236:239], a[52:55], a[212:215], v[236:239]
    buffer_load_dwordx4 a[140:143], v37, s[8:11], s62 offen offset:1024 sc1
    v_mfma_f32_16x16x32_bf16 a[104:107], a[52:55], a[216:219], a[104:107]
    v_mfma_f32_16x16x32_bf16 a[108:111], a[52:55], a[220:223], a[108:111]
    s_add_u32 s62, s62, 0x20000
    v_mfma_f32_16x16x32_bf16 v[240:243], a[56:59], a[208:211], v[240:243]
    s_add_u32 s52, s47, 0
    v_mfma_f32_16x16x32_bf16 v[244:247], a[56:59], a[212:215], v[244:247]
    buffer_store_dwordx4 v[72:75], v1, s[48:51], s52 offen offset:2048 sc1
    v_mfma_f32_16x16x32_bf16 a[112:115], a[56:59], a[216:219], a[112:115]
    v_mfma_f32_16x16x32_bf16 a[116:119], a[56:59], a[220:223], a[116:119]
    v_mfma_f32_16x16x32_bf16 v[248:251], a[60:63], a[208:211], v[248:251]
    v_mfma_f32_16x16x32_bf16 v[252:255], a[60:63], a[212:215], v[252:255]
    v_mfma_f32_16x16x32_bf16 a[120:123], a[60:63], a[216:219], a[120:123]
    v_mfma_f32_16x16x32_bf16 a[124:127], a[60:63], a[220:223], a[124:127]
    s_waitcnt vmcnt(15) lgkmcnt(0)
    v_mfma_f32_16x16x32_bf16 v[192:195], a[0:3], a[224:227], v[192:195]
    ds_read_b64_tr_b16 a[32:33], v42 offset:24576
    ds_read_b64_tr_b16 a[34:35], v42 offset:25600
    v_mfma_f32_16x16x32_bf16 v[196:199], a[0:3], a[228:231], v[196:199]
    buffer_load_dwordx4 a[144:147], v36, s[8:11], s62 offen offset:0 sc1
    v_mfma_f32_16x16x32_bf16 a[64:67], a[0:3], a[232:235], a[64:67]
    ds_read_b64_tr_b16 a[36:37], v43 offset:24576
    v_mfma_f32_16x16x32_bf16 a[68:71], a[0:3], a[236:239], a[68:71]
    ds_read_b64_tr_b16 a[38:39], v43 offset:25600
    v_mfma_f32_16x16x32_bf16 v[200:203], a[4:7], a[224:227], v[200:203]
    ds_read_b64_tr_b16 a[40:41], v44 offset:24576
    v_mfma_f32_16x16x32_bf16 v[204:207], a[4:7], a[228:231], v[204:207]
    v_mfma_f32_16x16x32_bf16 a[72:75], a[4:7], a[232:235], a[72:75]
    buffer_load_dwordx4 a[148:151], v36, s[8:11], s62 offen offset:1024 sc1
    ds_read_b64_tr_b16 a[42:43], v44 offset:25600
    v_mfma_f32_16x16x32_bf16 a[76:79], a[4:7], a[236:239], a[76:79]
    ds_read_b64_tr_b16 a[44:45], v45 offset:24576
    v_mfma_f32_16x16x32_bf16 v[208:211], a[8:11], a[224:227], v[208:211]
    v_mfma_f32_16x16x32_bf16 v[212:215], a[8:11], a[228:231], v[212:215]
    ds_read_b64_tr_b16 a[46:47], v45 offset:25600
    v_mfma_f32_16x16x32_bf16 a[80:83], a[8:11], a[232:235], a[80:83]
    ds_read_b64_tr_b16 a[48:49], v46 offset:24576
    v_mfma_f32_16x16x32_bf16 a[84:87], a[8:11], a[236:239], a[84:87]
    buffer_load_dwordx4 a[152:155], v37, s[8:11], s62 offen offset:0 sc1
    ds_read_b64_tr_b16 a[50:51], v46 offset:25600
    v_mfma_f32_16x16x32_bf16 v[216:219], a[12:15], a[224:227], v[216:219]
    v_mfma_f32_16x16x32_bf16 v[220:223], a[12:15], a[228:231], v[220:223]
    ds_read_b64_tr_b16 a[52:53], v47 offset:24576
    v_mfma_f32_16x16x32_bf16 a[88:91], a[12:15], a[232:235], a[88:91]
    ds_read_b64_tr_b16 a[54:55], v47 offset:25600
    v_mfma_f32_16x16x32_bf16 a[92:95], a[12:15], a[236:239], a[92:95]
    ds_read_b64_tr_b16 a[56:57], v48 offset:24576
    v_mfma_f32_16x16x32_bf16 v[224:227], a[16:19], a[224:227], v[224:227]
    v_mfma_f32_16x16x32_bf16 v[228:231], a[16:19], a[228:231], v[228:231]
    buffer_load_dwordx4 a[156:159], v37, s[8:11], s62 offen offset:1024 sc1
    ds_read_b64_tr_b16 a[58:59], v48 offset:25600
    v_mfma_f32_16x16x32_bf16 a[96:99], a[16:19], a[232:235], a[96:99]
    ds_read_b64_tr_b16 a[60:61], v49 offset:24576
    v_mfma_f32_16x16x32_bf16 a[100:103], a[16:19], a[236:239], a[100:103]
    v_mfma_f32_16x16x32_bf16 v[232:235], a[20:23], a[224:227], v[232:235]
    ds_read_b64_tr_b16 a[62:63], v49 offset:25600
    v_mfma_f32_16x16x32_bf16 v[236:239], a[20:23], a[228:231], v[236:239]
    s_add_u32 s62, s62, 0x20000
    v_mfma_f32_16x16x32_bf16 a[104:107], a[20:23], a[232:235], a[104:107]
    s_add_u32 s52, s47, 0
    v_mfma_f32_16x16x32_bf16 a[108:111], a[20:23], a[236:239], a[108:111]
    buffer_store_dwordx4 v[76:79], v1, s[48:51], s52 offen offset:3072 sc1
    v_mfma_f32_16x16x32_bf16 v[240:243], a[24:27], a[224:227], v[240:243]
    v_mfma_f32_16x16x32_bf16 v[244:247], a[24:27], a[228:231], v[244:247]
    v_mfma_f32_16x16x32_bf16 a[112:115], a[24:27], a[232:235], a[112:115]
    v_mfma_f32_16x16x32_bf16 a[116:119], a[24:27], a[236:239], a[116:119]
    v_mfma_f32_16x16x32_bf16 v[248:251], a[28:31], a[224:227], v[248:251]
    s_cmp_eq_u32 s45, 0
    s_cbranch_scc1 k12_ool_42
k12_oolret_43:
    v_mfma_f32_16x16x32_bf16 v[252:255], a[28:31], a[228:231], v[252:255]
    v_mfma_f32_16x16x32_bf16 a[120:123], a[28:31], a[232:235], a[120:123]
    v_mfma_f32_16x16x32_bf16 a[124:127], a[28:31], a[236:239], a[124:127]
    s_waitcnt vmcnt(10) lgkmcnt(0)
    s_barrier
    v_mfma_f32_16x16x32_bf16 v[192:195], a[32:35], a[240:243], v[192:195]
    ds_read_b64_tr_b16 a[0:1], v42 offset:32768
    ds_read_b64_tr_b16 a[2:3], v42 offset:33792
    v_mfma_f32_16x16x32_bf16 v[196:199], a[32:35], a[244:247], v[196:199]
    s_add_u32 m0, s60, 147456
    v_mfma_f32_16x16x32_bf16 a[64:67], a[32:35], a[248:251], a[64:67]
    buffer_load_dwordx4 v38, s[12:15], s61 offen offset:0 lds
    ds_read_b64_tr_b16 a[4:5], v43 offset:32768
    v_mfma_f32_16x16x32_bf16 a[68:71], a[32:35], a[252:255], a[68:71]
    ds_read_b64_tr_b16 a[6:7], v43 offset:33792
    v_mfma_f32_16x16x32_bf16 v[200:203], a[36:39], a[240:243], v[200:203]
    buffer_load_dwordx4 v39, s[12:15], s61 offen offset:1024 lds
    ds_read_b64_tr_b16 a[8:9], v44 offset:32768
    v_mfma_f32_16x16x32_bf16 v[204:207], a[36:39], a[244:247], v[204:207]
    v_mfma_f32_16x16x32_bf16 a[72:75], a[36:39], a[248:251], a[72:75]
    ds_read_b64_tr_b16 a[10:11], v44 offset:33792
    v_mfma_f32_16x16x32_bf16 a[76:79], a[36:39], a[252:255], a[76:79]
    buffer_load_dwordx4 v40, s[12:15], s61 offen offset:2048 lds
    ds_read_b64_tr_b16 a[12:13], v45 offset:32768
    v_mfma_f32_16x16x32_bf16 v[208:211], a[40:43], a[240:243], v[208:211]
    v_mfma_f32_16x16x32_bf16 v[212:215], a[40:43], a[244:247], v[212:215]
    ds_read_b64_tr_b16 a[14:15], v45 offset:33792
    v_mfma_f32_16x16x32_bf16 a[80:83], a[40:43], a[248:251], a[80:83]
    buffer_load_dwordx4 v41, s[12:15], s61 offen offset:3072 lds
    ds_read_b64_tr_b16 a[16:17], v46 offset:32768
    v_mfma_f32_16x16x32_bf16 a[84:87], a[40:43], a[252:255], a[84:87]
    ds_read_b64_tr_b16 a[18:19], v46 offset:33792
    v_mfma_f32_16x16x32_bf16 v[216:219], a[44:47], a[240:243], v[216:219]
    s_add_u32 s61, s61, 0x80000
    v_mfma_f32_16x16x32_bf16 v[220:223], a[44:47], a[244:247], v[220:223]
    buffer_load_dwordx4 a[160:163], v36, s[8:11], s62 offen offset:0 sc1
    ds_read_b64_tr_b16 a[20:21], v47 offset:32768
    v_mfma_f32_16x16x32_bf16 a[88:91], a[44:47], a[248:251], a[88:91]
    ds_read_b64_tr_b16 a[22:23], v47 offset:33792
    v_mfma_f32_16x16x32_bf16 a[92:95], a[44:47], a[252:255], a[92:95]
    buffer_load_dwordx4 a[164:167], v36, s[8:11], s62 offen offset:1024 sc1
    ds_read_b64_tr_b16 a[24:25], v48 offset:32768
    v_mfma_f32_16x16x32_bf16 v[224:227], a[48:51], a[240:243], v[224:227]
    v_mfma_f32_16x16x32_bf16 v[228:231], a[48:51], a[244:247], v[228:231]
    ds_read_b64_tr_b16 a[26:27], v48 offset:33792
    v_mfma_f32_16x16x32_bf16 a[96:99], a[48:51], a[248:251], a[96:99]
    buffer_load_dwordx4 a[168:171], v37, s[8:11], s62 offen offset:0 sc1
    ds_read_b64_tr_b16 a[28:29], v49 offset:32768
    v_mfma_f32_16x16x32_bf16 a[100:103], a[48:51], a[252:255], a[100:103]
    v_mfma_f32_16x16x32_bf16 v[232:235], a[52:55], a[240:243], v[232:235]
    ds_read_b64_tr_b16 a[30:31], v49 offset:33792
    v_mfma_f32_16x16x32_bf16 v[236:239], a[52:55], a[244:247], v[236:239]
    buffer_load_dwordx4 a[172:175], v37, s[8:11], s62 offen offset:1024 sc1
    v_mfma_f32_16x16x32_bf16 a[104:107], a[52:55], a[248:251], a[104:107]
    v_mfma_f32_16x16x32_bf16 a[108:111], a[52:55], a[252:255], a[108:111]
    s_add_u32 s62, s62, 0x20000
    v_mfma_f32_16x16x32_bf16 v[240:243], a[56:59], a[240:243], v[240:243]
    s_add_u32 s52, s47, 4096
    v_mfma_f32_16x16x32_bf16 v[244:247], a[56:59], a[244:247], v[244:247]
    buffer_store_dwordx4 v[80:83], v1, s[48:51], s52 offen offset:0 sc1
    v_mfma_f32_16x16x32_bf16 a[112:115], a[56:59], a[248:251], a[112:115]
    v_mfma_f32_16x16x32_bf16 a[116:119], a[56:59], a[252:255], a[116:119]
    v_mfma_f32_16x16x32_bf16 v[248:251], a[60:63], a[240:243], v[248:251]
    v_mfma_f32_16x16x32_bf16 v[252:255], a[60:63], a[244:247], v[252:255]
    v_mfma_f32_16x16x32_bf16 a[120:123], a[60:63], a[248:251], a[120:123]
    v_mfma_f32_16x16x32_bf16 a[124:127], a[60:63], a[252:255], a[124:127]
    s_waitcnt vmcnt(15) lgkmcnt(0)
    v_mfma_f32_16x16x32_bf16 v[192:195], a[0:3], a[128:131], v[192:195]
    ds_read_b64_tr_b16 a[32:33], v42 offset:40960
    ds_read_b64_tr_b16 a[34:35], v42 offset:41984
    v_mfma_f32_16x16x32_bf16 v[196:199], a[0:3], a[132:135], v[196:199]
    buffer_load_dwordx4 a[176:179], v36, s[8:11], s62 offen offset:0 sc1
    v_mfma_f32_16x16x32_bf16 a[64:67], a[0:3], a[136:139], a[64:67]
    ds_read_b64_tr_b16 a[36:37], v43 offset:40960
    v_mfma_f32_16x16x32_bf16 a[68:71], a[0:3], a[140:143], a[68:71]
    ds_read_b64_tr_b16 a[38:39], v43 offset:41984
    v_mfma_f32_16x16x32_bf16 v[200:203], a[4:7], a[128:131], v[200:203]
    ds_read_b64_tr_b16 a[40:41], v44 offset:40960
    v_mfma_f32_16x16x32_bf16 v[204:207], a[4:7], a[132:135], v[204:207]
    v_mfma_f32_16x16x32_bf16 a[72:75], a[4:7], a[136:139], a[72:75]
    buffer_load_dwordx4 a[180:183], v36, s[8:11], s62 offen offset:1024 sc1
    ds_read_b64_tr_b16 a[42:43], v44 offset:41984
    v_mfma_f32_16x16x32_bf16 a[76:79], a[4:7], a[140:143], a[76:79]
    ds_read_b64_tr_b16 a[44:45], v45 offset:40960
    v_mfma_f32_16x16x32_bf16 v[208:211], a[8:11], a[128:131], v[208:211]
    v_mfma_f32_16x16x32_bf16 v[212:215], a[8:11], a[132:135], v[212:215]
    ds_read_b64_tr_b16 a[46:47], v45 offset:41984
    v_mfma_f32_16x16x32_bf16 a[80:83], a[8:11], a[136:139], a[80:83]
    ds_read_b64_tr_b16 a[48:49], v46 offset:40960
    v_mfma_f32_16x16x32_bf16 a[84:87], a[8:11], a[140:143], a[84:87]
    buffer_load_dwordx4 a[184:187], v37, s[8:11], s62 offen offset:0 sc1
    ds_read_b64_tr_b16 a[50:51], v46 offset:41984
    v_mfma_f32_16x16x32_bf16 v[216:219], a[12:15], a[128:131], v[216:219]
    v_mfma_f32_16x16x32_bf16 v[220:223], a[12:15], a[132:135], v[220:223]
    ds_read_b64_tr_b16 a[52:53], v47 offset:40960
    v_mfma_f32_16x16x32_bf16 a[88:91], a[12:15], a[136:139], a[88:91]
    ds_read_b64_tr_b16 a[54:55], v47 offset:41984
    v_mfma_f32_16x16x32_bf16 a[92:95], a[12:15], a[140:143], a[92:95]
    ds_read_b64_tr_b16 a[56:57], v48 offset:40960
    v_mfma_f32_16x16x32_bf16 v[224:227], a[16:19], a[128:131], v[224:227]
    v_mfma_f32_16x16x32_bf16 v[228:231], a[16:19], a[132:135], v[228:231]
    buffer_load_dwordx4 a[188:191], v37, s[8:11], s62 offen offset:1024 sc1
    ds_read_b64_tr_b16 a[58:59], v48 offset:41984
    v_mfma_f32_16x16x32_bf16 a[96:99], a[16:19], a[136:139], a[96:99]
    ds_read_b64_tr_b16 a[60:61], v49 offset:40960
    v_mfma_f32_16x16x32_bf16 a[100:103], a[16:19], a[140:143], a[100:103]
    v_mfma_f32_16x16x32_bf16 v[232:235], a[20:23], a[128:131], v[232:235]
    ds_read_b64_tr_b16 a[62:63], v49 offset:41984
    v_mfma_f32_16x16x32_bf16 v[236:239], a[20:23], a[132:135], v[236:239]
    s_add_u32 s62, s62, 0x20000
    v_mfma_f32_16x16x32_bf16 a[104:107], a[20:23], a[136:139], a[104:107]
    s_add_u32 s52, s47, 4096
    v_mfma_f32_16x16x32_bf16 a[108:111], a[20:23], a[140:143], a[108:111]
    buffer_store_dwordx4 v[84:87], v1, s[48:51], s52 offen offset:1024 sc1
    v_mfma_f32_16x16x32_bf16 v[240:243], a[24:27], a[128:131], v[240:243]
    v_mfma_f32_16x16x32_bf16 v[244:247], a[24:27], a[132:135], v[244:247]
    v_mfma_f32_16x16x32_bf16 a[112:115], a[24:27], a[136:139], a[112:115]
    v_mfma_f32_16x16x32_bf16 a[116:119], a[24:27], a[140:143], a[116:119]
    v_mfma_f32_16x16x32_bf16 v[248:251], a[28:31], a[128:131], v[248:251]
    s_cmp_eq_u32 s45, 0
    s_cbranch_scc1 k12_ool_44
k12_oolret_45:
    v_mfma_f32_16x16x32_bf16 v[252:255], a[28:31], a[132:135], v[252:255]
    v_mfma_f32_16x16x32_bf16 a[120:123], a[28:31], a[136:139], a[120:123]
    v_mfma_f32_16x16x32_bf16 a[124:127], a[28:31], a[140:143], a[124:127]
    s_waitcnt vmcnt(10) lgkmcnt(0)
    s_barrier
    v_mfma_f32_16x16x32_bf16 v[192:195], a[32:35], a[144:147], v[192:195]
    ds_read_b64_tr_b16 a[0:1], v42 offset:49152
    ds_read_b64_tr_b16 a[2:3], v42 offset:50176
    v_mfma_f32_16x16x32_bf16 v[196:199], a[32:35], a[148:151], v[196:199]
    s_add_u32 m0, s60, 98304
    v_mfma_f32_16x16x32_bf16 a[64:67], a[32:35], a[152:155], a[64:67]
    buffer_load_dwordx4 v38, s[12:15], s61 offen offset:0 lds
    ds_read_b64_tr_b16 a[4:5], v43 offset:49152
    v_mfma_f32_16x16x32_bf16 a[68:71], a[32:35], a[156:159], a[68:71]
    ds_read_b64_tr_b16 a[6:7], v43 offset:50176
    v_mfma_f32_16x16x32_bf16 v[200:203], a[36:39], a[144:147], v[200:203]
    buffer_load_dwordx4 v39, s[12:15], s61 offen offset:1024 lds
    ds_read_b64_tr_b16 a[8:9], v44 offset:49152
    v_mfma_f32_16x16x32_bf16 v[204:207], a[36:39], a[148:151], v[204:207]
    v_mfma_f32_16x16x32_bf16 a[72:75], a[36:39], a[152:155], a[72:75]
    ds_read_b64_tr_b16 a[10:11], v44 offset:50176
    v_mfma_f32_16x16x32_bf16 a[76:79], a[36:39], a[156:159], a[76:79]
    buffer_load_dwordx4 v40, s[12:15], s61 offen offset:2048 lds
    ds_read_b64_tr_b16 a[12:13], v45 offset:49152
    v_mfma_f32_16x16x32_bf16 v[208:211], a[40:43], a[144:147], v[208:211]
    v_mfma_f32_16x16x32_bf16 v[212:215], a[40:43], a[148:151], v[212:215]
    ds_read_b64_tr_b16 a[14:15], v45 offset:50176
    v_mfma_f32_16x16x32_bf16 a[80:83], a[40:43], a[152:155], a[80:83]
    buffer_load_dwordx4 v41, s[12:15], s61 offen offset:3072 lds
    ds_read_b64_tr_b16 a[16:17], v46 offset:49152
    v_mfma_f32_16x16x32_bf16 a[84:87], a[40:43], a[156:159], a[84:87]
    ds_read_b64_tr_b16 a[18:19], v46 offset:50176
    v_mfma_f32_16x16x32_bf16 v[216:219], a[44:47], a[144:147], v[216:219]
    s_add_u32 s61, s61, 0x80000
    v_mfma_f32_16x16x32_bf16 v[220:223], a[44:47], a[148:151], v[220:223]
    buffer_load_dwordx4 a[192:195], v36, s[8:11], s62 offen offset:0 sc1
    ds_read_b64_tr_b16 a[20:21], v47 offset:49152
    v_mfma_f32_16x16x32_bf16 a[88:91], a[44:47], a[152:155], a[88:91]
    ds_read_b64_tr_b16 a[22:23], v47 offset:50176
    v_mfma_f32_16x16x32_bf16 a[92:95], a[44:47], a[156:159], a[92:95]
    buffer_load_dwordx4 a[196:199], v36, s[8:11], s62 offen offset:1024 sc1
    ds_read_b64_tr_b16 a[24:25], v48 offset:49152
    v_mfma_f32_16x16x32_bf16 v[224:227], a[48:51], a[144:147], v[224:227]
    v_mfma_f32_16x16x32_bf16 v[228:231], a[48:51], a[148:151], v[228:231]
    ds_read_b64_tr_b16 a[26:27], v48 offset:50176
    v_mfma_f32_16x16x32_bf16 a[96:99], a[48:51], a[152:155], a[96:99]
    buffer_load_dwordx4 a[200:203], v37, s[8:11], s62 offen offset:0 sc1
    ds_read_b64_tr_b16 a[28:29], v49 offset:49152
    v_mfma_f32_16x16x32_bf16 a[100:103], a[48:51], a[156:159], a[100:103]
    v_mfma_f32_16x16x32_bf16 v[232:235], a[52:55], a[144:147], v[232:235]
    ds_read_b64_tr_b16 a[30:31], v49 offset:50176
    v_mfma_f32_16x16x32_bf16 v[236:239], a[52:55], a[148:151], v[236:239]
    buffer_load_dwordx4 a[204:207], v37, s[8:11], s62 offen offset:1024 sc1
    v_mfma_f32_16x16x32_bf16 a[104:107], a[52:55], a[152:155], a[104:107]
    v_mfma_f32_16x16x32_bf16 a[108:111], a[52:55], a[156:159], a[108:111]
    s_add_u32 s62, s62, 0x20000
    v_mfma_f32_16x16x32_bf16 v[240:243], a[56:59], a[144:147], v[240:243]
    s_add_u32 s52, s47, 4096
    v_mfma_f32_16x16x32_bf16 v[244:247], a[56:59], a[148:151], v[244:247]
    buffer_store_dwordx4 v[88:91], v1, s[48:51], s52 offen offset:2048 sc1
    v_mfma_f32_16x16x32_bf16 a[112:115], a[56:59], a[152:155], a[112:115]
    v_mfma_f32_16x16x32_bf16 a[116:119], a[56:59], a[156:159], a[116:119]
    v_mfma_f32_16x16x32_bf16 v[248:251], a[60:63], a[144:147], v[248:251]
    v_mfma_f32_16x16x32_bf16 v[252:255], a[60:63], a[148:151], v[252:255]
    v_mfma_f32_16x16x32_bf16 a[120:123], a[60:63], a[152:155], a[120:123]
    v_mfma_f32_16x16x32_bf16 a[124:127], a[60:63], a[156:159], a[124:127]
    s_waitcnt vmcnt(15) lgkmcnt(0)
    v_mfma_f32_16x16x32_bf16 v[192:195], a[0:3], a[160:163], v[192:195]
    ds_read_b64_tr_b16 a[32:33], v42 offset:57344
    ds_read_b64_tr_b16 a[34:35], v42 offset:58368
    v_mfma_f32_16x16x32_bf16 v[196:199], a[0:3], a[164:167], v[196:199]
    buffer_load_dwordx4 a[208:211], v36, s[8:11], s62 offen offset:0 sc1
    v_mfma_f32_16x16x32_bf16 a[64:67], a[0:3], a[168:171], a[64:67]
    ds_read_b64_tr_b16 a[36:37], v43 offset:57344
    v_mfma_f32_16x16x32_bf16 a[68:71], a[0:3], a[172:175], a[68:71]
    ds_read_b64_tr_b16 a[38:39], v43 offset:58368
    v_mfma_f32_16x16x32_bf16 v[200:203], a[4:7], a[160:163], v[200:203]
    ds_read_b64_tr_b16 a[40:41], v44 offset:57344
    v_mfma_f32_16x16x32_bf16 v[204:207], a[4:7], a[164:167], v[204:207]
    v_mfma_f32_16x16x32_bf16 a[72:75], a[4:7], a[168:171], a[72:75]
    buffer_load_dwordx4 a[212:215], v36, s[8:11], s62 offen offset:1024 sc1
    ds_read_b64_tr_b16 a[42:43], v44 offset:58368
    v_mfma_f32_16x16x32_bf16 a[76:79], a[4:7], a[172:175], a[76:79]
    ds_read_b64_tr_b16 a[44:45], v45 offset:57344
    v_mfma_f32_16x16x32_bf16 v[208:211], a[8:11], a[160:163], v[208:211]
    v_mfma_f32_16x16x32_bf16 v[212:215], a[8:11], a[164:167], v[212:215]
    ds_read_b64_tr_b16 a[46:47], v45 offset:58368
    v_mfma_f32_16x16x32_bf16 a[80:83], a[8:11], a[168:171], a[80:83]
    ds_read_b64_tr_b16 a[48:49], v46 offset:57344
    v_mfma_f32_16x16x32_bf16 a[84:87], a[8:11], a[172:175], a[84:87]
    buffer_load_dwordx4 a[216:219], v37, s[8:11], s62 offen offset:0 sc1
    ds_read_b64_tr_b16 a[50:51], v46 offset:58368
    v_mfma_f32_16x16x32_bf16 v[216:219], a[12:15], a[160:163], v[216:219]
    v_mfma_f32_16x16x32_bf16 v[220:223], a[12:15], a[164:167], v[220:223]
    ds_read_b64_tr_b16 a[52:53], v47 offset:57344
    v_mfma_f32_16x16x32_bf16 a[88:91], a[12:15], a[168:171], a[88:91]
    ds_read_b64_tr_b16 a[54:55], v47 offset:58368
    v_mfma_f32_16x16x32_bf16 a[92:95], a[12:15], a[172:175], a[92:95]
    ds_read_b64_tr_b16 a[56:57], v48 offset:57344
    v_mfma_f32_16x16x32_bf16 v[224:227], a[16:19], a[160:163], v[224:227]
    v_mfma_f32_16x16x32_bf16 v[228:231], a[16:19], a[164:167], v[228:231]
    buffer_load_dwordx4 a[220:223], v37, s[8:11], s62 offen offset:1024 sc1
    ds_read_b64_tr_b16 a[58:59], v48 offset:58368
    v_mfma_f32_16x16x32_bf16 a[96:99], a[16:19], a[168:171], a[96:99]
    ds_read_b64_tr_b16 a[60:61], v49 offset:57344
    v_mfma_f32_16x16x32_bf16 a[100:103], a[16:19], a[172:175], a[100:103]
    v_mfma_f32_16x16x32_bf16 v[232:235], a[20:23], a[160:163], v[232:235]
    ds_read_b64_tr_b16 a[62:63], v49 offset:58368
    v_mfma_f32_16x16x32_bf16 v[236:239], a[20:23], a[164:167], v[236:239]
    s_add_u32 s62, s62, 0x20000
    v_mfma_f32_16x16x32_bf16 a[104:107], a[20:23], a[168:171], a[104:107]
    s_add_u32 s52, s47, 4096
    v_mfma_f32_16x16x32_bf16 a[108:111], a[20:23], a[172:175], a[108:111]
    buffer_store_dwordx4 v[92:95], v1, s[48:51], s52 offen offset:3072 sc1
    v_mfma_f32_16x16x32_bf16 v[240:243], a[24:27], a[160:163], v[240:243]
    v_mfma_f32_16x16x32_bf16 v[244:247], a[24:27], a[164:167], v[244:247]
    v_mfma_f32_16x16x32_bf16 a[112:115], a[24:27], a[168:171], a[112:115]
    v_mfma_f32_16x16x32_bf16 a[116:119], a[24:27], a[172:175], a[116:119]
    v_mfma_f32_16x16x32_bf16 v[248:251], a[28:31], a[160:163], v[248:251]
    s_cmp_eq_u32 s45, 0
    s_cbranch_scc1 k12_ool_46
k12_oolret_47:
    v_mfma_f32_16x16x32_bf16 v[252:255], a[28:31], a[164:167], v[252:255]
    v_mfma_f32_16x16x32_bf16 a[120:123], a[28:31], a[168:171], a[120:123]
    v_mfma_f32_16x16x32_bf16 a[124:127], a[28:31], a[172:175], a[124:127]
    s_waitcnt vmcnt(10) lgkmcnt(0)
    s_barrier
    v_mfma_f32_16x16x32_bf16 v[192:195], a[32:35], a[176:179], v[192:195]
    ds_read_b64_tr_b16 a[0:1], v42 offset:0
    ds_read_b64_tr_b16 a[2:3], v42 offset:1024
    v_mfma_f32_16x16x32_bf16 v[196:199], a[32:35], a[180:183], v[196:199]
    s_add_u32 m0, s60, 114688
    v_mfma_f32_16x16x32_bf16 a[64:67], a[32:35], a[184:187], a[64:67]
    buffer_load_dwordx4 v38, s[12:15], s61 offen offset:0 lds
    ds_read_b64_tr_b16 a[4:5], v43 offset:0
    v_mfma_f32_16x16x32_bf16 a[68:71], a[32:35], a[188:191], a[68:71]
    ds_read_b64_tr_b16 a[6:7], v43 offset:1024
    v_mfma_f32_16x16x32_bf16 v[200:203], a[36:39], a[176:179], v[200:203]
    buffer_load_dwordx4 v39, s[12:15], s61 offen offset:1024 lds
    ds_read_b64_tr_b16 a[8:9], v44 offset:0
    v_mfma_f32_16x16x32_bf16 v[204:207], a[36:39], a[180:183], v[204:207]
    v_mfma_f32_16x16x32_bf16 a[72:75], a[36:39], a[184:187], a[72:75]
    ds_read_b64_tr_b16 a[10:11], v44 offset:1024
    v_mfma_f32_16x16x32_bf16 a[76:79], a[36:39], a[188:191], a[76:79]
    buffer_load_dwordx4 v40, s[12:15], s61 offen offset:2048 lds
    ds_read_b64_tr_b16 a[12:13], v45 offset:0
    v_mfma_f32_16x16x32_bf16 v[208:211], a[40:43], a[176:179], v[208:211]
    v_mfma_f32_16x16x32_bf16 v[212:215], a[40:43], a[180:183], v[212:215]
    ds_read_b64_tr_b16 a[14:15], v45 offset:1024
    v_mfma_f32_16x16x32_bf16 a[80:83], a[40:43], a[184:187], a[80:83]
    buffer_load_dwordx4 v41, s[12:15], s61 offen offset:3072 lds
    ds_read_b64_tr_b16 a[16:17], v46 offset:0
    v_mfma_f32_16x16x32_bf16 a[84:87], a[40:43], a[188:191], a[84:87]
    ds_read_b64_tr_b16 a[18:19], v46 offset:1024
    v_mfma_f32_16x16x32_bf16 v[216:219], a[44:47], a[176:179], v[216:219]
    s_add_u32 s61, s61, 0x80000
    v_mfma_f32_16x16x32_bf16 v[220:223], a[44:47], a[180:183], v[220:223]
    buffer_load_dwordx4 a[224:227], v36, s[8:11], s62 offen offset:0 sc1
    ds_read_b64_tr_b16 a[20:21], v47 offset:0
    v_mfma_f32_16x16x32_bf16 a[88:91], a[44:47], a[184:187], a[88:91]
    ds_read_b64_tr_b16 a[22:23], v47 offset:1024
    v_mfma_f32_16x16x32_bf16 a[92:95], a[44:47], a[188:191], a[92:95]
    buffer_load_dwordx4 a[228:231], v36, s[8:11], s62 offen offset:1024 sc1
    ds_read_b64_tr_b16 a[24:25], v48 offset:0
    v_mfma_f32_16x16x32_bf16 v[224:227], a[48:51], a[176:179], v[224:227]
    v_mfma_f32_16x16x32_bf16 v[228:231], a[48:51], a[180:183], v[228:231]
    ds_read_b64_tr_b16 a[26:27], v48 offset:1024
    v_mfma_f32_16x16x32_bf16 a[96:99], a[48:51], a[184:187], a[96:99]
    buffer_load_dwordx4 a[232:235], v37, s[8:11], s62 offen offset:0 sc1
    ds_read_b64_tr_b16 a[28:29], v49 offset:0
    v_mfma_f32_16x16x32_bf16 a[100:103], a[48:51], a[188:191], a[100:103]
    v_mfma_f32_16x16x32_bf16 v[232:235], a[52:55], a[176:179], v[232:235]
    ds_read_b64_tr_b16 a[30:31], v49 offset:1024
    v_mfma_f32_16x16x32_bf16 v[236:239], a[52:55], a[180:183], v[236:239]
    buffer_load_dwordx4 a[236:239], v37, s[8:11], s62 offen offset:1024 sc1
    v_mfma_f32_16x16x32_bf16 a[104:107], a[52:55], a[184:187], a[104:107]
    v_mfma_f32_16x16x32_bf16 a[108:111], a[52:55], a[188:191], a[108:111]
    s_add_u32 s62, s62, 0x20000
    v_mfma_f32_16x16x32_bf16 v[240:243], a[56:59], a[176:179], v[240:243]
    s_add_u32 s52, s47, 8192
    v_mfma_f32_16x16x32_bf16 v[244:247], a[56:59], a[180:183], v[244:247]
    buffer_store_dwordx4 v[96:99], v1, s[48:51], s52 offen offset:0 sc1
    v_mfma_f32_16x16x32_bf16 a[112:115], a[56:59], a[184:187], a[112:115]
    v_mfma_f32_16x16x32_bf16 a[116:119], a[56:59], a[188:191], a[116:119]
    v_mfma_f32_16x16x32_bf16 v[248:251], a[60:63], a[176:179], v[248:251]
    v_mfma_f32_16x16x32_bf16 v[252:255], a[60:63], a[180:183], v[252:255]
    v_mfma_f32_16x16x32_bf16 a[120:123], a[60:63], a[184:187], a[120:123]
    v_mfma_f32_16x16x32_bf16 a[124:127], a[60:63], a[188:191], a[124:127]
    s_waitcnt vmcnt(15) lgkmcnt(0)
    v_mfma_f32_16x16x32_bf16 v[192:195], a[0:3], a[192:195], v[192:195]
    ds_read_b64_tr_b16 a[32:33], v42 offset:8192
    ds_read_b64_tr_b16 a[34:35], v42 offset:9216
    v_mfma_f32_16x16x32_bf16 v[196:199], a[0:3], a[196:199], v[196:199]
    buffer_load_dwordx4 a[240:243], v36, s[8:11], s62 offen offset:0 sc1
    v_mfma_f32_16x16x32_bf16 a[64:67], a[0:3], a[200:203], a[64:67]
    ds_read_b64_tr_b16 a[36:37], v43 offset:8192
    v_mfma_f32_16x16x32_bf16 a[68:71], a[0:3], a[204:207], a[68:71]
    ds_read_b64_tr_b16 a[38:39], v43 offset:9216
    v_mfma_f32_16x16x32_bf16 v[200:203], a[4:7], a[192:195], v[200:203]
    ds_read_b64_tr_b16 a[40:41], v44 offset:8192
    v_mfma_f32_16x16x32_bf16 v[204:207], a[4:7], a[196:199], v[204:207]
    v_mfma_f32_16x16x32_bf16 a[72:75], a[4:7], a[200:203], a[72:75]
    buffer_load_dwordx4 a[244:247], v36, s[8:11], s62 offen offset:1024 sc1
    ds_read_b64_tr_b16 a[42:43], v44 offset:9216
    v_mfma_f32_16x16x32_bf16 a[76:79], a[4:7], a[204:207], a[76:79]
    ds_read_b64_tr_b16 a[44:45], v45 offset:8192
    v_mfma_f32_16x16x32_bf16 v[208:211], a[8:11], a[192:195], v[208:211]
    v_mfma_f32_16x16x32_bf16 v[212:215], a[8:11], a[196:199], v[212:215]
    ds_read_b64_tr_b16 a[46:47], v45 offset:9216
    v_mfma_f32_16x16x32_bf16 a[80:83], a[8:11], a[200:203], a[80:83]
    ds_read_b64_tr_b16 a[48:49], v46 offset:8192
    v_mfma_f32_16x16x32_bf16 a[84:87], a[8:11], a[204:207], a[84:87]
    buffer_load_dwordx4 a[248:251], v37, s[8:11], s62 offen offset:0 sc1
    ds_read_b64_tr_b16 a[50:51], v46 offset:9216
    v_mfma_f32_16x16x32_bf16 v[216:219], a[12:15], a[192:195], v[216:219]
    v_mfma_f32_16x16x32_bf16 v[220:223], a[12:15], a[196:199], v[220:223]
    ds_read_b64_tr_b16 a[52:53], v47 offset:8192
    v_mfma_f32_16x16x32_bf16 a[88:91], a[12:15], a[200:203], a[88:91]
    ds_read_b64_tr_b16 a[54:55], v47 offset:9216
    v_mfma_f32_16x16x32_bf16 a[92:95], a[12:15], a[204:207], a[92:95]
    ds_read_b64_tr_b16 a[56:57], v48 offset:8192
    v_mfma_f32_16x16x32_bf16 v[224:227], a[16:19], a[192:195], v[224:227]
    v_mfma_f32_16x16x32_bf16 v[228:231], a[16:19], a[196:199], v[228:231]
    buffer_load_dwordx4 a[252:255], v37, s[8:11], s62 offen offset:1024 sc1
    ds_read_b64_tr_b16 a[58:59], v48 offset:9216
    v_mfma_f32_16x16x32_bf16 a[96:99], a[16:19], a[200:203], a[96:99]
    ds_read_b64_tr_b16 a[60:61], v49 offset:8192
    v_mfma_f32_16x16x32_bf16 a[100:103], a[16:19], a[204:207], a[100:103]
    v_mfma_f32_16x16x32_bf16 v[232:235], a[20:23], a[192:195], v[232:235]
    ds_read_b64_tr_b16 a[62:63], v49 offset:9216
    v_mfma_f32_16x16x32_bf16 v[236:239], a[20:23], a[196:199], v[236:239]
    s_add_u32 s62, s62, 0x20000
    v_mfma_f32_16x16x32_bf16 a[104:107], a[20:23], a[200:203], a[104:107]
    s_add_u32 s52, s47, 8192
    v_mfma_f32_16x16x32_bf16 a[108:111], a[20:23], a[204:207], a[108:111]
    buffer_store_dwordx4 v[100:103], v1, s[48:51], s52 offen offset:1024 sc1
    v_mfma_f32_16x16x32_bf16 v[240:243], a[24:27], a[192:195], v[240:243]
    v_mfma_f32_16x16x32_bf16 v[244:247], a[24:27], a[196:199], v[244:247]
    v_mfma_f32_16x16x32_bf16 a[112:115], a[24:27], a[200:203], a[112:115]
    v_mfma_f32_16x16x32_bf16 a[116:119], a[24:27], a[204:207], a[116:119]
    v_mfma_f32_16x16x32_bf16 v[248:251], a[28:31], a[192:195], v[248:251]
    s_cmp_eq_u32 s45, 0
    s_cbranch_scc1 k12_ool_48
k12_oolret_49:
    v_mfma_f32_16x16x32_bf16 v[252:255], a[28:31], a[196:199], v[252:255]
    v_mfma_f32_16x16x32_bf16 a[120:123], a[28:31], a[200:203], a[120:123]
    v_mfma_f32_16x16x32_bf16 a[124:127], a[28:31], a[204:207], a[124:127]
    s_waitcnt vmcnt(10) lgkmcnt(0)
    s_barrier
    v_mfma_f32_16x16x32_bf16 v[192:195], a[32:35], a[208:211], v[192:195]
    ds_read_b64_tr_b16 a[0:1], v42 offset:16384
    ds_read_b64_tr_b16 a[2:3], v42 offset:17408
    v_mfma_f32_16x16x32_bf16 v[196:199], a[32:35], a[212:215], v[196:199]
    s_add_u32 m0, s60, 131072
    v_mfma_f32_16x16x32_bf16 a[64:67], a[32:35], a[216:219], a[64:67]
    buffer_load_dwordx4 v38, s[12:15], s61 offen offset:0 lds
    ds_read_b64_tr_b16 a[4:5], v43 offset:16384
    v_mfma_f32_16x16x32_bf16 a[68:71], a[32:35], a[220:223], a[68:71]
    ds_read_b64_tr_b16 a[6:7], v43 offset:17408
    v_mfma_f32_16x16x32_bf16 v[200:203], a[36:39], a[208:211], v[200:203]
    buffer_load_dwordx4 v39, s[12:15], s61 offen offset:1024 lds
    ds_read_b64_tr_b16 a[8:9], v44 offset:16384
    v_mfma_f32_16x16x32_bf16 v[204:207], a[36:39], a[212:215], v[204:207]
    v_mfma_f32_16x16x32_bf16 a[72:75], a[36:39], a[216:219], a[72:75]
    buffer_load_dwordx4 v40, s[12:15], s61 offen offset:2048 lds
    ds_read_b64_tr_b16 a[10:11], v44 offset:17408
    v_mfma_f32_16x16x32_bf16 a[76:79], a[36:39], a[220:223], a[76:79]
    ds_read_b64_tr_b16 a[12:13], v45 offset:16384
    v_mfma_f32_16x16x32_bf16 v[208:211], a[40:43], a[208:211], v[208:211]
    v_mfma_f32_16x16x32_bf16 v[212:215], a[40:43], a[212:215], v[212:215]
    buffer_load_dwordx4 v41, s[12:15], s61 offen offset:3072 lds
    ds_read_b64_tr_b16 a[14:15], v45 offset:17408
    v_mfma_f32_16x16x32_bf16 a[80:83], a[40:43], a[216:219], a[80:83]
    s_add_u32 s61, s61, 0x80000
    ds_read_b64_tr_b16 a[16:17], v46 offset:16384
    v_mfma_f32_16x16x32_bf16 a[84:87], a[40:43], a[220:223], a[84:87]
    buffer_load_dwordx4 a[128:131], v36, s[8:11], s62 offen offset:0 sc1
    ds_read_b64_tr_b16 a[18:19], v46 offset:17408
    v_mfma_f32_16x16x32_bf16 v[216:219], a[44:47], a[208:211], v[216:219]
    v_mfma_f32_16x16x32_bf16 v[220:223], a[44:47], a[212:215], v[220:223]
    ds_read_b64_tr_b16 a[20:21], v47 offset:16384
    v_mfma_f32_16x16x32_bf16 a[88:91], a[44:47], a[216:219], a[88:91]
    buffer_load_dwordx4 a[132:135], v36, s[8:11], s62 offen offset:1024 sc1
    ds_read_b64_tr_b16 a[22:23], v47 offset:17408
    v_mfma_f32_16x16x32_bf16 a[92:95], a[44:47], a[220:223], a[92:95]
    ds_read_b64_tr_b16 a[24:25], v48 offset:16384
    v_mfma_f32_16x16x32_bf16 v[224:227], a[48:51], a[208:211], v[224:227]
    v_mfma_f32_16x16x32_bf16 v[228:231], a[48:51], a[212:215], v[228:231]
    buffer_load_dwordx4 a[136:139], v37, s[8:11], s62 offen offset:0 sc1
    ds_read_b64_tr_b16 a[26:27], v48 offset:17408
    v_mfma_f32_16x16x32_bf16 a[96:99], a[48:51], a[216:219], a[96:99]
    ds_read_b64_tr_b16 a[28:29], v49 offset:16384
    v_mfma_f32_16x16x32_bf16 a[100:103], a[48:51], a[220:223], a[100:103]
    buffer_load_dwordx4 a[140:143], v37, s[8:11], s62 offen offset:1024 sc1
    v_mfma_f32_16x16x32_bf16 v[232:235], a[52:55], a[208:211], v[232:235]
    ds_read_b64_tr_b16 a[30:31], v49 offset:17408
    v_mfma_f32_16x16x32_bf16 v[236:239], a[52:55], a[212:215], v[236:239]
    s_add_u32 s62, s62, 0x20000
    v_mfma_f32_16x16x32_bf16 a[104:107], a[52:55], a[216:219], a[104:107]
    s_add_u32 s52, s47, 8192
    v_mfma_f32_16x16x32_bf16 a[108:111], a[52:55], a[220:223], a[108:111]
    buffer_store_dwordx4 v[104:107], v1, s[48:51], s52 offen offset:2048 sc1
    v_mfma_f32_16x16x32_bf16 v[240:243], a[56:59], a[208:211], v[240:243]
    s_add_u32 s52, s47, 8192
    v_mfma_f32_16x16x32_bf16 v[244:247], a[56:59], a[212:215], v[244:247]
    buffer_store_dwordx4 v[108:111], v1, s[48:51], s52 offen offset:3072 sc1
    v_mfma_f32_16x16x32_bf16 a[112:115], a[56:59], a[216:219], a[112:115]
    v_mfma_f32_16x16x32_bf16 a[116:119], a[56:59], a[220:223], a[116:119]
    v_mfma_f32_16x16x32_bf16 v[248:251], a[60:63], a[208:211], v[248:251]
    v_mfma_f32_16x16x32_bf16 v[252:255], a[60:63], a[212:215], v[252:255]
    v_mfma_f32_16x16x32_bf16 a[120:123], a[60:63], a[216:219], a[120:123]
    v_mfma_f32_16x16x32_bf16 a[124:127], a[60:63], a[220:223], a[124:127]
    s_waitcnt vmcnt(16) lgkmcnt(0)
    v_mfma_f32_16x16x32_bf16 v[192:195], a[0:3], a[224:227], v[192:195]
    ds_read_b64_tr_b16 a[32:33], v42 offset:24576
    ds_read_b64_tr_b16 a[34:35], v42 offset:25600
    v_mfma_f32_16x16x32_bf16 v[196:199], a[0:3], a[228:231], v[196:199]
    buffer_load_dwordx4 a[144:147], v36, s[8:11], s62 offen offset:0 sc1
    v_mfma_f32_16x16x32_bf16 a[64:67], a[0:3], a[232:235], a[64:67]
    ds_read_b64_tr_b16 a[36:37], v43 offset:24576
    v_mfma_f32_16x16x32_bf16 a[68:71], a[0:3], a[236:239], a[68:71]
    ds_read_b64_tr_b16 a[38:39], v43 offset:25600
    v_mfma_f32_16x16x32_bf16 v[200:203], a[4:7], a[224:227], v[200:203]
    ds_read_b64_tr_b16 a[40:41], v44 offset:24576
    v_mfma_f32_16x16x32_bf16 v[204:207], a[4:7], a[228:231], v[204:207]
    v_mfma_f32_16x16x32_bf16 a[72:75], a[4:7], a[232:235], a[72:75]
    buffer_load_dwordx4 a[148:151], v36, s[8:11], s62 offen offset:1024 sc1
    ds_read_b64_tr_b16 a[42:43], v44 offset:25600
    v_mfma_f32_16x16x32_bf16 a[76:79], a[4:7], a[236:239], a[76:79]
    ds_read_b64_tr_b16 a[44:45], v45 offset:24576
    v_mfma_f32_16x16x32_bf16 v[208:211], a[8:11], a[224:227], v[208:211]
    v_mfma_f32_16x16x32_bf16 v[212:215], a[8:11], a[228:231], v[212:215]
    ds_read_b64_tr_b16 a[46:47], v45 offset:25600
    v_mfma_f32_16x16x32_bf16 a[80:83], a[8:11], a[232:235], a[80:83]
    ds_read_b64_tr_b16 a[48:49], v46 offset:24576
    v_mfma_f32_16x16x32_bf16 a[84:87], a[8:11], a[236:239], a[84:87]
    buffer_load_dwordx4 a[152:155], v37, s[8:11], s62 offen offset:0 sc1
    ds_read_b64_tr_b16 a[50:51], v46 offset:25600
    v_mfma_f32_16x16x32_bf16 v[216:219], a[12:15], a[224:227], v[216:219]
    v_mfma_f32_16x16x32_bf16 v[220:223], a[12:15], a[228:231], v[220:223]
    ds_read_b64_tr_b16 a[52:53], v47 offset:24576
    v_mfma_f32_16x16x32_bf16 a[88:91], a[12:15], a[232:235], a[88:91]
    ds_read_b64_tr_b16 a[54:55], v47 offset:25600
    v_mfma_f32_16x16x32_bf16 a[92:95], a[12:15], a[236:239], a[92:95]
    ds_read_b64_tr_b16 a[56:57], v48 offset:24576
    v_mfma_f32_16x16x32_bf16 v[224:227], a[16:19], a[224:227], v[224:227]
    v_mfma_f32_16x16x32_bf16 v[228:231], a[16:19], a[228:231], v[228:231]
    buffer_load_dwordx4 a[156:159], v37, s[8:11], s62 offen offset:1024 sc1
    ds_read_b64_tr_b16 a[58:59], v48 offset:25600
    v_mfma_f32_16x16x32_bf16 a[96:99], a[16:19], a[232:235], a[96:99]
    ds_read_b64_tr_b16 a[60:61], v49 offset:24576
    v_mfma_f32_16x16x32_bf16 a[100:103], a[16:19], a[236:239], a[100:103]
    v_mfma_f32_16x16x32_bf16 v[232:235], a[20:23], a[224:227], v[232:235]
    ds_read_b64_tr_b16 a[62:63], v49 offset:25600
    v_mfma_f32_16x16x32_bf16 v[236:239], a[20:23], a[228:231], v[236:239]
    s_add_u32 s62, s62, 0x20000
    v_mfma_f32_16x16x32_bf16 a[104:107], a[20:23], a[232:235], a[104:107]
    s_add_u32 s52, s47, 12288
    v_mfma_f32_16x16x32_bf16 a[108:111], a[20:23], a[236:239], a[108:111]
    buffer_store_dwordx4 v[112:115], v1, s[48:51], s52 offen offset:0 sc1
    v_mfma_f32_16x16x32_bf16 v[240:243], a[24:27], a[224:227], v[240:243]
    v_mfma_f32_16x16x32_bf16 v[244:247], a[24:27], a[228:231], v[244:247]
    v_mfma_f32_16x16x32_bf16 a[112:115], a[24:27], a[232:235], a[112:115]
    v_mfma_f32_16x16x32_bf16 a[116:119], a[24:27], a[236:239], a[116:119]
    v_mfma_f32_16x16x32_bf16 v[248:251], a[28:31], a[224:227], v[248:251]
    v_mfma_f32_16x16x32_bf16 v[252:255], a[28:31], a[228:231], v[252:255]
    v_mfma_f32_16x16x32_bf16 a[120:123], a[28:31], a[232:235], a[120:123]
    v_mfma_f32_16x16x32_bf16 a[124:127], a[28:31], a[236:239], a[124:127]
    s_waitcnt vmcnt(11) lgkmcnt(0)
    s_barrier
    v_mfma_f32_16x16x32_bf16 v[192:195], a[32:35], a[240:243], v[192:195]
    ds_read_b64_tr_b16 a[0:1], v42 offset:32768
    ds_read_b64_tr_b16 a[2:3], v42 offset:33792
    v_mfma_f32_16x16x32_bf16 v[196:199], a[32:35], a[244:247], v[196:199]
    s_add_u32 m0, s60, 147456
    v_mfma_f32_16x16x32_bf16 a[64:67], a[32:35], a[248:251], a[64:67]
    buffer_load_dwordx4 v38, s[12:15], s61 offen offset:0 lds
    ds_read_b64_tr_b16 a[4:5], v43 offset:32768
    v_mfma_f32_16x16x32_bf16 a[68:71], a[32:35], a[252:255], a[68:71]
    ds_read_b64_tr_b16 a[6:7], v43 offset:33792
    v_mfma_f32_16x16x32_bf16 v[200:203], a[36:39], a[240:243], v[200:203]
    buffer_load_dwordx4 v39, s[12:15], s61 offen offset:1024 lds
    ds_read_b64_tr_b16 a[8:9], v44 offset:32768
    v_mfma_f32_16x16x32_bf16 v[204:207], a[36:39], a[244:247], v[204:207]
    v_mfma_f32_16x16x32_bf16 a[72:75], a[36:39], a[248:251], a[72:75]
    ds_read_b64_tr_b16 a[10:11], v44 offset:33792
    v_mfma_f32_16x16x32_bf16 a[76:79], a[36:39], a[252:255], a[76:79]
    buffer_load_dwordx4 v40, s[12:15], s61 offen offset:2048 lds
    ds_read_b64_tr_b16 a[12:13], v45 offset:32768
    v_mfma_f32_16x16x32_bf16 v[208:211], a[40:43], a[240:243], v[208:211]
    v_mfma_f32_16x16x32_bf16 v[212:215], a[40:43], a[244:247], v[212:215]
    ds_read_b64_tr_b16 a[14:15], v45 offset:33792
    v_mfma_f32_16x16x32_bf16 a[80:83], a[40:43], a[248:251], a[80:83]
    buffer_load_dwordx4 v41, s[12:15], s61 offen offset:3072 lds
    ds_read_b64_tr_b16 a[16:17], v46 offset:32768
    v_mfma_f32_16x16x32_bf16 a[84:87], a[40:43], a[252:255], a[84:87]
    ds_read_b64_tr_b16 a[18:19], v46 offset:33792
    v_mfma_f32_16x16x32_bf16 v[216:219], a[44:47], a[240:243], v[216:219]
    s_add_u32 s61, s61, 0x80000
    v_mfma_f32_16x16x32_bf16 v[220:223], a[44:47], a[244:247], v[220:223]
    buffer_load_dwordx4 a[160:163], v36, s[8:11], s62 offen offset:0 sc1
    ds_read_b64_tr_b16 a[20:21], v47 offset:32768
    v_mfma_f32_16x16x32_bf16 a[88:91], a[44:47], a[248:251], a[88:91]
    ds_read_b64_tr_b16 a[22:23], v47 offset:33792
    v_mfma_f32_16x16x32_bf16 a[92:95], a[44:47], a[252:255], a[92:95]
    buffer_load_dwordx4 a[164:167], v36, s[8:11], s62 offen offset:1024 sc1
    ds_read_b64_tr_b16 a[24:25], v48 offset:32768
    v_mfma_f32_16x16x32_bf16 v[224:227], a[48:51], a[240:243], v[224:227]
    v_mfma_f32_16x16x32_bf16 v[228:231], a[48:51], a[244:247], v[228:231]
    ds_read_b64_tr_b16 a[26:27], v48 offset:33792
    v_mfma_f32_16x16x32_bf16 a[96:99], a[48:51], a[248:251], a[96:99]
    buffer_load_dwordx4 a[168:171], v37, s[8:11], s62 offen offset:0 sc1
    ds_read_b64_tr_b16 a[28:29], v49 offset:32768
    v_mfma_f32_16x16x32_bf16 a[100:103], a[48:51], a[252:255], a[100:103]
    v_mfma_f32_16x16x32_bf16 v[232:235], a[52:55], a[240:243], v[232:235]
    ds_read_b64_tr_b16 a[30:31], v49 offset:33792
    v_mfma_f32_16x16x32_bf16 v[236:239], a[52:55], a[244:247], v[236:239]
    buffer_load_dwordx4 a[172:175], v37, s[8:11], s62 offen offset:1024 sc1
    v_mfma_f32_16x16x32_bf16 a[104:107], a[52:55], a[248:251], a[104:107]
    v_mfma_f32_16x16x32_bf16 a[108:111], a[52:55], a[252:255], a[108:111]
    s_add_u32 s62, s62, 0x20000
    v_mfma_f32_16x16x32_bf16 v[240:243], a[56:59], a[240:243], v[240:243]
    s_add_u32 s52, s47, 12288
    v_mfma_f32_16x16x32_bf16 v[244:247], a[56:59], a[244:247], v[244:247]
    buffer_store_dwordx4 v[116:119], v1, s[48:51], s52 offen offset:1024 sc1
    v_mfma_f32_16x16x32_bf16 a[112:115], a[56:59], a[248:251], a[112:115]
    v_mfma_f32_16x16x32_bf16 a[116:119], a[56:59], a[252:255], a[116:119]
    v_mfma_f32_16x16x32_bf16 v[248:251], a[60:63], a[240:243], v[248:251]
    s_cmp_eq_u32 s45, 0
    s_cbranch_scc1 k12_ool_50
k12_oolret_51:
    v_mfma_f32_16x16x32_bf16 v[252:255], a[60:63], a[244:247], v[252:255]
    v_mfma_f32_16x16x32_bf16 a[120:123], a[60:63], a[248:251], a[120:123]
    v_mfma_f32_16x16x32_bf16 a[124:127], a[60:63], a[252:255], a[124:127]
    s_waitcnt vmcnt(16) lgkmcnt(0)
    v_mfma_f32_16x16x32_bf16 v[192:195], a[0:3], a[128:131], v[192:195]
    ds_read_b64_tr_b16 a[32:33], v42 offset:40960
    ds_read_b64_tr_b16 a[34:35], v42 offset:41984
    v_mfma_f32_16x16x32_bf16 v[196:199], a[0:3], a[132:135], v[196:199]
    buffer_load_dwordx4 a[176:179], v36, s[8:11], s62 offen offset:0 sc1
    v_mfma_f32_16x16x32_bf16 a[64:67], a[0:3], a[136:139], a[64:67]
    ds_read_b64_tr_b16 a[36:37], v43 offset:40960
    v_mfma_f32_16x16x32_bf16 a[68:71], a[0:3], a[140:143], a[68:71]
    ds_read_b64_tr_b16 a[38:39], v43 offset:41984
    v_mfma_f32_16x16x32_bf16 v[200:203], a[4:7], a[128:131], v[200:203]
    ds_read_b64_tr_b16 a[40:41], v44 offset:40960
    v_mfma_f32_16x16x32_bf16 v[204:207], a[4:7], a[132:135], v[204:207]
    v_mfma_f32_16x16x32_bf16 a[72:75], a[4:7], a[136:139], a[72:75]
    buffer_load_dwordx4 a[180:183], v36, s[8:11], s62 offen offset:1024 sc1
    ds_read_b64_tr_b16 a[42:43], v44 offset:41984
    v_mfma_f32_16x16x32_bf16 a[76:79], a[4:7], a[140:143], a[76:79]
    ds_read_b64_tr_b16 a[44:45], v45 offset:40960
    v_mfma_f32_16x16x32_bf16 v[208:211], a[8:11], a[128:131], v[208:211]
    v_mfma_f32_16x16x32_bf16 v[212:215], a[8:11], a[132:135], v[212:215]
    ds_read_b64_tr_b16 a[46:47], v45 offset:41984
    v_mfma_f32_16x16x32_bf16 a[80:83], a[8:11], a[136:139], a[80:83]
    ds_read_b64_tr_b16 a[48:49], v46 offset:40960
    v_mfma_f32_16x16x32_bf16 a[84:87], a[8:11], a[140:143], a[84:87]
    buffer_load_dwordx4 a[184:187], v37, s[8:11], s62 offen offset:0 sc1
    ds_read_b64_tr_b16 a[50:51], v46 offset:41984
    v_mfma_f32_16x16x32_bf16 v[216:219], a[12:15], a[128:131], v[216:219]
    v_mfma_f32_16x16x32_bf16 v[220:223], a[12:15], a[132:135], v[220:223]
    ds_read_b64_tr_b16 a[52:53], v47 offset:40960
    v_mfma_f32_16x16x32_bf16 a[88:91], a[12:15], a[136:139], a[88:91]
    ds_read_b64_tr_b16 a[54:55], v47 offset:41984
    v_mfma_f32_16x16x32_bf16 a[92:95], a[12:15], a[140:143], a[92:95]
    ds_read_b64_tr_b16 a[56:57], v48 offset:40960
    v_mfma_f32_16x16x32_bf16 v[224:227], a[16:19], a[128:131], v[224:227]
    v_mfma_f32_16x16x32_bf16 v[228:231], a[16:19], a[132:135], v[228:231]
    buffer_load_dwordx4 a[188:191], v37, s[8:11], s62 offen offset:1024 sc1
    ds_read_b64_tr_b16 a[58:59], v48 offset:41984
    v_mfma_f32_16x16x32_bf16 a[96:99], a[16:19], a[136:139], a[96:99]
    ds_read_b64_tr_b16 a[60:61], v49 offset:40960
    v_mfma_f32_16x16x32_bf16 a[100:103], a[16:19], a[140:143], a[100:103]
    v_mfma_f32_16x16x32_bf16 v[232:235], a[20:23], a[128:131], v[232:235]
    ds_read_b64_tr_b16 a[62:63], v49 offset:41984
    v_mfma_f32_16x16x32_bf16 v[236:239], a[20:23], a[132:135], v[236:239]
    s_add_u32 s62, s62, 0x20000
    v_mfma_f32_16x16x32_bf16 a[104:107], a[20:23], a[136:139], a[104:107]
    s_add_u32 s52, s47, 12288
    v_mfma_f32_16x16x32_bf16 a[108:111], a[20:23], a[140:143], a[108:111]
    buffer_store_dwordx4 v[120:123], v1, s[48:51], s52 offen offset:2048 sc1
    v_mfma_f32_16x16x32_bf16 v[240:243], a[24:27], a[128:131], v[240:243]
    v_mfma_f32_16x16x32_bf16 v[244:247], a[24:27], a[132:135], v[244:247]
    v_mfma_f32_16x16x32_bf16 a[112:115], a[24:27], a[136:139], a[112:115]
    v_mfma_f32_16x16x32_bf16 a[116:119], a[24:27], a[140:143], a[116:119]
    v_mfma_f32_16x16x32_bf16 v[248:251], a[28:31], a[128:131], v[248:251]
    v_mfma_f32_16x16x32_bf16 v[252:255], a[28:31], a[132:135], v[252:255]
    v_mfma_f32_16x16x32_bf16 a[120:123], a[28:31], a[136:139], a[120:123]
    v_mfma_f32_16x16x32_bf16 a[124:127], a[28:31], a[140:143], a[124:127]
    s_waitcnt vmcnt(10) lgkmcnt(0)
    s_barrier
    v_mfma_f32_16x16x32_bf16 v[192:195], a[32:35], a[144:147], v[192:195]
    ds_read_b64_tr_b16 a[0:1], v42 offset:49152
    ds_read_b64_tr_b16 a[2:3], v42 offset:50176
    v_mfma_f32_16x16x32_bf16 v[196:199], a[32:35], a[148:151], v[196:199]
    s_add_u32 m0, s60, 98304
    v_mfma_f32_16x16x32_bf16 a[64:67], a[32:35], a[152:155], a[64:67]
    buffer_load_dwordx4 v38, s[12:15], s61 offen offset:0 lds
    ds_read_b64_tr_b16 a[4:5], v43 offset:49152
    v_mfma_f32_16x16x32_bf16 a[68:71], a[32:35], a[156:159], a[68:71]
    ds_read_b64_tr_b16 a[6:7], v43 offset:50176
    v_mfma_f32_16x16x32_bf16 v[200:203], a[36:39], a[144:147], v[200:203]
    buffer_load_dwordx4 v39, s[12:15], s61 offen offset:1024 lds
    ds_read_b64_tr_b16 a[8:9], v44 offset:49152
    v_mfma_f32_16x16x32_bf16 v[204:207], a[36:39], a[148:151], v[204:207]
    v_mfma_f32_16x16x32_bf16 a[72:75], a[36:39], a[152:155], a[72:75]
    ds_read_b64_tr_b16 a[10:11], v44 offset:50176
    v_mfma_f32_16x16x32_bf16 a[76:79], a[36:39], a[156:159], a[76:79]
    buffer_load_dwordx4 v40, s[12:15], s61 offen offset:2048 lds
    ds_read_b64_tr_b16 a[12:13], v45 offset:49152
    v_mfma_f32_16x16x32_bf16 v[208:211], a[40:43], a[144:147], v[208:211]
    v_mfma_f32_16x16x32_bf16 v[212:215], a[40:43], a[148:151], v[212:215]
    ds_read_b64_tr_b16 a[14:15], v45 offset:50176
    v_mfma_f32_16x16x32_bf16 a[80:83], a[40:43], a[152:155], a[80:83]
    buffer_load_dwordx4 v41, s[12:15], s61 offen offset:3072 lds
    ds_read_b64_tr_b16 a[16:17], v46 offset:49152
    v_mfma_f32_16x16x32_bf16 a[84:87], a[40:43], a[156:159], a[84:87]
    ds_read_b64_tr_b16 a[18:19], v46 offset:50176
    v_mfma_f32_16x16x32_bf16 v[216:219], a[44:47], a[144:147], v[216:219]
    s_add_u32 s61, s61, 0x80000
    v_mfma_f32_16x16x32_bf16 v[220:223], a[44:47], a[148:151], v[220:223]
    buffer_load_dwordx4 a[192:195], v36, s[8:11], s62 offen offset:0 sc1
    ds_read_b64_tr_b16 a[20:21], v47 offset:49152
    v_mfma_f32_16x16x32_bf16 a[88:91], a[44:47], a[152:155], a[88:91]
    ds_read_b64_tr_b16 a[22:23], v47 offset:50176
    v_mfma_f32_16x16x32_bf16 a[92:95], a[44:47], a[156:159], a[92:95]
    buffer_load_dwordx4 a[196:199], v36, s[8:11], s62 offen offset:1024 sc1
    ds_read_b64_tr_b16 a[24:25], v48 offset:49152
    v_mfma_f32_16x16x32_bf16 v[224:227], a[48:51], a[144:147], v[224:227]
    v_mfma_f32_16x16x32_bf16 v[228:231], a[48:51], a[148:151], v[228:231]
    ds_read_b64_tr_b16 a[26:27], v48 offset:50176
    v_mfma_f32_16x16x32_bf16 a[96:99], a[48:51], a[152:155], a[96:99]
    buffer_load_dwordx4 a[200:203], v37, s[8:11], s62 offen offset:0 sc1
    ds_read_b64_tr_b16 a[28:29], v49 offset:49152
    v_mfma_f32_16x16x32_bf16 a[100:103], a[48:51], a[156:159], a[100:103]
    v_mfma_f32_16x16x32_bf16 v[232:235], a[52:55], a[144:147], v[232:235]
    ds_read_b64_tr_b16 a[30:31], v49 offset:50176
    v_mfma_f32_16x16x32_bf16 v[236:239], a[52:55], a[148:151], v[236:239]
    buffer_load_dwordx4 a[204:207], v37, s[8:11], s62 offen offset:1024 sc1
    v_mfma_f32_16x16x32_bf16 a[104:107], a[52:55], a[152:155], a[104:107]
    v_mfma_f32_16x16x32_bf16 a[108:111], a[52:55], a[156:159], a[108:111]
    s_add_u32 s62, s62, 0x20000
    v_mfma_f32_16x16x32_bf16 v[240:243], a[56:59], a[144:147], v[240:243]
    s_add_u32 s52, s47, 12288
    v_mfma_f32_16x16x32_bf16 v[244:247], a[56:59], a[148:151], v[244:247]
    buffer_store_dwordx4 v[124:127], v1, s[48:51], s52 offen offset:3072 sc1
    v_mfma_f32_16x16x32_bf16 a[112:115], a[56:59], a[152:155], a[112:115]
    v_mfma_f32_16x16x32_bf16 a[116:119], a[56:59], a[156:159], a[116:119]
    v_mfma_f32_16x16x32_bf16 v[248:251], a[60:63], a[144:147], v[248:251]
    s_cmp_eq_u32 s45, 0
    s_cbranch_scc1 k12_ool_52
k12_oolret_53:
    v_mfma_f32_16x16x32_bf16 v[252:255], a[60:63], a[148:151], v[252:255]
    v_mfma_f32_16x16x32_bf16 a[120:123], a[60:63], a[152:155], a[120:123]
    v_mfma_f32_16x16x32_bf16 a[124:127], a[60:63], a[156:159], a[124:127]
    s_waitcnt vmcnt(15) lgkmcnt(0)
    v_mfma_f32_16x16x32_bf16 v[192:195], a[0:3], a[160:163], v[192:195]
    ds_read_b64_tr_b16 a[32:33], v42 offset:57344
    ds_read_b64_tr_b16 a[34:35], v42 offset:58368
    v_mfma_f32_16x16x32_bf16 v[196:199], a[0:3], a[164:167], v[196:199]
    buffer_load_dwordx4 a[208:211], v36, s[8:11], s62 offen offset:0 sc1
    v_mfma_f32_16x16x32_bf16 a[64:67], a[0:3], a[168:171], a[64:67]
    ds_read_b64_tr_b16 a[36:37], v43 offset:57344
    v_mfma_f32_16x16x32_bf16 a[68:71], a[0:3], a[172:175], a[68:71]
    ds_read_b64_tr_b16 a[38:39], v43 offset:58368
    v_mfma_f32_16x16x32_bf16 v[200:203], a[4:7], a[160:163], v[200:203]
    ds_read_b64_tr_b16 a[40:41], v44 offset:57344
    v_mfma_f32_16x16x32_bf16 v[204:207], a[4:7], a[164:167], v[204:207]
    v_mfma_f32_16x16x32_bf16 a[72:75], a[4:7], a[168:171], a[72:75]
    buffer_load_dwordx4 a[212:215], v36, s[8:11], s62 offen offset:1024 sc1
    ds_read_b64_tr_b16 a[42:43], v44 offset:58368
    v_mfma_f32_16x16x32_bf16 a[76:79], a[4:7], a[172:175], a[76:79]
    ds_read_b64_tr_b16 a[44:45], v45 offset:57344
    v_mfma_f32_16x16x32_bf16 v[208:211], a[8:11], a[160:163], v[208:211]
    v_mfma_f32_16x16x32_bf16 v[212:215], a[8:11], a[164:167], v[212:215]
    ds_read_b64_tr_b16 a[46:47], v45 offset:58368
    v_mfma_f32_16x16x32_bf16 a[80:83], a[8:11], a[168:171], a[80:83]
    ds_read_b64_tr_b16 a[48:49], v46 offset:57344
    v_mfma_f32_16x16x32_bf16 a[84:87], a[8:11], a[172:175], a[84:87]
    buffer_load_dwordx4 a[216:219], v37, s[8:11], s62 offen offset:0 sc1
    ds_read_b64_tr_b16 a[50:51], v46 offset:58368
    v_mfma_f32_16x16x32_bf16 v[216:219], a[12:15], a[160:163], v[216:219]
    v_mfma_f32_16x16x32_bf16 v[220:223], a[12:15], a[164:167], v[220:223]
    ds_read_b64_tr_b16 a[52:53], v47 offset:57344
    v_mfma_f32_16x16x32_bf16 a[88:91], a[12:15], a[168:171], a[88:91]
    ds_read_b64_tr_b16 a[54:55], v47 offset:58368
    v_mfma_f32_16x16x32_bf16 a[92:95], a[12:15], a[172:175], a[92:95]
    ds_read_b64_tr_b16 a[56:57], v48 offset:57344
    v_mfma_f32_16x16x32_bf16 v[224:227], a[16:19], a[160:163], v[224:227]
    v_mfma_f32_16x16x32_bf16 v[228:231], a[16:19], a[164:167], v[228:231]
    buffer_load_dwordx4 a[220:223], v37, s[8:11], s62 offen offset:1024 sc1
    ds_read_b64_tr_b16 a[58:59], v48 offset:58368
    v_mfma_f32_16x16x32_bf16 a[96:99], a[16:19], a[168:171], a[96:99]
    ds_read_b64_tr_b16 a[60:61], v49 offset:57344
    v_mfma_f32_16x16x32_bf16 a[100:103], a[16:19], a[172:175], a[100:103]
    v_mfma_f32_16x16x32_bf16 v[232:235], a[20:23], a[160:163], v[232:235]
    ds_read_b64_tr_b16 a[62:63], v49 offset:58368
    v_mfma_f32_16x16x32_bf16 v[236:239], a[20:23], a[164:167], v[236:239]
    s_add_u32 s62, s62, 0x20000
    v_mfma_f32_16x16x32_bf16 a[104:107], a[20:23], a[168:171], a[104:107]
    s_add_u32 s52, s47, 524288
    v_mfma_f32_16x16x32_bf16 a[108:111], a[20:23], a[172:175], a[108:111]
    buffer_store_dwordx4 v[128:131], v1, s[48:51], s52 offen offset:0 sc1
    v_mfma_f32_16x16x32_bf16 v[240:243], a[24:27], a[160:163], v[240:243]
    v_mfma_f32_16x16x32_bf16 v[244:247], a[24:27], a[164:167], v[244:247]
    v_mfma_f32_16x16x32_bf16 a[112:115], a[24:27], a[168:171], a[112:115]
    v_mfma_f32_16x16x32_bf16 a[116:119], a[24:27], a[172:175], a[116:119]
    v_mfma_f32_16x16x32_bf16 v[248:251], a[28:31], a[160:163], v[248:251]
    v_mfma_f32_16x16x32_bf16 v[252:255], a[28:31], a[164:167], v[252:255]
    v_mfma_f32_16x16x32_bf16 a[120:123], a[28:31], a[168:171], a[120:123]
    v_mfma_f32_16x16x32_bf16 a[124:127], a[28:31], a[172:175], a[124:127]
    s_waitcnt vmcnt(10) lgkmcnt(0)
    s_barrier
    v_mfma_f32_16x16x32_bf16 v[192:195], a[32:35], a[176:179], v[192:195]
    ds_read_b64_tr_b16 a[0:1], v42 offset:0
    ds_read_b64_tr_b16 a[2:3], v42 offset:1024
    v_mfma_f32_16x16x32_bf16 v[196:199], a[32:35], a[180:183], v[196:199]
    s_add_u32 m0, s60, 114688
    v_mfma_f32_16x16x32_bf16 a[64:67], a[32:35], a[184:187], a[64:67]
    buffer_load_dwordx4 v38, s[12:15], s61 offen offset:0 lds
    ds_read_b64_tr_b16 a[4:5], v43 offset:0
    v_mfma_f32_16x16x32_bf16 a[68:71], a[32:35], a[188:191], a[68:71]
    ds_read_b64_tr_b16 a[6:7], v43 offset:1024
    v_mfma_f32_16x16x32_bf16 v[200:203], a[36:39], a[176:179], v[200:203]
    buffer_load_dwordx4 v39, s[12:15], s61 offen offset:1024 lds
    ds_read_b64_tr_b16 a[8:9], v44 offset:0
    v_mfma_f32_16x16x32_bf16 v[204:207], a[36:39], a[180:183], v[204:207]
    v_mfma_f32_16x16x32_bf16 a[72:75], a[36:39], a[184:187], a[72:75]
    ds_read_b64_tr_b16 a[10:11], v44 offset:1024
    v_mfma_f32_16x16x32_bf16 a[76:79], a[36:39], a[188:191], a[76:79]
    buffer_load_dwordx4 v40, s[12:15], s61 offen offset:2048 lds
    ds_read_b64_tr_b16 a[12:13], v45 offset:0
    v_mfma_f32_16x16x32_bf16 v[208:211], a[40:43], a[176:179], v[208:211]
    v_mfma_f32_16x16x32_bf16 v[212:215], a[40:43], a[180:183], v[212:215]
    ds_read_b64_tr_b16 a[14:15], v45 offset:1024
    v_mfma_f32_16x16x32_bf16 a[80:83], a[40:43], a[184:187], a[80:83]
    buffer_load_dwordx4 v41, s[12:15], s61 offen offset:3072 lds
    ds_read_b64_tr_b16 a[16:17], v46 offset:0
    v_mfma_f32_16x16x32_bf16 a[84:87], a[40:43], a[188:191], a[84:87]
    ds_read_b64_tr_b16 a[18:19], v46 offset:1024
    v_mfma_f32_16x16x32_bf16 v[216:219], a[44:47], a[176:179], v[216:219]
    s_add_u32 s61, s61, 0x80000
    v_mfma_f32_16x16x32_bf16 v[220:223], a[44:47], a[180:183], v[220:223]
    buffer_load_dwordx4 a[224:227], v36, s[8:11], s62 offen offset:0 sc1
    ds_read_b64_tr_b16 a[20:21], v47 offset:0
    v_mfma_f32_16x16x32_bf16 a[88:91], a[44:47], a[184:187], a[88:91]
    ds_read_b64_tr_b16 a[22:23], v47 offset:1024
    v_mfma_f32_16x16x32_bf16 a[92:95], a[44:47], a[188:191], a[92:95]
    buffer_load_dwordx4 a[228:231], v36, s[8:11], s62 offen offset:1024 sc1
    ds_read_b64_tr_b16 a[24:25], v48 offset:0
    v_mfma_f32_16x16x32_bf16 v[224:227], a[48:51], a[176:179], v[224:227]
    v_mfma_f32_16x16x32_bf16 v[228:231], a[48:51], a[180:183], v[228:231]
    ds_read_b64_tr_b16 a[26:27], v48 offset:1024
    v_mfma_f32_16x16x32_bf16 a[96:99], a[48:51], a[184:187], a[96:99]
    buffer_load_dwordx4 a[232:235], v37, s[8:11], s62 offen offset:0 sc1
    ds_read_b64_tr_b16 a[28:29], v49 offset:0
    v_mfma_f32_16x16x32_bf16 a[100:103], a[48:51], a[188:191], a[100:103]
    v_mfma_f32_16x16x32_bf16 v[232:235], a[52:55], a[176:179], v[232:235]
    ds_read_b64_tr_b16 a[30:31], v49 offset:1024
    v_mfma_f32_16x16x32_bf16 v[236:239], a[52:55], a[180:183], v[236:239]
    buffer_load_dwordx4 a[236:239], v37, s[8:11], s62 offen offset:1024 sc1
    v_mfma_f32_16x16x32_bf16 a[104:107], a[52:55], a[184:187], a[104:107]
    v_mfma_f32_16x16x32_bf16 a[108:111], a[52:55], a[188:191], a[108:111]
    s_add_u32 s62, s62, 0x20000
    v_mfma_f32_16x16x32_bf16 v[240:243], a[56:59], a[176:179], v[240:243]
    s_add_u32 s52, s47, 524288
    v_mfma_f32_16x16x32_bf16 v[244:247], a[56:59], a[180:183], v[244:247]
    buffer_store_dwordx4 v[132:135], v1, s[48:51], s52 offen offset:1024 sc1
    v_mfma_f32_16x16x32_bf16 a[112:115], a[56:59], a[184:187], a[112:115]
    v_mfma_f32_16x16x32_bf16 a[116:119], a[56:59], a[188:191], a[116:119]
    v_mfma_f32_16x16x32_bf16 v[248:251], a[60:63], a[176:179], v[248:251]
    s_cmp_eq_u32 s45, 0
    s_cbranch_scc1 k12_ool_54
k12_oolret_55:
    v_mfma_f32_16x16x32_bf16 v[252:255], a[60:63], a[180:183], v[252:255]
    v_mfma_f32_16x16x32_bf16 a[120:123], a[60:63], a[184:187], a[120:123]
    v_mfma_f32_16x16x32_bf16 a[124:127], a[60:63], a[188:191], a[124:127]
    s_waitcnt vmcnt(15) lgkmcnt(0)
    v_mfma_f32_16x16x32_bf16 v[192:195], a[0:3], a[192:195], v[192:195]
    ds_read_b64_tr_b16 a[32:33], v42 offset:8192
    ds_read_b64_tr_b16 a[34:35], v42 offset:9216
    v_mfma_f32_16x16x32_bf16 v[196:199], a[0:3], a[196:199], v[196:199]
    buffer_load_dwordx4 a[240:243], v36, s[8:11], s62 offen offset:0 sc1
    v_mfma_f32_16x16x32_bf16 a[64:67], a[0:3], a[200:203], a[64:67]
    ds_read_b64_tr_b16 a[36:37], v43 offset:8192
    v_mfma_f32_16x16x32_bf16 a[68:71], a[0:3], a[204:207], a[68:71]
    ds_read_b64_tr_b16 a[38:39], v43 offset:9216
    v_mfma_f32_16x16x32_bf16 v[200:203], a[4:7], a[192:195], v[200:203]
    ds_read_b64_tr_b16 a[40:41], v44 offset:8192
    v_mfma_f32_16x16x32_bf16 v[204:207], a[4:7], a[196:199], v[204:207]
    v_mfma_f32_16x16x32_bf16 a[72:75], a[4:7], a[200:203], a[72:75]
    buffer_load_dwordx4 a[244:247], v36, s[8:11], s62 offen offset:1024 sc1
    ds_read_b64_tr_b16 a[42:43], v44 offset:9216
    v_mfma_f32_16x16x32_bf16 a[76:79], a[4:7], a[204:207], a[76:79]
    ds_read_b64_tr_b16 a[44:45], v45 offset:8192
    v_mfma_f32_16x16x32_bf16 v[208:211], a[8:11], a[192:195], v[208:211]
    v_mfma_f32_16x16x32_bf16 v[212:215], a[8:11], a[196:199], v[212:215]
    ds_read_b64_tr_b16 a[46:47], v45 offset:9216
    v_mfma_f32_16x16x32_bf16 a[80:83], a[8:11], a[200:203], a[80:83]
    ds_read_b64_tr_b16 a[48:49], v46 offset:8192
    v_mfma_f32_16x16x32_bf16 a[84:87], a[8:11], a[204:207], a[84:87]
    buffer_load_dwordx4 a[248:251], v37, s[8:11], s62 offen offset:0 sc1
    ds_read_b64_tr_b16 a[50:51], v46 offset:9216
    v_mfma_f32_16x16x32_bf16 v[216:219], a[12:15], a[192:195], v[216:219]
    v_mfma_f32_16x16x32_bf16 v[220:223], a[12:15], a[196:199], v[220:223]
    ds_read_b64_tr_b16 a[52:53], v47 offset:8192
    v_mfma_f32_16x16x32_bf16 a[88:91], a[12:15], a[200:203], a[88:91]
    ds_read_b64_tr_b16 a[54:55], v47 offset:9216
    v_mfma_f32_16x16x32_bf16 a[92:95], a[12:15], a[204:207], a[92:95]
    ds_read_b64_tr_b16 a[56:57], v48 offset:8192
    v_mfma_f32_16x16x32_bf16 v[224:227], a[16:19], a[192:195], v[224:227]
    v_mfma_f32_16x16x32_bf16 v[228:231], a[16:19], a[196:199], v[228:231]
    buffer_load_dwordx4 a[252:255], v37, s[8:11], s62 offen offset:1024 sc1
    ds_read_b64_tr_b16 a[58:59], v48 offset:9216
    v_mfma_f32_16x16x32_bf16 a[96:99], a[16:19], a[200:203], a[96:99]
    ds_read_b64_tr_b16 a[60:61], v49 offset:8192
    v_mfma_f32_16x16x32_bf16 a[100:103], a[16:19], a[204:207], a[100:103]
    v_mfma_f32_16x16x32_bf16 v[232:235], a[20:23], a[192:195], v[232:235]
    ds_read_b64_tr_b16 a[62:63], v49 offset:9216
    v_mfma_f32_16x16x32_bf16 v[236:239], a[20:23], a[196:199], v[236:239]
    s_add_u32 s62, s62, 0x20000
    v_mfma_f32_16x16x32_bf16 a[104:107], a[20:23], a[200:203], a[104:107]
    s_add_u32 s52, s47, 524288
    v_mfma_f32_16x16x32_bf16 a[108:111], a[20:23], a[204:207], a[108:111]
    buffer_store_dwordx4 v[136:139], v1, s[48:51], s52 offen offset:2048 sc1
    v_mfma_f32_16x16x32_bf16 v[240:243], a[24:27], a[192:195], v[240:243]
    v_mfma_f32_16x16x32_bf16 v[244:247], a[24:27], a[196:199], v[244:247]
    v_mfma_f32_16x16x32_bf16 a[112:115], a[24:27], a[200:203], a[112:115]
    v_mfma_f32_16x16x32_bf16 a[116:119], a[24:27], a[204:207], a[116:119]
    v_mfma_f32_16x16x32_bf16 v[248:251], a[28:31], a[192:195], v[248:251]
    v_mfma_f32_16x16x32_bf16 v[252:255], a[28:31], a[196:199], v[252:255]
    v_mfma_f32_16x16x32_bf16 a[120:123], a[28:31], a[200:203], a[120:123]
    v_mfma_f32_16x16x32_bf16 a[124:127], a[28:31], a[204:207], a[124:127]
    s_waitcnt vmcnt(10) lgkmcnt(0)
    s_barrier
    v_mfma_f32_16x16x32_bf16 v[192:195], a[32:35], a[208:211], v[192:195]
    ds_read_b64_tr_b16 a[0:1], v42 offset:16384
    ds_read_b64_tr_b16 a[2:3], v42 offset:17408
    v_mfma_f32_16x16x32_bf16 v[196:199], a[32:35], a[212:215], v[196:199]
    s_add_u32 m0, s60, 131072
    v_mfma_f32_16x16x32_bf16 a[64:67], a[32:35], a[216:219], a[64:67]
    buffer_load_dwordx4 v38, s[12:15], s61 offen offset:0 lds
    ds_read_b64_tr_b16 a[4:5], v43 offset:16384
    v_mfma_f32_16x16x32_bf16 a[68:71], a[32:35], a[220:223], a[68:71]
    ds_read_b64_tr_b16 a[6:7], v43 offset:17408
    v_mfma_f32_16x16x32_bf16 v[200:203], a[36:39], a[208:211], v[200:203]
    buffer_load_dwordx4 v39, s[12:15], s61 offen offset:1024 lds
    ds_read_b64_tr_b16 a[8:9], v44 offset:16384
    v_mfma_f32_16x16x32_bf16 v[204:207], a[36:39], a[212:215], v[204:207]
    v_mfma_f32_16x16x32_bf16 a[72:75], a[36:39], a[216:219], a[72:75]
    ds_read_b64_tr_b16 a[10:11], v44 offset:17408
    v_mfma_f32_16x16x32_bf16 a[76:79], a[36:39], a[220:223], a[76:79]
    buffer_load_dwordx4 v40, s[12:15], s61 offen offset:2048 lds
    ds_read_b64_tr_b16 a[12:13], v45 offset:16384
    v_mfma_f32_16x16x32_bf16 v[208:211], a[40:43], a[208:211], v[208:211]
    v_mfma_f32_16x16x32_bf16 v[212:215], a[40:43], a[212:215], v[212:215]
    ds_read_b64_tr_b16 a[14:15], v45 offset:17408
    v_mfma_f32_16x16x32_bf16 a[80:83], a[40:43], a[216:219], a[80:83]
    buffer_load_dwordx4 v41, s[12:15], s61 offen offset:3072 lds
    ds_read_b64_tr_b16 a[16:17], v46 offset:16384
    v_mfma_f32_16x16x32_bf16 a[84:87], a[40:43], a[220:223], a[84:87]
    ds_read_b64_tr_b16 a[18:19], v46 offset:17408
    v_mfma_f32_16x16x32_bf16 v[216:219], a[44:47], a[208:211], v[216:219]
    s_add_u32 s61, s61, 0x80000
    v_mfma_f32_16x16x32_bf16 v[220:223], a[44:47], a[212:215], v[220:223]
    buffer_load_dwordx4 a[128:131], v36, s[8:11], s62 offen offset:0 sc1
    ds_read_b64_tr_b16 a[20:21], v47 offset:16384
    v_mfma_f32_16x16x32_bf16 a[88:91], a[44:47], a[216:219], a[88:91]
    ds_read_b64_tr_b16 a[22:23], v47 offset:17408
    v_mfma_f32_16x16x32_bf16 a[92:95], a[44:47], a[220:223], a[92:95]
    buffer_load_dwordx4 a[132:135], v36, s[8:11], s62 offen offset:1024 sc1
    ds_read_b64_tr_b16 a[24:25], v48 offset:16384
    v_mfma_f32_16x16x32_bf16 v[224:227], a[48:51], a[208:211], v[224:227]
    v_mfma_f32_16x16x32_bf16 v[228:231], a[48:51], a[212:215], v[228:231]
    ds_read_b64_tr_b16 a[26:27], v48 offset:17408
    v_mfma_f32_16x16x32_bf16 a[96:99], a[48:51], a[216:219], a[96:99]
    buffer_load_dwordx4 a[136:139], v37, s[8:11], s62 offen offset:0 sc1
    ds_read_b64_tr_b16 a[28:29], v49 offset:16384
    v_mfma_f32_16x16x32_bf16 a[100:103], a[48:51], a[220:223], a[100:103]
    v_mfma_f32_16x16x32_bf16 v[232:235], a[52:55], a[208:211], v[232:235]
    ds_read_b64_tr_b16 a[30:31], v49 offset:17408
    v_mfma_f32_16x16x32_bf16 v[236:239], a[52:55], a[212:215], v[236:239]
    buffer_load_dwordx4 a[140:143], v37, s[8:11], s62 offen offset:1024 sc1
    v_mfma_f32_16x16x32_bf16 a[104:107], a[52:55], a[216:219], a[104:107]
    v_mfma_f32_16x16x32_bf16 a[108:111], a[52:55], a[220:223], a[108:111]
    s_add_u32 s62, s62, 0x20000
    v_mfma_f32_16x16x32_bf16 v[240:243], a[56:59], a[208:211], v[240:243]
    s_add_u32 s52, s47, 524288
    v_mfma_f32_16x16x32_bf16 v[244:247], a[56:59], a[212:215], v[244:247]
    buffer_store_dwordx4 v[140:143], v1, s[48:51], s52 offen offset:3072 sc1
    v_mfma_f32_16x16x32_bf16 a[112:115], a[56:59], a[216:219], a[112:115]
    v_mfma_f32_16x16x32_bf16 a[116:119], a[56:59], a[220:223], a[116:119]
    v_mfma_f32_16x16x32_bf16 v[248:251], a[60:63], a[208:211], v[248:251]
    s_cmp_eq_u32 s45, 0
    s_cbranch_scc1 k12_ool_56
k12_oolret_57:
    v_mfma_f32_16x16x32_bf16 v[252:255], a[60:63], a[212:215], v[252:255]
    v_mfma_f32_16x16x32_bf16 a[120:123], a[60:63], a[216:219], a[120:123]
    v_mfma_f32_16x16x32_bf16 a[124:127], a[60:63], a[220:223], a[124:127]
    s_waitcnt vmcnt(15) lgkmcnt(0)
    v_mfma_f32_16x16x32_bf16 v[192:195], a[0:3], a[224:227], v[192:195]
    ds_read_b64_tr_b16 a[32:33], v42 offset:24576
    ds_read_b64_tr_b16 a[34:35], v42 offset:25600
    v_mfma_f32_16x16x32_bf16 v[196:199], a[0:3], a[228:231], v[196:199]
    buffer_load_dwordx4 a[144:147], v36, s[8:11], s62 offen offset:0 sc1
    v_mfma_f32_16x16x32_bf16 a[64:67], a[0:3], a[232:235], a[64:67]
    ds_read_b64_tr_b16 a[36:37], v43 offset:24576
    v_mfma_f32_16x16x32_bf16 a[68:71], a[0:3], a[236:239], a[68:71]
    ds_read_b64_tr_b16 a[38:39], v43 offset:25600
    v_mfma_f32_16x16x32_bf16 v[200:203], a[4:7], a[224:227], v[200:203]
    ds_read_b64_tr_b16 a[40:41], v44 offset:24576
    v_mfma_f32_16x16x32_bf16 v[204:207], a[4:7], a[228:231], v[204:207]
    v_mfma_f32_16x16x32_bf16 a[72:75], a[4:7], a[232:235], a[72:75]
    buffer_load_dwordx4 a[148:151], v36, s[8:11], s62 offen offset:1024 sc1
    ds_read_b64_tr_b16 a[42:43], v44 offset:25600
    v_mfma_f32_16x16x32_bf16 a[76:79], a[4:7], a[236:239], a[76:79]
    ds_read_b64_tr_b16 a[44:45], v45 offset:24576
    v_mfma_f32_16x16x32_bf16 v[208:211], a[8:11], a[224:227], v[208:211]
    v_mfma_f32_16x16x32_bf16 v[212:215], a[8:11], a[228:231], v[212:215]
    ds_read_b64_tr_b16 a[46:47], v45 offset:25600
    v_mfma_f32_16x16x32_bf16 a[80:83], a[8:11], a[232:235], a[80:83]
    ds_read_b64_tr_b16 a[48:49], v46 offset:24576
    v_mfma_f32_16x16x32_bf16 a[84:87], a[8:11], a[236:239], a[84:87]
    buffer_load_dwordx4 a[152:155], v37, s[8:11], s62 offen offset:0 sc1
    ds_read_b64_tr_b16 a[50:51], v46 offset:25600
    v_mfma_f32_16x16x32_bf16 v[216:219], a[12:15], a[224:227], v[216:219]
    v_mfma_f32_16x16x32_bf16 v[220:223], a[12:15], a[228:231], v[220:223]
    ds_read_b64_tr_b16 a[52:53], v47 offset:24576
    v_mfma_f32_16x16x32_bf16 a[88:91], a[12:15], a[232:235], a[88:91]
    ds_read_b64_tr_b16 a[54:55], v47 offset:25600
    v_mfma_f32_16x16x32_bf16 a[92:95], a[12:15], a[236:239], a[92:95]
    ds_read_b64_tr_b16 a[56:57], v48 offset:24576
    v_mfma_f32_16x16x32_bf16 v[224:227], a[16:19], a[224:227], v[224:227]
    v_mfma_f32_16x16x32_bf16 v[228:231], a[16:19], a[228:231], v[228:231]
    buffer_load_dwordx4 a[156:159], v37, s[8:11], s62 offen offset:1024 sc1
    ds_read_b64_tr_b16 a[58:59], v48 offset:25600
    v_mfma_f32_16x16x32_bf16 a[96:99], a[16:19], a[232:235], a[96:99]
    ds_read_b64_tr_b16 a[60:61], v49 offset:24576
    v_mfma_f32_16x16x32_bf16 a[100:103], a[16:19], a[236:239], a[100:103]
    v_mfma_f32_16x16x32_bf16 v[232:235], a[20:23], a[224:227], v[232:235]
    ds_read_b64_tr_b16 a[62:63], v49 offset:25600
    v_mfma_f32_16x16x32_bf16 v[236:239], a[20:23], a[228:231], v[236:239]
    s_add_u32 s62, s62, 0x20000
    v_mfma_f32_16x16x32_bf16 a[104:107], a[20:23], a[232:235], a[104:107]
    s_add_u32 s52, s47, 528384
    v_mfma_f32_16x16x32_bf16 a[108:111], a[20:23], a[236:239], a[108:111]
    buffer_store_dwordx4 v[144:147], v1, s[48:51], s52 offen offset:0 sc1
    v_mfma_f32_16x16x32_bf16 v[240:243], a[24:27], a[224:227], v[240:243]
    v_mfma_f32_16x16x32_bf16 v[244:247], a[24:27], a[228:231], v[244:247]
    v_mfma_f32_16x16x32_bf16 a[112:115], a[24:27], a[232:235], a[112:115]
    v_mfma_f32_16x16x32_bf16 a[116:119], a[24:27], a[236:239], a[116:119]
    v_mfma_f32_16x16x32_bf16 v[248:251], a[28:31], a[224:227], v[248:251]
    v_mfma_f32_16x16x32_bf16 v[252:255], a[28:31], a[228:231], v[252:255]
    v_mfma_f32_16x16x32_bf16 a[120:123], a[28:31], a[232:235], a[120:123]
    v_mfma_f32_16x16x32_bf16 a[124:127], a[28:31], a[236:239], a[124:127]
    s_waitcnt vmcnt(10) lgkmcnt(0)
    s_barrier
    v_mfma_f32_16x16x32_bf16 v[192:195], a[32:35], a[240:243], v[192:195]
    ds_read_b64_tr_b16 a[0:1], v42 offset:32768
    ds_read_b64_tr_b16 a[2:3], v42 offset:33792
    v_mfma_f32_16x16x32_bf16 v[196:199], a[32:35], a[244:247], v[196:199]
    s_add_u32 m0, s60, 147456
    v_mfma_f32_16x16x32_bf16 a[64:67], a[32:35], a[248:251], a[64:67]
    buffer_load_dwordx4 v38, s[12:15], s61 offen offset:0 lds
    ds_read_b64_tr_b16 a[4:5], v43 offset:32768
    v_mfma_f32_16x16x32_bf16 a[68:71], a[32:35], a[252:255], a[68:71]
    ds_read_b64_tr_b16 a[6:7], v43 offset:33792
    v_mfma_f32_16x16x32_bf16 v[200:203], a[36:39], a[240:243], v[200:203]
    buffer_load_dwordx4 v39, s[12:15], s61 offen offset:1024 lds
    ds_read_b64_tr_b16 a[8:9], v44 offset:32768
    v_mfma_f32_16x16x32_bf16 v[204:207], a[36:39], a[244:247], v[204:207]
    v_mfma_f32_16x16x32_bf16 a[72:75], a[36:39], a[248:251], a[72:75]
    buffer_load_dwordx4 v40, s[12:15], s61 offen offset:2048 lds
    ds_read_b64_tr_b16 a[10:11], v44 offset:33792
    v_mfma_f32_16x16x32_bf16 a[76:79], a[36:39], a[252:255], a[76:79]
    ds_read_b64_tr_b16 a[12:13], v45 offset:32768
    v_mfma_f32_16x16x32_bf16 v[208:211], a[40:43], a[240:243], v[208:211]
    v_mfma_f32_16x16x32_bf16 v[212:215], a[40:43], a[244:247], v[212:215]
    buffer_load_dwordx4 v41, s[12:15], s61 offen offset:3072 lds
    ds_read_b64_tr_b16 a[14:15], v45 offset:33792
    v_mfma_f32_16x16x32_bf16 a[80:83], a[40:43], a[248:251], a[80:83]
    s_add_u32 s61, s61, 0x80000
    ds_read_b64_tr_b16 a[16:17], v46 offset:32768
    v_mfma_f32_16x16x32_bf16 a[84:87], a[40:43], a[252:255], a[84:87]
    buffer_load_dwordx4 a[160:163], v36, s[8:11], s62 offen offset:0 sc1
    ds_read_b64_tr_b16 a[18:19], v46 offset:33792
    v_mfma_f32_16x16x32_bf16 v[216:219], a[44:47], a[240:243], v[216:219]
    v_mfma_f32_16x16x32_bf16 v[220:223], a[44:47], a[244:247], v[220:223]
    ds_read_b64_tr_b16 a[20:21], v47 offset:32768
    v_mfma_f32_16x16x32_bf16 a[88:91], a[44:47], a[248:251], a[88:91]
    buffer_load_dwordx4 a[164:167], v36, s[8:11], s62 offen offset:1024 sc1
    ds_read_b64_tr_b16 a[22:23], v47 offset:33792
    v_mfma_f32_16x16x32_bf16 a[92:95], a[44:47], a[252:255], a[92:95]
    ds_read_b64_tr_b16 a[24:25], v48 offset:32768
    v_mfma_f32_16x16x32_bf16 v[224:227], a[48:51], a[240:243], v[224:227]
    v_mfma_f32_16x16x32_bf16 v[228:231], a[48:51], a[244:247], v[228:231]
    buffer_load_dwordx4 a[168:171], v37, s[8:11], s62 offen offset:0 sc1
    ds_read_b64_tr_b16 a[26:27], v48 offset:33792
    v_mfma_f32_16x16x32_bf16 a[96:99], a[48:51], a[248:251], a[96:99]
    ds_read_b64_tr_b16 a[28:29], v49 offset:32768
    v_mfma_f32_16x16x32_bf16 a[100:103], a[48:51], a[252:255], a[100:103]
    buffer_load_dwordx4 a[172:175], v37, s[8:11], s62 offen offset:1024 sc1
    v_mfma_f32_16x16x32_bf16 v[232:235], a[52:55], a[240:243], v[232:235]
    ds_read_b64_tr_b16 a[30:31], v49 offset:33792
    v_mfma_f32_16x16x32_bf16 v[236:239], a[52:55], a[244:247], v[236:239]
    s_add_u32 s62, s62, 0x20000
    v_mfma_f32_16x16x32_bf16 a[104:107], a[52:55], a[248:251], a[104:107]
    s_add_u32 s52, s47, 528384
    v_mfma_f32_16x16x32_bf16 a[108:111], a[52:55], a[252:255], a[108:111]
    buffer_store_dwordx4 v[148:151], v1, s[48:51], s52 offen offset:1024 sc1
    v_mfma_f32_16x16x32_bf16 v[240:243], a[56:59], a[240:243], v[240:243]
    s_add_u32 s52, s47, 528384
    v_mfma_f32_16x16x32_bf16 v[244:247], a[56:59], a[244:247], v[244:247]
    buffer_store_dwordx4 v[152:155], v1, s[48:51], s52 offen offset:2048 sc1
    v_mfma_f32_16x16x32_bf16 a[112:115], a[56:59], a[248:251], a[112:115]
    v_mfma_f32_16x16x32_bf16 a[116:119], a[56:59], a[252:255], a[116:119]
    v_mfma_f32_16x16x32_bf16 v[248:251], a[60:63], a[240:243], v[248:251]
    s_cmp_eq_u32 s45, 0
    s_cbranch_scc1 k12_ool_58
k12_oolret_59:
    v_mfma_f32_16x16x32_bf16 v[252:255], a[60:63], a[244:247], v[252:255]
    v_mfma_f32_16x16x32_bf16 a[120:123], a[60:63], a[248:251], a[120:123]
    v_mfma_f32_16x16x32_bf16 a[124:127], a[60:63], a[252:255], a[124:127]
    s_waitcnt vmcnt(16) lgkmcnt(0)
    v_mfma_f32_16x16x32_bf16 v[192:195], a[0:3], a[128:131], v[192:195]
    ds_read_b64_tr_b16 a[32:33], v42 offset:40960
    ds_read_b64_tr_b16 a[34:35], v42 offset:41984
    v_mfma_f32_16x16x32_bf16 v[196:199], a[0:3], a[132:135], v[196:199]
    buffer_load_dwordx4 a[176:179], v36, s[8:11], s62 offen offset:0 sc1
    v_mfma_f32_16x16x32_bf16 a[64:67], a[0:3], a[136:139], a[64:67]
    ds_read_b64_tr_b16 a[36:37], v43 offset:40960
    v_mfma_f32_16x16x32_bf16 a[68:71], a[0:3], a[140:143], a[68:71]
    ds_read_b64_tr_b16 a[38:39], v43 offset:41984
    v_mfma_f32_16x16x32_bf16 v[200:203], a[4:7], a[128:131], v[200:203]
    ds_read_b64_tr_b16 a[40:41], v44 offset:40960
    v_mfma_f32_16x16x32_bf16 v[204:207], a[4:7], a[132:135], v[204:207]
    v_mfma_f32_16x16x32_bf16 a[72:75], a[4:7], a[136:139], a[72:75]
    buffer_load_dwordx4 a[180:183], v36, s[8:11], s62 offen offset:1024 sc1
    ds_read_b64_tr_b16 a[42:43], v44 offset:41984
    v_mfma_f32_16x16x32_bf16 a[76:79], a[4:7], a[140:143], a[76:79]
    ds_read_b64_tr_b16 a[44:45], v45 offset:40960
    v_mfma_f32_16x16x32_bf16 v[208:211], a[8:11], a[128:131], v[208:211]
    v_mfma_f32_16x16x32_bf16 v[212:215], a[8:11], a[132:135], v[212:215]
    ds_read_b64_tr_b16 a[46:47], v45 offset:41984
    v_mfma_f32_16x16x32_bf16 a[80:83], a[8:11], a[136:139], a[80:83]
    ds_read_b64_tr_b16 a[48:49], v46 offset:40960
    v_mfma_f32_16x16x32_bf16 a[84:87], a[8:11], a[140:143], a[84:87]
    buffer_load_dwordx4 a[184:187], v37, s[8:11], s62 offen offset:0 sc1
    ds_read_b64_tr_b16 a[50:51], v46 offset:41984
    v_mfma_f32_16x16x32_bf16 v[216:219], a[12:15], a[128:131], v[216:219]
    v_mfma_f32_16x16x32_bf16 v[220:223], a[12:15], a[132:135], v[220:223]
    ds_read_b64_tr_b16 a[52:53], v47 offset:40960
    v_mfma_f32_16x16x32_bf16 a[88:91], a[12:15], a[136:139], a[88:91]
    ds_read_b64_tr_b16 a[54:55], v47 offset:41984
    v_mfma_f32_16x16x32_bf16 a[92:95], a[12:15], a[140:143], a[92:95]
    ds_read_b64_tr_b16 a[56:57], v48 offset:40960
    v_mfma_f32_16x16x32_bf16 v[224:227], a[16:19], a[128:131], v[224:227]
    v_mfma_f32_16x16x32_bf16 v[228:231], a[16:19], a[132:135], v[228:231]
    buffer_load_dwordx4 a[188:191], v37, s[8:11], s62 offen offset:1024 sc1
    ds_read_b64_tr_b16 a[58:59], v48 offset:41984
    v_mfma_f32_16x16x32_bf16 a[96:99], a[16:19], a[136:139], a[96:99]
    ds_read_b64_tr_b16 a[60:61], v49 offset:40960
    v_mfma_f32_16x16x32_bf16 a[100:103], a[16:19], a[140:143], a[100:103]
    v_mfma_f32_16x16x32_bf16 v[232:235], a[20:23], a[128:131], v[232:235]
    ds_read_b64_tr_b16 a[62:63], v49 offset:41984
    v_mfma_f32_16x16x32_bf16 v[236:239], a[20:23], a[132:135], v[236:239]
    s_add_u32 s62, s62, 0x20000
    v_mfma_f32_16x16x32_bf16 a[104:107], a[20:23], a[136:139], a[104:107]
    s_add_u32 s52, s47, 528384
    v_mfma_f32_16x16x32_bf16 a[108:111], a[20:23], a[140:143], a[108:111]
    buffer_store_dwordx4 v[156:159], v1, s[48:51], s52 offen offset:3072 sc1
    v_mfma_f32_16x16x32_bf16 v[240:243], a[24:27], a[128:131], v[240:243]
    v_mfma_f32_16x16x32_bf16 v[244:247], a[24:27], a[132:135], v[244:247]
    v_mfma_f32_16x16x32_bf16 a[112:115], a[24:27], a[136:139], a[112:115]
    v_mfma_f32_16x16x32_bf16 a[116:119], a[24:27], a[140:143], a[116:119]
    v_mfma_f32_16x16x32_bf16 v[248:251], a[28:31], a[128:131], v[248:251]
    v_mfma_f32_16x16x32_bf16 v[252:255], a[28:31], a[132:135], v[252:255]
    v_mfma_f32_16x16x32_bf16 a[120:123], a[28:31], a[136:139], a[120:123]
    v_mfma_f32_16x16x32_bf16 a[124:127], a[28:31], a[140:143], a[124:127]
    s_waitcnt vmcnt(11) lgkmcnt(0)
    s_barrier
    v_mfma_f32_16x16x32_bf16 v[192:195], a[32:35], a[144:147], v[192:195]
    ds_read_b64_tr_b16 a[0:1], v42 offset:49152
    ds_read_b64_tr_b16 a[2:3], v42 offset:50176
    v_mfma_f32_16x16x32_bf16 v[196:199], a[32:35], a[148:151], v[196:199]
    s_add_u32 m0, s60, 98304
    v_mfma_f32_16x16x32_bf16 a[64:67], a[32:35], a[152:155], a[64:67]
    buffer_load_dwordx4 v38, s[12:15], s61 offen offset:0 lds
    ds_read_b64_tr_b16 a[4:5], v43 offset:49152
    v_mfma_f32_16x16x32_bf16 a[68:71], a[32:35], a[156:159], a[68:71]
    ds_read_b64_tr_b16 a[6:7], v43 offset:50176
    v_mfma_f32_16x16x32_bf16 v[200:203], a[36:39], a[144:147], v[200:203]
    buffer_load_dwordx4 v39, s[12:15], s61 offen offset:1024 lds
    ds_read_b64_tr_b16 a[8:9], v44 offset:49152
    v_mfma_f32_16x16x32_bf16 v[204:207], a[36:39], a[148:151], v[204:207]
    v_mfma_f32_16x16x32_bf16 a[72:75], a[36:39], a[152:155], a[72:75]
    ds_read_b64_tr_b16 a[10:11], v44 offset:50176
    v_mfma_f32_16x16x32_bf16 a[76:79], a[36:39], a[156:159], a[76:79]
    buffer_load_dwordx4 v40, s[12:15], s61 offen offset:2048 lds
    ds_read_b64_tr_b16 a[12:13], v45 offset:49152
    v_mfma_f32_16x16x32_bf16 v[208:211], a[40:43], a[144:147], v[208:211]
    v_mfma_f32_16x16x32_bf16 v[212:215], a[40:43], a[148:151], v[212:215]
    ds_read_b64_tr_b16 a[14:15], v45 offset:50176
    v_mfma_f32_16x16x32_bf16 a[80:83], a[40:43], a[152:155], a[80:83]
    buffer_load_dwordx4 v41, s[12:15], s61 offen offset:3072 lds
    ds_read_b64_tr_b16 a[16:17], v46 offset:49152
    v_mfma_f32_16x16x32_bf16 a[84:87], a[40:43], a[156:159], a[84:87]
    ds_read_b64_tr_b16 a[18:19], v46 offset:50176
    v_mfma_f32_16x16x32_bf16 v[216:219], a[44:47], a[144:147], v[216:219]
    s_add_u32 s61, s61, 0x80000
    v_mfma_f32_16x16x32_bf16 v[220:223], a[44:47], a[148:151], v[220:223]
    buffer_load_dwordx4 a[192:195], v36, s[8:11], s62 offen offset:0 sc1
    ds_read_b64_tr_b16 a[20:21], v47 offset:49152
    v_mfma_f32_16x16x32_bf16 a[88:91], a[44:47], a[152:155], a[88:91]
    ds_read_b64_tr_b16 a[22:23], v47 offset:50176
    v_mfma_f32_16x16x32_bf16 a[92:95], a[44:47], a[156:159], a[92:95]
    buffer_load_dwordx4 a[196:199], v36, s[8:11], s62 offen offset:1024 sc1
    ds_read_b64_tr_b16 a[24:25], v48 offset:49152
    v_mfma_f32_16x16x32_bf16 v[224:227], a[48:51], a[144:147], v[224:227]
    v_mfma_f32_16x16x32_bf16 v[228:231], a[48:51], a[148:151], v[228:231]
    ds_read_b64_tr_b16 a[26:27], v48 offset:50176
    v_mfma_f32_16x16x32_bf16 a[96:99], a[48:51], a[152:155], a[96:99]
    buffer_load_dwordx4 a[200:203], v37, s[8:11], s62 offen offset:0 sc1
    ds_read_b64_tr_b16 a[28:29], v49 offset:49152
    v_mfma_f32_16x16x32_bf16 a[100:103], a[48:51], a[156:159], a[100:103]
    v_mfma_f32_16x16x32_bf16 v[232:235], a[52:55], a[144:147], v[232:235]
    ds_read_b64_tr_b16 a[30:31], v49 offset:50176
    v_mfma_f32_16x16x32_bf16 v[236:239], a[52:55], a[148:151], v[236:239]
    buffer_load_dwordx4 a[204:207], v37, s[8:11], s62 offen offset:1024 sc1
    v_mfma_f32_16x16x32_bf16 a[104:107], a[52:55], a[152:155], a[104:107]
    v_mfma_f32_16x16x32_bf16 a[108:111], a[52:55], a[156:159], a[108:111]
    s_add_u32 s62, s62, 0x20000
    v_mfma_f32_16x16x32_bf16 v[240:243], a[56:59], a[144:147], v[240:243]
    s_add_u32 s52, s47, 532480
    v_mfma_f32_16x16x32_bf16 v[244:247], a[56:59], a[148:151], v[244:247]
    buffer_store_dwordx4 v[160:163], v1, s[48:51], s52 offen offset:0 sc1
    v_mfma_f32_16x16x32_bf16 a[112:115], a[56:59], a[152:155], a[112:115]
    v_mfma_f32_16x16x32_bf16 a[116:119], a[56:59], a[156:159], a[116:119]
    v_mfma_f32_16x16x32_bf16 v[248:251], a[60:63], a[144:147], v[248:251]
    v_mfma_f32_16x16x32_bf16 v[252:255], a[60:63], a[148:151], v[252:255]
    v_mfma_f32_16x16x32_bf16 a[120:123], a[60:63], a[152:155], a[120:123]
    v_mfma_f32_16x16x32_bf16 a[124:127], a[60:63], a[156:159], a[124:127]
    s_waitcnt vmcnt(16) lgkmcnt(0)
    v_mfma_f32_16x16x32_bf16 v[192:195], a[0:3], a[160:163], v[192:195]
    ds_read_b64_tr_b16 a[32:33], v42 offset:57344
    ds_read_b64_tr_b16 a[34:35], v42 offset:58368
    v_mfma_f32_16x16x32_bf16 v[196:199], a[0:3], a[164:167], v[196:199]
    buffer_load_dwordx4 a[208:211], v36, s[8:11], s62 offen offset:0 sc1
    v_mfma_f32_16x16x32_bf16 a[64:67], a[0:3], a[168:171], a[64:67]
    ds_read_b64_tr_b16 a[36:37], v43 offset:57344
    v_mfma_f32_16x16x32_bf16 a[68:71], a[0:3], a[172:175], a[68:71]
    ds_read_b64_tr_b16 a[38:39], v43 offset:58368
    v_mfma_f32_16x16x32_bf16 v[200:203], a[4:7], a[160:163], v[200:203]
    ds_read_b64_tr_b16 a[40:41], v44 offset:57344
    v_mfma_f32_16x16x32_bf16 v[204:207], a[4:7], a[164:167], v[204:207]
    v_mfma_f32_16x16x32_bf16 a[72:75], a[4:7], a[168:171], a[72:75]
    buffer_load_dwordx4 a[212:215], v36, s[8:11], s62 offen offset:1024 sc1
    ds_read_b64_tr_b16 a[42:43], v44 offset:58368
    v_mfma_f32_16x16x32_bf16 a[76:79], a[4:7], a[172:175], a[76:79]
    ds_read_b64_tr_b16 a[44:45], v45 offset:57344
    v_mfma_f32_16x16x32_bf16 v[208:211], a[8:11], a[160:163], v[208:211]
    v_mfma_f32_16x16x32_bf16 v[212:215], a[8:11], a[164:167], v[212:215]
    ds_read_b64_tr_b16 a[46:47], v45 offset:58368
    v_mfma_f32_16x16x32_bf16 a[80:83], a[8:11], a[168:171], a[80:83]
    ds_read_b64_tr_b16 a[48:49], v46 offset:57344
    v_mfma_f32_16x16x32_bf16 a[84:87], a[8:11], a[172:175], a[84:87]
    buffer_load_dwordx4 a[216:219], v37, s[8:11], s62 offen offset:0 sc1
    ds_read_b64_tr_b16 a[50:51], v46 offset:58368
    v_mfma_f32_16x16x32_bf16 v[216:219], a[12:15], a[160:163], v[216:219]
    v_mfma_f32_16x16x32_bf16 v[220:223], a[12:15], a[164:167], v[220:223]
    ds_read_b64_tr_b16 a[52:53], v47 offset:57344
    v_mfma_f32_16x16x32_bf16 a[88:91], a[12:15], a[168:171], a[88:91]
    ds_read_b64_tr_b16 a[54:55], v47 offset:58368
    v_mfma_f32_16x16x32_bf16 a[92:95], a[12:15], a[172:175], a[92:95]
    ds_read_b64_tr_b16 a[56:57], v48 offset:57344
    v_mfma_f32_16x16x32_bf16 v[224:227], a[16:19], a[160:163], v[224:227]
    v_mfma_f32_16x16x32_bf16 v[228:231], a[16:19], a[164:167], v[228:231]
    buffer_load_dwordx4 a[220:223], v37, s[8:11], s62 offen offset:1024 sc1
    ds_read_b64_tr_b16 a[58:59], v48 offset:58368
    v_mfma_f32_16x16x32_bf16 a[96:99], a[16:19], a[168:171], a[96:99]
    ds_read_b64_tr_b16 a[60:61], v49 offset:57344
    v_mfma_f32_16x16x32_bf16 a[100:103], a[16:19], a[172:175], a[100:103]
    v_mfma_f32_16x16x32_bf16 v[232:235], a[20:23], a[160:163], v[232:235]
    ds_read_b64_tr_b16 a[62:63], v49 offset:58368
    v_mfma_f32_16x16x32_bf16 v[236:239], a[20:23], a[164:167], v[236:239]
    s_add_u32 s62, s62, 0x20000
    v_mfma_f32_16x16x32_bf16 a[104:107], a[20:23], a[168:171], a[104:107]
    s_add_u32 s52, s47, 532480
    v_mfma_f32_16x16x32_bf16 a[108:111], a[20:23], a[172:175], a[108:111]
    buffer_store_dwordx4 v[164:167], v1, s[48:51], s52 offen offset:1024 sc1
    v_mfma_f32_16x16x32_bf16 v[240:243], a[24:27], a[160:163], v[240:243]
    v_mfma_f32_16x16x32_bf16 v[244:247], a[24:27], a[164:167], v[244:247]
    v_mfma_f32_16x16x32_bf16 a[112:115], a[24:27], a[168:171], a[112:115]
    v_mfma_f32_16x16x32_bf16 a[116:119], a[24:27], a[172:175], a[116:119]
    v_mfma_f32_16x16x32_bf16 v[248:251], a[28:31], a[160:163], v[248:251]
    v_mfma_f32_16x16x32_bf16 v[252:255], a[28:31], a[164:167], v[252:255]
    v_mfma_f32_16x16x32_bf16 a[120:123], a[28:31], a[168:171], a[120:123]
    v_mfma_f32_16x16x32_bf16 a[124:127], a[28:31], a[172:175], a[124:127]
    s_waitcnt vmcnt(10) lgkmcnt(0)
    s_barrier
    v_mfma_f32_16x16x32_bf16 v[192:195], a[32:35], a[176:179], v[192:195]
    ds_read_b64_tr_b16 a[0:1], v42 offset:0
    ds_read_b64_tr_b16 a[2:3], v42 offset:1024
    v_mfma_f32_16x16x32_bf16 v[196:199], a[32:35], a[180:183], v[196:199]
    s_cmp_eq_u32 s56, 0
    s_cbranch_scc1 k12_ool_60
k12_oolret_61:
    v_mfma_f32_16x16x32_bf16 a[64:67], a[32:35], a[184:187], a[64:67]
    s_add_u32 m0, s60, 114688
    ds_read_b64_tr_b16 a[4:5], v43 offset:0
    v_mfma_f32_16x16x32_bf16 a[68:71], a[32:35], a[188:191], a[68:71]
    buffer_load_dwordx4 v38, s[12:15], s61 offen offset:0 lds
    ds_read_b64_tr_b16 a[6:7], v43 offset:1024
    v_mfma_f32_16x16x32_bf16 v[200:203], a[36:39], a[176:179], v[200:203]
    buffer_load_dwordx4 v39, s[12:15], s61 offen offset:1024 lds
    ds_read_b64_tr_b16 a[8:9], v44 offset:0
    v_mfma_f32_16x16x32_bf16 v[204:207], a[36:39], a[180:183], v[204:207]
    v_mfma_f32_16x16x32_bf16 a[72:75], a[36:39], a[184:187], a[72:75]
    ds_read_b64_tr_b16 a[10:11], v44 offset:1024
    v_mfma_f32_16x16x32_bf16 a[76:79], a[36:39], a[188:191], a[76:79]
    buffer_load_dwordx4 v40, s[12:15], s61 offen offset:2048 lds
    ds_read_b64_tr_b16 a[12:13], v45 offset:0
    v_mfma_f32_16x16x32_bf16 v[208:211], a[40:43], a[176:179], v[208:211]
    s_mov_b32 s32, s60
    v_mfma_f32_16x16x32_bf16 v[212:215], a[40:43], a[180:183], v[212:215]
    ds_read_b64_tr_b16 a[14:15], v45 offset:1024
    v_mfma_f32_16x16x32_bf16 a[80:83], a[40:43], a[184:187], a[80:83]
    s_mov_b32 s34, s60
    buffer_load_dwordx4 v41, s[12:15], s61 offen offset:3072 lds
    ds_read_b64_tr_b16 a[16:17], v46 offset:0
    v_mfma_f32_16x16x32_bf16 a[84:87], a[40:43], a[188:191], a[84:87]
    ds_read_b64_tr_b16 a[18:19], v46 offset:1024
    v_mfma_f32_16x16x32_bf16 v[216:219], a[44:47], a[176:179], v[216:219]
    s_add_u32 s61, s61, 0x80000
    v_mfma_f32_16x16x32_bf16 v[220:223], a[44:47], a[180:183], v[220:223]
    s_mov_b32 s33, s60
    buffer_load_dwordx4 a[224:227], v36, s[8:11], s62 offen offset:0 sc1
    ds_read_b64_tr_b16 a[20:21], v47 offset:0
    v_mfma_f32_16x16x32_bf16 a[88:91], a[44:47], a[184:187], a[88:91]
    ds_read_b64_tr_b16 a[22:23], v47 offset:1024
    v_mfma_f32_16x16x32_bf16 a[92:95], a[44:47], a[188:191], a[92:95]
    buffer_load_dwordx4 a[228:231], v36, s[8:11], s62 offen offset:1024 sc1
    ds_read_b64_tr_b16 a[24:25], v48 offset:0
    v_mfma_f32_16x16x32_bf16 v[224:227], a[48:51], a[176:179], v[224:227]
    s_add_u32 s35, s60, 0x10000
    v_mfma_f32_16x16x32_bf16 v[228:231], a[48:51], a[180:183], v[228:231]
    ds_read_b64_tr_b16 a[26:27], v48 offset:1024
    v_mfma_f32_16x16x32_bf16 a[96:99], a[48:51], a[184:187], a[96:99]
    buffer_load_dwordx4 a[232:235], v37, s[8:11], s62 offen offset:0 sc1
    ds_read_b64_tr_b16 a[28:29], v49 offset:0
    v_mfma_f32_16x16x32_bf16 a[100:103], a[48:51], a[188:191], a[100:103]
    v_mfma_f32_16x16x32_bf16 v[232:235], a[52:55], a[176:179], v[232:235]
    ds_read_b64_tr_b16 a[30:31], v49 offset:1024
    v_mfma_f32_16x16x32_bf16 v[236:239], a[52:55], a[180:183], v[236:239]
    buffer_load_dwordx4 a[236:239], v37, s[8:11], s62 offen offset:1024 sc1
    v_mfma_f32_16x16x32_bf16 a[104:107], a[52:55], a[184:187], a[104:107]
    v_mfma_f32_16x16x32_bf16 a[108:111], a[52:55], a[188:191], a[108:111]
    s_add_u32 s62, s62, 0x20000
    v_mfma_f32_16x16x32_bf16 v[240:243], a[56:59], a[176:179], v[240:243]
    s_add_u32 s52, s47, 532480
    v_mfma_f32_16x16x32_bf16 v[244:247], a[56:59], a[180:183], v[244:247]
    buffer_store_dwordx4 v[168:171], v1, s[48:51], s52 offen offset:2048 sc1
    v_mfma_f32_16x16x32_bf16 a[112:115], a[56:59], a[184:187], a[112:115]
    v_mfma_f32_16x16x32_bf16 a[116:119], a[56:59], a[188:191], a[116:119]
    v_mfma_f32_16x16x32_bf16 v[248:251], a[60:63], a[176:179], v[248:251]
    v_mfma_f32_16x16x32_bf16 v[252:255], a[60:63], a[180:183], v[252:255]
    v_mfma_f32_16x16x32_bf16 a[120:123], a[60:63], a[184:187], a[120:123]
    v_mfma_f32_16x16x32_bf16 a[124:127], a[60:63], a[188:191], a[124:127]
    s_waitcnt vmcnt(15) lgkmcnt(0)
    v_mfma_f32_16x16x32_bf16 v[192:195], a[0:3], a[192:195], v[192:195]
    ds_read_b64_tr_b16 a[32:33], v42 offset:8192
    ds_read_b64_tr_b16 a[34:35], v42 offset:9216
    v_mfma_f32_16x16x32_bf16 v[196:199], a[0:3], a[196:199], v[196:199]
    buffer_load_dwordx4 a[240:243], v36, s[8:11], s62 offen offset:0 sc1
    v_mfma_f32_16x16x32_bf16 a[64:67], a[0:3], a[200:203], a[64:67]
    ds_read_b64_tr_b16 a[36:37], v43 offset:8192
    v_mfma_f32_16x16x32_bf16 a[68:71], a[0:3], a[204:207], a[68:71]
    ds_read_b64_tr_b16 a[38:39], v43 offset:9216
    v_mfma_f32_16x16x32_bf16 v[200:203], a[4:7], a[192:195], v[200:203]
    ds_read_b64_tr_b16 a[40:41], v44 offset:8192
    v_mfma_f32_16x16x32_bf16 v[204:207], a[4:7], a[196:199], v[204:207]
    v_mfma_f32_16x16x32_bf16 a[72:75], a[4:7], a[200:203], a[72:75]
    buffer_load_dwordx4 a[244:247], v36, s[8:11], s62 offen offset:1024 sc1
    ds_read_b64_tr_b16 a[42:43], v44 offset:9216
    v_mfma_f32_16x16x32_bf16 a[76:79], a[4:7], a[204:207], a[76:79]
    ds_read_b64_tr_b16 a[44:45], v45 offset:8192
    v_mfma_f32_16x16x32_bf16 v[208:211], a[8:11], a[192:195], v[208:211]
    v_mfma_f32_16x16x32_bf16 v[212:215], a[8:11], a[196:199], v[212:215]
    ds_read_b64_tr_b16 a[46:47], v45 offset:9216
    v_mfma_f32_16x16x32_bf16 a[80:83], a[8:11], a[200:203], a[80:83]
    ds_read_b64_tr_b16 a[48:49], v46 offset:8192
    v_mfma_f32_16x16x32_bf16 a[84:87], a[8:11], a[204:207], a[84:87]
    buffer_load_dwordx4 a[248:251], v37, s[8:11], s62 offen offset:0 sc1
    ds_read_b64_tr_b16 a[50:51], v46 offset:9216
    v_mfma_f32_16x16x32_bf16 v[216:219], a[12:15], a[192:195], v[216:219]
    v_mfma_f32_16x16x32_bf16 v[220:223], a[12:15], a[196:199], v[220:223]
    ds_read_b64_tr_b16 a[52:53], v47 offset:8192
    v_mfma_f32_16x16x32_bf16 a[88:91], a[12:15], a[200:203], a[88:91]
    ds_read_b64_tr_b16 a[54:55], v47 offset:9216
    v_mfma_f32_16x16x32_bf16 a[92:95], a[12:15], a[204:207], a[92:95]
    ds_read_b64_tr_b16 a[56:57], v48 offset:8192
    v_mfma_f32_16x16x32_bf16 v[224:227], a[16:19], a[192:195], v[224:227]
    v_mfma_f32_16x16x32_bf16 v[228:231], a[16:19], a[196:199], v[228:231]
    buffer_load_dwordx4 a[252:255], v37, s[8:11], s62 offen offset:1024 sc1
    ds_read_b64_tr_b16 a[58:59], v48 offset:9216
    v_mfma_f32_16x16x32_bf16 a[96:99], a[16:19], a[200:203], a[96:99]
    ds_read_b64_tr_b16 a[60:61], v49 offset:8192
    v_mfma_f32_16x16x32_bf16 a[100:103], a[16:19], a[204:207], a[100:103]
    v_mfma_f32_16x16x32_bf16 v[232:235], a[20:23], a[192:195], v[232:235]
    ds_read_b64_tr_b16 a[62:63], v49 offset:9216
    v_mfma_f32_16x16x32_bf16 v[236:239], a[20:23], a[196:199], v[236:239]
    s_add_u32 s62, s62, 0x20000
    v_mfma_f32_16x16x32_bf16 a[104:107], a[20:23], a[200:203], a[104:107]
    s_add_u32 s52, s47, 532480
    v_mfma_f32_16x16x32_bf16 a[108:111], a[20:23], a[204:207], a[108:111]
    buffer_store_dwordx4 v[172:175], v1, s[48:51], s52 offen offset:3072 sc1
    v_mfma_f32_16x16x32_bf16 v[240:243], a[24:27], a[192:195], v[240:243]
    v_mfma_f32_16x16x32_bf16 v[244:247], a[24:27], a[196:199], v[244:247]
    v_mfma_f32_16x16x32_bf16 a[112:115], a[24:27], a[200:203], a[112:115]
    v_mfma_f32_16x16x32_bf16 a[116:119], a[24:27], a[204:207], a[116:119]
    v_mfma_f32_16x16x32_bf16 v[248:251], a[28:31], a[192:195], v[248:251]
    v_add_co_u32 v2, vcc, 0x4000, v2
    s_nop 1
    v_addc_co_u32 v3, vcc, 0, v3, vcc
    global_load_dword v51, v[2:3], off
    v_mfma_f32_16x16x32_bf16 v[252:255], a[28:31], a[196:199], v[252:255]
    v_mfma_f32_16x16x32_bf16 a[120:123], a[28:31], a[200:203], a[120:123]
    v_mfma_f32_16x16x32_bf16 a[124:127], a[28:31], a[204:207], a[124:127]
    s_waitcnt vmcnt(10) lgkmcnt(0)
    s_barrier
    v_mfma_f32_16x16x32_bf16 v[192:195], a[32:35], a[208:211], v[192:195]
    ds_read_b64_tr_b16 a[0:1], v42 offset:16384
    ds_read_b64_tr_b16 a[2:3], v42 offset:17408
    v_mfma_f32_16x16x32_bf16 v[196:199], a[32:35], a[212:215], v[196:199]
    s_add_u32 m0, s60, 131072
    v_mfma_f32_16x16x32_bf16 a[64:67], a[32:35], a[216:219], a[64:67]
    buffer_load_dwordx4 v38, s[12:15], s61 offen offset:0 lds
    ds_read_b64_tr_b16 a[4:5], v43 offset:16384
    v_mfma_f32_16x16x32_bf16 a[68:71], a[32:35], a[220:223], a[68:71]
    ds_read_b64_tr_b16 a[6:7], v43 offset:17408
    v_mfma_f32_16x16x32_bf16 v[200:203], a[36:39], a[208:211], v[200:203]
    buffer_load_dwordx4 v39, s[12:15], s61 offen offset:1024 lds
    ds_read_b64_tr_b16 a[8:9], v44 offset:16384
    v_mfma_f32_16x16x32_bf16 v[204:207], a[36:39], a[212:215], v[204:207]
    v_mfma_f32_16x16x32_bf16 a[72:75], a[36:39], a[216:219], a[72:75]
    ds_read_b64_tr_b16 a[10:11], v44 offset:17408
    v_mfma_f32_16x16x32_bf16 a[76:79], a[36:39], a[220:223], a[76:79]
    buffer_load_dwordx4 v40, s[12:15], s61 offen offset:2048 lds
    ds_read_b64_tr_b16 a[12:13], v45 offset:16384
    v_mfma_f32_16x16x32_bf16 v[208:211], a[40:43], a[208:211], v[208:211]
    v_mfma_f32_16x16x32_bf16 v[212:215], a[40:43], a[212:215], v[212:215]
    ds_read_b64_tr_b16 a[14:15], v45 offset:17408
    v_mfma_f32_16x16x32_bf16 a[80:83], a[40:43], a[216:219], a[80:83]
    buffer_load_dwordx4 v41, s[12:15], s61 offen offset:3072 lds
    ds_read_b64_tr_b16 a[16:17], v46 offset:16384
    v_mfma_f32_16x16x32_bf16 a[84:87], a[40:43], a[220:223], a[84:87]
    ds_read_b64_tr_b16 a[18:19], v46 offset:17408
    v_mfma_f32_16x16x32_bf16 v[216:219], a[44:47], a[208:211], v[216:219]
    s_add_u32 s61, s61, 0x80000
    v_mfma_f32_16x16x32_bf16 v[220:223], a[44:47], a[212:215], v[220:223]
    buffer_load_dwordx4 a[128:131], v36, s[8:11], s62 offen offset:0 sc1
    ds_read_b64_tr_b16 a[20:21], v47 offset:16384
    v_mfma_f32_16x16x32_bf16 a[88:91], a[44:47], a[216:219], a[88:91]
    ds_read_b64_tr_b16 a[22:23], v47 offset:17408
    v_mfma_f32_16x16x32_bf16 a[92:95], a[44:47], a[220:223], a[92:95]
    buffer_load_dwordx4 a[132:135], v36, s[8:11], s62 offen offset:1024 sc1
    ds_read_b64_tr_b16 a[24:25], v48 offset:16384
    v_mfma_f32_16x16x32_bf16 v[224:227], a[48:51], a[208:211], v[224:227]
    v_mfma_f32_16x16x32_bf16 v[228:231], a[48:51], a[212:215], v[228:231]
    ds_read_b64_tr_b16 a[26:27], v48 offset:17408
    v_mfma_f32_16x16x32_bf16 a[96:99], a[48:51], a[216:219], a[96:99]
    buffer_load_dwordx4 a[136:139], v37, s[8:11], s62 offen offset:0 sc1
    ds_read_b64_tr_b16 a[28:29], v49 offset:16384
    v_mfma_f32_16x16x32_bf16 a[100:103], a[48:51], a[220:223], a[100:103]
    v_mfma_f32_16x16x32_bf16 v[232:235], a[52:55], a[208:211], v[232:235]
    ds_read_b64_tr_b16 a[30:31], v49 offset:17408
    v_mfma_f32_16x16x32_bf16 v[236:239], a[52:55], a[212:215], v[236:239]
    buffer_load_dwordx4 a[140:143], v37, s[8:11], s62 offen offset:1024 sc1
    v_mfma_f32_16x16x32_bf16 a[104:107], a[52:55], a[216:219], a[104:107]
    v_mfma_f32_16x16x32_bf16 a[108:111], a[52:55], a[220:223], a[108:111]
    s_add_u32 s62, s62, 0x20000
    v_mfma_f32_16x16x32_bf16 v[240:243], a[56:59], a[208:211], v[240:243]
    s_add_u32 s52, s47, 536576
    v_mfma_f32_16x16x32_bf16 v[244:247], a[56:59], a[212:215], v[244:247]
    buffer_store_dwordx4 v[176:179], v1, s[48:51], s52 offen offset:0 sc1
    v_mfma_f32_16x16x32_bf16 a[112:115], a[56:59], a[216:219], a[112:115]
    v_mfma_f32_16x16x32_bf16 a[116:119], a[56:59], a[220:223], a[116:119]
    v_mfma_f32_16x16x32_bf16 v[248:251], a[60:63], a[208:211], v[248:251]
    v_mfma_f32_16x16x32_bf16 v[252:255], a[60:63], a[212:215], v[252:255]
    v_mfma_f32_16x16x32_bf16 a[120:123], a[60:63], a[216:219], a[120:123]
    v_mfma_f32_16x16x32_bf16 a[124:127], a[60:63], a[220:223], a[124:127]
    s_waitcnt vmcnt(15) lgkmcnt(0)
    v_mfma_f32_16x16x32_bf16 v[192:195], a[0:3], a[224:227], v[192:195]
    ds_read_b64_tr_b16 a[32:33], v42 offset:24576
    ds_read_b64_tr_b16 a[34:35], v42 offset:25600
    v_mfma_f32_16x16x32_bf16 v[196:199], a[0:3], a[228:231], v[196:199]
    buffer_load_dwordx4 a[144:147], v36, s[8:11], s62 offen offset:0 sc1
    v_mfma_f32_16x16x32_bf16 a[64:67], a[0:3], a[232:235], a[64:67]
    ds_read_b64_tr_b16 a[36:37], v43 offset:24576
    v_mfma_f32_16x16x32_bf16 a[68:71], a[0:3], a[236:239], a[68:71]
    ds_read_b64_tr_b16 a[38:39], v43 offset:25600
    v_mfma_f32_16x16x32_bf16 v[200:203], a[4:7], a[224:227], v[200:203]
    ds_read_b64_tr_b16 a[40:41], v44 offset:24576
    v_mfma_f32_16x16x32_bf16 v[204:207], a[4:7], a[228:231], v[204:207]
    v_mfma_f32_16x16x32_bf16 a[72:75], a[4:7], a[232:235], a[72:75]
    buffer_load_dwordx4 a[148:151], v36, s[8:11], s62 offen offset:1024 sc1
    ds_read_b64_tr_b16 a[42:43], v44 offset:25600
    v_mfma_f32_16x16x32_bf16 a[76:79], a[4:7], a[236:239], a[76:79]
    ds_read_b64_tr_b16 a[44:45], v45 offset:24576
    v_mfma_f32_16x16x32_bf16 v[208:211], a[8:11], a[224:227], v[208:211]
    v_mfma_f32_16x16x32_bf16 v[212:215], a[8:11], a[228:231], v[212:215]
    ds_read_b64_tr_b16 a[46:47], v45 offset:25600
    v_mfma_f32_16x16x32_bf16 a[80:83], a[8:11], a[232:235], a[80:83]
    ds_read_b64_tr_b16 a[48:49], v46 offset:24576
    v_mfma_f32_16x16x32_bf16 a[84:87], a[8:11], a[236:239], a[84:87]
    buffer_load_dwordx4 a[152:155], v37, s[8:11], s62 offen offset:0 sc1
    ds_read_b64_tr_b16 a[50:51], v46 offset:25600
    v_mfma_f32_16x16x32_bf16 v[216:219], a[12:15], a[224:227], v[216:219]
    v_mfma_f32_16x16x32_bf16 v[220:223], a[12:15], a[228:231], v[220:223]
    ds_read_b64_tr_b16 a[52:53], v47 offset:24576
    v_mfma_f32_16x16x32_bf16 a[88:91], a[12:15], a[232:235], a[88:91]
    ds_read_b64_tr_b16 a[54:55], v47 offset:25600
    v_mfma_f32_16x16x32_bf16 a[92:95], a[12:15], a[236:239], a[92:95]
    ds_read_b64_tr_b16 a[56:57], v48 offset:24576
    v_mfma_f32_16x16x32_bf16 v[224:227], a[16:19], a[224:227], v[224:227]
    v_mfma_f32_16x16x32_bf16 v[228:231], a[16:19], a[228:231], v[228:231]
    buffer_load_dwordx4 a[156:159], v37, s[8:11], s62 offen offset:1024 sc1
    ds_read_b64_tr_b16 a[58:59], v48 offset:25600
    v_mfma_f32_16x16x32_bf16 a[96:99], a[16:19], a[232:235], a[96:99]
    ds_read_b64_tr_b16 a[60:61], v49 offset:24576
    v_mfma_f32_16x16x32_bf16 a[100:103], a[16:19], a[236:239], a[100:103]
    v_mfma_f32_16x16x32_bf16 v[232:235], a[20:23], a[224:227], v[232:235]
    ds_read_b64_tr_b16 a[62:63], v49 offset:25600
    v_mfma_f32_16x16x32_bf16 v[236:239], a[20:23], a[228:231], v[236:239]
    s_add_u32 s62, s62, 0x20000
    v_mfma_f32_16x16x32_bf16 a[104:107], a[20:23], a[232:235], a[104:107]
    s_add_u32 s52, s47, 536576
    v_mfma_f32_16x16x32_bf16 a[108:111], a[20:23], a[236:239], a[108:111]
    buffer_store_dwordx4 v[180:183], v1, s[48:51], s52 offen offset:1024 sc1
    v_mfma_f32_16x16x32_bf16 v[240:243], a[24:27], a[224:227], v[240:243]
    v_mfma_f32_16x16x32_bf16 v[244:247], a[24:27], a[228:231], v[244:247]
    v_mfma_f32_16x16x32_bf16 a[112:115], a[24:27], a[232:235], a[112:115]
    v_mfma_f32_16x16x32_bf16 a[116:119], a[24:27], a[236:239], a[116:119]
    v_mfma_f32_16x16x32_bf16 v[248:251], a[28:31], a[224:227], v[248:251]
    v_mfma_f32_16x16x32_bf16 v[252:255], a[28:31], a[228:231], v[252:255]
    v_mfma_f32_16x16x32_bf16 a[120:123], a[28:31], a[232:235], a[120:123]
    v_mfma_f32_16x16x32_bf16 a[124:127], a[28:31], a[236:239], a[124:127]
    s_waitcnt vmcnt(10) lgkmcnt(0)
    s_barrier
    v_mfma_f32_16x16x32_bf16 v[192:195], a[32:35], a[240:243], v[192:195]
    ds_read_b64_tr_b16 a[0:1], v42 offset:32768
    ds_read_b64_tr_b16 a[2:3], v42 offset:33792
    v_mfma_f32_16x16x32_bf16 v[196:199], a[32:35], a[244:247], v[196:199]
    s_cmp_eq_u32 s30, 0
    s_cbranch_scc1 k12_ool_62
k12_oolret_63:
    v_mfma_f32_16x16x32_bf16 a[64:67], a[32:35], a[248:251], a[64:67]
    s_add_u32 m0, s60, 147456
    ds_read_b64_tr_b16 a[4:5], v43 offset:32768
    v_mfma_f32_16x16x32_bf16 a[68:71], a[32:35], a[252:255], a[68:71]
    buffer_load_dwordx4 v38, s[12:15], s61 offen offset:0 lds
    ds_read_b64_tr_b16 a[6:7], v43 offset:33792
    v_mfma_f32_16x16x32_bf16 v[200:203], a[36:39], a[240:243], v[200:203]
    buffer_load_dwordx4 v39, s[12:15], s61 offen offset:1024 lds
    ds_read_b64_tr_b16 a[8:9], v44 offset:32768
    v_mfma_f32_16x16x32_bf16 v[204:207], a[36:39], a[244:247], v[204:207]
    v_mfma_f32_16x16x32_bf16 a[72:75], a[36:39], a[248:251], a[72:75]
    ds_read_b64_tr_b16 a[10:11], v44 offset:33792
    v_mfma_f32_16x16x32_bf16 a[76:79], a[36:39], a[252:255], a[76:79]
    buffer_load_dwordx4 v40, s[12:15], s61 offen offset:2048 lds
    ds_read_b64_tr_b16 a[12:13], v45 offset:32768
    v_mfma_f32_16x16x32_bf16 v[208:211], a[40:43], a[240:243], v[208:211]
    v_mfma_f32_16x16x32_bf16 v[212:215], a[40:43], a[244:247], v[212:215]
    ds_read_b64_tr_b16 a[14:15], v45 offset:33792
    v_mfma_f32_16x16x32_bf16 a[80:83], a[40:43], a[248:251], a[80:83]
    buffer_load_dwordx4 v41, s[12:15], s61 offen offset:3072 lds
    ds_read_b64_tr_b16 a[16:17], v46 offset:32768
    v_mfma_f32_16x16x32_bf16 a[84:87], a[40:43], a[252:255], a[84:87]
    ds_read_b64_tr_b16 a[18:19], v46 offset:33792
    v_mfma_f32_16x16x32_bf16 v[216:219], a[44:47], a[240:243], v[216:219]
    s_add_u32 s61, s61, 0x80000
    v_mfma_f32_16x16x32_bf16 v[220:223], a[44:47], a[244:247], v[220:223]
    buffer_load_dwordx4 a[160:163], v36, s[8:11], s62 offen offset:0 sc1
    ds_read_b64_tr_b16 a[20:21], v47 offset:32768
    v_mfma_f32_16x16x32_bf16 a[88:91], a[44:47], a[248:251], a[88:91]
    ds_read_b64_tr_b16 a[22:23], v47 offset:33792
    v_mfma_f32_16x16x32_bf16 a[92:95], a[44:47], a[252:255], a[92:95]
    buffer_load_dwordx4 a[164:167], v36, s[8:11], s62 offen offset:1024 sc1
    ds_read_b64_tr_b16 a[24:25], v48 offset:32768
    v_mfma_f32_16x16x32_bf16 v[224:227], a[48:51], a[240:243], v[224:227]
    v_mfma_f32_16x16x32_bf16 v[228:231], a[48:51], a[244:247], v[228:231]
    ds_read_b64_tr_b16 a[26:27], v48 offset:33792
    v_mfma_f32_16x16x32_bf16 a[96:99], a[48:51], a[248:251], a[96:99]
    buffer_load_dwordx4 a[168:171], v37, s[8:11], s62 offen offset:0 sc1
    ds_read_b64_tr_b16 a[28:29], v49 offset:32768
    v_mfma_f32_16x16x32_bf16 a[100:103], a[48:51], a[252:255], a[100:103]
    v_mfma_f32_16x16x32_bf16 v[232:235], a[52:55], a[240:243], v[232:235]
    ds_read_b64_tr_b16 a[30:31], v49 offset:33792
    v_mfma_f32_16x16x32_bf16 v[236:239], a[52:55], a[244:247], v[236:239]
    buffer_load_dwordx4 a[172:175], v37, s[8:11], s62 offen offset:1024 sc1
    v_mfma_f32_16x16x32_bf16 a[104:107], a[52:55], a[248:251], a[104:107]
    v_mfma_f32_16x16x32_bf16 a[108:111], a[52:55], a[252:255], a[108:111]
    s_add_u32 s62, s62, 0x20000
    v_mfma_f32_16x16x32_bf16 v[240:243], a[56:59], a[240:243], v[240:243]
    s_add_u32 s52, s47, 536576
    v_mfma_f32_16x16x32_bf16 v[244:247], a[56:59], a[244:247], v[244:247]
    buffer_store_dwordx4 v[184:187], v1, s[48:51], s52 offen offset:2048 sc1
    v_mfma_f32_16x16x32_bf16 a[112:115], a[56:59], a[248:251], a[112:115]
    v_mfma_f32_16x16x32_bf16 a[116:119], a[56:59], a[252:255], a[116:119]
    v_mfma_f32_16x16x32_bf16 v[248:251], a[60:63], a[240:243], v[248:251]
    v_mfma_f32_16x16x32_bf16 v[252:255], a[60:63], a[244:247], v[252:255]
    v_mfma_f32_16x16x32_bf16 a[120:123], a[60:63], a[248:251], a[120:123]
    v_mfma_f32_16x16x32_bf16 a[124:127], a[60:63], a[252:255], a[124:127]
    s_waitcnt vmcnt(15) lgkmcnt(0)
    v_mfma_f32_16x16x32_bf16 v[192:195], a[0:3], a[128:131], v[192:195]
    ds_read_b64_tr_b16 a[32:33], v42 offset:40960
    ds_read_b64_tr_b16 a[34:35], v42 offset:41984
    v_mfma_f32_16x16x32_bf16 v[196:199], a[0:3], a[132:135], v[196:199]
    buffer_load_dwordx4 a[176:179], v36, s[8:11], s62 offen offset:0 sc1
    v_mfma_f32_16x16x32_bf16 a[64:67], a[0:3], a[136:139], a[64:67]
    ds_read_b64_tr_b16 a[36:37], v43 offset:40960
    v_mfma_f32_16x16x32_bf16 a[68:71], a[0:3], a[140:143], a[68:71]
    ds_read_b64_tr_b16 a[38:39], v43 offset:41984
    v_mfma_f32_16x16x32_bf16 v[200:203], a[4:7], a[128:131], v[200:203]
    ds_read_b64_tr_b16 a[40:41], v44 offset:40960
    v_mfma_f32_16x16x32_bf16 v[204:207], a[4:7], a[132:135], v[204:207]
    v_mfma_f32_16x16x32_bf16 a[72:75], a[4:7], a[136:139], a[72:75]
    buffer_load_dwordx4 a[180:183], v36, s[8:11], s62 offen offset:1024 sc1
    ds_read_b64_tr_b16 a[42:43], v44 offset:41984
    v_mfma_f32_16x16x32_bf16 a[76:79], a[4:7], a[140:143], a[76:79]
    ds_read_b64_tr_b16 a[44:45], v45 offset:40960
    v_mfma_f32_16x16x32_bf16 v[208:211], a[8:11], a[128:131], v[208:211]
    v_mfma_f32_16x16x32_bf16 v[212:215], a[8:11], a[132:135], v[212:215]
    ds_read_b64_tr_b16 a[46:47], v45 offset:41984
    v_mfma_f32_16x16x32_bf16 a[80:83], a[8:11], a[136:139], a[80:83]
    ds_read_b64_tr_b16 a[48:49], v46 offset:40960
    v_mfma_f32_16x16x32_bf16 a[84:87], a[8:11], a[140:143], a[84:87]
    buffer_load_dwordx4 a[184:187], v37, s[8:11], s62 offen offset:0 sc1
    ds_read_b64_tr_b16 a[50:51], v46 offset:41984
    v_mfma_f32_16x16x32_bf16 v[216:219], a[12:15], a[128:131], v[216:219]
    v_mfma_f32_16x16x32_bf16 v[220:223], a[12:15], a[132:135], v[220:223]
    ds_read_b64_tr_b16 a[52:53], v47 offset:40960
    v_mfma_f32_16x16x32_bf16 a[88:91], a[12:15], a[136:139], a[88:91]
    ds_read_b64_tr_b16 a[54:55], v47 offset:41984
    v_mfma_f32_16x16x32_bf16 a[92:95], a[12:15], a[140:143], a[92:95]
    ds_read_b64_tr_b16 a[56:57], v48 offset:40960
    v_mfma_f32_16x16x32_bf16 v[224:227], a[16:19], a[128:131], v[224:227]
    v_mfma_f32_16x16x32_bf16 v[228:231], a[16:19], a[132:135], v[228:231]
    buffer_load_dwordx4 a[188:191], v37, s[8:11], s62 offen offset:1024 sc1
    ds_read_b64_tr_b16 a[58:59], v48 offset:41984
    v_mfma_f32_16x16x32_bf16 a[96:99], a[16:19], a[136:139], a[96:99]
    ds_read_b64_tr_b16 a[60:61], v49 offset:40960
    v_mfma_f32_16x16x32_bf16 a[100:103], a[16:19], a[140:143], a[100:103]
    v_mfma_f32_16x16x32_bf16 v[232:235], a[20:23], a[128:131], v[232:235]
    ds_read_b64_tr_b16 a[62:63], v49 offset:41984
    v_mfma_f32_16x16x32_bf16 v[236:239], a[20:23], a[132:135], v[236:239]
    s_add_u32 s62, s62, 0x20000
    v_mfma_f32_16x16x32_bf16 a[104:107], a[20:23], a[136:139], a[104:107]
    s_add_u32 s52, s47, 536576
    v_mfma_f32_16x16x32_bf16 a[108:111], a[20:23], a[140:143], a[108:111]
    buffer_store_dwordx4 v[188:191], v1, s[48:51], s52 offen offset:3072 sc1
    v_mfma_f32_16x16x32_bf16 v[240:243], a[24:27], a[128:131], v[240:243]
    v_mfma_f32_16x16x32_bf16 v[244:247], a[24:27], a[132:135], v[244:247]
    v_mfma_f32_16x16x32_bf16 a[112:115], a[24:27], a[136:139], a[112:115]
    v_mfma_f32_16x16x32_bf16 a[116:119], a[24:27], a[140:143], a[116:119]
    v_mfma_f32_16x16x32_bf16 v[248:251], a[28:31], a[128:131], v[248:251]
    s_cmp_eq_u32 s30, 0
    s_cbranch_scc1 k12_ool_66
k12_oolret_67:
    v_mfma_f32_16x16x32_bf16 v[252:255], a[28:31], a[132:135], v[252:255]
    v_mfma_f32_16x16x32_bf16 a[120:123], a[28:31], a[136:139], a[120:123]
    v_mfma_f32_16x16x32_bf16 a[124:127], a[28:31], a[140:143], a[124:127]
    s_waitcnt vmcnt(10) lgkmcnt(0)
    s_barrier
    v_mfma_f32_16x16x32_bf16 v[192:195], a[32:35], a[144:147], v[192:195]
    ds_read_b64_tr_b16 a[0:1], v42 offset:49152
    ds_read_b64_tr_b16 a[2:3], v42 offset:50176
    v_mfma_f32_16x16x32_bf16 v[196:199], a[32:35], a[148:151], v[196:199]
    s_mov_b32 m0, s34
    v_mfma_f32_16x16x32_bf16 a[64:67], a[32:35], a[152:155], a[64:67]
    buffer_load_dwordx4 v1, s[16:19], s32 offen offset:0 sc1 lds
    ds_read_b64_tr_b16 a[4:5], v43 offset:49152
    v_mfma_f32_16x16x32_bf16 a[68:71], a[32:35], a[156:159], a[68:71]
    ds_read_b64_tr_b16 a[6:7], v43 offset:50176
    v_mfma_f32_16x16x32_bf16 v[200:203], a[36:39], a[144:147], v[200:203]
    buffer_load_dwordx4 v1, s[16:19], s32 offen offset:1024 sc1 lds
    ds_read_b64_tr_b16 a[8:9], v44 offset:49152
    v_mfma_f32_16x16x32_bf16 v[204:207], a[36:39], a[148:151], v[204:207]
    v_mfma_f32_16x16x32_bf16 a[72:75], a[36:39], a[152:155], a[72:75]
    ds_read_b64_tr_b16 a[10:11], v44 offset:50176
    v_mfma_f32_16x16x32_bf16 a[76:79], a[36:39], a[156:159], a[76:79]
    buffer_load_dwordx4 v1, s[16:19], s32 offen offset:2048 sc1 lds
    ds_read_b64_tr_b16 a[12:13], v45 offset:49152
    v_mfma_f32_16x16x32_bf16 v[208:211], a[40:43], a[144:147], v[208:211]
    v_mfma_f32_16x16x32_bf16 v[212:215], a[40:43], a[148:151], v[212:215]
    ds_read_b64_tr_b16 a[14:15], v45 offset:50176
    v_mfma_f32_16x16x32_bf16 a[80:83], a[40:43], a[152:155], a[80:83]
    ds_read_b64_tr_b16 a[16:17], v46 offset:49152
    v_mfma_f32_16x16x32_bf16 a[84:87], a[40:43], a[156:159], a[84:87]
    buffer_load_dwordx4 v1, s[16:19], s32 offen offset:3072 sc1 lds
    ds_read_b64_tr_b16 a[18:19], v46 offset:50176
    v_mfma_f32_16x16x32_bf16 v[216:219], a[44:47], a[144:147], v[216:219]
    v_mfma_f32_16x16x32_bf16 v[220:223], a[44:47], a[148:151], v[220:223]
    s_add_u32 s32, s32, 0x80000
    ds_read_b64_tr_b16 a[20:21], v47 offset:49152
    v_mfma_f32_16x16x32_bf16 a[88:91], a[44:47], a[152:155], a[88:91]
    s_add_u32 s34, s34, 0x4000
    ds_read_b64_tr_b16 a[22:23], v47 offset:50176
    s_mov_b32 m0, s34
    v_mfma_f32_16x16x32_bf16 a[92:95], a[44:47], a[156:159], a[92:95]
    buffer_load_dwordx4 v1, s[16:19], s32 offen offset:0 sc1 lds
    ds_read_b64_tr_b16 a[24:25], v48 offset:49152
    v_mfma_f32_16x16x32_bf16 v[224:227], a[48:51], a[144:147], v[224:227]
    v_mfma_f32_16x16x32_bf16 v[228:231], a[48:51], a[148:151], v[228:231]
    buffer_load_dwordx4 v1, s[16:19], s32 offen offset:1024 sc1 lds
    ds_read_b64_tr_b16 a[26:27], v48 offset:50176
    v_mfma_f32_16x16x32_bf16 a[96:99], a[48:51], a[152:155], a[96:99]
    ds_read_b64_tr_b16 a[28:29], v49 offset:49152
    v_mfma_f32_16x16x32_bf16 a[100:103], a[48:51], a[156:159], a[100:103]
    v_mfma_f32_16x16x32_bf16 v[232:235], a[52:55], a[144:147], v[232:235]
    buffer_load_dwordx4 v1, s[16:19], s32 offen offset:2048 sc1 lds
    ds_read_b64_tr_b16 a[30:31], v49 offset:50176
    v_mfma_f32_16x16x32_bf16 v[236:239], a[52:55], a[148:151], v[236:239]
    v_mfma_f32_16x16x32_bf16 a[104:107], a[52:55], a[152:155], a[104:107]
    v_mfma_f32_16x16x32_bf16 a[108:111], a[52:55], a[156:159], a[108:111]
    v_mfma_f32_16x16x32_bf16 v[240:243], a[56:59], a[144:147], v[240:243]
    buffer_load_dwordx4 v1, s[16:19], s32 offen offset:3072 sc1 lds
    v_mfma_f32_16x16x32_bf16 v[244:247], a[56:59], a[148:151], v[244:247]
    v_mfma_f32_16x16x32_bf16 a[112:115], a[56:59], a[152:155], a[112:115]
    s_add_u32 s32, s32, 0x80000
    v_mfma_f32_16x16x32_bf16 a[116:119], a[56:59], a[156:159], a[116:119]
    s_add_u32 s34, s34, 0x4000
    v_mfma_f32_16x16x32_bf16 v[248:251], a[60:63], a[144:147], v[248:251]
    v_mfma_f32_16x16x32_bf16 v[252:255], a[60:63], a[148:151], v[252:255]
    v_mfma_f32_16x16x32_bf16 a[120:123], a[60:63], a[152:155], a[120:123]
    v_mfma_f32_16x16x32_bf16 a[124:127], a[60:63], a[156:159], a[124:127]
    s_waitcnt vmcnt(14) lgkmcnt(0)
    v_mfma_f32_16x16x32_bf16 v[192:195], a[0:3], a[160:163], v[192:195]
    ds_read_b64_tr_b16 a[32:33], v42 offset:57344
    ds_read_b64_tr_b16 a[34:35], v42 offset:58368
    v_mfma_f32_16x16x32_bf16 v[196:199], a[0:3], a[164:167], v[196:199]
    s_mov_b32 m0, s35
    v_mfma_f32_16x16x32_bf16 a[64:67], a[0:3], a[168:171], a[64:67]
    buffer_load_dwordx4 v1, s[20:23], s33 offen offset:0 sc1 lds
    ds_read_b64_tr_b16 a[36:37], v43 offset:57344
    v_mfma_f32_16x16x32_bf16 a[68:71], a[0:3], a[172:175], a[68:71]
    ds_read_b64_tr_b16 a[38:39], v43 offset:58368
    v_mfma_f32_16x16x32_bf16 v[200:203], a[4:7], a[160:163], v[200:203]
    buffer_load_dwordx4 v1, s[20:23], s33 offen offset:1024 sc1 lds
    ds_read_b64_tr_b16 a[40:41], v44 offset:57344
    v_mfma_f32_16x16x32_bf16 v[204:207], a[4:7], a[164:167], v[204:207]
    v_mfma_f32_16x16x32_bf16 a[72:75], a[4:7], a[168:171], a[72:75]
    ds_read_b64_tr_b16 a[42:43], v44 offset:58368
    v_mfma_f32_16x16x32_bf16 a[76:79], a[4:7], a[172:175], a[76:79]
    buffer_load_dwordx4 v1, s[20:23], s33 offen offset:2048 sc1 lds
    ds_read_b64_tr_b16 a[44:45], v45 offset:57344
    v_mfma_f32_16x16x32_bf16 v[208:211], a[8:11], a[160:163], v[208:211]
    v_mfma_f32_16x16x32_bf16 v[212:215], a[8:11], a[164:167], v[212:215]
    ds_read_b64_tr_b16 a[46:47], v45 offset:58368
    v_mfma_f32_16x16x32_bf16 a[80:83], a[8:11], a[168:171], a[80:83]
    ds_read_b64_tr_b16 a[48:49], v46 offset:57344
    v_mfma_f32_16x16x32_bf16 a[84:87], a[8:11], a[172:175], a[84:87]
    buffer_load_dwordx4 v1, s[20:23], s33 offen offset:3072 sc1 lds
    ds_read_b64_tr_b16 a[50:51], v46 offset:58368
    v_mfma_f32_16x16x32_bf16 v[216:219], a[12:15], a[160:163], v[216:219]
    v_mfma_f32_16x16x32_bf16 v[220:223], a[12:15], a[164:167], v[220:223]
    s_add_u32 s33, s33, 0x80000
    ds_read_b64_tr_b16 a[52:53], v47 offset:57344
    v_mfma_f32_16x16x32_bf16 a[88:91], a[12:15], a[168:171], a[88:91]
    s_add_u32 s35, s35, 0x4000
    ds_read_b64_tr_b16 a[54:55], v47 offset:58368
    s_mov_b32 m0, s34
    v_mfma_f32_16x16x32_bf16 a[92:95], a[12:15], a[172:175], a[92:95]
    buffer_load_dwordx4 v1, s[16:19], s32 offen offset:0 sc1 lds
    ds_read_b64_tr_b16 a[56:57], v48 offset:57344
    v_mfma_f32_16x16x32_bf16 v[224:227], a[16:19], a[160:163], v[224:227]
    v_mfma_f32_16x16x32_bf16 v[228:231], a[16:19], a[164:167], v[228:231]
    buffer_load_dwordx4 v1, s[16:19], s32 offen offset:1024 sc1 lds
    ds_read_b64_tr_b16 a[58:59], v48 offset:58368
    v_mfma_f32_16x16x32_bf16 a[96:99], a[16:19], a[168:171], a[96:99]
    ds_read_b64_tr_b16 a[60:61], v49 offset:57344
    v_mfma_f32_16x16x32_bf16 a[100:103], a[16:19], a[172:175], a[100:103]
    v_mfma_f32_16x16x32_bf16 v[232:235], a[20:23], a[160:163], v[232:235]
    buffer_load_dwordx4 v1, s[16:19], s32 offen offset:2048 sc1 lds
    ds_read_b64_tr_b16 a[62:63], v49 offset:58368
    v_mfma_f32_16x16x32_bf16 v[236:239], a[20:23], a[164:167], v[236:239]
    v_mfma_f32_16x16x32_bf16 a[104:107], a[20:23], a[168:171], a[104:107]
    v_mfma_f32_16x16x32_bf16 a[108:111], a[20:23], a[172:175], a[108:111]
    v_mfma_f32_16x16x32_bf16 v[240:243], a[24:27], a[160:163], v[240:243]
    buffer_load_dwordx4 v1, s[16:19], s32 offen offset:3072 sc1 lds
    v_mfma_f32_16x16x32_bf16 v[244:247], a[24:27], a[164:167], v[244:247]
    v_mfma_f32_16x16x32_bf16 a[112:115], a[24:27], a[168:171], a[112:115]
    s_add_u32 s32, s32, 0x80000
    v_mfma_f32_16x16x32_bf16 a[116:119], a[24:27], a[172:175], a[116:119]
    s_add_u32 s34, s34, 0x4000
    v_mfma_f32_16x16x32_bf16 v[248:251], a[28:31], a[160:163], v[248:251]
    v_mfma_f32_16x16x32_bf16 v[252:255], a[28:31], a[164:167], v[252:255]
    v_mfma_f32_16x16x32_bf16 a[120:123], a[28:31], a[168:171], a[120:123]
    v_mfma_f32_16x16x32_bf16 a[124:127], a[28:31], a[172:175], a[124:127]
    s_waitcnt vmcnt(17) lgkmcnt(0)
    s_barrier
    v_mfma_f32_16x16x32_bf16 v[192:195], a[32:35], a[176:179], v[192:195]
    v_mfma_f32_16x16x32_bf16 v[196:199], a[32:35], a[180:183], v[196:199]
    s_mov_b32 m0, s35
    v_mfma_f32_16x16x32_bf16 a[64:67], a[32:35], a[184:187], a[64:67]
    buffer_load_dwordx4 v1, s[20:23], s33 offen offset:0 sc1 lds
    v_mfma_f32_16x16x32_bf16 a[68:71], a[32:35], a[188:191], a[68:71]
    v_mfma_f32_16x16x32_bf16 v[200:203], a[36:39], a[176:179], v[200:203]
    v_mfma_f32_16x16x32_bf16 v[204:207], a[36:39], a[180:183], v[204:207]
    v_mfma_f32_16x16x32_bf16 a[72:75], a[36:39], a[184:187], a[72:75]
    v_mfma_f32_16x16x32_bf16 a[76:79], a[36:39], a[188:191], a[76:79]
    buffer_load_dwordx4 v1, s[20:23], s33 offen offset:1024 sc1 lds
    v_mfma_f32_16x16x32_bf16 v[208:211], a[40:43], a[176:179], v[208:211]
    v_mfma_f32_16x16x32_bf16 v[212:215], a[40:43], a[180:183], v[212:215]
    v_mfma_f32_16x16x32_bf16 a[80:83], a[40:43], a[184:187], a[80:83]
    v_mfma_f32_16x16x32_bf16 a[84:87], a[40:43], a[188:191], a[84:87]
    v_mfma_f32_16x16x32_bf16 v[216:219], a[44:47], a[176:179], v[216:219]
    v_mfma_f32_16x16x32_bf16 v[220:223], a[44:47], a[180:183], v[220:223]
    v_mfma_f32_16x16x32_bf16 a[88:91], a[44:47], a[184:187], a[88:91]
    buffer_load_dwordx4 v1, s[20:23], s33 offen offset:2048 sc1 lds
    v_mfma_f32_16x16x32_bf16 a[92:95], a[44:47], a[188:191], a[92:95]
    v_mfma_f32_16x16x32_bf16 v[224:227], a[48:51], a[176:179], v[224:227]
    v_mfma_f32_16x16x32_bf16 v[228:231], a[48:51], a[180:183], v[228:231]
    v_mfma_f32_16x16x32_bf16 a[96:99], a[48:51], a[184:187], a[96:99]
    v_mfma_f32_16x16x32_bf16 a[100:103], a[48:51], a[188:191], a[100:103]
    v_mfma_f32_16x16x32_bf16 v[232:235], a[52:55], a[176:179], v[232:235]
    buffer_load_dwordx4 v1, s[20:23], s33 offen offset:3072 sc1 lds
    v_mfma_f32_16x16x32_bf16 v[236:239], a[52:55], a[180:183], v[236:239]
    v_mfma_f32_16x16x32_bf16 a[104:107], a[52:55], a[184:187], a[104:107]
    v_mfma_f32_16x16x32_bf16 a[108:111], a[52:55], a[188:191], a[108:111]
    v_mfma_f32_16x16x32_bf16 v[240:243], a[56:59], a[176:179], v[240:243]
    v_mfma_f32_16x16x32_bf16 v[244:247], a[56:59], a[180:183], v[244:247]
    v_mfma_f32_16x16x32_bf16 a[112:115], a[56:59], a[184:187], a[112:115]
    s_add_u32 s33, s33, 0x80000
    v_mfma_f32_16x16x32_bf16 a[116:119], a[56:59], a[188:191], a[116:119]
    s_add_u32 s35, s35, 0x4000
    v_mfma_f32_16x16x32_bf16 v[248:251], a[60:63], a[176:179], v[248:251]
    v_mfma_f32_16x16x32_bf16 v[252:255], a[60:63], a[180:183], v[252:255]
    v_mfma_f32_16x16x32_bf16 a[120:123], a[60:63], a[184:187], a[120:123]
    v_mfma_f32_16x16x32_bf16 a[124:127], a[60:63], a[188:191], a[124:127]
    s_add_u32 s3, s54, 64
    s_add_u32 s5, s55, 64
    s_mov_b32 s63, s57
    s_load_dwordx2 s[44:45], s[0:1], 40
    s_load_dwordx2 s[46:47], s[0:1], 64
    s_load_dwordx4 s[48:51], s[0:1], 72
    s_mov_b32 s40, 0x3e0293ee
    s_mov_b32 s41, 0x3e0293ee
    s_mov_b32 m0, s34
    s_nop 0
    buffer_load_dwordx4 v1, s[16:19], s32 offen offset:0 sc1 lds
    buffer_load_dwordx4 v1, s[16:19], s32 offen offset:1024 sc1 lds
    buffer_load_dwordx4 v1, s[16:19], s32 offen offset:2048 sc1 lds
    buffer_load_dwordx4 v1, s[16:19], s32 offen offset:3072 sc1 lds
    s_mov_b32 m0, s35
    s_nop 0
    buffer_load_dwordx4 v1, s[20:23], s33 offen offset:0 sc1 lds
    buffer_load_dwordx4 v1, s[20:23], s33 offen offset:1024 sc1 lds
    buffer_load_dwordx4 v1, s[20:23], s33 offen offset:2048 sc1 lds
    buffer_load_dwordx4 v1, s[20:23], s33 offen offset:3072 sc1 lds
    s_add_u32 s32, s32, 0x80000
    s_add_u32 s33, s33, 0x80000
    s_add_u32 s34, s34, 0x4000
    s_and_b32 s34, s34, 0xffff
    s_add_u32 s35, s35, 0x4000
    s_and_b32 s35, s35, 0xffff
    s_or_b32 s35, s35, 0x10000
    v_mov_b32 v2, v1
    v_or_b32 v3, 0x10000, v1
    v_mov_b32 v56, v3
    s_mov_b32 s52, 0x4000
    s_mov_b32 s53, 0
    s_mul_i32 s62, s28, 63
    s_mul_i32 s31, s29, s29
    s_add_u32 s62, s62, s31
    s_sub_u32 s62, s62, 1
    s_cmp_eq_u32 s30, 0
    s_cselect_b32 s14, 0x800000, 0x0
    s_max_u32 s14, s14, 0x700000
    s_sub_u32 s31, s30, 1
    s_lshl_b32 s4, s31, 23
    s_add_u32 s4, s4, 0x6000000
    s_add_u32 s8, s6, s4
    s_addc_u32 s9, s7, 0
    s_and_b32 s9, s9, 0xffff
    s_mov_b32 s10, 0
    s_mov_b32 s58, 0
    s_mov_b32 s54, 4096
    s_mov_b32 s55, 0x20000
    s_mov_b32 s56, 1024
    s_cmp_lt_u32 s31, 2
    s_cselect_b32 s54, 229376, s54
    s_cselect_b32 s55, 128, s55
    s_cselect_b32 s56, 57344, s56
    s_cselect_b32 s59, 0x700000, 0
    s_cmp_eq_u32 s29, 0
    s_cselect_b32 s14, 0, s14
    s_cselect_b32 s59, 0, s59
    s_cselect_b32 s62, 0, s62
    s_waitcnt vmcnt(16) lgkmcnt(0)
    s_barrier
    s_cmp_eq_u32 s63, 0
    s_cbranch_scc1 k12_ool_68
k12_oolret_69:
    v_mov_b32 v59, 0
    ds_read_b128 a[128:131], v2 offset:0
    ds_read_b128 a[132:135], v2 offset:1024
    ds_read_b128 a[136:139], v2 offset:2048
    ds_read_b128 a[140:143], v2 offset:3072
    ds_read_b128 a[144:147], v2 offset:4096
    ds_read_b128 a[148:151], v2 offset:5120
    ds_read_b128 a[152:155], v2 offset:6144
    ds_read_b128 a[156:159], v2 offset:7168
    ds_read_b128 a[160:163], v2 offset:8192
    ds_read_b128 a[164:167], v2 offset:9216
    ds_read_b128 a[168:171], v2 offset:10240
    ds_read_b128 a[172:175], v2 offset:11264
    ds_read_b128 a[176:179], v2 offset:12288
    ds_read_b128 a[180:183], v2 offset:13312
    ds_read_b128 a[184:187], v2 offset:14336
    ds_read_b128 a[188:191], v2 offset:15360
    s_cmp_eq_u32 s30, 1
    s_cselect_b64 s[12:13], s[46:47], s[44:45]
    s_cmp_eq_u32 s30, 2
    s_cselect_b64 s[12:13], s[48:49], s[12:13]
    s_cmp_eq_u32 s30, 3
    s_cselect_b64 s[12:13], s[50:51], s[12:13]
    s_and_b32 s13, s13, 0xffff
    v_accvgpr_read_b32 v128, a64
    v_accvgpr_read_b32 v129, a65
    v_accvgpr_read_b32 v130, a66
    v_accvgpr_read_b32 v131, a67
    v_pk_mul_f32 v[128:129], v[128:129], s[40:41]
    v_pk_mul_f32 v[130:131], v[130:131], s[40:41]
    v_cvt_pk_bf16_f32 v96, v128, v129
    v_cvt_pk_bf16_f32 v97, v130, v131
    v_accvgpr_read_b32 v132, a72
    v_accvgpr_read_b32 v133, a73
    v_accvgpr_read_b32 v134, a74
    v_accvgpr_read_b32 v135, a75
    v_pk_mul_f32 v[132:133], v[132:133], s[40:41]
    v_pk_mul_f32 v[134:135], v[134:135], s[40:41]
    v_cvt_pk_bf16_f32 v98, v132, v133
    v_cvt_pk_bf16_f32 v99, v134, v135
    v_accvgpr_read_b32 v136, a80
    v_accvgpr_read_b32 v137, a81
    v_accvgpr_read_b32 v138, a82
    v_accvgpr_read_b32 v139, a83
    v_pk_mul_f32 v[136:137], v[136:137], s[40:41]
    v_pk_mul_f32 v[138:139], v[138:139], s[40:41]
    v_cvt_pk_bf16_f32 v100, v136, v137
    v_cvt_pk_bf16_f32 v101, v138, v139
    v_accvgpr_read_b32 v140, a88
    v_accvgpr_read_b32 v141, a89
    v_accvgpr_read_b32 v142, a90
    v_accvgpr_read_b32 v143, a91
    v_pk_mul_f32 v[140:141], v[140:141], s[40:41]
    v_pk_mul_f32 v[142:143], v[142:143], s[40:41]
    v_cvt_pk_bf16_f32 v102, v140, v141
    v_cvt_pk_bf16_f32 v103, v142, v143
    v_accvgpr_read_b32 v128, a96
    v_accvgpr_read_b32 v129, a97
    v_accvgpr_read_b32 v130, a98
    v_accvgpr_read_b32 v131, a99
    v_pk_mul_f32 v[128:129], v[128:129], s[40:41]
    v_pk_mul_f32 v[130:131], v[130:131], s[40:41]
    v_cvt_pk_bf16_f32 v104, v128, v129
    v_cvt_pk_bf16_f32 v105, v130, v131
    v_accvgpr_read_b32 v132, a104
    v_accvgpr_read_b32 v133, a105
    v_accvgpr_read_b32 v134, a106
    v_accvgpr_read_b32 v135, a107
    v_pk_mul_f32 v[132:133], v[132:133], s[40:41]
    v_pk_mul_f32 v[134:135], v[134:135], s[40:41]
    v_cvt_pk_bf16_f32 v106, v132, v133
    v_cvt_pk_bf16_f32 v107, v134, v135
    v_accvgpr_read_b32 v136, a112
    v_accvgpr_read_b32 v137, a113
    v_accvgpr_read_b32 v138, a114
    v_accvgpr_read_b32 v139, a115
    v_pk_mul_f32 v[136:137], v[136:137], s[40:41]
    v_pk_mul_f32 v[138:139], v[138:139], s[40:41]
    v_cvt_pk_bf16_f32 v108, v136, v137
    v_cvt_pk_bf16_f32 v109, v138, v139
    v_accvgpr_read_b32 v140, a120
    v_accvgpr_read_b32 v141, a121
    v_accvgpr_read_b32 v142, a122
    v_accvgpr_read_b32 v143, a123
    v_pk_mul_f32 v[140:141], v[140:141], s[40:41]
    v_pk_mul_f32 v[142:143], v[142:143], s[40:41]
    v_cvt_pk_bf16_f32 v110, v140, v141
    v_cvt_pk_bf16_f32 v111, v142, v143
    v_accvgpr_read_b32 v128, a68
    v_accvgpr_read_b32 v129, a69
    v_accvgpr_read_b32 v130, a70
    v_accvgpr_read_b32 v131, a71
    v_pk_mul_f32 v[128:129], v[128:129], s[40:41]
    v_pk_mul_f32 v[130:131], v[130:131], s[40:41]
    v_cvt_pk_bf16_f32 v112, v128, v129
    v_cvt_pk_bf16_f32 v113, v130, v131
    v_accvgpr_read_b32 v132, a76
    v_accvgpr_read_b32 v133, a77
    v_accvgpr_read_b32 v134, a78
    v_accvgpr_read_b32 v135, a79
    v_pk_mul_f32 v[132:133], v[132:133], s[40:41]
    v_pk_mul_f32 v[134:135], v[134:135], s[40:41]
    v_cvt_pk_bf16_f32 v114, v132, v133
    v_cvt_pk_bf16_f32 v115, v134, v135
    v_accvgpr_read_b32 v136, a84
    v_accvgpr_read_b32 v137, a85
    v_accvgpr_read_b32 v138, a86
    v_accvgpr_read_b32 v139, a87
    v_pk_mul_f32 v[136:137], v[136:137], s[40:41]
    v_pk_mul_f32 v[138:139], v[138:139], s[40:41]
    v_cvt_pk_bf16_f32 v116, v136, v137
    v_cvt_pk_bf16_f32 v117, v138, v139
    v_accvgpr_read_b32 v140, a92
    v_accvgpr_read_b32 v141, a93
    v_accvgpr_read_b32 v142, a94
    v_accvgpr_read_b32 v143, a95
    v_pk_mul_f32 v[140:141], v[140:141], s[40:41]
    v_pk_mul_f32 v[142:143], v[142:143], s[40:41]
    v_cvt_pk_bf16_f32 v118, v140, v141
    v_cvt_pk_bf16_f32 v119, v142, v143
    v_accvgpr_read_b32 v128, a100
    v_accvgpr_read_b32 v129, a101
    v_accvgpr_read_b32 v130, a102
    v_accvgpr_read_b32 v131, a103
    v_pk_mul_f32 v[128:129], v[128:129], s[40:41]
    v_pk_mul_f32 v[130:131], v[130:131], s[40:41]
    v_cvt_pk_bf16_f32 v120, v128, v129
    v_cvt_pk_bf16_f32 v121, v130, v131
    v_accvgpr_read_b32 v132, a108
    v_accvgpr_read_b32 v133, a109
    v_accvgpr_read_b32 v134, a110
    v_accvgpr_read_b32 v135, a111
    v_pk_mul_f32 v[132:133], v[132:133], s[40:41]
    v_pk_mul_f32 v[134:135], v[134:135], s[40:41]
    v_cvt_pk_bf16_f32 v122, v132, v133
    v_cvt_pk_bf16_f32 v123, v134, v135
    v_accvgpr_read_b32 v136, a116
    v_accvgpr_read_b32 v137, a117
    v_accvgpr_read_b32 v138, a118
    v_accvgpr_read_b32 v139, a119
    v_pk_mul_f32 v[136:137], v[136:137], s[40:41]
    v_pk_mul_f32 v[138:139], v[138:139], s[40:41]
    v_cvt_pk_bf16_f32 v124, v136, v137
    v_cvt_pk_bf16_f32 v125, v138, v139
    v_accvgpr_read_b32 v140, a124
    v_accvgpr_read_b32 v141, a125
    v_accvgpr_read_b32 v142, a126
    v_accvgpr_read_b32 v143, a127
    v_pk_mul_f32 v[140:141], v[140:141], s[40:41]
    v_pk_mul_f32 v[142:143], v[142:143], s[40:41]
    v_cvt_pk_bf16_f32 v126, v140, v141
    v_cvt_pk_bf16_f32 v127, v142, v143
    v_pk_mul_f32 v[192:193], v[192:193], s[40:41]
    v_pk_mul_f32 v[194:195], v[194:195], s[40:41]
    v_cvt_pk_bf16_f32 v64, v192, v193
    v_cvt_pk_bf16_f32 v65, v194, v195
    v_pk_mul_f32 v[200:201], v[200:201], s[40:41]
    v_pk_mul_f32 v[202:203], v[202:203], s[40:41]
    v_cvt_pk_bf16_f32 v66, v200, v201
    v_cvt_pk_bf16_f32 v67, v202, v203
    v_pk_mul_f32 v[208:209], v[208:209], s[40:41]
    v_pk_mul_f32 v[210:211], v[210:211], s[40:41]
    v_cvt_pk_bf16_f32 v68, v208, v209
    v_cvt_pk_bf16_f32 v69, v210, v211
    v_pk_mul_f32 v[216:217], v[216:217], s[40:41]
    v_pk_mul_f32 v[218:219], v[218:219], s[40:41]
    v_cvt_pk_bf16_f32 v70, v216, v217
    v_cvt_pk_bf16_f32 v71, v218, v219
    v_pk_mul_f32 v[224:225], v[224:225], s[40:41]
    v_pk_mul_f32 v[226:227], v[226:227], s[40:41]
    v_cvt_pk_bf16_f32 v72, v224, v225
    v_cvt_pk_bf16_f32 v73, v226, v227
    v_pk_mul_f32 v[232:233], v[232:233], s[40:41]
    v_pk_mul_f32 v[234:235], v[234:235], s[40:41]
    v_cvt_pk_bf16_f32 v74, v232, v233
    v_cvt_pk_bf16_f32 v75, v234, v235
    v_pk_mul_f32 v[240:241], v[240:241], s[40:41]
    v_pk_mul_f32 v[242:243], v[242:243], s[40:41]
    v_cvt_pk_bf16_f32 v76, v240, v241
    v_cvt_pk_bf16_f32 v77, v242, v243
    v_pk_mul_f32 v[248:249], v[248:249], s[40:41]
    v_pk_mul_f32 v[250:251], v[250:251], s[40:41]
    v_cvt_pk_bf16_f32 v78, v248, v249
    v_cvt_pk_bf16_f32 v79, v250, v251
    v_pk_mul_f32 v[196:197], v[196:197], s[40:41]
    v_pk_mul_f32 v[198:199], v[198:199], s[40:41]
    v_cvt_pk_bf16_f32 v80, v196, v197
    v_cvt_pk_bf16_f32 v81, v198, v199
    v_pk_mul_f32 v[204:205], v[204:205], s[40:41]
    v_pk_mul_f32 v[206:207], v[206:207], s[40:41]
    v_cvt_pk_bf16_f32 v82, v204, v205
    v_cvt_pk_bf16_f32 v83, v206, v207
    v_pk_mul_f32 v[212:213], v[212:213], s[40:41]
    v_pk_mul_f32 v[214:215], v[214:215], s[40:41]
    v_cvt_pk_bf16_f32 v84, v212, v213
    v_cvt_pk_bf16_f32 v85, v214, v215
    v_pk_mul_f32 v[220:221], v[220:221], s[40:41]
    v_pk_mul_f32 v[222:223], v[222:223], s[40:41]
    v_cvt_pk_bf16_f32 v86, v220, v221
    v_cvt_pk_bf16_f32 v87, v222, v223
    v_pk_mul_f32 v[228:229], v[228:229], s[40:41]
    v_pk_mul_f32 v[230:231], v[230:231], s[40:41]
    v_cvt_pk_bf16_f32 v88, v228, v229
    v_cvt_pk_bf16_f32 v89, v230, v231
    v_pk_mul_f32 v[236:237], v[236:237], s[40:41]
    v_pk_mul_f32 v[238:239], v[238:239], s[40:41]
    v_cvt_pk_bf16_f32 v90, v236, v237
    v_cvt_pk_bf16_f32 v91, v238, v239
    v_pk_mul_f32 v[244:245], v[244:245], s[40:41]
    v_pk_mul_f32 v[246:247], v[246:247], s[40:41]
    v_cvt_pk_bf16_f32 v92, v244, v245
    v_cvt_pk_bf16_f32 v93, v246, v247
    v_pk_mul_f32 v[252:253], v[252:253], s[40:41]
    v_pk_mul_f32 v[254:255], v[254:255], s[40:41]
    v_cvt_pk_bf16_f32 v94, v252, v253
    v_cvt_pk_bf16_f32 v95, v254, v255
    v_add_u32 v2, 0x4000, v1
    v_mov_b32 v8, 0
    v_mov_b32 v232, 0
    v_mov_b32 v9, 0
    v_mov_b32 v233, 0
    v_mov_b32 v10, 0
    v_mov_b32 v234, 0
    v_mov_b32 v11, 0
    v_mov_b32 v235, 0
    s_mov_b32 s36, 0
    s_mov_b32 s37, 0x40004000
    v_mfma_f32_32x32x16_bf16 v[16:31], v[232:235], v[232:235], 0
    v_mfma_f32_32x32x16_bf16 v[32:47], v[232:235], v[232:235], 0
    v_and_b32 v6, 0xf0, v1
    v_cmp_eq_u32 vcc, 0, v6
    v_mov_b32 v6, 0x3f803f80
    v_lshrrev_b32 v229, 7, v1
    s_lshr_b32 s4, s56, 3
    v_mul_u32_u24 v228, s4, v229
    v_and_b32 v7, 0x70, v1
    v_add_u32 v228, v228, v7
    v_lshlrev_b32 v229, 5, v229
    v_and_b32 v57, 0x10, v1
    v_add_u32 v229, v229, v57
    v_lshrrev_b32 v7, 5, v7
    v_lshl_add_u32 v229, v7, 15, v229
    v_cndmask_b32 v60, 0, v6, vcc
    v_cndmask_b32 v61, 0, v6, vcc
    v_cndmask_b32 v62, 0, v6, vcc
    v_cndmask_b32 v63, 0, v6, vcc
    v_mov_b32 v12, 0
    v_mov_b32 v13, 0
    v_mov_b32 v14, 0
    v_mov_b32 v15, 0
    v_mov_b32 v48, 0
    v_mov_b32 v49, 0
    v_mov_b32 v50, 0
    v_mov_b32 v51, 0
    v_mov_b32 v248, 0
    v_mov_b32 v249, 0
    v_mov_b32 v250, 0
    v_mov_b32 v251, 0
    v_mov_b32 v252, 0
    v_mov_b32 v253, 0
    v_mov_b32 v254, 0
    v_mov_b32 v255, 0
    s_waitcnt lgkmcnt(0)
    s_cmp_ge_u32 s36, s42
    s_cbranch_scc1 k2_prep_70
k2_prepret_71:
    v_mfma_f32_16x16x32_bf16 v[128:131], a[128:131], v[64:67], v[16:19]
    v_mfma_f32_16x16x32_bf16 v[132:135], a[128:131], v[80:83], v[20:23]
    v_mfma_f32_16x16x32_bf16 v[136:139], a[128:131], v[96:99], v[24:27]
    v_mfma_f32_16x16x32_bf16 v[140:143], a[128:131], v[112:115], v[28:31]
    s_add_u32 s36, s36, 32
    v_mfma_f32_16x16x32_bf16 v[128:131], a[132:135], v[68:71], v[128:131]
    v_mfma_f32_16x16x32_bf16 v[132:135], a[132:135], v[84:87], v[132:135]
    v_mfma_f32_16x16x32_bf16 v[136:139], a[132:135], v[100:103], v[136:139]
    v_mfma_f32_16x16x32_bf16 v[140:143], a[132:135], v[116:119], v[140:143]
    v_mfma_f32_16x16x32_bf16 v[128:131], a[136:139], v[72:75], v[128:131]
    v_mfma_f32_16x16x32_bf16 v[132:135], a[136:139], v[88:91], v[132:135]
    v_mfma_f32_16x16x32_bf16 v[136:139], a[136:139], v[104:107], v[136:139]
    v_mfma_f32_16x16x32_bf16 v[140:143], a[136:139], v[120:123], v[140:143]
    v_mfma_f32_16x16x32_bf16 v[128:131], a[140:143], v[76:79], v[128:131]
    v_mfma_f32_16x16x32_bf16 v[132:135], a[140:143], v[92:95], v[132:135]
    v_mfma_f32_16x16x32_bf16 v[136:139], a[140:143], v[108:111], v[136:139]
    v_mfma_f32_16x16x32_bf16 v[140:143], a[140:143], v[124:127], v[140:143]
    v_mfma_f32_16x16x32_bf16 v[144:147], a[144:147], v[64:67], v[32:35]
    v_mfma_f32_16x16x32_bf16 v[148:151], a[144:147], v[80:83], v[36:39]
    v_mfma_f32_16x16x32_bf16 v[152:155], a[144:147], v[96:99], v[40:43]
    v_mfma_f32_16x16x32_bf16 v[156:159], a[144:147], v[112:115], v[44:47]
    v_mfma_f32_16x16x32_bf16 v[144:147], a[148:151], v[68:71], v[144:147]
    v_mfma_f32_16x16x32_bf16 v[148:151], a[148:151], v[84:87], v[148:151]
    v_mfma_f32_16x16x32_bf16 v[152:155], a[148:151], v[100:103], v[152:155]
    v_mfma_f32_16x16x32_bf16 v[156:159], a[148:151], v[116:119], v[156:159]
    v_mfma_f32_16x16x32_bf16 v[144:147], a[152:155], v[72:75], v[144:147]
    v_mfma_f32_16x16x32_bf16 v[148:151], a[152:155], v[88:91], v[148:151]
    v_mfma_f32_16x16x32_bf16 v[152:155], a[152:155], v[104:107], v[152:155]
    v_mfma_f32_16x16x32_bf16 v[156:159], a[152:155], v[120:123], v[156:159]
    v_mfma_f32_16x16x32_bf16 v[144:147], a[156:159], v[76:79], v[144:147]
    v_mfma_f32_16x16x32_bf16 v[148:151], a[156:159], v[92:95], v[148:151]
    v_mfma_f32_16x16x32_bf16 v[152:155], a[156:159], v[108:111], v[152:155]
    v_mfma_f32_16x16x32_bf16 v[156:159], a[156:159], v[124:127], v[156:159]
    v_mfma_f32_32x32x16_bf16 a[0:15], v[232:235], v[232:235], 0
    v_mfma_f32_32x32x16_bf16 a[16:31], v[232:235], v[232:235], 0
    v_mfma_f32_32x32x16_bf16 a[32:47], v[232:235], v[232:235], 0
    v_mfma_f32_32x32x16_bf16 a[48:63], v[232:235], v[232:235], 0
    v_mfma_f32_32x32x16_bf16 a[64:79], v[232:235], v[232:235], 0
    v_mfma_f32_32x32x16_bf16 a[80:95], v[232:235], v[232:235], 0
    v_mfma_f32_32x32x16_bf16 a[96:111], v[232:235], v[232:235], 0
    v_mfma_f32_32x32x16_bf16 a[112:127], v[232:235], v[232:235], 0
    v_max_f32 v52, v128, v129
    v_max3_f32 v52, v52, v130, v131
    v_max3_f32 v52, v52, v144, v145
    v_max3_f32 v52, v52, v146, v147
    v_max_f32 v53, v132, v133
    v_max3_f32 v53, v53, v134, v135
    v_max3_f32 v53, v53, v148, v149
    v_max3_f32 v53, v53, v150, v151
    v_max_f32 v54, v136, v137
    v_max3_f32 v54, v54, v138, v139
    v_max3_f32 v54, v54, v152, v153
    v_max3_f32 v54, v54, v154, v155
    v_max_f32 v55, v140, v141
    v_max3_f32 v55, v55, v142, v143
    v_max3_f32 v55, v55, v156, v157
    v_max3_f32 v55, v55, v158, v159
    v_mov_b32 v224, v52
    v_mov_b32 v225, v53
    v_mov_b32 v226, v54
    v_mov_b32 v227, v55
    s_nop 1
    v_permlane16_swap_b32 v52, v224
    v_permlane16_swap_b32 v53, v225
    v_permlane16_swap_b32 v54, v226
    v_permlane16_swap_b32 v55, v227
    s_nop 1
    v_max_f32 v52, v52, v224
    v_max_f32 v53, v53, v225
    v_max_f32 v54, v54, v226
    v_max_f32 v55, v55, v227
    v_mov_b32 v224, v52
    v_mov_b32 v225, v53
    v_mov_b32 v226, v54
    v_mov_b32 v227, v55
    s_nop 1
    v_permlane32_swap_b32 v52, v224
    v_permlane32_swap_b32 v53, v225
    v_permlane32_swap_b32 v54, v226
    v_permlane32_swap_b32 v55, v227
    s_nop 1
    v_max_f32 v52, v52, v224
    v_max_f32 v53, v53, v225
    v_max_f32 v54, v54, v226
    v_max_f32 v55, v55, v227
    v_add_f32 v52, 0x41400000, v52
    v_add_f32 v53, 0x41400000, v53
    v_add_f32 v54, 0x41400000, v54
    v_add_f32 v55, 0x41400000, v55
    v_sub_f32 v16, 0, v52
    v_sub_f32 v17, 0, v52
    v_sub_f32 v18, 0, v52
    v_sub_f32 v19, 0, v52
    v_sub_f32 v20, 0, v53
    v_sub_f32 v21, 0, v53
    v_sub_f32 v22, 0, v53
    v_sub_f32 v23, 0, v53
    v_sub_f32 v24, 0, v54
    v_sub_f32 v25, 0, v54
    v_sub_f32 v26, 0, v54
    v_sub_f32 v27, 0, v54
    v_sub_f32 v28, 0, v55
    v_sub_f32 v29, 0, v55
    v_sub_f32 v30, 0, v55
    v_sub_f32 v31, 0, v55
    v_sub_f32 v32, 0, v52
    v_sub_f32 v33, 0, v52
    v_sub_f32 v34, 0, v52
    v_sub_f32 v35, 0, v52
    v_sub_f32 v36, 0, v53
    v_sub_f32 v37, 0, v53
    v_sub_f32 v38, 0, v53
    v_sub_f32 v39, 0, v53
    v_sub_f32 v40, 0, v54
    v_sub_f32 v41, 0, v54
    v_sub_f32 v42, 0, v54
    v_sub_f32 v43, 0, v54
    v_sub_f32 v44, 0, v55
    v_sub_f32 v45, 0, v55
    v_sub_f32 v46, 0, v55
    v_sub_f32 v47, 0, v55
    v_sub_f32 v8, 0, v52
    v_sub_f32 v9, 0, v53
    v_sub_f32 v10, 0, v54
    v_sub_f32 v11, 0, v55
    s_cmp_ge_u32 s36, s42
    s_cbranch_scc1 k2_prep_78
k2_prepret_79:
    v_mfma_f32_16x16x32_bf16 v[160:163], a[160:163], v[64:67], v[16:19]
    v_sub_f32 v128, v128, v52
    v_sub_f32 v129, v129, v52
    v_sub_f32 v130, v130, v52
    v_mfma_f32_16x16x32_bf16 v[164:167], a[160:163], v[80:83], v[20:23]
    v_exp_f32 v232, v128
    v_sub_f32 v131, v131, v52
    v_mfma_f32_16x16x32_bf16 v[168:171], a[160:163], v[96:99], v[24:27]
    v_exp_f32 v233, v129
    v_sub_f32 v144, v144, v52
    v_mfma_f32_16x16x32_bf16 v[172:175], a[160:163], v[112:115], v[28:31]
    s_add_u32 s36, s36, 32
    s_cmp_eq_u32 s30, 0
    s_cbranch_scc1 k12_ool_72
k12_oolret_73:
    v_sub_f32 v145, v145, v52
    v_mfma_f32_16x16x32_bf16 v[160:163], a[164:167], v[68:71], v[160:163]
    v_exp_f32 v234, v130
    v_cvt_pk_bf16_f32 v192, v232, v233
    v_mfma_f32_16x16x32_bf16 v[164:167], a[164:167], v[84:87], v[164:167]
    v_exp_f32 v235, v131
    v_sub_f32 v146, v146, v52
    v_mfma_f32_16x16x32_bf16 v[168:171], a[164:167], v[100:103], v[168:171]
    v_exp_f32 v236, v144
    v_sub_f32 v147, v147, v52
    v_mfma_f32_16x16x32_bf16 v[172:175], a[164:167], v[116:119], v[172:175]
    v_cvt_pk_bf16_f32 v193, v234, v235
    v_exp_f32 v237, v145
    v_mfma_f32_16x16x32_bf16 v[160:163], a[168:171], v[72:75], v[160:163]
    v_exp_f32 v238, v146
    v_sub_f32 v132, v132, v53
    v_mfma_f32_16x16x32_bf16 v[164:167], a[168:171], v[88:91], v[164:167]
    v_sub_f32 v133, v133, v53
    v_cvt_pk_bf16_f32 v194, v236, v237
    v_or3_b32 v57, v192, v193, v194
    v_mfma_f32_16x16x32_bf16 v[168:171], a[168:171], v[104:107], v[168:171]
    v_exp_f32 v239, v147
    v_sub_f32 v134, v134, v53
    v_mfma_f32_16x16x32_bf16 v[172:175], a[168:171], v[120:123], v[172:175]
    v_exp_f32 v240, v132
    v_sub_f32 v135, v135, v53
    v_mfma_f32_16x16x32_bf16 v[160:163], a[172:175], v[76:79], v[160:163]
    v_cvt_pk_bf16_f32 v195, v238, v239
    v_exp_f32 v241, v133
    v_mfma_f32_16x16x32_bf16 v[164:167], a[172:175], v[92:95], v[164:167]
    v_exp_f32 v242, v134
    v_sub_f32 v148, v148, v53
    v_mfma_f32_16x16x32_bf16 v[168:171], a[172:175], v[108:111], v[168:171]
    v_sub_f32 v149, v149, v53
    v_cvt_pk_bf16_f32 v196, v240, v241
    v_exp_f32 v243, v135
    v_mfma_f32_16x16x32_bf16 v[172:175], a[172:175], v[124:127], v[172:175]
    v_or3_b32 v57, v57, v195, v196
    v_exp_f32 v244, v148
    v_mfma_f32_16x16x32_bf16 v[176:179], a[176:179], v[64:67], v[32:35]
    v_sub_f32 v150, v150, v53
    v_sub_f32 v151, v151, v53
    v_cvt_pk_bf16_f32 v197, v242, v243
    v_mfma_f32_16x16x32_bf16 v[180:183], a[176:179], v[80:83], v[36:39]
    v_exp_f32 v245, v149
    v_exp_f32 v246, v150
    v_mfma_f32_16x16x32_bf16 v[184:187], a[176:179], v[96:99], v[40:43]
    v_sub_f32 v136, v136, v54
    v_sub_f32 v137, v137, v54
    v_cvt_pk_bf16_f32 v198, v244, v245
    v_mfma_f32_16x16x32_bf16 v[188:191], a[176:179], v[112:115], v[44:47]
    v_exp_f32 v247, v151
    v_or3_b32 v57, v57, v197, v198
    v_mfma_f32_16x16x32_bf16 v[176:179], a[180:183], v[68:71], v[176:179]
    v_exp_f32 v232, v136
    v_sub_f32 v138, v138, v54
    v_mfma_f32_16x16x32_bf16 v[180:183], a[180:183], v[84:87], v[180:183]
    ds_read_b128 a[192:195], v3 offset:0
    v_sub_f32 v139, v139, v54
    v_cvt_pk_bf16_f32 v199, v246, v247
    v_mfma_f32_16x16x32_bf16 v[184:187], a[180:183], v[100:103], v[184:187]
    v_exp_f32 v233, v137
    v_exp_f32 v234, v138
    v_mfma_f32_16x16x32_bf16 v[188:191], a[180:183], v[116:119], v[188:191]
    v_sub_f32 v152, v152, v54
    v_sub_f32 v153, v153, v54
    v_cvt_pk_bf16_f32 v200, v232, v233
    v_mfma_f32_16x16x32_bf16 v[176:179], a[184:187], v[72:75], v[176:179]
    v_exp_f32 v235, v139
    v_or3_b32 v57, v57, v199, v200
    v_mfma_f32_16x16x32_bf16 v[180:183], a[184:187], v[88:91], v[180:183]
    v_exp_f32 v236, v152
    v_sub_f32 v154, v154, v54
    v_mfma_f32_16x16x32_bf16 v[184:187], a[184:187], v[104:107], v[184:187]
    v_sub_f32 v155, v155, v54
    v_cvt_pk_bf16_f32 v201, v234, v235
    v_exp_f32 v237, v153
    v_mfma_f32_16x16x32_bf16 v[188:191], a[184:187], v[120:123], v[188:191]
    ds_read_b128 a[196:199], v3 offset:1024
    v_exp_f32 v238, v154
    v_mfma_f32_16x16x32_bf16 v[176:179], a[188:191], v[76:79], v[176:179]
    v_sub_f32 v140, v140, v55
    v_sub_f32 v141, v141, v55
    v_cvt_pk_bf16_f32 v202, v236, v237
    v_mfma_f32_16x16x32_bf16 v[180:183], a[188:191], v[92:95], v[180:183]
    v_exp_f32 v239, v155
    v_or3_b32 v57, v57, v201, v202
    v_mfma_f32_16x16x32_bf16 v[184:187], a[188:191], v[108:111], v[184:187]
    s_cmp_eq_u32 s30, 0
    s_cbranch_scc1 k12_ool_76
k12_oolret_77:
    v_exp_f32 v240, v140
    v_mfma_f32_16x16x32_bf16 v[188:191], a[188:191], v[124:127], v[188:191]
    s_waitcnt vmcnt(8)
    s_barrier
    v_sub_f32 v142, v142, v55
    v_sub_f32 v143, v143, v55
    v_cvt_pk_bf16_f32 v203, v238, v239
    v_exp_f32 v241, v141
    ds_read_b128 a[200:203], v3 offset:2048
    v_exp_f32 v242, v142
    v_sub_f32 v156, v156, v55
    v_sub_f32 v157, v157, v55
    v_cvt_pk_bf16_f32 v204, v240, v241
    v_exp_f32 v243, v143
    v_or3_b32 v57, v57, v203, v204
    v_exp_f32 v244, v156
    v_sub_f32 v158, v158, v55
    v_sub_f32 v159, v159, v55
    v_cvt_pk_bf16_f32 v205, v242, v243
    v_exp_f32 v245, v157
    ds_read_b128 a[204:207], v3 offset:3072
    v_exp_f32 v246, v158
    v_cvt_pk_bf16_f32 v206, v244, v245
    v_exp_f32 v247, v159
    v_or3_b32 v57, v57, v205, v206
    v_cvt_pk_bf16_f32 v207, v246, v247
    v_bitop3_b32 v57, v57, v207, s37 bitop3:0xa8
    v_cmp_ne_u32 vcc, 0, v57
    s_cbranch_vccnz k2_rare_80
k2_ret_81:
    s_add_u32 s24, s6, 0x3000000
    s_addc_u32 s25, s7, 0
    s_and_b32 s25, s25, 0xffff
    s_mov_b32 s26, 0x1000000
    s_mov_b32 s27, 0x00020000
    s_lshl_b32 s63, s29, 1
    s_add_u32 s63, s63, 1
k2_dloop_82:
    v_mfma_f32_16x16x32_bf16 v[12:15], v[60:63], v[192:195], v[12:15]
    ds_read_b128 a[208:211], v3 offset:4096
    v_mfma_f32_16x16x32_bf16 v[48:51], v[60:63], v[196:199], v[48:51]
    s_mov_b32 m0, s34
    v_exp_f32 v232, v160
    v_mfma_f32_16x16x32_bf16 v[248:251], v[60:63], v[200:203], v[248:251]
    s_add_u32 s53, s53, 8192
    buffer_load_dwordx4 v1, s[16:19], s32 offen offset:0 sc1 lds
    v_mfma_f32_16x16x32_bf16 v[252:255], v[60:63], v[204:207], v[252:255]
    s_waitcnt lgkmcnt(3)
    v_exp_f32 v233, v161
    v_mfma_f32_16x16x32_bf16 a[0:3], a[192:195], v[192:195], a[0:3]
    s_and_b32 s53, s53, 0xffff
    ds_read_b128 a[212:215], v3 offset:5120
    v_cvt_pk_bf16_f32 v208, v232, v233
    v_mfma_f32_16x16x32_bf16 a[4:7], a[192:195], v[196:199], a[4:7]
    s_add_u32 s34, s34, 0x4000
    v_exp_f32 v234, v162
    v_mfma_f32_16x16x32_bf16 a[8:11], a[192:195], v[200:203], a[8:11]
    v_exp_f32 v235, v163
    v_mfma_f32_16x16x32_bf16 a[12:15], a[192:195], v[204:207], a[12:15]
    buffer_load_dwordx4 v1, s[16:19], s32 offen offset:1024 sc1 lds
    ds_read_b128 a[216:219], v3 offset:6144
    v_mfma_f32_16x16x32_bf16 a[16:19], a[196:199], v[192:195], a[16:19]
    v_exp_f32 v236, v176
    v_mfma_f32_16x16x32_bf16 a[20:23], a[196:199], v[196:199], a[20:23]
    v_cvt_pk_bf16_f32 v209, v234, v235
    v_mfma_f32_16x16x32_bf16 a[24:27], a[196:199], v[200:203], a[24:27]
    v_exp_f32 v237, v177
    v_mfma_f32_16x16x32_bf16 a[28:31], a[196:199], v[204:207], a[28:31]
    s_waitcnt lgkmcnt(3)
    ds_read_b128 a[220:223], v3 offset:7168
    v_cvt_pk_bf16_f32 v210, v236, v237
    v_mfma_f32_16x16x32_bf16 a[32:35], a[200:203], v[192:195], a[32:35]
    s_and_b32 s34, s34, 0xffff
    v_exp_f32 v238, v178
    v_mfma_f32_16x16x32_bf16 a[36:39], a[200:203], v[196:199], a[36:39]
    buffer_load_dwordx4 v1, s[16:19], s32 offen offset:2048 sc1 lds
    v_mfma_f32_16x16x32_bf16 a[40:43], a[200:203], v[200:203], a[40:43]
    v_exp_f32 v239, v179
    v_mfma_f32_16x16x32_bf16 a[44:47], a[200:203], v[204:207], a[44:47]
    v_or3_b32 v57, v208, v209, v210
    v_cvt_pk_bf16_f32 v211, v238, v239
    v_mfma_f32_16x16x32_bf16 a[48:51], a[204:207], v[192:195], a[48:51]
    v_exp_f32 v240, v164
    v_mfma_f32_16x16x32_bf16 a[52:55], a[204:207], v[196:199], a[52:55]
    buffer_load_dwordx4 v1, s[16:19], s32 offen offset:3072 sc1 lds
    ds_read_b128 a[128:131], v2 offset:0
    v_mfma_f32_16x16x32_bf16 a[56:59], a[204:207], v[200:203], a[56:59]
    s_add_u32 s32, s32, 0x80000
    v_exp_f32 v241, v165
    v_mfma_f32_16x16x32_bf16 a[60:63], a[204:207], v[204:207], a[60:63]
    s_waitcnt lgkmcnt(3)
    v_add_u32 v3, s53, v56
    v_cvt_pk_bf16_f32 v212, v240, v241
    v_mfma_f32_16x16x32_bf16 a[64:67], a[208:211], v[192:195], a[64:67]
    v_exp_f32 v242, v166
    v_mfma_f32_16x16x32_bf16 a[68:71], a[208:211], v[196:199], a[68:71]
    ds_read_b128 a[132:135], v2 offset:1024
    v_or3_b32 v57, v57, v211, v212
    v_mfma_f32_16x16x32_bf16 a[72:75], a[208:211], v[200:203], a[72:75]
    v_exp_f32 v243, v167
    v_mfma_f32_16x16x32_bf16 a[76:79], a[208:211], v[204:207], a[76:79]
    s_cmp_ge_u32 s36, s42
    s_cbranch_scc1 k2_prep_83
k2_prepret_84:
    v_mfma_f32_16x16x32_bf16 a[80:83], a[212:215], v[192:195], a[80:83]
    s_waitcnt vmcnt(8)
    v_exp_f32 v244, v180
    v_mfma_f32_16x16x32_bf16 a[84:87], a[212:215], v[196:199], a[84:87]
    s_and_b32 s60, s62, 31
    ds_read_b128 a[136:139], v2 offset:2048
    v_cvt_pk_bf16_f32 v213, v242, v243
    v_mfma_f32_16x16x32_bf16 a[88:91], a[212:215], v[200:203], a[88:91]
    s_lshr_b32 s61, s62, 5
    buffer_store_dwordx4 a[224:227], v229, s[8:11], s58 offen offset:0 sc1
    v_mfma_f32_16x16x32_bf16 a[92:95], a[212:215], v[204:207], a[92:95]
    s_waitcnt lgkmcnt(3)
    v_exp_f32 v245, v181
    v_mfma_f32_16x16x32_bf16 a[96:99], a[216:219], v[192:195], a[96:99]
    v_exp_f32 v246, v182
    v_mfma_f32_16x16x32_bf16 a[100:103], a[216:219], v[196:199], a[100:103]
    s_mul_i32 s57, s60, s54
    ds_read_b128 a[140:143], v2 offset:3072
    v_cvt_pk_bf16_f32 v214, v244, v245
    v_mfma_f32_16x16x32_bf16 a[104:107], a[216:219], v[200:203], a[104:107]
    buffer_store_dwordx4 a[228:231], v229, s[8:11], s58 offen offset:256 sc1
    v_mfma_f32_16x16x32_bf16 a[108:111], a[216:219], v[204:207], a[108:111]
    s_mul_i32 s4, s61, s55
    v_exp_f32 v247, v183
    v_mfma_f32_16x16x32_bf16 a[112:115], a[220:223], v[192:195], a[112:115]
    v_or3_b32 v57, v57, v213, v214
    v_cvt_pk_bf16_f32 v215, v246, v247
    v_mfma_f32_16x16x32_bf16 a[116:119], a[220:223], v[196:199], a[116:119]
    v_exp_f32 v232, v168
    v_mfma_f32_16x16x32_bf16 a[120:123], a[220:223], v[200:203], a[120:123]
    s_add_u32 s57, s57, s4
    buffer_store_dwordx4 a[232:235], v229, s[8:11], s58 offen offset:512 sc1
    ds_read_b128 a[144:147], v2 offset:4096
    v_mfma_f32_16x16x32_bf16 a[124:127], a[220:223], v[204:207], a[124:127]
    s_waitcnt lgkmcnt(3)
    v_exp_f32 v233, v169
    v_mfma_f32_16x16x32_bf16 v[128:131], a[128:131], v[64:67], v[16:19]
    s_add_u32 s62, s62, 1
    v_exp_f32 v234, v170
    v_mfma_f32_16x16x32_bf16 v[132:135], a[128:131], v[80:83], v[20:23]
    ds_read_b128 a[148:151], v2 offset:5120
    v_cvt_pk_bf16_f32 v216, v232, v233
    v_mfma_f32_16x16x32_bf16 v[136:139], a[128:131], v[96:99], v[24:27]
    v_exp_f32 v235, v171
    v_mfma_f32_16x16x32_bf16 v[140:143], a[128:131], v[112:115], v[28:31]
    s_add_u32 s36, s36, 32
    v_or3_b32 v57, v57, v215, v216
    v_cvt_pk_bf16_f32 v217, v234, v235
    v_mfma_f32_16x16x32_bf16 v[128:131], a[132:135], v[68:71], v[128:131]
    buffer_store_dwordx4 a[236:239], v229, s[8:11], s58 offen offset:768 sc1
    v_mfma_f32_16x16x32_bf16 v[132:135], a[132:135], v[84:87], v[132:135]
    v_exp_f32 v236, v184
    v_mfma_f32_16x16x32_bf16 v[136:139], a[132:135], v[100:103], v[136:139]
    ds_read_b128 a[152:155], v2 offset:6144
    v_mfma_f32_16x16x32_bf16 v[140:143], a[132:135], v[116:119], v[140:143]
    s_waitcnt lgkmcnt(3)
    v_exp_f32 v237, v185
    v_mfma_f32_16x16x32_bf16 v[128:131], a[136:139], v[72:75], v[128:131]
    s_add_u32 s52, s52, 8192
    v_exp_f32 v238, v186
    v_mfma_f32_16x16x32_bf16 v[132:135], a[136:139], v[88:91], v[132:135]
    s_lshl_b32 s58, s61, 17
    ds_read_b128 a[156:159], v2 offset:7168
    v_cvt_pk_bf16_f32 v218, v236, v237
    v_mfma_f32_16x16x32_bf16 v[136:139], a[136:139], v[104:107], v[136:139]
    s_and_b32 s52, s52, 0xffff
    buffer_load_dwordx4 a[224:227], v228, s[12:15], s57 offen
    v_mfma_f32_16x16x32_bf16 v[140:143], a[136:139], v[120:123], v[140:143]
    s_add_u32 s57, s57, s56
    v_exp_f32 v239, v187
    v_mfma_f32_16x16x32_bf16 v[128:131], a[140:143], v[76:79], v[128:131]
    s_lshl_b32 s60, s60, 10
    v_or3_b32 v57, v57, v217, v218
    v_cvt_pk_bf16_f32 v219, v238, v239
    v_mfma_f32_16x16x32_bf16 v[132:135], a[140:143], v[92:95], v[132:135]
    v_exp_f32 v240, v172
    v_mfma_f32_16x16x32_bf16 v[136:139], a[140:143], v[108:111], v[136:139]
    buffer_load_dwordx4 a[228:231], v228, s[12:15], s57 offen
    v_mfma_f32_16x16x32_bf16 v[140:143], a[140:143], v[124:127], v[140:143]
    s_waitcnt lgkmcnt(2)
    v_exp_f32 v241, v173
    v_mfma_f32_16x16x32_bf16 v[144:147], a[144:147], v[64:67], v[32:35]
    s_add_u32 s57, s57, s56
    ds_read_b128 a[192:195], v3 offset:0
    v_cvt_pk_bf16_f32 v220, v240, v241
    v_mfma_f32_16x16x32_bf16 v[148:151], a[144:147], v[80:83], v[36:39]
    s_add_u32 s58, s58, s60
    v_exp_f32 v242, v174
    v_mfma_f32_16x16x32_bf16 v[152:155], a[144:147], v[96:99], v[40:43]
    v_add_u32 v2, s52, v1
    v_or3_b32 v57, v57, v219, v220
    v_mfma_f32_16x16x32_bf16 v[156:159], a[144:147], v[112:115], v[44:47]
    s_mov_b32 s10, s59
    v_exp_f32 v243, v175
    v_mfma_f32_16x16x32_bf16 v[144:147], a[148:151], v[68:71], v[144:147]
    buffer_load_dwordx4 a[232:235], v228, s[12:15], s57 offen
    ds_read_b128 a[196:199], v3 offset:1024
    v_mfma_f32_16x16x32_bf16 v[148:151], a[148:151], v[84:87], v[148:151]
    s_add_u32 s57, s57, s56
    v_exp_f32 v244, v188
    v_mfma_f32_16x16x32_bf16 v[152:155], a[148:151], v[100:103], v[152:155]
    ds_read_b128 a[200:203], v3 offset:2048
    v_cvt_pk_bf16_f32 v221, v242, v243
    v_mfma_f32_16x16x32_bf16 v[156:159], a[148:151], v[116:119], v[156:159]
    s_waitcnt lgkmcnt(3)
    v_exp_f32 v245, v189
    v_mfma_f32_16x16x32_bf16 v[144:147], a[152:155], v[72:75], v[144:147]
    buffer_load_dwordx4 a[236:239], v228, s[12:15], s57 offen
    v_mfma_f32_16x16x32_bf16 v[148:151], a[152:155], v[88:91], v[148:151]
    v_exp_f32 v246, v190
    v_mfma_f32_16x16x32_bf16 v[152:155], a[152:155], v[104:107], v[152:155]
    ds_read_b128 a[204:207], v3 offset:3072
    v_cvt_pk_bf16_f32 v222, v244, v245
    v_mfma_f32_16x16x32_bf16 v[156:159], a[152:155], v[120:123], v[156:159]
    v_exp_f32 v247, v191
    v_mfma_f32_16x16x32_bf16 v[144:147], a[156:159], v[76:79], v[144:147]
    v_or3_b32 v57, v57, v221, v222
    v_cvt_pk_bf16_f32 v223, v246, v247
    v_mfma_f32_16x16x32_bf16 v[148:151], a[156:159], v[92:95], v[148:151]
    v_bitop3_b32 v57, v57, v223, s37 bitop3:0xa8
    v_cmp_ne_u32 vcc, 0, v57
    v_mfma_f32_16x16x32_bf16 v[152:155], a[156:159], v[108:111], v[152:155]
    v_mfma_f32_16x16x32_bf16 v[156:159], a[156:159], v[124:127], v[156:159]
    s_cbranch_vccnz k2_rare_85
k2_ret_86:
    v_mfma_f32_16x16x32_bf16 v[12:15], v[60:63], v[208:211], v[12:15]
    ds_read_b128 a[208:211], v3 offset:4096
    v_mfma_f32_16x16x32_bf16 v[48:51], v[60:63], v[212:215], v[48:51]
    v_exp_f32 v232, v128
    v_mfma_f32_16x16x32_bf16 v[248:251], v[60:63], v[216:219], v[248:251]
    s_mov_b32 m0, s35
    v_exp_f32 v233, v129
    v_mfma_f32_16x16x32_bf16 v[252:255], v[60:63], v[220:223], v[252:255]
    s_waitcnt lgkmcnt(3)
    buffer_load_dwordx4 v1, s[20:23], s33 offen offset:0 sc1 lds
    ds_read_b128 a[212:215], v3 offset:5120
    v_mfma_f32_16x16x32_bf16 a[0:3], a[192:195], v[208:211], a[0:3]
    s_add_u32 s53, s53, 8192
    v_exp_f32 v234, v130
    v_mfma_f32_16x16x32_bf16 a[4:7], a[192:195], v[212:215], a[4:7]
    s_and_b32 s53, s53, 0xffff
    v_cvt_pk_bf16_f32 v192, v232, v233
    v_mfma_f32_16x16x32_bf16 a[8:11], a[192:195], v[216:219], a[8:11]
    v_exp_f32 v235, v131
    v_mfma_f32_16x16x32_bf16 a[12:15], a[192:195], v[220:223], a[12:15]
    ds_read_b128 a[216:219], v3 offset:6144
    v_cvt_pk_bf16_f32 v193, v234, v235
    v_mfma_f32_16x16x32_bf16 a[16:19], a[196:199], v[208:211], a[16:19]
    v_exp_f32 v236, v144
    v_mfma_f32_16x16x32_bf16 a[20:23], a[196:199], v[212:215], a[20:23]
    v_exp_f32 v237, v145
    v_mfma_f32_16x16x32_bf16 a[24:27], a[196:199], v[216:219], a[24:27]
    v_mfma_f32_16x16x32_bf16 a[28:31], a[196:199], v[220:223], a[28:31]
    s_waitcnt lgkmcnt(3)
    ds_read_b128 a[220:223], v3 offset:7168
    v_cvt_pk_bf16_f32 v194, v236, v237
    v_mfma_f32_16x16x32_bf16 a[32:35], a[200:203], v[208:211], a[32:35]
    v_exp_f32 v238, v146
    v_mfma_f32_16x16x32_bf16 a[36:39], a[200:203], v[212:215], a[36:39]
    v_exp_f32 v239, v147
    v_mfma_f32_16x16x32_bf16 a[40:43], a[200:203], v[216:219], a[40:43]
    v_or3_b32 v57, v192, v193, v194
    v_mfma_f32_16x16x32_bf16 a[44:47], a[200:203], v[220:223], a[44:47]
    v_exp_f32 v240, v132
    v_mfma_f32_16x16x32_bf16 a[48:51], a[204:207], v[208:211], a[48:51]
    s_add_u32 s35, s35, 0x4000
    v_cvt_pk_bf16_f32 v195, v238, v239
    v_mfma_f32_16x16x32_bf16 a[52:55], a[204:207], v[212:215], a[52:55]
    buffer_load_dwordx4 v1, s[20:23], s33 offen offset:1024 sc1 lds
    ds_read_b128 a[128:131], v2 offset:0
    v_mfma_f32_16x16x32_bf16 a[56:59], a[204:207], v[216:219], a[56:59]
    v_exp_f32 v241, v133
    v_mfma_f32_16x16x32_bf16 a[60:63], a[204:207], v[220:223], a[60:63]
    s_waitcnt lgkmcnt(3)
    v_add_u32 v3, s53, v56
    v_cvt_pk_bf16_f32 v196, v240, v241
    v_mfma_f32_16x16x32_bf16 a[64:67], a[208:211], v[208:211], a[64:67]
    v_exp_f32 v242, v134
    v_mfma_f32_16x16x32_bf16 a[68:71], a[208:211], v[212:215], a[68:71]
    ds_read_b128 a[132:135], v2 offset:1024
    v_or3_b32 v57, v57, v195, v196
    v_mfma_f32_16x16x32_bf16 a[72:75], a[208:211], v[216:219], a[72:75]
    v_exp_f32 v243, v135
    v_mfma_f32_16x16x32_bf16 a[76:79], a[208:211], v[220:223], a[76:79]
    s_cmp_ge_u32 s36, s42
    s_cbranch_scc1 k2_prep_87
k2_prepret_88:
    v_mfma_f32_16x16x32_bf16 a[80:83], a[212:215], v[208:211], a[80:83]
    v_exp_f32 v244, v148
    v_mfma_f32_16x16x32_bf16 a[84:87], a[212:215], v[212:215], a[84:87]
    ds_read_b128 a[136:139], v2 offset:2048
    v_cvt_pk_bf16_f32 v197, v242, v243
    v_mfma_f32_16x16x32_bf16 a[88:91], a[212:215], v[216:219], a[88:91]
    v_exp_f32 v245, v149
    v_mfma_f32_16x16x32_bf16 a[92:95], a[212:215], v[220:223], a[92:95]
    s_waitcnt lgkmcnt(3)
    v_exp_f32 v246, v150
    v_mfma_f32_16x16x32_bf16 a[96:99], a[216:219], v[208:211], a[96:99]
    ds_read_b128 a[140:143], v2 offset:3072
    v_cvt_pk_bf16_f32 v198, v244, v245
    v_mfma_f32_16x16x32_bf16 a[100:103], a[216:219], v[212:215], a[100:103]
    v_exp_f32 v247, v151
    v_mfma_f32_16x16x32_bf16 a[104:107], a[216:219], v[216:219], a[104:107]
    v_or3_b32 v57, v57, v197, v198
    v_mfma_f32_16x16x32_bf16 a[108:111], a[216:219], v[220:223], a[108:111]
    s_and_b32 s35, s35, 0xffff
    v_exp_f32 v232, v136
    v_mfma_f32_16x16x32_bf16 a[112:115], a[220:223], v[208:211], a[112:115]
    ds_read_b128 a[144:147], v2 offset:4096
    v_cvt_pk_bf16_f32 v199, v246, v247
    v_mfma_f32_16x16x32_bf16 a[116:119], a[220:223], v[212:215], a[116:119]
    buffer_load_dwordx4 v1, s[20:23], s33 offen offset:2048 sc1 lds
    v_mfma_f32_16x16x32_bf16 a[120:123], a[220:223], v[216:219], a[120:123]
    v_exp_f32 v233, v137
    v_mfma_f32_16x16x32_bf16 a[124:127], a[220:223], v[220:223], a[124:127]
    s_waitcnt lgkmcnt(3)
    v_exp_f32 v234, v138
    v_mfma_f32_16x16x32_bf16 v[160:163], a[128:131], v[64:67], v[16:19]
    v_cvt_pk_bf16_f32 v200, v232, v233
    v_mfma_f32_16x16x32_bf16 v[164:167], a[128:131], v[80:83], v[20:23]
    ds_read_b128 a[148:151], v2 offset:5120
    v_or3_b32 v57, v57, v199, v200
    v_mfma_f32_16x16x32_bf16 v[168:171], a[128:131], v[96:99], v[24:27]
    v_exp_f32 v235, v139
    v_mfma_f32_16x16x32_bf16 v[172:175], a[128:131], v[112:115], v[28:31]
    s_add_u32 s36, s36, 32
    v_exp_f32 v236, v152
    v_mfma_f32_16x16x32_bf16 v[160:163], a[132:135], v[68:71], v[160:163]
    s_or_b32 s35, s35, 0x10000
    v_cvt_pk_bf16_f32 v201, v234, v235
    v_mfma_f32_16x16x32_bf16 v[164:167], a[132:135], v[84:87], v[164:167]
    ds_read_b128 a[152:155], v2 offset:6144
    v_mfma_f32_16x16x32_bf16 v[168:171], a[132:135], v[100:103], v[168:171]
    v_exp_f32 v237, v153
    v_mfma_f32_16x16x32_bf16 v[172:175], a[132:135], v[116:119], v[172:175]
    s_waitcnt lgkmcnt(3)
    v_exp_f32 v238, v154
    v_mfma_f32_16x16x32_bf16 v[160:163], a[136:139], v[72:75], v[160:163]
    s_add_u32 s52, s52, 8192
    v_cvt_pk_bf16_f32 v202, v236, v237
    v_mfma_f32_16x16x32_bf16 v[164:167], a[136:139], v[88:91], v[164:167]
    ds_read_b128 a[156:159], v2 offset:7168
    v_or3_b32 v57, v57, v201, v202
    v_mfma_f32_16x16x32_bf16 v[168:171], a[136:139], v[104:107], v[168:171]
    s_and_b32 s52, s52, 0xffff
    v_exp_f32 v239, v155
    v_mfma_f32_16x16x32_bf16 v[172:175], a[136:139], v[120:123], v[172:175]
    v_exp_f32 v240, v140
    v_mfma_f32_16x16x32_bf16 v[160:163], a[140:143], v[76:79], v[160:163]
    v_cvt_pk_bf16_f32 v203, v238, v239
    v_mfma_f32_16x16x32_bf16 v[164:167], a[140:143], v[92:95], v[164:167]
    buffer_load_dwordx4 v1, s[20:23], s33 offen offset:3072 sc1 lds
    v_mfma_f32_16x16x32_bf16 v[168:171], a[140:143], v[108:111], v[168:171]
    s_add_u32 s33, s33, 0x80000
    v_exp_f32 v241, v141
    v_mfma_f32_16x16x32_bf16 v[172:175], a[140:143], v[124:127], v[172:175]
    s_waitcnt lgkmcnt(2)
    ds_read_b128 a[192:195], v3 offset:0
    v_cvt_pk_bf16_f32 v204, v240, v241
    v_mfma_f32_16x16x32_bf16 v[176:179], a[144:147], v[64:67], v[32:35]
    v_exp_f32 v242, v142
    v_mfma_f32_16x16x32_bf16 v[180:183], a[144:147], v[80:83], v[36:39]
    v_add_u32 v2, s52, v1
    v_or3_b32 v57, v57, v203, v204
    v_mfma_f32_16x16x32_bf16 v[184:187], a[144:147], v[96:99], v[40:43]
    v_exp_f32 v243, v143
    v_mfma_f32_16x16x32_bf16 v[188:191], a[144:147], v[112:115], v[44:47]
    ds_read_b128 a[196:199], v3 offset:1024
    v_cvt_pk_bf16_f32 v205, v242, v243
    v_mfma_f32_16x16x32_bf16 v[176:179], a[148:151], v[68:71], v[176:179]
    v_exp_f32 v244, v156
    v_mfma_f32_16x16x32_bf16 v[180:183], a[148:151], v[84:87], v[180:183]
    v_exp_f32 v245, v157
    v_mfma_f32_16x16x32_bf16 v[184:187], a[148:151], v[100:103], v[184:187]
    ds_read_b128 a[200:203], v3 offset:2048
    v_mfma_f32_16x16x32_bf16 v[188:191], a[148:151], v[116:119], v[188:191]
    s_waitcnt lgkmcnt(3)
    v_exp_f32 v246, v158
    v_mfma_f32_16x16x32_bf16 v[176:179], a[152:155], v[72:75], v[176:179]
    s_sub_u32 s63, s63, 1
    v_cvt_pk_bf16_f32 v206, v244, v245
    v_mfma_f32_16x16x32_bf16 v[180:183], a[152:155], v[88:91], v[180:183]
    v_exp_f32 v247, v159
    v_mfma_f32_16x16x32_bf16 v[184:187], a[152:155], v[104:107], v[184:187]
    ds_read_b128 a[204:207], v3 offset:3072
    v_or3_b32 v57, v57, v205, v206
    v_mfma_f32_16x16x32_bf16 v[188:191], a[152:155], v[120:123], v[188:191]
    v_cvt_pk_bf16_f32 v207, v246, v247
    v_mfma_f32_16x16x32_bf16 v[176:179], a[156:159], v[76:79], v[176:179]
    v_mfma_f32_16x16x32_bf16 v[180:183], a[156:159], v[92:95], v[180:183]
    v_bitop3_b32 v57, v57, v207, s37 bitop3:0xa8
    v_cmp_ne_u32 vcc, 0, v57
    v_mfma_f32_16x16x32_bf16 v[184:187], a[156:159], v[108:111], v[184:187]
    v_mfma_f32_16x16x32_bf16 v[188:191], a[156:159], v[124:127], v[188:191]
    s_waitcnt vmcnt(16)
    s_barrier
    s_cbranch_vccnz k2_rare_89
k2_ret_90:
    s_cmp_lg_u32 s63, 0
    s_cbranch_scc1 k2_dloop_82
    v_mfma_f32_16x16x32_bf16 v[12:15], v[60:63], v[192:195], v[12:15]
    ds_read_b128 a[208:211], v3 offset:4096
    v_mfma_f32_16x16x32_bf16 v[48:51], v[60:63], v[196:199], v[48:51]
    s_mov_b32 m0, s34
    v_exp_f32 v232, v160
    v_mfma_f32_16x16x32_bf16 v[248:251], v[60:63], v[200:203], v[248:251]
    s_add_u32 s53, s53, 8192
    buffer_load_dwordx4 v1, s[16:19], s32 offen offset:0 sc1 lds
    v_mfma_f32_16x16x32_bf16 v[252:255], v[60:63], v[204:207], v[252:255]
    s_waitcnt lgkmcnt(3)
    v_exp_f32 v233, v161
    v_mfma_f32_16x16x32_bf16 a[0:3], a[192:195], v[192:195], a[0:3]
    s_and_b32 s53, s53, 0xffff
    ds_read_b128 a[212:215], v3 offset:5120
    v_cvt_pk_bf16_f32 v208, v232, v233
    v_mfma_f32_16x16x32_bf16 a[4:7], a[192:195], v[196:199], a[4:7]
    v_exp_f32 v234, v162
    v_mfma_f32_16x16x32_bf16 a[8:11], a[192:195], v[200:203], a[8:11]
    v_exp_f32 v235, v163
    v_mfma_f32_16x16x32_bf16 a[12:15], a[192:195], v[204:207], a[12:15]
    ds_read_b128 a[216:219], v3 offset:6144
    v_cvt_pk_bf16_f32 v209, v234, v235
    v_mfma_f32_16x16x32_bf16 a[16:19], a[196:199], v[192:195], a[16:19]
    s_add_u32 s34, s34, 0x4000
    v_exp_f32 v236, v176
    v_mfma_f32_16x16x32_bf16 a[20:23], a[196:199], v[196:199], a[20:23]
    v_exp_f32 v237, v177
    v_mfma_f32_16x16x32_bf16 a[24:27], a[196:199], v[200:203], a[24:27]
    buffer_load_dwordx4 v1, s[16:19], s32 offen offset:1024 sc1 lds
    v_mfma_f32_16x16x32_bf16 a[28:31], a[196:199], v[204:207], a[28:31]
    s_waitcnt lgkmcnt(3)
    ds_read_b128 a[220:223], v3 offset:7168
    v_cvt_pk_bf16_f32 v210, v236, v237
    v_mfma_f32_16x16x32_bf16 a[32:35], a[200:203], v[192:195], a[32:35]
    v_exp_f32 v238, v178
    v_mfma_f32_16x16x32_bf16 a[36:39], a[200:203], v[196:199], a[36:39]
    v_exp_f32 v239, v179
    v_mfma_f32_16x16x32_bf16 a[40:43], a[200:203], v[200:203], a[40:43]
    v_or3_b32 v57, v208, v209, v210
    v_mfma_f32_16x16x32_bf16 a[44:47], a[200:203], v[204:207], a[44:47]
    v_exp_f32 v240, v164
    v_mfma_f32_16x16x32_bf16 a[48:51], a[204:207], v[192:195], a[48:51]
    v_cvt_pk_bf16_f32 v211, v238, v239
    v_mfma_f32_16x16x32_bf16 a[52:55], a[204:207], v[196:199], a[52:55]
    s_and_b32 s34, s34, 0xffff
    ds_read_b128 a[128:131], v2 offset:0
    v_mfma_f32_16x16x32_bf16 a[56:59], a[204:207], v[200:203], a[56:59]
    v_exp_f32 v241, v165
    v_mfma_f32_16x16x32_bf16 a[60:63], a[204:207], v[204:207], a[60:63]
    s_waitcnt lgkmcnt(3)
    buffer_load_dwordx4 v1, s[16:19], s32 offen offset:2048 sc1 lds
    ds_read_b128 a[132:135], v2 offset:1024
    v_mfma_f32_16x16x32_bf16 a[64:67], a[208:211], v[192:195], a[64:67]
    v_add_u32 v3, s53, v56
    v_cvt_pk_bf16_f32 v212, v240, v241
    v_mfma_f32_16x16x32_bf16 a[68:71], a[208:211], v[196:199], a[68:71]
    v_exp_f32 v242, v166
    v_mfma_f32_16x16x32_bf16 a[72:75], a[208:211], v[200:203], a[72:75]
    ds_read_b128 a[136:139], v2 offset:2048
    v_or3_b32 v57, v57, v211, v212
    v_mfma_f32_16x16x32_bf16 a[76:79], a[208:211], v[204:207], a[76:79]
    v_exp_f32 v243, v167
    v_mfma_f32_16x16x32_bf16 a[80:83], a[212:215], v[192:195], a[80:83]
    ds_read_b128 a[140:143], v2 offset:3072
    v_cvt_pk_bf16_f32 v213, v242, v243
    v_mfma_f32_16x16x32_bf16 a[84:87], a[212:215], v[196:199], a[84:87]
    s_branch k2_prep_91
k2_prepret_92:
    v_mfma_f32_16x16x32_bf16 a[88:91], a[212:215], v[200:203], a[88:91]
    v_exp_f32 v244, v180
    v_mfma_f32_16x16x32_bf16 a[92:95], a[212:215], v[204:207], a[92:95]
    s_waitcnt lgkmcnt(4)
    ds_read_b128 a[144:147], v2 offset:4096
    ds_read_b128 a[148:151], v2 offset:5120
    v_mfma_f32_16x16x32_bf16 a[96:99], a[216:219], v[192:195], a[96:99]
    v_exp_f32 v245, v181
    v_mfma_f32_16x16x32_bf16 a[100:103], a[216:219], v[196:199], a[100:103]
    buffer_load_dwordx4 v1, s[16:19], s32 offen offset:3072 sc1 lds
    ds_read_b128 a[152:155], v2 offset:6144
    v_mfma_f32_16x16x32_bf16 a[104:107], a[216:219], v[200:203], a[104:107]
    s_add_u32 s32, s32, 0x80000
    v_exp_f32 v246, v182
    v_mfma_f32_16x16x32_bf16 a[108:111], a[216:219], v[204:207], a[108:111]
    v_cvt_pk_bf16_f32 v214, v244, v245
    v_or3_b32 v57, v57, v213, v214
    v_mfma_f32_16x16x32_bf16 a[112:115], a[220:223], v[192:195], a[112:115]
    v_exp_f32 v247, v183
    v_mfma_f32_16x16x32_bf16 a[116:119], a[220:223], v[196:199], a[116:119]
    ds_read_b128 a[156:159], v2 offset:7168
    v_cvt_pk_bf16_f32 v215, v246, v247
    v_mfma_f32_16x16x32_bf16 a[120:123], a[220:223], v[200:203], a[120:123]
    v_exp_f32 v232, v168
    v_mfma_f32_16x16x32_bf16 a[124:127], a[220:223], v[204:207], a[124:127]
    s_waitcnt lgkmcnt(6)
    ds_read_b128 a[160:163], v2 offset:8192
    ds_read_b128 a[164:167], v2 offset:9216
    v_mfma_f32_16x16x32_bf16 v[128:131], a[128:131], v[96:99], v[16:19]
    s_waitcnt vmcnt(8)
    v_exp_f32 v233, v169
    v_mfma_f32_16x16x32_bf16 v[132:135], a[128:131], v[112:115], v[20:23]
    v_exp_f32 v234, v170
    v_mfma_f32_16x16x32_bf16 v[128:131], a[132:135], v[100:103], v[128:131]
    ds_read_b128 a[168:171], v2 offset:10240
    v_cvt_pk_bf16_f32 v216, v232, v233
    v_mfma_f32_16x16x32_bf16 v[132:135], a[132:135], v[116:119], v[132:135]
    s_waitcnt lgkmcnt(7)
    buffer_store_dwordx4 a[224:227], v229, s[8:11], s58 offen offset:0 sc1
    ds_read_b128 a[172:175], v2 offset:11264
    v_mfma_f32_16x16x32_bf16 v[128:131], a[136:139], v[104:107], v[128:131]
    s_add_u32 s36, s36, 64
    v_exp_f32 v235, v171
    v_mfma_f32_16x16x32_bf16 v[132:135], a[136:139], v[120:123], v[132:135]
    v_or3_b32 v57, v57, v215, v216
    v_cvt_pk_bf16_f32 v217, v234, v235
    v_mfma_f32_16x16x32_bf16 v[128:131], a[140:143], v[108:111], v[128:131]
    v_exp_f32 v236, v184
    v_mfma_f32_16x16x32_bf16 v[132:135], a[140:143], v[124:127], v[132:135]
    s_waitcnt lgkmcnt(6)
    ds_read_b128 a[176:179], v2 offset:12288
    ds_read_b128 a[180:183], v2 offset:13312
    v_mfma_f32_16x16x32_bf16 v[144:147], a[144:147], v[96:99], v[32:35]
    s_add_u32 s52, s52, 16384
    v_exp_f32 v237, v185
    v_mfma_f32_16x16x32_bf16 v[148:151], a[144:147], v[112:115], v[36:39]
    v_exp_f32 v238, v186
    v_mfma_f32_16x16x32_bf16 v[144:147], a[148:151], v[100:103], v[144:147]
    s_and_b32 s52, s52, 0xffff
    ds_read_b128 a[184:187], v2 offset:14336
    v_cvt_pk_bf16_f32 v218, v236, v237
    v_mfma_f32_16x16x32_bf16 v[148:151], a[148:151], v[116:119], v[148:151]
    s_waitcnt lgkmcnt(7)
    v_exp_f32 v239, v187
    v_mfma_f32_16x16x32_bf16 v[144:147], a[152:155], v[104:107], v[144:147]
    ds_read_b128 a[188:191], v2 offset:15360
    v_or3_b32 v57, v57, v217, v218
    v_mfma_f32_16x16x32_bf16 v[148:151], a[152:155], v[120:123], v[148:151]
    buffer_store_dwordx4 a[228:231], v229, s[8:11], s58 offen offset:256 sc1
    v_mfma_f32_16x16x32_bf16 v[144:147], a[156:159], v[108:111], v[144:147]
    v_exp_f32 v240, v172
    v_mfma_f32_16x16x32_bf16 v[148:151], a[156:159], v[124:127], v[148:151]
    s_waitcnt lgkmcnt(6)
    ds_read_b128 a[192:195], v3 offset:0
    v_cvt_pk_bf16_f32 v219, v238, v239
    v_mfma_f32_16x16x32_bf16 v[136:139], a[160:163], v[96:99], v[24:27]
    v_exp_f32 v241, v173
    v_mfma_f32_16x16x32_bf16 v[140:143], a[160:163], v[112:115], v[28:31]
    v_exp_f32 v242, v174
    v_mfma_f32_16x16x32_bf16 v[136:139], a[164:167], v[100:103], v[136:139]
    v_cvt_pk_bf16_f32 v220, v240, v241
    v_add_u32 v2, s52, v1
    v_mfma_f32_16x16x32_bf16 v[140:143], a[164:167], v[116:119], v[140:143]
    s_waitcnt lgkmcnt(5)
    v_exp_f32 v243, v175
    v_mfma_f32_16x16x32_bf16 v[136:139], a[168:171], v[104:107], v[136:139]
    ds_read_b128 a[196:199], v3 offset:1024
    v_or3_b32 v57, v57, v219, v220
    v_mfma_f32_16x16x32_bf16 v[140:143], a[168:171], v[120:123], v[140:143]
    v_exp_f32 v244, v188
    v_mfma_f32_16x16x32_bf16 v[136:139], a[172:175], v[108:111], v[136:139]
    ds_read_b128 a[200:203], v3 offset:2048
    v_cvt_pk_bf16_f32 v221, v242, v243
    v_mfma_f32_16x16x32_bf16 v[140:143], a[172:175], v[124:127], v[140:143]
    s_waitcnt lgkmcnt(5)
    buffer_store_dwordx4 a[232:235], v229, s[8:11], s58 offen offset:512 sc1
    v_mfma_f32_16x16x32_bf16 v[152:155], a[176:179], v[96:99], v[40:43]
    v_exp_f32 v245, v189
    v_mfma_f32_16x16x32_bf16 v[156:159], a[176:179], v[112:115], v[44:47]
    v_exp_f32 v246, v190
    v_mfma_f32_16x16x32_bf16 v[152:155], a[180:183], v[100:103], v[152:155]
    ds_read_b128 a[204:207], v3 offset:3072
    v_cvt_pk_bf16_f32 v222, v244, v245
    v_mfma_f32_16x16x32_bf16 v[156:159], a[180:183], v[116:119], v[156:159]
    s_waitcnt lgkmcnt(4)
    v_exp_f32 v247, v191
    v_mfma_f32_16x16x32_bf16 v[152:155], a[184:187], v[104:107], v[152:155]
    v_or3_b32 v57, v57, v221, v222
    v_cvt_pk_bf16_f32 v223, v246, v247
    v_mfma_f32_16x16x32_bf16 v[156:159], a[184:187], v[120:123], v[156:159]
    v_bitop3_b32 v57, v57, v223, s37 bitop3:0xa8
    v_cmp_ne_u32 vcc, 0, v57
    v_mfma_f32_16x16x32_bf16 v[152:155], a[188:191], v[108:111], v[152:155]
    buffer_store_dwordx4 a[236:239], v229, s[8:11], s58 offen offset:768 sc1
    v_mfma_f32_16x16x32_bf16 v[156:159], a[188:191], v[124:127], v[156:159]
    s_cbranch_vccnz k2_rare_93
k2_ret_94:
    v_mfma_f32_16x16x32_bf16 v[12:15], v[60:63], v[208:211], v[12:15]
    ds_read_b128 a[208:211], v3 offset:4096
    v_mfma_f32_16x16x32_bf16 v[48:51], v[60:63], v[212:215], v[48:51]
    s_mov_b32 m0, s35
    v_exp_f32 v232, v128
    v_mfma_f32_16x16x32_bf16 v[248:251], v[60:63], v[216:219], v[248:251]
    s_add_u32 s53, s53, 8192
    buffer_load_dwordx4 v1, s[20:23], s33 offen offset:0 sc1 lds
    v_mfma_f32_16x16x32_bf16 v[252:255], v[60:63], v[220:223], v[252:255]
    s_waitcnt lgkmcnt(3)
    v_exp_f32 v233, v129
    v_mfma_f32_16x16x32_bf16 a[0:3], a[192:195], v[208:211], a[0:3]
    s_and_b32 s53, s53, 0xffff
    ds_read_b128 a[212:215], v3 offset:5120
    v_cvt_pk_bf16_f32 v192, v232, v233
    v_mfma_f32_16x16x32_bf16 a[4:7], a[192:195], v[212:215], a[4:7]
    v_exp_f32 v234, v130
    v_mfma_f32_16x16x32_bf16 a[8:11], a[192:195], v[216:219], a[8:11]
    v_exp_f32 v235, v131
    v_mfma_f32_16x16x32_bf16 a[12:15], a[192:195], v[220:223], a[12:15]
    ds_read_b128 a[216:219], v3 offset:6144
    v_cvt_pk_bf16_f32 v193, v234, v235
    v_mfma_f32_16x16x32_bf16 a[16:19], a[196:199], v[208:211], a[16:19]
    s_add_u32 s35, s35, 0x4000
    v_exp_f32 v236, v144
    v_mfma_f32_16x16x32_bf16 a[20:23], a[196:199], v[212:215], a[20:23]
    v_exp_f32 v237, v145
    v_mfma_f32_16x16x32_bf16 a[24:27], a[196:199], v[216:219], a[24:27]
    buffer_load_dwordx4 v1, s[20:23], s33 offen offset:1024 sc1 lds
    v_mfma_f32_16x16x32_bf16 a[28:31], a[196:199], v[220:223], a[28:31]
    s_waitcnt lgkmcnt(3)
    ds_read_b128 a[220:223], v3 offset:7168
    v_cvt_pk_bf16_f32 v194, v236, v237
    v_mfma_f32_16x16x32_bf16 a[32:35], a[200:203], v[208:211], a[32:35]
    v_exp_f32 v238, v146
    v_mfma_f32_16x16x32_bf16 a[36:39], a[200:203], v[212:215], a[36:39]
    v_exp_f32 v239, v147
    v_mfma_f32_16x16x32_bf16 a[40:43], a[200:203], v[216:219], a[40:43]
    v_or3_b32 v57, v192, v193, v194
    v_mfma_f32_16x16x32_bf16 a[44:47], a[200:203], v[220:223], a[44:47]
    v_exp_f32 v240, v132
    v_mfma_f32_16x16x32_bf16 a[48:51], a[204:207], v[208:211], a[48:51]
    s_and_b32 s35, s35, 0xffff
    v_cvt_pk_bf16_f32 v195, v238, v239
    v_mfma_f32_16x16x32_bf16 a[52:55], a[204:207], v[212:215], a[52:55]
    buffer_load_dwordx4 v1, s[20:23], s33 offen offset:2048 sc1 lds
    ds_read_b128 a[128:131], v2 offset:0
    v_mfma_f32_16x16x32_bf16 a[56:59], a[204:207], v[216:219], a[56:59]
    v_exp_f32 v241, v133
    v_mfma_f32_16x16x32_bf16 a[60:63], a[204:207], v[220:223], a[60:63]
    s_waitcnt lgkmcnt(3)
    ds_read_b128 a[132:135], v2 offset:1024
    v_add_u32 v3, s53, v56
    v_mfma_f32_16x16x32_bf16 a[64:67], a[208:211], v[208:211], a[64:67]
    v_exp_f32 v242, v134
    v_mfma_f32_16x16x32_bf16 a[68:71], a[208:211], v[212:215], a[68:71]
    s_or_b32 s35, s35, 0x10000
    ds_read_b128 a[136:139], v2 offset:2048
    v_cvt_pk_bf16_f32 v196, v240, v241
    v_mfma_f32_16x16x32_bf16 a[72:75], a[208:211], v[216:219], a[72:75]
    v_exp_f32 v243, v135
    v_mfma_f32_16x16x32_bf16 a[76:79], a[208:211], v[220:223], a[76:79]
    ds_read_b128 a[140:143], v2 offset:3072
    v_or3_b32 v57, v57, v195, v196
    v_mfma_f32_16x16x32_bf16 a[80:83], a[212:215], v[208:211], a[80:83]
    s_cmp_ge_u32 s36, s43
    s_cbranch_scc1 k2_prep_95
k2_prepret_96:
    v_mfma_f32_16x16x32_bf16 a[84:87], a[212:215], v[212:215], a[84:87]
    v_exp_f32 v244, v148
    v_mfma_f32_16x16x32_bf16 a[88:91], a[212:215], v[216:219], a[88:91]
    ds_read_b128 a[144:147], v2 offset:4096
    v_cvt_pk_bf16_f32 v197, v242, v243
    v_mfma_f32_16x16x32_bf16 a[92:95], a[212:215], v[220:223], a[92:95]
    s_waitcnt lgkmcnt(5)
    v_exp_f32 v245, v149
    v_mfma_f32_16x16x32_bf16 a[96:99], a[216:219], v[208:211], a[96:99]
    buffer_load_dwordx4 v1, s[20:23], s33 offen offset:3072 sc1 lds
    ds_read_b128 a[148:151], v2 offset:5120
    v_mfma_f32_16x16x32_bf16 a[100:103], a[216:219], v[212:215], a[100:103]
    s_add_u32 s33, s33, 0x80000
    v_exp_f32 v246, v150
    v_mfma_f32_16x16x32_bf16 a[104:107], a[216:219], v[216:219], a[104:107]
    ds_read_b128 a[152:155], v2 offset:6144
    v_cvt_pk_bf16_f32 v198, v244, v245
    v_mfma_f32_16x16x32_bf16 a[108:111], a[216:219], v[220:223], a[108:111]
    v_exp_f32 v247, v151
    v_mfma_f32_16x16x32_bf16 a[112:115], a[220:223], v[208:211], a[112:115]
    ds_read_b128 a[156:159], v2 offset:7168
    v_or3_b32 v57, v57, v197, v198
    v_mfma_f32_16x16x32_bf16 a[116:119], a[220:223], v[212:215], a[116:119]
    v_exp_f32 v232, v136
    v_mfma_f32_16x16x32_bf16 a[120:123], a[220:223], v[216:219], a[120:123]
    ds_read_b128 a[160:163], v2 offset:8192
    v_cvt_pk_bf16_f32 v199, v246, v247
    v_mfma_f32_16x16x32_bf16 a[124:127], a[220:223], v[220:223], a[124:127]
    s_waitcnt lgkmcnt(7)
    v_exp_f32 v233, v137
    v_mfma_f32_16x16x32_bf16 v[160:163], a[128:131], v[96:99], v[16:19]
    s_waitcnt vmcnt(12)
    s_barrier
    ds_read_b128 a[164:167], v2 offset:9216
    v_cvt_pk_bf16_f32 v200, v232, v233
    v_mfma_f32_16x16x32_bf16 v[164:167], a[128:131], v[112:115], v[20:23]
    s_mov_b32 m0, s34
    v_exp_f32 v234, v138
    v_mfma_f32_16x16x32_bf16 v[160:163], a[132:135], v[100:103], v[160:163]
    buffer_load_dwordx4 v1, s[16:19], s32 offen offset:0 sc1 lds
    ds_read_b128 a[168:171], v2 offset:10240
    v_mfma_f32_16x16x32_bf16 v[164:167], a[132:135], v[116:119], v[164:167]
    s_waitcnt lgkmcnt(7)
    v_exp_f32 v235, v139
    v_mfma_f32_16x16x32_bf16 v[160:163], a[136:139], v[104:107], v[160:163]
    s_add_u32 s36, s36, 64
    ds_read_b128 a[172:175], v2 offset:11264
    v_or3_b32 v57, v57, v199, v200
    v_mfma_f32_16x16x32_bf16 v[164:167], a[136:139], v[120:123], v[164:167]
    v_exp_f32 v236, v152
    v_mfma_f32_16x16x32_bf16 v[160:163], a[140:143], v[108:111], v[160:163]
    ds_read_b128 a[176:179], v2 offset:12288
    v_cvt_pk_bf16_f32 v201, v234, v235
    v_mfma_f32_16x16x32_bf16 v[164:167], a[140:143], v[124:127], v[164:167]
    s_waitcnt lgkmcnt(7)
    v_exp_f32 v237, v153
    v_mfma_f32_16x16x32_bf16 v[176:179], a[144:147], v[96:99], v[32:35]
    s_add_u32 s34, s34, 0x4000
    ds_read_b128 a[180:183], v2 offset:13312
    v_cvt_pk_bf16_f32 v202, v236, v237
    v_mfma_f32_16x16x32_bf16 v[180:183], a[144:147], v[112:115], v[36:39]
    s_add_u32 s52, s52, 16384
    v_exp_f32 v238, v154
    v_mfma_f32_16x16x32_bf16 v[176:179], a[148:151], v[100:103], v[176:179]
    s_and_b32 s52, s52, 0xffff
    buffer_load_dwordx4 v1, s[16:19], s32 offen offset:1024 sc1 lds
    ds_read_b128 a[184:187], v2 offset:14336
    v_mfma_f32_16x16x32_bf16 v[180:183], a[148:151], v[116:119], v[180:183]
    s_waitcnt lgkmcnt(7)
    v_exp_f32 v239, v155
    v_mfma_f32_16x16x32_bf16 v[176:179], a[152:155], v[104:107], v[176:179]
    ds_read_b128 a[188:191], v2 offset:15360
    v_or3_b32 v57, v57, v201, v202
    v_mfma_f32_16x16x32_bf16 v[180:183], a[152:155], v[120:123], v[180:183]
    v_exp_f32 v240, v140
    v_mfma_f32_16x16x32_bf16 v[176:179], a[156:159], v[108:111], v[176:179]
    s_and_b32 s34, s34, 0xffff
    v_cvt_pk_bf16_f32 v203, v238, v239
    v_mfma_f32_16x16x32_bf16 v[180:183], a[156:159], v[124:127], v[180:183]
    s_waitcnt lgkmcnt(6)
    v_exp_f32 v241, v141
    v_mfma_f32_16x16x32_bf16 v[168:171], a[160:163], v[96:99], v[24:27]
    ds_read_b128 a[192:195], v3 offset:0
    v_cvt_pk_bf16_f32 v204, v240, v241
    v_mfma_f32_16x16x32_bf16 v[172:175], a[160:163], v[112:115], v[28:31]
    v_exp_f32 v242, v142
    v_mfma_f32_16x16x32_bf16 v[168:171], a[164:167], v[100:103], v[168:171]
    buffer_load_dwordx4 v1, s[16:19], s32 offen offset:2048 sc1 lds
    ds_read_b128 a[196:199], v3 offset:1024
    v_mfma_f32_16x16x32_bf16 v[172:175], a[164:167], v[116:119], v[172:175]
    s_waitcnt lgkmcnt(6)
    v_add_u32 v2, s52, v1
    v_or3_b32 v57, v57, v203, v204
    v_mfma_f32_16x16x32_bf16 v[168:171], a[168:171], v[104:107], v[168:171]
    v_exp_f32 v243, v143
    v_mfma_f32_16x16x32_bf16 v[172:175], a[168:171], v[120:123], v[172:175]
    ds_read_b128 a[200:203], v3 offset:2048
    v_cvt_pk_bf16_f32 v205, v242, v243
    v_mfma_f32_16x16x32_bf16 v[168:171], a[172:175], v[108:111], v[168:171]
    v_exp_f32 v244, v156
    v_mfma_f32_16x16x32_bf16 v[172:175], a[172:175], v[124:127], v[172:175]
    s_waitcnt lgkmcnt(5)
    ds_read_b128 a[204:207], v3 offset:3072
    ds_read_b128 a[208:211], v3 offset:4096
    v_mfma_f32_16x16x32_bf16 v[184:187], a[176:179], v[96:99], v[40:43]
    v_exp_f32 v245, v157
    v_mfma_f32_16x16x32_bf16 v[188:191], a[176:179], v[112:115], v[44:47]
    buffer_load_dwordx4 v1, s[16:19], s32 offen offset:3072 sc1 lds
    ds_read_b128 a[212:215], v3 offset:5120
    v_mfma_f32_16x16x32_bf16 v[184:187], a[180:183], v[100:103], v[184:187]
    s_add_u32 s32, s32, 0x80000
    v_exp_f32 v246, v158
    v_mfma_f32_16x16x32_bf16 v[188:191], a[180:183], v[116:119], v[188:191]
    s_waitcnt lgkmcnt(6)
    ds_read_b128 a[216:219], v3 offset:6144
    v_cvt_pk_bf16_f32 v206, v244, v245
    v_mfma_f32_16x16x32_bf16 v[184:187], a[184:187], v[104:107], v[184:187]
    v_exp_f32 v247, v159
    v_mfma_f32_16x16x32_bf16 v[188:191], a[184:187], v[120:123], v[188:191]
    ds_read_b128 a[220:223], v3 offset:7168
    v_or3_b32 v57, v57, v205, v206
    v_mfma_f32_16x16x32_bf16 v[184:187], a[188:191], v[108:111], v[184:187]
    v_cvt_pk_bf16_f32 v207, v246, v247
    v_bitop3_b32 v57, v57, v207, s37 bitop3:0xa8
    v_mfma_f32_16x16x32_bf16 v[188:191], a[188:191], v[124:127], v[188:191]
    v_cmp_ne_u32 vcc, 0, v57
    s_cbranch_vccnz k2_rare_97
k2_ret_98:
    s_lshl_b32 s31, s28, 19
    s_lshl_b32 s44, s38, 6
    s_add_u32 s44, s44, s31
    s_add_u32 s45, s44, 131072
    s_add_u32 s46, s44, 262144
    s_add_u32 s47, s44, 393216
    v_mov_b32 v13, v12
    v_mov_b32 v49, v48
    s_nop 1
    v_permlane16_swap_b32 v12, v13
    v_permlane16_swap_b32 v48, v49
    s_nop 1
    v_add_f32 v12, v12, v13
    v_add_f32 v48, v48, v49
    v_mov_b32 v13, v12
    v_mov_b32 v49, v48
    s_nop 1
    v_permlane32_swap_b32 v12, v13
    v_permlane32_swap_b32 v48, v49
    s_nop 1
    v_add_f32 v12, v12, v13
    v_add_f32 v48, v48, v49
    v_rcp_f32 v13, v12
    v_rcp_f32 v49, v48
    v_rcp_f32 v12, v12
    v_rcp_f32 v48, v48
    s_nop 0
    v_accvgpr_read_b32 v68, a0
    v_accvgpr_read_b32 v69, a1
    v_accvgpr_read_b32 v70, a2
    v_accvgpr_read_b32 v71, a3
    v_accvgpr_read_b32 v72, a16
    v_accvgpr_read_b32 v73, a17
    v_accvgpr_read_b32 v74, a18
    v_accvgpr_read_b32 v75, a19
    v_pk_mul_f32 v[68:69], v[68:69], v[12:13]
    v_pk_mul_f32 v[70:71], v[70:71], v[12:13]
    v_pk_mul_f32 v[72:73], v[72:73], v[12:13]
    v_pk_mul_f32 v[74:75], v[74:75], v[12:13]
    v_cvt_pk_bf16_f32 v64, v68, v69
    v_cvt_pk_bf16_f32 v65, v70, v71
    v_cvt_pk_bf16_f32 v66, v72, v73
    v_cvt_pk_bf16_f32 v67, v74, v75
    buffer_store_dwordx4 v[64:67], v1, s[24:27], s44 offen offset:0 sc1
    v_accvgpr_read_b32 v80, a32
    v_accvgpr_read_b32 v81, a33
    v_accvgpr_read_b32 v82, a34
    v_accvgpr_read_b32 v83, a35
    v_accvgpr_read_b32 v84, a48
    v_accvgpr_read_b32 v85, a49
    v_accvgpr_read_b32 v86, a50
    v_accvgpr_read_b32 v87, a51
    v_pk_mul_f32 v[80:81], v[80:81], v[12:13]
    v_pk_mul_f32 v[82:83], v[82:83], v[12:13]
    v_pk_mul_f32 v[84:85], v[84:85], v[12:13]
    v_pk_mul_f32 v[86:87], v[86:87], v[12:13]
    v_cvt_pk_bf16_f32 v76, v80, v81
    v_cvt_pk_bf16_f32 v77, v82, v83
    v_cvt_pk_bf16_f32 v78, v84, v85
    v_cvt_pk_bf16_f32 v79, v86, v87
    buffer_store_dwordx4 v[76:79], v1, s[24:27], s45 offen offset:0 sc1
    v_accvgpr_read_b32 v68, a64
    v_accvgpr_read_b32 v69, a65
    v_accvgpr_read_b32 v70, a66
    v_accvgpr_read_b32 v71, a67
    v_accvgpr_read_b32 v72, a80
    v_accvgpr_read_b32 v73, a81
    v_accvgpr_read_b32 v74, a82
    v_accvgpr_read_b32 v75, a83
    v_pk_mul_f32 v[68:69], v[68:69], v[12:13]
    v_pk_mul_f32 v[70:71], v[70:71], v[12:13]
    v_pk_mul_f32 v[72:73], v[72:73], v[12:13]
    v_pk_mul_f32 v[74:75], v[74:75], v[12:13]
    v_cvt_pk_bf16_f32 v64, v68, v69
    v_cvt_pk_bf16_f32 v65, v70, v71
    v_cvt_pk_bf16_f32 v66, v72, v73
    v_cvt_pk_bf16_f32 v67, v74, v75
    buffer_store_dwordx4 v[64:67], v1, s[24:27], s46 offen offset:0 sc1
    v_accvgpr_read_b32 v80, a96
    v_accvgpr_read_b32 v81, a97
    v_accvgpr_read_b32 v82, a98
    v_accvgpr_read_b32 v83, a99
    v_accvgpr_read_b32 v84, a112
    v_accvgpr_read_b32 v85, a113
    v_accvgpr_read_b32 v86, a114
    v_accvgpr_read_b32 v87, a115
    v_pk_mul_f32 v[80:81], v[80:81], v[12:13]
    v_pk_mul_f32 v[82:83], v[82:83], v[12:13]
    v_pk_mul_f32 v[84:85], v[84:85], v[12:13]
    v_pk_mul_f32 v[86:87], v[86:87], v[12:13]
    v_cvt_pk_bf16_f32 v76, v80, v81
    v_cvt_pk_bf16_f32 v77, v82, v83
    v_cvt_pk_bf16_f32 v78, v84, v85
    v_cvt_pk_bf16_f32 v79, v86, v87
    buffer_store_dwordx4 v[76:79], v1, s[24:27], s47 offen offset:0 sc1
    v_accvgpr_read_b32 v68, a4
    v_accvgpr_read_b32 v69, a5
    v_accvgpr_read_b32 v70, a6
    v_accvgpr_read_b32 v71, a7
    v_accvgpr_read_b32 v72, a20
    v_accvgpr_read_b32 v73, a21
    v_accvgpr_read_b32 v74, a22
    v_accvgpr_read_b32 v75, a23
    v_pk_mul_f32 v[68:69], v[68:69], v[48:49]
    v_pk_mul_f32 v[70:71], v[70:71], v[48:49]
    v_pk_mul_f32 v[72:73], v[72:73], v[48:49]
    v_pk_mul_f32 v[74:75], v[74:75], v[48:49]
    v_cvt_pk_bf16_f32 v64, v68, v69
    v_cvt_pk_bf16_f32 v65, v70, v71
    v_cvt_pk_bf16_f32 v66, v72, v73
    v_cvt_pk_bf16_f32 v67, v74, v75
    buffer_store_dwordx4 v[64:67], v1, s[24:27], s44 offen offset:1024 sc1
    v_accvgpr_read_b32 v80, a36
    v_accvgpr_read_b32 v81, a37
    v_accvgpr_read_b32 v82, a38
    v_accvgpr_read_b32 v83, a39
    v_accvgpr_read_b32 v84, a52
    v_accvgpr_read_b32 v85, a53
    v_accvgpr_read_b32 v86, a54
    v_accvgpr_read_b32 v87, a55
    v_pk_mul_f32 v[80:81], v[80:81], v[48:49]
    v_pk_mul_f32 v[82:83], v[82:83], v[48:49]
    v_pk_mul_f32 v[84:85], v[84:85], v[48:49]
    v_pk_mul_f32 v[86:87], v[86:87], v[48:49]
    v_cvt_pk_bf16_f32 v76, v80, v81
    v_cvt_pk_bf16_f32 v77, v82, v83
    v_cvt_pk_bf16_f32 v78, v84, v85
    v_cvt_pk_bf16_f32 v79, v86, v87
    buffer_store_dwordx4 v[76:79], v1, s[24:27], s45 offen offset:1024 sc1
    v_accvgpr_read_b32 v68, a68
    v_accvgpr_read_b32 v69, a69
    v_accvgpr_read_b32 v70, a70
    v_accvgpr_read_b32 v71, a71
    v_accvgpr_read_b32 v72, a84
    v_accvgpr_read_b32 v73, a85
    v_accvgpr_read_b32 v74, a86
    v_accvgpr_read_b32 v75, a87
    v_pk_mul_f32 v[68:69], v[68:69], v[48:49]
    v_pk_mul_f32 v[70:71], v[70:71], v[48:49]
    v_pk_mul_f32 v[72:73], v[72:73], v[48:49]
    v_pk_mul_f32 v[74:75], v[74:75], v[48:49]
    v_cvt_pk_bf16_f32 v64, v68, v69
    v_cvt_pk_bf16_f32 v65, v70, v71
    v_cvt_pk_bf16_f32 v66, v72, v73
    v_cvt_pk_bf16_f32 v67, v74, v75
    buffer_store_dwordx4 v[64:67], v1, s[24:27], s46 offen offset:1024 sc1
    v_accvgpr_read_b32 v80, a100
    v_accvgpr_read_b32 v81, a101
    v_accvgpr_read_b32 v82, a102
    v_accvgpr_read_b32 v83, a103
    v_accvgpr_read_b32 v84, a116
    v_accvgpr_read_b32 v85, a117
    v_accvgpr_read_b32 v86, a118
    v_accvgpr_read_b32 v87, a119
    v_pk_mul_f32 v[80:81], v[80:81], v[48:49]
    v_pk_mul_f32 v[82:83], v[82:83], v[48:49]
    v_pk_mul_f32 v[84:85], v[84:85], v[48:49]
    v_pk_mul_f32 v[86:87], v[86:87], v[48:49]
    v_cvt_pk_bf16_f32 v76, v80, v81
    v_cvt_pk_bf16_f32 v77, v82, v83
    v_cvt_pk_bf16_f32 v78, v84, v85
    v_cvt_pk_bf16_f32 v79, v86, v87
    buffer_store_dwordx4 v[76:79], v1, s[24:27], s47 offen offset:1024 sc1
    s_lshl_b32 s63, s29, 1
    s_sub_u32 s63, 14, s63
    s_cmp_eq_u32 s63, 0
    s_cbranch_scc1 k2_sdone_100
k2_sloop_99:
    v_mfma_f32_16x16x32_bf16 v[248:251], v[60:63], v[192:195], v[248:251]
    ds_read_b128 a[224:227], v3 offset:8192
    v_mfma_f32_16x16x32_bf16 v[252:255], v[60:63], v[196:199], v[252:255]
    s_mov_b32 m0, s35
    v_exp_f32 v232, v160
    v_mfma_f32_16x16x32_bf16 v[248:251], v[60:63], v[200:203], v[248:251]
    s_add_u32 s53, s53, 16384
    buffer_load_dwordx4 v1, s[20:23], s33 offen offset:0 sc1 lds
    ds_read_b128 a[228:231], v3 offset:9216
    v_mfma_f32_16x16x32_bf16 v[252:255], v[60:63], v[204:207], v[252:255]
    s_waitcnt lgkmcnt(8)
    v_exp_f32 v233, v161
    v_mfma_f32_16x16x32_bf16 a[8:11], a[192:195], v[192:195], a[8:11]
    s_and_b32 s53, s53, 0xffff
    ds_read_b128 a[232:235], v3 offset:10240
    v_cvt_pk_bf16_f32 v208, v232, v233
    v_mfma_f32_16x16x32_bf16 a[12:15], a[192:195], v[196:199], a[12:15]
    v_exp_f32 v234, v162
    v_mfma_f32_16x16x32_bf16 a[24:27], a[196:199], v[192:195], a[24:27]
    ds_read_b128 a[236:239], v3 offset:11264
    v_mfma_f32_16x16x32_bf16 a[28:31], a[196:199], v[196:199], a[28:31]
    s_waitcnt lgkmcnt(8)
    v_exp_f32 v235, v163
    v_mfma_f32_16x16x32_bf16 a[40:43], a[200:203], v[192:195], a[40:43]
    s_add_u32 s35, s35, 0x4000
    ds_read_b128 a[240:243], v3 offset:12288
    v_cvt_pk_bf16_f32 v209, v234, v235
    v_mfma_f32_16x16x32_bf16 a[44:47], a[200:203], v[196:199], a[44:47]
    v_exp_f32 v236, v176
    v_mfma_f32_16x16x32_bf16 a[56:59], a[204:207], v[192:195], a[56:59]
    buffer_load_dwordx4 v1, s[20:23], s33 offen offset:1024 sc1 lds
    ds_read_b128 a[244:247], v3 offset:13312
    v_mfma_f32_16x16x32_bf16 a[60:63], a[204:207], v[196:199], a[60:63]
    s_waitcnt lgkmcnt(8)
    v_exp_f32 v237, v177
    v_mfma_f32_16x16x32_bf16 a[72:75], a[208:211], v[192:195], a[72:75]
    ds_read_b128 a[248:251], v3 offset:14336
    v_cvt_pk_bf16_f32 v210, v236, v237
    v_mfma_f32_16x16x32_bf16 a[76:79], a[208:211], v[196:199], a[76:79]
    v_exp_f32 v238, v178
    v_mfma_f32_16x16x32_bf16 a[88:91], a[212:215], v[192:195], a[88:91]
    ds_read_b128 a[252:255], v3 offset:15360
    v_or3_b32 v57, v208, v209, v210
    v_mfma_f32_16x16x32_bf16 a[92:95], a[212:215], v[196:199], a[92:95]
    s_waitcnt lgkmcnt(8)
    v_exp_f32 v239, v179
    v_mfma_f32_16x16x32_bf16 a[104:107], a[216:219], v[192:195], a[104:107]
    s_and_b32 s35, s35, 0xffff
    v_exp_f32 v240, v164
    v_mfma_f32_16x16x32_bf16 a[108:111], a[216:219], v[196:199], a[108:111]
    ds_read_b128 a[128:131], v2 offset:0
    v_cvt_pk_bf16_f32 v211, v238, v239
    v_mfma_f32_16x16x32_bf16 a[120:123], a[220:223], v[192:195], a[120:123]
    v_exp_f32 v241, v165
    v_mfma_f32_16x16x32_bf16 a[124:127], a[220:223], v[196:199], a[124:127]
    s_waitcnt lgkmcnt(7)
    buffer_load_dwordx4 v1, s[20:23], s33 offen offset:2048 sc1 lds
    ds_read_b128 a[132:135], v2 offset:1024
    v_mfma_f32_16x16x32_bf16 a[8:11], a[224:227], v[200:203], a[8:11]
    v_add_u32 v3, s53, v56
    v_cvt_pk_bf16_f32 v212, v240, v241
    v_mfma_f32_16x16x32_bf16 a[12:15], a[224:227], v[204:207], a[12:15]
    s_or_b32 s35, s35, 0x10000
    v_exp_f32 v242, v166
    v_mfma_f32_16x16x32_bf16 a[24:27], a[228:231], v[200:203], a[24:27]
    ds_read_b128 a[136:139], v2 offset:2048
    v_or3_b32 v57, v57, v211, v212
    v_mfma_f32_16x16x32_bf16 a[28:31], a[228:231], v[204:207], a[28:31]
    s_waitcnt lgkmcnt(7)
    v_exp_f32 v243, v167
    v_mfma_f32_16x16x32_bf16 a[40:43], a[232:235], v[200:203], a[40:43]
    ds_read_b128 a[140:143], v2 offset:3072
    v_cvt_pk_bf16_f32 v213, v242, v243
    v_mfma_f32_16x16x32_bf16 a[44:47], a[232:235], v[204:207], a[44:47]
    s_cmp_ge_u32 s36, s43
    s_cbranch_scc1 k2_prep_101
k2_prepret_102:
    v_mfma_f32_16x16x32_bf16 a[56:59], a[236:239], v[200:203], a[56:59]
    v_exp_f32 v244, v180
    v_mfma_f32_16x16x32_bf16 a[60:63], a[236:239], v[204:207], a[60:63]
    s_waitcnt lgkmcnt(6)
    buffer_load_dwordx4 v1, s[20:23], s33 offen offset:3072 sc1 lds
    ds_read_b128 a[144:147], v2 offset:4096
    v_mfma_f32_16x16x32_bf16 a[72:75], a[240:243], v[200:203], a[72:75]
    s_add_u32 s33, s33, 0x80000
    v_exp_f32 v245, v181
    v_mfma_f32_16x16x32_bf16 a[76:79], a[240:243], v[204:207], a[76:79]
    ds_read_b128 a[148:151], v2 offset:5120
    v_cvt_pk_bf16_f32 v214, v244, v245
    v_mfma_f32_16x16x32_bf16 a[88:91], a[244:247], v[200:203], a[88:91]
    v_exp_f32 v246, v182
    v_mfma_f32_16x16x32_bf16 a[92:95], a[244:247], v[204:207], a[92:95]
    s_waitcnt lgkmcnt(6)
    ds_read_b128 a[152:155], v2 offset:6144
    v_or3_b32 v57, v57, v213, v214
    v_mfma_f32_16x16x32_bf16 a[104:107], a[248:251], v[200:203], a[104:107]
    v_exp_f32 v247, v183
    v_mfma_f32_16x16x32_bf16 a[108:111], a[248:251], v[204:207], a[108:111]
    ds_read_b128 a[156:159], v2 offset:7168
    v_cvt_pk_bf16_f32 v215, v246, v247
    v_mfma_f32_16x16x32_bf16 a[120:123], a[252:255], v[200:203], a[120:123]
    v_exp_f32 v232, v168
    v_mfma_f32_16x16x32_bf16 a[124:127], a[252:255], v[204:207], a[124:127]
    s_waitcnt lgkmcnt(6)
    ds_read_b128 a[160:163], v2 offset:8192
    ds_read_b128 a[164:167], v2 offset:9216
    v_mfma_f32_16x16x32_bf16 v[128:131], a[128:131], v[96:99], v[16:19]
    s_waitcnt vmcnt(12)
    s_barrier
    v_exp_f32 v233, v169
    v_mfma_f32_16x16x32_bf16 v[132:135], a[128:131], v[112:115], v[20:23]
    s_mov_b32 m0, s34
    v_exp_f32 v234, v170
    v_mfma_f32_16x16x32_bf16 v[128:131], a[132:135], v[100:103], v[128:131]
    ds_read_b128 a[168:171], v2 offset:10240
    v_cvt_pk_bf16_f32 v216, v232, v233
    v_mfma_f32_16x16x32_bf16 v[132:135], a[132:135], v[116:119], v[132:135]
    s_waitcnt lgkmcnt(7)
    buffer_load_dwordx4 v1, s[16:19], s32 offen offset:0 sc1 lds
    ds_read_b128 a[172:175], v2 offset:11264
    v_mfma_f32_16x16x32_bf16 v[128:131], a[136:139], v[104:107], v[128:131]
    s_add_u32 s36, s36, 64
    v_exp_f32 v235, v171
    v_mfma_f32_16x16x32_bf16 v[132:135], a[136:139], v[120:123], v[132:135]
    v_or3_b32 v57, v57, v215, v216
    v_cvt_pk_bf16_f32 v217, v234, v235
    v_mfma_f32_16x16x32_bf16 v[128:131], a[140:143], v[108:111], v[128:131]
    v_exp_f32 v236, v184
    v_mfma_f32_16x16x32_bf16 v[132:135], a[140:143], v[124:127], v[132:135]
    s_waitcnt lgkmcnt(6)
    ds_read_b128 a[176:179], v2 offset:12288
    ds_read_b128 a[180:183], v2 offset:13312
    v_mfma_f32_16x16x32_bf16 v[144:147], a[144:147], v[96:99], v[32:35]
    s_add_u32 s34, s34, 0x4000
    v_exp_f32 v237, v185
    v_mfma_f32_16x16x32_bf16 v[148:151], a[144:147], v[112:115], v[36:39]
    s_add_u32 s52, s52, 16384
    v_exp_f32 v238, v186
    v_mfma_f32_16x16x32_bf16 v[144:147], a[148:151], v[100:103], v[144:147]
    s_and_b32 s52, s52, 0xffff
    ds_read_b128 a[184:187], v2 offset:14336
    v_cvt_pk_bf16_f32 v218, v236, v237
    v_mfma_f32_16x16x32_bf16 v[148:151], a[148:151], v[116:119], v[148:151]
    s_waitcnt lgkmcnt(7)
    buffer_load_dwordx4 v1, s[16:19], s32 offen offset:1024 sc1 lds
    ds_read_b128 a[188:191], v2 offset:15360
    v_mfma_f32_16x16x32_bf16 v[144:147], a[152:155], v[104:107], v[144:147]
    v_exp_f32 v239, v187
    v_mfma_f32_16x16x32_bf16 v[148:151], a[152:155], v[120:123], v[148:151]
    v_or3_b32 v57, v57, v217, v218
    v_cvt_pk_bf16_f32 v219, v238, v239
    v_mfma_f32_16x16x32_bf16 v[144:147], a[156:159], v[108:111], v[144:147]
    s_and_b32 s34, s34, 0xffff
    v_exp_f32 v240, v172
    v_mfma_f32_16x16x32_bf16 v[148:151], a[156:159], v[124:127], v[148:151]
    s_waitcnt lgkmcnt(6)
    v_exp_f32 v241, v173
    v_mfma_f32_16x16x32_bf16 v[136:139], a[160:163], v[96:99], v[24:27]
    ds_read_b128 a[192:195], v3 offset:0
    v_cvt_pk_bf16_f32 v220, v240, v241
    v_mfma_f32_16x16x32_bf16 v[140:143], a[160:163], v[112:115], v[28:31]
    v_exp_f32 v242, v174
    v_mfma_f32_16x16x32_bf16 v[136:139], a[164:167], v[100:103], v[136:139]
    buffer_load_dwordx4 v1, s[16:19], s32 offen offset:2048 sc1 lds
    ds_read_b128 a[196:199], v3 offset:1024
    v_mfma_f32_16x16x32_bf16 v[140:143], a[164:167], v[116:119], v[140:143]
    s_waitcnt lgkmcnt(6)
    v_add_u32 v2, s52, v1
    v_or3_b32 v57, v57, v219, v220
    v_mfma_f32_16x16x32_bf16 v[136:139], a[168:171], v[104:107], v[136:139]
    v_exp_f32 v243, v175
    v_mfma_f32_16x16x32_bf16 v[140:143], a[168:171], v[120:123], v[140:143]
    ds_read_b128 a[200:203], v3 offset:2048
    v_cvt_pk_bf16_f32 v221, v242, v243
    v_mfma_f32_16x16x32_bf16 v[136:139], a[172:175], v[108:111], v[136:139]
    v_exp_f32 v244, v188
    v_mfma_f32_16x16x32_bf16 v[140:143], a[172:175], v[124:127], v[140:143]
    s_waitcnt lgkmcnt(5)
    ds_read_b128 a[204:207], v3 offset:3072
    ds_read_b128 a[208:211], v3 offset:4096
    v_mfma_f32_16x16x32_bf16 v[152:155], a[176:179], v[96:99], v[40:43]
    v_exp_f32 v245, v189
    v_mfma_f32_16x16x32_bf16 v[156:159], a[176:179], v[112:115], v[44:47]
    buffer_load_dwordx4 v1, s[16:19], s32 offen offset:3072 sc1 lds
    ds_read_b128 a[212:215], v3 offset:5120
    v_mfma_f32_16x16x32_bf16 v[152:155], a[180:183], v[100:103], v[152:155]
    s_add_u32 s32, s32, 0x80000
    v_exp_f32 v246, v190
    v_mfma_f32_16x16x32_bf16 v[156:159], a[180:183], v[116:119], v[156:159]
    s_waitcnt lgkmcnt(6)
    ds_read_b128 a[216:219], v3 offset:6144
    v_cvt_pk_bf16_f32 v222, v244, v245
    v_mfma_f32_16x16x32_bf16 v[152:155], a[184:187], v[104:107], v[152:155]
    v_exp_f32 v247, v191
    v_mfma_f32_16x16x32_bf16 v[156:159], a[184:187], v[120:123], v[156:159]
    ds_read_b128 a[220:223], v3 offset:7168
    v_or3_b32 v57, v57, v221, v222
    v_mfma_f32_16x16x32_bf16 v[152:155], a[188:191], v[108:111], v[152:155]
    v_cvt_pk_bf16_f32 v223, v246, v247
    v_bitop3_b32 v57, v57, v223, s37 bitop3:0xa8
    v_mfma_f32_16x16x32_bf16 v[156:159], a[188:191], v[124:127], v[156:159]
    v_cmp_ne_u32 vcc, 0, v57
    s_cbranch_vccnz k2_rare_103
k2_ret_104:
    v_mfma_f32_16x16x32_bf16 v[248:251], v[60:63], v[208:211], v[248:251]
    ds_read_b128 a[224:227], v3 offset:8192
    v_mfma_f32_16x16x32_bf16 v[252:255], v[60:63], v[212:215], v[252:255]
    s_mov_b32 m0, s35
    v_exp_f32 v232, v128
    v_mfma_f32_16x16x32_bf16 v[248:251], v[60:63], v[216:219], v[248:251]
    s_add_u32 s53, s53, 16384
    buffer_load_dwordx4 v1, s[20:23], s33 offen offset:0 sc1 lds
    ds_read_b128 a[228:231], v3 offset:9216
    v_mfma_f32_16x16x32_bf16 v[252:255], v[60:63], v[220:223], v[252:255]
    s_waitcnt lgkmcnt(8)
    v_exp_f32 v233, v129
    v_mfma_f32_16x16x32_bf16 a[8:11], a[192:195], v[208:211], a[8:11]
    s_and_b32 s53, s53, 0xffff
    ds_read_b128 a[232:235], v3 offset:10240
    v_cvt_pk_bf16_f32 v192, v232, v233
    v_mfma_f32_16x16x32_bf16 a[12:15], a[192:195], v[212:215], a[12:15]
    v_exp_f32 v234, v130
    v_mfma_f32_16x16x32_bf16 a[24:27], a[196:199], v[208:211], a[24:27]
    ds_read_b128 a[236:239], v3 offset:11264
    v_mfma_f32_16x16x32_bf16 a[28:31], a[196:199], v[212:215], a[28:31]
    s_waitcnt lgkmcnt(8)
    v_exp_f32 v235, v131
    v_mfma_f32_16x16x32_bf16 a[40:43], a[200:203], v[208:211], a[40:43]
    s_add_u32 s35, s35, 0x4000
    ds_read_b128 a[240:243], v3 offset:12288
    v_cvt_pk_bf16_f32 v193, v234, v235
    v_mfma_f32_16x16x32_bf16 a[44:47], a[200:203], v[212:215], a[44:47]
    v_exp_f32 v236, v144
    v_mfma_f32_16x16x32_bf16 a[56:59], a[204:207], v[208:211], a[56:59]
    buffer_load_dwordx4 v1, s[20:23], s33 offen offset:1024 sc1 lds
    ds_read_b128 a[244:247], v3 offset:13312
    v_mfma_f32_16x16x32_bf16 a[60:63], a[204:207], v[212:215], a[60:63]
    s_waitcnt lgkmcnt(8)
    v_exp_f32 v237, v145
    v_mfma_f32_16x16x32_bf16 a[72:75], a[208:211], v[208:211], a[72:75]
    ds_read_b128 a[248:251], v3 offset:14336
    v_cvt_pk_bf16_f32 v194, v236, v237
    v_mfma_f32_16x16x32_bf16 a[76:79], a[208:211], v[212:215], a[76:79]
    v_exp_f32 v238, v146
    v_mfma_f32_16x16x32_bf16 a[88:91], a[212:215], v[208:211], a[88:91]
    ds_read_b128 a[252:255], v3 offset:15360
    v_or3_b32 v57, v192, v193, v194
    v_mfma_f32_16x16x32_bf16 a[92:95], a[212:215], v[212:215], a[92:95]
    s_waitcnt lgkmcnt(8)
    v_exp_f32 v239, v147
    v_mfma_f32_16x16x32_bf16 a[104:107], a[216:219], v[208:211], a[104:107]
    s_and_b32 s35, s35, 0xffff
    v_exp_f32 v240, v132
    v_mfma_f32_16x16x32_bf16 a[108:111], a[216:219], v[212:215], a[108:111]
    ds_read_b128 a[128:131], v2 offset:0
    v_cvt_pk_bf16_f32 v195, v238, v239
    v_mfma_f32_16x16x32_bf16 a[120:123], a[220:223], v[208:211], a[120:123]
    v_exp_f32 v241, v133
    v_mfma_f32_16x16x32_bf16 a[124:127], a[220:223], v[212:215], a[124:127]
    s_waitcnt lgkmcnt(7)
    buffer_load_dwordx4 v1, s[20:23], s33 offen offset:2048 sc1 lds
    ds_read_b128 a[132:135], v2 offset:1024
    v_mfma_f32_16x16x32_bf16 a[8:11], a[224:227], v[216:219], a[8:11]
    v_add_u32 v3, s53, v56
    v_cvt_pk_bf16_f32 v196, v240, v241
    v_mfma_f32_16x16x32_bf16 a[12:15], a[224:227], v[220:223], a[12:15]
    s_or_b32 s35, s35, 0x10000
    v_exp_f32 v242, v134
    v_mfma_f32_16x16x32_bf16 a[24:27], a[228:231], v[216:219], a[24:27]
    ds_read_b128 a[136:139], v2 offset:2048
    v_or3_b32 v57, v57, v195, v196
    v_mfma_f32_16x16x32_bf16 a[28:31], a[228:231], v[220:223], a[28:31]
    s_waitcnt lgkmcnt(7)
    v_exp_f32 v243, v135
    v_mfma_f32_16x16x32_bf16 a[40:43], a[232:235], v[216:219], a[40:43]
    ds_read_b128 a[140:143], v2 offset:3072
    v_cvt_pk_bf16_f32 v197, v242, v243
    v_mfma_f32_16x16x32_bf16 a[44:47], a[232:235], v[220:223], a[44:47]
    s_cmp_ge_u32 s36, s43
    s_cbranch_scc1 k2_prep_105
k2_prepret_106:
    v_mfma_f32_16x16x32_bf16 a[56:59], a[236:239], v[216:219], a[56:59]
    v_exp_f32 v244, v148
    v_mfma_f32_16x16x32_bf16 a[60:63], a[236:239], v[220:223], a[60:63]
    s_waitcnt lgkmcnt(6)
    buffer_load_dwordx4 v1, s[20:23], s33 offen offset:3072 sc1 lds
    ds_read_b128 a[144:147], v2 offset:4096
    v_mfma_f32_16x16x32_bf16 a[72:75], a[240:243], v[216:219], a[72:75]
    s_add_u32 s33, s33, 0x80000
    v_exp_f32 v245, v149
    v_mfma_f32_16x16x32_bf16 a[76:79], a[240:243], v[220:223], a[76:79]
    ds_read_b128 a[148:151], v2 offset:5120
    v_cvt_pk_bf16_f32 v198, v244, v245
    v_mfma_f32_16x16x32_bf16 a[88:91], a[244:247], v[216:219], a[88:91]
    v_exp_f32 v246, v150
    v_mfma_f32_16x16x32_bf16 a[92:95], a[244:247], v[220:223], a[92:95]
    s_waitcnt lgkmcnt(6)
    ds_read_b128 a[152:155], v2 offset:6144
    v_or3_b32 v57, v57, v197, v198
    v_mfma_f32_16x16x32_bf16 a[104:107], a[248:251], v[216:219], a[104:107]
    v_exp_f32 v247, v151
    v_mfma_f32_16x16x32_bf16 a[108:111], a[248:251], v[220:223], a[108:111]
    ds_read_b128 a[156:159], v2 offset:7168
    v_cvt_pk_bf16_f32 v199, v246, v247
    v_mfma_f32_16x16x32_bf16 a[120:123], a[252:255], v[216:219], a[120:123]
    v_exp_f32 v232, v136
    v_mfma_f32_16x16x32_bf16 a[124:127], a[252:255], v[220:223], a[124:127]
    s_waitcnt lgkmcnt(6)
    ds_read_b128 a[160:163], v2 offset:8192
    ds_read_b128 a[164:167], v2 offset:9216
    v_mfma_f32_16x16x32_bf16 v[160:163], a[128:131], v[96:99], v[16:19]
    s_waitcnt vmcnt(12)
    s_barrier
    v_exp_f32 v233, v137
    v_mfma_f32_16x16x32_bf16 v[164:167], a[128:131], v[112:115], v[20:23]
    s_mov_b32 m0, s34
    v_exp_f32 v234, v138
    v_mfma_f32_16x16x32_bf16 v[160:163], a[132:135], v[100:103], v[160:163]
    ds_read_b128 a[168:171], v2 offset:10240
    v_cvt_pk_bf16_f32 v200, v232, v233
    v_mfma_f32_16x16x32_bf16 v[164:167], a[132:135], v[116:119], v[164:167]
    s_waitcnt lgkmcnt(7)
    buffer_load_dwordx4 v1, s[16:19], s32 offen offset:0 sc1 lds
    ds_read_b128 a[172:175], v2 offset:11264
    v_mfma_f32_16x16x32_bf16 v[160:163], a[136:139], v[104:107], v[160:163]
    s_add_u32 s36, s36, 64
    v_exp_f32 v235, v139
    v_mfma_f32_16x16x32_bf16 v[164:167], a[136:139], v[120:123], v[164:167]
    v_or3_b32 v57, v57, v199, v200
    v_cvt_pk_bf16_f32 v201, v234, v235
    v_mfma_f32_16x16x32_bf16 v[160:163], a[140:143], v[108:111], v[160:163]
    v_exp_f32 v236, v152
    v_mfma_f32_16x16x32_bf16 v[164:167], a[140:143], v[124:127], v[164:167]
    s_waitcnt lgkmcnt(6)
    ds_read_b128 a[176:179], v2 offset:12288
    ds_read_b128 a[180:183], v2 offset:13312
    v_mfma_f32_16x16x32_bf16 v[176:179], a[144:147], v[96:99], v[32:35]
    s_add_u32 s34, s34, 0x4000
    v_exp_f32 v237, v153
    v_mfma_f32_16x16x32_bf16 v[180:183], a[144:147], v[112:115], v[36:39]
    s_add_u32 s52, s52, 16384
    v_exp_f32 v238, v154
    v_mfma_f32_16x16x32_bf16 v[176:179], a[148:151], v[100:103], v[176:179]
    s_and_b32 s52, s52, 0xffff
    ds_read_b128 a[184:187], v2 offset:14336
    v_cvt_pk_bf16_f32 v202, v236, v237
    v_mfma_f32_16x16x32_bf16 v[180:183], a[148:151], v[116:119], v[180:183]
    s_waitcnt lgkmcnt(7)
    buffer_load_dwordx4 v1, s[16:19], s32 offen offset:1024 sc1 lds
    ds_read_b128 a[188:191], v2 offset:15360
    v_mfma_f32_16x16x32_bf16 v[176:179], a[152:155], v[104:107], v[176:179]
    v_exp_f32 v239, v155
    v_mfma_f32_16x16x32_bf16 v[180:183], a[152:155], v[120:123], v[180:183]
    v_or3_b32 v57, v57, v201, v202
    v_cvt_pk_bf16_f32 v203, v238, v239
    v_mfma_f32_16x16x32_bf16 v[176:179], a[156:159], v[108:111], v[176:179]
    s_and_b32 s34, s34, 0xffff
    v_exp_f32 v240, v140
    v_mfma_f32_16x16x32_bf16 v[180:183], a[156:159], v[124:127], v[180:183]
    s_waitcnt lgkmcnt(6)
    v_exp_f32 v241, v141
    v_mfma_f32_16x16x32_bf16 v[168:171], a[160:163], v[96:99], v[24:27]
    ds_read_b128 a[192:195], v3 offset:0
    v_cvt_pk_bf16_f32 v204, v240, v241
    v_mfma_f32_16x16x32_bf16 v[172:175], a[160:163], v[112:115], v[28:31]
    v_exp_f32 v242, v142
    v_mfma_f32_16x16x32_bf16 v[168:171], a[164:167], v[100:103], v[168:171]
    buffer_load_dwordx4 v1, s[16:19], s32 offen offset:2048 sc1 lds
    ds_read_b128 a[196:199], v3 offset:1024
    v_mfma_f32_16x16x32_bf16 v[172:175], a[164:167], v[116:119], v[172:175]
    s_waitcnt lgkmcnt(6)
    v_add_u32 v2, s52, v1
    v_or3_b32 v57, v57, v203, v204
    v_mfma_f32_16x16x32_bf16 v[168:171], a[168:171], v[104:107], v[168:171]
    v_exp_f32 v243, v143
    v_mfma_f32_16x16x32_bf16 v[172:175], a[168:171], v[120:123], v[172:175]
    ds_read_b128 a[200:203], v3 offset:2048
    v_cvt_pk_bf16_f32 v205, v242, v243
    v_mfma_f32_16x16x32_bf16 v[168:171], a[172:175], v[108:111], v[168:171]
    v_exp_f32 v244, v156
    v_mfma_f32_16x16x32_bf16 v[172:175], a[172:175], v[124:127], v[172:175]
    s_waitcnt lgkmcnt(5)
    ds_read_b128 a[204:207], v3 offset:3072
    ds_read_b128 a[208:211], v3 offset:4096
    v_mfma_f32_16x16x32_bf16 v[184:187], a[176:179], v[96:99], v[40:43]
    s_sub_u32 s63, s63, 1
    v_exp_f32 v245, v157
    v_mfma_f32_16x16x32_bf16 v[188:191], a[176:179], v[112:115], v[44:47]
    buffer_load_dwordx4 v1, s[16:19], s32 offen offset:3072 sc1 lds
    ds_read_b128 a[212:215], v3 offset:5120
    v_mfma_f32_16x16x32_bf16 v[184:187], a[180:183], v[100:103], v[184:187]
    s_add_u32 s32, s32, 0x80000
    v_exp_f32 v246, v158
    v_mfma_f32_16x16x32_bf16 v[188:191], a[180:183], v[116:119], v[188:191]
    s_waitcnt lgkmcnt(6)
    ds_read_b128 a[216:219], v3 offset:6144
    v_cvt_pk_bf16_f32 v206, v244, v245
    v_mfma_f32_16x16x32_bf16 v[184:187], a[184:187], v[104:107], v[184:187]
    v_exp_f32 v247, v159
    v_mfma_f32_16x16x32_bf16 v[188:191], a[184:187], v[120:123], v[188:191]
    ds_read_b128 a[220:223], v3 offset:7168
    v_or3_b32 v57, v57, v205, v206
    v_mfma_f32_16x16x32_bf16 v[184:187], a[188:191], v[108:111], v[184:187]
    v_cvt_pk_bf16_f32 v207, v246, v247
    v_bitop3_b32 v57, v57, v207, s37 bitop3:0xa8
    v_mfma_f32_16x16x32_bf16 v[188:191], a[188:191], v[124:127], v[188:191]
    v_cmp_ne_u32 vcc, 0, v57
    s_cbranch_vccnz k2_rare_107
k2_ret_108:
    s_cmp_lg_u32 s63, 0
    s_cbranch_scc1 k2_sloop_99
k2_sdone_100:
    v_mfma_f32_16x16x32_bf16 v[248:251], v[60:63], v[192:195], v[248:251]
    s_waitcnt vmcnt(0)
    s_barrier
    ds_read_b128 a[224:227], v3 offset:8192
    v_exp_f32 v232, v160
    v_mfma_f32_16x16x32_bf16 v[252:255], v[60:63], v[196:199], v[252:255]
    ds_read_b128 a[228:231], v3 offset:9216
    v_exp_f32 v233, v161
    v_mfma_f32_16x16x32_bf16 v[248:251], v[60:63], v[200:203], v[248:251]
    s_add_u32 s53, s53, 16384
    v_exp_f32 v234, v162
    v_cvt_pk_bf16_f32 v208, v232, v233
    v_mfma_f32_16x16x32_bf16 v[252:255], v[60:63], v[204:207], v[252:255]
    s_waitcnt lgkmcnt(8)
    ds_read_b128 a[232:235], v3 offset:10240
    v_exp_f32 v235, v163
    v_mfma_f32_16x16x32_bf16 a[8:11], a[192:195], v[192:195], a[8:11]
    s_and_b32 s53, s53, 0xffff
    v_exp_f32 v236, v176
    v_cvt_pk_bf16_f32 v209, v234, v235
    v_mfma_f32_16x16x32_bf16 a[12:15], a[192:195], v[196:199], a[12:15]
    ds_read_b128 a[236:239], v3 offset:11264
    v_exp_f32 v237, v177
    v_mfma_f32_16x16x32_bf16 a[24:27], a[196:199], v[192:195], a[24:27]
    v_exp_f32 v238, v178
    v_cvt_pk_bf16_f32 v210, v236, v237
    v_mfma_f32_16x16x32_bf16 a[28:31], a[196:199], v[196:199], a[28:31]
    s_waitcnt lgkmcnt(8)
    v_exp_f32 v239, v179
    v_or3_b32 v57, v208, v209, v210
    v_mfma_f32_16x16x32_bf16 a[40:43], a[200:203], v[192:195], a[40:43]
    ds_read_b128 a[240:243], v3 offset:12288
    v_exp_f32 v240, v164
    v_mfma_f32_16x16x32_bf16 a[44:47], a[200:203], v[196:199], a[44:47]
    v_cvt_pk_bf16_f32 v211, v238, v239
    v_exp_f32 v241, v165
    v_mfma_f32_16x16x32_bf16 a[56:59], a[204:207], v[192:195], a[56:59]
    ds_read_b128 a[244:247], v3 offset:13312
    v_exp_f32 v242, v166
    v_mfma_f32_16x16x32_bf16 a[60:63], a[204:207], v[196:199], a[60:63]
    s_waitcnt lgkmcnt(8)
    v_cvt_pk_bf16_f32 v212, v240, v241
    v_exp_f32 v243, v167
    v_mfma_f32_16x16x32_bf16 a[72:75], a[208:211], v[192:195], a[72:75]
    ds_read_b128 a[248:251], v3 offset:14336
    v_or3_b32 v57, v57, v211, v212
    v_cvt_pk_bf16_f32 v213, v242, v243
    v_mfma_f32_16x16x32_bf16 a[76:79], a[208:211], v[196:199], a[76:79]
    ds_read_b128 a[252:255], v3 offset:15360
    v_exp_f32 v244, v180
    v_mfma_f32_16x16x32_bf16 a[88:91], a[212:215], v[192:195], a[88:91]
    v_exp_f32 v245, v181
    v_mfma_f32_16x16x32_bf16 a[92:95], a[212:215], v[196:199], a[92:95]
    s_waitcnt lgkmcnt(8)
    v_exp_f32 v246, v182
    v_cvt_pk_bf16_f32 v214, v244, v245
    v_mfma_f32_16x16x32_bf16 a[104:107], a[216:219], v[192:195], a[104:107]
    v_exp_f32 v247, v183
    v_or3_b32 v57, v57, v213, v214
    v_mfma_f32_16x16x32_bf16 a[108:111], a[216:219], v[196:199], a[108:111]
    v_exp_f32 v232, v168
    v_cvt_pk_bf16_f32 v215, v246, v247
    v_mfma_f32_16x16x32_bf16 a[120:123], a[220:223], v[192:195], a[120:123]
    v_exp_f32 v233, v169
    v_mfma_f32_16x16x32_bf16 a[124:127], a[220:223], v[196:199], a[124:127]
    s_waitcnt lgkmcnt(6)
    v_exp_f32 v234, v170
    v_cvt_pk_bf16_f32 v216, v232, v233
    v_mfma_f32_16x16x32_bf16 a[8:11], a[224:227], v[200:203], a[8:11]
    v_exp_f32 v235, v171
    v_or3_b32 v57, v57, v215, v216
    v_mfma_f32_16x16x32_bf16 a[12:15], a[224:227], v[204:207], a[12:15]
    v_add_u32 v3, s53, v56
    ds_read_b128 a[192:195], v3 offset:0
    ds_read_b128 a[196:199], v3 offset:1024
    v_mfma_f32_16x16x32_bf16 a[24:27], a[228:231], v[200:203], a[24:27]
    v_exp_f32 v236, v184
    v_cvt_pk_bf16_f32 v217, v234, v235
    v_mfma_f32_16x16x32_bf16 a[28:31], a[228:231], v[204:207], a[28:31]
    s_waitcnt lgkmcnt(6)
    ds_read_b128 a[200:203], v3 offset:2048
    v_exp_f32 v237, v185
    v_mfma_f32_16x16x32_bf16 a[40:43], a[232:235], v[200:203], a[40:43]
    ds_read_b128 a[204:207], v3 offset:3072
    v_exp_f32 v238, v186
    v_mfma_f32_16x16x32_bf16 a[44:47], a[232:235], v[204:207], a[44:47]
    v_cvt_pk_bf16_f32 v218, v236, v237
    v_exp_f32 v239, v187
    v_mfma_f32_16x16x32_bf16 a[56:59], a[236:239], v[200:203], a[56:59]
    ds_read_b128 a[208:211], v3 offset:4096
    v_or3_b32 v57, v57, v217, v218
    v_cvt_pk_bf16_f32 v219, v238, v239
    v_mfma_f32_16x16x32_bf16 a[60:63], a[236:239], v[204:207], a[60:63]
    s_waitcnt lgkmcnt(7)
    ds_read_b128 a[212:215], v3 offset:5120
    v_exp_f32 v240, v172
    v_mfma_f32_16x16x32_bf16 a[72:75], a[240:243], v[200:203], a[72:75]
    ds_read_b128 a[216:219], v3 offset:6144
    v_exp_f32 v241, v173
    v_mfma_f32_16x16x32_bf16 a[76:79], a[240:243], v[204:207], a[76:79]
    v_exp_f32 v242, v174
    v_cvt_pk_bf16_f32 v220, v240, v241
    v_mfma_f32_16x16x32_bf16 a[88:91], a[244:247], v[200:203], a[88:91]
    v_exp_f32 v243, v175
    v_or3_b32 v57, v57, v219, v220
    v_mfma_f32_16x16x32_bf16 a[92:95], a[244:247], v[204:207], a[92:95]
    s_waitcnt lgkmcnt(7)
    ds_read_b128 a[220:223], v3 offset:7168
    v_exp_f32 v244, v188
    v_mfma_f32_16x16x32_bf16 a[104:107], a[248:251], v[200:203], a[104:107]
    ds_read_b128 a[224:227], v3 offset:8192
    ds_read_b128 a[228:231], v3 offset:9216
    v_cvt_pk_bf16_f32 v221, v242, v243
    v_mfma_f32_16x16x32_bf16 a[108:111], a[248:251], v[204:207], a[108:111]
    ds_read_b128 a[232:235], v3 offset:10240
    v_exp_f32 v245, v189
    v_mfma_f32_16x16x32_bf16 a[120:123], a[252:255], v[200:203], a[120:123]
    v_exp_f32 v246, v190
    v_cvt_pk_bf16_f32 v222, v244, v245
    v_mfma_f32_16x16x32_bf16 a[124:127], a[252:255], v[204:207], a[124:127]
    v_exp_f32 v247, v191
    v_or3_b32 v57, v57, v221, v222
    v_cvt_pk_bf16_f32 v223, v246, v247
    v_bitop3_b32 v57, v57, v223, s37 bitop3:0xa8
    ds_read_b128 a[236:239], v3 offset:11264
    v_cmp_ne_u32 vcc, 0, v57
    ds_read_b128 a[240:243], v3 offset:12288
    ds_read_b128 a[244:247], v3 offset:13312
    ds_read_b128 a[248:251], v3 offset:14336
    ds_read_b128 a[252:255], v3 offset:15360
    s_cbranch_vccnz k2_rare_109
k2_ret_110:
    v_lshrrev_b32 v6, 4, v1
    v_and_b32 v6, 31, v6
    s_getpc_b64 s[40:41]
pc_111:
    s_add_u32 s40, s40, k3_kernel-pc_111
    s_addc_u32 s41, s41, 0
    v_lshlrev_b32 v224, 7, v6
    v_mov_b32 v225, s41
    v_add_co_u32 v224, vcc, s40, v224
    s_nop 1
    v_addc_co_u32 v225, vcc, 0, v225, vcc
    global_load_dword v7, v[224:225], off
    v_mfma_f32_16x16x32_bf16 v[248:251], v[60:63], v[208:211], v[248:251]
    s_lshl_b32 s31, s28, 19
    v_mfma_f32_16x16x32_bf16 v[252:255], v[60:63], v[212:215], v[252:255]
    s_lshl_b32 s44, s39, 6
    v_mfma_f32_16x16x32_bf16 v[248:251], v[60:63], v[216:219], v[248:251]
    s_add_u32 s44, s44, s31
    v_mfma_f32_16x16x32_bf16 v[252:255], v[60:63], v[220:223], v[252:255]
    s_waitcnt lgkmcnt(0)
    v_mfma_f32_16x16x32_bf16 a[8:11], a[192:195], v[208:211], a[8:11]
    s_add_u32 s45, s44, 131072
    v_mfma_f32_16x16x32_bf16 a[12:15], a[192:195], v[212:215], a[12:15]
    s_add_u32 s46, s44, 262144
    v_mfma_f32_16x16x32_bf16 a[8:11], a[224:227], v[216:219], a[8:11]
    s_add_u32 s47, s44, 393216
    v_mfma_f32_16x16x32_bf16 a[12:15], a[224:227], v[220:223], a[12:15]
    v_mfma_f32_16x16x32_bf16 a[24:27], a[196:199], v[208:211], a[24:27]
    v_mov_b32 v249, v248
    v_mov_b32 v253, v252
    s_nop 1
    v_mfma_f32_16x16x32_bf16 a[28:31], a[196:199], v[212:215], a[28:31]
    v_permlane16_swap_b32 v248, v249
    v_permlane16_swap_b32 v252, v253
    s_nop 1
    v_mfma_f32_16x16x32_bf16 a[24:27], a[228:231], v[216:219], a[24:27]
    v_add_f32 v248, v248, v249
    v_add_f32 v252, v252, v253
    v_mov_b32 v249, v248
    v_mfma_f32_16x16x32_bf16 a[28:31], a[228:231], v[220:223], a[28:31]
    v_mov_b32 v253, v252
    s_nop 1
    v_permlane32_swap_b32 v248, v249
    v_mfma_f32_16x16x32_bf16 a[40:43], a[200:203], v[208:211], a[40:43]
    v_permlane32_swap_b32 v252, v253
    s_nop 1
    v_add_f32 v248, v248, v249
    v_mfma_f32_16x16x32_bf16 a[44:47], a[200:203], v[212:215], a[44:47]
    v_add_f32 v252, v252, v253
    v_rcp_f32 v249, v248
    v_rcp_f32 v253, v252
    v_mfma_f32_16x16x32_bf16 a[40:43], a[232:235], v[216:219], a[40:43]
    v_rcp_f32 v248, v248
    v_rcp_f32 v252, v252
    s_nop 0
    v_mfma_f32_16x16x32_bf16 a[44:47], a[232:235], v[220:223], a[44:47]
    v_accvgpr_read_b32 v132, a8
    v_accvgpr_read_b32 v144, a12
    v_accvgpr_read_b32 v133, a9
    v_mfma_f32_16x16x32_bf16 a[56:59], a[204:207], v[208:211], a[56:59]
    v_accvgpr_read_b32 v145, a13
    v_accvgpr_read_b32 v134, a10
    v_accvgpr_read_b32 v146, a14
    v_mfma_f32_16x16x32_bf16 a[60:63], a[204:207], v[212:215], a[60:63]
    v_accvgpr_read_b32 v135, a11
    v_accvgpr_read_b32 v147, a15
    v_accvgpr_read_b32 v136, a24
    v_mfma_f32_16x16x32_bf16 a[56:59], a[236:239], v[216:219], a[56:59]
    v_accvgpr_read_b32 v148, a28
    v_accvgpr_read_b32 v137, a25
    v_accvgpr_read_b32 v149, a29
    v_mfma_f32_16x16x32_bf16 a[60:63], a[236:239], v[220:223], a[60:63]
    v_accvgpr_read_b32 v138, a26
    v_accvgpr_read_b32 v150, a30
    v_accvgpr_read_b32 v139, a27
    v_mfma_f32_16x16x32_bf16 a[72:75], a[208:211], v[208:211], a[72:75]
    v_accvgpr_read_b32 v151, a31
    v_mul_f32 v132, v132, v248
    v_mul_f32 v144, v144, v252
    v_mfma_f32_16x16x32_bf16 a[76:79], a[208:211], v[212:215], a[76:79]
    v_mul_f32 v133, v133, v248
    v_mul_f32 v145, v145, v252
    v_mul_f32 v134, v134, v248
    v_mfma_f32_16x16x32_bf16 a[72:75], a[240:243], v[216:219], a[72:75]
    v_mul_f32 v146, v146, v252
    v_mul_f32 v135, v135, v248
    v_mul_f32 v147, v147, v252
    v_mfma_f32_16x16x32_bf16 a[76:79], a[240:243], v[220:223], a[76:79]
    v_mul_f32 v136, v136, v248
    v_mul_f32 v148, v148, v252
    v_mul_f32 v137, v137, v248
    v_mfma_f32_16x16x32_bf16 a[88:91], a[212:215], v[208:211], a[88:91]
    v_mul_f32 v149, v149, v252
    v_mul_f32 v138, v138, v248
    v_mul_f32 v150, v150, v252
    v_mfma_f32_16x16x32_bf16 a[92:95], a[212:215], v[212:215], a[92:95]
    v_mul_f32 v139, v139, v248
    v_mul_f32 v151, v151, v252
    v_cvt_pk_bf16_f32 v128, v132, v133
    v_mfma_f32_16x16x32_bf16 a[88:91], a[244:247], v[216:219], a[88:91]
    v_cvt_pk_bf16_f32 v140, v144, v145
    v_cvt_pk_bf16_f32 v129, v134, v135
    v_cvt_pk_bf16_f32 v141, v146, v147
    v_mfma_f32_16x16x32_bf16 a[92:95], a[244:247], v[220:223], a[92:95]
    v_cvt_pk_bf16_f32 v130, v136, v137
    v_cvt_pk_bf16_f32 v142, v148, v149
    v_cvt_pk_bf16_f32 v131, v138, v139
    v_mfma_f32_16x16x32_bf16 a[104:107], a[216:219], v[208:211], a[104:107]
    buffer_store_dwordx4 v[128:131], v1, s[24:27], s44 offen offset:0 sc1
    v_cvt_pk_bf16_f32 v143, v150, v151
    buffer_store_dwordx4 v[140:143], v1, s[24:27], s44 offen offset:1024 sc1
    v_mfma_f32_16x16x32_bf16 a[108:111], a[216:219], v[212:215], a[108:111]
    v_accvgpr_read_b32 v156, a40
    v_accvgpr_read_b32 v168, a44
    v_accvgpr_read_b32 v157, a41
    v_mfma_f32_16x16x32_bf16 a[104:107], a[248:251], v[216:219], a[104:107]
    v_accvgpr_read_b32 v169, a45
    v_accvgpr_read_b32 v158, a42
    v_accvgpr_read_b32 v170, a46
    v_mfma_f32_16x16x32_bf16 a[108:111], a[248:251], v[220:223], a[108:111]
    v_accvgpr_read_b32 v159, a43
    v_accvgpr_read_b32 v171, a47
    v_accvgpr_read_b32 v160, a56
    v_mfma_f32_16x16x32_bf16 a[120:123], a[220:223], v[208:211], a[120:123]
    v_accvgpr_read_b32 v172, a60
    v_accvgpr_read_b32 v161, a57
    v_accvgpr_read_b32 v173, a61
    v_mfma_f32_16x16x32_bf16 a[124:127], a[220:223], v[212:215], a[124:127]
    v_accvgpr_read_b32 v162, a58
    v_accvgpr_read_b32 v174, a62
    v_accvgpr_read_b32 v163, a59
    v_mfma_f32_16x16x32_bf16 a[120:123], a[252:255], v[216:219], a[120:123]
    v_accvgpr_read_b32 v175, a63
    v_mul_f32 v156, v156, v248
    v_mul_f32 v168, v168, v252
    v_mfma_f32_16x16x32_bf16 a[124:127], a[252:255], v[220:223], a[124:127]
    v_mul_f32 v157, v157, v248
    v_mul_f32 v169, v169, v252
    v_mul_f32 v158, v158, v248
    v_mul_f32 v170, v170, v252
    v_mul_f32 v159, v159, v248
    v_mul_f32 v171, v171, v252
    v_mul_f32 v160, v160, v248
    v_mul_f32 v172, v172, v252
    v_mul_f32 v161, v161, v248
    v_mul_f32 v173, v173, v252
    v_mul_f32 v162, v162, v248
    v_mul_f32 v174, v174, v252
    v_mul_f32 v163, v163, v248
    v_mul_f32 v175, v175, v252
    v_cvt_pk_bf16_f32 v152, v156, v157
    v_cvt_pk_bf16_f32 v164, v168, v169
    v_cvt_pk_bf16_f32 v153, v158, v159
    v_cvt_pk_bf16_f32 v165, v170, v171
    v_cvt_pk_bf16_f32 v154, v160, v161
    v_cvt_pk_bf16_f32 v166, v172, v173
    v_cvt_pk_bf16_f32 v155, v162, v163
    v_cvt_pk_bf16_f32 v167, v174, v175
    buffer_store_dwordx4 v[152:155], v1, s[24:27], s45 offen offset:0 sc1
    buffer_store_dwordx4 v[164:167], v1, s[24:27], s45 offen offset:1024 sc1
    v_accvgpr_read_b32 v132, a72
    v_accvgpr_read_b32 v144, a76
    v_accvgpr_read_b32 v133, a73
    v_accvgpr_read_b32 v145, a77
    v_accvgpr_read_b32 v134, a74
    v_accvgpr_read_b32 v146, a78
    v_accvgpr_read_b32 v135, a75
    v_accvgpr_read_b32 v147, a79
    v_accvgpr_read_b32 v136, a88
    v_accvgpr_read_b32 v148, a92
    v_accvgpr_read_b32 v137, a89
    v_accvgpr_read_b32 v149, a93
    v_accvgpr_read_b32 v138, a90
    v_accvgpr_read_b32 v150, a94
    v_accvgpr_read_b32 v139, a91
    v_accvgpr_read_b32 v151, a95
    v_mul_f32 v132, v132, v248
    v_mul_f32 v144, v144, v252
    v_mul_f32 v133, v133, v248
    v_mul_f32 v145, v145, v252
    v_mul_f32 v134, v134, v248
    v_mul_f32 v146, v146, v252
    v_mul_f32 v135, v135, v248
    v_mul_f32 v147, v147, v252
    v_mul_f32 v136, v136, v248
    v_mul_f32 v148, v148, v252
    v_mul_f32 v137, v137, v248
    v_mul_f32 v149, v149, v252
    v_mul_f32 v138, v138, v248
    v_mul_f32 v150, v150, v252
    v_mul_f32 v139, v139, v248
    v_mul_f32 v151, v151, v252
    v_cvt_pk_bf16_f32 v128, v132, v133
    v_cvt_pk_bf16_f32 v140, v144, v145
    v_cvt_pk_bf16_f32 v129, v134, v135
    v_cvt_pk_bf16_f32 v141, v146, v147
    v_cvt_pk_bf16_f32 v130, v136, v137
    v_cvt_pk_bf16_f32 v142, v148, v149
    v_cvt_pk_bf16_f32 v131, v138, v139
    v_cvt_pk_bf16_f32 v143, v150, v151
    buffer_store_dwordx4 v[128:131], v1, s[24:27], s46 offen offset:0 sc1
    buffer_store_dwordx4 v[140:143], v1, s[24:27], s46 offen offset:1024 sc1
    v_accvgpr_read_b32 v156, a104
    v_accvgpr_read_b32 v168, a108
    v_accvgpr_read_b32 v157, a105
    v_accvgpr_read_b32 v169, a109
    v_accvgpr_read_b32 v158, a106
    v_accvgpr_read_b32 v170, a110
    v_accvgpr_read_b32 v159, a107
    v_accvgpr_read_b32 v171, a111
    v_accvgpr_read_b32 v160, a120
    v_accvgpr_read_b32 v172, a124
    v_accvgpr_read_b32 v161, a121
    v_accvgpr_read_b32 v173, a125
    v_accvgpr_read_b32 v162, a122
    v_accvgpr_read_b32 v174, a126
    v_accvgpr_read_b32 v163, a123
    v_accvgpr_read_b32 v175, a127
    v_mul_f32 v156, v156, v248
    v_mul_f32 v168, v168, v252
    v_mul_f32 v157, v157, v248
    v_mul_f32 v169, v169, v252
    v_mul_f32 v158, v158, v248
    v_mul_f32 v170, v170, v252
    v_mul_f32 v159, v159, v248
    v_mul_f32 v171, v171, v252
    v_mul_f32 v160, v160, v248
    v_mul_f32 v172, v172, v252
    v_mul_f32 v161, v161, v248
    v_mul_f32 v173, v173, v252
    v_mul_f32 v162, v162, v248
    v_mul_f32 v174, v174, v252
    v_mul_f32 v163, v163, v248
    v_mul_f32 v175, v175, v252
    v_cvt_pk_bf16_f32 v152, v156, v157
    v_cvt_pk_bf16_f32 v164, v168, v169
    v_cvt_pk_bf16_f32 v153, v158, v159
    v_cvt_pk_bf16_f32 v165, v170, v171
    v_cvt_pk_bf16_f32 v154, v160, v161
    v_cvt_pk_bf16_f32 v166, v172, v173
    v_cvt_pk_bf16_f32 v155, v162, v163
    v_cvt_pk_bf16_f32 v167, v174, v175
    buffer_store_dwordx4 v[152:155], v1, s[24:27], s47 offen offset:0 sc1
    buffer_store_dwordx4 v[164:167], v1, s[24:27], s47 offen offset:1024 sc1
k12_end_1:
    s_endpgm
k2_prep_70:
    s_sub_u32 s40, s36, s38
    v_subrev_u32 v6, s40, v4
    v_cmp_gt_i32 s[44:45], -16, v6
    v_cmp_gt_i32 s[46:47], -15, v6
    v_cmp_gt_i32 s[48:49], -14, v6
    v_cmp_gt_i32 s[50:51], -13, v6
    s_nop 1
    v_cndmask_b32 v20, v9, v5, s[44:45]
    v_cndmask_b32 v21, v9, v5, s[46:47]
    v_cndmask_b32 v22, v9, v5, s[48:49]
    v_cndmask_b32 v23, v9, v5, s[50:51]
    v_cmp_gt_i32 s[44:45], 0, v6
    v_cmp_gt_i32 s[46:47], 1, v6
    v_cmp_gt_i32 s[48:49], 2, v6
    v_cmp_gt_i32 s[50:51], 3, v6
    s_nop 1
    v_cndmask_b32 v16, v8, v5, s[44:45]
    v_cndmask_b32 v17, v8, v5, s[46:47]
    v_cndmask_b32 v18, v8, v5, s[48:49]
    v_cndmask_b32 v19, v8, v5, s[50:51]
    v_cndmask_b32 v36, v9, v5, s[44:45]
    v_cndmask_b32 v37, v9, v5, s[46:47]
    v_cndmask_b32 v38, v9, v5, s[48:49]
    v_cndmask_b32 v39, v9, v5, s[50:51]
    v_cmp_gt_i32 s[44:45], 16, v6
    v_cmp_gt_i32 s[46:47], 17, v6
    v_cmp_gt_i32 s[48:49], 18, v6
    v_cmp_gt_i32 s[50:51], 19, v6
    s_nop 1
    v_cndmask_b32 v32, v8, v5, s[44:45]
    v_cndmask_b32 v33, v8, v5, s[46:47]
    v_cndmask_b32 v34, v8, v5, s[48:49]
    v_cndmask_b32 v35, v8, v5, s[50:51]
    s_nop 1
    s_branch k2_prepret_71
k2_prep_78:
    s_sub_u32 s40, s36, s38
    v_subrev_u32 v6, s40, v4
    v_cmp_gt_i32 s[44:45], -16, v6
    v_cmp_gt_i32 s[46:47], -15, v6
    v_cmp_gt_i32 s[48:49], -14, v6
    v_cmp_gt_i32 s[50:51], -13, v6
    s_nop 1
    v_cndmask_b32 v20, v9, v5, s[44:45]
    v_cndmask_b32 v21, v9, v5, s[46:47]
    v_cndmask_b32 v22, v9, v5, s[48:49]
    v_cndmask_b32 v23, v9, v5, s[50:51]
    v_cmp_gt_i32 s[44:45], 0, v6
    v_cmp_gt_i32 s[46:47], 1, v6
    v_cmp_gt_i32 s[48:49], 2, v6
    v_cmp_gt_i32 s[50:51], 3, v6
    s_nop 1
    v_cndmask_b32 v16, v8, v5, s[44:45]
    v_cndmask_b32 v17, v8, v5, s[46:47]
    v_cndmask_b32 v18, v8, v5, s[48:49]
    v_cndmask_b32 v19, v8, v5, s[50:51]
    v_cndmask_b32 v36, v9, v5, s[44:45]
    v_cndmask_b32 v37, v9, v5, s[46:47]
    v_cndmask_b32 v38, v9, v5, s[48:49]
    v_cndmask_b32 v39, v9, v5, s[50:51]
    v_cmp_gt_i32 s[44:45], 16, v6
    v_cmp_gt_i32 s[46:47], 17, v6
    v_cmp_gt_i32 s[48:49], 18, v6
    v_cmp_gt_i32 s[50:51], 19, v6
    s_nop 1
    v_cndmask_b32 v32, v8, v5, s[44:45]
    v_cndmask_b32 v33, v8, v5, s[46:47]
    v_cndmask_b32 v34, v8, v5, s[48:49]
    v_cndmask_b32 v35, v8, v5, s[50:51]
    s_nop 1
    s_branch k2_prepret_79
k2_prep_83:
    s_sub_u32 s40, s36, s38
    v_subrev_u32 v6, s40, v4
    v_cmp_gt_i32 s[44:45], -16, v6
    v_cmp_gt_i32 s[46:47], -15, v6
    v_cmp_gt_i32 s[48:49], -14, v6
    v_cmp_gt_i32 s[50:51], -13, v6
    s_nop 1
    v_cndmask_b32 v20, v9, v5, s[44:45]
    v_cndmask_b32 v21, v9, v5, s[46:47]
    v_cndmask_b32 v22, v9, v5, s[48:49]
    v_cndmask_b32 v23, v9, v5, s[50:51]
    v_cmp_gt_i32 s[44:45], 0, v6
    v_cmp_gt_i32 s[46:47], 1, v6
    v_cmp_gt_i32 s[48:49], 2, v6
    v_cmp_gt_i32 s[50:51], 3, v6
    s_nop 1
    v_cndmask_b32 v16, v8, v5, s[44:45]
    v_cndmask_b32 v17, v8, v5, s[46:47]
    v_cndmask_b32 v18, v8, v5, s[48:49]
    v_cndmask_b32 v19, v8, v5, s[50:51]
    v_cndmask_b32 v36, v9, v5, s[44:45]
    v_cndmask_b32 v37, v9, v5, s[46:47]
    v_cndmask_b32 v38, v9, v5, s[48:49]
    v_cndmask_b32 v39, v9, v5, s[50:51]
    v_cmp_gt_i32 s[44:45], 16, v6
    v_cmp_gt_i32 s[46:47], 17, v6
    v_cmp_gt_i32 s[48:49], 18, v6
    v_cmp_gt_i32 s[50:51], 19, v6
    s_nop 1
    v_cndmask_b32 v32, v8, v5, s[44:45]
    v_cndmask_b32 v33, v8, v5, s[46:47]
    v_cndmask_b32 v34, v8, v5, s[48:49]
    v_cndmask_b32 v35, v8, v5, s[50:51]
    s_nop 1
    s_branch k2_prepret_84
k2_prep_87:
    s_sub_u32 s40, s36, s38
    v_subrev_u32 v6, s40, v4
    v_cmp_gt_i32 s[44:45], -16, v6
    v_cmp_gt_i32 s[46:47], -15, v6
    v_cmp_gt_i32 s[48:49], -14, v6
    v_cmp_gt_i32 s[50:51], -13, v6
    s_nop 1
    v_cndmask_b32 v20, v9, v5, s[44:45]
    v_cndmask_b32 v21, v9, v5, s[46:47]
    v_cndmask_b32 v22, v9, v5, s[48:49]
    v_cndmask_b32 v23, v9, v5, s[50:51]
    v_cmp_gt_i32 s[44:45], 0, v6
    v_cmp_gt_i32 s[46:47], 1, v6
    v_cmp_gt_i32 s[48:49], 2, v6
    v_cmp_gt_i32 s[50:51], 3, v6
    s_nop 1
    v_cndmask_b32 v16, v8, v5, s[44:45]
    v_cndmask_b32 v17, v8, v5, s[46:47]
    v_cndmask_b32 v18, v8, v5, s[48:49]
    v_cndmask_b32 v19, v8, v5, s[50:51]
    v_cndmask_b32 v36, v9, v5, s[44:45]
    v_cndmask_b32 v37, v9, v5, s[46:47]
    v_cndmask_b32 v38, v9, v5, s[48:49]
    v_cndmask_b32 v39, v9, v5, s[50:51]
    v_cmp_gt_i32 s[44:45], 16, v6
    v_cmp_gt_i32 s[46:47], 17, v6
    v_cmp_gt_i32 s[48:49], 18, v6
    v_cmp_gt_i32 s[50:51], 19, v6
    s_nop 1
    v_cndmask_b32 v32, v8, v5, s[44:45]
    v_cndmask_b32 v33, v8, v5, s[46:47]
    v_cndmask_b32 v34, v8, v5, s[48:49]
    v_cndmask_b32 v35, v8, v5, s[50:51]
    s_nop 1
    s_branch k2_prepret_88
k2_prep_91:
    s_sub_u32 s40, s36, s39
    v_subrev_u32 v6, s40, v4
    v_cmp_gt_i32 s[44:45], -16, v6
    v_cmp_gt_i32 s[46:47], -15, v6
    v_cmp_gt_i32 s[48:49], -14, v6
    v_cmp_gt_i32 s[50:51], -13, v6
    s_nop 1
    v_cndmask_b32 v20, v11, v5, s[44:45]
    v_cndmask_b32 v21, v11, v5, s[46:47]
    v_cndmask_b32 v22, v11, v5, s[48:49]
    v_cndmask_b32 v23, v11, v5, s[50:51]
    v_cmp_gt_i32 s[44:45], 0, v6
    v_cmp_gt_i32 s[46:47], 1, v6
    v_cmp_gt_i32 s[48:49], 2, v6
    v_cmp_gt_i32 s[50:51], 3, v6
    s_nop 1
    v_cndmask_b32 v16, v10, v5, s[44:45]
    v_cndmask_b32 v17, v10, v5, s[46:47]
    v_cndmask_b32 v18, v10, v5, s[48:49]
    v_cndmask_b32 v19, v10, v5, s[50:51]
    v_cndmask_b32 v36, v11, v5, s[44:45]
    v_cndmask_b32 v37, v11, v5, s[46:47]
    v_cndmask_b32 v38, v11, v5, s[48:49]
    v_cndmask_b32 v39, v11, v5, s[50:51]
    v_cmp_gt_i32 s[44:45], 16, v6
    v_cmp_gt_i32 s[46:47], 17, v6
    v_cmp_gt_i32 s[48:49], 18, v6
    v_cmp_gt_i32 s[50:51], 19, v6
    s_nop 1
    v_cndmask_b32 v32, v10, v5, s[44:45]
    v_cndmask_b32 v33, v10, v5, s[46:47]
    v_cndmask_b32 v34, v10, v5, s[48:49]
    v_cndmask_b32 v35, v10, v5, s[50:51]
    v_cndmask_b32 v28, v11, v5, s[44:45]
    v_cndmask_b32 v29, v11, v5, s[46:47]
    v_cndmask_b32 v30, v11, v5, s[48:49]
    v_cndmask_b32 v31, v11, v5, s[50:51]
    v_cmp_gt_i32 s[44:45], 32, v6
    v_cmp_gt_i32 s[46:47], 33, v6
    v_cmp_gt_i32 s[48:49], 34, v6
    v_cmp_gt_i32 s[50:51], 35, v6
    s_nop 1
    v_cndmask_b32 v24, v10, v5, s[44:45]
    v_cndmask_b32 v25, v10, v5, s[46:47]
    v_cndmask_b32 v26, v10, v5, s[48:49]
    v_cndmask_b32 v27, v10, v5, s[50:51]
    v_cndmask_b32 v44, v11, v5, s[44:45]
    v_cndmask_b32 v45, v11, v5, s[46:47]
    v_cndmask_b32 v46, v11, v5, s[48:49]
    v_cndmask_b32 v47, v11, v5, s[50:51]
    v_cmp_gt_i32 s[44:45], 48, v6
    v_cmp_gt_i32 s[46:47], 49, v6
    v_cmp_gt_i32 s[48:49], 50, v6
    v_cmp_gt_i32 s[50:51], 51, v6
    s_nop 1
    v_cndmask_b32 v40, v10, v5, s[44:45]
    v_cndmask_b32 v41, v10, v5, s[46:47]
    v_cndmask_b32 v42, v10, v5, s[48:49]
    v_cndmask_b32 v43, v10, v5, s[50:51]
    s_nop 1
    s_branch k2_prepret_92
k2_prep_95:
    s_sub_u32 s40, s36, s39
    v_subrev_u32 v6, s40, v4
    v_cmp_gt_i32 s[44:45], -16, v6
    v_cmp_gt_i32 s[46:47], -15, v6
    v_cmp_gt_i32 s[48:49], -14, v6
    v_cmp_gt_i32 s[50:51], -13, v6
    s_nop 1
    v_cndmask_b32 v20, v11, v5, s[44:45]
    v_cndmask_b32 v21, v11, v5, s[46:47]
    v_cndmask_b32 v22, v11, v5, s[48:49]
    v_cndmask_b32 v23, v11, v5, s[50:51]
    v_cmp_gt_i32 s[44:45], 0, v6
    v_cmp_gt_i32 s[46:47], 1, v6
    v_cmp_gt_i32 s[48:49], 2, v6
    v_cmp_gt_i32 s[50:51], 3, v6
    s_nop 1
    v_cndmask_b32 v16, v10, v5, s[44:45]
    v_cndmask_b32 v17, v10, v5, s[46:47]
    v_cndmask_b32 v18, v10, v5, s[48:49]
    v_cndmask_b32 v19, v10, v5, s[50:51]
    v_cndmask_b32 v36, v11, v5, s[44:45]
    v_cndmask_b32 v37, v11, v5, s[46:47]
    v_cndmask_b32 v38, v11, v5, s[48:49]
    v_cndmask_b32 v39, v11, v5, s[50:51]
    v_cmp_gt_i32 s[44:45], 16, v6
    v_cmp_gt_i32 s[46:47], 17, v6
    v_cmp_gt_i32 s[48:49], 18, v6
    v_cmp_gt_i32 s[50:51], 19, v6
    s_nop 1
    v_cndmask_b32 v32, v10, v5, s[44:45]
    v_cndmask_b32 v33, v10, v5, s[46:47]
    v_cndmask_b32 v34, v10, v5, s[48:49]
    v_cndmask_b32 v35, v10, v5, s[50:51]
    v_cndmask_b32 v28, v11, v5, s[44:45]
    v_cndmask_b32 v29, v11, v5, s[46:47]
    v_cndmask_b32 v30, v11, v5, s[48:49]
    v_cndmask_b32 v31, v11, v5, s[50:51]
    v_cmp_gt_i32 s[44:45], 32, v6
    v_cmp_gt_i32 s[46:47], 33, v6
    v_cmp_gt_i32 s[48:49], 34, v6
    v_cmp_gt_i32 s[50:51], 35, v6
    s_nop 1
    v_cndmask_b32 v24, v10, v5, s[44:45]
    v_cndmask_b32 v25, v10, v5, s[46:47]
    v_cndmask_b32 v26, v10, v5, s[48:49]
    v_cndmask_b32 v27, v10, v5, s[50:51]
    v_cndmask_b32 v44, v11, v5, s[44:45]
    v_cndmask_b32 v45, v11, v5, s[46:47]
    v_cndmask_b32 v46, v11, v5, s[48:49]
    v_cndmask_b32 v47, v11, v5, s[50:51]
    v_cmp_gt_i32 s[44:45], 48, v6
    v_cmp_gt_i32 s[46:47], 49, v6
    v_cmp_gt_i32 s[48:49], 50, v6
    v_cmp_gt_i32 s[50:51], 51, v6
    s_nop 1
    v_cndmask_b32 v40, v10, v5, s[44:45]
    v_cndmask_b32 v41, v10, v5, s[46:47]
    v_cndmask_b32 v42, v10, v5, s[48:49]
    v_cndmask_b32 v43, v10, v5, s[50:51]
    s_nop 1
    s_branch k2_prepret_96
k2_prep_101:
    s_sub_u32 s40, s36, s39
    v_subrev_u32 v6, s40, v4
    v_cmp_gt_i32 s[44:45], -16, v6
    v_cmp_gt_i32 s[46:47], -15, v6
    v_cmp_gt_i32 s[48:49], -14, v6
    v_cmp_gt_i32 s[50:51], -13, v6
    s_nop 1
    v_cndmask_b32 v20, v11, v5, s[44:45]
    v_cndmask_b32 v21, v11, v5, s[46:47]
    v_cndmask_b32 v22, v11, v5, s[48:49]
    v_cndmask_b32 v23, v11, v5, s[50:51]
    v_cmp_gt_i32 s[44:45], 0, v6
    v_cmp_gt_i32 s[46:47], 1, v6
    v_cmp_gt_i32 s[48:49], 2, v6
    v_cmp_gt_i32 s[50:51], 3, v6
    s_nop 1
    v_cndmask_b32 v16, v10, v5, s[44:45]
    v_cndmask_b32 v17, v10, v5, s[46:47]
    v_cndmask_b32 v18, v10, v5, s[48:49]
    v_cndmask_b32 v19, v10, v5, s[50:51]
    v_cndmask_b32 v36, v11, v5, s[44:45]
    v_cndmask_b32 v37, v11, v5, s[46:47]
    v_cndmask_b32 v38, v11, v5, s[48:49]
    v_cndmask_b32 v39, v11, v5, s[50:51]
    v_cmp_gt_i32 s[44:45], 16, v6
    v_cmp_gt_i32 s[46:47], 17, v6
    v_cmp_gt_i32 s[48:49], 18, v6
    v_cmp_gt_i32 s[50:51], 19, v6
    s_nop 1
    v_cndmask_b32 v32, v10, v5, s[44:45]
    v_cndmask_b32 v33, v10, v5, s[46:47]
    v_cndmask_b32 v34, v10, v5, s[48:49]
    v_cndmask_b32 v35, v10, v5, s[50:51]
    v_cndmask_b32 v28, v11, v5, s[44:45]
    v_cndmask_b32 v29, v11, v5, s[46:47]
    v_cndmask_b32 v30, v11, v5, s[48:49]
    v_cndmask_b32 v31, v11, v5, s[50:51]
    v_cmp_gt_i32 s[44:45], 32, v6
    v_cmp_gt_i32 s[46:47], 33, v6
    v_cmp_gt_i32 s[48:49], 34, v6
    v_cmp_gt_i32 s[50:51], 35, v6
    s_nop 1
    v_cndmask_b32 v24, v10, v5, s[44:45]
    v_cndmask_b32 v25, v10, v5, s[46:47]
    v_cndmask_b32 v26, v10, v5, s[48:49]
    v_cndmask_b32 v27, v10, v5, s[50:51]
    v_cndmask_b32 v44, v11, v5, s[44:45]
    v_cndmask_b32 v45, v11, v5, s[46:47]
    v_cndmask_b32 v46, v11, v5, s[48:49]
    v_cndmask_b32 v47, v11, v5, s[50:51]
    v_cmp_gt_i32 s[44:45], 48, v6
    v_cmp_gt_i32 s[46:47], 49, v6
    v_cmp_gt_i32 s[48:49], 50, v6
    v_cmp_gt_i32 s[50:51], 51, v6
    s_nop 1
    v_cndmask_b32 v40, v10, v5, s[44:45]
    v_cndmask_b32 v41, v10, v5, s[46:47]
    v_cndmask_b32 v42, v10, v5, s[48:49]
    v_cndmask_b32 v43, v10, v5, s[50:51]
    s_nop 1
    s_branch k2_prepret_102
k2_prep_105:
    s_sub_u32 s40, s36, s39
    v_subrev_u32 v6, s40, v4
    v_cmp_gt_i32 s[44:45], -16, v6
    v_cmp_gt_i32 s[46:47], -15, v6
    v_cmp_gt_i32 s[48:49], -14, v6
    v_cmp_gt_i32 s[50:51], -13, v6
    s_nop 1
    v_cndmask_b32 v20, v11, v5, s[44:45]
    v_cndmask_b32 v21, v11, v5, s[46:47]
    v_cndmask_b32 v22, v11, v5, s[48:49]
    v_cndmask_b32 v23, v11, v5, s[50:51]
    v_cmp_gt_i32 s[44:45], 0, v6
    v_cmp_gt_i32 s[46:47], 1, v6
    v_cmp_gt_i32 s[48:49], 2, v6
    v_cmp_gt_i32 s[50:51], 3, v6
    s_nop 1
    v_cndmask_b32 v16, v10, v5, s[44:45]
    v_cndmask_b32 v17, v10, v5, s[46:47]
    v_cndmask_b32 v18, v10, v5, s[48:49]
    v_cndmask_b32 v19, v10, v5, s[50:51]
    v_cndmask_b32 v36, v11, v5, s[44:45]
    v_cndmask_b32 v37, v11, v5, s[46:47]
    v_cndmask_b32 v38, v11, v5, s[48:49]
    v_cndmask_b32 v39, v11, v5, s[50:51]
    v_cmp_gt_i32 s[44:45], 16, v6
    v_cmp_gt_i32 s[46:47], 17, v6
    v_cmp_gt_i32 s[48:49], 18, v6
    v_cmp_gt_i32 s[50:51], 19, v6
    s_nop 1
    v_cndmask_b32 v32, v10, v5, s[44:45]
    v_cndmask_b32 v33, v10, v5, s[46:47]
    v_cndmask_b32 v34, v10, v5, s[48:49]
    v_cndmask_b32 v35, v10, v5, s[50:51]
    v_cndmask_b32 v28, v11, v5, s[44:45]
    v_cndmask_b32 v29, v11, v5, s[46:47]
    v_cndmask_b32 v30, v11, v5, s[48:49]
    v_cndmask_b32 v31, v11, v5, s[50:51]
    v_cmp_gt_i32 s[44:45], 32, v6
    v_cmp_gt_i32 s[46:47], 33, v6
    v_cmp_gt_i32 s[48:49], 34, v6
    v_cmp_gt_i32 s[50:51], 35, v6
    s_nop 1
    v_cndmask_b32 v24, v10, v5, s[44:45]
    v_cndmask_b32 v25, v10, v5, s[46:47]
    v_cndmask_b32 v26, v10, v5, s[48:49]
    v_cndmask_b32 v27, v10, v5, s[50:51]
    v_cndmask_b32 v44, v11, v5, s[44:45]
    v_cndmask_b32 v45, v11, v5, s[46:47]
    v_cndmask_b32 v46, v11, v5, s[48:49]
    v_cndmask_b32 v47, v11, v5, s[50:51]
    v_cmp_gt_i32 s[44:45], 48, v6
    v_cmp_gt_i32 s[46:47], 49, v6
    v_cmp_gt_i32 s[48:49], 50, v6
    v_cmp_gt_i32 s[50:51], 51, v6
    s_nop 1
    v_cndmask_b32 v40, v10, v5, s[44:45]
    v_cndmask_b32 v41, v10, v5, s[46:47]
    v_cndmask_b32 v42, v10, v5, s[48:49]
    v_cndmask_b32 v43, v10, v5, s[50:51]
    s_nop 1
    s_branch k2_prepret_106
k12_ool_10:
    buffer_load_dword v52, v8, s[24:27], 0 offen sc1
    s_branch k12_oolret_11
k12_ool_12:
    s_mov_b64 exec, 1
    buffer_atomic_add v9, v8, s[24:27], 0 offen sc1
    s_mov_b64 exec, -1
    s_branch k12_oolret_13
k12_ool_14:
    buffer_load_dword v51, v50, s[12:15], s56 offen
    s_branch k12_oolret_15
k12_ool_18:
    v_readfirstlane_b32 s31, v52
    s_cmp_ge_u32 s31, 256
    s_cbranch_scc1 spin_ok_16
    s_mov_b32 s40, 1048576
spin_17:
    s_sleep 8
    buffer_load_dword v52, v8, s[24:27], 0 offen sc1
    s_waitcnt vmcnt(0)
    v_readfirstlane_b32 s31, v52
    s_sub_u32 s40, s40, 1
    s_cselect_b32 s31, -1, s31
    s_cmp_lt_u32 s31, 256
    s_cbranch_scc1 spin_17
spin_ok_16:
    s_branch k12_oolret_19
k12_ool_20:
    s_mov_b64 exec, 1
    buffer_atomic_add v9, v8, s[24:27], 0 offen sc1
    s_mov_b64 exec, -1
    s_branch k12_oolret_21
k12_ool_22:
    global_load_dword v51, v[2:3], off
    s_branch k12_oolret_23
k12_ool_26:
    buffer_load_dword v52, v8, s[24:27], 0 offen sc1
    s_branch k12_oolret_27
k12_ool_28:
    s_mov_b64 exec, 1
    buffer_atomic_add v9, v8, s[24:27], 0 offen sc1
    s_mov_b64 exec, -1
    s_branch k12_oolret_29
k12_ool_30:
    buffer_load_dword v51, v50, s[12:15], s56 offen
    s_branch k12_oolret_31
k12_ool_34:
    v_readfirstlane_b32 s31, v52
    s_cmp_ge_u32 s31, 256
    s_cbranch_scc1 spin_ok_32
    s_mov_b32 s40, 1048576
spin_33:
    s_sleep 8
    buffer_load_dword v52, v8, s[24:27], 0 offen sc1
    s_waitcnt vmcnt(0)
    v_readfirstlane_b32 s31, v52
    s_sub_u32 s40, s40, 1
    s_cselect_b32 s31, -1, s31
    s_cmp_lt_u32 s31, 256
    s_cbranch_scc1 spin_33
spin_ok_32:
    s_branch k12_oolret_35
k12_ool_36:
    s_mov_b64 exec, 1
    buffer_atomic_add v9, v8, s[24:27], 0 offen sc1
    s_mov_b64 exec, -1
    s_branch k12_oolret_37
k12_ool_38:
    global_load_dword v51, v[2:3], off
    s_branch k12_oolret_39
k12_ool_40:
    s_add_u32 s52, s47, 528384
    buffer_store_dwordx4 v[156:159], v1, s[48:51], s52 offen offset:3072 sc1
    s_branch k12_oolret_41
k12_ool_42:
    s_add_u32 s52, s47, 532480
    buffer_store_dwordx4 v[160:163], v1, s[48:51], s52 offen offset:0 sc1
    s_branch k12_oolret_43
k12_ool_44:
    s_add_u32 s52, s47, 532480
    buffer_store_dwordx4 v[164:167], v1, s[48:51], s52 offen offset:1024 sc1
    s_branch k12_oolret_45
k12_ool_46:
    s_add_u32 s52, s47, 532480
    buffer_store_dwordx4 v[168:171], v1, s[48:51], s52 offen offset:2048 sc1
    s_branch k12_oolret_47
k12_ool_48:
    s_add_u32 s52, s47, 532480
    buffer_store_dwordx4 v[172:175], v1, s[48:51], s52 offen offset:3072 sc1
    s_branch k12_oolret_49
k12_ool_50:
    s_add_u32 s52, s47, 536576
    buffer_store_dwordx4 v[176:179], v1, s[48:51], s52 offen offset:0 sc1
    s_branch k12_oolret_51
k12_ool_52:
    s_add_u32 s52, s47, 536576
    buffer_store_dwordx4 v[180:183], v1, s[48:51], s52 offen offset:1024 sc1
    s_branch k12_oolret_53
k12_ool_54:
    s_add_u32 s52, s47, 536576
    buffer_store_dwordx4 v[184:187], v1, s[48:51], s52 offen offset:2048 sc1
    s_branch k12_oolret_55
k12_ool_56:
    s_add_u32 s52, s47, 536576
    buffer_store_dwordx4 v[188:191], v1, s[48:51], s52 offen offset:3072 sc1
    s_branch k12_oolret_57
k12_ool_58:
    s_mov_b32 s50, 0
    s_branch k12_oolret_59
k12_ool_60:
    s_mov_b64 exec, 1
    buffer_atomic_add v9, v8, s[24:27], s54 offen sc1
    s_mov_b64 exec, -1
    s_branch k12_oolret_61
k12_ool_62:
    buffer_load_dword v52, v8, s[24:27], s55 offen sc1
    s_branch k12_oolret_63
k12_ool_66:
    s_waitcnt vmcnt(14)
    v_readfirstlane_b32 s31, v52
    s_cmp_ge_u32 s31, 2
    s_cbranch_scc1 spin_ok_64
    s_mov_b32 s40, 1048576
spin_65:
    s_sleep 8
    buffer_load_dword v52, v8, s[24:27], s55 offen sc1
    s_waitcnt vmcnt(0)
    v_readfirstlane_b32 s31, v52
    s_sub_u32 s40, s40, 1
    s_cselect_b32 s31, -1, s31
    s_cmp_lt_u32 s31, 2
    s_cbranch_scc1 spin_65
spin_ok_64:
    s_branch k12_oolret_67
k12_ool_68:
    s_mov_b64 exec, 1
    buffer_atomic_add v9, v8, s[24:27], s3 offen sc1
    s_mov_b64 exec, -1
    s_branch k12_oolret_69
k12_ool_72:
    buffer_load_dword v58, v59, s[24:27], s5 offen sc1
    s_branch k12_oolret_73
k12_ool_76:
    s_waitcnt vmcnt(0)
    v_readfirstlane_b32 s31, v58
    s_cmp_ge_u32 s31, 14
    s_cbranch_scc1 spin_ok_74
    s_mov_b32 s40, 1048576
spin_75:
    s_sleep 8
    buffer_load_dword v58, v59, s[24:27], s5 offen sc1
    s_waitcnt vmcnt(0)
    v_readfirstlane_b32 s31, v58
    s_sub_u32 s40, s40, 1
    s_cselect_b32 s31, -1, s31
    s_cmp_lt_u32 s31, 14
    s_cbranch_scc1 spin_75
spin_ok_74:
    s_branch k12_oolret_77
k2_rare_80:
    s_nop 7
    v_max_f32 v52, v128, v129
    v_max3_f32 v52, v52, v130, v131
    v_max3_f32 v52, v52, v144, v145
    v_max3_f32 v52, v52, v146, v147
    v_max_f32 v53, v132, v133
    v_max3_f32 v53, v53, v134, v135
    v_max3_f32 v53, v53, v148, v149
    v_max3_f32 v53, v53, v150, v151
    v_max_f32 v54, v136, v137
    v_max3_f32 v54, v54, v138, v139
    v_max3_f32 v54, v54, v152, v153
    v_max3_f32 v54, v54, v154, v155
    v_max_f32 v55, v140, v141
    v_max3_f32 v55, v55, v142, v143
    v_max3_f32 v55, v55, v156, v157
    v_max3_f32 v55, v55, v158, v159
    v_mov_b32 v224, v52
    v_mov_b32 v225, v53
    v_mov_b32 v226, v54
    v_mov_b32 v227, v55
    s_nop 1
    v_permlane16_swap_b32 v52, v224
    v_permlane16_swap_b32 v53, v225
    v_permlane16_swap_b32 v54, v226
    v_permlane16_swap_b32 v55, v227
    s_nop 1
    v_max_f32 v52, v52, v224
    v_max_f32 v53, v53, v225
    v_max_f32 v54, v54, v226
    v_max_f32 v55, v55, v227
    v_mov_b32 v224, v52
    v_mov_b32 v225, v53
    v_mov_b32 v226, v54
    v_mov_b32 v227, v55
    s_nop 1
    v_permlane32_swap_b32 v52, v224
    v_permlane32_swap_b32 v53, v225
    v_permlane32_swap_b32 v54, v226
    v_permlane32_swap_b32 v55, v227
    s_nop 1
    v_max_f32 v52, v52, v224
    v_max_f32 v53, v53, v225
    v_max_f32 v54, v54, v226
    v_max_f32 v55, v55, v227
    v_add_f32 v52, 0x41400000, v52
    v_max_f32 v52, 0, v52
    v_add_f32 v53, 0x41400000, v53
    v_max_f32 v53, 0, v53
    v_add_f32 v54, 0x41400000, v54
    v_max_f32 v54, 0, v54
    v_add_f32 v55, 0x41400000, v55
    v_max_f32 v55, 0, v55
    v_sub_f32 v128, v128, v52
    v_sub_f32 v129, v129, v52
    v_sub_f32 v130, v130, v52
    v_sub_f32 v131, v131, v52
    v_sub_f32 v132, v132, v53
    v_sub_f32 v133, v133, v53
    v_sub_f32 v134, v134, v53
    v_sub_f32 v135, v135, v53
    v_sub_f32 v136, v136, v54
    v_sub_f32 v137, v137, v54
    v_sub_f32 v138, v138, v54
    v_sub_f32 v139, v139, v54
    v_sub_f32 v140, v140, v55
    v_sub_f32 v141, v141, v55
    v_sub_f32 v142, v142, v55
    v_sub_f32 v143, v143, v55
    v_sub_f32 v144, v144, v52
    v_sub_f32 v145, v145, v52
    v_sub_f32 v146, v146, v52
    v_sub_f32 v147, v147, v52
    v_sub_f32 v148, v148, v53
    v_sub_f32 v149, v149, v53
    v_sub_f32 v150, v150, v53
    v_sub_f32 v151, v151, v53
    v_sub_f32 v152, v152, v54
    v_sub_f32 v153, v153, v54
    v_sub_f32 v154, v154, v54
    v_sub_f32 v155, v155, v54
    v_sub_f32 v156, v156, v55
    v_sub_f32 v157, v157, v55
    v_sub_f32 v158, v158, v55
    v_sub_f32 v159, v159, v55
    v_sub_f32 v160, v160, v52
    v_sub_f32 v16, v16, v52
    v_sub_f32 v161, v161, v52
    v_sub_f32 v17, v17, v52
    v_sub_f32 v162, v162, v52
    v_sub_f32 v18, v18, v52
    v_sub_f32 v163, v163, v52
    v_sub_f32 v19, v19, v52
    v_sub_f32 v164, v164, v53
    v_sub_f32 v20, v20, v53
    v_sub_f32 v165, v165, v53
    v_sub_f32 v21, v21, v53
    v_sub_f32 v166, v166, v53
    v_sub_f32 v22, v22, v53
    v_sub_f32 v167, v167, v53
    v_sub_f32 v23, v23, v53
    v_sub_f32 v168, v168, v54
    v_sub_f32 v24, v24, v54
    v_sub_f32 v169, v169, v54
    v_sub_f32 v25, v25, v54
    v_sub_f32 v170, v170, v54
    v_sub_f32 v26, v26, v54
    v_sub_f32 v171, v171, v54
    v_sub_f32 v27, v27, v54
    v_sub_f32 v172, v172, v55
    v_sub_f32 v28, v28, v55
    v_sub_f32 v173, v173, v55
    v_sub_f32 v29, v29, v55
    v_sub_f32 v174, v174, v55
    v_sub_f32 v30, v30, v55
    v_sub_f32 v175, v175, v55
    v_sub_f32 v31, v31, v55
    v_sub_f32 v176, v176, v52
    v_sub_f32 v32, v32, v52
    v_sub_f32 v177, v177, v52
    v_sub_f32 v33, v33, v52
    v_sub_f32 v178, v178, v52
    v_sub_f32 v34, v34, v52
    v_sub_f32 v179, v179, v52
    v_sub_f32 v35, v35, v52
    v_sub_f32 v180, v180, v53
    v_sub_f32 v36, v36, v53
    v_sub_f32 v181, v181, v53
    v_sub_f32 v37, v37, v53
    v_sub_f32 v182, v182, v53
    v_sub_f32 v38, v38, v53
    v_sub_f32 v183, v183, v53
    v_sub_f32 v39, v39, v53
    v_sub_f32 v184, v184, v54
    v_sub_f32 v40, v40, v54
    v_sub_f32 v185, v185, v54
    v_sub_f32 v41, v41, v54
    v_sub_f32 v186, v186, v54
    v_sub_f32 v42, v42, v54
    v_sub_f32 v187, v187, v54
    v_sub_f32 v43, v43, v54
    v_sub_f32 v188, v188, v55
    v_sub_f32 v44, v44, v55
    v_sub_f32 v189, v189, v55
    v_sub_f32 v45, v45, v55
    v_sub_f32 v190, v190, v55
    v_sub_f32 v46, v46, v55
    v_sub_f32 v191, v191, v55
    v_sub_f32 v47, v47, v55
    v_sub_f32 v8, v8, v52
    v_exp_f32 v52, -v52
    v_sub_f32 v9, v9, v53
    v_exp_f32 v53, -v53
    v_sub_f32 v10, v10, v54
    v_exp_f32 v54, -v54
    v_sub_f32 v11, v11, v55
    v_exp_f32 v55, -v55
    s_nop 0
    v_mul_f32 v12, v12, v52
    v_mul_f32 v48, v48, v53
    v_mul_f32 v248, v248, v54
    v_mul_f32 v252, v252, v55
    v_accvgpr_read_b32 v224, a0
    v_accvgpr_read_b32 v225, a1
    v_accvgpr_read_b32 v226, a2
    v_accvgpr_read_b32 v227, a3
    v_mul_f32 v224, v224, v52
    v_mul_f32 v225, v225, v52
    v_mul_f32 v226, v226, v52
    v_mul_f32 v227, v227, v52
    v_accvgpr_write_b32 a0, v224
    v_accvgpr_write_b32 a1, v225
    v_accvgpr_write_b32 a2, v226
    v_accvgpr_write_b32 a3, v227
    v_accvgpr_read_b32 v224, a4
    v_accvgpr_read_b32 v225, a5
    v_accvgpr_read_b32 v226, a6
    v_accvgpr_read_b32 v227, a7
    v_mul_f32 v224, v224, v53
    v_mul_f32 v225, v225, v53
    v_mul_f32 v226, v226, v53
    v_mul_f32 v227, v227, v53
    v_accvgpr_write_b32 a4, v224
    v_accvgpr_write_b32 a5, v225
    v_accvgpr_write_b32 a6, v226
    v_accvgpr_write_b32 a7, v227
    v_accvgpr_read_b32 v224, a8
    v_accvgpr_read_b32 v225, a9
    v_accvgpr_read_b32 v226, a10
    v_accvgpr_read_b32 v227, a11
    v_mul_f32 v224, v224, v54
    v_mul_f32 v225, v225, v54
    v_mul_f32 v226, v226, v54
    v_mul_f32 v227, v227, v54
    v_accvgpr_write_b32 a8, v224
    v_accvgpr_write_b32 a9, v225
    v_accvgpr_write_b32 a10, v226
    v_accvgpr_write_b32 a11, v227
    v_accvgpr_read_b32 v224, a12
    v_accvgpr_read_b32 v225, a13
    v_accvgpr_read_b32 v226, a14
    v_accvgpr_read_b32 v227, a15
    v_mul_f32 v224, v224, v55
    v_mul_f32 v225, v225, v55
    v_mul_f32 v226, v226, v55
    v_mul_f32 v227, v227, v55
    v_accvgpr_write_b32 a12, v224
    v_accvgpr_write_b32 a13, v225
    v_accvgpr_write_b32 a14, v226
    v_accvgpr_write_b32 a15, v227
    v_accvgpr_read_b32 v224, a16
    v_accvgpr_read_b32 v225, a17
    v_accvgpr_read_b32 v226, a18
    v_accvgpr_read_b32 v227, a19
    v_mul_f32 v224, v224, v52
    v_mul_f32 v225, v225, v52
    v_mul_f32 v226, v226, v52
    v_mul_f32 v227, v227, v52
    v_accvgpr_write_b32 a16, v224
    v_accvgpr_write_b32 a17, v225
    v_accvgpr_write_b32 a18, v226
    v_accvgpr_write_b32 a19, v227
    v_accvgpr_read_b32 v224, a20
    v_accvgpr_read_b32 v225, a21
    v_accvgpr_read_b32 v226, a22
    v_accvgpr_read_b32 v227, a23
    v_mul_f32 v224, v224, v53
    v_mul_f32 v225, v225, v53
    v_mul_f32 v226, v226, v53
    v_mul_f32 v227, v227, v53
    v_accvgpr_write_b32 a20, v224
    v_accvgpr_write_b32 a21, v225
    v_accvgpr_write_b32 a22, v226
    v_accvgpr_write_b32 a23, v227
    v_accvgpr_read_b32 v224, a24
    v_accvgpr_read_b32 v225, a25
    v_accvgpr_read_b32 v226, a26
    v_accvgpr_read_b32 v227, a27
    v_mul_f32 v224, v224, v54
    v_mul_f32 v225, v225, v54
    v_mul_f32 v226, v226, v54
    v_mul_f32 v227, v227, v54
    v_accvgpr_write_b32 a24, v224
    v_accvgpr_write_b32 a25, v225
    v_accvgpr_write_b32 a26, v226
    v_accvgpr_write_b32 a27, v227
    v_accvgpr_read_b32 v224, a28
    v_accvgpr_read_b32 v225, a29
    v_accvgpr_read_b32 v226, a30
    v_accvgpr_read_b32 v227, a31
    v_mul_f32 v224, v224, v55
    v_mul_f32 v225, v225, v55
    v_mul_f32 v226, v226, v55
    v_mul_f32 v227, v227, v55
    v_accvgpr_write_b32 a28, v224
    v_accvgpr_write_b32 a29, v225
    v_accvgpr_write_b32 a30, v226
    v_accvgpr_write_b32 a31, v227
    v_accvgpr_read_b32 v224, a32
    v_accvgpr_read_b32 v225, a33
    v_accvgpr_read_b32 v226, a34
    v_accvgpr_read_b32 v227, a35
    v_mul_f32 v224, v224, v52
    v_mul_f32 v225, v225, v52
    v_mul_f32 v226, v226, v52
    v_mul_f32 v227, v227, v52
    v_accvgpr_write_b32 a32, v224
    v_accvgpr_write_b32 a33, v225
    v_accvgpr_write_b32 a34, v226
    v_accvgpr_write_b32 a35, v227
    v_accvgpr_read_b32 v224, a36
    v_accvgpr_read_b32 v225, a37
    v_accvgpr_read_b32 v226, a38
    v_accvgpr_read_b32 v227, a39
    v_mul_f32 v224, v224, v53
    v_mul_f32 v225, v225, v53
    v_mul_f32 v226, v226, v53
    v_mul_f32 v227, v227, v53
    v_accvgpr_write_b32 a36, v224
    v_accvgpr_write_b32 a37, v225
    v_accvgpr_write_b32 a38, v226
    v_accvgpr_write_b32 a39, v227
    v_accvgpr_read_b32 v224, a40
    v_accvgpr_read_b32 v225, a41
    v_accvgpr_read_b32 v226, a42
    v_accvgpr_read_b32 v227, a43
    v_mul_f32 v224, v224, v54
    v_mul_f32 v225, v225, v54
    v_mul_f32 v226, v226, v54
    v_mul_f32 v227, v227, v54
    v_accvgpr_write_b32 a40, v224
    v_accvgpr_write_b32 a41, v225
    v_accvgpr_write_b32 a42, v226
    v_accvgpr_write_b32 a43, v227
    v_accvgpr_read_b32 v224, a44
    v_accvgpr_read_b32 v225, a45
    v_accvgpr_read_b32 v226, a46
    v_accvgpr_read_b32 v227, a47
    v_mul_f32 v224, v224, v55
    v_mul_f32 v225, v225, v55
    v_mul_f32 v226, v226, v55
    v_mul_f32 v227, v227, v55
    v_accvgpr_write_b32 a44, v224
    v_accvgpr_write_b32 a45, v225
    v_accvgpr_write_b32 a46, v226
    v_accvgpr_write_b32 a47, v227
    v_accvgpr_read_b32 v224, a48
    v_accvgpr_read_b32 v225, a49
    v_accvgpr_read_b32 v226, a50
    v_accvgpr_read_b32 v227, a51
    v_mul_f32 v224, v224, v52
    v_mul_f32 v225, v225, v52
    v_mul_f32 v226, v226, v52
    v_mul_f32 v227, v227, v52
    v_accvgpr_write_b32 a48, v224
    v_accvgpr_write_b32 a49, v225
    v_accvgpr_write_b32 a50, v226
    v_accvgpr_write_b32 a51, v227
    v_accvgpr_read_b32 v224, a52
    v_accvgpr_read_b32 v225, a53
    v_accvgpr_read_b32 v226, a54
    v_accvgpr_read_b32 v227, a55
    v_mul_f32 v224, v224, v53
    v_mul_f32 v225, v225, v53
    v_mul_f32 v226, v226, v53
    v_mul_f32 v227, v227, v53
    v_accvgpr_write_b32 a52, v224
    v_accvgpr_write_b32 a53, v225
    v_accvgpr_write_b32 a54, v226
    v_accvgpr_write_b32 a55, v227
    v_accvgpr_read_b32 v224, a56
    v_accvgpr_read_b32 v225, a57
    v_accvgpr_read_b32 v226, a58
    v_accvgpr_read_b32 v227, a59
    v_mul_f32 v224, v224, v54
    v_mul_f32 v225, v225, v54
    v_mul_f32 v226, v226, v54
    v_mul_f32 v227, v227, v54
    v_accvgpr_write_b32 a56, v224
    v_accvgpr_write_b32 a57, v225
    v_accvgpr_write_b32 a58, v226
    v_accvgpr_write_b32 a59, v227
    v_accvgpr_read_b32 v224, a60
    v_accvgpr_read_b32 v225, a61
    v_accvgpr_read_b32 v226, a62
    v_accvgpr_read_b32 v227, a63
    v_mul_f32 v224, v224, v55
    v_mul_f32 v225, v225, v55
    v_mul_f32 v226, v226, v55
    v_mul_f32 v227, v227, v55
    v_accvgpr_write_b32 a60, v224
    v_accvgpr_write_b32 a61, v225
    v_accvgpr_write_b32 a62, v226
    v_accvgpr_write_b32 a63, v227
    v_accvgpr_read_b32 v224, a64
    v_accvgpr_read_b32 v225, a65
    v_accvgpr_read_b32 v226, a66
    v_accvgpr_read_b32 v227, a67
    v_mul_f32 v224, v224, v52
    v_mul_f32 v225, v225, v52
    v_mul_f32 v226, v226, v52
    v_mul_f32 v227, v227, v52
    v_accvgpr_write_b32 a64, v224
    v_accvgpr_write_b32 a65, v225
    v_accvgpr_write_b32 a66, v226
    v_accvgpr_write_b32 a67, v227
    v_accvgpr_read_b32 v224, a68
    v_accvgpr_read_b32 v225, a69
    v_accvgpr_read_b32 v226, a70
    v_accvgpr_read_b32 v227, a71
    v_mul_f32 v224, v224, v53
    v_mul_f32 v225, v225, v53
    v_mul_f32 v226, v226, v53
    v_mul_f32 v227, v227, v53
    v_accvgpr_write_b32 a68, v224
    v_accvgpr_write_b32 a69, v225
    v_accvgpr_write_b32 a70, v226
    v_accvgpr_write_b32 a71, v227
    v_accvgpr_read_b32 v224, a72
    v_accvgpr_read_b32 v225, a73
    v_accvgpr_read_b32 v226, a74
    v_accvgpr_read_b32 v227, a75
    v_mul_f32 v224, v224, v54
    v_mul_f32 v225, v225, v54
    v_mul_f32 v226, v226, v54
    v_mul_f32 v227, v227, v54
    v_accvgpr_write_b32 a72, v224
    v_accvgpr_write_b32 a73, v225
    v_accvgpr_write_b32 a74, v226
    v_accvgpr_write_b32 a75, v227
    v_accvgpr_read_b32 v224, a76
    v_accvgpr_read_b32 v225, a77
    v_accvgpr_read_b32 v226, a78
    v_accvgpr_read_b32 v227, a79
    v_mul_f32 v224, v224, v55
    v_mul_f32 v225, v225, v55
    v_mul_f32 v226, v226, v55
    v_mul_f32 v227, v227, v55
    v_accvgpr_write_b32 a76, v224
    v_accvgpr_write_b32 a77, v225
    v_accvgpr_write_b32 a78, v226
    v_accvgpr_write_b32 a79, v227
    v_accvgpr_read_b32 v224, a80
    v_accvgpr_read_b32 v225, a81
    v_accvgpr_read_b32 v226, a82
    v_accvgpr_read_b32 v227, a83
    v_mul_f32 v224, v224, v52
    v_mul_f32 v225, v225, v52
    v_mul_f32 v226, v226, v52
    v_mul_f32 v227, v227, v52
    v_accvgpr_write_b32 a80, v224
    v_accvgpr_write_b32 a81, v225
    v_accvgpr_write_b32 a82, v226
    v_accvgpr_write_b32 a83, v227
    v_accvgpr_read_b32 v224, a84
    v_accvgpr_read_b32 v225, a85
    v_accvgpr_read_b32 v226, a86
    v_accvgpr_read_b32 v227, a87
    v_mul_f32 v224, v224, v53
    v_mul_f32 v225, v225, v53
    v_mul_f32 v226, v226, v53
    v_mul_f32 v227, v227, v53
    v_accvgpr_write_b32 a84, v224
    v_accvgpr_write_b32 a85, v225
    v_accvgpr_write_b32 a86, v226
    v_accvgpr_write_b32 a87, v227
    v_accvgpr_read_b32 v224, a88
    v_accvgpr_read_b32 v225, a89
    v_accvgpr_read_b32 v226, a90
    v_accvgpr_read_b32 v227, a91
    v_mul_f32 v224, v224, v54
    v_mul_f32 v225, v225, v54
    v_mul_f32 v226, v226, v54
    v_mul_f32 v227, v227, v54
    v_accvgpr_write_b32 a88, v224
    v_accvgpr_write_b32 a89, v225
    v_accvgpr_write_b32 a90, v226
    v_accvgpr_write_b32 a91, v227
    v_accvgpr_read_b32 v224, a92
    v_accvgpr_read_b32 v225, a93
    v_accvgpr_read_b32 v226, a94
    v_accvgpr_read_b32 v227, a95
    v_mul_f32 v224, v224, v55
    v_mul_f32 v225, v225, v55
    v_mul_f32 v226, v226, v55
    v_mul_f32 v227, v227, v55
    v_accvgpr_write_b32 a92, v224
    v_accvgpr_write_b32 a93, v225
    v_accvgpr_write_b32 a94, v226
    v_accvgpr_write_b32 a95, v227
    v_accvgpr_read_b32 v224, a96
    v_accvgpr_read_b32 v225, a97
    v_accvgpr_read_b32 v226, a98
    v_accvgpr_read_b32 v227, a99
    v_mul_f32 v224, v224, v52
    v_mul_f32 v225, v225, v52
    v_mul_f32 v226, v226, v52
    v_mul_f32 v227, v227, v52
    v_accvgpr_write_b32 a96, v224
    v_accvgpr_write_b32 a97, v225
    v_accvgpr_write_b32 a98, v226
    v_accvgpr_write_b32 a99, v227
    v_accvgpr_read_b32 v224, a100
    v_accvgpr_read_b32 v225, a101
    v_accvgpr_read_b32 v226, a102
    v_accvgpr_read_b32 v227, a103
    v_mul_f32 v224, v224, v53
    v_mul_f32 v225, v225, v53
    v_mul_f32 v226, v226, v53
    v_mul_f32 v227, v227, v53
    v_accvgpr_write_b32 a100, v224
    v_accvgpr_write_b32 a101, v225
    v_accvgpr_write_b32 a102, v226
    v_accvgpr_write_b32 a103, v227
    v_accvgpr_read_b32 v224, a104
    v_accvgpr_read_b32 v225, a105
    v_accvgpr_read_b32 v226, a106
    v_accvgpr_read_b32 v227, a107
    v_mul_f32 v224, v224, v54
    v_mul_f32 v225, v225, v54
    v_mul_f32 v226, v226, v54
    v_mul_f32 v227, v227, v54
    v_accvgpr_write_b32 a104, v224
    v_accvgpr_write_b32 a105, v225
    v_accvgpr_write_b32 a106, v226
    v_accvgpr_write_b32 a107, v227
    v_accvgpr_read_b32 v224, a108
    v_accvgpr_read_b32 v225, a109
    v_accvgpr_read_b32 v226, a110
    v_accvgpr_read_b32 v227, a111
    v_mul_f32 v224, v224, v55
    v_mul_f32 v225, v225, v55
    v_mul_f32 v226, v226, v55
    v_mul_f32 v227, v227, v55
    v_accvgpr_write_b32 a108, v224
    v_accvgpr_write_b32 a109, v225
    v_accvgpr_write_b32 a110, v226
    v_accvgpr_write_b32 a111, v227
    v_accvgpr_read_b32 v224, a112
    v_accvgpr_read_b32 v225, a113
    v_accvgpr_read_b32 v226, a114
    v_accvgpr_read_b32 v227, a115
    v_mul_f32 v224, v224, v52
    v_mul_f32 v225, v225, v52
    v_mul_f32 v226, v226, v52
    v_mul_f32 v227, v227, v52
    v_accvgpr_write_b32 a112, v224
    v_accvgpr_write_b32 a113, v225
    v_accvgpr_write_b32 a114, v226
    v_accvgpr_write_b32 a115, v227
    v_accvgpr_read_b32 v224, a116
    v_accvgpr_read_b32 v225, a117
    v_accvgpr_read_b32 v226, a118
    v_accvgpr_read_b32 v227, a119
    v_mul_f32 v224, v224, v53
    v_mul_f32 v225, v225, v53
    v_mul_f32 v226, v226, v53
    v_mul_f32 v227, v227, v53
    v_accvgpr_write_b32 a116, v224
    v_accvgpr_write_b32 a117, v225
    v_accvgpr_write_b32 a118, v226
    v_accvgpr_write_b32 a119, v227
    v_accvgpr_read_b32 v224, a120
    v_accvgpr_read_b32 v225, a121
    v_accvgpr_read_b32 v226, a122
    v_accvgpr_read_b32 v227, a123
    v_mul_f32 v224, v224, v54
    v_mul_f32 v225, v225, v54
    v_mul_f32 v226, v226, v54
    v_mul_f32 v227, v227, v54
    v_accvgpr_write_b32 a120, v224
    v_accvgpr_write_b32 a121, v225
    v_accvgpr_write_b32 a122, v226
    v_accvgpr_write_b32 a123, v227
    v_accvgpr_read_b32 v224, a124
    v_accvgpr_read_b32 v225, a125
    v_accvgpr_read_b32 v226, a126
    v_accvgpr_read_b32 v227, a127
    v_mul_f32 v224, v224, v55
    v_mul_f32 v225, v225, v55
    v_mul_f32 v226, v226, v55
    v_mul_f32 v227, v227, v55
    v_accvgpr_write_b32 a124, v224
    v_accvgpr_write_b32 a125, v225
    v_accvgpr_write_b32 a126, v226
    v_accvgpr_write_b32 a127, v227
    v_exp_f32 v232, v128
    v_exp_f32 v233, v129
    v_exp_f32 v234, v130
    v_exp_f32 v235, v131
    s_nop 0
    v_cvt_pk_bf16_f32 v192, v232, v233
    v_cvt_pk_bf16_f32 v193, v234, v235
    v_exp_f32 v232, v144
    v_exp_f32 v233, v145
    v_exp_f32 v234, v146
    v_exp_f32 v235, v147
    s_nop 0
    v_cvt_pk_bf16_f32 v194, v232, v233
    v_cvt_pk_bf16_f32 v195, v234, v235
    v_exp_f32 v232, v132
    v_exp_f32 v233, v133
    v_exp_f32 v234, v134
    v_exp_f32 v235, v135
    s_nop 0
    v_cvt_pk_bf16_f32 v196, v232, v233
    v_cvt_pk_bf16_f32 v197, v234, v235
    v_exp_f32 v232, v148
    v_exp_f32 v233, v149
    v_exp_f32 v234, v150
    v_exp_f32 v235, v151
    s_nop 0
    v_cvt_pk_bf16_f32 v198, v232, v233
    v_cvt_pk_bf16_f32 v199, v234, v235
    v_exp_f32 v232, v136
    v_exp_f32 v233, v137
    v_exp_f32 v234, v138
    v_exp_f32 v235, v139
    s_nop 0
    v_cvt_pk_bf16_f32 v200, v232, v233
    v_cvt_pk_bf16_f32 v201, v234, v235
    v_exp_f32 v232, v152
    v_exp_f32 v233, v153
    v_exp_f32 v234, v154
    v_exp_f32 v235, v155
    s_nop 0
    v_cvt_pk_bf16_f32 v202, v232, v233
    v_cvt_pk_bf16_f32 v203, v234, v235
    v_exp_f32 v232, v140
    v_exp_f32 v233, v141
    v_exp_f32 v234, v142
    v_exp_f32 v235, v143
    s_nop 0
    v_cvt_pk_bf16_f32 v204, v232, v233
    v_cvt_pk_bf16_f32 v205, v234, v235
    v_exp_f32 v232, v156
    v_exp_f32 v233, v157
    v_exp_f32 v234, v158
    v_exp_f32 v235, v159
    s_nop 0
    v_cvt_pk_bf16_f32 v206, v232, v233
    v_cvt_pk_bf16_f32 v207, v234, v235
    s_nop 1
    s_branch k2_ret_81
k2_rare_85:
    s_nop 7
    v_max_f32 v52, v160, v161
    v_max3_f32 v52, v52, v162, v163
    v_max3_f32 v52, v52, v176, v177
    v_max3_f32 v52, v52, v178, v179
    v_max_f32 v53, v164, v165
    v_max3_f32 v53, v53, v166, v167
    v_max3_f32 v53, v53, v180, v181
    v_max3_f32 v53, v53, v182, v183
    v_max_f32 v54, v168, v169
    v_max3_f32 v54, v54, v170, v171
    v_max3_f32 v54, v54, v184, v185
    v_max3_f32 v54, v54, v186, v187
    v_max_f32 v55, v172, v173
    v_max3_f32 v55, v55, v174, v175
    v_max3_f32 v55, v55, v188, v189
    v_max3_f32 v55, v55, v190, v191
    v_mov_b32 v224, v52
    v_mov_b32 v225, v53
    v_mov_b32 v226, v54
    v_mov_b32 v227, v55
    s_nop 1
    v_permlane16_swap_b32 v52, v224
    v_permlane16_swap_b32 v53, v225
    v_permlane16_swap_b32 v54, v226
    v_permlane16_swap_b32 v55, v227
    s_nop 1
    v_max_f32 v52, v52, v224
    v_max_f32 v53, v53, v225
    v_max_f32 v54, v54, v226
    v_max_f32 v55, v55, v227
    v_mov_b32 v224, v52
    v_mov_b32 v225, v53
    v_mov_b32 v226, v54
    v_mov_b32 v227, v55
    s_nop 1
    v_permlane32_swap_b32 v52, v224
    v_permlane32_swap_b32 v53, v225
    v_permlane32_swap_b32 v54, v226
    v_permlane32_swap_b32 v55, v227
    s_nop 1
    v_max_f32 v52, v52, v224
    v_max_f32 v53, v53, v225
    v_max_f32 v54, v54, v226
    v_max_f32 v55, v55, v227
    v_add_f32 v52, 0x41400000, v52
    v_max_f32 v52, 0, v52
    v_add_f32 v53, 0x41400000, v53
    v_max_f32 v53, 0, v53
    v_add_f32 v54, 0x41400000, v54
    v_max_f32 v54, 0, v54
    v_add_f32 v55, 0x41400000, v55
    v_max_f32 v55, 0, v55
    v_sub_f32 v160, v160, v52
    v_sub_f32 v161, v161, v52
    v_sub_f32 v162, v162, v52
    v_sub_f32 v163, v163, v52
    v_sub_f32 v164, v164, v53
    v_sub_f32 v165, v165, v53
    v_sub_f32 v166, v166, v53
    v_sub_f32 v167, v167, v53
    v_sub_f32 v168, v168, v54
    v_sub_f32 v169, v169, v54
    v_sub_f32 v170, v170, v54
    v_sub_f32 v171, v171, v54
    v_sub_f32 v172, v172, v55
    v_sub_f32 v173, v173, v55
    v_sub_f32 v174, v174, v55
    v_sub_f32 v175, v175, v55
    v_sub_f32 v176, v176, v52
    v_sub_f32 v177, v177, v52
    v_sub_f32 v178, v178, v52
    v_sub_f32 v179, v179, v52
    v_sub_f32 v180, v180, v53
    v_sub_f32 v181, v181, v53
    v_sub_f32 v182, v182, v53
    v_sub_f32 v183, v183, v53
    v_sub_f32 v184, v184, v54
    v_sub_f32 v185, v185, v54
    v_sub_f32 v186, v186, v54
    v_sub_f32 v187, v187, v54
    v_sub_f32 v188, v188, v55
    v_sub_f32 v189, v189, v55
    v_sub_f32 v190, v190, v55
    v_sub_f32 v191, v191, v55
    v_sub_f32 v128, v128, v52
    v_sub_f32 v16, v16, v52
    v_sub_f32 v129, v129, v52
    v_sub_f32 v17, v17, v52
    v_sub_f32 v130, v130, v52
    v_sub_f32 v18, v18, v52
    v_sub_f32 v131, v131, v52
    v_sub_f32 v19, v19, v52
    v_sub_f32 v132, v132, v53
    v_sub_f32 v20, v20, v53
    v_sub_f32 v133, v133, v53
    v_sub_f32 v21, v21, v53
    v_sub_f32 v134, v134, v53
    v_sub_f32 v22, v22, v53
    v_sub_f32 v135, v135, v53
    v_sub_f32 v23, v23, v53
    v_sub_f32 v136, v136, v54
    v_sub_f32 v24, v24, v54
    v_sub_f32 v137, v137, v54
    v_sub_f32 v25, v25, v54
    v_sub_f32 v138, v138, v54
    v_sub_f32 v26, v26, v54
    v_sub_f32 v139, v139, v54
    v_sub_f32 v27, v27, v54
    v_sub_f32 v140, v140, v55
    v_sub_f32 v28, v28, v55
    v_sub_f32 v141, v141, v55
    v_sub_f32 v29, v29, v55
    v_sub_f32 v142, v142, v55
    v_sub_f32 v30, v30, v55
    v_sub_f32 v143, v143, v55
    v_sub_f32 v31, v31, v55
    v_sub_f32 v144, v144, v52
    v_sub_f32 v32, v32, v52
    v_sub_f32 v145, v145, v52
    v_sub_f32 v33, v33, v52
    v_sub_f32 v146, v146, v52
    v_sub_f32 v34, v34, v52
    v_sub_f32 v147, v147, v52
    v_sub_f32 v35, v35, v52
    v_sub_f32 v148, v148, v53
    v_sub_f32 v36, v36, v53
    v_sub_f32 v149, v149, v53
    v_sub_f32 v37, v37, v53
    v_sub_f32 v150, v150, v53
    v_sub_f32 v38, v38, v53
    v_sub_f32 v151, v151, v53
    v_sub_f32 v39, v39, v53
    v_sub_f32 v152, v152, v54
    v_sub_f32 v40, v40, v54
    v_sub_f32 v153, v153, v54
    v_sub_f32 v41, v41, v54
    v_sub_f32 v154, v154, v54
    v_sub_f32 v42, v42, v54
    v_sub_f32 v155, v155, v54
    v_sub_f32 v43, v43, v54
    v_sub_f32 v156, v156, v55
    v_sub_f32 v44, v44, v55
    v_sub_f32 v157, v157, v55
    v_sub_f32 v45, v45, v55
    v_sub_f32 v158, v158, v55
    v_sub_f32 v46, v46, v55
    v_sub_f32 v159, v159, v55
    v_sub_f32 v47, v47, v55
    v_sub_f32 v8, v8, v52
    v_exp_f32 v52, -v52
    v_sub_f32 v9, v9, v53
    v_exp_f32 v53, -v53
    v_sub_f32 v10, v10, v54
    v_exp_f32 v54, -v54
    v_sub_f32 v11, v11, v55
    v_exp_f32 v55, -v55
    s_nop 0
    v_mul_f32 v12, v12, v52
    v_mul_f32 v48, v48, v53
    v_mul_f32 v248, v248, v54
    v_mul_f32 v252, v252, v55
    v_accvgpr_read_b32 v224, a0
    v_accvgpr_read_b32 v225, a1
    v_accvgpr_read_b32 v226, a2
    v_accvgpr_read_b32 v227, a3
    v_mul_f32 v224, v224, v52
    v_mul_f32 v225, v225, v52
    v_mul_f32 v226, v226, v52
    v_mul_f32 v227, v227, v52
    v_accvgpr_write_b32 a0, v224
    v_accvgpr_write_b32 a1, v225
    v_accvgpr_write_b32 a2, v226
    v_accvgpr_write_b32 a3, v227
    v_accvgpr_read_b32 v224, a4
    v_accvgpr_read_b32 v225, a5
    v_accvgpr_read_b32 v226, a6
    v_accvgpr_read_b32 v227, a7
    v_mul_f32 v224, v224, v53
    v_mul_f32 v225, v225, v53
    v_mul_f32 v226, v226, v53
    v_mul_f32 v227, v227, v53
    v_accvgpr_write_b32 a4, v224
    v_accvgpr_write_b32 a5, v225
    v_accvgpr_write_b32 a6, v226
    v_accvgpr_write_b32 a7, v227
    v_accvgpr_read_b32 v224, a8
    v_accvgpr_read_b32 v225, a9
    v_accvgpr_read_b32 v226, a10
    v_accvgpr_read_b32 v227, a11
    v_mul_f32 v224, v224, v54
    v_mul_f32 v225, v225, v54
    v_mul_f32 v226, v226, v54
    v_mul_f32 v227, v227, v54
    v_accvgpr_write_b32 a8, v224
    v_accvgpr_write_b32 a9, v225
    v_accvgpr_write_b32 a10, v226
    v_accvgpr_write_b32 a11, v227
    v_accvgpr_read_b32 v224, a12
    v_accvgpr_read_b32 v225, a13
    v_accvgpr_read_b32 v226, a14
    v_accvgpr_read_b32 v227, a15
    v_mul_f32 v224, v224, v55
    v_mul_f32 v225, v225, v55
    v_mul_f32 v226, v226, v55
    v_mul_f32 v227, v227, v55
    v_accvgpr_write_b32 a12, v224
    v_accvgpr_write_b32 a13, v225
    v_accvgpr_write_b32 a14, v226
    v_accvgpr_write_b32 a15, v227
    v_accvgpr_read_b32 v224, a16
    v_accvgpr_read_b32 v225, a17
    v_accvgpr_read_b32 v226, a18
    v_accvgpr_read_b32 v227, a19
    v_mul_f32 v224, v224, v52
    v_mul_f32 v225, v225, v52
    v_mul_f32 v226, v226, v52
    v_mul_f32 v227, v227, v52
    v_accvgpr_write_b32 a16, v224
    v_accvgpr_write_b32 a17, v225
    v_accvgpr_write_b32 a18, v226
    v_accvgpr_write_b32 a19, v227
    v_accvgpr_read_b32 v224, a20
    v_accvgpr_read_b32 v225, a21
    v_accvgpr_read_b32 v226, a22
    v_accvgpr_read_b32 v227, a23
    v_mul_f32 v224, v224, v53
    v_mul_f32 v225, v225, v53
    v_mul_f32 v226, v226, v53
    v_mul_f32 v227, v227, v53
    v_accvgpr_write_b32 a20, v224
    v_accvgpr_write_b32 a21, v225
    v_accvgpr_write_b32 a22, v226
    v_accvgpr_write_b32 a23, v227
    v_accvgpr_read_b32 v224, a24
    v_accvgpr_read_b32 v225, a25
    v_accvgpr_read_b32 v226, a26
    v_accvgpr_read_b32 v227, a27
    v_mul_f32 v224, v224, v54
    v_mul_f32 v225, v225, v54
    v_mul_f32 v226, v226, v54
    v_mul_f32 v227, v227, v54
    v_accvgpr_write_b32 a24, v224
    v_accvgpr_write_b32 a25, v225
    v_accvgpr_write_b32 a26, v226
    v_accvgpr_write_b32 a27, v227
    v_accvgpr_read_b32 v224, a28
    v_accvgpr_read_b32 v225, a29
    v_accvgpr_read_b32 v226, a30
    v_accvgpr_read_b32 v227, a31
    v_mul_f32 v224, v224, v55
    v_mul_f32 v225, v225, v55
    v_mul_f32 v226, v226, v55
    v_mul_f32 v227, v227, v55
    v_accvgpr_write_b32 a28, v224
    v_accvgpr_write_b32 a29, v225
    v_accvgpr_write_b32 a30, v226
    v_accvgpr_write_b32 a31, v227
    v_accvgpr_read_b32 v224, a32
    v_accvgpr_read_b32 v225, a33
    v_accvgpr_read_b32 v226, a34
    v_accvgpr_read_b32 v227, a35
    v_mul_f32 v224, v224, v52
    v_mul_f32 v225, v225, v52
    v_mul_f32 v226, v226, v52
    v_mul_f32 v227, v227, v52
    v_accvgpr_write_b32 a32, v224
    v_accvgpr_write_b32 a33, v225
    v_accvgpr_write_b32 a34, v226
    v_accvgpr_write_b32 a35, v227
    v_accvgpr_read_b32 v224, a36
    v_accvgpr_read_b32 v225, a37
    v_accvgpr_read_b32 v226, a38
    v_accvgpr_read_b32 v227, a39
    v_mul_f32 v224, v224, v53
    v_mul_f32 v225, v225, v53
    v_mul_f32 v226, v226, v53
    v_mul_f32 v227, v227, v53
    v_accvgpr_write_b32 a36, v224
    v_accvgpr_write_b32 a37, v225
    v_accvgpr_write_b32 a38, v226
    v_accvgpr_write_b32 a39, v227
    v_accvgpr_read_b32 v224, a40
    v_accvgpr_read_b32 v225, a41
    v_accvgpr_read_b32 v226, a42
    v_accvgpr_read_b32 v227, a43
    v_mul_f32 v224, v224, v54
    v_mul_f32 v225, v225, v54
    v_mul_f32 v226, v226, v54
    v_mul_f32 v227, v227, v54
    v_accvgpr_write_b32 a40, v224
    v_accvgpr_write_b32 a41, v225
    v_accvgpr_write_b32 a42, v226
    v_accvgpr_write_b32 a43, v227
    v_accvgpr_read_b32 v224, a44
    v_accvgpr_read_b32 v225, a45
    v_accvgpr_read_b32 v226, a46
    v_accvgpr_read_b32 v227, a47
    v_mul_f32 v224, v224, v55
    v_mul_f32 v225, v225, v55
    v_mul_f32 v226, v226, v55
    v_mul_f32 v227, v227, v55
    v_accvgpr_write_b32 a44, v224
    v_accvgpr_write_b32 a45, v225
    v_accvgpr_write_b32 a46, v226
    v_accvgpr_write_b32 a47, v227
    v_accvgpr_read_b32 v224, a48
    v_accvgpr_read_b32 v225, a49
    v_accvgpr_read_b32 v226, a50
    v_accvgpr_read_b32 v227, a51
    v_mul_f32 v224, v224, v52
    v_mul_f32 v225, v225, v52
    v_mul_f32 v226, v226, v52
    v_mul_f32 v227, v227, v52
    v_accvgpr_write_b32 a48, v224
    v_accvgpr_write_b32 a49, v225
    v_accvgpr_write_b32 a50, v226
    v_accvgpr_write_b32 a51, v227
    v_accvgpr_read_b32 v224, a52
    v_accvgpr_read_b32 v225, a53
    v_accvgpr_read_b32 v226, a54
    v_accvgpr_read_b32 v227, a55
    v_mul_f32 v224, v224, v53
    v_mul_f32 v225, v225, v53
    v_mul_f32 v226, v226, v53
    v_mul_f32 v227, v227, v53
    v_accvgpr_write_b32 a52, v224
    v_accvgpr_write_b32 a53, v225
    v_accvgpr_write_b32 a54, v226
    v_accvgpr_write_b32 a55, v227
    v_accvgpr_read_b32 v224, a56
    v_accvgpr_read_b32 v225, a57
    v_accvgpr_read_b32 v226, a58
    v_accvgpr_read_b32 v227, a59
    v_mul_f32 v224, v224, v54
    v_mul_f32 v225, v225, v54
    v_mul_f32 v226, v226, v54
    v_mul_f32 v227, v227, v54
    v_accvgpr_write_b32 a56, v224
    v_accvgpr_write_b32 a57, v225
    v_accvgpr_write_b32 a58, v226
    v_accvgpr_write_b32 a59, v227
    v_accvgpr_read_b32 v224, a60
    v_accvgpr_read_b32 v225, a61
    v_accvgpr_read_b32 v226, a62
    v_accvgpr_read_b32 v227, a63
    v_mul_f32 v224, v224, v55
    v_mul_f32 v225, v225, v55
    v_mul_f32 v226, v226, v55
    v_mul_f32 v227, v227, v55
    v_accvgpr_write_b32 a60, v224
    v_accvgpr_write_b32 a61, v225
    v_accvgpr_write_b32 a62, v226
    v_accvgpr_write_b32 a63, v227
    v_accvgpr_read_b32 v224, a64
    v_accvgpr_read_b32 v225, a65
    v_accvgpr_read_b32 v226, a66
    v_accvgpr_read_b32 v227, a67
    v_mul_f32 v224, v224, v52
    v_mul_f32 v225, v225, v52
    v_mul_f32 v226, v226, v52
    v_mul_f32 v227, v227, v52
    v_accvgpr_write_b32 a64, v224
    v_accvgpr_write_b32 a65, v225
    v_accvgpr_write_b32 a66, v226
    v_accvgpr_write_b32 a67, v227
    v_accvgpr_read_b32 v224, a68
    v_accvgpr_read_b32 v225, a69
    v_accvgpr_read_b32 v226, a70
    v_accvgpr_read_b32 v227, a71
    v_mul_f32 v224, v224, v53
    v_mul_f32 v225, v225, v53
    v_mul_f32 v226, v226, v53
    v_mul_f32 v227, v227, v53
    v_accvgpr_write_b32 a68, v224
    v_accvgpr_write_b32 a69, v225
    v_accvgpr_write_b32 a70, v226
    v_accvgpr_write_b32 a71, v227
    v_accvgpr_read_b32 v224, a72
    v_accvgpr_read_b32 v225, a73
    v_accvgpr_read_b32 v226, a74
    v_accvgpr_read_b32 v227, a75
    v_mul_f32 v224, v224, v54
    v_mul_f32 v225, v225, v54
    v_mul_f32 v226, v226, v54
    v_mul_f32 v227, v227, v54
    v_accvgpr_write_b32 a72, v224
    v_accvgpr_write_b32 a73, v225
    v_accvgpr_write_b32 a74, v226
    v_accvgpr_write_b32 a75, v227
    v_accvgpr_read_b32 v224, a76
    v_accvgpr_read_b32 v225, a77
    v_accvgpr_read_b32 v226, a78
    v_accvgpr_read_b32 v227, a79
    v_mul_f32 v224, v224, v55
    v_mul_f32 v225, v225, v55
    v_mul_f32 v226, v226, v55
    v_mul_f32 v227, v227, v55
    v_accvgpr_write_b32 a76, v224
    v_accvgpr_write_b32 a77, v225
    v_accvgpr_write_b32 a78, v226
    v_accvgpr_write_b32 a79, v227
    v_accvgpr_read_b32 v224, a80
    v_accvgpr_read_b32 v225, a81
    v_accvgpr_read_b32 v226, a82
    v_accvgpr_read_b32 v227, a83
    v_mul_f32 v224, v224, v52
    v_mul_f32 v225, v225, v52
    v_mul_f32 v226, v226, v52
    v_mul_f32 v227, v227, v52
    v_accvgpr_write_b32 a80, v224
    v_accvgpr_write_b32 a81, v225
    v_accvgpr_write_b32 a82, v226
    v_accvgpr_write_b32 a83, v227
    v_accvgpr_read_b32 v224, a84
    v_accvgpr_read_b32 v225, a85
    v_accvgpr_read_b32 v226, a86
    v_accvgpr_read_b32 v227, a87
    v_mul_f32 v224, v224, v53
    v_mul_f32 v225, v225, v53
    v_mul_f32 v226, v226, v53
    v_mul_f32 v227, v227, v53
    v_accvgpr_write_b32 a84, v224
    v_accvgpr_write_b32 a85, v225
    v_accvgpr_write_b32 a86, v226
    v_accvgpr_write_b32 a87, v227
    v_accvgpr_read_b32 v224, a88
    v_accvgpr_read_b32 v225, a89
    v_accvgpr_read_b32 v226, a90
    v_accvgpr_read_b32 v227, a91
    v_mul_f32 v224, v224, v54
    v_mul_f32 v225, v225, v54
    v_mul_f32 v226, v226, v54
    v_mul_f32 v227, v227, v54
    v_accvgpr_write_b32 a88, v224
    v_accvgpr_write_b32 a89, v225
    v_accvgpr_write_b32 a90, v226
    v_accvgpr_write_b32 a91, v227
    v_accvgpr_read_b32 v224, a92
    v_accvgpr_read_b32 v225, a93
    v_accvgpr_read_b32 v226, a94
    v_accvgpr_read_b32 v227, a95
    v_mul_f32 v224, v224, v55
    v_mul_f32 v225, v225, v55
    v_mul_f32 v226, v226, v55
    v_mul_f32 v227, v227, v55
    v_accvgpr_write_b32 a92, v224
    v_accvgpr_write_b32 a93, v225
    v_accvgpr_write_b32 a94, v226
    v_accvgpr_write_b32 a95, v227
    v_accvgpr_read_b32 v224, a96
    v_accvgpr_read_b32 v225, a97
    v_accvgpr_read_b32 v226, a98
    v_accvgpr_read_b32 v227, a99
    v_mul_f32 v224, v224, v52
    v_mul_f32 v225, v225, v52
    v_mul_f32 v226, v226, v52
    v_mul_f32 v227, v227, v52
    v_accvgpr_write_b32 a96, v224
    v_accvgpr_write_b32 a97, v225
    v_accvgpr_write_b32 a98, v226
    v_accvgpr_write_b32 a99, v227
    v_accvgpr_read_b32 v224, a100
    v_accvgpr_read_b32 v225, a101
    v_accvgpr_read_b32 v226, a102
    v_accvgpr_read_b32 v227, a103
    v_mul_f32 v224, v224, v53
    v_mul_f32 v225, v225, v53
    v_mul_f32 v226, v226, v53
    v_mul_f32 v227, v227, v53
    v_accvgpr_write_b32 a100, v224
    v_accvgpr_write_b32 a101, v225
    v_accvgpr_write_b32 a102, v226
    v_accvgpr_write_b32 a103, v227
    v_accvgpr_read_b32 v224, a104
    v_accvgpr_read_b32 v225, a105
    v_accvgpr_read_b32 v226, a106
    v_accvgpr_read_b32 v227, a107
    v_mul_f32 v224, v224, v54
    v_mul_f32 v225, v225, v54
    v_mul_f32 v226, v226, v54
    v_mul_f32 v227, v227, v54
    v_accvgpr_write_b32 a104, v224
    v_accvgpr_write_b32 a105, v225
    v_accvgpr_write_b32 a106, v226
    v_accvgpr_write_b32 a107, v227
    v_accvgpr_read_b32 v224, a108
    v_accvgpr_read_b32 v225, a109
    v_accvgpr_read_b32 v226, a110
    v_accvgpr_read_b32 v227, a111
    v_mul_f32 v224, v224, v55
    v_mul_f32 v225, v225, v55
    v_mul_f32 v226, v226, v55
    v_mul_f32 v227, v227, v55
    v_accvgpr_write_b32 a108, v224
    v_accvgpr_write_b32 a109, v225
    v_accvgpr_write_b32 a110, v226
    v_accvgpr_write_b32 a111, v227
    v_accvgpr_read_b32 v224, a112
    v_accvgpr_read_b32 v225, a113
    v_accvgpr_read_b32 v226, a114
    v_accvgpr_read_b32 v227, a115
    v_mul_f32 v224, v224, v52
    v_mul_f32 v225, v225, v52
    v_mul_f32 v226, v226, v52
    v_mul_f32 v227, v227, v52
    v_accvgpr_write_b32 a112, v224
    v_accvgpr_write_b32 a113, v225
    v_accvgpr_write_b32 a114, v226
    v_accvgpr_write_b32 a115, v227
    v_accvgpr_read_b32 v224, a116
    v_accvgpr_read_b32 v225, a117
    v_accvgpr_read_b32 v226, a118
    v_accvgpr_read_b32 v227, a119
    v_mul_f32 v224, v224, v53
    v_mul_f32 v225, v225, v53
    v_mul_f32 v226, v226, v53
    v_mul_f32 v227, v227, v53
    v_accvgpr_write_b32 a116, v224
    v_accvgpr_write_b32 a117, v225
    v_accvgpr_write_b32 a118, v226
    v_accvgpr_write_b32 a119, v227
    v_accvgpr_read_b32 v224, a120
    v_accvgpr_read_b32 v225, a121
    v_accvgpr_read_b32 v226, a122
    v_accvgpr_read_b32 v227, a123
    v_mul_f32 v224, v224, v54
    v_mul_f32 v225, v225, v54
    v_mul_f32 v226, v226, v54
    v_mul_f32 v227, v227, v54
    v_accvgpr_write_b32 a120, v224
    v_accvgpr_write_b32 a121, v225
    v_accvgpr_write_b32 a122, v226
    v_accvgpr_write_b32 a123, v227
    v_accvgpr_read_b32 v224, a124
    v_accvgpr_read_b32 v225, a125
    v_accvgpr_read_b32 v226, a126
    v_accvgpr_read_b32 v227, a127
    v_mul_f32 v224, v224, v55
    v_mul_f32 v225, v225, v55
    v_mul_f32 v226, v226, v55
    v_mul_f32 v227, v227, v55
    v_accvgpr_write_b32 a124, v224
    v_accvgpr_write_b32 a125, v225
    v_accvgpr_write_b32 a126, v226
    v_accvgpr_write_b32 a127, v227
    v_exp_f32 v232, v160
    v_exp_f32 v233, v161
    v_exp_f32 v234, v162
    v_exp_f32 v235, v163
    s_nop 0
    v_cvt_pk_bf16_f32 v208, v232, v233
    v_cvt_pk_bf16_f32 v209, v234, v235
    v_exp_f32 v232, v176
    v_exp_f32 v233, v177
    v_exp_f32 v234, v178
    v_exp_f32 v235, v179
    s_nop 0
    v_cvt_pk_bf16_f32 v210, v232, v233
    v_cvt_pk_bf16_f32 v211, v234, v235
    v_exp_f32 v232, v164
    v_exp_f32 v233, v165
    v_exp_f32 v234, v166
    v_exp_f32 v235, v167
    s_nop 0
    v_cvt_pk_bf16_f32 v212, v232, v233
    v_cvt_pk_bf16_f32 v213, v234, v235
    v_exp_f32 v232, v180
    v_exp_f32 v233, v181
    v_exp_f32 v234, v182
    v_exp_f32 v235, v183
    s_nop 0
    v_cvt_pk_bf16_f32 v214, v232, v233
    v_cvt_pk_bf16_f32 v215, v234, v235
    v_exp_f32 v232, v168
    v_exp_f32 v233, v169
    v_exp_f32 v234, v170
    v_exp_f32 v235, v171
    s_nop 0
    v_cvt_pk_bf16_f32 v216, v232, v233
    v_cvt_pk_bf16_f32 v217, v234, v235
    v_exp_f32 v232, v184
    v_exp_f32 v233, v185
    v_exp_f32 v234, v186
    v_exp_f32 v235, v187
    s_nop 0
    v_cvt_pk_bf16_f32 v218, v232, v233
    v_cvt_pk_bf16_f32 v219, v234, v235
    v_exp_f32 v232, v172
    v_exp_f32 v233, v173
    v_exp_f32 v234, v174
    v_exp_f32 v235, v175
    s_nop 0
    v_cvt_pk_bf16_f32 v220, v232, v233
    v_cvt_pk_bf16_f32 v221, v234, v235
    v_exp_f32 v232, v188
    v_exp_f32 v233, v189
    v_exp_f32 v234, v190
    v_exp_f32 v235, v191
    s_nop 0
    v_cvt_pk_bf16_f32 v222, v232, v233
    v_cvt_pk_bf16_f32 v223, v234, v235
    s_nop 1
    s_branch k2_ret_86
k2_rare_89:
    s_nop 7
    v_max_f32 v52, v128, v129
    v_max3_f32 v52, v52, v130, v131
    v_max3_f32 v52, v52, v144, v145
    v_max3_f32 v52, v52, v146, v147
    v_max_f32 v53, v132, v133
    v_max3_f32 v53, v53, v134, v135
    v_max3_f32 v53, v53, v148, v149
    v_max3_f32 v53, v53, v150, v151
    v_max_f32 v54, v136, v137
    v_max3_f32 v54, v54, v138, v139
    v_max3_f32 v54, v54, v152, v153
    v_max3_f32 v54, v54, v154, v155
    v_max_f32 v55, v140, v141
    v_max3_f32 v55, v55, v142, v143
    v_max3_f32 v55, v55, v156, v157
    v_max3_f32 v55, v55, v158, v159
    v_mov_b32 v224, v52
    v_mov_b32 v225, v53
    v_mov_b32 v226, v54
    v_mov_b32 v227, v55
    s_nop 1
    v_permlane16_swap_b32 v52, v224
    v_permlane16_swap_b32 v53, v225
    v_permlane16_swap_b32 v54, v226
    v_permlane16_swap_b32 v55, v227
    s_nop 1
    v_max_f32 v52, v52, v224
    v_max_f32 v53, v53, v225
    v_max_f32 v54, v54, v226
    v_max_f32 v55, v55, v227
    v_mov_b32 v224, v52
    v_mov_b32 v225, v53
    v_mov_b32 v226, v54
    v_mov_b32 v227, v55
    s_nop 1
    v_permlane32_swap_b32 v52, v224
    v_permlane32_swap_b32 v53, v225
    v_permlane32_swap_b32 v54, v226
    v_permlane32_swap_b32 v55, v227
    s_nop 1
    v_max_f32 v52, v52, v224
    v_max_f32 v53, v53, v225
    v_max_f32 v54, v54, v226
    v_max_f32 v55, v55, v227
    v_add_f32 v52, 0x41400000, v52
    v_max_f32 v52, 0, v52
    v_add_f32 v53, 0x41400000, v53
    v_max_f32 v53, 0, v53
    v_add_f32 v54, 0x41400000, v54
    v_max_f32 v54, 0, v54
    v_add_f32 v55, 0x41400000, v55
    v_max_f32 v55, 0, v55
    v_sub_f32 v128, v128, v52
    v_sub_f32 v129, v129, v52
    v_sub_f32 v130, v130, v52
    v_sub_f32 v131, v131, v52
    v_sub_f32 v132, v132, v53
    v_sub_f32 v133, v133, v53
    v_sub_f32 v134, v134, v53
    v_sub_f32 v135, v135, v53
    v_sub_f32 v136, v136, v54
    v_sub_f32 v137, v137, v54
    v_sub_f32 v138, v138, v54
    v_sub_f32 v139, v139, v54
    v_sub_f32 v140, v140, v55
    v_sub_f32 v141, v141, v55
    v_sub_f32 v142, v142, v55
    v_sub_f32 v143, v143, v55
    v_sub_f32 v144, v144, v52
    v_sub_f32 v145, v145, v52
    v_sub_f32 v146, v146, v52
    v_sub_f32 v147, v147, v52
    v_sub_f32 v148, v148, v53
    v_sub_f32 v149, v149, v53
    v_sub_f32 v150, v150, v53
    v_sub_f32 v151, v151, v53
    v_sub_f32 v152, v152, v54
    v_sub_f32 v153, v153, v54
    v_sub_f32 v154, v154, v54
    v_sub_f32 v155, v155, v54
    v_sub_f32 v156, v156, v55
    v_sub_f32 v157, v157, v55
    v_sub_f32 v158, v158, v55
    v_sub_f32 v159, v159, v55
    v_sub_f32 v160, v160, v52
    v_sub_f32 v16, v16, v52
    v_sub_f32 v161, v161, v52
    v_sub_f32 v17, v17, v52
    v_sub_f32 v162, v162, v52
    v_sub_f32 v18, v18, v52
    v_sub_f32 v163, v163, v52
    v_sub_f32 v19, v19, v52
    v_sub_f32 v164, v164, v53
    v_sub_f32 v20, v20, v53
    v_sub_f32 v165, v165, v53
    v_sub_f32 v21, v21, v53
    v_sub_f32 v166, v166, v53
    v_sub_f32 v22, v22, v53
    v_sub_f32 v167, v167, v53
    v_sub_f32 v23, v23, v53
    v_sub_f32 v168, v168, v54
    v_sub_f32 v24, v24, v54
    v_sub_f32 v169, v169, v54
    v_sub_f32 v25, v25, v54
    v_sub_f32 v170, v170, v54
    v_sub_f32 v26, v26, v54
    v_sub_f32 v171, v171, v54
    v_sub_f32 v27, v27, v54
    v_sub_f32 v172, v172, v55
    v_sub_f32 v28, v28, v55
    v_sub_f32 v173, v173, v55
    v_sub_f32 v29, v29, v55
    v_sub_f32 v174, v174, v55
    v_sub_f32 v30, v30, v55
    v_sub_f32 v175, v175, v55
    v_sub_f32 v31, v31, v55
    v_sub_f32 v176, v176, v52
    v_sub_f32 v32, v32, v52
    v_sub_f32 v177, v177, v52
    v_sub_f32 v33, v33, v52
    v_sub_f32 v178, v178, v52
    v_sub_f32 v34, v34, v52
    v_sub_f32 v179, v179, v52
    v_sub_f32 v35, v35, v52
    v_sub_f32 v180, v180, v53
    v_sub_f32 v36, v36, v53
    v_sub_f32 v181, v181, v53
    v_sub_f32 v37, v37, v53
    v_sub_f32 v182, v182, v53
    v_sub_f32 v38, v38, v53
    v_sub_f32 v183, v183, v53
    v_sub_f32 v39, v39, v53
    v_sub_f32 v184, v184, v54
    v_sub_f32 v40, v40, v54
    v_sub_f32 v185, v185, v54
    v_sub_f32 v41, v41, v54
    v_sub_f32 v186, v186, v54
    v_sub_f32 v42, v42, v54
    v_sub_f32 v187, v187, v54
    v_sub_f32 v43, v43, v54
    v_sub_f32 v188, v188, v55
    v_sub_f32 v44, v44, v55
    v_sub_f32 v189, v189, v55
    v_sub_f32 v45, v45, v55
    v_sub_f32 v190, v190, v55
    v_sub_f32 v46, v46, v55
    v_sub_f32 v191, v191, v55
    v_sub_f32 v47, v47, v55
    v_sub_f32 v8, v8, v52
    v_exp_f32 v52, -v52
    v_sub_f32 v9, v9, v53
    v_exp_f32 v53, -v53
    v_sub_f32 v10, v10, v54
    v_exp_f32 v54, -v54
    v_sub_f32 v11, v11, v55
    v_exp_f32 v55, -v55
    s_nop 0
    v_mul_f32 v12, v12, v52
    v_mul_f32 v48, v48, v53
    v_mul_f32 v248, v248, v54
    v_mul_f32 v252, v252, v55
    v_accvgpr_read_b32 v224, a0
    v_accvgpr_read_b32 v225, a1
    v_accvgpr_read_b32 v226, a2
    v_accvgpr_read_b32 v227, a3
    v_mul_f32 v224, v224, v52
    v_mul_f32 v225, v225, v52
    v_mul_f32 v226, v226, v52
    v_mul_f32 v227, v227, v52
    v_accvgpr_write_b32 a0, v224
    v_accvgpr_write_b32 a1, v225
    v_accvgpr_write_b32 a2, v226
    v_accvgpr_write_b32 a3, v227
    v_accvgpr_read_b32 v224, a4
    v_accvgpr_read_b32 v225, a5
    v_accvgpr_read_b32 v226, a6
    v_accvgpr_read_b32 v227, a7
    v_mul_f32 v224, v224, v53
    v_mul_f32 v225, v225, v53
    v_mul_f32 v226, v226, v53
    v_mul_f32 v227, v227, v53
    v_accvgpr_write_b32 a4, v224
    v_accvgpr_write_b32 a5, v225
    v_accvgpr_write_b32 a6, v226
    v_accvgpr_write_b32 a7, v227
    v_accvgpr_read_b32 v224, a8
    v_accvgpr_read_b32 v225, a9
    v_accvgpr_read_b32 v226, a10
    v_accvgpr_read_b32 v227, a11
    v_mul_f32 v224, v224, v54
    v_mul_f32 v225, v225, v54
    v_mul_f32 v226, v226, v54
    v_mul_f32 v227, v227, v54
    v_accvgpr_write_b32 a8, v224
    v_accvgpr_write_b32 a9, v225
    v_accvgpr_write_b32 a10, v226
    v_accvgpr_write_b32 a11, v227
    v_accvgpr_read_b32 v224, a12
    v_accvgpr_read_b32 v225, a13
    v_accvgpr_read_b32 v226, a14
    v_accvgpr_read_b32 v227, a15
    v_mul_f32 v224, v224, v55
    v_mul_f32 v225, v225, v55
    v_mul_f32 v226, v226, v55
    v_mul_f32 v227, v227, v55
    v_accvgpr_write_b32 a12, v224
    v_accvgpr_write_b32 a13, v225
    v_accvgpr_write_b32 a14, v226
    v_accvgpr_write_b32 a15, v227
    v_accvgpr_read_b32 v224, a16
    v_accvgpr_read_b32 v225, a17
    v_accvgpr_read_b32 v226, a18
    v_accvgpr_read_b32 v227, a19
    v_mul_f32 v224, v224, v52
    v_mul_f32 v225, v225, v52
    v_mul_f32 v226, v226, v52
    v_mul_f32 v227, v227, v52
    v_accvgpr_write_b32 a16, v224
    v_accvgpr_write_b32 a17, v225
    v_accvgpr_write_b32 a18, v226
    v_accvgpr_write_b32 a19, v227
    v_accvgpr_read_b32 v224, a20
    v_accvgpr_read_b32 v225, a21
    v_accvgpr_read_b32 v226, a22
    v_accvgpr_read_b32 v227, a23
    v_mul_f32 v224, v224, v53
    v_mul_f32 v225, v225, v53
    v_mul_f32 v226, v226, v53
    v_mul_f32 v227, v227, v53
    v_accvgpr_write_b32 a20, v224
    v_accvgpr_write_b32 a21, v225
    v_accvgpr_write_b32 a22, v226
    v_accvgpr_write_b32 a23, v227
    v_accvgpr_read_b32 v224, a24
    v_accvgpr_read_b32 v225, a25
    v_accvgpr_read_b32 v226, a26
    v_accvgpr_read_b32 v227, a27
    v_mul_f32 v224, v224, v54
    v_mul_f32 v225, v225, v54
    v_mul_f32 v226, v226, v54
    v_mul_f32 v227, v227, v54
    v_accvgpr_write_b32 a24, v224
    v_accvgpr_write_b32 a25, v225
    v_accvgpr_write_b32 a26, v226
    v_accvgpr_write_b32 a27, v227
    v_accvgpr_read_b32 v224, a28
    v_accvgpr_read_b32 v225, a29
    v_accvgpr_read_b32 v226, a30
    v_accvgpr_read_b32 v227, a31
    v_mul_f32 v224, v224, v55
    v_mul_f32 v225, v225, v55
    v_mul_f32 v226, v226, v55
    v_mul_f32 v227, v227, v55
    v_accvgpr_write_b32 a28, v224
    v_accvgpr_write_b32 a29, v225
    v_accvgpr_write_b32 a30, v226
    v_accvgpr_write_b32 a31, v227
    v_accvgpr_read_b32 v224, a32
    v_accvgpr_read_b32 v225, a33
    v_accvgpr_read_b32 v226, a34
    v_accvgpr_read_b32 v227, a35
    v_mul_f32 v224, v224, v52
    v_mul_f32 v225, v225, v52
    v_mul_f32 v226, v226, v52
    v_mul_f32 v227, v227, v52
    v_accvgpr_write_b32 a32, v224
    v_accvgpr_write_b32 a33, v225
    v_accvgpr_write_b32 a34, v226
    v_accvgpr_write_b32 a35, v227
    v_accvgpr_read_b32 v224, a36
    v_accvgpr_read_b32 v225, a37
    v_accvgpr_read_b32 v226, a38
    v_accvgpr_read_b32 v227, a39
    v_mul_f32 v224, v224, v53
    v_mul_f32 v225, v225, v53
    v_mul_f32 v226, v226, v53
    v_mul_f32 v227, v227, v53
    v_accvgpr_write_b32 a36, v224
    v_accvgpr_write_b32 a37, v225
    v_accvgpr_write_b32 a38, v226
    v_accvgpr_write_b32 a39, v227
    v_accvgpr_read_b32 v224, a40
    v_accvgpr_read_b32 v225, a41
    v_accvgpr_read_b32 v226, a42
    v_accvgpr_read_b32 v227, a43
    v_mul_f32 v224, v224, v54
    v_mul_f32 v225, v225, v54
    v_mul_f32 v226, v226, v54
    v_mul_f32 v227, v227, v54
    v_accvgpr_write_b32 a40, v224
    v_accvgpr_write_b32 a41, v225
    v_accvgpr_write_b32 a42, v226
    v_accvgpr_write_b32 a43, v227
    v_accvgpr_read_b32 v224, a44
    v_accvgpr_read_b32 v225, a45
    v_accvgpr_read_b32 v226, a46
    v_accvgpr_read_b32 v227, a47
    v_mul_f32 v224, v224, v55
    v_mul_f32 v225, v225, v55
    v_mul_f32 v226, v226, v55
    v_mul_f32 v227, v227, v55
    v_accvgpr_write_b32 a44, v224
    v_accvgpr_write_b32 a45, v225
    v_accvgpr_write_b32 a46, v226
    v_accvgpr_write_b32 a47, v227
    v_accvgpr_read_b32 v224, a48
    v_accvgpr_read_b32 v225, a49
    v_accvgpr_read_b32 v226, a50
    v_accvgpr_read_b32 v227, a51
    v_mul_f32 v224, v224, v52
    v_mul_f32 v225, v225, v52
    v_mul_f32 v226, v226, v52
    v_mul_f32 v227, v227, v52
    v_accvgpr_write_b32 a48, v224
    v_accvgpr_write_b32 a49, v225
    v_accvgpr_write_b32 a50, v226
    v_accvgpr_write_b32 a51, v227
    v_accvgpr_read_b32 v224, a52
    v_accvgpr_read_b32 v225, a53
    v_accvgpr_read_b32 v226, a54
    v_accvgpr_read_b32 v227, a55
    v_mul_f32 v224, v224, v53
    v_mul_f32 v225, v225, v53
    v_mul_f32 v226, v226, v53
    v_mul_f32 v227, v227, v53
    v_accvgpr_write_b32 a52, v224
    v_accvgpr_write_b32 a53, v225
    v_accvgpr_write_b32 a54, v226
    v_accvgpr_write_b32 a55, v227
    v_accvgpr_read_b32 v224, a56
    v_accvgpr_read_b32 v225, a57
    v_accvgpr_read_b32 v226, a58
    v_accvgpr_read_b32 v227, a59
    v_mul_f32 v224, v224, v54
    v_mul_f32 v225, v225, v54
    v_mul_f32 v226, v226, v54
    v_mul_f32 v227, v227, v54
    v_accvgpr_write_b32 a56, v224
    v_accvgpr_write_b32 a57, v225
    v_accvgpr_write_b32 a58, v226
    v_accvgpr_write_b32 a59, v227
    v_accvgpr_read_b32 v224, a60
    v_accvgpr_read_b32 v225, a61
    v_accvgpr_read_b32 v226, a62
    v_accvgpr_read_b32 v227, a63
    v_mul_f32 v224, v224, v55
    v_mul_f32 v225, v225, v55
    v_mul_f32 v226, v226, v55
    v_mul_f32 v227, v227, v55
    v_accvgpr_write_b32 a60, v224
    v_accvgpr_write_b32 a61, v225
    v_accvgpr_write_b32 a62, v226
    v_accvgpr_write_b32 a63, v227
    v_accvgpr_read_b32 v224, a64
    v_accvgpr_read_b32 v225, a65
    v_accvgpr_read_b32 v226, a66
    v_accvgpr_read_b32 v227, a67
    v_mul_f32 v224, v224, v52
    v_mul_f32 v225, v225, v52
    v_mul_f32 v226, v226, v52
    v_mul_f32 v227, v227, v52
    v_accvgpr_write_b32 a64, v224
    v_accvgpr_write_b32 a65, v225
    v_accvgpr_write_b32 a66, v226
    v_accvgpr_write_b32 a67, v227
    v_accvgpr_read_b32 v224, a68
    v_accvgpr_read_b32 v225, a69
    v_accvgpr_read_b32 v226, a70
    v_accvgpr_read_b32 v227, a71
    v_mul_f32 v224, v224, v53
    v_mul_f32 v225, v225, v53
    v_mul_f32 v226, v226, v53
    v_mul_f32 v227, v227, v53
    v_accvgpr_write_b32 a68, v224
    v_accvgpr_write_b32 a69, v225
    v_accvgpr_write_b32 a70, v226
    v_accvgpr_write_b32 a71, v227
    v_accvgpr_read_b32 v224, a72
    v_accvgpr_read_b32 v225, a73
    v_accvgpr_read_b32 v226, a74
    v_accvgpr_read_b32 v227, a75
    v_mul_f32 v224, v224, v54
    v_mul_f32 v225, v225, v54
    v_mul_f32 v226, v226, v54
    v_mul_f32 v227, v227, v54
    v_accvgpr_write_b32 a72, v224
    v_accvgpr_write_b32 a73, v225
    v_accvgpr_write_b32 a74, v226
    v_accvgpr_write_b32 a75, v227
    v_accvgpr_read_b32 v224, a76
    v_accvgpr_read_b32 v225, a77
    v_accvgpr_read_b32 v226, a78
    v_accvgpr_read_b32 v227, a79
    v_mul_f32 v224, v224, v55
    v_mul_f32 v225, v225, v55
    v_mul_f32 v226, v226, v55
    v_mul_f32 v227, v227, v55
    v_accvgpr_write_b32 a76, v224
    v_accvgpr_write_b32 a77, v225
    v_accvgpr_write_b32 a78, v226
    v_accvgpr_write_b32 a79, v227
    v_accvgpr_read_b32 v224, a80
    v_accvgpr_read_b32 v225, a81
    v_accvgpr_read_b32 v226, a82
    v_accvgpr_read_b32 v227, a83
    v_mul_f32 v224, v224, v52
    v_mul_f32 v225, v225, v52
    v_mul_f32 v226, v226, v52
    v_mul_f32 v227, v227, v52
    v_accvgpr_write_b32 a80, v224
    v_accvgpr_write_b32 a81, v225
    v_accvgpr_write_b32 a82, v226
    v_accvgpr_write_b32 a83, v227
    v_accvgpr_read_b32 v224, a84
    v_accvgpr_read_b32 v225, a85
    v_accvgpr_read_b32 v226, a86
    v_accvgpr_read_b32 v227, a87
    v_mul_f32 v224, v224, v53
    v_mul_f32 v225, v225, v53
    v_mul_f32 v226, v226, v53
    v_mul_f32 v227, v227, v53
    v_accvgpr_write_b32 a84, v224
    v_accvgpr_write_b32 a85, v225
    v_accvgpr_write_b32 a86, v226
    v_accvgpr_write_b32 a87, v227
    v_accvgpr_read_b32 v224, a88
    v_accvgpr_read_b32 v225, a89
    v_accvgpr_read_b32 v226, a90
    v_accvgpr_read_b32 v227, a91
    v_mul_f32 v224, v224, v54
    v_mul_f32 v225, v225, v54
    v_mul_f32 v226, v226, v54
    v_mul_f32 v227, v227, v54
    v_accvgpr_write_b32 a88, v224
    v_accvgpr_write_b32 a89, v225
    v_accvgpr_write_b32 a90, v226
    v_accvgpr_write_b32 a91, v227
    v_accvgpr_read_b32 v224, a92
    v_accvgpr_read_b32 v225, a93
    v_accvgpr_read_b32 v226, a94
    v_accvgpr_read_b32 v227, a95
    v_mul_f32 v224, v224, v55
    v_mul_f32 v225, v225, v55
    v_mul_f32 v226, v226, v55
    v_mul_f32 v227, v227, v55
    v_accvgpr_write_b32 a92, v224
    v_accvgpr_write_b32 a93, v225
    v_accvgpr_write_b32 a94, v226
    v_accvgpr_write_b32 a95, v227
    v_accvgpr_read_b32 v224, a96
    v_accvgpr_read_b32 v225, a97
    v_accvgpr_read_b32 v226, a98
    v_accvgpr_read_b32 v227, a99
    v_mul_f32 v224, v224, v52
    v_mul_f32 v225, v225, v52
    v_mul_f32 v226, v226, v52
    v_mul_f32 v227, v227, v52
    v_accvgpr_write_b32 a96, v224
    v_accvgpr_write_b32 a97, v225
    v_accvgpr_write_b32 a98, v226
    v_accvgpr_write_b32 a99, v227
    v_accvgpr_read_b32 v224, a100
    v_accvgpr_read_b32 v225, a101
    v_accvgpr_read_b32 v226, a102
    v_accvgpr_read_b32 v227, a103
    v_mul_f32 v224, v224, v53
    v_mul_f32 v225, v225, v53
    v_mul_f32 v226, v226, v53
    v_mul_f32 v227, v227, v53
    v_accvgpr_write_b32 a100, v224
    v_accvgpr_write_b32 a101, v225
    v_accvgpr_write_b32 a102, v226
    v_accvgpr_write_b32 a103, v227
    v_accvgpr_read_b32 v224, a104
    v_accvgpr_read_b32 v225, a105
    v_accvgpr_read_b32 v226, a106
    v_accvgpr_read_b32 v227, a107
    v_mul_f32 v224, v224, v54
    v_mul_f32 v225, v225, v54
    v_mul_f32 v226, v226, v54
    v_mul_f32 v227, v227, v54
    v_accvgpr_write_b32 a104, v224
    v_accvgpr_write_b32 a105, v225
    v_accvgpr_write_b32 a106, v226
    v_accvgpr_write_b32 a107, v227
    v_accvgpr_read_b32 v224, a108
    v_accvgpr_read_b32 v225, a109
    v_accvgpr_read_b32 v226, a110
    v_accvgpr_read_b32 v227, a111
    v_mul_f32 v224, v224, v55
    v_mul_f32 v225, v225, v55
    v_mul_f32 v226, v226, v55
    v_mul_f32 v227, v227, v55
    v_accvgpr_write_b32 a108, v224
    v_accvgpr_write_b32 a109, v225
    v_accvgpr_write_b32 a110, v226
    v_accvgpr_write_b32 a111, v227
    v_accvgpr_read_b32 v224, a112
    v_accvgpr_read_b32 v225, a113
    v_accvgpr_read_b32 v226, a114
    v_accvgpr_read_b32 v227, a115
    v_mul_f32 v224, v224, v52
    v_mul_f32 v225, v225, v52
    v_mul_f32 v226, v226, v52
    v_mul_f32 v227, v227, v52
    v_accvgpr_write_b32 a112, v224
    v_accvgpr_write_b32 a113, v225
    v_accvgpr_write_b32 a114, v226
    v_accvgpr_write_b32 a115, v227
    v_accvgpr_read_b32 v224, a116
    v_accvgpr_read_b32 v225, a117
    v_accvgpr_read_b32 v226, a118
    v_accvgpr_read_b32 v227, a119
    v_mul_f32 v224, v224, v53
    v_mul_f32 v225, v225, v53
    v_mul_f32 v226, v226, v53
    v_mul_f32 v227, v227, v53
    v_accvgpr_write_b32 a116, v224
    v_accvgpr_write_b32 a117, v225
    v_accvgpr_write_b32 a118, v226
    v_accvgpr_write_b32 a119, v227
    v_accvgpr_read_b32 v224, a120
    v_accvgpr_read_b32 v225, a121
    v_accvgpr_read_b32 v226, a122
    v_accvgpr_read_b32 v227, a123
    v_mul_f32 v224, v224, v54
    v_mul_f32 v225, v225, v54
    v_mul_f32 v226, v226, v54
    v_mul_f32 v227, v227, v54
    v_accvgpr_write_b32 a120, v224
    v_accvgpr_write_b32 a121, v225
    v_accvgpr_write_b32 a122, v226
    v_accvgpr_write_b32 a123, v227
    v_accvgpr_read_b32 v224, a124
    v_accvgpr_read_b32 v225, a125
    v_accvgpr_read_b32 v226, a126
    v_accvgpr_read_b32 v227, a127
    v_mul_f32 v224, v224, v55
    v_mul_f32 v225, v225, v55
    v_mul_f32 v226, v226, v55
    v_mul_f32 v227, v227, v55
    v_accvgpr_write_b32 a124, v224
    v_accvgpr_write_b32 a125, v225
    v_accvgpr_write_b32 a126, v226
    v_accvgpr_write_b32 a127, v227
    v_exp_f32 v232, v128
    v_exp_f32 v233, v129
    v_exp_f32 v234, v130
    v_exp_f32 v235, v131
    s_nop 0
    v_cvt_pk_bf16_f32 v192, v232, v233
    v_cvt_pk_bf16_f32 v193, v234, v235
    v_exp_f32 v232, v144
    v_exp_f32 v233, v145
    v_exp_f32 v234, v146
    v_exp_f32 v235, v147
    s_nop 0
    v_cvt_pk_bf16_f32 v194, v232, v233
    v_cvt_pk_bf16_f32 v195, v234, v235
    v_exp_f32 v232, v132
    v_exp_f32 v233, v133
    v_exp_f32 v234, v134
    v_exp_f32 v235, v135
    s_nop 0
    v_cvt_pk_bf16_f32 v196, v232, v233
    v_cvt_pk_bf16_f32 v197, v234, v235
    v_exp_f32 v232, v148
    v_exp_f32 v233, v149
    v_exp_f32 v234, v150
    v_exp_f32 v235, v151
    s_nop 0
    v_cvt_pk_bf16_f32 v198, v232, v233
    v_cvt_pk_bf16_f32 v199, v234, v235
    v_exp_f32 v232, v136
    v_exp_f32 v233, v137
    v_exp_f32 v234, v138
    v_exp_f32 v235, v139
    s_nop 0
    v_cvt_pk_bf16_f32 v200, v232, v233
    v_cvt_pk_bf16_f32 v201, v234, v235
    v_exp_f32 v232, v152
    v_exp_f32 v233, v153
    v_exp_f32 v234, v154
    v_exp_f32 v235, v155
    s_nop 0
    v_cvt_pk_bf16_f32 v202, v232, v233
    v_cvt_pk_bf16_f32 v203, v234, v235
    v_exp_f32 v232, v140
    v_exp_f32 v233, v141
    v_exp_f32 v234, v142
    v_exp_f32 v235, v143
    s_nop 0
    v_cvt_pk_bf16_f32 v204, v232, v233
    v_cvt_pk_bf16_f32 v205, v234, v235
    v_exp_f32 v232, v156
    v_exp_f32 v233, v157
    v_exp_f32 v234, v158
    v_exp_f32 v235, v159
    s_nop 0
    v_cvt_pk_bf16_f32 v206, v232, v233
    v_cvt_pk_bf16_f32 v207, v234, v235
    s_nop 1
    s_branch k2_ret_90
k2_rare_93:
    s_nop 7
    v_max_f32 v52, v160, v161
    v_max3_f32 v52, v52, v162, v163
    v_max3_f32 v52, v52, v176, v177
    v_max3_f32 v52, v52, v178, v179
    v_max_f32 v53, v164, v165
    v_max3_f32 v53, v53, v166, v167
    v_max3_f32 v53, v53, v180, v181
    v_max3_f32 v53, v53, v182, v183
    v_max_f32 v54, v168, v169
    v_max3_f32 v54, v54, v170, v171
    v_max3_f32 v54, v54, v184, v185
    v_max3_f32 v54, v54, v186, v187
    v_max_f32 v55, v172, v173
    v_max3_f32 v55, v55, v174, v175
    v_max3_f32 v55, v55, v188, v189
    v_max3_f32 v55, v55, v190, v191
    v_mov_b32 v224, v52
    v_mov_b32 v225, v53
    v_mov_b32 v226, v54
    v_mov_b32 v227, v55
    s_nop 1
    v_permlane16_swap_b32 v52, v224
    v_permlane16_swap_b32 v53, v225
    v_permlane16_swap_b32 v54, v226
    v_permlane16_swap_b32 v55, v227
    s_nop 1
    v_max_f32 v52, v52, v224
    v_max_f32 v53, v53, v225
    v_max_f32 v54, v54, v226
    v_max_f32 v55, v55, v227
    v_mov_b32 v224, v52
    v_mov_b32 v225, v53
    v_mov_b32 v226, v54
    v_mov_b32 v227, v55
    s_nop 1
    v_permlane32_swap_b32 v52, v224
    v_permlane32_swap_b32 v53, v225
    v_permlane32_swap_b32 v54, v226
    v_permlane32_swap_b32 v55, v227
    s_nop 1
    v_max_f32 v52, v52, v224
    v_max_f32 v53, v53, v225
    v_max_f32 v54, v54, v226
    v_max_f32 v55, v55, v227
    v_add_f32 v52, 0x41400000, v52
    v_max_f32 v52, 0, v52
    v_add_f32 v53, 0x41400000, v53
    v_max_f32 v53, 0, v53
    v_add_f32 v54, 0x41400000, v54
    v_max_f32 v54, 0, v54
    v_add_f32 v55, 0x41400000, v55
    v_max_f32 v55, 0, v55
    v_sub_f32 v160, v160, v52
    v_sub_f32 v161, v161, v52
    v_sub_f32 v162, v162, v52
    v_sub_f32 v163, v163, v52
    v_sub_f32 v164, v164, v53
    v_sub_f32 v165, v165, v53
    v_sub_f32 v166, v166, v53
    v_sub_f32 v167, v167, v53
    v_sub_f32 v168, v168, v54
    v_sub_f32 v169, v169, v54
    v_sub_f32 v170, v170, v54
    v_sub_f32 v171, v171, v54
    v_sub_f32 v172, v172, v55
    v_sub_f32 v173, v173, v55
    v_sub_f32 v174, v174, v55
    v_sub_f32 v175, v175, v55
    v_sub_f32 v176, v176, v52
    v_sub_f32 v177, v177, v52
    v_sub_f32 v178, v178, v52
    v_sub_f32 v179, v179, v52
    v_sub_f32 v180, v180, v53
    v_sub_f32 v181, v181, v53
    v_sub_f32 v182, v182, v53
    v_sub_f32 v183, v183, v53
    v_sub_f32 v184, v184, v54
    v_sub_f32 v185, v185, v54
    v_sub_f32 v186, v186, v54
    v_sub_f32 v187, v187, v54
    v_sub_f32 v188, v188, v55
    v_sub_f32 v189, v189, v55
    v_sub_f32 v190, v190, v55
    v_sub_f32 v191, v191, v55
    v_sub_f32 v128, v128, v54
    v_sub_f32 v16, v16, v54
    v_sub_f32 v129, v129, v54
    v_sub_f32 v17, v17, v54
    v_sub_f32 v130, v130, v54
    v_sub_f32 v18, v18, v54
    v_sub_f32 v131, v131, v54
    v_sub_f32 v19, v19, v54
    v_sub_f32 v132, v132, v55
    v_sub_f32 v20, v20, v55
    v_sub_f32 v133, v133, v55
    v_sub_f32 v21, v21, v55
    v_sub_f32 v134, v134, v55
    v_sub_f32 v22, v22, v55
    v_sub_f32 v135, v135, v55
    v_sub_f32 v23, v23, v55
    v_sub_f32 v136, v136, v54
    v_sub_f32 v24, v24, v54
    v_sub_f32 v137, v137, v54
    v_sub_f32 v25, v25, v54
    v_sub_f32 v138, v138, v54
    v_sub_f32 v26, v26, v54
    v_sub_f32 v139, v139, v54
    v_sub_f32 v27, v27, v54
    v_sub_f32 v140, v140, v55
    v_sub_f32 v28, v28, v55
    v_sub_f32 v141, v141, v55
    v_sub_f32 v29, v29, v55
    v_sub_f32 v142, v142, v55
    v_sub_f32 v30, v30, v55
    v_sub_f32 v143, v143, v55
    v_sub_f32 v31, v31, v55
    v_sub_f32 v144, v144, v54
    v_sub_f32 v32, v32, v54
    v_sub_f32 v145, v145, v54
    v_sub_f32 v33, v33, v54
    v_sub_f32 v146, v146, v54
    v_sub_f32 v34, v34, v54
    v_sub_f32 v147, v147, v54
    v_sub_f32 v35, v35, v54
    v_sub_f32 v148, v148, v55
    v_sub_f32 v36, v36, v55
    v_sub_f32 v149, v149, v55
    v_sub_f32 v37, v37, v55
    v_sub_f32 v150, v150, v55
    v_sub_f32 v38, v38, v55
    v_sub_f32 v151, v151, v55
    v_sub_f32 v39, v39, v55
    v_sub_f32 v152, v152, v54
    v_sub_f32 v40, v40, v54
    v_sub_f32 v153, v153, v54
    v_sub_f32 v41, v41, v54
    v_sub_f32 v154, v154, v54
    v_sub_f32 v42, v42, v54
    v_sub_f32 v155, v155, v54
    v_sub_f32 v43, v43, v54
    v_sub_f32 v156, v156, v55
    v_sub_f32 v44, v44, v55
    v_sub_f32 v157, v157, v55
    v_sub_f32 v45, v45, v55
    v_sub_f32 v158, v158, v55
    v_sub_f32 v46, v46, v55
    v_sub_f32 v159, v159, v55
    v_sub_f32 v47, v47, v55
    v_sub_f32 v8, v8, v52
    v_exp_f32 v52, -v52
    v_sub_f32 v9, v9, v53
    v_exp_f32 v53, -v53
    v_sub_f32 v10, v10, v54
    v_exp_f32 v54, -v54
    v_sub_f32 v11, v11, v55
    v_exp_f32 v55, -v55
    s_nop 0
    v_mul_f32 v12, v12, v52
    v_mul_f32 v48, v48, v53
    v_mul_f32 v248, v248, v54
    v_mul_f32 v252, v252, v55
    v_accvgpr_read_b32 v224, a0
    v_accvgpr_read_b32 v225, a1
    v_accvgpr_read_b32 v226, a2
    v_accvgpr_read_b32 v227, a3
    v_mul_f32 v224, v224, v52
    v_mul_f32 v225, v225, v52
    v_mul_f32 v226, v226, v52
    v_mul_f32 v227, v227, v52
    v_accvgpr_write_b32 a0, v224
    v_accvgpr_write_b32 a1, v225
    v_accvgpr_write_b32 a2, v226
    v_accvgpr_write_b32 a3, v227
    v_accvgpr_read_b32 v224, a4
    v_accvgpr_read_b32 v225, a5
    v_accvgpr_read_b32 v226, a6
    v_accvgpr_read_b32 v227, a7
    v_mul_f32 v224, v224, v53
    v_mul_f32 v225, v225, v53
    v_mul_f32 v226, v226, v53
    v_mul_f32 v227, v227, v53
    v_accvgpr_write_b32 a4, v224
    v_accvgpr_write_b32 a5, v225
    v_accvgpr_write_b32 a6, v226
    v_accvgpr_write_b32 a7, v227
    v_accvgpr_read_b32 v224, a8
    v_accvgpr_read_b32 v225, a9
    v_accvgpr_read_b32 v226, a10
    v_accvgpr_read_b32 v227, a11
    v_mul_f32 v224, v224, v54
    v_mul_f32 v225, v225, v54
    v_mul_f32 v226, v226, v54
    v_mul_f32 v227, v227, v54
    v_accvgpr_write_b32 a8, v224
    v_accvgpr_write_b32 a9, v225
    v_accvgpr_write_b32 a10, v226
    v_accvgpr_write_b32 a11, v227
    v_accvgpr_read_b32 v224, a12
    v_accvgpr_read_b32 v225, a13
    v_accvgpr_read_b32 v226, a14
    v_accvgpr_read_b32 v227, a15
    v_mul_f32 v224, v224, v55
    v_mul_f32 v225, v225, v55
    v_mul_f32 v226, v226, v55
    v_mul_f32 v227, v227, v55
    v_accvgpr_write_b32 a12, v224
    v_accvgpr_write_b32 a13, v225
    v_accvgpr_write_b32 a14, v226
    v_accvgpr_write_b32 a15, v227
    v_accvgpr_read_b32 v224, a16
    v_accvgpr_read_b32 v225, a17
    v_accvgpr_read_b32 v226, a18
    v_accvgpr_read_b32 v227, a19
    v_mul_f32 v224, v224, v52
    v_mul_f32 v225, v225, v52
    v_mul_f32 v226, v226, v52
    v_mul_f32 v227, v227, v52
    v_accvgpr_write_b32 a16, v224
    v_accvgpr_write_b32 a17, v225
    v_accvgpr_write_b32 a18, v226
    v_accvgpr_write_b32 a19, v227
    v_accvgpr_read_b32 v224, a20
    v_accvgpr_read_b32 v225, a21
    v_accvgpr_read_b32 v226, a22
    v_accvgpr_read_b32 v227, a23
    v_mul_f32 v224, v224, v53
    v_mul_f32 v225, v225, v53
    v_mul_f32 v226, v226, v53
    v_mul_f32 v227, v227, v53
    v_accvgpr_write_b32 a20, v224
    v_accvgpr_write_b32 a21, v225
    v_accvgpr_write_b32 a22, v226
    v_accvgpr_write_b32 a23, v227
    v_accvgpr_read_b32 v224, a24
    v_accvgpr_read_b32 v225, a25
    v_accvgpr_read_b32 v226, a26
    v_accvgpr_read_b32 v227, a27
    v_mul_f32 v224, v224, v54
    v_mul_f32 v225, v225, v54
    v_mul_f32 v226, v226, v54
    v_mul_f32 v227, v227, v54
    v_accvgpr_write_b32 a24, v224
    v_accvgpr_write_b32 a25, v225
    v_accvgpr_write_b32 a26, v226
    v_accvgpr_write_b32 a27, v227
    v_accvgpr_read_b32 v224, a28
    v_accvgpr_read_b32 v225, a29
    v_accvgpr_read_b32 v226, a30
    v_accvgpr_read_b32 v227, a31
    v_mul_f32 v224, v224, v55
    v_mul_f32 v225, v225, v55
    v_mul_f32 v226, v226, v55
    v_mul_f32 v227, v227, v55
    v_accvgpr_write_b32 a28, v224
    v_accvgpr_write_b32 a29, v225
    v_accvgpr_write_b32 a30, v226
    v_accvgpr_write_b32 a31, v227
    v_accvgpr_read_b32 v224, a32
    v_accvgpr_read_b32 v225, a33
    v_accvgpr_read_b32 v226, a34
    v_accvgpr_read_b32 v227, a35
    v_mul_f32 v224, v224, v52
    v_mul_f32 v225, v225, v52
    v_mul_f32 v226, v226, v52
    v_mul_f32 v227, v227, v52
    v_accvgpr_write_b32 a32, v224
    v_accvgpr_write_b32 a33, v225
    v_accvgpr_write_b32 a34, v226
    v_accvgpr_write_b32 a35, v227
    v_accvgpr_read_b32 v224, a36
    v_accvgpr_read_b32 v225, a37
    v_accvgpr_read_b32 v226, a38
    v_accvgpr_read_b32 v227, a39
    v_mul_f32 v224, v224, v53
    v_mul_f32 v225, v225, v53
    v_mul_f32 v226, v226, v53
    v_mul_f32 v227, v227, v53
    v_accvgpr_write_b32 a36, v224
    v_accvgpr_write_b32 a37, v225
    v_accvgpr_write_b32 a38, v226
    v_accvgpr_write_b32 a39, v227
    v_accvgpr_read_b32 v224, a40
    v_accvgpr_read_b32 v225, a41
    v_accvgpr_read_b32 v226, a42
    v_accvgpr_read_b32 v227, a43
    v_mul_f32 v224, v224, v54
    v_mul_f32 v225, v225, v54
    v_mul_f32 v226, v226, v54
    v_mul_f32 v227, v227, v54
    v_accvgpr_write_b32 a40, v224
    v_accvgpr_write_b32 a41, v225
    v_accvgpr_write_b32 a42, v226
    v_accvgpr_write_b32 a43, v227
    v_accvgpr_read_b32 v224, a44
    v_accvgpr_read_b32 v225, a45
    v_accvgpr_read_b32 v226, a46
    v_accvgpr_read_b32 v227, a47
    v_mul_f32 v224, v224, v55
    v_mul_f32 v225, v225, v55
    v_mul_f32 v226, v226, v55
    v_mul_f32 v227, v227, v55
    v_accvgpr_write_b32 a44, v224
    v_accvgpr_write_b32 a45, v225
    v_accvgpr_write_b32 a46, v226
    v_accvgpr_write_b32 a47, v227
    v_accvgpr_read_b32 v224, a48
    v_accvgpr_read_b32 v225, a49
    v_accvgpr_read_b32 v226, a50
    v_accvgpr_read_b32 v227, a51
    v_mul_f32 v224, v224, v52
    v_mul_f32 v225, v225, v52
    v_mul_f32 v226, v226, v52
    v_mul_f32 v227, v227, v52
    v_accvgpr_write_b32 a48, v224
    v_accvgpr_write_b32 a49, v225
    v_accvgpr_write_b32 a50, v226
    v_accvgpr_write_b32 a51, v227
    v_accvgpr_read_b32 v224, a52
    v_accvgpr_read_b32 v225, a53
    v_accvgpr_read_b32 v226, a54
    v_accvgpr_read_b32 v227, a55
    v_mul_f32 v224, v224, v53
    v_mul_f32 v225, v225, v53
    v_mul_f32 v226, v226, v53
    v_mul_f32 v227, v227, v53
    v_accvgpr_write_b32 a52, v224
    v_accvgpr_write_b32 a53, v225
    v_accvgpr_write_b32 a54, v226
    v_accvgpr_write_b32 a55, v227
    v_accvgpr_read_b32 v224, a56
    v_accvgpr_read_b32 v225, a57
    v_accvgpr_read_b32 v226, a58
    v_accvgpr_read_b32 v227, a59
    v_mul_f32 v224, v224, v54
    v_mul_f32 v225, v225, v54
    v_mul_f32 v226, v226, v54
    v_mul_f32 v227, v227, v54
    v_accvgpr_write_b32 a56, v224
    v_accvgpr_write_b32 a57, v225
    v_accvgpr_write_b32 a58, v226
    v_accvgpr_write_b32 a59, v227
    v_accvgpr_read_b32 v224, a60
    v_accvgpr_read_b32 v225, a61
    v_accvgpr_read_b32 v226, a62
    v_accvgpr_read_b32 v227, a63
    v_mul_f32 v224, v224, v55
    v_mul_f32 v225, v225, v55
    v_mul_f32 v226, v226, v55
    v_mul_f32 v227, v227, v55
    v_accvgpr_write_b32 a60, v224
    v_accvgpr_write_b32 a61, v225
    v_accvgpr_write_b32 a62, v226
    v_accvgpr_write_b32 a63, v227
    v_accvgpr_read_b32 v224, a64
    v_accvgpr_read_b32 v225, a65
    v_accvgpr_read_b32 v226, a66
    v_accvgpr_read_b32 v227, a67
    v_mul_f32 v224, v224, v52
    v_mul_f32 v225, v225, v52
    v_mul_f32 v226, v226, v52
    v_mul_f32 v227, v227, v52
    v_accvgpr_write_b32 a64, v224
    v_accvgpr_write_b32 a65, v225
    v_accvgpr_write_b32 a66, v226
    v_accvgpr_write_b32 a67, v227
    v_accvgpr_read_b32 v224, a68
    v_accvgpr_read_b32 v225, a69
    v_accvgpr_read_b32 v226, a70
    v_accvgpr_read_b32 v227, a71
    v_mul_f32 v224, v224, v53
    v_mul_f32 v225, v225, v53
    v_mul_f32 v226, v226, v53
    v_mul_f32 v227, v227, v53
    v_accvgpr_write_b32 a68, v224
    v_accvgpr_write_b32 a69, v225
    v_accvgpr_write_b32 a70, v226
    v_accvgpr_write_b32 a71, v227
    v_accvgpr_read_b32 v224, a72
    v_accvgpr_read_b32 v225, a73
    v_accvgpr_read_b32 v226, a74
    v_accvgpr_read_b32 v227, a75
    v_mul_f32 v224, v224, v54
    v_mul_f32 v225, v225, v54
    v_mul_f32 v226, v226, v54
    v_mul_f32 v227, v227, v54
    v_accvgpr_write_b32 a72, v224
    v_accvgpr_write_b32 a73, v225
    v_accvgpr_write_b32 a74, v226
    v_accvgpr_write_b32 a75, v227
    v_accvgpr_read_b32 v224, a76
    v_accvgpr_read_b32 v225, a77
    v_accvgpr_read_b32 v226, a78
    v_accvgpr_read_b32 v227, a79
    v_mul_f32 v224, v224, v55
    v_mul_f32 v225, v225, v55
    v_mul_f32 v226, v226, v55
    v_mul_f32 v227, v227, v55
    v_accvgpr_write_b32 a76, v224
    v_accvgpr_write_b32 a77, v225
    v_accvgpr_write_b32 a78, v226
    v_accvgpr_write_b32 a79, v227
    v_accvgpr_read_b32 v224, a80
    v_accvgpr_read_b32 v225, a81
    v_accvgpr_read_b32 v226, a82
    v_accvgpr_read_b32 v227, a83
    v_mul_f32 v224, v224, v52
    v_mul_f32 v225, v225, v52
    v_mul_f32 v226, v226, v52
    v_mul_f32 v227, v227, v52
    v_accvgpr_write_b32 a80, v224
    v_accvgpr_write_b32 a81, v225
    v_accvgpr_write_b32 a82, v226
    v_accvgpr_write_b32 a83, v227
    v_accvgpr_read_b32 v224, a84
    v_accvgpr_read_b32 v225, a85
    v_accvgpr_read_b32 v226, a86
    v_accvgpr_read_b32 v227, a87
    v_mul_f32 v224, v224, v53
    v_mul_f32 v225, v225, v53
    v_mul_f32 v226, v226, v53
    v_mul_f32 v227, v227, v53
    v_accvgpr_write_b32 a84, v224
    v_accvgpr_write_b32 a85, v225
    v_accvgpr_write_b32 a86, v226
    v_accvgpr_write_b32 a87, v227
    v_accvgpr_read_b32 v224, a88
    v_accvgpr_read_b32 v225, a89
    v_accvgpr_read_b32 v226, a90
    v_accvgpr_read_b32 v227, a91
    v_mul_f32 v224, v224, v54
    v_mul_f32 v225, v225, v54
    v_mul_f32 v226, v226, v54
    v_mul_f32 v227, v227, v54
    v_accvgpr_write_b32 a88, v224
    v_accvgpr_write_b32 a89, v225
    v_accvgpr_write_b32 a90, v226
    v_accvgpr_write_b32 a91, v227
    v_accvgpr_read_b32 v224, a92
    v_accvgpr_read_b32 v225, a93
    v_accvgpr_read_b32 v226, a94
    v_accvgpr_read_b32 v227, a95
    v_mul_f32 v224, v224, v55
    v_mul_f32 v225, v225, v55
    v_mul_f32 v226, v226, v55
    v_mul_f32 v227, v227, v55
    v_accvgpr_write_b32 a92, v224
    v_accvgpr_write_b32 a93, v225
    v_accvgpr_write_b32 a94, v226
    v_accvgpr_write_b32 a95, v227
    v_accvgpr_read_b32 v224, a96
    v_accvgpr_read_b32 v225, a97
    v_accvgpr_read_b32 v226, a98
    v_accvgpr_read_b32 v227, a99
    v_mul_f32 v224, v224, v52
    v_mul_f32 v225, v225, v52
    v_mul_f32 v226, v226, v52
    v_mul_f32 v227, v227, v52
    v_accvgpr_write_b32 a96, v224
    v_accvgpr_write_b32 a97, v225
    v_accvgpr_write_b32 a98, v226
    v_accvgpr_write_b32 a99, v227
    v_accvgpr_read_b32 v224, a100
    v_accvgpr_read_b32 v225, a101
    v_accvgpr_read_b32 v226, a102
    v_accvgpr_read_b32 v227, a103
    v_mul_f32 v224, v224, v53
    v_mul_f32 v225, v225, v53
    v_mul_f32 v226, v226, v53
    v_mul_f32 v227, v227, v53
    v_accvgpr_write_b32 a100, v224
    v_accvgpr_write_b32 a101, v225
    v_accvgpr_write_b32 a102, v226
    v_accvgpr_write_b32 a103, v227
    v_accvgpr_read_b32 v224, a104
    v_accvgpr_read_b32 v225, a105
    v_accvgpr_read_b32 v226, a106
    v_accvgpr_read_b32 v227, a107
    v_mul_f32 v224, v224, v54
    v_mul_f32 v225, v225, v54
    v_mul_f32 v226, v226, v54
    v_mul_f32 v227, v227, v54
    v_accvgpr_write_b32 a104, v224
    v_accvgpr_write_b32 a105, v225
    v_accvgpr_write_b32 a106, v226
    v_accvgpr_write_b32 a107, v227
    v_accvgpr_read_b32 v224, a108
    v_accvgpr_read_b32 v225, a109
    v_accvgpr_read_b32 v226, a110
    v_accvgpr_read_b32 v227, a111
    v_mul_f32 v224, v224, v55
    v_mul_f32 v225, v225, v55
    v_mul_f32 v226, v226, v55
    v_mul_f32 v227, v227, v55
    v_accvgpr_write_b32 a108, v224
    v_accvgpr_write_b32 a109, v225
    v_accvgpr_write_b32 a110, v226
    v_accvgpr_write_b32 a111, v227
    v_accvgpr_read_b32 v224, a112
    v_accvgpr_read_b32 v225, a113
    v_accvgpr_read_b32 v226, a114
    v_accvgpr_read_b32 v227, a115
    v_mul_f32 v224, v224, v52
    v_mul_f32 v225, v225, v52
    v_mul_f32 v226, v226, v52
    v_mul_f32 v227, v227, v52
    v_accvgpr_write_b32 a112, v224
    v_accvgpr_write_b32 a113, v225
    v_accvgpr_write_b32 a114, v226
    v_accvgpr_write_b32 a115, v227
    v_accvgpr_read_b32 v224, a116
    v_accvgpr_read_b32 v225, a117
    v_accvgpr_read_b32 v226, a118
    v_accvgpr_read_b32 v227, a119
    v_mul_f32 v224, v224, v53
    v_mul_f32 v225, v225, v53
    v_mul_f32 v226, v226, v53
    v_mul_f32 v227, v227, v53
    v_accvgpr_write_b32 a116, v224
    v_accvgpr_write_b32 a117, v225
    v_accvgpr_write_b32 a118, v226
    v_accvgpr_write_b32 a119, v227
    v_accvgpr_read_b32 v224, a120
    v_accvgpr_read_b32 v225, a121
    v_accvgpr_read_b32 v226, a122
    v_accvgpr_read_b32 v227, a123
    v_mul_f32 v224, v224, v54
    v_mul_f32 v225, v225, v54
    v_mul_f32 v226, v226, v54
    v_mul_f32 v227, v227, v54
    v_accvgpr_write_b32 a120, v224
    v_accvgpr_write_b32 a121, v225
    v_accvgpr_write_b32 a122, v226
    v_accvgpr_write_b32 a123, v227
    v_accvgpr_read_b32 v224, a124
    v_accvgpr_read_b32 v225, a125
    v_accvgpr_read_b32 v226, a126
    v_accvgpr_read_b32 v227, a127
    v_mul_f32 v224, v224, v55
    v_mul_f32 v225, v225, v55
    v_mul_f32 v226, v226, v55
    v_mul_f32 v227, v227, v55
    v_accvgpr_write_b32 a124, v224
    v_accvgpr_write_b32 a125, v225
    v_accvgpr_write_b32 a126, v226
    v_accvgpr_write_b32 a127, v227
    v_exp_f32 v232, v160
    v_exp_f32 v233, v161
    v_exp_f32 v234, v162
    v_exp_f32 v235, v163
    s_nop 0
    v_cvt_pk_bf16_f32 v208, v232, v233
    v_cvt_pk_bf16_f32 v209, v234, v235
    v_exp_f32 v232, v176
    v_exp_f32 v233, v177
    v_exp_f32 v234, v178
    v_exp_f32 v235, v179
    s_nop 0
    v_cvt_pk_bf16_f32 v210, v232, v233
    v_cvt_pk_bf16_f32 v211, v234, v235
    v_exp_f32 v232, v164
    v_exp_f32 v233, v165
    v_exp_f32 v234, v166
    v_exp_f32 v235, v167
    s_nop 0
    v_cvt_pk_bf16_f32 v212, v232, v233
    v_cvt_pk_bf16_f32 v213, v234, v235
    v_exp_f32 v232, v180
    v_exp_f32 v233, v181
    v_exp_f32 v234, v182
    v_exp_f32 v235, v183
    s_nop 0
    v_cvt_pk_bf16_f32 v214, v232, v233
    v_cvt_pk_bf16_f32 v215, v234, v235
    v_exp_f32 v232, v168
    v_exp_f32 v233, v169
    v_exp_f32 v234, v170
    v_exp_f32 v235, v171
    s_nop 0
    v_cvt_pk_bf16_f32 v216, v232, v233
    v_cvt_pk_bf16_f32 v217, v234, v235
    v_exp_f32 v232, v184
    v_exp_f32 v233, v185
    v_exp_f32 v234, v186
    v_exp_f32 v235, v187
    s_nop 0
    v_cvt_pk_bf16_f32 v218, v232, v233
    v_cvt_pk_bf16_f32 v219, v234, v235
    v_exp_f32 v232, v172
    v_exp_f32 v233, v173
    v_exp_f32 v234, v174
    v_exp_f32 v235, v175
    s_nop 0
    v_cvt_pk_bf16_f32 v220, v232, v233
    v_cvt_pk_bf16_f32 v221, v234, v235
    v_exp_f32 v232, v188
    v_exp_f32 v233, v189
    v_exp_f32 v234, v190
    v_exp_f32 v235, v191
    s_nop 0
    v_cvt_pk_bf16_f32 v222, v232, v233
    v_cvt_pk_bf16_f32 v223, v234, v235
    s_nop 1
    s_branch k2_ret_94
k2_rare_97:
    s_nop 7
    v_max_f32 v54, v128, v129
    v_max3_f32 v54, v54, v130, v131
    v_max3_f32 v54, v54, v144, v145
    v_max3_f32 v54, v54, v146, v147
    v_max3_f32 v54, v54, v136, v137
    v_max3_f32 v54, v54, v138, v139
    v_max3_f32 v54, v54, v152, v153
    v_max3_f32 v54, v54, v154, v155
    v_max_f32 v55, v132, v133
    v_max3_f32 v55, v55, v134, v135
    v_max3_f32 v55, v55, v148, v149
    v_max3_f32 v55, v55, v150, v151
    v_max3_f32 v55, v55, v140, v141
    v_max3_f32 v55, v55, v142, v143
    v_max3_f32 v55, v55, v156, v157
    v_max3_f32 v55, v55, v158, v159
    v_mov_b32 v226, v54
    v_mov_b32 v227, v55
    s_nop 1
    v_permlane16_swap_b32 v54, v226
    v_permlane16_swap_b32 v55, v227
    s_nop 1
    v_max_f32 v54, v54, v226
    v_max_f32 v55, v55, v227
    v_mov_b32 v226, v54
    v_mov_b32 v227, v55
    s_nop 1
    v_permlane32_swap_b32 v54, v226
    v_permlane32_swap_b32 v55, v227
    s_nop 1
    v_max_f32 v54, v54, v226
    v_max_f32 v55, v55, v227
    v_add_f32 v54, 0x41400000, v54
    v_max_f32 v54, 0, v54
    v_add_f32 v55, 0x41400000, v55
    v_max_f32 v55, 0, v55
    v_sub_f32 v128, v128, v54
    v_sub_f32 v129, v129, v54
    v_sub_f32 v130, v130, v54
    v_sub_f32 v131, v131, v54
    v_sub_f32 v132, v132, v55
    v_sub_f32 v133, v133, v55
    v_sub_f32 v134, v134, v55
    v_sub_f32 v135, v135, v55
    v_sub_f32 v136, v136, v54
    v_sub_f32 v137, v137, v54
    v_sub_f32 v138, v138, v54
    v_sub_f32 v139, v139, v54
    v_sub_f32 v140, v140, v55
    v_sub_f32 v141, v141, v55
    v_sub_f32 v142, v142, v55
    v_sub_f32 v143, v143, v55
    v_sub_f32 v144, v144, v54
    v_sub_f32 v145, v145, v54
    v_sub_f32 v146, v146, v54
    v_sub_f32 v147, v147, v54
    v_sub_f32 v148, v148, v55
    v_sub_f32 v149, v149, v55
    v_sub_f32 v150, v150, v55
    v_sub_f32 v151, v151, v55
    v_sub_f32 v152, v152, v54
    v_sub_f32 v153, v153, v54
    v_sub_f32 v154, v154, v54
    v_sub_f32 v155, v155, v54
    v_sub_f32 v156, v156, v55
    v_sub_f32 v157, v157, v55
    v_sub_f32 v158, v158, v55
    v_sub_f32 v159, v159, v55
    v_sub_f32 v160, v160, v54
    v_sub_f32 v16, v16, v54
    v_sub_f32 v161, v161, v54
    v_sub_f32 v17, v17, v54
    v_sub_f32 v162, v162, v54
    v_sub_f32 v18, v18, v54
    v_sub_f32 v163, v163, v54
    v_sub_f32 v19, v19, v54
    v_sub_f32 v164, v164, v55
    v_sub_f32 v20, v20, v55
    v_sub_f32 v165, v165, v55
    v_sub_f32 v21, v21, v55
    v_sub_f32 v166, v166, v55
    v_sub_f32 v22, v22, v55
    v_sub_f32 v167, v167, v55
    v_sub_f32 v23, v23, v55
    v_sub_f32 v168, v168, v54
    v_sub_f32 v24, v24, v54
    v_sub_f32 v169, v169, v54
    v_sub_f32 v25, v25, v54
    v_sub_f32 v170, v170, v54
    v_sub_f32 v26, v26, v54
    v_sub_f32 v171, v171, v54
    v_sub_f32 v27, v27, v54
    v_sub_f32 v172, v172, v55
    v_sub_f32 v28, v28, v55
    v_sub_f32 v173, v173, v55
    v_sub_f32 v29, v29, v55
    v_sub_f32 v174, v174, v55
    v_sub_f32 v30, v30, v55
    v_sub_f32 v175, v175, v55
    v_sub_f32 v31, v31, v55
    v_sub_f32 v176, v176, v54
    v_sub_f32 v32, v32, v54
    v_sub_f32 v177, v177, v54
    v_sub_f32 v33, v33, v54
    v_sub_f32 v178, v178, v54
    v_sub_f32 v34, v34, v54
    v_sub_f32 v179, v179, v54
    v_sub_f32 v35, v35, v54
    v_sub_f32 v180, v180, v55
    v_sub_f32 v36, v36, v55
    v_sub_f32 v181, v181, v55
    v_sub_f32 v37, v37, v55
    v_sub_f32 v182, v182, v55
    v_sub_f32 v38, v38, v55
    v_sub_f32 v183, v183, v55
    v_sub_f32 v39, v39, v55
    v_sub_f32 v184, v184, v54
    v_sub_f32 v40, v40, v54
    v_sub_f32 v185, v185, v54
    v_sub_f32 v41, v41, v54
    v_sub_f32 v186, v186, v54
    v_sub_f32 v42, v42, v54
    v_sub_f32 v187, v187, v54
    v_sub_f32 v43, v43, v54
    v_sub_f32 v188, v188, v55
    v_sub_f32 v44, v44, v55
    v_sub_f32 v189, v189, v55
    v_sub_f32 v45, v45, v55
    v_sub_f32 v190, v190, v55
    v_sub_f32 v46, v46, v55
    v_sub_f32 v191, v191, v55
    v_sub_f32 v47, v47, v55
    v_sub_f32 v10, v10, v54
    v_exp_f32 v54, -v54
    v_sub_f32 v11, v11, v55
    v_exp_f32 v55, -v55
    s_nop 0
    v_mul_f32 v248, v248, v54
    v_mul_f32 v252, v252, v55
    v_accvgpr_read_b32 v224, a8
    v_accvgpr_read_b32 v225, a9
    v_accvgpr_read_b32 v226, a10
    v_accvgpr_read_b32 v227, a11
    v_mul_f32 v224, v224, v54
    v_mul_f32 v225, v225, v54
    v_mul_f32 v226, v226, v54
    v_mul_f32 v227, v227, v54
    v_accvgpr_write_b32 a8, v224
    v_accvgpr_write_b32 a9, v225
    v_accvgpr_write_b32 a10, v226
    v_accvgpr_write_b32 a11, v227
    v_accvgpr_read_b32 v224, a12
    v_accvgpr_read_b32 v225, a13
    v_accvgpr_read_b32 v226, a14
    v_accvgpr_read_b32 v227, a15
    v_mul_f32 v224, v224, v55
    v_mul_f32 v225, v225, v55
    v_mul_f32 v226, v226, v55
    v_mul_f32 v227, v227, v55
    v_accvgpr_write_b32 a12, v224
    v_accvgpr_write_b32 a13, v225
    v_accvgpr_write_b32 a14, v226
    v_accvgpr_write_b32 a15, v227
    v_accvgpr_read_b32 v224, a24
    v_accvgpr_read_b32 v225, a25
    v_accvgpr_read_b32 v226, a26
    v_accvgpr_read_b32 v227, a27
    v_mul_f32 v224, v224, v54
    v_mul_f32 v225, v225, v54
    v_mul_f32 v226, v226, v54
    v_mul_f32 v227, v227, v54
    v_accvgpr_write_b32 a24, v224
    v_accvgpr_write_b32 a25, v225
    v_accvgpr_write_b32 a26, v226
    v_accvgpr_write_b32 a27, v227
    v_accvgpr_read_b32 v224, a28
    v_accvgpr_read_b32 v225, a29
    v_accvgpr_read_b32 v226, a30
    v_accvgpr_read_b32 v227, a31
    v_mul_f32 v224, v224, v55
    v_mul_f32 v225, v225, v55
    v_mul_f32 v226, v226, v55
    v_mul_f32 v227, v227, v55
    v_accvgpr_write_b32 a28, v224
    v_accvgpr_write_b32 a29, v225
    v_accvgpr_write_b32 a30, v226
    v_accvgpr_write_b32 a31, v227
    v_accvgpr_read_b32 v224, a40
    v_accvgpr_read_b32 v225, a41
    v_accvgpr_read_b32 v226, a42
    v_accvgpr_read_b32 v227, a43
    v_mul_f32 v224, v224, v54
    v_mul_f32 v225, v225, v54
    v_mul_f32 v226, v226, v54
    v_mul_f32 v227, v227, v54
    v_accvgpr_write_b32 a40, v224
    v_accvgpr_write_b32 a41, v225
    v_accvgpr_write_b32 a42, v226
    v_accvgpr_write_b32 a43, v227
    v_accvgpr_read_b32 v224, a44
    v_accvgpr_read_b32 v225, a45
    v_accvgpr_read_b32 v226, a46
    v_accvgpr_read_b32 v227, a47
    v_mul_f32 v224, v224, v55
    v_mul_f32 v225, v225, v55
    v_mul_f32 v226, v226, v55
    v_mul_f32 v227, v227, v55
    v_accvgpr_write_b32 a44, v224
    v_accvgpr_write_b32 a45, v225
    v_accvgpr_write_b32 a46, v226
    v_accvgpr_write_b32 a47, v227
    v_accvgpr_read_b32 v224, a56
    v_accvgpr_read_b32 v225, a57
    v_accvgpr_read_b32 v226, a58
    v_accvgpr_read_b32 v227, a59
    v_mul_f32 v224, v224, v54
    v_mul_f32 v225, v225, v54
    v_mul_f32 v226, v226, v54
    v_mul_f32 v227, v227, v54
    v_accvgpr_write_b32 a56, v224
    v_accvgpr_write_b32 a57, v225
    v_accvgpr_write_b32 a58, v226
    v_accvgpr_write_b32 a59, v227
    v_accvgpr_read_b32 v224, a60
    v_accvgpr_read_b32 v225, a61
    v_accvgpr_read_b32 v226, a62
    v_accvgpr_read_b32 v227, a63
    v_mul_f32 v224, v224, v55
    v_mul_f32 v225, v225, v55
    v_mul_f32 v226, v226, v55
    v_mul_f32 v227, v227, v55
    v_accvgpr_write_b32 a60, v224
    v_accvgpr_write_b32 a61, v225
    v_accvgpr_write_b32 a62, v226
    v_accvgpr_write_b32 a63, v227
    v_accvgpr_read_b32 v224, a72
    v_accvgpr_read_b32 v225, a73
    v_accvgpr_read_b32 v226, a74
    v_accvgpr_read_b32 v227, a75
    v_mul_f32 v224, v224, v54
    v_mul_f32 v225, v225, v54
    v_mul_f32 v226, v226, v54
    v_mul_f32 v227, v227, v54
    v_accvgpr_write_b32 a72, v224
    v_accvgpr_write_b32 a73, v225
    v_accvgpr_write_b32 a74, v226
    v_accvgpr_write_b32 a75, v227
    v_accvgpr_read_b32 v224, a76
    v_accvgpr_read_b32 v225, a77
    v_accvgpr_read_b32 v226, a78
    v_accvgpr_read_b32 v227, a79
    v_mul_f32 v224, v224, v55
    v_mul_f32 v225, v225, v55
    v_mul_f32 v226, v226, v55
    v_mul_f32 v227, v227, v55
    v_accvgpr_write_b32 a76, v224
    v_accvgpr_write_b32 a77, v225
    v_accvgpr_write_b32 a78, v226
    v_accvgpr_write_b32 a79, v227
    v_accvgpr_read_b32 v224, a88
    v_accvgpr_read_b32 v225, a89
    v_accvgpr_read_b32 v226, a90
    v_accvgpr_read_b32 v227, a91
    v_mul_f32 v224, v224, v54
    v_mul_f32 v225, v225, v54
    v_mul_f32 v226, v226, v54
    v_mul_f32 v227, v227, v54
    v_accvgpr_write_b32 a88, v224
    v_accvgpr_write_b32 a89, v225
    v_accvgpr_write_b32 a90, v226
    v_accvgpr_write_b32 a91, v227
    v_accvgpr_read_b32 v224, a92
    v_accvgpr_read_b32 v225, a93
    v_accvgpr_read_b32 v226, a94
    v_accvgpr_read_b32 v227, a95
    v_mul_f32 v224, v224, v55
    v_mul_f32 v225, v225, v55
    v_mul_f32 v226, v226, v55
    v_mul_f32 v227, v227, v55
    v_accvgpr_write_b32 a92, v224
    v_accvgpr_write_b32 a93, v225
    v_accvgpr_write_b32 a94, v226
    v_accvgpr_write_b32 a95, v227
    v_accvgpr_read_b32 v224, a104
    v_accvgpr_read_b32 v225, a105
    v_accvgpr_read_b32 v226, a106
    v_accvgpr_read_b32 v227, a107
    v_mul_f32 v224, v224, v54
    v_mul_f32 v225, v225, v54
    v_mul_f32 v226, v226, v54
    v_mul_f32 v227, v227, v54
    v_accvgpr_write_b32 a104, v224
    v_accvgpr_write_b32 a105, v225
    v_accvgpr_write_b32 a106, v226
    v_accvgpr_write_b32 a107, v227
    v_accvgpr_read_b32 v224, a108
    v_accvgpr_read_b32 v225, a109
    v_accvgpr_read_b32 v226, a110
    v_accvgpr_read_b32 v227, a111
    v_mul_f32 v224, v224, v55
    v_mul_f32 v225, v225, v55
    v_mul_f32 v226, v226, v55
    v_mul_f32 v227, v227, v55
    v_accvgpr_write_b32 a108, v224
    v_accvgpr_write_b32 a109, v225
    v_accvgpr_write_b32 a110, v226
    v_accvgpr_write_b32 a111, v227
    v_accvgpr_read_b32 v224, a120
    v_accvgpr_read_b32 v225, a121
    v_accvgpr_read_b32 v226, a122
    v_accvgpr_read_b32 v227, a123
    v_mul_f32 v224, v224, v54
    v_mul_f32 v225, v225, v54
    v_mul_f32 v226, v226, v54
    v_mul_f32 v227, v227, v54
    v_accvgpr_write_b32 a120, v224
    v_accvgpr_write_b32 a121, v225
    v_accvgpr_write_b32 a122, v226
    v_accvgpr_write_b32 a123, v227
    v_accvgpr_read_b32 v224, a124
    v_accvgpr_read_b32 v225, a125
    v_accvgpr_read_b32 v226, a126
    v_accvgpr_read_b32 v227, a127
    v_mul_f32 v224, v224, v55
    v_mul_f32 v225, v225, v55
    v_mul_f32 v226, v226, v55
    v_mul_f32 v227, v227, v55
    v_accvgpr_write_b32 a124, v224
    v_accvgpr_write_b32 a125, v225
    v_accvgpr_write_b32 a126, v226
    v_accvgpr_write_b32 a127, v227
    v_exp_f32 v232, v128
    v_exp_f32 v233, v129
    v_exp_f32 v234, v130
    v_exp_f32 v235, v131
    s_nop 0
    v_cvt_pk_bf16_f32 v192, v232, v233
    v_cvt_pk_bf16_f32 v193, v234, v235
    v_exp_f32 v232, v144
    v_exp_f32 v233, v145
    v_exp_f32 v234, v146
    v_exp_f32 v235, v147
    s_nop 0
    v_cvt_pk_bf16_f32 v194, v232, v233
    v_cvt_pk_bf16_f32 v195, v234, v235
    v_exp_f32 v232, v132
    v_exp_f32 v233, v133
    v_exp_f32 v234, v134
    v_exp_f32 v235, v135
    s_nop 0
    v_cvt_pk_bf16_f32 v196, v232, v233
    v_cvt_pk_bf16_f32 v197, v234, v235
    v_exp_f32 v232, v148
    v_exp_f32 v233, v149
    v_exp_f32 v234, v150
    v_exp_f32 v235, v151
    s_nop 0
    v_cvt_pk_bf16_f32 v198, v232, v233
    v_cvt_pk_bf16_f32 v199, v234, v235
    v_exp_f32 v232, v136
    v_exp_f32 v233, v137
    v_exp_f32 v234, v138
    v_exp_f32 v235, v139
    s_nop 0
    v_cvt_pk_bf16_f32 v200, v232, v233
    v_cvt_pk_bf16_f32 v201, v234, v235
    v_exp_f32 v232, v152
    v_exp_f32 v233, v153
    v_exp_f32 v234, v154
    v_exp_f32 v235, v155
    s_nop 0
    v_cvt_pk_bf16_f32 v202, v232, v233
    v_cvt_pk_bf16_f32 v203, v234, v235
    v_exp_f32 v232, v140
    v_exp_f32 v233, v141
    v_exp_f32 v234, v142
    v_exp_f32 v235, v143
    s_nop 0
    v_cvt_pk_bf16_f32 v204, v232, v233
    v_cvt_pk_bf16_f32 v205, v234, v235
    v_exp_f32 v232, v156
    v_exp_f32 v233, v157
    v_exp_f32 v234, v158
    v_exp_f32 v235, v159
    s_nop 0
    v_cvt_pk_bf16_f32 v206, v232, v233
    v_cvt_pk_bf16_f32 v207, v234, v235
    s_nop 1
    s_branch k2_ret_98
k2_rare_103:
    s_nop 7
    v_max_f32 v54, v160, v161
    v_max3_f32 v54, v54, v162, v163
    v_max3_f32 v54, v54, v176, v177
    v_max3_f32 v54, v54, v178, v179
    v_max3_f32 v54, v54, v168, v169
    v_max3_f32 v54, v54, v170, v171
    v_max3_f32 v54, v54, v184, v185
    v_max3_f32 v54, v54, v186, v187
    v_max_f32 v55, v164, v165
    v_max3_f32 v55, v55, v166, v167
    v_max3_f32 v55, v55, v180, v181
    v_max3_f32 v55, v55, v182, v183
    v_max3_f32 v55, v55, v172, v173
    v_max3_f32 v55, v55, v174, v175
    v_max3_f32 v55, v55, v188, v189
    v_max3_f32 v55, v55, v190, v191
    v_mov_b32 v226, v54
    v_mov_b32 v227, v55
    s_nop 1
    v_permlane16_swap_b32 v54, v226
    v_permlane16_swap_b32 v55, v227
    s_nop 1
    v_max_f32 v54, v54, v226
    v_max_f32 v55, v55, v227
    v_mov_b32 v226, v54
    v_mov_b32 v227, v55
    s_nop 1
    v_permlane32_swap_b32 v54, v226
    v_permlane32_swap_b32 v55, v227
    s_nop 1
    v_max_f32 v54, v54, v226
    v_max_f32 v55, v55, v227
    v_add_f32 v54, 0x41400000, v54
    v_max_f32 v54, 0, v54
    v_add_f32 v55, 0x41400000, v55
    v_max_f32 v55, 0, v55
    v_sub_f32 v160, v160, v54
    v_sub_f32 v161, v161, v54
    v_sub_f32 v162, v162, v54
    v_sub_f32 v163, v163, v54
    v_sub_f32 v164, v164, v55
    v_sub_f32 v165, v165, v55
    v_sub_f32 v166, v166, v55
    v_sub_f32 v167, v167, v55
    v_sub_f32 v168, v168, v54
    v_sub_f32 v169, v169, v54
    v_sub_f32 v170, v170, v54
    v_sub_f32 v171, v171, v54
    v_sub_f32 v172, v172, v55
    v_sub_f32 v173, v173, v55
    v_sub_f32 v174, v174, v55
    v_sub_f32 v175, v175, v55
    v_sub_f32 v176, v176, v54
    v_sub_f32 v177, v177, v54
    v_sub_f32 v178, v178, v54
    v_sub_f32 v179, v179, v54
    v_sub_f32 v180, v180, v55
    v_sub_f32 v181, v181, v55
    v_sub_f32 v182, v182, v55
    v_sub_f32 v183, v183, v55
    v_sub_f32 v184, v184, v54
    v_sub_f32 v185, v185, v54
    v_sub_f32 v186, v186, v54
    v_sub_f32 v187, v187, v54
    v_sub_f32 v188, v188, v55
    v_sub_f32 v189, v189, v55
    v_sub_f32 v190, v190, v55
    v_sub_f32 v191, v191, v55
    v_sub_f32 v128, v128, v54
    v_sub_f32 v16, v16, v54
    v_sub_f32 v129, v129, v54
    v_sub_f32 v17, v17, v54
    v_sub_f32 v130, v130, v54
    v_sub_f32 v18, v18, v54
    v_sub_f32 v131, v131, v54
    v_sub_f32 v19, v19, v54
    v_sub_f32 v132, v132, v55
    v_sub_f32 v20, v20, v55
    v_sub_f32 v133, v133, v55
    v_sub_f32 v21, v21, v55
    v_sub_f32 v134, v134, v55
    v_sub_f32 v22, v22, v55
    v_sub_f32 v135, v135, v55
    v_sub_f32 v23, v23, v55
    v_sub_f32 v136, v136, v54
    v_sub_f32 v24, v24, v54
    v_sub_f32 v137, v137, v54
    v_sub_f32 v25, v25, v54
    v_sub_f32 v138, v138, v54
    v_sub_f32 v26, v26, v54
    v_sub_f32 v139, v139, v54
    v_sub_f32 v27, v27, v54
    v_sub_f32 v140, v140, v55
    v_sub_f32 v28, v28, v55
    v_sub_f32 v141, v141, v55
    v_sub_f32 v29, v29, v55
    v_sub_f32 v142, v142, v55
    v_sub_f32 v30, v30, v55
    v_sub_f32 v143, v143, v55
    v_sub_f32 v31, v31, v55
    v_sub_f32 v144, v144, v54
    v_sub_f32 v32, v32, v54
    v_sub_f32 v145, v145, v54
    v_sub_f32 v33, v33, v54
    v_sub_f32 v146, v146, v54
    v_sub_f32 v34, v34, v54
    v_sub_f32 v147, v147, v54
    v_sub_f32 v35, v35, v54
    v_sub_f32 v148, v148, v55
    v_sub_f32 v36, v36, v55
    v_sub_f32 v149, v149, v55
    v_sub_f32 v37, v37, v55
    v_sub_f32 v150, v150, v55
    v_sub_f32 v38, v38, v55
    v_sub_f32 v151, v151, v55
    v_sub_f32 v39, v39, v55
    v_sub_f32 v152, v152, v54
    v_sub_f32 v40, v40, v54
    v_sub_f32 v153, v153, v54
    v_sub_f32 v41, v41, v54
    v_sub_f32 v154, v154, v54
    v_sub_f32 v42, v42, v54
    v_sub_f32 v155, v155, v54
    v_sub_f32 v43, v43, v54
    v_sub_f32 v156, v156, v55
    v_sub_f32 v44, v44, v55
    v_sub_f32 v157, v157, v55
    v_sub_f32 v45, v45, v55
    v_sub_f32 v158, v158, v55
    v_sub_f32 v46, v46, v55
    v_sub_f32 v159, v159, v55
    v_sub_f32 v47, v47, v55
    v_sub_f32 v10, v10, v54
    v_exp_f32 v54, -v54
    v_sub_f32 v11, v11, v55
    v_exp_f32 v55, -v55
    s_nop 0
    v_mul_f32 v248, v248, v54
    v_mul_f32 v252, v252, v55
    v_accvgpr_read_b32 v224, a8
    v_accvgpr_read_b32 v225, a9
    v_accvgpr_read_b32 v226, a10
    v_accvgpr_read_b32 v227, a11
    v_mul_f32 v224, v224, v54
    v_mul_f32 v225, v225, v54
    v_mul_f32 v226, v226, v54
    v_mul_f32 v227, v227, v54
    v_accvgpr_write_b32 a8, v224
    v_accvgpr_write_b32 a9, v225
    v_accvgpr_write_b32 a10, v226
    v_accvgpr_write_b32 a11, v227
    v_accvgpr_read_b32 v224, a12
    v_accvgpr_read_b32 v225, a13
    v_accvgpr_read_b32 v226, a14
    v_accvgpr_read_b32 v227, a15
    v_mul_f32 v224, v224, v55
    v_mul_f32 v225, v225, v55
    v_mul_f32 v226, v226, v55
    v_mul_f32 v227, v227, v55
    v_accvgpr_write_b32 a12, v224
    v_accvgpr_write_b32 a13, v225
    v_accvgpr_write_b32 a14, v226
    v_accvgpr_write_b32 a15, v227
    v_accvgpr_read_b32 v224, a24
    v_accvgpr_read_b32 v225, a25
    v_accvgpr_read_b32 v226, a26
    v_accvgpr_read_b32 v227, a27
    v_mul_f32 v224, v224, v54
    v_mul_f32 v225, v225, v54
    v_mul_f32 v226, v226, v54
    v_mul_f32 v227, v227, v54
    v_accvgpr_write_b32 a24, v224
    v_accvgpr_write_b32 a25, v225
    v_accvgpr_write_b32 a26, v226
    v_accvgpr_write_b32 a27, v227
    v_accvgpr_read_b32 v224, a28
    v_accvgpr_read_b32 v225, a29
    v_accvgpr_read_b32 v226, a30
    v_accvgpr_read_b32 v227, a31
    v_mul_f32 v224, v224, v55
    v_mul_f32 v225, v225, v55
    v_mul_f32 v226, v226, v55
    v_mul_f32 v227, v227, v55
    v_accvgpr_write_b32 a28, v224
    v_accvgpr_write_b32 a29, v225
    v_accvgpr_write_b32 a30, v226
    v_accvgpr_write_b32 a31, v227
    v_accvgpr_read_b32 v224, a40
    v_accvgpr_read_b32 v225, a41
    v_accvgpr_read_b32 v226, a42
    v_accvgpr_read_b32 v227, a43
    v_mul_f32 v224, v224, v54
    v_mul_f32 v225, v225, v54
    v_mul_f32 v226, v226, v54
    v_mul_f32 v227, v227, v54
    v_accvgpr_write_b32 a40, v224
    v_accvgpr_write_b32 a41, v225
    v_accvgpr_write_b32 a42, v226
    v_accvgpr_write_b32 a43, v227
    v_accvgpr_read_b32 v224, a44
    v_accvgpr_read_b32 v225, a45
    v_accvgpr_read_b32 v226, a46
    v_accvgpr_read_b32 v227, a47
    v_mul_f32 v224, v224, v55
    v_mul_f32 v225, v225, v55
    v_mul_f32 v226, v226, v55
    v_mul_f32 v227, v227, v55
    v_accvgpr_write_b32 a44, v224
    v_accvgpr_write_b32 a45, v225
    v_accvgpr_write_b32 a46, v226
    v_accvgpr_write_b32 a47, v227
    v_accvgpr_read_b32 v224, a56
    v_accvgpr_read_b32 v225, a57
    v_accvgpr_read_b32 v226, a58
    v_accvgpr_read_b32 v227, a59
    v_mul_f32 v224, v224, v54
    v_mul_f32 v225, v225, v54
    v_mul_f32 v226, v226, v54
    v_mul_f32 v227, v227, v54
    v_accvgpr_write_b32 a56, v224
    v_accvgpr_write_b32 a57, v225
    v_accvgpr_write_b32 a58, v226
    v_accvgpr_write_b32 a59, v227
    v_accvgpr_read_b32 v224, a60
    v_accvgpr_read_b32 v225, a61
    v_accvgpr_read_b32 v226, a62
    v_accvgpr_read_b32 v227, a63
    v_mul_f32 v224, v224, v55
    v_mul_f32 v225, v225, v55
    v_mul_f32 v226, v226, v55
    v_mul_f32 v227, v227, v55
    v_accvgpr_write_b32 a60, v224
    v_accvgpr_write_b32 a61, v225
    v_accvgpr_write_b32 a62, v226
    v_accvgpr_write_b32 a63, v227
    v_accvgpr_read_b32 v224, a72
    v_accvgpr_read_b32 v225, a73
    v_accvgpr_read_b32 v226, a74
    v_accvgpr_read_b32 v227, a75
    v_mul_f32 v224, v224, v54
    v_mul_f32 v225, v225, v54
    v_mul_f32 v226, v226, v54
    v_mul_f32 v227, v227, v54
    v_accvgpr_write_b32 a72, v224
    v_accvgpr_write_b32 a73, v225
    v_accvgpr_write_b32 a74, v226
    v_accvgpr_write_b32 a75, v227
    v_accvgpr_read_b32 v224, a76
    v_accvgpr_read_b32 v225, a77
    v_accvgpr_read_b32 v226, a78
    v_accvgpr_read_b32 v227, a79
    v_mul_f32 v224, v224, v55
    v_mul_f32 v225, v225, v55
    v_mul_f32 v226, v226, v55
    v_mul_f32 v227, v227, v55
    v_accvgpr_write_b32 a76, v224
    v_accvgpr_write_b32 a77, v225
    v_accvgpr_write_b32 a78, v226
    v_accvgpr_write_b32 a79, v227
    v_accvgpr_read_b32 v224, a88
    v_accvgpr_read_b32 v225, a89
    v_accvgpr_read_b32 v226, a90
    v_accvgpr_read_b32 v227, a91
    v_mul_f32 v224, v224, v54
    v_mul_f32 v225, v225, v54
    v_mul_f32 v226, v226, v54
    v_mul_f32 v227, v227, v54
    v_accvgpr_write_b32 a88, v224
    v_accvgpr_write_b32 a89, v225
    v_accvgpr_write_b32 a90, v226
    v_accvgpr_write_b32 a91, v227
    v_accvgpr_read_b32 v224, a92
    v_accvgpr_read_b32 v225, a93
    v_accvgpr_read_b32 v226, a94
    v_accvgpr_read_b32 v227, a95
    v_mul_f32 v224, v224, v55
    v_mul_f32 v225, v225, v55
    v_mul_f32 v226, v226, v55
    v_mul_f32 v227, v227, v55
    v_accvgpr_write_b32 a92, v224
    v_accvgpr_write_b32 a93, v225
    v_accvgpr_write_b32 a94, v226
    v_accvgpr_write_b32 a95, v227
    v_accvgpr_read_b32 v224, a104
    v_accvgpr_read_b32 v225, a105
    v_accvgpr_read_b32 v226, a106
    v_accvgpr_read_b32 v227, a107
    v_mul_f32 v224, v224, v54
    v_mul_f32 v225, v225, v54
    v_mul_f32 v226, v226, v54
    v_mul_f32 v227, v227, v54
    v_accvgpr_write_b32 a104, v224
    v_accvgpr_write_b32 a105, v225
    v_accvgpr_write_b32 a106, v226
    v_accvgpr_write_b32 a107, v227
    v_accvgpr_read_b32 v224, a108
    v_accvgpr_read_b32 v225, a109
    v_accvgpr_read_b32 v226, a110
    v_accvgpr_read_b32 v227, a111
    v_mul_f32 v224, v224, v55
    v_mul_f32 v225, v225, v55
    v_mul_f32 v226, v226, v55
    v_mul_f32 v227, v227, v55
    v_accvgpr_write_b32 a108, v224
    v_accvgpr_write_b32 a109, v225
    v_accvgpr_write_b32 a110, v226
    v_accvgpr_write_b32 a111, v227
    v_accvgpr_read_b32 v224, a120
    v_accvgpr_read_b32 v225, a121
    v_accvgpr_read_b32 v226, a122
    v_accvgpr_read_b32 v227, a123
    v_mul_f32 v224, v224, v54
    v_mul_f32 v225, v225, v54
    v_mul_f32 v226, v226, v54
    v_mul_f32 v227, v227, v54
    v_accvgpr_write_b32 a120, v224
    v_accvgpr_write_b32 a121, v225
    v_accvgpr_write_b32 a122, v226
    v_accvgpr_write_b32 a123, v227
    v_accvgpr_read_b32 v224, a124
    v_accvgpr_read_b32 v225, a125
    v_accvgpr_read_b32 v226, a126
    v_accvgpr_read_b32 v227, a127
    v_mul_f32 v224, v224, v55
    v_mul_f32 v225, v225, v55
    v_mul_f32 v226, v226, v55
    v_mul_f32 v227, v227, v55
    v_accvgpr_write_b32 a124, v224
    v_accvgpr_write_b32 a125, v225
    v_accvgpr_write_b32 a126, v226
    v_accvgpr_write_b32 a127, v227
    v_exp_f32 v232, v160
    v_exp_f32 v233, v161
    v_exp_f32 v234, v162
    v_exp_f32 v235, v163
    s_nop 0
    v_cvt_pk_bf16_f32 v208, v232, v233
    v_cvt_pk_bf16_f32 v209, v234, v235
    v_exp_f32 v232, v176
    v_exp_f32 v233, v177
    v_exp_f32 v234, v178
    v_exp_f32 v235, v179
    s_nop 0
    v_cvt_pk_bf16_f32 v210, v232, v233
    v_cvt_pk_bf16_f32 v211, v234, v235
    v_exp_f32 v232, v164
    v_exp_f32 v233, v165
    v_exp_f32 v234, v166
    v_exp_f32 v235, v167
    s_nop 0
    v_cvt_pk_bf16_f32 v212, v232, v233
    v_cvt_pk_bf16_f32 v213, v234, v235
    v_exp_f32 v232, v180
    v_exp_f32 v233, v181
    v_exp_f32 v234, v182
    v_exp_f32 v235, v183
    s_nop 0
    v_cvt_pk_bf16_f32 v214, v232, v233
    v_cvt_pk_bf16_f32 v215, v234, v235
    v_exp_f32 v232, v168
    v_exp_f32 v233, v169
    v_exp_f32 v234, v170
    v_exp_f32 v235, v171
    s_nop 0
    v_cvt_pk_bf16_f32 v216, v232, v233
    v_cvt_pk_bf16_f32 v217, v234, v235
    v_exp_f32 v232, v184
    v_exp_f32 v233, v185
    v_exp_f32 v234, v186
    v_exp_f32 v235, v187
    s_nop 0
    v_cvt_pk_bf16_f32 v218, v232, v233
    v_cvt_pk_bf16_f32 v219, v234, v235
    v_exp_f32 v232, v172
    v_exp_f32 v233, v173
    v_exp_f32 v234, v174
    v_exp_f32 v235, v175
    s_nop 0
    v_cvt_pk_bf16_f32 v220, v232, v233
    v_cvt_pk_bf16_f32 v221, v234, v235
    v_exp_f32 v232, v188
    v_exp_f32 v233, v189
    v_exp_f32 v234, v190
    v_exp_f32 v235, v191
    s_nop 0
    v_cvt_pk_bf16_f32 v222, v232, v233
    v_cvt_pk_bf16_f32 v223, v234, v235
    s_nop 1
    s_branch k2_ret_104
k2_rare_107:
    s_nop 7
    v_max_f32 v54, v128, v129
    v_max3_f32 v54, v54, v130, v131
    v_max3_f32 v54, v54, v144, v145
    v_max3_f32 v54, v54, v146, v147
    v_max3_f32 v54, v54, v136, v137
    v_max3_f32 v54, v54, v138, v139
    v_max3_f32 v54, v54, v152, v153
    v_max3_f32 v54, v54, v154, v155
    v_max_f32 v55, v132, v133
    v_max3_f32 v55, v55, v134, v135
    v_max3_f32 v55, v55, v148, v149
    v_max3_f32 v55, v55, v150, v151
    v_max3_f32 v55, v55, v140, v141
    v_max3_f32 v55, v55, v142, v143
    v_max3_f32 v55, v55, v156, v157
    v_max3_f32 v55, v55, v158, v159
    v_mov_b32 v226, v54
    v_mov_b32 v227, v55
    s_nop 1
    v_permlane16_swap_b32 v54, v226
    v_permlane16_swap_b32 v55, v227
    s_nop 1
    v_max_f32 v54, v54, v226
    v_max_f32 v55, v55, v227
    v_mov_b32 v226, v54
    v_mov_b32 v227, v55
    s_nop 1
    v_permlane32_swap_b32 v54, v226
    v_permlane32_swap_b32 v55, v227
    s_nop 1
    v_max_f32 v54, v54, v226
    v_max_f32 v55, v55, v227
    v_add_f32 v54, 0x41400000, v54
    v_max_f32 v54, 0, v54
    v_add_f32 v55, 0x41400000, v55
    v_max_f32 v55, 0, v55
    v_sub_f32 v128, v128, v54
    v_sub_f32 v129, v129, v54
    v_sub_f32 v130, v130, v54
    v_sub_f32 v131, v131, v54
    v_sub_f32 v132, v132, v55
    v_sub_f32 v133, v133, v55
    v_sub_f32 v134, v134, v55
    v_sub_f32 v135, v135, v55
    v_sub_f32 v136, v136, v54
    v_sub_f32 v137, v137, v54
    v_sub_f32 v138, v138, v54
    v_sub_f32 v139, v139, v54
    v_sub_f32 v140, v140, v55
    v_sub_f32 v141, v141, v55
    v_sub_f32 v142, v142, v55
    v_sub_f32 v143, v143, v55
    v_sub_f32 v144, v144, v54
    v_sub_f32 v145, v145, v54
    v_sub_f32 v146, v146, v54
    v_sub_f32 v147, v147, v54
    v_sub_f32 v148, v148, v55
    v_sub_f32 v149, v149, v55
    v_sub_f32 v150, v150, v55
    v_sub_f32 v151, v151, v55
    v_sub_f32 v152, v152, v54
    v_sub_f32 v153, v153, v54
    v_sub_f32 v154, v154, v54
    v_sub_f32 v155, v155, v54
    v_sub_f32 v156, v156, v55
    v_sub_f32 v157, v157, v55
    v_sub_f32 v158, v158, v55
    v_sub_f32 v159, v159, v55
    v_sub_f32 v160, v160, v54
    v_sub_f32 v16, v16, v54
    v_sub_f32 v161, v161, v54
    v_sub_f32 v17, v17, v54
    v_sub_f32 v162, v162, v54
    v_sub_f32 v18, v18, v54
    v_sub_f32 v163, v163, v54
    v_sub_f32 v19, v19, v54
    v_sub_f32 v164, v164, v55
    v_sub_f32 v20, v20, v55
    v_sub_f32 v165, v165, v55
    v_sub_f32 v21, v21, v55
    v_sub_f32 v166, v166, v55
    v_sub_f32 v22, v22, v55
    v_sub_f32 v167, v167, v55
    v_sub_f32 v23, v23, v55
    v_sub_f32 v168, v168, v54
    v_sub_f32 v24, v24, v54
    v_sub_f32 v169, v169, v54
    v_sub_f32 v25, v25, v54
    v_sub_f32 v170, v170, v54
    v_sub_f32 v26, v26, v54
    v_sub_f32 v171, v171, v54
    v_sub_f32 v27, v27, v54
    v_sub_f32 v172, v172, v55
    v_sub_f32 v28, v28, v55
    v_sub_f32 v173, v173, v55
    v_sub_f32 v29, v29, v55
    v_sub_f32 v174, v174, v55
    v_sub_f32 v30, v30, v55
    v_sub_f32 v175, v175, v55
    v_sub_f32 v31, v31, v55
    v_sub_f32 v176, v176, v54
    v_sub_f32 v32, v32, v54
    v_sub_f32 v177, v177, v54
    v_sub_f32 v33, v33, v54
    v_sub_f32 v178, v178, v54
    v_sub_f32 v34, v34, v54
    v_sub_f32 v179, v179, v54
    v_sub_f32 v35, v35, v54
    v_sub_f32 v180, v180, v55
    v_sub_f32 v36, v36, v55
    v_sub_f32 v181, v181, v55
    v_sub_f32 v37, v37, v55
    v_sub_f32 v182, v182, v55
    v_sub_f32 v38, v38, v55
    v_sub_f32 v183, v183, v55
    v_sub_f32 v39, v39, v55
    v_sub_f32 v184, v184, v54
    v_sub_f32 v40, v40, v54
    v_sub_f32 v185, v185, v54
    v_sub_f32 v41, v41, v54
    v_sub_f32 v186, v186, v54
    v_sub_f32 v42, v42, v54
    v_sub_f32 v187, v187, v54
    v_sub_f32 v43, v43, v54
    v_sub_f32 v188, v188, v55
    v_sub_f32 v44, v44, v55
    v_sub_f32 v189, v189, v55
    v_sub_f32 v45, v45, v55
    v_sub_f32 v190, v190, v55
    v_sub_f32 v46, v46, v55
    v_sub_f32 v191, v191, v55
    v_sub_f32 v47, v47, v55
    v_sub_f32 v10, v10, v54
    v_exp_f32 v54, -v54
    v_sub_f32 v11, v11, v55
    v_exp_f32 v55, -v55
    s_nop 0
    v_mul_f32 v248, v248, v54
    v_mul_f32 v252, v252, v55
    v_accvgpr_read_b32 v224, a8
    v_accvgpr_read_b32 v225, a9
    v_accvgpr_read_b32 v226, a10
    v_accvgpr_read_b32 v227, a11
    v_mul_f32 v224, v224, v54
    v_mul_f32 v225, v225, v54
    v_mul_f32 v226, v226, v54
    v_mul_f32 v227, v227, v54
    v_accvgpr_write_b32 a8, v224
    v_accvgpr_write_b32 a9, v225
    v_accvgpr_write_b32 a10, v226
    v_accvgpr_write_b32 a11, v227
    v_accvgpr_read_b32 v224, a12
    v_accvgpr_read_b32 v225, a13
    v_accvgpr_read_b32 v226, a14
    v_accvgpr_read_b32 v227, a15
    v_mul_f32 v224, v224, v55
    v_mul_f32 v225, v225, v55
    v_mul_f32 v226, v226, v55
    v_mul_f32 v227, v227, v55
    v_accvgpr_write_b32 a12, v224
    v_accvgpr_write_b32 a13, v225
    v_accvgpr_write_b32 a14, v226
    v_accvgpr_write_b32 a15, v227
    v_accvgpr_read_b32 v224, a24
    v_accvgpr_read_b32 v225, a25
    v_accvgpr_read_b32 v226, a26
    v_accvgpr_read_b32 v227, a27
    v_mul_f32 v224, v224, v54
    v_mul_f32 v225, v225, v54
    v_mul_f32 v226, v226, v54
    v_mul_f32 v227, v227, v54
    v_accvgpr_write_b32 a24, v224
    v_accvgpr_write_b32 a25, v225
    v_accvgpr_write_b32 a26, v226
    v_accvgpr_write_b32 a27, v227
    v_accvgpr_read_b32 v224, a28
    v_accvgpr_read_b32 v225, a29
    v_accvgpr_read_b32 v226, a30
    v_accvgpr_read_b32 v227, a31
    v_mul_f32 v224, v224, v55
    v_mul_f32 v225, v225, v55
    v_mul_f32 v226, v226, v55
    v_mul_f32 v227, v227, v55
    v_accvgpr_write_b32 a28, v224
    v_accvgpr_write_b32 a29, v225
    v_accvgpr_write_b32 a30, v226
    v_accvgpr_write_b32 a31, v227
    v_accvgpr_read_b32 v224, a40
    v_accvgpr_read_b32 v225, a41
    v_accvgpr_read_b32 v226, a42
    v_accvgpr_read_b32 v227, a43
    v_mul_f32 v224, v224, v54
    v_mul_f32 v225, v225, v54
    v_mul_f32 v226, v226, v54
    v_mul_f32 v227, v227, v54
    v_accvgpr_write_b32 a40, v224
    v_accvgpr_write_b32 a41, v225
    v_accvgpr_write_b32 a42, v226
    v_accvgpr_write_b32 a43, v227
    v_accvgpr_read_b32 v224, a44
    v_accvgpr_read_b32 v225, a45
    v_accvgpr_read_b32 v226, a46
    v_accvgpr_read_b32 v227, a47
    v_mul_f32 v224, v224, v55
    v_mul_f32 v225, v225, v55
    v_mul_f32 v226, v226, v55
    v_mul_f32 v227, v227, v55
    v_accvgpr_write_b32 a44, v224
    v_accvgpr_write_b32 a45, v225
    v_accvgpr_write_b32 a46, v226
    v_accvgpr_write_b32 a47, v227
    v_accvgpr_read_b32 v224, a56
    v_accvgpr_read_b32 v225, a57
    v_accvgpr_read_b32 v226, a58
    v_accvgpr_read_b32 v227, a59
    v_mul_f32 v224, v224, v54
    v_mul_f32 v225, v225, v54
    v_mul_f32 v226, v226, v54
    v_mul_f32 v227, v227, v54
    v_accvgpr_write_b32 a56, v224
    v_accvgpr_write_b32 a57, v225
    v_accvgpr_write_b32 a58, v226
    v_accvgpr_write_b32 a59, v227
    v_accvgpr_read_b32 v224, a60
    v_accvgpr_read_b32 v225, a61
    v_accvgpr_read_b32 v226, a62
    v_accvgpr_read_b32 v227, a63
    v_mul_f32 v224, v224, v55
    v_mul_f32 v225, v225, v55
    v_mul_f32 v226, v226, v55
    v_mul_f32 v227, v227, v55
    v_accvgpr_write_b32 a60, v224
    v_accvgpr_write_b32 a61, v225
    v_accvgpr_write_b32 a62, v226
    v_accvgpr_write_b32 a63, v227
    v_accvgpr_read_b32 v224, a72
    v_accvgpr_read_b32 v225, a73
    v_accvgpr_read_b32 v226, a74
    v_accvgpr_read_b32 v227, a75
    v_mul_f32 v224, v224, v54
    v_mul_f32 v225, v225, v54
    v_mul_f32 v226, v226, v54
    v_mul_f32 v227, v227, v54
    v_accvgpr_write_b32 a72, v224
    v_accvgpr_write_b32 a73, v225
    v_accvgpr_write_b32 a74, v226
    v_accvgpr_write_b32 a75, v227
    v_accvgpr_read_b32 v224, a76
    v_accvgpr_read_b32 v225, a77
    v_accvgpr_read_b32 v226, a78
    v_accvgpr_read_b32 v227, a79
    v_mul_f32 v224, v224, v55
    v_mul_f32 v225, v225, v55
    v_mul_f32 v226, v226, v55
    v_mul_f32 v227, v227, v55
    v_accvgpr_write_b32 a76, v224
    v_accvgpr_write_b32 a77, v225
    v_accvgpr_write_b32 a78, v226
    v_accvgpr_write_b32 a79, v227
    v_accvgpr_read_b32 v224, a88
    v_accvgpr_read_b32 v225, a89
    v_accvgpr_read_b32 v226, a90
    v_accvgpr_read_b32 v227, a91
    v_mul_f32 v224, v224, v54
    v_mul_f32 v225, v225, v54
    v_mul_f32 v226, v226, v54
    v_mul_f32 v227, v227, v54
    v_accvgpr_write_b32 a88, v224
    v_accvgpr_write_b32 a89, v225
    v_accvgpr_write_b32 a90, v226
    v_accvgpr_write_b32 a91, v227
    v_accvgpr_read_b32 v224, a92
    v_accvgpr_read_b32 v225, a93
    v_accvgpr_read_b32 v226, a94
    v_accvgpr_read_b32 v227, a95
    v_mul_f32 v224, v224, v55
    v_mul_f32 v225, v225, v55
    v_mul_f32 v226, v226, v55
    v_mul_f32 v227, v227, v55
    v_accvgpr_write_b32 a92, v224
    v_accvgpr_write_b32 a93, v225
    v_accvgpr_write_b32 a94, v226
    v_accvgpr_write_b32 a95, v227
    v_accvgpr_read_b32 v224, a104
    v_accvgpr_read_b32 v225, a105
    v_accvgpr_read_b32 v226, a106
    v_accvgpr_read_b32 v227, a107
    v_mul_f32 v224, v224, v54
    v_mul_f32 v225, v225, v54
    v_mul_f32 v226, v226, v54
    v_mul_f32 v227, v227, v54
    v_accvgpr_write_b32 a104, v224
    v_accvgpr_write_b32 a105, v225
    v_accvgpr_write_b32 a106, v226
    v_accvgpr_write_b32 a107, v227
    v_accvgpr_read_b32 v224, a108
    v_accvgpr_read_b32 v225, a109
    v_accvgpr_read_b32 v226, a110
    v_accvgpr_read_b32 v227, a111
    v_mul_f32 v224, v224, v55
    v_mul_f32 v225, v225, v55
    v_mul_f32 v226, v226, v55
    v_mul_f32 v227, v227, v55
    v_accvgpr_write_b32 a108, v224
    v_accvgpr_write_b32 a109, v225
    v_accvgpr_write_b32 a110, v226
    v_accvgpr_write_b32 a111, v227
    v_accvgpr_read_b32 v224, a120
    v_accvgpr_read_b32 v225, a121
    v_accvgpr_read_b32 v226, a122
    v_accvgpr_read_b32 v227, a123
    v_mul_f32 v224, v224, v54
    v_mul_f32 v225, v225, v54
    v_mul_f32 v226, v226, v54
    v_mul_f32 v227, v227, v54
    v_accvgpr_write_b32 a120, v224
    v_accvgpr_write_b32 a121, v225
    v_accvgpr_write_b32 a122, v226
    v_accvgpr_write_b32 a123, v227
    v_accvgpr_read_b32 v224, a124
    v_accvgpr_read_b32 v225, a125
    v_accvgpr_read_b32 v226, a126
    v_accvgpr_read_b32 v227, a127
    v_mul_f32 v224, v224, v55
    v_mul_f32 v225, v225, v55
    v_mul_f32 v226, v226, v55
    v_mul_f32 v227, v227, v55
    v_accvgpr_write_b32 a124, v224
    v_accvgpr_write_b32 a125, v225
    v_accvgpr_write_b32 a126, v226
    v_accvgpr_write_b32 a127, v227
    v_exp_f32 v232, v128
    v_exp_f32 v233, v129
    v_exp_f32 v234, v130
    v_exp_f32 v235, v131
    s_nop 0
    v_cvt_pk_bf16_f32 v192, v232, v233
    v_cvt_pk_bf16_f32 v193, v234, v235
    v_exp_f32 v232, v144
    v_exp_f32 v233, v145
    v_exp_f32 v234, v146
    v_exp_f32 v235, v147
    s_nop 0
    v_cvt_pk_bf16_f32 v194, v232, v233
    v_cvt_pk_bf16_f32 v195, v234, v235
    v_exp_f32 v232, v132
    v_exp_f32 v233, v133
    v_exp_f32 v234, v134
    v_exp_f32 v235, v135
    s_nop 0
    v_cvt_pk_bf16_f32 v196, v232, v233
    v_cvt_pk_bf16_f32 v197, v234, v235
    v_exp_f32 v232, v148
    v_exp_f32 v233, v149
    v_exp_f32 v234, v150
    v_exp_f32 v235, v151
    s_nop 0
    v_cvt_pk_bf16_f32 v198, v232, v233
    v_cvt_pk_bf16_f32 v199, v234, v235
    v_exp_f32 v232, v136
    v_exp_f32 v233, v137
    v_exp_f32 v234, v138
    v_exp_f32 v235, v139
    s_nop 0
    v_cvt_pk_bf16_f32 v200, v232, v233
    v_cvt_pk_bf16_f32 v201, v234, v235
    v_exp_f32 v232, v152
    v_exp_f32 v233, v153
    v_exp_f32 v234, v154
    v_exp_f32 v235, v155
    s_nop 0
    v_cvt_pk_bf16_f32 v202, v232, v233
    v_cvt_pk_bf16_f32 v203, v234, v235
    v_exp_f32 v232, v140
    v_exp_f32 v233, v141
    v_exp_f32 v234, v142
    v_exp_f32 v235, v143
    s_nop 0
    v_cvt_pk_bf16_f32 v204, v232, v233
    v_cvt_pk_bf16_f32 v205, v234, v235
    v_exp_f32 v232, v156
    v_exp_f32 v233, v157
    v_exp_f32 v234, v158
    v_exp_f32 v235, v159
    s_nop 0
    v_cvt_pk_bf16_f32 v206, v232, v233
    v_cvt_pk_bf16_f32 v207, v234, v235
    s_nop 1
    s_branch k2_ret_108
k2_rare_109:
    s_nop 7
    v_max_f32 v54, v160, v161
    v_max3_f32 v54, v54, v162, v163
    v_max3_f32 v54, v54, v176, v177
    v_max3_f32 v54, v54, v178, v179
    v_max3_f32 v54, v54, v168, v169
    v_max3_f32 v54, v54, v170, v171
    v_max3_f32 v54, v54, v184, v185
    v_max3_f32 v54, v54, v186, v187
    v_max_f32 v55, v164, v165
    v_max3_f32 v55, v55, v166, v167
    v_max3_f32 v55, v55, v180, v181
    v_max3_f32 v55, v55, v182, v183
    v_max3_f32 v55, v55, v172, v173
    v_max3_f32 v55, v55, v174, v175
    v_max3_f32 v55, v55, v188, v189
    v_max3_f32 v55, v55, v190, v191
    v_mov_b32 v226, v54
    v_mov_b32 v227, v55
    s_nop 1
    v_permlane16_swap_b32 v54, v226
    v_permlane16_swap_b32 v55, v227
    s_nop 1
    v_max_f32 v54, v54, v226
    v_max_f32 v55, v55, v227
    v_mov_b32 v226, v54
    v_mov_b32 v227, v55
    s_nop 1
    v_permlane32_swap_b32 v54, v226
    v_permlane32_swap_b32 v55, v227
    s_nop 1
    v_max_f32 v54, v54, v226
    v_max_f32 v55, v55, v227
    v_add_f32 v54, 0x41400000, v54
    v_max_f32 v54, 0, v54
    v_add_f32 v55, 0x41400000, v55
    v_max_f32 v55, 0, v55
    v_sub_f32 v160, v160, v54
    v_sub_f32 v161, v161, v54
    v_sub_f32 v162, v162, v54
    v_sub_f32 v163, v163, v54
    v_sub_f32 v164, v164, v55
    v_sub_f32 v165, v165, v55
    v_sub_f32 v166, v166, v55
    v_sub_f32 v167, v167, v55
    v_sub_f32 v168, v168, v54
    v_sub_f32 v169, v169, v54
    v_sub_f32 v170, v170, v54
    v_sub_f32 v171, v171, v54
    v_sub_f32 v172, v172, v55
    v_sub_f32 v173, v173, v55
    v_sub_f32 v174, v174, v55
    v_sub_f32 v175, v175, v55
    v_sub_f32 v176, v176, v54
    v_sub_f32 v177, v177, v54
    v_sub_f32 v178, v178, v54
    v_sub_f32 v179, v179, v54
    v_sub_f32 v180, v180, v55
    v_sub_f32 v181, v181, v55
    v_sub_f32 v182, v182, v55
    v_sub_f32 v183, v183, v55
    v_sub_f32 v184, v184, v54
    v_sub_f32 v185, v185, v54
    v_sub_f32 v186, v186, v54
    v_sub_f32 v187, v187, v54
    v_sub_f32 v188, v188, v55
    v_sub_f32 v189, v189, v55
    v_sub_f32 v190, v190, v55
    v_sub_f32 v191, v191, v55
    v_sub_f32 v10, v10, v54
    v_exp_f32 v54, -v54
    v_sub_f32 v11, v11, v55
    v_exp_f32 v55, -v55
    s_nop 0
    v_mul_f32 v248, v248, v54
    v_mul_f32 v252, v252, v55
    v_accvgpr_read_b32 v224, a8
    v_accvgpr_read_b32 v225, a9
    v_accvgpr_read_b32 v226, a10
    v_accvgpr_read_b32 v227, a11
    v_mul_f32 v224, v224, v54
    v_mul_f32 v225, v225, v54
    v_mul_f32 v226, v226, v54
    v_mul_f32 v227, v227, v54
    v_accvgpr_write_b32 a8, v224
    v_accvgpr_write_b32 a9, v225
    v_accvgpr_write_b32 a10, v226
    v_accvgpr_write_b32 a11, v227
    v_accvgpr_read_b32 v224, a12
    v_accvgpr_read_b32 v225, a13
    v_accvgpr_read_b32 v226, a14
    v_accvgpr_read_b32 v227, a15
    v_mul_f32 v224, v224, v55
    v_mul_f32 v225, v225, v55
    v_mul_f32 v226, v226, v55
    v_mul_f32 v227, v227, v55
    v_accvgpr_write_b32 a12, v224
    v_accvgpr_write_b32 a13, v225
    v_accvgpr_write_b32 a14, v226
    v_accvgpr_write_b32 a15, v227
    v_accvgpr_read_b32 v224, a24
    v_accvgpr_read_b32 v225, a25
    v_accvgpr_read_b32 v226, a26
    v_accvgpr_read_b32 v227, a27
    v_mul_f32 v224, v224, v54
    v_mul_f32 v225, v225, v54
    v_mul_f32 v226, v226, v54
    v_mul_f32 v227, v227, v54
    v_accvgpr_write_b32 a24, v224
    v_accvgpr_write_b32 a25, v225
    v_accvgpr_write_b32 a26, v226
    v_accvgpr_write_b32 a27, v227
    v_accvgpr_read_b32 v224, a28
    v_accvgpr_read_b32 v225, a29
    v_accvgpr_read_b32 v226, a30
    v_accvgpr_read_b32 v227, a31
    v_mul_f32 v224, v224, v55
    v_mul_f32 v225, v225, v55
    v_mul_f32 v226, v226, v55
    v_mul_f32 v227, v227, v55
    v_accvgpr_write_b32 a28, v224
    v_accvgpr_write_b32 a29, v225
    v_accvgpr_write_b32 a30, v226
    v_accvgpr_write_b32 a31, v227
    v_accvgpr_read_b32 v224, a40
    v_accvgpr_read_b32 v225, a41
    v_accvgpr_read_b32 v226, a42
    v_accvgpr_read_b32 v227, a43
    v_mul_f32 v224, v224, v54
    v_mul_f32 v225, v225, v54
    v_mul_f32 v226, v226, v54
    v_mul_f32 v227, v227, v54
    v_accvgpr_write_b32 a40, v224
    v_accvgpr_write_b32 a41, v225
    v_accvgpr_write_b32 a42, v226
    v_accvgpr_write_b32 a43, v227
    v_accvgpr_read_b32 v224, a44
    v_accvgpr_read_b32 v225, a45
    v_accvgpr_read_b32 v226, a46
    v_accvgpr_read_b32 v227, a47
    v_mul_f32 v224, v224, v55
    v_mul_f32 v225, v225, v55
    v_mul_f32 v226, v226, v55
    v_mul_f32 v227, v227, v55
    v_accvgpr_write_b32 a44, v224
    v_accvgpr_write_b32 a45, v225
    v_accvgpr_write_b32 a46, v226
    v_accvgpr_write_b32 a47, v227
    v_accvgpr_read_b32 v224, a56
    v_accvgpr_read_b32 v225, a57
    v_accvgpr_read_b32 v226, a58
    v_accvgpr_read_b32 v227, a59
    v_mul_f32 v224, v224, v54
    v_mul_f32 v225, v225, v54
    v_mul_f32 v226, v226, v54
    v_mul_f32 v227, v227, v54
    v_accvgpr_write_b32 a56, v224
    v_accvgpr_write_b32 a57, v225
    v_accvgpr_write_b32 a58, v226
    v_accvgpr_write_b32 a59, v227
    v_accvgpr_read_b32 v224, a60
    v_accvgpr_read_b32 v225, a61
    v_accvgpr_read_b32 v226, a62
    v_accvgpr_read_b32 v227, a63
    v_mul_f32 v224, v224, v55
    v_mul_f32 v225, v225, v55
    v_mul_f32 v226, v226, v55
    v_mul_f32 v227, v227, v55
    v_accvgpr_write_b32 a60, v224
    v_accvgpr_write_b32 a61, v225
    v_accvgpr_write_b32 a62, v226
    v_accvgpr_write_b32 a63, v227
    v_accvgpr_read_b32 v224, a72
    v_accvgpr_read_b32 v225, a73
    v_accvgpr_read_b32 v226, a74
    v_accvgpr_read_b32 v227, a75
    v_mul_f32 v224, v224, v54
    v_mul_f32 v225, v225, v54
    v_mul_f32 v226, v226, v54
    v_mul_f32 v227, v227, v54
    v_accvgpr_write_b32 a72, v224
    v_accvgpr_write_b32 a73, v225
    v_accvgpr_write_b32 a74, v226
    v_accvgpr_write_b32 a75, v227
    v_accvgpr_read_b32 v224, a76
    v_accvgpr_read_b32 v225, a77
    v_accvgpr_read_b32 v226, a78
    v_accvgpr_read_b32 v227, a79
    v_mul_f32 v224, v224, v55
    v_mul_f32 v225, v225, v55
    v_mul_f32 v226, v226, v55
    v_mul_f32 v227, v227, v55
    v_accvgpr_write_b32 a76, v224
    v_accvgpr_write_b32 a77, v225
    v_accvgpr_write_b32 a78, v226
    v_accvgpr_write_b32 a79, v227
    v_accvgpr_read_b32 v224, a88
    v_accvgpr_read_b32 v225, a89
    v_accvgpr_read_b32 v226, a90
    v_accvgpr_read_b32 v227, a91
    v_mul_f32 v224, v224, v54
    v_mul_f32 v225, v225, v54
    v_mul_f32 v226, v226, v54
    v_mul_f32 v227, v227, v54
    v_accvgpr_write_b32 a88, v224
    v_accvgpr_write_b32 a89, v225
    v_accvgpr_write_b32 a90, v226
    v_accvgpr_write_b32 a91, v227
    v_accvgpr_read_b32 v224, a92
    v_accvgpr_read_b32 v225, a93
    v_accvgpr_read_b32 v226, a94
    v_accvgpr_read_b32 v227, a95
    v_mul_f32 v224, v224, v55
    v_mul_f32 v225, v225, v55
    v_mul_f32 v226, v226, v55
    v_mul_f32 v227, v227, v55
    v_accvgpr_write_b32 a92, v224
    v_accvgpr_write_b32 a93, v225
    v_accvgpr_write_b32 a94, v226
    v_accvgpr_write_b32 a95, v227
    v_accvgpr_read_b32 v224, a104
    v_accvgpr_read_b32 v225, a105
    v_accvgpr_read_b32 v226, a106
    v_accvgpr_read_b32 v227, a107
    v_mul_f32 v224, v224, v54
    v_mul_f32 v225, v225, v54
    v_mul_f32 v226, v226, v54
    v_mul_f32 v227, v227, v54
    v_accvgpr_write_b32 a104, v224
    v_accvgpr_write_b32 a105, v225
    v_accvgpr_write_b32 a106, v226
    v_accvgpr_write_b32 a107, v227
    v_accvgpr_read_b32 v224, a108
    v_accvgpr_read_b32 v225, a109
    v_accvgpr_read_b32 v226, a110
    v_accvgpr_read_b32 v227, a111
    v_mul_f32 v224, v224, v55
    v_mul_f32 v225, v225, v55
    v_mul_f32 v226, v226, v55
    v_mul_f32 v227, v227, v55
    v_accvgpr_write_b32 a108, v224
    v_accvgpr_write_b32 a109, v225
    v_accvgpr_write_b32 a110, v226
    v_accvgpr_write_b32 a111, v227
    v_accvgpr_read_b32 v224, a120
    v_accvgpr_read_b32 v225, a121
    v_accvgpr_read_b32 v226, a122
    v_accvgpr_read_b32 v227, a123
    v_mul_f32 v224, v224, v54
    v_mul_f32 v225, v225, v54
    v_mul_f32 v226, v226, v54
    v_mul_f32 v227, v227, v54
    v_accvgpr_write_b32 a120, v224
    v_accvgpr_write_b32 a121, v225
    v_accvgpr_write_b32 a122, v226
    v_accvgpr_write_b32 a123, v227
    v_accvgpr_read_b32 v224, a124
    v_accvgpr_read_b32 v225, a125
    v_accvgpr_read_b32 v226, a126
    v_accvgpr_read_b32 v227, a127
    v_mul_f32 v224, v224, v55
    v_mul_f32 v225, v225, v55
    v_mul_f32 v226, v226, v55
    v_mul_f32 v227, v227, v55
    v_accvgpr_write_b32 a124, v224
    v_accvgpr_write_b32 a125, v225
    v_accvgpr_write_b32 a126, v226
    v_accvgpr_write_b32 a127, v227
    v_exp_f32 v232, v160
    v_exp_f32 v233, v161
    v_exp_f32 v234, v162
    v_exp_f32 v235, v163
    s_nop 0
    v_cvt_pk_bf16_f32 v208, v232, v233
    v_cvt_pk_bf16_f32 v209, v234, v235
    v_exp_f32 v232, v176
    v_exp_f32 v233, v177
    v_exp_f32 v234, v178
    v_exp_f32 v235, v179
    s_nop 0
    v_cvt_pk_bf16_f32 v210, v232, v233
    v_cvt_pk_bf16_f32 v211, v234, v235
    v_exp_f32 v232, v164
    v_exp_f32 v233, v165
    v_exp_f32 v234, v166
    v_exp_f32 v235, v167
    s_nop 0
    v_cvt_pk_bf16_f32 v212, v232, v233
    v_cvt_pk_bf16_f32 v213, v234, v235
    v_exp_f32 v232, v180
    v_exp_f32 v233, v181
    v_exp_f32 v234, v182
    v_exp_f32 v235, v183
    s_nop 0
    v_cvt_pk_bf16_f32 v214, v232, v233
    v_cvt_pk_bf16_f32 v215, v234, v235
    v_exp_f32 v232, v168
    v_exp_f32 v233, v169
    v_exp_f32 v234, v170
    v_exp_f32 v235, v171
    s_nop 0
    v_cvt_pk_bf16_f32 v216, v232, v233
    v_cvt_pk_bf16_f32 v217, v234, v235
    v_exp_f32 v232, v184
    v_exp_f32 v233, v185
    v_exp_f32 v234, v186
    v_exp_f32 v235, v187
    s_nop 0
    v_cvt_pk_bf16_f32 v218, v232, v233
    v_cvt_pk_bf16_f32 v219, v234, v235
    v_exp_f32 v232, v172
    v_exp_f32 v233, v173
    v_exp_f32 v234, v174
    v_exp_f32 v235, v175
    s_nop 0
    v_cvt_pk_bf16_f32 v220, v232, v233
    v_cvt_pk_bf16_f32 v221, v234, v235
    v_exp_f32 v232, v188
    v_exp_f32 v233, v189
    v_exp_f32 v234, v190
    v_exp_f32 v235, v191
    s_nop 0
    v_cvt_pk_bf16_f32 v222, v232, v233
    v_cvt_pk_bf16_f32 v223, v234, v235
    s_nop 1
    s_branch k2_ret_110
.globl k3_kernel
.p2align 8
.type k3_kernel,@function
k3_kernel:
    s_cmp_ge_u32 s2, 256
    s_cbranch_scc1 k3_end_112
    s_load_dwordx2 s[4:5], s[0:1], 40
    s_load_dwordx2 s[6:7], s[0:1], 104
    s_load_dwordx2 s[28:29], s[0:1], 0
    s_load_dwordx2 s[30:31], s[0:1], 56
    s_lshr_b32 s41, s2, 3
    s_bfe_u32 s44, s2, 0x10002
    s_and_b32 s42, s2, 1
    s_lshl_b32 s42, s42, 3
    s_and_b32 s43, s41, 7
    s_add_u32 s42, s42, s43
    s_and_b32 s43, s2, 2
    s_lshl_b32 s43, s43, 1
    s_lshr_b32 s40, s41, 3
    s_add_u32 s43, s43, s40
    v_lshrrev_b32 v10, 6, v0
    v_and_b32 v11, 63, v0
    v_readfirstlane_b32 s45, v10
    v_lshlrev_b32 v1, 4, v11
    s_lshl_b32 s46, s42, 7
    s_lshl_b32 s47, s45, 5
    s_add_u32 s46, s46, s47
    s_lshl_b32 s47, s46, 6
    v_add_u32 v12, s47, v1
    v_add_u32 v13, 0x20000, v12
    v_lshrrev_b32 v20, 4, v11
    v_bfe_u32 v21, v11, 1, 3
    v_xor_b32 v21, v21, v20
    v_and_b32 v22, 1, v11
    v_lshl_add_u32 v23, v10, 4, v20
    v_lshlrev_b32 v23, 11, v23
    v_lshl_add_u32 v23, v22, 4, v23
    s_lshl_b32 s47, s43, 8
    v_add_u32 v23, s47, v23
    v_xor_b32 v22, 0, v21
    v_lshl_add_u32 v22, v22, 5, v23
    v_add_u32 v16, 0, v22
    v_xor_b32 v22, 4, v21
    v_lshl_add_u32 v22, v22, 5, v23
    v_add_u32 v17, 7168, v22
    v_xor_b32 v22, 0, v21
    v_lshl_add_u32 v22, v22, 5, v23
    v_add_u32 v18, 14336, v22
    v_xor_b32 v22, 4, v21
    v_lshl_add_u32 v22, v22, 5, v23
    v_add_u32 v19, 21504, v22
    s_lshl_b32 s60, s45, 12
    s_lshl_b32 s61, s44, 22
    s_lshl_b32 s62, s44, 23
    s_waitcnt lgkmcnt(0)
    s_add_u32 s8, s6, 0x3000000
    s_addc_u32 s9, s7, 0
    s_and_b32 s9, s9, 0xffff
    s_mov_b32 s10, 0x1000000
    s_mov_b32 s11, 0x00020000
    s_mov_b32 s12, s4
    s_and_b32 s13, s5, 0xffff
    s_mov_b32 s14, 0x800000
    s_mov_b32 s15, 0x00020000
    s_add_u32 s10, s62, 0x800000
    s_add_u32 s14, s61, 0x400000
    s_add_u32 m0, s60, 0
    s_nop 0
    buffer_load_dwordx4 v16, s[12:15], s61 offen offset:0 lds
    buffer_load_dwordx4 v17, s[12:15], s61 offen offset:1024 lds
    buffer_load_dwordx4 v18, s[12:15], s61 offen offset:2048 lds
    buffer_load_dwordx4 v19, s[12:15], s61 offen offset:3072 lds
    s_add_u32 s61, s61, 0x20000
    buffer_load_dwordx4 a[128:131], v12, s[8:11], s62 offen offset:0
    buffer_load_dwordx4 a[132:135], v12, s[8:11], s62 offen offset:1024
    buffer_load_dwordx4 a[136:139], v13, s[8:11], s62 offen offset:0
    buffer_load_dwordx4 a[140:143], v13, s[8:11], s62 offen offset:1024
    s_add_u32 s62, s62, 0x40000
    s_add_u32 m0, s60, 16384
    s_nop 0
    buffer_load_dwordx4 v16, s[12:15], s61 offen offset:0 lds
    buffer_load_dwordx4 v17, s[12:15], s61 offen offset:1024 lds
    buffer_load_dwordx4 v18, s[12:15], s61 offen offset:2048 lds
    buffer_load_dwordx4 v19, s[12:15], s61 offen offset:3072 lds
    s_add_u32 s61, s61, 0x20000
    buffer_load_dwordx4 a[144:147], v12, s[8:11], s62 offen offset:0
    buffer_load_dwordx4 a[148:151], v12, s[8:11], s62 offen offset:1024
    buffer_load_dwordx4 a[152:155], v13, s[8:11], s62 offen offset:0
    buffer_load_dwordx4 a[156:159], v13, s[8:11], s62 offen offset:1024
    s_add_u32 s62, s62, 0x40000
    s_add_u32 m0, s60, 32768
    s_nop 0
    buffer_load_dwordx4 v16, s[12:15], s61 offen offset:0 lds
    buffer_load_dwordx4 v17, s[12:15], s61 offen offset:1024 lds
    buffer_load_dwordx4 v18, s[12:15], s61 offen offset:2048 lds
    buffer_load_dwordx4 v19, s[12:15], s61 offen offset:3072 lds
    s_add_u32 s61, s61, 0x20000
    buffer_load_dwordx4 a[160:163], v12, s[8:11], s62 offen offset:0
    buffer_load_dwordx4 a[164:167], v12, s[8:11], s62 offen offset:1024
    buffer_load_dwordx4 a[168:171], v13, s[8:11], s62 offen offset:0
    buffer_load_dwordx4 a[172:175], v13, s[8:11], s62 offen offset:1024
    s_add_u32 s62, s62, 0x40000
    s_mov_b32 s16, s28
    s_and_b32 s17, s29, 0xffff
    s_mov_b32 s18, 0x400000
    s_mov_b32 s19, 0x00020000
    s_mov_b32 s20, s30
    s_and_b32 s21, s31, 0xffff
    s_mov_b32 s22, 0x800
    s_mov_b32 s23, 0x00020000
    s_add_u32 s24, s6, 0x4000000
    s_addc_u32 s25, s7, 0
    s_and_b32 s25, s25, 0xffff
    s_mov_b32 s26, 0x400000
    s_mov_b32 s27, 0x00020000
    s_add_u32 s32, s6, 0x4800000
    s_addc_u32 s33, s7, 0
    s_and_b32 s33, s33, 0xffff
    s_mov_b32 s34, 0x6000
    s_mov_b32 s35, 0x00020000
    s_add_u32 s36, s6, 0x5000000
    s_addc_u32 s37, s7, 0
    s_and_b32 s37, s37, 0xffff
    s_mov_b32 s38, 0x800000
    s_mov_b32 s39, 0x00020000
    s_add_u32 s48, s6, 0x4807000
    s_addc_u32 s49, s7, 0
    s_and_b32 s49, s49, 0xffff
    s_mov_b32 s50, 0x8000
    s_mov_b32 s51, 0x00020000
    v_and_b32 v21, 15, v11
    v_add_u32 v22, s46, v21
    v_lshlrev_b32 v2, 2, v22
    v_lshl_add_u32 v2, v20, 13, v2
    v_lshlrev_b32 v22, 11, v22
    s_lshl_b32 s52, s44, 7
    s_add_u32 s47, s47, s52
    v_lshl_add_u32 v14, v20, 3, s47
    v_add_u32 v3, v22, v14
    v_add_u32 v4, 0x8000, v3
    s_lshl_b32 s52, s2, 14
    s_add_u32 s52, s52, s60
    s_xor_b32 s53, s52, 0x10000
    s_lshl_b32 s54, s2, 7
    s_xor_b32 s55, s54, 0x200
    v_mov_b32 v5, 0
    v_mov_b32 v6, 1
    v_lshrrev_b32 v22, 2, v21
    v_lshl_add_u32 v22, v20, 2, v22
    v_and_b32 v23, 7, v22
    s_lshl_b32 s56, s44, 2
    v_xor_b32 v23, s56, v23
    v_lshlrev_b32 v22, 8, v22
    v_and_b32 v32, 3, v11
    v_lshl_add_u32 v22, v32, 3, v22
    v_xor_b32 v32, 0, v23
    v_lshl_add_u32 v24, v32, 5, v22
    v_xor_b32 v32, 1, v23
    v_lshl_add_u32 v25, v32, 5, v22
    v_xor_b32 v32, 2, v23
    v_lshl_add_u32 v26, v32, 5, v22
    v_xor_b32 v32, 3, v23
    v_lshl_add_u32 v27, v32, 5, v22
    v_xor_b32 v32, 4, v23
    v_lshl_add_u32 v28, v32, 5, v22
    v_xor_b32 v32, 5, v23
    v_lshl_add_u32 v29, v32, 5, v22
    v_xor_b32 v32, 6, v23
    v_lshl_add_u32 v30, v32, 5, v22
    v_xor_b32 v32, 7, v23
    v_lshl_add_u32 v31, v32, 5, v22
    s_mov_b32 s57, (code_end-k3_tail)/128
    v_mov_b32 v56, 0
    v_mov_b32 v57, 0
    v_mov_b32 v58, 0
    v_mov_b32 v59, 0
    s_nop 1
    v_mfma_f32_32x32x16_bf16 v[64:79], v[56:59], v[56:59], 0
    v_mfma_f32_32x32x16_bf16 v[80:95], v[56:59], v[56:59], 0
    v_mfma_f32_32x32x16_bf16 v[96:111], v[56:59], v[56:59], 0
    v_mfma_f32_32x32x16_bf16 v[112:127], v[56:59], v[56:59], 0
    v_min_u32 v33, s57, v0
    s_getpc_b64 s[58:59]
pc_113:
    s_add_u32 s58, s58, k3_tail-pc_113
    s_addc_u32 s59, s59, 0
    v_lshlrev_b32 v8, 7, v33
    v_mov_b32 v9, s59
    v_add_co_u32 v8, vcc, s58, v8
    s_nop 1
    v_addc_co_u32 v9, vcc, 0, v9, vcc
    s_waitcnt vmcnt(20)
    s_barrier
    ds_read_b64_tr_b16 a[0:1], v24 offset:0
    ds_read_b64_tr_b16 a[2:3], v24 offset:4096
    ds_read_b64_tr_b16 a[4:5], v25 offset:0
    ds_read_b64_tr_b16 a[6:7], v25 offset:4096
    ds_read_b64_tr_b16 a[8:9], v26 offset:0
    ds_read_b64_tr_b16 a[10:11], v26 offset:4096
    ds_read_b64_tr_b16 a[12:13], v27 offset:0
    ds_read_b64_tr_b16 a[14:15], v27 offset:4096
    ds_read_b64_tr_b16 a[16:17], v28 offset:0
    ds_read_b64_tr_b16 a[18:19], v28 offset:4096
    ds_read_b64_tr_b16 a[20:21], v29 offset:0
    ds_read_b64_tr_b16 a[22:23], v29 offset:4096
    ds_read_b64_tr_b16 a[24:25], v30 offset:0
    ds_read_b64_tr_b16 a[26:27], v30 offset:4096
    ds_read_b64_tr_b16 a[28:29], v31 offset:0
    ds_read_b64_tr_b16 a[30:31], v31 offset:4096
    ds_read_b64_tr_b16 a[32:33], v24 offset:8192
    ds_read_b64_tr_b16 a[34:35], v24 offset:12288
    ds_read_b64_tr_b16 a[36:37], v25 offset:8192
    ds_read_b64_tr_b16 a[38:39], v25 offset:12288
    ds_read_b64_tr_b16 a[40:41], v26 offset:8192
    ds_read_b64_tr_b16 a[42:43], v26 offset:12288
    ds_read_b64_tr_b16 a[44:45], v27 offset:8192
    ds_read_b64_tr_b16 a[46:47], v27 offset:12288
    ds_read_b64_tr_b16 a[48:49], v28 offset:8192
    ds_read_b64_tr_b16 a[50:51], v28 offset:12288
    ds_read_b64_tr_b16 a[52:53], v29 offset:8192
    ds_read_b64_tr_b16 a[54:55], v29 offset:12288
    ds_read_b64_tr_b16 a[56:57], v30 offset:8192
    ds_read_b64_tr_b16 a[58:59], v30 offset:12288
    ds_read_b64_tr_b16 a[60:61], v31 offset:8192
    ds_read_b64_tr_b16 a[62:63], v31 offset:12288
    s_mov_b32 s63, 0
    s_waitcnt vmcnt(12) lgkmcnt(0)
    s_barrier
k3_loop_114:
    v_mfma_f32_16x16x32_bf16 v[96:99], a[16:19], a[128:131], v[96:99]
    s_add_u32 m0, s60, 49152
    ds_read_b64_tr_b16 a[64:65], v24 offset:16384
    ds_read_b64_tr_b16 a[66:67], v24 offset:20480
    v_mfma_f32_16x16x32_bf16 v[100:103], a[16:19], a[132:135], v[100:103]
    buffer_load_dwordx4 v16, s[12:15], s61 offen offset:0 lds
    ds_read_b64_tr_b16 a[68:69], v25 offset:16384
    v_mfma_f32_16x16x32_bf16 v[104:107], a[20:23], a[128:131], v[104:107]
    ds_read_b64_tr_b16 a[70:71], v25 offset:20480
    ds_read_b64_tr_b16 a[72:73], v26 offset:16384
    v_mfma_f32_16x16x32_bf16 v[108:111], a[20:23], a[132:135], v[108:111]
    buffer_load_dwordx4 v17, s[12:15], s61 offen offset:1024 lds
    ds_read_b64_tr_b16 a[74:75], v26 offset:20480
    v_mfma_f32_16x16x32_bf16 v[112:115], a[24:27], a[128:131], v[112:115]
    ds_read_b64_tr_b16 a[76:77], v27 offset:16384
    ds_read_b64_tr_b16 a[78:79], v27 offset:20480
    v_mfma_f32_16x16x32_bf16 v[116:119], a[24:27], a[132:135], v[116:119]
    ds_read_b64_tr_b16 a[80:81], v28 offset:16384
    v_mfma_f32_16x16x32_bf16 v[120:123], a[28:31], a[128:131], v[120:123]
    ds_read_b64_tr_b16 a[82:83], v28 offset:20480
    v_mfma_f32_16x16x32_bf16 v[124:127], a[28:31], a[132:135], v[124:127]
    buffer_load_dwordx4 v18, s[12:15], s61 offen offset:2048 lds
    ds_read_b64_tr_b16 a[84:85], v29 offset:16384
    v_mfma_f32_16x16x32_bf16 v[64:67], a[0:3], a[128:131], v[64:67]
    ds_read_b64_tr_b16 a[86:87], v29 offset:20480
    ds_read_b64_tr_b16 a[88:89], v30 offset:16384
    v_mfma_f32_16x16x32_bf16 v[68:71], a[0:3], a[132:135], v[68:71]
    ds_read_b64_tr_b16 a[90:91], v30 offset:20480
    v_mfma_f32_16x16x32_bf16 v[72:75], a[4:7], a[128:131], v[72:75]
    buffer_load_dwordx4 v19, s[12:15], s61 offen offset:3072 lds
    ds_read_b64_tr_b16 a[92:93], v31 offset:16384
    v_mfma_f32_16x16x32_bf16 v[76:79], a[4:7], a[132:135], v[76:79]
    ds_read_b64_tr_b16 a[94:95], v31 offset:20480
    ds_read_b64_tr_b16 a[96:97], v24 offset:24576
    v_mfma_f32_16x16x32_bf16 v[80:83], a[8:11], a[128:131], v[80:83]
    ds_read_b64_tr_b16 a[98:99], v24 offset:28672
    v_mfma_f32_16x16x32_bf16 v[84:87], a[8:11], a[132:135], v[84:87]
    ds_read_b64_tr_b16 a[100:101], v25 offset:24576
    v_mfma_f32_16x16x32_bf16 v[88:91], a[12:15], a[128:131], v[88:91]
    buffer_load_dwordx4 a[176:179], v12, s[8:11], s62 offen offset:0
    ds_read_b64_tr_b16 a[102:103], v25 offset:28672
    v_mfma_f32_16x16x32_bf16 v[92:95], a[12:15], a[132:135], v[92:95]
    s_add_u32 s61, s61, 0x20000
    ds_read_b64_tr_b16 a[104:105], v26 offset:24576
    ds_read_b64_tr_b16 a[106:107], v26 offset:28672
    v_mfma_f32_16x16x32_bf16 v[96:99], a[48:51], a[136:139], v[96:99]
    ds_read_b64_tr_b16 a[108:109], v27 offset:24576
    v_mfma_f32_16x16x32_bf16 v[100:103], a[48:51], a[140:143], v[100:103]
    buffer_load_dwordx4 a[180:183], v12, s[8:11], s62 offen offset:1024
    ds_read_b64_tr_b16 a[110:111], v27 offset:28672
    v_mfma_f32_16x16x32_bf16 v[104:107], a[52:55], a[136:139], v[104:107]
    ds_read_b64_tr_b16 a[112:113], v28 offset:24576
    v_mfma_f32_16x16x32_bf16 v[108:111], a[52:55], a[140:143], v[108:111]
    ds_read_b64_tr_b16 a[114:115], v28 offset:28672
    ds_read_b64_tr_b16 a[116:117], v29 offset:24576
    v_mfma_f32_16x16x32_bf16 v[112:115], a[56:59], a[136:139], v[112:115]
    ds_read_b64_tr_b16 a[118:119], v29 offset:28672
    v_mfma_f32_16x16x32_bf16 v[116:119], a[56:59], a[140:143], v[116:119]
    buffer_load_dwordx4 a[184:187], v13, s[8:11], s62 offen offset:0
    ds_read_b64_tr_b16 a[120:121], v30 offset:24576
    v_mfma_f32_16x16x32_bf16 v[120:123], a[60:63], a[136:139], v[120:123]
    ds_read_b64_tr_b16 a[122:123], v30 offset:28672
    ds_read_b64_tr_b16 a[124:125], v31 offset:24576
    v_mfma_f32_16x16x32_bf16 v[124:127], a[60:63], a[140:143], v[124:127]
    ds_read_b64_tr_b16 a[126:127], v31 offset:28672
    v_mfma_f32_16x16x32_bf16 v[64:67], a[32:35], a[136:139], v[64:67]
    buffer_load_dwordx4 a[188:191], v13, s[8:11], s62 offen offset:1024
    v_mfma_f32_16x16x32_bf16 v[68:71], a[32:35], a[140:143], v[68:71]
    v_mfma_f32_16x16x32_bf16 v[72:75], a[36:39], a[136:139], v[72:75]
    v_mfma_f32_16x16x32_bf16 v[76:79], a[36:39], a[140:143], v[76:79]
    v_mfma_f32_16x16x32_bf16 v[80:83], a[40:43], a[136:139], v[80:83]
    s_cmp_eq_u32 s63, 7
    s_cbranch_scc1 k3_ool_115
k3_oolret_116:
    v_mfma_f32_16x16x32_bf16 v[84:87], a[40:43], a[140:143], v[84:87]
    s_add_u32 s62, s62, 0x40000
    v_mfma_f32_16x16x32_bf16 v[88:91], a[44:47], a[136:139], v[88:91]
    v_mfma_f32_16x16x32_bf16 v[92:95], a[44:47], a[140:143], v[92:95]
    s_waitcnt vmcnt(12) lgkmcnt(0)
    s_barrier
    v_mfma_f32_16x16x32_bf16 v[96:99], a[80:83], a[144:147], v[96:99]
    s_add_u32 m0, s60, 0
    ds_read_b64_tr_b16 a[0:1], v24 offset:32768
    ds_read_b64_tr_b16 a[2:3], v24 offset:36864
    v_mfma_f32_16x16x32_bf16 v[100:103], a[80:83], a[148:151], v[100:103]
    buffer_load_dwordx4 v16, s[12:15], s61 offen offset:0 lds
    ds_read_b64_tr_b16 a[4:5], v25 offset:32768
    v_mfma_f32_16x16x32_bf16 v[104:107], a[84:87], a[144:147], v[104:107]
    ds_read_b64_tr_b16 a[6:7], v25 offset:36864
    ds_read_b64_tr_b16 a[8:9], v26 offset:32768
    v_mfma_f32_16x16x32_bf16 v[108:111], a[84:87], a[148:151], v[108:111]
    buffer_load_dwordx4 v17, s[12:15], s61 offen offset:1024 lds
    ds_read_b64_tr_b16 a[10:11], v26 offset:36864
    v_mfma_f32_16x16x32_bf16 v[112:115], a[88:91], a[144:147], v[112:115]
    ds_read_b64_tr_b16 a[12:13], v27 offset:32768
    ds_read_b64_tr_b16 a[14:15], v27 offset:36864
    v_mfma_f32_16x16x32_bf16 v[116:119], a[88:91], a[148:151], v[116:119]
    ds_read_b64_tr_b16 a[16:17], v28 offset:32768
    v_mfma_f32_16x16x32_bf16 v[120:123], a[92:95], a[144:147], v[120:123]
    ds_read_b64_tr_b16 a[18:19], v28 offset:36864
    v_mfma_f32_16x16x32_bf16 v[124:127], a[92:95], a[148:151], v[124:127]
    buffer_load_dwordx4 v18, s[12:15], s61 offen offset:2048 lds
    ds_read_b64_tr_b16 a[20:21], v29 offset:32768
    v_mfma_f32_16x16x32_bf16 v[64:67], a[64:67], a[144:147], v[64:67]
    ds_read_b64_tr_b16 a[22:23], v29 offset:36864
    ds_read_b64_tr_b16 a[24:25], v30 offset:32768
    v_mfma_f32_16x16x32_bf16 v[68:71], a[64:67], a[148:151], v[68:71]
    ds_read_b64_tr_b16 a[26:27], v30 offset:36864
    v_mfma_f32_16x16x32_bf16 v[72:75], a[68:71], a[144:147], v[72:75]
    buffer_load_dwordx4 v19, s[12:15], s61 offen offset:3072 lds
    ds_read_b64_tr_b16 a[28:29], v31 offset:32768
    v_mfma_f32_16x16x32_bf16 v[76:79], a[68:71], a[148:151], v[76:79]
    ds_read_b64_tr_b16 a[30:31], v31 offset:36864
    ds_read_b64_tr_b16 a[32:33], v24 offset:40960
    v_mfma_f32_16x16x32_bf16 v[80:83], a[72:75], a[144:147], v[80:83]
    ds_read_b64_tr_b16 a[34:35], v24 offset:45056
    v_mfma_f32_16x16x32_bf16 v[84:87], a[72:75], a[148:151], v[84:87]
    ds_read_b64_tr_b16 a[36:37], v25 offset:40960
    v_mfma_f32_16x16x32_bf16 v[88:91], a[76:79], a[144:147], v[88:91]
    buffer_load_dwordx4 a[128:131], v12, s[8:11], s62 offen offset:0
    ds_read_b64_tr_b16 a[38:39], v25 offset:45056
    v_mfma_f32_16x16x32_bf16 v[92:95], a[76:79], a[148:151], v[92:95]
    s_add_u32 s61, s61, 0x20000
    ds_read_b64_tr_b16 a[40:41], v26 offset:40960
    ds_read_b64_tr_b16 a[42:43], v26 offset:45056
    v_mfma_f32_16x16x32_bf16 v[96:99], a[112:115], a[152:155], v[96:99]
    ds_read_b64_tr_b16 a[44:45], v27 offset:40960
    v_mfma_f32_16x16x32_bf16 v[100:103], a[112:115], a[156:159], v[100:103]
    buffer_load_dwordx4 a[132:135], v12, s[8:11], s62 offen offset:1024
    ds_read_b64_tr_b16 a[46:47], v27 offset:45056
    v_mfma_f32_16x16x32_bf16 v[104:107], a[116:119], a[152:155], v[104:107]
    ds_read_b64_tr_b16 a[48:49], v28 offset:40960
    v_mfma_f32_16x16x32_bf16 v[108:111], a[116:119], a[156:159], v[108:111]
    ds_read_b64_tr_b16 a[50:51], v28 offset:45056
    ds_read_b64_tr_b16 a[52:53], v29 offset:40960
    v_mfma_f32_16x16x32_bf16 v[112:115], a[120:123], a[152:155], v[112:115]
    ds_read_b64_tr_b16 a[54:55], v29 offset:45056
    v_mfma_f32_16x16x32_bf16 v[116:119], a[120:123], a[156:159], v[116:119]
    buffer_load_dwordx4 a[136:139], v13, s[8:11], s62 offen offset:0
    ds_read_b64_tr_b16 a[56:57], v30 offset:40960
    v_mfma_f32_16x16x32_bf16 v[120:123], a[124:127], a[152:155], v[120:123]
    ds_read_b64_tr_b16 a[58:59], v30 offset:45056
    ds_read_b64_tr_b16 a[60:61], v31 offset:40960
    v_mfma_f32_16x16x32_bf16 v[124:127], a[124:127], a[156:159], v[124:127]
    ds_read_b64_tr_b16 a[62:63], v31 offset:45056
    v_mfma_f32_16x16x32_bf16 v[64:67], a[96:99], a[152:155], v[64:67]
    buffer_load_dwordx4 a[140:143], v13, s[8:11], s62 offen offset:1024
    v_mfma_f32_16x16x32_bf16 v[68:71], a[96:99], a[156:159], v[68:71]
    v_mfma_f32_16x16x32_bf16 v[72:75], a[100:103], a[152:155], v[72:75]
    v_mfma_f32_16x16x32_bf16 v[76:79], a[100:103], a[156:159], v[76:79]
    v_mfma_f32_16x16x32_bf16 v[80:83], a[104:107], a[152:155], v[80:83]
    v_mfma_f32_16x16x32_bf16 v[84:87], a[104:107], a[156:159], v[84:87]
    s_add_u32 s62, s62, 0x40000
    v_mfma_f32_16x16x32_bf16 v[88:91], a[108:111], a[152:155], v[88:91]
    v_mfma_f32_16x16x32_bf16 v[92:95], a[108:111], a[156:159], v[92:95]
    s_waitcnt vmcnt(12) lgkmcnt(0)
    s_barrier
    v_mfma_f32_16x16x32_bf16 v[96:99], a[16:19], a[160:163], v[96:99]
    s_add_u32 m0, s60, 16384
    ds_read_b64_tr_b16 a[64:65], v24 offset:49152
    ds_read_b64_tr_b16 a[66:67], v24 offset:53248
    v_mfma_f32_16x16x32_bf16 v[100:103], a[16:19], a[164:167], v[100:103]
    buffer_load_dwordx4 v16, s[12:15], s61 offen offset:0 lds
    ds_read_b64_tr_b16 a[68:69], v25 offset:49152
    v_mfma_f32_16x16x32_bf16 v[104:107], a[20:23], a[160:163], v[104:107]
    ds_read_b64_tr_b16 a[70:71], v25 offset:53248
    ds_read_b64_tr_b16 a[72:73], v26 offset:49152
    v_mfma_f32_16x16x32_bf16 v[108:111], a[20:23], a[164:167], v[108:111]
    buffer_load_dwordx4 v17, s[12:15], s61 offen offset:1024 lds
    ds_read_b64_tr_b16 a[74:75], v26 offset:53248
    v_mfma_f32_16x16x32_bf16 v[112:115], a[24:27], a[160:163], v[112:115]
    ds_read_b64_tr_b16 a[76:77], v27 offset:49152
    ds_read_b64_tr_b16 a[78:79], v27 offset:53248
    v_mfma_f32_16x16x32_bf16 v[116:119], a[24:27], a[164:167], v[116:119]
    ds_read_b64_tr_b16 a[80:81], v28 offset:49152
    v_mfma_f32_16x16x32_bf16 v[120:123], a[28:31], a[160:163], v[120:123]
    ds_read_b64_tr_b16 a[82:83], v28 offset:53248
    v_mfma_f32_16x16x32_bf16 v[124:127], a[28:31], a[164:167], v[124:127]
    buffer_load_dwordx4 v18, s[12:15], s61 offen offset:2048 lds
    ds_read_b64_tr_b16 a[84:85], v29 offset:49152
    v_mfma_f32_16x16x32_bf16 v[64:67], a[0:3], a[160:163], v[64:67]
    ds_read_b64_tr_b16 a[86:87], v29 offset:53248
    ds_read_b64_tr_b16 a[88:89], v30 offset:49152
    v_mfma_f32_16x16x32_bf16 v[68:71], a[0:3], a[164:167], v[68:71]
    ds_read_b64_tr_b16 a[90:91], v30 offset:53248
    v_mfma_f32_16x16x32_bf16 v[72:75], a[4:7], a[160:163], v[72:75]
    buffer_load_dwordx4 v19, s[12:15], s61 offen offset:3072 lds
    ds_read_b64_tr_b16 a[92:93], v31 offset:49152
    v_mfma_f32_16x16x32_bf16 v[76:79], a[4:7], a[164:167], v[76:79]
    ds_read_b64_tr_b16 a[94:95], v31 offset:53248
    ds_read_b64_tr_b16 a[96:97], v24 offset:57344
    v_mfma_f32_16x16x32_bf16 v[80:83], a[8:11], a[160:163], v[80:83]
    ds_read_b64_tr_b16 a[98:99], v24 offset:61440
    v_mfma_f32_16x16x32_bf16 v[84:87], a[8:11], a[164:167], v[84:87]
    ds_read_b64_tr_b16 a[100:101], v25 offset:57344
    v_mfma_f32_16x16x32_bf16 v[88:91], a[12:15], a[160:163], v[88:91]
    buffer_load_dwordx4 a[144:147], v12, s[8:11], s62 offen offset:0
    ds_read_b64_tr_b16 a[102:103], v25 offset:61440
    v_mfma_f32_16x16x32_bf16 v[92:95], a[12:15], a[164:167], v[92:95]
    s_add_u32 s61, s61, 0x20000
    ds_read_b64_tr_b16 a[104:105], v26 offset:57344
    ds_read_b64_tr_b16 a[106:107], v26 offset:61440
    v_mfma_f32_16x16x32_bf16 v[96:99], a[48:51], a[168:171], v[96:99]
    ds_read_b64_tr_b16 a[108:109], v27 offset:57344
    v_mfma_f32_16x16x32_bf16 v[100:103], a[48:51], a[172:175], v[100:103]
    buffer_load_dwordx4 a[148:151], v12, s[8:11], s62 offen offset:1024
    ds_read_b64_tr_b16 a[110:111], v27 offset:61440
    v_mfma_f32_16x16x32_bf16 v[104:107], a[52:55], a[168:171], v[104:107]
    ds_read_b64_tr_b16 a[112:113], v28 offset:57344
    v_mfma_f32_16x16x32_bf16 v[108:111], a[52:55], a[172:175], v[108:111]
    ds_read_b64_tr_b16 a[114:115], v28 offset:61440
    ds_read_b64_tr_b16 a[116:117], v29 offset:57344
    v_mfma_f32_16x16x32_bf16 v[112:115], a[56:59], a[168:171], v[112:115]
    ds_read_b64_tr_b16 a[118:119], v29 offset:61440
    v_mfma_f32_16x16x32_bf16 v[116:119], a[56:59], a[172:175], v[116:119]
    buffer_load_dwordx4 a[152:155], v13, s[8:11], s62 offen offset:0
    ds_read_b64_tr_b16 a[120:121], v30 offset:57344
    v_mfma_f32_16x16x32_bf16 v[120:123], a[60:63], a[168:171], v[120:123]
    ds_read_b64_tr_b16 a[122:123], v30 offset:61440
    ds_read_b64_tr_b16 a[124:125], v31 offset:57344
    v_mfma_f32_16x16x32_bf16 v[124:127], a[60:63], a[172:175], v[124:127]
    ds_read_b64_tr_b16 a[126:127], v31 offset:61440
    v_mfma_f32_16x16x32_bf16 v[64:67], a[32:35], a[168:171], v[64:67]
    buffer_load_dwordx4 a[156:159], v13, s[8:11], s62 offen offset:1024
    v_mfma_f32_16x16x32_bf16 v[68:71], a[32:35], a[172:175], v[68:71]
    v_mfma_f32_16x16x32_bf16 v[72:75], a[36:39], a[168:171], v[72:75]
    v_mfma_f32_16x16x32_bf16 v[76:79], a[36:39], a[172:175], v[76:79]
    v_mfma_f32_16x16x32_bf16 v[80:83], a[40:43], a[168:171], v[80:83]
    v_mfma_f32_16x16x32_bf16 v[84:87], a[40:43], a[172:175], v[84:87]
    s_add_u32 s62, s62, 0x40000
    v_mfma_f32_16x16x32_bf16 v[88:91], a[44:47], a[168:171], v[88:91]
    v_mfma_f32_16x16x32_bf16 v[92:95], a[44:47], a[172:175], v[92:95]
    s_waitcnt vmcnt(12) lgkmcnt(0)
    s_barrier
    v_mfma_f32_16x16x32_bf16 v[96:99], a[80:83], a[176:179], v[96:99]
    s_add_u32 m0, s60, 32768
    ds_read_b64_tr_b16 a[0:1], v24 offset:0
    ds_read_b64_tr_b16 a[2:3], v24 offset:4096
    v_mfma_f32_16x16x32_bf16 v[100:103], a[80:83], a[180:183], v[100:103]
    buffer_load_dwordx4 v16, s[12:15], s61 offen offset:0 lds
    ds_read_b64_tr_b16 a[4:5], v25 offset:0
    v_mfma_f32_16x16x32_bf16 v[104:107], a[84:87], a[176:179], v[104:107]
    ds_read_b64_tr_b16 a[6:7], v25 offset:4096
    ds_read_b64_tr_b16 a[8:9], v26 offset:0
    v_mfma_f32_16x16x32_bf16 v[108:111], a[84:87], a[180:183], v[108:111]
    buffer_load_dwordx4 v17, s[12:15], s61 offen offset:1024 lds
    ds_read_b64_tr_b16 a[10:11], v26 offset:4096
    v_mfma_f32_16x16x32_bf16 v[112:115], a[88:91], a[176:179], v[112:115]
    ds_read_b64_tr_b16 a[12:13], v27 offset:0
    ds_read_b64_tr_b16 a[14:15], v27 offset:4096
    v_mfma_f32_16x16x32_bf16 v[116:119], a[88:91], a[180:183], v[116:119]
    ds_read_b64_tr_b16 a[16:17], v28 offset:0
    v_mfma_f32_16x16x32_bf16 v[120:123], a[92:95], a[176:179], v[120:123]
    ds_read_b64_tr_b16 a[18:19], v28 offset:4096
    v_mfma_f32_16x16x32_bf16 v[124:127], a[92:95], a[180:183], v[124:127]
    buffer_load_dwordx4 v18, s[12:15], s61 offen offset:2048 lds
    ds_read_b64_tr_b16 a[20:21], v29 offset:0
    v_mfma_f32_16x16x32_bf16 v[64:67], a[64:67], a[176:179], v[64:67]
    ds_read_b64_tr_b16 a[22:23], v29 offset:4096
    ds_read_b64_tr_b16 a[24:25], v30 offset:0
    v_mfma_f32_16x16x32_bf16 v[68:71], a[64:67], a[180:183], v[68:71]
    ds_read_b64_tr_b16 a[26:27], v30 offset:4096
    v_mfma_f32_16x16x32_bf16 v[72:75], a[68:71], a[176:179], v[72:75]
    buffer_load_dwordx4 v19, s[12:15], s61 offen offset:3072 lds
    ds_read_b64_tr_b16 a[28:29], v31 offset:0
    v_mfma_f32_16x16x32_bf16 v[76:79], a[68:71], a[180:183], v[76:79]
    ds_read_b64_tr_b16 a[30:31], v31 offset:4096
    ds_read_b64_tr_b16 a[32:33], v24 offset:8192
    v_mfma_f32_16x16x32_bf16 v[80:83], a[72:75], a[176:179], v[80:83]
    ds_read_b64_tr_b16 a[34:35], v24 offset:12288
    v_mfma_f32_16x16x32_bf16 v[84:87], a[72:75], a[180:183], v[84:87]
    ds_read_b64_tr_b16 a[36:37], v25 offset:8192
    v_mfma_f32_16x16x32_bf16 v[88:91], a[76:79], a[176:179], v[88:91]
    buffer_load_dwordx4 a[160:163], v12, s[8:11], s62 offen offset:0
    ds_read_b64_tr_b16 a[38:39], v25 offset:12288
    v_mfma_f32_16x16x32_bf16 v[92:95], a[76:79], a[180:183], v[92:95]
    s_add_u32 s61, s61, 0x20000
    ds_read_b64_tr_b16 a[40:41], v26 offset:8192
    ds_read_b64_tr_b16 a[42:43], v26 offset:12288
    v_mfma_f32_16x16x32_bf16 v[96:99], a[112:115], a[184:187], v[96:99]
    ds_read_b64_tr_b16 a[44:45], v27 offset:8192
    v_mfma_f32_16x16x32_bf16 v[100:103], a[112:115], a[188:191], v[100:103]
    buffer_load_dwordx4 a[164:167], v12, s[8:11], s62 offen offset:1024
    ds_read_b64_tr_b16 a[46:47], v27 offset:12288
    v_mfma_f32_16x16x32_bf16 v[104:107], a[116:119], a[184:187], v[104:107]
    ds_read_b64_tr_b16 a[48:49], v28 offset:8192
    v_mfma_f32_16x16x32_bf16 v[108:111], a[116:119], a[188:191], v[108:111]
    ds_read_b64_tr_b16 a[50:51], v28 offset:12288
    ds_read_b64_tr_b16 a[52:53], v29 offset:8192
    v_mfma_f32_16x16x32_bf16 v[112:115], a[120:123], a[184:187], v[112:115]
    ds_read_b64_tr_b16 a[54:55], v29 offset:12288
    v_mfma_f32_16x16x32_bf16 v[116:119], a[120:123], a[188:191], v[116:119]
    buffer_load_dwordx4 a[168:171], v13, s[8:11], s62 offen offset:0
    ds_read_b64_tr_b16 a[56:57], v30 offset:8192
    v_mfma_f32_16x16x32_bf16 v[120:123], a[124:127], a[184:187], v[120:123]
    ds_read_b64_tr_b16 a[58:59], v30 offset:12288
    ds_read_b64_tr_b16 a[60:61], v31 offset:8192
    v_mfma_f32_16x16x32_bf16 v[124:127], a[124:127], a[188:191], v[124:127]
    ds_read_b64_tr_b16 a[62:63], v31 offset:12288
    v_mfma_f32_16x16x32_bf16 v[64:67], a[96:99], a[184:187], v[64:67]
    buffer_load_dwordx4 a[172:175], v13, s[8:11], s62 offen offset:1024
    v_mfma_f32_16x16x32_bf16 v[68:71], a[96:99], a[188:191], v[68:71]
    v_mfma_f32_16x16x32_bf16 v[72:75], a[100:103], a[184:187], v[72:75]
    v_mfma_f32_16x16x32_bf16 v[76:79], a[100:103], a[188:191], v[76:79]
    v_mfma_f32_16x16x32_bf16 v[80:83], a[104:107], a[184:187], v[80:83]
    v_mfma_f32_16x16x32_bf16 v[84:87], a[104:107], a[188:191], v[84:87]
    s_add_u32 s62, s62, 0x40000
    v_mfma_f32_16x16x32_bf16 v[88:91], a[108:111], a[184:187], v[88:91]
    s_add_u32 s63, s63, 1
    v_mfma_f32_16x16x32_bf16 v[92:95], a[108:111], a[188:191], v[92:95]
    s_waitcnt vmcnt(12) lgkmcnt(0)
    s_barrier
    s_cmp_lt_u32 s63, 8
    s_cbranch_scc1 k3_loop_114
k3_tail:
    s_nop 1
    v_cvt_pk_bf16_f32 v96, v96, v97
    v_cvt_pk_bf16_f32 v97, v98, v99
    v_cvt_pk_bf16_f32 v98, v100, v101
    v_cvt_pk_bf16_f32 v99, v102, v103
    buffer_store_dwordx4 v[96:99], v1, s[36:39], s52 offen offset:0 sc1
    v_cvt_pk_bf16_f32 v104, v104, v105
    v_cvt_pk_bf16_f32 v105, v106, v107
    v_cvt_pk_bf16_f32 v106, v108, v109
    v_cvt_pk_bf16_f32 v107, v110, v111
    buffer_store_dwordx4 v[104:107], v1, s[36:39], s52 offen offset:1024 sc1
    v_cvt_pk_bf16_f32 v112, v112, v113
    v_cvt_pk_bf16_f32 v113, v114, v115
    v_cvt_pk_bf16_f32 v114, v116, v117
    v_cvt_pk_bf16_f32 v115, v118, v119
    buffer_store_dwordx4 v[112:115], v1, s[36:39], s52 offen offset:2048 sc1
    v_cvt_pk_bf16_f32 v120, v120, v121
    v_cvt_pk_bf16_f32 v121, v122, v123
    v_cvt_pk_bf16_f32 v122, v124, v125
    v_cvt_pk_bf16_f32 v123, v126, v127
    buffer_store_dwordx4 v[120:123], v1, s[36:39], s52 offen offset:3072 sc1
    s_waitcnt vmcnt(4)
    v_lshlrev_b32 v58, 16, v128
    v_and_b32 v59, 0xffff0000, v128
    v_pk_add_f32 v[64:65], v[64:65], v[58:59]
    v_lshlrev_b32 v58, 16, v129
    v_and_b32 v59, 0xffff0000, v129
    v_pk_add_f32 v[66:67], v[66:67], v[58:59]
    v_lshlrev_b32 v58, 16, v136
    v_and_b32 v59, 0xffff0000, v136
    v_pk_add_f32 v[68:69], v[68:69], v[58:59]
    v_lshlrev_b32 v58, 16, v137
    v_and_b32 v59, 0xffff0000, v137
    v_pk_add_f32 v[70:71], v[70:71], v[58:59]
    v_lshlrev_b32 v58, 16, v130
    v_and_b32 v59, 0xffff0000, v130
    v_pk_add_f32 v[72:73], v[72:73], v[58:59]
    v_lshlrev_b32 v58, 16, v131
    v_and_b32 v59, 0xffff0000, v131
    v_pk_add_f32 v[74:75], v[74:75], v[58:59]
    v_lshlrev_b32 v58, 16, v138
    v_and_b32 v59, 0xffff0000, v138
    v_pk_add_f32 v[76:77], v[76:77], v[58:59]
    v_lshlrev_b32 v58, 16, v139
    v_and_b32 v59, 0xffff0000, v139
    v_pk_add_f32 v[78:79], v[78:79], v[58:59]
    v_lshlrev_b32 v58, 16, v132
    v_and_b32 v59, 0xffff0000, v132
    v_pk_add_f32 v[80:81], v[80:81], v[58:59]
    v_lshlrev_b32 v58, 16, v133
    v_and_b32 v59, 0xffff0000, v133
    v_pk_add_f32 v[82:83], v[82:83], v[58:59]
    v_lshlrev_b32 v58, 16, v140
    v_and_b32 v59, 0xffff0000, v140
    v_pk_add_f32 v[84:85], v[84:85], v[58:59]
    v_lshlrev_b32 v58, 16, v141
    v_and_b32 v59, 0xffff0000, v141
    v_pk_add_f32 v[86:87], v[86:87], v[58:59]
    v_lshlrev_b32 v58, 16, v134
    v_and_b32 v59, 0xffff0000, v134
    v_pk_add_f32 v[88:89], v[88:89], v[58:59]
    v_lshlrev_b32 v58, 16, v135
    v_and_b32 v59, 0xffff0000, v135
    v_pk_add_f32 v[90:91], v[90:91], v[58:59]
    v_lshlrev_b32 v58, 16, v142
    v_and_b32 v59, 0xffff0000, v142
    v_pk_add_f32 v[92:93], v[92:93], v[58:59]
    v_lshlrev_b32 v58, 16, v143
    v_and_b32 v59, 0xffff0000, v143
    v_pk_add_f32 v[94:95], v[94:95], v[58:59]
    v_and_b32 v58, 1, v20
    v_lshrrev_b32 v59, 1, v20
    v_lshlrev_b32 v58, 5, v58
    v_lshl_add_u32 v58, v59, 4, v58
    v_lshlrev_b32 v59, 3, v20
    v_sub_u32 v58, v58, v59
    v_add_u32 v3, v3, v58
    v_add_u32 v4, v4, v58
    v_lshlrev_b32 v32, 16, v144
    v_and_b32 v33, 0xffff0000, v144
    v_lshlrev_b32 v34, 16, v145
    v_and_b32 v35, 0xffff0000, v145
    v_lshlrev_b32 v36, 16, v146
    v_and_b32 v37, 0xffff0000, v146
    v_lshlrev_b32 v38, 16, v147
    v_and_b32 v39, 0xffff0000, v147
    v_lshlrev_b32 v40, 16, v148
    v_and_b32 v41, 0xffff0000, v148
    v_lshlrev_b32 v42, 16, v149
    v_and_b32 v43, 0xffff0000, v149
    v_lshlrev_b32 v44, 16, v150
    v_and_b32 v45, 0xffff0000, v150
    v_lshlrev_b32 v46, 16, v151
    v_and_b32 v47, 0xffff0000, v151
    s_or_b32 s57, s42, s45
    s_cbranch_scc1 k3_nowr_117
    v_pk_add_f32 v[56:57], v[32:33], v[34:35]
    v_pk_add_f32 v[56:57], v[56:57], v[36:37]
    v_pk_add_f32 v[56:57], v[56:57], v[38:39]
    v_pk_add_f32 v[56:57], v[56:57], v[40:41]
    v_pk_add_f32 v[56:57], v[56:57], v[42:43]
    v_pk_add_f32 v[56:57], v[56:57], v[44:45]
    v_pk_add_f32 v[56:57], v[56:57], v[46:47]
    v_add_f32 v56, v56, v57
    v_mov_b32 v57, v56
    s_nop 1
    v_permlane16_swap_b32 v56, v57
    s_nop 1
    v_add_f32 v56, v56, v57
    v_mov_b32 v57, v56
    s_nop 1
    v_permlane32_swap_b32 v56, v57
    s_nop 1
    v_add_f32 v56, v56, v57
    s_mov_b32 s57, 24704
    s_mov_b32 s34, 24708
    s_mov_b64 exec, 1
    buffer_atomic_add_f32 v56, v5, s[32:35], s57 offen
    s_mov_b64 exec, -1
    s_mov_b32 s34, 24576
k3_nowr_117:
    v_mov_b32 v144, 0
    v_mov_b32 v145, 0
    v_mov_b32 v146, 0
    v_mov_b32 v147, 0
    v_mov_b32 v148, 0
    v_mov_b32 v149, 0
    v_mov_b32 v150, 0
    v_mov_b32 v151, 0
    v_mov_b32 v152, 0
    v_mov_b32 v153, 0
    v_mov_b32 v154, 0
    v_mov_b32 v155, 0
    s_waitcnt vmcnt(0)
    s_barrier
    s_cmp_lg_u32 s45, 0
    s_cbranch_scc1 k3_nopoll_118
    s_mov_b64 exec, 1
    buffer_store_dword v6, v5, s[48:51], s54 offen sc1
    s_mov_b64 exec, -1
    s_mov_b32 s57, 1048576
k3_spin_119:
    buffer_load_dword v7, v5, s[48:51], s55 offen sc1
    s_waitcnt vmcnt(0)
    v_readfirstlane_b32 s58, v7
    s_sub_u32 s57, s57, 1
    s_cselect_b32 s58, 1, s58
    s_cmp_eq_u32 s58, 0
    s_cbranch_scc1 k3_spin_119
k3_nopoll_118:
    s_barrier
    buffer_load_dwordx4 v[96:99], v1, s[36:39], s53 offen offset:0 sc1
    buffer_load_dwordx4 v[100:103], v1, s[36:39], s53 offen offset:1024 sc1
    buffer_load_dwordx4 v[104:107], v1, s[36:39], s53 offen offset:2048 sc1
    buffer_load_dwordx4 v[108:111], v1, s[36:39], s53 offen offset:3072 sc1
    s_waitcnt vmcnt(3)
    v_lshlrev_b32 v56, 16, v96
    v_and_b32 v57, 0xffff0000, v96
    v_lshlrev_b32 v58, 16, v97
    v_and_b32 v59, 0xffff0000, v97
    v_pk_add_f32 v[64:65], v[64:65], v[56:57]
    v_pk_add_f32 v[66:67], v[66:67], v[58:59]
    v_cvt_pk_bf16_f32 v128, v64, v65
    v_cvt_pk_bf16_f32 v129, v66, v67
    v_lshlrev_b32 v64, 16, v128
    v_and_b32 v65, 0xffff0000, v128
    v_lshlrev_b32 v66, 16, v129
    v_and_b32 v67, 0xffff0000, v129
    v_pk_add_f32 v[144:145], v[144:145], v[64:65]
    v_pk_fma_f32 v[146:147], v[64:65], v[64:65], v[146:147]
    v_pk_fma_f32 v[148:149], v[64:65], v[32:33], v[148:149]
    v_pk_add_f32 v[144:145], v[144:145], v[66:67]
    v_pk_fma_f32 v[146:147], v[66:67], v[66:67], v[146:147]
    v_pk_fma_f32 v[148:149], v[66:67], v[34:35], v[148:149]
    v_lshlrev_b32 v56, 16, v98
    v_and_b32 v57, 0xffff0000, v98
    v_lshlrev_b32 v58, 16, v99
    v_and_b32 v59, 0xffff0000, v99
    v_pk_add_f32 v[68:69], v[68:69], v[56:57]
    v_pk_add_f32 v[70:71], v[70:71], v[58:59]
    v_cvt_pk_bf16_f32 v136, v68, v69
    v_cvt_pk_bf16_f32 v137, v70, v71
    v_lshlrev_b32 v68, 16, v136
    v_and_b32 v69, 0xffff0000, v136
    v_lshlrev_b32 v70, 16, v137
    v_and_b32 v71, 0xffff0000, v137
    v_pk_add_f32 v[150:151], v[150:151], v[68:69]
    v_pk_fma_f32 v[152:153], v[68:69], v[68:69], v[152:153]
    v_pk_fma_f32 v[154:155], v[68:69], v[32:33], v[154:155]
    v_pk_add_f32 v[150:151], v[150:151], v[70:71]
    v_pk_fma_f32 v[152:153], v[70:71], v[70:71], v[152:153]
    v_pk_fma_f32 v[154:155], v[70:71], v[34:35], v[154:155]
    s_waitcnt vmcnt(2)
    v_lshlrev_b32 v56, 16, v100
    v_and_b32 v57, 0xffff0000, v100
    v_lshlrev_b32 v58, 16, v101
    v_and_b32 v59, 0xffff0000, v101
    v_pk_add_f32 v[72:73], v[72:73], v[56:57]
    v_pk_add_f32 v[74:75], v[74:75], v[58:59]
    v_cvt_pk_bf16_f32 v130, v72, v73
    v_cvt_pk_bf16_f32 v131, v74, v75
    v_lshlrev_b32 v72, 16, v130
    v_and_b32 v73, 0xffff0000, v130
    v_lshlrev_b32 v74, 16, v131
    v_and_b32 v75, 0xffff0000, v131
    v_permlane16_swap_b32 v128, v130
    v_permlane16_swap_b32 v129, v131
    buffer_store_dwordx4 v[128:131], v3, s[24:27], 0 offen offset:0 sc1
    v_pk_add_f32 v[144:145], v[144:145], v[72:73]
    v_pk_fma_f32 v[146:147], v[72:73], v[72:73], v[146:147]
    v_pk_fma_f32 v[148:149], v[72:73], v[36:37], v[148:149]
    v_pk_add_f32 v[144:145], v[144:145], v[74:75]
    v_pk_fma_f32 v[146:147], v[74:75], v[74:75], v[146:147]
    v_pk_fma_f32 v[148:149], v[74:75], v[38:39], v[148:149]
    v_lshlrev_b32 v56, 16, v102
    v_and_b32 v57, 0xffff0000, v102
    v_lshlrev_b32 v58, 16, v103
    v_and_b32 v59, 0xffff0000, v103
    v_pk_add_f32 v[76:77], v[76:77], v[56:57]
    v_pk_add_f32 v[78:79], v[78:79], v[58:59]
    v_cvt_pk_bf16_f32 v138, v76, v77
    v_cvt_pk_bf16_f32 v139, v78, v79
    v_lshlrev_b32 v76, 16, v138
    v_and_b32 v77, 0xffff0000, v138
    v_lshlrev_b32 v78, 16, v139
    v_and_b32 v79, 0xffff0000, v139
    v_permlane16_swap_b32 v136, v138
    v_permlane16_swap_b32 v137, v139
    buffer_store_dwordx4 v[136:139], v4, s[24:27], 0 offen offset:0 sc1
    v_pk_add_f32 v[150:151], v[150:151], v[76:77]
    v_pk_fma_f32 v[152:153], v[76:77], v[76:77], v[152:153]
    v_pk_fma_f32 v[154:155], v[76:77], v[36:37], v[154:155]
    v_pk_add_f32 v[150:151], v[150:151], v[78:79]
    v_pk_fma_f32 v[152:153], v[78:79], v[78:79], v[152:153]
    v_pk_fma_f32 v[154:155], v[78:79], v[38:39], v[154:155]
    s_waitcnt vmcnt(3)
    v_lshlrev_b32 v56, 16, v104
    v_and_b32 v57, 0xffff0000, v104
    v_lshlrev_b32 v58, 16, v105
    v_and_b32 v59, 0xffff0000, v105
    v_pk_add_f32 v[80:81], v[80:81], v[56:57]
    v_pk_add_f32 v[82:83], v[82:83], v[58:59]
    v_cvt_pk_bf16_f32 v132, v80, v81
    v_cvt_pk_bf16_f32 v133, v82, v83
    v_lshlrev_b32 v80, 16, v132
    v_and_b32 v81, 0xffff0000, v132
    v_lshlrev_b32 v82, 16, v133
    v_and_b32 v83, 0xffff0000, v133
    v_pk_add_f32 v[144:145], v[144:145], v[80:81]
    v_pk_fma_f32 v[146:147], v[80:81], v[80:81], v[146:147]
    v_pk_fma_f32 v[148:149], v[80:81], v[40:41], v[148:149]
    v_pk_add_f32 v[144:145], v[144:145], v[82:83]
    v_pk_fma_f32 v[146:147], v[82:83], v[82:83], v[146:147]
    v_pk_fma_f32 v[148:149], v[82:83], v[42:43], v[148:149]
    v_lshlrev_b32 v56, 16, v106
    v_and_b32 v57, 0xffff0000, v106
    v_lshlrev_b32 v58, 16, v107
    v_and_b32 v59, 0xffff0000, v107
    v_pk_add_f32 v[84:85], v[84:85], v[56:57]
    v_pk_add_f32 v[86:87], v[86:87], v[58:59]
    v_cvt_pk_bf16_f32 v140, v84, v85
    v_cvt_pk_bf16_f32 v141, v86, v87
    v_lshlrev_b32 v84, 16, v140
    v_and_b32 v85, 0xffff0000, v140
    v_lshlrev_b32 v86, 16, v141
    v_and_b32 v87, 0xffff0000, v141
    v_pk_add_f32 v[150:151], v[150:151], v[84:85]
    v_pk_fma_f32 v[152:153], v[84:85], v[84:85], v[152:153]
    v_pk_fma_f32 v[154:155], v[84:85], v[40:41], v[154:155]
    v_pk_add_f32 v[150:151], v[150:151], v[86:87]
    v_pk_fma_f32 v[152:153], v[86:87], v[86:87], v[152:153]
    v_pk_fma_f32 v[154:155], v[86:87], v[42:43], v[154:155]
    s_waitcnt vmcnt(2)
    v_lshlrev_b32 v56, 16, v108
    v_and_b32 v57, 0xffff0000, v108
    v_lshlrev_b32 v58, 16, v109
    v_and_b32 v59, 0xffff0000, v109
    v_pk_add_f32 v[88:89], v[88:89], v[56:57]
    v_pk_add_f32 v[90:91], v[90:91], v[58:59]
    v_cvt_pk_bf16_f32 v134, v88, v89
    v_cvt_pk_bf16_f32 v135, v90, v91
    v_lshlrev_b32 v88, 16, v134
    v_and_b32 v89, 0xffff0000, v134
    v_lshlrev_b32 v90, 16, v135
    v_and_b32 v91, 0xffff0000, v135
    v_permlane16_swap_b32 v132, v134
    v_permlane16_swap_b32 v133, v135
    buffer_store_dwordx4 v[132:135], v3, s[24:27], 0 offen offset:64 sc1
    v_pk_add_f32 v[144:145], v[144:145], v[88:89]
    v_pk_fma_f32 v[146:147], v[88:89], v[88:89], v[146:147]
    v_pk_fma_f32 v[148:149], v[88:89], v[44:45], v[148:149]
    v_pk_add_f32 v[144:145], v[144:145], v[90:91]
    v_pk_fma_f32 v[146:147], v[90:91], v[90:91], v[146:147]
    v_pk_fma_f32 v[148:149], v[90:91], v[46:47], v[148:149]
    v_lshlrev_b32 v56, 16, v110
    v_and_b32 v57, 0xffff0000, v110
    v_lshlrev_b32 v58, 16, v111
    v_and_b32 v59, 0xffff0000, v111
    v_pk_add_f32 v[92:93], v[92:93], v[56:57]
    v_pk_add_f32 v[94:95], v[94:95], v[58:59]
    v_cvt_pk_bf16_f32 v142, v92, v93
    v_cvt_pk_bf16_f32 v143, v94, v95
    v_lshlrev_b32 v92, 16, v142
    v_and_b32 v93, 0xffff0000, v142
    v_lshlrev_b32 v94, 16, v143
    v_and_b32 v95, 0xffff0000, v143
    v_permlane16_swap_b32 v140, v142
    v_permlane16_swap_b32 v141, v143
    buffer_store_dwordx4 v[140:143], v4, s[24:27], 0 offen offset:64 sc1
    v_pk_add_f32 v[150:151], v[150:151], v[92:93]
    v_pk_fma_f32 v[152:153], v[92:93], v[92:93], v[152:153]
    v_pk_fma_f32 v[154:155], v[92:93], v[44:45], v[154:155]
    v_pk_add_f32 v[150:151], v[150:151], v[94:95]
    v_pk_fma_f32 v[152:153], v[94:95], v[94:95], v[152:153]
    v_pk_fma_f32 v[154:155], v[94:95], v[46:47], v[154:155]
    v_add_f32 v48, v144, v145
    v_add_f32 v49, v146, v147
    v_add_f32 v50, v148, v149
    v_add_f32 v52, v150, v151
    v_add_f32 v53, v152, v153
    v_add_f32 v54, v154, v155
    v_mov_b32 v56, v48
    v_mov_b32 v57, v49
    v_mov_b32 v58, v50
    v_mov_b32 v59, v52
    v_mov_b32 v60, v53
    v_mov_b32 v61, v54
    s_nop 1
    v_permlane16_swap_b32 v48, v56
    v_permlane16_swap_b32 v49, v57
    v_permlane16_swap_b32 v50, v58
    v_permlane16_swap_b32 v52, v59
    v_permlane16_swap_b32 v53, v60
    v_permlane16_swap_b32 v54, v61
    s_nop 1
    v_add_f32 v48, v48, v56
    v_add_f32 v49, v49, v57
    v_add_f32 v50, v50, v58
    v_add_f32 v52, v52, v59
    v_add_f32 v53, v53, v60
    v_add_f32 v54, v54, v61
    v_mov_b32 v56, v48
    v_mov_b32 v57, v49
    v_mov_b32 v58, v50
    v_mov_b32 v59, v52
    v_mov_b32 v60, v53
    v_mov_b32 v61, v54
    s_nop 1
    v_permlane32_swap_b32 v48, v56
    v_permlane32_swap_b32 v49, v57
    v_permlane32_swap_b32 v50, v58
    v_permlane32_swap_b32 v52, v59
    v_permlane32_swap_b32 v53, v60
    v_permlane32_swap_b32 v54, v61
    s_nop 1
    v_add_f32 v48, v48, v56
    v_add_f32 v49, v49, v57
    v_add_f32 v50, v50, v58
    v_add_f32 v52, v52, v59
    v_add_f32 v53, v53, v60
    v_add_f32 v54, v54, v61
    v_cmp_eq_u32 s[56:57], 1, v20
    v_cmp_eq_u32 s[58:59], 2, v20
    s_nop 1
    v_cndmask_b32 v48, v48, v49, s[56:57]
    v_cndmask_b32 v48, v48, v50, s[58:59]
    buffer_atomic_add_f32 v48, v2, s[32:35], 0 offen offset:0
    v_cndmask_b32 v52, v52, v53, s[56:57]
    v_cndmask_b32 v52, v52, v54, s[58:59]
    buffer_atomic_add_f32 v52, v2, s[32:35], 0 offen offset:64
    s_and_b32 s56, s2, 7
    s_mul_i32 s56, s56, 28
    s_add_u32 s56, s56, s41
    s_lshl_b32 s56, s56, 15
    s_lshl_b32 s57, s45, 13
    s_add_u32 s56, s56, s57
    s_add_u32 s8, s6, 0x6000000
    s_addc_u32 s9, s7, 0
    s_and_b32 s9, s9, 0xffff
    s_mov_b32 s10, 0x1000000
    s_mov_b32 s11, 0x00020000
    s_cmp_ge_u32 s2, 224
    s_cselect_b32 s10, 0, s10
    v_lshlrev_b32 v8, 3, v1
    buffer_load_dword v9, v8, s[8:11], s56 offen
    s_add_u32 s56, s56, 0x800000
    buffer_load_dword v9, v8, s[8:11], s56 offen
    s_add_u32 s56, s56, 0x800000
k3_end_112:
    s_endpgm
k3_ool_115:
    buffer_load_dwordx2 v[128:129], v3, s[16:19], 0 offen offset:0
    buffer_load_dwordx2 v[130:131], v3, s[16:19], 0 offen offset:32
    buffer_load_dwordx2 v[132:133], v3, s[16:19], 0 offen offset:64
    buffer_load_dwordx2 v[134:135], v3, s[16:19], 0 offen offset:96
    buffer_load_dwordx2 v[136:137], v4, s[16:19], 0 offen offset:0
    buffer_load_dwordx2 v[138:139], v4, s[16:19], 0 offen offset:32
    buffer_load_dwordx2 v[140:141], v4, s[16:19], 0 offen offset:64
    buffer_load_dwordx2 v[142:143], v4, s[16:19], 0 offen offset:96
    buffer_load_dwordx2 v[144:145], v14, s[20:23], 0 offen offset:0
    buffer_load_dwordx2 v[146:147], v14, s[20:23], 0 offen offset:32
    buffer_load_dwordx2 v[148:149], v14, s[20:23], 0 offen offset:64
    buffer_load_dwordx2 v[150:151], v14, s[20:23], 0 offen offset:96
    global_load_dword v7, v[8:9], off
    s_branch k3_oolret_116
.globl k4_kernel
.p2align 8
.type k4_kernel,@function
k4_kernel:
    s_cmp_ge_u32 s2, 256
    s_cbranch_scc1 k4_end_120
    s_load_dwordx8 s[4:11], s[0:1], 56
    s_load_dwordx2 s[12:13], s[0:1], 88
    s_load_dwordx2 s[14:15], s[0:1], 104
    v_lshrrev_b32 v1, 6, v0
    v_and_b32 v2, 63, v0
    v_readfirstlane_b32 s44, v1
    s_and_b32 s45, s2, 7
    s_lshr_b32 s46, s2, 3
    s_mul_i32 s45, s45, 28
    s_add_u32 s45, s45, s46
    v_and_b32 v4, 31, v2
    v_lshrrev_b32 v5, 5, v2
    v_lshlrev_b32 v7, 4, v4
    v_mov_b32 v11, 69632
    v_lshl_add_u32 v12, v2, 2, v11
    v_mov_b32 v13, 0
    ds_write_b32 v12, v13
    s_waitcnt lgkmcnt(0)
    s_barrier
    s_add_u32 s20, s14, 0x4000000
    s_addc_u32 s21, s15, 0
    s_and_b32 s21, s21, 0xffff
    s_mov_b32 s22, 0x400000
    s_mov_b32 s23, 0x00020000
    s_cmp_ge_u32 s44, 4
    s_cbranch_scc1 k4_b_121
    s_setprio 3
    s_add_u32 s16, s14, 0x4800000
    s_addc_u32 s17, s15, 0
    s_and_b32 s17, s17, 0xffff
    s_mov_b32 s18, 0x6084
    s_mov_b32 s19, 0x00020000
    v_lshlrev_b32 v3, 5, v0
    s_mov_b32 s48, 0
    buffer_load_dwordx4 v[16:19], v3, s[16:19], s48 offen
    buffer_load_dwordx4 v[20:23], v3, s[16:19], s48 offen offset:16
    s_mov_b32 s48, 8192
    buffer_load_dwordx4 v[24:27], v3, s[16:19], s48 offen
    buffer_load_dwordx4 v[28:31], v3, s[16:19], s48 offen offset:16
    s_mov_b32 s48, 16384
    buffer_load_dwordx4 v[32:35], v3, s[16:19], s48 offen
    buffer_load_dwordx4 v[36:39], v3, s[16:19], s48 offen offset:16
    s_mov_b32 s48, 24704
    buffer_load_dword v10, v13, s[16:19], s48 offen
    s_mov_b32 s32, s10
    s_and_b32 s33, s11, 0xffff
    s_mov_b32 s34, 0x700000
    s_mov_b32 s35, 0x00020000
    s_cmp_ge_u32 s2, 224
    s_cselect_b32 s34, 0, s34
    s_mov_b32 s52, 0x3a800000
    s_mov_b32 s53, 0x3a800000
    s_mov_b32 s54, 0x7ff
    v_mov_b32 v14, 0x3727c5ac
    v_mov_b32 v15, v14
    v_mov_b32 v8, 0xff800000
    v_mov_b32 v9, v8
    s_waitcnt vmcnt(0)
    v_sub_f32 v10, 0, v10
    v_mov_b32 v11, v10
    v_pk_mul_f32 v[16:17], v[16:17], s[52:53]
    v_pk_fma_f32 v[24:25], v[24:25], s[52:53], v[14:15]
    v_pk_fma_f32 v[32:33], v[16:17], v[10:11], v[32:33]
    v_pk_fma_f32 v[24:25], v[16:17], v[16:17], v[24:25] neg_lo:[1,0,0] neg_hi:[1,0,0]
    v_pk_mul_f32 v[18:19], v[18:19], s[52:53]
    v_pk_fma_f32 v[26:27], v[26:27], s[52:53], v[14:15]
    v_pk_fma_f32 v[34:35], v[18:19], v[10:11], v[34:35]
    v_pk_fma_f32 v[26:27], v[18:19], v[18:19], v[26:27] neg_lo:[1,0,0] neg_hi:[1,0,0]
    v_pk_mul_f32 v[20:21], v[20:21], s[52:53]
    v_pk_fma_f32 v[28:29], v[28:29], s[52:53], v[14:15]
    v_pk_fma_f32 v[36:37], v[20:21], v[10:11], v[36:37]
    v_pk_fma_f32 v[28:29], v[20:21], v[20:21], v[28:29] neg_lo:[1,0,0] neg_hi:[1,0,0]
    v_pk_mul_f32 v[22:23], v[22:23], s[52:53]
    v_pk_fma_f32 v[30:31], v[30:31], s[52:53], v[14:15]
    v_pk_fma_f32 v[38:39], v[22:23], v[10:11], v[38:39]
    v_pk_fma_f32 v[30:31], v[22:23], v[22:23], v[30:31] neg_lo:[1,0,0] neg_hi:[1,0,0]
    v_max_f32 v24, v14, v24
    v_max_f32 v25, v14, v25
    v_max_f32 v26, v14, v26
    v_max_f32 v27, v14, v27
    v_max_f32 v28, v14, v28
    v_max_f32 v29, v14, v29
    v_max_f32 v30, v14, v30
    v_max_f32 v31, v14, v31
    v_rsq_f32 v24, v24
    v_rsq_f32 v25, v25
    v_rsq_f32 v26, v26
    v_rsq_f32 v27, v27
    v_rsq_f32 v28, v28
    v_rsq_f32 v29, v29
    v_rsq_f32 v30, v30
    v_rsq_f32 v31, v31
    v_pk_mul_f32 v[32:33], v[32:33], v[24:25]
    v_pk_mul_f32 v[34:35], v[34:35], v[26:27]
    v_pk_mul_f32 v[36:37], v[36:37], v[28:29]
    v_pk_mul_f32 v[38:39], v[38:39], v[30:31]
    v_bfi_b32 v32, s54, 0, v32
    v_med3_f32 v9, v8, v9, v32
    v_max_f32 v8, v8, v32
    v_bfi_b32 v33, s54, 1, v33
    v_med3_f32 v9, v8, v9, v33
    v_max_f32 v8, v8, v33
    v_bfi_b32 v34, s54, 2, v34
    v_med3_f32 v9, v8, v9, v34
    v_max_f32 v8, v8, v34
    v_bfi_b32 v35, s54, 3, v35
    v_med3_f32 v9, v8, v9, v35
    v_max_f32 v8, v8, v35
    v_bfi_b32 v36, s54, 4, v36
    v_med3_f32 v9, v8, v9, v36
    v_max_f32 v8, v8, v36
    v_bfi_b32 v37, s54, 5, v37
    v_med3_f32 v9, v8, v9, v37
    v_max_f32 v8, v8, v37
    v_bfi_b32 v38, s54, 6, v38
    v_med3_f32 v9, v8, v9, v38
    v_max_f32 v8, v8, v38
    v_bfi_b32 v39, s54, 7, v39
    v_med3_f32 v9, v8, v9, v39
    v_max_f32 v8, v8, v39
    v_lshl_or_b32 v8, v0, 3, v8
    v_lshl_or_b32 v9, v0, 3, v9
    s_nop 1
    v_mov_b32_dpp v10, v8 quad_perm:[1,0,3,2] row_mask:0xf bank_mask:0xf
    v_mov_b32_dpp v11, v9 quad_perm:[1,0,3,2] row_mask:0xf bank_mask:0xf
    v_max_f32 v11, v11, v9
    v_med3_f32 v9, v8, v10, v11
    v_max_f32 v8, v8, v10
    s_nop 1
    v_mov_b32_dpp v10, v8 quad_perm:[2,3,0,1] row_mask:0xf bank_mask:0xf
    v_mov_b32_dpp v11, v9 quad_perm:[2,3,0,1] row_mask:0xf bank_mask:0xf
    v_max_f32 v11, v11, v9
    v_med3_f32 v9, v8, v10, v11
    v_max_f32 v8, v8, v10
    s_nop 1
    v_mov_b32_dpp v10, v8 row_half_mirror row_mask:0xf bank_mask:0xf
    v_mov_b32_dpp v11, v9 row_half_mirror row_mask:0xf bank_mask:0xf
    v_max_f32 v11, v11, v9
    v_med3_f32 v9, v8, v10, v11
    v_max_f32 v8, v8, v10
    s_nop 1
    v_mov_b32_dpp v10, v8 row_mirror row_mask:0xf bank_mask:0xf
    v_mov_b32_dpp v11, v9 row_mirror row_mask:0xf bank_mask:0xf
    v_max_f32 v11, v11, v9
    v_med3_f32 v9, v8, v10, v11
    v_max_f32 v8, v8, v10
    v_mov_b32 v10, v8
    v_mov_b32 v11, v9
    s_nop 1
    v_permlane16_swap_b32 v8, v10
    v_permlane16_swap_b32 v9, v11
    s_nop 1
    v_max_f32 v11, v11, v9
    v_med3_f32 v9, v8, v10, v11
    v_max_f32 v8, v8, v10
    v_mov_b32 v10, v8
    v_mov_b32 v11, v9
    s_nop 1
    v_permlane32_swap_b32 v8, v10
    v_permlane32_swap_b32 v9, v11
    s_nop 1
    v_max_f32 v11, v11, v9
    v_med3_f32 v9, v8, v10, v11
    v_max_f32 v8, v8, v10
    v_mov_b32 v10, 1
    v_mov_b32 v11, 1
    v_lshlrev_b32 v12, 4, v1
    v_add_u32 v12, 69632, v12
    ds_write_b128 v12, v[8:11]
    v_mov_b32 v12, 69632
k4_mail_125:
    ds_read_b128 v[16:19], v12 offset:0
    ds_read_b128 v[20:23], v12 offset:16
    ds_read_b128 v[24:27], v12 offset:32
    ds_read_b128 v[28:31], v12 offset:48
    s_waitcnt lgkmcnt(0)
    v_and_b32 v10, v18, v22
    v_and_b32 v11, v26, v30
    v_and_b32 v10, v10, v11
    v_cmp_eq_u32 vcc, 0, v10
    s_cbranch_vccnz k4_mail_125
    v_max_f32 v21, v21, v17
    v_med3_f32 v17, v16, v20, v21
    v_max_f32 v16, v16, v20
    v_max_f32 v29, v29, v25
    v_med3_f32 v25, v24, v28, v29
    v_max_f32 v24, v24, v28
    v_max_f32 v25, v25, v17
    v_med3_f32 v17, v16, v24, v25
    v_max_f32 v16, v16, v24
    v_cmp_eq_u32 vcc, 0, v5
    s_lshl_b32 s52, s45, 15
    v_lshlrev_b32 v9, 3, v0
    v_cndmask_b32 v11, v17, v16, vcc
    v_and_b32 v15, 0x7ff, v11
    v_lshl_add_u32 v11, v15, 11, v7
    buffer_load_dwordx4 v[40:43], v11, s[20:23], 0 offen offset:0
    buffer_load_dwordx4 v[44:47], v11, s[20:23], 0 offen offset:512
    buffer_load_dwordx4 v[48:51], v11, s[20:23], 0 offen offset:1024
    buffer_load_dwordx4 v[52:55], v11, s[20:23], 0 offen offset:1536
    buffer_load_dwordx2 v[88:89], v9, s[32:35], s52 offen offset:0
    buffer_load_dwordx2 v[90:91], v9, s[32:35], s52 offen offset:2048
    s_add_u32 s52, s52, 4096
    buffer_load_dwordx2 v[92:93], v9, s[32:35], s52 offen offset:0
    buffer_load_dwordx2 v[94:95], v9, s[32:35], s52 offen offset:2048
    s_add_u32 s52, s52, 4096
    buffer_load_dwordx2 v[96:97], v9, s[32:35], s52 offen offset:0
    buffer_load_dwordx2 v[98:99], v9, s[32:35], s52 offen offset:2048
    s_add_u32 s52, s52, 4096
    buffer_load_dwordx2 v[100:101], v9, s[32:35], s52 offen offset:0
    buffer_load_dwordx2 v[102:103], v9, s[32:35], s52 offen offset:2048
    s_add_u32 s52, s52, 4096
    buffer_load_dwordx2 v[104:105], v9, s[32:35], s52 offen offset:0
    buffer_load_dwordx2 v[106:107], v9, s[32:35], s52 offen offset:2048
    s_add_u32 s52, s52, 4096
    buffer_load_dwordx2 v[108:109], v9, s[32:35], s52 offen offset:0
    buffer_load_dwordx2 v[110:111], v9, s[32:35], s52 offen offset:2048
    s_add_u32 s52, s52, 4096
    buffer_load_dwordx2 v[112:113], v9, s[32:35], s52 offen offset:0
    buffer_load_dwordx2 v[114:115], v9, s[32:35], s52 offen offset:2048
    s_add_u32 s52, s52, 4096
    buffer_load_dwordx2 v[116:117], v9, s[32:35], s52 offen offset:0
    buffer_load_dwordx2 v[118:119], v9, s[32:35], s52 offen offset:2048
    s_add_u32 s52, s52, 4096
    s_waitcnt vmcnt(16)
k4_ln_122:
    v_lshlrev_b32 v200, 16, v40
    v_and_b32 v201, 0xffff0000, v40
    v_lshlrev_b32 v202, 16, v41
    v_and_b32 v203, 0xffff0000, v41
    v_lshlrev_b32 v204, 16, v42
    v_and_b32 v205, 0xffff0000, v42
    v_lshlrev_b32 v206, 16, v43
    v_and_b32 v207, 0xffff0000, v43
    v_lshlrev_b32 v208, 16, v44
    v_and_b32 v209, 0xffff0000, v44
    v_lshlrev_b32 v210, 16, v45
    v_and_b32 v211, 0xffff0000, v45
    v_lshlrev_b32 v212, 16, v46
    v_and_b32 v213, 0xffff0000, v46
    v_lshlrev_b32 v214, 16, v47
    v_and_b32 v215, 0xffff0000, v47
    v_lshlrev_b32 v216, 16, v48
    v_and_b32 v217, 0xffff0000, v48
    v_lshlrev_b32 v218, 16, v49
    v_and_b32 v219, 0xffff0000, v49
    v_lshlrev_b32 v220, 16, v50
    v_and_b32 v221, 0xffff0000, v50
    v_lshlrev_b32 v222, 16, v51
    v_and_b32 v223, 0xffff0000, v51
    v_lshlrev_b32 v224, 16, v52
    v_and_b32 v225, 0xffff0000, v52
    v_lshlrev_b32 v226, 16, v53
    v_and_b32 v227, 0xffff0000, v53
    v_lshlrev_b32 v228, 16, v54
    v_and_b32 v229, 0xffff0000, v54
    v_lshlrev_b32 v230, 16, v55
    v_and_b32 v231, 0xffff0000, v55
    v_pk_add_f32 v[192:193], v[200:201], v[202:203]
    v_pk_add_f32 v[194:195], v[204:205], v[206:207]
    v_pk_add_f32 v[192:193], v[192:193], v[208:209]
    v_pk_add_f32 v[194:195], v[194:195], v[210:211]
    v_pk_add_f32 v[192:193], v[192:193], v[212:213]
    v_pk_add_f32 v[194:195], v[194:195], v[214:215]
    v_pk_add_f32 v[192:193], v[192:193], v[216:217]
    v_pk_add_f32 v[194:195], v[194:195], v[218:219]
    v_pk_add_f32 v[192:193], v[192:193], v[220:221]
    v_pk_add_f32 v[194:195], v[194:195], v[222:223]
    v_pk_add_f32 v[192:193], v[192:193], v[224:225]
    v_pk_add_f32 v[194:195], v[194:195], v[226:227]
    v_pk_add_f32 v[192:193], v[192:193], v[228:229]
    v_pk_add_f32 v[194:195], v[194:195], v[230:231]
    v_pk_add_f32 v[192:193], v[192:193], v[194:195]
    v_add_f32 v192, v192, v193
    s_nop 1
    v_add_f32_dpp v192, v192, v192 quad_perm:[1,0,3,2] row_mask:0xf bank_mask:0xf
    s_nop 1
    v_add_f32_dpp v192, v192, v192 quad_perm:[2,3,0,1] row_mask:0xf bank_mask:0xf
    s_nop 1
    v_add_f32_dpp v192, v192, v192 row_half_mirror row_mask:0xf bank_mask:0xf
    s_nop 1
    v_add_f32_dpp v192, v192, v192 row_mirror row_mask:0xf bank_mask:0xf
    v_mov_b32 v194, v192
    s_nop 1
    v_permlane16_swap_b32 v192, v194
    s_nop 1
    v_add_f32 v192, v192, v194
    v_mul_f32 v192, 0xba800000, v192
    v_mov_b32 v193, v192
    v_pk_add_f32 v[194:195], v[200:201], v[192:193]
    v_pk_add_f32 v[198:199], v[202:203], v[192:193]
    v_pk_mul_f32 v[196:197], v[194:195], v[194:195]
    v_pk_fma_f32 v[196:197], v[198:199], v[198:199], v[196:197]
    v_pk_add_f32 v[194:195], v[204:205], v[192:193]
    v_pk_add_f32 v[198:199], v[206:207], v[192:193]
    v_pk_fma_f32 v[196:197], v[194:195], v[194:195], v[196:197]
    v_pk_fma_f32 v[196:197], v[198:199], v[198:199], v[196:197]
    v_pk_add_f32 v[194:195], v[208:209], v[192:193]
    v_pk_add_f32 v[198:199], v[210:211], v[192:193]
    v_pk_fma_f32 v[196:197], v[194:195], v[194:195], v[196:197]
    v_pk_fma_f32 v[196:197], v[198:199], v[198:199], v[196:197]
    v_pk_add_f32 v[194:195], v[212:213], v[192:193]
    v_pk_add_f32 v[198:199], v[214:215], v[192:193]
    v_pk_fma_f32 v[196:197], v[194:195], v[194:195], v[196:197]
    v_pk_fma_f32 v[196:197], v[198:199], v[198:199], v[196:197]
    v_pk_add_f32 v[194:195], v[216:217], v[192:193]
    v_pk_add_f32 v[198:199], v[218:219], v[192:193]
    v_pk_fma_f32 v[196:197], v[194:195], v[194:195], v[196:197]
    v_pk_fma_f32 v[196:197], v[198:199], v[198:199], v[196:197]
    v_pk_add_f32 v[194:195], v[220:221], v[192:193]
    v_pk_add_f32 v[198:199], v[222:223], v[192:193]
    v_pk_fma_f32 v[196:197], v[194:195], v[194:195], v[196:197]
    v_pk_fma_f32 v[196:197], v[198:199], v[198:199], v[196:197]
    v_pk_add_f32 v[194:195], v[224:225], v[192:193]
    v_pk_add_f32 v[198:199], v[226:227], v[192:193]
    v_pk_fma_f32 v[196:197], v[194:195], v[194:195], v[196:197]
    v_pk_fma_f32 v[196:197], v[198:199], v[198:199], v[196:197]
    v_pk_add_f32 v[194:195], v[228:229], v[192:193]
    v_pk_add_f32 v[198:199], v[230:231], v[192:193]
    v_pk_fma_f32 v[196:197], v[194:195], v[194:195], v[196:197]
    v_pk_fma_f32 v[196:197], v[198:199], v[198:199], v[196:197]
    v_add_f32 v196, v196, v197
    s_nop 1
    v_add_f32_dpp v196, v196, v196 quad_perm:[1,0,3,2] row_mask:0xf bank_mask:0xf
    s_nop 1
    v_add_f32_dpp v196, v196, v196 quad_perm:[2,3,0,1] row_mask:0xf bank_mask:0xf
    s_nop 1
    v_add_f32_dpp v196, v196, v196 row_half_mirror row_mask:0xf bank_mask:0xf
    s_nop 1
    v_add_f32_dpp v196, v196, v196 row_mirror row_mask:0xf bank_mask:0xf
    v_mov_b32 v194, v196
    s_nop 1
    v_permlane16_swap_b32 v196, v194
    s_nop 1
    v_add_f32 v196, v196, v194
    v_mul_f32 v196, 0x3a800000, v196
    v_cvt_pk_bf16_f32 v198, v192, v196
    v_and_b32 v196, 0xffff0000, v198
    v_lshlrev_b32 v198, 16, v198
    v_add_f32 v196, 0x3727c5ac, v196
    v_mov_b32 v199, v198
    v_cvt_pk_bf16_f32 v196, v196, v196
    v_and_b32 v196, 0xffff0000, v196
    v_sqrt_f32 v196, v196
    v_pk_add_f32 v[160:161], v[200:201], v[198:199]
    v_pk_add_f32 v[162:163], v[202:203], v[198:199]
    v_pk_add_f32 v[164:165], v[204:205], v[198:199]
    v_pk_add_f32 v[166:167], v[206:207], v[198:199]
    v_pk_add_f32 v[168:169], v[208:209], v[198:199]
    v_pk_add_f32 v[170:171], v[210:211], v[198:199]
    v_pk_add_f32 v[172:173], v[212:213], v[198:199]
    v_pk_add_f32 v[174:175], v[214:215], v[198:199]
    v_pk_add_f32 v[176:177], v[216:217], v[198:199]
    v_pk_add_f32 v[178:179], v[218:219], v[198:199]
    v_pk_add_f32 v[180:181], v[220:221], v[198:199]
    v_pk_add_f32 v[182:183], v[222:223], v[198:199]
    v_pk_add_f32 v[184:185], v[224:225], v[198:199]
    v_pk_add_f32 v[186:187], v[226:227], v[198:199]
    v_pk_add_f32 v[188:189], v[228:229], v[198:199]
    v_pk_add_f32 v[190:191], v[230:231], v[198:199]
    v_cvt_pk_bf16_f32 v196, v196, v196
    v_and_b32 v196, 0xffff0000, v196
    v_rcp_f32 v196, v196
    v_cvt_pk_bf16_f32 v40, v160, v161
    v_cvt_pk_bf16_f32 v41, v162, v163
    v_cvt_pk_bf16_f32 v42, v164, v165
    v_cvt_pk_bf16_f32 v43, v166, v167
    v_cvt_pk_bf16_f32 v44, v168, v169
    v_cvt_pk_bf16_f32 v45, v170, v171
    v_cvt_pk_bf16_f32 v46, v172, v173
    v_cvt_pk_bf16_f32 v47, v174, v175
    v_cvt_pk_bf16_f32 v48, v176, v177
    v_cvt_pk_bf16_f32 v49, v178, v179
    v_cvt_pk_bf16_f32 v50, v180, v181
    v_cvt_pk_bf16_f32 v51, v182, v183
    v_cvt_pk_bf16_f32 v52, v184, v185
    v_cvt_pk_bf16_f32 v53, v186, v187
    v_cvt_pk_bf16_f32 v54, v188, v189
    v_cvt_pk_bf16_f32 v55, v190, v191
    v_mov_b32 v197, v196
    v_lshlrev_b32 v160, 16, v40
    v_and_b32 v161, 0xffff0000, v40
    v_lshlrev_b32 v162, 16, v41
    v_and_b32 v163, 0xffff0000, v41
    v_lshlrev_b32 v164, 16, v42
    v_and_b32 v165, 0xffff0000, v42
    v_lshlrev_b32 v166, 16, v43
    v_and_b32 v167, 0xffff0000, v43
    v_lshlrev_b32 v168, 16, v44
    v_and_b32 v169, 0xffff0000, v44
    v_lshlrev_b32 v170, 16, v45
    v_and_b32 v171, 0xffff0000, v45
    v_lshlrev_b32 v172, 16, v46
    v_and_b32 v173, 0xffff0000, v46
    v_lshlrev_b32 v174, 16, v47
    v_and_b32 v175, 0xffff0000, v47
    v_lshlrev_b32 v176, 16, v48
    v_and_b32 v177, 0xffff0000, v48
    v_lshlrev_b32 v178, 16, v49
    v_and_b32 v179, 0xffff0000, v49
    v_lshlrev_b32 v180, 16, v50
    v_and_b32 v181, 0xffff0000, v50
    v_lshlrev_b32 v182, 16, v51
    v_and_b32 v183, 0xffff0000, v51
    v_lshlrev_b32 v184, 16, v52
    v_and_b32 v185, 0xffff0000, v52
    v_lshlrev_b32 v186, 16, v53
    v_and_b32 v187, 0xffff0000, v53
    v_lshlrev_b32 v188, 16, v54
    v_and_b32 v189, 0xffff0000, v54
    v_lshlrev_b32 v190, 16, v55
    v_and_b32 v191, 0xffff0000, v55
    v_pk_mul_f32 v[160:161], v[160:161], v[196:197]
    v_pk_mul_f32 v[162:163], v[162:163], v[196:197]
    v_pk_mul_f32 v[164:165], v[164:165], v[196:197]
    v_pk_mul_f32 v[166:167], v[166:167], v[196:197]
    v_pk_mul_f32 v[168:169], v[168:169], v[196:197]
    v_pk_mul_f32 v[170:171], v[170:171], v[196:197]
    v_pk_mul_f32 v[172:173], v[172:173], v[196:197]
    v_pk_mul_f32 v[174:175], v[174:175], v[196:197]
    v_pk_mul_f32 v[176:177], v[176:177], v[196:197]
    v_pk_mul_f32 v[178:179], v[178:179], v[196:197]
    v_pk_mul_f32 v[180:181], v[180:181], v[196:197]
    v_pk_mul_f32 v[182:183], v[182:183], v[196:197]
    v_pk_mul_f32 v[184:185], v[184:185], v[196:197]
    v_pk_mul_f32 v[186:187], v[186:187], v[196:197]
    v_pk_mul_f32 v[188:189], v[188:189], v[196:197]
    v_pk_mul_f32 v[190:191], v[190:191], v[196:197]
    v_cvt_pk_bf16_f32 v40, v160, v161
    v_cvt_pk_bf16_f32 v41, v162, v163
    v_cvt_pk_bf16_f32 v42, v164, v165
    v_cvt_pk_bf16_f32 v43, v166, v167
    v_cvt_pk_bf16_f32 v44, v168, v169
    v_cvt_pk_bf16_f32 v45, v170, v171
    v_cvt_pk_bf16_f32 v46, v172, v173
    v_cvt_pk_bf16_f32 v47, v174, v175
    v_cvt_pk_bf16_f32 v48, v176, v177
    v_cvt_pk_bf16_f32 v49, v178, v179
    v_cvt_pk_bf16_f32 v50, v180, v181
    v_cvt_pk_bf16_f32 v51, v182, v183
    v_cvt_pk_bf16_f32 v52, v184, v185
    v_cvt_pk_bf16_f32 v53, v186, v187
    v_cvt_pk_bf16_f32 v54, v188, v189
    v_cvt_pk_bf16_f32 v55, v190, v191
    s_cmp_ge_u32 s44, 4
    s_cbranch_scc1 k4_bout_124
    v_lshl_add_u32 v11, v5, 11, v7
    v_add_u32 v12, 65536, v11
    ds_write_b128 v12, v[40:43] offset:0
    ds_write_b128 v12, v[44:47] offset:512
    ds_write_b128 v12, v[48:51] offset:1024
    ds_write_b128 v12, v[52:55] offset:1536
    v_lshlrev_b32 v12, 2, v5
    v_add_u32 v12, 69760, v12
    ds_write_b32 v12, v15
    s_mov_b32 s54, 0x05040100
    s_mov_b32 s55, 0x07060302
    s_waitcnt vmcnt(0)
    v_perm_b32 v56, v90, v88, s54
    v_perm_b32 v57, v90, v88, s55
    v_perm_b32 v58, v91, v89, s54
    v_perm_b32 v59, v91, v89, s55
    v_perm_b32 v60, v94, v92, s54
    v_perm_b32 v61, v94, v92, s55
    v_perm_b32 v62, v95, v93, s54
    v_perm_b32 v63, v95, v93, s55
    v_perm_b32 v64, v98, v96, s54
    v_perm_b32 v65, v98, v96, s55
    v_perm_b32 v66, v99, v97, s54
    v_perm_b32 v67, v99, v97, s55
    v_perm_b32 v68, v102, v100, s54
    v_perm_b32 v69, v102, v100, s55
    v_perm_b32 v70, v103, v101, s54
    v_perm_b32 v71, v103, v101, s55
    v_perm_b32 v72, v106, v104, s54
    v_perm_b32 v73, v106, v104, s55
    v_perm_b32 v74, v107, v105, s54
    v_perm_b32 v75, v107, v105, s55
    v_perm_b32 v76, v110, v108, s54
    v_perm_b32 v77, v110, v108, s55
    v_perm_b32 v78, v111, v109, s54
    v_perm_b32 v79, v111, v109, s55
    v_perm_b32 v80, v114, v112, s54
    v_perm_b32 v81, v114, v112, s55
    v_perm_b32 v82, v115, v113, s54
    v_perm_b32 v83, v115, v113, s55
    v_perm_b32 v84, v118, v116, s54
    v_perm_b32 v85, v118, v116, s55
    v_perm_b32 v86, v119, v117, s54
    v_perm_b32 v87, v119, v117, s55
    s_add_u32 s56, s14, 0x4900000
    s_addc_u32 s57, s15, 0
    s_and_b32 s57, s57, 0xffff
    s_mov_b32 s58, 0x1c0000
    s_mov_b32 s59, 0x00020000
    s_add_u32 s60, s14, 0x480f000
    s_addc_u32 s61, s15, 0
    s_and_b32 s61, s61, 0xffff
    s_mov_b32 s62, 0x2000
    s_mov_b32 s63, 0x00020000
    s_waitcnt lgkmcnt(0)
k4_mm_123:
    s_barrier
    s_cmp_ge_u32 s2, 224
    s_cbranch_scc1 k4_red_126
    v_lshrrev_b32 v12, 4, v2
    v_and_b32 v13, 1, v2
    v_lshlrev_b32 v13, 11, v13
    v_lshl_add_u32 v13, v12, 3, v13
    s_lshl_b32 s54, s44, 8
    s_add_u32 s54, s54, 65536
    v_add_u32 v13, s54, v13
    v_lshlrev_b32 v14, 3, v2
    s_lshl_b32 s54, s44, 12
    v_add_u32 v14, s54, v14
    ds_read_b64 v[128:129], v13 offset:0
    ds_read_b64 v[130:131], v13 offset:32
    ds_read_b64_tr_b16 v[144:145], v14 offset:0
    ds_read_b64_tr_b16 v[146:147], v14 offset:512
    ds_read_b64_tr_b16 v[160:161], v14 offset:32768
    ds_read_b64_tr_b16 v[162:163], v14 offset:33280
    ds_read_b64 v[132:133], v13 offset:64
    ds_read_b64 v[134:135], v13 offset:96
    ds_read_b64_tr_b16 v[148:149], v14 offset:1024
    ds_read_b64_tr_b16 v[150:151], v14 offset:1536
    ds_read_b64_tr_b16 v[164:165], v14 offset:33792
    ds_read_b64_tr_b16 v[166:167], v14 offset:34304
    ds_read_b64 v[136:137], v13 offset:128
    ds_read_b64 v[138:139], v13 offset:160
    ds_read_b64_tr_b16 v[152:153], v14 offset:2048
    ds_read_b64_tr_b16 v[154:155], v14 offset:2560
    ds_read_b64_tr_b16 v[168:169], v14 offset:34816
    ds_read_b64_tr_b16 v[170:171], v14 offset:35328
    ds_read_b64 v[140:141], v13 offset:192
    ds_read_b64 v[142:143], v13 offset:224
    ds_read_b64_tr_b16 v[156:157], v14 offset:3072
    ds_read_b64_tr_b16 v[158:159], v14 offset:3584
    ds_read_b64_tr_b16 v[172:173], v14 offset:35840
    ds_read_b64_tr_b16 v[174:175], v14 offset:36352
    v_and_b32 v13, 15, v2
    v_lshlrev_b32 v13, 6, v13
    v_lshl_add_u32 v13, v12, 4, v13
    s_lshl_b32 s54, s44, 11
    s_add_u32 s54, s54, 69888
    v_add_u32 v13, s54, v13
    s_waitcnt lgkmcnt(0)
    v_mfma_f32_16x16x32_bf16 v[16:19], v[144:147], v[128:131], 0
    v_mfma_f32_16x16x32_bf16 v[20:23], v[160:163], v[128:131], 0
    v_mfma_f32_16x16x32_bf16 v[16:19], v[148:151], v[132:135], v[16:19]
    v_mfma_f32_16x16x32_bf16 v[20:23], v[164:167], v[132:135], v[20:23]
    v_mfma_f32_16x16x32_bf16 v[16:19], v[152:155], v[136:139], v[16:19]
    v_mfma_f32_16x16x32_bf16 v[20:23], v[168:171], v[136:139], v[20:23]
    v_mfma_f32_16x16x32_bf16 v[16:19], v[156:159], v[140:143], v[16:19]
    v_mfma_f32_16x16x32_bf16 v[20:23], v[172:175], v[140:143], v[20:23]
    s_nop 7
    ds_write_b128 v13, v[16:19]
    ds_write_b128 v13, v[20:23] offset:1024
    s_waitcnt lgkmcnt(0)
    s_barrier
    s_cmp_ge_u32 s44, 4
    s_cbranch_scc1 k4_ln_122
    v_lshlrev_b32 v13, 2, v4
    v_add_u32 v13, 69888, v13
    ds_read2st64_b32 v[16:17], v13 offset0:0 offset1:4
    ds_read2st64_b32 v[18:19], v13 offset0:8 offset1:12
    ds_read2st64_b32 v[20:21], v13 offset0:16 offset1:20
    ds_read2st64_b32 v[22:23], v13 offset0:24 offset1:28
    ds_read2st64_b32 v[24:25], v13 offset0:32 offset1:36
    ds_read2st64_b32 v[26:27], v13 offset0:40 offset1:44
    ds_read2st64_b32 v[28:29], v13 offset0:48 offset1:52
    ds_read2st64_b32 v[30:31], v13 offset0:56 offset1:60
    s_waitcnt lgkmcnt(0)
    v_pk_add_f32 v[16:17], v[16:17], v[24:25]
    v_pk_add_f32 v[18:19], v[18:19], v[26:27]
    v_pk_add_f32 v[20:21], v[20:21], v[28:29]
    v_pk_add_f32 v[22:23], v[22:23], v[30:31]
    v_pk_add_f32 v[16:17], v[16:17], v[20:21]
    v_pk_add_f32 v[18:19], v[18:19], v[22:23]
    v_pk_add_f32 v[16:17], v[16:17], v[18:19]
    v_cvt_pk_bf16_f32 v16, v16, v17
    v_and_b32 v20, 0xffff0000, v16
    v_lshlrev_b32 v16, 16, v16
    v_mul_f32 v17, 0xbfb8aa3b, v16
    v_exp_f32 v17, v17
    s_lshl_b32 s54, s45, 13
    v_add_f32 v17, 1.0, v17
    v_rcp_f32 v17, v17
    s_add_u32 s55, s54, 4096
    v_mul_f32 v16, v16, v17
    v_cvt_pk_bf16_f32 v16, v16, v16
    v_and_b32 v16, 0xffff0000, v16
    v_mul_f32 v16, v16, v20
    s_nop 1
    v_mov_b32_dpp v17, v16 quad_perm:[1,0,3,2] row_mask:0xf bank_mask:0xf
    v_cvt_pk_bf16_f32 v16, v16, v17
    v_lshlrev_b32 v13, 4, v0
    v_readlane_b32 s24, v16, 0
    v_readlane_b32 s25, v16, 2
    v_readlane_b32 s26, v16, 4
    v_readlane_b32 s27, v16, 6
    v_readlane_b32 s28, v16, 8
    v_readlane_b32 s29, v16, 10
    v_readlane_b32 s30, v16, 12
    v_readlane_b32 s31, v16, 14
    v_readlane_b32 s32, v16, 16
    v_readlane_b32 s33, v16, 18
    v_readlane_b32 s34, v16, 20
    v_readlane_b32 s35, v16, 22
    v_readlane_b32 s36, v16, 24
    v_readlane_b32 s37, v16, 26
    v_readlane_b32 s38, v16, 28
    v_readlane_b32 s39, v16, 30
    v_dot2_f32_bf16 v24, v56, s24, 0
    v_dot2_f32_bf16 v25, v57, s24, 0
    v_dot2_f32_bf16 v26, v58, s24, 0
    v_dot2_f32_bf16 v27, v59, s24, 0
    v_dot2_f32_bf16 v24, v60, s25, v24
    v_dot2_f32_bf16 v25, v61, s25, v25
    v_dot2_f32_bf16 v26, v62, s25, v26
    v_dot2_f32_bf16 v27, v63, s25, v27
    v_dot2_f32_bf16 v24, v64, s26, v24
    v_dot2_f32_bf16 v25, v65, s26, v25
    v_dot2_f32_bf16 v26, v66, s26, v26
    v_dot2_f32_bf16 v27, v67, s26, v27
    v_dot2_f32_bf16 v24, v68, s27, v24
    v_dot2_f32_bf16 v25, v69, s27, v25
    v_dot2_f32_bf16 v26, v70, s27, v26
    v_dot2_f32_bf16 v27, v71, s27, v27
    v_dot2_f32_bf16 v24, v72, s28, v24
    v_dot2_f32_bf16 v25, v73, s28, v25
    v_dot2_f32_bf16 v26, v74, s28, v26
    v_dot2_f32_bf16 v27, v75, s28, v27
    v_dot2_f32_bf16 v24, v76, s29, v24
    v_dot2_f32_bf16 v25, v77, s29, v25
    v_dot2_f32_bf16 v26, v78, s29, v26
    v_dot2_f32_bf16 v27, v79, s29, v27
    v_dot2_f32_bf16 v24, v80, s30, v24
    v_dot2_f32_bf16 v25, v81, s30, v25
    v_dot2_f32_bf16 v26, v82, s30, v26
    v_dot2_f32_bf16 v27, v83, s30, v27
    v_dot2_f32_bf16 v24, v84, s31, v24
    v_dot2_f32_bf16 v25, v85, s31, v25
    v_dot2_f32_bf16 v26, v86, s31, v26
    v_dot2_f32_bf16 v27, v87, s31, v27
    v_dot2_f32_bf16 v28, v56, s32, 0
    v_dot2_f32_bf16 v29, v57, s32, 0
    v_dot2_f32_bf16 v30, v58, s32, 0
    v_dot2_f32_bf16 v31, v59, s32, 0
    v_dot2_f32_bf16 v28, v60, s33, v28
    v_dot2_f32_bf16 v29, v61, s33, v29
    v_dot2_f32_bf16 v30, v62, s33, v30
    v_dot2_f32_bf16 v31, v63, s33, v31
    v_dot2_f32_bf16 v28, v64, s34, v28
    v_dot2_f32_bf16 v29, v65, s34, v29
    v_dot2_f32_bf16 v30, v66, s34, v30
    v_dot2_f32_bf16 v31, v67, s34, v31
    v_dot2_f32_bf16 v28, v68, s35, v28
    v_dot2_f32_bf16 v29, v69, s35, v29
    v_dot2_f32_bf16 v30, v70, s35, v30
    v_dot2_f32_bf16 v31, v71, s35, v31
    v_dot2_f32_bf16 v28, v72, s36, v28
    v_dot2_f32_bf16 v29, v73, s36, v29
    v_dot2_f32_bf16 v30, v74, s36, v30
    v_dot2_f32_bf16 v31, v75, s36, v31
    v_dot2_f32_bf16 v28, v76, s37, v28
    v_dot2_f32_bf16 v29, v77, s37, v29
    v_dot2_f32_bf16 v30, v78, s37, v30
    v_dot2_f32_bf16 v31, v79, s37, v31
    v_dot2_f32_bf16 v28, v80, s38, v28
    v_dot2_f32_bf16 v29, v81, s38, v29
    v_dot2_f32_bf16 v30, v82, s38, v30
    v_dot2_f32_bf16 v31, v83, s38, v31
    v_dot2_f32_bf16 v28, v84, s39, v28
    v_dot2_f32_bf16 v29, v85, s39, v29
    v_dot2_f32_bf16 v30, v86, s39, v30
    v_dot2_f32_bf16 v31, v87, s39, v31
    s_and_b32 s52, s45, 15
    s_lshl_b32 s53, s44, 4
    s_add_u32 s52, s52, s53
    s_lshl_b32 s52, s52, 7
    buffer_store_dwordx4 v[24:27], v13, s[56:59], s54 offen sc1
    buffer_store_dwordx4 v[28:31], v13, s[56:59], s55 offen sc1
    v_mov_b32 v12, 0
    v_mov_b32 v13, 1
    s_mov_b64 exec, 1
    s_waitcnt vmcnt(0)
    buffer_atomic_add v13, v12, s[60:63], s52 offen sc1
    s_mov_b64 exec, -1
    s_endpgm
k4_red_126:
    s_cmp_ge_u32 s44, 4
    s_cbranch_scc1 k4_ln_122
    s_sub_u32 s40, s2, 224
    s_lshr_b32 s41, s40, 4
    s_and_b32 s42, s40, 15
    s_mov_b32 s24, s4
    s_and_b32 s25, s5, 0xffff
    s_mov_b32 s26, 0x800
    s_mov_b32 s27, 0x00020000
    s_mov_b32 s28, s12
    s_and_b32 s29, s13, 0xffff
    s_mov_b32 s30, 0x400000
    s_mov_b32 s31, 0x00020000
    buffer_load_dwordx4 v[56:59], v7, s[24:27], 0 offen offset:0
    buffer_load_dwordx4 v[60:63], v7, s[24:27], 0 offen offset:512
    buffer_load_dwordx4 v[64:67], v7, s[24:27], 0 offen offset:1024
    buffer_load_dwordx4 v[68:71], v7, s[24:27], 0 offen offset:1536
    s_lshl_b32 s43, s41, 5
    v_readlane_b32 s46, v15, s43
    v_and_b32 v8, 15, v0
    s_lshl_b32 s47, s42, 7
    v_lshl_add_u32 v9, v8, 3, s47
    s_lshl_b32 s46, s46, 11
    s_lshl_b32 s48, s41, 11
    s_add_u32 s48, s48, 65536
    v_add_u32 v12, s48, v9
    ds_read_b64 v[72:73], v12
    buffer_load_dwordx2 v[74:75], v9, s[20:23], s46 offen
    v_lshrrev_b32 v10, 4, v0
    v_lshlrev_b32 v10, 13, v10
    v_lshl_add_u32 v10, v8, 4, v10
    s_lshl_b32 s49, s40, 8
    s_waitcnt vmcnt(1)
    v_dot2_f32_bf16 v12, v40, v56, 0
    v_dot2_f32_bf16 v12, v41, v57, v12
    v_dot2_f32_bf16 v12, v42, v58, v12
    v_dot2_f32_bf16 v12, v43, v59, v12
    v_dot2_f32_bf16 v12, v44, v60, v12
    v_dot2_f32_bf16 v12, v45, v61, v12
    v_dot2_f32_bf16 v12, v46, v62, v12
    v_dot2_f32_bf16 v12, v47, v63, v12
    v_dot2_f32_bf16 v12, v48, v64, v12
    v_dot2_f32_bf16 v12, v49, v65, v12
    v_dot2_f32_bf16 v12, v50, v66, v12
    v_dot2_f32_bf16 v12, v51, v67, v12
    v_dot2_f32_bf16 v12, v52, v68, v12
    v_dot2_f32_bf16 v12, v53, v69, v12
    v_dot2_f32_bf16 v12, v54, v70, v12
    v_dot2_f32_bf16 v12, v55, v71, v12
    s_nop 2
    s_nop 1
    v_add_f32_dpp v12, v12, v12 quad_perm:[1,0,3,2] row_mask:0xf bank_mask:0xf
    s_nop 1
    v_add_f32_dpp v12, v12, v12 quad_perm:[2,3,0,1] row_mask:0xf bank_mask:0xf
    s_nop 1
    v_add_f32_dpp v12, v12, v12 row_half_mirror row_mask:0xf bank_mask:0xf
    s_nop 1
    v_add_f32_dpp v12, v12, v12 row_mirror row_mask:0xf bank_mask:0xf
    v_mov_b32 v13, v12
    s_nop 1
    v_permlane16_swap_b32 v12, v13
    s_nop 1
    v_add_f32 v12, v12, v13
    v_cvt_pk_bf16_f32 v12, v12, v12
    v_and_b32 v12, 0xffff0000, v12
    v_mul_f32 v12, 0xbfb8aa3b, v12
    v_exp_f32 v12, v12
    v_mov_b32 v3, v8
    v_add_f32 v12, 1.0, v12
    v_rcp_f32 v12, v12
    s_lshr_b32 s50, s42, 2
    v_cvt_pk_bf16_f32 v12, v12, v12
    v_and_b32 v12, 0xffff0000, v12
    s_lshl_b32 s50, s50, 11
    v_readlane_b32 s51, v12, s43
    v_lshlrev_b32 v3, 7, v3
    s_mov_b32 s47, s49
    s_mov_b32 s30, 0
    s_mov_b32 s58, 0
    s_branch k4_go_127
k4_again_129:
    s_mov_b32 s49, s47
    s_mov_b32 s30, 0x400000
    s_mov_b32 s58, 1835008
    s_cmp_lg_u32 s44, 0
    s_cbranch_scc1 k4_go_127
    s_mov_b32 s52, 1048576
k4_poll_128:
    s_sleep 8
    buffer_load_dword v13, v3, s[60:63], s50 offen sc1
    s_sub_u32 s52, s52, 1
    s_cbranch_scc1 k4_go_127
    s_waitcnt vmcnt(0)
    v_cmp_gt_u32 vcc, 14, v13
    s_cbranch_vccnz k4_poll_128
k4_go_127:
    s_barrier
    buffer_load_dwordx4 v[76:79], v10, s[56:59], s49 offen sc1
    s_add_u32 s49, s49, 0x20000
    buffer_load_dwordx4 v[80:83], v10, s[56:59], s49 offen sc1
    s_add_u32 s49, s49, 0x20000
    buffer_load_dwordx4 v[84:87], v10, s[56:59], s49 offen sc1
    s_add_u32 s49, s49, 0x20000
    buffer_load_dwordx4 v[88:91], v10, s[56:59], s49 offen sc1
    s_add_u32 s49, s49, 0x20000
    buffer_load_dwordx4 v[92:95], v10, s[56:59], s49 offen sc1
    s_add_u32 s49, s49, 0x20000
    buffer_load_dwordx4 v[96:99], v10, s[56:59], s49 offen sc1
    s_add_u32 s49, s49, 0x20000
    buffer_load_dwordx4 v[100:103], v10, s[56:59], s49 offen sc1
    s_add_u32 s49, s49, 0x20000
    buffer_load_dwordx4 v[104:107], v10, s[56:59], s49 offen sc1
    s_add_u32 s49, s49, 0x20000
    buffer_load_dwordx4 v[108:111], v10, s[56:59], s49 offen sc1
    s_add_u32 s49, s49, 0x20000
    buffer_load_dwordx4 v[112:115], v10, s[56:59], s49 offen sc1
    s_add_u32 s49, s49, 0x20000
    buffer_load_dwordx4 v[116:119], v10, s[56:59], s49 offen sc1
    s_add_u32 s49, s49, 0x20000
    buffer_load_dwordx4 v[120:123], v10, s[56:59], s49 offen sc1
    s_add_u32 s49, s49, 0x20000
    buffer_load_dwordx4 v[124:127], v10, s[56:59], s49 offen sc1
    s_add_u32 s49, s49, 0x20000
    buffer_load_dwordx4 v[128:131], v10, s[56:59], s49 offen sc1
    s_add_u32 s49, s49, 0x20000
    s_waitcnt vmcnt(12)
    v_pk_add_f32 v[76:77], v[76:77], v[80:81]
    v_pk_add_f32 v[78:79], v[78:79], v[82:83]
    s_waitcnt vmcnt(11)
    v_pk_add_f32 v[76:77], v[76:77], v[84:85]
    v_pk_add_f32 v[78:79], v[78:79], v[86:87]
    s_waitcnt vmcnt(10)
    v_pk_add_f32 v[76:77], v[76:77], v[88:89]
    v_pk_add_f32 v[78:79], v[78:79], v[90:91]
    s_waitcnt vmcnt(9)
    v_pk_add_f32 v[76:77], v[76:77], v[92:93]
    v_pk_add_f32 v[78:79], v[78:79], v[94:95]
    s_waitcnt vmcnt(8)
    v_pk_add_f32 v[76:77], v[76:77], v[96:97]
    v_pk_add_f32 v[78:79], v[78:79], v[98:99]
    s_waitcnt vmcnt(7)
    v_pk_add_f32 v[76:77], v[76:77], v[100:101]
    v_pk_add_f32 v[78:79], v[78:79], v[102:103]
    s_waitcnt vmcnt(6)
    v_pk_add_f32 v[76:77], v[76:77], v[104:105]
    v_pk_add_f32 v[78:79], v[78:79], v[106:107]
    s_waitcnt vmcnt(5)
    v_pk_add_f32 v[76:77], v[76:77], v[108:109]
    v_pk_add_f32 v[78:79], v[78:79], v[110:111]
    s_waitcnt vmcnt(4)
    v_pk_add_f32 v[76:77], v[76:77], v[112:113]
    v_pk_add_f32 v[78:79], v[78:79], v[114:115]
    s_waitcnt vmcnt(3)
    v_pk_add_f32 v[76:77], v[76:77], v[116:117]
    v_pk_add_f32 v[78:79], v[78:79], v[118:119]
    s_waitcnt vmcnt(2)
    v_pk_add_f32 v[76:77], v[76:77], v[120:121]
    v_pk_add_f32 v[78:79], v[78:79], v[122:123]
    s_waitcnt vmcnt(1)
    v_pk_add_f32 v[76:77], v[76:77], v[124:125]
    v_pk_add_f32 v[78:79], v[78:79], v[126:127]
    s_waitcnt vmcnt(0)
    v_pk_add_f32 v[76:77], v[76:77], v[128:129]
    v_pk_add_f32 v[78:79], v[78:79], v[130:131]
    v_mov_b32 v80, v76
    v_mov_b32 v81, v77
    v_mov_b32 v82, v78
    v_mov_b32 v83, v79
    s_nop 1
    v_permlane16_swap_b32 v76, v80
    v_permlane16_swap_b32 v77, v81
    v_permlane16_swap_b32 v78, v82
    v_permlane16_swap_b32 v79, v83
    s_nop 1
    v_add_f32 v76, v76, v80
    v_add_f32 v77, v77, v81
    v_add_f32 v78, v78, v82
    v_add_f32 v79, v79, v83
    v_mov_b32 v80, v76
    v_mov_b32 v81, v77
    v_mov_b32 v82, v78
    v_mov_b32 v83, v79
    s_nop 1
    v_permlane32_swap_b32 v76, v80
    v_permlane32_swap_b32 v77, v81
    v_permlane32_swap_b32 v78, v82
    v_permlane32_swap_b32 v79, v83
    s_nop 1
    v_add_f32 v76, v76, v80
    v_add_f32 v77, v77, v81
    v_add_f32 v78, v78, v82
    v_add_f32 v79, v79, v83
    v_lshlrev_b32 v14, 8, v1
    v_lshl_add_u32 v14, v8, 4, v14
    ds_write_b128 v14, v[76:79]
    s_waitcnt lgkmcnt(0)
    s_barrier
    v_lshlrev_b32 v14, 4, v8
    ds_read_b128 v[76:79], v14 offset:0
    ds_read_b128 v[80:83], v14 offset:256
    ds_read_b128 v[84:87], v14 offset:512
    ds_read_b128 v[88:91], v14 offset:768
    s_waitcnt lgkmcnt(0)
    v_pk_add_f32 v[76:77], v[76:77], v[80:81]
    v_pk_add_f32 v[78:79], v[78:79], v[82:83]
    v_pk_add_f32 v[76:77], v[76:77], v[84:85]
    v_pk_add_f32 v[78:79], v[78:79], v[86:87]
    v_pk_add_f32 v[76:77], v[76:77], v[88:89]
    v_pk_add_f32 v[78:79], v[78:79], v[90:91]
    v_cvt_pk_bf16_f32 v20, v76, v77
    v_lshlrev_b32 v21, 16, v20
    v_and_b32 v22, 0xffff0000, v20
    v_mul_f32 v21, s51, v21
    v_mul_f32 v22, s51, v22
    v_cvt_pk_bf16_f32 v20, v21, v22
    v_lshlrev_b32 v21, 16, v20
    v_and_b32 v22, 0xffff0000, v20
    v_lshlrev_b32 v23, 16, v72
    v_and_b32 v24, 0xffff0000, v72
    v_add_f32 v21, v21, v23
    v_add_f32 v22, v22, v24
    v_cvt_pk_bf16_f32 v20, v21, v22
    v_lshlrev_b32 v21, 16, v20
    v_and_b32 v22, 0xffff0000, v20
    v_lshlrev_b32 v23, 16, v74
    v_and_b32 v24, 0xffff0000, v74
    v_add_f32 v21, v21, v23
    v_add_f32 v22, v22, v24
    v_cvt_pk_bf16_f32 v26, v21, v22
    v_cvt_pk_bf16_f32 v20, v78, v79
    v_lshlrev_b32 v21, 16, v20
    v_and_b32 v22, 0xffff0000, v20
    v_mul_f32 v21, s51, v21
    v_mul_f32 v22, s51, v22
    v_cvt_pk_bf16_f32 v20, v21, v22
    v_lshlrev_b32 v21, 16, v20
    v_and_b32 v22, 0xffff0000, v20
    v_lshlrev_b32 v23, 16, v73
    v_and_b32 v24, 0xffff0000, v73
    v_add_f32 v21, v21, v23
    v_add_f32 v22, v22, v24
    v_cvt_pk_bf16_f32 v20, v21, v22
    v_lshlrev_b32 v21, 16, v20
    v_and_b32 v22, 0xffff0000, v20
    v_lshlrev_b32 v23, 16, v75
    v_and_b32 v24, 0xffff0000, v75
    v_add_f32 v21, v21, v23
    v_add_f32 v22, v22, v24
    v_cvt_pk_bf16_f32 v27, v21, v22
    v_cmp_gt_u32 vcc, 16, v0
    s_and_saveexec_b64 s[52:53], vcc
    s_cbranch_execz k4_skip_130
    buffer_store_dwordx2 v[26:27], v9, s[28:31], s46 offen sc1
k4_skip_130:
    s_mov_b64 exec, s[52:53]
    s_cmp_lg_u32 s30, 0
    s_cbranch_scc1 k4_fin_131
    s_branch k4_again_129
k4_fin_131:
    s_endpgm
k4_b_121:
    v_lshl_add_u32 v6, v1, 1, v5
    s_lshl_b32 s47, s2, 3
    s_sub_u32 s47, s47, 8
    v_add_u32 v6, s47, v6
    v_lshl_add_u32 v6, v6, 11, v7
    s_mov_b32 s36, s12
    s_and_b32 s37, s13, 0xffff
    s_mov_b32 s38, 0x400000
    s_mov_b32 s39, 0x00020000
    s_cmp_ge_u32 s2, 224
    s_cbranch_scc1 k4_noffn_132
    s_add_u32 s24, s14, 0x6000000
    s_addc_u32 s25, s15, 0
    s_and_b32 s25, s25, 0xffff
    s_mov_b32 s26, 0x1000000
    s_mov_b32 s27, 0x00020000
    s_and_b32 s50, s44, 3
    s_lshl_b32 s50, s50, 13
    s_lshl_b32 s52, s45, 15
    s_add_u32 s52, s52, s50
    v_lshlrev_b32 v8, 4, v2
    s_add_u32 m0, s50, 0
    s_add_u32 s53, s52, 0
    buffer_load_dwordx4 v8, s[24:27], s53 offen offset:0 lds
    buffer_load_dwordx4 v8, s[24:27], s53 offen offset:1024 lds
    buffer_load_dwordx4 v8, s[24:27], s53 offen offset:2048 lds
    buffer_load_dwordx4 v8, s[24:27], s53 offen offset:3072 lds
    s_add_u32 m0, s50, 4096
    s_add_u32 s53, s52, 4096
    buffer_load_dwordx4 v8, s[24:27], s53 offen offset:0 lds
    buffer_load_dwordx4 v8, s[24:27], s53 offen offset:1024 lds
    buffer_load_dwordx4 v8, s[24:27], s53 offen offset:2048 lds
    buffer_load_dwordx4 v8, s[24:27], s53 offen offset:3072 lds
    s_add_u32 m0, s50, 32768
    s_add_u32 s53, s52, 8388608
    buffer_load_dwordx4 v8, s[24:27], s53 offen offset:0 lds
    buffer_load_dwordx4 v8, s[24:27], s53 offen offset:1024 lds
    buffer_load_dwordx4 v8, s[24:27], s53 offen offset:2048 lds
    buffer_load_dwordx4 v8, s[24:27], s53 offen offset:3072 lds
    s_add_u32 m0, s50, 36864
    s_add_u32 s53, s52, 8392704
    buffer_load_dwordx4 v8, s[24:27], s53 offen offset:0 lds
    buffer_load_dwordx4 v8, s[24:27], s53 offen offset:1024 lds
    buffer_load_dwordx4 v8, s[24:27], s53 offen offset:2048 lds
    buffer_load_dwordx4 v8, s[24:27], s53 offen offset:3072 lds
k4_noffn_132:
    buffer_load_dwordx4 v[40:43], v6, s[20:23], 0 offen offset:0
    buffer_load_dwordx4 v[44:47], v6, s[20:23], 0 offen offset:512
    buffer_load_dwordx4 v[48:51], v6, s[20:23], 0 offen offset:1024
    buffer_load_dwordx4 v[52:55], v6, s[20:23], 0 offen offset:1536
    s_waitcnt vmcnt(0)
    s_branch k4_mm_123
k4_bout_124:
    v_mov_b32 v12, 69760
    ds_read_b64 v[12:13], v12
    v_lshrrev_b32 v14, 11, v6
    v_lshlrev_b32 v160, 16, v40
    v_and_b32 v161, 0xffff0000, v40
    v_lshlrev_b32 v162, 16, v41
    v_and_b32 v163, 0xffff0000, v41
    v_lshlrev_b32 v164, 16, v42
    v_and_b32 v165, 0xffff0000, v42
    v_lshlrev_b32 v166, 16, v43
    v_and_b32 v167, 0xffff0000, v43
    v_lshlrev_b32 v168, 16, v44
    v_and_b32 v169, 0xffff0000, v44
    v_lshlrev_b32 v170, 16, v45
    v_and_b32 v171, 0xffff0000, v45
    v_lshlrev_b32 v172, 16, v46
    v_and_b32 v173, 0xffff0000, v46
    v_lshlrev_b32 v174, 16, v47
    v_and_b32 v175, 0xffff0000, v47
    v_lshlrev_b32 v176, 16, v48
    v_and_b32 v177, 0xffff0000, v48
    v_lshlrev_b32 v178, 16, v49
    v_and_b32 v179, 0xffff0000, v49
    v_lshlrev_b32 v180, 16, v50
    v_and_b32 v181, 0xffff0000, v50
    v_lshlrev_b32 v182, 16, v51
    v_and_b32 v183, 0xffff0000, v51
    v_lshlrev_b32 v184, 16, v52
    v_and_b32 v185, 0xffff0000, v52
    v_lshlrev_b32 v186, 16, v53
    v_and_b32 v187, 0xffff0000, v53
    v_lshlrev_b32 v188, 16, v54
    v_and_b32 v189, 0xffff0000, v54
    v_lshlrev_b32 v190, 16, v55
    v_and_b32 v191, 0xffff0000, v55
    v_pk_add_f32 v[160:161], v[160:161], v[200:201]
    v_pk_add_f32 v[162:163], v[162:163], v[202:203]
    v_pk_add_f32 v[164:165], v[164:165], v[204:205]
    v_pk_add_f32 v[166:167], v[166:167], v[206:207]
    v_pk_add_f32 v[168:169], v[168:169], v[208:209]
    v_pk_add_f32 v[170:171], v[170:171], v[210:211]
    v_pk_add_f32 v[172:173], v[172:173], v[212:213]
    v_pk_add_f32 v[174:175], v[174:175], v[214:215]
    v_pk_add_f32 v[176:177], v[176:177], v[216:217]
    v_pk_add_f32 v[178:179], v[178:179], v[218:219]
    v_pk_add_f32 v[180:181], v[180:181], v[220:221]
    v_pk_add_f32 v[182:183], v[182:183], v[222:223]
    v_pk_add_f32 v[184:185], v[184:185], v[224:225]
    v_pk_add_f32 v[186:187], v[186:187], v[226:227]
    v_pk_add_f32 v[188:189], v[188:189], v[228:229]
    v_pk_add_f32 v[190:191], v[190:191], v[230:231]
    v_cvt_pk_bf16_f32 v40, v160, v161
    v_cvt_pk_bf16_f32 v41, v162, v163
    v_cvt_pk_bf16_f32 v42, v164, v165
    v_cvt_pk_bf16_f32 v43, v166, v167
    v_cvt_pk_bf16_f32 v44, v168, v169
    v_cvt_pk_bf16_f32 v45, v170, v171
    v_cvt_pk_bf16_f32 v46, v172, v173
    v_cvt_pk_bf16_f32 v47, v174, v175
    v_cvt_pk_bf16_f32 v48, v176, v177
    v_cvt_pk_bf16_f32 v49, v178, v179
    v_cvt_pk_bf16_f32 v50, v180, v181
    v_cvt_pk_bf16_f32 v51, v182, v183
    v_cvt_pk_bf16_f32 v52, v184, v185
    v_cvt_pk_bf16_f32 v53, v186, v187
    v_cvt_pk_bf16_f32 v54, v188, v189
    v_cvt_pk_bf16_f32 v55, v190, v191
    s_waitcnt lgkmcnt(0)
    v_cmp_eq_u32 vcc, v12, v14
    v_cmp_eq_u32 s[52:53], v13, v14
    v_mov_b32 v12, 0x7fffffff
    s_or_b64 vcc, vcc, s[52:53]
    v_cndmask_b32 v6, v6, v12, vcc
    buffer_store_dwordx4 v[40:43], v6, s[36:39], 0 offen offset:0 sc1
    buffer_store_dwordx4 v[44:47], v6, s[36:39], 0 offen offset:512 sc1
    buffer_store_dwordx4 v[48:51], v6, s[36:39], 0 offen offset:1024 sc1
    buffer_store_dwordx4 v[52:55], v6, s[36:39], 0 offen offset:1536 sc1
k4_end_120:
    s_endpgm
code_end:
    s_endpgm
.section .rodata,"a"
.p2align 6
.amdhsa_kernel k12_kernel
  .amdhsa_next_free_vgpr 512
  .amdhsa_next_free_sgpr 102
  .amdhsa_accum_offset 256
  .amdhsa_group_segment_fixed_size 0
  .amdhsa_kernarg_size 112
  .amdhsa_user_sgpr_count 2
  .amdhsa_user_sgpr_kernarg_segment_ptr 1
  .amdhsa_system_sgpr_workgroup_id_x 1
.end_amdhsa_kernel
.p2align 6
.amdhsa_kernel k3_kernel
  .amdhsa_next_free_vgpr 348
  .amdhsa_next_free_sgpr 102
  .amdhsa_accum_offset 156
  .amdhsa_group_segment_fixed_size 0
  .amdhsa_kernarg_size 112
  .amdhsa_user_sgpr_count 2
  .amdhsa_user_sgpr_kernarg_segment_ptr 1
  .amdhsa_system_sgpr_workgroup_id_x 1
.end_amdhsa_kernel
.p2align 6
.amdhsa_kernel k4_kernel
  .amdhsa_next_free_vgpr 232
  .amdhsa_next_free_sgpr 102
  .amdhsa_accum_offset 232
  .amdhsa_group_segment_fixed_size 0
  .amdhsa_kernarg_size 112
  .amdhsa_user_sgpr_count 2
  .amdhsa_user_sgpr_kernarg_segment_ptr 1
  .amdhsa_system_sgpr_workgroup_id_x 1
  .amdhsa_float_denorm_mode_32 3
.end_amdhsa_kernel
```

```asm
; @launch kernel=k12_kernel grid=(256,1,1) block=(256,1,1) lds=163840
; @launch kernel=k4_kernel grid=(256,1,1) block=(512,1,1) lds=86272
.amdgcn_target "amdgcn-amd-amdhsa--gfx950"
.text
.globl k12_kernel
.p2align 8
.type k12_kernel,@function
k12_kernel:
    s_cmp_ge_u32 s2, 256
    s_cbranch_scc1 k12_end_1
    s_load_dwordx4 s[36:39], s[0:1], 0
    s_load_dwordx4 s[40:43], s[0:1], 24
    s_load_dwordx2 s[4:5], s[0:1], 16
    s_load_dwordx4 s[60:63], s[0:1], 96
    s_lshr_b32 s59, s2, 3
    s_lshl_b32 s58, s59, 4
    v_add_u32 v6, s58, v0
    v_cmp_gt_u32 vcc, 48, v0
    v_cmp_gt_u32 s[56:57], 64, v0
    s_nop 0
    v_cndmask_b32 v6, v6, v0, vcc
    s_getpc_b64 s[52:53]
pc_2:
    s_add_u32 s52, s52, k12_code0-pc_2
    s_addc_u32 s53, s53, 0
    v_lshlrev_b32 v58, 7, v6
    v_mov_b32 v59, s53
    v_add_co_u32 v58, vcc, s52, v58
    s_nop 1
    v_addc_co_u32 v59, vcc, 0, v59, vcc
k12_code0:
    s_mov_b64 exec, s[56:57]
    s_cbranch_execz k12_nocode_3
    global_load_dword v51, v[58:59], off
k12_nocode_3:
    s_mov_b64 exec, -1
    s_and_b32 s58, s2, 7
    s_lshr_b32 s59, s2, 3
    s_and_b32 s45, s59, 7
    s_lshr_b32 s57, s59, 3
    s_and_b32 s44, s57, 1
    s_lshl_b32 s52, s58, 1
    s_add_u32 s44, s44, s52
    s_lshr_b32 s57, s57, 1
    v_lshrrev_b32 v2, 6, v0
    v_and_b32 v3, 63, v0
    v_readfirstlane_b32 s30, v2
    v_lshlrev_b32 v1, 4, v3
    v_lshrrev_b32 v60, 5, v3
    v_lshl_add_u32 v60, v2, 1, v60
    v_and_b32 v61, 31, v3
    v_lshlrev_b32 v6, 11, v60
    v_lshl_add_u32 v62, v61, 4, v6
    s_lshl_b32 s52, s2, 14
    v_lshrrev_b32 v56, 3, v3
    v_and_b32 v57, 7, v3
    v_lshrrev_b32 v58, 1, v56
    v_xor_b32 v6, v57, v58
    v_xor_b32 v7, 4, v6
    v_lshl_add_u32 v58, v2, 6, v56
    v_lshlrev_b32 v58, 10, v58
    s_lshl_b32 s47, s45, 18
    v_add_u32 v58, s47, v58
    v_lshl_add_u32 v10, v6, 4, v58
    v_lshl_add_u32 v11, v7, 4, v58
    v_add_u32 v17, 54272, v11
    v_add_u32 v16, 47104, v10
    v_add_u32 v15, 39936, v11
    v_add_u32 v14, 32768, v10
    v_add_u32 v13, 21504, v11
    v_add_u32 v12, 14336, v10
    v_add_u32 v11, 7168, v11
    v_add_u32 v10, 0, v10
    v_lshrrev_b32 v6, 5, v3
    v_bfe_u32 v7, v3, 1, 4
    v_and_b32 v59, 1, v3
    v_lshl_add_u32 v58, v2, 4, v6
    v_lshlrev_b32 v58, 13, v58
    v_lshl_add_u32 v58, v59, 4, v58
    s_lshl_b32 s47, s44, 9
    v_add_u32 v58, s47, v58
    v_xor_b32 v7, v7, v6
    v_xor_b32 v6, 0, v7
    v_lshl_add_u32 v6, v6, 5, v58
    v_add_u32 v18, 0, v6
    v_xor_b32 v6, 2, v7
    v_lshl_add_u32 v6, v6, 5, v58
    v_add_u32 v19, 15360, v6
    v_xor_b32 v6, 0, v7
    v_lshl_add_u32 v6, v6, 5, v58
    v_add_u32 v20, 30720, v6
    v_xor_b32 v6, 2, v7
    v_lshl_add_u32 v6, v6, 5, v58
    v_add_u32 v21, 46080, v6
    v_xor_b32 v6, 4, v7
    v_lshl_add_u32 v6, v6, 5, v58
    v_add_u32 v22, 65536, v6
    v_xor_b32 v6, 6, v7
    v_lshl_add_u32 v6, v6, 5, v58
    v_add_u32 v23, 80896, v6
    v_xor_b32 v6, 4, v7
    v_lshl_add_u32 v6, v6, 5, v58
    v_add_u32 v24, 96256, v6
    v_xor_b32 v6, 6, v7
    v_lshl_add_u32 v6, v6, 5, v58
    v_add_u32 v25, 111616, v6
    s_lshl_b32 s48, s30, 13
    s_mov_b32 s49, 0
    s_mov_b32 s50, 0
    s_waitcnt lgkmcnt(0)
    s_mov_b32 s24, s36
    s_and_b32 s25, s37, 0xffff
    s_mov_b32 s26, 0x400000
    s_mov_b32 s27, 0x00020000
    buffer_load_dwordx4 v[64:67], v62, s[24:27], s52 offen offset:0
    buffer_load_dwordx4 v[68:71], v62, s[24:27], s52 offen offset:512
    buffer_load_dwordx4 v[72:75], v62, s[24:27], s52 offen offset:1024
    buffer_load_dwordx4 v[76:79], v62, s[24:27], s52 offen offset:1536
    s_mov_b32 s16, s38
    s_and_b32 s17, s39, 0xffff
    s_mov_b32 s18, 0x200000
    s_mov_b32 s19, 0x00020000
    s_cmp_eq_u32 s57, 0
    s_cselect_b32 s20, s40, s42
    s_cselect_b32 s21, s41, s43
    s_and_b32 s21, s21, 0xffff
    s_mov_b32 s22, 0x400000
    s_mov_b32 s23, 0x00020000
    s_add_u32 m0, s48, 0
    s_nop 0
    buffer_load_dwordx4 v10, s[16:19], s49 offen offset:0 lds
    buffer_load_dwordx4 v11, s[16:19], s49 offen offset:1024 lds
    buffer_load_dwordx4 v12, s[16:19], s49 offen offset:2048 lds
    buffer_load_dwordx4 v13, s[16:19], s49 offen offset:3072 lds
    s_add_u32 m0, s48, 65536
    s_nop 0
    buffer_load_dwordx4 v18, s[20:23], s50 offen offset:0 lds
    buffer_load_dwordx4 v19, s[20:23], s50 offen offset:1024 lds
    buffer_load_dwordx4 v20, s[20:23], s50 offen offset:2048 lds
    buffer_load_dwordx4 v21, s[20:23], s50 offen offset:3072 lds
    s_mov_b64 s[6:7], s[62:63]
    s_add_u32 s8, s6, 0x0
    s_addc_u32 s9, s7, 0
    s_and_b32 s9, s9, 0xffff
    s_mov_b32 s10, 0x400000
    s_mov_b32 s11, 0x00020000
    s_mov_b32 s12, s4
    s_and_b32 s13, s5, 0xffff
    s_mov_b32 s14, 0x800000
    s_mov_b32 s15, 0x00020000
    s_add_u32 s32, s6, 0x1000000
    s_addc_u32 s33, s7, 0
    s_and_b32 s33, s33, 0xffff
    s_mov_b32 s34, 0x2000000
    s_mov_b32 s35, 0x00020000
    s_mov_b32 s24, s60
    s_and_b32 s25, s61, 0xffff
    s_mov_b32 s26, 0x100
    s_mov_b32 s27, 0x00020000
    s_lshl_b32 s28, s58, 2
    s_and_b32 s31, s59, 3
    s_add_u32 s28, s28, s31
    s_lshr_b32 s29, s59, 2
    s_lshl_b32 s42, s29, 7
    s_sub_u32 s43, 1920, s42
    s_lshl_b32 s31, s30, 4
    s_add_u32 s38, s42, s31
    s_add_u32 s39, s43, s31
    s_lshl_b32 s60, s30, 12
    s_mov_b32 s61, 0
    s_mov_b32 s62, 0
    s_lshl_b32 s47, s44, 1
    s_lshr_b32 s52, s30, 1
    s_add_u32 s47, s47, s52
    s_lshl_b32 s47, s47, 14
    s_lshl_b32 s52, s45, 1
    s_and_b32 s53, s30, 1
    s_add_u32 s52, s52, s53
    s_lshl_b32 s52, s52, 20
    s_add_u32 s47, s47, s52
    s_lshl_b32 s52, s57, 24
    s_add_u32 s47, s47, s52
    s_lshl_b32 s54, s44, 8
    s_lshr_b32 s55, s28, 1
    s_lshl_b32 s55, s55, 8
    s_and_b32 s53, s59, 3
    s_add_u32 s53, s53, 1
    s_cmp_eq_u32 s30, 0
    s_cselect_b32 s53, s53, -1
    s_cselect_b32 s46, 6, -1
    v_lshlrev_b32 v6, 13, v56
    v_lshl_add_u32 v50, v57, 7, v6
    s_lshl_b32 s56, s30, 5
    s_add_u32 s56, s56, s59
    s_lshl_b32 s56, s56, 16
    s_lshl_b32 s52, s58, 10
    s_add_u32 s56, s56, s52
    s_lshl_b32 s63, s30, 1
    v_mul_u32_u24 v6, 2064, v60
    v_lshl_add_u32 v6, v61, 4, v6
    v_add_u32 v54, 131072, v6
    v_mul_u32_u24 v7, 2064, v57
    v_lshl_add_u32 v7, v56, 4, v7
    v_lshl_add_u32 v7, v2, 9, v7
    v_add_u32 v55, 131072, v7
    v_lshrrev_b32 v7, 2, v56
    v_lshl_add_u32 v7, v2, 3, v7
    v_lshlrev_b32 v7, 17, v7
    v_and_b32 v6, 3, v56
    v_lshl_add_u32 v7, v6, 8, v7
    v_lshl_add_u32 v7, v57, 4, v7
    s_lshr_b32 s52, s2, 1
    s_lshl_b32 s52, s52, 10
    s_and_b32 s31, s2, 1
    s_lshl_b32 s31, s31, 7
    s_add_u32 s52, s52, s31
    v_add_u32 v53, s52, v7
    v_and_b32 v56, 15, v3
    v_lshrrev_b32 v57, 4, v3
    v_lshrrev_b32 v6, 1, v56
    v_xor_b32 v6, v6, v57
    v_and_b32 v7, 1, v2
    v_lshl_add_u32 v7, v7, 7, v56
    v_lshlrev_b32 v7, 7, v7
    v_lshl_add_u32 v26, v6, 4, v7
    v_xor_b32 v27, 64, v26
    v_lshrrev_b32 v6, 2, v56
    v_and_b32 v58, 1, v57
    v_lshl_add_u32 v58, v58, 2, v6
    v_lshl_add_u32 v59, v57, 3, v6
    v_and_b32 v63, 3, v3
    v_lshlrev_b32 v7, 9, v59
    v_lshrrev_b32 v6, 1, v2
    v_lshl_add_u32 v7, v6, 8, v7
    v_lshl_add_u32 v7, v63, 3, v7
    v_add_u32 v7, 65536, v7
    v_lshlrev_b32 v59, 8, v59
    v_lshl_add_u32 v59, v63, 3, v59
    v_add_u32 v59, 98304, v59
    v_xor_b32 v6, 0, v58
    v_lshl_add_u32 v28, v6, 5, v7
    v_lshl_add_u32 v42, v6, 5, v59
    v_xor_b32 v6, 1, v58
    v_lshl_add_u32 v29, v6, 5, v7
    v_lshl_add_u32 v43, v6, 5, v59
    v_xor_b32 v6, 2, v58
    v_lshl_add_u32 v30, v6, 5, v7
    v_lshl_add_u32 v44, v6, 5, v59
    v_xor_b32 v6, 3, v58
    v_lshl_add_u32 v31, v6, 5, v7
    v_lshl_add_u32 v45, v6, 5, v59
    v_xor_b32 v6, 4, v58
    v_lshl_add_u32 v32, v6, 5, v7
    v_lshl_add_u32 v46, v6, 5, v59
    v_xor_b32 v6, 5, v58
    v_lshl_add_u32 v33, v6, 5, v7
    v_lshl_add_u32 v47, v6, 5, v59
    v_xor_b32 v6, 6, v58
    v_lshl_add_u32 v34, v6, 5, v7
    v_lshl_add_u32 v48, v6, 5, v59
    v_xor_b32 v6, 7, v58
    v_lshl_add_u32 v35, v6, 5, v7
    v_lshl_add_u32 v49, v6, 5, v59
    s_lshl_b32 s31, s38, 6
    v_add_u32 v36, s31, v1
    s_lshl_b32 s31, s39, 6
    v_add_u32 v37, s31, v1
    v_bfe_u32 v6, v3, 1, 3
    v_and_b32 v7, 1, v3
    v_lshl_add_u32 v58, v2, 4, v57
    v_lshlrev_b32 v58, 13, v58
    v_lshl_add_u32 v58, v7, 4, v58
    s_lshl_b32 s31, s28, 8
    v_add_u32 v58, s31, v58
    v_xor_b32 v6, v6, v57
    v_xor_b32 v7, 0, v6
    v_lshl_add_u32 v7, v7, 5, v58
    v_add_u32 v38, 0, v7
    v_xor_b32 v7, 0, v6
    v_lshl_add_u32 v7, v7, 5, v58
    v_add_u32 v39, 31744, v7
    v_xor_b32 v7, 4, v6
    v_lshl_add_u32 v7, v7, 5, v58
    v_add_u32 v40, 63488, v7
    v_xor_b32 v7, 4, v6
    v_lshl_add_u32 v7, v7, 5, v58
    v_add_u32 v41, 95232, v7
    v_lshlrev_b32 v6, 2, v57
    v_sub_u32 v4, v56, v6
    v_mov_b32 v5, 0xff800000
    v_mov_b32 v8, 0
    v_mov_b32 v9, 1
    s_lshl_b32 s52, s59, 2
    s_add_u32 s52, s52, s30
    v_and_b32 v6, 1, v3
    v_lshl_add_u32 v6, s52, 1, v6
    s_getpc_b64 s[40:41]
pc_4:
    s_add_u32 s40, s40, k12_qcode-pc_4
    s_addc_u32 s41, s41, 0
    v_lshlrev_b32 v2, 7, v6
    v_mov_b32 v3, s41
    v_add_co_u32 v2, vcc, s40, v2
    s_nop 1
    v_addc_co_u32 v3, vcc, 0, v3, vcc
    v_mov_b32 v56, 0
    v_mov_b32 v57, 0
    v_mov_b32 v58, 0
    v_mov_b32 v59, 0
    s_nop 1
    v_mfma_f32_32x32x16_bf16 a[128:143], v[56:59], v[56:59], 0
    v_mfma_f32_32x32x16_bf16 a[144:159], v[56:59], v[56:59], 0
    v_mfma_f32_32x32x16_bf16 a[160:175], v[56:59], v[56:59], 0
    v_mfma_f32_32x32x16_bf16 a[176:191], v[56:59], v[56:59], 0
    v_mfma_f32_32x32x16_bf16 v[128:143], v[56:59], v[56:59], 0
    v_mfma_f32_32x32x16_bf16 v[144:159], v[56:59], v[56:59], 0
    v_mfma_f32_32x32x16_bf16 v[160:175], v[56:59], v[56:59], 0
    v_mfma_f32_32x32x16_bf16 v[176:191], v[56:59], v[56:59], 0
    v_mfma_f32_32x32x16_bf16 v[192:207], v[56:59], v[56:59], 0
    v_mfma_f32_32x32x16_bf16 v[208:223], v[56:59], v[56:59], 0
    v_mfma_f32_32x32x16_bf16 v[224:239], v[56:59], v[56:59], 0
    v_mfma_f32_32x32x16_bf16 v[240:255], v[56:59], v[56:59], 0
    s_add_u32 m0, s48, 4096
    s_nop 0
    buffer_load_dwordx4 v14, s[16:19], s49 offen offset:0 lds
    buffer_load_dwordx4 v15, s[16:19], s49 offen offset:1024 lds
    buffer_load_dwordx4 v16, s[16:19], s49 offen offset:2048 lds
    buffer_load_dwordx4 v17, s[16:19], s49 offen offset:3072 lds
    s_add_u32 s49, s49, 128
    s_add_u32 m0, s48, 69632
    s_nop 0
    buffer_load_dwordx4 v22, s[20:23], s50 offen offset:0 lds
    buffer_load_dwordx4 v23, s[20:23], s50 offen offset:1024 lds
    buffer_load_dwordx4 v24, s[20:23], s50 offen offset:2048 lds
    buffer_load_dwordx4 v25, s[20:23], s50 offen offset:3072 lds
    s_add_u32 s50, s50, 0x80000
    s_waitcnt vmcnt(16)
    v_lshlrev_b32 v80, 16, v64
    v_and_b32 v81, 0xffff0000, v64
    v_lshlrev_b32 v82, 16, v65
    v_and_b32 v83, 0xffff0000, v65
    v_lshlrev_b32 v84, 16, v66
    v_and_b32 v85, 0xffff0000, v66
    v_lshlrev_b32 v86, 16, v67
    v_and_b32 v87, 0xffff0000, v67
    v_lshlrev_b32 v88, 16, v68
    v_and_b32 v89, 0xffff0000, v68
    v_lshlrev_b32 v90, 16, v69
    v_and_b32 v91, 0xffff0000, v69
    v_lshlrev_b32 v92, 16, v70
    v_and_b32 v93, 0xffff0000, v70
    v_lshlrev_b32 v94, 16, v71
    v_and_b32 v95, 0xffff0000, v71
    v_lshlrev_b32 v96, 16, v72
    v_and_b32 v97, 0xffff0000, v72
    v_lshlrev_b32 v98, 16, v73
    v_and_b32 v99, 0xffff0000, v73
    v_lshlrev_b32 v100, 16, v74
    v_and_b32 v101, 0xffff0000, v74
    v_lshlrev_b32 v102, 16, v75
    v_and_b32 v103, 0xffff0000, v75
    v_lshlrev_b32 v104, 16, v76
    v_and_b32 v105, 0xffff0000, v76
    v_lshlrev_b32 v106, 16, v77
    v_and_b32 v107, 0xffff0000, v77
    v_lshlrev_b32 v108, 16, v78
    v_and_b32 v109, 0xffff0000, v78
    v_lshlrev_b32 v110, 16, v79
    v_and_b32 v111, 0xffff0000, v79
    v_pk_add_f32 v[112:113], v[80:81], v[82:83]
    v_pk_add_f32 v[114:115], v[84:85], v[86:87]
    v_pk_add_f32 v[112:113], v[112:113], v[88:89]
    v_pk_add_f32 v[114:115], v[114:115], v[90:91]
    v_pk_add_f32 v[112:113], v[112:113], v[92:93]
    v_pk_add_f32 v[114:115], v[114:115], v[94:95]
    v_pk_add_f32 v[112:113], v[112:113], v[96:97]
    v_pk_add_f32 v[114:115], v[114:115], v[98:99]
    v_pk_add_f32 v[112:113], v[112:113], v[100:101]
    v_pk_add_f32 v[114:115], v[114:115], v[102:103]
    v_pk_add_f32 v[112:113], v[112:113], v[104:105]
    v_pk_add_f32 v[114:115], v[114:115], v[106:107]
    s_add_u32 m0, s48, 32768
    s_nop 0
    buffer_load_dwordx4 v10, s[16:19], s49 offen offset:0 lds
    buffer_load_dwordx4 v11, s[16:19], s49 offen offset:1024 lds
    buffer_load_dwordx4 v12, s[16:19], s49 offen offset:2048 lds
    buffer_load_dwordx4 v13, s[16:19], s49 offen offset:3072 lds
    v_pk_add_f32 v[112:113], v[112:113], v[108:109]
    v_pk_add_f32 v[114:115], v[114:115], v[110:111]
    v_pk_add_f32 v[112:113], v[112:113], v[114:115]
    v_add_f32 v112, v112, v113
    s_nop 1
    v_add_f32_dpp v112, v112, v112 quad_perm:[1,0,3,2] row_mask:0xf bank_mask:0xf
    s_nop 1
    v_add_f32_dpp v112, v112, v112 quad_perm:[2,3,0,1] row_mask:0xf bank_mask:0xf
    s_nop 1
    v_add_f32_dpp v112, v112, v112 row_half_mirror row_mask:0xf bank_mask:0xf
    s_nop 1
    v_add_f32_dpp v112, v112, v112 row_mirror row_mask:0xf bank_mask:0xf
    v_mov_b32 v114, v112
    s_nop 1
    v_permlane16_swap_b32 v112, v114
    s_nop 1
    v_add_f32 v112, v112, v114
    v_mul_f32 v112, 0xba800000, v112
    v_mov_b32 v113, v112
    v_pk_add_f32 v[114:115], v[80:81], v[112:113]
    v_pk_add_f32 v[118:119], v[82:83], v[112:113]
    v_pk_mul_f32 v[116:117], v[114:115], v[114:115]
    v_pk_fma_f32 v[116:117], v[118:119], v[118:119], v[116:117]
    v_pk_add_f32 v[114:115], v[84:85], v[112:113]
    v_pk_add_f32 v[118:119], v[86:87], v[112:113]
    v_pk_fma_f32 v[116:117], v[114:115], v[114:115], v[116:117]
    v_pk_fma_f32 v[116:117], v[118:119], v[118:119], v[116:117]
    v_pk_add_f32 v[114:115], v[88:89], v[112:113]
    v_pk_add_f32 v[118:119], v[90:91], v[112:113]
    v_pk_fma_f32 v[116:117], v[114:115], v[114:115], v[116:117]
    v_pk_fma_f32 v[116:117], v[118:119], v[118:119], v[116:117]
    v_pk_add_f32 v[114:115], v[92:93], v[112:113]
    v_pk_add_f32 v[118:119], v[94:95], v[112:113]
    v_pk_fma_f32 v[116:117], v[114:115], v[114:115], v[116:117]
    v_pk_fma_f32 v[116:117], v[118:119], v[118:119], v[116:117]
    v_pk_add_f32 v[114:115], v[96:97], v[112:113]
    v_pk_add_f32 v[118:119], v[98:99], v[112:113]
    v_pk_fma_f32 v[116:117], v[114:115], v[114:115], v[116:117]
    v_pk_fma_f32 v[116:117], v[118:119], v[118:119], v[116:117]
    v_pk_add_f32 v[114:115], v[100:101], v[112:113]
    v_pk_add_f32 v[118:119], v[102:103], v[112:113]
    v_pk_fma_f32 v[116:117], v[114:115], v[114:115], v[116:117]
    v_pk_fma_f32 v[116:117], v[118:119], v[118:119], v[116:117]
    v_pk_add_f32 v[114:115], v[104:105], v[112:113]
    s_add_u32 m0, s48, 98304
    s_nop 0
    buffer_load_dwordx4 v18, s[20:23], s50 offen offset:0 lds
    buffer_load_dwordx4 v19, s[20:23], s50 offen offset:1024 lds
    buffer_load_dwordx4 v20, s[20:23], s50 offen offset:2048 lds
    buffer_load_dwordx4 v21, s[20:23], s50 offen offset:3072 lds
    v_pk_add_f32 v[118:119], v[106:107], v[112:113]
    v_pk_fma_f32 v[116:117], v[114:115], v[114:115], v[116:117]
    v_pk_fma_f32 v[116:117], v[118:119], v[118:119], v[116:117]
    v_pk_add_f32 v[114:115], v[108:109], v[112:113]
    v_pk_add_f32 v[118:119], v[110:111], v[112:113]
    v_pk_fma_f32 v[116:117], v[114:115], v[114:115], v[116:117]
    v_pk_fma_f32 v[116:117], v[118:119], v[118:119], v[116:117]
    v_add_f32 v116, v116, v117
    s_nop 1
    v_add_f32_dpp v116, v116, v116 quad_perm:[1,0,3,2] row_mask:0xf bank_mask:0xf
    s_nop 1
    v_add_f32_dpp v116, v116, v116 quad_perm:[2,3,0,1] row_mask:0xf bank_mask:0xf
    s_nop 1
    v_add_f32_dpp v116, v116, v116 row_half_mirror row_mask:0xf bank_mask:0xf
    s_nop 1
    v_add_f32_dpp v116, v116, v116 row_mirror row_mask:0xf bank_mask:0xf
    v_mov_b32 v114, v116
    s_nop 1
    v_permlane16_swap_b32 v116, v114
    s_nop 1
    v_add_f32 v116, v116, v114
    v_mul_f32 v116, 0x3a800000, v116
    v_cvt_pk_bf16_f32 v118, v112, v116
    v_and_b32 v116, 0xffff0000, v118
    v_lshlrev_b32 v118, 16, v118
    v_add_f32 v116, 0x3727c5ac, v116
    v_mov_b32 v119, v118
    v_cvt_pk_bf16_f32 v116, v116, v116
    v_and_b32 v116, 0xffff0000, v116
    v_sqrt_f32 v116, v116
    v_pk_add_f32 v[80:81], v[80:81], v[118:119]
    v_pk_add_f32 v[82:83], v[82:83], v[118:119]
    v_pk_add_f32 v[84:85], v[84:85], v[118:119]
    v_pk_add_f32 v[86:87], v[86:87], v[118:119]
    v_pk_add_f32 v[88:89], v[88:89], v[118:119]
    v_pk_add_f32 v[90:91], v[90:91], v[118:119]
    v_pk_add_f32 v[92:93], v[92:93], v[118:119]
    v_pk_add_f32 v[94:95], v[94:95], v[118:119]
    v_pk_add_f32 v[96:97], v[96:97], v[118:119]
    v_pk_add_f32 v[98:99], v[98:99], v[118:119]
    v_pk_add_f32 v[100:101], v[100:101], v[118:119]
    v_pk_add_f32 v[102:103], v[102:103], v[118:119]
    v_pk_add_f32 v[104:105], v[104:105], v[118:119]
    s_add_u32 m0, s48, 36864
    s_nop 0
    buffer_load_dwordx4 v14, s[16:19], s49 offen offset:0 lds
    buffer_load_dwordx4 v15, s[16:19], s49 offen offset:1024 lds
    buffer_load_dwordx4 v16, s[16:19], s49 offen offset:2048 lds
    buffer_load_dwordx4 v17, s[16:19], s49 offen offset:3072 lds
    s_add_u32 s49, s49, 128
    v_pk_add_f32 v[106:107], v[106:107], v[118:119]
    v_pk_add_f32 v[108:109], v[108:109], v[118:119]
    v_pk_add_f32 v[110:111], v[110:111], v[118:119]
    v_cvt_pk_bf16_f32 v116, v116, v116
    v_and_b32 v116, 0xffff0000, v116
    v_rcp_f32 v116, v116
    v_cvt_pk_bf16_f32 v64, v80, v81
    v_cvt_pk_bf16_f32 v65, v82, v83
    v_cvt_pk_bf16_f32 v66, v84, v85
    v_cvt_pk_bf16_f32 v67, v86, v87
    v_cvt_pk_bf16_f32 v68, v88, v89
    v_cvt_pk_bf16_f32 v69, v90, v91
    v_cvt_pk_bf16_f32 v70, v92, v93
    v_cvt_pk_bf16_f32 v71, v94, v95
    v_cvt_pk_bf16_f32 v72, v96, v97
    v_cvt_pk_bf16_f32 v73, v98, v99
    v_cvt_pk_bf16_f32 v74, v100, v101
    v_cvt_pk_bf16_f32 v75, v102, v103
    v_cvt_pk_bf16_f32 v76, v104, v105
    v_cvt_pk_bf16_f32 v77, v106, v107
    v_cvt_pk_bf16_f32 v78, v108, v109
    v_cvt_pk_bf16_f32 v79, v110, v111
    v_mov_b32 v117, v116
    v_lshlrev_b32 v80, 16, v64
    v_and_b32 v81, 0xffff0000, v64
    v_lshlrev_b32 v82, 16, v65
    v_and_b32 v83, 0xffff0000, v65
    v_lshlrev_b32 v84, 16, v66
    v_and_b32 v85, 0xffff0000, v66
    v_lshlrev_b32 v86, 16, v67
    v_and_b32 v87, 0xffff0000, v67
    v_lshlrev_b32 v88, 16, v68
    v_and_b32 v89, 0xffff0000, v68
    v_lshlrev_b32 v90, 16, v69
    v_and_b32 v91, 0xffff0000, v69
    v_lshlrev_b32 v92, 16, v70
    v_and_b32 v93, 0xffff0000, v70
    v_lshlrev_b32 v94, 16, v71
    v_and_b32 v95, 0xffff0000, v71
    v_lshlrev_b32 v96, 16, v72
    v_and_b32 v97, 0xffff0000, v72
    v_lshlrev_b32 v98, 16, v73
    v_and_b32 v99, 0xffff0000, v73
    v_lshlrev_b32 v100, 16, v74
    s_add_u32 m0, s48, 102400
    s_nop 0
    buffer_load_dwordx4 v22, s[20:23], s50 offen offset:0 lds
    buffer_load_dwordx4 v23, s[20:23], s50 offen offset:1024 lds
    buffer_load_dwordx4 v24, s[20:23], s50 offen offset:2048 lds
    buffer_load_dwordx4 v25, s[20:23], s50 offen offset:3072 lds
    s_add_u32 s50, s50, 0x80000
    v_and_b32 v101, 0xffff0000, v74
    v_lshlrev_b32 v102, 16, v75
    v_and_b32 v103, 0xffff0000, v75
    v_lshlrev_b32 v104, 16, v76
    v_and_b32 v105, 0xffff0000, v76
    v_lshlrev_b32 v106, 16, v77
    v_and_b32 v107, 0xffff0000, v77
    v_lshlrev_b32 v108, 16, v78
    v_and_b32 v109, 0xffff0000, v78
    v_lshlrev_b32 v110, 16, v79
    v_and_b32 v111, 0xffff0000, v79
    v_pk_mul_f32 v[80:81], v[80:81], v[116:117]
    v_pk_mul_f32 v[82:83], v[82:83], v[116:117]
    v_pk_mul_f32 v[84:85], v[84:85], v[116:117]
    v_pk_mul_f32 v[86:87], v[86:87], v[116:117]
    v_pk_mul_f32 v[88:89], v[88:89], v[116:117]
    v_pk_mul_f32 v[90:91], v[90:91], v[116:117]
    v_pk_mul_f32 v[92:93], v[92:93], v[116:117]
    v_pk_mul_f32 v[94:95], v[94:95], v[116:117]
    v_pk_mul_f32 v[96:97], v[96:97], v[116:117]
    v_pk_mul_f32 v[98:99], v[98:99], v[116:117]
    v_pk_mul_f32 v[100:101], v[100:101], v[116:117]
    v_pk_mul_f32 v[102:103], v[102:103], v[116:117]
    v_pk_mul_f32 v[104:105], v[104:105], v[116:117]
    v_pk_mul_f32 v[106:107], v[106:107], v[116:117]
    v_pk_mul_f32 v[108:109], v[108:109], v[116:117]
    v_pk_mul_f32 v[110:111], v[110:111], v[116:117]
    v_cvt_pk_bf16_f32 v64, v80, v81
    v_cvt_pk_bf16_f32 v65, v82, v83
    v_cvt_pk_bf16_f32 v66, v84, v85
    v_cvt_pk_bf16_f32 v67, v86, v87
    v_cvt_pk_bf16_f32 v68, v88, v89
    v_cvt_pk_bf16_f32 v69, v90, v91
    v_cvt_pk_bf16_f32 v70, v92, v93
    v_cvt_pk_bf16_f32 v71, v94, v95
    v_cvt_pk_bf16_f32 v72, v96, v97
    v_cvt_pk_bf16_f32 v73, v98, v99
    v_cvt_pk_bf16_f32 v74, v100, v101
    v_cvt_pk_bf16_f32 v75, v102, v103
    v_cvt_pk_bf16_f32 v76, v104, v105
    v_cvt_pk_bf16_f32 v77, v106, v107
    v_cvt_pk_bf16_f32 v78, v108, v109
    v_cvt_pk_bf16_f32 v79, v110, v111
    ds_write_b128 v54, v[64:67] offset:0
    ds_write_b128 v54, v[68:71] offset:512
    ds_write_b128 v54, v[72:75] offset:1024
    ds_write_b128 v54, v[76:79] offset:1536
    s_waitcnt vmcnt(16) lgkmcnt(0)
    s_barrier
    ds_read_b128 a[192:195], v55 offset:0
    ds_read_b128 a[196:199], v55 offset:128
    ds_read_b128 a[200:203], v55 offset:256
    ds_read_b128 a[204:207], v55 offset:384
    v_add_u32 v54, 4096, v36
    v_add_u32 v55, 4096, v37
    v_mfma_f32_32x32x16_bf16 v[64:79], v[56:59], v[56:59], 0
    v_mfma_f32_32x32x16_bf16 v[80:95], v[56:59], v[56:59], 0
    v_mfma_f32_32x32x16_bf16 v[96:111], v[56:59], v[56:59], 0
    v_mfma_f32_32x32x16_bf16 v[112:127], v[56:59], v[56:59], 0
    s_cmp_ge_u32 s2, 21
    s_cbranch_scc1 k12_nostat_5
    s_lshl_b32 s52, s2, 12
    s_add_u32 s52, s52, 0x3800000
    s_mov_b32 s34, -1
    v_lshlrev_b32 v6, 4, v0
    buffer_store_dwordx4 v[56:59], v6, s[32:35], s52 offen sc1
    s_mov_b32 s34, 0x2000000
k12_nostat_5:
    ds_read_b128 a[0:3], v26 offset:0
    ds_read_b64_tr_b16 a[32:33], v28 offset:0
    ds_read_b64_tr_b16 a[34:35], v28 offset:2048
    ds_read_b128 a[4:7], v26 offset:2048
    ds_read_b64_tr_b16 a[36:37], v29 offset:0
    ds_read_b64_tr_b16 a[38:39], v29 offset:2048
    ds_read_b128 a[8:11], v26 offset:4096
    ds_read_b64_tr_b16 a[40:41], v30 offset:0
    ds_read_b64_tr_b16 a[42:43], v30 offset:2048
    ds_read_b128 a[12:15], v26 offset:6144
    ds_read_b64_tr_b16 a[44:45], v31 offset:0
    ds_read_b64_tr_b16 a[46:47], v31 offset:2048
    ds_read_b128 a[16:19], v26 offset:8192
    ds_read_b64_tr_b16 a[48:49], v32 offset:0
    ds_read_b64_tr_b16 a[50:51], v32 offset:2048
    ds_read_b128 a[20:23], v26 offset:10240
    ds_read_b64_tr_b16 a[52:53], v33 offset:0
    ds_read_b64_tr_b16 a[54:55], v33 offset:2048
    ds_read_b128 a[24:27], v26 offset:12288
    ds_read_b64_tr_b16 a[56:57], v34 offset:0
    ds_read_b64_tr_b16 a[58:59], v34 offset:2048
    ds_read_b128 a[28:31], v26 offset:14336
    ds_read_b64_tr_b16 a[60:61], v35 offset:0
    ds_read_b64_tr_b16 a[62:63], v35 offset:2048
    s_mov_b32 s51, 0
    s_waitcnt lgkmcnt(15)
    s_mov_b32 s52, 0
    buffer_store_dwordx4 a[192:195], v53, s[8:11], s52 offen sc1
    s_mov_b32 s52, 262144
    buffer_store_dwordx4 a[196:199], v53, s[8:11], s52 offen sc1
    s_mov_b32 s52, 524288
    buffer_store_dwordx4 a[200:203], v53, s[8:11], s52 offen sc1
    s_mov_b32 s52, 786432
    buffer_store_dwordx4 a[204:207], v53, s[8:11], s52 offen sc1
    s_waitcnt lgkmcnt(0)
    s_cmp_lg_u32 s57, 0
    s_cbranch_scc1 k12_v_6
k12_loop_8:
    v_mfma_f32_16x16x32_bf16 v[64:67], a[32:35], a[0:3], v[64:67]
    ds_read_b128 a[64:67], v27 offset:0
    v_mfma_f32_16x16x32_bf16 v[80:83], a[32:35], a[4:7], v[80:83]
    ds_read_b64_tr_b16 a[96:97], v28 offset:16384
    v_mfma_f32_16x16x32_bf16 v[96:99], a[32:35], a[8:11], v[96:99]
    v_mfma_f32_16x16x32_bf16 v[112:115], a[32:35], a[12:15], v[112:115]
    s_cmp_eq_u32 s51, s46
    s_cbranch_scc1 k12_ool_10
k12_oolret_11:
    v_mfma_f32_16x16x32_bf16 v[128:131], a[32:35], a[16:19], v[128:131]
    ds_read_b64_tr_b16 a[98:99], v28 offset:18432
    v_mfma_f32_16x16x32_bf16 v[144:147], a[32:35], a[20:23], v[144:147]
    ds_read_b128 a[68:71], v27 offset:2048
    v_mfma_f32_16x16x32_bf16 a[128:131], a[32:35], a[24:27], a[128:131]
    v_mfma_f32_16x16x32_bf16 a[160:163], a[32:35], a[28:31], a[160:163]
    ds_read_b64_tr_b16 a[100:101], v29 offset:16384
    v_mfma_f32_16x16x32_bf16 v[160:163], a[36:39], a[0:3], v[160:163]
    v_mfma_f32_16x16x32_bf16 v[176:179], a[36:39], a[4:7], v[176:179]
    ds_read_b64_tr_b16 a[102:103], v29 offset:18432
    v_mfma_f32_16x16x32_bf16 v[192:195], a[36:39], a[8:11], v[192:195]
    v_mfma_f32_16x16x32_bf16 v[208:211], a[36:39], a[12:15], v[208:211]
    ds_read_b128 a[72:75], v27 offset:4096
    v_mfma_f32_16x16x32_bf16 v[224:227], a[36:39], a[16:19], v[224:227]
    v_mfma_f32_16x16x32_bf16 v[240:243], a[36:39], a[20:23], v[240:243]
    v_mfma_f32_16x16x32_bf16 a[132:135], a[36:39], a[24:27], a[132:135]
    ds_read_b64_tr_b16 a[104:105], v30 offset:16384
    v_mfma_f32_16x16x32_bf16 a[164:167], a[36:39], a[28:31], a[164:167]
    v_mfma_f32_16x16x32_bf16 v[68:71], a[40:43], a[0:3], v[68:71]
    ds_read_b64_tr_b16 a[106:107], v30 offset:18432
    v_mfma_f32_16x16x32_bf16 v[84:87], a[40:43], a[4:7], v[84:87]
    v_mfma_f32_16x16x32_bf16 v[100:103], a[40:43], a[8:11], v[100:103]
    ds_read_b128 a[76:79], v27 offset:6144
    v_mfma_f32_16x16x32_bf16 v[116:119], a[40:43], a[12:15], v[116:119]
    v_mfma_f32_16x16x32_bf16 v[132:135], a[40:43], a[16:19], v[132:135]
    ds_read_b64_tr_b16 a[108:109], v31 offset:16384
    v_mfma_f32_16x16x32_bf16 v[148:151], a[40:43], a[20:23], v[148:151]
    v_mfma_f32_16x16x32_bf16 a[136:139], a[40:43], a[24:27], a[136:139]
    ds_read_b64_tr_b16 a[110:111], v31 offset:18432
    v_mfma_f32_16x16x32_bf16 a[168:171], a[40:43], a[28:31], a[168:171]
    v_mfma_f32_16x16x32_bf16 v[164:167], a[44:47], a[0:3], v[164:167]
    ds_read_b128 a[80:83], v27 offset:8192
    v_mfma_f32_16x16x32_bf16 v[180:183], a[44:47], a[4:7], v[180:183]
    v_mfma_f32_16x16x32_bf16 v[196:199], a[44:47], a[8:11], v[196:199]
    ds_read_b64_tr_b16 a[112:113], v32 offset:16384
    v_mfma_f32_16x16x32_bf16 v[212:215], a[44:47], a[12:15], v[212:215]
    v_mfma_f32_16x16x32_bf16 v[228:231], a[44:47], a[16:19], v[228:231]
    ds_read_b64_tr_b16 a[114:115], v32 offset:18432
    v_mfma_f32_16x16x32_bf16 v[244:247], a[44:47], a[20:23], v[244:247]
    v_mfma_f32_16x16x32_bf16 a[140:143], a[44:47], a[24:27], a[140:143]
    ds_read_b128 a[84:87], v27 offset:10240
    v_mfma_f32_16x16x32_bf16 a[172:175], a[44:47], a[28:31], a[172:175]
    v_mfma_f32_16x16x32_bf16 v[72:75], a[48:51], a[0:3], v[72:75]
    ds_read_b64_tr_b16 a[116:117], v33 offset:16384
    v_mfma_f32_16x16x32_bf16 v[88:91], a[48:51], a[4:7], v[88:91]
    v_mfma_f32_16x16x32_bf16 v[104:107], a[48:51], a[8:11], v[104:107]
    ds_read_b64_tr_b16 a[118:119], v33 offset:18432
    v_mfma_f32_16x16x32_bf16 v[120:123], a[48:51], a[12:15], v[120:123]
    v_mfma_f32_16x16x32_bf16 v[136:139], a[48:51], a[16:19], v[136:139]
    ds_read_b128 a[88:91], v27 offset:12288
    v_mfma_f32_16x16x32_bf16 v[152:155], a[48:51], a[20:23], v[152:155]
    v_mfma_f32_16x16x32_bf16 a[144:147], a[48:51], a[24:27], a[144:147]
    v_mfma_f32_16x16x32_bf16 a[176:179], a[48:51], a[28:31], a[176:179]
    ds_read_b64_tr_b16 a[120:121], v34 offset:16384
    v_mfma_f32_16x16x32_bf16 v[168:171], a[52:55], a[0:3], v[168:171]
    v_mfma_f32_16x16x32_bf16 v[184:187], a[52:55], a[4:7], v[184:187]
    ds_read_b64_tr_b16 a[122:123], v34 offset:18432
    v_mfma_f32_16x16x32_bf16 v[200:203], a[52:55], a[8:11], v[200:203]
    v_mfma_f32_16x16x32_bf16 v[216:219], a[52:55], a[12:15], v[216:219]
    ds_read_b128 a[92:95], v27 offset:14336
    v_mfma_f32_16x16x32_bf16 v[232:235], a[52:55], a[16:19], v[232:235]
    v_mfma_f32_16x16x32_bf16 v[248:251], a[52:55], a[20:23], v[248:251]
    ds_read_b64_tr_b16 a[124:125], v35 offset:16384
    v_mfma_f32_16x16x32_bf16 a[148:151], a[52:55], a[24:27], a[148:151]
    v_mfma_f32_16x16x32_bf16 a[180:183], a[52:55], a[28:31], a[180:183]
    ds_read_b64_tr_b16 a[126:127], v35 offset:18432
    v_mfma_f32_16x16x32_bf16 v[76:79], a[56:59], a[0:3], v[76:79]
    v_mfma_f32_16x16x32_bf16 v[92:95], a[56:59], a[4:7], v[92:95]
    v_mfma_f32_16x16x32_bf16 v[108:111], a[56:59], a[8:11], v[108:111]
    v_mfma_f32_16x16x32_bf16 v[124:127], a[56:59], a[12:15], v[124:127]
    v_mfma_f32_16x16x32_bf16 v[140:143], a[56:59], a[16:19], v[140:143]
    v_mfma_f32_16x16x32_bf16 v[156:159], a[56:59], a[20:23], v[156:159]
    v_mfma_f32_16x16x32_bf16 a[152:155], a[56:59], a[24:27], a[152:155]
    v_mfma_f32_16x16x32_bf16 a[184:187], a[56:59], a[28:31], a[184:187]
    v_mfma_f32_16x16x32_bf16 v[172:175], a[60:63], a[0:3], v[172:175]
    v_mfma_f32_16x16x32_bf16 v[188:191], a[60:63], a[4:7], v[188:191]
    v_mfma_f32_16x16x32_bf16 v[204:207], a[60:63], a[8:11], v[204:207]
    v_mfma_f32_16x16x32_bf16 v[220:223], a[60:63], a[12:15], v[220:223]
    v_mfma_f32_16x16x32_bf16 v[236:239], a[60:63], a[16:19], v[236:239]
    v_mfma_f32_16x16x32_bf16 v[252:255], a[60:63], a[20:23], v[252:255]
    v_mfma_f32_16x16x32_bf16 a[156:159], a[60:63], a[24:27], a[156:159]
    v_mfma_f32_16x16x32_bf16 a[188:191], a[60:63], a[28:31], a[188:191]
    s_waitcnt vmcnt(0) lgkmcnt(0)
    s_barrier
    v_mfma_f32_16x16x32_bf16 v[64:67], a[96:99], a[64:67], v[64:67]
    s_cmp_ge_u32 s49, 1024
    s_cselect_b32 s18, 0, s18
    s_cselect_b32 s22, 0, s22
    ds_read_b128 a[0:3], v26 offset:32768
    v_mfma_f32_16x16x32_bf16 v[80:83], a[96:99], a[68:71], v[80:83]
    s_add_u32 m0, s48, 0
    ds_read_b64_tr_b16 a[32:33], v28 offset:32768
    v_mfma_f32_16x16x32_bf16 v[96:99], a[96:99], a[72:75], v[96:99]
    buffer_load_dwordx4 v10, s[16:19], s49 offen offset:0 lds
    v_mfma_f32_16x16x32_bf16 v[112:115], a[96:99], a[76:79], v[112:115]
    ds_read_b64_tr_b16 a[34:35], v28 offset:34816
    v_mfma_f32_16x16x32_bf16 v[128:131], a[96:99], a[80:83], v[128:131]
    buffer_load_dwordx4 v11, s[16:19], s49 offen offset:1024 lds
    v_mfma_f32_16x16x32_bf16 v[144:147], a[96:99], a[84:87], v[144:147]
    ds_read_b128 a[4:7], v26 offset:34816
    v_mfma_f32_16x16x32_bf16 a[128:131], a[96:99], a[88:91], a[128:131]
    v_mfma_f32_16x16x32_bf16 a[160:163], a[96:99], a[92:95], a[160:163]
    ds_read_b64_tr_b16 a[36:37], v29 offset:32768
    v_mfma_f32_16x16x32_bf16 v[160:163], a[100:103], a[64:67], v[160:163]
    buffer_load_dwordx4 v12, s[16:19], s49 offen offset:2048 lds
    v_mfma_f32_16x16x32_bf16 v[176:179], a[100:103], a[68:71], v[176:179]
    ds_read_b64_tr_b16 a[38:39], v29 offset:34816
    v_mfma_f32_16x16x32_bf16 v[192:195], a[100:103], a[72:75], v[192:195]
    v_mfma_f32_16x16x32_bf16 v[208:211], a[100:103], a[76:79], v[208:211]
    buffer_load_dwordx4 v13, s[16:19], s49 offen offset:3072 lds
    ds_read_b128 a[8:11], v26 offset:36864
    v_mfma_f32_16x16x32_bf16 v[224:227], a[100:103], a[80:83], v[224:227]
    v_mfma_f32_16x16x32_bf16 v[240:243], a[100:103], a[84:87], v[240:243]
    s_add_u32 m0, s48, 4096
    v_mfma_f32_16x16x32_bf16 a[132:135], a[100:103], a[88:91], a[132:135]
    ds_read_b64_tr_b16 a[40:41], v30 offset:32768
    v_mfma_f32_16x16x32_bf16 a[164:167], a[100:103], a[92:95], a[164:167]
    buffer_load_dwordx4 v14, s[16:19], s49 offen offset:0 lds
    v_mfma_f32_16x16x32_bf16 v[68:71], a[104:107], a[64:67], v[68:71]
    ds_read_b64_tr_b16 a[42:43], v30 offset:34816
    v_mfma_f32_16x16x32_bf16 v[84:87], a[104:107], a[68:71], v[84:87]
    v_mfma_f32_16x16x32_bf16 v[100:103], a[104:107], a[72:75], v[100:103]
    buffer_load_dwordx4 v15, s[16:19], s49 offen offset:1024 lds
    ds_read_b128 a[12:15], v26 offset:38912
    v_mfma_f32_16x16x32_bf16 v[116:119], a[104:107], a[76:79], v[116:119]
    v_mfma_f32_16x16x32_bf16 v[132:135], a[104:107], a[80:83], v[132:135]
    ds_read_b64_tr_b16 a[44:45], v31 offset:32768
    v_mfma_f32_16x16x32_bf16 v[148:151], a[104:107], a[84:87], v[148:151]
    v_mfma_f32_16x16x32_bf16 a[136:139], a[104:107], a[88:91], a[136:139]
    buffer_load_dwordx4 v16, s[16:19], s49 offen offset:2048 lds
    ds_read_b64_tr_b16 a[46:47], v31 offset:34816
    v_mfma_f32_16x16x32_bf16 a[168:171], a[104:107], a[92:95], a[168:171]
    v_mfma_f32_16x16x32_bf16 v[164:167], a[108:111], a[64:67], v[164:167]
    ds_read_b128 a[16:19], v26 offset:40960
    v_mfma_f32_16x16x32_bf16 v[180:183], a[108:111], a[68:71], v[180:183]
    buffer_load_dwordx4 v17, s[16:19], s49 offen offset:3072 lds
    v_mfma_f32_16x16x32_bf16 v[196:199], a[108:111], a[72:75], v[196:199]
    ds_read_b64_tr_b16 a[48:49], v32 offset:32768
    v_mfma_f32_16x16x32_bf16 v[212:215], a[108:111], a[76:79], v[212:215]
    s_add_u32 s49, s49, 128
    v_mfma_f32_16x16x32_bf16 v[228:231], a[108:111], a[80:83], v[228:231]
    s_add_u32 m0, s48, 65536
    ds_read_b64_tr_b16 a[50:51], v32 offset:34816
    v_mfma_f32_16x16x32_bf16 v[244:247], a[108:111], a[84:87], v[244:247]
    buffer_load_dwordx4 v18, s[20:23], s50 offen offset:0 lds
    v_mfma_f32_16x16x32_bf16 a[140:143], a[108:111], a[88:91], a[140:143]
    ds_read_b128 a[20:23], v26 offset:43008
    v_mfma_f32_16x16x32_bf16 a[172:175], a[108:111], a[92:95], a[172:175]
    v_mfma_f32_16x16x32_bf16 v[72:75], a[112:115], a[64:67], v[72:75]
    buffer_load_dwordx4 v19, s[20:23], s50 offen offset:1024 lds
    ds_read_b64_tr_b16 a[52:53], v33 offset:32768
    v_mfma_f32_16x16x32_bf16 v[88:91], a[112:115], a[68:71], v[88:91]
    v_mfma_f32_16x16x32_bf16 v[104:107], a[112:115], a[72:75], v[104:107]
    ds_read_b64_tr_b16 a[54:55], v33 offset:34816
    v_mfma_f32_16x16x32_bf16 v[120:123], a[112:115], a[76:79], v[120:123]
    buffer_load_dwordx4 v20, s[20:23], s50 offen offset:2048 lds
    v_mfma_f32_16x16x32_bf16 v[136:139], a[112:115], a[80:83], v[136:139]
    ds_read_b128 a[24:27], v26 offset:45056
    v_mfma_f32_16x16x32_bf16 v[152:155], a[112:115], a[84:87], v[152:155]
    v_mfma_f32_16x16x32_bf16 a[144:147], a[112:115], a[88:91], a[144:147]
    v_mfma_f32_16x16x32_bf16 a[176:179], a[112:115], a[92:95], a[176:179]
    buffer_load_dwordx4 v21, s[20:23], s50 offen offset:3072 lds
    ds_read_b64_tr_b16 a[56:57], v34 offset:32768
    v_mfma_f32_16x16x32_bf16 v[168:171], a[116:119], a[64:67], v[168:171]
    s_add_u32 m0, s48, 69632
    v_mfma_f32_16x16x32_bf16 v[184:187], a[116:119], a[68:71], v[184:187]
    ds_read_b64_tr_b16 a[58:59], v34 offset:34816
    v_mfma_f32_16x16x32_bf16 v[200:203], a[116:119], a[72:75], v[200:203]
    buffer_load_dwordx4 v22, s[20:23], s50 offen offset:0 lds
    v_mfma_f32_16x16x32_bf16 v[216:219], a[116:119], a[76:79], v[216:219]
    ds_read_b128 a[28:31], v26 offset:47104
    v_mfma_f32_16x16x32_bf16 v[232:235], a[116:119], a[80:83], v[232:235]
    v_mfma_f32_16x16x32_bf16 v[248:251], a[116:119], a[84:87], v[248:251]
    ds_read_b64_tr_b16 a[60:61], v35 offset:32768
    v_mfma_f32_16x16x32_bf16 a[148:151], a[116:119], a[88:91], a[148:151]
    buffer_load_dwordx4 v23, s[20:23], s50 offen offset:1024 lds
    v_mfma_f32_16x16x32_bf16 a[180:183], a[116:119], a[92:95], a[180:183]
    ds_read_b64_tr_b16 a[62:63], v35 offset:34816
    v_mfma_f32_16x16x32_bf16 v[76:79], a[120:123], a[64:67], v[76:79]
    v_mfma_f32_16x16x32_bf16 v[92:95], a[120:123], a[68:71], v[92:95]
    buffer_load_dwordx4 v24, s[20:23], s50 offen offset:2048 lds
    v_mfma_f32_16x16x32_bf16 v[108:111], a[120:123], a[72:75], v[108:111]
    v_mfma_f32_16x16x32_bf16 v[124:127], a[120:123], a[76:79], v[124:127]
    v_mfma_f32_16x16x32_bf16 v[140:143], a[120:123], a[80:83], v[140:143]
    v_mfma_f32_16x16x32_bf16 v[156:159], a[120:123], a[84:87], v[156:159]
    buffer_load_dwordx4 v25, s[20:23], s50 offen offset:3072 lds
    v_mfma_f32_16x16x32_bf16 a[152:155], a[120:123], a[88:91], a[152:155]
    v_mfma_f32_16x16x32_bf16 a[184:187], a[120:123], a[92:95], a[184:187]
    s_add_u32 s50, s50, 0x80000
    v_mfma_f32_16x16x32_bf16 v[172:175], a[124:127], a[64:67], v[172:175]
    v_mfma_f32_16x16x32_bf16 v[188:191], a[124:127], a[68:71], v[188:191]
    s_cmp_eq_u32 s51, s53
    s_cbranch_scc1 k12_ool_12
k12_oolret_13:
    v_mfma_f32_16x16x32_bf16 v[204:207], a[124:127], a[72:75], v[204:207]
    v_mfma_f32_16x16x32_bf16 v[220:223], a[124:127], a[76:79], v[220:223]
    s_cmp_eq_u32 s51, s63
    s_cbranch_scc1 k12_ool_14
k12_oolret_15:
    v_mfma_f32_16x16x32_bf16 v[236:239], a[124:127], a[80:83], v[236:239]
    v_mfma_f32_16x16x32_bf16 v[252:255], a[124:127], a[84:87], v[252:255]
    s_add_u32 s51, s51, 1
    v_mfma_f32_16x16x32_bf16 a[156:159], a[124:127], a[88:91], a[156:159]
    v_mfma_f32_16x16x32_bf16 a[188:191], a[124:127], a[92:95], a[188:191]
    s_waitcnt lgkmcnt(0)
    v_mfma_f32_16x16x32_bf16 v[64:67], a[32:35], a[0:3], v[64:67]
    ds_read_b128 a[64:67], v27 offset:32768
    v_mfma_f32_16x16x32_bf16 v[80:83], a[32:35], a[4:7], v[80:83]
    ds_read_b64_tr_b16 a[96:97], v28 offset:49152
    v_mfma_f32_16x16x32_bf16 v[96:99], a[32:35], a[8:11], v[96:99]
    v_mfma_f32_16x16x32_bf16 v[112:115], a[32:35], a[12:15], v[112:115]
    ds_read_b64_tr_b16 a[98:99], v28 offset:51200
    v_mfma_f32_16x16x32_bf16 v[128:131], a[32:35], a[16:19], v[128:131]
    v_mfma_f32_16x16x32_bf16 v[144:147], a[32:35], a[20:23], v[144:147]
    ds_read_b128 a[68:71], v27 offset:34816
    v_mfma_f32_16x16x32_bf16 a[128:131], a[32:35], a[24:27], a[128:131]
    v_mfma_f32_16x16x32_bf16 a[160:163], a[32:35], a[28:31], a[160:163]
    ds_read_b64_tr_b16 a[100:101], v29 offset:49152
    v_mfma_f32_16x16x32_bf16 v[160:163], a[36:39], a[0:3], v[160:163]
    v_mfma_f32_16x16x32_bf16 v[176:179], a[36:39], a[4:7], v[176:179]
    ds_read_b64_tr_b16 a[102:103], v29 offset:51200
    v_mfma_f32_16x16x32_bf16 v[192:195], a[36:39], a[8:11], v[192:195]
    v_mfma_f32_16x16x32_bf16 v[208:211], a[36:39], a[12:15], v[208:211]
    ds_read_b128 a[72:75], v27 offset:36864
    v_mfma_f32_16x16x32_bf16 v[224:227], a[36:39], a[16:19], v[224:227]
    v_mfma_f32_16x16x32_bf16 v[240:243], a[36:39], a[20:23], v[240:243]
    v_mfma_f32_16x16x32_bf16 a[132:135], a[36:39], a[24:27], a[132:135]
    ds_read_b64_tr_b16 a[104:105], v30 offset:49152
    v_mfma_f32_16x16x32_bf16 a[164:167], a[36:39], a[28:31], a[164:167]
    v_mfma_f32_16x16x32_bf16 v[68:71], a[40:43], a[0:3], v[68:71]
    ds_read_b64_tr_b16 a[106:107], v30 offset:51200
    v_mfma_f32_16x16x32_bf16 v[84:87], a[40:43], a[4:7], v[84:87]
    v_mfma_f32_16x16x32_bf16 v[100:103], a[40:43], a[8:11], v[100:103]
    ds_read_b128 a[76:79], v27 offset:38912
    v_mfma_f32_16x16x32_bf16 v[116:119], a[40:43], a[12:15], v[116:119]
    v_mfma_f32_16x16x32_bf16 v[132:135], a[40:43], a[16:19], v[132:135]
    ds_read_b64_tr_b16 a[108:109], v31 offset:49152
    v_mfma_f32_16x16x32_bf16 v[148:151], a[40:43], a[20:23], v[148:151]
    v_mfma_f32_16x16x32_bf16 a[136:139], a[40:43], a[24:27], a[136:139]
    ds_read_b64_tr_b16 a[110:111], v31 offset:51200
    v_mfma_f32_16x16x32_bf16 a[168:171], a[40:43], a[28:31], a[168:171]
    v_mfma_f32_16x16x32_bf16 v[164:167], a[44:47], a[0:3], v[164:167]
    ds_read_b128 a[80:83], v27 offset:40960
    v_mfma_f32_16x16x32_bf16 v[180:183], a[44:47], a[4:7], v[180:183]
    v_mfma_f32_16x16x32_bf16 v[196:199], a[44:47], a[8:11], v[196:199]
    ds_read_b64_tr_b16 a[112:113], v32 offset:49152
    v_mfma_f32_16x16x32_bf16 v[212:215], a[44:47], a[12:15], v[212:215]
    v_mfma_f32_16x16x32_bf16 v[228:231], a[44:47], a[16:19], v[228:231]
    ds_read_b64_tr_b16 a[114:115], v32 offset:51200
    v_mfma_f32_16x16x32_bf16 v[244:247], a[44:47], a[20:23], v[244:247]
    v_mfma_f32_16x16x32_bf16 a[140:143], a[44:47], a[24:27], a[140:143]
    ds_read_b128 a[84:87], v27 offset:43008
    v_mfma_f32_16x16x32_bf16 a[172:175], a[44:47], a[28:31], a[172:175]
    v_mfma_f32_16x16x32_bf16 v[72:75], a[48:51], a[0:3], v[72:75]
    ds_read_b64_tr_b16 a[116:117], v33 offset:49152
    v_mfma_f32_16x16x32_bf16 v[88:91], a[48:51], a[4:7], v[88:91]
    v_mfma_f32_16x16x32_bf16 v[104:107], a[48:51], a[8:11], v[104:107]
    ds_read_b64_tr_b16 a[118:119], v33 offset:51200
    v_mfma_f32_16x16x32_bf16 v[120:123], a[48:51], a[12:15], v[120:123]
    v_mfma_f32_16x16x32_bf16 v[136:139], a[48:51], a[16:19], v[136:139]
    ds_read_b128 a[88:91], v27 offset:45056
    v_mfma_f32_16x16x32_bf16 v[152:155], a[48:51], a[20:23], v[152:155]
    v_mfma_f32_16x16x32_bf16 a[144:147], a[48:51], a[24:27], a[144:147]
    v_mfma_f32_16x16x32_bf16 a[176:179], a[48:51], a[28:31], a[176:179]
    ds_read_b64_tr_b16 a[120:121], v34 offset:49152
    v_mfma_f32_16x16x32_bf16 v[168:171], a[52:55], a[0:3], v[168:171]
    v_mfma_f32_16x16x32_bf16 v[184:187], a[52:55], a[4:7], v[184:187]
    ds_read_b64_tr_b16 a[122:123], v34 offset:51200
    v_mfma_f32_16x16x32_bf16 v[200:203], a[52:55], a[8:11], v[200:203]
    v_mfma_f32_16x16x32_bf16 v[216:219], a[52:55], a[12:15], v[216:219]
    ds_read_b128 a[92:95], v27 offset:47104
    v_mfma_f32_16x16x32_bf16 v[232:235], a[52:55], a[16:19], v[232:235]
    v_mfma_f32_16x16x32_bf16 v[248:251], a[52:55], a[20:23], v[248:251]
    ds_read_b64_tr_b16 a[124:125], v35 offset:49152
    v_mfma_f32_16x16x32_bf16 a[148:151], a[52:55], a[24:27], a[148:151]
    v_mfma_f32_16x16x32_bf16 a[180:183], a[52:55], a[28:31], a[180:183]
    ds_read_b64_tr_b16 a[126:127], v35 offset:51200
    v_mfma_f32_16x16x32_bf16 v[76:79], a[56:59], a[0:3], v[76:79]
    v_mfma_f32_16x16x32_bf16 v[92:95], a[56:59], a[4:7], v[92:95]
    v_mfma_f32_16x16x32_bf16 v[108:111], a[56:59], a[8:11], v[108:111]
    v_mfma_f32_16x16x32_bf16 v[124:127], a[56:59], a[12:15], v[124:127]
    v_mfma_f32_16x16x32_bf16 v[140:143], a[56:59], a[16:19], v[140:143]
    v_mfma_f32_16x16x32_bf16 v[156:159], a[56:59], a[20:23], v[156:159]
    v_mfma_f32_16x16x32_bf16 a[152:155], a[56:59], a[24:27], a[152:155]
    v_mfma_f32_16x16x32_bf16 a[184:187], a[56:59], a[28:31], a[184:187]
    s_sub_u32 s52, s51, 1
    s_cmp_eq_u32 s52, s46
    s_cbranch_scc1 k12_ool_18
k12_oolret_19:
    v_mfma_f32_16x16x32_bf16 v[172:175], a[60:63], a[0:3], v[172:175]
    v_mfma_f32_16x16x32_bf16 v[188:191], a[60:63], a[4:7], v[188:191]
    v_mfma_f32_16x16x32_bf16 v[204:207], a[60:63], a[8:11], v[204:207]
    v_mfma_f32_16x16x32_bf16 v[220:223], a[60:63], a[12:15], v[220:223]
    v_mfma_f32_16x16x32_bf16 v[236:239], a[60:63], a[16:19], v[236:239]
    v_mfma_f32_16x16x32_bf16 v[252:255], a[60:63], a[20:23], v[252:255]
    v_mfma_f32_16x16x32_bf16 a[156:159], a[60:63], a[24:27], a[156:159]
    v_mfma_f32_16x16x32_bf16 a[188:191], a[60:63], a[28:31], a[188:191]
    s_waitcnt vmcnt(0) lgkmcnt(0)
    s_barrier
    s_cmp_eq_u32 s51, 7
    s_cbranch_scc1 k12_last_9
    v_mfma_f32_16x16x32_bf16 v[64:67], a[96:99], a[64:67], v[64:67]
    ds_read_b128 a[0:3], v26 offset:0
    v_mfma_f32_16x16x32_bf16 v[80:83], a[96:99], a[68:71], v[80:83]
    s_add_u32 m0, s48, 32768
    ds_read_b64_tr_b16 a[32:33], v28 offset:0
    v_mfma_f32_16x16x32_bf16 v[96:99], a[96:99], a[72:75], v[96:99]
    buffer_load_dwordx4 v10, s[16:19], s49 offen offset:0 lds
    v_mfma_f32_16x16x32_bf16 v[112:115], a[96:99], a[76:79], v[112:115]
    ds_read_b64_tr_b16 a[34:35], v28 offset:2048
    v_mfma_f32_16x16x32_bf16 v[128:131], a[96:99], a[80:83], v[128:131]
    buffer_load_dwordx4 v11, s[16:19], s49 offen offset:1024 lds
    v_mfma_f32_16x16x32_bf16 v[144:147], a[96:99], a[84:87], v[144:147]
    ds_read_b128 a[4:7], v26 offset:2048
    v_mfma_f32_16x16x32_bf16 a[128:131], a[96:99], a[88:91], a[128:131]
    v_mfma_f32_16x16x32_bf16 a[160:163], a[96:99], a[92:95], a[160:163]
    ds_read_b64_tr_b16 a[36:37], v29 offset:0
    v_mfma_f32_16x16x32_bf16 v[160:163], a[100:103], a[64:67], v[160:163]
    buffer_load_dwordx4 v12, s[16:19], s49 offen offset:2048 lds
    v_mfma_f32_16x16x32_bf16 v[176:179], a[100:103], a[68:71], v[176:179]
    ds_read_b64_tr_b16 a[38:39], v29 offset:2048
    v_mfma_f32_16x16x32_bf16 v[192:195], a[100:103], a[72:75], v[192:195]
    v_mfma_f32_16x16x32_bf16 v[208:211], a[100:103], a[76:79], v[208:211]
    buffer_load_dwordx4 v13, s[16:19], s49 offen offset:3072 lds
    ds_read_b128 a[8:11], v26 offset:4096
    v_mfma_f32_16x16x32_bf16 v[224:227], a[100:103], a[80:83], v[224:227]
    v_mfma_f32_16x16x32_bf16 v[240:243], a[100:103], a[84:87], v[240:243]
    s_add_u32 m0, s48, 36864
    v_mfma_f32_16x16x32_bf16 a[132:135], a[100:103], a[88:91], a[132:135]
    ds_read_b64_tr_b16 a[40:41], v30 offset:0
    v_mfma_f32_16x16x32_bf16 a[164:167], a[100:103], a[92:95], a[164:167]
    buffer_load_dwordx4 v14, s[16:19], s49 offen offset:0 lds
    v_mfma_f32_16x16x32_bf16 v[68:71], a[104:107], a[64:67], v[68:71]
    ds_read_b64_tr_b16 a[42:43], v30 offset:2048
    v_mfma_f32_16x16x32_bf16 v[84:87], a[104:107], a[68:71], v[84:87]
    v_mfma_f32_16x16x32_bf16 v[100:103], a[104:107], a[72:75], v[100:103]
    buffer_load_dwordx4 v15, s[16:19], s49 offen offset:1024 lds
    ds_read_b128 a[12:15], v26 offset:6144
    v_mfma_f32_16x16x32_bf16 v[116:119], a[104:107], a[76:79], v[116:119]
    v_mfma_f32_16x16x32_bf16 v[132:135], a[104:107], a[80:83], v[132:135]
    ds_read_b64_tr_b16 a[44:45], v31 offset:0
    v_mfma_f32_16x16x32_bf16 v[148:151], a[104:107], a[84:87], v[148:151]
    v_mfma_f32_16x16x32_bf16 a[136:139], a[104:107], a[88:91], a[136:139]
    buffer_load_dwordx4 v16, s[16:19], s49 offen offset:2048 lds
    ds_read_b64_tr_b16 a[46:47], v31 offset:2048
    v_mfma_f32_16x16x32_bf16 a[168:171], a[104:107], a[92:95], a[168:171]
    v_mfma_f32_16x16x32_bf16 v[164:167], a[108:111], a[64:67], v[164:167]
    ds_read_b128 a[16:19], v26 offset:8192
    v_mfma_f32_16x16x32_bf16 v[180:183], a[108:111], a[68:71], v[180:183]
    buffer_load_dwordx4 v17, s[16:19], s49 offen offset:3072 lds
    v_mfma_f32_16x16x32_bf16 v[196:199], a[108:111], a[72:75], v[196:199]
    ds_read_b64_tr_b16 a[48:49], v32 offset:0
    v_mfma_f32_16x16x32_bf16 v[212:215], a[108:111], a[76:79], v[212:215]
    s_add_u32 s49, s49, 128
    v_mfma_f32_16x16x32_bf16 v[228:231], a[108:111], a[80:83], v[228:231]
    s_add_u32 m0, s48, 98304
    ds_read_b64_tr_b16 a[50:51], v32 offset:2048
    v_mfma_f32_16x16x32_bf16 v[244:247], a[108:111], a[84:87], v[244:247]
    buffer_load_dwordx4 v18, s[20:23], s50 offen offset:0 lds
    v_mfma_f32_16x16x32_bf16 a[140:143], a[108:111], a[88:91], a[140:143]
    ds_read_b128 a[20:23], v26 offset:10240
    v_mfma_f32_16x16x32_bf16 a[172:175], a[108:111], a[92:95], a[172:175]
    v_mfma_f32_16x16x32_bf16 v[72:75], a[112:115], a[64:67], v[72:75]
    buffer_load_dwordx4 v19, s[20:23], s50 offen offset:1024 lds
    ds_read_b64_tr_b16 a[52:53], v33 offset:0
    v_mfma_f32_16x16x32_bf16 v[88:91], a[112:115], a[68:71], v[88:91]
    v_mfma_f32_16x16x32_bf16 v[104:107], a[112:115], a[72:75], v[104:107]
    ds_read_b64_tr_b16 a[54:55], v33 offset:2048
    v_mfma_f32_16x16x32_bf16 v[120:123], a[112:115], a[76:79], v[120:123]
    buffer_load_dwordx4 v20, s[20:23], s50 offen offset:2048 lds
    v_mfma_f32_16x16x32_bf16 v[136:139], a[112:115], a[80:83], v[136:139]
    ds_read_b128 a[24:27], v26 offset:12288
    v_mfma_f32_16x16x32_bf16 v[152:155], a[112:115], a[84:87], v[152:155]
    v_mfma_f32_16x16x32_bf16 a[144:147], a[112:115], a[88:91], a[144:147]
    v_mfma_f32_16x16x32_bf16 a[176:179], a[112:115], a[92:95], a[176:179]
    buffer_load_dwordx4 v21, s[20:23], s50 offen offset:3072 lds
    ds_read_b64_tr_b16 a[56:57], v34 offset:0
    v_mfma_f32_16x16x32_bf16 v[168:171], a[116:119], a[64:67], v[168:171]
    s_add_u32 m0, s48, 102400
    v_mfma_f32_16x16x32_bf16 v[184:187], a[116:119], a[68:71], v[184:187]
    ds_read_b64_tr_b16 a[58:59], v34 offset:2048
    v_mfma_f32_16x16x32_bf16 v[200:203], a[116:119], a[72:75], v[200:203]
    buffer_load_dwordx4 v22, s[20:23], s50 offen offset:0 lds
    v_mfma_f32_16x16x32_bf16 v[216:219], a[116:119], a[76:79], v[216:219]
    ds_read_b128 a[28:31], v26 offset:14336
    v_mfma_f32_16x16x32_bf16 v[232:235], a[116:119], a[80:83], v[232:235]
    v_mfma_f32_16x16x32_bf16 v[248:251], a[116:119], a[84:87], v[248:251]
    ds_read_b64_tr_b16 a[60:61], v35 offset:0
    v_mfma_f32_16x16x32_bf16 a[148:151], a[116:119], a[88:91], a[148:151]
    buffer_load_dwordx4 v23, s[20:23], s50 offen offset:1024 lds
    v_mfma_f32_16x16x32_bf16 a[180:183], a[116:119], a[92:95], a[180:183]
    ds_read_b64_tr_b16 a[62:63], v35 offset:2048
    v_mfma_f32_16x16x32_bf16 v[76:79], a[120:123], a[64:67], v[76:79]
    v_mfma_f32_16x16x32_bf16 v[92:95], a[120:123], a[68:71], v[92:95]
    buffer_load_dwordx4 v24, s[20:23], s50 offen offset:2048 lds
    v_mfma_f32_16x16x32_bf16 v[108:111], a[120:123], a[72:75], v[108:111]
    v_mfma_f32_16x16x32_bf16 v[124:127], a[120:123], a[76:79], v[124:127]
    v_mfma_f32_16x16x32_bf16 v[140:143], a[120:123], a[80:83], v[140:143]
    v_mfma_f32_16x16x32_bf16 v[156:159], a[120:123], a[84:87], v[156:159]
    buffer_load_dwordx4 v25, s[20:23], s50 offen offset:3072 lds
    v_mfma_f32_16x16x32_bf16 a[152:155], a[120:123], a[88:91], a[152:155]
    v_mfma_f32_16x16x32_bf16 a[184:187], a[120:123], a[92:95], a[184:187]
    s_add_u32 s50, s50, 0x80000
    v_mfma_f32_16x16x32_bf16 v[172:175], a[124:127], a[64:67], v[172:175]
    v_mfma_f32_16x16x32_bf16 v[188:191], a[124:127], a[68:71], v[188:191]
    s_cmp_eq_u32 s51, s53
    s_cbranch_scc1 k12_ool_20
k12_oolret_21:
    v_mfma_f32_16x16x32_bf16 v[204:207], a[124:127], a[72:75], v[204:207]
    v_mfma_f32_16x16x32_bf16 v[220:223], a[124:127], a[76:79], v[220:223]
    s_cmp_eq_u32 s51, 5
    s_cbranch_scc1 k12_ool_22
k12_oolret_23:
    v_mfma_f32_16x16x32_bf16 v[236:239], a[124:127], a[80:83], v[236:239]
    v_mfma_f32_16x16x32_bf16 v[252:255], a[124:127], a[84:87], v[252:255]
    s_add_u32 s51, s51, 1
    v_mfma_f32_16x16x32_bf16 a[156:159], a[124:127], a[88:91], a[156:159]
    v_mfma_f32_16x16x32_bf16 a[188:191], a[124:127], a[92:95], a[188:191]
    s_waitcnt lgkmcnt(0)
    s_branch k12_loop_8
k12_last_9:
    v_mfma_f32_16x16x32_bf16 v[64:67], a[96:99], a[64:67], v[64:67]
    s_add_u32 m0, s60, 98304
    v_mfma_f32_16x16x32_bf16 v[160:163], a[100:103], a[64:67], v[160:163]
    buffer_load_dwordx4 v38, s[12:15], s61 offen offset:0 lds
    v_mfma_f32_16x16x32_bf16 v[68:71], a[104:107], a[64:67], v[68:71]
    buffer_load_dwordx4 v39, s[12:15], s61 offen offset:1024 lds
    v_mfma_f32_16x16x32_bf16 v[164:167], a[108:111], a[64:67], v[164:167]
    v_mfma_f32_16x16x32_bf16 v[72:75], a[112:115], a[64:67], v[72:75]
    buffer_load_dwordx4 v40, s[12:15], s61 offen offset:2048 lds
    v_mfma_f32_16x16x32_bf16 v[168:171], a[116:119], a[64:67], v[168:171]
    v_cvt_pk_bf16_f32 v64, v64, v65
    v_cvt_pk_bf16_f32 v65, v66, v67
    v_cvt_pk_bf16_f32 v66, v160, v161
    v_mfma_f32_16x16x32_bf16 v[76:79], a[120:123], a[64:67], v[76:79]
    v_cvt_pk_bf16_f32 v67, v162, v163
    v_mfma_f32_16x16x32_bf16 v[172:175], a[124:127], a[64:67], v[172:175]
    v_cvt_pk_bf16_f32 v68, v68, v69
    v_cvt_pk_bf16_f32 v69, v70, v71
    v_cvt_pk_bf16_f32 v70, v164, v165
    v_mfma_f32_16x16x32_bf16 v[80:83], a[96:99], a[68:71], v[80:83]
    buffer_load_dwordx4 v41, s[12:15], s61 offen offset:3072 lds
    v_mfma_f32_16x16x32_bf16 v[176:179], a[100:103], a[68:71], v[176:179]
    s_add_u32 s61, s61, 0x80000
    v_cvt_pk_bf16_f32 v71, v166, v167
    v_cvt_pk_bf16_f32 v72, v72, v73
    v_cvt_pk_bf16_f32 v73, v74, v75
    v_mfma_f32_16x16x32_bf16 v[84:87], a[104:107], a[68:71], v[84:87]
    buffer_load_dwordx4 a[192:195], v36, s[8:11], s62 offen sc1
    buffer_load_dwordx4 a[196:199], v54, s[8:11], s62 offen sc1
    v_mfma_f32_16x16x32_bf16 v[180:183], a[108:111], a[68:71], v[180:183]
    v_cvt_pk_bf16_f32 v74, v168, v169
    v_cvt_pk_bf16_f32 v75, v170, v171
    v_cvt_pk_bf16_f32 v76, v76, v77
    v_mfma_f32_16x16x32_bf16 v[88:91], a[112:115], a[68:71], v[88:91]
    v_cvt_pk_bf16_f32 v77, v78, v79
    v_cvt_pk_bf16_f32 v78, v172, v173
    v_cvt_pk_bf16_f32 v79, v174, v175
    v_mfma_f32_16x16x32_bf16 v[184:187], a[116:119], a[68:71], v[184:187]
    v_cvt_pk_bf16_f32 v80, v80, v81
    v_cvt_pk_bf16_f32 v81, v82, v83
    v_cvt_pk_bf16_f32 v82, v176, v177
    v_mfma_f32_16x16x32_bf16 v[92:95], a[120:123], a[68:71], v[92:95]
    buffer_load_dwordx4 a[200:203], v37, s[8:11], s62 offen sc1
    buffer_load_dwordx4 a[204:207], v55, s[8:11], s62 offen sc1
    v_mfma_f32_16x16x32_bf16 v[188:191], a[124:127], a[68:71], v[188:191]
    s_add_u32 s62, s62, 0x20000
    v_cvt_pk_bf16_f32 v83, v178, v179
    v_cvt_pk_bf16_f32 v84, v84, v85
    v_cvt_pk_bf16_f32 v85, v86, v87
    v_mfma_f32_16x16x32_bf16 a[128:131], a[96:99], a[88:91], a[128:131]
    v_cvt_pk_bf16_f32 v86, v180, v181
    v_cvt_pk_bf16_f32 v87, v182, v183
    v_mfma_f32_16x16x32_bf16 a[132:135], a[100:103], a[88:91], a[132:135]
    v_cvt_pk_bf16_f32 v88, v88, v89
    v_cvt_pk_bf16_f32 v89, v90, v91
    v_cvt_pk_bf16_f32 v90, v184, v185
    v_mfma_f32_16x16x32_bf16 v[96:99], a[96:99], a[72:75], v[96:99]
    buffer_load_dwordx4 a[208:211], v36, s[8:11], s62 offen sc1
    buffer_load_dwordx4 a[212:215], v54, s[8:11], s62 offen sc1
    v_mfma_f32_16x16x32_bf16 v[192:195], a[100:103], a[72:75], v[192:195]
    v_cvt_pk_bf16_f32 v91, v186, v187
    v_cvt_pk_bf16_f32 v92, v92, v93
    v_cvt_pk_bf16_f32 v93, v94, v95
    v_mfma_f32_16x16x32_bf16 v[100:103], a[104:107], a[72:75], v[100:103]
    v_cvt_pk_bf16_f32 v94, v188, v189
    v_cvt_pk_bf16_f32 v95, v190, v191
    v_mfma_f32_16x16x32_bf16 v[196:199], a[108:111], a[72:75], v[196:199]
    v_accvgpr_read_b32 v56, a128
    v_accvgpr_read_b32 v57, a129
    v_accvgpr_read_b32 v58, a130
    v_mfma_f32_16x16x32_bf16 a[136:139], a[104:107], a[88:91], a[136:139]
    buffer_load_dwordx4 a[216:219], v37, s[8:11], s62 offen sc1
    buffer_load_dwordx4 a[220:223], v55, s[8:11], s62 offen sc1
    v_mfma_f32_16x16x32_bf16 a[140:143], a[108:111], a[88:91], a[140:143]
    s_add_u32 s62, s62, 0x20000
    v_accvgpr_read_b32 v59, a131
    v_accvgpr_read_b32 v60, a132
    v_cvt_pk_bf16_f32 v96, v96, v97
    v_mfma_f32_16x16x32_bf16 v[104:107], a[112:115], a[72:75], v[104:107]
    s_add_u32 m0, s60, 114688
    v_accvgpr_read_b32 v61, a133
    v_accvgpr_read_b32 v62, a134
    v_cvt_pk_bf16_f32 v97, v98, v99
    v_mfma_f32_16x16x32_bf16 v[200:203], a[116:119], a[72:75], v[200:203]
    v_accvgpr_read_b32 v63, a135
    v_cvt_pk_bf16_f32 v98, v192, v193
    v_cvt_pk_bf16_f32 v160, v56, v57
    v_mfma_f32_16x16x32_bf16 v[108:111], a[120:123], a[72:75], v[108:111]
    v_cvt_pk_bf16_f32 v99, v194, v195
    v_cvt_pk_bf16_f32 v161, v58, v59
    v_cvt_pk_bf16_f32 v100, v100, v101
    v_mfma_f32_16x16x32_bf16 v[204:207], a[124:127], a[72:75], v[204:207]
    buffer_load_dwordx4 v38, s[12:15], s61 offen offset:0 lds
    buffer_load_dwordx4 v39, s[12:15], s61 offen offset:1024 lds
    v_mfma_f32_16x16x32_bf16 a[144:147], a[112:115], a[88:91], a[144:147]
    v_cvt_pk_bf16_f32 v162, v60, v61
    v_cvt_pk_bf16_f32 v101, v102, v103
    v_cvt_pk_bf16_f32 v163, v62, v63
    v_mfma_f32_16x16x32_bf16 a[148:151], a[116:119], a[88:91], a[148:151]
    v_cvt_pk_bf16_f32 v102, v196, v197
    v_cvt_pk_bf16_f32 v103, v198, v199
    v_accvgpr_read_b32 v56, a136
    v_mfma_f32_16x16x32_bf16 v[112:115], a[96:99], a[76:79], v[112:115]
    v_accvgpr_read_b32 v57, a137
    v_accvgpr_read_b32 v58, a138
    v_accvgpr_read_b32 v59, a139
    v_mfma_f32_16x16x32_bf16 v[208:211], a[100:103], a[76:79], v[208:211]
    v_accvgpr_read_b32 v60, a140
    v_cvt_pk_bf16_f32 v104, v104, v105
    v_accvgpr_read_b32 v61, a141
    v_mfma_f32_16x16x32_bf16 v[116:119], a[104:107], a[76:79], v[116:119]
    buffer_load_dwordx4 v40, s[12:15], s61 offen offset:2048 lds
    buffer_load_dwordx4 v41, s[12:15], s61 offen offset:3072 lds
    v_mfma_f32_16x16x32_bf16 v[212:215], a[108:111], a[76:79], v[212:215]
    s_add_u32 s61, s61, 0x80000
    v_accvgpr_read_b32 v62, a142
    v_cvt_pk_bf16_f32 v105, v106, v107
    v_accvgpr_read_b32 v63, a143
    v_mfma_f32_16x16x32_bf16 a[152:155], a[120:123], a[88:91], a[152:155]
    v_cvt_pk_bf16_f32 v106, v200, v201
    v_cvt_pk_bf16_f32 v164, v56, v57
    v_cvt_pk_bf16_f32 v107, v202, v203
    v_mfma_f32_16x16x32_bf16 a[156:159], a[124:127], a[88:91], a[156:159]
    v_cvt_pk_bf16_f32 v165, v58, v59
    v_cvt_pk_bf16_f32 v108, v108, v109
    v_cvt_pk_bf16_f32 v166, v60, v61
    v_mfma_f32_16x16x32_bf16 v[120:123], a[112:115], a[76:79], v[120:123]
    v_cvt_pk_bf16_f32 v109, v110, v111
    v_cvt_pk_bf16_f32 v167, v62, v63
    v_cvt_pk_bf16_f32 v110, v204, v205
    v_mfma_f32_16x16x32_bf16 v[216:219], a[116:119], a[76:79], v[216:219]
    buffer_load_dwordx4 a[224:227], v36, s[8:11], s62 offen sc1
    v_cvt_pk_bf16_f32 v111, v206, v207
    v_accvgpr_read_b32 v56, a144
    v_mfma_f32_16x16x32_bf16 v[124:127], a[120:123], a[76:79], v[124:127]
    v_accvgpr_read_b32 v57, a145
    v_accvgpr_read_b32 v58, a146
    v_accvgpr_read_b32 v59, a147
    v_mfma_f32_16x16x32_bf16 v[220:223], a[124:127], a[76:79], v[220:223]
    buffer_load_dwordx4 a[228:231], v54, s[8:11], s62 offen sc1
    v_accvgpr_read_b32 v60, a148
    v_cvt_pk_bf16_f32 v112, v112, v113
    v_mfma_f32_16x16x32_bf16 a[160:163], a[96:99], a[92:95], a[160:163]
    v_accvgpr_read_b32 v61, a149
    v_accvgpr_read_b32 v62, a150
    v_cvt_pk_bf16_f32 v113, v114, v115
    v_mfma_f32_16x16x32_bf16 a[164:167], a[100:103], a[92:95], a[164:167]
    v_accvgpr_read_b32 v63, a151
    v_cvt_pk_bf16_f32 v114, v208, v209
    v_cvt_pk_bf16_f32 v168, v56, v57
    v_mfma_f32_16x16x32_bf16 v[128:131], a[96:99], a[80:83], v[128:131]
    v_cvt_pk_bf16_f32 v115, v210, v211
    v_cvt_pk_bf16_f32 v169, v58, v59
    v_cvt_pk_bf16_f32 v116, v116, v117
    v_mfma_f32_16x16x32_bf16 v[224:227], a[100:103], a[80:83], v[224:227]
    buffer_load_dwordx4 a[232:235], v37, s[8:11], s62 offen sc1
    v_cvt_pk_bf16_f32 v170, v60, v61
    v_cvt_pk_bf16_f32 v117, v118, v119
    v_mfma_f32_16x16x32_bf16 v[132:135], a[104:107], a[80:83], v[132:135]
    v_cvt_pk_bf16_f32 v171, v62, v63
    v_cvt_pk_bf16_f32 v118, v212, v213
    v_cvt_pk_bf16_f32 v119, v214, v215
    v_mfma_f32_16x16x32_bf16 v[228:231], a[108:111], a[80:83], v[228:231]
    buffer_load_dwordx4 a[236:239], v55, s[8:11], s62 offen sc1
    v_accvgpr_read_b32 v56, a152
    v_accvgpr_read_b32 v57, a153
    v_mfma_f32_16x16x32_bf16 a[168:171], a[104:107], a[92:95], a[168:171]
    s_add_u32 s62, s62, 0x20000
    v_accvgpr_read_b32 v58, a154
    v_accvgpr_read_b32 v59, a155
    v_accvgpr_read_b32 v60, a156
    v_mfma_f32_16x16x32_bf16 a[172:175], a[108:111], a[92:95], a[172:175]
    s_waitcnt vmcnt(16)
    s_barrier
    v_cvt_pk_bf16_f32 v120, v120, v121
    v_accvgpr_read_b32 v61, a157
    v_accvgpr_read_b32 v62, a158
    v_mfma_f32_16x16x32_bf16 v[136:139], a[112:115], a[80:83], v[136:139]
    v_cvt_pk_bf16_f32 v121, v122, v123
    v_accvgpr_read_b32 v63, a159
    v_cvt_pk_bf16_f32 v122, v216, v217
    v_mfma_f32_16x16x32_bf16 v[232:235], a[116:119], a[80:83], v[232:235]
    v_cvt_pk_bf16_f32 v172, v56, v57
    v_cvt_pk_bf16_f32 v123, v218, v219
    v_cvt_pk_bf16_f32 v173, v58, v59
    v_mfma_f32_16x16x32_bf16 v[140:143], a[120:123], a[80:83], v[140:143]
    v_cvt_pk_bf16_f32 v124, v124, v125
    v_cvt_pk_bf16_f32 v174, v60, v61
    v_cvt_pk_bf16_f32 v125, v126, v127
    v_mfma_f32_16x16x32_bf16 v[236:239], a[124:127], a[80:83], v[236:239]
    v_cvt_pk_bf16_f32 v175, v62, v63
    v_cvt_pk_bf16_f32 v126, v220, v221
    v_cvt_pk_bf16_f32 v127, v222, v223
    v_mfma_f32_16x16x32_bf16 a[176:179], a[112:115], a[92:95], a[176:179]
    ds_read_b64_tr_b16 a[0:1], v42 offset:0
    v_accvgpr_read_b32 v56, a160
    v_accvgpr_read_b32 v57, a161
    v_mfma_f32_16x16x32_bf16 a[180:183], a[116:119], a[92:95], a[180:183]
    ds_read_b64_tr_b16 a[2:3], v42 offset:1024
    v_accvgpr_read_b32 v58, a162
    v_accvgpr_read_b32 v59, a163
    v_mfma_f32_16x16x32_bf16 v[144:147], a[96:99], a[84:87], v[144:147]
    ds_read_b64_tr_b16 a[4:5], v43 offset:0
    v_accvgpr_read_b32 v60, a164
    v_cvt_pk_bf16_f32 v128, v128, v129
    v_mfma_f32_16x16x32_bf16 v[240:243], a[100:103], a[84:87], v[240:243]
    v_accvgpr_read_b32 v61, a165
    v_accvgpr_read_b32 v62, a166
    v_cvt_pk_bf16_f32 v129, v130, v131
    v_mfma_f32_16x16x32_bf16 v[148:151], a[104:107], a[84:87], v[148:151]
    ds_read_b64_tr_b16 a[6:7], v43 offset:1024
    v_accvgpr_read_b32 v63, a167
    v_cvt_pk_bf16_f32 v130, v224, v225
    v_mfma_f32_16x16x32_bf16 v[244:247], a[108:111], a[84:87], v[244:247]
    v_cvt_pk_bf16_f32 v176, v56, v57
    v_cvt_pk_bf16_f32 v131, v226, v227
    v_cvt_pk_bf16_f32 v177, v58, v59
    v_mfma_f32_16x16x32_bf16 a[184:187], a[120:123], a[92:95], a[184:187]
    ds_read_b64_tr_b16 a[8:9], v44 offset:0
    v_cvt_pk_bf16_f32 v132, v132, v133
    v_cvt_pk_bf16_f32 v178, v60, v61
    v_mfma_f32_16x16x32_bf16 a[188:191], a[124:127], a[92:95], a[188:191]
    ds_read_b64_tr_b16 a[10:11], v44 offset:1024
    v_cvt_pk_bf16_f32 v133, v134, v135
    v_cvt_pk_bf16_f32 v179, v62, v63
    v_mfma_f32_16x16x32_bf16 v[152:155], a[112:115], a[84:87], v[152:155]
    ds_read_b64_tr_b16 a[12:13], v45 offset:0
    v_cvt_pk_bf16_f32 v134, v228, v229
    v_cvt_pk_bf16_f32 v135, v230, v231
    v_mfma_f32_16x16x32_bf16 v[248:251], a[116:119], a[84:87], v[248:251]
    ds_read_b64_tr_b16 a[14:15], v45 offset:1024
    v_accvgpr_read_b32 v56, a168
    v_accvgpr_read_b32 v57, a169
    v_mfma_f32_16x16x32_bf16 v[156:159], a[120:123], a[84:87], v[156:159]
    ds_read_b64_tr_b16 a[16:17], v46 offset:0
    v_accvgpr_read_b32 v58, a170
    v_accvgpr_read_b32 v59, a171
    v_mfma_f32_16x16x32_bf16 v[252:255], a[124:127], a[84:87], v[252:255]
    v_accvgpr_read_b32 v60, a172
    v_cvt_pk_bf16_f32 v136, v136, v137
    v_accvgpr_read_b32 v61, a173
    ds_read_b64_tr_b16 a[18:19], v46 offset:1024
    v_accvgpr_read_b32 v62, a174
    v_cvt_pk_bf16_f32 v137, v138, v139
    v_accvgpr_read_b32 v63, a175
    v_cvt_pk_bf16_f32 v138, v232, v233
    v_cvt_pk_bf16_f32 v180, v56, v57
    ds_read_b64_tr_b16 a[20:21], v47 offset:0
    v_cvt_pk_bf16_f32 v139, v234, v235
    v_cvt_pk_bf16_f32 v181, v58, v59
    v_cvt_pk_bf16_f32 v140, v140, v141
    v_cvt_pk_bf16_f32 v182, v60, v61
    ds_read_b64_tr_b16 a[22:23], v47 offset:1024
    v_cvt_pk_bf16_f32 v141, v142, v143
    v_cvt_pk_bf16_f32 v183, v62, v63
    v_cvt_pk_bf16_f32 v142, v236, v237
    ds_read_b64_tr_b16 a[24:25], v48 offset:0
    v_cvt_pk_bf16_f32 v143, v238, v239
    v_accvgpr_read_b32 v56, a176
    ds_read_b64_tr_b16 a[26:27], v48 offset:1024
    v_accvgpr_read_b32 v57, a177
    v_accvgpr_read_b32 v58, a178
    ds_read_b64_tr_b16 a[28:29], v49 offset:0
    v_accvgpr_read_b32 v59, a179
    v_accvgpr_read_b32 v60, a180
    v_cvt_pk_bf16_f32 v144, v144, v145
    ds_read_b64_tr_b16 a[30:31], v49 offset:1024
    v_accvgpr_read_b32 v61, a181
    v_accvgpr_read_b32 v62, a182
    v_cvt_pk_bf16_f32 v145, v146, v147
    v_accvgpr_read_b32 v63, a183
    v_cvt_pk_bf16_f32 v146, v240, v241
    v_cvt_pk_bf16_f32 v184, v56, v57
    v_cvt_pk_bf16_f32 v147, v242, v243
    v_cvt_pk_bf16_f32 v185, v58, v59
    v_cvt_pk_bf16_f32 v148, v148, v149
    v_cvt_pk_bf16_f32 v186, v60, v61
    v_cvt_pk_bf16_f32 v149, v150, v151
    v_cvt_pk_bf16_f32 v187, v62, v63
    v_cvt_pk_bf16_f32 v150, v244, v245
    v_cvt_pk_bf16_f32 v151, v246, v247
    v_accvgpr_read_b32 v56, a184
    v_accvgpr_read_b32 v57, a185
    v_accvgpr_read_b32 v58, a186
    v_accvgpr_read_b32 v59, a187
    v_accvgpr_read_b32 v60, a188
    v_cvt_pk_bf16_f32 v152, v152, v153
    v_accvgpr_read_b32 v61, a189
    v_accvgpr_read_b32 v62, a190
    v_cvt_pk_bf16_f32 v153, v154, v155
    v_accvgpr_read_b32 v63, a191
    v_cvt_pk_bf16_f32 v154, v248, v249
    v_cvt_pk_bf16_f32 v188, v56, v57
    v_cvt_pk_bf16_f32 v155, v250, v251
    v_cvt_pk_bf16_f32 v189, v58, v59
    v_cvt_pk_bf16_f32 v156, v156, v157
    v_cvt_pk_bf16_f32 v190, v60, v61
    v_cvt_pk_bf16_f32 v157, v158, v159
    v_cvt_pk_bf16_f32 v191, v62, v63
    v_cvt_pk_bf16_f32 v158, v252, v253
    v_cvt_pk_bf16_f32 v159, v254, v255
    s_branch k12_join_7
k12_v_6:
k12_loop_24:
    v_mfma_f32_16x16x32_bf16 v[64:67], a[0:3], a[32:35], v[64:67]
    ds_read_b128 a[64:67], v27 offset:0
    v_mfma_f32_16x16x32_bf16 v[68:71], a[0:3], a[36:39], v[68:71]
    ds_read_b64_tr_b16 a[96:97], v28 offset:16384
    v_mfma_f32_16x16x32_bf16 v[72:75], a[0:3], a[40:43], v[72:75]
    v_mfma_f32_16x16x32_bf16 v[76:79], a[0:3], a[44:47], v[76:79]
    s_cmp_eq_u32 s51, s46
    s_cbranch_scc1 k12_ool_26
k12_oolret_27:
    v_mfma_f32_16x16x32_bf16 v[80:83], a[0:3], a[48:51], v[80:83]
    ds_read_b64_tr_b16 a[98:99], v28 offset:18432
    v_mfma_f32_16x16x32_bf16 v[84:87], a[0:3], a[52:55], v[84:87]
    ds_read_b128 a[68:71], v27 offset:2048
    v_mfma_f32_16x16x32_bf16 v[88:91], a[0:3], a[56:59], v[88:91]
    v_mfma_f32_16x16x32_bf16 v[92:95], a[0:3], a[60:63], v[92:95]
    ds_read_b64_tr_b16 a[100:101], v29 offset:16384
    v_mfma_f32_16x16x32_bf16 v[160:163], a[4:7], a[32:35], v[160:163]
    v_mfma_f32_16x16x32_bf16 v[164:167], a[4:7], a[36:39], v[164:167]
    ds_read_b64_tr_b16 a[102:103], v29 offset:18432
    v_mfma_f32_16x16x32_bf16 v[168:171], a[4:7], a[40:43], v[168:171]
    v_mfma_f32_16x16x32_bf16 v[172:175], a[4:7], a[44:47], v[172:175]
    ds_read_b128 a[72:75], v27 offset:4096
    v_mfma_f32_16x16x32_bf16 v[176:179], a[4:7], a[48:51], v[176:179]
    v_mfma_f32_16x16x32_bf16 v[180:183], a[4:7], a[52:55], v[180:183]
    v_mfma_f32_16x16x32_bf16 v[184:187], a[4:7], a[56:59], v[184:187]
    ds_read_b64_tr_b16 a[104:105], v30 offset:16384
    v_mfma_f32_16x16x32_bf16 v[188:191], a[4:7], a[60:63], v[188:191]
    v_mfma_f32_16x16x32_bf16 v[96:99], a[8:11], a[32:35], v[96:99]
    ds_read_b64_tr_b16 a[106:107], v30 offset:18432
    v_mfma_f32_16x16x32_bf16 v[100:103], a[8:11], a[36:39], v[100:103]
    v_mfma_f32_16x16x32_bf16 v[104:107], a[8:11], a[40:43], v[104:107]
    ds_read_b128 a[76:79], v27 offset:6144
    v_mfma_f32_16x16x32_bf16 v[108:111], a[8:11], a[44:47], v[108:111]
    v_mfma_f32_16x16x32_bf16 v[112:115], a[8:11], a[48:51], v[112:115]
    ds_read_b64_tr_b16 a[108:109], v31 offset:16384
    v_mfma_f32_16x16x32_bf16 v[116:119], a[8:11], a[52:55], v[116:119]
    v_mfma_f32_16x16x32_bf16 v[120:123], a[8:11], a[56:59], v[120:123]
    ds_read_b64_tr_b16 a[110:111], v31 offset:18432
    v_mfma_f32_16x16x32_bf16 v[124:127], a[8:11], a[60:63], v[124:127]
    v_mfma_f32_16x16x32_bf16 v[192:195], a[12:15], a[32:35], v[192:195]
    ds_read_b128 a[80:83], v27 offset:8192
    v_mfma_f32_16x16x32_bf16 v[196:199], a[12:15], a[36:39], v[196:199]
    v_mfma_f32_16x16x32_bf16 v[200:203], a[12:15], a[40:43], v[200:203]
    ds_read_b64_tr_b16 a[112:113], v32 offset:16384
    v_mfma_f32_16x16x32_bf16 v[204:207], a[12:15], a[44:47], v[204:207]
    v_mfma_f32_16x16x32_bf16 v[208:211], a[12:15], a[48:51], v[208:211]
    ds_read_b64_tr_b16 a[114:115], v32 offset:18432
    v_mfma_f32_16x16x32_bf16 v[212:215], a[12:15], a[52:55], v[212:215]
    v_mfma_f32_16x16x32_bf16 v[216:219], a[12:15], a[56:59], v[216:219]
    ds_read_b128 a[84:87], v27 offset:10240
    v_mfma_f32_16x16x32_bf16 v[220:223], a[12:15], a[60:63], v[220:223]
    v_mfma_f32_16x16x32_bf16 v[128:131], a[16:19], a[32:35], v[128:131]
    ds_read_b64_tr_b16 a[116:117], v33 offset:16384
    v_mfma_f32_16x16x32_bf16 v[132:135], a[16:19], a[36:39], v[132:135]
    v_mfma_f32_16x16x32_bf16 v[136:139], a[16:19], a[40:43], v[136:139]
    ds_read_b64_tr_b16 a[118:119], v33 offset:18432
    v_mfma_f32_16x16x32_bf16 v[140:143], a[16:19], a[44:47], v[140:143]
    v_mfma_f32_16x16x32_bf16 v[144:147], a[16:19], a[48:51], v[144:147]
    ds_read_b128 a[88:91], v27 offset:12288
    v_mfma_f32_16x16x32_bf16 v[148:151], a[16:19], a[52:55], v[148:151]
    v_mfma_f32_16x16x32_bf16 v[152:155], a[16:19], a[56:59], v[152:155]
    v_mfma_f32_16x16x32_bf16 v[156:159], a[16:19], a[60:63], v[156:159]
    ds_read_b64_tr_b16 a[120:121], v34 offset:16384
    v_mfma_f32_16x16x32_bf16 v[224:227], a[20:23], a[32:35], v[224:227]
    v_mfma_f32_16x16x32_bf16 v[228:231], a[20:23], a[36:39], v[228:231]
    ds_read_b64_tr_b16 a[122:123], v34 offset:18432
    v_mfma_f32_16x16x32_bf16 v[232:235], a[20:23], a[40:43], v[232:235]
    v_mfma_f32_16x16x32_bf16 v[236:239], a[20:23], a[44:47], v[236:239]
    ds_read_b128 a[92:95], v27 offset:14336
    v_mfma_f32_16x16x32_bf16 v[240:243], a[20:23], a[48:51], v[240:243]
    v_mfma_f32_16x16x32_bf16 v[244:247], a[20:23], a[52:55], v[244:247]
    ds_read_b64_tr_b16 a[124:125], v35 offset:16384
    v_mfma_f32_16x16x32_bf16 v[248:251], a[20:23], a[56:59], v[248:251]
    v_mfma_f32_16x16x32_bf16 v[252:255], a[20:23], a[60:63], v[252:255]
    ds_read_b64_tr_b16 a[126:127], v35 offset:18432
    v_mfma_f32_16x16x32_bf16 a[128:131], a[24:27], a[32:35], a[128:131]
    v_mfma_f32_16x16x32_bf16 a[136:139], a[24:27], a[36:39], a[136:139]
    v_mfma_f32_16x16x32_bf16 a[144:147], a[24:27], a[40:43], a[144:147]
    v_mfma_f32_16x16x32_bf16 a[152:155], a[24:27], a[44:47], a[152:155]
    v_mfma_f32_16x16x32_bf16 a[160:163], a[24:27], a[48:51], a[160:163]
    v_mfma_f32_16x16x32_bf16 a[168:171], a[24:27], a[52:55], a[168:171]
    v_mfma_f32_16x16x32_bf16 a[176:179], a[24:27], a[56:59], a[176:179]
    v_mfma_f32_16x16x32_bf16 a[184:187], a[24:27], a[60:63], a[184:187]
    v_mfma_f32_16x16x32_bf16 a[132:135], a[28:31], a[32:35], a[132:135]
    v_mfma_f32_16x16x32_bf16 a[140:143], a[28:31], a[36:39], a[140:143]
    v_mfma_f32_16x16x32_bf16 a[148:151], a[28:31], a[40:43], a[148:151]
    v_mfma_f32_16x16x32_bf16 a[156:159], a[28:31], a[44:47], a[156:159]
    v_mfma_f32_16x16x32_bf16 a[164:167], a[28:31], a[48:51], a[164:167]
    v_mfma_f32_16x16x32_bf16 a[172:175], a[28:31], a[52:55], a[172:175]
    v_mfma_f32_16x16x32_bf16 a[180:183], a[28:31], a[56:59], a[180:183]
    v_mfma_f32_16x16x32_bf16 a[188:191], a[28:31], a[60:63], a[188:191]
    s_waitcnt vmcnt(0) lgkmcnt(0)
    s_barrier
    v_mfma_f32_16x16x32_bf16 v[64:67], a[64:67], a[96:99], v[64:67]
    s_cmp_ge_u32 s49, 1024
    s_cselect_b32 s18, 0, s18
    s_cselect_b32 s22, 0, s22
    ds_read_b128 a[0:3], v26 offset:32768
    v_mfma_f32_16x16x32_bf16 v[68:71], a[64:67], a[100:103], v[68:71]
    s_add_u32 m0, s48, 0
    ds_read_b64_tr_b16 a[32:33], v28 offset:32768
    v_mfma_f32_16x16x32_bf16 v[72:75], a[64:67], a[104:107], v[72:75]
    buffer_load_dwordx4 v10, s[16:19], s49 offen offset:0 lds
    v_mfma_f32_16x16x32_bf16 v[76:79], a[64:67], a[108:111], v[76:79]
    ds_read_b64_tr_b16 a[34:35], v28 offset:34816
    v_mfma_f32_16x16x32_bf16 v[80:83], a[64:67], a[112:115], v[80:83]
    buffer_load_dwordx4 v11, s[16:19], s49 offen offset:1024 lds
    v_mfma_f32_16x16x32_bf16 v[84:87], a[64:67], a[116:119], v[84:87]
    ds_read_b128 a[4:7], v26 offset:34816
    v_mfma_f32_16x16x32_bf16 v[88:91], a[64:67], a[120:123], v[88:91]
    v_mfma_f32_16x16x32_bf16 v[92:95], a[64:67], a[124:127], v[92:95]
    ds_read_b64_tr_b16 a[36:37], v29 offset:32768
    v_mfma_f32_16x16x32_bf16 v[160:163], a[68:71], a[96:99], v[160:163]
    buffer_load_dwordx4 v12, s[16:19], s49 offen offset:2048 lds
    v_mfma_f32_16x16x32_bf16 v[164:167], a[68:71], a[100:103], v[164:167]
    ds_read_b64_tr_b16 a[38:39], v29 offset:34816
    v_mfma_f32_16x16x32_bf16 v[168:171], a[68:71], a[104:107], v[168:171]
    v_mfma_f32_16x16x32_bf16 v[172:175], a[68:71], a[108:111], v[172:175]
    buffer_load_dwordx4 v13, s[16:19], s49 offen offset:3072 lds
    ds_read_b128 a[8:11], v26 offset:36864
    v_mfma_f32_16x16x32_bf16 v[176:179], a[68:71], a[112:115], v[176:179]
    v_mfma_f32_16x16x32_bf16 v[180:183], a[68:71], a[116:119], v[180:183]
    s_add_u32 m0, s48, 4096
    v_mfma_f32_16x16x32_bf16 v[184:187], a[68:71], a[120:123], v[184:187]
    ds_read_b64_tr_b16 a[40:41], v30 offset:32768
    v_mfma_f32_16x16x32_bf16 v[188:191], a[68:71], a[124:127], v[188:191]
    buffer_load_dwordx4 v14, s[16:19], s49 offen offset:0 lds
    v_mfma_f32_16x16x32_bf16 v[96:99], a[72:75], a[96:99], v[96:99]
    ds_read_b64_tr_b16 a[42:43], v30 offset:34816
    v_mfma_f32_16x16x32_bf16 v[100:103], a[72:75], a[100:103], v[100:103]
    v_mfma_f32_16x16x32_bf16 v[104:107], a[72:75], a[104:107], v[104:107]
    buffer_load_dwordx4 v15, s[16:19], s49 offen offset:1024 lds
    ds_read_b128 a[12:15], v26 offset:38912
    v_mfma_f32_16x16x32_bf16 v[108:111], a[72:75], a[108:111], v[108:111]
    v_mfma_f32_16x16x32_bf16 v[112:115], a[72:75], a[112:115], v[112:115]
    ds_read_b64_tr_b16 a[44:45], v31 offset:32768
    v_mfma_f32_16x16x32_bf16 v[116:119], a[72:75], a[116:119], v[116:119]
    v_mfma_f32_16x16x32_bf16 v[120:123], a[72:75], a[120:123], v[120:123]
    buffer_load_dwordx4 v16, s[16:19], s49 offen offset:2048 lds
    ds_read_b64_tr_b16 a[46:47], v31 offset:34816
    v_mfma_f32_16x16x32_bf16 v[124:127], a[72:75], a[124:127], v[124:127]
    v_mfma_f32_16x16x32_bf16 v[192:195], a[76:79], a[96:99], v[192:195]
    ds_read_b128 a[16:19], v26 offset:40960
    v_mfma_f32_16x16x32_bf16 v[196:199], a[76:79], a[100:103], v[196:199]
    buffer_load_dwordx4 v17, s[16:19], s49 offen offset:3072 lds
    v_mfma_f32_16x16x32_bf16 v[200:203], a[76:79], a[104:107], v[200:203]
    ds_read_b64_tr_b16 a[48:49], v32 offset:32768
    v_mfma_f32_16x16x32_bf16 v[204:207], a[76:79], a[108:111], v[204:207]
    s_add_u32 s49, s49, 128
    v_mfma_f32_16x16x32_bf16 v[208:211], a[76:79], a[112:115], v[208:211]
    s_add_u32 m0, s48, 65536
    ds_read_b64_tr_b16 a[50:51], v32 offset:34816
    v_mfma_f32_16x16x32_bf16 v[212:215], a[76:79], a[116:119], v[212:215]
    buffer_load_dwordx4 v18, s[20:23], s50 offen offset:0 lds
    v_mfma_f32_16x16x32_bf16 v[216:219], a[76:79], a[120:123], v[216:219]
    ds_read_b128 a[20:23], v26 offset:43008
    v_mfma_f32_16x16x32_bf16 v[220:223], a[76:79], a[124:127], v[220:223]
    v_mfma_f32_16x16x32_bf16 v[128:131], a[80:83], a[96:99], v[128:131]
    buffer_load_dwordx4 v19, s[20:23], s50 offen offset:1024 lds
    ds_read_b64_tr_b16 a[52:53], v33 offset:32768
    v_mfma_f32_16x16x32_bf16 v[132:135], a[80:83], a[100:103], v[132:135]
    v_mfma_f32_16x16x32_bf16 v[136:139], a[80:83], a[104:107], v[136:139]
    ds_read_b64_tr_b16 a[54:55], v33 offset:34816
    v_mfma_f32_16x16x32_bf16 v[140:143], a[80:83], a[108:111], v[140:143]
    buffer_load_dwordx4 v20, s[20:23], s50 offen offset:2048 lds
    v_mfma_f32_16x16x32_bf16 v[144:147], a[80:83], a[112:115], v[144:147]
    ds_read_b128 a[24:27], v26 offset:45056
    v_mfma_f32_16x16x32_bf16 v[148:151], a[80:83], a[116:119], v[148:151]
    v_mfma_f32_16x16x32_bf16 v[152:155], a[80:83], a[120:123], v[152:155]
    v_mfma_f32_16x16x32_bf16 v[156:159], a[80:83], a[124:127], v[156:159]
    buffer_load_dwordx4 v21, s[20:23], s50 offen offset:3072 lds
    ds_read_b64_tr_b16 a[56:57], v34 offset:32768
    v_mfma_f32_16x16x32_bf16 v[224:227], a[84:87], a[96:99], v[224:227]
    s_add_u32 m0, s48, 69632
    v_mfma_f32_16x16x32_bf16 v[228:231], a[84:87], a[100:103], v[228:231]
    ds_read_b64_tr_b16 a[58:59], v34 offset:34816
    v_mfma_f32_16x16x32_bf16 v[232:235], a[84:87], a[104:107], v[232:235]
    buffer_load_dwordx4 v22, s[20:23], s50 offen offset:0 lds
    v_mfma_f32_16x16x32_bf16 v[236:239], a[84:87], a[108:111], v[236:239]
    ds_read_b128 a[28:31], v26 offset:47104
    v_mfma_f32_16x16x32_bf16 v[240:243], a[84:87], a[112:115], v[240:243]
    v_mfma_f32_16x16x32_bf16 v[244:247], a[84:87], a[116:119], v[244:247]
    ds_read_b64_tr_b16 a[60:61], v35 offset:32768
    v_mfma_f32_16x16x32_bf16 v[248:251], a[84:87], a[120:123], v[248:251]
    buffer_load_dwordx4 v23, s[20:23], s50 offen offset:1024 lds
    v_mfma_f32_16x16x32_bf16 v[252:255], a[84:87], a[124:127], v[252:255]
    ds_read_b64_tr_b16 a[62:63], v35 offset:34816
    v_mfma_f32_16x16x32_bf16 a[128:131], a[88:91], a[96:99], a[128:131]
    v_mfma_f32_16x16x32_bf16 a[136:139], a[88:91], a[100:103], a[136:139]
    buffer_load_dwordx4 v24, s[20:23], s50 offen offset:2048 lds
    v_mfma_f32_16x16x32_bf16 a[144:147], a[88:91], a[104:107], a[144:147]
    v_mfma_f32_16x16x32_bf16 a[152:155], a[88:91], a[108:111], a[152:155]
    v_mfma_f32_16x16x32_bf16 a[160:163], a[88:91], a[112:115], a[160:163]
    v_mfma_f32_16x16x32_bf16 a[168:171], a[88:91], a[116:119], a[168:171]
    buffer_load_dwordx4 v25, s[20:23], s50 offen offset:3072 lds
    v_mfma_f32_16x16x32_bf16 a[176:179], a[88:91], a[120:123], a[176:179]
    v_mfma_f32_16x16x32_bf16 a[184:187], a[88:91], a[124:127], a[184:187]
    s_add_u32 s50, s50, 0x80000
    v_mfma_f32_16x16x32_bf16 a[132:135], a[92:95], a[96:99], a[132:135]
    v_mfma_f32_16x16x32_bf16 a[140:143], a[92:95], a[100:103], a[140:143]
    s_cmp_eq_u32 s51, s53
    s_cbranch_scc1 k12_ool_28
k12_oolret_29:
    v_mfma_f32_16x16x32_bf16 a[148:151], a[92:95], a[104:107], a[148:151]
    v_mfma_f32_16x16x32_bf16 a[156:159], a[92:95], a[108:111], a[156:159]
    s_cmp_eq_u32 s51, s63
    s_cbranch_scc1 k12_ool_30
k12_oolret_31:
    v_mfma_f32_16x16x32_bf16 a[164:167], a[92:95], a[112:115], a[164:167]
    v_mfma_f32_16x16x32_bf16 a[172:175], a[92:95], a[116:119], a[172:175]
    s_add_u32 s51, s51, 1
    v_mfma_f32_16x16x32_bf16 a[180:183], a[92:95], a[120:123], a[180:183]
    v_mfma_f32_16x16x32_bf16 a[188:191], a[92:95], a[124:127], a[188:191]
    s_waitcnt lgkmcnt(0)
    v_mfma_f32_16x16x32_bf16 v[64:67], a[0:3], a[32:35], v[64:67]
    ds_read_b128 a[64:67], v27 offset:32768
    v_mfma_f32_16x16x32_bf16 v[68:71], a[0:3], a[36:39], v[68:71]
    ds_read_b64_tr_b16 a[96:97], v28 offset:49152
    v_mfma_f32_16x16x32_bf16 v[72:75], a[0:3], a[40:43], v[72:75]
    v_mfma_f32_16x16x32_bf16 v[76:79], a[0:3], a[44:47], v[76:79]
    ds_read_b64_tr_b16 a[98:99], v28 offset:51200
    v_mfma_f32_16x16x32_bf16 v[80:83], a[0:3], a[48:51], v[80:83]
    v_mfma_f32_16x16x32_bf16 v[84:87], a[0:3], a[52:55], v[84:87]
    ds_read_b128 a[68:71], v27 offset:34816
    v_mfma_f32_16x16x32_bf16 v[88:91], a[0:3], a[56:59], v[88:91]
    v_mfma_f32_16x16x32_bf16 v[92:95], a[0:3], a[60:63], v[92:95]
    ds_read_b64_tr_b16 a[100:101], v29 offset:49152
    v_mfma_f32_16x16x32_bf16 v[160:163], a[4:7], a[32:35], v[160:163]
    v_mfma_f32_16x16x32_bf16 v[164:167], a[4:7], a[36:39], v[164:167]
    ds_read_b64_tr_b16 a[102:103], v29 offset:51200
    v_mfma_f32_16x16x32_bf16 v[168:171], a[4:7], a[40:43], v[168:171]
    v_mfma_f32_16x16x32_bf16 v[172:175], a[4:7], a[44:47], v[172:175]
    ds_read_b128 a[72:75], v27 offset:36864
    v_mfma_f32_16x16x32_bf16 v[176:179], a[4:7], a[48:51], v[176:179]
    v_mfma_f32_16x16x32_bf16 v[180:183], a[4:7], a[52:55], v[180:183]
    v_mfma_f32_16x16x32_bf16 v[184:187], a[4:7], a[56:59], v[184:187]
    ds_read_b64_tr_b16 a[104:105], v30 offset:49152
    v_mfma_f32_16x16x32_bf16 v[188:191], a[4:7], a[60:63], v[188:191]
    v_mfma_f32_16x16x32_bf16 v[96:99], a[8:11], a[32:35], v[96:99]
    ds_read_b64_tr_b16 a[106:107], v30 offset:51200
    v_mfma_f32_16x16x32_bf16 v[100:103], a[8:11], a[36:39], v[100:103]
    v_mfma_f32_16x16x32_bf16 v[104:107], a[8:11], a[40:43], v[104:107]
    ds_read_b128 a[76:79], v27 offset:38912
    v_mfma_f32_16x16x32_bf16 v[108:111], a[8:11], a[44:47], v[108:111]
    v_mfma_f32_16x16x32_bf16 v[112:115], a[8:11], a[48:51], v[112:115]
    ds_read_b64_tr_b16 a[108:109], v31 offset:49152
    v_mfma_f32_16x16x32_bf16 v[116:119], a[8:11], a[52:55], v[116:119]
    v_mfma_f32_16x16x32_bf16 v[120:123], a[8:11], a[56:59], v[120:123]
    ds_read_b64_tr_b16 a[110:111], v31 offset:51200
    v_mfma_f32_16x16x32_bf16 v[124:127], a[8:11], a[60:63], v[124:127]
    v_mfma_f32_16x16x32_bf16 v[192:195], a[12:15], a[32:35], v[192:195]
    ds_read_b128 a[80:83], v27 offset:40960
    v_mfma_f32_16x16x32_bf16 v[196:199], a[12:15], a[36:39], v[196:199]
    v_mfma_f32_16x16x32_bf16 v[200:203], a[12:15], a[40:43], v[200:203]
    ds_read_b64_tr_b16 a[112:113], v32 offset:49152
    v_mfma_f32_16x16x32_bf16 v[204:207], a[12:15], a[44:47], v[204:207]
    v_mfma_f32_16x16x32_bf16 v[208:211], a[12:15], a[48:51], v[208:211]
    ds_read_b64_tr_b16 a[114:115], v32 offset:51200
    v_mfma_f32_16x16x32_bf16 v[212:215], a[12:15], a[52:55], v[212:215]
    v_mfma_f32_16x16x32_bf16 v[216:219], a[12:15], a[56:59], v[216:219]
    ds_read_b128 a[84:87], v27 offset:43008
    v_mfma_f32_16x16x32_bf16 v[220:223], a[12:15], a[60:63], v[220:223]
    v_mfma_f32_16x16x32_bf16 v[128:131], a[16:19], a[32:35], v[128:131]
    ds_read_b64_tr_b16 a[116:117], v33 offset:49152
    v_mfma_f32_16x16x32_bf16 v[132:135], a[16:19], a[36:39], v[132:135]
    v_mfma_f32_16x16x32_bf16 v[136:139], a[16:19], a[40:43], v[136:139]
    ds_read_b64_tr_b16 a[118:119], v33 offset:51200
    v_mfma_f32_16x16x32_bf16 v[140:143], a[16:19], a[44:47], v[140:143]
    v_mfma_f32_16x16x32_bf16 v[144:147], a[16:19], a[48:51], v[144:147]
    ds_read_b128 a[88:91], v27 offset:45056
    v_mfma_f32_16x16x32_bf16 v[148:151], a[16:19], a[52:55], v[148:151]
    v_mfma_f32_16x16x32_bf16 v[152:155], a[16:19], a[56:59], v[152:155]
    v_mfma_f32_16x16x32_bf16 v[156:159], a[16:19], a[60:63], v[156:159]
    ds_read_b64_tr_b16 a[120:121], v34 offset:49152
    v_mfma_f32_16x16x32_bf16 v[224:227], a[20:23], a[32:35], v[224:227]
    v_mfma_f32_16x16x32_bf16 v[228:231], a[20:23], a[36:39], v[228:231]
    ds_read_b64_tr_b16 a[122:123], v34 offset:51200
    v_mfma_f32_16x16x32_bf16 v[232:235], a[20:23], a[40:43], v[232:235]
    v_mfma_f32_16x16x32_bf16 v[236:239], a[20:23], a[44:47], v[236:239]
    ds_read_b128 a[92:95], v27 offset:47104
    v_mfma_f32_16x16x32_bf16 v[240:243], a[20:23], a[48:51], v[240:243]
    v_mfma_f32_16x16x32_bf16 v[244:247], a[20:23], a[52:55], v[244:247]
    ds_read_b64_tr_b16 a[124:125], v35 offset:49152
    v_mfma_f32_16x16x32_bf16 v[248:251], a[20:23], a[56:59], v[248:251]
    v_mfma_f32_16x16x32_bf16 v[252:255], a[20:23], a[60:63], v[252:255]
    ds_read_b64_tr_b16 a[126:127], v35 offset:51200
    v_mfma_f32_16x16x32_bf16 a[128:131], a[24:27], a[32:35], a[128:131]
    v_mfma_f32_16x16x32_bf16 a[136:139], a[24:27], a[36:39], a[136:139]
    v_mfma_f32_16x16x32_bf16 a[144:147], a[24:27], a[40:43], a[144:147]
    v_mfma_f32_16x16x32_bf16 a[152:155], a[24:27], a[44:47], a[152:155]
    v_mfma_f32_16x16x32_bf16 a[160:163], a[24:27], a[48:51], a[160:163]
    v_mfma_f32_16x16x32_bf16 a[168:171], a[24:27], a[52:55], a[168:171]
    v_mfma_f32_16x16x32_bf16 a[176:179], a[24:27], a[56:59], a[176:179]
    v_mfma_f32_16x16x32_bf16 a[184:187], a[24:27], a[60:63], a[184:187]
    s_sub_u32 s52, s51, 1
    s_cmp_eq_u32 s52, s46
    s_cbranch_scc1 k12_ool_34
k12_oolret_35:
    v_mfma_f32_16x16x32_bf16 a[132:135], a[28:31], a[32:35], a[132:135]
    v_mfma_f32_16x16x32_bf16 a[140:143], a[28:31], a[36:39], a[140:143]
    v_mfma_f32_16x16x32_bf16 a[148:151], a[28:31], a[40:43], a[148:151]
    v_mfma_f32_16x16x32_bf16 a[156:159], a[28:31], a[44:47], a[156:159]
    v_mfma_f32_16x16x32_bf16 a[164:167], a[28:31], a[48:51], a[164:167]
    v_mfma_f32_16x16x32_bf16 a[172:175], a[28:31], a[52:55], a[172:175]
    v_mfma_f32_16x16x32_bf16 a[180:183], a[28:31], a[56:59], a[180:183]
    v_mfma_f32_16x16x32_bf16 a[188:191], a[28:31], a[60:63], a[188:191]
    s_waitcnt vmcnt(0) lgkmcnt(0)
    s_barrier
    s_cmp_eq_u32 s51, 7
    s_cbranch_scc1 k12_last_25
    v_mfma_f32_16x16x32_bf16 v[64:67], a[64:67], a[96:99], v[64:67]
    ds_read_b128 a[0:3], v26 offset:0
    v_mfma_f32_16x16x32_bf16 v[68:71], a[64:67], a[100:103], v[68:71]
    s_add_u32 m0, s48, 32768
    ds_read_b64_tr_b16 a[32:33], v28 offset:0
    v_mfma_f32_16x16x32_bf16 v[72:75], a[64:67], a[104:107], v[72:75]
    buffer_load_dwordx4 v10, s[16:19], s49 offen offset:0 lds
    v_mfma_f32_16x16x32_bf16 v[76:79], a[64:67], a[108:111], v[76:79]
    ds_read_b64_tr_b16 a[34:35], v28 offset:2048
    v_mfma_f32_16x16x32_bf16 v[80:83], a[64:67], a[112:115], v[80:83]
    buffer_load_dwordx4 v11, s[16:19], s49 offen offset:1024 lds
    v_mfma_f32_16x16x32_bf16 v[84:87], a[64:67], a[116:119], v[84:87]
    ds_read_b128 a[4:7], v26 offset:2048
    v_mfma_f32_16x16x32_bf16 v[88:91], a[64:67], a[120:123], v[88:91]
    v_mfma_f32_16x16x32_bf16 v[92:95], a[64:67], a[124:127], v[92:95]
    ds_read_b64_tr_b16 a[36:37], v29 offset:0
    v_mfma_f32_16x16x32_bf16 v[160:163], a[68:71], a[96:99], v[160:163]
    buffer_load_dwordx4 v12, s[16:19], s49 offen offset:2048 lds
    v_mfma_f32_16x16x32_bf16 v[164:167], a[68:71], a[100:103], v[164:167]
    ds_read_b64_tr_b16 a[38:39], v29 offset:2048
    v_mfma_f32_16x16x32_bf16 v[168:171], a[68:71], a[104:107], v[168:171]
    v_mfma_f32_16x16x32_bf16 v[172:175], a[68:71], a[108:111], v[172:175]
    buffer_load_dwordx4 v13, s[16:19], s49 offen offset:3072 lds
    ds_read_b128 a[8:11], v26 offset:4096
    v_mfma_f32_16x16x32_bf16 v[176:179], a[68:71], a[112:115], v[176:179]
    v_mfma_f32_16x16x32_bf16 v[180:183], a[68:71], a[116:119], v[180:183]
    s_add_u32 m0, s48, 36864
    v_mfma_f32_16x16x32_bf16 v[184:187], a[68:71], a[120:123], v[184:187]
    ds_read_b64_tr_b16 a[40:41], v30 offset:0
    v_mfma_f32_16x16x32_bf16 v[188:191], a[68:71], a[124:127], v[188:191]
    buffer_load_dwordx4 v14, s[16:19], s49 offen offset:0 lds
    v_mfma_f32_16x16x32_bf16 v[96:99], a[72:75], a[96:99], v[96:99]
    ds_read_b64_tr_b16 a[42:43], v30 offset:2048
    v_mfma_f32_16x16x32_bf16 v[100:103], a[72:75], a[100:103], v[100:103]
    v_mfma_f32_16x16x32_bf16 v[104:107], a[72:75], a[104:107], v[104:107]
    buffer_load_dwordx4 v15, s[16:19], s49 offen offset:1024 lds
    ds_read_b128 a[12:15], v26 offset:6144
    v_mfma_f32_16x16x32_bf16 v[108:111], a[72:75], a[108:111], v[108:111]
    v_mfma_f32_16x16x32_bf16 v[112:115], a[72:75], a[112:115], v[112:115]
    ds_read_b64_tr_b16 a[44:45], v31 offset:0
    v_mfma_f32_16x16x32_bf16 v[116:119], a[72:75], a[116:119], v[116:119]
    v_mfma_f32_16x16x32_bf16 v[120:123], a[72:75], a[120:123], v[120:123]
    buffer_load_dwordx4 v16, s[16:19], s49 offen offset:2048 lds
    ds_read_b64_tr_b16 a[46:47], v31 offset:2048
    v_mfma_f32_16x16x32_bf16 v[124:127], a[72:75], a[124:127], v[124:127]
    v_mfma_f32_16x16x32_bf16 v[192:195], a[76:79], a[96:99], v[192:195]
    ds_read_b128 a[16:19], v26 offset:8192
    v_mfma_f32_16x16x32_bf16 v[196:199], a[76:79], a[100:103], v[196:199]
    buffer_load_dwordx4 v17, s[16:19], s49 offen offset:3072 lds
    v_mfma_f32_16x16x32_bf16 v[200:203], a[76:79], a[104:107], v[200:203]
    ds_read_b64_tr_b16 a[48:49], v32 offset:0
    v_mfma_f32_16x16x32_bf16 v[204:207], a[76:79], a[108:111], v[204:207]
    s_add_u32 s49, s49, 128
    v_mfma_f32_16x16x32_bf16 v[208:211], a[76:79], a[112:115], v[208:211]
    s_add_u32 m0, s48, 98304
    ds_read_b64_tr_b16 a[50:51], v32 offset:2048
    v_mfma_f32_16x16x32_bf16 v[212:215], a[76:79], a[116:119], v[212:215]
    buffer_load_dwordx4 v18, s[20:23], s50 offen offset:0 lds
    v_mfma_f32_16x16x32_bf16 v[216:219], a[76:79], a[120:123], v[216:219]
    ds_read_b128 a[20:23], v26 offset:10240
    v_mfma_f32_16x16x32_bf16 v[220:223], a[76:79], a[124:127], v[220:223]
    v_mfma_f32_16x16x32_bf16 v[128:131], a[80:83], a[96:99], v[128:131]
    buffer_load_dwordx4 v19, s[20:23], s50 offen offset:1024 lds
    ds_read_b64_tr_b16 a[52:53], v33 offset:0
    v_mfma_f32_16x16x32_bf16 v[132:135], a[80:83], a[100:103], v[132:135]
    v_mfma_f32_16x16x32_bf16 v[136:139], a[80:83], a[104:107], v[136:139]
    ds_read_b64_tr_b16 a[54:55], v33 offset:2048
    v_mfma_f32_16x16x32_bf16 v[140:143], a[80:83], a[108:111], v[140:143]
    buffer_load_dwordx4 v20, s[20:23], s50 offen offset:2048 lds
    v_mfma_f32_16x16x32_bf16 v[144:147], a[80:83], a[112:115], v[144:147]
    ds_read_b128 a[24:27], v26 offset:12288
    v_mfma_f32_16x16x32_bf16 v[148:151], a[80:83], a[116:119], v[148:151]
    v_mfma_f32_16x16x32_bf16 v[152:155], a[80:83], a[120:123], v[152:155]
    v_mfma_f32_16x16x32_bf16 v[156:159], a[80:83], a[124:127], v[156:159]
    buffer_load_dwordx4 v21, s[20:23], s50 offen offset:3072 lds
    ds_read_b64_tr_b16 a[56:57], v34 offset:0
    v_mfma_f32_16x16x32_bf16 v[224:227], a[84:87], a[96:99], v[224:227]
    s_add_u32 m0, s48, 102400
    v_mfma_f32_16x16x32_bf16 v[228:231], a[84:87], a[100:103], v[228:231]
    ds_read_b64_tr_b16 a[58:59], v34 offset:2048
    v_mfma_f32_16x16x32_bf16 v[232:235], a[84:87], a[104:107], v[232:235]
    buffer_load_dwordx4 v22, s[20:23], s50 offen offset:0 lds
    v_mfma_f32_16x16x32_bf16 v[236:239], a[84:87], a[108:111], v[236:239]
    ds_read_b128 a[28:31], v26 offset:14336
    v_mfma_f32_16x16x32_bf16 v[240:243], a[84:87], a[112:115], v[240:243]
    v_mfma_f32_16x16x32_bf16 v[244:247], a[84:87], a[116:119], v[244:247]
    ds_read_b64_tr_b16 a[60:61], v35 offset:0
    v_mfma_f32_16x16x32_bf16 v[248:251], a[84:87], a[120:123], v[248:251]
    buffer_load_dwordx4 v23, s[20:23], s50 offen offset:1024 lds
    v_mfma_f32_16x16x32_bf16 v[252:255], a[84:87], a[124:127], v[252:255]
    ds_read_b64_tr_b16 a[62:63], v35 offset:2048
    v_mfma_f32_16x16x32_bf16 a[128:131], a[88:91], a[96:99], a[128:131]
    v_mfma_f32_16x16x32_bf16 a[136:139], a[88:91], a[100:103], a[136:139]
    buffer_load_dwordx4 v24, s[20:23], s50 offen offset:2048 lds
    v_mfma_f32_16x16x32_bf16 a[144:147], a[88:91], a[104:107], a[144:147]
    v_mfma_f32_16x16x32_bf16 a[152:155], a[88:91], a[108:111], a[152:155]
    v_mfma_f32_16x16x32_bf16 a[160:163], a[88:91], a[112:115], a[160:163]
    v_mfma_f32_16x16x32_bf16 a[168:171], a[88:91], a[116:119], a[168:171]
    buffer_load_dwordx4 v25, s[20:23], s50 offen offset:3072 lds
    v_mfma_f32_16x16x32_bf16 a[176:179], a[88:91], a[120:123], a[176:179]
    v_mfma_f32_16x16x32_bf16 a[184:187], a[88:91], a[124:127], a[184:187]
    s_add_u32 s50, s50, 0x80000
    v_mfma_f32_16x16x32_bf16 a[132:135], a[92:95], a[96:99], a[132:135]
    v_mfma_f32_16x16x32_bf16 a[140:143], a[92:95], a[100:103], a[140:143]
    s_cmp_eq_u32 s51, s53
    s_cbranch_scc1 k12_ool_36
k12_oolret_37:
    v_mfma_f32_16x16x32_bf16 a[148:151], a[92:95], a[104:107], a[148:151]
    v_mfma_f32_16x16x32_bf16 a[156:159], a[92:95], a[108:111], a[156:159]
    s_cmp_eq_u32 s51, 5
    s_cbranch_scc1 k12_ool_38
k12_oolret_39:
    v_mfma_f32_16x16x32_bf16 a[164:167], a[92:95], a[112:115], a[164:167]
    v_mfma_f32_16x16x32_bf16 a[172:175], a[92:95], a[116:119], a[172:175]
    s_add_u32 s51, s51, 1
    v_mfma_f32_16x16x32_bf16 a[180:183], a[92:95], a[120:123], a[180:183]
    v_mfma_f32_16x16x32_bf16 a[188:191], a[92:95], a[124:127], a[188:191]
    s_waitcnt lgkmcnt(0)
    s_branch k12_loop_24
k12_last_25:
    v_mfma_f32_16x16x32_bf16 v[64:67], a[64:67], a[96:99], v[64:67]
    s_add_u32 m0, s60, 98304
    v_mfma_f32_16x16x32_bf16 v[160:163], a[68:71], a[96:99], v[160:163]
    buffer_load_dwordx4 v38, s[12:15], s61 offen offset:0 lds
    v_mfma_f32_16x16x32_bf16 v[68:71], a[64:67], a[100:103], v[68:71]
    buffer_load_dwordx4 v39, s[12:15], s61 offen offset:1024 lds
    v_mfma_f32_16x16x32_bf16 v[164:167], a[68:71], a[100:103], v[164:167]
    v_mfma_f32_16x16x32_bf16 v[72:75], a[64:67], a[104:107], v[72:75]
    buffer_load_dwordx4 v40, s[12:15], s61 offen offset:2048 lds
    v_mfma_f32_16x16x32_bf16 v[168:171], a[68:71], a[104:107], v[168:171]
    v_cvt_pk_bf16_f32 v64, v64, v65
    v_cvt_pk_bf16_f32 v65, v66, v67
    v_cvt_pk_bf16_f32 v66, v160, v161
    v_mfma_f32_16x16x32_bf16 v[76:79], a[64:67], a[108:111], v[76:79]
    v_cvt_pk_bf16_f32 v67, v162, v163
    v_mfma_f32_16x16x32_bf16 v[172:175], a[68:71], a[108:111], v[172:175]
    v_cvt_pk_bf16_f32 v68, v68, v69
    v_cvt_pk_bf16_f32 v69, v70, v71
    v_cvt_pk_bf16_f32 v70, v164, v165
    v_mfma_f32_16x16x32_bf16 v[80:83], a[64:67], a[112:115], v[80:83]
    buffer_load_dwordx4 v41, s[12:15], s61 offen offset:3072 lds
    v_mfma_f32_16x16x32_bf16 v[176:179], a[68:71], a[112:115], v[176:179]
    s_add_u32 s61, s61, 0x80000
    v_cvt_pk_bf16_f32 v71, v166, v167
    v_cvt_pk_bf16_f32 v72, v72, v73
    v_cvt_pk_bf16_f32 v73, v74, v75
    v_mfma_f32_16x16x32_bf16 v[84:87], a[64:67], a[116:119], v[84:87]
    buffer_load_dwordx4 a[192:195], v36, s[8:11], s62 offen sc1
    buffer_load_dwordx4 a[196:199], v54, s[8:11], s62 offen sc1
    v_mfma_f32_16x16x32_bf16 v[180:183], a[68:71], a[116:119], v[180:183]
    v_cvt_pk_bf16_f32 v74, v168, v169
    v_cvt_pk_bf16_f32 v75, v170, v171
    v_cvt_pk_bf16_f32 v76, v76, v77
    v_mfma_f32_16x16x32_bf16 v[88:91], a[64:67], a[120:123], v[88:91]
    v_cvt_pk_bf16_f32 v77, v78, v79
    v_cvt_pk_bf16_f32 v78, v172, v173
    v_cvt_pk_bf16_f32 v79, v174, v175
    v_mfma_f32_16x16x32_bf16 v[184:187], a[68:71], a[120:123], v[184:187]
    v_cvt_pk_bf16_f32 v80, v80, v81
    v_cvt_pk_bf16_f32 v81, v82, v83
    v_cvt_pk_bf16_f32 v82, v176, v177
    v_mfma_f32_16x16x32_bf16 v[92:95], a[64:67], a[124:127], v[92:95]
    buffer_load_dwordx4 a[200:203], v37, s[8:11], s62 offen sc1
    buffer_load_dwordx4 a[204:207], v55, s[8:11], s62 offen sc1
    v_mfma_f32_16x16x32_bf16 v[188:191], a[68:71], a[124:127], v[188:191]
    s_add_u32 s62, s62, 0x20000
    v_cvt_pk_bf16_f32 v83, v178, v179
    v_cvt_pk_bf16_f32 v84, v84, v85
    v_cvt_pk_bf16_f32 v85, v86, v87
    v_mfma_f32_16x16x32_bf16 a[128:131], a[88:91], a[96:99], a[128:131]
    v_cvt_pk_bf16_f32 v86, v180, v181
    v_cvt_pk_bf16_f32 v87, v182, v183
    v_mfma_f32_16x16x32_bf16 a[132:135], a[92:95], a[96:99], a[132:135]
    v_cvt_pk_bf16_f32 v88, v88, v89
    v_cvt_pk_bf16_f32 v89, v90, v91
    v_cvt_pk_bf16_f32 v90, v184, v185
    v_mfma_f32_16x16x32_bf16 v[96:99], a[72:75], a[96:99], v[96:99]
    buffer_load_dwordx4 a[208:211], v36, s[8:11], s62 offen sc1
    buffer_load_dwordx4 a[212:215], v54, s[8:11], s62 offen sc1
    v_mfma_f32_16x16x32_bf16 v[192:195], a[76:79], a[96:99], v[192:195]
    v_cvt_pk_bf16_f32 v91, v186, v187
    v_cvt_pk_bf16_f32 v92, v92, v93
    v_cvt_pk_bf16_f32 v93, v94, v95
    v_mfma_f32_16x16x32_bf16 v[100:103], a[72:75], a[100:103], v[100:103]
    v_cvt_pk_bf16_f32 v94, v188, v189
    v_cvt_pk_bf16_f32 v95, v190, v191
    v_mfma_f32_16x16x32_bf16 v[196:199], a[76:79], a[100:103], v[196:199]
    v_accvgpr_read_b32 v56, a128
    v_accvgpr_read_b32 v57, a129
    v_accvgpr_read_b32 v58, a130
    v_mfma_f32_16x16x32_bf16 a[136:139], a[88:91], a[100:103], a[136:139]
    buffer_load_dwordx4 a[216:219], v37, s[8:11], s62 offen sc1
    buffer_load_dwordx4 a[220:223], v55, s[8:11], s62 offen sc1
    v_mfma_f32_16x16x32_bf16 a[140:143], a[92:95], a[100:103], a[140:143]
    s_add_u32 s62, s62, 0x20000
    v_accvgpr_read_b32 v59, a131
    v_accvgpr_read_b32 v60, a132
    v_cvt_pk_bf16_f32 v96, v96, v97
    v_mfma_f32_16x16x32_bf16 v[104:107], a[72:75], a[104:107], v[104:107]
    s_add_u32 m0, s60, 114688
    v_accvgpr_read_b32 v61, a133
    v_accvgpr_read_b32 v62, a134
    v_cvt_pk_bf16_f32 v97, v98, v99
    v_mfma_f32_16x16x32_bf16 v[200:203], a[76:79], a[104:107], v[200:203]
    v_accvgpr_read_b32 v63, a135
    v_cvt_pk_bf16_f32 v98, v192, v193
    v_cvt_pk_bf16_f32 v160, v56, v57
    v_mfma_f32_16x16x32_bf16 v[108:111], a[72:75], a[108:111], v[108:111]
    v_cvt_pk_bf16_f32 v99, v194, v195
    v_cvt_pk_bf16_f32 v161, v58, v59
    v_cvt_pk_bf16_f32 v100, v100, v101
    v_mfma_f32_16x16x32_bf16 v[204:207], a[76:79], a[108:111], v[204:207]
    buffer_load_dwordx4 v38, s[12:15], s61 offen offset:0 lds
    buffer_load_dwordx4 v39, s[12:15], s61 offen offset:1024 lds
    v_mfma_f32_16x16x32_bf16 a[144:147], a[88:91], a[104:107], a[144:147]
    v_cvt_pk_bf16_f32 v162, v60, v61
    v_cvt_pk_bf16_f32 v101, v102, v103
    v_cvt_pk_bf16_f32 v163, v62, v63
    v_mfma_f32_16x16x32_bf16 a[148:151], a[92:95], a[104:107], a[148:151]
    v_cvt_pk_bf16_f32 v102, v196, v197
    v_cvt_pk_bf16_f32 v103, v198, v199
    v_accvgpr_read_b32 v56, a136
    v_mfma_f32_16x16x32_bf16 v[112:115], a[72:75], a[112:115], v[112:115]
    v_accvgpr_read_b32 v57, a137
    v_accvgpr_read_b32 v58, a138
    v_accvgpr_read_b32 v59, a139
    v_mfma_f32_16x16x32_bf16 v[208:211], a[76:79], a[112:115], v[208:211]
    v_accvgpr_read_b32 v60, a140
    v_cvt_pk_bf16_f32 v104, v104, v105
    v_accvgpr_read_b32 v61, a141
    v_mfma_f32_16x16x32_bf16 v[116:119], a[72:75], a[116:119], v[116:119]
    buffer_load_dwordx4 v40, s[12:15], s61 offen offset:2048 lds
    buffer_load_dwordx4 v41, s[12:15], s61 offen offset:3072 lds
    v_mfma_f32_16x16x32_bf16 v[212:215], a[76:79], a[116:119], v[212:215]
    s_add_u32 s61, s61, 0x80000
    v_accvgpr_read_b32 v62, a142
    v_cvt_pk_bf16_f32 v105, v106, v107
    v_accvgpr_read_b32 v63, a143
    v_mfma_f32_16x16x32_bf16 a[152:155], a[88:91], a[108:111], a[152:155]
    v_cvt_pk_bf16_f32 v106, v200, v201
    v_cvt_pk_bf16_f32 v164, v56, v57
    v_cvt_pk_bf16_f32 v107, v202, v203
    v_mfma_f32_16x16x32_bf16 a[156:159], a[92:95], a[108:111], a[156:159]
    v_cvt_pk_bf16_f32 v165, v58, v59
    v_cvt_pk_bf16_f32 v108, v108, v109
    v_cvt_pk_bf16_f32 v166, v60, v61
    v_mfma_f32_16x16x32_bf16 v[120:123], a[72:75], a[120:123], v[120:123]
    v_cvt_pk_bf16_f32 v109, v110, v111
    v_cvt_pk_bf16_f32 v167, v62, v63
    v_cvt_pk_bf16_f32 v110, v204, v205
    v_mfma_f32_16x16x32_bf16 v[216:219], a[76:79], a[120:123], v[216:219]
    buffer_load_dwordx4 a[224:227], v36, s[8:11], s62 offen sc1
    v_cvt_pk_bf16_f32 v111, v206, v207
    v_accvgpr_read_b32 v56, a144
    v_mfma_f32_16x16x32_bf16 v[124:127], a[72:75], a[124:127], v[124:127]
    v_accvgpr_read_b32 v57, a145
    v_accvgpr_read_b32 v58, a146
    v_accvgpr_read_b32 v59, a147
    v_mfma_f32_16x16x32_bf16 v[220:223], a[76:79], a[124:127], v[220:223]
    buffer_load_dwordx4 a[228:231], v54, s[8:11], s62 offen sc1
    v_accvgpr_read_b32 v60, a148
    v_cvt_pk_bf16_f32 v112, v112, v113
    v_mfma_f32_16x16x32_bf16 a[160:163], a[88:91], a[112:115], a[160:163]
    v_accvgpr_read_b32 v61, a149
    v_accvgpr_read_b32 v62, a150
    v_cvt_pk_bf16_f32 v113, v114, v115
    v_mfma_f32_16x16x32_bf16 a[164:167], a[92:95], a[112:115], a[164:167]
    v_accvgpr_read_b32 v63, a151
    v_cvt_pk_bf16_f32 v114, v208, v209
    v_cvt_pk_bf16_f32 v168, v56, v57
    v_mfma_f32_16x16x32_bf16 v[128:131], a[80:83], a[96:99], v[128:131]
    v_cvt_pk_bf16_f32 v115, v210, v211
    v_cvt_pk_bf16_f32 v169, v58, v59
    v_cvt_pk_bf16_f32 v116, v116, v117
    v_mfma_f32_16x16x32_bf16 v[224:227], a[84:87], a[96:99], v[224:227]
    buffer_load_dwordx4 a[232:235], v37, s[8:11], s62 offen sc1
    v_cvt_pk_bf16_f32 v170, v60, v61
    v_cvt_pk_bf16_f32 v117, v118, v119
    v_mfma_f32_16x16x32_bf16 v[132:135], a[80:83], a[100:103], v[132:135]
    v_cvt_pk_bf16_f32 v171, v62, v63
    v_cvt_pk_bf16_f32 v118, v212, v213
    v_cvt_pk_bf16_f32 v119, v214, v215
    v_mfma_f32_16x16x32_bf16 v[228:231], a[84:87], a[100:103], v[228:231]
    buffer_load_dwordx4 a[236:239], v55, s[8:11], s62 offen sc1
    v_accvgpr_read_b32 v56, a152
    v_accvgpr_read_b32 v57, a153
    v_mfma_f32_16x16x32_bf16 a[168:171], a[88:91], a[116:119], a[168:171]
    s_add_u32 s62, s62, 0x20000
    v_accvgpr_read_b32 v58, a154
    v_accvgpr_read_b32 v59, a155
    v_accvgpr_read_b32 v60, a156
    v_mfma_f32_16x16x32_bf16 a[172:175], a[92:95], a[116:119], a[172:175]
    s_waitcnt vmcnt(16)
    s_barrier
    v_cvt_pk_bf16_f32 v120, v120, v121
    v_accvgpr_read_b32 v61, a157
    v_accvgpr_read_b32 v62, a158
    v_mfma_f32_16x16x32_bf16 v[136:139], a[80:83], a[104:107], v[136:139]
    v_cvt_pk_bf16_f32 v121, v122, v123
    v_accvgpr_read_b32 v63, a159
    v_cvt_pk_bf16_f32 v122, v216, v217
    v_mfma_f32_16x16x32_bf16 v[232:235], a[84:87], a[104:107], v[232:235]
    v_cvt_pk_bf16_f32 v172, v56, v57
    v_cvt_pk_bf16_f32 v123, v218, v219
    v_cvt_pk_bf16_f32 v173, v58, v59
    v_mfma_f32_16x16x32_bf16 v[140:143], a[80:83], a[108:111], v[140:143]
    v_cvt_pk_bf16_f32 v124, v124, v125
    v_cvt_pk_bf16_f32 v174, v60, v61
    v_cvt_pk_bf16_f32 v125, v126, v127
    v_mfma_f32_16x16x32_bf16 v[236:239], a[84:87], a[108:111], v[236:239]
    v_cvt_pk_bf16_f32 v175, v62, v63
    v_cvt_pk_bf16_f32 v126, v220, v221
    v_cvt_pk_bf16_f32 v127, v222, v223
    v_mfma_f32_16x16x32_bf16 a[176:179], a[88:91], a[120:123], a[176:179]
    ds_read_b64_tr_b16 a[0:1], v42 offset:0
    v_accvgpr_read_b32 v56, a160
    v_accvgpr_read_b32 v57, a161
    v_mfma_f32_16x16x32_bf16 a[180:183], a[92:95], a[120:123], a[180:183]
    ds_read_b64_tr_b16 a[2:3], v42 offset:1024
    v_accvgpr_read_b32 v58, a162
    v_accvgpr_read_b32 v59, a163
    v_mfma_f32_16x16x32_bf16 v[144:147], a[80:83], a[112:115], v[144:147]
    ds_read_b64_tr_b16 a[4:5], v43 offset:0
    v_accvgpr_read_b32 v60, a164
    v_cvt_pk_bf16_f32 v128, v128, v129
    v_mfma_f32_16x16x32_bf16 v[240:243], a[84:87], a[112:115], v[240:243]
    v_accvgpr_read_b32 v61, a165
    v_accvgpr_read_b32 v62, a166
    v_cvt_pk_bf16_f32 v129, v130, v131
    v_mfma_f32_16x16x32_bf16 v[148:151], a[80:83], a[116:119], v[148:151]
    ds_read_b64_tr_b16 a[6:7], v43 offset:1024
    v_accvgpr_read_b32 v63, a167
    v_cvt_pk_bf16_f32 v130, v224, v225
    v_mfma_f32_16x16x32_bf16 v[244:247], a[84:87], a[116:119], v[244:247]
    v_cvt_pk_bf16_f32 v176, v56, v57
    v_cvt_pk_bf16_f32 v131, v226, v227
    v_cvt_pk_bf16_f32 v177, v58, v59
    v_mfma_f32_16x16x32_bf16 a[184:187], a[88:91], a[124:127], a[184:187]
    ds_read_b64_tr_b16 a[8:9], v44 offset:0
    v_cvt_pk_bf16_f32 v132, v132, v133
    v_cvt_pk_bf16_f32 v178, v60, v61
    v_mfma_f32_16x16x32_bf16 a[188:191], a[92:95], a[124:127], a[188:191]
    ds_read_b64_tr_b16 a[10:11], v44 offset:1024
    v_cvt_pk_bf16_f32 v133, v134, v135
    v_cvt_pk_bf16_f32 v179, v62, v63
    v_mfma_f32_16x16x32_bf16 v[152:155], a[80:83], a[120:123], v[152:155]
    ds_read_b64_tr_b16 a[12:13], v45 offset:0
    v_cvt_pk_bf16_f32 v134, v228, v229
    v_cvt_pk_bf16_f32 v135, v230, v231
    v_mfma_f32_16x16x32_bf16 v[248:251], a[84:87], a[120:123], v[248:251]
    ds_read_b64_tr_b16 a[14:15], v45 offset:1024
    v_accvgpr_read_b32 v56, a168
    v_accvgpr_read_b32 v57, a169
    v_mfma_f32_16x16x32_bf16 v[156:159], a[80:83], a[124:127], v[156:159]
    ds_read_b64_tr_b16 a[16:17], v46 offset:0
    v_accvgpr_read_b32 v58, a170
    v_accvgpr_read_b32 v59, a171
    v_mfma_f32_16x16x32_bf16 v[252:255], a[84:87], a[124:127], v[252:255]
    v_accvgpr_read_b32 v60, a172
    v_cvt_pk_bf16_f32 v136, v136, v137
    v_accvgpr_read_b32 v61, a173
    ds_read_b64_tr_b16 a[18:19], v46 offset:1024
    v_accvgpr_read_b32 v62, a174
    v_cvt_pk_bf16_f32 v137, v138, v139
    v_accvgpr_read_b32 v63, a175
    v_cvt_pk_bf16_f32 v138, v232, v233
    v_cvt_pk_bf16_f32 v180, v56, v57
    ds_read_b64_tr_b16 a[20:21], v47 offset:0
    v_cvt_pk_bf16_f32 v139, v234, v235
    v_cvt_pk_bf16_f32 v181, v58, v59
    v_cvt_pk_bf16_f32 v140, v140, v141
    v_cvt_pk_bf16_f32 v182, v60, v61
    ds_read_b64_tr_b16 a[22:23], v47 offset:1024
    v_cvt_pk_bf16_f32 v141, v142, v143
    v_cvt_pk_bf16_f32 v183, v62, v63
    v_cvt_pk_bf16_f32 v142, v236, v237
    ds_read_b64_tr_b16 a[24:25], v48 offset:0
    v_cvt_pk_bf16_f32 v143, v238, v239
    v_accvgpr_read_b32 v56, a176
    ds_read_b64_tr_b16 a[26:27], v48 offset:1024
    v_accvgpr_read_b32 v57, a177
    v_accvgpr_read_b32 v58, a178
    ds_read_b64_tr_b16 a[28:29], v49 offset:0
    v_accvgpr_read_b32 v59, a179
    v_accvgpr_read_b32 v60, a180
    v_cvt_pk_bf16_f32 v144, v144, v145
    ds_read_b64_tr_b16 a[30:31], v49 offset:1024
    v_accvgpr_read_b32 v61, a181
    v_accvgpr_read_b32 v62, a182
    v_cvt_pk_bf16_f32 v145, v146, v147
    v_accvgpr_read_b32 v63, a183
    v_cvt_pk_bf16_f32 v146, v240, v241
    v_cvt_pk_bf16_f32 v184, v56, v57
    v_cvt_pk_bf16_f32 v147, v242, v243
    v_cvt_pk_bf16_f32 v185, v58, v59
    v_cvt_pk_bf16_f32 v148, v148, v149
    v_cvt_pk_bf16_f32 v186, v60, v61
    v_cvt_pk_bf16_f32 v149, v150, v151
    v_cvt_pk_bf16_f32 v187, v62, v63
    v_cvt_pk_bf16_f32 v150, v244, v245
    v_cvt_pk_bf16_f32 v151, v246, v247
    v_accvgpr_read_b32 v56, a184
    v_accvgpr_read_b32 v57, a185
    v_accvgpr_read_b32 v58, a186
    v_accvgpr_read_b32 v59, a187
    v_accvgpr_read_b32 v60, a188
    v_cvt_pk_bf16_f32 v152, v152, v153
    v_accvgpr_read_b32 v61, a189
    v_accvgpr_read_b32 v62, a190
    v_cvt_pk_bf16_f32 v153, v154, v155
    v_accvgpr_read_b32 v63, a191
    v_cvt_pk_bf16_f32 v154, v248, v249
    v_cvt_pk_bf16_f32 v188, v56, v57
    v_cvt_pk_bf16_f32 v155, v250, v251
    v_cvt_pk_bf16_f32 v189, v58, v59
    v_cvt_pk_bf16_f32 v156, v156, v157
    v_cvt_pk_bf16_f32 v190, v60, v61
    v_cvt_pk_bf16_f32 v157, v158, v159
    v_cvt_pk_bf16_f32 v191, v62, v63
    v_cvt_pk_bf16_f32 v158, v252, v253
    v_cvt_pk_bf16_f32 v159, v254, v255
k12_join_7:
k12_qcode:
    s_mov_b64 s[48:49], s[32:33]
    s_mov_b32 s51, 0x00020000
    s_cmp_eq_u32 s45, 0
    s_mov_b32 s50, s34
    s_cselect_b32 s56, s30, -1
    s_cselect_b32 s57, -1, s30
    s_waitcnt vmcnt(12) lgkmcnt(0)
    v_mfma_f32_16x16x32_bf16 v[192:195], a[0:3], a[192:195], 0
    ds_read_b64_tr_b16 a[32:33], v42 offset:8192
    ds_read_b64_tr_b16 a[34:35], v42 offset:9216
    v_mfma_f32_16x16x32_bf16 v[196:199], a[0:3], a[196:199], 0
    buffer_load_dwordx4 a[240:243], v36, s[8:11], s62 offen sc1
    v_mfma_f32_16x16x32_bf16 a[64:67], a[0:3], a[200:203], 0
    ds_read_b64_tr_b16 a[36:37], v43 offset:8192
    v_mfma_f32_16x16x32_bf16 a[68:71], a[0:3], a[204:207], 0
    ds_read_b64_tr_b16 a[38:39], v43 offset:9216
    v_mfma_f32_16x16x32_bf16 v[200:203], a[4:7], a[192:195], 0
    ds_read_b64_tr_b16 a[40:41], v44 offset:8192
    v_mfma_f32_16x16x32_bf16 v[204:207], a[4:7], a[196:199], 0
    buffer_load_dwordx4 a[244:247], v54, s[8:11], s62 offen sc1
    v_mfma_f32_16x16x32_bf16 a[72:75], a[4:7], a[200:203], 0
    s_lshl_b32 s31, s28, 14
    ds_read_b64_tr_b16 a[42:43], v44 offset:9216
    v_mfma_f32_16x16x32_bf16 a[76:79], a[4:7], a[204:207], 0
    s_add_u32 s16, s6, s31
    s_addc_u32 s17, s7, 0
    ds_read_b64_tr_b16 a[44:45], v45 offset:8192
    v_mfma_f32_16x16x32_bf16 v[208:211], a[8:11], a[192:195], 0
    v_mfma_f32_16x16x32_bf16 v[212:215], a[8:11], a[196:199], 0
    s_add_u32 s20, s16, 0x2000000
    s_addc_u32 s21, s17, 0
    ds_read_b64_tr_b16 a[46:47], v45 offset:9216
    v_mfma_f32_16x16x32_bf16 a[80:83], a[8:11], a[200:203], 0
    buffer_load_dwordx4 a[248:251], v37, s[8:11], s62 offen sc1
    ds_read_b64_tr_b16 a[48:49], v46 offset:8192
    v_mfma_f32_16x16x32_bf16 a[84:87], a[8:11], a[204:207], 0
    s_add_u32 s16, s16, 0x1000000
    s_addc_u32 s17, s17, 0
    ds_read_b64_tr_b16 a[50:51], v46 offset:9216
    v_mfma_f32_16x16x32_bf16 v[216:219], a[12:15], a[192:195], 0
    v_mfma_f32_16x16x32_bf16 v[220:223], a[12:15], a[196:199], 0
    s_and_b32 s17, s17, 0xffff
    ds_read_b64_tr_b16 a[52:53], v47 offset:8192
    v_mfma_f32_16x16x32_bf16 a[88:91], a[12:15], a[200:203], 0
    buffer_load_dwordx4 a[252:255], v55, s[8:11], s62 offen sc1
    ds_read_b64_tr_b16 a[54:55], v47 offset:9216
    v_mfma_f32_16x16x32_bf16 a[92:95], a[12:15], a[204:207], 0
    s_and_b32 s21, s21, 0xffff
    ds_read_b64_tr_b16 a[56:57], v48 offset:8192
    v_mfma_f32_16x16x32_bf16 v[224:227], a[16:19], a[192:195], 0
    v_mfma_f32_16x16x32_bf16 v[228:231], a[16:19], a[196:199], 0
    s_lshl_b32 s31, s29, 20
    ds_read_b64_tr_b16 a[58:59], v48 offset:9216
    v_mfma_f32_16x16x32_bf16 a[96:99], a[16:19], a[200:203], 0
    s_add_u32 s62, s62, 0x20000
    ds_read_b64_tr_b16 a[60:61], v49 offset:8192
    v_mfma_f32_16x16x32_bf16 a[100:103], a[16:19], a[204:207], 0
    s_add_u32 s52, s47, 0
    v_mfma_f32_16x16x32_bf16 v[232:235], a[20:23], a[192:195], 0
    s_sub_u32 s18, 0xf84000, s31
    buffer_store_dwordx4 v[64:67], v1, s[48:51], s52 offen offset:0 sc1
    ds_read_b64_tr_b16 a[62:63], v49 offset:9216
    v_mfma_f32_16x16x32_bf16 v[236:239], a[20:23], a[196:199], 0
    s_add_u32 s52, s47, 0
    v_mfma_f32_16x16x32_bf16 a[104:107], a[20:23], a[200:203], 0
    s_mov_b32 s22, s18
    v_mfma_f32_16x16x32_bf16 a[108:111], a[20:23], a[204:207], 0
    s_add_u32 s24, s6, 0x4806000
    s_addc_u32 s25, s7, 0
    buffer_store_dwordx4 v[68:71], v1, s[48:51], s52 offen offset:1024 sc1
    v_mfma_f32_16x16x32_bf16 v[240:243], a[24:27], a[192:195], 0
    v_mfma_f32_16x16x32_bf16 v[244:247], a[24:27], a[196:199], 0
    s_and_b32 s25, s25, 0xffff
    v_mfma_f32_16x16x32_bf16 a[112:115], a[24:27], a[200:203], 0
    v_mfma_f32_16x16x32_bf16 a[116:119], a[24:27], a[204:207], 0
    s_mov_b32 s26, 4096
    v_mfma_f32_16x16x32_bf16 v[248:251], a[28:31], a[192:195], 0
    s_cmp_eq_u32 s45, 0
    s_cbranch_scc1 k12_ool_40
k12_oolret_41:
    v_mfma_f32_16x16x32_bf16 v[252:255], a[28:31], a[196:199], 0
    v_mfma_f32_16x16x32_bf16 a[120:123], a[28:31], a[200:203], 0
    v_mfma_f32_16x16x32_bf16 a[124:127], a[28:31], a[204:207], 0
    s_waitcnt vmcnt(10) lgkmcnt(0)
    s_barrier
    v_mfma_f32_16x16x32_bf16 v[192:195], a[32:35], a[208:211], v[192:195]
    ds_read_b64_tr_b16 a[0:1], v42 offset:16384
    ds_read_b64_tr_b16 a[2:3], v42 offset:17408
    v_mfma_f32_16x16x32_bf16 v[196:199], a[32:35], a[212:215], v[196:199]
    s_add_u32 m0, s60, 131072
    v_mfma_f32_16x16x32_bf16 a[64:67], a[32:35], a[216:219], a[64:67]
    buffer_load_dwordx4 v38, s[12:15], s61 offen offset:0 lds
    ds_read_b64_tr_b16 a[4:5], v43 offset:16384
    v_mfma_f32_16x16x32_bf16 a[68:71], a[32:35], a[220:223], a[68:71]
    ds_read_b64_tr_b16 a[6:7], v43 offset:17408
    v_mfma_f32_16x16x32_bf16 v[200:203], a[36:39], a[208:211], v[200:203]
    buffer_load_dwordx4 v39, s[12:15], s61 offen offset:1024 lds
    ds_read_b64_tr_b16 a[8:9], v44 offset:16384
    v_mfma_f32_16x16x32_bf16 v[204:207], a[36:39], a[212:215], v[204:207]
    v_mfma_f32_16x16x32_bf16 a[72:75], a[36:39], a[216:219], a[72:75]
    ds_read_b64_tr_b16 a[10:11], v44 offset:17408
    v_mfma_f32_16x16x32_bf16 a[76:79], a[36:39], a[220:223], a[76:79]
    buffer_load_dwordx4 v40, s[12:15], s61 offen offset:2048 lds
    ds_read_b64_tr_b16 a[12:13], v45 offset:16384
    v_mfma_f32_16x16x32_bf16 v[208:211], a[40:43], a[208:211], v[208:211]
    v_mfma_f32_16x16x32_bf16 v[212:215], a[40:43], a[212:215], v[212:215]
    ds_read_b64_tr_b16 a[14:15], v45 offset:17408
    v_mfma_f32_16x16x32_bf16 a[80:83], a[40:43], a[216:219], a[80:83]
    buffer_load_dwordx4 v41, s[12:15], s61 offen offset:3072 lds
    ds_read_b64_tr_b16 a[16:17], v46 offset:16384
    v_mfma_f32_16x16x32_bf16 a[84:87], a[40:43], a[220:223], a[84:87]
    ds_read_b64_tr_b16 a[18:19], v46 offset:17408
    v_mfma_f32_16x16x32_bf16 v[216:219], a[44:47], a[208:211], v[216:219]
    s_add_u32 s61, s61, 0x80000
    v_mfma_f32_16x16x32_bf16 v[220:223], a[44:47], a[212:215], v[220:223]
    buffer_load_dwordx4 a[128:131], v36, s[8:11], s62 offen sc1
    ds_read_b64_tr_b16 a[20:21], v47 offset:16384
    v_mfma_f32_16x16x32_bf16 a[88:91], a[44:47], a[216:219], a[88:91]
    ds_read_b64_tr_b16 a[22:23], v47 offset:17408
    v_mfma_f32_16x16x32_bf16 a[92:95], a[44:47], a[220:223], a[92:95]
    buffer_load_dwordx4 a[132:135], v54, s[8:11], s62 offen sc1
    ds_read_b64_tr_b16 a[24:25], v48 offset:16384
    v_mfma_f32_16x16x32_bf16 v[224:227], a[48:51], a[208:211], v[224:227]
    v_mfma_f32_16x16x32_bf16 v[228:231], a[48:51], a[212:215], v[228:231]
    ds_read_b64_tr_b16 a[26:27], v48 offset:17408
    v_mfma_f32_16x16x32_bf16 a[96:99], a[48:51], a[216:219], a[96:99]
    buffer_load_dwordx4 a[136:139], v37, s[8:11], s62 offen sc1
    ds_read_b64_tr_b16 a[28:29], v49 offset:16384
    v_mfma_f32_16x16x32_bf16 a[100:103], a[48:51], a[220:223], a[100:103]
    v_mfma_f32_16x16x32_bf16 v[232:235], a[52:55], a[208:211], v[232:235]
    ds_read_b64_tr_b16 a[30:31], v49 offset:17408
    v_mfma_f32_16x16x32_bf16 v[236:239], a[52:55], a[212:215], v[236:239]
    buffer_load_dwordx4 a[140:143], v55, s[8:11], s62 offen sc1
    v_mfma_f32_16x16x32_bf16 a[104:107], a[52:55], a[216:219], a[104:107]
    v_mfma_f32_16x16x32_bf16 a[108:111], a[52:55], a[220:223], a[108:111]
    s_add_u32 s62, s62, 0x20000
    v_mfma_f32_16x16x32_bf16 v[240:243], a[56:59], a[208:211], v[240:243]
    s_add_u32 s52, s47, 0
    v_mfma_f32_16x16x32_bf16 v[244:247], a[56:59], a[212:215], v[244:247]
    buffer_store_dwordx4 v[72:75], v1, s[48:51], s52 offen offset:2048 sc1
    v_mfma_f32_16x16x32_bf16 a[112:115], a[56:59], a[216:219], a[112:115]
    v_mfma_f32_16x16x32_bf16 a[116:119], a[56:59], a[220:223], a[116:119]
    v_mfma_f32_16x16x32_bf16 v[248:251], a[60:63], a[208:211], v[248:251]
    v_mfma_f32_16x16x32_bf16 v[252:255], a[60:63], a[212:215], v[252:255]
    v_mfma_f32_16x16x32_bf16 a[120:123], a[60:63], a[216:219], a[120:123]
    v_mfma_f32_16x16x32_bf16 a[124:127], a[60:63], a[220:223], a[124:127]
    s_waitcnt vmcnt(15) lgkmcnt(0)
    v_mfma_f32_16x16x32_bf16 v[192:195], a[0:3], a[224:227], v[192:195]
    ds_read_b64_tr_b16 a[32:33], v42 offset:24576
    ds_read_b64_tr_b16 a[34:35], v42 offset:25600
    v_mfma_f32_16x16x32_bf16 v[196:199], a[0:3], a[228:231], v[196:199]
    buffer_load_dwordx4 a[144:147], v36, s[8:11], s62 offen sc1
    v_mfma_f32_16x16x32_bf16 a[64:67], a[0:3], a[232:235], a[64:67]
    ds_read_b64_tr_b16 a[36:37], v43 offset:24576
    v_mfma_f32_16x16x32_bf16 a[68:71], a[0:3], a[236:239], a[68:71]
    ds_read_b64_tr_b16 a[38:39], v43 offset:25600
    v_mfma_f32_16x16x32_bf16 v[200:203], a[4:7], a[224:227], v[200:203]
    ds_read_b64_tr_b16 a[40:41], v44 offset:24576
    v_mfma_f32_16x16x32_bf16 v[204:207], a[4:7], a[228:231], v[204:207]
    v_mfma_f32_16x16x32_bf16 a[72:75], a[4:7], a[232:235], a[72:75]
    buffer_load_dwordx4 a[148:151], v54, s[8:11], s62 offen sc1
    ds_read_b64_tr_b16 a[42:43], v44 offset:25600
    v_mfma_f32_16x16x32_bf16 a[76:79], a[4:7], a[236:239], a[76:79]
    ds_read_b64_tr_b16 a[44:45], v45 offset:24576
    v_mfma_f32_16x16x32_bf16 v[208:211], a[8:11], a[224:227], v[208:211]
    v_mfma_f32_16x16x32_bf16 v[212:215], a[8:11], a[228:231], v[212:215]
    ds_read_b64_tr_b16 a[46:47], v45 offset:25600
    v_mfma_f32_16x16x32_bf16 a[80:83], a[8:11], a[232:235], a[80:83]
    ds_read_b64_tr_b16 a[48:49], v46 offset:24576
    v_mfma_f32_16x16x32_bf16 a[84:87], a[8:11], a[236:239], a[84:87]
    buffer_load_dwordx4 a[152:155], v37, s[8:11], s62 offen sc1
    ds_read_b64_tr_b16 a[50:51], v46 offset:25600
    v_mfma_f32_16x16x32_bf16 v[216:219], a[12:15], a[224:227], v[216:219]
    v_mfma_f32_16x16x32_bf16 v[220:223], a[12:15], a[228:231], v[220:223]
    ds_read_b64_tr_b16 a[52:53], v47 offset:24576
    v_mfma_f32_16x16x32_bf16 a[88:91], a[12:15], a[232:235], a[88:91]
    ds_read_b64_tr_b16 a[54:55], v47 offset:25600
    v_mfma_f32_16x16x32_bf16 a[92:95], a[12:15], a[236:239], a[92:95]
    ds_read_b64_tr_b16 a[56:57], v48 offset:24576
    v_mfma_f32_16x16x32_bf16 v[224:227], a[16:19], a[224:227], v[224:227]
    v_mfma_f32_16x16x32_bf16 v[228:231], a[16:19], a[228:231], v[228:231]
    buffer_load_dwordx4 a[156:159], v55, s[8:11], s62 offen sc1
    ds_read_b64_tr_b16 a[58:59], v48 offset:25600
    v_mfma_f32_16x16x32_bf16 a[96:99], a[16:19], a[232:235], a[96:99]
    ds_read_b64_tr_b16 a[60:61], v49 offset:24576
    v_mfma_f32_16x16x32_bf16 a[100:103], a[16:19], a[236:239], a[100:103]
    v_mfma_f32_16x16x32_bf16 v[232:235], a[20:23], a[224:227], v[232:235]
    ds_read_b64_tr_b16 a[62:63], v49 offset:25600
    v_mfma_f32_16x16x32_bf16 v[236:239], a[20:23], a[228:231], v[236:239]
    s_add_u32 s62, s62, 0x20000
    v_mfma_f32_16x16x32_bf16 a[104:107], a[20:23], a[232:235], a[104:107]
    s_add_u32 s52, s47, 0
    v_mfma_f32_16x16x32_bf16 a[108:111], a[20:23], a[236:239], a[108:111]
    buffer_store_dwordx4 v[76:79], v1, s[48:51], s52 offen offset:3072 sc1
    v_mfma_f32_16x16x32_bf16 v[240:243], a[24:27], a[224:227], v[240:243]
    v_mfma_f32_16x16x32_bf16 v[244:247], a[24:27], a[228:231], v[244:247]
    v_mfma_f32_16x16x32_bf16 a[112:115], a[24:27], a[232:235], a[112:115]
    v_mfma_f32_16x16x32_bf16 a[116:119], a[24:27], a[236:239], a[116:119]
    v_mfma_f32_16x16x32_bf16 v[248:251], a[28:31], a[224:227], v[248:251]
    s_cmp_eq_u32 s45, 0
    s_cbranch_scc1 k12_ool_42
k12_oolret_43:
    v_mfma_f32_16x16x32_bf16 v[252:255], a[28:31], a[228:231], v[252:255]
    v_mfma_f32_16x16x32_bf16 a[120:123], a[28:31], a[232:235], a[120:123]
    v_mfma_f32_16x16x32_bf16 a[124:127], a[28:31], a[236:239], a[124:127]
    s_waitcnt vmcnt(10) lgkmcnt(0)
    s_barrier
    v_mfma_f32_16x16x32_bf16 v[192:195], a[32:35], a[240:243], v[192:195]
    ds_read_b64_tr_b16 a[0:1], v42 offset:32768
    ds_read_b64_tr_b16 a[2:3], v42 offset:33792
    v_mfma_f32_16x16x32_bf16 v[196:199], a[32:35], a[244:247], v[196:199]
    s_add_u32 m0, s60, 147456
    v_mfma_f32_16x16x32_bf16 a[64:67], a[32:35], a[248:251], a[64:67]
    buffer_load_dwordx4 v38, s[12:15], s61 offen offset:0 lds
    ds_read_b64_tr_b16 a[4:5], v43 offset:32768
    v_mfma_f32_16x16x32_bf16 a[68:71], a[32:35], a[252:255], a[68:71]
    ds_read_b64_tr_b16 a[6:7], v43 offset:33792
    v_mfma_f32_16x16x32_bf16 v[200:203], a[36:39], a[240:243], v[200:203]
    buffer_load_dwordx4 v39, s[12:15], s61 offen offset:1024 lds
    ds_read_b64_tr_b16 a[8:9], v44 offset:32768
    v_mfma_f32_16x16x32_bf16 v[204:207], a[36:39], a[244:247], v[204:207]
    v_mfma_f32_16x16x32_bf16 a[72:75], a[36:39], a[248:251], a[72:75]
    ds_read_b64_tr_b16 a[10:11], v44 offset:33792
    v_mfma_f32_16x16x32_bf16 a[76:79], a[36:39], a[252:255], a[76:79]
    buffer_load_dwordx4 v40, s[12:15], s61 offen offset:2048 lds
    ds_read_b64_tr_b16 a[12:13], v45 offset:32768
    v_mfma_f32_16x16x32_bf16 v[208:211], a[40:43], a[240:243], v[208:211]
    v_mfma_f32_16x16x32_bf16 v[212:215], a[40:43], a[244:247], v[212:215]
    ds_read_b64_tr_b16 a[14:15], v45 offset:33792
    v_mfma_f32_16x16x32_bf16 a[80:83], a[40:43], a[248:251], a[80:83]
    buffer_load_dwordx4 v41, s[12:15], s61 offen offset:3072 lds
    ds_read_b64_tr_b16 a[16:17], v46 offset:32768
    v_mfma_f32_16x16x32_bf16 a[84:87], a[40:43], a[252:255], a[84:87]
    ds_read_b64_tr_b16 a[18:19], v46 offset:33792
    v_mfma_f32_16x16x32_bf16 v[216:219], a[44:47], a[240:243], v[216:219]
    s_add_u32 s61, s61, 0x80000
    v_mfma_f32_16x16x32_bf16 v[220:223], a[44:47], a[244:247], v[220:223]
    buffer_load_dwordx4 a[160:163], v36, s[8:11], s62 offen sc1
    ds_read_b64_tr_b16 a[20:21], v47 offset:32768
    v_mfma_f32_16x16x32_bf16 a[88:91], a[44:47], a[248:251], a[88:91]
    ds_read_b64_tr_b16 a[22:23], v47 offset:33792
    v_mfma_f32_16x16x32_bf16 a[92:95], a[44:47], a[252:255], a[92:95]
    buffer_load_dwordx4 a[164:167], v54, s[8:11], s62 offen sc1
    ds_read_b64_tr_b16 a[24:25], v48 offset:32768
    v_mfma_f32_16x16x32_bf16 v[224:227], a[48:51], a[240:243], v[224:227]
    v_mfma_f32_16x16x32_bf16 v[228:231], a[48:51], a[244:247], v[228:231]
    ds_read_b64_tr_b16 a[26:27], v48 offset:33792
    v_mfma_f32_16x16x32_bf16 a[96:99], a[48:51], a[248:251], a[96:99]
    buffer_load_dwordx4 a[168:171], v37, s[8:11], s62 offen sc1
    ds_read_b64_tr_b16 a[28:29], v49 offset:32768
    v_mfma_f32_16x16x32_bf16 a[100:103], a[48:51], a[252:255], a[100:103]
    v_mfma_f32_16x16x32_bf16 v[232:235], a[52:55], a[240:243], v[232:235]
    ds_read_b64_tr_b16 a[30:31], v49 offset:33792
    v_mfma_f32_16x16x32_bf16 v[236:239], a[52:55], a[244:247], v[236:239]
    buffer_load_dwordx4 a[172:175], v55, s[8:11], s62 offen sc1
    v_mfma_f32_16x16x32_bf16 a[104:107], a[52:55], a[248:251], a[104:107]
    v_mfma_f32_16x16x32_bf16 a[108:111], a[52:55], a[252:255], a[108:111]
    s_add_u32 s62, s62, 0x20000
    v_mfma_f32_16x16x32_bf16 v[240:243], a[56:59], a[240:243], v[240:243]
    s_add_u32 s52, s47, 4096
    v_mfma_f32_16x16x32_bf16 v[244:247], a[56:59], a[244:247], v[244:247]
    buffer_store_dwordx4 v[80:83], v1, s[48:51], s52 offen offset:0 sc1
    v_mfma_f32_16x16x32_bf16 a[112:115], a[56:59], a[248:251], a[112:115]
    v_mfma_f32_16x16x32_bf16 a[116:119], a[56:59], a[252:255], a[116:119]
    v_mfma_f32_16x16x32_bf16 v[248:251], a[60:63], a[240:243], v[248:251]
    v_mfma_f32_16x16x32_bf16 v[252:255], a[60:63], a[244:247], v[252:255]
    v_mfma_f32_16x16x32_bf16 a[120:123], a[60:63], a[248:251], a[120:123]
    v_mfma_f32_16x16x32_bf16 a[124:127], a[60:63], a[252:255], a[124:127]
    s_waitcnt vmcnt(15) lgkmcnt(0)
    v_mfma_f32_16x16x32_bf16 v[192:195], a[0:3], a[128:131], v[192:195]
    ds_read_b64_tr_b16 a[32:33], v42 offset:40960
    ds_read_b64_tr_b16 a[34:35], v42 offset:41984
    v_mfma_f32_16x16x32_bf16 v[196:199], a[0:3], a[132:135], v[196:199]
    buffer_load_dwordx4 a[176:179], v36, s[8:11], s62 offen sc1
    v_mfma_f32_16x16x32_bf16 a[64:67], a[0:3], a[136:139], a[64:67]
    ds_read_b64_tr_b16 a[36:37], v43 offset:40960
    v_mfma_f32_16x16x32_bf16 a[68:71], a[0:3], a[140:143], a[68:71]
    ds_read_b64_tr_b16 a[38:39], v43 offset:41984
    v_mfma_f32_16x16x32_bf16 v[200:203], a[4:7], a[128:131], v[200:203]
    ds_read_b64_tr_b16 a[40:41], v44 offset:40960
    v_mfma_f32_16x16x32_bf16 v[204:207], a[4:7], a[132:135], v[204:207]
    v_mfma_f32_16x16x32_bf16 a[72:75], a[4:7], a[136:139], a[72:75]
    buffer_load_dwordx4 a[180:183], v54, s[8:11], s62 offen sc1
    ds_read_b64_tr_b16 a[42:43], v44 offset:41984
    v_mfma_f32_16x16x32_bf16 a[76:79], a[4:7], a[140:143], a[76:79]
    ds_read_b64_tr_b16 a[44:45], v45 offset:40960
    v_mfma_f32_16x16x32_bf16 v[208:211], a[8:11], a[128:131], v[208:211]
    v_mfma_f32_16x16x32_bf16 v[212:215], a[8:11], a[132:135], v[212:215]
    ds_read_b64_tr_b16 a[46:47], v45 offset:41984
    v_mfma_f32_16x16x32_bf16 a[80:83], a[8:11], a[136:139], a[80:83]
    ds_read_b64_tr_b16 a[48:49], v46 offset:40960
    v_mfma_f32_16x16x32_bf16 a[84:87], a[8:11], a[140:143], a[84:87]
    buffer_load_dwordx4 a[184:187], v37, s[8:11], s62 offen sc1
    ds_read_b64_tr_b16 a[50:51], v46 offset:41984
    v_mfma_f32_16x16x32_bf16 v[216:219], a[12:15], a[128:131], v[216:219]
    v_mfma_f32_16x16x32_bf16 v[220:223], a[12:15], a[132:135], v[220:223]
    ds_read_b64_tr_b16 a[52:53], v47 offset:40960
    v_mfma_f32_16x16x32_bf16 a[88:91], a[12:15], a[136:139], a[88:91]
    ds_read_b64_tr_b16 a[54:55], v47 offset:41984
    v_mfma_f32_16x16x32_bf16 a[92:95], a[12:15], a[140:143], a[92:95]
    ds_read_b64_tr_b16 a[56:57], v48 offset:40960
    v_mfma_f32_16x16x32_bf16 v[224:227], a[16:19], a[128:131], v[224:227]
    v_mfma_f32_16x16x32_bf16 v[228:231], a[16:19], a[132:135], v[228:231]
    buffer_load_dwordx4 a[188:191], v55, s[8:11], s62 offen sc1
    ds_read_b64_tr_b16 a[58:59], v48 offset:41984
    v_mfma_f32_16x16x32_bf16 a[96:99], a[16:19], a[136:139], a[96:99]
    ds_read_b64_tr_b16 a[60:61], v49 offset:40960
    v_mfma_f32_16x16x32_bf16 a[100:103], a[16:19], a[140:143], a[100:103]
    v_mfma_f32_16x16x32_bf16 v[232:235], a[20:23], a[128:131], v[232:235]
    ds_read_b64_tr_b16 a[62:63], v49 offset:41984
    v_mfma_f32_16x16x32_bf16 v[236:239], a[20:23], a[132:135], v[236:239]
    s_add_u32 s62, s62, 0x20000
    v_mfma_f32_16x16x32_bf16 a[104:107], a[20:23], a[136:139], a[104:107]
    s_add_u32 s52, s47, 4096
    v_mfma_f32_16x16x32_bf16 a[108:111], a[20:23], a[140:143], a[108:111]
    buffer_store_dwordx4 v[84:87], v1, s[48:51], s52 offen offset:1024 sc1
    v_mfma_f32_16x16x32_bf16 v[240:243], a[24:27], a[128:131], v[240:243]
    v_mfma_f32_16x16x32_bf16 v[244:247], a[24:27], a[132:135], v[244:247]
    v_mfma_f32_16x16x32_bf16 a[112:115], a[24:27], a[136:139], a[112:115]
    v_mfma_f32_16x16x32_bf16 a[116:119], a[24:27], a[140:143], a[116:119]
    v_mfma_f32_16x16x32_bf16 v[248:251], a[28:31], a[128:131], v[248:251]
    s_cmp_eq_u32 s45, 0
    s_cbranch_scc1 k12_ool_44
k12_oolret_45:
    v_mfma_f32_16x16x32_bf16 v[252:255], a[28:31], a[132:135], v[252:255]
    v_mfma_f32_16x16x32_bf16 a[120:123], a[28:31], a[136:139], a[120:123]
    v_mfma_f32_16x16x32_bf16 a[124:127], a[28:31], a[140:143], a[124:127]
    s_waitcnt vmcnt(10) lgkmcnt(0)
    s_barrier
    v_mfma_f32_16x16x32_bf16 v[192:195], a[32:35], a[144:147], v[192:195]
    ds_read_b64_tr_b16 a[0:1], v42 offset:49152
    ds_read_b64_tr_b16 a[2:3], v42 offset:50176
    v_mfma_f32_16x16x32_bf16 v[196:199], a[32:35], a[148:151], v[196:199]
    s_add_u32 m0, s60, 98304
    v_mfma_f32_16x16x32_bf16 a[64:67], a[32:35], a[152:155], a[64:67]
    buffer_load_dwordx4 v38, s[12:15], s61 offen offset:0 lds
    ds_read_b64_tr_b16 a[4:5], v43 offset:49152
    v_mfma_f32_16x16x32_bf16 a[68:71], a[32:35], a[156:159], a[68:71]
    ds_read_b64_tr_b16 a[6:7], v43 offset:50176
    v_mfma_f32_16x16x32_bf16 v[200:203], a[36:39], a[144:147], v[200:203]
    buffer_load_dwordx4 v39, s[12:15], s61 offen offset:1024 lds
    ds_read_b64_tr_b16 a[8:9], v44 offset:49152
    v_mfma_f32_16x16x32_bf16 v[204:207], a[36:39], a[148:151], v[204:207]
    v_mfma_f32_16x16x32_bf16 a[72:75], a[36:39], a[152:155], a[72:75]
    ds_read_b64_tr_b16 a[10:11], v44 offset:50176
    v_mfma_f32_16x16x32_bf16 a[76:79], a[36:39], a[156:159], a[76:79]
    buffer_load_dwordx4 v40, s[12:15], s61 offen offset:2048 lds
    ds_read_b64_tr_b16 a[12:13], v45 offset:49152
    v_mfma_f32_16x16x32_bf16 v[208:211], a[40:43], a[144:147], v[208:211]
    v_mfma_f32_16x16x32_bf16 v[212:215], a[40:43], a[148:151], v[212:215]
    ds_read_b64_tr_b16 a[14:15], v45 offset:50176
    v_mfma_f32_16x16x32_bf16 a[80:83], a[40:43], a[152:155], a[80:83]
    buffer_load_dwordx4 v41, s[12:15], s61 offen offset:3072 lds
    ds_read_b64_tr_b16 a[16:17], v46 offset:49152
    v_mfma_f32_16x16x32_bf16 a[84:87], a[40:43], a[156:159], a[84:87]
    ds_read_b64_tr_b16 a[18:19], v46 offset:50176
    v_mfma_f32_16x16x32_bf16 v[216:219], a[44:47], a[144:147], v[216:219]
    s_add_u32 s61, s61, 0x80000
    v_mfma_f32_16x16x32_bf16 v[220:223], a[44:47], a[148:151], v[220:223]
    buffer_load_dwordx4 a[192:195], v36, s[8:11], s62 offen sc1
    ds_read_b64_tr_b16 a[20:21], v47 offset:49152
    v_mfma_f32_16x16x32_bf16 a[88:91], a[44:47], a[152:155], a[88:91]
    ds_read_b64_tr_b16 a[22:23], v47 offset:50176
    v_mfma_f32_16x16x32_bf16 a[92:95], a[44:47], a[156:159], a[92:95]
    buffer_load_dwordx4 a[196:199], v54, s[8:11], s62 offen sc1
    ds_read_b64_tr_b16 a[24:25], v48 offset:49152
    v_mfma_f32_16x16x32_bf16 v[224:227], a[48:51], a[144:147], v[224:227]
    v_mfma_f32_16x16x32_bf16 v[228:231], a[48:51], a[148:151], v[228:231]
    ds_read_b64_tr_b16 a[26:27], v48 offset:50176
    v_mfma_f32_16x16x32_bf16 a[96:99], a[48:51], a[152:155], a[96:99]
    buffer_load_dwordx4 a[200:203], v37, s[8:11], s62 offen sc1
    ds_read_b64_tr_b16 a[28:29], v49 offset:49152
    v_mfma_f32_16x16x32_bf16 a[100:103], a[48:51], a[156:159], a[100:103]
    v_mfma_f32_16x16x32_bf16 v[232:235], a[52:55], a[144:147], v[232:235]
    ds_read_b64_tr_b16 a[30:31], v49 offset:50176
    v_mfma_f32_16x16x32_bf16 v[236:239], a[52:55], a[148:151], v[236:239]
    buffer_load_dwordx4 a[204:207], v55, s[8:11], s62 offen sc1
    v_mfma_f32_16x16x32_bf16 a[104:107], a[52:55], a[152:155], a[104:107]
    v_mfma_f32_16x16x32_bf16 a[108:111], a[52:55], a[156:159], a[108:111]
    s_add_u32 s62, s62, 0x20000
    v_mfma_f32_16x16x32_bf16 v[240:243], a[56:59], a[144:147], v[240:243]
    s_add_u32 s52, s47, 4096
    v_mfma_f32_16x16x32_bf16 v[244:247], a[56:59], a[148:151], v[244:247]
    buffer_store_dwordx4 v[88:91], v1, s[48:51], s52 offen offset:2048 sc1
    v_mfma_f32_16x16x32_bf16 a[112:115], a[56:59], a[152:155], a[112:115]
    v_mfma_f32_16x16x32_bf16 a[116:119], a[56:59], a[156:159], a[116:119]
    v_mfma_f32_16x16x32_bf16 v[248:251], a[60:63], a[144:147], v[248:251]
    v_mfma_f32_16x16x32_bf16 v[252:255], a[60:63], a[148:151], v[252:255]
    v_mfma_f32_16x16x32_bf16 a[120:123], a[60:63], a[152:155], a[120:123]
    v_mfma_f32_16x16x32_bf16 a[124:127], a[60:63], a[156:159], a[124:127]
    s_waitcnt vmcnt(15) lgkmcnt(0)
    v_mfma_f32_16x16x32_bf16 v[192:195], a[0:3], a[160:163], v[192:195]
    ds_read_b64_tr_b16 a[32:33], v42 offset:57344
    ds_read_b64_tr_b16 a[34:35], v42 offset:58368
    v_mfma_f32_16x16x32_bf16 v[196:199], a[0:3], a[164:167], v[196:199]
    buffer_load_dwordx4 a[208:211], v36, s[8:11], s62 offen sc1
    v_mfma_f32_16x16x32_bf16 a[64:67], a[0:3], a[168:171], a[64:67]
    ds_read_b64_tr_b16 a[36:37], v43 offset:57344
    v_mfma_f32_16x16x32_bf16 a[68:71], a[0:3], a[172:175], a[68:71]
    ds_read_b64_tr_b16 a[38:39], v43 offset:58368
    v_mfma_f32_16x16x32_bf16 v[200:203], a[4:7], a[160:163], v[200:203]
    ds_read_b64_tr_b16 a[40:41], v44 offset:57344
    v_mfma_f32_16x16x32_bf16 v[204:207], a[4:7], a[164:167], v[204:207]
    v_mfma_f32_16x16x32_bf16 a[72:75], a[4:7], a[168:171], a[72:75]
    buffer_load_dwordx4 a[212:215], v54, s[8:11], s62 offen sc1
    ds_read_b64_tr_b16 a[42:43], v44 offset:58368
    v_mfma_f32_16x16x32_bf16 a[76:79], a[4:7], a[172:175], a[76:79]
    ds_read_b64_tr_b16 a[44:45], v45 offset:57344
    v_mfma_f32_16x16x32_bf16 v[208:211], a[8:11], a[160:163], v[208:211]
    v_mfma_f32_16x16x32_bf16 v[212:215], a[8:11], a[164:167], v[212:215]
    ds_read_b64_tr_b16 a[46:47], v45 offset:58368
    v_mfma_f32_16x16x32_bf16 a[80:83], a[8:11], a[168:171], a[80:83]
    ds_read_b64_tr_b16 a[48:49], v46 offset:57344
    v_mfma_f32_16x16x32_bf16 a[84:87], a[8:11], a[172:175], a[84:87]
    buffer_load_dwordx4 a[216:219], v37, s[8:11], s62 offen sc1
    ds_read_b64_tr_b16 a[50:51], v46 offset:58368
    v_mfma_f32_16x16x32_bf16 v[216:219], a[12:15], a[160:163], v[216:219]
    v_mfma_f32_16x16x32_bf16 v[220:223], a[12:15], a[164:167], v[220:223]
    ds_read_b64_tr_b16 a[52:53], v47 offset:57344
    v_mfma_f32_16x16x32_bf16 a[88:91], a[12:15], a[168:171], a[88:91]
    ds_read_b64_tr_b16 a[54:55], v47 offset:58368
    v_mfma_f32_16x16x32_bf16 a[92:95], a[12:15], a[172:175], a[92:95]
    ds_read_b64_tr_b16 a[56:57], v48 offset:57344
    v_mfma_f32_16x16x32_bf16 v[224:227], a[16:19], a[160:163], v[224:227]
    v_mfma_f32_16x16x32_bf16 v[228:231], a[16:19], a[164:167], v[228:231]
    buffer_load_dwordx4 a[220:223], v55, s[8:11], s62 offen sc1
    ds_read_b64_tr_b16 a[58:59], v48 offset:58368
    v_mfma_f32_16x16x32_bf16 a[96:99], a[16:19], a[168:171], a[96:99]
    ds_read_b64_tr_b16 a[60:61], v49 offset:57344
    v_mfma_f32_16x16x32_bf16 a[100:103], a[16:19], a[172:175], a[100:103]
    v_mfma_f32_16x16x32_bf16 v[232:235], a[20:23], a[160:163], v[232:235]
    ds_read_b64_tr_b16 a[62:63], v49 offset:58368
    v_mfma_f32_16x16x32_bf16 v[236:239], a[20:23], a[164:167], v[236:239]
    s_add_u32 s62, s62, 0x20000
    v_mfma_f32_16x16x32_bf16 a[104:107], a[20:23], a[168:171], a[104:107]
    s_add_u32 s52, s47, 4096
    v_mfma_f32_16x16x32_bf16 a[108:111], a[20:23], a[172:175], a[108:111]
    buffer_store_dwordx4 v[92:95], v1, s[48:51], s52 offen offset:3072 sc1
    v_mfma_f32_16x16x32_bf16 v[240:243], a[24:27], a[160:163], v[240:243]
    v_mfma_f32_16x16x32_bf16 v[244:247], a[24:27], a[164:167], v[244:247]
    v_mfma_f32_16x16x32_bf16 a[112:115], a[24:27], a[168:171], a[112:115]
    v_mfma_f32_16x16x32_bf16 a[116:119], a[24:27], a[172:175], a[116:119]
    v_mfma_f32_16x16x32_bf16 v[248:251], a[28:31], a[160:163], v[248:251]
    s_cmp_eq_u32 s45, 0
    s_cbranch_scc1 k12_ool_46
k12_oolret_47:
    v_mfma_f32_16x16x32_bf16 v[252:255], a[28:31], a[164:167], v[252:255]
    v_mfma_f32_16x16x32_bf16 a[120:123], a[28:31], a[168:171], a[120:123]
    v_mfma_f32_16x16x32_bf16 a[124:127], a[28:31], a[172:175], a[124:127]
    s_waitcnt vmcnt(10) lgkmcnt(0)
    s_barrier
    v_mfma_f32_16x16x32_bf16 v[192:195], a[32:35], a[176:179], v[192:195]
    ds_read_b64_tr_b16 a[0:1], v42 offset:0
    ds_read_b64_tr_b16 a[2:3], v42 offset:1024
    v_mfma_f32_16x16x32_bf16 v[196:199], a[32:35], a[180:183], v[196:199]
    s_add_u32 m0, s60, 114688
    v_mfma_f32_16x16x32_bf16 a[64:67], a[32:35], a[184:187], a[64:67]
    buffer_load_dwordx4 v38, s[12:15], s61 offen offset:0 lds
    ds_read_b64_tr_b16 a[4:5], v43 offset:0
    v_mfma_f32_16x16x32_bf16 a[68:71], a[32:35], a[188:191], a[68:71]
    ds_read_b64_tr_b16 a[6:7], v43 offset:1024
    v_mfma_f32_16x16x32_bf16 v[200:203], a[36:39], a[176:179], v[200:203]
    buffer_load_dwordx4 v39, s[12:15], s61 offen offset:1024 lds
    ds_read_b64_tr_b16 a[8:9], v44 offset:0
    v_mfma_f32_16x16x32_bf16 v[204:207], a[36:39], a[180:183], v[204:207]
    v_mfma_f32_16x16x32_bf16 a[72:75], a[36:39], a[184:187], a[72:75]
    ds_read_b64_tr_b16 a[10:11], v44 offset:1024
    v_mfma_f32_16x16x32_bf16 a[76:79], a[36:39], a[188:191], a[76:79]
    buffer_load_dwordx4 v40, s[12:15], s61 offen offset:2048 lds
    ds_read_b64_tr_b16 a[12:13], v45 offset:0
    v_mfma_f32_16x16x32_bf16 v[208:211], a[40:43], a[176:179], v[208:211]
    v_mfma_f32_16x16x32_bf16 v[212:215], a[40:43], a[180:183], v[212:215]
    ds_read_b64_tr_b16 a[14:15], v45 offset:1024
    v_mfma_f32_16x16x32_bf16 a[80:83], a[40:43], a[184:187], a[80:83]
    buffer_load_dwordx4 v41, s[12:15], s61 offen offset:3072 lds
    ds_read_b64_tr_b16 a[16:17], v46 offset:0
    v_mfma_f32_16x16x32_bf16 a[84:87], a[40:43], a[188:191], a[84:87]
    ds_read_b64_tr_b16 a[18:19], v46 offset:1024
    v_mfma_f32_16x16x32_bf16 v[216:219], a[44:47], a[176:179], v[216:219]
    s_add_u32 s61, s61, 0x80000
    v_mfma_f32_16x16x32_bf16 v[220:223], a[44:47], a[180:183], v[220:223]
    buffer_load_dwordx4 a[224:227], v36, s[8:11], s62 offen sc1
    ds_read_b64_tr_b16 a[20:21], v47 offset:0
    v_mfma_f32_16x16x32_bf16 a[88:91], a[44:47], a[184:187], a[88:91]
    ds_read_b64_tr_b16 a[22:23], v47 offset:1024
    v_mfma_f32_16x16x32_bf16 a[92:95], a[44:47], a[188:191], a[92:95]
    buffer_load_dwordx4 a[228:231], v54, s[8:11], s62 offen sc1
    ds_read_b64_tr_b16 a[24:25], v48 offset:0
    v_mfma_f32_16x16x32_bf16 v[224:227], a[48:51], a[176:179], v[224:227]
    v_mfma_f32_16x16x32_bf16 v[228:231], a[48:51], a[180:183], v[228:231]
    ds_read_b64_tr_b16 a[26:27], v48 offset:1024
    v_mfma_f32_16x16x32_bf16 a[96:99], a[48:51], a[184:187], a[96:99]
    buffer_load_dwordx4 a[232:235], v37, s[8:11], s62 offen sc1
    ds_read_b64_tr_b16 a[28:29], v49 offset:0
    v_mfma_f32_16x16x32_bf16 a[100:103], a[48:51], a[188:191], a[100:103]
    v_mfma_f32_16x16x32_bf16 v[232:235], a[52:55], a[176:179], v[232:235]
    ds_read_b64_tr_b16 a[30:31], v49 offset:1024
    v_mfma_f32_16x16x32_bf16 v[236:239], a[52:55], a[180:183], v[236:239]
    buffer_load_dwordx4 a[236:239], v55, s[8:11], s62 offen sc1
    v_mfma_f32_16x16x32_bf16 a[104:107], a[52:55], a[184:187], a[104:107]
    v_mfma_f32_16x16x32_bf16 a[108:111], a[52:55], a[188:191], a[108:111]
    s_add_u32 s62, s62, 0x20000
    v_mfma_f32_16x16x32_bf16 v[240:243], a[56:59], a[176:179], v[240:243]
    s_add_u32 s52, s47, 8192
    v_mfma_f32_16x16x32_bf16 v[244:247], a[56:59], a[180:183], v[244:247]
    buffer_store_dwordx4 v[96:99], v1, s[48:51], s52 offen offset:0 sc1
    v_mfma_f32_16x16x32_bf16 a[112:115], a[56:59], a[184:187], a[112:115]
    v_mfma_f32_16x16x32_bf16 a[116:119], a[56:59], a[188:191], a[116:119]
    v_mfma_f32_16x16x32_bf16 v[248:251], a[60:63], a[176:179], v[248:251]
    v_mfma_f32_16x16x32_bf16 v[252:255], a[60:63], a[180:183], v[252:255]
    v_mfma_f32_16x16x32_bf16 a[120:123], a[60:63], a[184:187], a[120:123]
    v_mfma_f32_16x16x32_bf16 a[124:127], a[60:63], a[188:191], a[124:127]
    s_waitcnt vmcnt(15) lgkmcnt(0)
    v_mfma_f32_16x16x32_bf16 v[192:195], a[0:3], a[192:195], v[192:195]
    ds_read_b64_tr_b16 a[32:33], v42 offset:8192
    ds_read_b64_tr_b16 a[34:35], v42 offset:9216
    v_mfma_f32_16x16x32_bf16 v[196:199], a[0:3], a[196:199], v[196:199]
    buffer_load_dwordx4 a[240:243], v36, s[8:11], s62 offen sc1
    v_mfma_f32_16x16x32_bf16 a[64:67], a[0:3], a[200:203], a[64:67]
    ds_read_b64_tr_b16 a[36:37], v43 offset:8192
    v_mfma_f32_16x16x32_bf16 a[68:71], a[0:3], a[204:207], a[68:71]
    ds_read_b64_tr_b16 a[38:39], v43 offset:9216
    v_mfma_f32_16x16x32_bf16 v[200:203], a[4:7], a[192:195], v[200:203]
    ds_read_b64_tr_b16 a[40:41], v44 offset:8192
    v_mfma_f32_16x16x32_bf16 v[204:207], a[4:7], a[196:199], v[204:207]
    v_mfma_f32_16x16x32_bf16 a[72:75], a[4:7], a[200:203], a[72:75]
    buffer_load_dwordx4 a[244:247], v54, s[8:11], s62 offen sc1
    ds_read_b64_tr_b16 a[42:43], v44 offset:9216
    v_mfma_f32_16x16x32_bf16 a[76:79], a[4:7], a[204:207], a[76:79]
    ds_read_b64_tr_b16 a[44:45], v45 offset:8192
    v_mfma_f32_16x16x32_bf16 v[208:211], a[8:11], a[192:195], v[208:211]
    v_mfma_f32_16x16x32_bf16 v[212:215], a[8:11], a[196:199], v[212:215]
    ds_read_b64_tr_b16 a[46:47], v45 offset:9216
    v_mfma_f32_16x16x32_bf16 a[80:83], a[8:11], a[200:203], a[80:83]
    ds_read_b64_tr_b16 a[48:49], v46 offset:8192
    v_mfma_f32_16x16x32_bf16 a[84:87], a[8:11], a[204:207], a[84:87]
    buffer_load_dwordx4 a[248:251], v37, s[8:11], s62 offen sc1
    ds_read_b64_tr_b16 a[50:51], v46 offset:9216
    v_mfma_f32_16x16x32_bf16 v[216:219], a[12:15], a[192:195], v[216:219]
    v_mfma_f32_16x16x32_bf16 v[220:223], a[12:15], a[196:199], v[220:223]
    ds_read_b64_tr_b16 a[52:53], v47 offset:8192
    v_mfma_f32_16x16x32_bf16 a[88:91], a[12:15], a[200:203], a[88:91]
    ds_read_b64_tr_b16 a[54:55], v47 offset:9216
    v_mfma_f32_16x16x32_bf16 a[92:95], a[12:15], a[204:207], a[92:95]
    ds_read_b64_tr_b16 a[56:57], v48 offset:8192
    v_mfma_f32_16x16x32_bf16 v[224:227], a[16:19], a[192:195], v[224:227]
    v_mfma_f32_16x16x32_bf16 v[228:231], a[16:19], a[196:199], v[228:231]
    buffer_load_dwordx4 a[252:255], v55, s[8:11], s62 offen sc1
    ds_read_b64_tr_b16 a[58:59], v48 offset:9216
    v_mfma_f32_16x16x32_bf16 a[96:99], a[16:19], a[200:203], a[96:99]
    ds_read_b64_tr_b16 a[60:61], v49 offset:8192
    v_mfma_f32_16x16x32_bf16 a[100:103], a[16:19], a[204:207], a[100:103]
    v_mfma_f32_16x16x32_bf16 v[232:235], a[20:23], a[192:195], v[232:235]
    ds_read_b64_tr_b16 a[62:63], v49 offset:9216
    v_mfma_f32_16x16x32_bf16 v[236:239], a[20:23], a[196:199], v[236:239]
    s_add_u32 s62, s62, 0x20000
    v_mfma_f32_16x16x32_bf16 a[104:107], a[20:23], a[200:203], a[104:107]
    s_add_u32 s52, s47, 8192
    v_mfma_f32_16x16x32_bf16 a[108:111], a[20:23], a[204:207], a[108:111]
    buffer_store_dwordx4 v[100:103], v1, s[48:51], s52 offen offset:1024 sc1
    v_mfma_f32_16x16x32_bf16 v[240:243], a[24:27], a[192:195], v[240:243]
    v_mfma_f32_16x16x32_bf16 v[244:247], a[24:27], a[196:199], v[244:247]
    v_mfma_f32_16x16x32_bf16 a[112:115], a[24:27], a[200:203], a[112:115]
    v_mfma_f32_16x16x32_bf16 a[116:119], a[24:27], a[204:207], a[116:119]
    v_mfma_f32_16x16x32_bf16 v[248:251], a[28:31], a[192:195], v[248:251]
    s_cmp_eq_u32 s45, 0
    s_cbranch_scc1 k12_ool_48
k12_oolret_49:
    v_mfma_f32_16x16x32_bf16 v[252:255], a[28:31], a[196:199], v[252:255]
    v_mfma_f32_16x16x32_bf16 a[120:123], a[28:31], a[200:203], a[120:123]
    v_mfma_f32_16x16x32_bf16 a[124:127], a[28:31], a[204:207], a[124:127]
    s_waitcnt vmcnt(10) lgkmcnt(0)
    s_barrier
    v_mfma_f32_16x16x32_bf16 v[192:195], a[32:35], a[208:211], v[192:195]
    ds_read_b64_tr_b16 a[0:1], v42 offset:16384
    ds_read_b64_tr_b16 a[2:3], v42 offset:17408
    v_mfma_f32_16x16x32_bf16 v[196:199], a[32:35], a[212:215], v[196:199]
    s_add_u32 m0, s60, 131072
    v_mfma_f32_16x16x32_bf16 a[64:67], a[32:35], a[216:219], a[64:67]
    buffer_load_dwordx4 v38, s[12:15], s61 offen offset:0 lds
    ds_read_b64_tr_b16 a[4:5], v43 offset:16384
    v_mfma_f32_16x16x32_bf16 a[68:71], a[32:35], a[220:223], a[68:71]
    ds_read_b64_tr_b16 a[6:7], v43 offset:17408
    v_mfma_f32_16x16x32_bf16 v[200:203], a[36:39], a[208:211], v[200:203]
    buffer_load_dwordx4 v39, s[12:15], s61 offen offset:1024 lds
    ds_read_b64_tr_b16 a[8:9], v44 offset:16384
    v_mfma_f32_16x16x32_bf16 v[204:207], a[36:39], a[212:215], v[204:207]
    v_mfma_f32_16x16x32_bf16 a[72:75], a[36:39], a[216:219], a[72:75]
    buffer_load_dwordx4 v40, s[12:15], s61 offen offset:2048 lds
    ds_read_b64_tr_b16 a[10:11], v44 offset:17408
    v_mfma_f32_16x16x32_bf16 a[76:79], a[36:39], a[220:223], a[76:79]
    ds_read_b64_tr_b16 a[12:13], v45 offset:16384
    v_mfma_f32_16x16x32_bf16 v[208:211], a[40:43], a[208:211], v[208:211]
    v_mfma_f32_16x16x32_bf16 v[212:215], a[40:43], a[212:215], v[212:215]
    buffer_load_dwordx4 v41, s[12:15], s61 offen offset:3072 lds
    ds_read_b64_tr_b16 a[14:15], v45 offset:17408
    v_mfma_f32_16x16x32_bf16 a[80:83], a[40:43], a[216:219], a[80:83]
    s_add_u32 s61, s61, 0x80000
    ds_read_b64_tr_b16 a[16:17], v46 offset:16384
    v_mfma_f32_16x16x32_bf16 a[84:87], a[40:43], a[220:223], a[84:87]
    buffer_load_dwordx4 a[128:131], v36, s[8:11], s62 offen sc1
    ds_read_b64_tr_b16 a[18:19], v46 offset:17408
    v_mfma_f32_16x16x32_bf16 v[216:219], a[44:47], a[208:211], v[216:219]
    v_mfma_f32_16x16x32_bf16 v[220:223], a[44:47], a[212:215], v[220:223]
    ds_read_b64_tr_b16 a[20:21], v47 offset:16384
    v_mfma_f32_16x16x32_bf16 a[88:91], a[44:47], a[216:219], a[88:91]
    buffer_load_dwordx4 a[132:135], v54, s[8:11], s62 offen sc1
    ds_read_b64_tr_b16 a[22:23], v47 offset:17408
    v_mfma_f32_16x16x32_bf16 a[92:95], a[44:47], a[220:223], a[92:95]
    ds_read_b64_tr_b16 a[24:25], v48 offset:16384
    v_mfma_f32_16x16x32_bf16 v[224:227], a[48:51], a[208:211], v[224:227]
    v_mfma_f32_16x16x32_bf16 v[228:231], a[48:51], a[212:215], v[228:231]
    buffer_load_dwordx4 a[136:139], v37, s[8:11], s62 offen sc1
    ds_read_b64_tr_b16 a[26:27], v48 offset:17408
    v_mfma_f32_16x16x32_bf16 a[96:99], a[48:51], a[216:219], a[96:99]
    ds_read_b64_tr_b16 a[28:29], v49 offset:16384
    v_mfma_f32_16x16x32_bf16 a[100:103], a[48:51], a[220:223], a[100:103]
    buffer_load_dwordx4 a[140:143], v55, s[8:11], s62 offen sc1
    v_mfma_f32_16x16x32_bf16 v[232:235], a[52:55], a[208:211], v[232:235]
    ds_read_b64_tr_b16 a[30:31], v49 offset:17408
    v_mfma_f32_16x16x32_bf16 v[236:239], a[52:55], a[212:215], v[236:239]
    s_add_u32 s62, s62, 0x20000
    v_mfma_f32_16x16x32_bf16 a[104:107], a[52:55], a[216:219], a[104:107]
    s_add_u32 s52, s47, 8192
    v_mfma_f32_16x16x32_bf16 a[108:111], a[52:55], a[220:223], a[108:111]
    buffer_store_dwordx4 v[104:107], v1, s[48:51], s52 offen offset:2048 sc1
    v_mfma_f32_16x16x32_bf16 v[240:243], a[56:59], a[208:211], v[240:243]
    s_add_u32 s52, s47, 8192
    v_mfma_f32_16x16x32_bf16 v[244:247], a[56:59], a[212:215], v[244:247]
    buffer_store_dwordx4 v[108:111], v1, s[48:51], s52 offen offset:3072 sc1
    v_mfma_f32_16x16x32_bf16 a[112:115], a[56:59], a[216:219], a[112:115]
    v_mfma_f32_16x16x32_bf16 a[116:119], a[56:59], a[220:223], a[116:119]
    v_mfma_f32_16x16x32_bf16 v[248:251], a[60:63], a[208:211], v[248:251]
    v_mfma_f32_16x16x32_bf16 v[252:255], a[60:63], a[212:215], v[252:255]
    v_mfma_f32_16x16x32_bf16 a[120:123], a[60:63], a[216:219], a[120:123]
    v_mfma_f32_16x16x32_bf16 a[124:127], a[60:63], a[220:223], a[124:127]
    s_waitcnt vmcnt(16) lgkmcnt(0)
    v_mfma_f32_16x16x32_bf16 v[192:195], a[0:3], a[224:227], v[192:195]
    ds_read_b64_tr_b16 a[32:33], v42 offset:24576
    ds_read_b64_tr_b16 a[34:35], v42 offset:25600
    v_mfma_f32_16x16x32_bf16 v[196:199], a[0:3], a[228:231], v[196:199]
    buffer_load_dwordx4 a[144:147], v36, s[8:11], s62 offen sc1
    v_mfma_f32_16x16x32_bf16 a[64:67], a[0:3], a[232:235], a[64:67]
    ds_read_b64_tr_b16 a[36:37], v43 offset:24576
    v_mfma_f32_16x16x32_bf16 a[68:71], a[0:3], a[236:239], a[68:71]
    ds_read_b64_tr_b16 a[38:39], v43 offset:25600
    v_mfma_f32_16x16x32_bf16 v[200:203], a[4:7], a[224:227], v[200:203]
    ds_read_b64_tr_b16 a[40:41], v44 offset:24576
    v_mfma_f32_16x16x32_bf16 v[204:207], a[4:7], a[228:231], v[204:207]
    v_mfma_f32_16x16x32_bf16 a[72:75], a[4:7], a[232:235], a[72:75]
    buffer_load_dwordx4 a[148:151], v54, s[8:11], s62 offen sc1
    ds_read_b64_tr_b16 a[42:43], v44 offset:25600
    v_mfma_f32_16x16x32_bf16 a[76:79], a[4:7], a[236:239], a[76:79]
    ds_read_b64_tr_b16 a[44:45], v45 offset:24576
    v_mfma_f32_16x16x32_bf16 v[208:211], a[8:11], a[224:227], v[208:211]
    v_mfma_f32_16x16x32_bf16 v[212:215], a[8:11], a[228:231], v[212:215]
    ds_read_b64_tr_b16 a[46:47], v45 offset:25600
    v_mfma_f32_16x16x32_bf16 a[80:83], a[8:11], a[232:235], a[80:83]
    ds_read_b64_tr_b16 a[48:49], v46 offset:24576
    v_mfma_f32_16x16x32_bf16 a[84:87], a[8:11], a[236:239], a[84:87]
    buffer_load_dwordx4 a[152:155], v37, s[8:11], s62 offen sc1
    ds_read_b64_tr_b16 a[50:51], v46 offset:25600
    v_mfma_f32_16x16x32_bf16 v[216:219], a[12:15], a[224:227], v[216:219]
    v_mfma_f32_16x16x32_bf16 v[220:223], a[12:15], a[228:231], v[220:223]
    ds_read_b64_tr_b16 a[52:53], v47 offset:24576
    v_mfma_f32_16x16x32_bf16 a[88:91], a[12:15], a[232:235], a[88:91]
    ds_read_b64_tr_b16 a[54:55], v47 offset:25600
    v_mfma_f32_16x16x32_bf16 a[92:95], a[12:15], a[236:239], a[92:95]
    ds_read_b64_tr_b16 a[56:57], v48 offset:24576
    v_mfma_f32_16x16x32_bf16 v[224:227], a[16:19], a[224:227], v[224:227]
    v_mfma_f32_16x16x32_bf16 v[228:231], a[16:19], a[228:231], v[228:231]
    buffer_load_dwordx4 a[156:159], v55, s[8:11], s62 offen sc1
    ds_read_b64_tr_b16 a[58:59], v48 offset:25600
    v_mfma_f32_16x16x32_bf16 a[96:99], a[16:19], a[232:235], a[96:99]
    ds_read_b64_tr_b16 a[60:61], v49 offset:24576
    v_mfma_f32_16x16x32_bf16 a[100:103], a[16:19], a[236:239], a[100:103]
    v_mfma_f32_16x16x32_bf16 v[232:235], a[20:23], a[224:227], v[232:235]
    ds_read_b64_tr_b16 a[62:63], v49 offset:25600
    v_mfma_f32_16x16x32_bf16 v[236:239], a[20:23], a[228:231], v[236:239]
    s_add_u32 s62, s62, 0x20000
    v_mfma_f32_16x16x32_bf16 a[104:107], a[20:23], a[232:235], a[104:107]
    s_add_u32 s52, s47, 12288
    v_mfma_f32_16x16x32_bf16 a[108:111], a[20:23], a[236:239], a[108:111]
    buffer_store_dwordx4 v[112:115], v1, s[48:51], s52 offen offset:0 sc1
    v_mfma_f32_16x16x32_bf16 v[240:243], a[24:27], a[224:227], v[240:243]
    v_mfma_f32_16x16x32_bf16 v[244:247], a[24:27], a[228:231], v[244:247]
    v_mfma_f32_16x16x32_bf16 a[112:115], a[24:27], a[232:235], a[112:115]
    v_mfma_f32_16x16x32_bf16 a[116:119], a[24:27], a[236:239], a[116:119]
    v_mfma_f32_16x16x32_bf16 v[248:251], a[28:31], a[224:227], v[248:251]
    v_mfma_f32_16x16x32_bf16 v[252:255], a[28:31], a[228:231], v[252:255]
    v_mfma_f32_16x16x32_bf16 a[120:123], a[28:31], a[232:235], a[120:123]
    v_mfma_f32_16x16x32_bf16 a[124:127], a[28:31], a[236:239], a[124:127]
    s_waitcnt vmcnt(11) lgkmcnt(0)
    s_barrier
    v_mfma_f32_16x16x32_bf16 v[192:195], a[32:35], a[240:243], v[192:195]
    ds_read_b64_tr_b16 a[0:1], v42 offset:32768
    ds_read_b64_tr_b16 a[2:3], v42 offset:33792
    v_mfma_f32_16x16x32_bf16 v[196:199], a[32:35], a[244:247], v[196:199]
    s_add_u32 m0, s60, 147456
    v_mfma_f32_16x16x32_bf16 a[64:67], a[32:35], a[248:251], a[64:67]
    buffer_load_dwordx4 v38, s[12:15], s61 offen offset:0 lds
    ds_read_b64_tr_b16 a[4:5], v43 offset:32768
    v_mfma_f32_16x16x32_bf16 a[68:71], a[32:35], a[252:255], a[68:71]
    ds_read_b64_tr_b16 a[6:7], v43 offset:33792
    v_mfma_f32_16x16x32_bf16 v[200:203], a[36:39], a[240:243], v[200:203]
    buffer_load_dwordx4 v39, s[12:15], s61 offen offset:1024 lds
    ds_read_b64_tr_b16 a[8:9], v44 offset:32768
    v_mfma_f32_16x16x32_bf16 v[204:207], a[36:39], a[244:247], v[204:207]
    v_mfma_f32_16x16x32_bf16 a[72:75], a[36:39], a[248:251], a[72:75]
    ds_read_b64_tr_b16 a[10:11], v44 offset:33792
    v_mfma_f32_16x16x32_bf16 a[76:79], a[36:39], a[252:255], a[76:79]
    buffer_load_dwordx4 v40, s[12:15], s61 offen offset:2048 lds
    ds_read_b64_tr_b16 a[12:13], v45 offset:32768
    v_mfma_f32_16x16x32_bf16 v[208:211], a[40:43], a[240:243], v[208:211]
    v_mfma_f32_16x16x32_bf16 v[212:215], a[40:43], a[244:247], v[212:215]
    ds_read_b64_tr_b16 a[14:15], v45 offset:33792
    v_mfma_f32_16x16x32_bf16 a[80:83], a[40:43], a[248:251], a[80:83]
    buffer_load_dwordx4 v41, s[12:15], s61 offen offset:3072 lds
    ds_read_b64_tr_b16 a[16:17], v46 offset:32768
    v_mfma_f32_16x16x32_bf16 a[84:87], a[40:43], a[252:255], a[84:87]
    ds_read_b64_tr_b16 a[18:19], v46 offset:33792
    v_mfma_f32_16x16x32_bf16 v[216:219], a[44:47], a[240:243], v[216:219]
    s_add_u32 s61, s61, 0x80000
    v_mfma_f32_16x16x32_bf16 v[220:223], a[44:47], a[244:247], v[220:223]
    buffer_load_dwordx4 a[160:163], v36, s[8:11], s62 offen sc1
    ds_read_b64_tr_b16 a[20:21], v47 offset:32768
    v_mfma_f32_16x16x32_bf16 a[88:91], a[44:47], a[248:251], a[88:91]
    ds_read_b64_tr_b16 a[22:23], v47 offset:33792
    v_mfma_f32_16x16x32_bf16 a[92:95], a[44:47], a[252:255], a[92:95]
    buffer_load_dwordx4 a[164:167], v54, s[8:11], s62 offen sc1
    ds_read_b64_tr_b16 a[24:25], v48 offset:32768
    v_mfma_f32_16x16x32_bf16 v[224:227], a[48:51], a[240:243], v[224:227]
    v_mfma_f32_16x16x32_bf16 v[228:231], a[48:51], a[244:247], v[228:231]
    ds_read_b64_tr_b16 a[26:27], v48 offset:33792
    v_mfma_f32_16x16x32_bf16 a[96:99], a[48:51], a[248:251], a[96:99]
    buffer_load_dwordx4 a[168:171], v37, s[8:11], s62 offen sc1
    ds_read_b64_tr_b16 a[28:29], v49 offset:32768
    v_mfma_f32_16x16x32_bf16 a[100:103], a[48:51], a[252:255], a[100:103]
    v_mfma_f32_16x16x32_bf16 v[232:235], a[52:55], a[240:243], v[232:235]
    ds_read_b64_tr_b16 a[30:31], v49 offset:33792
    v_mfma_f32_16x16x32_bf16 v[236:239], a[52:55], a[244:247], v[236:239]
    buffer_load_dwordx4 a[172:175], v55, s[8:11], s62 offen sc1
    v_mfma_f32_16x16x32_bf16 a[104:107], a[52:55], a[248:251], a[104:107]
    v_mfma_f32_16x16x32_bf16 a[108:111], a[52:55], a[252:255], a[108:111]
    s_add_u32 s62, s62, 0x20000
    v_mfma_f32_16x16x32_bf16 v[240:243], a[56:59], a[240:243], v[240:243]
    s_add_u32 s52, s47, 12288
    v_mfma_f32_16x16x32_bf16 v[244:247], a[56:59], a[244:247], v[244:247]
    buffer_store_dwordx4 v[116:119], v1, s[48:51], s52 offen offset:1024 sc1
    v_mfma_f32_16x16x32_bf16 a[112:115], a[56:59], a[248:251], a[112:115]
    v_mfma_f32_16x16x32_bf16 a[116:119], a[56:59], a[252:255], a[116:119]
    v_mfma_f32_16x16x32_bf16 v[248:251], a[60:63], a[240:243], v[248:251]
    s_cmp_eq_u32 s45, 0
    s_cbranch_scc1 k12_ool_50
k12_oolret_51:
    v_mfma_f32_16x16x32_bf16 v[252:255], a[60:63], a[244:247], v[252:255]
    v_mfma_f32_16x16x32_bf16 a[120:123], a[60:63], a[248:251], a[120:123]
    v_mfma_f32_16x16x32_bf16 a[124:127], a[60:63], a[252:255], a[124:127]
    s_waitcnt vmcnt(16) lgkmcnt(0)
    v_mfma_f32_16x16x32_bf16 v[192:195], a[0:3], a[128:131], v[192:195]
    ds_read_b64_tr_b16 a[32:33], v42 offset:40960
    ds_read_b64_tr_b16 a[34:35], v42 offset:41984
    v_mfma_f32_16x16x32_bf16 v[196:199], a[0:3], a[132:135], v[196:199]
    buffer_load_dwordx4 a[176:179], v36, s[8:11], s62 offen sc1
    v_mfma_f32_16x16x32_bf16 a[64:67], a[0:3], a[136:139], a[64:67]
    ds_read_b64_tr_b16 a[36:37], v43 offset:40960
    v_mfma_f32_16x16x32_bf16 a[68:71], a[0:3], a[140:143], a[68:71]
    ds_read_b64_tr_b16 a[38:39], v43 offset:41984
    v_mfma_f32_16x16x32_bf16 v[200:203], a[4:7], a[128:131], v[200:203]
    ds_read_b64_tr_b16 a[40:41], v44 offset:40960
    v_mfma_f32_16x16x32_bf16 v[204:207], a[4:7], a[132:135], v[204:207]
    v_mfma_f32_16x16x32_bf16 a[72:75], a[4:7], a[136:139], a[72:75]
    buffer_load_dwordx4 a[180:183], v54, s[8:11], s62 offen sc1
    ds_read_b64_tr_b16 a[42:43], v44 offset:41984
    v_mfma_f32_16x16x32_bf16 a[76:79], a[4:7], a[140:143], a[76:79]
    ds_read_b64_tr_b16 a[44:45], v45 offset:40960
    v_mfma_f32_16x16x32_bf16 v[208:211], a[8:11], a[128:131], v[208:211]
    v_mfma_f32_16x16x32_bf16 v[212:215], a[8:11], a[132:135], v[212:215]
    ds_read_b64_tr_b16 a[46:47], v45 offset:41984
    v_mfma_f32_16x16x32_bf16 a[80:83], a[8:11], a[136:139], a[80:83]
    ds_read_b64_tr_b16 a[48:49], v46 offset:40960
    v_mfma_f32_16x16x32_bf16 a[84:87], a[8:11], a[140:143], a[84:87]
    buffer_load_dwordx4 a[184:187], v37, s[8:11], s62 offen sc1
    ds_read_b64_tr_b16 a[50:51], v46 offset:41984
    v_mfma_f32_16x16x32_bf16 v[216:219], a[12:15], a[128:131], v[216:219]
    v_mfma_f32_16x16x32_bf16 v[220:223], a[12:15], a[132:135], v[220:223]
    ds_read_b64_tr_b16 a[52:53], v47 offset:40960
    v_mfma_f32_16x16x32_bf16 a[88:91], a[12:15], a[136:139], a[88:91]
    ds_read_b64_tr_b16 a[54:55], v47 offset:41984
    v_mfma_f32_16x16x32_bf16 a[92:95], a[12:15], a[140:143], a[92:95]
    ds_read_b64_tr_b16 a[56:57], v48 offset:40960
    v_mfma_f32_16x16x32_bf16 v[224:227], a[16:19], a[128:131], v[224:227]
    v_mfma_f32_16x16x32_bf16 v[228:231], a[16:19], a[132:135], v[228:231]
    buffer_load_dwordx4 a[188:191], v55, s[8:11], s62 offen sc1
    ds_read_b64_tr_b16 a[58:59], v48 offset:41984
    v_mfma_f32_16x16x32_bf16 a[96:99], a[16:19], a[136:139], a[96:99]
    ds_read_b64_tr_b16 a[60:61], v49 offset:40960
    v_mfma_f32_16x16x32_bf16 a[100:103], a[16:19], a[140:143], a[100:103]
    v_mfma_f32_16x16x32_bf16 v[232:235], a[20:23], a[128:131], v[232:235]
    ds_read_b64_tr_b16 a[62:63], v49 offset:41984
    v_mfma_f32_16x16x32_bf16 v[236:239], a[20:23], a[132:135], v[236:239]
    s_add_u32 s62, s62, 0x20000
    v_mfma_f32_16x16x32_bf16 a[104:107], a[20:23], a[136:139], a[104:107]
    s_add_u32 s52, s47, 12288
    v_mfma_f32_16x16x32_bf16 a[108:111], a[20:23], a[140:143], a[108:111]
    buffer_store_dwordx4 v[120:123], v1, s[48:51], s52 offen offset:2048 sc1
    v_mfma_f32_16x16x32_bf16 v[240:243], a[24:27], a[128:131], v[240:243]
    v_mfma_f32_16x16x32_bf16 v[244:247], a[24:27], a[132:135], v[244:247]
    v_mfma_f32_16x16x32_bf16 a[112:115], a[24:27], a[136:139], a[112:115]
    v_mfma_f32_16x16x32_bf16 a[116:119], a[24:27], a[140:143], a[116:119]
    v_mfma_f32_16x16x32_bf16 v[248:251], a[28:31], a[128:131], v[248:251]
    v_mfma_f32_16x16x32_bf16 v[252:255], a[28:31], a[132:135], v[252:255]
    v_mfma_f32_16x16x32_bf16 a[120:123], a[28:31], a[136:139], a[120:123]
    v_mfma_f32_16x16x32_bf16 a[124:127], a[28:31], a[140:143], a[124:127]
    s_waitcnt vmcnt(10) lgkmcnt(0)
    s_barrier
    v_mfma_f32_16x16x32_bf16 v[192:195], a[32:35], a[144:147], v[192:195]
    ds_read_b64_tr_b16 a[0:1], v42 offset:49152
    ds_read_b64_tr_b16 a[2:3], v42 offset:50176
    v_mfma_f32_16x16x32_bf16 v[196:199], a[32:35], a[148:151], v[196:199]
    s_add_u32 m0, s60, 98304
    v_mfma_f32_16x16x32_bf16 a[64:67], a[32:35], a[152:155], a[64:67]
    buffer_load_dwordx4 v38, s[12:15], s61 offen offset:0 lds
    ds_read_b64_tr_b16 a[4:5], v43 offset:49152
    v_mfma_f32_16x16x32_bf16 a[68:71], a[32:35], a[156:159], a[68:71]
    ds_read_b64_tr_b16 a[6:7], v43 offset:50176
    v_mfma_f32_16x16x32_bf16 v[200:203], a[36:39], a[144:147], v[200:203]
    buffer_load_dwordx4 v39, s[12:15], s61 offen offset:1024 lds
    ds_read_b64_tr_b16 a[8:9], v44 offset:49152
    v_mfma_f32_16x16x32_bf16 v[204:207], a[36:39], a[148:151], v[204:207]
    v_mfma_f32_16x16x32_bf16 a[72:75], a[36:39], a[152:155], a[72:75]
    ds_read_b64_tr_b16 a[10:11], v44 offset:50176
    v_mfma_f32_16x16x32_bf16 a[76:79], a[36:39], a[156:159], a[76:79]
    buffer_load_dwordx4 v40, s[12:15], s61 offen offset:2048 lds
    ds_read_b64_tr_b16 a[12:13], v45 offset:49152
    v_mfma_f32_16x16x32_bf16 v[208:211], a[40:43], a[144:147], v[208:211]
    v_mfma_f32_16x16x32_bf16 v[212:215], a[40:43], a[148:151], v[212:215]
    ds_read_b64_tr_b16 a[14:15], v45 offset:50176
    v_mfma_f32_16x16x32_bf16 a[80:83], a[40:43], a[152:155], a[80:83]
    buffer_load_dwordx4 v41, s[12:15], s61 offen offset:3072 lds
    ds_read_b64_tr_b16 a[16:17], v46 offset:49152
    v_mfma_f32_16x16x32_bf16 a[84:87], a[40:43], a[156:159], a[84:87]
    ds_read_b64_tr_b16 a[18:19], v46 offset:50176
    v_mfma_f32_16x16x32_bf16 v[216:219], a[44:47], a[144:147], v[216:219]
    s_add_u32 s61, s61, 0x80000
    v_mfma_f32_16x16x32_bf16 v[220:223], a[44:47], a[148:151], v[220:223]
    buffer_load_dwordx4 a[192:195], v36, s[8:11], s62 offen sc1
    ds_read_b64_tr_b16 a[20:21], v47 offset:49152
    v_mfma_f32_16x16x32_bf16 a[88:91], a[44:47], a[152:155], a[88:91]
    ds_read_b64_tr_b16 a[22:23], v47 offset:50176
    v_mfma_f32_16x16x32_bf16 a[92:95], a[44:47], a[156:159], a[92:95]
    buffer_load_dwordx4 a[196:199], v54, s[8:11], s62 offen sc1
    ds_read_b64_tr_b16 a[24:25], v48 offset:49152
    v_mfma_f32_16x16x32_bf16 v[224:227], a[48:51], a[144:147], v[224:227]
    v_mfma_f32_16x16x32_bf16 v[228:231], a[48:51], a[148:151], v[228:231]
    ds_read_b64_tr_b16 a[26:27], v48 offset:50176
    v_mfma_f32_16x16x32_bf16 a[96:99], a[48:51], a[152:155], a[96:99]
    buffer_load_dwordx4 a[200:203], v37, s[8:11], s62 offen sc1
    ds_read_b64_tr_b16 a[28:29], v49 offset:49152
    v_mfma_f32_16x16x32_bf16 a[100:103], a[48:51], a[156:159], a[100:103]
    v_mfma_f32_16x16x32_bf16 v[232:235], a[52:55], a[144:147], v[232:235]
    ds_read_b64_tr_b16 a[30:31], v49 offset:50176
    v_mfma_f32_16x16x32_bf16 v[236:239], a[52:55], a[148:151], v[236:239]
    buffer_load_dwordx4 a[204:207], v55, s[8:11], s62 offen sc1
    v_mfma_f32_16x16x32_bf16 a[104:107], a[52:55], a[152:155], a[104:107]
    v_mfma_f32_16x16x32_bf16 a[108:111], a[52:55], a[156:159], a[108:111]
    s_add_u32 s62, s62, 0x20000
    v_mfma_f32_16x16x32_bf16 v[240:243], a[56:59], a[144:147], v[240:243]
    s_add_u32 s52, s47, 12288
    v_mfma_f32_16x16x32_bf16 v[244:247], a[56:59], a[148:151], v[244:247]
    buffer_store_dwordx4 v[124:127], v1, s[48:51], s52 offen offset:3072 sc1
    v_mfma_f32_16x16x32_bf16 a[112:115], a[56:59], a[152:155], a[112:115]
    v_mfma_f32_16x16x32_bf16 a[116:119], a[56:59], a[156:159], a[116:119]
    v_mfma_f32_16x16x32_bf16 v[248:251], a[60:63], a[144:147], v[248:251]
    s_cmp_eq_u32 s45, 0
    s_cbranch_scc1 k12_ool_52
k12_oolret_53:
    v_mfma_f32_16x16x32_bf16 v[252:255], a[60:63], a[148:151], v[252:255]
    v_mfma_f32_16x16x32_bf16 a[120:123], a[60:63], a[152:155], a[120:123]
    v_mfma_f32_16x16x32_bf16 a[124:127], a[60:63], a[156:159], a[124:127]
    s_waitcnt vmcnt(15) lgkmcnt(0)
    v_mfma_f32_16x16x32_bf16 v[192:195], a[0:3], a[160:163], v[192:195]
    ds_read_b64_tr_b16 a[32:33], v42 offset:57344
    ds_read_b64_tr_b16 a[34:35], v42 offset:58368
    v_mfma_f32_16x16x32_bf16 v[196:199], a[0:3], a[164:167], v[196:199]
    buffer_load_dwordx4 a[208:211], v36, s[8:11], s62 offen sc1
    v_mfma_f32_16x16x32_bf16 a[64:67], a[0:3], a[168:171], a[64:67]
    ds_read_b64_tr_b16 a[36:37], v43 offset:57344
    v_mfma_f32_16x16x32_bf16 a[68:71], a[0:3], a[172:175], a[68:71]
    ds_read_b64_tr_b16 a[38:39], v43 offset:58368
    v_mfma_f32_16x16x32_bf16 v[200:203], a[4:7], a[160:163], v[200:203]
    ds_read_b64_tr_b16 a[40:41], v44 offset:57344
    v_mfma_f32_16x16x32_bf16 v[204:207], a[4:7], a[164:167], v[204:207]
    v_mfma_f32_16x16x32_bf16 a[72:75], a[4:7], a[168:171], a[72:75]
    buffer_load_dwordx4 a[212:215], v54, s[8:11], s62 offen sc1
    ds_read_b64_tr_b16 a[42:43], v44 offset:58368
    v_mfma_f32_16x16x32_bf16 a[76:79], a[4:7], a[172:175], a[76:79]
    ds_read_b64_tr_b16 a[44:45], v45 offset:57344
    v_mfma_f32_16x16x32_bf16 v[208:211], a[8:11], a[160:163], v[208:211]
    v_mfma_f32_16x16x32_bf16 v[212:215], a[8:11], a[164:167], v[212:215]
    ds_read_b64_tr_b16 a[46:47], v45 offset:58368
    v_mfma_f32_16x16x32_bf16 a[80:83], a[8:11], a[168:171], a[80:83]
    ds_read_b64_tr_b16 a[48:49], v46 offset:57344
    v_mfma_f32_16x16x32_bf16 a[84:87], a[8:11], a[172:175], a[84:87]
    buffer_load_dwordx4 a[216:219], v37, s[8:11], s62 offen sc1
    ds_read_b64_tr_b16 a[50:51], v46 offset:58368
    v_mfma_f32_16x16x32_bf16 v[216:219], a[12:15], a[160:163], v[216:219]
    v_mfma_f32_16x16x32_bf16 v[220:223], a[12:15], a[164:167], v[220:223]
    ds_read_b64_tr_b16 a[52:53], v47 offset:57344
    v_mfma_f32_16x16x32_bf16 a[88:91], a[12:15], a[168:171], a[88:91]
    ds_read_b64_tr_b16 a[54:55], v47 offset:58368
    v_mfma_f32_16x16x32_bf16 a[92:95], a[12:15], a[172:175], a[92:95]
    ds_read_b64_tr_b16 a[56:57], v48 offset:57344
    v_mfma_f32_16x16x32_bf16 v[224:227], a[16:19], a[160:163], v[224:227]
    v_mfma_f32_16x16x32_bf16 v[228:231], a[16:19], a[164:167], v[228:231]
    buffer_load_dwordx4 a[220:223], v55, s[8:11], s62 offen sc1
    ds_read_b64_tr_b16 a[58:59], v48 offset:58368
    v_mfma_f32_16x16x32_bf16 a[96:99], a[16:19], a[168:171], a[96:99]
    ds_read_b64_tr_b16 a[60:61], v49 offset:57344
    v_mfma_f32_16x16x32_bf16 a[100:103], a[16:19], a[172:175], a[100:103]
    v_mfma_f32_16x16x32_bf16 v[232:235], a[20:23], a[160:163], v[232:235]
    ds_read_b64_tr_b16 a[62:63], v49 offset:58368
    v_mfma_f32_16x16x32_bf16 v[236:239], a[20:23], a[164:167], v[236:239]
    s_add_u32 s62, s62, 0x20000
    v_mfma_f32_16x16x32_bf16 a[104:107], a[20:23], a[168:171], a[104:107]
    s_add_u32 s52, s47, 524288
    v_mfma_f32_16x16x32_bf16 a[108:111], a[20:23], a[172:175], a[108:111]
    buffer_store_dwordx4 v[128:131], v1, s[48:51], s52 offen offset:0 sc1
    v_mfma_f32_16x16x32_bf16 v[240:243], a[24:27], a[160:163], v[240:243]
    v_mfma_f32_16x16x32_bf16 v[244:247], a[24:27], a[164:167], v[244:247]
    v_mfma_f32_16x16x32_bf16 a[112:115], a[24:27], a[168:171], a[112:115]
    v_mfma_f32_16x16x32_bf16 a[116:119], a[24:27], a[172:175], a[116:119]
    v_mfma_f32_16x16x32_bf16 v[248:251], a[28:31], a[160:163], v[248:251]
    v_mfma_f32_16x16x32_bf16 v[252:255], a[28:31], a[164:167], v[252:255]
    v_mfma_f32_16x16x32_bf16 a[120:123], a[28:31], a[168:171], a[120:123]
    v_mfma_f32_16x16x32_bf16 a[124:127], a[28:31], a[172:175], a[124:127]
    s_waitcnt vmcnt(10) lgkmcnt(0)
    s_barrier
    v_mfma_f32_16x16x32_bf16 v[192:195], a[32:35], a[176:179], v[192:195]
    ds_read_b64_tr_b16 a[0:1], v42 offset:0
    ds_read_b64_tr_b16 a[2:3], v42 offset:1024
    v_mfma_f32_16x16x32_bf16 v[196:199], a[32:35], a[180:183], v[196:199]
    s_add_u32 m0, s60, 114688
    v_mfma_f32_16x16x32_bf16 a[64:67], a[32:35], a[184:187], a[64:67]
    buffer_load_dwordx4 v38, s[12:15], s61 offen offset:0 lds
    ds_read_b64_tr_b16 a[4:5], v43 offset:0
    v_mfma_f32_16x16x32_bf16 a[68:71], a[32:35], a[188:191], a[68:71]
    ds_read_b64_tr_b16 a[6:7], v43 offset:1024
    v_mfma_f32_16x16x32_bf16 v[200:203], a[36:39], a[176:179], v[200:203]
    buffer_load_dwordx4 v39, s[12:15], s61 offen offset:1024 lds
    ds_read_b64_tr_b16 a[8:9], v44 offset:0
    v_mfma_f32_16x16x32_bf16 v[204:207], a[36:39], a[180:183], v[204:207]
    v_mfma_f32_16x16x32_bf16 a[72:75], a[36:39], a[184:187], a[72:75]
    ds_read_b64_tr_b16 a[10:11], v44 offset:1024
    v_mfma_f32_16x16x32_bf16 a[76:79], a[36:39], a[188:191], a[76:79]
    buffer_load_dwordx4 v40, s[12:15], s61 offen offset:2048 lds
    ds_read_b64_tr_b16 a[12:13], v45 offset:0
    v_mfma_f32_16x16x32_bf16 v[208:211], a[40:43], a[176:179], v[208:211]
    v_mfma_f32_16x16x32_bf16 v[212:215], a[40:43], a[180:183], v[212:215]
    ds_read_b64_tr_b16 a[14:15], v45 offset:1024
    v_mfma_f32_16x16x32_bf16 a[80:83], a[40:43], a[184:187], a[80:83]
    buffer_load_dwordx4 v41, s[12:15], s61 offen offset:3072 lds
    ds_read_b64_tr_b16 a[16:17], v46 offset:0
    v_mfma_f32_16x16x32_bf16 a[84:87], a[40:43], a[188:191], a[84:87]
    ds_read_b64_tr_b16 a[18:19], v46 offset:1024
    v_mfma_f32_16x16x32_bf16 v[216:219], a[44:47], a[176:179], v[216:219]
    s_add_u32 s61, s61, 0x80000
    v_mfma_f32_16x16x32_bf16 v[220:223], a[44:47], a[180:183], v[220:223]
    buffer_load_dwordx4 a[224:227], v36, s[8:11], s62 offen sc1
    ds_read_b64_tr_b16 a[20:21], v47 offset:0
    v_mfma_f32_16x16x32_bf16 a[88:91], a[44:47], a[184:187], a[88:91]
    ds_read_b64_tr_b16 a[22:23], v47 offset:1024
    v_mfma_f32_16x16x32_bf16 a[92:95], a[44:47], a[188:191], a[92:95]
    buffer_load_dwordx4 a[228:231], v54, s[8:11], s62 offen sc1
    ds_read_b64_tr_b16 a[24:25], v48 offset:0
    v_mfma_f32_16x16x32_bf16 v[224:227], a[48:51], a[176:179], v[224:227]
    v_mfma_f32_16x16x32_bf16 v[228:231], a[48:51], a[180:183], v[228:231]
    ds_read_b64_tr_b16 a[26:27], v48 offset:1024
    v_mfma_f32_16x16x32_bf16 a[96:99], a[48:51], a[184:187], a[96:99]
    buffer_load_dwordx4 a[232:235], v37, s[8:11], s62 offen sc1
    ds_read_b64_tr_b16 a[28:29], v49 offset:0
    v_mfma_f32_16x16x32_bf16 a[100:103], a[48:51], a[188:191], a[100:103]
    v_mfma_f32_16x16x32_bf16 v[232:235], a[52:55], a[176:179], v[232:235]
    ds_read_b64_tr_b16 a[30:31], v49 offset:1024
    v_mfma_f32_16x16x32_bf16 v[236:239], a[52:55], a[180:183], v[236:239]
    buffer_load_dwordx4 a[236:239], v55, s[8:11], s62 offen sc1
    v_mfma_f32_16x16x32_bf16 a[104:107], a[52:55], a[184:187], a[104:107]
    v_mfma_f32_16x16x32_bf16 a[108:111], a[52:55], a[188:191], a[108:111]
    s_add_u32 s62, s62, 0x20000
    v_mfma_f32_16x16x32_bf16 v[240:243], a[56:59], a[176:179], v[240:243]
    s_add_u32 s52, s47, 524288
    v_mfma_f32_16x16x32_bf16 v[244:247], a[56:59], a[180:183], v[244:247]
    buffer_store_dwordx4 v[132:135], v1, s[48:51], s52 offen offset:1024 sc1
    v_mfma_f32_16x16x32_bf16 a[112:115], a[56:59], a[184:187], a[112:115]
    v_mfma_f32_16x16x32_bf16 a[116:119], a[56:59], a[188:191], a[116:119]
    v_mfma_f32_16x16x32_bf16 v[248:251], a[60:63], a[176:179], v[248:251]
    s_cmp_eq_u32 s45, 0
    s_cbranch_scc1 k12_ool_54
k12_oolret_55:
    v_mfma_f32_16x16x32_bf16 v[252:255], a[60:63], a[180:183], v[252:255]
    v_mfma_f32_16x16x32_bf16 a[120:123], a[60:63], a[184:187], a[120:123]
    v_mfma_f32_16x16x32_bf16 a[124:127], a[60:63], a[188:191], a[124:127]
    s_waitcnt vmcnt(15) lgkmcnt(0)
    v_mfma_f32_16x16x32_bf16 v[192:195], a[0:3], a[192:195], v[192:195]
    ds_read_b64_tr_b16 a[32:33], v42 offset:8192
    ds_read_b64_tr_b16 a[34:35], v42 offset:9216
    v_mfma_f32_16x16x32_bf16 v[196:199], a[0:3], a[196:199], v[196:199]
    buffer_load_dwordx4 a[240:243], v36, s[8:11], s62 offen sc1
    v_mfma_f32_16x16x32_bf16 a[64:67], a[0:3], a[200:203], a[64:67]
    ds_read_b64_tr_b16 a[36:37], v43 offset:8192
    v_mfma_f32_16x16x32_bf16 a[68:71], a[0:3], a[204:207], a[68:71]
    ds_read_b64_tr_b16 a[38:39], v43 offset:9216
    v_mfma_f32_16x16x32_bf16 v[200:203], a[4:7], a[192:195], v[200:203]
    ds_read_b64_tr_b16 a[40:41], v44 offset:8192
    v_mfma_f32_16x16x32_bf16 v[204:207], a[4:7], a[196:199], v[204:207]
    v_mfma_f32_16x16x32_bf16 a[72:75], a[4:7], a[200:203], a[72:75]
    buffer_load_dwordx4 a[244:247], v54, s[8:11], s62 offen sc1
    ds_read_b64_tr_b16 a[42:43], v44 offset:9216
    v_mfma_f32_16x16x32_bf16 a[76:79], a[4:7], a[204:207], a[76:79]
    ds_read_b64_tr_b16 a[44:45], v45 offset:8192
    v_mfma_f32_16x16x32_bf16 v[208:211], a[8:11], a[192:195], v[208:211]
    v_mfma_f32_16x16x32_bf16 v[212:215], a[8:11], a[196:199], v[212:215]
    ds_read_b64_tr_b16 a[46:47], v45 offset:9216
    v_mfma_f32_16x16x32_bf16 a[80:83], a[8:11], a[200:203], a[80:83]
    ds_read_b64_tr_b16 a[48:49], v46 offset:8192
    v_mfma_f32_16x16x32_bf16 a[84:87], a[8:11], a[204:207], a[84:87]
    buffer_load_dwordx4 a[248:251], v37, s[8:11], s62 offen sc1
    ds_read_b64_tr_b16 a[50:51], v46 offset:9216
    v_mfma_f32_16x16x32_bf16 v[216:219], a[12:15], a[192:195], v[216:219]
    v_mfma_f32_16x16x32_bf16 v[220:223], a[12:15], a[196:199], v[220:223]
    ds_read_b64_tr_b16 a[52:53], v47 offset:8192
    v_mfma_f32_16x16x32_bf16 a[88:91], a[12:15], a[200:203], a[88:91]
    ds_read_b64_tr_b16 a[54:55], v47 offset:9216
    v_mfma_f32_16x16x32_bf16 a[92:95], a[12:15], a[204:207], a[92:95]
    ds_read_b64_tr_b16 a[56:57], v48 offset:8192
    v_mfma_f32_16x16x32_bf16 v[224:227], a[16:19], a[192:195], v[224:227]
    v_mfma_f32_16x16x32_bf16 v[228:231], a[16:19], a[196:199], v[228:231]
    buffer_load_dwordx4 a[252:255], v55, s[8:11], s62 offen sc1
    ds_read_b64_tr_b16 a[58:59], v48 offset:9216
    v_mfma_f32_16x16x32_bf16 a[96:99], a[16:19], a[200:203], a[96:99]
    ds_read_b64_tr_b16 a[60:61], v49 offset:8192
    v_mfma_f32_16x16x32_bf16 a[100:103], a[16:19], a[204:207], a[100:103]
    v_mfma_f32_16x16x32_bf16 v[232:235], a[20:23], a[192:195], v[232:235]
    ds_read_b64_tr_b16 a[62:63], v49 offset:9216
    v_mfma_f32_16x16x32_bf16 v[236:239], a[20:23], a[196:199], v[236:239]
    s_add_u32 s62, s62, 0x20000
    v_mfma_f32_16x16x32_bf16 a[104:107], a[20:23], a[200:203], a[104:107]
    s_add_u32 s52, s47, 524288
    v_mfma_f32_16x16x32_bf16 a[108:111], a[20:23], a[204:207], a[108:111]
    buffer_store_dwordx4 v[136:139], v1, s[48:51], s52 offen offset:2048 sc1
    v_mfma_f32_16x16x32_bf16 v[240:243], a[24:27], a[192:195], v[240:243]
    v_mfma_f32_16x16x32_bf16 v[244:247], a[24:27], a[196:199], v[244:247]
    v_mfma_f32_16x16x32_bf16 a[112:115], a[24:27], a[200:203], a[112:115]
    v_mfma_f32_16x16x32_bf16 a[116:119], a[24:27], a[204:207], a[116:119]
    v_mfma_f32_16x16x32_bf16 v[248:251], a[28:31], a[192:195], v[248:251]
    v_mfma_f32_16x16x32_bf16 v[252:255], a[28:31], a[196:199], v[252:255]
    v_mfma_f32_16x16x32_bf16 a[120:123], a[28:31], a[200:203], a[120:123]
    v_mfma_f32_16x16x32_bf16 a[124:127], a[28:31], a[204:207], a[124:127]
    s_waitcnt vmcnt(10) lgkmcnt(0)
    s_barrier
    v_mfma_f32_16x16x32_bf16 v[192:195], a[32:35], a[208:211], v[192:195]
    ds_read_b64_tr_b16 a[0:1], v42 offset:16384
    ds_read_b64_tr_b16 a[2:3], v42 offset:17408
    v_mfma_f32_16x16x32_bf16 v[196:199], a[32:35], a[212:215], v[196:199]
    s_add_u32 m0, s60, 131072
    v_mfma_f32_16x16x32_bf16 a[64:67], a[32:35], a[216:219], a[64:67]
    buffer_load_dwordx4 v38, s[12:15], s61 offen offset:0 lds
    ds_read_b64_tr_b16 a[4:5], v43 offset:16384
    v_mfma_f32_16x16x32_bf16 a[68:71], a[32:35], a[220:223], a[68:71]
    ds_read_b64_tr_b16 a[6:7], v43 offset:17408
    v_mfma_f32_16x16x32_bf16 v[200:203], a[36:39], a[208:211], v[200:203]
    buffer_load_dwordx4 v39, s[12:15], s61 offen offset:1024 lds
    ds_read_b64_tr_b16 a[8:9], v44 offset:16384
    v_mfma_f32_16x16x32_bf16 v[204:207], a[36:39], a[212:215], v[204:207]
    v_mfma_f32_16x16x32_bf16 a[72:75], a[36:39], a[216:219], a[72:75]
    ds_read_b64_tr_b16 a[10:11], v44 offset:17408
    v_mfma_f32_16x16x32_bf16 a[76:79], a[36:39], a[220:223], a[76:79]
    buffer_load_dwordx4 v40, s[12:15], s61 offen offset:2048 lds
    ds_read_b64_tr_b16 a[12:13], v45 offset:16384
    v_mfma_f32_16x16x32_bf16 v[208:211], a[40:43], a[208:211], v[208:211]
    v_mfma_f32_16x16x32_bf16 v[212:215], a[40:43], a[212:215], v[212:215]
    ds_read_b64_tr_b16 a[14:15], v45 offset:17408
    v_mfma_f32_16x16x32_bf16 a[80:83], a[40:43], a[216:219], a[80:83]
    buffer_load_dwordx4 v41, s[12:15], s61 offen offset:3072 lds
    ds_read_b64_tr_b16 a[16:17], v46 offset:16384
    v_mfma_f32_16x16x32_bf16 a[84:87], a[40:43], a[220:223], a[84:87]
    ds_read_b64_tr_b16 a[18:19], v46 offset:17408
    v_mfma_f32_16x16x32_bf16 v[216:219], a[44:47], a[208:211], v[216:219]
    s_add_u32 s61, s61, 0x80000
    v_mfma_f32_16x16x32_bf16 v[220:223], a[44:47], a[212:215], v[220:223]
    buffer_load_dwordx4 a[128:131], v36, s[8:11], s62 offen sc1
    ds_read_b64_tr_b16 a[20:21], v47 offset:16384
    v_mfma_f32_16x16x32_bf16 a[88:91], a[44:47], a[216:219], a[88:91]
    ds_read_b64_tr_b16 a[22:23], v47 offset:17408
    v_mfma_f32_16x16x32_bf16 a[92:95], a[44:47], a[220:223], a[92:95]
    buffer_load_dwordx4 a[132:135], v54, s[8:11], s62 offen sc1
    ds_read_b64_tr_b16 a[24:25], v48 offset:16384
    v_mfma_f32_16x16x32_bf16 v[224:227], a[48:51], a[208:211], v[224:227]
    v_mfma_f32_16x16x32_bf16 v[228:231], a[48:51], a[212:215], v[228:231]
    ds_read_b64_tr_b16 a[26:27], v48 offset:17408
    v_mfma_f32_16x16x32_bf16 a[96:99], a[48:51], a[216:219], a[96:99]
    buffer_load_dwordx4 a[136:139], v37, s[8:11], s62 offen sc1
    ds_read_b64_tr_b16 a[28:29], v49 offset:16384
    v_mfma_f32_16x16x32_bf16 a[100:103], a[48:51], a[220:223], a[100:103]
    v_mfma_f32_16x16x32_bf16 v[232:235], a[52:55], a[208:211], v[232:235]
    ds_read_b64_tr_b16 a[30:31], v49 offset:17408
    v_mfma_f32_16x16x32_bf16 v[236:239], a[52:55], a[212:215], v[236:239]
    buffer_load_dwordx4 a[140:143], v55, s[8:11], s62 offen sc1
    v_mfma_f32_16x16x32_bf16 a[104:107], a[52:55], a[216:219], a[104:107]
    v_mfma_f32_16x16x32_bf16 a[108:111], a[52:55], a[220:223], a[108:111]
    s_add_u32 s62, s62, 0x20000
    v_mfma_f32_16x16x32_bf16 v[240:243], a[56:59], a[208:211], v[240:243]
    s_add_u32 s52, s47, 524288
    v_mfma_f32_16x16x32_bf16 v[244:247], a[56:59], a[212:215], v[244:247]
    buffer_store_dwordx4 v[140:143], v1, s[48:51], s52 offen offset:3072 sc1
    v_mfma_f32_16x16x32_bf16 a[112:115], a[56:59], a[216:219], a[112:115]
    v_mfma_f32_16x16x32_bf16 a[116:119], a[56:59], a[220:223], a[116:119]
    v_mfma_f32_16x16x32_bf16 v[248:251], a[60:63], a[208:211], v[248:251]
    s_cmp_eq_u32 s45, 0
    s_cbranch_scc1 k12_ool_56
k12_oolret_57:
    v_mfma_f32_16x16x32_bf16 v[252:255], a[60:63], a[212:215], v[252:255]
    v_mfma_f32_16x16x32_bf16 a[120:123], a[60:63], a[216:219], a[120:123]
    v_mfma_f32_16x16x32_bf16 a[124:127], a[60:63], a[220:223], a[124:127]
    s_waitcnt vmcnt(15) lgkmcnt(0)
    v_mfma_f32_16x16x32_bf16 v[192:195], a[0:3], a[224:227], v[192:195]
    ds_read_b64_tr_b16 a[32:33], v42 offset:24576
    ds_read_b64_tr_b16 a[34:35], v42 offset:25600
    v_mfma_f32_16x16x32_bf16 v[196:199], a[0:3], a[228:231], v[196:199]
    buffer_load_dwordx4 a[144:147], v36, s[8:11], s62 offen sc1
    v_mfma_f32_16x16x32_bf16 a[64:67], a[0:3], a[232:235], a[64:67]
    ds_read_b64_tr_b16 a[36:37], v43 offset:24576
    v_mfma_f32_16x16x32_bf16 a[68:71], a[0:3], a[236:239], a[68:71]
    ds_read_b64_tr_b16 a[38:39], v43 offset:25600
    v_mfma_f32_16x16x32_bf16 v[200:203], a[4:7], a[224:227], v[200:203]
    ds_read_b64_tr_b16 a[40:41], v44 offset:24576
    v_mfma_f32_16x16x32_bf16 v[204:207], a[4:7], a[228:231], v[204:207]
    v_mfma_f32_16x16x32_bf16 a[72:75], a[4:7], a[232:235], a[72:75]
    buffer_load_dwordx4 a[148:151], v54, s[8:11], s62 offen sc1
    ds_read_b64_tr_b16 a[42:43], v44 offset:25600
    v_mfma_f32_16x16x32_bf16 a[76:79], a[4:7], a[236:239], a[76:79]
    ds_read_b64_tr_b16 a[44:45], v45 offset:24576
    v_mfma_f32_16x16x32_bf16 v[208:211], a[8:11], a[224:227], v[208:211]
    v_mfma_f32_16x16x32_bf16 v[212:215], a[8:11], a[228:231], v[212:215]
    ds_read_b64_tr_b16 a[46:47], v45 offset:25600
    v_mfma_f32_16x16x32_bf16 a[80:83], a[8:11], a[232:235], a[80:83]
    ds_read_b64_tr_b16 a[48:49], v46 offset:24576
    v_mfma_f32_16x16x32_bf16 a[84:87], a[8:11], a[236:239], a[84:87]
    buffer_load_dwordx4 a[152:155], v37, s[8:11], s62 offen sc1
    ds_read_b64_tr_b16 a[50:51], v46 offset:25600
    v_mfma_f32_16x16x32_bf16 v[216:219], a[12:15], a[224:227], v[216:219]
    v_mfma_f32_16x16x32_bf16 v[220:223], a[12:15], a[228:231], v[220:223]
    ds_read_b64_tr_b16 a[52:53], v47 offset:24576
    v_mfma_f32_16x16x32_bf16 a[88:91], a[12:15], a[232:235], a[88:91]
    ds_read_b64_tr_b16 a[54:55], v47 offset:25600
    v_mfma_f32_16x16x32_bf16 a[92:95], a[12:15], a[236:239], a[92:95]
    ds_read_b64_tr_b16 a[56:57], v48 offset:24576
    v_mfma_f32_16x16x32_bf16 v[224:227], a[16:19], a[224:227], v[224:227]
    v_mfma_f32_16x16x32_bf16 v[228:231], a[16:19], a[228:231], v[228:231]
    buffer_load_dwordx4 a[156:159], v55, s[8:11], s62 offen sc1
    ds_read_b64_tr_b16 a[58:59], v48 offset:25600
    v_mfma_f32_16x16x32_bf16 a[96:99], a[16:19], a[232:235], a[96:99]
    ds_read_b64_tr_b16 a[60:61], v49 offset:24576
    v_mfma_f32_16x16x32_bf16 a[100:103], a[16:19], a[236:239], a[100:103]
    v_mfma_f32_16x16x32_bf16 v[232:235], a[20:23], a[224:227], v[232:235]
    ds_read_b64_tr_b16 a[62:63], v49 offset:25600
    v_mfma_f32_16x16x32_bf16 v[236:239], a[20:23], a[228:231], v[236:239]
    s_add_u32 s62, s62, 0x20000
    v_mfma_f32_16x16x32_bf16 a[104:107], a[20:23], a[232:235], a[104:107]
    s_add_u32 s52, s47, 528384
    v_mfma_f32_16x16x32_bf16 a[108:111], a[20:23], a[236:239], a[108:111]
    buffer_store_dwordx4 v[144:147], v1, s[48:51], s52 offen offset:0 sc1
    v_mfma_f32_16x16x32_bf16 v[240:243], a[24:27], a[224:227], v[240:243]
    v_mfma_f32_16x16x32_bf16 v[244:247], a[24:27], a[228:231], v[244:247]
    v_mfma_f32_16x16x32_bf16 a[112:115], a[24:27], a[232:235], a[112:115]
    v_mfma_f32_16x16x32_bf16 a[116:119], a[24:27], a[236:239], a[116:119]
    v_mfma_f32_16x16x32_bf16 v[248:251], a[28:31], a[224:227], v[248:251]
    v_mfma_f32_16x16x32_bf16 v[252:255], a[28:31], a[228:231], v[252:255]
    v_mfma_f32_16x16x32_bf16 a[120:123], a[28:31], a[232:235], a[120:123]
    v_mfma_f32_16x16x32_bf16 a[124:127], a[28:31], a[236:239], a[124:127]
    s_waitcnt vmcnt(10) lgkmcnt(0)
    s_barrier
    v_mfma_f32_16x16x32_bf16 v[192:195], a[32:35], a[240:243], v[192:195]
    ds_read_b64_tr_b16 a[0:1], v42 offset:32768
    ds_read_b64_tr_b16 a[2:3], v42 offset:33792
    v_mfma_f32_16x16x32_bf16 v[196:199], a[32:35], a[244:247], v[196:199]
    s_add_u32 m0, s60, 147456
    v_mfma_f32_16x16x32_bf16 a[64:67], a[32:35], a[248:251], a[64:67]
    buffer_load_dwordx4 v38, s[12:15], s61 offen offset:0 lds
    ds_read_b64_tr_b16 a[4:5], v43 offset:32768
    v_mfma_f32_16x16x32_bf16 a[68:71], a[32:35], a[252:255], a[68:71]
    ds_read_b64_tr_b16 a[6:7], v43 offset:33792
    v_mfma_f32_16x16x32_bf16 v[200:203], a[36:39], a[240:243], v[200:203]
    buffer_load_dwordx4 v39, s[12:15], s61 offen offset:1024 lds
    ds_read_b64_tr_b16 a[8:9], v44 offset:32768
    v_mfma_f32_16x16x32_bf16 v[204:207], a[36:39], a[244:247], v[204:207]
    v_mfma_f32_16x16x32_bf16 a[72:75], a[36:39], a[248:251], a[72:75]
    buffer_load_dwordx4 v40, s[12:15], s61 offen offset:2048 lds
    ds_read_b64_tr_b16 a[10:11], v44 offset:33792
    v_mfma_f32_16x16x32_bf16 a[76:79], a[36:39], a[252:255], a[76:79]
    ds_read_b64_tr_b16 a[12:13], v45 offset:32768
    v_mfma_f32_16x16x32_bf16 v[208:211], a[40:43], a[240:243], v[208:211]
    v_mfma_f32_16x16x32_bf16 v[212:215], a[40:43], a[244:247], v[212:215]
    buffer_load_dwordx4 v41, s[12:15], s61 offen offset:3072 lds
    ds_read_b64_tr_b16 a[14:15], v45 offset:33792
    v_mfma_f32_16x16x32_bf16 a[80:83], a[40:43], a[248:251], a[80:83]
    s_add_u32 s61, s61, 0x80000
    ds_read_b64_tr_b16 a[16:17], v46 offset:32768
    v_mfma_f32_16x16x32_bf16 a[84:87], a[40:43], a[252:255], a[84:87]
    buffer_load_dwordx4 a[160:163], v36, s[8:11], s62 offen sc1
    ds_read_b64_tr_b16 a[18:19], v46 offset:33792
    v_mfma_f32_16x16x32_bf16 v[216:219], a[44:47], a[240:243], v[216:219]
    v_mfma_f32_16x16x32_bf16 v[220:223], a[44:47], a[244:247], v[220:223]
    ds_read_b64_tr_b16 a[20:21], v47 offset:32768
    v_mfma_f32_16x16x32_bf16 a[88:91], a[44:47], a[248:251], a[88:91]
    buffer_load_dwordx4 a[164:167], v54, s[8:11], s62 offen sc1
    ds_read_b64_tr_b16 a[22:23], v47 offset:33792
    v_mfma_f32_16x16x32_bf16 a[92:95], a[44:47], a[252:255], a[92:95]
    ds_read_b64_tr_b16 a[24:25], v48 offset:32768
    v_mfma_f32_16x16x32_bf16 v[224:227], a[48:51], a[240:243], v[224:227]
    v_mfma_f32_16x16x32_bf16 v[228:231], a[48:51], a[244:247], v[228:231]
    buffer_load_dwordx4 a[168:171], v37, s[8:11], s62 offen sc1
    ds_read_b64_tr_b16 a[26:27], v48 offset:33792
    v_mfma_f32_16x16x32_bf16 a[96:99], a[48:51], a[248:251], a[96:99]
    ds_read_b64_tr_b16 a[28:29], v49 offset:32768
    v_mfma_f32_16x16x32_bf16 a[100:103], a[48:51], a[252:255], a[100:103]
    buffer_load_dwordx4 a[172:175], v55, s[8:11], s62 offen sc1
    v_mfma_f32_16x16x32_bf16 v[232:235], a[52:55], a[240:243], v[232:235]
    ds_read_b64_tr_b16 a[30:31], v49 offset:33792
    v_mfma_f32_16x16x32_bf16 v[236:239], a[52:55], a[244:247], v[236:239]
    s_add_u32 s62, s62, 0x20000
    v_mfma_f32_16x16x32_bf16 a[104:107], a[52:55], a[248:251], a[104:107]
    s_add_u32 s52, s47, 528384
    v_mfma_f32_16x16x32_bf16 a[108:111], a[52:55], a[252:255], a[108:111]
    buffer_store_dwordx4 v[148:151], v1, s[48:51], s52 offen offset:1024 sc1
    v_mfma_f32_16x16x32_bf16 v[240:243], a[56:59], a[240:243], v[240:243]
    s_add_u32 s52, s47, 528384
    v_mfma_f32_16x16x32_bf16 v[244:247], a[56:59], a[244:247], v[244:247]
    buffer_store_dwordx4 v[152:155], v1, s[48:51], s52 offen offset:2048 sc1
    v_mfma_f32_16x16x32_bf16 a[112:115], a[56:59], a[248:251], a[112:115]
    v_mfma_f32_16x16x32_bf16 a[116:119], a[56:59], a[252:255], a[116:119]
    v_mfma_f32_16x16x32_bf16 v[248:251], a[60:63], a[240:243], v[248:251]
    s_cmp_eq_u32 s45, 0
    s_cbranch_scc1 k12_ool_58
k12_oolret_59:
    v_mfma_f32_16x16x32_bf16 v[252:255], a[60:63], a[244:247], v[252:255]
    v_mfma_f32_16x16x32_bf16 a[120:123], a[60:63], a[248:251], a[120:123]
    v_mfma_f32_16x16x32_bf16 a[124:127], a[60:63], a[252:255], a[124:127]
    s_waitcnt vmcnt(16) lgkmcnt(0)
    v_mfma_f32_16x16x32_bf16 v[192:195], a[0:3], a[128:131], v[192:195]
    ds_read_b64_tr_b16 a[32:33], v42 offset:40960
    ds_read_b64_tr_b16 a[34:35], v42 offset:41984
    v_mfma_f32_16x16x32_bf16 v[196:199], a[0:3], a[132:135], v[196:199]
    buffer_load_dwordx4 a[176:179], v36, s[8:11], s62 offen sc1
    v_mfma_f32_16x16x32_bf16 a[64:67], a[0:3], a[136:139], a[64:67]
    ds_read_b64_tr_b16 a[36:37], v43 offset:40960
    v_mfma_f32_16x16x32_bf16 a[68:71], a[0:3], a[140:143], a[68:71]
    ds_read_b64_tr_b16 a[38:39], v43 offset:41984
    v_mfma_f32_16x16x32_bf16 v[200:203], a[4:7], a[128:131], v[200:203]
    ds_read_b64_tr_b16 a[40:41], v44 offset:40960
    v_mfma_f32_16x16x32_bf16 v[204:207], a[4:7], a[132:135], v[204:207]
    v_mfma_f32_16x16x32_bf16 a[72:75], a[4:7], a[136:139], a[72:75]
    buffer_load_dwordx4 a[180:183], v54, s[8:11], s62 offen sc1
    ds_read_b64_tr_b16 a[42:43], v44 offset:41984
    v_mfma_f32_16x16x32_bf16 a[76:79], a[4:7], a[140:143], a[76:79]
    ds_read_b64_tr_b16 a[44:45], v45 offset:40960
    v_mfma_f32_16x16x32_bf16 v[208:211], a[8:11], a[128:131], v[208:211]
    v_mfma_f32_16x16x32_bf16 v[212:215], a[8:11], a[132:135], v[212:215]
    ds_read_b64_tr_b16 a[46:47], v45 offset:41984
    v_mfma_f32_16x16x32_bf16 a[80:83], a[8:11], a[136:139], a[80:83]
    ds_read_b64_tr_b16 a[48:49], v46 offset:40960
    v_mfma_f32_16x16x32_bf16 a[84:87], a[8:11], a[140:143], a[84:87]
    buffer_load_dwordx4 a[184:187], v37, s[8:11], s62 offen sc1
    ds_read_b64_tr_b16 a[50:51], v46 offset:41984
    v_mfma_f32_16x16x32_bf16 v[216:219], a[12:15], a[128:131], v[216:219]
    v_mfma_f32_16x16x32_bf16 v[220:223], a[12:15], a[132:135], v[220:223]
    ds_read_b64_tr_b16 a[52:53], v47 offset:40960
    v_mfma_f32_16x16x32_bf16 a[88:91], a[12:15], a[136:139], a[88:91]
    ds_read_b64_tr_b16 a[54:55], v47 offset:41984
    v_mfma_f32_16x16x32_bf16 a[92:95], a[12:15], a[140:143], a[92:95]
    ds_read_b64_tr_b16 a[56:57], v48 offset:40960
    v_mfma_f32_16x16x32_bf16 v[224:227], a[16:19], a[128:131], v[224:227]
    v_mfma_f32_16x16x32_bf16 v[228:231], a[16:19], a[132:135], v[228:231]
    buffer_load_dwordx4 a[188:191], v55, s[8:11], s62 offen sc1
    ds_read_b64_tr_b16 a[58:59], v48 offset:41984
    v_mfma_f32_16x16x32_bf16 a[96:99], a[16:19], a[136:139], a[96:99]
    ds_read_b64_tr_b16 a[60:61], v49 offset:40960
    v_mfma_f32_16x16x32_bf16 a[100:103], a[16:19], a[140:143], a[100:103]
    v_mfma_f32_16x16x32_bf16 v[232:235], a[20:23], a[128:131], v[232:235]
    ds_read_b64_tr_b16 a[62:63], v49 offset:41984
    v_mfma_f32_16x16x32_bf16 v[236:239], a[20:23], a[132:135], v[236:239]
    s_add_u32 s62, s62, 0x20000
    v_mfma_f32_16x16x32_bf16 a[104:107], a[20:23], a[136:139], a[104:107]
    s_add_u32 s52, s47, 528384
    v_mfma_f32_16x16x32_bf16 a[108:111], a[20:23], a[140:143], a[108:111]
    buffer_store_dwordx4 v[156:159], v1, s[48:51], s52 offen offset:3072 sc1
    v_mfma_f32_16x16x32_bf16 v[240:243], a[24:27], a[128:131], v[240:243]
    v_mfma_f32_16x16x32_bf16 v[244:247], a[24:27], a[132:135], v[244:247]
    v_mfma_f32_16x16x32_bf16 a[112:115], a[24:27], a[136:139], a[112:115]
    v_mfma_f32_16x16x32_bf16 a[116:119], a[24:27], a[140:143], a[116:119]
    v_mfma_f32_16x16x32_bf16 v[248:251], a[28:31], a[128:131], v[248:251]
    v_mfma_f32_16x16x32_bf16 v[252:255], a[28:31], a[132:135], v[252:255]
    v_mfma_f32_16x16x32_bf16 a[120:123], a[28:31], a[136:139], a[120:123]
    v_mfma_f32_16x16x32_bf16 a[124:127], a[28:31], a[140:143], a[124:127]
    s_waitcnt vmcnt(11) lgkmcnt(0)
    s_barrier
    v_mfma_f32_16x16x32_bf16 v[192:195], a[32:35], a[144:147], v[192:195]
    ds_read_b64_tr_b16 a[0:1], v42 offset:49152
    ds_read_b64_tr_b16 a[2:3], v42 offset:50176
    v_mfma_f32_16x16x32_bf16 v[196:199], a[32:35], a[148:151], v[196:199]
    s_add_u32 m0, s60, 98304
    v_mfma_f32_16x16x32_bf16 a[64:67], a[32:35], a[152:155], a[64:67]
    buffer_load_dwordx4 v38, s[12:15], s61 offen offset:0 lds
    ds_read_b64_tr_b16 a[4:5], v43 offset:49152
    v_mfma_f32_16x16x32_bf16 a[68:71], a[32:35], a[156:159], a[68:71]
    ds_read_b64_tr_b16 a[6:7], v43 offset:50176
    v_mfma_f32_16x16x32_bf16 v[200:203], a[36:39], a[144:147], v[200:203]
    buffer_load_dwordx4 v39, s[12:15], s61 offen offset:1024 lds
    ds_read_b64_tr_b16 a[8:9], v44 offset:49152
    v_mfma_f32_16x16x32_bf16 v[204:207], a[36:39], a[148:151], v[204:207]
    v_mfma_f32_16x16x32_bf16 a[72:75], a[36:39], a[152:155], a[72:75]
    ds_read_b64_tr_b16 a[10:11], v44 offset:50176
    v_mfma_f32_16x16x32_bf16 a[76:79], a[36:39], a[156:159], a[76:79]
    buffer_load_dwordx4 v40, s[12:15], s61 offen offset:2048 lds
    ds_read_b64_tr_b16 a[12:13], v45 offset:49152
    v_mfma_f32_16x16x32_bf16 v[208:211], a[40:43], a[144:147], v[208:211]
    v_mfma_f32_16x16x32_bf16 v[212:215], a[40:43], a[148:151], v[212:215]
    ds_read_b64_tr_b16 a[14:15], v45 offset:50176
    v_mfma_f32_16x16x32_bf16 a[80:83], a[40:43], a[152:155], a[80:83]
    buffer_load_dwordx4 v41, s[12:15], s61 offen offset:3072 lds
    ds_read_b64_tr_b16 a[16:17], v46 offset:49152
    v_mfma_f32_16x16x32_bf16 a[84:87], a[40:43], a[156:159], a[84:87]
    ds_read_b64_tr_b16 a[18:19], v46 offset:50176
    v_mfma_f32_16x16x32_bf16 v[216:219], a[44:47], a[144:147], v[216:219]
    s_add_u32 s61, s61, 0x80000
    v_mfma_f32_16x16x32_bf16 v[220:223], a[44:47], a[148:151], v[220:223]
    buffer_load_dwordx4 a[192:195], v36, s[8:11], s62 offen sc1
    ds_read_b64_tr_b16 a[20:21], v47 offset:49152
    v_mfma_f32_16x16x32_bf16 a[88:91], a[44:47], a[152:155], a[88:91]
    ds_read_b64_tr_b16 a[22:23], v47 offset:50176
    v_mfma_f32_16x16x32_bf16 a[92:95], a[44:47], a[156:159], a[92:95]
    buffer_load_dwordx4 a[196:199], v54, s[8:11], s62 offen sc1
    ds_read_b64_tr_b16 a[24:25], v48 offset:49152
    v_mfma_f32_16x16x32_bf16 v[224:227], a[48:51], a[144:147], v[224:227]
    v_mfma_f32_16x16x32_bf16 v[228:231], a[48:51], a[148:151], v[228:231]
    ds_read_b64_tr_b16 a[26:27], v48 offset:50176
    v_mfma_f32_16x16x32_bf16 a[96:99], a[48:51], a[152:155], a[96:99]
    buffer_load_dwordx4 a[200:203], v37, s[8:11], s62 offen sc1
    ds_read_b64_tr_b16 a[28:29], v49 offset:49152
    v_mfma_f32_16x16x32_bf16 a[100:103], a[48:51], a[156:159], a[100:103]
    v_mfma_f32_16x16x32_bf16 v[232:235], a[52:55], a[144:147], v[232:235]
    ds_read_b64_tr_b16 a[30:31], v49 offset:50176
    v_mfma_f32_16x16x32_bf16 v[236:239], a[52:55], a[148:151], v[236:239]
    buffer_load_dwordx4 a[204:207], v55, s[8:11], s62 offen sc1
    v_mfma_f32_16x16x32_bf16 a[104:107], a[52:55], a[152:155], a[104:107]
    v_mfma_f32_16x16x32_bf16 a[108:111], a[52:55], a[156:159], a[108:111]
    s_add_u32 s62, s62, 0x20000
    v_mfma_f32_16x16x32_bf16 v[240:243], a[56:59], a[144:147], v[240:243]
    s_add_u32 s52, s47, 532480
    v_mfma_f32_16x16x32_bf16 v[244:247], a[56:59], a[148:151], v[244:247]
    buffer_store_dwordx4 v[160:163], v1, s[48:51], s52 offen offset:0 sc1
    v_mfma_f32_16x16x32_bf16 a[112:115], a[56:59], a[152:155], a[112:115]
    v_mfma_f32_16x16x32_bf16 a[116:119], a[56:59], a[156:159], a[116:119]
    v_mfma_f32_16x16x32_bf16 v[248:251], a[60:63], a[144:147], v[248:251]
    v_mfma_f32_16x16x32_bf16 v[252:255], a[60:63], a[148:151], v[252:255]
    v_mfma_f32_16x16x32_bf16 a[120:123], a[60:63], a[152:155], a[120:123]
    v_mfma_f32_16x16x32_bf16 a[124:127], a[60:63], a[156:159], a[124:127]
    s_waitcnt vmcnt(16) lgkmcnt(0)
    v_mfma_f32_16x16x32_bf16 v[192:195], a[0:3], a[160:163], v[192:195]
    ds_read_b64_tr_b16 a[32:33], v42 offset:57344
    ds_read_b64_tr_b16 a[34:35], v42 offset:58368
    v_mfma_f32_16x16x32_bf16 v[196:199], a[0:3], a[164:167], v[196:199]
    buffer_load_dwordx4 a[208:211], v36, s[8:11], s62 offen sc1
    v_mfma_f32_16x16x32_bf16 a[64:67], a[0:3], a[168:171], a[64:67]
    ds_read_b64_tr_b16 a[36:37], v43 offset:57344
    v_mfma_f32_16x16x32_bf16 a[68:71], a[0:3], a[172:175], a[68:71]
    ds_read_b64_tr_b16 a[38:39], v43 offset:58368
    v_mfma_f32_16x16x32_bf16 v[200:203], a[4:7], a[160:163], v[200:203]
    ds_read_b64_tr_b16 a[40:41], v44 offset:57344
    v_mfma_f32_16x16x32_bf16 v[204:207], a[4:7], a[164:167], v[204:207]
    v_mfma_f32_16x16x32_bf16 a[72:75], a[4:7], a[168:171], a[72:75]
    buffer_load_dwordx4 a[212:215], v54, s[8:11], s62 offen sc1
    ds_read_b64_tr_b16 a[42:43], v44 offset:58368
    v_mfma_f32_16x16x32_bf16 a[76:79], a[4:7], a[172:175], a[76:79]
    ds_read_b64_tr_b16 a[44:45], v45 offset:57344
    v_mfma_f32_16x16x32_bf16 v[208:211], a[8:11], a[160:163], v[208:211]
    v_mfma_f32_16x16x32_bf16 v[212:215], a[8:11], a[164:167], v[212:215]
    ds_read_b64_tr_b16 a[46:47], v45 offset:58368
    v_mfma_f32_16x16x32_bf16 a[80:83], a[8:11], a[168:171], a[80:83]
    ds_read_b64_tr_b16 a[48:49], v46 offset:57344
    v_mfma_f32_16x16x32_bf16 a[84:87], a[8:11], a[172:175], a[84:87]
    buffer_load_dwordx4 a[216:219], v37, s[8:11], s62 offen sc1
    ds_read_b64_tr_b16 a[50:51], v46 offset:58368
    v_mfma_f32_16x16x32_bf16 v[216:219], a[12:15], a[160:163], v[216:219]
    v_mfma_f32_16x16x32_bf16 v[220:223], a[12:15], a[164:167], v[220:223]
    ds_read_b64_tr_b16 a[52:53], v47 offset:57344
    v_mfma_f32_16x16x32_bf16 a[88:91], a[12:15], a[168:171], a[88:91]
    ds_read_b64_tr_b16 a[54:55], v47 offset:58368
    v_mfma_f32_16x16x32_bf16 a[92:95], a[12:15], a[172:175], a[92:95]
    ds_read_b64_tr_b16 a[56:57], v48 offset:57344
    v_mfma_f32_16x16x32_bf16 v[224:227], a[16:19], a[160:163], v[224:227]
    v_mfma_f32_16x16x32_bf16 v[228:231], a[16:19], a[164:167], v[228:231]
    buffer_load_dwordx4 a[220:223], v55, s[8:11], s62 offen sc1
    ds_read_b64_tr_b16 a[58:59], v48 offset:58368
    v_mfma_f32_16x16x32_bf16 a[96:99], a[16:19], a[168:171], a[96:99]
    ds_read_b64_tr_b16 a[60:61], v49 offset:57344
    v_mfma_f32_16x16x32_bf16 a[100:103], a[16:19], a[172:175], a[100:103]
    v_mfma_f32_16x16x32_bf16 v[232:235], a[20:23], a[160:163], v[232:235]
    ds_read_b64_tr_b16 a[62:63], v49 offset:58368
    v_mfma_f32_16x16x32_bf16 v[236:239], a[20:23], a[164:167], v[236:239]
    s_add_u32 s62, s62, 0x20000
    v_mfma_f32_16x16x32_bf16 a[104:107], a[20:23], a[168:171], a[104:107]
    s_add_u32 s52, s47, 532480
    v_mfma_f32_16x16x32_bf16 a[108:111], a[20:23], a[172:175], a[108:111]
    buffer_store_dwordx4 v[164:167], v1, s[48:51], s52 offen offset:1024 sc1
    v_mfma_f32_16x16x32_bf16 v[240:243], a[24:27], a[160:163], v[240:243]
    v_mfma_f32_16x16x32_bf16 v[244:247], a[24:27], a[164:167], v[244:247]
    v_mfma_f32_16x16x32_bf16 a[112:115], a[24:27], a[168:171], a[112:115]
    v_mfma_f32_16x16x32_bf16 a[116:119], a[24:27], a[172:175], a[116:119]
    v_mfma_f32_16x16x32_bf16 v[248:251], a[28:31], a[160:163], v[248:251]
    v_mfma_f32_16x16x32_bf16 v[252:255], a[28:31], a[164:167], v[252:255]
    v_mfma_f32_16x16x32_bf16 a[120:123], a[28:31], a[168:171], a[120:123]
    v_mfma_f32_16x16x32_bf16 a[124:127], a[28:31], a[172:175], a[124:127]
    s_waitcnt vmcnt(10) lgkmcnt(0)
    s_barrier
    v_mfma_f32_16x16x32_bf16 v[192:195], a[32:35], a[176:179], v[192:195]
    ds_read_b64_tr_b16 a[0:1], v42 offset:0
    ds_read_b64_tr_b16 a[2:3], v42 offset:1024
    v_mfma_f32_16x16x32_bf16 v[196:199], a[32:35], a[180:183], v[196:199]
    s_cmp_eq_u32 s56, 0
    s_cbranch_scc1 k12_ool_60
k12_oolret_61:
    v_mfma_f32_16x16x32_bf16 a[64:67], a[32:35], a[184:187], a[64:67]
    s_add_u32 m0, s60, 114688
    ds_read_b64_tr_b16 a[4:5], v43 offset:0
    v_mfma_f32_16x16x32_bf16 a[68:71], a[32:35], a[188:191], a[68:71]
    buffer_load_dwordx4 v38, s[12:15], s61 offen offset:0 lds
    ds_read_b64_tr_b16 a[6:7], v43 offset:1024
    v_mfma_f32_16x16x32_bf16 v[200:203], a[36:39], a[176:179], v[200:203]
    buffer_load_dwordx4 v39, s[12:15], s61 offen offset:1024 lds
    ds_read_b64_tr_b16 a[8:9], v44 offset:0
    v_mfma_f32_16x16x32_bf16 v[204:207], a[36:39], a[180:183], v[204:207]
    v_mfma_f32_16x16x32_bf16 a[72:75], a[36:39], a[184:187], a[72:75]
    ds_read_b64_tr_b16 a[10:11], v44 offset:1024
    v_mfma_f32_16x16x32_bf16 a[76:79], a[36:39], a[188:191], a[76:79]
    buffer_load_dwordx4 v40, s[12:15], s61 offen offset:2048 lds
    ds_read_b64_tr_b16 a[12:13], v45 offset:0
    v_mfma_f32_16x16x32_bf16 v[208:211], a[40:43], a[176:179], v[208:211]
    s_mov_b32 s32, s60
    v_mfma_f32_16x16x32_bf16 v[212:215], a[40:43], a[180:183], v[212:215]
    ds_read_b64_tr_b16 a[14:15], v45 offset:1024
    v_mfma_f32_16x16x32_bf16 a[80:83], a[40:43], a[184:187], a[80:83]
    s_mov_b32 s34, s60
    buffer_load_dwordx4 v41, s[12:15], s61 offen offset:3072 lds
    ds_read_b64_tr_b16 a[16:17], v46 offset:0
    v_mfma_f32_16x16x32_bf16 a[84:87], a[40:43], a[188:191], a[84:87]
    ds_read_b64_tr_b16 a[18:19], v46 offset:1024
    v_mfma_f32_16x16x32_bf16 v[216:219], a[44:47], a[176:179], v[216:219]
    s_add_u32 s61, s61, 0x80000
    v_mfma_f32_16x16x32_bf16 v[220:223], a[44:47], a[180:183], v[220:223]
    s_mov_b32 s33, s60
    buffer_load_dwordx4 a[224:227], v36, s[8:11], s62 offen sc1
    ds_read_b64_tr_b16 a[20:21], v47 offset:0
    v_mfma_f32_16x16x32_bf16 a[88:91], a[44:47], a[184:187], a[88:91]
    ds_read_b64_tr_b16 a[22:23], v47 offset:1024
    v_mfma_f32_16x16x32_bf16 a[92:95], a[44:47], a[188:191], a[92:95]
    buffer_load_dwordx4 a[228:231], v54, s[8:11], s62 offen sc1
    ds_read_b64_tr_b16 a[24:25], v48 offset:0
    v_mfma_f32_16x16x32_bf16 v[224:227], a[48:51], a[176:179], v[224:227]
    s_add_u32 s35, s60, 0x10000
    v_mfma_f32_16x16x32_bf16 v[228:231], a[48:51], a[180:183], v[228:231]
    ds_read_b64_tr_b16 a[26:27], v48 offset:1024
    v_mfma_f32_16x16x32_bf16 a[96:99], a[48:51], a[184:187], a[96:99]
    buffer_load_dwordx4 a[232:235], v37, s[8:11], s62 offen sc1
    ds_read_b64_tr_b16 a[28:29], v49 offset:0
    v_mfma_f32_16x16x32_bf16 a[100:103], a[48:51], a[188:191], a[100:103]
    v_mfma_f32_16x16x32_bf16 v[232:235], a[52:55], a[176:179], v[232:235]
    ds_read_b64_tr_b16 a[30:31], v49 offset:1024
    v_mfma_f32_16x16x32_bf16 v[236:239], a[52:55], a[180:183], v[236:239]
    buffer_load_dwordx4 a[236:239], v55, s[8:11], s62 offen sc1
    v_mfma_f32_16x16x32_bf16 a[104:107], a[52:55], a[184:187], a[104:107]
    v_mfma_f32_16x16x32_bf16 a[108:111], a[52:55], a[188:191], a[108:111]
    s_add_u32 s62, s62, 0x20000
    v_mfma_f32_16x16x32_bf16 v[240:243], a[56:59], a[176:179], v[240:243]
    s_add_u32 s52, s47, 532480
    v_mfma_f32_16x16x32_bf16 v[244:247], a[56:59], a[180:183], v[244:247]
    buffer_store_dwordx4 v[168:171], v1, s[48:51], s52 offen offset:2048 sc1
    v_mfma_f32_16x16x32_bf16 a[112:115], a[56:59], a[184:187], a[112:115]
    v_mfma_f32_16x16x32_bf16 a[116:119], a[56:59], a[188:191], a[116:119]
    v_mfma_f32_16x16x32_bf16 v[248:251], a[60:63], a[176:179], v[248:251]
    v_mfma_f32_16x16x32_bf16 v[252:255], a[60:63], a[180:183], v[252:255]
    v_mfma_f32_16x16x32_bf16 a[120:123], a[60:63], a[184:187], a[120:123]
    v_mfma_f32_16x16x32_bf16 a[124:127], a[60:63], a[188:191], a[124:127]
    s_waitcnt vmcnt(15) lgkmcnt(0)
    v_mfma_f32_16x16x32_bf16 v[192:195], a[0:3], a[192:195], v[192:195]
    ds_read_b64_tr_b16 a[32:33], v42 offset:8192
    ds_read_b64_tr_b16 a[34:35], v42 offset:9216
    v_mfma_f32_16x16x32_bf16 v[196:199], a[0:3], a[196:199], v[196:199]
    buffer_load_dwordx4 a[240:243], v36, s[8:11], s62 offen sc1
    v_mfma_f32_16x16x32_bf16 a[64:67], a[0:3], a[200:203], a[64:67]
    ds_read_b64_tr_b16 a[36:37], v43 offset:8192
    v_mfma_f32_16x16x32_bf16 a[68:71], a[0:3], a[204:207], a[68:71]
    ds_read_b64_tr_b16 a[38:39], v43 offset:9216
    v_mfma_f32_16x16x32_bf16 v[200:203], a[4:7], a[192:195], v[200:203]
    ds_read_b64_tr_b16 a[40:41], v44 offset:8192
    v_mfma_f32_16x16x32_bf16 v[204:207], a[4:7], a[196:199], v[204:207]
    v_mfma_f32_16x16x32_bf16 a[72:75], a[4:7], a[200:203], a[72:75]
    buffer_load_dwordx4 a[244:247], v54, s[8:11], s62 offen sc1
    ds_read_b64_tr_b16 a[42:43], v44 offset:9216
    v_mfma_f32_16x16x32_bf16 a[76:79], a[4:7], a[204:207], a[76:79]
    ds_read_b64_tr_b16 a[44:45], v45 offset:8192
    v_mfma_f32_16x16x32_bf16 v[208:211], a[8:11], a[192:195], v[208:211]
    v_mfma_f32_16x16x32_bf16 v[212:215], a[8:11], a[196:199], v[212:215]
    ds_read_b64_tr_b16 a[46:47], v45 offset:9216
    v_mfma_f32_16x16x32_bf16 a[80:83], a[8:11], a[200:203], a[80:83]
    ds_read_b64_tr_b16 a[48:49], v46 offset:8192
    v_mfma_f32_16x16x32_bf16 a[84:87], a[8:11], a[204:207], a[84:87]
    buffer_load_dwordx4 a[248:251], v37, s[8:11], s62 offen sc1
    ds_read_b64_tr_b16 a[50:51], v46 offset:9216
    v_mfma_f32_16x16x32_bf16 v[216:219], a[12:15], a[192:195], v[216:219]
    v_mfma_f32_16x16x32_bf16 v[220:223], a[12:15], a[196:199], v[220:223]
    ds_read_b64_tr_b16 a[52:53], v47 offset:8192
    v_mfma_f32_16x16x32_bf16 a[88:91], a[12:15], a[200:203], a[88:91]
    ds_read_b64_tr_b16 a[54:55], v47 offset:9216
    v_mfma_f32_16x16x32_bf16 a[92:95], a[12:15], a[204:207], a[92:95]
    ds_read_b64_tr_b16 a[56:57], v48 offset:8192
    v_mfma_f32_16x16x32_bf16 v[224:227], a[16:19], a[192:195], v[224:227]
    v_mfma_f32_16x16x32_bf16 v[228:231], a[16:19], a[196:199], v[228:231]
    buffer_load_dwordx4 a[252:255], v55, s[8:11], s62 offen sc1
    ds_read_b64_tr_b16 a[58:59], v48 offset:9216
    v_mfma_f32_16x16x32_bf16 a[96:99], a[16:19], a[200:203], a[96:99]
    ds_read_b64_tr_b16 a[60:61], v49 offset:8192
    v_mfma_f32_16x16x32_bf16 a[100:103], a[16:19], a[204:207], a[100:103]
    v_mfma_f32_16x16x32_bf16 v[232:235], a[20:23], a[192:195], v[232:235]
    ds_read_b64_tr_b16 a[62:63], v49 offset:9216
    v_mfma_f32_16x16x32_bf16 v[236:239], a[20:23], a[196:199], v[236:239]
    s_add_u32 s62, s62, 0x20000
    v_mfma_f32_16x16x32_bf16 a[104:107], a[20:23], a[200:203], a[104:107]
    s_add_u32 s52, s47, 532480
    v_mfma_f32_16x16x32_bf16 a[108:111], a[20:23], a[204:207], a[108:111]
    buffer_store_dwordx4 v[172:175], v1, s[48:51], s52 offen offset:3072 sc1
    v_mfma_f32_16x16x32_bf16 v[240:243], a[24:27], a[192:195], v[240:243]
    v_mfma_f32_16x16x32_bf16 v[244:247], a[24:27], a[196:199], v[244:247]
    v_mfma_f32_16x16x32_bf16 a[112:115], a[24:27], a[200:203], a[112:115]
    v_mfma_f32_16x16x32_bf16 a[116:119], a[24:27], a[204:207], a[116:119]
    v_mfma_f32_16x16x32_bf16 v[248:251], a[28:31], a[192:195], v[248:251]
    v_add_co_u32 v2, vcc, 0x4000, v2
    s_nop 1
    v_addc_co_u32 v3, vcc, 0, v3, vcc
    global_load_dword v51, v[2:3], off
    v_mfma_f32_16x16x32_bf16 v[252:255], a[28:31], a[196:199], v[252:255]
    v_mfma_f32_16x16x32_bf16 a[120:123], a[28:31], a[200:203], a[120:123]
    v_mfma_f32_16x16x32_bf16 a[124:127], a[28:31], a[204:207], a[124:127]
    s_waitcnt vmcnt(10) lgkmcnt(0)
    s_barrier
    v_mfma_f32_16x16x32_bf16 v[192:195], a[32:35], a[208:211], v[192:195]
    ds_read_b64_tr_b16 a[0:1], v42 offset:16384
    ds_read_b64_tr_b16 a[2:3], v42 offset:17408
    v_mfma_f32_16x16x32_bf16 v[196:199], a[32:35], a[212:215], v[196:199]
    s_add_u32 m0, s60, 131072
    v_mfma_f32_16x16x32_bf16 a[64:67], a[32:35], a[216:219], a[64:67]
    buffer_load_dwordx4 v38, s[12:15], s61 offen offset:0 lds
    ds_read_b64_tr_b16 a[4:5], v43 offset:16384
    v_mfma_f32_16x16x32_bf16 a[68:71], a[32:35], a[220:223], a[68:71]
    ds_read_b64_tr_b16 a[6:7], v43 offset:17408
    v_mfma_f32_16x16x32_bf16 v[200:203], a[36:39], a[208:211], v[200:203]
    buffer_load_dwordx4 v39, s[12:15], s61 offen offset:1024 lds
    ds_read_b64_tr_b16 a[8:9], v44 offset:16384
    v_mfma_f32_16x16x32_bf16 v[204:207], a[36:39], a[212:215], v[204:207]
    v_mfma_f32_16x16x32_bf16 a[72:75], a[36:39], a[216:219], a[72:75]
    ds_read_b64_tr_b16 a[10:11], v44 offset:17408
    v_mfma_f32_16x16x32_bf16 a[76:79], a[36:39], a[220:223], a[76:79]
    buffer_load_dwordx4 v40, s[12:15], s61 offen offset:2048 lds
    ds_read_b64_tr_b16 a[12:13], v45 offset:16384
    v_mfma_f32_16x16x32_bf16 v[208:211], a[40:43], a[208:211], v[208:211]
    v_mfma_f32_16x16x32_bf16 v[212:215], a[40:43], a[212:215], v[212:215]
    ds_read_b64_tr_b16 a[14:15], v45 offset:17408
    v_mfma_f32_16x16x32_bf16 a[80:83], a[40:43], a[216:219], a[80:83]
    buffer_load_dwordx4 v41, s[12:15], s61 offen offset:3072 lds
    ds_read_b64_tr_b16 a[16:17], v46 offset:16384
    v_mfma_f32_16x16x32_bf16 a[84:87], a[40:43], a[220:223], a[84:87]
    ds_read_b64_tr_b16 a[18:19], v46 offset:17408
    v_mfma_f32_16x16x32_bf16 v[216:219], a[44:47], a[208:211], v[216:219]
    s_add_u32 s61, s61, 0x80000
    v_mfma_f32_16x16x32_bf16 v[220:223], a[44:47], a[212:215], v[220:223]
    buffer_load_dwordx4 a[128:131], v36, s[8:11], s62 offen sc1
    ds_read_b64_tr_b16 a[20:21], v47 offset:16384
    v_mfma_f32_16x16x32_bf16 a[88:91], a[44:47], a[216:219], a[88:91]
    ds_read_b64_tr_b16 a[22:23], v47 offset:17408
    v_mfma_f32_16x16x32_bf16 a[92:95], a[44:47], a[220:223], a[92:95]
    buffer_load_dwordx4 a[132:135], v54, s[8:11], s62 offen sc1
    ds_read_b64_tr_b16 a[24:25], v48 offset:16384
    v_mfma_f32_16x16x32_bf16 v[224:227], a[48:51], a[208:211], v[224:227]
    v_mfma_f32_16x16x32_bf16 v[228:231], a[48:51], a[212:215], v[228:231]
    ds_read_b64_tr_b16 a[26:27], v48 offset:17408
    v_mfma_f32_16x16x32_bf16 a[96:99], a[48:51], a[216:219], a[96:99]
    buffer_load_dwordx4 a[136:139], v37, s[8:11], s62 offen sc1
    ds_read_b64_tr_b16 a[28:29], v49 offset:16384
    v_mfma_f32_16x16x32_bf16 a[100:103], a[48:51], a[220:223], a[100:103]
    v_mfma_f32_16x16x32_bf16 v[232:235], a[52:55], a[208:211], v[232:235]
    ds_read_b64_tr_b16 a[30:31], v49 offset:17408
    v_mfma_f32_16x16x32_bf16 v[236:239], a[52:55], a[212:215], v[236:239]
    buffer_load_dwordx4 a[140:143], v55, s[8:11], s62 offen sc1
    v_mfma_f32_16x16x32_bf16 a[104:107], a[52:55], a[216:219], a[104:107]
    v_mfma_f32_16x16x32_bf16 a[108:111], a[52:55], a[220:223], a[108:111]
    s_add_u32 s62, s62, 0x20000
    v_mfma_f32_16x16x32_bf16 v[240:243], a[56:59], a[208:211], v[240:243]
    s_add_u32 s52, s47, 536576
    v_mfma_f32_16x16x32_bf16 v[244:247], a[56:59], a[212:215], v[244:247]
    buffer_store_dwordx4 v[176:179], v1, s[48:51], s52 offen offset:0 sc1
    v_mfma_f32_16x16x32_bf16 a[112:115], a[56:59], a[216:219], a[112:115]
    v_mfma_f32_16x16x32_bf16 a[116:119], a[56:59], a[220:223], a[116:119]
    v_mfma_f32_16x16x32_bf16 v[248:251], a[60:63], a[208:211], v[248:251]
    v_mfma_f32_16x16x32_bf16 v[252:255], a[60:63], a[212:215], v[252:255]
    v_mfma_f32_16x16x32_bf16 a[120:123], a[60:63], a[216:219], a[120:123]
    v_mfma_f32_16x16x32_bf16 a[124:127], a[60:63], a[220:223], a[124:127]
    s_waitcnt vmcnt(15) lgkmcnt(0)
    v_mfma_f32_16x16x32_bf16 v[192:195], a[0:3], a[224:227], v[192:195]
    ds_read_b64_tr_b16 a[32:33], v42 offset:24576
    ds_read_b64_tr_b16 a[34:35], v42 offset:25600
    v_mfma_f32_16x16x32_bf16 v[196:199], a[0:3], a[228:231], v[196:199]
    buffer_load_dwordx4 a[144:147], v36, s[8:11], s62 offen sc1
    v_mfma_f32_16x16x32_bf16 a[64:67], a[0:3], a[232:235], a[64:67]
    ds_read_b64_tr_b16 a[36:37], v43 offset:24576
    v_mfma_f32_16x16x32_bf16 a[68:71], a[0:3], a[236:239], a[68:71]
    ds_read_b64_tr_b16 a[38:39], v43 offset:25600
    v_mfma_f32_16x16x32_bf16 v[200:203], a[4:7], a[224:227], v[200:203]
    ds_read_b64_tr_b16 a[40:41], v44 offset:24576
    v_mfma_f32_16x16x32_bf16 v[204:207], a[4:7], a[228:231], v[204:207]
    v_mfma_f32_16x16x32_bf16 a[72:75], a[4:7], a[232:235], a[72:75]
    buffer_load_dwordx4 a[148:151], v54, s[8:11], s62 offen sc1
    ds_read_b64_tr_b16 a[42:43], v44 offset:25600
    v_mfma_f32_16x16x32_bf16 a[76:79], a[4:7], a[236:239], a[76:79]
    ds_read_b64_tr_b16 a[44:45], v45 offset:24576
    v_mfma_f32_16x16x32_bf16 v[208:211], a[8:11], a[224:227], v[208:211]
    v_mfma_f32_16x16x32_bf16 v[212:215], a[8:11], a[228:231], v[212:215]
    ds_read_b64_tr_b16 a[46:47], v45 offset:25600
    v_mfma_f32_16x16x32_bf16 a[80:83], a[8:11], a[232:235], a[80:83]
    ds_read_b64_tr_b16 a[48:49], v46 offset:24576
    v_mfma_f32_16x16x32_bf16 a[84:87], a[8:11], a[236:239], a[84:87]
    buffer_load_dwordx4 a[152:155], v37, s[8:11], s62 offen sc1
    ds_read_b64_tr_b16 a[50:51], v46 offset:25600
    v_mfma_f32_16x16x32_bf16 v[216:219], a[12:15], a[224:227], v[216:219]
    v_mfma_f32_16x16x32_bf16 v[220:223], a[12:15], a[228:231], v[220:223]
    ds_read_b64_tr_b16 a[52:53], v47 offset:24576
    v_mfma_f32_16x16x32_bf16 a[88:91], a[12:15], a[232:235], a[88:91]
    ds_read_b64_tr_b16 a[54:55], v47 offset:25600
    v_mfma_f32_16x16x32_bf16 a[92:95], a[12:15], a[236:239], a[92:95]
    ds_read_b64_tr_b16 a[56:57], v48 offset:24576
    v_mfma_f32_16x16x32_bf16 v[224:227], a[16:19], a[224:227], v[224:227]
    v_mfma_f32_16x16x32_bf16 v[228:231], a[16:19], a[228:231], v[228:231]
    buffer_load_dwordx4 a[156:159], v55, s[8:11], s62 offen sc1
    ds_read_b64_tr_b16 a[58:59], v48 offset:25600
    v_mfma_f32_16x16x32_bf16 a[96:99], a[16:19], a[232:235], a[96:99]
    ds_read_b64_tr_b16 a[60:61], v49 offset:24576
    v_mfma_f32_16x16x32_bf16 a[100:103], a[16:19], a[236:239], a[100:103]
    v_mfma_f32_16x16x32_bf16 v[232:235], a[20:23], a[224:227], v[232:235]
    ds_read_b64_tr_b16 a[62:63], v49 offset:25600
    v_mfma_f32_16x16x32_bf16 v[236:239], a[20:23], a[228:231], v[236:239]
    s_add_u32 s62, s62, 0x20000
    v_mfma_f32_16x16x32_bf16 a[104:107], a[20:23], a[232:235], a[104:107]
    s_add_u32 s52, s47, 536576
    v_mfma_f32_16x16x32_bf16 a[108:111], a[20:23], a[236:239], a[108:111]
    buffer_store_dwordx4 v[180:183], v1, s[48:51], s52 offen offset:1024 sc1
    v_mfma_f32_16x16x32_bf16 v[240:243], a[24:27], a[224:227], v[240:243]
    v_mfma_f32_16x16x32_bf16 v[244:247], a[24:27], a[228:231], v[244:247]
    v_mfma_f32_16x16x32_bf16 a[112:115], a[24:27], a[232:235], a[112:115]
    v_mfma_f32_16x16x32_bf16 a[116:119], a[24:27], a[236:239], a[116:119]
    v_mfma_f32_16x16x32_bf16 v[248:251], a[28:31], a[224:227], v[248:251]
    v_mfma_f32_16x16x32_bf16 v[252:255], a[28:31], a[228:231], v[252:255]
    v_mfma_f32_16x16x32_bf16 a[120:123], a[28:31], a[232:235], a[120:123]
    v_mfma_f32_16x16x32_bf16 a[124:127], a[28:31], a[236:239], a[124:127]
    s_waitcnt vmcnt(10) lgkmcnt(0)
    s_barrier
    v_mfma_f32_16x16x32_bf16 v[192:195], a[32:35], a[240:243], v[192:195]
    ds_read_b64_tr_b16 a[0:1], v42 offset:32768
    ds_read_b64_tr_b16 a[2:3], v42 offset:33792
    v_mfma_f32_16x16x32_bf16 v[196:199], a[32:35], a[244:247], v[196:199]
    s_cmp_eq_u32 s30, 0
    s_cbranch_scc1 k12_ool_62
k12_oolret_63:
    v_mfma_f32_16x16x32_bf16 a[64:67], a[32:35], a[248:251], a[64:67]
    s_add_u32 m0, s60, 147456
    ds_read_b64_tr_b16 a[4:5], v43 offset:32768
    v_mfma_f32_16x16x32_bf16 a[68:71], a[32:35], a[252:255], a[68:71]
    buffer_load_dwordx4 v38, s[12:15], s61 offen offset:0 lds
    ds_read_b64_tr_b16 a[6:7], v43 offset:33792
    v_mfma_f32_16x16x32_bf16 v[200:203], a[36:39], a[240:243], v[200:203]
    buffer_load_dwordx4 v39, s[12:15], s61 offen offset:1024 lds
    ds_read_b64_tr_b16 a[8:9], v44 offset:32768
    v_mfma_f32_16x16x32_bf16 v[204:207], a[36:39], a[244:247], v[204:207]
    v_mfma_f32_16x16x32_bf16 a[72:75], a[36:39], a[248:251], a[72:75]
    ds_read_b64_tr_b16 a[10:11], v44 offset:33792
    v_mfma_f32_16x16x32_bf16 a[76:79], a[36:39], a[252:255], a[76:79]
    buffer_load_dwordx4 v40, s[12:15], s61 offen offset:2048 lds
    ds_read_b64_tr_b16 a[12:13], v45 offset:32768
    v_mfma_f32_16x16x32_bf16 v[208:211], a[40:43], a[240:243], v[208:211]
    v_mfma_f32_16x16x32_bf16 v[212:215], a[40:43], a[244:247], v[212:215]
    ds_read_b64_tr_b16 a[14:15], v45 offset:33792
    v_mfma_f32_16x16x32_bf16 a[80:83], a[40:43], a[248:251], a[80:83]
    buffer_load_dwordx4 v41, s[12:15], s61 offen offset:3072 lds
    ds_read_b64_tr_b16 a[16:17], v46 offset:32768
    v_mfma_f32_16x16x32_bf16 a[84:87], a[40:43], a[252:255], a[84:87]
    ds_read_b64_tr_b16 a[18:19], v46 offset:33792
    v_mfma_f32_16x16x32_bf16 v[216:219], a[44:47], a[240:243], v[216:219]
    s_add_u32 s61, s61, 0x80000
    v_mfma_f32_16x16x32_bf16 v[220:223], a[44:47], a[244:247], v[220:223]
    buffer_load_dwordx4 a[160:163], v36, s[8:11], s62 offen sc1
    ds_read_b64_tr_b16 a[20:21], v47 offset:32768
    v_mfma_f32_16x16x32_bf16 a[88:91], a[44:47], a[248:251], a[88:91]
    ds_read_b64_tr_b16 a[22:23], v47 offset:33792
    v_mfma_f32_16x16x32_bf16 a[92:95], a[44:47], a[252:255], a[92:95]
    buffer_load_dwordx4 a[164:167], v54, s[8:11], s62 offen sc1
    ds_read_b64_tr_b16 a[24:25], v48 offset:32768
    v_mfma_f32_16x16x32_bf16 v[224:227], a[48:51], a[240:243], v[224:227]
    v_mfma_f32_16x16x32_bf16 v[228:231], a[48:51], a[244:247], v[228:231]
    ds_read_b64_tr_b16 a[26:27], v48 offset:33792
    v_mfma_f32_16x16x32_bf16 a[96:99], a[48:51], a[248:251], a[96:99]
    buffer_load_dwordx4 a[168:171], v37, s[8:11], s62 offen sc1
    ds_read_b64_tr_b16 a[28:29], v49 offset:32768
    v_mfma_f32_16x16x32_bf16 a[100:103], a[48:51], a[252:255], a[100:103]
    v_mfma_f32_16x16x32_bf16 v[232:235], a[52:55], a[240:243], v[232:235]
    ds_read_b64_tr_b16 a[30:31], v49 offset:33792
    v_mfma_f32_16x16x32_bf16 v[236:239], a[52:55], a[244:247], v[236:239]
    buffer_load_dwordx4 a[172:175], v55, s[8:11], s62 offen sc1
    v_mfma_f32_16x16x32_bf16 a[104:107], a[52:55], a[248:251], a[104:107]
    v_mfma_f32_16x16x32_bf16 a[108:111], a[52:55], a[252:255], a[108:111]
    s_add_u32 s62, s62, 0x20000
    v_mfma_f32_16x16x32_bf16 v[240:243], a[56:59], a[240:243], v[240:243]
    s_add_u32 s52, s47, 536576
    v_mfma_f32_16x16x32_bf16 v[244:247], a[56:59], a[244:247], v[244:247]
    buffer_store_dwordx4 v[184:187], v1, s[48:51], s52 offen offset:2048 sc1
    v_mfma_f32_16x16x32_bf16 a[112:115], a[56:59], a[248:251], a[112:115]
    v_mfma_f32_16x16x32_bf16 a[116:119], a[56:59], a[252:255], a[116:119]
    v_mfma_f32_16x16x32_bf16 v[248:251], a[60:63], a[240:243], v[248:251]
    v_mfma_f32_16x16x32_bf16 v[252:255], a[60:63], a[244:247], v[252:255]
    v_mfma_f32_16x16x32_bf16 a[120:123], a[60:63], a[248:251], a[120:123]
    v_mfma_f32_16x16x32_bf16 a[124:127], a[60:63], a[252:255], a[124:127]
    s_waitcnt vmcnt(15) lgkmcnt(0)
    v_mfma_f32_16x16x32_bf16 v[192:195], a[0:3], a[128:131], v[192:195]
    ds_read_b64_tr_b16 a[32:33], v42 offset:40960
    ds_read_b64_tr_b16 a[34:35], v42 offset:41984
    v_mfma_f32_16x16x32_bf16 v[196:199], a[0:3], a[132:135], v[196:199]
    buffer_load_dwordx4 a[176:179], v36, s[8:11], s62 offen sc1
    v_mfma_f32_16x16x32_bf16 a[64:67], a[0:3], a[136:139], a[64:67]
    ds_read_b64_tr_b16 a[36:37], v43 offset:40960
    v_mfma_f32_16x16x32_bf16 a[68:71], a[0:3], a[140:143], a[68:71]
    ds_read_b64_tr_b16 a[38:39], v43 offset:41984
    v_mfma_f32_16x16x32_bf16 v[200:203], a[4:7], a[128:131], v[200:203]
    ds_read_b64_tr_b16 a[40:41], v44 offset:40960
    v_mfma_f32_16x16x32_bf16 v[204:207], a[4:7], a[132:135], v[204:207]
    v_mfma_f32_16x16x32_bf16 a[72:75], a[4:7], a[136:139], a[72:75]
    buffer_load_dwordx4 a[180:183], v54, s[8:11], s62 offen sc1
    ds_read_b64_tr_b16 a[42:43], v44 offset:41984
    v_mfma_f32_16x16x32_bf16 a[76:79], a[4:7], a[140:143], a[76:79]
    ds_read_b64_tr_b16 a[44:45], v45 offset:40960
    v_mfma_f32_16x16x32_bf16 v[208:211], a[8:11], a[128:131], v[208:211]
    v_mfma_f32_16x16x32_bf16 v[212:215], a[8:11], a[132:135], v[212:215]
    ds_read_b64_tr_b16 a[46:47], v45 offset:41984
    v_mfma_f32_16x16x32_bf16 a[80:83], a[8:11], a[136:139], a[80:83]
    ds_read_b64_tr_b16 a[48:49], v46 offset:40960
    v_mfma_f32_16x16x32_bf16 a[84:87], a[8:11], a[140:143], a[84:87]
    buffer_load_dwordx4 a[184:187], v37, s[8:11], s62 offen sc1
    ds_read_b64_tr_b16 a[50:51], v46 offset:41984
    v_mfma_f32_16x16x32_bf16 v[216:219], a[12:15], a[128:131], v[216:219]
    v_mfma_f32_16x16x32_bf16 v[220:223], a[12:15], a[132:135], v[220:223]
    ds_read_b64_tr_b16 a[52:53], v47 offset:40960
    v_mfma_f32_16x16x32_bf16 a[88:91], a[12:15], a[136:139], a[88:91]
    ds_read_b64_tr_b16 a[54:55], v47 offset:41984
    v_mfma_f32_16x16x32_bf16 a[92:95], a[12:15], a[140:143], a[92:95]
    ds_read_b64_tr_b16 a[56:57], v48 offset:40960
    v_mfma_f32_16x16x32_bf16 v[224:227], a[16:19], a[128:131], v[224:227]
    v_mfma_f32_16x16x32_bf16 v[228:231], a[16:19], a[132:135], v[228:231]
    buffer_load_dwordx4 a[188:191], v55, s[8:11], s62 offen sc1
    ds_read_b64_tr_b16 a[58:59], v48 offset:41984
    v_mfma_f32_16x16x32_bf16 a[96:99], a[16:19], a[136:139], a[96:99]
    ds_read_b64_tr_b16 a[60:61], v49 offset:40960
    v_mfma_f32_16x16x32_bf16 a[100:103], a[16:19], a[140:143], a[100:103]
    v_mfma_f32_16x16x32_bf16 v[232:235], a[20:23], a[128:131], v[232:235]
    ds_read_b64_tr_b16 a[62:63], v49 offset:41984
    v_mfma_f32_16x16x32_bf16 v[236:239], a[20:23], a[132:135], v[236:239]
    s_add_u32 s62, s62, 0x20000
    v_mfma_f32_16x16x32_bf16 a[104:107], a[20:23], a[136:139], a[104:107]
    s_add_u32 s52, s47, 536576
    v_mfma_f32_16x16x32_bf16 a[108:111], a[20:23], a[140:143], a[108:111]
    buffer_store_dwordx4 v[188:191], v1, s[48:51], s52 offen offset:3072 sc1
    v_mfma_f32_16x16x32_bf16 v[240:243], a[24:27], a[128:131], v[240:243]
    v_mfma_f32_16x16x32_bf16 v[244:247], a[24:27], a[132:135], v[244:247]
    v_mfma_f32_16x16x32_bf16 a[112:115], a[24:27], a[136:139], a[112:115]
    v_mfma_f32_16x16x32_bf16 a[116:119], a[24:27], a[140:143], a[116:119]
    v_mfma_f32_16x16x32_bf16 v[248:251], a[28:31], a[128:131], v[248:251]
    s_cmp_eq_u32 s30, 0
    s_cbranch_scc1 k12_ool_66
k12_oolret_67:
    v_mfma_f32_16x16x32_bf16 v[252:255], a[28:31], a[132:135], v[252:255]
    v_mfma_f32_16x16x32_bf16 a[120:123], a[28:31], a[136:139], a[120:123]
    v_mfma_f32_16x16x32_bf16 a[124:127], a[28:31], a[140:143], a[124:127]
    s_waitcnt vmcnt(10) lgkmcnt(0)
    s_barrier
    v_mfma_f32_16x16x32_bf16 v[192:195], a[32:35], a[144:147], v[192:195]
    ds_read_b64_tr_b16 a[0:1], v42 offset:49152
    ds_read_b64_tr_b16 a[2:3], v42 offset:50176
    v_mfma_f32_16x16x32_bf16 v[196:199], a[32:35], a[148:151], v[196:199]
    s_mov_b32 m0, s34
    v_mfma_f32_16x16x32_bf16 a[64:67], a[32:35], a[152:155], a[64:67]
    buffer_load_dwordx4 v1, s[16:19], s32 offen offset:0 sc1 lds
    ds_read_b64_tr_b16 a[4:5], v43 offset:49152
    v_mfma_f32_16x16x32_bf16 a[68:71], a[32:35], a[156:159], a[68:71]
    ds_read_b64_tr_b16 a[6:7], v43 offset:50176
    v_mfma_f32_16x16x32_bf16 v[200:203], a[36:39], a[144:147], v[200:203]
    buffer_load_dwordx4 v1, s[16:19], s32 offen offset:1024 sc1 lds
    ds_read_b64_tr_b16 a[8:9], v44 offset:49152
    v_mfma_f32_16x16x32_bf16 v[204:207], a[36:39], a[148:151], v[204:207]
    v_mfma_f32_16x16x32_bf16 a[72:75], a[36:39], a[152:155], a[72:75]
    ds_read_b64_tr_b16 a[10:11], v44 offset:50176
    v_mfma_f32_16x16x32_bf16 a[76:79], a[36:39], a[156:159], a[76:79]
    buffer_load_dwordx4 v1, s[16:19], s32 offen offset:2048 sc1 lds
    ds_read_b64_tr_b16 a[12:13], v45 offset:49152
    v_mfma_f32_16x16x32_bf16 v[208:211], a[40:43], a[144:147], v[208:211]
    v_mfma_f32_16x16x32_bf16 v[212:215], a[40:43], a[148:151], v[212:215]
    ds_read_b64_tr_b16 a[14:15], v45 offset:50176
    v_mfma_f32_16x16x32_bf16 a[80:83], a[40:43], a[152:155], a[80:83]
    ds_read_b64_tr_b16 a[16:17], v46 offset:49152
    v_mfma_f32_16x16x32_bf16 a[84:87], a[40:43], a[156:159], a[84:87]
    buffer_load_dwordx4 v1, s[16:19], s32 offen offset:3072 sc1 lds
    ds_read_b64_tr_b16 a[18:19], v46 offset:50176
    v_mfma_f32_16x16x32_bf16 v[216:219], a[44:47], a[144:147], v[216:219]
    v_mfma_f32_16x16x32_bf16 v[220:223], a[44:47], a[148:151], v[220:223]
    s_add_u32 s32, s32, 0x80000
    ds_read_b64_tr_b16 a[20:21], v47 offset:49152
    v_mfma_f32_16x16x32_bf16 a[88:91], a[44:47], a[152:155], a[88:91]
    s_add_u32 s34, s34, 0x4000
    ds_read_b64_tr_b16 a[22:23], v47 offset:50176
    s_mov_b32 m0, s34
    v_mfma_f32_16x16x32_bf16 a[92:95], a[44:47], a[156:159], a[92:95]
    buffer_load_dwordx4 v1, s[16:19], s32 offen offset:0 sc1 lds
    ds_read_b64_tr_b16 a[24:25], v48 offset:49152
    v_mfma_f32_16x16x32_bf16 v[224:227], a[48:51], a[144:147], v[224:227]
    v_mfma_f32_16x16x32_bf16 v[228:231], a[48:51], a[148:151], v[228:231]
    buffer_load_dwordx4 v1, s[16:19], s32 offen offset:1024 sc1 lds
    ds_read_b64_tr_b16 a[26:27], v48 offset:50176
    v_mfma_f32_16x16x32_bf16 a[96:99], a[48:51], a[152:155], a[96:99]
    ds_read_b64_tr_b16 a[28:29], v49 offset:49152
    v_mfma_f32_16x16x32_bf16 a[100:103], a[48:51], a[156:159], a[100:103]
    v_mfma_f32_16x16x32_bf16 v[232:235], a[52:55], a[144:147], v[232:235]
    buffer_load_dwordx4 v1, s[16:19], s32 offen offset:2048 sc1 lds
    ds_read_b64_tr_b16 a[30:31], v49 offset:50176
    v_mfma_f32_16x16x32_bf16 v[236:239], a[52:55], a[148:151], v[236:239]
    v_mfma_f32_16x16x32_bf16 a[104:107], a[52:55], a[152:155], a[104:107]
    v_mfma_f32_16x16x32_bf16 a[108:111], a[52:55], a[156:159], a[108:111]
    v_mfma_f32_16x16x32_bf16 v[240:243], a[56:59], a[144:147], v[240:243]
    buffer_load_dwordx4 v1, s[16:19], s32 offen offset:3072 sc1 lds
    v_mfma_f32_16x16x32_bf16 v[244:247], a[56:59], a[148:151], v[244:247]
    v_mfma_f32_16x16x32_bf16 a[112:115], a[56:59], a[152:155], a[112:115]
    s_add_u32 s32, s32, 0x80000
    v_mfma_f32_16x16x32_bf16 a[116:119], a[56:59], a[156:159], a[116:119]
    s_add_u32 s34, s34, 0x4000
    v_mfma_f32_16x16x32_bf16 v[248:251], a[60:63], a[144:147], v[248:251]
    v_mfma_f32_16x16x32_bf16 v[252:255], a[60:63], a[148:151], v[252:255]
    v_mfma_f32_16x16x32_bf16 a[120:123], a[60:63], a[152:155], a[120:123]
    v_mfma_f32_16x16x32_bf16 a[124:127], a[60:63], a[156:159], a[124:127]
    s_waitcnt vmcnt(14) lgkmcnt(0)
    v_mfma_f32_16x16x32_bf16 v[192:195], a[0:3], a[160:163], v[192:195]
    ds_read_b64_tr_b16 a[32:33], v42 offset:57344
    ds_read_b64_tr_b16 a[34:35], v42 offset:58368
    v_mfma_f32_16x16x32_bf16 v[196:199], a[0:3], a[164:167], v[196:199]
    s_mov_b32 m0, s35
    v_mfma_f32_16x16x32_bf16 a[64:67], a[0:3], a[168:171], a[64:67]
    buffer_load_dwordx4 v1, s[20:23], s33 offen offset:0 sc1 lds
    ds_read_b64_tr_b16 a[36:37], v43 offset:57344
    v_mfma_f32_16x16x32_bf16 a[68:71], a[0:3], a[172:175], a[68:71]
    ds_read_b64_tr_b16 a[38:39], v43 offset:58368
    v_mfma_f32_16x16x32_bf16 v[200:203], a[4:7], a[160:163], v[200:203]
    buffer_load_dwordx4 v1, s[20:23], s33 offen offset:1024 sc1 lds
    ds_read_b64_tr_b16 a[40:41], v44 offset:57344
    v_mfma_f32_16x16x32_bf16 v[204:207], a[4:7], a[164:167], v[204:207]
    v_mfma_f32_16x16x32_bf16 a[72:75], a[4:7], a[168:171], a[72:75]
    ds_read_b64_tr_b16 a[42:43], v44 offset:58368
    v_mfma_f32_16x16x32_bf16 a[76:79], a[4:7], a[172:175], a[76:79]
    buffer_load_dwordx4 v1, s[20:23], s33 offen offset:2048 sc1 lds
    ds_read_b64_tr_b16 a[44:45], v45 offset:57344
    v_mfma_f32_16x16x32_bf16 v[208:211], a[8:11], a[160:163], v[208:211]
    v_mfma_f32_16x16x32_bf16 v[212:215], a[8:11], a[164:167], v[212:215]
    ds_read_b64_tr_b16 a[46:47], v45 offset:58368
    v_mfma_f32_16x16x32_bf16 a[80:83], a[8:11], a[168:171], a[80:83]
    ds_read_b64_tr_b16 a[48:49], v46 offset:57344
    v_mfma_f32_16x16x32_bf16 a[84:87], a[8:11], a[172:175], a[84:87]
    buffer_load_dwordx4 v1, s[20:23], s33 offen offset:3072 sc1 lds
    ds_read_b64_tr_b16 a[50:51], v46 offset:58368
    v_mfma_f32_16x16x32_bf16 v[216:219], a[12:15], a[160:163], v[216:219]
    v_mfma_f32_16x16x32_bf16 v[220:223], a[12:15], a[164:167], v[220:223]
    s_add_u32 s33, s33, 0x80000
    ds_read_b64_tr_b16 a[52:53], v47 offset:57344
    v_mfma_f32_16x16x32_bf16 a[88:91], a[12:15], a[168:171], a[88:91]
    s_add_u32 s35, s35, 0x4000
    ds_read_b64_tr_b16 a[54:55], v47 offset:58368
    s_mov_b32 m0, s34
    v_mfma_f32_16x16x32_bf16 a[92:95], a[12:15], a[172:175], a[92:95]
    buffer_load_dwordx4 v1, s[16:19], s32 offen offset:0 sc1 lds
    ds_read_b64_tr_b16 a[56:57], v48 offset:57344
    v_mfma_f32_16x16x32_bf16 v[224:227], a[16:19], a[160:163], v[224:227]
    v_mfma_f32_16x16x32_bf16 v[228:231], a[16:19], a[164:167], v[228:231]
    buffer_load_dwordx4 v1, s[16:19], s32 offen offset:1024 sc1 lds
    ds_read_b64_tr_b16 a[58:59], v48 offset:58368
    v_mfma_f32_16x16x32_bf16 a[96:99], a[16:19], a[168:171], a[96:99]
    ds_read_b64_tr_b16 a[60:61], v49 offset:57344
    v_mfma_f32_16x16x32_bf16 a[100:103], a[16:19], a[172:175], a[100:103]
    v_mfma_f32_16x16x32_bf16 v[232:235], a[20:23], a[160:163], v[232:235]
    buffer_load_dwordx4 v1, s[16:19], s32 offen offset:2048 sc1 lds
    ds_read_b64_tr_b16 a[62:63], v49 offset:58368
    v_mfma_f32_16x16x32_bf16 v[236:239], a[20:23], a[164:167], v[236:239]
    v_mfma_f32_16x16x32_bf16 a[104:107], a[20:23], a[168:171], a[104:107]
    v_mfma_f32_16x16x32_bf16 a[108:111], a[20:23], a[172:175], a[108:111]
    v_mfma_f32_16x16x32_bf16 v[240:243], a[24:27], a[160:163], v[240:243]
    buffer_load_dwordx4 v1, s[16:19], s32 offen offset:3072 sc1 lds
    v_mfma_f32_16x16x32_bf16 v[244:247], a[24:27], a[164:167], v[244:247]
    v_mfma_f32_16x16x32_bf16 a[112:115], a[24:27], a[168:171], a[112:115]
    s_add_u32 s32, s32, 0x80000
    v_mfma_f32_16x16x32_bf16 a[116:119], a[24:27], a[172:175], a[116:119]
    s_add_u32 s34, s34, 0x4000
    v_mfma_f32_16x16x32_bf16 v[248:251], a[28:31], a[160:163], v[248:251]
    v_mfma_f32_16x16x32_bf16 v[252:255], a[28:31], a[164:167], v[252:255]
    v_mfma_f32_16x16x32_bf16 a[120:123], a[28:31], a[168:171], a[120:123]
    v_mfma_f32_16x16x32_bf16 a[124:127], a[28:31], a[172:175], a[124:127]
    s_waitcnt vmcnt(17) lgkmcnt(0)
    s_barrier
    v_mfma_f32_16x16x32_bf16 v[192:195], a[32:35], a[176:179], v[192:195]
    v_mfma_f32_16x16x32_bf16 v[196:199], a[32:35], a[180:183], v[196:199]
    s_mov_b32 m0, s35
    v_mfma_f32_16x16x32_bf16 a[64:67], a[32:35], a[184:187], a[64:67]
    buffer_load_dwordx4 v1, s[20:23], s33 offen offset:0 sc1 lds
    v_mfma_f32_16x16x32_bf16 a[68:71], a[32:35], a[188:191], a[68:71]
    v_mfma_f32_16x16x32_bf16 v[200:203], a[36:39], a[176:179], v[200:203]
    v_mfma_f32_16x16x32_bf16 v[204:207], a[36:39], a[180:183], v[204:207]
    v_mfma_f32_16x16x32_bf16 a[72:75], a[36:39], a[184:187], a[72:75]
    v_mfma_f32_16x16x32_bf16 a[76:79], a[36:39], a[188:191], a[76:79]
    buffer_load_dwordx4 v1, s[20:23], s33 offen offset:1024 sc1 lds
    v_mfma_f32_16x16x32_bf16 v[208:211], a[40:43], a[176:179], v[208:211]
    v_mfma_f32_16x16x32_bf16 v[212:215], a[40:43], a[180:183], v[212:215]
    v_mfma_f32_16x16x32_bf16 a[80:83], a[40:43], a[184:187], a[80:83]
    v_mfma_f32_16x16x32_bf16 a[84:87], a[40:43], a[188:191], a[84:87]
    v_mfma_f32_16x16x32_bf16 v[216:219], a[44:47], a[176:179], v[216:219]
    v_mfma_f32_16x16x32_bf16 v[220:223], a[44:47], a[180:183], v[220:223]
    v_mfma_f32_16x16x32_bf16 a[88:91], a[44:47], a[184:187], a[88:91]
    buffer_load_dwordx4 v1, s[20:23], s33 offen offset:2048 sc1 lds
    v_mfma_f32_16x16x32_bf16 a[92:95], a[44:47], a[188:191], a[92:95]
    v_mfma_f32_16x16x32_bf16 v[224:227], a[48:51], a[176:179], v[224:227]
    v_mfma_f32_16x16x32_bf16 v[228:231], a[48:51], a[180:183], v[228:231]
    v_mfma_f32_16x16x32_bf16 a[96:99], a[48:51], a[184:187], a[96:99]
    v_mfma_f32_16x16x32_bf16 a[100:103], a[48:51], a[188:191], a[100:103]
    v_mfma_f32_16x16x32_bf16 v[232:235], a[52:55], a[176:179], v[232:235]
    buffer_load_dwordx4 v1, s[20:23], s33 offen offset:3072 sc1 lds
    v_mfma_f32_16x16x32_bf16 v[236:239], a[52:55], a[180:183], v[236:239]
    v_mfma_f32_16x16x32_bf16 a[104:107], a[52:55], a[184:187], a[104:107]
    v_mfma_f32_16x16x32_bf16 a[108:111], a[52:55], a[188:191], a[108:111]
    v_mfma_f32_16x16x32_bf16 v[240:243], a[56:59], a[176:179], v[240:243]
    v_mfma_f32_16x16x32_bf16 v[244:247], a[56:59], a[180:183], v[244:247]
    v_mfma_f32_16x16x32_bf16 a[112:115], a[56:59], a[184:187], a[112:115]
    s_add_u32 s33, s33, 0x80000
    v_mfma_f32_16x16x32_bf16 a[116:119], a[56:59], a[188:191], a[116:119]
    s_add_u32 s35, s35, 0x4000
    v_mfma_f32_16x16x32_bf16 v[248:251], a[60:63], a[176:179], v[248:251]
    v_mfma_f32_16x16x32_bf16 v[252:255], a[60:63], a[180:183], v[252:255]
    v_mfma_f32_16x16x32_bf16 a[120:123], a[60:63], a[184:187], a[120:123]
    v_mfma_f32_16x16x32_bf16 a[124:127], a[60:63], a[188:191], a[124:127]
    s_add_u32 s3, s54, 64
    s_add_u32 s5, s55, 64
    s_mov_b32 s63, s57
    s_load_dwordx2 s[44:45], s[0:1], 40
    s_load_dwordx2 s[46:47], s[0:1], 64
    s_load_dwordx4 s[48:51], s[0:1], 72
    s_mov_b32 s40, 0x3e0293ee
    s_mov_b32 s41, 0x3e0293ee
    s_mov_b32 m0, s34
    s_nop 0
    buffer_load_dwordx4 v1, s[16:19], s32 offen offset:0 sc1 lds
    buffer_load_dwordx4 v1, s[16:19], s32 offen offset:1024 sc1 lds
    buffer_load_dwordx4 v1, s[16:19], s32 offen offset:2048 sc1 lds
    buffer_load_dwordx4 v1, s[16:19], s32 offen offset:3072 sc1 lds
    s_mov_b32 m0, s35
    s_nop 0
    buffer_load_dwordx4 v1, s[20:23], s33 offen offset:0 sc1 lds
    buffer_load_dwordx4 v1, s[20:23], s33 offen offset:1024 sc1 lds
    buffer_load_dwordx4 v1, s[20:23], s33 offen offset:2048 sc1 lds
    buffer_load_dwordx4 v1, s[20:23], s33 offen offset:3072 sc1 lds
    s_add_u32 s32, s32, 0x80000
    s_add_u32 s33, s33, 0x80000
    s_add_u32 s34, s34, 0x4000
    s_and_b32 s34, s34, 0xffff
    s_add_u32 s35, s35, 0x4000
    s_and_b32 s35, s35, 0xffff
    s_or_b32 s35, s35, 0x10000
    v_mov_b32 v2, v1
    v_or_b32 v3, 0x10000, v1
    v_mov_b32 v56, v3
    s_mov_b32 s52, 0x4000
    s_mov_b32 s53, 0
    s_lshl_b32 s62, s28, 6
    s_mul_i32 s31, s29, s29
    s_add_u32 s62, s62, s31
    s_lshr_b32 s31, s30, 1
    s_lshl_b32 s4, s31, 23
    s_add_u32 s4, s4, 0x6000000
    s_add_u32 s8, s6, s4
    s_addc_u32 s9, s7, 0
    s_and_b32 s9, s9, 0xffff
    s_mov_b32 s10, 0
    s_mov_b32 s58, 0
    s_mov_b32 s14, 0x700000
    s_mov_b32 s59, 0x700000
    s_lshl_b32 s54, s62, 12
    s_waitcnt vmcnt(16) lgkmcnt(0)
    s_barrier
    s_cmp_eq_u32 s63, 0
    s_cbranch_scc1 k12_ool_68
k12_oolret_69:
    v_mov_b32 v59, 0
    ds_read_b128 a[128:131], v2 offset:0
    ds_read_b128 a[132:135], v2 offset:1024
    ds_read_b128 a[136:139], v2 offset:2048
    ds_read_b128 a[140:143], v2 offset:3072
    ds_read_b128 a[144:147], v2 offset:4096
    ds_read_b128 a[148:151], v2 offset:5120
    ds_read_b128 a[152:155], v2 offset:6144
    ds_read_b128 a[156:159], v2 offset:7168
    ds_read_b128 a[160:163], v2 offset:8192
    ds_read_b128 a[164:167], v2 offset:9216
    ds_read_b128 a[168:171], v2 offset:10240
    ds_read_b128 a[172:175], v2 offset:11264
    ds_read_b128 a[176:179], v2 offset:12288
    ds_read_b128 a[180:183], v2 offset:13312
    ds_read_b128 a[184:187], v2 offset:14336
    ds_read_b128 a[188:191], v2 offset:15360
    s_cmp_lt_u32 s30, 2
    s_cselect_b64 s[12:13], s[46:47], s[48:49]
    s_cselect_b64 s[60:61], s[44:45], s[50:51]
    s_cselect_b32 s55, 0x800000, s14
    s_and_b32 s13, s13, 0xffff
    v_accvgpr_read_b32 v128, a64
    v_accvgpr_read_b32 v129, a65
    v_accvgpr_read_b32 v130, a66
    v_accvgpr_read_b32 v131, a67
    v_pk_mul_f32 v[128:129], v[128:129], s[40:41]
    v_pk_mul_f32 v[130:131], v[130:131], s[40:41]
    v_cvt_pk_bf16_f32 v96, v128, v129
    v_cvt_pk_bf16_f32 v97, v130, v131
    v_accvgpr_read_b32 v132, a72
    v_accvgpr_read_b32 v133, a73
    v_accvgpr_read_b32 v134, a74
    v_accvgpr_read_b32 v135, a75
    v_pk_mul_f32 v[132:133], v[132:133], s[40:41]
    v_pk_mul_f32 v[134:135], v[134:135], s[40:41]
    v_cvt_pk_bf16_f32 v98, v132, v133
    v_cvt_pk_bf16_f32 v99, v134, v135
    v_accvgpr_read_b32 v136, a80
    v_accvgpr_read_b32 v137, a81
    v_accvgpr_read_b32 v138, a82
    v_accvgpr_read_b32 v139, a83
    v_pk_mul_f32 v[136:137], v[136:137], s[40:41]
    v_pk_mul_f32 v[138:139], v[138:139], s[40:41]
    v_cvt_pk_bf16_f32 v100, v136, v137
    v_cvt_pk_bf16_f32 v101, v138, v139
    v_accvgpr_read_b32 v140, a88
    v_accvgpr_read_b32 v141, a89
    v_accvgpr_read_b32 v142, a90
    v_accvgpr_read_b32 v143, a91
    v_pk_mul_f32 v[140:141], v[140:141], s[40:41]
    v_pk_mul_f32 v[142:143], v[142:143], s[40:41]
    v_cvt_pk_bf16_f32 v102, v140, v141
    v_cvt_pk_bf16_f32 v103, v142, v143
    v_accvgpr_read_b32 v128, a96
    v_accvgpr_read_b32 v129, a97
    v_accvgpr_read_b32 v130, a98
    v_accvgpr_read_b32 v131, a99
    v_pk_mul_f32 v[128:129], v[128:129], s[40:41]
    v_pk_mul_f32 v[130:131], v[130:131], s[40:41]
    v_cvt_pk_bf16_f32 v104, v128, v129
    v_cvt_pk_bf16_f32 v105, v130, v131
    v_accvgpr_read_b32 v132, a104
    v_accvgpr_read_b32 v133, a105
    v_accvgpr_read_b32 v134, a106
    v_accvgpr_read_b32 v135, a107
    v_pk_mul_f32 v[132:133], v[132:133], s[40:41]
    v_pk_mul_f32 v[134:135], v[134:135], s[40:41]
    v_cvt_pk_bf16_f32 v106, v132, v133
    v_cvt_pk_bf16_f32 v107, v134, v135
    v_accvgpr_read_b32 v136, a112
    v_accvgpr_read_b32 v137, a113
    v_accvgpr_read_b32 v138, a114
    v_accvgpr_read_b32 v139, a115
    v_pk_mul_f32 v[136:137], v[136:137], s[40:41]
    v_pk_mul_f32 v[138:139], v[138:139], s[40:41]
    v_cvt_pk_bf16_f32 v108, v136, v137
    v_cvt_pk_bf16_f32 v109, v138, v139
    v_accvgpr_read_b32 v140, a120
    v_accvgpr_read_b32 v141, a121
    v_accvgpr_read_b32 v142, a122
    v_accvgpr_read_b32 v143, a123
    v_pk_mul_f32 v[140:141], v[140:141], s[40:41]
    v_pk_mul_f32 v[142:143], v[142:143], s[40:41]
    v_cvt_pk_bf16_f32 v110, v140, v141
    v_cvt_pk_bf16_f32 v111, v142, v143
    v_accvgpr_read_b32 v128, a68
    v_accvgpr_read_b32 v129, a69
    v_accvgpr_read_b32 v130, a70
    v_accvgpr_read_b32 v131, a71
    v_pk_mul_f32 v[128:129], v[128:129], s[40:41]
    v_pk_mul_f32 v[130:131], v[130:131], s[40:41]
    v_cvt_pk_bf16_f32 v112, v128, v129
    v_cvt_pk_bf16_f32 v113, v130, v131
    v_accvgpr_read_b32 v132, a76
    v_accvgpr_read_b32 v133, a77
    v_accvgpr_read_b32 v134, a78
    v_accvgpr_read_b32 v135, a79
    v_pk_mul_f32 v[132:133], v[132:133], s[40:41]
    v_pk_mul_f32 v[134:135], v[134:135], s[40:41]
    v_cvt_pk_bf16_f32 v114, v132, v133
    v_cvt_pk_bf16_f32 v115, v134, v135
    v_accvgpr_read_b32 v136, a84
    v_accvgpr_read_b32 v137, a85
    v_accvgpr_read_b32 v138, a86
    v_accvgpr_read_b32 v139, a87
    v_pk_mul_f32 v[136:137], v[136:137], s[40:41]
    v_pk_mul_f32 v[138:139], v[138:139], s[40:41]
    v_cvt_pk_bf16_f32 v116, v136, v137
    v_cvt_pk_bf16_f32 v117, v138, v139
    v_accvgpr_read_b32 v140, a92
    v_accvgpr_read_b32 v141, a93
    v_accvgpr_read_b32 v142, a94
    v_accvgpr_read_b32 v143, a95
    v_pk_mul_f32 v[140:141], v[140:141], s[40:41]
    v_pk_mul_f32 v[142:143], v[142:143], s[40:41]
    v_cvt_pk_bf16_f32 v118, v140, v141
    v_cvt_pk_bf16_f32 v119, v142, v143
    v_accvgpr_read_b32 v128, a100
    v_accvgpr_read_b32 v129, a101
    v_accvgpr_read_b32 v130, a102
    v_accvgpr_read_b32 v131, a103
    v_pk_mul_f32 v[128:129], v[128:129], s[40:41]
    v_pk_mul_f32 v[130:131], v[130:131], s[40:41]
    v_cvt_pk_bf16_f32 v120, v128, v129
    v_cvt_pk_bf16_f32 v121, v130, v131
    v_accvgpr_read_b32 v132, a108
    v_accvgpr_read_b32 v133, a109
    v_accvgpr_read_b32 v134, a110
    v_accvgpr_read_b32 v135, a111
    v_pk_mul_f32 v[132:133], v[132:133], s[40:41]
    v_pk_mul_f32 v[134:135], v[134:135], s[40:41]
    v_cvt_pk_bf16_f32 v122, v132, v133
    v_cvt_pk_bf16_f32 v123, v134, v135
    v_accvgpr_read_b32 v136, a116
    v_accvgpr_read_b32 v137, a117
    v_accvgpr_read_b32 v138, a118
    v_accvgpr_read_b32 v139, a119
    v_pk_mul_f32 v[136:137], v[136:137], s[40:41]
    v_pk_mul_f32 v[138:139], v[138:139], s[40:41]
    v_cvt_pk_bf16_f32 v124, v136, v137
    v_cvt_pk_bf16_f32 v125, v138, v139
    v_accvgpr_read_b32 v140, a124
    v_accvgpr_read_b32 v141, a125
    v_accvgpr_read_b32 v142, a126
    v_accvgpr_read_b32 v143, a127
    v_pk_mul_f32 v[140:141], v[140:141], s[40:41]
    v_pk_mul_f32 v[142:143], v[142:143], s[40:41]
    v_cvt_pk_bf16_f32 v126, v140, v141
    v_cvt_pk_bf16_f32 v127, v142, v143
    v_pk_mul_f32 v[192:193], v[192:193], s[40:41]
    v_pk_mul_f32 v[194:195], v[194:195], s[40:41]
    v_cvt_pk_bf16_f32 v64, v192, v193
    v_cvt_pk_bf16_f32 v65, v194, v195
    v_pk_mul_f32 v[200:201], v[200:201], s[40:41]
    v_pk_mul_f32 v[202:203], v[202:203], s[40:41]
    v_cvt_pk_bf16_f32 v66, v200, v201
    v_cvt_pk_bf16_f32 v67, v202, v203
    v_pk_mul_f32 v[208:209], v[208:209], s[40:41]
    v_pk_mul_f32 v[210:211], v[210:211], s[40:41]
    v_cvt_pk_bf16_f32 v68, v208, v209
    v_cvt_pk_bf16_f32 v69, v210, v211
    v_pk_mul_f32 v[216:217], v[216:217], s[40:41]
    v_pk_mul_f32 v[218:219], v[218:219], s[40:41]
    v_cvt_pk_bf16_f32 v70, v216, v217
    v_cvt_pk_bf16_f32 v71, v218, v219
    v_pk_mul_f32 v[224:225], v[224:225], s[40:41]
    v_pk_mul_f32 v[226:227], v[226:227], s[40:41]
    v_cvt_pk_bf16_f32 v72, v224, v225
    v_cvt_pk_bf16_f32 v73, v226, v227
    v_pk_mul_f32 v[232:233], v[232:233], s[40:41]
    v_pk_mul_f32 v[234:235], v[234:235], s[40:41]
    v_cvt_pk_bf16_f32 v74, v232, v233
    v_cvt_pk_bf16_f32 v75, v234, v235
    v_pk_mul_f32 v[240:241], v[240:241], s[40:41]
    v_pk_mul_f32 v[242:243], v[242:243], s[40:41]
    v_cvt_pk_bf16_f32 v76, v240, v241
    v_cvt_pk_bf16_f32 v77, v242, v243
    v_pk_mul_f32 v[248:249], v[248:249], s[40:41]
    v_pk_mul_f32 v[250:251], v[250:251], s[40:41]
    v_cvt_pk_bf16_f32 v78, v248, v249
    v_cvt_pk_bf16_f32 v79, v250, v251
    v_pk_mul_f32 v[196:197], v[196:197], s[40:41]
    v_pk_mul_f32 v[198:199], v[198:199], s[40:41]
    v_cvt_pk_bf16_f32 v80, v196, v197
    v_cvt_pk_bf16_f32 v81, v198, v199
    v_pk_mul_f32 v[204:205], v[204:205], s[40:41]
    v_pk_mul_f32 v[206:207], v[206:207], s[40:41]
    v_cvt_pk_bf16_f32 v82, v204, v205
    v_cvt_pk_bf16_f32 v83, v206, v207
    v_pk_mul_f32 v[212:213], v[212:213], s[40:41]
    v_pk_mul_f32 v[214:215], v[214:215], s[40:41]
    v_cvt_pk_bf16_f32 v84, v212, v213
    v_cvt_pk_bf16_f32 v85, v214, v215
    v_pk_mul_f32 v[220:221], v[220:221], s[40:41]
    v_pk_mul_f32 v[222:223], v[222:223], s[40:41]
    v_cvt_pk_bf16_f32 v86, v220, v221
    v_cvt_pk_bf16_f32 v87, v222, v223
    v_pk_mul_f32 v[228:229], v[228:229], s[40:41]
    v_pk_mul_f32 v[230:231], v[230:231], s[40:41]
    v_cvt_pk_bf16_f32 v88, v228, v229
    v_cvt_pk_bf16_f32 v89, v230, v231
    v_pk_mul_f32 v[236:237], v[236:237], s[40:41]
    v_pk_mul_f32 v[238:239], v[238:239], s[40:41]
    v_cvt_pk_bf16_f32 v90, v236, v237
    v_cvt_pk_bf16_f32 v91, v238, v239
    v_pk_mul_f32 v[244:245], v[244:245], s[40:41]
    v_pk_mul_f32 v[246:247], v[246:247], s[40:41]
    v_cvt_pk_bf16_f32 v92, v244, v245
    v_cvt_pk_bf16_f32 v93, v246, v247
    v_pk_mul_f32 v[252:253], v[252:253], s[40:41]
    v_pk_mul_f32 v[254:255], v[254:255], s[40:41]
    v_cvt_pk_bf16_f32 v94, v252, v253
    v_cvt_pk_bf16_f32 v95, v254, v255
    v_add_u32 v2, 0x4000, v1
    v_mov_b32 v8, 0
    v_mov_b32 v232, 0
    v_mov_b32 v9, 0
    v_mov_b32 v233, 0
    v_mov_b32 v10, 0
    v_mov_b32 v234, 0
    v_mov_b32 v11, 0
    v_mov_b32 v235, 0
    s_mov_b32 s36, 0
    s_mov_b32 s37, 0x40004000
    v_mfma_f32_32x32x16_bf16 v[16:31], v[232:235], v[232:235], 0
    v_mfma_f32_32x32x16_bf16 v[32:47], v[232:235], v[232:235], 0
    v_and_b32 v6, 0xf0, v1
    v_cmp_eq_u32 vcc, 0, v6
    v_mov_b32 v6, 0x3f803f80
    v_lshrrev_b32 v229, 7, v1
    s_and_b32 s4, s30, 1
    s_lshl_b32 s31, s4, 11
    v_lshl_add_u32 v230, v1, 1, s31
    v_lshl_add_u32 v229, s4, 4, v229
    v_mul_u32_u24 v228, 7168, v229
    v_and_b32 v7, 0x70, v1
    v_add_u32 v228, v228, v7
    v_lshlrev_b32 v229, 5, v229
    v_and_b32 v57, 0x10, v1
    v_add_u32 v229, v229, v57
    v_lshrrev_b32 v7, 5, v7
    v_lshl_add_u32 v229, v7, 15, v229
    v_cndmask_b32 v60, 0, v6, vcc
    v_cndmask_b32 v61, 0, v6, vcc
    v_cndmask_b32 v62, 0, v6, vcc
    v_cndmask_b32 v63, 0, v6, vcc
    v_mov_b32 v12, 0
    v_mov_b32 v13, 0
    v_mov_b32 v14, 0
    v_mov_b32 v15, 0
    v_mov_b32 v48, 0
    v_mov_b32 v49, 0
    v_mov_b32 v50, 0
    v_mov_b32 v51, 0
    v_mov_b32 v248, 0
    v_mov_b32 v249, 0
    v_mov_b32 v250, 0
    v_mov_b32 v251, 0
    v_mov_b32 v252, 0
    v_mov_b32 v253, 0
    v_mov_b32 v254, 0
    v_mov_b32 v255, 0
    s_waitcnt lgkmcnt(0)
    s_cmp_ge_u32 s36, s42
    s_cbranch_scc1 k2_prep_70
k2_prepret_71:
    v_mfma_f32_16x16x32_bf16 v[128:131], a[128:131], v[64:67], v[16:19]
    v_mfma_f32_16x16x32_bf16 v[132:135], a[128:131], v[80:83], v[20:23]
    v_mfma_f32_16x16x32_bf16 v[136:139], a[128:131], v[96:99], v[24:27]
    v_mfma_f32_16x16x32_bf16 v[140:143], a[128:131], v[112:115], v[28:31]
    s_add_u32 s36, s36, 32
    v_mfma_f32_16x16x32_bf16 v[128:131], a[132:135], v[68:71], v[128:131]
    v_mfma_f32_16x16x32_bf16 v[132:135], a[132:135], v[84:87], v[132:135]
    v_mfma_f32_16x16x32_bf16 v[136:139], a[132:135], v[100:103], v[136:139]
    v_mfma_f32_16x16x32_bf16 v[140:143], a[132:135], v[116:119], v[140:143]
    v_mfma_f32_16x16x32_bf16 v[128:131], a[136:139], v[72:75], v[128:131]
    v_mfma_f32_16x16x32_bf16 v[132:135], a[136:139], v[88:91], v[132:135]
    v_mfma_f32_16x16x32_bf16 v[136:139], a[136:139], v[104:107], v[136:139]
    v_mfma_f32_16x16x32_bf16 v[140:143], a[136:139], v[120:123], v[140:143]
    v_mfma_f32_16x16x32_bf16 v[128:131], a[140:143], v[76:79], v[128:131]
    v_mfma_f32_16x16x32_bf16 v[132:135], a[140:143], v[92:95], v[132:135]
    v_mfma_f32_16x16x32_bf16 v[136:139], a[140:143], v[108:111], v[136:139]
    v_mfma_f32_16x16x32_bf16 v[140:143], a[140:143], v[124:127], v[140:143]
    v_mfma_f32_16x16x32_bf16 v[144:147], a[144:147], v[64:67], v[32:35]
    v_mfma_f32_16x16x32_bf16 v[148:151], a[144:147], v[80:83], v[36:39]
    v_mfma_f32_16x16x32_bf16 v[152:155], a[144:147], v[96:99], v[40:43]
    v_mfma_f32_16x16x32_bf16 v[156:159], a[144:147], v[112:115], v[44:47]
    v_mfma_f32_16x16x32_bf16 v[144:147], a[148:151], v[68:71], v[144:147]
    v_mfma_f32_16x16x32_bf16 v[148:151], a[148:151], v[84:87], v[148:151]
    v_mfma_f32_16x16x32_bf16 v[152:155], a[148:151], v[100:103], v[152:155]
    v_mfma_f32_16x16x32_bf16 v[156:159], a[148:151], v[116:119], v[156:159]
    v_mfma_f32_16x16x32_bf16 v[144:147], a[152:155], v[72:75], v[144:147]
    v_mfma_f32_16x16x32_bf16 v[148:151], a[152:155], v[88:91], v[148:151]
    v_mfma_f32_16x16x32_bf16 v[152:155], a[152:155], v[104:107], v[152:155]
    v_mfma_f32_16x16x32_bf16 v[156:159], a[152:155], v[120:123], v[156:159]
    v_mfma_f32_16x16x32_bf16 v[144:147], a[156:159], v[76:79], v[144:147]
    v_mfma_f32_16x16x32_bf16 v[148:151], a[156:159], v[92:95], v[148:151]
    v_mfma_f32_16x16x32_bf16 v[152:155], a[156:159], v[108:111], v[152:155]
    v_mfma_f32_16x16x32_bf16 v[156:159], a[156:159], v[124:127], v[156:159]
    v_mfma_f32_32x32x16_bf16 a[0:15], v[232:235], v[232:235], 0
    v_mfma_f32_32x32x16_bf16 a[16:31], v[232:235], v[232:235], 0
    v_mfma_f32_32x32x16_bf16 a[32:47], v[232:235], v[232:235], 0
    v_mfma_f32_32x32x16_bf16 a[48:63], v[232:235], v[232:235], 0
    v_mfma_f32_32x32x16_bf16 a[64:79], v[232:235], v[232:235], 0
    v_mfma_f32_32x32x16_bf16 a[80:95], v[232:235], v[232:235], 0
    v_mfma_f32_32x32x16_bf16 a[96:111], v[232:235], v[232:235], 0
    v_mfma_f32_32x32x16_bf16 a[112:127], v[232:235], v[232:235], 0
    v_max_f32 v52, v128, v129
    v_max3_f32 v52, v52, v130, v131
    v_max3_f32 v52, v52, v144, v145
    v_max3_f32 v52, v52, v146, v147
    v_max_f32 v53, v132, v133
    v_max3_f32 v53, v53, v134, v135
    v_max3_f32 v53, v53, v148, v149
    v_max3_f32 v53, v53, v150, v151
    v_max_f32 v54, v136, v137
    v_max3_f32 v54, v54, v138, v139
    v_max3_f32 v54, v54, v152, v153
    v_max3_f32 v54, v54, v154, v155
    v_max_f32 v55, v140, v141
    v_max3_f32 v55, v55, v142, v143
    v_max3_f32 v55, v55, v156, v157
    v_max3_f32 v55, v55, v158, v159
    v_mov_b32 v224, v52
    v_mov_b32 v225, v53
    v_mov_b32 v226, v54
    v_mov_b32 v227, v55
    s_nop 1
    v_permlane16_swap_b32 v52, v224
    v_permlane16_swap_b32 v53, v225
    v_permlane16_swap_b32 v54, v226
    v_permlane16_swap_b32 v55, v227
    s_nop 1
    v_max_f32 v52, v52, v224
    v_max_f32 v53, v53, v225
    v_max_f32 v54, v54, v226
    v_max_f32 v55, v55, v227
    v_mov_b32 v224, v52
    v_mov_b32 v225, v53
    v_mov_b32 v226, v54
    v_mov_b32 v227, v55
    s_nop 1
    v_permlane32_swap_b32 v52, v224
    v_permlane32_swap_b32 v53, v225
    v_permlane32_swap_b32 v54, v226
    v_permlane32_swap_b32 v55, v227
    s_nop 1
    v_max_f32 v52, v52, v224
    v_max_f32 v53, v53, v225
    v_max_f32 v54, v54, v226
    v_max_f32 v55, v55, v227
    v_add_f32 v52, 0x41400000, v52
    v_add_f32 v53, 0x41400000, v53
    v_add_f32 v54, 0x41400000, v54
    v_add_f32 v55, 0x41400000, v55
    v_sub_f32 v16, 0, v52
    v_sub_f32 v17, 0, v52
    v_sub_f32 v18, 0, v52
    v_sub_f32 v19, 0, v52
    v_sub_f32 v20, 0, v53
    v_sub_f32 v21, 0, v53
    v_sub_f32 v22, 0, v53
    v_sub_f32 v23, 0, v53
    v_sub_f32 v24, 0, v54
    v_sub_f32 v25, 0, v54
    v_sub_f32 v26, 0, v54
    v_sub_f32 v27, 0, v54
    v_sub_f32 v28, 0, v55
    v_sub_f32 v29, 0, v55
    v_sub_f32 v30, 0, v55
    v_sub_f32 v31, 0, v55
    v_sub_f32 v32, 0, v52
    v_sub_f32 v33, 0, v52
    v_sub_f32 v34, 0, v52
    v_sub_f32 v35, 0, v52
    v_sub_f32 v36, 0, v53
    v_sub_f32 v37, 0, v53
    v_sub_f32 v38, 0, v53
    v_sub_f32 v39, 0, v53
    v_sub_f32 v40, 0, v54
    v_sub_f32 v41, 0, v54
    v_sub_f32 v42, 0, v54
    v_sub_f32 v43, 0, v54
    v_sub_f32 v44, 0, v55
    v_sub_f32 v45, 0, v55
    v_sub_f32 v46, 0, v55
    v_sub_f32 v47, 0, v55
    v_sub_f32 v8, 0, v52
    v_sub_f32 v9, 0, v53
    v_sub_f32 v10, 0, v54
    v_sub_f32 v11, 0, v55
    s_cmp_ge_u32 s36, s42
    s_cbranch_scc1 k2_prep_78
k2_prepret_79:
    v_mfma_f32_16x16x32_bf16 v[160:163], a[160:163], v[64:67], v[16:19]
    v_sub_f32 v128, v128, v52
    v_sub_f32 v129, v129, v52
    v_sub_f32 v130, v130, v52
    v_mfma_f32_16x16x32_bf16 v[164:167], a[160:163], v[80:83], v[20:23]
    v_exp_f32 v232, v128
    v_sub_f32 v131, v131, v52
    v_mfma_f32_16x16x32_bf16 v[168:171], a[160:163], v[96:99], v[24:27]
    v_exp_f32 v233, v129
    v_sub_f32 v144, v144, v52
    v_mfma_f32_16x16x32_bf16 v[172:175], a[160:163], v[112:115], v[28:31]
    s_add_u32 s36, s36, 32
    s_cmp_eq_u32 s30, 0
    s_cbranch_scc1 k12_ool_72
k12_oolret_73:
    v_sub_f32 v145, v145, v52
    v_mfma_f32_16x16x32_bf16 v[160:163], a[164:167], v[68:71], v[160:163]
    v_exp_f32 v234, v130
    v_cvt_pk_bf16_f32 v192, v232, v233
    v_mfma_f32_16x16x32_bf16 v[164:167], a[164:167], v[84:87], v[164:167]
    v_exp_f32 v235, v131
    v_sub_f32 v146, v146, v52
    v_mfma_f32_16x16x32_bf16 v[168:171], a[164:167], v[100:103], v[168:171]
    v_exp_f32 v236, v144
    v_sub_f32 v147, v147, v52
    v_mfma_f32_16x16x32_bf16 v[172:175], a[164:167], v[116:119], v[172:175]
    v_cvt_pk_bf16_f32 v193, v234, v235
    v_exp_f32 v237, v145
    v_mfma_f32_16x16x32_bf16 v[160:163], a[168:171], v[72:75], v[160:163]
    v_exp_f32 v238, v146
    v_sub_f32 v132, v132, v53
    v_mfma_f32_16x16x32_bf16 v[164:167], a[168:171], v[88:91], v[164:167]
    v_sub_f32 v133, v133, v53
    v_cvt_pk_bf16_f32 v194, v236, v237
    v_or3_b32 v57, v192, v193, v194
    v_mfma_f32_16x16x32_bf16 v[168:171], a[168:171], v[104:107], v[168:171]
    v_exp_f32 v239, v147
    v_sub_f32 v134, v134, v53
    v_mfma_f32_16x16x32_bf16 v[172:175], a[168:171], v[120:123], v[172:175]
    v_exp_f32 v240, v132
    v_sub_f32 v135, v135, v53
    v_mfma_f32_16x16x32_bf16 v[160:163], a[172:175], v[76:79], v[160:163]
    v_cvt_pk_bf16_f32 v195, v238, v239
    v_exp_f32 v241, v133
    v_mfma_f32_16x16x32_bf16 v[164:167], a[172:175], v[92:95], v[164:167]
    v_exp_f32 v242, v134
    v_sub_f32 v148, v148, v53
    v_mfma_f32_16x16x32_bf16 v[168:171], a[172:175], v[108:111], v[168:171]
    v_sub_f32 v149, v149, v53
    v_cvt_pk_bf16_f32 v196, v240, v241
    v_exp_f32 v243, v135
    v_mfma_f32_16x16x32_bf16 v[172:175], a[172:175], v[124:127], v[172:175]
    v_or3_b32 v57, v57, v195, v196
    v_exp_f32 v244, v148
    v_mfma_f32_16x16x32_bf16 v[176:179], a[176:179], v[64:67], v[32:35]
    v_sub_f32 v150, v150, v53
    v_sub_f32 v151, v151, v53
    v_cvt_pk_bf16_f32 v197, v242, v243
    v_mfma_f32_16x16x32_bf16 v[180:183], a[176:179], v[80:83], v[36:39]
    v_exp_f32 v245, v149
    v_exp_f32 v246, v150
    v_mfma_f32_16x16x32_bf16 v[184:187], a[176:179], v[96:99], v[40:43]
    v_sub_f32 v136, v136, v54
    v_sub_f32 v137, v137, v54
    v_cvt_pk_bf16_f32 v198, v244, v245
    v_mfma_f32_16x16x32_bf16 v[188:191], a[176:179], v[112:115], v[44:47]
    v_exp_f32 v247, v151
    v_or3_b32 v57, v57, v197, v198
    v_mfma_f32_16x16x32_bf16 v[176:179], a[180:183], v[68:71], v[176:179]
    v_exp_f32 v232, v136
    v_sub_f32 v138, v138, v54
    v_mfma_f32_16x16x32_bf16 v[180:183], a[180:183], v[84:87], v[180:183]
    ds_read_b128 a[192:195], v3 offset:0
    v_sub_f32 v139, v139, v54
    v_cvt_pk_bf16_f32 v199, v246, v247
    v_mfma_f32_16x16x32_bf16 v[184:187], a[180:183], v[100:103], v[184:187]
    v_exp_f32 v233, v137
    v_exp_f32 v234, v138
    v_mfma_f32_16x16x32_bf16 v[188:191], a[180:183], v[116:119], v[188:191]
    v_sub_f32 v152, v152, v54
    v_sub_f32 v153, v153, v54
    v_cvt_pk_bf16_f32 v200, v232, v233
    v_mfma_f32_16x16x32_bf16 v[176:179], a[184:187], v[72:75], v[176:179]
    v_exp_f32 v235, v139
    v_or3_b32 v57, v57, v199, v200
    v_mfma_f32_16x16x32_bf16 v[180:183], a[184:187], v[88:91], v[180:183]
    v_exp_f32 v236, v152
    v_sub_f32 v154, v154, v54
    v_mfma_f32_16x16x32_bf16 v[184:187], a[184:187], v[104:107], v[184:187]
    v_sub_f32 v155, v155, v54
    v_cvt_pk_bf16_f32 v201, v234, v235
    v_exp_f32 v237, v153
    v_mfma_f32_16x16x32_bf16 v[188:191], a[184:187], v[120:123], v[188:191]
    ds_read_b128 a[196:199], v3 offset:1024
    v_exp_f32 v238, v154
    v_mfma_f32_16x16x32_bf16 v[176:179], a[188:191], v[76:79], v[176:179]
    v_sub_f32 v140, v140, v55
    v_sub_f32 v141, v141, v55
    v_cvt_pk_bf16_f32 v202, v236, v237
    v_mfma_f32_16x16x32_bf16 v[180:183], a[188:191], v[92:95], v[180:183]
    v_exp_f32 v239, v155
    v_or3_b32 v57, v57, v201, v202
    v_mfma_f32_16x16x32_bf16 v[184:187], a[188:191], v[108:111], v[184:187]
    s_cmp_eq_u32 s30, 0
    s_cbranch_scc1 k12_ool_76
k12_oolret_77:
    v_exp_f32 v240, v140
    v_mfma_f32_16x16x32_bf16 v[188:191], a[188:191], v[124:127], v[188:191]
    s_waitcnt vmcnt(8)
    s_barrier
    v_sub_f32 v142, v142, v55
    v_sub_f32 v143, v143, v55
    v_cvt_pk_bf16_f32 v203, v238, v239
    v_exp_f32 v241, v141
    v_exp_f32 v242, v142
    v_sub_f32 v156, v156, v55
    v_sub_f32 v157, v157, v55
    ds_read_b128 a[200:203], v3 offset:2048
    v_cvt_pk_bf16_f32 v204, v240, v241
    v_exp_f32 v243, v143
    v_or3_b32 v57, v57, v203, v204
    v_exp_f32 v244, v156
    v_sub_f32 v158, v158, v55
    v_sub_f32 v159, v159, v55
    v_cvt_pk_bf16_f32 v205, v242, v243
    v_exp_f32 v245, v157
    v_exp_f32 v246, v158
    v_cvt_pk_bf16_f32 v206, v244, v245
    ds_read_b128 a[204:207], v3 offset:3072
    v_exp_f32 v247, v159
    v_or3_b32 v57, v57, v205, v206
    v_cvt_pk_bf16_f32 v207, v246, v247
    v_bitop3_b32 v57, v57, v207, s37 bitop3:0xa8
    v_cmp_ne_u32 vcc, 0, v57
    s_cbranch_vccnz k2_tramp_80
k2_ret_81:
    s_mov_b32 s24, s60
    s_and_b32 s25, s61, 0xffff
    s_mov_b32 s26, s55
    s_lshl_b32 s63, s29, 1
    s_sub_u32 s63, s63, 1
    s_cbranch_scc1 k2_dm3_83
k2_dloop_82:
    v_mfma_f32_16x16x32_bf16 v[12:15], v[60:63], v[192:195], v[12:15]
    v_exp_f32 v232, v160
    v_mfma_f32_16x16x32_bf16 v[48:51], v[60:63], v[196:199], v[48:51]
    s_mov_b32 m0, s34
    ds_read_b128 a[208:211], v3 offset:4096
    v_mfma_f32_16x16x32_bf16 v[248:251], v[60:63], v[200:203], v[248:251]
    s_add_u32 s53, s53, 8192
    buffer_load_dwordx4 v1, s[16:19], s32 offen offset:0 sc1 lds
    v_mfma_f32_16x16x32_bf16 v[252:255], v[60:63], v[204:207], v[252:255]
    s_waitcnt lgkmcnt(3)
    v_exp_f32 v233, v161
    v_mfma_f32_16x16x32_bf16 a[0:3], a[192:195], v[192:195], a[0:3]
    s_and_b32 s53, s53, 0xffff
    v_exp_f32 v234, v162
    v_mfma_f32_16x16x32_bf16 a[4:7], a[192:195], v[196:199], a[4:7]
    s_add_u32 s34, s34, 0x4000
    ds_read_b128 a[212:215], v3 offset:5120
    v_cvt_pk_bf16_f32 v208, v232, v233
    v_mfma_f32_16x16x32_bf16 a[8:11], a[192:195], v[200:203], a[8:11]
    v_exp_f32 v235, v163
    v_mfma_f32_16x16x32_bf16 a[12:15], a[192:195], v[204:207], a[12:15]
    buffer_load_dwordx4 v1, s[16:19], s32 offen offset:1024 sc1 lds
    v_mfma_f32_16x16x32_bf16 a[16:19], a[196:199], v[192:195], a[16:19]
    v_exp_f32 v236, v176
    v_mfma_f32_16x16x32_bf16 a[20:23], a[196:199], v[196:199], a[20:23]
    ds_read_b128 a[216:219], v3 offset:6144
    v_cvt_pk_bf16_f32 v209, v234, v235
    v_mfma_f32_16x16x32_bf16 a[24:27], a[196:199], v[200:203], a[24:27]
    v_exp_f32 v237, v177
    v_mfma_f32_16x16x32_bf16 a[28:31], a[196:199], v[204:207], a[28:31]
    s_waitcnt lgkmcnt(3)
    v_exp_f32 v238, v178
    v_mfma_f32_16x16x32_bf16 a[32:35], a[200:203], v[192:195], a[32:35]
    s_and_b32 s34, s34, 0xffff
    ds_read_b128 a[220:223], v3 offset:7168
    v_cvt_pk_bf16_f32 v210, v236, v237
    v_mfma_f32_16x16x32_bf16 a[36:39], a[200:203], v[196:199], a[36:39]
    s_and_b32 s60, s62, 31
    buffer_load_dwordx4 v1, s[16:19], s32 offen offset:2048 sc1 lds
    v_mfma_f32_16x16x32_bf16 a[40:43], a[200:203], v[200:203], a[40:43]
    v_exp_f32 v239, v179
    v_mfma_f32_16x16x32_bf16 a[44:47], a[200:203], v[204:207], a[44:47]
    s_lshr_b32 s61, s62, 5
    v_or3_b32 v57, v208, v209, v210
    v_add_u32 v3, s53, v56
    v_mfma_f32_16x16x32_bf16 a[48:51], a[204:207], v[192:195], a[48:51]
    v_exp_f32 v240, v164
    v_mfma_f32_16x16x32_bf16 a[52:55], a[204:207], v[196:199], a[52:55]
    ds_read_b128 a[128:131], v2 offset:0
    v_cvt_pk_bf16_f32 v211, v238, v239
    v_mfma_f32_16x16x32_bf16 a[56:59], a[204:207], v[200:203], a[56:59]
    s_mul_i32 s57, s60, 229376
    v_exp_f32 v241, v165
    v_mfma_f32_16x16x32_bf16 a[60:63], a[204:207], v[204:207], a[60:63]
    s_waitcnt lgkmcnt(3)
    buffer_load_dwordx4 v1, s[16:19], s32 offen offset:3072 sc1 lds
    v_mfma_f32_16x16x32_bf16 a[64:67], a[208:211], v[192:195], a[64:67]
    s_add_u32 s32, s32, 0x80000
    v_exp_f32 v242, v166
    v_mfma_f32_16x16x32_bf16 a[68:71], a[208:211], v[196:199], a[68:71]
    s_lshl_b32 s4, s61, 7
    ds_read_b128 a[132:135], v2 offset:1024
    v_cvt_pk_bf16_f32 v212, v240, v241
    v_mfma_f32_16x16x32_bf16 a[72:75], a[208:211], v[200:203], a[72:75]
    v_exp_f32 v243, v167
    v_mfma_f32_16x16x32_bf16 a[76:79], a[208:211], v[204:207], a[76:79]
    s_add_u32 s57, s57, s4
    v_or3_b32 v57, v57, v211, v212
    v_cvt_pk_bf16_f32 v213, v242, v243
    v_mfma_f32_16x16x32_bf16 a[80:83], a[212:215], v[192:195], a[80:83]
    s_waitcnt vmcnt(8)
    v_exp_f32 v244, v180
    v_mfma_f32_16x16x32_bf16 a[84:87], a[212:215], v[196:199], a[84:87]
    buffer_store_dwordx4 a[224:227], v229, s[8:11], s58 offen offset:0 sc1
    ds_read_b128 a[136:139], v2 offset:2048
    v_mfma_f32_16x16x32_bf16 a[88:91], a[212:215], v[200:203], a[88:91]
    s_add_u32 s56, s57, 57344
    v_exp_f32 v245, v181
    v_mfma_f32_16x16x32_bf16 a[92:95], a[212:215], v[204:207], a[92:95]
    s_waitcnt lgkmcnt(3)
    v_exp_f32 v246, v182
    v_mfma_f32_16x16x32_bf16 a[96:99], a[216:219], v[192:195], a[96:99]
    ds_read_b128 a[140:143], v2 offset:3072
    v_cvt_pk_bf16_f32 v214, v244, v245
    v_mfma_f32_16x16x32_bf16 a[100:103], a[216:219], v[196:199], a[100:103]
    s_add_u32 s62, s62, 1
    v_exp_f32 v247, v183
    v_mfma_f32_16x16x32_bf16 a[104:107], a[216:219], v[200:203], a[104:107]
    v_or3_b32 v57, v57, v213, v214
    v_mfma_f32_16x16x32_bf16 a[108:111], a[216:219], v[204:207], a[108:111]
    v_exp_f32 v232, v168
    v_mfma_f32_16x16x32_bf16 a[112:115], a[220:223], v[192:195], a[112:115]
    ds_read_b128 a[144:147], v2 offset:4096
    v_cvt_pk_bf16_f32 v215, v246, v247
    v_mfma_f32_16x16x32_bf16 a[116:119], a[220:223], v[196:199], a[116:119]
    buffer_store_dwordx4 a[228:231], v229, s[8:11], s58 offen offset:256 sc1
    v_mfma_f32_16x16x32_bf16 a[120:123], a[220:223], v[200:203], a[120:123]
    v_exp_f32 v233, v169
    v_mfma_f32_16x16x32_bf16 a[124:127], a[220:223], v[204:207], a[124:127]
    s_waitcnt lgkmcnt(3)
    v_exp_f32 v234, v170
    v_mfma_f32_16x16x32_bf16 v[128:131], a[128:131], v[64:67], v[16:19]
    ds_read_b128 a[148:151], v2 offset:5120
    v_cvt_pk_bf16_f32 v216, v232, v233
    v_mfma_f32_16x16x32_bf16 v[132:135], a[128:131], v[80:83], v[20:23]
    v_exp_f32 v235, v171
    v_mfma_f32_16x16x32_bf16 v[136:139], a[128:131], v[96:99], v[24:27]
    v_or3_b32 v57, v57, v215, v216
    v_mfma_f32_16x16x32_bf16 v[140:143], a[128:131], v[112:115], v[28:31]
    s_add_u32 s36, s36, 32
    v_exp_f32 v236, v184
    v_mfma_f32_16x16x32_bf16 v[128:131], a[132:135], v[68:71], v[128:131]
    ds_read_b128 a[152:155], v2 offset:6144
    v_cvt_pk_bf16_f32 v217, v234, v235
    v_mfma_f32_16x16x32_bf16 v[132:135], a[132:135], v[84:87], v[132:135]
    s_lshl_b32 s58, s61, 17
    buffer_load_dwordx4 a[224:227], v228, s[12:15], s57 offen
    v_mfma_f32_16x16x32_bf16 v[136:139], a[132:135], v[100:103], v[136:139]
    s_add_u32 s52, s52, 8192
    v_exp_f32 v237, v185
    v_mfma_f32_16x16x32_bf16 v[140:143], a[132:135], v[116:119], v[140:143]
    s_waitcnt lgkmcnt(3)
    v_exp_f32 v238, v186
    v_mfma_f32_16x16x32_bf16 v[128:131], a[136:139], v[72:75], v[128:131]
    s_lshl_b32 s60, s60, 10
    ds_read_b128 a[156:159], v2 offset:7168
    v_cvt_pk_bf16_f32 v218, v236, v237
    v_mfma_f32_16x16x32_bf16 v[132:135], a[136:139], v[88:91], v[132:135]
    s_and_b32 s52, s52, 0xffff
    v_exp_f32 v239, v187
    v_mfma_f32_16x16x32_bf16 v[136:139], a[136:139], v[104:107], v[136:139]
    v_or3_b32 v57, v57, v217, v218
    v_mfma_f32_16x16x32_bf16 v[140:143], a[136:139], v[120:123], v[140:143]
    v_add_u32 v2, s52, v1
    v_cvt_pk_bf16_f32 v219, v238, v239
    v_mfma_f32_16x16x32_bf16 v[128:131], a[140:143], v[76:79], v[128:131]
    s_add_u32 s58, s58, s60
    v_exp_f32 v240, v172
    v_mfma_f32_16x16x32_bf16 v[132:135], a[140:143], v[92:95], v[132:135]
    buffer_load_dwordx4 a[228:231], v228, s[12:15], s56 offen
    v_mfma_f32_16x16x32_bf16 v[136:139], a[140:143], v[108:111], v[136:139]
    v_exp_f32 v241, v173
    v_mfma_f32_16x16x32_bf16 v[140:143], a[140:143], v[124:127], v[140:143]
    s_waitcnt lgkmcnt(2)
    ds_read_b128 a[192:195], v3 offset:0
    v_cvt_pk_bf16_f32 v220, v240, v241
    v_mfma_f32_16x16x32_bf16 v[144:147], a[144:147], v[64:67], v[32:35]
    s_mov_b32 s10, s59
    v_exp_f32 v242, v174
    v_mfma_f32_16x16x32_bf16 v[148:151], a[144:147], v[80:83], v[36:39]
    v_exp_f32 v243, v175
    v_mfma_f32_16x16x32_bf16 v[152:155], a[144:147], v[96:99], v[40:43]
    ds_read_b128 a[196:199], v3 offset:1024
    v_or3_b32 v57, v57, v219, v220
    v_mfma_f32_16x16x32_bf16 v[156:159], a[144:147], v[112:115], v[44:47]
    v_exp_f32 v244, v188
    v_mfma_f32_16x16x32_bf16 v[144:147], a[148:151], v[68:71], v[144:147]
    v_cvt_pk_bf16_f32 v221, v242, v243
    v_mfma_f32_16x16x32_bf16 v[148:151], a[148:151], v[84:87], v[148:151]
    buffer_load_dword v7, v230, s[24:27], s54 offen
    v_mfma_f32_16x16x32_bf16 v[152:155], a[148:151], v[100:103], v[152:155]
    v_exp_f32 v245, v189
    v_mfma_f32_16x16x32_bf16 v[156:159], a[148:151], v[116:119], v[156:159]
    s_waitcnt lgkmcnt(2)
    ds_read_b128 a[200:203], v3 offset:2048
    v_cvt_pk_bf16_f32 v222, v244, v245
    v_mfma_f32_16x16x32_bf16 v[144:147], a[152:155], v[72:75], v[144:147]
    v_exp_f32 v246, v190
    v_mfma_f32_16x16x32_bf16 v[148:151], a[152:155], v[88:91], v[148:151]
    v_exp_f32 v247, v191
    v_mfma_f32_16x16x32_bf16 v[152:155], a[152:155], v[104:107], v[152:155]
    ds_read_b128 a[204:207], v3 offset:3072
    v_or3_b32 v57, v57, v221, v222
    v_mfma_f32_16x16x32_bf16 v[156:159], a[152:155], v[120:123], v[156:159]
    v_cvt_pk_bf16_f32 v223, v246, v247
    v_mfma_f32_16x16x32_bf16 v[144:147], a[156:159], v[76:79], v[144:147]
    s_add_u32 s54, s54, 4096
    v_mfma_f32_16x16x32_bf16 v[148:151], a[156:159], v[92:95], v[148:151]
    v_bitop3_b32 v57, v57, v223, s37 bitop3:0xa8
    v_cmp_ne_u32 vcc, 0, v57
    v_mfma_f32_16x16x32_bf16 v[152:155], a[156:159], v[108:111], v[152:155]
    v_mfma_f32_16x16x32_bf16 v[156:159], a[156:159], v[124:127], v[156:159]
    s_cbranch_vccnz k2_tramp_84
k2_ret_85:
    v_mfma_f32_16x16x32_bf16 v[12:15], v[60:63], v[208:211], v[12:15]
    v_exp_f32 v232, v128
    v_mfma_f32_16x16x32_bf16 v[48:51], v[60:63], v[212:215], v[48:51]
    s_mov_b32 m0, s35
    ds_read_b128 a[208:211], v3 offset:4096
    v_mfma_f32_16x16x32_bf16 v[248:251], v[60:63], v[216:219], v[248:251]
    s_add_u32 s53, s53, 8192
    buffer_load_dwordx4 v1, s[20:23], s33 offen offset:0 sc1 lds
    v_mfma_f32_16x16x32_bf16 v[252:255], v[60:63], v[220:223], v[252:255]
    s_waitcnt lgkmcnt(3)
    v_exp_f32 v233, v129
    v_mfma_f32_16x16x32_bf16 a[0:3], a[192:195], v[208:211], a[0:3]
    s_and_b32 s53, s53, 0xffff
    v_exp_f32 v234, v130
    v_mfma_f32_16x16x32_bf16 a[4:7], a[192:195], v[212:215], a[4:7]
    ds_read_b128 a[212:215], v3 offset:5120
    v_cvt_pk_bf16_f32 v192, v232, v233
    v_mfma_f32_16x16x32_bf16 a[8:11], a[192:195], v[216:219], a[8:11]
    v_exp_f32 v235, v131
    v_mfma_f32_16x16x32_bf16 a[12:15], a[192:195], v[220:223], a[12:15]
    v_exp_f32 v236, v144
    v_mfma_f32_16x16x32_bf16 a[16:19], a[196:199], v[208:211], a[16:19]
    ds_read_b128 a[216:219], v3 offset:6144
    v_cvt_pk_bf16_f32 v193, v234, v235
    v_mfma_f32_16x16x32_bf16 a[20:23], a[196:199], v[212:215], a[20:23]
    v_exp_f32 v237, v145
    v_mfma_f32_16x16x32_bf16 a[24:27], a[196:199], v[216:219], a[24:27]
    v_mfma_f32_16x16x32_bf16 a[28:31], a[196:199], v[220:223], a[28:31]
    s_waitcnt lgkmcnt(3)
    v_exp_f32 v238, v146
    v_mfma_f32_16x16x32_bf16 a[32:35], a[200:203], v[208:211], a[32:35]
    ds_read_b128 a[220:223], v3 offset:7168
    v_cvt_pk_bf16_f32 v194, v236, v237
    v_mfma_f32_16x16x32_bf16 a[36:39], a[200:203], v[212:215], a[36:39]
    v_exp_f32 v239, v147
    v_mfma_f32_16x16x32_bf16 a[40:43], a[200:203], v[216:219], a[40:43]
    v_or3_b32 v57, v192, v193, v194
    v_mfma_f32_16x16x32_bf16 a[44:47], a[200:203], v[220:223], a[44:47]
    s_add_u32 s35, s35, 0x4000
    v_add_u32 v3, s53, v56
    v_cvt_pk_bf16_f32 v195, v238, v239
    v_mfma_f32_16x16x32_bf16 a[48:51], a[204:207], v[208:211], a[48:51]
    v_exp_f32 v240, v132
    v_mfma_f32_16x16x32_bf16 a[52:55], a[204:207], v[212:215], a[52:55]
    buffer_load_dwordx4 v1, s[20:23], s33 offen offset:1024 sc1 lds
    ds_read_b128 a[128:131], v2 offset:0
    v_mfma_f32_16x16x32_bf16 a[56:59], a[204:207], v[216:219], a[56:59]
    v_exp_f32 v241, v133
    v_mfma_f32_16x16x32_bf16 a[60:63], a[204:207], v[220:223], a[60:63]
    s_waitcnt lgkmcnt(3)
    v_exp_f32 v242, v134
    v_mfma_f32_16x16x32_bf16 a[64:67], a[208:211], v[208:211], a[64:67]
    ds_read_b128 a[132:135], v2 offset:1024
    v_cvt_pk_bf16_f32 v196, v240, v241
    v_mfma_f32_16x16x32_bf16 a[68:71], a[208:211], v[212:215], a[68:71]
    v_exp_f32 v243, v135
    v_mfma_f32_16x16x32_bf16 a[72:75], a[208:211], v[216:219], a[72:75]
    v_or3_b32 v57, v57, v195, v196
    v_mfma_f32_16x16x32_bf16 a[76:79], a[208:211], v[220:223], a[76:79]
    v_exp_f32 v244, v148
    v_mfma_f32_16x16x32_bf16 a[80:83], a[212:215], v[208:211], a[80:83]
    ds_read_b128 a[136:139], v2 offset:2048
    v_cvt_pk_bf16_f32 v197, v242, v243
    v_mfma_f32_16x16x32_bf16 a[84:87], a[212:215], v[212:215], a[84:87]
    v_exp_f32 v245, v149
    v_mfma_f32_16x16x32_bf16 a[88:91], a[212:215], v[216:219], a[88:91]
    v_mfma_f32_16x16x32_bf16 a[92:95], a[212:215], v[220:223], a[92:95]
    s_waitcnt lgkmcnt(3)
    v_exp_f32 v246, v150
    v_mfma_f32_16x16x32_bf16 a[96:99], a[216:219], v[208:211], a[96:99]
    ds_read_b128 a[140:143], v2 offset:3072
    v_cvt_pk_bf16_f32 v198, v244, v245
    v_mfma_f32_16x16x32_bf16 a[100:103], a[216:219], v[212:215], a[100:103]
    v_exp_f32 v247, v151
    v_mfma_f32_16x16x32_bf16 a[104:107], a[216:219], v[216:219], a[104:107]
    v_or3_b32 v57, v57, v197, v198
    v_mfma_f32_16x16x32_bf16 a[108:111], a[216:219], v[220:223], a[108:111]
    s_and_b32 s35, s35, 0xffff
    v_exp_f32 v232, v136
    v_mfma_f32_16x16x32_bf16 a[112:115], a[220:223], v[208:211], a[112:115]
    ds_read_b128 a[144:147], v2 offset:4096
    v_cvt_pk_bf16_f32 v199, v246, v247
    v_mfma_f32_16x16x32_bf16 a[116:119], a[220:223], v[212:215], a[116:119]
    buffer_load_dwordx4 v1, s[20:23], s33 offen offset:2048 sc1 lds
    v_mfma_f32_16x16x32_bf16 a[120:123], a[220:223], v[216:219], a[120:123]
    v_exp_f32 v233, v137
    v_mfma_f32_16x16x32_bf16 a[124:127], a[220:223], v[220:223], a[124:127]
    s_waitcnt lgkmcnt(3)
    v_exp_f32 v234, v138
    v_mfma_f32_16x16x32_bf16 v[160:163], a[128:131], v[64:67], v[16:19]
    ds_read_b128 a[148:151], v2 offset:5120
    v_cvt_pk_bf16_f32 v200, v232, v233
    v_mfma_f32_16x16x32_bf16 v[164:167], a[128:131], v[80:83], v[20:23]
    v_exp_f32 v235, v139
    v_mfma_f32_16x16x32_bf16 v[168:171], a[128:131], v[96:99], v[24:27]
    v_or3_b32 v57, v57, v199, v200
    v_mfma_f32_16x16x32_bf16 v[172:175], a[128:131], v[112:115], v[28:31]
    s_or_b32 s35, s35, 0x10000
    v_exp_f32 v236, v152
    v_mfma_f32_16x16x32_bf16 v[160:163], a[132:135], v[68:71], v[160:163]
    s_add_u32 s36, s36, 32
    ds_read_b128 a[152:155], v2 offset:6144
    v_cvt_pk_bf16_f32 v201, v234, v235
    v_mfma_f32_16x16x32_bf16 v[164:167], a[132:135], v[84:87], v[164:167]
    v_exp_f32 v237, v153
    v_mfma_f32_16x16x32_bf16 v[168:171], a[132:135], v[100:103], v[168:171]
    s_add_u32 s52, s52, 8192
    v_mfma_f32_16x16x32_bf16 v[172:175], a[132:135], v[116:119], v[172:175]
    s_waitcnt lgkmcnt(3)
    v_exp_f32 v238, v154
    v_mfma_f32_16x16x32_bf16 v[160:163], a[136:139], v[72:75], v[160:163]
    s_and_b32 s52, s52, 0xffff
    ds_read_b128 a[156:159], v2 offset:7168
    v_cvt_pk_bf16_f32 v202, v236, v237
    v_mfma_f32_16x16x32_bf16 v[164:167], a[136:139], v[88:91], v[164:167]
    v_exp_f32 v239, v155
    v_mfma_f32_16x16x32_bf16 v[168:171], a[136:139], v[104:107], v[168:171]
    v_or3_b32 v57, v57, v201, v202
    v_mfma_f32_16x16x32_bf16 v[172:175], a[136:139], v[120:123], v[172:175]
    v_add_u32 v2, s52, v1
    v_cvt_pk_bf16_f32 v203, v238, v239
    v_mfma_f32_16x16x32_bf16 v[160:163], a[140:143], v[76:79], v[160:163]
    v_exp_f32 v240, v140
    v_mfma_f32_16x16x32_bf16 v[164:167], a[140:143], v[92:95], v[164:167]
    buffer_load_dwordx4 v1, s[20:23], s33 offen offset:3072 sc1 lds
    v_mfma_f32_16x16x32_bf16 v[168:171], a[140:143], v[108:111], v[168:171]
    s_add_u32 s33, s33, 0x80000
    v_exp_f32 v241, v141
    v_mfma_f32_16x16x32_bf16 v[172:175], a[140:143], v[124:127], v[172:175]
    s_waitcnt lgkmcnt(2)
    ds_read_b128 a[192:195], v3 offset:0
    v_cvt_pk_bf16_f32 v204, v240, v241
    v_mfma_f32_16x16x32_bf16 v[176:179], a[144:147], v[64:67], v[32:35]
    v_exp_f32 v242, v142
    v_mfma_f32_16x16x32_bf16 v[180:183], a[144:147], v[80:83], v[36:39]
    v_exp_f32 v243, v143
    v_mfma_f32_16x16x32_bf16 v[184:187], a[144:147], v[96:99], v[40:43]
    ds_read_b128 a[196:199], v3 offset:1024
    v_or3_b32 v57, v57, v203, v204
    v_mfma_f32_16x16x32_bf16 v[188:191], a[144:147], v[112:115], v[44:47]
    v_exp_f32 v244, v156
    v_mfma_f32_16x16x32_bf16 v[176:179], a[148:151], v[68:71], v[176:179]
    v_cvt_pk_bf16_f32 v205, v242, v243
    v_mfma_f32_16x16x32_bf16 v[180:183], a[148:151], v[84:87], v[180:183]
    v_exp_f32 v245, v157
    v_mfma_f32_16x16x32_bf16 v[184:187], a[148:151], v[100:103], v[184:187]
    ds_read_b128 a[200:203], v3 offset:2048
    v_mfma_f32_16x16x32_bf16 v[188:191], a[148:151], v[116:119], v[188:191]
    s_waitcnt lgkmcnt(3)
    v_exp_f32 v246, v158
    v_mfma_f32_16x16x32_bf16 v[176:179], a[152:155], v[72:75], v[176:179]
    s_sub_u32 s63, s63, 1
    v_cvt_pk_bf16_f32 v206, v244, v245
    v_mfma_f32_16x16x32_bf16 v[180:183], a[152:155], v[88:91], v[180:183]
    v_exp_f32 v247, v159
    v_mfma_f32_16x16x32_bf16 v[184:187], a[152:155], v[104:107], v[184:187]
    ds_read_b128 a[204:207], v3 offset:3072
    v_or3_b32 v57, v57, v205, v206
    v_mfma_f32_16x16x32_bf16 v[188:191], a[152:155], v[120:123], v[188:191]
    v_cvt_pk_bf16_f32 v207, v246, v247
    v_mfma_f32_16x16x32_bf16 v[176:179], a[156:159], v[76:79], v[176:179]
    v_mfma_f32_16x16x32_bf16 v[180:183], a[156:159], v[92:95], v[180:183]
    v_bitop3_b32 v57, v57, v207, s37 bitop3:0xa8
    v_cmp_ne_u32 vcc, 0, v57
    v_mfma_f32_16x16x32_bf16 v[184:187], a[156:159], v[108:111], v[184:187]
    v_mfma_f32_16x16x32_bf16 v[188:191], a[156:159], v[124:127], v[188:191]
    s_waitcnt vmcnt(13)
    s_barrier
    s_cbranch_vccnz k2_tramp_86
k2_ret_87:
    s_cmp_lg_u32 s63, 0
    s_cbranch_scc1 k2_dloop_82
    v_mfma_f32_16x16x32_bf16 v[12:15], v[60:63], v[192:195], v[12:15]
    v_exp_f32 v232, v160
    v_mfma_f32_16x16x32_bf16 v[48:51], v[60:63], v[196:199], v[48:51]
    s_mov_b32 m0, s34
    ds_read_b128 a[208:211], v3 offset:4096
    v_mfma_f32_16x16x32_bf16 v[248:251], v[60:63], v[200:203], v[248:251]
    s_add_u32 s53, s53, 8192
    buffer_load_dwordx4 v1, s[16:19], s32 offen offset:0 sc1 lds
    v_mfma_f32_16x16x32_bf16 v[252:255], v[60:63], v[204:207], v[252:255]
    s_waitcnt lgkmcnt(3)
    v_exp_f32 v233, v161
    v_mfma_f32_16x16x32_bf16 a[0:3], a[192:195], v[192:195], a[0:3]
    s_sub_u32 s40, s36, s38
    v_exp_f32 v234, v162
    v_mfma_f32_16x16x32_bf16 a[4:7], a[192:195], v[196:199], a[4:7]
    s_and_b32 s53, s53, 0xffff
    ds_read_b128 a[212:215], v3 offset:5120
    v_cvt_pk_bf16_f32 v208, v232, v233
    v_mfma_f32_16x16x32_bf16 a[8:11], a[192:195], v[200:203], a[8:11]
    s_add_u32 s34, s34, 0x4000
    v_subrev_u32 v6, s40, v4
    v_cmp_gt_i32 s[44:45], 0, v6
    v_mfma_f32_16x16x32_bf16 a[12:15], a[192:195], v[204:207], a[12:15]
    v_exp_f32 v235, v163
    v_mfma_f32_16x16x32_bf16 a[16:19], a[196:199], v[192:195], a[16:19]
    buffer_load_dwordx4 v1, s[16:19], s32 offen offset:1024 sc1 lds
    ds_read_b128 a[216:219], v3 offset:6144
    v_mfma_f32_16x16x32_bf16 a[20:23], a[196:199], v[196:199], a[20:23]
    v_exp_f32 v236, v176
    v_mfma_f32_16x16x32_bf16 a[24:27], a[196:199], v[200:203], a[24:27]
    v_cmp_gt_i32 s[46:47], 1, v6
    v_cvt_pk_bf16_f32 v209, v234, v235
    v_mfma_f32_16x16x32_bf16 a[28:31], a[196:199], v[204:207], a[28:31]
    s_waitcnt lgkmcnt(3)
    v_cmp_gt_i32 s[48:49], 2, v6
    v_cmp_gt_i32 s[50:51], 3, v6
    v_mfma_f32_16x16x32_bf16 a[32:35], a[200:203], v[192:195], a[32:35]
    s_and_b32 s34, s34, 0xffff
    v_exp_f32 v237, v177
    v_mfma_f32_16x16x32_bf16 a[36:39], a[200:203], v[196:199], a[36:39]
    s_and_b32 s60, s62, 31
    v_exp_f32 v238, v178
    v_mfma_f32_16x16x32_bf16 a[40:43], a[200:203], v[200:203], a[40:43]
    ds_read_b128 a[220:223], v3 offset:7168
    v_cvt_pk_bf16_f32 v210, v236, v237
    v_mfma_f32_16x16x32_bf16 a[44:47], a[200:203], v[204:207], a[44:47]
    s_lshr_b32 s61, s62, 5
    buffer_load_dwordx4 v1, s[16:19], s32 offen offset:2048 sc1 lds
    v_mfma_f32_16x16x32_bf16 a[48:51], a[204:207], v[192:195], a[48:51]
    v_cndmask_b32 v16, v8, v5, s[44:45]
    v_or3_b32 v57, v208, v209, v210
    v_mfma_f32_16x16x32_bf16 a[52:55], a[204:207], v[196:199], a[52:55]
    v_exp_f32 v239, v179
    v_mfma_f32_16x16x32_bf16 a[56:59], a[204:207], v[200:203], a[56:59]
    s_mul_i32 s57, s60, 229376
    v_cndmask_b32 v17, v8, v5, s[46:47]
    v_add_u32 v3, s53, v56
    v_mfma_f32_16x16x32_bf16 a[60:63], a[204:207], v[204:207], a[60:63]
    s_waitcnt lgkmcnt(2)
    v_exp_f32 v240, v164
    v_mfma_f32_16x16x32_bf16 a[64:67], a[208:211], v[192:195], a[64:67]
    v_cvt_pk_bf16_f32 v211, v238, v239
    v_cndmask_b32 v18, v8, v5, s[48:49]
    v_mfma_f32_16x16x32_bf16 a[68:71], a[208:211], v[196:199], a[68:71]
    s_lshl_b32 s4, s61, 7
    ds_read_b128 a[128:131], v2 offset:0
    v_cndmask_b32 v19, v8, v5, s[50:51]
    v_mfma_f32_16x16x32_bf16 a[72:75], a[208:211], v[200:203], a[72:75]
    v_exp_f32 v241, v165
    v_mfma_f32_16x16x32_bf16 a[76:79], a[208:211], v[204:207], a[76:79]
    s_add_u32 s57, s57, s4
    buffer_load_dwordx4 v1, s[16:19], s32 offen offset:3072 sc1 lds
    s_add_u32 s32, s32, 0x80000
    v_mfma_f32_16x16x32_bf16 a[80:83], a[212:215], v[192:195], a[80:83]
    s_waitcnt vmcnt(8)
    v_cmp_gt_i32 s[44:45], 16, v6
    v_exp_f32 v242, v166
    v_mfma_f32_16x16x32_bf16 a[84:87], a[212:215], v[196:199], a[84:87]
    ds_read_b128 a[132:135], v2 offset:1024
    v_cvt_pk_bf16_f32 v212, v240, v241
    v_mfma_f32_16x16x32_bf16 a[88:91], a[212:215], v[200:203], a[88:91]
    s_add_u32 s56, s57, 57344
    v_cmp_gt_i32 s[46:47], 17, v6
    v_exp_f32 v243, v167
    v_mfma_f32_16x16x32_bf16 a[92:95], a[212:215], v[204:207], a[92:95]
    s_waitcnt lgkmcnt(2)
    v_or3_b32 v57, v57, v211, v212
    v_cmp_gt_i32 s[48:49], 18, v6
    v_mfma_f32_16x16x32_bf16 a[96:99], a[216:219], v[192:195], a[96:99]
    v_exp_f32 v244, v180
    v_mfma_f32_16x16x32_bf16 a[100:103], a[216:219], v[196:199], a[100:103]
    s_add_u32 s62, s62, 1
    v_cvt_pk_bf16_f32 v213, v242, v243
    v_cmp_gt_i32 s[50:51], 19, v6
    v_mfma_f32_16x16x32_bf16 a[104:107], a[216:219], v[200:203], a[104:107]
    buffer_store_dwordx4 a[224:227], v229, s[8:11], s58 offen offset:0 sc1
    ds_read_b128 a[136:139], v2 offset:2048
    v_mfma_f32_16x16x32_bf16 a[108:111], a[216:219], v[204:207], a[108:111]
    v_exp_f32 v245, v181
    v_mfma_f32_16x16x32_bf16 a[112:115], a[220:223], v[192:195], a[112:115]
    v_cndmask_b32 v32, v8, v5, s[44:45]
    v_exp_f32 v246, v182
    v_mfma_f32_16x16x32_bf16 a[116:119], a[220:223], v[196:199], a[116:119]
    ds_read_b128 a[140:143], v2 offset:3072
    v_cndmask_b32 v33, v8, v5, s[46:47]
    v_cvt_pk_bf16_f32 v214, v244, v245
    v_cndmask_b32 v34, v8, v5, s[48:49]
    v_cndmask_b32 v35, v8, v5, s[50:51]
    v_mfma_f32_16x16x32_bf16 a[120:123], a[220:223], v[200:203], a[120:123]
    v_exp_f32 v247, v183
    v_mfma_f32_16x16x32_bf16 a[124:127], a[220:223], v[204:207], a[124:127]
    s_waitcnt lgkmcnt(2)
    v_or3_b32 v57, v57, v213, v214
    v_cvt_pk_bf16_f32 v215, v246, v247
    v_mfma_f32_16x16x32_bf16 v[128:131], a[128:131], v[64:67], v[16:19]
    v_exp_f32 v232, v168
    v_mfma_f32_16x16x32_bf16 v[132:135], a[128:131], v[80:83], v[20:23]
    buffer_store_dwordx4 a[228:231], v229, s[8:11], s58 offen offset:256 sc1
    ds_read_b128 a[144:147], v2 offset:4096
    v_mfma_f32_16x16x32_bf16 v[136:139], a[128:131], v[96:99], v[24:27]
    v_exp_f32 v233, v169
    v_mfma_f32_16x16x32_bf16 v[140:143], a[128:131], v[112:115], v[28:31]
    s_add_u32 s36, s36, 32
    v_exp_f32 v234, v170
    v_mfma_f32_16x16x32_bf16 v[128:131], a[132:135], v[68:71], v[128:131]
    ds_read_b128 a[148:151], v2 offset:5120
    v_cvt_pk_bf16_f32 v216, v232, v233
    v_mfma_f32_16x16x32_bf16 v[132:135], a[132:135], v[84:87], v[132:135]
    s_lshl_b32 s58, s61, 17
    v_exp_f32 v235, v171
    v_mfma_f32_16x16x32_bf16 v[136:139], a[132:135], v[100:103], v[136:139]
    s_add_u32 s52, s52, 8192
    v_or3_b32 v57, v57, v215, v216
    v_cvt_pk_bf16_f32 v217, v234, v235
    v_mfma_f32_16x16x32_bf16 v[140:143], a[132:135], v[116:119], v[140:143]
    s_waitcnt lgkmcnt(2)
    v_exp_f32 v236, v184
    v_mfma_f32_16x16x32_bf16 v[128:131], a[136:139], v[72:75], v[128:131]
    s_lshl_b32 s60, s60, 10
    buffer_load_dwordx4 a[224:227], v228, s[12:15], s57 offen
    ds_read_b128 a[152:155], v2 offset:6144
    v_mfma_f32_16x16x32_bf16 v[132:135], a[136:139], v[88:91], v[132:135]
    s_and_b32 s52, s52, 0xffff
    v_exp_f32 v237, v185
    v_mfma_f32_16x16x32_bf16 v[136:139], a[136:139], v[104:107], v[136:139]
    v_exp_f32 v238, v186
    v_mfma_f32_16x16x32_bf16 v[140:143], a[136:139], v[120:123], v[140:143]
    ds_read_b128 a[156:159], v2 offset:7168
    v_cvt_pk_bf16_f32 v218, v236, v237
    v_mfma_f32_16x16x32_bf16 v[128:131], a[140:143], v[76:79], v[128:131]
    s_add_u32 s58, s58, s60
    v_exp_f32 v239, v187
    v_mfma_f32_16x16x32_bf16 v[132:135], a[140:143], v[92:95], v[132:135]
    v_or3_b32 v57, v57, v217, v218
    v_add_u32 v2, s52, v1
    v_mfma_f32_16x16x32_bf16 v[136:139], a[140:143], v[108:111], v[136:139]
    v_exp_f32 v240, v172
    v_mfma_f32_16x16x32_bf16 v[140:143], a[140:143], v[124:127], v[140:143]
    s_waitcnt lgkmcnt(2)
    ds_read_b128 a[192:195], v3 offset:0
    v_cvt_pk_bf16_f32 v219, v238, v239
    v_mfma_f32_16x16x32_bf16 v[144:147], a[144:147], v[64:67], v[32:35]
    s_mov_b32 s10, s59
    buffer_load_dwordx4 a[228:231], v228, s[12:15], s56 offen
    v_mfma_f32_16x16x32_bf16 v[148:151], a[144:147], v[80:83], v[36:39]
    v_exp_f32 v241, v173
    v_mfma_f32_16x16x32_bf16 v[152:155], a[144:147], v[96:99], v[40:43]
    v_exp_f32 v242, v174
    v_mfma_f32_16x16x32_bf16 v[156:159], a[144:147], v[112:115], v[44:47]
    v_cvt_pk_bf16_f32 v220, v240, v241
    v_or3_b32 v57, v57, v219, v220
    v_mfma_f32_16x16x32_bf16 v[144:147], a[148:151], v[68:71], v[144:147]
    v_exp_f32 v243, v175
    v_mfma_f32_16x16x32_bf16 v[148:151], a[148:151], v[84:87], v[148:151]
    ds_read_b128 a[196:199], v3 offset:1024
    v_cvt_pk_bf16_f32 v221, v242, v243
    v_mfma_f32_16x16x32_bf16 v[152:155], a[148:151], v[100:103], v[152:155]
    v_exp_f32 v244, v188
    v_mfma_f32_16x16x32_bf16 v[156:159], a[148:151], v[116:119], v[156:159]
    s_waitcnt lgkmcnt(2)
    buffer_load_dword v7, v230, s[24:27], s54 offen
    ds_read_b128 a[200:203], v3 offset:2048
    v_mfma_f32_16x16x32_bf16 v[144:147], a[152:155], v[72:75], v[144:147]
    v_exp_f32 v245, v189
    v_mfma_f32_16x16x32_bf16 v[148:151], a[152:155], v[88:91], v[148:151]
    v_exp_f32 v246, v190
    v_mfma_f32_16x16x32_bf16 v[152:155], a[152:155], v[104:107], v[152:155]
    v_cvt_pk_bf16_f32 v222, v244, v245
    v_or3_b32 v57, v57, v221, v222
    v_mfma_f32_16x16x32_bf16 v[156:159], a[152:155], v[120:123], v[156:159]
    v_exp_f32 v247, v191
    v_mfma_f32_16x16x32_bf16 v[144:147], a[156:159], v[76:79], v[144:147]
    s_add_u32 s54, s54, 4096
    ds_read_b128 a[204:207], v3 offset:3072
    v_cvt_pk_bf16_f32 v223, v246, v247
    v_mfma_f32_16x16x32_bf16 v[148:151], a[156:159], v[92:95], v[148:151]
    v_bitop3_b32 v57, v57, v223, s37 bitop3:0xa8
    v_cmp_ne_u32 vcc, 0, v57
    v_mfma_f32_16x16x32_bf16 v[152:155], a[156:159], v[108:111], v[152:155]
    v_mfma_f32_16x16x32_bf16 v[156:159], a[156:159], v[124:127], v[156:159]
    s_cbranch_vccnz k2_tramp_88
k2_ret_89:
    v_mfma_f32_16x16x32_bf16 v[12:15], v[60:63], v[208:211], v[12:15]
    v_exp_f32 v232, v128
    v_mfma_f32_16x16x32_bf16 v[48:51], v[60:63], v[212:215], v[48:51]
    s_mov_b32 m0, s35
    ds_read_b128 a[208:211], v3 offset:4096
    v_mfma_f32_16x16x32_bf16 v[248:251], v[60:63], v[216:219], v[248:251]
    s_add_u32 s53, s53, 8192
    buffer_load_dwordx4 v1, s[20:23], s33 offen offset:0 sc1 lds
    v_mfma_f32_16x16x32_bf16 v[252:255], v[60:63], v[220:223], v[252:255]
    s_waitcnt lgkmcnt(3)
    v_exp_f32 v233, v129
    v_mfma_f32_16x16x32_bf16 a[0:3], a[192:195], v[208:211], a[0:3]
    s_sub_u32 s40, s36, s38
    v_exp_f32 v234, v130
    v_mfma_f32_16x16x32_bf16 a[4:7], a[192:195], v[212:215], a[4:7]
    s_and_b32 s53, s53, 0xffff
    ds_read_b128 a[212:215], v3 offset:5120
    v_cvt_pk_bf16_f32 v192, v232, v233
    v_mfma_f32_16x16x32_bf16 a[8:11], a[192:195], v[216:219], a[8:11]
    v_subrev_u32 v6, s40, v4
    v_cmp_gt_i32 s[44:45], 0, v6
    v_mfma_f32_16x16x32_bf16 a[12:15], a[192:195], v[220:223], a[12:15]
    v_exp_f32 v235, v131
    v_mfma_f32_16x16x32_bf16 a[16:19], a[196:199], v[208:211], a[16:19]
    v_exp_f32 v236, v144
    v_mfma_f32_16x16x32_bf16 a[20:23], a[196:199], v[212:215], a[20:23]
    v_cmp_gt_i32 s[46:47], 1, v6
    v_cvt_pk_bf16_f32 v193, v234, v235
    v_mfma_f32_16x16x32_bf16 a[24:27], a[196:199], v[216:219], a[24:27]
    ds_read_b128 a[216:219], v3 offset:6144
    v_cmp_gt_i32 s[48:49], 2, v6
    v_mfma_f32_16x16x32_bf16 a[28:31], a[196:199], v[220:223], a[28:31]
    s_waitcnt lgkmcnt(3)
    v_exp_f32 v237, v145
    v_mfma_f32_16x16x32_bf16 a[32:35], a[200:203], v[208:211], a[32:35]
    v_cmp_gt_i32 s[50:51], 3, v6
    v_cvt_pk_bf16_f32 v194, v236, v237
    v_mfma_f32_16x16x32_bf16 a[36:39], a[200:203], v[212:215], a[36:39]
    v_exp_f32 v238, v146
    v_mfma_f32_16x16x32_bf16 a[40:43], a[200:203], v[216:219], a[40:43]
    ds_read_b128 a[220:223], v3 offset:7168
    v_cndmask_b32 v16, v8, v5, s[44:45]
    v_mfma_f32_16x16x32_bf16 a[44:47], a[200:203], v[220:223], a[44:47]
    s_add_u32 s35, s35, 0x4000
    v_exp_f32 v239, v147
    v_mfma_f32_16x16x32_bf16 a[48:51], a[204:207], v[208:211], a[48:51]
    v_or3_b32 v57, v192, v193, v194
    v_cndmask_b32 v17, v8, v5, s[46:47]
    v_mfma_f32_16x16x32_bf16 a[52:55], a[204:207], v[212:215], a[52:55]
    v_add_u32 v3, s53, v56
    v_cvt_pk_bf16_f32 v195, v238, v239
    v_mfma_f32_16x16x32_bf16 a[56:59], a[204:207], v[216:219], a[56:59]
    v_exp_f32 v240, v132
    v_mfma_f32_16x16x32_bf16 a[60:63], a[204:207], v[220:223], a[60:63]
    s_waitcnt lgkmcnt(2)
    ds_read_b128 a[128:131], v2 offset:0
    v_cndmask_b32 v18, v8, v5, s[48:49]
    v_mfma_f32_16x16x32_bf16 a[64:67], a[208:211], v[208:211], a[64:67]
    buffer_load_dwordx4 v1, s[20:23], s33 offen offset:1024 sc1 lds
    ds_read_b128 a[132:135], v2 offset:1024
    v_mfma_f32_16x16x32_bf16 a[68:71], a[208:211], v[212:215], a[68:71]
    v_exp_f32 v241, v133
    v_mfma_f32_16x16x32_bf16 a[72:75], a[208:211], v[216:219], a[72:75]
    v_cndmask_b32 v19, v8, v5, s[50:51]
    v_cmp_gt_i32 s[44:45], 16, v6
    v_mfma_f32_16x16x32_bf16 a[76:79], a[208:211], v[220:223], a[76:79]
    v_exp_f32 v242, v134
    v_mfma_f32_16x16x32_bf16 a[80:83], a[212:215], v[208:211], a[80:83]
    v_cvt_pk_bf16_f32 v196, v240, v241
    v_cmp_gt_i32 s[46:47], 17, v6
    v_mfma_f32_16x16x32_bf16 a[84:87], a[212:215], v[212:215], a[84:87]
    v_exp_f32 v243, v135
    v_mfma_f32_16x16x32_bf16 a[88:91], a[212:215], v[216:219], a[88:91]
    v_or3_b32 v57, v57, v195, v196
    v_cmp_gt_i32 s[48:49], 18, v6
    v_mfma_f32_16x16x32_bf16 a[92:95], a[212:215], v[220:223], a[92:95]
    s_waitcnt lgkmcnt(2)
    v_exp_f32 v244, v148
    v_mfma_f32_16x16x32_bf16 a[96:99], a[216:219], v[208:211], a[96:99]
    v_cvt_pk_bf16_f32 v197, v242, v243
    v_cmp_gt_i32 s[50:51], 19, v6
    v_mfma_f32_16x16x32_bf16 a[100:103], a[216:219], v[212:215], a[100:103]
    ds_read_b128 a[136:139], v2 offset:2048
    v_cndmask_b32 v32, v8, v5, s[44:45]
    v_mfma_f32_16x16x32_bf16 a[104:107], a[216:219], v[216:219], a[104:107]
    v_exp_f32 v245, v149
    v_mfma_f32_16x16x32_bf16 a[108:111], a[216:219], v[220:223], a[108:111]
    s_and_b32 s35, s35, 0xffff
    v_exp_f32 v246, v150
    v_mfma_f32_16x16x32_bf16 a[112:115], a[220:223], v[208:211], a[112:115]
    v_cndmask_b32 v33, v8, v5, s[46:47]
    v_cvt_pk_bf16_f32 v198, v244, v245
    v_mfma_f32_16x16x32_bf16 a[116:119], a[220:223], v[212:215], a[116:119]
    ds_read_b128 a[140:143], v2 offset:3072
    v_cndmask_b32 v34, v8, v5, s[48:49]
    v_cndmask_b32 v35, v8, v5, s[50:51]
    v_mfma_f32_16x16x32_bf16 a[120:123], a[220:223], v[216:219], a[120:123]
    v_exp_f32 v247, v151
    v_mfma_f32_16x16x32_bf16 a[124:127], a[220:223], v[220:223], a[124:127]
    s_waitcnt lgkmcnt(2)
    v_or3_b32 v57, v57, v197, v198
    v_cvt_pk_bf16_f32 v199, v246, v247
    v_mfma_f32_16x16x32_bf16 v[160:163], a[128:131], v[64:67], v[16:19]
    v_exp_f32 v232, v136
    v_mfma_f32_16x16x32_bf16 v[164:167], a[128:131], v[80:83], v[20:23]
    buffer_load_dwordx4 v1, s[20:23], s33 offen offset:2048 sc1 lds
    ds_read_b128 a[144:147], v2 offset:4096
    v_mfma_f32_16x16x32_bf16 v[168:171], a[128:131], v[96:99], v[24:27]
    v_exp_f32 v233, v137
    v_mfma_f32_16x16x32_bf16 v[172:175], a[128:131], v[112:115], v[28:31]
    s_or_b32 s35, s35, 0x10000
    v_exp_f32 v234, v138
    v_mfma_f32_16x16x32_bf16 v[160:163], a[132:135], v[68:71], v[160:163]
    s_add_u32 s36, s36, 32
    ds_read_b128 a[148:151], v2 offset:5120
    v_cvt_pk_bf16_f32 v200, v232, v233
    v_mfma_f32_16x16x32_bf16 v[164:167], a[132:135], v[84:87], v[164:167]
    v_exp_f32 v235, v139
    v_mfma_f32_16x16x32_bf16 v[168:171], a[132:135], v[100:103], v[168:171]
    s_add_u32 s52, s52, 8192
    v_or3_b32 v57, v57, v199, v200
    v_cvt_pk_bf16_f32 v201, v234, v235
    v_mfma_f32_16x16x32_bf16 v[172:175], a[132:135], v[116:119], v[172:175]
    s_waitcnt lgkmcnt(2)
    v_exp_f32 v236, v152
    v_mfma_f32_16x16x32_bf16 v[160:163], a[136:139], v[72:75], v[160:163]
    s_and_b32 s52, s52, 0xffff
    ds_read_b128 a[152:155], v2 offset:6144
    ds_read_b128 a[156:159], v2 offset:7168
    v_mfma_f32_16x16x32_bf16 v[164:167], a[136:139], v[88:91], v[164:167]
    v_exp_f32 v237, v153
    v_mfma_f32_16x16x32_bf16 v[168:171], a[136:139], v[104:107], v[168:171]
    v_exp_f32 v238, v154
    v_mfma_f32_16x16x32_bf16 v[172:175], a[136:139], v[120:123], v[172:175]
    v_cvt_pk_bf16_f32 v202, v236, v237
    v_or3_b32 v57, v57, v201, v202
    v_mfma_f32_16x16x32_bf16 v[160:163], a[140:143], v[76:79], v[160:163]
    v_exp_f32 v239, v155
    v_mfma_f32_16x16x32_bf16 v[164:167], a[140:143], v[92:95], v[164:167]
    v_add_u32 v2, s52, v1
    v_cvt_pk_bf16_f32 v203, v238, v239
    v_mfma_f32_16x16x32_bf16 v[168:171], a[140:143], v[108:111], v[168:171]
    v_exp_f32 v240, v140
    v_mfma_f32_16x16x32_bf16 v[172:175], a[140:143], v[124:127], v[172:175]
    s_waitcnt lgkmcnt(2)
    buffer_load_dwordx4 v1, s[20:23], s33 offen offset:3072 sc1 lds
    s_add_u32 s33, s33, 0x80000
    v_mfma_f32_16x16x32_bf16 v[176:179], a[144:147], v[64:67], v[32:35]
    v_exp_f32 v241, v141
    v_mfma_f32_16x16x32_bf16 v[180:183], a[144:147], v[80:83], v[36:39]
    ds_read_b128 a[192:195], v3 offset:0
    v_cvt_pk_bf16_f32 v204, v240, v241
    v_mfma_f32_16x16x32_bf16 v[184:187], a[144:147], v[96:99], v[40:43]
    v_exp_f32 v242, v142
    v_mfma_f32_16x16x32_bf16 v[188:191], a[144:147], v[112:115], v[44:47]
    v_exp_f32 v243, v143
    v_mfma_f32_16x16x32_bf16 v[176:179], a[148:151], v[68:71], v[176:179]
    ds_read_b128 a[196:199], v3 offset:1024
    v_or3_b32 v57, v57, v203, v204
    v_mfma_f32_16x16x32_bf16 v[180:183], a[148:151], v[84:87], v[180:183]
    v_exp_f32 v244, v156
    v_mfma_f32_16x16x32_bf16 v[184:187], a[148:151], v[100:103], v[184:187]
    ds_read_b128 a[200:203], v3 offset:2048
    v_cvt_pk_bf16_f32 v205, v242, v243
    v_mfma_f32_16x16x32_bf16 v[188:191], a[148:151], v[116:119], v[188:191]
    s_waitcnt lgkmcnt(3)
    v_exp_f32 v245, v157
    v_mfma_f32_16x16x32_bf16 v[176:179], a[152:155], v[72:75], v[176:179]
    v_exp_f32 v246, v158
    v_mfma_f32_16x16x32_bf16 v[180:183], a[152:155], v[88:91], v[180:183]
    v_cvt_pk_bf16_f32 v206, v244, v245
    v_or3_b32 v57, v57, v205, v206
    v_mfma_f32_16x16x32_bf16 v[184:187], a[152:155], v[104:107], v[184:187]
    v_exp_f32 v247, v159
    v_mfma_f32_16x16x32_bf16 v[188:191], a[152:155], v[120:123], v[188:191]
    ds_read_b128 a[204:207], v3 offset:3072
    v_cvt_pk_bf16_f32 v207, v246, v247
    v_mfma_f32_16x16x32_bf16 v[176:179], a[156:159], v[76:79], v[176:179]
    v_mfma_f32_16x16x32_bf16 v[180:183], a[156:159], v[92:95], v[180:183]
    v_bitop3_b32 v57, v57, v207, s37 bitop3:0xa8
    v_cmp_ne_u32 vcc, 0, v57
    v_mfma_f32_16x16x32_bf16 v[184:187], a[156:159], v[108:111], v[184:187]
    v_mfma_f32_16x16x32_bf16 v[188:191], a[156:159], v[124:127], v[188:191]
    s_waitcnt vmcnt(13)
    s_barrier
    s_cbranch_vccnz k2_tramp_90
k2_ret_91:
k2_dm3_83:
    v_mfma_f32_16x16x32_bf16 v[12:15], v[60:63], v[192:195], v[12:15]
    v_exp_f32 v232, v160
    v_mfma_f32_16x16x32_bf16 v[48:51], v[60:63], v[196:199], v[48:51]
    s_mov_b32 m0, s34
    ds_read_b128 a[208:211], v3 offset:4096
    v_mfma_f32_16x16x32_bf16 v[248:251], v[60:63], v[200:203], v[248:251]
    s_add_u32 s53, s53, 8192
    v_exp_f32 v233, v161
    v_mfma_f32_16x16x32_bf16 v[252:255], v[60:63], v[204:207], v[252:255]
    s_waitcnt lgkmcnt(3)
    buffer_load_dwordx4 v1, s[16:19], s32 offen offset:0 sc1 lds
    v_mfma_f32_16x16x32_bf16 a[0:3], a[192:195], v[192:195], a[0:3]
    s_sub_u32 s40, s36, s38
    s_sub_u32 s40, s40, 64
    v_exp_f32 v234, v162
    v_cvt_pk_bf16_f32 v208, v232, v233
    v_mfma_f32_16x16x32_bf16 a[4:7], a[192:195], v[196:199], a[4:7]
    s_and_b32 s53, s53, 0xffff
    ds_read_b128 a[212:215], v3 offset:5120
    v_subrev_u32 v6, s40, v4
    v_mfma_f32_16x16x32_bf16 a[8:11], a[192:195], v[200:203], a[8:11]
    s_add_u32 s34, s34, 0x4000
    v_exp_f32 v235, v163
    v_cmp_gt_i32 s[44:45], 0, v6
    v_mfma_f32_16x16x32_bf16 a[12:15], a[192:195], v[204:207], a[12:15]
    v_exp_f32 v236, v176
    v_cvt_pk_bf16_f32 v209, v234, v235
    v_mfma_f32_16x16x32_bf16 a[16:19], a[196:199], v[192:195], a[16:19]
    buffer_load_dwordx4 v1, s[16:19], s32 offen offset:1024 sc1 lds
    ds_read_b128 a[216:219], v3 offset:6144
    v_mfma_f32_16x16x32_bf16 a[20:23], a[196:199], v[196:199], a[20:23]
    v_cmp_gt_i32 s[46:47], 1, v6
    v_exp_f32 v237, v177
    v_mfma_f32_16x16x32_bf16 a[24:27], a[196:199], v[200:203], a[24:27]
    v_cmp_gt_i32 s[48:49], 2, v6
    v_exp_f32 v238, v178
    v_mfma_f32_16x16x32_bf16 a[28:31], a[196:199], v[204:207], a[28:31]
    s_waitcnt lgkmcnt(3)
    v_cvt_pk_bf16_f32 v210, v236, v237
    v_cmp_gt_i32 s[50:51], 3, v6
    v_mfma_f32_16x16x32_bf16 a[32:35], a[200:203], v[192:195], a[32:35]
    s_and_b32 s34, s34, 0xffff
    v_exp_f32 v239, v179
    v_mfma_f32_16x16x32_bf16 a[36:39], a[200:203], v[196:199], a[36:39]
    s_and_b32 s60, s62, 31
    ds_read_b128 a[220:223], v3 offset:7168
    v_or3_b32 v57, v208, v209, v210
    v_cndmask_b32 v20, v9, v5, s[44:45]
    v_mfma_f32_16x16x32_bf16 a[40:43], a[200:203], v[200:203], a[40:43]
    buffer_load_dwordx4 v1, s[16:19], s32 offen offset:2048 sc1 lds
    v_mfma_f32_16x16x32_bf16 a[44:47], a[200:203], v[204:207], a[44:47]
    s_lshr_b32 s61, s62, 5
    v_exp_f32 v240, v164
    v_cvt_pk_bf16_f32 v211, v238, v239
    v_mfma_f32_16x16x32_bf16 a[48:51], a[204:207], v[192:195], a[48:51]
    v_cndmask_b32 v21, v9, v5, s[46:47]
    v_add_u32 v3, s53, v56
    v_mfma_f32_16x16x32_bf16 a[52:55], a[204:207], v[196:199], a[52:55]
    s_mul_i32 s57, s60, 229376
    v_exp_f32 v241, v165
    v_mfma_f32_16x16x32_bf16 a[56:59], a[204:207], v[200:203], a[56:59]
    ds_read_b128 a[128:131], v2 offset:0
    v_cndmask_b32 v22, v9, v5, s[48:49]
    v_cvt_pk_bf16_f32 v212, v240, v241
    v_mfma_f32_16x16x32_bf16 a[60:63], a[204:207], v[204:207], a[60:63]
    s_waitcnt lgkmcnt(3)
    v_exp_f32 v242, v166
    v_mfma_f32_16x16x32_bf16 a[64:67], a[208:211], v[192:195], a[64:67]
    s_lshl_b32 s4, s61, 7
    v_cndmask_b32 v23, v9, v5, s[50:51]
    v_or3_b32 v57, v57, v211, v212
    v_mfma_f32_16x16x32_bf16 a[68:71], a[208:211], v[196:199], a[68:71]
    buffer_load_dwordx4 v1, s[16:19], s32 offen offset:3072 sc1 lds
    ds_read_b128 a[132:135], v2 offset:1024
    s_add_u32 s32, s32, 0x80000
    v_mfma_f32_16x16x32_bf16 a[72:75], a[208:211], v[200:203], a[72:75]
    v_exp_f32 v243, v167
    v_mfma_f32_16x16x32_bf16 a[76:79], a[208:211], v[204:207], a[76:79]
    s_add_u32 s57, s57, s4
    v_cmp_gt_i32 s[44:45], 16, v6
    v_cvt_pk_bf16_f32 v213, v242, v243
    v_mfma_f32_16x16x32_bf16 a[80:83], a[212:215], v[192:195], a[80:83]
    s_waitcnt vmcnt(8)
    v_exp_f32 v244, v180
    v_mfma_f32_16x16x32_bf16 a[84:87], a[212:215], v[196:199], a[84:87]
    s_add_u32 s56, s57, 57344
    ds_read_b128 a[136:139], v2 offset:2048
    v_cmp_gt_i32 s[46:47], 17, v6
    v_mfma_f32_16x16x32_bf16 a[88:91], a[212:215], v[200:203], a[88:91]
    v_exp_f32 v245, v181
    v_cmp_gt_i32 s[48:49], 18, v6
    v_mfma_f32_16x16x32_bf16 a[92:95], a[212:215], v[204:207], a[92:95]
    s_waitcnt lgkmcnt(3)
    v_exp_f32 v246, v182
    v_mfma_f32_16x16x32_bf16 a[96:99], a[216:219], v[192:195], a[96:99]
    s_add_u32 s62, s62, 1
    v_cmp_gt_i32 s[50:51], 19, v6
    v_cvt_pk_bf16_f32 v214, v244, v245
    v_mfma_f32_16x16x32_bf16 a[100:103], a[216:219], v[196:199], a[100:103]
    buffer_store_dwordx4 a[224:227], v229, s[8:11], s58 offen offset:0 sc1
    ds_read_b128 a[140:143], v2 offset:3072
    ds_read_b128 a[144:147], v2 offset:4096
    v_mfma_f32_16x16x32_bf16 a[104:107], a[216:219], v[200:203], a[104:107]
    v_exp_f32 v247, v183
    v_mfma_f32_16x16x32_bf16 a[108:111], a[216:219], v[204:207], a[108:111]
    v_cndmask_b32 v36, v9, v5, s[44:45]
    v_or3_b32 v57, v57, v213, v214
    v_mfma_f32_16x16x32_bf16 a[112:115], a[220:223], v[192:195], a[112:115]
    v_exp_f32 v232, v168
    v_mfma_f32_16x16x32_bf16 a[116:119], a[220:223], v[196:199], a[116:119]
    v_cndmask_b32 v37, v9, v5, s[46:47]
    v_cvt_pk_bf16_f32 v215, v246, v247
    v_cndmask_b32 v38, v9, v5, s[48:49]
    v_cndmask_b32 v39, v9, v5, s[50:51]
    v_mfma_f32_16x16x32_bf16 a[120:123], a[220:223], v[200:203], a[120:123]
    v_exp_f32 v233, v169
    v_mfma_f32_16x16x32_bf16 a[124:127], a[220:223], v[204:207], a[124:127]
    s_waitcnt lgkmcnt(3)
    buffer_store_dwordx4 a[228:231], v229, s[8:11], s58 offen offset:256 sc1
    v_exp_f32 v234, v170
    v_mfma_f32_16x16x32_bf16 v[132:135], a[128:131], v[80:83], v[20:23]
    ds_read_b128 a[148:151], v2 offset:5120
    v_cvt_pk_bf16_f32 v216, v232, v233
    v_mfma_f32_16x16x32_bf16 v[136:139], a[128:131], v[96:99], v[24:27]
    v_exp_f32 v235, v171
    v_mfma_f32_16x16x32_bf16 v[140:143], a[128:131], v[112:115], v[28:31]
    s_lshl_b32 s58, s61, 17
    ds_read_b128 a[152:155], v2 offset:6144
    v_or3_b32 v57, v57, v215, v216
    v_mfma_f32_16x16x32_bf16 v[132:135], a[132:135], v[84:87], v[132:135]
    s_add_u32 s36, s36, 32
    v_exp_f32 v236, v184
    v_mfma_f32_16x16x32_bf16 v[136:139], a[132:135], v[100:103], v[136:139]
    s_lshl_b32 s60, s60, 10
    v_cvt_pk_bf16_f32 v217, v234, v235
    v_exp_f32 v237, v185
    v_mfma_f32_16x16x32_bf16 v[140:143], a[132:135], v[116:119], v[140:143]
    s_waitcnt lgkmcnt(3)
    buffer_load_dwordx4 a[224:227], v228, s[12:15], s57 offen
    ds_read_b128 a[156:159], v2 offset:7168
    v_mfma_f32_16x16x32_bf16 v[132:135], a[136:139], v[88:91], v[132:135]
    s_add_u32 s52, s52, 8192
    v_exp_f32 v238, v186
    v_mfma_f32_16x16x32_bf16 v[136:139], a[136:139], v[104:107], v[136:139]
    s_add_u32 s58, s58, s60
    v_cvt_pk_bf16_f32 v218, v236, v237
    v_or3_b32 v57, v57, v217, v218
    v_mfma_f32_16x16x32_bf16 v[140:143], a[136:139], v[120:123], v[140:143]
    s_and_b32 s52, s52, 0xffff
    v_exp_f32 v239, v187
    v_mfma_f32_16x16x32_bf16 v[132:135], a[140:143], v[92:95], v[132:135]
    v_add_u32 v2, s52, v1
    v_cvt_pk_bf16_f32 v219, v238, v239
    v_mfma_f32_16x16x32_bf16 v[136:139], a[140:143], v[108:111], v[136:139]
    s_mov_b32 s10, s59
    v_exp_f32 v240, v172
    v_mfma_f32_16x16x32_bf16 v[140:143], a[140:143], v[124:127], v[140:143]
    s_waitcnt lgkmcnt(2)
    ds_read_b128 a[192:195], v3 offset:0
    v_exp_f32 v241, v173
    v_mfma_f32_16x16x32_bf16 v[148:151], a[144:147], v[80:83], v[36:39]
    buffer_load_dwordx4 a[228:231], v228, s[12:15], s56 offen
    ds_read_b128 a[196:199], v3 offset:1024
    v_mfma_f32_16x16x32_bf16 v[152:155], a[144:147], v[96:99], v[40:43]
    v_exp_f32 v242, v174
    v_mfma_f32_16x16x32_bf16 v[156:159], a[144:147], v[112:115], v[44:47]
    v_cvt_pk_bf16_f32 v220, v240, v241
    v_or3_b32 v57, v57, v219, v220
    v_mfma_f32_16x16x32_bf16 v[148:151], a[148:151], v[84:87], v[148:151]
    v_exp_f32 v243, v175
    v_mfma_f32_16x16x32_bf16 v[152:155], a[148:151], v[100:103], v[152:155]
    v_exp_f32 v244, v188
    v_mfma_f32_16x16x32_bf16 v[156:159], a[148:151], v[116:119], v[156:159]
    s_waitcnt lgkmcnt(2)
    v_cvt_pk_bf16_f32 v221, v242, v243
    v_exp_f32 v245, v189
    v_mfma_f32_16x16x32_bf16 v[148:151], a[152:155], v[88:91], v[148:151]
    buffer_load_dword v7, v230, s[24:27], s54 offen
    ds_read_b128 a[200:203], v3 offset:2048
    v_mfma_f32_16x16x32_bf16 v[152:155], a[152:155], v[104:107], v[152:155]
    v_exp_f32 v246, v190
    v_mfma_f32_16x16x32_bf16 v[156:159], a[152:155], v[120:123], v[156:159]
    s_add_u32 s54, s54, 4096
    v_cvt_pk_bf16_f32 v222, v244, v245
    v_or3_b32 v57, v57, v221, v222
    v_mfma_f32_16x16x32_bf16 v[148:151], a[156:159], v[92:95], v[148:151]
    v_exp_f32 v247, v191
    v_mfma_f32_16x16x32_bf16 v[152:155], a[156:159], v[108:111], v[152:155]
    ds_read_b128 a[204:207], v3 offset:3072
    v_cvt_pk_bf16_f32 v223, v246, v247
    v_bitop3_b32 v57, v57, v223, s37 bitop3:0xa8
    v_mfma_f32_16x16x32_bf16 v[156:159], a[156:159], v[124:127], v[156:159]
    v_cmp_ne_u32 vcc, 0, v57
    s_cbranch_vccnz k2_tramp_92
k2_ret_93:
    v_mfma_f32_16x16x32_bf16 v[12:15], v[60:63], v[208:211], v[12:15]
    v_exp_f32 v232, v132
    v_mfma_f32_16x16x32_bf16 v[48:51], v[60:63], v[212:215], v[48:51]
    s_mov_b32 m0, s35
    ds_read_b128 a[208:211], v3 offset:4096
    v_mfma_f32_16x16x32_bf16 v[248:251], v[60:63], v[216:219], v[248:251]
    s_add_u32 s53, s53, 8192
    buffer_load_dwordx4 v1, s[20:23], s33 offen offset:0 sc1 lds
    v_mfma_f32_16x16x32_bf16 v[252:255], v[60:63], v[220:223], v[252:255]
    s_waitcnt lgkmcnt(3)
    v_exp_f32 v233, v133
    v_mfma_f32_16x16x32_bf16 a[0:3], a[192:195], v[208:211], a[0:3]
    s_sub_u32 s40, s36, s38
    s_sub_u32 s40, s40, 64
    v_exp_f32 v234, v134
    v_mfma_f32_16x16x32_bf16 a[4:7], a[192:195], v[212:215], a[4:7]
    s_and_b32 s53, s53, 0xffff
    ds_read_b128 a[212:215], v3 offset:5120
    v_subrev_u32 v6, s40, v4
    v_mfma_f32_16x16x32_bf16 a[8:11], a[192:195], v[216:219], a[8:11]
    v_cvt_pk_bf16_f32 v196, v232, v233
    v_cmp_gt_i32 s[44:45], 0, v6
    v_mfma_f32_16x16x32_bf16 a[12:15], a[192:195], v[220:223], a[12:15]
    v_exp_f32 v235, v135
    v_mfma_f32_16x16x32_bf16 a[16:19], a[196:199], v[208:211], a[16:19]
    ds_read_b128 a[216:219], v3 offset:6144
    v_cmp_gt_i32 s[46:47], 1, v6
    v_mfma_f32_16x16x32_bf16 a[20:23], a[196:199], v[212:215], a[20:23]
    v_exp_f32 v236, v148
    v_mfma_f32_16x16x32_bf16 a[24:27], a[196:199], v[216:219], a[24:27]
    v_cvt_pk_bf16_f32 v197, v234, v235
    v_cmp_gt_i32 s[48:49], 2, v6
    v_mfma_f32_16x16x32_bf16 a[28:31], a[196:199], v[220:223], a[28:31]
    s_waitcnt lgkmcnt(3)
    v_cmp_gt_i32 s[50:51], 3, v6
    v_mfma_f32_16x16x32_bf16 a[32:35], a[200:203], v[208:211], a[32:35]
    v_exp_f32 v237, v149
    v_mfma_f32_16x16x32_bf16 a[36:39], a[200:203], v[212:215], a[36:39]
    s_add_u32 s35, s35, 0x4000
    ds_read_b128 a[220:223], v3 offset:7168
    v_cndmask_b32 v20, v9, v5, s[44:45]
    v_mfma_f32_16x16x32_bf16 a[40:43], a[200:203], v[216:219], a[40:43]
    v_exp_f32 v238, v150
    v_mfma_f32_16x16x32_bf16 a[44:47], a[200:203], v[220:223], a[44:47]
    v_cvt_pk_bf16_f32 v198, v236, v237
    v_cndmask_b32 v21, v9, v5, s[46:47]
    v_mfma_f32_16x16x32_bf16 a[48:51], a[204:207], v[208:211], a[48:51]
    buffer_load_dwordx4 v1, s[20:23], s33 offen offset:1024 sc1 lds
    ds_read_b128 a[128:131], v2 offset:0
    v_mfma_f32_16x16x32_bf16 a[52:55], a[204:207], v[212:215], a[52:55]
    v_add_u32 v3, s53, v56
    v_cndmask_b32 v22, v9, v5, s[48:49]
    v_mfma_f32_16x16x32_bf16 a[56:59], a[204:207], v[216:219], a[56:59]
    v_exp_f32 v239, v151
    v_mfma_f32_16x16x32_bf16 a[60:63], a[204:207], v[220:223], a[60:63]
    s_waitcnt lgkmcnt(3)
    v_or3_b32 v57, v196, v197, v198
    v_cndmask_b32 v23, v9, v5, s[50:51]
    v_mfma_f32_16x16x32_bf16 a[64:67], a[208:211], v[208:211], a[64:67]
    v_exp_f32 v240, v136
    v_mfma_f32_16x16x32_bf16 a[68:71], a[208:211], v[212:215], a[68:71]
    v_cvt_pk_bf16_f32 v199, v238, v239
    v_cmp_gt_i32 s[44:45], 16, v6
    v_mfma_f32_16x16x32_bf16 a[72:75], a[208:211], v[216:219], a[72:75]
    ds_read_b128 a[132:135], v2 offset:1024
    v_cmp_gt_i32 s[46:47], 17, v6
    v_mfma_f32_16x16x32_bf16 a[76:79], a[208:211], v[220:223], a[76:79]
    v_exp_f32 v241, v137
    v_mfma_f32_16x16x32_bf16 a[80:83], a[212:215], v[208:211], a[80:83]
    ds_read_b128 a[136:139], v2 offset:2048
    v_cmp_gt_i32 s[48:49], 18, v6
    v_mfma_f32_16x16x32_bf16 a[84:87], a[212:215], v[212:215], a[84:87]
    v_exp_f32 v242, v138
    v_mfma_f32_16x16x32_bf16 a[88:91], a[212:215], v[216:219], a[88:91]
    v_cvt_pk_bf16_f32 v200, v240, v241
    v_cmp_gt_i32 s[50:51], 19, v6
    v_mfma_f32_16x16x32_bf16 a[92:95], a[212:215], v[220:223], a[92:95]
    s_waitcnt lgkmcnt(3)
    v_exp_f32 v243, v139
    v_mfma_f32_16x16x32_bf16 a[96:99], a[216:219], v[208:211], a[96:99]
    s_and_b32 s35, s35, 0xffff
    ds_read_b128 a[140:143], v2 offset:3072
    v_or3_b32 v57, v57, v199, v200
    v_mfma_f32_16x16x32_bf16 a[100:103], a[216:219], v[212:215], a[100:103]
    v_cndmask_b32 v36, v9, v5, s[44:45]
    v_cndmask_b32 v37, v9, v5, s[46:47]
    v_mfma_f32_16x16x32_bf16 a[104:107], a[216:219], v[216:219], a[104:107]
    v_exp_f32 v244, v152
    v_mfma_f32_16x16x32_bf16 a[108:111], a[216:219], v[220:223], a[108:111]
    ds_read_b128 a[144:147], v2 offset:4096
    v_cvt_pk_bf16_f32 v201, v242, v243
    v_mfma_f32_16x16x32_bf16 a[112:115], a[220:223], v[208:211], a[112:115]
    buffer_load_dwordx4 v1, s[20:23], s33 offen offset:2048 sc1 lds
    ds_read_b128 a[148:151], v2 offset:5120
    v_mfma_f32_16x16x32_bf16 a[116:119], a[220:223], v[212:215], a[116:119]
    v_cndmask_b32 v38, v9, v5, s[48:49]
    v_cndmask_b32 v39, v9, v5, s[50:51]
    v_mfma_f32_16x16x32_bf16 a[120:123], a[220:223], v[216:219], a[120:123]
    s_or_b32 s35, s35, 0x10000
    v_exp_f32 v245, v153
    v_mfma_f32_16x16x32_bf16 a[124:127], a[220:223], v[220:223], a[124:127]
    s_waitcnt lgkmcnt(4)
    v_exp_f32 v246, v154
    v_mfma_f32_16x16x32_bf16 v[164:167], a[128:131], v[80:83], v[20:23]
    ds_read_b128 a[152:155], v2 offset:6144
    v_cvt_pk_bf16_f32 v202, v244, v245
    v_mfma_f32_16x16x32_bf16 v[168:171], a[128:131], v[96:99], v[24:27]
    v_exp_f32 v247, v155
    v_mfma_f32_16x16x32_bf16 v[172:175], a[128:131], v[112:115], v[28:31]
    v_or3_b32 v57, v57, v201, v202
    v_cvt_pk_bf16_f32 v203, v246, v247
    v_mfma_f32_16x16x32_bf16 v[164:167], a[132:135], v[84:87], v[164:167]
    s_add_u32 s36, s36, 32
    v_exp_f32 v232, v140
    v_mfma_f32_16x16x32_bf16 v[168:171], a[132:135], v[100:103], v[168:171]
    ds_read_b128 a[156:159], v2 offset:7168
    v_mfma_f32_16x16x32_bf16 v[172:175], a[132:135], v[116:119], v[172:175]
    s_waitcnt lgkmcnt(4)
    v_exp_f32 v233, v141
    v_mfma_f32_16x16x32_bf16 v[164:167], a[136:139], v[88:91], v[164:167]
    s_add_u32 s52, s52, 8192
    v_exp_f32 v234, v142
    v_mfma_f32_16x16x32_bf16 v[168:171], a[136:139], v[104:107], v[168:171]
    ds_read_b128 a[192:195], v3 offset:0
    v_cvt_pk_bf16_f32 v204, v232, v233
    v_mfma_f32_16x16x32_bf16 v[172:175], a[136:139], v[120:123], v[172:175]
    s_and_b32 s52, s52, 0xffff
    v_add_u32 v2, s52, v1
    v_or3_b32 v57, v57, v203, v204
    v_mfma_f32_16x16x32_bf16 v[164:167], a[140:143], v[92:95], v[164:167]
    buffer_load_dwordx4 v1, s[20:23], s33 offen offset:3072 sc1 lds
    s_add_u32 s33, s33, 0x80000
    v_mfma_f32_16x16x32_bf16 v[168:171], a[140:143], v[108:111], v[168:171]
    v_exp_f32 v235, v143
    v_mfma_f32_16x16x32_bf16 v[172:175], a[140:143], v[124:127], v[172:175]
    s_waitcnt lgkmcnt(3)
    v_exp_f32 v236, v156
    v_mfma_f32_16x16x32_bf16 v[180:183], a[144:147], v[80:83], v[36:39]
    ds_read_b128 a[196:199], v3 offset:1024
    v_cvt_pk_bf16_f32 v205, v234, v235
    v_mfma_f32_16x16x32_bf16 v[184:187], a[144:147], v[96:99], v[40:43]
    v_exp_f32 v237, v157
    v_mfma_f32_16x16x32_bf16 v[188:191], a[144:147], v[112:115], v[44:47]
    ds_read_b128 a[200:203], v3 offset:2048
    v_mfma_f32_16x16x32_bf16 v[180:183], a[148:151], v[84:87], v[180:183]
    v_exp_f32 v238, v158
    v_mfma_f32_16x16x32_bf16 v[184:187], a[148:151], v[100:103], v[184:187]
    v_cvt_pk_bf16_f32 v206, v236, v237
    v_mfma_f32_16x16x32_bf16 v[188:191], a[148:151], v[116:119], v[188:191]
    s_waitcnt lgkmcnt(3)
    v_exp_f32 v239, v159
    v_mfma_f32_16x16x32_bf16 v[180:183], a[152:155], v[88:91], v[180:183]
    ds_read_b128 a[204:207], v3 offset:3072
    v_or3_b32 v57, v57, v205, v206
    v_mfma_f32_16x16x32_bf16 v[184:187], a[152:155], v[104:107], v[184:187]
    v_cvt_pk_bf16_f32 v207, v238, v239
    v_mfma_f32_16x16x32_bf16 v[188:191], a[152:155], v[120:123], v[188:191]
    v_mfma_f32_16x16x32_bf16 v[180:183], a[156:159], v[92:95], v[180:183]
    v_bitop3_b32 v57, v57, v207, s37 bitop3:0xa8
    v_cmp_ne_u32 vcc, 0, v57
    v_mfma_f32_16x16x32_bf16 v[184:187], a[156:159], v[108:111], v[184:187]
    v_mfma_f32_16x16x32_bf16 v[188:191], a[156:159], v[124:127], v[188:191]
    s_waitcnt vmcnt(13)
    s_barrier
    s_cbranch_vccnz k2_tramp_94
k2_ret_95:
    v_mfma_f32_16x16x32_bf16 v[48:51], v[60:63], v[196:199], v[48:51]
    ds_read_b128 a[208:211], v3 offset:4096
    ds_read_b128 a[212:215], v3 offset:5120
    v_mfma_f32_16x16x32_bf16 v[248:251], v[60:63], v[200:203], v[248:251]
    s_mov_b32 m0, s34
    v_exp_f32 v232, v164
    v_mfma_f32_16x16x32_bf16 v[252:255], v[60:63], v[204:207], v[252:255]
    s_waitcnt lgkmcnt(4)
    buffer_load_dwordx4 v1, s[16:19], s32 offen offset:0 sc1 lds
    ds_read_b128 a[216:219], v3 offset:6144
    v_mfma_f32_16x16x32_bf16 a[4:7], a[192:195], v[196:199], a[4:7]
    s_add_u32 s53, s53, 8192
    v_exp_f32 v233, v165
    v_mfma_f32_16x16x32_bf16 a[8:11], a[192:195], v[200:203], a[8:11]
    s_and_b32 s53, s53, 0xffff
    v_mov_b32 v16, v10
    v_mov_b32 v17, v10
    v_mfma_f32_16x16x32_bf16 a[12:15], a[192:195], v[204:207], a[12:15]
    s_add_u32 s34, s34, 0x4000
    v_exp_f32 v234, v166
    v_mfma_f32_16x16x32_bf16 a[20:23], a[196:199], v[196:199], a[20:23]
    ds_read_b128 a[220:223], v3 offset:7168
    v_cvt_pk_bf16_f32 v212, v232, v233
    v_mfma_f32_16x16x32_bf16 a[24:27], a[196:199], v[200:203], a[24:27]
    v_mov_b32 v18, v10
    v_mov_b32 v19, v10
    v_mfma_f32_16x16x32_bf16 a[28:31], a[196:199], v[204:207], a[28:31]
    s_waitcnt lgkmcnt(4)
    v_exp_f32 v235, v167
    v_mfma_f32_16x16x32_bf16 a[36:39], a[200:203], v[196:199], a[36:39]
    buffer_load_dwordx4 v1, s[16:19], s32 offen offset:1024 sc1 lds
    ds_read_b128 a[128:131], v2 offset:0
    v_mfma_f32_16x16x32_bf16 a[40:43], a[200:203], v[200:203], a[40:43]
    v_mov_b32 v20, v11
    v_add_u32 v3, s53, v56
    v_mfma_f32_16x16x32_bf16 a[44:47], a[200:203], v[204:207], a[44:47]
    s_and_b32 s34, s34, 0xffff
    v_mov_b32 v21, v11
    v_mov_b32 v22, v11
    v_mfma_f32_16x16x32_bf16 a[52:55], a[204:207], v[196:199], a[52:55]
    v_exp_f32 v236, v180
    v_mfma_f32_16x16x32_bf16 a[56:59], a[204:207], v[200:203], a[56:59]
    ds_read_b128 a[132:135], v2 offset:1024
    v_cvt_pk_bf16_f32 v213, v234, v235
    v_mfma_f32_16x16x32_bf16 a[60:63], a[204:207], v[204:207], a[60:63]
    s_waitcnt lgkmcnt(4)
    v_mov_b32 v23, v11
    v_mov_b32 v32, v10
    v_mfma_f32_16x16x32_bf16 a[68:71], a[208:211], v[196:199], a[68:71]
    v_exp_f32 v237, v181
    v_mfma_f32_16x16x32_bf16 a[72:75], a[208:211], v[200:203], a[72:75]
    ds_read_b128 a[136:139], v2 offset:2048
    v_mov_b32 v33, v10
    v_mfma_f32_16x16x32_bf16 a[76:79], a[208:211], v[204:207], a[76:79]
    buffer_load_dwordx4 v1, s[16:19], s32 offen offset:2048 sc1 lds
    v_mov_b32 v34, v10
    v_mfma_f32_16x16x32_bf16 a[84:87], a[212:215], v[196:199], a[84:87]
    v_exp_f32 v238, v182
    v_mfma_f32_16x16x32_bf16 a[88:91], a[212:215], v[200:203], a[88:91]
    ds_read_b128 a[140:143], v2 offset:3072
    v_cvt_pk_bf16_f32 v214, v236, v237
    v_mfma_f32_16x16x32_bf16 a[92:95], a[212:215], v[204:207], a[92:95]
    s_waitcnt lgkmcnt(4)
    v_mov_b32 v35, v10
    v_mov_b32 v36, v11
    v_mfma_f32_16x16x32_bf16 a[100:103], a[216:219], v[196:199], a[100:103]
    ds_read_b128 a[144:147], v2 offset:4096
    v_exp_f32 v239, v183
    v_mfma_f32_16x16x32_bf16 a[104:107], a[216:219], v[200:203], a[104:107]
    v_mov_b32 v37, v11
    v_or3_b32 v57, v212, v213, v214
    v_mov_b32 v38, v11
    v_mov_b32 v39, v11
    v_mfma_f32_16x16x32_bf16 a[108:111], a[216:219], v[204:207], a[108:111]
    buffer_load_dwordx4 v1, s[16:19], s32 offen offset:3072 sc1 lds
    ds_read_b128 a[148:151], v2 offset:5120
    v_mfma_f32_16x16x32_bf16 a[116:119], a[220:223], v[196:199], a[116:119]
    s_add_u32 s32, s32, 0x80000
    s_cmp_ge_u32 s36, s43
    s_cbranch_scc1 k2_prep_96
k2_prepret_97:
    v_mfma_f32_16x16x32_bf16 a[120:123], a[220:223], v[200:203], a[120:123]
    s_waitcnt vmcnt(8)
    v_exp_f32 v240, v168
    v_mfma_f32_16x16x32_bf16 a[124:127], a[220:223], v[204:207], a[124:127]
    s_waitcnt lgkmcnt(4)
    ds_read_b128 a[152:155], v2 offset:6144
    v_cvt_pk_bf16_f32 v215, v238, v239
    v_mfma_f32_16x16x32_bf16 v[128:131], a[128:131], v[96:99], v[16:19]
    v_exp_f32 v241, v169
    v_mfma_f32_16x16x32_bf16 v[132:135], a[128:131], v[112:115], v[20:23]
    ds_read_b128 a[156:159], v2 offset:7168
    v_exp_f32 v242, v170
    v_mfma_f32_16x16x32_bf16 v[128:131], a[132:135], v[100:103], v[128:131]
    ds_read_b128 a[160:163], v2 offset:8192
    v_cvt_pk_bf16_f32 v216, v240, v241
    v_mfma_f32_16x16x32_bf16 v[132:135], a[132:135], v[116:119], v[132:135]
    s_waitcnt lgkmcnt(5)
    buffer_store_dwordx4 a[224:227], v229, s[8:11], s58 offen offset:0 sc1
    v_exp_f32 v243, v171
    v_mfma_f32_16x16x32_bf16 v[128:131], a[136:139], v[104:107], v[128:131]
    s_add_u32 s36, s36, 64
    ds_read_b128 a[164:167], v2 offset:9216
    v_or3_b32 v57, v57, v215, v216
    v_mfma_f32_16x16x32_bf16 v[132:135], a[136:139], v[120:123], v[132:135]
    v_exp_f32 v244, v184
    v_mfma_f32_16x16x32_bf16 v[128:131], a[140:143], v[108:111], v[128:131]
    s_add_u32 s52, s52, 16384
    ds_read_b128 a[168:171], v2 offset:10240
    v_cvt_pk_bf16_f32 v217, v242, v243
    v_mfma_f32_16x16x32_bf16 v[132:135], a[140:143], v[124:127], v[132:135]
    s_waitcnt lgkmcnt(5)
    v_exp_f32 v245, v185
    v_mfma_f32_16x16x32_bf16 v[144:147], a[144:147], v[96:99], v[32:35]
    s_and_b32 s52, s52, 0xffff
    ds_read_b128 a[172:175], v2 offset:11264
    ds_read_b128 a[176:179], v2 offset:12288
    v_mfma_f32_16x16x32_bf16 v[148:151], a[144:147], v[112:115], v[36:39]
    v_exp_f32 v246, v186
    v_mfma_f32_16x16x32_bf16 v[144:147], a[148:151], v[100:103], v[144:147]
    ds_read_b128 a[180:183], v2 offset:13312
    v_cvt_pk_bf16_f32 v218, v244, v245
    v_mfma_f32_16x16x32_bf16 v[148:151], a[148:151], v[116:119], v[148:151]
    s_waitcnt lgkmcnt(6)
    v_exp_f32 v247, v187
    v_mfma_f32_16x16x32_bf16 v[144:147], a[152:155], v[104:107], v[144:147]
    ds_read_b128 a[184:187], v2 offset:14336
    v_or3_b32 v57, v57, v217, v218
    v_mfma_f32_16x16x32_bf16 v[148:151], a[152:155], v[120:123], v[148:151]
    v_exp_f32 v232, v172
    v_mfma_f32_16x16x32_bf16 v[144:147], a[156:159], v[108:111], v[144:147]
    ds_read_b128 a[188:191], v2 offset:15360
    v_cvt_pk_bf16_f32 v219, v246, v247
    v_mfma_f32_16x16x32_bf16 v[148:151], a[156:159], v[124:127], v[148:151]
    s_waitcnt lgkmcnt(6)
    v_exp_f32 v233, v173
    v_mfma_f32_16x16x32_bf16 v[136:139], a[160:163], v[96:99], v[24:27]
    buffer_store_dwordx4 a[228:231], v229, s[8:11], s58 offen offset:256 sc1
    ds_read_b128 a[192:195], v3 offset:0
    v_mfma_f32_16x16x32_bf16 v[140:143], a[160:163], v[112:115], v[28:31]
    v_add_u32 v2, s52, v1
    v_cvt_pk_bf16_f32 v220, v232, v233
    v_mfma_f32_16x16x32_bf16 v[136:139], a[164:167], v[100:103], v[136:139]
    v_exp_f32 v234, v174
    v_mfma_f32_16x16x32_bf16 v[140:143], a[164:167], v[116:119], v[140:143]
    s_waitcnt lgkmcnt(5)
    v_exp_f32 v235, v175
    v_mfma_f32_16x16x32_bf16 v[136:139], a[168:171], v[104:107], v[136:139]
    ds_read_b128 a[196:199], v3 offset:1024
    v_or3_b32 v57, v57, v219, v220
    v_mfma_f32_16x16x32_bf16 v[140:143], a[168:171], v[120:123], v[140:143]
    v_exp_f32 v236, v188
    v_mfma_f32_16x16x32_bf16 v[136:139], a[172:175], v[108:111], v[136:139]
    ds_read_b128 a[200:203], v3 offset:2048
    v_cvt_pk_bf16_f32 v221, v234, v235
    v_mfma_f32_16x16x32_bf16 v[140:143], a[172:175], v[124:127], v[140:143]
    s_waitcnt lgkmcnt(5)
    v_exp_f32 v237, v189
    v_mfma_f32_16x16x32_bf16 v[152:155], a[176:179], v[96:99], v[40:43]
    v_exp_f32 v238, v190
    v_mfma_f32_16x16x32_bf16 v[156:159], a[176:179], v[112:115], v[44:47]
    v_cvt_pk_bf16_f32 v222, v236, v237
    v_or3_b32 v57, v57, v221, v222
    v_mfma_f32_16x16x32_bf16 v[152:155], a[180:183], v[100:103], v[152:155]
    v_exp_f32 v239, v191
    v_mfma_f32_16x16x32_bf16 v[156:159], a[180:183], v[116:119], v[156:159]
    s_waitcnt lgkmcnt(3)
    ds_read_b128 a[204:207], v3 offset:3072
    v_cvt_pk_bf16_f32 v223, v238, v239
    v_mfma_f32_16x16x32_bf16 v[152:155], a[184:187], v[104:107], v[152:155]
    v_mfma_f32_16x16x32_bf16 v[156:159], a[184:187], v[120:123], v[156:159]
    v_bitop3_b32 v57, v57, v223, s37 bitop3:0xa8
    v_cmp_ne_u32 vcc, 0, v57
    v_mfma_f32_16x16x32_bf16 v[152:155], a[188:191], v[108:111], v[152:155]
    v_mfma_f32_16x16x32_bf16 v[156:159], a[188:191], v[124:127], v[156:159]
    s_cbranch_vccnz k2_tramp_98
k2_ret_99:
    v_mfma_f32_16x16x32_bf16 v[48:51], v[60:63], v[212:215], v[48:51]
    ds_read_b128 a[208:211], v3 offset:4096
    ds_read_b128 a[212:215], v3 offset:5120
    v_mfma_f32_16x16x32_bf16 v[248:251], v[60:63], v[216:219], v[248:251]
    s_mov_b32 m0, s35
    v_exp_f32 v232, v128
    v_mfma_f32_16x16x32_bf16 v[252:255], v[60:63], v[220:223], v[252:255]
    s_waitcnt lgkmcnt(4)
    ds_read_b128 a[216:219], v3 offset:6144
    v_exp_f32 v233, v129
    v_mfma_f32_16x16x32_bf16 a[4:7], a[192:195], v[212:215], a[4:7]
    s_add_u32 s53, s53, 8192
    buffer_load_dwordx4 v1, s[20:23], s33 offen offset:0 sc1 lds
    v_mfma_f32_16x16x32_bf16 a[8:11], a[192:195], v[216:219], a[8:11]
    s_and_b32 s53, s53, 0xffff
    v_exp_f32 v234, v130
    v_cvt_pk_bf16_f32 v192, v232, v233
    v_mfma_f32_16x16x32_bf16 a[12:15], a[192:195], v[220:223], a[12:15]
    ds_read_b128 a[220:223], v3 offset:7168
    v_mfma_f32_16x16x32_bf16 a[20:23], a[196:199], v[212:215], a[20:23]
    s_add_u32 s35, s35, 0x4000
    v_exp_f32 v235, v131
    v_mfma_f32_16x16x32_bf16 a[24:27], a[196:199], v[216:219], a[24:27]
    v_exp_f32 v236, v144
    v_cvt_pk_bf16_f32 v193, v234, v235
    v_mfma_f32_16x16x32_bf16 a[28:31], a[196:199], v[220:223], a[28:31]
    s_waitcnt lgkmcnt(4)
    buffer_load_dwordx4 v1, s[20:23], s33 offen offset:1024 sc1 lds
    ds_read_b128 a[128:131], v2 offset:0
    v_mfma_f32_16x16x32_bf16 a[36:39], a[200:203], v[212:215], a[36:39]
    v_add_u32 v3, s53, v56
    v_exp_f32 v237, v145
    v_mfma_f32_16x16x32_bf16 a[40:43], a[200:203], v[216:219], a[40:43]
    ds_read_b128 a[132:135], v2 offset:1024
    v_cvt_pk_bf16_f32 v194, v236, v237
    v_mfma_f32_16x16x32_bf16 a[44:47], a[200:203], v[220:223], a[44:47]
    ds_read_b128 a[136:139], v2 offset:2048
    v_exp_f32 v238, v146
    v_mfma_f32_16x16x32_bf16 a[52:55], a[204:207], v[212:215], a[52:55]
    s_and_b32 s35, s35, 0xffff
    v_exp_f32 v239, v147
    v_mfma_f32_16x16x32_bf16 a[56:59], a[204:207], v[216:219], a[56:59]
    ds_read_b128 a[140:143], v2 offset:3072
    v_or3_b32 v57, v192, v193, v194
    v_mfma_f32_16x16x32_bf16 a[60:63], a[204:207], v[220:223], a[60:63]
    s_waitcnt lgkmcnt(6)
    v_exp_f32 v240, v132
    v_mfma_f32_16x16x32_bf16 a[68:71], a[208:211], v[212:215], a[68:71]
    s_or_b32 s35, s35, 0x10000
    buffer_load_dwordx4 v1, s[20:23], s33 offen offset:2048 sc1 lds
    ds_read_b128 a[144:147], v2 offset:4096
    v_mfma_f32_16x16x32_bf16 a[72:75], a[208:211], v[216:219], a[72:75]
    v_cvt_pk_bf16_f32 v195, v238, v239
    v_exp_f32 v241, v133
    v_mfma_f32_16x16x32_bf16 a[76:79], a[208:211], v[220:223], a[76:79]
    v_exp_f32 v242, v134
    v_mfma_f32_16x16x32_bf16 a[84:87], a[212:215], v[212:215], a[84:87]
    ds_read_b128 a[148:151], v2 offset:5120
    v_cvt_pk_bf16_f32 v196, v240, v241
    v_mfma_f32_16x16x32_bf16 a[88:91], a[212:215], v[216:219], a[88:91]
    v_exp_f32 v243, v135
    v_mfma_f32_16x16x32_bf16 a[92:95], a[212:215], v[220:223], a[92:95]
    s_waitcnt lgkmcnt(6)
    ds_read_b128 a[152:155], v2 offset:6144
    v_or3_b32 v57, v57, v195, v196
    v_cvt_pk_bf16_f32 v197, v242, v243
    v_mfma_f32_16x16x32_bf16 a[100:103], a[216:219], v[212:215], a[100:103]
    buffer_load_dwordx4 v1, s[20:23], s33 offen offset:3072 sc1 lds
    ds_read_b128 a[156:159], v2 offset:7168
    v_mfma_f32_16x16x32_bf16 a[104:107], a[216:219], v[216:219], a[104:107]
    s_add_u32 s33, s33, 0x80000
    v_exp_f32 v244, v148
    v_mfma_f32_16x16x32_bf16 a[108:111], a[216:219], v[220:223], a[108:111]
    v_exp_f32 v245, v149
    v_mfma_f32_16x16x32_bf16 a[116:119], a[220:223], v[212:215], a[116:119]
    ds_read_b128 a[160:163], v2 offset:8192
    s_cmp_ge_u32 s36, s43
    s_cbranch_scc1 k2_prep_100
k2_prepret_101:
    v_mfma_f32_16x16x32_bf16 a[120:123], a[220:223], v[216:219], a[120:123]
    v_exp_f32 v246, v150
    v_mfma_f32_16x16x32_bf16 a[124:127], a[220:223], v[220:223], a[124:127]
    s_waitcnt lgkmcnt(7)
    ds_read_b128 a[164:167], v2 offset:9216
    v_cvt_pk_bf16_f32 v198, v244, v245
    v_mfma_f32_16x16x32_bf16 v[160:163], a[128:131], v[96:99], v[16:19]
    s_waitcnt vmcnt(12)
    s_barrier
    v_exp_f32 v247, v151
    v_mfma_f32_16x16x32_bf16 v[164:167], a[128:131], v[112:115], v[20:23]
    s_mov_b32 m0, s34
    v_or3_b32 v57, v57, v197, v198
    v_cvt_pk_bf16_f32 v199, v246, v247
    v_mfma_f32_16x16x32_bf16 v[160:163], a[132:135], v[100:103], v[160:163]
    ds_read_b128 a[168:171], v2 offset:10240
    v_exp_f32 v232, v136
    v_mfma_f32_16x16x32_bf16 v[164:167], a[132:135], v[116:119], v[164:167]
    s_waitcnt lgkmcnt(7)
    buffer_load_dwordx4 v1, s[16:19], s32 offen offset:0 sc1 lds
    ds_read_b128 a[172:175], v2 offset:11264
    v_mfma_f32_16x16x32_bf16 v[160:163], a[136:139], v[104:107], v[160:163]
    s_add_u32 s36, s36, 64
    v_exp_f32 v233, v137
    v_mfma_f32_16x16x32_bf16 v[164:167], a[136:139], v[120:123], v[164:167]
    v_exp_f32 v234, v138
    v_mfma_f32_16x16x32_bf16 v[160:163], a[140:143], v[108:111], v[160:163]
    s_add_u32 s52, s52, 16384
    ds_read_b128 a[176:179], v2 offset:12288
    v_cvt_pk_bf16_f32 v200, v232, v233
    v_mfma_f32_16x16x32_bf16 v[164:167], a[140:143], v[124:127], v[164:167]
    s_waitcnt lgkmcnt(7)
    v_exp_f32 v235, v139
    v_or3_b32 v57, v57, v199, v200
    v_mfma_f32_16x16x32_bf16 v[176:179], a[144:147], v[96:99], v[32:35]
    s_add_u32 s34, s34, 0x4000
    ds_read_b128 a[180:183], v2 offset:13312
    v_cvt_pk_bf16_f32 v201, v234, v235
    v_mfma_f32_16x16x32_bf16 v[180:183], a[144:147], v[112:115], v[36:39]
    s_and_b32 s52, s52, 0xffff
    v_exp_f32 v236, v152
    v_mfma_f32_16x16x32_bf16 v[176:179], a[148:151], v[100:103], v[176:179]
    buffer_load_dwordx4 v1, s[16:19], s32 offen offset:1024 sc1 lds
    ds_read_b128 a[184:187], v2 offset:14336
    v_mfma_f32_16x16x32_bf16 v[180:183], a[148:151], v[116:119], v[180:183]
    s_waitcnt lgkmcnt(7)
    ds_read_b128 a[188:191], v2 offset:15360
    v_exp_f32 v237, v153
    v_mfma_f32_16x16x32_bf16 v[176:179], a[152:155], v[104:107], v[176:179]
    v_exp_f32 v238, v154
    v_mfma_f32_16x16x32_bf16 v[180:183], a[152:155], v[120:123], v[180:183]
    v_cvt_pk_bf16_f32 v202, v236, v237
    v_or3_b32 v57, v57, v201, v202
    v_mfma_f32_16x16x32_bf16 v[176:179], a[156:159], v[108:111], v[176:179]
    s_and_b32 s34, s34, 0xffff
    v_exp_f32 v239, v155
    v_mfma_f32_16x16x32_bf16 v[180:183], a[156:159], v[124:127], v[180:183]
    s_waitcnt lgkmcnt(6)
    v_add_u32 v2, s52, v1
    v_cvt_pk_bf16_f32 v203, v238, v239
    v_mfma_f32_16x16x32_bf16 v[168:171], a[160:163], v[96:99], v[24:27]
    ds_read_b128 a[192:195], v3 offset:0
    v_exp_f32 v240, v140
    v_mfma_f32_16x16x32_bf16 v[172:175], a[160:163], v[112:115], v[28:31]
    v_exp_f32 v241, v141
    v_mfma_f32_16x16x32_bf16 v[168:171], a[164:167], v[100:103], v[168:171]
    buffer_load_dwordx4 v1, s[16:19], s32 offen offset:2048 sc1 lds
    ds_read_b128 a[196:199], v3 offset:1024
    v_mfma_f32_16x16x32_bf16 v[172:175], a[164:167], v[116:119], v[172:175]
    s_waitcnt lgkmcnt(6)
    v_exp_f32 v242, v142
    v_mfma_f32_16x16x32_bf16 v[168:171], a[168:171], v[104:107], v[168:171]
    ds_read_b128 a[200:203], v3 offset:2048
    v_cvt_pk_bf16_f32 v204, v240, v241
    v_or3_b32 v57, v57, v203, v204
    v_mfma_f32_16x16x32_bf16 v[172:175], a[168:171], v[120:123], v[172:175]
    v_exp_f32 v243, v143
    v_mfma_f32_16x16x32_bf16 v[168:171], a[172:175], v[108:111], v[168:171]
    ds_read_b128 a[204:207], v3 offset:3072
    v_cvt_pk_bf16_f32 v205, v242, v243
    v_mfma_f32_16x16x32_bf16 v[172:175], a[172:175], v[124:127], v[172:175]
    s_waitcnt lgkmcnt(6)
    v_exp_f32 v244, v156
    v_mfma_f32_16x16x32_bf16 v[184:187], a[176:179], v[96:99], v[40:43]
    v_exp_f32 v245, v157
    v_mfma_f32_16x16x32_bf16 v[188:191], a[176:179], v[112:115], v[44:47]
    buffer_load_dwordx4 v1, s[16:19], s32 offen offset:3072 sc1 lds
    ds_read_b128 a[208:211], v3 offset:4096
    ds_read_b128 a[212:215], v3 offset:5120
    v_mfma_f32_16x16x32_bf16 v[184:187], a[180:183], v[100:103], v[184:187]
    s_add_u32 s32, s32, 0x80000
    v_exp_f32 v246, v158
    v_mfma_f32_16x16x32_bf16 v[188:191], a[180:183], v[116:119], v[188:191]
    s_waitcnt lgkmcnt(6)
    v_cvt_pk_bf16_f32 v206, v244, v245
    v_or3_b32 v57, v57, v205, v206
    v_mfma_f32_16x16x32_bf16 v[184:187], a[184:187], v[104:107], v[184:187]
    v_exp_f32 v247, v159
    v_mfma_f32_16x16x32_bf16 v[188:191], a[184:187], v[120:123], v[188:191]
    ds_read_b128 a[216:219], v3 offset:6144
    ds_read_b128 a[220:223], v3 offset:7168
    v_cvt_pk_bf16_f32 v207, v246, v247
    v_mfma_f32_16x16x32_bf16 v[184:187], a[188:191], v[108:111], v[184:187]
    v_bitop3_b32 v57, v57, v207, s37 bitop3:0xa8
    v_cmp_ne_u32 vcc, 0, v57
    v_mfma_f32_16x16x32_bf16 v[188:191], a[188:191], v[124:127], v[188:191]
    s_cbranch_vccnz k2_tramp_102
k2_ret_103:
    s_load_dwordx2 s[4:5], s[0:1], 40
    s_add_u32 s24, s6, 0x3000000
    s_addc_u32 s25, s7, 0
    s_and_b32 s25, s25, 0xffff
    s_mov_b32 s26, 0x1000000
    s_mov_b32 s27, 0x00020000
    s_lshl_b32 s31, s28, 19
    s_lshl_b32 s44, s38, 6
    s_add_u32 s44, s44, s31
    s_add_u32 s45, s44, 131072
    s_add_u32 s46, s44, 262144
    s_add_u32 s47, s44, 393216
    s_add_u32 s48, s44, 4096
    s_add_u32 s49, s44, 135168
    s_add_u32 s50, s44, 266240
    s_add_u32 s51, s44, 397312
    v_mov_b32 v13, v12
    v_mov_b32 v49, v48
    s_nop 1
    v_permlane16_swap_b32 v12, v13
    v_permlane16_swap_b32 v48, v49
    s_nop 1
    v_add_f32 v12, v12, v13
    v_add_f32 v48, v48, v49
    v_mov_b32 v13, v12
    v_mov_b32 v49, v48
    s_nop 1
    v_permlane32_swap_b32 v12, v13
    v_permlane32_swap_b32 v48, v49
    s_nop 1
    v_add_f32 v12, v12, v13
    v_add_f32 v48, v48, v49
    v_rcp_f32 v13, v12
    v_rcp_f32 v49, v48
    v_rcp_f32 v12, v12
    v_rcp_f32 v48, v48
    s_nop 0
    v_accvgpr_read_b32 v68, a0
    v_accvgpr_read_b32 v69, a1
    v_accvgpr_read_b32 v70, a2
    v_accvgpr_read_b32 v71, a3
    v_accvgpr_read_b32 v72, a16
    v_accvgpr_read_b32 v73, a17
    v_accvgpr_read_b32 v74, a18
    v_accvgpr_read_b32 v75, a19
    v_pk_mul_f32 v[68:69], v[68:69], v[12:13]
    v_pk_mul_f32 v[70:71], v[70:71], v[12:13]
    v_pk_mul_f32 v[72:73], v[72:73], v[12:13]
    v_pk_mul_f32 v[74:75], v[74:75], v[12:13]
    v_cvt_pk_bf16_f32 v64, v68, v69
    v_cvt_pk_bf16_f32 v65, v70, v71
    v_cvt_pk_bf16_f32 v66, v72, v73
    v_cvt_pk_bf16_f32 v67, v74, v75
    buffer_store_dwordx4 v[64:67], v1, s[24:27], s44 offen sc1
    v_accvgpr_read_b32 v80, a32
    v_accvgpr_read_b32 v81, a33
    v_accvgpr_read_b32 v82, a34
    v_accvgpr_read_b32 v83, a35
    v_accvgpr_read_b32 v84, a48
    v_accvgpr_read_b32 v85, a49
    v_accvgpr_read_b32 v86, a50
    v_accvgpr_read_b32 v87, a51
    v_pk_mul_f32 v[80:81], v[80:81], v[12:13]
    v_pk_mul_f32 v[82:83], v[82:83], v[12:13]
    v_pk_mul_f32 v[84:85], v[84:85], v[12:13]
    v_pk_mul_f32 v[86:87], v[86:87], v[12:13]
    v_cvt_pk_bf16_f32 v76, v80, v81
    v_cvt_pk_bf16_f32 v77, v82, v83
    v_cvt_pk_bf16_f32 v78, v84, v85
    v_cvt_pk_bf16_f32 v79, v86, v87
    buffer_store_dwordx4 v[76:79], v1, s[24:27], s45 offen sc1
    v_accvgpr_read_b32 v68, a64
    v_accvgpr_read_b32 v69, a65
    v_accvgpr_read_b32 v70, a66
    v_accvgpr_read_b32 v71, a67
    v_accvgpr_read_b32 v72, a80
    v_accvgpr_read_b32 v73, a81
    v_accvgpr_read_b32 v74, a82
    v_accvgpr_read_b32 v75, a83
    v_pk_mul_f32 v[68:69], v[68:69], v[12:13]
    v_pk_mul_f32 v[70:71], v[70:71], v[12:13]
    v_pk_mul_f32 v[72:73], v[72:73], v[12:13]
    v_pk_mul_f32 v[74:75], v[74:75], v[12:13]
    v_cvt_pk_bf16_f32 v64, v68, v69
    v_cvt_pk_bf16_f32 v65, v70, v71
    v_cvt_pk_bf16_f32 v66, v72, v73
    v_cvt_pk_bf16_f32 v67, v74, v75
    buffer_store_dwordx4 v[64:67], v1, s[24:27], s46 offen sc1
    v_accvgpr_read_b32 v80, a96
    v_accvgpr_read_b32 v81, a97
    v_accvgpr_read_b32 v82, a98
    v_accvgpr_read_b32 v83, a99
    v_accvgpr_read_b32 v84, a112
    v_accvgpr_read_b32 v85, a113
    v_accvgpr_read_b32 v86, a114
    v_accvgpr_read_b32 v87, a115
    v_pk_mul_f32 v[80:81], v[80:81], v[12:13]
    v_pk_mul_f32 v[82:83], v[82:83], v[12:13]
    v_pk_mul_f32 v[84:85], v[84:85], v[12:13]
    v_pk_mul_f32 v[86:87], v[86:87], v[12:13]
    v_cvt_pk_bf16_f32 v76, v80, v81
    v_cvt_pk_bf16_f32 v77, v82, v83
    v_cvt_pk_bf16_f32 v78, v84, v85
    v_cvt_pk_bf16_f32 v79, v86, v87
    buffer_store_dwordx4 v[76:79], v1, s[24:27], s47 offen sc1
    v_accvgpr_read_b32 v68, a4
    v_accvgpr_read_b32 v69, a5
    v_accvgpr_read_b32 v70, a6
    v_accvgpr_read_b32 v71, a7
    v_accvgpr_read_b32 v72, a20
    v_accvgpr_read_b32 v73, a21
    v_accvgpr_read_b32 v74, a22
    v_accvgpr_read_b32 v75, a23
    v_pk_mul_f32 v[68:69], v[68:69], v[48:49]
    v_pk_mul_f32 v[70:71], v[70:71], v[48:49]
    v_pk_mul_f32 v[72:73], v[72:73], v[48:49]
    v_pk_mul_f32 v[74:75], v[74:75], v[48:49]
    v_cvt_pk_bf16_f32 v64, v68, v69
    v_cvt_pk_bf16_f32 v65, v70, v71
    v_cvt_pk_bf16_f32 v66, v72, v73
    v_cvt_pk_bf16_f32 v67, v74, v75
    buffer_store_dwordx4 v[64:67], v1, s[24:27], s48 offen sc1
    v_accvgpr_read_b32 v80, a36
    v_accvgpr_read_b32 v81, a37
    v_accvgpr_read_b32 v82, a38
    v_accvgpr_read_b32 v83, a39
    v_accvgpr_read_b32 v84, a52
    v_accvgpr_read_b32 v85, a53
    v_accvgpr_read_b32 v86, a54
    v_accvgpr_read_b32 v87, a55
    v_pk_mul_f32 v[80:81], v[80:81], v[48:49]
    v_pk_mul_f32 v[82:83], v[82:83], v[48:49]
    v_pk_mul_f32 v[84:85], v[84:85], v[48:49]
    v_pk_mul_f32 v[86:87], v[86:87], v[48:49]
    v_cvt_pk_bf16_f32 v76, v80, v81
    v_cvt_pk_bf16_f32 v77, v82, v83
    v_cvt_pk_bf16_f32 v78, v84, v85
    v_cvt_pk_bf16_f32 v79, v86, v87
    buffer_store_dwordx4 v[76:79], v1, s[24:27], s49 offen sc1
    v_accvgpr_read_b32 v68, a68
    v_accvgpr_read_b32 v69, a69
    v_accvgpr_read_b32 v70, a70
    v_accvgpr_read_b32 v71, a71
    v_accvgpr_read_b32 v72, a84
    v_accvgpr_read_b32 v73, a85
    v_accvgpr_read_b32 v74, a86
    v_accvgpr_read_b32 v75, a87
    v_pk_mul_f32 v[68:69], v[68:69], v[48:49]
    v_pk_mul_f32 v[70:71], v[70:71], v[48:49]
    v_pk_mul_f32 v[72:73], v[72:73], v[48:49]
    v_pk_mul_f32 v[74:75], v[74:75], v[48:49]
    v_cvt_pk_bf16_f32 v64, v68, v69
    v_cvt_pk_bf16_f32 v65, v70, v71
    v_cvt_pk_bf16_f32 v66, v72, v73
    v_cvt_pk_bf16_f32 v67, v74, v75
    buffer_store_dwordx4 v[64:67], v1, s[24:27], s50 offen sc1
    v_accvgpr_read_b32 v80, a100
    v_accvgpr_read_b32 v81, a101
    v_accvgpr_read_b32 v82, a102
    v_accvgpr_read_b32 v83, a103
    v_accvgpr_read_b32 v84, a116
    v_accvgpr_read_b32 v85, a117
    v_accvgpr_read_b32 v86, a118
    v_accvgpr_read_b32 v87, a119
    v_pk_mul_f32 v[80:81], v[80:81], v[48:49]
    v_pk_mul_f32 v[82:83], v[82:83], v[48:49]
    v_pk_mul_f32 v[84:85], v[84:85], v[48:49]
    v_pk_mul_f32 v[86:87], v[86:87], v[48:49]
    v_cvt_pk_bf16_f32 v76, v80, v81
    v_cvt_pk_bf16_f32 v77, v82, v83
    v_cvt_pk_bf16_f32 v78, v84, v85
    v_cvt_pk_bf16_f32 v79, v86, v87
    buffer_store_dwordx4 v[76:79], v1, s[24:27], s51 offen sc1
    s_nop 1
    s_lshr_b32 s31, s2, 3
    s_bfe_u32 s56, s2, 0x10002
    s_and_b32 s54, s2, 1
    s_lshl_b32 s54, s54, 3
    s_and_b32 s55, s31, 7
    s_add_u32 s54, s54, s55
    s_and_b32 s55, s2, 2
    s_lshl_b32 s55, s55, 1
    s_lshr_b32 s31, s31, 3
    s_add_u32 s55, s55, s31
    v_lshrrev_b32 v87, 4, v1
    v_lshrrev_b32 v72, 4, v87
    s_lshl_b32 s57, s54, 7
    s_lshl_b32 s31, s30, 5
    s_add_u32 s57, s57, s31
    s_lshl_b32 s31, s57, 6
    v_add_u32 v88, s31, v1
    v_add_u32 v89, 0x20000, v88
    v_bfe_u32 v84, v87, 1, 3
    v_xor_b32 v84, v84, v72
    v_and_b32 v85, 16, v1
    v_lshl_add_u32 v85, v72, 11, v85
    s_lshl_b32 s31, s30, 15
    s_lshl_b32 s58, s55, 8
    s_add_u32 s31, s31, s58
    v_add_u32 v85, s31, v85
    v_xor_b32 v86, 0, v84
    v_lshl_add_u32 v86, v86, 5, v85
    v_add_u32 v90, 0, v86
    v_xor_b32 v86, 4, v84
    v_lshl_add_u32 v86, v86, 5, v85
    v_add_u32 v91, 7168, v86
    v_xor_b32 v86, 0, v84
    v_lshl_add_u32 v86, v86, 5, v85
    v_add_u32 v92, 14336, v86
    v_xor_b32 v86, 4, v84
    v_lshl_add_u32 v86, v86, 5, v85
    v_add_u32 v93, 21504, v86
    v_and_b32 v84, 15, v87
    v_add_u32 v85, s57, v84
    v_lshlrev_b32 v77, 2, v85
    v_lshl_add_u32 v77, v72, 13, v77
    s_lshl_b32 s31, s56, 7
    s_add_u32 s58, s58, s31
    v_lshl_add_u32 v80, v72, 3, s58
    v_lshl_add_u32 v78, v85, 11, v80
    v_add_u32 v79, 0x8000, v78
    v_lshrrev_b32 v85, 2, v84
    v_lshl_add_u32 v85, v72, 2, v85
    v_and_b32 v84, 7, v85
    s_lshl_b32 s31, s56, 2
    v_xor_b32 v84, s31, v84
    v_lshlrev_b32 v85, 8, v85
    v_and_b32 v86, 3, v87
    v_lshl_add_u32 v85, v86, 3, v85
    s_add_u32 s31, s2, 1
    s_and_b32 s31, s31, 3
    v_add_u32 v73, s31, v86
    v_and_b32 v73, 3, v73
    v_lshlrev_b32 v73, 7, v73
    v_xor_b32 v86, 0, v84
    v_lshl_add_u32 v64, v86, 5, v85
    v_xor_b32 v86, 1, v84
    v_lshl_add_u32 v65, v86, 5, v85
    v_xor_b32 v86, 2, v84
    v_lshl_add_u32 v66, v86, 5, v85
    v_xor_b32 v86, 3, v84
    v_lshl_add_u32 v67, v86, 5, v85
    v_xor_b32 v86, 4, v84
    v_lshl_add_u32 v68, v86, 5, v85
    v_xor_b32 v86, 5, v84
    v_lshl_add_u32 v69, v86, 5, v85
    v_xor_b32 v86, 6, v84
    v_lshl_add_u32 v70, v86, 5, v85
    v_xor_b32 v86, 7, v84
    v_lshl_add_u32 v71, v86, 5, v85
    s_lshl_b32 s61, s31, 20
    s_lshl_b32 s62, s31, 21
    s_lshl_b32 s60, s30, 12
    s_lshl_b32 s59, s54, 10
    s_lshl_b32 s31, s56, 9
    s_add_u32 s59, s59, s31
    s_lshr_b32 s31, s28, 2
    s_lshl_b32 s31, s31, 7
    s_lshl_b32 s57, s29, 10
    s_sub_u32 s58, 0x3c00, s57
    s_add_u32 s57, s57, s31
    s_add_u32 s58, s58, s31
    v_mov_b32 v75, 0
    v_mov_b32 v76, 1
    s_lshl_b32 s31, s56, 23
    s_add_u32 s31, s31, 0x3000000
    s_add_u32 s8, s6, s31
    s_addc_u32 s9, s7, 0
    s_and_b32 s9, s9, 0xffff
    s_mov_b32 s10, 0x800000
    s_lshl_b32 s31, s56, 22
    s_waitcnt lgkmcnt(0)
    s_add_u32 s12, s4, s31
    s_addc_u32 s13, s5, 0
    s_and_b32 s13, s13, 0xffff
    s_mov_b32 s14, 0x400000
    s_lshl_b32 s63, s29, 1
    s_sub_u32 s63, 13, s63
    s_cbranch_scc1 k2_sdone_105
k2_sloop_104:
    v_mfma_f32_16x16x32_bf16 v[248:251], v[60:63], v[192:195], v[248:251]
    v_exp_f32 v232, v160
    v_mfma_f32_16x16x32_bf16 v[252:255], v[60:63], v[196:199], v[252:255]
    s_mov_b32 m0, s35
    ds_read_b128 a[224:227], v3 offset:8192
    v_mfma_f32_16x16x32_bf16 v[248:251], v[60:63], v[200:203], v[248:251]
    s_add_u32 s53, s53, 16384
    buffer_load_dwordx4 v1, s[20:23], s33 offen offset:0 sc1 lds
    ds_read_b128 a[228:231], v3 offset:9216
    v_mfma_f32_16x16x32_bf16 v[252:255], v[60:63], v[204:207], v[252:255]
    s_waitcnt lgkmcnt(8)
    v_exp_f32 v233, v161
    v_mfma_f32_16x16x32_bf16 a[8:11], a[192:195], v[192:195], a[8:11]
    s_and_b32 s53, s53, 0xffff
    v_exp_f32 v234, v162
    v_mfma_f32_16x16x32_bf16 a[12:15], a[192:195], v[196:199], a[12:15]
    ds_read_b128 a[232:235], v3 offset:10240
    v_cvt_pk_bf16_f32 v208, v232, v233
    v_mfma_f32_16x16x32_bf16 a[24:27], a[196:199], v[192:195], a[24:27]
    v_exp_f32 v235, v163
    v_mfma_f32_16x16x32_bf16 a[28:31], a[196:199], v[196:199], a[28:31]
    s_waitcnt lgkmcnt(7)
    ds_read_b128 a[236:239], v3 offset:11264
    v_cvt_pk_bf16_f32 v209, v234, v235
    v_mfma_f32_16x16x32_bf16 a[40:43], a[200:203], v[192:195], a[40:43]
    s_add_u32 s35, s35, 0x4000
    v_exp_f32 v236, v176
    v_mfma_f32_16x16x32_bf16 a[44:47], a[200:203], v[196:199], a[44:47]
    buffer_load_dwordx4 v1, s[20:23], s33 offen offset:1024 sc1 lds
    ds_read_b128 a[240:243], v3 offset:12288
    v_mfma_f32_16x16x32_bf16 a[56:59], a[204:207], v[192:195], a[56:59]
    v_exp_f32 v237, v177
    v_mfma_f32_16x16x32_bf16 a[60:63], a[204:207], v[196:199], a[60:63]
    s_waitcnt lgkmcnt(7)
    ds_read_b128 a[244:247], v3 offset:13312
    v_cvt_pk_bf16_f32 v210, v236, v237
    v_mfma_f32_16x16x32_bf16 a[72:75], a[208:211], v[192:195], a[72:75]
    v_exp_f32 v238, v178
    v_mfma_f32_16x16x32_bf16 a[76:79], a[208:211], v[196:199], a[76:79]
    ds_read_b128 a[248:251], v3 offset:14336
    v_or3_b32 v57, v208, v209, v210
    v_mfma_f32_16x16x32_bf16 a[88:91], a[212:215], v[192:195], a[88:91]
    v_exp_f32 v239, v179
    v_mfma_f32_16x16x32_bf16 a[92:95], a[212:215], v[196:199], a[92:95]
    s_waitcnt lgkmcnt(7)
    ds_read_b128 a[252:255], v3 offset:15360
    v_cvt_pk_bf16_f32 v211, v238, v239
    v_mfma_f32_16x16x32_bf16 a[104:107], a[216:219], v[192:195], a[104:107]
    s_and_b32 s35, s35, 0xffff
    v_exp_f32 v240, v164
    v_mfma_f32_16x16x32_bf16 a[108:111], a[216:219], v[196:199], a[108:111]
    ds_read_b128 a[128:131], v2 offset:0
    v_add_u32 v3, s53, v56
    v_mfma_f32_16x16x32_bf16 a[120:123], a[220:223], v[192:195], a[120:123]
    v_exp_f32 v241, v165
    v_mfma_f32_16x16x32_bf16 a[124:127], a[220:223], v[196:199], a[124:127]
    s_waitcnt lgkmcnt(7)
    buffer_load_dwordx4 v1, s[20:23], s33 offen offset:2048 sc1 lds
    ds_read_b128 a[132:135], v2 offset:1024
    v_mfma_f32_16x16x32_bf16 a[8:11], a[224:227], v[200:203], a[8:11]
    v_exp_f32 v242, v166
    v_mfma_f32_16x16x32_bf16 a[12:15], a[224:227], v[204:207], a[12:15]
    s_or_b32 s35, s35, 0x10000
    ds_read_b128 a[136:139], v2 offset:2048
    v_cvt_pk_bf16_f32 v212, v240, v241
    v_mfma_f32_16x16x32_bf16 a[24:27], a[228:231], v[200:203], a[24:27]
    v_exp_f32 v243, v167
    v_mfma_f32_16x16x32_bf16 a[28:31], a[228:231], v[204:207], a[28:31]
    s_waitcnt lgkmcnt(7)
    ds_read_b128 a[140:143], v2 offset:3072
    v_or3_b32 v57, v57, v211, v212
    v_mfma_f32_16x16x32_bf16 a[40:43], a[232:235], v[200:203], a[40:43]
    v_exp_f32 v244, v180
    v_mfma_f32_16x16x32_bf16 a[44:47], a[232:235], v[204:207], a[44:47]
    ds_read_b128 a[144:147], v2 offset:4096
    v_cvt_pk_bf16_f32 v213, v242, v243
    v_mfma_f32_16x16x32_bf16 a[56:59], a[236:239], v[200:203], a[56:59]
    v_exp_f32 v245, v181
    v_mfma_f32_16x16x32_bf16 a[60:63], a[236:239], v[204:207], a[60:63]
    s_waitcnt lgkmcnt(7)
    buffer_load_dwordx4 v1, s[20:23], s33 offen offset:3072 sc1 lds
    ds_read_b128 a[148:151], v2 offset:5120
    v_mfma_f32_16x16x32_bf16 a[72:75], a[240:243], v[200:203], a[72:75]
    s_add_u32 s33, s33, 0x80000
    v_exp_f32 v246, v182
    v_mfma_f32_16x16x32_bf16 a[76:79], a[240:243], v[204:207], a[76:79]
    ds_read_b128 a[152:155], v2 offset:6144
    v_cvt_pk_bf16_f32 v214, v244, v245
    v_mfma_f32_16x16x32_bf16 a[88:91], a[244:247], v[200:203], a[88:91]
    v_exp_f32 v247, v183
    v_mfma_f32_16x16x32_bf16 a[92:95], a[244:247], v[204:207], a[92:95]
    s_waitcnt lgkmcnt(7)
    ds_read_b128 a[156:159], v2 offset:7168
    v_or3_b32 v57, v57, v213, v214
    v_mfma_f32_16x16x32_bf16 a[104:107], a[248:251], v[200:203], a[104:107]
    v_exp_f32 v232, v168
    v_mfma_f32_16x16x32_bf16 a[108:111], a[248:251], v[204:207], a[108:111]
    ds_read_b128 a[160:163], v2 offset:8192
    v_cvt_pk_bf16_f32 v215, v246, v247
    v_mfma_f32_16x16x32_bf16 a[120:123], a[252:255], v[200:203], a[120:123]
    v_exp_f32 v233, v169
    v_mfma_f32_16x16x32_bf16 a[124:127], a[252:255], v[204:207], a[124:127]
    s_waitcnt lgkmcnt(7)
    ds_read_b128 a[164:167], v2 offset:9216
    v_cvt_pk_bf16_f32 v216, v232, v233
    v_mfma_f32_16x16x32_bf16 v[128:131], a[128:131], v[96:99], v[16:19]
    s_waitcnt vmcnt(12)
    s_barrier
    v_exp_f32 v234, v170
    v_mfma_f32_16x16x32_bf16 v[132:135], a[128:131], v[112:115], v[20:23]
    s_mov_b32 m0, s34
    ds_read_b128 a[168:171], v2 offset:10240
    v_or3_b32 v57, v57, v215, v216
    v_mfma_f32_16x16x32_bf16 v[128:131], a[132:135], v[100:103], v[128:131]
    buffer_load_dwordx4 v1, s[16:19], s32 offen offset:0 sc1 lds
    ds_read_b128 a[172:175], v2 offset:11264
    v_mfma_f32_16x16x32_bf16 v[132:135], a[132:135], v[116:119], v[132:135]
    s_waitcnt lgkmcnt(8)
    v_exp_f32 v235, v171
    v_mfma_f32_16x16x32_bf16 v[128:131], a[136:139], v[104:107], v[128:131]
    s_add_u32 s36, s36, 64
    v_exp_f32 v236, v184
    v_mfma_f32_16x16x32_bf16 v[132:135], a[136:139], v[120:123], v[132:135]
    ds_read_b128 a[176:179], v2 offset:12288
    v_cvt_pk_bf16_f32 v217, v234, v235
    v_mfma_f32_16x16x32_bf16 v[128:131], a[140:143], v[108:111], v[128:131]
    s_add_u32 s52, s52, 16384
    v_exp_f32 v237, v185
    v_mfma_f32_16x16x32_bf16 v[132:135], a[140:143], v[124:127], v[132:135]
    s_waitcnt lgkmcnt(7)
    ds_read_b128 a[180:183], v2 offset:13312
    v_cvt_pk_bf16_f32 v218, v236, v237
    v_mfma_f32_16x16x32_bf16 v[144:147], a[144:147], v[96:99], v[32:35]
    s_add_u32 s34, s34, 0x4000
    v_exp_f32 v238, v186
    v_mfma_f32_16x16x32_bf16 v[148:151], a[144:147], v[112:115], v[36:39]
    s_and_b32 s52, s52, 0xffff
    buffer_load_dwordx4 v1, s[16:19], s32 offen offset:1024 sc1 lds
    ds_read_b128 a[184:187], v2 offset:14336
    v_mfma_f32_16x16x32_bf16 v[144:147], a[148:151], v[100:103], v[144:147]
    v_exp_f32 v239, v187
    v_mfma_f32_16x16x32_bf16 v[148:151], a[148:151], v[116:119], v[148:151]
    s_waitcnt lgkmcnt(7)
    ds_read_b128 a[188:191], v2 offset:15360
    v_or3_b32 v57, v57, v217, v218
    v_mfma_f32_16x16x32_bf16 v[144:147], a[152:155], v[104:107], v[144:147]
    v_exp_f32 v240, v172
    v_mfma_f32_16x16x32_bf16 v[148:151], a[152:155], v[120:123], v[148:151]
    v_cvt_pk_bf16_f32 v219, v238, v239
    v_add_u32 v2, s52, v1
    v_mfma_f32_16x16x32_bf16 v[144:147], a[156:159], v[108:111], v[144:147]
    s_and_b32 s34, s34, 0xffff
    v_exp_f32 v241, v173
    v_mfma_f32_16x16x32_bf16 v[148:151], a[156:159], v[124:127], v[148:151]
    s_waitcnt lgkmcnt(6)
    ds_read_b128 a[192:195], v3 offset:0
    v_cvt_pk_bf16_f32 v220, v240, v241
    v_mfma_f32_16x16x32_bf16 v[136:139], a[160:163], v[96:99], v[24:27]
    v_exp_f32 v242, v174
    v_mfma_f32_16x16x32_bf16 v[140:143], a[160:163], v[112:115], v[28:31]
    buffer_load_dwordx4 v1, s[16:19], s32 offen offset:2048 sc1 lds
    ds_read_b128 a[196:199], v3 offset:1024
    v_mfma_f32_16x16x32_bf16 v[136:139], a[164:167], v[100:103], v[136:139]
    v_exp_f32 v243, v175
    v_mfma_f32_16x16x32_bf16 v[140:143], a[164:167], v[116:119], v[140:143]
    s_waitcnt lgkmcnt(6)
    ds_read_b128 a[200:203], v3 offset:2048
    v_or3_b32 v57, v57, v219, v220
    v_mfma_f32_16x16x32_bf16 v[136:139], a[168:171], v[104:107], v[136:139]
    v_exp_f32 v244, v188
    v_mfma_f32_16x16x32_bf16 v[140:143], a[168:171], v[120:123], v[140:143]
    ds_read_b128 a[204:207], v3 offset:3072
    v_cvt_pk_bf16_f32 v221, v242, v243
    v_mfma_f32_16x16x32_bf16 v[136:139], a[172:175], v[108:111], v[136:139]
    v_exp_f32 v245, v189
    v_mfma_f32_16x16x32_bf16 v[140:143], a[172:175], v[124:127], v[140:143]
    s_waitcnt lgkmcnt(6)
    buffer_load_dwordx4 v1, s[16:19], s32 offen offset:3072 sc1 lds
    ds_read_b128 a[208:211], v3 offset:4096
    v_mfma_f32_16x16x32_bf16 v[152:155], a[176:179], v[96:99], v[40:43]
    s_add_u32 s32, s32, 0x80000
    v_exp_f32 v246, v190
    v_mfma_f32_16x16x32_bf16 v[156:159], a[176:179], v[112:115], v[44:47]
    ds_read_b128 a[212:215], v3 offset:5120
    v_cvt_pk_bf16_f32 v222, v244, v245
    v_mfma_f32_16x16x32_bf16 v[152:155], a[180:183], v[100:103], v[152:155]
    v_exp_f32 v247, v191
    v_mfma_f32_16x16x32_bf16 v[156:159], a[180:183], v[116:119], v[156:159]
    s_waitcnt lgkmcnt(6)
    ds_read_b128 a[216:219], v3 offset:6144
    v_or3_b32 v57, v57, v221, v222
    v_mfma_f32_16x16x32_bf16 v[152:155], a[184:187], v[104:107], v[152:155]
    ds_read_b128 a[220:223], v3 offset:7168
    v_cvt_pk_bf16_f32 v223, v246, v247
    v_mfma_f32_16x16x32_bf16 v[156:159], a[184:187], v[120:123], v[156:159]
    v_bitop3_b32 v57, v57, v223, s37 bitop3:0xa8
    v_cmp_ne_u32 vcc, 0, v57
    v_mfma_f32_16x16x32_bf16 v[152:155], a[188:191], v[108:111], v[152:155]
    v_mfma_f32_16x16x32_bf16 v[156:159], a[188:191], v[124:127], v[156:159]
    s_cbranch_vccnz k2_tramp_106
k2_ret_107:
    v_mfma_f32_16x16x32_bf16 v[248:251], v[60:63], v[208:211], v[248:251]
    v_exp_f32 v232, v128
    v_mfma_f32_16x16x32_bf16 v[252:255], v[60:63], v[212:215], v[252:255]
    s_mov_b32 m0, s35
    ds_read_b128 a[224:227], v3 offset:8192
    v_mfma_f32_16x16x32_bf16 v[248:251], v[60:63], v[216:219], v[248:251]
    s_add_u32 s53, s53, 16384
    buffer_load_dwordx4 v1, s[20:23], s33 offen offset:0 sc1 lds
    ds_read_b128 a[228:231], v3 offset:9216
    v_mfma_f32_16x16x32_bf16 v[252:255], v[60:63], v[220:223], v[252:255]
    s_waitcnt lgkmcnt(8)
    v_exp_f32 v233, v129
    v_mfma_f32_16x16x32_bf16 a[8:11], a[192:195], v[208:211], a[8:11]
    s_and_b32 s53, s53, 0xffff
    v_exp_f32 v234, v130
    v_mfma_f32_16x16x32_bf16 a[12:15], a[192:195], v[212:215], a[12:15]
    ds_read_b128 a[232:235], v3 offset:10240
    v_cvt_pk_bf16_f32 v192, v232, v233
    v_mfma_f32_16x16x32_bf16 a[24:27], a[196:199], v[208:211], a[24:27]
    v_exp_f32 v235, v131
    v_mfma_f32_16x16x32_bf16 a[28:31], a[196:199], v[212:215], a[28:31]
    s_waitcnt lgkmcnt(7)
    ds_read_b128 a[236:239], v3 offset:11264
    v_cvt_pk_bf16_f32 v193, v234, v235
    v_mfma_f32_16x16x32_bf16 a[40:43], a[200:203], v[208:211], a[40:43]
    s_add_u32 s35, s35, 0x4000
    v_exp_f32 v236, v144
    v_mfma_f32_16x16x32_bf16 a[44:47], a[200:203], v[212:215], a[44:47]
    buffer_load_dwordx4 v1, s[20:23], s33 offen offset:1024 sc1 lds
    ds_read_b128 a[240:243], v3 offset:12288
    v_mfma_f32_16x16x32_bf16 a[56:59], a[204:207], v[208:211], a[56:59]
    v_exp_f32 v237, v145
    v_mfma_f32_16x16x32_bf16 a[60:63], a[204:207], v[212:215], a[60:63]
    s_waitcnt lgkmcnt(7)
    ds_read_b128 a[244:247], v3 offset:13312
    v_cvt_pk_bf16_f32 v194, v236, v237
    v_mfma_f32_16x16x32_bf16 a[72:75], a[208:211], v[208:211], a[72:75]
    v_exp_f32 v238, v146
    v_mfma_f32_16x16x32_bf16 a[76:79], a[208:211], v[212:215], a[76:79]
    ds_read_b128 a[248:251], v3 offset:14336
    v_or3_b32 v57, v192, v193, v194
    v_mfma_f32_16x16x32_bf16 a[88:91], a[212:215], v[208:211], a[88:91]
    v_exp_f32 v239, v147
    v_mfma_f32_16x16x32_bf16 a[92:95], a[212:215], v[212:215], a[92:95]
    s_waitcnt lgkmcnt(7)
    ds_read_b128 a[252:255], v3 offset:15360
    v_cvt_pk_bf16_f32 v195, v238, v239
    v_mfma_f32_16x16x32_bf16 a[104:107], a[216:219], v[208:211], a[104:107]
    s_and_b32 s35, s35, 0xffff
    v_exp_f32 v240, v132
    v_mfma_f32_16x16x32_bf16 a[108:111], a[216:219], v[212:215], a[108:111]
    ds_read_b128 a[128:131], v2 offset:0
    v_add_u32 v3, s53, v56
    v_mfma_f32_16x16x32_bf16 a[120:123], a[220:223], v[208:211], a[120:123]
    v_exp_f32 v241, v133
    v_mfma_f32_16x16x32_bf16 a[124:127], a[220:223], v[212:215], a[124:127]
    s_waitcnt lgkmcnt(7)
    buffer_load_dwordx4 v1, s[20:23], s33 offen offset:2048 sc1 lds
    ds_read_b128 a[132:135], v2 offset:1024
    v_mfma_f32_16x16x32_bf16 a[8:11], a[224:227], v[216:219], a[8:11]
    v_exp_f32 v242, v134
    v_mfma_f32_16x16x32_bf16 a[12:15], a[224:227], v[220:223], a[12:15]
    s_or_b32 s35, s35, 0x10000
    ds_read_b128 a[136:139], v2 offset:2048
    v_cvt_pk_bf16_f32 v196, v240, v241
    v_mfma_f32_16x16x32_bf16 a[24:27], a[228:231], v[216:219], a[24:27]
    v_exp_f32 v243, v135
    v_mfma_f32_16x16x32_bf16 a[28:31], a[228:231], v[220:223], a[28:31]
    s_waitcnt lgkmcnt(7)
    ds_read_b128 a[140:143], v2 offset:3072
    v_or3_b32 v57, v57, v195, v196
    v_mfma_f32_16x16x32_bf16 a[40:43], a[232:235], v[216:219], a[40:43]
    v_exp_f32 v244, v148
    v_mfma_f32_16x16x32_bf16 a[44:47], a[232:235], v[220:223], a[44:47]
    ds_read_b128 a[144:147], v2 offset:4096
    v_cvt_pk_bf16_f32 v197, v242, v243
    v_mfma_f32_16x16x32_bf16 a[56:59], a[236:239], v[216:219], a[56:59]
    v_exp_f32 v245, v149
    v_mfma_f32_16x16x32_bf16 a[60:63], a[236:239], v[220:223], a[60:63]
    s_waitcnt lgkmcnt(7)
    buffer_load_dwordx4 v1, s[20:23], s33 offen offset:3072 sc1 lds
    ds_read_b128 a[148:151], v2 offset:5120
    v_mfma_f32_16x16x32_bf16 a[72:75], a[240:243], v[216:219], a[72:75]
    s_add_u32 s33, s33, 0x80000
    v_exp_f32 v246, v150
    v_mfma_f32_16x16x32_bf16 a[76:79], a[240:243], v[220:223], a[76:79]
    ds_read_b128 a[152:155], v2 offset:6144
    v_cvt_pk_bf16_f32 v198, v244, v245
    v_mfma_f32_16x16x32_bf16 a[88:91], a[244:247], v[216:219], a[88:91]
    v_exp_f32 v247, v151
    v_mfma_f32_16x16x32_bf16 a[92:95], a[244:247], v[220:223], a[92:95]
    s_waitcnt lgkmcnt(7)
    ds_read_b128 a[156:159], v2 offset:7168
    v_or3_b32 v57, v57, v197, v198
    v_mfma_f32_16x16x32_bf16 a[104:107], a[248:251], v[216:219], a[104:107]
    v_exp_f32 v232, v136
    v_mfma_f32_16x16x32_bf16 a[108:111], a[248:251], v[220:223], a[108:111]
    ds_read_b128 a[160:163], v2 offset:8192
    v_cvt_pk_bf16_f32 v199, v246, v247
    v_mfma_f32_16x16x32_bf16 a[120:123], a[252:255], v[216:219], a[120:123]
    v_exp_f32 v233, v137
    v_mfma_f32_16x16x32_bf16 a[124:127], a[252:255], v[220:223], a[124:127]
    s_waitcnt lgkmcnt(7)
    ds_read_b128 a[164:167], v2 offset:9216
    v_cvt_pk_bf16_f32 v200, v232, v233
    v_mfma_f32_16x16x32_bf16 v[160:163], a[128:131], v[96:99], v[16:19]
    s_waitcnt vmcnt(12)
    s_barrier
    v_exp_f32 v234, v138
    v_mfma_f32_16x16x32_bf16 v[164:167], a[128:131], v[112:115], v[20:23]
    s_mov_b32 m0, s34
    ds_read_b128 a[168:171], v2 offset:10240
    v_or3_b32 v57, v57, v199, v200
    v_mfma_f32_16x16x32_bf16 v[160:163], a[132:135], v[100:103], v[160:163]
    buffer_load_dwordx4 v1, s[16:19], s32 offen offset:0 sc1 lds
    ds_read_b128 a[172:175], v2 offset:11264
    v_mfma_f32_16x16x32_bf16 v[164:167], a[132:135], v[116:119], v[164:167]
    s_waitcnt lgkmcnt(8)
    v_exp_f32 v235, v139
    v_mfma_f32_16x16x32_bf16 v[160:163], a[136:139], v[104:107], v[160:163]
    s_add_u32 s36, s36, 64
    v_exp_f32 v236, v152
    v_mfma_f32_16x16x32_bf16 v[164:167], a[136:139], v[120:123], v[164:167]
    ds_read_b128 a[176:179], v2 offset:12288
    v_cvt_pk_bf16_f32 v201, v234, v235
    v_mfma_f32_16x16x32_bf16 v[160:163], a[140:143], v[108:111], v[160:163]
    s_add_u32 s52, s52, 16384
    v_exp_f32 v237, v153
    v_mfma_f32_16x16x32_bf16 v[164:167], a[140:143], v[124:127], v[164:167]
    s_waitcnt lgkmcnt(7)
    ds_read_b128 a[180:183], v2 offset:13312
    v_cvt_pk_bf16_f32 v202, v236, v237
    v_mfma_f32_16x16x32_bf16 v[176:179], a[144:147], v[96:99], v[32:35]
    s_add_u32 s34, s34, 0x4000
    v_exp_f32 v238, v154
    v_mfma_f32_16x16x32_bf16 v[180:183], a[144:147], v[112:115], v[36:39]
    s_and_b32 s52, s52, 0xffff
    buffer_load_dwordx4 v1, s[16:19], s32 offen offset:1024 sc1 lds
    ds_read_b128 a[184:187], v2 offset:14336
    v_mfma_f32_16x16x32_bf16 v[176:179], a[148:151], v[100:103], v[176:179]
    v_exp_f32 v239, v155
    v_mfma_f32_16x16x32_bf16 v[180:183], a[148:151], v[116:119], v[180:183]
    s_waitcnt lgkmcnt(7)
    ds_read_b128 a[188:191], v2 offset:15360
    v_or3_b32 v57, v57, v201, v202
    v_mfma_f32_16x16x32_bf16 v[176:179], a[152:155], v[104:107], v[176:179]
    v_exp_f32 v240, v140
    v_mfma_f32_16x16x32_bf16 v[180:183], a[152:155], v[120:123], v[180:183]
    v_cvt_pk_bf16_f32 v203, v238, v239
    v_add_u32 v2, s52, v1
    v_mfma_f32_16x16x32_bf16 v[176:179], a[156:159], v[108:111], v[176:179]
    s_and_b32 s34, s34, 0xffff
    v_exp_f32 v241, v141
    v_mfma_f32_16x16x32_bf16 v[180:183], a[156:159], v[124:127], v[180:183]
    s_waitcnt lgkmcnt(6)
    ds_read_b128 a[192:195], v3 offset:0
    v_cvt_pk_bf16_f32 v204, v240, v241
    v_mfma_f32_16x16x32_bf16 v[168:171], a[160:163], v[96:99], v[24:27]
    v_exp_f32 v242, v142
    v_mfma_f32_16x16x32_bf16 v[172:175], a[160:163], v[112:115], v[28:31]
    buffer_load_dwordx4 v1, s[16:19], s32 offen offset:2048 sc1 lds
    ds_read_b128 a[196:199], v3 offset:1024
    v_mfma_f32_16x16x32_bf16 v[168:171], a[164:167], v[100:103], v[168:171]
    v_exp_f32 v243, v143
    v_mfma_f32_16x16x32_bf16 v[172:175], a[164:167], v[116:119], v[172:175]
    s_waitcnt lgkmcnt(6)
    ds_read_b128 a[200:203], v3 offset:2048
    v_or3_b32 v57, v57, v203, v204
    v_mfma_f32_16x16x32_bf16 v[168:171], a[168:171], v[104:107], v[168:171]
    v_exp_f32 v244, v156
    v_mfma_f32_16x16x32_bf16 v[172:175], a[168:171], v[120:123], v[172:175]
    ds_read_b128 a[204:207], v3 offset:3072
    v_cvt_pk_bf16_f32 v205, v242, v243
    v_mfma_f32_16x16x32_bf16 v[168:171], a[172:175], v[108:111], v[168:171]
    v_exp_f32 v245, v157
    v_mfma_f32_16x16x32_bf16 v[172:175], a[172:175], v[124:127], v[172:175]
    s_waitcnt lgkmcnt(6)
    buffer_load_dwordx4 v1, s[16:19], s32 offen offset:3072 sc1 lds
    ds_read_b128 a[208:211], v3 offset:4096
    v_mfma_f32_16x16x32_bf16 v[184:187], a[176:179], v[96:99], v[40:43]
    s_sub_u32 s63, s63, 1
    v_exp_f32 v246, v158
    v_mfma_f32_16x16x32_bf16 v[188:191], a[176:179], v[112:115], v[44:47]
    s_add_u32 s32, s32, 0x80000
    ds_read_b128 a[212:215], v3 offset:5120
    v_cvt_pk_bf16_f32 v206, v244, v245
    v_mfma_f32_16x16x32_bf16 v[184:187], a[180:183], v[100:103], v[184:187]
    v_exp_f32 v247, v159
    v_mfma_f32_16x16x32_bf16 v[188:191], a[180:183], v[116:119], v[188:191]
    s_waitcnt lgkmcnt(6)
    ds_read_b128 a[216:219], v3 offset:6144
    v_or3_b32 v57, v57, v205, v206
    v_mfma_f32_16x16x32_bf16 v[184:187], a[184:187], v[104:107], v[184:187]
    ds_read_b128 a[220:223], v3 offset:7168
    v_cvt_pk_bf16_f32 v207, v246, v247
    v_mfma_f32_16x16x32_bf16 v[188:191], a[184:187], v[120:123], v[188:191]
    v_bitop3_b32 v57, v57, v207, s37 bitop3:0xa8
    v_cmp_ne_u32 vcc, 0, v57
    v_mfma_f32_16x16x32_bf16 v[184:187], a[188:191], v[108:111], v[184:187]
    v_mfma_f32_16x16x32_bf16 v[188:191], a[188:191], v[124:127], v[188:191]
    s_cbranch_vccnz k2_tramp_108
k2_ret_109:
    s_cmp_lg_u32 s63, 0
    s_cbranch_scc1 k2_sloop_104
    v_mfma_f32_16x16x32_bf16 v[248:251], v[60:63], v[192:195], v[248:251]
    v_exp_f32 v232, v160
    v_mfma_f32_16x16x32_bf16 v[252:255], v[60:63], v[196:199], v[252:255]
    s_mov_b32 m0, s35
    ds_read_b128 a[224:227], v3 offset:8192
    v_exp_f32 v233, v161
    v_mfma_f32_16x16x32_bf16 v[248:251], v[60:63], v[200:203], v[248:251]
    s_add_u32 s53, s53, 16384
    buffer_load_dwordx4 v1, s[20:23], s33 offen offset:0 sc1 lds
    ds_read_b128 a[228:231], v3 offset:9216
    v_mfma_f32_16x16x32_bf16 v[252:255], v[60:63], v[204:207], v[252:255]
    s_waitcnt lgkmcnt(8)
    v_exp_f32 v234, v162
    v_cvt_pk_bf16_f32 v208, v232, v233
    v_mfma_f32_16x16x32_bf16 a[8:11], a[192:195], v[192:195], a[8:11]
    s_sub_u32 s40, s36, s39
    ds_read_b128 a[232:235], v3 offset:10240
    v_mfma_f32_16x16x32_bf16 a[12:15], a[192:195], v[196:199], a[12:15]
    s_and_b32 s53, s53, 0xffff
    v_subrev_u32 v6, s40, v4
    v_cmp_gt_i32 s[44:45], 0, v6
    v_mfma_f32_16x16x32_bf16 a[24:27], a[196:199], v[192:195], a[24:27]
    v_exp_f32 v235, v163
    v_cmp_gt_i32 s[46:47], 1, v6
    v_mfma_f32_16x16x32_bf16 a[28:31], a[196:199], v[196:199], a[28:31]
    s_waitcnt lgkmcnt(7)
    ds_read_b128 a[236:239], v3 offset:11264
    v_cmp_gt_i32 s[48:49], 2, v6
    v_cmp_gt_i32 s[50:51], 3, v6
    v_mfma_f32_16x16x32_bf16 a[40:43], a[200:203], v[192:195], a[40:43]
    s_add_u32 s35, s35, 0x4000
    v_exp_f32 v236, v176
    v_mfma_f32_16x16x32_bf16 a[44:47], a[200:203], v[196:199], a[44:47]
    ds_read_b128 a[240:243], v3 offset:12288
    v_cvt_pk_bf16_f32 v209, v234, v235
    v_cndmask_b32 v16, v10, v5, s[44:45]
    v_mfma_f32_16x16x32_bf16 a[56:59], a[204:207], v[192:195], a[56:59]
    v_exp_f32 v237, v177
    v_mfma_f32_16x16x32_bf16 a[60:63], a[204:207], v[196:199], a[60:63]
    s_waitcnt lgkmcnt(7)
    ds_read_b128 a[244:247], v3 offset:13312
    v_cndmask_b32 v17, v10, v5, s[46:47]
    v_cndmask_b32 v18, v10, v5, s[48:49]
    v_mfma_f32_16x16x32_bf16 a[72:75], a[208:211], v[192:195], a[72:75]
    buffer_load_dwordx4 v1, s[20:23], s33 offen offset:1024 sc1 lds
    ds_read_b128 a[248:251], v3 offset:14336
    v_mfma_f32_16x16x32_bf16 a[76:79], a[208:211], v[196:199], a[76:79]
    v_cndmask_b32 v19, v10, v5, s[50:51]
    v_cvt_pk_bf16_f32 v210, v236, v237
    v_mfma_f32_16x16x32_bf16 a[88:91], a[212:215], v[192:195], a[88:91]
    v_exp_f32 v238, v178
    v_cmp_gt_i32 s[44:45], 16, v6
    v_mfma_f32_16x16x32_bf16 a[92:95], a[212:215], v[196:199], a[92:95]
    s_waitcnt lgkmcnt(7)
    v_cmp_gt_i32 s[46:47], 17, v6
    v_cmp_gt_i32 s[48:49], 18, v6
    v_mfma_f32_16x16x32_bf16 a[104:107], a[216:219], v[192:195], a[104:107]
    s_and_b32 s35, s35, 0xffff
    v_exp_f32 v239, v179
    v_mfma_f32_16x16x32_bf16 a[108:111], a[216:219], v[196:199], a[108:111]
    ds_read_b128 a[252:255], v3 offset:15360
    v_or3_b32 v57, v208, v209, v210
    v_cmp_gt_i32 s[50:51], 19, v6
    v_mfma_f32_16x16x32_bf16 a[120:123], a[220:223], v[192:195], a[120:123]
    v_exp_f32 v240, v164
    v_mfma_f32_16x16x32_bf16 a[124:127], a[220:223], v[196:199], a[124:127]
    s_waitcnt lgkmcnt(6)
    v_cndmask_b32 v32, v10, v5, s[44:45]
    v_cvt_pk_bf16_f32 v211, v238, v239
    v_cndmask_b32 v33, v10, v5, s[46:47]
    v_mfma_f32_16x16x32_bf16 a[8:11], a[224:227], v[200:203], a[8:11]
    ds_read_b128 a[128:131], v2 offset:0
    v_cndmask_b32 v34, v10, v5, s[48:49]
    v_mfma_f32_16x16x32_bf16 a[12:15], a[224:227], v[204:207], a[12:15]
    s_or_b32 s35, s35, 0x10000
    v_add_u32 v3, s53, v56
    v_cndmask_b32 v35, v10, v5, s[50:51]
    v_mfma_f32_16x16x32_bf16 a[24:27], a[228:231], v[200:203], a[24:27]
    buffer_load_dwordx4 v1, s[20:23], s33 offen offset:2048 sc1 lds
    v_exp_f32 v241, v165
    v_mfma_f32_16x16x32_bf16 a[28:31], a[228:231], v[204:207], a[28:31]
    s_waitcnt lgkmcnt(5)
    ds_read_b128 a[132:135], v2 offset:1024
    v_cmp_gt_i32 s[44:45], 32, v6
    v_mfma_f32_16x16x32_bf16 a[40:43], a[232:235], v[200:203], a[40:43]
    v_exp_f32 v242, v166
    v_cmp_gt_i32 s[46:47], 33, v6
    v_mfma_f32_16x16x32_bf16 a[44:47], a[232:235], v[204:207], a[44:47]
    ds_read_b128 a[136:139], v2 offset:2048
    v_cvt_pk_bf16_f32 v212, v240, v241
    v_mfma_f32_16x16x32_bf16 a[56:59], a[236:239], v[200:203], a[56:59]
    v_cmp_gt_i32 s[48:49], 34, v6
    v_cmp_gt_i32 s[50:51], 35, v6
    v_mfma_f32_16x16x32_bf16 a[60:63], a[236:239], v[204:207], a[60:63]
    s_waitcnt lgkmcnt(5)
    v_exp_f32 v243, v167
    v_or3_b32 v57, v57, v211, v212
    v_mfma_f32_16x16x32_bf16 a[72:75], a[240:243], v[200:203], a[72:75]
    ds_read_b128 a[140:143], v2 offset:3072
    v_cndmask_b32 v24, v10, v5, s[44:45]
    v_mfma_f32_16x16x32_bf16 a[76:79], a[240:243], v[204:207], a[76:79]
    v_cndmask_b32 v25, v10, v5, s[46:47]
    v_exp_f32 v244, v180
    v_mfma_f32_16x16x32_bf16 a[88:91], a[244:247], v[200:203], a[88:91]
    v_cvt_pk_bf16_f32 v213, v242, v243
    v_cndmask_b32 v26, v10, v5, s[48:49]
    v_mfma_f32_16x16x32_bf16 a[92:95], a[244:247], v[204:207], a[92:95]
    s_waitcnt lgkmcnt(4)
    ds_read_b128 a[144:147], v2 offset:4096
    v_cndmask_b32 v27, v10, v5, s[50:51]
    v_mfma_f32_16x16x32_bf16 a[104:107], a[248:251], v[200:203], a[104:107]
    v_exp_f32 v245, v181
    v_cmp_gt_i32 s[44:45], 48, v6
    v_mfma_f32_16x16x32_bf16 a[108:111], a[248:251], v[204:207], a[108:111]
    buffer_load_dwordx4 v1, s[20:23], s33 offen offset:3072 sc1 lds
    ds_read_b128 a[148:151], v2 offset:5120
    ds_read_b128 a[152:155], v2 offset:6144
    v_cmp_gt_i32 s[46:47], 49, v6
    s_add_u32 s33, s33, 0x80000
    v_cmp_gt_i32 s[48:49], 50, v6
    v_exp_f32 v246, v182
    v_cvt_pk_bf16_f32 v214, v244, v245
    v_cmp_gt_i32 s[50:51], 51, v6
    v_cndmask_b32 v40, v10, v5, s[44:45]
    v_mfma_f32_16x16x32_bf16 a[120:123], a[252:255], v[200:203], a[120:123]
    v_exp_f32 v247, v183
    v_or3_b32 v57, v57, v213, v214
    v_cndmask_b32 v41, v10, v5, s[46:47]
    v_mfma_f32_16x16x32_bf16 a[124:127], a[252:255], v[204:207], a[124:127]
    s_waitcnt lgkmcnt(5)
    ds_read_b128 a[156:159], v2 offset:7168
    v_cndmask_b32 v42, v10, v5, s[48:49]
    v_cndmask_b32 v43, v10, v5, s[50:51]
    v_mfma_f32_16x16x32_bf16 v[128:131], a[128:131], v[96:99], v[16:19]
    s_waitcnt vmcnt(4)
    s_barrier
    v_exp_f32 v232, v168
    v_mfma_f32_16x16x32_bf16 v[132:135], a[128:131], v[112:115], v[20:23]
    ds_read_b128 a[160:163], v2 offset:8192
    v_cvt_pk_bf16_f32 v215, v246, v247
    v_mfma_f32_16x16x32_bf16 v[128:131], a[132:135], v[100:103], v[128:131]
    v_exp_f32 v233, v169
    v_mfma_f32_16x16x32_bf16 v[132:135], a[132:135], v[116:119], v[132:135]
    s_waitcnt lgkmcnt(5)
    ds_read_b128 a[164:167], v2 offset:9216
    v_cvt_pk_bf16_f32 v216, v232, v233
    v_mfma_f32_16x16x32_bf16 v[128:131], a[136:139], v[104:107], v[128:131]
    s_add_u32 s36, s36, 64
    v_exp_f32 v234, v170
    v_mfma_f32_16x16x32_bf16 v[132:135], a[136:139], v[120:123], v[132:135]
    ds_read_b128 a[168:171], v2 offset:10240
    v_or3_b32 v57, v57, v215, v216
    v_mfma_f32_16x16x32_bf16 v[128:131], a[140:143], v[108:111], v[128:131]
    s_add_u32 s52, s52, 16384
    v_exp_f32 v235, v171
    v_mfma_f32_16x16x32_bf16 v[132:135], a[140:143], v[124:127], v[132:135]
    s_waitcnt lgkmcnt(5)
    ds_read_b128 a[172:175], v2 offset:11264
    v_cvt_pk_bf16_f32 v217, v234, v235
    v_mfma_f32_16x16x32_bf16 v[144:147], a[144:147], v[96:99], v[32:35]
    s_and_b32 s52, s52, 0xffff
    v_exp_f32 v236, v184
    v_mfma_f32_16x16x32_bf16 v[148:151], a[144:147], v[112:115], v[36:39]
    ds_read_b128 a[176:179], v2 offset:12288
    ds_read_b128 a[180:183], v2 offset:13312
    v_mfma_f32_16x16x32_bf16 v[144:147], a[148:151], v[100:103], v[144:147]
    v_exp_f32 v237, v185
    v_mfma_f32_16x16x32_bf16 v[148:151], a[148:151], v[116:119], v[148:151]
    s_waitcnt lgkmcnt(6)
    v_exp_f32 v238, v186
    v_mfma_f32_16x16x32_bf16 v[144:147], a[152:155], v[104:107], v[144:147]
    ds_read_b128 a[184:187], v2 offset:14336
    v_cvt_pk_bf16_f32 v218, v236, v237
    v_mfma_f32_16x16x32_bf16 v[148:151], a[152:155], v[120:123], v[148:151]
    v_exp_f32 v239, v187
    v_mfma_f32_16x16x32_bf16 v[144:147], a[156:159], v[108:111], v[144:147]
    ds_read_b128 a[188:191], v2 offset:15360
    v_or3_b32 v57, v57, v217, v218
    v_mfma_f32_16x16x32_bf16 v[148:151], a[156:159], v[124:127], v[148:151]
    s_waitcnt lgkmcnt(6)
    v_exp_f32 v240, v172
    v_mfma_f32_16x16x32_bf16 v[136:139], a[160:163], v[96:99], v[24:27]
    v_cvt_pk_bf16_f32 v219, v238, v239
    v_add_u32 v2, s52, v1
    v_mfma_f32_16x16x32_bf16 v[140:143], a[160:163], v[112:115], v[28:31]
    v_exp_f32 v241, v173
    v_mfma_f32_16x16x32_bf16 v[136:139], a[164:167], v[100:103], v[136:139]
    ds_read_b128 a[192:195], v3 offset:0
    v_cvt_pk_bf16_f32 v220, v240, v241
    v_mfma_f32_16x16x32_bf16 v[140:143], a[164:167], v[116:119], v[140:143]
    s_waitcnt lgkmcnt(5)
    v_exp_f32 v242, v174
    v_mfma_f32_16x16x32_bf16 v[136:139], a[168:171], v[104:107], v[136:139]
    ds_read_b128 a[196:199], v3 offset:1024
    v_or3_b32 v57, v57, v219, v220
    v_mfma_f32_16x16x32_bf16 v[140:143], a[168:171], v[120:123], v[140:143]
    v_exp_f32 v243, v175
    v_mfma_f32_16x16x32_bf16 v[136:139], a[172:175], v[108:111], v[136:139]
    ds_read_b128 a[200:203], v3 offset:2048
    v_cvt_pk_bf16_f32 v221, v242, v243
    v_mfma_f32_16x16x32_bf16 v[140:143], a[172:175], v[124:127], v[140:143]
    s_waitcnt lgkmcnt(5)
    v_exp_f32 v244, v188
    v_mfma_f32_16x16x32_bf16 v[152:155], a[176:179], v[96:99], v[40:43]
    ds_read_b128 a[204:207], v3 offset:3072
    ds_read_b128 a[208:211], v3 offset:4096
    v_mfma_f32_16x16x32_bf16 v[156:159], a[176:179], v[112:115], v[44:47]
    v_exp_f32 v245, v189
    v_mfma_f32_16x16x32_bf16 v[152:155], a[180:183], v[100:103], v[152:155]
    v_exp_f32 v246, v190
    v_mfma_f32_16x16x32_bf16 v[156:159], a[180:183], v[116:119], v[156:159]
    s_waitcnt lgkmcnt(5)
    ds_read_b128 a[212:215], v3 offset:5120
    v_cvt_pk_bf16_f32 v222, v244, v245
    v_mfma_f32_16x16x32_bf16 v[152:155], a[184:187], v[104:107], v[152:155]
    v_exp_f32 v247, v191
    v_mfma_f32_16x16x32_bf16 v[156:159], a[184:187], v[120:123], v[156:159]
    ds_read_b128 a[216:219], v3 offset:6144
    v_or3_b32 v57, v57, v221, v222
    v_mfma_f32_16x16x32_bf16 v[152:155], a[188:191], v[108:111], v[152:155]
    ds_read_b128 a[220:223], v3 offset:7168
    v_cvt_pk_bf16_f32 v223, v246, v247
    v_bitop3_b32 v57, v57, v223, s37 bitop3:0xa8
    v_mfma_f32_16x16x32_bf16 v[156:159], a[188:191], v[124:127], v[156:159]
    v_cmp_ne_u32 vcc, 0, v57
    s_cbranch_vccnz k2_tramp_110
k2_ret_111:
    v_mfma_f32_16x16x32_bf16 v[248:251], v[60:63], v[208:211], v[248:251]
    ds_read_b128 a[224:227], v3 offset:8192
    v_exp_f32 v232, v128
    v_mfma_f32_16x16x32_bf16 v[252:255], v[60:63], v[212:215], v[252:255]
    v_exp_f32 v233, v129
    v_mfma_f32_16x16x32_bf16 v[248:251], v[60:63], v[216:219], v[248:251]
    s_add_u32 s53, s53, 16384
    ds_read_b128 a[228:231], v3 offset:9216
    v_exp_f32 v234, v130
    v_mfma_f32_16x16x32_bf16 v[252:255], v[60:63], v[220:223], v[252:255]
    s_waitcnt lgkmcnt(8)
    v_cvt_pk_bf16_f32 v192, v232, v233
    v_exp_f32 v235, v131
    v_mfma_f32_16x16x32_bf16 a[8:11], a[192:195], v[208:211], a[8:11]
    s_sub_u32 s40, s36, s39
    s_sub_u32 s40, s40, 64
    ds_read_b128 a[232:235], v3 offset:10240
    v_mfma_f32_16x16x32_bf16 a[12:15], a[192:195], v[212:215], a[12:15]
    s_and_b32 s53, s53, 0xffff
    v_subrev_u32 v6, s40, v4
    v_cmp_gt_i32 s[44:45], 0, v6
    v_cvt_pk_bf16_f32 v193, v234, v235
    v_mfma_f32_16x16x32_bf16 a[24:27], a[196:199], v[208:211], a[24:27]
    v_exp_f32 v236, v144
    v_cmp_gt_i32 s[46:47], 1, v6
    v_mfma_f32_16x16x32_bf16 a[28:31], a[196:199], v[212:215], a[28:31]
    s_waitcnt lgkmcnt(7)
    ds_read_b128 a[236:239], v3 offset:11264
    v_exp_f32 v237, v145
    v_mfma_f32_16x16x32_bf16 a[40:43], a[200:203], v[208:211], a[40:43]
    ds_read_b128 a[240:243], v3 offset:12288
    v_cmp_gt_i32 s[48:49], 2, v6
    v_cmp_gt_i32 s[50:51], 3, v6
    v_mfma_f32_16x16x32_bf16 a[44:47], a[200:203], v[212:215], a[44:47]
    v_exp_f32 v238, v146
    v_cndmask_b32 v20, v11, v5, s[44:45]
    v_mfma_f32_16x16x32_bf16 a[56:59], a[204:207], v[208:211], a[56:59]
    v_cvt_pk_bf16_f32 v194, v236, v237
    v_cndmask_b32 v21, v11, v5, s[46:47]
    v_or3_b32 v57, v192, v193, v194
    v_mfma_f32_16x16x32_bf16 a[60:63], a[204:207], v[212:215], a[60:63]
    s_waitcnt lgkmcnt(7)
    v_exp_f32 v239, v147
    v_cndmask_b32 v22, v11, v5, s[48:49]
    v_mfma_f32_16x16x32_bf16 a[72:75], a[208:211], v[208:211], a[72:75]
    ds_read_b128 a[244:247], v3 offset:13312
    v_cndmask_b32 v23, v11, v5, s[50:51]
    v_cvt_pk_bf16_f32 v195, v238, v239
    v_mfma_f32_16x16x32_bf16 a[76:79], a[208:211], v[212:215], a[76:79]
    v_exp_f32 v240, v132
    v_cmp_gt_i32 s[44:45], 16, v6
    v_mfma_f32_16x16x32_bf16 a[88:91], a[212:215], v[208:211], a[88:91]
    ds_read_b128 a[248:251], v3 offset:14336
    v_cmp_gt_i32 s[46:47], 17, v6
    v_cmp_gt_i32 s[48:49], 18, v6
    v_mfma_f32_16x16x32_bf16 a[92:95], a[212:215], v[212:215], a[92:95]
    s_waitcnt lgkmcnt(7)
    ds_read_b128 a[252:255], v3 offset:15360
    v_exp_f32 v241, v133
    v_mfma_f32_16x16x32_bf16 a[104:107], a[216:219], v[208:211], a[104:107]
    v_exp_f32 v242, v134
    v_cmp_gt_i32 s[50:51], 19, v6
    v_mfma_f32_16x16x32_bf16 a[108:111], a[216:219], v[212:215], a[108:111]
    v_cvt_pk_bf16_f32 v196, v240, v241
    v_cndmask_b32 v36, v11, v5, s[44:45]
    v_or3_b32 v57, v57, v195, v196
    v_mfma_f32_16x16x32_bf16 a[120:123], a[220:223], v[208:211], a[120:123]
    v_exp_f32 v243, v135
    v_cndmask_b32 v37, v11, v5, s[46:47]
    v_mfma_f32_16x16x32_bf16 a[124:127], a[220:223], v[212:215], a[124:127]
    s_waitcnt lgkmcnt(6)
    ds_read_b128 a[128:131], v2 offset:0
    v_cndmask_b32 v38, v11, v5, s[48:49]
    v_add_u32 v3, s53, v56
    v_mfma_f32_16x16x32_bf16 a[8:11], a[224:227], v[216:219], a[8:11]
    ds_read_b128 a[132:135], v2 offset:1024
    v_exp_f32 v244, v148
    v_mfma_f32_16x16x32_bf16 a[12:15], a[224:227], v[220:223], a[12:15]
    ds_read_b128 a[136:139], v2 offset:2048
    v_cvt_pk_bf16_f32 v197, v242, v243
    v_cndmask_b32 v39, v11, v5, s[50:51]
    v_mfma_f32_16x16x32_bf16 a[24:27], a[228:231], v[216:219], a[24:27]
    v_cmp_gt_i32 s[44:45], 32, v6
    v_exp_f32 v245, v149
    v_mfma_f32_16x16x32_bf16 a[28:31], a[228:231], v[220:223], a[28:31]
    s_waitcnt lgkmcnt(7)
    ds_read_b128 a[140:143], v2 offset:3072
    ds_read_b128 a[144:147], v2 offset:4096
    v_cmp_gt_i32 s[46:47], 33, v6
    v_mfma_f32_16x16x32_bf16 a[40:43], a[232:235], v[216:219], a[40:43]
    v_exp_f32 v246, v150
    v_cmp_gt_i32 s[48:49], 34, v6
    v_mfma_f32_16x16x32_bf16 a[44:47], a[232:235], v[220:223], a[44:47]
    ds_read_b128 a[148:151], v2 offset:5120
    v_cvt_pk_bf16_f32 v198, v244, v245
    v_cmp_gt_i32 s[50:51], 35, v6
    v_mfma_f32_16x16x32_bf16 a[56:59], a[236:239], v[216:219], a[56:59]
    v_exp_f32 v247, v151
    v_or3_b32 v57, v57, v197, v198
    v_mfma_f32_16x16x32_bf16 a[60:63], a[236:239], v[220:223], a[60:63]
    s_waitcnt lgkmcnt(8)
    ds_read_b128 a[152:155], v2 offset:6144
    v_cndmask_b32 v28, v11, v5, s[44:45]
    v_cndmask_b32 v29, v11, v5, s[46:47]
    v_mfma_f32_16x16x32_bf16 a[72:75], a[240:243], v[216:219], a[72:75]
    ds_read_b128 a[156:159], v2 offset:7168
    v_exp_f32 v232, v136
    v_mfma_f32_16x16x32_bf16 a[76:79], a[240:243], v[220:223], a[76:79]
    ds_read_b128 a[160:163], v2 offset:8192
    v_cvt_pk_bf16_f32 v199, v246, v247
    v_cndmask_b32 v30, v11, v5, s[48:49]
    v_mfma_f32_16x16x32_bf16 a[88:91], a[244:247], v[216:219], a[88:91]
    v_cndmask_b32 v31, v11, v5, s[50:51]
    v_exp_f32 v233, v137
    v_mfma_f32_16x16x32_bf16 a[92:95], a[244:247], v[220:223], a[92:95]
    s_waitcnt lgkmcnt(9)
    ds_read_b128 a[164:167], v2 offset:9216
    ds_read_b128 a[168:171], v2 offset:10240
    v_cmp_gt_i32 s[44:45], 48, v6
    v_mfma_f32_16x16x32_bf16 a[104:107], a[248:251], v[216:219], a[104:107]
    v_exp_f32 v234, v138
    v_cmp_gt_i32 s[46:47], 49, v6
    v_mfma_f32_16x16x32_bf16 a[108:111], a[248:251], v[220:223], a[108:111]
    ds_read_b128 a[172:175], v2 offset:11264
    ds_read_b128 a[176:179], v2 offset:12288
    v_cvt_pk_bf16_f32 v200, v232, v233
    v_cmp_gt_i32 s[48:49], 50, v6
    v_exp_f32 v235, v139
    v_cmp_gt_i32 s[50:51], 51, v6
    v_or3_b32 v57, v57, v199, v200
    v_cndmask_b32 v44, v11, v5, s[44:45]
    v_mfma_f32_16x16x32_bf16 a[120:123], a[252:255], v[216:219], a[120:123]
    ds_read_b128 a[180:183], v2 offset:13312
    v_exp_f32 v236, v152
    v_cvt_pk_bf16_f32 v201, v234, v235
    v_cndmask_b32 v45, v11, v5, s[46:47]
    v_mfma_f32_16x16x32_bf16 a[124:127], a[252:255], v[220:223], a[124:127]
    s_waitcnt lgkmcnt(12)
    ds_read_b128 a[184:187], v2 offset:14336
    v_cndmask_b32 v46, v11, v5, s[48:49]
    v_cndmask_b32 v47, v11, v5, s[50:51]
    v_mfma_f32_16x16x32_bf16 v[164:167], a[128:131], v[112:115], v[20:23]
    v_exp_f32 v237, v153
    v_mfma_f32_16x16x32_bf16 v[164:167], a[132:135], v[116:119], v[164:167]
    s_waitcnt lgkmcnt(11)
    ds_read_b128 a[188:191], v2 offset:15360
    v_exp_f32 v238, v154
    v_mfma_f32_16x16x32_bf16 v[164:167], a[136:139], v[120:123], v[164:167]
    v_cvt_pk_bf16_f32 v202, v236, v237
    v_exp_f32 v239, v155
    v_mfma_f32_16x16x32_bf16 v[164:167], a[140:143], v[124:127], v[164:167]
    s_waitcnt lgkmcnt(10)
    ds_read_b128 a[192:195], v3 offset:0
    v_or3_b32 v57, v57, v201, v202
    v_mfma_f32_16x16x32_bf16 v[180:183], a[144:147], v[112:115], v[36:39]
    s_add_u32 s36, s36, 64
    v_exp_f32 v240, v140
    v_mfma_f32_16x16x32_bf16 v[180:183], a[148:151], v[116:119], v[180:183]
    s_waitcnt lgkmcnt(9)
    ds_read_b128 a[196:199], v3 offset:1024
    v_cvt_pk_bf16_f32 v203, v238, v239
    v_exp_f32 v241, v141
    v_mfma_f32_16x16x32_bf16 v[180:183], a[152:155], v[120:123], v[180:183]
    s_add_u32 s52, s52, 16384
    ds_read_b128 a[200:203], v3 offset:2048
    v_cvt_pk_bf16_f32 v204, v240, v241
    v_mfma_f32_16x16x32_bf16 v[180:183], a[156:159], v[124:127], v[180:183]
    s_waitcnt lgkmcnt(9)
    v_exp_f32 v242, v142
    v_or3_b32 v57, v57, v203, v204
    v_mfma_f32_16x16x32_bf16 v[172:175], a[160:163], v[112:115], v[28:31]
    s_and_b32 s52, s52, 0xffff
    v_add_u32 v2, s52, v1
    v_exp_f32 v243, v143
    v_mfma_f32_16x16x32_bf16 v[172:175], a[164:167], v[116:119], v[172:175]
    s_waitcnt lgkmcnt(7)
    ds_read_b128 a[204:207], v3 offset:3072
    v_exp_f32 v244, v156
    v_mfma_f32_16x16x32_bf16 v[172:175], a[168:171], v[120:123], v[172:175]
    ds_read_b128 a[208:211], v3 offset:4096
    ds_read_b128 a[212:215], v3 offset:5120
    v_cvt_pk_bf16_f32 v205, v242, v243
    v_mfma_f32_16x16x32_bf16 v[172:175], a[172:175], v[124:127], v[172:175]
    s_waitcnt lgkmcnt(8)
    ds_read_b128 a[216:219], v3 offset:6144
    v_exp_f32 v245, v157
    v_mfma_f32_16x16x32_bf16 v[188:191], a[176:179], v[112:115], v[44:47]
    v_exp_f32 v246, v158
    v_cvt_pk_bf16_f32 v206, v244, v245
    v_mfma_f32_16x16x32_bf16 v[188:191], a[180:183], v[116:119], v[188:191]
    s_waitcnt lgkmcnt(7)
    v_exp_f32 v247, v159
    v_or3_b32 v57, v57, v205, v206
    v_mfma_f32_16x16x32_bf16 v[188:191], a[184:187], v[120:123], v[188:191]
    ds_read_b128 a[220:223], v3 offset:7168
    v_cvt_pk_bf16_f32 v207, v246, v247
    v_bitop3_b32 v57, v57, v207, s37 bitop3:0xa8
    v_mfma_f32_16x16x32_bf16 v[188:191], a[188:191], v[124:127], v[188:191]
    v_cmp_ne_u32 vcc, 0, v57
    s_cbranch_vccnz k2_tramp_112
k2_ret_113:
k2_sdone_105:
    s_add_u32 s16, s6, 0x4811000
    s_addc_u32 s17, s7, 0
    s_and_b32 s17, s17, 0xffff
    s_mov_b32 s18, 0x4000
    s_mov_b32 s19, 0x00020000
    v_mfma_f32_16x16x32_bf16 v[248:251], v[60:63], v[192:195], v[248:251]
    s_waitcnt vmcnt(0)
    s_barrier
    v_exp_f32 v232, v164
    v_mfma_f32_16x16x32_bf16 v[252:255], v[60:63], v[196:199], v[252:255]
    ds_read_b128 a[224:227], v3 offset:8192
    s_cmp_eq_u32 s30, 0
    s_cbranch_scc1 k12_ool_116
k12_oolret_117:
    v_mfma_f32_16x16x32_bf16 v[248:251], v[60:63], v[200:203], v[248:251]
    s_add_u32 m0, s60, 0
    v_exp_f32 v233, v165
    v_mfma_f32_16x16x32_bf16 v[252:255], v[60:63], v[204:207], v[252:255]
    s_waitcnt lgkmcnt(7)
    buffer_load_dwordx4 v90, s[12:15], s61 offen offset:0 lds
    ds_read_b128 a[228:231], v3 offset:9216
    v_mfma_f32_16x16x32_bf16 a[8:11], a[192:195], v[192:195], a[8:11]
    s_add_u32 s53, s53, 16384
    v_exp_f32 v234, v166
    v_cvt_pk_bf16_f32 v212, v232, v233
    v_mfma_f32_16x16x32_bf16 a[12:15], a[192:195], v[196:199], a[12:15]
    s_and_b32 s53, s53, 0xffff
    buffer_load_dwordx4 v91, s[12:15], s61 offen offset:1024 lds
    ds_read_b128 a[232:235], v3 offset:10240
    v_mfma_f32_16x16x32_bf16 a[24:27], a[196:199], v[192:195], a[24:27]
    ds_read_b128 a[236:239], v3 offset:11264
    v_exp_f32 v235, v167
    v_mfma_f32_16x16x32_bf16 a[28:31], a[196:199], v[196:199], a[28:31]
    s_waitcnt lgkmcnt(8)
    v_exp_f32 v236, v180
    v_mfma_f32_16x16x32_bf16 a[40:43], a[200:203], v[192:195], a[40:43]
    buffer_load_dwordx4 v92, s[12:15], s61 offen offset:2048 lds
    ds_read_b128 a[240:243], v3 offset:12288
    v_mfma_f32_16x16x32_bf16 a[44:47], a[200:203], v[196:199], a[44:47]
    v_cvt_pk_bf16_f32 v213, v234, v235
    v_exp_f32 v237, v181
    v_mfma_f32_16x16x32_bf16 a[56:59], a[204:207], v[192:195], a[56:59]
    buffer_load_dwordx4 v93, s[12:15], s61 offen offset:3072 lds
    ds_read_b128 a[244:247], v3 offset:13312
    v_mfma_f32_16x16x32_bf16 a[60:63], a[204:207], v[196:199], a[60:63]
    s_waitcnt lgkmcnt(8)
    v_exp_f32 v238, v182
    v_cvt_pk_bf16_f32 v214, v236, v237
    v_mfma_f32_16x16x32_bf16 a[72:75], a[208:211], v[192:195], a[72:75]
    s_add_u32 s61, s61, 0x20000
    s_and_b32 s61, s61, 0x3fffff
    ds_read_b128 a[248:251], v3 offset:14336
    v_mfma_f32_16x16x32_bf16 a[76:79], a[208:211], v[196:199], a[76:79]
    s_add_u32 m0, s60, 16384
    v_exp_f32 v239, v183
    v_or3_b32 v57, v212, v213, v214
    v_mfma_f32_16x16x32_bf16 a[88:91], a[212:215], v[192:195], a[88:91]
    buffer_load_dwordx4 v90, s[12:15], s61 offen offset:0 lds
    buffer_load_dwordx4 v91, s[12:15], s61 offen offset:1024 lds
    ds_read_b128 a[252:255], v3 offset:15360
    v_mfma_f32_16x16x32_bf16 a[92:95], a[212:215], v[196:199], a[92:95]
    s_waitcnt lgkmcnt(8)
    v_exp_f32 v240, v172
    v_cvt_pk_bf16_f32 v215, v238, v239
    v_mfma_f32_16x16x32_bf16 a[104:107], a[216:219], v[192:195], a[104:107]
    v_mfma_f32_16x16x32_bf16 a[108:111], a[216:219], v[196:199], a[108:111]
    v_add_u32 v3, s53, v56
    ds_read_b128 a[192:195], v3 offset:0
    v_mfma_f32_16x16x32_bf16 a[120:123], a[220:223], v[192:195], a[120:123]
    ds_read_b128 a[196:199], v3 offset:1024
    v_exp_f32 v241, v173
    v_mfma_f32_16x16x32_bf16 a[124:127], a[220:223], v[196:199], a[124:127]
    s_waitcnt lgkmcnt(8)
    buffer_load_dwordx4 v92, s[12:15], s61 offen offset:2048 lds
    buffer_load_dwordx4 v93, s[12:15], s61 offen offset:3072 lds
    ds_read_b128 a[200:203], v3 offset:2048
    v_mfma_f32_16x16x32_bf16 a[8:11], a[224:227], v[200:203], a[8:11]
    v_exp_f32 v242, v174
    v_cvt_pk_bf16_f32 v220, v240, v241
    v_mfma_f32_16x16x32_bf16 a[12:15], a[224:227], v[204:207], a[12:15]
    ds_read_b128 a[204:207], v3 offset:3072
    ds_read_b128 a[208:211], v3 offset:4096
    v_or3_b32 v57, v57, v215, v220
    v_mfma_f32_16x16x32_bf16 a[24:27], a[228:231], v[200:203], a[24:27]
    s_add_u32 s61, s61, 0x20000
    s_and_b32 s61, s61, 0x3fffff
    ds_read_b128 a[212:215], v3 offset:5120
    v_exp_f32 v243, v175
    v_mfma_f32_16x16x32_bf16 a[28:31], a[228:231], v[204:207], a[28:31]
    s_waitcnt lgkmcnt(10)
    ds_read_b128 a[216:219], v3 offset:6144
    s_add_u32 m0, s60, 32768
    v_mfma_f32_16x16x32_bf16 a[40:43], a[232:235], v[200:203], a[40:43]
    buffer_load_dwordx4 v90, s[12:15], s61 offen offset:0 lds
    ds_read_b128 a[220:223], v3 offset:7168
    v_mfma_f32_16x16x32_bf16 a[44:47], a[232:235], v[204:207], a[44:47]
    v_exp_f32 v244, v188
    v_cvt_pk_bf16_f32 v221, v242, v243
    v_mfma_f32_16x16x32_bf16 a[56:59], a[236:239], v[200:203], a[56:59]
    buffer_load_dwordx4 v91, s[12:15], s61 offen offset:1024 lds
    ds_read_b128 a[224:227], v3 offset:8192
    v_mfma_f32_16x16x32_bf16 a[60:63], a[236:239], v[204:207], a[60:63]
    s_waitcnt lgkmcnt(11)
    ds_read_b128 a[228:231], v3 offset:9216
    v_exp_f32 v245, v189
    v_mfma_f32_16x16x32_bf16 a[72:75], a[240:243], v[200:203], a[72:75]
    buffer_load_dwordx4 v92, s[12:15], s61 offen offset:2048 lds
    ds_read_b128 a[232:235], v3 offset:10240
    v_mfma_f32_16x16x32_bf16 a[76:79], a[240:243], v[204:207], a[76:79]
    v_exp_f32 v246, v190
    v_mfma_f32_16x16x32_bf16 a[88:91], a[244:247], v[200:203], a[88:91]
    ds_read_b128 a[236:239], v3 offset:11264
    ds_read_b128 a[240:243], v3 offset:12288
    v_cvt_pk_bf16_f32 v222, v244, v245
    v_mfma_f32_16x16x32_bf16 a[92:95], a[244:247], v[204:207], a[92:95]
    s_waitcnt lgkmcnt(13)
    v_exp_f32 v247, v191
    v_mfma_f32_16x16x32_bf16 a[104:107], a[248:251], v[200:203], a[104:107]
    ds_read_b128 a[244:247], v3 offset:13312
    v_or3_b32 v57, v57, v221, v222
    v_cvt_pk_bf16_f32 v223, v246, v247
    v_mfma_f32_16x16x32_bf16 a[108:111], a[248:251], v[204:207], a[108:111]
    buffer_load_dwordx4 v93, s[12:15], s61 offen offset:3072 lds
    v_mfma_f32_16x16x32_bf16 a[120:123], a[252:255], v[200:203], a[120:123]
    s_add_u32 s61, s61, 0x20000
    s_and_b32 s61, s61, 0x3fffff
    ds_read_b128 a[248:251], v3 offset:14336
    v_bitop3_b32 v57, v57, v223, s37 bitop3:0xa8
    v_cmp_ne_u32 vcc, 0, v57
    v_mfma_f32_16x16x32_bf16 a[124:127], a[252:255], v[204:207], a[124:127]
    buffer_load_dword v74, v73, s[16:19], s59 offen sc1
    ds_read_b128 a[252:255], v3 offset:15360
    s_cbranch_vccnz k2_tramp_114
k2_ret_115:
    v_lshrrev_b32 v6, 4, v1
    v_and_b32 v6, 31, v6
    s_getpc_b64 s[40:41]
pc_118:
    s_add_u32 s40, s40, op_head-pc_118
    s_addc_u32 s41, s41, 0
    v_lshlrev_b32 v224, 7, v6
    v_mov_b32 v225, s41
    v_add_co_u32 v224, vcc, s40, v224
    s_nop 1
    v_addc_co_u32 v225, vcc, 0, v225, vcc
    global_load_dword v7, v[224:225], off
    v_mfma_f32_16x16x32_bf16 v[252:255], v[60:63], v[212:215], v[252:255]
    s_lshl_b32 s31, s28, 19
    v_mov_b32 v249, v248
    s_nop 1
    v_permlane16_swap_b32 v248, v249
    v_mfma_f32_16x16x32_bf16 v[252:255], v[60:63], v[220:223], v[252:255]
    s_waitcnt lgkmcnt(0)
    s_nop 1
    v_add_f32 v248, v248, v249
    v_mov_b32 v249, v248
    v_mfma_f32_16x16x32_bf16 a[12:15], a[192:195], v[212:215], a[12:15]
    s_lshl_b32 s44, s39, 6
    s_nop 1
    v_permlane32_swap_b32 v248, v249
    s_nop 1
    v_mfma_f32_16x16x32_bf16 a[12:15], a[224:227], v[220:223], a[12:15]
    s_add_u32 s44, s44, s31
    s_add_u32 s45, s44, 131072
    v_add_f32 v248, v248, v249
    v_rcp_f32 v249, v248
    v_mfma_f32_16x16x32_bf16 a[28:31], a[196:199], v[212:215], a[28:31]
    s_add_u32 s46, s44, 262144
    v_rcp_f32 v248, v248
    s_nop 0
    s_add_u32 s47, s44, 393216
    v_mfma_f32_16x16x32_bf16 a[28:31], a[228:231], v[220:223], a[28:31]
    s_add_u32 s48, s44, 4096
    v_accvgpr_read_b32 v132, a8
    v_accvgpr_read_b32 v133, a9
    v_accvgpr_read_b32 v134, a10
    v_mfma_f32_16x16x32_bf16 a[44:47], a[200:203], v[212:215], a[44:47]
    s_add_u32 s49, s44, 135168
    v_accvgpr_read_b32 v135, a11
    v_accvgpr_read_b32 v136, a24
    v_accvgpr_read_b32 v137, a25
    v_mfma_f32_16x16x32_bf16 a[44:47], a[232:235], v[220:223], a[44:47]
    s_add_u32 s50, s44, 266240
    v_accvgpr_read_b32 v138, a26
    v_accvgpr_read_b32 v139, a27
    v_mul_f32 v132, v132, v248
    v_mfma_f32_16x16x32_bf16 a[60:63], a[204:207], v[212:215], a[60:63]
    s_add_u32 s51, s44, 397312
    v_mul_f32 v133, v133, v248
    v_mul_f32 v134, v134, v248
    v_mul_f32 v135, v135, v248
    v_mfma_f32_16x16x32_bf16 a[60:63], a[236:239], v[220:223], a[60:63]
    v_mul_f32 v136, v136, v248
    v_mul_f32 v137, v137, v248
    v_mul_f32 v138, v138, v248
    v_mfma_f32_16x16x32_bf16 a[76:79], a[208:211], v[212:215], a[76:79]
    v_mul_f32 v139, v139, v248
    v_cvt_pk_bf16_f32 v128, v132, v133
    v_cvt_pk_bf16_f32 v129, v134, v135
    v_mfma_f32_16x16x32_bf16 a[76:79], a[240:243], v[220:223], a[76:79]
    v_cvt_pk_bf16_f32 v130, v136, v137
    v_cvt_pk_bf16_f32 v131, v138, v139
    buffer_store_dwordx4 v[128:131], v1, s[24:27], s44 offen sc1
    v_mfma_f32_16x16x32_bf16 a[92:95], a[212:215], v[212:215], a[92:95]
    v_accvgpr_read_b32 v144, a40
    v_accvgpr_read_b32 v145, a41
    v_accvgpr_read_b32 v146, a42
    v_mfma_f32_16x16x32_bf16 a[92:95], a[244:247], v[220:223], a[92:95]
    v_accvgpr_read_b32 v147, a43
    v_accvgpr_read_b32 v148, a56
    v_mov_b32 v253, v252
    v_mfma_f32_16x16x32_bf16 a[108:111], a[216:219], v[212:215], a[108:111]
    v_accvgpr_read_b32 v149, a57
    v_accvgpr_read_b32 v150, a58
    s_nop 1
    v_mfma_f32_16x16x32_bf16 a[108:111], a[248:251], v[220:223], a[108:111]
    v_accvgpr_read_b32 v151, a59
    v_permlane16_swap_b32 v252, v253
    v_mul_f32 v144, v144, v248
    v_mfma_f32_16x16x32_bf16 a[124:127], a[220:223], v[212:215], a[124:127]
    s_nop 1
    v_mul_f32 v145, v145, v248
    v_add_f32 v252, v252, v253
    v_mfma_f32_16x16x32_bf16 a[124:127], a[252:255], v[220:223], a[124:127]
    v_mul_f32 v146, v146, v248
    v_mov_b32 v253, v252
    v_mul_f32 v147, v147, v248
    s_nop 1
    v_mul_f32 v148, v148, v248
    v_mul_f32 v149, v149, v248
    v_permlane32_swap_b32 v252, v253
    v_mul_f32 v150, v150, v248
    s_nop 1
    v_mul_f32 v151, v151, v248
    v_add_f32 v252, v252, v253
    v_cvt_pk_bf16_f32 v140, v144, v145
    v_rcp_f32 v253, v252
    v_cvt_pk_bf16_f32 v141, v146, v147
    v_rcp_f32 v252, v252
    v_cvt_pk_bf16_f32 v142, v148, v149
    s_nop 0
    v_cvt_pk_bf16_f32 v143, v150, v151
    buffer_store_dwordx4 v[140:143], v1, s[24:27], s45 offen sc1
    v_accvgpr_read_b32 v156, a72
    v_accvgpr_read_b32 v157, a73
    v_accvgpr_read_b32 v158, a74
    v_accvgpr_read_b32 v159, a75
    v_accvgpr_read_b32 v160, a88
    v_accvgpr_read_b32 v161, a89
    v_accvgpr_read_b32 v162, a90
    v_accvgpr_read_b32 v163, a91
    v_mul_f32 v156, v156, v248
    v_mul_f32 v157, v157, v248
    v_mul_f32 v158, v158, v248
    v_mul_f32 v159, v159, v248
    v_mul_f32 v160, v160, v248
    v_mul_f32 v161, v161, v248
    v_mul_f32 v162, v162, v248
    v_mul_f32 v163, v163, v248
    v_cvt_pk_bf16_f32 v152, v156, v157
    v_cvt_pk_bf16_f32 v153, v158, v159
    v_cvt_pk_bf16_f32 v154, v160, v161
    v_cvt_pk_bf16_f32 v155, v162, v163
    buffer_store_dwordx4 v[152:155], v1, s[24:27], s46 offen sc1
    v_accvgpr_read_b32 v168, a104
    v_accvgpr_read_b32 v169, a105
    v_accvgpr_read_b32 v170, a106
    v_accvgpr_read_b32 v171, a107
    v_accvgpr_read_b32 v172, a120
    v_accvgpr_read_b32 v173, a121
    v_accvgpr_read_b32 v174, a122
    v_accvgpr_read_b32 v175, a123
    v_mul_f32 v168, v168, v248
    v_mul_f32 v169, v169, v248
    v_mul_f32 v170, v170, v248
    v_mul_f32 v171, v171, v248
    v_mul_f32 v172, v172, v248
    v_mul_f32 v173, v173, v248
    v_mul_f32 v174, v174, v248
    v_mul_f32 v175, v175, v248
    v_cvt_pk_bf16_f32 v164, v168, v169
    v_cvt_pk_bf16_f32 v165, v170, v171
    v_cvt_pk_bf16_f32 v166, v172, v173
    v_cvt_pk_bf16_f32 v167, v174, v175
    buffer_store_dwordx4 v[164:167], v1, s[24:27], s47 offen sc1
    v_accvgpr_read_b32 v132, a12
    v_accvgpr_read_b32 v133, a13
    v_accvgpr_read_b32 v134, a14
    v_accvgpr_read_b32 v135, a15
    v_accvgpr_read_b32 v136, a28
    v_accvgpr_read_b32 v137, a29
    v_accvgpr_read_b32 v138, a30
    v_accvgpr_read_b32 v139, a31
    v_pk_mul_f32 v[132:133], v[132:133], v[252:253]
    v_pk_mul_f32 v[134:135], v[134:135], v[252:253]
    v_pk_mul_f32 v[136:137], v[136:137], v[252:253]
    v_pk_mul_f32 v[138:139], v[138:139], v[252:253]
    v_cvt_pk_bf16_f32 v128, v132, v133
    v_cvt_pk_bf16_f32 v129, v134, v135
    v_cvt_pk_bf16_f32 v130, v136, v137
    v_cvt_pk_bf16_f32 v131, v138, v139
    v_accvgpr_read_b32 v144, a44
    v_accvgpr_read_b32 v145, a45
    v_accvgpr_read_b32 v146, a46
    v_accvgpr_read_b32 v147, a47
    v_accvgpr_read_b32 v148, a60
    v_accvgpr_read_b32 v149, a61
    v_accvgpr_read_b32 v150, a62
    v_accvgpr_read_b32 v151, a63
    v_pk_mul_f32 v[144:145], v[144:145], v[252:253]
    v_pk_mul_f32 v[146:147], v[146:147], v[252:253]
    v_pk_mul_f32 v[148:149], v[148:149], v[252:253]
    v_pk_mul_f32 v[150:151], v[150:151], v[252:253]
    v_cvt_pk_bf16_f32 v140, v144, v145
    v_cvt_pk_bf16_f32 v141, v146, v147
    v_cvt_pk_bf16_f32 v142, v148, v149
    v_cvt_pk_bf16_f32 v143, v150, v151
    v_accvgpr_read_b32 v156, a76
    v_accvgpr_read_b32 v157, a77
    v_accvgpr_read_b32 v158, a78
    v_accvgpr_read_b32 v159, a79
    v_accvgpr_read_b32 v160, a92
    v_accvgpr_read_b32 v161, a93
    v_accvgpr_read_b32 v162, a94
    v_accvgpr_read_b32 v163, a95
    v_pk_mul_f32 v[156:157], v[156:157], v[252:253]
    v_pk_mul_f32 v[158:159], v[158:159], v[252:253]
    v_pk_mul_f32 v[160:161], v[160:161], v[252:253]
    v_pk_mul_f32 v[162:163], v[162:163], v[252:253]
    v_cvt_pk_bf16_f32 v152, v156, v157
    v_cvt_pk_bf16_f32 v153, v158, v159
    v_cvt_pk_bf16_f32 v154, v160, v161
    v_cvt_pk_bf16_f32 v155, v162, v163
    v_accvgpr_read_b32 v168, a108
    v_accvgpr_read_b32 v169, a109
    v_accvgpr_read_b32 v170, a110
    v_accvgpr_read_b32 v171, a111
    v_accvgpr_read_b32 v172, a124
    v_accvgpr_read_b32 v173, a125
    v_accvgpr_read_b32 v174, a126
    v_accvgpr_read_b32 v175, a127
    v_pk_mul_f32 v[168:169], v[168:169], v[252:253]
    v_pk_mul_f32 v[170:171], v[170:171], v[252:253]
    v_pk_mul_f32 v[172:173], v[172:173], v[252:253]
    v_pk_mul_f32 v[174:175], v[174:175], v[252:253]
    v_cvt_pk_bf16_f32 v164, v168, v169
    v_cvt_pk_bf16_f32 v165, v170, v171
    v_cvt_pk_bf16_f32 v166, v172, v173
    v_cvt_pk_bf16_f32 v167, v174, v175
    buffer_store_dwordx4 v[128:131], v1, s[24:27], s48 offen sc1
    buffer_store_dwordx4 v[140:143], v1, s[24:27], s49 offen sc1
    buffer_store_dwordx4 v[152:155], v1, s[24:27], s50 offen sc1
    buffer_store_dwordx4 v[164:167], v1, s[24:27], s51 offen sc1
op_head:
    s_load_dwordx2 s[28:29], s[0:1], 0
    s_load_dwordx2 s[42:43], s[0:1], 56
    s_waitcnt vmcnt(8)
    v_cmp_le_u32 vcc, 4, v74
    v_mov_b32 v56, 0
    v_mov_b32 v57, 0
    v_mov_b32 v58, 0
    v_mov_b32 v59, 0
    s_nop 1
    v_mfma_f32_32x32x16_bf16 v[128:143], v[56:59], v[56:59], 0
    v_mfma_f32_32x32x16_bf16 v[144:159], v[56:59], v[56:59], 0
    v_mfma_f32_32x32x16_bf16 v[160:175], v[56:59], v[56:59], 0
    v_mfma_f32_32x32x16_bf16 v[176:191], v[56:59], v[56:59], 0
    s_mov_b32 s33, vcc_lo
    s_bitcmp1_b32 s33, 0
    s_cbranch_scc0 op_late_119
    buffer_load_dwordx4 a[128:131], v88, s[8:11], s62 offen offset:0 sc1
    buffer_load_dwordx4 a[132:135], v88, s[8:11], s62 offen offset:1024 sc1
    buffer_load_dwordx4 a[136:139], v89, s[8:11], s62 offen offset:0 sc1
    buffer_load_dwordx4 a[140:143], v89, s[8:11], s62 offen offset:1024 sc1
    s_add_u32 s62, s62, 0x40000
    s_and_b32 s62, s62, 0x7fffff
    buffer_load_dwordx4 a[144:147], v88, s[8:11], s62 offen offset:0 sc1
    buffer_load_dwordx4 a[148:151], v88, s[8:11], s62 offen offset:1024 sc1
    buffer_load_dwordx4 a[152:155], v89, s[8:11], s62 offen offset:0 sc1
    buffer_load_dwordx4 a[156:159], v89, s[8:11], s62 offen offset:1024 sc1
    s_add_u32 s62, s62, 0x40000
    s_and_b32 s62, s62, 0x7fffff
    buffer_load_dwordx4 a[160:163], v88, s[8:11], s62 offen offset:0 sc1
    buffer_load_dwordx4 a[164:167], v88, s[8:11], s62 offen offset:1024 sc1
    buffer_load_dwordx4 a[168:171], v89, s[8:11], s62 offen offset:0 sc1
    buffer_load_dwordx4 a[172:175], v89, s[8:11], s62 offen offset:1024 sc1
    s_add_u32 s62, s62, 0x40000
    s_and_b32 s62, s62, 0x7fffff
    s_waitcnt vmcnt(12)
    s_branch op_join_120
op_late_119:
    s_waitcnt vmcnt(0)
op_join_120:
    s_barrier
    s_cmp_eq_u32 s30, 0
    s_cbranch_scc1 k12_ool_121
k12_oolret_122:
    s_bitcmp0_b32 s33, 0
    s_cbranch_scc1 k12_ool_125
k12_oolret_126:
    ds_read_b64_tr_b16 a[0:1], v64 offset:0
    ds_read_b64_tr_b16 a[2:3], v64 offset:4096
    ds_read_b64_tr_b16 a[4:5], v65 offset:0
    ds_read_b64_tr_b16 a[6:7], v65 offset:4096
    ds_read_b64_tr_b16 a[8:9], v66 offset:0
    ds_read_b64_tr_b16 a[10:11], v66 offset:4096
    ds_read_b64_tr_b16 a[12:13], v67 offset:0
    ds_read_b64_tr_b16 a[14:15], v67 offset:4096
    ds_read_b64_tr_b16 a[16:17], v68 offset:0
    ds_read_b64_tr_b16 a[18:19], v68 offset:4096
    ds_read_b64_tr_b16 a[20:21], v69 offset:0
    ds_read_b64_tr_b16 a[22:23], v69 offset:4096
    ds_read_b64_tr_b16 a[24:25], v70 offset:0
    ds_read_b64_tr_b16 a[26:27], v70 offset:4096
    ds_read_b64_tr_b16 a[28:29], v71 offset:0
    ds_read_b64_tr_b16 a[30:31], v71 offset:4096
    ds_read_b64_tr_b16 a[32:33], v64 offset:8192
    ds_read_b64_tr_b16 a[34:35], v64 offset:12288
    ds_read_b64_tr_b16 a[36:37], v65 offset:8192
    ds_read_b64_tr_b16 a[38:39], v65 offset:12288
    ds_read_b64_tr_b16 a[40:41], v66 offset:8192
    ds_read_b64_tr_b16 a[42:43], v66 offset:12288
    ds_read_b64_tr_b16 a[44:45], v67 offset:8192
    ds_read_b64_tr_b16 a[46:47], v67 offset:12288
    ds_read_b64_tr_b16 a[48:49], v68 offset:8192
    ds_read_b64_tr_b16 a[50:51], v68 offset:12288
    ds_read_b64_tr_b16 a[52:53], v69 offset:8192
    ds_read_b64_tr_b16 a[54:55], v69 offset:12288
    ds_read_b64_tr_b16 a[56:57], v70 offset:8192
    ds_read_b64_tr_b16 a[58:59], v70 offset:12288
    ds_read_b64_tr_b16 a[60:61], v71 offset:8192
    ds_read_b64_tr_b16 a[62:63], v71 offset:12288
    s_add_u32 s24, s6, 0x4000000
    s_addc_u32 s25, s7, 0
    s_and_b32 s25, s25, 0xffff
    s_mov_b32 s26, 0x400000
    s_mov_b32 s27, 0x00020000
    s_add_u32 s36, s6, 0x5000000
    s_addc_u32 s37, s7, 0
    s_and_b32 s37, s37, 0xffff
    s_mov_b32 s38, 0x800000
    s_mov_b32 s39, 0x00020000
    s_add_u32 s48, s6, 0x4807000
    s_addc_u32 s49, s7, 0
    s_and_b32 s49, s49, 0xffff
    s_mov_b32 s50, 0x8000
    s_mov_b32 s51, 0x00020000
    s_lshl_b32 s52, s2, 14
    s_add_u32 s52, s52, s60
    s_xor_b32 s53, s52, 0x10000
    s_lshl_b32 s57, s2, 7
    s_xor_b32 s58, s57, 0x200
    v_lshrrev_b32 v56, 4, v1
    s_lshl_b32 s31, s30, 6
    s_add_u32 s31, s31, (op_tail2-op_tail)/128-64
    s_cmp_eq_u32 s30, 0
    s_cselect_b32 s31, 0, s31
    v_add_u32 v56, s31, v56
    s_mov_b32 s31, (code_end-op_tail)/128
    v_min_u32 v56, s31, v56
    s_getpc_b64 s[40:41]
pc_127:
    s_add_u32 s40, s40, op_tail-pc_127
    s_addc_u32 s41, s41, 0
    v_lshlrev_b32 v82, 7, v56
    v_mov_b32 v83, s41
    v_add_co_u32 v82, vcc, s40, v82
    s_nop 1
    v_addc_co_u32 v83, vcc, 0, v83, vcc
    s_mov_b32 s63, 0
    s_waitcnt vmcnt(8) lgkmcnt(0)
    s_mov_b32 s20, s28
    s_and_b32 s21, s29, 0xffff
    s_mov_b32 s22, 0x400000
    s_mov_b32 s23, 0x00020000
    s_mov_b32 s44, s42
    s_and_b32 s45, s43, 0xffff
    s_mov_b32 s46, 0x800
    s_mov_b32 s47, 0x00020000
op_loop_128:
    v_mfma_f32_16x16x32_bf16 v[160:163], a[16:19], a[128:131], v[160:163]
    s_add_u32 m0, s60, 49152
    ds_read_b64_tr_b16 a[64:65], v64 offset:16384
    ds_read_b64_tr_b16 a[66:67], v64 offset:20480
    v_mfma_f32_16x16x32_bf16 v[164:167], a[16:19], a[132:135], v[164:167]
    buffer_load_dwordx4 v90, s[12:15], s61 offen offset:0 lds
    ds_read_b64_tr_b16 a[68:69], v65 offset:16384
    v_mfma_f32_16x16x32_bf16 v[168:171], a[20:23], a[128:131], v[168:171]
    ds_read_b64_tr_b16 a[70:71], v65 offset:20480
    ds_read_b64_tr_b16 a[72:73], v66 offset:16384
    v_mfma_f32_16x16x32_bf16 v[172:175], a[20:23], a[132:135], v[172:175]
    buffer_load_dwordx4 v91, s[12:15], s61 offen offset:1024 lds
    ds_read_b64_tr_b16 a[74:75], v66 offset:20480
    v_mfma_f32_16x16x32_bf16 v[176:179], a[24:27], a[128:131], v[176:179]
    ds_read_b64_tr_b16 a[76:77], v67 offset:16384
    ds_read_b64_tr_b16 a[78:79], v67 offset:20480
    v_mfma_f32_16x16x32_bf16 v[180:183], a[24:27], a[132:135], v[180:183]
    ds_read_b64_tr_b16 a[80:81], v68 offset:16384
    v_mfma_f32_16x16x32_bf16 v[184:187], a[28:31], a[128:131], v[184:187]
    ds_read_b64_tr_b16 a[82:83], v68 offset:20480
    v_mfma_f32_16x16x32_bf16 v[188:191], a[28:31], a[132:135], v[188:191]
    buffer_load_dwordx4 v92, s[12:15], s61 offen offset:2048 lds
    ds_read_b64_tr_b16 a[84:85], v69 offset:16384
    v_mfma_f32_16x16x32_bf16 v[128:131], a[0:3], a[128:131], v[128:131]
    ds_read_b64_tr_b16 a[86:87], v69 offset:20480
    ds_read_b64_tr_b16 a[88:89], v70 offset:16384
    v_mfma_f32_16x16x32_bf16 v[132:135], a[0:3], a[132:135], v[132:135]
    ds_read_b64_tr_b16 a[90:91], v70 offset:20480
    v_mfma_f32_16x16x32_bf16 v[136:139], a[4:7], a[128:131], v[136:139]
    buffer_load_dwordx4 v93, s[12:15], s61 offen offset:3072 lds
    ds_read_b64_tr_b16 a[92:93], v71 offset:16384
    v_mfma_f32_16x16x32_bf16 v[140:143], a[4:7], a[132:135], v[140:143]
    ds_read_b64_tr_b16 a[94:95], v71 offset:20480
    ds_read_b64_tr_b16 a[96:97], v64 offset:24576
    v_mfma_f32_16x16x32_bf16 v[144:147], a[8:11], a[128:131], v[144:147]
    ds_read_b64_tr_b16 a[98:99], v64 offset:28672
    v_mfma_f32_16x16x32_bf16 v[148:151], a[8:11], a[132:135], v[148:151]
    ds_read_b64_tr_b16 a[100:101], v65 offset:24576
    v_mfma_f32_16x16x32_bf16 v[152:155], a[12:15], a[128:131], v[152:155]
    buffer_load_dwordx4 a[176:179], v88, s[8:11], s62 offen offset:0 sc1
    ds_read_b64_tr_b16 a[102:103], v65 offset:28672
    v_mfma_f32_16x16x32_bf16 v[156:159], a[12:15], a[132:135], v[156:159]
    s_add_u32 s61, s61, 0x20000
    s_and_b32 s61, s61, 0x3fffff
    ds_read_b64_tr_b16 a[104:105], v66 offset:24576
    ds_read_b64_tr_b16 a[106:107], v66 offset:28672
    v_mfma_f32_16x16x32_bf16 v[160:163], a[48:51], a[136:139], v[160:163]
    ds_read_b64_tr_b16 a[108:109], v67 offset:24576
    v_mfma_f32_16x16x32_bf16 v[164:167], a[48:51], a[140:143], v[164:167]
    buffer_load_dwordx4 a[180:183], v88, s[8:11], s62 offen offset:1024 sc1
    ds_read_b64_tr_b16 a[110:111], v67 offset:28672
    v_mfma_f32_16x16x32_bf16 v[168:171], a[52:55], a[136:139], v[168:171]
    ds_read_b64_tr_b16 a[112:113], v68 offset:24576
    v_mfma_f32_16x16x32_bf16 v[172:175], a[52:55], a[140:143], v[172:175]
    ds_read_b64_tr_b16 a[114:115], v68 offset:28672
    ds_read_b64_tr_b16 a[116:117], v69 offset:24576
    v_mfma_f32_16x16x32_bf16 v[176:179], a[56:59], a[136:139], v[176:179]
    ds_read_b64_tr_b16 a[118:119], v69 offset:28672
    v_mfma_f32_16x16x32_bf16 v[180:183], a[56:59], a[140:143], v[180:183]
    buffer_load_dwordx4 a[184:187], v89, s[8:11], s62 offen offset:0 sc1
    ds_read_b64_tr_b16 a[120:121], v70 offset:24576
    v_mfma_f32_16x16x32_bf16 v[184:187], a[60:63], a[136:139], v[184:187]
    ds_read_b64_tr_b16 a[122:123], v70 offset:28672
    ds_read_b64_tr_b16 a[124:125], v71 offset:24576
    v_mfma_f32_16x16x32_bf16 v[188:191], a[60:63], a[140:143], v[188:191]
    ds_read_b64_tr_b16 a[126:127], v71 offset:28672
    v_mfma_f32_16x16x32_bf16 v[128:131], a[32:35], a[136:139], v[128:131]
    buffer_load_dwordx4 a[188:191], v89, s[8:11], s62 offen offset:1024 sc1
    v_mfma_f32_16x16x32_bf16 v[132:135], a[32:35], a[140:143], v[132:135]
    v_mfma_f32_16x16x32_bf16 v[136:139], a[36:39], a[136:139], v[136:139]
    v_mfma_f32_16x16x32_bf16 v[140:143], a[36:39], a[140:143], v[140:143]
    v_mfma_f32_16x16x32_bf16 v[144:147], a[40:43], a[136:139], v[144:147]
    s_cmp_eq_u32 s63, 7
    s_cbranch_scc1 k12_ool_129
k12_oolret_130:
    v_mfma_f32_16x16x32_bf16 v[148:151], a[40:43], a[140:143], v[148:151]
    s_add_u32 s62, s62, 0x40000
    s_and_b32 s62, s62, 0x7fffff
    v_mfma_f32_16x16x32_bf16 v[152:155], a[44:47], a[136:139], v[152:155]
    v_mfma_f32_16x16x32_bf16 v[156:159], a[44:47], a[140:143], v[156:159]
    s_waitcnt vmcnt(12) lgkmcnt(0)
    s_barrier
    v_mfma_f32_16x16x32_bf16 v[160:163], a[80:83], a[144:147], v[160:163]
    s_add_u32 s32, s63, 1
    s_lshr_b32 s32, s32, 1
    ds_read_b64_tr_b16 a[0:1], v64 offset:32768
    v_cmp_le_u32 vcc, 4, v74
    v_mfma_f32_16x16x32_bf16 v[164:167], a[80:83], a[148:151], v[164:167]
    s_add_u32 m0, s60, 0
    ds_read_b64_tr_b16 a[2:3], v64 offset:36864
    ds_read_b64_tr_b16 a[4:5], v65 offset:32768
    v_mfma_f32_16x16x32_bf16 v[168:171], a[84:87], a[144:147], v[168:171]
    s_or_b32 s33, vcc_lo, 16
    buffer_load_dwordx4 v90, s[12:15], s61 offen offset:0 lds
    ds_read_b64_tr_b16 a[6:7], v65 offset:36864
    v_mfma_f32_16x16x32_bf16 v[172:175], a[84:87], a[148:151], v[172:175]
    ds_read_b64_tr_b16 a[8:9], v66 offset:32768
    ds_read_b64_tr_b16 a[10:11], v66 offset:36864
    v_mfma_f32_16x16x32_bf16 v[176:179], a[88:91], a[144:147], v[176:179]
    buffer_load_dwordx4 v91, s[12:15], s61 offen offset:1024 lds
    ds_read_b64_tr_b16 a[12:13], v67 offset:32768
    v_mfma_f32_16x16x32_bf16 v[180:183], a[88:91], a[148:151], v[180:183]
    ds_read_b64_tr_b16 a[14:15], v67 offset:36864
    ds_read_b64_tr_b16 a[16:17], v68 offset:32768
    v_mfma_f32_16x16x32_bf16 v[184:187], a[92:95], a[144:147], v[184:187]
    s_bitcmp0_b32 s33, s32
    s_cbranch_scc1 k12_ool_133
k12_oolret_134:
    v_mfma_f32_16x16x32_bf16 v[188:191], a[92:95], a[148:151], v[188:191]
    ds_read_b64_tr_b16 a[18:19], v68 offset:36864
    ds_read_b64_tr_b16 a[20:21], v69 offset:32768
    v_mfma_f32_16x16x32_bf16 v[128:131], a[64:67], a[144:147], v[128:131]
    buffer_load_dwordx4 v92, s[12:15], s61 offen offset:2048 lds
    ds_read_b64_tr_b16 a[22:23], v69 offset:36864
    v_mfma_f32_16x16x32_bf16 v[132:135], a[64:67], a[148:151], v[132:135]
    ds_read_b64_tr_b16 a[24:25], v70 offset:32768
    ds_read_b64_tr_b16 a[26:27], v70 offset:36864
    v_mfma_f32_16x16x32_bf16 v[136:139], a[68:71], a[144:147], v[136:139]
    buffer_load_dwordx4 v93, s[12:15], s61 offen offset:3072 lds
    ds_read_b64_tr_b16 a[28:29], v71 offset:32768
    v_mfma_f32_16x16x32_bf16 v[140:143], a[68:71], a[148:151], v[140:143]
    ds_read_b64_tr_b16 a[30:31], v71 offset:36864
    ds_read_b64_tr_b16 a[32:33], v64 offset:40960
    v_mfma_f32_16x16x32_bf16 v[144:147], a[72:75], a[144:147], v[144:147]
    ds_read_b64_tr_b16 a[34:35], v64 offset:45056
    v_mfma_f32_16x16x32_bf16 v[148:151], a[72:75], a[148:151], v[148:151]
    ds_read_b64_tr_b16 a[36:37], v65 offset:40960
    v_mfma_f32_16x16x32_bf16 v[152:155], a[76:79], a[144:147], v[152:155]
    buffer_load_dwordx4 a[128:131], v88, s[8:11], s62 offen offset:0 sc1
    ds_read_b64_tr_b16 a[38:39], v65 offset:45056
    v_mfma_f32_16x16x32_bf16 v[156:159], a[76:79], a[148:151], v[156:159]
    s_add_u32 s61, s61, 0x20000
    s_and_b32 s61, s61, 0x3fffff
    ds_read_b64_tr_b16 a[40:41], v66 offset:40960
    ds_read_b64_tr_b16 a[42:43], v66 offset:45056
    v_mfma_f32_16x16x32_bf16 v[160:163], a[112:115], a[152:155], v[160:163]
    ds_read_b64_tr_b16 a[44:45], v67 offset:40960
    v_mfma_f32_16x16x32_bf16 v[164:167], a[112:115], a[156:159], v[164:167]
    buffer_load_dwordx4 a[132:135], v88, s[8:11], s62 offen offset:1024 sc1
    ds_read_b64_tr_b16 a[46:47], v67 offset:45056
    v_mfma_f32_16x16x32_bf16 v[168:171], a[116:119], a[152:155], v[168:171]
    ds_read_b64_tr_b16 a[48:49], v68 offset:40960
    v_mfma_f32_16x16x32_bf16 v[172:175], a[116:119], a[156:159], v[172:175]
    ds_read_b64_tr_b16 a[50:51], v68 offset:45056
    ds_read_b64_tr_b16 a[52:53], v69 offset:40960
    v_mfma_f32_16x16x32_bf16 v[176:179], a[120:123], a[152:155], v[176:179]
    ds_read_b64_tr_b16 a[54:55], v69 offset:45056
    v_mfma_f32_16x16x32_bf16 v[180:183], a[120:123], a[156:159], v[180:183]
    buffer_load_dwordx4 a[136:139], v89, s[8:11], s62 offen offset:0 sc1
    ds_read_b64_tr_b16 a[56:57], v70 offset:40960
    v_mfma_f32_16x16x32_bf16 v[184:187], a[124:127], a[152:155], v[184:187]
    ds_read_b64_tr_b16 a[58:59], v70 offset:45056
    ds_read_b64_tr_b16 a[60:61], v71 offset:40960
    v_mfma_f32_16x16x32_bf16 v[188:191], a[124:127], a[156:159], v[188:191]
    ds_read_b64_tr_b16 a[62:63], v71 offset:45056
    v_mfma_f32_16x16x32_bf16 v[128:131], a[96:99], a[152:155], v[128:131]
    buffer_load_dwordx4 a[140:143], v89, s[8:11], s62 offen offset:1024 sc1
    v_mfma_f32_16x16x32_bf16 v[132:135], a[96:99], a[156:159], v[132:135]
    v_mfma_f32_16x16x32_bf16 v[136:139], a[100:103], a[152:155], v[136:139]
    v_mfma_f32_16x16x32_bf16 v[140:143], a[100:103], a[156:159], v[140:143]
    v_mfma_f32_16x16x32_bf16 v[144:147], a[104:107], a[152:155], v[144:147]
    v_mfma_f32_16x16x32_bf16 v[148:151], a[104:107], a[156:159], v[148:151]
    s_add_u32 s62, s62, 0x40000
    s_and_b32 s62, s62, 0x7fffff
    v_mfma_f32_16x16x32_bf16 v[152:155], a[108:111], a[152:155], v[152:155]
    v_mfma_f32_16x16x32_bf16 v[156:159], a[108:111], a[156:159], v[156:159]
    s_waitcnt vmcnt(12) lgkmcnt(0)
    s_barrier
    v_mfma_f32_16x16x32_bf16 v[160:163], a[16:19], a[160:163], v[160:163]
    s_add_u32 m0, s60, 16384
    buffer_load_dword v74, v73, s[16:19], s59 offen sc1
    ds_read_b64_tr_b16 a[64:65], v64 offset:49152
    v_mfma_f32_16x16x32_bf16 v[164:167], a[16:19], a[164:167], v[164:167]
    buffer_load_dwordx4 v90, s[12:15], s61 offen offset:0 lds
    ds_read_b64_tr_b16 a[66:67], v64 offset:53248
    v_mfma_f32_16x16x32_bf16 v[168:171], a[20:23], a[160:163], v[168:171]
    ds_read_b64_tr_b16 a[68:69], v65 offset:49152
    ds_read_b64_tr_b16 a[70:71], v65 offset:53248
    v_mfma_f32_16x16x32_bf16 v[172:175], a[20:23], a[164:167], v[172:175]
    ds_read_b64_tr_b16 a[72:73], v66 offset:49152
    ds_read_b64_tr_b16 a[74:75], v66 offset:53248
    v_mfma_f32_16x16x32_bf16 v[176:179], a[24:27], a[160:163], v[176:179]
    buffer_load_dwordx4 v91, s[12:15], s61 offen offset:1024 lds
    ds_read_b64_tr_b16 a[76:77], v67 offset:49152
    v_mfma_f32_16x16x32_bf16 v[180:183], a[24:27], a[164:167], v[180:183]
    ds_read_b64_tr_b16 a[78:79], v67 offset:53248
    ds_read_b64_tr_b16 a[80:81], v68 offset:49152
    v_mfma_f32_16x16x32_bf16 v[184:187], a[28:31], a[160:163], v[184:187]
    ds_read_b64_tr_b16 a[82:83], v68 offset:53248
    v_mfma_f32_16x16x32_bf16 v[188:191], a[28:31], a[164:167], v[188:191]
    buffer_load_dwordx4 v92, s[12:15], s61 offen offset:2048 lds
    ds_read_b64_tr_b16 a[84:85], v69 offset:49152
    v_mfma_f32_16x16x32_bf16 v[128:131], a[0:3], a[160:163], v[128:131]
    ds_read_b64_tr_b16 a[86:87], v69 offset:53248
    ds_read_b64_tr_b16 a[88:89], v70 offset:49152
    v_mfma_f32_16x16x32_bf16 v[132:135], a[0:3], a[164:167], v[132:135]
    ds_read_b64_tr_b16 a[90:91], v70 offset:53248
    v_mfma_f32_16x16x32_bf16 v[136:139], a[4:7], a[160:163], v[136:139]
    buffer_load_dwordx4 v93, s[12:15], s61 offen offset:3072 lds
    ds_read_b64_tr_b16 a[92:93], v71 offset:49152
    v_mfma_f32_16x16x32_bf16 v[140:143], a[4:7], a[164:167], v[140:143]
    ds_read_b64_tr_b16 a[94:95], v71 offset:53248
    ds_read_b64_tr_b16 a[96:97], v64 offset:57344
    v_mfma_f32_16x16x32_bf16 v[144:147], a[8:11], a[160:163], v[144:147]
    ds_read_b64_tr_b16 a[98:99], v64 offset:61440
    v_mfma_f32_16x16x32_bf16 v[148:151], a[8:11], a[164:167], v[148:151]
    ds_read_b64_tr_b16 a[100:101], v65 offset:57344
    v_mfma_f32_16x16x32_bf16 v[152:155], a[12:15], a[160:163], v[152:155]
    buffer_load_dwordx4 a[144:147], v88, s[8:11], s62 offen offset:0 sc1
    ds_read_b64_tr_b16 a[102:103], v65 offset:61440
    v_mfma_f32_16x16x32_bf16 v[156:159], a[12:15], a[164:167], v[156:159]
    s_add_u32 s61, s61, 0x20000
    s_and_b32 s61, s61, 0x3fffff
    ds_read_b64_tr_b16 a[104:105], v66 offset:57344
    ds_read_b64_tr_b16 a[106:107], v66 offset:61440
    v_mfma_f32_16x16x32_bf16 v[160:163], a[48:51], a[168:171], v[160:163]
    ds_read_b64_tr_b16 a[108:109], v67 offset:57344
    v_mfma_f32_16x16x32_bf16 v[164:167], a[48:51], a[172:175], v[164:167]
    buffer_load_dwordx4 a[148:151], v88, s[8:11], s62 offen offset:1024 sc1
    ds_read_b64_tr_b16 a[110:111], v67 offset:61440
    v_mfma_f32_16x16x32_bf16 v[168:171], a[52:55], a[168:171], v[168:171]
    ds_read_b64_tr_b16 a[112:113], v68 offset:57344
    v_mfma_f32_16x16x32_bf16 v[172:175], a[52:55], a[172:175], v[172:175]
    ds_read_b64_tr_b16 a[114:115], v68 offset:61440
    ds_read_b64_tr_b16 a[116:117], v69 offset:57344
    v_mfma_f32_16x16x32_bf16 v[176:179], a[56:59], a[168:171], v[176:179]
    ds_read_b64_tr_b16 a[118:119], v69 offset:61440
    v_mfma_f32_16x16x32_bf16 v[180:183], a[56:59], a[172:175], v[180:183]
    buffer_load_dwordx4 a[152:155], v89, s[8:11], s62 offen offset:0 sc1
    ds_read_b64_tr_b16 a[120:121], v70 offset:57344
    v_mfma_f32_16x16x32_bf16 v[184:187], a[60:63], a[168:171], v[184:187]
    ds_read_b64_tr_b16 a[122:123], v70 offset:61440
    ds_read_b64_tr_b16 a[124:125], v71 offset:57344
    v_mfma_f32_16x16x32_bf16 v[188:191], a[60:63], a[172:175], v[188:191]
    ds_read_b64_tr_b16 a[126:127], v71 offset:61440
    v_mfma_f32_16x16x32_bf16 v[128:131], a[32:35], a[168:171], v[128:131]
    buffer_load_dwordx4 a[156:159], v89, s[8:11], s62 offen offset:1024 sc1
    v_mfma_f32_16x16x32_bf16 v[132:135], a[32:35], a[172:175], v[132:135]
    v_mfma_f32_16x16x32_bf16 v[136:139], a[36:39], a[168:171], v[136:139]
    v_mfma_f32_16x16x32_bf16 v[140:143], a[36:39], a[172:175], v[140:143]
    v_mfma_f32_16x16x32_bf16 v[144:147], a[40:43], a[168:171], v[144:147]
    v_mfma_f32_16x16x32_bf16 v[148:151], a[40:43], a[172:175], v[148:151]
    s_add_u32 s62, s62, 0x40000
    s_and_b32 s62, s62, 0x7fffff
    v_mfma_f32_16x16x32_bf16 v[152:155], a[44:47], a[168:171], v[152:155]
    v_mfma_f32_16x16x32_bf16 v[156:159], a[44:47], a[172:175], v[156:159]
    s_waitcnt vmcnt(12) lgkmcnt(0)
    s_barrier
    v_mfma_f32_16x16x32_bf16 v[160:163], a[80:83], a[176:179], v[160:163]
    s_add_u32 m0, s60, 32768
    ds_read_b64_tr_b16 a[0:1], v64 offset:0
    ds_read_b64_tr_b16 a[2:3], v64 offset:4096
    v_mfma_f32_16x16x32_bf16 v[164:167], a[80:83], a[180:183], v[164:167]
    buffer_load_dwordx4 v90, s[12:15], s61 offen offset:0 lds
    ds_read_b64_tr_b16 a[4:5], v65 offset:0
    v_mfma_f32_16x16x32_bf16 v[168:171], a[84:87], a[176:179], v[168:171]
    ds_read_b64_tr_b16 a[6:7], v65 offset:4096
    ds_read_b64_tr_b16 a[8:9], v66 offset:0
    v_mfma_f32_16x16x32_bf16 v[172:175], a[84:87], a[180:183], v[172:175]
    buffer_load_dwordx4 v91, s[12:15], s61 offen offset:1024 lds
    ds_read_b64_tr_b16 a[10:11], v66 offset:4096
    v_mfma_f32_16x16x32_bf16 v[176:179], a[88:91], a[176:179], v[176:179]
    ds_read_b64_tr_b16 a[12:13], v67 offset:0
    ds_read_b64_tr_b16 a[14:15], v67 offset:4096
    v_mfma_f32_16x16x32_bf16 v[180:183], a[88:91], a[180:183], v[180:183]
    ds_read_b64_tr_b16 a[16:17], v68 offset:0
    v_mfma_f32_16x16x32_bf16 v[184:187], a[92:95], a[176:179], v[184:187]
    ds_read_b64_tr_b16 a[18:19], v68 offset:4096
    v_mfma_f32_16x16x32_bf16 v[188:191], a[92:95], a[180:183], v[188:191]
    buffer_load_dwordx4 v92, s[12:15], s61 offen offset:2048 lds
    ds_read_b64_tr_b16 a[20:21], v69 offset:0
    v_mfma_f32_16x16x32_bf16 v[128:131], a[64:67], a[176:179], v[128:131]
    ds_read_b64_tr_b16 a[22:23], v69 offset:4096
    ds_read_b64_tr_b16 a[24:25], v70 offset:0
    v_mfma_f32_16x16x32_bf16 v[132:135], a[64:67], a[180:183], v[132:135]
    ds_read_b64_tr_b16 a[26:27], v70 offset:4096
    v_mfma_f32_16x16x32_bf16 v[136:139], a[68:71], a[176:179], v[136:139]
    buffer_load_dwordx4 v93, s[12:15], s61 offen offset:3072 lds
    ds_read_b64_tr_b16 a[28:29], v71 offset:0
    v_mfma_f32_16x16x32_bf16 v[140:143], a[68:71], a[180:183], v[140:143]
    ds_read_b64_tr_b16 a[30:31], v71 offset:4096
    ds_read_b64_tr_b16 a[32:33], v64 offset:8192
    v_mfma_f32_16x16x32_bf16 v[144:147], a[72:75], a[176:179], v[144:147]
    ds_read_b64_tr_b16 a[34:35], v64 offset:12288
    v_mfma_f32_16x16x32_bf16 v[148:151], a[72:75], a[180:183], v[148:151]
    ds_read_b64_tr_b16 a[36:37], v65 offset:8192
    v_mfma_f32_16x16x32_bf16 v[152:155], a[76:79], a[176:179], v[152:155]
    buffer_load_dwordx4 a[160:163], v88, s[8:11], s62 offen offset:0 sc1
    ds_read_b64_tr_b16 a[38:39], v65 offset:12288
    v_mfma_f32_16x16x32_bf16 v[156:159], a[76:79], a[180:183], v[156:159]
    s_add_u32 s61, s61, 0x20000
    s_and_b32 s61, s61, 0x3fffff
    ds_read_b64_tr_b16 a[40:41], v66 offset:8192
    ds_read_b64_tr_b16 a[42:43], v66 offset:12288
    v_mfma_f32_16x16x32_bf16 v[160:163], a[112:115], a[184:187], v[160:163]
    ds_read_b64_tr_b16 a[44:45], v67 offset:8192
    v_mfma_f32_16x16x32_bf16 v[164:167], a[112:115], a[188:191], v[164:167]
    buffer_load_dwordx4 a[164:167], v88, s[8:11], s62 offen offset:1024 sc1
    ds_read_b64_tr_b16 a[46:47], v67 offset:12288
    v_mfma_f32_16x16x32_bf16 v[168:171], a[116:119], a[184:187], v[168:171]
    ds_read_b64_tr_b16 a[48:49], v68 offset:8192
    v_mfma_f32_16x16x32_bf16 v[172:175], a[116:119], a[188:191], v[172:175]
    ds_read_b64_tr_b16 a[50:51], v68 offset:12288
    ds_read_b64_tr_b16 a[52:53], v69 offset:8192
    v_mfma_f32_16x16x32_bf16 v[176:179], a[120:123], a[184:187], v[176:179]
    ds_read_b64_tr_b16 a[54:55], v69 offset:12288
    v_mfma_f32_16x16x32_bf16 v[180:183], a[120:123], a[188:191], v[180:183]
    buffer_load_dwordx4 a[168:171], v89, s[8:11], s62 offen offset:0 sc1
    ds_read_b64_tr_b16 a[56:57], v70 offset:8192
    v_mfma_f32_16x16x32_bf16 v[184:187], a[124:127], a[184:187], v[184:187]
    ds_read_b64_tr_b16 a[58:59], v70 offset:12288
    ds_read_b64_tr_b16 a[60:61], v71 offset:8192
    v_mfma_f32_16x16x32_bf16 v[188:191], a[124:127], a[188:191], v[188:191]
    ds_read_b64_tr_b16 a[62:63], v71 offset:12288
    v_mfma_f32_16x16x32_bf16 v[128:131], a[96:99], a[184:187], v[128:131]
    buffer_load_dwordx4 a[172:175], v89, s[8:11], s62 offen offset:1024 sc1
    v_mfma_f32_16x16x32_bf16 v[132:135], a[96:99], a[188:191], v[132:135]
    v_mfma_f32_16x16x32_bf16 v[136:139], a[100:103], a[184:187], v[136:139]
    v_mfma_f32_16x16x32_bf16 v[140:143], a[100:103], a[188:191], v[140:143]
    v_mfma_f32_16x16x32_bf16 v[144:147], a[104:107], a[184:187], v[144:147]
    v_mfma_f32_16x16x32_bf16 v[148:151], a[104:107], a[188:191], v[148:151]
    s_add_u32 s62, s62, 0x40000
    s_and_b32 s62, s62, 0x7fffff
    v_mfma_f32_16x16x32_bf16 v[152:155], a[108:111], a[184:187], v[152:155]
    s_add_u32 s63, s63, 1
    v_mfma_f32_16x16x32_bf16 v[156:159], a[108:111], a[188:191], v[156:159]
    s_waitcnt vmcnt(12) lgkmcnt(0)
    s_barrier
    s_cmp_lt_u32 s63, 8
    s_cbranch_scc1 op_loop_128
op_tail:
    s_nop 1
    v_cvt_pk_bf16_f32 v160, v160, v161
    v_cvt_pk_bf16_f32 v161, v162, v163
    v_cvt_pk_bf16_f32 v162, v164, v165
    v_cvt_pk_bf16_f32 v163, v166, v167
    buffer_store_dwordx4 v[160:163], v1, s[36:39], s52 offen offset:0 sc1
    v_cvt_pk_bf16_f32 v168, v168, v169
    v_cvt_pk_bf16_f32 v169, v170, v171
    v_cvt_pk_bf16_f32 v170, v172, v173
    v_cvt_pk_bf16_f32 v171, v174, v175
    buffer_store_dwordx4 v[168:171], v1, s[36:39], s52 offen offset:1024 sc1
    v_cvt_pk_bf16_f32 v176, v176, v177
    v_cvt_pk_bf16_f32 v177, v178, v179
    v_cvt_pk_bf16_f32 v178, v180, v181
    v_cvt_pk_bf16_f32 v179, v182, v183
    buffer_store_dwordx4 v[176:179], v1, s[36:39], s52 offen offset:2048 sc1
    v_cvt_pk_bf16_f32 v184, v184, v185
    v_cvt_pk_bf16_f32 v185, v186, v187
    v_cvt_pk_bf16_f32 v186, v188, v189
    v_cvt_pk_bf16_f32 v187, v190, v191
    buffer_store_dwordx4 v[184:187], v1, s[36:39], s52 offen offset:3072 sc1
    s_add_u32 s32, s6, 0x4800000
    s_addc_u32 s33, s7, 0
    s_and_b32 s33, s33, 0xffff
    s_mov_b32 s34, 0x6000
    s_mov_b32 s35, 0x00020000
    s_waitcnt vmcnt(4)
    v_lshlrev_b32 v58, 16, v192
    v_and_b32 v59, 0xffff0000, v192
    v_pk_add_f32 v[128:129], v[128:129], v[58:59]
    v_lshlrev_b32 v58, 16, v193
    v_and_b32 v59, 0xffff0000, v193
    v_pk_add_f32 v[130:131], v[130:131], v[58:59]
    v_lshlrev_b32 v58, 16, v200
    v_and_b32 v59, 0xffff0000, v200
    v_pk_add_f32 v[132:133], v[132:133], v[58:59]
    v_lshlrev_b32 v58, 16, v201
    v_and_b32 v59, 0xffff0000, v201
    v_pk_add_f32 v[134:135], v[134:135], v[58:59]
    v_lshlrev_b32 v58, 16, v194
    v_and_b32 v59, 0xffff0000, v194
    v_pk_add_f32 v[136:137], v[136:137], v[58:59]
    v_lshlrev_b32 v58, 16, v195
    v_and_b32 v59, 0xffff0000, v195
    v_pk_add_f32 v[138:139], v[138:139], v[58:59]
    v_lshlrev_b32 v58, 16, v202
    v_and_b32 v59, 0xffff0000, v202
    v_pk_add_f32 v[140:141], v[140:141], v[58:59]
    v_lshlrev_b32 v58, 16, v203
    v_and_b32 v59, 0xffff0000, v203
    v_pk_add_f32 v[142:143], v[142:143], v[58:59]
    v_lshlrev_b32 v58, 16, v196
    v_and_b32 v59, 0xffff0000, v196
    v_pk_add_f32 v[144:145], v[144:145], v[58:59]
    v_lshlrev_b32 v58, 16, v197
    v_and_b32 v59, 0xffff0000, v197
    v_pk_add_f32 v[146:147], v[146:147], v[58:59]
    v_lshlrev_b32 v58, 16, v204
    v_and_b32 v59, 0xffff0000, v204
    v_pk_add_f32 v[148:149], v[148:149], v[58:59]
    v_lshlrev_b32 v58, 16, v205
    v_and_b32 v59, 0xffff0000, v205
    v_pk_add_f32 v[150:151], v[150:151], v[58:59]
    v_lshlrev_b32 v58, 16, v198
    v_and_b32 v59, 0xffff0000, v198
    v_pk_add_f32 v[152:153], v[152:153], v[58:59]
    v_lshlrev_b32 v58, 16, v199
    v_and_b32 v59, 0xffff0000, v199
    v_pk_add_f32 v[154:155], v[154:155], v[58:59]
    v_lshlrev_b32 v58, 16, v206
    v_and_b32 v59, 0xffff0000, v206
    v_pk_add_f32 v[156:157], v[156:157], v[58:59]
    v_lshlrev_b32 v58, 16, v207
    v_and_b32 v59, 0xffff0000, v207
    v_pk_add_f32 v[158:159], v[158:159], v[58:59]
    v_and_b32 v58, 1, v72
    v_lshrrev_b32 v59, 1, v72
    v_lshlrev_b32 v58, 5, v58
    v_lshl_add_u32 v58, v59, 4, v58
    v_lshlrev_b32 v59, 3, v72
    v_sub_u32 v58, v58, v59
    v_add_u32 v78, v78, v58
    v_add_u32 v79, v79, v58
    v_lshlrev_b32 v32, 16, v208
    v_and_b32 v33, 0xffff0000, v208
    v_lshlrev_b32 v34, 16, v209
    v_and_b32 v35, 0xffff0000, v209
    v_lshlrev_b32 v36, 16, v210
    v_and_b32 v37, 0xffff0000, v210
    v_lshlrev_b32 v38, 16, v211
    v_and_b32 v39, 0xffff0000, v211
    v_lshlrev_b32 v40, 16, v212
    v_and_b32 v41, 0xffff0000, v212
    v_lshlrev_b32 v42, 16, v213
    v_and_b32 v43, 0xffff0000, v213
    v_lshlrev_b32 v44, 16, v214
    v_and_b32 v45, 0xffff0000, v214
    v_lshlrev_b32 v46, 16, v215
    v_and_b32 v47, 0xffff0000, v215
    s_or_b32 s31, s54, s30
    s_cbranch_scc1 op_nowr_135
    v_pk_add_f32 v[56:57], v[32:33], v[34:35]
    v_pk_add_f32 v[56:57], v[56:57], v[36:37]
    v_pk_add_f32 v[56:57], v[56:57], v[38:39]
    v_pk_add_f32 v[56:57], v[56:57], v[40:41]
    v_pk_add_f32 v[56:57], v[56:57], v[42:43]
    v_pk_add_f32 v[56:57], v[56:57], v[44:45]
    v_pk_add_f32 v[56:57], v[56:57], v[46:47]
    v_add_f32 v56, v56, v57
    v_mov_b32 v57, v56
    s_nop 1
    v_permlane16_swap_b32 v56, v57
    s_nop 1
    v_add_f32 v56, v56, v57
    v_mov_b32 v57, v56
    s_nop 1
    v_permlane32_swap_b32 v56, v57
    s_nop 1
    v_add_f32 v56, v56, v57
    s_mov_b32 s31, 24704
    s_mov_b32 s34, 24708
    s_mov_b64 exec, 1
    buffer_atomic_add_f32 v56, v75, s[32:35], s31 offen
    s_mov_b64 exec, -1
    s_mov_b32 s34, 24576
op_nowr_135:
    v_mov_b32 v208, 0
    v_mov_b32 v209, 0
    v_mov_b32 v210, 0
    v_mov_b32 v211, 0
    v_mov_b32 v212, 0
    v_mov_b32 v213, 0
    v_mov_b32 v214, 0
    v_mov_b32 v215, 0
    v_mov_b32 v216, 0
    v_mov_b32 v217, 0
    v_mov_b32 v218, 0
    v_mov_b32 v219, 0
    s_waitcnt vmcnt(0)
    s_barrier
    s_cmp_lg_u32 s30, 0
    s_cbranch_scc1 op_nopoll_136
    s_mov_b64 exec, 1
    buffer_store_dword v76, v75, s[48:51], s57 offen sc1
    s_mov_b64 exec, -1
    s_mov_b32 s40, 1048576
op_xspin_137:
    buffer_load_dword v84, v75, s[48:51], s58 offen sc1
    s_waitcnt vmcnt(0)
    v_readfirstlane_b32 s41, v84
    s_sub_u32 s40, s40, 1
    s_cselect_b32 s41, 1, s41
    s_cmp_eq_u32 s41, 0
    s_cbranch_scc1 op_xspin_137
op_nopoll_136:
    s_barrier
    buffer_load_dwordx4 v[160:163], v1, s[36:39], s53 offen offset:0 sc1
    buffer_load_dwordx4 v[164:167], v1, s[36:39], s53 offen offset:1024 sc1
    buffer_load_dwordx4 v[168:171], v1, s[36:39], s53 offen offset:2048 sc1
    buffer_load_dwordx4 v[172:175], v1, s[36:39], s53 offen offset:3072 sc1
    s_waitcnt vmcnt(3)
    v_lshlrev_b32 v56, 16, v160
    v_and_b32 v57, 0xffff0000, v160
    v_lshlrev_b32 v58, 16, v161
    v_and_b32 v59, 0xffff0000, v161
    v_pk_add_f32 v[128:129], v[128:129], v[56:57]
    v_pk_add_f32 v[130:131], v[130:131], v[58:59]
    v_cvt_pk_bf16_f32 v192, v128, v129
    v_cvt_pk_bf16_f32 v193, v130, v131
    v_lshlrev_b32 v128, 16, v192
    v_and_b32 v129, 0xffff0000, v192
    v_lshlrev_b32 v130, 16, v193
    v_and_b32 v131, 0xffff0000, v193
    v_pk_add_f32 v[208:209], v[208:209], v[128:129]
    v_pk_fma_f32 v[210:211], v[128:129], v[128:129], v[210:211]
    v_pk_fma_f32 v[212:213], v[128:129], v[32:33], v[212:213]
    v_pk_add_f32 v[208:209], v[208:209], v[130:131]
    v_pk_fma_f32 v[210:211], v[130:131], v[130:131], v[210:211]
    v_pk_fma_f32 v[212:213], v[130:131], v[34:35], v[212:213]
    v_lshlrev_b32 v56, 16, v162
    v_and_b32 v57, 0xffff0000, v162
    v_lshlrev_b32 v58, 16, v163
    v_and_b32 v59, 0xffff0000, v163
    v_pk_add_f32 v[132:133], v[132:133], v[56:57]
    v_pk_add_f32 v[134:135], v[134:135], v[58:59]
    v_cvt_pk_bf16_f32 v200, v132, v133
    v_cvt_pk_bf16_f32 v201, v134, v135
    v_lshlrev_b32 v132, 16, v200
    v_and_b32 v133, 0xffff0000, v200
    v_lshlrev_b32 v134, 16, v201
    v_and_b32 v135, 0xffff0000, v201
    v_pk_add_f32 v[214:215], v[214:215], v[132:133]
    v_pk_fma_f32 v[216:217], v[132:133], v[132:133], v[216:217]
    v_pk_fma_f32 v[218:219], v[132:133], v[32:33], v[218:219]
    v_pk_add_f32 v[214:215], v[214:215], v[134:135]
    v_pk_fma_f32 v[216:217], v[134:135], v[134:135], v[216:217]
    v_pk_fma_f32 v[218:219], v[134:135], v[34:35], v[218:219]
    s_waitcnt vmcnt(2)
    v_lshlrev_b32 v56, 16, v164
    v_and_b32 v57, 0xffff0000, v164
    v_lshlrev_b32 v58, 16, v165
    v_and_b32 v59, 0xffff0000, v165
    v_pk_add_f32 v[136:137], v[136:137], v[56:57]
    v_pk_add_f32 v[138:139], v[138:139], v[58:59]
    v_cvt_pk_bf16_f32 v194, v136, v137
    v_cvt_pk_bf16_f32 v195, v138, v139
    v_lshlrev_b32 v136, 16, v194
    v_and_b32 v137, 0xffff0000, v194
    v_lshlrev_b32 v138, 16, v195
    v_and_b32 v139, 0xffff0000, v195
    v_permlane16_swap_b32 v192, v194
    v_permlane16_swap_b32 v193, v195
    buffer_store_dwordx4 v[192:195], v78, s[24:27], 0 offen offset:0 sc1
    v_pk_add_f32 v[208:209], v[208:209], v[136:137]
    v_pk_fma_f32 v[210:211], v[136:137], v[136:137], v[210:211]
    v_pk_fma_f32 v[212:213], v[136:137], v[36:37], v[212:213]
    v_pk_add_f32 v[208:209], v[208:209], v[138:139]
    v_pk_fma_f32 v[210:211], v[138:139], v[138:139], v[210:211]
    v_pk_fma_f32 v[212:213], v[138:139], v[38:39], v[212:213]
    v_lshlrev_b32 v56, 16, v166
    v_and_b32 v57, 0xffff0000, v166
    v_lshlrev_b32 v58, 16, v167
    v_and_b32 v59, 0xffff0000, v167
    v_pk_add_f32 v[140:141], v[140:141], v[56:57]
    v_pk_add_f32 v[142:143], v[142:143], v[58:59]
    v_cvt_pk_bf16_f32 v202, v140, v141
    v_cvt_pk_bf16_f32 v203, v142, v143
    v_lshlrev_b32 v140, 16, v202
    v_and_b32 v141, 0xffff0000, v202
    v_lshlrev_b32 v142, 16, v203
    v_and_b32 v143, 0xffff0000, v203
    v_permlane16_swap_b32 v200, v202
    v_permlane16_swap_b32 v201, v203
    buffer_store_dwordx4 v[200:203], v79, s[24:27], 0 offen offset:0 sc1
    v_pk_add_f32 v[214:215], v[214:215], v[140:141]
    v_pk_fma_f32 v[216:217], v[140:141], v[140:141], v[216:217]
    v_pk_fma_f32 v[218:219], v[140:141], v[36:37], v[218:219]
    v_pk_add_f32 v[214:215], v[214:215], v[142:143]
    v_pk_fma_f32 v[216:217], v[142:143], v[142:143], v[216:217]
    v_pk_fma_f32 v[218:219], v[142:143], v[38:39], v[218:219]
    s_waitcnt vmcnt(3)
    v_lshlrev_b32 v56, 16, v168
    v_and_b32 v57, 0xffff0000, v168
    v_lshlrev_b32 v58, 16, v169
    v_and_b32 v59, 0xffff0000, v169
    v_pk_add_f32 v[144:145], v[144:145], v[56:57]
    v_pk_add_f32 v[146:147], v[146:147], v[58:59]
    v_cvt_pk_bf16_f32 v196, v144, v145
    v_cvt_pk_bf16_f32 v197, v146, v147
    v_lshlrev_b32 v144, 16, v196
    v_and_b32 v145, 0xffff0000, v196
    v_lshlrev_b32 v146, 16, v197
    v_and_b32 v147, 0xffff0000, v197
    v_pk_add_f32 v[208:209], v[208:209], v[144:145]
    v_pk_fma_f32 v[210:211], v[144:145], v[144:145], v[210:211]
    v_pk_fma_f32 v[212:213], v[144:145], v[40:41], v[212:213]
    v_pk_add_f32 v[208:209], v[208:209], v[146:147]
    v_pk_fma_f32 v[210:211], v[146:147], v[146:147], v[210:211]
    v_pk_fma_f32 v[212:213], v[146:147], v[42:43], v[212:213]
    v_lshlrev_b32 v56, 16, v170
    v_and_b32 v57, 0xffff0000, v170
    v_lshlrev_b32 v58, 16, v171
    v_and_b32 v59, 0xffff0000, v171
    v_pk_add_f32 v[148:149], v[148:149], v[56:57]
    v_pk_add_f32 v[150:151], v[150:151], v[58:59]
    v_cvt_pk_bf16_f32 v204, v148, v149
    v_cvt_pk_bf16_f32 v205, v150, v151
    v_lshlrev_b32 v148, 16, v204
    v_and_b32 v149, 0xffff0000, v204
    v_lshlrev_b32 v150, 16, v205
    v_and_b32 v151, 0xffff0000, v205
    v_pk_add_f32 v[214:215], v[214:215], v[148:149]
    v_pk_fma_f32 v[216:217], v[148:149], v[148:149], v[216:217]
    v_pk_fma_f32 v[218:219], v[148:149], v[40:41], v[218:219]
    v_pk_add_f32 v[214:215], v[214:215], v[150:151]
    v_pk_fma_f32 v[216:217], v[150:151], v[150:151], v[216:217]
    v_pk_fma_f32 v[218:219], v[150:151], v[42:43], v[218:219]
    s_waitcnt vmcnt(2)
    v_lshlrev_b32 v56, 16, v172
    v_and_b32 v57, 0xffff0000, v172
    v_lshlrev_b32 v58, 16, v173
    v_and_b32 v59, 0xffff0000, v173
    v_pk_add_f32 v[152:153], v[152:153], v[56:57]
    v_pk_add_f32 v[154:155], v[154:155], v[58:59]
    v_cvt_pk_bf16_f32 v198, v152, v153
    v_cvt_pk_bf16_f32 v199, v154, v155
    v_lshlrev_b32 v152, 16, v198
    v_and_b32 v153, 0xffff0000, v198
    v_lshlrev_b32 v154, 16, v199
    v_and_b32 v155, 0xffff0000, v199
    v_permlane16_swap_b32 v196, v198
    v_permlane16_swap_b32 v197, v199
    buffer_store_dwordx4 v[196:199], v78, s[24:27], 0 offen offset:64 sc1
    v_pk_add_f32 v[208:209], v[208:209], v[152:153]
    v_pk_fma_f32 v[210:211], v[152:153], v[152:153], v[210:211]
    v_pk_fma_f32 v[212:213], v[152:153], v[44:45], v[212:213]
    v_pk_add_f32 v[208:209], v[208:209], v[154:155]
    v_pk_fma_f32 v[210:211], v[154:155], v[154:155], v[210:211]
    v_pk_fma_f32 v[212:213], v[154:155], v[46:47], v[212:213]
    v_lshlrev_b32 v56, 16, v174
    v_and_b32 v57, 0xffff0000, v174
    v_lshlrev_b32 v58, 16, v175
    v_and_b32 v59, 0xffff0000, v175
    v_pk_add_f32 v[156:157], v[156:157], v[56:57]
    v_pk_add_f32 v[158:159], v[158:159], v[58:59]
    v_cvt_pk_bf16_f32 v206, v156, v157
    v_cvt_pk_bf16_f32 v207, v158, v159
    v_lshlrev_b32 v156, 16, v206
    v_and_b32 v157, 0xffff0000, v206
    v_lshlrev_b32 v158, 16, v207
    v_and_b32 v159, 0xffff0000, v207
    v_permlane16_swap_b32 v204, v206
    v_permlane16_swap_b32 v205, v207
    buffer_store_dwordx4 v[204:207], v79, s[24:27], 0 offen offset:64 sc1
    v_pk_add_f32 v[214:215], v[214:215], v[156:157]
    v_pk_fma_f32 v[216:217], v[156:157], v[156:157], v[216:217]
    v_pk_fma_f32 v[218:219], v[156:157], v[44:45], v[218:219]
    v_pk_add_f32 v[214:215], v[214:215], v[158:159]
    v_pk_fma_f32 v[216:217], v[158:159], v[158:159], v[216:217]
    v_pk_fma_f32 v[218:219], v[158:159], v[46:47], v[218:219]
    v_add_f32 v48, v208, v209
    v_add_f32 v49, v210, v211
    v_add_f32 v50, v212, v213
    v_add_f32 v52, v214, v215
    v_add_f32 v53, v216, v217
    v_add_f32 v54, v218, v219
    v_mov_b32 v56, v48
    v_mov_b32 v57, v49
    v_mov_b32 v58, v50
    v_mov_b32 v59, v52
    v_mov_b32 v60, v53
    v_mov_b32 v61, v54
    s_nop 1
    v_permlane16_swap_b32 v48, v56
    v_permlane16_swap_b32 v49, v57
    v_permlane16_swap_b32 v50, v58
    v_permlane16_swap_b32 v52, v59
    v_permlane16_swap_b32 v53, v60
    v_permlane16_swap_b32 v54, v61
    s_nop 1
    v_add_f32 v48, v48, v56
    v_add_f32 v49, v49, v57
    v_add_f32 v50, v50, v58
    v_add_f32 v52, v52, v59
    v_add_f32 v53, v53, v60
    v_add_f32 v54, v54, v61
    v_mov_b32 v56, v48
    v_mov_b32 v57, v49
    v_mov_b32 v58, v50
    v_mov_b32 v59, v52
    v_mov_b32 v60, v53
    v_mov_b32 v61, v54
    s_nop 1
    v_permlane32_swap_b32 v48, v56
    v_permlane32_swap_b32 v49, v57
    v_permlane32_swap_b32 v50, v58
    v_permlane32_swap_b32 v52, v59
    v_permlane32_swap_b32 v53, v60
    v_permlane32_swap_b32 v54, v61
    s_nop 1
    v_add_f32 v48, v48, v56
    v_add_f32 v49, v49, v57
    v_add_f32 v50, v50, v58
    v_add_f32 v52, v52, v59
    v_add_f32 v53, v53, v60
    v_add_f32 v54, v54, v61
    v_cmp_eq_u32 s[40:41], 1, v72
    v_cmp_eq_u32 s[42:43], 2, v72
    s_nop 1
    v_cndmask_b32 v48, v48, v49, s[40:41]
    v_cndmask_b32 v48, v48, v50, s[42:43]
    buffer_atomic_add_f32 v48, v77, s[32:35], 0 offen offset:0
    v_cndmask_b32 v52, v52, v53, s[40:41]
    v_cndmask_b32 v52, v52, v54, s[42:43]
    buffer_atomic_add_f32 v52, v77, s[32:35], 0 offen offset:64
    s_and_b32 s56, s2, 7
    s_mul_i32 s56, s56, 28
    s_lshr_b32 s31, s2, 3
    s_add_u32 s56, s56, s31
    s_lshl_b32 s56, s56, 15
    s_lshl_b32 s57, s30, 13
    s_add_u32 s56, s56, s57
    s_add_u32 s8, s6, 0x6000000
    s_addc_u32 s9, s7, 0
    s_and_b32 s9, s9, 0xffff
    s_mov_b32 s10, 0x1000000
    s_mov_b32 s11, 0x00020000
    s_cmp_ge_u32 s2, 224
    s_cselect_b32 s10, 0, s10
    v_lshlrev_b32 v8, 3, v1
    buffer_load_dword v9, v8, s[8:11], s56 offen
    s_add_u32 s56, s56, 0x800000
k12_end_1:
    s_endpgm
k2_prep_70:
    s_sub_u32 s40, s36, s38
    v_subrev_u32 v6, s40, v4
    v_cmp_gt_i32 s[44:45], 0, v6
    v_cmp_gt_i32 s[46:47], 1, v6
    v_cmp_gt_i32 s[48:49], 2, v6
    v_cmp_gt_i32 s[50:51], 3, v6
    v_cndmask_b32 v16, v8, v5, s[44:45]
    v_cndmask_b32 v17, v8, v5, s[46:47]
    v_cndmask_b32 v18, v8, v5, s[48:49]
    v_cndmask_b32 v19, v8, v5, s[50:51]
    v_cmp_gt_i32 s[44:45], 16, v6
    v_cmp_gt_i32 s[46:47], 17, v6
    v_cmp_gt_i32 s[48:49], 18, v6
    v_cmp_gt_i32 s[50:51], 19, v6
    v_cndmask_b32 v32, v8, v5, s[44:45]
    v_cndmask_b32 v33, v8, v5, s[46:47]
    v_cndmask_b32 v34, v8, v5, s[48:49]
    v_cndmask_b32 v35, v8, v5, s[50:51]
    s_nop 1
    s_branch k2_prepret_71
k2_prep_78:
    s_sub_u32 s40, s36, s38
    v_subrev_u32 v6, s40, v4
    v_cmp_gt_i32 s[44:45], 0, v6
    v_cmp_gt_i32 s[46:47], 1, v6
    v_cmp_gt_i32 s[48:49], 2, v6
    v_cmp_gt_i32 s[50:51], 3, v6
    v_cndmask_b32 v16, v8, v5, s[44:45]
    v_cndmask_b32 v17, v8, v5, s[46:47]
    v_cndmask_b32 v18, v8, v5, s[48:49]
    v_cndmask_b32 v19, v8, v5, s[50:51]
    v_cmp_gt_i32 s[44:45], 16, v6
    v_cmp_gt_i32 s[46:47], 17, v6
    v_cmp_gt_i32 s[48:49], 18, v6
    v_cmp_gt_i32 s[50:51], 19, v6
    v_cndmask_b32 v32, v8, v5, s[44:45]
    v_cndmask_b32 v33, v8, v5, s[46:47]
    v_cndmask_b32 v34, v8, v5, s[48:49]
    v_cndmask_b32 v35, v8, v5, s[50:51]
    s_nop 1
    s_branch k2_prepret_79
k2_prep_96:
    s_sub_u32 s40, s36, s39
    v_subrev_u32 v6, s40, v4
    v_cmp_gt_i32 s[44:45], 0, v6
    v_cmp_gt_i32 s[46:47], 1, v6
    v_cmp_gt_i32 s[48:49], 2, v6
    v_cmp_gt_i32 s[50:51], 3, v6
    v_cndmask_b32 v16, v10, v5, s[44:45]
    v_cndmask_b32 v17, v10, v5, s[46:47]
    v_cndmask_b32 v18, v10, v5, s[48:49]
    v_cndmask_b32 v19, v10, v5, s[50:51]
    v_cmp_gt_i32 s[44:45], 16, v6
    v_cmp_gt_i32 s[46:47], 17, v6
    v_cmp_gt_i32 s[48:49], 18, v6
    v_cmp_gt_i32 s[50:51], 19, v6
    v_cndmask_b32 v32, v10, v5, s[44:45]
    v_cndmask_b32 v33, v10, v5, s[46:47]
    v_cndmask_b32 v34, v10, v5, s[48:49]
    v_cndmask_b32 v35, v10, v5, s[50:51]
    v_cmp_gt_i32 s[44:45], 32, v6
    v_cmp_gt_i32 s[46:47], 33, v6
    v_cmp_gt_i32 s[48:49], 34, v6
    v_cmp_gt_i32 s[50:51], 35, v6
    v_cndmask_b32 v24, v10, v5, s[44:45]
    v_cndmask_b32 v25, v10, v5, s[46:47]
    v_cndmask_b32 v26, v10, v5, s[48:49]
    v_cndmask_b32 v27, v10, v5, s[50:51]
    v_cmp_gt_i32 s[44:45], 48, v6
    v_cmp_gt_i32 s[46:47], 49, v6
    v_cmp_gt_i32 s[48:49], 50, v6
    v_cmp_gt_i32 s[50:51], 51, v6
    v_cndmask_b32 v40, v10, v5, s[44:45]
    v_cndmask_b32 v41, v10, v5, s[46:47]
    v_cndmask_b32 v42, v10, v5, s[48:49]
    v_cndmask_b32 v43, v10, v5, s[50:51]
    s_nop 1
    s_branch k2_prepret_97
k2_prep_100:
    s_sub_u32 s40, s36, s39
    s_sub_u32 s40, s40, 64
    v_subrev_u32 v6, s40, v4
    v_cmp_gt_i32 s[44:45], 0, v6
    v_cmp_gt_i32 s[46:47], 1, v6
    v_cmp_gt_i32 s[48:49], 2, v6
    v_cmp_gt_i32 s[50:51], 3, v6
    v_cndmask_b32 v20, v11, v5, s[44:45]
    v_cndmask_b32 v21, v11, v5, s[46:47]
    v_cndmask_b32 v22, v11, v5, s[48:49]
    v_cndmask_b32 v23, v11, v5, s[50:51]
    v_cmp_gt_i32 s[44:45], 16, v6
    v_cmp_gt_i32 s[46:47], 17, v6
    v_cmp_gt_i32 s[48:49], 18, v6
    v_cmp_gt_i32 s[50:51], 19, v6
    v_cndmask_b32 v36, v11, v5, s[44:45]
    v_cndmask_b32 v37, v11, v5, s[46:47]
    v_cndmask_b32 v38, v11, v5, s[48:49]
    v_cndmask_b32 v39, v11, v5, s[50:51]
    v_cmp_gt_i32 s[44:45], 32, v6
    v_cmp_gt_i32 s[46:47], 33, v6
    v_cmp_gt_i32 s[48:49], 34, v6
    v_cmp_gt_i32 s[50:51], 35, v6
    v_cndmask_b32 v28, v11, v5, s[44:45]
    v_cndmask_b32 v29, v11, v5, s[46:47]
    v_cndmask_b32 v30, v11, v5, s[48:49]
    v_cndmask_b32 v31, v11, v5, s[50:51]
    v_cmp_gt_i32 s[44:45], 48, v6
    v_cmp_gt_i32 s[46:47], 49, v6
    v_cmp_gt_i32 s[48:49], 50, v6
    v_cmp_gt_i32 s[50:51], 51, v6
    v_cndmask_b32 v44, v11, v5, s[44:45]
    v_cndmask_b32 v45, v11, v5, s[46:47]
    v_cndmask_b32 v46, v11, v5, s[48:49]
    v_cndmask_b32 v47, v11, v5, s[50:51]
    s_nop 1
    s_branch k2_prepret_101
k12_ool_10:
    buffer_load_dword v52, v8, s[24:27], 0 offen sc1
    s_branch k12_oolret_11
k12_ool_12:
    s_mov_b64 exec, 1
    buffer_atomic_add v9, v8, s[24:27], 0 offen sc1
    s_mov_b64 exec, -1
    s_branch k12_oolret_13
k12_ool_14:
    buffer_load_dword v51, v50, s[12:15], s56 offen
    s_branch k12_oolret_15
k12_ool_18:
    v_readfirstlane_b32 s31, v52
    s_cmp_ge_u32 s31, 256
    s_cbranch_scc1 spin_ok_16
    s_mov_b32 s40, 1048576
spin_17:
    s_sleep 8
    buffer_load_dword v52, v8, s[24:27], 0 offen sc1
    s_waitcnt vmcnt(0)
    v_readfirstlane_b32 s31, v52
    s_sub_u32 s40, s40, 1
    s_cselect_b32 s31, -1, s31
    s_cmp_lt_u32 s31, 256
    s_cbranch_scc1 spin_17
spin_ok_16:
    s_branch k12_oolret_19
k12_ool_20:
    s_mov_b64 exec, 1
    buffer_atomic_add v9, v8, s[24:27], 0 offen sc1
    s_mov_b64 exec, -1
    s_branch k12_oolret_21
k12_ool_22:
    global_load_dword v51, v[2:3], off
    s_branch k12_oolret_23
k12_ool_26:
    buffer_load_dword v52, v8, s[24:27], 0 offen sc1
    s_branch k12_oolret_27
k12_ool_28:
    s_mov_b64 exec, 1
    buffer_atomic_add v9, v8, s[24:27], 0 offen sc1
    s_mov_b64 exec, -1
    s_branch k12_oolret_29
k12_ool_30:
    buffer_load_dword v51, v50, s[12:15], s56 offen
    s_branch k12_oolret_31
k12_ool_34:
    v_readfirstlane_b32 s31, v52
    s_cmp_ge_u32 s31, 256
    s_cbranch_scc1 spin_ok_32
    s_mov_b32 s40, 1048576
spin_33:
    s_sleep 8
    buffer_load_dword v52, v8, s[24:27], 0 offen sc1
    s_waitcnt vmcnt(0)
    v_readfirstlane_b32 s31, v52
    s_sub_u32 s40, s40, 1
    s_cselect_b32 s31, -1, s31
    s_cmp_lt_u32 s31, 256
    s_cbranch_scc1 spin_33
spin_ok_32:
    s_branch k12_oolret_35
k12_ool_36:
    s_mov_b64 exec, 1
    buffer_atomic_add v9, v8, s[24:27], 0 offen sc1
    s_mov_b64 exec, -1
    s_branch k12_oolret_37
k12_ool_38:
    global_load_dword v51, v[2:3], off
    s_branch k12_oolret_39
k12_ool_40:
    s_add_u32 s52, s47, 528384
    buffer_store_dwordx4 v[156:159], v1, s[48:51], s52 offen offset:3072 sc1
    s_branch k12_oolret_41
k12_ool_42:
    s_add_u32 s52, s47, 532480
    buffer_store_dwordx4 v[160:163], v1, s[48:51], s52 offen offset:0 sc1
    s_branch k12_oolret_43
k12_ool_44:
    s_add_u32 s52, s47, 532480
    buffer_store_dwordx4 v[164:167], v1, s[48:51], s52 offen offset:1024 sc1
    s_branch k12_oolret_45
k12_ool_46:
    s_add_u32 s52, s47, 532480
    buffer_store_dwordx4 v[168:171], v1, s[48:51], s52 offen offset:2048 sc1
    s_branch k12_oolret_47
k12_ool_48:
    s_add_u32 s52, s47, 532480
    buffer_store_dwordx4 v[172:175], v1, s[48:51], s52 offen offset:3072 sc1
    s_branch k12_oolret_49
k12_ool_50:
    s_add_u32 s52, s47, 536576
    buffer_store_dwordx4 v[176:179], v1, s[48:51], s52 offen offset:0 sc1
    s_branch k12_oolret_51
k12_ool_52:
    s_add_u32 s52, s47, 536576
    buffer_store_dwordx4 v[180:183], v1, s[48:51], s52 offen offset:1024 sc1
    s_branch k12_oolret_53
k12_ool_54:
    s_add_u32 s52, s47, 536576
    buffer_store_dwordx4 v[184:187], v1, s[48:51], s52 offen offset:2048 sc1
    s_branch k12_oolret_55
k12_ool_56:
    s_add_u32 s52, s47, 536576
    buffer_store_dwordx4 v[188:191], v1, s[48:51], s52 offen offset:3072 sc1
    s_branch k12_oolret_57
k12_ool_58:
    s_mov_b32 s50, 0
    s_branch k12_oolret_59
k12_ool_60:
    s_mov_b64 exec, 1
    buffer_atomic_add v9, v8, s[24:27], s54 offen sc1
    s_mov_b64 exec, -1
    s_branch k12_oolret_61
k12_ool_62:
    buffer_load_dword v52, v8, s[24:27], s55 offen sc1
    s_branch k12_oolret_63
k12_ool_66:
    s_waitcnt vmcnt(14)
    v_readfirstlane_b32 s31, v52
    s_cmp_ge_u32 s31, 2
    s_cbranch_scc1 spin_ok_64
    s_mov_b32 s40, 1048576
spin_65:
    s_sleep 8
    buffer_load_dword v52, v8, s[24:27], s55 offen sc1
    s_waitcnt vmcnt(0)
    v_readfirstlane_b32 s31, v52
    s_sub_u32 s40, s40, 1
    s_cselect_b32 s31, -1, s31
    s_cmp_lt_u32 s31, 2
    s_cbranch_scc1 spin_65
spin_ok_64:
    s_branch k12_oolret_67
k12_ool_68:
    s_mov_b64 exec, 1
    buffer_atomic_add v9, v8, s[24:27], s3 offen sc1
    s_mov_b64 exec, -1
    s_branch k12_oolret_69
k12_ool_72:
    buffer_load_dword v58, v59, s[24:27], s5 offen sc1
    s_branch k12_oolret_73
k12_ool_76:
    s_waitcnt vmcnt(0)
    v_readfirstlane_b32 s31, v58
    s_cmp_ge_u32 s31, 14
    s_cbranch_scc1 spin_ok_74
    s_mov_b32 s40, 1048576
spin_75:
    s_sleep 8
    buffer_load_dword v58, v59, s[24:27], s5 offen sc1
    s_waitcnt vmcnt(0)
    v_readfirstlane_b32 s31, v58
    s_sub_u32 s40, s40, 1
    s_cselect_b32 s31, -1, s31
    s_cmp_lt_u32 s31, 14
    s_cbranch_scc1 spin_75
spin_ok_74:
    s_branch k12_oolret_77
k12_ool_116:
    s_mov_b64 exec, 1
    buffer_atomic_add v76, v75, s[16:19], s57 offen sc1
    s_mov_b64 exec, -1
    s_branch k12_oolret_117
k12_ool_121:
    s_mov_b64 exec, 1
    buffer_atomic_add v76, v75, s[16:19], s58 offen sc1
    s_mov_b64 exec, -1
    s_branch k12_oolret_122
k12_ool_125:
    s_mov_b32 s34, 1048576
op_spin_123:
    buffer_load_dword v74, v73, s[16:19], s59 offen sc1
    s_waitcnt vmcnt(0)
    v_cmp_le_u32 vcc, 4, v74
    s_sub_u32 s34, s34, 1
    s_cbranch_scc1 op_ok_124
    s_mov_b32 s33, vcc_lo
    s_bitcmp1_b32 s33, 0
    s_cbranch_scc1 op_ok_124
    s_sleep 4
    s_branch op_spin_123
op_ok_124:
    buffer_load_dwordx4 a[128:131], v88, s[8:11], s62 offen offset:0 sc1
    buffer_load_dwordx4 a[132:135], v88, s[8:11], s62 offen offset:1024 sc1
    buffer_load_dwordx4 a[136:139], v89, s[8:11], s62 offen offset:0 sc1
    buffer_load_dwordx4 a[140:143], v89, s[8:11], s62 offen offset:1024 sc1
    s_add_u32 s62, s62, 0x40000
    s_and_b32 s62, s62, 0x7fffff
    buffer_load_dwordx4 a[144:147], v88, s[8:11], s62 offen offset:0 sc1
    buffer_load_dwordx4 a[148:151], v88, s[8:11], s62 offen offset:1024 sc1
    buffer_load_dwordx4 a[152:155], v89, s[8:11], s62 offen offset:0 sc1
    buffer_load_dwordx4 a[156:159], v89, s[8:11], s62 offen offset:1024 sc1
    s_add_u32 s62, s62, 0x40000
    s_and_b32 s62, s62, 0x7fffff
    buffer_load_dwordx4 a[160:163], v88, s[8:11], s62 offen offset:0 sc1
    buffer_load_dwordx4 a[164:167], v88, s[8:11], s62 offen offset:1024 sc1
    buffer_load_dwordx4 a[168:171], v89, s[8:11], s62 offen offset:0 sc1
    buffer_load_dwordx4 a[172:175], v89, s[8:11], s62 offen offset:1024 sc1
    s_add_u32 s62, s62, 0x40000
    s_and_b32 s62, s62, 0x7fffff
    s_branch k12_oolret_126
k12_ool_129:
    buffer_load_dwordx2 v[192:193], v78, s[20:23], 0 offen offset:0
    buffer_load_dwordx2 v[194:195], v78, s[20:23], 0 offen offset:32
    buffer_load_dwordx2 v[196:197], v78, s[20:23], 0 offen offset:64
    buffer_load_dwordx2 v[198:199], v78, s[20:23], 0 offen offset:96
    buffer_load_dwordx2 v[200:201], v79, s[20:23], 0 offen offset:0
    buffer_load_dwordx2 v[202:203], v79, s[20:23], 0 offen offset:32
    buffer_load_dwordx2 v[204:205], v79, s[20:23], 0 offen offset:64
    buffer_load_dwordx2 v[206:207], v79, s[20:23], 0 offen offset:96
    buffer_load_dwordx2 v[208:209], v80, s[44:47], 0 offen offset:0
    buffer_load_dwordx2 v[210:211], v80, s[44:47], 0 offen offset:32
    buffer_load_dwordx2 v[212:213], v80, s[44:47], 0 offen offset:64
    buffer_load_dwordx2 v[214:215], v80, s[44:47], 0 offen offset:96
    global_load_dword v84, v[82:83], off
    s_mov_b32 s10, 0
    s_mov_b32 s14, 0
    s_branch k12_oolret_130
k12_ool_133:
    s_mov_b32 s34, 1048576
op_spin_131:
    buffer_load_dword v74, v73, s[16:19], s59 offen sc1
    s_waitcnt vmcnt(0)
    v_cmp_le_u32 vcc, 4, v74
    s_sub_u32 s34, s34, 1
    s_cbranch_scc1 op_ok_132
    s_mov_b32 s33, vcc_lo
    s_bitcmp1_b32 s33, s32
    s_cbranch_scc1 op_ok_132
    s_sleep 4
    s_branch op_spin_131
op_ok_132:
    s_branch k12_oolret_134
k2_tramp_80:
    s_call_b64 s[40:41], k2_rare_138
    s_branch k2_ret_81
k2_tramp_84:
    s_call_b64 s[40:41], k2_rare_139
    s_branch k2_ret_85
k2_tramp_86:
    s_call_b64 s[40:41], k2_rare_138
    s_branch k2_ret_87
k2_tramp_88:
    s_call_b64 s[40:41], k2_rare_139
    s_branch k2_ret_89
k2_tramp_90:
    s_call_b64 s[40:41], k2_rare_138
    s_branch k2_ret_91
k2_tramp_92:
    s_call_b64 s[40:41], k2_rare_139
    s_branch k2_ret_93
k2_tramp_94:
    s_call_b64 s[40:41], k2_rare_144
    s_branch k2_ret_95
k2_tramp_98:
    s_call_b64 s[40:41], k2_rare_145
    s_branch k2_ret_99
k2_tramp_102:
    s_call_b64 s[40:41], k2_rare_146
    s_branch k2_ret_103
k2_tramp_106:
    s_call_b64 s[40:41], k2_rare_147
    s_branch k2_ret_107
k2_tramp_108:
    s_call_b64 s[40:41], k2_rare_146
    s_branch k2_ret_109
k2_tramp_110:
    s_call_b64 s[40:41], k2_rare_147
    s_branch k2_ret_111
k2_tramp_112:
    s_call_b64 s[40:41], k2_rare_146
    s_branch k2_ret_113
k2_tramp_114:
    s_call_b64 s[40:41], k2_rare_151
    s_branch k2_ret_115
k2_rare_138:
    s_nop 7
    v_max_f32 v52, v128, v129
    v_max3_f32 v52, v52, v130, v131
    v_max3_f32 v52, v52, v144, v145
    v_max3_f32 v52, v52, v146, v147
    v_max_f32 v53, v132, v133
    v_max3_f32 v53, v53, v134, v135
    v_max3_f32 v53, v53, v148, v149
    v_max3_f32 v53, v53, v150, v151
    v_max_f32 v54, v136, v137
    v_max3_f32 v54, v54, v138, v139
    v_max3_f32 v54, v54, v152, v153
    v_max3_f32 v54, v54, v154, v155
    v_max_f32 v55, v140, v141
    v_max3_f32 v55, v55, v142, v143
    v_max3_f32 v55, v55, v156, v157
    v_max3_f32 v55, v55, v158, v159
    v_mov_b32 v224, v52
    v_mov_b32 v225, v53
    v_mov_b32 v226, v54
    v_mov_b32 v227, v55
    s_nop 1
    v_permlane16_swap_b32 v52, v224
    v_permlane16_swap_b32 v53, v225
    v_permlane16_swap_b32 v54, v226
    v_permlane16_swap_b32 v55, v227
    s_nop 1
    v_max_f32 v52, v52, v224
    v_max_f32 v53, v53, v225
    v_max_f32 v54, v54, v226
    v_max_f32 v55, v55, v227
    v_mov_b32 v224, v52
    v_mov_b32 v225, v53
    v_mov_b32 v226, v54
    v_mov_b32 v227, v55
    s_nop 1
    v_permlane32_swap_b32 v52, v224
    v_permlane32_swap_b32 v53, v225
    v_permlane32_swap_b32 v54, v226
    v_permlane32_swap_b32 v55, v227
    s_nop 1
    v_max_f32 v52, v52, v224
    v_max_f32 v53, v53, v225
    v_max_f32 v54, v54, v226
    v_max_f32 v55, v55, v227
    v_add_f32 v52, 0x41400000, v52
    v_max_f32 v52, 0, v52
    v_add_f32 v53, 0x41400000, v53
    v_max_f32 v53, 0, v53
    v_add_f32 v54, 0x41400000, v54
    v_max_f32 v54, 0, v54
    v_add_f32 v55, 0x41400000, v55
    v_max_f32 v55, 0, v55
    v_sub_f32 v128, v128, v52
    v_sub_f32 v129, v129, v52
    v_sub_f32 v130, v130, v52
    v_sub_f32 v131, v131, v52
    v_sub_f32 v132, v132, v53
    v_sub_f32 v133, v133, v53
    v_sub_f32 v134, v134, v53
    v_sub_f32 v135, v135, v53
    v_sub_f32 v136, v136, v54
    v_sub_f32 v137, v137, v54
    v_sub_f32 v138, v138, v54
    v_sub_f32 v139, v139, v54
    v_sub_f32 v140, v140, v55
    v_sub_f32 v141, v141, v55
    v_sub_f32 v142, v142, v55
    v_sub_f32 v143, v143, v55
    v_sub_f32 v144, v144, v52
    v_sub_f32 v145, v145, v52
    v_sub_f32 v146, v146, v52
    v_sub_f32 v147, v147, v52
    v_sub_f32 v148, v148, v53
    v_sub_f32 v149, v149, v53
    v_sub_f32 v150, v150, v53
    v_sub_f32 v151, v151, v53
    v_sub_f32 v152, v152, v54
    v_sub_f32 v153, v153, v54
    v_sub_f32 v154, v154, v54
    v_sub_f32 v155, v155, v54
    v_sub_f32 v156, v156, v55
    v_sub_f32 v157, v157, v55
    v_sub_f32 v158, v158, v55
    v_sub_f32 v159, v159, v55
    v_sub_f32 v160, v160, v52
    v_sub_f32 v16, v16, v52
    v_sub_f32 v161, v161, v52
    v_sub_f32 v17, v17, v52
    v_sub_f32 v162, v162, v52
    v_sub_f32 v18, v18, v52
    v_sub_f32 v163, v163, v52
    v_sub_f32 v19, v19, v52
    v_sub_f32 v164, v164, v53
    v_sub_f32 v20, v20, v53
    v_sub_f32 v165, v165, v53
    v_sub_f32 v21, v21, v53
    v_sub_f32 v166, v166, v53
    v_sub_f32 v22, v22, v53
    v_sub_f32 v167, v167, v53
    v_sub_f32 v23, v23, v53
    v_sub_f32 v168, v168, v54
    v_sub_f32 v24, v24, v54
    v_sub_f32 v169, v169, v54
    v_sub_f32 v25, v25, v54
    v_sub_f32 v170, v170, v54
    v_sub_f32 v26, v26, v54
    v_sub_f32 v171, v171, v54
    v_sub_f32 v27, v27, v54
    v_sub_f32 v172, v172, v55
    v_sub_f32 v28, v28, v55
    v_sub_f32 v173, v173, v55
    v_sub_f32 v29, v29, v55
    v_sub_f32 v174, v174, v55
    v_sub_f32 v30, v30, v55
    v_sub_f32 v175, v175, v55
    v_sub_f32 v31, v31, v55
    v_sub_f32 v176, v176, v52
    v_sub_f32 v32, v32, v52
    v_sub_f32 v177, v177, v52
    v_sub_f32 v33, v33, v52
    v_sub_f32 v178, v178, v52
    v_sub_f32 v34, v34, v52
    v_sub_f32 v179, v179, v52
    v_sub_f32 v35, v35, v52
    v_sub_f32 v180, v180, v53
    v_sub_f32 v36, v36, v53
    v_sub_f32 v181, v181, v53
    v_sub_f32 v37, v37, v53
    v_sub_f32 v182, v182, v53
    v_sub_f32 v38, v38, v53
    v_sub_f32 v183, v183, v53
    v_sub_f32 v39, v39, v53
    v_sub_f32 v184, v184, v54
    v_sub_f32 v40, v40, v54
    v_sub_f32 v185, v185, v54
    v_sub_f32 v41, v41, v54
    v_sub_f32 v186, v186, v54
    v_sub_f32 v42, v42, v54
    v_sub_f32 v187, v187, v54
    v_sub_f32 v43, v43, v54
    v_sub_f32 v188, v188, v55
    v_sub_f32 v44, v44, v55
    v_sub_f32 v189, v189, v55
    v_sub_f32 v45, v45, v55
    v_sub_f32 v190, v190, v55
    v_sub_f32 v46, v46, v55
    v_sub_f32 v191, v191, v55
    v_sub_f32 v47, v47, v55
    v_sub_f32 v8, v8, v52
    v_exp_f32 v52, -v52
    v_sub_f32 v9, v9, v53
    v_exp_f32 v53, -v53
    v_sub_f32 v10, v10, v54
    v_exp_f32 v54, -v54
    v_sub_f32 v11, v11, v55
    v_exp_f32 v55, -v55
    s_nop 0
    v_mul_f32 v12, v12, v52
    v_mul_f32 v48, v48, v53
    v_mul_f32 v248, v248, v54
    v_mul_f32 v252, v252, v55
    v_accvgpr_read_b32 v224, a0
    v_accvgpr_read_b32 v225, a1
    v_accvgpr_read_b32 v226, a2
    v_accvgpr_read_b32 v227, a3
    v_mul_f32 v224, v224, v52
    v_mul_f32 v225, v225, v52
    v_mul_f32 v226, v226, v52
    v_mul_f32 v227, v227, v52
    v_accvgpr_write_b32 a0, v224
    v_accvgpr_write_b32 a1, v225
    v_accvgpr_write_b32 a2, v226
    v_accvgpr_write_b32 a3, v227
    v_accvgpr_read_b32 v224, a4
    v_accvgpr_read_b32 v225, a5
    v_accvgpr_read_b32 v226, a6
    v_accvgpr_read_b32 v227, a7
    v_mul_f32 v224, v224, v53
    v_mul_f32 v225, v225, v53
    v_mul_f32 v226, v226, v53
    v_mul_f32 v227, v227, v53
    v_accvgpr_write_b32 a4, v224
    v_accvgpr_write_b32 a5, v225
    v_accvgpr_write_b32 a6, v226
    v_accvgpr_write_b32 a7, v227
    v_accvgpr_read_b32 v224, a8
    v_accvgpr_read_b32 v225, a9
    v_accvgpr_read_b32 v226, a10
    v_accvgpr_read_b32 v227, a11
    v_mul_f32 v224, v224, v54
    v_mul_f32 v225, v225, v54
    v_mul_f32 v226, v226, v54
    v_mul_f32 v227, v227, v54
    v_accvgpr_write_b32 a8, v224
    v_accvgpr_write_b32 a9, v225
    v_accvgpr_write_b32 a10, v226
    v_accvgpr_write_b32 a11, v227
    v_accvgpr_read_b32 v224, a12
    v_accvgpr_read_b32 v225, a13
    v_accvgpr_read_b32 v226, a14
    v_accvgpr_read_b32 v227, a15
    v_mul_f32 v224, v224, v55
    v_mul_f32 v225, v225, v55
    v_mul_f32 v226, v226, v55
    v_mul_f32 v227, v227, v55
    v_accvgpr_write_b32 a12, v224
    v_accvgpr_write_b32 a13, v225
    v_accvgpr_write_b32 a14, v226
    v_accvgpr_write_b32 a15, v227
    v_accvgpr_read_b32 v224, a16
    v_accvgpr_read_b32 v225, a17
    v_accvgpr_read_b32 v226, a18
    v_accvgpr_read_b32 v227, a19
    v_mul_f32 v224, v224, v52
    v_mul_f32 v225, v225, v52
    v_mul_f32 v226, v226, v52
    v_mul_f32 v227, v227, v52
    v_accvgpr_write_b32 a16, v224
    v_accvgpr_write_b32 a17, v225
    v_accvgpr_write_b32 a18, v226
    v_accvgpr_write_b32 a19, v227
    v_accvgpr_read_b32 v224, a20
    v_accvgpr_read_b32 v225, a21
    v_accvgpr_read_b32 v226, a22
    v_accvgpr_read_b32 v227, a23
    v_mul_f32 v224, v224, v53
    v_mul_f32 v225, v225, v53
    v_mul_f32 v226, v226, v53
    v_mul_f32 v227, v227, v53
    v_accvgpr_write_b32 a20, v224
    v_accvgpr_write_b32 a21, v225
    v_accvgpr_write_b32 a22, v226
    v_accvgpr_write_b32 a23, v227
    v_accvgpr_read_b32 v224, a24
    v_accvgpr_read_b32 v225, a25
    v_accvgpr_read_b32 v226, a26
    v_accvgpr_read_b32 v227, a27
    v_mul_f32 v224, v224, v54
    v_mul_f32 v225, v225, v54
    v_mul_f32 v226, v226, v54
    v_mul_f32 v227, v227, v54
    v_accvgpr_write_b32 a24, v224
    v_accvgpr_write_b32 a25, v225
    v_accvgpr_write_b32 a26, v226
    v_accvgpr_write_b32 a27, v227
    v_accvgpr_read_b32 v224, a28
    v_accvgpr_read_b32 v225, a29
    v_accvgpr_read_b32 v226, a30
    v_accvgpr_read_b32 v227, a31
    v_mul_f32 v224, v224, v55
    v_mul_f32 v225, v225, v55
    v_mul_f32 v226, v226, v55
    v_mul_f32 v227, v227, v55
    v_accvgpr_write_b32 a28, v224
    v_accvgpr_write_b32 a29, v225
    v_accvgpr_write_b32 a30, v226
    v_accvgpr_write_b32 a31, v227
    v_accvgpr_read_b32 v224, a32
    v_accvgpr_read_b32 v225, a33
    v_accvgpr_read_b32 v226, a34
    v_accvgpr_read_b32 v227, a35
    v_mul_f32 v224, v224, v52
    v_mul_f32 v225, v225, v52
    v_mul_f32 v226, v226, v52
    v_mul_f32 v227, v227, v52
    v_accvgpr_write_b32 a32, v224
    v_accvgpr_write_b32 a33, v225
    v_accvgpr_write_b32 a34, v226
    v_accvgpr_write_b32 a35, v227
    v_accvgpr_read_b32 v224, a36
    v_accvgpr_read_b32 v225, a37
    v_accvgpr_read_b32 v226, a38
    v_accvgpr_read_b32 v227, a39
    v_mul_f32 v224, v224, v53
    v_mul_f32 v225, v225, v53
    v_mul_f32 v226, v226, v53
    v_mul_f32 v227, v227, v53
    v_accvgpr_write_b32 a36, v224
    v_accvgpr_write_b32 a37, v225
    v_accvgpr_write_b32 a38, v226
    v_accvgpr_write_b32 a39, v227
    v_accvgpr_read_b32 v224, a40
    v_accvgpr_read_b32 v225, a41
    v_accvgpr_read_b32 v226, a42
    v_accvgpr_read_b32 v227, a43
    v_mul_f32 v224, v224, v54
    v_mul_f32 v225, v225, v54
    v_mul_f32 v226, v226, v54
    v_mul_f32 v227, v227, v54
    v_accvgpr_write_b32 a40, v224
    v_accvgpr_write_b32 a41, v225
    v_accvgpr_write_b32 a42, v226
    v_accvgpr_write_b32 a43, v227
    v_accvgpr_read_b32 v224, a44
    v_accvgpr_read_b32 v225, a45
    v_accvgpr_read_b32 v226, a46
    v_accvgpr_read_b32 v227, a47
    v_mul_f32 v224, v224, v55
    v_mul_f32 v225, v225, v55
    v_mul_f32 v226, v226, v55
    v_mul_f32 v227, v227, v55
    v_accvgpr_write_b32 a44, v224
    v_accvgpr_write_b32 a45, v225
    v_accvgpr_write_b32 a46, v226
    v_accvgpr_write_b32 a47, v227
    v_accvgpr_read_b32 v224, a48
    v_accvgpr_read_b32 v225, a49
    v_accvgpr_read_b32 v226, a50
    v_accvgpr_read_b32 v227, a51
    v_mul_f32 v224, v224, v52
    v_mul_f32 v225, v225, v52
    v_mul_f32 v226, v226, v52
    v_mul_f32 v227, v227, v52
    v_accvgpr_write_b32 a48, v224
    v_accvgpr_write_b32 a49, v225
    v_accvgpr_write_b32 a50, v226
    v_accvgpr_write_b32 a51, v227
    v_accvgpr_read_b32 v224, a52
    v_accvgpr_read_b32 v225, a53
    v_accvgpr_read_b32 v226, a54
    v_accvgpr_read_b32 v227, a55
    v_mul_f32 v224, v224, v53
    v_mul_f32 v225, v225, v53
    v_mul_f32 v226, v226, v53
    v_mul_f32 v227, v227, v53
    v_accvgpr_write_b32 a52, v224
    v_accvgpr_write_b32 a53, v225
    v_accvgpr_write_b32 a54, v226
    v_accvgpr_write_b32 a55, v227
    v_accvgpr_read_b32 v224, a56
    v_accvgpr_read_b32 v225, a57
    v_accvgpr_read_b32 v226, a58
    v_accvgpr_read_b32 v227, a59
    v_mul_f32 v224, v224, v54
    v_mul_f32 v225, v225, v54
    v_mul_f32 v226, v226, v54
    v_mul_f32 v227, v227, v54
    v_accvgpr_write_b32 a56, v224
    v_accvgpr_write_b32 a57, v225
    v_accvgpr_write_b32 a58, v226
    v_accvgpr_write_b32 a59, v227
    v_accvgpr_read_b32 v224, a60
    v_accvgpr_read_b32 v225, a61
    v_accvgpr_read_b32 v226, a62
    v_accvgpr_read_b32 v227, a63
    v_mul_f32 v224, v224, v55
    v_mul_f32 v225, v225, v55
    v_mul_f32 v226, v226, v55
    v_mul_f32 v227, v227, v55
    v_accvgpr_write_b32 a60, v224
    v_accvgpr_write_b32 a61, v225
    v_accvgpr_write_b32 a62, v226
    v_accvgpr_write_b32 a63, v227
    v_accvgpr_read_b32 v224, a64
    v_accvgpr_read_b32 v225, a65
    v_accvgpr_read_b32 v226, a66
    v_accvgpr_read_b32 v227, a67
    v_mul_f32 v224, v224, v52
    v_mul_f32 v225, v225, v52
    v_mul_f32 v226, v226, v52
    v_mul_f32 v227, v227, v52
    v_accvgpr_write_b32 a64, v224
    v_accvgpr_write_b32 a65, v225
    v_accvgpr_write_b32 a66, v226
    v_accvgpr_write_b32 a67, v227
    v_accvgpr_read_b32 v224, a68
    v_accvgpr_read_b32 v225, a69
    v_accvgpr_read_b32 v226, a70
    v_accvgpr_read_b32 v227, a71
    v_mul_f32 v224, v224, v53
    v_mul_f32 v225, v225, v53
    v_mul_f32 v226, v226, v53
    v_mul_f32 v227, v227, v53
    v_accvgpr_write_b32 a68, v224
    v_accvgpr_write_b32 a69, v225
    v_accvgpr_write_b32 a70, v226
    v_accvgpr_write_b32 a71, v227
    v_accvgpr_read_b32 v224, a72
    v_accvgpr_read_b32 v225, a73
    v_accvgpr_read_b32 v226, a74
    v_accvgpr_read_b32 v227, a75
    v_mul_f32 v224, v224, v54
    v_mul_f32 v225, v225, v54
    v_mul_f32 v226, v226, v54
    v_mul_f32 v227, v227, v54
    v_accvgpr_write_b32 a72, v224
    v_accvgpr_write_b32 a73, v225
    v_accvgpr_write_b32 a74, v226
    v_accvgpr_write_b32 a75, v227
    v_accvgpr_read_b32 v224, a76
    v_accvgpr_read_b32 v225, a77
    v_accvgpr_read_b32 v226, a78
    v_accvgpr_read_b32 v227, a79
    v_mul_f32 v224, v224, v55
    v_mul_f32 v225, v225, v55
    v_mul_f32 v226, v226, v55
    v_mul_f32 v227, v227, v55
    v_accvgpr_write_b32 a76, v224
    v_accvgpr_write_b32 a77, v225
    v_accvgpr_write_b32 a78, v226
    v_accvgpr_write_b32 a79, v227
    v_accvgpr_read_b32 v224, a80
    v_accvgpr_read_b32 v225, a81
    v_accvgpr_read_b32 v226, a82
    v_accvgpr_read_b32 v227, a83
    v_mul_f32 v224, v224, v52
    v_mul_f32 v225, v225, v52
    v_mul_f32 v226, v226, v52
    v_mul_f32 v227, v227, v52
    v_accvgpr_write_b32 a80, v224
    v_accvgpr_write_b32 a81, v225
    v_accvgpr_write_b32 a82, v226
    v_accvgpr_write_b32 a83, v227
    v_accvgpr_read_b32 v224, a84
    v_accvgpr_read_b32 v225, a85
    v_accvgpr_read_b32 v226, a86
    v_accvgpr_read_b32 v227, a87
    v_mul_f32 v224, v224, v53
    v_mul_f32 v225, v225, v53
    v_mul_f32 v226, v226, v53
    v_mul_f32 v227, v227, v53
    v_accvgpr_write_b32 a84, v224
    v_accvgpr_write_b32 a85, v225
    v_accvgpr_write_b32 a86, v226
    v_accvgpr_write_b32 a87, v227
    v_accvgpr_read_b32 v224, a88
    v_accvgpr_read_b32 v225, a89
    v_accvgpr_read_b32 v226, a90
    v_accvgpr_read_b32 v227, a91
    v_mul_f32 v224, v224, v54
    v_mul_f32 v225, v225, v54
    v_mul_f32 v226, v226, v54
    v_mul_f32 v227, v227, v54
    v_accvgpr_write_b32 a88, v224
    v_accvgpr_write_b32 a89, v225
    v_accvgpr_write_b32 a90, v226
    v_accvgpr_write_b32 a91, v227
    v_accvgpr_read_b32 v224, a92
    v_accvgpr_read_b32 v225, a93
    v_accvgpr_read_b32 v226, a94
    v_accvgpr_read_b32 v227, a95
    v_mul_f32 v224, v224, v55
    v_mul_f32 v225, v225, v55
    v_mul_f32 v226, v226, v55
    v_mul_f32 v227, v227, v55
    v_accvgpr_write_b32 a92, v224
    v_accvgpr_write_b32 a93, v225
    v_accvgpr_write_b32 a94, v226
    v_accvgpr_write_b32 a95, v227
    v_accvgpr_read_b32 v224, a96
    v_accvgpr_read_b32 v225, a97
    v_accvgpr_read_b32 v226, a98
    v_accvgpr_read_b32 v227, a99
    v_mul_f32 v224, v224, v52
    v_mul_f32 v225, v225, v52
    v_mul_f32 v226, v226, v52
    v_mul_f32 v227, v227, v52
    v_accvgpr_write_b32 a96, v224
    v_accvgpr_write_b32 a97, v225
    v_accvgpr_write_b32 a98, v226
    v_accvgpr_write_b32 a99, v227
    v_accvgpr_read_b32 v224, a100
    v_accvgpr_read_b32 v225, a101
    v_accvgpr_read_b32 v226, a102
    v_accvgpr_read_b32 v227, a103
    v_mul_f32 v224, v224, v53
    v_mul_f32 v225, v225, v53
    v_mul_f32 v226, v226, v53
    v_mul_f32 v227, v227, v53
    v_accvgpr_write_b32 a100, v224
    v_accvgpr_write_b32 a101, v225
    v_accvgpr_write_b32 a102, v226
    v_accvgpr_write_b32 a103, v227
    v_accvgpr_read_b32 v224, a104
    v_accvgpr_read_b32 v225, a105
    v_accvgpr_read_b32 v226, a106
    v_accvgpr_read_b32 v227, a107
    v_mul_f32 v224, v224, v54
    v_mul_f32 v225, v225, v54
    v_mul_f32 v226, v226, v54
    v_mul_f32 v227, v227, v54
    v_accvgpr_write_b32 a104, v224
    v_accvgpr_write_b32 a105, v225
    v_accvgpr_write_b32 a106, v226
    v_accvgpr_write_b32 a107, v227
    v_accvgpr_read_b32 v224, a108
    v_accvgpr_read_b32 v225, a109
    v_accvgpr_read_b32 v226, a110
    v_accvgpr_read_b32 v227, a111
    v_mul_f32 v224, v224, v55
    v_mul_f32 v225, v225, v55
    v_mul_f32 v226, v226, v55
    v_mul_f32 v227, v227, v55
    v_accvgpr_write_b32 a108, v224
    v_accvgpr_write_b32 a109, v225
    v_accvgpr_write_b32 a110, v226
    v_accvgpr_write_b32 a111, v227
    v_accvgpr_read_b32 v224, a112
    v_accvgpr_read_b32 v225, a113
    v_accvgpr_read_b32 v226, a114
    v_accvgpr_read_b32 v227, a115
    v_mul_f32 v224, v224, v52
    v_mul_f32 v225, v225, v52
    v_mul_f32 v226, v226, v52
    v_mul_f32 v227, v227, v52
    v_accvgpr_write_b32 a112, v224
    v_accvgpr_write_b32 a113, v225
    v_accvgpr_write_b32 a114, v226
    v_accvgpr_write_b32 a115, v227
    v_accvgpr_read_b32 v224, a116
    v_accvgpr_read_b32 v225, a117
    v_accvgpr_read_b32 v226, a118
    v_accvgpr_read_b32 v227, a119
    v_mul_f32 v224, v224, v53
    v_mul_f32 v225, v225, v53
    v_mul_f32 v226, v226, v53
    v_mul_f32 v227, v227, v53
    v_accvgpr_write_b32 a116, v224
    v_accvgpr_write_b32 a117, v225
    v_accvgpr_write_b32 a118, v226
    v_accvgpr_write_b32 a119, v227
    v_accvgpr_read_b32 v224, a120
    v_accvgpr_read_b32 v225, a121
    v_accvgpr_read_b32 v226, a122
    v_accvgpr_read_b32 v227, a123
    v_mul_f32 v224, v224, v54
    v_mul_f32 v225, v225, v54
    v_mul_f32 v226, v226, v54
    v_mul_f32 v227, v227, v54
    v_accvgpr_write_b32 a120, v224
    v_accvgpr_write_b32 a121, v225
    v_accvgpr_write_b32 a122, v226
    v_accvgpr_write_b32 a123, v227
    v_accvgpr_read_b32 v224, a124
    v_accvgpr_read_b32 v225, a125
    v_accvgpr_read_b32 v226, a126
    v_accvgpr_read_b32 v227, a127
    v_mul_f32 v224, v224, v55
    v_mul_f32 v225, v225, v55
    v_mul_f32 v226, v226, v55
    v_mul_f32 v227, v227, v55
    v_accvgpr_write_b32 a124, v224
    v_accvgpr_write_b32 a125, v225
    v_accvgpr_write_b32 a126, v226
    v_accvgpr_write_b32 a127, v227
    v_exp_f32 v232, v128
    v_exp_f32 v233, v129
    v_exp_f32 v234, v130
    v_exp_f32 v235, v131
    s_nop 0
    v_cvt_pk_bf16_f32 v192, v232, v233
    v_cvt_pk_bf16_f32 v193, v234, v235
    v_exp_f32 v232, v144
    v_exp_f32 v233, v145
    v_exp_f32 v234, v146
    v_exp_f32 v235, v147
    s_nop 0
    v_cvt_pk_bf16_f32 v194, v232, v233
    v_cvt_pk_bf16_f32 v195, v234, v235
    v_exp_f32 v232, v132
    v_exp_f32 v233, v133
    v_exp_f32 v234, v134
    v_exp_f32 v235, v135
    s_nop 0
    v_cvt_pk_bf16_f32 v196, v232, v233
    v_cvt_pk_bf16_f32 v197, v234, v235
    v_exp_f32 v232, v148
    v_exp_f32 v233, v149
    v_exp_f32 v234, v150
    v_exp_f32 v235, v151
    s_nop 0
    v_cvt_pk_bf16_f32 v198, v232, v233
    v_cvt_pk_bf16_f32 v199, v234, v235
    v_exp_f32 v232, v136
    v_exp_f32 v233, v137
    v_exp_f32 v234, v138
    v_exp_f32 v235, v139
    s_nop 0
    v_cvt_pk_bf16_f32 v200, v232, v233
    v_cvt_pk_bf16_f32 v201, v234, v235
    v_exp_f32 v232, v152
    v_exp_f32 v233, v153
    v_exp_f32 v234, v154
    v_exp_f32 v235, v155
    s_nop 0
    v_cvt_pk_bf16_f32 v202, v232, v233
    v_cvt_pk_bf16_f32 v203, v234, v235
    v_exp_f32 v232, v140
    v_exp_f32 v233, v141
    v_exp_f32 v234, v142
    v_exp_f32 v235, v143
    s_nop 0
    v_cvt_pk_bf16_f32 v204, v232, v233
    v_cvt_pk_bf16_f32 v205, v234, v235
    v_exp_f32 v232, v156
    v_exp_f32 v233, v157
    v_exp_f32 v234, v158
    v_exp_f32 v235, v159
    s_nop 0
    v_cvt_pk_bf16_f32 v206, v232, v233
    v_cvt_pk_bf16_f32 v207, v234, v235
    s_nop 3
    s_setpc_b64 s[40:41]
k2_rare_139:
    s_nop 7
    v_max_f32 v52, v160, v161
    v_max3_f32 v52, v52, v162, v163
    v_max3_f32 v52, v52, v176, v177
    v_max3_f32 v52, v52, v178, v179
    v_max_f32 v53, v164, v165
    v_max3_f32 v53, v53, v166, v167
    v_max3_f32 v53, v53, v180, v181
    v_max3_f32 v53, v53, v182, v183
    v_max_f32 v54, v168, v169
    v_max3_f32 v54, v54, v170, v171
    v_max3_f32 v54, v54, v184, v185
    v_max3_f32 v54, v54, v186, v187
    v_max_f32 v55, v172, v173
    v_max3_f32 v55, v55, v174, v175
    v_max3_f32 v55, v55, v188, v189
    v_max3_f32 v55, v55, v190, v191
    v_mov_b32 v224, v52
    v_mov_b32 v225, v53
    v_mov_b32 v226, v54
    v_mov_b32 v227, v55
    s_nop 1
    v_permlane16_swap_b32 v52, v224
    v_permlane16_swap_b32 v53, v225
    v_permlane16_swap_b32 v54, v226
    v_permlane16_swap_b32 v55, v227
    s_nop 1
    v_max_f32 v52, v52, v224
    v_max_f32 v53, v53, v225
    v_max_f32 v54, v54, v226
    v_max_f32 v55, v55, v227
    v_mov_b32 v224, v52
    v_mov_b32 v225, v53
    v_mov_b32 v226, v54
    v_mov_b32 v227, v55
    s_nop 1
    v_permlane32_swap_b32 v52, v224
    v_permlane32_swap_b32 v53, v225
    v_permlane32_swap_b32 v54, v226
    v_permlane32_swap_b32 v55, v227
    s_nop 1
    v_max_f32 v52, v52, v224
    v_max_f32 v53, v53, v225
    v_max_f32 v54, v54, v226
    v_max_f32 v55, v55, v227
    v_add_f32 v52, 0x41400000, v52
    v_max_f32 v52, 0, v52
    v_add_f32 v53, 0x41400000, v53
    v_max_f32 v53, 0, v53
    v_add_f32 v54, 0x41400000, v54
    v_max_f32 v54, 0, v54
    v_add_f32 v55, 0x41400000, v55
    v_max_f32 v55, 0, v55
    v_sub_f32 v160, v160, v52
    v_sub_f32 v161, v161, v52
    v_sub_f32 v162, v162, v52
    v_sub_f32 v163, v163, v52
    v_sub_f32 v164, v164, v53
    v_sub_f32 v165, v165, v53
    v_sub_f32 v166, v166, v53
    v_sub_f32 v167, v167, v53
    v_sub_f32 v168, v168, v54
    v_sub_f32 v169, v169, v54
    v_sub_f32 v170, v170, v54
    v_sub_f32 v171, v171, v54
    v_sub_f32 v172, v172, v55
    v_sub_f32 v173, v173, v55
    v_sub_f32 v174, v174, v55
    v_sub_f32 v175, v175, v55
    v_sub_f32 v176, v176, v52
    v_sub_f32 v177, v177, v52
    v_sub_f32 v178, v178, v52
    v_sub_f32 v179, v179, v52
    v_sub_f32 v180, v180, v53
    v_sub_f32 v181, v181, v53
    v_sub_f32 v182, v182, v53
    v_sub_f32 v183, v183, v53
    v_sub_f32 v184, v184, v54
    v_sub_f32 v185, v185, v54
    v_sub_f32 v186, v186, v54
    v_sub_f32 v187, v187, v54
    v_sub_f32 v188, v188, v55
    v_sub_f32 v189, v189, v55
    v_sub_f32 v190, v190, v55
    v_sub_f32 v191, v191, v55
    v_sub_f32 v128, v128, v52
    v_sub_f32 v16, v16, v52
    v_sub_f32 v129, v129, v52
    v_sub_f32 v17, v17, v52
    v_sub_f32 v130, v130, v52
    v_sub_f32 v18, v18, v52
    v_sub_f32 v131, v131, v52
    v_sub_f32 v19, v19, v52
    v_sub_f32 v132, v132, v53
    v_sub_f32 v20, v20, v53
    v_sub_f32 v133, v133, v53
    v_sub_f32 v21, v21, v53
    v_sub_f32 v134, v134, v53
    v_sub_f32 v22, v22, v53
    v_sub_f32 v135, v135, v53
    v_sub_f32 v23, v23, v53
    v_sub_f32 v136, v136, v54
    v_sub_f32 v24, v24, v54
    v_sub_f32 v137, v137, v54
    v_sub_f32 v25, v25, v54
    v_sub_f32 v138, v138, v54
    v_sub_f32 v26, v26, v54
    v_sub_f32 v139, v139, v54
    v_sub_f32 v27, v27, v54
    v_sub_f32 v140, v140, v55
    v_sub_f32 v28, v28, v55
    v_sub_f32 v141, v141, v55
    v_sub_f32 v29, v29, v55
    v_sub_f32 v142, v142, v55
    v_sub_f32 v30, v30, v55
    v_sub_f32 v143, v143, v55
    v_sub_f32 v31, v31, v55
    v_sub_f32 v144, v144, v52
    v_sub_f32 v32, v32, v52
    v_sub_f32 v145, v145, v52
    v_sub_f32 v33, v33, v52
    v_sub_f32 v146, v146, v52
    v_sub_f32 v34, v34, v52
    v_sub_f32 v147, v147, v52
    v_sub_f32 v35, v35, v52
    v_sub_f32 v148, v148, v53
    v_sub_f32 v36, v36, v53
    v_sub_f32 v149, v149, v53
    v_sub_f32 v37, v37, v53
    v_sub_f32 v150, v150, v53
    v_sub_f32 v38, v38, v53
    v_sub_f32 v151, v151, v53
    v_sub_f32 v39, v39, v53
    v_sub_f32 v152, v152, v54
    v_sub_f32 v40, v40, v54
    v_sub_f32 v153, v153, v54
    v_sub_f32 v41, v41, v54
    v_sub_f32 v154, v154, v54
    v_sub_f32 v42, v42, v54
    v_sub_f32 v155, v155, v54
    v_sub_f32 v43, v43, v54
    v_sub_f32 v156, v156, v55
    v_sub_f32 v44, v44, v55
    v_sub_f32 v157, v157, v55
    v_sub_f32 v45, v45, v55
    v_sub_f32 v158, v158, v55
    v_sub_f32 v46, v46, v55
    v_sub_f32 v159, v159, v55
    v_sub_f32 v47, v47, v55
    v_sub_f32 v8, v8, v52
    v_exp_f32 v52, -v52
    v_sub_f32 v9, v9, v53
    v_exp_f32 v53, -v53
    v_sub_f32 v10, v10, v54
    v_exp_f32 v54, -v54
    v_sub_f32 v11, v11, v55
    v_exp_f32 v55, -v55
    s_nop 0
    v_mul_f32 v12, v12, v52
    v_mul_f32 v48, v48, v53
    v_mul_f32 v248, v248, v54
    v_mul_f32 v252, v252, v55
    v_accvgpr_read_b32 v224, a0
    v_accvgpr_read_b32 v225, a1
    v_accvgpr_read_b32 v226, a2
    v_accvgpr_read_b32 v227, a3
    v_mul_f32 v224, v224, v52
    v_mul_f32 v225, v225, v52
    v_mul_f32 v226, v226, v52
    v_mul_f32 v227, v227, v52
    v_accvgpr_write_b32 a0, v224
    v_accvgpr_write_b32 a1, v225
    v_accvgpr_write_b32 a2, v226
    v_accvgpr_write_b32 a3, v227
    v_accvgpr_read_b32 v224, a4
    v_accvgpr_read_b32 v225, a5
    v_accvgpr_read_b32 v226, a6
    v_accvgpr_read_b32 v227, a7
    v_mul_f32 v224, v224, v53
    v_mul_f32 v225, v225, v53
    v_mul_f32 v226, v226, v53
    v_mul_f32 v227, v227, v53
    v_accvgpr_write_b32 a4, v224
    v_accvgpr_write_b32 a5, v225
    v_accvgpr_write_b32 a6, v226
    v_accvgpr_write_b32 a7, v227
    v_accvgpr_read_b32 v224, a8
    v_accvgpr_read_b32 v225, a9
    v_accvgpr_read_b32 v226, a10
    v_accvgpr_read_b32 v227, a11
    v_mul_f32 v224, v224, v54
    v_mul_f32 v225, v225, v54
    v_mul_f32 v226, v226, v54
    v_mul_f32 v227, v227, v54
    v_accvgpr_write_b32 a8, v224
    v_accvgpr_write_b32 a9, v225
    v_accvgpr_write_b32 a10, v226
    v_accvgpr_write_b32 a11, v227
    v_accvgpr_read_b32 v224, a12
    v_accvgpr_read_b32 v225, a13
    v_accvgpr_read_b32 v226, a14
    v_accvgpr_read_b32 v227, a15
    v_mul_f32 v224, v224, v55
    v_mul_f32 v225, v225, v55
    v_mul_f32 v226, v226, v55
    v_mul_f32 v227, v227, v55
    v_accvgpr_write_b32 a12, v224
    v_accvgpr_write_b32 a13, v225
    v_accvgpr_write_b32 a14, v226
    v_accvgpr_write_b32 a15, v227
    v_accvgpr_read_b32 v224, a16
    v_accvgpr_read_b32 v225, a17
    v_accvgpr_read_b32 v226, a18
    v_accvgpr_read_b32 v227, a19
    v_mul_f32 v224, v224, v52
    v_mul_f32 v225, v225, v52
    v_mul_f32 v226, v226, v52
    v_mul_f32 v227, v227, v52
    v_accvgpr_write_b32 a16, v224
    v_accvgpr_write_b32 a17, v225
    v_accvgpr_write_b32 a18, v226
    v_accvgpr_write_b32 a19, v227
    v_accvgpr_read_b32 v224, a20
    v_accvgpr_read_b32 v225, a21
    v_accvgpr_read_b32 v226, a22
    v_accvgpr_read_b32 v227, a23
    v_mul_f32 v224, v224, v53
    v_mul_f32 v225, v225, v53
    v_mul_f32 v226, v226, v53
    v_mul_f32 v227, v227, v53
    v_accvgpr_write_b32 a20, v224
    v_accvgpr_write_b32 a21, v225
    v_accvgpr_write_b32 a22, v226
    v_accvgpr_write_b32 a23, v227
    v_accvgpr_read_b32 v224, a24
    v_accvgpr_read_b32 v225, a25
    v_accvgpr_read_b32 v226, a26
    v_accvgpr_read_b32 v227, a27
    v_mul_f32 v224, v224, v54
    v_mul_f32 v225, v225, v54
    v_mul_f32 v226, v226, v54
    v_mul_f32 v227, v227, v54
    v_accvgpr_write_b32 a24, v224
    v_accvgpr_write_b32 a25, v225
    v_accvgpr_write_b32 a26, v226
    v_accvgpr_write_b32 a27, v227
    v_accvgpr_read_b32 v224, a28
    v_accvgpr_read_b32 v225, a29
    v_accvgpr_read_b32 v226, a30
    v_accvgpr_read_b32 v227, a31
    v_mul_f32 v224, v224, v55
    v_mul_f32 v225, v225, v55
    v_mul_f32 v226, v226, v55
    v_mul_f32 v227, v227, v55
    v_accvgpr_write_b32 a28, v224
    v_accvgpr_write_b32 a29, v225
    v_accvgpr_write_b32 a30, v226
    v_accvgpr_write_b32 a31, v227
    v_accvgpr_read_b32 v224, a32
    v_accvgpr_read_b32 v225, a33
    v_accvgpr_read_b32 v226, a34
    v_accvgpr_read_b32 v227, a35
    v_mul_f32 v224, v224, v52
    v_mul_f32 v225, v225, v52
    v_mul_f32 v226, v226, v52
    v_mul_f32 v227, v227, v52
    v_accvgpr_write_b32 a32, v224
    v_accvgpr_write_b32 a33, v225
    v_accvgpr_write_b32 a34, v226
    v_accvgpr_write_b32 a35, v227
    v_accvgpr_read_b32 v224, a36
    v_accvgpr_read_b32 v225, a37
    v_accvgpr_read_b32 v226, a38
    v_accvgpr_read_b32 v227, a39
    v_mul_f32 v224, v224, v53
    v_mul_f32 v225, v225, v53
    v_mul_f32 v226, v226, v53
    v_mul_f32 v227, v227, v53
    v_accvgpr_write_b32 a36, v224
    v_accvgpr_write_b32 a37, v225
    v_accvgpr_write_b32 a38, v226
    v_accvgpr_write_b32 a39, v227
    v_accvgpr_read_b32 v224, a40
    v_accvgpr_read_b32 v225, a41
    v_accvgpr_read_b32 v226, a42
    v_accvgpr_read_b32 v227, a43
    v_mul_f32 v224, v224, v54
    v_mul_f32 v225, v225, v54
    v_mul_f32 v226, v226, v54
    v_mul_f32 v227, v227, v54
    v_accvgpr_write_b32 a40, v224
    v_accvgpr_write_b32 a41, v225
    v_accvgpr_write_b32 a42, v226
    v_accvgpr_write_b32 a43, v227
    v_accvgpr_read_b32 v224, a44
    v_accvgpr_read_b32 v225, a45
    v_accvgpr_read_b32 v226, a46
    v_accvgpr_read_b32 v227, a47
    v_mul_f32 v224, v224, v55
    v_mul_f32 v225, v225, v55
    v_mul_f32 v226, v226, v55
    v_mul_f32 v227, v227, v55
    v_accvgpr_write_b32 a44, v224
    v_accvgpr_write_b32 a45, v225
    v_accvgpr_write_b32 a46, v226
    v_accvgpr_write_b32 a47, v227
    v_accvgpr_read_b32 v224, a48
    v_accvgpr_read_b32 v225, a49
    v_accvgpr_read_b32 v226, a50
    v_accvgpr_read_b32 v227, a51
    v_mul_f32 v224, v224, v52
    v_mul_f32 v225, v225, v52
    v_mul_f32 v226, v226, v52
    v_mul_f32 v227, v227, v52
    v_accvgpr_write_b32 a48, v224
    v_accvgpr_write_b32 a49, v225
    v_accvgpr_write_b32 a50, v226
    v_accvgpr_write_b32 a51, v227
    v_accvgpr_read_b32 v224, a52
    v_accvgpr_read_b32 v225, a53
    v_accvgpr_read_b32 v226, a54
    v_accvgpr_read_b32 v227, a55
    v_mul_f32 v224, v224, v53
    v_mul_f32 v225, v225, v53
    v_mul_f32 v226, v226, v53
    v_mul_f32 v227, v227, v53
    v_accvgpr_write_b32 a52, v224
    v_accvgpr_write_b32 a53, v225
    v_accvgpr_write_b32 a54, v226
    v_accvgpr_write_b32 a55, v227
    v_accvgpr_read_b32 v224, a56
    v_accvgpr_read_b32 v225, a57
    v_accvgpr_read_b32 v226, a58
    v_accvgpr_read_b32 v227, a59
    v_mul_f32 v224, v224, v54
    v_mul_f32 v225, v225, v54
    v_mul_f32 v226, v226, v54
    v_mul_f32 v227, v227, v54
    v_accvgpr_write_b32 a56, v224
    v_accvgpr_write_b32 a57, v225
    v_accvgpr_write_b32 a58, v226
    v_accvgpr_write_b32 a59, v227
    v_accvgpr_read_b32 v224, a60
    v_accvgpr_read_b32 v225, a61
    v_accvgpr_read_b32 v226, a62
    v_accvgpr_read_b32 v227, a63
    v_mul_f32 v224, v224, v55
    v_mul_f32 v225, v225, v55
    v_mul_f32 v226, v226, v55
    v_mul_f32 v227, v227, v55
    v_accvgpr_write_b32 a60, v224
    v_accvgpr_write_b32 a61, v225
    v_accvgpr_write_b32 a62, v226
    v_accvgpr_write_b32 a63, v227
    v_accvgpr_read_b32 v224, a64
    v_accvgpr_read_b32 v225, a65
    v_accvgpr_read_b32 v226, a66
    v_accvgpr_read_b32 v227, a67
    v_mul_f32 v224, v224, v52
    v_mul_f32 v225, v225, v52
    v_mul_f32 v226, v226, v52
    v_mul_f32 v227, v227, v52
    v_accvgpr_write_b32 a64, v224
    v_accvgpr_write_b32 a65, v225
    v_accvgpr_write_b32 a66, v226
    v_accvgpr_write_b32 a67, v227
    v_accvgpr_read_b32 v224, a68
    v_accvgpr_read_b32 v225, a69
    v_accvgpr_read_b32 v226, a70
    v_accvgpr_read_b32 v227, a71
    v_mul_f32 v224, v224, v53
    v_mul_f32 v225, v225, v53
    v_mul_f32 v226, v226, v53
    v_mul_f32 v227, v227, v53
    v_accvgpr_write_b32 a68, v224
    v_accvgpr_write_b32 a69, v225
    v_accvgpr_write_b32 a70, v226
    v_accvgpr_write_b32 a71, v227
    v_accvgpr_read_b32 v224, a72
    v_accvgpr_read_b32 v225, a73
    v_accvgpr_read_b32 v226, a74
    v_accvgpr_read_b32 v227, a75
    v_mul_f32 v224, v224, v54
    v_mul_f32 v225, v225, v54
    v_mul_f32 v226, v226, v54
    v_mul_f32 v227, v227, v54
    v_accvgpr_write_b32 a72, v224
    v_accvgpr_write_b32 a73, v225
    v_accvgpr_write_b32 a74, v226
    v_accvgpr_write_b32 a75, v227
    v_accvgpr_read_b32 v224, a76
    v_accvgpr_read_b32 v225, a77
    v_accvgpr_read_b32 v226, a78
    v_accvgpr_read_b32 v227, a79
    v_mul_f32 v224, v224, v55
    v_mul_f32 v225, v225, v55
    v_mul_f32 v226, v226, v55
    v_mul_f32 v227, v227, v55
    v_accvgpr_write_b32 a76, v224
    v_accvgpr_write_b32 a77, v225
    v_accvgpr_write_b32 a78, v226
    v_accvgpr_write_b32 a79, v227
    v_accvgpr_read_b32 v224, a80
    v_accvgpr_read_b32 v225, a81
    v_accvgpr_read_b32 v226, a82
    v_accvgpr_read_b32 v227, a83
    v_mul_f32 v224, v224, v52
    v_mul_f32 v225, v225, v52
    v_mul_f32 v226, v226, v52
    v_mul_f32 v227, v227, v52
    v_accvgpr_write_b32 a80, v224
    v_accvgpr_write_b32 a81, v225
    v_accvgpr_write_b32 a82, v226
    v_accvgpr_write_b32 a83, v227
    v_accvgpr_read_b32 v224, a84
    v_accvgpr_read_b32 v225, a85
    v_accvgpr_read_b32 v226, a86
    v_accvgpr_read_b32 v227, a87
    v_mul_f32 v224, v224, v53
    v_mul_f32 v225, v225, v53
    v_mul_f32 v226, v226, v53
    v_mul_f32 v227, v227, v53
    v_accvgpr_write_b32 a84, v224
    v_accvgpr_write_b32 a85, v225
    v_accvgpr_write_b32 a86, v226
    v_accvgpr_write_b32 a87, v227
    v_accvgpr_read_b32 v224, a88
    v_accvgpr_read_b32 v225, a89
    v_accvgpr_read_b32 v226, a90
    v_accvgpr_read_b32 v227, a91
    v_mul_f32 v224, v224, v54
    v_mul_f32 v225, v225, v54
    v_mul_f32 v226, v226, v54
    v_mul_f32 v227, v227, v54
    v_accvgpr_write_b32 a88, v224
    v_accvgpr_write_b32 a89, v225
    v_accvgpr_write_b32 a90, v226
    v_accvgpr_write_b32 a91, v227
    v_accvgpr_read_b32 v224, a92
    v_accvgpr_read_b32 v225, a93
    v_accvgpr_read_b32 v226, a94
    v_accvgpr_read_b32 v227, a95
    v_mul_f32 v224, v224, v55
    v_mul_f32 v225, v225, v55
    v_mul_f32 v226, v226, v55
    v_mul_f32 v227, v227, v55
    v_accvgpr_write_b32 a92, v224
    v_accvgpr_write_b32 a93, v225
    v_accvgpr_write_b32 a94, v226
    v_accvgpr_write_b32 a95, v227
    v_accvgpr_read_b32 v224, a96
    v_accvgpr_read_b32 v225, a97
    v_accvgpr_read_b32 v226, a98
    v_accvgpr_read_b32 v227, a99
    v_mul_f32 v224, v224, v52
    v_mul_f32 v225, v225, v52
    v_mul_f32 v226, v226, v52
    v_mul_f32 v227, v227, v52
    v_accvgpr_write_b32 a96, v224
    v_accvgpr_write_b32 a97, v225
    v_accvgpr_write_b32 a98, v226
    v_accvgpr_write_b32 a99, v227
    v_accvgpr_read_b32 v224, a100
    v_accvgpr_read_b32 v225, a101
    v_accvgpr_read_b32 v226, a102
    v_accvgpr_read_b32 v227, a103
    v_mul_f32 v224, v224, v53
    v_mul_f32 v225, v225, v53
    v_mul_f32 v226, v226, v53
    v_mul_f32 v227, v227, v53
    v_accvgpr_write_b32 a100, v224
    v_accvgpr_write_b32 a101, v225
    v_accvgpr_write_b32 a102, v226
    v_accvgpr_write_b32 a103, v227
    v_accvgpr_read_b32 v224, a104
    v_accvgpr_read_b32 v225, a105
    v_accvgpr_read_b32 v226, a106
    v_accvgpr_read_b32 v227, a107
    v_mul_f32 v224, v224, v54
    v_mul_f32 v225, v225, v54
    v_mul_f32 v226, v226, v54
    v_mul_f32 v227, v227, v54
    v_accvgpr_write_b32 a104, v224
    v_accvgpr_write_b32 a105, v225
    v_accvgpr_write_b32 a106, v226
    v_accvgpr_write_b32 a107, v227
    v_accvgpr_read_b32 v224, a108
    v_accvgpr_read_b32 v225, a109
    v_accvgpr_read_b32 v226, a110
    v_accvgpr_read_b32 v227, a111
    v_mul_f32 v224, v224, v55
    v_mul_f32 v225, v225, v55
    v_mul_f32 v226, v226, v55
    v_mul_f32 v227, v227, v55
    v_accvgpr_write_b32 a108, v224
    v_accvgpr_write_b32 a109, v225
    v_accvgpr_write_b32 a110, v226
    v_accvgpr_write_b32 a111, v227
    v_accvgpr_read_b32 v224, a112
    v_accvgpr_read_b32 v225, a113
    v_accvgpr_read_b32 v226, a114
    v_accvgpr_read_b32 v227, a115
    v_mul_f32 v224, v224, v52
    v_mul_f32 v225, v225, v52
    v_mul_f32 v226, v226, v52
    v_mul_f32 v227, v227, v52
    v_accvgpr_write_b32 a112, v224
    v_accvgpr_write_b32 a113, v225
    v_accvgpr_write_b32 a114, v226
    v_accvgpr_write_b32 a115, v227
    v_accvgpr_read_b32 v224, a116
    v_accvgpr_read_b32 v225, a117
    v_accvgpr_read_b32 v226, a118
    v_accvgpr_read_b32 v227, a119
    v_mul_f32 v224, v224, v53
    v_mul_f32 v225, v225, v53
    v_mul_f32 v226, v226, v53
    v_mul_f32 v227, v227, v53
    v_accvgpr_write_b32 a116, v224
    v_accvgpr_write_b32 a117, v225
    v_accvgpr_write_b32 a118, v226
    v_accvgpr_write_b32 a119, v227
    v_accvgpr_read_b32 v224, a120
    v_accvgpr_read_b32 v225, a121
    v_accvgpr_read_b32 v226, a122
    v_accvgpr_read_b32 v227, a123
    v_mul_f32 v224, v224, v54
    v_mul_f32 v225, v225, v54
    v_mul_f32 v226, v226, v54
    v_mul_f32 v227, v227, v54
    v_accvgpr_write_b32 a120, v224
    v_accvgpr_write_b32 a121, v225
    v_accvgpr_write_b32 a122, v226
    v_accvgpr_write_b32 a123, v227
    v_accvgpr_read_b32 v224, a124
    v_accvgpr_read_b32 v225, a125
    v_accvgpr_read_b32 v226, a126
    v_accvgpr_read_b32 v227, a127
    v_mul_f32 v224, v224, v55
    v_mul_f32 v225, v225, v55
    v_mul_f32 v226, v226, v55
    v_mul_f32 v227, v227, v55
    v_accvgpr_write_b32 a124, v224
    v_accvgpr_write_b32 a125, v225
    v_accvgpr_write_b32 a126, v226
    v_accvgpr_write_b32 a127, v227
    v_exp_f32 v232, v160
    v_exp_f32 v233, v161
    v_exp_f32 v234, v162
    v_exp_f32 v235, v163
    s_nop 0
    v_cvt_pk_bf16_f32 v208, v232, v233
    v_cvt_pk_bf16_f32 v209, v234, v235
    v_exp_f32 v232, v176
    v_exp_f32 v233, v177
    v_exp_f32 v234, v178
    v_exp_f32 v235, v179
    s_nop 0
    v_cvt_pk_bf16_f32 v210, v232, v233
    v_cvt_pk_bf16_f32 v211, v234, v235
    v_exp_f32 v232, v164
    v_exp_f32 v233, v165
    v_exp_f32 v234, v166
    v_exp_f32 v235, v167
    s_nop 0
    v_cvt_pk_bf16_f32 v212, v232, v233
    v_cvt_pk_bf16_f32 v213, v234, v235
    v_exp_f32 v232, v180
    v_exp_f32 v233, v181
    v_exp_f32 v234, v182
    v_exp_f32 v235, v183
    s_nop 0
    v_cvt_pk_bf16_f32 v214, v232, v233
    v_cvt_pk_bf16_f32 v215, v234, v235
    v_exp_f32 v232, v168
    v_exp_f32 v233, v169
    v_exp_f32 v234, v170
    v_exp_f32 v235, v171
    s_nop 0
    v_cvt_pk_bf16_f32 v216, v232, v233
    v_cvt_pk_bf16_f32 v217, v234, v235
    v_exp_f32 v232, v184
    v_exp_f32 v233, v185
    v_exp_f32 v234, v186
    v_exp_f32 v235, v187
    s_nop 0
    v_cvt_pk_bf16_f32 v218, v232, v233
    v_cvt_pk_bf16_f32 v219, v234, v235
    v_exp_f32 v232, v172
    v_exp_f32 v233, v173
    v_exp_f32 v234, v174
    v_exp_f32 v235, v175
    s_nop 0
    v_cvt_pk_bf16_f32 v220, v232, v233
    v_cvt_pk_bf16_f32 v221, v234, v235
    v_exp_f32 v232, v188
    v_exp_f32 v233, v189
    v_exp_f32 v234, v190
    v_exp_f32 v235, v191
    s_nop 0
    v_cvt_pk_bf16_f32 v222, v232, v233
    v_cvt_pk_bf16_f32 v223, v234, v235
    s_nop 3
    s_setpc_b64 s[40:41]
k2_rare_144:
    s_nop 7
    v_max_f32 v53, v132, v133
    v_max3_f32 v53, v53, v134, v135
    v_max3_f32 v53, v53, v148, v149
    v_max3_f32 v53, v53, v150, v151
    v_max_f32 v54, v136, v137
    v_max3_f32 v54, v54, v138, v139
    v_max3_f32 v54, v54, v152, v153
    v_max3_f32 v54, v54, v154, v155
    v_max_f32 v55, v140, v141
    v_max3_f32 v55, v55, v142, v143
    v_max3_f32 v55, v55, v156, v157
    v_max3_f32 v55, v55, v158, v159
    v_mov_b32 v225, v53
    v_mov_b32 v226, v54
    v_mov_b32 v227, v55
    s_nop 1
    v_permlane16_swap_b32 v53, v225
    v_permlane16_swap_b32 v54, v226
    v_permlane16_swap_b32 v55, v227
    s_nop 1
    v_max_f32 v53, v53, v225
    v_max_f32 v54, v54, v226
    v_max_f32 v55, v55, v227
    v_mov_b32 v225, v53
    v_mov_b32 v226, v54
    v_mov_b32 v227, v55
    s_nop 1
    v_permlane32_swap_b32 v53, v225
    v_permlane32_swap_b32 v54, v226
    v_permlane32_swap_b32 v55, v227
    s_nop 1
    v_max_f32 v53, v53, v225
    v_max_f32 v54, v54, v226
    v_max_f32 v55, v55, v227
    v_add_f32 v53, 0x41400000, v53
    v_max_f32 v53, 0, v53
    v_add_f32 v54, 0x41400000, v54
    v_max_f32 v54, 0, v54
    v_add_f32 v55, 0x41400000, v55
    v_max_f32 v55, 0, v55
    v_sub_f32 v132, v132, v53
    v_sub_f32 v133, v133, v53
    v_sub_f32 v134, v134, v53
    v_sub_f32 v135, v135, v53
    v_sub_f32 v136, v136, v54
    v_sub_f32 v137, v137, v54
    v_sub_f32 v138, v138, v54
    v_sub_f32 v139, v139, v54
    v_sub_f32 v140, v140, v55
    v_sub_f32 v141, v141, v55
    v_sub_f32 v142, v142, v55
    v_sub_f32 v143, v143, v55
    v_sub_f32 v148, v148, v53
    v_sub_f32 v149, v149, v53
    v_sub_f32 v150, v150, v53
    v_sub_f32 v151, v151, v53
    v_sub_f32 v152, v152, v54
    v_sub_f32 v153, v153, v54
    v_sub_f32 v154, v154, v54
    v_sub_f32 v155, v155, v54
    v_sub_f32 v156, v156, v55
    v_sub_f32 v157, v157, v55
    v_sub_f32 v158, v158, v55
    v_sub_f32 v159, v159, v55
    v_sub_f32 v164, v164, v53
    v_sub_f32 v20, v20, v53
    v_sub_f32 v165, v165, v53
    v_sub_f32 v21, v21, v53
    v_sub_f32 v166, v166, v53
    v_sub_f32 v22, v22, v53
    v_sub_f32 v167, v167, v53
    v_sub_f32 v23, v23, v53
    v_sub_f32 v168, v168, v54
    v_sub_f32 v24, v24, v54
    v_sub_f32 v169, v169, v54
    v_sub_f32 v25, v25, v54
    v_sub_f32 v170, v170, v54
    v_sub_f32 v26, v26, v54
    v_sub_f32 v171, v171, v54
    v_sub_f32 v27, v27, v54
    v_sub_f32 v172, v172, v55
    v_sub_f32 v28, v28, v55
    v_sub_f32 v173, v173, v55
    v_sub_f32 v29, v29, v55
    v_sub_f32 v174, v174, v55
    v_sub_f32 v30, v30, v55
    v_sub_f32 v175, v175, v55
    v_sub_f32 v31, v31, v55
    v_sub_f32 v180, v180, v53
    v_sub_f32 v36, v36, v53
    v_sub_f32 v181, v181, v53
    v_sub_f32 v37, v37, v53
    v_sub_f32 v182, v182, v53
    v_sub_f32 v38, v38, v53
    v_sub_f32 v183, v183, v53
    v_sub_f32 v39, v39, v53
    v_sub_f32 v184, v184, v54
    v_sub_f32 v40, v40, v54
    v_sub_f32 v185, v185, v54
    v_sub_f32 v41, v41, v54
    v_sub_f32 v186, v186, v54
    v_sub_f32 v42, v42, v54
    v_sub_f32 v187, v187, v54
    v_sub_f32 v43, v43, v54
    v_sub_f32 v188, v188, v55
    v_sub_f32 v44, v44, v55
    v_sub_f32 v189, v189, v55
    v_sub_f32 v45, v45, v55
    v_sub_f32 v190, v190, v55
    v_sub_f32 v46, v46, v55
    v_sub_f32 v191, v191, v55
    v_sub_f32 v47, v47, v55
    v_sub_f32 v9, v9, v53
    v_exp_f32 v53, -v53
    v_sub_f32 v10, v10, v54
    v_exp_f32 v54, -v54
    v_sub_f32 v11, v11, v55
    v_exp_f32 v55, -v55
    s_nop 0
    v_mul_f32 v48, v48, v53
    v_mul_f32 v248, v248, v54
    v_mul_f32 v252, v252, v55
    v_accvgpr_read_b32 v224, a4
    v_accvgpr_read_b32 v225, a5
    v_accvgpr_read_b32 v226, a6
    v_accvgpr_read_b32 v227, a7
    v_mul_f32 v224, v224, v53
    v_mul_f32 v225, v225, v53
    v_mul_f32 v226, v226, v53
    v_mul_f32 v227, v227, v53
    v_accvgpr_write_b32 a4, v224
    v_accvgpr_write_b32 a5, v225
    v_accvgpr_write_b32 a6, v226
    v_accvgpr_write_b32 a7, v227
    v_accvgpr_read_b32 v224, a8
    v_accvgpr_read_b32 v225, a9
    v_accvgpr_read_b32 v226, a10
    v_accvgpr_read_b32 v227, a11
    v_mul_f32 v224, v224, v54
    v_mul_f32 v225, v225, v54
    v_mul_f32 v226, v226, v54
    v_mul_f32 v227, v227, v54
    v_accvgpr_write_b32 a8, v224
    v_accvgpr_write_b32 a9, v225
    v_accvgpr_write_b32 a10, v226
    v_accvgpr_write_b32 a11, v227
    v_accvgpr_read_b32 v224, a12
    v_accvgpr_read_b32 v225, a13
    v_accvgpr_read_b32 v226, a14
    v_accvgpr_read_b32 v227, a15
    v_mul_f32 v224, v224, v55
    v_mul_f32 v225, v225, v55
    v_mul_f32 v226, v226, v55
    v_mul_f32 v227, v227, v55
    v_accvgpr_write_b32 a12, v224
    v_accvgpr_write_b32 a13, v225
    v_accvgpr_write_b32 a14, v226
    v_accvgpr_write_b32 a15, v227
    v_accvgpr_read_b32 v224, a20
    v_accvgpr_read_b32 v225, a21
    v_accvgpr_read_b32 v226, a22
    v_accvgpr_read_b32 v227, a23
    v_mul_f32 v224, v224, v53
    v_mul_f32 v225, v225, v53
    v_mul_f32 v226, v226, v53
    v_mul_f32 v227, v227, v53
    v_accvgpr_write_b32 a20, v224
    v_accvgpr_write_b32 a21, v225
    v_accvgpr_write_b32 a22, v226
    v_accvgpr_write_b32 a23, v227
    v_accvgpr_read_b32 v224, a24
    v_accvgpr_read_b32 v225, a25
    v_accvgpr_read_b32 v226, a26
    v_accvgpr_read_b32 v227, a27
    v_mul_f32 v224, v224, v54
    v_mul_f32 v225, v225, v54
    v_mul_f32 v226, v226, v54
    v_mul_f32 v227, v227, v54
    v_accvgpr_write_b32 a24, v224
    v_accvgpr_write_b32 a25, v225
    v_accvgpr_write_b32 a26, v226
    v_accvgpr_write_b32 a27, v227
    v_accvgpr_read_b32 v224, a28
    v_accvgpr_read_b32 v225, a29
    v_accvgpr_read_b32 v226, a30
    v_accvgpr_read_b32 v227, a31
    v_mul_f32 v224, v224, v55
    v_mul_f32 v225, v225, v55
    v_mul_f32 v226, v226, v55
    v_mul_f32 v227, v227, v55
    v_accvgpr_write_b32 a28, v224
    v_accvgpr_write_b32 a29, v225
    v_accvgpr_write_b32 a30, v226
    v_accvgpr_write_b32 a31, v227
    v_accvgpr_read_b32 v224, a36
    v_accvgpr_read_b32 v225, a37
    v_accvgpr_read_b32 v226, a38
    v_accvgpr_read_b32 v227, a39
    v_mul_f32 v224, v224, v53
    v_mul_f32 v225, v225, v53
    v_mul_f32 v226, v226, v53
    v_mul_f32 v227, v227, v53
    v_accvgpr_write_b32 a36, v224
    v_accvgpr_write_b32 a37, v225
    v_accvgpr_write_b32 a38, v226
    v_accvgpr_write_b32 a39, v227
    v_accvgpr_read_b32 v224, a40
    v_accvgpr_read_b32 v225, a41
    v_accvgpr_read_b32 v226, a42
    v_accvgpr_read_b32 v227, a43
    v_mul_f32 v224, v224, v54
    v_mul_f32 v225, v225, v54
    v_mul_f32 v226, v226, v54
    v_mul_f32 v227, v227, v54
    v_accvgpr_write_b32 a40, v224
    v_accvgpr_write_b32 a41, v225
    v_accvgpr_write_b32 a42, v226
    v_accvgpr_write_b32 a43, v227
    v_accvgpr_read_b32 v224, a44
    v_accvgpr_read_b32 v225, a45
    v_accvgpr_read_b32 v226, a46
    v_accvgpr_read_b32 v227, a47
    v_mul_f32 v224, v224, v55
    v_mul_f32 v225, v225, v55
    v_mul_f32 v226, v226, v55
    v_mul_f32 v227, v227, v55
    v_accvgpr_write_b32 a44, v224
    v_accvgpr_write_b32 a45, v225
    v_accvgpr_write_b32 a46, v226
    v_accvgpr_write_b32 a47, v227
    v_accvgpr_read_b32 v224, a52
    v_accvgpr_read_b32 v225, a53
    v_accvgpr_read_b32 v226, a54
    v_accvgpr_read_b32 v227, a55
    v_mul_f32 v224, v224, v53
    v_mul_f32 v225, v225, v53
    v_mul_f32 v226, v226, v53
    v_mul_f32 v227, v227, v53
    v_accvgpr_write_b32 a52, v224
    v_accvgpr_write_b32 a53, v225
    v_accvgpr_write_b32 a54, v226
    v_accvgpr_write_b32 a55, v227
    v_accvgpr_read_b32 v224, a56
    v_accvgpr_read_b32 v225, a57
    v_accvgpr_read_b32 v226, a58
    v_accvgpr_read_b32 v227, a59
    v_mul_f32 v224, v224, v54
    v_mul_f32 v225, v225, v54
    v_mul_f32 v226, v226, v54
    v_mul_f32 v227, v227, v54
    v_accvgpr_write_b32 a56, v224
    v_accvgpr_write_b32 a57, v225
    v_accvgpr_write_b32 a58, v226
    v_accvgpr_write_b32 a59, v227
    v_accvgpr_read_b32 v224, a60
    v_accvgpr_read_b32 v225, a61
    v_accvgpr_read_b32 v226, a62
    v_accvgpr_read_b32 v227, a63
    v_mul_f32 v224, v224, v55
    v_mul_f32 v225, v225, v55
    v_mul_f32 v226, v226, v55
    v_mul_f32 v227, v227, v55
    v_accvgpr_write_b32 a60, v224
    v_accvgpr_write_b32 a61, v225
    v_accvgpr_write_b32 a62, v226
    v_accvgpr_write_b32 a63, v227
    v_accvgpr_read_b32 v224, a68
    v_accvgpr_read_b32 v225, a69
    v_accvgpr_read_b32 v226, a70
    v_accvgpr_read_b32 v227, a71
    v_mul_f32 v224, v224, v53
    v_mul_f32 v225, v225, v53
    v_mul_f32 v226, v226, v53
    v_mul_f32 v227, v227, v53
    v_accvgpr_write_b32 a68, v224
    v_accvgpr_write_b32 a69, v225
    v_accvgpr_write_b32 a70, v226
    v_accvgpr_write_b32 a71, v227
    v_accvgpr_read_b32 v224, a72
    v_accvgpr_read_b32 v225, a73
    v_accvgpr_read_b32 v226, a74
    v_accvgpr_read_b32 v227, a75
    v_mul_f32 v224, v224, v54
    v_mul_f32 v225, v225, v54
    v_mul_f32 v226, v226, v54
    v_mul_f32 v227, v227, v54
    v_accvgpr_write_b32 a72, v224
    v_accvgpr_write_b32 a73, v225
    v_accvgpr_write_b32 a74, v226
    v_accvgpr_write_b32 a75, v227
    v_accvgpr_read_b32 v224, a76
    v_accvgpr_read_b32 v225, a77
    v_accvgpr_read_b32 v226, a78
    v_accvgpr_read_b32 v227, a79
    v_mul_f32 v224, v224, v55
    v_mul_f32 v225, v225, v55
    v_mul_f32 v226, v226, v55
    v_mul_f32 v227, v227, v55
    v_accvgpr_write_b32 a76, v224
    v_accvgpr_write_b32 a77, v225
    v_accvgpr_write_b32 a78, v226
    v_accvgpr_write_b32 a79, v227
    v_accvgpr_read_b32 v224, a84
    v_accvgpr_read_b32 v225, a85
    v_accvgpr_read_b32 v226, a86
    v_accvgpr_read_b32 v227, a87
    v_mul_f32 v224, v224, v53
    v_mul_f32 v225, v225, v53
    v_mul_f32 v226, v226, v53
    v_mul_f32 v227, v227, v53
    v_accvgpr_write_b32 a84, v224
    v_accvgpr_write_b32 a85, v225
    v_accvgpr_write_b32 a86, v226
    v_accvgpr_write_b32 a87, v227
    v_accvgpr_read_b32 v224, a88
    v_accvgpr_read_b32 v225, a89
    v_accvgpr_read_b32 v226, a90
    v_accvgpr_read_b32 v227, a91
    v_mul_f32 v224, v224, v54
    v_mul_f32 v225, v225, v54
    v_mul_f32 v226, v226, v54
    v_mul_f32 v227, v227, v54
    v_accvgpr_write_b32 a88, v224
    v_accvgpr_write_b32 a89, v225
    v_accvgpr_write_b32 a90, v226
    v_accvgpr_write_b32 a91, v227
    v_accvgpr_read_b32 v224, a92
    v_accvgpr_read_b32 v225, a93
    v_accvgpr_read_b32 v226, a94
    v_accvgpr_read_b32 v227, a95
    v_mul_f32 v224, v224, v55
    v_mul_f32 v225, v225, v55
    v_mul_f32 v226, v226, v55
    v_mul_f32 v227, v227, v55
    v_accvgpr_write_b32 a92, v224
    v_accvgpr_write_b32 a93, v225
    v_accvgpr_write_b32 a94, v226
    v_accvgpr_write_b32 a95, v227
    v_accvgpr_read_b32 v224, a100
    v_accvgpr_read_b32 v225, a101
    v_accvgpr_read_b32 v226, a102
    v_accvgpr_read_b32 v227, a103
    v_mul_f32 v224, v224, v53
    v_mul_f32 v225, v225, v53
    v_mul_f32 v226, v226, v53
    v_mul_f32 v227, v227, v53
    v_accvgpr_write_b32 a100, v224
    v_accvgpr_write_b32 a101, v225
    v_accvgpr_write_b32 a102, v226
    v_accvgpr_write_b32 a103, v227
    v_accvgpr_read_b32 v224, a104
    v_accvgpr_read_b32 v225, a105
    v_accvgpr_read_b32 v226, a106
    v_accvgpr_read_b32 v227, a107
    v_mul_f32 v224, v224, v54
    v_mul_f32 v225, v225, v54
    v_mul_f32 v226, v226, v54
    v_mul_f32 v227, v227, v54
    v_accvgpr_write_b32 a104, v224
    v_accvgpr_write_b32 a105, v225
    v_accvgpr_write_b32 a106, v226
    v_accvgpr_write_b32 a107, v227
    v_accvgpr_read_b32 v224, a108
    v_accvgpr_read_b32 v225, a109
    v_accvgpr_read_b32 v226, a110
    v_accvgpr_read_b32 v227, a111
    v_mul_f32 v224, v224, v55
    v_mul_f32 v225, v225, v55
    v_mul_f32 v226, v226, v55
    v_mul_f32 v227, v227, v55
    v_accvgpr_write_b32 a108, v224
    v_accvgpr_write_b32 a109, v225
    v_accvgpr_write_b32 a110, v226
    v_accvgpr_write_b32 a111, v227
    v_accvgpr_read_b32 v224, a116
    v_accvgpr_read_b32 v225, a117
    v_accvgpr_read_b32 v226, a118
    v_accvgpr_read_b32 v227, a119
    v_mul_f32 v224, v224, v53
    v_mul_f32 v225, v225, v53
    v_mul_f32 v226, v226, v53
    v_mul_f32 v227, v227, v53
    v_accvgpr_write_b32 a116, v224
    v_accvgpr_write_b32 a117, v225
    v_accvgpr_write_b32 a118, v226
    v_accvgpr_write_b32 a119, v227
    v_accvgpr_read_b32 v224, a120
    v_accvgpr_read_b32 v225, a121
    v_accvgpr_read_b32 v226, a122
    v_accvgpr_read_b32 v227, a123
    v_mul_f32 v224, v224, v54
    v_mul_f32 v225, v225, v54
    v_mul_f32 v226, v226, v54
    v_mul_f32 v227, v227, v54
    v_accvgpr_write_b32 a120, v224
    v_accvgpr_write_b32 a121, v225
    v_accvgpr_write_b32 a122, v226
    v_accvgpr_write_b32 a123, v227
    v_accvgpr_read_b32 v224, a124
    v_accvgpr_read_b32 v225, a125
    v_accvgpr_read_b32 v226, a126
    v_accvgpr_read_b32 v227, a127
    v_mul_f32 v224, v224, v55
    v_mul_f32 v225, v225, v55
    v_mul_f32 v226, v226, v55
    v_mul_f32 v227, v227, v55
    v_accvgpr_write_b32 a124, v224
    v_accvgpr_write_b32 a125, v225
    v_accvgpr_write_b32 a126, v226
    v_accvgpr_write_b32 a127, v227
    v_exp_f32 v232, v132
    v_exp_f32 v233, v133
    v_exp_f32 v234, v134
    v_exp_f32 v235, v135
    s_nop 0
    v_cvt_pk_bf16_f32 v196, v232, v233
    v_cvt_pk_bf16_f32 v197, v234, v235
    v_exp_f32 v232, v148
    v_exp_f32 v233, v149
    v_exp_f32 v234, v150
    v_exp_f32 v235, v151
    s_nop 0
    v_cvt_pk_bf16_f32 v198, v232, v233
    v_cvt_pk_bf16_f32 v199, v234, v235
    v_exp_f32 v232, v136
    v_exp_f32 v233, v137
    v_exp_f32 v234, v138
    v_exp_f32 v235, v139
    s_nop 0
    v_cvt_pk_bf16_f32 v200, v232, v233
    v_cvt_pk_bf16_f32 v201, v234, v235
    v_exp_f32 v232, v152
    v_exp_f32 v233, v153
    v_exp_f32 v234, v154
    v_exp_f32 v235, v155
    s_nop 0
    v_cvt_pk_bf16_f32 v202, v232, v233
    v_cvt_pk_bf16_f32 v203, v234, v235
    v_exp_f32 v232, v140
    v_exp_f32 v233, v141
    v_exp_f32 v234, v142
    v_exp_f32 v235, v143
    s_nop 0
    v_cvt_pk_bf16_f32 v204, v232, v233
    v_cvt_pk_bf16_f32 v205, v234, v235
    v_exp_f32 v232, v156
    v_exp_f32 v233, v157
    v_exp_f32 v234, v158
    v_exp_f32 v235, v159
    s_nop 0
    v_cvt_pk_bf16_f32 v206, v232, v233
    v_cvt_pk_bf16_f32 v207, v234, v235
    s_nop 3
    s_setpc_b64 s[40:41]
k2_rare_145:
    s_nop 7
    v_max_f32 v53, v164, v165
    v_max3_f32 v53, v53, v166, v167
    v_max3_f32 v53, v53, v180, v181
    v_max3_f32 v53, v53, v182, v183
    v_max_f32 v54, v168, v169
    v_max3_f32 v54, v54, v170, v171
    v_max3_f32 v54, v54, v184, v185
    v_max3_f32 v54, v54, v186, v187
    v_max_f32 v55, v172, v173
    v_max3_f32 v55, v55, v174, v175
    v_max3_f32 v55, v55, v188, v189
    v_max3_f32 v55, v55, v190, v191
    v_mov_b32 v225, v53
    v_mov_b32 v226, v54
    v_mov_b32 v227, v55
    s_nop 1
    v_permlane16_swap_b32 v53, v225
    v_permlane16_swap_b32 v54, v226
    v_permlane16_swap_b32 v55, v227
    s_nop 1
    v_max_f32 v53, v53, v225
    v_max_f32 v54, v54, v226
    v_max_f32 v55, v55, v227
    v_mov_b32 v225, v53
    v_mov_b32 v226, v54
    v_mov_b32 v227, v55
    s_nop 1
    v_permlane32_swap_b32 v53, v225
    v_permlane32_swap_b32 v54, v226
    v_permlane32_swap_b32 v55, v227
    s_nop 1
    v_max_f32 v53, v53, v225
    v_max_f32 v54, v54, v226
    v_max_f32 v55, v55, v227
    v_add_f32 v53, 0x41400000, v53
    v_max_f32 v53, 0, v53
    v_add_f32 v54, 0x41400000, v54
    v_max_f32 v54, 0, v54
    v_add_f32 v55, 0x41400000, v55
    v_max_f32 v55, 0, v55
    v_sub_f32 v164, v164, v53
    v_sub_f32 v165, v165, v53
    v_sub_f32 v166, v166, v53
    v_sub_f32 v167, v167, v53
    v_sub_f32 v168, v168, v54
    v_sub_f32 v169, v169, v54
    v_sub_f32 v170, v170, v54
    v_sub_f32 v171, v171, v54
    v_sub_f32 v172, v172, v55
    v_sub_f32 v173, v173, v55
    v_sub_f32 v174, v174, v55
    v_sub_f32 v175, v175, v55
    v_sub_f32 v180, v180, v53
    v_sub_f32 v181, v181, v53
    v_sub_f32 v182, v182, v53
    v_sub_f32 v183, v183, v53
    v_sub_f32 v184, v184, v54
    v_sub_f32 v185, v185, v54
    v_sub_f32 v186, v186, v54
    v_sub_f32 v187, v187, v54
    v_sub_f32 v188, v188, v55
    v_sub_f32 v189, v189, v55
    v_sub_f32 v190, v190, v55
    v_sub_f32 v191, v191, v55
    v_sub_f32 v128, v128, v54
    v_sub_f32 v16, v16, v54
    v_sub_f32 v129, v129, v54
    v_sub_f32 v17, v17, v54
    v_sub_f32 v130, v130, v54
    v_sub_f32 v18, v18, v54
    v_sub_f32 v131, v131, v54
    v_sub_f32 v19, v19, v54
    v_sub_f32 v132, v132, v55
    v_sub_f32 v20, v20, v55
    v_sub_f32 v133, v133, v55
    v_sub_f32 v21, v21, v55
    v_sub_f32 v134, v134, v55
    v_sub_f32 v22, v22, v55
    v_sub_f32 v135, v135, v55
    v_sub_f32 v23, v23, v55
    v_sub_f32 v136, v136, v54
    v_sub_f32 v24, v24, v54
    v_sub_f32 v137, v137, v54
    v_sub_f32 v25, v25, v54
    v_sub_f32 v138, v138, v54
    v_sub_f32 v26, v26, v54
    v_sub_f32 v139, v139, v54
    v_sub_f32 v27, v27, v54
    v_sub_f32 v140, v140, v55
    v_sub_f32 v28, v28, v55
    v_sub_f32 v141, v141, v55
    v_sub_f32 v29, v29, v55
    v_sub_f32 v142, v142, v55
    v_sub_f32 v30, v30, v55
    v_sub_f32 v143, v143, v55
    v_sub_f32 v31, v31, v55
    v_sub_f32 v144, v144, v54
    v_sub_f32 v32, v32, v54
    v_sub_f32 v145, v145, v54
    v_sub_f32 v33, v33, v54
    v_sub_f32 v146, v146, v54
    v_sub_f32 v34, v34, v54
    v_sub_f32 v147, v147, v54
    v_sub_f32 v35, v35, v54
    v_sub_f32 v148, v148, v55
    v_sub_f32 v36, v36, v55
    v_sub_f32 v149, v149, v55
    v_sub_f32 v37, v37, v55
    v_sub_f32 v150, v150, v55
    v_sub_f32 v38, v38, v55
    v_sub_f32 v151, v151, v55
    v_sub_f32 v39, v39, v55
    v_sub_f32 v152, v152, v54
    v_sub_f32 v40, v40, v54
    v_sub_f32 v153, v153, v54
    v_sub_f32 v41, v41, v54
    v_sub_f32 v154, v154, v54
    v_sub_f32 v42, v42, v54
    v_sub_f32 v155, v155, v54
    v_sub_f32 v43, v43, v54
    v_sub_f32 v156, v156, v55
    v_sub_f32 v44, v44, v55
    v_sub_f32 v157, v157, v55
    v_sub_f32 v45, v45, v55
    v_sub_f32 v158, v158, v55
    v_sub_f32 v46, v46, v55
    v_sub_f32 v159, v159, v55
    v_sub_f32 v47, v47, v55
    v_sub_f32 v9, v9, v53
    v_exp_f32 v53, -v53
    v_sub_f32 v10, v10, v54
    v_exp_f32 v54, -v54
    v_sub_f32 v11, v11, v55
    v_exp_f32 v55, -v55
    s_nop 0
    v_mul_f32 v48, v48, v53
    v_mul_f32 v248, v248, v54
    v_mul_f32 v252, v252, v55
    v_accvgpr_read_b32 v224, a4
    v_accvgpr_read_b32 v225, a5
    v_accvgpr_read_b32 v226, a6
    v_accvgpr_read_b32 v227, a7
    v_mul_f32 v224, v224, v53
    v_mul_f32 v225, v225, v53
    v_mul_f32 v226, v226, v53
    v_mul_f32 v227, v227, v53
    v_accvgpr_write_b32 a4, v224
    v_accvgpr_write_b32 a5, v225
    v_accvgpr_write_b32 a6, v226
    v_accvgpr_write_b32 a7, v227
    v_accvgpr_read_b32 v224, a8
    v_accvgpr_read_b32 v225, a9
    v_accvgpr_read_b32 v226, a10
    v_accvgpr_read_b32 v227, a11
    v_mul_f32 v224, v224, v54
    v_mul_f32 v225, v225, v54
    v_mul_f32 v226, v226, v54
    v_mul_f32 v227, v227, v54
    v_accvgpr_write_b32 a8, v224
    v_accvgpr_write_b32 a9, v225
    v_accvgpr_write_b32 a10, v226
    v_accvgpr_write_b32 a11, v227
    v_accvgpr_read_b32 v224, a12
    v_accvgpr_read_b32 v225, a13
    v_accvgpr_read_b32 v226, a14
    v_accvgpr_read_b32 v227, a15
    v_mul_f32 v224, v224, v55
    v_mul_f32 v225, v225, v55
    v_mul_f32 v226, v226, v55
    v_mul_f32 v227, v227, v55
    v_accvgpr_write_b32 a12, v224
    v_accvgpr_write_b32 a13, v225
    v_accvgpr_write_b32 a14, v226
    v_accvgpr_write_b32 a15, v227
    v_accvgpr_read_b32 v224, a20
    v_accvgpr_read_b32 v225, a21
    v_accvgpr_read_b32 v226, a22
    v_accvgpr_read_b32 v227, a23
    v_mul_f32 v224, v224, v53
    v_mul_f32 v225, v225, v53
    v_mul_f32 v226, v226, v53
    v_mul_f32 v227, v227, v53
    v_accvgpr_write_b32 a20, v224
    v_accvgpr_write_b32 a21, v225
    v_accvgpr_write_b32 a22, v226
    v_accvgpr_write_b32 a23, v227
    v_accvgpr_read_b32 v224, a24
    v_accvgpr_read_b32 v225, a25
    v_accvgpr_read_b32 v226, a26
    v_accvgpr_read_b32 v227, a27
    v_mul_f32 v224, v224, v54
    v_mul_f32 v225, v225, v54
    v_mul_f32 v226, v226, v54
    v_mul_f32 v227, v227, v54
    v_accvgpr_write_b32 a24, v224
    v_accvgpr_write_b32 a25, v225
    v_accvgpr_write_b32 a26, v226
    v_accvgpr_write_b32 a27, v227
    v_accvgpr_read_b32 v224, a28
    v_accvgpr_read_b32 v225, a29
    v_accvgpr_read_b32 v226, a30
    v_accvgpr_read_b32 v227, a31
    v_mul_f32 v224, v224, v55
    v_mul_f32 v225, v225, v55
    v_mul_f32 v226, v226, v55
    v_mul_f32 v227, v227, v55
    v_accvgpr_write_b32 a28, v224
    v_accvgpr_write_b32 a29, v225
    v_accvgpr_write_b32 a30, v226
    v_accvgpr_write_b32 a31, v227
    v_accvgpr_read_b32 v224, a36
    v_accvgpr_read_b32 v225, a37
    v_accvgpr_read_b32 v226, a38
    v_accvgpr_read_b32 v227, a39
    v_mul_f32 v224, v224, v53
    v_mul_f32 v225, v225, v53
    v_mul_f32 v226, v226, v53
    v_mul_f32 v227, v227, v53
    v_accvgpr_write_b32 a36, v224
    v_accvgpr_write_b32 a37, v225
    v_accvgpr_write_b32 a38, v226
    v_accvgpr_write_b32 a39, v227
    v_accvgpr_read_b32 v224, a40
    v_accvgpr_read_b32 v225, a41
    v_accvgpr_read_b32 v226, a42
    v_accvgpr_read_b32 v227, a43
    v_mul_f32 v224, v224, v54
    v_mul_f32 v225, v225, v54
    v_mul_f32 v226, v226, v54
    v_mul_f32 v227, v227, v54
    v_accvgpr_write_b32 a40, v224
    v_accvgpr_write_b32 a41, v225
    v_accvgpr_write_b32 a42, v226
    v_accvgpr_write_b32 a43, v227
    v_accvgpr_read_b32 v224, a44
    v_accvgpr_read_b32 v225, a45
    v_accvgpr_read_b32 v226, a46
    v_accvgpr_read_b32 v227, a47
    v_mul_f32 v224, v224, v55
    v_mul_f32 v225, v225, v55
    v_mul_f32 v226, v226, v55
    v_mul_f32 v227, v227, v55
    v_accvgpr_write_b32 a44, v224
    v_accvgpr_write_b32 a45, v225
    v_accvgpr_write_b32 a46, v226
    v_accvgpr_write_b32 a47, v227
    v_accvgpr_read_b32 v224, a52
    v_accvgpr_read_b32 v225, a53
    v_accvgpr_read_b32 v226, a54
    v_accvgpr_read_b32 v227, a55
    v_mul_f32 v224, v224, v53
    v_mul_f32 v225, v225, v53
    v_mul_f32 v226, v226, v53
    v_mul_f32 v227, v227, v53
    v_accvgpr_write_b32 a52, v224
    v_accvgpr_write_b32 a53, v225
    v_accvgpr_write_b32 a54, v226
    v_accvgpr_write_b32 a55, v227
    v_accvgpr_read_b32 v224, a56
    v_accvgpr_read_b32 v225, a57
    v_accvgpr_read_b32 v226, a58
    v_accvgpr_read_b32 v227, a59
    v_mul_f32 v224, v224, v54
    v_mul_f32 v225, v225, v54
    v_mul_f32 v226, v226, v54
    v_mul_f32 v227, v227, v54
    v_accvgpr_write_b32 a56, v224
    v_accvgpr_write_b32 a57, v225
    v_accvgpr_write_b32 a58, v226
    v_accvgpr_write_b32 a59, v227
    v_accvgpr_read_b32 v224, a60
    v_accvgpr_read_b32 v225, a61
    v_accvgpr_read_b32 v226, a62
    v_accvgpr_read_b32 v227, a63
    v_mul_f32 v224, v224, v55
    v_mul_f32 v225, v225, v55
    v_mul_f32 v226, v226, v55
    v_mul_f32 v227, v227, v55
    v_accvgpr_write_b32 a60, v224
    v_accvgpr_write_b32 a61, v225
    v_accvgpr_write_b32 a62, v226
    v_accvgpr_write_b32 a63, v227
    v_accvgpr_read_b32 v224, a68
    v_accvgpr_read_b32 v225, a69
    v_accvgpr_read_b32 v226, a70
    v_accvgpr_read_b32 v227, a71
    v_mul_f32 v224, v224, v53
    v_mul_f32 v225, v225, v53
    v_mul_f32 v226, v226, v53
    v_mul_f32 v227, v227, v53
    v_accvgpr_write_b32 a68, v224
    v_accvgpr_write_b32 a69, v225
    v_accvgpr_write_b32 a70, v226
    v_accvgpr_write_b32 a71, v227
    v_accvgpr_read_b32 v224, a72
    v_accvgpr_read_b32 v225, a73
    v_accvgpr_read_b32 v226, a74
    v_accvgpr_read_b32 v227, a75
    v_mul_f32 v224, v224, v54
    v_mul_f32 v225, v225, v54
    v_mul_f32 v226, v226, v54
    v_mul_f32 v227, v227, v54
    v_accvgpr_write_b32 a72, v224
    v_accvgpr_write_b32 a73, v225
    v_accvgpr_write_b32 a74, v226
    v_accvgpr_write_b32 a75, v227
    v_accvgpr_read_b32 v224, a76
    v_accvgpr_read_b32 v225, a77
    v_accvgpr_read_b32 v226, a78
    v_accvgpr_read_b32 v227, a79
    v_mul_f32 v224, v224, v55
    v_mul_f32 v225, v225, v55
    v_mul_f32 v226, v226, v55
    v_mul_f32 v227, v227, v55
    v_accvgpr_write_b32 a76, v224
    v_accvgpr_write_b32 a77, v225
    v_accvgpr_write_b32 a78, v226
    v_accvgpr_write_b32 a79, v227
    v_accvgpr_read_b32 v224, a84
    v_accvgpr_read_b32 v225, a85
    v_accvgpr_read_b32 v226, a86
    v_accvgpr_read_b32 v227, a87
    v_mul_f32 v224, v224, v53
    v_mul_f32 v225, v225, v53
    v_mul_f32 v226, v226, v53
    v_mul_f32 v227, v227, v53
    v_accvgpr_write_b32 a84, v224
    v_accvgpr_write_b32 a85, v225
    v_accvgpr_write_b32 a86, v226
    v_accvgpr_write_b32 a87, v227
    v_accvgpr_read_b32 v224, a88
    v_accvgpr_read_b32 v225, a89
    v_accvgpr_read_b32 v226, a90
    v_accvgpr_read_b32 v227, a91
    v_mul_f32 v224, v224, v54
    v_mul_f32 v225, v225, v54
    v_mul_f32 v226, v226, v54
    v_mul_f32 v227, v227, v54
    v_accvgpr_write_b32 a88, v224
    v_accvgpr_write_b32 a89, v225
    v_accvgpr_write_b32 a90, v226
    v_accvgpr_write_b32 a91, v227
    v_accvgpr_read_b32 v224, a92
    v_accvgpr_read_b32 v225, a93
    v_accvgpr_read_b32 v226, a94
    v_accvgpr_read_b32 v227, a95
    v_mul_f32 v224, v224, v55
    v_mul_f32 v225, v225, v55
    v_mul_f32 v226, v226, v55
    v_mul_f32 v227, v227, v55
    v_accvgpr_write_b32 a92, v224
    v_accvgpr_write_b32 a93, v225
    v_accvgpr_write_b32 a94, v226
    v_accvgpr_write_b32 a95, v227
    v_accvgpr_read_b32 v224, a100
    v_accvgpr_read_b32 v225, a101
    v_accvgpr_read_b32 v226, a102
    v_accvgpr_read_b32 v227, a103
    v_mul_f32 v224, v224, v53
    v_mul_f32 v225, v225, v53
    v_mul_f32 v226, v226, v53
    v_mul_f32 v227, v227, v53
    v_accvgpr_write_b32 a100, v224
    v_accvgpr_write_b32 a101, v225
    v_accvgpr_write_b32 a102, v226
    v_accvgpr_write_b32 a103, v227
    v_accvgpr_read_b32 v224, a104
    v_accvgpr_read_b32 v225, a105
    v_accvgpr_read_b32 v226, a106
    v_accvgpr_read_b32 v227, a107
    v_mul_f32 v224, v224, v54
    v_mul_f32 v225, v225, v54
    v_mul_f32 v226, v226, v54
    v_mul_f32 v227, v227, v54
    v_accvgpr_write_b32 a104, v224
    v_accvgpr_write_b32 a105, v225
    v_accvgpr_write_b32 a106, v226
    v_accvgpr_write_b32 a107, v227
    v_accvgpr_read_b32 v224, a108
    v_accvgpr_read_b32 v225, a109
    v_accvgpr_read_b32 v226, a110
    v_accvgpr_read_b32 v227, a111
    v_mul_f32 v224, v224, v55
    v_mul_f32 v225, v225, v55
    v_mul_f32 v226, v226, v55
    v_mul_f32 v227, v227, v55
    v_accvgpr_write_b32 a108, v224
    v_accvgpr_write_b32 a109, v225
    v_accvgpr_write_b32 a110, v226
    v_accvgpr_write_b32 a111, v227
    v_accvgpr_read_b32 v224, a116
    v_accvgpr_read_b32 v225, a117
    v_accvgpr_read_b32 v226, a118
    v_accvgpr_read_b32 v227, a119
    v_mul_f32 v224, v224, v53
    v_mul_f32 v225, v225, v53
    v_mul_f32 v226, v226, v53
    v_mul_f32 v227, v227, v53
    v_accvgpr_write_b32 a116, v224
    v_accvgpr_write_b32 a117, v225
    v_accvgpr_write_b32 a118, v226
    v_accvgpr_write_b32 a119, v227
    v_accvgpr_read_b32 v224, a120
    v_accvgpr_read_b32 v225, a121
    v_accvgpr_read_b32 v226, a122
    v_accvgpr_read_b32 v227, a123
    v_mul_f32 v224, v224, v54
    v_mul_f32 v225, v225, v54
    v_mul_f32 v226, v226, v54
    v_mul_f32 v227, v227, v54
    v_accvgpr_write_b32 a120, v224
    v_accvgpr_write_b32 a121, v225
    v_accvgpr_write_b32 a122, v226
    v_accvgpr_write_b32 a123, v227
    v_accvgpr_read_b32 v224, a124
    v_accvgpr_read_b32 v225, a125
    v_accvgpr_read_b32 v226, a126
    v_accvgpr_read_b32 v227, a127
    v_mul_f32 v224, v224, v55
    v_mul_f32 v225, v225, v55
    v_mul_f32 v226, v226, v55
    v_mul_f32 v227, v227, v55
    v_accvgpr_write_b32 a124, v224
    v_accvgpr_write_b32 a125, v225
    v_accvgpr_write_b32 a126, v226
    v_accvgpr_write_b32 a127, v227
    v_exp_f32 v232, v164
    v_exp_f32 v233, v165
    v_exp_f32 v234, v166
    v_exp_f32 v235, v167
    s_nop 0
    v_cvt_pk_bf16_f32 v212, v232, v233
    v_cvt_pk_bf16_f32 v213, v234, v235
    v_exp_f32 v232, v180
    v_exp_f32 v233, v181
    v_exp_f32 v234, v182
    v_exp_f32 v235, v183
    s_nop 0
    v_cvt_pk_bf16_f32 v214, v232, v233
    v_cvt_pk_bf16_f32 v215, v234, v235
    v_exp_f32 v232, v168
    v_exp_f32 v233, v169
    v_exp_f32 v234, v170
    v_exp_f32 v235, v171
    s_nop 0
    v_cvt_pk_bf16_f32 v216, v232, v233
    v_cvt_pk_bf16_f32 v217, v234, v235
    v_exp_f32 v232, v184
    v_exp_f32 v233, v185
    v_exp_f32 v234, v186
    v_exp_f32 v235, v187
    s_nop 0
    v_cvt_pk_bf16_f32 v218, v232, v233
    v_cvt_pk_bf16_f32 v219, v234, v235
    v_exp_f32 v232, v172
    v_exp_f32 v233, v173
    v_exp_f32 v234, v174
    v_exp_f32 v235, v175
    s_nop 0
    v_cvt_pk_bf16_f32 v220, v232, v233
    v_cvt_pk_bf16_f32 v221, v234, v235
    v_exp_f32 v232, v188
    v_exp_f32 v233, v189
    v_exp_f32 v234, v190
    v_exp_f32 v235, v191
    s_nop 0
    v_cvt_pk_bf16_f32 v222, v232, v233
    v_cvt_pk_bf16_f32 v223, v234, v235
    s_nop 3
    s_setpc_b64 s[40:41]
k2_rare_146:
    s_nop 7
    v_max_f32 v54, v128, v129
    v_max3_f32 v54, v54, v130, v131
    v_max3_f32 v54, v54, v144, v145
    v_max3_f32 v54, v54, v146, v147
    v_max3_f32 v54, v54, v136, v137
    v_max3_f32 v54, v54, v138, v139
    v_max3_f32 v54, v54, v152, v153
    v_max3_f32 v54, v54, v154, v155
    v_max_f32 v55, v132, v133
    v_max3_f32 v55, v55, v134, v135
    v_max3_f32 v55, v55, v148, v149
    v_max3_f32 v55, v55, v150, v151
    v_max3_f32 v55, v55, v140, v141
    v_max3_f32 v55, v55, v142, v143
    v_max3_f32 v55, v55, v156, v157
    v_max3_f32 v55, v55, v158, v159
    v_mov_b32 v226, v54
    v_mov_b32 v227, v55
    s_nop 1
    v_permlane16_swap_b32 v54, v226
    v_permlane16_swap_b32 v55, v227
    s_nop 1
    v_max_f32 v54, v54, v226
    v_max_f32 v55, v55, v227
    v_mov_b32 v226, v54
    v_mov_b32 v227, v55
    s_nop 1
    v_permlane32_swap_b32 v54, v226
    v_permlane32_swap_b32 v55, v227
    s_nop 1
    v_max_f32 v54, v54, v226
    v_max_f32 v55, v55, v227
    v_add_f32 v54, 0x41400000, v54
    v_max_f32 v54, 0, v54
    v_add_f32 v55, 0x41400000, v55
    v_max_f32 v55, 0, v55
    v_sub_f32 v128, v128, v54
    v_sub_f32 v129, v129, v54
    v_sub_f32 v130, v130, v54
    v_sub_f32 v131, v131, v54
    v_sub_f32 v132, v132, v55
    v_sub_f32 v133, v133, v55
    v_sub_f32 v134, v134, v55
    v_sub_f32 v135, v135, v55
    v_sub_f32 v136, v136, v54
    v_sub_f32 v137, v137, v54
    v_sub_f32 v138, v138, v54
    v_sub_f32 v139, v139, v54
    v_sub_f32 v140, v140, v55
    v_sub_f32 v141, v141, v55
    v_sub_f32 v142, v142, v55
    v_sub_f32 v143, v143, v55
    v_sub_f32 v144, v144, v54
    v_sub_f32 v145, v145, v54
    v_sub_f32 v146, v146, v54
    v_sub_f32 v147, v147, v54
    v_sub_f32 v148, v148, v55
    v_sub_f32 v149, v149, v55
    v_sub_f32 v150, v150, v55
    v_sub_f32 v151, v151, v55
    v_sub_f32 v152, v152, v54
    v_sub_f32 v153, v153, v54
    v_sub_f32 v154, v154, v54
    v_sub_f32 v155, v155, v54
    v_sub_f32 v156, v156, v55
    v_sub_f32 v157, v157, v55
    v_sub_f32 v158, v158, v55
    v_sub_f32 v159, v159, v55
    v_sub_f32 v160, v160, v54
    v_sub_f32 v16, v16, v54
    v_sub_f32 v161, v161, v54
    v_sub_f32 v17, v17, v54
    v_sub_f32 v162, v162, v54
    v_sub_f32 v18, v18, v54
    v_sub_f32 v163, v163, v54
    v_sub_f32 v19, v19, v54
    v_sub_f32 v164, v164, v55
    v_sub_f32 v20, v20, v55
    v_sub_f32 v165, v165, v55
    v_sub_f32 v21, v21, v55
    v_sub_f32 v166, v166, v55
    v_sub_f32 v22, v22, v55
    v_sub_f32 v167, v167, v55
    v_sub_f32 v23, v23, v55
    v_sub_f32 v168, v168, v54
    v_sub_f32 v24, v24, v54
    v_sub_f32 v169, v169, v54
    v_sub_f32 v25, v25, v54
    v_sub_f32 v170, v170, v54
    v_sub_f32 v26, v26, v54
    v_sub_f32 v171, v171, v54
    v_sub_f32 v27, v27, v54
    v_sub_f32 v172, v172, v55
    v_sub_f32 v28, v28, v55
    v_sub_f32 v173, v173, v55
    v_sub_f32 v29, v29, v55
    v_sub_f32 v174, v174, v55
    v_sub_f32 v30, v30, v55
    v_sub_f32 v175, v175, v55
    v_sub_f32 v31, v31, v55
    v_sub_f32 v176, v176, v54
    v_sub_f32 v32, v32, v54
    v_sub_f32 v177, v177, v54
    v_sub_f32 v33, v33, v54
    v_sub_f32 v178, v178, v54
    v_sub_f32 v34, v34, v54
    v_sub_f32 v179, v179, v54
    v_sub_f32 v35, v35, v54
    v_sub_f32 v180, v180, v55
    v_sub_f32 v36, v36, v55
    v_sub_f32 v181, v181, v55
    v_sub_f32 v37, v37, v55
    v_sub_f32 v182, v182, v55
    v_sub_f32 v38, v38, v55
    v_sub_f32 v183, v183, v55
    v_sub_f32 v39, v39, v55
    v_sub_f32 v184, v184, v54
    v_sub_f32 v40, v40, v54
    v_sub_f32 v185, v185, v54
    v_sub_f32 v41, v41, v54
    v_sub_f32 v186, v186, v54
    v_sub_f32 v42, v42, v54
    v_sub_f32 v187, v187, v54
    v_sub_f32 v43, v43, v54
    v_sub_f32 v188, v188, v55
    v_sub_f32 v44, v44, v55
    v_sub_f32 v189, v189, v55
    v_sub_f32 v45, v45, v55
    v_sub_f32 v190, v190, v55
    v_sub_f32 v46, v46, v55
    v_sub_f32 v191, v191, v55
    v_sub_f32 v47, v47, v55
    v_sub_f32 v10, v10, v54
    v_exp_f32 v54, -v54
    v_sub_f32 v11, v11, v55
    v_exp_f32 v55, -v55
    s_nop 0
    v_mul_f32 v248, v248, v54
    v_mul_f32 v252, v252, v55
    v_accvgpr_read_b32 v224, a8
    v_accvgpr_read_b32 v225, a9
    v_accvgpr_read_b32 v226, a10
    v_accvgpr_read_b32 v227, a11
    v_mul_f32 v224, v224, v54
    v_mul_f32 v225, v225, v54
    v_mul_f32 v226, v226, v54
    v_mul_f32 v227, v227, v54
    v_accvgpr_write_b32 a8, v224
    v_accvgpr_write_b32 a9, v225
    v_accvgpr_write_b32 a10, v226
    v_accvgpr_write_b32 a11, v227
    v_accvgpr_read_b32 v224, a12
    v_accvgpr_read_b32 v225, a13
    v_accvgpr_read_b32 v226, a14
    v_accvgpr_read_b32 v227, a15
    v_mul_f32 v224, v224, v55
    v_mul_f32 v225, v225, v55
    v_mul_f32 v226, v226, v55
    v_mul_f32 v227, v227, v55
    v_accvgpr_write_b32 a12, v224
    v_accvgpr_write_b32 a13, v225
    v_accvgpr_write_b32 a14, v226
    v_accvgpr_write_b32 a15, v227
    v_accvgpr_read_b32 v224, a24
    v_accvgpr_read_b32 v225, a25
    v_accvgpr_read_b32 v226, a26
    v_accvgpr_read_b32 v227, a27
    v_mul_f32 v224, v224, v54
    v_mul_f32 v225, v225, v54
    v_mul_f32 v226, v226, v54
    v_mul_f32 v227, v227, v54
    v_accvgpr_write_b32 a24, v224
    v_accvgpr_write_b32 a25, v225
    v_accvgpr_write_b32 a26, v226
    v_accvgpr_write_b32 a27, v227
    v_accvgpr_read_b32 v224, a28
    v_accvgpr_read_b32 v225, a29
    v_accvgpr_read_b32 v226, a30
    v_accvgpr_read_b32 v227, a31
    v_mul_f32 v224, v224, v55
    v_mul_f32 v225, v225, v55
    v_mul_f32 v226, v226, v55
    v_mul_f32 v227, v227, v55
    v_accvgpr_write_b32 a28, v224
    v_accvgpr_write_b32 a29, v225
    v_accvgpr_write_b32 a30, v226
    v_accvgpr_write_b32 a31, v227
    v_accvgpr_read_b32 v224, a40
    v_accvgpr_read_b32 v225, a41
    v_accvgpr_read_b32 v226, a42
    v_accvgpr_read_b32 v227, a43
    v_mul_f32 v224, v224, v54
    v_mul_f32 v225, v225, v54
    v_mul_f32 v226, v226, v54
    v_mul_f32 v227, v227, v54
    v_accvgpr_write_b32 a40, v224
    v_accvgpr_write_b32 a41, v225
    v_accvgpr_write_b32 a42, v226
    v_accvgpr_write_b32 a43, v227
    v_accvgpr_read_b32 v224, a44
    v_accvgpr_read_b32 v225, a45
    v_accvgpr_read_b32 v226, a46
    v_accvgpr_read_b32 v227, a47
    v_mul_f32 v224, v224, v55
    v_mul_f32 v225, v225, v55
    v_mul_f32 v226, v226, v55
    v_mul_f32 v227, v227, v55
    v_accvgpr_write_b32 a44, v224
    v_accvgpr_write_b32 a45, v225
    v_accvgpr_write_b32 a46, v226
    v_accvgpr_write_b32 a47, v227
    v_accvgpr_read_b32 v224, a56
    v_accvgpr_read_b32 v225, a57
    v_accvgpr_read_b32 v226, a58
    v_accvgpr_read_b32 v227, a59
    v_mul_f32 v224, v224, v54
    v_mul_f32 v225, v225, v54
    v_mul_f32 v226, v226, v54
    v_mul_f32 v227, v227, v54
    v_accvgpr_write_b32 a56, v224
    v_accvgpr_write_b32 a57, v225
    v_accvgpr_write_b32 a58, v226
    v_accvgpr_write_b32 a59, v227
    v_accvgpr_read_b32 v224, a60
    v_accvgpr_read_b32 v225, a61
    v_accvgpr_read_b32 v226, a62
    v_accvgpr_read_b32 v227, a63
    v_mul_f32 v224, v224, v55
    v_mul_f32 v225, v225, v55
    v_mul_f32 v226, v226, v55
    v_mul_f32 v227, v227, v55
    v_accvgpr_write_b32 a60, v224
    v_accvgpr_write_b32 a61, v225
    v_accvgpr_write_b32 a62, v226
    v_accvgpr_write_b32 a63, v227
    v_accvgpr_read_b32 v224, a72
    v_accvgpr_read_b32 v225, a73
    v_accvgpr_read_b32 v226, a74
    v_accvgpr_read_b32 v227, a75
    v_mul_f32 v224, v224, v54
    v_mul_f32 v225, v225, v54
    v_mul_f32 v226, v226, v54
    v_mul_f32 v227, v227, v54
    v_accvgpr_write_b32 a72, v224
    v_accvgpr_write_b32 a73, v225
    v_accvgpr_write_b32 a74, v226
    v_accvgpr_write_b32 a75, v227
    v_accvgpr_read_b32 v224, a76
    v_accvgpr_read_b32 v225, a77
    v_accvgpr_read_b32 v226, a78
    v_accvgpr_read_b32 v227, a79
    v_mul_f32 v224, v224, v55
    v_mul_f32 v225, v225, v55
    v_mul_f32 v226, v226, v55
    v_mul_f32 v227, v227, v55
    v_accvgpr_write_b32 a76, v224
    v_accvgpr_write_b32 a77, v225
    v_accvgpr_write_b32 a78, v226
    v_accvgpr_write_b32 a79, v227
    v_accvgpr_read_b32 v224, a88
    v_accvgpr_read_b32 v225, a89
    v_accvgpr_read_b32 v226, a90
    v_accvgpr_read_b32 v227, a91
    v_mul_f32 v224, v224, v54
    v_mul_f32 v225, v225, v54
    v_mul_f32 v226, v226, v54
    v_mul_f32 v227, v227, v54
    v_accvgpr_write_b32 a88, v224
    v_accvgpr_write_b32 a89, v225
    v_accvgpr_write_b32 a90, v226
    v_accvgpr_write_b32 a91, v227
    v_accvgpr_read_b32 v224, a92
    v_accvgpr_read_b32 v225, a93
    v_accvgpr_read_b32 v226, a94
    v_accvgpr_read_b32 v227, a95
    v_mul_f32 v224, v224, v55
    v_mul_f32 v225, v225, v55
    v_mul_f32 v226, v226, v55
    v_mul_f32 v227, v227, v55
    v_accvgpr_write_b32 a92, v224
    v_accvgpr_write_b32 a93, v225
    v_accvgpr_write_b32 a94, v226
    v_accvgpr_write_b32 a95, v227
    v_accvgpr_read_b32 v224, a104
    v_accvgpr_read_b32 v225, a105
    v_accvgpr_read_b32 v226, a106
    v_accvgpr_read_b32 v227, a107
    v_mul_f32 v224, v224, v54
    v_mul_f32 v225, v225, v54
    v_mul_f32 v226, v226, v54
    v_mul_f32 v227, v227, v54
    v_accvgpr_write_b32 a104, v224
    v_accvgpr_write_b32 a105, v225
    v_accvgpr_write_b32 a106, v226
    v_accvgpr_write_b32 a107, v227
    v_accvgpr_read_b32 v224, a108
    v_accvgpr_read_b32 v225, a109
    v_accvgpr_read_b32 v226, a110
    v_accvgpr_read_b32 v227, a111
    v_mul_f32 v224, v224, v55
    v_mul_f32 v225, v225, v55
    v_mul_f32 v226, v226, v55
    v_mul_f32 v227, v227, v55
    v_accvgpr_write_b32 a108, v224
    v_accvgpr_write_b32 a109, v225
    v_accvgpr_write_b32 a110, v226
    v_accvgpr_write_b32 a111, v227
    v_accvgpr_read_b32 v224, a120
    v_accvgpr_read_b32 v225, a121
    v_accvgpr_read_b32 v226, a122
    v_accvgpr_read_b32 v227, a123
    v_mul_f32 v224, v224, v54
    v_mul_f32 v225, v225, v54
    v_mul_f32 v226, v226, v54
    v_mul_f32 v227, v227, v54
    v_accvgpr_write_b32 a120, v224
    v_accvgpr_write_b32 a121, v225
    v_accvgpr_write_b32 a122, v226
    v_accvgpr_write_b32 a123, v227
    v_accvgpr_read_b32 v224, a124
    v_accvgpr_read_b32 v225, a125
    v_accvgpr_read_b32 v226, a126
    v_accvgpr_read_b32 v227, a127
    v_mul_f32 v224, v224, v55
    v_mul_f32 v225, v225, v55
    v_mul_f32 v226, v226, v55
    v_mul_f32 v227, v227, v55
    v_accvgpr_write_b32 a124, v224
    v_accvgpr_write_b32 a125, v225
    v_accvgpr_write_b32 a126, v226
    v_accvgpr_write_b32 a127, v227
    v_exp_f32 v232, v128
    v_exp_f32 v233, v129
    v_exp_f32 v234, v130
    v_exp_f32 v235, v131
    s_nop 0
    v_cvt_pk_bf16_f32 v192, v232, v233
    v_cvt_pk_bf16_f32 v193, v234, v235
    v_exp_f32 v232, v144
    v_exp_f32 v233, v145
    v_exp_f32 v234, v146
    v_exp_f32 v235, v147
    s_nop 0
    v_cvt_pk_bf16_f32 v194, v232, v233
    v_cvt_pk_bf16_f32 v195, v234, v235
    v_exp_f32 v232, v132
    v_exp_f32 v233, v133
    v_exp_f32 v234, v134
    v_exp_f32 v235, v135
    s_nop 0
    v_cvt_pk_bf16_f32 v196, v232, v233
    v_cvt_pk_bf16_f32 v197, v234, v235
    v_exp_f32 v232, v148
    v_exp_f32 v233, v149
    v_exp_f32 v234, v150
    v_exp_f32 v235, v151
    s_nop 0
    v_cvt_pk_bf16_f32 v198, v232, v233
    v_cvt_pk_bf16_f32 v199, v234, v235
    v_exp_f32 v232, v136
    v_exp_f32 v233, v137
    v_exp_f32 v234, v138
    v_exp_f32 v235, v139
    s_nop 0
    v_cvt_pk_bf16_f32 v200, v232, v233
    v_cvt_pk_bf16_f32 v201, v234, v235
    v_exp_f32 v232, v152
    v_exp_f32 v233, v153
    v_exp_f32 v234, v154
    v_exp_f32 v235, v155
    s_nop 0
    v_cvt_pk_bf16_f32 v202, v232, v233
    v_cvt_pk_bf16_f32 v203, v234, v235
    v_exp_f32 v232, v140
    v_exp_f32 v233, v141
    v_exp_f32 v234, v142
    v_exp_f32 v235, v143
    s_nop 0
    v_cvt_pk_bf16_f32 v204, v232, v233
    v_cvt_pk_bf16_f32 v205, v234, v235
    v_exp_f32 v232, v156
    v_exp_f32 v233, v157
    v_exp_f32 v234, v158
    v_exp_f32 v235, v159
    s_nop 0
    v_cvt_pk_bf16_f32 v206, v232, v233
    v_cvt_pk_bf16_f32 v207, v234, v235
    s_nop 3
    s_setpc_b64 s[40:41]
k2_rare_147:
    s_nop 7
    v_max_f32 v54, v160, v161
    v_max3_f32 v54, v54, v162, v163
    v_max3_f32 v54, v54, v176, v177
    v_max3_f32 v54, v54, v178, v179
    v_max3_f32 v54, v54, v168, v169
    v_max3_f32 v54, v54, v170, v171
    v_max3_f32 v54, v54, v184, v185
    v_max3_f32 v54, v54, v186, v187
    v_max_f32 v55, v164, v165
    v_max3_f32 v55, v55, v166, v167
    v_max3_f32 v55, v55, v180, v181
    v_max3_f32 v55, v55, v182, v183
    v_max3_f32 v55, v55, v172, v173
    v_max3_f32 v55, v55, v174, v175
    v_max3_f32 v55, v55, v188, v189
    v_max3_f32 v55, v55, v190, v191
    v_mov_b32 v226, v54
    v_mov_b32 v227, v55
    s_nop 1
    v_permlane16_swap_b32 v54, v226
    v_permlane16_swap_b32 v55, v227
    s_nop 1
    v_max_f32 v54, v54, v226
    v_max_f32 v55, v55, v227
    v_mov_b32 v226, v54
    v_mov_b32 v227, v55
    s_nop 1
    v_permlane32_swap_b32 v54, v226
    v_permlane32_swap_b32 v55, v227
    s_nop 1
    v_max_f32 v54, v54, v226
    v_max_f32 v55, v55, v227
    v_add_f32 v54, 0x41400000, v54
    v_max_f32 v54, 0, v54
    v_add_f32 v55, 0x41400000, v55
    v_max_f32 v55, 0, v55
    v_sub_f32 v160, v160, v54
    v_sub_f32 v161, v161, v54
    v_sub_f32 v162, v162, v54
    v_sub_f32 v163, v163, v54
    v_sub_f32 v164, v164, v55
    v_sub_f32 v165, v165, v55
    v_sub_f32 v166, v166, v55
    v_sub_f32 v167, v167, v55
    v_sub_f32 v168, v168, v54
    v_sub_f32 v169, v169, v54
    v_sub_f32 v170, v170, v54
    v_sub_f32 v171, v171, v54
    v_sub_f32 v172, v172, v55
    v_sub_f32 v173, v173, v55
    v_sub_f32 v174, v174, v55
    v_sub_f32 v175, v175, v55
    v_sub_f32 v176, v176, v54
    v_sub_f32 v177, v177, v54
    v_sub_f32 v178, v178, v54
    v_sub_f32 v179, v179, v54
    v_sub_f32 v180, v180, v55
    v_sub_f32 v181, v181, v55
    v_sub_f32 v182, v182, v55
    v_sub_f32 v183, v183, v55
    v_sub_f32 v184, v184, v54
    v_sub_f32 v185, v185, v54
    v_sub_f32 v186, v186, v54
    v_sub_f32 v187, v187, v54
    v_sub_f32 v188, v188, v55
    v_sub_f32 v189, v189, v55
    v_sub_f32 v190, v190, v55
    v_sub_f32 v191, v191, v55
    v_sub_f32 v128, v128, v54
    v_sub_f32 v16, v16, v54
    v_sub_f32 v129, v129, v54
    v_sub_f32 v17, v17, v54
    v_sub_f32 v130, v130, v54
    v_sub_f32 v18, v18, v54
    v_sub_f32 v131, v131, v54
    v_sub_f32 v19, v19, v54
    v_sub_f32 v132, v132, v55
    v_sub_f32 v20, v20, v55
    v_sub_f32 v133, v133, v55
    v_sub_f32 v21, v21, v55
    v_sub_f32 v134, v134, v55
    v_sub_f32 v22, v22, v55
    v_sub_f32 v135, v135, v55
    v_sub_f32 v23, v23, v55
    v_sub_f32 v136, v136, v54
    v_sub_f32 v24, v24, v54
    v_sub_f32 v137, v137, v54
    v_sub_f32 v25, v25, v54
    v_sub_f32 v138, v138, v54
    v_sub_f32 v26, v26, v54
    v_sub_f32 v139, v139, v54
    v_sub_f32 v27, v27, v54
    v_sub_f32 v140, v140, v55
    v_sub_f32 v28, v28, v55
    v_sub_f32 v141, v141, v55
    v_sub_f32 v29, v29, v55
    v_sub_f32 v142, v142, v55
    v_sub_f32 v30, v30, v55
    v_sub_f32 v143, v143, v55
    v_sub_f32 v31, v31, v55
    v_sub_f32 v144, v144, v54
    v_sub_f32 v32, v32, v54
    v_sub_f32 v145, v145, v54
    v_sub_f32 v33, v33, v54
    v_sub_f32 v146, v146, v54
    v_sub_f32 v34, v34, v54
    v_sub_f32 v147, v147, v54
    v_sub_f32 v35, v35, v54
    v_sub_f32 v148, v148, v55
    v_sub_f32 v36, v36, v55
    v_sub_f32 v149, v149, v55
    v_sub_f32 v37, v37, v55
    v_sub_f32 v150, v150, v55
    v_sub_f32 v38, v38, v55
    v_sub_f32 v151, v151, v55
    v_sub_f32 v39, v39, v55
    v_sub_f32 v152, v152, v54
    v_sub_f32 v40, v40, v54
    v_sub_f32 v153, v153, v54
    v_sub_f32 v41, v41, v54
    v_sub_f32 v154, v154, v54
    v_sub_f32 v42, v42, v54
    v_sub_f32 v155, v155, v54
    v_sub_f32 v43, v43, v54
    v_sub_f32 v156, v156, v55
    v_sub_f32 v44, v44, v55
    v_sub_f32 v157, v157, v55
    v_sub_f32 v45, v45, v55
    v_sub_f32 v158, v158, v55
    v_sub_f32 v46, v46, v55
    v_sub_f32 v159, v159, v55
    v_sub_f32 v47, v47, v55
    v_sub_f32 v10, v10, v54
    v_exp_f32 v54, -v54
    v_sub_f32 v11, v11, v55
    v_exp_f32 v55, -v55
    s_nop 0
    v_mul_f32 v248, v248, v54
    v_mul_f32 v252, v252, v55
    v_accvgpr_read_b32 v224, a8
    v_accvgpr_read_b32 v225, a9
    v_accvgpr_read_b32 v226, a10
    v_accvgpr_read_b32 v227, a11
    v_mul_f32 v224, v224, v54
    v_mul_f32 v225, v225, v54
    v_mul_f32 v226, v226, v54
    v_mul_f32 v227, v227, v54
    v_accvgpr_write_b32 a8, v224
    v_accvgpr_write_b32 a9, v225
    v_accvgpr_write_b32 a10, v226
    v_accvgpr_write_b32 a11, v227
    v_accvgpr_read_b32 v224, a12
    v_accvgpr_read_b32 v225, a13
    v_accvgpr_read_b32 v226, a14
    v_accvgpr_read_b32 v227, a15
    v_mul_f32 v224, v224, v55
    v_mul_f32 v225, v225, v55
    v_mul_f32 v226, v226, v55
    v_mul_f32 v227, v227, v55
    v_accvgpr_write_b32 a12, v224
    v_accvgpr_write_b32 a13, v225
    v_accvgpr_write_b32 a14, v226
    v_accvgpr_write_b32 a15, v227
    v_accvgpr_read_b32 v224, a24
    v_accvgpr_read_b32 v225, a25
    v_accvgpr_read_b32 v226, a26
    v_accvgpr_read_b32 v227, a27
    v_mul_f32 v224, v224, v54
    v_mul_f32 v225, v225, v54
    v_mul_f32 v226, v226, v54
    v_mul_f32 v227, v227, v54
    v_accvgpr_write_b32 a24, v224
    v_accvgpr_write_b32 a25, v225
    v_accvgpr_write_b32 a26, v226
    v_accvgpr_write_b32 a27, v227
    v_accvgpr_read_b32 v224, a28
    v_accvgpr_read_b32 v225, a29
    v_accvgpr_read_b32 v226, a30
    v_accvgpr_read_b32 v227, a31
    v_mul_f32 v224, v224, v55
    v_mul_f32 v225, v225, v55
    v_mul_f32 v226, v226, v55
    v_mul_f32 v227, v227, v55
    v_accvgpr_write_b32 a28, v224
    v_accvgpr_write_b32 a29, v225
    v_accvgpr_write_b32 a30, v226
    v_accvgpr_write_b32 a31, v227
    v_accvgpr_read_b32 v224, a40
    v_accvgpr_read_b32 v225, a41
    v_accvgpr_read_b32 v226, a42
    v_accvgpr_read_b32 v227, a43
    v_mul_f32 v224, v224, v54
    v_mul_f32 v225, v225, v54
    v_mul_f32 v226, v226, v54
    v_mul_f32 v227, v227, v54
    v_accvgpr_write_b32 a40, v224
    v_accvgpr_write_b32 a41, v225
    v_accvgpr_write_b32 a42, v226
    v_accvgpr_write_b32 a43, v227
    v_accvgpr_read_b32 v224, a44
    v_accvgpr_read_b32 v225, a45
    v_accvgpr_read_b32 v226, a46
    v_accvgpr_read_b32 v227, a47
    v_mul_f32 v224, v224, v55
    v_mul_f32 v225, v225, v55
    v_mul_f32 v226, v226, v55
    v_mul_f32 v227, v227, v55
    v_accvgpr_write_b32 a44, v224
    v_accvgpr_write_b32 a45, v225
    v_accvgpr_write_b32 a46, v226
    v_accvgpr_write_b32 a47, v227
    v_accvgpr_read_b32 v224, a56
    v_accvgpr_read_b32 v225, a57
    v_accvgpr_read_b32 v226, a58
    v_accvgpr_read_b32 v227, a59
    v_mul_f32 v224, v224, v54
    v_mul_f32 v225, v225, v54
    v_mul_f32 v226, v226, v54
    v_mul_f32 v227, v227, v54
    v_accvgpr_write_b32 a56, v224
    v_accvgpr_write_b32 a57, v225
    v_accvgpr_write_b32 a58, v226
    v_accvgpr_write_b32 a59, v227
    v_accvgpr_read_b32 v224, a60
    v_accvgpr_read_b32 v225, a61
    v_accvgpr_read_b32 v226, a62
    v_accvgpr_read_b32 v227, a63
    v_mul_f32 v224, v224, v55
    v_mul_f32 v225, v225, v55
    v_mul_f32 v226, v226, v55
    v_mul_f32 v227, v227, v55
    v_accvgpr_write_b32 a60, v224
    v_accvgpr_write_b32 a61, v225
    v_accvgpr_write_b32 a62, v226
    v_accvgpr_write_b32 a63, v227
    v_accvgpr_read_b32 v224, a72
    v_accvgpr_read_b32 v225, a73
    v_accvgpr_read_b32 v226, a74
    v_accvgpr_read_b32 v227, a75
    v_mul_f32 v224, v224, v54
    v_mul_f32 v225, v225, v54
    v_mul_f32 v226, v226, v54
    v_mul_f32 v227, v227, v54
    v_accvgpr_write_b32 a72, v224
    v_accvgpr_write_b32 a73, v225
    v_accvgpr_write_b32 a74, v226
    v_accvgpr_write_b32 a75, v227
    v_accvgpr_read_b32 v224, a76
    v_accvgpr_read_b32 v225, a77
    v_accvgpr_read_b32 v226, a78
    v_accvgpr_read_b32 v227, a79
    v_mul_f32 v224, v224, v55
    v_mul_f32 v225, v225, v55
    v_mul_f32 v226, v226, v55
    v_mul_f32 v227, v227, v55
    v_accvgpr_write_b32 a76, v224
    v_accvgpr_write_b32 a77, v225
    v_accvgpr_write_b32 a78, v226
    v_accvgpr_write_b32 a79, v227
    v_accvgpr_read_b32 v224, a88
    v_accvgpr_read_b32 v225, a89
    v_accvgpr_read_b32 v226, a90
    v_accvgpr_read_b32 v227, a91
    v_mul_f32 v224, v224, v54
    v_mul_f32 v225, v225, v54
    v_mul_f32 v226, v226, v54
    v_mul_f32 v227, v227, v54
    v_accvgpr_write_b32 a88, v224
    v_accvgpr_write_b32 a89, v225
    v_accvgpr_write_b32 a90, v226
    v_accvgpr_write_b32 a91, v227
    v_accvgpr_read_b32 v224, a92
    v_accvgpr_read_b32 v225, a93
    v_accvgpr_read_b32 v226, a94
    v_accvgpr_read_b32 v227, a95
    v_mul_f32 v224, v224, v55
    v_mul_f32 v225, v225, v55
    v_mul_f32 v226, v226, v55
    v_mul_f32 v227, v227, v55
    v_accvgpr_write_b32 a92, v224
    v_accvgpr_write_b32 a93, v225
    v_accvgpr_write_b32 a94, v226
    v_accvgpr_write_b32 a95, v227
    v_accvgpr_read_b32 v224, a104
    v_accvgpr_read_b32 v225, a105
    v_accvgpr_read_b32 v226, a106
    v_accvgpr_read_b32 v227, a107
    v_mul_f32 v224, v224, v54
    v_mul_f32 v225, v225, v54
    v_mul_f32 v226, v226, v54
    v_mul_f32 v227, v227, v54
    v_accvgpr_write_b32 a104, v224
    v_accvgpr_write_b32 a105, v225
    v_accvgpr_write_b32 a106, v226
    v_accvgpr_write_b32 a107, v227
    v_accvgpr_read_b32 v224, a108
    v_accvgpr_read_b32 v225, a109
    v_accvgpr_read_b32 v226, a110
    v_accvgpr_read_b32 v227, a111
    v_mul_f32 v224, v224, v55
    v_mul_f32 v225, v225, v55
    v_mul_f32 v226, v226, v55
    v_mul_f32 v227, v227, v55
    v_accvgpr_write_b32 a108, v224
    v_accvgpr_write_b32 a109, v225
    v_accvgpr_write_b32 a110, v226
    v_accvgpr_write_b32 a111, v227
    v_accvgpr_read_b32 v224, a120
    v_accvgpr_read_b32 v225, a121
    v_accvgpr_read_b32 v226, a122
    v_accvgpr_read_b32 v227, a123
    v_mul_f32 v224, v224, v54
    v_mul_f32 v225, v225, v54
    v_mul_f32 v226, v226, v54
    v_mul_f32 v227, v227, v54
    v_accvgpr_write_b32 a120, v224
    v_accvgpr_write_b32 a121, v225
    v_accvgpr_write_b32 a122, v226
    v_accvgpr_write_b32 a123, v227
    v_accvgpr_read_b32 v224, a124
    v_accvgpr_read_b32 v225, a125
    v_accvgpr_read_b32 v226, a126
    v_accvgpr_read_b32 v227, a127
    v_mul_f32 v224, v224, v55
    v_mul_f32 v225, v225, v55
    v_mul_f32 v226, v226, v55
    v_mul_f32 v227, v227, v55
    v_accvgpr_write_b32 a124, v224
    v_accvgpr_write_b32 a125, v225
    v_accvgpr_write_b32 a126, v226
    v_accvgpr_write_b32 a127, v227
    v_exp_f32 v232, v160
    v_exp_f32 v233, v161
    v_exp_f32 v234, v162
    v_exp_f32 v235, v163
    s_nop 0
    v_cvt_pk_bf16_f32 v208, v232, v233
    v_cvt_pk_bf16_f32 v209, v234, v235
    v_exp_f32 v232, v176
    v_exp_f32 v233, v177
    v_exp_f32 v234, v178
    v_exp_f32 v235, v179
    s_nop 0
    v_cvt_pk_bf16_f32 v210, v232, v233
    v_cvt_pk_bf16_f32 v211, v234, v235
    v_exp_f32 v232, v164
    v_exp_f32 v233, v165
    v_exp_f32 v234, v166
    v_exp_f32 v235, v167
    s_nop 0
    v_cvt_pk_bf16_f32 v212, v232, v233
    v_cvt_pk_bf16_f32 v213, v234, v235
    v_exp_f32 v232, v180
    v_exp_f32 v233, v181
    v_exp_f32 v234, v182
    v_exp_f32 v235, v183
    s_nop 0
    v_cvt_pk_bf16_f32 v214, v232, v233
    v_cvt_pk_bf16_f32 v215, v234, v235
    v_exp_f32 v232, v168
    v_exp_f32 v233, v169
    v_exp_f32 v234, v170
    v_exp_f32 v235, v171
    s_nop 0
    v_cvt_pk_bf16_f32 v216, v232, v233
    v_cvt_pk_bf16_f32 v217, v234, v235
    v_exp_f32 v232, v184
    v_exp_f32 v233, v185
    v_exp_f32 v234, v186
    v_exp_f32 v235, v187
    s_nop 0
    v_cvt_pk_bf16_f32 v218, v232, v233
    v_cvt_pk_bf16_f32 v219, v234, v235
    v_exp_f32 v232, v172
    v_exp_f32 v233, v173
    v_exp_f32 v234, v174
    v_exp_f32 v235, v175
    s_nop 0
    v_cvt_pk_bf16_f32 v220, v232, v233
    v_cvt_pk_bf16_f32 v221, v234, v235
    v_exp_f32 v232, v188
    v_exp_f32 v233, v189
    v_exp_f32 v234, v190
    v_exp_f32 v235, v191
    s_nop 0
    v_cvt_pk_bf16_f32 v222, v232, v233
    v_cvt_pk_bf16_f32 v223, v234, v235
    s_nop 3
    s_setpc_b64 s[40:41]
k2_rare_151:
    s_nop 7
    v_max_f32 v55, v164, v165
    v_max3_f32 v55, v55, v166, v167
    v_max3_f32 v55, v55, v180, v181
    v_max3_f32 v55, v55, v182, v183
    v_max3_f32 v55, v55, v172, v173
    v_max3_f32 v55, v55, v174, v175
    v_max3_f32 v55, v55, v188, v189
    v_max3_f32 v55, v55, v190, v191
    v_mov_b32 v227, v55
    s_nop 1
    v_permlane16_swap_b32 v55, v227
    s_nop 1
    v_max_f32 v55, v55, v227
    v_mov_b32 v227, v55
    s_nop 1
    v_permlane32_swap_b32 v55, v227
    s_nop 1
    v_max_f32 v55, v55, v227
    v_add_f32 v55, 0x41400000, v55
    v_max_f32 v55, 0, v55
    v_sub_f32 v164, v164, v55
    v_sub_f32 v165, v165, v55
    v_sub_f32 v166, v166, v55
    v_sub_f32 v167, v167, v55
    v_sub_f32 v172, v172, v55
    v_sub_f32 v173, v173, v55
    v_sub_f32 v174, v174, v55
    v_sub_f32 v175, v175, v55
    v_sub_f32 v180, v180, v55
    v_sub_f32 v181, v181, v55
    v_sub_f32 v182, v182, v55
    v_sub_f32 v183, v183, v55
    v_sub_f32 v188, v188, v55
    v_sub_f32 v189, v189, v55
    v_sub_f32 v190, v190, v55
    v_sub_f32 v191, v191, v55
    v_sub_f32 v11, v11, v55
    v_exp_f32 v55, -v55
    s_nop 0
    v_mul_f32 v252, v252, v55
    v_accvgpr_read_b32 v224, a12
    v_accvgpr_read_b32 v225, a13
    v_accvgpr_read_b32 v226, a14
    v_accvgpr_read_b32 v227, a15
    v_mul_f32 v224, v224, v55
    v_mul_f32 v225, v225, v55
    v_mul_f32 v226, v226, v55
    v_mul_f32 v227, v227, v55
    v_accvgpr_write_b32 a12, v224
    v_accvgpr_write_b32 a13, v225
    v_accvgpr_write_b32 a14, v226
    v_accvgpr_write_b32 a15, v227
    v_accvgpr_read_b32 v224, a28
    v_accvgpr_read_b32 v225, a29
    v_accvgpr_read_b32 v226, a30
    v_accvgpr_read_b32 v227, a31
    v_mul_f32 v224, v224, v55
    v_mul_f32 v225, v225, v55
    v_mul_f32 v226, v226, v55
    v_mul_f32 v227, v227, v55
    v_accvgpr_write_b32 a28, v224
    v_accvgpr_write_b32 a29, v225
    v_accvgpr_write_b32 a30, v226
    v_accvgpr_write_b32 a31, v227
    v_accvgpr_read_b32 v224, a44
    v_accvgpr_read_b32 v225, a45
    v_accvgpr_read_b32 v226, a46
    v_accvgpr_read_b32 v227, a47
    v_mul_f32 v224, v224, v55
    v_mul_f32 v225, v225, v55
    v_mul_f32 v226, v226, v55
    v_mul_f32 v227, v227, v55
    v_accvgpr_write_b32 a44, v224
    v_accvgpr_write_b32 a45, v225
    v_accvgpr_write_b32 a46, v226
    v_accvgpr_write_b32 a47, v227
    v_accvgpr_read_b32 v224, a60
    v_accvgpr_read_b32 v225, a61
    v_accvgpr_read_b32 v226, a62
    v_accvgpr_read_b32 v227, a63
    v_mul_f32 v224, v224, v55
    v_mul_f32 v225, v225, v55
    v_mul_f32 v226, v226, v55
    v_mul_f32 v227, v227, v55
    v_accvgpr_write_b32 a60, v224
    v_accvgpr_write_b32 a61, v225
    v_accvgpr_write_b32 a62, v226
    v_accvgpr_write_b32 a63, v227
    v_accvgpr_read_b32 v224, a76
    v_accvgpr_read_b32 v225, a77
    v_accvgpr_read_b32 v226, a78
    v_accvgpr_read_b32 v227, a79
    v_mul_f32 v224, v224, v55
    v_mul_f32 v225, v225, v55
    v_mul_f32 v226, v226, v55
    v_mul_f32 v227, v227, v55
    v_accvgpr_write_b32 a76, v224
    v_accvgpr_write_b32 a77, v225
    v_accvgpr_write_b32 a78, v226
    v_accvgpr_write_b32 a79, v227
    v_accvgpr_read_b32 v224, a92
    v_accvgpr_read_b32 v225, a93
    v_accvgpr_read_b32 v226, a94
    v_accvgpr_read_b32 v227, a95
    v_mul_f32 v224, v224, v55
    v_mul_f32 v225, v225, v55
    v_mul_f32 v226, v226, v55
    v_mul_f32 v227, v227, v55
    v_accvgpr_write_b32 a92, v224
    v_accvgpr_write_b32 a93, v225
    v_accvgpr_write_b32 a94, v226
    v_accvgpr_write_b32 a95, v227
    v_accvgpr_read_b32 v224, a108
    v_accvgpr_read_b32 v225, a109
    v_accvgpr_read_b32 v226, a110
    v_accvgpr_read_b32 v227, a111
    v_mul_f32 v224, v224, v55
    v_mul_f32 v225, v225, v55
    v_mul_f32 v226, v226, v55
    v_mul_f32 v227, v227, v55
    v_accvgpr_write_b32 a108, v224
    v_accvgpr_write_b32 a109, v225
    v_accvgpr_write_b32 a110, v226
    v_accvgpr_write_b32 a111, v227
    v_accvgpr_read_b32 v224, a124
    v_accvgpr_read_b32 v225, a125
    v_accvgpr_read_b32 v226, a126
    v_accvgpr_read_b32 v227, a127
    v_mul_f32 v224, v224, v55
    v_mul_f32 v225, v225, v55
    v_mul_f32 v226, v226, v55
    v_mul_f32 v227, v227, v55
    v_accvgpr_write_b32 a124, v224
    v_accvgpr_write_b32 a125, v225
    v_accvgpr_write_b32 a126, v226
    v_accvgpr_write_b32 a127, v227
    v_exp_f32 v232, v164
    v_exp_f32 v233, v165
    v_exp_f32 v234, v166
    v_exp_f32 v235, v167
    s_nop 0
    v_cvt_pk_bf16_f32 v212, v232, v233
    v_cvt_pk_bf16_f32 v213, v234, v235
    v_exp_f32 v232, v180
    v_exp_f32 v233, v181
    v_exp_f32 v234, v182
    v_exp_f32 v235, v183
    s_nop 0
    v_cvt_pk_bf16_f32 v214, v232, v233
    v_cvt_pk_bf16_f32 v215, v234, v235
    v_exp_f32 v232, v172
    v_exp_f32 v233, v173
    v_exp_f32 v234, v174
    v_exp_f32 v235, v175
    s_nop 0
    v_cvt_pk_bf16_f32 v220, v232, v233
    v_cvt_pk_bf16_f32 v221, v234, v235
    v_exp_f32 v232, v188
    v_exp_f32 v233, v189
    v_exp_f32 v234, v190
    v_exp_f32 v235, v191
    s_nop 0
    v_cvt_pk_bf16_f32 v222, v232, v233
    v_cvt_pk_bf16_f32 v223, v234, v235
    s_nop 3
    s_setpc_b64 s[40:41]
op_tail2:
.globl k4_kernel
.p2align 8
.type k4_kernel,@function
k4_kernel:
    s_cmp_ge_u32 s2, 256
    s_cbranch_scc1 k4_end_152
    s_load_dwordx8 s[4:11], s[0:1], 56
    s_load_dwordx2 s[12:13], s[0:1], 88
    s_load_dwordx2 s[14:15], s[0:1], 104
    v_lshrrev_b32 v1, 6, v0
    v_and_b32 v2, 63, v0
    v_readfirstlane_b32 s44, v1
    s_and_b32 s45, s2, 7
    s_lshr_b32 s46, s2, 3
    s_mul_i32 s45, s45, 28
    s_add_u32 s45, s45, s46
    v_and_b32 v4, 31, v2
    v_lshrrev_b32 v5, 5, v2
    v_lshlrev_b32 v7, 4, v4
    v_mov_b32 v11, 69632
    v_lshl_add_u32 v12, v2, 2, v11
    v_mov_b32 v13, 0
    ds_write_b32 v12, v13
    s_waitcnt lgkmcnt(0)
    s_barrier
    s_add_u32 s20, s14, 0x4000000
    s_addc_u32 s21, s15, 0
    s_and_b32 s21, s21, 0xffff
    s_mov_b32 s22, 0x400000
    s_mov_b32 s23, 0x00020000
    s_cmp_ge_u32 s44, 4
    s_cbranch_scc1 k4_b_153
    s_setprio 3
    s_add_u32 s16, s14, 0x4800000
    s_addc_u32 s17, s15, 0
    s_and_b32 s17, s17, 0xffff
    s_mov_b32 s18, 0x6084
    s_mov_b32 s19, 0x00020000
    v_lshlrev_b32 v3, 5, v0
    s_mov_b32 s48, 0
    buffer_load_dwordx4 v[16:19], v3, s[16:19], s48 offen
    buffer_load_dwordx4 v[20:23], v3, s[16:19], s48 offen offset:16
    s_mov_b32 s48, 8192
    buffer_load_dwordx4 v[24:27], v3, s[16:19], s48 offen
    buffer_load_dwordx4 v[28:31], v3, s[16:19], s48 offen offset:16
    s_mov_b32 s48, 16384
    buffer_load_dwordx4 v[32:35], v3, s[16:19], s48 offen
    buffer_load_dwordx4 v[36:39], v3, s[16:19], s48 offen offset:16
    s_mov_b32 s48, 24704
    buffer_load_dword v10, v13, s[16:19], s48 offen
    s_mov_b32 s32, s10
    s_and_b32 s33, s11, 0xffff
    s_mov_b32 s34, 0x700000
    s_mov_b32 s35, 0x00020000
    s_cmp_ge_u32 s2, 224
    s_cselect_b32 s34, 0, s34
    s_mov_b32 s52, 0x3a800000
    s_mov_b32 s53, 0x3a800000
    s_mov_b32 s54, 0x7ff
    v_mov_b32 v14, 0x3727c5ac
    v_mov_b32 v15, v14
    v_mov_b32 v8, 0xff800000
    v_mov_b32 v9, v8
    s_waitcnt vmcnt(0)
    v_sub_f32 v10, 0, v10
    v_mov_b32 v11, v10
    v_pk_mul_f32 v[16:17], v[16:17], s[52:53]
    v_pk_fma_f32 v[24:25], v[24:25], s[52:53], v[14:15]
    v_pk_fma_f32 v[32:33], v[16:17], v[10:11], v[32:33]
    v_pk_fma_f32 v[24:25], v[16:17], v[16:17], v[24:25] neg_lo:[1,0,0] neg_hi:[1,0,0]
    v_pk_mul_f32 v[18:19], v[18:19], s[52:53]
    v_pk_fma_f32 v[26:27], v[26:27], s[52:53], v[14:15]
    v_pk_fma_f32 v[34:35], v[18:19], v[10:11], v[34:35]
    v_pk_fma_f32 v[26:27], v[18:19], v[18:19], v[26:27] neg_lo:[1,0,0] neg_hi:[1,0,0]
    v_pk_mul_f32 v[20:21], v[20:21], s[52:53]
    v_pk_fma_f32 v[28:29], v[28:29], s[52:53], v[14:15]
    v_pk_fma_f32 v[36:37], v[20:21], v[10:11], v[36:37]
    v_pk_fma_f32 v[28:29], v[20:21], v[20:21], v[28:29] neg_lo:[1,0,0] neg_hi:[1,0,0]
    v_pk_mul_f32 v[22:23], v[22:23], s[52:53]
    v_pk_fma_f32 v[30:31], v[30:31], s[52:53], v[14:15]
    v_pk_fma_f32 v[38:39], v[22:23], v[10:11], v[38:39]
    v_pk_fma_f32 v[30:31], v[22:23], v[22:23], v[30:31] neg_lo:[1,0,0] neg_hi:[1,0,0]
    v_max_f32 v24, v14, v24
    v_max_f32 v25, v14, v25
    v_max_f32 v26, v14, v26
    v_max_f32 v27, v14, v27
    v_max_f32 v28, v14, v28
    v_max_f32 v29, v14, v29
    v_max_f32 v30, v14, v30
    v_max_f32 v31, v14, v31
    v_rsq_f32 v24, v24
    v_rsq_f32 v25, v25
    v_rsq_f32 v26, v26
    v_rsq_f32 v27, v27
    v_rsq_f32 v28, v28
    v_rsq_f32 v29, v29
    v_rsq_f32 v30, v30
    v_rsq_f32 v31, v31
    v_pk_mul_f32 v[32:33], v[32:33], v[24:25]
    v_pk_mul_f32 v[34:35], v[34:35], v[26:27]
    v_pk_mul_f32 v[36:37], v[36:37], v[28:29]
    v_pk_mul_f32 v[38:39], v[38:39], v[30:31]
    v_bfi_b32 v32, s54, 0, v32
    v_med3_f32 v9, v8, v9, v32
    v_max_f32 v8, v8, v32
    v_bfi_b32 v33, s54, 1, v33
    v_med3_f32 v9, v8, v9, v33
    v_max_f32 v8, v8, v33
    v_bfi_b32 v34, s54, 2, v34
    v_med3_f32 v9, v8, v9, v34
    v_max_f32 v8, v8, v34
    v_bfi_b32 v35, s54, 3, v35
    v_med3_f32 v9, v8, v9, v35
    v_max_f32 v8, v8, v35
    v_bfi_b32 v36, s54, 4, v36
    v_med3_f32 v9, v8, v9, v36
    v_max_f32 v8, v8, v36
    v_bfi_b32 v37, s54, 5, v37
    v_med3_f32 v9, v8, v9, v37
    v_max_f32 v8, v8, v37
    v_bfi_b32 v38, s54, 6, v38
    v_med3_f32 v9, v8, v9, v38
    v_max_f32 v8, v8, v38
    v_bfi_b32 v39, s54, 7, v39
    v_med3_f32 v9, v8, v9, v39
    v_max_f32 v8, v8, v39
    v_lshl_or_b32 v8, v0, 3, v8
    v_lshl_or_b32 v9, v0, 3, v9
    s_nop 1
    v_mov_b32_dpp v10, v8 quad_perm:[1,0,3,2] row_mask:0xf bank_mask:0xf
    v_mov_b32_dpp v11, v9 quad_perm:[1,0,3,2] row_mask:0xf bank_mask:0xf
    v_max_f32 v11, v11, v9
    v_med3_f32 v9, v8, v10, v11
    v_max_f32 v8, v8, v10
    s_nop 1
    v_mov_b32_dpp v10, v8 quad_perm:[2,3,0,1] row_mask:0xf bank_mask:0xf
    v_mov_b32_dpp v11, v9 quad_perm:[2,3,0,1] row_mask:0xf bank_mask:0xf
    v_max_f32 v11, v11, v9
    v_med3_f32 v9, v8, v10, v11
    v_max_f32 v8, v8, v10
    s_nop 1
    v_mov_b32_dpp v10, v8 row_half_mirror row_mask:0xf bank_mask:0xf
    v_mov_b32_dpp v11, v9 row_half_mirror row_mask:0xf bank_mask:0xf
    v_max_f32 v11, v11, v9
    v_med3_f32 v9, v8, v10, v11
    v_max_f32 v8, v8, v10
    s_nop 1
    v_mov_b32_dpp v10, v8 row_mirror row_mask:0xf bank_mask:0xf
    v_mov_b32_dpp v11, v9 row_mirror row_mask:0xf bank_mask:0xf
    v_max_f32 v11, v11, v9
    v_med3_f32 v9, v8, v10, v11
    v_max_f32 v8, v8, v10
    v_mov_b32 v10, v8
    v_mov_b32 v11, v9
    s_nop 1
    v_permlane16_swap_b32 v8, v10
    v_permlane16_swap_b32 v9, v11
    s_nop 1
    v_max_f32 v11, v11, v9
    v_med3_f32 v9, v8, v10, v11
    v_max_f32 v8, v8, v10
    v_mov_b32 v10, v8
    v_mov_b32 v11, v9
    s_nop 1
    v_permlane32_swap_b32 v8, v10
    v_permlane32_swap_b32 v9, v11
    s_nop 1
    v_max_f32 v11, v11, v9
    v_med3_f32 v9, v8, v10, v11
    v_max_f32 v8, v8, v10
    v_mov_b32 v10, 1
    v_mov_b32 v11, 1
    v_lshlrev_b32 v12, 4, v1
    v_add_u32 v12, 69632, v12
    ds_write_b128 v12, v[8:11]
    v_mov_b32 v12, 69632
k4_mail_157:
    ds_read_b128 v[16:19], v12 offset:0
    ds_read_b128 v[20:23], v12 offset:16
    ds_read_b128 v[24:27], v12 offset:32
    ds_read_b128 v[28:31], v12 offset:48
    s_waitcnt lgkmcnt(0)
    v_and_b32 v10, v18, v22
    v_and_b32 v11, v26, v30
    v_and_b32 v10, v10, v11
    v_cmp_eq_u32 vcc, 0, v10
    s_cbranch_vccnz k4_mail_157
    v_max_f32 v21, v21, v17
    v_med3_f32 v17, v16, v20, v21
    v_max_f32 v16, v16, v20
    v_max_f32 v29, v29, v25
    v_med3_f32 v25, v24, v28, v29
    v_max_f32 v24, v24, v28
    v_max_f32 v25, v25, v17
    v_med3_f32 v17, v16, v24, v25
    v_max_f32 v16, v16, v24
    v_cmp_eq_u32 vcc, 0, v5
    s_lshl_b32 s52, s45, 15
    v_lshlrev_b32 v9, 3, v0
    v_cndmask_b32 v11, v17, v16, vcc
    v_and_b32 v15, 0x7ff, v11
    v_lshl_add_u32 v11, v15, 11, v7
    buffer_load_dwordx4 v[40:43], v11, s[20:23], 0 offen offset:0
    buffer_load_dwordx4 v[44:47], v11, s[20:23], 0 offen offset:512
    buffer_load_dwordx4 v[48:51], v11, s[20:23], 0 offen offset:1024
    buffer_load_dwordx4 v[52:55], v11, s[20:23], 0 offen offset:1536
    buffer_load_dwordx2 v[88:89], v9, s[32:35], s52 offen offset:0
    buffer_load_dwordx2 v[90:91], v9, s[32:35], s52 offen offset:2048
    s_add_u32 s52, s52, 4096
    buffer_load_dwordx2 v[92:93], v9, s[32:35], s52 offen offset:0
    buffer_load_dwordx2 v[94:95], v9, s[32:35], s52 offen offset:2048
    s_add_u32 s52, s52, 4096
    buffer_load_dwordx2 v[96:97], v9, s[32:35], s52 offen offset:0
    buffer_load_dwordx2 v[98:99], v9, s[32:35], s52 offen offset:2048
    s_add_u32 s52, s52, 4096
    buffer_load_dwordx2 v[100:101], v9, s[32:35], s52 offen offset:0
    buffer_load_dwordx2 v[102:103], v9, s[32:35], s52 offen offset:2048
    s_add_u32 s52, s52, 4096
    buffer_load_dwordx2 v[104:105], v9, s[32:35], s52 offen offset:0
    buffer_load_dwordx2 v[106:107], v9, s[32:35], s52 offen offset:2048
    s_add_u32 s52, s52, 4096
    buffer_load_dwordx2 v[108:109], v9, s[32:35], s52 offen offset:0
    buffer_load_dwordx2 v[110:111], v9, s[32:35], s52 offen offset:2048
    s_add_u32 s52, s52, 4096
    buffer_load_dwordx2 v[112:113], v9, s[32:35], s52 offen offset:0
    buffer_load_dwordx2 v[114:115], v9, s[32:35], s52 offen offset:2048
    s_add_u32 s52, s52, 4096
    buffer_load_dwordx2 v[116:117], v9, s[32:35], s52 offen offset:0
    buffer_load_dwordx2 v[118:119], v9, s[32:35], s52 offen offset:2048
    s_add_u32 s52, s52, 4096
    s_waitcnt vmcnt(16)
k4_ln_154:
    v_lshlrev_b32 v200, 16, v40
    v_and_b32 v201, 0xffff0000, v40
    v_lshlrev_b32 v202, 16, v41
    v_and_b32 v203, 0xffff0000, v41
    v_lshlrev_b32 v204, 16, v42
    v_and_b32 v205, 0xffff0000, v42
    v_lshlrev_b32 v206, 16, v43
    v_and_b32 v207, 0xffff0000, v43
    v_lshlrev_b32 v208, 16, v44
    v_and_b32 v209, 0xffff0000, v44
    v_lshlrev_b32 v210, 16, v45
    v_and_b32 v211, 0xffff0000, v45
    v_lshlrev_b32 v212, 16, v46
    v_and_b32 v213, 0xffff0000, v46
    v_lshlrev_b32 v214, 16, v47
    v_and_b32 v215, 0xffff0000, v47
    v_lshlrev_b32 v216, 16, v48
    v_and_b32 v217, 0xffff0000, v48
    v_lshlrev_b32 v218, 16, v49
    v_and_b32 v219, 0xffff0000, v49
    v_lshlrev_b32 v220, 16, v50
    v_and_b32 v221, 0xffff0000, v50
    v_lshlrev_b32 v222, 16, v51
    v_and_b32 v223, 0xffff0000, v51
    v_lshlrev_b32 v224, 16, v52
    v_and_b32 v225, 0xffff0000, v52
    v_lshlrev_b32 v226, 16, v53
    v_and_b32 v227, 0xffff0000, v53
    v_lshlrev_b32 v228, 16, v54
    v_and_b32 v229, 0xffff0000, v54
    v_lshlrev_b32 v230, 16, v55
    v_and_b32 v231, 0xffff0000, v55
    v_pk_add_f32 v[192:193], v[200:201], v[202:203]
    v_pk_add_f32 v[194:195], v[204:205], v[206:207]
    v_pk_add_f32 v[192:193], v[192:193], v[208:209]
    v_pk_add_f32 v[194:195], v[194:195], v[210:211]
    v_pk_add_f32 v[192:193], v[192:193], v[212:213]
    v_pk_add_f32 v[194:195], v[194:195], v[214:215]
    v_pk_add_f32 v[192:193], v[192:193], v[216:217]
    v_pk_add_f32 v[194:195], v[194:195], v[218:219]
    v_pk_add_f32 v[192:193], v[192:193], v[220:221]
    v_pk_add_f32 v[194:195], v[194:195], v[222:223]
    v_pk_add_f32 v[192:193], v[192:193], v[224:225]
    v_pk_add_f32 v[194:195], v[194:195], v[226:227]
    v_pk_add_f32 v[192:193], v[192:193], v[228:229]
    v_pk_add_f32 v[194:195], v[194:195], v[230:231]
    v_pk_add_f32 v[192:193], v[192:193], v[194:195]
    v_add_f32 v192, v192, v193
    s_nop 1
    v_add_f32_dpp v192, v192, v192 quad_perm:[1,0,3,2] row_mask:0xf bank_mask:0xf
    s_nop 1
    v_add_f32_dpp v192, v192, v192 quad_perm:[2,3,0,1] row_mask:0xf bank_mask:0xf
    s_nop 1
    v_add_f32_dpp v192, v192, v192 row_half_mirror row_mask:0xf bank_mask:0xf
    s_nop 1
    v_add_f32_dpp v192, v192, v192 row_mirror row_mask:0xf bank_mask:0xf
    v_mov_b32 v194, v192
    s_nop 1
    v_permlane16_swap_b32 v192, v194
    s_nop 1
    v_add_f32 v192, v192, v194
    v_mul_f32 v192, 0xba800000, v192
    v_mov_b32 v193, v192
    v_pk_add_f32 v[194:195], v[200:201], v[192:193]
    v_pk_add_f32 v[198:199], v[202:203], v[192:193]
    v_pk_mul_f32 v[196:197], v[194:195], v[194:195]
    v_pk_fma_f32 v[196:197], v[198:199], v[198:199], v[196:197]
    v_pk_add_f32 v[194:195], v[204:205], v[192:193]
    v_pk_add_f32 v[198:199], v[206:207], v[192:193]
    v_pk_fma_f32 v[196:197], v[194:195], v[194:195], v[196:197]
    v_pk_fma_f32 v[196:197], v[198:199], v[198:199], v[196:197]
    v_pk_add_f32 v[194:195], v[208:209], v[192:193]
    v_pk_add_f32 v[198:199], v[210:211], v[192:193]
    v_pk_fma_f32 v[196:197], v[194:195], v[194:195], v[196:197]
    v_pk_fma_f32 v[196:197], v[198:199], v[198:199], v[196:197]
    v_pk_add_f32 v[194:195], v[212:213], v[192:193]
    v_pk_add_f32 v[198:199], v[214:215], v[192:193]
    v_pk_fma_f32 v[196:197], v[194:195], v[194:195], v[196:197]
    v_pk_fma_f32 v[196:197], v[198:199], v[198:199], v[196:197]
    v_pk_add_f32 v[194:195], v[216:217], v[192:193]
    v_pk_add_f32 v[198:199], v[218:219], v[192:193]
    v_pk_fma_f32 v[196:197], v[194:195], v[194:195], v[196:197]
    v_pk_fma_f32 v[196:197], v[198:199], v[198:199], v[196:197]
    v_pk_add_f32 v[194:195], v[220:221], v[192:193]
    v_pk_add_f32 v[198:199], v[222:223], v[192:193]
    v_pk_fma_f32 v[196:197], v[194:195], v[194:195], v[196:197]
    v_pk_fma_f32 v[196:197], v[198:199], v[198:199], v[196:197]
    v_pk_add_f32 v[194:195], v[224:225], v[192:193]
    v_pk_add_f32 v[198:199], v[226:227], v[192:193]
    v_pk_fma_f32 v[196:197], v[194:195], v[194:195], v[196:197]
    v_pk_fma_f32 v[196:197], v[198:199], v[198:199], v[196:197]
    v_pk_add_f32 v[194:195], v[228:229], v[192:193]
    v_pk_add_f32 v[198:199], v[230:231], v[192:193]
    v_pk_fma_f32 v[196:197], v[194:195], v[194:195], v[196:197]
    v_pk_fma_f32 v[196:197], v[198:199], v[198:199], v[196:197]
    v_add_f32 v196, v196, v197
    s_nop 1
    v_add_f32_dpp v196, v196, v196 quad_perm:[1,0,3,2] row_mask:0xf bank_mask:0xf
    s_nop 1
    v_add_f32_dpp v196, v196, v196 quad_perm:[2,3,0,1] row_mask:0xf bank_mask:0xf
    s_nop 1
    v_add_f32_dpp v196, v196, v196 row_half_mirror row_mask:0xf bank_mask:0xf
    s_nop 1
    v_add_f32_dpp v196, v196, v196 row_mirror row_mask:0xf bank_mask:0xf
    v_mov_b32 v194, v196
    s_nop 1
    v_permlane16_swap_b32 v196, v194
    s_nop 1
    v_add_f32 v196, v196, v194
    v_mul_f32 v196, 0x3a800000, v196
    v_cvt_pk_bf16_f32 v198, v192, v196
    v_and_b32 v196, 0xffff0000, v198
    v_lshlrev_b32 v198, 16, v198
    v_add_f32 v196, 0x3727c5ac, v196
    v_mov_b32 v199, v198
    v_cvt_pk_bf16_f32 v196, v196, v196
    v_and_b32 v196, 0xffff0000, v196
    v_sqrt_f32 v196, v196
    v_pk_add_f32 v[160:161], v[200:201], v[198:199]
    v_pk_add_f32 v[162:163], v[202:203], v[198:199]
    v_pk_add_f32 v[164:165], v[204:205], v[198:199]
    v_pk_add_f32 v[166:167], v[206:207], v[198:199]
    v_pk_add_f32 v[168:169], v[208:209], v[198:199]
    v_pk_add_f32 v[170:171], v[210:211], v[198:199]
    v_pk_add_f32 v[172:173], v[212:213], v[198:199]
    v_pk_add_f32 v[174:175], v[214:215], v[198:199]
    v_pk_add_f32 v[176:177], v[216:217], v[198:199]
    v_pk_add_f32 v[178:179], v[218:219], v[198:199]
    v_pk_add_f32 v[180:181], v[220:221], v[198:199]
    v_pk_add_f32 v[182:183], v[222:223], v[198:199]
    v_pk_add_f32 v[184:185], v[224:225], v[198:199]
    v_pk_add_f32 v[186:187], v[226:227], v[198:199]
    v_pk_add_f32 v[188:189], v[228:229], v[198:199]
    v_pk_add_f32 v[190:191], v[230:231], v[198:199]
    v_cvt_pk_bf16_f32 v196, v196, v196
    v_and_b32 v196, 0xffff0000, v196
    v_rcp_f32 v196, v196
    v_cvt_pk_bf16_f32 v40, v160, v161
    v_cvt_pk_bf16_f32 v41, v162, v163
    v_cvt_pk_bf16_f32 v42, v164, v165
    v_cvt_pk_bf16_f32 v43, v166, v167
    v_cvt_pk_bf16_f32 v44, v168, v169
    v_cvt_pk_bf16_f32 v45, v170, v171
    v_cvt_pk_bf16_f32 v46, v172, v173
    v_cvt_pk_bf16_f32 v47, v174, v175
    v_cvt_pk_bf16_f32 v48, v176, v177
    v_cvt_pk_bf16_f32 v49, v178, v179
    v_cvt_pk_bf16_f32 v50, v180, v181
    v_cvt_pk_bf16_f32 v51, v182, v183
    v_cvt_pk_bf16_f32 v52, v184, v185
    v_cvt_pk_bf16_f32 v53, v186, v187
    v_cvt_pk_bf16_f32 v54, v188, v189
    v_cvt_pk_bf16_f32 v55, v190, v191
    v_mov_b32 v197, v196
    v_lshlrev_b32 v160, 16, v40
    v_and_b32 v161, 0xffff0000, v40
    v_lshlrev_b32 v162, 16, v41
    v_and_b32 v163, 0xffff0000, v41
    v_lshlrev_b32 v164, 16, v42
    v_and_b32 v165, 0xffff0000, v42
    v_lshlrev_b32 v166, 16, v43
    v_and_b32 v167, 0xffff0000, v43
    v_lshlrev_b32 v168, 16, v44
    v_and_b32 v169, 0xffff0000, v44
    v_lshlrev_b32 v170, 16, v45
    v_and_b32 v171, 0xffff0000, v45
    v_lshlrev_b32 v172, 16, v46
    v_and_b32 v173, 0xffff0000, v46
    v_lshlrev_b32 v174, 16, v47
    v_and_b32 v175, 0xffff0000, v47
    v_lshlrev_b32 v176, 16, v48
    v_and_b32 v177, 0xffff0000, v48
    v_lshlrev_b32 v178, 16, v49
    v_and_b32 v179, 0xffff0000, v49
    v_lshlrev_b32 v180, 16, v50
    v_and_b32 v181, 0xffff0000, v50
    v_lshlrev_b32 v182, 16, v51
    v_and_b32 v183, 0xffff0000, v51
    v_lshlrev_b32 v184, 16, v52
    v_and_b32 v185, 0xffff0000, v52
    v_lshlrev_b32 v186, 16, v53
    v_and_b32 v187, 0xffff0000, v53
    v_lshlrev_b32 v188, 16, v54
    v_and_b32 v189, 0xffff0000, v54
    v_lshlrev_b32 v190, 16, v55
    v_and_b32 v191, 0xffff0000, v55
    v_pk_mul_f32 v[160:161], v[160:161], v[196:197]
    v_pk_mul_f32 v[162:163], v[162:163], v[196:197]
    v_pk_mul_f32 v[164:165], v[164:165], v[196:197]
    v_pk_mul_f32 v[166:167], v[166:167], v[196:197]
    v_pk_mul_f32 v[168:169], v[168:169], v[196:197]
    v_pk_mul_f32 v[170:171], v[170:171], v[196:197]
    v_pk_mul_f32 v[172:173], v[172:173], v[196:197]
    v_pk_mul_f32 v[174:175], v[174:175], v[196:197]
    v_pk_mul_f32 v[176:177], v[176:177], v[196:197]
    v_pk_mul_f32 v[178:179], v[178:179], v[196:197]
    v_pk_mul_f32 v[180:181], v[180:181], v[196:197]
    v_pk_mul_f32 v[182:183], v[182:183], v[196:197]
    v_pk_mul_f32 v[184:185], v[184:185], v[196:197]
    v_pk_mul_f32 v[186:187], v[186:187], v[196:197]
    v_pk_mul_f32 v[188:189], v[188:189], v[196:197]
    v_pk_mul_f32 v[190:191], v[190:191], v[196:197]
    v_cvt_pk_bf16_f32 v40, v160, v161
    v_cvt_pk_bf16_f32 v41, v162, v163
    v_cvt_pk_bf16_f32 v42, v164, v165
    v_cvt_pk_bf16_f32 v43, v166, v167
    v_cvt_pk_bf16_f32 v44, v168, v169
    v_cvt_pk_bf16_f32 v45, v170, v171
    v_cvt_pk_bf16_f32 v46, v172, v173
    v_cvt_pk_bf16_f32 v47, v174, v175
    v_cvt_pk_bf16_f32 v48, v176, v177
    v_cvt_pk_bf16_f32 v49, v178, v179
    v_cvt_pk_bf16_f32 v50, v180, v181
    v_cvt_pk_bf16_f32 v51, v182, v183
    v_cvt_pk_bf16_f32 v52, v184, v185
    v_cvt_pk_bf16_f32 v53, v186, v187
    v_cvt_pk_bf16_f32 v54, v188, v189
    v_cvt_pk_bf16_f32 v55, v190, v191
    s_cmp_ge_u32 s44, 4
    s_cbranch_scc1 k4_bout_156
    v_lshl_add_u32 v11, v5, 11, v7
    v_add_u32 v12, 65536, v11
    ds_write_b128 v12, v[40:43] offset:0
    ds_write_b128 v12, v[44:47] offset:512
    ds_write_b128 v12, v[48:51] offset:1024
    ds_write_b128 v12, v[52:55] offset:1536
    v_lshlrev_b32 v12, 2, v5
    v_add_u32 v12, 69760, v12
    ds_write_b32 v12, v15
    s_mov_b32 s54, 0x05040100
    s_mov_b32 s55, 0x07060302
    s_waitcnt vmcnt(0)
    v_perm_b32 v56, v90, v88, s54
    v_perm_b32 v57, v90, v88, s55
    v_perm_b32 v58, v91, v89, s54
    v_perm_b32 v59, v91, v89, s55
    v_perm_b32 v60, v94, v92, s54
    v_perm_b32 v61, v94, v92, s55
    v_perm_b32 v62, v95, v93, s54
    v_perm_b32 v63, v95, v93, s55
    v_perm_b32 v64, v98, v96, s54
    v_perm_b32 v65, v98, v96, s55
    v_perm_b32 v66, v99, v97, s54
    v_perm_b32 v67, v99, v97, s55
    v_perm_b32 v68, v102, v100, s54
    v_perm_b32 v69, v102, v100, s55
    v_perm_b32 v70, v103, v101, s54
    v_perm_b32 v71, v103, v101, s55
    v_perm_b32 v72, v106, v104, s54
    v_perm_b32 v73, v106, v104, s55
    v_perm_b32 v74, v107, v105, s54
    v_perm_b32 v75, v107, v105, s55
    v_perm_b32 v76, v110, v108, s54
    v_perm_b32 v77, v110, v108, s55
    v_perm_b32 v78, v111, v109, s54
    v_perm_b32 v79, v111, v109, s55
    v_perm_b32 v80, v114, v112, s54
    v_perm_b32 v81, v114, v112, s55
    v_perm_b32 v82, v115, v113, s54
    v_perm_b32 v83, v115, v113, s55
    v_perm_b32 v84, v118, v116, s54
    v_perm_b32 v85, v118, v116, s55
    v_perm_b32 v86, v119, v117, s54
    v_perm_b32 v87, v119, v117, s55
    s_add_u32 s56, s14, 0x4900000
    s_addc_u32 s57, s15, 0
    s_and_b32 s57, s57, 0xffff
    s_mov_b32 s58, 0x1c0000
    s_mov_b32 s59, 0x00020000
    s_add_u32 s60, s14, 0x480f000
    s_addc_u32 s61, s15, 0
    s_and_b32 s61, s61, 0xffff
    s_mov_b32 s62, 0x2000
    s_mov_b32 s63, 0x00020000
    s_waitcnt lgkmcnt(0)
k4_mm_155:
    s_barrier
    s_cmp_ge_u32 s2, 224
    s_cbranch_scc1 k4_red_158
    v_lshrrev_b32 v12, 4, v2
    v_and_b32 v13, 1, v2
    v_lshlrev_b32 v13, 11, v13
    v_lshl_add_u32 v13, v12, 3, v13
    s_lshl_b32 s54, s44, 8
    s_add_u32 s54, s54, 65536
    v_add_u32 v13, s54, v13
    v_lshlrev_b32 v14, 3, v2
    s_lshl_b32 s54, s44, 12
    v_add_u32 v14, s54, v14
    ds_read_b64 v[128:129], v13 offset:0
    ds_read_b64 v[130:131], v13 offset:32
    ds_read_b64_tr_b16 v[144:145], v14 offset:0
    ds_read_b64_tr_b16 v[146:147], v14 offset:512
    ds_read_b64_tr_b16 v[160:161], v14 offset:32768
    ds_read_b64_tr_b16 v[162:163], v14 offset:33280
    ds_read_b64 v[132:133], v13 offset:64
    ds_read_b64 v[134:135], v13 offset:96
    ds_read_b64_tr_b16 v[148:149], v14 offset:1024
    ds_read_b64_tr_b16 v[150:151], v14 offset:1536
    ds_read_b64_tr_b16 v[164:165], v14 offset:33792
    ds_read_b64_tr_b16 v[166:167], v14 offset:34304
    ds_read_b64 v[136:137], v13 offset:128
    ds_read_b64 v[138:139], v13 offset:160
    ds_read_b64_tr_b16 v[152:153], v14 offset:2048
    ds_read_b64_tr_b16 v[154:155], v14 offset:2560
    ds_read_b64_tr_b16 v[168:169], v14 offset:34816
    ds_read_b64_tr_b16 v[170:171], v14 offset:35328
    ds_read_b64 v[140:141], v13 offset:192
    ds_read_b64 v[142:143], v13 offset:224
    ds_read_b64_tr_b16 v[156:157], v14 offset:3072
    ds_read_b64_tr_b16 v[158:159], v14 offset:3584
    ds_read_b64_tr_b16 v[172:173], v14 offset:35840
    ds_read_b64_tr_b16 v[174:175], v14 offset:36352
    v_and_b32 v13, 15, v2
    v_lshlrev_b32 v13, 6, v13
    v_lshl_add_u32 v13, v12, 4, v13
    s_lshl_b32 s54, s44, 11
    s_add_u32 s54, s54, 69888
    v_add_u32 v13, s54, v13
    s_waitcnt lgkmcnt(0)
    v_mfma_f32_16x16x32_bf16 v[16:19], v[144:147], v[128:131], 0
    v_mfma_f32_16x16x32_bf16 v[20:23], v[160:163], v[128:131], 0
    v_mfma_f32_16x16x32_bf16 v[16:19], v[148:151], v[132:135], v[16:19]
    v_mfma_f32_16x16x32_bf16 v[20:23], v[164:167], v[132:135], v[20:23]
    v_mfma_f32_16x16x32_bf16 v[16:19], v[152:155], v[136:139], v[16:19]
    v_mfma_f32_16x16x32_bf16 v[20:23], v[168:171], v[136:139], v[20:23]
    v_mfma_f32_16x16x32_bf16 v[16:19], v[156:159], v[140:143], v[16:19]
    v_mfma_f32_16x16x32_bf16 v[20:23], v[172:175], v[140:143], v[20:23]
    s_nop 7
    ds_write_b128 v13, v[16:19]
    ds_write_b128 v13, v[20:23] offset:1024
    s_waitcnt lgkmcnt(0)
    s_barrier
    s_cmp_ge_u32 s44, 4
    s_cbranch_scc1 k4_ln_154
    v_lshlrev_b32 v13, 2, v4
    v_add_u32 v13, 69888, v13
    ds_read2st64_b32 v[16:17], v13 offset0:0 offset1:4
    ds_read2st64_b32 v[18:19], v13 offset0:8 offset1:12
    ds_read2st64_b32 v[20:21], v13 offset0:16 offset1:20
    ds_read2st64_b32 v[22:23], v13 offset0:24 offset1:28
    ds_read2st64_b32 v[24:25], v13 offset0:32 offset1:36
    ds_read2st64_b32 v[26:27], v13 offset0:40 offset1:44
    ds_read2st64_b32 v[28:29], v13 offset0:48 offset1:52
    ds_read2st64_b32 v[30:31], v13 offset0:56 offset1:60
    s_waitcnt lgkmcnt(0)
    v_pk_add_f32 v[16:17], v[16:17], v[24:25]
    v_pk_add_f32 v[18:19], v[18:19], v[26:27]
    v_pk_add_f32 v[20:21], v[20:21], v[28:29]
    v_pk_add_f32 v[22:23], v[22:23], v[30:31]
    v_pk_add_f32 v[16:17], v[16:17], v[20:21]
    v_pk_add_f32 v[18:19], v[18:19], v[22:23]
    v_pk_add_f32 v[16:17], v[16:17], v[18:19]
    v_cvt_pk_bf16_f32 v16, v16, v17
    v_and_b32 v20, 0xffff0000, v16
    v_lshlrev_b32 v16, 16, v16
    v_mul_f32 v17, 0xbfb8aa3b, v16
    v_exp_f32 v17, v17
    s_lshl_b32 s54, s45, 13
    v_add_f32 v17, 1.0, v17
    v_rcp_f32 v17, v17
    s_add_u32 s55, s54, 4096
    v_mul_f32 v16, v16, v17
    v_cvt_pk_bf16_f32 v16, v16, v16
    v_and_b32 v16, 0xffff0000, v16
    v_mul_f32 v16, v16, v20
    s_nop 1
    v_mov_b32_dpp v17, v16 quad_perm:[1,0,3,2] row_mask:0xf bank_mask:0xf
    v_cvt_pk_bf16_f32 v16, v16, v17
    v_lshlrev_b32 v13, 4, v0
    v_readlane_b32 s24, v16, 0
    v_readlane_b32 s25, v16, 2
    v_readlane_b32 s26, v16, 4
    v_readlane_b32 s27, v16, 6
    v_readlane_b32 s28, v16, 8
    v_readlane_b32 s29, v16, 10
    v_readlane_b32 s30, v16, 12
    v_readlane_b32 s31, v16, 14
    v_readlane_b32 s32, v16, 16
    v_readlane_b32 s33, v16, 18
    v_readlane_b32 s34, v16, 20
    v_readlane_b32 s35, v16, 22
    v_readlane_b32 s36, v16, 24
    v_readlane_b32 s37, v16, 26
    v_readlane_b32 s38, v16, 28
    v_readlane_b32 s39, v16, 30
    v_dot2_f32_bf16 v24, v56, s24, 0
    v_dot2_f32_bf16 v25, v57, s24, 0
    v_dot2_f32_bf16 v26, v58, s24, 0
    v_dot2_f32_bf16 v27, v59, s24, 0
    v_dot2_f32_bf16 v24, v60, s25, v24
    v_dot2_f32_bf16 v25, v61, s25, v25
    v_dot2_f32_bf16 v26, v62, s25, v26
    v_dot2_f32_bf16 v27, v63, s25, v27
    v_dot2_f32_bf16 v24, v64, s26, v24
    v_dot2_f32_bf16 v25, v65, s26, v25
    v_dot2_f32_bf16 v26, v66, s26, v26
    v_dot2_f32_bf16 v27, v67, s26, v27
    v_dot2_f32_bf16 v24, v68, s27, v24
    v_dot2_f32_bf16 v25, v69, s27, v25
    v_dot2_f32_bf16 v26, v70, s27, v26
    v_dot2_f32_bf16 v27, v71, s27, v27
    v_dot2_f32_bf16 v24, v72, s28, v24
    v_dot2_f32_bf16 v25, v73, s28, v25
    v_dot2_f32_bf16 v26, v74, s28, v26
    v_dot2_f32_bf16 v27, v75, s28, v27
    v_dot2_f32_bf16 v24, v76, s29, v24
    v_dot2_f32_bf16 v25, v77, s29, v25
    v_dot2_f32_bf16 v26, v78, s29, v26
    v_dot2_f32_bf16 v27, v79, s29, v27
    v_dot2_f32_bf16 v24, v80, s30, v24
    v_dot2_f32_bf16 v25, v81, s30, v25
    v_dot2_f32_bf16 v26, v82, s30, v26
    v_dot2_f32_bf16 v27, v83, s30, v27
    v_dot2_f32_bf16 v24, v84, s31, v24
    v_dot2_f32_bf16 v25, v85, s31, v25
    v_dot2_f32_bf16 v26, v86, s31, v26
    v_dot2_f32_bf16 v27, v87, s31, v27
    v_dot2_f32_bf16 v28, v56, s32, 0
    v_dot2_f32_bf16 v29, v57, s32, 0
    v_dot2_f32_bf16 v30, v58, s32, 0
    v_dot2_f32_bf16 v31, v59, s32, 0
    v_dot2_f32_bf16 v28, v60, s33, v28
    v_dot2_f32_bf16 v29, v61, s33, v29
    v_dot2_f32_bf16 v30, v62, s33, v30
    v_dot2_f32_bf16 v31, v63, s33, v31
    v_dot2_f32_bf16 v28, v64, s34, v28
    v_dot2_f32_bf16 v29, v65, s34, v29
    v_dot2_f32_bf16 v30, v66, s34, v30
    v_dot2_f32_bf16 v31, v67, s34, v31
    v_dot2_f32_bf16 v28, v68, s35, v28
    v_dot2_f32_bf16 v29, v69, s35, v29
    v_dot2_f32_bf16 v30, v70, s35, v30
    v_dot2_f32_bf16 v31, v71, s35, v31
    v_dot2_f32_bf16 v28, v72, s36, v28
    v_dot2_f32_bf16 v29, v73, s36, v29
    v_dot2_f32_bf16 v30, v74, s36, v30
    v_dot2_f32_bf16 v31, v75, s36, v31
    v_dot2_f32_bf16 v28, v76, s37, v28
    v_dot2_f32_bf16 v29, v77, s37, v29
    v_dot2_f32_bf16 v30, v78, s37, v30
    v_dot2_f32_bf16 v31, v79, s37, v31
    v_dot2_f32_bf16 v28, v80, s38, v28
    v_dot2_f32_bf16 v29, v81, s38, v29
    v_dot2_f32_bf16 v30, v82, s38, v30
    v_dot2_f32_bf16 v31, v83, s38, v31
    v_dot2_f32_bf16 v28, v84, s39, v28
    v_dot2_f32_bf16 v29, v85, s39, v29
    v_dot2_f32_bf16 v30, v86, s39, v30
    v_dot2_f32_bf16 v31, v87, s39, v31
    s_and_b32 s52, s45, 15
    s_lshl_b32 s53, s44, 4
    s_add_u32 s52, s52, s53
    s_lshl_b32 s52, s52, 7
    buffer_store_dwordx4 v[24:27], v13, s[56:59], s54 offen sc1
    buffer_store_dwordx4 v[28:31], v13, s[56:59], s55 offen sc1
    v_mov_b32 v12, 0
    v_mov_b32 v13, 1
    s_mov_b64 exec, 1
    s_waitcnt vmcnt(0)
    buffer_atomic_add v13, v12, s[60:63], s52 offen sc1
    s_mov_b64 exec, -1
    s_endpgm
k4_red_158:
    s_cmp_ge_u32 s44, 4
    s_cbranch_scc1 k4_ln_154
    s_sub_u32 s40, s2, 224
    s_lshr_b32 s41, s40, 4
    s_and_b32 s42, s40, 15
    s_mov_b32 s24, s4
    s_and_b32 s25, s5, 0xffff
    s_mov_b32 s26, 0x800
    s_mov_b32 s27, 0x00020000
    s_mov_b32 s28, s12
    s_and_b32 s29, s13, 0xffff
    s_mov_b32 s30, 0x400000
    s_mov_b32 s31, 0x00020000
    buffer_load_dwordx4 v[56:59], v7, s[24:27], 0 offen offset:0
    buffer_load_dwordx4 v[60:63], v7, s[24:27], 0 offen offset:512
    buffer_load_dwordx4 v[64:67], v7, s[24:27], 0 offen offset:1024
    buffer_load_dwordx4 v[68:71], v7, s[24:27], 0 offen offset:1536
    s_lshl_b32 s43, s41, 5
    v_readlane_b32 s46, v15, s43
    v_and_b32 v8, 15, v0
    s_lshl_b32 s47, s42, 7
    v_lshl_add_u32 v9, v8, 3, s47
    s_lshl_b32 s46, s46, 11
    s_lshl_b32 s48, s41, 11
    s_add_u32 s48, s48, 65536
    v_add_u32 v12, s48, v9
    ds_read_b64 v[72:73], v12
    buffer_load_dwordx2 v[74:75], v9, s[20:23], s46 offen
    v_lshrrev_b32 v10, 4, v0
    v_lshlrev_b32 v10, 13, v10
    v_lshl_add_u32 v10, v8, 4, v10
    s_lshl_b32 s49, s40, 8
    s_waitcnt vmcnt(1)
    v_dot2_f32_bf16 v12, v40, v56, 0
    v_dot2_f32_bf16 v12, v41, v57, v12
    v_dot2_f32_bf16 v12, v42, v58, v12
    v_dot2_f32_bf16 v12, v43, v59, v12
    v_dot2_f32_bf16 v12, v44, v60, v12
    v_dot2_f32_bf16 v12, v45, v61, v12
    v_dot2_f32_bf16 v12, v46, v62, v12
    v_dot2_f32_bf16 v12, v47, v63, v12
    v_dot2_f32_bf16 v12, v48, v64, v12
    v_dot2_f32_bf16 v12, v49, v65, v12
    v_dot2_f32_bf16 v12, v50, v66, v12
    v_dot2_f32_bf16 v12, v51, v67, v12
    v_dot2_f32_bf16 v12, v52, v68, v12
    v_dot2_f32_bf16 v12, v53, v69, v12
    v_dot2_f32_bf16 v12, v54, v70, v12
    v_dot2_f32_bf16 v12, v55, v71, v12
    s_nop 2
    s_nop 1
    v_add_f32_dpp v12, v12, v12 quad_perm:[1,0,3,2] row_mask:0xf bank_mask:0xf
    s_nop 1
    v_add_f32_dpp v12, v12, v12 quad_perm:[2,3,0,1] row_mask:0xf bank_mask:0xf
    s_nop 1
    v_add_f32_dpp v12, v12, v12 row_half_mirror row_mask:0xf bank_mask:0xf
    s_nop 1
    v_add_f32_dpp v12, v12, v12 row_mirror row_mask:0xf bank_mask:0xf
    v_mov_b32 v13, v12
    s_nop 1
    v_permlane16_swap_b32 v12, v13
    s_nop 1
    v_add_f32 v12, v12, v13
    v_cvt_pk_bf16_f32 v12, v12, v12
    v_and_b32 v12, 0xffff0000, v12
    v_mul_f32 v12, 0xbfb8aa3b, v12
    v_exp_f32 v12, v12
    v_mov_b32 v3, v8
    v_add_f32 v12, 1.0, v12
    v_rcp_f32 v12, v12
    s_lshr_b32 s50, s42, 2
    v_cvt_pk_bf16_f32 v12, v12, v12
    v_and_b32 v12, 0xffff0000, v12
    s_lshl_b32 s50, s50, 11
    v_readlane_b32 s51, v12, s43
    v_lshlrev_b32 v3, 7, v3
    s_mov_b32 s47, s49
    s_mov_b32 s30, 0
    s_mov_b32 s58, 0
    s_branch k4_go_159
k4_again_161:
    s_mov_b32 s49, s47
    s_mov_b32 s30, 0x400000
    s_mov_b32 s58, 1835008
    s_cmp_lg_u32 s44, 0
    s_cbranch_scc1 k4_go_159
    s_mov_b32 s52, 1048576
k4_poll_160:
    s_sleep 8
    buffer_load_dword v13, v3, s[60:63], s50 offen sc1
    s_sub_u32 s52, s52, 1
    s_cbranch_scc1 k4_go_159
    s_waitcnt vmcnt(0)
    v_cmp_gt_u32 vcc, 14, v13
    s_cbranch_vccnz k4_poll_160
k4_go_159:
    s_barrier
    buffer_load_dwordx4 v[76:79], v10, s[56:59], s49 offen sc1
    s_add_u32 s49, s49, 0x20000
    buffer_load_dwordx4 v[80:83], v10, s[56:59], s49 offen sc1
    s_add_u32 s49, s49, 0x20000
    buffer_load_dwordx4 v[84:87], v10, s[56:59], s49 offen sc1
    s_add_u32 s49, s49, 0x20000
    buffer_load_dwordx4 v[88:91], v10, s[56:59], s49 offen sc1
    s_add_u32 s49, s49, 0x20000
    buffer_load_dwordx4 v[92:95], v10, s[56:59], s49 offen sc1
    s_add_u32 s49, s49, 0x20000
    buffer_load_dwordx4 v[96:99], v10, s[56:59], s49 offen sc1
    s_add_u32 s49, s49, 0x20000
    buffer_load_dwordx4 v[100:103], v10, s[56:59], s49 offen sc1
    s_add_u32 s49, s49, 0x20000
    buffer_load_dwordx4 v[104:107], v10, s[56:59], s49 offen sc1
    s_add_u32 s49, s49, 0x20000
    buffer_load_dwordx4 v[108:111], v10, s[56:59], s49 offen sc1
    s_add_u32 s49, s49, 0x20000
    buffer_load_dwordx4 v[112:115], v10, s[56:59], s49 offen sc1
    s_add_u32 s49, s49, 0x20000
    buffer_load_dwordx4 v[116:119], v10, s[56:59], s49 offen sc1
    s_add_u32 s49, s49, 0x20000
    buffer_load_dwordx4 v[120:123], v10, s[56:59], s49 offen sc1
    s_add_u32 s49, s49, 0x20000
    buffer_load_dwordx4 v[124:127], v10, s[56:59], s49 offen sc1
    s_add_u32 s49, s49, 0x20000
    buffer_load_dwordx4 v[128:131], v10, s[56:59], s49 offen sc1
    s_add_u32 s49, s49, 0x20000
    s_waitcnt vmcnt(12)
    v_pk_add_f32 v[76:77], v[76:77], v[80:81]
    v_pk_add_f32 v[78:79], v[78:79], v[82:83]
    s_waitcnt vmcnt(11)
    v_pk_add_f32 v[76:77], v[76:77], v[84:85]
    v_pk_add_f32 v[78:79], v[78:79], v[86:87]
    s_waitcnt vmcnt(10)
    v_pk_add_f32 v[76:77], v[76:77], v[88:89]
    v_pk_add_f32 v[78:79], v[78:79], v[90:91]
    s_waitcnt vmcnt(9)
    v_pk_add_f32 v[76:77], v[76:77], v[92:93]
    v_pk_add_f32 v[78:79], v[78:79], v[94:95]
    s_waitcnt vmcnt(8)
    v_pk_add_f32 v[76:77], v[76:77], v[96:97]
    v_pk_add_f32 v[78:79], v[78:79], v[98:99]
    s_waitcnt vmcnt(7)
    v_pk_add_f32 v[76:77], v[76:77], v[100:101]
    v_pk_add_f32 v[78:79], v[78:79], v[102:103]
    s_waitcnt vmcnt(6)
    v_pk_add_f32 v[76:77], v[76:77], v[104:105]
    v_pk_add_f32 v[78:79], v[78:79], v[106:107]
    s_waitcnt vmcnt(5)
    v_pk_add_f32 v[76:77], v[76:77], v[108:109]
    v_pk_add_f32 v[78:79], v[78:79], v[110:111]
    s_waitcnt vmcnt(4)
    v_pk_add_f32 v[76:77], v[76:77], v[112:113]
    v_pk_add_f32 v[78:79], v[78:79], v[114:115]
    s_waitcnt vmcnt(3)
    v_pk_add_f32 v[76:77], v[76:77], v[116:117]
    v_pk_add_f32 v[78:79], v[78:79], v[118:119]
    s_waitcnt vmcnt(2)
    v_pk_add_f32 v[76:77], v[76:77], v[120:121]
    v_pk_add_f32 v[78:79], v[78:79], v[122:123]
    s_waitcnt vmcnt(1)
    v_pk_add_f32 v[76:77], v[76:77], v[124:125]
    v_pk_add_f32 v[78:79], v[78:79], v[126:127]
    s_waitcnt vmcnt(0)
    v_pk_add_f32 v[76:77], v[76:77], v[128:129]
    v_pk_add_f32 v[78:79], v[78:79], v[130:131]
    v_mov_b32 v80, v76
    v_mov_b32 v81, v77
    v_mov_b32 v82, v78
    v_mov_b32 v83, v79
    s_nop 1
    v_permlane16_swap_b32 v76, v80
    v_permlane16_swap_b32 v77, v81
    v_permlane16_swap_b32 v78, v82
    v_permlane16_swap_b32 v79, v83
    s_nop 1
    v_add_f32 v76, v76, v80
    v_add_f32 v77, v77, v81
    v_add_f32 v78, v78, v82
    v_add_f32 v79, v79, v83
    v_mov_b32 v80, v76
    v_mov_b32 v81, v77
    v_mov_b32 v82, v78
    v_mov_b32 v83, v79
    s_nop 1
    v_permlane32_swap_b32 v76, v80
    v_permlane32_swap_b32 v77, v81
    v_permlane32_swap_b32 v78, v82
    v_permlane32_swap_b32 v79, v83
    s_nop 1
    v_add_f32 v76, v76, v80
    v_add_f32 v77, v77, v81
    v_add_f32 v78, v78, v82
    v_add_f32 v79, v79, v83
    v_lshlrev_b32 v14, 8, v1
    v_lshl_add_u32 v14, v8, 4, v14
    ds_write_b128 v14, v[76:79]
    s_waitcnt lgkmcnt(0)
    s_barrier
    v_lshlrev_b32 v14, 4, v8
    ds_read_b128 v[76:79], v14 offset:0
    ds_read_b128 v[80:83], v14 offset:256
    ds_read_b128 v[84:87], v14 offset:512
    ds_read_b128 v[88:91], v14 offset:768
    s_waitcnt lgkmcnt(0)
    v_pk_add_f32 v[76:77], v[76:77], v[80:81]
    v_pk_add_f32 v[78:79], v[78:79], v[82:83]
    v_pk_add_f32 v[76:77], v[76:77], v[84:85]
    v_pk_add_f32 v[78:79], v[78:79], v[86:87]
    v_pk_add_f32 v[76:77], v[76:77], v[88:89]
    v_pk_add_f32 v[78:79], v[78:79], v[90:91]
    v_cvt_pk_bf16_f32 v20, v76, v77
    v_lshlrev_b32 v21, 16, v20
    v_and_b32 v22, 0xffff0000, v20
    v_mul_f32 v21, s51, v21
    v_mul_f32 v22, s51, v22
    v_cvt_pk_bf16_f32 v20, v21, v22
    v_lshlrev_b32 v21, 16, v20
    v_and_b32 v22, 0xffff0000, v20
    v_lshlrev_b32 v23, 16, v72
    v_and_b32 v24, 0xffff0000, v72
    v_add_f32 v21, v21, v23
    v_add_f32 v22, v22, v24
    v_cvt_pk_bf16_f32 v20, v21, v22
    v_lshlrev_b32 v21, 16, v20
    v_and_b32 v22, 0xffff0000, v20
    v_lshlrev_b32 v23, 16, v74
    v_and_b32 v24, 0xffff0000, v74
    v_add_f32 v21, v21, v23
    v_add_f32 v22, v22, v24
    v_cvt_pk_bf16_f32 v26, v21, v22
    v_cvt_pk_bf16_f32 v20, v78, v79
    v_lshlrev_b32 v21, 16, v20
    v_and_b32 v22, 0xffff0000, v20
    v_mul_f32 v21, s51, v21
    v_mul_f32 v22, s51, v22
    v_cvt_pk_bf16_f32 v20, v21, v22
    v_lshlrev_b32 v21, 16, v20
    v_and_b32 v22, 0xffff0000, v20
    v_lshlrev_b32 v23, 16, v73
    v_and_b32 v24, 0xffff0000, v73
    v_add_f32 v21, v21, v23
    v_add_f32 v22, v22, v24
    v_cvt_pk_bf16_f32 v20, v21, v22
    v_lshlrev_b32 v21, 16, v20
    v_and_b32 v22, 0xffff0000, v20
    v_lshlrev_b32 v23, 16, v75
    v_and_b32 v24, 0xffff0000, v75
    v_add_f32 v21, v21, v23
    v_add_f32 v22, v22, v24
    v_cvt_pk_bf16_f32 v27, v21, v22
    v_cmp_gt_u32 vcc, 16, v0
    s_and_saveexec_b64 s[52:53], vcc
    s_cbranch_execz k4_skip_162
    buffer_store_dwordx2 v[26:27], v9, s[28:31], s46 offen sc1
k4_skip_162:
    s_mov_b64 exec, s[52:53]
    s_cmp_lg_u32 s30, 0
    s_cbranch_scc1 k4_fin_163
    s_branch k4_again_161
k4_fin_163:
    s_endpgm
k4_b_153:
    v_lshl_add_u32 v6, v1, 1, v5
    s_lshl_b32 s47, s2, 3
    s_sub_u32 s47, s47, 8
    v_add_u32 v6, s47, v6
    v_lshl_add_u32 v6, v6, 11, v7
    s_mov_b32 s36, s12
    s_and_b32 s37, s13, 0xffff
    s_mov_b32 s38, 0x400000
    s_mov_b32 s39, 0x00020000
    s_cmp_ge_u32 s2, 224
    s_cbranch_scc1 k4_noffn_164
    s_add_u32 s24, s14, 0x6000000
    s_addc_u32 s25, s15, 0
    s_and_b32 s25, s25, 0xffff
    s_mov_b32 s26, 0x1000000
    s_mov_b32 s27, 0x00020000
    s_and_b32 s50, s44, 3
    s_lshl_b32 s50, s50, 13
    s_lshl_b32 s52, s45, 15
    s_add_u32 s52, s52, s50
    v_lshlrev_b32 v8, 4, v2
    s_add_u32 m0, s50, 0
    s_add_u32 s53, s52, 0
    buffer_load_dwordx4 v8, s[24:27], s53 offen offset:0 lds
    buffer_load_dwordx4 v8, s[24:27], s53 offen offset:1024 lds
    buffer_load_dwordx4 v8, s[24:27], s53 offen offset:2048 lds
    buffer_load_dwordx4 v8, s[24:27], s53 offen offset:3072 lds
    s_add_u32 m0, s50, 4096
    s_add_u32 s53, s52, 4096
    buffer_load_dwordx4 v8, s[24:27], s53 offen offset:0 lds
    buffer_load_dwordx4 v8, s[24:27], s53 offen offset:1024 lds
    buffer_load_dwordx4 v8, s[24:27], s53 offen offset:2048 lds
    buffer_load_dwordx4 v8, s[24:27], s53 offen offset:3072 lds
    s_add_u32 m0, s50, 32768
    s_add_u32 s53, s52, 8388608
    buffer_load_dwordx4 v8, s[24:27], s53 offen offset:0 lds
    buffer_load_dwordx4 v8, s[24:27], s53 offen offset:1024 lds
    buffer_load_dwordx4 v8, s[24:27], s53 offen offset:2048 lds
    buffer_load_dwordx4 v8, s[24:27], s53 offen offset:3072 lds
    s_add_u32 m0, s50, 36864
    s_add_u32 s53, s52, 8392704
    buffer_load_dwordx4 v8, s[24:27], s53 offen offset:0 lds
    buffer_load_dwordx4 v8, s[24:27], s53 offen offset:1024 lds
    buffer_load_dwordx4 v8, s[24:27], s53 offen offset:2048 lds
    buffer_load_dwordx4 v8, s[24:27], s53 offen offset:3072 lds
k4_noffn_164:
    buffer_load_dwordx4 v[40:43], v6, s[20:23], 0 offen offset:0
    buffer_load_dwordx4 v[44:47], v6, s[20:23], 0 offen offset:512
    buffer_load_dwordx4 v[48:51], v6, s[20:23], 0 offen offset:1024
    buffer_load_dwordx4 v[52:55], v6, s[20:23], 0 offen offset:1536
    s_waitcnt vmcnt(0)
    s_branch k4_mm_155
k4_bout_156:
    v_mov_b32 v12, 69760
    ds_read_b64 v[12:13], v12
    v_lshrrev_b32 v14, 11, v6
    v_lshlrev_b32 v160, 16, v40
    v_and_b32 v161, 0xffff0000, v40
    v_lshlrev_b32 v162, 16, v41
    v_and_b32 v163, 0xffff0000, v41
    v_lshlrev_b32 v164, 16, v42
    v_and_b32 v165, 0xffff0000, v42
    v_lshlrev_b32 v166, 16, v43
    v_and_b32 v167, 0xffff0000, v43
    v_lshlrev_b32 v168, 16, v44
    v_and_b32 v169, 0xffff0000, v44
    v_lshlrev_b32 v170, 16, v45
    v_and_b32 v171, 0xffff0000, v45
    v_lshlrev_b32 v172, 16, v46
    v_and_b32 v173, 0xffff0000, v46
    v_lshlrev_b32 v174, 16, v47
    v_and_b32 v175, 0xffff0000, v47
    v_lshlrev_b32 v176, 16, v48
    v_and_b32 v177, 0xffff0000, v48
    v_lshlrev_b32 v178, 16, v49
    v_and_b32 v179, 0xffff0000, v49
    v_lshlrev_b32 v180, 16, v50
    v_and_b32 v181, 0xffff0000, v50
    v_lshlrev_b32 v182, 16, v51
    v_and_b32 v183, 0xffff0000, v51
    v_lshlrev_b32 v184, 16, v52
    v_and_b32 v185, 0xffff0000, v52
    v_lshlrev_b32 v186, 16, v53
    v_and_b32 v187, 0xffff0000, v53
    v_lshlrev_b32 v188, 16, v54
    v_and_b32 v189, 0xffff0000, v54
    v_lshlrev_b32 v190, 16, v55
    v_and_b32 v191, 0xffff0000, v55
    v_pk_add_f32 v[160:161], v[160:161], v[200:201]
    v_pk_add_f32 v[162:163], v[162:163], v[202:203]
    v_pk_add_f32 v[164:165], v[164:165], v[204:205]
    v_pk_add_f32 v[166:167], v[166:167], v[206:207]
    v_pk_add_f32 v[168:169], v[168:169], v[208:209]
    v_pk_add_f32 v[170:171], v[170:171], v[210:211]
    v_pk_add_f32 v[172:173], v[172:173], v[212:213]
    v_pk_add_f32 v[174:175], v[174:175], v[214:215]
    v_pk_add_f32 v[176:177], v[176:177], v[216:217]
    v_pk_add_f32 v[178:179], v[178:179], v[218:219]
    v_pk_add_f32 v[180:181], v[180:181], v[220:221]
    v_pk_add_f32 v[182:183], v[182:183], v[222:223]
    v_pk_add_f32 v[184:185], v[184:185], v[224:225]
    v_pk_add_f32 v[186:187], v[186:187], v[226:227]
    v_pk_add_f32 v[188:189], v[188:189], v[228:229]
    v_pk_add_f32 v[190:191], v[190:191], v[230:231]
    v_cvt_pk_bf16_f32 v40, v160, v161
    v_cvt_pk_bf16_f32 v41, v162, v163
    v_cvt_pk_bf16_f32 v42, v164, v165
    v_cvt_pk_bf16_f32 v43, v166, v167
    v_cvt_pk_bf16_f32 v44, v168, v169
    v_cvt_pk_bf16_f32 v45, v170, v171
    v_cvt_pk_bf16_f32 v46, v172, v173
    v_cvt_pk_bf16_f32 v47, v174, v175
    v_cvt_pk_bf16_f32 v48, v176, v177
    v_cvt_pk_bf16_f32 v49, v178, v179
    v_cvt_pk_bf16_f32 v50, v180, v181
    v_cvt_pk_bf16_f32 v51, v182, v183
    v_cvt_pk_bf16_f32 v52, v184, v185
    v_cvt_pk_bf16_f32 v53, v186, v187
    v_cvt_pk_bf16_f32 v54, v188, v189
    v_cvt_pk_bf16_f32 v55, v190, v191
    s_waitcnt lgkmcnt(0)
    v_cmp_eq_u32 vcc, v12, v14
    v_cmp_eq_u32 s[52:53], v13, v14
    v_mov_b32 v12, 0x7fffffff
    s_or_b64 vcc, vcc, s[52:53]
    v_cndmask_b32 v6, v6, v12, vcc
    buffer_store_dwordx4 v[40:43], v6, s[36:39], 0 offen offset:0 sc1
    buffer_store_dwordx4 v[44:47], v6, s[36:39], 0 offen offset:512 sc1
    buffer_store_dwordx4 v[48:51], v6, s[36:39], 0 offen offset:1024 sc1
    buffer_store_dwordx4 v[52:55], v6, s[36:39], 0 offen offset:1536 sc1
k4_end_152:
    s_endpgm
code_end:
    s_endpgm
.section .rodata,"a"
.p2align 6
.amdhsa_kernel k12_kernel
  .amdhsa_next_free_vgpr 512
  .amdhsa_next_free_sgpr 102
  .amdhsa_accum_offset 256
  .amdhsa_group_segment_fixed_size 0
  .amdhsa_kernarg_size 112
  .amdhsa_user_sgpr_count 2
  .amdhsa_user_sgpr_kernarg_segment_ptr 1
  .amdhsa_system_sgpr_workgroup_id_x 1
.end_amdhsa_kernel
.p2align 6
.amdhsa_kernel k4_kernel
  .amdhsa_next_free_vgpr 232
  .amdhsa_next_free_sgpr 102
  .amdhsa_accum_offset 232
  .amdhsa_group_segment_fixed_size 0
  .amdhsa_kernarg_size 112
  .amdhsa_user_sgpr_count 2
  .amdhsa_user_sgpr_kernarg_segment_ptr 1
  .amdhsa_system_sgpr_workgroup_id_x 1
  .amdhsa_float_denorm_mode_32 3
.end_amdhsa_kernel
```

```asm
; @launch grid=(256,1,1) block=(256,1,1) lds=163840
.amdgcn_target "amdgcn-amd-amdhsa--gfx950"
.text
.globl sequential_preLN__compressed_kv_cla__moe_arch_mod__prompt_kernel
.p2align 8
.type sequential_preLN__compressed_kv_cla__moe_arch_mod__prompt_kernel,@function
sequential_preLN__compressed_kv_cla__moe_arch_mod__prompt_kernel:
    s_cmp_ge_u32 s2, 256
    s_cbranch_scc1 k12_end_1
    s_load_dwordx4 s[36:39], s[0:1], 0
    s_load_dwordx4 s[40:43], s[0:1], 24
    s_load_dwordx2 s[4:5], s[0:1], 16
    s_load_dwordx4 s[60:63], s[0:1], 96
    s_lshr_b32 s59, s2, 3
    s_lshl_b32 s58, s59, 4
    v_add_u32 v6, s58, v0
    v_cmp_gt_u32 vcc, 48, v0
    v_cmp_gt_u32 s[56:57], 64, v0
    s_nop 0
    v_cndmask_b32 v6, v6, v0, vcc
    s_getpc_b64 s[52:53]
pc_2:
    s_add_u32 s52, s52, k12_code0-pc_2
    s_addc_u32 s53, s53, 0
    v_lshlrev_b32 v58, 7, v6
    v_mov_b32 v59, s53
    v_add_co_u32 v58, vcc, s52, v58
    s_nop 1
    v_addc_co_u32 v59, vcc, 0, v59, vcc
k12_code0:
    s_mov_b64 exec, s[56:57]
    s_cbranch_execz k12_nocode_3
    global_load_dword v51, v[58:59], off
k12_nocode_3:
    s_mov_b64 exec, -1
    s_and_b32 s58, s2, 7
    s_lshr_b32 s59, s2, 3
    s_and_b32 s45, s59, 7
    s_lshr_b32 s57, s59, 3
    s_and_b32 s44, s57, 1
    s_lshl_b32 s52, s58, 1
    s_add_u32 s44, s44, s52
    s_lshr_b32 s57, s57, 1
    v_lshrrev_b32 v2, 6, v0
    v_and_b32 v3, 63, v0
    v_readfirstlane_b32 s30, v2
    v_lshlrev_b32 v1, 4, v3
    v_lshrrev_b32 v60, 5, v3
    v_lshl_add_u32 v60, v2, 1, v60
    v_and_b32 v61, 31, v3
    v_lshlrev_b32 v6, 11, v60
    v_lshl_add_u32 v62, v61, 4, v6
    s_lshl_b32 s52, s2, 14
    v_lshrrev_b32 v56, 3, v3
    v_and_b32 v57, 7, v3
    v_lshrrev_b32 v58, 1, v56
    v_xor_b32 v6, v57, v58
    v_xor_b32 v7, 4, v6
    v_lshl_add_u32 v58, v2, 6, v56
    v_lshlrev_b32 v58, 10, v58
    s_lshl_b32 s47, s45, 18
    v_add_u32 v58, s47, v58
    v_lshl_add_u32 v10, v6, 4, v58
    v_lshl_add_u32 v11, v7, 4, v58
    v_add_u32 v17, 54272, v11
    v_add_u32 v16, 47104, v10
    v_add_u32 v15, 39936, v11
    v_add_u32 v14, 32768, v10
    v_add_u32 v13, 21504, v11
    v_add_u32 v12, 14336, v10
    v_add_u32 v11, 7168, v11
    v_add_u32 v10, 0, v10
    v_lshrrev_b32 v6, 5, v3
    v_bfe_u32 v7, v3, 1, 4
    v_and_b32 v59, 1, v3
    v_lshl_add_u32 v58, v2, 4, v6
    v_lshlrev_b32 v58, 13, v58
    v_lshl_add_u32 v58, v59, 4, v58
    s_lshl_b32 s47, s44, 9
    v_add_u32 v58, s47, v58
    v_xor_b32 v7, v7, v6
    v_xor_b32 v6, 0, v7
    v_lshl_add_u32 v6, v6, 5, v58
    v_add_u32 v18, 0, v6
    v_xor_b32 v6, 2, v7
    v_lshl_add_u32 v6, v6, 5, v58
    v_add_u32 v19, 15360, v6
    v_xor_b32 v6, 0, v7
    v_lshl_add_u32 v6, v6, 5, v58
    v_add_u32 v20, 30720, v6
    v_xor_b32 v6, 2, v7
    v_lshl_add_u32 v6, v6, 5, v58
    v_add_u32 v21, 46080, v6
    v_xor_b32 v6, 4, v7
    v_lshl_add_u32 v6, v6, 5, v58
    v_add_u32 v22, 65536, v6
    v_xor_b32 v6, 6, v7
    v_lshl_add_u32 v6, v6, 5, v58
    v_add_u32 v23, 80896, v6
    v_xor_b32 v6, 4, v7
    v_lshl_add_u32 v6, v6, 5, v58
    v_add_u32 v24, 96256, v6
    v_xor_b32 v6, 6, v7
    v_lshl_add_u32 v6, v6, 5, v58
    v_add_u32 v25, 111616, v6
    s_lshl_b32 s48, s30, 13
    s_mov_b32 s49, 0
    s_mov_b32 s50, 0
    s_waitcnt lgkmcnt(0)
    s_mov_b32 s24, s36
    s_and_b32 s25, s37, 0xffff
    s_mov_b32 s26, 0x400000
    s_mov_b32 s27, 0x00020000
    buffer_load_dwordx4 v[64:67], v62, s[24:27], s52 offen offset:0
    buffer_load_dwordx4 v[68:71], v62, s[24:27], s52 offen offset:512
    buffer_load_dwordx4 v[72:75], v62, s[24:27], s52 offen offset:1024
    buffer_load_dwordx4 v[76:79], v62, s[24:27], s52 offen offset:1536
    s_mov_b32 s16, s38
    s_and_b32 s17, s39, 0xffff
    s_mov_b32 s18, 0x200000
    s_mov_b32 s19, 0x00020000
    s_cmp_eq_u32 s57, 0
    s_cselect_b32 s20, s40, s42
    s_cselect_b32 s21, s41, s43
    s_and_b32 s21, s21, 0xffff
    s_mov_b32 s22, 0x400000
    s_mov_b32 s23, 0x00020000
    s_add_u32 m0, s48, 0
    s_nop 0
    buffer_load_dwordx4 v10, s[16:19], s49 offen offset:0 lds
    buffer_load_dwordx4 v11, s[16:19], s49 offen offset:1024 lds
    buffer_load_dwordx4 v12, s[16:19], s49 offen offset:2048 lds
    buffer_load_dwordx4 v13, s[16:19], s49 offen offset:3072 lds
    s_add_u32 m0, s48, 65536
    s_nop 0
    buffer_load_dwordx4 v18, s[20:23], s50 offen offset:0 lds
    buffer_load_dwordx4 v19, s[20:23], s50 offen offset:1024 lds
    buffer_load_dwordx4 v20, s[20:23], s50 offen offset:2048 lds
    buffer_load_dwordx4 v21, s[20:23], s50 offen offset:3072 lds
    s_mov_b64 s[6:7], s[62:63]
    s_add_u32 s8, s6, 0x0
    s_addc_u32 s9, s7, 0
    s_and_b32 s9, s9, 0xffff
    s_mov_b32 s10, 0x400000
    s_mov_b32 s11, 0x00020000
    s_mov_b32 s12, s4
    s_and_b32 s13, s5, 0xffff
    s_mov_b32 s14, 0x800000
    s_mov_b32 s15, 0x00020000
    s_add_u32 s32, s6, 0x1000000
    s_addc_u32 s33, s7, 0
    s_and_b32 s33, s33, 0xffff
    s_mov_b32 s34, 0x2000000
    s_mov_b32 s35, 0x00020000
    s_mov_b32 s24, s60
    s_and_b32 s25, s61, 0xffff
    s_mov_b32 s26, 0x100
    s_mov_b32 s27, 0x00020000
    s_lshl_b32 s28, s58, 2
    s_and_b32 s31, s59, 3
    s_add_u32 s28, s28, s31
    s_lshr_b32 s29, s59, 2
    s_lshl_b32 s42, s29, 7
    s_sub_u32 s43, 1920, s42
    s_lshl_b32 s31, s30, 4
    s_add_u32 s38, s42, s31
    s_add_u32 s39, s43, s31
    s_lshl_b32 s60, s30, 12
    s_mov_b32 s61, 0
    s_mov_b32 s62, 0
    s_lshl_b32 s47, s44, 1
    s_lshr_b32 s52, s30, 1
    s_add_u32 s47, s47, s52
    s_lshl_b32 s47, s47, 14
    s_lshl_b32 s52, s45, 1
    s_and_b32 s53, s30, 1
    s_add_u32 s52, s52, s53
    s_lshl_b32 s52, s52, 20
    s_add_u32 s47, s47, s52
    s_lshl_b32 s52, s57, 24
    s_add_u32 s47, s47, s52
    s_lshl_b32 s54, s44, 8
    s_lshr_b32 s55, s28, 1
    s_lshl_b32 s55, s55, 8
    s_and_b32 s53, s59, 3
    s_add_u32 s53, s53, 1
    s_cmp_eq_u32 s30, 0
    s_cselect_b32 s53, s53, -1
    s_cselect_b32 s46, 6, -1
    v_lshlrev_b32 v6, 13, v56
    v_lshl_add_u32 v50, v57, 7, v6
    s_lshl_b32 s56, s30, 5
    s_add_u32 s56, s56, s59
    s_lshl_b32 s56, s56, 16
    s_lshl_b32 s52, s58, 10
    s_add_u32 s56, s56, s52
    s_lshl_b32 s63, s30, 1
    v_mul_u32_u24 v6, 2064, v60
    v_lshl_add_u32 v6, v61, 4, v6
    v_add_u32 v54, 131072, v6
    v_mul_u32_u24 v7, 2064, v57
    v_lshl_add_u32 v7, v56, 4, v7
    v_lshl_add_u32 v7, v2, 9, v7
    v_add_u32 v55, 131072, v7
    v_lshrrev_b32 v7, 2, v56
    v_lshl_add_u32 v7, v2, 3, v7
    v_lshlrev_b32 v7, 17, v7
    v_and_b32 v6, 3, v56
    v_lshl_add_u32 v7, v6, 8, v7
    v_lshl_add_u32 v7, v57, 4, v7
    s_lshr_b32 s52, s2, 1
    s_lshl_b32 s52, s52, 10
    s_and_b32 s31, s2, 1
    s_lshl_b32 s31, s31, 7
    s_add_u32 s52, s52, s31
    v_add_u32 v53, s52, v7
    v_and_b32 v56, 15, v3
    v_lshrrev_b32 v57, 4, v3
    v_lshrrev_b32 v6, 1, v56
    v_xor_b32 v6, v6, v57
    v_and_b32 v7, 1, v2
    v_lshl_add_u32 v7, v7, 7, v56
    v_lshlrev_b32 v7, 7, v7
    v_lshl_add_u32 v26, v6, 4, v7
    v_xor_b32 v27, 64, v26
    v_lshrrev_b32 v6, 2, v56
    v_and_b32 v58, 1, v57
    v_lshl_add_u32 v58, v58, 2, v6
    v_lshl_add_u32 v59, v57, 3, v6
    v_and_b32 v63, 3, v3
    v_lshlrev_b32 v7, 9, v59
    v_lshrrev_b32 v6, 1, v2
    v_lshl_add_u32 v7, v6, 8, v7
    v_lshl_add_u32 v7, v63, 3, v7
    v_add_u32 v7, 65536, v7
    v_lshlrev_b32 v59, 8, v59
    v_lshl_add_u32 v59, v63, 3, v59
    v_add_u32 v59, 98304, v59
    v_xor_b32 v6, 0, v58
    v_lshl_add_u32 v28, v6, 5, v7
    v_lshl_add_u32 v42, v6, 5, v59
    v_xor_b32 v6, 1, v58
    v_lshl_add_u32 v29, v6, 5, v7
    v_lshl_add_u32 v43, v6, 5, v59
    v_xor_b32 v6, 2, v58
    v_lshl_add_u32 v30, v6, 5, v7
    v_lshl_add_u32 v44, v6, 5, v59
    v_xor_b32 v6, 3, v58
    v_lshl_add_u32 v31, v6, 5, v7
    v_lshl_add_u32 v45, v6, 5, v59
    v_xor_b32 v6, 4, v58
    v_lshl_add_u32 v32, v6, 5, v7
    v_lshl_add_u32 v46, v6, 5, v59
    v_xor_b32 v6, 5, v58
    v_lshl_add_u32 v33, v6, 5, v7
    v_lshl_add_u32 v47, v6, 5, v59
    v_xor_b32 v6, 6, v58
    v_lshl_add_u32 v34, v6, 5, v7
    v_lshl_add_u32 v48, v6, 5, v59
    v_xor_b32 v6, 7, v58
    v_lshl_add_u32 v35, v6, 5, v7
    v_lshl_add_u32 v49, v6, 5, v59
    s_lshl_b32 s31, s38, 6
    v_add_u32 v36, s31, v1
    s_lshl_b32 s31, s39, 6
    v_add_u32 v37, s31, v1
    v_bfe_u32 v6, v3, 1, 3
    v_and_b32 v7, 1, v3
    v_lshl_add_u32 v58, v2, 4, v57
    v_lshlrev_b32 v58, 13, v58
    v_lshl_add_u32 v58, v7, 4, v58
    s_lshl_b32 s31, s28, 8
    v_add_u32 v58, s31, v58
    v_xor_b32 v6, v6, v57
    v_xor_b32 v7, 0, v6
    v_lshl_add_u32 v7, v7, 5, v58
    v_add_u32 v38, 0, v7
    v_xor_b32 v7, 0, v6
    v_lshl_add_u32 v7, v7, 5, v58
    v_add_u32 v39, 31744, v7
    v_xor_b32 v7, 4, v6
    v_lshl_add_u32 v7, v7, 5, v58
    v_add_u32 v40, 63488, v7
    v_xor_b32 v7, 4, v6
    v_lshl_add_u32 v7, v7, 5, v58
    v_add_u32 v41, 95232, v7
    v_lshlrev_b32 v6, 2, v57
    v_sub_u32 v4, v56, v6
    v_mov_b32 v5, 0xff800000
    v_mov_b32 v8, 0
    v_mov_b32 v9, 1
    s_lshl_b32 s52, s59, 2
    s_add_u32 s52, s52, s30
    v_and_b32 v6, 1, v3
    v_lshl_add_u32 v6, s52, 1, v6
    s_getpc_b64 s[40:41]
pc_4:
    s_add_u32 s40, s40, k12_qcode-pc_4
    s_addc_u32 s41, s41, 0
    v_lshlrev_b32 v2, 7, v6
    v_mov_b32 v3, s41
    v_add_co_u32 v2, vcc, s40, v2
    s_nop 1
    v_addc_co_u32 v3, vcc, 0, v3, vcc
    v_mov_b32 v56, 0
    v_mov_b32 v57, 0
    v_mov_b32 v58, 0
    v_mov_b32 v59, 0
    s_nop 1
    v_mfma_f32_32x32x16_bf16 a[128:143], v[56:59], v[56:59], 0
    v_mfma_f32_32x32x16_bf16 a[144:159], v[56:59], v[56:59], 0
    v_mfma_f32_32x32x16_bf16 a[160:175], v[56:59], v[56:59], 0
    v_mfma_f32_32x32x16_bf16 a[176:191], v[56:59], v[56:59], 0
    v_mfma_f32_32x32x16_bf16 v[128:143], v[56:59], v[56:59], 0
    v_mfma_f32_32x32x16_bf16 v[144:159], v[56:59], v[56:59], 0
    v_mfma_f32_32x32x16_bf16 v[160:175], v[56:59], v[56:59], 0
    v_mfma_f32_32x32x16_bf16 v[176:191], v[56:59], v[56:59], 0
    v_mfma_f32_32x32x16_bf16 v[192:207], v[56:59], v[56:59], 0
    v_mfma_f32_32x32x16_bf16 v[208:223], v[56:59], v[56:59], 0
    v_mfma_f32_32x32x16_bf16 v[224:239], v[56:59], v[56:59], 0
    v_mfma_f32_32x32x16_bf16 v[240:255], v[56:59], v[56:59], 0
    s_add_u32 m0, s48, 4096
    s_nop 0
    buffer_load_dwordx4 v14, s[16:19], s49 offen offset:0 lds
    buffer_load_dwordx4 v15, s[16:19], s49 offen offset:1024 lds
    buffer_load_dwordx4 v16, s[16:19], s49 offen offset:2048 lds
    buffer_load_dwordx4 v17, s[16:19], s49 offen offset:3072 lds
    s_add_u32 s49, s49, 128
    s_add_u32 m0, s48, 69632
    s_nop 0
    buffer_load_dwordx4 v22, s[20:23], s50 offen offset:0 lds
    buffer_load_dwordx4 v23, s[20:23], s50 offen offset:1024 lds
    buffer_load_dwordx4 v24, s[20:23], s50 offen offset:2048 lds
    buffer_load_dwordx4 v25, s[20:23], s50 offen offset:3072 lds
    s_add_u32 s50, s50, 0x80000
    s_waitcnt vmcnt(16)
    v_lshlrev_b32 v80, 16, v64
    v_and_b32 v81, 0xffff0000, v64
    v_lshlrev_b32 v82, 16, v65
    v_and_b32 v83, 0xffff0000, v65
    v_lshlrev_b32 v84, 16, v66
    v_and_b32 v85, 0xffff0000, v66
    v_lshlrev_b32 v86, 16, v67
    v_and_b32 v87, 0xffff0000, v67
    v_lshlrev_b32 v88, 16, v68
    v_and_b32 v89, 0xffff0000, v68
    v_lshlrev_b32 v90, 16, v69
    v_and_b32 v91, 0xffff0000, v69
    v_lshlrev_b32 v92, 16, v70
    v_and_b32 v93, 0xffff0000, v70
    v_lshlrev_b32 v94, 16, v71
    v_and_b32 v95, 0xffff0000, v71
    v_lshlrev_b32 v96, 16, v72
    v_and_b32 v97, 0xffff0000, v72
    v_lshlrev_b32 v98, 16, v73
    v_and_b32 v99, 0xffff0000, v73
    v_lshlrev_b32 v100, 16, v74
    v_and_b32 v101, 0xffff0000, v74
    v_lshlrev_b32 v102, 16, v75
    v_and_b32 v103, 0xffff0000, v75
    v_lshlrev_b32 v104, 16, v76
    v_and_b32 v105, 0xffff0000, v76
    v_lshlrev_b32 v106, 16, v77
    v_and_b32 v107, 0xffff0000, v77
    v_lshlrev_b32 v108, 16, v78
    v_and_b32 v109, 0xffff0000, v78
    v_lshlrev_b32 v110, 16, v79
    v_and_b32 v111, 0xffff0000, v79
    v_pk_add_f32 v[112:113], v[80:81], v[82:83]
    v_pk_add_f32 v[114:115], v[84:85], v[86:87]
    v_pk_add_f32 v[112:113], v[112:113], v[88:89]
    v_pk_add_f32 v[114:115], v[114:115], v[90:91]
    v_pk_add_f32 v[112:113], v[112:113], v[92:93]
    v_pk_add_f32 v[114:115], v[114:115], v[94:95]
    v_pk_add_f32 v[112:113], v[112:113], v[96:97]
    v_pk_add_f32 v[114:115], v[114:115], v[98:99]
    v_pk_add_f32 v[112:113], v[112:113], v[100:101]
    v_pk_add_f32 v[114:115], v[114:115], v[102:103]
    v_pk_add_f32 v[112:113], v[112:113], v[104:105]
    v_pk_add_f32 v[114:115], v[114:115], v[106:107]
    s_add_u32 m0, s48, 32768
    s_nop 0
    buffer_load_dwordx4 v10, s[16:19], s49 offen offset:0 lds
    buffer_load_dwordx4 v11, s[16:19], s49 offen offset:1024 lds
    buffer_load_dwordx4 v12, s[16:19], s49 offen offset:2048 lds
    buffer_load_dwordx4 v13, s[16:19], s49 offen offset:3072 lds
    v_pk_add_f32 v[112:113], v[112:113], v[108:109]
    v_pk_add_f32 v[114:115], v[114:115], v[110:111]
    v_pk_add_f32 v[112:113], v[112:113], v[114:115]
    v_add_f32 v112, v112, v113
    s_nop 1
    v_add_f32_dpp v112, v112, v112 quad_perm:[1,0,3,2] row_mask:0xf bank_mask:0xf
    s_nop 1
    v_add_f32_dpp v112, v112, v112 quad_perm:[2,3,0,1] row_mask:0xf bank_mask:0xf
    s_nop 1
    v_add_f32_dpp v112, v112, v112 row_half_mirror row_mask:0xf bank_mask:0xf
    s_nop 1
    v_add_f32_dpp v112, v112, v112 row_mirror row_mask:0xf bank_mask:0xf
    v_mov_b32 v114, v112
    s_nop 1
    v_permlane16_swap_b32 v112, v114
    s_nop 1
    v_add_f32 v112, v112, v114
    v_mul_f32 v112, 0xba800000, v112
    v_mov_b32 v113, v112
    v_pk_add_f32 v[114:115], v[80:81], v[112:113]
    v_pk_add_f32 v[118:119], v[82:83], v[112:113]
    v_pk_mul_f32 v[116:117], v[114:115], v[114:115]
    v_pk_fma_f32 v[116:117], v[118:119], v[118:119], v[116:117]
    v_pk_add_f32 v[114:115], v[84:85], v[112:113]
    v_pk_add_f32 v[118:119], v[86:87], v[112:113]
    v_pk_fma_f32 v[116:117], v[114:115], v[114:115], v[116:117]
    v_pk_fma_f32 v[116:117], v[118:119], v[118:119], v[116:117]
    v_pk_add_f32 v[114:115], v[88:89], v[112:113]
    v_pk_add_f32 v[118:119], v[90:91], v[112:113]
    v_pk_fma_f32 v[116:117], v[114:115], v[114:115], v[116:117]
    v_pk_fma_f32 v[116:117], v[118:119], v[118:119], v[116:117]
    v_pk_add_f32 v[114:115], v[92:93], v[112:113]
    v_pk_add_f32 v[118:119], v[94:95], v[112:113]
    v_pk_fma_f32 v[116:117], v[114:115], v[114:115], v[116:117]
    v_pk_fma_f32 v[116:117], v[118:119], v[118:119], v[116:117]
    v_pk_add_f32 v[114:115], v[96:97], v[112:113]
    v_pk_add_f32 v[118:119], v[98:99], v[112:113]
    v_pk_fma_f32 v[116:117], v[114:115], v[114:115], v[116:117]
    v_pk_fma_f32 v[116:117], v[118:119], v[118:119], v[116:117]
    v_pk_add_f32 v[114:115], v[100:101], v[112:113]
    v_pk_add_f32 v[118:119], v[102:103], v[112:113]
    v_pk_fma_f32 v[116:117], v[114:115], v[114:115], v[116:117]
    v_pk_fma_f32 v[116:117], v[118:119], v[118:119], v[116:117]
    v_pk_add_f32 v[114:115], v[104:105], v[112:113]
    s_add_u32 m0, s48, 98304
    s_nop 0
    buffer_load_dwordx4 v18, s[20:23], s50 offen offset:0 lds
    buffer_load_dwordx4 v19, s[20:23], s50 offen offset:1024 lds
    buffer_load_dwordx4 v20, s[20:23], s50 offen offset:2048 lds
    buffer_load_dwordx4 v21, s[20:23], s50 offen offset:3072 lds
    v_pk_add_f32 v[118:119], v[106:107], v[112:113]
    v_pk_fma_f32 v[116:117], v[114:115], v[114:115], v[116:117]
    v_pk_fma_f32 v[116:117], v[118:119], v[118:119], v[116:117]
    v_pk_add_f32 v[114:115], v[108:109], v[112:113]
    v_pk_add_f32 v[118:119], v[110:111], v[112:113]
    v_pk_fma_f32 v[116:117], v[114:115], v[114:115], v[116:117]
    v_pk_fma_f32 v[116:117], v[118:119], v[118:119], v[116:117]
    v_add_f32 v116, v116, v117
    s_nop 1
    v_add_f32_dpp v116, v116, v116 quad_perm:[1,0,3,2] row_mask:0xf bank_mask:0xf
    s_nop 1
    v_add_f32_dpp v116, v116, v116 quad_perm:[2,3,0,1] row_mask:0xf bank_mask:0xf
    s_nop 1
    v_add_f32_dpp v116, v116, v116 row_half_mirror row_mask:0xf bank_mask:0xf
    s_nop 1
    v_add_f32_dpp v116, v116, v116 row_mirror row_mask:0xf bank_mask:0xf
    v_mov_b32 v114, v116
    s_nop 1
    v_permlane16_swap_b32 v116, v114
    s_nop 1
    v_add_f32 v116, v116, v114
    v_mul_f32 v116, 0x3a800000, v116
    v_cvt_pk_bf16_f32 v118, v112, v116
    v_and_b32 v116, 0xffff0000, v118
    v_lshlrev_b32 v118, 16, v118
    v_add_f32 v116, 0x3727c5ac, v116
    v_mov_b32 v119, v118
    v_cvt_pk_bf16_f32 v116, v116, v116
    v_and_b32 v116, 0xffff0000, v116
    v_sqrt_f32 v116, v116
    v_pk_add_f32 v[80:81], v[80:81], v[118:119]
    v_pk_add_f32 v[82:83], v[82:83], v[118:119]
    v_pk_add_f32 v[84:85], v[84:85], v[118:119]
    v_pk_add_f32 v[86:87], v[86:87], v[118:119]
    v_pk_add_f32 v[88:89], v[88:89], v[118:119]
    v_pk_add_f32 v[90:91], v[90:91], v[118:119]
    v_pk_add_f32 v[92:93], v[92:93], v[118:119]
    v_pk_add_f32 v[94:95], v[94:95], v[118:119]
    v_pk_add_f32 v[96:97], v[96:97], v[118:119]
    v_pk_add_f32 v[98:99], v[98:99], v[118:119]
    v_pk_add_f32 v[100:101], v[100:101], v[118:119]
    v_pk_add_f32 v[102:103], v[102:103], v[118:119]
    v_pk_add_f32 v[104:105], v[104:105], v[118:119]
    s_add_u32 m0, s48, 36864
    s_nop 0
    buffer_load_dwordx4 v14, s[16:19], s49 offen offset:0 lds
    buffer_load_dwordx4 v15, s[16:19], s49 offen offset:1024 lds
    buffer_load_dwordx4 v16, s[16:19], s49 offen offset:2048 lds
    buffer_load_dwordx4 v17, s[16:19], s49 offen offset:3072 lds
    s_add_u32 s49, s49, 128
    v_pk_add_f32 v[106:107], v[106:107], v[118:119]
    v_pk_add_f32 v[108:109], v[108:109], v[118:119]
    v_pk_add_f32 v[110:111], v[110:111], v[118:119]
    v_cvt_pk_bf16_f32 v116, v116, v116
    v_and_b32 v116, 0xffff0000, v116
    v_rcp_f32 v116, v116
    v_cvt_pk_bf16_f32 v64, v80, v81
    v_cvt_pk_bf16_f32 v65, v82, v83
    v_cvt_pk_bf16_f32 v66, v84, v85
    v_cvt_pk_bf16_f32 v67, v86, v87
    v_cvt_pk_bf16_f32 v68, v88, v89
    v_cvt_pk_bf16_f32 v69, v90, v91
    v_cvt_pk_bf16_f32 v70, v92, v93
    v_cvt_pk_bf16_f32 v71, v94, v95
    v_cvt_pk_bf16_f32 v72, v96, v97
    v_cvt_pk_bf16_f32 v73, v98, v99
    v_cvt_pk_bf16_f32 v74, v100, v101
    v_cvt_pk_bf16_f32 v75, v102, v103
    v_cvt_pk_bf16_f32 v76, v104, v105
    v_cvt_pk_bf16_f32 v77, v106, v107
    v_cvt_pk_bf16_f32 v78, v108, v109
    v_cvt_pk_bf16_f32 v79, v110, v111
    v_mov_b32 v117, v116
    v_lshlrev_b32 v80, 16, v64
    v_and_b32 v81, 0xffff0000, v64
    v_lshlrev_b32 v82, 16, v65
    v_and_b32 v83, 0xffff0000, v65
    v_lshlrev_b32 v84, 16, v66
    v_and_b32 v85, 0xffff0000, v66
    v_lshlrev_b32 v86, 16, v67
    v_and_b32 v87, 0xffff0000, v67
    v_lshlrev_b32 v88, 16, v68
    v_and_b32 v89, 0xffff0000, v68
    v_lshlrev_b32 v90, 16, v69
    v_and_b32 v91, 0xffff0000, v69
    v_lshlrev_b32 v92, 16, v70
    v_and_b32 v93, 0xffff0000, v70
    v_lshlrev_b32 v94, 16, v71
    v_and_b32 v95, 0xffff0000, v71
    v_lshlrev_b32 v96, 16, v72
    v_and_b32 v97, 0xffff0000, v72
    v_lshlrev_b32 v98, 16, v73
    v_and_b32 v99, 0xffff0000, v73
    v_lshlrev_b32 v100, 16, v74
    s_add_u32 m0, s48, 102400
    s_nop 0
    buffer_load_dwordx4 v22, s[20:23], s50 offen offset:0 lds
    buffer_load_dwordx4 v23, s[20:23], s50 offen offset:1024 lds
    buffer_load_dwordx4 v24, s[20:23], s50 offen offset:2048 lds
    buffer_load_dwordx4 v25, s[20:23], s50 offen offset:3072 lds
    s_add_u32 s50, s50, 0x80000
    v_and_b32 v101, 0xffff0000, v74
    v_lshlrev_b32 v102, 16, v75
    v_and_b32 v103, 0xffff0000, v75
    v_lshlrev_b32 v104, 16, v76
    v_and_b32 v105, 0xffff0000, v76
    v_lshlrev_b32 v106, 16, v77
    v_and_b32 v107, 0xffff0000, v77
    v_lshlrev_b32 v108, 16, v78
    v_and_b32 v109, 0xffff0000, v78
    v_lshlrev_b32 v110, 16, v79
    v_and_b32 v111, 0xffff0000, v79
    v_pk_mul_f32 v[80:81], v[80:81], v[116:117]
    v_pk_mul_f32 v[82:83], v[82:83], v[116:117]
    v_pk_mul_f32 v[84:85], v[84:85], v[116:117]
    v_pk_mul_f32 v[86:87], v[86:87], v[116:117]
    v_pk_mul_f32 v[88:89], v[88:89], v[116:117]
    v_pk_mul_f32 v[90:91], v[90:91], v[116:117]
    v_pk_mul_f32 v[92:93], v[92:93], v[116:117]
    v_pk_mul_f32 v[94:95], v[94:95], v[116:117]
    v_pk_mul_f32 v[96:97], v[96:97], v[116:117]
    v_pk_mul_f32 v[98:99], v[98:99], v[116:117]
    v_pk_mul_f32 v[100:101], v[100:101], v[116:117]
    v_pk_mul_f32 v[102:103], v[102:103], v[116:117]
    v_pk_mul_f32 v[104:105], v[104:105], v[116:117]
    v_pk_mul_f32 v[106:107], v[106:107], v[116:117]
    v_pk_mul_f32 v[108:109], v[108:109], v[116:117]
    v_pk_mul_f32 v[110:111], v[110:111], v[116:117]
    v_cvt_pk_bf16_f32 v64, v80, v81
    v_cvt_pk_bf16_f32 v65, v82, v83
    v_cvt_pk_bf16_f32 v66, v84, v85
    v_cvt_pk_bf16_f32 v67, v86, v87
    v_cvt_pk_bf16_f32 v68, v88, v89
    v_cvt_pk_bf16_f32 v69, v90, v91
    v_cvt_pk_bf16_f32 v70, v92, v93
    v_cvt_pk_bf16_f32 v71, v94, v95
    v_cvt_pk_bf16_f32 v72, v96, v97
    v_cvt_pk_bf16_f32 v73, v98, v99
    v_cvt_pk_bf16_f32 v74, v100, v101
    v_cvt_pk_bf16_f32 v75, v102, v103
    v_cvt_pk_bf16_f32 v76, v104, v105
    v_cvt_pk_bf16_f32 v77, v106, v107
    v_cvt_pk_bf16_f32 v78, v108, v109
    v_cvt_pk_bf16_f32 v79, v110, v111
    ds_write_b128 v54, v[64:67] offset:0
    ds_write_b128 v54, v[68:71] offset:512
    ds_write_b128 v54, v[72:75] offset:1024
    ds_write_b128 v54, v[76:79] offset:1536
    s_waitcnt vmcnt(16) lgkmcnt(0)
    s_barrier
    ds_read_b128 a[192:195], v55 offset:0
    ds_read_b128 a[196:199], v55 offset:128
    ds_read_b128 a[200:203], v55 offset:256
    ds_read_b128 a[204:207], v55 offset:384
    v_add_u32 v54, 4096, v36
    v_add_u32 v55, 4096, v37
    v_mfma_f32_32x32x16_bf16 v[64:79], v[56:59], v[56:59], 0
    v_mfma_f32_32x32x16_bf16 v[80:95], v[56:59], v[56:59], 0
    v_mfma_f32_32x32x16_bf16 v[96:111], v[56:59], v[56:59], 0
    v_mfma_f32_32x32x16_bf16 v[112:127], v[56:59], v[56:59], 0
    s_cmp_ge_u32 s2, 38
    s_cbranch_scc1 k12_nostat_5
    s_lshl_b32 s52, s2, 12
    s_add_u32 s52, s52, 0x3800000
    s_mov_b32 s34, -1
    v_lshlrev_b32 v6, 4, v0
    buffer_store_dwordx4 v[56:59], v6, s[32:35], s52 offen sc1
    s_mov_b32 s34, 0x2000000
k12_nostat_5:
    ds_read_b128 a[0:3], v26 offset:0
    ds_read_b64_tr_b16 a[32:33], v28 offset:0
    ds_read_b64_tr_b16 a[34:35], v28 offset:2048
    ds_read_b128 a[4:7], v26 offset:2048
    ds_read_b64_tr_b16 a[36:37], v29 offset:0
    ds_read_b64_tr_b16 a[38:39], v29 offset:2048
    ds_read_b128 a[8:11], v26 offset:4096
    ds_read_b64_tr_b16 a[40:41], v30 offset:0
    ds_read_b64_tr_b16 a[42:43], v30 offset:2048
    ds_read_b128 a[12:15], v26 offset:6144
    ds_read_b64_tr_b16 a[44:45], v31 offset:0
    ds_read_b64_tr_b16 a[46:47], v31 offset:2048
    ds_read_b128 a[16:19], v26 offset:8192
    ds_read_b64_tr_b16 a[48:49], v32 offset:0
    ds_read_b64_tr_b16 a[50:51], v32 offset:2048
    ds_read_b128 a[20:23], v26 offset:10240
    ds_read_b64_tr_b16 a[52:53], v33 offset:0
    ds_read_b64_tr_b16 a[54:55], v33 offset:2048
    ds_read_b128 a[24:27], v26 offset:12288
    ds_read_b64_tr_b16 a[56:57], v34 offset:0
    ds_read_b64_tr_b16 a[58:59], v34 offset:2048
    ds_read_b128 a[28:31], v26 offset:14336
    ds_read_b64_tr_b16 a[60:61], v35 offset:0
    ds_read_b64_tr_b16 a[62:63], v35 offset:2048
    s_mov_b32 s51, 0
    s_waitcnt lgkmcnt(15)
    s_mov_b32 s52, 0
    buffer_store_dwordx4 a[192:195], v53, s[8:11], s52 offen sc1
    s_mov_b32 s52, 262144
    buffer_store_dwordx4 a[196:199], v53, s[8:11], s52 offen sc1
    s_mov_b32 s52, 524288
    buffer_store_dwordx4 a[200:203], v53, s[8:11], s52 offen sc1
    s_mov_b32 s52, 786432
    buffer_store_dwordx4 a[204:207], v53, s[8:11], s52 offen sc1
    s_waitcnt lgkmcnt(0)
    s_cmp_lg_u32 s57, 0
    s_cbranch_scc1 k12_v_6
k12_loop_8:
    v_mfma_f32_16x16x32_bf16 v[64:67], a[32:35], a[0:3], v[64:67]
    ds_read_b128 a[64:67], v27 offset:0
    v_mfma_f32_16x16x32_bf16 v[80:83], a[32:35], a[4:7], v[80:83]
    ds_read_b64_tr_b16 a[96:97], v28 offset:16384
    v_mfma_f32_16x16x32_bf16 v[96:99], a[32:35], a[8:11], v[96:99]
    v_mfma_f32_16x16x32_bf16 v[112:115], a[32:35], a[12:15], v[112:115]
    s_cmp_eq_u32 s51, s46
    s_cbranch_scc1 k12_ool_10
k12_oolret_11:
    v_mfma_f32_16x16x32_bf16 v[128:131], a[32:35], a[16:19], v[128:131]
    ds_read_b64_tr_b16 a[98:99], v28 offset:18432
    v_mfma_f32_16x16x32_bf16 v[144:147], a[32:35], a[20:23], v[144:147]
    ds_read_b128 a[68:71], v27 offset:2048
    v_mfma_f32_16x16x32_bf16 a[128:131], a[32:35], a[24:27], a[128:131]
    v_mfma_f32_16x16x32_bf16 a[160:163], a[32:35], a[28:31], a[160:163]
    ds_read_b64_tr_b16 a[100:101], v29 offset:16384
    v_mfma_f32_16x16x32_bf16 v[160:163], a[36:39], a[0:3], v[160:163]
    v_mfma_f32_16x16x32_bf16 v[176:179], a[36:39], a[4:7], v[176:179]
    ds_read_b64_tr_b16 a[102:103], v29 offset:18432
    v_mfma_f32_16x16x32_bf16 v[192:195], a[36:39], a[8:11], v[192:195]
    v_mfma_f32_16x16x32_bf16 v[208:211], a[36:39], a[12:15], v[208:211]
    ds_read_b128 a[72:75], v27 offset:4096
    v_mfma_f32_16x16x32_bf16 v[224:227], a[36:39], a[16:19], v[224:227]
    v_mfma_f32_16x16x32_bf16 v[240:243], a[36:39], a[20:23], v[240:243]
    v_mfma_f32_16x16x32_bf16 a[132:135], a[36:39], a[24:27], a[132:135]
    ds_read_b64_tr_b16 a[104:105], v30 offset:16384
    v_mfma_f32_16x16x32_bf16 a[164:167], a[36:39], a[28:31], a[164:167]
    v_mfma_f32_16x16x32_bf16 v[68:71], a[40:43], a[0:3], v[68:71]
    ds_read_b64_tr_b16 a[106:107], v30 offset:18432
    v_mfma_f32_16x16x32_bf16 v[84:87], a[40:43], a[4:7], v[84:87]
    v_mfma_f32_16x16x32_bf16 v[100:103], a[40:43], a[8:11], v[100:103]
    ds_read_b128 a[76:79], v27 offset:6144
    v_mfma_f32_16x16x32_bf16 v[116:119], a[40:43], a[12:15], v[116:119]
    v_mfma_f32_16x16x32_bf16 v[132:135], a[40:43], a[16:19], v[132:135]
    ds_read_b64_tr_b16 a[108:109], v31 offset:16384
    v_mfma_f32_16x16x32_bf16 v[148:151], a[40:43], a[20:23], v[148:151]
    v_mfma_f32_16x16x32_bf16 a[136:139], a[40:43], a[24:27], a[136:139]
    ds_read_b64_tr_b16 a[110:111], v31 offset:18432
    v_mfma_f32_16x16x32_bf16 a[168:171], a[40:43], a[28:31], a[168:171]
    v_mfma_f32_16x16x32_bf16 v[164:167], a[44:47], a[0:3], v[164:167]
    ds_read_b128 a[80:83], v27 offset:8192
    v_mfma_f32_16x16x32_bf16 v[180:183], a[44:47], a[4:7], v[180:183]
    v_mfma_f32_16x16x32_bf16 v[196:199], a[44:47], a[8:11], v[196:199]
    ds_read_b64_tr_b16 a[112:113], v32 offset:16384
    v_mfma_f32_16x16x32_bf16 v[212:215], a[44:47], a[12:15], v[212:215]
    v_mfma_f32_16x16x32_bf16 v[228:231], a[44:47], a[16:19], v[228:231]
    ds_read_b64_tr_b16 a[114:115], v32 offset:18432
    v_mfma_f32_16x16x32_bf16 v[244:247], a[44:47], a[20:23], v[244:247]
    v_mfma_f32_16x16x32_bf16 a[140:143], a[44:47], a[24:27], a[140:143]
    ds_read_b128 a[84:87], v27 offset:10240
    v_mfma_f32_16x16x32_bf16 a[172:175], a[44:47], a[28:31], a[172:175]
    v_mfma_f32_16x16x32_bf16 v[72:75], a[48:51], a[0:3], v[72:75]
    ds_read_b64_tr_b16 a[116:117], v33 offset:16384
    v_mfma_f32_16x16x32_bf16 v[88:91], a[48:51], a[4:7], v[88:91]
    v_mfma_f32_16x16x32_bf16 v[104:107], a[48:51], a[8:11], v[104:107]
    ds_read_b64_tr_b16 a[118:119], v33 offset:18432
    v_mfma_f32_16x16x32_bf16 v[120:123], a[48:51], a[12:15], v[120:123]
    v_mfma_f32_16x16x32_bf16 v[136:139], a[48:51], a[16:19], v[136:139]
    ds_read_b128 a[88:91], v27 offset:12288
    v_mfma_f32_16x16x32_bf16 v[152:155], a[48:51], a[20:23], v[152:155]
    v_mfma_f32_16x16x32_bf16 a[144:147], a[48:51], a[24:27], a[144:147]
    v_mfma_f32_16x16x32_bf16 a[176:179], a[48:51], a[28:31], a[176:179]
    ds_read_b64_tr_b16 a[120:121], v34 offset:16384
    v_mfma_f32_16x16x32_bf16 v[168:171], a[52:55], a[0:3], v[168:171]
    v_mfma_f32_16x16x32_bf16 v[184:187], a[52:55], a[4:7], v[184:187]
    ds_read_b64_tr_b16 a[122:123], v34 offset:18432
    v_mfma_f32_16x16x32_bf16 v[200:203], a[52:55], a[8:11], v[200:203]
    v_mfma_f32_16x16x32_bf16 v[216:219], a[52:55], a[12:15], v[216:219]
    ds_read_b128 a[92:95], v27 offset:14336
    v_mfma_f32_16x16x32_bf16 v[232:235], a[52:55], a[16:19], v[232:235]
    v_mfma_f32_16x16x32_bf16 v[248:251], a[52:55], a[20:23], v[248:251]
    ds_read_b64_tr_b16 a[124:125], v35 offset:16384
    v_mfma_f32_16x16x32_bf16 a[148:151], a[52:55], a[24:27], a[148:151]
    v_mfma_f32_16x16x32_bf16 a[180:183], a[52:55], a[28:31], a[180:183]
    ds_read_b64_tr_b16 a[126:127], v35 offset:18432
    v_mfma_f32_16x16x32_bf16 v[76:79], a[56:59], a[0:3], v[76:79]
    v_mfma_f32_16x16x32_bf16 v[92:95], a[56:59], a[4:7], v[92:95]
    v_mfma_f32_16x16x32_bf16 v[108:111], a[56:59], a[8:11], v[108:111]
    v_mfma_f32_16x16x32_bf16 v[124:127], a[56:59], a[12:15], v[124:127]
    v_mfma_f32_16x16x32_bf16 v[140:143], a[56:59], a[16:19], v[140:143]
    v_mfma_f32_16x16x32_bf16 v[156:159], a[56:59], a[20:23], v[156:159]
    v_mfma_f32_16x16x32_bf16 a[152:155], a[56:59], a[24:27], a[152:155]
    v_mfma_f32_16x16x32_bf16 a[184:187], a[56:59], a[28:31], a[184:187]
    v_mfma_f32_16x16x32_bf16 v[172:175], a[60:63], a[0:3], v[172:175]
    v_mfma_f32_16x16x32_bf16 v[188:191], a[60:63], a[4:7], v[188:191]
    v_mfma_f32_16x16x32_bf16 v[204:207], a[60:63], a[8:11], v[204:207]
    v_mfma_f32_16x16x32_bf16 v[220:223], a[60:63], a[12:15], v[220:223]
    v_mfma_f32_16x16x32_bf16 v[236:239], a[60:63], a[16:19], v[236:239]
    v_mfma_f32_16x16x32_bf16 v[252:255], a[60:63], a[20:23], v[252:255]
    v_mfma_f32_16x16x32_bf16 a[156:159], a[60:63], a[24:27], a[156:159]
    v_mfma_f32_16x16x32_bf16 a[188:191], a[60:63], a[28:31], a[188:191]
    s_waitcnt vmcnt(0) lgkmcnt(0)
    s_barrier
    v_mfma_f32_16x16x32_bf16 v[64:67], a[96:99], a[64:67], v[64:67]
    s_cmp_ge_u32 s49, 1024
    s_cselect_b32 s18, 0, s18
    s_cselect_b32 s22, 0, s22
    ds_read_b128 a[0:3], v26 offset:32768
    v_mfma_f32_16x16x32_bf16 v[80:83], a[96:99], a[68:71], v[80:83]
    s_add_u32 m0, s48, 0
    ds_read_b64_tr_b16 a[32:33], v28 offset:32768
    v_mfma_f32_16x16x32_bf16 v[96:99], a[96:99], a[72:75], v[96:99]
    buffer_load_dwordx4 v10, s[16:19], s49 offen offset:0 lds
    v_mfma_f32_16x16x32_bf16 v[112:115], a[96:99], a[76:79], v[112:115]
    ds_read_b64_tr_b16 a[34:35], v28 offset:34816
    v_mfma_f32_16x16x32_bf16 v[128:131], a[96:99], a[80:83], v[128:131]
    buffer_load_dwordx4 v11, s[16:19], s49 offen offset:1024 lds
    v_mfma_f32_16x16x32_bf16 v[144:147], a[96:99], a[84:87], v[144:147]
    ds_read_b128 a[4:7], v26 offset:34816
    v_mfma_f32_16x16x32_bf16 a[128:131], a[96:99], a[88:91], a[128:131]
    v_mfma_f32_16x16x32_bf16 a[160:163], a[96:99], a[92:95], a[160:163]
    ds_read_b64_tr_b16 a[36:37], v29 offset:32768
    v_mfma_f32_16x16x32_bf16 v[160:163], a[100:103], a[64:67], v[160:163]
    buffer_load_dwordx4 v12, s[16:19], s49 offen offset:2048 lds
    v_mfma_f32_16x16x32_bf16 v[176:179], a[100:103], a[68:71], v[176:179]
    ds_read_b64_tr_b16 a[38:39], v29 offset:34816
    v_mfma_f32_16x16x32_bf16 v[192:195], a[100:103], a[72:75], v[192:195]
    v_mfma_f32_16x16x32_bf16 v[208:211], a[100:103], a[76:79], v[208:211]
    buffer_load_dwordx4 v13, s[16:19], s49 offen offset:3072 lds
    ds_read_b128 a[8:11], v26 offset:36864
    v_mfma_f32_16x16x32_bf16 v[224:227], a[100:103], a[80:83], v[224:227]
    v_mfma_f32_16x16x32_bf16 v[240:243], a[100:103], a[84:87], v[240:243]
    s_add_u32 m0, s48, 4096
    v_mfma_f32_16x16x32_bf16 a[132:135], a[100:103], a[88:91], a[132:135]
    ds_read_b64_tr_b16 a[40:41], v30 offset:32768
    v_mfma_f32_16x16x32_bf16 a[164:167], a[100:103], a[92:95], a[164:167]
    buffer_load_dwordx4 v14, s[16:19], s49 offen offset:0 lds
    v_mfma_f32_16x16x32_bf16 v[68:71], a[104:107], a[64:67], v[68:71]
    ds_read_b64_tr_b16 a[42:43], v30 offset:34816
    v_mfma_f32_16x16x32_bf16 v[84:87], a[104:107], a[68:71], v[84:87]
    v_mfma_f32_16x16x32_bf16 v[100:103], a[104:107], a[72:75], v[100:103]
    buffer_load_dwordx4 v15, s[16:19], s49 offen offset:1024 lds
    ds_read_b128 a[12:15], v26 offset:38912
    v_mfma_f32_16x16x32_bf16 v[116:119], a[104:107], a[76:79], v[116:119]
    v_mfma_f32_16x16x32_bf16 v[132:135], a[104:107], a[80:83], v[132:135]
    ds_read_b64_tr_b16 a[44:45], v31 offset:32768
    v_mfma_f32_16x16x32_bf16 v[148:151], a[104:107], a[84:87], v[148:151]
    v_mfma_f32_16x16x32_bf16 a[136:139], a[104:107], a[88:91], a[136:139]
    buffer_load_dwordx4 v16, s[16:19], s49 offen offset:2048 lds
    ds_read_b64_tr_b16 a[46:47], v31 offset:34816
    v_mfma_f32_16x16x32_bf16 a[168:171], a[104:107], a[92:95], a[168:171]
    v_mfma_f32_16x16x32_bf16 v[164:167], a[108:111], a[64:67], v[164:167]
    ds_read_b128 a[16:19], v26 offset:40960
    v_mfma_f32_16x16x32_bf16 v[180:183], a[108:111], a[68:71], v[180:183]
    buffer_load_dwordx4 v17, s[16:19], s49 offen offset:3072 lds
    v_mfma_f32_16x16x32_bf16 v[196:199], a[108:111], a[72:75], v[196:199]
    ds_read_b64_tr_b16 a[48:49], v32 offset:32768
    v_mfma_f32_16x16x32_bf16 v[212:215], a[108:111], a[76:79], v[212:215]
    s_add_u32 s49, s49, 128
    v_mfma_f32_16x16x32_bf16 v[228:231], a[108:111], a[80:83], v[228:231]
    s_add_u32 m0, s48, 65536
    ds_read_b64_tr_b16 a[50:51], v32 offset:34816
    v_mfma_f32_16x16x32_bf16 v[244:247], a[108:111], a[84:87], v[244:247]
    buffer_load_dwordx4 v18, s[20:23], s50 offen offset:0 lds
    v_mfma_f32_16x16x32_bf16 a[140:143], a[108:111], a[88:91], a[140:143]
    ds_read_b128 a[20:23], v26 offset:43008
    v_mfma_f32_16x16x32_bf16 a[172:175], a[108:111], a[92:95], a[172:175]
    v_mfma_f32_16x16x32_bf16 v[72:75], a[112:115], a[64:67], v[72:75]
    buffer_load_dwordx4 v19, s[20:23], s50 offen offset:1024 lds
    ds_read_b64_tr_b16 a[52:53], v33 offset:32768
    v_mfma_f32_16x16x32_bf16 v[88:91], a[112:115], a[68:71], v[88:91]
    v_mfma_f32_16x16x32_bf16 v[104:107], a[112:115], a[72:75], v[104:107]
    ds_read_b64_tr_b16 a[54:55], v33 offset:34816
    v_mfma_f32_16x16x32_bf16 v[120:123], a[112:115], a[76:79], v[120:123]
    buffer_load_dwordx4 v20, s[20:23], s50 offen offset:2048 lds
    v_mfma_f32_16x16x32_bf16 v[136:139], a[112:115], a[80:83], v[136:139]
    ds_read_b128 a[24:27], v26 offset:45056
    v_mfma_f32_16x16x32_bf16 v[152:155], a[112:115], a[84:87], v[152:155]
    v_mfma_f32_16x16x32_bf16 a[144:147], a[112:115], a[88:91], a[144:147]
    v_mfma_f32_16x16x32_bf16 a[176:179], a[112:115], a[92:95], a[176:179]
    buffer_load_dwordx4 v21, s[20:23], s50 offen offset:3072 lds
    ds_read_b64_tr_b16 a[56:57], v34 offset:32768
    v_mfma_f32_16x16x32_bf16 v[168:171], a[116:119], a[64:67], v[168:171]
    s_add_u32 m0, s48, 69632
    v_mfma_f32_16x16x32_bf16 v[184:187], a[116:119], a[68:71], v[184:187]
    ds_read_b64_tr_b16 a[58:59], v34 offset:34816
    v_mfma_f32_16x16x32_bf16 v[200:203], a[116:119], a[72:75], v[200:203]
    buffer_load_dwordx4 v22, s[20:23], s50 offen offset:0 lds
    v_mfma_f32_16x16x32_bf16 v[216:219], a[116:119], a[76:79], v[216:219]
    ds_read_b128 a[28:31], v26 offset:47104
    v_mfma_f32_16x16x32_bf16 v[232:235], a[116:119], a[80:83], v[232:235]
    v_mfma_f32_16x16x32_bf16 v[248:251], a[116:119], a[84:87], v[248:251]
    ds_read_b64_tr_b16 a[60:61], v35 offset:32768
    v_mfma_f32_16x16x32_bf16 a[148:151], a[116:119], a[88:91], a[148:151]
    buffer_load_dwordx4 v23, s[20:23], s50 offen offset:1024 lds
    v_mfma_f32_16x16x32_bf16 a[180:183], a[116:119], a[92:95], a[180:183]
    ds_read_b64_tr_b16 a[62:63], v35 offset:34816
    v_mfma_f32_16x16x32_bf16 v[76:79], a[120:123], a[64:67], v[76:79]
    v_mfma_f32_16x16x32_bf16 v[92:95], a[120:123], a[68:71], v[92:95]
    buffer_load_dwordx4 v24, s[20:23], s50 offen offset:2048 lds
    v_mfma_f32_16x16x32_bf16 v[108:111], a[120:123], a[72:75], v[108:111]
    v_mfma_f32_16x16x32_bf16 v[124:127], a[120:123], a[76:79], v[124:127]
    v_mfma_f32_16x16x32_bf16 v[140:143], a[120:123], a[80:83], v[140:143]
    v_mfma_f32_16x16x32_bf16 v[156:159], a[120:123], a[84:87], v[156:159]
    buffer_load_dwordx4 v25, s[20:23], s50 offen offset:3072 lds
    v_mfma_f32_16x16x32_bf16 a[152:155], a[120:123], a[88:91], a[152:155]
    v_mfma_f32_16x16x32_bf16 a[184:187], a[120:123], a[92:95], a[184:187]
    s_add_u32 s50, s50, 0x80000
    v_mfma_f32_16x16x32_bf16 v[172:175], a[124:127], a[64:67], v[172:175]
    v_mfma_f32_16x16x32_bf16 v[188:191], a[124:127], a[68:71], v[188:191]
    s_cmp_eq_u32 s51, s53
    s_cbranch_scc1 k12_ool_12
k12_oolret_13:
    v_mfma_f32_16x16x32_bf16 v[204:207], a[124:127], a[72:75], v[204:207]
    v_mfma_f32_16x16x32_bf16 v[220:223], a[124:127], a[76:79], v[220:223]
    s_cmp_eq_u32 s51, s63
    s_cbranch_scc1 k12_ool_14
k12_oolret_15:
    v_mfma_f32_16x16x32_bf16 v[236:239], a[124:127], a[80:83], v[236:239]
    v_mfma_f32_16x16x32_bf16 v[252:255], a[124:127], a[84:87], v[252:255]
    s_add_u32 s51, s51, 1
    v_mfma_f32_16x16x32_bf16 a[156:159], a[124:127], a[88:91], a[156:159]
    v_mfma_f32_16x16x32_bf16 a[188:191], a[124:127], a[92:95], a[188:191]
    s_waitcnt lgkmcnt(0)
    v_mfma_f32_16x16x32_bf16 v[64:67], a[32:35], a[0:3], v[64:67]
    ds_read_b128 a[64:67], v27 offset:32768
    v_mfma_f32_16x16x32_bf16 v[80:83], a[32:35], a[4:7], v[80:83]
    ds_read_b64_tr_b16 a[96:97], v28 offset:49152
    v_mfma_f32_16x16x32_bf16 v[96:99], a[32:35], a[8:11], v[96:99]
    v_mfma_f32_16x16x32_bf16 v[112:115], a[32:35], a[12:15], v[112:115]
    ds_read_b64_tr_b16 a[98:99], v28 offset:51200
    v_mfma_f32_16x16x32_bf16 v[128:131], a[32:35], a[16:19], v[128:131]
    v_mfma_f32_16x16x32_bf16 v[144:147], a[32:35], a[20:23], v[144:147]
    ds_read_b128 a[68:71], v27 offset:34816
    v_mfma_f32_16x16x32_bf16 a[128:131], a[32:35], a[24:27], a[128:131]
    v_mfma_f32_16x16x32_bf16 a[160:163], a[32:35], a[28:31], a[160:163]
    ds_read_b64_tr_b16 a[100:101], v29 offset:49152
    v_mfma_f32_16x16x32_bf16 v[160:163], a[36:39], a[0:3], v[160:163]
    v_mfma_f32_16x16x32_bf16 v[176:179], a[36:39], a[4:7], v[176:179]
    ds_read_b64_tr_b16 a[102:103], v29 offset:51200
    v_mfma_f32_16x16x32_bf16 v[192:195], a[36:39], a[8:11], v[192:195]
    v_mfma_f32_16x16x32_bf16 v[208:211], a[36:39], a[12:15], v[208:211]
    ds_read_b128 a[72:75], v27 offset:36864
    v_mfma_f32_16x16x32_bf16 v[224:227], a[36:39], a[16:19], v[224:227]
    v_mfma_f32_16x16x32_bf16 v[240:243], a[36:39], a[20:23], v[240:243]
    v_mfma_f32_16x16x32_bf16 a[132:135], a[36:39], a[24:27], a[132:135]
    ds_read_b64_tr_b16 a[104:105], v30 offset:49152
    v_mfma_f32_16x16x32_bf16 a[164:167], a[36:39], a[28:31], a[164:167]
    v_mfma_f32_16x16x32_bf16 v[68:71], a[40:43], a[0:3], v[68:71]
    ds_read_b64_tr_b16 a[106:107], v30 offset:51200
    v_mfma_f32_16x16x32_bf16 v[84:87], a[40:43], a[4:7], v[84:87]
    v_mfma_f32_16x16x32_bf16 v[100:103], a[40:43], a[8:11], v[100:103]
    ds_read_b128 a[76:79], v27 offset:38912
    v_mfma_f32_16x16x32_bf16 v[116:119], a[40:43], a[12:15], v[116:119]
    v_mfma_f32_16x16x32_bf16 v[132:135], a[40:43], a[16:19], v[132:135]
    ds_read_b64_tr_b16 a[108:109], v31 offset:49152
    v_mfma_f32_16x16x32_bf16 v[148:151], a[40:43], a[20:23], v[148:151]
    v_mfma_f32_16x16x32_bf16 a[136:139], a[40:43], a[24:27], a[136:139]
    ds_read_b64_tr_b16 a[110:111], v31 offset:51200
    v_mfma_f32_16x16x32_bf16 a[168:171], a[40:43], a[28:31], a[168:171]
    v_mfma_f32_16x16x32_bf16 v[164:167], a[44:47], a[0:3], v[164:167]
    ds_read_b128 a[80:83], v27 offset:40960
    v_mfma_f32_16x16x32_bf16 v[180:183], a[44:47], a[4:7], v[180:183]
    v_mfma_f32_16x16x32_bf16 v[196:199], a[44:47], a[8:11], v[196:199]
    ds_read_b64_tr_b16 a[112:113], v32 offset:49152
    v_mfma_f32_16x16x32_bf16 v[212:215], a[44:47], a[12:15], v[212:215]
    v_mfma_f32_16x16x32_bf16 v[228:231], a[44:47], a[16:19], v[228:231]
    ds_read_b64_tr_b16 a[114:115], v32 offset:51200
    v_mfma_f32_16x16x32_bf16 v[244:247], a[44:47], a[20:23], v[244:247]
    v_mfma_f32_16x16x32_bf16 a[140:143], a[44:47], a[24:27], a[140:143]
    ds_read_b128 a[84:87], v27 offset:43008
    v_mfma_f32_16x16x32_bf16 a[172:175], a[44:47], a[28:31], a[172:175]
    v_mfma_f32_16x16x32_bf16 v[72:75], a[48:51], a[0:3], v[72:75]
    ds_read_b64_tr_b16 a[116:117], v33 offset:49152
    v_mfma_f32_16x16x32_bf16 v[88:91], a[48:51], a[4:7], v[88:91]
    v_mfma_f32_16x16x32_bf16 v[104:107], a[48:51], a[8:11], v[104:107]
    ds_read_b64_tr_b16 a[118:119], v33 offset:51200
    v_mfma_f32_16x16x32_bf16 v[120:123], a[48:51], a[12:15], v[120:123]
    v_mfma_f32_16x16x32_bf16 v[136:139], a[48:51], a[16:19], v[136:139]
    ds_read_b128 a[88:91], v27 offset:45056
    v_mfma_f32_16x16x32_bf16 v[152:155], a[48:51], a[20:23], v[152:155]
    v_mfma_f32_16x16x32_bf16 a[144:147], a[48:51], a[24:27], a[144:147]
    v_mfma_f32_16x16x32_bf16 a[176:179], a[48:51], a[28:31], a[176:179]
    ds_read_b64_tr_b16 a[120:121], v34 offset:49152
    v_mfma_f32_16x16x32_bf16 v[168:171], a[52:55], a[0:3], v[168:171]
    v_mfma_f32_16x16x32_bf16 v[184:187], a[52:55], a[4:7], v[184:187]
    ds_read_b64_tr_b16 a[122:123], v34 offset:51200
    v_mfma_f32_16x16x32_bf16 v[200:203], a[52:55], a[8:11], v[200:203]
    v_mfma_f32_16x16x32_bf16 v[216:219], a[52:55], a[12:15], v[216:219]
    ds_read_b128 a[92:95], v27 offset:47104
    v_mfma_f32_16x16x32_bf16 v[232:235], a[52:55], a[16:19], v[232:235]
    v_mfma_f32_16x16x32_bf16 v[248:251], a[52:55], a[20:23], v[248:251]
    ds_read_b64_tr_b16 a[124:125], v35 offset:49152
    v_mfma_f32_16x16x32_bf16 a[148:151], a[52:55], a[24:27], a[148:151]
    v_mfma_f32_16x16x32_bf16 a[180:183], a[52:55], a[28:31], a[180:183]
    ds_read_b64_tr_b16 a[126:127], v35 offset:51200
    v_mfma_f32_16x16x32_bf16 v[76:79], a[56:59], a[0:3], v[76:79]
    v_mfma_f32_16x16x32_bf16 v[92:95], a[56:59], a[4:7], v[92:95]
    v_mfma_f32_16x16x32_bf16 v[108:111], a[56:59], a[8:11], v[108:111]
    v_mfma_f32_16x16x32_bf16 v[124:127], a[56:59], a[12:15], v[124:127]
    v_mfma_f32_16x16x32_bf16 v[140:143], a[56:59], a[16:19], v[140:143]
    v_mfma_f32_16x16x32_bf16 v[156:159], a[56:59], a[20:23], v[156:159]
    v_mfma_f32_16x16x32_bf16 a[152:155], a[56:59], a[24:27], a[152:155]
    v_mfma_f32_16x16x32_bf16 a[184:187], a[56:59], a[28:31], a[184:187]
    s_sub_u32 s52, s51, 1
    s_cmp_eq_u32 s52, s46
    s_cbranch_scc1 k12_ool_18
k12_oolret_19:
    v_mfma_f32_16x16x32_bf16 v[172:175], a[60:63], a[0:3], v[172:175]
    v_mfma_f32_16x16x32_bf16 v[188:191], a[60:63], a[4:7], v[188:191]
    v_mfma_f32_16x16x32_bf16 v[204:207], a[60:63], a[8:11], v[204:207]
    v_mfma_f32_16x16x32_bf16 v[220:223], a[60:63], a[12:15], v[220:223]
    v_mfma_f32_16x16x32_bf16 v[236:239], a[60:63], a[16:19], v[236:239]
    v_mfma_f32_16x16x32_bf16 v[252:255], a[60:63], a[20:23], v[252:255]
    v_mfma_f32_16x16x32_bf16 a[156:159], a[60:63], a[24:27], a[156:159]
    v_mfma_f32_16x16x32_bf16 a[188:191], a[60:63], a[28:31], a[188:191]
    s_waitcnt vmcnt(0) lgkmcnt(0)
    s_barrier
    s_cmp_eq_u32 s51, 7
    s_cbranch_scc1 k12_last_9
    v_mfma_f32_16x16x32_bf16 v[64:67], a[96:99], a[64:67], v[64:67]
    ds_read_b128 a[0:3], v26 offset:0
    v_mfma_f32_16x16x32_bf16 v[80:83], a[96:99], a[68:71], v[80:83]
    s_add_u32 m0, s48, 32768
    ds_read_b64_tr_b16 a[32:33], v28 offset:0
    v_mfma_f32_16x16x32_bf16 v[96:99], a[96:99], a[72:75], v[96:99]
    buffer_load_dwordx4 v10, s[16:19], s49 offen offset:0 lds
    v_mfma_f32_16x16x32_bf16 v[112:115], a[96:99], a[76:79], v[112:115]
    ds_read_b64_tr_b16 a[34:35], v28 offset:2048
    v_mfma_f32_16x16x32_bf16 v[128:131], a[96:99], a[80:83], v[128:131]
    buffer_load_dwordx4 v11, s[16:19], s49 offen offset:1024 lds
    v_mfma_f32_16x16x32_bf16 v[144:147], a[96:99], a[84:87], v[144:147]
    ds_read_b128 a[4:7], v26 offset:2048
    v_mfma_f32_16x16x32_bf16 a[128:131], a[96:99], a[88:91], a[128:131]
    v_mfma_f32_16x16x32_bf16 a[160:163], a[96:99], a[92:95], a[160:163]
    ds_read_b64_tr_b16 a[36:37], v29 offset:0
    v_mfma_f32_16x16x32_bf16 v[160:163], a[100:103], a[64:67], v[160:163]
    buffer_load_dwordx4 v12, s[16:19], s49 offen offset:2048 lds
    v_mfma_f32_16x16x32_bf16 v[176:179], a[100:103], a[68:71], v[176:179]
    ds_read_b64_tr_b16 a[38:39], v29 offset:2048
    v_mfma_f32_16x16x32_bf16 v[192:195], a[100:103], a[72:75], v[192:195]
    v_mfma_f32_16x16x32_bf16 v[208:211], a[100:103], a[76:79], v[208:211]
    buffer_load_dwordx4 v13, s[16:19], s49 offen offset:3072 lds
    ds_read_b128 a[8:11], v26 offset:4096
    v_mfma_f32_16x16x32_bf16 v[224:227], a[100:103], a[80:83], v[224:227]
    v_mfma_f32_16x16x32_bf16 v[240:243], a[100:103], a[84:87], v[240:243]
    s_add_u32 m0, s48, 36864
    v_mfma_f32_16x16x32_bf16 a[132:135], a[100:103], a[88:91], a[132:135]
    ds_read_b64_tr_b16 a[40:41], v30 offset:0
    v_mfma_f32_16x16x32_bf16 a[164:167], a[100:103], a[92:95], a[164:167]
    buffer_load_dwordx4 v14, s[16:19], s49 offen offset:0 lds
    v_mfma_f32_16x16x32_bf16 v[68:71], a[104:107], a[64:67], v[68:71]
    ds_read_b64_tr_b16 a[42:43], v30 offset:2048
    v_mfma_f32_16x16x32_bf16 v[84:87], a[104:107], a[68:71], v[84:87]
    v_mfma_f32_16x16x32_bf16 v[100:103], a[104:107], a[72:75], v[100:103]
    buffer_load_dwordx4 v15, s[16:19], s49 offen offset:1024 lds
    ds_read_b128 a[12:15], v26 offset:6144
    v_mfma_f32_16x16x32_bf16 v[116:119], a[104:107], a[76:79], v[116:119]
    v_mfma_f32_16x16x32_bf16 v[132:135], a[104:107], a[80:83], v[132:135]
    ds_read_b64_tr_b16 a[44:45], v31 offset:0
    v_mfma_f32_16x16x32_bf16 v[148:151], a[104:107], a[84:87], v[148:151]
    v_mfma_f32_16x16x32_bf16 a[136:139], a[104:107], a[88:91], a[136:139]
    buffer_load_dwordx4 v16, s[16:19], s49 offen offset:2048 lds
    ds_read_b64_tr_b16 a[46:47], v31 offset:2048
    v_mfma_f32_16x16x32_bf16 a[168:171], a[104:107], a[92:95], a[168:171]
    v_mfma_f32_16x16x32_bf16 v[164:167], a[108:111], a[64:67], v[164:167]
    ds_read_b128 a[16:19], v26 offset:8192
    v_mfma_f32_16x16x32_bf16 v[180:183], a[108:111], a[68:71], v[180:183]
    buffer_load_dwordx4 v17, s[16:19], s49 offen offset:3072 lds
    v_mfma_f32_16x16x32_bf16 v[196:199], a[108:111], a[72:75], v[196:199]
    ds_read_b64_tr_b16 a[48:49], v32 offset:0
    v_mfma_f32_16x16x32_bf16 v[212:215], a[108:111], a[76:79], v[212:215]
    s_add_u32 s49, s49, 128
    v_mfma_f32_16x16x32_bf16 v[228:231], a[108:111], a[80:83], v[228:231]
    s_add_u32 m0, s48, 98304
    ds_read_b64_tr_b16 a[50:51], v32 offset:2048
    v_mfma_f32_16x16x32_bf16 v[244:247], a[108:111], a[84:87], v[244:247]
    buffer_load_dwordx4 v18, s[20:23], s50 offen offset:0 lds
    v_mfma_f32_16x16x32_bf16 a[140:143], a[108:111], a[88:91], a[140:143]
    ds_read_b128 a[20:23], v26 offset:10240
    v_mfma_f32_16x16x32_bf16 a[172:175], a[108:111], a[92:95], a[172:175]
    v_mfma_f32_16x16x32_bf16 v[72:75], a[112:115], a[64:67], v[72:75]
    buffer_load_dwordx4 v19, s[20:23], s50 offen offset:1024 lds
    ds_read_b64_tr_b16 a[52:53], v33 offset:0
    v_mfma_f32_16x16x32_bf16 v[88:91], a[112:115], a[68:71], v[88:91]
    v_mfma_f32_16x16x32_bf16 v[104:107], a[112:115], a[72:75], v[104:107]
    ds_read_b64_tr_b16 a[54:55], v33 offset:2048
    v_mfma_f32_16x16x32_bf16 v[120:123], a[112:115], a[76:79], v[120:123]
    buffer_load_dwordx4 v20, s[20:23], s50 offen offset:2048 lds
    v_mfma_f32_16x16x32_bf16 v[136:139], a[112:115], a[80:83], v[136:139]
    ds_read_b128 a[24:27], v26 offset:12288
    v_mfma_f32_16x16x32_bf16 v[152:155], a[112:115], a[84:87], v[152:155]
    v_mfma_f32_16x16x32_bf16 a[144:147], a[112:115], a[88:91], a[144:147]
    v_mfma_f32_16x16x32_bf16 a[176:179], a[112:115], a[92:95], a[176:179]
    buffer_load_dwordx4 v21, s[20:23], s50 offen offset:3072 lds
    ds_read_b64_tr_b16 a[56:57], v34 offset:0
    v_mfma_f32_16x16x32_bf16 v[168:171], a[116:119], a[64:67], v[168:171]
    s_add_u32 m0, s48, 102400
    v_mfma_f32_16x16x32_bf16 v[184:187], a[116:119], a[68:71], v[184:187]
    ds_read_b64_tr_b16 a[58:59], v34 offset:2048
    v_mfma_f32_16x16x32_bf16 v[200:203], a[116:119], a[72:75], v[200:203]
    buffer_load_dwordx4 v22, s[20:23], s50 offen offset:0 lds
    v_mfma_f32_16x16x32_bf16 v[216:219], a[116:119], a[76:79], v[216:219]
    ds_read_b128 a[28:31], v26 offset:14336
    v_mfma_f32_16x16x32_bf16 v[232:235], a[116:119], a[80:83], v[232:235]
    v_mfma_f32_16x16x32_bf16 v[248:251], a[116:119], a[84:87], v[248:251]
    ds_read_b64_tr_b16 a[60:61], v35 offset:0
    v_mfma_f32_16x16x32_bf16 a[148:151], a[116:119], a[88:91], a[148:151]
    buffer_load_dwordx4 v23, s[20:23], s50 offen offset:1024 lds
    v_mfma_f32_16x16x32_bf16 a[180:183], a[116:119], a[92:95], a[180:183]
    ds_read_b64_tr_b16 a[62:63], v35 offset:2048
    v_mfma_f32_16x16x32_bf16 v[76:79], a[120:123], a[64:67], v[76:79]
    v_mfma_f32_16x16x32_bf16 v[92:95], a[120:123], a[68:71], v[92:95]
    buffer_load_dwordx4 v24, s[20:23], s50 offen offset:2048 lds
    v_mfma_f32_16x16x32_bf16 v[108:111], a[120:123], a[72:75], v[108:111]
    v_mfma_f32_16x16x32_bf16 v[124:127], a[120:123], a[76:79], v[124:127]
    v_mfma_f32_16x16x32_bf16 v[140:143], a[120:123], a[80:83], v[140:143]
    v_mfma_f32_16x16x32_bf16 v[156:159], a[120:123], a[84:87], v[156:159]
    buffer_load_dwordx4 v25, s[20:23], s50 offen offset:3072 lds
    v_mfma_f32_16x16x32_bf16 a[152:155], a[120:123], a[88:91], a[152:155]
    v_mfma_f32_16x16x32_bf16 a[184:187], a[120:123], a[92:95], a[184:187]
    s_add_u32 s50, s50, 0x80000
    v_mfma_f32_16x16x32_bf16 v[172:175], a[124:127], a[64:67], v[172:175]
    v_mfma_f32_16x16x32_bf16 v[188:191], a[124:127], a[68:71], v[188:191]
    s_cmp_eq_u32 s51, s53
    s_cbranch_scc1 k12_ool_20
k12_oolret_21:
    v_mfma_f32_16x16x32_bf16 v[204:207], a[124:127], a[72:75], v[204:207]
    v_mfma_f32_16x16x32_bf16 v[220:223], a[124:127], a[76:79], v[220:223]
    s_cmp_eq_u32 s51, 5
    s_cbranch_scc1 k12_ool_22
k12_oolret_23:
    v_mfma_f32_16x16x32_bf16 v[236:239], a[124:127], a[80:83], v[236:239]
    v_mfma_f32_16x16x32_bf16 v[252:255], a[124:127], a[84:87], v[252:255]
    s_add_u32 s51, s51, 1
    v_mfma_f32_16x16x32_bf16 a[156:159], a[124:127], a[88:91], a[156:159]
    v_mfma_f32_16x16x32_bf16 a[188:191], a[124:127], a[92:95], a[188:191]
    s_waitcnt lgkmcnt(0)
    s_branch k12_loop_8
k12_last_9:
    v_mfma_f32_16x16x32_bf16 v[64:67], a[96:99], a[64:67], v[64:67]
    s_add_u32 m0, s60, 98304
    v_mfma_f32_16x16x32_bf16 v[160:163], a[100:103], a[64:67], v[160:163]
    buffer_load_dwordx4 v38, s[12:15], s61 offen offset:0 lds
    v_mfma_f32_16x16x32_bf16 v[68:71], a[104:107], a[64:67], v[68:71]
    buffer_load_dwordx4 v39, s[12:15], s61 offen offset:1024 lds
    v_mfma_f32_16x16x32_bf16 v[164:167], a[108:111], a[64:67], v[164:167]
    v_mfma_f32_16x16x32_bf16 v[72:75], a[112:115], a[64:67], v[72:75]
    buffer_load_dwordx4 v40, s[12:15], s61 offen offset:2048 lds
    v_mfma_f32_16x16x32_bf16 v[168:171], a[116:119], a[64:67], v[168:171]
    v_cvt_pk_bf16_f32 v64, v64, v65
    v_cvt_pk_bf16_f32 v65, v66, v67
    v_cvt_pk_bf16_f32 v66, v160, v161
    v_mfma_f32_16x16x32_bf16 v[76:79], a[120:123], a[64:67], v[76:79]
    v_cvt_pk_bf16_f32 v67, v162, v163
    v_mfma_f32_16x16x32_bf16 v[172:175], a[124:127], a[64:67], v[172:175]
    v_cvt_pk_bf16_f32 v68, v68, v69
    v_cvt_pk_bf16_f32 v69, v70, v71
    v_cvt_pk_bf16_f32 v70, v164, v165
    v_mfma_f32_16x16x32_bf16 v[80:83], a[96:99], a[68:71], v[80:83]
    buffer_load_dwordx4 v41, s[12:15], s61 offen offset:3072 lds
    v_mfma_f32_16x16x32_bf16 v[176:179], a[100:103], a[68:71], v[176:179]
    s_add_u32 s61, s61, 0x80000
    v_cvt_pk_bf16_f32 v71, v166, v167
    v_cvt_pk_bf16_f32 v72, v72, v73
    v_cvt_pk_bf16_f32 v73, v74, v75
    v_mfma_f32_16x16x32_bf16 v[84:87], a[104:107], a[68:71], v[84:87]
    buffer_load_dwordx4 a[192:195], v36, s[8:11], s62 offen sc1
    buffer_load_dwordx4 a[196:199], v54, s[8:11], s62 offen sc1
    v_mfma_f32_16x16x32_bf16 v[180:183], a[108:111], a[68:71], v[180:183]
    v_cvt_pk_bf16_f32 v74, v168, v169
    v_cvt_pk_bf16_f32 v75, v170, v171
    v_cvt_pk_bf16_f32 v76, v76, v77
    v_mfma_f32_16x16x32_bf16 v[88:91], a[112:115], a[68:71], v[88:91]
    v_cvt_pk_bf16_f32 v77, v78, v79
    v_cvt_pk_bf16_f32 v78, v172, v173
    v_cvt_pk_bf16_f32 v79, v174, v175
    v_mfma_f32_16x16x32_bf16 v[184:187], a[116:119], a[68:71], v[184:187]
    v_cvt_pk_bf16_f32 v80, v80, v81
    v_cvt_pk_bf16_f32 v81, v82, v83
    v_cvt_pk_bf16_f32 v82, v176, v177
    v_mfma_f32_16x16x32_bf16 v[92:95], a[120:123], a[68:71], v[92:95]
    buffer_load_dwordx4 a[200:203], v37, s[8:11], s62 offen sc1
    buffer_load_dwordx4 a[204:207], v55, s[8:11], s62 offen sc1
    v_mfma_f32_16x16x32_bf16 v[188:191], a[124:127], a[68:71], v[188:191]
    s_add_u32 s62, s62, 0x20000
    v_cvt_pk_bf16_f32 v83, v178, v179
    v_cvt_pk_bf16_f32 v84, v84, v85
    v_cvt_pk_bf16_f32 v85, v86, v87
    v_mfma_f32_16x16x32_bf16 a[128:131], a[96:99], a[88:91], a[128:131]
    v_cvt_pk_bf16_f32 v86, v180, v181
    v_cvt_pk_bf16_f32 v87, v182, v183
    v_mfma_f32_16x16x32_bf16 a[132:135], a[100:103], a[88:91], a[132:135]
    v_cvt_pk_bf16_f32 v88, v88, v89
    v_cvt_pk_bf16_f32 v89, v90, v91
    v_cvt_pk_bf16_f32 v90, v184, v185
    v_mfma_f32_16x16x32_bf16 v[96:99], a[96:99], a[72:75], v[96:99]
    buffer_load_dwordx4 a[208:211], v36, s[8:11], s62 offen sc1
    buffer_load_dwordx4 a[212:215], v54, s[8:11], s62 offen sc1
    v_mfma_f32_16x16x32_bf16 v[192:195], a[100:103], a[72:75], v[192:195]
    v_cvt_pk_bf16_f32 v91, v186, v187
    v_cvt_pk_bf16_f32 v92, v92, v93
    v_cvt_pk_bf16_f32 v93, v94, v95
    v_mfma_f32_16x16x32_bf16 v[100:103], a[104:107], a[72:75], v[100:103]
    v_cvt_pk_bf16_f32 v94, v188, v189
    v_cvt_pk_bf16_f32 v95, v190, v191
    v_mfma_f32_16x16x32_bf16 v[196:199], a[108:111], a[72:75], v[196:199]
    v_accvgpr_read_b32 v56, a128
    v_accvgpr_read_b32 v57, a129
    v_accvgpr_read_b32 v58, a130
    v_mfma_f32_16x16x32_bf16 a[136:139], a[104:107], a[88:91], a[136:139]
    buffer_load_dwordx4 a[216:219], v37, s[8:11], s62 offen sc1
    buffer_load_dwordx4 a[220:223], v55, s[8:11], s62 offen sc1
    v_mfma_f32_16x16x32_bf16 a[140:143], a[108:111], a[88:91], a[140:143]
    s_add_u32 s62, s62, 0x20000
    v_accvgpr_read_b32 v59, a131
    v_accvgpr_read_b32 v60, a132
    v_cvt_pk_bf16_f32 v96, v96, v97
    v_mfma_f32_16x16x32_bf16 v[104:107], a[112:115], a[72:75], v[104:107]
    s_add_u32 m0, s60, 114688
    v_accvgpr_read_b32 v61, a133
    v_accvgpr_read_b32 v62, a134
    v_cvt_pk_bf16_f32 v97, v98, v99
    v_mfma_f32_16x16x32_bf16 v[200:203], a[116:119], a[72:75], v[200:203]
    v_accvgpr_read_b32 v63, a135
    v_cvt_pk_bf16_f32 v98, v192, v193
    v_cvt_pk_bf16_f32 v160, v56, v57
    v_mfma_f32_16x16x32_bf16 v[108:111], a[120:123], a[72:75], v[108:111]
    v_cvt_pk_bf16_f32 v99, v194, v195
    v_cvt_pk_bf16_f32 v161, v58, v59
    v_cvt_pk_bf16_f32 v100, v100, v101
    v_mfma_f32_16x16x32_bf16 v[204:207], a[124:127], a[72:75], v[204:207]
    buffer_load_dwordx4 v38, s[12:15], s61 offen offset:0 lds
    buffer_load_dwordx4 v39, s[12:15], s61 offen offset:1024 lds
    v_mfma_f32_16x16x32_bf16 a[144:147], a[112:115], a[88:91], a[144:147]
    v_cvt_pk_bf16_f32 v162, v60, v61
    v_cvt_pk_bf16_f32 v101, v102, v103
    v_cvt_pk_bf16_f32 v163, v62, v63
    v_mfma_f32_16x16x32_bf16 a[148:151], a[116:119], a[88:91], a[148:151]
    v_cvt_pk_bf16_f32 v102, v196, v197
    v_cvt_pk_bf16_f32 v103, v198, v199
    v_accvgpr_read_b32 v56, a136
    v_mfma_f32_16x16x32_bf16 v[112:115], a[96:99], a[76:79], v[112:115]
    v_accvgpr_read_b32 v57, a137
    v_accvgpr_read_b32 v58, a138
    v_accvgpr_read_b32 v59, a139
    v_mfma_f32_16x16x32_bf16 v[208:211], a[100:103], a[76:79], v[208:211]
    v_accvgpr_read_b32 v60, a140
    v_cvt_pk_bf16_f32 v104, v104, v105
    v_accvgpr_read_b32 v61, a141
    v_mfma_f32_16x16x32_bf16 v[116:119], a[104:107], a[76:79], v[116:119]
    buffer_load_dwordx4 v40, s[12:15], s61 offen offset:2048 lds
    buffer_load_dwordx4 v41, s[12:15], s61 offen offset:3072 lds
    v_mfma_f32_16x16x32_bf16 v[212:215], a[108:111], a[76:79], v[212:215]
    s_add_u32 s61, s61, 0x80000
    v_accvgpr_read_b32 v62, a142
    v_cvt_pk_bf16_f32 v105, v106, v107
    v_accvgpr_read_b32 v63, a143
    v_mfma_f32_16x16x32_bf16 a[152:155], a[120:123], a[88:91], a[152:155]
    v_cvt_pk_bf16_f32 v106, v200, v201
    v_cvt_pk_bf16_f32 v164, v56, v57
    v_cvt_pk_bf16_f32 v107, v202, v203
    v_mfma_f32_16x16x32_bf16 a[156:159], a[124:127], a[88:91], a[156:159]
    v_cvt_pk_bf16_f32 v165, v58, v59
    v_cvt_pk_bf16_f32 v108, v108, v109
    v_cvt_pk_bf16_f32 v166, v60, v61
    v_mfma_f32_16x16x32_bf16 v[120:123], a[112:115], a[76:79], v[120:123]
    v_cvt_pk_bf16_f32 v109, v110, v111
    v_cvt_pk_bf16_f32 v167, v62, v63
    v_cvt_pk_bf16_f32 v110, v204, v205
    v_mfma_f32_16x16x32_bf16 v[216:219], a[116:119], a[76:79], v[216:219]
    buffer_load_dwordx4 a[224:227], v36, s[8:11], s62 offen sc1
    v_cvt_pk_bf16_f32 v111, v206, v207
    v_accvgpr_read_b32 v56, a144
    v_mfma_f32_16x16x32_bf16 v[124:127], a[120:123], a[76:79], v[124:127]
    v_accvgpr_read_b32 v57, a145
    v_accvgpr_read_b32 v58, a146
    v_accvgpr_read_b32 v59, a147
    v_mfma_f32_16x16x32_bf16 v[220:223], a[124:127], a[76:79], v[220:223]
    buffer_load_dwordx4 a[228:231], v54, s[8:11], s62 offen sc1
    v_accvgpr_read_b32 v60, a148
    v_cvt_pk_bf16_f32 v112, v112, v113
    v_mfma_f32_16x16x32_bf16 a[160:163], a[96:99], a[92:95], a[160:163]
    v_accvgpr_read_b32 v61, a149
    v_accvgpr_read_b32 v62, a150
    v_cvt_pk_bf16_f32 v113, v114, v115
    v_mfma_f32_16x16x32_bf16 a[164:167], a[100:103], a[92:95], a[164:167]
    v_accvgpr_read_b32 v63, a151
    v_cvt_pk_bf16_f32 v114, v208, v209
    v_cvt_pk_bf16_f32 v168, v56, v57
    v_mfma_f32_16x16x32_bf16 v[128:131], a[96:99], a[80:83], v[128:131]
    v_cvt_pk_bf16_f32 v115, v210, v211
    v_cvt_pk_bf16_f32 v169, v58, v59
    v_cvt_pk_bf16_f32 v116, v116, v117
    v_mfma_f32_16x16x32_bf16 v[224:227], a[100:103], a[80:83], v[224:227]
    buffer_load_dwordx4 a[232:235], v37, s[8:11], s62 offen sc1
    v_cvt_pk_bf16_f32 v170, v60, v61
    v_cvt_pk_bf16_f32 v117, v118, v119
    v_mfma_f32_16x16x32_bf16 v[132:135], a[104:107], a[80:83], v[132:135]
    v_cvt_pk_bf16_f32 v171, v62, v63
    v_cvt_pk_bf16_f32 v118, v212, v213
    v_cvt_pk_bf16_f32 v119, v214, v215
    v_mfma_f32_16x16x32_bf16 v[228:231], a[108:111], a[80:83], v[228:231]
    buffer_load_dwordx4 a[236:239], v55, s[8:11], s62 offen sc1
    v_accvgpr_read_b32 v56, a152
    v_accvgpr_read_b32 v57, a153
    v_mfma_f32_16x16x32_bf16 a[168:171], a[104:107], a[92:95], a[168:171]
    s_add_u32 s62, s62, 0x20000
    v_accvgpr_read_b32 v58, a154
    v_accvgpr_read_b32 v59, a155
    v_accvgpr_read_b32 v60, a156
    v_mfma_f32_16x16x32_bf16 a[172:175], a[108:111], a[92:95], a[172:175]
    s_waitcnt vmcnt(16)
    s_barrier
    v_cvt_pk_bf16_f32 v120, v120, v121
    v_accvgpr_read_b32 v61, a157
    v_accvgpr_read_b32 v62, a158
    v_mfma_f32_16x16x32_bf16 v[136:139], a[112:115], a[80:83], v[136:139]
    v_cvt_pk_bf16_f32 v121, v122, v123
    v_accvgpr_read_b32 v63, a159
    v_cvt_pk_bf16_f32 v122, v216, v217
    v_mfma_f32_16x16x32_bf16 v[232:235], a[116:119], a[80:83], v[232:235]
    v_cvt_pk_bf16_f32 v172, v56, v57
    v_cvt_pk_bf16_f32 v123, v218, v219
    v_cvt_pk_bf16_f32 v173, v58, v59
    v_mfma_f32_16x16x32_bf16 v[140:143], a[120:123], a[80:83], v[140:143]
    v_cvt_pk_bf16_f32 v124, v124, v125
    v_cvt_pk_bf16_f32 v174, v60, v61
    v_cvt_pk_bf16_f32 v125, v126, v127
    v_mfma_f32_16x16x32_bf16 v[236:239], a[124:127], a[80:83], v[236:239]
    v_cvt_pk_bf16_f32 v175, v62, v63
    v_cvt_pk_bf16_f32 v126, v220, v221
    v_cvt_pk_bf16_f32 v127, v222, v223
    v_mfma_f32_16x16x32_bf16 a[176:179], a[112:115], a[92:95], a[176:179]
    ds_read_b64_tr_b16 a[0:1], v42 offset:0
    v_accvgpr_read_b32 v56, a160
    v_accvgpr_read_b32 v57, a161
    v_mfma_f32_16x16x32_bf16 a[180:183], a[116:119], a[92:95], a[180:183]
    ds_read_b64_tr_b16 a[2:3], v42 offset:1024
    v_accvgpr_read_b32 v58, a162
    v_accvgpr_read_b32 v59, a163
    v_mfma_f32_16x16x32_bf16 v[144:147], a[96:99], a[84:87], v[144:147]
    ds_read_b64_tr_b16 a[4:5], v43 offset:0
    v_accvgpr_read_b32 v60, a164
    v_cvt_pk_bf16_f32 v128, v128, v129
    v_mfma_f32_16x16x32_bf16 v[240:243], a[100:103], a[84:87], v[240:243]
    v_accvgpr_read_b32 v61, a165
    v_accvgpr_read_b32 v62, a166
    v_cvt_pk_bf16_f32 v129, v130, v131
    v_mfma_f32_16x16x32_bf16 v[148:151], a[104:107], a[84:87], v[148:151]
    ds_read_b64_tr_b16 a[6:7], v43 offset:1024
    v_accvgpr_read_b32 v63, a167
    v_cvt_pk_bf16_f32 v130, v224, v225
    v_mfma_f32_16x16x32_bf16 v[244:247], a[108:111], a[84:87], v[244:247]
    v_cvt_pk_bf16_f32 v176, v56, v57
    v_cvt_pk_bf16_f32 v131, v226, v227
    v_cvt_pk_bf16_f32 v177, v58, v59
    v_mfma_f32_16x16x32_bf16 a[184:187], a[120:123], a[92:95], a[184:187]
    ds_read_b64_tr_b16 a[8:9], v44 offset:0
    v_cvt_pk_bf16_f32 v132, v132, v133
    v_cvt_pk_bf16_f32 v178, v60, v61
    v_mfma_f32_16x16x32_bf16 a[188:191], a[124:127], a[92:95], a[188:191]
    ds_read_b64_tr_b16 a[10:11], v44 offset:1024
    v_cvt_pk_bf16_f32 v133, v134, v135
    v_cvt_pk_bf16_f32 v179, v62, v63
    v_mfma_f32_16x16x32_bf16 v[152:155], a[112:115], a[84:87], v[152:155]
    ds_read_b64_tr_b16 a[12:13], v45 offset:0
    v_cvt_pk_bf16_f32 v134, v228, v229
    v_cvt_pk_bf16_f32 v135, v230, v231
    v_mfma_f32_16x16x32_bf16 v[248:251], a[116:119], a[84:87], v[248:251]
    ds_read_b64_tr_b16 a[14:15], v45 offset:1024
    v_accvgpr_read_b32 v56, a168
    v_accvgpr_read_b32 v57, a169
    v_mfma_f32_16x16x32_bf16 v[156:159], a[120:123], a[84:87], v[156:159]
    ds_read_b64_tr_b16 a[16:17], v46 offset:0
    v_accvgpr_read_b32 v58, a170
    v_accvgpr_read_b32 v59, a171
    v_mfma_f32_16x16x32_bf16 v[252:255], a[124:127], a[84:87], v[252:255]
    v_accvgpr_read_b32 v60, a172
    v_cvt_pk_bf16_f32 v136, v136, v137
    v_accvgpr_read_b32 v61, a173
    ds_read_b64_tr_b16 a[18:19], v46 offset:1024
    v_accvgpr_read_b32 v62, a174
    v_cvt_pk_bf16_f32 v137, v138, v139
    v_accvgpr_read_b32 v63, a175
    v_cvt_pk_bf16_f32 v138, v232, v233
    v_cvt_pk_bf16_f32 v180, v56, v57
    ds_read_b64_tr_b16 a[20:21], v47 offset:0
    v_cvt_pk_bf16_f32 v139, v234, v235
    v_cvt_pk_bf16_f32 v181, v58, v59
    v_cvt_pk_bf16_f32 v140, v140, v141
    v_cvt_pk_bf16_f32 v182, v60, v61
    ds_read_b64_tr_b16 a[22:23], v47 offset:1024
    v_cvt_pk_bf16_f32 v141, v142, v143
    v_cvt_pk_bf16_f32 v183, v62, v63
    v_cvt_pk_bf16_f32 v142, v236, v237
    ds_read_b64_tr_b16 a[24:25], v48 offset:0
    v_cvt_pk_bf16_f32 v143, v238, v239
    v_accvgpr_read_b32 v56, a176
    ds_read_b64_tr_b16 a[26:27], v48 offset:1024
    v_accvgpr_read_b32 v57, a177
    v_accvgpr_read_b32 v58, a178
    ds_read_b64_tr_b16 a[28:29], v49 offset:0
    v_accvgpr_read_b32 v59, a179
    v_accvgpr_read_b32 v60, a180
    v_cvt_pk_bf16_f32 v144, v144, v145
    ds_read_b64_tr_b16 a[30:31], v49 offset:1024
    v_accvgpr_read_b32 v61, a181
    v_accvgpr_read_b32 v62, a182
    v_cvt_pk_bf16_f32 v145, v146, v147
    v_accvgpr_read_b32 v63, a183
    v_cvt_pk_bf16_f32 v146, v240, v241
    v_cvt_pk_bf16_f32 v184, v56, v57
    v_cvt_pk_bf16_f32 v147, v242, v243
    v_cvt_pk_bf16_f32 v185, v58, v59
    v_cvt_pk_bf16_f32 v148, v148, v149
    v_cvt_pk_bf16_f32 v186, v60, v61
    v_cvt_pk_bf16_f32 v149, v150, v151
    v_cvt_pk_bf16_f32 v187, v62, v63
    v_cvt_pk_bf16_f32 v150, v244, v245
    v_cvt_pk_bf16_f32 v151, v246, v247
    v_accvgpr_read_b32 v56, a184
    v_accvgpr_read_b32 v57, a185
    v_accvgpr_read_b32 v58, a186
    v_accvgpr_read_b32 v59, a187
    v_accvgpr_read_b32 v60, a188
    v_cvt_pk_bf16_f32 v152, v152, v153
    v_accvgpr_read_b32 v61, a189
    v_accvgpr_read_b32 v62, a190
    v_cvt_pk_bf16_f32 v153, v154, v155
    v_accvgpr_read_b32 v63, a191
    v_cvt_pk_bf16_f32 v154, v248, v249
    v_cvt_pk_bf16_f32 v188, v56, v57
    v_cvt_pk_bf16_f32 v155, v250, v251
    v_cvt_pk_bf16_f32 v189, v58, v59
    v_cvt_pk_bf16_f32 v156, v156, v157
    v_cvt_pk_bf16_f32 v190, v60, v61
    v_cvt_pk_bf16_f32 v157, v158, v159
    v_cvt_pk_bf16_f32 v191, v62, v63
    v_cvt_pk_bf16_f32 v158, v252, v253
    v_cvt_pk_bf16_f32 v159, v254, v255
    s_branch k12_join_7
k12_v_6:
k12_loop_24:
    v_mfma_f32_16x16x32_bf16 v[64:67], a[0:3], a[32:35], v[64:67]
    ds_read_b128 a[64:67], v27 offset:0
    v_mfma_f32_16x16x32_bf16 v[68:71], a[0:3], a[36:39], v[68:71]
    ds_read_b64_tr_b16 a[96:97], v28 offset:16384
    v_mfma_f32_16x16x32_bf16 v[72:75], a[0:3], a[40:43], v[72:75]
    v_mfma_f32_16x16x32_bf16 v[76:79], a[0:3], a[44:47], v[76:79]
    s_cmp_eq_u32 s51, s46
    s_cbranch_scc1 k12_ool_26
k12_oolret_27:
    v_mfma_f32_16x16x32_bf16 v[80:83], a[0:3], a[48:51], v[80:83]
    ds_read_b64_tr_b16 a[98:99], v28 offset:18432
    v_mfma_f32_16x16x32_bf16 v[84:87], a[0:3], a[52:55], v[84:87]
    ds_read_b128 a[68:71], v27 offset:2048
    v_mfma_f32_16x16x32_bf16 v[88:91], a[0:3], a[56:59], v[88:91]
    v_mfma_f32_16x16x32_bf16 v[92:95], a[0:3], a[60:63], v[92:95]
    ds_read_b64_tr_b16 a[100:101], v29 offset:16384
    v_mfma_f32_16x16x32_bf16 v[160:163], a[4:7], a[32:35], v[160:163]
    v_mfma_f32_16x16x32_bf16 v[164:167], a[4:7], a[36:39], v[164:167]
    ds_read_b64_tr_b16 a[102:103], v29 offset:18432
    v_mfma_f32_16x16x32_bf16 v[168:171], a[4:7], a[40:43], v[168:171]
    v_mfma_f32_16x16x32_bf16 v[172:175], a[4:7], a[44:47], v[172:175]
    ds_read_b128 a[72:75], v27 offset:4096
    v_mfma_f32_16x16x32_bf16 v[176:179], a[4:7], a[48:51], v[176:179]
    v_mfma_f32_16x16x32_bf16 v[180:183], a[4:7], a[52:55], v[180:183]
    v_mfma_f32_16x16x32_bf16 v[184:187], a[4:7], a[56:59], v[184:187]
    ds_read_b64_tr_b16 a[104:105], v30 offset:16384
    v_mfma_f32_16x16x32_bf16 v[188:191], a[4:7], a[60:63], v[188:191]
    v_mfma_f32_16x16x32_bf16 v[96:99], a[8:11], a[32:35], v[96:99]
    ds_read_b64_tr_b16 a[106:107], v30 offset:18432
    v_mfma_f32_16x16x32_bf16 v[100:103], a[8:11], a[36:39], v[100:103]
    v_mfma_f32_16x16x32_bf16 v[104:107], a[8:11], a[40:43], v[104:107]
    ds_read_b128 a[76:79], v27 offset:6144
    v_mfma_f32_16x16x32_bf16 v[108:111], a[8:11], a[44:47], v[108:111]
    v_mfma_f32_16x16x32_bf16 v[112:115], a[8:11], a[48:51], v[112:115]
    ds_read_b64_tr_b16 a[108:109], v31 offset:16384
    v_mfma_f32_16x16x32_bf16 v[116:119], a[8:11], a[52:55], v[116:119]
    v_mfma_f32_16x16x32_bf16 v[120:123], a[8:11], a[56:59], v[120:123]
    ds_read_b64_tr_b16 a[110:111], v31 offset:18432
    v_mfma_f32_16x16x32_bf16 v[124:127], a[8:11], a[60:63], v[124:127]
    v_mfma_f32_16x16x32_bf16 v[192:195], a[12:15], a[32:35], v[192:195]
    ds_read_b128 a[80:83], v27 offset:8192
    v_mfma_f32_16x16x32_bf16 v[196:199], a[12:15], a[36:39], v[196:199]
    v_mfma_f32_16x16x32_bf16 v[200:203], a[12:15], a[40:43], v[200:203]
    ds_read_b64_tr_b16 a[112:113], v32 offset:16384
    v_mfma_f32_16x16x32_bf16 v[204:207], a[12:15], a[44:47], v[204:207]
    v_mfma_f32_16x16x32_bf16 v[208:211], a[12:15], a[48:51], v[208:211]
    ds_read_b64_tr_b16 a[114:115], v32 offset:18432
    v_mfma_f32_16x16x32_bf16 v[212:215], a[12:15], a[52:55], v[212:215]
    v_mfma_f32_16x16x32_bf16 v[216:219], a[12:15], a[56:59], v[216:219]
    ds_read_b128 a[84:87], v27 offset:10240
    v_mfma_f32_16x16x32_bf16 v[220:223], a[12:15], a[60:63], v[220:223]
    v_mfma_f32_16x16x32_bf16 v[128:131], a[16:19], a[32:35], v[128:131]
    ds_read_b64_tr_b16 a[116:117], v33 offset:16384
    v_mfma_f32_16x16x32_bf16 v[132:135], a[16:19], a[36:39], v[132:135]
    v_mfma_f32_16x16x32_bf16 v[136:139], a[16:19], a[40:43], v[136:139]
    ds_read_b64_tr_b16 a[118:119], v33 offset:18432
    v_mfma_f32_16x16x32_bf16 v[140:143], a[16:19], a[44:47], v[140:143]
    v_mfma_f32_16x16x32_bf16 v[144:147], a[16:19], a[48:51], v[144:147]
    ds_read_b128 a[88:91], v27 offset:12288
    v_mfma_f32_16x16x32_bf16 v[148:151], a[16:19], a[52:55], v[148:151]
    v_mfma_f32_16x16x32_bf16 v[152:155], a[16:19], a[56:59], v[152:155]
    v_mfma_f32_16x16x32_bf16 v[156:159], a[16:19], a[60:63], v[156:159]
    ds_read_b64_tr_b16 a[120:121], v34 offset:16384
    v_mfma_f32_16x16x32_bf16 v[224:227], a[20:23], a[32:35], v[224:227]
    v_mfma_f32_16x16x32_bf16 v[228:231], a[20:23], a[36:39], v[228:231]
    ds_read_b64_tr_b16 a[122:123], v34 offset:18432
    v_mfma_f32_16x16x32_bf16 v[232:235], a[20:23], a[40:43], v[232:235]
    v_mfma_f32_16x16x32_bf16 v[236:239], a[20:23], a[44:47], v[236:239]
    ds_read_b128 a[92:95], v27 offset:14336
    v_mfma_f32_16x16x32_bf16 v[240:243], a[20:23], a[48:51], v[240:243]
    v_mfma_f32_16x16x32_bf16 v[244:247], a[20:23], a[52:55], v[244:247]
    ds_read_b64_tr_b16 a[124:125], v35 offset:16384
    v_mfma_f32_16x16x32_bf16 v[248:251], a[20:23], a[56:59], v[248:251]
    v_mfma_f32_16x16x32_bf16 v[252:255], a[20:23], a[60:63], v[252:255]
    ds_read_b64_tr_b16 a[126:127], v35 offset:18432
    v_mfma_f32_16x16x32_bf16 a[128:131], a[24:27], a[32:35], a[128:131]
    v_mfma_f32_16x16x32_bf16 a[136:139], a[24:27], a[36:39], a[136:139]
    v_mfma_f32_16x16x32_bf16 a[144:147], a[24:27], a[40:43], a[144:147]
    v_mfma_f32_16x16x32_bf16 a[152:155], a[24:27], a[44:47], a[152:155]
    v_mfma_f32_16x16x32_bf16 a[160:163], a[24:27], a[48:51], a[160:163]
    v_mfma_f32_16x16x32_bf16 a[168:171], a[24:27], a[52:55], a[168:171]
    v_mfma_f32_16x16x32_bf16 a[176:179], a[24:27], a[56:59], a[176:179]
    v_mfma_f32_16x16x32_bf16 a[184:187], a[24:27], a[60:63], a[184:187]
    v_mfma_f32_16x16x32_bf16 a[132:135], a[28:31], a[32:35], a[132:135]
    v_mfma_f32_16x16x32_bf16 a[140:143], a[28:31], a[36:39], a[140:143]
    v_mfma_f32_16x16x32_bf16 a[148:151], a[28:31], a[40:43], a[148:151]
    v_mfma_f32_16x16x32_bf16 a[156:159], a[28:31], a[44:47], a[156:159]
    v_mfma_f32_16x16x32_bf16 a[164:167], a[28:31], a[48:51], a[164:167]
    v_mfma_f32_16x16x32_bf16 a[172:175], a[28:31], a[52:55], a[172:175]
    v_mfma_f32_16x16x32_bf16 a[180:183], a[28:31], a[56:59], a[180:183]
    v_mfma_f32_16x16x32_bf16 a[188:191], a[28:31], a[60:63], a[188:191]
    s_waitcnt vmcnt(0) lgkmcnt(0)
    s_barrier
    v_mfma_f32_16x16x32_bf16 v[64:67], a[64:67], a[96:99], v[64:67]
    s_cmp_ge_u32 s49, 1024
    s_cselect_b32 s18, 0, s18
    s_cselect_b32 s22, 0, s22
    ds_read_b128 a[0:3], v26 offset:32768
    v_mfma_f32_16x16x32_bf16 v[68:71], a[64:67], a[100:103], v[68:71]
    s_add_u32 m0, s48, 0
    ds_read_b64_tr_b16 a[32:33], v28 offset:32768
    v_mfma_f32_16x16x32_bf16 v[72:75], a[64:67], a[104:107], v[72:75]
    buffer_load_dwordx4 v10, s[16:19], s49 offen offset:0 lds
    v_mfma_f32_16x16x32_bf16 v[76:79], a[64:67], a[108:111], v[76:79]
    ds_read_b64_tr_b16 a[34:35], v28 offset:34816
    v_mfma_f32_16x16x32_bf16 v[80:83], a[64:67], a[112:115], v[80:83]
    buffer_load_dwordx4 v11, s[16:19], s49 offen offset:1024 lds
    v_mfma_f32_16x16x32_bf16 v[84:87], a[64:67], a[116:119], v[84:87]
    ds_read_b128 a[4:7], v26 offset:34816
    v_mfma_f32_16x16x32_bf16 v[88:91], a[64:67], a[120:123], v[88:91]
    v_mfma_f32_16x16x32_bf16 v[92:95], a[64:67], a[124:127], v[92:95]
    ds_read_b64_tr_b16 a[36:37], v29 offset:32768
    v_mfma_f32_16x16x32_bf16 v[160:163], a[68:71], a[96:99], v[160:163]
    buffer_load_dwordx4 v12, s[16:19], s49 offen offset:2048 lds
    v_mfma_f32_16x16x32_bf16 v[164:167], a[68:71], a[100:103], v[164:167]
    ds_read_b64_tr_b16 a[38:39], v29 offset:34816
    v_mfma_f32_16x16x32_bf16 v[168:171], a[68:71], a[104:107], v[168:171]
    v_mfma_f32_16x16x32_bf16 v[172:175], a[68:71], a[108:111], v[172:175]
    buffer_load_dwordx4 v13, s[16:19], s49 offen offset:3072 lds
    ds_read_b128 a[8:11], v26 offset:36864
    v_mfma_f32_16x16x32_bf16 v[176:179], a[68:71], a[112:115], v[176:179]
    v_mfma_f32_16x16x32_bf16 v[180:183], a[68:71], a[116:119], v[180:183]
    s_add_u32 m0, s48, 4096
    v_mfma_f32_16x16x32_bf16 v[184:187], a[68:71], a[120:123], v[184:187]
    ds_read_b64_tr_b16 a[40:41], v30 offset:32768
    v_mfma_f32_16x16x32_bf16 v[188:191], a[68:71], a[124:127], v[188:191]
    buffer_load_dwordx4 v14, s[16:19], s49 offen offset:0 lds
    v_mfma_f32_16x16x32_bf16 v[96:99], a[72:75], a[96:99], v[96:99]
    ds_read_b64_tr_b16 a[42:43], v30 offset:34816
    v_mfma_f32_16x16x32_bf16 v[100:103], a[72:75], a[100:103], v[100:103]
    v_mfma_f32_16x16x32_bf16 v[104:107], a[72:75], a[104:107], v[104:107]
    buffer_load_dwordx4 v15, s[16:19], s49 offen offset:1024 lds
    ds_read_b128 a[12:15], v26 offset:38912
    v_mfma_f32_16x16x32_bf16 v[108:111], a[72:75], a[108:111], v[108:111]
    v_mfma_f32_16x16x32_bf16 v[112:115], a[72:75], a[112:115], v[112:115]
    ds_read_b64_tr_b16 a[44:45], v31 offset:32768
    v_mfma_f32_16x16x32_bf16 v[116:119], a[72:75], a[116:119], v[116:119]
    v_mfma_f32_16x16x32_bf16 v[120:123], a[72:75], a[120:123], v[120:123]
    buffer_load_dwordx4 v16, s[16:19], s49 offen offset:2048 lds
    ds_read_b64_tr_b16 a[46:47], v31 offset:34816
    v_mfma_f32_16x16x32_bf16 v[124:127], a[72:75], a[124:127], v[124:127]
    v_mfma_f32_16x16x32_bf16 v[192:195], a[76:79], a[96:99], v[192:195]
    ds_read_b128 a[16:19], v26 offset:40960
    v_mfma_f32_16x16x32_bf16 v[196:199], a[76:79], a[100:103], v[196:199]
    buffer_load_dwordx4 v17, s[16:19], s49 offen offset:3072 lds
    v_mfma_f32_16x16x32_bf16 v[200:203], a[76:79], a[104:107], v[200:203]
    ds_read_b64_tr_b16 a[48:49], v32 offset:32768
    v_mfma_f32_16x16x32_bf16 v[204:207], a[76:79], a[108:111], v[204:207]
    s_add_u32 s49, s49, 128
    v_mfma_f32_16x16x32_bf16 v[208:211], a[76:79], a[112:115], v[208:211]
    s_add_u32 m0, s48, 65536
    ds_read_b64_tr_b16 a[50:51], v32 offset:34816
    v_mfma_f32_16x16x32_bf16 v[212:215], a[76:79], a[116:119], v[212:215]
    buffer_load_dwordx4 v18, s[20:23], s50 offen offset:0 lds
    v_mfma_f32_16x16x32_bf16 v[216:219], a[76:79], a[120:123], v[216:219]
    ds_read_b128 a[20:23], v26 offset:43008
    v_mfma_f32_16x16x32_bf16 v[220:223], a[76:79], a[124:127], v[220:223]
    v_mfma_f32_16x16x32_bf16 v[128:131], a[80:83], a[96:99], v[128:131]
    buffer_load_dwordx4 v19, s[20:23], s50 offen offset:1024 lds
    ds_read_b64_tr_b16 a[52:53], v33 offset:32768
    v_mfma_f32_16x16x32_bf16 v[132:135], a[80:83], a[100:103], v[132:135]
    v_mfma_f32_16x16x32_bf16 v[136:139], a[80:83], a[104:107], v[136:139]
    ds_read_b64_tr_b16 a[54:55], v33 offset:34816
    v_mfma_f32_16x16x32_bf16 v[140:143], a[80:83], a[108:111], v[140:143]
    buffer_load_dwordx4 v20, s[20:23], s50 offen offset:2048 lds
    v_mfma_f32_16x16x32_bf16 v[144:147], a[80:83], a[112:115], v[144:147]
    ds_read_b128 a[24:27], v26 offset:45056
    v_mfma_f32_16x16x32_bf16 v[148:151], a[80:83], a[116:119], v[148:151]
    v_mfma_f32_16x16x32_bf16 v[152:155], a[80:83], a[120:123], v[152:155]
    v_mfma_f32_16x16x32_bf16 v[156:159], a[80:83], a[124:127], v[156:159]
    buffer_load_dwordx4 v21, s[20:23], s50 offen offset:3072 lds
    ds_read_b64_tr_b16 a[56:57], v34 offset:32768
    v_mfma_f32_16x16x32_bf16 v[224:227], a[84:87], a[96:99], v[224:227]
    s_add_u32 m0, s48, 69632
    v_mfma_f32_16x16x32_bf16 v[228:231], a[84:87], a[100:103], v[228:231]
    ds_read_b64_tr_b16 a[58:59], v34 offset:34816
    v_mfma_f32_16x16x32_bf16 v[232:235], a[84:87], a[104:107], v[232:235]
    buffer_load_dwordx4 v22, s[20:23], s50 offen offset:0 lds
    v_mfma_f32_16x16x32_bf16 v[236:239], a[84:87], a[108:111], v[236:239]
    ds_read_b128 a[28:31], v26 offset:47104
    v_mfma_f32_16x16x32_bf16 v[240:243], a[84:87], a[112:115], v[240:243]
    v_mfma_f32_16x16x32_bf16 v[244:247], a[84:87], a[116:119], v[244:247]
    ds_read_b64_tr_b16 a[60:61], v35 offset:32768
    v_mfma_f32_16x16x32_bf16 v[248:251], a[84:87], a[120:123], v[248:251]
    buffer_load_dwordx4 v23, s[20:23], s50 offen offset:1024 lds
    v_mfma_f32_16x16x32_bf16 v[252:255], a[84:87], a[124:127], v[252:255]
    ds_read_b64_tr_b16 a[62:63], v35 offset:34816
    v_mfma_f32_16x16x32_bf16 a[128:131], a[88:91], a[96:99], a[128:131]
    v_mfma_f32_16x16x32_bf16 a[136:139], a[88:91], a[100:103], a[136:139]
    buffer_load_dwordx4 v24, s[20:23], s50 offen offset:2048 lds
    v_mfma_f32_16x16x32_bf16 a[144:147], a[88:91], a[104:107], a[144:147]
    v_mfma_f32_16x16x32_bf16 a[152:155], a[88:91], a[108:111], a[152:155]
    v_mfma_f32_16x16x32_bf16 a[160:163], a[88:91], a[112:115], a[160:163]
    v_mfma_f32_16x16x32_bf16 a[168:171], a[88:91], a[116:119], a[168:171]
    buffer_load_dwordx4 v25, s[20:23], s50 offen offset:3072 lds
    v_mfma_f32_16x16x32_bf16 a[176:179], a[88:91], a[120:123], a[176:179]
    v_mfma_f32_16x16x32_bf16 a[184:187], a[88:91], a[124:127], a[184:187]
    s_add_u32 s50, s50, 0x80000
    v_mfma_f32_16x16x32_bf16 a[132:135], a[92:95], a[96:99], a[132:135]
    v_mfma_f32_16x16x32_bf16 a[140:143], a[92:95], a[100:103], a[140:143]
    s_cmp_eq_u32 s51, s53
    s_cbranch_scc1 k12_ool_28
k12_oolret_29:
    v_mfma_f32_16x16x32_bf16 a[148:151], a[92:95], a[104:107], a[148:151]
    v_mfma_f32_16x16x32_bf16 a[156:159], a[92:95], a[108:111], a[156:159]
    s_cmp_eq_u32 s51, s63
    s_cbranch_scc1 k12_ool_30
k12_oolret_31:
    v_mfma_f32_16x16x32_bf16 a[164:167], a[92:95], a[112:115], a[164:167]
    v_mfma_f32_16x16x32_bf16 a[172:175], a[92:95], a[116:119], a[172:175]
    s_add_u32 s51, s51, 1
    v_mfma_f32_16x16x32_bf16 a[180:183], a[92:95], a[120:123], a[180:183]
    v_mfma_f32_16x16x32_bf16 a[188:191], a[92:95], a[124:127], a[188:191]
    s_waitcnt lgkmcnt(0)
    v_mfma_f32_16x16x32_bf16 v[64:67], a[0:3], a[32:35], v[64:67]
    ds_read_b128 a[64:67], v27 offset:32768
    v_mfma_f32_16x16x32_bf16 v[68:71], a[0:3], a[36:39], v[68:71]
    ds_read_b64_tr_b16 a[96:97], v28 offset:49152
    v_mfma_f32_16x16x32_bf16 v[72:75], a[0:3], a[40:43], v[72:75]
    v_mfma_f32_16x16x32_bf16 v[76:79], a[0:3], a[44:47], v[76:79]
    ds_read_b64_tr_b16 a[98:99], v28 offset:51200
    v_mfma_f32_16x16x32_bf16 v[80:83], a[0:3], a[48:51], v[80:83]
    v_mfma_f32_16x16x32_bf16 v[84:87], a[0:3], a[52:55], v[84:87]
    ds_read_b128 a[68:71], v27 offset:34816
    v_mfma_f32_16x16x32_bf16 v[88:91], a[0:3], a[56:59], v[88:91]
    v_mfma_f32_16x16x32_bf16 v[92:95], a[0:3], a[60:63], v[92:95]
    ds_read_b64_tr_b16 a[100:101], v29 offset:49152
    v_mfma_f32_16x16x32_bf16 v[160:163], a[4:7], a[32:35], v[160:163]
    v_mfma_f32_16x16x32_bf16 v[164:167], a[4:7], a[36:39], v[164:167]
    ds_read_b64_tr_b16 a[102:103], v29 offset:51200
    v_mfma_f32_16x16x32_bf16 v[168:171], a[4:7], a[40:43], v[168:171]
    v_mfma_f32_16x16x32_bf16 v[172:175], a[4:7], a[44:47], v[172:175]
    ds_read_b128 a[72:75], v27 offset:36864
    v_mfma_f32_16x16x32_bf16 v[176:179], a[4:7], a[48:51], v[176:179]
    v_mfma_f32_16x16x32_bf16 v[180:183], a[4:7], a[52:55], v[180:183]
    v_mfma_f32_16x16x32_bf16 v[184:187], a[4:7], a[56:59], v[184:187]
    ds_read_b64_tr_b16 a[104:105], v30 offset:49152
    v_mfma_f32_16x16x32_bf16 v[188:191], a[4:7], a[60:63], v[188:191]
    v_mfma_f32_16x16x32_bf16 v[96:99], a[8:11], a[32:35], v[96:99]
    ds_read_b64_tr_b16 a[106:107], v30 offset:51200
    v_mfma_f32_16x16x32_bf16 v[100:103], a[8:11], a[36:39], v[100:103]
    v_mfma_f32_16x16x32_bf16 v[104:107], a[8:11], a[40:43], v[104:107]
    ds_read_b128 a[76:79], v27 offset:38912
    v_mfma_f32_16x16x32_bf16 v[108:111], a[8:11], a[44:47], v[108:111]
    v_mfma_f32_16x16x32_bf16 v[112:115], a[8:11], a[48:51], v[112:115]
    ds_read_b64_tr_b16 a[108:109], v31 offset:49152
    v_mfma_f32_16x16x32_bf16 v[116:119], a[8:11], a[52:55], v[116:119]
    v_mfma_f32_16x16x32_bf16 v[120:123], a[8:11], a[56:59], v[120:123]
    ds_read_b64_tr_b16 a[110:111], v31 offset:51200
    v_mfma_f32_16x16x32_bf16 v[124:127], a[8:11], a[60:63], v[124:127]
    v_mfma_f32_16x16x32_bf16 v[192:195], a[12:15], a[32:35], v[192:195]
    ds_read_b128 a[80:83], v27 offset:40960
    v_mfma_f32_16x16x32_bf16 v[196:199], a[12:15], a[36:39], v[196:199]
    v_mfma_f32_16x16x32_bf16 v[200:203], a[12:15], a[40:43], v[200:203]
    ds_read_b64_tr_b16 a[112:113], v32 offset:49152
    v_mfma_f32_16x16x32_bf16 v[204:207], a[12:15], a[44:47], v[204:207]
    v_mfma_f32_16x16x32_bf16 v[208:211], a[12:15], a[48:51], v[208:211]
    ds_read_b64_tr_b16 a[114:115], v32 offset:51200
    v_mfma_f32_16x16x32_bf16 v[212:215], a[12:15], a[52:55], v[212:215]
    v_mfma_f32_16x16x32_bf16 v[216:219], a[12:15], a[56:59], v[216:219]
    ds_read_b128 a[84:87], v27 offset:43008
    v_mfma_f32_16x16x32_bf16 v[220:223], a[12:15], a[60:63], v[220:223]
    v_mfma_f32_16x16x32_bf16 v[128:131], a[16:19], a[32:35], v[128:131]
    ds_read_b64_tr_b16 a[116:117], v33 offset:49152
    v_mfma_f32_16x16x32_bf16 v[132:135], a[16:19], a[36:39], v[132:135]
    v_mfma_f32_16x16x32_bf16 v[136:139], a[16:19], a[40:43], v[136:139]
    ds_read_b64_tr_b16 a[118:119], v33 offset:51200
    v_mfma_f32_16x16x32_bf16 v[140:143], a[16:19], a[44:47], v[140:143]
    v_mfma_f32_16x16x32_bf16 v[144:147], a[16:19], a[48:51], v[144:147]
    ds_read_b128 a[88:91], v27 offset:45056
    v_mfma_f32_16x16x32_bf16 v[148:151], a[16:19], a[52:55], v[148:151]
    v_mfma_f32_16x16x32_bf16 v[152:155], a[16:19], a[56:59], v[152:155]
    v_mfma_f32_16x16x32_bf16 v[156:159], a[16:19], a[60:63], v[156:159]
    ds_read_b64_tr_b16 a[120:121], v34 offset:49152
    v_mfma_f32_16x16x32_bf16 v[224:227], a[20:23], a[32:35], v[224:227]
    v_mfma_f32_16x16x32_bf16 v[228:231], a[20:23], a[36:39], v[228:231]
    ds_read_b64_tr_b16 a[122:123], v34 offset:51200
    v_mfma_f32_16x16x32_bf16 v[232:235], a[20:23], a[40:43], v[232:235]
    v_mfma_f32_16x16x32_bf16 v[236:239], a[20:23], a[44:47], v[236:239]
    ds_read_b128 a[92:95], v27 offset:47104
    v_mfma_f32_16x16x32_bf16 v[240:243], a[20:23], a[48:51], v[240:243]
    v_mfma_f32_16x16x32_bf16 v[244:247], a[20:23], a[52:55], v[244:247]
    ds_read_b64_tr_b16 a[124:125], v35 offset:49152
    v_mfma_f32_16x16x32_bf16 v[248:251], a[20:23], a[56:59], v[248:251]
    v_mfma_f32_16x16x32_bf16 v[252:255], a[20:23], a[60:63], v[252:255]
    ds_read_b64_tr_b16 a[126:127], v35 offset:51200
    v_mfma_f32_16x16x32_bf16 a[128:131], a[24:27], a[32:35], a[128:131]
    v_mfma_f32_16x16x32_bf16 a[136:139], a[24:27], a[36:39], a[136:139]
    v_mfma_f32_16x16x32_bf16 a[144:147], a[24:27], a[40:43], a[144:147]
    v_mfma_f32_16x16x32_bf16 a[152:155], a[24:27], a[44:47], a[152:155]
    v_mfma_f32_16x16x32_bf16 a[160:163], a[24:27], a[48:51], a[160:163]
    v_mfma_f32_16x16x32_bf16 a[168:171], a[24:27], a[52:55], a[168:171]
    v_mfma_f32_16x16x32_bf16 a[176:179], a[24:27], a[56:59], a[176:179]
    v_mfma_f32_16x16x32_bf16 a[184:187], a[24:27], a[60:63], a[184:187]
    s_sub_u32 s52, s51, 1
    s_cmp_eq_u32 s52, s46
    s_cbranch_scc1 k12_ool_34
k12_oolret_35:
    v_mfma_f32_16x16x32_bf16 a[132:135], a[28:31], a[32:35], a[132:135]
    v_mfma_f32_16x16x32_bf16 a[140:143], a[28:31], a[36:39], a[140:143]
    v_mfma_f32_16x16x32_bf16 a[148:151], a[28:31], a[40:43], a[148:151]
    v_mfma_f32_16x16x32_bf16 a[156:159], a[28:31], a[44:47], a[156:159]
    v_mfma_f32_16x16x32_bf16 a[164:167], a[28:31], a[48:51], a[164:167]
    v_mfma_f32_16x16x32_bf16 a[172:175], a[28:31], a[52:55], a[172:175]
    v_mfma_f32_16x16x32_bf16 a[180:183], a[28:31], a[56:59], a[180:183]
    v_mfma_f32_16x16x32_bf16 a[188:191], a[28:31], a[60:63], a[188:191]
    s_waitcnt vmcnt(0) lgkmcnt(0)
    s_barrier
    s_cmp_eq_u32 s51, 7
    s_cbranch_scc1 k12_last_25
    v_mfma_f32_16x16x32_bf16 v[64:67], a[64:67], a[96:99], v[64:67]
    ds_read_b128 a[0:3], v26 offset:0
    v_mfma_f32_16x16x32_bf16 v[68:71], a[64:67], a[100:103], v[68:71]
    s_add_u32 m0, s48, 32768
    ds_read_b64_tr_b16 a[32:33], v28 offset:0
    v_mfma_f32_16x16x32_bf16 v[72:75], a[64:67], a[104:107], v[72:75]
    buffer_load_dwordx4 v10, s[16:19], s49 offen offset:0 lds
    v_mfma_f32_16x16x32_bf16 v[76:79], a[64:67], a[108:111], v[76:79]
    ds_read_b64_tr_b16 a[34:35], v28 offset:2048
    v_mfma_f32_16x16x32_bf16 v[80:83], a[64:67], a[112:115], v[80:83]
    buffer_load_dwordx4 v11, s[16:19], s49 offen offset:1024 lds
    v_mfma_f32_16x16x32_bf16 v[84:87], a[64:67], a[116:119], v[84:87]
    ds_read_b128 a[4:7], v26 offset:2048
    v_mfma_f32_16x16x32_bf16 v[88:91], a[64:67], a[120:123], v[88:91]
    v_mfma_f32_16x16x32_bf16 v[92:95], a[64:67], a[124:127], v[92:95]
    ds_read_b64_tr_b16 a[36:37], v29 offset:0
    v_mfma_f32_16x16x32_bf16 v[160:163], a[68:71], a[96:99], v[160:163]
    buffer_load_dwordx4 v12, s[16:19], s49 offen offset:2048 lds
    v_mfma_f32_16x16x32_bf16 v[164:167], a[68:71], a[100:103], v[164:167]
    ds_read_b64_tr_b16 a[38:39], v29 offset:2048
    v_mfma_f32_16x16x32_bf16 v[168:171], a[68:71], a[104:107], v[168:171]
    v_mfma_f32_16x16x32_bf16 v[172:175], a[68:71], a[108:111], v[172:175]
    buffer_load_dwordx4 v13, s[16:19], s49 offen offset:3072 lds
    ds_read_b128 a[8:11], v26 offset:4096
    v_mfma_f32_16x16x32_bf16 v[176:179], a[68:71], a[112:115], v[176:179]
    v_mfma_f32_16x16x32_bf16 v[180:183], a[68:71], a[116:119], v[180:183]
    s_add_u32 m0, s48, 36864
    v_mfma_f32_16x16x32_bf16 v[184:187], a[68:71], a[120:123], v[184:187]
    ds_read_b64_tr_b16 a[40:41], v30 offset:0
    v_mfma_f32_16x16x32_bf16 v[188:191], a[68:71], a[124:127], v[188:191]
    buffer_load_dwordx4 v14, s[16:19], s49 offen offset:0 lds
    v_mfma_f32_16x16x32_bf16 v[96:99], a[72:75], a[96:99], v[96:99]
    ds_read_b64_tr_b16 a[42:43], v30 offset:2048
    v_mfma_f32_16x16x32_bf16 v[100:103], a[72:75], a[100:103], v[100:103]
    v_mfma_f32_16x16x32_bf16 v[104:107], a[72:75], a[104:107], v[104:107]
    buffer_load_dwordx4 v15, s[16:19], s49 offen offset:1024 lds
    ds_read_b128 a[12:15], v26 offset:6144
    v_mfma_f32_16x16x32_bf16 v[108:111], a[72:75], a[108:111], v[108:111]
    v_mfma_f32_16x16x32_bf16 v[112:115], a[72:75], a[112:115], v[112:115]
    ds_read_b64_tr_b16 a[44:45], v31 offset:0
    v_mfma_f32_16x16x32_bf16 v[116:119], a[72:75], a[116:119], v[116:119]
    v_mfma_f32_16x16x32_bf16 v[120:123], a[72:75], a[120:123], v[120:123]
    buffer_load_dwordx4 v16, s[16:19], s49 offen offset:2048 lds
    ds_read_b64_tr_b16 a[46:47], v31 offset:2048
    v_mfma_f32_16x16x32_bf16 v[124:127], a[72:75], a[124:127], v[124:127]
    v_mfma_f32_16x16x32_bf16 v[192:195], a[76:79], a[96:99], v[192:195]
    ds_read_b128 a[16:19], v26 offset:8192
    v_mfma_f32_16x16x32_bf16 v[196:199], a[76:79], a[100:103], v[196:199]
    buffer_load_dwordx4 v17, s[16:19], s49 offen offset:3072 lds
    v_mfma_f32_16x16x32_bf16 v[200:203], a[76:79], a[104:107], v[200:203]
    ds_read_b64_tr_b16 a[48:49], v32 offset:0
    v_mfma_f32_16x16x32_bf16 v[204:207], a[76:79], a[108:111], v[204:207]
    s_add_u32 s49, s49, 128
    v_mfma_f32_16x16x32_bf16 v[208:211], a[76:79], a[112:115], v[208:211]
    s_add_u32 m0, s48, 98304
    ds_read_b64_tr_b16 a[50:51], v32 offset:2048
    v_mfma_f32_16x16x32_bf16 v[212:215], a[76:79], a[116:119], v[212:215]
    buffer_load_dwordx4 v18, s[20:23], s50 offen offset:0 lds
    v_mfma_f32_16x16x32_bf16 v[216:219], a[76:79], a[120:123], v[216:219]
    ds_read_b128 a[20:23], v26 offset:10240
    v_mfma_f32_16x16x32_bf16 v[220:223], a[76:79], a[124:127], v[220:223]
    v_mfma_f32_16x16x32_bf16 v[128:131], a[80:83], a[96:99], v[128:131]
    buffer_load_dwordx4 v19, s[20:23], s50 offen offset:1024 lds
    ds_read_b64_tr_b16 a[52:53], v33 offset:0
    v_mfma_f32_16x16x32_bf16 v[132:135], a[80:83], a[100:103], v[132:135]
    v_mfma_f32_16x16x32_bf16 v[136:139], a[80:83], a[104:107], v[136:139]
    ds_read_b64_tr_b16 a[54:55], v33 offset:2048
    v_mfma_f32_16x16x32_bf16 v[140:143], a[80:83], a[108:111], v[140:143]
    buffer_load_dwordx4 v20, s[20:23], s50 offen offset:2048 lds
    v_mfma_f32_16x16x32_bf16 v[144:147], a[80:83], a[112:115], v[144:147]
    ds_read_b128 a[24:27], v26 offset:12288
    v_mfma_f32_16x16x32_bf16 v[148:151], a[80:83], a[116:119], v[148:151]
    v_mfma_f32_16x16x32_bf16 v[152:155], a[80:83], a[120:123], v[152:155]
    v_mfma_f32_16x16x32_bf16 v[156:159], a[80:83], a[124:127], v[156:159]
    buffer_load_dwordx4 v21, s[20:23], s50 offen offset:3072 lds
    ds_read_b64_tr_b16 a[56:57], v34 offset:0
    v_mfma_f32_16x16x32_bf16 v[224:227], a[84:87], a[96:99], v[224:227]
    s_add_u32 m0, s48, 102400
    v_mfma_f32_16x16x32_bf16 v[228:231], a[84:87], a[100:103], v[228:231]
    ds_read_b64_tr_b16 a[58:59], v34 offset:2048
    v_mfma_f32_16x16x32_bf16 v[232:235], a[84:87], a[104:107], v[232:235]
    buffer_load_dwordx4 v22, s[20:23], s50 offen offset:0 lds
    v_mfma_f32_16x16x32_bf16 v[236:239], a[84:87], a[108:111], v[236:239]
    ds_read_b128 a[28:31], v26 offset:14336
    v_mfma_f32_16x16x32_bf16 v[240:243], a[84:87], a[112:115], v[240:243]
    v_mfma_f32_16x16x32_bf16 v[244:247], a[84:87], a[116:119], v[244:247]
    ds_read_b64_tr_b16 a[60:61], v35 offset:0
    v_mfma_f32_16x16x32_bf16 v[248:251], a[84:87], a[120:123], v[248:251]
    buffer_load_dwordx4 v23, s[20:23], s50 offen offset:1024 lds
    v_mfma_f32_16x16x32_bf16 v[252:255], a[84:87], a[124:127], v[252:255]
    ds_read_b64_tr_b16 a[62:63], v35 offset:2048
    v_mfma_f32_16x16x32_bf16 a[128:131], a[88:91], a[96:99], a[128:131]
    v_mfma_f32_16x16x32_bf16 a[136:139], a[88:91], a[100:103], a[136:139]
    buffer_load_dwordx4 v24, s[20:23], s50 offen offset:2048 lds
    v_mfma_f32_16x16x32_bf16 a[144:147], a[88:91], a[104:107], a[144:147]
    v_mfma_f32_16x16x32_bf16 a[152:155], a[88:91], a[108:111], a[152:155]
    v_mfma_f32_16x16x32_bf16 a[160:163], a[88:91], a[112:115], a[160:163]
    v_mfma_f32_16x16x32_bf16 a[168:171], a[88:91], a[116:119], a[168:171]
    buffer_load_dwordx4 v25, s[20:23], s50 offen offset:3072 lds
    v_mfma_f32_16x16x32_bf16 a[176:179], a[88:91], a[120:123], a[176:179]
    v_mfma_f32_16x16x32_bf16 a[184:187], a[88:91], a[124:127], a[184:187]
    s_add_u32 s50, s50, 0x80000
    v_mfma_f32_16x16x32_bf16 a[132:135], a[92:95], a[96:99], a[132:135]
    v_mfma_f32_16x16x32_bf16 a[140:143], a[92:95], a[100:103], a[140:143]
    s_cmp_eq_u32 s51, s53
    s_cbranch_scc1 k12_ool_36
k12_oolret_37:
    v_mfma_f32_16x16x32_bf16 a[148:151], a[92:95], a[104:107], a[148:151]
    v_mfma_f32_16x16x32_bf16 a[156:159], a[92:95], a[108:111], a[156:159]
    s_cmp_eq_u32 s51, 5
    s_cbranch_scc1 k12_ool_38
k12_oolret_39:
    v_mfma_f32_16x16x32_bf16 a[164:167], a[92:95], a[112:115], a[164:167]
    v_mfma_f32_16x16x32_bf16 a[172:175], a[92:95], a[116:119], a[172:175]
    s_add_u32 s51, s51, 1
    v_mfma_f32_16x16x32_bf16 a[180:183], a[92:95], a[120:123], a[180:183]
    v_mfma_f32_16x16x32_bf16 a[188:191], a[92:95], a[124:127], a[188:191]
    s_waitcnt lgkmcnt(0)
    s_branch k12_loop_24
k12_last_25:
    v_mfma_f32_16x16x32_bf16 v[64:67], a[64:67], a[96:99], v[64:67]
    s_add_u32 m0, s60, 98304
    v_mfma_f32_16x16x32_bf16 v[160:163], a[68:71], a[96:99], v[160:163]
    buffer_load_dwordx4 v38, s[12:15], s61 offen offset:0 lds
    v_mfma_f32_16x16x32_bf16 v[68:71], a[64:67], a[100:103], v[68:71]
    buffer_load_dwordx4 v39, s[12:15], s61 offen offset:1024 lds
    v_mfma_f32_16x16x32_bf16 v[164:167], a[68:71], a[100:103], v[164:167]
    v_mfma_f32_16x16x32_bf16 v[72:75], a[64:67], a[104:107], v[72:75]
    buffer_load_dwordx4 v40, s[12:15], s61 offen offset:2048 lds
    v_mfma_f32_16x16x32_bf16 v[168:171], a[68:71], a[104:107], v[168:171]
    v_cvt_pk_bf16_f32 v64, v64, v65
    v_cvt_pk_bf16_f32 v65, v66, v67
    v_cvt_pk_bf16_f32 v66, v160, v161
    v_mfma_f32_16x16x32_bf16 v[76:79], a[64:67], a[108:111], v[76:79]
    v_cvt_pk_bf16_f32 v67, v162, v163
    v_mfma_f32_16x16x32_bf16 v[172:175], a[68:71], a[108:111], v[172:175]
    v_cvt_pk_bf16_f32 v68, v68, v69
    v_cvt_pk_bf16_f32 v69, v70, v71
    v_cvt_pk_bf16_f32 v70, v164, v165
    v_mfma_f32_16x16x32_bf16 v[80:83], a[64:67], a[112:115], v[80:83]
    buffer_load_dwordx4 v41, s[12:15], s61 offen offset:3072 lds
    v_mfma_f32_16x16x32_bf16 v[176:179], a[68:71], a[112:115], v[176:179]
    s_add_u32 s61, s61, 0x80000
    v_cvt_pk_bf16_f32 v71, v166, v167
    v_cvt_pk_bf16_f32 v72, v72, v73
    v_cvt_pk_bf16_f32 v73, v74, v75
    v_mfma_f32_16x16x32_bf16 v[84:87], a[64:67], a[116:119], v[84:87]
    buffer_load_dwordx4 a[192:195], v36, s[8:11], s62 offen sc1
    buffer_load_dwordx4 a[196:199], v54, s[8:11], s62 offen sc1
    v_mfma_f32_16x16x32_bf16 v[180:183], a[68:71], a[116:119], v[180:183]
    v_cvt_pk_bf16_f32 v74, v168, v169
    v_cvt_pk_bf16_f32 v75, v170, v171
    v_cvt_pk_bf16_f32 v76, v76, v77
    v_mfma_f32_16x16x32_bf16 v[88:91], a[64:67], a[120:123], v[88:91]
    v_cvt_pk_bf16_f32 v77, v78, v79
    v_cvt_pk_bf16_f32 v78, v172, v173
    v_cvt_pk_bf16_f32 v79, v174, v175
    v_mfma_f32_16x16x32_bf16 v[184:187], a[68:71], a[120:123], v[184:187]
    v_cvt_pk_bf16_f32 v80, v80, v81
    v_cvt_pk_bf16_f32 v81, v82, v83
    v_cvt_pk_bf16_f32 v82, v176, v177
    v_mfma_f32_16x16x32_bf16 v[92:95], a[64:67], a[124:127], v[92:95]
    buffer_load_dwordx4 a[200:203], v37, s[8:11], s62 offen sc1
    buffer_load_dwordx4 a[204:207], v55, s[8:11], s62 offen sc1
    v_mfma_f32_16x16x32_bf16 v[188:191], a[68:71], a[124:127], v[188:191]
    s_add_u32 s62, s62, 0x20000
    v_cvt_pk_bf16_f32 v83, v178, v179
    v_cvt_pk_bf16_f32 v84, v84, v85
    v_cvt_pk_bf16_f32 v85, v86, v87
    v_mfma_f32_16x16x32_bf16 a[128:131], a[88:91], a[96:99], a[128:131]
    v_cvt_pk_bf16_f32 v86, v180, v181
    v_cvt_pk_bf16_f32 v87, v182, v183
    v_mfma_f32_16x16x32_bf16 a[132:135], a[92:95], a[96:99], a[132:135]
    v_cvt_pk_bf16_f32 v88, v88, v89
    v_cvt_pk_bf16_f32 v89, v90, v91
    v_cvt_pk_bf16_f32 v90, v184, v185
    v_mfma_f32_16x16x32_bf16 v[96:99], a[72:75], a[96:99], v[96:99]
    buffer_load_dwordx4 a[208:211], v36, s[8:11], s62 offen sc1
    buffer_load_dwordx4 a[212:215], v54, s[8:11], s62 offen sc1
    v_mfma_f32_16x16x32_bf16 v[192:195], a[76:79], a[96:99], v[192:195]
    v_cvt_pk_bf16_f32 v91, v186, v187
    v_cvt_pk_bf16_f32 v92, v92, v93
    v_cvt_pk_bf16_f32 v93, v94, v95
    v_mfma_f32_16x16x32_bf16 v[100:103], a[72:75], a[100:103], v[100:103]
    v_cvt_pk_bf16_f32 v94, v188, v189
    v_cvt_pk_bf16_f32 v95, v190, v191
    v_mfma_f32_16x16x32_bf16 v[196:199], a[76:79], a[100:103], v[196:199]
    v_accvgpr_read_b32 v56, a128
    v_accvgpr_read_b32 v57, a129
    v_accvgpr_read_b32 v58, a130
    v_mfma_f32_16x16x32_bf16 a[136:139], a[88:91], a[100:103], a[136:139]
    buffer_load_dwordx4 a[216:219], v37, s[8:11], s62 offen sc1
    buffer_load_dwordx4 a[220:223], v55, s[8:11], s62 offen sc1
    v_mfma_f32_16x16x32_bf16 a[140:143], a[92:95], a[100:103], a[140:143]
    s_add_u32 s62, s62, 0x20000
    v_accvgpr_read_b32 v59, a131
    v_accvgpr_read_b32 v60, a132
    v_cvt_pk_bf16_f32 v96, v96, v97
    v_mfma_f32_16x16x32_bf16 v[104:107], a[72:75], a[104:107], v[104:107]
    s_add_u32 m0, s60, 114688
    v_accvgpr_read_b32 v61, a133
    v_accvgpr_read_b32 v62, a134
    v_cvt_pk_bf16_f32 v97, v98, v99
    v_mfma_f32_16x16x32_bf16 v[200:203], a[76:79], a[104:107], v[200:203]
    v_accvgpr_read_b32 v63, a135
    v_cvt_pk_bf16_f32 v98, v192, v193
    v_cvt_pk_bf16_f32 v160, v56, v57
    v_mfma_f32_16x16x32_bf16 v[108:111], a[72:75], a[108:111], v[108:111]
    v_cvt_pk_bf16_f32 v99, v194, v195
    v_cvt_pk_bf16_f32 v161, v58, v59
    v_cvt_pk_bf16_f32 v100, v100, v101
    v_mfma_f32_16x16x32_bf16 v[204:207], a[76:79], a[108:111], v[204:207]
    buffer_load_dwordx4 v38, s[12:15], s61 offen offset:0 lds
    buffer_load_dwordx4 v39, s[12:15], s61 offen offset:1024 lds
    v_mfma_f32_16x16x32_bf16 a[144:147], a[88:91], a[104:107], a[144:147]
    v_cvt_pk_bf16_f32 v162, v60, v61
    v_cvt_pk_bf16_f32 v101, v102, v103
    v_cvt_pk_bf16_f32 v163, v62, v63
    v_mfma_f32_16x16x32_bf16 a[148:151], a[92:95], a[104:107], a[148:151]
    v_cvt_pk_bf16_f32 v102, v196, v197
    v_cvt_pk_bf16_f32 v103, v198, v199
    v_accvgpr_read_b32 v56, a136
    v_mfma_f32_16x16x32_bf16 v[112:115], a[72:75], a[112:115], v[112:115]
    v_accvgpr_read_b32 v57, a137
    v_accvgpr_read_b32 v58, a138
    v_accvgpr_read_b32 v59, a139
    v_mfma_f32_16x16x32_bf16 v[208:211], a[76:79], a[112:115], v[208:211]
    v_accvgpr_read_b32 v60, a140
    v_cvt_pk_bf16_f32 v104, v104, v105
    v_accvgpr_read_b32 v61, a141
    v_mfma_f32_16x16x32_bf16 v[116:119], a[72:75], a[116:119], v[116:119]
    buffer_load_dwordx4 v40, s[12:15], s61 offen offset:2048 lds
    buffer_load_dwordx4 v41, s[12:15], s61 offen offset:3072 lds
    v_mfma_f32_16x16x32_bf16 v[212:215], a[76:79], a[116:119], v[212:215]
    s_add_u32 s61, s61, 0x80000
    v_accvgpr_read_b32 v62, a142
    v_cvt_pk_bf16_f32 v105, v106, v107
    v_accvgpr_read_b32 v63, a143
    v_mfma_f32_16x16x32_bf16 a[152:155], a[88:91], a[108:111], a[152:155]
    v_cvt_pk_bf16_f32 v106, v200, v201
    v_cvt_pk_bf16_f32 v164, v56, v57
    v_cvt_pk_bf16_f32 v107, v202, v203
    v_mfma_f32_16x16x32_bf16 a[156:159], a[92:95], a[108:111], a[156:159]
    v_cvt_pk_bf16_f32 v165, v58, v59
    v_cvt_pk_bf16_f32 v108, v108, v109
    v_cvt_pk_bf16_f32 v166, v60, v61
    v_mfma_f32_16x16x32_bf16 v[120:123], a[72:75], a[120:123], v[120:123]
    v_cvt_pk_bf16_f32 v109, v110, v111
    v_cvt_pk_bf16_f32 v167, v62, v63
    v_cvt_pk_bf16_f32 v110, v204, v205
    v_mfma_f32_16x16x32_bf16 v[216:219], a[76:79], a[120:123], v[216:219]
    buffer_load_dwordx4 a[224:227], v36, s[8:11], s62 offen sc1
    v_cvt_pk_bf16_f32 v111, v206, v207
    v_accvgpr_read_b32 v56, a144
    v_mfma_f32_16x16x32_bf16 v[124:127], a[72:75], a[124:127], v[124:127]
    v_accvgpr_read_b32 v57, a145
    v_accvgpr_read_b32 v58, a146
    v_accvgpr_read_b32 v59, a147
    v_mfma_f32_16x16x32_bf16 v[220:223], a[76:79], a[124:127], v[220:223]
    buffer_load_dwordx4 a[228:231], v54, s[8:11], s62 offen sc1
    v_accvgpr_read_b32 v60, a148
    v_cvt_pk_bf16_f32 v112, v112, v113
    v_mfma_f32_16x16x32_bf16 a[160:163], a[88:91], a[112:115], a[160:163]
    v_accvgpr_read_b32 v61, a149
    v_accvgpr_read_b32 v62, a150
    v_cvt_pk_bf16_f32 v113, v114, v115
    v_mfma_f32_16x16x32_bf16 a[164:167], a[92:95], a[112:115], a[164:167]
    v_accvgpr_read_b32 v63, a151
    v_cvt_pk_bf16_f32 v114, v208, v209
    v_cvt_pk_bf16_f32 v168, v56, v57
    v_mfma_f32_16x16x32_bf16 v[128:131], a[80:83], a[96:99], v[128:131]
    v_cvt_pk_bf16_f32 v115, v210, v211
    v_cvt_pk_bf16_f32 v169, v58, v59
    v_cvt_pk_bf16_f32 v116, v116, v117
    v_mfma_f32_16x16x32_bf16 v[224:227], a[84:87], a[96:99], v[224:227]
    buffer_load_dwordx4 a[232:235], v37, s[8:11], s62 offen sc1
    v_cvt_pk_bf16_f32 v170, v60, v61
    v_cvt_pk_bf16_f32 v117, v118, v119
    v_mfma_f32_16x16x32_bf16 v[132:135], a[80:83], a[100:103], v[132:135]
    v_cvt_pk_bf16_f32 v171, v62, v63
    v_cvt_pk_bf16_f32 v118, v212, v213
    v_cvt_pk_bf16_f32 v119, v214, v215
    v_mfma_f32_16x16x32_bf16 v[228:231], a[84:87], a[100:103], v[228:231]
    buffer_load_dwordx4 a[236:239], v55, s[8:11], s62 offen sc1
    v_accvgpr_read_b32 v56, a152
    v_accvgpr_read_b32 v57, a153
    v_mfma_f32_16x16x32_bf16 a[168:171], a[88:91], a[116:119], a[168:171]
    s_add_u32 s62, s62, 0x20000
    v_accvgpr_read_b32 v58, a154
    v_accvgpr_read_b32 v59, a155
    v_accvgpr_read_b32 v60, a156
    v_mfma_f32_16x16x32_bf16 a[172:175], a[92:95], a[116:119], a[172:175]
    s_waitcnt vmcnt(16)
    s_barrier
    v_cvt_pk_bf16_f32 v120, v120, v121
    v_accvgpr_read_b32 v61, a157
    v_accvgpr_read_b32 v62, a158
    v_mfma_f32_16x16x32_bf16 v[136:139], a[80:83], a[104:107], v[136:139]
    v_cvt_pk_bf16_f32 v121, v122, v123
    v_accvgpr_read_b32 v63, a159
    v_cvt_pk_bf16_f32 v122, v216, v217
    v_mfma_f32_16x16x32_bf16 v[232:235], a[84:87], a[104:107], v[232:235]
    v_cvt_pk_bf16_f32 v172, v56, v57
    v_cvt_pk_bf16_f32 v123, v218, v219
    v_cvt_pk_bf16_f32 v173, v58, v59
    v_mfma_f32_16x16x32_bf16 v[140:143], a[80:83], a[108:111], v[140:143]
    v_cvt_pk_bf16_f32 v124, v124, v125
    v_cvt_pk_bf16_f32 v174, v60, v61
    v_cvt_pk_bf16_f32 v125, v126, v127
    v_mfma_f32_16x16x32_bf16 v[236:239], a[84:87], a[108:111], v[236:239]
    v_cvt_pk_bf16_f32 v175, v62, v63
    v_cvt_pk_bf16_f32 v126, v220, v221
    v_cvt_pk_bf16_f32 v127, v222, v223
    v_mfma_f32_16x16x32_bf16 a[176:179], a[88:91], a[120:123], a[176:179]
    ds_read_b64_tr_b16 a[0:1], v42 offset:0
    v_accvgpr_read_b32 v56, a160
    v_accvgpr_read_b32 v57, a161
    v_mfma_f32_16x16x32_bf16 a[180:183], a[92:95], a[120:123], a[180:183]
    ds_read_b64_tr_b16 a[2:3], v42 offset:1024
    v_accvgpr_read_b32 v58, a162
    v_accvgpr_read_b32 v59, a163
    v_mfma_f32_16x16x32_bf16 v[144:147], a[80:83], a[112:115], v[144:147]
    ds_read_b64_tr_b16 a[4:5], v43 offset:0
    v_accvgpr_read_b32 v60, a164
    v_cvt_pk_bf16_f32 v128, v128, v129
    v_mfma_f32_16x16x32_bf16 v[240:243], a[84:87], a[112:115], v[240:243]
    v_accvgpr_read_b32 v61, a165
    v_accvgpr_read_b32 v62, a166
    v_cvt_pk_bf16_f32 v129, v130, v131
    v_mfma_f32_16x16x32_bf16 v[148:151], a[80:83], a[116:119], v[148:151]
    ds_read_b64_tr_b16 a[6:7], v43 offset:1024
    v_accvgpr_read_b32 v63, a167
    v_cvt_pk_bf16_f32 v130, v224, v225
    v_mfma_f32_16x16x32_bf16 v[244:247], a[84:87], a[116:119], v[244:247]
    v_cvt_pk_bf16_f32 v176, v56, v57
    v_cvt_pk_bf16_f32 v131, v226, v227
    v_cvt_pk_bf16_f32 v177, v58, v59
    v_mfma_f32_16x16x32_bf16 a[184:187], a[88:91], a[124:127], a[184:187]
    ds_read_b64_tr_b16 a[8:9], v44 offset:0
    v_cvt_pk_bf16_f32 v132, v132, v133
    v_cvt_pk_bf16_f32 v178, v60, v61
    v_mfma_f32_16x16x32_bf16 a[188:191], a[92:95], a[124:127], a[188:191]
    ds_read_b64_tr_b16 a[10:11], v44 offset:1024
    v_cvt_pk_bf16_f32 v133, v134, v135
    v_cvt_pk_bf16_f32 v179, v62, v63
    v_mfma_f32_16x16x32_bf16 v[152:155], a[80:83], a[120:123], v[152:155]
    ds_read_b64_tr_b16 a[12:13], v45 offset:0
    v_cvt_pk_bf16_f32 v134, v228, v229
    v_cvt_pk_bf16_f32 v135, v230, v231
    v_mfma_f32_16x16x32_bf16 v[248:251], a[84:87], a[120:123], v[248:251]
    ds_read_b64_tr_b16 a[14:15], v45 offset:1024
    v_accvgpr_read_b32 v56, a168
    v_accvgpr_read_b32 v57, a169
    v_mfma_f32_16x16x32_bf16 v[156:159], a[80:83], a[124:127], v[156:159]
    ds_read_b64_tr_b16 a[16:17], v46 offset:0
    v_accvgpr_read_b32 v58, a170
    v_accvgpr_read_b32 v59, a171
    v_mfma_f32_16x16x32_bf16 v[252:255], a[84:87], a[124:127], v[252:255]
    v_accvgpr_read_b32 v60, a172
    v_cvt_pk_bf16_f32 v136, v136, v137
    v_accvgpr_read_b32 v61, a173
    ds_read_b64_tr_b16 a[18:19], v46 offset:1024
    v_accvgpr_read_b32 v62, a174
    v_cvt_pk_bf16_f32 v137, v138, v139
    v_accvgpr_read_b32 v63, a175
    v_cvt_pk_bf16_f32 v138, v232, v233
    v_cvt_pk_bf16_f32 v180, v56, v57
    ds_read_b64_tr_b16 a[20:21], v47 offset:0
    v_cvt_pk_bf16_f32 v139, v234, v235
    v_cvt_pk_bf16_f32 v181, v58, v59
    v_cvt_pk_bf16_f32 v140, v140, v141
    v_cvt_pk_bf16_f32 v182, v60, v61
    ds_read_b64_tr_b16 a[22:23], v47 offset:1024
    v_cvt_pk_bf16_f32 v141, v142, v143
    v_cvt_pk_bf16_f32 v183, v62, v63
    v_cvt_pk_bf16_f32 v142, v236, v237
    ds_read_b64_tr_b16 a[24:25], v48 offset:0
    v_cvt_pk_bf16_f32 v143, v238, v239
    v_accvgpr_read_b32 v56, a176
    ds_read_b64_tr_b16 a[26:27], v48 offset:1024
    v_accvgpr_read_b32 v57, a177
    v_accvgpr_read_b32 v58, a178
    ds_read_b64_tr_b16 a[28:29], v49 offset:0
    v_accvgpr_read_b32 v59, a179
    v_accvgpr_read_b32 v60, a180
    v_cvt_pk_bf16_f32 v144, v144, v145
    ds_read_b64_tr_b16 a[30:31], v49 offset:1024
    v_accvgpr_read_b32 v61, a181
    v_accvgpr_read_b32 v62, a182
    v_cvt_pk_bf16_f32 v145, v146, v147
    v_accvgpr_read_b32 v63, a183
    v_cvt_pk_bf16_f32 v146, v240, v241
    v_cvt_pk_bf16_f32 v184, v56, v57
    v_cvt_pk_bf16_f32 v147, v242, v243
    v_cvt_pk_bf16_f32 v185, v58, v59
    v_cvt_pk_bf16_f32 v148, v148, v149
    v_cvt_pk_bf16_f32 v186, v60, v61
    v_cvt_pk_bf16_f32 v149, v150, v151
    v_cvt_pk_bf16_f32 v187, v62, v63
    v_cvt_pk_bf16_f32 v150, v244, v245
    v_cvt_pk_bf16_f32 v151, v246, v247
    v_accvgpr_read_b32 v56, a184
    v_accvgpr_read_b32 v57, a185
    v_accvgpr_read_b32 v58, a186
    v_accvgpr_read_b32 v59, a187
    v_accvgpr_read_b32 v60, a188
    v_cvt_pk_bf16_f32 v152, v152, v153
    v_accvgpr_read_b32 v61, a189
    v_accvgpr_read_b32 v62, a190
    v_cvt_pk_bf16_f32 v153, v154, v155
    v_accvgpr_read_b32 v63, a191
    v_cvt_pk_bf16_f32 v154, v248, v249
    v_cvt_pk_bf16_f32 v188, v56, v57
    v_cvt_pk_bf16_f32 v155, v250, v251
    v_cvt_pk_bf16_f32 v189, v58, v59
    v_cvt_pk_bf16_f32 v156, v156, v157
    v_cvt_pk_bf16_f32 v190, v60, v61
    v_cvt_pk_bf16_f32 v157, v158, v159
    v_cvt_pk_bf16_f32 v191, v62, v63
    v_cvt_pk_bf16_f32 v158, v252, v253
    v_cvt_pk_bf16_f32 v159, v254, v255
k12_join_7:
k12_qcode:
    s_mov_b64 s[48:49], s[32:33]
    s_mov_b32 s51, 0x00020000
    s_cmp_eq_u32 s45, 0
    s_mov_b32 s50, s34
    s_cselect_b32 s56, s30, -1
    s_cselect_b32 s57, -1, s30
    s_waitcnt vmcnt(12) lgkmcnt(0)
    v_mfma_f32_16x16x32_bf16 v[192:195], a[0:3], a[192:195], 0
    ds_read_b64_tr_b16 a[32:33], v42 offset:8192
    ds_read_b64_tr_b16 a[34:35], v42 offset:9216
    v_mfma_f32_16x16x32_bf16 v[196:199], a[0:3], a[196:199], 0
    buffer_load_dwordx4 a[240:243], v36, s[8:11], s62 offen sc1
    v_mfma_f32_16x16x32_bf16 a[64:67], a[0:3], a[200:203], 0
    ds_read_b64_tr_b16 a[36:37], v43 offset:8192
    v_mfma_f32_16x16x32_bf16 a[68:71], a[0:3], a[204:207], 0
    ds_read_b64_tr_b16 a[38:39], v43 offset:9216
    v_mfma_f32_16x16x32_bf16 v[200:203], a[4:7], a[192:195], 0
    ds_read_b64_tr_b16 a[40:41], v44 offset:8192
    v_mfma_f32_16x16x32_bf16 v[204:207], a[4:7], a[196:199], 0
    buffer_load_dwordx4 a[244:247], v54, s[8:11], s62 offen sc1
    v_mfma_f32_16x16x32_bf16 a[72:75], a[4:7], a[200:203], 0
    s_lshl_b32 s31, s28, 14
    ds_read_b64_tr_b16 a[42:43], v44 offset:9216
    v_mfma_f32_16x16x32_bf16 a[76:79], a[4:7], a[204:207], 0
    s_add_u32 s16, s6, s31
    s_addc_u32 s17, s7, 0
    ds_read_b64_tr_b16 a[44:45], v45 offset:8192
    v_mfma_f32_16x16x32_bf16 v[208:211], a[8:11], a[192:195], 0
    v_mfma_f32_16x16x32_bf16 v[212:215], a[8:11], a[196:199], 0
    s_add_u32 s20, s16, 0x2000000
    s_addc_u32 s21, s17, 0
    ds_read_b64_tr_b16 a[46:47], v45 offset:9216
    v_mfma_f32_16x16x32_bf16 a[80:83], a[8:11], a[200:203], 0
    buffer_load_dwordx4 a[248:251], v37, s[8:11], s62 offen sc1
    ds_read_b64_tr_b16 a[48:49], v46 offset:8192
    v_mfma_f32_16x16x32_bf16 a[84:87], a[8:11], a[204:207], 0
    s_add_u32 s16, s16, 0x1000000
    s_addc_u32 s17, s17, 0
    ds_read_b64_tr_b16 a[50:51], v46 offset:9216
    v_mfma_f32_16x16x32_bf16 v[216:219], a[12:15], a[192:195], 0
    v_mfma_f32_16x16x32_bf16 v[220:223], a[12:15], a[196:199], 0
    s_and_b32 s17, s17, 0xffff
    ds_read_b64_tr_b16 a[52:53], v47 offset:8192
    v_mfma_f32_16x16x32_bf16 a[88:91], a[12:15], a[200:203], 0
    buffer_load_dwordx4 a[252:255], v55, s[8:11], s62 offen sc1
    ds_read_b64_tr_b16 a[54:55], v47 offset:9216
    v_mfma_f32_16x16x32_bf16 a[92:95], a[12:15], a[204:207], 0
    s_and_b32 s21, s21, 0xffff
    ds_read_b64_tr_b16 a[56:57], v48 offset:8192
    v_mfma_f32_16x16x32_bf16 v[224:227], a[16:19], a[192:195], 0
    v_mfma_f32_16x16x32_bf16 v[228:231], a[16:19], a[196:199], 0
    s_lshl_b32 s31, s29, 20
    ds_read_b64_tr_b16 a[58:59], v48 offset:9216
    v_mfma_f32_16x16x32_bf16 a[96:99], a[16:19], a[200:203], 0
    s_add_u32 s62, s62, 0x20000
    ds_read_b64_tr_b16 a[60:61], v49 offset:8192
    v_mfma_f32_16x16x32_bf16 a[100:103], a[16:19], a[204:207], 0
    s_add_u32 s52, s47, 0
    v_mfma_f32_16x16x32_bf16 v[232:235], a[20:23], a[192:195], 0
    s_sub_u32 s18, 0xf84000, s31
    buffer_store_dwordx4 v[64:67], v1, s[48:51], s52 offen offset:0 sc1
    ds_read_b64_tr_b16 a[62:63], v49 offset:9216
    v_mfma_f32_16x16x32_bf16 v[236:239], a[20:23], a[196:199], 0
    s_add_u32 s52, s47, 0
    v_mfma_f32_16x16x32_bf16 a[104:107], a[20:23], a[200:203], 0
    s_mov_b32 s22, s18
    v_mfma_f32_16x16x32_bf16 a[108:111], a[20:23], a[204:207], 0
    s_add_u32 s24, s6, 0x4806000
    s_addc_u32 s25, s7, 0
    buffer_store_dwordx4 v[68:71], v1, s[48:51], s52 offen offset:1024 sc1
    v_mfma_f32_16x16x32_bf16 v[240:243], a[24:27], a[192:195], 0
    v_mfma_f32_16x16x32_bf16 v[244:247], a[24:27], a[196:199], 0
    s_and_b32 s25, s25, 0xffff
    v_mfma_f32_16x16x32_bf16 a[112:115], a[24:27], a[200:203], 0
    v_mfma_f32_16x16x32_bf16 a[116:119], a[24:27], a[204:207], 0
    s_mov_b32 s26, 4096
    v_mfma_f32_16x16x32_bf16 v[248:251], a[28:31], a[192:195], 0
    s_cmp_eq_u32 s45, 0
    s_cbranch_scc1 k12_ool_40
k12_oolret_41:
    v_mfma_f32_16x16x32_bf16 v[252:255], a[28:31], a[196:199], 0
    v_mfma_f32_16x16x32_bf16 a[120:123], a[28:31], a[200:203], 0
    v_mfma_f32_16x16x32_bf16 a[124:127], a[28:31], a[204:207], 0
    s_waitcnt vmcnt(10) lgkmcnt(0)
    s_barrier
    v_mfma_f32_16x16x32_bf16 v[192:195], a[32:35], a[208:211], v[192:195]
    ds_read_b64_tr_b16 a[0:1], v42 offset:16384
    ds_read_b64_tr_b16 a[2:3], v42 offset:17408
    v_mfma_f32_16x16x32_bf16 v[196:199], a[32:35], a[212:215], v[196:199]
    s_add_u32 m0, s60, 131072
    v_mfma_f32_16x16x32_bf16 a[64:67], a[32:35], a[216:219], a[64:67]
    buffer_load_dwordx4 v38, s[12:15], s61 offen offset:0 lds
    ds_read_b64_tr_b16 a[4:5], v43 offset:16384
    v_mfma_f32_16x16x32_bf16 a[68:71], a[32:35], a[220:223], a[68:71]
    ds_read_b64_tr_b16 a[6:7], v43 offset:17408
    v_mfma_f32_16x16x32_bf16 v[200:203], a[36:39], a[208:211], v[200:203]
    buffer_load_dwordx4 v39, s[12:15], s61 offen offset:1024 lds
    ds_read_b64_tr_b16 a[8:9], v44 offset:16384
    v_mfma_f32_16x16x32_bf16 v[204:207], a[36:39], a[212:215], v[204:207]
    v_mfma_f32_16x16x32_bf16 a[72:75], a[36:39], a[216:219], a[72:75]
    ds_read_b64_tr_b16 a[10:11], v44 offset:17408
    v_mfma_f32_16x16x32_bf16 a[76:79], a[36:39], a[220:223], a[76:79]
    buffer_load_dwordx4 v40, s[12:15], s61 offen offset:2048 lds
    ds_read_b64_tr_b16 a[12:13], v45 offset:16384
    v_mfma_f32_16x16x32_bf16 v[208:211], a[40:43], a[208:211], v[208:211]
    v_mfma_f32_16x16x32_bf16 v[212:215], a[40:43], a[212:215], v[212:215]
    ds_read_b64_tr_b16 a[14:15], v45 offset:17408
    v_mfma_f32_16x16x32_bf16 a[80:83], a[40:43], a[216:219], a[80:83]
    buffer_load_dwordx4 v41, s[12:15], s61 offen offset:3072 lds
    ds_read_b64_tr_b16 a[16:17], v46 offset:16384
    v_mfma_f32_16x16x32_bf16 a[84:87], a[40:43], a[220:223], a[84:87]
    ds_read_b64_tr_b16 a[18:19], v46 offset:17408
    v_mfma_f32_16x16x32_bf16 v[216:219], a[44:47], a[208:211], v[216:219]
    s_add_u32 s61, s61, 0x80000
    v_mfma_f32_16x16x32_bf16 v[220:223], a[44:47], a[212:215], v[220:223]
    buffer_load_dwordx4 a[128:131], v36, s[8:11], s62 offen sc1
    ds_read_b64_tr_b16 a[20:21], v47 offset:16384
    v_mfma_f32_16x16x32_bf16 a[88:91], a[44:47], a[216:219], a[88:91]
    ds_read_b64_tr_b16 a[22:23], v47 offset:17408
    v_mfma_f32_16x16x32_bf16 a[92:95], a[44:47], a[220:223], a[92:95]
    buffer_load_dwordx4 a[132:135], v54, s[8:11], s62 offen sc1
    ds_read_b64_tr_b16 a[24:25], v48 offset:16384
    v_mfma_f32_16x16x32_bf16 v[224:227], a[48:51], a[208:211], v[224:227]
    v_mfma_f32_16x16x32_bf16 v[228:231], a[48:51], a[212:215], v[228:231]
    ds_read_b64_tr_b16 a[26:27], v48 offset:17408
    v_mfma_f32_16x16x32_bf16 a[96:99], a[48:51], a[216:219], a[96:99]
    buffer_load_dwordx4 a[136:139], v37, s[8:11], s62 offen sc1
    ds_read_b64_tr_b16 a[28:29], v49 offset:16384
    v_mfma_f32_16x16x32_bf16 a[100:103], a[48:51], a[220:223], a[100:103]
    v_mfma_f32_16x16x32_bf16 v[232:235], a[52:55], a[208:211], v[232:235]
    ds_read_b64_tr_b16 a[30:31], v49 offset:17408
    v_mfma_f32_16x16x32_bf16 v[236:239], a[52:55], a[212:215], v[236:239]
    buffer_load_dwordx4 a[140:143], v55, s[8:11], s62 offen sc1
    v_mfma_f32_16x16x32_bf16 a[104:107], a[52:55], a[216:219], a[104:107]
    v_mfma_f32_16x16x32_bf16 a[108:111], a[52:55], a[220:223], a[108:111]
    s_add_u32 s62, s62, 0x20000
    v_mfma_f32_16x16x32_bf16 v[240:243], a[56:59], a[208:211], v[240:243]
    s_add_u32 s52, s47, 0
    v_mfma_f32_16x16x32_bf16 v[244:247], a[56:59], a[212:215], v[244:247]
    buffer_store_dwordx4 v[72:75], v1, s[48:51], s52 offen offset:2048 sc1
    v_mfma_f32_16x16x32_bf16 a[112:115], a[56:59], a[216:219], a[112:115]
    v_mfma_f32_16x16x32_bf16 a[116:119], a[56:59], a[220:223], a[116:119]
    v_mfma_f32_16x16x32_bf16 v[248:251], a[60:63], a[208:211], v[248:251]
    v_mfma_f32_16x16x32_bf16 v[252:255], a[60:63], a[212:215], v[252:255]
    v_mfma_f32_16x16x32_bf16 a[120:123], a[60:63], a[216:219], a[120:123]
    v_mfma_f32_16x16x32_bf16 a[124:127], a[60:63], a[220:223], a[124:127]
    s_waitcnt vmcnt(15) lgkmcnt(0)
    v_mfma_f32_16x16x32_bf16 v[192:195], a[0:3], a[224:227], v[192:195]
    ds_read_b64_tr_b16 a[32:33], v42 offset:24576
    ds_read_b64_tr_b16 a[34:35], v42 offset:25600
    v_mfma_f32_16x16x32_bf16 v[196:199], a[0:3], a[228:231], v[196:199]
    buffer_load_dwordx4 a[144:147], v36, s[8:11], s62 offen sc1
    v_mfma_f32_16x16x32_bf16 a[64:67], a[0:3], a[232:235], a[64:67]
    ds_read_b64_tr_b16 a[36:37], v43 offset:24576
    v_mfma_f32_16x16x32_bf16 a[68:71], a[0:3], a[236:239], a[68:71]
    ds_read_b64_tr_b16 a[38:39], v43 offset:25600
    v_mfma_f32_16x16x32_bf16 v[200:203], a[4:7], a[224:227], v[200:203]
    ds_read_b64_tr_b16 a[40:41], v44 offset:24576
    v_mfma_f32_16x16x32_bf16 v[204:207], a[4:7], a[228:231], v[204:207]
    v_mfma_f32_16x16x32_bf16 a[72:75], a[4:7], a[232:235], a[72:75]
    buffer_load_dwordx4 a[148:151], v54, s[8:11], s62 offen sc1
    ds_read_b64_tr_b16 a[42:43], v44 offset:25600
    v_mfma_f32_16x16x32_bf16 a[76:79], a[4:7], a[236:239], a[76:79]
    ds_read_b64_tr_b16 a[44:45], v45 offset:24576
    v_mfma_f32_16x16x32_bf16 v[208:211], a[8:11], a[224:227], v[208:211]
    v_mfma_f32_16x16x32_bf16 v[212:215], a[8:11], a[228:231], v[212:215]
    ds_read_b64_tr_b16 a[46:47], v45 offset:25600
    v_mfma_f32_16x16x32_bf16 a[80:83], a[8:11], a[232:235], a[80:83]
    ds_read_b64_tr_b16 a[48:49], v46 offset:24576
    v_mfma_f32_16x16x32_bf16 a[84:87], a[8:11], a[236:239], a[84:87]
    buffer_load_dwordx4 a[152:155], v37, s[8:11], s62 offen sc1
    ds_read_b64_tr_b16 a[50:51], v46 offset:25600
    v_mfma_f32_16x16x32_bf16 v[216:219], a[12:15], a[224:227], v[216:219]
    v_mfma_f32_16x16x32_bf16 v[220:223], a[12:15], a[228:231], v[220:223]
    ds_read_b64_tr_b16 a[52:53], v47 offset:24576
    v_mfma_f32_16x16x32_bf16 a[88:91], a[12:15], a[232:235], a[88:91]
    ds_read_b64_tr_b16 a[54:55], v47 offset:25600
    v_mfma_f32_16x16x32_bf16 a[92:95], a[12:15], a[236:239], a[92:95]
    ds_read_b64_tr_b16 a[56:57], v48 offset:24576
    v_mfma_f32_16x16x32_bf16 v[224:227], a[16:19], a[224:227], v[224:227]
    v_mfma_f32_16x16x32_bf16 v[228:231], a[16:19], a[228:231], v[228:231]
    buffer_load_dwordx4 a[156:159], v55, s[8:11], s62 offen sc1
    ds_read_b64_tr_b16 a[58:59], v48 offset:25600
    v_mfma_f32_16x16x32_bf16 a[96:99], a[16:19], a[232:235], a[96:99]
    ds_read_b64_tr_b16 a[60:61], v49 offset:24576
    v_mfma_f32_16x16x32_bf16 a[100:103], a[16:19], a[236:239], a[100:103]
    v_mfma_f32_16x16x32_bf16 v[232:235], a[20:23], a[224:227], v[232:235]
    ds_read_b64_tr_b16 a[62:63], v49 offset:25600
    v_mfma_f32_16x16x32_bf16 v[236:239], a[20:23], a[228:231], v[236:239]
    s_add_u32 s62, s62, 0x20000
    v_mfma_f32_16x16x32_bf16 a[104:107], a[20:23], a[232:235], a[104:107]
    s_add_u32 s52, s47, 0
    v_mfma_f32_16x16x32_bf16 a[108:111], a[20:23], a[236:239], a[108:111]
    buffer_store_dwordx4 v[76:79], v1, s[48:51], s52 offen offset:3072 sc1
    v_mfma_f32_16x16x32_bf16 v[240:243], a[24:27], a[224:227], v[240:243]
    v_mfma_f32_16x16x32_bf16 v[244:247], a[24:27], a[228:231], v[244:247]
    v_mfma_f32_16x16x32_bf16 a[112:115], a[24:27], a[232:235], a[112:115]
    v_mfma_f32_16x16x32_bf16 a[116:119], a[24:27], a[236:239], a[116:119]
    v_mfma_f32_16x16x32_bf16 v[248:251], a[28:31], a[224:227], v[248:251]
    s_cmp_eq_u32 s45, 0
    s_cbranch_scc1 k12_ool_42
k12_oolret_43:
    v_mfma_f32_16x16x32_bf16 v[252:255], a[28:31], a[228:231], v[252:255]
    v_mfma_f32_16x16x32_bf16 a[120:123], a[28:31], a[232:235], a[120:123]
    v_mfma_f32_16x16x32_bf16 a[124:127], a[28:31], a[236:239], a[124:127]
    s_waitcnt vmcnt(10) lgkmcnt(0)
    s_barrier
    v_mfma_f32_16x16x32_bf16 v[192:195], a[32:35], a[240:243], v[192:195]
    ds_read_b64_tr_b16 a[0:1], v42 offset:32768
    ds_read_b64_tr_b16 a[2:3], v42 offset:33792
    v_mfma_f32_16x16x32_bf16 v[196:199], a[32:35], a[244:247], v[196:199]
    s_add_u32 m0, s60, 147456
    v_mfma_f32_16x16x32_bf16 a[64:67], a[32:35], a[248:251], a[64:67]
    buffer_load_dwordx4 v38, s[12:15], s61 offen offset:0 lds
    ds_read_b64_tr_b16 a[4:5], v43 offset:32768
    v_mfma_f32_16x16x32_bf16 a[68:71], a[32:35], a[252:255], a[68:71]
    ds_read_b64_tr_b16 a[6:7], v43 offset:33792
    v_mfma_f32_16x16x32_bf16 v[200:203], a[36:39], a[240:243], v[200:203]
    buffer_load_dwordx4 v39, s[12:15], s61 offen offset:1024 lds
    ds_read_b64_tr_b16 a[8:9], v44 offset:32768
    v_mfma_f32_16x16x32_bf16 v[204:207], a[36:39], a[244:247], v[204:207]
    v_mfma_f32_16x16x32_bf16 a[72:75], a[36:39], a[248:251], a[72:75]
    ds_read_b64_tr_b16 a[10:11], v44 offset:33792
    v_mfma_f32_16x16x32_bf16 a[76:79], a[36:39], a[252:255], a[76:79]
    buffer_load_dwordx4 v40, s[12:15], s61 offen offset:2048 lds
    ds_read_b64_tr_b16 a[12:13], v45 offset:32768
    v_mfma_f32_16x16x32_bf16 v[208:211], a[40:43], a[240:243], v[208:211]
    v_mfma_f32_16x16x32_bf16 v[212:215], a[40:43], a[244:247], v[212:215]
    ds_read_b64_tr_b16 a[14:15], v45 offset:33792
    v_mfma_f32_16x16x32_bf16 a[80:83], a[40:43], a[248:251], a[80:83]
    buffer_load_dwordx4 v41, s[12:15], s61 offen offset:3072 lds
    ds_read_b64_tr_b16 a[16:17], v46 offset:32768
    v_mfma_f32_16x16x32_bf16 a[84:87], a[40:43], a[252:255], a[84:87]
    ds_read_b64_tr_b16 a[18:19], v46 offset:33792
    v_mfma_f32_16x16x32_bf16 v[216:219], a[44:47], a[240:243], v[216:219]
    s_add_u32 s61, s61, 0x80000
    v_mfma_f32_16x16x32_bf16 v[220:223], a[44:47], a[244:247], v[220:223]
    buffer_load_dwordx4 a[160:163], v36, s[8:11], s62 offen sc1
    ds_read_b64_tr_b16 a[20:21], v47 offset:32768
    v_mfma_f32_16x16x32_bf16 a[88:91], a[44:47], a[248:251], a[88:91]
    ds_read_b64_tr_b16 a[22:23], v47 offset:33792
    v_mfma_f32_16x16x32_bf16 a[92:95], a[44:47], a[252:255], a[92:95]
    buffer_load_dwordx4 a[164:167], v54, s[8:11], s62 offen sc1
    ds_read_b64_tr_b16 a[24:25], v48 offset:32768
    v_mfma_f32_16x16x32_bf16 v[224:227], a[48:51], a[240:243], v[224:227]
    v_mfma_f32_16x16x32_bf16 v[228:231], a[48:51], a[244:247], v[228:231]
    ds_read_b64_tr_b16 a[26:27], v48 offset:33792
    v_mfma_f32_16x16x32_bf16 a[96:99], a[48:51], a[248:251], a[96:99]
    buffer_load_dwordx4 a[168:171], v37, s[8:11], s62 offen sc1
    ds_read_b64_tr_b16 a[28:29], v49 offset:32768
    v_mfma_f32_16x16x32_bf16 a[100:103], a[48:51], a[252:255], a[100:103]
    v_mfma_f32_16x16x32_bf16 v[232:235], a[52:55], a[240:243], v[232:235]
    ds_read_b64_tr_b16 a[30:31], v49 offset:33792
    v_mfma_f32_16x16x32_bf16 v[236:239], a[52:55], a[244:247], v[236:239]
    buffer_load_dwordx4 a[172:175], v55, s[8:11], s62 offen sc1
    v_mfma_f32_16x16x32_bf16 a[104:107], a[52:55], a[248:251], a[104:107]
    v_mfma_f32_16x16x32_bf16 a[108:111], a[52:55], a[252:255], a[108:111]
    s_add_u32 s62, s62, 0x20000
    v_mfma_f32_16x16x32_bf16 v[240:243], a[56:59], a[240:243], v[240:243]
    s_add_u32 s52, s47, 4096
    v_mfma_f32_16x16x32_bf16 v[244:247], a[56:59], a[244:247], v[244:247]
    buffer_store_dwordx4 v[80:83], v1, s[48:51], s52 offen offset:0 sc1
    v_mfma_f32_16x16x32_bf16 a[112:115], a[56:59], a[248:251], a[112:115]
    v_mfma_f32_16x16x32_bf16 a[116:119], a[56:59], a[252:255], a[116:119]
    v_mfma_f32_16x16x32_bf16 v[248:251], a[60:63], a[240:243], v[248:251]
    v_mfma_f32_16x16x32_bf16 v[252:255], a[60:63], a[244:247], v[252:255]
    v_mfma_f32_16x16x32_bf16 a[120:123], a[60:63], a[248:251], a[120:123]
    v_mfma_f32_16x16x32_bf16 a[124:127], a[60:63], a[252:255], a[124:127]
    s_waitcnt vmcnt(15) lgkmcnt(0)
    v_mfma_f32_16x16x32_bf16 v[192:195], a[0:3], a[128:131], v[192:195]
    ds_read_b64_tr_b16 a[32:33], v42 offset:40960
    ds_read_b64_tr_b16 a[34:35], v42 offset:41984
    v_mfma_f32_16x16x32_bf16 v[196:199], a[0:3], a[132:135], v[196:199]
    buffer_load_dwordx4 a[176:179], v36, s[8:11], s62 offen sc1
    v_mfma_f32_16x16x32_bf16 a[64:67], a[0:3], a[136:139], a[64:67]
    ds_read_b64_tr_b16 a[36:37], v43 offset:40960
    v_mfma_f32_16x16x32_bf16 a[68:71], a[0:3], a[140:143], a[68:71]
    ds_read_b64_tr_b16 a[38:39], v43 offset:41984
    v_mfma_f32_16x16x32_bf16 v[200:203], a[4:7], a[128:131], v[200:203]
    ds_read_b64_tr_b16 a[40:41], v44 offset:40960
    v_mfma_f32_16x16x32_bf16 v[204:207], a[4:7], a[132:135], v[204:207]
    v_mfma_f32_16x16x32_bf16 a[72:75], a[4:7], a[136:139], a[72:75]
    buffer_load_dwordx4 a[180:183], v54, s[8:11], s62 offen sc1
    ds_read_b64_tr_b16 a[42:43], v44 offset:41984
    v_mfma_f32_16x16x32_bf16 a[76:79], a[4:7], a[140:143], a[76:79]
    ds_read_b64_tr_b16 a[44:45], v45 offset:40960
    v_mfma_f32_16x16x32_bf16 v[208:211], a[8:11], a[128:131], v[208:211]
    v_mfma_f32_16x16x32_bf16 v[212:215], a[8:11], a[132:135], v[212:215]
    ds_read_b64_tr_b16 a[46:47], v45 offset:41984
    v_mfma_f32_16x16x32_bf16 a[80:83], a[8:11], a[136:139], a[80:83]
    ds_read_b64_tr_b16 a[48:49], v46 offset:40960
    v_mfma_f32_16x16x32_bf16 a[84:87], a[8:11], a[140:143], a[84:87]
    buffer_load_dwordx4 a[184:187], v37, s[8:11], s62 offen sc1
    ds_read_b64_tr_b16 a[50:51], v46 offset:41984
    v_mfma_f32_16x16x32_bf16 v[216:219], a[12:15], a[128:131], v[216:219]
    v_mfma_f32_16x16x32_bf16 v[220:223], a[12:15], a[132:135], v[220:223]
    ds_read_b64_tr_b16 a[52:53], v47 offset:40960
    v_mfma_f32_16x16x32_bf16 a[88:91], a[12:15], a[136:139], a[88:91]
    ds_read_b64_tr_b16 a[54:55], v47 offset:41984
    v_mfma_f32_16x16x32_bf16 a[92:95], a[12:15], a[140:143], a[92:95]
    ds_read_b64_tr_b16 a[56:57], v48 offset:40960
    v_mfma_f32_16x16x32_bf16 v[224:227], a[16:19], a[128:131], v[224:227]
    v_mfma_f32_16x16x32_bf16 v[228:231], a[16:19], a[132:135], v[228:231]
    buffer_load_dwordx4 a[188:191], v55, s[8:11], s62 offen sc1
    ds_read_b64_tr_b16 a[58:59], v48 offset:41984
    v_mfma_f32_16x16x32_bf16 a[96:99], a[16:19], a[136:139], a[96:99]
    ds_read_b64_tr_b16 a[60:61], v49 offset:40960
    v_mfma_f32_16x16x32_bf16 a[100:103], a[16:19], a[140:143], a[100:103]
    v_mfma_f32_16x16x32_bf16 v[232:235], a[20:23], a[128:131], v[232:235]
    ds_read_b64_tr_b16 a[62:63], v49 offset:41984
    v_mfma_f32_16x16x32_bf16 v[236:239], a[20:23], a[132:135], v[236:239]
    s_add_u32 s62, s62, 0x20000
    v_mfma_f32_16x16x32_bf16 a[104:107], a[20:23], a[136:139], a[104:107]
    s_add_u32 s52, s47, 4096
    v_mfma_f32_16x16x32_bf16 a[108:111], a[20:23], a[140:143], a[108:111]
    buffer_store_dwordx4 v[84:87], v1, s[48:51], s52 offen offset:1024 sc1
    v_mfma_f32_16x16x32_bf16 v[240:243], a[24:27], a[128:131], v[240:243]
    v_mfma_f32_16x16x32_bf16 v[244:247], a[24:27], a[132:135], v[244:247]
    v_mfma_f32_16x16x32_bf16 a[112:115], a[24:27], a[136:139], a[112:115]
    v_mfma_f32_16x16x32_bf16 a[116:119], a[24:27], a[140:143], a[116:119]
    v_mfma_f32_16x16x32_bf16 v[248:251], a[28:31], a[128:131], v[248:251]
    s_cmp_eq_u32 s45, 0
    s_cbranch_scc1 k12_ool_44
k12_oolret_45:
    v_mfma_f32_16x16x32_bf16 v[252:255], a[28:31], a[132:135], v[252:255]
    v_mfma_f32_16x16x32_bf16 a[120:123], a[28:31], a[136:139], a[120:123]
    v_mfma_f32_16x16x32_bf16 a[124:127], a[28:31], a[140:143], a[124:127]
    s_waitcnt vmcnt(10) lgkmcnt(0)
    s_barrier
    v_mfma_f32_16x16x32_bf16 v[192:195], a[32:35], a[144:147], v[192:195]
    ds_read_b64_tr_b16 a[0:1], v42 offset:49152
    ds_read_b64_tr_b16 a[2:3], v42 offset:50176
    v_mfma_f32_16x16x32_bf16 v[196:199], a[32:35], a[148:151], v[196:199]
    s_add_u32 m0, s60, 98304
    v_mfma_f32_16x16x32_bf16 a[64:67], a[32:35], a[152:155], a[64:67]
    buffer_load_dwordx4 v38, s[12:15], s61 offen offset:0 lds
    ds_read_b64_tr_b16 a[4:5], v43 offset:49152
    v_mfma_f32_16x16x32_bf16 a[68:71], a[32:35], a[156:159], a[68:71]
    ds_read_b64_tr_b16 a[6:7], v43 offset:50176
    v_mfma_f32_16x16x32_bf16 v[200:203], a[36:39], a[144:147], v[200:203]
    buffer_load_dwordx4 v39, s[12:15], s61 offen offset:1024 lds
    ds_read_b64_tr_b16 a[8:9], v44 offset:49152
    v_mfma_f32_16x16x32_bf16 v[204:207], a[36:39], a[148:151], v[204:207]
    v_mfma_f32_16x16x32_bf16 a[72:75], a[36:39], a[152:155], a[72:75]
    ds_read_b64_tr_b16 a[10:11], v44 offset:50176
    v_mfma_f32_16x16x32_bf16 a[76:79], a[36:39], a[156:159], a[76:79]
    buffer_load_dwordx4 v40, s[12:15], s61 offen offset:2048 lds
    ds_read_b64_tr_b16 a[12:13], v45 offset:49152
    v_mfma_f32_16x16x32_bf16 v[208:211], a[40:43], a[144:147], v[208:211]
    v_mfma_f32_16x16x32_bf16 v[212:215], a[40:43], a[148:151], v[212:215]
    ds_read_b64_tr_b16 a[14:15], v45 offset:50176
    v_mfma_f32_16x16x32_bf16 a[80:83], a[40:43], a[152:155], a[80:83]
    buffer_load_dwordx4 v41, s[12:15], s61 offen offset:3072 lds
    ds_read_b64_tr_b16 a[16:17], v46 offset:49152
    v_mfma_f32_16x16x32_bf16 a[84:87], a[40:43], a[156:159], a[84:87]
    ds_read_b64_tr_b16 a[18:19], v46 offset:50176
    v_mfma_f32_16x16x32_bf16 v[216:219], a[44:47], a[144:147], v[216:219]
    s_add_u32 s61, s61, 0x80000
    v_mfma_f32_16x16x32_bf16 v[220:223], a[44:47], a[148:151], v[220:223]
    buffer_load_dwordx4 a[192:195], v36, s[8:11], s62 offen sc1
    ds_read_b64_tr_b16 a[20:21], v47 offset:49152
    v_mfma_f32_16x16x32_bf16 a[88:91], a[44:47], a[152:155], a[88:91]
    ds_read_b64_tr_b16 a[22:23], v47 offset:50176
    v_mfma_f32_16x16x32_bf16 a[92:95], a[44:47], a[156:159], a[92:95]
    buffer_load_dwordx4 a[196:199], v54, s[8:11], s62 offen sc1
    ds_read_b64_tr_b16 a[24:25], v48 offset:49152
    v_mfma_f32_16x16x32_bf16 v[224:227], a[48:51], a[144:147], v[224:227]
    v_mfma_f32_16x16x32_bf16 v[228:231], a[48:51], a[148:151], v[228:231]
    ds_read_b64_tr_b16 a[26:27], v48 offset:50176
    v_mfma_f32_16x16x32_bf16 a[96:99], a[48:51], a[152:155], a[96:99]
    buffer_load_dwordx4 a[200:203], v37, s[8:11], s62 offen sc1
    ds_read_b64_tr_b16 a[28:29], v49 offset:49152
    v_mfma_f32_16x16x32_bf16 a[100:103], a[48:51], a[156:159], a[100:103]
    v_mfma_f32_16x16x32_bf16 v[232:235], a[52:55], a[144:147], v[232:235]
    ds_read_b64_tr_b16 a[30:31], v49 offset:50176
    v_mfma_f32_16x16x32_bf16 v[236:239], a[52:55], a[148:151], v[236:239]
    buffer_load_dwordx4 a[204:207], v55, s[8:11], s62 offen sc1
    v_mfma_f32_16x16x32_bf16 a[104:107], a[52:55], a[152:155], a[104:107]
    v_mfma_f32_16x16x32_bf16 a[108:111], a[52:55], a[156:159], a[108:111]
    s_add_u32 s62, s62, 0x20000
    v_mfma_f32_16x16x32_bf16 v[240:243], a[56:59], a[144:147], v[240:243]
    s_add_u32 s52, s47, 4096
    v_mfma_f32_16x16x32_bf16 v[244:247], a[56:59], a[148:151], v[244:247]
    buffer_store_dwordx4 v[88:91], v1, s[48:51], s52 offen offset:2048 sc1
    v_mfma_f32_16x16x32_bf16 a[112:115], a[56:59], a[152:155], a[112:115]
    v_mfma_f32_16x16x32_bf16 a[116:119], a[56:59], a[156:159], a[116:119]
    v_mfma_f32_16x16x32_bf16 v[248:251], a[60:63], a[144:147], v[248:251]
    v_mfma_f32_16x16x32_bf16 v[252:255], a[60:63], a[148:151], v[252:255]
    v_mfma_f32_16x16x32_bf16 a[120:123], a[60:63], a[152:155], a[120:123]
    v_mfma_f32_16x16x32_bf16 a[124:127], a[60:63], a[156:159], a[124:127]
    s_waitcnt vmcnt(15) lgkmcnt(0)
    v_mfma_f32_16x16x32_bf16 v[192:195], a[0:3], a[160:163], v[192:195]
    ds_read_b64_tr_b16 a[32:33], v42 offset:57344
    ds_read_b64_tr_b16 a[34:35], v42 offset:58368
    v_mfma_f32_16x16x32_bf16 v[196:199], a[0:3], a[164:167], v[196:199]
    buffer_load_dwordx4 a[208:211], v36, s[8:11], s62 offen sc1
    v_mfma_f32_16x16x32_bf16 a[64:67], a[0:3], a[168:171], a[64:67]
    ds_read_b64_tr_b16 a[36:37], v43 offset:57344
    v_mfma_f32_16x16x32_bf16 a[68:71], a[0:3], a[172:175], a[68:71]
    ds_read_b64_tr_b16 a[38:39], v43 offset:58368
    v_mfma_f32_16x16x32_bf16 v[200:203], a[4:7], a[160:163], v[200:203]
    ds_read_b64_tr_b16 a[40:41], v44 offset:57344
    v_mfma_f32_16x16x32_bf16 v[204:207], a[4:7], a[164:167], v[204:207]
    v_mfma_f32_16x16x32_bf16 a[72:75], a[4:7], a[168:171], a[72:75]
    buffer_load_dwordx4 a[212:215], v54, s[8:11], s62 offen sc1
    ds_read_b64_tr_b16 a[42:43], v44 offset:58368
    v_mfma_f32_16x16x32_bf16 a[76:79], a[4:7], a[172:175], a[76:79]
    ds_read_b64_tr_b16 a[44:45], v45 offset:57344
    v_mfma_f32_16x16x32_bf16 v[208:211], a[8:11], a[160:163], v[208:211]
    v_mfma_f32_16x16x32_bf16 v[212:215], a[8:11], a[164:167], v[212:215]
    ds_read_b64_tr_b16 a[46:47], v45 offset:58368
    v_mfma_f32_16x16x32_bf16 a[80:83], a[8:11], a[168:171], a[80:83]
    ds_read_b64_tr_b16 a[48:49], v46 offset:57344
    v_mfma_f32_16x16x32_bf16 a[84:87], a[8:11], a[172:175], a[84:87]
    buffer_load_dwordx4 a[216:219], v37, s[8:11], s62 offen sc1
    ds_read_b64_tr_b16 a[50:51], v46 offset:58368
    v_mfma_f32_16x16x32_bf16 v[216:219], a[12:15], a[160:163], v[216:219]
    v_mfma_f32_16x16x32_bf16 v[220:223], a[12:15], a[164:167], v[220:223]
    ds_read_b64_tr_b16 a[52:53], v47 offset:57344
    v_mfma_f32_16x16x32_bf16 a[88:91], a[12:15], a[168:171], a[88:91]
    ds_read_b64_tr_b16 a[54:55], v47 offset:58368
    v_mfma_f32_16x16x32_bf16 a[92:95], a[12:15], a[172:175], a[92:95]
    ds_read_b64_tr_b16 a[56:57], v48 offset:57344
    v_mfma_f32_16x16x32_bf16 v[224:227], a[16:19], a[160:163], v[224:227]
    v_mfma_f32_16x16x32_bf16 v[228:231], a[16:19], a[164:167], v[228:231]
    buffer_load_dwordx4 a[220:223], v55, s[8:11], s62 offen sc1
    ds_read_b64_tr_b16 a[58:59], v48 offset:58368
    v_mfma_f32_16x16x32_bf16 a[96:99], a[16:19], a[168:171], a[96:99]
    ds_read_b64_tr_b16 a[60:61], v49 offset:57344
    v_mfma_f32_16x16x32_bf16 a[100:103], a[16:19], a[172:175], a[100:103]
    v_mfma_f32_16x16x32_bf16 v[232:235], a[20:23], a[160:163], v[232:235]
    ds_read_b64_tr_b16 a[62:63], v49 offset:58368
    v_mfma_f32_16x16x32_bf16 v[236:239], a[20:23], a[164:167], v[236:239]
    s_add_u32 s62, s62, 0x20000
    v_mfma_f32_16x16x32_bf16 a[104:107], a[20:23], a[168:171], a[104:107]
    s_add_u32 s52, s47, 4096
    v_mfma_f32_16x16x32_bf16 a[108:111], a[20:23], a[172:175], a[108:111]
    buffer_store_dwordx4 v[92:95], v1, s[48:51], s52 offen offset:3072 sc1
    v_mfma_f32_16x16x32_bf16 v[240:243], a[24:27], a[160:163], v[240:243]
    v_mfma_f32_16x16x32_bf16 v[244:247], a[24:27], a[164:167], v[244:247]
    v_mfma_f32_16x16x32_bf16 a[112:115], a[24:27], a[168:171], a[112:115]
    v_mfma_f32_16x16x32_bf16 a[116:119], a[24:27], a[172:175], a[116:119]
    v_mfma_f32_16x16x32_bf16 v[248:251], a[28:31], a[160:163], v[248:251]
    s_cmp_eq_u32 s45, 0
    s_cbranch_scc1 k12_ool_46
k12_oolret_47:
    v_mfma_f32_16x16x32_bf16 v[252:255], a[28:31], a[164:167], v[252:255]
    v_mfma_f32_16x16x32_bf16 a[120:123], a[28:31], a[168:171], a[120:123]
    v_mfma_f32_16x16x32_bf16 a[124:127], a[28:31], a[172:175], a[124:127]
    s_waitcnt vmcnt(10) lgkmcnt(0)
    s_barrier
    v_mfma_f32_16x16x32_bf16 v[192:195], a[32:35], a[176:179], v[192:195]
    ds_read_b64_tr_b16 a[0:1], v42 offset:0
    ds_read_b64_tr_b16 a[2:3], v42 offset:1024
    v_mfma_f32_16x16x32_bf16 v[196:199], a[32:35], a[180:183], v[196:199]
    s_add_u32 m0, s60, 114688
    v_mfma_f32_16x16x32_bf16 a[64:67], a[32:35], a[184:187], a[64:67]
    buffer_load_dwordx4 v38, s[12:15], s61 offen offset:0 lds
    ds_read_b64_tr_b16 a[4:5], v43 offset:0
    v_mfma_f32_16x16x32_bf16 a[68:71], a[32:35], a[188:191], a[68:71]
    ds_read_b64_tr_b16 a[6:7], v43 offset:1024
    v_mfma_f32_16x16x32_bf16 v[200:203], a[36:39], a[176:179], v[200:203]
    buffer_load_dwordx4 v39, s[12:15], s61 offen offset:1024 lds
    ds_read_b64_tr_b16 a[8:9], v44 offset:0
    v_mfma_f32_16x16x32_bf16 v[204:207], a[36:39], a[180:183], v[204:207]
    v_mfma_f32_16x16x32_bf16 a[72:75], a[36:39], a[184:187], a[72:75]
    ds_read_b64_tr_b16 a[10:11], v44 offset:1024
    v_mfma_f32_16x16x32_bf16 a[76:79], a[36:39], a[188:191], a[76:79]
    buffer_load_dwordx4 v40, s[12:15], s61 offen offset:2048 lds
    ds_read_b64_tr_b16 a[12:13], v45 offset:0
    v_mfma_f32_16x16x32_bf16 v[208:211], a[40:43], a[176:179], v[208:211]
    v_mfma_f32_16x16x32_bf16 v[212:215], a[40:43], a[180:183], v[212:215]
    ds_read_b64_tr_b16 a[14:15], v45 offset:1024
    v_mfma_f32_16x16x32_bf16 a[80:83], a[40:43], a[184:187], a[80:83]
    buffer_load_dwordx4 v41, s[12:15], s61 offen offset:3072 lds
    ds_read_b64_tr_b16 a[16:17], v46 offset:0
    v_mfma_f32_16x16x32_bf16 a[84:87], a[40:43], a[188:191], a[84:87]
    ds_read_b64_tr_b16 a[18:19], v46 offset:1024
    v_mfma_f32_16x16x32_bf16 v[216:219], a[44:47], a[176:179], v[216:219]
    s_add_u32 s61, s61, 0x80000
    v_mfma_f32_16x16x32_bf16 v[220:223], a[44:47], a[180:183], v[220:223]
    buffer_load_dwordx4 a[224:227], v36, s[8:11], s62 offen sc1
    ds_read_b64_tr_b16 a[20:21], v47 offset:0
    v_mfma_f32_16x16x32_bf16 a[88:91], a[44:47], a[184:187], a[88:91]
    ds_read_b64_tr_b16 a[22:23], v47 offset:1024
    v_mfma_f32_16x16x32_bf16 a[92:95], a[44:47], a[188:191], a[92:95]
    buffer_load_dwordx4 a[228:231], v54, s[8:11], s62 offen sc1
    ds_read_b64_tr_b16 a[24:25], v48 offset:0
    v_mfma_f32_16x16x32_bf16 v[224:227], a[48:51], a[176:179], v[224:227]
    v_mfma_f32_16x16x32_bf16 v[228:231], a[48:51], a[180:183], v[228:231]
    ds_read_b64_tr_b16 a[26:27], v48 offset:1024
    v_mfma_f32_16x16x32_bf16 a[96:99], a[48:51], a[184:187], a[96:99]
    buffer_load_dwordx4 a[232:235], v37, s[8:11], s62 offen sc1
    ds_read_b64_tr_b16 a[28:29], v49 offset:0
    v_mfma_f32_16x16x32_bf16 a[100:103], a[48:51], a[188:191], a[100:103]
    v_mfma_f32_16x16x32_bf16 v[232:235], a[52:55], a[176:179], v[232:235]
    ds_read_b64_tr_b16 a[30:31], v49 offset:1024
    v_mfma_f32_16x16x32_bf16 v[236:239], a[52:55], a[180:183], v[236:239]
    buffer_load_dwordx4 a[236:239], v55, s[8:11], s62 offen sc1
    v_mfma_f32_16x16x32_bf16 a[104:107], a[52:55], a[184:187], a[104:107]
    v_mfma_f32_16x16x32_bf16 a[108:111], a[52:55], a[188:191], a[108:111]
    s_add_u32 s62, s62, 0x20000
    v_mfma_f32_16x16x32_bf16 v[240:243], a[56:59], a[176:179], v[240:243]
    s_add_u32 s52, s47, 8192
    v_mfma_f32_16x16x32_bf16 v[244:247], a[56:59], a[180:183], v[244:247]
    buffer_store_dwordx4 v[96:99], v1, s[48:51], s52 offen offset:0 sc1
    v_mfma_f32_16x16x32_bf16 a[112:115], a[56:59], a[184:187], a[112:115]
    v_mfma_f32_16x16x32_bf16 a[116:119], a[56:59], a[188:191], a[116:119]
    v_mfma_f32_16x16x32_bf16 v[248:251], a[60:63], a[176:179], v[248:251]
    v_mfma_f32_16x16x32_bf16 v[252:255], a[60:63], a[180:183], v[252:255]
    v_mfma_f32_16x16x32_bf16 a[120:123], a[60:63], a[184:187], a[120:123]
    v_mfma_f32_16x16x32_bf16 a[124:127], a[60:63], a[188:191], a[124:127]
    s_waitcnt vmcnt(15) lgkmcnt(0)
    v_mfma_f32_16x16x32_bf16 v[192:195], a[0:3], a[192:195], v[192:195]
    ds_read_b64_tr_b16 a[32:33], v42 offset:8192
    ds_read_b64_tr_b16 a[34:35], v42 offset:9216
    v_mfma_f32_16x16x32_bf16 v[196:199], a[0:3], a[196:199], v[196:199]
    buffer_load_dwordx4 a[240:243], v36, s[8:11], s62 offen sc1
    v_mfma_f32_16x16x32_bf16 a[64:67], a[0:3], a[200:203], a[64:67]
    ds_read_b64_tr_b16 a[36:37], v43 offset:8192
    v_mfma_f32_16x16x32_bf16 a[68:71], a[0:3], a[204:207], a[68:71]
    ds_read_b64_tr_b16 a[38:39], v43 offset:9216
    v_mfma_f32_16x16x32_bf16 v[200:203], a[4:7], a[192:195], v[200:203]
    ds_read_b64_tr_b16 a[40:41], v44 offset:8192
    v_mfma_f32_16x16x32_bf16 v[204:207], a[4:7], a[196:199], v[204:207]
    v_mfma_f32_16x16x32_bf16 a[72:75], a[4:7], a[200:203], a[72:75]
    buffer_load_dwordx4 a[244:247], v54, s[8:11], s62 offen sc1
    ds_read_b64_tr_b16 a[42:43], v44 offset:9216
    v_mfma_f32_16x16x32_bf16 a[76:79], a[4:7], a[204:207], a[76:79]
    ds_read_b64_tr_b16 a[44:45], v45 offset:8192
    v_mfma_f32_16x16x32_bf16 v[208:211], a[8:11], a[192:195], v[208:211]
    v_mfma_f32_16x16x32_bf16 v[212:215], a[8:11], a[196:199], v[212:215]
    ds_read_b64_tr_b16 a[46:47], v45 offset:9216
    v_mfma_f32_16x16x32_bf16 a[80:83], a[8:11], a[200:203], a[80:83]
    ds_read_b64_tr_b16 a[48:49], v46 offset:8192
    v_mfma_f32_16x16x32_bf16 a[84:87], a[8:11], a[204:207], a[84:87]
    buffer_load_dwordx4 a[248:251], v37, s[8:11], s62 offen sc1
    ds_read_b64_tr_b16 a[50:51], v46 offset:9216
    v_mfma_f32_16x16x32_bf16 v[216:219], a[12:15], a[192:195], v[216:219]
    v_mfma_f32_16x16x32_bf16 v[220:223], a[12:15], a[196:199], v[220:223]
    ds_read_b64_tr_b16 a[52:53], v47 offset:8192
    v_mfma_f32_16x16x32_bf16 a[88:91], a[12:15], a[200:203], a[88:91]
    ds_read_b64_tr_b16 a[54:55], v47 offset:9216
    v_mfma_f32_16x16x32_bf16 a[92:95], a[12:15], a[204:207], a[92:95]
    ds_read_b64_tr_b16 a[56:57], v48 offset:8192
    v_mfma_f32_16x16x32_bf16 v[224:227], a[16:19], a[192:195], v[224:227]
    v_mfma_f32_16x16x32_bf16 v[228:231], a[16:19], a[196:199], v[228:231]
    buffer_load_dwordx4 a[252:255], v55, s[8:11], s62 offen sc1
    ds_read_b64_tr_b16 a[58:59], v48 offset:9216
    v_mfma_f32_16x16x32_bf16 a[96:99], a[16:19], a[200:203], a[96:99]
    ds_read_b64_tr_b16 a[60:61], v49 offset:8192
    v_mfma_f32_16x16x32_bf16 a[100:103], a[16:19], a[204:207], a[100:103]
    v_mfma_f32_16x16x32_bf16 v[232:235], a[20:23], a[192:195], v[232:235]
    ds_read_b64_tr_b16 a[62:63], v49 offset:9216
    v_mfma_f32_16x16x32_bf16 v[236:239], a[20:23], a[196:199], v[236:239]
    s_add_u32 s62, s62, 0x20000
    v_mfma_f32_16x16x32_bf16 a[104:107], a[20:23], a[200:203], a[104:107]
    s_add_u32 s52, s47, 8192
    v_mfma_f32_16x16x32_bf16 a[108:111], a[20:23], a[204:207], a[108:111]
    buffer_store_dwordx4 v[100:103], v1, s[48:51], s52 offen offset:1024 sc1
    v_mfma_f32_16x16x32_bf16 v[240:243], a[24:27], a[192:195], v[240:243]
    v_mfma_f32_16x16x32_bf16 v[244:247], a[24:27], a[196:199], v[244:247]
    v_mfma_f32_16x16x32_bf16 a[112:115], a[24:27], a[200:203], a[112:115]
    v_mfma_f32_16x16x32_bf16 a[116:119], a[24:27], a[204:207], a[116:119]
    v_mfma_f32_16x16x32_bf16 v[248:251], a[28:31], a[192:195], v[248:251]
    s_cmp_eq_u32 s45, 0
    s_cbranch_scc1 k12_ool_48
k12_oolret_49:
    v_mfma_f32_16x16x32_bf16 v[252:255], a[28:31], a[196:199], v[252:255]
    v_mfma_f32_16x16x32_bf16 a[120:123], a[28:31], a[200:203], a[120:123]
    v_mfma_f32_16x16x32_bf16 a[124:127], a[28:31], a[204:207], a[124:127]
    s_waitcnt vmcnt(10) lgkmcnt(0)
    s_barrier
    v_mfma_f32_16x16x32_bf16 v[192:195], a[32:35], a[208:211], v[192:195]
    ds_read_b64_tr_b16 a[0:1], v42 offset:16384
    ds_read_b64_tr_b16 a[2:3], v42 offset:17408
    v_mfma_f32_16x16x32_bf16 v[196:199], a[32:35], a[212:215], v[196:199]
    s_add_u32 m0, s60, 131072
    v_mfma_f32_16x16x32_bf16 a[64:67], a[32:35], a[216:219], a[64:67]
    buffer_load_dwordx4 v38, s[12:15], s61 offen offset:0 lds
    ds_read_b64_tr_b16 a[4:5], v43 offset:16384
    v_mfma_f32_16x16x32_bf16 a[68:71], a[32:35], a[220:223], a[68:71]
    ds_read_b64_tr_b16 a[6:7], v43 offset:17408
    v_mfma_f32_16x16x32_bf16 v[200:203], a[36:39], a[208:211], v[200:203]
    buffer_load_dwordx4 v39, s[12:15], s61 offen offset:1024 lds
    ds_read_b64_tr_b16 a[8:9], v44 offset:16384
    v_mfma_f32_16x16x32_bf16 v[204:207], a[36:39], a[212:215], v[204:207]
    v_mfma_f32_16x16x32_bf16 a[72:75], a[36:39], a[216:219], a[72:75]
    buffer_load_dwordx4 v40, s[12:15], s61 offen offset:2048 lds
    ds_read_b64_tr_b16 a[10:11], v44 offset:17408
    v_mfma_f32_16x16x32_bf16 a[76:79], a[36:39], a[220:223], a[76:79]
    ds_read_b64_tr_b16 a[12:13], v45 offset:16384
    v_mfma_f32_16x16x32_bf16 v[208:211], a[40:43], a[208:211], v[208:211]
    v_mfma_f32_16x16x32_bf16 v[212:215], a[40:43], a[212:215], v[212:215]
    buffer_load_dwordx4 v41, s[12:15], s61 offen offset:3072 lds
    ds_read_b64_tr_b16 a[14:15], v45 offset:17408
    v_mfma_f32_16x16x32_bf16 a[80:83], a[40:43], a[216:219], a[80:83]
    s_add_u32 s61, s61, 0x80000
    ds_read_b64_tr_b16 a[16:17], v46 offset:16384
    v_mfma_f32_16x16x32_bf16 a[84:87], a[40:43], a[220:223], a[84:87]
    buffer_load_dwordx4 a[128:131], v36, s[8:11], s62 offen sc1
    ds_read_b64_tr_b16 a[18:19], v46 offset:17408
    v_mfma_f32_16x16x32_bf16 v[216:219], a[44:47], a[208:211], v[216:219]
    v_mfma_f32_16x16x32_bf16 v[220:223], a[44:47], a[212:215], v[220:223]
    ds_read_b64_tr_b16 a[20:21], v47 offset:16384
    v_mfma_f32_16x16x32_bf16 a[88:91], a[44:47], a[216:219], a[88:91]
    buffer_load_dwordx4 a[132:135], v54, s[8:11], s62 offen sc1
    ds_read_b64_tr_b16 a[22:23], v47 offset:17408
    v_mfma_f32_16x16x32_bf16 a[92:95], a[44:47], a[220:223], a[92:95]
    ds_read_b64_tr_b16 a[24:25], v48 offset:16384
    v_mfma_f32_16x16x32_bf16 v[224:227], a[48:51], a[208:211], v[224:227]
    v_mfma_f32_16x16x32_bf16 v[228:231], a[48:51], a[212:215], v[228:231]
    buffer_load_dwordx4 a[136:139], v37, s[8:11], s62 offen sc1
    ds_read_b64_tr_b16 a[26:27], v48 offset:17408
    v_mfma_f32_16x16x32_bf16 a[96:99], a[48:51], a[216:219], a[96:99]
    ds_read_b64_tr_b16 a[28:29], v49 offset:16384
    v_mfma_f32_16x16x32_bf16 a[100:103], a[48:51], a[220:223], a[100:103]
    buffer_load_dwordx4 a[140:143], v55, s[8:11], s62 offen sc1
    v_mfma_f32_16x16x32_bf16 v[232:235], a[52:55], a[208:211], v[232:235]
    ds_read_b64_tr_b16 a[30:31], v49 offset:17408
    v_mfma_f32_16x16x32_bf16 v[236:239], a[52:55], a[212:215], v[236:239]
    s_add_u32 s62, s62, 0x20000
    v_mfma_f32_16x16x32_bf16 a[104:107], a[52:55], a[216:219], a[104:107]
    s_add_u32 s52, s47, 8192
    v_mfma_f32_16x16x32_bf16 a[108:111], a[52:55], a[220:223], a[108:111]
    buffer_store_dwordx4 v[104:107], v1, s[48:51], s52 offen offset:2048 sc1
    v_mfma_f32_16x16x32_bf16 v[240:243], a[56:59], a[208:211], v[240:243]
    s_add_u32 s52, s47, 8192
    v_mfma_f32_16x16x32_bf16 v[244:247], a[56:59], a[212:215], v[244:247]
    buffer_store_dwordx4 v[108:111], v1, s[48:51], s52 offen offset:3072 sc1
    v_mfma_f32_16x16x32_bf16 a[112:115], a[56:59], a[216:219], a[112:115]
    v_mfma_f32_16x16x32_bf16 a[116:119], a[56:59], a[220:223], a[116:119]
    v_mfma_f32_16x16x32_bf16 v[248:251], a[60:63], a[208:211], v[248:251]
    v_mfma_f32_16x16x32_bf16 v[252:255], a[60:63], a[212:215], v[252:255]
    v_mfma_f32_16x16x32_bf16 a[120:123], a[60:63], a[216:219], a[120:123]
    v_mfma_f32_16x16x32_bf16 a[124:127], a[60:63], a[220:223], a[124:127]
    s_waitcnt vmcnt(16) lgkmcnt(0)
    v_mfma_f32_16x16x32_bf16 v[192:195], a[0:3], a[224:227], v[192:195]
    ds_read_b64_tr_b16 a[32:33], v42 offset:24576
    ds_read_b64_tr_b16 a[34:35], v42 offset:25600
    v_mfma_f32_16x16x32_bf16 v[196:199], a[0:3], a[228:231], v[196:199]
    buffer_load_dwordx4 a[144:147], v36, s[8:11], s62 offen sc1
    v_mfma_f32_16x16x32_bf16 a[64:67], a[0:3], a[232:235], a[64:67]
    ds_read_b64_tr_b16 a[36:37], v43 offset:24576
    v_mfma_f32_16x16x32_bf16 a[68:71], a[0:3], a[236:239], a[68:71]
    ds_read_b64_tr_b16 a[38:39], v43 offset:25600
    v_mfma_f32_16x16x32_bf16 v[200:203], a[4:7], a[224:227], v[200:203]
    ds_read_b64_tr_b16 a[40:41], v44 offset:24576
    v_mfma_f32_16x16x32_bf16 v[204:207], a[4:7], a[228:231], v[204:207]
    v_mfma_f32_16x16x32_bf16 a[72:75], a[4:7], a[232:235], a[72:75]
    buffer_load_dwordx4 a[148:151], v54, s[8:11], s62 offen sc1
    ds_read_b64_tr_b16 a[42:43], v44 offset:25600
    v_mfma_f32_16x16x32_bf16 a[76:79], a[4:7], a[236:239], a[76:79]
    ds_read_b64_tr_b16 a[44:45], v45 offset:24576
    v_mfma_f32_16x16x32_bf16 v[208:211], a[8:11], a[224:227], v[208:211]
    v_mfma_f32_16x16x32_bf16 v[212:215], a[8:11], a[228:231], v[212:215]
    ds_read_b64_tr_b16 a[46:47], v45 offset:25600
    v_mfma_f32_16x16x32_bf16 a[80:83], a[8:11], a[232:235], a[80:83]
    ds_read_b64_tr_b16 a[48:49], v46 offset:24576
    v_mfma_f32_16x16x32_bf16 a[84:87], a[8:11], a[236:239], a[84:87]
    buffer_load_dwordx4 a[152:155], v37, s[8:11], s62 offen sc1
    ds_read_b64_tr_b16 a[50:51], v46 offset:25600
    v_mfma_f32_16x16x32_bf16 v[216:219], a[12:15], a[224:227], v[216:219]
    v_mfma_f32_16x16x32_bf16 v[220:223], a[12:15], a[228:231], v[220:223]
    ds_read_b64_tr_b16 a[52:53], v47 offset:24576
    v_mfma_f32_16x16x32_bf16 a[88:91], a[12:15], a[232:235], a[88:91]
    ds_read_b64_tr_b16 a[54:55], v47 offset:25600
    v_mfma_f32_16x16x32_bf16 a[92:95], a[12:15], a[236:239], a[92:95]
    ds_read_b64_tr_b16 a[56:57], v48 offset:24576
    v_mfma_f32_16x16x32_bf16 v[224:227], a[16:19], a[224:227], v[224:227]
    v_mfma_f32_16x16x32_bf16 v[228:231], a[16:19], a[228:231], v[228:231]
    buffer_load_dwordx4 a[156:159], v55, s[8:11], s62 offen sc1
    ds_read_b64_tr_b16 a[58:59], v48 offset:25600
    v_mfma_f32_16x16x32_bf16 a[96:99], a[16:19], a[232:235], a[96:99]
    ds_read_b64_tr_b16 a[60:61], v49 offset:24576
    v_mfma_f32_16x16x32_bf16 a[100:103], a[16:19], a[236:239], a[100:103]
    v_mfma_f32_16x16x32_bf16 v[232:235], a[20:23], a[224:227], v[232:235]
    ds_read_b64_tr_b16 a[62:63], v49 offset:25600
    v_mfma_f32_16x16x32_bf16 v[236:239], a[20:23], a[228:231], v[236:239]
    s_add_u32 s62, s62, 0x20000
    v_mfma_f32_16x16x32_bf16 a[104:107], a[20:23], a[232:235], a[104:107]
    s_add_u32 s52, s47, 12288
    v_mfma_f32_16x16x32_bf16 a[108:111], a[20:23], a[236:239], a[108:111]
    buffer_store_dwordx4 v[112:115], v1, s[48:51], s52 offen offset:0 sc1
    v_mfma_f32_16x16x32_bf16 v[240:243], a[24:27], a[224:227], v[240:243]
    v_mfma_f32_16x16x32_bf16 v[244:247], a[24:27], a[228:231], v[244:247]
    v_mfma_f32_16x16x32_bf16 a[112:115], a[24:27], a[232:235], a[112:115]
    v_mfma_f32_16x16x32_bf16 a[116:119], a[24:27], a[236:239], a[116:119]
    v_mfma_f32_16x16x32_bf16 v[248:251], a[28:31], a[224:227], v[248:251]
    v_mfma_f32_16x16x32_bf16 v[252:255], a[28:31], a[228:231], v[252:255]
    v_mfma_f32_16x16x32_bf16 a[120:123], a[28:31], a[232:235], a[120:123]
    v_mfma_f32_16x16x32_bf16 a[124:127], a[28:31], a[236:239], a[124:127]
    s_waitcnt vmcnt(11) lgkmcnt(0)
    s_barrier
    v_mfma_f32_16x16x32_bf16 v[192:195], a[32:35], a[240:243], v[192:195]
    ds_read_b64_tr_b16 a[0:1], v42 offset:32768
    ds_read_b64_tr_b16 a[2:3], v42 offset:33792
    v_mfma_f32_16x16x32_bf16 v[196:199], a[32:35], a[244:247], v[196:199]
    s_add_u32 m0, s60, 147456
    v_mfma_f32_16x16x32_bf16 a[64:67], a[32:35], a[248:251], a[64:67]
    buffer_load_dwordx4 v38, s[12:15], s61 offen offset:0 lds
    ds_read_b64_tr_b16 a[4:5], v43 offset:32768
    v_mfma_f32_16x16x32_bf16 a[68:71], a[32:35], a[252:255], a[68:71]
    ds_read_b64_tr_b16 a[6:7], v43 offset:33792
    v_mfma_f32_16x16x32_bf16 v[200:203], a[36:39], a[240:243], v[200:203]
    buffer_load_dwordx4 v39, s[12:15], s61 offen offset:1024 lds
    ds_read_b64_tr_b16 a[8:9], v44 offset:32768
    v_mfma_f32_16x16x32_bf16 v[204:207], a[36:39], a[244:247], v[204:207]
    v_mfma_f32_16x16x32_bf16 a[72:75], a[36:39], a[248:251], a[72:75]
    ds_read_b64_tr_b16 a[10:11], v44 offset:33792
    v_mfma_f32_16x16x32_bf16 a[76:79], a[36:39], a[252:255], a[76:79]
    buffer_load_dwordx4 v40, s[12:15], s61 offen offset:2048 lds
    ds_read_b64_tr_b16 a[12:13], v45 offset:32768
    v_mfma_f32_16x16x32_bf16 v[208:211], a[40:43], a[240:243], v[208:211]
    v_mfma_f32_16x16x32_bf16 v[212:215], a[40:43], a[244:247], v[212:215]
    ds_read_b64_tr_b16 a[14:15], v45 offset:33792
    v_mfma_f32_16x16x32_bf16 a[80:83], a[40:43], a[248:251], a[80:83]
    buffer_load_dwordx4 v41, s[12:15], s61 offen offset:3072 lds
    ds_read_b64_tr_b16 a[16:17], v46 offset:32768
    v_mfma_f32_16x16x32_bf16 a[84:87], a[40:43], a[252:255], a[84:87]
    ds_read_b64_tr_b16 a[18:19], v46 offset:33792
    v_mfma_f32_16x16x32_bf16 v[216:219], a[44:47], a[240:243], v[216:219]
    s_add_u32 s61, s61, 0x80000
    v_mfma_f32_16x16x32_bf16 v[220:223], a[44:47], a[244:247], v[220:223]
    buffer_load_dwordx4 a[160:163], v36, s[8:11], s62 offen sc1
    ds_read_b64_tr_b16 a[20:21], v47 offset:32768
    v_mfma_f32_16x16x32_bf16 a[88:91], a[44:47], a[248:251], a[88:91]
    ds_read_b64_tr_b16 a[22:23], v47 offset:33792
    v_mfma_f32_16x16x32_bf16 a[92:95], a[44:47], a[252:255], a[92:95]
    buffer_load_dwordx4 a[164:167], v54, s[8:11], s62 offen sc1
    ds_read_b64_tr_b16 a[24:25], v48 offset:32768
    v_mfma_f32_16x16x32_bf16 v[224:227], a[48:51], a[240:243], v[224:227]
    v_mfma_f32_16x16x32_bf16 v[228:231], a[48:51], a[244:247], v[228:231]
    ds_read_b64_tr_b16 a[26:27], v48 offset:33792
    v_mfma_f32_16x16x32_bf16 a[96:99], a[48:51], a[248:251], a[96:99]
    buffer_load_dwordx4 a[168:171], v37, s[8:11], s62 offen sc1
    ds_read_b64_tr_b16 a[28:29], v49 offset:32768
    v_mfma_f32_16x16x32_bf16 a[100:103], a[48:51], a[252:255], a[100:103]
    v_mfma_f32_16x16x32_bf16 v[232:235], a[52:55], a[240:243], v[232:235]
    ds_read_b64_tr_b16 a[30:31], v49 offset:33792
    v_mfma_f32_16x16x32_bf16 v[236:239], a[52:55], a[244:247], v[236:239]
    buffer_load_dwordx4 a[172:175], v55, s[8:11], s62 offen sc1
    v_mfma_f32_16x16x32_bf16 a[104:107], a[52:55], a[248:251], a[104:107]
    v_mfma_f32_16x16x32_bf16 a[108:111], a[52:55], a[252:255], a[108:111]
    s_add_u32 s62, s62, 0x20000
    v_mfma_f32_16x16x32_bf16 v[240:243], a[56:59], a[240:243], v[240:243]
    s_add_u32 s52, s47, 12288
    v_mfma_f32_16x16x32_bf16 v[244:247], a[56:59], a[244:247], v[244:247]
    buffer_store_dwordx4 v[116:119], v1, s[48:51], s52 offen offset:1024 sc1
    v_mfma_f32_16x16x32_bf16 a[112:115], a[56:59], a[248:251], a[112:115]
    v_mfma_f32_16x16x32_bf16 a[116:119], a[56:59], a[252:255], a[116:119]
    v_mfma_f32_16x16x32_bf16 v[248:251], a[60:63], a[240:243], v[248:251]
    s_cmp_eq_u32 s45, 0
    s_cbranch_scc1 k12_ool_50
k12_oolret_51:
    v_mfma_f32_16x16x32_bf16 v[252:255], a[60:63], a[244:247], v[252:255]
    v_mfma_f32_16x16x32_bf16 a[120:123], a[60:63], a[248:251], a[120:123]
    v_mfma_f32_16x16x32_bf16 a[124:127], a[60:63], a[252:255], a[124:127]
    s_waitcnt vmcnt(16) lgkmcnt(0)
    v_mfma_f32_16x16x32_bf16 v[192:195], a[0:3], a[128:131], v[192:195]
    ds_read_b64_tr_b16 a[32:33], v42 offset:40960
    ds_read_b64_tr_b16 a[34:35], v42 offset:41984
    v_mfma_f32_16x16x32_bf16 v[196:199], a[0:3], a[132:135], v[196:199]
    buffer_load_dwordx4 a[176:179], v36, s[8:11], s62 offen sc1
    v_mfma_f32_16x16x32_bf16 a[64:67], a[0:3], a[136:139], a[64:67]
    ds_read_b64_tr_b16 a[36:37], v43 offset:40960
    v_mfma_f32_16x16x32_bf16 a[68:71], a[0:3], a[140:143], a[68:71]
    ds_read_b64_tr_b16 a[38:39], v43 offset:41984
    v_mfma_f32_16x16x32_bf16 v[200:203], a[4:7], a[128:131], v[200:203]
    ds_read_b64_tr_b16 a[40:41], v44 offset:40960
    v_mfma_f32_16x16x32_bf16 v[204:207], a[4:7], a[132:135], v[204:207]
    v_mfma_f32_16x16x32_bf16 a[72:75], a[4:7], a[136:139], a[72:75]
    buffer_load_dwordx4 a[180:183], v54, s[8:11], s62 offen sc1
    ds_read_b64_tr_b16 a[42:43], v44 offset:41984
    v_mfma_f32_16x16x32_bf16 a[76:79], a[4:7], a[140:143], a[76:79]
    ds_read_b64_tr_b16 a[44:45], v45 offset:40960
    v_mfma_f32_16x16x32_bf16 v[208:211], a[8:11], a[128:131], v[208:211]
    v_mfma_f32_16x16x32_bf16 v[212:215], a[8:11], a[132:135], v[212:215]
    ds_read_b64_tr_b16 a[46:47], v45 offset:41984
    v_mfma_f32_16x16x32_bf16 a[80:83], a[8:11], a[136:139], a[80:83]
    ds_read_b64_tr_b16 a[48:49], v46 offset:40960
    v_mfma_f32_16x16x32_bf16 a[84:87], a[8:11], a[140:143], a[84:87]
    buffer_load_dwordx4 a[184:187], v37, s[8:11], s62 offen sc1
    ds_read_b64_tr_b16 a[50:51], v46 offset:41984
    v_mfma_f32_16x16x32_bf16 v[216:219], a[12:15], a[128:131], v[216:219]
    v_mfma_f32_16x16x32_bf16 v[220:223], a[12:15], a[132:135], v[220:223]
    ds_read_b64_tr_b16 a[52:53], v47 offset:40960
    v_mfma_f32_16x16x32_bf16 a[88:91], a[12:15], a[136:139], a[88:91]
    ds_read_b64_tr_b16 a[54:55], v47 offset:41984
    v_mfma_f32_16x16x32_bf16 a[92:95], a[12:15], a[140:143], a[92:95]
    ds_read_b64_tr_b16 a[56:57], v48 offset:40960
    v_mfma_f32_16x16x32_bf16 v[224:227], a[16:19], a[128:131], v[224:227]
    v_mfma_f32_16x16x32_bf16 v[228:231], a[16:19], a[132:135], v[228:231]
    buffer_load_dwordx4 a[188:191], v55, s[8:11], s62 offen sc1
    ds_read_b64_tr_b16 a[58:59], v48 offset:41984
    v_mfma_f32_16x16x32_bf16 a[96:99], a[16:19], a[136:139], a[96:99]
    ds_read_b64_tr_b16 a[60:61], v49 offset:40960
    v_mfma_f32_16x16x32_bf16 a[100:103], a[16:19], a[140:143], a[100:103]
    v_mfma_f32_16x16x32_bf16 v[232:235], a[20:23], a[128:131], v[232:235]
    ds_read_b64_tr_b16 a[62:63], v49 offset:41984
    v_mfma_f32_16x16x32_bf16 v[236:239], a[20:23], a[132:135], v[236:239]
    s_add_u32 s62, s62, 0x20000
    v_mfma_f32_16x16x32_bf16 a[104:107], a[20:23], a[136:139], a[104:107]
    s_add_u32 s52, s47, 12288
    v_mfma_f32_16x16x32_bf16 a[108:111], a[20:23], a[140:143], a[108:111]
    buffer_store_dwordx4 v[120:123], v1, s[48:51], s52 offen offset:2048 sc1
    v_mfma_f32_16x16x32_bf16 v[240:243], a[24:27], a[128:131], v[240:243]
    v_mfma_f32_16x16x32_bf16 v[244:247], a[24:27], a[132:135], v[244:247]
    v_mfma_f32_16x16x32_bf16 a[112:115], a[24:27], a[136:139], a[112:115]
    v_mfma_f32_16x16x32_bf16 a[116:119], a[24:27], a[140:143], a[116:119]
    v_mfma_f32_16x16x32_bf16 v[248:251], a[28:31], a[128:131], v[248:251]
    v_mfma_f32_16x16x32_bf16 v[252:255], a[28:31], a[132:135], v[252:255]
    v_mfma_f32_16x16x32_bf16 a[120:123], a[28:31], a[136:139], a[120:123]
    v_mfma_f32_16x16x32_bf16 a[124:127], a[28:31], a[140:143], a[124:127]
    s_waitcnt vmcnt(10) lgkmcnt(0)
    s_barrier
    v_mfma_f32_16x16x32_bf16 v[192:195], a[32:35], a[144:147], v[192:195]
    ds_read_b64_tr_b16 a[0:1], v42 offset:49152
    ds_read_b64_tr_b16 a[2:3], v42 offset:50176
    v_mfma_f32_16x16x32_bf16 v[196:199], a[32:35], a[148:151], v[196:199]
    s_add_u32 m0, s60, 98304
    v_mfma_f32_16x16x32_bf16 a[64:67], a[32:35], a[152:155], a[64:67]
    buffer_load_dwordx4 v38, s[12:15], s61 offen offset:0 lds
    ds_read_b64_tr_b16 a[4:5], v43 offset:49152
    v_mfma_f32_16x16x32_bf16 a[68:71], a[32:35], a[156:159], a[68:71]
    ds_read_b64_tr_b16 a[6:7], v43 offset:50176
    v_mfma_f32_16x16x32_bf16 v[200:203], a[36:39], a[144:147], v[200:203]
    buffer_load_dwordx4 v39, s[12:15], s61 offen offset:1024 lds
    ds_read_b64_tr_b16 a[8:9], v44 offset:49152
    v_mfma_f32_16x16x32_bf16 v[204:207], a[36:39], a[148:151], v[204:207]
    v_mfma_f32_16x16x32_bf16 a[72:75], a[36:39], a[152:155], a[72:75]
    ds_read_b64_tr_b16 a[10:11], v44 offset:50176
    v_mfma_f32_16x16x32_bf16 a[76:79], a[36:39], a[156:159], a[76:79]
    buffer_load_dwordx4 v40, s[12:15], s61 offen offset:2048 lds
    ds_read_b64_tr_b16 a[12:13], v45 offset:49152
    v_mfma_f32_16x16x32_bf16 v[208:211], a[40:43], a[144:147], v[208:211]
    v_mfma_f32_16x16x32_bf16 v[212:215], a[40:43], a[148:151], v[212:215]
    ds_read_b64_tr_b16 a[14:15], v45 offset:50176
    v_mfma_f32_16x16x32_bf16 a[80:83], a[40:43], a[152:155], a[80:83]
    buffer_load_dwordx4 v41, s[12:15], s61 offen offset:3072 lds
    ds_read_b64_tr_b16 a[16:17], v46 offset:49152
    v_mfma_f32_16x16x32_bf16 a[84:87], a[40:43], a[156:159], a[84:87]
    ds_read_b64_tr_b16 a[18:19], v46 offset:50176
    v_mfma_f32_16x16x32_bf16 v[216:219], a[44:47], a[144:147], v[216:219]
    s_add_u32 s61, s61, 0x80000
    v_mfma_f32_16x16x32_bf16 v[220:223], a[44:47], a[148:151], v[220:223]
    buffer_load_dwordx4 a[192:195], v36, s[8:11], s62 offen sc1
    ds_read_b64_tr_b16 a[20:21], v47 offset:49152
    v_mfma_f32_16x16x32_bf16 a[88:91], a[44:47], a[152:155], a[88:91]
    ds_read_b64_tr_b16 a[22:23], v47 offset:50176
    v_mfma_f32_16x16x32_bf16 a[92:95], a[44:47], a[156:159], a[92:95]
    buffer_load_dwordx4 a[196:199], v54, s[8:11], s62 offen sc1
    ds_read_b64_tr_b16 a[24:25], v48 offset:49152
    v_mfma_f32_16x16x32_bf16 v[224:227], a[48:51], a[144:147], v[224:227]
    v_mfma_f32_16x16x32_bf16 v[228:231], a[48:51], a[148:151], v[228:231]
    ds_read_b64_tr_b16 a[26:27], v48 offset:50176
    v_mfma_f32_16x16x32_bf16 a[96:99], a[48:51], a[152:155], a[96:99]
    buffer_load_dwordx4 a[200:203], v37, s[8:11], s62 offen sc1
    ds_read_b64_tr_b16 a[28:29], v49 offset:49152
    v_mfma_f32_16x16x32_bf16 a[100:103], a[48:51], a[156:159], a[100:103]
    v_mfma_f32_16x16x32_bf16 v[232:235], a[52:55], a[144:147], v[232:235]
    ds_read_b64_tr_b16 a[30:31], v49 offset:50176
    v_mfma_f32_16x16x32_bf16 v[236:239], a[52:55], a[148:151], v[236:239]
    buffer_load_dwordx4 a[204:207], v55, s[8:11], s62 offen sc1
    v_mfma_f32_16x16x32_bf16 a[104:107], a[52:55], a[152:155], a[104:107]
    v_mfma_f32_16x16x32_bf16 a[108:111], a[52:55], a[156:159], a[108:111]
    s_add_u32 s62, s62, 0x20000
    v_mfma_f32_16x16x32_bf16 v[240:243], a[56:59], a[144:147], v[240:243]
    s_add_u32 s52, s47, 12288
    v_mfma_f32_16x16x32_bf16 v[244:247], a[56:59], a[148:151], v[244:247]
    buffer_store_dwordx4 v[124:127], v1, s[48:51], s52 offen offset:3072 sc1
    v_mfma_f32_16x16x32_bf16 a[112:115], a[56:59], a[152:155], a[112:115]
    v_mfma_f32_16x16x32_bf16 a[116:119], a[56:59], a[156:159], a[116:119]
    v_mfma_f32_16x16x32_bf16 v[248:251], a[60:63], a[144:147], v[248:251]
    s_cmp_eq_u32 s45, 0
    s_cbranch_scc1 k12_ool_52
k12_oolret_53:
    v_mfma_f32_16x16x32_bf16 v[252:255], a[60:63], a[148:151], v[252:255]
    v_mfma_f32_16x16x32_bf16 a[120:123], a[60:63], a[152:155], a[120:123]
    v_mfma_f32_16x16x32_bf16 a[124:127], a[60:63], a[156:159], a[124:127]
    s_waitcnt vmcnt(15) lgkmcnt(0)
    v_mfma_f32_16x16x32_bf16 v[192:195], a[0:3], a[160:163], v[192:195]
    ds_read_b64_tr_b16 a[32:33], v42 offset:57344
    ds_read_b64_tr_b16 a[34:35], v42 offset:58368
    v_mfma_f32_16x16x32_bf16 v[196:199], a[0:3], a[164:167], v[196:199]
    buffer_load_dwordx4 a[208:211], v36, s[8:11], s62 offen sc1
    v_mfma_f32_16x16x32_bf16 a[64:67], a[0:3], a[168:171], a[64:67]
    ds_read_b64_tr_b16 a[36:37], v43 offset:57344
    v_mfma_f32_16x16x32_bf16 a[68:71], a[0:3], a[172:175], a[68:71]
    ds_read_b64_tr_b16 a[38:39], v43 offset:58368
    v_mfma_f32_16x16x32_bf16 v[200:203], a[4:7], a[160:163], v[200:203]
    ds_read_b64_tr_b16 a[40:41], v44 offset:57344
    v_mfma_f32_16x16x32_bf16 v[204:207], a[4:7], a[164:167], v[204:207]
    v_mfma_f32_16x16x32_bf16 a[72:75], a[4:7], a[168:171], a[72:75]
    buffer_load_dwordx4 a[212:215], v54, s[8:11], s62 offen sc1
    ds_read_b64_tr_b16 a[42:43], v44 offset:58368
    v_mfma_f32_16x16x32_bf16 a[76:79], a[4:7], a[172:175], a[76:79]
    ds_read_b64_tr_b16 a[44:45], v45 offset:57344
    v_mfma_f32_16x16x32_bf16 v[208:211], a[8:11], a[160:163], v[208:211]
    v_mfma_f32_16x16x32_bf16 v[212:215], a[8:11], a[164:167], v[212:215]
    ds_read_b64_tr_b16 a[46:47], v45 offset:58368
    v_mfma_f32_16x16x32_bf16 a[80:83], a[8:11], a[168:171], a[80:83]
    ds_read_b64_tr_b16 a[48:49], v46 offset:57344
    v_mfma_f32_16x16x32_bf16 a[84:87], a[8:11], a[172:175], a[84:87]
    buffer_load_dwordx4 a[216:219], v37, s[8:11], s62 offen sc1
    ds_read_b64_tr_b16 a[50:51], v46 offset:58368
    v_mfma_f32_16x16x32_bf16 v[216:219], a[12:15], a[160:163], v[216:219]
    v_mfma_f32_16x16x32_bf16 v[220:223], a[12:15], a[164:167], v[220:223]
    ds_read_b64_tr_b16 a[52:53], v47 offset:57344
    v_mfma_f32_16x16x32_bf16 a[88:91], a[12:15], a[168:171], a[88:91]
    ds_read_b64_tr_b16 a[54:55], v47 offset:58368
    v_mfma_f32_16x16x32_bf16 a[92:95], a[12:15], a[172:175], a[92:95]
    ds_read_b64_tr_b16 a[56:57], v48 offset:57344
    v_mfma_f32_16x16x32_bf16 v[224:227], a[16:19], a[160:163], v[224:227]
    v_mfma_f32_16x16x32_bf16 v[228:231], a[16:19], a[164:167], v[228:231]
    buffer_load_dwordx4 a[220:223], v55, s[8:11], s62 offen sc1
    ds_read_b64_tr_b16 a[58:59], v48 offset:58368
    v_mfma_f32_16x16x32_bf16 a[96:99], a[16:19], a[168:171], a[96:99]
    ds_read_b64_tr_b16 a[60:61], v49 offset:57344
    v_mfma_f32_16x16x32_bf16 a[100:103], a[16:19], a[172:175], a[100:103]
    v_mfma_f32_16x16x32_bf16 v[232:235], a[20:23], a[160:163], v[232:235]
    ds_read_b64_tr_b16 a[62:63], v49 offset:58368
    v_mfma_f32_16x16x32_bf16 v[236:239], a[20:23], a[164:167], v[236:239]
    s_add_u32 s62, s62, 0x20000
    v_mfma_f32_16x16x32_bf16 a[104:107], a[20:23], a[168:171], a[104:107]
    s_add_u32 s52, s47, 524288
    v_mfma_f32_16x16x32_bf16 a[108:111], a[20:23], a[172:175], a[108:111]
    buffer_store_dwordx4 v[128:131], v1, s[48:51], s52 offen offset:0 sc1
    v_mfma_f32_16x16x32_bf16 v[240:243], a[24:27], a[160:163], v[240:243]
    v_mfma_f32_16x16x32_bf16 v[244:247], a[24:27], a[164:167], v[244:247]
    v_mfma_f32_16x16x32_bf16 a[112:115], a[24:27], a[168:171], a[112:115]
    v_mfma_f32_16x16x32_bf16 a[116:119], a[24:27], a[172:175], a[116:119]
    v_mfma_f32_16x16x32_bf16 v[248:251], a[28:31], a[160:163], v[248:251]
    v_mfma_f32_16x16x32_bf16 v[252:255], a[28:31], a[164:167], v[252:255]
    v_mfma_f32_16x16x32_bf16 a[120:123], a[28:31], a[168:171], a[120:123]
    v_mfma_f32_16x16x32_bf16 a[124:127], a[28:31], a[172:175], a[124:127]
    s_waitcnt vmcnt(10) lgkmcnt(0)
    s_barrier
    v_mfma_f32_16x16x32_bf16 v[192:195], a[32:35], a[176:179], v[192:195]
    ds_read_b64_tr_b16 a[0:1], v42 offset:0
    ds_read_b64_tr_b16 a[2:3], v42 offset:1024
    v_mfma_f32_16x16x32_bf16 v[196:199], a[32:35], a[180:183], v[196:199]
    s_add_u32 m0, s60, 114688
    v_mfma_f32_16x16x32_bf16 a[64:67], a[32:35], a[184:187], a[64:67]
    buffer_load_dwordx4 v38, s[12:15], s61 offen offset:0 lds
    ds_read_b64_tr_b16 a[4:5], v43 offset:0
    v_mfma_f32_16x16x32_bf16 a[68:71], a[32:35], a[188:191], a[68:71]
    ds_read_b64_tr_b16 a[6:7], v43 offset:1024
    v_mfma_f32_16x16x32_bf16 v[200:203], a[36:39], a[176:179], v[200:203]
    buffer_load_dwordx4 v39, s[12:15], s61 offen offset:1024 lds
    ds_read_b64_tr_b16 a[8:9], v44 offset:0
    v_mfma_f32_16x16x32_bf16 v[204:207], a[36:39], a[180:183], v[204:207]
    v_mfma_f32_16x16x32_bf16 a[72:75], a[36:39], a[184:187], a[72:75]
    ds_read_b64_tr_b16 a[10:11], v44 offset:1024
    v_mfma_f32_16x16x32_bf16 a[76:79], a[36:39], a[188:191], a[76:79]
    buffer_load_dwordx4 v40, s[12:15], s61 offen offset:2048 lds
    ds_read_b64_tr_b16 a[12:13], v45 offset:0
    v_mfma_f32_16x16x32_bf16 v[208:211], a[40:43], a[176:179], v[208:211]
    v_mfma_f32_16x16x32_bf16 v[212:215], a[40:43], a[180:183], v[212:215]
    ds_read_b64_tr_b16 a[14:15], v45 offset:1024
    v_mfma_f32_16x16x32_bf16 a[80:83], a[40:43], a[184:187], a[80:83]
    buffer_load_dwordx4 v41, s[12:15], s61 offen offset:3072 lds
    ds_read_b64_tr_b16 a[16:17], v46 offset:0
    v_mfma_f32_16x16x32_bf16 a[84:87], a[40:43], a[188:191], a[84:87]
    ds_read_b64_tr_b16 a[18:19], v46 offset:1024
    v_mfma_f32_16x16x32_bf16 v[216:219], a[44:47], a[176:179], v[216:219]
    s_add_u32 s61, s61, 0x80000
    v_mfma_f32_16x16x32_bf16 v[220:223], a[44:47], a[180:183], v[220:223]
    buffer_load_dwordx4 a[224:227], v36, s[8:11], s62 offen sc1
    ds_read_b64_tr_b16 a[20:21], v47 offset:0
    v_mfma_f32_16x16x32_bf16 a[88:91], a[44:47], a[184:187], a[88:91]
    ds_read_b64_tr_b16 a[22:23], v47 offset:1024
    v_mfma_f32_16x16x32_bf16 a[92:95], a[44:47], a[188:191], a[92:95]
    buffer_load_dwordx4 a[228:231], v54, s[8:11], s62 offen sc1
    ds_read_b64_tr_b16 a[24:25], v48 offset:0
    v_mfma_f32_16x16x32_bf16 v[224:227], a[48:51], a[176:179], v[224:227]
    v_mfma_f32_16x16x32_bf16 v[228:231], a[48:51], a[180:183], v[228:231]
    ds_read_b64_tr_b16 a[26:27], v48 offset:1024
    v_mfma_f32_16x16x32_bf16 a[96:99], a[48:51], a[184:187], a[96:99]
    buffer_load_dwordx4 a[232:235], v37, s[8:11], s62 offen sc1
    ds_read_b64_tr_b16 a[28:29], v49 offset:0
    v_mfma_f32_16x16x32_bf16 a[100:103], a[48:51], a[188:191], a[100:103]
    v_mfma_f32_16x16x32_bf16 v[232:235], a[52:55], a[176:179], v[232:235]
    ds_read_b64_tr_b16 a[30:31], v49 offset:1024
    v_mfma_f32_16x16x32_bf16 v[236:239], a[52:55], a[180:183], v[236:239]
    buffer_load_dwordx4 a[236:239], v55, s[8:11], s62 offen sc1
    v_mfma_f32_16x16x32_bf16 a[104:107], a[52:55], a[184:187], a[104:107]
    v_mfma_f32_16x16x32_bf16 a[108:111], a[52:55], a[188:191], a[108:111]
    s_add_u32 s62, s62, 0x20000
    v_mfma_f32_16x16x32_bf16 v[240:243], a[56:59], a[176:179], v[240:243]
    s_add_u32 s52, s47, 524288
    v_mfma_f32_16x16x32_bf16 v[244:247], a[56:59], a[180:183], v[244:247]
    buffer_store_dwordx4 v[132:135], v1, s[48:51], s52 offen offset:1024 sc1
    v_mfma_f32_16x16x32_bf16 a[112:115], a[56:59], a[184:187], a[112:115]
    v_mfma_f32_16x16x32_bf16 a[116:119], a[56:59], a[188:191], a[116:119]
    v_mfma_f32_16x16x32_bf16 v[248:251], a[60:63], a[176:179], v[248:251]
    s_cmp_eq_u32 s45, 0
    s_cbranch_scc1 k12_ool_54
k12_oolret_55:
    v_mfma_f32_16x16x32_bf16 v[252:255], a[60:63], a[180:183], v[252:255]
    v_mfma_f32_16x16x32_bf16 a[120:123], a[60:63], a[184:187], a[120:123]
    v_mfma_f32_16x16x32_bf16 a[124:127], a[60:63], a[188:191], a[124:127]
    s_waitcnt vmcnt(15) lgkmcnt(0)
    v_mfma_f32_16x16x32_bf16 v[192:195], a[0:3], a[192:195], v[192:195]
    ds_read_b64_tr_b16 a[32:33], v42 offset:8192
    ds_read_b64_tr_b16 a[34:35], v42 offset:9216
    v_mfma_f32_16x16x32_bf16 v[196:199], a[0:3], a[196:199], v[196:199]
    buffer_load_dwordx4 a[240:243], v36, s[8:11], s62 offen sc1
    v_mfma_f32_16x16x32_bf16 a[64:67], a[0:3], a[200:203], a[64:67]
    ds_read_b64_tr_b16 a[36:37], v43 offset:8192
    v_mfma_f32_16x16x32_bf16 a[68:71], a[0:3], a[204:207], a[68:71]
    ds_read_b64_tr_b16 a[38:39], v43 offset:9216
    v_mfma_f32_16x16x32_bf16 v[200:203], a[4:7], a[192:195], v[200:203]
    ds_read_b64_tr_b16 a[40:41], v44 offset:8192
    v_mfma_f32_16x16x32_bf16 v[204:207], a[4:7], a[196:199], v[204:207]
    v_mfma_f32_16x16x32_bf16 a[72:75], a[4:7], a[200:203], a[72:75]
    buffer_load_dwordx4 a[244:247], v54, s[8:11], s62 offen sc1
    ds_read_b64_tr_b16 a[42:43], v44 offset:9216
    v_mfma_f32_16x16x32_bf16 a[76:79], a[4:7], a[204:207], a[76:79]
    ds_read_b64_tr_b16 a[44:45], v45 offset:8192
    v_mfma_f32_16x16x32_bf16 v[208:211], a[8:11], a[192:195], v[208:211]
    v_mfma_f32_16x16x32_bf16 v[212:215], a[8:11], a[196:199], v[212:215]
    ds_read_b64_tr_b16 a[46:47], v45 offset:9216
    v_mfma_f32_16x16x32_bf16 a[80:83], a[8:11], a[200:203], a[80:83]
    ds_read_b64_tr_b16 a[48:49], v46 offset:8192
    v_mfma_f32_16x16x32_bf16 a[84:87], a[8:11], a[204:207], a[84:87]
    buffer_load_dwordx4 a[248:251], v37, s[8:11], s62 offen sc1
    ds_read_b64_tr_b16 a[50:51], v46 offset:9216
    v_mfma_f32_16x16x32_bf16 v[216:219], a[12:15], a[192:195], v[216:219]
    v_mfma_f32_16x16x32_bf16 v[220:223], a[12:15], a[196:199], v[220:223]
    ds_read_b64_tr_b16 a[52:53], v47 offset:8192
    v_mfma_f32_16x16x32_bf16 a[88:91], a[12:15], a[200:203], a[88:91]
    ds_read_b64_tr_b16 a[54:55], v47 offset:9216
    v_mfma_f32_16x16x32_bf16 a[92:95], a[12:15], a[204:207], a[92:95]
    ds_read_b64_tr_b16 a[56:57], v48 offset:8192
    v_mfma_f32_16x16x32_bf16 v[224:227], a[16:19], a[192:195], v[224:227]
    v_mfma_f32_16x16x32_bf16 v[228:231], a[16:19], a[196:199], v[228:231]
    buffer_load_dwordx4 a[252:255], v55, s[8:11], s62 offen sc1
    ds_read_b64_tr_b16 a[58:59], v48 offset:9216
    v_mfma_f32_16x16x32_bf16 a[96:99], a[16:19], a[200:203], a[96:99]
    ds_read_b64_tr_b16 a[60:61], v49 offset:8192
    v_mfma_f32_16x16x32_bf16 a[100:103], a[16:19], a[204:207], a[100:103]
    v_mfma_f32_16x16x32_bf16 v[232:235], a[20:23], a[192:195], v[232:235]
    ds_read_b64_tr_b16 a[62:63], v49 offset:9216
    v_mfma_f32_16x16x32_bf16 v[236:239], a[20:23], a[196:199], v[236:239]
    s_add_u32 s62, s62, 0x20000
    v_mfma_f32_16x16x32_bf16 a[104:107], a[20:23], a[200:203], a[104:107]
    s_add_u32 s52, s47, 524288
    v_mfma_f32_16x16x32_bf16 a[108:111], a[20:23], a[204:207], a[108:111]
    buffer_store_dwordx4 v[136:139], v1, s[48:51], s52 offen offset:2048 sc1
    v_mfma_f32_16x16x32_bf16 v[240:243], a[24:27], a[192:195], v[240:243]
    v_mfma_f32_16x16x32_bf16 v[244:247], a[24:27], a[196:199], v[244:247]
    v_mfma_f32_16x16x32_bf16 a[112:115], a[24:27], a[200:203], a[112:115]
    v_mfma_f32_16x16x32_bf16 a[116:119], a[24:27], a[204:207], a[116:119]
    v_mfma_f32_16x16x32_bf16 v[248:251], a[28:31], a[192:195], v[248:251]
    v_mfma_f32_16x16x32_bf16 v[252:255], a[28:31], a[196:199], v[252:255]
    v_mfma_f32_16x16x32_bf16 a[120:123], a[28:31], a[200:203], a[120:123]
    v_mfma_f32_16x16x32_bf16 a[124:127], a[28:31], a[204:207], a[124:127]
    s_waitcnt vmcnt(10) lgkmcnt(0)
    s_barrier
    v_mfma_f32_16x16x32_bf16 v[192:195], a[32:35], a[208:211], v[192:195]
    ds_read_b64_tr_b16 a[0:1], v42 offset:16384
    ds_read_b64_tr_b16 a[2:3], v42 offset:17408
    v_mfma_f32_16x16x32_bf16 v[196:199], a[32:35], a[212:215], v[196:199]
    s_add_u32 m0, s60, 131072
    v_mfma_f32_16x16x32_bf16 a[64:67], a[32:35], a[216:219], a[64:67]
    buffer_load_dwordx4 v38, s[12:15], s61 offen offset:0 lds
    ds_read_b64_tr_b16 a[4:5], v43 offset:16384
    v_mfma_f32_16x16x32_bf16 a[68:71], a[32:35], a[220:223], a[68:71]
    ds_read_b64_tr_b16 a[6:7], v43 offset:17408
    v_mfma_f32_16x16x32_bf16 v[200:203], a[36:39], a[208:211], v[200:203]
    buffer_load_dwordx4 v39, s[12:15], s61 offen offset:1024 lds
    ds_read_b64_tr_b16 a[8:9], v44 offset:16384
    v_mfma_f32_16x16x32_bf16 v[204:207], a[36:39], a[212:215], v[204:207]
    v_mfma_f32_16x16x32_bf16 a[72:75], a[36:39], a[216:219], a[72:75]
    ds_read_b64_tr_b16 a[10:11], v44 offset:17408
    v_mfma_f32_16x16x32_bf16 a[76:79], a[36:39], a[220:223], a[76:79]
    buffer_load_dwordx4 v40, s[12:15], s61 offen offset:2048 lds
    ds_read_b64_tr_b16 a[12:13], v45 offset:16384
    v_mfma_f32_16x16x32_bf16 v[208:211], a[40:43], a[208:211], v[208:211]
    v_mfma_f32_16x16x32_bf16 v[212:215], a[40:43], a[212:215], v[212:215]
    ds_read_b64_tr_b16 a[14:15], v45 offset:17408
    v_mfma_f32_16x16x32_bf16 a[80:83], a[40:43], a[216:219], a[80:83]
    buffer_load_dwordx4 v41, s[12:15], s61 offen offset:3072 lds
    ds_read_b64_tr_b16 a[16:17], v46 offset:16384
    v_mfma_f32_16x16x32_bf16 a[84:87], a[40:43], a[220:223], a[84:87]
    ds_read_b64_tr_b16 a[18:19], v46 offset:17408
    v_mfma_f32_16x16x32_bf16 v[216:219], a[44:47], a[208:211], v[216:219]
    s_add_u32 s61, s61, 0x80000
    v_mfma_f32_16x16x32_bf16 v[220:223], a[44:47], a[212:215], v[220:223]
    buffer_load_dwordx4 a[128:131], v36, s[8:11], s62 offen sc1
    ds_read_b64_tr_b16 a[20:21], v47 offset:16384
    v_mfma_f32_16x16x32_bf16 a[88:91], a[44:47], a[216:219], a[88:91]
    ds_read_b64_tr_b16 a[22:23], v47 offset:17408
    v_mfma_f32_16x16x32_bf16 a[92:95], a[44:47], a[220:223], a[92:95]
    buffer_load_dwordx4 a[132:135], v54, s[8:11], s62 offen sc1
    ds_read_b64_tr_b16 a[24:25], v48 offset:16384
    v_mfma_f32_16x16x32_bf16 v[224:227], a[48:51], a[208:211], v[224:227]
    v_mfma_f32_16x16x32_bf16 v[228:231], a[48:51], a[212:215], v[228:231]
    ds_read_b64_tr_b16 a[26:27], v48 offset:17408
    v_mfma_f32_16x16x32_bf16 a[96:99], a[48:51], a[216:219], a[96:99]
    buffer_load_dwordx4 a[136:139], v37, s[8:11], s62 offen sc1
    ds_read_b64_tr_b16 a[28:29], v49 offset:16384
    v_mfma_f32_16x16x32_bf16 a[100:103], a[48:51], a[220:223], a[100:103]
    v_mfma_f32_16x16x32_bf16 v[232:235], a[52:55], a[208:211], v[232:235]
    ds_read_b64_tr_b16 a[30:31], v49 offset:17408
    v_mfma_f32_16x16x32_bf16 v[236:239], a[52:55], a[212:215], v[236:239]
    buffer_load_dwordx4 a[140:143], v55, s[8:11], s62 offen sc1
    v_mfma_f32_16x16x32_bf16 a[104:107], a[52:55], a[216:219], a[104:107]
    v_mfma_f32_16x16x32_bf16 a[108:111], a[52:55], a[220:223], a[108:111]
    s_add_u32 s62, s62, 0x20000
    v_mfma_f32_16x16x32_bf16 v[240:243], a[56:59], a[208:211], v[240:243]
    s_add_u32 s52, s47, 524288
    v_mfma_f32_16x16x32_bf16 v[244:247], a[56:59], a[212:215], v[244:247]
    buffer_store_dwordx4 v[140:143], v1, s[48:51], s52 offen offset:3072 sc1
    v_mfma_f32_16x16x32_bf16 a[112:115], a[56:59], a[216:219], a[112:115]
    v_mfma_f32_16x16x32_bf16 a[116:119], a[56:59], a[220:223], a[116:119]
    v_mfma_f32_16x16x32_bf16 v[248:251], a[60:63], a[208:211], v[248:251]
    s_cmp_eq_u32 s45, 0
    s_cbranch_scc1 k12_ool_56
k12_oolret_57:
    v_mfma_f32_16x16x32_bf16 v[252:255], a[60:63], a[212:215], v[252:255]
    v_mfma_f32_16x16x32_bf16 a[120:123], a[60:63], a[216:219], a[120:123]
    v_mfma_f32_16x16x32_bf16 a[124:127], a[60:63], a[220:223], a[124:127]
    s_waitcnt vmcnt(15) lgkmcnt(0)
    v_mfma_f32_16x16x32_bf16 v[192:195], a[0:3], a[224:227], v[192:195]
    ds_read_b64_tr_b16 a[32:33], v42 offset:24576
    ds_read_b64_tr_b16 a[34:35], v42 offset:25600
    v_mfma_f32_16x16x32_bf16 v[196:199], a[0:3], a[228:231], v[196:199]
    buffer_load_dwordx4 a[144:147], v36, s[8:11], s62 offen sc1
    v_mfma_f32_16x16x32_bf16 a[64:67], a[0:3], a[232:235], a[64:67]
    ds_read_b64_tr_b16 a[36:37], v43 offset:24576
    v_mfma_f32_16x16x32_bf16 a[68:71], a[0:3], a[236:239], a[68:71]
    ds_read_b64_tr_b16 a[38:39], v43 offset:25600
    v_mfma_f32_16x16x32_bf16 v[200:203], a[4:7], a[224:227], v[200:203]
    ds_read_b64_tr_b16 a[40:41], v44 offset:24576
    v_mfma_f32_16x16x32_bf16 v[204:207], a[4:7], a[228:231], v[204:207]
    v_mfma_f32_16x16x32_bf16 a[72:75], a[4:7], a[232:235], a[72:75]
    buffer_load_dwordx4 a[148:151], v54, s[8:11], s62 offen sc1
    ds_read_b64_tr_b16 a[42:43], v44 offset:25600
    v_mfma_f32_16x16x32_bf16 a[76:79], a[4:7], a[236:239], a[76:79]
    ds_read_b64_tr_b16 a[44:45], v45 offset:24576
    v_mfma_f32_16x16x32_bf16 v[208:211], a[8:11], a[224:227], v[208:211]
    v_mfma_f32_16x16x32_bf16 v[212:215], a[8:11], a[228:231], v[212:215]
    ds_read_b64_tr_b16 a[46:47], v45 offset:25600
    v_mfma_f32_16x16x32_bf16 a[80:83], a[8:11], a[232:235], a[80:83]
    ds_read_b64_tr_b16 a[48:49], v46 offset:24576
    v_mfma_f32_16x16x32_bf16 a[84:87], a[8:11], a[236:239], a[84:87]
    buffer_load_dwordx4 a[152:155], v37, s[8:11], s62 offen sc1
    ds_read_b64_tr_b16 a[50:51], v46 offset:25600
    v_mfma_f32_16x16x32_bf16 v[216:219], a[12:15], a[224:227], v[216:219]
    v_mfma_f32_16x16x32_bf16 v[220:223], a[12:15], a[228:231], v[220:223]
    ds_read_b64_tr_b16 a[52:53], v47 offset:24576
    v_mfma_f32_16x16x32_bf16 a[88:91], a[12:15], a[232:235], a[88:91]
    ds_read_b64_tr_b16 a[54:55], v47 offset:25600
    v_mfma_f32_16x16x32_bf16 a[92:95], a[12:15], a[236:239], a[92:95]
    ds_read_b64_tr_b16 a[56:57], v48 offset:24576
    v_mfma_f32_16x16x32_bf16 v[224:227], a[16:19], a[224:227], v[224:227]
    v_mfma_f32_16x16x32_bf16 v[228:231], a[16:19], a[228:231], v[228:231]
    buffer_load_dwordx4 a[156:159], v55, s[8:11], s62 offen sc1
    ds_read_b64_tr_b16 a[58:59], v48 offset:25600
    v_mfma_f32_16x16x32_bf16 a[96:99], a[16:19], a[232:235], a[96:99]
    ds_read_b64_tr_b16 a[60:61], v49 offset:24576
    v_mfma_f32_16x16x32_bf16 a[100:103], a[16:19], a[236:239], a[100:103]
    v_mfma_f32_16x16x32_bf16 v[232:235], a[20:23], a[224:227], v[232:235]
    ds_read_b64_tr_b16 a[62:63], v49 offset:25600
    v_mfma_f32_16x16x32_bf16 v[236:239], a[20:23], a[228:231], v[236:239]
    s_add_u32 s62, s62, 0x20000
    v_mfma_f32_16x16x32_bf16 a[104:107], a[20:23], a[232:235], a[104:107]
    s_add_u32 s52, s47, 528384
    v_mfma_f32_16x16x32_bf16 a[108:111], a[20:23], a[236:239], a[108:111]
    buffer_store_dwordx4 v[144:147], v1, s[48:51], s52 offen offset:0 sc1
    v_mfma_f32_16x16x32_bf16 v[240:243], a[24:27], a[224:227], v[240:243]
    v_mfma_f32_16x16x32_bf16 v[244:247], a[24:27], a[228:231], v[244:247]
    v_mfma_f32_16x16x32_bf16 a[112:115], a[24:27], a[232:235], a[112:115]
    v_mfma_f32_16x16x32_bf16 a[116:119], a[24:27], a[236:239], a[116:119]
    v_mfma_f32_16x16x32_bf16 v[248:251], a[28:31], a[224:227], v[248:251]
    v_mfma_f32_16x16x32_bf16 v[252:255], a[28:31], a[228:231], v[252:255]
    v_mfma_f32_16x16x32_bf16 a[120:123], a[28:31], a[232:235], a[120:123]
    v_mfma_f32_16x16x32_bf16 a[124:127], a[28:31], a[236:239], a[124:127]
    s_waitcnt vmcnt(10) lgkmcnt(0)
    s_barrier
    v_mfma_f32_16x16x32_bf16 v[192:195], a[32:35], a[240:243], v[192:195]
    ds_read_b64_tr_b16 a[0:1], v42 offset:32768
    ds_read_b64_tr_b16 a[2:3], v42 offset:33792
    v_mfma_f32_16x16x32_bf16 v[196:199], a[32:35], a[244:247], v[196:199]
    s_add_u32 m0, s60, 147456
    v_mfma_f32_16x16x32_bf16 a[64:67], a[32:35], a[248:251], a[64:67]
    buffer_load_dwordx4 v38, s[12:15], s61 offen offset:0 lds
    ds_read_b64_tr_b16 a[4:5], v43 offset:32768
    v_mfma_f32_16x16x32_bf16 a[68:71], a[32:35], a[252:255], a[68:71]
    ds_read_b64_tr_b16 a[6:7], v43 offset:33792
    v_mfma_f32_16x16x32_bf16 v[200:203], a[36:39], a[240:243], v[200:203]
    buffer_load_dwordx4 v39, s[12:15], s61 offen offset:1024 lds
    ds_read_b64_tr_b16 a[8:9], v44 offset:32768
    v_mfma_f32_16x16x32_bf16 v[204:207], a[36:39], a[244:247], v[204:207]
    v_mfma_f32_16x16x32_bf16 a[72:75], a[36:39], a[248:251], a[72:75]
    buffer_load_dwordx4 v40, s[12:15], s61 offen offset:2048 lds
    ds_read_b64_tr_b16 a[10:11], v44 offset:33792
    v_mfma_f32_16x16x32_bf16 a[76:79], a[36:39], a[252:255], a[76:79]
    ds_read_b64_tr_b16 a[12:13], v45 offset:32768
    v_mfma_f32_16x16x32_bf16 v[208:211], a[40:43], a[240:243], v[208:211]
    v_mfma_f32_16x16x32_bf16 v[212:215], a[40:43], a[244:247], v[212:215]
    buffer_load_dwordx4 v41, s[12:15], s61 offen offset:3072 lds
    ds_read_b64_tr_b16 a[14:15], v45 offset:33792
    v_mfma_f32_16x16x32_bf16 a[80:83], a[40:43], a[248:251], a[80:83]
    s_add_u32 s61, s61, 0x80000
    ds_read_b64_tr_b16 a[16:17], v46 offset:32768
    v_mfma_f32_16x16x32_bf16 a[84:87], a[40:43], a[252:255], a[84:87]
    buffer_load_dwordx4 a[160:163], v36, s[8:11], s62 offen sc1
    ds_read_b64_tr_b16 a[18:19], v46 offset:33792
    v_mfma_f32_16x16x32_bf16 v[216:219], a[44:47], a[240:243], v[216:219]
    v_mfma_f32_16x16x32_bf16 v[220:223], a[44:47], a[244:247], v[220:223]
    ds_read_b64_tr_b16 a[20:21], v47 offset:32768
    v_mfma_f32_16x16x32_bf16 a[88:91], a[44:47], a[248:251], a[88:91]
    buffer_load_dwordx4 a[164:167], v54, s[8:11], s62 offen sc1
    ds_read_b64_tr_b16 a[22:23], v47 offset:33792
    v_mfma_f32_16x16x32_bf16 a[92:95], a[44:47], a[252:255], a[92:95]
    ds_read_b64_tr_b16 a[24:25], v48 offset:32768
    v_mfma_f32_16x16x32_bf16 v[224:227], a[48:51], a[240:243], v[224:227]
    v_mfma_f32_16x16x32_bf16 v[228:231], a[48:51], a[244:247], v[228:231]
    buffer_load_dwordx4 a[168:171], v37, s[8:11], s62 offen sc1
    ds_read_b64_tr_b16 a[26:27], v48 offset:33792
    v_mfma_f32_16x16x32_bf16 a[96:99], a[48:51], a[248:251], a[96:99]
    ds_read_b64_tr_b16 a[28:29], v49 offset:32768
    v_mfma_f32_16x16x32_bf16 a[100:103], a[48:51], a[252:255], a[100:103]
    buffer_load_dwordx4 a[172:175], v55, s[8:11], s62 offen sc1
    v_mfma_f32_16x16x32_bf16 v[232:235], a[52:55], a[240:243], v[232:235]
    ds_read_b64_tr_b16 a[30:31], v49 offset:33792
    v_mfma_f32_16x16x32_bf16 v[236:239], a[52:55], a[244:247], v[236:239]
    s_add_u32 s62, s62, 0x20000
    v_mfma_f32_16x16x32_bf16 a[104:107], a[52:55], a[248:251], a[104:107]
    s_add_u32 s52, s47, 528384
    v_mfma_f32_16x16x32_bf16 a[108:111], a[52:55], a[252:255], a[108:111]
    buffer_store_dwordx4 v[148:151], v1, s[48:51], s52 offen offset:1024 sc1
    v_mfma_f32_16x16x32_bf16 v[240:243], a[56:59], a[240:243], v[240:243]
    s_add_u32 s52, s47, 528384
    v_mfma_f32_16x16x32_bf16 v[244:247], a[56:59], a[244:247], v[244:247]
    buffer_store_dwordx4 v[152:155], v1, s[48:51], s52 offen offset:2048 sc1
    v_mfma_f32_16x16x32_bf16 a[112:115], a[56:59], a[248:251], a[112:115]
    v_mfma_f32_16x16x32_bf16 a[116:119], a[56:59], a[252:255], a[116:119]
    v_mfma_f32_16x16x32_bf16 v[248:251], a[60:63], a[240:243], v[248:251]
    s_cmp_eq_u32 s45, 0
    s_cbranch_scc1 k12_ool_58
k12_oolret_59:
    v_mfma_f32_16x16x32_bf16 v[252:255], a[60:63], a[244:247], v[252:255]
    v_mfma_f32_16x16x32_bf16 a[120:123], a[60:63], a[248:251], a[120:123]
    v_mfma_f32_16x16x32_bf16 a[124:127], a[60:63], a[252:255], a[124:127]
    s_waitcnt vmcnt(16) lgkmcnt(0)
    v_mfma_f32_16x16x32_bf16 v[192:195], a[0:3], a[128:131], v[192:195]
    ds_read_b64_tr_b16 a[32:33], v42 offset:40960
    ds_read_b64_tr_b16 a[34:35], v42 offset:41984
    v_mfma_f32_16x16x32_bf16 v[196:199], a[0:3], a[132:135], v[196:199]
    buffer_load_dwordx4 a[176:179], v36, s[8:11], s62 offen sc1
    v_mfma_f32_16x16x32_bf16 a[64:67], a[0:3], a[136:139], a[64:67]
    ds_read_b64_tr_b16 a[36:37], v43 offset:40960
    v_mfma_f32_16x16x32_bf16 a[68:71], a[0:3], a[140:143], a[68:71]
    ds_read_b64_tr_b16 a[38:39], v43 offset:41984
    v_mfma_f32_16x16x32_bf16 v[200:203], a[4:7], a[128:131], v[200:203]
    ds_read_b64_tr_b16 a[40:41], v44 offset:40960
    v_mfma_f32_16x16x32_bf16 v[204:207], a[4:7], a[132:135], v[204:207]
    v_mfma_f32_16x16x32_bf16 a[72:75], a[4:7], a[136:139], a[72:75]
    buffer_load_dwordx4 a[180:183], v54, s[8:11], s62 offen sc1
    ds_read_b64_tr_b16 a[42:43], v44 offset:41984
    v_mfma_f32_16x16x32_bf16 a[76:79], a[4:7], a[140:143], a[76:79]
    ds_read_b64_tr_b16 a[44:45], v45 offset:40960
    v_mfma_f32_16x16x32_bf16 v[208:211], a[8:11], a[128:131], v[208:211]
    v_mfma_f32_16x16x32_bf16 v[212:215], a[8:11], a[132:135], v[212:215]
    ds_read_b64_tr_b16 a[46:47], v45 offset:41984
    v_mfma_f32_16x16x32_bf16 a[80:83], a[8:11], a[136:139], a[80:83]
    ds_read_b64_tr_b16 a[48:49], v46 offset:40960
    v_mfma_f32_16x16x32_bf16 a[84:87], a[8:11], a[140:143], a[84:87]
    buffer_load_dwordx4 a[184:187], v37, s[8:11], s62 offen sc1
    ds_read_b64_tr_b16 a[50:51], v46 offset:41984
    v_mfma_f32_16x16x32_bf16 v[216:219], a[12:15], a[128:131], v[216:219]
    v_mfma_f32_16x16x32_bf16 v[220:223], a[12:15], a[132:135], v[220:223]
    ds_read_b64_tr_b16 a[52:53], v47 offset:40960
    v_mfma_f32_16x16x32_bf16 a[88:91], a[12:15], a[136:139], a[88:91]
    ds_read_b64_tr_b16 a[54:55], v47 offset:41984
    v_mfma_f32_16x16x32_bf16 a[92:95], a[12:15], a[140:143], a[92:95]
    ds_read_b64_tr_b16 a[56:57], v48 offset:40960
    v_mfma_f32_16x16x32_bf16 v[224:227], a[16:19], a[128:131], v[224:227]
    v_mfma_f32_16x16x32_bf16 v[228:231], a[16:19], a[132:135], v[228:231]
    buffer_load_dwordx4 a[188:191], v55, s[8:11], s62 offen sc1
    ds_read_b64_tr_b16 a[58:59], v48 offset:41984
    v_mfma_f32_16x16x32_bf16 a[96:99], a[16:19], a[136:139], a[96:99]
    ds_read_b64_tr_b16 a[60:61], v49 offset:40960
    v_mfma_f32_16x16x32_bf16 a[100:103], a[16:19], a[140:143], a[100:103]
    v_mfma_f32_16x16x32_bf16 v[232:235], a[20:23], a[128:131], v[232:235]
    ds_read_b64_tr_b16 a[62:63], v49 offset:41984
    v_mfma_f32_16x16x32_bf16 v[236:239], a[20:23], a[132:135], v[236:239]
    s_add_u32 s62, s62, 0x20000
    v_mfma_f32_16x16x32_bf16 a[104:107], a[20:23], a[136:139], a[104:107]
    s_add_u32 s52, s47, 528384
    v_mfma_f32_16x16x32_bf16 a[108:111], a[20:23], a[140:143], a[108:111]
    buffer_store_dwordx4 v[156:159], v1, s[48:51], s52 offen offset:3072 sc1
    v_mfma_f32_16x16x32_bf16 v[240:243], a[24:27], a[128:131], v[240:243]
    v_mfma_f32_16x16x32_bf16 v[244:247], a[24:27], a[132:135], v[244:247]
    v_mfma_f32_16x16x32_bf16 a[112:115], a[24:27], a[136:139], a[112:115]
    v_mfma_f32_16x16x32_bf16 a[116:119], a[24:27], a[140:143], a[116:119]
    v_mfma_f32_16x16x32_bf16 v[248:251], a[28:31], a[128:131], v[248:251]
    v_mfma_f32_16x16x32_bf16 v[252:255], a[28:31], a[132:135], v[252:255]
    v_mfma_f32_16x16x32_bf16 a[120:123], a[28:31], a[136:139], a[120:123]
    v_mfma_f32_16x16x32_bf16 a[124:127], a[28:31], a[140:143], a[124:127]
    s_waitcnt vmcnt(11) lgkmcnt(0)
    s_barrier
    v_mfma_f32_16x16x32_bf16 v[192:195], a[32:35], a[144:147], v[192:195]
    ds_read_b64_tr_b16 a[0:1], v42 offset:49152
    ds_read_b64_tr_b16 a[2:3], v42 offset:50176
    v_mfma_f32_16x16x32_bf16 v[196:199], a[32:35], a[148:151], v[196:199]
    s_add_u32 m0, s60, 98304
    v_mfma_f32_16x16x32_bf16 a[64:67], a[32:35], a[152:155], a[64:67]
    buffer_load_dwordx4 v38, s[12:15], s61 offen offset:0 lds
    ds_read_b64_tr_b16 a[4:5], v43 offset:49152
    v_mfma_f32_16x16x32_bf16 a[68:71], a[32:35], a[156:159], a[68:71]
    ds_read_b64_tr_b16 a[6:7], v43 offset:50176
    v_mfma_f32_16x16x32_bf16 v[200:203], a[36:39], a[144:147], v[200:203]
    buffer_load_dwordx4 v39, s[12:15], s61 offen offset:1024 lds
    ds_read_b64_tr_b16 a[8:9], v44 offset:49152
    v_mfma_f32_16x16x32_bf16 v[204:207], a[36:39], a[148:151], v[204:207]
    v_mfma_f32_16x16x32_bf16 a[72:75], a[36:39], a[152:155], a[72:75]
    ds_read_b64_tr_b16 a[10:11], v44 offset:50176
    v_mfma_f32_16x16x32_bf16 a[76:79], a[36:39], a[156:159], a[76:79]
    buffer_load_dwordx4 v40, s[12:15], s61 offen offset:2048 lds
    ds_read_b64_tr_b16 a[12:13], v45 offset:49152
    v_mfma_f32_16x16x32_bf16 v[208:211], a[40:43], a[144:147], v[208:211]
    v_mfma_f32_16x16x32_bf16 v[212:215], a[40:43], a[148:151], v[212:215]
    ds_read_b64_tr_b16 a[14:15], v45 offset:50176
    v_mfma_f32_16x16x32_bf16 a[80:83], a[40:43], a[152:155], a[80:83]
    buffer_load_dwordx4 v41, s[12:15], s61 offen offset:3072 lds
    ds_read_b64_tr_b16 a[16:17], v46 offset:49152
    v_mfma_f32_16x16x32_bf16 a[84:87], a[40:43], a[156:159], a[84:87]
    ds_read_b64_tr_b16 a[18:19], v46 offset:50176
    v_mfma_f32_16x16x32_bf16 v[216:219], a[44:47], a[144:147], v[216:219]
    s_add_u32 s61, s61, 0x80000
    v_mfma_f32_16x16x32_bf16 v[220:223], a[44:47], a[148:151], v[220:223]
    buffer_load_dwordx4 a[192:195], v36, s[8:11], s62 offen sc1
    ds_read_b64_tr_b16 a[20:21], v47 offset:49152
    v_mfma_f32_16x16x32_bf16 a[88:91], a[44:47], a[152:155], a[88:91]
    ds_read_b64_tr_b16 a[22:23], v47 offset:50176
    v_mfma_f32_16x16x32_bf16 a[92:95], a[44:47], a[156:159], a[92:95]
    buffer_load_dwordx4 a[196:199], v54, s[8:11], s62 offen sc1
    ds_read_b64_tr_b16 a[24:25], v48 offset:49152
    v_mfma_f32_16x16x32_bf16 v[224:227], a[48:51], a[144:147], v[224:227]
    v_mfma_f32_16x16x32_bf16 v[228:231], a[48:51], a[148:151], v[228:231]
    ds_read_b64_tr_b16 a[26:27], v48 offset:50176
    v_mfma_f32_16x16x32_bf16 a[96:99], a[48:51], a[152:155], a[96:99]
    buffer_load_dwordx4 a[200:203], v37, s[8:11], s62 offen sc1
    ds_read_b64_tr_b16 a[28:29], v49 offset:49152
    v_mfma_f32_16x16x32_bf16 a[100:103], a[48:51], a[156:159], a[100:103]
    v_mfma_f32_16x16x32_bf16 v[232:235], a[52:55], a[144:147], v[232:235]
    ds_read_b64_tr_b16 a[30:31], v49 offset:50176
    v_mfma_f32_16x16x32_bf16 v[236:239], a[52:55], a[148:151], v[236:239]
    buffer_load_dwordx4 a[204:207], v55, s[8:11], s62 offen sc1
    v_mfma_f32_16x16x32_bf16 a[104:107], a[52:55], a[152:155], a[104:107]
    v_mfma_f32_16x16x32_bf16 a[108:111], a[52:55], a[156:159], a[108:111]
    s_add_u32 s62, s62, 0x20000
    v_mfma_f32_16x16x32_bf16 v[240:243], a[56:59], a[144:147], v[240:243]
    s_add_u32 s52, s47, 532480
    v_mfma_f32_16x16x32_bf16 v[244:247], a[56:59], a[148:151], v[244:247]
    buffer_store_dwordx4 v[160:163], v1, s[48:51], s52 offen offset:0 sc1
    v_mfma_f32_16x16x32_bf16 a[112:115], a[56:59], a[152:155], a[112:115]
    v_mfma_f32_16x16x32_bf16 a[116:119], a[56:59], a[156:159], a[116:119]
    v_mfma_f32_16x16x32_bf16 v[248:251], a[60:63], a[144:147], v[248:251]
    v_mfma_f32_16x16x32_bf16 v[252:255], a[60:63], a[148:151], v[252:255]
    v_mfma_f32_16x16x32_bf16 a[120:123], a[60:63], a[152:155], a[120:123]
    v_mfma_f32_16x16x32_bf16 a[124:127], a[60:63], a[156:159], a[124:127]
    s_waitcnt vmcnt(16) lgkmcnt(0)
    v_mfma_f32_16x16x32_bf16 v[192:195], a[0:3], a[160:163], v[192:195]
    ds_read_b64_tr_b16 a[32:33], v42 offset:57344
    ds_read_b64_tr_b16 a[34:35], v42 offset:58368
    v_mfma_f32_16x16x32_bf16 v[196:199], a[0:3], a[164:167], v[196:199]
    buffer_load_dwordx4 a[208:211], v36, s[8:11], s62 offen sc1
    v_mfma_f32_16x16x32_bf16 a[64:67], a[0:3], a[168:171], a[64:67]
    ds_read_b64_tr_b16 a[36:37], v43 offset:57344
    v_mfma_f32_16x16x32_bf16 a[68:71], a[0:3], a[172:175], a[68:71]
    ds_read_b64_tr_b16 a[38:39], v43 offset:58368
    v_mfma_f32_16x16x32_bf16 v[200:203], a[4:7], a[160:163], v[200:203]
    ds_read_b64_tr_b16 a[40:41], v44 offset:57344
    v_mfma_f32_16x16x32_bf16 v[204:207], a[4:7], a[164:167], v[204:207]
    v_mfma_f32_16x16x32_bf16 a[72:75], a[4:7], a[168:171], a[72:75]
    buffer_load_dwordx4 a[212:215], v54, s[8:11], s62 offen sc1
    ds_read_b64_tr_b16 a[42:43], v44 offset:58368
    v_mfma_f32_16x16x32_bf16 a[76:79], a[4:7], a[172:175], a[76:79]
    ds_read_b64_tr_b16 a[44:45], v45 offset:57344
    v_mfma_f32_16x16x32_bf16 v[208:211], a[8:11], a[160:163], v[208:211]
    v_mfma_f32_16x16x32_bf16 v[212:215], a[8:11], a[164:167], v[212:215]
    ds_read_b64_tr_b16 a[46:47], v45 offset:58368
    v_mfma_f32_16x16x32_bf16 a[80:83], a[8:11], a[168:171], a[80:83]
    ds_read_b64_tr_b16 a[48:49], v46 offset:57344
    v_mfma_f32_16x16x32_bf16 a[84:87], a[8:11], a[172:175], a[84:87]
    buffer_load_dwordx4 a[216:219], v37, s[8:11], s62 offen sc1
    ds_read_b64_tr_b16 a[50:51], v46 offset:58368
    v_mfma_f32_16x16x32_bf16 v[216:219], a[12:15], a[160:163], v[216:219]
    v_mfma_f32_16x16x32_bf16 v[220:223], a[12:15], a[164:167], v[220:223]
    ds_read_b64_tr_b16 a[52:53], v47 offset:57344
    v_mfma_f32_16x16x32_bf16 a[88:91], a[12:15], a[168:171], a[88:91]
    ds_read_b64_tr_b16 a[54:55], v47 offset:58368
    v_mfma_f32_16x16x32_bf16 a[92:95], a[12:15], a[172:175], a[92:95]
    ds_read_b64_tr_b16 a[56:57], v48 offset:57344
    v_mfma_f32_16x16x32_bf16 v[224:227], a[16:19], a[160:163], v[224:227]
    v_mfma_f32_16x16x32_bf16 v[228:231], a[16:19], a[164:167], v[228:231]
    buffer_load_dwordx4 a[220:223], v55, s[8:11], s62 offen sc1
    ds_read_b64_tr_b16 a[58:59], v48 offset:58368
    v_mfma_f32_16x16x32_bf16 a[96:99], a[16:19], a[168:171], a[96:99]
    ds_read_b64_tr_b16 a[60:61], v49 offset:57344
    v_mfma_f32_16x16x32_bf16 a[100:103], a[16:19], a[172:175], a[100:103]
    v_mfma_f32_16x16x32_bf16 v[232:235], a[20:23], a[160:163], v[232:235]
    ds_read_b64_tr_b16 a[62:63], v49 offset:58368
    v_mfma_f32_16x16x32_bf16 v[236:239], a[20:23], a[164:167], v[236:239]
    s_add_u32 s62, s62, 0x20000
    v_mfma_f32_16x16x32_bf16 a[104:107], a[20:23], a[168:171], a[104:107]
    s_add_u32 s52, s47, 532480
    v_mfma_f32_16x16x32_bf16 a[108:111], a[20:23], a[172:175], a[108:111]
    buffer_store_dwordx4 v[164:167], v1, s[48:51], s52 offen offset:1024 sc1
    v_mfma_f32_16x16x32_bf16 v[240:243], a[24:27], a[160:163], v[240:243]
    v_mfma_f32_16x16x32_bf16 v[244:247], a[24:27], a[164:167], v[244:247]
    v_mfma_f32_16x16x32_bf16 a[112:115], a[24:27], a[168:171], a[112:115]
    v_mfma_f32_16x16x32_bf16 a[116:119], a[24:27], a[172:175], a[116:119]
    v_mfma_f32_16x16x32_bf16 v[248:251], a[28:31], a[160:163], v[248:251]
    v_mfma_f32_16x16x32_bf16 v[252:255], a[28:31], a[164:167], v[252:255]
    v_mfma_f32_16x16x32_bf16 a[120:123], a[28:31], a[168:171], a[120:123]
    v_mfma_f32_16x16x32_bf16 a[124:127], a[28:31], a[172:175], a[124:127]
    s_waitcnt vmcnt(10) lgkmcnt(0)
    s_barrier
    v_mfma_f32_16x16x32_bf16 v[192:195], a[32:35], a[176:179], v[192:195]
    ds_read_b64_tr_b16 a[0:1], v42 offset:0
    ds_read_b64_tr_b16 a[2:3], v42 offset:1024
    v_mfma_f32_16x16x32_bf16 v[196:199], a[32:35], a[180:183], v[196:199]
    s_cmp_eq_u32 s56, 0
    s_cbranch_scc1 k12_ool_60
k12_oolret_61:
    v_mfma_f32_16x16x32_bf16 a[64:67], a[32:35], a[184:187], a[64:67]
    s_add_u32 m0, s60, 114688
    ds_read_b64_tr_b16 a[4:5], v43 offset:0
    v_mfma_f32_16x16x32_bf16 a[68:71], a[32:35], a[188:191], a[68:71]
    buffer_load_dwordx4 v38, s[12:15], s61 offen offset:0 lds
    ds_read_b64_tr_b16 a[6:7], v43 offset:1024
    v_mfma_f32_16x16x32_bf16 v[200:203], a[36:39], a[176:179], v[200:203]
    buffer_load_dwordx4 v39, s[12:15], s61 offen offset:1024 lds
    ds_read_b64_tr_b16 a[8:9], v44 offset:0
    v_mfma_f32_16x16x32_bf16 v[204:207], a[36:39], a[180:183], v[204:207]
    v_mfma_f32_16x16x32_bf16 a[72:75], a[36:39], a[184:187], a[72:75]
    ds_read_b64_tr_b16 a[10:11], v44 offset:1024
    v_mfma_f32_16x16x32_bf16 a[76:79], a[36:39], a[188:191], a[76:79]
    buffer_load_dwordx4 v40, s[12:15], s61 offen offset:2048 lds
    ds_read_b64_tr_b16 a[12:13], v45 offset:0
    v_mfma_f32_16x16x32_bf16 v[208:211], a[40:43], a[176:179], v[208:211]
    s_mov_b32 s32, s60
    v_mfma_f32_16x16x32_bf16 v[212:215], a[40:43], a[180:183], v[212:215]
    ds_read_b64_tr_b16 a[14:15], v45 offset:1024
    v_mfma_f32_16x16x32_bf16 a[80:83], a[40:43], a[184:187], a[80:83]
    s_mov_b32 s34, s60
    buffer_load_dwordx4 v41, s[12:15], s61 offen offset:3072 lds
    ds_read_b64_tr_b16 a[16:17], v46 offset:0
    v_mfma_f32_16x16x32_bf16 a[84:87], a[40:43], a[188:191], a[84:87]
    ds_read_b64_tr_b16 a[18:19], v46 offset:1024
    v_mfma_f32_16x16x32_bf16 v[216:219], a[44:47], a[176:179], v[216:219]
    s_add_u32 s61, s61, 0x80000
    v_mfma_f32_16x16x32_bf16 v[220:223], a[44:47], a[180:183], v[220:223]
    s_mov_b32 s33, s60
    buffer_load_dwordx4 a[224:227], v36, s[8:11], s62 offen sc1
    ds_read_b64_tr_b16 a[20:21], v47 offset:0
    v_mfma_f32_16x16x32_bf16 a[88:91], a[44:47], a[184:187], a[88:91]
    ds_read_b64_tr_b16 a[22:23], v47 offset:1024
    v_mfma_f32_16x16x32_bf16 a[92:95], a[44:47], a[188:191], a[92:95]
    buffer_load_dwordx4 a[228:231], v54, s[8:11], s62 offen sc1
    ds_read_b64_tr_b16 a[24:25], v48 offset:0
    v_mfma_f32_16x16x32_bf16 v[224:227], a[48:51], a[176:179], v[224:227]
    s_add_u32 s35, s60, 0x10000
    v_mfma_f32_16x16x32_bf16 v[228:231], a[48:51], a[180:183], v[228:231]
    ds_read_b64_tr_b16 a[26:27], v48 offset:1024
    v_mfma_f32_16x16x32_bf16 a[96:99], a[48:51], a[184:187], a[96:99]
    buffer_load_dwordx4 a[232:235], v37, s[8:11], s62 offen sc1
    ds_read_b64_tr_b16 a[28:29], v49 offset:0
    v_mfma_f32_16x16x32_bf16 a[100:103], a[48:51], a[188:191], a[100:103]
    v_mfma_f32_16x16x32_bf16 v[232:235], a[52:55], a[176:179], v[232:235]
    ds_read_b64_tr_b16 a[30:31], v49 offset:1024
    v_mfma_f32_16x16x32_bf16 v[236:239], a[52:55], a[180:183], v[236:239]
    buffer_load_dwordx4 a[236:239], v55, s[8:11], s62 offen sc1
    v_mfma_f32_16x16x32_bf16 a[104:107], a[52:55], a[184:187], a[104:107]
    v_mfma_f32_16x16x32_bf16 a[108:111], a[52:55], a[188:191], a[108:111]
    s_add_u32 s62, s62, 0x20000
    v_mfma_f32_16x16x32_bf16 v[240:243], a[56:59], a[176:179], v[240:243]
    s_add_u32 s52, s47, 532480
    v_mfma_f32_16x16x32_bf16 v[244:247], a[56:59], a[180:183], v[244:247]
    buffer_store_dwordx4 v[168:171], v1, s[48:51], s52 offen offset:2048 sc1
    v_mfma_f32_16x16x32_bf16 a[112:115], a[56:59], a[184:187], a[112:115]
    v_mfma_f32_16x16x32_bf16 a[116:119], a[56:59], a[188:191], a[116:119]
    v_mfma_f32_16x16x32_bf16 v[248:251], a[60:63], a[176:179], v[248:251]
    v_mfma_f32_16x16x32_bf16 v[252:255], a[60:63], a[180:183], v[252:255]
    v_mfma_f32_16x16x32_bf16 a[120:123], a[60:63], a[184:187], a[120:123]
    v_mfma_f32_16x16x32_bf16 a[124:127], a[60:63], a[188:191], a[124:127]
    s_waitcnt vmcnt(15) lgkmcnt(0)
    v_mfma_f32_16x16x32_bf16 v[192:195], a[0:3], a[192:195], v[192:195]
    ds_read_b64_tr_b16 a[32:33], v42 offset:8192
    ds_read_b64_tr_b16 a[34:35], v42 offset:9216
    v_mfma_f32_16x16x32_bf16 v[196:199], a[0:3], a[196:199], v[196:199]
    buffer_load_dwordx4 a[240:243], v36, s[8:11], s62 offen sc1
    v_mfma_f32_16x16x32_bf16 a[64:67], a[0:3], a[200:203], a[64:67]
    ds_read_b64_tr_b16 a[36:37], v43 offset:8192
    v_mfma_f32_16x16x32_bf16 a[68:71], a[0:3], a[204:207], a[68:71]
    ds_read_b64_tr_b16 a[38:39], v43 offset:9216
    v_mfma_f32_16x16x32_bf16 v[200:203], a[4:7], a[192:195], v[200:203]
    ds_read_b64_tr_b16 a[40:41], v44 offset:8192
    v_mfma_f32_16x16x32_bf16 v[204:207], a[4:7], a[196:199], v[204:207]
    v_mfma_f32_16x16x32_bf16 a[72:75], a[4:7], a[200:203], a[72:75]
    buffer_load_dwordx4 a[244:247], v54, s[8:11], s62 offen sc1
    ds_read_b64_tr_b16 a[42:43], v44 offset:9216
    v_mfma_f32_16x16x32_bf16 a[76:79], a[4:7], a[204:207], a[76:79]
    ds_read_b64_tr_b16 a[44:45], v45 offset:8192
    v_mfma_f32_16x16x32_bf16 v[208:211], a[8:11], a[192:195], v[208:211]
    v_mfma_f32_16x16x32_bf16 v[212:215], a[8:11], a[196:199], v[212:215]
    ds_read_b64_tr_b16 a[46:47], v45 offset:9216
    v_mfma_f32_16x16x32_bf16 a[80:83], a[8:11], a[200:203], a[80:83]
    ds_read_b64_tr_b16 a[48:49], v46 offset:8192
    v_mfma_f32_16x16x32_bf16 a[84:87], a[8:11], a[204:207], a[84:87]
    buffer_load_dwordx4 a[248:251], v37, s[8:11], s62 offen sc1
    ds_read_b64_tr_b16 a[50:51], v46 offset:9216
    v_mfma_f32_16x16x32_bf16 v[216:219], a[12:15], a[192:195], v[216:219]
    v_mfma_f32_16x16x32_bf16 v[220:223], a[12:15], a[196:199], v[220:223]
    ds_read_b64_tr_b16 a[52:53], v47 offset:8192
    v_mfma_f32_16x16x32_bf16 a[88:91], a[12:15], a[200:203], a[88:91]
    ds_read_b64_tr_b16 a[54:55], v47 offset:9216
    v_mfma_f32_16x16x32_bf16 a[92:95], a[12:15], a[204:207], a[92:95]
    ds_read_b64_tr_b16 a[56:57], v48 offset:8192
    v_mfma_f32_16x16x32_bf16 v[224:227], a[16:19], a[192:195], v[224:227]
    v_mfma_f32_16x16x32_bf16 v[228:231], a[16:19], a[196:199], v[228:231]
    buffer_load_dwordx4 a[252:255], v55, s[8:11], s62 offen sc1
    ds_read_b64_tr_b16 a[58:59], v48 offset:9216
    v_mfma_f32_16x16x32_bf16 a[96:99], a[16:19], a[200:203], a[96:99]
    ds_read_b64_tr_b16 a[60:61], v49 offset:8192
    v_mfma_f32_16x16x32_bf16 a[100:103], a[16:19], a[204:207], a[100:103]
    v_mfma_f32_16x16x32_bf16 v[232:235], a[20:23], a[192:195], v[232:235]
    ds_read_b64_tr_b16 a[62:63], v49 offset:9216
    v_mfma_f32_16x16x32_bf16 v[236:239], a[20:23], a[196:199], v[236:239]
    s_add_u32 s62, s62, 0x20000
    v_mfma_f32_16x16x32_bf16 a[104:107], a[20:23], a[200:203], a[104:107]
    s_add_u32 s52, s47, 532480
    v_mfma_f32_16x16x32_bf16 a[108:111], a[20:23], a[204:207], a[108:111]
    buffer_store_dwordx4 v[172:175], v1, s[48:51], s52 offen offset:3072 sc1
    v_mfma_f32_16x16x32_bf16 v[240:243], a[24:27], a[192:195], v[240:243]
    v_mfma_f32_16x16x32_bf16 v[244:247], a[24:27], a[196:199], v[244:247]
    v_mfma_f32_16x16x32_bf16 a[112:115], a[24:27], a[200:203], a[112:115]
    v_mfma_f32_16x16x32_bf16 a[116:119], a[24:27], a[204:207], a[116:119]
    v_mfma_f32_16x16x32_bf16 v[248:251], a[28:31], a[192:195], v[248:251]
    v_add_co_u32 v2, vcc, 0x4000, v2
    s_nop 1
    v_addc_co_u32 v3, vcc, 0, v3, vcc
    global_load_dword v51, v[2:3], off
    v_mfma_f32_16x16x32_bf16 v[252:255], a[28:31], a[196:199], v[252:255]
    v_mfma_f32_16x16x32_bf16 a[120:123], a[28:31], a[200:203], a[120:123]
    v_mfma_f32_16x16x32_bf16 a[124:127], a[28:31], a[204:207], a[124:127]
    s_waitcnt vmcnt(10) lgkmcnt(0)
    s_barrier
    v_mfma_f32_16x16x32_bf16 v[192:195], a[32:35], a[208:211], v[192:195]
    ds_read_b64_tr_b16 a[0:1], v42 offset:16384
    ds_read_b64_tr_b16 a[2:3], v42 offset:17408
    v_mfma_f32_16x16x32_bf16 v[196:199], a[32:35], a[212:215], v[196:199]
    s_add_u32 m0, s60, 131072
    v_mfma_f32_16x16x32_bf16 a[64:67], a[32:35], a[216:219], a[64:67]
    buffer_load_dwordx4 v38, s[12:15], s61 offen offset:0 lds
    ds_read_b64_tr_b16 a[4:5], v43 offset:16384
    v_mfma_f32_16x16x32_bf16 a[68:71], a[32:35], a[220:223], a[68:71]
    ds_read_b64_tr_b16 a[6:7], v43 offset:17408
    v_mfma_f32_16x16x32_bf16 v[200:203], a[36:39], a[208:211], v[200:203]
    buffer_load_dwordx4 v39, s[12:15], s61 offen offset:1024 lds
    ds_read_b64_tr_b16 a[8:9], v44 offset:16384
    v_mfma_f32_16x16x32_bf16 v[204:207], a[36:39], a[212:215], v[204:207]
    v_mfma_f32_16x16x32_bf16 a[72:75], a[36:39], a[216:219], a[72:75]
    ds_read_b64_tr_b16 a[10:11], v44 offset:17408
    v_mfma_f32_16x16x32_bf16 a[76:79], a[36:39], a[220:223], a[76:79]
    buffer_load_dwordx4 v40, s[12:15], s61 offen offset:2048 lds
    ds_read_b64_tr_b16 a[12:13], v45 offset:16384
    v_mfma_f32_16x16x32_bf16 v[208:211], a[40:43], a[208:211], v[208:211]
    v_mfma_f32_16x16x32_bf16 v[212:215], a[40:43], a[212:215], v[212:215]
    ds_read_b64_tr_b16 a[14:15], v45 offset:17408
    v_mfma_f32_16x16x32_bf16 a[80:83], a[40:43], a[216:219], a[80:83]
    buffer_load_dwordx4 v41, s[12:15], s61 offen offset:3072 lds
    ds_read_b64_tr_b16 a[16:17], v46 offset:16384
    v_mfma_f32_16x16x32_bf16 a[84:87], a[40:43], a[220:223], a[84:87]
    ds_read_b64_tr_b16 a[18:19], v46 offset:17408
    v_mfma_f32_16x16x32_bf16 v[216:219], a[44:47], a[208:211], v[216:219]
    s_add_u32 s61, s61, 0x80000
    v_mfma_f32_16x16x32_bf16 v[220:223], a[44:47], a[212:215], v[220:223]
    buffer_load_dwordx4 a[128:131], v36, s[8:11], s62 offen sc1
    ds_read_b64_tr_b16 a[20:21], v47 offset:16384
    v_mfma_f32_16x16x32_bf16 a[88:91], a[44:47], a[216:219], a[88:91]
    ds_read_b64_tr_b16 a[22:23], v47 offset:17408
    v_mfma_f32_16x16x32_bf16 a[92:95], a[44:47], a[220:223], a[92:95]
    buffer_load_dwordx4 a[132:135], v54, s[8:11], s62 offen sc1
    ds_read_b64_tr_b16 a[24:25], v48 offset:16384
    v_mfma_f32_16x16x32_bf16 v[224:227], a[48:51], a[208:211], v[224:227]
    v_mfma_f32_16x16x32_bf16 v[228:231], a[48:51], a[212:215], v[228:231]
    ds_read_b64_tr_b16 a[26:27], v48 offset:17408
    v_mfma_f32_16x16x32_bf16 a[96:99], a[48:51], a[216:219], a[96:99]
    buffer_load_dwordx4 a[136:139], v37, s[8:11], s62 offen sc1
    ds_read_b64_tr_b16 a[28:29], v49 offset:16384
    v_mfma_f32_16x16x32_bf16 a[100:103], a[48:51], a[220:223], a[100:103]
    v_mfma_f32_16x16x32_bf16 v[232:235], a[52:55], a[208:211], v[232:235]
    ds_read_b64_tr_b16 a[30:31], v49 offset:17408
    v_mfma_f32_16x16x32_bf16 v[236:239], a[52:55], a[212:215], v[236:239]
    buffer_load_dwordx4 a[140:143], v55, s[8:11], s62 offen sc1
    v_mfma_f32_16x16x32_bf16 a[104:107], a[52:55], a[216:219], a[104:107]
    v_mfma_f32_16x16x32_bf16 a[108:111], a[52:55], a[220:223], a[108:111]
    s_add_u32 s62, s62, 0x20000
    v_mfma_f32_16x16x32_bf16 v[240:243], a[56:59], a[208:211], v[240:243]
    s_add_u32 s52, s47, 536576
    v_mfma_f32_16x16x32_bf16 v[244:247], a[56:59], a[212:215], v[244:247]
    buffer_store_dwordx4 v[176:179], v1, s[48:51], s52 offen offset:0 sc1
    v_mfma_f32_16x16x32_bf16 a[112:115], a[56:59], a[216:219], a[112:115]
    v_mfma_f32_16x16x32_bf16 a[116:119], a[56:59], a[220:223], a[116:119]
    v_mfma_f32_16x16x32_bf16 v[248:251], a[60:63], a[208:211], v[248:251]
    v_mfma_f32_16x16x32_bf16 v[252:255], a[60:63], a[212:215], v[252:255]
    v_mfma_f32_16x16x32_bf16 a[120:123], a[60:63], a[216:219], a[120:123]
    v_mfma_f32_16x16x32_bf16 a[124:127], a[60:63], a[220:223], a[124:127]
    s_waitcnt vmcnt(15) lgkmcnt(0)
    v_mfma_f32_16x16x32_bf16 v[192:195], a[0:3], a[224:227], v[192:195]
    ds_read_b64_tr_b16 a[32:33], v42 offset:24576
    ds_read_b64_tr_b16 a[34:35], v42 offset:25600
    v_mfma_f32_16x16x32_bf16 v[196:199], a[0:3], a[228:231], v[196:199]
    buffer_load_dwordx4 a[144:147], v36, s[8:11], s62 offen sc1
    v_mfma_f32_16x16x32_bf16 a[64:67], a[0:3], a[232:235], a[64:67]
    ds_read_b64_tr_b16 a[36:37], v43 offset:24576
    v_mfma_f32_16x16x32_bf16 a[68:71], a[0:3], a[236:239], a[68:71]
    ds_read_b64_tr_b16 a[38:39], v43 offset:25600
    v_mfma_f32_16x16x32_bf16 v[200:203], a[4:7], a[224:227], v[200:203]
    ds_read_b64_tr_b16 a[40:41], v44 offset:24576
    v_mfma_f32_16x16x32_bf16 v[204:207], a[4:7], a[228:231], v[204:207]
    v_mfma_f32_16x16x32_bf16 a[72:75], a[4:7], a[232:235], a[72:75]
    buffer_load_dwordx4 a[148:151], v54, s[8:11], s62 offen sc1
    ds_read_b64_tr_b16 a[42:43], v44 offset:25600
    v_mfma_f32_16x16x32_bf16 a[76:79], a[4:7], a[236:239], a[76:79]
    ds_read_b64_tr_b16 a[44:45], v45 offset:24576
    v_mfma_f32_16x16x32_bf16 v[208:211], a[8:11], a[224:227], v[208:211]
    v_mfma_f32_16x16x32_bf16 v[212:215], a[8:11], a[228:231], v[212:215]
    ds_read_b64_tr_b16 a[46:47], v45 offset:25600
    v_mfma_f32_16x16x32_bf16 a[80:83], a[8:11], a[232:235], a[80:83]
    ds_read_b64_tr_b16 a[48:49], v46 offset:24576
    v_mfma_f32_16x16x32_bf16 a[84:87], a[8:11], a[236:239], a[84:87]
    buffer_load_dwordx4 a[152:155], v37, s[8:11], s62 offen sc1
    ds_read_b64_tr_b16 a[50:51], v46 offset:25600
    v_mfma_f32_16x16x32_bf16 v[216:219], a[12:15], a[224:227], v[216:219]
    v_mfma_f32_16x16x32_bf16 v[220:223], a[12:15], a[228:231], v[220:223]
    ds_read_b64_tr_b16 a[52:53], v47 offset:24576
    v_mfma_f32_16x16x32_bf16 a[88:91], a[12:15], a[232:235], a[88:91]
    ds_read_b64_tr_b16 a[54:55], v47 offset:25600
    v_mfma_f32_16x16x32_bf16 a[92:95], a[12:15], a[236:239], a[92:95]
    ds_read_b64_tr_b16 a[56:57], v48 offset:24576
    v_mfma_f32_16x16x32_bf16 v[224:227], a[16:19], a[224:227], v[224:227]
    v_mfma_f32_16x16x32_bf16 v[228:231], a[16:19], a[228:231], v[228:231]
    buffer_load_dwordx4 a[156:159], v55, s[8:11], s62 offen sc1
    ds_read_b64_tr_b16 a[58:59], v48 offset:25600
    v_mfma_f32_16x16x32_bf16 a[96:99], a[16:19], a[232:235], a[96:99]
    ds_read_b64_tr_b16 a[60:61], v49 offset:24576
    v_mfma_f32_16x16x32_bf16 a[100:103], a[16:19], a[236:239], a[100:103]
    v_mfma_f32_16x16x32_bf16 v[232:235], a[20:23], a[224:227], v[232:235]
    ds_read_b64_tr_b16 a[62:63], v49 offset:25600
    v_mfma_f32_16x16x32_bf16 v[236:239], a[20:23], a[228:231], v[236:239]
    s_add_u32 s62, s62, 0x20000
    v_mfma_f32_16x16x32_bf16 a[104:107], a[20:23], a[232:235], a[104:107]
    s_add_u32 s52, s47, 536576
    v_mfma_f32_16x16x32_bf16 a[108:111], a[20:23], a[236:239], a[108:111]
    buffer_store_dwordx4 v[180:183], v1, s[48:51], s52 offen offset:1024 sc1
    v_mfma_f32_16x16x32_bf16 v[240:243], a[24:27], a[224:227], v[240:243]
    v_mfma_f32_16x16x32_bf16 v[244:247], a[24:27], a[228:231], v[244:247]
    v_mfma_f32_16x16x32_bf16 a[112:115], a[24:27], a[232:235], a[112:115]
    v_mfma_f32_16x16x32_bf16 a[116:119], a[24:27], a[236:239], a[116:119]
    v_mfma_f32_16x16x32_bf16 v[248:251], a[28:31], a[224:227], v[248:251]
    v_mfma_f32_16x16x32_bf16 v[252:255], a[28:31], a[228:231], v[252:255]
    v_mfma_f32_16x16x32_bf16 a[120:123], a[28:31], a[232:235], a[120:123]
    v_mfma_f32_16x16x32_bf16 a[124:127], a[28:31], a[236:239], a[124:127]
    s_waitcnt vmcnt(10) lgkmcnt(0)
    s_barrier
    v_mfma_f32_16x16x32_bf16 v[192:195], a[32:35], a[240:243], v[192:195]
    ds_read_b64_tr_b16 a[0:1], v42 offset:32768
    ds_read_b64_tr_b16 a[2:3], v42 offset:33792
    v_mfma_f32_16x16x32_bf16 v[196:199], a[32:35], a[244:247], v[196:199]
    s_cmp_eq_u32 s30, 0
    s_cbranch_scc1 k12_ool_62
k12_oolret_63:
    v_mfma_f32_16x16x32_bf16 a[64:67], a[32:35], a[248:251], a[64:67]
    s_add_u32 m0, s60, 147456
    ds_read_b64_tr_b16 a[4:5], v43 offset:32768
    v_mfma_f32_16x16x32_bf16 a[68:71], a[32:35], a[252:255], a[68:71]
    buffer_load_dwordx4 v38, s[12:15], s61 offen offset:0 lds
    ds_read_b64_tr_b16 a[6:7], v43 offset:33792
    v_mfma_f32_16x16x32_bf16 v[200:203], a[36:39], a[240:243], v[200:203]
    buffer_load_dwordx4 v39, s[12:15], s61 offen offset:1024 lds
    ds_read_b64_tr_b16 a[8:9], v44 offset:32768
    v_mfma_f32_16x16x32_bf16 v[204:207], a[36:39], a[244:247], v[204:207]
    v_mfma_f32_16x16x32_bf16 a[72:75], a[36:39], a[248:251], a[72:75]
    ds_read_b64_tr_b16 a[10:11], v44 offset:33792
    v_mfma_f32_16x16x32_bf16 a[76:79], a[36:39], a[252:255], a[76:79]
    buffer_load_dwordx4 v40, s[12:15], s61 offen offset:2048 lds
    ds_read_b64_tr_b16 a[12:13], v45 offset:32768
    v_mfma_f32_16x16x32_bf16 v[208:211], a[40:43], a[240:243], v[208:211]
    v_mfma_f32_16x16x32_bf16 v[212:215], a[40:43], a[244:247], v[212:215]
    ds_read_b64_tr_b16 a[14:15], v45 offset:33792
    v_mfma_f32_16x16x32_bf16 a[80:83], a[40:43], a[248:251], a[80:83]
    buffer_load_dwordx4 v41, s[12:15], s61 offen offset:3072 lds
    ds_read_b64_tr_b16 a[16:17], v46 offset:32768
    v_mfma_f32_16x16x32_bf16 a[84:87], a[40:43], a[252:255], a[84:87]
    ds_read_b64_tr_b16 a[18:19], v46 offset:33792
    v_mfma_f32_16x16x32_bf16 v[216:219], a[44:47], a[240:243], v[216:219]
    s_add_u32 s61, s61, 0x80000
    v_mfma_f32_16x16x32_bf16 v[220:223], a[44:47], a[244:247], v[220:223]
    buffer_load_dwordx4 a[160:163], v36, s[8:11], s62 offen sc1
    ds_read_b64_tr_b16 a[20:21], v47 offset:32768
    v_mfma_f32_16x16x32_bf16 a[88:91], a[44:47], a[248:251], a[88:91]
    ds_read_b64_tr_b16 a[22:23], v47 offset:33792
    v_mfma_f32_16x16x32_bf16 a[92:95], a[44:47], a[252:255], a[92:95]
    buffer_load_dwordx4 a[164:167], v54, s[8:11], s62 offen sc1
    ds_read_b64_tr_b16 a[24:25], v48 offset:32768
    v_mfma_f32_16x16x32_bf16 v[224:227], a[48:51], a[240:243], v[224:227]
    v_mfma_f32_16x16x32_bf16 v[228:231], a[48:51], a[244:247], v[228:231]
    ds_read_b64_tr_b16 a[26:27], v48 offset:33792
    v_mfma_f32_16x16x32_bf16 a[96:99], a[48:51], a[248:251], a[96:99]
    buffer_load_dwordx4 a[168:171], v37, s[8:11], s62 offen sc1
    ds_read_b64_tr_b16 a[28:29], v49 offset:32768
    v_mfma_f32_16x16x32_bf16 a[100:103], a[48:51], a[252:255], a[100:103]
    v_mfma_f32_16x16x32_bf16 v[232:235], a[52:55], a[240:243], v[232:235]
    ds_read_b64_tr_b16 a[30:31], v49 offset:33792
    v_mfma_f32_16x16x32_bf16 v[236:239], a[52:55], a[244:247], v[236:239]
    buffer_load_dwordx4 a[172:175], v55, s[8:11], s62 offen sc1
    v_mfma_f32_16x16x32_bf16 a[104:107], a[52:55], a[248:251], a[104:107]
    v_mfma_f32_16x16x32_bf16 a[108:111], a[52:55], a[252:255], a[108:111]
    s_add_u32 s62, s62, 0x20000
    v_mfma_f32_16x16x32_bf16 v[240:243], a[56:59], a[240:243], v[240:243]
    s_add_u32 s52, s47, 536576
    v_mfma_f32_16x16x32_bf16 v[244:247], a[56:59], a[244:247], v[244:247]
    buffer_store_dwordx4 v[184:187], v1, s[48:51], s52 offen offset:2048 sc1
    v_mfma_f32_16x16x32_bf16 a[112:115], a[56:59], a[248:251], a[112:115]
    v_mfma_f32_16x16x32_bf16 a[116:119], a[56:59], a[252:255], a[116:119]
    v_mfma_f32_16x16x32_bf16 v[248:251], a[60:63], a[240:243], v[248:251]
    v_mfma_f32_16x16x32_bf16 v[252:255], a[60:63], a[244:247], v[252:255]
    v_mfma_f32_16x16x32_bf16 a[120:123], a[60:63], a[248:251], a[120:123]
    v_mfma_f32_16x16x32_bf16 a[124:127], a[60:63], a[252:255], a[124:127]
    s_waitcnt vmcnt(15) lgkmcnt(0)
    v_mfma_f32_16x16x32_bf16 v[192:195], a[0:3], a[128:131], v[192:195]
    ds_read_b64_tr_b16 a[32:33], v42 offset:40960
    ds_read_b64_tr_b16 a[34:35], v42 offset:41984
    v_mfma_f32_16x16x32_bf16 v[196:199], a[0:3], a[132:135], v[196:199]
    buffer_load_dwordx4 a[176:179], v36, s[8:11], s62 offen sc1
    v_mfma_f32_16x16x32_bf16 a[64:67], a[0:3], a[136:139], a[64:67]
    ds_read_b64_tr_b16 a[36:37], v43 offset:40960
    v_mfma_f32_16x16x32_bf16 a[68:71], a[0:3], a[140:143], a[68:71]
    ds_read_b64_tr_b16 a[38:39], v43 offset:41984
    v_mfma_f32_16x16x32_bf16 v[200:203], a[4:7], a[128:131], v[200:203]
    ds_read_b64_tr_b16 a[40:41], v44 offset:40960
    v_mfma_f32_16x16x32_bf16 v[204:207], a[4:7], a[132:135], v[204:207]
    v_mfma_f32_16x16x32_bf16 a[72:75], a[4:7], a[136:139], a[72:75]
    buffer_load_dwordx4 a[180:183], v54, s[8:11], s62 offen sc1
    ds_read_b64_tr_b16 a[42:43], v44 offset:41984
    v_mfma_f32_16x16x32_bf16 a[76:79], a[4:7], a[140:143], a[76:79]
    ds_read_b64_tr_b16 a[44:45], v45 offset:40960
    v_mfma_f32_16x16x32_bf16 v[208:211], a[8:11], a[128:131], v[208:211]
    v_mfma_f32_16x16x32_bf16 v[212:215], a[8:11], a[132:135], v[212:215]
    ds_read_b64_tr_b16 a[46:47], v45 offset:41984
    v_mfma_f32_16x16x32_bf16 a[80:83], a[8:11], a[136:139], a[80:83]
    ds_read_b64_tr_b16 a[48:49], v46 offset:40960
    v_mfma_f32_16x16x32_bf16 a[84:87], a[8:11], a[140:143], a[84:87]
    buffer_load_dwordx4 a[184:187], v37, s[8:11], s62 offen sc1
    ds_read_b64_tr_b16 a[50:51], v46 offset:41984
    v_mfma_f32_16x16x32_bf16 v[216:219], a[12:15], a[128:131], v[216:219]
    v_mfma_f32_16x16x32_bf16 v[220:223], a[12:15], a[132:135], v[220:223]
    ds_read_b64_tr_b16 a[52:53], v47 offset:40960
    v_mfma_f32_16x16x32_bf16 a[88:91], a[12:15], a[136:139], a[88:91]
    ds_read_b64_tr_b16 a[54:55], v47 offset:41984
    v_mfma_f32_16x16x32_bf16 a[92:95], a[12:15], a[140:143], a[92:95]
    ds_read_b64_tr_b16 a[56:57], v48 offset:40960
    v_mfma_f32_16x16x32_bf16 v[224:227], a[16:19], a[128:131], v[224:227]
    v_mfma_f32_16x16x32_bf16 v[228:231], a[16:19], a[132:135], v[228:231]
    buffer_load_dwordx4 a[188:191], v55, s[8:11], s62 offen sc1
    ds_read_b64_tr_b16 a[58:59], v48 offset:41984
    v_mfma_f32_16x16x32_bf16 a[96:99], a[16:19], a[136:139], a[96:99]
    ds_read_b64_tr_b16 a[60:61], v49 offset:40960
    v_mfma_f32_16x16x32_bf16 a[100:103], a[16:19], a[140:143], a[100:103]
    v_mfma_f32_16x16x32_bf16 v[232:235], a[20:23], a[128:131], v[232:235]
    ds_read_b64_tr_b16 a[62:63], v49 offset:41984
    v_mfma_f32_16x16x32_bf16 v[236:239], a[20:23], a[132:135], v[236:239]
    s_add_u32 s62, s62, 0x20000
    v_mfma_f32_16x16x32_bf16 a[104:107], a[20:23], a[136:139], a[104:107]
    s_add_u32 s52, s47, 536576
    v_mfma_f32_16x16x32_bf16 a[108:111], a[20:23], a[140:143], a[108:111]
    buffer_store_dwordx4 v[188:191], v1, s[48:51], s52 offen offset:3072 sc1
    v_mfma_f32_16x16x32_bf16 v[240:243], a[24:27], a[128:131], v[240:243]
    v_mfma_f32_16x16x32_bf16 v[244:247], a[24:27], a[132:135], v[244:247]
    v_mfma_f32_16x16x32_bf16 a[112:115], a[24:27], a[136:139], a[112:115]
    v_mfma_f32_16x16x32_bf16 a[116:119], a[24:27], a[140:143], a[116:119]
    v_mfma_f32_16x16x32_bf16 v[248:251], a[28:31], a[128:131], v[248:251]
    s_cmp_eq_u32 s30, 0
    s_cbranch_scc1 k12_ool_66
k12_oolret_67:
    v_mfma_f32_16x16x32_bf16 v[252:255], a[28:31], a[132:135], v[252:255]
    v_mfma_f32_16x16x32_bf16 a[120:123], a[28:31], a[136:139], a[120:123]
    v_mfma_f32_16x16x32_bf16 a[124:127], a[28:31], a[140:143], a[124:127]
    s_waitcnt vmcnt(10) lgkmcnt(0)
    s_barrier
    v_mfma_f32_16x16x32_bf16 v[192:195], a[32:35], a[144:147], v[192:195]
    ds_read_b64_tr_b16 a[0:1], v42 offset:49152
    ds_read_b64_tr_b16 a[2:3], v42 offset:50176
    v_mfma_f32_16x16x32_bf16 v[196:199], a[32:35], a[148:151], v[196:199]
    s_mov_b32 m0, s34
    v_mfma_f32_16x16x32_bf16 a[64:67], a[32:35], a[152:155], a[64:67]
    buffer_load_dwordx4 v1, s[16:19], s32 offen offset:0 sc1 lds
    ds_read_b64_tr_b16 a[4:5], v43 offset:49152
    v_mfma_f32_16x16x32_bf16 a[68:71], a[32:35], a[156:159], a[68:71]
    ds_read_b64_tr_b16 a[6:7], v43 offset:50176
    v_mfma_f32_16x16x32_bf16 v[200:203], a[36:39], a[144:147], v[200:203]
    buffer_load_dwordx4 v1, s[16:19], s32 offen offset:1024 sc1 lds
    ds_read_b64_tr_b16 a[8:9], v44 offset:49152
    v_mfma_f32_16x16x32_bf16 v[204:207], a[36:39], a[148:151], v[204:207]
    v_mfma_f32_16x16x32_bf16 a[72:75], a[36:39], a[152:155], a[72:75]
    ds_read_b64_tr_b16 a[10:11], v44 offset:50176
    v_mfma_f32_16x16x32_bf16 a[76:79], a[36:39], a[156:159], a[76:79]
    buffer_load_dwordx4 v1, s[16:19], s32 offen offset:2048 sc1 lds
    ds_read_b64_tr_b16 a[12:13], v45 offset:49152
    v_mfma_f32_16x16x32_bf16 v[208:211], a[40:43], a[144:147], v[208:211]
    v_mfma_f32_16x16x32_bf16 v[212:215], a[40:43], a[148:151], v[212:215]
    ds_read_b64_tr_b16 a[14:15], v45 offset:50176
    v_mfma_f32_16x16x32_bf16 a[80:83], a[40:43], a[152:155], a[80:83]
    ds_read_b64_tr_b16 a[16:17], v46 offset:49152
    v_mfma_f32_16x16x32_bf16 a[84:87], a[40:43], a[156:159], a[84:87]
    buffer_load_dwordx4 v1, s[16:19], s32 offen offset:3072 sc1 lds
    ds_read_b64_tr_b16 a[18:19], v46 offset:50176
    v_mfma_f32_16x16x32_bf16 v[216:219], a[44:47], a[144:147], v[216:219]
    v_mfma_f32_16x16x32_bf16 v[220:223], a[44:47], a[148:151], v[220:223]
    s_add_u32 s32, s32, 0x80000
    ds_read_b64_tr_b16 a[20:21], v47 offset:49152
    v_mfma_f32_16x16x32_bf16 a[88:91], a[44:47], a[152:155], a[88:91]
    s_add_u32 s34, s34, 0x4000
    ds_read_b64_tr_b16 a[22:23], v47 offset:50176
    s_mov_b32 m0, s34
    v_mfma_f32_16x16x32_bf16 a[92:95], a[44:47], a[156:159], a[92:95]
    buffer_load_dwordx4 v1, s[16:19], s32 offen offset:0 sc1 lds
    ds_read_b64_tr_b16 a[24:25], v48 offset:49152
    v_mfma_f32_16x16x32_bf16 v[224:227], a[48:51], a[144:147], v[224:227]
    v_mfma_f32_16x16x32_bf16 v[228:231], a[48:51], a[148:151], v[228:231]
    buffer_load_dwordx4 v1, s[16:19], s32 offen offset:1024 sc1 lds
    ds_read_b64_tr_b16 a[26:27], v48 offset:50176
    v_mfma_f32_16x16x32_bf16 a[96:99], a[48:51], a[152:155], a[96:99]
    ds_read_b64_tr_b16 a[28:29], v49 offset:49152
    v_mfma_f32_16x16x32_bf16 a[100:103], a[48:51], a[156:159], a[100:103]
    v_mfma_f32_16x16x32_bf16 v[232:235], a[52:55], a[144:147], v[232:235]
    buffer_load_dwordx4 v1, s[16:19], s32 offen offset:2048 sc1 lds
    ds_read_b64_tr_b16 a[30:31], v49 offset:50176
    v_mfma_f32_16x16x32_bf16 v[236:239], a[52:55], a[148:151], v[236:239]
    v_mfma_f32_16x16x32_bf16 a[104:107], a[52:55], a[152:155], a[104:107]
    v_mfma_f32_16x16x32_bf16 a[108:111], a[52:55], a[156:159], a[108:111]
    v_mfma_f32_16x16x32_bf16 v[240:243], a[56:59], a[144:147], v[240:243]
    buffer_load_dwordx4 v1, s[16:19], s32 offen offset:3072 sc1 lds
    v_mfma_f32_16x16x32_bf16 v[244:247], a[56:59], a[148:151], v[244:247]
    v_mfma_f32_16x16x32_bf16 a[112:115], a[56:59], a[152:155], a[112:115]
    s_add_u32 s32, s32, 0x80000
    v_mfma_f32_16x16x32_bf16 a[116:119], a[56:59], a[156:159], a[116:119]
    s_add_u32 s34, s34, 0x4000
    v_mfma_f32_16x16x32_bf16 v[248:251], a[60:63], a[144:147], v[248:251]
    v_mfma_f32_16x16x32_bf16 v[252:255], a[60:63], a[148:151], v[252:255]
    v_mfma_f32_16x16x32_bf16 a[120:123], a[60:63], a[152:155], a[120:123]
    v_mfma_f32_16x16x32_bf16 a[124:127], a[60:63], a[156:159], a[124:127]
    s_waitcnt vmcnt(14) lgkmcnt(0)
    v_mfma_f32_16x16x32_bf16 v[192:195], a[0:3], a[160:163], v[192:195]
    ds_read_b64_tr_b16 a[32:33], v42 offset:57344
    ds_read_b64_tr_b16 a[34:35], v42 offset:58368
    v_mfma_f32_16x16x32_bf16 v[196:199], a[0:3], a[164:167], v[196:199]
    s_mov_b32 m0, s35
    v_mfma_f32_16x16x32_bf16 a[64:67], a[0:3], a[168:171], a[64:67]
    buffer_load_dwordx4 v1, s[20:23], s33 offen offset:0 sc1 lds
    ds_read_b64_tr_b16 a[36:37], v43 offset:57344
    v_mfma_f32_16x16x32_bf16 a[68:71], a[0:3], a[172:175], a[68:71]
    ds_read_b64_tr_b16 a[38:39], v43 offset:58368
    v_mfma_f32_16x16x32_bf16 v[200:203], a[4:7], a[160:163], v[200:203]
    buffer_load_dwordx4 v1, s[20:23], s33 offen offset:1024 sc1 lds
    ds_read_b64_tr_b16 a[40:41], v44 offset:57344
    v_mfma_f32_16x16x32_bf16 v[204:207], a[4:7], a[164:167], v[204:207]
    v_mfma_f32_16x16x32_bf16 a[72:75], a[4:7], a[168:171], a[72:75]
    ds_read_b64_tr_b16 a[42:43], v44 offset:58368
    v_mfma_f32_16x16x32_bf16 a[76:79], a[4:7], a[172:175], a[76:79]
    buffer_load_dwordx4 v1, s[20:23], s33 offen offset:2048 sc1 lds
    ds_read_b64_tr_b16 a[44:45], v45 offset:57344
    v_mfma_f32_16x16x32_bf16 v[208:211], a[8:11], a[160:163], v[208:211]
    v_mfma_f32_16x16x32_bf16 v[212:215], a[8:11], a[164:167], v[212:215]
    ds_read_b64_tr_b16 a[46:47], v45 offset:58368
    v_mfma_f32_16x16x32_bf16 a[80:83], a[8:11], a[168:171], a[80:83]
    ds_read_b64_tr_b16 a[48:49], v46 offset:57344
    v_mfma_f32_16x16x32_bf16 a[84:87], a[8:11], a[172:175], a[84:87]
    buffer_load_dwordx4 v1, s[20:23], s33 offen offset:3072 sc1 lds
    ds_read_b64_tr_b16 a[50:51], v46 offset:58368
    v_mfma_f32_16x16x32_bf16 v[216:219], a[12:15], a[160:163], v[216:219]
    v_mfma_f32_16x16x32_bf16 v[220:223], a[12:15], a[164:167], v[220:223]
    s_add_u32 s33, s33, 0x80000
    ds_read_b64_tr_b16 a[52:53], v47 offset:57344
    v_mfma_f32_16x16x32_bf16 a[88:91], a[12:15], a[168:171], a[88:91]
    s_add_u32 s35, s35, 0x4000
    ds_read_b64_tr_b16 a[54:55], v47 offset:58368
    s_mov_b32 m0, s34
    v_mfma_f32_16x16x32_bf16 a[92:95], a[12:15], a[172:175], a[92:95]
    buffer_load_dwordx4 v1, s[16:19], s32 offen offset:0 sc1 lds
    ds_read_b64_tr_b16 a[56:57], v48 offset:57344
    v_mfma_f32_16x16x32_bf16 v[224:227], a[16:19], a[160:163], v[224:227]
    v_mfma_f32_16x16x32_bf16 v[228:231], a[16:19], a[164:167], v[228:231]
    buffer_load_dwordx4 v1, s[16:19], s32 offen offset:1024 sc1 lds
    ds_read_b64_tr_b16 a[58:59], v48 offset:58368
    v_mfma_f32_16x16x32_bf16 a[96:99], a[16:19], a[168:171], a[96:99]
    ds_read_b64_tr_b16 a[60:61], v49 offset:57344
    v_mfma_f32_16x16x32_bf16 a[100:103], a[16:19], a[172:175], a[100:103]
    v_mfma_f32_16x16x32_bf16 v[232:235], a[20:23], a[160:163], v[232:235]
    buffer_load_dwordx4 v1, s[16:19], s32 offen offset:2048 sc1 lds
    ds_read_b64_tr_b16 a[62:63], v49 offset:58368
    v_mfma_f32_16x16x32_bf16 v[236:239], a[20:23], a[164:167], v[236:239]
    v_mfma_f32_16x16x32_bf16 a[104:107], a[20:23], a[168:171], a[104:107]
    v_mfma_f32_16x16x32_bf16 a[108:111], a[20:23], a[172:175], a[108:111]
    v_mfma_f32_16x16x32_bf16 v[240:243], a[24:27], a[160:163], v[240:243]
    buffer_load_dwordx4 v1, s[16:19], s32 offen offset:3072 sc1 lds
    v_mfma_f32_16x16x32_bf16 v[244:247], a[24:27], a[164:167], v[244:247]
    v_mfma_f32_16x16x32_bf16 a[112:115], a[24:27], a[168:171], a[112:115]
    s_add_u32 s32, s32, 0x80000
    v_mfma_f32_16x16x32_bf16 a[116:119], a[24:27], a[172:175], a[116:119]
    s_add_u32 s34, s34, 0x4000
    v_mfma_f32_16x16x32_bf16 v[248:251], a[28:31], a[160:163], v[248:251]
    v_mfma_f32_16x16x32_bf16 v[252:255], a[28:31], a[164:167], v[252:255]
    v_mfma_f32_16x16x32_bf16 a[120:123], a[28:31], a[168:171], a[120:123]
    v_mfma_f32_16x16x32_bf16 a[124:127], a[28:31], a[172:175], a[124:127]
    s_waitcnt vmcnt(17) lgkmcnt(0)
    s_barrier
    v_mfma_f32_16x16x32_bf16 v[192:195], a[32:35], a[176:179], v[192:195]
    v_mfma_f32_16x16x32_bf16 v[196:199], a[32:35], a[180:183], v[196:199]
    s_mov_b32 m0, s35
    v_mfma_f32_16x16x32_bf16 a[64:67], a[32:35], a[184:187], a[64:67]
    buffer_load_dwordx4 v1, s[20:23], s33 offen offset:0 sc1 lds
    v_mfma_f32_16x16x32_bf16 a[68:71], a[32:35], a[188:191], a[68:71]
    v_mfma_f32_16x16x32_bf16 v[200:203], a[36:39], a[176:179], v[200:203]
    v_mfma_f32_16x16x32_bf16 v[204:207], a[36:39], a[180:183], v[204:207]
    v_mfma_f32_16x16x32_bf16 a[72:75], a[36:39], a[184:187], a[72:75]
    v_mfma_f32_16x16x32_bf16 a[76:79], a[36:39], a[188:191], a[76:79]
    buffer_load_dwordx4 v1, s[20:23], s33 offen offset:1024 sc1 lds
    v_mfma_f32_16x16x32_bf16 v[208:211], a[40:43], a[176:179], v[208:211]
    v_mfma_f32_16x16x32_bf16 v[212:215], a[40:43], a[180:183], v[212:215]
    v_mfma_f32_16x16x32_bf16 a[80:83], a[40:43], a[184:187], a[80:83]
    v_mfma_f32_16x16x32_bf16 a[84:87], a[40:43], a[188:191], a[84:87]
    v_mfma_f32_16x16x32_bf16 v[216:219], a[44:47], a[176:179], v[216:219]
    v_mfma_f32_16x16x32_bf16 v[220:223], a[44:47], a[180:183], v[220:223]
    v_mfma_f32_16x16x32_bf16 a[88:91], a[44:47], a[184:187], a[88:91]
    buffer_load_dwordx4 v1, s[20:23], s33 offen offset:2048 sc1 lds
    v_mfma_f32_16x16x32_bf16 a[92:95], a[44:47], a[188:191], a[92:95]
    v_mfma_f32_16x16x32_bf16 v[224:227], a[48:51], a[176:179], v[224:227]
    v_mfma_f32_16x16x32_bf16 v[228:231], a[48:51], a[180:183], v[228:231]
    v_mfma_f32_16x16x32_bf16 a[96:99], a[48:51], a[184:187], a[96:99]
    v_mfma_f32_16x16x32_bf16 a[100:103], a[48:51], a[188:191], a[100:103]
    v_mfma_f32_16x16x32_bf16 v[232:235], a[52:55], a[176:179], v[232:235]
    buffer_load_dwordx4 v1, s[20:23], s33 offen offset:3072 sc1 lds
    v_mfma_f32_16x16x32_bf16 v[236:239], a[52:55], a[180:183], v[236:239]
    v_mfma_f32_16x16x32_bf16 a[104:107], a[52:55], a[184:187], a[104:107]
    v_mfma_f32_16x16x32_bf16 a[108:111], a[52:55], a[188:191], a[108:111]
    v_mfma_f32_16x16x32_bf16 v[240:243], a[56:59], a[176:179], v[240:243]
    v_mfma_f32_16x16x32_bf16 v[244:247], a[56:59], a[180:183], v[244:247]
    v_mfma_f32_16x16x32_bf16 a[112:115], a[56:59], a[184:187], a[112:115]
    s_add_u32 s33, s33, 0x80000
    v_mfma_f32_16x16x32_bf16 a[116:119], a[56:59], a[188:191], a[116:119]
    s_add_u32 s35, s35, 0x4000
    v_mfma_f32_16x16x32_bf16 v[248:251], a[60:63], a[176:179], v[248:251]
    v_mfma_f32_16x16x32_bf16 v[252:255], a[60:63], a[180:183], v[252:255]
    v_mfma_f32_16x16x32_bf16 a[120:123], a[60:63], a[184:187], a[120:123]
    v_mfma_f32_16x16x32_bf16 a[124:127], a[60:63], a[188:191], a[124:127]
    s_add_u32 s3, s54, 64
    s_add_u32 s5, s55, 64
    s_mov_b32 s63, s57
    s_load_dwordx2 s[44:45], s[0:1], 40
    s_load_dwordx2 s[46:47], s[0:1], 64
    s_load_dwordx4 s[48:51], s[0:1], 72
    s_mov_b32 s40, 0x3e0293ee
    s_mov_b32 s41, 0x3e0293ee
    s_mov_b32 m0, s34
    s_nop 0
    buffer_load_dwordx4 v1, s[16:19], s32 offen offset:0 sc1 lds
    buffer_load_dwordx4 v1, s[16:19], s32 offen offset:1024 sc1 lds
    buffer_load_dwordx4 v1, s[16:19], s32 offen offset:2048 sc1 lds
    buffer_load_dwordx4 v1, s[16:19], s32 offen offset:3072 sc1 lds
    s_mov_b32 m0, s35
    s_nop 0
    buffer_load_dwordx4 v1, s[20:23], s33 offen offset:0 sc1 lds
    buffer_load_dwordx4 v1, s[20:23], s33 offen offset:1024 sc1 lds
    buffer_load_dwordx4 v1, s[20:23], s33 offen offset:2048 sc1 lds
    buffer_load_dwordx4 v1, s[20:23], s33 offen offset:3072 sc1 lds
    s_add_u32 s32, s32, 0x80000
    s_add_u32 s33, s33, 0x80000
    s_add_u32 s34, s34, 0x4000
    s_and_b32 s34, s34, 0xffff
    s_add_u32 s35, s35, 0x4000
    s_and_b32 s35, s35, 0xffff
    s_or_b32 s35, s35, 0x10000
    v_mov_b32 v2, v1
    v_or_b32 v3, 0x10000, v1
    v_mov_b32 v56, v3
    s_mov_b32 s52, 0x4000
    s_mov_b32 s53, 0
    s_lshl_b32 s62, s28, 6
    s_mul_i32 s31, s29, s29
    s_add_u32 s62, s62, s31
    s_lshr_b32 s31, s30, 1
    s_lshl_b32 s4, s31, 23
    s_add_u32 s4, s4, 0x6000000
    s_add_u32 s8, s6, s4
    s_addc_u32 s9, s7, 0
    s_and_b32 s9, s9, 0xffff
    s_mov_b32 s10, 0
    s_mov_b32 s58, 0
    s_mov_b32 s14, 0x700000
    s_mov_b32 s59, 0x700000
    s_lshl_b32 s54, s62, 12
    s_waitcnt vmcnt(16) lgkmcnt(0)
    s_barrier
    s_cmp_eq_u32 s63, 0
    s_cbranch_scc1 k12_ool_68
k12_oolret_69:
    v_mov_b32 v59, 0
    ds_read_b128 a[128:131], v2 offset:0
    ds_read_b128 a[132:135], v2 offset:1024
    ds_read_b128 a[136:139], v2 offset:2048
    ds_read_b128 a[140:143], v2 offset:3072
    ds_read_b128 a[144:147], v2 offset:4096
    ds_read_b128 a[148:151], v2 offset:5120
    ds_read_b128 a[152:155], v2 offset:6144
    ds_read_b128 a[156:159], v2 offset:7168
    ds_read_b128 a[160:163], v2 offset:8192
    ds_read_b128 a[164:167], v2 offset:9216
    ds_read_b128 a[168:171], v2 offset:10240
    ds_read_b128 a[172:175], v2 offset:11264
    ds_read_b128 a[176:179], v2 offset:12288
    ds_read_b128 a[180:183], v2 offset:13312
    ds_read_b128 a[184:187], v2 offset:14336
    ds_read_b128 a[188:191], v2 offset:15360
    s_cmp_lt_u32 s30, 2
    s_cselect_b64 s[12:13], s[46:47], s[48:49]
    s_cselect_b64 s[60:61], s[44:45], s[50:51]
    s_cselect_b32 s55, 0x800000, s14
    s_and_b32 s13, s13, 0xffff
    v_accvgpr_read_b32 v128, a64
    v_accvgpr_read_b32 v129, a65
    v_accvgpr_read_b32 v130, a66
    v_accvgpr_read_b32 v131, a67
    v_pk_mul_f32 v[128:129], v[128:129], s[40:41]
    v_pk_mul_f32 v[130:131], v[130:131], s[40:41]
    v_cvt_pk_bf16_f32 v96, v128, v129
    v_cvt_pk_bf16_f32 v97, v130, v131
    v_accvgpr_read_b32 v132, a72
    v_accvgpr_read_b32 v133, a73
    v_accvgpr_read_b32 v134, a74
    v_accvgpr_read_b32 v135, a75
    v_pk_mul_f32 v[132:133], v[132:133], s[40:41]
    v_pk_mul_f32 v[134:135], v[134:135], s[40:41]
    v_cvt_pk_bf16_f32 v98, v132, v133
    v_cvt_pk_bf16_f32 v99, v134, v135
    v_accvgpr_read_b32 v136, a80
    v_accvgpr_read_b32 v137, a81
    v_accvgpr_read_b32 v138, a82
    v_accvgpr_read_b32 v139, a83
    v_pk_mul_f32 v[136:137], v[136:137], s[40:41]
    v_pk_mul_f32 v[138:139], v[138:139], s[40:41]
    v_cvt_pk_bf16_f32 v100, v136, v137
    v_cvt_pk_bf16_f32 v101, v138, v139
    v_accvgpr_read_b32 v140, a88
    v_accvgpr_read_b32 v141, a89
    v_accvgpr_read_b32 v142, a90
    v_accvgpr_read_b32 v143, a91
    v_pk_mul_f32 v[140:141], v[140:141], s[40:41]
    v_pk_mul_f32 v[142:143], v[142:143], s[40:41]
    v_cvt_pk_bf16_f32 v102, v140, v141
    v_cvt_pk_bf16_f32 v103, v142, v143
    v_accvgpr_read_b32 v128, a96
    v_accvgpr_read_b32 v129, a97
    v_accvgpr_read_b32 v130, a98
    v_accvgpr_read_b32 v131, a99
    v_pk_mul_f32 v[128:129], v[128:129], s[40:41]
    v_pk_mul_f32 v[130:131], v[130:131], s[40:41]
    v_cvt_pk_bf16_f32 v104, v128, v129
    v_cvt_pk_bf16_f32 v105, v130, v131
    v_accvgpr_read_b32 v132, a104
    v_accvgpr_read_b32 v133, a105
    v_accvgpr_read_b32 v134, a106
    v_accvgpr_read_b32 v135, a107
    v_pk_mul_f32 v[132:133], v[132:133], s[40:41]
    v_pk_mul_f32 v[134:135], v[134:135], s[40:41]
    v_cvt_pk_bf16_f32 v106, v132, v133
    v_cvt_pk_bf16_f32 v107, v134, v135
    v_accvgpr_read_b32 v136, a112
    v_accvgpr_read_b32 v137, a113
    v_accvgpr_read_b32 v138, a114
    v_accvgpr_read_b32 v139, a115
    v_pk_mul_f32 v[136:137], v[136:137], s[40:41]
    v_pk_mul_f32 v[138:139], v[138:139], s[40:41]
    v_cvt_pk_bf16_f32 v108, v136, v137
    v_cvt_pk_bf16_f32 v109, v138, v139
    v_accvgpr_read_b32 v140, a120
    v_accvgpr_read_b32 v141, a121
    v_accvgpr_read_b32 v142, a122
    v_accvgpr_read_b32 v143, a123
    v_pk_mul_f32 v[140:141], v[140:141], s[40:41]
    v_pk_mul_f32 v[142:143], v[142:143], s[40:41]
    v_cvt_pk_bf16_f32 v110, v140, v141
    v_cvt_pk_bf16_f32 v111, v142, v143
    v_accvgpr_read_b32 v128, a68
    v_accvgpr_read_b32 v129, a69
    v_accvgpr_read_b32 v130, a70
    v_accvgpr_read_b32 v131, a71
    v_pk_mul_f32 v[128:129], v[128:129], s[40:41]
    v_pk_mul_f32 v[130:131], v[130:131], s[40:41]
    v_cvt_pk_bf16_f32 v112, v128, v129
    v_cvt_pk_bf16_f32 v113, v130, v131
    v_accvgpr_read_b32 v132, a76
    v_accvgpr_read_b32 v133, a77
    v_accvgpr_read_b32 v134, a78
    v_accvgpr_read_b32 v135, a79
    v_pk_mul_f32 v[132:133], v[132:133], s[40:41]
    v_pk_mul_f32 v[134:135], v[134:135], s[40:41]
    v_cvt_pk_bf16_f32 v114, v132, v133
    v_cvt_pk_bf16_f32 v115, v134, v135
    v_accvgpr_read_b32 v136, a84
    v_accvgpr_read_b32 v137, a85
    v_accvgpr_read_b32 v138, a86
    v_accvgpr_read_b32 v139, a87
    v_pk_mul_f32 v[136:137], v[136:137], s[40:41]
    v_pk_mul_f32 v[138:139], v[138:139], s[40:41]
    v_cvt_pk_bf16_f32 v116, v136, v137
    v_cvt_pk_bf16_f32 v117, v138, v139
    v_accvgpr_read_b32 v140, a92
    v_accvgpr_read_b32 v141, a93
    v_accvgpr_read_b32 v142, a94
    v_accvgpr_read_b32 v143, a95
    v_pk_mul_f32 v[140:141], v[140:141], s[40:41]
    v_pk_mul_f32 v[142:143], v[142:143], s[40:41]
    v_cvt_pk_bf16_f32 v118, v140, v141
    v_cvt_pk_bf16_f32 v119, v142, v143
    v_accvgpr_read_b32 v128, a100
    v_accvgpr_read_b32 v129, a101
    v_accvgpr_read_b32 v130, a102
    v_accvgpr_read_b32 v131, a103
    v_pk_mul_f32 v[128:129], v[128:129], s[40:41]
    v_pk_mul_f32 v[130:131], v[130:131], s[40:41]
    v_cvt_pk_bf16_f32 v120, v128, v129
    v_cvt_pk_bf16_f32 v121, v130, v131
    v_accvgpr_read_b32 v132, a108
    v_accvgpr_read_b32 v133, a109
    v_accvgpr_read_b32 v134, a110
    v_accvgpr_read_b32 v135, a111
    v_pk_mul_f32 v[132:133], v[132:133], s[40:41]
    v_pk_mul_f32 v[134:135], v[134:135], s[40:41]
    v_cvt_pk_bf16_f32 v122, v132, v133
    v_cvt_pk_bf16_f32 v123, v134, v135
    v_accvgpr_read_b32 v136, a116
    v_accvgpr_read_b32 v137, a117
    v_accvgpr_read_b32 v138, a118
    v_accvgpr_read_b32 v139, a119
    v_pk_mul_f32 v[136:137], v[136:137], s[40:41]
    v_pk_mul_f32 v[138:139], v[138:139], s[40:41]
    v_cvt_pk_bf16_f32 v124, v136, v137
    v_cvt_pk_bf16_f32 v125, v138, v139
    v_accvgpr_read_b32 v140, a124
    v_accvgpr_read_b32 v141, a125
    v_accvgpr_read_b32 v142, a126
    v_accvgpr_read_b32 v143, a127
    v_pk_mul_f32 v[140:141], v[140:141], s[40:41]
    v_pk_mul_f32 v[142:143], v[142:143], s[40:41]
    v_cvt_pk_bf16_f32 v126, v140, v141
    v_cvt_pk_bf16_f32 v127, v142, v143
    v_pk_mul_f32 v[192:193], v[192:193], s[40:41]
    v_pk_mul_f32 v[194:195], v[194:195], s[40:41]
    v_cvt_pk_bf16_f32 v64, v192, v193
    v_cvt_pk_bf16_f32 v65, v194, v195
    v_pk_mul_f32 v[200:201], v[200:201], s[40:41]
    v_pk_mul_f32 v[202:203], v[202:203], s[40:41]
    v_cvt_pk_bf16_f32 v66, v200, v201
    v_cvt_pk_bf16_f32 v67, v202, v203
    v_pk_mul_f32 v[208:209], v[208:209], s[40:41]
    v_pk_mul_f32 v[210:211], v[210:211], s[40:41]
    v_cvt_pk_bf16_f32 v68, v208, v209
    v_cvt_pk_bf16_f32 v69, v210, v211
    v_pk_mul_f32 v[216:217], v[216:217], s[40:41]
    v_pk_mul_f32 v[218:219], v[218:219], s[40:41]
    v_cvt_pk_bf16_f32 v70, v216, v217
    v_cvt_pk_bf16_f32 v71, v218, v219
    v_pk_mul_f32 v[224:225], v[224:225], s[40:41]
    v_pk_mul_f32 v[226:227], v[226:227], s[40:41]
    v_cvt_pk_bf16_f32 v72, v224, v225
    v_cvt_pk_bf16_f32 v73, v226, v227
    v_pk_mul_f32 v[232:233], v[232:233], s[40:41]
    v_pk_mul_f32 v[234:235], v[234:235], s[40:41]
    v_cvt_pk_bf16_f32 v74, v232, v233
    v_cvt_pk_bf16_f32 v75, v234, v235
    v_pk_mul_f32 v[240:241], v[240:241], s[40:41]
    v_pk_mul_f32 v[242:243], v[242:243], s[40:41]
    v_cvt_pk_bf16_f32 v76, v240, v241
    v_cvt_pk_bf16_f32 v77, v242, v243
    v_pk_mul_f32 v[248:249], v[248:249], s[40:41]
    v_pk_mul_f32 v[250:251], v[250:251], s[40:41]
    v_cvt_pk_bf16_f32 v78, v248, v249
    v_cvt_pk_bf16_f32 v79, v250, v251
    v_pk_mul_f32 v[196:197], v[196:197], s[40:41]
    v_pk_mul_f32 v[198:199], v[198:199], s[40:41]
    v_cvt_pk_bf16_f32 v80, v196, v197
    v_cvt_pk_bf16_f32 v81, v198, v199
    v_pk_mul_f32 v[204:205], v[204:205], s[40:41]
    v_pk_mul_f32 v[206:207], v[206:207], s[40:41]
    v_cvt_pk_bf16_f32 v82, v204, v205
    v_cvt_pk_bf16_f32 v83, v206, v207
    v_pk_mul_f32 v[212:213], v[212:213], s[40:41]
    v_pk_mul_f32 v[214:215], v[214:215], s[40:41]
    v_cvt_pk_bf16_f32 v84, v212, v213
    v_cvt_pk_bf16_f32 v85, v214, v215
    v_pk_mul_f32 v[220:221], v[220:221], s[40:41]
    v_pk_mul_f32 v[222:223], v[222:223], s[40:41]
    v_cvt_pk_bf16_f32 v86, v220, v221
    v_cvt_pk_bf16_f32 v87, v222, v223
    v_pk_mul_f32 v[228:229], v[228:229], s[40:41]
    v_pk_mul_f32 v[230:231], v[230:231], s[40:41]
    v_cvt_pk_bf16_f32 v88, v228, v229
    v_cvt_pk_bf16_f32 v89, v230, v231
    v_pk_mul_f32 v[236:237], v[236:237], s[40:41]
    v_pk_mul_f32 v[238:239], v[238:239], s[40:41]
    v_cvt_pk_bf16_f32 v90, v236, v237
    v_cvt_pk_bf16_f32 v91, v238, v239
    v_pk_mul_f32 v[244:245], v[244:245], s[40:41]
    v_pk_mul_f32 v[246:247], v[246:247], s[40:41]
    v_cvt_pk_bf16_f32 v92, v244, v245
    v_cvt_pk_bf16_f32 v93, v246, v247
    v_pk_mul_f32 v[252:253], v[252:253], s[40:41]
    v_pk_mul_f32 v[254:255], v[254:255], s[40:41]
    v_cvt_pk_bf16_f32 v94, v252, v253
    v_cvt_pk_bf16_f32 v95, v254, v255
    v_add_u32 v2, 0x4000, v1
    v_mov_b32 v8, 0
    v_mov_b32 v232, 0
    v_mov_b32 v9, 0
    v_mov_b32 v233, 0
    v_mov_b32 v10, 0
    v_mov_b32 v234, 0
    v_mov_b32 v11, 0
    v_mov_b32 v235, 0
    s_mov_b32 s36, 0
    s_mov_b32 s37, 0x40004000
    v_mfma_f32_32x32x16_bf16 v[16:31], v[232:235], v[232:235], 0
    v_mfma_f32_32x32x16_bf16 v[32:47], v[232:235], v[232:235], 0
    v_and_b32 v6, 0xf0, v1
    v_cmp_eq_u32 vcc, 0, v6
    v_mov_b32 v6, 0x3f803f80
    v_lshrrev_b32 v229, 7, v1
    s_and_b32 s4, s30, 1
    s_lshl_b32 s31, s4, 11
    v_lshl_add_u32 v230, v1, 1, s31
    v_lshl_add_u32 v229, s4, 4, v229
    v_mul_u32_u24 v228, 7168, v229
    v_and_b32 v7, 0x70, v1
    v_add_u32 v228, v228, v7
    v_lshlrev_b32 v229, 5, v229
    v_and_b32 v57, 0x10, v1
    v_add_u32 v229, v229, v57
    v_lshrrev_b32 v7, 5, v7
    v_lshl_add_u32 v229, v7, 15, v229
    v_cndmask_b32 v60, 0, v6, vcc
    v_cndmask_b32 v61, 0, v6, vcc
    v_cndmask_b32 v62, 0, v6, vcc
    v_cndmask_b32 v63, 0, v6, vcc
    v_mov_b32 v12, 0
    v_mov_b32 v13, 0
    v_mov_b32 v14, 0
    v_mov_b32 v15, 0
    v_mov_b32 v48, 0
    v_mov_b32 v49, 0
    v_mov_b32 v50, 0
    v_mov_b32 v51, 0
    v_mov_b32 v248, 0
    v_mov_b32 v249, 0
    v_mov_b32 v250, 0
    v_mov_b32 v251, 0
    v_mov_b32 v252, 0
    v_mov_b32 v253, 0
    v_mov_b32 v254, 0
    v_mov_b32 v255, 0
    s_waitcnt lgkmcnt(0)
    s_cmp_ge_u32 s36, s42
    s_cbranch_scc1 k2_prep_70
k2_prepret_71:
    v_mfma_f32_16x16x32_bf16 v[128:131], a[128:131], v[64:67], v[16:19]
    v_mfma_f32_16x16x32_bf16 v[132:135], a[128:131], v[80:83], v[20:23]
    v_mfma_f32_16x16x32_bf16 v[136:139], a[128:131], v[96:99], v[24:27]
    v_mfma_f32_16x16x32_bf16 v[140:143], a[128:131], v[112:115], v[28:31]
    s_add_u32 s36, s36, 32
    v_mfma_f32_16x16x32_bf16 v[128:131], a[132:135], v[68:71], v[128:131]
    v_mfma_f32_16x16x32_bf16 v[132:135], a[132:135], v[84:87], v[132:135]
    v_mfma_f32_16x16x32_bf16 v[136:139], a[132:135], v[100:103], v[136:139]
    v_mfma_f32_16x16x32_bf16 v[140:143], a[132:135], v[116:119], v[140:143]
    v_mfma_f32_16x16x32_bf16 v[128:131], a[136:139], v[72:75], v[128:131]
    v_mfma_f32_16x16x32_bf16 v[132:135], a[136:139], v[88:91], v[132:135]
    v_mfma_f32_16x16x32_bf16 v[136:139], a[136:139], v[104:107], v[136:139]
    v_mfma_f32_16x16x32_bf16 v[140:143], a[136:139], v[120:123], v[140:143]
    v_mfma_f32_16x16x32_bf16 v[128:131], a[140:143], v[76:79], v[128:131]
    v_mfma_f32_16x16x32_bf16 v[132:135], a[140:143], v[92:95], v[132:135]
    v_mfma_f32_16x16x32_bf16 v[136:139], a[140:143], v[108:111], v[136:139]
    v_mfma_f32_16x16x32_bf16 v[140:143], a[140:143], v[124:127], v[140:143]
    v_mfma_f32_16x16x32_bf16 v[144:147], a[144:147], v[64:67], v[32:35]
    v_mfma_f32_16x16x32_bf16 v[148:151], a[144:147], v[80:83], v[36:39]
    v_mfma_f32_16x16x32_bf16 v[152:155], a[144:147], v[96:99], v[40:43]
    v_mfma_f32_16x16x32_bf16 v[156:159], a[144:147], v[112:115], v[44:47]
    v_mfma_f32_16x16x32_bf16 v[144:147], a[148:151], v[68:71], v[144:147]
    v_mfma_f32_16x16x32_bf16 v[148:151], a[148:151], v[84:87], v[148:151]
    v_mfma_f32_16x16x32_bf16 v[152:155], a[148:151], v[100:103], v[152:155]
    v_mfma_f32_16x16x32_bf16 v[156:159], a[148:151], v[116:119], v[156:159]
    v_mfma_f32_16x16x32_bf16 v[144:147], a[152:155], v[72:75], v[144:147]
    v_mfma_f32_16x16x32_bf16 v[148:151], a[152:155], v[88:91], v[148:151]
    v_mfma_f32_16x16x32_bf16 v[152:155], a[152:155], v[104:107], v[152:155]
    v_mfma_f32_16x16x32_bf16 v[156:159], a[152:155], v[120:123], v[156:159]
    v_mfma_f32_16x16x32_bf16 v[144:147], a[156:159], v[76:79], v[144:147]
    v_mfma_f32_16x16x32_bf16 v[148:151], a[156:159], v[92:95], v[148:151]
    v_mfma_f32_16x16x32_bf16 v[152:155], a[156:159], v[108:111], v[152:155]
    v_mfma_f32_16x16x32_bf16 v[156:159], a[156:159], v[124:127], v[156:159]
    v_mfma_f32_32x32x16_bf16 a[0:15], v[232:235], v[232:235], 0
    v_mfma_f32_32x32x16_bf16 a[16:31], v[232:235], v[232:235], 0
    v_mfma_f32_32x32x16_bf16 a[32:47], v[232:235], v[232:235], 0
    v_mfma_f32_32x32x16_bf16 a[48:63], v[232:235], v[232:235], 0
    v_mfma_f32_32x32x16_bf16 a[64:79], v[232:235], v[232:235], 0
    v_mfma_f32_32x32x16_bf16 a[80:95], v[232:235], v[232:235], 0
    v_mfma_f32_32x32x16_bf16 a[96:111], v[232:235], v[232:235], 0
    v_mfma_f32_32x32x16_bf16 a[112:127], v[232:235], v[232:235], 0
    v_max_f32 v52, v128, v129
    v_max3_f32 v52, v52, v130, v131
    v_max3_f32 v52, v52, v144, v145
    v_max3_f32 v52, v52, v146, v147
    v_max_f32 v53, v132, v133
    v_max3_f32 v53, v53, v134, v135
    v_max3_f32 v53, v53, v148, v149
    v_max3_f32 v53, v53, v150, v151
    v_max_f32 v54, v136, v137
    v_max3_f32 v54, v54, v138, v139
    v_max3_f32 v54, v54, v152, v153
    v_max3_f32 v54, v54, v154, v155
    v_max_f32 v55, v140, v141
    v_max3_f32 v55, v55, v142, v143
    v_max3_f32 v55, v55, v156, v157
    v_max3_f32 v55, v55, v158, v159
    v_mov_b32 v224, v52
    v_mov_b32 v225, v53
    v_mov_b32 v226, v54
    v_mov_b32 v227, v55
    s_nop 1
    v_permlane16_swap_b32 v52, v224
    v_permlane16_swap_b32 v53, v225
    v_permlane16_swap_b32 v54, v226
    v_permlane16_swap_b32 v55, v227
    s_nop 1
    v_max_f32 v52, v52, v224
    v_max_f32 v53, v53, v225
    v_max_f32 v54, v54, v226
    v_max_f32 v55, v55, v227
    v_mov_b32 v224, v52
    v_mov_b32 v225, v53
    v_mov_b32 v226, v54
    v_mov_b32 v227, v55
    s_nop 1
    v_permlane32_swap_b32 v52, v224
    v_permlane32_swap_b32 v53, v225
    v_permlane32_swap_b32 v54, v226
    v_permlane32_swap_b32 v55, v227
    s_nop 1
    v_max_f32 v52, v52, v224
    v_max_f32 v53, v53, v225
    v_max_f32 v54, v54, v226
    v_max_f32 v55, v55, v227
    v_add_f32 v52, 0x41400000, v52
    v_add_f32 v53, 0x41400000, v53
    v_add_f32 v54, 0x41400000, v54
    v_add_f32 v55, 0x41400000, v55
    v_sub_f32 v16, 0, v52
    v_sub_f32 v17, 0, v52
    v_sub_f32 v18, 0, v52
    v_sub_f32 v19, 0, v52
    v_sub_f32 v20, 0, v53
    v_sub_f32 v21, 0, v53
    v_sub_f32 v22, 0, v53
    v_sub_f32 v23, 0, v53
    v_sub_f32 v24, 0, v54
    v_sub_f32 v25, 0, v54
    v_sub_f32 v26, 0, v54
    v_sub_f32 v27, 0, v54
    v_sub_f32 v28, 0, v55
    v_sub_f32 v29, 0, v55
    v_sub_f32 v30, 0, v55
    v_sub_f32 v31, 0, v55
    v_sub_f32 v32, 0, v52
    v_sub_f32 v33, 0, v52
    v_sub_f32 v34, 0, v52
    v_sub_f32 v35, 0, v52
    v_sub_f32 v36, 0, v53
    v_sub_f32 v37, 0, v53
    v_sub_f32 v38, 0, v53
    v_sub_f32 v39, 0, v53
    v_sub_f32 v40, 0, v54
    v_sub_f32 v41, 0, v54
    v_sub_f32 v42, 0, v54
    v_sub_f32 v43, 0, v54
    v_sub_f32 v44, 0, v55
    v_sub_f32 v45, 0, v55
    v_sub_f32 v46, 0, v55
    v_sub_f32 v47, 0, v55
    v_sub_f32 v8, 0, v52
    v_sub_f32 v9, 0, v53
    v_sub_f32 v10, 0, v54
    v_sub_f32 v11, 0, v55
    s_cmp_ge_u32 s36, s42
    s_cbranch_scc1 k2_prep_78
k2_prepret_79:
    v_mfma_f32_16x16x32_bf16 v[160:163], a[160:163], v[64:67], v[16:19]
    v_sub_f32 v128, v128, v52
    v_sub_f32 v129, v129, v52
    v_sub_f32 v130, v130, v52
    v_mfma_f32_16x16x32_bf16 v[164:167], a[160:163], v[80:83], v[20:23]
    v_exp_f32 v232, v128
    v_sub_f32 v131, v131, v52
    v_mfma_f32_16x16x32_bf16 v[168:171], a[160:163], v[96:99], v[24:27]
    v_exp_f32 v233, v129
    v_sub_f32 v144, v144, v52
    v_mfma_f32_16x16x32_bf16 v[172:175], a[160:163], v[112:115], v[28:31]
    s_add_u32 s36, s36, 32
    s_cmp_eq_u32 s30, 0
    s_cbranch_scc1 k12_ool_72
k12_oolret_73:
    v_sub_f32 v145, v145, v52
    v_mfma_f32_16x16x32_bf16 v[160:163], a[164:167], v[68:71], v[160:163]
    v_exp_f32 v234, v130
    v_cvt_pk_bf16_f32 v192, v232, v233
    v_mfma_f32_16x16x32_bf16 v[164:167], a[164:167], v[84:87], v[164:167]
    v_exp_f32 v235, v131
    v_sub_f32 v146, v146, v52
    v_mfma_f32_16x16x32_bf16 v[168:171], a[164:167], v[100:103], v[168:171]
    v_exp_f32 v236, v144
    v_sub_f32 v147, v147, v52
    v_mfma_f32_16x16x32_bf16 v[172:175], a[164:167], v[116:119], v[172:175]
    v_cvt_pk_bf16_f32 v193, v234, v235
    v_exp_f32 v237, v145
    v_mfma_f32_16x16x32_bf16 v[160:163], a[168:171], v[72:75], v[160:163]
    v_exp_f32 v238, v146
    v_sub_f32 v132, v132, v53
    v_mfma_f32_16x16x32_bf16 v[164:167], a[168:171], v[88:91], v[164:167]
    v_sub_f32 v133, v133, v53
    v_cvt_pk_bf16_f32 v194, v236, v237
    v_or3_b32 v57, v192, v193, v194
    v_mfma_f32_16x16x32_bf16 v[168:171], a[168:171], v[104:107], v[168:171]
    v_exp_f32 v239, v147
    v_sub_f32 v134, v134, v53
    v_mfma_f32_16x16x32_bf16 v[172:175], a[168:171], v[120:123], v[172:175]
    v_exp_f32 v240, v132
    v_sub_f32 v135, v135, v53
    v_mfma_f32_16x16x32_bf16 v[160:163], a[172:175], v[76:79], v[160:163]
    v_cvt_pk_bf16_f32 v195, v238, v239
    v_exp_f32 v241, v133
    v_mfma_f32_16x16x32_bf16 v[164:167], a[172:175], v[92:95], v[164:167]
    v_exp_f32 v242, v134
    v_sub_f32 v148, v148, v53
    v_mfma_f32_16x16x32_bf16 v[168:171], a[172:175], v[108:111], v[168:171]
    v_sub_f32 v149, v149, v53
    v_cvt_pk_bf16_f32 v196, v240, v241
    v_exp_f32 v243, v135
    v_mfma_f32_16x16x32_bf16 v[172:175], a[172:175], v[124:127], v[172:175]
    v_or3_b32 v57, v57, v195, v196
    v_exp_f32 v244, v148
    v_mfma_f32_16x16x32_bf16 v[176:179], a[176:179], v[64:67], v[32:35]
    v_sub_f32 v150, v150, v53
    v_sub_f32 v151, v151, v53
    v_cvt_pk_bf16_f32 v197, v242, v243
    v_mfma_f32_16x16x32_bf16 v[180:183], a[176:179], v[80:83], v[36:39]
    v_exp_f32 v245, v149
    v_exp_f32 v246, v150
    v_mfma_f32_16x16x32_bf16 v[184:187], a[176:179], v[96:99], v[40:43]
    v_sub_f32 v136, v136, v54
    v_sub_f32 v137, v137, v54
    v_cvt_pk_bf16_f32 v198, v244, v245
    v_mfma_f32_16x16x32_bf16 v[188:191], a[176:179], v[112:115], v[44:47]
    v_exp_f32 v247, v151
    v_or3_b32 v57, v57, v197, v198
    v_mfma_f32_16x16x32_bf16 v[176:179], a[180:183], v[68:71], v[176:179]
    v_exp_f32 v232, v136
    v_sub_f32 v138, v138, v54
    v_mfma_f32_16x16x32_bf16 v[180:183], a[180:183], v[84:87], v[180:183]
    ds_read_b128 a[192:195], v3 offset:0
    v_sub_f32 v139, v139, v54
    v_cvt_pk_bf16_f32 v199, v246, v247
    v_mfma_f32_16x16x32_bf16 v[184:187], a[180:183], v[100:103], v[184:187]
    v_exp_f32 v233, v137
    v_exp_f32 v234, v138
    v_mfma_f32_16x16x32_bf16 v[188:191], a[180:183], v[116:119], v[188:191]
    v_sub_f32 v152, v152, v54
    v_sub_f32 v153, v153, v54
    v_cvt_pk_bf16_f32 v200, v232, v233
    v_mfma_f32_16x16x32_bf16 v[176:179], a[184:187], v[72:75], v[176:179]
    v_exp_f32 v235, v139
    v_or3_b32 v57, v57, v199, v200
    v_mfma_f32_16x16x32_bf16 v[180:183], a[184:187], v[88:91], v[180:183]
    v_exp_f32 v236, v152
    v_sub_f32 v154, v154, v54
    v_mfma_f32_16x16x32_bf16 v[184:187], a[184:187], v[104:107], v[184:187]
    v_sub_f32 v155, v155, v54
    v_cvt_pk_bf16_f32 v201, v234, v235
    v_exp_f32 v237, v153
    v_mfma_f32_16x16x32_bf16 v[188:191], a[184:187], v[120:123], v[188:191]
    ds_read_b128 a[196:199], v3 offset:1024
    v_exp_f32 v238, v154
    v_mfma_f32_16x16x32_bf16 v[176:179], a[188:191], v[76:79], v[176:179]
    v_sub_f32 v140, v140, v55
    v_sub_f32 v141, v141, v55
    v_cvt_pk_bf16_f32 v202, v236, v237
    v_mfma_f32_16x16x32_bf16 v[180:183], a[188:191], v[92:95], v[180:183]
    v_exp_f32 v239, v155
    v_or3_b32 v57, v57, v201, v202
    v_mfma_f32_16x16x32_bf16 v[184:187], a[188:191], v[108:111], v[184:187]
    s_cmp_eq_u32 s30, 0
    s_cbranch_scc1 k12_ool_76
k12_oolret_77:
    v_exp_f32 v240, v140
    v_mfma_f32_16x16x32_bf16 v[188:191], a[188:191], v[124:127], v[188:191]
    s_waitcnt vmcnt(8)
    s_barrier
    v_sub_f32 v142, v142, v55
    v_sub_f32 v143, v143, v55
    v_cvt_pk_bf16_f32 v203, v238, v239
    v_exp_f32 v241, v141
    v_exp_f32 v242, v142
    v_sub_f32 v156, v156, v55
    v_sub_f32 v157, v157, v55
    ds_read_b128 a[200:203], v3 offset:2048
    v_cvt_pk_bf16_f32 v204, v240, v241
    v_exp_f32 v243, v143
    v_or3_b32 v57, v57, v203, v204
    v_exp_f32 v244, v156
    v_sub_f32 v158, v158, v55
    v_sub_f32 v159, v159, v55
    v_cvt_pk_bf16_f32 v205, v242, v243
    v_exp_f32 v245, v157
    v_exp_f32 v246, v158
    v_cvt_pk_bf16_f32 v206, v244, v245
    ds_read_b128 a[204:207], v3 offset:3072
    v_exp_f32 v247, v159
    v_or3_b32 v57, v57, v205, v206
    v_cvt_pk_bf16_f32 v207, v246, v247
    v_bitop3_b32 v57, v57, v207, s37 bitop3:0xa8
    v_cmp_ne_u32 vcc, 0, v57
    s_cbranch_vccnz k2_tramp_80
k2_ret_81:
    s_mov_b32 s24, s60
    s_and_b32 s25, s61, 0xffff
    s_mov_b32 s26, s55
    s_lshl_b32 s63, s29, 1
    s_sub_u32 s63, s63, 1
    s_cbranch_scc1 k2_dm3_83
k2_dloop_82:
    v_mfma_f32_16x16x32_bf16 v[12:15], v[60:63], v[192:195], v[12:15]
    v_exp_f32 v232, v160
    v_mfma_f32_16x16x32_bf16 v[48:51], v[60:63], v[196:199], v[48:51]
    s_mov_b32 m0, s34
    ds_read_b128 a[208:211], v3 offset:4096
    v_mfma_f32_16x16x32_bf16 v[248:251], v[60:63], v[200:203], v[248:251]
    s_add_u32 s53, s53, 8192
    buffer_load_dwordx4 v1, s[16:19], s32 offen offset:0 sc1 lds
    v_mfma_f32_16x16x32_bf16 v[252:255], v[60:63], v[204:207], v[252:255]
    s_waitcnt lgkmcnt(3)
    v_exp_f32 v233, v161
    v_mfma_f32_16x16x32_bf16 a[0:3], a[192:195], v[192:195], a[0:3]
    s_and_b32 s53, s53, 0xffff
    v_exp_f32 v234, v162
    v_mfma_f32_16x16x32_bf16 a[4:7], a[192:195], v[196:199], a[4:7]
    s_add_u32 s34, s34, 0x4000
    ds_read_b128 a[212:215], v3 offset:5120
    v_cvt_pk_bf16_f32 v208, v232, v233
    v_mfma_f32_16x16x32_bf16 a[8:11], a[192:195], v[200:203], a[8:11]
    v_exp_f32 v235, v163
    v_mfma_f32_16x16x32_bf16 a[12:15], a[192:195], v[204:207], a[12:15]
    buffer_load_dwordx4 v1, s[16:19], s32 offen offset:1024 sc1 lds
    v_mfma_f32_16x16x32_bf16 a[16:19], a[196:199], v[192:195], a[16:19]
    v_exp_f32 v236, v176
    v_mfma_f32_16x16x32_bf16 a[20:23], a[196:199], v[196:199], a[20:23]
    ds_read_b128 a[216:219], v3 offset:6144
    v_cvt_pk_bf16_f32 v209, v234, v235
    v_mfma_f32_16x16x32_bf16 a[24:27], a[196:199], v[200:203], a[24:27]
    v_exp_f32 v237, v177
    v_mfma_f32_16x16x32_bf16 a[28:31], a[196:199], v[204:207], a[28:31]
    s_waitcnt lgkmcnt(3)
    v_exp_f32 v238, v178
    v_mfma_f32_16x16x32_bf16 a[32:35], a[200:203], v[192:195], a[32:35]
    s_and_b32 s34, s34, 0xffff
    ds_read_b128 a[220:223], v3 offset:7168
    v_cvt_pk_bf16_f32 v210, v236, v237
    v_mfma_f32_16x16x32_bf16 a[36:39], a[200:203], v[196:199], a[36:39]
    s_and_b32 s60, s62, 31
    buffer_load_dwordx4 v1, s[16:19], s32 offen offset:2048 sc1 lds
    v_mfma_f32_16x16x32_bf16 a[40:43], a[200:203], v[200:203], a[40:43]
    v_exp_f32 v239, v179
    v_mfma_f32_16x16x32_bf16 a[44:47], a[200:203], v[204:207], a[44:47]
    s_lshr_b32 s61, s62, 5
    v_or3_b32 v57, v208, v209, v210
    v_add_u32 v3, s53, v56
    v_mfma_f32_16x16x32_bf16 a[48:51], a[204:207], v[192:195], a[48:51]
    v_exp_f32 v240, v164
    v_mfma_f32_16x16x32_bf16 a[52:55], a[204:207], v[196:199], a[52:55]
    ds_read_b128 a[128:131], v2 offset:0
    v_cvt_pk_bf16_f32 v211, v238, v239
    v_mfma_f32_16x16x32_bf16 a[56:59], a[204:207], v[200:203], a[56:59]
    s_mul_i32 s57, s60, 229376
    v_exp_f32 v241, v165
    v_mfma_f32_16x16x32_bf16 a[60:63], a[204:207], v[204:207], a[60:63]
    s_waitcnt lgkmcnt(3)
    buffer_load_dwordx4 v1, s[16:19], s32 offen offset:3072 sc1 lds
    v_mfma_f32_16x16x32_bf16 a[64:67], a[208:211], v[192:195], a[64:67]
    s_add_u32 s32, s32, 0x80000
    v_exp_f32 v242, v166
    v_mfma_f32_16x16x32_bf16 a[68:71], a[208:211], v[196:199], a[68:71]
    s_lshl_b32 s4, s61, 7
    ds_read_b128 a[132:135], v2 offset:1024
    v_cvt_pk_bf16_f32 v212, v240, v241
    v_mfma_f32_16x16x32_bf16 a[72:75], a[208:211], v[200:203], a[72:75]
    v_exp_f32 v243, v167
    v_mfma_f32_16x16x32_bf16 a[76:79], a[208:211], v[204:207], a[76:79]
    s_add_u32 s57, s57, s4
    v_or3_b32 v57, v57, v211, v212
    v_cvt_pk_bf16_f32 v213, v242, v243
    v_mfma_f32_16x16x32_bf16 a[80:83], a[212:215], v[192:195], a[80:83]
    s_waitcnt vmcnt(8)
    v_exp_f32 v244, v180
    v_mfma_f32_16x16x32_bf16 a[84:87], a[212:215], v[196:199], a[84:87]
    buffer_store_dwordx4 a[224:227], v229, s[8:11], s58 offen offset:0 sc1
    ds_read_b128 a[136:139], v2 offset:2048
    v_mfma_f32_16x16x32_bf16 a[88:91], a[212:215], v[200:203], a[88:91]
    s_add_u32 s56, s57, 57344
    v_exp_f32 v245, v181
    v_mfma_f32_16x16x32_bf16 a[92:95], a[212:215], v[204:207], a[92:95]
    s_waitcnt lgkmcnt(3)
    v_exp_f32 v246, v182
    v_mfma_f32_16x16x32_bf16 a[96:99], a[216:219], v[192:195], a[96:99]
    ds_read_b128 a[140:143], v2 offset:3072
    v_cvt_pk_bf16_f32 v214, v244, v245
    v_mfma_f32_16x16x32_bf16 a[100:103], a[216:219], v[196:199], a[100:103]
    s_add_u32 s62, s62, 1
    v_exp_f32 v247, v183
    v_mfma_f32_16x16x32_bf16 a[104:107], a[216:219], v[200:203], a[104:107]
    v_or3_b32 v57, v57, v213, v214
    v_mfma_f32_16x16x32_bf16 a[108:111], a[216:219], v[204:207], a[108:111]
    v_exp_f32 v232, v168
    v_mfma_f32_16x16x32_bf16 a[112:115], a[220:223], v[192:195], a[112:115]
    ds_read_b128 a[144:147], v2 offset:4096
    v_cvt_pk_bf16_f32 v215, v246, v247
    v_mfma_f32_16x16x32_bf16 a[116:119], a[220:223], v[196:199], a[116:119]
    buffer_store_dwordx4 a[228:231], v229, s[8:11], s58 offen offset:256 sc1
    v_mfma_f32_16x16x32_bf16 a[120:123], a[220:223], v[200:203], a[120:123]
    v_exp_f32 v233, v169
    v_mfma_f32_16x16x32_bf16 a[124:127], a[220:223], v[204:207], a[124:127]
    s_waitcnt lgkmcnt(3)
    v_exp_f32 v234, v170
    v_mfma_f32_16x16x32_bf16 v[128:131], a[128:131], v[64:67], v[16:19]
    ds_read_b128 a[148:151], v2 offset:5120
    v_cvt_pk_bf16_f32 v216, v232, v233
    v_mfma_f32_16x16x32_bf16 v[132:135], a[128:131], v[80:83], v[20:23]
    v_exp_f32 v235, v171
    v_mfma_f32_16x16x32_bf16 v[136:139], a[128:131], v[96:99], v[24:27]
    v_or3_b32 v57, v57, v215, v216
    v_mfma_f32_16x16x32_bf16 v[140:143], a[128:131], v[112:115], v[28:31]
    s_add_u32 s36, s36, 32
    v_exp_f32 v236, v184
    v_mfma_f32_16x16x32_bf16 v[128:131], a[132:135], v[68:71], v[128:131]
    ds_read_b128 a[152:155], v2 offset:6144
    v_cvt_pk_bf16_f32 v217, v234, v235
    v_mfma_f32_16x16x32_bf16 v[132:135], a[132:135], v[84:87], v[132:135]
    s_lshl_b32 s58, s61, 17
    buffer_load_dwordx4 a[224:227], v228, s[12:15], s57 offen
    v_mfma_f32_16x16x32_bf16 v[136:139], a[132:135], v[100:103], v[136:139]
    s_add_u32 s52, s52, 8192
    v_exp_f32 v237, v185
    v_mfma_f32_16x16x32_bf16 v[140:143], a[132:135], v[116:119], v[140:143]
    s_waitcnt lgkmcnt(3)
    v_exp_f32 v238, v186
    v_mfma_f32_16x16x32_bf16 v[128:131], a[136:139], v[72:75], v[128:131]
    s_lshl_b32 s60, s60, 10
    ds_read_b128 a[156:159], v2 offset:7168
    v_cvt_pk_bf16_f32 v218, v236, v237
    v_mfma_f32_16x16x32_bf16 v[132:135], a[136:139], v[88:91], v[132:135]
    s_and_b32 s52, s52, 0xffff
    v_exp_f32 v239, v187
    v_mfma_f32_16x16x32_bf16 v[136:139], a[136:139], v[104:107], v[136:139]
    v_or3_b32 v57, v57, v217, v218
    v_mfma_f32_16x16x32_bf16 v[140:143], a[136:139], v[120:123], v[140:143]
    v_add_u32 v2, s52, v1
    v_cvt_pk_bf16_f32 v219, v238, v239
    v_mfma_f32_16x16x32_bf16 v[128:131], a[140:143], v[76:79], v[128:131]
    s_add_u32 s58, s58, s60
    v_exp_f32 v240, v172
    v_mfma_f32_16x16x32_bf16 v[132:135], a[140:143], v[92:95], v[132:135]
    buffer_load_dwordx4 a[228:231], v228, s[12:15], s56 offen
    v_mfma_f32_16x16x32_bf16 v[136:139], a[140:143], v[108:111], v[136:139]
    v_exp_f32 v241, v173
    v_mfma_f32_16x16x32_bf16 v[140:143], a[140:143], v[124:127], v[140:143]
    s_waitcnt lgkmcnt(2)
    ds_read_b128 a[192:195], v3 offset:0
    v_cvt_pk_bf16_f32 v220, v240, v241
    v_mfma_f32_16x16x32_bf16 v[144:147], a[144:147], v[64:67], v[32:35]
    s_mov_b32 s10, s59
    v_exp_f32 v242, v174
    v_mfma_f32_16x16x32_bf16 v[148:151], a[144:147], v[80:83], v[36:39]
    v_exp_f32 v243, v175
    v_mfma_f32_16x16x32_bf16 v[152:155], a[144:147], v[96:99], v[40:43]
    ds_read_b128 a[196:199], v3 offset:1024
    v_or3_b32 v57, v57, v219, v220
    v_mfma_f32_16x16x32_bf16 v[156:159], a[144:147], v[112:115], v[44:47]
    v_exp_f32 v244, v188
    v_mfma_f32_16x16x32_bf16 v[144:147], a[148:151], v[68:71], v[144:147]
    v_cvt_pk_bf16_f32 v221, v242, v243
    v_mfma_f32_16x16x32_bf16 v[148:151], a[148:151], v[84:87], v[148:151]
    buffer_load_dword v7, v230, s[24:27], s54 offen
    v_mfma_f32_16x16x32_bf16 v[152:155], a[148:151], v[100:103], v[152:155]
    v_exp_f32 v245, v189
    v_mfma_f32_16x16x32_bf16 v[156:159], a[148:151], v[116:119], v[156:159]
    s_waitcnt lgkmcnt(2)
    ds_read_b128 a[200:203], v3 offset:2048
    v_cvt_pk_bf16_f32 v222, v244, v245
    v_mfma_f32_16x16x32_bf16 v[144:147], a[152:155], v[72:75], v[144:147]
    v_exp_f32 v246, v190
    v_mfma_f32_16x16x32_bf16 v[148:151], a[152:155], v[88:91], v[148:151]
    v_exp_f32 v247, v191
    v_mfma_f32_16x16x32_bf16 v[152:155], a[152:155], v[104:107], v[152:155]
    ds_read_b128 a[204:207], v3 offset:3072
    v_or3_b32 v57, v57, v221, v222
    v_mfma_f32_16x16x32_bf16 v[156:159], a[152:155], v[120:123], v[156:159]
    v_cvt_pk_bf16_f32 v223, v246, v247
    v_mfma_f32_16x16x32_bf16 v[144:147], a[156:159], v[76:79], v[144:147]
    s_add_u32 s54, s54, 4096
    v_mfma_f32_16x16x32_bf16 v[148:151], a[156:159], v[92:95], v[148:151]
    v_bitop3_b32 v57, v57, v223, s37 bitop3:0xa8
    v_cmp_ne_u32 vcc, 0, v57
    v_mfma_f32_16x16x32_bf16 v[152:155], a[156:159], v[108:111], v[152:155]
    v_mfma_f32_16x16x32_bf16 v[156:159], a[156:159], v[124:127], v[156:159]
    s_cbranch_vccnz k2_tramp_84
k2_ret_85:
    v_mfma_f32_16x16x32_bf16 v[12:15], v[60:63], v[208:211], v[12:15]
    v_exp_f32 v232, v128
    v_mfma_f32_16x16x32_bf16 v[48:51], v[60:63], v[212:215], v[48:51]
    s_mov_b32 m0, s35
    ds_read_b128 a[208:211], v3 offset:4096
    v_mfma_f32_16x16x32_bf16 v[248:251], v[60:63], v[216:219], v[248:251]
    s_add_u32 s53, s53, 8192
    buffer_load_dwordx4 v1, s[20:23], s33 offen offset:0 sc1 lds
    v_mfma_f32_16x16x32_bf16 v[252:255], v[60:63], v[220:223], v[252:255]
    s_waitcnt lgkmcnt(3)
    v_exp_f32 v233, v129
    v_mfma_f32_16x16x32_bf16 a[0:3], a[192:195], v[208:211], a[0:3]
    s_and_b32 s53, s53, 0xffff
    v_exp_f32 v234, v130
    v_mfma_f32_16x16x32_bf16 a[4:7], a[192:195], v[212:215], a[4:7]
    ds_read_b128 a[212:215], v3 offset:5120
    v_cvt_pk_bf16_f32 v192, v232, v233
    v_mfma_f32_16x16x32_bf16 a[8:11], a[192:195], v[216:219], a[8:11]
    v_exp_f32 v235, v131
    v_mfma_f32_16x16x32_bf16 a[12:15], a[192:195], v[220:223], a[12:15]
    v_exp_f32 v236, v144
    v_mfma_f32_16x16x32_bf16 a[16:19], a[196:199], v[208:211], a[16:19]
    ds_read_b128 a[216:219], v3 offset:6144
    v_cvt_pk_bf16_f32 v193, v234, v235
    v_mfma_f32_16x16x32_bf16 a[20:23], a[196:199], v[212:215], a[20:23]
    v_exp_f32 v237, v145
    v_mfma_f32_16x16x32_bf16 a[24:27], a[196:199], v[216:219], a[24:27]
    v_mfma_f32_16x16x32_bf16 a[28:31], a[196:199], v[220:223], a[28:31]
    s_waitcnt lgkmcnt(3)
    v_exp_f32 v238, v146
    v_mfma_f32_16x16x32_bf16 a[32:35], a[200:203], v[208:211], a[32:35]
    ds_read_b128 a[220:223], v3 offset:7168
    v_cvt_pk_bf16_f32 v194, v236, v237
    v_mfma_f32_16x16x32_bf16 a[36:39], a[200:203], v[212:215], a[36:39]
    v_exp_f32 v239, v147
    v_mfma_f32_16x16x32_bf16 a[40:43], a[200:203], v[216:219], a[40:43]
    v_or3_b32 v57, v192, v193, v194
    v_mfma_f32_16x16x32_bf16 a[44:47], a[200:203], v[220:223], a[44:47]
    s_add_u32 s35, s35, 0x4000
    v_add_u32 v3, s53, v56
    v_cvt_pk_bf16_f32 v195, v238, v239
    v_mfma_f32_16x16x32_bf16 a[48:51], a[204:207], v[208:211], a[48:51]
    v_exp_f32 v240, v132
    v_mfma_f32_16x16x32_bf16 a[52:55], a[204:207], v[212:215], a[52:55]
    buffer_load_dwordx4 v1, s[20:23], s33 offen offset:1024 sc1 lds
    ds_read_b128 a[128:131], v2 offset:0
    v_mfma_f32_16x16x32_bf16 a[56:59], a[204:207], v[216:219], a[56:59]
    v_exp_f32 v241, v133
    v_mfma_f32_16x16x32_bf16 a[60:63], a[204:207], v[220:223], a[60:63]
    s_waitcnt lgkmcnt(3)
    v_exp_f32 v242, v134
    v_mfma_f32_16x16x32_bf16 a[64:67], a[208:211], v[208:211], a[64:67]
    ds_read_b128 a[132:135], v2 offset:1024
    v_cvt_pk_bf16_f32 v196, v240, v241
    v_mfma_f32_16x16x32_bf16 a[68:71], a[208:211], v[212:215], a[68:71]
    v_exp_f32 v243, v135
    v_mfma_f32_16x16x32_bf16 a[72:75], a[208:211], v[216:219], a[72:75]
    v_or3_b32 v57, v57, v195, v196
    v_mfma_f32_16x16x32_bf16 a[76:79], a[208:211], v[220:223], a[76:79]
    v_exp_f32 v244, v148
    v_mfma_f32_16x16x32_bf16 a[80:83], a[212:215], v[208:211], a[80:83]
    ds_read_b128 a[136:139], v2 offset:2048
    v_cvt_pk_bf16_f32 v197, v242, v243
    v_mfma_f32_16x16x32_bf16 a[84:87], a[212:215], v[212:215], a[84:87]
    v_exp_f32 v245, v149
    v_mfma_f32_16x16x32_bf16 a[88:91], a[212:215], v[216:219], a[88:91]
    v_mfma_f32_16x16x32_bf16 a[92:95], a[212:215], v[220:223], a[92:95]
    s_waitcnt lgkmcnt(3)
    v_exp_f32 v246, v150
    v_mfma_f32_16x16x32_bf16 a[96:99], a[216:219], v[208:211], a[96:99]
    ds_read_b128 a[140:143], v2 offset:3072
    v_cvt_pk_bf16_f32 v198, v244, v245
    v_mfma_f32_16x16x32_bf16 a[100:103], a[216:219], v[212:215], a[100:103]
    v_exp_f32 v247, v151
    v_mfma_f32_16x16x32_bf16 a[104:107], a[216:219], v[216:219], a[104:107]
    v_or3_b32 v57, v57, v197, v198
    v_mfma_f32_16x16x32_bf16 a[108:111], a[216:219], v[220:223], a[108:111]
    s_and_b32 s35, s35, 0xffff
    v_exp_f32 v232, v136
    v_mfma_f32_16x16x32_bf16 a[112:115], a[220:223], v[208:211], a[112:115]
    ds_read_b128 a[144:147], v2 offset:4096
    v_cvt_pk_bf16_f32 v199, v246, v247
    v_mfma_f32_16x16x32_bf16 a[116:119], a[220:223], v[212:215], a[116:119]
    buffer_load_dwordx4 v1, s[20:23], s33 offen offset:2048 sc1 lds
    v_mfma_f32_16x16x32_bf16 a[120:123], a[220:223], v[216:219], a[120:123]
    v_exp_f32 v233, v137
    v_mfma_f32_16x16x32_bf16 a[124:127], a[220:223], v[220:223], a[124:127]
    s_waitcnt lgkmcnt(3)
    v_exp_f32 v234, v138
    v_mfma_f32_16x16x32_bf16 v[160:163], a[128:131], v[64:67], v[16:19]
    ds_read_b128 a[148:151], v2 offset:5120
    v_cvt_pk_bf16_f32 v200, v232, v233
    v_mfma_f32_16x16x32_bf16 v[164:167], a[128:131], v[80:83], v[20:23]
    v_exp_f32 v235, v139
    v_mfma_f32_16x16x32_bf16 v[168:171], a[128:131], v[96:99], v[24:27]
    v_or3_b32 v57, v57, v199, v200
    v_mfma_f32_16x16x32_bf16 v[172:175], a[128:131], v[112:115], v[28:31]
    s_or_b32 s35, s35, 0x10000
    v_exp_f32 v236, v152
    v_mfma_f32_16x16x32_bf16 v[160:163], a[132:135], v[68:71], v[160:163]
    s_add_u32 s36, s36, 32
    ds_read_b128 a[152:155], v2 offset:6144
    v_cvt_pk_bf16_f32 v201, v234, v235
    v_mfma_f32_16x16x32_bf16 v[164:167], a[132:135], v[84:87], v[164:167]
    v_exp_f32 v237, v153
    v_mfma_f32_16x16x32_bf16 v[168:171], a[132:135], v[100:103], v[168:171]
    s_add_u32 s52, s52, 8192
    v_mfma_f32_16x16x32_bf16 v[172:175], a[132:135], v[116:119], v[172:175]
    s_waitcnt lgkmcnt(3)
    v_exp_f32 v238, v154
    v_mfma_f32_16x16x32_bf16 v[160:163], a[136:139], v[72:75], v[160:163]
    s_and_b32 s52, s52, 0xffff
    ds_read_b128 a[156:159], v2 offset:7168
    v_cvt_pk_bf16_f32 v202, v236, v237
    v_mfma_f32_16x16x32_bf16 v[164:167], a[136:139], v[88:91], v[164:167]
    v_exp_f32 v239, v155
    v_mfma_f32_16x16x32_bf16 v[168:171], a[136:139], v[104:107], v[168:171]
    v_or3_b32 v57, v57, v201, v202
    v_mfma_f32_16x16x32_bf16 v[172:175], a[136:139], v[120:123], v[172:175]
    v_add_u32 v2, s52, v1
    v_cvt_pk_bf16_f32 v203, v238, v239
    v_mfma_f32_16x16x32_bf16 v[160:163], a[140:143], v[76:79], v[160:163]
    v_exp_f32 v240, v140
    v_mfma_f32_16x16x32_bf16 v[164:167], a[140:143], v[92:95], v[164:167]
    buffer_load_dwordx4 v1, s[20:23], s33 offen offset:3072 sc1 lds
    v_mfma_f32_16x16x32_bf16 v[168:171], a[140:143], v[108:111], v[168:171]
    s_add_u32 s33, s33, 0x80000
    v_exp_f32 v241, v141
    v_mfma_f32_16x16x32_bf16 v[172:175], a[140:143], v[124:127], v[172:175]
    s_waitcnt lgkmcnt(2)
    ds_read_b128 a[192:195], v3 offset:0
    v_cvt_pk_bf16_f32 v204, v240, v241
    v_mfma_f32_16x16x32_bf16 v[176:179], a[144:147], v[64:67], v[32:35]
    v_exp_f32 v242, v142
    v_mfma_f32_16x16x32_bf16 v[180:183], a[144:147], v[80:83], v[36:39]
    v_exp_f32 v243, v143
    v_mfma_f32_16x16x32_bf16 v[184:187], a[144:147], v[96:99], v[40:43]
    ds_read_b128 a[196:199], v3 offset:1024
    v_or3_b32 v57, v57, v203, v204
    v_mfma_f32_16x16x32_bf16 v[188:191], a[144:147], v[112:115], v[44:47]
    v_exp_f32 v244, v156
    v_mfma_f32_16x16x32_bf16 v[176:179], a[148:151], v[68:71], v[176:179]
    v_cvt_pk_bf16_f32 v205, v242, v243
    v_mfma_f32_16x16x32_bf16 v[180:183], a[148:151], v[84:87], v[180:183]
    v_exp_f32 v245, v157
    v_mfma_f32_16x16x32_bf16 v[184:187], a[148:151], v[100:103], v[184:187]
    ds_read_b128 a[200:203], v3 offset:2048
    v_mfma_f32_16x16x32_bf16 v[188:191], a[148:151], v[116:119], v[188:191]
    s_waitcnt lgkmcnt(3)
    v_exp_f32 v246, v158
    v_mfma_f32_16x16x32_bf16 v[176:179], a[152:155], v[72:75], v[176:179]
    s_sub_u32 s63, s63, 1
    v_cvt_pk_bf16_f32 v206, v244, v245
    v_mfma_f32_16x16x32_bf16 v[180:183], a[152:155], v[88:91], v[180:183]
    v_exp_f32 v247, v159
    v_mfma_f32_16x16x32_bf16 v[184:187], a[152:155], v[104:107], v[184:187]
    ds_read_b128 a[204:207], v3 offset:3072
    v_or3_b32 v57, v57, v205, v206
    v_mfma_f32_16x16x32_bf16 v[188:191], a[152:155], v[120:123], v[188:191]
    v_cvt_pk_bf16_f32 v207, v246, v247
    v_mfma_f32_16x16x32_bf16 v[176:179], a[156:159], v[76:79], v[176:179]
    v_mfma_f32_16x16x32_bf16 v[180:183], a[156:159], v[92:95], v[180:183]
    v_bitop3_b32 v57, v57, v207, s37 bitop3:0xa8
    v_cmp_ne_u32 vcc, 0, v57
    v_mfma_f32_16x16x32_bf16 v[184:187], a[156:159], v[108:111], v[184:187]
    v_mfma_f32_16x16x32_bf16 v[188:191], a[156:159], v[124:127], v[188:191]
    s_waitcnt vmcnt(13)
    s_barrier
    s_cbranch_vccnz k2_tramp_86
k2_ret_87:
    s_cmp_lg_u32 s63, 0
    s_cbranch_scc1 k2_dloop_82
    v_mfma_f32_16x16x32_bf16 v[12:15], v[60:63], v[192:195], v[12:15]
    v_exp_f32 v232, v160
    v_mfma_f32_16x16x32_bf16 v[48:51], v[60:63], v[196:199], v[48:51]
    s_mov_b32 m0, s34
    ds_read_b128 a[208:211], v3 offset:4096
    v_mfma_f32_16x16x32_bf16 v[248:251], v[60:63], v[200:203], v[248:251]
    s_add_u32 s53, s53, 8192
    buffer_load_dwordx4 v1, s[16:19], s32 offen offset:0 sc1 lds
    v_mfma_f32_16x16x32_bf16 v[252:255], v[60:63], v[204:207], v[252:255]
    s_waitcnt lgkmcnt(3)
    v_exp_f32 v233, v161
    v_mfma_f32_16x16x32_bf16 a[0:3], a[192:195], v[192:195], a[0:3]
    s_sub_u32 s40, s36, s38
    v_exp_f32 v234, v162
    v_mfma_f32_16x16x32_bf16 a[4:7], a[192:195], v[196:199], a[4:7]
    s_and_b32 s53, s53, 0xffff
    ds_read_b128 a[212:215], v3 offset:5120
    v_cvt_pk_bf16_f32 v208, v232, v233
    v_mfma_f32_16x16x32_bf16 a[8:11], a[192:195], v[200:203], a[8:11]
    s_add_u32 s34, s34, 0x4000
    v_subrev_u32 v6, s40, v4
    v_cmp_gt_i32 s[44:45], 0, v6
    v_mfma_f32_16x16x32_bf16 a[12:15], a[192:195], v[204:207], a[12:15]
    v_exp_f32 v235, v163
    v_mfma_f32_16x16x32_bf16 a[16:19], a[196:199], v[192:195], a[16:19]
    buffer_load_dwordx4 v1, s[16:19], s32 offen offset:1024 sc1 lds
    ds_read_b128 a[216:219], v3 offset:6144
    v_mfma_f32_16x16x32_bf16 a[20:23], a[196:199], v[196:199], a[20:23]
    v_exp_f32 v236, v176
    v_mfma_f32_16x16x32_bf16 a[24:27], a[196:199], v[200:203], a[24:27]
    v_cmp_gt_i32 s[46:47], 1, v6
    v_cvt_pk_bf16_f32 v209, v234, v235
    v_mfma_f32_16x16x32_bf16 a[28:31], a[196:199], v[204:207], a[28:31]
    s_waitcnt lgkmcnt(3)
    v_cmp_gt_i32 s[48:49], 2, v6
    v_cmp_gt_i32 s[50:51], 3, v6
    v_mfma_f32_16x16x32_bf16 a[32:35], a[200:203], v[192:195], a[32:35]
    s_and_b32 s34, s34, 0xffff
    v_exp_f32 v237, v177
    v_mfma_f32_16x16x32_bf16 a[36:39], a[200:203], v[196:199], a[36:39]
    s_and_b32 s60, s62, 31
    v_exp_f32 v238, v178
    v_mfma_f32_16x16x32_bf16 a[40:43], a[200:203], v[200:203], a[40:43]
    ds_read_b128 a[220:223], v3 offset:7168
    v_cvt_pk_bf16_f32 v210, v236, v237
    v_mfma_f32_16x16x32_bf16 a[44:47], a[200:203], v[204:207], a[44:47]
    s_lshr_b32 s61, s62, 5
    buffer_load_dwordx4 v1, s[16:19], s32 offen offset:2048 sc1 lds
    v_mfma_f32_16x16x32_bf16 a[48:51], a[204:207], v[192:195], a[48:51]
    v_cndmask_b32 v16, v8, v5, s[44:45]
    v_or3_b32 v57, v208, v209, v210
    v_mfma_f32_16x16x32_bf16 a[52:55], a[204:207], v[196:199], a[52:55]
    v_exp_f32 v239, v179
    v_mfma_f32_16x16x32_bf16 a[56:59], a[204:207], v[200:203], a[56:59]
    s_mul_i32 s57, s60, 229376
    v_cndmask_b32 v17, v8, v5, s[46:47]
    v_add_u32 v3, s53, v56
    v_mfma_f32_16x16x32_bf16 a[60:63], a[204:207], v[204:207], a[60:63]
    s_waitcnt lgkmcnt(2)
    v_exp_f32 v240, v164
    v_mfma_f32_16x16x32_bf16 a[64:67], a[208:211], v[192:195], a[64:67]
    v_cvt_pk_bf16_f32 v211, v238, v239
    v_cndmask_b32 v18, v8, v5, s[48:49]
    v_mfma_f32_16x16x32_bf16 a[68:71], a[208:211], v[196:199], a[68:71]
    s_lshl_b32 s4, s61, 7
    ds_read_b128 a[128:131], v2 offset:0
    v_cndmask_b32 v19, v8, v5, s[50:51]
    v_mfma_f32_16x16x32_bf16 a[72:75], a[208:211], v[200:203], a[72:75]
    v_exp_f32 v241, v165
    v_mfma_f32_16x16x32_bf16 a[76:79], a[208:211], v[204:207], a[76:79]
    s_add_u32 s57, s57, s4
    buffer_load_dwordx4 v1, s[16:19], s32 offen offset:3072 sc1 lds
    s_add_u32 s32, s32, 0x80000
    v_mfma_f32_16x16x32_bf16 a[80:83], a[212:215], v[192:195], a[80:83]
    s_waitcnt vmcnt(8)
    v_cmp_gt_i32 s[44:45], 16, v6
    v_exp_f32 v242, v166
    v_mfma_f32_16x16x32_bf16 a[84:87], a[212:215], v[196:199], a[84:87]
    ds_read_b128 a[132:135], v2 offset:1024
    v_cvt_pk_bf16_f32 v212, v240, v241
    v_mfma_f32_16x16x32_bf16 a[88:91], a[212:215], v[200:203], a[88:91]
    s_add_u32 s56, s57, 57344
    v_cmp_gt_i32 s[46:47], 17, v6
    v_exp_f32 v243, v167
    v_mfma_f32_16x16x32_bf16 a[92:95], a[212:215], v[204:207], a[92:95]
    s_waitcnt lgkmcnt(2)
    v_or3_b32 v57, v57, v211, v212
    v_cmp_gt_i32 s[48:49], 18, v6
    v_mfma_f32_16x16x32_bf16 a[96:99], a[216:219], v[192:195], a[96:99]
    v_exp_f32 v244, v180
    v_mfma_f32_16x16x32_bf16 a[100:103], a[216:219], v[196:199], a[100:103]
    s_add_u32 s62, s62, 1
    v_cvt_pk_bf16_f32 v213, v242, v243
    v_cmp_gt_i32 s[50:51], 19, v6
    v_mfma_f32_16x16x32_bf16 a[104:107], a[216:219], v[200:203], a[104:107]
    buffer_store_dwordx4 a[224:227], v229, s[8:11], s58 offen offset:0 sc1
    ds_read_b128 a[136:139], v2 offset:2048
    v_mfma_f32_16x16x32_bf16 a[108:111], a[216:219], v[204:207], a[108:111]
    v_exp_f32 v245, v181
    v_mfma_f32_16x16x32_bf16 a[112:115], a[220:223], v[192:195], a[112:115]
    v_cndmask_b32 v32, v8, v5, s[44:45]
    v_exp_f32 v246, v182
    v_mfma_f32_16x16x32_bf16 a[116:119], a[220:223], v[196:199], a[116:119]
    ds_read_b128 a[140:143], v2 offset:3072
    v_cndmask_b32 v33, v8, v5, s[46:47]
    v_cvt_pk_bf16_f32 v214, v244, v245
    v_cndmask_b32 v34, v8, v5, s[48:49]
    v_cndmask_b32 v35, v8, v5, s[50:51]
    v_mfma_f32_16x16x32_bf16 a[120:123], a[220:223], v[200:203], a[120:123]
    v_exp_f32 v247, v183
    v_mfma_f32_16x16x32_bf16 a[124:127], a[220:223], v[204:207], a[124:127]
    s_waitcnt lgkmcnt(2)
    v_or3_b32 v57, v57, v213, v214
    v_cvt_pk_bf16_f32 v215, v246, v247
    v_mfma_f32_16x16x32_bf16 v[128:131], a[128:131], v[64:67], v[16:19]
    v_exp_f32 v232, v168
    v_mfma_f32_16x16x32_bf16 v[132:135], a[128:131], v[80:83], v[20:23]
    buffer_store_dwordx4 a[228:231], v229, s[8:11], s58 offen offset:256 sc1
    ds_read_b128 a[144:147], v2 offset:4096
    v_mfma_f32_16x16x32_bf16 v[136:139], a[128:131], v[96:99], v[24:27]
    v_exp_f32 v233, v169
    v_mfma_f32_16x16x32_bf16 v[140:143], a[128:131], v[112:115], v[28:31]
    s_add_u32 s36, s36, 32
    v_exp_f32 v234, v170
    v_mfma_f32_16x16x32_bf16 v[128:131], a[132:135], v[68:71], v[128:131]
    ds_read_b128 a[148:151], v2 offset:5120
    v_cvt_pk_bf16_f32 v216, v232, v233
    v_mfma_f32_16x16x32_bf16 v[132:135], a[132:135], v[84:87], v[132:135]
    s_lshl_b32 s58, s61, 17
    v_exp_f32 v235, v171
    v_mfma_f32_16x16x32_bf16 v[136:139], a[132:135], v[100:103], v[136:139]
    s_add_u32 s52, s52, 8192
    v_or3_b32 v57, v57, v215, v216
    v_cvt_pk_bf16_f32 v217, v234, v235
    v_mfma_f32_16x16x32_bf16 v[140:143], a[132:135], v[116:119], v[140:143]
    s_waitcnt lgkmcnt(2)
    v_exp_f32 v236, v184
    v_mfma_f32_16x16x32_bf16 v[128:131], a[136:139], v[72:75], v[128:131]
    s_lshl_b32 s60, s60, 10
    buffer_load_dwordx4 a[224:227], v228, s[12:15], s57 offen
    ds_read_b128 a[152:155], v2 offset:6144
    v_mfma_f32_16x16x32_bf16 v[132:135], a[136:139], v[88:91], v[132:135]
    s_and_b32 s52, s52, 0xffff
    v_exp_f32 v237, v185
    v_mfma_f32_16x16x32_bf16 v[136:139], a[136:139], v[104:107], v[136:139]
    v_exp_f32 v238, v186
    v_mfma_f32_16x16x32_bf16 v[140:143], a[136:139], v[120:123], v[140:143]
    ds_read_b128 a[156:159], v2 offset:7168
    v_cvt_pk_bf16_f32 v218, v236, v237
    v_mfma_f32_16x16x32_bf16 v[128:131], a[140:143], v[76:79], v[128:131]
    s_add_u32 s58, s58, s60
    v_exp_f32 v239, v187
    v_mfma_f32_16x16x32_bf16 v[132:135], a[140:143], v[92:95], v[132:135]
    v_or3_b32 v57, v57, v217, v218
    v_add_u32 v2, s52, v1
    v_mfma_f32_16x16x32_bf16 v[136:139], a[140:143], v[108:111], v[136:139]
    v_exp_f32 v240, v172
    v_mfma_f32_16x16x32_bf16 v[140:143], a[140:143], v[124:127], v[140:143]
    s_waitcnt lgkmcnt(2)
    ds_read_b128 a[192:195], v3 offset:0
    v_cvt_pk_bf16_f32 v219, v238, v239
    v_mfma_f32_16x16x32_bf16 v[144:147], a[144:147], v[64:67], v[32:35]
    s_mov_b32 s10, s59
    buffer_load_dwordx4 a[228:231], v228, s[12:15], s56 offen
    v_mfma_f32_16x16x32_bf16 v[148:151], a[144:147], v[80:83], v[36:39]
    v_exp_f32 v241, v173
    v_mfma_f32_16x16x32_bf16 v[152:155], a[144:147], v[96:99], v[40:43]
    v_exp_f32 v242, v174
    v_mfma_f32_16x16x32_bf16 v[156:159], a[144:147], v[112:115], v[44:47]
    v_cvt_pk_bf16_f32 v220, v240, v241
    v_or3_b32 v57, v57, v219, v220
    v_mfma_f32_16x16x32_bf16 v[144:147], a[148:151], v[68:71], v[144:147]
    v_exp_f32 v243, v175
    v_mfma_f32_16x16x32_bf16 v[148:151], a[148:151], v[84:87], v[148:151]
    ds_read_b128 a[196:199], v3 offset:1024
    v_cvt_pk_bf16_f32 v221, v242, v243
    v_mfma_f32_16x16x32_bf16 v[152:155], a[148:151], v[100:103], v[152:155]
    v_exp_f32 v244, v188
    v_mfma_f32_16x16x32_bf16 v[156:159], a[148:151], v[116:119], v[156:159]
    s_waitcnt lgkmcnt(2)
    buffer_load_dword v7, v230, s[24:27], s54 offen
    ds_read_b128 a[200:203], v3 offset:2048
    v_mfma_f32_16x16x32_bf16 v[144:147], a[152:155], v[72:75], v[144:147]
    v_exp_f32 v245, v189
    v_mfma_f32_16x16x32_bf16 v[148:151], a[152:155], v[88:91], v[148:151]
    v_exp_f32 v246, v190
    v_mfma_f32_16x16x32_bf16 v[152:155], a[152:155], v[104:107], v[152:155]
    v_cvt_pk_bf16_f32 v222, v244, v245
    v_or3_b32 v57, v57, v221, v222
    v_mfma_f32_16x16x32_bf16 v[156:159], a[152:155], v[120:123], v[156:159]
    v_exp_f32 v247, v191
    v_mfma_f32_16x16x32_bf16 v[144:147], a[156:159], v[76:79], v[144:147]
    s_add_u32 s54, s54, 4096
    ds_read_b128 a[204:207], v3 offset:3072
    v_cvt_pk_bf16_f32 v223, v246, v247
    v_mfma_f32_16x16x32_bf16 v[148:151], a[156:159], v[92:95], v[148:151]
    v_bitop3_b32 v57, v57, v223, s37 bitop3:0xa8
    v_cmp_ne_u32 vcc, 0, v57
    v_mfma_f32_16x16x32_bf16 v[152:155], a[156:159], v[108:111], v[152:155]
    v_mfma_f32_16x16x32_bf16 v[156:159], a[156:159], v[124:127], v[156:159]
    s_cbranch_vccnz k2_tramp_88
k2_ret_89:
    v_mfma_f32_16x16x32_bf16 v[12:15], v[60:63], v[208:211], v[12:15]
    v_exp_f32 v232, v128
    v_mfma_f32_16x16x32_bf16 v[48:51], v[60:63], v[212:215], v[48:51]
    s_mov_b32 m0, s35
    ds_read_b128 a[208:211], v3 offset:4096
    v_mfma_f32_16x16x32_bf16 v[248:251], v[60:63], v[216:219], v[248:251]
    s_add_u32 s53, s53, 8192
    buffer_load_dwordx4 v1, s[20:23], s33 offen offset:0 sc1 lds
    v_mfma_f32_16x16x32_bf16 v[252:255], v[60:63], v[220:223], v[252:255]
    s_waitcnt lgkmcnt(3)
    v_exp_f32 v233, v129
    v_mfma_f32_16x16x32_bf16 a[0:3], a[192:195], v[208:211], a[0:3]
    s_sub_u32 s40, s36, s38
    v_exp_f32 v234, v130
    v_mfma_f32_16x16x32_bf16 a[4:7], a[192:195], v[212:215], a[4:7]
    s_and_b32 s53, s53, 0xffff
    ds_read_b128 a[212:215], v3 offset:5120
    v_cvt_pk_bf16_f32 v192, v232, v233
    v_mfma_f32_16x16x32_bf16 a[8:11], a[192:195], v[216:219], a[8:11]
    v_subrev_u32 v6, s40, v4
    v_cmp_gt_i32 s[44:45], 0, v6
    v_mfma_f32_16x16x32_bf16 a[12:15], a[192:195], v[220:223], a[12:15]
    v_exp_f32 v235, v131
    v_mfma_f32_16x16x32_bf16 a[16:19], a[196:199], v[208:211], a[16:19]
    v_exp_f32 v236, v144
    v_mfma_f32_16x16x32_bf16 a[20:23], a[196:199], v[212:215], a[20:23]
    v_cmp_gt_i32 s[46:47], 1, v6
    v_cvt_pk_bf16_f32 v193, v234, v235
    v_mfma_f32_16x16x32_bf16 a[24:27], a[196:199], v[216:219], a[24:27]
    ds_read_b128 a[216:219], v3 offset:6144
    v_cmp_gt_i32 s[48:49], 2, v6
    v_mfma_f32_16x16x32_bf16 a[28:31], a[196:199], v[220:223], a[28:31]
    s_waitcnt lgkmcnt(3)
    v_exp_f32 v237, v145
    v_mfma_f32_16x16x32_bf16 a[32:35], a[200:203], v[208:211], a[32:35]
    v_cmp_gt_i32 s[50:51], 3, v6
    v_cvt_pk_bf16_f32 v194, v236, v237
    v_mfma_f32_16x16x32_bf16 a[36:39], a[200:203], v[212:215], a[36:39]
    v_exp_f32 v238, v146
    v_mfma_f32_16x16x32_bf16 a[40:43], a[200:203], v[216:219], a[40:43]
    ds_read_b128 a[220:223], v3 offset:7168
    v_cndmask_b32 v16, v8, v5, s[44:45]
    v_mfma_f32_16x16x32_bf16 a[44:47], a[200:203], v[220:223], a[44:47]
    s_add_u32 s35, s35, 0x4000
    v_exp_f32 v239, v147
    v_mfma_f32_16x16x32_bf16 a[48:51], a[204:207], v[208:211], a[48:51]
    v_or3_b32 v57, v192, v193, v194
    v_cndmask_b32 v17, v8, v5, s[46:47]
    v_mfma_f32_16x16x32_bf16 a[52:55], a[204:207], v[212:215], a[52:55]
    v_add_u32 v3, s53, v56
    v_cvt_pk_bf16_f32 v195, v238, v239
    v_mfma_f32_16x16x32_bf16 a[56:59], a[204:207], v[216:219], a[56:59]
    v_exp_f32 v240, v132
    v_mfma_f32_16x16x32_bf16 a[60:63], a[204:207], v[220:223], a[60:63]
    s_waitcnt lgkmcnt(2)
    ds_read_b128 a[128:131], v2 offset:0
    v_cndmask_b32 v18, v8, v5, s[48:49]
    v_mfma_f32_16x16x32_bf16 a[64:67], a[208:211], v[208:211], a[64:67]
    buffer_load_dwordx4 v1, s[20:23], s33 offen offset:1024 sc1 lds
    ds_read_b128 a[132:135], v2 offset:1024
    v_mfma_f32_16x16x32_bf16 a[68:71], a[208:211], v[212:215], a[68:71]
    v_exp_f32 v241, v133
    v_mfma_f32_16x16x32_bf16 a[72:75], a[208:211], v[216:219], a[72:75]
    v_cndmask_b32 v19, v8, v5, s[50:51]
    v_cmp_gt_i32 s[44:45], 16, v6
    v_mfma_f32_16x16x32_bf16 a[76:79], a[208:211], v[220:223], a[76:79]
    v_exp_f32 v242, v134
    v_mfma_f32_16x16x32_bf16 a[80:83], a[212:215], v[208:211], a[80:83]
    v_cvt_pk_bf16_f32 v196, v240, v241
    v_cmp_gt_i32 s[46:47], 17, v6
    v_mfma_f32_16x16x32_bf16 a[84:87], a[212:215], v[212:215], a[84:87]
    v_exp_f32 v243, v135
    v_mfma_f32_16x16x32_bf16 a[88:91], a[212:215], v[216:219], a[88:91]
    v_or3_b32 v57, v57, v195, v196
    v_cmp_gt_i32 s[48:49], 18, v6
    v_mfma_f32_16x16x32_bf16 a[92:95], a[212:215], v[220:223], a[92:95]
    s_waitcnt lgkmcnt(2)
    v_exp_f32 v244, v148
    v_mfma_f32_16x16x32_bf16 a[96:99], a[216:219], v[208:211], a[96:99]
    v_cvt_pk_bf16_f32 v197, v242, v243
    v_cmp_gt_i32 s[50:51], 19, v6
    v_mfma_f32_16x16x32_bf16 a[100:103], a[216:219], v[212:215], a[100:103]
    ds_read_b128 a[136:139], v2 offset:2048
    v_cndmask_b32 v32, v8, v5, s[44:45]
    v_mfma_f32_16x16x32_bf16 a[104:107], a[216:219], v[216:219], a[104:107]
    v_exp_f32 v245, v149
    v_mfma_f32_16x16x32_bf16 a[108:111], a[216:219], v[220:223], a[108:111]
    s_and_b32 s35, s35, 0xffff
    v_exp_f32 v246, v150
    v_mfma_f32_16x16x32_bf16 a[112:115], a[220:223], v[208:211], a[112:115]
    v_cndmask_b32 v33, v8, v5, s[46:47]
    v_cvt_pk_bf16_f32 v198, v244, v245
    v_mfma_f32_16x16x32_bf16 a[116:119], a[220:223], v[212:215], a[116:119]
    ds_read_b128 a[140:143], v2 offset:3072
    v_cndmask_b32 v34, v8, v5, s[48:49]
    v_cndmask_b32 v35, v8, v5, s[50:51]
    v_mfma_f32_16x16x32_bf16 a[120:123], a[220:223], v[216:219], a[120:123]
    v_exp_f32 v247, v151
    v_mfma_f32_16x16x32_bf16 a[124:127], a[220:223], v[220:223], a[124:127]
    s_waitcnt lgkmcnt(2)
    v_or3_b32 v57, v57, v197, v198
    v_cvt_pk_bf16_f32 v199, v246, v247
    v_mfma_f32_16x16x32_bf16 v[160:163], a[128:131], v[64:67], v[16:19]
    v_exp_f32 v232, v136
    v_mfma_f32_16x16x32_bf16 v[164:167], a[128:131], v[80:83], v[20:23]
    buffer_load_dwordx4 v1, s[20:23], s33 offen offset:2048 sc1 lds
    ds_read_b128 a[144:147], v2 offset:4096
    v_mfma_f32_16x16x32_bf16 v[168:171], a[128:131], v[96:99], v[24:27]
    v_exp_f32 v233, v137
    v_mfma_f32_16x16x32_bf16 v[172:175], a[128:131], v[112:115], v[28:31]
    s_or_b32 s35, s35, 0x10000
    v_exp_f32 v234, v138
    v_mfma_f32_16x16x32_bf16 v[160:163], a[132:135], v[68:71], v[160:163]
    s_add_u32 s36, s36, 32
    ds_read_b128 a[148:151], v2 offset:5120
    v_cvt_pk_bf16_f32 v200, v232, v233
    v_mfma_f32_16x16x32_bf16 v[164:167], a[132:135], v[84:87], v[164:167]
    v_exp_f32 v235, v139
    v_mfma_f32_16x16x32_bf16 v[168:171], a[132:135], v[100:103], v[168:171]
    s_add_u32 s52, s52, 8192
    v_or3_b32 v57, v57, v199, v200
    v_cvt_pk_bf16_f32 v201, v234, v235
    v_mfma_f32_16x16x32_bf16 v[172:175], a[132:135], v[116:119], v[172:175]
    s_waitcnt lgkmcnt(2)
    v_exp_f32 v236, v152
    v_mfma_f32_16x16x32_bf16 v[160:163], a[136:139], v[72:75], v[160:163]
    s_and_b32 s52, s52, 0xffff
    ds_read_b128 a[152:155], v2 offset:6144
    ds_read_b128 a[156:159], v2 offset:7168
    v_mfma_f32_16x16x32_bf16 v[164:167], a[136:139], v[88:91], v[164:167]
    v_exp_f32 v237, v153
    v_mfma_f32_16x16x32_bf16 v[168:171], a[136:139], v[104:107], v[168:171]
    v_exp_f32 v238, v154
    v_mfma_f32_16x16x32_bf16 v[172:175], a[136:139], v[120:123], v[172:175]
    v_cvt_pk_bf16_f32 v202, v236, v237
    v_or3_b32 v57, v57, v201, v202
    v_mfma_f32_16x16x32_bf16 v[160:163], a[140:143], v[76:79], v[160:163]
    v_exp_f32 v239, v155
    v_mfma_f32_16x16x32_bf16 v[164:167], a[140:143], v[92:95], v[164:167]
    v_add_u32 v2, s52, v1
    v_cvt_pk_bf16_f32 v203, v238, v239
    v_mfma_f32_16x16x32_bf16 v[168:171], a[140:143], v[108:111], v[168:171]
    v_exp_f32 v240, v140
    v_mfma_f32_16x16x32_bf16 v[172:175], a[140:143], v[124:127], v[172:175]
    s_waitcnt lgkmcnt(2)
    buffer_load_dwordx4 v1, s[20:23], s33 offen offset:3072 sc1 lds
    s_add_u32 s33, s33, 0x80000
    v_mfma_f32_16x16x32_bf16 v[176:179], a[144:147], v[64:67], v[32:35]
    v_exp_f32 v241, v141
    v_mfma_f32_16x16x32_bf16 v[180:183], a[144:147], v[80:83], v[36:39]
    ds_read_b128 a[192:195], v3 offset:0
    v_cvt_pk_bf16_f32 v204, v240, v241
    v_mfma_f32_16x16x32_bf16 v[184:187], a[144:147], v[96:99], v[40:43]
    v_exp_f32 v242, v142
    v_mfma_f32_16x16x32_bf16 v[188:191], a[144:147], v[112:115], v[44:47]
    v_exp_f32 v243, v143
    v_mfma_f32_16x16x32_bf16 v[176:179], a[148:151], v[68:71], v[176:179]
    ds_read_b128 a[196:199], v3 offset:1024
    v_or3_b32 v57, v57, v203, v204
    v_mfma_f32_16x16x32_bf16 v[180:183], a[148:151], v[84:87], v[180:183]
    v_exp_f32 v244, v156
    v_mfma_f32_16x16x32_bf16 v[184:187], a[148:151], v[100:103], v[184:187]
    ds_read_b128 a[200:203], v3 offset:2048
    v_cvt_pk_bf16_f32 v205, v242, v243
    v_mfma_f32_16x16x32_bf16 v[188:191], a[148:151], v[116:119], v[188:191]
    s_waitcnt lgkmcnt(3)
    v_exp_f32 v245, v157
    v_mfma_f32_16x16x32_bf16 v[176:179], a[152:155], v[72:75], v[176:179]
    v_exp_f32 v246, v158
    v_mfma_f32_16x16x32_bf16 v[180:183], a[152:155], v[88:91], v[180:183]
    v_cvt_pk_bf16_f32 v206, v244, v245
    v_or3_b32 v57, v57, v205, v206
    v_mfma_f32_16x16x32_bf16 v[184:187], a[152:155], v[104:107], v[184:187]
    v_exp_f32 v247, v159
    v_mfma_f32_16x16x32_bf16 v[188:191], a[152:155], v[120:123], v[188:191]
    ds_read_b128 a[204:207], v3 offset:3072
    v_cvt_pk_bf16_f32 v207, v246, v247
    v_mfma_f32_16x16x32_bf16 v[176:179], a[156:159], v[76:79], v[176:179]
    v_mfma_f32_16x16x32_bf16 v[180:183], a[156:159], v[92:95], v[180:183]
    v_bitop3_b32 v57, v57, v207, s37 bitop3:0xa8
    v_cmp_ne_u32 vcc, 0, v57
    v_mfma_f32_16x16x32_bf16 v[184:187], a[156:159], v[108:111], v[184:187]
    v_mfma_f32_16x16x32_bf16 v[188:191], a[156:159], v[124:127], v[188:191]
    s_waitcnt vmcnt(13)
    s_barrier
    s_cbranch_vccnz k2_tramp_90
k2_ret_91:
k2_dm3_83:
    v_mfma_f32_16x16x32_bf16 v[12:15], v[60:63], v[192:195], v[12:15]
    v_exp_f32 v232, v160
    v_mfma_f32_16x16x32_bf16 v[48:51], v[60:63], v[196:199], v[48:51]
    s_mov_b32 m0, s34
    ds_read_b128 a[208:211], v3 offset:4096
    v_mfma_f32_16x16x32_bf16 v[248:251], v[60:63], v[200:203], v[248:251]
    s_add_u32 s53, s53, 8192
    v_exp_f32 v233, v161
    v_mfma_f32_16x16x32_bf16 v[252:255], v[60:63], v[204:207], v[252:255]
    s_waitcnt lgkmcnt(3)
    buffer_load_dwordx4 v1, s[16:19], s32 offen offset:0 sc1 lds
    v_mfma_f32_16x16x32_bf16 a[0:3], a[192:195], v[192:195], a[0:3]
    s_sub_u32 s40, s36, s38
    s_sub_u32 s40, s40, 64
    v_exp_f32 v234, v162
    v_cvt_pk_bf16_f32 v208, v232, v233
    v_mfma_f32_16x16x32_bf16 a[4:7], a[192:195], v[196:199], a[4:7]
    s_and_b32 s53, s53, 0xffff
    ds_read_b128 a[212:215], v3 offset:5120
    v_subrev_u32 v6, s40, v4
    v_mfma_f32_16x16x32_bf16 a[8:11], a[192:195], v[200:203], a[8:11]
    s_add_u32 s34, s34, 0x4000
    v_exp_f32 v235, v163
    v_cmp_gt_i32 s[44:45], 0, v6
    v_mfma_f32_16x16x32_bf16 a[12:15], a[192:195], v[204:207], a[12:15]
    v_exp_f32 v236, v176
    v_cvt_pk_bf16_f32 v209, v234, v235
    v_mfma_f32_16x16x32_bf16 a[16:19], a[196:199], v[192:195], a[16:19]
    buffer_load_dwordx4 v1, s[16:19], s32 offen offset:1024 sc1 lds
    ds_read_b128 a[216:219], v3 offset:6144
    v_mfma_f32_16x16x32_bf16 a[20:23], a[196:199], v[196:199], a[20:23]
    v_cmp_gt_i32 s[46:47], 1, v6
    v_exp_f32 v237, v177
    v_mfma_f32_16x16x32_bf16 a[24:27], a[196:199], v[200:203], a[24:27]
    v_cmp_gt_i32 s[48:49], 2, v6
    v_exp_f32 v238, v178
    v_mfma_f32_16x16x32_bf16 a[28:31], a[196:199], v[204:207], a[28:31]
    s_waitcnt lgkmcnt(3)
    v_cvt_pk_bf16_f32 v210, v236, v237
    v_cmp_gt_i32 s[50:51], 3, v6
    v_mfma_f32_16x16x32_bf16 a[32:35], a[200:203], v[192:195], a[32:35]
    s_and_b32 s34, s34, 0xffff
    v_exp_f32 v239, v179
    v_mfma_f32_16x16x32_bf16 a[36:39], a[200:203], v[196:199], a[36:39]
    s_and_b32 s60, s62, 31
    ds_read_b128 a[220:223], v3 offset:7168
    v_or3_b32 v57, v208, v209, v210
    v_cndmask_b32 v20, v9, v5, s[44:45]
    v_mfma_f32_16x16x32_bf16 a[40:43], a[200:203], v[200:203], a[40:43]
    buffer_load_dwordx4 v1, s[16:19], s32 offen offset:2048 sc1 lds
    v_mfma_f32_16x16x32_bf16 a[44:47], a[200:203], v[204:207], a[44:47]
    s_lshr_b32 s61, s62, 5
    v_exp_f32 v240, v164
    v_cvt_pk_bf16_f32 v211, v238, v239
    v_mfma_f32_16x16x32_bf16 a[48:51], a[204:207], v[192:195], a[48:51]
    v_cndmask_b32 v21, v9, v5, s[46:47]
    v_add_u32 v3, s53, v56
    v_mfma_f32_16x16x32_bf16 a[52:55], a[204:207], v[196:199], a[52:55]
    s_mul_i32 s57, s60, 229376
    v_exp_f32 v241, v165
    v_mfma_f32_16x16x32_bf16 a[56:59], a[204:207], v[200:203], a[56:59]
    ds_read_b128 a[128:131], v2 offset:0
    v_cndmask_b32 v22, v9, v5, s[48:49]
    v_cvt_pk_bf16_f32 v212, v240, v241
    v_mfma_f32_16x16x32_bf16 a[60:63], a[204:207], v[204:207], a[60:63]
    s_waitcnt lgkmcnt(3)
    v_exp_f32 v242, v166
    v_mfma_f32_16x16x32_bf16 a[64:67], a[208:211], v[192:195], a[64:67]
    s_lshl_b32 s4, s61, 7
    v_cndmask_b32 v23, v9, v5, s[50:51]
    v_or3_b32 v57, v57, v211, v212
    v_mfma_f32_16x16x32_bf16 a[68:71], a[208:211], v[196:199], a[68:71]
    buffer_load_dwordx4 v1, s[16:19], s32 offen offset:3072 sc1 lds
    ds_read_b128 a[132:135], v2 offset:1024
    s_add_u32 s32, s32, 0x80000
    v_mfma_f32_16x16x32_bf16 a[72:75], a[208:211], v[200:203], a[72:75]
    v_exp_f32 v243, v167
    v_mfma_f32_16x16x32_bf16 a[76:79], a[208:211], v[204:207], a[76:79]
    s_add_u32 s57, s57, s4
    v_cmp_gt_i32 s[44:45], 16, v6
    v_cvt_pk_bf16_f32 v213, v242, v243
    v_mfma_f32_16x16x32_bf16 a[80:83], a[212:215], v[192:195], a[80:83]
    s_waitcnt vmcnt(8)
    v_exp_f32 v244, v180
    v_mfma_f32_16x16x32_bf16 a[84:87], a[212:215], v[196:199], a[84:87]
    s_add_u32 s56, s57, 57344
    ds_read_b128 a[136:139], v2 offset:2048
    v_cmp_gt_i32 s[46:47], 17, v6
    v_mfma_f32_16x16x32_bf16 a[88:91], a[212:215], v[200:203], a[88:91]
    v_exp_f32 v245, v181
    v_cmp_gt_i32 s[48:49], 18, v6
    v_mfma_f32_16x16x32_bf16 a[92:95], a[212:215], v[204:207], a[92:95]
    s_waitcnt lgkmcnt(3)
    v_exp_f32 v246, v182
    v_mfma_f32_16x16x32_bf16 a[96:99], a[216:219], v[192:195], a[96:99]
    s_add_u32 s62, s62, 1
    v_cmp_gt_i32 s[50:51], 19, v6
    v_cvt_pk_bf16_f32 v214, v244, v245
    v_mfma_f32_16x16x32_bf16 a[100:103], a[216:219], v[196:199], a[100:103]
    buffer_store_dwordx4 a[224:227], v229, s[8:11], s58 offen offset:0 sc1
    ds_read_b128 a[140:143], v2 offset:3072
    ds_read_b128 a[144:147], v2 offset:4096
    v_mfma_f32_16x16x32_bf16 a[104:107], a[216:219], v[200:203], a[104:107]
    v_exp_f32 v247, v183
    v_mfma_f32_16x16x32_bf16 a[108:111], a[216:219], v[204:207], a[108:111]
    v_cndmask_b32 v36, v9, v5, s[44:45]
    v_or3_b32 v57, v57, v213, v214
    v_mfma_f32_16x16x32_bf16 a[112:115], a[220:223], v[192:195], a[112:115]
    v_exp_f32 v232, v168
    v_mfma_f32_16x16x32_bf16 a[116:119], a[220:223], v[196:199], a[116:119]
    v_cndmask_b32 v37, v9, v5, s[46:47]
    v_cvt_pk_bf16_f32 v215, v246, v247
    v_cndmask_b32 v38, v9, v5, s[48:49]
    v_cndmask_b32 v39, v9, v5, s[50:51]
    v_mfma_f32_16x16x32_bf16 a[120:123], a[220:223], v[200:203], a[120:123]
    v_exp_f32 v233, v169
    v_mfma_f32_16x16x32_bf16 a[124:127], a[220:223], v[204:207], a[124:127]
    s_waitcnt lgkmcnt(3)
    buffer_store_dwordx4 a[228:231], v229, s[8:11], s58 offen offset:256 sc1
    v_exp_f32 v234, v170
    v_mfma_f32_16x16x32_bf16 v[132:135], a[128:131], v[80:83], v[20:23]
    ds_read_b128 a[148:151], v2 offset:5120
    v_cvt_pk_bf16_f32 v216, v232, v233
    v_mfma_f32_16x16x32_bf16 v[136:139], a[128:131], v[96:99], v[24:27]
    v_exp_f32 v235, v171
    v_mfma_f32_16x16x32_bf16 v[140:143], a[128:131], v[112:115], v[28:31]
    s_lshl_b32 s58, s61, 17
    ds_read_b128 a[152:155], v2 offset:6144
    v_or3_b32 v57, v57, v215, v216
    v_mfma_f32_16x16x32_bf16 v[132:135], a[132:135], v[84:87], v[132:135]
    s_add_u32 s36, s36, 32
    v_exp_f32 v236, v184
    v_mfma_f32_16x16x32_bf16 v[136:139], a[132:135], v[100:103], v[136:139]
    s_lshl_b32 s60, s60, 10
    v_cvt_pk_bf16_f32 v217, v234, v235
    v_exp_f32 v237, v185
    v_mfma_f32_16x16x32_bf16 v[140:143], a[132:135], v[116:119], v[140:143]
    s_waitcnt lgkmcnt(3)
    buffer_load_dwordx4 a[224:227], v228, s[12:15], s57 offen
    ds_read_b128 a[156:159], v2 offset:7168
    v_mfma_f32_16x16x32_bf16 v[132:135], a[136:139], v[88:91], v[132:135]
    s_add_u32 s52, s52, 8192
    v_exp_f32 v238, v186
    v_mfma_f32_16x16x32_bf16 v[136:139], a[136:139], v[104:107], v[136:139]
    s_add_u32 s58, s58, s60
    v_cvt_pk_bf16_f32 v218, v236, v237
    v_or3_b32 v57, v57, v217, v218
    v_mfma_f32_16x16x32_bf16 v[140:143], a[136:139], v[120:123], v[140:143]
    s_and_b32 s52, s52, 0xffff
    v_exp_f32 v239, v187
    v_mfma_f32_16x16x32_bf16 v[132:135], a[140:143], v[92:95], v[132:135]
    v_add_u32 v2, s52, v1
    v_cvt_pk_bf16_f32 v219, v238, v239
    v_mfma_f32_16x16x32_bf16 v[136:139], a[140:143], v[108:111], v[136:139]
    s_mov_b32 s10, s59
    v_exp_f32 v240, v172
    v_mfma_f32_16x16x32_bf16 v[140:143], a[140:143], v[124:127], v[140:143]
    s_waitcnt lgkmcnt(2)
    ds_read_b128 a[192:195], v3 offset:0
    v_exp_f32 v241, v173
    v_mfma_f32_16x16x32_bf16 v[148:151], a[144:147], v[80:83], v[36:39]
    buffer_load_dwordx4 a[228:231], v228, s[12:15], s56 offen
    ds_read_b128 a[196:199], v3 offset:1024
    v_mfma_f32_16x16x32_bf16 v[152:155], a[144:147], v[96:99], v[40:43]
    v_exp_f32 v242, v174
    v_mfma_f32_16x16x32_bf16 v[156:159], a[144:147], v[112:115], v[44:47]
    v_cvt_pk_bf16_f32 v220, v240, v241
    v_or3_b32 v57, v57, v219, v220
    v_mfma_f32_16x16x32_bf16 v[148:151], a[148:151], v[84:87], v[148:151]
    v_exp_f32 v243, v175
    v_mfma_f32_16x16x32_bf16 v[152:155], a[148:151], v[100:103], v[152:155]
    v_exp_f32 v244, v188
    v_mfma_f32_16x16x32_bf16 v[156:159], a[148:151], v[116:119], v[156:159]
    s_waitcnt lgkmcnt(2)
    v_cvt_pk_bf16_f32 v221, v242, v243
    v_exp_f32 v245, v189
    v_mfma_f32_16x16x32_bf16 v[148:151], a[152:155], v[88:91], v[148:151]
    buffer_load_dword v7, v230, s[24:27], s54 offen
    ds_read_b128 a[200:203], v3 offset:2048
    v_mfma_f32_16x16x32_bf16 v[152:155], a[152:155], v[104:107], v[152:155]
    v_exp_f32 v246, v190
    v_mfma_f32_16x16x32_bf16 v[156:159], a[152:155], v[120:123], v[156:159]
    s_add_u32 s54, s54, 4096
    v_cvt_pk_bf16_f32 v222, v244, v245
    v_or3_b32 v57, v57, v221, v222
    v_mfma_f32_16x16x32_bf16 v[148:151], a[156:159], v[92:95], v[148:151]
    v_exp_f32 v247, v191
    v_mfma_f32_16x16x32_bf16 v[152:155], a[156:159], v[108:111], v[152:155]
    ds_read_b128 a[204:207], v3 offset:3072
    v_cvt_pk_bf16_f32 v223, v246, v247
    v_bitop3_b32 v57, v57, v223, s37 bitop3:0xa8
    v_mfma_f32_16x16x32_bf16 v[156:159], a[156:159], v[124:127], v[156:159]
    v_cmp_ne_u32 vcc, 0, v57
    s_cbranch_vccnz k2_tramp_92
k2_ret_93:
    v_mfma_f32_16x16x32_bf16 v[12:15], v[60:63], v[208:211], v[12:15]
    v_exp_f32 v232, v132
    v_mfma_f32_16x16x32_bf16 v[48:51], v[60:63], v[212:215], v[48:51]
    s_mov_b32 m0, s35
    ds_read_b128 a[208:211], v3 offset:4096
    v_mfma_f32_16x16x32_bf16 v[248:251], v[60:63], v[216:219], v[248:251]
    s_add_u32 s53, s53, 8192
    buffer_load_dwordx4 v1, s[20:23], s33 offen offset:0 sc1 lds
    v_mfma_f32_16x16x32_bf16 v[252:255], v[60:63], v[220:223], v[252:255]
    s_waitcnt lgkmcnt(3)
    v_exp_f32 v233, v133
    v_mfma_f32_16x16x32_bf16 a[0:3], a[192:195], v[208:211], a[0:3]
    s_sub_u32 s40, s36, s38
    s_sub_u32 s40, s40, 64
    v_exp_f32 v234, v134
    v_mfma_f32_16x16x32_bf16 a[4:7], a[192:195], v[212:215], a[4:7]
    s_and_b32 s53, s53, 0xffff
    ds_read_b128 a[212:215], v3 offset:5120
    v_subrev_u32 v6, s40, v4
    v_mfma_f32_16x16x32_bf16 a[8:11], a[192:195], v[216:219], a[8:11]
    v_cvt_pk_bf16_f32 v196, v232, v233
    v_cmp_gt_i32 s[44:45], 0, v6
    v_mfma_f32_16x16x32_bf16 a[12:15], a[192:195], v[220:223], a[12:15]
    v_exp_f32 v235, v135
    v_mfma_f32_16x16x32_bf16 a[16:19], a[196:199], v[208:211], a[16:19]
    ds_read_b128 a[216:219], v3 offset:6144
    v_cmp_gt_i32 s[46:47], 1, v6
    v_mfma_f32_16x16x32_bf16 a[20:23], a[196:199], v[212:215], a[20:23]
    v_exp_f32 v236, v148
    v_mfma_f32_16x16x32_bf16 a[24:27], a[196:199], v[216:219], a[24:27]
    v_cvt_pk_bf16_f32 v197, v234, v235
    v_cmp_gt_i32 s[48:49], 2, v6
    v_mfma_f32_16x16x32_bf16 a[28:31], a[196:199], v[220:223], a[28:31]
    s_waitcnt lgkmcnt(3)
    v_cmp_gt_i32 s[50:51], 3, v6
    v_mfma_f32_16x16x32_bf16 a[32:35], a[200:203], v[208:211], a[32:35]
    v_exp_f32 v237, v149
    v_mfma_f32_16x16x32_bf16 a[36:39], a[200:203], v[212:215], a[36:39]
    s_add_u32 s35, s35, 0x4000
    ds_read_b128 a[220:223], v3 offset:7168
    v_cndmask_b32 v20, v9, v5, s[44:45]
    v_mfma_f32_16x16x32_bf16 a[40:43], a[200:203], v[216:219], a[40:43]
    v_exp_f32 v238, v150
    v_mfma_f32_16x16x32_bf16 a[44:47], a[200:203], v[220:223], a[44:47]
    v_cvt_pk_bf16_f32 v198, v236, v237
    v_cndmask_b32 v21, v9, v5, s[46:47]
    v_mfma_f32_16x16x32_bf16 a[48:51], a[204:207], v[208:211], a[48:51]
    buffer_load_dwordx4 v1, s[20:23], s33 offen offset:1024 sc1 lds
    ds_read_b128 a[128:131], v2 offset:0
    v_mfma_f32_16x16x32_bf16 a[52:55], a[204:207], v[212:215], a[52:55]
    v_add_u32 v3, s53, v56
    v_cndmask_b32 v22, v9, v5, s[48:49]
    v_mfma_f32_16x16x32_bf16 a[56:59], a[204:207], v[216:219], a[56:59]
    v_exp_f32 v239, v151
    v_mfma_f32_16x16x32_bf16 a[60:63], a[204:207], v[220:223], a[60:63]
    s_waitcnt lgkmcnt(3)
    v_or3_b32 v57, v196, v197, v198
    v_cndmask_b32 v23, v9, v5, s[50:51]
    v_mfma_f32_16x16x32_bf16 a[64:67], a[208:211], v[208:211], a[64:67]
    v_exp_f32 v240, v136
    v_mfma_f32_16x16x32_bf16 a[68:71], a[208:211], v[212:215], a[68:71]
    v_cvt_pk_bf16_f32 v199, v238, v239
    v_cmp_gt_i32 s[44:45], 16, v6
    v_mfma_f32_16x16x32_bf16 a[72:75], a[208:211], v[216:219], a[72:75]
    ds_read_b128 a[132:135], v2 offset:1024
    v_cmp_gt_i32 s[46:47], 17, v6
    v_mfma_f32_16x16x32_bf16 a[76:79], a[208:211], v[220:223], a[76:79]
    v_exp_f32 v241, v137
    v_mfma_f32_16x16x32_bf16 a[80:83], a[212:215], v[208:211], a[80:83]
    ds_read_b128 a[136:139], v2 offset:2048
    v_cmp_gt_i32 s[48:49], 18, v6
    v_mfma_f32_16x16x32_bf16 a[84:87], a[212:215], v[212:215], a[84:87]
    v_exp_f32 v242, v138
    v_mfma_f32_16x16x32_bf16 a[88:91], a[212:215], v[216:219], a[88:91]
    v_cvt_pk_bf16_f32 v200, v240, v241
    v_cmp_gt_i32 s[50:51], 19, v6
    v_mfma_f32_16x16x32_bf16 a[92:95], a[212:215], v[220:223], a[92:95]
    s_waitcnt lgkmcnt(3)
    v_exp_f32 v243, v139
    v_mfma_f32_16x16x32_bf16 a[96:99], a[216:219], v[208:211], a[96:99]
    s_and_b32 s35, s35, 0xffff
    ds_read_b128 a[140:143], v2 offset:3072
    v_or3_b32 v57, v57, v199, v200
    v_mfma_f32_16x16x32_bf16 a[100:103], a[216:219], v[212:215], a[100:103]
    v_cndmask_b32 v36, v9, v5, s[44:45]
    v_cndmask_b32 v37, v9, v5, s[46:47]
    v_mfma_f32_16x16x32_bf16 a[104:107], a[216:219], v[216:219], a[104:107]
    v_exp_f32 v244, v152
    v_mfma_f32_16x16x32_bf16 a[108:111], a[216:219], v[220:223], a[108:111]
    ds_read_b128 a[144:147], v2 offset:4096
    v_cvt_pk_bf16_f32 v201, v242, v243
    v_mfma_f32_16x16x32_bf16 a[112:115], a[220:223], v[208:211], a[112:115]
    buffer_load_dwordx4 v1, s[20:23], s33 offen offset:2048 sc1 lds
    ds_read_b128 a[148:151], v2 offset:5120
    v_mfma_f32_16x16x32_bf16 a[116:119], a[220:223], v[212:215], a[116:119]
    v_cndmask_b32 v38, v9, v5, s[48:49]
    v_cndmask_b32 v39, v9, v5, s[50:51]
    v_mfma_f32_16x16x32_bf16 a[120:123], a[220:223], v[216:219], a[120:123]
    s_or_b32 s35, s35, 0x10000
    v_exp_f32 v245, v153
    v_mfma_f32_16x16x32_bf16 a[124:127], a[220:223], v[220:223], a[124:127]
    s_waitcnt lgkmcnt(4)
    v_exp_f32 v246, v154
    v_mfma_f32_16x16x32_bf16 v[164:167], a[128:131], v[80:83], v[20:23]
    ds_read_b128 a[152:155], v2 offset:6144
    v_cvt_pk_bf16_f32 v202, v244, v245
    v_mfma_f32_16x16x32_bf16 v[168:171], a[128:131], v[96:99], v[24:27]
    v_exp_f32 v247, v155
    v_mfma_f32_16x16x32_bf16 v[172:175], a[128:131], v[112:115], v[28:31]
    v_or3_b32 v57, v57, v201, v202
    v_cvt_pk_bf16_f32 v203, v246, v247
    v_mfma_f32_16x16x32_bf16 v[164:167], a[132:135], v[84:87], v[164:167]
    s_add_u32 s36, s36, 32
    v_exp_f32 v232, v140
    v_mfma_f32_16x16x32_bf16 v[168:171], a[132:135], v[100:103], v[168:171]
    ds_read_b128 a[156:159], v2 offset:7168
    v_mfma_f32_16x16x32_bf16 v[172:175], a[132:135], v[116:119], v[172:175]
    s_waitcnt lgkmcnt(4)
    v_exp_f32 v233, v141
    v_mfma_f32_16x16x32_bf16 v[164:167], a[136:139], v[88:91], v[164:167]
    s_add_u32 s52, s52, 8192
    v_exp_f32 v234, v142
    v_mfma_f32_16x16x32_bf16 v[168:171], a[136:139], v[104:107], v[168:171]
    ds_read_b128 a[192:195], v3 offset:0
    v_cvt_pk_bf16_f32 v204, v232, v233
    v_mfma_f32_16x16x32_bf16 v[172:175], a[136:139], v[120:123], v[172:175]
    s_and_b32 s52, s52, 0xffff
    v_add_u32 v2, s52, v1
    v_or3_b32 v57, v57, v203, v204
    v_mfma_f32_16x16x32_bf16 v[164:167], a[140:143], v[92:95], v[164:167]
    buffer_load_dwordx4 v1, s[20:23], s33 offen offset:3072 sc1 lds
    s_add_u32 s33, s33, 0x80000
    v_mfma_f32_16x16x32_bf16 v[168:171], a[140:143], v[108:111], v[168:171]
    v_exp_f32 v235, v143
    v_mfma_f32_16x16x32_bf16 v[172:175], a[140:143], v[124:127], v[172:175]
    s_waitcnt lgkmcnt(3)
    v_exp_f32 v236, v156
    v_mfma_f32_16x16x32_bf16 v[180:183], a[144:147], v[80:83], v[36:39]
    ds_read_b128 a[196:199], v3 offset:1024
    v_cvt_pk_bf16_f32 v205, v234, v235
    v_mfma_f32_16x16x32_bf16 v[184:187], a[144:147], v[96:99], v[40:43]
    v_exp_f32 v237, v157
    v_mfma_f32_16x16x32_bf16 v[188:191], a[144:147], v[112:115], v[44:47]
    ds_read_b128 a[200:203], v3 offset:2048
    v_mfma_f32_16x16x32_bf16 v[180:183], a[148:151], v[84:87], v[180:183]
    v_exp_f32 v238, v158
    v_mfma_f32_16x16x32_bf16 v[184:187], a[148:151], v[100:103], v[184:187]
    v_cvt_pk_bf16_f32 v206, v236, v237
    v_mfma_f32_16x16x32_bf16 v[188:191], a[148:151], v[116:119], v[188:191]
    s_waitcnt lgkmcnt(3)
    v_exp_f32 v239, v159
    v_mfma_f32_16x16x32_bf16 v[180:183], a[152:155], v[88:91], v[180:183]
    ds_read_b128 a[204:207], v3 offset:3072
    v_or3_b32 v57, v57, v205, v206
    v_mfma_f32_16x16x32_bf16 v[184:187], a[152:155], v[104:107], v[184:187]
    v_cvt_pk_bf16_f32 v207, v238, v239
    v_mfma_f32_16x16x32_bf16 v[188:191], a[152:155], v[120:123], v[188:191]
    v_mfma_f32_16x16x32_bf16 v[180:183], a[156:159], v[92:95], v[180:183]
    v_bitop3_b32 v57, v57, v207, s37 bitop3:0xa8
    v_cmp_ne_u32 vcc, 0, v57
    v_mfma_f32_16x16x32_bf16 v[184:187], a[156:159], v[108:111], v[184:187]
    v_mfma_f32_16x16x32_bf16 v[188:191], a[156:159], v[124:127], v[188:191]
    s_waitcnt vmcnt(13)
    s_barrier
    s_cbranch_vccnz k2_tramp_94
k2_ret_95:
    v_mfma_f32_16x16x32_bf16 v[48:51], v[60:63], v[196:199], v[48:51]
    ds_read_b128 a[208:211], v3 offset:4096
    ds_read_b128 a[212:215], v3 offset:5120
    v_mfma_f32_16x16x32_bf16 v[248:251], v[60:63], v[200:203], v[248:251]
    s_mov_b32 m0, s34
    v_exp_f32 v232, v164
    v_mfma_f32_16x16x32_bf16 v[252:255], v[60:63], v[204:207], v[252:255]
    s_waitcnt lgkmcnt(4)
    buffer_load_dwordx4 v1, s[16:19], s32 offen offset:0 sc1 lds
    ds_read_b128 a[216:219], v3 offset:6144
    v_mfma_f32_16x16x32_bf16 a[4:7], a[192:195], v[196:199], a[4:7]
    s_add_u32 s53, s53, 8192
    v_exp_f32 v233, v165
    v_mfma_f32_16x16x32_bf16 a[8:11], a[192:195], v[200:203], a[8:11]
    s_and_b32 s53, s53, 0xffff
    v_mov_b32 v16, v10
    v_mov_b32 v17, v10
    v_mfma_f32_16x16x32_bf16 a[12:15], a[192:195], v[204:207], a[12:15]
    s_add_u32 s34, s34, 0x4000
    v_exp_f32 v234, v166
    v_mfma_f32_16x16x32_bf16 a[20:23], a[196:199], v[196:199], a[20:23]
    ds_read_b128 a[220:223], v3 offset:7168
    v_cvt_pk_bf16_f32 v212, v232, v233
    v_mfma_f32_16x16x32_bf16 a[24:27], a[196:199], v[200:203], a[24:27]
    v_mov_b32 v18, v10
    v_mov_b32 v19, v10
    v_mfma_f32_16x16x32_bf16 a[28:31], a[196:199], v[204:207], a[28:31]
    s_waitcnt lgkmcnt(4)
    v_exp_f32 v235, v167
    v_mfma_f32_16x16x32_bf16 a[36:39], a[200:203], v[196:199], a[36:39]
    buffer_load_dwordx4 v1, s[16:19], s32 offen offset:1024 sc1 lds
    ds_read_b128 a[128:131], v2 offset:0
    v_mfma_f32_16x16x32_bf16 a[40:43], a[200:203], v[200:203], a[40:43]
    v_mov_b32 v20, v11
    v_add_u32 v3, s53, v56
    v_mfma_f32_16x16x32_bf16 a[44:47], a[200:203], v[204:207], a[44:47]
    s_and_b32 s34, s34, 0xffff
    v_mov_b32 v21, v11
    v_mov_b32 v22, v11
    v_mfma_f32_16x16x32_bf16 a[52:55], a[204:207], v[196:199], a[52:55]
    v_exp_f32 v236, v180
    v_mfma_f32_16x16x32_bf16 a[56:59], a[204:207], v[200:203], a[56:59]
    ds_read_b128 a[132:135], v2 offset:1024
    v_cvt_pk_bf16_f32 v213, v234, v235
    v_mfma_f32_16x16x32_bf16 a[60:63], a[204:207], v[204:207], a[60:63]
    s_waitcnt lgkmcnt(4)
    v_mov_b32 v23, v11
    v_mov_b32 v32, v10
    v_mfma_f32_16x16x32_bf16 a[68:71], a[208:211], v[196:199], a[68:71]
    v_exp_f32 v237, v181
    v_mfma_f32_16x16x32_bf16 a[72:75], a[208:211], v[200:203], a[72:75]
    ds_read_b128 a[136:139], v2 offset:2048
    v_mov_b32 v33, v10
    v_mfma_f32_16x16x32_bf16 a[76:79], a[208:211], v[204:207], a[76:79]
    buffer_load_dwordx4 v1, s[16:19], s32 offen offset:2048 sc1 lds
    v_mov_b32 v34, v10
    v_mfma_f32_16x16x32_bf16 a[84:87], a[212:215], v[196:199], a[84:87]
    v_exp_f32 v238, v182
    v_mfma_f32_16x16x32_bf16 a[88:91], a[212:215], v[200:203], a[88:91]
    ds_read_b128 a[140:143], v2 offset:3072
    v_cvt_pk_bf16_f32 v214, v236, v237
    v_mfma_f32_16x16x32_bf16 a[92:95], a[212:215], v[204:207], a[92:95]
    s_waitcnt lgkmcnt(4)
    v_mov_b32 v35, v10
    v_mov_b32 v36, v11
    v_mfma_f32_16x16x32_bf16 a[100:103], a[216:219], v[196:199], a[100:103]
    ds_read_b128 a[144:147], v2 offset:4096
    v_exp_f32 v239, v183
    v_mfma_f32_16x16x32_bf16 a[104:107], a[216:219], v[200:203], a[104:107]
    v_mov_b32 v37, v11
    v_or3_b32 v57, v212, v213, v214
    v_mov_b32 v38, v11
    v_mov_b32 v39, v11
    v_mfma_f32_16x16x32_bf16 a[108:111], a[216:219], v[204:207], a[108:111]
    buffer_load_dwordx4 v1, s[16:19], s32 offen offset:3072 sc1 lds
    ds_read_b128 a[148:151], v2 offset:5120
    v_mfma_f32_16x16x32_bf16 a[116:119], a[220:223], v[196:199], a[116:119]
    s_add_u32 s32, s32, 0x80000
    s_cmp_ge_u32 s36, s43
    s_cbranch_scc1 k2_prep_96
k2_prepret_97:
    v_mfma_f32_16x16x32_bf16 a[120:123], a[220:223], v[200:203], a[120:123]
    s_waitcnt vmcnt(8)
    v_exp_f32 v240, v168
    v_mfma_f32_16x16x32_bf16 a[124:127], a[220:223], v[204:207], a[124:127]
    s_waitcnt lgkmcnt(4)
    ds_read_b128 a[152:155], v2 offset:6144
    v_cvt_pk_bf16_f32 v215, v238, v239
    v_mfma_f32_16x16x32_bf16 v[128:131], a[128:131], v[96:99], v[16:19]
    v_exp_f32 v241, v169
    v_mfma_f32_16x16x32_bf16 v[132:135], a[128:131], v[112:115], v[20:23]
    ds_read_b128 a[156:159], v2 offset:7168
    v_exp_f32 v242, v170
    v_mfma_f32_16x16x32_bf16 v[128:131], a[132:135], v[100:103], v[128:131]
    ds_read_b128 a[160:163], v2 offset:8192
    v_cvt_pk_bf16_f32 v216, v240, v241
    v_mfma_f32_16x16x32_bf16 v[132:135], a[132:135], v[116:119], v[132:135]
    s_waitcnt lgkmcnt(5)
    buffer_store_dwordx4 a[224:227], v229, s[8:11], s58 offen offset:0 sc1
    v_exp_f32 v243, v171
    v_mfma_f32_16x16x32_bf16 v[128:131], a[136:139], v[104:107], v[128:131]
    s_add_u32 s36, s36, 64
    ds_read_b128 a[164:167], v2 offset:9216
    v_or3_b32 v57, v57, v215, v216
    v_mfma_f32_16x16x32_bf16 v[132:135], a[136:139], v[120:123], v[132:135]
    v_exp_f32 v244, v184
    v_mfma_f32_16x16x32_bf16 v[128:131], a[140:143], v[108:111], v[128:131]
    s_add_u32 s52, s52, 16384
    ds_read_b128 a[168:171], v2 offset:10240
    v_cvt_pk_bf16_f32 v217, v242, v243
    v_mfma_f32_16x16x32_bf16 v[132:135], a[140:143], v[124:127], v[132:135]
    s_waitcnt lgkmcnt(5)
    v_exp_f32 v245, v185
    v_mfma_f32_16x16x32_bf16 v[144:147], a[144:147], v[96:99], v[32:35]
    s_and_b32 s52, s52, 0xffff
    ds_read_b128 a[172:175], v2 offset:11264
    ds_read_b128 a[176:179], v2 offset:12288
    v_mfma_f32_16x16x32_bf16 v[148:151], a[144:147], v[112:115], v[36:39]
    v_exp_f32 v246, v186
    v_mfma_f32_16x16x32_bf16 v[144:147], a[148:151], v[100:103], v[144:147]
    ds_read_b128 a[180:183], v2 offset:13312
    v_cvt_pk_bf16_f32 v218, v244, v245
    v_mfma_f32_16x16x32_bf16 v[148:151], a[148:151], v[116:119], v[148:151]
    s_waitcnt lgkmcnt(6)
    v_exp_f32 v247, v187
    v_mfma_f32_16x16x32_bf16 v[144:147], a[152:155], v[104:107], v[144:147]
    ds_read_b128 a[184:187], v2 offset:14336
    v_or3_b32 v57, v57, v217, v218
    v_mfma_f32_16x16x32_bf16 v[148:151], a[152:155], v[120:123], v[148:151]
    v_exp_f32 v232, v172
    v_mfma_f32_16x16x32_bf16 v[144:147], a[156:159], v[108:111], v[144:147]
    ds_read_b128 a[188:191], v2 offset:15360
    v_cvt_pk_bf16_f32 v219, v246, v247
    v_mfma_f32_16x16x32_bf16 v[148:151], a[156:159], v[124:127], v[148:151]
    s_waitcnt lgkmcnt(6)
    v_exp_f32 v233, v173
    v_mfma_f32_16x16x32_bf16 v[136:139], a[160:163], v[96:99], v[24:27]
    buffer_store_dwordx4 a[228:231], v229, s[8:11], s58 offen offset:256 sc1
    ds_read_b128 a[192:195], v3 offset:0
    v_mfma_f32_16x16x32_bf16 v[140:143], a[160:163], v[112:115], v[28:31]
    v_add_u32 v2, s52, v1
    v_cvt_pk_bf16_f32 v220, v232, v233
    v_mfma_f32_16x16x32_bf16 v[136:139], a[164:167], v[100:103], v[136:139]
    v_exp_f32 v234, v174
    v_mfma_f32_16x16x32_bf16 v[140:143], a[164:167], v[116:119], v[140:143]
    s_waitcnt lgkmcnt(5)
    v_exp_f32 v235, v175
    v_mfma_f32_16x16x32_bf16 v[136:139], a[168:171], v[104:107], v[136:139]
    ds_read_b128 a[196:199], v3 offset:1024
    v_or3_b32 v57, v57, v219, v220
    v_mfma_f32_16x16x32_bf16 v[140:143], a[168:171], v[120:123], v[140:143]
    v_exp_f32 v236, v188
    v_mfma_f32_16x16x32_bf16 v[136:139], a[172:175], v[108:111], v[136:139]
    ds_read_b128 a[200:203], v3 offset:2048
    v_cvt_pk_bf16_f32 v221, v234, v235
    v_mfma_f32_16x16x32_bf16 v[140:143], a[172:175], v[124:127], v[140:143]
    s_waitcnt lgkmcnt(5)
    v_exp_f32 v237, v189
    v_mfma_f32_16x16x32_bf16 v[152:155], a[176:179], v[96:99], v[40:43]
    v_exp_f32 v238, v190
    v_mfma_f32_16x16x32_bf16 v[156:159], a[176:179], v[112:115], v[44:47]
    v_cvt_pk_bf16_f32 v222, v236, v237
    v_or3_b32 v57, v57, v221, v222
    v_mfma_f32_16x16x32_bf16 v[152:155], a[180:183], v[100:103], v[152:155]
    v_exp_f32 v239, v191
    v_mfma_f32_16x16x32_bf16 v[156:159], a[180:183], v[116:119], v[156:159]
    s_waitcnt lgkmcnt(3)
    ds_read_b128 a[204:207], v3 offset:3072
    v_cvt_pk_bf16_f32 v223, v238, v239
    v_mfma_f32_16x16x32_bf16 v[152:155], a[184:187], v[104:107], v[152:155]
    v_mfma_f32_16x16x32_bf16 v[156:159], a[184:187], v[120:123], v[156:159]
    v_bitop3_b32 v57, v57, v223, s37 bitop3:0xa8
    v_cmp_ne_u32 vcc, 0, v57
    v_mfma_f32_16x16x32_bf16 v[152:155], a[188:191], v[108:111], v[152:155]
    v_mfma_f32_16x16x32_bf16 v[156:159], a[188:191], v[124:127], v[156:159]
    s_cbranch_vccnz k2_tramp_98
k2_ret_99:
    v_mfma_f32_16x16x32_bf16 v[48:51], v[60:63], v[212:215], v[48:51]
    ds_read_b128 a[208:211], v3 offset:4096
    ds_read_b128 a[212:215], v3 offset:5120
    v_mfma_f32_16x16x32_bf16 v[248:251], v[60:63], v[216:219], v[248:251]
    s_mov_b32 m0, s35
    v_exp_f32 v232, v128
    v_mfma_f32_16x16x32_bf16 v[252:255], v[60:63], v[220:223], v[252:255]
    s_waitcnt lgkmcnt(4)
    ds_read_b128 a[216:219], v3 offset:6144
    v_exp_f32 v233, v129
    v_mfma_f32_16x16x32_bf16 a[4:7], a[192:195], v[212:215], a[4:7]
    s_add_u32 s53, s53, 8192
    buffer_load_dwordx4 v1, s[20:23], s33 offen offset:0 sc1 lds
    v_mfma_f32_16x16x32_bf16 a[8:11], a[192:195], v[216:219], a[8:11]
    s_and_b32 s53, s53, 0xffff
    v_exp_f32 v234, v130
    v_cvt_pk_bf16_f32 v192, v232, v233
    v_mfma_f32_16x16x32_bf16 a[12:15], a[192:195], v[220:223], a[12:15]
    ds_read_b128 a[220:223], v3 offset:7168
    v_mfma_f32_16x16x32_bf16 a[20:23], a[196:199], v[212:215], a[20:23]
    s_add_u32 s35, s35, 0x4000
    v_exp_f32 v235, v131
    v_mfma_f32_16x16x32_bf16 a[24:27], a[196:199], v[216:219], a[24:27]
    v_exp_f32 v236, v144
    v_cvt_pk_bf16_f32 v193, v234, v235
    v_mfma_f32_16x16x32_bf16 a[28:31], a[196:199], v[220:223], a[28:31]
    s_waitcnt lgkmcnt(4)
    buffer_load_dwordx4 v1, s[20:23], s33 offen offset:1024 sc1 lds
    ds_read_b128 a[128:131], v2 offset:0
    v_mfma_f32_16x16x32_bf16 a[36:39], a[200:203], v[212:215], a[36:39]
    v_add_u32 v3, s53, v56
    v_exp_f32 v237, v145
    v_mfma_f32_16x16x32_bf16 a[40:43], a[200:203], v[216:219], a[40:43]
    ds_read_b128 a[132:135], v2 offset:1024
    v_cvt_pk_bf16_f32 v194, v236, v237
    v_mfma_f32_16x16x32_bf16 a[44:47], a[200:203], v[220:223], a[44:47]
    ds_read_b128 a[136:139], v2 offset:2048
    v_exp_f32 v238, v146
    v_mfma_f32_16x16x32_bf16 a[52:55], a[204:207], v[212:215], a[52:55]
    s_and_b32 s35, s35, 0xffff
    v_exp_f32 v239, v147
    v_mfma_f32_16x16x32_bf16 a[56:59], a[204:207], v[216:219], a[56:59]
    ds_read_b128 a[140:143], v2 offset:3072
    v_or3_b32 v57, v192, v193, v194
    v_mfma_f32_16x16x32_bf16 a[60:63], a[204:207], v[220:223], a[60:63]
    s_waitcnt lgkmcnt(6)
    v_exp_f32 v240, v132
    v_mfma_f32_16x16x32_bf16 a[68:71], a[208:211], v[212:215], a[68:71]
    s_or_b32 s35, s35, 0x10000
    buffer_load_dwordx4 v1, s[20:23], s33 offen offset:2048 sc1 lds
    ds_read_b128 a[144:147], v2 offset:4096
    v_mfma_f32_16x16x32_bf16 a[72:75], a[208:211], v[216:219], a[72:75]
    v_cvt_pk_bf16_f32 v195, v238, v239
    v_exp_f32 v241, v133
    v_mfma_f32_16x16x32_bf16 a[76:79], a[208:211], v[220:223], a[76:79]
    v_exp_f32 v242, v134
    v_mfma_f32_16x16x32_bf16 a[84:87], a[212:215], v[212:215], a[84:87]
    ds_read_b128 a[148:151], v2 offset:5120
    v_cvt_pk_bf16_f32 v196, v240, v241
    v_mfma_f32_16x16x32_bf16 a[88:91], a[212:215], v[216:219], a[88:91]
    v_exp_f32 v243, v135
    v_mfma_f32_16x16x32_bf16 a[92:95], a[212:215], v[220:223], a[92:95]
    s_waitcnt lgkmcnt(6)
    ds_read_b128 a[152:155], v2 offset:6144
    v_or3_b32 v57, v57, v195, v196
    v_cvt_pk_bf16_f32 v197, v242, v243
    v_mfma_f32_16x16x32_bf16 a[100:103], a[216:219], v[212:215], a[100:103]
    buffer_load_dwordx4 v1, s[20:23], s33 offen offset:3072 sc1 lds
    ds_read_b128 a[156:159], v2 offset:7168
    v_mfma_f32_16x16x32_bf16 a[104:107], a[216:219], v[216:219], a[104:107]
    s_add_u32 s33, s33, 0x80000
    v_exp_f32 v244, v148
    v_mfma_f32_16x16x32_bf16 a[108:111], a[216:219], v[220:223], a[108:111]
    v_exp_f32 v245, v149
    v_mfma_f32_16x16x32_bf16 a[116:119], a[220:223], v[212:215], a[116:119]
    ds_read_b128 a[160:163], v2 offset:8192
    s_cmp_ge_u32 s36, s43
    s_cbranch_scc1 k2_prep_100
k2_prepret_101:
    v_mfma_f32_16x16x32_bf16 a[120:123], a[220:223], v[216:219], a[120:123]
    v_exp_f32 v246, v150
    v_mfma_f32_16x16x32_bf16 a[124:127], a[220:223], v[220:223], a[124:127]
    s_waitcnt lgkmcnt(7)
    ds_read_b128 a[164:167], v2 offset:9216
    v_cvt_pk_bf16_f32 v198, v244, v245
    v_mfma_f32_16x16x32_bf16 v[160:163], a[128:131], v[96:99], v[16:19]
    s_waitcnt vmcnt(12)
    s_barrier
    v_exp_f32 v247, v151
    v_mfma_f32_16x16x32_bf16 v[164:167], a[128:131], v[112:115], v[20:23]
    s_mov_b32 m0, s34
    v_or3_b32 v57, v57, v197, v198
    v_cvt_pk_bf16_f32 v199, v246, v247
    v_mfma_f32_16x16x32_bf16 v[160:163], a[132:135], v[100:103], v[160:163]
    ds_read_b128 a[168:171], v2 offset:10240
    v_exp_f32 v232, v136
    v_mfma_f32_16x16x32_bf16 v[164:167], a[132:135], v[116:119], v[164:167]
    s_waitcnt lgkmcnt(7)
    buffer_load_dwordx4 v1, s[16:19], s32 offen offset:0 sc1 lds
    ds_read_b128 a[172:175], v2 offset:11264
    v_mfma_f32_16x16x32_bf16 v[160:163], a[136:139], v[104:107], v[160:163]
    s_add_u32 s36, s36, 64
    v_exp_f32 v233, v137
    v_mfma_f32_16x16x32_bf16 v[164:167], a[136:139], v[120:123], v[164:167]
    v_exp_f32 v234, v138
    v_mfma_f32_16x16x32_bf16 v[160:163], a[140:143], v[108:111], v[160:163]
    s_add_u32 s52, s52, 16384
    ds_read_b128 a[176:179], v2 offset:12288
    v_cvt_pk_bf16_f32 v200, v232, v233
    v_mfma_f32_16x16x32_bf16 v[164:167], a[140:143], v[124:127], v[164:167]
    s_waitcnt lgkmcnt(7)
    v_exp_f32 v235, v139
    v_or3_b32 v57, v57, v199, v200
    v_mfma_f32_16x16x32_bf16 v[176:179], a[144:147], v[96:99], v[32:35]
    s_add_u32 s34, s34, 0x4000
    ds_read_b128 a[180:183], v2 offset:13312
    v_cvt_pk_bf16_f32 v201, v234, v235
    v_mfma_f32_16x16x32_bf16 v[180:183], a[144:147], v[112:115], v[36:39]
    s_and_b32 s52, s52, 0xffff
    v_exp_f32 v236, v152
    v_mfma_f32_16x16x32_bf16 v[176:179], a[148:151], v[100:103], v[176:179]
    buffer_load_dwordx4 v1, s[16:19], s32 offen offset:1024 sc1 lds
    ds_read_b128 a[184:187], v2 offset:14336
    v_mfma_f32_16x16x32_bf16 v[180:183], a[148:151], v[116:119], v[180:183]
    s_waitcnt lgkmcnt(7)
    ds_read_b128 a[188:191], v2 offset:15360
    v_exp_f32 v237, v153
    v_mfma_f32_16x16x32_bf16 v[176:179], a[152:155], v[104:107], v[176:179]
    v_exp_f32 v238, v154
    v_mfma_f32_16x16x32_bf16 v[180:183], a[152:155], v[120:123], v[180:183]
    v_cvt_pk_bf16_f32 v202, v236, v237
    v_or3_b32 v57, v57, v201, v202
    v_mfma_f32_16x16x32_bf16 v[176:179], a[156:159], v[108:111], v[176:179]
    s_and_b32 s34, s34, 0xffff
    v_exp_f32 v239, v155
    v_mfma_f32_16x16x32_bf16 v[180:183], a[156:159], v[124:127], v[180:183]
    s_waitcnt lgkmcnt(6)
    v_add_u32 v2, s52, v1
    v_cvt_pk_bf16_f32 v203, v238, v239
    v_mfma_f32_16x16x32_bf16 v[168:171], a[160:163], v[96:99], v[24:27]
    ds_read_b128 a[192:195], v3 offset:0
    v_exp_f32 v240, v140
    v_mfma_f32_16x16x32_bf16 v[172:175], a[160:163], v[112:115], v[28:31]
    v_exp_f32 v241, v141
    v_mfma_f32_16x16x32_bf16 v[168:171], a[164:167], v[100:103], v[168:171]
    buffer_load_dwordx4 v1, s[16:19], s32 offen offset:2048 sc1 lds
    ds_read_b128 a[196:199], v3 offset:1024
    v_mfma_f32_16x16x32_bf16 v[172:175], a[164:167], v[116:119], v[172:175]
    s_waitcnt lgkmcnt(6)
    v_exp_f32 v242, v142
    v_mfma_f32_16x16x32_bf16 v[168:171], a[168:171], v[104:107], v[168:171]
    ds_read_b128 a[200:203], v3 offset:2048
    v_cvt_pk_bf16_f32 v204, v240, v241
    v_or3_b32 v57, v57, v203, v204
    v_mfma_f32_16x16x32_bf16 v[172:175], a[168:171], v[120:123], v[172:175]
    v_exp_f32 v243, v143
    v_mfma_f32_16x16x32_bf16 v[168:171], a[172:175], v[108:111], v[168:171]
    ds_read_b128 a[204:207], v3 offset:3072
    v_cvt_pk_bf16_f32 v205, v242, v243
    v_mfma_f32_16x16x32_bf16 v[172:175], a[172:175], v[124:127], v[172:175]
    s_waitcnt lgkmcnt(6)
    v_exp_f32 v244, v156
    v_mfma_f32_16x16x32_bf16 v[184:187], a[176:179], v[96:99], v[40:43]
    v_exp_f32 v245, v157
    v_mfma_f32_16x16x32_bf16 v[188:191], a[176:179], v[112:115], v[44:47]
    buffer_load_dwordx4 v1, s[16:19], s32 offen offset:3072 sc1 lds
    ds_read_b128 a[208:211], v3 offset:4096
    ds_read_b128 a[212:215], v3 offset:5120
    v_mfma_f32_16x16x32_bf16 v[184:187], a[180:183], v[100:103], v[184:187]
    s_add_u32 s32, s32, 0x80000
    v_exp_f32 v246, v158
    v_mfma_f32_16x16x32_bf16 v[188:191], a[180:183], v[116:119], v[188:191]
    s_waitcnt lgkmcnt(6)
    v_cvt_pk_bf16_f32 v206, v244, v245
    v_or3_b32 v57, v57, v205, v206
    v_mfma_f32_16x16x32_bf16 v[184:187], a[184:187], v[104:107], v[184:187]
    v_exp_f32 v247, v159
    v_mfma_f32_16x16x32_bf16 v[188:191], a[184:187], v[120:123], v[188:191]
    ds_read_b128 a[216:219], v3 offset:6144
    ds_read_b128 a[220:223], v3 offset:7168
    v_cvt_pk_bf16_f32 v207, v246, v247
    v_mfma_f32_16x16x32_bf16 v[184:187], a[188:191], v[108:111], v[184:187]
    v_bitop3_b32 v57, v57, v207, s37 bitop3:0xa8
    v_cmp_ne_u32 vcc, 0, v57
    v_mfma_f32_16x16x32_bf16 v[188:191], a[188:191], v[124:127], v[188:191]
    s_cbranch_vccnz k2_tramp_102
k2_ret_103:
    s_load_dwordx2 s[4:5], s[0:1], 40
    s_load_dwordx2 s[8:9], s[0:1], 80
    s_add_u32 s24, s6, 0x3000000
    s_addc_u32 s25, s7, 0
    s_and_b32 s25, s25, 0xffff
    s_mov_b32 s26, 0x1000000
    s_mov_b32 s27, 0x00020000
    s_lshl_b32 s31, s28, 19
    s_lshl_b32 s44, s38, 6
    s_add_u32 s44, s44, s31
    s_add_u32 s45, s44, 131072
    s_add_u32 s46, s44, 262144
    s_add_u32 s47, s44, 393216
    s_add_u32 s48, s44, 4096
    s_add_u32 s49, s44, 135168
    s_add_u32 s50, s44, 266240
    s_add_u32 s51, s44, 397312
    v_mov_b32 v13, v12
    v_mov_b32 v49, v48
    s_nop 1
    v_permlane16_swap_b32 v12, v13
    v_permlane16_swap_b32 v48, v49
    s_nop 1
    v_add_f32 v12, v12, v13
    v_add_f32 v48, v48, v49
    v_mov_b32 v13, v12
    v_mov_b32 v49, v48
    s_nop 1
    v_permlane32_swap_b32 v12, v13
    v_permlane32_swap_b32 v48, v49
    s_nop 1
    v_add_f32 v12, v12, v13
    v_add_f32 v48, v48, v49
    v_rcp_f32 v13, v12
    v_rcp_f32 v49, v48
    v_rcp_f32 v12, v12
    v_rcp_f32 v48, v48
    s_nop 0
    v_accvgpr_read_b32 v68, a0
    v_accvgpr_read_b32 v69, a1
    v_accvgpr_read_b32 v70, a2
    v_accvgpr_read_b32 v71, a3
    v_accvgpr_read_b32 v72, a16
    v_accvgpr_read_b32 v73, a17
    v_accvgpr_read_b32 v74, a18
    v_accvgpr_read_b32 v75, a19
    v_pk_mul_f32 v[68:69], v[68:69], v[12:13]
    v_pk_mul_f32 v[70:71], v[70:71], v[12:13]
    v_pk_mul_f32 v[72:73], v[72:73], v[12:13]
    v_pk_mul_f32 v[74:75], v[74:75], v[12:13]
    v_cvt_pk_bf16_f32 v64, v68, v69
    v_cvt_pk_bf16_f32 v65, v70, v71
    v_cvt_pk_bf16_f32 v66, v72, v73
    v_cvt_pk_bf16_f32 v67, v74, v75
    buffer_store_dwordx4 v[64:67], v1, s[24:27], s44 offen sc1
    v_accvgpr_read_b32 v80, a32
    v_accvgpr_read_b32 v81, a33
    v_accvgpr_read_b32 v82, a34
    v_accvgpr_read_b32 v83, a35
    v_accvgpr_read_b32 v84, a48
    v_accvgpr_read_b32 v85, a49
    v_accvgpr_read_b32 v86, a50
    v_accvgpr_read_b32 v87, a51
    v_pk_mul_f32 v[80:81], v[80:81], v[12:13]
    v_pk_mul_f32 v[82:83], v[82:83], v[12:13]
    v_pk_mul_f32 v[84:85], v[84:85], v[12:13]
    v_pk_mul_f32 v[86:87], v[86:87], v[12:13]
    v_cvt_pk_bf16_f32 v76, v80, v81
    v_cvt_pk_bf16_f32 v77, v82, v83
    v_cvt_pk_bf16_f32 v78, v84, v85
    v_cvt_pk_bf16_f32 v79, v86, v87
    buffer_store_dwordx4 v[76:79], v1, s[24:27], s45 offen sc1
    v_accvgpr_read_b32 v68, a64
    v_accvgpr_read_b32 v69, a65
    v_accvgpr_read_b32 v70, a66
    v_accvgpr_read_b32 v71, a67
    v_accvgpr_read_b32 v72, a80
    v_accvgpr_read_b32 v73, a81
    v_accvgpr_read_b32 v74, a82
    v_accvgpr_read_b32 v75, a83
    v_pk_mul_f32 v[68:69], v[68:69], v[12:13]
    v_pk_mul_f32 v[70:71], v[70:71], v[12:13]
    v_pk_mul_f32 v[72:73], v[72:73], v[12:13]
    v_pk_mul_f32 v[74:75], v[74:75], v[12:13]
    v_cvt_pk_bf16_f32 v64, v68, v69
    v_cvt_pk_bf16_f32 v65, v70, v71
    v_cvt_pk_bf16_f32 v66, v72, v73
    v_cvt_pk_bf16_f32 v67, v74, v75
    buffer_store_dwordx4 v[64:67], v1, s[24:27], s46 offen sc1
    v_accvgpr_read_b32 v80, a96
    v_accvgpr_read_b32 v81, a97
    v_accvgpr_read_b32 v82, a98
    v_accvgpr_read_b32 v83, a99
    v_accvgpr_read_b32 v84, a112
    v_accvgpr_read_b32 v85, a113
    v_accvgpr_read_b32 v86, a114
    v_accvgpr_read_b32 v87, a115
    v_pk_mul_f32 v[80:81], v[80:81], v[12:13]
    v_pk_mul_f32 v[82:83], v[82:83], v[12:13]
    v_pk_mul_f32 v[84:85], v[84:85], v[12:13]
    v_pk_mul_f32 v[86:87], v[86:87], v[12:13]
    v_cvt_pk_bf16_f32 v76, v80, v81
    v_cvt_pk_bf16_f32 v77, v82, v83
    v_cvt_pk_bf16_f32 v78, v84, v85
    v_cvt_pk_bf16_f32 v79, v86, v87
    buffer_store_dwordx4 v[76:79], v1, s[24:27], s47 offen sc1
    v_accvgpr_read_b32 v68, a4
    v_accvgpr_read_b32 v69, a5
    v_accvgpr_read_b32 v70, a6
    v_accvgpr_read_b32 v71, a7
    v_accvgpr_read_b32 v72, a20
    v_accvgpr_read_b32 v73, a21
    v_accvgpr_read_b32 v74, a22
    v_accvgpr_read_b32 v75, a23
    v_pk_mul_f32 v[68:69], v[68:69], v[48:49]
    v_pk_mul_f32 v[70:71], v[70:71], v[48:49]
    v_pk_mul_f32 v[72:73], v[72:73], v[48:49]
    v_pk_mul_f32 v[74:75], v[74:75], v[48:49]
    v_cvt_pk_bf16_f32 v64, v68, v69
    v_cvt_pk_bf16_f32 v65, v70, v71
    v_cvt_pk_bf16_f32 v66, v72, v73
    v_cvt_pk_bf16_f32 v67, v74, v75
    buffer_store_dwordx4 v[64:67], v1, s[24:27], s48 offen sc1
    v_accvgpr_read_b32 v80, a36
    v_accvgpr_read_b32 v81, a37
    v_accvgpr_read_b32 v82, a38
    v_accvgpr_read_b32 v83, a39
    v_accvgpr_read_b32 v84, a52
    v_accvgpr_read_b32 v85, a53
    v_accvgpr_read_b32 v86, a54
    v_accvgpr_read_b32 v87, a55
    v_pk_mul_f32 v[80:81], v[80:81], v[48:49]
    v_pk_mul_f32 v[82:83], v[82:83], v[48:49]
    v_pk_mul_f32 v[84:85], v[84:85], v[48:49]
    v_pk_mul_f32 v[86:87], v[86:87], v[48:49]
    v_cvt_pk_bf16_f32 v76, v80, v81
    v_cvt_pk_bf16_f32 v77, v82, v83
    v_cvt_pk_bf16_f32 v78, v84, v85
    v_cvt_pk_bf16_f32 v79, v86, v87
    buffer_store_dwordx4 v[76:79], v1, s[24:27], s49 offen sc1
    v_accvgpr_read_b32 v68, a68
    v_accvgpr_read_b32 v69, a69
    v_accvgpr_read_b32 v70, a70
    v_accvgpr_read_b32 v71, a71
    v_accvgpr_read_b32 v72, a84
    v_accvgpr_read_b32 v73, a85
    v_accvgpr_read_b32 v74, a86
    v_accvgpr_read_b32 v75, a87
    v_pk_mul_f32 v[68:69], v[68:69], v[48:49]
    v_pk_mul_f32 v[70:71], v[70:71], v[48:49]
    v_pk_mul_f32 v[72:73], v[72:73], v[48:49]
    v_pk_mul_f32 v[74:75], v[74:75], v[48:49]
    v_cvt_pk_bf16_f32 v64, v68, v69
    v_cvt_pk_bf16_f32 v65, v70, v71
    v_cvt_pk_bf16_f32 v66, v72, v73
    v_cvt_pk_bf16_f32 v67, v74, v75
    buffer_store_dwordx4 v[64:67], v1, s[24:27], s50 offen sc1
    v_accvgpr_read_b32 v80, a100
    v_accvgpr_read_b32 v81, a101
    v_accvgpr_read_b32 v82, a102
    v_accvgpr_read_b32 v83, a103
    v_accvgpr_read_b32 v84, a116
    v_accvgpr_read_b32 v85, a117
    v_accvgpr_read_b32 v86, a118
    v_accvgpr_read_b32 v87, a119
    v_pk_mul_f32 v[80:81], v[80:81], v[48:49]
    v_pk_mul_f32 v[82:83], v[82:83], v[48:49]
    v_pk_mul_f32 v[84:85], v[84:85], v[48:49]
    v_pk_mul_f32 v[86:87], v[86:87], v[48:49]
    v_cvt_pk_bf16_f32 v76, v80, v81
    v_cvt_pk_bf16_f32 v77, v82, v83
    v_cvt_pk_bf16_f32 v78, v84, v85
    v_cvt_pk_bf16_f32 v79, v86, v87
    buffer_store_dwordx4 v[76:79], v1, s[24:27], s51 offen sc1
    s_and_b32 s31, s2, 7
    s_mul_i32 s31, s31, 28
    s_lshr_b32 s40, s2, 3
    s_add_u32 s31, s31, s40
    s_lshl_b32 s31, s31, 15
    s_lshl_b32 s40, s30, 13
    s_add_u32 s31, s31, s40
    s_cmp_ge_u32 s2, 224
    s_cselect_b32 s10, 0, 7340032
    s_waitcnt lgkmcnt(0)
    s_and_b32 s9, s9, 0xffff
    s_add_u32 m0, s40, 131072
    s_nop 0
    buffer_load_dwordx4 v1, s[8:11], s31 offen offset:0 lds
    buffer_load_dwordx4 v1, s[8:11], s31 offen offset:1024 lds
    buffer_load_dwordx4 v1, s[8:11], s31 offen offset:2048 lds
    buffer_load_dwordx4 v1, s[8:11], s31 offen offset:3072 lds
    s_add_u32 s31, s31, 4096
    s_add_u32 m0, s40, 135168
    s_nop 0
    buffer_load_dwordx4 v1, s[8:11], s31 offen offset:0 lds
    buffer_load_dwordx4 v1, s[8:11], s31 offen offset:1024 lds
    buffer_load_dwordx4 v1, s[8:11], s31 offen offset:2048 lds
    buffer_load_dwordx4 v1, s[8:11], s31 offen offset:3072 lds
    s_add_u32 s31, s31, 4096
    s_nop 1
    s_lshr_b32 s31, s2, 3
    s_bfe_u32 s56, s2, 0x10002
    s_and_b32 s54, s2, 1
    s_lshl_b32 s54, s54, 3
    s_and_b32 s55, s31, 7
    s_add_u32 s54, s54, s55
    s_and_b32 s55, s2, 2
    s_lshl_b32 s55, s55, 1
    s_lshr_b32 s31, s31, 3
    s_add_u32 s55, s55, s31
    v_lshrrev_b32 v87, 4, v1
    v_lshrrev_b32 v72, 4, v87
    s_lshl_b32 s57, s54, 7
    s_lshl_b32 s31, s30, 5
    s_add_u32 s57, s57, s31
    s_lshl_b32 s31, s57, 6
    v_add_u32 v88, s31, v1
    v_add_u32 v89, 0x20000, v88
    v_bfe_u32 v84, v87, 1, 3
    v_xor_b32 v84, v84, v72
    v_and_b32 v85, 16, v1
    v_lshl_add_u32 v85, v72, 11, v85
    s_lshl_b32 s31, s30, 15
    s_lshl_b32 s58, s55, 8
    s_add_u32 s31, s31, s58
    v_add_u32 v85, s31, v85
    v_xor_b32 v86, 0, v84
    v_lshl_add_u32 v86, v86, 5, v85
    v_add_u32 v90, 0, v86
    v_xor_b32 v86, 4, v84
    v_lshl_add_u32 v86, v86, 5, v85
    v_add_u32 v91, 7168, v86
    v_xor_b32 v86, 0, v84
    v_lshl_add_u32 v86, v86, 5, v85
    v_add_u32 v92, 14336, v86
    v_xor_b32 v86, 4, v84
    v_lshl_add_u32 v86, v86, 5, v85
    v_add_u32 v93, 21504, v86
    v_and_b32 v84, 15, v87
    v_add_u32 v85, s57, v84
    v_lshlrev_b32 v77, 2, v85
    v_lshl_add_u32 v77, v72, 13, v77
    s_lshl_b32 s31, s56, 7
    s_add_u32 s58, s58, s31
    v_lshl_add_u32 v80, v72, 3, s58
    v_lshl_add_u32 v78, v85, 11, v80
    v_add_u32 v79, 0x8000, v78
    v_lshrrev_b32 v85, 2, v84
    v_lshl_add_u32 v85, v72, 2, v85
    v_and_b32 v84, 7, v85
    s_lshl_b32 s31, s56, 2
    v_xor_b32 v84, s31, v84
    v_lshlrev_b32 v85, 8, v85
    v_and_b32 v86, 3, v87
    v_lshl_add_u32 v85, v86, 3, v85
    s_add_u32 s31, s2, 1
    s_and_b32 s31, s31, 3
    v_add_u32 v73, s31, v86
    v_and_b32 v73, 3, v73
    v_lshlrev_b32 v73, 7, v73
    v_xor_b32 v86, 0, v84
    v_lshl_add_u32 v64, v86, 5, v85
    v_xor_b32 v86, 1, v84
    v_lshl_add_u32 v65, v86, 5, v85
    v_xor_b32 v86, 2, v84
    v_lshl_add_u32 v66, v86, 5, v85
    v_xor_b32 v86, 3, v84
    v_lshl_add_u32 v67, v86, 5, v85
    v_xor_b32 v86, 4, v84
    v_lshl_add_u32 v68, v86, 5, v85
    v_xor_b32 v86, 5, v84
    v_lshl_add_u32 v69, v86, 5, v85
    v_xor_b32 v86, 6, v84
    v_lshl_add_u32 v70, v86, 5, v85
    v_xor_b32 v86, 7, v84
    v_lshl_add_u32 v71, v86, 5, v85
    s_lshl_b32 s61, s31, 20
    s_lshl_b32 s62, s31, 21
    s_lshl_b32 s60, s30, 12
    s_lshl_b32 s59, s54, 10
    s_lshl_b32 s31, s56, 9
    s_add_u32 s59, s59, s31
    s_lshr_b32 s31, s28, 2
    s_lshl_b32 s31, s31, 7
    s_lshl_b32 s57, s29, 10
    s_sub_u32 s58, 0x3c00, s57
    s_add_u32 s57, s57, s31
    s_add_u32 s58, s58, s31
    v_mov_b32 v75, 0
    v_mov_b32 v76, 1
    s_lshl_b32 s31, s56, 23
    s_add_u32 s31, s31, 0x3000000
    s_add_u32 s8, s6, s31
    s_addc_u32 s9, s7, 0
    s_and_b32 s9, s9, 0xffff
    s_mov_b32 s10, 0x800000
    s_lshl_b32 s31, s56, 22
    s_waitcnt lgkmcnt(0)
    s_add_u32 s12, s4, s31
    s_addc_u32 s13, s5, 0
    s_and_b32 s13, s13, 0xffff
    s_mov_b32 s14, 0x400000
    s_lshl_b32 s63, s29, 1
    s_sub_u32 s63, 13, s63
    s_cbranch_scc1 k2_sdone_105
k2_sloop_104:
    v_mfma_f32_16x16x32_bf16 v[248:251], v[60:63], v[192:195], v[248:251]
    v_exp_f32 v232, v160
    v_mfma_f32_16x16x32_bf16 v[252:255], v[60:63], v[196:199], v[252:255]
    s_mov_b32 m0, s35
    ds_read_b128 a[224:227], v3 offset:8192
    v_mfma_f32_16x16x32_bf16 v[248:251], v[60:63], v[200:203], v[248:251]
    s_add_u32 s53, s53, 16384
    buffer_load_dwordx4 v1, s[20:23], s33 offen offset:0 sc1 lds
    ds_read_b128 a[228:231], v3 offset:9216
    v_mfma_f32_16x16x32_bf16 v[252:255], v[60:63], v[204:207], v[252:255]
    s_waitcnt lgkmcnt(8)
    v_exp_f32 v233, v161
    v_mfma_f32_16x16x32_bf16 a[8:11], a[192:195], v[192:195], a[8:11]
    s_and_b32 s53, s53, 0xffff
    v_exp_f32 v234, v162
    v_mfma_f32_16x16x32_bf16 a[12:15], a[192:195], v[196:199], a[12:15]
    ds_read_b128 a[232:235], v3 offset:10240
    v_cvt_pk_bf16_f32 v208, v232, v233
    v_mfma_f32_16x16x32_bf16 a[24:27], a[196:199], v[192:195], a[24:27]
    v_exp_f32 v235, v163
    v_mfma_f32_16x16x32_bf16 a[28:31], a[196:199], v[196:199], a[28:31]
    s_waitcnt lgkmcnt(7)
    ds_read_b128 a[236:239], v3 offset:11264
    v_cvt_pk_bf16_f32 v209, v234, v235
    v_mfma_f32_16x16x32_bf16 a[40:43], a[200:203], v[192:195], a[40:43]
    s_add_u32 s35, s35, 0x4000
    v_exp_f32 v236, v176
    v_mfma_f32_16x16x32_bf16 a[44:47], a[200:203], v[196:199], a[44:47]
    buffer_load_dwordx4 v1, s[20:23], s33 offen offset:1024 sc1 lds
    ds_read_b128 a[240:243], v3 offset:12288
    v_mfma_f32_16x16x32_bf16 a[56:59], a[204:207], v[192:195], a[56:59]
    v_exp_f32 v237, v177
    v_mfma_f32_16x16x32_bf16 a[60:63], a[204:207], v[196:199], a[60:63]
    s_waitcnt lgkmcnt(7)
    ds_read_b128 a[244:247], v3 offset:13312
    v_cvt_pk_bf16_f32 v210, v236, v237
    v_mfma_f32_16x16x32_bf16 a[72:75], a[208:211], v[192:195], a[72:75]
    v_exp_f32 v238, v178
    v_mfma_f32_16x16x32_bf16 a[76:79], a[208:211], v[196:199], a[76:79]
    ds_read_b128 a[248:251], v3 offset:14336
    v_or3_b32 v57, v208, v209, v210
    v_mfma_f32_16x16x32_bf16 a[88:91], a[212:215], v[192:195], a[88:91]
    v_exp_f32 v239, v179
    v_mfma_f32_16x16x32_bf16 a[92:95], a[212:215], v[196:199], a[92:95]
    s_waitcnt lgkmcnt(7)
    ds_read_b128 a[252:255], v3 offset:15360
    v_cvt_pk_bf16_f32 v211, v238, v239
    v_mfma_f32_16x16x32_bf16 a[104:107], a[216:219], v[192:195], a[104:107]
    s_and_b32 s35, s35, 0xffff
    v_exp_f32 v240, v164
    v_mfma_f32_16x16x32_bf16 a[108:111], a[216:219], v[196:199], a[108:111]
    ds_read_b128 a[128:131], v2 offset:0
    v_add_u32 v3, s53, v56
    v_mfma_f32_16x16x32_bf16 a[120:123], a[220:223], v[192:195], a[120:123]
    v_exp_f32 v241, v165
    v_mfma_f32_16x16x32_bf16 a[124:127], a[220:223], v[196:199], a[124:127]
    s_waitcnt lgkmcnt(7)
    buffer_load_dwordx4 v1, s[20:23], s33 offen offset:2048 sc1 lds
    ds_read_b128 a[132:135], v2 offset:1024
    v_mfma_f32_16x16x32_bf16 a[8:11], a[224:227], v[200:203], a[8:11]
    v_exp_f32 v242, v166
    v_mfma_f32_16x16x32_bf16 a[12:15], a[224:227], v[204:207], a[12:15]
    s_or_b32 s35, s35, 0x10000
    ds_read_b128 a[136:139], v2 offset:2048
    v_cvt_pk_bf16_f32 v212, v240, v241
    v_mfma_f32_16x16x32_bf16 a[24:27], a[228:231], v[200:203], a[24:27]
    v_exp_f32 v243, v167
    v_mfma_f32_16x16x32_bf16 a[28:31], a[228:231], v[204:207], a[28:31]
    s_waitcnt lgkmcnt(7)
    ds_read_b128 a[140:143], v2 offset:3072
    v_or3_b32 v57, v57, v211, v212
    v_mfma_f32_16x16x32_bf16 a[40:43], a[232:235], v[200:203], a[40:43]
    v_exp_f32 v244, v180
    v_mfma_f32_16x16x32_bf16 a[44:47], a[232:235], v[204:207], a[44:47]
    ds_read_b128 a[144:147], v2 offset:4096
    v_cvt_pk_bf16_f32 v213, v242, v243
    v_mfma_f32_16x16x32_bf16 a[56:59], a[236:239], v[200:203], a[56:59]
    v_exp_f32 v245, v181
    v_mfma_f32_16x16x32_bf16 a[60:63], a[236:239], v[204:207], a[60:63]
    s_waitcnt lgkmcnt(7)
    buffer_load_dwordx4 v1, s[20:23], s33 offen offset:3072 sc1 lds
    ds_read_b128 a[148:151], v2 offset:5120
    v_mfma_f32_16x16x32_bf16 a[72:75], a[240:243], v[200:203], a[72:75]
    s_add_u32 s33, s33, 0x80000
    v_exp_f32 v246, v182
    v_mfma_f32_16x16x32_bf16 a[76:79], a[240:243], v[204:207], a[76:79]
    ds_read_b128 a[152:155], v2 offset:6144
    v_cvt_pk_bf16_f32 v214, v244, v245
    v_mfma_f32_16x16x32_bf16 a[88:91], a[244:247], v[200:203], a[88:91]
    v_exp_f32 v247, v183
    v_mfma_f32_16x16x32_bf16 a[92:95], a[244:247], v[204:207], a[92:95]
    s_waitcnt lgkmcnt(7)
    ds_read_b128 a[156:159], v2 offset:7168
    v_or3_b32 v57, v57, v213, v214
    v_mfma_f32_16x16x32_bf16 a[104:107], a[248:251], v[200:203], a[104:107]
    v_exp_f32 v232, v168
    v_mfma_f32_16x16x32_bf16 a[108:111], a[248:251], v[204:207], a[108:111]
    ds_read_b128 a[160:163], v2 offset:8192
    v_cvt_pk_bf16_f32 v215, v246, v247
    v_mfma_f32_16x16x32_bf16 a[120:123], a[252:255], v[200:203], a[120:123]
    v_exp_f32 v233, v169
    v_mfma_f32_16x16x32_bf16 a[124:127], a[252:255], v[204:207], a[124:127]
    s_waitcnt lgkmcnt(7)
    ds_read_b128 a[164:167], v2 offset:9216
    v_cvt_pk_bf16_f32 v216, v232, v233
    v_mfma_f32_16x16x32_bf16 v[128:131], a[128:131], v[96:99], v[16:19]
    s_waitcnt vmcnt(12)
    s_barrier
    v_exp_f32 v234, v170
    v_mfma_f32_16x16x32_bf16 v[132:135], a[128:131], v[112:115], v[20:23]
    s_mov_b32 m0, s34
    ds_read_b128 a[168:171], v2 offset:10240
    v_or3_b32 v57, v57, v215, v216
    v_mfma_f32_16x16x32_bf16 v[128:131], a[132:135], v[100:103], v[128:131]
    buffer_load_dwordx4 v1, s[16:19], s32 offen offset:0 sc1 lds
    ds_read_b128 a[172:175], v2 offset:11264
    v_mfma_f32_16x16x32_bf16 v[132:135], a[132:135], v[116:119], v[132:135]
    s_waitcnt lgkmcnt(8)
    v_exp_f32 v235, v171
    v_mfma_f32_16x16x32_bf16 v[128:131], a[136:139], v[104:107], v[128:131]
    s_add_u32 s36, s36, 64
    v_exp_f32 v236, v184
    v_mfma_f32_16x16x32_bf16 v[132:135], a[136:139], v[120:123], v[132:135]
    ds_read_b128 a[176:179], v2 offset:12288
    v_cvt_pk_bf16_f32 v217, v234, v235
    v_mfma_f32_16x16x32_bf16 v[128:131], a[140:143], v[108:111], v[128:131]
    s_add_u32 s52, s52, 16384
    v_exp_f32 v237, v185
    v_mfma_f32_16x16x32_bf16 v[132:135], a[140:143], v[124:127], v[132:135]
    s_waitcnt lgkmcnt(7)
    ds_read_b128 a[180:183], v2 offset:13312
    v_cvt_pk_bf16_f32 v218, v236, v237
    v_mfma_f32_16x16x32_bf16 v[144:147], a[144:147], v[96:99], v[32:35]
    s_add_u32 s34, s34, 0x4000
    v_exp_f32 v238, v186
    v_mfma_f32_16x16x32_bf16 v[148:151], a[144:147], v[112:115], v[36:39]
    s_and_b32 s52, s52, 0xffff
    buffer_load_dwordx4 v1, s[16:19], s32 offen offset:1024 sc1 lds
    ds_read_b128 a[184:187], v2 offset:14336
    v_mfma_f32_16x16x32_bf16 v[144:147], a[148:151], v[100:103], v[144:147]
    v_exp_f32 v239, v187
    v_mfma_f32_16x16x32_bf16 v[148:151], a[148:151], v[116:119], v[148:151]
    s_waitcnt lgkmcnt(7)
    ds_read_b128 a[188:191], v2 offset:15360
    v_or3_b32 v57, v57, v217, v218
    v_mfma_f32_16x16x32_bf16 v[144:147], a[152:155], v[104:107], v[144:147]
    v_exp_f32 v240, v172
    v_mfma_f32_16x16x32_bf16 v[148:151], a[152:155], v[120:123], v[148:151]
    v_cvt_pk_bf16_f32 v219, v238, v239
    v_add_u32 v2, s52, v1
    v_mfma_f32_16x16x32_bf16 v[144:147], a[156:159], v[108:111], v[144:147]
    s_and_b32 s34, s34, 0xffff
    v_exp_f32 v241, v173
    v_mfma_f32_16x16x32_bf16 v[148:151], a[156:159], v[124:127], v[148:151]
    s_waitcnt lgkmcnt(6)
    ds_read_b128 a[192:195], v3 offset:0
    v_cvt_pk_bf16_f32 v220, v240, v241
    v_mfma_f32_16x16x32_bf16 v[136:139], a[160:163], v[96:99], v[24:27]
    v_exp_f32 v242, v174
    v_mfma_f32_16x16x32_bf16 v[140:143], a[160:163], v[112:115], v[28:31]
    buffer_load_dwordx4 v1, s[16:19], s32 offen offset:2048 sc1 lds
    ds_read_b128 a[196:199], v3 offset:1024
    v_mfma_f32_16x16x32_bf16 v[136:139], a[164:167], v[100:103], v[136:139]
    v_exp_f32 v243, v175
    v_mfma_f32_16x16x32_bf16 v[140:143], a[164:167], v[116:119], v[140:143]
    s_waitcnt lgkmcnt(6)
    ds_read_b128 a[200:203], v3 offset:2048
    v_or3_b32 v57, v57, v219, v220
    v_mfma_f32_16x16x32_bf16 v[136:139], a[168:171], v[104:107], v[136:139]
    v_exp_f32 v244, v188
    v_mfma_f32_16x16x32_bf16 v[140:143], a[168:171], v[120:123], v[140:143]
    ds_read_b128 a[204:207], v3 offset:3072
    v_cvt_pk_bf16_f32 v221, v242, v243
    v_mfma_f32_16x16x32_bf16 v[136:139], a[172:175], v[108:111], v[136:139]
    v_exp_f32 v245, v189
    v_mfma_f32_16x16x32_bf16 v[140:143], a[172:175], v[124:127], v[140:143]
    s_waitcnt lgkmcnt(6)
    buffer_load_dwordx4 v1, s[16:19], s32 offen offset:3072 sc1 lds
    ds_read_b128 a[208:211], v3 offset:4096
    v_mfma_f32_16x16x32_bf16 v[152:155], a[176:179], v[96:99], v[40:43]
    s_add_u32 s32, s32, 0x80000
    v_exp_f32 v246, v190
    v_mfma_f32_16x16x32_bf16 v[156:159], a[176:179], v[112:115], v[44:47]
    ds_read_b128 a[212:215], v3 offset:5120
    v_cvt_pk_bf16_f32 v222, v244, v245
    v_mfma_f32_16x16x32_bf16 v[152:155], a[180:183], v[100:103], v[152:155]
    v_exp_f32 v247, v191
    v_mfma_f32_16x16x32_bf16 v[156:159], a[180:183], v[116:119], v[156:159]
    s_waitcnt lgkmcnt(6)
    ds_read_b128 a[216:219], v3 offset:6144
    v_or3_b32 v57, v57, v221, v222
    v_mfma_f32_16x16x32_bf16 v[152:155], a[184:187], v[104:107], v[152:155]
    ds_read_b128 a[220:223], v3 offset:7168
    v_cvt_pk_bf16_f32 v223, v246, v247
    v_mfma_f32_16x16x32_bf16 v[156:159], a[184:187], v[120:123], v[156:159]
    v_bitop3_b32 v57, v57, v223, s37 bitop3:0xa8
    v_cmp_ne_u32 vcc, 0, v57
    v_mfma_f32_16x16x32_bf16 v[152:155], a[188:191], v[108:111], v[152:155]
    v_mfma_f32_16x16x32_bf16 v[156:159], a[188:191], v[124:127], v[156:159]
    s_cbranch_vccnz k2_tramp_106
k2_ret_107:
    v_mfma_f32_16x16x32_bf16 v[248:251], v[60:63], v[208:211], v[248:251]
    v_exp_f32 v232, v128
    v_mfma_f32_16x16x32_bf16 v[252:255], v[60:63], v[212:215], v[252:255]
    s_mov_b32 m0, s35
    ds_read_b128 a[224:227], v3 offset:8192
    v_mfma_f32_16x16x32_bf16 v[248:251], v[60:63], v[216:219], v[248:251]
    s_add_u32 s53, s53, 16384
    buffer_load_dwordx4 v1, s[20:23], s33 offen offset:0 sc1 lds
    ds_read_b128 a[228:231], v3 offset:9216
    v_mfma_f32_16x16x32_bf16 v[252:255], v[60:63], v[220:223], v[252:255]
    s_waitcnt lgkmcnt(8)
    v_exp_f32 v233, v129
    v_mfma_f32_16x16x32_bf16 a[8:11], a[192:195], v[208:211], a[8:11]
    s_and_b32 s53, s53, 0xffff
    v_exp_f32 v234, v130
    v_mfma_f32_16x16x32_bf16 a[12:15], a[192:195], v[212:215], a[12:15]
    ds_read_b128 a[232:235], v3 offset:10240
    v_cvt_pk_bf16_f32 v192, v232, v233
    v_mfma_f32_16x16x32_bf16 a[24:27], a[196:199], v[208:211], a[24:27]
    v_exp_f32 v235, v131
    v_mfma_f32_16x16x32_bf16 a[28:31], a[196:199], v[212:215], a[28:31]
    s_waitcnt lgkmcnt(7)
    ds_read_b128 a[236:239], v3 offset:11264
    v_cvt_pk_bf16_f32 v193, v234, v235
    v_mfma_f32_16x16x32_bf16 a[40:43], a[200:203], v[208:211], a[40:43]
    s_add_u32 s35, s35, 0x4000
    v_exp_f32 v236, v144
    v_mfma_f32_16x16x32_bf16 a[44:47], a[200:203], v[212:215], a[44:47]
    buffer_load_dwordx4 v1, s[20:23], s33 offen offset:1024 sc1 lds
    ds_read_b128 a[240:243], v3 offset:12288
    v_mfma_f32_16x16x32_bf16 a[56:59], a[204:207], v[208:211], a[56:59]
    v_exp_f32 v237, v145
    v_mfma_f32_16x16x32_bf16 a[60:63], a[204:207], v[212:215], a[60:63]
    s_waitcnt lgkmcnt(7)
    ds_read_b128 a[244:247], v3 offset:13312
    v_cvt_pk_bf16_f32 v194, v236, v237
    v_mfma_f32_16x16x32_bf16 a[72:75], a[208:211], v[208:211], a[72:75]
    v_exp_f32 v238, v146
    v_mfma_f32_16x16x32_bf16 a[76:79], a[208:211], v[212:215], a[76:79]
    ds_read_b128 a[248:251], v3 offset:14336
    v_or3_b32 v57, v192, v193, v194
    v_mfma_f32_16x16x32_bf16 a[88:91], a[212:215], v[208:211], a[88:91]
    v_exp_f32 v239, v147
    v_mfma_f32_16x16x32_bf16 a[92:95], a[212:215], v[212:215], a[92:95]
    s_waitcnt lgkmcnt(7)
    ds_read_b128 a[252:255], v3 offset:15360
    v_cvt_pk_bf16_f32 v195, v238, v239
    v_mfma_f32_16x16x32_bf16 a[104:107], a[216:219], v[208:211], a[104:107]
    s_and_b32 s35, s35, 0xffff
    v_exp_f32 v240, v132
    v_mfma_f32_16x16x32_bf16 a[108:111], a[216:219], v[212:215], a[108:111]
    ds_read_b128 a[128:131], v2 offset:0
    v_add_u32 v3, s53, v56
    v_mfma_f32_16x16x32_bf16 a[120:123], a[220:223], v[208:211], a[120:123]
    v_exp_f32 v241, v133
    v_mfma_f32_16x16x32_bf16 a[124:127], a[220:223], v[212:215], a[124:127]
    s_waitcnt lgkmcnt(7)
    buffer_load_dwordx4 v1, s[20:23], s33 offen offset:2048 sc1 lds
    ds_read_b128 a[132:135], v2 offset:1024
    v_mfma_f32_16x16x32_bf16 a[8:11], a[224:227], v[216:219], a[8:11]
    v_exp_f32 v242, v134
    v_mfma_f32_16x16x32_bf16 a[12:15], a[224:227], v[220:223], a[12:15]
    s_or_b32 s35, s35, 0x10000
    ds_read_b128 a[136:139], v2 offset:2048
    v_cvt_pk_bf16_f32 v196, v240, v241
    v_mfma_f32_16x16x32_bf16 a[24:27], a[228:231], v[216:219], a[24:27]
    v_exp_f32 v243, v135
    v_mfma_f32_16x16x32_bf16 a[28:31], a[228:231], v[220:223], a[28:31]
    s_waitcnt lgkmcnt(7)
    ds_read_b128 a[140:143], v2 offset:3072
    v_or3_b32 v57, v57, v195, v196
    v_mfma_f32_16x16x32_bf16 a[40:43], a[232:235], v[216:219], a[40:43]
    v_exp_f32 v244, v148
    v_mfma_f32_16x16x32_bf16 a[44:47], a[232:235], v[220:223], a[44:47]
    ds_read_b128 a[144:147], v2 offset:4096
    v_cvt_pk_bf16_f32 v197, v242, v243
    v_mfma_f32_16x16x32_bf16 a[56:59], a[236:239], v[216:219], a[56:59]
    v_exp_f32 v245, v149
    v_mfma_f32_16x16x32_bf16 a[60:63], a[236:239], v[220:223], a[60:63]
    s_waitcnt lgkmcnt(7)
    buffer_load_dwordx4 v1, s[20:23], s33 offen offset:3072 sc1 lds
    ds_read_b128 a[148:151], v2 offset:5120
    v_mfma_f32_16x16x32_bf16 a[72:75], a[240:243], v[216:219], a[72:75]
    s_add_u32 s33, s33, 0x80000
    v_exp_f32 v246, v150
    v_mfma_f32_16x16x32_bf16 a[76:79], a[240:243], v[220:223], a[76:79]
    ds_read_b128 a[152:155], v2 offset:6144
    v_cvt_pk_bf16_f32 v198, v244, v245
    v_mfma_f32_16x16x32_bf16 a[88:91], a[244:247], v[216:219], a[88:91]
    v_exp_f32 v247, v151
    v_mfma_f32_16x16x32_bf16 a[92:95], a[244:247], v[220:223], a[92:95]
    s_waitcnt lgkmcnt(7)
    ds_read_b128 a[156:159], v2 offset:7168
    v_or3_b32 v57, v57, v197, v198
    v_mfma_f32_16x16x32_bf16 a[104:107], a[248:251], v[216:219], a[104:107]
    v_exp_f32 v232, v136
    v_mfma_f32_16x16x32_bf16 a[108:111], a[248:251], v[220:223], a[108:111]
    ds_read_b128 a[160:163], v2 offset:8192
    v_cvt_pk_bf16_f32 v199, v246, v247
    v_mfma_f32_16x16x32_bf16 a[120:123], a[252:255], v[216:219], a[120:123]
    v_exp_f32 v233, v137
    v_mfma_f32_16x16x32_bf16 a[124:127], a[252:255], v[220:223], a[124:127]
    s_waitcnt lgkmcnt(7)
    ds_read_b128 a[164:167], v2 offset:9216
    v_cvt_pk_bf16_f32 v200, v232, v233
    v_mfma_f32_16x16x32_bf16 v[160:163], a[128:131], v[96:99], v[16:19]
    s_waitcnt vmcnt(12)
    s_barrier
    v_exp_f32 v234, v138
    v_mfma_f32_16x16x32_bf16 v[164:167], a[128:131], v[112:115], v[20:23]
    s_mov_b32 m0, s34
    ds_read_b128 a[168:171], v2 offset:10240
    v_or3_b32 v57, v57, v199, v200
    v_mfma_f32_16x16x32_bf16 v[160:163], a[132:135], v[100:103], v[160:163]
    buffer_load_dwordx4 v1, s[16:19], s32 offen offset:0 sc1 lds
    ds_read_b128 a[172:175], v2 offset:11264
    v_mfma_f32_16x16x32_bf16 v[164:167], a[132:135], v[116:119], v[164:167]
    s_waitcnt lgkmcnt(8)
    v_exp_f32 v235, v139
    v_mfma_f32_16x16x32_bf16 v[160:163], a[136:139], v[104:107], v[160:163]
    s_add_u32 s36, s36, 64
    v_exp_f32 v236, v152
    v_mfma_f32_16x16x32_bf16 v[164:167], a[136:139], v[120:123], v[164:167]
    ds_read_b128 a[176:179], v2 offset:12288
    v_cvt_pk_bf16_f32 v201, v234, v235
    v_mfma_f32_16x16x32_bf16 v[160:163], a[140:143], v[108:111], v[160:163]
    s_add_u32 s52, s52, 16384
    v_exp_f32 v237, v153
    v_mfma_f32_16x16x32_bf16 v[164:167], a[140:143], v[124:127], v[164:167]
    s_waitcnt lgkmcnt(7)
    ds_read_b128 a[180:183], v2 offset:13312
    v_cvt_pk_bf16_f32 v202, v236, v237
    v_mfma_f32_16x16x32_bf16 v[176:179], a[144:147], v[96:99], v[32:35]
    s_add_u32 s34, s34, 0x4000
    v_exp_f32 v238, v154
    v_mfma_f32_16x16x32_bf16 v[180:183], a[144:147], v[112:115], v[36:39]
    s_and_b32 s52, s52, 0xffff
    buffer_load_dwordx4 v1, s[16:19], s32 offen offset:1024 sc1 lds
    ds_read_b128 a[184:187], v2 offset:14336
    v_mfma_f32_16x16x32_bf16 v[176:179], a[148:151], v[100:103], v[176:179]
    v_exp_f32 v239, v155
    v_mfma_f32_16x16x32_bf16 v[180:183], a[148:151], v[116:119], v[180:183]
    s_waitcnt lgkmcnt(7)
    ds_read_b128 a[188:191], v2 offset:15360
    v_or3_b32 v57, v57, v201, v202
    v_mfma_f32_16x16x32_bf16 v[176:179], a[152:155], v[104:107], v[176:179]
    v_exp_f32 v240, v140
    v_mfma_f32_16x16x32_bf16 v[180:183], a[152:155], v[120:123], v[180:183]
    v_cvt_pk_bf16_f32 v203, v238, v239
    v_add_u32 v2, s52, v1
    v_mfma_f32_16x16x32_bf16 v[176:179], a[156:159], v[108:111], v[176:179]
    s_and_b32 s34, s34, 0xffff
    v_exp_f32 v241, v141
    v_mfma_f32_16x16x32_bf16 v[180:183], a[156:159], v[124:127], v[180:183]
    s_waitcnt lgkmcnt(6)
    ds_read_b128 a[192:195], v3 offset:0
    v_cvt_pk_bf16_f32 v204, v240, v241
    v_mfma_f32_16x16x32_bf16 v[168:171], a[160:163], v[96:99], v[24:27]
    v_exp_f32 v242, v142
    v_mfma_f32_16x16x32_bf16 v[172:175], a[160:163], v[112:115], v[28:31]
    buffer_load_dwordx4 v1, s[16:19], s32 offen offset:2048 sc1 lds
    ds_read_b128 a[196:199], v3 offset:1024
    v_mfma_f32_16x16x32_bf16 v[168:171], a[164:167], v[100:103], v[168:171]
    v_exp_f32 v243, v143
    v_mfma_f32_16x16x32_bf16 v[172:175], a[164:167], v[116:119], v[172:175]
    s_waitcnt lgkmcnt(6)
    ds_read_b128 a[200:203], v3 offset:2048
    v_or3_b32 v57, v57, v203, v204
    v_mfma_f32_16x16x32_bf16 v[168:171], a[168:171], v[104:107], v[168:171]
    v_exp_f32 v244, v156
    v_mfma_f32_16x16x32_bf16 v[172:175], a[168:171], v[120:123], v[172:175]
    ds_read_b128 a[204:207], v3 offset:3072
    v_cvt_pk_bf16_f32 v205, v242, v243
    v_mfma_f32_16x16x32_bf16 v[168:171], a[172:175], v[108:111], v[168:171]
    v_exp_f32 v245, v157
    v_mfma_f32_16x16x32_bf16 v[172:175], a[172:175], v[124:127], v[172:175]
    s_waitcnt lgkmcnt(6)
    buffer_load_dwordx4 v1, s[16:19], s32 offen offset:3072 sc1 lds
    ds_read_b128 a[208:211], v3 offset:4096
    v_mfma_f32_16x16x32_bf16 v[184:187], a[176:179], v[96:99], v[40:43]
    s_sub_u32 s63, s63, 1
    v_exp_f32 v246, v158
    v_mfma_f32_16x16x32_bf16 v[188:191], a[176:179], v[112:115], v[44:47]
    s_add_u32 s32, s32, 0x80000
    ds_read_b128 a[212:215], v3 offset:5120
    v_cvt_pk_bf16_f32 v206, v244, v245
    v_mfma_f32_16x16x32_bf16 v[184:187], a[180:183], v[100:103], v[184:187]
    v_exp_f32 v247, v159
    v_mfma_f32_16x16x32_bf16 v[188:191], a[180:183], v[116:119], v[188:191]
    s_waitcnt lgkmcnt(6)
    ds_read_b128 a[216:219], v3 offset:6144
    v_or3_b32 v57, v57, v205, v206
    v_mfma_f32_16x16x32_bf16 v[184:187], a[184:187], v[104:107], v[184:187]
    ds_read_b128 a[220:223], v3 offset:7168
    v_cvt_pk_bf16_f32 v207, v246, v247
    v_mfma_f32_16x16x32_bf16 v[188:191], a[184:187], v[120:123], v[188:191]
    v_bitop3_b32 v57, v57, v207, s37 bitop3:0xa8
    v_cmp_ne_u32 vcc, 0, v57
    v_mfma_f32_16x16x32_bf16 v[184:187], a[188:191], v[108:111], v[184:187]
    v_mfma_f32_16x16x32_bf16 v[188:191], a[188:191], v[124:127], v[188:191]
    s_cbranch_vccnz k2_tramp_108
k2_ret_109:
    s_cmp_lg_u32 s63, 0
    s_cbranch_scc1 k2_sloop_104
    v_mfma_f32_16x16x32_bf16 v[248:251], v[60:63], v[192:195], v[248:251]
    v_exp_f32 v232, v160
    v_mfma_f32_16x16x32_bf16 v[252:255], v[60:63], v[196:199], v[252:255]
    s_mov_b32 m0, s35
    ds_read_b128 a[224:227], v3 offset:8192
    v_exp_f32 v233, v161
    v_mfma_f32_16x16x32_bf16 v[248:251], v[60:63], v[200:203], v[248:251]
    s_add_u32 s53, s53, 16384
    buffer_load_dwordx4 v1, s[20:23], s33 offen offset:0 sc1 lds
    ds_read_b128 a[228:231], v3 offset:9216
    v_mfma_f32_16x16x32_bf16 v[252:255], v[60:63], v[204:207], v[252:255]
    s_waitcnt lgkmcnt(8)
    v_exp_f32 v234, v162
    v_cvt_pk_bf16_f32 v208, v232, v233
    v_mfma_f32_16x16x32_bf16 a[8:11], a[192:195], v[192:195], a[8:11]
    s_sub_u32 s40, s36, s39
    ds_read_b128 a[232:235], v3 offset:10240
    v_mfma_f32_16x16x32_bf16 a[12:15], a[192:195], v[196:199], a[12:15]
    s_and_b32 s53, s53, 0xffff
    v_subrev_u32 v6, s40, v4
    v_cmp_gt_i32 s[44:45], 0, v6
    v_mfma_f32_16x16x32_bf16 a[24:27], a[196:199], v[192:195], a[24:27]
    v_exp_f32 v235, v163
    v_cmp_gt_i32 s[46:47], 1, v6
    v_mfma_f32_16x16x32_bf16 a[28:31], a[196:199], v[196:199], a[28:31]
    s_waitcnt lgkmcnt(7)
    ds_read_b128 a[236:239], v3 offset:11264
    v_cmp_gt_i32 s[48:49], 2, v6
    v_cmp_gt_i32 s[50:51], 3, v6
    v_mfma_f32_16x16x32_bf16 a[40:43], a[200:203], v[192:195], a[40:43]
    s_add_u32 s35, s35, 0x4000
    v_exp_f32 v236, v176
    v_mfma_f32_16x16x32_bf16 a[44:47], a[200:203], v[196:199], a[44:47]
    ds_read_b128 a[240:243], v3 offset:12288
    v_cvt_pk_bf16_f32 v209, v234, v235
    v_cndmask_b32 v16, v10, v5, s[44:45]
    v_mfma_f32_16x16x32_bf16 a[56:59], a[204:207], v[192:195], a[56:59]
    v_exp_f32 v237, v177
    v_mfma_f32_16x16x32_bf16 a[60:63], a[204:207], v[196:199], a[60:63]
    s_waitcnt lgkmcnt(7)
    ds_read_b128 a[244:247], v3 offset:13312
    v_cndmask_b32 v17, v10, v5, s[46:47]
    v_cndmask_b32 v18, v10, v5, s[48:49]
    v_mfma_f32_16x16x32_bf16 a[72:75], a[208:211], v[192:195], a[72:75]
    buffer_load_dwordx4 v1, s[20:23], s33 offen offset:1024 sc1 lds
    ds_read_b128 a[248:251], v3 offset:14336
    v_mfma_f32_16x16x32_bf16 a[76:79], a[208:211], v[196:199], a[76:79]
    v_cndmask_b32 v19, v10, v5, s[50:51]
    v_cvt_pk_bf16_f32 v210, v236, v237
    v_mfma_f32_16x16x32_bf16 a[88:91], a[212:215], v[192:195], a[88:91]
    v_exp_f32 v238, v178
    v_cmp_gt_i32 s[44:45], 16, v6
    v_mfma_f32_16x16x32_bf16 a[92:95], a[212:215], v[196:199], a[92:95]
    s_waitcnt lgkmcnt(7)
    v_cmp_gt_i32 s[46:47], 17, v6
    v_cmp_gt_i32 s[48:49], 18, v6
    v_mfma_f32_16x16x32_bf16 a[104:107], a[216:219], v[192:195], a[104:107]
    s_and_b32 s35, s35, 0xffff
    v_exp_f32 v239, v179
    v_mfma_f32_16x16x32_bf16 a[108:111], a[216:219], v[196:199], a[108:111]
    ds_read_b128 a[252:255], v3 offset:15360
    v_or3_b32 v57, v208, v209, v210
    v_cmp_gt_i32 s[50:51], 19, v6
    v_mfma_f32_16x16x32_bf16 a[120:123], a[220:223], v[192:195], a[120:123]
    v_exp_f32 v240, v164
    v_mfma_f32_16x16x32_bf16 a[124:127], a[220:223], v[196:199], a[124:127]
    s_waitcnt lgkmcnt(6)
    v_cndmask_b32 v32, v10, v5, s[44:45]
    v_cvt_pk_bf16_f32 v211, v238, v239
    v_cndmask_b32 v33, v10, v5, s[46:47]
    v_mfma_f32_16x16x32_bf16 a[8:11], a[224:227], v[200:203], a[8:11]
    ds_read_b128 a[128:131], v2 offset:0
    v_cndmask_b32 v34, v10, v5, s[48:49]
    v_mfma_f32_16x16x32_bf16 a[12:15], a[224:227], v[204:207], a[12:15]
    s_or_b32 s35, s35, 0x10000
    v_add_u32 v3, s53, v56
    v_cndmask_b32 v35, v10, v5, s[50:51]
    v_mfma_f32_16x16x32_bf16 a[24:27], a[228:231], v[200:203], a[24:27]
    buffer_load_dwordx4 v1, s[20:23], s33 offen offset:2048 sc1 lds
    v_exp_f32 v241, v165
    v_mfma_f32_16x16x32_bf16 a[28:31], a[228:231], v[204:207], a[28:31]
    s_waitcnt lgkmcnt(5)
    ds_read_b128 a[132:135], v2 offset:1024
    v_cmp_gt_i32 s[44:45], 32, v6
    v_mfma_f32_16x16x32_bf16 a[40:43], a[232:235], v[200:203], a[40:43]
    v_exp_f32 v242, v166
    v_cmp_gt_i32 s[46:47], 33, v6
    v_mfma_f32_16x16x32_bf16 a[44:47], a[232:235], v[204:207], a[44:47]
    ds_read_b128 a[136:139], v2 offset:2048
    v_cvt_pk_bf16_f32 v212, v240, v241
    v_mfma_f32_16x16x32_bf16 a[56:59], a[236:239], v[200:203], a[56:59]
    v_cmp_gt_i32 s[48:49], 34, v6
    v_cmp_gt_i32 s[50:51], 35, v6
    v_mfma_f32_16x16x32_bf16 a[60:63], a[236:239], v[204:207], a[60:63]
    s_waitcnt lgkmcnt(5)
    v_exp_f32 v243, v167
    v_or3_b32 v57, v57, v211, v212
    v_mfma_f32_16x16x32_bf16 a[72:75], a[240:243], v[200:203], a[72:75]
    ds_read_b128 a[140:143], v2 offset:3072
    v_cndmask_b32 v24, v10, v5, s[44:45]
    v_mfma_f32_16x16x32_bf16 a[76:79], a[240:243], v[204:207], a[76:79]
    v_cndmask_b32 v25, v10, v5, s[46:47]
    v_exp_f32 v244, v180
    v_mfma_f32_16x16x32_bf16 a[88:91], a[244:247], v[200:203], a[88:91]
    v_cvt_pk_bf16_f32 v213, v242, v243
    v_cndmask_b32 v26, v10, v5, s[48:49]
    v_mfma_f32_16x16x32_bf16 a[92:95], a[244:247], v[204:207], a[92:95]
    s_waitcnt lgkmcnt(4)
    ds_read_b128 a[144:147], v2 offset:4096
    v_cndmask_b32 v27, v10, v5, s[50:51]
    v_mfma_f32_16x16x32_bf16 a[104:107], a[248:251], v[200:203], a[104:107]
    v_exp_f32 v245, v181
    v_cmp_gt_i32 s[44:45], 48, v6
    v_mfma_f32_16x16x32_bf16 a[108:111], a[248:251], v[204:207], a[108:111]
    buffer_load_dwordx4 v1, s[20:23], s33 offen offset:3072 sc1 lds
    ds_read_b128 a[148:151], v2 offset:5120
    ds_read_b128 a[152:155], v2 offset:6144
    v_cmp_gt_i32 s[46:47], 49, v6
    s_add_u32 s33, s33, 0x80000
    v_cmp_gt_i32 s[48:49], 50, v6
    v_exp_f32 v246, v182
    v_cvt_pk_bf16_f32 v214, v244, v245
    v_cmp_gt_i32 s[50:51], 51, v6
    v_cndmask_b32 v40, v10, v5, s[44:45]
    v_mfma_f32_16x16x32_bf16 a[120:123], a[252:255], v[200:203], a[120:123]
    v_exp_f32 v247, v183
    v_or3_b32 v57, v57, v213, v214
    v_cndmask_b32 v41, v10, v5, s[46:47]
    v_mfma_f32_16x16x32_bf16 a[124:127], a[252:255], v[204:207], a[124:127]
    s_waitcnt lgkmcnt(5)
    ds_read_b128 a[156:159], v2 offset:7168
    v_cndmask_b32 v42, v10, v5, s[48:49]
    v_cndmask_b32 v43, v10, v5, s[50:51]
    v_mfma_f32_16x16x32_bf16 v[128:131], a[128:131], v[96:99], v[16:19]
    s_waitcnt vmcnt(4)
    s_barrier
    v_exp_f32 v232, v168
    v_mfma_f32_16x16x32_bf16 v[132:135], a[128:131], v[112:115], v[20:23]
    ds_read_b128 a[160:163], v2 offset:8192
    v_cvt_pk_bf16_f32 v215, v246, v247
    v_mfma_f32_16x16x32_bf16 v[128:131], a[132:135], v[100:103], v[128:131]
    v_exp_f32 v233, v169
    v_mfma_f32_16x16x32_bf16 v[132:135], a[132:135], v[116:119], v[132:135]
    s_waitcnt lgkmcnt(5)
    ds_read_b128 a[164:167], v2 offset:9216
    v_cvt_pk_bf16_f32 v216, v232, v233
    v_mfma_f32_16x16x32_bf16 v[128:131], a[136:139], v[104:107], v[128:131]
    s_add_u32 s36, s36, 64
    v_exp_f32 v234, v170
    v_mfma_f32_16x16x32_bf16 v[132:135], a[136:139], v[120:123], v[132:135]
    ds_read_b128 a[168:171], v2 offset:10240
    v_or3_b32 v57, v57, v215, v216
    v_mfma_f32_16x16x32_bf16 v[128:131], a[140:143], v[108:111], v[128:131]
    s_add_u32 s52, s52, 16384
    v_exp_f32 v235, v171
    v_mfma_f32_16x16x32_bf16 v[132:135], a[140:143], v[124:127], v[132:135]
    s_waitcnt lgkmcnt(5)
    ds_read_b128 a[172:175], v2 offset:11264
    v_cvt_pk_bf16_f32 v217, v234, v235
    v_mfma_f32_16x16x32_bf16 v[144:147], a[144:147], v[96:99], v[32:35]
    s_and_b32 s52, s52, 0xffff
    v_exp_f32 v236, v184
    v_mfma_f32_16x16x32_bf16 v[148:151], a[144:147], v[112:115], v[36:39]
    ds_read_b128 a[176:179], v2 offset:12288
    ds_read_b128 a[180:183], v2 offset:13312
    v_mfma_f32_16x16x32_bf16 v[144:147], a[148:151], v[100:103], v[144:147]
    v_exp_f32 v237, v185
    v_mfma_f32_16x16x32_bf16 v[148:151], a[148:151], v[116:119], v[148:151]
    s_waitcnt lgkmcnt(6)
    v_exp_f32 v238, v186
    v_mfma_f32_16x16x32_bf16 v[144:147], a[152:155], v[104:107], v[144:147]
    ds_read_b128 a[184:187], v2 offset:14336
    v_cvt_pk_bf16_f32 v218, v236, v237
    v_mfma_f32_16x16x32_bf16 v[148:151], a[152:155], v[120:123], v[148:151]
    v_exp_f32 v239, v187
    v_mfma_f32_16x16x32_bf16 v[144:147], a[156:159], v[108:111], v[144:147]
    ds_read_b128 a[188:191], v2 offset:15360
    v_or3_b32 v57, v57, v217, v218
    v_mfma_f32_16x16x32_bf16 v[148:151], a[156:159], v[124:127], v[148:151]
    s_waitcnt lgkmcnt(6)
    v_exp_f32 v240, v172
    v_mfma_f32_16x16x32_bf16 v[136:139], a[160:163], v[96:99], v[24:27]
    v_cvt_pk_bf16_f32 v219, v238, v239
    v_add_u32 v2, s52, v1
    v_mfma_f32_16x16x32_bf16 v[140:143], a[160:163], v[112:115], v[28:31]
    v_exp_f32 v241, v173
    v_mfma_f32_16x16x32_bf16 v[136:139], a[164:167], v[100:103], v[136:139]
    ds_read_b128 a[192:195], v3 offset:0
    v_cvt_pk_bf16_f32 v220, v240, v241
    v_mfma_f32_16x16x32_bf16 v[140:143], a[164:167], v[116:119], v[140:143]
    s_waitcnt lgkmcnt(5)
    v_exp_f32 v242, v174
    v_mfma_f32_16x16x32_bf16 v[136:139], a[168:171], v[104:107], v[136:139]
    ds_read_b128 a[196:199], v3 offset:1024
    v_or3_b32 v57, v57, v219, v220
    v_mfma_f32_16x16x32_bf16 v[140:143], a[168:171], v[120:123], v[140:143]
    v_exp_f32 v243, v175
    v_mfma_f32_16x16x32_bf16 v[136:139], a[172:175], v[108:111], v[136:139]
    ds_read_b128 a[200:203], v3 offset:2048
    v_cvt_pk_bf16_f32 v221, v242, v243
    v_mfma_f32_16x16x32_bf16 v[140:143], a[172:175], v[124:127], v[140:143]
    s_waitcnt lgkmcnt(5)
    v_exp_f32 v244, v188
    v_mfma_f32_16x16x32_bf16 v[152:155], a[176:179], v[96:99], v[40:43]
    ds_read_b128 a[204:207], v3 offset:3072
    ds_read_b128 a[208:211], v3 offset:4096
    v_mfma_f32_16x16x32_bf16 v[156:159], a[176:179], v[112:115], v[44:47]
    v_exp_f32 v245, v189
    v_mfma_f32_16x16x32_bf16 v[152:155], a[180:183], v[100:103], v[152:155]
    v_exp_f32 v246, v190
    v_mfma_f32_16x16x32_bf16 v[156:159], a[180:183], v[116:119], v[156:159]
    s_waitcnt lgkmcnt(5)
    ds_read_b128 a[212:215], v3 offset:5120
    v_cvt_pk_bf16_f32 v222, v244, v245
    v_mfma_f32_16x16x32_bf16 v[152:155], a[184:187], v[104:107], v[152:155]
    v_exp_f32 v247, v191
    v_mfma_f32_16x16x32_bf16 v[156:159], a[184:187], v[120:123], v[156:159]
    ds_read_b128 a[216:219], v3 offset:6144
    v_or3_b32 v57, v57, v221, v222
    v_mfma_f32_16x16x32_bf16 v[152:155], a[188:191], v[108:111], v[152:155]
    ds_read_b128 a[220:223], v3 offset:7168
    v_cvt_pk_bf16_f32 v223, v246, v247
    v_bitop3_b32 v57, v57, v223, s37 bitop3:0xa8
    v_mfma_f32_16x16x32_bf16 v[156:159], a[188:191], v[124:127], v[156:159]
    v_cmp_ne_u32 vcc, 0, v57
    s_cbranch_vccnz k2_tramp_110
k2_ret_111:
    v_mfma_f32_16x16x32_bf16 v[248:251], v[60:63], v[208:211], v[248:251]
    ds_read_b128 a[224:227], v3 offset:8192
    v_exp_f32 v232, v128
    v_mfma_f32_16x16x32_bf16 v[252:255], v[60:63], v[212:215], v[252:255]
    v_exp_f32 v233, v129
    v_mfma_f32_16x16x32_bf16 v[248:251], v[60:63], v[216:219], v[248:251]
    s_add_u32 s53, s53, 16384
    ds_read_b128 a[228:231], v3 offset:9216
    v_exp_f32 v234, v130
    v_mfma_f32_16x16x32_bf16 v[252:255], v[60:63], v[220:223], v[252:255]
    s_waitcnt lgkmcnt(8)
    v_cvt_pk_bf16_f32 v192, v232, v233
    v_exp_f32 v235, v131
    v_mfma_f32_16x16x32_bf16 a[8:11], a[192:195], v[208:211], a[8:11]
    s_sub_u32 s40, s36, s39
    s_sub_u32 s40, s40, 64
    ds_read_b128 a[232:235], v3 offset:10240
    v_mfma_f32_16x16x32_bf16 a[12:15], a[192:195], v[212:215], a[12:15]
    s_and_b32 s53, s53, 0xffff
    v_subrev_u32 v6, s40, v4
    v_cmp_gt_i32 s[44:45], 0, v6
    v_cvt_pk_bf16_f32 v193, v234, v235
    v_mfma_f32_16x16x32_bf16 a[24:27], a[196:199], v[208:211], a[24:27]
    v_exp_f32 v236, v144
    v_cmp_gt_i32 s[46:47], 1, v6
    v_mfma_f32_16x16x32_bf16 a[28:31], a[196:199], v[212:215], a[28:31]
    s_waitcnt lgkmcnt(7)
    ds_read_b128 a[236:239], v3 offset:11264
    v_exp_f32 v237, v145
    v_mfma_f32_16x16x32_bf16 a[40:43], a[200:203], v[208:211], a[40:43]
    ds_read_b128 a[240:243], v3 offset:12288
    v_cmp_gt_i32 s[48:49], 2, v6
    v_cmp_gt_i32 s[50:51], 3, v6
    v_mfma_f32_16x16x32_bf16 a[44:47], a[200:203], v[212:215], a[44:47]
    v_exp_f32 v238, v146
    v_cndmask_b32 v20, v11, v5, s[44:45]
    v_mfma_f32_16x16x32_bf16 a[56:59], a[204:207], v[208:211], a[56:59]
    v_cvt_pk_bf16_f32 v194, v236, v237
    v_cndmask_b32 v21, v11, v5, s[46:47]
    v_or3_b32 v57, v192, v193, v194
    v_mfma_f32_16x16x32_bf16 a[60:63], a[204:207], v[212:215], a[60:63]
    s_waitcnt lgkmcnt(7)
    v_exp_f32 v239, v147
    v_cndmask_b32 v22, v11, v5, s[48:49]
    v_mfma_f32_16x16x32_bf16 a[72:75], a[208:211], v[208:211], a[72:75]
    ds_read_b128 a[244:247], v3 offset:13312
    v_cndmask_b32 v23, v11, v5, s[50:51]
    v_cvt_pk_bf16_f32 v195, v238, v239
    v_mfma_f32_16x16x32_bf16 a[76:79], a[208:211], v[212:215], a[76:79]
    v_exp_f32 v240, v132
    v_cmp_gt_i32 s[44:45], 16, v6
    v_mfma_f32_16x16x32_bf16 a[88:91], a[212:215], v[208:211], a[88:91]
    ds_read_b128 a[248:251], v3 offset:14336
    v_cmp_gt_i32 s[46:47], 17, v6
    v_cmp_gt_i32 s[48:49], 18, v6
    v_mfma_f32_16x16x32_bf16 a[92:95], a[212:215], v[212:215], a[92:95]
    s_waitcnt lgkmcnt(7)
    ds_read_b128 a[252:255], v3 offset:15360
    v_exp_f32 v241, v133
    v_mfma_f32_16x16x32_bf16 a[104:107], a[216:219], v[208:211], a[104:107]
    v_exp_f32 v242, v134
    v_cmp_gt_i32 s[50:51], 19, v6
    v_mfma_f32_16x16x32_bf16 a[108:111], a[216:219], v[212:215], a[108:111]
    v_cvt_pk_bf16_f32 v196, v240, v241
    v_cndmask_b32 v36, v11, v5, s[44:45]
    v_or3_b32 v57, v57, v195, v196
    v_mfma_f32_16x16x32_bf16 a[120:123], a[220:223], v[208:211], a[120:123]
    v_exp_f32 v243, v135
    v_cndmask_b32 v37, v11, v5, s[46:47]
    v_mfma_f32_16x16x32_bf16 a[124:127], a[220:223], v[212:215], a[124:127]
    s_waitcnt lgkmcnt(6)
    ds_read_b128 a[128:131], v2 offset:0
    v_cndmask_b32 v38, v11, v5, s[48:49]
    v_add_u32 v3, s53, v56
    v_mfma_f32_16x16x32_bf16 a[8:11], a[224:227], v[216:219], a[8:11]
    ds_read_b128 a[132:135], v2 offset:1024
    v_exp_f32 v244, v148
    v_mfma_f32_16x16x32_bf16 a[12:15], a[224:227], v[220:223], a[12:15]
    ds_read_b128 a[136:139], v2 offset:2048
    v_cvt_pk_bf16_f32 v197, v242, v243
    v_cndmask_b32 v39, v11, v5, s[50:51]
    v_mfma_f32_16x16x32_bf16 a[24:27], a[228:231], v[216:219], a[24:27]
    v_cmp_gt_i32 s[44:45], 32, v6
    v_exp_f32 v245, v149
    v_mfma_f32_16x16x32_bf16 a[28:31], a[228:231], v[220:223], a[28:31]
    s_waitcnt lgkmcnt(7)
    ds_read_b128 a[140:143], v2 offset:3072
    ds_read_b128 a[144:147], v2 offset:4096
    v_cmp_gt_i32 s[46:47], 33, v6
    v_mfma_f32_16x16x32_bf16 a[40:43], a[232:235], v[216:219], a[40:43]
    v_exp_f32 v246, v150
    v_cmp_gt_i32 s[48:49], 34, v6
    v_mfma_f32_16x16x32_bf16 a[44:47], a[232:235], v[220:223], a[44:47]
    ds_read_b128 a[148:151], v2 offset:5120
    v_cvt_pk_bf16_f32 v198, v244, v245
    v_cmp_gt_i32 s[50:51], 35, v6
    v_mfma_f32_16x16x32_bf16 a[56:59], a[236:239], v[216:219], a[56:59]
    v_exp_f32 v247, v151
    v_or3_b32 v57, v57, v197, v198
    v_mfma_f32_16x16x32_bf16 a[60:63], a[236:239], v[220:223], a[60:63]
    s_waitcnt lgkmcnt(8)
    ds_read_b128 a[152:155], v2 offset:6144
    v_cndmask_b32 v28, v11, v5, s[44:45]
    v_cndmask_b32 v29, v11, v5, s[46:47]
    v_mfma_f32_16x16x32_bf16 a[72:75], a[240:243], v[216:219], a[72:75]
    ds_read_b128 a[156:159], v2 offset:7168
    v_exp_f32 v232, v136
    v_mfma_f32_16x16x32_bf16 a[76:79], a[240:243], v[220:223], a[76:79]
    ds_read_b128 a[160:163], v2 offset:8192
    v_cvt_pk_bf16_f32 v199, v246, v247
    v_cndmask_b32 v30, v11, v5, s[48:49]
    v_mfma_f32_16x16x32_bf16 a[88:91], a[244:247], v[216:219], a[88:91]
    v_cndmask_b32 v31, v11, v5, s[50:51]
    v_exp_f32 v233, v137
    v_mfma_f32_16x16x32_bf16 a[92:95], a[244:247], v[220:223], a[92:95]
    s_waitcnt lgkmcnt(9)
    ds_read_b128 a[164:167], v2 offset:9216
    ds_read_b128 a[168:171], v2 offset:10240
    v_cmp_gt_i32 s[44:45], 48, v6
    v_mfma_f32_16x16x32_bf16 a[104:107], a[248:251], v[216:219], a[104:107]
    v_exp_f32 v234, v138
    v_cmp_gt_i32 s[46:47], 49, v6
    v_mfma_f32_16x16x32_bf16 a[108:111], a[248:251], v[220:223], a[108:111]
    ds_read_b128 a[172:175], v2 offset:11264
    ds_read_b128 a[176:179], v2 offset:12288
    v_cvt_pk_bf16_f32 v200, v232, v233
    v_cmp_gt_i32 s[48:49], 50, v6
    v_exp_f32 v235, v139
    v_cmp_gt_i32 s[50:51], 51, v6
    v_or3_b32 v57, v57, v199, v200
    v_cndmask_b32 v44, v11, v5, s[44:45]
    v_mfma_f32_16x16x32_bf16 a[120:123], a[252:255], v[216:219], a[120:123]
    ds_read_b128 a[180:183], v2 offset:13312
    v_exp_f32 v236, v152
    v_cvt_pk_bf16_f32 v201, v234, v235
    v_cndmask_b32 v45, v11, v5, s[46:47]
    v_mfma_f32_16x16x32_bf16 a[124:127], a[252:255], v[220:223], a[124:127]
    s_waitcnt lgkmcnt(12)
    ds_read_b128 a[184:187], v2 offset:14336
    v_cndmask_b32 v46, v11, v5, s[48:49]
    v_cndmask_b32 v47, v11, v5, s[50:51]
    v_mfma_f32_16x16x32_bf16 v[164:167], a[128:131], v[112:115], v[20:23]
    v_exp_f32 v237, v153
    v_mfma_f32_16x16x32_bf16 v[164:167], a[132:135], v[116:119], v[164:167]
    s_waitcnt lgkmcnt(11)
    ds_read_b128 a[188:191], v2 offset:15360
    v_exp_f32 v238, v154
    v_mfma_f32_16x16x32_bf16 v[164:167], a[136:139], v[120:123], v[164:167]
    v_cvt_pk_bf16_f32 v202, v236, v237
    v_exp_f32 v239, v155
    v_mfma_f32_16x16x32_bf16 v[164:167], a[140:143], v[124:127], v[164:167]
    s_waitcnt lgkmcnt(10)
    ds_read_b128 a[192:195], v3 offset:0
    v_or3_b32 v57, v57, v201, v202
    v_mfma_f32_16x16x32_bf16 v[180:183], a[144:147], v[112:115], v[36:39]
    s_add_u32 s36, s36, 64
    v_exp_f32 v240, v140
    v_mfma_f32_16x16x32_bf16 v[180:183], a[148:151], v[116:119], v[180:183]
    s_waitcnt lgkmcnt(9)
    ds_read_b128 a[196:199], v3 offset:1024
    v_cvt_pk_bf16_f32 v203, v238, v239
    v_exp_f32 v241, v141
    v_mfma_f32_16x16x32_bf16 v[180:183], a[152:155], v[120:123], v[180:183]
    s_add_u32 s52, s52, 16384
    ds_read_b128 a[200:203], v3 offset:2048
    v_cvt_pk_bf16_f32 v204, v240, v241
    v_mfma_f32_16x16x32_bf16 v[180:183], a[156:159], v[124:127], v[180:183]
    s_waitcnt lgkmcnt(9)
    v_exp_f32 v242, v142
    v_or3_b32 v57, v57, v203, v204
    v_mfma_f32_16x16x32_bf16 v[172:175], a[160:163], v[112:115], v[28:31]
    s_and_b32 s52, s52, 0xffff
    v_add_u32 v2, s52, v1
    v_exp_f32 v243, v143
    v_mfma_f32_16x16x32_bf16 v[172:175], a[164:167], v[116:119], v[172:175]
    s_waitcnt lgkmcnt(7)
    ds_read_b128 a[204:207], v3 offset:3072
    v_exp_f32 v244, v156
    v_mfma_f32_16x16x32_bf16 v[172:175], a[168:171], v[120:123], v[172:175]
    ds_read_b128 a[208:211], v3 offset:4096
    ds_read_b128 a[212:215], v3 offset:5120
    v_cvt_pk_bf16_f32 v205, v242, v243
    v_mfma_f32_16x16x32_bf16 v[172:175], a[172:175], v[124:127], v[172:175]
    s_waitcnt lgkmcnt(8)
    ds_read_b128 a[216:219], v3 offset:6144
    v_exp_f32 v245, v157
    v_mfma_f32_16x16x32_bf16 v[188:191], a[176:179], v[112:115], v[44:47]
    v_exp_f32 v246, v158
    v_cvt_pk_bf16_f32 v206, v244, v245
    v_mfma_f32_16x16x32_bf16 v[188:191], a[180:183], v[116:119], v[188:191]
    s_waitcnt lgkmcnt(7)
    v_exp_f32 v247, v159
    v_or3_b32 v57, v57, v205, v206
    v_mfma_f32_16x16x32_bf16 v[188:191], a[184:187], v[120:123], v[188:191]
    ds_read_b128 a[220:223], v3 offset:7168
    v_cvt_pk_bf16_f32 v207, v246, v247
    v_bitop3_b32 v57, v57, v207, s37 bitop3:0xa8
    v_mfma_f32_16x16x32_bf16 v[188:191], a[188:191], v[124:127], v[188:191]
    v_cmp_ne_u32 vcc, 0, v57
    s_cbranch_vccnz k2_tramp_112
k2_ret_113:
k2_sdone_105:
    s_add_u32 s16, s6, 0x4811000
    s_addc_u32 s17, s7, 0
    s_and_b32 s17, s17, 0xffff
    s_mov_b32 s18, 0x4000
    s_mov_b32 s19, 0x00020000
    v_mfma_f32_16x16x32_bf16 v[248:251], v[60:63], v[192:195], v[248:251]
    s_waitcnt vmcnt(0)
    s_barrier
    v_exp_f32 v232, v164
    v_mfma_f32_16x16x32_bf16 v[252:255], v[60:63], v[196:199], v[252:255]
    ds_read_b128 a[224:227], v3 offset:8192
    s_cmp_eq_u32 s30, 0
    s_cbranch_scc1 k12_ool_116
k12_oolret_117:
    v_mfma_f32_16x16x32_bf16 v[248:251], v[60:63], v[200:203], v[248:251]
    s_add_u32 m0, s60, 0
    v_exp_f32 v233, v165
    v_mfma_f32_16x16x32_bf16 v[252:255], v[60:63], v[204:207], v[252:255]
    s_waitcnt lgkmcnt(7)
    buffer_load_dwordx4 v90, s[12:15], s61 offen offset:0 lds
    ds_read_b128 a[228:231], v3 offset:9216
    v_mfma_f32_16x16x32_bf16 a[8:11], a[192:195], v[192:195], a[8:11]
    s_add_u32 s53, s53, 16384
    v_exp_f32 v234, v166
    v_cvt_pk_bf16_f32 v212, v232, v233
    v_mfma_f32_16x16x32_bf16 a[12:15], a[192:195], v[196:199], a[12:15]
    s_and_b32 s53, s53, 0xffff
    buffer_load_dwordx4 v91, s[12:15], s61 offen offset:1024 lds
    ds_read_b128 a[232:235], v3 offset:10240
    v_mfma_f32_16x16x32_bf16 a[24:27], a[196:199], v[192:195], a[24:27]
    ds_read_b128 a[236:239], v3 offset:11264
    v_exp_f32 v235, v167
    v_mfma_f32_16x16x32_bf16 a[28:31], a[196:199], v[196:199], a[28:31]
    s_waitcnt lgkmcnt(8)
    v_exp_f32 v236, v180
    v_mfma_f32_16x16x32_bf16 a[40:43], a[200:203], v[192:195], a[40:43]
    buffer_load_dwordx4 v92, s[12:15], s61 offen offset:2048 lds
    ds_read_b128 a[240:243], v3 offset:12288
    v_mfma_f32_16x16x32_bf16 a[44:47], a[200:203], v[196:199], a[44:47]
    v_cvt_pk_bf16_f32 v213, v234, v235
    v_exp_f32 v237, v181
    v_mfma_f32_16x16x32_bf16 a[56:59], a[204:207], v[192:195], a[56:59]
    buffer_load_dwordx4 v93, s[12:15], s61 offen offset:3072 lds
    ds_read_b128 a[244:247], v3 offset:13312
    v_mfma_f32_16x16x32_bf16 a[60:63], a[204:207], v[196:199], a[60:63]
    s_waitcnt lgkmcnt(8)
    v_exp_f32 v238, v182
    v_cvt_pk_bf16_f32 v214, v236, v237
    v_mfma_f32_16x16x32_bf16 a[72:75], a[208:211], v[192:195], a[72:75]
    s_add_u32 s61, s61, 0x20000
    s_and_b32 s61, s61, 0x3fffff
    ds_read_b128 a[248:251], v3 offset:14336
    v_mfma_f32_16x16x32_bf16 a[76:79], a[208:211], v[196:199], a[76:79]
    s_add_u32 m0, s60, 16384
    v_exp_f32 v239, v183
    v_or3_b32 v57, v212, v213, v214
    v_mfma_f32_16x16x32_bf16 a[88:91], a[212:215], v[192:195], a[88:91]
    buffer_load_dwordx4 v90, s[12:15], s61 offen offset:0 lds
    buffer_load_dwordx4 v91, s[12:15], s61 offen offset:1024 lds
    ds_read_b128 a[252:255], v3 offset:15360
    v_mfma_f32_16x16x32_bf16 a[92:95], a[212:215], v[196:199], a[92:95]
    s_waitcnt lgkmcnt(8)
    v_exp_f32 v240, v172
    v_cvt_pk_bf16_f32 v215, v238, v239
    v_mfma_f32_16x16x32_bf16 a[104:107], a[216:219], v[192:195], a[104:107]
    v_mfma_f32_16x16x32_bf16 a[108:111], a[216:219], v[196:199], a[108:111]
    v_add_u32 v3, s53, v56
    ds_read_b128 a[192:195], v3 offset:0
    v_mfma_f32_16x16x32_bf16 a[120:123], a[220:223], v[192:195], a[120:123]
    ds_read_b128 a[196:199], v3 offset:1024
    v_exp_f32 v241, v173
    v_mfma_f32_16x16x32_bf16 a[124:127], a[220:223], v[196:199], a[124:127]
    s_waitcnt lgkmcnt(8)
    buffer_load_dwordx4 v92, s[12:15], s61 offen offset:2048 lds
    buffer_load_dwordx4 v93, s[12:15], s61 offen offset:3072 lds
    ds_read_b128 a[200:203], v3 offset:2048
    v_mfma_f32_16x16x32_bf16 a[8:11], a[224:227], v[200:203], a[8:11]
    v_exp_f32 v242, v174
    v_cvt_pk_bf16_f32 v220, v240, v241
    v_mfma_f32_16x16x32_bf16 a[12:15], a[224:227], v[204:207], a[12:15]
    ds_read_b128 a[204:207], v3 offset:3072
    ds_read_b128 a[208:211], v3 offset:4096
    v_or3_b32 v57, v57, v215, v220
    v_mfma_f32_16x16x32_bf16 a[24:27], a[228:231], v[200:203], a[24:27]
    s_add_u32 s61, s61, 0x20000
    s_and_b32 s61, s61, 0x3fffff
    ds_read_b128 a[212:215], v3 offset:5120
    v_exp_f32 v243, v175
    v_mfma_f32_16x16x32_bf16 a[28:31], a[228:231], v[204:207], a[28:31]
    s_waitcnt lgkmcnt(10)
    ds_read_b128 a[216:219], v3 offset:6144
    s_add_u32 m0, s60, 32768
    v_mfma_f32_16x16x32_bf16 a[40:43], a[232:235], v[200:203], a[40:43]
    buffer_load_dwordx4 v90, s[12:15], s61 offen offset:0 lds
    ds_read_b128 a[220:223], v3 offset:7168
    v_mfma_f32_16x16x32_bf16 a[44:47], a[232:235], v[204:207], a[44:47]
    v_exp_f32 v244, v188
    v_cvt_pk_bf16_f32 v221, v242, v243
    v_mfma_f32_16x16x32_bf16 a[56:59], a[236:239], v[200:203], a[56:59]
    buffer_load_dwordx4 v91, s[12:15], s61 offen offset:1024 lds
    ds_read_b128 a[224:227], v3 offset:8192
    v_mfma_f32_16x16x32_bf16 a[60:63], a[236:239], v[204:207], a[60:63]
    s_waitcnt lgkmcnt(11)
    ds_read_b128 a[228:231], v3 offset:9216
    v_exp_f32 v245, v189
    v_mfma_f32_16x16x32_bf16 a[72:75], a[240:243], v[200:203], a[72:75]
    buffer_load_dwordx4 v92, s[12:15], s61 offen offset:2048 lds
    ds_read_b128 a[232:235], v3 offset:10240
    v_mfma_f32_16x16x32_bf16 a[76:79], a[240:243], v[204:207], a[76:79]
    v_exp_f32 v246, v190
    v_mfma_f32_16x16x32_bf16 a[88:91], a[244:247], v[200:203], a[88:91]
    ds_read_b128 a[236:239], v3 offset:11264
    ds_read_b128 a[240:243], v3 offset:12288
    v_cvt_pk_bf16_f32 v222, v244, v245
    v_mfma_f32_16x16x32_bf16 a[92:95], a[244:247], v[204:207], a[92:95]
    s_waitcnt lgkmcnt(13)
    v_exp_f32 v247, v191
    v_mfma_f32_16x16x32_bf16 a[104:107], a[248:251], v[200:203], a[104:107]
    ds_read_b128 a[244:247], v3 offset:13312
    v_or3_b32 v57, v57, v221, v222
    v_cvt_pk_bf16_f32 v223, v246, v247
    v_mfma_f32_16x16x32_bf16 a[108:111], a[248:251], v[204:207], a[108:111]
    buffer_load_dwordx4 v93, s[12:15], s61 offen offset:3072 lds
    v_mfma_f32_16x16x32_bf16 a[120:123], a[252:255], v[200:203], a[120:123]
    s_add_u32 s61, s61, 0x20000
    s_and_b32 s61, s61, 0x3fffff
    ds_read_b128 a[248:251], v3 offset:14336
    v_bitop3_b32 v57, v57, v223, s37 bitop3:0xa8
    v_cmp_ne_u32 vcc, 0, v57
    v_mfma_f32_16x16x32_bf16 a[124:127], a[252:255], v[204:207], a[124:127]
    buffer_load_dword v74, v73, s[16:19], s59 offen sc1
    ds_read_b128 a[252:255], v3 offset:15360
    s_cbranch_vccnz k2_tramp_114
k2_ret_115:
    v_lshrrev_b32 v6, 4, v1
    v_and_b32 v6, 31, v6
    s_getpc_b64 s[40:41]
pc_118:
    s_add_u32 s40, s40, op_head-pc_118
    s_addc_u32 s41, s41, 0
    v_lshlrev_b32 v224, 7, v6
    v_mov_b32 v225, s41
    v_add_co_u32 v224, vcc, s40, v224
    s_nop 1
    v_addc_co_u32 v225, vcc, 0, v225, vcc
    global_load_dword v7, v[224:225], off
    v_mfma_f32_16x16x32_bf16 v[252:255], v[60:63], v[212:215], v[252:255]
    s_lshl_b32 s31, s28, 19
    v_mov_b32 v249, v248
    s_nop 1
    v_permlane16_swap_b32 v248, v249
    v_mfma_f32_16x16x32_bf16 v[252:255], v[60:63], v[220:223], v[252:255]
    s_waitcnt lgkmcnt(0)
    s_nop 1
    v_add_f32 v248, v248, v249
    v_mov_b32 v249, v248
    v_mfma_f32_16x16x32_bf16 a[12:15], a[192:195], v[212:215], a[12:15]
    s_lshl_b32 s44, s39, 6
    s_nop 1
    v_permlane32_swap_b32 v248, v249
    s_nop 1
    v_mfma_f32_16x16x32_bf16 a[12:15], a[224:227], v[220:223], a[12:15]
    s_add_u32 s44, s44, s31
    s_add_u32 s45, s44, 131072
    v_add_f32 v248, v248, v249
    v_rcp_f32 v249, v248
    v_mfma_f32_16x16x32_bf16 a[28:31], a[196:199], v[212:215], a[28:31]
    s_add_u32 s46, s44, 262144
    v_rcp_f32 v248, v248
    s_nop 0
    s_add_u32 s47, s44, 393216
    v_mfma_f32_16x16x32_bf16 a[28:31], a[228:231], v[220:223], a[28:31]
    s_add_u32 s48, s44, 4096
    v_accvgpr_read_b32 v132, a8
    v_accvgpr_read_b32 v133, a9
    v_accvgpr_read_b32 v134, a10
    v_mfma_f32_16x16x32_bf16 a[44:47], a[200:203], v[212:215], a[44:47]
    s_add_u32 s49, s44, 135168
    v_accvgpr_read_b32 v135, a11
    v_accvgpr_read_b32 v136, a24
    v_accvgpr_read_b32 v137, a25
    v_mfma_f32_16x16x32_bf16 a[44:47], a[232:235], v[220:223], a[44:47]
    s_add_u32 s50, s44, 266240
    v_accvgpr_read_b32 v138, a26
    v_accvgpr_read_b32 v139, a27
    v_mul_f32 v132, v132, v248
    v_mfma_f32_16x16x32_bf16 a[60:63], a[204:207], v[212:215], a[60:63]
    s_add_u32 s51, s44, 397312
    v_mul_f32 v133, v133, v248
    v_mul_f32 v134, v134, v248
    v_mul_f32 v135, v135, v248
    v_mfma_f32_16x16x32_bf16 a[60:63], a[236:239], v[220:223], a[60:63]
    v_mul_f32 v136, v136, v248
    v_mul_f32 v137, v137, v248
    v_mul_f32 v138, v138, v248
    v_mfma_f32_16x16x32_bf16 a[76:79], a[208:211], v[212:215], a[76:79]
    v_mul_f32 v139, v139, v248
    v_cvt_pk_bf16_f32 v128, v132, v133
    v_cvt_pk_bf16_f32 v129, v134, v135
    v_mfma_f32_16x16x32_bf16 a[76:79], a[240:243], v[220:223], a[76:79]
    v_cvt_pk_bf16_f32 v130, v136, v137
    v_cvt_pk_bf16_f32 v131, v138, v139
    buffer_store_dwordx4 v[128:131], v1, s[24:27], s44 offen sc1
    v_mfma_f32_16x16x32_bf16 a[92:95], a[212:215], v[212:215], a[92:95]
    v_accvgpr_read_b32 v144, a40
    v_accvgpr_read_b32 v145, a41
    v_accvgpr_read_b32 v146, a42
    v_mfma_f32_16x16x32_bf16 a[92:95], a[244:247], v[220:223], a[92:95]
    v_accvgpr_read_b32 v147, a43
    v_accvgpr_read_b32 v148, a56
    v_mov_b32 v253, v252
    v_mfma_f32_16x16x32_bf16 a[108:111], a[216:219], v[212:215], a[108:111]
    v_accvgpr_read_b32 v149, a57
    v_accvgpr_read_b32 v150, a58
    s_nop 1
    v_mfma_f32_16x16x32_bf16 a[108:111], a[248:251], v[220:223], a[108:111]
    v_accvgpr_read_b32 v151, a59
    v_permlane16_swap_b32 v252, v253
    v_mul_f32 v144, v144, v248
    v_mfma_f32_16x16x32_bf16 a[124:127], a[220:223], v[212:215], a[124:127]
    s_nop 1
    v_mul_f32 v145, v145, v248
    v_add_f32 v252, v252, v253
    v_mfma_f32_16x16x32_bf16 a[124:127], a[252:255], v[220:223], a[124:127]
    v_mul_f32 v146, v146, v248
    v_mov_b32 v253, v252
    v_mul_f32 v147, v147, v248
    s_nop 1
    v_mul_f32 v148, v148, v248
    v_mul_f32 v149, v149, v248
    v_permlane32_swap_b32 v252, v253
    v_mul_f32 v150, v150, v248
    s_nop 1
    v_mul_f32 v151, v151, v248
    v_add_f32 v252, v252, v253
    v_cvt_pk_bf16_f32 v140, v144, v145
    v_rcp_f32 v253, v252
    v_cvt_pk_bf16_f32 v141, v146, v147
    v_rcp_f32 v252, v252
    v_cvt_pk_bf16_f32 v142, v148, v149
    s_nop 0
    v_cvt_pk_bf16_f32 v143, v150, v151
    buffer_store_dwordx4 v[140:143], v1, s[24:27], s45 offen sc1
    v_accvgpr_read_b32 v156, a72
    v_accvgpr_read_b32 v157, a73
    v_accvgpr_read_b32 v158, a74
    v_accvgpr_read_b32 v159, a75
    v_accvgpr_read_b32 v160, a88
    v_accvgpr_read_b32 v161, a89
    v_accvgpr_read_b32 v162, a90
    v_accvgpr_read_b32 v163, a91
    v_mul_f32 v156, v156, v248
    v_mul_f32 v157, v157, v248
    v_mul_f32 v158, v158, v248
    v_mul_f32 v159, v159, v248
    v_mul_f32 v160, v160, v248
    v_mul_f32 v161, v161, v248
    v_mul_f32 v162, v162, v248
    v_mul_f32 v163, v163, v248
    v_cvt_pk_bf16_f32 v152, v156, v157
    v_cvt_pk_bf16_f32 v153, v158, v159
    v_cvt_pk_bf16_f32 v154, v160, v161
    v_cvt_pk_bf16_f32 v155, v162, v163
    buffer_store_dwordx4 v[152:155], v1, s[24:27], s46 offen sc1
    v_accvgpr_read_b32 v168, a104
    v_accvgpr_read_b32 v169, a105
    v_accvgpr_read_b32 v170, a106
    v_accvgpr_read_b32 v171, a107
    v_accvgpr_read_b32 v172, a120
    v_accvgpr_read_b32 v173, a121
    v_accvgpr_read_b32 v174, a122
    v_accvgpr_read_b32 v175, a123
    v_mul_f32 v168, v168, v248
    v_mul_f32 v169, v169, v248
    v_mul_f32 v170, v170, v248
    v_mul_f32 v171, v171, v248
    v_mul_f32 v172, v172, v248
    v_mul_f32 v173, v173, v248
    v_mul_f32 v174, v174, v248
    v_mul_f32 v175, v175, v248
    v_cvt_pk_bf16_f32 v164, v168, v169
    v_cvt_pk_bf16_f32 v165, v170, v171
    v_cvt_pk_bf16_f32 v166, v172, v173
    v_cvt_pk_bf16_f32 v167, v174, v175
    buffer_store_dwordx4 v[164:167], v1, s[24:27], s47 offen sc1
    v_accvgpr_read_b32 v132, a12
    v_accvgpr_read_b32 v133, a13
    v_accvgpr_read_b32 v134, a14
    v_accvgpr_read_b32 v135, a15
    v_accvgpr_read_b32 v136, a28
    v_accvgpr_read_b32 v137, a29
    v_accvgpr_read_b32 v138, a30
    v_accvgpr_read_b32 v139, a31
    v_pk_mul_f32 v[132:133], v[132:133], v[252:253]
    v_pk_mul_f32 v[134:135], v[134:135], v[252:253]
    v_pk_mul_f32 v[136:137], v[136:137], v[252:253]
    v_pk_mul_f32 v[138:139], v[138:139], v[252:253]
    v_cvt_pk_bf16_f32 v128, v132, v133
    v_cvt_pk_bf16_f32 v129, v134, v135
    v_cvt_pk_bf16_f32 v130, v136, v137
    v_cvt_pk_bf16_f32 v131, v138, v139
    v_accvgpr_read_b32 v144, a44
    v_accvgpr_read_b32 v145, a45
    v_accvgpr_read_b32 v146, a46
    v_accvgpr_read_b32 v147, a47
    v_accvgpr_read_b32 v148, a60
    v_accvgpr_read_b32 v149, a61
    v_accvgpr_read_b32 v150, a62
    v_accvgpr_read_b32 v151, a63
    v_pk_mul_f32 v[144:145], v[144:145], v[252:253]
    v_pk_mul_f32 v[146:147], v[146:147], v[252:253]
    v_pk_mul_f32 v[148:149], v[148:149], v[252:253]
    v_pk_mul_f32 v[150:151], v[150:151], v[252:253]
    v_cvt_pk_bf16_f32 v140, v144, v145
    v_cvt_pk_bf16_f32 v141, v146, v147
    v_cvt_pk_bf16_f32 v142, v148, v149
    v_cvt_pk_bf16_f32 v143, v150, v151
    v_accvgpr_read_b32 v156, a76
    v_accvgpr_read_b32 v157, a77
    v_accvgpr_read_b32 v158, a78
    v_accvgpr_read_b32 v159, a79
    v_accvgpr_read_b32 v160, a92
    v_accvgpr_read_b32 v161, a93
    v_accvgpr_read_b32 v162, a94
    v_accvgpr_read_b32 v163, a95
    v_pk_mul_f32 v[156:157], v[156:157], v[252:253]
    v_pk_mul_f32 v[158:159], v[158:159], v[252:253]
    v_pk_mul_f32 v[160:161], v[160:161], v[252:253]
    v_pk_mul_f32 v[162:163], v[162:163], v[252:253]
    v_cvt_pk_bf16_f32 v152, v156, v157
    v_cvt_pk_bf16_f32 v153, v158, v159
    v_cvt_pk_bf16_f32 v154, v160, v161
    v_cvt_pk_bf16_f32 v155, v162, v163
    v_accvgpr_read_b32 v168, a108
    v_accvgpr_read_b32 v169, a109
    v_accvgpr_read_b32 v170, a110
    v_accvgpr_read_b32 v171, a111
    v_accvgpr_read_b32 v172, a124
    v_accvgpr_read_b32 v173, a125
    v_accvgpr_read_b32 v174, a126
    v_accvgpr_read_b32 v175, a127
    v_pk_mul_f32 v[168:169], v[168:169], v[252:253]
    v_pk_mul_f32 v[170:171], v[170:171], v[252:253]
    v_pk_mul_f32 v[172:173], v[172:173], v[252:253]
    v_pk_mul_f32 v[174:175], v[174:175], v[252:253]
    v_cvt_pk_bf16_f32 v164, v168, v169
    v_cvt_pk_bf16_f32 v165, v170, v171
    v_cvt_pk_bf16_f32 v166, v172, v173
    v_cvt_pk_bf16_f32 v167, v174, v175
    buffer_store_dwordx4 v[128:131], v1, s[24:27], s48 offen sc1
    buffer_store_dwordx4 v[140:143], v1, s[24:27], s49 offen sc1
    buffer_store_dwordx4 v[152:155], v1, s[24:27], s50 offen sc1
    buffer_store_dwordx4 v[164:167], v1, s[24:27], s51 offen sc1
op_head:
    s_load_dwordx2 s[28:29], s[0:1], 0
    s_load_dwordx2 s[42:43], s[0:1], 56
    s_waitcnt vmcnt(8)
    v_cmp_le_u32 vcc, 4, v74
    v_mov_b32 v56, 0
    v_mov_b32 v57, 0
    v_mov_b32 v58, 0
    v_mov_b32 v59, 0
    s_nop 1
    v_mfma_f32_32x32x16_bf16 v[128:143], v[56:59], v[56:59], 0
    v_mfma_f32_32x32x16_bf16 v[144:159], v[56:59], v[56:59], 0
    v_mfma_f32_32x32x16_bf16 v[160:175], v[56:59], v[56:59], 0
    v_mfma_f32_32x32x16_bf16 v[176:191], v[56:59], v[56:59], 0
    s_mov_b32 s33, vcc_lo
    s_bitcmp1_b32 s33, 0
    s_cbranch_scc0 op_late_119
    buffer_load_dwordx4 a[128:131], v88, s[8:11], s62 offen offset:0 sc1
    buffer_load_dwordx4 a[132:135], v88, s[8:11], s62 offen offset:1024 sc1
    buffer_load_dwordx4 a[136:139], v89, s[8:11], s62 offen offset:0 sc1
    buffer_load_dwordx4 a[140:143], v89, s[8:11], s62 offen offset:1024 sc1
    s_add_u32 s62, s62, 0x40000
    s_and_b32 s62, s62, 0x7fffff
    buffer_load_dwordx4 a[144:147], v88, s[8:11], s62 offen offset:0 sc1
    buffer_load_dwordx4 a[148:151], v88, s[8:11], s62 offen offset:1024 sc1
    buffer_load_dwordx4 a[152:155], v89, s[8:11], s62 offen offset:0 sc1
    buffer_load_dwordx4 a[156:159], v89, s[8:11], s62 offen offset:1024 sc1
    s_add_u32 s62, s62, 0x40000
    s_and_b32 s62, s62, 0x7fffff
    buffer_load_dwordx4 a[160:163], v88, s[8:11], s62 offen offset:0 sc1
    buffer_load_dwordx4 a[164:167], v88, s[8:11], s62 offen offset:1024 sc1
    buffer_load_dwordx4 a[168:171], v89, s[8:11], s62 offen offset:0 sc1
    buffer_load_dwordx4 a[172:175], v89, s[8:11], s62 offen offset:1024 sc1
    s_add_u32 s62, s62, 0x40000
    s_and_b32 s62, s62, 0x7fffff
    s_waitcnt vmcnt(12)
    s_branch op_join_120
op_late_119:
    s_waitcnt vmcnt(0)
op_join_120:
    s_barrier
    s_cmp_eq_u32 s30, 0
    s_cbranch_scc1 k12_ool_121
k12_oolret_122:
    s_bitcmp0_b32 s33, 0
    s_cbranch_scc1 k12_ool_125
k12_oolret_126:
    ds_read_b64_tr_b16 a[0:1], v64 offset:0
    ds_read_b64_tr_b16 a[2:3], v64 offset:4096
    ds_read_b64_tr_b16 a[4:5], v65 offset:0
    ds_read_b64_tr_b16 a[6:7], v65 offset:4096
    ds_read_b64_tr_b16 a[8:9], v66 offset:0
    ds_read_b64_tr_b16 a[10:11], v66 offset:4096
    ds_read_b64_tr_b16 a[12:13], v67 offset:0
    ds_read_b64_tr_b16 a[14:15], v67 offset:4096
    ds_read_b64_tr_b16 a[16:17], v68 offset:0
    ds_read_b64_tr_b16 a[18:19], v68 offset:4096
    ds_read_b64_tr_b16 a[20:21], v69 offset:0
    ds_read_b64_tr_b16 a[22:23], v69 offset:4096
    ds_read_b64_tr_b16 a[24:25], v70 offset:0
    ds_read_b64_tr_b16 a[26:27], v70 offset:4096
    ds_read_b64_tr_b16 a[28:29], v71 offset:0
    ds_read_b64_tr_b16 a[30:31], v71 offset:4096
    ds_read_b64_tr_b16 a[32:33], v64 offset:8192
    ds_read_b64_tr_b16 a[34:35], v64 offset:12288
    ds_read_b64_tr_b16 a[36:37], v65 offset:8192
    ds_read_b64_tr_b16 a[38:39], v65 offset:12288
    ds_read_b64_tr_b16 a[40:41], v66 offset:8192
    ds_read_b64_tr_b16 a[42:43], v66 offset:12288
    ds_read_b64_tr_b16 a[44:45], v67 offset:8192
    ds_read_b64_tr_b16 a[46:47], v67 offset:12288
    ds_read_b64_tr_b16 a[48:49], v68 offset:8192
    ds_read_b64_tr_b16 a[50:51], v68 offset:12288
    ds_read_b64_tr_b16 a[52:53], v69 offset:8192
    ds_read_b64_tr_b16 a[54:55], v69 offset:12288
    ds_read_b64_tr_b16 a[56:57], v70 offset:8192
    ds_read_b64_tr_b16 a[58:59], v70 offset:12288
    ds_read_b64_tr_b16 a[60:61], v71 offset:8192
    ds_read_b64_tr_b16 a[62:63], v71 offset:12288
    s_add_u32 s24, s6, 0x4000000
    s_addc_u32 s25, s7, 0
    s_and_b32 s25, s25, 0xffff
    s_mov_b32 s26, 0x400000
    s_mov_b32 s27, 0x00020000
    s_add_u32 s36, s6, 0x5000000
    s_addc_u32 s37, s7, 0
    s_and_b32 s37, s37, 0xffff
    s_mov_b32 s38, 0x800000
    s_mov_b32 s39, 0x00020000
    s_add_u32 s48, s6, 0x4807000
    s_addc_u32 s49, s7, 0
    s_and_b32 s49, s49, 0xffff
    s_mov_b32 s50, 0x8000
    s_mov_b32 s51, 0x00020000
    s_lshl_b32 s52, s2, 14
    s_add_u32 s52, s52, s60
    s_xor_b32 s53, s52, 0x10000
    s_lshl_b32 s57, s2, 7
    s_xor_b32 s58, s57, 0x200
    v_lshrrev_b32 v56, 4, v1
    s_lshl_b32 s31, s30, 6
    s_and_b32 s31, s31, 64
    v_add_u32 v56, s31, v56
    s_mov_b32 s31, (code_end-op_tail)/128
    v_min_u32 v56, s31, v56
    s_getpc_b64 s[40:41]
pc_127:
    s_add_u32 s40, s40, op_tail-pc_127
    s_addc_u32 s41, s41, 0
    v_lshlrev_b32 v82, 7, v56
    v_mov_b32 v83, s41
    v_add_co_u32 v82, vcc, s40, v82
    s_nop 1
    v_addc_co_u32 v83, vcc, 0, v83, vcc
    v_lshlrev_b32 v94, 3, v1
    s_and_b32 s35, s2, 7
    s_mul_i32 s35, s35, 28
    s_lshr_b32 s31, s2, 3
    s_add_u32 s55, s35, s31
    s_lshl_b32 s3, s55, 15
    s_lshl_b32 s31, s30, 13
    s_add_u32 s3, s3, s31
    s_mov_b32 s63, 0
    s_waitcnt vmcnt(8) lgkmcnt(0)
    s_mov_b32 s20, s28
    s_and_b32 s21, s29, 0xffff
    s_mov_b32 s22, 0x400000
    s_mov_b32 s23, 0x00020000
    s_mov_b32 s44, s42
    s_and_b32 s45, s43, 0xffff
    s_mov_b32 s46, 0x800
    s_mov_b32 s47, 0x00020000
op_loop_128:
    v_mfma_f32_16x16x32_bf16 v[160:163], a[16:19], a[128:131], v[160:163]
    s_add_u32 m0, s60, 49152
    ds_read_b64_tr_b16 a[64:65], v64 offset:16384
    ds_read_b64_tr_b16 a[66:67], v64 offset:20480
    v_mfma_f32_16x16x32_bf16 v[164:167], a[16:19], a[132:135], v[164:167]
    buffer_load_dwordx4 v90, s[12:15], s61 offen offset:0 lds
    ds_read_b64_tr_b16 a[68:69], v65 offset:16384
    v_mfma_f32_16x16x32_bf16 v[168:171], a[20:23], a[128:131], v[168:171]
    ds_read_b64_tr_b16 a[70:71], v65 offset:20480
    ds_read_b64_tr_b16 a[72:73], v66 offset:16384
    v_mfma_f32_16x16x32_bf16 v[172:175], a[20:23], a[132:135], v[172:175]
    buffer_load_dwordx4 v91, s[12:15], s61 offen offset:1024 lds
    ds_read_b64_tr_b16 a[74:75], v66 offset:20480
    v_mfma_f32_16x16x32_bf16 v[176:179], a[24:27], a[128:131], v[176:179]
    ds_read_b64_tr_b16 a[76:77], v67 offset:16384
    ds_read_b64_tr_b16 a[78:79], v67 offset:20480
    v_mfma_f32_16x16x32_bf16 v[180:183], a[24:27], a[132:135], v[180:183]
    ds_read_b64_tr_b16 a[80:81], v68 offset:16384
    v_mfma_f32_16x16x32_bf16 v[184:187], a[28:31], a[128:131], v[184:187]
    ds_read_b64_tr_b16 a[82:83], v68 offset:20480
    v_mfma_f32_16x16x32_bf16 v[188:191], a[28:31], a[132:135], v[188:191]
    buffer_load_dwordx4 v92, s[12:15], s61 offen offset:2048 lds
    ds_read_b64_tr_b16 a[84:85], v69 offset:16384
    v_mfma_f32_16x16x32_bf16 v[128:131], a[0:3], a[128:131], v[128:131]
    ds_read_b64_tr_b16 a[86:87], v69 offset:20480
    ds_read_b64_tr_b16 a[88:89], v70 offset:16384
    v_mfma_f32_16x16x32_bf16 v[132:135], a[0:3], a[132:135], v[132:135]
    ds_read_b64_tr_b16 a[90:91], v70 offset:20480
    v_mfma_f32_16x16x32_bf16 v[136:139], a[4:7], a[128:131], v[136:139]
    buffer_load_dwordx4 v93, s[12:15], s61 offen offset:3072 lds
    ds_read_b64_tr_b16 a[92:93], v71 offset:16384
    v_mfma_f32_16x16x32_bf16 v[140:143], a[4:7], a[132:135], v[140:143]
    ds_read_b64_tr_b16 a[94:95], v71 offset:20480
    ds_read_b64_tr_b16 a[96:97], v64 offset:24576
    v_mfma_f32_16x16x32_bf16 v[144:147], a[8:11], a[128:131], v[144:147]
    ds_read_b64_tr_b16 a[98:99], v64 offset:28672
    v_mfma_f32_16x16x32_bf16 v[148:151], a[8:11], a[132:135], v[148:151]
    ds_read_b64_tr_b16 a[100:101], v65 offset:24576
    v_mfma_f32_16x16x32_bf16 v[152:155], a[12:15], a[128:131], v[152:155]
    buffer_load_dwordx4 a[176:179], v88, s[8:11], s62 offen offset:0 sc1
    ds_read_b64_tr_b16 a[102:103], v65 offset:28672
    v_mfma_f32_16x16x32_bf16 v[156:159], a[12:15], a[132:135], v[156:159]
    s_add_u32 s61, s61, 0x20000
    s_and_b32 s61, s61, 0x3fffff
    ds_read_b64_tr_b16 a[104:105], v66 offset:24576
    ds_read_b64_tr_b16 a[106:107], v66 offset:28672
    v_mfma_f32_16x16x32_bf16 v[160:163], a[48:51], a[136:139], v[160:163]
    ds_read_b64_tr_b16 a[108:109], v67 offset:24576
    v_mfma_f32_16x16x32_bf16 v[164:167], a[48:51], a[140:143], v[164:167]
    buffer_load_dwordx4 a[180:183], v88, s[8:11], s62 offen offset:1024 sc1
    ds_read_b64_tr_b16 a[110:111], v67 offset:28672
    v_mfma_f32_16x16x32_bf16 v[168:171], a[52:55], a[136:139], v[168:171]
    ds_read_b64_tr_b16 a[112:113], v68 offset:24576
    v_mfma_f32_16x16x32_bf16 v[172:175], a[52:55], a[140:143], v[172:175]
    ds_read_b64_tr_b16 a[114:115], v68 offset:28672
    ds_read_b64_tr_b16 a[116:117], v69 offset:24576
    v_mfma_f32_16x16x32_bf16 v[176:179], a[56:59], a[136:139], v[176:179]
    ds_read_b64_tr_b16 a[118:119], v69 offset:28672
    v_mfma_f32_16x16x32_bf16 v[180:183], a[56:59], a[140:143], v[180:183]
    buffer_load_dwordx4 a[184:187], v89, s[8:11], s62 offen offset:0 sc1
    ds_read_b64_tr_b16 a[120:121], v70 offset:24576
    v_mfma_f32_16x16x32_bf16 v[184:187], a[60:63], a[136:139], v[184:187]
    ds_read_b64_tr_b16 a[122:123], v70 offset:28672
    ds_read_b64_tr_b16 a[124:125], v71 offset:24576
    v_mfma_f32_16x16x32_bf16 v[188:191], a[60:63], a[140:143], v[188:191]
    ds_read_b64_tr_b16 a[126:127], v71 offset:28672
    v_mfma_f32_16x16x32_bf16 v[128:131], a[32:35], a[136:139], v[128:131]
    buffer_load_dwordx4 a[188:191], v89, s[8:11], s62 offen offset:1024 sc1
    v_mfma_f32_16x16x32_bf16 v[132:135], a[32:35], a[140:143], v[132:135]
    v_mfma_f32_16x16x32_bf16 v[136:139], a[36:39], a[136:139], v[136:139]
    v_mfma_f32_16x16x32_bf16 v[140:143], a[36:39], a[140:143], v[140:143]
    v_mfma_f32_16x16x32_bf16 v[144:147], a[40:43], a[136:139], v[144:147]
    s_cmp_eq_u32 s63, 7
    s_cbranch_scc1 k12_ool_131
k12_oolret_132:
    v_mfma_f32_16x16x32_bf16 v[148:151], a[40:43], a[140:143], v[148:151]
    s_add_u32 s62, s62, 0x40000
    s_and_b32 s62, s62, 0x7fffff
    v_mfma_f32_16x16x32_bf16 v[152:155], a[44:47], a[136:139], v[152:155]
    v_mfma_f32_16x16x32_bf16 v[156:159], a[44:47], a[140:143], v[156:159]
    s_waitcnt vmcnt(12) lgkmcnt(0)
    s_barrier
    v_mfma_f32_16x16x32_bf16 v[160:163], a[80:83], a[144:147], v[160:163]
    s_add_u32 s32, s63, 1
    s_lshr_b32 s32, s32, 1
    ds_read_b64_tr_b16 a[0:1], v64 offset:32768
    v_cmp_le_u32 vcc, 4, v74
    v_mfma_f32_16x16x32_bf16 v[164:167], a[80:83], a[148:151], v[164:167]
    s_add_u32 m0, s60, 0
    ds_read_b64_tr_b16 a[2:3], v64 offset:36864
    ds_read_b64_tr_b16 a[4:5], v65 offset:32768
    v_mfma_f32_16x16x32_bf16 v[168:171], a[84:87], a[144:147], v[168:171]
    s_or_b32 s33, vcc_lo, 16
    buffer_load_dwordx4 v90, s[12:15], s61 offen offset:0 lds
    ds_read_b64_tr_b16 a[6:7], v65 offset:36864
    v_mfma_f32_16x16x32_bf16 v[172:175], a[84:87], a[148:151], v[172:175]
    ds_read_b64_tr_b16 a[8:9], v66 offset:32768
    ds_read_b64_tr_b16 a[10:11], v66 offset:36864
    v_mfma_f32_16x16x32_bf16 v[176:179], a[88:91], a[144:147], v[176:179]
    buffer_load_dwordx4 v91, s[12:15], s61 offen offset:1024 lds
    ds_read_b64_tr_b16 a[12:13], v67 offset:32768
    v_mfma_f32_16x16x32_bf16 v[180:183], a[88:91], a[148:151], v[180:183]
    ds_read_b64_tr_b16 a[14:15], v67 offset:36864
    ds_read_b64_tr_b16 a[16:17], v68 offset:32768
    v_mfma_f32_16x16x32_bf16 v[184:187], a[92:95], a[144:147], v[184:187]
    s_bitcmp0_b32 s33, s32
    s_cbranch_scc1 k12_ool_135
k12_oolret_136:
    v_mfma_f32_16x16x32_bf16 v[188:191], a[92:95], a[148:151], v[188:191]
    ds_read_b64_tr_b16 a[18:19], v68 offset:36864
    ds_read_b64_tr_b16 a[20:21], v69 offset:32768
    v_mfma_f32_16x16x32_bf16 v[128:131], a[64:67], a[144:147], v[128:131]
    buffer_load_dwordx4 v92, s[12:15], s61 offen offset:2048 lds
    ds_read_b64_tr_b16 a[22:23], v69 offset:36864
    v_mfma_f32_16x16x32_bf16 v[132:135], a[64:67], a[148:151], v[132:135]
    ds_read_b64_tr_b16 a[24:25], v70 offset:32768
    ds_read_b64_tr_b16 a[26:27], v70 offset:36864
    v_mfma_f32_16x16x32_bf16 v[136:139], a[68:71], a[144:147], v[136:139]
    buffer_load_dwordx4 v93, s[12:15], s61 offen offset:3072 lds
    ds_read_b64_tr_b16 a[28:29], v71 offset:32768
    v_mfma_f32_16x16x32_bf16 v[140:143], a[68:71], a[148:151], v[140:143]
    ds_read_b64_tr_b16 a[30:31], v71 offset:36864
    ds_read_b64_tr_b16 a[32:33], v64 offset:40960
    v_mfma_f32_16x16x32_bf16 v[144:147], a[72:75], a[144:147], v[144:147]
    ds_read_b64_tr_b16 a[34:35], v64 offset:45056
    v_mfma_f32_16x16x32_bf16 v[148:151], a[72:75], a[148:151], v[148:151]
    ds_read_b64_tr_b16 a[36:37], v65 offset:40960
    v_mfma_f32_16x16x32_bf16 v[152:155], a[76:79], a[144:147], v[152:155]
    buffer_load_dwordx4 a[128:131], v88, s[8:11], s62 offen offset:0 sc1
    ds_read_b64_tr_b16 a[38:39], v65 offset:45056
    v_mfma_f32_16x16x32_bf16 v[156:159], a[76:79], a[148:151], v[156:159]
    s_add_u32 s61, s61, 0x20000
    s_and_b32 s61, s61, 0x3fffff
    ds_read_b64_tr_b16 a[40:41], v66 offset:40960
    ds_read_b64_tr_b16 a[42:43], v66 offset:45056
    v_mfma_f32_16x16x32_bf16 v[160:163], a[112:115], a[152:155], v[160:163]
    ds_read_b64_tr_b16 a[44:45], v67 offset:40960
    v_mfma_f32_16x16x32_bf16 v[164:167], a[112:115], a[156:159], v[164:167]
    buffer_load_dwordx4 a[132:135], v88, s[8:11], s62 offen offset:1024 sc1
    ds_read_b64_tr_b16 a[46:47], v67 offset:45056
    v_mfma_f32_16x16x32_bf16 v[168:171], a[116:119], a[152:155], v[168:171]
    ds_read_b64_tr_b16 a[48:49], v68 offset:40960
    v_mfma_f32_16x16x32_bf16 v[172:175], a[116:119], a[156:159], v[172:175]
    ds_read_b64_tr_b16 a[50:51], v68 offset:45056
    ds_read_b64_tr_b16 a[52:53], v69 offset:40960
    v_mfma_f32_16x16x32_bf16 v[176:179], a[120:123], a[152:155], v[176:179]
    ds_read_b64_tr_b16 a[54:55], v69 offset:45056
    v_mfma_f32_16x16x32_bf16 v[180:183], a[120:123], a[156:159], v[180:183]
    buffer_load_dwordx4 a[136:139], v89, s[8:11], s62 offen offset:0 sc1
    ds_read_b64_tr_b16 a[56:57], v70 offset:40960
    v_mfma_f32_16x16x32_bf16 v[184:187], a[124:127], a[152:155], v[184:187]
    ds_read_b64_tr_b16 a[58:59], v70 offset:45056
    ds_read_b64_tr_b16 a[60:61], v71 offset:40960
    v_mfma_f32_16x16x32_bf16 v[188:191], a[124:127], a[156:159], v[188:191]
    ds_read_b64_tr_b16 a[62:63], v71 offset:45056
    v_mfma_f32_16x16x32_bf16 v[128:131], a[96:99], a[152:155], v[128:131]
    buffer_load_dwordx4 a[140:143], v89, s[8:11], s62 offen offset:1024 sc1
    v_mfma_f32_16x16x32_bf16 v[132:135], a[96:99], a[156:159], v[132:135]
    v_mfma_f32_16x16x32_bf16 v[136:139], a[100:103], a[152:155], v[136:139]
    s_cmp_eq_u32 s63, 6
    s_cbranch_scc1 k12_ool_137
k12_oolret_138:
    v_mfma_f32_16x16x32_bf16 v[140:143], a[100:103], a[156:159], v[140:143]
    v_mfma_f32_16x16x32_bf16 v[144:147], a[104:107], a[152:155], v[144:147]
    v_mfma_f32_16x16x32_bf16 v[148:151], a[104:107], a[156:159], v[148:151]
    s_add_u32 s62, s62, 0x40000
    s_and_b32 s62, s62, 0x7fffff
    v_mfma_f32_16x16x32_bf16 v[152:155], a[108:111], a[152:155], v[152:155]
    v_mfma_f32_16x16x32_bf16 v[156:159], a[108:111], a[156:159], v[156:159]
    s_waitcnt vmcnt(12) lgkmcnt(0)
    s_barrier
    v_mfma_f32_16x16x32_bf16 v[160:163], a[16:19], a[160:163], v[160:163]
    s_add_u32 m0, s60, 16384
    buffer_load_dword v74, v73, s[16:19], s59 offen sc1
    ds_read_b64_tr_b16 a[64:65], v64 offset:49152
    v_mfma_f32_16x16x32_bf16 v[164:167], a[16:19], a[164:167], v[164:167]
    buffer_load_dwordx4 v90, s[12:15], s61 offen offset:0 lds
    ds_read_b64_tr_b16 a[66:67], v64 offset:53248
    v_mfma_f32_16x16x32_bf16 v[168:171], a[20:23], a[160:163], v[168:171]
    ds_read_b64_tr_b16 a[68:69], v65 offset:49152
    ds_read_b64_tr_b16 a[70:71], v65 offset:53248
    v_mfma_f32_16x16x32_bf16 v[172:175], a[20:23], a[164:167], v[172:175]
    ds_read_b64_tr_b16 a[72:73], v66 offset:49152
    ds_read_b64_tr_b16 a[74:75], v66 offset:53248
    v_mfma_f32_16x16x32_bf16 v[176:179], a[24:27], a[160:163], v[176:179]
    buffer_load_dwordx4 v91, s[12:15], s61 offen offset:1024 lds
    ds_read_b64_tr_b16 a[76:77], v67 offset:49152
    v_mfma_f32_16x16x32_bf16 v[180:183], a[24:27], a[164:167], v[180:183]
    ds_read_b64_tr_b16 a[78:79], v67 offset:53248
    ds_read_b64_tr_b16 a[80:81], v68 offset:49152
    v_mfma_f32_16x16x32_bf16 v[184:187], a[28:31], a[160:163], v[184:187]
    ds_read_b64_tr_b16 a[82:83], v68 offset:53248
    v_mfma_f32_16x16x32_bf16 v[188:191], a[28:31], a[164:167], v[188:191]
    buffer_load_dwordx4 v92, s[12:15], s61 offen offset:2048 lds
    ds_read_b64_tr_b16 a[84:85], v69 offset:49152
    v_mfma_f32_16x16x32_bf16 v[128:131], a[0:3], a[160:163], v[128:131]
    ds_read_b64_tr_b16 a[86:87], v69 offset:53248
    ds_read_b64_tr_b16 a[88:89], v70 offset:49152
    v_mfma_f32_16x16x32_bf16 v[132:135], a[0:3], a[164:167], v[132:135]
    ds_read_b64_tr_b16 a[90:91], v70 offset:53248
    v_mfma_f32_16x16x32_bf16 v[136:139], a[4:7], a[160:163], v[136:139]
    buffer_load_dwordx4 v93, s[12:15], s61 offen offset:3072 lds
    ds_read_b64_tr_b16 a[92:93], v71 offset:49152
    v_mfma_f32_16x16x32_bf16 v[140:143], a[4:7], a[164:167], v[140:143]
    ds_read_b64_tr_b16 a[94:95], v71 offset:53248
    ds_read_b64_tr_b16 a[96:97], v64 offset:57344
    v_mfma_f32_16x16x32_bf16 v[144:147], a[8:11], a[160:163], v[144:147]
    ds_read_b64_tr_b16 a[98:99], v64 offset:61440
    v_mfma_f32_16x16x32_bf16 v[148:151], a[8:11], a[164:167], v[148:151]
    ds_read_b64_tr_b16 a[100:101], v65 offset:57344
    v_mfma_f32_16x16x32_bf16 v[152:155], a[12:15], a[160:163], v[152:155]
    buffer_load_dwordx4 a[144:147], v88, s[8:11], s62 offen offset:0 sc1
    ds_read_b64_tr_b16 a[102:103], v65 offset:61440
    v_mfma_f32_16x16x32_bf16 v[156:159], a[12:15], a[164:167], v[156:159]
    s_add_u32 s61, s61, 0x20000
    s_and_b32 s61, s61, 0x3fffff
    ds_read_b64_tr_b16 a[104:105], v66 offset:57344
    ds_read_b64_tr_b16 a[106:107], v66 offset:61440
    v_mfma_f32_16x16x32_bf16 v[160:163], a[48:51], a[168:171], v[160:163]
    ds_read_b64_tr_b16 a[108:109], v67 offset:57344
    v_mfma_f32_16x16x32_bf16 v[164:167], a[48:51], a[172:175], v[164:167]
    buffer_load_dwordx4 a[148:151], v88, s[8:11], s62 offen offset:1024 sc1
    ds_read_b64_tr_b16 a[110:111], v67 offset:61440
    v_mfma_f32_16x16x32_bf16 v[168:171], a[52:55], a[168:171], v[168:171]
    ds_read_b64_tr_b16 a[112:113], v68 offset:57344
    v_mfma_f32_16x16x32_bf16 v[172:175], a[52:55], a[172:175], v[172:175]
    ds_read_b64_tr_b16 a[114:115], v68 offset:61440
    ds_read_b64_tr_b16 a[116:117], v69 offset:57344
    v_mfma_f32_16x16x32_bf16 v[176:179], a[56:59], a[168:171], v[176:179]
    ds_read_b64_tr_b16 a[118:119], v69 offset:61440
    v_mfma_f32_16x16x32_bf16 v[180:183], a[56:59], a[172:175], v[180:183]
    buffer_load_dwordx4 a[152:155], v89, s[8:11], s62 offen offset:0 sc1
    ds_read_b64_tr_b16 a[120:121], v70 offset:57344
    v_mfma_f32_16x16x32_bf16 v[184:187], a[60:63], a[168:171], v[184:187]
    ds_read_b64_tr_b16 a[122:123], v70 offset:61440
    ds_read_b64_tr_b16 a[124:125], v71 offset:57344
    v_mfma_f32_16x16x32_bf16 v[188:191], a[60:63], a[172:175], v[188:191]
    ds_read_b64_tr_b16 a[126:127], v71 offset:61440
    v_mfma_f32_16x16x32_bf16 v[128:131], a[32:35], a[168:171], v[128:131]
    buffer_load_dwordx4 a[156:159], v89, s[8:11], s62 offen offset:1024 sc1
    v_mfma_f32_16x16x32_bf16 v[132:135], a[32:35], a[172:175], v[132:135]
    v_mfma_f32_16x16x32_bf16 v[136:139], a[36:39], a[168:171], v[136:139]
    v_mfma_f32_16x16x32_bf16 v[140:143], a[36:39], a[172:175], v[140:143]
    v_mfma_f32_16x16x32_bf16 v[144:147], a[40:43], a[168:171], v[144:147]
    v_mfma_f32_16x16x32_bf16 v[148:151], a[40:43], a[172:175], v[148:151]
    s_add_u32 s62, s62, 0x40000
    s_and_b32 s62, s62, 0x7fffff
    v_mfma_f32_16x16x32_bf16 v[152:155], a[44:47], a[168:171], v[152:155]
    v_mfma_f32_16x16x32_bf16 v[156:159], a[44:47], a[172:175], v[156:159]
    s_waitcnt vmcnt(12) lgkmcnt(0)
    s_barrier
    v_mfma_f32_16x16x32_bf16 v[160:163], a[80:83], a[176:179], v[160:163]
    s_add_u32 m0, s60, 32768
    ds_read_b64_tr_b16 a[0:1], v64 offset:0
    ds_read_b64_tr_b16 a[2:3], v64 offset:4096
    v_mfma_f32_16x16x32_bf16 v[164:167], a[80:83], a[180:183], v[164:167]
    buffer_load_dwordx4 v90, s[12:15], s61 offen offset:0 lds
    ds_read_b64_tr_b16 a[4:5], v65 offset:0
    v_mfma_f32_16x16x32_bf16 v[168:171], a[84:87], a[176:179], v[168:171]
    ds_read_b64_tr_b16 a[6:7], v65 offset:4096
    ds_read_b64_tr_b16 a[8:9], v66 offset:0
    v_mfma_f32_16x16x32_bf16 v[172:175], a[84:87], a[180:183], v[172:175]
    buffer_load_dwordx4 v91, s[12:15], s61 offen offset:1024 lds
    ds_read_b64_tr_b16 a[10:11], v66 offset:4096
    v_mfma_f32_16x16x32_bf16 v[176:179], a[88:91], a[176:179], v[176:179]
    ds_read_b64_tr_b16 a[12:13], v67 offset:0
    ds_read_b64_tr_b16 a[14:15], v67 offset:4096
    v_mfma_f32_16x16x32_bf16 v[180:183], a[88:91], a[180:183], v[180:183]
    ds_read_b64_tr_b16 a[16:17], v68 offset:0
    v_mfma_f32_16x16x32_bf16 v[184:187], a[92:95], a[176:179], v[184:187]
    ds_read_b64_tr_b16 a[18:19], v68 offset:4096
    v_mfma_f32_16x16x32_bf16 v[188:191], a[92:95], a[180:183], v[188:191]
    buffer_load_dwordx4 v92, s[12:15], s61 offen offset:2048 lds
    ds_read_b64_tr_b16 a[20:21], v69 offset:0
    v_mfma_f32_16x16x32_bf16 v[128:131], a[64:67], a[176:179], v[128:131]
    ds_read_b64_tr_b16 a[22:23], v69 offset:4096
    ds_read_b64_tr_b16 a[24:25], v70 offset:0
    v_mfma_f32_16x16x32_bf16 v[132:135], a[64:67], a[180:183], v[132:135]
    ds_read_b64_tr_b16 a[26:27], v70 offset:4096
    v_mfma_f32_16x16x32_bf16 v[136:139], a[68:71], a[176:179], v[136:139]
    buffer_load_dwordx4 v93, s[12:15], s61 offen offset:3072 lds
    ds_read_b64_tr_b16 a[28:29], v71 offset:0
    v_mfma_f32_16x16x32_bf16 v[140:143], a[68:71], a[180:183], v[140:143]
    ds_read_b64_tr_b16 a[30:31], v71 offset:4096
    ds_read_b64_tr_b16 a[32:33], v64 offset:8192
    v_mfma_f32_16x16x32_bf16 v[144:147], a[72:75], a[176:179], v[144:147]
    ds_read_b64_tr_b16 a[34:35], v64 offset:12288
    v_mfma_f32_16x16x32_bf16 v[148:151], a[72:75], a[180:183], v[148:151]
    ds_read_b64_tr_b16 a[36:37], v65 offset:8192
    v_mfma_f32_16x16x32_bf16 v[152:155], a[76:79], a[176:179], v[152:155]
    buffer_load_dwordx4 a[160:163], v88, s[8:11], s62 offen offset:0 sc1
    ds_read_b64_tr_b16 a[38:39], v65 offset:12288
    v_mfma_f32_16x16x32_bf16 v[156:159], a[76:79], a[180:183], v[156:159]
    s_add_u32 s61, s61, 0x20000
    s_and_b32 s61, s61, 0x3fffff
    ds_read_b64_tr_b16 a[40:41], v66 offset:8192
    ds_read_b64_tr_b16 a[42:43], v66 offset:12288
    v_mfma_f32_16x16x32_bf16 v[160:163], a[112:115], a[184:187], v[160:163]
    ds_read_b64_tr_b16 a[44:45], v67 offset:8192
    v_mfma_f32_16x16x32_bf16 v[164:167], a[112:115], a[188:191], v[164:167]
    buffer_load_dwordx4 a[164:167], v88, s[8:11], s62 offen offset:1024 sc1
    ds_read_b64_tr_b16 a[46:47], v67 offset:12288
    v_mfma_f32_16x16x32_bf16 v[168:171], a[116:119], a[184:187], v[168:171]
    ds_read_b64_tr_b16 a[48:49], v68 offset:8192
    v_mfma_f32_16x16x32_bf16 v[172:175], a[116:119], a[188:191], v[172:175]
    ds_read_b64_tr_b16 a[50:51], v68 offset:12288
    ds_read_b64_tr_b16 a[52:53], v69 offset:8192
    v_mfma_f32_16x16x32_bf16 v[176:179], a[120:123], a[184:187], v[176:179]
    ds_read_b64_tr_b16 a[54:55], v69 offset:12288
    v_mfma_f32_16x16x32_bf16 v[180:183], a[120:123], a[188:191], v[180:183]
    buffer_load_dwordx4 a[168:171], v89, s[8:11], s62 offen offset:0 sc1
    ds_read_b64_tr_b16 a[56:57], v70 offset:8192
    v_mfma_f32_16x16x32_bf16 v[184:187], a[124:127], a[184:187], v[184:187]
    ds_read_b64_tr_b16 a[58:59], v70 offset:12288
    ds_read_b64_tr_b16 a[60:61], v71 offset:8192
    v_mfma_f32_16x16x32_bf16 v[188:191], a[124:127], a[188:191], v[188:191]
    ds_read_b64_tr_b16 a[62:63], v71 offset:12288
    v_mfma_f32_16x16x32_bf16 v[128:131], a[96:99], a[184:187], v[128:131]
    buffer_load_dwordx4 a[172:175], v89, s[8:11], s62 offen offset:1024 sc1
    v_mfma_f32_16x16x32_bf16 v[132:135], a[96:99], a[188:191], v[132:135]
    v_mfma_f32_16x16x32_bf16 v[136:139], a[100:103], a[184:187], v[136:139]
    v_mfma_f32_16x16x32_bf16 v[140:143], a[100:103], a[188:191], v[140:143]
    v_mfma_f32_16x16x32_bf16 v[144:147], a[104:107], a[184:187], v[144:147]
    v_mfma_f32_16x16x32_bf16 v[148:151], a[104:107], a[188:191], v[148:151]
    s_add_u32 s62, s62, 0x40000
    s_and_b32 s62, s62, 0x7fffff
    v_mfma_f32_16x16x32_bf16 v[152:155], a[108:111], a[184:187], v[152:155]
    s_add_u32 s63, s63, 1
    v_mfma_f32_16x16x32_bf16 v[156:159], a[108:111], a[188:191], v[156:159]
    s_waitcnt vmcnt(12) lgkmcnt(0)
    s_barrier
    s_cmp_lt_u32 s63, 8
    s_cbranch_scc1 op_loop_128
op_tail:
    s_nop 1
    v_cvt_pk_bf16_f32 v160, v160, v161
    v_cvt_pk_bf16_f32 v161, v162, v163
    v_cvt_pk_bf16_f32 v162, v164, v165
    v_cvt_pk_bf16_f32 v163, v166, v167
    buffer_store_dwordx4 v[160:163], v1, s[36:39], s52 offen offset:0 sc1
    v_cvt_pk_bf16_f32 v168, v168, v169
    v_cvt_pk_bf16_f32 v169, v170, v171
    v_cvt_pk_bf16_f32 v170, v172, v173
    v_cvt_pk_bf16_f32 v171, v174, v175
    buffer_store_dwordx4 v[168:171], v1, s[36:39], s52 offen offset:1024 sc1
    v_cvt_pk_bf16_f32 v176, v176, v177
    v_cvt_pk_bf16_f32 v177, v178, v179
    v_cvt_pk_bf16_f32 v178, v180, v181
    v_cvt_pk_bf16_f32 v179, v182, v183
    buffer_store_dwordx4 v[176:179], v1, s[36:39], s52 offen offset:2048 sc1
    v_cvt_pk_bf16_f32 v184, v184, v185
    v_cvt_pk_bf16_f32 v185, v186, v187
    v_cvt_pk_bf16_f32 v186, v188, v189
    v_cvt_pk_bf16_f32 v187, v190, v191
    buffer_store_dwordx4 v[184:187], v1, s[36:39], s52 offen offset:3072 sc1
    s_add_u32 s32, s6, 0x4800000
    s_addc_u32 s33, s7, 0
    s_and_b32 s33, s33, 0xffff
    s_mov_b32 s34, 0x6000
    s_mov_b32 s35, 0x00020000
    s_waitcnt vmcnt(4) lgkmcnt(0)
    v_lshlrev_b32 v58, 16, v192
    v_and_b32 v59, 0xffff0000, v192
    v_pk_add_f32 v[128:129], v[128:129], v[58:59]
    v_lshlrev_b32 v58, 16, v193
    v_and_b32 v59, 0xffff0000, v193
    v_pk_add_f32 v[130:131], v[130:131], v[58:59]
    v_lshlrev_b32 v58, 16, v200
    v_and_b32 v59, 0xffff0000, v200
    v_pk_add_f32 v[132:133], v[132:133], v[58:59]
    v_lshlrev_b32 v58, 16, v201
    v_and_b32 v59, 0xffff0000, v201
    v_pk_add_f32 v[134:135], v[134:135], v[58:59]
    v_lshlrev_b32 v58, 16, v194
    v_and_b32 v59, 0xffff0000, v194
    v_pk_add_f32 v[136:137], v[136:137], v[58:59]
    v_lshlrev_b32 v58, 16, v195
    v_and_b32 v59, 0xffff0000, v195
    v_pk_add_f32 v[138:139], v[138:139], v[58:59]
    v_lshlrev_b32 v58, 16, v202
    v_and_b32 v59, 0xffff0000, v202
    v_pk_add_f32 v[140:141], v[140:141], v[58:59]
    v_lshlrev_b32 v58, 16, v203
    v_and_b32 v59, 0xffff0000, v203
    v_pk_add_f32 v[142:143], v[142:143], v[58:59]
    v_lshlrev_b32 v58, 16, v196
    v_and_b32 v59, 0xffff0000, v196
    v_pk_add_f32 v[144:145], v[144:145], v[58:59]
    v_lshlrev_b32 v58, 16, v197
    v_and_b32 v59, 0xffff0000, v197
    v_pk_add_f32 v[146:147], v[146:147], v[58:59]
    v_lshlrev_b32 v58, 16, v204
    v_and_b32 v59, 0xffff0000, v204
    v_pk_add_f32 v[148:149], v[148:149], v[58:59]
    v_lshlrev_b32 v58, 16, v205
    v_and_b32 v59, 0xffff0000, v205
    v_pk_add_f32 v[150:151], v[150:151], v[58:59]
    v_lshlrev_b32 v58, 16, v198
    v_and_b32 v59, 0xffff0000, v198
    v_pk_add_f32 v[152:153], v[152:153], v[58:59]
    v_lshlrev_b32 v58, 16, v199
    v_and_b32 v59, 0xffff0000, v199
    v_pk_add_f32 v[154:155], v[154:155], v[58:59]
    v_lshlrev_b32 v58, 16, v206
    v_and_b32 v59, 0xffff0000, v206
    v_pk_add_f32 v[156:157], v[156:157], v[58:59]
    v_lshlrev_b32 v58, 16, v207
    v_and_b32 v59, 0xffff0000, v207
    v_pk_add_f32 v[158:159], v[158:159], v[58:59]
    v_and_b32 v58, 1, v72
    v_lshrrev_b32 v59, 1, v72
    v_lshlrev_b32 v58, 5, v58
    v_lshl_add_u32 v58, v59, 4, v58
    v_lshlrev_b32 v59, 3, v72
    v_sub_u32 v58, v58, v59
    v_add_u32 v78, v78, v58
    v_add_u32 v79, v79, v58
    v_lshlrev_b32 v32, 16, v208
    v_and_b32 v33, 0xffff0000, v208
    v_lshlrev_b32 v34, 16, v209
    v_and_b32 v35, 0xffff0000, v209
    v_lshlrev_b32 v36, 16, v210
    v_and_b32 v37, 0xffff0000, v210
    v_lshlrev_b32 v38, 16, v211
    v_and_b32 v39, 0xffff0000, v211
    v_lshlrev_b32 v40, 16, v212
    v_and_b32 v41, 0xffff0000, v212
    v_lshlrev_b32 v42, 16, v213
    v_and_b32 v43, 0xffff0000, v213
    v_lshlrev_b32 v44, 16, v214
    v_and_b32 v45, 0xffff0000, v214
    v_lshlrev_b32 v46, 16, v215
    v_and_b32 v47, 0xffff0000, v215
    s_or_b32 s31, s54, s30
    s_cbranch_scc1 op_nowr_139
    v_pk_add_f32 v[56:57], v[32:33], v[34:35]
    v_pk_add_f32 v[56:57], v[56:57], v[36:37]
    v_pk_add_f32 v[56:57], v[56:57], v[38:39]
    v_pk_add_f32 v[56:57], v[56:57], v[40:41]
    v_pk_add_f32 v[56:57], v[56:57], v[42:43]
    v_pk_add_f32 v[56:57], v[56:57], v[44:45]
    v_pk_add_f32 v[56:57], v[56:57], v[46:47]
    v_add_f32 v56, v56, v57
    v_mov_b32 v57, v56
    s_nop 1
    v_permlane16_swap_b32 v56, v57
    s_nop 1
    v_add_f32 v56, v56, v57
    v_mov_b32 v57, v56
    s_nop 1
    v_permlane32_swap_b32 v56, v57
    s_nop 1
    v_add_f32 v56, v56, v57
    s_mov_b32 s31, 24704
    s_mov_b32 s34, 24708
    s_mov_b64 exec, 1
    buffer_atomic_add_f32 v56, v75, s[32:35], s31 offen
    s_mov_b64 exec, -1
    s_mov_b32 s34, 24576
op_nowr_139:
    v_mov_b32 v208, 0
    v_mov_b32 v209, 0
    v_mov_b32 v210, 0
    v_mov_b32 v211, 0
    v_mov_b32 v212, 0
    v_mov_b32 v213, 0
    v_mov_b32 v214, 0
    v_mov_b32 v215, 0
    v_mov_b32 v216, 0
    v_mov_b32 v217, 0
    v_mov_b32 v218, 0
    v_mov_b32 v219, 0
    s_waitcnt vmcnt(0)
    s_barrier
    s_cmp_lg_u32 s30, 0
    s_cbranch_scc1 op_nopoll_140
    s_mov_b64 exec, 1
    buffer_store_dword v76, v75, s[48:51], s57 offen sc1
    s_mov_b64 exec, -1
    s_mov_b32 s40, 1048576
op_xspin_141:
    buffer_load_dword v84, v75, s[48:51], s58 offen sc1
    s_waitcnt vmcnt(0)
    v_readfirstlane_b32 s41, v84
    s_sub_u32 s40, s40, 1
    s_cselect_b32 s41, 1, s41
    s_cmp_eq_u32 s41, 0
    s_cbranch_scc1 op_xspin_141
op_nopoll_140:
    s_barrier
    buffer_load_dwordx4 v[160:163], v1, s[36:39], s53 offen offset:0 sc1
    buffer_load_dwordx4 v[164:167], v1, s[36:39], s53 offen offset:1024 sc1
    buffer_load_dwordx4 v[168:171], v1, s[36:39], s53 offen offset:2048 sc1
    buffer_load_dwordx4 v[172:175], v1, s[36:39], s53 offen offset:3072 sc1
    s_waitcnt vmcnt(3)
    v_lshlrev_b32 v56, 16, v160
    v_and_b32 v57, 0xffff0000, v160
    v_lshlrev_b32 v58, 16, v161
    v_and_b32 v59, 0xffff0000, v161
    v_pk_add_f32 v[128:129], v[128:129], v[56:57]
    v_pk_add_f32 v[130:131], v[130:131], v[58:59]
    v_cvt_pk_bf16_f32 v192, v128, v129
    v_cvt_pk_bf16_f32 v193, v130, v131
    v_lshlrev_b32 v128, 16, v192
    v_and_b32 v129, 0xffff0000, v192
    v_lshlrev_b32 v130, 16, v193
    v_and_b32 v131, 0xffff0000, v193
    v_pk_add_f32 v[208:209], v[208:209], v[128:129]
    v_pk_fma_f32 v[210:211], v[128:129], v[128:129], v[210:211]
    v_pk_fma_f32 v[212:213], v[128:129], v[32:33], v[212:213]
    v_pk_add_f32 v[208:209], v[208:209], v[130:131]
    v_pk_fma_f32 v[210:211], v[130:131], v[130:131], v[210:211]
    v_pk_fma_f32 v[212:213], v[130:131], v[34:35], v[212:213]
    v_lshlrev_b32 v56, 16, v162
    v_and_b32 v57, 0xffff0000, v162
    v_lshlrev_b32 v58, 16, v163
    v_and_b32 v59, 0xffff0000, v163
    v_pk_add_f32 v[132:133], v[132:133], v[56:57]
    v_pk_add_f32 v[134:135], v[134:135], v[58:59]
    v_cvt_pk_bf16_f32 v200, v132, v133
    v_cvt_pk_bf16_f32 v201, v134, v135
    v_lshlrev_b32 v132, 16, v200
    v_and_b32 v133, 0xffff0000, v200
    v_lshlrev_b32 v134, 16, v201
    v_and_b32 v135, 0xffff0000, v201
    v_pk_add_f32 v[214:215], v[214:215], v[132:133]
    v_pk_fma_f32 v[216:217], v[132:133], v[132:133], v[216:217]
    v_pk_fma_f32 v[218:219], v[132:133], v[32:33], v[218:219]
    v_pk_add_f32 v[214:215], v[214:215], v[134:135]
    v_pk_fma_f32 v[216:217], v[134:135], v[134:135], v[216:217]
    v_pk_fma_f32 v[218:219], v[134:135], v[34:35], v[218:219]
    s_waitcnt vmcnt(2)
    v_lshlrev_b32 v56, 16, v164
    v_and_b32 v57, 0xffff0000, v164
    v_lshlrev_b32 v58, 16, v165
    v_and_b32 v59, 0xffff0000, v165
    v_pk_add_f32 v[136:137], v[136:137], v[56:57]
    v_pk_add_f32 v[138:139], v[138:139], v[58:59]
    v_cvt_pk_bf16_f32 v194, v136, v137
    v_cvt_pk_bf16_f32 v195, v138, v139
    v_lshlrev_b32 v136, 16, v194
    v_and_b32 v137, 0xffff0000, v194
    v_lshlrev_b32 v138, 16, v195
    v_and_b32 v139, 0xffff0000, v195
    v_permlane16_swap_b32 v192, v194
    v_permlane16_swap_b32 v193, v195
    buffer_store_dwordx4 v[192:195], v78, s[24:27], 0 offen offset:0 sc1
    v_pk_add_f32 v[208:209], v[208:209], v[136:137]
    v_pk_fma_f32 v[210:211], v[136:137], v[136:137], v[210:211]
    v_pk_fma_f32 v[212:213], v[136:137], v[36:37], v[212:213]
    v_pk_add_f32 v[208:209], v[208:209], v[138:139]
    v_pk_fma_f32 v[210:211], v[138:139], v[138:139], v[210:211]
    v_pk_fma_f32 v[212:213], v[138:139], v[38:39], v[212:213]
    v_lshlrev_b32 v56, 16, v166
    v_and_b32 v57, 0xffff0000, v166
    v_lshlrev_b32 v58, 16, v167
    v_and_b32 v59, 0xffff0000, v167
    v_pk_add_f32 v[140:141], v[140:141], v[56:57]
    v_pk_add_f32 v[142:143], v[142:143], v[58:59]
    v_cvt_pk_bf16_f32 v202, v140, v141
    v_cvt_pk_bf16_f32 v203, v142, v143
    v_lshlrev_b32 v140, 16, v202
    v_and_b32 v141, 0xffff0000, v202
    v_lshlrev_b32 v142, 16, v203
    v_and_b32 v143, 0xffff0000, v203
    v_permlane16_swap_b32 v200, v202
    v_permlane16_swap_b32 v201, v203
    buffer_store_dwordx4 v[200:203], v79, s[24:27], 0 offen offset:0 sc1
    v_pk_add_f32 v[214:215], v[214:215], v[140:141]
    v_pk_fma_f32 v[216:217], v[140:141], v[140:141], v[216:217]
    v_pk_fma_f32 v[218:219], v[140:141], v[36:37], v[218:219]
    v_pk_add_f32 v[214:215], v[214:215], v[142:143]
    v_pk_fma_f32 v[216:217], v[142:143], v[142:143], v[216:217]
    v_pk_fma_f32 v[218:219], v[142:143], v[38:39], v[218:219]
    s_waitcnt vmcnt(3)
    v_lshlrev_b32 v56, 16, v168
    v_and_b32 v57, 0xffff0000, v168
    v_lshlrev_b32 v58, 16, v169
    v_and_b32 v59, 0xffff0000, v169
    v_pk_add_f32 v[144:145], v[144:145], v[56:57]
    v_pk_add_f32 v[146:147], v[146:147], v[58:59]
    v_cvt_pk_bf16_f32 v196, v144, v145
    v_cvt_pk_bf16_f32 v197, v146, v147
    v_lshlrev_b32 v144, 16, v196
    v_and_b32 v145, 0xffff0000, v196
    v_lshlrev_b32 v146, 16, v197
    v_and_b32 v147, 0xffff0000, v197
    v_pk_add_f32 v[208:209], v[208:209], v[144:145]
    v_pk_fma_f32 v[210:211], v[144:145], v[144:145], v[210:211]
    v_pk_fma_f32 v[212:213], v[144:145], v[40:41], v[212:213]
    v_pk_add_f32 v[208:209], v[208:209], v[146:147]
    v_pk_fma_f32 v[210:211], v[146:147], v[146:147], v[210:211]
    v_pk_fma_f32 v[212:213], v[146:147], v[42:43], v[212:213]
    v_lshlrev_b32 v56, 16, v170
    v_and_b32 v57, 0xffff0000, v170
    v_lshlrev_b32 v58, 16, v171
    v_and_b32 v59, 0xffff0000, v171
    v_pk_add_f32 v[148:149], v[148:149], v[56:57]
    v_pk_add_f32 v[150:151], v[150:151], v[58:59]
    v_cvt_pk_bf16_f32 v204, v148, v149
    v_cvt_pk_bf16_f32 v205, v150, v151
    v_lshlrev_b32 v148, 16, v204
    v_and_b32 v149, 0xffff0000, v204
    v_lshlrev_b32 v150, 16, v205
    v_and_b32 v151, 0xffff0000, v205
    v_pk_add_f32 v[214:215], v[214:215], v[148:149]
    v_pk_fma_f32 v[216:217], v[148:149], v[148:149], v[216:217]
    v_pk_fma_f32 v[218:219], v[148:149], v[40:41], v[218:219]
    v_pk_add_f32 v[214:215], v[214:215], v[150:151]
    v_pk_fma_f32 v[216:217], v[150:151], v[150:151], v[216:217]
    v_pk_fma_f32 v[218:219], v[150:151], v[42:43], v[218:219]
    s_waitcnt vmcnt(2)
    v_lshlrev_b32 v56, 16, v172
    v_and_b32 v57, 0xffff0000, v172
    v_lshlrev_b32 v58, 16, v173
    v_and_b32 v59, 0xffff0000, v173
    v_pk_add_f32 v[152:153], v[152:153], v[56:57]
    v_pk_add_f32 v[154:155], v[154:155], v[58:59]
    v_cvt_pk_bf16_f32 v198, v152, v153
    v_cvt_pk_bf16_f32 v199, v154, v155
    v_lshlrev_b32 v152, 16, v198
    v_and_b32 v153, 0xffff0000, v198
    v_lshlrev_b32 v154, 16, v199
    v_and_b32 v155, 0xffff0000, v199
    v_permlane16_swap_b32 v196, v198
    v_permlane16_swap_b32 v197, v199
    buffer_store_dwordx4 v[196:199], v78, s[24:27], 0 offen offset:64 sc1
    v_pk_add_f32 v[208:209], v[208:209], v[152:153]
    v_pk_fma_f32 v[210:211], v[152:153], v[152:153], v[210:211]
    v_pk_fma_f32 v[212:213], v[152:153], v[44:45], v[212:213]
    v_pk_add_f32 v[208:209], v[208:209], v[154:155]
    v_pk_fma_f32 v[210:211], v[154:155], v[154:155], v[210:211]
    v_pk_fma_f32 v[212:213], v[154:155], v[46:47], v[212:213]
    v_lshlrev_b32 v56, 16, v174
    v_and_b32 v57, 0xffff0000, v174
    v_lshlrev_b32 v58, 16, v175
    v_and_b32 v59, 0xffff0000, v175
    v_pk_add_f32 v[156:157], v[156:157], v[56:57]
    v_pk_add_f32 v[158:159], v[158:159], v[58:59]
    v_cvt_pk_bf16_f32 v206, v156, v157
    v_cvt_pk_bf16_f32 v207, v158, v159
    v_lshlrev_b32 v156, 16, v206
    v_and_b32 v157, 0xffff0000, v206
    v_lshlrev_b32 v158, 16, v207
    v_and_b32 v159, 0xffff0000, v207
    v_permlane16_swap_b32 v204, v206
    v_permlane16_swap_b32 v205, v207
    buffer_store_dwordx4 v[204:207], v79, s[24:27], 0 offen offset:64 sc1
    v_pk_add_f32 v[214:215], v[214:215], v[156:157]
    v_pk_fma_f32 v[216:217], v[156:157], v[156:157], v[216:217]
    v_pk_fma_f32 v[218:219], v[156:157], v[44:45], v[218:219]
    v_pk_add_f32 v[214:215], v[214:215], v[158:159]
    v_pk_fma_f32 v[216:217], v[158:159], v[158:159], v[216:217]
    v_pk_fma_f32 v[218:219], v[158:159], v[46:47], v[218:219]
    v_add_f32 v48, v208, v209
    v_add_f32 v49, v210, v211
    v_add_f32 v50, v212, v213
    v_add_f32 v52, v214, v215
    v_add_f32 v53, v216, v217
    v_add_f32 v54, v218, v219
    v_mov_b32 v56, v48
    v_mov_b32 v57, v49
    v_mov_b32 v58, v50
    v_mov_b32 v59, v52
    v_mov_b32 v60, v53
    v_mov_b32 v61, v54
    s_nop 1
    v_permlane16_swap_b32 v48, v56
    v_permlane16_swap_b32 v49, v57
    v_permlane16_swap_b32 v50, v58
    v_permlane16_swap_b32 v52, v59
    v_permlane16_swap_b32 v53, v60
    v_permlane16_swap_b32 v54, v61
    s_nop 1
    v_add_f32 v48, v48, v56
    v_add_f32 v49, v49, v57
    v_add_f32 v50, v50, v58
    v_add_f32 v52, v52, v59
    v_add_f32 v53, v53, v60
    v_add_f32 v54, v54, v61
    v_mov_b32 v56, v48
    v_mov_b32 v57, v49
    v_mov_b32 v58, v50
    v_mov_b32 v59, v52
    v_mov_b32 v60, v53
    v_mov_b32 v61, v54
    s_nop 1
    v_permlane32_swap_b32 v48, v56
    v_permlane32_swap_b32 v49, v57
    v_permlane32_swap_b32 v50, v58
    v_permlane32_swap_b32 v52, v59
    v_permlane32_swap_b32 v53, v60
    v_permlane32_swap_b32 v54, v61
    s_nop 1
    v_add_f32 v48, v48, v56
    v_add_f32 v49, v49, v57
    v_add_f32 v50, v50, v58
    v_add_f32 v52, v52, v59
    v_add_f32 v53, v53, v60
    v_add_f32 v54, v54, v61
    v_cmp_eq_u32 s[40:41], 1, v72
    v_cmp_eq_u32 s[42:43], 2, v72
    s_nop 1
    v_cndmask_b32 v48, v48, v49, s[40:41]
    v_cndmask_b32 v48, v48, v50, s[42:43]
    buffer_atomic_add_f32 v48, v77, s[32:35], 0 offen offset:0
    v_cndmask_b32 v52, v52, v53, s[40:41]
    v_cndmask_b32 v52, v52, v54, s[42:43]
    buffer_atomic_add_f32 v52, v77, s[32:35], 0 offen offset:64
    s_load_dwordx2 s[42:43], s[0:1], 88
    s_load_dwordx2 s[56:57], s[0:1], 56
    s_add_u32 s16, s6, 0x4815000
    s_addc_u32 s17, s7, 0
    s_and_b32 s17, s17, 0xffff
    s_mov_b32 s18, 0x1000
    s_mov_b32 s19, 0x00020000
    v_lshrrev_b32 v3, 4, v1
    v_lshl_add_u32 v2, s30, 6, v3
    v_and_b32 v4, 31, v3
    v_lshrrev_b32 v5, 5, v3
    v_lshlrev_b32 v7, 4, v4
    v_and_b32 v8, 15, v3
    v_lshlrev_b32 v6, 7, v8
    s_bfe_u32 s31, s2, 0x20003
    s_lshl_b32 s31, s31, 7
    v_lshlrev_b32 v12, 9, v3
    v_and_b32 v14, 3, v3
    v_lshlrev_b32 v14, 7, v14
    s_and_b32 s59, s2, 7
    s_lshl_b32 s59, s59, 9
    s_setreg_imm32_b32 hwreg(HW_REG_MODE, 4, 2), 3
    s_waitcnt vmcnt(0) lgkmcnt(0)
    s_barrier
    s_cmp_lg_u32 s30, 0
    s_cbranch_scc1 ff_nosig_142
    s_mov_b64 exec, 0xff
    buffer_atomic_add v76, v12, s[16:19], s31 offen sc1
    s_mov_b64 exec, -1
ff_nosig_142:
    s_lshl_b32 s40, s30, 13
    s_add_u32 m0, s40, 65536
    s_add_u32 s41, s3, 0
    buffer_load_dwordx4 v1, s[44:47], s41 offen offset:0 sc1 lds
    buffer_load_dwordx4 v1, s[44:47], s41 offen offset:1024 sc1 lds
    buffer_load_dwordx4 v1, s[44:47], s41 offen offset:2048 sc1 lds
    buffer_load_dwordx4 v1, s[44:47], s41 offen offset:3072 sc1 lds
    s_lshl_b32 s40, s30, 13
    s_add_u32 m0, s40, 69632
    s_add_u32 s41, s3, 4096
    buffer_load_dwordx4 v1, s[44:47], s41 offen offset:0 sc1 lds
    buffer_load_dwordx4 v1, s[44:47], s41 offen offset:1024 sc1 lds
    buffer_load_dwordx4 v1, s[44:47], s41 offen offset:2048 sc1 lds
    buffer_load_dwordx4 v1, s[44:47], s41 offen offset:3072 sc1 lds
    s_lshl_b32 s40, s30, 13
    s_add_u32 m0, s40, 98304
    s_add_u32 s41, s3, 8388608
    buffer_load_dwordx4 v1, s[44:47], s41 offen offset:0 sc1 lds
    buffer_load_dwordx4 v1, s[44:47], s41 offen offset:1024 sc1 lds
    buffer_load_dwordx4 v1, s[44:47], s41 offen offset:2048 sc1 lds
    buffer_load_dwordx4 v1, s[44:47], s41 offen offset:3072 sc1 lds
    s_lshl_b32 s40, s30, 13
    s_add_u32 m0, s40, 102400
    s_add_u32 s41, s3, 8392704
    buffer_load_dwordx4 v1, s[44:47], s41 offen offset:0 sc1 lds
    buffer_load_dwordx4 v1, s[44:47], s41 offen offset:1024 sc1 lds
    buffer_load_dwordx4 v1, s[44:47], s41 offen offset:2048 sc1 lds
    buffer_load_dwordx4 v1, s[44:47], s41 offen offset:3072 sc1 lds
    s_lshl_b32 s41, s30, 9
    s_add_u32 s41, s41, 131072
    v_lshrrev_b32 v9, 1, v1
    v_add_u32 v9, s41, v9
    ds_read_b64 v[96:97], v9 offset:0
    ds_read_b64 v[98:99], v9 offset:2048
    ds_read_b64 v[100:101], v9 offset:4096
    ds_read_b64 v[102:103], v9 offset:6144
    ds_read_b64 v[104:105], v9 offset:8192
    ds_read_b64 v[106:107], v9 offset:10240
    ds_read_b64 v[108:109], v9 offset:12288
    ds_read_b64 v[110:111], v9 offset:14336
    ds_read_b64 v[112:113], v9 offset:16384
    ds_read_b64 v[114:115], v9 offset:18432
    ds_read_b64 v[116:117], v9 offset:20480
    ds_read_b64 v[118:119], v9 offset:22528
    ds_read_b64 v[120:121], v9 offset:24576
    ds_read_b64 v[122:123], v9 offset:26624
    ds_read_b64 v[124:125], v9 offset:28672
    ds_read_b64 v[126:127], v9 offset:30720
    s_mov_b32 s54, 0x05040100
    s_mov_b32 s53, 0x07060302
    s_waitcnt lgkmcnt(0)
    v_perm_b32 v144, v98, v96, s54
    v_perm_b32 v145, v98, v96, s53
    v_perm_b32 v146, v99, v97, s54
    v_perm_b32 v147, v99, v97, s53
    v_perm_b32 v148, v102, v100, s54
    v_perm_b32 v149, v102, v100, s53
    v_perm_b32 v150, v103, v101, s54
    v_perm_b32 v151, v103, v101, s53
    v_perm_b32 v152, v106, v104, s54
    v_perm_b32 v153, v106, v104, s53
    v_perm_b32 v154, v107, v105, s54
    v_perm_b32 v155, v107, v105, s53
    v_perm_b32 v156, v110, v108, s54
    v_perm_b32 v157, v110, v108, s53
    v_perm_b32 v158, v111, v109, s54
    v_perm_b32 v159, v111, v109, s53
    v_perm_b32 v160, v114, v112, s54
    v_perm_b32 v161, v114, v112, s53
    v_perm_b32 v162, v115, v113, s54
    v_perm_b32 v163, v115, v113, s53
    v_perm_b32 v164, v118, v116, s54
    v_perm_b32 v165, v118, v116, s53
    v_perm_b32 v166, v119, v117, s54
    v_perm_b32 v167, v119, v117, s53
    v_perm_b32 v168, v122, v120, s54
    v_perm_b32 v169, v122, v120, s53
    v_perm_b32 v170, v123, v121, s54
    v_perm_b32 v171, v123, v121, s53
    v_perm_b32 v172, v126, v124, s54
    v_perm_b32 v173, v126, v124, s53
    v_perm_b32 v174, v127, v125, s54
    v_perm_b32 v175, v127, v125, s53
    s_mov_b32 s34, 24708
    s_mov_b32 s36, s42
    s_and_b32 s37, s43, 0xffff
    s_mov_b32 s38, 0x400000
    s_mov_b32 s39, 0x00020000
    s_add_u32 s48, s6, 0x4900000
    s_addc_u32 s49, s7, 0
    s_and_b32 s49, s49, 0xffff
    s_mov_b32 s50, 0x1c0000
    s_mov_b32 s51, 0x00020000
    s_add_u32 s60, s6, 0x4816000
    s_addc_u32 s61, s7, 0
    s_and_b32 s61, s61, 0xffff
    s_mov_b32 s62, 0x10000
    s_mov_b32 s63, 0x00020000
    v_lshlrev_b32 v10, 5, v2
    v_lshl_add_u32 v11, s30, 1, v5
    s_lshl_b32 s31, s2, 3
    v_add_u32 v11, s31, v11
    v_lshl_add_u32 v0, v11, 11, v7
    s_cmp_lg_u32 s30, 0
    s_cbranch_scc1 ff_go_143
    s_mov_b32 s52, 1048576
ff_poll_144:
    buffer_load_dword v13, v14, s[16:19], s59 offen sc1
    s_sub_u32 s52, s52, 1
    s_cbranch_scc1 ff_go_143
    s_waitcnt vmcnt(0)
    v_cmp_gt_u32 vcc, 64, v13
    s_cbranch_vccz ff_go_143
    s_sleep 4
    s_branch ff_poll_144
ff_go_143:
    s_barrier
    s_mov_b32 s31, 0
    buffer_load_dwordx4 v[16:19], v10, s[32:35], s31 offen sc1
    buffer_load_dwordx4 v[20:23], v10, s[32:35], s31 offen offset:16 sc1
    s_mov_b32 s31, 8192
    buffer_load_dwordx4 v[24:27], v10, s[32:35], s31 offen sc1
    buffer_load_dwordx4 v[28:31], v10, s[32:35], s31 offen offset:16 sc1
    s_mov_b32 s31, 16384
    buffer_load_dwordx4 v[32:35], v10, s[32:35], s31 offen sc1
    buffer_load_dwordx4 v[36:39], v10, s[32:35], s31 offen offset:16 sc1
    s_mov_b32 s31, 24704
    buffer_load_dword v10, v75, s[32:35], s31 offen sc1
    buffer_load_dwordx4 v[128:131], v0, s[24:27], 0 offen offset:0 sc1
    buffer_load_dwordx4 v[132:135], v0, s[24:27], 0 offen offset:512 sc1
    buffer_load_dwordx4 v[136:139], v0, s[24:27], 0 offen offset:1024 sc1
    buffer_load_dwordx4 v[140:143], v0, s[24:27], 0 offen offset:1536 sc1
    s_mov_b32 s52, 0x3a800000
    s_mov_b32 s53, 0x3a800000
    s_mov_b32 s54, 0x7ff
    v_mov_b32 v14, 0x3727c5ac
    v_mov_b32 v15, v14
    v_mov_b32 v12, 0xff800000
    v_mov_b32 v13, v12
    s_waitcnt vmcnt(4)
    v_sub_f32 v56, 0, v10
    v_sub_f32 v57, 0, v10
    v_pk_mul_f32 v[16:17], v[16:17], s[52:53]
    v_pk_fma_f32 v[24:25], v[24:25], s[52:53], v[14:15]
    v_pk_fma_f32 v[32:33], v[16:17], v[56:57], v[32:33]
    v_pk_fma_f32 v[24:25], v[16:17], v[16:17], v[24:25] neg_lo:[1,0,0] neg_hi:[1,0,0]
    v_pk_mul_f32 v[18:19], v[18:19], s[52:53]
    v_pk_fma_f32 v[26:27], v[26:27], s[52:53], v[14:15]
    v_pk_fma_f32 v[34:35], v[18:19], v[56:57], v[34:35]
    v_pk_fma_f32 v[26:27], v[18:19], v[18:19], v[26:27] neg_lo:[1,0,0] neg_hi:[1,0,0]
    v_pk_mul_f32 v[20:21], v[20:21], s[52:53]
    v_pk_fma_f32 v[28:29], v[28:29], s[52:53], v[14:15]
    v_pk_fma_f32 v[36:37], v[20:21], v[56:57], v[36:37]
    v_pk_fma_f32 v[28:29], v[20:21], v[20:21], v[28:29] neg_lo:[1,0,0] neg_hi:[1,0,0]
    v_pk_mul_f32 v[22:23], v[22:23], s[52:53]
    v_pk_fma_f32 v[30:31], v[30:31], s[52:53], v[14:15]
    v_pk_fma_f32 v[38:39], v[22:23], v[56:57], v[38:39]
    v_pk_fma_f32 v[30:31], v[22:23], v[22:23], v[30:31] neg_lo:[1,0,0] neg_hi:[1,0,0]
    v_max_f32 v24, v14, v24
    v_max_f32 v25, v14, v25
    v_max_f32 v26, v14, v26
    v_max_f32 v27, v14, v27
    v_max_f32 v28, v14, v28
    v_max_f32 v29, v14, v29
    v_max_f32 v30, v14, v30
    v_max_f32 v31, v14, v31
    v_rsq_f32 v24, v24
    v_rsq_f32 v25, v25
    v_rsq_f32 v26, v26
    v_rsq_f32 v27, v27
    v_rsq_f32 v28, v28
    v_rsq_f32 v29, v29
    v_rsq_f32 v30, v30
    v_rsq_f32 v31, v31
    v_pk_mul_f32 v[32:33], v[32:33], v[24:25]
    v_pk_mul_f32 v[34:35], v[34:35], v[26:27]
    v_pk_mul_f32 v[36:37], v[36:37], v[28:29]
    v_pk_mul_f32 v[38:39], v[38:39], v[30:31]
    v_bfi_b32 v32, s54, 0, v32
    v_med3_f32 v13, v12, v13, v32
    v_max_f32 v12, v12, v32
    v_bfi_b32 v33, s54, 1, v33
    v_med3_f32 v13, v12, v13, v33
    v_max_f32 v12, v12, v33
    v_bfi_b32 v34, s54, 2, v34
    v_med3_f32 v13, v12, v13, v34
    v_max_f32 v12, v12, v34
    v_bfi_b32 v35, s54, 3, v35
    v_med3_f32 v13, v12, v13, v35
    v_max_f32 v12, v12, v35
    v_bfi_b32 v36, s54, 4, v36
    v_med3_f32 v13, v12, v13, v36
    v_max_f32 v12, v12, v36
    v_bfi_b32 v37, s54, 5, v37
    v_med3_f32 v13, v12, v13, v37
    v_max_f32 v12, v12, v37
    v_bfi_b32 v38, s54, 6, v38
    v_med3_f32 v13, v12, v13, v38
    v_max_f32 v12, v12, v38
    v_bfi_b32 v39, s54, 7, v39
    v_med3_f32 v13, v12, v13, v39
    v_max_f32 v12, v12, v39
    v_lshl_or_b32 v12, v2, 3, v12
    v_lshl_or_b32 v13, v2, 3, v13
    s_nop 1
    v_mov_b32_dpp v14, v12 quad_perm:[1,0,3,2] row_mask:0xf bank_mask:0xf
    v_mov_b32_dpp v15, v13 quad_perm:[1,0,3,2] row_mask:0xf bank_mask:0xf
    v_max_f32 v15, v15, v13
    v_med3_f32 v13, v12, v14, v15
    v_max_f32 v12, v12, v14
    s_nop 1
    v_mov_b32_dpp v14, v12 quad_perm:[2,3,0,1] row_mask:0xf bank_mask:0xf
    v_mov_b32_dpp v15, v13 quad_perm:[2,3,0,1] row_mask:0xf bank_mask:0xf
    v_max_f32 v15, v15, v13
    v_med3_f32 v13, v12, v14, v15
    v_max_f32 v12, v12, v14
    s_nop 1
    v_mov_b32_dpp v14, v12 row_half_mirror row_mask:0xf bank_mask:0xf
    v_mov_b32_dpp v15, v13 row_half_mirror row_mask:0xf bank_mask:0xf
    v_max_f32 v15, v15, v13
    v_med3_f32 v13, v12, v14, v15
    v_max_f32 v12, v12, v14
    s_nop 1
    v_mov_b32_dpp v14, v12 row_mirror row_mask:0xf bank_mask:0xf
    v_mov_b32_dpp v15, v13 row_mirror row_mask:0xf bank_mask:0xf
    v_max_f32 v15, v15, v13
    v_med3_f32 v13, v12, v14, v15
    v_max_f32 v12, v12, v14
    v_mov_b32 v14, v12
    v_mov_b32 v15, v13
    s_nop 1
    v_permlane16_swap_b32 v12, v14
    v_permlane16_swap_b32 v13, v15
    s_nop 1
    v_max_f32 v15, v15, v13
    v_med3_f32 v13, v12, v14, v15
    v_max_f32 v12, v12, v14
    v_mov_b32 v14, v12
    v_mov_b32 v15, v13
    s_nop 1
    v_permlane32_swap_b32 v12, v14
    v_permlane32_swap_b32 v13, v15
    s_nop 1
    v_max_f32 v15, v15, v13
    v_med3_f32 v13, v12, v14, v15
    v_max_f32 v12, v12, v14
    s_lshl_b32 s31, s30, 3
    s_add_u32 s31, s31, 8192
    v_mov_b32 v14, s31
    ds_write_b64 v14, v[12:13]
    v_mov_b32 v14, 8192
    s_waitcnt lgkmcnt(0)
    s_barrier
    ds_read_b128 v[16:19], v14
    ds_read_b128 v[20:23], v14 offset:16
    v_cmp_eq_u32 vcc, 0, v5
    s_waitcnt lgkmcnt(0)
    v_max_f32 v19, v19, v17
    v_med3_f32 v17, v16, v18, v19
    v_max_f32 v16, v16, v18
    v_max_f32 v23, v23, v21
    v_med3_f32 v21, v20, v22, v23
    v_max_f32 v20, v20, v22
    v_max_f32 v21, v21, v17
    v_med3_f32 v17, v16, v20, v21
    v_max_f32 v16, v16, v20
    v_and_b32 v16, 0x7ff, v16
    v_and_b32 v17, 0x7ff, v17
    v_cndmask_b32 v15, v17, v16, vcc
    v_lshl_add_u32 v12, v15, 11, v7
    buffer_load_dwordx4 v[40:43], v12, s[24:27], 0 offen offset:0 sc1
    buffer_load_dwordx4 v[44:47], v12, s[24:27], 0 offen offset:512 sc1
    buffer_load_dwordx4 v[48:51], v12, s[24:27], 0 offen offset:1024 sc1
    buffer_load_dwordx4 v[52:55], v12, s[24:27], 0 offen offset:1536 sc1
    v_cmp_eq_u32 vcc, v16, v11
    v_cmp_eq_u32 s[52:53], v17, v11
    v_mov_b32 v13, 0x7fffffff
    s_or_b64 vcc, vcc, s[52:53]
    v_cndmask_b32 v0, v0, v13, vcc
    v_lshl_add_u32 v12, v5, 11, v7
    v_add_u32 v12, 4096, v12
    s_mov_b32 s58, 0
    s_waitcnt vmcnt(0)
ff_ln_145:
    v_lshlrev_b32 v216, 16, v40
    v_and_b32 v217, 0xffff0000, v40
    v_lshlrev_b32 v218, 16, v41
    v_and_b32 v219, 0xffff0000, v41
    v_lshlrev_b32 v220, 16, v42
    v_and_b32 v221, 0xffff0000, v42
    v_lshlrev_b32 v222, 16, v43
    v_and_b32 v223, 0xffff0000, v43
    v_lshlrev_b32 v224, 16, v44
    v_and_b32 v225, 0xffff0000, v44
    v_lshlrev_b32 v226, 16, v45
    v_and_b32 v227, 0xffff0000, v45
    v_lshlrev_b32 v228, 16, v46
    v_and_b32 v229, 0xffff0000, v46
    v_lshlrev_b32 v230, 16, v47
    v_and_b32 v231, 0xffff0000, v47
    v_lshlrev_b32 v232, 16, v48
    v_and_b32 v233, 0xffff0000, v48
    v_lshlrev_b32 v234, 16, v49
    v_and_b32 v235, 0xffff0000, v49
    v_lshlrev_b32 v236, 16, v50
    v_and_b32 v237, 0xffff0000, v50
    v_lshlrev_b32 v238, 16, v51
    v_and_b32 v239, 0xffff0000, v51
    v_lshlrev_b32 v240, 16, v52
    v_and_b32 v241, 0xffff0000, v52
    v_lshlrev_b32 v242, 16, v53
    v_and_b32 v243, 0xffff0000, v53
    v_lshlrev_b32 v244, 16, v54
    v_and_b32 v245, 0xffff0000, v54
    v_lshlrev_b32 v246, 16, v55
    v_and_b32 v247, 0xffff0000, v55
    v_pk_add_f32 v[208:209], v[216:217], v[218:219]
    v_pk_add_f32 v[210:211], v[220:221], v[222:223]
    v_pk_add_f32 v[208:209], v[208:209], v[224:225]
    v_pk_add_f32 v[210:211], v[210:211], v[226:227]
    v_pk_add_f32 v[208:209], v[208:209], v[228:229]
    v_pk_add_f32 v[210:211], v[210:211], v[230:231]
    v_pk_add_f32 v[208:209], v[208:209], v[232:233]
    v_pk_add_f32 v[210:211], v[210:211], v[234:235]
    v_pk_add_f32 v[208:209], v[208:209], v[236:237]
    v_pk_add_f32 v[210:211], v[210:211], v[238:239]
    v_pk_add_f32 v[208:209], v[208:209], v[240:241]
    v_pk_add_f32 v[210:211], v[210:211], v[242:243]
    v_pk_add_f32 v[208:209], v[208:209], v[244:245]
    v_pk_add_f32 v[210:211], v[210:211], v[246:247]
    v_pk_add_f32 v[208:209], v[208:209], v[210:211]
    v_add_f32 v208, v208, v209
    s_nop 1
    v_add_f32_dpp v208, v208, v208 quad_perm:[1,0,3,2] row_mask:0xf bank_mask:0xf
    s_nop 1
    v_add_f32_dpp v208, v208, v208 quad_perm:[2,3,0,1] row_mask:0xf bank_mask:0xf
    s_nop 1
    v_add_f32_dpp v208, v208, v208 row_half_mirror row_mask:0xf bank_mask:0xf
    s_nop 1
    v_add_f32_dpp v208, v208, v208 row_mirror row_mask:0xf bank_mask:0xf
    v_mov_b32 v210, v208
    s_nop 1
    v_permlane16_swap_b32 v208, v210
    s_nop 1
    v_add_f32 v208, v208, v210
    v_mul_f32 v208, 0xba800000, v208
    v_mov_b32 v209, v208
    v_pk_add_f32 v[210:211], v[216:217], v[208:209]
    v_pk_add_f32 v[214:215], v[218:219], v[208:209]
    v_pk_mul_f32 v[212:213], v[210:211], v[210:211]
    v_pk_fma_f32 v[212:213], v[214:215], v[214:215], v[212:213]
    v_pk_add_f32 v[210:211], v[220:221], v[208:209]
    v_pk_add_f32 v[214:215], v[222:223], v[208:209]
    v_pk_fma_f32 v[212:213], v[210:211], v[210:211], v[212:213]
    v_pk_fma_f32 v[212:213], v[214:215], v[214:215], v[212:213]
    v_pk_add_f32 v[210:211], v[224:225], v[208:209]
    v_pk_add_f32 v[214:215], v[226:227], v[208:209]
    v_pk_fma_f32 v[212:213], v[210:211], v[210:211], v[212:213]
    v_pk_fma_f32 v[212:213], v[214:215], v[214:215], v[212:213]
    v_pk_add_f32 v[210:211], v[228:229], v[208:209]
    v_pk_add_f32 v[214:215], v[230:231], v[208:209]
    v_pk_fma_f32 v[212:213], v[210:211], v[210:211], v[212:213]
    v_pk_fma_f32 v[212:213], v[214:215], v[214:215], v[212:213]
    v_pk_add_f32 v[210:211], v[232:233], v[208:209]
    v_pk_add_f32 v[214:215], v[234:235], v[208:209]
    v_pk_fma_f32 v[212:213], v[210:211], v[210:211], v[212:213]
    v_pk_fma_f32 v[212:213], v[214:215], v[214:215], v[212:213]
    v_pk_add_f32 v[210:211], v[236:237], v[208:209]
    v_pk_add_f32 v[214:215], v[238:239], v[208:209]
    v_pk_fma_f32 v[212:213], v[210:211], v[210:211], v[212:213]
    v_pk_fma_f32 v[212:213], v[214:215], v[214:215], v[212:213]
    v_pk_add_f32 v[210:211], v[240:241], v[208:209]
    v_pk_add_f32 v[214:215], v[242:243], v[208:209]
    v_pk_fma_f32 v[212:213], v[210:211], v[210:211], v[212:213]
    v_pk_fma_f32 v[212:213], v[214:215], v[214:215], v[212:213]
    v_pk_add_f32 v[210:211], v[244:245], v[208:209]
    v_pk_add_f32 v[214:215], v[246:247], v[208:209]
    v_pk_fma_f32 v[212:213], v[210:211], v[210:211], v[212:213]
    v_pk_fma_f32 v[212:213], v[214:215], v[214:215], v[212:213]
    v_add_f32 v212, v212, v213
    s_nop 1
    v_add_f32_dpp v212, v212, v212 quad_perm:[1,0,3,2] row_mask:0xf bank_mask:0xf
    s_nop 1
    v_add_f32_dpp v212, v212, v212 quad_perm:[2,3,0,1] row_mask:0xf bank_mask:0xf
    s_nop 1
    v_add_f32_dpp v212, v212, v212 row_half_mirror row_mask:0xf bank_mask:0xf
    s_nop 1
    v_add_f32_dpp v212, v212, v212 row_mirror row_mask:0xf bank_mask:0xf
    v_mov_b32 v210, v212
    s_nop 1
    v_permlane16_swap_b32 v212, v210
    s_nop 1
    v_add_f32 v212, v212, v210
    v_mul_f32 v212, 0x3a800000, v212
    v_cvt_pk_bf16_f32 v214, v208, v212
    v_and_b32 v212, 0xffff0000, v214
    v_lshlrev_b32 v214, 16, v214
    v_add_f32 v212, 0x3727c5ac, v212
    v_mov_b32 v215, v214
    v_cvt_pk_bf16_f32 v212, v212, v212
    v_and_b32 v212, 0xffff0000, v212
    v_sqrt_f32 v212, v212
    v_pk_add_f32 v[176:177], v[216:217], v[214:215]
    v_pk_add_f32 v[178:179], v[218:219], v[214:215]
    v_pk_add_f32 v[180:181], v[220:221], v[214:215]
    v_pk_add_f32 v[182:183], v[222:223], v[214:215]
    v_pk_add_f32 v[184:185], v[224:225], v[214:215]
    v_pk_add_f32 v[186:187], v[226:227], v[214:215]
    v_pk_add_f32 v[188:189], v[228:229], v[214:215]
    v_pk_add_f32 v[190:191], v[230:231], v[214:215]
    v_pk_add_f32 v[192:193], v[232:233], v[214:215]
    v_pk_add_f32 v[194:195], v[234:235], v[214:215]
    v_pk_add_f32 v[196:197], v[236:237], v[214:215]
    v_pk_add_f32 v[198:199], v[238:239], v[214:215]
    v_pk_add_f32 v[200:201], v[240:241], v[214:215]
    v_pk_add_f32 v[202:203], v[242:243], v[214:215]
    v_pk_add_f32 v[204:205], v[244:245], v[214:215]
    v_pk_add_f32 v[206:207], v[246:247], v[214:215]
    v_cvt_pk_bf16_f32 v212, v212, v212
    v_and_b32 v212, 0xffff0000, v212
    v_rcp_f32 v212, v212
    v_cvt_pk_bf16_f32 v40, v176, v177
    v_cvt_pk_bf16_f32 v41, v178, v179
    v_cvt_pk_bf16_f32 v42, v180, v181
    v_cvt_pk_bf16_f32 v43, v182, v183
    v_cvt_pk_bf16_f32 v44, v184, v185
    v_cvt_pk_bf16_f32 v45, v186, v187
    v_cvt_pk_bf16_f32 v46, v188, v189
    v_cvt_pk_bf16_f32 v47, v190, v191
    v_cvt_pk_bf16_f32 v48, v192, v193
    v_cvt_pk_bf16_f32 v49, v194, v195
    v_cvt_pk_bf16_f32 v50, v196, v197
    v_cvt_pk_bf16_f32 v51, v198, v199
    v_cvt_pk_bf16_f32 v52, v200, v201
    v_cvt_pk_bf16_f32 v53, v202, v203
    v_cvt_pk_bf16_f32 v54, v204, v205
    v_cvt_pk_bf16_f32 v55, v206, v207
    v_mov_b32 v213, v212
    v_lshlrev_b32 v176, 16, v40
    v_and_b32 v177, 0xffff0000, v40
    v_lshlrev_b32 v178, 16, v41
    v_and_b32 v179, 0xffff0000, v41
    v_lshlrev_b32 v180, 16, v42
    v_and_b32 v181, 0xffff0000, v42
    v_lshlrev_b32 v182, 16, v43
    v_and_b32 v183, 0xffff0000, v43
    v_lshlrev_b32 v184, 16, v44
    v_and_b32 v185, 0xffff0000, v44
    v_lshlrev_b32 v186, 16, v45
    v_and_b32 v187, 0xffff0000, v45
    v_lshlrev_b32 v188, 16, v46
    v_and_b32 v189, 0xffff0000, v46
    v_lshlrev_b32 v190, 16, v47
    v_and_b32 v191, 0xffff0000, v47
    v_lshlrev_b32 v192, 16, v48
    v_and_b32 v193, 0xffff0000, v48
    v_lshlrev_b32 v194, 16, v49
    v_and_b32 v195, 0xffff0000, v49
    v_lshlrev_b32 v196, 16, v50
    v_and_b32 v197, 0xffff0000, v50
    v_lshlrev_b32 v198, 16, v51
    v_and_b32 v199, 0xffff0000, v51
    v_lshlrev_b32 v200, 16, v52
    v_and_b32 v201, 0xffff0000, v52
    v_lshlrev_b32 v202, 16, v53
    v_and_b32 v203, 0xffff0000, v53
    v_lshlrev_b32 v204, 16, v54
    v_and_b32 v205, 0xffff0000, v54
    v_lshlrev_b32 v206, 16, v55
    v_and_b32 v207, 0xffff0000, v55
    v_pk_mul_f32 v[176:177], v[176:177], v[212:213]
    v_pk_mul_f32 v[178:179], v[178:179], v[212:213]
    v_pk_mul_f32 v[180:181], v[180:181], v[212:213]
    v_pk_mul_f32 v[182:183], v[182:183], v[212:213]
    v_pk_mul_f32 v[184:185], v[184:185], v[212:213]
    v_pk_mul_f32 v[186:187], v[186:187], v[212:213]
    v_pk_mul_f32 v[188:189], v[188:189], v[212:213]
    v_pk_mul_f32 v[190:191], v[190:191], v[212:213]
    v_pk_mul_f32 v[192:193], v[192:193], v[212:213]
    v_pk_mul_f32 v[194:195], v[194:195], v[212:213]
    v_pk_mul_f32 v[196:197], v[196:197], v[212:213]
    v_pk_mul_f32 v[198:199], v[198:199], v[212:213]
    v_pk_mul_f32 v[200:201], v[200:201], v[212:213]
    v_pk_mul_f32 v[202:203], v[202:203], v[212:213]
    v_pk_mul_f32 v[204:205], v[204:205], v[212:213]
    v_pk_mul_f32 v[206:207], v[206:207], v[212:213]
    v_cvt_pk_bf16_f32 v40, v176, v177
    v_cvt_pk_bf16_f32 v41, v178, v179
    v_cvt_pk_bf16_f32 v42, v180, v181
    v_cvt_pk_bf16_f32 v43, v182, v183
    v_cvt_pk_bf16_f32 v44, v184, v185
    v_cvt_pk_bf16_f32 v45, v186, v187
    v_cvt_pk_bf16_f32 v46, v188, v189
    v_cvt_pk_bf16_f32 v47, v190, v191
    v_cvt_pk_bf16_f32 v48, v192, v193
    v_cvt_pk_bf16_f32 v49, v194, v195
    v_cvt_pk_bf16_f32 v50, v196, v197
    v_cvt_pk_bf16_f32 v51, v198, v199
    v_cvt_pk_bf16_f32 v52, v200, v201
    v_cvt_pk_bf16_f32 v53, v202, v203
    v_cvt_pk_bf16_f32 v54, v204, v205
    v_cvt_pk_bf16_f32 v55, v206, v207
    s_cmp_lg_u32 s58, 0
    s_cbranch_scc1 ff_own_146
    ds_write_b128 v12, v[40:43] offset:0
    ds_write_b128 v12, v[44:47] offset:512
    ds_write_b128 v12, v[48:51] offset:1024
    ds_write_b128 v12, v[52:55] offset:1536
    s_cmp_ge_u32 s2, 224
    s_cbranch_scc1 ff_red_147
    v_lshrrev_b32 v12, 4, v3
    v_and_b32 v13, 1, v3
    v_lshlrev_b32 v13, 11, v13
    v_lshl_add_u32 v13, v12, 3, v13
    s_lshl_b32 s54, s30, 9
    s_add_u32 s54, s54, 4096
    v_add_u32 v13, s54, v13
    v_lshlrev_b32 v14, 3, v3
    s_lshl_b32 s54, s30, 13
    s_add_u32 s54, s54, 65536
    v_add_u32 v14, s54, v14
    ds_read_b64_tr_b16 a[0:1], v14 offset:0
    ds_read_b64_tr_b16 a[2:3], v14 offset:512
    ds_read_b64_tr_b16 a[4:5], v14 offset:1024
    ds_read_b64_tr_b16 a[6:7], v14 offset:1536
    ds_read_b64_tr_b16 a[8:9], v14 offset:2048
    ds_read_b64_tr_b16 a[10:11], v14 offset:2560
    ds_read_b64_tr_b16 a[12:13], v14 offset:3072
    ds_read_b64_tr_b16 a[14:15], v14 offset:3584
    ds_read_b64_tr_b16 a[16:17], v14 offset:4096
    ds_read_b64_tr_b16 a[18:19], v14 offset:4608
    ds_read_b64_tr_b16 a[20:21], v14 offset:5120
    ds_read_b64_tr_b16 a[22:23], v14 offset:5632
    ds_read_b64_tr_b16 a[24:25], v14 offset:6144
    ds_read_b64_tr_b16 a[26:27], v14 offset:6656
    ds_read_b64_tr_b16 a[28:29], v14 offset:7168
    ds_read_b64_tr_b16 a[30:31], v14 offset:7680
    ds_read_b64_tr_b16 a[32:33], v14 offset:32768
    ds_read_b64_tr_b16 a[34:35], v14 offset:33280
    ds_read_b64_tr_b16 a[36:37], v14 offset:33792
    ds_read_b64_tr_b16 a[38:39], v14 offset:34304
    ds_read_b64_tr_b16 a[40:41], v14 offset:34816
    ds_read_b64_tr_b16 a[42:43], v14 offset:35328
    ds_read_b64_tr_b16 a[44:45], v14 offset:35840
    ds_read_b64_tr_b16 a[46:47], v14 offset:36352
    ds_read_b64_tr_b16 a[48:49], v14 offset:36864
    ds_read_b64_tr_b16 a[50:51], v14 offset:37376
    ds_read_b64_tr_b16 a[52:53], v14 offset:37888
    ds_read_b64_tr_b16 a[54:55], v14 offset:38400
    ds_read_b64_tr_b16 a[56:57], v14 offset:38912
    ds_read_b64_tr_b16 a[58:59], v14 offset:39424
    ds_read_b64_tr_b16 a[60:61], v14 offset:39936
    ds_read_b64_tr_b16 a[62:63], v14 offset:40448
    ds_read_b64 a[64:65], v13 offset:0
    ds_read_b64 a[66:67], v13 offset:32
    ds_read_b64 a[68:69], v13 offset:64
    ds_read_b64 a[70:71], v13 offset:96
    ds_read_b64 a[72:73], v13 offset:128
    ds_read_b64 a[74:75], v13 offset:160
    ds_read_b64 a[76:77], v13 offset:192
    ds_read_b64 a[78:79], v13 offset:224
    ds_read_b64 a[80:81], v13 offset:256
    ds_read_b64 a[82:83], v13 offset:288
    ds_read_b64 a[84:85], v13 offset:320
    ds_read_b64 a[86:87], v13 offset:352
    ds_read_b64 a[88:89], v13 offset:384
    ds_read_b64 a[90:91], v13 offset:416
    ds_read_b64 a[92:93], v13 offset:448
    ds_read_b64 a[94:95], v13 offset:480
    v_lshlrev_b32 v13, 6, v8
    v_lshl_add_u32 v13, v12, 4, v13
    s_lshl_b32 s54, s30, 11
    s_add_u32 s54, s54, 8448
    v_add_u32 v13, s54, v13
    s_waitcnt lgkmcnt(0)
    v_mfma_f32_16x16x32_bf16 v[16:19], a[0:3], a[64:67], 0
    v_mfma_f32_16x16x32_bf16 v[20:23], a[32:35], a[64:67], 0
    v_mfma_f32_16x16x32_bf16 v[16:19], a[4:7], a[68:71], v[16:19]
    v_mfma_f32_16x16x32_bf16 v[20:23], a[36:39], a[68:71], v[20:23]
    v_mfma_f32_16x16x32_bf16 v[16:19], a[8:11], a[72:75], v[16:19]
    v_mfma_f32_16x16x32_bf16 v[20:23], a[40:43], a[72:75], v[20:23]
    v_mfma_f32_16x16x32_bf16 v[16:19], a[12:15], a[76:79], v[16:19]
    v_mfma_f32_16x16x32_bf16 v[20:23], a[44:47], a[76:79], v[20:23]
    v_mfma_f32_16x16x32_bf16 v[16:19], a[16:19], a[80:83], v[16:19]
    v_mfma_f32_16x16x32_bf16 v[20:23], a[48:51], a[80:83], v[20:23]
    v_mfma_f32_16x16x32_bf16 v[16:19], a[20:23], a[84:87], v[16:19]
    v_mfma_f32_16x16x32_bf16 v[20:23], a[52:55], a[84:87], v[20:23]
    v_mfma_f32_16x16x32_bf16 v[16:19], a[24:27], a[88:91], v[16:19]
    v_mfma_f32_16x16x32_bf16 v[20:23], a[56:59], a[88:91], v[20:23]
    v_mfma_f32_16x16x32_bf16 v[16:19], a[28:31], a[92:95], v[16:19]
    v_mfma_f32_16x16x32_bf16 v[20:23], a[60:63], a[92:95], v[20:23]
    s_nop 7
    ds_write_b128 v13, v[16:19]
    ds_write_b128 v13, v[20:23] offset:1024
    v_lshlrev_b32 v13, 2, v4
    v_add_u32 v13, 8448, v13
    s_waitcnt lgkmcnt(0)
    s_barrier
    ds_read2st64_b32 v[16:17], v13 offset0:0 offset1:4
    ds_read2st64_b32 v[18:19], v13 offset0:8 offset1:12
    ds_read2st64_b32 v[20:21], v13 offset0:16 offset1:20
    ds_read2st64_b32 v[22:23], v13 offset0:24 offset1:28
    s_waitcnt lgkmcnt(0)
    v_pk_add_f32 v[16:17], v[16:17], v[20:21]
    v_pk_add_f32 v[18:19], v[18:19], v[22:23]
    v_pk_add_f32 v[16:17], v[16:17], v[18:19]
    v_cvt_pk_bf16_f32 v16, v16, v17
    v_and_b32 v20, 0xffff0000, v16
    v_lshlrev_b32 v16, 16, v16
    v_mul_f32 v17, 0xbfb8aa3b, v16
    v_exp_f32 v17, v17
    s_lshl_b32 s54, s55, 13
    v_add_f32 v17, 1.0, v17
    v_rcp_f32 v17, v17
    s_add_u32 s53, s54, 4096
    v_mul_f32 v16, v16, v17
    v_cvt_pk_bf16_f32 v16, v16, v16
    v_and_b32 v16, 0xffff0000, v16
    v_mul_f32 v16, v16, v20
    s_nop 1
    v_mov_b32_dpp v17, v16 quad_perm:[1,0,3,2] row_mask:0xf bank_mask:0xf
    v_cvt_pk_bf16_f32 v16, v16, v17
    v_lshlrev_b32 v13, 4, v2
    v_readlane_b32 s8, v16, 0
    v_readlane_b32 s9, v16, 2
    v_readlane_b32 s10, v16, 4
    v_readlane_b32 s11, v16, 6
    v_readlane_b32 s12, v16, 8
    v_readlane_b32 s13, v16, 10
    v_readlane_b32 s14, v16, 12
    v_readlane_b32 s15, v16, 14
    v_readlane_b32 s16, v16, 16
    v_readlane_b32 s17, v16, 18
    v_readlane_b32 s18, v16, 20
    v_readlane_b32 s19, v16, 22
    v_readlane_b32 s20, v16, 24
    v_readlane_b32 s21, v16, 26
    v_readlane_b32 s22, v16, 28
    v_readlane_b32 s23, v16, 30
    v_dot2_f32_bf16 v24, v144, s8, 0
    v_dot2_f32_bf16 v25, v145, s8, 0
    v_dot2_f32_bf16 v26, v146, s8, 0
    v_dot2_f32_bf16 v27, v147, s8, 0
    v_dot2_f32_bf16 v24, v148, s9, v24
    v_dot2_f32_bf16 v25, v149, s9, v25
    v_dot2_f32_bf16 v26, v150, s9, v26
    v_dot2_f32_bf16 v27, v151, s9, v27
    v_dot2_f32_bf16 v24, v152, s10, v24
    v_dot2_f32_bf16 v25, v153, s10, v25
    v_dot2_f32_bf16 v26, v154, s10, v26
    v_dot2_f32_bf16 v27, v155, s10, v27
    v_dot2_f32_bf16 v24, v156, s11, v24
    v_dot2_f32_bf16 v25, v157, s11, v25
    v_dot2_f32_bf16 v26, v158, s11, v26
    v_dot2_f32_bf16 v27, v159, s11, v27
    v_dot2_f32_bf16 v24, v160, s12, v24
    v_dot2_f32_bf16 v25, v161, s12, v25
    v_dot2_f32_bf16 v26, v162, s12, v26
    v_dot2_f32_bf16 v27, v163, s12, v27
    v_dot2_f32_bf16 v24, v164, s13, v24
    v_dot2_f32_bf16 v25, v165, s13, v25
    v_dot2_f32_bf16 v26, v166, s13, v26
    v_dot2_f32_bf16 v27, v167, s13, v27
    v_dot2_f32_bf16 v24, v168, s14, v24
    v_dot2_f32_bf16 v25, v169, s14, v25
    v_dot2_f32_bf16 v26, v170, s14, v26
    v_dot2_f32_bf16 v27, v171, s14, v27
    v_dot2_f32_bf16 v24, v172, s15, v24
    v_dot2_f32_bf16 v25, v173, s15, v25
    v_dot2_f32_bf16 v26, v174, s15, v26
    v_dot2_f32_bf16 v27, v175, s15, v27
    v_dot2_f32_bf16 v28, v144, s16, 0
    v_dot2_f32_bf16 v29, v145, s16, 0
    v_dot2_f32_bf16 v30, v146, s16, 0
    v_dot2_f32_bf16 v31, v147, s16, 0
    v_dot2_f32_bf16 v28, v148, s17, v28
    v_dot2_f32_bf16 v29, v149, s17, v29
    v_dot2_f32_bf16 v30, v150, s17, v30
    v_dot2_f32_bf16 v31, v151, s17, v31
    v_dot2_f32_bf16 v28, v152, s18, v28
    v_dot2_f32_bf16 v29, v153, s18, v29
    v_dot2_f32_bf16 v30, v154, s18, v30
    v_dot2_f32_bf16 v31, v155, s18, v31
    v_dot2_f32_bf16 v28, v156, s19, v28
    v_dot2_f32_bf16 v29, v157, s19, v29
    v_dot2_f32_bf16 v30, v158, s19, v30
    v_dot2_f32_bf16 v31, v159, s19, v31
    v_dot2_f32_bf16 v28, v160, s20, v28
    v_dot2_f32_bf16 v29, v161, s20, v29
    v_dot2_f32_bf16 v30, v162, s20, v30
    v_dot2_f32_bf16 v31, v163, s20, v31
    v_dot2_f32_bf16 v28, v164, s21, v28
    v_dot2_f32_bf16 v29, v165, s21, v29
    v_dot2_f32_bf16 v30, v166, s21, v30
    v_dot2_f32_bf16 v31, v167, s21, v31
    v_dot2_f32_bf16 v28, v168, s22, v28
    v_dot2_f32_bf16 v29, v169, s22, v29
    v_dot2_f32_bf16 v30, v170, s22, v30
    v_dot2_f32_bf16 v31, v171, s22, v31
    v_dot2_f32_bf16 v28, v172, s23, v28
    v_dot2_f32_bf16 v29, v173, s23, v29
    v_dot2_f32_bf16 v30, v174, s23, v30
    v_dot2_f32_bf16 v31, v175, s23, v31
    s_and_b32 s52, s55, 15
    s_lshl_b32 s31, s30, 7
    s_add_u32 s52, s52, s31
    s_lshl_b32 s52, s52, 7
    v_lshlrev_b32 v12, 11, v3
    buffer_store_dwordx4 v[24:27], v13, s[48:51], s54 offen sc1
    buffer_store_dwordx4 v[28:31], v13, s[48:51], s53 offen sc1
    v_mov_b32 v40, v128
    v_mov_b32 v41, v129
    v_mov_b32 v42, v130
    v_mov_b32 v43, v131
    v_mov_b32 v44, v132
    v_mov_b32 v45, v133
    v_mov_b32 v46, v134
    v_mov_b32 v47, v135
    v_mov_b32 v48, v136
    v_mov_b32 v49, v137
    v_mov_b32 v50, v138
    v_mov_b32 v51, v139
    v_mov_b32 v52, v140
    v_mov_b32 v53, v141
    v_mov_b32 v54, v142
    v_mov_b32 v55, v143
    s_mov_b32 s58, 1
    s_waitcnt vmcnt(0)
    s_mov_b64 exec, 0xff
    buffer_atomic_add v76, v12, s[60:63], s52 offen sc1
    s_mov_b64 exec, -1
    s_branch ff_ln_145
ff_own_146:
    v_lshlrev_b32 v176, 16, v40
    v_and_b32 v177, 0xffff0000, v40
    v_lshlrev_b32 v178, 16, v41
    v_and_b32 v179, 0xffff0000, v41
    v_lshlrev_b32 v180, 16, v42
    v_and_b32 v181, 0xffff0000, v42
    v_lshlrev_b32 v182, 16, v43
    v_and_b32 v183, 0xffff0000, v43
    v_lshlrev_b32 v184, 16, v44
    v_and_b32 v185, 0xffff0000, v44
    v_lshlrev_b32 v186, 16, v45
    v_and_b32 v187, 0xffff0000, v45
    v_lshlrev_b32 v188, 16, v46
    v_and_b32 v189, 0xffff0000, v46
    v_lshlrev_b32 v190, 16, v47
    v_and_b32 v191, 0xffff0000, v47
    v_lshlrev_b32 v192, 16, v48
    v_and_b32 v193, 0xffff0000, v48
    v_lshlrev_b32 v194, 16, v49
    v_and_b32 v195, 0xffff0000, v49
    v_lshlrev_b32 v196, 16, v50
    v_and_b32 v197, 0xffff0000, v50
    v_lshlrev_b32 v198, 16, v51
    v_and_b32 v199, 0xffff0000, v51
    v_lshlrev_b32 v200, 16, v52
    v_and_b32 v201, 0xffff0000, v52
    v_lshlrev_b32 v202, 16, v53
    v_and_b32 v203, 0xffff0000, v53
    v_lshlrev_b32 v204, 16, v54
    v_and_b32 v205, 0xffff0000, v54
    v_lshlrev_b32 v206, 16, v55
    v_and_b32 v207, 0xffff0000, v55
    v_pk_add_f32 v[176:177], v[176:177], v[216:217]
    v_pk_add_f32 v[178:179], v[178:179], v[218:219]
    v_pk_add_f32 v[180:181], v[180:181], v[220:221]
    v_pk_add_f32 v[182:183], v[182:183], v[222:223]
    v_pk_add_f32 v[184:185], v[184:185], v[224:225]
    v_pk_add_f32 v[186:187], v[186:187], v[226:227]
    v_pk_add_f32 v[188:189], v[188:189], v[228:229]
    v_pk_add_f32 v[190:191], v[190:191], v[230:231]
    v_pk_add_f32 v[192:193], v[192:193], v[232:233]
    v_pk_add_f32 v[194:195], v[194:195], v[234:235]
    v_pk_add_f32 v[196:197], v[196:197], v[236:237]
    v_pk_add_f32 v[198:199], v[198:199], v[238:239]
    v_pk_add_f32 v[200:201], v[200:201], v[240:241]
    v_pk_add_f32 v[202:203], v[202:203], v[242:243]
    v_pk_add_f32 v[204:205], v[204:205], v[244:245]
    v_pk_add_f32 v[206:207], v[206:207], v[246:247]
    v_cvt_pk_bf16_f32 v40, v176, v177
    v_cvt_pk_bf16_f32 v41, v178, v179
    v_cvt_pk_bf16_f32 v42, v180, v181
    v_cvt_pk_bf16_f32 v43, v182, v183
    v_cvt_pk_bf16_f32 v44, v184, v185
    v_cvt_pk_bf16_f32 v45, v186, v187
    v_cvt_pk_bf16_f32 v46, v188, v189
    v_cvt_pk_bf16_f32 v47, v190, v191
    v_cvt_pk_bf16_f32 v48, v192, v193
    v_cvt_pk_bf16_f32 v49, v194, v195
    v_cvt_pk_bf16_f32 v50, v196, v197
    v_cvt_pk_bf16_f32 v51, v198, v199
    v_cvt_pk_bf16_f32 v52, v200, v201
    v_cvt_pk_bf16_f32 v53, v202, v203
    v_cvt_pk_bf16_f32 v54, v204, v205
    v_cvt_pk_bf16_f32 v55, v206, v207
    buffer_store_dwordx4 v[40:43], v0, s[36:39], 0 offen offset:0 sc1
    buffer_store_dwordx4 v[44:47], v0, s[36:39], 0 offen offset:512 sc1
    buffer_store_dwordx4 v[48:51], v0, s[36:39], 0 offen offset:1024 sc1
    buffer_store_dwordx4 v[52:55], v0, s[36:39], 0 offen offset:1536 sc1
    s_cmp_ge_u32 s2, 224
    s_cbranch_scc1 ff_red2_148
    s_branch ff_fin_149
ff_red_147:
    s_sub_u32 s40, s2, 224
    s_lshr_b32 s41, s40, 4
    s_and_b32 s42, s40, 15
    s_mov_b32 s8, s56
    s_and_b32 s9, s57, 0xffff
    s_mov_b32 s10, 0x800
    s_mov_b32 s11, 0x00020000
    buffer_load_dwordx4 v[96:99], v7, s[8:11], 0 offen offset:0
    buffer_load_dwordx4 v[100:103], v7, s[8:11], 0 offen offset:512
    buffer_load_dwordx4 v[104:107], v7, s[8:11], 0 offen offset:1024
    buffer_load_dwordx4 v[108:111], v7, s[8:11], 0 offen offset:1536
    s_lshl_b32 s43, s41, 5
    v_readlane_b32 s46, v15, s43
    s_lshl_b32 s47, s42, 7
    v_lshl_add_u32 v9, v8, 3, s47
    s_lshl_b32 s46, s46, 11
    s_lshl_b32 s31, s41, 11
    s_add_u32 s31, s31, 4096
    v_add_u32 v12, s31, v9
    s_waitcnt lgkmcnt(0)
    ds_read_b64 v[32:33], v12
    buffer_load_dwordx2 v[34:35], v9, s[24:27], s46 offen sc1
    v_lshrrev_b32 v10, 4, v2
    v_lshlrev_b32 v10, 13, v10
    v_lshl_add_u32 v10, v8, 4, v10
    s_lshl_b32 s47, s40, 8
    s_waitcnt vmcnt(1)
    v_dot2_f32_bf16 v12, v40, v96, 0
    v_dot2_f32_bf16 v12, v41, v97, v12
    v_dot2_f32_bf16 v12, v42, v98, v12
    v_dot2_f32_bf16 v12, v43, v99, v12
    v_dot2_f32_bf16 v12, v44, v100, v12
    v_dot2_f32_bf16 v12, v45, v101, v12
    v_dot2_f32_bf16 v12, v46, v102, v12
    v_dot2_f32_bf16 v12, v47, v103, v12
    v_dot2_f32_bf16 v12, v48, v104, v12
    v_dot2_f32_bf16 v12, v49, v105, v12
    v_dot2_f32_bf16 v12, v50, v106, v12
    v_dot2_f32_bf16 v12, v51, v107, v12
    v_dot2_f32_bf16 v12, v52, v108, v12
    v_dot2_f32_bf16 v12, v53, v109, v12
    v_dot2_f32_bf16 v12, v54, v110, v12
    v_dot2_f32_bf16 v12, v55, v111, v12
    s_nop 2
    s_nop 1
    v_add_f32_dpp v12, v12, v12 quad_perm:[1,0,3,2] row_mask:0xf bank_mask:0xf
    s_nop 1
    v_add_f32_dpp v12, v12, v12 quad_perm:[2,3,0,1] row_mask:0xf bank_mask:0xf
    s_nop 1
    v_add_f32_dpp v12, v12, v12 row_half_mirror row_mask:0xf bank_mask:0xf
    s_nop 1
    v_add_f32_dpp v12, v12, v12 row_mirror row_mask:0xf bank_mask:0xf
    v_mov_b32 v13, v12
    s_nop 1
    v_permlane16_swap_b32 v12, v13
    s_nop 1
    v_add_f32 v12, v12, v13
    v_cvt_pk_bf16_f32 v12, v12, v12
    v_and_b32 v12, 0xffff0000, v12
    v_mul_f32 v12, 0xbfb8aa3b, v12
    v_exp_f32 v12, v12
    s_lshl_b32 s44, s42, 1
    v_add_f32 v12, 1.0, v12
    v_rcp_f32 v12, v12
    s_add_u32 s44, s44, s41
    s_lshl_b32 s44, s44, 11
    v_cvt_pk_bf16_f32 v12, v12, v12
    v_and_b32 v12, 0xffff0000, v12
    v_mov_b32 v40, v128
    v_mov_b32 v41, v129
    v_mov_b32 v42, v130
    v_mov_b32 v43, v131
    v_mov_b32 v44, v132
    v_mov_b32 v45, v133
    v_mov_b32 v46, v134
    v_mov_b32 v47, v135
    v_mov_b32 v48, v136
    v_mov_b32 v49, v137
    v_mov_b32 v50, v138
    v_mov_b32 v51, v139
    v_mov_b32 v52, v140
    v_mov_b32 v53, v141
    v_mov_b32 v54, v142
    v_mov_b32 v55, v143
    v_readlane_b32 s45, v12, s43
    s_mov_b32 s58, 1
    s_branch ff_ln_145
ff_red2_148:
    s_cmp_lg_u32 s30, 0
    s_cbranch_scc1 ff_rgo_150
    s_mov_b32 s52, 1048576
ff_rpoll_151:
    buffer_load_dword v13, v6, s[60:63], s44 offen sc1
    s_sub_u32 s52, s52, 1
    s_cbranch_scc1 ff_rgo_150
    s_waitcnt vmcnt(0)
    v_cmp_gt_u32 vcc, 14, v13
    s_cbranch_vccz ff_rgo_150
    s_sleep 2
    s_branch ff_rpoll_151
ff_rgo_150:
    s_barrier
    buffer_load_dwordx4 v[96:99], v10, s[48:51], s47 offen sc1
    s_add_u32 s47, s47, 0x20000
    buffer_load_dwordx4 v[100:103], v10, s[48:51], s47 offen sc1
    s_add_u32 s47, s47, 0x20000
    buffer_load_dwordx4 v[104:107], v10, s[48:51], s47 offen sc1
    s_add_u32 s47, s47, 0x20000
    buffer_load_dwordx4 v[108:111], v10, s[48:51], s47 offen sc1
    s_add_u32 s47, s47, 0x20000
    buffer_load_dwordx4 v[112:115], v10, s[48:51], s47 offen sc1
    s_add_u32 s47, s47, 0x20000
    buffer_load_dwordx4 v[116:119], v10, s[48:51], s47 offen sc1
    s_add_u32 s47, s47, 0x20000
    buffer_load_dwordx4 v[120:123], v10, s[48:51], s47 offen sc1
    s_add_u32 s47, s47, 0x20000
    buffer_load_dwordx4 v[124:127], v10, s[48:51], s47 offen sc1
    s_add_u32 s47, s47, 0x20000
    buffer_load_dwordx4 v[128:131], v10, s[48:51], s47 offen sc1
    s_add_u32 s47, s47, 0x20000
    buffer_load_dwordx4 v[132:135], v10, s[48:51], s47 offen sc1
    s_add_u32 s47, s47, 0x20000
    buffer_load_dwordx4 v[136:139], v10, s[48:51], s47 offen sc1
    s_add_u32 s47, s47, 0x20000
    buffer_load_dwordx4 v[140:143], v10, s[48:51], s47 offen sc1
    s_add_u32 s47, s47, 0x20000
    buffer_load_dwordx4 v[144:147], v10, s[48:51], s47 offen sc1
    s_add_u32 s47, s47, 0x20000
    buffer_load_dwordx4 v[148:151], v10, s[48:51], s47 offen sc1
    s_add_u32 s47, s47, 0x20000
    s_waitcnt vmcnt(12)
    v_pk_add_f32 v[96:97], v[96:97], v[100:101]
    v_pk_add_f32 v[98:99], v[98:99], v[102:103]
    s_waitcnt vmcnt(11)
    v_pk_add_f32 v[96:97], v[96:97], v[104:105]
    v_pk_add_f32 v[98:99], v[98:99], v[106:107]
    s_waitcnt vmcnt(10)
    v_pk_add_f32 v[96:97], v[96:97], v[108:109]
    v_pk_add_f32 v[98:99], v[98:99], v[110:111]
    s_waitcnt vmcnt(9)
    v_pk_add_f32 v[96:97], v[96:97], v[112:113]
    v_pk_add_f32 v[98:99], v[98:99], v[114:115]
    s_waitcnt vmcnt(8)
    v_pk_add_f32 v[96:97], v[96:97], v[116:117]
    v_pk_add_f32 v[98:99], v[98:99], v[118:119]
    s_waitcnt vmcnt(7)
    v_pk_add_f32 v[96:97], v[96:97], v[120:121]
    v_pk_add_f32 v[98:99], v[98:99], v[122:123]
    s_waitcnt vmcnt(6)
    v_pk_add_f32 v[96:97], v[96:97], v[124:125]
    v_pk_add_f32 v[98:99], v[98:99], v[126:127]
    s_waitcnt vmcnt(5)
    v_pk_add_f32 v[96:97], v[96:97], v[128:129]
    v_pk_add_f32 v[98:99], v[98:99], v[130:131]
    s_waitcnt vmcnt(4)
    v_pk_add_f32 v[96:97], v[96:97], v[132:133]
    v_pk_add_f32 v[98:99], v[98:99], v[134:135]
    s_waitcnt vmcnt(3)
    v_pk_add_f32 v[96:97], v[96:97], v[136:137]
    v_pk_add_f32 v[98:99], v[98:99], v[138:139]
    s_waitcnt vmcnt(2)
    v_pk_add_f32 v[96:97], v[96:97], v[140:141]
    v_pk_add_f32 v[98:99], v[98:99], v[142:143]
    s_waitcnt vmcnt(1)
    v_pk_add_f32 v[96:97], v[96:97], v[144:145]
    v_pk_add_f32 v[98:99], v[98:99], v[146:147]
    s_waitcnt vmcnt(0)
    v_pk_add_f32 v[96:97], v[96:97], v[148:149]
    v_pk_add_f32 v[98:99], v[98:99], v[150:151]
    v_mov_b32 v100, v96
    v_mov_b32 v101, v97
    v_mov_b32 v102, v98
    v_mov_b32 v103, v99
    s_nop 1
    v_permlane16_swap_b32 v96, v100
    v_permlane16_swap_b32 v97, v101
    v_permlane16_swap_b32 v98, v102
    v_permlane16_swap_b32 v99, v103
    s_nop 1
    v_add_f32 v96, v96, v100
    v_add_f32 v97, v97, v101
    v_add_f32 v98, v98, v102
    v_add_f32 v99, v99, v103
    v_mov_b32 v100, v96
    v_mov_b32 v101, v97
    v_mov_b32 v102, v98
    v_mov_b32 v103, v99
    s_nop 1
    v_permlane32_swap_b32 v96, v100
    v_permlane32_swap_b32 v97, v101
    v_permlane32_swap_b32 v98, v102
    v_permlane32_swap_b32 v99, v103
    s_nop 1
    v_add_f32 v96, v96, v100
    v_add_f32 v97, v97, v101
    v_add_f32 v98, v98, v102
    v_add_f32 v99, v99, v103
    v_lshlrev_b32 v14, 4, v8
    s_lshl_b32 s31, s30, 8
    v_add_u32 v13, s31, v14
    ds_write_b128 v13, v[96:99]
    s_waitcnt lgkmcnt(0)
    s_barrier
    ds_read_b128 v[96:99], v14 offset:0
    ds_read_b128 v[100:103], v14 offset:256
    ds_read_b128 v[104:107], v14 offset:512
    ds_read_b128 v[108:111], v14 offset:768
    s_waitcnt lgkmcnt(0)
    v_pk_add_f32 v[96:97], v[96:97], v[100:101]
    v_pk_add_f32 v[98:99], v[98:99], v[102:103]
    v_pk_add_f32 v[96:97], v[96:97], v[104:105]
    v_pk_add_f32 v[98:99], v[98:99], v[106:107]
    v_pk_add_f32 v[96:97], v[96:97], v[108:109]
    v_pk_add_f32 v[98:99], v[98:99], v[110:111]
    v_cvt_pk_bf16_f32 v20, v96, v97
    v_lshlrev_b32 v21, 16, v20
    v_and_b32 v22, 0xffff0000, v20
    v_mul_f32 v21, s45, v21
    v_mul_f32 v22, s45, v22
    v_cvt_pk_bf16_f32 v20, v21, v22
    v_lshlrev_b32 v21, 16, v20
    v_and_b32 v22, 0xffff0000, v20
    v_lshlrev_b32 v23, 16, v32
    v_and_b32 v24, 0xffff0000, v32
    v_add_f32 v21, v21, v23
    v_add_f32 v22, v22, v24
    v_cvt_pk_bf16_f32 v20, v21, v22
    v_lshlrev_b32 v21, 16, v20
    v_and_b32 v22, 0xffff0000, v20
    v_lshlrev_b32 v23, 16, v34
    v_and_b32 v24, 0xffff0000, v34
    v_add_f32 v21, v21, v23
    v_add_f32 v22, v22, v24
    v_cvt_pk_bf16_f32 v26, v21, v22
    v_cvt_pk_bf16_f32 v20, v98, v99
    v_lshlrev_b32 v21, 16, v20
    v_and_b32 v22, 0xffff0000, v20
    v_mul_f32 v21, s45, v21
    v_mul_f32 v22, s45, v22
    v_cvt_pk_bf16_f32 v20, v21, v22
    v_lshlrev_b32 v21, 16, v20
    v_and_b32 v22, 0xffff0000, v20
    v_lshlrev_b32 v23, 16, v33
    v_and_b32 v24, 0xffff0000, v33
    v_add_f32 v21, v21, v23
    v_add_f32 v22, v22, v24
    v_cvt_pk_bf16_f32 v20, v21, v22
    v_lshlrev_b32 v21, 16, v20
    v_and_b32 v22, 0xffff0000, v20
    v_lshlrev_b32 v23, 16, v35
    v_and_b32 v24, 0xffff0000, v35
    v_add_f32 v21, v21, v23
    v_add_f32 v22, v22, v24
    v_cvt_pk_bf16_f32 v27, v21, v22
    v_cmp_gt_u32 vcc, 16, v2
    s_and_saveexec_b64 s[52:53], vcc
    s_cbranch_execz ff_fin_149
    buffer_store_dwordx2 v[26:27], v9, s[36:39], s46 offen sc1
ff_fin_149:
    s_mov_b64 exec, -1
k12_end_1:
    s_endpgm
k2_prep_70:
    s_sub_u32 s40, s36, s38
    v_subrev_u32 v6, s40, v4
    v_cmp_gt_i32 s[44:45], 0, v6
    v_cmp_gt_i32 s[46:47], 1, v6
    v_cmp_gt_i32 s[48:49], 2, v6
    v_cmp_gt_i32 s[50:51], 3, v6
    v_cndmask_b32 v16, v8, v5, s[44:45]
    v_cndmask_b32 v17, v8, v5, s[46:47]
    v_cndmask_b32 v18, v8, v5, s[48:49]
    v_cndmask_b32 v19, v8, v5, s[50:51]
    v_cmp_gt_i32 s[44:45], 16, v6
    v_cmp_gt_i32 s[46:47], 17, v6
    v_cmp_gt_i32 s[48:49], 18, v6
    v_cmp_gt_i32 s[50:51], 19, v6
    v_cndmask_b32 v32, v8, v5, s[44:45]
    v_cndmask_b32 v33, v8, v5, s[46:47]
    v_cndmask_b32 v34, v8, v5, s[48:49]
    v_cndmask_b32 v35, v8, v5, s[50:51]
    s_nop 1
    s_branch k2_prepret_71
k2_prep_78:
    s_sub_u32 s40, s36, s38
    v_subrev_u32 v6, s40, v4
    v_cmp_gt_i32 s[44:45], 0, v6
    v_cmp_gt_i32 s[46:47], 1, v6
    v_cmp_gt_i32 s[48:49], 2, v6
    v_cmp_gt_i32 s[50:51], 3, v6
    v_cndmask_b32 v16, v8, v5, s[44:45]
    v_cndmask_b32 v17, v8, v5, s[46:47]
    v_cndmask_b32 v18, v8, v5, s[48:49]
    v_cndmask_b32 v19, v8, v5, s[50:51]
    v_cmp_gt_i32 s[44:45], 16, v6
    v_cmp_gt_i32 s[46:47], 17, v6
    v_cmp_gt_i32 s[48:49], 18, v6
    v_cmp_gt_i32 s[50:51], 19, v6
    v_cndmask_b32 v32, v8, v5, s[44:45]
    v_cndmask_b32 v33, v8, v5, s[46:47]
    v_cndmask_b32 v34, v8, v5, s[48:49]
    v_cndmask_b32 v35, v8, v5, s[50:51]
    s_nop 1
    s_branch k2_prepret_79
k2_prep_96:
    s_sub_u32 s40, s36, s39
    v_subrev_u32 v6, s40, v4
    v_cmp_gt_i32 s[44:45], 0, v6
    v_cmp_gt_i32 s[46:47], 1, v6
    v_cmp_gt_i32 s[48:49], 2, v6
    v_cmp_gt_i32 s[50:51], 3, v6
    v_cndmask_b32 v16, v10, v5, s[44:45]
    v_cndmask_b32 v17, v10, v5, s[46:47]
    v_cndmask_b32 v18, v10, v5, s[48:49]
    v_cndmask_b32 v19, v10, v5, s[50:51]
    v_cmp_gt_i32 s[44:45], 16, v6
    v_cmp_gt_i32 s[46:47], 17, v6
    v_cmp_gt_i32 s[48:49], 18, v6
    v_cmp_gt_i32 s[50:51], 19, v6
    v_cndmask_b32 v32, v10, v5, s[44:45]
    v_cndmask_b32 v33, v10, v5, s[46:47]
    v_cndmask_b32 v34, v10, v5, s[48:49]
    v_cndmask_b32 v35, v10, v5, s[50:51]
    v_cmp_gt_i32 s[44:45], 32, v6
    v_cmp_gt_i32 s[46:47], 33, v6
    v_cmp_gt_i32 s[48:49], 34, v6
    v_cmp_gt_i32 s[50:51], 35, v6
    v_cndmask_b32 v24, v10, v5, s[44:45]
    v_cndmask_b32 v25, v10, v5, s[46:47]
    v_cndmask_b32 v26, v10, v5, s[48:49]
    v_cndmask_b32 v27, v10, v5, s[50:51]
    v_cmp_gt_i32 s[44:45], 48, v6
    v_cmp_gt_i32 s[46:47], 49, v6
    v_cmp_gt_i32 s[48:49], 50, v6
    v_cmp_gt_i32 s[50:51], 51, v6
    v_cndmask_b32 v40, v10, v5, s[44:45]
    v_cndmask_b32 v41, v10, v5, s[46:47]
    v_cndmask_b32 v42, v10, v5, s[48:49]
    v_cndmask_b32 v43, v10, v5, s[50:51]
    s_nop 1
    s_branch k2_prepret_97
k2_prep_100:
    s_sub_u32 s40, s36, s39
    s_sub_u32 s40, s40, 64
    v_subrev_u32 v6, s40, v4
    v_cmp_gt_i32 s[44:45], 0, v6
    v_cmp_gt_i32 s[46:47], 1, v6
    v_cmp_gt_i32 s[48:49], 2, v6
    v_cmp_gt_i32 s[50:51], 3, v6
    v_cndmask_b32 v20, v11, v5, s[44:45]
    v_cndmask_b32 v21, v11, v5, s[46:47]
    v_cndmask_b32 v22, v11, v5, s[48:49]
    v_cndmask_b32 v23, v11, v5, s[50:51]
    v_cmp_gt_i32 s[44:45], 16, v6
    v_cmp_gt_i32 s[46:47], 17, v6
    v_cmp_gt_i32 s[48:49], 18, v6
    v_cmp_gt_i32 s[50:51], 19, v6
    v_cndmask_b32 v36, v11, v5, s[44:45]
    v_cndmask_b32 v37, v11, v5, s[46:47]
    v_cndmask_b32 v38, v11, v5, s[48:49]
    v_cndmask_b32 v39, v11, v5, s[50:51]
    v_cmp_gt_i32 s[44:45], 32, v6
    v_cmp_gt_i32 s[46:47], 33, v6
    v_cmp_gt_i32 s[48:49], 34, v6
    v_cmp_gt_i32 s[50:51], 35, v6
    v_cndmask_b32 v28, v11, v5, s[44:45]
    v_cndmask_b32 v29, v11, v5, s[46:47]
    v_cndmask_b32 v30, v11, v5, s[48:49]
    v_cndmask_b32 v31, v11, v5, s[50:51]
    v_cmp_gt_i32 s[44:45], 48, v6
    v_cmp_gt_i32 s[46:47], 49, v6
    v_cmp_gt_i32 s[48:49], 50, v6
    v_cmp_gt_i32 s[50:51], 51, v6
    v_cndmask_b32 v44, v11, v5, s[44:45]
    v_cndmask_b32 v45, v11, v5, s[46:47]
    v_cndmask_b32 v46, v11, v5, s[48:49]
    v_cndmask_b32 v47, v11, v5, s[50:51]
    s_nop 1
    s_branch k2_prepret_101
k12_ool_10:
    buffer_load_dword v52, v8, s[24:27], 0 offen sc1
    s_branch k12_oolret_11
k12_ool_12:
    s_mov_b64 exec, 1
    buffer_atomic_add v9, v8, s[24:27], 0 offen sc1
    s_mov_b64 exec, -1
    s_branch k12_oolret_13
k12_ool_14:
    buffer_load_dword v51, v50, s[12:15], s56 offen
    s_branch k12_oolret_15
k12_ool_18:
    v_readfirstlane_b32 s31, v52
    s_cmp_ge_u32 s31, 256
    s_cbranch_scc1 spin_ok_16
    s_mov_b32 s40, 1048576
spin_17:
    s_sleep 8
    buffer_load_dword v52, v8, s[24:27], 0 offen sc1
    s_waitcnt vmcnt(0)
    v_readfirstlane_b32 s31, v52
    s_sub_u32 s40, s40, 1
    s_cselect_b32 s31, -1, s31
    s_cmp_lt_u32 s31, 256
    s_cbranch_scc1 spin_17
spin_ok_16:
    s_branch k12_oolret_19
k12_ool_20:
    s_mov_b64 exec, 1
    buffer_atomic_add v9, v8, s[24:27], 0 offen sc1
    s_mov_b64 exec, -1
    s_branch k12_oolret_21
k12_ool_22:
    global_load_dword v51, v[2:3], off
    s_branch k12_oolret_23
k12_ool_26:
    buffer_load_dword v52, v8, s[24:27], 0 offen sc1
    s_branch k12_oolret_27
k12_ool_28:
    s_mov_b64 exec, 1
    buffer_atomic_add v9, v8, s[24:27], 0 offen sc1
    s_mov_b64 exec, -1
    s_branch k12_oolret_29
k12_ool_30:
    buffer_load_dword v51, v50, s[12:15], s56 offen
    s_branch k12_oolret_31
k12_ool_34:
    v_readfirstlane_b32 s31, v52
    s_cmp_ge_u32 s31, 256
    s_cbranch_scc1 spin_ok_32
    s_mov_b32 s40, 1048576
spin_33:
    s_sleep 8
    buffer_load_dword v52, v8, s[24:27], 0 offen sc1
    s_waitcnt vmcnt(0)
    v_readfirstlane_b32 s31, v52
    s_sub_u32 s40, s40, 1
    s_cselect_b32 s31, -1, s31
    s_cmp_lt_u32 s31, 256
    s_cbranch_scc1 spin_33
spin_ok_32:
    s_branch k12_oolret_35
k12_ool_36:
    s_mov_b64 exec, 1
    buffer_atomic_add v9, v8, s[24:27], 0 offen sc1
    s_mov_b64 exec, -1
    s_branch k12_oolret_37
k12_ool_38:
    global_load_dword v51, v[2:3], off
    s_branch k12_oolret_39
k12_ool_40:
    s_add_u32 s52, s47, 528384
    buffer_store_dwordx4 v[156:159], v1, s[48:51], s52 offen offset:3072 sc1
    s_branch k12_oolret_41
k12_ool_42:
    s_add_u32 s52, s47, 532480
    buffer_store_dwordx4 v[160:163], v1, s[48:51], s52 offen offset:0 sc1
    s_branch k12_oolret_43
k12_ool_44:
    s_add_u32 s52, s47, 532480
    buffer_store_dwordx4 v[164:167], v1, s[48:51], s52 offen offset:1024 sc1
    s_branch k12_oolret_45
k12_ool_46:
    s_add_u32 s52, s47, 532480
    buffer_store_dwordx4 v[168:171], v1, s[48:51], s52 offen offset:2048 sc1
    s_branch k12_oolret_47
k12_ool_48:
    s_add_u32 s52, s47, 532480
    buffer_store_dwordx4 v[172:175], v1, s[48:51], s52 offen offset:3072 sc1
    s_branch k12_oolret_49
k12_ool_50:
    s_add_u32 s52, s47, 536576
    buffer_store_dwordx4 v[176:179], v1, s[48:51], s52 offen offset:0 sc1
    s_branch k12_oolret_51
k12_ool_52:
    s_add_u32 s52, s47, 536576
    buffer_store_dwordx4 v[180:183], v1, s[48:51], s52 offen offset:1024 sc1
    s_branch k12_oolret_53
k12_ool_54:
    s_add_u32 s52, s47, 536576
    buffer_store_dwordx4 v[184:187], v1, s[48:51], s52 offen offset:2048 sc1
    s_branch k12_oolret_55
k12_ool_56:
    s_add_u32 s52, s47, 536576
    buffer_store_dwordx4 v[188:191], v1, s[48:51], s52 offen offset:3072 sc1
    s_branch k12_oolret_57
k12_ool_58:
    s_mov_b32 s50, 0
    s_branch k12_oolret_59
k12_ool_60:
    s_mov_b64 exec, 1
    buffer_atomic_add v9, v8, s[24:27], s54 offen sc1
    s_mov_b64 exec, -1
    s_branch k12_oolret_61
k12_ool_62:
    buffer_load_dword v52, v8, s[24:27], s55 offen sc1
    s_branch k12_oolret_63
k12_ool_66:
    s_waitcnt vmcnt(14)
    v_readfirstlane_b32 s31, v52
    s_cmp_ge_u32 s31, 2
    s_cbranch_scc1 spin_ok_64
    s_mov_b32 s40, 1048576
spin_65:
    s_sleep 8
    buffer_load_dword v52, v8, s[24:27], s55 offen sc1
    s_waitcnt vmcnt(0)
    v_readfirstlane_b32 s31, v52
    s_sub_u32 s40, s40, 1
    s_cselect_b32 s31, -1, s31
    s_cmp_lt_u32 s31, 2
    s_cbranch_scc1 spin_65
spin_ok_64:
    s_branch k12_oolret_67
k12_ool_68:
    s_mov_b64 exec, 1
    buffer_atomic_add v9, v8, s[24:27], s3 offen sc1
    s_mov_b64 exec, -1
    s_branch k12_oolret_69
k12_ool_72:
    buffer_load_dword v58, v59, s[24:27], s5 offen sc1
    s_branch k12_oolret_73
k12_ool_76:
    s_waitcnt vmcnt(0)
    v_readfirstlane_b32 s31, v58
    s_cmp_ge_u32 s31, 14
    s_cbranch_scc1 spin_ok_74
    s_mov_b32 s40, 1048576
spin_75:
    s_sleep 8
    buffer_load_dword v58, v59, s[24:27], s5 offen sc1
    s_waitcnt vmcnt(0)
    v_readfirstlane_b32 s31, v58
    s_sub_u32 s40, s40, 1
    s_cselect_b32 s31, -1, s31
    s_cmp_lt_u32 s31, 14
    s_cbranch_scc1 spin_75
spin_ok_74:
    s_branch k12_oolret_77
k12_ool_116:
    s_mov_b64 exec, 1
    buffer_atomic_add v76, v75, s[16:19], s57 offen sc1
    s_mov_b64 exec, -1
    s_branch k12_oolret_117
k12_ool_121:
    s_mov_b64 exec, 1
    buffer_atomic_add v76, v75, s[16:19], s58 offen sc1
    s_mov_b64 exec, -1
    s_branch k12_oolret_122
k12_ool_125:
    s_mov_b32 s34, 1048576
op_spin_123:
    buffer_load_dword v74, v73, s[16:19], s59 offen sc1
    s_waitcnt vmcnt(0)
    v_cmp_le_u32 vcc, 4, v74
    s_sub_u32 s34, s34, 1
    s_cbranch_scc1 op_ok_124
    s_mov_b32 s33, vcc_lo
    s_bitcmp1_b32 s33, 0
    s_cbranch_scc1 op_ok_124
    s_sleep 4
    s_branch op_spin_123
op_ok_124:
    buffer_load_dwordx4 a[128:131], v88, s[8:11], s62 offen offset:0 sc1
    buffer_load_dwordx4 a[132:135], v88, s[8:11], s62 offen offset:1024 sc1
    buffer_load_dwordx4 a[136:139], v89, s[8:11], s62 offen offset:0 sc1
    buffer_load_dwordx4 a[140:143], v89, s[8:11], s62 offen offset:1024 sc1
    s_add_u32 s62, s62, 0x40000
    s_and_b32 s62, s62, 0x7fffff
    buffer_load_dwordx4 a[144:147], v88, s[8:11], s62 offen offset:0 sc1
    buffer_load_dwordx4 a[148:151], v88, s[8:11], s62 offen offset:1024 sc1
    buffer_load_dwordx4 a[152:155], v89, s[8:11], s62 offen offset:0 sc1
    buffer_load_dwordx4 a[156:159], v89, s[8:11], s62 offen offset:1024 sc1
    s_add_u32 s62, s62, 0x40000
    s_and_b32 s62, s62, 0x7fffff
    buffer_load_dwordx4 a[160:163], v88, s[8:11], s62 offen offset:0 sc1
    buffer_load_dwordx4 a[164:167], v88, s[8:11], s62 offen offset:1024 sc1
    buffer_load_dwordx4 a[168:171], v89, s[8:11], s62 offen offset:0 sc1
    buffer_load_dwordx4 a[172:175], v89, s[8:11], s62 offen offset:1024 sc1
    s_add_u32 s62, s62, 0x40000
    s_and_b32 s62, s62, 0x7fffff
    s_branch k12_oolret_126
k12_ool_131:
    buffer_load_dwordx2 v[192:193], v78, s[20:23], 0 offen offset:0
    buffer_load_dwordx2 v[194:195], v78, s[20:23], 0 offen offset:32
    buffer_load_dwordx2 v[196:197], v78, s[20:23], 0 offen offset:64
    buffer_load_dwordx2 v[198:199], v78, s[20:23], 0 offen offset:96
    buffer_load_dwordx2 v[200:201], v79, s[20:23], 0 offen offset:0
    buffer_load_dwordx2 v[202:203], v79, s[20:23], 0 offen offset:32
    buffer_load_dwordx2 v[204:205], v79, s[20:23], 0 offen offset:64
    buffer_load_dwordx2 v[206:207], v79, s[20:23], 0 offen offset:96
    buffer_load_dwordx2 v[208:209], v80, s[44:47], 0 offen offset:0
    buffer_load_dwordx2 v[210:211], v80, s[44:47], 0 offen offset:32
    buffer_load_dwordx2 v[212:213], v80, s[44:47], 0 offen offset:64
    buffer_load_dwordx2 v[214:215], v80, s[44:47], 0 offen offset:96
    global_load_dword v84, v[82:83], off
    s_mov_b32 s10, 0
    s_mov_b32 s14, 0
    s_mov_b32 s34, 1048576
ff_spin_129:
    v_cmp_gt_u32 vcc, 4, v95
    s_cbranch_vccz ff_ok_130
    s_sub_u32 s34, s34, 1
    s_cbranch_scc1 ff_ok_130
    s_sleep 4
    buffer_load_dword v95, v94, s[16:19], 0 offen sc1
    s_waitcnt vmcnt(0)
    s_branch ff_spin_129
ff_ok_130:
    s_add_u32 s44, s6, 0x6000000
    s_addc_u32 s45, s7, 0
    s_and_b32 s45, s45, 0xffff
    s_cmp_ge_u32 s2, 224
    s_cselect_b32 s46, 0, 0x1000000
    s_branch k12_oolret_132
k12_ool_135:
    s_mov_b32 s34, 1048576
op_spin_133:
    buffer_load_dword v74, v73, s[16:19], s59 offen sc1
    s_waitcnt vmcnt(0)
    v_cmp_le_u32 vcc, 4, v74
    s_sub_u32 s34, s34, 1
    s_cbranch_scc1 op_ok_134
    s_mov_b32 s33, vcc_lo
    s_bitcmp1_b32 s33, s32
    s_cbranch_scc1 op_ok_134
    s_sleep 4
    s_branch op_spin_133
op_ok_134:
    s_branch k12_oolret_136
k12_ool_137:
    buffer_load_dword v95, v94, s[16:19], 0 offen sc1
    s_branch k12_oolret_138
k2_tramp_80:
    s_call_b64 s[40:41], k2_rare_152
    s_branch k2_ret_81
k2_tramp_84:
    s_call_b64 s[40:41], k2_rare_153
    s_branch k2_ret_85
k2_tramp_86:
    s_call_b64 s[40:41], k2_rare_152
    s_branch k2_ret_87
k2_tramp_88:
    s_call_b64 s[40:41], k2_rare_153
    s_branch k2_ret_89
k2_tramp_90:
    s_call_b64 s[40:41], k2_rare_152
    s_branch k2_ret_91
k2_tramp_92:
    s_call_b64 s[40:41], k2_rare_153
    s_branch k2_ret_93
k2_tramp_94:
    s_call_b64 s[40:41], k2_rare_158
    s_branch k2_ret_95
k2_tramp_98:
    s_call_b64 s[40:41], k2_rare_159
    s_branch k2_ret_99
k2_tramp_102:
    s_call_b64 s[40:41], k2_rare_160
    s_branch k2_ret_103
k2_tramp_106:
    s_call_b64 s[40:41], k2_rare_161
    s_branch k2_ret_107
k2_tramp_108:
    s_call_b64 s[40:41], k2_rare_160
    s_branch k2_ret_109
k2_tramp_110:
    s_call_b64 s[40:41], k2_rare_161
    s_branch k2_ret_111
k2_tramp_112:
    s_call_b64 s[40:41], k2_rare_160
    s_branch k2_ret_113
k2_tramp_114:
    s_call_b64 s[40:41], k2_rare_165
    s_branch k2_ret_115
k2_rare_152:
    s_nop 7
    v_max_f32 v52, v128, v129
    v_max3_f32 v52, v52, v130, v131
    v_max3_f32 v52, v52, v144, v145
    v_max3_f32 v52, v52, v146, v147
    v_max_f32 v53, v132, v133
    v_max3_f32 v53, v53, v134, v135
    v_max3_f32 v53, v53, v148, v149
    v_max3_f32 v53, v53, v150, v151
    v_max_f32 v54, v136, v137
    v_max3_f32 v54, v54, v138, v139
    v_max3_f32 v54, v54, v152, v153
    v_max3_f32 v54, v54, v154, v155
    v_max_f32 v55, v140, v141
    v_max3_f32 v55, v55, v142, v143
    v_max3_f32 v55, v55, v156, v157
    v_max3_f32 v55, v55, v158, v159
    v_mov_b32 v224, v52
    v_mov_b32 v225, v53
    v_mov_b32 v226, v54
    v_mov_b32 v227, v55
    s_nop 1
    v_permlane16_swap_b32 v52, v224
    v_permlane16_swap_b32 v53, v225
    v_permlane16_swap_b32 v54, v226
    v_permlane16_swap_b32 v55, v227
    s_nop 1
    v_max_f32 v52, v52, v224
    v_max_f32 v53, v53, v225
    v_max_f32 v54, v54, v226
    v_max_f32 v55, v55, v227
    v_mov_b32 v224, v52
    v_mov_b32 v225, v53
    v_mov_b32 v226, v54
    v_mov_b32 v227, v55
    s_nop 1
    v_permlane32_swap_b32 v52, v224
    v_permlane32_swap_b32 v53, v225
    v_permlane32_swap_b32 v54, v226
    v_permlane32_swap_b32 v55, v227
    s_nop 1
    v_max_f32 v52, v52, v224
    v_max_f32 v53, v53, v225
    v_max_f32 v54, v54, v226
    v_max_f32 v55, v55, v227
    v_add_f32 v52, 0x41400000, v52
    v_max_f32 v52, 0, v52
    v_add_f32 v53, 0x41400000, v53
    v_max_f32 v53, 0, v53
    v_add_f32 v54, 0x41400000, v54
    v_max_f32 v54, 0, v54
    v_add_f32 v55, 0x41400000, v55
    v_max_f32 v55, 0, v55
    v_sub_f32 v128, v128, v52
    v_sub_f32 v129, v129, v52
    v_sub_f32 v130, v130, v52
    v_sub_f32 v131, v131, v52
    v_sub_f32 v132, v132, v53
    v_sub_f32 v133, v133, v53
    v_sub_f32 v134, v134, v53
    v_sub_f32 v135, v135, v53
    v_sub_f32 v136, v136, v54
    v_sub_f32 v137, v137, v54
    v_sub_f32 v138, v138, v54
    v_sub_f32 v139, v139, v54
    v_sub_f32 v140, v140, v55
    v_sub_f32 v141, v141, v55
    v_sub_f32 v142, v142, v55
    v_sub_f32 v143, v143, v55
    v_sub_f32 v144, v144, v52
    v_sub_f32 v145, v145, v52
    v_sub_f32 v146, v146, v52
    v_sub_f32 v147, v147, v52
    v_sub_f32 v148, v148, v53
    v_sub_f32 v149, v149, v53
    v_sub_f32 v150, v150, v53
    v_sub_f32 v151, v151, v53
    v_sub_f32 v152, v152, v54
    v_sub_f32 v153, v153, v54
    v_sub_f32 v154, v154, v54
    v_sub_f32 v155, v155, v54
    v_sub_f32 v156, v156, v55
    v_sub_f32 v157, v157, v55
    v_sub_f32 v158, v158, v55
    v_sub_f32 v159, v159, v55
    v_sub_f32 v160, v160, v52
    v_sub_f32 v16, v16, v52
    v_sub_f32 v161, v161, v52
    v_sub_f32 v17, v17, v52
    v_sub_f32 v162, v162, v52
    v_sub_f32 v18, v18, v52
    v_sub_f32 v163, v163, v52
    v_sub_f32 v19, v19, v52
    v_sub_f32 v164, v164, v53
    v_sub_f32 v20, v20, v53
    v_sub_f32 v165, v165, v53
    v_sub_f32 v21, v21, v53
    v_sub_f32 v166, v166, v53
    v_sub_f32 v22, v22, v53
    v_sub_f32 v167, v167, v53
    v_sub_f32 v23, v23, v53
    v_sub_f32 v168, v168, v54
    v_sub_f32 v24, v24, v54
    v_sub_f32 v169, v169, v54
    v_sub_f32 v25, v25, v54
    v_sub_f32 v170, v170, v54
    v_sub_f32 v26, v26, v54
    v_sub_f32 v171, v171, v54
    v_sub_f32 v27, v27, v54
    v_sub_f32 v172, v172, v55
    v_sub_f32 v28, v28, v55
    v_sub_f32 v173, v173, v55
    v_sub_f32 v29, v29, v55
    v_sub_f32 v174, v174, v55
    v_sub_f32 v30, v30, v55
    v_sub_f32 v175, v175, v55
    v_sub_f32 v31, v31, v55
    v_sub_f32 v176, v176, v52
    v_sub_f32 v32, v32, v52
    v_sub_f32 v177, v177, v52
    v_sub_f32 v33, v33, v52
    v_sub_f32 v178, v178, v52
    v_sub_f32 v34, v34, v52
    v_sub_f32 v179, v179, v52
    v_sub_f32 v35, v35, v52
    v_sub_f32 v180, v180, v53
    v_sub_f32 v36, v36, v53
    v_sub_f32 v181, v181, v53
    v_sub_f32 v37, v37, v53
    v_sub_f32 v182, v182, v53
    v_sub_f32 v38, v38, v53
    v_sub_f32 v183, v183, v53
    v_sub_f32 v39, v39, v53
    v_sub_f32 v184, v184, v54
    v_sub_f32 v40, v40, v54
    v_sub_f32 v185, v185, v54
    v_sub_f32 v41, v41, v54
    v_sub_f32 v186, v186, v54
    v_sub_f32 v42, v42, v54
    v_sub_f32 v187, v187, v54
    v_sub_f32 v43, v43, v54
    v_sub_f32 v188, v188, v55
    v_sub_f32 v44, v44, v55
    v_sub_f32 v189, v189, v55
    v_sub_f32 v45, v45, v55
    v_sub_f32 v190, v190, v55
    v_sub_f32 v46, v46, v55
    v_sub_f32 v191, v191, v55
    v_sub_f32 v47, v47, v55
    v_sub_f32 v8, v8, v52
    v_exp_f32 v52, -v52
    v_sub_f32 v9, v9, v53
    v_exp_f32 v53, -v53
    v_sub_f32 v10, v10, v54
    v_exp_f32 v54, -v54
    v_sub_f32 v11, v11, v55
    v_exp_f32 v55, -v55
    s_nop 0
    v_mul_f32 v12, v12, v52
    v_mul_f32 v48, v48, v53
    v_mul_f32 v248, v248, v54
    v_mul_f32 v252, v252, v55
    v_accvgpr_read_b32 v224, a0
    v_accvgpr_read_b32 v225, a1
    v_accvgpr_read_b32 v226, a2
    v_accvgpr_read_b32 v227, a3
    v_mul_f32 v224, v224, v52
    v_mul_f32 v225, v225, v52
    v_mul_f32 v226, v226, v52
    v_mul_f32 v227, v227, v52
    v_accvgpr_write_b32 a0, v224
    v_accvgpr_write_b32 a1, v225
    v_accvgpr_write_b32 a2, v226
    v_accvgpr_write_b32 a3, v227
    v_accvgpr_read_b32 v224, a4
    v_accvgpr_read_b32 v225, a5
    v_accvgpr_read_b32 v226, a6
    v_accvgpr_read_b32 v227, a7
    v_mul_f32 v224, v224, v53
    v_mul_f32 v225, v225, v53
    v_mul_f32 v226, v226, v53
    v_mul_f32 v227, v227, v53
    v_accvgpr_write_b32 a4, v224
    v_accvgpr_write_b32 a5, v225
    v_accvgpr_write_b32 a6, v226
    v_accvgpr_write_b32 a7, v227
    v_accvgpr_read_b32 v224, a8
    v_accvgpr_read_b32 v225, a9
    v_accvgpr_read_b32 v226, a10
    v_accvgpr_read_b32 v227, a11
    v_mul_f32 v224, v224, v54
    v_mul_f32 v225, v225, v54
    v_mul_f32 v226, v226, v54
    v_mul_f32 v227, v227, v54
    v_accvgpr_write_b32 a8, v224
    v_accvgpr_write_b32 a9, v225
    v_accvgpr_write_b32 a10, v226
    v_accvgpr_write_b32 a11, v227
    v_accvgpr_read_b32 v224, a12
    v_accvgpr_read_b32 v225, a13
    v_accvgpr_read_b32 v226, a14
    v_accvgpr_read_b32 v227, a15
    v_mul_f32 v224, v224, v55
    v_mul_f32 v225, v225, v55
    v_mul_f32 v226, v226, v55
    v_mul_f32 v227, v227, v55
    v_accvgpr_write_b32 a12, v224
    v_accvgpr_write_b32 a13, v225
    v_accvgpr_write_b32 a14, v226
    v_accvgpr_write_b32 a15, v227
    v_accvgpr_read_b32 v224, a16
    v_accvgpr_read_b32 v225, a17
    v_accvgpr_read_b32 v226, a18
    v_accvgpr_read_b32 v227, a19
    v_mul_f32 v224, v224, v52
    v_mul_f32 v225, v225, v52
    v_mul_f32 v226, v226, v52
    v_mul_f32 v227, v227, v52
    v_accvgpr_write_b32 a16, v224
    v_accvgpr_write_b32 a17, v225
    v_accvgpr_write_b32 a18, v226
    v_accvgpr_write_b32 a19, v227
    v_accvgpr_read_b32 v224, a20
    v_accvgpr_read_b32 v225, a21
    v_accvgpr_read_b32 v226, a22
    v_accvgpr_read_b32 v227, a23
    v_mul_f32 v224, v224, v53
    v_mul_f32 v225, v225, v53
    v_mul_f32 v226, v226, v53
    v_mul_f32 v227, v227, v53
    v_accvgpr_write_b32 a20, v224
    v_accvgpr_write_b32 a21, v225
    v_accvgpr_write_b32 a22, v226
    v_accvgpr_write_b32 a23, v227
    v_accvgpr_read_b32 v224, a24
    v_accvgpr_read_b32 v225, a25
    v_accvgpr_read_b32 v226, a26
    v_accvgpr_read_b32 v227, a27
    v_mul_f32 v224, v224, v54
    v_mul_f32 v225, v225, v54
    v_mul_f32 v226, v226, v54
    v_mul_f32 v227, v227, v54
    v_accvgpr_write_b32 a24, v224
    v_accvgpr_write_b32 a25, v225
    v_accvgpr_write_b32 a26, v226
    v_accvgpr_write_b32 a27, v227
    v_accvgpr_read_b32 v224, a28
    v_accvgpr_read_b32 v225, a29
    v_accvgpr_read_b32 v226, a30
    v_accvgpr_read_b32 v227, a31
    v_mul_f32 v224, v224, v55
    v_mul_f32 v225, v225, v55
    v_mul_f32 v226, v226, v55
    v_mul_f32 v227, v227, v55
    v_accvgpr_write_b32 a28, v224
    v_accvgpr_write_b32 a29, v225
    v_accvgpr_write_b32 a30, v226
    v_accvgpr_write_b32 a31, v227
    v_accvgpr_read_b32 v224, a32
    v_accvgpr_read_b32 v225, a33
    v_accvgpr_read_b32 v226, a34
    v_accvgpr_read_b32 v227, a35
    v_mul_f32 v224, v224, v52
    v_mul_f32 v225, v225, v52
    v_mul_f32 v226, v226, v52
    v_mul_f32 v227, v227, v52
    v_accvgpr_write_b32 a32, v224
    v_accvgpr_write_b32 a33, v225
    v_accvgpr_write_b32 a34, v226
    v_accvgpr_write_b32 a35, v227
    v_accvgpr_read_b32 v224, a36
    v_accvgpr_read_b32 v225, a37
    v_accvgpr_read_b32 v226, a38
    v_accvgpr_read_b32 v227, a39
    v_mul_f32 v224, v224, v53
    v_mul_f32 v225, v225, v53
    v_mul_f32 v226, v226, v53
    v_mul_f32 v227, v227, v53
    v_accvgpr_write_b32 a36, v224
    v_accvgpr_write_b32 a37, v225
    v_accvgpr_write_b32 a38, v226
    v_accvgpr_write_b32 a39, v227
    v_accvgpr_read_b32 v224, a40
    v_accvgpr_read_b32 v225, a41
    v_accvgpr_read_b32 v226, a42
    v_accvgpr_read_b32 v227, a43
    v_mul_f32 v224, v224, v54
    v_mul_f32 v225, v225, v54
    v_mul_f32 v226, v226, v54
    v_mul_f32 v227, v227, v54
    v_accvgpr_write_b32 a40, v224
    v_accvgpr_write_b32 a41, v225
    v_accvgpr_write_b32 a42, v226
    v_accvgpr_write_b32 a43, v227
    v_accvgpr_read_b32 v224, a44
    v_accvgpr_read_b32 v225, a45
    v_accvgpr_read_b32 v226, a46
    v_accvgpr_read_b32 v227, a47
    v_mul_f32 v224, v224, v55
    v_mul_f32 v225, v225, v55
    v_mul_f32 v226, v226, v55
    v_mul_f32 v227, v227, v55
    v_accvgpr_write_b32 a44, v224
    v_accvgpr_write_b32 a45, v225
    v_accvgpr_write_b32 a46, v226
    v_accvgpr_write_b32 a47, v227
    v_accvgpr_read_b32 v224, a48
    v_accvgpr_read_b32 v225, a49
    v_accvgpr_read_b32 v226, a50
    v_accvgpr_read_b32 v227, a51
    v_mul_f32 v224, v224, v52
    v_mul_f32 v225, v225, v52
    v_mul_f32 v226, v226, v52
    v_mul_f32 v227, v227, v52
    v_accvgpr_write_b32 a48, v224
    v_accvgpr_write_b32 a49, v225
    v_accvgpr_write_b32 a50, v226
    v_accvgpr_write_b32 a51, v227
    v_accvgpr_read_b32 v224, a52
    v_accvgpr_read_b32 v225, a53
    v_accvgpr_read_b32 v226, a54
    v_accvgpr_read_b32 v227, a55
    v_mul_f32 v224, v224, v53
    v_mul_f32 v225, v225, v53
    v_mul_f32 v226, v226, v53
    v_mul_f32 v227, v227, v53
    v_accvgpr_write_b32 a52, v224
    v_accvgpr_write_b32 a53, v225
    v_accvgpr_write_b32 a54, v226
    v_accvgpr_write_b32 a55, v227
    v_accvgpr_read_b32 v224, a56
    v_accvgpr_read_b32 v225, a57
    v_accvgpr_read_b32 v226, a58
    v_accvgpr_read_b32 v227, a59
    v_mul_f32 v224, v224, v54
    v_mul_f32 v225, v225, v54
    v_mul_f32 v226, v226, v54
    v_mul_f32 v227, v227, v54
    v_accvgpr_write_b32 a56, v224
    v_accvgpr_write_b32 a57, v225
    v_accvgpr_write_b32 a58, v226
    v_accvgpr_write_b32 a59, v227
    v_accvgpr_read_b32 v224, a60
    v_accvgpr_read_b32 v225, a61
    v_accvgpr_read_b32 v226, a62
    v_accvgpr_read_b32 v227, a63
    v_mul_f32 v224, v224, v55
    v_mul_f32 v225, v225, v55
    v_mul_f32 v226, v226, v55
    v_mul_f32 v227, v227, v55
    v_accvgpr_write_b32 a60, v224
    v_accvgpr_write_b32 a61, v225
    v_accvgpr_write_b32 a62, v226
    v_accvgpr_write_b32 a63, v227
    v_accvgpr_read_b32 v224, a64
    v_accvgpr_read_b32 v225, a65
    v_accvgpr_read_b32 v226, a66
    v_accvgpr_read_b32 v227, a67
    v_mul_f32 v224, v224, v52
    v_mul_f32 v225, v225, v52
    v_mul_f32 v226, v226, v52
    v_mul_f32 v227, v227, v52
    v_accvgpr_write_b32 a64, v224
    v_accvgpr_write_b32 a65, v225
    v_accvgpr_write_b32 a66, v226
    v_accvgpr_write_b32 a67, v227
    v_accvgpr_read_b32 v224, a68
    v_accvgpr_read_b32 v225, a69
    v_accvgpr_read_b32 v226, a70
    v_accvgpr_read_b32 v227, a71
    v_mul_f32 v224, v224, v53
    v_mul_f32 v225, v225, v53
    v_mul_f32 v226, v226, v53
    v_mul_f32 v227, v227, v53
    v_accvgpr_write_b32 a68, v224
    v_accvgpr_write_b32 a69, v225
    v_accvgpr_write_b32 a70, v226
    v_accvgpr_write_b32 a71, v227
    v_accvgpr_read_b32 v224, a72
    v_accvgpr_read_b32 v225, a73
    v_accvgpr_read_b32 v226, a74
    v_accvgpr_read_b32 v227, a75
    v_mul_f32 v224, v224, v54
    v_mul_f32 v225, v225, v54
    v_mul_f32 v226, v226, v54
    v_mul_f32 v227, v227, v54
    v_accvgpr_write_b32 a72, v224
    v_accvgpr_write_b32 a73, v225
    v_accvgpr_write_b32 a74, v226
    v_accvgpr_write_b32 a75, v227
    v_accvgpr_read_b32 v224, a76
    v_accvgpr_read_b32 v225, a77
    v_accvgpr_read_b32 v226, a78
    v_accvgpr_read_b32 v227, a79
    v_mul_f32 v224, v224, v55
    v_mul_f32 v225, v225, v55
    v_mul_f32 v226, v226, v55
    v_mul_f32 v227, v227, v55
    v_accvgpr_write_b32 a76, v224
    v_accvgpr_write_b32 a77, v225
    v_accvgpr_write_b32 a78, v226
    v_accvgpr_write_b32 a79, v227
    v_accvgpr_read_b32 v224, a80
    v_accvgpr_read_b32 v225, a81
    v_accvgpr_read_b32 v226, a82
    v_accvgpr_read_b32 v227, a83
    v_mul_f32 v224, v224, v52
    v_mul_f32 v225, v225, v52
    v_mul_f32 v226, v226, v52
    v_mul_f32 v227, v227, v52
    v_accvgpr_write_b32 a80, v224
    v_accvgpr_write_b32 a81, v225
    v_accvgpr_write_b32 a82, v226
    v_accvgpr_write_b32 a83, v227
    v_accvgpr_read_b32 v224, a84
    v_accvgpr_read_b32 v225, a85
    v_accvgpr_read_b32 v226, a86
    v_accvgpr_read_b32 v227, a87
    v_mul_f32 v224, v224, v53
    v_mul_f32 v225, v225, v53
    v_mul_f32 v226, v226, v53
    v_mul_f32 v227, v227, v53
    v_accvgpr_write_b32 a84, v224
    v_accvgpr_write_b32 a85, v225
    v_accvgpr_write_b32 a86, v226
    v_accvgpr_write_b32 a87, v227
    v_accvgpr_read_b32 v224, a88
    v_accvgpr_read_b32 v225, a89
    v_accvgpr_read_b32 v226, a90
    v_accvgpr_read_b32 v227, a91
    v_mul_f32 v224, v224, v54
    v_mul_f32 v225, v225, v54
    v_mul_f32 v226, v226, v54
    v_mul_f32 v227, v227, v54
    v_accvgpr_write_b32 a88, v224
    v_accvgpr_write_b32 a89, v225
    v_accvgpr_write_b32 a90, v226
    v_accvgpr_write_b32 a91, v227
    v_accvgpr_read_b32 v224, a92
    v_accvgpr_read_b32 v225, a93
    v_accvgpr_read_b32 v226, a94
    v_accvgpr_read_b32 v227, a95
    v_mul_f32 v224, v224, v55
    v_mul_f32 v225, v225, v55
    v_mul_f32 v226, v226, v55
    v_mul_f32 v227, v227, v55
    v_accvgpr_write_b32 a92, v224
    v_accvgpr_write_b32 a93, v225
    v_accvgpr_write_b32 a94, v226
    v_accvgpr_write_b32 a95, v227
    v_accvgpr_read_b32 v224, a96
    v_accvgpr_read_b32 v225, a97
    v_accvgpr_read_b32 v226, a98
    v_accvgpr_read_b32 v227, a99
    v_mul_f32 v224, v224, v52
    v_mul_f32 v225, v225, v52
    v_mul_f32 v226, v226, v52
    v_mul_f32 v227, v227, v52
    v_accvgpr_write_b32 a96, v224
    v_accvgpr_write_b32 a97, v225
    v_accvgpr_write_b32 a98, v226
    v_accvgpr_write_b32 a99, v227
    v_accvgpr_read_b32 v224, a100
    v_accvgpr_read_b32 v225, a101
    v_accvgpr_read_b32 v226, a102
    v_accvgpr_read_b32 v227, a103
    v_mul_f32 v224, v224, v53
    v_mul_f32 v225, v225, v53
    v_mul_f32 v226, v226, v53
    v_mul_f32 v227, v227, v53
    v_accvgpr_write_b32 a100, v224
    v_accvgpr_write_b32 a101, v225
    v_accvgpr_write_b32 a102, v226
    v_accvgpr_write_b32 a103, v227
    v_accvgpr_read_b32 v224, a104
    v_accvgpr_read_b32 v225, a105
    v_accvgpr_read_b32 v226, a106
    v_accvgpr_read_b32 v227, a107
    v_mul_f32 v224, v224, v54
    v_mul_f32 v225, v225, v54
    v_mul_f32 v226, v226, v54
    v_mul_f32 v227, v227, v54
    v_accvgpr_write_b32 a104, v224
    v_accvgpr_write_b32 a105, v225
    v_accvgpr_write_b32 a106, v226
    v_accvgpr_write_b32 a107, v227
    v_accvgpr_read_b32 v224, a108
    v_accvgpr_read_b32 v225, a109
    v_accvgpr_read_b32 v226, a110
    v_accvgpr_read_b32 v227, a111
    v_mul_f32 v224, v224, v55
    v_mul_f32 v225, v225, v55
    v_mul_f32 v226, v226, v55
    v_mul_f32 v227, v227, v55
    v_accvgpr_write_b32 a108, v224
    v_accvgpr_write_b32 a109, v225
    v_accvgpr_write_b32 a110, v226
    v_accvgpr_write_b32 a111, v227
    v_accvgpr_read_b32 v224, a112
    v_accvgpr_read_b32 v225, a113
    v_accvgpr_read_b32 v226, a114
    v_accvgpr_read_b32 v227, a115
    v_mul_f32 v224, v224, v52
    v_mul_f32 v225, v225, v52
    v_mul_f32 v226, v226, v52
    v_mul_f32 v227, v227, v52
    v_accvgpr_write_b32 a112, v224
    v_accvgpr_write_b32 a113, v225
    v_accvgpr_write_b32 a114, v226
    v_accvgpr_write_b32 a115, v227
    v_accvgpr_read_b32 v224, a116
    v_accvgpr_read_b32 v225, a117
    v_accvgpr_read_b32 v226, a118
    v_accvgpr_read_b32 v227, a119
    v_mul_f32 v224, v224, v53
    v_mul_f32 v225, v225, v53
    v_mul_f32 v226, v226, v53
    v_mul_f32 v227, v227, v53
    v_accvgpr_write_b32 a116, v224
    v_accvgpr_write_b32 a117, v225
    v_accvgpr_write_b32 a118, v226
    v_accvgpr_write_b32 a119, v227
    v_accvgpr_read_b32 v224, a120
    v_accvgpr_read_b32 v225, a121
    v_accvgpr_read_b32 v226, a122
    v_accvgpr_read_b32 v227, a123
    v_mul_f32 v224, v224, v54
    v_mul_f32 v225, v225, v54
    v_mul_f32 v226, v226, v54
    v_mul_f32 v227, v227, v54
    v_accvgpr_write_b32 a120, v224
    v_accvgpr_write_b32 a121, v225
    v_accvgpr_write_b32 a122, v226
    v_accvgpr_write_b32 a123, v227
    v_accvgpr_read_b32 v224, a124
    v_accvgpr_read_b32 v225, a125
    v_accvgpr_read_b32 v226, a126
    v_accvgpr_read_b32 v227, a127
    v_mul_f32 v224, v224, v55
    v_mul_f32 v225, v225, v55
    v_mul_f32 v226, v226, v55
    v_mul_f32 v227, v227, v55
    v_accvgpr_write_b32 a124, v224
    v_accvgpr_write_b32 a125, v225
    v_accvgpr_write_b32 a126, v226
    v_accvgpr_write_b32 a127, v227
    v_exp_f32 v232, v128
    v_exp_f32 v233, v129
    v_exp_f32 v234, v130
    v_exp_f32 v235, v131
    s_nop 0
    v_cvt_pk_bf16_f32 v192, v232, v233
    v_cvt_pk_bf16_f32 v193, v234, v235
    v_exp_f32 v232, v144
    v_exp_f32 v233, v145
    v_exp_f32 v234, v146
    v_exp_f32 v235, v147
    s_nop 0
    v_cvt_pk_bf16_f32 v194, v232, v233
    v_cvt_pk_bf16_f32 v195, v234, v235
    v_exp_f32 v232, v132
    v_exp_f32 v233, v133
    v_exp_f32 v234, v134
    v_exp_f32 v235, v135
    s_nop 0
    v_cvt_pk_bf16_f32 v196, v232, v233
    v_cvt_pk_bf16_f32 v197, v234, v235
    v_exp_f32 v232, v148
    v_exp_f32 v233, v149
    v_exp_f32 v234, v150
    v_exp_f32 v235, v151
    s_nop 0
    v_cvt_pk_bf16_f32 v198, v232, v233
    v_cvt_pk_bf16_f32 v199, v234, v235
    v_exp_f32 v232, v136
    v_exp_f32 v233, v137
    v_exp_f32 v234, v138
    v_exp_f32 v235, v139
    s_nop 0
    v_cvt_pk_bf16_f32 v200, v232, v233
    v_cvt_pk_bf16_f32 v201, v234, v235
    v_exp_f32 v232, v152
    v_exp_f32 v233, v153
    v_exp_f32 v234, v154
    v_exp_f32 v235, v155
    s_nop 0
    v_cvt_pk_bf16_f32 v202, v232, v233
    v_cvt_pk_bf16_f32 v203, v234, v235
    v_exp_f32 v232, v140
    v_exp_f32 v233, v141
    v_exp_f32 v234, v142
    v_exp_f32 v235, v143
    s_nop 0
    v_cvt_pk_bf16_f32 v204, v232, v233
    v_cvt_pk_bf16_f32 v205, v234, v235
    v_exp_f32 v232, v156
    v_exp_f32 v233, v157
    v_exp_f32 v234, v158
    v_exp_f32 v235, v159
    s_nop 0
    v_cvt_pk_bf16_f32 v206, v232, v233
    v_cvt_pk_bf16_f32 v207, v234, v235
    s_nop 3
    s_setpc_b64 s[40:41]
k2_rare_153:
    s_nop 7
    v_max_f32 v52, v160, v161
    v_max3_f32 v52, v52, v162, v163
    v_max3_f32 v52, v52, v176, v177
    v_max3_f32 v52, v52, v178, v179
    v_max_f32 v53, v164, v165
    v_max3_f32 v53, v53, v166, v167
    v_max3_f32 v53, v53, v180, v181
    v_max3_f32 v53, v53, v182, v183
    v_max_f32 v54, v168, v169
    v_max3_f32 v54, v54, v170, v171
    v_max3_f32 v54, v54, v184, v185
    v_max3_f32 v54, v54, v186, v187
    v_max_f32 v55, v172, v173
    v_max3_f32 v55, v55, v174, v175
    v_max3_f32 v55, v55, v188, v189
    v_max3_f32 v55, v55, v190, v191
    v_mov_b32 v224, v52
    v_mov_b32 v225, v53
    v_mov_b32 v226, v54
    v_mov_b32 v227, v55
    s_nop 1
    v_permlane16_swap_b32 v52, v224
    v_permlane16_swap_b32 v53, v225
    v_permlane16_swap_b32 v54, v226
    v_permlane16_swap_b32 v55, v227
    s_nop 1
    v_max_f32 v52, v52, v224
    v_max_f32 v53, v53, v225
    v_max_f32 v54, v54, v226
    v_max_f32 v55, v55, v227
    v_mov_b32 v224, v52
    v_mov_b32 v225, v53
    v_mov_b32 v226, v54
    v_mov_b32 v227, v55
    s_nop 1
    v_permlane32_swap_b32 v52, v224
    v_permlane32_swap_b32 v53, v225
    v_permlane32_swap_b32 v54, v226
    v_permlane32_swap_b32 v55, v227
    s_nop 1
    v_max_f32 v52, v52, v224
    v_max_f32 v53, v53, v225
    v_max_f32 v54, v54, v226
    v_max_f32 v55, v55, v227
    v_add_f32 v52, 0x41400000, v52
    v_max_f32 v52, 0, v52
    v_add_f32 v53, 0x41400000, v53
    v_max_f32 v53, 0, v53
    v_add_f32 v54, 0x41400000, v54
    v_max_f32 v54, 0, v54
    v_add_f32 v55, 0x41400000, v55
    v_max_f32 v55, 0, v55
    v_sub_f32 v160, v160, v52
    v_sub_f32 v161, v161, v52
    v_sub_f32 v162, v162, v52
    v_sub_f32 v163, v163, v52
    v_sub_f32 v164, v164, v53
    v_sub_f32 v165, v165, v53
    v_sub_f32 v166, v166, v53
    v_sub_f32 v167, v167, v53
    v_sub_f32 v168, v168, v54
    v_sub_f32 v169, v169, v54
    v_sub_f32 v170, v170, v54
    v_sub_f32 v171, v171, v54
    v_sub_f32 v172, v172, v55
    v_sub_f32 v173, v173, v55
    v_sub_f32 v174, v174, v55
    v_sub_f32 v175, v175, v55
    v_sub_f32 v176, v176, v52
    v_sub_f32 v177, v177, v52
    v_sub_f32 v178, v178, v52
    v_sub_f32 v179, v179, v52
    v_sub_f32 v180, v180, v53
    v_sub_f32 v181, v181, v53
    v_sub_f32 v182, v182, v53
    v_sub_f32 v183, v183, v53
    v_sub_f32 v184, v184, v54
    v_sub_f32 v185, v185, v54
    v_sub_f32 v186, v186, v54
    v_sub_f32 v187, v187, v54
    v_sub_f32 v188, v188, v55
    v_sub_f32 v189, v189, v55
    v_sub_f32 v190, v190, v55
    v_sub_f32 v191, v191, v55
    v_sub_f32 v128, v128, v52
    v_sub_f32 v16, v16, v52
    v_sub_f32 v129, v129, v52
    v_sub_f32 v17, v17, v52
    v_sub_f32 v130, v130, v52
    v_sub_f32 v18, v18, v52
    v_sub_f32 v131, v131, v52
    v_sub_f32 v19, v19, v52
    v_sub_f32 v132, v132, v53
    v_sub_f32 v20, v20, v53
    v_sub_f32 v133, v133, v53
    v_sub_f32 v21, v21, v53
    v_sub_f32 v134, v134, v53
    v_sub_f32 v22, v22, v53
    v_sub_f32 v135, v135, v53
    v_sub_f32 v23, v23, v53
    v_sub_f32 v136, v136, v54
    v_sub_f32 v24, v24, v54
    v_sub_f32 v137, v137, v54
    v_sub_f32 v25, v25, v54
    v_sub_f32 v138, v138, v54
    v_sub_f32 v26, v26, v54
    v_sub_f32 v139, v139, v54
    v_sub_f32 v27, v27, v54
    v_sub_f32 v140, v140, v55
    v_sub_f32 v28, v28, v55
    v_sub_f32 v141, v141, v55
    v_sub_f32 v29, v29, v55
    v_sub_f32 v142, v142, v55
    v_sub_f32 v30, v30, v55
    v_sub_f32 v143, v143, v55
    v_sub_f32 v31, v31, v55
    v_sub_f32 v144, v144, v52
    v_sub_f32 v32, v32, v52
    v_sub_f32 v145, v145, v52
    v_sub_f32 v33, v33, v52
    v_sub_f32 v146, v146, v52
    v_sub_f32 v34, v34, v52
    v_sub_f32 v147, v147, v52
    v_sub_f32 v35, v35, v52
    v_sub_f32 v148, v148, v53
    v_sub_f32 v36, v36, v53
    v_sub_f32 v149, v149, v53
    v_sub_f32 v37, v37, v53
    v_sub_f32 v150, v150, v53
    v_sub_f32 v38, v38, v53
    v_sub_f32 v151, v151, v53
    v_sub_f32 v39, v39, v53
    v_sub_f32 v152, v152, v54
    v_sub_f32 v40, v40, v54
    v_sub_f32 v153, v153, v54
    v_sub_f32 v41, v41, v54
    v_sub_f32 v154, v154, v54
    v_sub_f32 v42, v42, v54
    v_sub_f32 v155, v155, v54
    v_sub_f32 v43, v43, v54
    v_sub_f32 v156, v156, v55
    v_sub_f32 v44, v44, v55
    v_sub_f32 v157, v157, v55
    v_sub_f32 v45, v45, v55
    v_sub_f32 v158, v158, v55
    v_sub_f32 v46, v46, v55
    v_sub_f32 v159, v159, v55
    v_sub_f32 v47, v47, v55
    v_sub_f32 v8, v8, v52
    v_exp_f32 v52, -v52
    v_sub_f32 v9, v9, v53
    v_exp_f32 v53, -v53
    v_sub_f32 v10, v10, v54
    v_exp_f32 v54, -v54
    v_sub_f32 v11, v11, v55
    v_exp_f32 v55, -v55
    s_nop 0
    v_mul_f32 v12, v12, v52
    v_mul_f32 v48, v48, v53
    v_mul_f32 v248, v248, v54
    v_mul_f32 v252, v252, v55
    v_accvgpr_read_b32 v224, a0
    v_accvgpr_read_b32 v225, a1
    v_accvgpr_read_b32 v226, a2
    v_accvgpr_read_b32 v227, a3
    v_mul_f32 v224, v224, v52
    v_mul_f32 v225, v225, v52
    v_mul_f32 v226, v226, v52
    v_mul_f32 v227, v227, v52
    v_accvgpr_write_b32 a0, v224
    v_accvgpr_write_b32 a1, v225
    v_accvgpr_write_b32 a2, v226
    v_accvgpr_write_b32 a3, v227
    v_accvgpr_read_b32 v224, a4
    v_accvgpr_read_b32 v225, a5
    v_accvgpr_read_b32 v226, a6
    v_accvgpr_read_b32 v227, a7
    v_mul_f32 v224, v224, v53
    v_mul_f32 v225, v225, v53
    v_mul_f32 v226, v226, v53
    v_mul_f32 v227, v227, v53
    v_accvgpr_write_b32 a4, v224
    v_accvgpr_write_b32 a5, v225
    v_accvgpr_write_b32 a6, v226
    v_accvgpr_write_b32 a7, v227
    v_accvgpr_read_b32 v224, a8
    v_accvgpr_read_b32 v225, a9
    v_accvgpr_read_b32 v226, a10
    v_accvgpr_read_b32 v227, a11
    v_mul_f32 v224, v224, v54
    v_mul_f32 v225, v225, v54
    v_mul_f32 v226, v226, v54
    v_mul_f32 v227, v227, v54
    v_accvgpr_write_b32 a8, v224
    v_accvgpr_write_b32 a9, v225
    v_accvgpr_write_b32 a10, v226
    v_accvgpr_write_b32 a11, v227
    v_accvgpr_read_b32 v224, a12
    v_accvgpr_read_b32 v225, a13
    v_accvgpr_read_b32 v226, a14
    v_accvgpr_read_b32 v227, a15
    v_mul_f32 v224, v224, v55
    v_mul_f32 v225, v225, v55
    v_mul_f32 v226, v226, v55
    v_mul_f32 v227, v227, v55
    v_accvgpr_write_b32 a12, v224
    v_accvgpr_write_b32 a13, v225
    v_accvgpr_write_b32 a14, v226
    v_accvgpr_write_b32 a15, v227
    v_accvgpr_read_b32 v224, a16
    v_accvgpr_read_b32 v225, a17
    v_accvgpr_read_b32 v226, a18
    v_accvgpr_read_b32 v227, a19
    v_mul_f32 v224, v224, v52
    v_mul_f32 v225, v225, v52
    v_mul_f32 v226, v226, v52
    v_mul_f32 v227, v227, v52
    v_accvgpr_write_b32 a16, v224
    v_accvgpr_write_b32 a17, v225
    v_accvgpr_write_b32 a18, v226
    v_accvgpr_write_b32 a19, v227
    v_accvgpr_read_b32 v224, a20
    v_accvgpr_read_b32 v225, a21
    v_accvgpr_read_b32 v226, a22
    v_accvgpr_read_b32 v227, a23
    v_mul_f32 v224, v224, v53
    v_mul_f32 v225, v225, v53
    v_mul_f32 v226, v226, v53
    v_mul_f32 v227, v227, v53
    v_accvgpr_write_b32 a20, v224
    v_accvgpr_write_b32 a21, v225
    v_accvgpr_write_b32 a22, v226
    v_accvgpr_write_b32 a23, v227
    v_accvgpr_read_b32 v224, a24
    v_accvgpr_read_b32 v225, a25
    v_accvgpr_read_b32 v226, a26
    v_accvgpr_read_b32 v227, a27
    v_mul_f32 v224, v224, v54
    v_mul_f32 v225, v225, v54
    v_mul_f32 v226, v226, v54
    v_mul_f32 v227, v227, v54
    v_accvgpr_write_b32 a24, v224
    v_accvgpr_write_b32 a25, v225
    v_accvgpr_write_b32 a26, v226
    v_accvgpr_write_b32 a27, v227
    v_accvgpr_read_b32 v224, a28
    v_accvgpr_read_b32 v225, a29
    v_accvgpr_read_b32 v226, a30
    v_accvgpr_read_b32 v227, a31
    v_mul_f32 v224, v224, v55
    v_mul_f32 v225, v225, v55
    v_mul_f32 v226, v226, v55
    v_mul_f32 v227, v227, v55
    v_accvgpr_write_b32 a28, v224
    v_accvgpr_write_b32 a29, v225
    v_accvgpr_write_b32 a30, v226
    v_accvgpr_write_b32 a31, v227
    v_accvgpr_read_b32 v224, a32
    v_accvgpr_read_b32 v225, a33
    v_accvgpr_read_b32 v226, a34
    v_accvgpr_read_b32 v227, a35
    v_mul_f32 v224, v224, v52
    v_mul_f32 v225, v225, v52
    v_mul_f32 v226, v226, v52
    v_mul_f32 v227, v227, v52
    v_accvgpr_write_b32 a32, v224
    v_accvgpr_write_b32 a33, v225
    v_accvgpr_write_b32 a34, v226
    v_accvgpr_write_b32 a35, v227
    v_accvgpr_read_b32 v224, a36
    v_accvgpr_read_b32 v225, a37
    v_accvgpr_read_b32 v226, a38
    v_accvgpr_read_b32 v227, a39
    v_mul_f32 v224, v224, v53
    v_mul_f32 v225, v225, v53
    v_mul_f32 v226, v226, v53
    v_mul_f32 v227, v227, v53
    v_accvgpr_write_b32 a36, v224
    v_accvgpr_write_b32 a37, v225
    v_accvgpr_write_b32 a38, v226
    v_accvgpr_write_b32 a39, v227
    v_accvgpr_read_b32 v224, a40
    v_accvgpr_read_b32 v225, a41
    v_accvgpr_read_b32 v226, a42
    v_accvgpr_read_b32 v227, a43
    v_mul_f32 v224, v224, v54
    v_mul_f32 v225, v225, v54
    v_mul_f32 v226, v226, v54
    v_mul_f32 v227, v227, v54
    v_accvgpr_write_b32 a40, v224
    v_accvgpr_write_b32 a41, v225
    v_accvgpr_write_b32 a42, v226
    v_accvgpr_write_b32 a43, v227
    v_accvgpr_read_b32 v224, a44
    v_accvgpr_read_b32 v225, a45
    v_accvgpr_read_b32 v226, a46
    v_accvgpr_read_b32 v227, a47
    v_mul_f32 v224, v224, v55
    v_mul_f32 v225, v225, v55
    v_mul_f32 v226, v226, v55
    v_mul_f32 v227, v227, v55
    v_accvgpr_write_b32 a44, v224
    v_accvgpr_write_b32 a45, v225
    v_accvgpr_write_b32 a46, v226
    v_accvgpr_write_b32 a47, v227
    v_accvgpr_read_b32 v224, a48
    v_accvgpr_read_b32 v225, a49
    v_accvgpr_read_b32 v226, a50
    v_accvgpr_read_b32 v227, a51
    v_mul_f32 v224, v224, v52
    v_mul_f32 v225, v225, v52
    v_mul_f32 v226, v226, v52
    v_mul_f32 v227, v227, v52
    v_accvgpr_write_b32 a48, v224
    v_accvgpr_write_b32 a49, v225
    v_accvgpr_write_b32 a50, v226
    v_accvgpr_write_b32 a51, v227
    v_accvgpr_read_b32 v224, a52
    v_accvgpr_read_b32 v225, a53
    v_accvgpr_read_b32 v226, a54
    v_accvgpr_read_b32 v227, a55
    v_mul_f32 v224, v224, v53
    v_mul_f32 v225, v225, v53
    v_mul_f32 v226, v226, v53
    v_mul_f32 v227, v227, v53
    v_accvgpr_write_b32 a52, v224
    v_accvgpr_write_b32 a53, v225
    v_accvgpr_write_b32 a54, v226
    v_accvgpr_write_b32 a55, v227
    v_accvgpr_read_b32 v224, a56
    v_accvgpr_read_b32 v225, a57
    v_accvgpr_read_b32 v226, a58
    v_accvgpr_read_b32 v227, a59
    v_mul_f32 v224, v224, v54
    v_mul_f32 v225, v225, v54
    v_mul_f32 v226, v226, v54
    v_mul_f32 v227, v227, v54
    v_accvgpr_write_b32 a56, v224
    v_accvgpr_write_b32 a57, v225
    v_accvgpr_write_b32 a58, v226
    v_accvgpr_write_b32 a59, v227
    v_accvgpr_read_b32 v224, a60
    v_accvgpr_read_b32 v225, a61
    v_accvgpr_read_b32 v226, a62
    v_accvgpr_read_b32 v227, a63
    v_mul_f32 v224, v224, v55
    v_mul_f32 v225, v225, v55
    v_mul_f32 v226, v226, v55
    v_mul_f32 v227, v227, v55
    v_accvgpr_write_b32 a60, v224
    v_accvgpr_write_b32 a61, v225
    v_accvgpr_write_b32 a62, v226
    v_accvgpr_write_b32 a63, v227
    v_accvgpr_read_b32 v224, a64
    v_accvgpr_read_b32 v225, a65
    v_accvgpr_read_b32 v226, a66
    v_accvgpr_read_b32 v227, a67
    v_mul_f32 v224, v224, v52
    v_mul_f32 v225, v225, v52
    v_mul_f32 v226, v226, v52
    v_mul_f32 v227, v227, v52
    v_accvgpr_write_b32 a64, v224
    v_accvgpr_write_b32 a65, v225
    v_accvgpr_write_b32 a66, v226
    v_accvgpr_write_b32 a67, v227
    v_accvgpr_read_b32 v224, a68
    v_accvgpr_read_b32 v225, a69
    v_accvgpr_read_b32 v226, a70
    v_accvgpr_read_b32 v227, a71
    v_mul_f32 v224, v224, v53
    v_mul_f32 v225, v225, v53
    v_mul_f32 v226, v226, v53
    v_mul_f32 v227, v227, v53
    v_accvgpr_write_b32 a68, v224
    v_accvgpr_write_b32 a69, v225
    v_accvgpr_write_b32 a70, v226
    v_accvgpr_write_b32 a71, v227
    v_accvgpr_read_b32 v224, a72
    v_accvgpr_read_b32 v225, a73
    v_accvgpr_read_b32 v226, a74
    v_accvgpr_read_b32 v227, a75
    v_mul_f32 v224, v224, v54
    v_mul_f32 v225, v225, v54
    v_mul_f32 v226, v226, v54
    v_mul_f32 v227, v227, v54
    v_accvgpr_write_b32 a72, v224
    v_accvgpr_write_b32 a73, v225
    v_accvgpr_write_b32 a74, v226
    v_accvgpr_write_b32 a75, v227
    v_accvgpr_read_b32 v224, a76
    v_accvgpr_read_b32 v225, a77
    v_accvgpr_read_b32 v226, a78
    v_accvgpr_read_b32 v227, a79
    v_mul_f32 v224, v224, v55
    v_mul_f32 v225, v225, v55
    v_mul_f32 v226, v226, v55
    v_mul_f32 v227, v227, v55
    v_accvgpr_write_b32 a76, v224
    v_accvgpr_write_b32 a77, v225
    v_accvgpr_write_b32 a78, v226
    v_accvgpr_write_b32 a79, v227
    v_accvgpr_read_b32 v224, a80
    v_accvgpr_read_b32 v225, a81
    v_accvgpr_read_b32 v226, a82
    v_accvgpr_read_b32 v227, a83
    v_mul_f32 v224, v224, v52
    v_mul_f32 v225, v225, v52
    v_mul_f32 v226, v226, v52
    v_mul_f32 v227, v227, v52
    v_accvgpr_write_b32 a80, v224
    v_accvgpr_write_b32 a81, v225
    v_accvgpr_write_b32 a82, v226
    v_accvgpr_write_b32 a83, v227
    v_accvgpr_read_b32 v224, a84
    v_accvgpr_read_b32 v225, a85
    v_accvgpr_read_b32 v226, a86
    v_accvgpr_read_b32 v227, a87
    v_mul_f32 v224, v224, v53
    v_mul_f32 v225, v225, v53
    v_mul_f32 v226, v226, v53
    v_mul_f32 v227, v227, v53
    v_accvgpr_write_b32 a84, v224
    v_accvgpr_write_b32 a85, v225
    v_accvgpr_write_b32 a86, v226
    v_accvgpr_write_b32 a87, v227
    v_accvgpr_read_b32 v224, a88
    v_accvgpr_read_b32 v225, a89
    v_accvgpr_read_b32 v226, a90
    v_accvgpr_read_b32 v227, a91
    v_mul_f32 v224, v224, v54
    v_mul_f32 v225, v225, v54
    v_mul_f32 v226, v226, v54
    v_mul_f32 v227, v227, v54
    v_accvgpr_write_b32 a88, v224
    v_accvgpr_write_b32 a89, v225
    v_accvgpr_write_b32 a90, v226
    v_accvgpr_write_b32 a91, v227
    v_accvgpr_read_b32 v224, a92
    v_accvgpr_read_b32 v225, a93
    v_accvgpr_read_b32 v226, a94
    v_accvgpr_read_b32 v227, a95
    v_mul_f32 v224, v224, v55
    v_mul_f32 v225, v225, v55
    v_mul_f32 v226, v226, v55
    v_mul_f32 v227, v227, v55
    v_accvgpr_write_b32 a92, v224
    v_accvgpr_write_b32 a93, v225
    v_accvgpr_write_b32 a94, v226
    v_accvgpr_write_b32 a95, v227
    v_accvgpr_read_b32 v224, a96
    v_accvgpr_read_b32 v225, a97
    v_accvgpr_read_b32 v226, a98
    v_accvgpr_read_b32 v227, a99
    v_mul_f32 v224, v224, v52
    v_mul_f32 v225, v225, v52
    v_mul_f32 v226, v226, v52
    v_mul_f32 v227, v227, v52
    v_accvgpr_write_b32 a96, v224
    v_accvgpr_write_b32 a97, v225
    v_accvgpr_write_b32 a98, v226
    v_accvgpr_write_b32 a99, v227
    v_accvgpr_read_b32 v224, a100
    v_accvgpr_read_b32 v225, a101
    v_accvgpr_read_b32 v226, a102
    v_accvgpr_read_b32 v227, a103
    v_mul_f32 v224, v224, v53
    v_mul_f32 v225, v225, v53
    v_mul_f32 v226, v226, v53
    v_mul_f32 v227, v227, v53
    v_accvgpr_write_b32 a100, v224
    v_accvgpr_write_b32 a101, v225
    v_accvgpr_write_b32 a102, v226
    v_accvgpr_write_b32 a103, v227
    v_accvgpr_read_b32 v224, a104
    v_accvgpr_read_b32 v225, a105
    v_accvgpr_read_b32 v226, a106
    v_accvgpr_read_b32 v227, a107
    v_mul_f32 v224, v224, v54
    v_mul_f32 v225, v225, v54
    v_mul_f32 v226, v226, v54
    v_mul_f32 v227, v227, v54
    v_accvgpr_write_b32 a104, v224
    v_accvgpr_write_b32 a105, v225
    v_accvgpr_write_b32 a106, v226
    v_accvgpr_write_b32 a107, v227
    v_accvgpr_read_b32 v224, a108
    v_accvgpr_read_b32 v225, a109
    v_accvgpr_read_b32 v226, a110
    v_accvgpr_read_b32 v227, a111
    v_mul_f32 v224, v224, v55
    v_mul_f32 v225, v225, v55
    v_mul_f32 v226, v226, v55
    v_mul_f32 v227, v227, v55
    v_accvgpr_write_b32 a108, v224
    v_accvgpr_write_b32 a109, v225
    v_accvgpr_write_b32 a110, v226
    v_accvgpr_write_b32 a111, v227
    v_accvgpr_read_b32 v224, a112
    v_accvgpr_read_b32 v225, a113
    v_accvgpr_read_b32 v226, a114
    v_accvgpr_read_b32 v227, a115
    v_mul_f32 v224, v224, v52
    v_mul_f32 v225, v225, v52
    v_mul_f32 v226, v226, v52
    v_mul_f32 v227, v227, v52
    v_accvgpr_write_b32 a112, v224
    v_accvgpr_write_b32 a113, v225
    v_accvgpr_write_b32 a114, v226
    v_accvgpr_write_b32 a115, v227
    v_accvgpr_read_b32 v224, a116
    v_accvgpr_read_b32 v225, a117
    v_accvgpr_read_b32 v226, a118
    v_accvgpr_read_b32 v227, a119
    v_mul_f32 v224, v224, v53
    v_mul_f32 v225, v225, v53
    v_mul_f32 v226, v226, v53
    v_mul_f32 v227, v227, v53
    v_accvgpr_write_b32 a116, v224
    v_accvgpr_write_b32 a117, v225
    v_accvgpr_write_b32 a118, v226
    v_accvgpr_write_b32 a119, v227
    v_accvgpr_read_b32 v224, a120
    v_accvgpr_read_b32 v225, a121
    v_accvgpr_read_b32 v226, a122
    v_accvgpr_read_b32 v227, a123
    v_mul_f32 v224, v224, v54
    v_mul_f32 v225, v225, v54
    v_mul_f32 v226, v226, v54
    v_mul_f32 v227, v227, v54
    v_accvgpr_write_b32 a120, v224
    v_accvgpr_write_b32 a121, v225
    v_accvgpr_write_b32 a122, v226
    v_accvgpr_write_b32 a123, v227
    v_accvgpr_read_b32 v224, a124
    v_accvgpr_read_b32 v225, a125
    v_accvgpr_read_b32 v226, a126
    v_accvgpr_read_b32 v227, a127
    v_mul_f32 v224, v224, v55
    v_mul_f32 v225, v225, v55
    v_mul_f32 v226, v226, v55
    v_mul_f32 v227, v227, v55
    v_accvgpr_write_b32 a124, v224
    v_accvgpr_write_b32 a125, v225
    v_accvgpr_write_b32 a126, v226
    v_accvgpr_write_b32 a127, v227
    v_exp_f32 v232, v160
    v_exp_f32 v233, v161
    v_exp_f32 v234, v162
    v_exp_f32 v235, v163
    s_nop 0
    v_cvt_pk_bf16_f32 v208, v232, v233
    v_cvt_pk_bf16_f32 v209, v234, v235
    v_exp_f32 v232, v176
    v_exp_f32 v233, v177
    v_exp_f32 v234, v178
    v_exp_f32 v235, v179
    s_nop 0
    v_cvt_pk_bf16_f32 v210, v232, v233
    v_cvt_pk_bf16_f32 v211, v234, v235
    v_exp_f32 v232, v164
    v_exp_f32 v233, v165
    v_exp_f32 v234, v166
    v_exp_f32 v235, v167
    s_nop 0
    v_cvt_pk_bf16_f32 v212, v232, v233
    v_cvt_pk_bf16_f32 v213, v234, v235
    v_exp_f32 v232, v180
    v_exp_f32 v233, v181
    v_exp_f32 v234, v182
    v_exp_f32 v235, v183
    s_nop 0
    v_cvt_pk_bf16_f32 v214, v232, v233
    v_cvt_pk_bf16_f32 v215, v234, v235
    v_exp_f32 v232, v168
    v_exp_f32 v233, v169
    v_exp_f32 v234, v170
    v_exp_f32 v235, v171
    s_nop 0
    v_cvt_pk_bf16_f32 v216, v232, v233
    v_cvt_pk_bf16_f32 v217, v234, v235
    v_exp_f32 v232, v184
    v_exp_f32 v233, v185
    v_exp_f32 v234, v186
    v_exp_f32 v235, v187
    s_nop 0
    v_cvt_pk_bf16_f32 v218, v232, v233
    v_cvt_pk_bf16_f32 v219, v234, v235
    v_exp_f32 v232, v172
    v_exp_f32 v233, v173
    v_exp_f32 v234, v174
    v_exp_f32 v235, v175
    s_nop 0
    v_cvt_pk_bf16_f32 v220, v232, v233
    v_cvt_pk_bf16_f32 v221, v234, v235
    v_exp_f32 v232, v188
    v_exp_f32 v233, v189
    v_exp_f32 v234, v190
    v_exp_f32 v235, v191
    s_nop 0
    v_cvt_pk_bf16_f32 v222, v232, v233
    v_cvt_pk_bf16_f32 v223, v234, v235
    s_nop 3
    s_setpc_b64 s[40:41]
k2_rare_158:
    s_nop 7
    v_max_f32 v53, v132, v133
    v_max3_f32 v53, v53, v134, v135
    v_max3_f32 v53, v53, v148, v149
    v_max3_f32 v53, v53, v150, v151
    v_max_f32 v54, v136, v137
    v_max3_f32 v54, v54, v138, v139
    v_max3_f32 v54, v54, v152, v153
    v_max3_f32 v54, v54, v154, v155
    v_max_f32 v55, v140, v141
    v_max3_f32 v55, v55, v142, v143
    v_max3_f32 v55, v55, v156, v157
    v_max3_f32 v55, v55, v158, v159
    v_mov_b32 v225, v53
    v_mov_b32 v226, v54
    v_mov_b32 v227, v55
    s_nop 1
    v_permlane16_swap_b32 v53, v225
    v_permlane16_swap_b32 v54, v226
    v_permlane16_swap_b32 v55, v227
    s_nop 1
    v_max_f32 v53, v53, v225
    v_max_f32 v54, v54, v226
    v_max_f32 v55, v55, v227
    v_mov_b32 v225, v53
    v_mov_b32 v226, v54
    v_mov_b32 v227, v55
    s_nop 1
    v_permlane32_swap_b32 v53, v225
    v_permlane32_swap_b32 v54, v226
    v_permlane32_swap_b32 v55, v227
    s_nop 1
    v_max_f32 v53, v53, v225
    v_max_f32 v54, v54, v226
    v_max_f32 v55, v55, v227
    v_add_f32 v53, 0x41400000, v53
    v_max_f32 v53, 0, v53
    v_add_f32 v54, 0x41400000, v54
    v_max_f32 v54, 0, v54
    v_add_f32 v55, 0x41400000, v55
    v_max_f32 v55, 0, v55
    v_sub_f32 v132, v132, v53
    v_sub_f32 v133, v133, v53
    v_sub_f32 v134, v134, v53
    v_sub_f32 v135, v135, v53
    v_sub_f32 v136, v136, v54
    v_sub_f32 v137, v137, v54
    v_sub_f32 v138, v138, v54
    v_sub_f32 v139, v139, v54
    v_sub_f32 v140, v140, v55
    v_sub_f32 v141, v141, v55
    v_sub_f32 v142, v142, v55
    v_sub_f32 v143, v143, v55
    v_sub_f32 v148, v148, v53
    v_sub_f32 v149, v149, v53
    v_sub_f32 v150, v150, v53
    v_sub_f32 v151, v151, v53
    v_sub_f32 v152, v152, v54
    v_sub_f32 v153, v153, v54
    v_sub_f32 v154, v154, v54
    v_sub_f32 v155, v155, v54
    v_sub_f32 v156, v156, v55
    v_sub_f32 v157, v157, v55
    v_sub_f32 v158, v158, v55
    v_sub_f32 v159, v159, v55
    v_sub_f32 v164, v164, v53
    v_sub_f32 v20, v20, v53
    v_sub_f32 v165, v165, v53
    v_sub_f32 v21, v21, v53
    v_sub_f32 v166, v166, v53
    v_sub_f32 v22, v22, v53
    v_sub_f32 v167, v167, v53
    v_sub_f32 v23, v23, v53
    v_sub_f32 v168, v168, v54
    v_sub_f32 v24, v24, v54
    v_sub_f32 v169, v169, v54
    v_sub_f32 v25, v25, v54
    v_sub_f32 v170, v170, v54
    v_sub_f32 v26, v26, v54
    v_sub_f32 v171, v171, v54
    v_sub_f32 v27, v27, v54
    v_sub_f32 v172, v172, v55
    v_sub_f32 v28, v28, v55
    v_sub_f32 v173, v173, v55
    v_sub_f32 v29, v29, v55
    v_sub_f32 v174, v174, v55
    v_sub_f32 v30, v30, v55
    v_sub_f32 v175, v175, v55
    v_sub_f32 v31, v31, v55
    v_sub_f32 v180, v180, v53
    v_sub_f32 v36, v36, v53
    v_sub_f32 v181, v181, v53
    v_sub_f32 v37, v37, v53
    v_sub_f32 v182, v182, v53
    v_sub_f32 v38, v38, v53
    v_sub_f32 v183, v183, v53
    v_sub_f32 v39, v39, v53
    v_sub_f32 v184, v184, v54
    v_sub_f32 v40, v40, v54
    v_sub_f32 v185, v185, v54
    v_sub_f32 v41, v41, v54
    v_sub_f32 v186, v186, v54
    v_sub_f32 v42, v42, v54
    v_sub_f32 v187, v187, v54
    v_sub_f32 v43, v43, v54
    v_sub_f32 v188, v188, v55
    v_sub_f32 v44, v44, v55
    v_sub_f32 v189, v189, v55
    v_sub_f32 v45, v45, v55
    v_sub_f32 v190, v190, v55
    v_sub_f32 v46, v46, v55
    v_sub_f32 v191, v191, v55
    v_sub_f32 v47, v47, v55
    v_sub_f32 v9, v9, v53
    v_exp_f32 v53, -v53
    v_sub_f32 v10, v10, v54
    v_exp_f32 v54, -v54
    v_sub_f32 v11, v11, v55
    v_exp_f32 v55, -v55
    s_nop 0
    v_mul_f32 v48, v48, v53
    v_mul_f32 v248, v248, v54
    v_mul_f32 v252, v252, v55
    v_accvgpr_read_b32 v224, a4
    v_accvgpr_read_b32 v225, a5
    v_accvgpr_read_b32 v226, a6
    v_accvgpr_read_b32 v227, a7
    v_mul_f32 v224, v224, v53
    v_mul_f32 v225, v225, v53
    v_mul_f32 v226, v226, v53
    v_mul_f32 v227, v227, v53
    v_accvgpr_write_b32 a4, v224
    v_accvgpr_write_b32 a5, v225
    v_accvgpr_write_b32 a6, v226
    v_accvgpr_write_b32 a7, v227
    v_accvgpr_read_b32 v224, a8
    v_accvgpr_read_b32 v225, a9
    v_accvgpr_read_b32 v226, a10
    v_accvgpr_read_b32 v227, a11
    v_mul_f32 v224, v224, v54
    v_mul_f32 v225, v225, v54
    v_mul_f32 v226, v226, v54
    v_mul_f32 v227, v227, v54
    v_accvgpr_write_b32 a8, v224
    v_accvgpr_write_b32 a9, v225
    v_accvgpr_write_b32 a10, v226
    v_accvgpr_write_b32 a11, v227
    v_accvgpr_read_b32 v224, a12
    v_accvgpr_read_b32 v225, a13
    v_accvgpr_read_b32 v226, a14
    v_accvgpr_read_b32 v227, a15
    v_mul_f32 v224, v224, v55
    v_mul_f32 v225, v225, v55
    v_mul_f32 v226, v226, v55
    v_mul_f32 v227, v227, v55
    v_accvgpr_write_b32 a12, v224
    v_accvgpr_write_b32 a13, v225
    v_accvgpr_write_b32 a14, v226
    v_accvgpr_write_b32 a15, v227
    v_accvgpr_read_b32 v224, a20
    v_accvgpr_read_b32 v225, a21
    v_accvgpr_read_b32 v226, a22
    v_accvgpr_read_b32 v227, a23
    v_mul_f32 v224, v224, v53
    v_mul_f32 v225, v225, v53
    v_mul_f32 v226, v226, v53
    v_mul_f32 v227, v227, v53
    v_accvgpr_write_b32 a20, v224
    v_accvgpr_write_b32 a21, v225
    v_accvgpr_write_b32 a22, v226
    v_accvgpr_write_b32 a23, v227
    v_accvgpr_read_b32 v224, a24
    v_accvgpr_read_b32 v225, a25
    v_accvgpr_read_b32 v226, a26
    v_accvgpr_read_b32 v227, a27
    v_mul_f32 v224, v224, v54
    v_mul_f32 v225, v225, v54
    v_mul_f32 v226, v226, v54
    v_mul_f32 v227, v227, v54
    v_accvgpr_write_b32 a24, v224
    v_accvgpr_write_b32 a25, v225
    v_accvgpr_write_b32 a26, v226
    v_accvgpr_write_b32 a27, v227
    v_accvgpr_read_b32 v224, a28
    v_accvgpr_read_b32 v225, a29
    v_accvgpr_read_b32 v226, a30
    v_accvgpr_read_b32 v227, a31
    v_mul_f32 v224, v224, v55
    v_mul_f32 v225, v225, v55
    v_mul_f32 v226, v226, v55
    v_mul_f32 v227, v227, v55
    v_accvgpr_write_b32 a28, v224
    v_accvgpr_write_b32 a29, v225
    v_accvgpr_write_b32 a30, v226
    v_accvgpr_write_b32 a31, v227
    v_accvgpr_read_b32 v224, a36
    v_accvgpr_read_b32 v225, a37
    v_accvgpr_read_b32 v226, a38
    v_accvgpr_read_b32 v227, a39
    v_mul_f32 v224, v224, v53
    v_mul_f32 v225, v225, v53
    v_mul_f32 v226, v226, v53
    v_mul_f32 v227, v227, v53
    v_accvgpr_write_b32 a36, v224
    v_accvgpr_write_b32 a37, v225
    v_accvgpr_write_b32 a38, v226
    v_accvgpr_write_b32 a39, v227
    v_accvgpr_read_b32 v224, a40
    v_accvgpr_read_b32 v225, a41
    v_accvgpr_read_b32 v226, a42
    v_accvgpr_read_b32 v227, a43
    v_mul_f32 v224, v224, v54
    v_mul_f32 v225, v225, v54
    v_mul_f32 v226, v226, v54
    v_mul_f32 v227, v227, v54
    v_accvgpr_write_b32 a40, v224
    v_accvgpr_write_b32 a41, v225
    v_accvgpr_write_b32 a42, v226
    v_accvgpr_write_b32 a43, v227
    v_accvgpr_read_b32 v224, a44
    v_accvgpr_read_b32 v225, a45
    v_accvgpr_read_b32 v226, a46
    v_accvgpr_read_b32 v227, a47
    v_mul_f32 v224, v224, v55
    v_mul_f32 v225, v225, v55
    v_mul_f32 v226, v226, v55
    v_mul_f32 v227, v227, v55
    v_accvgpr_write_b32 a44, v224
    v_accvgpr_write_b32 a45, v225
    v_accvgpr_write_b32 a46, v226
    v_accvgpr_write_b32 a47, v227
    v_accvgpr_read_b32 v224, a52
    v_accvgpr_read_b32 v225, a53
    v_accvgpr_read_b32 v226, a54
    v_accvgpr_read_b32 v227, a55
    v_mul_f32 v224, v224, v53
    v_mul_f32 v225, v225, v53
    v_mul_f32 v226, v226, v53
    v_mul_f32 v227, v227, v53
    v_accvgpr_write_b32 a52, v224
    v_accvgpr_write_b32 a53, v225
    v_accvgpr_write_b32 a54, v226
    v_accvgpr_write_b32 a55, v227
    v_accvgpr_read_b32 v224, a56
    v_accvgpr_read_b32 v225, a57
    v_accvgpr_read_b32 v226, a58
    v_accvgpr_read_b32 v227, a59
    v_mul_f32 v224, v224, v54
    v_mul_f32 v225, v225, v54
    v_mul_f32 v226, v226, v54
    v_mul_f32 v227, v227, v54
    v_accvgpr_write_b32 a56, v224
    v_accvgpr_write_b32 a57, v225
    v_accvgpr_write_b32 a58, v226
    v_accvgpr_write_b32 a59, v227
    v_accvgpr_read_b32 v224, a60
    v_accvgpr_read_b32 v225, a61
    v_accvgpr_read_b32 v226, a62
    v_accvgpr_read_b32 v227, a63
    v_mul_f32 v224, v224, v55
    v_mul_f32 v225, v225, v55
    v_mul_f32 v226, v226, v55
    v_mul_f32 v227, v227, v55
    v_accvgpr_write_b32 a60, v224
    v_accvgpr_write_b32 a61, v225
    v_accvgpr_write_b32 a62, v226
    v_accvgpr_write_b32 a63, v227
    v_accvgpr_read_b32 v224, a68
    v_accvgpr_read_b32 v225, a69
    v_accvgpr_read_b32 v226, a70
    v_accvgpr_read_b32 v227, a71
    v_mul_f32 v224, v224, v53
    v_mul_f32 v225, v225, v53
    v_mul_f32 v226, v226, v53
    v_mul_f32 v227, v227, v53
    v_accvgpr_write_b32 a68, v224
    v_accvgpr_write_b32 a69, v225
    v_accvgpr_write_b32 a70, v226
    v_accvgpr_write_b32 a71, v227
    v_accvgpr_read_b32 v224, a72
    v_accvgpr_read_b32 v225, a73
    v_accvgpr_read_b32 v226, a74
    v_accvgpr_read_b32 v227, a75
    v_mul_f32 v224, v224, v54
    v_mul_f32 v225, v225, v54
    v_mul_f32 v226, v226, v54
    v_mul_f32 v227, v227, v54
    v_accvgpr_write_b32 a72, v224
    v_accvgpr_write_b32 a73, v225
    v_accvgpr_write_b32 a74, v226
    v_accvgpr_write_b32 a75, v227
    v_accvgpr_read_b32 v224, a76
    v_accvgpr_read_b32 v225, a77
    v_accvgpr_read_b32 v226, a78
    v_accvgpr_read_b32 v227, a79
    v_mul_f32 v224, v224, v55
    v_mul_f32 v225, v225, v55
    v_mul_f32 v226, v226, v55
    v_mul_f32 v227, v227, v55
    v_accvgpr_write_b32 a76, v224
    v_accvgpr_write_b32 a77, v225
    v_accvgpr_write_b32 a78, v226
    v_accvgpr_write_b32 a79, v227
    v_accvgpr_read_b32 v224, a84
    v_accvgpr_read_b32 v225, a85
    v_accvgpr_read_b32 v226, a86
    v_accvgpr_read_b32 v227, a87
    v_mul_f32 v224, v224, v53
    v_mul_f32 v225, v225, v53
    v_mul_f32 v226, v226, v53
    v_mul_f32 v227, v227, v53
    v_accvgpr_write_b32 a84, v224
    v_accvgpr_write_b32 a85, v225
    v_accvgpr_write_b32 a86, v226
    v_accvgpr_write_b32 a87, v227
    v_accvgpr_read_b32 v224, a88
    v_accvgpr_read_b32 v225, a89
    v_accvgpr_read_b32 v226, a90
    v_accvgpr_read_b32 v227, a91
    v_mul_f32 v224, v224, v54
    v_mul_f32 v225, v225, v54
    v_mul_f32 v226, v226, v54
    v_mul_f32 v227, v227, v54
    v_accvgpr_write_b32 a88, v224
    v_accvgpr_write_b32 a89, v225
    v_accvgpr_write_b32 a90, v226
    v_accvgpr_write_b32 a91, v227
    v_accvgpr_read_b32 v224, a92
    v_accvgpr_read_b32 v225, a93
    v_accvgpr_read_b32 v226, a94
    v_accvgpr_read_b32 v227, a95
    v_mul_f32 v224, v224, v55
    v_mul_f32 v225, v225, v55
    v_mul_f32 v226, v226, v55
    v_mul_f32 v227, v227, v55
    v_accvgpr_write_b32 a92, v224
    v_accvgpr_write_b32 a93, v225
    v_accvgpr_write_b32 a94, v226
    v_accvgpr_write_b32 a95, v227
    v_accvgpr_read_b32 v224, a100
    v_accvgpr_read_b32 v225, a101
    v_accvgpr_read_b32 v226, a102
    v_accvgpr_read_b32 v227, a103
    v_mul_f32 v224, v224, v53
    v_mul_f32 v225, v225, v53
    v_mul_f32 v226, v226, v53
    v_mul_f32 v227, v227, v53
    v_accvgpr_write_b32 a100, v224
    v_accvgpr_write_b32 a101, v225
    v_accvgpr_write_b32 a102, v226
    v_accvgpr_write_b32 a103, v227
    v_accvgpr_read_b32 v224, a104
    v_accvgpr_read_b32 v225, a105
    v_accvgpr_read_b32 v226, a106
    v_accvgpr_read_b32 v227, a107
    v_mul_f32 v224, v224, v54
    v_mul_f32 v225, v225, v54
    v_mul_f32 v226, v226, v54
    v_mul_f32 v227, v227, v54
    v_accvgpr_write_b32 a104, v224
    v_accvgpr_write_b32 a105, v225
    v_accvgpr_write_b32 a106, v226
    v_accvgpr_write_b32 a107, v227
    v_accvgpr_read_b32 v224, a108
    v_accvgpr_read_b32 v225, a109
    v_accvgpr_read_b32 v226, a110
    v_accvgpr_read_b32 v227, a111
    v_mul_f32 v224, v224, v55
    v_mul_f32 v225, v225, v55
    v_mul_f32 v226, v226, v55
    v_mul_f32 v227, v227, v55
    v_accvgpr_write_b32 a108, v224
    v_accvgpr_write_b32 a109, v225
    v_accvgpr_write_b32 a110, v226
    v_accvgpr_write_b32 a111, v227
    v_accvgpr_read_b32 v224, a116
    v_accvgpr_read_b32 v225, a117
    v_accvgpr_read_b32 v226, a118
    v_accvgpr_read_b32 v227, a119
    v_mul_f32 v224, v224, v53
    v_mul_f32 v225, v225, v53
    v_mul_f32 v226, v226, v53
    v_mul_f32 v227, v227, v53
    v_accvgpr_write_b32 a116, v224
    v_accvgpr_write_b32 a117, v225
    v_accvgpr_write_b32 a118, v226
    v_accvgpr_write_b32 a119, v227
    v_accvgpr_read_b32 v224, a120
    v_accvgpr_read_b32 v225, a121
    v_accvgpr_read_b32 v226, a122
    v_accvgpr_read_b32 v227, a123
    v_mul_f32 v224, v224, v54
    v_mul_f32 v225, v225, v54
    v_mul_f32 v226, v226, v54
    v_mul_f32 v227, v227, v54
    v_accvgpr_write_b32 a120, v224
    v_accvgpr_write_b32 a121, v225
    v_accvgpr_write_b32 a122, v226
    v_accvgpr_write_b32 a123, v227
    v_accvgpr_read_b32 v224, a124
    v_accvgpr_read_b32 v225, a125
    v_accvgpr_read_b32 v226, a126
    v_accvgpr_read_b32 v227, a127
    v_mul_f32 v224, v224, v55
    v_mul_f32 v225, v225, v55
    v_mul_f32 v226, v226, v55
    v_mul_f32 v227, v227, v55
    v_accvgpr_write_b32 a124, v224
    v_accvgpr_write_b32 a125, v225
    v_accvgpr_write_b32 a126, v226
    v_accvgpr_write_b32 a127, v227
    v_exp_f32 v232, v132
    v_exp_f32 v233, v133
    v_exp_f32 v234, v134
    v_exp_f32 v235, v135
    s_nop 0
    v_cvt_pk_bf16_f32 v196, v232, v233
    v_cvt_pk_bf16_f32 v197, v234, v235
    v_exp_f32 v232, v148
    v_exp_f32 v233, v149
    v_exp_f32 v234, v150
    v_exp_f32 v235, v151
    s_nop 0
    v_cvt_pk_bf16_f32 v198, v232, v233
    v_cvt_pk_bf16_f32 v199, v234, v235
    v_exp_f32 v232, v136
    v_exp_f32 v233, v137
    v_exp_f32 v234, v138
    v_exp_f32 v235, v139
    s_nop 0
    v_cvt_pk_bf16_f32 v200, v232, v233
    v_cvt_pk_bf16_f32 v201, v234, v235
    v_exp_f32 v232, v152
    v_exp_f32 v233, v153
    v_exp_f32 v234, v154
    v_exp_f32 v235, v155
    s_nop 0
    v_cvt_pk_bf16_f32 v202, v232, v233
    v_cvt_pk_bf16_f32 v203, v234, v235
    v_exp_f32 v232, v140
    v_exp_f32 v233, v141
    v_exp_f32 v234, v142
    v_exp_f32 v235, v143
    s_nop 0
    v_cvt_pk_bf16_f32 v204, v232, v233
    v_cvt_pk_bf16_f32 v205, v234, v235
    v_exp_f32 v232, v156
    v_exp_f32 v233, v157
    v_exp_f32 v234, v158
    v_exp_f32 v235, v159
    s_nop 0
    v_cvt_pk_bf16_f32 v206, v232, v233
    v_cvt_pk_bf16_f32 v207, v234, v235
    s_nop 3
    s_setpc_b64 s[40:41]
k2_rare_159:
    s_nop 7
    v_max_f32 v53, v164, v165
    v_max3_f32 v53, v53, v166, v167
    v_max3_f32 v53, v53, v180, v181
    v_max3_f32 v53, v53, v182, v183
    v_max_f32 v54, v168, v169
    v_max3_f32 v54, v54, v170, v171
    v_max3_f32 v54, v54, v184, v185
    v_max3_f32 v54, v54, v186, v187
    v_max_f32 v55, v172, v173
    v_max3_f32 v55, v55, v174, v175
    v_max3_f32 v55, v55, v188, v189
    v_max3_f32 v55, v55, v190, v191
    v_mov_b32 v225, v53
    v_mov_b32 v226, v54
    v_mov_b32 v227, v55
    s_nop 1
    v_permlane16_swap_b32 v53, v225
    v_permlane16_swap_b32 v54, v226
    v_permlane16_swap_b32 v55, v227
    s_nop 1
    v_max_f32 v53, v53, v225
    v_max_f32 v54, v54, v226
    v_max_f32 v55, v55, v227
    v_mov_b32 v225, v53
    v_mov_b32 v226, v54
    v_mov_b32 v227, v55
    s_nop 1
    v_permlane32_swap_b32 v53, v225
    v_permlane32_swap_b32 v54, v226
    v_permlane32_swap_b32 v55, v227
    s_nop 1
    v_max_f32 v53, v53, v225
    v_max_f32 v54, v54, v226
    v_max_f32 v55, v55, v227
    v_add_f32 v53, 0x41400000, v53
    v_max_f32 v53, 0, v53
    v_add_f32 v54, 0x41400000, v54
    v_max_f32 v54, 0, v54
    v_add_f32 v55, 0x41400000, v55
    v_max_f32 v55, 0, v55
    v_sub_f32 v164, v164, v53
    v_sub_f32 v165, v165, v53
    v_sub_f32 v166, v166, v53
    v_sub_f32 v167, v167, v53
    v_sub_f32 v168, v168, v54
    v_sub_f32 v169, v169, v54
    v_sub_f32 v170, v170, v54
    v_sub_f32 v171, v171, v54
    v_sub_f32 v172, v172, v55
    v_sub_f32 v173, v173, v55
    v_sub_f32 v174, v174, v55
    v_sub_f32 v175, v175, v55
    v_sub_f32 v180, v180, v53
    v_sub_f32 v181, v181, v53
    v_sub_f32 v182, v182, v53
    v_sub_f32 v183, v183, v53
    v_sub_f32 v184, v184, v54
    v_sub_f32 v185, v185, v54
    v_sub_f32 v186, v186, v54
    v_sub_f32 v187, v187, v54
    v_sub_f32 v188, v188, v55
    v_sub_f32 v189, v189, v55
    v_sub_f32 v190, v190, v55
    v_sub_f32 v191, v191, v55
    v_sub_f32 v128, v128, v54
    v_sub_f32 v16, v16, v54
    v_sub_f32 v129, v129, v54
    v_sub_f32 v17, v17, v54
    v_sub_f32 v130, v130, v54
    v_sub_f32 v18, v18, v54
    v_sub_f32 v131, v131, v54
    v_sub_f32 v19, v19, v54
    v_sub_f32 v132, v132, v55
    v_sub_f32 v20, v20, v55
    v_sub_f32 v133, v133, v55
    v_sub_f32 v21, v21, v55
    v_sub_f32 v134, v134, v55
    v_sub_f32 v22, v22, v55
    v_sub_f32 v135, v135, v55
    v_sub_f32 v23, v23, v55
    v_sub_f32 v136, v136, v54
    v_sub_f32 v24, v24, v54
    v_sub_f32 v137, v137, v54
    v_sub_f32 v25, v25, v54
    v_sub_f32 v138, v138, v54
    v_sub_f32 v26, v26, v54
    v_sub_f32 v139, v139, v54
    v_sub_f32 v27, v27, v54
    v_sub_f32 v140, v140, v55
    v_sub_f32 v28, v28, v55
    v_sub_f32 v141, v141, v55
    v_sub_f32 v29, v29, v55
    v_sub_f32 v142, v142, v55
    v_sub_f32 v30, v30, v55
    v_sub_f32 v143, v143, v55
    v_sub_f32 v31, v31, v55
    v_sub_f32 v144, v144, v54
    v_sub_f32 v32, v32, v54
    v_sub_f32 v145, v145, v54
    v_sub_f32 v33, v33, v54
    v_sub_f32 v146, v146, v54
    v_sub_f32 v34, v34, v54
    v_sub_f32 v147, v147, v54
    v_sub_f32 v35, v35, v54
    v_sub_f32 v148, v148, v55
    v_sub_f32 v36, v36, v55
    v_sub_f32 v149, v149, v55
    v_sub_f32 v37, v37, v55
    v_sub_f32 v150, v150, v55
    v_sub_f32 v38, v38, v55
    v_sub_f32 v151, v151, v55
    v_sub_f32 v39, v39, v55
    v_sub_f32 v152, v152, v54
    v_sub_f32 v40, v40, v54
    v_sub_f32 v153, v153, v54
    v_sub_f32 v41, v41, v54
    v_sub_f32 v154, v154, v54
    v_sub_f32 v42, v42, v54
    v_sub_f32 v155, v155, v54
    v_sub_f32 v43, v43, v54
    v_sub_f32 v156, v156, v55
    v_sub_f32 v44, v44, v55
    v_sub_f32 v157, v157, v55
    v_sub_f32 v45, v45, v55
    v_sub_f32 v158, v158, v55
    v_sub_f32 v46, v46, v55
    v_sub_f32 v159, v159, v55
    v_sub_f32 v47, v47, v55
    v_sub_f32 v9, v9, v53
    v_exp_f32 v53, -v53
    v_sub_f32 v10, v10, v54
    v_exp_f32 v54, -v54
    v_sub_f32 v11, v11, v55
    v_exp_f32 v55, -v55
    s_nop 0
    v_mul_f32 v48, v48, v53
    v_mul_f32 v248, v248, v54
    v_mul_f32 v252, v252, v55
    v_accvgpr_read_b32 v224, a4
    v_accvgpr_read_b32 v225, a5
    v_accvgpr_read_b32 v226, a6
    v_accvgpr_read_b32 v227, a7
    v_mul_f32 v224, v224, v53
    v_mul_f32 v225, v225, v53
    v_mul_f32 v226, v226, v53
    v_mul_f32 v227, v227, v53
    v_accvgpr_write_b32 a4, v224
    v_accvgpr_write_b32 a5, v225
    v_accvgpr_write_b32 a6, v226
    v_accvgpr_write_b32 a7, v227
    v_accvgpr_read_b32 v224, a8
    v_accvgpr_read_b32 v225, a9
    v_accvgpr_read_b32 v226, a10
    v_accvgpr_read_b32 v227, a11
    v_mul_f32 v224, v224, v54
    v_mul_f32 v225, v225, v54
    v_mul_f32 v226, v226, v54
    v_mul_f32 v227, v227, v54
    v_accvgpr_write_b32 a8, v224
    v_accvgpr_write_b32 a9, v225
    v_accvgpr_write_b32 a10, v226
    v_accvgpr_write_b32 a11, v227
    v_accvgpr_read_b32 v224, a12
    v_accvgpr_read_b32 v225, a13
    v_accvgpr_read_b32 v226, a14
    v_accvgpr_read_b32 v227, a15
    v_mul_f32 v224, v224, v55
    v_mul_f32 v225, v225, v55
    v_mul_f32 v226, v226, v55
    v_mul_f32 v227, v227, v55
    v_accvgpr_write_b32 a12, v224
    v_accvgpr_write_b32 a13, v225
    v_accvgpr_write_b32 a14, v226
    v_accvgpr_write_b32 a15, v227
    v_accvgpr_read_b32 v224, a20
    v_accvgpr_read_b32 v225, a21
    v_accvgpr_read_b32 v226, a22
    v_accvgpr_read_b32 v227, a23
    v_mul_f32 v224, v224, v53
    v_mul_f32 v225, v225, v53
    v_mul_f32 v226, v226, v53
    v_mul_f32 v227, v227, v53
    v_accvgpr_write_b32 a20, v224
    v_accvgpr_write_b32 a21, v225
    v_accvgpr_write_b32 a22, v226
    v_accvgpr_write_b32 a23, v227
    v_accvgpr_read_b32 v224, a24
    v_accvgpr_read_b32 v225, a25
    v_accvgpr_read_b32 v226, a26
    v_accvgpr_read_b32 v227, a27
    v_mul_f32 v224, v224, v54
    v_mul_f32 v225, v225, v54
    v_mul_f32 v226, v226, v54
    v_mul_f32 v227, v227, v54
    v_accvgpr_write_b32 a24, v224
    v_accvgpr_write_b32 a25, v225
    v_accvgpr_write_b32 a26, v226
    v_accvgpr_write_b32 a27, v227
    v_accvgpr_read_b32 v224, a28
    v_accvgpr_read_b32 v225, a29
    v_accvgpr_read_b32 v226, a30
    v_accvgpr_read_b32 v227, a31
    v_mul_f32 v224, v224, v55
    v_mul_f32 v225, v225, v55
    v_mul_f32 v226, v226, v55
    v_mul_f32 v227, v227, v55
    v_accvgpr_write_b32 a28, v224
    v_accvgpr_write_b32 a29, v225
    v_accvgpr_write_b32 a30, v226
    v_accvgpr_write_b32 a31, v227
    v_accvgpr_read_b32 v224, a36
    v_accvgpr_read_b32 v225, a37
    v_accvgpr_read_b32 v226, a38
    v_accvgpr_read_b32 v227, a39
    v_mul_f32 v224, v224, v53
    v_mul_f32 v225, v225, v53
    v_mul_f32 v226, v226, v53
    v_mul_f32 v227, v227, v53
    v_accvgpr_write_b32 a36, v224
    v_accvgpr_write_b32 a37, v225
    v_accvgpr_write_b32 a38, v226
    v_accvgpr_write_b32 a39, v227
    v_accvgpr_read_b32 v224, a40
    v_accvgpr_read_b32 v225, a41
    v_accvgpr_read_b32 v226, a42
    v_accvgpr_read_b32 v227, a43
    v_mul_f32 v224, v224, v54
    v_mul_f32 v225, v225, v54
    v_mul_f32 v226, v226, v54
    v_mul_f32 v227, v227, v54
    v_accvgpr_write_b32 a40, v224
    v_accvgpr_write_b32 a41, v225
    v_accvgpr_write_b32 a42, v226
    v_accvgpr_write_b32 a43, v227
    v_accvgpr_read_b32 v224, a44
    v_accvgpr_read_b32 v225, a45
    v_accvgpr_read_b32 v226, a46
    v_accvgpr_read_b32 v227, a47
    v_mul_f32 v224, v224, v55
    v_mul_f32 v225, v225, v55
    v_mul_f32 v226, v226, v55
    v_mul_f32 v227, v227, v55
    v_accvgpr_write_b32 a44, v224
    v_accvgpr_write_b32 a45, v225
    v_accvgpr_write_b32 a46, v226
    v_accvgpr_write_b32 a47, v227
    v_accvgpr_read_b32 v224, a52
    v_accvgpr_read_b32 v225, a53
    v_accvgpr_read_b32 v226, a54
    v_accvgpr_read_b32 v227, a55
    v_mul_f32 v224, v224, v53
    v_mul_f32 v225, v225, v53
    v_mul_f32 v226, v226, v53
    v_mul_f32 v227, v227, v53
    v_accvgpr_write_b32 a52, v224
    v_accvgpr_write_b32 a53, v225
    v_accvgpr_write_b32 a54, v226
    v_accvgpr_write_b32 a55, v227
    v_accvgpr_read_b32 v224, a56
    v_accvgpr_read_b32 v225, a57
    v_accvgpr_read_b32 v226, a58
    v_accvgpr_read_b32 v227, a59
    v_mul_f32 v224, v224, v54
    v_mul_f32 v225, v225, v54
    v_mul_f32 v226, v226, v54
    v_mul_f32 v227, v227, v54
    v_accvgpr_write_b32 a56, v224
    v_accvgpr_write_b32 a57, v225
    v_accvgpr_write_b32 a58, v226
    v_accvgpr_write_b32 a59, v227
    v_accvgpr_read_b32 v224, a60
    v_accvgpr_read_b32 v225, a61
    v_accvgpr_read_b32 v226, a62
    v_accvgpr_read_b32 v227, a63
    v_mul_f32 v224, v224, v55
    v_mul_f32 v225, v225, v55
    v_mul_f32 v226, v226, v55
    v_mul_f32 v227, v227, v55
    v_accvgpr_write_b32 a60, v224
    v_accvgpr_write_b32 a61, v225
    v_accvgpr_write_b32 a62, v226
    v_accvgpr_write_b32 a63, v227
    v_accvgpr_read_b32 v224, a68
    v_accvgpr_read_b32 v225, a69
    v_accvgpr_read_b32 v226, a70
    v_accvgpr_read_b32 v227, a71
    v_mul_f32 v224, v224, v53
    v_mul_f32 v225, v225, v53
    v_mul_f32 v226, v226, v53
    v_mul_f32 v227, v227, v53
    v_accvgpr_write_b32 a68, v224
    v_accvgpr_write_b32 a69, v225
    v_accvgpr_write_b32 a70, v226
    v_accvgpr_write_b32 a71, v227
    v_accvgpr_read_b32 v224, a72
    v_accvgpr_read_b32 v225, a73
    v_accvgpr_read_b32 v226, a74
    v_accvgpr_read_b32 v227, a75
    v_mul_f32 v224, v224, v54
    v_mul_f32 v225, v225, v54
    v_mul_f32 v226, v226, v54
    v_mul_f32 v227, v227, v54
    v_accvgpr_write_b32 a72, v224
    v_accvgpr_write_b32 a73, v225
    v_accvgpr_write_b32 a74, v226
    v_accvgpr_write_b32 a75, v227
    v_accvgpr_read_b32 v224, a76
    v_accvgpr_read_b32 v225, a77
    v_accvgpr_read_b32 v226, a78
    v_accvgpr_read_b32 v227, a79
    v_mul_f32 v224, v224, v55
    v_mul_f32 v225, v225, v55
    v_mul_f32 v226, v226, v55
    v_mul_f32 v227, v227, v55
    v_accvgpr_write_b32 a76, v224
    v_accvgpr_write_b32 a77, v225
    v_accvgpr_write_b32 a78, v226
    v_accvgpr_write_b32 a79, v227
    v_accvgpr_read_b32 v224, a84
    v_accvgpr_read_b32 v225, a85
    v_accvgpr_read_b32 v226, a86
    v_accvgpr_read_b32 v227, a87
    v_mul_f32 v224, v224, v53
    v_mul_f32 v225, v225, v53
    v_mul_f32 v226, v226, v53
    v_mul_f32 v227, v227, v53
    v_accvgpr_write_b32 a84, v224
    v_accvgpr_write_b32 a85, v225
    v_accvgpr_write_b32 a86, v226
    v_accvgpr_write_b32 a87, v227
    v_accvgpr_read_b32 v224, a88
    v_accvgpr_read_b32 v225, a89
    v_accvgpr_read_b32 v226, a90
    v_accvgpr_read_b32 v227, a91
    v_mul_f32 v224, v224, v54
    v_mul_f32 v225, v225, v54
    v_mul_f32 v226, v226, v54
    v_mul_f32 v227, v227, v54
    v_accvgpr_write_b32 a88, v224
    v_accvgpr_write_b32 a89, v225
    v_accvgpr_write_b32 a90, v226
    v_accvgpr_write_b32 a91, v227
    v_accvgpr_read_b32 v224, a92
    v_accvgpr_read_b32 v225, a93
    v_accvgpr_read_b32 v226, a94
    v_accvgpr_read_b32 v227, a95
    v_mul_f32 v224, v224, v55
    v_mul_f32 v225, v225, v55
    v_mul_f32 v226, v226, v55
    v_mul_f32 v227, v227, v55
    v_accvgpr_write_b32 a92, v224
    v_accvgpr_write_b32 a93, v225
    v_accvgpr_write_b32 a94, v226
    v_accvgpr_write_b32 a95, v227
    v_accvgpr_read_b32 v224, a100
    v_accvgpr_read_b32 v225, a101
    v_accvgpr_read_b32 v226, a102
    v_accvgpr_read_b32 v227, a103
    v_mul_f32 v224, v224, v53
    v_mul_f32 v225, v225, v53
    v_mul_f32 v226, v226, v53
    v_mul_f32 v227, v227, v53
    v_accvgpr_write_b32 a100, v224
    v_accvgpr_write_b32 a101, v225
    v_accvgpr_write_b32 a102, v226
    v_accvgpr_write_b32 a103, v227
    v_accvgpr_read_b32 v224, a104
    v_accvgpr_read_b32 v225, a105
    v_accvgpr_read_b32 v226, a106
    v_accvgpr_read_b32 v227, a107
    v_mul_f32 v224, v224, v54
    v_mul_f32 v225, v225, v54
    v_mul_f32 v226, v226, v54
    v_mul_f32 v227, v227, v54
    v_accvgpr_write_b32 a104, v224
    v_accvgpr_write_b32 a105, v225
    v_accvgpr_write_b32 a106, v226
    v_accvgpr_write_b32 a107, v227
    v_accvgpr_read_b32 v224, a108
    v_accvgpr_read_b32 v225, a109
    v_accvgpr_read_b32 v226, a110
    v_accvgpr_read_b32 v227, a111
    v_mul_f32 v224, v224, v55
    v_mul_f32 v225, v225, v55
    v_mul_f32 v226, v226, v55
    v_mul_f32 v227, v227, v55
    v_accvgpr_write_b32 a108, v224
    v_accvgpr_write_b32 a109, v225
    v_accvgpr_write_b32 a110, v226
    v_accvgpr_write_b32 a111, v227
    v_accvgpr_read_b32 v224, a116
    v_accvgpr_read_b32 v225, a117
    v_accvgpr_read_b32 v226, a118
    v_accvgpr_read_b32 v227, a119
    v_mul_f32 v224, v224, v53
    v_mul_f32 v225, v225, v53
    v_mul_f32 v226, v226, v53
    v_mul_f32 v227, v227, v53
    v_accvgpr_write_b32 a116, v224
    v_accvgpr_write_b32 a117, v225
    v_accvgpr_write_b32 a118, v226
    v_accvgpr_write_b32 a119, v227
    v_accvgpr_read_b32 v224, a120
    v_accvgpr_read_b32 v225, a121
    v_accvgpr_read_b32 v226, a122
    v_accvgpr_read_b32 v227, a123
    v_mul_f32 v224, v224, v54
    v_mul_f32 v225, v225, v54
    v_mul_f32 v226, v226, v54
    v_mul_f32 v227, v227, v54
    v_accvgpr_write_b32 a120, v224
    v_accvgpr_write_b32 a121, v225
    v_accvgpr_write_b32 a122, v226
    v_accvgpr_write_b32 a123, v227
    v_accvgpr_read_b32 v224, a124
    v_accvgpr_read_b32 v225, a125
    v_accvgpr_read_b32 v226, a126
    v_accvgpr_read_b32 v227, a127
    v_mul_f32 v224, v224, v55
    v_mul_f32 v225, v225, v55
    v_mul_f32 v226, v226, v55
    v_mul_f32 v227, v227, v55
    v_accvgpr_write_b32 a124, v224
    v_accvgpr_write_b32 a125, v225
    v_accvgpr_write_b32 a126, v226
    v_accvgpr_write_b32 a127, v227
    v_exp_f32 v232, v164
    v_exp_f32 v233, v165
    v_exp_f32 v234, v166
    v_exp_f32 v235, v167
    s_nop 0
    v_cvt_pk_bf16_f32 v212, v232, v233
    v_cvt_pk_bf16_f32 v213, v234, v235
    v_exp_f32 v232, v180
    v_exp_f32 v233, v181
    v_exp_f32 v234, v182
    v_exp_f32 v235, v183
    s_nop 0
    v_cvt_pk_bf16_f32 v214, v232, v233
    v_cvt_pk_bf16_f32 v215, v234, v235
    v_exp_f32 v232, v168
    v_exp_f32 v233, v169
    v_exp_f32 v234, v170
    v_exp_f32 v235, v171
    s_nop 0
    v_cvt_pk_bf16_f32 v216, v232, v233
    v_cvt_pk_bf16_f32 v217, v234, v235
    v_exp_f32 v232, v184
    v_exp_f32 v233, v185
    v_exp_f32 v234, v186
    v_exp_f32 v235, v187
    s_nop 0
    v_cvt_pk_bf16_f32 v218, v232, v233
    v_cvt_pk_bf16_f32 v219, v234, v235
    v_exp_f32 v232, v172
    v_exp_f32 v233, v173
    v_exp_f32 v234, v174
    v_exp_f32 v235, v175
    s_nop 0
    v_cvt_pk_bf16_f32 v220, v232, v233
    v_cvt_pk_bf16_f32 v221, v234, v235
    v_exp_f32 v232, v188
    v_exp_f32 v233, v189
    v_exp_f32 v234, v190
    v_exp_f32 v235, v191
    s_nop 0
    v_cvt_pk_bf16_f32 v222, v232, v233
    v_cvt_pk_bf16_f32 v223, v234, v235
    s_nop 3
    s_setpc_b64 s[40:41]
k2_rare_160:
    s_nop 7
    v_max_f32 v54, v128, v129
    v_max3_f32 v54, v54, v130, v131
    v_max3_f32 v54, v54, v144, v145
    v_max3_f32 v54, v54, v146, v147
    v_max3_f32 v54, v54, v136, v137
    v_max3_f32 v54, v54, v138, v139
    v_max3_f32 v54, v54, v152, v153
    v_max3_f32 v54, v54, v154, v155
    v_max_f32 v55, v132, v133
    v_max3_f32 v55, v55, v134, v135
    v_max3_f32 v55, v55, v148, v149
    v_max3_f32 v55, v55, v150, v151
    v_max3_f32 v55, v55, v140, v141
    v_max3_f32 v55, v55, v142, v143
    v_max3_f32 v55, v55, v156, v157
    v_max3_f32 v55, v55, v158, v159
    v_mov_b32 v226, v54
    v_mov_b32 v227, v55
    s_nop 1
    v_permlane16_swap_b32 v54, v226
    v_permlane16_swap_b32 v55, v227
    s_nop 1
    v_max_f32 v54, v54, v226
    v_max_f32 v55, v55, v227
    v_mov_b32 v226, v54
    v_mov_b32 v227, v55
    s_nop 1
    v_permlane32_swap_b32 v54, v226
    v_permlane32_swap_b32 v55, v227
    s_nop 1
    v_max_f32 v54, v54, v226
    v_max_f32 v55, v55, v227
    v_add_f32 v54, 0x41400000, v54
    v_max_f32 v54, 0, v54
    v_add_f32 v55, 0x41400000, v55
    v_max_f32 v55, 0, v55
    v_sub_f32 v128, v128, v54
    v_sub_f32 v129, v129, v54
    v_sub_f32 v130, v130, v54
    v_sub_f32 v131, v131, v54
    v_sub_f32 v132, v132, v55
    v_sub_f32 v133, v133, v55
    v_sub_f32 v134, v134, v55
    v_sub_f32 v135, v135, v55
    v_sub_f32 v136, v136, v54
    v_sub_f32 v137, v137, v54
    v_sub_f32 v138, v138, v54
    v_sub_f32 v139, v139, v54
    v_sub_f32 v140, v140, v55
    v_sub_f32 v141, v141, v55
    v_sub_f32 v142, v142, v55
    v_sub_f32 v143, v143, v55
    v_sub_f32 v144, v144, v54
    v_sub_f32 v145, v145, v54
    v_sub_f32 v146, v146, v54
    v_sub_f32 v147, v147, v54
    v_sub_f32 v148, v148, v55
    v_sub_f32 v149, v149, v55
    v_sub_f32 v150, v150, v55
    v_sub_f32 v151, v151, v55
    v_sub_f32 v152, v152, v54
    v_sub_f32 v153, v153, v54
    v_sub_f32 v154, v154, v54
    v_sub_f32 v155, v155, v54
    v_sub_f32 v156, v156, v55
    v_sub_f32 v157, v157, v55
    v_sub_f32 v158, v158, v55
    v_sub_f32 v159, v159, v55
    v_sub_f32 v160, v160, v54
    v_sub_f32 v16, v16, v54
    v_sub_f32 v161, v161, v54
    v_sub_f32 v17, v17, v54
    v_sub_f32 v162, v162, v54
    v_sub_f32 v18, v18, v54
    v_sub_f32 v163, v163, v54
    v_sub_f32 v19, v19, v54
    v_sub_f32 v164, v164, v55
    v_sub_f32 v20, v20, v55
    v_sub_f32 v165, v165, v55
    v_sub_f32 v21, v21, v55
    v_sub_f32 v166, v166, v55
    v_sub_f32 v22, v22, v55
    v_sub_f32 v167, v167, v55
    v_sub_f32 v23, v23, v55
    v_sub_f32 v168, v168, v54
    v_sub_f32 v24, v24, v54
    v_sub_f32 v169, v169, v54
    v_sub_f32 v25, v25, v54
    v_sub_f32 v170, v170, v54
    v_sub_f32 v26, v26, v54
    v_sub_f32 v171, v171, v54
    v_sub_f32 v27, v27, v54
    v_sub_f32 v172, v172, v55
    v_sub_f32 v28, v28, v55
    v_sub_f32 v173, v173, v55
    v_sub_f32 v29, v29, v55
    v_sub_f32 v174, v174, v55
    v_sub_f32 v30, v30, v55
    v_sub_f32 v175, v175, v55
    v_sub_f32 v31, v31, v55
    v_sub_f32 v176, v176, v54
    v_sub_f32 v32, v32, v54
    v_sub_f32 v177, v177, v54
    v_sub_f32 v33, v33, v54
    v_sub_f32 v178, v178, v54
    v_sub_f32 v34, v34, v54
    v_sub_f32 v179, v179, v54
    v_sub_f32 v35, v35, v54
    v_sub_f32 v180, v180, v55
    v_sub_f32 v36, v36, v55
    v_sub_f32 v181, v181, v55
    v_sub_f32 v37, v37, v55
    v_sub_f32 v182, v182, v55
    v_sub_f32 v38, v38, v55
    v_sub_f32 v183, v183, v55
    v_sub_f32 v39, v39, v55
    v_sub_f32 v184, v184, v54
    v_sub_f32 v40, v40, v54
    v_sub_f32 v185, v185, v54
    v_sub_f32 v41, v41, v54
    v_sub_f32 v186, v186, v54
    v_sub_f32 v42, v42, v54
    v_sub_f32 v187, v187, v54
    v_sub_f32 v43, v43, v54
    v_sub_f32 v188, v188, v55
    v_sub_f32 v44, v44, v55
    v_sub_f32 v189, v189, v55
    v_sub_f32 v45, v45, v55
    v_sub_f32 v190, v190, v55
    v_sub_f32 v46, v46, v55
    v_sub_f32 v191, v191, v55
    v_sub_f32 v47, v47, v55
    v_sub_f32 v10, v10, v54
    v_exp_f32 v54, -v54
    v_sub_f32 v11, v11, v55
    v_exp_f32 v55, -v55
    s_nop 0
    v_mul_f32 v248, v248, v54
    v_mul_f32 v252, v252, v55
    v_accvgpr_read_b32 v224, a8
    v_accvgpr_read_b32 v225, a9
    v_accvgpr_read_b32 v226, a10
    v_accvgpr_read_b32 v227, a11
    v_mul_f32 v224, v224, v54
    v_mul_f32 v225, v225, v54
    v_mul_f32 v226, v226, v54
    v_mul_f32 v227, v227, v54
    v_accvgpr_write_b32 a8, v224
    v_accvgpr_write_b32 a9, v225
    v_accvgpr_write_b32 a10, v226
    v_accvgpr_write_b32 a11, v227
    v_accvgpr_read_b32 v224, a12
    v_accvgpr_read_b32 v225, a13
    v_accvgpr_read_b32 v226, a14
    v_accvgpr_read_b32 v227, a15
    v_mul_f32 v224, v224, v55
    v_mul_f32 v225, v225, v55
    v_mul_f32 v226, v226, v55
    v_mul_f32 v227, v227, v55
    v_accvgpr_write_b32 a12, v224
    v_accvgpr_write_b32 a13, v225
    v_accvgpr_write_b32 a14, v226
    v_accvgpr_write_b32 a15, v227
    v_accvgpr_read_b32 v224, a24
    v_accvgpr_read_b32 v225, a25
    v_accvgpr_read_b32 v226, a26
    v_accvgpr_read_b32 v227, a27
    v_mul_f32 v224, v224, v54
    v_mul_f32 v225, v225, v54
    v_mul_f32 v226, v226, v54
    v_mul_f32 v227, v227, v54
    v_accvgpr_write_b32 a24, v224
    v_accvgpr_write_b32 a25, v225
    v_accvgpr_write_b32 a26, v226
    v_accvgpr_write_b32 a27, v227
    v_accvgpr_read_b32 v224, a28
    v_accvgpr_read_b32 v225, a29
    v_accvgpr_read_b32 v226, a30
    v_accvgpr_read_b32 v227, a31
    v_mul_f32 v224, v224, v55
    v_mul_f32 v225, v225, v55
    v_mul_f32 v226, v226, v55
    v_mul_f32 v227, v227, v55
    v_accvgpr_write_b32 a28, v224
    v_accvgpr_write_b32 a29, v225
    v_accvgpr_write_b32 a30, v226
    v_accvgpr_write_b32 a31, v227
    v_accvgpr_read_b32 v224, a40
    v_accvgpr_read_b32 v225, a41
    v_accvgpr_read_b32 v226, a42
    v_accvgpr_read_b32 v227, a43
    v_mul_f32 v224, v224, v54
    v_mul_f32 v225, v225, v54
    v_mul_f32 v226, v226, v54
    v_mul_f32 v227, v227, v54
    v_accvgpr_write_b32 a40, v224
    v_accvgpr_write_b32 a41, v225
    v_accvgpr_write_b32 a42, v226
    v_accvgpr_write_b32 a43, v227
    v_accvgpr_read_b32 v224, a44
    v_accvgpr_read_b32 v225, a45
    v_accvgpr_read_b32 v226, a46
    v_accvgpr_read_b32 v227, a47
    v_mul_f32 v224, v224, v55
    v_mul_f32 v225, v225, v55
    v_mul_f32 v226, v226, v55
    v_mul_f32 v227, v227, v55
    v_accvgpr_write_b32 a44, v224
    v_accvgpr_write_b32 a45, v225
    v_accvgpr_write_b32 a46, v226
    v_accvgpr_write_b32 a47, v227
    v_accvgpr_read_b32 v224, a56
    v_accvgpr_read_b32 v225, a57
    v_accvgpr_read_b32 v226, a58
    v_accvgpr_read_b32 v227, a59
    v_mul_f32 v224, v224, v54
    v_mul_f32 v225, v225, v54
    v_mul_f32 v226, v226, v54
    v_mul_f32 v227, v227, v54
    v_accvgpr_write_b32 a56, v224
    v_accvgpr_write_b32 a57, v225
    v_accvgpr_write_b32 a58, v226
    v_accvgpr_write_b32 a59, v227
    v_accvgpr_read_b32 v224, a60
    v_accvgpr_read_b32 v225, a61
    v_accvgpr_read_b32 v226, a62
    v_accvgpr_read_b32 v227, a63
    v_mul_f32 v224, v224, v55
    v_mul_f32 v225, v225, v55
    v_mul_f32 v226, v226, v55
    v_mul_f32 v227, v227, v55
    v_accvgpr_write_b32 a60, v224
    v_accvgpr_write_b32 a61, v225
    v_accvgpr_write_b32 a62, v226
    v_accvgpr_write_b32 a63, v227
    v_accvgpr_read_b32 v224, a72
    v_accvgpr_read_b32 v225, a73
    v_accvgpr_read_b32 v226, a74
    v_accvgpr_read_b32 v227, a75
    v_mul_f32 v224, v224, v54
    v_mul_f32 v225, v225, v54
    v_mul_f32 v226, v226, v54
    v_mul_f32 v227, v227, v54
    v_accvgpr_write_b32 a72, v224
    v_accvgpr_write_b32 a73, v225
    v_accvgpr_write_b32 a74, v226
    v_accvgpr_write_b32 a75, v227
    v_accvgpr_read_b32 v224, a76
    v_accvgpr_read_b32 v225, a77
    v_accvgpr_read_b32 v226, a78
    v_accvgpr_read_b32 v227, a79
    v_mul_f32 v224, v224, v55
    v_mul_f32 v225, v225, v55
    v_mul_f32 v226, v226, v55
    v_mul_f32 v227, v227, v55
    v_accvgpr_write_b32 a76, v224
    v_accvgpr_write_b32 a77, v225
    v_accvgpr_write_b32 a78, v226
    v_accvgpr_write_b32 a79, v227
    v_accvgpr_read_b32 v224, a88
    v_accvgpr_read_b32 v225, a89
    v_accvgpr_read_b32 v226, a90
    v_accvgpr_read_b32 v227, a91
    v_mul_f32 v224, v224, v54
    v_mul_f32 v225, v225, v54
    v_mul_f32 v226, v226, v54
    v_mul_f32 v227, v227, v54
    v_accvgpr_write_b32 a88, v224
    v_accvgpr_write_b32 a89, v225
    v_accvgpr_write_b32 a90, v226
    v_accvgpr_write_b32 a91, v227
    v_accvgpr_read_b32 v224, a92
    v_accvgpr_read_b32 v225, a93
    v_accvgpr_read_b32 v226, a94
    v_accvgpr_read_b32 v227, a95
    v_mul_f32 v224, v224, v55
    v_mul_f32 v225, v225, v55
    v_mul_f32 v226, v226, v55
    v_mul_f32 v227, v227, v55
    v_accvgpr_write_b32 a92, v224
    v_accvgpr_write_b32 a93, v225
    v_accvgpr_write_b32 a94, v226
    v_accvgpr_write_b32 a95, v227
    v_accvgpr_read_b32 v224, a104
    v_accvgpr_read_b32 v225, a105
    v_accvgpr_read_b32 v226, a106
    v_accvgpr_read_b32 v227, a107
    v_mul_f32 v224, v224, v54
    v_mul_f32 v225, v225, v54
    v_mul_f32 v226, v226, v54
    v_mul_f32 v227, v227, v54
    v_accvgpr_write_b32 a104, v224
    v_accvgpr_write_b32 a105, v225
    v_accvgpr_write_b32 a106, v226
    v_accvgpr_write_b32 a107, v227
    v_accvgpr_read_b32 v224, a108
    v_accvgpr_read_b32 v225, a109
    v_accvgpr_read_b32 v226, a110
    v_accvgpr_read_b32 v227, a111
    v_mul_f32 v224, v224, v55
    v_mul_f32 v225, v225, v55
    v_mul_f32 v226, v226, v55
    v_mul_f32 v227, v227, v55
    v_accvgpr_write_b32 a108, v224
    v_accvgpr_write_b32 a109, v225
    v_accvgpr_write_b32 a110, v226
    v_accvgpr_write_b32 a111, v227
    v_accvgpr_read_b32 v224, a120
    v_accvgpr_read_b32 v225, a121
    v_accvgpr_read_b32 v226, a122
    v_accvgpr_read_b32 v227, a123
    v_mul_f32 v224, v224, v54
    v_mul_f32 v225, v225, v54
    v_mul_f32 v226, v226, v54
    v_mul_f32 v227, v227, v54
    v_accvgpr_write_b32 a120, v224
    v_accvgpr_write_b32 a121, v225
    v_accvgpr_write_b32 a122, v226
    v_accvgpr_write_b32 a123, v227
    v_accvgpr_read_b32 v224, a124
    v_accvgpr_read_b32 v225, a125
    v_accvgpr_read_b32 v226, a126
    v_accvgpr_read_b32 v227, a127
    v_mul_f32 v224, v224, v55
    v_mul_f32 v225, v225, v55
    v_mul_f32 v226, v226, v55
    v_mul_f32 v227, v227, v55
    v_accvgpr_write_b32 a124, v224
    v_accvgpr_write_b32 a125, v225
    v_accvgpr_write_b32 a126, v226
    v_accvgpr_write_b32 a127, v227
    v_exp_f32 v232, v128
    v_exp_f32 v233, v129
    v_exp_f32 v234, v130
    v_exp_f32 v235, v131
    s_nop 0
    v_cvt_pk_bf16_f32 v192, v232, v233
    v_cvt_pk_bf16_f32 v193, v234, v235
    v_exp_f32 v232, v144
    v_exp_f32 v233, v145
    v_exp_f32 v234, v146
    v_exp_f32 v235, v147
    s_nop 0
    v_cvt_pk_bf16_f32 v194, v232, v233
    v_cvt_pk_bf16_f32 v195, v234, v235
    v_exp_f32 v232, v132
    v_exp_f32 v233, v133
    v_exp_f32 v234, v134
    v_exp_f32 v235, v135
    s_nop 0
    v_cvt_pk_bf16_f32 v196, v232, v233
    v_cvt_pk_bf16_f32 v197, v234, v235
    v_exp_f32 v232, v148
    v_exp_f32 v233, v149
    v_exp_f32 v234, v150
    v_exp_f32 v235, v151
    s_nop 0
    v_cvt_pk_bf16_f32 v198, v232, v233
    v_cvt_pk_bf16_f32 v199, v234, v235
    v_exp_f32 v232, v136
    v_exp_f32 v233, v137
    v_exp_f32 v234, v138
    v_exp_f32 v235, v139
    s_nop 0
    v_cvt_pk_bf16_f32 v200, v232, v233
    v_cvt_pk_bf16_f32 v201, v234, v235
    v_exp_f32 v232, v152
    v_exp_f32 v233, v153
    v_exp_f32 v234, v154
    v_exp_f32 v235, v155
    s_nop 0
    v_cvt_pk_bf16_f32 v202, v232, v233
    v_cvt_pk_bf16_f32 v203, v234, v235
    v_exp_f32 v232, v140
    v_exp_f32 v233, v141
    v_exp_f32 v234, v142
    v_exp_f32 v235, v143
    s_nop 0
    v_cvt_pk_bf16_f32 v204, v232, v233
    v_cvt_pk_bf16_f32 v205, v234, v235
    v_exp_f32 v232, v156
    v_exp_f32 v233, v157
    v_exp_f32 v234, v158
    v_exp_f32 v235, v159
    s_nop 0
    v_cvt_pk_bf16_f32 v206, v232, v233
    v_cvt_pk_bf16_f32 v207, v234, v235
    s_nop 3
    s_setpc_b64 s[40:41]
k2_rare_161:
    s_nop 7
    v_max_f32 v54, v160, v161
    v_max3_f32 v54, v54, v162, v163
    v_max3_f32 v54, v54, v176, v177
    v_max3_f32 v54, v54, v178, v179
    v_max3_f32 v54, v54, v168, v169
    v_max3_f32 v54, v54, v170, v171
    v_max3_f32 v54, v54, v184, v185
    v_max3_f32 v54, v54, v186, v187
    v_max_f32 v55, v164, v165
    v_max3_f32 v55, v55, v166, v167
    v_max3_f32 v55, v55, v180, v181
    v_max3_f32 v55, v55, v182, v183
    v_max3_f32 v55, v55, v172, v173
    v_max3_f32 v55, v55, v174, v175
    v_max3_f32 v55, v55, v188, v189
    v_max3_f32 v55, v55, v190, v191
    v_mov_b32 v226, v54
    v_mov_b32 v227, v55
    s_nop 1
    v_permlane16_swap_b32 v54, v226
    v_permlane16_swap_b32 v55, v227
    s_nop 1
    v_max_f32 v54, v54, v226
    v_max_f32 v55, v55, v227
    v_mov_b32 v226, v54
    v_mov_b32 v227, v55
    s_nop 1
    v_permlane32_swap_b32 v54, v226
    v_permlane32_swap_b32 v55, v227
    s_nop 1
    v_max_f32 v54, v54, v226
    v_max_f32 v55, v55, v227
    v_add_f32 v54, 0x41400000, v54
    v_max_f32 v54, 0, v54
    v_add_f32 v55, 0x41400000, v55
    v_max_f32 v55, 0, v55
    v_sub_f32 v160, v160, v54
    v_sub_f32 v161, v161, v54
    v_sub_f32 v162, v162, v54
    v_sub_f32 v163, v163, v54
    v_sub_f32 v164, v164, v55
    v_sub_f32 v165, v165, v55
    v_sub_f32 v166, v166, v55
    v_sub_f32 v167, v167, v55
    v_sub_f32 v168, v168, v54
    v_sub_f32 v169, v169, v54
    v_sub_f32 v170, v170, v54
    v_sub_f32 v171, v171, v54
    v_sub_f32 v172, v172, v55
    v_sub_f32 v173, v173, v55
    v_sub_f32 v174, v174, v55
    v_sub_f32 v175, v175, v55
    v_sub_f32 v176, v176, v54
    v_sub_f32 v177, v177, v54
    v_sub_f32 v178, v178, v54
    v_sub_f32 v179, v179, v54
    v_sub_f32 v180, v180, v55
    v_sub_f32 v181, v181, v55
    v_sub_f32 v182, v182, v55
    v_sub_f32 v183, v183, v55
    v_sub_f32 v184, v184, v54
    v_sub_f32 v185, v185, v54
    v_sub_f32 v186, v186, v54
    v_sub_f32 v187, v187, v54
    v_sub_f32 v188, v188, v55
    v_sub_f32 v189, v189, v55
    v_sub_f32 v190, v190, v55
    v_sub_f32 v191, v191, v55
    v_sub_f32 v128, v128, v54
    v_sub_f32 v16, v16, v54
    v_sub_f32 v129, v129, v54
    v_sub_f32 v17, v17, v54
    v_sub_f32 v130, v130, v54
    v_sub_f32 v18, v18, v54
    v_sub_f32 v131, v131, v54
    v_sub_f32 v19, v19, v54
    v_sub_f32 v132, v132, v55
    v_sub_f32 v20, v20, v55
    v_sub_f32 v133, v133, v55
    v_sub_f32 v21, v21, v55
    v_sub_f32 v134, v134, v55
    v_sub_f32 v22, v22, v55
    v_sub_f32 v135, v135, v55
    v_sub_f32 v23, v23, v55
    v_sub_f32 v136, v136, v54
    v_sub_f32 v24, v24, v54
    v_sub_f32 v137, v137, v54
    v_sub_f32 v25, v25, v54
    v_sub_f32 v138, v138, v54
    v_sub_f32 v26, v26, v54
    v_sub_f32 v139, v139, v54
    v_sub_f32 v27, v27, v54
    v_sub_f32 v140, v140, v55
    v_sub_f32 v28, v28, v55
    v_sub_f32 v141, v141, v55
    v_sub_f32 v29, v29, v55
    v_sub_f32 v142, v142, v55
    v_sub_f32 v30, v30, v55
    v_sub_f32 v143, v143, v55
    v_sub_f32 v31, v31, v55
    v_sub_f32 v144, v144, v54
    v_sub_f32 v32, v32, v54
    v_sub_f32 v145, v145, v54
    v_sub_f32 v33, v33, v54
    v_sub_f32 v146, v146, v54
    v_sub_f32 v34, v34, v54
    v_sub_f32 v147, v147, v54
    v_sub_f32 v35, v35, v54
    v_sub_f32 v148, v148, v55
    v_sub_f32 v36, v36, v55
    v_sub_f32 v149, v149, v55
    v_sub_f32 v37, v37, v55
    v_sub_f32 v150, v150, v55
    v_sub_f32 v38, v38, v55
    v_sub_f32 v151, v151, v55
    v_sub_f32 v39, v39, v55
    v_sub_f32 v152, v152, v54
    v_sub_f32 v40, v40, v54
    v_sub_f32 v153, v153, v54
    v_sub_f32 v41, v41, v54
    v_sub_f32 v154, v154, v54
    v_sub_f32 v42, v42, v54
    v_sub_f32 v155, v155, v54
    v_sub_f32 v43, v43, v54
    v_sub_f32 v156, v156, v55
    v_sub_f32 v44, v44, v55
    v_sub_f32 v157, v157, v55
    v_sub_f32 v45, v45, v55
    v_sub_f32 v158, v158, v55
    v_sub_f32 v46, v46, v55
    v_sub_f32 v159, v159, v55
    v_sub_f32 v47, v47, v55
    v_sub_f32 v10, v10, v54
    v_exp_f32 v54, -v54
    v_sub_f32 v11, v11, v55
    v_exp_f32 v55, -v55
    s_nop 0
    v_mul_f32 v248, v248, v54
    v_mul_f32 v252, v252, v55
    v_accvgpr_read_b32 v224, a8
    v_accvgpr_read_b32 v225, a9
    v_accvgpr_read_b32 v226, a10
    v_accvgpr_read_b32 v227, a11
    v_mul_f32 v224, v224, v54
    v_mul_f32 v225, v225, v54
    v_mul_f32 v226, v226, v54
    v_mul_f32 v227, v227, v54
    v_accvgpr_write_b32 a8, v224
    v_accvgpr_write_b32 a9, v225
    v_accvgpr_write_b32 a10, v226
    v_accvgpr_write_b32 a11, v227
    v_accvgpr_read_b32 v224, a12
    v_accvgpr_read_b32 v225, a13
    v_accvgpr_read_b32 v226, a14
    v_accvgpr_read_b32 v227, a15
    v_mul_f32 v224, v224, v55
    v_mul_f32 v225, v225, v55
    v_mul_f32 v226, v226, v55
    v_mul_f32 v227, v227, v55
    v_accvgpr_write_b32 a12, v224
    v_accvgpr_write_b32 a13, v225
    v_accvgpr_write_b32 a14, v226
    v_accvgpr_write_b32 a15, v227
    v_accvgpr_read_b32 v224, a24
    v_accvgpr_read_b32 v225, a25
    v_accvgpr_read_b32 v226, a26
    v_accvgpr_read_b32 v227, a27
    v_mul_f32 v224, v224, v54
    v_mul_f32 v225, v225, v54
    v_mul_f32 v226, v226, v54
    v_mul_f32 v227, v227, v54
    v_accvgpr_write_b32 a24, v224
    v_accvgpr_write_b32 a25, v225
    v_accvgpr_write_b32 a26, v226
    v_accvgpr_write_b32 a27, v227
    v_accvgpr_read_b32 v224, a28
    v_accvgpr_read_b32 v225, a29
    v_accvgpr_read_b32 v226, a30
    v_accvgpr_read_b32 v227, a31
    v_mul_f32 v224, v224, v55
    v_mul_f32 v225, v225, v55
    v_mul_f32 v226, v226, v55
    v_mul_f32 v227, v227, v55
    v_accvgpr_write_b32 a28, v224
    v_accvgpr_write_b32 a29, v225
    v_accvgpr_write_b32 a30, v226
    v_accvgpr_write_b32 a31, v227
    v_accvgpr_read_b32 v224, a40
    v_accvgpr_read_b32 v225, a41
    v_accvgpr_read_b32 v226, a42
    v_accvgpr_read_b32 v227, a43
    v_mul_f32 v224, v224, v54
    v_mul_f32 v225, v225, v54
    v_mul_f32 v226, v226, v54
    v_mul_f32 v227, v227, v54
    v_accvgpr_write_b32 a40, v224
    v_accvgpr_write_b32 a41, v225
    v_accvgpr_write_b32 a42, v226
    v_accvgpr_write_b32 a43, v227
    v_accvgpr_read_b32 v224, a44
    v_accvgpr_read_b32 v225, a45
    v_accvgpr_read_b32 v226, a46
    v_accvgpr_read_b32 v227, a47
    v_mul_f32 v224, v224, v55
    v_mul_f32 v225, v225, v55
    v_mul_f32 v226, v226, v55
    v_mul_f32 v227, v227, v55
    v_accvgpr_write_b32 a44, v224
    v_accvgpr_write_b32 a45, v225
    v_accvgpr_write_b32 a46, v226
    v_accvgpr_write_b32 a47, v227
    v_accvgpr_read_b32 v224, a56
    v_accvgpr_read_b32 v225, a57
    v_accvgpr_read_b32 v226, a58
    v_accvgpr_read_b32 v227, a59
    v_mul_f32 v224, v224, v54
    v_mul_f32 v225, v225, v54
    v_mul_f32 v226, v226, v54
    v_mul_f32 v227, v227, v54
    v_accvgpr_write_b32 a56, v224
    v_accvgpr_write_b32 a57, v225
    v_accvgpr_write_b32 a58, v226
    v_accvgpr_write_b32 a59, v227
    v_accvgpr_read_b32 v224, a60
    v_accvgpr_read_b32 v225, a61
    v_accvgpr_read_b32 v226, a62
    v_accvgpr_read_b32 v227, a63
    v_mul_f32 v224, v224, v55
    v_mul_f32 v225, v225, v55
    v_mul_f32 v226, v226, v55
    v_mul_f32 v227, v227, v55
    v_accvgpr_write_b32 a60, v224
    v_accvgpr_write_b32 a61, v225
    v_accvgpr_write_b32 a62, v226
    v_accvgpr_write_b32 a63, v227
    v_accvgpr_read_b32 v224, a72
    v_accvgpr_read_b32 v225, a73
    v_accvgpr_read_b32 v226, a74
    v_accvgpr_read_b32 v227, a75
    v_mul_f32 v224, v224, v54
    v_mul_f32 v225, v225, v54
    v_mul_f32 v226, v226, v54
    v_mul_f32 v227, v227, v54
    v_accvgpr_write_b32 a72, v224
    v_accvgpr_write_b32 a73, v225
    v_accvgpr_write_b32 a74, v226
    v_accvgpr_write_b32 a75, v227
    v_accvgpr_read_b32 v224, a76
    v_accvgpr_read_b32 v225, a77
    v_accvgpr_read_b32 v226, a78
    v_accvgpr_read_b32 v227, a79
    v_mul_f32 v224, v224, v55
    v_mul_f32 v225, v225, v55
    v_mul_f32 v226, v226, v55
    v_mul_f32 v227, v227, v55
    v_accvgpr_write_b32 a76, v224
    v_accvgpr_write_b32 a77, v225
    v_accvgpr_write_b32 a78, v226
    v_accvgpr_write_b32 a79, v227
    v_accvgpr_read_b32 v224, a88
    v_accvgpr_read_b32 v225, a89
    v_accvgpr_read_b32 v226, a90
    v_accvgpr_read_b32 v227, a91
    v_mul_f32 v224, v224, v54
    v_mul_f32 v225, v225, v54
    v_mul_f32 v226, v226, v54
    v_mul_f32 v227, v227, v54
    v_accvgpr_write_b32 a88, v224
    v_accvgpr_write_b32 a89, v225
    v_accvgpr_write_b32 a90, v226
    v_accvgpr_write_b32 a91, v227
    v_accvgpr_read_b32 v224, a92
    v_accvgpr_read_b32 v225, a93
    v_accvgpr_read_b32 v226, a94
    v_accvgpr_read_b32 v227, a95
    v_mul_f32 v224, v224, v55
    v_mul_f32 v225, v225, v55
    v_mul_f32 v226, v226, v55
    v_mul_f32 v227, v227, v55
    v_accvgpr_write_b32 a92, v224
    v_accvgpr_write_b32 a93, v225
    v_accvgpr_write_b32 a94, v226
    v_accvgpr_write_b32 a95, v227
    v_accvgpr_read_b32 v224, a104
    v_accvgpr_read_b32 v225, a105
    v_accvgpr_read_b32 v226, a106
    v_accvgpr_read_b32 v227, a107
    v_mul_f32 v224, v224, v54
    v_mul_f32 v225, v225, v54
    v_mul_f32 v226, v226, v54
    v_mul_f32 v227, v227, v54
    v_accvgpr_write_b32 a104, v224
    v_accvgpr_write_b32 a105, v225
    v_accvgpr_write_b32 a106, v226
    v_accvgpr_write_b32 a107, v227
    v_accvgpr_read_b32 v224, a108
    v_accvgpr_read_b32 v225, a109
    v_accvgpr_read_b32 v226, a110
    v_accvgpr_read_b32 v227, a111
    v_mul_f32 v224, v224, v55
    v_mul_f32 v225, v225, v55
    v_mul_f32 v226, v226, v55
    v_mul_f32 v227, v227, v55
    v_accvgpr_write_b32 a108, v224
    v_accvgpr_write_b32 a109, v225
    v_accvgpr_write_b32 a110, v226
    v_accvgpr_write_b32 a111, v227
    v_accvgpr_read_b32 v224, a120
    v_accvgpr_read_b32 v225, a121
    v_accvgpr_read_b32 v226, a122
    v_accvgpr_read_b32 v227, a123
    v_mul_f32 v224, v224, v54
    v_mul_f32 v225, v225, v54
    v_mul_f32 v226, v226, v54
    v_mul_f32 v227, v227, v54
    v_accvgpr_write_b32 a120, v224
    v_accvgpr_write_b32 a121, v225
    v_accvgpr_write_b32 a122, v226
    v_accvgpr_write_b32 a123, v227
    v_accvgpr_read_b32 v224, a124
    v_accvgpr_read_b32 v225, a125
    v_accvgpr_read_b32 v226, a126
    v_accvgpr_read_b32 v227, a127
    v_mul_f32 v224, v224, v55
    v_mul_f32 v225, v225, v55
    v_mul_f32 v226, v226, v55
    v_mul_f32 v227, v227, v55
    v_accvgpr_write_b32 a124, v224
    v_accvgpr_write_b32 a125, v225
    v_accvgpr_write_b32 a126, v226
    v_accvgpr_write_b32 a127, v227
    v_exp_f32 v232, v160
    v_exp_f32 v233, v161
    v_exp_f32 v234, v162
    v_exp_f32 v235, v163
    s_nop 0
    v_cvt_pk_bf16_f32 v208, v232, v233
    v_cvt_pk_bf16_f32 v209, v234, v235
    v_exp_f32 v232, v176
    v_exp_f32 v233, v177
    v_exp_f32 v234, v178
    v_exp_f32 v235, v179
    s_nop 0
    v_cvt_pk_bf16_f32 v210, v232, v233
    v_cvt_pk_bf16_f32 v211, v234, v235
    v_exp_f32 v232, v164
    v_exp_f32 v233, v165
    v_exp_f32 v234, v166
    v_exp_f32 v235, v167
    s_nop 0
    v_cvt_pk_bf16_f32 v212, v232, v233
    v_cvt_pk_bf16_f32 v213, v234, v235
    v_exp_f32 v232, v180
    v_exp_f32 v233, v181
    v_exp_f32 v234, v182
    v_exp_f32 v235, v183
    s_nop 0
    v_cvt_pk_bf16_f32 v214, v232, v233
    v_cvt_pk_bf16_f32 v215, v234, v235
    v_exp_f32 v232, v168
    v_exp_f32 v233, v169
    v_exp_f32 v234, v170
    v_exp_f32 v235, v171
    s_nop 0
    v_cvt_pk_bf16_f32 v216, v232, v233
    v_cvt_pk_bf16_f32 v217, v234, v235
    v_exp_f32 v232, v184
    v_exp_f32 v233, v185
    v_exp_f32 v234, v186
    v_exp_f32 v235, v187
    s_nop 0
    v_cvt_pk_bf16_f32 v218, v232, v233
    v_cvt_pk_bf16_f32 v219, v234, v235
    v_exp_f32 v232, v172
    v_exp_f32 v233, v173
    v_exp_f32 v234, v174
    v_exp_f32 v235, v175
    s_nop 0
    v_cvt_pk_bf16_f32 v220, v232, v233
    v_cvt_pk_bf16_f32 v221, v234, v235
    v_exp_f32 v232, v188
    v_exp_f32 v233, v189
    v_exp_f32 v234, v190
    v_exp_f32 v235, v191
    s_nop 0
    v_cvt_pk_bf16_f32 v222, v232, v233
    v_cvt_pk_bf16_f32 v223, v234, v235
    s_nop 3
    s_setpc_b64 s[40:41]
k2_rare_165:
    s_nop 7
    v_max_f32 v55, v164, v165
    v_max3_f32 v55, v55, v166, v167
    v_max3_f32 v55, v55, v180, v181
    v_max3_f32 v55, v55, v182, v183
    v_max3_f32 v55, v55, v172, v173
    v_max3_f32 v55, v55, v174, v175
    v_max3_f32 v55, v55, v188, v189
    v_max3_f32 v55, v55, v190, v191
    v_mov_b32 v227, v55
    s_nop 1
    v_permlane16_swap_b32 v55, v227
    s_nop 1
    v_max_f32 v55, v55, v227
    v_mov_b32 v227, v55
    s_nop 1
    v_permlane32_swap_b32 v55, v227
    s_nop 1
    v_max_f32 v55, v55, v227
    v_add_f32 v55, 0x41400000, v55
    v_max_f32 v55, 0, v55
    v_sub_f32 v164, v164, v55
    v_sub_f32 v165, v165, v55
    v_sub_f32 v166, v166, v55
    v_sub_f32 v167, v167, v55
    v_sub_f32 v172, v172, v55
    v_sub_f32 v173, v173, v55
    v_sub_f32 v174, v174, v55
    v_sub_f32 v175, v175, v55
    v_sub_f32 v180, v180, v55
    v_sub_f32 v181, v181, v55
    v_sub_f32 v182, v182, v55
    v_sub_f32 v183, v183, v55
    v_sub_f32 v188, v188, v55
    v_sub_f32 v189, v189, v55
    v_sub_f32 v190, v190, v55
    v_sub_f32 v191, v191, v55
    v_sub_f32 v11, v11, v55
    v_exp_f32 v55, -v55
    s_nop 0
    v_mul_f32 v252, v252, v55
    v_accvgpr_read_b32 v224, a12
    v_accvgpr_read_b32 v225, a13
    v_accvgpr_read_b32 v226, a14
    v_accvgpr_read_b32 v227, a15
    v_mul_f32 v224, v224, v55
    v_mul_f32 v225, v225, v55
    v_mul_f32 v226, v226, v55
    v_mul_f32 v227, v227, v55
    v_accvgpr_write_b32 a12, v224
    v_accvgpr_write_b32 a13, v225
    v_accvgpr_write_b32 a14, v226
    v_accvgpr_write_b32 a15, v227
    v_accvgpr_read_b32 v224, a28
    v_accvgpr_read_b32 v225, a29
    v_accvgpr_read_b32 v226, a30
    v_accvgpr_read_b32 v227, a31
    v_mul_f32 v224, v224, v55
    v_mul_f32 v225, v225, v55
    v_mul_f32 v226, v226, v55
    v_mul_f32 v227, v227, v55
    v_accvgpr_write_b32 a28, v224
    v_accvgpr_write_b32 a29, v225
    v_accvgpr_write_b32 a30, v226
    v_accvgpr_write_b32 a31, v227
    v_accvgpr_read_b32 v224, a44
    v_accvgpr_read_b32 v225, a45
    v_accvgpr_read_b32 v226, a46
    v_accvgpr_read_b32 v227, a47
    v_mul_f32 v224, v224, v55
    v_mul_f32 v225, v225, v55
    v_mul_f32 v226, v226, v55
    v_mul_f32 v227, v227, v55
    v_accvgpr_write_b32 a44, v224
    v_accvgpr_write_b32 a45, v225
    v_accvgpr_write_b32 a46, v226
    v_accvgpr_write_b32 a47, v227
    v_accvgpr_read_b32 v224, a60
    v_accvgpr_read_b32 v225, a61
    v_accvgpr_read_b32 v226, a62
    v_accvgpr_read_b32 v227, a63
    v_mul_f32 v224, v224, v55
    v_mul_f32 v225, v225, v55
    v_mul_f32 v226, v226, v55
    v_mul_f32 v227, v227, v55
    v_accvgpr_write_b32 a60, v224
    v_accvgpr_write_b32 a61, v225
    v_accvgpr_write_b32 a62, v226
    v_accvgpr_write_b32 a63, v227
    v_accvgpr_read_b32 v224, a76
    v_accvgpr_read_b32 v225, a77
    v_accvgpr_read_b32 v226, a78
    v_accvgpr_read_b32 v227, a79
    v_mul_f32 v224, v224, v55
    v_mul_f32 v225, v225, v55
    v_mul_f32 v226, v226, v55
    v_mul_f32 v227, v227, v55
    v_accvgpr_write_b32 a76, v224
    v_accvgpr_write_b32 a77, v225
    v_accvgpr_write_b32 a78, v226
    v_accvgpr_write_b32 a79, v227
    v_accvgpr_read_b32 v224, a92
    v_accvgpr_read_b32 v225, a93
    v_accvgpr_read_b32 v226, a94
    v_accvgpr_read_b32 v227, a95
    v_mul_f32 v224, v224, v55
    v_mul_f32 v225, v225, v55
    v_mul_f32 v226, v226, v55
    v_mul_f32 v227, v227, v55
    v_accvgpr_write_b32 a92, v224
    v_accvgpr_write_b32 a93, v225
    v_accvgpr_write_b32 a94, v226
    v_accvgpr_write_b32 a95, v227
    v_accvgpr_read_b32 v224, a108
    v_accvgpr_read_b32 v225, a109
    v_accvgpr_read_b32 v226, a110
    v_accvgpr_read_b32 v227, a111
    v_mul_f32 v224, v224, v55
    v_mul_f32 v225, v225, v55
    v_mul_f32 v226, v226, v55
    v_mul_f32 v227, v227, v55
    v_accvgpr_write_b32 a108, v224
    v_accvgpr_write_b32 a109, v225
    v_accvgpr_write_b32 a110, v226
    v_accvgpr_write_b32 a111, v227
    v_accvgpr_read_b32 v224, a124
    v_accvgpr_read_b32 v225, a125
    v_accvgpr_read_b32 v226, a126
    v_accvgpr_read_b32 v227, a127
    v_mul_f32 v224, v224, v55
    v_mul_f32 v225, v225, v55
    v_mul_f32 v226, v226, v55
    v_mul_f32 v227, v227, v55
    v_accvgpr_write_b32 a124, v224
    v_accvgpr_write_b32 a125, v225
    v_accvgpr_write_b32 a126, v226
    v_accvgpr_write_b32 a127, v227
    v_exp_f32 v232, v164
    v_exp_f32 v233, v165
    v_exp_f32 v234, v166
    v_exp_f32 v235, v167
    s_nop 0
    v_cvt_pk_bf16_f32 v212, v232, v233
    v_cvt_pk_bf16_f32 v213, v234, v235
    v_exp_f32 v232, v180
    v_exp_f32 v233, v181
    v_exp_f32 v234, v182
    v_exp_f32 v235, v183
    s_nop 0
    v_cvt_pk_bf16_f32 v214, v232, v233
    v_cvt_pk_bf16_f32 v215, v234, v235
    v_exp_f32 v232, v172
    v_exp_f32 v233, v173
    v_exp_f32 v234, v174
    v_exp_f32 v235, v175
    s_nop 0
    v_cvt_pk_bf16_f32 v220, v232, v233
    v_cvt_pk_bf16_f32 v221, v234, v235
    v_exp_f32 v232, v188
    v_exp_f32 v233, v189
    v_exp_f32 v234, v190
    v_exp_f32 v235, v191
    s_nop 0
    v_cvt_pk_bf16_f32 v222, v232, v233
    v_cvt_pk_bf16_f32 v223, v234, v235
    s_nop 3
    s_setpc_b64 s[40:41]
code_end:
    s_endpgm
.section .rodata,"a"
.p2align 6
.amdhsa_kernel sequential_preLN__compressed_kv_cla__moe_arch_mod__prompt_kernel
  .amdhsa_next_free_vgpr 512
  .amdhsa_next_free_sgpr 102
  .amdhsa_accum_offset 256
  .amdhsa_group_segment_fixed_size 0
  .amdhsa_kernarg_size 112
  .amdhsa_user_sgpr_count 2
  .amdhsa_user_sgpr_kernarg_segment_ptr 1
  .amdhsa_system_sgpr_workgroup_id_x 1
.end_amdhsa_kernel
```

```asm
; @launch grid=(256,1,1) block=(256,1,1) lds=163840
.amdgcn_target "amdgcn-amd-amdhsa--gfx950"
.text
.globl sequential_preLN__compressed_kv_cla__moe_arch_mod__prompt_kernel
.p2align 8
.type sequential_preLN__compressed_kv_cla__moe_arch_mod__prompt_kernel,@function
sequential_preLN__compressed_kv_cla__moe_arch_mod__prompt_kernel:
    s_cmp_ge_u32 s2, 256
    s_cbranch_scc1 k12_end_1
    s_load_dwordx4 s[36:39], s[0:1], 0
    s_load_dwordx4 s[40:43], s[0:1], 24
    s_load_dwordx2 s[4:5], s[0:1], 16
    s_load_dwordx4 s[60:63], s[0:1], 96
    s_lshr_b32 s59, s2, 3
    s_lshl_b32 s58, s59, 4
    v_add_u32 v6, s58, v0
    v_cmp_gt_u32 vcc, 48, v0
    v_cmp_gt_u32 s[56:57], 64, v0
    s_nop 0
    v_cndmask_b32 v6, v6, v0, vcc
    s_getpc_b64 s[52:53]
pc_2:
    s_add_u32 s52, s52, k12_code0-pc_2
    s_addc_u32 s53, s53, 0
    v_lshlrev_b32 v58, 7, v6
    v_mov_b32 v59, s53
    v_add_co_u32 v58, vcc, s52, v58
    s_nop 1
    v_addc_co_u32 v59, vcc, 0, v59, vcc
k12_code0:
    s_mov_b64 exec, s[56:57]
    s_cbranch_execz k12_nocode_3
    global_load_dword v51, v[58:59], off
k12_nocode_3:
    s_mov_b64 exec, -1
    s_and_b32 s58, s2, 7
    s_lshr_b32 s59, s2, 3
    s_and_b32 s45, s59, 7
    s_lshr_b32 s57, s59, 3
    s_and_b32 s44, s57, 1
    s_lshl_b32 s52, s58, 1
    s_add_u32 s44, s44, s52
    s_lshr_b32 s57, s57, 1
    v_lshrrev_b32 v2, 6, v0
    v_and_b32 v3, 63, v0
    v_readfirstlane_b32 s30, v2
    v_lshlrev_b32 v1, 4, v3
    v_lshrrev_b32 v60, 5, v3
    v_lshl_add_u32 v60, v2, 1, v60
    v_and_b32 v61, 31, v3
    v_lshlrev_b32 v6, 11, v60
    v_lshl_add_u32 v62, v61, 4, v6
    s_lshl_b32 s52, s2, 14
    v_lshrrev_b32 v56, 3, v3
    v_and_b32 v57, 7, v3
    v_lshrrev_b32 v58, 1, v56
    v_xor_b32 v6, v57, v58
    v_xor_b32 v7, 4, v6
    v_lshl_add_u32 v58, v2, 6, v56
    v_lshlrev_b32 v58, 10, v58
    s_lshl_b32 s47, s45, 18
    v_add_u32 v58, s47, v58
    v_lshl_add_u32 v10, v6, 4, v58
    v_lshl_add_u32 v11, v7, 4, v58
    v_add_u32 v17, 54272, v11
    v_add_u32 v16, 47104, v10
    v_add_u32 v15, 39936, v11
    v_add_u32 v14, 32768, v10
    v_add_u32 v13, 21504, v11
    v_add_u32 v12, 14336, v10
    v_add_u32 v11, 7168, v11
    v_add_u32 v10, 0, v10
    v_lshrrev_b32 v6, 5, v3
    v_bfe_u32 v7, v3, 1, 4
    v_and_b32 v59, 1, v3
    v_lshl_add_u32 v58, v2, 4, v6
    v_lshlrev_b32 v58, 13, v58
    v_lshl_add_u32 v58, v59, 4, v58
    s_lshl_b32 s47, s44, 9
    v_add_u32 v58, s47, v58
    v_xor_b32 v7, v7, v6
    v_xor_b32 v6, 0, v7
    v_lshl_add_u32 v6, v6, 5, v58
    v_add_u32 v18, 0, v6
    v_xor_b32 v6, 2, v7
    v_lshl_add_u32 v6, v6, 5, v58
    v_add_u32 v19, 15360, v6
    v_xor_b32 v6, 0, v7
    v_lshl_add_u32 v6, v6, 5, v58
    v_add_u32 v20, 30720, v6
    v_xor_b32 v6, 2, v7
    v_lshl_add_u32 v6, v6, 5, v58
    v_add_u32 v21, 46080, v6
    v_xor_b32 v6, 4, v7
    v_lshl_add_u32 v6, v6, 5, v58
    v_add_u32 v22, 65536, v6
    v_xor_b32 v6, 6, v7
    v_lshl_add_u32 v6, v6, 5, v58
    v_add_u32 v23, 80896, v6
    v_xor_b32 v6, 4, v7
    v_lshl_add_u32 v6, v6, 5, v58
    v_add_u32 v24, 96256, v6
    v_xor_b32 v6, 6, v7
    v_lshl_add_u32 v6, v6, 5, v58
    v_add_u32 v25, 111616, v6
    s_lshl_b32 s48, s30, 13
    s_mov_b32 s49, 0
    s_mov_b32 s50, 0
    s_waitcnt lgkmcnt(0)
    s_mov_b32 s24, s36
    s_and_b32 s25, s37, 0xffff
    s_mov_b32 s26, 0x400000
    s_mov_b32 s27, 0x00020000
    buffer_load_dwordx4 v[64:67], v62, s[24:27], s52 offen offset:0
    buffer_load_dwordx4 v[68:71], v62, s[24:27], s52 offen offset:512
    buffer_load_dwordx4 v[72:75], v62, s[24:27], s52 offen offset:1024
    buffer_load_dwordx4 v[76:79], v62, s[24:27], s52 offen offset:1536
    s_mov_b32 s16, s38
    s_and_b32 s17, s39, 0xffff
    s_mov_b32 s18, 0x200000
    s_mov_b32 s19, 0x00020000
    s_cmp_eq_u32 s57, 0
    s_cselect_b32 s20, s40, s42
    s_cselect_b32 s21, s41, s43
    s_and_b32 s21, s21, 0xffff
    s_mov_b32 s22, 0x400000
    s_mov_b32 s23, 0x00020000
    s_add_u32 m0, s48, 0
    s_nop 0
    buffer_load_dwordx4 v10, s[16:19], s49 offen offset:0 lds
    buffer_load_dwordx4 v11, s[16:19], s49 offen offset:1024 lds
    buffer_load_dwordx4 v12, s[16:19], s49 offen offset:2048 lds
    buffer_load_dwordx4 v13, s[16:19], s49 offen offset:3072 lds
    s_add_u32 m0, s48, 65536
    s_nop 0
    buffer_load_dwordx4 v18, s[20:23], s50 offen offset:0 lds
    buffer_load_dwordx4 v19, s[20:23], s50 offen offset:1024 lds
    buffer_load_dwordx4 v20, s[20:23], s50 offen offset:2048 lds
    buffer_load_dwordx4 v21, s[20:23], s50 offen offset:3072 lds
    s_mov_b64 s[6:7], s[62:63]
    s_add_u32 s8, s6, 0x0
    s_addc_u32 s9, s7, 0
    s_and_b32 s9, s9, 0xffff
    s_mov_b32 s10, 0x400000
    s_mov_b32 s11, 0x00020000
    s_mov_b32 s12, s4
    s_and_b32 s13, s5, 0xffff
    s_mov_b32 s14, 0x800000
    s_mov_b32 s15, 0x00020000
    s_add_u32 s32, s6, 0x1000000
    s_addc_u32 s33, s7, 0
    s_and_b32 s33, s33, 0xffff
    s_mov_b32 s34, 0x2000000
    s_mov_b32 s35, 0x00020000
    s_mov_b32 s24, s60
    s_and_b32 s25, s61, 0xffff
    s_mov_b32 s26, 0x100
    s_mov_b32 s27, 0x00020000
    s_lshl_b32 s28, s58, 2
    s_and_b32 s31, s59, 3
    s_add_u32 s28, s28, s31
    s_lshr_b32 s29, s59, 2
    s_lshl_b32 s42, s29, 7
    s_sub_u32 s43, 1920, s42
    s_lshl_b32 s31, s30, 4
    s_add_u32 s38, s42, s31
    s_add_u32 s39, s43, s31
    s_lshl_b32 s60, s30, 12
    s_mov_b32 s61, 0
    s_mov_b32 s62, 0
    s_lshl_b32 s47, s44, 1
    s_lshr_b32 s52, s30, 1
    s_add_u32 s47, s47, s52
    s_lshl_b32 s47, s47, 14
    s_lshl_b32 s52, s45, 1
    s_and_b32 s53, s30, 1
    s_add_u32 s52, s52, s53
    s_lshl_b32 s52, s52, 20
    s_add_u32 s47, s47, s52
    s_lshl_b32 s52, s57, 24
    s_add_u32 s47, s47, s52
    s_lshl_b32 s54, s44, 8
    s_lshr_b32 s55, s28, 1
    s_lshl_b32 s55, s55, 8
    s_and_b32 s53, s59, 3
    s_add_u32 s53, s53, 1
    s_cmp_eq_u32 s30, 0
    s_cselect_b32 s53, s53, -1
    s_cselect_b32 s46, 6, -1
    v_lshlrev_b32 v6, 13, v56
    v_lshl_add_u32 v50, v57, 7, v6
    s_lshl_b32 s56, s30, 5
    s_add_u32 s56, s56, s59
    s_lshl_b32 s56, s56, 16
    s_lshl_b32 s52, s58, 10
    s_add_u32 s56, s56, s52
    s_lshl_b32 s63, s30, 1
    v_mul_u32_u24 v6, 2064, v60
    v_lshl_add_u32 v6, v61, 4, v6
    v_add_u32 v54, 131072, v6
    v_mul_u32_u24 v7, 2064, v57
    v_lshl_add_u32 v7, v56, 4, v7
    v_lshl_add_u32 v7, v2, 9, v7
    v_add_u32 v55, 131072, v7
    v_lshrrev_b32 v7, 2, v56
    v_lshl_add_u32 v7, v2, 3, v7
    v_lshlrev_b32 v7, 17, v7
    v_and_b32 v6, 3, v56
    v_lshl_add_u32 v7, v6, 8, v7
    v_lshl_add_u32 v7, v57, 4, v7
    s_lshr_b32 s52, s2, 1
    s_lshl_b32 s52, s52, 10
    s_and_b32 s31, s2, 1
    s_lshl_b32 s31, s31, 7
    s_add_u32 s52, s52, s31
    v_add_u32 v53, s52, v7
    v_and_b32 v56, 15, v3
    v_lshrrev_b32 v57, 4, v3
    v_lshrrev_b32 v6, 1, v56
    v_xor_b32 v6, v6, v57
    v_and_b32 v7, 1, v2
    v_lshl_add_u32 v7, v7, 7, v56
    v_lshlrev_b32 v7, 7, v7
    v_lshl_add_u32 v26, v6, 4, v7
    v_xor_b32 v27, 64, v26
    v_lshrrev_b32 v6, 2, v56
    v_and_b32 v58, 1, v57
    v_lshl_add_u32 v58, v58, 2, v6
    v_lshl_add_u32 v59, v57, 3, v6
    v_and_b32 v63, 3, v3
    v_lshlrev_b32 v7, 9, v59
    v_lshrrev_b32 v6, 1, v2
    v_lshl_add_u32 v7, v6, 8, v7
    v_lshl_add_u32 v7, v63, 3, v7
    v_add_u32 v7, 65536, v7
    v_lshlrev_b32 v59, 8, v59
    v_lshl_add_u32 v59, v63, 3, v59
    v_add_u32 v59, 98304, v59
    v_xor_b32 v6, 0, v58
    v_lshl_add_u32 v28, v6, 5, v7
    v_lshl_add_u32 v42, v6, 5, v59
    v_xor_b32 v6, 1, v58
    v_lshl_add_u32 v29, v6, 5, v7
    v_lshl_add_u32 v43, v6, 5, v59
    v_xor_b32 v6, 2, v58
    v_lshl_add_u32 v30, v6, 5, v7
    v_lshl_add_u32 v44, v6, 5, v59
    v_xor_b32 v6, 3, v58
    v_lshl_add_u32 v31, v6, 5, v7
    v_lshl_add_u32 v45, v6, 5, v59
    v_xor_b32 v6, 4, v58
    v_lshl_add_u32 v32, v6, 5, v7
    v_lshl_add_u32 v46, v6, 5, v59
    v_xor_b32 v6, 5, v58
    v_lshl_add_u32 v33, v6, 5, v7
    v_lshl_add_u32 v47, v6, 5, v59
    v_xor_b32 v6, 6, v58
    v_lshl_add_u32 v34, v6, 5, v7
    v_lshl_add_u32 v48, v6, 5, v59
    v_xor_b32 v6, 7, v58
    v_lshl_add_u32 v35, v6, 5, v7
    v_lshl_add_u32 v49, v6, 5, v59
    s_lshl_b32 s31, s38, 6
    v_add_u32 v36, s31, v1
    s_lshl_b32 s31, s39, 6
    v_add_u32 v37, s31, v1
    v_bfe_u32 v6, v3, 1, 3
    v_and_b32 v7, 1, v3
    v_lshl_add_u32 v58, v2, 4, v57
    v_lshlrev_b32 v58, 13, v58
    v_lshl_add_u32 v58, v7, 4, v58
    s_lshl_b32 s31, s28, 8
    v_add_u32 v58, s31, v58
    v_xor_b32 v6, v6, v57
    v_xor_b32 v7, 0, v6
    v_lshl_add_u32 v7, v7, 5, v58
    v_add_u32 v38, 0, v7
    v_xor_b32 v7, 0, v6
    v_lshl_add_u32 v7, v7, 5, v58
    v_add_u32 v39, 31744, v7
    v_xor_b32 v7, 4, v6
    v_lshl_add_u32 v7, v7, 5, v58
    v_add_u32 v40, 63488, v7
    v_xor_b32 v7, 4, v6
    v_lshl_add_u32 v7, v7, 5, v58
    v_add_u32 v41, 95232, v7
    v_lshlrev_b32 v6, 2, v57
    v_sub_u32 v4, v56, v6
    v_mov_b32 v5, 0xff800000
    v_mov_b32 v8, 0
    v_mov_b32 v9, 1
    s_lshl_b32 s52, s59, 2
    s_add_u32 s52, s52, s30
    v_and_b32 v6, 1, v3
    v_lshl_add_u32 v6, s52, 1, v6
    s_getpc_b64 s[40:41]
pc_4:
    s_add_u32 s40, s40, k12_qcode-pc_4
    s_addc_u32 s41, s41, 0
    v_lshlrev_b32 v2, 7, v6
    v_mov_b32 v3, s41
    v_add_co_u32 v2, vcc, s40, v2
    s_nop 1
    v_addc_co_u32 v3, vcc, 0, v3, vcc
    v_mov_b32 v56, 0
    v_mov_b32 v57, 0
    v_mov_b32 v58, 0
    v_mov_b32 v59, 0
    s_nop 1
    v_mfma_f32_32x32x16_bf16 a[128:143], v[56:59], v[56:59], 0
    v_mfma_f32_32x32x16_bf16 a[144:159], v[56:59], v[56:59], 0
    v_mfma_f32_32x32x16_bf16 a[160:175], v[56:59], v[56:59], 0
    v_mfma_f32_32x32x16_bf16 a[176:191], v[56:59], v[56:59], 0
    v_mfma_f32_32x32x16_bf16 v[128:143], v[56:59], v[56:59], 0
    v_mfma_f32_32x32x16_bf16 v[144:159], v[56:59], v[56:59], 0
    v_mfma_f32_32x32x16_bf16 v[160:175], v[56:59], v[56:59], 0
    v_mfma_f32_32x32x16_bf16 v[176:191], v[56:59], v[56:59], 0
    v_mfma_f32_32x32x16_bf16 v[192:207], v[56:59], v[56:59], 0
    v_mfma_f32_32x32x16_bf16 v[208:223], v[56:59], v[56:59], 0
    v_mfma_f32_32x32x16_bf16 v[224:239], v[56:59], v[56:59], 0
    v_mfma_f32_32x32x16_bf16 v[240:255], v[56:59], v[56:59], 0
    s_add_u32 m0, s48, 4096
    s_nop 0
    buffer_load_dwordx4 v14, s[16:19], s49 offen offset:0 lds
    buffer_load_dwordx4 v15, s[16:19], s49 offen offset:1024 lds
    buffer_load_dwordx4 v16, s[16:19], s49 offen offset:2048 lds
    buffer_load_dwordx4 v17, s[16:19], s49 offen offset:3072 lds
    s_add_u32 s49, s49, 128
    s_add_u32 m0, s48, 69632
    s_nop 0
    buffer_load_dwordx4 v22, s[20:23], s50 offen offset:0 lds
    buffer_load_dwordx4 v23, s[20:23], s50 offen offset:1024 lds
    buffer_load_dwordx4 v24, s[20:23], s50 offen offset:2048 lds
    buffer_load_dwordx4 v25, s[20:23], s50 offen offset:3072 lds
    s_add_u32 s50, s50, 0x80000
    s_waitcnt vmcnt(16)
    v_lshlrev_b32 v80, 16, v64
    v_and_b32 v81, 0xffff0000, v64
    v_lshlrev_b32 v82, 16, v65
    v_and_b32 v83, 0xffff0000, v65
    v_lshlrev_b32 v84, 16, v66
    v_and_b32 v85, 0xffff0000, v66
    v_lshlrev_b32 v86, 16, v67
    v_and_b32 v87, 0xffff0000, v67
    v_lshlrev_b32 v88, 16, v68
    v_and_b32 v89, 0xffff0000, v68
    v_lshlrev_b32 v90, 16, v69
    v_and_b32 v91, 0xffff0000, v69
    v_lshlrev_b32 v92, 16, v70
    v_and_b32 v93, 0xffff0000, v70
    v_lshlrev_b32 v94, 16, v71
    v_and_b32 v95, 0xffff0000, v71
    v_lshlrev_b32 v96, 16, v72
    v_and_b32 v97, 0xffff0000, v72
    v_lshlrev_b32 v98, 16, v73
    v_and_b32 v99, 0xffff0000, v73
    v_lshlrev_b32 v100, 16, v74
    v_and_b32 v101, 0xffff0000, v74
    v_lshlrev_b32 v102, 16, v75
    v_and_b32 v103, 0xffff0000, v75
    v_lshlrev_b32 v104, 16, v76
    v_and_b32 v105, 0xffff0000, v76
    v_lshlrev_b32 v106, 16, v77
    v_and_b32 v107, 0xffff0000, v77
    v_lshlrev_b32 v108, 16, v78
    v_and_b32 v109, 0xffff0000, v78
    v_lshlrev_b32 v110, 16, v79
    v_and_b32 v111, 0xffff0000, v79
    v_pk_add_f32 v[112:113], v[80:81], v[82:83]
    v_pk_add_f32 v[114:115], v[84:85], v[86:87]
    v_pk_add_f32 v[112:113], v[112:113], v[88:89]
    v_pk_add_f32 v[114:115], v[114:115], v[90:91]
    v_pk_add_f32 v[112:113], v[112:113], v[92:93]
    v_pk_add_f32 v[114:115], v[114:115], v[94:95]
    v_pk_add_f32 v[112:113], v[112:113], v[96:97]
    v_pk_add_f32 v[114:115], v[114:115], v[98:99]
    v_pk_add_f32 v[112:113], v[112:113], v[100:101]
    v_pk_add_f32 v[114:115], v[114:115], v[102:103]
    v_pk_add_f32 v[112:113], v[112:113], v[104:105]
    v_pk_add_f32 v[114:115], v[114:115], v[106:107]
    s_add_u32 m0, s48, 32768
    s_nop 0
    buffer_load_dwordx4 v10, s[16:19], s49 offen offset:0 lds
    buffer_load_dwordx4 v11, s[16:19], s49 offen offset:1024 lds
    buffer_load_dwordx4 v12, s[16:19], s49 offen offset:2048 lds
    buffer_load_dwordx4 v13, s[16:19], s49 offen offset:3072 lds
    v_pk_add_f32 v[112:113], v[112:113], v[108:109]
    v_pk_add_f32 v[114:115], v[114:115], v[110:111]
    v_pk_add_f32 v[112:113], v[112:113], v[114:115]
    v_add_f32 v112, v112, v113
    s_nop 1
    v_add_f32_dpp v112, v112, v112 quad_perm:[1,0,3,2] row_mask:0xf bank_mask:0xf
    s_nop 1
    v_add_f32_dpp v112, v112, v112 quad_perm:[2,3,0,1] row_mask:0xf bank_mask:0xf
    s_nop 1
    v_add_f32_dpp v112, v112, v112 row_half_mirror row_mask:0xf bank_mask:0xf
    s_nop 1
    v_add_f32_dpp v112, v112, v112 row_mirror row_mask:0xf bank_mask:0xf
    v_mov_b32 v114, v112
    s_nop 1
    v_permlane16_swap_b32 v112, v114
    s_nop 1
    v_add_f32 v112, v112, v114
    v_mul_f32 v112, 0xba800000, v112
    v_mov_b32 v113, v112
    v_pk_add_f32 v[114:115], v[80:81], v[112:113]
    v_pk_add_f32 v[118:119], v[82:83], v[112:113]
    v_pk_mul_f32 v[116:117], v[114:115], v[114:115]
    v_pk_fma_f32 v[116:117], v[118:119], v[118:119], v[116:117]
    v_pk_add_f32 v[114:115], v[84:85], v[112:113]
    v_pk_add_f32 v[118:119], v[86:87], v[112:113]
    v_pk_fma_f32 v[116:117], v[114:115], v[114:115], v[116:117]
    v_pk_fma_f32 v[116:117], v[118:119], v[118:119], v[116:117]
    v_pk_add_f32 v[114:115], v[88:89], v[112:113]
    v_pk_add_f32 v[118:119], v[90:91], v[112:113]
    v_pk_fma_f32 v[116:117], v[114:115], v[114:115], v[116:117]
    v_pk_fma_f32 v[116:117], v[118:119], v[118:119], v[116:117]
    v_pk_add_f32 v[114:115], v[92:93], v[112:113]
    v_pk_add_f32 v[118:119], v[94:95], v[112:113]
    v_pk_fma_f32 v[116:117], v[114:115], v[114:115], v[116:117]
    v_pk_fma_f32 v[116:117], v[118:119], v[118:119], v[116:117]
    v_pk_add_f32 v[114:115], v[96:97], v[112:113]
    v_pk_add_f32 v[118:119], v[98:99], v[112:113]
    v_pk_fma_f32 v[116:117], v[114:115], v[114:115], v[116:117]
    v_pk_fma_f32 v[116:117], v[118:119], v[118:119], v[116:117]
    v_pk_add_f32 v[114:115], v[100:101], v[112:113]
    v_pk_add_f32 v[118:119], v[102:103], v[112:113]
    v_pk_fma_f32 v[116:117], v[114:115], v[114:115], v[116:117]
    v_pk_fma_f32 v[116:117], v[118:119], v[118:119], v[116:117]
    v_pk_add_f32 v[114:115], v[104:105], v[112:113]
    s_add_u32 m0, s48, 98304
    s_nop 0
    buffer_load_dwordx4 v18, s[20:23], s50 offen offset:0 lds
    buffer_load_dwordx4 v19, s[20:23], s50 offen offset:1024 lds
    buffer_load_dwordx4 v20, s[20:23], s50 offen offset:2048 lds
    buffer_load_dwordx4 v21, s[20:23], s50 offen offset:3072 lds
    v_pk_add_f32 v[118:119], v[106:107], v[112:113]
    v_pk_fma_f32 v[116:117], v[114:115], v[114:115], v[116:117]
    v_pk_fma_f32 v[116:117], v[118:119], v[118:119], v[116:117]
    v_pk_add_f32 v[114:115], v[108:109], v[112:113]
    v_pk_add_f32 v[118:119], v[110:111], v[112:113]
    v_pk_fma_f32 v[116:117], v[114:115], v[114:115], v[116:117]
    v_pk_fma_f32 v[116:117], v[118:119], v[118:119], v[116:117]
    v_add_f32 v116, v116, v117
    s_nop 1
    v_add_f32_dpp v116, v116, v116 quad_perm:[1,0,3,2] row_mask:0xf bank_mask:0xf
    s_nop 1
    v_add_f32_dpp v116, v116, v116 quad_perm:[2,3,0,1] row_mask:0xf bank_mask:0xf
    s_nop 1
    v_add_f32_dpp v116, v116, v116 row_half_mirror row_mask:0xf bank_mask:0xf
    s_nop 1
    v_add_f32_dpp v116, v116, v116 row_mirror row_mask:0xf bank_mask:0xf
    v_mov_b32 v114, v116
    s_nop 1
    v_permlane16_swap_b32 v116, v114
    s_nop 1
    v_add_f32 v116, v116, v114
    v_mul_f32 v116, 0x3a800000, v116
    v_cvt_pk_bf16_f32 v118, v112, v116
    v_and_b32 v116, 0xffff0000, v118
    v_lshlrev_b32 v118, 16, v118
    v_add_f32 v116, 0x3727c5ac, v116
    v_mov_b32 v119, v118
    v_cvt_pk_bf16_f32 v116, v116, v116
    v_and_b32 v116, 0xffff0000, v116
    v_sqrt_f32 v116, v116
    v_pk_add_f32 v[80:81], v[80:81], v[118:119]
    v_pk_add_f32 v[82:83], v[82:83], v[118:119]
    v_pk_add_f32 v[84:85], v[84:85], v[118:119]
    v_pk_add_f32 v[86:87], v[86:87], v[118:119]
    v_pk_add_f32 v[88:89], v[88:89], v[118:119]
    v_pk_add_f32 v[90:91], v[90:91], v[118:119]
    v_pk_add_f32 v[92:93], v[92:93], v[118:119]
    v_pk_add_f32 v[94:95], v[94:95], v[118:119]
    v_pk_add_f32 v[96:97], v[96:97], v[118:119]
    v_pk_add_f32 v[98:99], v[98:99], v[118:119]
    v_pk_add_f32 v[100:101], v[100:101], v[118:119]
    v_pk_add_f32 v[102:103], v[102:103], v[118:119]
    v_pk_add_f32 v[104:105], v[104:105], v[118:119]
    s_add_u32 m0, s48, 36864
    s_nop 0
    buffer_load_dwordx4 v14, s[16:19], s49 offen offset:0 lds
    buffer_load_dwordx4 v15, s[16:19], s49 offen offset:1024 lds
    buffer_load_dwordx4 v16, s[16:19], s49 offen offset:2048 lds
    buffer_load_dwordx4 v17, s[16:19], s49 offen offset:3072 lds
    s_add_u32 s49, s49, 128
    v_pk_add_f32 v[106:107], v[106:107], v[118:119]
    v_pk_add_f32 v[108:109], v[108:109], v[118:119]
    v_pk_add_f32 v[110:111], v[110:111], v[118:119]
    v_cvt_pk_bf16_f32 v116, v116, v116
    v_and_b32 v116, 0xffff0000, v116
    v_rcp_f32 v116, v116
    v_cvt_pk_bf16_f32 v64, v80, v81
    v_cvt_pk_bf16_f32 v65, v82, v83
    v_cvt_pk_bf16_f32 v66, v84, v85
    v_cvt_pk_bf16_f32 v67, v86, v87
    v_cvt_pk_bf16_f32 v68, v88, v89
    v_cvt_pk_bf16_f32 v69, v90, v91
    v_cvt_pk_bf16_f32 v70, v92, v93
    v_cvt_pk_bf16_f32 v71, v94, v95
    v_cvt_pk_bf16_f32 v72, v96, v97
    v_cvt_pk_bf16_f32 v73, v98, v99
    v_cvt_pk_bf16_f32 v74, v100, v101
    v_cvt_pk_bf16_f32 v75, v102, v103
    v_cvt_pk_bf16_f32 v76, v104, v105
    v_cvt_pk_bf16_f32 v77, v106, v107
    v_cvt_pk_bf16_f32 v78, v108, v109
    v_cvt_pk_bf16_f32 v79, v110, v111
    v_mov_b32 v117, v116
    v_lshlrev_b32 v80, 16, v64
    v_and_b32 v81, 0xffff0000, v64
    v_lshlrev_b32 v82, 16, v65
    v_and_b32 v83, 0xffff0000, v65
    v_lshlrev_b32 v84, 16, v66
    v_and_b32 v85, 0xffff0000, v66
    v_lshlrev_b32 v86, 16, v67
    v_and_b32 v87, 0xffff0000, v67
    v_lshlrev_b32 v88, 16, v68
    v_and_b32 v89, 0xffff0000, v68
    v_lshlrev_b32 v90, 16, v69
    v_and_b32 v91, 0xffff0000, v69
    v_lshlrev_b32 v92, 16, v70
    v_and_b32 v93, 0xffff0000, v70
    v_lshlrev_b32 v94, 16, v71
    v_and_b32 v95, 0xffff0000, v71
    v_lshlrev_b32 v96, 16, v72
    v_and_b32 v97, 0xffff0000, v72
    v_lshlrev_b32 v98, 16, v73
    v_and_b32 v99, 0xffff0000, v73
    v_lshlrev_b32 v100, 16, v74
    s_add_u32 m0, s48, 102400
    s_nop 0
    buffer_load_dwordx4 v22, s[20:23], s50 offen offset:0 lds
    buffer_load_dwordx4 v23, s[20:23], s50 offen offset:1024 lds
    buffer_load_dwordx4 v24, s[20:23], s50 offen offset:2048 lds
    buffer_load_dwordx4 v25, s[20:23], s50 offen offset:3072 lds
    s_add_u32 s50, s50, 0x80000
    v_and_b32 v101, 0xffff0000, v74
    v_lshlrev_b32 v102, 16, v75
    v_and_b32 v103, 0xffff0000, v75
    v_lshlrev_b32 v104, 16, v76
    v_and_b32 v105, 0xffff0000, v76
    v_lshlrev_b32 v106, 16, v77
    v_and_b32 v107, 0xffff0000, v77
    v_lshlrev_b32 v108, 16, v78
    v_and_b32 v109, 0xffff0000, v78
    v_lshlrev_b32 v110, 16, v79
    v_and_b32 v111, 0xffff0000, v79
    v_pk_mul_f32 v[80:81], v[80:81], v[116:117]
    v_pk_mul_f32 v[82:83], v[82:83], v[116:117]
    v_pk_mul_f32 v[84:85], v[84:85], v[116:117]
    v_pk_mul_f32 v[86:87], v[86:87], v[116:117]
    v_pk_mul_f32 v[88:89], v[88:89], v[116:117]
    v_pk_mul_f32 v[90:91], v[90:91], v[116:117]
    v_pk_mul_f32 v[92:93], v[92:93], v[116:117]
    v_pk_mul_f32 v[94:95], v[94:95], v[116:117]
    v_pk_mul_f32 v[96:97], v[96:97], v[116:117]
    v_pk_mul_f32 v[98:99], v[98:99], v[116:117]
    v_pk_mul_f32 v[100:101], v[100:101], v[116:117]
    v_pk_mul_f32 v[102:103], v[102:103], v[116:117]
    v_pk_mul_f32 v[104:105], v[104:105], v[116:117]
    v_pk_mul_f32 v[106:107], v[106:107], v[116:117]
    v_pk_mul_f32 v[108:109], v[108:109], v[116:117]
    v_pk_mul_f32 v[110:111], v[110:111], v[116:117]
    v_cvt_pk_bf16_f32 v64, v80, v81
    v_cvt_pk_bf16_f32 v65, v82, v83
    v_cvt_pk_bf16_f32 v66, v84, v85
    v_cvt_pk_bf16_f32 v67, v86, v87
    v_cvt_pk_bf16_f32 v68, v88, v89
    v_cvt_pk_bf16_f32 v69, v90, v91
    v_cvt_pk_bf16_f32 v70, v92, v93
    v_cvt_pk_bf16_f32 v71, v94, v95
    v_cvt_pk_bf16_f32 v72, v96, v97
    v_cvt_pk_bf16_f32 v73, v98, v99
    v_cvt_pk_bf16_f32 v74, v100, v101
    v_cvt_pk_bf16_f32 v75, v102, v103
    v_cvt_pk_bf16_f32 v76, v104, v105
    v_cvt_pk_bf16_f32 v77, v106, v107
    v_cvt_pk_bf16_f32 v78, v108, v109
    v_cvt_pk_bf16_f32 v79, v110, v111
    ds_write_b128 v54, v[64:67] offset:0
    ds_write_b128 v54, v[68:71] offset:512
    ds_write_b128 v54, v[72:75] offset:1024
    ds_write_b128 v54, v[76:79] offset:1536
    s_waitcnt vmcnt(16) lgkmcnt(0)
    s_barrier
    ds_read_b128 a[192:195], v55 offset:0
    ds_read_b128 a[196:199], v55 offset:128
    ds_read_b128 a[200:203], v55 offset:256
    ds_read_b128 a[204:207], v55 offset:384
    v_add_u32 v54, 4096, v36
    v_add_u32 v55, 4096, v37
    v_mfma_f32_32x32x16_bf16 v[64:79], v[56:59], v[56:59], 0
    v_mfma_f32_32x32x16_bf16 v[80:95], v[56:59], v[56:59], 0
    v_mfma_f32_32x32x16_bf16 v[96:111], v[56:59], v[56:59], 0
    v_mfma_f32_32x32x16_bf16 v[112:127], v[56:59], v[56:59], 0
    s_cmp_ge_u32 s2, 22
    s_cbranch_scc1 k12_nostat_5
    s_lshl_b32 s52, s2, 12
    s_add_u32 s52, s52, 0x3800000
    s_mov_b32 s34, -1
    v_lshlrev_b32 v6, 4, v0
    buffer_store_dwordx4 v[56:59], v6, s[32:35], s52 offen sc1
    s_mov_b32 s34, 0x2000000
k12_nostat_5:
    ds_read_b128 a[0:3], v26 offset:0
    ds_read_b64_tr_b16 a[32:33], v28 offset:0
    ds_read_b64_tr_b16 a[34:35], v28 offset:2048
    ds_read_b128 a[4:7], v26 offset:2048
    ds_read_b64_tr_b16 a[36:37], v29 offset:0
    ds_read_b64_tr_b16 a[38:39], v29 offset:2048
    ds_read_b128 a[8:11], v26 offset:4096
    ds_read_b64_tr_b16 a[40:41], v30 offset:0
    ds_read_b64_tr_b16 a[42:43], v30 offset:2048
    ds_read_b128 a[12:15], v26 offset:6144
    ds_read_b64_tr_b16 a[44:45], v31 offset:0
    ds_read_b64_tr_b16 a[46:47], v31 offset:2048
    ds_read_b128 a[16:19], v26 offset:8192
    ds_read_b64_tr_b16 a[48:49], v32 offset:0
    ds_read_b64_tr_b16 a[50:51], v32 offset:2048
    ds_read_b128 a[20:23], v26 offset:10240
    ds_read_b64_tr_b16 a[52:53], v33 offset:0
    ds_read_b64_tr_b16 a[54:55], v33 offset:2048
    ds_read_b128 a[24:27], v26 offset:12288
    ds_read_b64_tr_b16 a[56:57], v34 offset:0
    ds_read_b64_tr_b16 a[58:59], v34 offset:2048
    ds_read_b128 a[28:31], v26 offset:14336
    ds_read_b64_tr_b16 a[60:61], v35 offset:0
    ds_read_b64_tr_b16 a[62:63], v35 offset:2048
    s_mov_b32 s51, 0
    s_waitcnt lgkmcnt(15)
    s_mov_b32 s52, 0
    buffer_store_dwordx4 a[192:195], v53, s[8:11], s52 offen sc1
    s_mov_b32 s52, 262144
    buffer_store_dwordx4 a[196:199], v53, s[8:11], s52 offen sc1
    s_mov_b32 s52, 524288
    buffer_store_dwordx4 a[200:203], v53, s[8:11], s52 offen sc1
    s_mov_b32 s52, 786432
    buffer_store_dwordx4 a[204:207], v53, s[8:11], s52 offen sc1
    s_waitcnt lgkmcnt(0)
    s_cmp_lg_u32 s57, 0
    s_cbranch_scc1 k12_v_6
k12_loop_8:
    v_mfma_f32_16x16x32_bf16 v[64:67], a[32:35], a[0:3], v[64:67]
    ds_read_b128 a[64:67], v27 offset:0
    v_mfma_f32_16x16x32_bf16 v[80:83], a[32:35], a[4:7], v[80:83]
    ds_read_b64_tr_b16 a[96:97], v28 offset:16384
    v_mfma_f32_16x16x32_bf16 v[96:99], a[32:35], a[8:11], v[96:99]
    v_mfma_f32_16x16x32_bf16 v[112:115], a[32:35], a[12:15], v[112:115]
    s_cmp_eq_u32 s51, s46
    s_cbranch_scc1 k12_ool_10
k12_oolret_11:
    v_mfma_f32_16x16x32_bf16 v[128:131], a[32:35], a[16:19], v[128:131]
    ds_read_b64_tr_b16 a[98:99], v28 offset:18432
    v_mfma_f32_16x16x32_bf16 v[144:147], a[32:35], a[20:23], v[144:147]
    ds_read_b128 a[68:71], v27 offset:2048
    v_mfma_f32_16x16x32_bf16 a[128:131], a[32:35], a[24:27], a[128:131]
    v_mfma_f32_16x16x32_bf16 a[160:163], a[32:35], a[28:31], a[160:163]
    ds_read_b64_tr_b16 a[100:101], v29 offset:16384
    v_mfma_f32_16x16x32_bf16 v[160:163], a[36:39], a[0:3], v[160:163]
    v_mfma_f32_16x16x32_bf16 v[176:179], a[36:39], a[4:7], v[176:179]
    ds_read_b64_tr_b16 a[102:103], v29 offset:18432
    v_mfma_f32_16x16x32_bf16 v[192:195], a[36:39], a[8:11], v[192:195]
    v_mfma_f32_16x16x32_bf16 v[208:211], a[36:39], a[12:15], v[208:211]
    ds_read_b128 a[72:75], v27 offset:4096
    v_mfma_f32_16x16x32_bf16 v[224:227], a[36:39], a[16:19], v[224:227]
    v_mfma_f32_16x16x32_bf16 v[240:243], a[36:39], a[20:23], v[240:243]
    v_mfma_f32_16x16x32_bf16 a[132:135], a[36:39], a[24:27], a[132:135]
    ds_read_b64_tr_b16 a[104:105], v30 offset:16384
    v_mfma_f32_16x16x32_bf16 a[164:167], a[36:39], a[28:31], a[164:167]
    v_mfma_f32_16x16x32_bf16 v[68:71], a[40:43], a[0:3], v[68:71]
    ds_read_b64_tr_b16 a[106:107], v30 offset:18432
    v_mfma_f32_16x16x32_bf16 v[84:87], a[40:43], a[4:7], v[84:87]
    v_mfma_f32_16x16x32_bf16 v[100:103], a[40:43], a[8:11], v[100:103]
    ds_read_b128 a[76:79], v27 offset:6144
    v_mfma_f32_16x16x32_bf16 v[116:119], a[40:43], a[12:15], v[116:119]
    v_mfma_f32_16x16x32_bf16 v[132:135], a[40:43], a[16:19], v[132:135]
    ds_read_b64_tr_b16 a[108:109], v31 offset:16384
    v_mfma_f32_16x16x32_bf16 v[148:151], a[40:43], a[20:23], v[148:151]
    v_mfma_f32_16x16x32_bf16 a[136:139], a[40:43], a[24:27], a[136:139]
    ds_read_b64_tr_b16 a[110:111], v31 offset:18432
    v_mfma_f32_16x16x32_bf16 a[168:171], a[40:43], a[28:31], a[168:171]
    v_mfma_f32_16x16x32_bf16 v[164:167], a[44:47], a[0:3], v[164:167]
    ds_read_b128 a[80:83], v27 offset:8192
    v_mfma_f32_16x16x32_bf16 v[180:183], a[44:47], a[4:7], v[180:183]
    v_mfma_f32_16x16x32_bf16 v[196:199], a[44:47], a[8:11], v[196:199]
    ds_read_b64_tr_b16 a[112:113], v32 offset:16384
    v_mfma_f32_16x16x32_bf16 v[212:215], a[44:47], a[12:15], v[212:215]
    v_mfma_f32_16x16x32_bf16 v[228:231], a[44:47], a[16:19], v[228:231]
    ds_read_b64_tr_b16 a[114:115], v32 offset:18432
    v_mfma_f32_16x16x32_bf16 v[244:247], a[44:47], a[20:23], v[244:247]
    v_mfma_f32_16x16x32_bf16 a[140:143], a[44:47], a[24:27], a[140:143]
    ds_read_b128 a[84:87], v27 offset:10240
    v_mfma_f32_16x16x32_bf16 a[172:175], a[44:47], a[28:31], a[172:175]
    v_mfma_f32_16x16x32_bf16 v[72:75], a[48:51], a[0:3], v[72:75]
    ds_read_b64_tr_b16 a[116:117], v33 offset:16384
    v_mfma_f32_16x16x32_bf16 v[88:91], a[48:51], a[4:7], v[88:91]
    v_mfma_f32_16x16x32_bf16 v[104:107], a[48:51], a[8:11], v[104:107]
    ds_read_b64_tr_b16 a[118:119], v33 offset:18432
    v_mfma_f32_16x16x32_bf16 v[120:123], a[48:51], a[12:15], v[120:123]
    v_mfma_f32_16x16x32_bf16 v[136:139], a[48:51], a[16:19], v[136:139]
    ds_read_b128 a[88:91], v27 offset:12288
    v_mfma_f32_16x16x32_bf16 v[152:155], a[48:51], a[20:23], v[152:155]
    v_mfma_f32_16x16x32_bf16 a[144:147], a[48:51], a[24:27], a[144:147]
    v_mfma_f32_16x16x32_bf16 a[176:179], a[48:51], a[28:31], a[176:179]
    ds_read_b64_tr_b16 a[120:121], v34 offset:16384
    v_mfma_f32_16x16x32_bf16 v[168:171], a[52:55], a[0:3], v[168:171]
    v_mfma_f32_16x16x32_bf16 v[184:187], a[52:55], a[4:7], v[184:187]
    ds_read_b64_tr_b16 a[122:123], v34 offset:18432
    v_mfma_f32_16x16x32_bf16 v[200:203], a[52:55], a[8:11], v[200:203]
    v_mfma_f32_16x16x32_bf16 v[216:219], a[52:55], a[12:15], v[216:219]
    ds_read_b128 a[92:95], v27 offset:14336
    v_mfma_f32_16x16x32_bf16 v[232:235], a[52:55], a[16:19], v[232:235]
    v_mfma_f32_16x16x32_bf16 v[248:251], a[52:55], a[20:23], v[248:251]
    ds_read_b64_tr_b16 a[124:125], v35 offset:16384
    v_mfma_f32_16x16x32_bf16 a[148:151], a[52:55], a[24:27], a[148:151]
    v_mfma_f32_16x16x32_bf16 a[180:183], a[52:55], a[28:31], a[180:183]
    ds_read_b64_tr_b16 a[126:127], v35 offset:18432
    v_mfma_f32_16x16x32_bf16 v[76:79], a[56:59], a[0:3], v[76:79]
    v_mfma_f32_16x16x32_bf16 v[92:95], a[56:59], a[4:7], v[92:95]
    v_mfma_f32_16x16x32_bf16 v[108:111], a[56:59], a[8:11], v[108:111]
    v_mfma_f32_16x16x32_bf16 v[124:127], a[56:59], a[12:15], v[124:127]
    v_mfma_f32_16x16x32_bf16 v[140:143], a[56:59], a[16:19], v[140:143]
    v_mfma_f32_16x16x32_bf16 v[156:159], a[56:59], a[20:23], v[156:159]
    v_mfma_f32_16x16x32_bf16 a[152:155], a[56:59], a[24:27], a[152:155]
    v_mfma_f32_16x16x32_bf16 a[184:187], a[56:59], a[28:31], a[184:187]
    v_mfma_f32_16x16x32_bf16 v[172:175], a[60:63], a[0:3], v[172:175]
    v_mfma_f32_16x16x32_bf16 v[188:191], a[60:63], a[4:7], v[188:191]
    v_mfma_f32_16x16x32_bf16 v[204:207], a[60:63], a[8:11], v[204:207]
    v_mfma_f32_16x16x32_bf16 v[220:223], a[60:63], a[12:15], v[220:223]
    v_mfma_f32_16x16x32_bf16 v[236:239], a[60:63], a[16:19], v[236:239]
    v_mfma_f32_16x16x32_bf16 v[252:255], a[60:63], a[20:23], v[252:255]
    v_mfma_f32_16x16x32_bf16 a[156:159], a[60:63], a[24:27], a[156:159]
    v_mfma_f32_16x16x32_bf16 a[188:191], a[60:63], a[28:31], a[188:191]
    s_waitcnt vmcnt(0) lgkmcnt(0)
    s_barrier
    v_mfma_f32_16x16x32_bf16 v[64:67], a[96:99], a[64:67], v[64:67]
    s_cmp_ge_u32 s49, 1024
    s_cselect_b32 s18, 0, s18
    s_cselect_b32 s22, 0, s22
    ds_read_b128 a[0:3], v26 offset:32768
    v_mfma_f32_16x16x32_bf16 v[80:83], a[96:99], a[68:71], v[80:83]
    s_add_u32 m0, s48, 0
    ds_read_b64_tr_b16 a[32:33], v28 offset:32768
    v_mfma_f32_16x16x32_bf16 v[96:99], a[96:99], a[72:75], v[96:99]
    buffer_load_dwordx4 v10, s[16:19], s49 offen offset:0 lds
    v_mfma_f32_16x16x32_bf16 v[112:115], a[96:99], a[76:79], v[112:115]
    ds_read_b64_tr_b16 a[34:35], v28 offset:34816
    v_mfma_f32_16x16x32_bf16 v[128:131], a[96:99], a[80:83], v[128:131]
    buffer_load_dwordx4 v11, s[16:19], s49 offen offset:1024 lds
    v_mfma_f32_16x16x32_bf16 v[144:147], a[96:99], a[84:87], v[144:147]
    ds_read_b128 a[4:7], v26 offset:34816
    v_mfma_f32_16x16x32_bf16 a[128:131], a[96:99], a[88:91], a[128:131]
    v_mfma_f32_16x16x32_bf16 a[160:163], a[96:99], a[92:95], a[160:163]
    ds_read_b64_tr_b16 a[36:37], v29 offset:32768
    v_mfma_f32_16x16x32_bf16 v[160:163], a[100:103], a[64:67], v[160:163]
    buffer_load_dwordx4 v12, s[16:19], s49 offen offset:2048 lds
    v_mfma_f32_16x16x32_bf16 v[176:179], a[100:103], a[68:71], v[176:179]
    ds_read_b64_tr_b16 a[38:39], v29 offset:34816
    v_mfma_f32_16x16x32_bf16 v[192:195], a[100:103], a[72:75], v[192:195]
    v_mfma_f32_16x16x32_bf16 v[208:211], a[100:103], a[76:79], v[208:211]
    buffer_load_dwordx4 v13, s[16:19], s49 offen offset:3072 lds
    ds_read_b128 a[8:11], v26 offset:36864
    v_mfma_f32_16x16x32_bf16 v[224:227], a[100:103], a[80:83], v[224:227]
    v_mfma_f32_16x16x32_bf16 v[240:243], a[100:103], a[84:87], v[240:243]
    s_add_u32 m0, s48, 4096
    v_mfma_f32_16x16x32_bf16 a[132:135], a[100:103], a[88:91], a[132:135]
    ds_read_b64_tr_b16 a[40:41], v30 offset:32768
    v_mfma_f32_16x16x32_bf16 a[164:167], a[100:103], a[92:95], a[164:167]
    buffer_load_dwordx4 v14, s[16:19], s49 offen offset:0 lds
    v_mfma_f32_16x16x32_bf16 v[68:71], a[104:107], a[64:67], v[68:71]
    ds_read_b64_tr_b16 a[42:43], v30 offset:34816
    v_mfma_f32_16x16x32_bf16 v[84:87], a[104:107], a[68:71], v[84:87]
    v_mfma_f32_16x16x32_bf16 v[100:103], a[104:107], a[72:75], v[100:103]
    buffer_load_dwordx4 v15, s[16:19], s49 offen offset:1024 lds
    ds_read_b128 a[12:15], v26 offset:38912
    v_mfma_f32_16x16x32_bf16 v[116:119], a[104:107], a[76:79], v[116:119]
    v_mfma_f32_16x16x32_bf16 v[132:135], a[104:107], a[80:83], v[132:135]
    ds_read_b64_tr_b16 a[44:45], v31 offset:32768
    v_mfma_f32_16x16x32_bf16 v[148:151], a[104:107], a[84:87], v[148:151]
    v_mfma_f32_16x16x32_bf16 a[136:139], a[104:107], a[88:91], a[136:139]
    buffer_load_dwordx4 v16, s[16:19], s49 offen offset:2048 lds
    ds_read_b64_tr_b16 a[46:47], v31 offset:34816
    v_mfma_f32_16x16x32_bf16 a[168:171], a[104:107], a[92:95], a[168:171]
    v_mfma_f32_16x16x32_bf16 v[164:167], a[108:111], a[64:67], v[164:167]
    ds_read_b128 a[16:19], v26 offset:40960
    v_mfma_f32_16x16x32_bf16 v[180:183], a[108:111], a[68:71], v[180:183]
    buffer_load_dwordx4 v17, s[16:19], s49 offen offset:3072 lds
    v_mfma_f32_16x16x32_bf16 v[196:199], a[108:111], a[72:75], v[196:199]
    ds_read_b64_tr_b16 a[48:49], v32 offset:32768
    v_mfma_f32_16x16x32_bf16 v[212:215], a[108:111], a[76:79], v[212:215]
    s_add_u32 s49, s49, 128
    v_mfma_f32_16x16x32_bf16 v[228:231], a[108:111], a[80:83], v[228:231]
    s_add_u32 m0, s48, 65536
    ds_read_b64_tr_b16 a[50:51], v32 offset:34816
    v_mfma_f32_16x16x32_bf16 v[244:247], a[108:111], a[84:87], v[244:247]
    buffer_load_dwordx4 v18, s[20:23], s50 offen offset:0 lds
    v_mfma_f32_16x16x32_bf16 a[140:143], a[108:111], a[88:91], a[140:143]
    ds_read_b128 a[20:23], v26 offset:43008
    v_mfma_f32_16x16x32_bf16 a[172:175], a[108:111], a[92:95], a[172:175]
    v_mfma_f32_16x16x32_bf16 v[72:75], a[112:115], a[64:67], v[72:75]
    buffer_load_dwordx4 v19, s[20:23], s50 offen offset:1024 lds
    ds_read_b64_tr_b16 a[52:53], v33 offset:32768
    v_mfma_f32_16x16x32_bf16 v[88:91], a[112:115], a[68:71], v[88:91]
    v_mfma_f32_16x16x32_bf16 v[104:107], a[112:115], a[72:75], v[104:107]
    ds_read_b64_tr_b16 a[54:55], v33 offset:34816
    v_mfma_f32_16x16x32_bf16 v[120:123], a[112:115], a[76:79], v[120:123]
    buffer_load_dwordx4 v20, s[20:23], s50 offen offset:2048 lds
    v_mfma_f32_16x16x32_bf16 v[136:139], a[112:115], a[80:83], v[136:139]
    ds_read_b128 a[24:27], v26 offset:45056
    v_mfma_f32_16x16x32_bf16 v[152:155], a[112:115], a[84:87], v[152:155]
    v_mfma_f32_16x16x32_bf16 a[144:147], a[112:115], a[88:91], a[144:147]
    v_mfma_f32_16x16x32_bf16 a[176:179], a[112:115], a[92:95], a[176:179]
    buffer_load_dwordx4 v21, s[20:23], s50 offen offset:3072 lds
    ds_read_b64_tr_b16 a[56:57], v34 offset:32768
    v_mfma_f32_16x16x32_bf16 v[168:171], a[116:119], a[64:67], v[168:171]
    s_add_u32 m0, s48, 69632
    v_mfma_f32_16x16x32_bf16 v[184:187], a[116:119], a[68:71], v[184:187]
    ds_read_b64_tr_b16 a[58:59], v34 offset:34816
    v_mfma_f32_16x16x32_bf16 v[200:203], a[116:119], a[72:75], v[200:203]
    buffer_load_dwordx4 v22, s[20:23], s50 offen offset:0 lds
    v_mfma_f32_16x16x32_bf16 v[216:219], a[116:119], a[76:79], v[216:219]
    ds_read_b128 a[28:31], v26 offset:47104
    v_mfma_f32_16x16x32_bf16 v[232:235], a[116:119], a[80:83], v[232:235]
    v_mfma_f32_16x16x32_bf16 v[248:251], a[116:119], a[84:87], v[248:251]
    ds_read_b64_tr_b16 a[60:61], v35 offset:32768
    v_mfma_f32_16x16x32_bf16 a[148:151], a[116:119], a[88:91], a[148:151]
    buffer_load_dwordx4 v23, s[20:23], s50 offen offset:1024 lds
    v_mfma_f32_16x16x32_bf16 a[180:183], a[116:119], a[92:95], a[180:183]
    ds_read_b64_tr_b16 a[62:63], v35 offset:34816
    v_mfma_f32_16x16x32_bf16 v[76:79], a[120:123], a[64:67], v[76:79]
    v_mfma_f32_16x16x32_bf16 v[92:95], a[120:123], a[68:71], v[92:95]
    buffer_load_dwordx4 v24, s[20:23], s50 offen offset:2048 lds
    v_mfma_f32_16x16x32_bf16 v[108:111], a[120:123], a[72:75], v[108:111]
    v_mfma_f32_16x16x32_bf16 v[124:127], a[120:123], a[76:79], v[124:127]
    v_mfma_f32_16x16x32_bf16 v[140:143], a[120:123], a[80:83], v[140:143]
    v_mfma_f32_16x16x32_bf16 v[156:159], a[120:123], a[84:87], v[156:159]
    buffer_load_dwordx4 v25, s[20:23], s50 offen offset:3072 lds
    v_mfma_f32_16x16x32_bf16 a[152:155], a[120:123], a[88:91], a[152:155]
    v_mfma_f32_16x16x32_bf16 a[184:187], a[120:123], a[92:95], a[184:187]
    s_add_u32 s50, s50, 0x80000
    v_mfma_f32_16x16x32_bf16 v[172:175], a[124:127], a[64:67], v[172:175]
    v_mfma_f32_16x16x32_bf16 v[188:191], a[124:127], a[68:71], v[188:191]
    s_cmp_eq_u32 s51, s53
    s_cbranch_scc1 k12_ool_12
k12_oolret_13:
    v_mfma_f32_16x16x32_bf16 v[204:207], a[124:127], a[72:75], v[204:207]
    v_mfma_f32_16x16x32_bf16 v[220:223], a[124:127], a[76:79], v[220:223]
    s_cmp_eq_u32 s51, s63
    s_cbranch_scc1 k12_ool_14
k12_oolret_15:
    v_mfma_f32_16x16x32_bf16 v[236:239], a[124:127], a[80:83], v[236:239]
    v_mfma_f32_16x16x32_bf16 v[252:255], a[124:127], a[84:87], v[252:255]
    s_add_u32 s51, s51, 1
    v_mfma_f32_16x16x32_bf16 a[156:159], a[124:127], a[88:91], a[156:159]
    v_mfma_f32_16x16x32_bf16 a[188:191], a[124:127], a[92:95], a[188:191]
    s_waitcnt lgkmcnt(0)
    v_mfma_f32_16x16x32_bf16 v[64:67], a[32:35], a[0:3], v[64:67]
    ds_read_b128 a[64:67], v27 offset:32768
    v_mfma_f32_16x16x32_bf16 v[80:83], a[32:35], a[4:7], v[80:83]
    ds_read_b64_tr_b16 a[96:97], v28 offset:49152
    v_mfma_f32_16x16x32_bf16 v[96:99], a[32:35], a[8:11], v[96:99]
    v_mfma_f32_16x16x32_bf16 v[112:115], a[32:35], a[12:15], v[112:115]
    ds_read_b64_tr_b16 a[98:99], v28 offset:51200
    v_mfma_f32_16x16x32_bf16 v[128:131], a[32:35], a[16:19], v[128:131]
    v_mfma_f32_16x16x32_bf16 v[144:147], a[32:35], a[20:23], v[144:147]
    ds_read_b128 a[68:71], v27 offset:34816
    v_mfma_f32_16x16x32_bf16 a[128:131], a[32:35], a[24:27], a[128:131]
    v_mfma_f32_16x16x32_bf16 a[160:163], a[32:35], a[28:31], a[160:163]
    ds_read_b64_tr_b16 a[100:101], v29 offset:49152
    v_mfma_f32_16x16x32_bf16 v[160:163], a[36:39], a[0:3], v[160:163]
    v_mfma_f32_16x16x32_bf16 v[176:179], a[36:39], a[4:7], v[176:179]
    ds_read_b64_tr_b16 a[102:103], v29 offset:51200
    v_mfma_f32_16x16x32_bf16 v[192:195], a[36:39], a[8:11], v[192:195]
    v_mfma_f32_16x16x32_bf16 v[208:211], a[36:39], a[12:15], v[208:211]
    ds_read_b128 a[72:75], v27 offset:36864
    v_mfma_f32_16x16x32_bf16 v[224:227], a[36:39], a[16:19], v[224:227]
    v_mfma_f32_16x16x32_bf16 v[240:243], a[36:39], a[20:23], v[240:243]
    v_mfma_f32_16x16x32_bf16 a[132:135], a[36:39], a[24:27], a[132:135]
    ds_read_b64_tr_b16 a[104:105], v30 offset:49152
    v_mfma_f32_16x16x32_bf16 a[164:167], a[36:39], a[28:31], a[164:167]
    v_mfma_f32_16x16x32_bf16 v[68:71], a[40:43], a[0:3], v[68:71]
    ds_read_b64_tr_b16 a[106:107], v30 offset:51200
    v_mfma_f32_16x16x32_bf16 v[84:87], a[40:43], a[4:7], v[84:87]
    v_mfma_f32_16x16x32_bf16 v[100:103], a[40:43], a[8:11], v[100:103]
    ds_read_b128 a[76:79], v27 offset:38912
    v_mfma_f32_16x16x32_bf16 v[116:119], a[40:43], a[12:15], v[116:119]
    v_mfma_f32_16x16x32_bf16 v[132:135], a[40:43], a[16:19], v[132:135]
    ds_read_b64_tr_b16 a[108:109], v31 offset:49152
    v_mfma_f32_16x16x32_bf16 v[148:151], a[40:43], a[20:23], v[148:151]
    v_mfma_f32_16x16x32_bf16 a[136:139], a[40:43], a[24:27], a[136:139]
    ds_read_b64_tr_b16 a[110:111], v31 offset:51200
    v_mfma_f32_16x16x32_bf16 a[168:171], a[40:43], a[28:31], a[168:171]
    v_mfma_f32_16x16x32_bf16 v[164:167], a[44:47], a[0:3], v[164:167]
    ds_read_b128 a[80:83], v27 offset:40960
    v_mfma_f32_16x16x32_bf16 v[180:183], a[44:47], a[4:7], v[180:183]
    v_mfma_f32_16x16x32_bf16 v[196:199], a[44:47], a[8:11], v[196:199]
    ds_read_b64_tr_b16 a[112:113], v32 offset:49152
    v_mfma_f32_16x16x32_bf16 v[212:215], a[44:47], a[12:15], v[212:215]
    v_mfma_f32_16x16x32_bf16 v[228:231], a[44:47], a[16:19], v[228:231]
    ds_read_b64_tr_b16 a[114:115], v32 offset:51200
    v_mfma_f32_16x16x32_bf16 v[244:247], a[44:47], a[20:23], v[244:247]
    v_mfma_f32_16x16x32_bf16 a[140:143], a[44:47], a[24:27], a[140:143]
    ds_read_b128 a[84:87], v27 offset:43008
    v_mfma_f32_16x16x32_bf16 a[172:175], a[44:47], a[28:31], a[172:175]
    v_mfma_f32_16x16x32_bf16 v[72:75], a[48:51], a[0:3], v[72:75]
    ds_read_b64_tr_b16 a[116:117], v33 offset:49152
    v_mfma_f32_16x16x32_bf16 v[88:91], a[48:51], a[4:7], v[88:91]
    v_mfma_f32_16x16x32_bf16 v[104:107], a[48:51], a[8:11], v[104:107]
    ds_read_b64_tr_b16 a[118:119], v33 offset:51200
    v_mfma_f32_16x16x32_bf16 v[120:123], a[48:51], a[12:15], v[120:123]
    v_mfma_f32_16x16x32_bf16 v[136:139], a[48:51], a[16:19], v[136:139]
    ds_read_b128 a[88:91], v27 offset:45056
    v_mfma_f32_16x16x32_bf16 v[152:155], a[48:51], a[20:23], v[152:155]
    v_mfma_f32_16x16x32_bf16 a[144:147], a[48:51], a[24:27], a[144:147]
    v_mfma_f32_16x16x32_bf16 a[176:179], a[48:51], a[28:31], a[176:179]
    ds_read_b64_tr_b16 a[120:121], v34 offset:49152
    v_mfma_f32_16x16x32_bf16 v[168:171], a[52:55], a[0:3], v[168:171]
    v_mfma_f32_16x16x32_bf16 v[184:187], a[52:55], a[4:7], v[184:187]
    ds_read_b64_tr_b16 a[122:123], v34 offset:51200
    v_mfma_f32_16x16x32_bf16 v[200:203], a[52:55], a[8:11], v[200:203]
    v_mfma_f32_16x16x32_bf16 v[216:219], a[52:55], a[12:15], v[216:219]
    ds_read_b128 a[92:95], v27 offset:47104
    v_mfma_f32_16x16x32_bf16 v[232:235], a[52:55], a[16:19], v[232:235]
    v_mfma_f32_16x16x32_bf16 v[248:251], a[52:55], a[20:23], v[248:251]
    ds_read_b64_tr_b16 a[124:125], v35 offset:49152
    v_mfma_f32_16x16x32_bf16 a[148:151], a[52:55], a[24:27], a[148:151]
    v_mfma_f32_16x16x32_bf16 a[180:183], a[52:55], a[28:31], a[180:183]
    ds_read_b64_tr_b16 a[126:127], v35 offset:51200
    v_mfma_f32_16x16x32_bf16 v[76:79], a[56:59], a[0:3], v[76:79]
    v_mfma_f32_16x16x32_bf16 v[92:95], a[56:59], a[4:7], v[92:95]
    v_mfma_f32_16x16x32_bf16 v[108:111], a[56:59], a[8:11], v[108:111]
    v_mfma_f32_16x16x32_bf16 v[124:127], a[56:59], a[12:15], v[124:127]
    v_mfma_f32_16x16x32_bf16 v[140:143], a[56:59], a[16:19], v[140:143]
    v_mfma_f32_16x16x32_bf16 v[156:159], a[56:59], a[20:23], v[156:159]
    v_mfma_f32_16x16x32_bf16 a[152:155], a[56:59], a[24:27], a[152:155]
    v_mfma_f32_16x16x32_bf16 a[184:187], a[56:59], a[28:31], a[184:187]
    s_sub_u32 s52, s51, 1
    s_cmp_eq_u32 s52, s46
    s_cbranch_scc1 k12_ool_18
k12_oolret_19:
    v_mfma_f32_16x16x32_bf16 v[172:175], a[60:63], a[0:3], v[172:175]
    v_mfma_f32_16x16x32_bf16 v[188:191], a[60:63], a[4:7], v[188:191]
    v_mfma_f32_16x16x32_bf16 v[204:207], a[60:63], a[8:11], v[204:207]
    v_mfma_f32_16x16x32_bf16 v[220:223], a[60:63], a[12:15], v[220:223]
    v_mfma_f32_16x16x32_bf16 v[236:239], a[60:63], a[16:19], v[236:239]
    v_mfma_f32_16x16x32_bf16 v[252:255], a[60:63], a[20:23], v[252:255]
    v_mfma_f32_16x16x32_bf16 a[156:159], a[60:63], a[24:27], a[156:159]
    v_mfma_f32_16x16x32_bf16 a[188:191], a[60:63], a[28:31], a[188:191]
    s_waitcnt vmcnt(0) lgkmcnt(0)
    s_barrier
    s_cmp_eq_u32 s51, 7
    s_cbranch_scc1 k12_last_9
    v_mfma_f32_16x16x32_bf16 v[64:67], a[96:99], a[64:67], v[64:67]
    ds_read_b128 a[0:3], v26 offset:0
    v_mfma_f32_16x16x32_bf16 v[80:83], a[96:99], a[68:71], v[80:83]
    s_add_u32 m0, s48, 32768
    ds_read_b64_tr_b16 a[32:33], v28 offset:0
    v_mfma_f32_16x16x32_bf16 v[96:99], a[96:99], a[72:75], v[96:99]
    buffer_load_dwordx4 v10, s[16:19], s49 offen offset:0 lds
    v_mfma_f32_16x16x32_bf16 v[112:115], a[96:99], a[76:79], v[112:115]
    ds_read_b64_tr_b16 a[34:35], v28 offset:2048
    v_mfma_f32_16x16x32_bf16 v[128:131], a[96:99], a[80:83], v[128:131]
    buffer_load_dwordx4 v11, s[16:19], s49 offen offset:1024 lds
    v_mfma_f32_16x16x32_bf16 v[144:147], a[96:99], a[84:87], v[144:147]
    ds_read_b128 a[4:7], v26 offset:2048
    v_mfma_f32_16x16x32_bf16 a[128:131], a[96:99], a[88:91], a[128:131]
    v_mfma_f32_16x16x32_bf16 a[160:163], a[96:99], a[92:95], a[160:163]
    ds_read_b64_tr_b16 a[36:37], v29 offset:0
    v_mfma_f32_16x16x32_bf16 v[160:163], a[100:103], a[64:67], v[160:163]
    buffer_load_dwordx4 v12, s[16:19], s49 offen offset:2048 lds
    v_mfma_f32_16x16x32_bf16 v[176:179], a[100:103], a[68:71], v[176:179]
    ds_read_b64_tr_b16 a[38:39], v29 offset:2048
    v_mfma_f32_16x16x32_bf16 v[192:195], a[100:103], a[72:75], v[192:195]
    v_mfma_f32_16x16x32_bf16 v[208:211], a[100:103], a[76:79], v[208:211]
    buffer_load_dwordx4 v13, s[16:19], s49 offen offset:3072 lds
    ds_read_b128 a[8:11], v26 offset:4096
    v_mfma_f32_16x16x32_bf16 v[224:227], a[100:103], a[80:83], v[224:227]
    v_mfma_f32_16x16x32_bf16 v[240:243], a[100:103], a[84:87], v[240:243]
    s_add_u32 m0, s48, 36864
    v_mfma_f32_16x16x32_bf16 a[132:135], a[100:103], a[88:91], a[132:135]
    ds_read_b64_tr_b16 a[40:41], v30 offset:0
    v_mfma_f32_16x16x32_bf16 a[164:167], a[100:103], a[92:95], a[164:167]
    buffer_load_dwordx4 v14, s[16:19], s49 offen offset:0 lds
    v_mfma_f32_16x16x32_bf16 v[68:71], a[104:107], a[64:67], v[68:71]
    ds_read_b64_tr_b16 a[42:43], v30 offset:2048
    v_mfma_f32_16x16x32_bf16 v[84:87], a[104:107], a[68:71], v[84:87]
    v_mfma_f32_16x16x32_bf16 v[100:103], a[104:107], a[72:75], v[100:103]
    buffer_load_dwordx4 v15, s[16:19], s49 offen offset:1024 lds
    ds_read_b128 a[12:15], v26 offset:6144
    v_mfma_f32_16x16x32_bf16 v[116:119], a[104:107], a[76:79], v[116:119]
    v_mfma_f32_16x16x32_bf16 v[132:135], a[104:107], a[80:83], v[132:135]
    ds_read_b64_tr_b16 a[44:45], v31 offset:0
    v_mfma_f32_16x16x32_bf16 v[148:151], a[104:107], a[84:87], v[148:151]
    v_mfma_f32_16x16x32_bf16 a[136:139], a[104:107], a[88:91], a[136:139]
    buffer_load_dwordx4 v16, s[16:19], s49 offen offset:2048 lds
    ds_read_b64_tr_b16 a[46:47], v31 offset:2048
    v_mfma_f32_16x16x32_bf16 a[168:171], a[104:107], a[92:95], a[168:171]
    v_mfma_f32_16x16x32_bf16 v[164:167], a[108:111], a[64:67], v[164:167]
    ds_read_b128 a[16:19], v26 offset:8192
    v_mfma_f32_16x16x32_bf16 v[180:183], a[108:111], a[68:71], v[180:183]
    buffer_load_dwordx4 v17, s[16:19], s49 offen offset:3072 lds
    v_mfma_f32_16x16x32_bf16 v[196:199], a[108:111], a[72:75], v[196:199]
    ds_read_b64_tr_b16 a[48:49], v32 offset:0
    v_mfma_f32_16x16x32_bf16 v[212:215], a[108:111], a[76:79], v[212:215]
    s_add_u32 s49, s49, 128
    v_mfma_f32_16x16x32_bf16 v[228:231], a[108:111], a[80:83], v[228:231]
    s_add_u32 m0, s48, 98304
    ds_read_b64_tr_b16 a[50:51], v32 offset:2048
    v_mfma_f32_16x16x32_bf16 v[244:247], a[108:111], a[84:87], v[244:247]
    buffer_load_dwordx4 v18, s[20:23], s50 offen offset:0 lds
    v_mfma_f32_16x16x32_bf16 a[140:143], a[108:111], a[88:91], a[140:143]
    ds_read_b128 a[20:23], v26 offset:10240
    v_mfma_f32_16x16x32_bf16 a[172:175], a[108:111], a[92:95], a[172:175]
    v_mfma_f32_16x16x32_bf16 v[72:75], a[112:115], a[64:67], v[72:75]
    buffer_load_dwordx4 v19, s[20:23], s50 offen offset:1024 lds
    ds_read_b64_tr_b16 a[52:53], v33 offset:0
    v_mfma_f32_16x16x32_bf16 v[88:91], a[112:115], a[68:71], v[88:91]
    v_mfma_f32_16x16x32_bf16 v[104:107], a[112:115], a[72:75], v[104:107]
    ds_read_b64_tr_b16 a[54:55], v33 offset:2048
    v_mfma_f32_16x16x32_bf16 v[120:123], a[112:115], a[76:79], v[120:123]
    buffer_load_dwordx4 v20, s[20:23], s50 offen offset:2048 lds
    v_mfma_f32_16x16x32_bf16 v[136:139], a[112:115], a[80:83], v[136:139]
    ds_read_b128 a[24:27], v26 offset:12288
    v_mfma_f32_16x16x32_bf16 v[152:155], a[112:115], a[84:87], v[152:155]
    v_mfma_f32_16x16x32_bf16 a[144:147], a[112:115], a[88:91], a[144:147]
    v_mfma_f32_16x16x32_bf16 a[176:179], a[112:115], a[92:95], a[176:179]
    buffer_load_dwordx4 v21, s[20:23], s50 offen offset:3072 lds
    ds_read_b64_tr_b16 a[56:57], v34 offset:0
    v_mfma_f32_16x16x32_bf16 v[168:171], a[116:119], a[64:67], v[168:171]
    s_add_u32 m0, s48, 102400
    v_mfma_f32_16x16x32_bf16 v[184:187], a[116:119], a[68:71], v[184:187]
    ds_read_b64_tr_b16 a[58:59], v34 offset:2048
    v_mfma_f32_16x16x32_bf16 v[200:203], a[116:119], a[72:75], v[200:203]
    buffer_load_dwordx4 v22, s[20:23], s50 offen offset:0 lds
    v_mfma_f32_16x16x32_bf16 v[216:219], a[116:119], a[76:79], v[216:219]
    ds_read_b128 a[28:31], v26 offset:14336
    v_mfma_f32_16x16x32_bf16 v[232:235], a[116:119], a[80:83], v[232:235]
    v_mfma_f32_16x16x32_bf16 v[248:251], a[116:119], a[84:87], v[248:251]
    ds_read_b64_tr_b16 a[60:61], v35 offset:0
    v_mfma_f32_16x16x32_bf16 a[148:151], a[116:119], a[88:91], a[148:151]
    buffer_load_dwordx4 v23, s[20:23], s50 offen offset:1024 lds
    v_mfma_f32_16x16x32_bf16 a[180:183], a[116:119], a[92:95], a[180:183]
    ds_read_b64_tr_b16 a[62:63], v35 offset:2048
    v_mfma_f32_16x16x32_bf16 v[76:79], a[120:123], a[64:67], v[76:79]
    v_mfma_f32_16x16x32_bf16 v[92:95], a[120:123], a[68:71], v[92:95]
    buffer_load_dwordx4 v24, s[20:23], s50 offen offset:2048 lds
    v_mfma_f32_16x16x32_bf16 v[108:111], a[120:123], a[72:75], v[108:111]
    v_mfma_f32_16x16x32_bf16 v[124:127], a[120:123], a[76:79], v[124:127]
    v_mfma_f32_16x16x32_bf16 v[140:143], a[120:123], a[80:83], v[140:143]
    v_mfma_f32_16x16x32_bf16 v[156:159], a[120:123], a[84:87], v[156:159]
    buffer_load_dwordx4 v25, s[20:23], s50 offen offset:3072 lds
    v_mfma_f32_16x16x32_bf16 a[152:155], a[120:123], a[88:91], a[152:155]
    v_mfma_f32_16x16x32_bf16 a[184:187], a[120:123], a[92:95], a[184:187]
    s_add_u32 s50, s50, 0x80000
    v_mfma_f32_16x16x32_bf16 v[172:175], a[124:127], a[64:67], v[172:175]
    v_mfma_f32_16x16x32_bf16 v[188:191], a[124:127], a[68:71], v[188:191]
    s_cmp_eq_u32 s51, s53
    s_cbranch_scc1 k12_ool_20
k12_oolret_21:
    v_mfma_f32_16x16x32_bf16 v[204:207], a[124:127], a[72:75], v[204:207]
    v_mfma_f32_16x16x32_bf16 v[220:223], a[124:127], a[76:79], v[220:223]
    s_cmp_eq_u32 s51, 5
    s_cbranch_scc1 k12_ool_22
k12_oolret_23:
    v_mfma_f32_16x16x32_bf16 v[236:239], a[124:127], a[80:83], v[236:239]
    v_mfma_f32_16x16x32_bf16 v[252:255], a[124:127], a[84:87], v[252:255]
    s_add_u32 s51, s51, 1
    v_mfma_f32_16x16x32_bf16 a[156:159], a[124:127], a[88:91], a[156:159]
    v_mfma_f32_16x16x32_bf16 a[188:191], a[124:127], a[92:95], a[188:191]
    s_waitcnt lgkmcnt(0)
    s_branch k12_loop_8
k12_last_9:
    v_mfma_f32_16x16x32_bf16 v[64:67], a[96:99], a[64:67], v[64:67]
    s_add_u32 m0, s60, 98304
    v_mfma_f32_16x16x32_bf16 v[160:163], a[100:103], a[64:67], v[160:163]
    buffer_load_dwordx4 v38, s[12:15], s61 offen offset:0 lds
    v_mfma_f32_16x16x32_bf16 v[68:71], a[104:107], a[64:67], v[68:71]
    buffer_load_dwordx4 v39, s[12:15], s61 offen offset:1024 lds
    v_mfma_f32_16x16x32_bf16 v[164:167], a[108:111], a[64:67], v[164:167]
    v_mfma_f32_16x16x32_bf16 v[72:75], a[112:115], a[64:67], v[72:75]
    buffer_load_dwordx4 v40, s[12:15], s61 offen offset:2048 lds
    v_mfma_f32_16x16x32_bf16 v[168:171], a[116:119], a[64:67], v[168:171]
    v_cvt_pk_bf16_f32 v64, v64, v65
    v_cvt_pk_bf16_f32 v65, v66, v67
    v_cvt_pk_bf16_f32 v66, v160, v161
    v_mfma_f32_16x16x32_bf16 v[76:79], a[120:123], a[64:67], v[76:79]
    v_cvt_pk_bf16_f32 v67, v162, v163
    v_mfma_f32_16x16x32_bf16 v[172:175], a[124:127], a[64:67], v[172:175]
    v_cvt_pk_bf16_f32 v68, v68, v69
    v_cvt_pk_bf16_f32 v69, v70, v71
    v_cvt_pk_bf16_f32 v70, v164, v165
    v_mfma_f32_16x16x32_bf16 v[80:83], a[96:99], a[68:71], v[80:83]
    buffer_load_dwordx4 v41, s[12:15], s61 offen offset:3072 lds
    v_mfma_f32_16x16x32_bf16 v[176:179], a[100:103], a[68:71], v[176:179]
    s_add_u32 s61, s61, 0x80000
    v_cvt_pk_bf16_f32 v71, v166, v167
    v_cvt_pk_bf16_f32 v72, v72, v73
    v_cvt_pk_bf16_f32 v73, v74, v75
    v_mfma_f32_16x16x32_bf16 v[84:87], a[104:107], a[68:71], v[84:87]
    buffer_load_dwordx4 a[192:195], v36, s[8:11], s62 offen sc1
    buffer_load_dwordx4 a[196:199], v54, s[8:11], s62 offen sc1
    v_mfma_f32_16x16x32_bf16 v[180:183], a[108:111], a[68:71], v[180:183]
    v_cvt_pk_bf16_f32 v74, v168, v169
    v_cvt_pk_bf16_f32 v75, v170, v171
    v_cvt_pk_bf16_f32 v76, v76, v77
    v_mfma_f32_16x16x32_bf16 v[88:91], a[112:115], a[68:71], v[88:91]
    v_cvt_pk_bf16_f32 v77, v78, v79
    v_cvt_pk_bf16_f32 v78, v172, v173
    v_cvt_pk_bf16_f32 v79, v174, v175
    v_mfma_f32_16x16x32_bf16 v[184:187], a[116:119], a[68:71], v[184:187]
    v_cvt_pk_bf16_f32 v80, v80, v81
    v_cvt_pk_bf16_f32 v81, v82, v83
    v_cvt_pk_bf16_f32 v82, v176, v177
    v_mfma_f32_16x16x32_bf16 v[92:95], a[120:123], a[68:71], v[92:95]
    buffer_load_dwordx4 a[200:203], v37, s[8:11], s62 offen sc1
    buffer_load_dwordx4 a[204:207], v55, s[8:11], s62 offen sc1
    v_mfma_f32_16x16x32_bf16 v[188:191], a[124:127], a[68:71], v[188:191]
    s_add_u32 s62, s62, 0x20000
    v_cvt_pk_bf16_f32 v83, v178, v179
    v_cvt_pk_bf16_f32 v84, v84, v85
    v_cvt_pk_bf16_f32 v85, v86, v87
    v_mfma_f32_16x16x32_bf16 a[128:131], a[96:99], a[88:91], a[128:131]
    v_cvt_pk_bf16_f32 v86, v180, v181
    v_cvt_pk_bf16_f32 v87, v182, v183
    v_mfma_f32_16x16x32_bf16 a[132:135], a[100:103], a[88:91], a[132:135]
    v_cvt_pk_bf16_f32 v88, v88, v89
    v_cvt_pk_bf16_f32 v89, v90, v91
    v_cvt_pk_bf16_f32 v90, v184, v185
    v_mfma_f32_16x16x32_bf16 v[96:99], a[96:99], a[72:75], v[96:99]
    buffer_load_dwordx4 a[208:211], v36, s[8:11], s62 offen sc1
    buffer_load_dwordx4 a[212:215], v54, s[8:11], s62 offen sc1
    v_mfma_f32_16x16x32_bf16 v[192:195], a[100:103], a[72:75], v[192:195]
    v_cvt_pk_bf16_f32 v91, v186, v187
    v_cvt_pk_bf16_f32 v92, v92, v93
    v_cvt_pk_bf16_f32 v93, v94, v95
    v_mfma_f32_16x16x32_bf16 v[100:103], a[104:107], a[72:75], v[100:103]
    v_cvt_pk_bf16_f32 v94, v188, v189
    v_cvt_pk_bf16_f32 v95, v190, v191
    v_mfma_f32_16x16x32_bf16 v[196:199], a[108:111], a[72:75], v[196:199]
    v_accvgpr_read_b32 v56, a128
    v_accvgpr_read_b32 v57, a129
    v_accvgpr_read_b32 v58, a130
    v_mfma_f32_16x16x32_bf16 a[136:139], a[104:107], a[88:91], a[136:139]
    buffer_load_dwordx4 a[216:219], v37, s[8:11], s62 offen sc1
    buffer_load_dwordx4 a[220:223], v55, s[8:11], s62 offen sc1
    v_mfma_f32_16x16x32_bf16 a[140:143], a[108:111], a[88:91], a[140:143]
    s_add_u32 s62, s62, 0x20000
    v_accvgpr_read_b32 v59, a131
    v_accvgpr_read_b32 v60, a132
    v_cvt_pk_bf16_f32 v96, v96, v97
    v_mfma_f32_16x16x32_bf16 v[104:107], a[112:115], a[72:75], v[104:107]
    s_add_u32 m0, s60, 114688
    v_accvgpr_read_b32 v61, a133
    v_accvgpr_read_b32 v62, a134
    v_cvt_pk_bf16_f32 v97, v98, v99
    v_mfma_f32_16x16x32_bf16 v[200:203], a[116:119], a[72:75], v[200:203]
    v_accvgpr_read_b32 v63, a135
    v_cvt_pk_bf16_f32 v98, v192, v193
    v_cvt_pk_bf16_f32 v160, v56, v57
    v_mfma_f32_16x16x32_bf16 v[108:111], a[120:123], a[72:75], v[108:111]
    v_cvt_pk_bf16_f32 v99, v194, v195
    v_cvt_pk_bf16_f32 v161, v58, v59
    v_cvt_pk_bf16_f32 v100, v100, v101
    v_mfma_f32_16x16x32_bf16 v[204:207], a[124:127], a[72:75], v[204:207]
    buffer_load_dwordx4 v38, s[12:15], s61 offen offset:0 lds
    buffer_load_dwordx4 v39, s[12:15], s61 offen offset:1024 lds
    v_mfma_f32_16x16x32_bf16 a[144:147], a[112:115], a[88:91], a[144:147]
    v_cvt_pk_bf16_f32 v162, v60, v61
    v_cvt_pk_bf16_f32 v101, v102, v103
    v_cvt_pk_bf16_f32 v163, v62, v63
    v_mfma_f32_16x16x32_bf16 a[148:151], a[116:119], a[88:91], a[148:151]
    v_cvt_pk_bf16_f32 v102, v196, v197
    v_cvt_pk_bf16_f32 v103, v198, v199
    v_accvgpr_read_b32 v56, a136
    v_mfma_f32_16x16x32_bf16 v[112:115], a[96:99], a[76:79], v[112:115]
    v_accvgpr_read_b32 v57, a137
    v_accvgpr_read_b32 v58, a138
    v_accvgpr_read_b32 v59, a139
    v_mfma_f32_16x16x32_bf16 v[208:211], a[100:103], a[76:79], v[208:211]
    v_accvgpr_read_b32 v60, a140
    v_cvt_pk_bf16_f32 v104, v104, v105
    v_accvgpr_read_b32 v61, a141
    v_mfma_f32_16x16x32_bf16 v[116:119], a[104:107], a[76:79], v[116:119]
    buffer_load_dwordx4 v40, s[12:15], s61 offen offset:2048 lds
    buffer_load_dwordx4 v41, s[12:15], s61 offen offset:3072 lds
    v_mfma_f32_16x16x32_bf16 v[212:215], a[108:111], a[76:79], v[212:215]
    s_add_u32 s61, s61, 0x80000
    v_accvgpr_read_b32 v62, a142
    v_cvt_pk_bf16_f32 v105, v106, v107
    v_accvgpr_read_b32 v63, a143
    v_mfma_f32_16x16x32_bf16 a[152:155], a[120:123], a[88:91], a[152:155]
    v_cvt_pk_bf16_f32 v106, v200, v201
    v_cvt_pk_bf16_f32 v164, v56, v57
    v_cvt_pk_bf16_f32 v107, v202, v203
    v_mfma_f32_16x16x32_bf16 a[156:159], a[124:127], a[88:91], a[156:159]
    v_cvt_pk_bf16_f32 v165, v58, v59
    v_cvt_pk_bf16_f32 v108, v108, v109
    v_cvt_pk_bf16_f32 v166, v60, v61
    v_mfma_f32_16x16x32_bf16 v[120:123], a[112:115], a[76:79], v[120:123]
    v_cvt_pk_bf16_f32 v109, v110, v111
    v_cvt_pk_bf16_f32 v167, v62, v63
    v_cvt_pk_bf16_f32 v110, v204, v205
    v_mfma_f32_16x16x32_bf16 v[216:219], a[116:119], a[76:79], v[216:219]
    buffer_load_dwordx4 a[224:227], v36, s[8:11], s62 offen sc1
    v_cvt_pk_bf16_f32 v111, v206, v207
    v_accvgpr_read_b32 v56, a144
    v_mfma_f32_16x16x32_bf16 v[124:127], a[120:123], a[76:79], v[124:127]
    v_accvgpr_read_b32 v57, a145
    v_accvgpr_read_b32 v58, a146
    v_accvgpr_read_b32 v59, a147
    v_mfma_f32_16x16x32_bf16 v[220:223], a[124:127], a[76:79], v[220:223]
    buffer_load_dwordx4 a[228:231], v54, s[8:11], s62 offen sc1
    v_accvgpr_read_b32 v60, a148
    v_cvt_pk_bf16_f32 v112, v112, v113
    v_mfma_f32_16x16x32_bf16 a[160:163], a[96:99], a[92:95], a[160:163]
    v_accvgpr_read_b32 v61, a149
    v_accvgpr_read_b32 v62, a150
    v_cvt_pk_bf16_f32 v113, v114, v115
    v_mfma_f32_16x16x32_bf16 a[164:167], a[100:103], a[92:95], a[164:167]
    v_accvgpr_read_b32 v63, a151
    v_cvt_pk_bf16_f32 v114, v208, v209
    v_cvt_pk_bf16_f32 v168, v56, v57
    v_mfma_f32_16x16x32_bf16 v[128:131], a[96:99], a[80:83], v[128:131]
    v_cvt_pk_bf16_f32 v115, v210, v211
    v_cvt_pk_bf16_f32 v169, v58, v59
    v_cvt_pk_bf16_f32 v116, v116, v117
    v_mfma_f32_16x16x32_bf16 v[224:227], a[100:103], a[80:83], v[224:227]
    buffer_load_dwordx4 a[232:235], v37, s[8:11], s62 offen sc1
    v_cvt_pk_bf16_f32 v170, v60, v61
    v_cvt_pk_bf16_f32 v117, v118, v119
    v_mfma_f32_16x16x32_bf16 v[132:135], a[104:107], a[80:83], v[132:135]
    v_cvt_pk_bf16_f32 v171, v62, v63
    v_cvt_pk_bf16_f32 v118, v212, v213
    v_cvt_pk_bf16_f32 v119, v214, v215
    v_mfma_f32_16x16x32_bf16 v[228:231], a[108:111], a[80:83], v[228:231]
    buffer_load_dwordx4 a[236:239], v55, s[8:11], s62 offen sc1
    v_accvgpr_read_b32 v56, a152
    v_accvgpr_read_b32 v57, a153
    v_mfma_f32_16x16x32_bf16 a[168:171], a[104:107], a[92:95], a[168:171]
    s_add_u32 s62, s62, 0x20000
    v_accvgpr_read_b32 v58, a154
    v_accvgpr_read_b32 v59, a155
    v_accvgpr_read_b32 v60, a156
    v_mfma_f32_16x16x32_bf16 a[172:175], a[108:111], a[92:95], a[172:175]
    s_waitcnt vmcnt(16)
    s_barrier
    v_cvt_pk_bf16_f32 v120, v120, v121
    v_accvgpr_read_b32 v61, a157
    v_accvgpr_read_b32 v62, a158
    v_mfma_f32_16x16x32_bf16 v[136:139], a[112:115], a[80:83], v[136:139]
    v_cvt_pk_bf16_f32 v121, v122, v123
    v_accvgpr_read_b32 v63, a159
    v_cvt_pk_bf16_f32 v122, v216, v217
    v_mfma_f32_16x16x32_bf16 v[232:235], a[116:119], a[80:83], v[232:235]
    v_cvt_pk_bf16_f32 v172, v56, v57
    v_cvt_pk_bf16_f32 v123, v218, v219
    v_cvt_pk_bf16_f32 v173, v58, v59
    v_mfma_f32_16x16x32_bf16 v[140:143], a[120:123], a[80:83], v[140:143]
    v_cvt_pk_bf16_f32 v124, v124, v125
    v_cvt_pk_bf16_f32 v174, v60, v61
    v_cvt_pk_bf16_f32 v125, v126, v127
    v_mfma_f32_16x16x32_bf16 v[236:239], a[124:127], a[80:83], v[236:239]
    v_cvt_pk_bf16_f32 v175, v62, v63
    v_cvt_pk_bf16_f32 v126, v220, v221
    v_cvt_pk_bf16_f32 v127, v222, v223
    v_mfma_f32_16x16x32_bf16 a[176:179], a[112:115], a[92:95], a[176:179]
    ds_read_b64_tr_b16 a[0:1], v42 offset:0
    v_accvgpr_read_b32 v56, a160
    v_accvgpr_read_b32 v57, a161
    v_mfma_f32_16x16x32_bf16 a[180:183], a[116:119], a[92:95], a[180:183]
    ds_read_b64_tr_b16 a[2:3], v42 offset:1024
    v_accvgpr_read_b32 v58, a162
    v_accvgpr_read_b32 v59, a163
    v_mfma_f32_16x16x32_bf16 v[144:147], a[96:99], a[84:87], v[144:147]
    ds_read_b64_tr_b16 a[4:5], v43 offset:0
    v_accvgpr_read_b32 v60, a164
    v_cvt_pk_bf16_f32 v128, v128, v129
    v_mfma_f32_16x16x32_bf16 v[240:243], a[100:103], a[84:87], v[240:243]
    v_accvgpr_read_b32 v61, a165
    v_accvgpr_read_b32 v62, a166
    v_cvt_pk_bf16_f32 v129, v130, v131
    v_mfma_f32_16x16x32_bf16 v[148:151], a[104:107], a[84:87], v[148:151]
    ds_read_b64_tr_b16 a[6:7], v43 offset:1024
    v_accvgpr_read_b32 v63, a167
    v_cvt_pk_bf16_f32 v130, v224, v225
    v_mfma_f32_16x16x32_bf16 v[244:247], a[108:111], a[84:87], v[244:247]
    v_cvt_pk_bf16_f32 v176, v56, v57
    v_cvt_pk_bf16_f32 v131, v226, v227
    v_cvt_pk_bf16_f32 v177, v58, v59
    v_mfma_f32_16x16x32_bf16 a[184:187], a[120:123], a[92:95], a[184:187]
    ds_read_b64_tr_b16 a[8:9], v44 offset:0
    v_cvt_pk_bf16_f32 v132, v132, v133
    v_cvt_pk_bf16_f32 v178, v60, v61
    v_mfma_f32_16x16x32_bf16 a[188:191], a[124:127], a[92:95], a[188:191]
    ds_read_b64_tr_b16 a[10:11], v44 offset:1024
    v_cvt_pk_bf16_f32 v133, v134, v135
    v_cvt_pk_bf16_f32 v179, v62, v63
    v_mfma_f32_16x16x32_bf16 v[152:155], a[112:115], a[84:87], v[152:155]
    ds_read_b64_tr_b16 a[12:13], v45 offset:0
    v_cvt_pk_bf16_f32 v134, v228, v229
    v_cvt_pk_bf16_f32 v135, v230, v231
    v_mfma_f32_16x16x32_bf16 v[248:251], a[116:119], a[84:87], v[248:251]
    ds_read_b64_tr_b16 a[14:15], v45 offset:1024
    v_accvgpr_read_b32 v56, a168
    v_accvgpr_read_b32 v57, a169
    v_mfma_f32_16x16x32_bf16 v[156:159], a[120:123], a[84:87], v[156:159]
    ds_read_b64_tr_b16 a[16:17], v46 offset:0
    v_accvgpr_read_b32 v58, a170
    v_accvgpr_read_b32 v59, a171
    v_mfma_f32_16x16x32_bf16 v[252:255], a[124:127], a[84:87], v[252:255]
    v_accvgpr_read_b32 v60, a172
    v_cvt_pk_bf16_f32 v136, v136, v137
    v_accvgpr_read_b32 v61, a173
    ds_read_b64_tr_b16 a[18:19], v46 offset:1024
    v_accvgpr_read_b32 v62, a174
    v_cvt_pk_bf16_f32 v137, v138, v139
    v_accvgpr_read_b32 v63, a175
    v_cvt_pk_bf16_f32 v138, v232, v233
    v_cvt_pk_bf16_f32 v180, v56, v57
    ds_read_b64_tr_b16 a[20:21], v47 offset:0
    v_cvt_pk_bf16_f32 v139, v234, v235
    v_cvt_pk_bf16_f32 v181, v58, v59
    v_cvt_pk_bf16_f32 v140, v140, v141
    v_cvt_pk_bf16_f32 v182, v60, v61
    ds_read_b64_tr_b16 a[22:23], v47 offset:1024
    v_cvt_pk_bf16_f32 v141, v142, v143
    v_cvt_pk_bf16_f32 v183, v62, v63
    v_cvt_pk_bf16_f32 v142, v236, v237
    ds_read_b64_tr_b16 a[24:25], v48 offset:0
    v_cvt_pk_bf16_f32 v143, v238, v239
    v_accvgpr_read_b32 v56, a176
    ds_read_b64_tr_b16 a[26:27], v48 offset:1024
    v_accvgpr_read_b32 v57, a177
    v_accvgpr_read_b32 v58, a178
    ds_read_b64_tr_b16 a[28:29], v49 offset:0
    v_accvgpr_read_b32 v59, a179
    v_accvgpr_read_b32 v60, a180
    v_cvt_pk_bf16_f32 v144, v144, v145
    ds_read_b64_tr_b16 a[30:31], v49 offset:1024
    v_accvgpr_read_b32 v61, a181
    v_accvgpr_read_b32 v62, a182
    v_cvt_pk_bf16_f32 v145, v146, v147
    v_accvgpr_read_b32 v63, a183
    v_cvt_pk_bf16_f32 v146, v240, v241
    v_cvt_pk_bf16_f32 v184, v56, v57
    v_cvt_pk_bf16_f32 v147, v242, v243
    v_cvt_pk_bf16_f32 v185, v58, v59
    v_cvt_pk_bf16_f32 v148, v148, v149
    v_cvt_pk_bf16_f32 v186, v60, v61
    v_cvt_pk_bf16_f32 v149, v150, v151
    v_cvt_pk_bf16_f32 v187, v62, v63
    v_cvt_pk_bf16_f32 v150, v244, v245
    v_cvt_pk_bf16_f32 v151, v246, v247
    v_accvgpr_read_b32 v56, a184
    v_accvgpr_read_b32 v57, a185
    v_accvgpr_read_b32 v58, a186
    v_accvgpr_read_b32 v59, a187
    v_accvgpr_read_b32 v60, a188
    v_cvt_pk_bf16_f32 v152, v152, v153
    v_accvgpr_read_b32 v61, a189
    v_accvgpr_read_b32 v62, a190
    v_cvt_pk_bf16_f32 v153, v154, v155
    v_accvgpr_read_b32 v63, a191
    v_cvt_pk_bf16_f32 v154, v248, v249
    v_cvt_pk_bf16_f32 v188, v56, v57
    v_cvt_pk_bf16_f32 v155, v250, v251
    v_cvt_pk_bf16_f32 v189, v58, v59
    v_cvt_pk_bf16_f32 v156, v156, v157
    v_cvt_pk_bf16_f32 v190, v60, v61
    v_cvt_pk_bf16_f32 v157, v158, v159
    v_cvt_pk_bf16_f32 v191, v62, v63
    v_cvt_pk_bf16_f32 v158, v252, v253
    v_cvt_pk_bf16_f32 v159, v254, v255
    s_branch k12_join_7
k12_v_6:
k12_loop_24:
    v_mfma_f32_16x16x32_bf16 v[64:67], a[0:3], a[32:35], v[64:67]
    ds_read_b128 a[64:67], v27 offset:0
    v_mfma_f32_16x16x32_bf16 v[68:71], a[0:3], a[36:39], v[68:71]
    ds_read_b64_tr_b16 a[96:97], v28 offset:16384
    v_mfma_f32_16x16x32_bf16 v[72:75], a[0:3], a[40:43], v[72:75]
    v_mfma_f32_16x16x32_bf16 v[76:79], a[0:3], a[44:47], v[76:79]
    s_cmp_eq_u32 s51, s46
    s_cbranch_scc1 k12_ool_26
k12_oolret_27:
    v_mfma_f32_16x16x32_bf16 v[80:83], a[0:3], a[48:51], v[80:83]
    ds_read_b64_tr_b16 a[98:99], v28 offset:18432
    v_mfma_f32_16x16x32_bf16 v[84:87], a[0:3], a[52:55], v[84:87]
    ds_read_b128 a[68:71], v27 offset:2048
    v_mfma_f32_16x16x32_bf16 v[88:91], a[0:3], a[56:59], v[88:91]
    v_mfma_f32_16x16x32_bf16 v[92:95], a[0:3], a[60:63], v[92:95]
    ds_read_b64_tr_b16 a[100:101], v29 offset:16384
    v_mfma_f32_16x16x32_bf16 v[160:163], a[4:7], a[32:35], v[160:163]
    v_mfma_f32_16x16x32_bf16 v[164:167], a[4:7], a[36:39], v[164:167]
    ds_read_b64_tr_b16 a[102:103], v29 offset:18432
    v_mfma_f32_16x16x32_bf16 v[168:171], a[4:7], a[40:43], v[168:171]
    v_mfma_f32_16x16x32_bf16 v[172:175], a[4:7], a[44:47], v[172:175]
    ds_read_b128 a[72:75], v27 offset:4096
    v_mfma_f32_16x16x32_bf16 v[176:179], a[4:7], a[48:51], v[176:179]
    v_mfma_f32_16x16x32_bf16 v[180:183], a[4:7], a[52:55], v[180:183]
    v_mfma_f32_16x16x32_bf16 v[184:187], a[4:7], a[56:59], v[184:187]
    ds_read_b64_tr_b16 a[104:105], v30 offset:16384
    v_mfma_f32_16x16x32_bf16 v[188:191], a[4:7], a[60:63], v[188:191]
    v_mfma_f32_16x16x32_bf16 v[96:99], a[8:11], a[32:35], v[96:99]
    ds_read_b64_tr_b16 a[106:107], v30 offset:18432
    v_mfma_f32_16x16x32_bf16 v[100:103], a[8:11], a[36:39], v[100:103]
    v_mfma_f32_16x16x32_bf16 v[104:107], a[8:11], a[40:43], v[104:107]
    ds_read_b128 a[76:79], v27 offset:6144
    v_mfma_f32_16x16x32_bf16 v[108:111], a[8:11], a[44:47], v[108:111]
    v_mfma_f32_16x16x32_bf16 v[112:115], a[8:11], a[48:51], v[112:115]
    ds_read_b64_tr_b16 a[108:109], v31 offset:16384
    v_mfma_f32_16x16x32_bf16 v[116:119], a[8:11], a[52:55], v[116:119]
    v_mfma_f32_16x16x32_bf16 v[120:123], a[8:11], a[56:59], v[120:123]
    ds_read_b64_tr_b16 a[110:111], v31 offset:18432
    v_mfma_f32_16x16x32_bf16 v[124:127], a[8:11], a[60:63], v[124:127]
    v_mfma_f32_16x16x32_bf16 v[192:195], a[12:15], a[32:35], v[192:195]
    ds_read_b128 a[80:83], v27 offset:8192
    v_mfma_f32_16x16x32_bf16 v[196:199], a[12:15], a[36:39], v[196:199]
    v_mfma_f32_16x16x32_bf16 v[200:203], a[12:15], a[40:43], v[200:203]
    ds_read_b64_tr_b16 a[112:113], v32 offset:16384
    v_mfma_f32_16x16x32_bf16 v[204:207], a[12:15], a[44:47], v[204:207]
    v_mfma_f32_16x16x32_bf16 v[208:211], a[12:15], a[48:51], v[208:211]
    ds_read_b64_tr_b16 a[114:115], v32 offset:18432
    v_mfma_f32_16x16x32_bf16 v[212:215], a[12:15], a[52:55], v[212:215]
    v_mfma_f32_16x16x32_bf16 v[216:219], a[12:15], a[56:59], v[216:219]
    ds_read_b128 a[84:87], v27 offset:10240
    v_mfma_f32_16x16x32_bf16 v[220:223], a[12:15], a[60:63], v[220:223]
    v_mfma_f32_16x16x32_bf16 v[128:131], a[16:19], a[32:35], v[128:131]
    ds_read_b64_tr_b16 a[116:117], v33 offset:16384
    v_mfma_f32_16x16x32_bf16 v[132:135], a[16:19], a[36:39], v[132:135]
    v_mfma_f32_16x16x32_bf16 v[136:139], a[16:19], a[40:43], v[136:139]
    ds_read_b64_tr_b16 a[118:119], v33 offset:18432
    v_mfma_f32_16x16x32_bf16 v[140:143], a[16:19], a[44:47], v[140:143]
    v_mfma_f32_16x16x32_bf16 v[144:147], a[16:19], a[48:51], v[144:147]
    ds_read_b128 a[88:91], v27 offset:12288
    v_mfma_f32_16x16x32_bf16 v[148:151], a[16:19], a[52:55], v[148:151]
    v_mfma_f32_16x16x32_bf16 v[152:155], a[16:19], a[56:59], v[152:155]
    v_mfma_f32_16x16x32_bf16 v[156:159], a[16:19], a[60:63], v[156:159]
    ds_read_b64_tr_b16 a[120:121], v34 offset:16384
    v_mfma_f32_16x16x32_bf16 v[224:227], a[20:23], a[32:35], v[224:227]
    v_mfma_f32_16x16x32_bf16 v[228:231], a[20:23], a[36:39], v[228:231]
    ds_read_b64_tr_b16 a[122:123], v34 offset:18432
    v_mfma_f32_16x16x32_bf16 v[232:235], a[20:23], a[40:43], v[232:235]
    v_mfma_f32_16x16x32_bf16 v[236:239], a[20:23], a[44:47], v[236:239]
    ds_read_b128 a[92:95], v27 offset:14336
    v_mfma_f32_16x16x32_bf16 v[240:243], a[20:23], a[48:51], v[240:243]
    v_mfma_f32_16x16x32_bf16 v[244:247], a[20:23], a[52:55], v[244:247]
    ds_read_b64_tr_b16 a[124:125], v35 offset:16384
    v_mfma_f32_16x16x32_bf16 v[248:251], a[20:23], a[56:59], v[248:251]
    v_mfma_f32_16x16x32_bf16 v[252:255], a[20:23], a[60:63], v[252:255]
    ds_read_b64_tr_b16 a[126:127], v35 offset:18432
    v_mfma_f32_16x16x32_bf16 a[128:131], a[24:27], a[32:35], a[128:131]
    v_mfma_f32_16x16x32_bf16 a[136:139], a[24:27], a[36:39], a[136:139]
    v_mfma_f32_16x16x32_bf16 a[144:147], a[24:27], a[40:43], a[144:147]
    v_mfma_f32_16x16x32_bf16 a[152:155], a[24:27], a[44:47], a[152:155]
    v_mfma_f32_16x16x32_bf16 a[160:163], a[24:27], a[48:51], a[160:163]
    v_mfma_f32_16x16x32_bf16 a[168:171], a[24:27], a[52:55], a[168:171]
    v_mfma_f32_16x16x32_bf16 a[176:179], a[24:27], a[56:59], a[176:179]
    v_mfma_f32_16x16x32_bf16 a[184:187], a[24:27], a[60:63], a[184:187]
    v_mfma_f32_16x16x32_bf16 a[132:135], a[28:31], a[32:35], a[132:135]
    v_mfma_f32_16x16x32_bf16 a[140:143], a[28:31], a[36:39], a[140:143]
    v_mfma_f32_16x16x32_bf16 a[148:151], a[28:31], a[40:43], a[148:151]
    v_mfma_f32_16x16x32_bf16 a[156:159], a[28:31], a[44:47], a[156:159]
    v_mfma_f32_16x16x32_bf16 a[164:167], a[28:31], a[48:51], a[164:167]
    v_mfma_f32_16x16x32_bf16 a[172:175], a[28:31], a[52:55], a[172:175]
    v_mfma_f32_16x16x32_bf16 a[180:183], a[28:31], a[56:59], a[180:183]
    v_mfma_f32_16x16x32_bf16 a[188:191], a[28:31], a[60:63], a[188:191]
    s_waitcnt vmcnt(0) lgkmcnt(0)
    s_barrier
    v_mfma_f32_16x16x32_bf16 v[64:67], a[64:67], a[96:99], v[64:67]
    s_cmp_ge_u32 s49, 1024
    s_cselect_b32 s18, 0, s18
    s_cselect_b32 s22, 0, s22
    ds_read_b128 a[0:3], v26 offset:32768
    v_mfma_f32_16x16x32_bf16 v[68:71], a[64:67], a[100:103], v[68:71]
    s_add_u32 m0, s48, 0
    ds_read_b64_tr_b16 a[32:33], v28 offset:32768
    v_mfma_f32_16x16x32_bf16 v[72:75], a[64:67], a[104:107], v[72:75]
    buffer_load_dwordx4 v10, s[16:19], s49 offen offset:0 lds
    v_mfma_f32_16x16x32_bf16 v[76:79], a[64:67], a[108:111], v[76:79]
    ds_read_b64_tr_b16 a[34:35], v28 offset:34816
    v_mfma_f32_16x16x32_bf16 v[80:83], a[64:67], a[112:115], v[80:83]
    buffer_load_dwordx4 v11, s[16:19], s49 offen offset:1024 lds
    v_mfma_f32_16x16x32_bf16 v[84:87], a[64:67], a[116:119], v[84:87]
    ds_read_b128 a[4:7], v26 offset:34816
    v_mfma_f32_16x16x32_bf16 v[88:91], a[64:67], a[120:123], v[88:91]
    v_mfma_f32_16x16x32_bf16 v[92:95], a[64:67], a[124:127], v[92:95]
    ds_read_b64_tr_b16 a[36:37], v29 offset:32768
    v_mfma_f32_16x16x32_bf16 v[160:163], a[68:71], a[96:99], v[160:163]
    buffer_load_dwordx4 v12, s[16:19], s49 offen offset:2048 lds
    v_mfma_f32_16x16x32_bf16 v[164:167], a[68:71], a[100:103], v[164:167]
    ds_read_b64_tr_b16 a[38:39], v29 offset:34816
    v_mfma_f32_16x16x32_bf16 v[168:171], a[68:71], a[104:107], v[168:171]
    v_mfma_f32_16x16x32_bf16 v[172:175], a[68:71], a[108:111], v[172:175]
    buffer_load_dwordx4 v13, s[16:19], s49 offen offset:3072 lds
    ds_read_b128 a[8:11], v26 offset:36864
    v_mfma_f32_16x16x32_bf16 v[176:179], a[68:71], a[112:115], v[176:179]
    v_mfma_f32_16x16x32_bf16 v[180:183], a[68:71], a[116:119], v[180:183]
    s_add_u32 m0, s48, 4096
    v_mfma_f32_16x16x32_bf16 v[184:187], a[68:71], a[120:123], v[184:187]
    ds_read_b64_tr_b16 a[40:41], v30 offset:32768
    v_mfma_f32_16x16x32_bf16 v[188:191], a[68:71], a[124:127], v[188:191]
    buffer_load_dwordx4 v14, s[16:19], s49 offen offset:0 lds
    v_mfma_f32_16x16x32_bf16 v[96:99], a[72:75], a[96:99], v[96:99]
    ds_read_b64_tr_b16 a[42:43], v30 offset:34816
    v_mfma_f32_16x16x32_bf16 v[100:103], a[72:75], a[100:103], v[100:103]
    v_mfma_f32_16x16x32_bf16 v[104:107], a[72:75], a[104:107], v[104:107]
    buffer_load_dwordx4 v15, s[16:19], s49 offen offset:1024 lds
    ds_read_b128 a[12:15], v26 offset:38912
    v_mfma_f32_16x16x32_bf16 v[108:111], a[72:75], a[108:111], v[108:111]
    v_mfma_f32_16x16x32_bf16 v[112:115], a[72:75], a[112:115], v[112:115]
    ds_read_b64_tr_b16 a[44:45], v31 offset:32768
    v_mfma_f32_16x16x32_bf16 v[116:119], a[72:75], a[116:119], v[116:119]
    v_mfma_f32_16x16x32_bf16 v[120:123], a[72:75], a[120:123], v[120:123]
    buffer_load_dwordx4 v16, s[16:19], s49 offen offset:2048 lds
    ds_read_b64_tr_b16 a[46:47], v31 offset:34816
    v_mfma_f32_16x16x32_bf16 v[124:127], a[72:75], a[124:127], v[124:127]
    v_mfma_f32_16x16x32_bf16 v[192:195], a[76:79], a[96:99], v[192:195]
    ds_read_b128 a[16:19], v26 offset:40960
    v_mfma_f32_16x16x32_bf16 v[196:199], a[76:79], a[100:103], v[196:199]
    buffer_load_dwordx4 v17, s[16:19], s49 offen offset:3072 lds
    v_mfma_f32_16x16x32_bf16 v[200:203], a[76:79], a[104:107], v[200:203]
    ds_read_b64_tr_b16 a[48:49], v32 offset:32768
    v_mfma_f32_16x16x32_bf16 v[204:207], a[76:79], a[108:111], v[204:207]
    s_add_u32 s49, s49, 128
    v_mfma_f32_16x16x32_bf16 v[208:211], a[76:79], a[112:115], v[208:211]
    s_add_u32 m0, s48, 65536
    ds_read_b64_tr_b16 a[50:51], v32 offset:34816
    v_mfma_f32_16x16x32_bf16 v[212:215], a[76:79], a[116:119], v[212:215]
    buffer_load_dwordx4 v18, s[20:23], s50 offen offset:0 lds
    v_mfma_f32_16x16x32_bf16 v[216:219], a[76:79], a[120:123], v[216:219]
    ds_read_b128 a[20:23], v26 offset:43008
    v_mfma_f32_16x16x32_bf16 v[220:223], a[76:79], a[124:127], v[220:223]
    v_mfma_f32_16x16x32_bf16 v[128:131], a[80:83], a[96:99], v[128:131]
    buffer_load_dwordx4 v19, s[20:23], s50 offen offset:1024 lds
    ds_read_b64_tr_b16 a[52:53], v33 offset:32768
    v_mfma_f32_16x16x32_bf16 v[132:135], a[80:83], a[100:103], v[132:135]
    v_mfma_f32_16x16x32_bf16 v[136:139], a[80:83], a[104:107], v[136:139]
    ds_read_b64_tr_b16 a[54:55], v33 offset:34816
    v_mfma_f32_16x16x32_bf16 v[140:143], a[80:83], a[108:111], v[140:143]
    buffer_load_dwordx4 v20, s[20:23], s50 offen offset:2048 lds
    v_mfma_f32_16x16x32_bf16 v[144:147], a[80:83], a[112:115], v[144:147]
    ds_read_b128 a[24:27], v26 offset:45056
    v_mfma_f32_16x16x32_bf16 v[148:151], a[80:83], a[116:119], v[148:151]
    v_mfma_f32_16x16x32_bf16 v[152:155], a[80:83], a[120:123], v[152:155]
    v_mfma_f32_16x16x32_bf16 v[156:159], a[80:83], a[124:127], v[156:159]
    buffer_load_dwordx4 v21, s[20:23], s50 offen offset:3072 lds
    ds_read_b64_tr_b16 a[56:57], v34 offset:32768
    v_mfma_f32_16x16x32_bf16 v[224:227], a[84:87], a[96:99], v[224:227]
    s_add_u32 m0, s48, 69632
    v_mfma_f32_16x16x32_bf16 v[228:231], a[84:87], a[100:103], v[228:231]
    ds_read_b64_tr_b16 a[58:59], v34 offset:34816
    v_mfma_f32_16x16x32_bf16 v[232:235], a[84:87], a[104:107], v[232:235]
    buffer_load_dwordx4 v22, s[20:23], s50 offen offset:0 lds
    v_mfma_f32_16x16x32_bf16 v[236:239], a[84:87], a[108:111], v[236:239]
    ds_read_b128 a[28:31], v26 offset:47104
    v_mfma_f32_16x16x32_bf16 v[240:243], a[84:87], a[112:115], v[240:243]
    v_mfma_f32_16x16x32_bf16 v[244:247], a[84:87], a[116:119], v[244:247]
    ds_read_b64_tr_b16 a[60:61], v35 offset:32768
    v_mfma_f32_16x16x32_bf16 v[248:251], a[84:87], a[120:123], v[248:251]
    buffer_load_dwordx4 v23, s[20:23], s50 offen offset:1024 lds
    v_mfma_f32_16x16x32_bf16 v[252:255], a[84:87], a[124:127], v[252:255]
    ds_read_b64_tr_b16 a[62:63], v35 offset:34816
    v_mfma_f32_16x16x32_bf16 a[128:131], a[88:91], a[96:99], a[128:131]
    v_mfma_f32_16x16x32_bf16 a[136:139], a[88:91], a[100:103], a[136:139]
    buffer_load_dwordx4 v24, s[20:23], s50 offen offset:2048 lds
    v_mfma_f32_16x16x32_bf16 a[144:147], a[88:91], a[104:107], a[144:147]
    v_mfma_f32_16x16x32_bf16 a[152:155], a[88:91], a[108:111], a[152:155]
    v_mfma_f32_16x16x32_bf16 a[160:163], a[88:91], a[112:115], a[160:163]
    v_mfma_f32_16x16x32_bf16 a[168:171], a[88:91], a[116:119], a[168:171]
    buffer_load_dwordx4 v25, s[20:23], s50 offen offset:3072 lds
    v_mfma_f32_16x16x32_bf16 a[176:179], a[88:91], a[120:123], a[176:179]
    v_mfma_f32_16x16x32_bf16 a[184:187], a[88:91], a[124:127], a[184:187]
    s_add_u32 s50, s50, 0x80000
    v_mfma_f32_16x16x32_bf16 a[132:135], a[92:95], a[96:99], a[132:135]
    v_mfma_f32_16x16x32_bf16 a[140:143], a[92:95], a[100:103], a[140:143]
    s_cmp_eq_u32 s51, s53
    s_cbranch_scc1 k12_ool_28
k12_oolret_29:
    v_mfma_f32_16x16x32_bf16 a[148:151], a[92:95], a[104:107], a[148:151]
    v_mfma_f32_16x16x32_bf16 a[156:159], a[92:95], a[108:111], a[156:159]
    s_cmp_eq_u32 s51, s63
    s_cbranch_scc1 k12_ool_30
k12_oolret_31:
    v_mfma_f32_16x16x32_bf16 a[164:167], a[92:95], a[112:115], a[164:167]
    v_mfma_f32_16x16x32_bf16 a[172:175], a[92:95], a[116:119], a[172:175]
    s_add_u32 s51, s51, 1
    v_mfma_f32_16x16x32_bf16 a[180:183], a[92:95], a[120:123], a[180:183]
    v_mfma_f32_16x16x32_bf16 a[188:191], a[92:95], a[124:127], a[188:191]
    s_waitcnt lgkmcnt(0)
    v_mfma_f32_16x16x32_bf16 v[64:67], a[0:3], a[32:35], v[64:67]
    ds_read_b128 a[64:67], v27 offset:32768
    v_mfma_f32_16x16x32_bf16 v[68:71], a[0:3], a[36:39], v[68:71]
    ds_read_b64_tr_b16 a[96:97], v28 offset:49152
    v_mfma_f32_16x16x32_bf16 v[72:75], a[0:3], a[40:43], v[72:75]
    v_mfma_f32_16x16x32_bf16 v[76:79], a[0:3], a[44:47], v[76:79]
    ds_read_b64_tr_b16 a[98:99], v28 offset:51200
    v_mfma_f32_16x16x32_bf16 v[80:83], a[0:3], a[48:51], v[80:83]
    v_mfma_f32_16x16x32_bf16 v[84:87], a[0:3], a[52:55], v[84:87]
    ds_read_b128 a[68:71], v27 offset:34816
    v_mfma_f32_16x16x32_bf16 v[88:91], a[0:3], a[56:59], v[88:91]
    v_mfma_f32_16x16x32_bf16 v[92:95], a[0:3], a[60:63], v[92:95]
    ds_read_b64_tr_b16 a[100:101], v29 offset:49152
    v_mfma_f32_16x16x32_bf16 v[160:163], a[4:7], a[32:35], v[160:163]
    v_mfma_f32_16x16x32_bf16 v[164:167], a[4:7], a[36:39], v[164:167]
    ds_read_b64_tr_b16 a[102:103], v29 offset:51200
    v_mfma_f32_16x16x32_bf16 v[168:171], a[4:7], a[40:43], v[168:171]
    v_mfma_f32_16x16x32_bf16 v[172:175], a[4:7], a[44:47], v[172:175]
    ds_read_b128 a[72:75], v27 offset:36864
    v_mfma_f32_16x16x32_bf16 v[176:179], a[4:7], a[48:51], v[176:179]
    v_mfma_f32_16x16x32_bf16 v[180:183], a[4:7], a[52:55], v[180:183]
    v_mfma_f32_16x16x32_bf16 v[184:187], a[4:7], a[56:59], v[184:187]
    ds_read_b64_tr_b16 a[104:105], v30 offset:49152
    v_mfma_f32_16x16x32_bf16 v[188:191], a[4:7], a[60:63], v[188:191]
    v_mfma_f32_16x16x32_bf16 v[96:99], a[8:11], a[32:35], v[96:99]
    ds_read_b64_tr_b16 a[106:107], v30 offset:51200
    v_mfma_f32_16x16x32_bf16 v[100:103], a[8:11], a[36:39], v[100:103]
    v_mfma_f32_16x16x32_bf16 v[104:107], a[8:11], a[40:43], v[104:107]
    ds_read_b128 a[76:79], v27 offset:38912
    v_mfma_f32_16x16x32_bf16 v[108:111], a[8:11], a[44:47], v[108:111]
    v_mfma_f32_16x16x32_bf16 v[112:115], a[8:11], a[48:51], v[112:115]
    ds_read_b64_tr_b16 a[108:109], v31 offset:49152
    v_mfma_f32_16x16x32_bf16 v[116:119], a[8:11], a[52:55], v[116:119]
    v_mfma_f32_16x16x32_bf16 v[120:123], a[8:11], a[56:59], v[120:123]
    ds_read_b64_tr_b16 a[110:111], v31 offset:51200
    v_mfma_f32_16x16x32_bf16 v[124:127], a[8:11], a[60:63], v[124:127]
    v_mfma_f32_16x16x32_bf16 v[192:195], a[12:15], a[32:35], v[192:195]
    ds_read_b128 a[80:83], v27 offset:40960
    v_mfma_f32_16x16x32_bf16 v[196:199], a[12:15], a[36:39], v[196:199]
    v_mfma_f32_16x16x32_bf16 v[200:203], a[12:15], a[40:43], v[200:203]
    ds_read_b64_tr_b16 a[112:113], v32 offset:49152
    v_mfma_f32_16x16x32_bf16 v[204:207], a[12:15], a[44:47], v[204:207]
    v_mfma_f32_16x16x32_bf16 v[208:211], a[12:15], a[48:51], v[208:211]
    ds_read_b64_tr_b16 a[114:115], v32 offset:51200
    v_mfma_f32_16x16x32_bf16 v[212:215], a[12:15], a[52:55], v[212:215]
    v_mfma_f32_16x16x32_bf16 v[216:219], a[12:15], a[56:59], v[216:219]
    ds_read_b128 a[84:87], v27 offset:43008
    v_mfma_f32_16x16x32_bf16 v[220:223], a[12:15], a[60:63], v[220:223]
    v_mfma_f32_16x16x32_bf16 v[128:131], a[16:19], a[32:35], v[128:131]
    ds_read_b64_tr_b16 a[116:117], v33 offset:49152
    v_mfma_f32_16x16x32_bf16 v[132:135], a[16:19], a[36:39], v[132:135]
    v_mfma_f32_16x16x32_bf16 v[136:139], a[16:19], a[40:43], v[136:139]
    ds_read_b64_tr_b16 a[118:119], v33 offset:51200
    v_mfma_f32_16x16x32_bf16 v[140:143], a[16:19], a[44:47], v[140:143]
    v_mfma_f32_16x16x32_bf16 v[144:147], a[16:19], a[48:51], v[144:147]
    ds_read_b128 a[88:91], v27 offset:45056
    v_mfma_f32_16x16x32_bf16 v[148:151], a[16:19], a[52:55], v[148:151]
    v_mfma_f32_16x16x32_bf16 v[152:155], a[16:19], a[56:59], v[152:155]
    v_mfma_f32_16x16x32_bf16 v[156:159], a[16:19], a[60:63], v[156:159]
    ds_read_b64_tr_b16 a[120:121], v34 offset:49152
    v_mfma_f32_16x16x32_bf16 v[224:227], a[20:23], a[32:35], v[224:227]
    v_mfma_f32_16x16x32_bf16 v[228:231], a[20:23], a[36:39], v[228:231]
    ds_read_b64_tr_b16 a[122:123], v34 offset:51200
    v_mfma_f32_16x16x32_bf16 v[232:235], a[20:23], a[40:43], v[232:235]
    v_mfma_f32_16x16x32_bf16 v[236:239], a[20:23], a[44:47], v[236:239]
    ds_read_b128 a[92:95], v27 offset:47104
    v_mfma_f32_16x16x32_bf16 v[240:243], a[20:23], a[48:51], v[240:243]
    v_mfma_f32_16x16x32_bf16 v[244:247], a[20:23], a[52:55], v[244:247]
    ds_read_b64_tr_b16 a[124:125], v35 offset:49152
    v_mfma_f32_16x16x32_bf16 v[248:251], a[20:23], a[56:59], v[248:251]
    v_mfma_f32_16x16x32_bf16 v[252:255], a[20:23], a[60:63], v[252:255]
    ds_read_b64_tr_b16 a[126:127], v35 offset:51200
    v_mfma_f32_16x16x32_bf16 a[128:131], a[24:27], a[32:35], a[128:131]
    v_mfma_f32_16x16x32_bf16 a[136:139], a[24:27], a[36:39], a[136:139]
    v_mfma_f32_16x16x32_bf16 a[144:147], a[24:27], a[40:43], a[144:147]
    v_mfma_f32_16x16x32_bf16 a[152:155], a[24:27], a[44:47], a[152:155]
    v_mfma_f32_16x16x32_bf16 a[160:163], a[24:27], a[48:51], a[160:163]
    v_mfma_f32_16x16x32_bf16 a[168:171], a[24:27], a[52:55], a[168:171]
    v_mfma_f32_16x16x32_bf16 a[176:179], a[24:27], a[56:59], a[176:179]
    v_mfma_f32_16x16x32_bf16 a[184:187], a[24:27], a[60:63], a[184:187]
    s_sub_u32 s52, s51, 1
    s_cmp_eq_u32 s52, s46
    s_cbranch_scc1 k12_ool_34
k12_oolret_35:
    v_mfma_f32_16x16x32_bf16 a[132:135], a[28:31], a[32:35], a[132:135]
    v_mfma_f32_16x16x32_bf16 a[140:143], a[28:31], a[36:39], a[140:143]
    v_mfma_f32_16x16x32_bf16 a[148:151], a[28:31], a[40:43], a[148:151]
    v_mfma_f32_16x16x32_bf16 a[156:159], a[28:31], a[44:47], a[156:159]
    v_mfma_f32_16x16x32_bf16 a[164:167], a[28:31], a[48:51], a[164:167]
    v_mfma_f32_16x16x32_bf16 a[172:175], a[28:31], a[52:55], a[172:175]
    v_mfma_f32_16x16x32_bf16 a[180:183], a[28:31], a[56:59], a[180:183]
    v_mfma_f32_16x16x32_bf16 a[188:191], a[28:31], a[60:63], a[188:191]
    s_waitcnt vmcnt(0) lgkmcnt(0)
    s_barrier
    s_cmp_eq_u32 s51, 7
    s_cbranch_scc1 k12_last_25
    v_mfma_f32_16x16x32_bf16 v[64:67], a[64:67], a[96:99], v[64:67]
    ds_read_b128 a[0:3], v26 offset:0
    v_mfma_f32_16x16x32_bf16 v[68:71], a[64:67], a[100:103], v[68:71]
    s_add_u32 m0, s48, 32768
    ds_read_b64_tr_b16 a[32:33], v28 offset:0
    v_mfma_f32_16x16x32_bf16 v[72:75], a[64:67], a[104:107], v[72:75]
    buffer_load_dwordx4 v10, s[16:19], s49 offen offset:0 lds
    v_mfma_f32_16x16x32_bf16 v[76:79], a[64:67], a[108:111], v[76:79]
    ds_read_b64_tr_b16 a[34:35], v28 offset:2048
    v_mfma_f32_16x16x32_bf16 v[80:83], a[64:67], a[112:115], v[80:83]
    buffer_load_dwordx4 v11, s[16:19], s49 offen offset:1024 lds
    v_mfma_f32_16x16x32_bf16 v[84:87], a[64:67], a[116:119], v[84:87]
    ds_read_b128 a[4:7], v26 offset:2048
    v_mfma_f32_16x16x32_bf16 v[88:91], a[64:67], a[120:123], v[88:91]
    v_mfma_f32_16x16x32_bf16 v[92:95], a[64:67], a[124:127], v[92:95]
    ds_read_b64_tr_b16 a[36:37], v29 offset:0
    v_mfma_f32_16x16x32_bf16 v[160:163], a[68:71], a[96:99], v[160:163]
    buffer_load_dwordx4 v12, s[16:19], s49 offen offset:2048 lds
    v_mfma_f32_16x16x32_bf16 v[164:167], a[68:71], a[100:103], v[164:167]
    ds_read_b64_tr_b16 a[38:39], v29 offset:2048
    v_mfma_f32_16x16x32_bf16 v[168:171], a[68:71], a[104:107], v[168:171]
    v_mfma_f32_16x16x32_bf16 v[172:175], a[68:71], a[108:111], v[172:175]
    buffer_load_dwordx4 v13, s[16:19], s49 offen offset:3072 lds
    ds_read_b128 a[8:11], v26 offset:4096
    v_mfma_f32_16x16x32_bf16 v[176:179], a[68:71], a[112:115], v[176:179]
    v_mfma_f32_16x16x32_bf16 v[180:183], a[68:71], a[116:119], v[180:183]
    s_add_u32 m0, s48, 36864
    v_mfma_f32_16x16x32_bf16 v[184:187], a[68:71], a[120:123], v[184:187]
    ds_read_b64_tr_b16 a[40:41], v30 offset:0
    v_mfma_f32_16x16x32_bf16 v[188:191], a[68:71], a[124:127], v[188:191]
    buffer_load_dwordx4 v14, s[16:19], s49 offen offset:0 lds
    v_mfma_f32_16x16x32_bf16 v[96:99], a[72:75], a[96:99], v[96:99]
    ds_read_b64_tr_b16 a[42:43], v30 offset:2048
    v_mfma_f32_16x16x32_bf16 v[100:103], a[72:75], a[100:103], v[100:103]
    v_mfma_f32_16x16x32_bf16 v[104:107], a[72:75], a[104:107], v[104:107]
    buffer_load_dwordx4 v15, s[16:19], s49 offen offset:1024 lds
    ds_read_b128 a[12:15], v26 offset:6144
    v_mfma_f32_16x16x32_bf16 v[108:111], a[72:75], a[108:111], v[108:111]
    v_mfma_f32_16x16x32_bf16 v[112:115], a[72:75], a[112:115], v[112:115]
    ds_read_b64_tr_b16 a[44:45], v31 offset:0
    v_mfma_f32_16x16x32_bf16 v[116:119], a[72:75], a[116:119], v[116:119]
    v_mfma_f32_16x16x32_bf16 v[120:123], a[72:75], a[120:123], v[120:123]
    buffer_load_dwordx4 v16, s[16:19], s49 offen offset:2048 lds
    ds_read_b64_tr_b16 a[46:47], v31 offset:2048
    v_mfma_f32_16x16x32_bf16 v[124:127], a[72:75], a[124:127], v[124:127]
    v_mfma_f32_16x16x32_bf16 v[192:195], a[76:79], a[96:99], v[192:195]
    ds_read_b128 a[16:19], v26 offset:8192
    v_mfma_f32_16x16x32_bf16 v[196:199], a[76:79], a[100:103], v[196:199]
    buffer_load_dwordx4 v17, s[16:19], s49 offen offset:3072 lds
    v_mfma_f32_16x16x32_bf16 v[200:203], a[76:79], a[104:107], v[200:203]
    ds_read_b64_tr_b16 a[48:49], v32 offset:0
    v_mfma_f32_16x16x32_bf16 v[204:207], a[76:79], a[108:111], v[204:207]
    s_add_u32 s49, s49, 128
    v_mfma_f32_16x16x32_bf16 v[208:211], a[76:79], a[112:115], v[208:211]
    s_add_u32 m0, s48, 98304
    ds_read_b64_tr_b16 a[50:51], v32 offset:2048
    v_mfma_f32_16x16x32_bf16 v[212:215], a[76:79], a[116:119], v[212:215]
    buffer_load_dwordx4 v18, s[20:23], s50 offen offset:0 lds
    v_mfma_f32_16x16x32_bf16 v[216:219], a[76:79], a[120:123], v[216:219]
    ds_read_b128 a[20:23], v26 offset:10240
    v_mfma_f32_16x16x32_bf16 v[220:223], a[76:79], a[124:127], v[220:223]
    v_mfma_f32_16x16x32_bf16 v[128:131], a[80:83], a[96:99], v[128:131]
    buffer_load_dwordx4 v19, s[20:23], s50 offen offset:1024 lds
    ds_read_b64_tr_b16 a[52:53], v33 offset:0
    v_mfma_f32_16x16x32_bf16 v[132:135], a[80:83], a[100:103], v[132:135]
    v_mfma_f32_16x16x32_bf16 v[136:139], a[80:83], a[104:107], v[136:139]
    ds_read_b64_tr_b16 a[54:55], v33 offset:2048
    v_mfma_f32_16x16x32_bf16 v[140:143], a[80:83], a[108:111], v[140:143]
    buffer_load_dwordx4 v20, s[20:23], s50 offen offset:2048 lds
    v_mfma_f32_16x16x32_bf16 v[144:147], a[80:83], a[112:115], v[144:147]
    ds_read_b128 a[24:27], v26 offset:12288
    v_mfma_f32_16x16x32_bf16 v[148:151], a[80:83], a[116:119], v[148:151]
    v_mfma_f32_16x16x32_bf16 v[152:155], a[80:83], a[120:123], v[152:155]
    v_mfma_f32_16x16x32_bf16 v[156:159], a[80:83], a[124:127], v[156:159]
    buffer_load_dwordx4 v21, s[20:23], s50 offen offset:3072 lds
    ds_read_b64_tr_b16 a[56:57], v34 offset:0
    v_mfma_f32_16x16x32_bf16 v[224:227], a[84:87], a[96:99], v[224:227]
    s_add_u32 m0, s48, 102400
    v_mfma_f32_16x16x32_bf16 v[228:231], a[84:87], a[100:103], v[228:231]
    ds_read_b64_tr_b16 a[58:59], v34 offset:2048
    v_mfma_f32_16x16x32_bf16 v[232:235], a[84:87], a[104:107], v[232:235]
    buffer_load_dwordx4 v22, s[20:23], s50 offen offset:0 lds
    v_mfma_f32_16x16x32_bf16 v[236:239], a[84:87], a[108:111], v[236:239]
    ds_read_b128 a[28:31], v26 offset:14336
    v_mfma_f32_16x16x32_bf16 v[240:243], a[84:87], a[112:115], v[240:243]
    v_mfma_f32_16x16x32_bf16 v[244:247], a[84:87], a[116:119], v[244:247]
    ds_read_b64_tr_b16 a[60:61], v35 offset:0
    v_mfma_f32_16x16x32_bf16 v[248:251], a[84:87], a[120:123], v[248:251]
    buffer_load_dwordx4 v23, s[20:23], s50 offen offset:1024 lds
    v_mfma_f32_16x16x32_bf16 v[252:255], a[84:87], a[124:127], v[252:255]
    ds_read_b64_tr_b16 a[62:63], v35 offset:2048
    v_mfma_f32_16x16x32_bf16 a[128:131], a[88:91], a[96:99], a[128:131]
    v_mfma_f32_16x16x32_bf16 a[136:139], a[88:91], a[100:103], a[136:139]
    buffer_load_dwordx4 v24, s[20:23], s50 offen offset:2048 lds
    v_mfma_f32_16x16x32_bf16 a[144:147], a[88:91], a[104:107], a[144:147]
    v_mfma_f32_16x16x32_bf16 a[152:155], a[88:91], a[108:111], a[152:155]
    v_mfma_f32_16x16x32_bf16 a[160:163], a[88:91], a[112:115], a[160:163]
    v_mfma_f32_16x16x32_bf16 a[168:171], a[88:91], a[116:119], a[168:171]
    buffer_load_dwordx4 v25, s[20:23], s50 offen offset:3072 lds
    v_mfma_f32_16x16x32_bf16 a[176:179], a[88:91], a[120:123], a[176:179]
    v_mfma_f32_16x16x32_bf16 a[184:187], a[88:91], a[124:127], a[184:187]
    s_add_u32 s50, s50, 0x80000
    v_mfma_f32_16x16x32_bf16 a[132:135], a[92:95], a[96:99], a[132:135]
    v_mfma_f32_16x16x32_bf16 a[140:143], a[92:95], a[100:103], a[140:143]
    s_cmp_eq_u32 s51, s53
    s_cbranch_scc1 k12_ool_36
k12_oolret_37:
    v_mfma_f32_16x16x32_bf16 a[148:151], a[92:95], a[104:107], a[148:151]
    v_mfma_f32_16x16x32_bf16 a[156:159], a[92:95], a[108:111], a[156:159]
    s_cmp_eq_u32 s51, 5
    s_cbranch_scc1 k12_ool_38
k12_oolret_39:
    v_mfma_f32_16x16x32_bf16 a[164:167], a[92:95], a[112:115], a[164:167]
    v_mfma_f32_16x16x32_bf16 a[172:175], a[92:95], a[116:119], a[172:175]
    s_add_u32 s51, s51, 1
    v_mfma_f32_16x16x32_bf16 a[180:183], a[92:95], a[120:123], a[180:183]
    v_mfma_f32_16x16x32_bf16 a[188:191], a[92:95], a[124:127], a[188:191]
    s_waitcnt lgkmcnt(0)
    s_branch k12_loop_24
k12_last_25:
    v_mfma_f32_16x16x32_bf16 v[64:67], a[64:67], a[96:99], v[64:67]
    s_add_u32 m0, s60, 98304
    v_mfma_f32_16x16x32_bf16 v[160:163], a[68:71], a[96:99], v[160:163]
    buffer_load_dwordx4 v38, s[12:15], s61 offen offset:0 lds
    v_mfma_f32_16x16x32_bf16 v[68:71], a[64:67], a[100:103], v[68:71]
    buffer_load_dwordx4 v39, s[12:15], s61 offen offset:1024 lds
    v_mfma_f32_16x16x32_bf16 v[164:167], a[68:71], a[100:103], v[164:167]
    v_mfma_f32_16x16x32_bf16 v[72:75], a[64:67], a[104:107], v[72:75]
    buffer_load_dwordx4 v40, s[12:15], s61 offen offset:2048 lds
    v_mfma_f32_16x16x32_bf16 v[168:171], a[68:71], a[104:107], v[168:171]
    v_cvt_pk_bf16_f32 v64, v64, v65
    v_cvt_pk_bf16_f32 v65, v66, v67
    v_cvt_pk_bf16_f32 v66, v160, v161
    v_mfma_f32_16x16x32_bf16 v[76:79], a[64:67], a[108:111], v[76:79]
    v_cvt_pk_bf16_f32 v67, v162, v163
    v_mfma_f32_16x16x32_bf16 v[172:175], a[68:71], a[108:111], v[172:175]
    v_cvt_pk_bf16_f32 v68, v68, v69
    v_cvt_pk_bf16_f32 v69, v70, v71
    v_cvt_pk_bf16_f32 v70, v164, v165
    v_mfma_f32_16x16x32_bf16 v[80:83], a[64:67], a[112:115], v[80:83]
    buffer_load_dwordx4 v41, s[12:15], s61 offen offset:3072 lds
    v_mfma_f32_16x16x32_bf16 v[176:179], a[68:71], a[112:115], v[176:179]
    s_add_u32 s61, s61, 0x80000
    v_cvt_pk_bf16_f32 v71, v166, v167
    v_cvt_pk_bf16_f32 v72, v72, v73
    v_cvt_pk_bf16_f32 v73, v74, v75
    v_mfma_f32_16x16x32_bf16 v[84:87], a[64:67], a[116:119], v[84:87]
    buffer_load_dwordx4 a[192:195], v36, s[8:11], s62 offen sc1
    buffer_load_dwordx4 a[196:199], v54, s[8:11], s62 offen sc1
    v_mfma_f32_16x16x32_bf16 v[180:183], a[68:71], a[116:119], v[180:183]
    v_cvt_pk_bf16_f32 v74, v168, v169
    v_cvt_pk_bf16_f32 v75, v170, v171
    v_cvt_pk_bf16_f32 v76, v76, v77
    v_mfma_f32_16x16x32_bf16 v[88:91], a[64:67], a[120:123], v[88:91]
    v_cvt_pk_bf16_f32 v77, v78, v79
    v_cvt_pk_bf16_f32 v78, v172, v173
    v_cvt_pk_bf16_f32 v79, v174, v175
    v_mfma_f32_16x16x32_bf16 v[184:187], a[68:71], a[120:123], v[184:187]
    v_cvt_pk_bf16_f32 v80, v80, v81
    v_cvt_pk_bf16_f32 v81, v82, v83
    v_cvt_pk_bf16_f32 v82, v176, v177
    v_mfma_f32_16x16x32_bf16 v[92:95], a[64:67], a[124:127], v[92:95]
    buffer_load_dwordx4 a[200:203], v37, s[8:11], s62 offen sc1
    buffer_load_dwordx4 a[204:207], v55, s[8:11], s62 offen sc1
    v_mfma_f32_16x16x32_bf16 v[188:191], a[68:71], a[124:127], v[188:191]
    s_add_u32 s62, s62, 0x20000
    v_cvt_pk_bf16_f32 v83, v178, v179
    v_cvt_pk_bf16_f32 v84, v84, v85
    v_cvt_pk_bf16_f32 v85, v86, v87
    v_mfma_f32_16x16x32_bf16 a[128:131], a[88:91], a[96:99], a[128:131]
    v_cvt_pk_bf16_f32 v86, v180, v181
    v_cvt_pk_bf16_f32 v87, v182, v183
    v_mfma_f32_16x16x32_bf16 a[132:135], a[92:95], a[96:99], a[132:135]
    v_cvt_pk_bf16_f32 v88, v88, v89
    v_cvt_pk_bf16_f32 v89, v90, v91
    v_cvt_pk_bf16_f32 v90, v184, v185
    v_mfma_f32_16x16x32_bf16 v[96:99], a[72:75], a[96:99], v[96:99]
    buffer_load_dwordx4 a[208:211], v36, s[8:11], s62 offen sc1
    buffer_load_dwordx4 a[212:215], v54, s[8:11], s62 offen sc1
    v_mfma_f32_16x16x32_bf16 v[192:195], a[76:79], a[96:99], v[192:195]
    v_cvt_pk_bf16_f32 v91, v186, v187
    v_cvt_pk_bf16_f32 v92, v92, v93
    v_cvt_pk_bf16_f32 v93, v94, v95
    v_mfma_f32_16x16x32_bf16 v[100:103], a[72:75], a[100:103], v[100:103]
    v_cvt_pk_bf16_f32 v94, v188, v189
    v_cvt_pk_bf16_f32 v95, v190, v191
    v_mfma_f32_16x16x32_bf16 v[196:199], a[76:79], a[100:103], v[196:199]
    v_accvgpr_read_b32 v56, a128
    v_accvgpr_read_b32 v57, a129
    v_accvgpr_read_b32 v58, a130
    v_mfma_f32_16x16x32_bf16 a[136:139], a[88:91], a[100:103], a[136:139]
    buffer_load_dwordx4 a[216:219], v37, s[8:11], s62 offen sc1
    buffer_load_dwordx4 a[220:223], v55, s[8:11], s62 offen sc1
    v_mfma_f32_16x16x32_bf16 a[140:143], a[92:95], a[100:103], a[140:143]
    s_add_u32 s62, s62, 0x20000
    v_accvgpr_read_b32 v59, a131
    v_accvgpr_read_b32 v60, a132
    v_cvt_pk_bf16_f32 v96, v96, v97
    v_mfma_f32_16x16x32_bf16 v[104:107], a[72:75], a[104:107], v[104:107]
    s_add_u32 m0, s60, 114688
    v_accvgpr_read_b32 v61, a133
    v_accvgpr_read_b32 v62, a134
    v_cvt_pk_bf16_f32 v97, v98, v99
    v_mfma_f32_16x16x32_bf16 v[200:203], a[76:79], a[104:107], v[200:203]
    v_accvgpr_read_b32 v63, a135
    v_cvt_pk_bf16_f32 v98, v192, v193
    v_cvt_pk_bf16_f32 v160, v56, v57
    v_mfma_f32_16x16x32_bf16 v[108:111], a[72:75], a[108:111], v[108:111]
    v_cvt_pk_bf16_f32 v99, v194, v195
    v_cvt_pk_bf16_f32 v161, v58, v59
    v_cvt_pk_bf16_f32 v100, v100, v101
    v_mfma_f32_16x16x32_bf16 v[204:207], a[76:79], a[108:111], v[204:207]
    buffer_load_dwordx4 v38, s[12:15], s61 offen offset:0 lds
    buffer_load_dwordx4 v39, s[12:15], s61 offen offset:1024 lds
    v_mfma_f32_16x16x32_bf16 a[144:147], a[88:91], a[104:107], a[144:147]
    v_cvt_pk_bf16_f32 v162, v60, v61
    v_cvt_pk_bf16_f32 v101, v102, v103
    v_cvt_pk_bf16_f32 v163, v62, v63
    v_mfma_f32_16x16x32_bf16 a[148:151], a[92:95], a[104:107], a[148:151]
    v_cvt_pk_bf16_f32 v102, v196, v197
    v_cvt_pk_bf16_f32 v103, v198, v199
    v_accvgpr_read_b32 v56, a136
    v_mfma_f32_16x16x32_bf16 v[112:115], a[72:75], a[112:115], v[112:115]
    v_accvgpr_read_b32 v57, a137
    v_accvgpr_read_b32 v58, a138
    v_accvgpr_read_b32 v59, a139
    v_mfma_f32_16x16x32_bf16 v[208:211], a[76:79], a[112:115], v[208:211]
    v_accvgpr_read_b32 v60, a140
    v_cvt_pk_bf16_f32 v104, v104, v105
    v_accvgpr_read_b32 v61, a141
    v_mfma_f32_16x16x32_bf16 v[116:119], a[72:75], a[116:119], v[116:119]
    buffer_load_dwordx4 v40, s[12:15], s61 offen offset:2048 lds
    buffer_load_dwordx4 v41, s[12:15], s61 offen offset:3072 lds
    v_mfma_f32_16x16x32_bf16 v[212:215], a[76:79], a[116:119], v[212:215]
    s_add_u32 s61, s61, 0x80000
    v_accvgpr_read_b32 v62, a142
    v_cvt_pk_bf16_f32 v105, v106, v107
    v_accvgpr_read_b32 v63, a143
    v_mfma_f32_16x16x32_bf16 a[152:155], a[88:91], a[108:111], a[152:155]
    v_cvt_pk_bf16_f32 v106, v200, v201
    v_cvt_pk_bf16_f32 v164, v56, v57
    v_cvt_pk_bf16_f32 v107, v202, v203
    v_mfma_f32_16x16x32_bf16 a[156:159], a[92:95], a[108:111], a[156:159]
    v_cvt_pk_bf16_f32 v165, v58, v59
    v_cvt_pk_bf16_f32 v108, v108, v109
    v_cvt_pk_bf16_f32 v166, v60, v61
    v_mfma_f32_16x16x32_bf16 v[120:123], a[72:75], a[120:123], v[120:123]
    v_cvt_pk_bf16_f32 v109, v110, v111
    v_cvt_pk_bf16_f32 v167, v62, v63
    v_cvt_pk_bf16_f32 v110, v204, v205
    v_mfma_f32_16x16x32_bf16 v[216:219], a[76:79], a[120:123], v[216:219]
    buffer_load_dwordx4 a[224:227], v36, s[8:11], s62 offen sc1
    v_cvt_pk_bf16_f32 v111, v206, v207
    v_accvgpr_read_b32 v56, a144
    v_mfma_f32_16x16x32_bf16 v[124:127], a[72:75], a[124:127], v[124:127]
    v_accvgpr_read_b32 v57, a145
    v_accvgpr_read_b32 v58, a146
    v_accvgpr_read_b32 v59, a147
    v_mfma_f32_16x16x32_bf16 v[220:223], a[76:79], a[124:127], v[220:223]
    buffer_load_dwordx4 a[228:231], v54, s[8:11], s62 offen sc1
    v_accvgpr_read_b32 v60, a148
    v_cvt_pk_bf16_f32 v112, v112, v113
    v_mfma_f32_16x16x32_bf16 a[160:163], a[88:91], a[112:115], a[160:163]
    v_accvgpr_read_b32 v61, a149
    v_accvgpr_read_b32 v62, a150
    v_cvt_pk_bf16_f32 v113, v114, v115
    v_mfma_f32_16x16x32_bf16 a[164:167], a[92:95], a[112:115], a[164:167]
    v_accvgpr_read_b32 v63, a151
    v_cvt_pk_bf16_f32 v114, v208, v209
    v_cvt_pk_bf16_f32 v168, v56, v57
    v_mfma_f32_16x16x32_bf16 v[128:131], a[80:83], a[96:99], v[128:131]
    v_cvt_pk_bf16_f32 v115, v210, v211
    v_cvt_pk_bf16_f32 v169, v58, v59
    v_cvt_pk_bf16_f32 v116, v116, v117
    v_mfma_f32_16x16x32_bf16 v[224:227], a[84:87], a[96:99], v[224:227]
    buffer_load_dwordx4 a[232:235], v37, s[8:11], s62 offen sc1
    v_cvt_pk_bf16_f32 v170, v60, v61
    v_cvt_pk_bf16_f32 v117, v118, v119
    v_mfma_f32_16x16x32_bf16 v[132:135], a[80:83], a[100:103], v[132:135]
    v_cvt_pk_bf16_f32 v171, v62, v63
    v_cvt_pk_bf16_f32 v118, v212, v213
    v_cvt_pk_bf16_f32 v119, v214, v215
    v_mfma_f32_16x16x32_bf16 v[228:231], a[84:87], a[100:103], v[228:231]
    buffer_load_dwordx4 a[236:239], v55, s[8:11], s62 offen sc1
    v_accvgpr_read_b32 v56, a152
    v_accvgpr_read_b32 v57, a153
    v_mfma_f32_16x16x32_bf16 a[168:171], a[88:91], a[116:119], a[168:171]
    s_add_u32 s62, s62, 0x20000
    v_accvgpr_read_b32 v58, a154
    v_accvgpr_read_b32 v59, a155
    v_accvgpr_read_b32 v60, a156
    v_mfma_f32_16x16x32_bf16 a[172:175], a[92:95], a[116:119], a[172:175]
    s_waitcnt vmcnt(16)
    s_barrier
    v_cvt_pk_bf16_f32 v120, v120, v121
    v_accvgpr_read_b32 v61, a157
    v_accvgpr_read_b32 v62, a158
    v_mfma_f32_16x16x32_bf16 v[136:139], a[80:83], a[104:107], v[136:139]
    v_cvt_pk_bf16_f32 v121, v122, v123
    v_accvgpr_read_b32 v63, a159
    v_cvt_pk_bf16_f32 v122, v216, v217
    v_mfma_f32_16x16x32_bf16 v[232:235], a[84:87], a[104:107], v[232:235]
    v_cvt_pk_bf16_f32 v172, v56, v57
    v_cvt_pk_bf16_f32 v123, v218, v219
    v_cvt_pk_bf16_f32 v173, v58, v59
    v_mfma_f32_16x16x32_bf16 v[140:143], a[80:83], a[108:111], v[140:143]
    v_cvt_pk_bf16_f32 v124, v124, v125
    v_cvt_pk_bf16_f32 v174, v60, v61
    v_cvt_pk_bf16_f32 v125, v126, v127
    v_mfma_f32_16x16x32_bf16 v[236:239], a[84:87], a[108:111], v[236:239]
    v_cvt_pk_bf16_f32 v175, v62, v63
    v_cvt_pk_bf16_f32 v126, v220, v221
    v_cvt_pk_bf16_f32 v127, v222, v223
    v_mfma_f32_16x16x32_bf16 a[176:179], a[88:91], a[120:123], a[176:179]
    ds_read_b64_tr_b16 a[0:1], v42 offset:0
    v_accvgpr_read_b32 v56, a160
    v_accvgpr_read_b32 v57, a161
    v_mfma_f32_16x16x32_bf16 a[180:183], a[92:95], a[120:123], a[180:183]
    ds_read_b64_tr_b16 a[2:3], v42 offset:1024
    v_accvgpr_read_b32 v58, a162
    v_accvgpr_read_b32 v59, a163
    v_mfma_f32_16x16x32_bf16 v[144:147], a[80:83], a[112:115], v[144:147]
    ds_read_b64_tr_b16 a[4:5], v43 offset:0
    v_accvgpr_read_b32 v60, a164
    v_cvt_pk_bf16_f32 v128, v128, v129
    v_mfma_f32_16x16x32_bf16 v[240:243], a[84:87], a[112:115], v[240:243]
    v_accvgpr_read_b32 v61, a165
    v_accvgpr_read_b32 v62, a166
    v_cvt_pk_bf16_f32 v129, v130, v131
    v_mfma_f32_16x16x32_bf16 v[148:151], a[80:83], a[116:119], v[148:151]
    ds_read_b64_tr_b16 a[6:7], v43 offset:1024
    v_accvgpr_read_b32 v63, a167
    v_cvt_pk_bf16_f32 v130, v224, v225
    v_mfma_f32_16x16x32_bf16 v[244:247], a[84:87], a[116:119], v[244:247]
    v_cvt_pk_bf16_f32 v176, v56, v57
    v_cvt_pk_bf16_f32 v131, v226, v227
    v_cvt_pk_bf16_f32 v177, v58, v59
    v_mfma_f32_16x16x32_bf16 a[184:187], a[88:91], a[124:127], a[184:187]
    ds_read_b64_tr_b16 a[8:9], v44 offset:0
    v_cvt_pk_bf16_f32 v132, v132, v133
    v_cvt_pk_bf16_f32 v178, v60, v61
    v_mfma_f32_16x16x32_bf16 a[188:191], a[92:95], a[124:127], a[188:191]
    ds_read_b64_tr_b16 a[10:11], v44 offset:1024
    v_cvt_pk_bf16_f32 v133, v134, v135
    v_cvt_pk_bf16_f32 v179, v62, v63
    v_mfma_f32_16x16x32_bf16 v[152:155], a[80:83], a[120:123], v[152:155]
    ds_read_b64_tr_b16 a[12:13], v45 offset:0
    v_cvt_pk_bf16_f32 v134, v228, v229
    v_cvt_pk_bf16_f32 v135, v230, v231
    v_mfma_f32_16x16x32_bf16 v[248:251], a[84:87], a[120:123], v[248:251]
    ds_read_b64_tr_b16 a[14:15], v45 offset:1024
    v_accvgpr_read_b32 v56, a168
    v_accvgpr_read_b32 v57, a169
    v_mfma_f32_16x16x32_bf16 v[156:159], a[80:83], a[124:127], v[156:159]
    ds_read_b64_tr_b16 a[16:17], v46 offset:0
    v_accvgpr_read_b32 v58, a170
    v_accvgpr_read_b32 v59, a171
    v_mfma_f32_16x16x32_bf16 v[252:255], a[84:87], a[124:127], v[252:255]
    v_accvgpr_read_b32 v60, a172
    v_cvt_pk_bf16_f32 v136, v136, v137
    v_accvgpr_read_b32 v61, a173
    ds_read_b64_tr_b16 a[18:19], v46 offset:1024
    v_accvgpr_read_b32 v62, a174
    v_cvt_pk_bf16_f32 v137, v138, v139
    v_accvgpr_read_b32 v63, a175
    v_cvt_pk_bf16_f32 v138, v232, v233
    v_cvt_pk_bf16_f32 v180, v56, v57
    ds_read_b64_tr_b16 a[20:21], v47 offset:0
    v_cvt_pk_bf16_f32 v139, v234, v235
    v_cvt_pk_bf16_f32 v181, v58, v59
    v_cvt_pk_bf16_f32 v140, v140, v141
    v_cvt_pk_bf16_f32 v182, v60, v61
    ds_read_b64_tr_b16 a[22:23], v47 offset:1024
    v_cvt_pk_bf16_f32 v141, v142, v143
    v_cvt_pk_bf16_f32 v183, v62, v63
    v_cvt_pk_bf16_f32 v142, v236, v237
    ds_read_b64_tr_b16 a[24:25], v48 offset:0
    v_cvt_pk_bf16_f32 v143, v238, v239
    v_accvgpr_read_b32 v56, a176
    ds_read_b64_tr_b16 a[26:27], v48 offset:1024
    v_accvgpr_read_b32 v57, a177
    v_accvgpr_read_b32 v58, a178
    ds_read_b64_tr_b16 a[28:29], v49 offset:0
    v_accvgpr_read_b32 v59, a179
    v_accvgpr_read_b32 v60, a180
    v_cvt_pk_bf16_f32 v144, v144, v145
    ds_read_b64_tr_b16 a[30:31], v49 offset:1024
    v_accvgpr_read_b32 v61, a181
    v_accvgpr_read_b32 v62, a182
    v_cvt_pk_bf16_f32 v145, v146, v147
    v_accvgpr_read_b32 v63, a183
    v_cvt_pk_bf16_f32 v146, v240, v241
    v_cvt_pk_bf16_f32 v184, v56, v57
    v_cvt_pk_bf16_f32 v147, v242, v243
    v_cvt_pk_bf16_f32 v185, v58, v59
    v_cvt_pk_bf16_f32 v148, v148, v149
    v_cvt_pk_bf16_f32 v186, v60, v61
    v_cvt_pk_bf16_f32 v149, v150, v151
    v_cvt_pk_bf16_f32 v187, v62, v63
    v_cvt_pk_bf16_f32 v150, v244, v245
    v_cvt_pk_bf16_f32 v151, v246, v247
    v_accvgpr_read_b32 v56, a184
    v_accvgpr_read_b32 v57, a185
    v_accvgpr_read_b32 v58, a186
    v_accvgpr_read_b32 v59, a187
    v_accvgpr_read_b32 v60, a188
    v_cvt_pk_bf16_f32 v152, v152, v153
    v_accvgpr_read_b32 v61, a189
    v_accvgpr_read_b32 v62, a190
    v_cvt_pk_bf16_f32 v153, v154, v155
    v_accvgpr_read_b32 v63, a191
    v_cvt_pk_bf16_f32 v154, v248, v249
    v_cvt_pk_bf16_f32 v188, v56, v57
    v_cvt_pk_bf16_f32 v155, v250, v251
    v_cvt_pk_bf16_f32 v189, v58, v59
    v_cvt_pk_bf16_f32 v156, v156, v157
    v_cvt_pk_bf16_f32 v190, v60, v61
    v_cvt_pk_bf16_f32 v157, v158, v159
    v_cvt_pk_bf16_f32 v191, v62, v63
    v_cvt_pk_bf16_f32 v158, v252, v253
    v_cvt_pk_bf16_f32 v159, v254, v255
k12_join_7:
k12_qcode:
    s_mov_b64 s[48:49], s[32:33]
    s_mov_b32 s51, 0x00020000
    s_cmp_eq_u32 s45, 0
    s_mov_b32 s50, s34
    s_cselect_b32 s56, s30, -1
    s_cselect_b32 s57, -1, s30
    s_waitcnt vmcnt(12) lgkmcnt(0)
    v_mfma_f32_16x16x32_bf16 v[192:195], a[0:3], a[192:195], 0
    ds_read_b64_tr_b16 a[32:33], v42 offset:8192
    ds_read_b64_tr_b16 a[34:35], v42 offset:9216
    v_mfma_f32_16x16x32_bf16 v[196:199], a[0:3], a[196:199], 0
    buffer_load_dwordx4 a[240:243], v36, s[8:11], s62 offen sc1
    v_mfma_f32_16x16x32_bf16 a[64:67], a[0:3], a[200:203], 0
    ds_read_b64_tr_b16 a[36:37], v43 offset:8192
    v_mfma_f32_16x16x32_bf16 a[68:71], a[0:3], a[204:207], 0
    ds_read_b64_tr_b16 a[38:39], v43 offset:9216
    v_mfma_f32_16x16x32_bf16 v[200:203], a[4:7], a[192:195], 0
    ds_read_b64_tr_b16 a[40:41], v44 offset:8192
    v_mfma_f32_16x16x32_bf16 v[204:207], a[4:7], a[196:199], 0
    buffer_load_dwordx4 a[244:247], v54, s[8:11], s62 offen sc1
    v_mfma_f32_16x16x32_bf16 a[72:75], a[4:7], a[200:203], 0
    s_lshl_b32 s31, s28, 14
    ds_read_b64_tr_b16 a[42:43], v44 offset:9216
    v_mfma_f32_16x16x32_bf16 a[76:79], a[4:7], a[204:207], 0
    s_add_u32 s16, s6, s31
    s_addc_u32 s17, s7, 0
    ds_read_b64_tr_b16 a[44:45], v45 offset:8192
    v_mfma_f32_16x16x32_bf16 v[208:211], a[8:11], a[192:195], 0
    v_mfma_f32_16x16x32_bf16 v[212:215], a[8:11], a[196:199], 0
    s_add_u32 s20, s16, 0x2000000
    s_addc_u32 s21, s17, 0
    ds_read_b64_tr_b16 a[46:47], v45 offset:9216
    v_mfma_f32_16x16x32_bf16 a[80:83], a[8:11], a[200:203], 0
    buffer_load_dwordx4 a[248:251], v37, s[8:11], s62 offen sc1
    ds_read_b64_tr_b16 a[48:49], v46 offset:8192
    v_mfma_f32_16x16x32_bf16 a[84:87], a[8:11], a[204:207], 0
    s_add_u32 s16, s16, 0x1000000
    s_addc_u32 s17, s17, 0
    ds_read_b64_tr_b16 a[50:51], v46 offset:9216
    v_mfma_f32_16x16x32_bf16 v[216:219], a[12:15], a[192:195], 0
    v_mfma_f32_16x16x32_bf16 v[220:223], a[12:15], a[196:199], 0
    s_and_b32 s17, s17, 0xffff
    ds_read_b64_tr_b16 a[52:53], v47 offset:8192
    v_mfma_f32_16x16x32_bf16 a[88:91], a[12:15], a[200:203], 0
    buffer_load_dwordx4 a[252:255], v55, s[8:11], s62 offen sc1
    ds_read_b64_tr_b16 a[54:55], v47 offset:9216
    v_mfma_f32_16x16x32_bf16 a[92:95], a[12:15], a[204:207], 0
    s_and_b32 s21, s21, 0xffff
    ds_read_b64_tr_b16 a[56:57], v48 offset:8192
    v_mfma_f32_16x16x32_bf16 v[224:227], a[16:19], a[192:195], 0
    v_mfma_f32_16x16x32_bf16 v[228:231], a[16:19], a[196:199], 0
    s_lshl_b32 s31, s29, 20
    ds_read_b64_tr_b16 a[58:59], v48 offset:9216
    v_mfma_f32_16x16x32_bf16 a[96:99], a[16:19], a[200:203], 0
    s_add_u32 s62, s62, 0x20000
    ds_read_b64_tr_b16 a[60:61], v49 offset:8192
    v_mfma_f32_16x16x32_bf16 a[100:103], a[16:19], a[204:207], 0
    s_add_u32 s52, s47, 0
    v_mfma_f32_16x16x32_bf16 v[232:235], a[20:23], a[192:195], 0
    s_sub_u32 s18, 0xf84000, s31
    buffer_store_dwordx4 v[64:67], v1, s[48:51], s52 offen offset:0 sc1
    ds_read_b64_tr_b16 a[62:63], v49 offset:9216
    v_mfma_f32_16x16x32_bf16 v[236:239], a[20:23], a[196:199], 0
    s_add_u32 s52, s47, 0
    v_mfma_f32_16x16x32_bf16 a[104:107], a[20:23], a[200:203], 0
    s_mov_b32 s22, s18
    v_mfma_f32_16x16x32_bf16 a[108:111], a[20:23], a[204:207], 0
    s_add_u32 s24, s6, 0x4806000
    s_addc_u32 s25, s7, 0
    buffer_store_dwordx4 v[68:71], v1, s[48:51], s52 offen offset:1024 sc1
    v_mfma_f32_16x16x32_bf16 v[240:243], a[24:27], a[192:195], 0
    v_mfma_f32_16x16x32_bf16 v[244:247], a[24:27], a[196:199], 0
    s_and_b32 s25, s25, 0xffff
    v_mfma_f32_16x16x32_bf16 a[112:115], a[24:27], a[200:203], 0
    v_mfma_f32_16x16x32_bf16 a[116:119], a[24:27], a[204:207], 0
    s_mov_b32 s26, 4096
    v_mfma_f32_16x16x32_bf16 v[248:251], a[28:31], a[192:195], 0
    s_cmp_eq_u32 s45, 0
    s_cbranch_scc1 k12_ool_40
k12_oolret_41:
    v_mfma_f32_16x16x32_bf16 v[252:255], a[28:31], a[196:199], 0
    v_mfma_f32_16x16x32_bf16 a[120:123], a[28:31], a[200:203], 0
    v_mfma_f32_16x16x32_bf16 a[124:127], a[28:31], a[204:207], 0
    s_waitcnt vmcnt(10) lgkmcnt(0)
    s_barrier
    v_mfma_f32_16x16x32_bf16 v[192:195], a[32:35], a[208:211], v[192:195]
    ds_read_b64_tr_b16 a[0:1], v42 offset:16384
    ds_read_b64_tr_b16 a[2:3], v42 offset:17408
    v_mfma_f32_16x16x32_bf16 v[196:199], a[32:35], a[212:215], v[196:199]
    s_add_u32 m0, s60, 131072
    v_mfma_f32_16x16x32_bf16 a[64:67], a[32:35], a[216:219], a[64:67]
    buffer_load_dwordx4 v38, s[12:15], s61 offen offset:0 lds
    ds_read_b64_tr_b16 a[4:5], v43 offset:16384
    v_mfma_f32_16x16x32_bf16 a[68:71], a[32:35], a[220:223], a[68:71]
    ds_read_b64_tr_b16 a[6:7], v43 offset:17408
    v_mfma_f32_16x16x32_bf16 v[200:203], a[36:39], a[208:211], v[200:203]
    buffer_load_dwordx4 v39, s[12:15], s61 offen offset:1024 lds
    ds_read_b64_tr_b16 a[8:9], v44 offset:16384
    v_mfma_f32_16x16x32_bf16 v[204:207], a[36:39], a[212:215], v[204:207]
    v_mfma_f32_16x16x32_bf16 a[72:75], a[36:39], a[216:219], a[72:75]
    ds_read_b64_tr_b16 a[10:11], v44 offset:17408
    v_mfma_f32_16x16x32_bf16 a[76:79], a[36:39], a[220:223], a[76:79]
    buffer_load_dwordx4 v40, s[12:15], s61 offen offset:2048 lds
    ds_read_b64_tr_b16 a[12:13], v45 offset:16384
    v_mfma_f32_16x16x32_bf16 v[208:211], a[40:43], a[208:211], v[208:211]
    v_mfma_f32_16x16x32_bf16 v[212:215], a[40:43], a[212:215], v[212:215]
    ds_read_b64_tr_b16 a[14:15], v45 offset:17408
    v_mfma_f32_16x16x32_bf16 a[80:83], a[40:43], a[216:219], a[80:83]
    buffer_load_dwordx4 v41, s[12:15], s61 offen offset:3072 lds
    ds_read_b64_tr_b16 a[16:17], v46 offset:16384
    v_mfma_f32_16x16x32_bf16 a[84:87], a[40:43], a[220:223], a[84:87]
    ds_read_b64_tr_b16 a[18:19], v46 offset:17408
    v_mfma_f32_16x16x32_bf16 v[216:219], a[44:47], a[208:211], v[216:219]
    s_add_u32 s61, s61, 0x80000
    v_mfma_f32_16x16x32_bf16 v[220:223], a[44:47], a[212:215], v[220:223]
    buffer_load_dwordx4 a[128:131], v36, s[8:11], s62 offen sc1
    ds_read_b64_tr_b16 a[20:21], v47 offset:16384
    v_mfma_f32_16x16x32_bf16 a[88:91], a[44:47], a[216:219], a[88:91]
    ds_read_b64_tr_b16 a[22:23], v47 offset:17408
    v_mfma_f32_16x16x32_bf16 a[92:95], a[44:47], a[220:223], a[92:95]
    buffer_load_dwordx4 a[132:135], v54, s[8:11], s62 offen sc1
    ds_read_b64_tr_b16 a[24:25], v48 offset:16384
    v_mfma_f32_16x16x32_bf16 v[224:227], a[48:51], a[208:211], v[224:227]
    v_mfma_f32_16x16x32_bf16 v[228:231], a[48:51], a[212:215], v[228:231]
    ds_read_b64_tr_b16 a[26:27], v48 offset:17408
    v_mfma_f32_16x16x32_bf16 a[96:99], a[48:51], a[216:219], a[96:99]
    buffer_load_dwordx4 a[136:139], v37, s[8:11], s62 offen sc1
    ds_read_b64_tr_b16 a[28:29], v49 offset:16384
    v_mfma_f32_16x16x32_bf16 a[100:103], a[48:51], a[220:223], a[100:103]
    v_mfma_f32_16x16x32_bf16 v[232:235], a[52:55], a[208:211], v[232:235]
    ds_read_b64_tr_b16 a[30:31], v49 offset:17408
    v_mfma_f32_16x16x32_bf16 v[236:239], a[52:55], a[212:215], v[236:239]
    buffer_load_dwordx4 a[140:143], v55, s[8:11], s62 offen sc1
    v_mfma_f32_16x16x32_bf16 a[104:107], a[52:55], a[216:219], a[104:107]
    v_mfma_f32_16x16x32_bf16 a[108:111], a[52:55], a[220:223], a[108:111]
    s_add_u32 s62, s62, 0x20000
    v_mfma_f32_16x16x32_bf16 v[240:243], a[56:59], a[208:211], v[240:243]
    s_add_u32 s52, s47, 0
    v_mfma_f32_16x16x32_bf16 v[244:247], a[56:59], a[212:215], v[244:247]
    buffer_store_dwordx4 v[72:75], v1, s[48:51], s52 offen offset:2048 sc1
    v_mfma_f32_16x16x32_bf16 a[112:115], a[56:59], a[216:219], a[112:115]
    v_mfma_f32_16x16x32_bf16 a[116:119], a[56:59], a[220:223], a[116:119]
    v_mfma_f32_16x16x32_bf16 v[248:251], a[60:63], a[208:211], v[248:251]
    v_mfma_f32_16x16x32_bf16 v[252:255], a[60:63], a[212:215], v[252:255]
    v_mfma_f32_16x16x32_bf16 a[120:123], a[60:63], a[216:219], a[120:123]
    v_mfma_f32_16x16x32_bf16 a[124:127], a[60:63], a[220:223], a[124:127]
    s_waitcnt vmcnt(15) lgkmcnt(0)
    v_mfma_f32_16x16x32_bf16 v[192:195], a[0:3], a[224:227], v[192:195]
    ds_read_b64_tr_b16 a[32:33], v42 offset:24576
    ds_read_b64_tr_b16 a[34:35], v42 offset:25600
    v_mfma_f32_16x16x32_bf16 v[196:199], a[0:3], a[228:231], v[196:199]
    buffer_load_dwordx4 a[144:147], v36, s[8:11], s62 offen sc1
    v_mfma_f32_16x16x32_bf16 a[64:67], a[0:3], a[232:235], a[64:67]
    ds_read_b64_tr_b16 a[36:37], v43 offset:24576
    v_mfma_f32_16x16x32_bf16 a[68:71], a[0:3], a[236:239], a[68:71]
    ds_read_b64_tr_b16 a[38:39], v43 offset:25600
    v_mfma_f32_16x16x32_bf16 v[200:203], a[4:7], a[224:227], v[200:203]
    ds_read_b64_tr_b16 a[40:41], v44 offset:24576
    v_mfma_f32_16x16x32_bf16 v[204:207], a[4:7], a[228:231], v[204:207]
    v_mfma_f32_16x16x32_bf16 a[72:75], a[4:7], a[232:235], a[72:75]
    buffer_load_dwordx4 a[148:151], v54, s[8:11], s62 offen sc1
    ds_read_b64_tr_b16 a[42:43], v44 offset:25600
    v_mfma_f32_16x16x32_bf16 a[76:79], a[4:7], a[236:239], a[76:79]
    ds_read_b64_tr_b16 a[44:45], v45 offset:24576
    v_mfma_f32_16x16x32_bf16 v[208:211], a[8:11], a[224:227], v[208:211]
    v_mfma_f32_16x16x32_bf16 v[212:215], a[8:11], a[228:231], v[212:215]
    ds_read_b64_tr_b16 a[46:47], v45 offset:25600
    v_mfma_f32_16x16x32_bf16 a[80:83], a[8:11], a[232:235], a[80:83]
    ds_read_b64_tr_b16 a[48:49], v46 offset:24576
    v_mfma_f32_16x16x32_bf16 a[84:87], a[8:11], a[236:239], a[84:87]
    buffer_load_dwordx4 a[152:155], v37, s[8:11], s62 offen sc1
    ds_read_b64_tr_b16 a[50:51], v46 offset:25600
    v_mfma_f32_16x16x32_bf16 v[216:219], a[12:15], a[224:227], v[216:219]
    v_mfma_f32_16x16x32_bf16 v[220:223], a[12:15], a[228:231], v[220:223]
    ds_read_b64_tr_b16 a[52:53], v47 offset:24576
    v_mfma_f32_16x16x32_bf16 a[88:91], a[12:15], a[232:235], a[88:91]
    ds_read_b64_tr_b16 a[54:55], v47 offset:25600
    v_mfma_f32_16x16x32_bf16 a[92:95], a[12:15], a[236:239], a[92:95]
    ds_read_b64_tr_b16 a[56:57], v48 offset:24576
    v_mfma_f32_16x16x32_bf16 v[224:227], a[16:19], a[224:227], v[224:227]
    v_mfma_f32_16x16x32_bf16 v[228:231], a[16:19], a[228:231], v[228:231]
    buffer_load_dwordx4 a[156:159], v55, s[8:11], s62 offen sc1
    ds_read_b64_tr_b16 a[58:59], v48 offset:25600
    v_mfma_f32_16x16x32_bf16 a[96:99], a[16:19], a[232:235], a[96:99]
    ds_read_b64_tr_b16 a[60:61], v49 offset:24576
    v_mfma_f32_16x16x32_bf16 a[100:103], a[16:19], a[236:239], a[100:103]
    v_mfma_f32_16x16x32_bf16 v[232:235], a[20:23], a[224:227], v[232:235]
    ds_read_b64_tr_b16 a[62:63], v49 offset:25600
    v_mfma_f32_16x16x32_bf16 v[236:239], a[20:23], a[228:231], v[236:239]
    s_add_u32 s62, s62, 0x20000
    v_mfma_f32_16x16x32_bf16 a[104:107], a[20:23], a[232:235], a[104:107]
    s_add_u32 s52, s47, 0
    v_mfma_f32_16x16x32_bf16 a[108:111], a[20:23], a[236:239], a[108:111]
    buffer_store_dwordx4 v[76:79], v1, s[48:51], s52 offen offset:3072 sc1
    v_mfma_f32_16x16x32_bf16 v[240:243], a[24:27], a[224:227], v[240:243]
    v_mfma_f32_16x16x32_bf16 v[244:247], a[24:27], a[228:231], v[244:247]
    v_mfma_f32_16x16x32_bf16 a[112:115], a[24:27], a[232:235], a[112:115]
    v_mfma_f32_16x16x32_bf16 a[116:119], a[24:27], a[236:239], a[116:119]
    v_mfma_f32_16x16x32_bf16 v[248:251], a[28:31], a[224:227], v[248:251]
    s_cmp_eq_u32 s45, 0
    s_cbranch_scc1 k12_ool_42
k12_oolret_43:
    v_mfma_f32_16x16x32_bf16 v[252:255], a[28:31], a[228:231], v[252:255]
    v_mfma_f32_16x16x32_bf16 a[120:123], a[28:31], a[232:235], a[120:123]
    v_mfma_f32_16x16x32_bf16 a[124:127], a[28:31], a[236:239], a[124:127]
    s_waitcnt vmcnt(10) lgkmcnt(0)
    s_barrier
    v_mfma_f32_16x16x32_bf16 v[192:195], a[32:35], a[240:243], v[192:195]
    ds_read_b64_tr_b16 a[0:1], v42 offset:32768
    ds_read_b64_tr_b16 a[2:3], v42 offset:33792
    v_mfma_f32_16x16x32_bf16 v[196:199], a[32:35], a[244:247], v[196:199]
    s_add_u32 m0, s60, 147456
    v_mfma_f32_16x16x32_bf16 a[64:67], a[32:35], a[248:251], a[64:67]
    buffer_load_dwordx4 v38, s[12:15], s61 offen offset:0 lds
    ds_read_b64_tr_b16 a[4:5], v43 offset:32768
    v_mfma_f32_16x16x32_bf16 a[68:71], a[32:35], a[252:255], a[68:71]
    ds_read_b64_tr_b16 a[6:7], v43 offset:33792
    v_mfma_f32_16x16x32_bf16 v[200:203], a[36:39], a[240:243], v[200:203]
    buffer_load_dwordx4 v39, s[12:15], s61 offen offset:1024 lds
    ds_read_b64_tr_b16 a[8:9], v44 offset:32768
    v_mfma_f32_16x16x32_bf16 v[204:207], a[36:39], a[244:247], v[204:207]
    v_mfma_f32_16x16x32_bf16 a[72:75], a[36:39], a[248:251], a[72:75]
    ds_read_b64_tr_b16 a[10:11], v44 offset:33792
    v_mfma_f32_16x16x32_bf16 a[76:79], a[36:39], a[252:255], a[76:79]
    buffer_load_dwordx4 v40, s[12:15], s61 offen offset:2048 lds
    ds_read_b64_tr_b16 a[12:13], v45 offset:32768
    v_mfma_f32_16x16x32_bf16 v[208:211], a[40:43], a[240:243], v[208:211]
    v_mfma_f32_16x16x32_bf16 v[212:215], a[40:43], a[244:247], v[212:215]
    ds_read_b64_tr_b16 a[14:15], v45 offset:33792
    v_mfma_f32_16x16x32_bf16 a[80:83], a[40:43], a[248:251], a[80:83]
    buffer_load_dwordx4 v41, s[12:15], s61 offen offset:3072 lds
    ds_read_b64_tr_b16 a[16:17], v46 offset:32768
    v_mfma_f32_16x16x32_bf16 a[84:87], a[40:43], a[252:255], a[84:87]
    ds_read_b64_tr_b16 a[18:19], v46 offset:33792
    v_mfma_f32_16x16x32_bf16 v[216:219], a[44:47], a[240:243], v[216:219]
    s_add_u32 s61, s61, 0x80000
    v_mfma_f32_16x16x32_bf16 v[220:223], a[44:47], a[244:247], v[220:223]
    buffer_load_dwordx4 a[160:163], v36, s[8:11], s62 offen sc1
    ds_read_b64_tr_b16 a[20:21], v47 offset:32768
    v_mfma_f32_16x16x32_bf16 a[88:91], a[44:47], a[248:251], a[88:91]
    ds_read_b64_tr_b16 a[22:23], v47 offset:33792
    v_mfma_f32_16x16x32_bf16 a[92:95], a[44:47], a[252:255], a[92:95]
    buffer_load_dwordx4 a[164:167], v54, s[8:11], s62 offen sc1
    ds_read_b64_tr_b16 a[24:25], v48 offset:32768
    v_mfma_f32_16x16x32_bf16 v[224:227], a[48:51], a[240:243], v[224:227]
    v_mfma_f32_16x16x32_bf16 v[228:231], a[48:51], a[244:247], v[228:231]
    ds_read_b64_tr_b16 a[26:27], v48 offset:33792
    v_mfma_f32_16x16x32_bf16 a[96:99], a[48:51], a[248:251], a[96:99]
    buffer_load_dwordx4 a[168:171], v37, s[8:11], s62 offen sc1
    ds_read_b64_tr_b16 a[28:29], v49 offset:32768
    v_mfma_f32_16x16x32_bf16 a[100:103], a[48:51], a[252:255], a[100:103]
    v_mfma_f32_16x16x32_bf16 v[232:235], a[52:55], a[240:243], v[232:235]
    ds_read_b64_tr_b16 a[30:31], v49 offset:33792
    v_mfma_f32_16x16x32_bf16 v[236:239], a[52:55], a[244:247], v[236:239]
    buffer_load_dwordx4 a[172:175], v55, s[8:11], s62 offen sc1
    v_mfma_f32_16x16x32_bf16 a[104:107], a[52:55], a[248:251], a[104:107]
    v_mfma_f32_16x16x32_bf16 a[108:111], a[52:55], a[252:255], a[108:111]
    s_add_u32 s62, s62, 0x20000
    v_mfma_f32_16x16x32_bf16 v[240:243], a[56:59], a[240:243], v[240:243]
    s_add_u32 s52, s47, 4096
    v_mfma_f32_16x16x32_bf16 v[244:247], a[56:59], a[244:247], v[244:247]
    buffer_store_dwordx4 v[80:83], v1, s[48:51], s52 offen offset:0 sc1
    v_mfma_f32_16x16x32_bf16 a[112:115], a[56:59], a[248:251], a[112:115]
    v_mfma_f32_16x16x32_bf16 a[116:119], a[56:59], a[252:255], a[116:119]
    v_mfma_f32_16x16x32_bf16 v[248:251], a[60:63], a[240:243], v[248:251]
    v_mfma_f32_16x16x32_bf16 v[252:255], a[60:63], a[244:247], v[252:255]
    v_mfma_f32_16x16x32_bf16 a[120:123], a[60:63], a[248:251], a[120:123]
    v_mfma_f32_16x16x32_bf16 a[124:127], a[60:63], a[252:255], a[124:127]
    s_waitcnt vmcnt(15) lgkmcnt(0)
    v_mfma_f32_16x16x32_bf16 v[192:195], a[0:3], a[128:131], v[192:195]
    ds_read_b64_tr_b16 a[32:33], v42 offset:40960
    ds_read_b64_tr_b16 a[34:35], v42 offset:41984
    v_mfma_f32_16x16x32_bf16 v[196:199], a[0:3], a[132:135], v[196:199]
    buffer_load_dwordx4 a[176:179], v36, s[8:11], s62 offen sc1
    v_mfma_f32_16x16x32_bf16 a[64:67], a[0:3], a[136:139], a[64:67]
    ds_read_b64_tr_b16 a[36:37], v43 offset:40960
    v_mfma_f32_16x16x32_bf16 a[68:71], a[0:3], a[140:143], a[68:71]
    ds_read_b64_tr_b16 a[38:39], v43 offset:41984
    v_mfma_f32_16x16x32_bf16 v[200:203], a[4:7], a[128:131], v[200:203]
    ds_read_b64_tr_b16 a[40:41], v44 offset:40960
    v_mfma_f32_16x16x32_bf16 v[204:207], a[4:7], a[132:135], v[204:207]
    v_mfma_f32_16x16x32_bf16 a[72:75], a[4:7], a[136:139], a[72:75]
    buffer_load_dwordx4 a[180:183], v54, s[8:11], s62 offen sc1
    ds_read_b64_tr_b16 a[42:43], v44 offset:41984
    v_mfma_f32_16x16x32_bf16 a[76:79], a[4:7], a[140:143], a[76:79]
    ds_read_b64_tr_b16 a[44:45], v45 offset:40960
    v_mfma_f32_16x16x32_bf16 v[208:211], a[8:11], a[128:131], v[208:211]
    v_mfma_f32_16x16x32_bf16 v[212:215], a[8:11], a[132:135], v[212:215]
    ds_read_b64_tr_b16 a[46:47], v45 offset:41984
    v_mfma_f32_16x16x32_bf16 a[80:83], a[8:11], a[136:139], a[80:83]
    ds_read_b64_tr_b16 a[48:49], v46 offset:40960
    v_mfma_f32_16x16x32_bf16 a[84:87], a[8:11], a[140:143], a[84:87]
    buffer_load_dwordx4 a[184:187], v37, s[8:11], s62 offen sc1
    ds_read_b64_tr_b16 a[50:51], v46 offset:41984
    v_mfma_f32_16x16x32_bf16 v[216:219], a[12:15], a[128:131], v[216:219]
    v_mfma_f32_16x16x32_bf16 v[220:223], a[12:15], a[132:135], v[220:223]
    ds_read_b64_tr_b16 a[52:53], v47 offset:40960
    v_mfma_f32_16x16x32_bf16 a[88:91], a[12:15], a[136:139], a[88:91]
    ds_read_b64_tr_b16 a[54:55], v47 offset:41984
    v_mfma_f32_16x16x32_bf16 a[92:95], a[12:15], a[140:143], a[92:95]
    ds_read_b64_tr_b16 a[56:57], v48 offset:40960
    v_mfma_f32_16x16x32_bf16 v[224:227], a[16:19], a[128:131], v[224:227]
    v_mfma_f32_16x16x32_bf16 v[228:231], a[16:19], a[132:135], v[228:231]
    buffer_load_dwordx4 a[188:191], v55, s[8:11], s62 offen sc1
    ds_read_b64_tr_b16 a[58:59], v48 offset:41984
    v_mfma_f32_16x16x32_bf16 a[96:99], a[16:19], a[136:139], a[96:99]
    ds_read_b64_tr_b16 a[60:61], v49 offset:40960
    v_mfma_f32_16x16x32_bf16 a[100:103], a[16:19], a[140:143], a[100:103]
    v_mfma_f32_16x16x32_bf16 v[232:235], a[20:23], a[128:131], v[232:235]
    ds_read_b64_tr_b16 a[62:63], v49 offset:41984
    v_mfma_f32_16x16x32_bf16 v[236:239], a[20:23], a[132:135], v[236:239]
    s_add_u32 s62, s62, 0x20000
    v_mfma_f32_16x16x32_bf16 a[104:107], a[20:23], a[136:139], a[104:107]
    s_add_u32 s52, s47, 4096
    v_mfma_f32_16x16x32_bf16 a[108:111], a[20:23], a[140:143], a[108:111]
    buffer_store_dwordx4 v[84:87], v1, s[48:51], s52 offen offset:1024 sc1
    v_mfma_f32_16x16x32_bf16 v[240:243], a[24:27], a[128:131], v[240:243]
    v_mfma_f32_16x16x32_bf16 v[244:247], a[24:27], a[132:135], v[244:247]
    v_mfma_f32_16x16x32_bf16 a[112:115], a[24:27], a[136:139], a[112:115]
    v_mfma_f32_16x16x32_bf16 a[116:119], a[24:27], a[140:143], a[116:119]
    v_mfma_f32_16x16x32_bf16 v[248:251], a[28:31], a[128:131], v[248:251]
    s_cmp_eq_u32 s45, 0
    s_cbranch_scc1 k12_ool_44
k12_oolret_45:
    v_mfma_f32_16x16x32_bf16 v[252:255], a[28:31], a[132:135], v[252:255]
    v_mfma_f32_16x16x32_bf16 a[120:123], a[28:31], a[136:139], a[120:123]
    v_mfma_f32_16x16x32_bf16 a[124:127], a[28:31], a[140:143], a[124:127]
    s_waitcnt vmcnt(10) lgkmcnt(0)
    s_barrier
    v_mfma_f32_16x16x32_bf16 v[192:195], a[32:35], a[144:147], v[192:195]
    ds_read_b64_tr_b16 a[0:1], v42 offset:49152
    ds_read_b64_tr_b16 a[2:3], v42 offset:50176
    v_mfma_f32_16x16x32_bf16 v[196:199], a[32:35], a[148:151], v[196:199]
    s_add_u32 m0, s60, 98304
    v_mfma_f32_16x16x32_bf16 a[64:67], a[32:35], a[152:155], a[64:67]
    buffer_load_dwordx4 v38, s[12:15], s61 offen offset:0 lds
    ds_read_b64_tr_b16 a[4:5], v43 offset:49152
    v_mfma_f32_16x16x32_bf16 a[68:71], a[32:35], a[156:159], a[68:71]
    ds_read_b64_tr_b16 a[6:7], v43 offset:50176
    v_mfma_f32_16x16x32_bf16 v[200:203], a[36:39], a[144:147], v[200:203]
    buffer_load_dwordx4 v39, s[12:15], s61 offen offset:1024 lds
    ds_read_b64_tr_b16 a[8:9], v44 offset:49152
    v_mfma_f32_16x16x32_bf16 v[204:207], a[36:39], a[148:151], v[204:207]
    v_mfma_f32_16x16x32_bf16 a[72:75], a[36:39], a[152:155], a[72:75]
    ds_read_b64_tr_b16 a[10:11], v44 offset:50176
    v_mfma_f32_16x16x32_bf16 a[76:79], a[36:39], a[156:159], a[76:79]
    buffer_load_dwordx4 v40, s[12:15], s61 offen offset:2048 lds
    ds_read_b64_tr_b16 a[12:13], v45 offset:49152
    v_mfma_f32_16x16x32_bf16 v[208:211], a[40:43], a[144:147], v[208:211]
    v_mfma_f32_16x16x32_bf16 v[212:215], a[40:43], a[148:151], v[212:215]
    ds_read_b64_tr_b16 a[14:15], v45 offset:50176
    v_mfma_f32_16x16x32_bf16 a[80:83], a[40:43], a[152:155], a[80:83]
    buffer_load_dwordx4 v41, s[12:15], s61 offen offset:3072 lds
    ds_read_b64_tr_b16 a[16:17], v46 offset:49152
    v_mfma_f32_16x16x32_bf16 a[84:87], a[40:43], a[156:159], a[84:87]
    ds_read_b64_tr_b16 a[18:19], v46 offset:50176
    v_mfma_f32_16x16x32_bf16 v[216:219], a[44:47], a[144:147], v[216:219]
    s_add_u32 s61, s61, 0x80000
    v_mfma_f32_16x16x32_bf16 v[220:223], a[44:47], a[148:151], v[220:223]
    buffer_load_dwordx4 a[192:195], v36, s[8:11], s62 offen sc1
    ds_read_b64_tr_b16 a[20:21], v47 offset:49152
    v_mfma_f32_16x16x32_bf16 a[88:91], a[44:47], a[152:155], a[88:91]
    ds_read_b64_tr_b16 a[22:23], v47 offset:50176
    v_mfma_f32_16x16x32_bf16 a[92:95], a[44:47], a[156:159], a[92:95]
    buffer_load_dwordx4 a[196:199], v54, s[8:11], s62 offen sc1
    ds_read_b64_tr_b16 a[24:25], v48 offset:49152
    v_mfma_f32_16x16x32_bf16 v[224:227], a[48:51], a[144:147], v[224:227]
    v_mfma_f32_16x16x32_bf16 v[228:231], a[48:51], a[148:151], v[228:231]
    ds_read_b64_tr_b16 a[26:27], v48 offset:50176
    v_mfma_f32_16x16x32_bf16 a[96:99], a[48:51], a[152:155], a[96:99]
    buffer_load_dwordx4 a[200:203], v37, s[8:11], s62 offen sc1
    ds_read_b64_tr_b16 a[28:29], v49 offset:49152
    v_mfma_f32_16x16x32_bf16 a[100:103], a[48:51], a[156:159], a[100:103]
    v_mfma_f32_16x16x32_bf16 v[232:235], a[52:55], a[144:147], v[232:235]
    ds_read_b64_tr_b16 a[30:31], v49 offset:50176
    v_mfma_f32_16x16x32_bf16 v[236:239], a[52:55], a[148:151], v[236:239]
    buffer_load_dwordx4 a[204:207], v55, s[8:11], s62 offen sc1
    v_mfma_f32_16x16x32_bf16 a[104:107], a[52:55], a[152:155], a[104:107]
    v_mfma_f32_16x16x32_bf16 a[108:111], a[52:55], a[156:159], a[108:111]
    s_add_u32 s62, s62, 0x20000
    v_mfma_f32_16x16x32_bf16 v[240:243], a[56:59], a[144:147], v[240:243]
    s_add_u32 s52, s47, 4096
    v_mfma_f32_16x16x32_bf16 v[244:247], a[56:59], a[148:151], v[244:247]
    buffer_store_dwordx4 v[88:91], v1, s[48:51], s52 offen offset:2048 sc1
    v_mfma_f32_16x16x32_bf16 a[112:115], a[56:59], a[152:155], a[112:115]
    v_mfma_f32_16x16x32_bf16 a[116:119], a[56:59], a[156:159], a[116:119]
    v_mfma_f32_16x16x32_bf16 v[248:251], a[60:63], a[144:147], v[248:251]
    v_mfma_f32_16x16x32_bf16 v[252:255], a[60:63], a[148:151], v[252:255]
    v_mfma_f32_16x16x32_bf16 a[120:123], a[60:63], a[152:155], a[120:123]
    v_mfma_f32_16x16x32_bf16 a[124:127], a[60:63], a[156:159], a[124:127]
    s_waitcnt vmcnt(15) lgkmcnt(0)
    v_mfma_f32_16x16x32_bf16 v[192:195], a[0:3], a[160:163], v[192:195]
    ds_read_b64_tr_b16 a[32:33], v42 offset:57344
    ds_read_b64_tr_b16 a[34:35], v42 offset:58368
    v_mfma_f32_16x16x32_bf16 v[196:199], a[0:3], a[164:167], v[196:199]
    buffer_load_dwordx4 a[208:211], v36, s[8:11], s62 offen sc1
    v_mfma_f32_16x16x32_bf16 a[64:67], a[0:3], a[168:171], a[64:67]
    ds_read_b64_tr_b16 a[36:37], v43 offset:57344
    v_mfma_f32_16x16x32_bf16 a[68:71], a[0:3], a[172:175], a[68:71]
    ds_read_b64_tr_b16 a[38:39], v43 offset:58368
    v_mfma_f32_16x16x32_bf16 v[200:203], a[4:7], a[160:163], v[200:203]
    ds_read_b64_tr_b16 a[40:41], v44 offset:57344
    v_mfma_f32_16x16x32_bf16 v[204:207], a[4:7], a[164:167], v[204:207]
    v_mfma_f32_16x16x32_bf16 a[72:75], a[4:7], a[168:171], a[72:75]
    buffer_load_dwordx4 a[212:215], v54, s[8:11], s62 offen sc1
    ds_read_b64_tr_b16 a[42:43], v44 offset:58368
    v_mfma_f32_16x16x32_bf16 a[76:79], a[4:7], a[172:175], a[76:79]
    ds_read_b64_tr_b16 a[44:45], v45 offset:57344
    v_mfma_f32_16x16x32_bf16 v[208:211], a[8:11], a[160:163], v[208:211]
    v_mfma_f32_16x16x32_bf16 v[212:215], a[8:11], a[164:167], v[212:215]
    ds_read_b64_tr_b16 a[46:47], v45 offset:58368
    v_mfma_f32_16x16x32_bf16 a[80:83], a[8:11], a[168:171], a[80:83]
    ds_read_b64_tr_b16 a[48:49], v46 offset:57344
    v_mfma_f32_16x16x32_bf16 a[84:87], a[8:11], a[172:175], a[84:87]
    buffer_load_dwordx4 a[216:219], v37, s[8:11], s62 offen sc1
    ds_read_b64_tr_b16 a[50:51], v46 offset:58368
    v_mfma_f32_16x16x32_bf16 v[216:219], a[12:15], a[160:163], v[216:219]
    v_mfma_f32_16x16x32_bf16 v[220:223], a[12:15], a[164:167], v[220:223]
    ds_read_b64_tr_b16 a[52:53], v47 offset:57344
    v_mfma_f32_16x16x32_bf16 a[88:91], a[12:15], a[168:171], a[88:91]
    ds_read_b64_tr_b16 a[54:55], v47 offset:58368
    v_mfma_f32_16x16x32_bf16 a[92:95], a[12:15], a[172:175], a[92:95]
    ds_read_b64_tr_b16 a[56:57], v48 offset:57344
    v_mfma_f32_16x16x32_bf16 v[224:227], a[16:19], a[160:163], v[224:227]
    v_mfma_f32_16x16x32_bf16 v[228:231], a[16:19], a[164:167], v[228:231]
    buffer_load_dwordx4 a[220:223], v55, s[8:11], s62 offen sc1
    ds_read_b64_tr_b16 a[58:59], v48 offset:58368
    v_mfma_f32_16x16x32_bf16 a[96:99], a[16:19], a[168:171], a[96:99]
    ds_read_b64_tr_b16 a[60:61], v49 offset:57344
    v_mfma_f32_16x16x32_bf16 a[100:103], a[16:19], a[172:175], a[100:103]
    v_mfma_f32_16x16x32_bf16 v[232:235], a[20:23], a[160:163], v[232:235]
    ds_read_b64_tr_b16 a[62:63], v49 offset:58368
    v_mfma_f32_16x16x32_bf16 v[236:239], a[20:23], a[164:167], v[236:239]
    s_add_u32 s62, s62, 0x20000
    v_mfma_f32_16x16x32_bf16 a[104:107], a[20:23], a[168:171], a[104:107]
    s_add_u32 s52, s47, 4096
    v_mfma_f32_16x16x32_bf16 a[108:111], a[20:23], a[172:175], a[108:111]
    buffer_store_dwordx4 v[92:95], v1, s[48:51], s52 offen offset:3072 sc1
    v_mfma_f32_16x16x32_bf16 v[240:243], a[24:27], a[160:163], v[240:243]
    v_mfma_f32_16x16x32_bf16 v[244:247], a[24:27], a[164:167], v[244:247]
    v_mfma_f32_16x16x32_bf16 a[112:115], a[24:27], a[168:171], a[112:115]
    v_mfma_f32_16x16x32_bf16 a[116:119], a[24:27], a[172:175], a[116:119]
    v_mfma_f32_16x16x32_bf16 v[248:251], a[28:31], a[160:163], v[248:251]
    s_cmp_eq_u32 s45, 0
    s_cbranch_scc1 k12_ool_46
k12_oolret_47:
    v_mfma_f32_16x16x32_bf16 v[252:255], a[28:31], a[164:167], v[252:255]
    v_mfma_f32_16x16x32_bf16 a[120:123], a[28:31], a[168:171], a[120:123]
    v_mfma_f32_16x16x32_bf16 a[124:127], a[28:31], a[172:175], a[124:127]
    s_waitcnt vmcnt(10) lgkmcnt(0)
    s_barrier
    v_mfma_f32_16x16x32_bf16 v[192:195], a[32:35], a[176:179], v[192:195]
    ds_read_b64_tr_b16 a[0:1], v42 offset:0
    ds_read_b64_tr_b16 a[2:3], v42 offset:1024
    v_mfma_f32_16x16x32_bf16 v[196:199], a[32:35], a[180:183], v[196:199]
    s_add_u32 m0, s60, 114688
    v_mfma_f32_16x16x32_bf16 a[64:67], a[32:35], a[184:187], a[64:67]
    buffer_load_dwordx4 v38, s[12:15], s61 offen offset:0 lds
    ds_read_b64_tr_b16 a[4:5], v43 offset:0
    v_mfma_f32_16x16x32_bf16 a[68:71], a[32:35], a[188:191], a[68:71]
    ds_read_b64_tr_b16 a[6:7], v43 offset:1024
    v_mfma_f32_16x16x32_bf16 v[200:203], a[36:39], a[176:179], v[200:203]
    buffer_load_dwordx4 v39, s[12:15], s61 offen offset:1024 lds
    ds_read_b64_tr_b16 a[8:9], v44 offset:0
    v_mfma_f32_16x16x32_bf16 v[204:207], a[36:39], a[180:183], v[204:207]
    v_mfma_f32_16x16x32_bf16 a[72:75], a[36:39], a[184:187], a[72:75]
    ds_read_b64_tr_b16 a[10:11], v44 offset:1024
    v_mfma_f32_16x16x32_bf16 a[76:79], a[36:39], a[188:191], a[76:79]
    buffer_load_dwordx4 v40, s[12:15], s61 offen offset:2048 lds
    ds_read_b64_tr_b16 a[12:13], v45 offset:0
    v_mfma_f32_16x16x32_bf16 v[208:211], a[40:43], a[176:179], v[208:211]
    v_mfma_f32_16x16x32_bf16 v[212:215], a[40:43], a[180:183], v[212:215]
    ds_read_b64_tr_b16 a[14:15], v45 offset:1024
    v_mfma_f32_16x16x32_bf16 a[80:83], a[40:43], a[184:187], a[80:83]
    buffer_load_dwordx4 v41, s[12:15], s61 offen offset:3072 lds
    ds_read_b64_tr_b16 a[16:17], v46 offset:0
    v_mfma_f32_16x16x32_bf16 a[84:87], a[40:43], a[188:191], a[84:87]
    ds_read_b64_tr_b16 a[18:19], v46 offset:1024
    v_mfma_f32_16x16x32_bf16 v[216:219], a[44:47], a[176:179], v[216:219]
    s_add_u32 s61, s61, 0x80000
    v_mfma_f32_16x16x32_bf16 v[220:223], a[44:47], a[180:183], v[220:223]
    buffer_load_dwordx4 a[224:227], v36, s[8:11], s62 offen sc1
    ds_read_b64_tr_b16 a[20:21], v47 offset:0
    v_mfma_f32_16x16x32_bf16 a[88:91], a[44:47], a[184:187], a[88:91]
    ds_read_b64_tr_b16 a[22:23], v47 offset:1024
    v_mfma_f32_16x16x32_bf16 a[92:95], a[44:47], a[188:191], a[92:95]
    buffer_load_dwordx4 a[228:231], v54, s[8:11], s62 offen sc1
    ds_read_b64_tr_b16 a[24:25], v48 offset:0
    v_mfma_f32_16x16x32_bf16 v[224:227], a[48:51], a[176:179], v[224:227]
    v_mfma_f32_16x16x32_bf16 v[228:231], a[48:51], a[180:183], v[228:231]
    ds_read_b64_tr_b16 a[26:27], v48 offset:1024
    v_mfma_f32_16x16x32_bf16 a[96:99], a[48:51], a[184:187], a[96:99]
    buffer_load_dwordx4 a[232:235], v37, s[8:11], s62 offen sc1
    ds_read_b64_tr_b16 a[28:29], v49 offset:0
    v_mfma_f32_16x16x32_bf16 a[100:103], a[48:51], a[188:191], a[100:103]
    v_mfma_f32_16x16x32_bf16 v[232:235], a[52:55], a[176:179], v[232:235]
    ds_read_b64_tr_b16 a[30:31], v49 offset:1024
    v_mfma_f32_16x16x32_bf16 v[236:239], a[52:55], a[180:183], v[236:239]
    buffer_load_dwordx4 a[236:239], v55, s[8:11], s62 offen sc1
    v_mfma_f32_16x16x32_bf16 a[104:107], a[52:55], a[184:187], a[104:107]
    v_mfma_f32_16x16x32_bf16 a[108:111], a[52:55], a[188:191], a[108:111]
    s_add_u32 s62, s62, 0x20000
    v_mfma_f32_16x16x32_bf16 v[240:243], a[56:59], a[176:179], v[240:243]
    s_add_u32 s52, s47, 8192
    v_mfma_f32_16x16x32_bf16 v[244:247], a[56:59], a[180:183], v[244:247]
    buffer_store_dwordx4 v[96:99], v1, s[48:51], s52 offen offset:0 sc1
    v_mfma_f32_16x16x32_bf16 a[112:115], a[56:59], a[184:187], a[112:115]
    v_mfma_f32_16x16x32_bf16 a[116:119], a[56:59], a[188:191], a[116:119]
    v_mfma_f32_16x16x32_bf16 v[248:251], a[60:63], a[176:179], v[248:251]
    v_mfma_f32_16x16x32_bf16 v[252:255], a[60:63], a[180:183], v[252:255]
    v_mfma_f32_16x16x32_bf16 a[120:123], a[60:63], a[184:187], a[120:123]
    v_mfma_f32_16x16x32_bf16 a[124:127], a[60:63], a[188:191], a[124:127]
    s_waitcnt vmcnt(15) lgkmcnt(0)
    v_mfma_f32_16x16x32_bf16 v[192:195], a[0:3], a[192:195], v[192:195]
    ds_read_b64_tr_b16 a[32:33], v42 offset:8192
    ds_read_b64_tr_b16 a[34:35], v42 offset:9216
    v_mfma_f32_16x16x32_bf16 v[196:199], a[0:3], a[196:199], v[196:199]
    buffer_load_dwordx4 a[240:243], v36, s[8:11], s62 offen sc1
    v_mfma_f32_16x16x32_bf16 a[64:67], a[0:3], a[200:203], a[64:67]
    ds_read_b64_tr_b16 a[36:37], v43 offset:8192
    v_mfma_f32_16x16x32_bf16 a[68:71], a[0:3], a[204:207], a[68:71]
    ds_read_b64_tr_b16 a[38:39], v43 offset:9216
    v_mfma_f32_16x16x32_bf16 v[200:203], a[4:7], a[192:195], v[200:203]
    ds_read_b64_tr_b16 a[40:41], v44 offset:8192
    v_mfma_f32_16x16x32_bf16 v[204:207], a[4:7], a[196:199], v[204:207]
    v_mfma_f32_16x16x32_bf16 a[72:75], a[4:7], a[200:203], a[72:75]
    buffer_load_dwordx4 a[244:247], v54, s[8:11], s62 offen sc1
    ds_read_b64_tr_b16 a[42:43], v44 offset:9216
    v_mfma_f32_16x16x32_bf16 a[76:79], a[4:7], a[204:207], a[76:79]
    ds_read_b64_tr_b16 a[44:45], v45 offset:8192
    v_mfma_f32_16x16x32_bf16 v[208:211], a[8:11], a[192:195], v[208:211]
    v_mfma_f32_16x16x32_bf16 v[212:215], a[8:11], a[196:199], v[212:215]
    ds_read_b64_tr_b16 a[46:47], v45 offset:9216
    v_mfma_f32_16x16x32_bf16 a[80:83], a[8:11], a[200:203], a[80:83]
    ds_read_b64_tr_b16 a[48:49], v46 offset:8192
    v_mfma_f32_16x16x32_bf16 a[84:87], a[8:11], a[204:207], a[84:87]
    buffer_load_dwordx4 a[248:251], v37, s[8:11], s62 offen sc1
    ds_read_b64_tr_b16 a[50:51], v46 offset:9216
    v_mfma_f32_16x16x32_bf16 v[216:219], a[12:15], a[192:195], v[216:219]
    v_mfma_f32_16x16x32_bf16 v[220:223], a[12:15], a[196:199], v[220:223]
    ds_read_b64_tr_b16 a[52:53], v47 offset:8192
    v_mfma_f32_16x16x32_bf16 a[88:91], a[12:15], a[200:203], a[88:91]
    ds_read_b64_tr_b16 a[54:55], v47 offset:9216
    v_mfma_f32_16x16x32_bf16 a[92:95], a[12:15], a[204:207], a[92:95]
    ds_read_b64_tr_b16 a[56:57], v48 offset:8192
    v_mfma_f32_16x16x32_bf16 v[224:227], a[16:19], a[192:195], v[224:227]
    v_mfma_f32_16x16x32_bf16 v[228:231], a[16:19], a[196:199], v[228:231]
    buffer_load_dwordx4 a[252:255], v55, s[8:11], s62 offen sc1
    ds_read_b64_tr_b16 a[58:59], v48 offset:9216
    v_mfma_f32_16x16x32_bf16 a[96:99], a[16:19], a[200:203], a[96:99]
    ds_read_b64_tr_b16 a[60:61], v49 offset:8192
    v_mfma_f32_16x16x32_bf16 a[100:103], a[16:19], a[204:207], a[100:103]
    v_mfma_f32_16x16x32_bf16 v[232:235], a[20:23], a[192:195], v[232:235]
    ds_read_b64_tr_b16 a[62:63], v49 offset:9216
    v_mfma_f32_16x16x32_bf16 v[236:239], a[20:23], a[196:199], v[236:239]
    s_add_u32 s62, s62, 0x20000
    v_mfma_f32_16x16x32_bf16 a[104:107], a[20:23], a[200:203], a[104:107]
    s_add_u32 s52, s47, 8192
    v_mfma_f32_16x16x32_bf16 a[108:111], a[20:23], a[204:207], a[108:111]
    buffer_store_dwordx4 v[100:103], v1, s[48:51], s52 offen offset:1024 sc1
    v_mfma_f32_16x16x32_bf16 v[240:243], a[24:27], a[192:195], v[240:243]
    v_mfma_f32_16x16x32_bf16 v[244:247], a[24:27], a[196:199], v[244:247]
    v_mfma_f32_16x16x32_bf16 a[112:115], a[24:27], a[200:203], a[112:115]
    v_mfma_f32_16x16x32_bf16 a[116:119], a[24:27], a[204:207], a[116:119]
    v_mfma_f32_16x16x32_bf16 v[248:251], a[28:31], a[192:195], v[248:251]
    s_cmp_eq_u32 s45, 0
    s_cbranch_scc1 k12_ool_48
k12_oolret_49:
    v_mfma_f32_16x16x32_bf16 v[252:255], a[28:31], a[196:199], v[252:255]
    v_mfma_f32_16x16x32_bf16 a[120:123], a[28:31], a[200:203], a[120:123]
    v_mfma_f32_16x16x32_bf16 a[124:127], a[28:31], a[204:207], a[124:127]
    s_waitcnt vmcnt(10) lgkmcnt(0)
    s_barrier
    v_mfma_f32_16x16x32_bf16 v[192:195], a[32:35], a[208:211], v[192:195]
    ds_read_b64_tr_b16 a[0:1], v42 offset:16384
    ds_read_b64_tr_b16 a[2:3], v42 offset:17408
    v_mfma_f32_16x16x32_bf16 v[196:199], a[32:35], a[212:215], v[196:199]
    s_add_u32 m0, s60, 131072
    v_mfma_f32_16x16x32_bf16 a[64:67], a[32:35], a[216:219], a[64:67]
    buffer_load_dwordx4 v38, s[12:15], s61 offen offset:0 lds
    ds_read_b64_tr_b16 a[4:5], v43 offset:16384
    v_mfma_f32_16x16x32_bf16 a[68:71], a[32:35], a[220:223], a[68:71]
    ds_read_b64_tr_b16 a[6:7], v43 offset:17408
    v_mfma_f32_16x16x32_bf16 v[200:203], a[36:39], a[208:211], v[200:203]
    buffer_load_dwordx4 v39, s[12:15], s61 offen offset:1024 lds
    ds_read_b64_tr_b16 a[8:9], v44 offset:16384
    v_mfma_f32_16x16x32_bf16 v[204:207], a[36:39], a[212:215], v[204:207]
    v_mfma_f32_16x16x32_bf16 a[72:75], a[36:39], a[216:219], a[72:75]
    buffer_load_dwordx4 v40, s[12:15], s61 offen offset:2048 lds
    ds_read_b64_tr_b16 a[10:11], v44 offset:17408
    v_mfma_f32_16x16x32_bf16 a[76:79], a[36:39], a[220:223], a[76:79]
    ds_read_b64_tr_b16 a[12:13], v45 offset:16384
    v_mfma_f32_16x16x32_bf16 v[208:211], a[40:43], a[208:211], v[208:211]
    v_mfma_f32_16x16x32_bf16 v[212:215], a[40:43], a[212:215], v[212:215]
    buffer_load_dwordx4 v41, s[12:15], s61 offen offset:3072 lds
    ds_read_b64_tr_b16 a[14:15], v45 offset:17408
    v_mfma_f32_16x16x32_bf16 a[80:83], a[40:43], a[216:219], a[80:83]
    s_add_u32 s61, s61, 0x80000
    ds_read_b64_tr_b16 a[16:17], v46 offset:16384
    v_mfma_f32_16x16x32_bf16 a[84:87], a[40:43], a[220:223], a[84:87]
    buffer_load_dwordx4 a[128:131], v36, s[8:11], s62 offen sc1
    ds_read_b64_tr_b16 a[18:19], v46 offset:17408
    v_mfma_f32_16x16x32_bf16 v[216:219], a[44:47], a[208:211], v[216:219]
    v_mfma_f32_16x16x32_bf16 v[220:223], a[44:47], a[212:215], v[220:223]
    ds_read_b64_tr_b16 a[20:21], v47 offset:16384
    v_mfma_f32_16x16x32_bf16 a[88:91], a[44:47], a[216:219], a[88:91]
    buffer_load_dwordx4 a[132:135], v54, s[8:11], s62 offen sc1
    ds_read_b64_tr_b16 a[22:23], v47 offset:17408
    v_mfma_f32_16x16x32_bf16 a[92:95], a[44:47], a[220:223], a[92:95]
    ds_read_b64_tr_b16 a[24:25], v48 offset:16384
    v_mfma_f32_16x16x32_bf16 v[224:227], a[48:51], a[208:211], v[224:227]
    v_mfma_f32_16x16x32_bf16 v[228:231], a[48:51], a[212:215], v[228:231]
    buffer_load_dwordx4 a[136:139], v37, s[8:11], s62 offen sc1
    ds_read_b64_tr_b16 a[26:27], v48 offset:17408
    v_mfma_f32_16x16x32_bf16 a[96:99], a[48:51], a[216:219], a[96:99]
    ds_read_b64_tr_b16 a[28:29], v49 offset:16384
    v_mfma_f32_16x16x32_bf16 a[100:103], a[48:51], a[220:223], a[100:103]
    buffer_load_dwordx4 a[140:143], v55, s[8:11], s62 offen sc1
    v_mfma_f32_16x16x32_bf16 v[232:235], a[52:55], a[208:211], v[232:235]
    ds_read_b64_tr_b16 a[30:31], v49 offset:17408
    v_mfma_f32_16x16x32_bf16 v[236:239], a[52:55], a[212:215], v[236:239]
    s_add_u32 s62, s62, 0x20000
    v_mfma_f32_16x16x32_bf16 a[104:107], a[52:55], a[216:219], a[104:107]
    s_add_u32 s52, s47, 8192
    v_mfma_f32_16x16x32_bf16 a[108:111], a[52:55], a[220:223], a[108:111]
    buffer_store_dwordx4 v[104:107], v1, s[48:51], s52 offen offset:2048 sc1
    v_mfma_f32_16x16x32_bf16 v[240:243], a[56:59], a[208:211], v[240:243]
    s_add_u32 s52, s47, 8192
    v_mfma_f32_16x16x32_bf16 v[244:247], a[56:59], a[212:215], v[244:247]
    buffer_store_dwordx4 v[108:111], v1, s[48:51], s52 offen offset:3072 sc1
    v_mfma_f32_16x16x32_bf16 a[112:115], a[56:59], a[216:219], a[112:115]
    v_mfma_f32_16x16x32_bf16 a[116:119], a[56:59], a[220:223], a[116:119]
    v_mfma_f32_16x16x32_bf16 v[248:251], a[60:63], a[208:211], v[248:251]
    v_mfma_f32_16x16x32_bf16 v[252:255], a[60:63], a[212:215], v[252:255]
    v_mfma_f32_16x16x32_bf16 a[120:123], a[60:63], a[216:219], a[120:123]
    v_mfma_f32_16x16x32_bf16 a[124:127], a[60:63], a[220:223], a[124:127]
    s_waitcnt vmcnt(16) lgkmcnt(0)
    v_mfma_f32_16x16x32_bf16 v[192:195], a[0:3], a[224:227], v[192:195]
    ds_read_b64_tr_b16 a[32:33], v42 offset:24576
    ds_read_b64_tr_b16 a[34:35], v42 offset:25600
    v_mfma_f32_16x16x32_bf16 v[196:199], a[0:3], a[228:231], v[196:199]
    buffer_load_dwordx4 a[144:147], v36, s[8:11], s62 offen sc1
    v_mfma_f32_16x16x32_bf16 a[64:67], a[0:3], a[232:235], a[64:67]
    ds_read_b64_tr_b16 a[36:37], v43 offset:24576
    v_mfma_f32_16x16x32_bf16 a[68:71], a[0:3], a[236:239], a[68:71]
    ds_read_b64_tr_b16 a[38:39], v43 offset:25600
    v_mfma_f32_16x16x32_bf16 v[200:203], a[4:7], a[224:227], v[200:203]
    ds_read_b64_tr_b16 a[40:41], v44 offset:24576
    v_mfma_f32_16x16x32_bf16 v[204:207], a[4:7], a[228:231], v[204:207]
    v_mfma_f32_16x16x32_bf16 a[72:75], a[4:7], a[232:235], a[72:75]
    buffer_load_dwordx4 a[148:151], v54, s[8:11], s62 offen sc1
    ds_read_b64_tr_b16 a[42:43], v44 offset:25600
    v_mfma_f32_16x16x32_bf16 a[76:79], a[4:7], a[236:239], a[76:79]
    ds_read_b64_tr_b16 a[44:45], v45 offset:24576
    v_mfma_f32_16x16x32_bf16 v[208:211], a[8:11], a[224:227], v[208:211]
    v_mfma_f32_16x16x32_bf16 v[212:215], a[8:11], a[228:231], v[212:215]
    ds_read_b64_tr_b16 a[46:47], v45 offset:25600
    v_mfma_f32_16x16x32_bf16 a[80:83], a[8:11], a[232:235], a[80:83]
    ds_read_b64_tr_b16 a[48:49], v46 offset:24576
    v_mfma_f32_16x16x32_bf16 a[84:87], a[8:11], a[236:239], a[84:87]
    buffer_load_dwordx4 a[152:155], v37, s[8:11], s62 offen sc1
    ds_read_b64_tr_b16 a[50:51], v46 offset:25600
    v_mfma_f32_16x16x32_bf16 v[216:219], a[12:15], a[224:227], v[216:219]
    v_mfma_f32_16x16x32_bf16 v[220:223], a[12:15], a[228:231], v[220:223]
    ds_read_b64_tr_b16 a[52:53], v47 offset:24576
    v_mfma_f32_16x16x32_bf16 a[88:91], a[12:15], a[232:235], a[88:91]
    ds_read_b64_tr_b16 a[54:55], v47 offset:25600
    v_mfma_f32_16x16x32_bf16 a[92:95], a[12:15], a[236:239], a[92:95]
    ds_read_b64_tr_b16 a[56:57], v48 offset:24576
    v_mfma_f32_16x16x32_bf16 v[224:227], a[16:19], a[224:227], v[224:227]
    v_mfma_f32_16x16x32_bf16 v[228:231], a[16:19], a[228:231], v[228:231]
    buffer_load_dwordx4 a[156:159], v55, s[8:11], s62 offen sc1
    ds_read_b64_tr_b16 a[58:59], v48 offset:25600
    v_mfma_f32_16x16x32_bf16 a[96:99], a[16:19], a[232:235], a[96:99]
    ds_read_b64_tr_b16 a[60:61], v49 offset:24576
    v_mfma_f32_16x16x32_bf16 a[100:103], a[16:19], a[236:239], a[100:103]
    v_mfma_f32_16x16x32_bf16 v[232:235], a[20:23], a[224:227], v[232:235]
    ds_read_b64_tr_b16 a[62:63], v49 offset:25600
    v_mfma_f32_16x16x32_bf16 v[236:239], a[20:23], a[228:231], v[236:239]
    s_add_u32 s62, s62, 0x20000
    v_mfma_f32_16x16x32_bf16 a[104:107], a[20:23], a[232:235], a[104:107]
    s_add_u32 s52, s47, 12288
    v_mfma_f32_16x16x32_bf16 a[108:111], a[20:23], a[236:239], a[108:111]
    buffer_store_dwordx4 v[112:115], v1, s[48:51], s52 offen offset:0 sc1
    v_mfma_f32_16x16x32_bf16 v[240:243], a[24:27], a[224:227], v[240:243]
    v_mfma_f32_16x16x32_bf16 v[244:247], a[24:27], a[228:231], v[244:247]
    v_mfma_f32_16x16x32_bf16 a[112:115], a[24:27], a[232:235], a[112:115]
    v_mfma_f32_16x16x32_bf16 a[116:119], a[24:27], a[236:239], a[116:119]
    v_mfma_f32_16x16x32_bf16 v[248:251], a[28:31], a[224:227], v[248:251]
    v_mfma_f32_16x16x32_bf16 v[252:255], a[28:31], a[228:231], v[252:255]
    v_mfma_f32_16x16x32_bf16 a[120:123], a[28:31], a[232:235], a[120:123]
    v_mfma_f32_16x16x32_bf16 a[124:127], a[28:31], a[236:239], a[124:127]
    s_waitcnt vmcnt(11) lgkmcnt(0)
    s_barrier
    v_mfma_f32_16x16x32_bf16 v[192:195], a[32:35], a[240:243], v[192:195]
    ds_read_b64_tr_b16 a[0:1], v42 offset:32768
    ds_read_b64_tr_b16 a[2:3], v42 offset:33792
    v_mfma_f32_16x16x32_bf16 v[196:199], a[32:35], a[244:247], v[196:199]
    s_add_u32 m0, s60, 147456
    v_mfma_f32_16x16x32_bf16 a[64:67], a[32:35], a[248:251], a[64:67]
    buffer_load_dwordx4 v38, s[12:15], s61 offen offset:0 lds
    ds_read_b64_tr_b16 a[4:5], v43 offset:32768
    v_mfma_f32_16x16x32_bf16 a[68:71], a[32:35], a[252:255], a[68:71]
    ds_read_b64_tr_b16 a[6:7], v43 offset:33792
    v_mfma_f32_16x16x32_bf16 v[200:203], a[36:39], a[240:243], v[200:203]
    buffer_load_dwordx4 v39, s[12:15], s61 offen offset:1024 lds
    ds_read_b64_tr_b16 a[8:9], v44 offset:32768
    v_mfma_f32_16x16x32_bf16 v[204:207], a[36:39], a[244:247], v[204:207]
    v_mfma_f32_16x16x32_bf16 a[72:75], a[36:39], a[248:251], a[72:75]
    ds_read_b64_tr_b16 a[10:11], v44 offset:33792
    v_mfma_f32_16x16x32_bf16 a[76:79], a[36:39], a[252:255], a[76:79]
    buffer_load_dwordx4 v40, s[12:15], s61 offen offset:2048 lds
    ds_read_b64_tr_b16 a[12:13], v45 offset:32768
    v_mfma_f32_16x16x32_bf16 v[208:211], a[40:43], a[240:243], v[208:211]
    v_mfma_f32_16x16x32_bf16 v[212:215], a[40:43], a[244:247], v[212:215]
    ds_read_b64_tr_b16 a[14:15], v45 offset:33792
    v_mfma_f32_16x16x32_bf16 a[80:83], a[40:43], a[248:251], a[80:83]
    buffer_load_dwordx4 v41, s[12:15], s61 offen offset:3072 lds
    ds_read_b64_tr_b16 a[16:17], v46 offset:32768
    v_mfma_f32_16x16x32_bf16 a[84:87], a[40:43], a[252:255], a[84:87]
    ds_read_b64_tr_b16 a[18:19], v46 offset:33792
    v_mfma_f32_16x16x32_bf16 v[216:219], a[44:47], a[240:243], v[216:219]
    s_add_u32 s61, s61, 0x80000
    v_mfma_f32_16x16x32_bf16 v[220:223], a[44:47], a[244:247], v[220:223]
    buffer_load_dwordx4 a[160:163], v36, s[8:11], s62 offen sc1
    ds_read_b64_tr_b16 a[20:21], v47 offset:32768
    v_mfma_f32_16x16x32_bf16 a[88:91], a[44:47], a[248:251], a[88:91]
    ds_read_b64_tr_b16 a[22:23], v47 offset:33792
    v_mfma_f32_16x16x32_bf16 a[92:95], a[44:47], a[252:255], a[92:95]
    buffer_load_dwordx4 a[164:167], v54, s[8:11], s62 offen sc1
    ds_read_b64_tr_b16 a[24:25], v48 offset:32768
    v_mfma_f32_16x16x32_bf16 v[224:227], a[48:51], a[240:243], v[224:227]
    v_mfma_f32_16x16x32_bf16 v[228:231], a[48:51], a[244:247], v[228:231]
    ds_read_b64_tr_b16 a[26:27], v48 offset:33792
    v_mfma_f32_16x16x32_bf16 a[96:99], a[48:51], a[248:251], a[96:99]
    buffer_load_dwordx4 a[168:171], v37, s[8:11], s62 offen sc1
    ds_read_b64_tr_b16 a[28:29], v49 offset:32768
    v_mfma_f32_16x16x32_bf16 a[100:103], a[48:51], a[252:255], a[100:103]
    v_mfma_f32_16x16x32_bf16 v[232:235], a[52:55], a[240:243], v[232:235]
    ds_read_b64_tr_b16 a[30:31], v49 offset:33792
    v_mfma_f32_16x16x32_bf16 v[236:239], a[52:55], a[244:247], v[236:239]
    buffer_load_dwordx4 a[172:175], v55, s[8:11], s62 offen sc1
    v_mfma_f32_16x16x32_bf16 a[104:107], a[52:55], a[248:251], a[104:107]
    v_mfma_f32_16x16x32_bf16 a[108:111], a[52:55], a[252:255], a[108:111]
    s_add_u32 s62, s62, 0x20000
    v_mfma_f32_16x16x32_bf16 v[240:243], a[56:59], a[240:243], v[240:243]
    s_add_u32 s52, s47, 12288
    v_mfma_f32_16x16x32_bf16 v[244:247], a[56:59], a[244:247], v[244:247]
    buffer_store_dwordx4 v[116:119], v1, s[48:51], s52 offen offset:1024 sc1
    v_mfma_f32_16x16x32_bf16 a[112:115], a[56:59], a[248:251], a[112:115]
    v_mfma_f32_16x16x32_bf16 a[116:119], a[56:59], a[252:255], a[116:119]
    v_mfma_f32_16x16x32_bf16 v[248:251], a[60:63], a[240:243], v[248:251]
    s_cmp_eq_u32 s45, 0
    s_cbranch_scc1 k12_ool_50
k12_oolret_51:
    v_mfma_f32_16x16x32_bf16 v[252:255], a[60:63], a[244:247], v[252:255]
    v_mfma_f32_16x16x32_bf16 a[120:123], a[60:63], a[248:251], a[120:123]
    v_mfma_f32_16x16x32_bf16 a[124:127], a[60:63], a[252:255], a[124:127]
    s_waitcnt vmcnt(16) lgkmcnt(0)
    v_mfma_f32_16x16x32_bf16 v[192:195], a[0:3], a[128:131], v[192:195]
    ds_read_b64_tr_b16 a[32:33], v42 offset:40960
    ds_read_b64_tr_b16 a[34:35], v42 offset:41984
    v_mfma_f32_16x16x32_bf16 v[196:199], a[0:3], a[132:135], v[196:199]
    buffer_load_dwordx4 a[176:179], v36, s[8:11], s62 offen sc1
    v_mfma_f32_16x16x32_bf16 a[64:67], a[0:3], a[136:139], a[64:67]
    ds_read_b64_tr_b16 a[36:37], v43 offset:40960
    v_mfma_f32_16x16x32_bf16 a[68:71], a[0:3], a[140:143], a[68:71]
    ds_read_b64_tr_b16 a[38:39], v43 offset:41984
    v_mfma_f32_16x16x32_bf16 v[200:203], a[4:7], a[128:131], v[200:203]
    ds_read_b64_tr_b16 a[40:41], v44 offset:40960
    v_mfma_f32_16x16x32_bf16 v[204:207], a[4:7], a[132:135], v[204:207]
    v_mfma_f32_16x16x32_bf16 a[72:75], a[4:7], a[136:139], a[72:75]
    buffer_load_dwordx4 a[180:183], v54, s[8:11], s62 offen sc1
    ds_read_b64_tr_b16 a[42:43], v44 offset:41984
    v_mfma_f32_16x16x32_bf16 a[76:79], a[4:7], a[140:143], a[76:79]
    ds_read_b64_tr_b16 a[44:45], v45 offset:40960
    v_mfma_f32_16x16x32_bf16 v[208:211], a[8:11], a[128:131], v[208:211]
    v_mfma_f32_16x16x32_bf16 v[212:215], a[8:11], a[132:135], v[212:215]
    ds_read_b64_tr_b16 a[46:47], v45 offset:41984
    v_mfma_f32_16x16x32_bf16 a[80:83], a[8:11], a[136:139], a[80:83]
    ds_read_b64_tr_b16 a[48:49], v46 offset:40960
    v_mfma_f32_16x16x32_bf16 a[84:87], a[8:11], a[140:143], a[84:87]
    buffer_load_dwordx4 a[184:187], v37, s[8:11], s62 offen sc1
    ds_read_b64_tr_b16 a[50:51], v46 offset:41984
    v_mfma_f32_16x16x32_bf16 v[216:219], a[12:15], a[128:131], v[216:219]
    v_mfma_f32_16x16x32_bf16 v[220:223], a[12:15], a[132:135], v[220:223]
    ds_read_b64_tr_b16 a[52:53], v47 offset:40960
    v_mfma_f32_16x16x32_bf16 a[88:91], a[12:15], a[136:139], a[88:91]
    ds_read_b64_tr_b16 a[54:55], v47 offset:41984
    v_mfma_f32_16x16x32_bf16 a[92:95], a[12:15], a[140:143], a[92:95]
    ds_read_b64_tr_b16 a[56:57], v48 offset:40960
    v_mfma_f32_16x16x32_bf16 v[224:227], a[16:19], a[128:131], v[224:227]
    v_mfma_f32_16x16x32_bf16 v[228:231], a[16:19], a[132:135], v[228:231]
    buffer_load_dwordx4 a[188:191], v55, s[8:11], s62 offen sc1
    ds_read_b64_tr_b16 a[58:59], v48 offset:41984
    v_mfma_f32_16x16x32_bf16 a[96:99], a[16:19], a[136:139], a[96:99]
    ds_read_b64_tr_b16 a[60:61], v49 offset:40960
    v_mfma_f32_16x16x32_bf16 a[100:103], a[16:19], a[140:143], a[100:103]
    v_mfma_f32_16x16x32_bf16 v[232:235], a[20:23], a[128:131], v[232:235]
    ds_read_b64_tr_b16 a[62:63], v49 offset:41984
    v_mfma_f32_16x16x32_bf16 v[236:239], a[20:23], a[132:135], v[236:239]
    s_add_u32 s62, s62, 0x20000
    v_mfma_f32_16x16x32_bf16 a[104:107], a[20:23], a[136:139], a[104:107]
    s_add_u32 s52, s47, 12288
    v_mfma_f32_16x16x32_bf16 a[108:111], a[20:23], a[140:143], a[108:111]
    buffer_store_dwordx4 v[120:123], v1, s[48:51], s52 offen offset:2048 sc1
    v_mfma_f32_16x16x32_bf16 v[240:243], a[24:27], a[128:131], v[240:243]
    v_mfma_f32_16x16x32_bf16 v[244:247], a[24:27], a[132:135], v[244:247]
    v_mfma_f32_16x16x32_bf16 a[112:115], a[24:27], a[136:139], a[112:115]
    v_mfma_f32_16x16x32_bf16 a[116:119], a[24:27], a[140:143], a[116:119]
    v_mfma_f32_16x16x32_bf16 v[248:251], a[28:31], a[128:131], v[248:251]
    v_mfma_f32_16x16x32_bf16 v[252:255], a[28:31], a[132:135], v[252:255]
    v_mfma_f32_16x16x32_bf16 a[120:123], a[28:31], a[136:139], a[120:123]
    v_mfma_f32_16x16x32_bf16 a[124:127], a[28:31], a[140:143], a[124:127]
    s_waitcnt vmcnt(10) lgkmcnt(0)
    s_barrier
    v_mfma_f32_16x16x32_bf16 v[192:195], a[32:35], a[144:147], v[192:195]
    ds_read_b64_tr_b16 a[0:1], v42 offset:49152
    ds_read_b64_tr_b16 a[2:3], v42 offset:50176
    v_mfma_f32_16x16x32_bf16 v[196:199], a[32:35], a[148:151], v[196:199]
    s_add_u32 m0, s60, 98304
    v_mfma_f32_16x16x32_bf16 a[64:67], a[32:35], a[152:155], a[64:67]
    buffer_load_dwordx4 v38, s[12:15], s61 offen offset:0 lds
    ds_read_b64_tr_b16 a[4:5], v43 offset:49152
    v_mfma_f32_16x16x32_bf16 a[68:71], a[32:35], a[156:159], a[68:71]
    ds_read_b64_tr_b16 a[6:7], v43 offset:50176
    v_mfma_f32_16x16x32_bf16 v[200:203], a[36:39], a[144:147], v[200:203]
    buffer_load_dwordx4 v39, s[12:15], s61 offen offset:1024 lds
    ds_read_b64_tr_b16 a[8:9], v44 offset:49152
    v_mfma_f32_16x16x32_bf16 v[204:207], a[36:39], a[148:151], v[204:207]
    v_mfma_f32_16x16x32_bf16 a[72:75], a[36:39], a[152:155], a[72:75]
    ds_read_b64_tr_b16 a[10:11], v44 offset:50176
    v_mfma_f32_16x16x32_bf16 a[76:79], a[36:39], a[156:159], a[76:79]
    buffer_load_dwordx4 v40, s[12:15], s61 offen offset:2048 lds
    ds_read_b64_tr_b16 a[12:13], v45 offset:49152
    v_mfma_f32_16x16x32_bf16 v[208:211], a[40:43], a[144:147], v[208:211]
    v_mfma_f32_16x16x32_bf16 v[212:215], a[40:43], a[148:151], v[212:215]
    ds_read_b64_tr_b16 a[14:15], v45 offset:50176
    v_mfma_f32_16x16x32_bf16 a[80:83], a[40:43], a[152:155], a[80:83]
    buffer_load_dwordx4 v41, s[12:15], s61 offen offset:3072 lds
    ds_read_b64_tr_b16 a[16:17], v46 offset:49152
    v_mfma_f32_16x16x32_bf16 a[84:87], a[40:43], a[156:159], a[84:87]
    ds_read_b64_tr_b16 a[18:19], v46 offset:50176
    v_mfma_f32_16x16x32_bf16 v[216:219], a[44:47], a[144:147], v[216:219]
    s_add_u32 s61, s61, 0x80000
    v_mfma_f32_16x16x32_bf16 v[220:223], a[44:47], a[148:151], v[220:223]
    buffer_load_dwordx4 a[192:195], v36, s[8:11], s62 offen sc1
    ds_read_b64_tr_b16 a[20:21], v47 offset:49152
    v_mfma_f32_16x16x32_bf16 a[88:91], a[44:47], a[152:155], a[88:91]
    ds_read_b64_tr_b16 a[22:23], v47 offset:50176
    v_mfma_f32_16x16x32_bf16 a[92:95], a[44:47], a[156:159], a[92:95]
    buffer_load_dwordx4 a[196:199], v54, s[8:11], s62 offen sc1
    ds_read_b64_tr_b16 a[24:25], v48 offset:49152
    v_mfma_f32_16x16x32_bf16 v[224:227], a[48:51], a[144:147], v[224:227]
    v_mfma_f32_16x16x32_bf16 v[228:231], a[48:51], a[148:151], v[228:231]
    ds_read_b64_tr_b16 a[26:27], v48 offset:50176
    v_mfma_f32_16x16x32_bf16 a[96:99], a[48:51], a[152:155], a[96:99]
    buffer_load_dwordx4 a[200:203], v37, s[8:11], s62 offen sc1
    ds_read_b64_tr_b16 a[28:29], v49 offset:49152
    v_mfma_f32_16x16x32_bf16 a[100:103], a[48:51], a[156:159], a[100:103]
    v_mfma_f32_16x16x32_bf16 v[232:235], a[52:55], a[144:147], v[232:235]
    ds_read_b64_tr_b16 a[30:31], v49 offset:50176
    v_mfma_f32_16x16x32_bf16 v[236:239], a[52:55], a[148:151], v[236:239]
    buffer_load_dwordx4 a[204:207], v55, s[8:11], s62 offen sc1
    v_mfma_f32_16x16x32_bf16 a[104:107], a[52:55], a[152:155], a[104:107]
    v_mfma_f32_16x16x32_bf16 a[108:111], a[52:55], a[156:159], a[108:111]
    s_add_u32 s62, s62, 0x20000
    v_mfma_f32_16x16x32_bf16 v[240:243], a[56:59], a[144:147], v[240:243]
    s_add_u32 s52, s47, 12288
    v_mfma_f32_16x16x32_bf16 v[244:247], a[56:59], a[148:151], v[244:247]
    buffer_store_dwordx4 v[124:127], v1, s[48:51], s52 offen offset:3072 sc1
    v_mfma_f32_16x16x32_bf16 a[112:115], a[56:59], a[152:155], a[112:115]
    v_mfma_f32_16x16x32_bf16 a[116:119], a[56:59], a[156:159], a[116:119]
    v_mfma_f32_16x16x32_bf16 v[248:251], a[60:63], a[144:147], v[248:251]
    s_cmp_eq_u32 s45, 0
    s_cbranch_scc1 k12_ool_52
k12_oolret_53:
    v_mfma_f32_16x16x32_bf16 v[252:255], a[60:63], a[148:151], v[252:255]
    v_mfma_f32_16x16x32_bf16 a[120:123], a[60:63], a[152:155], a[120:123]
    v_mfma_f32_16x16x32_bf16 a[124:127], a[60:63], a[156:159], a[124:127]
    s_waitcnt vmcnt(15) lgkmcnt(0)
    v_mfma_f32_16x16x32_bf16 v[192:195], a[0:3], a[160:163], v[192:195]
    ds_read_b64_tr_b16 a[32:33], v42 offset:57344
    ds_read_b64_tr_b16 a[34:35], v42 offset:58368
    v_mfma_f32_16x16x32_bf16 v[196:199], a[0:3], a[164:167], v[196:199]
    buffer_load_dwordx4 a[208:211], v36, s[8:11], s62 offen sc1
    v_mfma_f32_16x16x32_bf16 a[64:67], a[0:3], a[168:171], a[64:67]
    ds_read_b64_tr_b16 a[36:37], v43 offset:57344
    v_mfma_f32_16x16x32_bf16 a[68:71], a[0:3], a[172:175], a[68:71]
    ds_read_b64_tr_b16 a[38:39], v43 offset:58368
    v_mfma_f32_16x16x32_bf16 v[200:203], a[4:7], a[160:163], v[200:203]
    ds_read_b64_tr_b16 a[40:41], v44 offset:57344
    v_mfma_f32_16x16x32_bf16 v[204:207], a[4:7], a[164:167], v[204:207]
    v_mfma_f32_16x16x32_bf16 a[72:75], a[4:7], a[168:171], a[72:75]
    buffer_load_dwordx4 a[212:215], v54, s[8:11], s62 offen sc1
    ds_read_b64_tr_b16 a[42:43], v44 offset:58368
    v_mfma_f32_16x16x32_bf16 a[76:79], a[4:7], a[172:175], a[76:79]
    ds_read_b64_tr_b16 a[44:45], v45 offset:57344
    v_mfma_f32_16x16x32_bf16 v[208:211], a[8:11], a[160:163], v[208:211]
    v_mfma_f32_16x16x32_bf16 v[212:215], a[8:11], a[164:167], v[212:215]
    ds_read_b64_tr_b16 a[46:47], v45 offset:58368
    v_mfma_f32_16x16x32_bf16 a[80:83], a[8:11], a[168:171], a[80:83]
    ds_read_b64_tr_b16 a[48:49], v46 offset:57344
    v_mfma_f32_16x16x32_bf16 a[84:87], a[8:11], a[172:175], a[84:87]
    buffer_load_dwordx4 a[216:219], v37, s[8:11], s62 offen sc1
    ds_read_b64_tr_b16 a[50:51], v46 offset:58368
    v_mfma_f32_16x16x32_bf16 v[216:219], a[12:15], a[160:163], v[216:219]
    v_mfma_f32_16x16x32_bf16 v[220:223], a[12:15], a[164:167], v[220:223]
    ds_read_b64_tr_b16 a[52:53], v47 offset:57344
    v_mfma_f32_16x16x32_bf16 a[88:91], a[12:15], a[168:171], a[88:91]
    ds_read_b64_tr_b16 a[54:55], v47 offset:58368
    v_mfma_f32_16x16x32_bf16 a[92:95], a[12:15], a[172:175], a[92:95]
    ds_read_b64_tr_b16 a[56:57], v48 offset:57344
    v_mfma_f32_16x16x32_bf16 v[224:227], a[16:19], a[160:163], v[224:227]
    v_mfma_f32_16x16x32_bf16 v[228:231], a[16:19], a[164:167], v[228:231]
    buffer_load_dwordx4 a[220:223], v55, s[8:11], s62 offen sc1
    ds_read_b64_tr_b16 a[58:59], v48 offset:58368
    v_mfma_f32_16x16x32_bf16 a[96:99], a[16:19], a[168:171], a[96:99]
    ds_read_b64_tr_b16 a[60:61], v49 offset:57344
    v_mfma_f32_16x16x32_bf16 a[100:103], a[16:19], a[172:175], a[100:103]
    v_mfma_f32_16x16x32_bf16 v[232:235], a[20:23], a[160:163], v[232:235]
    ds_read_b64_tr_b16 a[62:63], v49 offset:58368
    v_mfma_f32_16x16x32_bf16 v[236:239], a[20:23], a[164:167], v[236:239]
    s_add_u32 s62, s62, 0x20000
    v_mfma_f32_16x16x32_bf16 a[104:107], a[20:23], a[168:171], a[104:107]
    s_add_u32 s52, s47, 524288
    v_mfma_f32_16x16x32_bf16 a[108:111], a[20:23], a[172:175], a[108:111]
    buffer_store_dwordx4 v[128:131], v1, s[48:51], s52 offen offset:0 sc1
    v_mfma_f32_16x16x32_bf16 v[240:243], a[24:27], a[160:163], v[240:243]
    v_mfma_f32_16x16x32_bf16 v[244:247], a[24:27], a[164:167], v[244:247]
    v_mfma_f32_16x16x32_bf16 a[112:115], a[24:27], a[168:171], a[112:115]
    v_mfma_f32_16x16x32_bf16 a[116:119], a[24:27], a[172:175], a[116:119]
    v_mfma_f32_16x16x32_bf16 v[248:251], a[28:31], a[160:163], v[248:251]
    v_mfma_f32_16x16x32_bf16 v[252:255], a[28:31], a[164:167], v[252:255]
    v_mfma_f32_16x16x32_bf16 a[120:123], a[28:31], a[168:171], a[120:123]
    v_mfma_f32_16x16x32_bf16 a[124:127], a[28:31], a[172:175], a[124:127]
    s_waitcnt vmcnt(10) lgkmcnt(0)
    s_barrier
    v_mfma_f32_16x16x32_bf16 v[192:195], a[32:35], a[176:179], v[192:195]
    ds_read_b64_tr_b16 a[0:1], v42 offset:0
    ds_read_b64_tr_b16 a[2:3], v42 offset:1024
    v_mfma_f32_16x16x32_bf16 v[196:199], a[32:35], a[180:183], v[196:199]
    s_add_u32 m0, s60, 114688
    v_mfma_f32_16x16x32_bf16 a[64:67], a[32:35], a[184:187], a[64:67]
    buffer_load_dwordx4 v38, s[12:15], s61 offen offset:0 lds
    ds_read_b64_tr_b16 a[4:5], v43 offset:0
    v_mfma_f32_16x16x32_bf16 a[68:71], a[32:35], a[188:191], a[68:71]
    ds_read_b64_tr_b16 a[6:7], v43 offset:1024
    v_mfma_f32_16x16x32_bf16 v[200:203], a[36:39], a[176:179], v[200:203]
    buffer_load_dwordx4 v39, s[12:15], s61 offen offset:1024 lds
    ds_read_b64_tr_b16 a[8:9], v44 offset:0
    v_mfma_f32_16x16x32_bf16 v[204:207], a[36:39], a[180:183], v[204:207]
    v_mfma_f32_16x16x32_bf16 a[72:75], a[36:39], a[184:187], a[72:75]
    ds_read_b64_tr_b16 a[10:11], v44 offset:1024
    v_mfma_f32_16x16x32_bf16 a[76:79], a[36:39], a[188:191], a[76:79]
    buffer_load_dwordx4 v40, s[12:15], s61 offen offset:2048 lds
    ds_read_b64_tr_b16 a[12:13], v45 offset:0
    v_mfma_f32_16x16x32_bf16 v[208:211], a[40:43], a[176:179], v[208:211]
    v_mfma_f32_16x16x32_bf16 v[212:215], a[40:43], a[180:183], v[212:215]
    ds_read_b64_tr_b16 a[14:15], v45 offset:1024
    v_mfma_f32_16x16x32_bf16 a[80:83], a[40:43], a[184:187], a[80:83]
    buffer_load_dwordx4 v41, s[12:15], s61 offen offset:3072 lds
    ds_read_b64_tr_b16 a[16:17], v46 offset:0
    v_mfma_f32_16x16x32_bf16 a[84:87], a[40:43], a[188:191], a[84:87]
    ds_read_b64_tr_b16 a[18:19], v46 offset:1024
    v_mfma_f32_16x16x32_bf16 v[216:219], a[44:47], a[176:179], v[216:219]
    s_add_u32 s61, s61, 0x80000
    v_mfma_f32_16x16x32_bf16 v[220:223], a[44:47], a[180:183], v[220:223]
    buffer_load_dwordx4 a[224:227], v36, s[8:11], s62 offen sc1
    ds_read_b64_tr_b16 a[20:21], v47 offset:0
    v_mfma_f32_16x16x32_bf16 a[88:91], a[44:47], a[184:187], a[88:91]
    ds_read_b64_tr_b16 a[22:23], v47 offset:1024
    v_mfma_f32_16x16x32_bf16 a[92:95], a[44:47], a[188:191], a[92:95]
    buffer_load_dwordx4 a[228:231], v54, s[8:11], s62 offen sc1
    ds_read_b64_tr_b16 a[24:25], v48 offset:0
    v_mfma_f32_16x16x32_bf16 v[224:227], a[48:51], a[176:179], v[224:227]
    v_mfma_f32_16x16x32_bf16 v[228:231], a[48:51], a[180:183], v[228:231]
    ds_read_b64_tr_b16 a[26:27], v48 offset:1024
    v_mfma_f32_16x16x32_bf16 a[96:99], a[48:51], a[184:187], a[96:99]
    buffer_load_dwordx4 a[232:235], v37, s[8:11], s62 offen sc1
    ds_read_b64_tr_b16 a[28:29], v49 offset:0
    v_mfma_f32_16x16x32_bf16 a[100:103], a[48:51], a[188:191], a[100:103]
    v_mfma_f32_16x16x32_bf16 v[232:235], a[52:55], a[176:179], v[232:235]
    ds_read_b64_tr_b16 a[30:31], v49 offset:1024
    v_mfma_f32_16x16x32_bf16 v[236:239], a[52:55], a[180:183], v[236:239]
    buffer_load_dwordx4 a[236:239], v55, s[8:11], s62 offen sc1
    v_mfma_f32_16x16x32_bf16 a[104:107], a[52:55], a[184:187], a[104:107]
    v_mfma_f32_16x16x32_bf16 a[108:111], a[52:55], a[188:191], a[108:111]
    s_add_u32 s62, s62, 0x20000
    v_mfma_f32_16x16x32_bf16 v[240:243], a[56:59], a[176:179], v[240:243]
    s_add_u32 s52, s47, 524288
    v_mfma_f32_16x16x32_bf16 v[244:247], a[56:59], a[180:183], v[244:247]
    buffer_store_dwordx4 v[132:135], v1, s[48:51], s52 offen offset:1024 sc1
    v_mfma_f32_16x16x32_bf16 a[112:115], a[56:59], a[184:187], a[112:115]
    v_mfma_f32_16x16x32_bf16 a[116:119], a[56:59], a[188:191], a[116:119]
    v_mfma_f32_16x16x32_bf16 v[248:251], a[60:63], a[176:179], v[248:251]
    s_cmp_eq_u32 s45, 0
    s_cbranch_scc1 k12_ool_54
k12_oolret_55:
    v_mfma_f32_16x16x32_bf16 v[252:255], a[60:63], a[180:183], v[252:255]
    v_mfma_f32_16x16x32_bf16 a[120:123], a[60:63], a[184:187], a[120:123]
    v_mfma_f32_16x16x32_bf16 a[124:127], a[60:63], a[188:191], a[124:127]
    s_waitcnt vmcnt(15) lgkmcnt(0)
    v_mfma_f32_16x16x32_bf16 v[192:195], a[0:3], a[192:195], v[192:195]
    ds_read_b64_tr_b16 a[32:33], v42 offset:8192
    ds_read_b64_tr_b16 a[34:35], v42 offset:9216
    v_mfma_f32_16x16x32_bf16 v[196:199], a[0:3], a[196:199], v[196:199]
    buffer_load_dwordx4 a[240:243], v36, s[8:11], s62 offen sc1
    v_mfma_f32_16x16x32_bf16 a[64:67], a[0:3], a[200:203], a[64:67]
    ds_read_b64_tr_b16 a[36:37], v43 offset:8192
    v_mfma_f32_16x16x32_bf16 a[68:71], a[0:3], a[204:207], a[68:71]
    ds_read_b64_tr_b16 a[38:39], v43 offset:9216
    v_mfma_f32_16x16x32_bf16 v[200:203], a[4:7], a[192:195], v[200:203]
    ds_read_b64_tr_b16 a[40:41], v44 offset:8192
    v_mfma_f32_16x16x32_bf16 v[204:207], a[4:7], a[196:199], v[204:207]
    v_mfma_f32_16x16x32_bf16 a[72:75], a[4:7], a[200:203], a[72:75]
    buffer_load_dwordx4 a[244:247], v54, s[8:11], s62 offen sc1
    ds_read_b64_tr_b16 a[42:43], v44 offset:9216
    v_mfma_f32_16x16x32_bf16 a[76:79], a[4:7], a[204:207], a[76:79]
    ds_read_b64_tr_b16 a[44:45], v45 offset:8192
    v_mfma_f32_16x16x32_bf16 v[208:211], a[8:11], a[192:195], v[208:211]
    v_mfma_f32_16x16x32_bf16 v[212:215], a[8:11], a[196:199], v[212:215]
    ds_read_b64_tr_b16 a[46:47], v45 offset:9216
    v_mfma_f32_16x16x32_bf16 a[80:83], a[8:11], a[200:203], a[80:83]
    ds_read_b64_tr_b16 a[48:49], v46 offset:8192
    v_mfma_f32_16x16x32_bf16 a[84:87], a[8:11], a[204:207], a[84:87]
    buffer_load_dwordx4 a[248:251], v37, s[8:11], s62 offen sc1
    ds_read_b64_tr_b16 a[50:51], v46 offset:9216
    v_mfma_f32_16x16x32_bf16 v[216:219], a[12:15], a[192:195], v[216:219]
    v_mfma_f32_16x16x32_bf16 v[220:223], a[12:15], a[196:199], v[220:223]
    ds_read_b64_tr_b16 a[52:53], v47 offset:8192
    v_mfma_f32_16x16x32_bf16 a[88:91], a[12:15], a[200:203], a[88:91]
    ds_read_b64_tr_b16 a[54:55], v47 offset:9216
    v_mfma_f32_16x16x32_bf16 a[92:95], a[12:15], a[204:207], a[92:95]
    ds_read_b64_tr_b16 a[56:57], v48 offset:8192
    v_mfma_f32_16x16x32_bf16 v[224:227], a[16:19], a[192:195], v[224:227]
    v_mfma_f32_16x16x32_bf16 v[228:231], a[16:19], a[196:199], v[228:231]
    buffer_load_dwordx4 a[252:255], v55, s[8:11], s62 offen sc1
    ds_read_b64_tr_b16 a[58:59], v48 offset:9216
    v_mfma_f32_16x16x32_bf16 a[96:99], a[16:19], a[200:203], a[96:99]
    ds_read_b64_tr_b16 a[60:61], v49 offset:8192
    v_mfma_f32_16x16x32_bf16 a[100:103], a[16:19], a[204:207], a[100:103]
    v_mfma_f32_16x16x32_bf16 v[232:235], a[20:23], a[192:195], v[232:235]
    ds_read_b64_tr_b16 a[62:63], v49 offset:9216
    v_mfma_f32_16x16x32_bf16 v[236:239], a[20:23], a[196:199], v[236:239]
    s_add_u32 s62, s62, 0x20000
    v_mfma_f32_16x16x32_bf16 a[104:107], a[20:23], a[200:203], a[104:107]
    s_add_u32 s52, s47, 524288
    v_mfma_f32_16x16x32_bf16 a[108:111], a[20:23], a[204:207], a[108:111]
    buffer_store_dwordx4 v[136:139], v1, s[48:51], s52 offen offset:2048 sc1
    v_mfma_f32_16x16x32_bf16 v[240:243], a[24:27], a[192:195], v[240:243]
    v_mfma_f32_16x16x32_bf16 v[244:247], a[24:27], a[196:199], v[244:247]
    v_mfma_f32_16x16x32_bf16 a[112:115], a[24:27], a[200:203], a[112:115]
    v_mfma_f32_16x16x32_bf16 a[116:119], a[24:27], a[204:207], a[116:119]
    v_mfma_f32_16x16x32_bf16 v[248:251], a[28:31], a[192:195], v[248:251]
    v_mfma_f32_16x16x32_bf16 v[252:255], a[28:31], a[196:199], v[252:255]
    v_mfma_f32_16x16x32_bf16 a[120:123], a[28:31], a[200:203], a[120:123]
    v_mfma_f32_16x16x32_bf16 a[124:127], a[28:31], a[204:207], a[124:127]
    s_waitcnt vmcnt(10) lgkmcnt(0)
    s_barrier
    v_mfma_f32_16x16x32_bf16 v[192:195], a[32:35], a[208:211], v[192:195]
    ds_read_b64_tr_b16 a[0:1], v42 offset:16384
    ds_read_b64_tr_b16 a[2:3], v42 offset:17408
    v_mfma_f32_16x16x32_bf16 v[196:199], a[32:35], a[212:215], v[196:199]
    s_add_u32 m0, s60, 131072
    v_mfma_f32_16x16x32_bf16 a[64:67], a[32:35], a[216:219], a[64:67]
    buffer_load_dwordx4 v38, s[12:15], s61 offen offset:0 lds
    ds_read_b64_tr_b16 a[4:5], v43 offset:16384
    v_mfma_f32_16x16x32_bf16 a[68:71], a[32:35], a[220:223], a[68:71]
    ds_read_b64_tr_b16 a[6:7], v43 offset:17408
    v_mfma_f32_16x16x32_bf16 v[200:203], a[36:39], a[208:211], v[200:203]
    buffer_load_dwordx4 v39, s[12:15], s61 offen offset:1024 lds
    ds_read_b64_tr_b16 a[8:9], v44 offset:16384
    v_mfma_f32_16x16x32_bf16 v[204:207], a[36:39], a[212:215], v[204:207]
    v_mfma_f32_16x16x32_bf16 a[72:75], a[36:39], a[216:219], a[72:75]
    ds_read_b64_tr_b16 a[10:11], v44 offset:17408
    v_mfma_f32_16x16x32_bf16 a[76:79], a[36:39], a[220:223], a[76:79]
    buffer_load_dwordx4 v40, s[12:15], s61 offen offset:2048 lds
    ds_read_b64_tr_b16 a[12:13], v45 offset:16384
    v_mfma_f32_16x16x32_bf16 v[208:211], a[40:43], a[208:211], v[208:211]
    v_mfma_f32_16x16x32_bf16 v[212:215], a[40:43], a[212:215], v[212:215]
    ds_read_b64_tr_b16 a[14:15], v45 offset:17408
    v_mfma_f32_16x16x32_bf16 a[80:83], a[40:43], a[216:219], a[80:83]
    buffer_load_dwordx4 v41, s[12:15], s61 offen offset:3072 lds
    ds_read_b64_tr_b16 a[16:17], v46 offset:16384
    v_mfma_f32_16x16x32_bf16 a[84:87], a[40:43], a[220:223], a[84:87]
    ds_read_b64_tr_b16 a[18:19], v46 offset:17408
    v_mfma_f32_16x16x32_bf16 v[216:219], a[44:47], a[208:211], v[216:219]
    s_add_u32 s61, s61, 0x80000
    v_mfma_f32_16x16x32_bf16 v[220:223], a[44:47], a[212:215], v[220:223]
    buffer_load_dwordx4 a[128:131], v36, s[8:11], s62 offen sc1
    ds_read_b64_tr_b16 a[20:21], v47 offset:16384
    v_mfma_f32_16x16x32_bf16 a[88:91], a[44:47], a[216:219], a[88:91]
    ds_read_b64_tr_b16 a[22:23], v47 offset:17408
    v_mfma_f32_16x16x32_bf16 a[92:95], a[44:47], a[220:223], a[92:95]
    buffer_load_dwordx4 a[132:135], v54, s[8:11], s62 offen sc1
    ds_read_b64_tr_b16 a[24:25], v48 offset:16384
    v_mfma_f32_16x16x32_bf16 v[224:227], a[48:51], a[208:211], v[224:227]
    v_mfma_f32_16x16x32_bf16 v[228:231], a[48:51], a[212:215], v[228:231]
    ds_read_b64_tr_b16 a[26:27], v48 offset:17408
    v_mfma_f32_16x16x32_bf16 a[96:99], a[48:51], a[216:219], a[96:99]
    buffer_load_dwordx4 a[136:139], v37, s[8:11], s62 offen sc1
    ds_read_b64_tr_b16 a[28:29], v49 offset:16384
    v_mfma_f32_16x16x32_bf16 a[100:103], a[48:51], a[220:223], a[100:103]
    v_mfma_f32_16x16x32_bf16 v[232:235], a[52:55], a[208:211], v[232:235]
    ds_read_b64_tr_b16 a[30:31], v49 offset:17408
    v_mfma_f32_16x16x32_bf16 v[236:239], a[52:55], a[212:215], v[236:239]
    buffer_load_dwordx4 a[140:143], v55, s[8:11], s62 offen sc1
    v_mfma_f32_16x16x32_bf16 a[104:107], a[52:55], a[216:219], a[104:107]
    v_mfma_f32_16x16x32_bf16 a[108:111], a[52:55], a[220:223], a[108:111]
    s_add_u32 s62, s62, 0x20000
    v_mfma_f32_16x16x32_bf16 v[240:243], a[56:59], a[208:211], v[240:243]
    s_add_u32 s52, s47, 524288
    v_mfma_f32_16x16x32_bf16 v[244:247], a[56:59], a[212:215], v[244:247]
    buffer_store_dwordx4 v[140:143], v1, s[48:51], s52 offen offset:3072 sc1
    v_mfma_f32_16x16x32_bf16 a[112:115], a[56:59], a[216:219], a[112:115]
    v_mfma_f32_16x16x32_bf16 a[116:119], a[56:59], a[220:223], a[116:119]
    v_mfma_f32_16x16x32_bf16 v[248:251], a[60:63], a[208:211], v[248:251]
    s_cmp_eq_u32 s45, 0
    s_cbranch_scc1 k12_ool_56
k12_oolret_57:
    v_mfma_f32_16x16x32_bf16 v[252:255], a[60:63], a[212:215], v[252:255]
    v_mfma_f32_16x16x32_bf16 a[120:123], a[60:63], a[216:219], a[120:123]
    v_mfma_f32_16x16x32_bf16 a[124:127], a[60:63], a[220:223], a[124:127]
    s_waitcnt vmcnt(15) lgkmcnt(0)
    v_mfma_f32_16x16x32_bf16 v[192:195], a[0:3], a[224:227], v[192:195]
    ds_read_b64_tr_b16 a[32:33], v42 offset:24576
    ds_read_b64_tr_b16 a[34:35], v42 offset:25600
    v_mfma_f32_16x16x32_bf16 v[196:199], a[0:3], a[228:231], v[196:199]
    buffer_load_dwordx4 a[144:147], v36, s[8:11], s62 offen sc1
    v_mfma_f32_16x16x32_bf16 a[64:67], a[0:3], a[232:235], a[64:67]
    ds_read_b64_tr_b16 a[36:37], v43 offset:24576
    v_mfma_f32_16x16x32_bf16 a[68:71], a[0:3], a[236:239], a[68:71]
    ds_read_b64_tr_b16 a[38:39], v43 offset:25600
    v_mfma_f32_16x16x32_bf16 v[200:203], a[4:7], a[224:227], v[200:203]
    ds_read_b64_tr_b16 a[40:41], v44 offset:24576
    v_mfma_f32_16x16x32_bf16 v[204:207], a[4:7], a[228:231], v[204:207]
    v_mfma_f32_16x16x32_bf16 a[72:75], a[4:7], a[232:235], a[72:75]
    buffer_load_dwordx4 a[148:151], v54, s[8:11], s62 offen sc1
    ds_read_b64_tr_b16 a[42:43], v44 offset:25600
    v_mfma_f32_16x16x32_bf16 a[76:79], a[4:7], a[236:239], a[76:79]
    ds_read_b64_tr_b16 a[44:45], v45 offset:24576
    v_mfma_f32_16x16x32_bf16 v[208:211], a[8:11], a[224:227], v[208:211]
    v_mfma_f32_16x16x32_bf16 v[212:215], a[8:11], a[228:231], v[212:215]
    ds_read_b64_tr_b16 a[46:47], v45 offset:25600
    v_mfma_f32_16x16x32_bf16 a[80:83], a[8:11], a[232:235], a[80:83]
    ds_read_b64_tr_b16 a[48:49], v46 offset:24576
    v_mfma_f32_16x16x32_bf16 a[84:87], a[8:11], a[236:239], a[84:87]
    buffer_load_dwordx4 a[152:155], v37, s[8:11], s62 offen sc1
    ds_read_b64_tr_b16 a[50:51], v46 offset:25600
    v_mfma_f32_16x16x32_bf16 v[216:219], a[12:15], a[224:227], v[216:219]
    v_mfma_f32_16x16x32_bf16 v[220:223], a[12:15], a[228:231], v[220:223]
    ds_read_b64_tr_b16 a[52:53], v47 offset:24576
    v_mfma_f32_16x16x32_bf16 a[88:91], a[12:15], a[232:235], a[88:91]
    ds_read_b64_tr_b16 a[54:55], v47 offset:25600
    v_mfma_f32_16x16x32_bf16 a[92:95], a[12:15], a[236:239], a[92:95]
    ds_read_b64_tr_b16 a[56:57], v48 offset:24576
    v_mfma_f32_16x16x32_bf16 v[224:227], a[16:19], a[224:227], v[224:227]
    v_mfma_f32_16x16x32_bf16 v[228:231], a[16:19], a[228:231], v[228:231]
    buffer_load_dwordx4 a[156:159], v55, s[8:11], s62 offen sc1
    ds_read_b64_tr_b16 a[58:59], v48 offset:25600
    v_mfma_f32_16x16x32_bf16 a[96:99], a[16:19], a[232:235], a[96:99]
    ds_read_b64_tr_b16 a[60:61], v49 offset:24576
    v_mfma_f32_16x16x32_bf16 a[100:103], a[16:19], a[236:239], a[100:103]
    v_mfma_f32_16x16x32_bf16 v[232:235], a[20:23], a[224:227], v[232:235]
    ds_read_b64_tr_b16 a[62:63], v49 offset:25600
    v_mfma_f32_16x16x32_bf16 v[236:239], a[20:23], a[228:231], v[236:239]
    s_add_u32 s62, s62, 0x20000
    v_mfma_f32_16x16x32_bf16 a[104:107], a[20:23], a[232:235], a[104:107]
    s_add_u32 s52, s47, 528384
    v_mfma_f32_16x16x32_bf16 a[108:111], a[20:23], a[236:239], a[108:111]
    buffer_store_dwordx4 v[144:147], v1, s[48:51], s52 offen offset:0 sc1
    v_mfma_f32_16x16x32_bf16 v[240:243], a[24:27], a[224:227], v[240:243]
    v_mfma_f32_16x16x32_bf16 v[244:247], a[24:27], a[228:231], v[244:247]
    v_mfma_f32_16x16x32_bf16 a[112:115], a[24:27], a[232:235], a[112:115]
    v_mfma_f32_16x16x32_bf16 a[116:119], a[24:27], a[236:239], a[116:119]
    v_mfma_f32_16x16x32_bf16 v[248:251], a[28:31], a[224:227], v[248:251]
    v_mfma_f32_16x16x32_bf16 v[252:255], a[28:31], a[228:231], v[252:255]
    v_mfma_f32_16x16x32_bf16 a[120:123], a[28:31], a[232:235], a[120:123]
    v_mfma_f32_16x16x32_bf16 a[124:127], a[28:31], a[236:239], a[124:127]
    s_waitcnt vmcnt(10) lgkmcnt(0)
    s_barrier
    v_mfma_f32_16x16x32_bf16 v[192:195], a[32:35], a[240:243], v[192:195]
    ds_read_b64_tr_b16 a[0:1], v42 offset:32768
    ds_read_b64_tr_b16 a[2:3], v42 offset:33792
    v_mfma_f32_16x16x32_bf16 v[196:199], a[32:35], a[244:247], v[196:199]
    s_add_u32 m0, s60, 147456
    v_mfma_f32_16x16x32_bf16 a[64:67], a[32:35], a[248:251], a[64:67]
    buffer_load_dwordx4 v38, s[12:15], s61 offen offset:0 lds
    ds_read_b64_tr_b16 a[4:5], v43 offset:32768
    v_mfma_f32_16x16x32_bf16 a[68:71], a[32:35], a[252:255], a[68:71]
    ds_read_b64_tr_b16 a[6:7], v43 offset:33792
    v_mfma_f32_16x16x32_bf16 v[200:203], a[36:39], a[240:243], v[200:203]
    buffer_load_dwordx4 v39, s[12:15], s61 offen offset:1024 lds
    ds_read_b64_tr_b16 a[8:9], v44 offset:32768
    v_mfma_f32_16x16x32_bf16 v[204:207], a[36:39], a[244:247], v[204:207]
    v_mfma_f32_16x16x32_bf16 a[72:75], a[36:39], a[248:251], a[72:75]
    buffer_load_dwordx4 v40, s[12:15], s61 offen offset:2048 lds
    ds_read_b64_tr_b16 a[10:11], v44 offset:33792
    v_mfma_f32_16x16x32_bf16 a[76:79], a[36:39], a[252:255], a[76:79]
    ds_read_b64_tr_b16 a[12:13], v45 offset:32768
    v_mfma_f32_16x16x32_bf16 v[208:211], a[40:43], a[240:243], v[208:211]
    v_mfma_f32_16x16x32_bf16 v[212:215], a[40:43], a[244:247], v[212:215]
    buffer_load_dwordx4 v41, s[12:15], s61 offen offset:3072 lds
    ds_read_b64_tr_b16 a[14:15], v45 offset:33792
    v_mfma_f32_16x16x32_bf16 a[80:83], a[40:43], a[248:251], a[80:83]
    s_add_u32 s61, s61, 0x80000
    ds_read_b64_tr_b16 a[16:17], v46 offset:32768
    v_mfma_f32_16x16x32_bf16 a[84:87], a[40:43], a[252:255], a[84:87]
    buffer_load_dwordx4 a[160:163], v36, s[8:11], s62 offen sc1
    ds_read_b64_tr_b16 a[18:19], v46 offset:33792
    v_mfma_f32_16x16x32_bf16 v[216:219], a[44:47], a[240:243], v[216:219]
    v_mfma_f32_16x16x32_bf16 v[220:223], a[44:47], a[244:247], v[220:223]
    ds_read_b64_tr_b16 a[20:21], v47 offset:32768
    v_mfma_f32_16x16x32_bf16 a[88:91], a[44:47], a[248:251], a[88:91]
    buffer_load_dwordx4 a[164:167], v54, s[8:11], s62 offen sc1
    ds_read_b64_tr_b16 a[22:23], v47 offset:33792
    v_mfma_f32_16x16x32_bf16 a[92:95], a[44:47], a[252:255], a[92:95]
    ds_read_b64_tr_b16 a[24:25], v48 offset:32768
    v_mfma_f32_16x16x32_bf16 v[224:227], a[48:51], a[240:243], v[224:227]
    v_mfma_f32_16x16x32_bf16 v[228:231], a[48:51], a[244:247], v[228:231]
    buffer_load_dwordx4 a[168:171], v37, s[8:11], s62 offen sc1
    ds_read_b64_tr_b16 a[26:27], v48 offset:33792
    v_mfma_f32_16x16x32_bf16 a[96:99], a[48:51], a[248:251], a[96:99]
    ds_read_b64_tr_b16 a[28:29], v49 offset:32768
    v_mfma_f32_16x16x32_bf16 a[100:103], a[48:51], a[252:255], a[100:103]
    buffer_load_dwordx4 a[172:175], v55, s[8:11], s62 offen sc1
    v_mfma_f32_16x16x32_bf16 v[232:235], a[52:55], a[240:243], v[232:235]
    ds_read_b64_tr_b16 a[30:31], v49 offset:33792
    v_mfma_f32_16x16x32_bf16 v[236:239], a[52:55], a[244:247], v[236:239]
    s_add_u32 s62, s62, 0x20000
    v_mfma_f32_16x16x32_bf16 a[104:107], a[52:55], a[248:251], a[104:107]
    s_add_u32 s52, s47, 528384
    v_mfma_f32_16x16x32_bf16 a[108:111], a[52:55], a[252:255], a[108:111]
    buffer_store_dwordx4 v[148:151], v1, s[48:51], s52 offen offset:1024 sc1
    v_mfma_f32_16x16x32_bf16 v[240:243], a[56:59], a[240:243], v[240:243]
    s_add_u32 s52, s47, 528384
    v_mfma_f32_16x16x32_bf16 v[244:247], a[56:59], a[244:247], v[244:247]
    buffer_store_dwordx4 v[152:155], v1, s[48:51], s52 offen offset:2048 sc1
    v_mfma_f32_16x16x32_bf16 a[112:115], a[56:59], a[248:251], a[112:115]
    v_mfma_f32_16x16x32_bf16 a[116:119], a[56:59], a[252:255], a[116:119]
    v_mfma_f32_16x16x32_bf16 v[248:251], a[60:63], a[240:243], v[248:251]
    s_cmp_eq_u32 s45, 0
    s_cbranch_scc1 k12_ool_58
k12_oolret_59:
    v_mfma_f32_16x16x32_bf16 v[252:255], a[60:63], a[244:247], v[252:255]
    v_mfma_f32_16x16x32_bf16 a[120:123], a[60:63], a[248:251], a[120:123]
    v_mfma_f32_16x16x32_bf16 a[124:127], a[60:63], a[252:255], a[124:127]
    s_waitcnt vmcnt(16) lgkmcnt(0)
    v_mfma_f32_16x16x32_bf16 v[192:195], a[0:3], a[128:131], v[192:195]
    ds_read_b64_tr_b16 a[32:33], v42 offset:40960
    ds_read_b64_tr_b16 a[34:35], v42 offset:41984
    v_mfma_f32_16x16x32_bf16 v[196:199], a[0:3], a[132:135], v[196:199]
    buffer_load_dwordx4 a[176:179], v36, s[8:11], s62 offen sc1
    v_mfma_f32_16x16x32_bf16 a[64:67], a[0:3], a[136:139], a[64:67]
    ds_read_b64_tr_b16 a[36:37], v43 offset:40960
    v_mfma_f32_16x16x32_bf16 a[68:71], a[0:3], a[140:143], a[68:71]
    ds_read_b64_tr_b16 a[38:39], v43 offset:41984
    v_mfma_f32_16x16x32_bf16 v[200:203], a[4:7], a[128:131], v[200:203]
    ds_read_b64_tr_b16 a[40:41], v44 offset:40960
    v_mfma_f32_16x16x32_bf16 v[204:207], a[4:7], a[132:135], v[204:207]
    v_mfma_f32_16x16x32_bf16 a[72:75], a[4:7], a[136:139], a[72:75]
    buffer_load_dwordx4 a[180:183], v54, s[8:11], s62 offen sc1
    ds_read_b64_tr_b16 a[42:43], v44 offset:41984
    v_mfma_f32_16x16x32_bf16 a[76:79], a[4:7], a[140:143], a[76:79]
    ds_read_b64_tr_b16 a[44:45], v45 offset:40960
    v_mfma_f32_16x16x32_bf16 v[208:211], a[8:11], a[128:131], v[208:211]
    v_mfma_f32_16x16x32_bf16 v[212:215], a[8:11], a[132:135], v[212:215]
    ds_read_b64_tr_b16 a[46:47], v45 offset:41984
    v_mfma_f32_16x16x32_bf16 a[80:83], a[8:11], a[136:139], a[80:83]
    ds_read_b64_tr_b16 a[48:49], v46 offset:40960
    v_mfma_f32_16x16x32_bf16 a[84:87], a[8:11], a[140:143], a[84:87]
    buffer_load_dwordx4 a[184:187], v37, s[8:11], s62 offen sc1
    ds_read_b64_tr_b16 a[50:51], v46 offset:41984
    v_mfma_f32_16x16x32_bf16 v[216:219], a[12:15], a[128:131], v[216:219]
    v_mfma_f32_16x16x32_bf16 v[220:223], a[12:15], a[132:135], v[220:223]
    ds_read_b64_tr_b16 a[52:53], v47 offset:40960
    v_mfma_f32_16x16x32_bf16 a[88:91], a[12:15], a[136:139], a[88:91]
    ds_read_b64_tr_b16 a[54:55], v47 offset:41984
    v_mfma_f32_16x16x32_bf16 a[92:95], a[12:15], a[140:143], a[92:95]
    ds_read_b64_tr_b16 a[56:57], v48 offset:40960
    v_mfma_f32_16x16x32_bf16 v[224:227], a[16:19], a[128:131], v[224:227]
    v_mfma_f32_16x16x32_bf16 v[228:231], a[16:19], a[132:135], v[228:231]
    buffer_load_dwordx4 a[188:191], v55, s[8:11], s62 offen sc1
    ds_read_b64_tr_b16 a[58:59], v48 offset:41984
    v_mfma_f32_16x16x32_bf16 a[96:99], a[16:19], a[136:139], a[96:99]
    ds_read_b64_tr_b16 a[60:61], v49 offset:40960
    v_mfma_f32_16x16x32_bf16 a[100:103], a[16:19], a[140:143], a[100:103]
    v_mfma_f32_16x16x32_bf16 v[232:235], a[20:23], a[128:131], v[232:235]
    ds_read_b64_tr_b16 a[62:63], v49 offset:41984
    v_mfma_f32_16x16x32_bf16 v[236:239], a[20:23], a[132:135], v[236:239]
    s_add_u32 s62, s62, 0x20000
    v_mfma_f32_16x16x32_bf16 a[104:107], a[20:23], a[136:139], a[104:107]
    s_add_u32 s52, s47, 528384
    v_mfma_f32_16x16x32_bf16 a[108:111], a[20:23], a[140:143], a[108:111]
    buffer_store_dwordx4 v[156:159], v1, s[48:51], s52 offen offset:3072 sc1
    v_mfma_f32_16x16x32_bf16 v[240:243], a[24:27], a[128:131], v[240:243]
    v_mfma_f32_16x16x32_bf16 v[244:247], a[24:27], a[132:135], v[244:247]
    v_mfma_f32_16x16x32_bf16 a[112:115], a[24:27], a[136:139], a[112:115]
    v_mfma_f32_16x16x32_bf16 a[116:119], a[24:27], a[140:143], a[116:119]
    v_mfma_f32_16x16x32_bf16 v[248:251], a[28:31], a[128:131], v[248:251]
    v_mfma_f32_16x16x32_bf16 v[252:255], a[28:31], a[132:135], v[252:255]
    v_mfma_f32_16x16x32_bf16 a[120:123], a[28:31], a[136:139], a[120:123]
    v_mfma_f32_16x16x32_bf16 a[124:127], a[28:31], a[140:143], a[124:127]
    s_waitcnt vmcnt(11) lgkmcnt(0)
    s_barrier
    v_mfma_f32_16x16x32_bf16 v[192:195], a[32:35], a[144:147], v[192:195]
    ds_read_b64_tr_b16 a[0:1], v42 offset:49152
    ds_read_b64_tr_b16 a[2:3], v42 offset:50176
    v_mfma_f32_16x16x32_bf16 v[196:199], a[32:35], a[148:151], v[196:199]
    s_add_u32 m0, s60, 98304
    v_mfma_f32_16x16x32_bf16 a[64:67], a[32:35], a[152:155], a[64:67]
    buffer_load_dwordx4 v38, s[12:15], s61 offen offset:0 lds
    ds_read_b64_tr_b16 a[4:5], v43 offset:49152
    v_mfma_f32_16x16x32_bf16 a[68:71], a[32:35], a[156:159], a[68:71]
    ds_read_b64_tr_b16 a[6:7], v43 offset:50176
    v_mfma_f32_16x16x32_bf16 v[200:203], a[36:39], a[144:147], v[200:203]
    buffer_load_dwordx4 v39, s[12:15], s61 offen offset:1024 lds
    ds_read_b64_tr_b16 a[8:9], v44 offset:49152
    v_mfma_f32_16x16x32_bf16 v[204:207], a[36:39], a[148:151], v[204:207]
    v_mfma_f32_16x16x32_bf16 a[72:75], a[36:39], a[152:155], a[72:75]
    ds_read_b64_tr_b16 a[10:11], v44 offset:50176
    v_mfma_f32_16x16x32_bf16 a[76:79], a[36:39], a[156:159], a[76:79]
    buffer_load_dwordx4 v40, s[12:15], s61 offen offset:2048 lds
    ds_read_b64_tr_b16 a[12:13], v45 offset:49152
    v_mfma_f32_16x16x32_bf16 v[208:211], a[40:43], a[144:147], v[208:211]
    v_mfma_f32_16x16x32_bf16 v[212:215], a[40:43], a[148:151], v[212:215]
    ds_read_b64_tr_b16 a[14:15], v45 offset:50176
    v_mfma_f32_16x16x32_bf16 a[80:83], a[40:43], a[152:155], a[80:83]
    buffer_load_dwordx4 v41, s[12:15], s61 offen offset:3072 lds
    ds_read_b64_tr_b16 a[16:17], v46 offset:49152
    v_mfma_f32_16x16x32_bf16 a[84:87], a[40:43], a[156:159], a[84:87]
    ds_read_b64_tr_b16 a[18:19], v46 offset:50176
    v_mfma_f32_16x16x32_bf16 v[216:219], a[44:47], a[144:147], v[216:219]
    s_add_u32 s61, s61, 0x80000
    v_mfma_f32_16x16x32_bf16 v[220:223], a[44:47], a[148:151], v[220:223]
    buffer_load_dwordx4 a[192:195], v36, s[8:11], s62 offen sc1
    ds_read_b64_tr_b16 a[20:21], v47 offset:49152
    v_mfma_f32_16x16x32_bf16 a[88:91], a[44:47], a[152:155], a[88:91]
    ds_read_b64_tr_b16 a[22:23], v47 offset:50176
    v_mfma_f32_16x16x32_bf16 a[92:95], a[44:47], a[156:159], a[92:95]
    buffer_load_dwordx4 a[196:199], v54, s[8:11], s62 offen sc1
    ds_read_b64_tr_b16 a[24:25], v48 offset:49152
    v_mfma_f32_16x16x32_bf16 v[224:227], a[48:51], a[144:147], v[224:227]
    v_mfma_f32_16x16x32_bf16 v[228:231], a[48:51], a[148:151], v[228:231]
    ds_read_b64_tr_b16 a[26:27], v48 offset:50176
    v_mfma_f32_16x16x32_bf16 a[96:99], a[48:51], a[152:155], a[96:99]
    buffer_load_dwordx4 a[200:203], v37, s[8:11], s62 offen sc1
    ds_read_b64_tr_b16 a[28:29], v49 offset:49152
    v_mfma_f32_16x16x32_bf16 a[100:103], a[48:51], a[156:159], a[100:103]
    v_mfma_f32_16x16x32_bf16 v[232:235], a[52:55], a[144:147], v[232:235]
    ds_read_b64_tr_b16 a[30:31], v49 offset:50176
    v_mfma_f32_16x16x32_bf16 v[236:239], a[52:55], a[148:151], v[236:239]
    buffer_load_dwordx4 a[204:207], v55, s[8:11], s62 offen sc1
    v_mfma_f32_16x16x32_bf16 a[104:107], a[52:55], a[152:155], a[104:107]
    v_mfma_f32_16x16x32_bf16 a[108:111], a[52:55], a[156:159], a[108:111]
    s_add_u32 s62, s62, 0x20000
    v_mfma_f32_16x16x32_bf16 v[240:243], a[56:59], a[144:147], v[240:243]
    s_add_u32 s52, s47, 532480
    v_mfma_f32_16x16x32_bf16 v[244:247], a[56:59], a[148:151], v[244:247]
    buffer_store_dwordx4 v[160:163], v1, s[48:51], s52 offen offset:0 sc1
    v_mfma_f32_16x16x32_bf16 a[112:115], a[56:59], a[152:155], a[112:115]
    v_mfma_f32_16x16x32_bf16 a[116:119], a[56:59], a[156:159], a[116:119]
    v_mfma_f32_16x16x32_bf16 v[248:251], a[60:63], a[144:147], v[248:251]
    v_mfma_f32_16x16x32_bf16 v[252:255], a[60:63], a[148:151], v[252:255]
    v_mfma_f32_16x16x32_bf16 a[120:123], a[60:63], a[152:155], a[120:123]
    v_mfma_f32_16x16x32_bf16 a[124:127], a[60:63], a[156:159], a[124:127]
    s_waitcnt vmcnt(16) lgkmcnt(0)
    v_mfma_f32_16x16x32_bf16 v[192:195], a[0:3], a[160:163], v[192:195]
    ds_read_b64_tr_b16 a[32:33], v42 offset:57344
    ds_read_b64_tr_b16 a[34:35], v42 offset:58368
    v_mfma_f32_16x16x32_bf16 v[196:199], a[0:3], a[164:167], v[196:199]
    buffer_load_dwordx4 a[208:211], v36, s[8:11], s62 offen sc1
    v_mfma_f32_16x16x32_bf16 a[64:67], a[0:3], a[168:171], a[64:67]
    ds_read_b64_tr_b16 a[36:37], v43 offset:57344
    v_mfma_f32_16x16x32_bf16 a[68:71], a[0:3], a[172:175], a[68:71]
    ds_read_b64_tr_b16 a[38:39], v43 offset:58368
    v_mfma_f32_16x16x32_bf16 v[200:203], a[4:7], a[160:163], v[200:203]
    ds_read_b64_tr_b16 a[40:41], v44 offset:57344
    v_mfma_f32_16x16x32_bf16 v[204:207], a[4:7], a[164:167], v[204:207]
    v_mfma_f32_16x16x32_bf16 a[72:75], a[4:7], a[168:171], a[72:75]
    buffer_load_dwordx4 a[212:215], v54, s[8:11], s62 offen sc1
    ds_read_b64_tr_b16 a[42:43], v44 offset:58368
    v_mfma_f32_16x16x32_bf16 a[76:79], a[4:7], a[172:175], a[76:79]
    ds_read_b64_tr_b16 a[44:45], v45 offset:57344
    v_mfma_f32_16x16x32_bf16 v[208:211], a[8:11], a[160:163], v[208:211]
    v_mfma_f32_16x16x32_bf16 v[212:215], a[8:11], a[164:167], v[212:215]
    ds_read_b64_tr_b16 a[46:47], v45 offset:58368
    v_mfma_f32_16x16x32_bf16 a[80:83], a[8:11], a[168:171], a[80:83]
    ds_read_b64_tr_b16 a[48:49], v46 offset:57344
    v_mfma_f32_16x16x32_bf16 a[84:87], a[8:11], a[172:175], a[84:87]
    buffer_load_dwordx4 a[216:219], v37, s[8:11], s62 offen sc1
    ds_read_b64_tr_b16 a[50:51], v46 offset:58368
    v_mfma_f32_16x16x32_bf16 v[216:219], a[12:15], a[160:163], v[216:219]
    v_mfma_f32_16x16x32_bf16 v[220:223], a[12:15], a[164:167], v[220:223]
    ds_read_b64_tr_b16 a[52:53], v47 offset:57344
    v_mfma_f32_16x16x32_bf16 a[88:91], a[12:15], a[168:171], a[88:91]
    ds_read_b64_tr_b16 a[54:55], v47 offset:58368
    v_mfma_f32_16x16x32_bf16 a[92:95], a[12:15], a[172:175], a[92:95]
    ds_read_b64_tr_b16 a[56:57], v48 offset:57344
    v_mfma_f32_16x16x32_bf16 v[224:227], a[16:19], a[160:163], v[224:227]
    v_mfma_f32_16x16x32_bf16 v[228:231], a[16:19], a[164:167], v[228:231]
    buffer_load_dwordx4 a[220:223], v55, s[8:11], s62 offen sc1
    ds_read_b64_tr_b16 a[58:59], v48 offset:58368
    v_mfma_f32_16x16x32_bf16 a[96:99], a[16:19], a[168:171], a[96:99]
    ds_read_b64_tr_b16 a[60:61], v49 offset:57344
    v_mfma_f32_16x16x32_bf16 a[100:103], a[16:19], a[172:175], a[100:103]
    v_mfma_f32_16x16x32_bf16 v[232:235], a[20:23], a[160:163], v[232:235]
    ds_read_b64_tr_b16 a[62:63], v49 offset:58368
    v_mfma_f32_16x16x32_bf16 v[236:239], a[20:23], a[164:167], v[236:239]
    s_add_u32 s62, s62, 0x20000
    v_mfma_f32_16x16x32_bf16 a[104:107], a[20:23], a[168:171], a[104:107]
    s_add_u32 s52, s47, 532480
    v_mfma_f32_16x16x32_bf16 a[108:111], a[20:23], a[172:175], a[108:111]
    buffer_store_dwordx4 v[164:167], v1, s[48:51], s52 offen offset:1024 sc1
    v_mfma_f32_16x16x32_bf16 v[240:243], a[24:27], a[160:163], v[240:243]
    v_mfma_f32_16x16x32_bf16 v[244:247], a[24:27], a[164:167], v[244:247]
    v_mfma_f32_16x16x32_bf16 a[112:115], a[24:27], a[168:171], a[112:115]
    v_mfma_f32_16x16x32_bf16 a[116:119], a[24:27], a[172:175], a[116:119]
    v_mfma_f32_16x16x32_bf16 v[248:251], a[28:31], a[160:163], v[248:251]
    v_mfma_f32_16x16x32_bf16 v[252:255], a[28:31], a[164:167], v[252:255]
    v_mfma_f32_16x16x32_bf16 a[120:123], a[28:31], a[168:171], a[120:123]
    v_mfma_f32_16x16x32_bf16 a[124:127], a[28:31], a[172:175], a[124:127]
    s_waitcnt vmcnt(10) lgkmcnt(0)
    s_barrier
    v_mfma_f32_16x16x32_bf16 v[192:195], a[32:35], a[176:179], v[192:195]
    ds_read_b64_tr_b16 a[0:1], v42 offset:0
    ds_read_b64_tr_b16 a[2:3], v42 offset:1024
    v_mfma_f32_16x16x32_bf16 v[196:199], a[32:35], a[180:183], v[196:199]
    s_cmp_eq_u32 s56, 0
    s_cbranch_scc1 k12_ool_60
k12_oolret_61:
    v_mfma_f32_16x16x32_bf16 a[64:67], a[32:35], a[184:187], a[64:67]
    s_add_u32 m0, s60, 114688
    ds_read_b64_tr_b16 a[4:5], v43 offset:0
    v_mfma_f32_16x16x32_bf16 a[68:71], a[32:35], a[188:191], a[68:71]
    buffer_load_dwordx4 v38, s[12:15], s61 offen offset:0 lds
    ds_read_b64_tr_b16 a[6:7], v43 offset:1024
    v_mfma_f32_16x16x32_bf16 v[200:203], a[36:39], a[176:179], v[200:203]
    buffer_load_dwordx4 v39, s[12:15], s61 offen offset:1024 lds
    ds_read_b64_tr_b16 a[8:9], v44 offset:0
    v_mfma_f32_16x16x32_bf16 v[204:207], a[36:39], a[180:183], v[204:207]
    v_mfma_f32_16x16x32_bf16 a[72:75], a[36:39], a[184:187], a[72:75]
    ds_read_b64_tr_b16 a[10:11], v44 offset:1024
    v_mfma_f32_16x16x32_bf16 a[76:79], a[36:39], a[188:191], a[76:79]
    buffer_load_dwordx4 v40, s[12:15], s61 offen offset:2048 lds
    ds_read_b64_tr_b16 a[12:13], v45 offset:0
    v_mfma_f32_16x16x32_bf16 v[208:211], a[40:43], a[176:179], v[208:211]
    s_mov_b32 s32, s60
    v_mfma_f32_16x16x32_bf16 v[212:215], a[40:43], a[180:183], v[212:215]
    ds_read_b64_tr_b16 a[14:15], v45 offset:1024
    v_mfma_f32_16x16x32_bf16 a[80:83], a[40:43], a[184:187], a[80:83]
    s_mov_b32 s34, s60
    buffer_load_dwordx4 v41, s[12:15], s61 offen offset:3072 lds
    ds_read_b64_tr_b16 a[16:17], v46 offset:0
    v_mfma_f32_16x16x32_bf16 a[84:87], a[40:43], a[188:191], a[84:87]
    ds_read_b64_tr_b16 a[18:19], v46 offset:1024
    v_mfma_f32_16x16x32_bf16 v[216:219], a[44:47], a[176:179], v[216:219]
    s_add_u32 s61, s61, 0x80000
    v_mfma_f32_16x16x32_bf16 v[220:223], a[44:47], a[180:183], v[220:223]
    s_mov_b32 s33, s60
    buffer_load_dwordx4 a[224:227], v36, s[8:11], s62 offen sc1
    ds_read_b64_tr_b16 a[20:21], v47 offset:0
    v_mfma_f32_16x16x32_bf16 a[88:91], a[44:47], a[184:187], a[88:91]
    ds_read_b64_tr_b16 a[22:23], v47 offset:1024
    v_mfma_f32_16x16x32_bf16 a[92:95], a[44:47], a[188:191], a[92:95]
    buffer_load_dwordx4 a[228:231], v54, s[8:11], s62 offen sc1
    ds_read_b64_tr_b16 a[24:25], v48 offset:0
    v_mfma_f32_16x16x32_bf16 v[224:227], a[48:51], a[176:179], v[224:227]
    s_add_u32 s35, s60, 0x10000
    v_mfma_f32_16x16x32_bf16 v[228:231], a[48:51], a[180:183], v[228:231]
    ds_read_b64_tr_b16 a[26:27], v48 offset:1024
    v_mfma_f32_16x16x32_bf16 a[96:99], a[48:51], a[184:187], a[96:99]
    buffer_load_dwordx4 a[232:235], v37, s[8:11], s62 offen sc1
    ds_read_b64_tr_b16 a[28:29], v49 offset:0
    v_mfma_f32_16x16x32_bf16 a[100:103], a[48:51], a[188:191], a[100:103]
    v_mfma_f32_16x16x32_bf16 v[232:235], a[52:55], a[176:179], v[232:235]
    ds_read_b64_tr_b16 a[30:31], v49 offset:1024
    v_mfma_f32_16x16x32_bf16 v[236:239], a[52:55], a[180:183], v[236:239]
    buffer_load_dwordx4 a[236:239], v55, s[8:11], s62 offen sc1
    v_mfma_f32_16x16x32_bf16 a[104:107], a[52:55], a[184:187], a[104:107]
    v_mfma_f32_16x16x32_bf16 a[108:111], a[52:55], a[188:191], a[108:111]
    s_add_u32 s62, s62, 0x20000
    v_mfma_f32_16x16x32_bf16 v[240:243], a[56:59], a[176:179], v[240:243]
    s_add_u32 s52, s47, 532480
    v_mfma_f32_16x16x32_bf16 v[244:247], a[56:59], a[180:183], v[244:247]
    buffer_store_dwordx4 v[168:171], v1, s[48:51], s52 offen offset:2048 sc1
    v_mfma_f32_16x16x32_bf16 a[112:115], a[56:59], a[184:187], a[112:115]
    v_mfma_f32_16x16x32_bf16 a[116:119], a[56:59], a[188:191], a[116:119]
    v_mfma_f32_16x16x32_bf16 v[248:251], a[60:63], a[176:179], v[248:251]
    v_mfma_f32_16x16x32_bf16 v[252:255], a[60:63], a[180:183], v[252:255]
    v_mfma_f32_16x16x32_bf16 a[120:123], a[60:63], a[184:187], a[120:123]
    v_mfma_f32_16x16x32_bf16 a[124:127], a[60:63], a[188:191], a[124:127]
    s_waitcnt vmcnt(15) lgkmcnt(0)
    v_mfma_f32_16x16x32_bf16 v[192:195], a[0:3], a[192:195], v[192:195]
    ds_read_b64_tr_b16 a[32:33], v42 offset:8192
    ds_read_b64_tr_b16 a[34:35], v42 offset:9216
    v_mfma_f32_16x16x32_bf16 v[196:199], a[0:3], a[196:199], v[196:199]
    buffer_load_dwordx4 a[240:243], v36, s[8:11], s62 offen sc1
    v_mfma_f32_16x16x32_bf16 a[64:67], a[0:3], a[200:203], a[64:67]
    ds_read_b64_tr_b16 a[36:37], v43 offset:8192
    v_mfma_f32_16x16x32_bf16 a[68:71], a[0:3], a[204:207], a[68:71]
    ds_read_b64_tr_b16 a[38:39], v43 offset:9216
    v_mfma_f32_16x16x32_bf16 v[200:203], a[4:7], a[192:195], v[200:203]
    ds_read_b64_tr_b16 a[40:41], v44 offset:8192
    v_mfma_f32_16x16x32_bf16 v[204:207], a[4:7], a[196:199], v[204:207]
    v_mfma_f32_16x16x32_bf16 a[72:75], a[4:7], a[200:203], a[72:75]
    buffer_load_dwordx4 a[244:247], v54, s[8:11], s62 offen sc1
    ds_read_b64_tr_b16 a[42:43], v44 offset:9216
    v_mfma_f32_16x16x32_bf16 a[76:79], a[4:7], a[204:207], a[76:79]
    ds_read_b64_tr_b16 a[44:45], v45 offset:8192
    v_mfma_f32_16x16x32_bf16 v[208:211], a[8:11], a[192:195], v[208:211]
    v_mfma_f32_16x16x32_bf16 v[212:215], a[8:11], a[196:199], v[212:215]
    ds_read_b64_tr_b16 a[46:47], v45 offset:9216
    v_mfma_f32_16x16x32_bf16 a[80:83], a[8:11], a[200:203], a[80:83]
    ds_read_b64_tr_b16 a[48:49], v46 offset:8192
    v_mfma_f32_16x16x32_bf16 a[84:87], a[8:11], a[204:207], a[84:87]
    buffer_load_dwordx4 a[248:251], v37, s[8:11], s62 offen sc1
    ds_read_b64_tr_b16 a[50:51], v46 offset:9216
    v_mfma_f32_16x16x32_bf16 v[216:219], a[12:15], a[192:195], v[216:219]
    v_mfma_f32_16x16x32_bf16 v[220:223], a[12:15], a[196:199], v[220:223]
    ds_read_b64_tr_b16 a[52:53], v47 offset:8192
    v_mfma_f32_16x16x32_bf16 a[88:91], a[12:15], a[200:203], a[88:91]
    ds_read_b64_tr_b16 a[54:55], v47 offset:9216
    v_mfma_f32_16x16x32_bf16 a[92:95], a[12:15], a[204:207], a[92:95]
    ds_read_b64_tr_b16 a[56:57], v48 offset:8192
    v_mfma_f32_16x16x32_bf16 v[224:227], a[16:19], a[192:195], v[224:227]
    v_mfma_f32_16x16x32_bf16 v[228:231], a[16:19], a[196:199], v[228:231]
    buffer_load_dwordx4 a[252:255], v55, s[8:11], s62 offen sc1
    ds_read_b64_tr_b16 a[58:59], v48 offset:9216
    v_mfma_f32_16x16x32_bf16 a[96:99], a[16:19], a[200:203], a[96:99]
    ds_read_b64_tr_b16 a[60:61], v49 offset:8192
    v_mfma_f32_16x16x32_bf16 a[100:103], a[16:19], a[204:207], a[100:103]
    v_mfma_f32_16x16x32_bf16 v[232:235], a[20:23], a[192:195], v[232:235]
    ds_read_b64_tr_b16 a[62:63], v49 offset:9216
    v_mfma_f32_16x16x32_bf16 v[236:239], a[20:23], a[196:199], v[236:239]
    s_add_u32 s62, s62, 0x20000
    v_mfma_f32_16x16x32_bf16 a[104:107], a[20:23], a[200:203], a[104:107]
    s_add_u32 s52, s47, 532480
    v_mfma_f32_16x16x32_bf16 a[108:111], a[20:23], a[204:207], a[108:111]
    buffer_store_dwordx4 v[172:175], v1, s[48:51], s52 offen offset:3072 sc1
    v_mfma_f32_16x16x32_bf16 v[240:243], a[24:27], a[192:195], v[240:243]
    v_mfma_f32_16x16x32_bf16 v[244:247], a[24:27], a[196:199], v[244:247]
    v_mfma_f32_16x16x32_bf16 a[112:115], a[24:27], a[200:203], a[112:115]
    v_mfma_f32_16x16x32_bf16 a[116:119], a[24:27], a[204:207], a[116:119]
    v_mfma_f32_16x16x32_bf16 v[248:251], a[28:31], a[192:195], v[248:251]
    v_add_co_u32 v2, vcc, 0x4000, v2
    s_nop 1
    v_addc_co_u32 v3, vcc, 0, v3, vcc
    global_load_dword v51, v[2:3], off
    v_mfma_f32_16x16x32_bf16 v[252:255], a[28:31], a[196:199], v[252:255]
    v_mfma_f32_16x16x32_bf16 a[120:123], a[28:31], a[200:203], a[120:123]
    v_mfma_f32_16x16x32_bf16 a[124:127], a[28:31], a[204:207], a[124:127]
    s_waitcnt vmcnt(10) lgkmcnt(0)
    s_barrier
    v_mfma_f32_16x16x32_bf16 v[192:195], a[32:35], a[208:211], v[192:195]
    ds_read_b64_tr_b16 a[0:1], v42 offset:16384
    ds_read_b64_tr_b16 a[2:3], v42 offset:17408
    v_mfma_f32_16x16x32_bf16 v[196:199], a[32:35], a[212:215], v[196:199]
    s_add_u32 m0, s60, 131072
    v_mfma_f32_16x16x32_bf16 a[64:67], a[32:35], a[216:219], a[64:67]
    buffer_load_dwordx4 v38, s[12:15], s61 offen offset:0 lds
    ds_read_b64_tr_b16 a[4:5], v43 offset:16384
    v_mfma_f32_16x16x32_bf16 a[68:71], a[32:35], a[220:223], a[68:71]
    ds_read_b64_tr_b16 a[6:7], v43 offset:17408
    v_mfma_f32_16x16x32_bf16 v[200:203], a[36:39], a[208:211], v[200:203]
    buffer_load_dwordx4 v39, s[12:15], s61 offen offset:1024 lds
    ds_read_b64_tr_b16 a[8:9], v44 offset:16384
    v_mfma_f32_16x16x32_bf16 v[204:207], a[36:39], a[212:215], v[204:207]
    v_mfma_f32_16x16x32_bf16 a[72:75], a[36:39], a[216:219], a[72:75]
    ds_read_b64_tr_b16 a[10:11], v44 offset:17408
    v_mfma_f32_16x16x32_bf16 a[76:79], a[36:39], a[220:223], a[76:79]
    buffer_load_dwordx4 v40, s[12:15], s61 offen offset:2048 lds
    ds_read_b64_tr_b16 a[12:13], v45 offset:16384
    v_mfma_f32_16x16x32_bf16 v[208:211], a[40:43], a[208:211], v[208:211]
    v_mfma_f32_16x16x32_bf16 v[212:215], a[40:43], a[212:215], v[212:215]
    ds_read_b64_tr_b16 a[14:15], v45 offset:17408
    v_mfma_f32_16x16x32_bf16 a[80:83], a[40:43], a[216:219], a[80:83]
    buffer_load_dwordx4 v41, s[12:15], s61 offen offset:3072 lds
    ds_read_b64_tr_b16 a[16:17], v46 offset:16384
    v_mfma_f32_16x16x32_bf16 a[84:87], a[40:43], a[220:223], a[84:87]
    ds_read_b64_tr_b16 a[18:19], v46 offset:17408
    v_mfma_f32_16x16x32_bf16 v[216:219], a[44:47], a[208:211], v[216:219]
    s_add_u32 s61, s61, 0x80000
    v_mfma_f32_16x16x32_bf16 v[220:223], a[44:47], a[212:215], v[220:223]
    buffer_load_dwordx4 a[128:131], v36, s[8:11], s62 offen sc1
    ds_read_b64_tr_b16 a[20:21], v47 offset:16384
    v_mfma_f32_16x16x32_bf16 a[88:91], a[44:47], a[216:219], a[88:91]
    ds_read_b64_tr_b16 a[22:23], v47 offset:17408
    v_mfma_f32_16x16x32_bf16 a[92:95], a[44:47], a[220:223], a[92:95]
    buffer_load_dwordx4 a[132:135], v54, s[8:11], s62 offen sc1
    ds_read_b64_tr_b16 a[24:25], v48 offset:16384
    v_mfma_f32_16x16x32_bf16 v[224:227], a[48:51], a[208:211], v[224:227]
    v_mfma_f32_16x16x32_bf16 v[228:231], a[48:51], a[212:215], v[228:231]
    ds_read_b64_tr_b16 a[26:27], v48 offset:17408
    v_mfma_f32_16x16x32_bf16 a[96:99], a[48:51], a[216:219], a[96:99]
    buffer_load_dwordx4 a[136:139], v37, s[8:11], s62 offen sc1
    ds_read_b64_tr_b16 a[28:29], v49 offset:16384
    v_mfma_f32_16x16x32_bf16 a[100:103], a[48:51], a[220:223], a[100:103]
    v_mfma_f32_16x16x32_bf16 v[232:235], a[52:55], a[208:211], v[232:235]
    ds_read_b64_tr_b16 a[30:31], v49 offset:17408
    v_mfma_f32_16x16x32_bf16 v[236:239], a[52:55], a[212:215], v[236:239]
    buffer_load_dwordx4 a[140:143], v55, s[8:11], s62 offen sc1
    v_mfma_f32_16x16x32_bf16 a[104:107], a[52:55], a[216:219], a[104:107]
    v_mfma_f32_16x16x32_bf16 a[108:111], a[52:55], a[220:223], a[108:111]
    s_add_u32 s62, s62, 0x20000
    v_mfma_f32_16x16x32_bf16 v[240:243], a[56:59], a[208:211], v[240:243]
    s_add_u32 s52, s47, 536576
    v_mfma_f32_16x16x32_bf16 v[244:247], a[56:59], a[212:215], v[244:247]
    buffer_store_dwordx4 v[176:179], v1, s[48:51], s52 offen offset:0 sc1
    v_mfma_f32_16x16x32_bf16 a[112:115], a[56:59], a[216:219], a[112:115]
    v_mfma_f32_16x16x32_bf16 a[116:119], a[56:59], a[220:223], a[116:119]
    v_mfma_f32_16x16x32_bf16 v[248:251], a[60:63], a[208:211], v[248:251]
    v_mfma_f32_16x16x32_bf16 v[252:255], a[60:63], a[212:215], v[252:255]
    v_mfma_f32_16x16x32_bf16 a[120:123], a[60:63], a[216:219], a[120:123]
    v_mfma_f32_16x16x32_bf16 a[124:127], a[60:63], a[220:223], a[124:127]
    s_waitcnt vmcnt(15) lgkmcnt(0)
    v_mfma_f32_16x16x32_bf16 v[192:195], a[0:3], a[224:227], v[192:195]
    ds_read_b64_tr_b16 a[32:33], v42 offset:24576
    ds_read_b64_tr_b16 a[34:35], v42 offset:25600
    v_mfma_f32_16x16x32_bf16 v[196:199], a[0:3], a[228:231], v[196:199]
    buffer_load_dwordx4 a[144:147], v36, s[8:11], s62 offen sc1
    v_mfma_f32_16x16x32_bf16 a[64:67], a[0:3], a[232:235], a[64:67]
    ds_read_b64_tr_b16 a[36:37], v43 offset:24576
    v_mfma_f32_16x16x32_bf16 a[68:71], a[0:3], a[236:239], a[68:71]
    ds_read_b64_tr_b16 a[38:39], v43 offset:25600
    v_mfma_f32_16x16x32_bf16 v[200:203], a[4:7], a[224:227], v[200:203]
    ds_read_b64_tr_b16 a[40:41], v44 offset:24576
    v_mfma_f32_16x16x32_bf16 v[204:207], a[4:7], a[228:231], v[204:207]
    v_mfma_f32_16x16x32_bf16 a[72:75], a[4:7], a[232:235], a[72:75]
    buffer_load_dwordx4 a[148:151], v54, s[8:11], s62 offen sc1
    ds_read_b64_tr_b16 a[42:43], v44 offset:25600
    v_mfma_f32_16x16x32_bf16 a[76:79], a[4:7], a[236:239], a[76:79]
    ds_read_b64_tr_b16 a[44:45], v45 offset:24576
    v_mfma_f32_16x16x32_bf16 v[208:211], a[8:11], a[224:227], v[208:211]
    v_mfma_f32_16x16x32_bf16 v[212:215], a[8:11], a[228:231], v[212:215]
    ds_read_b64_tr_b16 a[46:47], v45 offset:25600
    v_mfma_f32_16x16x32_bf16 a[80:83], a[8:11], a[232:235], a[80:83]
    ds_read_b64_tr_b16 a[48:49], v46 offset:24576
    v_mfma_f32_16x16x32_bf16 a[84:87], a[8:11], a[236:239], a[84:87]
    buffer_load_dwordx4 a[152:155], v37, s[8:11], s62 offen sc1
    ds_read_b64_tr_b16 a[50:51], v46 offset:25600
    v_mfma_f32_16x16x32_bf16 v[216:219], a[12:15], a[224:227], v[216:219]
    v_mfma_f32_16x16x32_bf16 v[220:223], a[12:15], a[228:231], v[220:223]
    ds_read_b64_tr_b16 a[52:53], v47 offset:24576
    v_mfma_f32_16x16x32_bf16 a[88:91], a[12:15], a[232:235], a[88:91]
    ds_read_b64_tr_b16 a[54:55], v47 offset:25600
    v_mfma_f32_16x16x32_bf16 a[92:95], a[12:15], a[236:239], a[92:95]
    ds_read_b64_tr_b16 a[56:57], v48 offset:24576
    v_mfma_f32_16x16x32_bf16 v[224:227], a[16:19], a[224:227], v[224:227]
    v_mfma_f32_16x16x32_bf16 v[228:231], a[16:19], a[228:231], v[228:231]
    buffer_load_dwordx4 a[156:159], v55, s[8:11], s62 offen sc1
    ds_read_b64_tr_b16 a[58:59], v48 offset:25600
    v_mfma_f32_16x16x32_bf16 a[96:99], a[16:19], a[232:235], a[96:99]
    ds_read_b64_tr_b16 a[60:61], v49 offset:24576
    v_mfma_f32_16x16x32_bf16 a[100:103], a[16:19], a[236:239], a[100:103]
    v_mfma_f32_16x16x32_bf16 v[232:235], a[20:23], a[224:227], v[232:235]
    ds_read_b64_tr_b16 a[62:63], v49 offset:25600
    v_mfma_f32_16x16x32_bf16 v[236:239], a[20:23], a[228:231], v[236:239]
    s_add_u32 s62, s62, 0x20000
    v_mfma_f32_16x16x32_bf16 a[104:107], a[20:23], a[232:235], a[104:107]
    s_add_u32 s52, s47, 536576
    v_mfma_f32_16x16x32_bf16 a[108:111], a[20:23], a[236:239], a[108:111]
    buffer_store_dwordx4 v[180:183], v1, s[48:51], s52 offen offset:1024 sc1
    v_mfma_f32_16x16x32_bf16 v[240:243], a[24:27], a[224:227], v[240:243]
    v_mfma_f32_16x16x32_bf16 v[244:247], a[24:27], a[228:231], v[244:247]
    v_mfma_f32_16x16x32_bf16 a[112:115], a[24:27], a[232:235], a[112:115]
    v_mfma_f32_16x16x32_bf16 a[116:119], a[24:27], a[236:239], a[116:119]
    v_mfma_f32_16x16x32_bf16 v[248:251], a[28:31], a[224:227], v[248:251]
    v_mfma_f32_16x16x32_bf16 v[252:255], a[28:31], a[228:231], v[252:255]
    v_mfma_f32_16x16x32_bf16 a[120:123], a[28:31], a[232:235], a[120:123]
    v_mfma_f32_16x16x32_bf16 a[124:127], a[28:31], a[236:239], a[124:127]
    s_waitcnt vmcnt(10) lgkmcnt(0)
    s_barrier
    v_mfma_f32_16x16x32_bf16 v[192:195], a[32:35], a[240:243], v[192:195]
    ds_read_b64_tr_b16 a[0:1], v42 offset:32768
    ds_read_b64_tr_b16 a[2:3], v42 offset:33792
    v_mfma_f32_16x16x32_bf16 v[196:199], a[32:35], a[244:247], v[196:199]
    s_cmp_eq_u32 s30, 0
    s_cbranch_scc1 k12_ool_62
k12_oolret_63:
    v_mfma_f32_16x16x32_bf16 a[64:67], a[32:35], a[248:251], a[64:67]
    s_add_u32 m0, s60, 147456
    ds_read_b64_tr_b16 a[4:5], v43 offset:32768
    v_mfma_f32_16x16x32_bf16 a[68:71], a[32:35], a[252:255], a[68:71]
    buffer_load_dwordx4 v38, s[12:15], s61 offen offset:0 lds
    ds_read_b64_tr_b16 a[6:7], v43 offset:33792
    v_mfma_f32_16x16x32_bf16 v[200:203], a[36:39], a[240:243], v[200:203]
    buffer_load_dwordx4 v39, s[12:15], s61 offen offset:1024 lds
    ds_read_b64_tr_b16 a[8:9], v44 offset:32768
    v_mfma_f32_16x16x32_bf16 v[204:207], a[36:39], a[244:247], v[204:207]
    v_mfma_f32_16x16x32_bf16 a[72:75], a[36:39], a[248:251], a[72:75]
    ds_read_b64_tr_b16 a[10:11], v44 offset:33792
    v_mfma_f32_16x16x32_bf16 a[76:79], a[36:39], a[252:255], a[76:79]
    buffer_load_dwordx4 v40, s[12:15], s61 offen offset:2048 lds
    ds_read_b64_tr_b16 a[12:13], v45 offset:32768
    v_mfma_f32_16x16x32_bf16 v[208:211], a[40:43], a[240:243], v[208:211]
    v_mfma_f32_16x16x32_bf16 v[212:215], a[40:43], a[244:247], v[212:215]
    ds_read_b64_tr_b16 a[14:15], v45 offset:33792
    v_mfma_f32_16x16x32_bf16 a[80:83], a[40:43], a[248:251], a[80:83]
    buffer_load_dwordx4 v41, s[12:15], s61 offen offset:3072 lds
    ds_read_b64_tr_b16 a[16:17], v46 offset:32768
    v_mfma_f32_16x16x32_bf16 a[84:87], a[40:43], a[252:255], a[84:87]
    ds_read_b64_tr_b16 a[18:19], v46 offset:33792
    v_mfma_f32_16x16x32_bf16 v[216:219], a[44:47], a[240:243], v[216:219]
    s_add_u32 s61, s61, 0x80000
    v_mfma_f32_16x16x32_bf16 v[220:223], a[44:47], a[244:247], v[220:223]
    buffer_load_dwordx4 a[160:163], v36, s[8:11], s62 offen sc1
    ds_read_b64_tr_b16 a[20:21], v47 offset:32768
    v_mfma_f32_16x16x32_bf16 a[88:91], a[44:47], a[248:251], a[88:91]
    ds_read_b64_tr_b16 a[22:23], v47 offset:33792
    v_mfma_f32_16x16x32_bf16 a[92:95], a[44:47], a[252:255], a[92:95]
    buffer_load_dwordx4 a[164:167], v54, s[8:11], s62 offen sc1
    ds_read_b64_tr_b16 a[24:25], v48 offset:32768
    v_mfma_f32_16x16x32_bf16 v[224:227], a[48:51], a[240:243], v[224:227]
    v_mfma_f32_16x16x32_bf16 v[228:231], a[48:51], a[244:247], v[228:231]
    ds_read_b64_tr_b16 a[26:27], v48 offset:33792
    v_mfma_f32_16x16x32_bf16 a[96:99], a[48:51], a[248:251], a[96:99]
    buffer_load_dwordx4 a[168:171], v37, s[8:11], s62 offen sc1
    ds_read_b64_tr_b16 a[28:29], v49 offset:32768
    v_mfma_f32_16x16x32_bf16 a[100:103], a[48:51], a[252:255], a[100:103]
    v_mfma_f32_16x16x32_bf16 v[232:235], a[52:55], a[240:243], v[232:235]
    ds_read_b64_tr_b16 a[30:31], v49 offset:33792
    v_mfma_f32_16x16x32_bf16 v[236:239], a[52:55], a[244:247], v[236:239]
    buffer_load_dwordx4 a[172:175], v55, s[8:11], s62 offen sc1
    v_mfma_f32_16x16x32_bf16 a[104:107], a[52:55], a[248:251], a[104:107]
    v_mfma_f32_16x16x32_bf16 a[108:111], a[52:55], a[252:255], a[108:111]
    s_add_u32 s62, s62, 0x20000
    v_mfma_f32_16x16x32_bf16 v[240:243], a[56:59], a[240:243], v[240:243]
    s_add_u32 s52, s47, 536576
    v_mfma_f32_16x16x32_bf16 v[244:247], a[56:59], a[244:247], v[244:247]
    buffer_store_dwordx4 v[184:187], v1, s[48:51], s52 offen offset:2048 sc1
    v_mfma_f32_16x16x32_bf16 a[112:115], a[56:59], a[248:251], a[112:115]
    v_mfma_f32_16x16x32_bf16 a[116:119], a[56:59], a[252:255], a[116:119]
    v_mfma_f32_16x16x32_bf16 v[248:251], a[60:63], a[240:243], v[248:251]
    v_mfma_f32_16x16x32_bf16 v[252:255], a[60:63], a[244:247], v[252:255]
    v_mfma_f32_16x16x32_bf16 a[120:123], a[60:63], a[248:251], a[120:123]
    v_mfma_f32_16x16x32_bf16 a[124:127], a[60:63], a[252:255], a[124:127]
    s_waitcnt vmcnt(15) lgkmcnt(0)
    v_mfma_f32_16x16x32_bf16 v[192:195], a[0:3], a[128:131], v[192:195]
    ds_read_b64_tr_b16 a[32:33], v42 offset:40960
    ds_read_b64_tr_b16 a[34:35], v42 offset:41984
    v_mfma_f32_16x16x32_bf16 v[196:199], a[0:3], a[132:135], v[196:199]
    buffer_load_dwordx4 a[176:179], v36, s[8:11], s62 offen sc1
    v_mfma_f32_16x16x32_bf16 a[64:67], a[0:3], a[136:139], a[64:67]
    ds_read_b64_tr_b16 a[36:37], v43 offset:40960
    v_mfma_f32_16x16x32_bf16 a[68:71], a[0:3], a[140:143], a[68:71]
    ds_read_b64_tr_b16 a[38:39], v43 offset:41984
    v_mfma_f32_16x16x32_bf16 v[200:203], a[4:7], a[128:131], v[200:203]
    ds_read_b64_tr_b16 a[40:41], v44 offset:40960
    v_mfma_f32_16x16x32_bf16 v[204:207], a[4:7], a[132:135], v[204:207]
    v_mfma_f32_16x16x32_bf16 a[72:75], a[4:7], a[136:139], a[72:75]
    buffer_load_dwordx4 a[180:183], v54, s[8:11], s62 offen sc1
    ds_read_b64_tr_b16 a[42:43], v44 offset:41984
    v_mfma_f32_16x16x32_bf16 a[76:79], a[4:7], a[140:143], a[76:79]
    ds_read_b64_tr_b16 a[44:45], v45 offset:40960
    v_mfma_f32_16x16x32_bf16 v[208:211], a[8:11], a[128:131], v[208:211]
    v_mfma_f32_16x16x32_bf16 v[212:215], a[8:11], a[132:135], v[212:215]
    ds_read_b64_tr_b16 a[46:47], v45 offset:41984
    v_mfma_f32_16x16x32_bf16 a[80:83], a[8:11], a[136:139], a[80:83]
    ds_read_b64_tr_b16 a[48:49], v46 offset:40960
    v_mfma_f32_16x16x32_bf16 a[84:87], a[8:11], a[140:143], a[84:87]
    buffer_load_dwordx4 a[184:187], v37, s[8:11], s62 offen sc1
    ds_read_b64_tr_b16 a[50:51], v46 offset:41984
    v_mfma_f32_16x16x32_bf16 v[216:219], a[12:15], a[128:131], v[216:219]
    v_mfma_f32_16x16x32_bf16 v[220:223], a[12:15], a[132:135], v[220:223]
    ds_read_b64_tr_b16 a[52:53], v47 offset:40960
    v_mfma_f32_16x16x32_bf16 a[88:91], a[12:15], a[136:139], a[88:91]
    ds_read_b64_tr_b16 a[54:55], v47 offset:41984
    v_mfma_f32_16x16x32_bf16 a[92:95], a[12:15], a[140:143], a[92:95]
    ds_read_b64_tr_b16 a[56:57], v48 offset:40960
    v_mfma_f32_16x16x32_bf16 v[224:227], a[16:19], a[128:131], v[224:227]
    v_mfma_f32_16x16x32_bf16 v[228:231], a[16:19], a[132:135], v[228:231]
    buffer_load_dwordx4 a[188:191], v55, s[8:11], s62 offen sc1
    ds_read_b64_tr_b16 a[58:59], v48 offset:41984
    v_mfma_f32_16x16x32_bf16 a[96:99], a[16:19], a[136:139], a[96:99]
    ds_read_b64_tr_b16 a[60:61], v49 offset:40960
    v_mfma_f32_16x16x32_bf16 a[100:103], a[16:19], a[140:143], a[100:103]
    v_mfma_f32_16x16x32_bf16 v[232:235], a[20:23], a[128:131], v[232:235]
    ds_read_b64_tr_b16 a[62:63], v49 offset:41984
    v_mfma_f32_16x16x32_bf16 v[236:239], a[20:23], a[132:135], v[236:239]
    s_add_u32 s62, s62, 0x20000
    v_mfma_f32_16x16x32_bf16 a[104:107], a[20:23], a[136:139], a[104:107]
    s_add_u32 s52, s47, 536576
    v_mfma_f32_16x16x32_bf16 a[108:111], a[20:23], a[140:143], a[108:111]
    buffer_store_dwordx4 v[188:191], v1, s[48:51], s52 offen offset:3072 sc1
    v_mfma_f32_16x16x32_bf16 v[240:243], a[24:27], a[128:131], v[240:243]
    v_mfma_f32_16x16x32_bf16 v[244:247], a[24:27], a[132:135], v[244:247]
    v_mfma_f32_16x16x32_bf16 a[112:115], a[24:27], a[136:139], a[112:115]
    v_mfma_f32_16x16x32_bf16 a[116:119], a[24:27], a[140:143], a[116:119]
    v_mfma_f32_16x16x32_bf16 v[248:251], a[28:31], a[128:131], v[248:251]
    s_cmp_eq_u32 s30, 0
    s_cbranch_scc1 k12_ool_66
k12_oolret_67:
    v_mfma_f32_16x16x32_bf16 v[252:255], a[28:31], a[132:135], v[252:255]
    v_mfma_f32_16x16x32_bf16 a[120:123], a[28:31], a[136:139], a[120:123]
    v_mfma_f32_16x16x32_bf16 a[124:127], a[28:31], a[140:143], a[124:127]
    s_waitcnt vmcnt(10) lgkmcnt(0)
    s_barrier
    v_mfma_f32_16x16x32_bf16 v[192:195], a[32:35], a[144:147], v[192:195]
    ds_read_b64_tr_b16 a[0:1], v42 offset:49152
    ds_read_b64_tr_b16 a[2:3], v42 offset:50176
    v_mfma_f32_16x16x32_bf16 v[196:199], a[32:35], a[148:151], v[196:199]
    s_mov_b32 m0, s34
    v_mfma_f32_16x16x32_bf16 a[64:67], a[32:35], a[152:155], a[64:67]
    buffer_load_dwordx4 v1, s[16:19], s32 offen offset:0 sc1 lds
    ds_read_b64_tr_b16 a[4:5], v43 offset:49152
    v_mfma_f32_16x16x32_bf16 a[68:71], a[32:35], a[156:159], a[68:71]
    ds_read_b64_tr_b16 a[6:7], v43 offset:50176
    v_mfma_f32_16x16x32_bf16 v[200:203], a[36:39], a[144:147], v[200:203]
    buffer_load_dwordx4 v1, s[16:19], s32 offen offset:1024 sc1 lds
    ds_read_b64_tr_b16 a[8:9], v44 offset:49152
    v_mfma_f32_16x16x32_bf16 v[204:207], a[36:39], a[148:151], v[204:207]
    v_mfma_f32_16x16x32_bf16 a[72:75], a[36:39], a[152:155], a[72:75]
    ds_read_b64_tr_b16 a[10:11], v44 offset:50176
    v_mfma_f32_16x16x32_bf16 a[76:79], a[36:39], a[156:159], a[76:79]
    buffer_load_dwordx4 v1, s[16:19], s32 offen offset:2048 sc1 lds
    ds_read_b64_tr_b16 a[12:13], v45 offset:49152
    v_mfma_f32_16x16x32_bf16 v[208:211], a[40:43], a[144:147], v[208:211]
    v_mfma_f32_16x16x32_bf16 v[212:215], a[40:43], a[148:151], v[212:215]
    ds_read_b64_tr_b16 a[14:15], v45 offset:50176
    v_mfma_f32_16x16x32_bf16 a[80:83], a[40:43], a[152:155], a[80:83]
    ds_read_b64_tr_b16 a[16:17], v46 offset:49152
    v_mfma_f32_16x16x32_bf16 a[84:87], a[40:43], a[156:159], a[84:87]
    buffer_load_dwordx4 v1, s[16:19], s32 offen offset:3072 sc1 lds
    ds_read_b64_tr_b16 a[18:19], v46 offset:50176
    v_mfma_f32_16x16x32_bf16 v[216:219], a[44:47], a[144:147], v[216:219]
    v_mfma_f32_16x16x32_bf16 v[220:223], a[44:47], a[148:151], v[220:223]
    s_add_u32 s32, s32, 0x80000
    ds_read_b64_tr_b16 a[20:21], v47 offset:49152
    v_mfma_f32_16x16x32_bf16 a[88:91], a[44:47], a[152:155], a[88:91]
    s_add_u32 s34, s34, 0x4000
    ds_read_b64_tr_b16 a[22:23], v47 offset:50176
    s_mov_b32 m0, s34
    v_mfma_f32_16x16x32_bf16 a[92:95], a[44:47], a[156:159], a[92:95]
    buffer_load_dwordx4 v1, s[16:19], s32 offen offset:0 sc1 lds
    ds_read_b64_tr_b16 a[24:25], v48 offset:49152
    v_mfma_f32_16x16x32_bf16 v[224:227], a[48:51], a[144:147], v[224:227]
    v_mfma_f32_16x16x32_bf16 v[228:231], a[48:51], a[148:151], v[228:231]
    buffer_load_dwordx4 v1, s[16:19], s32 offen offset:1024 sc1 lds
    ds_read_b64_tr_b16 a[26:27], v48 offset:50176
    v_mfma_f32_16x16x32_bf16 a[96:99], a[48:51], a[152:155], a[96:99]
    ds_read_b64_tr_b16 a[28:29], v49 offset:49152
    v_mfma_f32_16x16x32_bf16 a[100:103], a[48:51], a[156:159], a[100:103]
    v_mfma_f32_16x16x32_bf16 v[232:235], a[52:55], a[144:147], v[232:235]
    buffer_load_dwordx4 v1, s[16:19], s32 offen offset:2048 sc1 lds
    ds_read_b64_tr_b16 a[30:31], v49 offset:50176
    v_mfma_f32_16x16x32_bf16 v[236:239], a[52:55], a[148:151], v[236:239]
    v_mfma_f32_16x16x32_bf16 a[104:107], a[52:55], a[152:155], a[104:107]
    v_mfma_f32_16x16x32_bf16 a[108:111], a[52:55], a[156:159], a[108:111]
    v_mfma_f32_16x16x32_bf16 v[240:243], a[56:59], a[144:147], v[240:243]
    buffer_load_dwordx4 v1, s[16:19], s32 offen offset:3072 sc1 lds
    v_mfma_f32_16x16x32_bf16 v[244:247], a[56:59], a[148:151], v[244:247]
    v_mfma_f32_16x16x32_bf16 a[112:115], a[56:59], a[152:155], a[112:115]
    s_add_u32 s32, s32, 0x80000
    v_mfma_f32_16x16x32_bf16 a[116:119], a[56:59], a[156:159], a[116:119]
    s_add_u32 s34, s34, 0x4000
    v_mfma_f32_16x16x32_bf16 v[248:251], a[60:63], a[144:147], v[248:251]
    v_mfma_f32_16x16x32_bf16 v[252:255], a[60:63], a[148:151], v[252:255]
    v_mfma_f32_16x16x32_bf16 a[120:123], a[60:63], a[152:155], a[120:123]
    v_mfma_f32_16x16x32_bf16 a[124:127], a[60:63], a[156:159], a[124:127]
    s_waitcnt vmcnt(14) lgkmcnt(0)
    v_mfma_f32_16x16x32_bf16 v[192:195], a[0:3], a[160:163], v[192:195]
    ds_read_b64_tr_b16 a[32:33], v42 offset:57344
    ds_read_b64_tr_b16 a[34:35], v42 offset:58368
    v_mfma_f32_16x16x32_bf16 v[196:199], a[0:3], a[164:167], v[196:199]
    s_mov_b32 m0, s35
    v_mfma_f32_16x16x32_bf16 a[64:67], a[0:3], a[168:171], a[64:67]
    buffer_load_dwordx4 v1, s[20:23], s33 offen offset:0 sc1 lds
    ds_read_b64_tr_b16 a[36:37], v43 offset:57344
    v_mfma_f32_16x16x32_bf16 a[68:71], a[0:3], a[172:175], a[68:71]
    ds_read_b64_tr_b16 a[38:39], v43 offset:58368
    v_mfma_f32_16x16x32_bf16 v[200:203], a[4:7], a[160:163], v[200:203]
    buffer_load_dwordx4 v1, s[20:23], s33 offen offset:1024 sc1 lds
    ds_read_b64_tr_b16 a[40:41], v44 offset:57344
    v_mfma_f32_16x16x32_bf16 v[204:207], a[4:7], a[164:167], v[204:207]
    v_mfma_f32_16x16x32_bf16 a[72:75], a[4:7], a[168:171], a[72:75]
    ds_read_b64_tr_b16 a[42:43], v44 offset:58368
    v_mfma_f32_16x16x32_bf16 a[76:79], a[4:7], a[172:175], a[76:79]
    buffer_load_dwordx4 v1, s[20:23], s33 offen offset:2048 sc1 lds
    ds_read_b64_tr_b16 a[44:45], v45 offset:57344
    v_mfma_f32_16x16x32_bf16 v[208:211], a[8:11], a[160:163], v[208:211]
    v_mfma_f32_16x16x32_bf16 v[212:215], a[8:11], a[164:167], v[212:215]
    ds_read_b64_tr_b16 a[46:47], v45 offset:58368
    v_mfma_f32_16x16x32_bf16 a[80:83], a[8:11], a[168:171], a[80:83]
    ds_read_b64_tr_b16 a[48:49], v46 offset:57344
    v_mfma_f32_16x16x32_bf16 a[84:87], a[8:11], a[172:175], a[84:87]
    buffer_load_dwordx4 v1, s[20:23], s33 offen offset:3072 sc1 lds
    ds_read_b64_tr_b16 a[50:51], v46 offset:58368
    v_mfma_f32_16x16x32_bf16 v[216:219], a[12:15], a[160:163], v[216:219]
    v_mfma_f32_16x16x32_bf16 v[220:223], a[12:15], a[164:167], v[220:223]
    s_add_u32 s33, s33, 0x80000
    ds_read_b64_tr_b16 a[52:53], v47 offset:57344
    v_mfma_f32_16x16x32_bf16 a[88:91], a[12:15], a[168:171], a[88:91]
    s_add_u32 s35, s35, 0x4000
    ds_read_b64_tr_b16 a[54:55], v47 offset:58368
    s_mov_b32 m0, s34
    v_mfma_f32_16x16x32_bf16 a[92:95], a[12:15], a[172:175], a[92:95]
    buffer_load_dwordx4 v1, s[16:19], s32 offen offset:0 sc1 lds
    ds_read_b64_tr_b16 a[56:57], v48 offset:57344
    v_mfma_f32_16x16x32_bf16 v[224:227], a[16:19], a[160:163], v[224:227]
    v_mfma_f32_16x16x32_bf16 v[228:231], a[16:19], a[164:167], v[228:231]
    buffer_load_dwordx4 v1, s[16:19], s32 offen offset:1024 sc1 lds
    ds_read_b64_tr_b16 a[58:59], v48 offset:58368
    v_mfma_f32_16x16x32_bf16 a[96:99], a[16:19], a[168:171], a[96:99]
    ds_read_b64_tr_b16 a[60:61], v49 offset:57344
    v_mfma_f32_16x16x32_bf16 a[100:103], a[16:19], a[172:175], a[100:103]
    v_mfma_f32_16x16x32_bf16 v[232:235], a[20:23], a[160:163], v[232:235]
    buffer_load_dwordx4 v1, s[16:19], s32 offen offset:2048 sc1 lds
    ds_read_b64_tr_b16 a[62:63], v49 offset:58368
    v_mfma_f32_16x16x32_bf16 v[236:239], a[20:23], a[164:167], v[236:239]
    v_mfma_f32_16x16x32_bf16 a[104:107], a[20:23], a[168:171], a[104:107]
    v_mfma_f32_16x16x32_bf16 a[108:111], a[20:23], a[172:175], a[108:111]
    v_mfma_f32_16x16x32_bf16 v[240:243], a[24:27], a[160:163], v[240:243]
    buffer_load_dwordx4 v1, s[16:19], s32 offen offset:3072 sc1 lds
    v_mfma_f32_16x16x32_bf16 v[244:247], a[24:27], a[164:167], v[244:247]
    v_mfma_f32_16x16x32_bf16 a[112:115], a[24:27], a[168:171], a[112:115]
    s_add_u32 s32, s32, 0x80000
    v_mfma_f32_16x16x32_bf16 a[116:119], a[24:27], a[172:175], a[116:119]
    s_add_u32 s34, s34, 0x4000
    v_mfma_f32_16x16x32_bf16 v[248:251], a[28:31], a[160:163], v[248:251]
    v_mfma_f32_16x16x32_bf16 v[252:255], a[28:31], a[164:167], v[252:255]
    v_mfma_f32_16x16x32_bf16 a[120:123], a[28:31], a[168:171], a[120:123]
    v_mfma_f32_16x16x32_bf16 a[124:127], a[28:31], a[172:175], a[124:127]
    s_waitcnt vmcnt(17) lgkmcnt(0)
    s_barrier
    v_mfma_f32_16x16x32_bf16 v[192:195], a[32:35], a[176:179], v[192:195]
    v_mfma_f32_16x16x32_bf16 v[196:199], a[32:35], a[180:183], v[196:199]
    s_mov_b32 m0, s35
    v_mfma_f32_16x16x32_bf16 a[64:67], a[32:35], a[184:187], a[64:67]
    buffer_load_dwordx4 v1, s[20:23], s33 offen offset:0 sc1 lds
    v_mfma_f32_16x16x32_bf16 a[68:71], a[32:35], a[188:191], a[68:71]
    v_mfma_f32_16x16x32_bf16 v[200:203], a[36:39], a[176:179], v[200:203]
    v_mfma_f32_16x16x32_bf16 v[204:207], a[36:39], a[180:183], v[204:207]
    v_mfma_f32_16x16x32_bf16 a[72:75], a[36:39], a[184:187], a[72:75]
    v_mfma_f32_16x16x32_bf16 a[76:79], a[36:39], a[188:191], a[76:79]
    buffer_load_dwordx4 v1, s[20:23], s33 offen offset:1024 sc1 lds
    v_mfma_f32_16x16x32_bf16 v[208:211], a[40:43], a[176:179], v[208:211]
    v_mfma_f32_16x16x32_bf16 v[212:215], a[40:43], a[180:183], v[212:215]
    v_mfma_f32_16x16x32_bf16 a[80:83], a[40:43], a[184:187], a[80:83]
    v_mfma_f32_16x16x32_bf16 a[84:87], a[40:43], a[188:191], a[84:87]
    v_mfma_f32_16x16x32_bf16 v[216:219], a[44:47], a[176:179], v[216:219]
    v_mfma_f32_16x16x32_bf16 v[220:223], a[44:47], a[180:183], v[220:223]
    v_mfma_f32_16x16x32_bf16 a[88:91], a[44:47], a[184:187], a[88:91]
    buffer_load_dwordx4 v1, s[20:23], s33 offen offset:2048 sc1 lds
    v_mfma_f32_16x16x32_bf16 a[92:95], a[44:47], a[188:191], a[92:95]
    v_mfma_f32_16x16x32_bf16 v[224:227], a[48:51], a[176:179], v[224:227]
    v_mfma_f32_16x16x32_bf16 v[228:231], a[48:51], a[180:183], v[228:231]
    v_mfma_f32_16x16x32_bf16 a[96:99], a[48:51], a[184:187], a[96:99]
    v_mfma_f32_16x16x32_bf16 a[100:103], a[48:51], a[188:191], a[100:103]
    v_mfma_f32_16x16x32_bf16 v[232:235], a[52:55], a[176:179], v[232:235]
    buffer_load_dwordx4 v1, s[20:23], s33 offen offset:3072 sc1 lds
    v_mfma_f32_16x16x32_bf16 v[236:239], a[52:55], a[180:183], v[236:239]
    v_mfma_f32_16x16x32_bf16 a[104:107], a[52:55], a[184:187], a[104:107]
    v_mfma_f32_16x16x32_bf16 a[108:111], a[52:55], a[188:191], a[108:111]
    v_mfma_f32_16x16x32_bf16 v[240:243], a[56:59], a[176:179], v[240:243]
    v_mfma_f32_16x16x32_bf16 v[244:247], a[56:59], a[180:183], v[244:247]
    v_mfma_f32_16x16x32_bf16 a[112:115], a[56:59], a[184:187], a[112:115]
    s_add_u32 s33, s33, 0x80000
    v_mfma_f32_16x16x32_bf16 a[116:119], a[56:59], a[188:191], a[116:119]
    s_add_u32 s35, s35, 0x4000
    v_mfma_f32_16x16x32_bf16 v[248:251], a[60:63], a[176:179], v[248:251]
    v_mfma_f32_16x16x32_bf16 v[252:255], a[60:63], a[180:183], v[252:255]
    v_mfma_f32_16x16x32_bf16 a[120:123], a[60:63], a[184:187], a[120:123]
    v_mfma_f32_16x16x32_bf16 a[124:127], a[60:63], a[188:191], a[124:127]
    s_add_u32 s3, s54, 64
    s_add_u32 s5, s55, 64
    s_mov_b32 s63, s57
    s_load_dwordx2 s[44:45], s[0:1], 40
    s_load_dwordx2 s[46:47], s[0:1], 64
    s_load_dwordx4 s[48:51], s[0:1], 72
    s_mov_b32 s40, 0x3e0293ee
    s_mov_b32 s41, 0x3e0293ee
    s_mov_b32 m0, s34
    s_nop 0
    buffer_load_dwordx4 v1, s[16:19], s32 offen offset:0 sc1 lds
    buffer_load_dwordx4 v1, s[16:19], s32 offen offset:1024 sc1 lds
    buffer_load_dwordx4 v1, s[16:19], s32 offen offset:2048 sc1 lds
    buffer_load_dwordx4 v1, s[16:19], s32 offen offset:3072 sc1 lds
    s_mov_b32 m0, s35
    s_nop 0
    buffer_load_dwordx4 v1, s[20:23], s33 offen offset:0 sc1 lds
    buffer_load_dwordx4 v1, s[20:23], s33 offen offset:1024 sc1 lds
    buffer_load_dwordx4 v1, s[20:23], s33 offen offset:2048 sc1 lds
    buffer_load_dwordx4 v1, s[20:23], s33 offen offset:3072 sc1 lds
    s_add_u32 s32, s32, 0x80000
    s_add_u32 s33, s33, 0x80000
    s_add_u32 s34, s34, 0x4000
    s_and_b32 s34, s34, 0xffff
    s_add_u32 s35, s35, 0x4000
    s_and_b32 s35, s35, 0xffff
    s_or_b32 s35, s35, 0x10000
    v_mov_b32 v2, v1
    v_or_b32 v3, 0x10000, v1
    v_mov_b32 v56, v3
    s_mov_b32 s52, 0x4000
    s_mov_b32 s53, 0
    s_lshl_b32 s62, s28, 6
    s_mul_i32 s31, s29, s29
    s_add_u32 s62, s62, s31
    s_lshr_b32 s31, s30, 1
    s_lshl_b32 s4, s31, 23
    s_add_u32 s4, s4, 0x6000000
    s_add_u32 s8, s6, s4
    s_addc_u32 s9, s7, 0
    s_and_b32 s9, s9, 0xffff
    s_mov_b32 s10, 0
    s_mov_b32 s58, 0
    s_mov_b32 s14, 0x700000
    s_mov_b32 s59, 0x700000
    s_lshl_b32 s54, s62, 12
    s_waitcnt vmcnt(16) lgkmcnt(0)
    s_barrier
    s_cmp_eq_u32 s63, 0
    s_cbranch_scc1 k12_ool_68
k12_oolret_69:
    v_mov_b32 v59, 0
    ds_read_b128 a[128:131], v2 offset:0
    ds_read_b128 a[132:135], v2 offset:1024
    ds_read_b128 a[136:139], v2 offset:2048
    ds_read_b128 a[140:143], v2 offset:3072
    ds_read_b128 a[144:147], v2 offset:4096
    ds_read_b128 a[148:151], v2 offset:5120
    ds_read_b128 a[152:155], v2 offset:6144
    ds_read_b128 a[156:159], v2 offset:7168
    ds_read_b128 a[160:163], v2 offset:8192
    ds_read_b128 a[164:167], v2 offset:9216
    ds_read_b128 a[168:171], v2 offset:10240
    ds_read_b128 a[172:175], v2 offset:11264
    ds_read_b128 a[176:179], v2 offset:12288
    ds_read_b128 a[180:183], v2 offset:13312
    ds_read_b128 a[184:187], v2 offset:14336
    ds_read_b128 a[188:191], v2 offset:15360
    s_cmp_lt_u32 s30, 2
    s_cselect_b64 s[12:13], s[46:47], s[48:49]
    s_cselect_b64 s[60:61], s[44:45], s[50:51]
    s_cselect_b32 s55, 0x800000, s14
    s_and_b32 s13, s13, 0xffff
    v_accvgpr_read_b32 v128, a64
    v_accvgpr_read_b32 v129, a65
    v_accvgpr_read_b32 v130, a66
    v_accvgpr_read_b32 v131, a67
    v_pk_mul_f32 v[128:129], v[128:129], s[40:41]
    v_pk_mul_f32 v[130:131], v[130:131], s[40:41]
    v_cvt_pk_bf16_f32 v96, v128, v129
    v_cvt_pk_bf16_f32 v97, v130, v131
    v_accvgpr_read_b32 v132, a72
    v_accvgpr_read_b32 v133, a73
    v_accvgpr_read_b32 v134, a74
    v_accvgpr_read_b32 v135, a75
    v_pk_mul_f32 v[132:133], v[132:133], s[40:41]
    v_pk_mul_f32 v[134:135], v[134:135], s[40:41]
    v_cvt_pk_bf16_f32 v98, v132, v133
    v_cvt_pk_bf16_f32 v99, v134, v135
    v_accvgpr_read_b32 v136, a80
    v_accvgpr_read_b32 v137, a81
    v_accvgpr_read_b32 v138, a82
    v_accvgpr_read_b32 v139, a83
    v_pk_mul_f32 v[136:137], v[136:137], s[40:41]
    v_pk_mul_f32 v[138:139], v[138:139], s[40:41]
    v_cvt_pk_bf16_f32 v100, v136, v137
    v_cvt_pk_bf16_f32 v101, v138, v139
    v_accvgpr_read_b32 v140, a88
    v_accvgpr_read_b32 v141, a89
    v_accvgpr_read_b32 v142, a90
    v_accvgpr_read_b32 v143, a91
    v_pk_mul_f32 v[140:141], v[140:141], s[40:41]
    v_pk_mul_f32 v[142:143], v[142:143], s[40:41]
    v_cvt_pk_bf16_f32 v102, v140, v141
    v_cvt_pk_bf16_f32 v103, v142, v143
    v_accvgpr_read_b32 v128, a96
    v_accvgpr_read_b32 v129, a97
    v_accvgpr_read_b32 v130, a98
    v_accvgpr_read_b32 v131, a99
    v_pk_mul_f32 v[128:129], v[128:129], s[40:41]
    v_pk_mul_f32 v[130:131], v[130:131], s[40:41]
    v_cvt_pk_bf16_f32 v104, v128, v129
    v_cvt_pk_bf16_f32 v105, v130, v131
    v_accvgpr_read_b32 v132, a104
    v_accvgpr_read_b32 v133, a105
    v_accvgpr_read_b32 v134, a106
    v_accvgpr_read_b32 v135, a107
    v_pk_mul_f32 v[132:133], v[132:133], s[40:41]
    v_pk_mul_f32 v[134:135], v[134:135], s[40:41]
    v_cvt_pk_bf16_f32 v106, v132, v133
    v_cvt_pk_bf16_f32 v107, v134, v135
    v_accvgpr_read_b32 v136, a112
    v_accvgpr_read_b32 v137, a113
    v_accvgpr_read_b32 v138, a114
    v_accvgpr_read_b32 v139, a115
    v_pk_mul_f32 v[136:137], v[136:137], s[40:41]
    v_pk_mul_f32 v[138:139], v[138:139], s[40:41]
    v_cvt_pk_bf16_f32 v108, v136, v137
    v_cvt_pk_bf16_f32 v109, v138, v139
    v_accvgpr_read_b32 v140, a120
    v_accvgpr_read_b32 v141, a121
    v_accvgpr_read_b32 v142, a122
    v_accvgpr_read_b32 v143, a123
    v_pk_mul_f32 v[140:141], v[140:141], s[40:41]
    v_pk_mul_f32 v[142:143], v[142:143], s[40:41]
    v_cvt_pk_bf16_f32 v110, v140, v141
    v_cvt_pk_bf16_f32 v111, v142, v143
    v_accvgpr_read_b32 v128, a68
    v_accvgpr_read_b32 v129, a69
    v_accvgpr_read_b32 v130, a70
    v_accvgpr_read_b32 v131, a71
    v_pk_mul_f32 v[128:129], v[128:129], s[40:41]
    v_pk_mul_f32 v[130:131], v[130:131], s[40:41]
    v_cvt_pk_bf16_f32 v112, v128, v129
    v_cvt_pk_bf16_f32 v113, v130, v131
    v_accvgpr_read_b32 v132, a76
    v_accvgpr_read_b32 v133, a77
    v_accvgpr_read_b32 v134, a78
    v_accvgpr_read_b32 v135, a79
    v_pk_mul_f32 v[132:133], v[132:133], s[40:41]
    v_pk_mul_f32 v[134:135], v[134:135], s[40:41]
    v_cvt_pk_bf16_f32 v114, v132, v133
    v_cvt_pk_bf16_f32 v115, v134, v135
    v_accvgpr_read_b32 v136, a84
    v_accvgpr_read_b32 v137, a85
    v_accvgpr_read_b32 v138, a86
    v_accvgpr_read_b32 v139, a87
    v_pk_mul_f32 v[136:137], v[136:137], s[40:41]
    v_pk_mul_f32 v[138:139], v[138:139], s[40:41]
    v_cvt_pk_bf16_f32 v116, v136, v137
    v_cvt_pk_bf16_f32 v117, v138, v139
    v_accvgpr_read_b32 v140, a92
    v_accvgpr_read_b32 v141, a93
    v_accvgpr_read_b32 v142, a94
    v_accvgpr_read_b32 v143, a95
    v_pk_mul_f32 v[140:141], v[140:141], s[40:41]
    v_pk_mul_f32 v[142:143], v[142:143], s[40:41]
    v_cvt_pk_bf16_f32 v118, v140, v141
    v_cvt_pk_bf16_f32 v119, v142, v143
    v_accvgpr_read_b32 v128, a100
    v_accvgpr_read_b32 v129, a101
    v_accvgpr_read_b32 v130, a102
    v_accvgpr_read_b32 v131, a103
    v_pk_mul_f32 v[128:129], v[128:129], s[40:41]
    v_pk_mul_f32 v[130:131], v[130:131], s[40:41]
    v_cvt_pk_bf16_f32 v120, v128, v129
    v_cvt_pk_bf16_f32 v121, v130, v131
    v_accvgpr_read_b32 v132, a108
    v_accvgpr_read_b32 v133, a109
    v_accvgpr_read_b32 v134, a110
    v_accvgpr_read_b32 v135, a111
    v_pk_mul_f32 v[132:133], v[132:133], s[40:41]
    v_pk_mul_f32 v[134:135], v[134:135], s[40:41]
    v_cvt_pk_bf16_f32 v122, v132, v133
    v_cvt_pk_bf16_f32 v123, v134, v135
    v_accvgpr_read_b32 v136, a116
    v_accvgpr_read_b32 v137, a117
    v_accvgpr_read_b32 v138, a118
    v_accvgpr_read_b32 v139, a119
    v_pk_mul_f32 v[136:137], v[136:137], s[40:41]
    v_pk_mul_f32 v[138:139], v[138:139], s[40:41]
    v_cvt_pk_bf16_f32 v124, v136, v137
    v_cvt_pk_bf16_f32 v125, v138, v139
    v_accvgpr_read_b32 v140, a124
    v_accvgpr_read_b32 v141, a125
    v_accvgpr_read_b32 v142, a126
    v_accvgpr_read_b32 v143, a127
    v_pk_mul_f32 v[140:141], v[140:141], s[40:41]
    v_pk_mul_f32 v[142:143], v[142:143], s[40:41]
    v_cvt_pk_bf16_f32 v126, v140, v141
    v_cvt_pk_bf16_f32 v127, v142, v143
    v_pk_mul_f32 v[192:193], v[192:193], s[40:41]
    v_pk_mul_f32 v[194:195], v[194:195], s[40:41]
    v_cvt_pk_bf16_f32 v64, v192, v193
    v_cvt_pk_bf16_f32 v65, v194, v195
    v_pk_mul_f32 v[200:201], v[200:201], s[40:41]
    v_pk_mul_f32 v[202:203], v[202:203], s[40:41]
    v_cvt_pk_bf16_f32 v66, v200, v201
    v_cvt_pk_bf16_f32 v67, v202, v203
    v_pk_mul_f32 v[208:209], v[208:209], s[40:41]
    v_pk_mul_f32 v[210:211], v[210:211], s[40:41]
    v_cvt_pk_bf16_f32 v68, v208, v209
    v_cvt_pk_bf16_f32 v69, v210, v211
    v_pk_mul_f32 v[216:217], v[216:217], s[40:41]
    v_pk_mul_f32 v[218:219], v[218:219], s[40:41]
    v_cvt_pk_bf16_f32 v70, v216, v217
    v_cvt_pk_bf16_f32 v71, v218, v219
    v_pk_mul_f32 v[224:225], v[224:225], s[40:41]
    v_pk_mul_f32 v[226:227], v[226:227], s[40:41]
    v_cvt_pk_bf16_f32 v72, v224, v225
    v_cvt_pk_bf16_f32 v73, v226, v227
    v_pk_mul_f32 v[232:233], v[232:233], s[40:41]
    v_pk_mul_f32 v[234:235], v[234:235], s[40:41]
    v_cvt_pk_bf16_f32 v74, v232, v233
    v_cvt_pk_bf16_f32 v75, v234, v235
    v_pk_mul_f32 v[240:241], v[240:241], s[40:41]
    v_pk_mul_f32 v[242:243], v[242:243], s[40:41]
    v_cvt_pk_bf16_f32 v76, v240, v241
    v_cvt_pk_bf16_f32 v77, v242, v243
    v_pk_mul_f32 v[248:249], v[248:249], s[40:41]
    v_pk_mul_f32 v[250:251], v[250:251], s[40:41]
    v_cvt_pk_bf16_f32 v78, v248, v249
    v_cvt_pk_bf16_f32 v79, v250, v251
    v_pk_mul_f32 v[196:197], v[196:197], s[40:41]
    v_pk_mul_f32 v[198:199], v[198:199], s[40:41]
    v_cvt_pk_bf16_f32 v80, v196, v197
    v_cvt_pk_bf16_f32 v81, v198, v199
    v_pk_mul_f32 v[204:205], v[204:205], s[40:41]
    v_pk_mul_f32 v[206:207], v[206:207], s[40:41]
    v_cvt_pk_bf16_f32 v82, v204, v205
    v_cvt_pk_bf16_f32 v83, v206, v207
    v_pk_mul_f32 v[212:213], v[212:213], s[40:41]
    v_pk_mul_f32 v[214:215], v[214:215], s[40:41]
    v_cvt_pk_bf16_f32 v84, v212, v213
    v_cvt_pk_bf16_f32 v85, v214, v215
    v_pk_mul_f32 v[220:221], v[220:221], s[40:41]
    v_pk_mul_f32 v[222:223], v[222:223], s[40:41]
    v_cvt_pk_bf16_f32 v86, v220, v221
    v_cvt_pk_bf16_f32 v87, v222, v223
    v_pk_mul_f32 v[228:229], v[228:229], s[40:41]
    v_pk_mul_f32 v[230:231], v[230:231], s[40:41]
    v_cvt_pk_bf16_f32 v88, v228, v229
    v_cvt_pk_bf16_f32 v89, v230, v231
    v_pk_mul_f32 v[236:237], v[236:237], s[40:41]
    v_pk_mul_f32 v[238:239], v[238:239], s[40:41]
    v_cvt_pk_bf16_f32 v90, v236, v237
    v_cvt_pk_bf16_f32 v91, v238, v239
    v_pk_mul_f32 v[244:245], v[244:245], s[40:41]
    v_pk_mul_f32 v[246:247], v[246:247], s[40:41]
    v_cvt_pk_bf16_f32 v92, v244, v245
    v_cvt_pk_bf16_f32 v93, v246, v247
    v_pk_mul_f32 v[252:253], v[252:253], s[40:41]
    v_pk_mul_f32 v[254:255], v[254:255], s[40:41]
    v_cvt_pk_bf16_f32 v94, v252, v253
    v_cvt_pk_bf16_f32 v95, v254, v255
    v_add_u32 v2, 0x4000, v1
    v_mov_b32 v8, 0
    v_mov_b32 v232, 0
    v_mov_b32 v9, 0
    v_mov_b32 v233, 0
    v_mov_b32 v10, 0
    v_mov_b32 v234, 0
    v_mov_b32 v11, 0
    v_mov_b32 v235, 0
    s_mov_b32 s36, 0
    s_mov_b32 s37, 0x40004000
    v_mfma_f32_32x32x16_bf16 v[16:31], v[232:235], v[232:235], 0
    v_mfma_f32_32x32x16_bf16 v[32:47], v[232:235], v[232:235], 0
    v_and_b32 v6, 0xf0, v1
    v_cmp_eq_u32 vcc, 0, v6
    v_mov_b32 v6, 0x3f803f80
    v_lshrrev_b32 v229, 7, v1
    s_and_b32 s4, s30, 1
    s_lshl_b32 s31, s4, 11
    v_lshl_add_u32 v230, v1, 1, s31
    v_lshl_add_u32 v229, s4, 4, v229
    v_mul_u32_u24 v228, 7168, v229
    v_and_b32 v7, 0x70, v1
    v_add_u32 v228, v228, v7
    v_lshlrev_b32 v229, 5, v229
    v_and_b32 v57, 0x10, v1
    v_add_u32 v229, v229, v57
    v_lshrrev_b32 v7, 5, v7
    v_lshl_add_u32 v229, v7, 15, v229
    v_cndmask_b32 v60, 0, v6, vcc
    v_cndmask_b32 v61, 0, v6, vcc
    v_cndmask_b32 v62, 0, v6, vcc
    v_cndmask_b32 v63, 0, v6, vcc
    v_mov_b32 v12, 0
    v_mov_b32 v13, 0
    v_mov_b32 v14, 0
    v_mov_b32 v15, 0
    v_mov_b32 v48, 0
    v_mov_b32 v49, 0
    v_mov_b32 v50, 0
    v_mov_b32 v51, 0
    v_mov_b32 v248, 0
    v_mov_b32 v249, 0
    v_mov_b32 v250, 0
    v_mov_b32 v251, 0
    v_mov_b32 v252, 0
    v_mov_b32 v253, 0
    v_mov_b32 v254, 0
    v_mov_b32 v255, 0
    s_waitcnt lgkmcnt(0)
    s_cmp_ge_u32 s36, s42
    s_cbranch_scc1 k2_prep_70
k2_prepret_71:
    v_mfma_f32_16x16x32_bf16 v[128:131], a[128:131], v[64:67], v[16:19]
    v_mfma_f32_16x16x32_bf16 v[132:135], a[128:131], v[80:83], v[20:23]
    v_mfma_f32_16x16x32_bf16 v[136:139], a[128:131], v[96:99], v[24:27]
    v_mfma_f32_16x16x32_bf16 v[140:143], a[128:131], v[112:115], v[28:31]
    s_add_u32 s36, s36, 32
    v_mfma_f32_16x16x32_bf16 v[128:131], a[132:135], v[68:71], v[128:131]
    v_mfma_f32_16x16x32_bf16 v[132:135], a[132:135], v[84:87], v[132:135]
    v_mfma_f32_16x16x32_bf16 v[136:139], a[132:135], v[100:103], v[136:139]
    v_mfma_f32_16x16x32_bf16 v[140:143], a[132:135], v[116:119], v[140:143]
    v_mfma_f32_16x16x32_bf16 v[128:131], a[136:139], v[72:75], v[128:131]
    v_mfma_f32_16x16x32_bf16 v[132:135], a[136:139], v[88:91], v[132:135]
    v_mfma_f32_16x16x32_bf16 v[136:139], a[136:139], v[104:107], v[136:139]
    v_mfma_f32_16x16x32_bf16 v[140:143], a[136:139], v[120:123], v[140:143]
    v_mfma_f32_16x16x32_bf16 v[128:131], a[140:143], v[76:79], v[128:131]
    v_mfma_f32_16x16x32_bf16 v[132:135], a[140:143], v[92:95], v[132:135]
    v_mfma_f32_16x16x32_bf16 v[136:139], a[140:143], v[108:111], v[136:139]
    v_mfma_f32_16x16x32_bf16 v[140:143], a[140:143], v[124:127], v[140:143]
    v_mfma_f32_16x16x32_bf16 v[144:147], a[144:147], v[64:67], v[32:35]
    v_mfma_f32_16x16x32_bf16 v[148:151], a[144:147], v[80:83], v[36:39]
    v_mfma_f32_16x16x32_bf16 v[152:155], a[144:147], v[96:99], v[40:43]
    v_mfma_f32_16x16x32_bf16 v[156:159], a[144:147], v[112:115], v[44:47]
    v_mfma_f32_16x16x32_bf16 v[144:147], a[148:151], v[68:71], v[144:147]
    v_mfma_f32_16x16x32_bf16 v[148:151], a[148:151], v[84:87], v[148:151]
    v_mfma_f32_16x16x32_bf16 v[152:155], a[148:151], v[100:103], v[152:155]
    v_mfma_f32_16x16x32_bf16 v[156:159], a[148:151], v[116:119], v[156:159]
    v_mfma_f32_16x16x32_bf16 v[144:147], a[152:155], v[72:75], v[144:147]
    v_mfma_f32_16x16x32_bf16 v[148:151], a[152:155], v[88:91], v[148:151]
    v_mfma_f32_16x16x32_bf16 v[152:155], a[152:155], v[104:107], v[152:155]
    v_mfma_f32_16x16x32_bf16 v[156:159], a[152:155], v[120:123], v[156:159]
    v_mfma_f32_16x16x32_bf16 v[144:147], a[156:159], v[76:79], v[144:147]
    v_mfma_f32_16x16x32_bf16 v[148:151], a[156:159], v[92:95], v[148:151]
    v_mfma_f32_16x16x32_bf16 v[152:155], a[156:159], v[108:111], v[152:155]
    v_mfma_f32_16x16x32_bf16 v[156:159], a[156:159], v[124:127], v[156:159]
    v_mfma_f32_32x32x16_bf16 a[0:15], v[232:235], v[232:235], 0
    v_mfma_f32_32x32x16_bf16 a[16:31], v[232:235], v[232:235], 0
    v_mfma_f32_32x32x16_bf16 a[32:47], v[232:235], v[232:235], 0
    v_mfma_f32_32x32x16_bf16 a[48:63], v[232:235], v[232:235], 0
    v_mfma_f32_32x32x16_bf16 a[64:79], v[232:235], v[232:235], 0
    v_mfma_f32_32x32x16_bf16 a[80:95], v[232:235], v[232:235], 0
    v_mfma_f32_32x32x16_bf16 a[96:111], v[232:235], v[232:235], 0
    v_mfma_f32_32x32x16_bf16 a[112:127], v[232:235], v[232:235], 0
    v_max_f32 v52, v128, v129
    v_max3_f32 v52, v52, v130, v131
    v_max3_f32 v52, v52, v144, v145
    v_max3_f32 v52, v52, v146, v147
    v_max_f32 v53, v132, v133
    v_max3_f32 v53, v53, v134, v135
    v_max3_f32 v53, v53, v148, v149
    v_max3_f32 v53, v53, v150, v151
    v_max_f32 v54, v136, v137
    v_max3_f32 v54, v54, v138, v139
    v_max3_f32 v54, v54, v152, v153
    v_max3_f32 v54, v54, v154, v155
    v_max_f32 v55, v140, v141
    v_max3_f32 v55, v55, v142, v143
    v_max3_f32 v55, v55, v156, v157
    v_max3_f32 v55, v55, v158, v159
    v_mov_b32 v224, v52
    v_mov_b32 v225, v53
    v_mov_b32 v226, v54
    v_mov_b32 v227, v55
    s_nop 1
    v_permlane16_swap_b32 v52, v224
    v_permlane16_swap_b32 v53, v225
    v_permlane16_swap_b32 v54, v226
    v_permlane16_swap_b32 v55, v227
    s_nop 1
    v_max_f32 v52, v52, v224
    v_max_f32 v53, v53, v225
    v_max_f32 v54, v54, v226
    v_max_f32 v55, v55, v227
    v_mov_b32 v224, v52
    v_mov_b32 v225, v53
    v_mov_b32 v226, v54
    v_mov_b32 v227, v55
    s_nop 1
    v_permlane32_swap_b32 v52, v224
    v_permlane32_swap_b32 v53, v225
    v_permlane32_swap_b32 v54, v226
    v_permlane32_swap_b32 v55, v227
    s_nop 1
    v_max_f32 v52, v52, v224
    v_max_f32 v53, v53, v225
    v_max_f32 v54, v54, v226
    v_max_f32 v55, v55, v227
    v_add_f32 v52, 0x41400000, v52
    v_add_f32 v53, 0x41400000, v53
    v_add_f32 v54, 0x41400000, v54
    v_add_f32 v55, 0x41400000, v55
    v_sub_f32 v16, 0, v52
    v_sub_f32 v17, 0, v52
    v_sub_f32 v18, 0, v52
    v_sub_f32 v19, 0, v52
    v_sub_f32 v20, 0, v53
    v_sub_f32 v21, 0, v53
    v_sub_f32 v22, 0, v53
    v_sub_f32 v23, 0, v53
    v_sub_f32 v24, 0, v54
    v_sub_f32 v25, 0, v54
    v_sub_f32 v26, 0, v54
    v_sub_f32 v27, 0, v54
    v_sub_f32 v28, 0, v55
    v_sub_f32 v29, 0, v55
    v_sub_f32 v30, 0, v55
    v_sub_f32 v31, 0, v55
    v_sub_f32 v32, 0, v52
    v_sub_f32 v33, 0, v52
    v_sub_f32 v34, 0, v52
    v_sub_f32 v35, 0, v52
    v_sub_f32 v36, 0, v53
    v_sub_f32 v37, 0, v53
    v_sub_f32 v38, 0, v53
    v_sub_f32 v39, 0, v53
    v_sub_f32 v40, 0, v54
    v_sub_f32 v41, 0, v54
    v_sub_f32 v42, 0, v54
    v_sub_f32 v43, 0, v54
    v_sub_f32 v44, 0, v55
    v_sub_f32 v45, 0, v55
    v_sub_f32 v46, 0, v55
    v_sub_f32 v47, 0, v55
    v_sub_f32 v8, 0, v52
    v_sub_f32 v9, 0, v53
    v_sub_f32 v10, 0, v54
    v_sub_f32 v11, 0, v55
    s_cmp_ge_u32 s36, s42
    s_cbranch_scc1 k2_prep_78
k2_prepret_79:
    v_mfma_f32_16x16x32_bf16 v[160:163], a[160:163], v[64:67], v[16:19]
    v_sub_f32 v128, v128, v52
    v_sub_f32 v129, v129, v52
    v_sub_f32 v130, v130, v52
    v_mfma_f32_16x16x32_bf16 v[164:167], a[160:163], v[80:83], v[20:23]
    v_exp_f32 v232, v128
    v_sub_f32 v131, v131, v52
    v_mfma_f32_16x16x32_bf16 v[168:171], a[160:163], v[96:99], v[24:27]
    v_exp_f32 v233, v129
    v_sub_f32 v144, v144, v52
    v_mfma_f32_16x16x32_bf16 v[172:175], a[160:163], v[112:115], v[28:31]
    s_add_u32 s36, s36, 32
    s_cmp_eq_u32 s30, 0
    s_cbranch_scc1 k12_ool_72
k12_oolret_73:
    v_sub_f32 v145, v145, v52
    v_mfma_f32_16x16x32_bf16 v[160:163], a[164:167], v[68:71], v[160:163]
    v_exp_f32 v234, v130
    v_cvt_pk_bf16_f32 v192, v232, v233
    v_mfma_f32_16x16x32_bf16 v[164:167], a[164:167], v[84:87], v[164:167]
    v_exp_f32 v235, v131
    v_sub_f32 v146, v146, v52
    v_mfma_f32_16x16x32_bf16 v[168:171], a[164:167], v[100:103], v[168:171]
    v_exp_f32 v236, v144
    v_sub_f32 v147, v147, v52
    v_mfma_f32_16x16x32_bf16 v[172:175], a[164:167], v[116:119], v[172:175]
    v_cvt_pk_bf16_f32 v193, v234, v235
    v_exp_f32 v237, v145
    v_mfma_f32_16x16x32_bf16 v[160:163], a[168:171], v[72:75], v[160:163]
    v_exp_f32 v238, v146
    v_sub_f32 v132, v132, v53
    v_mfma_f32_16x16x32_bf16 v[164:167], a[168:171], v[88:91], v[164:167]
    v_sub_f32 v133, v133, v53
    v_cvt_pk_bf16_f32 v194, v236, v237
    v_or3_b32 v57, v192, v193, v194
    v_mfma_f32_16x16x32_bf16 v[168:171], a[168:171], v[104:107], v[168:171]
    v_exp_f32 v239, v147
    v_sub_f32 v134, v134, v53
    v_mfma_f32_16x16x32_bf16 v[172:175], a[168:171], v[120:123], v[172:175]
    v_exp_f32 v240, v132
    v_sub_f32 v135, v135, v53
    v_mfma_f32_16x16x32_bf16 v[160:163], a[172:175], v[76:79], v[160:163]
    v_cvt_pk_bf16_f32 v195, v238, v239
    v_exp_f32 v241, v133
    v_mfma_f32_16x16x32_bf16 v[164:167], a[172:175], v[92:95], v[164:167]
    v_exp_f32 v242, v134
    v_sub_f32 v148, v148, v53
    v_mfma_f32_16x16x32_bf16 v[168:171], a[172:175], v[108:111], v[168:171]
    v_sub_f32 v149, v149, v53
    v_cvt_pk_bf16_f32 v196, v240, v241
    v_exp_f32 v243, v135
    v_mfma_f32_16x16x32_bf16 v[172:175], a[172:175], v[124:127], v[172:175]
    v_or3_b32 v57, v57, v195, v196
    v_exp_f32 v244, v148
    v_mfma_f32_16x16x32_bf16 v[176:179], a[176:179], v[64:67], v[32:35]
    v_sub_f32 v150, v150, v53
    v_sub_f32 v151, v151, v53
    v_cvt_pk_bf16_f32 v197, v242, v243
    v_mfma_f32_16x16x32_bf16 v[180:183], a[176:179], v[80:83], v[36:39]
    v_exp_f32 v245, v149
    v_exp_f32 v246, v150
    v_mfma_f32_16x16x32_bf16 v[184:187], a[176:179], v[96:99], v[40:43]
    v_sub_f32 v136, v136, v54
    v_sub_f32 v137, v137, v54
    v_cvt_pk_bf16_f32 v198, v244, v245
    v_mfma_f32_16x16x32_bf16 v[188:191], a[176:179], v[112:115], v[44:47]
    v_exp_f32 v247, v151
    v_or3_b32 v57, v57, v197, v198
    v_mfma_f32_16x16x32_bf16 v[176:179], a[180:183], v[68:71], v[176:179]
    v_exp_f32 v232, v136
    v_sub_f32 v138, v138, v54
    v_mfma_f32_16x16x32_bf16 v[180:183], a[180:183], v[84:87], v[180:183]
    ds_read_b128 a[192:195], v3 offset:0
    v_sub_f32 v139, v139, v54
    v_cvt_pk_bf16_f32 v199, v246, v247
    v_mfma_f32_16x16x32_bf16 v[184:187], a[180:183], v[100:103], v[184:187]
    v_exp_f32 v233, v137
    v_exp_f32 v234, v138
    v_mfma_f32_16x16x32_bf16 v[188:191], a[180:183], v[116:119], v[188:191]
    v_sub_f32 v152, v152, v54
    v_sub_f32 v153, v153, v54
    v_cvt_pk_bf16_f32 v200, v232, v233
    v_mfma_f32_16x16x32_bf16 v[176:179], a[184:187], v[72:75], v[176:179]
    v_exp_f32 v235, v139
    v_or3_b32 v57, v57, v199, v200
    v_mfma_f32_16x16x32_bf16 v[180:183], a[184:187], v[88:91], v[180:183]
    v_exp_f32 v236, v152
    v_sub_f32 v154, v154, v54
    v_mfma_f32_16x16x32_bf16 v[184:187], a[184:187], v[104:107], v[184:187]
    v_sub_f32 v155, v155, v54
    v_cvt_pk_bf16_f32 v201, v234, v235
    v_exp_f32 v237, v153
    v_mfma_f32_16x16x32_bf16 v[188:191], a[184:187], v[120:123], v[188:191]
    ds_read_b128 a[196:199], v3 offset:1024
    v_exp_f32 v238, v154
    v_mfma_f32_16x16x32_bf16 v[176:179], a[188:191], v[76:79], v[176:179]
    v_sub_f32 v140, v140, v55
    v_sub_f32 v141, v141, v55
    v_cvt_pk_bf16_f32 v202, v236, v237
    v_mfma_f32_16x16x32_bf16 v[180:183], a[188:191], v[92:95], v[180:183]
    v_exp_f32 v239, v155
    v_or3_b32 v57, v57, v201, v202
    v_mfma_f32_16x16x32_bf16 v[184:187], a[188:191], v[108:111], v[184:187]
    s_cmp_eq_u32 s30, 0
    s_cbranch_scc1 k12_ool_76
k12_oolret_77:
    v_exp_f32 v240, v140
    v_mfma_f32_16x16x32_bf16 v[188:191], a[188:191], v[124:127], v[188:191]
    s_waitcnt vmcnt(8)
    s_barrier
    v_sub_f32 v142, v142, v55
    v_sub_f32 v143, v143, v55
    v_cvt_pk_bf16_f32 v203, v238, v239
    v_exp_f32 v241, v141
    v_exp_f32 v242, v142
    v_sub_f32 v156, v156, v55
    v_sub_f32 v157, v157, v55
    ds_read_b128 a[200:203], v3 offset:2048
    v_cvt_pk_bf16_f32 v204, v240, v241
    v_exp_f32 v243, v143
    v_or3_b32 v57, v57, v203, v204
    v_exp_f32 v244, v156
    v_sub_f32 v158, v158, v55
    v_sub_f32 v159, v159, v55
    v_cvt_pk_bf16_f32 v205, v242, v243
    v_exp_f32 v245, v157
    v_exp_f32 v246, v158
    v_cvt_pk_bf16_f32 v206, v244, v245
    ds_read_b128 a[204:207], v3 offset:3072
    v_exp_f32 v247, v159
    v_or3_b32 v57, v57, v205, v206
    v_cvt_pk_bf16_f32 v207, v246, v247
    v_bitop3_b32 v57, v57, v207, s37 bitop3:0xa8
    v_cmp_ne_u32 vcc, 0, v57
    s_cbranch_vccnz k2_tramp_80
k2_ret_81:
    s_mov_b32 s24, s60
    s_and_b32 s25, s61, 0xffff
    s_mov_b32 s26, s55
    s_lshl_b32 s63, s29, 1
    s_sub_u32 s63, s63, 1
    s_cbranch_scc1 k2_dm3_83
k2_dloop_82:
    v_mfma_f32_16x16x32_bf16 v[12:15], v[60:63], v[192:195], v[12:15]
    v_exp_f32 v232, v160
    v_mfma_f32_16x16x32_bf16 v[48:51], v[60:63], v[196:199], v[48:51]
    s_mov_b32 m0, s34
    ds_read_b128 a[208:211], v3 offset:4096
    v_mfma_f32_16x16x32_bf16 v[248:251], v[60:63], v[200:203], v[248:251]
    s_add_u32 s53, s53, 8192
    buffer_load_dwordx4 v1, s[16:19], s32 offen offset:0 sc1 lds
    v_mfma_f32_16x16x32_bf16 v[252:255], v[60:63], v[204:207], v[252:255]
    s_waitcnt lgkmcnt(3)
    v_exp_f32 v233, v161
    v_mfma_f32_16x16x32_bf16 a[0:3], a[192:195], v[192:195], a[0:3]
    s_and_b32 s53, s53, 0xffff
    v_exp_f32 v234, v162
    v_mfma_f32_16x16x32_bf16 a[4:7], a[192:195], v[196:199], a[4:7]
    s_add_u32 s34, s34, 0x4000
    ds_read_b128 a[212:215], v3 offset:5120
    v_cvt_pk_bf16_f32 v208, v232, v233
    v_mfma_f32_16x16x32_bf16 a[8:11], a[192:195], v[200:203], a[8:11]
    v_exp_f32 v235, v163
    v_mfma_f32_16x16x32_bf16 a[12:15], a[192:195], v[204:207], a[12:15]
    buffer_load_dwordx4 v1, s[16:19], s32 offen offset:1024 sc1 lds
    v_mfma_f32_16x16x32_bf16 a[16:19], a[196:199], v[192:195], a[16:19]
    v_exp_f32 v236, v176
    v_mfma_f32_16x16x32_bf16 a[20:23], a[196:199], v[196:199], a[20:23]
    ds_read_b128 a[216:219], v3 offset:6144
    v_cvt_pk_bf16_f32 v209, v234, v235
    v_mfma_f32_16x16x32_bf16 a[24:27], a[196:199], v[200:203], a[24:27]
    v_exp_f32 v237, v177
    v_mfma_f32_16x16x32_bf16 a[28:31], a[196:199], v[204:207], a[28:31]
    s_waitcnt lgkmcnt(3)
    v_exp_f32 v238, v178
    v_mfma_f32_16x16x32_bf16 a[32:35], a[200:203], v[192:195], a[32:35]
    s_and_b32 s34, s34, 0xffff
    ds_read_b128 a[220:223], v3 offset:7168
    v_cvt_pk_bf16_f32 v210, v236, v237
    v_mfma_f32_16x16x32_bf16 a[36:39], a[200:203], v[196:199], a[36:39]
    s_and_b32 s60, s62, 31
    buffer_load_dwordx4 v1, s[16:19], s32 offen offset:2048 sc1 lds
    v_mfma_f32_16x16x32_bf16 a[40:43], a[200:203], v[200:203], a[40:43]
    v_exp_f32 v239, v179
    v_mfma_f32_16x16x32_bf16 a[44:47], a[200:203], v[204:207], a[44:47]
    s_lshr_b32 s61, s62, 5
    v_or3_b32 v57, v208, v209, v210
    v_add_u32 v3, s53, v56
    v_mfma_f32_16x16x32_bf16 a[48:51], a[204:207], v[192:195], a[48:51]
    v_exp_f32 v240, v164
    v_mfma_f32_16x16x32_bf16 a[52:55], a[204:207], v[196:199], a[52:55]
    ds_read_b128 a[128:131], v2 offset:0
    v_cvt_pk_bf16_f32 v211, v238, v239
    v_mfma_f32_16x16x32_bf16 a[56:59], a[204:207], v[200:203], a[56:59]
    s_mul_i32 s57, s60, 229376
    v_exp_f32 v241, v165
    v_mfma_f32_16x16x32_bf16 a[60:63], a[204:207], v[204:207], a[60:63]
    s_waitcnt lgkmcnt(3)
    buffer_load_dwordx4 v1, s[16:19], s32 offen offset:3072 sc1 lds
    v_mfma_f32_16x16x32_bf16 a[64:67], a[208:211], v[192:195], a[64:67]
    s_add_u32 s32, s32, 0x80000
    v_exp_f32 v242, v166
    v_mfma_f32_16x16x32_bf16 a[68:71], a[208:211], v[196:199], a[68:71]
    s_lshl_b32 s4, s61, 7
    ds_read_b128 a[132:135], v2 offset:1024
    v_cvt_pk_bf16_f32 v212, v240, v241
    v_mfma_f32_16x16x32_bf16 a[72:75], a[208:211], v[200:203], a[72:75]
    v_exp_f32 v243, v167
    v_mfma_f32_16x16x32_bf16 a[76:79], a[208:211], v[204:207], a[76:79]
    s_add_u32 s57, s57, s4
    v_or3_b32 v57, v57, v211, v212
    v_cvt_pk_bf16_f32 v213, v242, v243
    v_mfma_f32_16x16x32_bf16 a[80:83], a[212:215], v[192:195], a[80:83]
    s_waitcnt vmcnt(8)
    v_exp_f32 v244, v180
    v_mfma_f32_16x16x32_bf16 a[84:87], a[212:215], v[196:199], a[84:87]
    buffer_store_dwordx4 a[224:227], v229, s[8:11], s58 offen offset:0 sc1
    ds_read_b128 a[136:139], v2 offset:2048
    v_mfma_f32_16x16x32_bf16 a[88:91], a[212:215], v[200:203], a[88:91]
    s_add_u32 s56, s57, 57344
    v_exp_f32 v245, v181
    v_mfma_f32_16x16x32_bf16 a[92:95], a[212:215], v[204:207], a[92:95]
    s_waitcnt lgkmcnt(3)
    v_exp_f32 v246, v182
    v_mfma_f32_16x16x32_bf16 a[96:99], a[216:219], v[192:195], a[96:99]
    ds_read_b128 a[140:143], v2 offset:3072
    v_cvt_pk_bf16_f32 v214, v244, v245
    v_mfma_f32_16x16x32_bf16 a[100:103], a[216:219], v[196:199], a[100:103]
    s_add_u32 s62, s62, 1
    v_exp_f32 v247, v183
    v_mfma_f32_16x16x32_bf16 a[104:107], a[216:219], v[200:203], a[104:107]
    v_or3_b32 v57, v57, v213, v214
    v_mfma_f32_16x16x32_bf16 a[108:111], a[216:219], v[204:207], a[108:111]
    v_exp_f32 v232, v168
    v_mfma_f32_16x16x32_bf16 a[112:115], a[220:223], v[192:195], a[112:115]
    ds_read_b128 a[144:147], v2 offset:4096
    v_cvt_pk_bf16_f32 v215, v246, v247
    v_mfma_f32_16x16x32_bf16 a[116:119], a[220:223], v[196:199], a[116:119]
    buffer_store_dwordx4 a[228:231], v229, s[8:11], s58 offen offset:256 sc1
    v_mfma_f32_16x16x32_bf16 a[120:123], a[220:223], v[200:203], a[120:123]
    v_exp_f32 v233, v169
    v_mfma_f32_16x16x32_bf16 a[124:127], a[220:223], v[204:207], a[124:127]
    s_waitcnt lgkmcnt(3)
    v_exp_f32 v234, v170
    v_mfma_f32_16x16x32_bf16 v[128:131], a[128:131], v[64:67], v[16:19]
    ds_read_b128 a[148:151], v2 offset:5120
    v_cvt_pk_bf16_f32 v216, v232, v233
    v_mfma_f32_16x16x32_bf16 v[132:135], a[128:131], v[80:83], v[20:23]
    v_exp_f32 v235, v171
    v_mfma_f32_16x16x32_bf16 v[136:139], a[128:131], v[96:99], v[24:27]
    v_or3_b32 v57, v57, v215, v216
    v_mfma_f32_16x16x32_bf16 v[140:143], a[128:131], v[112:115], v[28:31]
    s_add_u32 s36, s36, 32
    v_exp_f32 v236, v184
    v_mfma_f32_16x16x32_bf16 v[128:131], a[132:135], v[68:71], v[128:131]
    ds_read_b128 a[152:155], v2 offset:6144
    v_cvt_pk_bf16_f32 v217, v234, v235
    v_mfma_f32_16x16x32_bf16 v[132:135], a[132:135], v[84:87], v[132:135]
    s_lshl_b32 s58, s61, 17
    buffer_load_dwordx4 a[224:227], v228, s[12:15], s57 offen
    v_mfma_f32_16x16x32_bf16 v[136:139], a[132:135], v[100:103], v[136:139]
    s_add_u32 s52, s52, 8192
    v_exp_f32 v237, v185
    v_mfma_f32_16x16x32_bf16 v[140:143], a[132:135], v[116:119], v[140:143]
    s_waitcnt lgkmcnt(3)
    v_exp_f32 v238, v186
    v_mfma_f32_16x16x32_bf16 v[128:131], a[136:139], v[72:75], v[128:131]
    s_lshl_b32 s60, s60, 10
    ds_read_b128 a[156:159], v2 offset:7168
    v_cvt_pk_bf16_f32 v218, v236, v237
    v_mfma_f32_16x16x32_bf16 v[132:135], a[136:139], v[88:91], v[132:135]
    s_and_b32 s52, s52, 0xffff
    v_exp_f32 v239, v187
    v_mfma_f32_16x16x32_bf16 v[136:139], a[136:139], v[104:107], v[136:139]
    v_or3_b32 v57, v57, v217, v218
    v_mfma_f32_16x16x32_bf16 v[140:143], a[136:139], v[120:123], v[140:143]
    v_add_u32 v2, s52, v1
    v_cvt_pk_bf16_f32 v219, v238, v239
    v_mfma_f32_16x16x32_bf16 v[128:131], a[140:143], v[76:79], v[128:131]
    s_add_u32 s58, s58, s60
    v_exp_f32 v240, v172
    v_mfma_f32_16x16x32_bf16 v[132:135], a[140:143], v[92:95], v[132:135]
    buffer_load_dwordx4 a[228:231], v228, s[12:15], s56 offen
    v_mfma_f32_16x16x32_bf16 v[136:139], a[140:143], v[108:111], v[136:139]
    v_exp_f32 v241, v173
    v_mfma_f32_16x16x32_bf16 v[140:143], a[140:143], v[124:127], v[140:143]
    s_waitcnt lgkmcnt(2)
    ds_read_b128 a[192:195], v3 offset:0
    v_cvt_pk_bf16_f32 v220, v240, v241
    v_mfma_f32_16x16x32_bf16 v[144:147], a[144:147], v[64:67], v[32:35]
    s_mov_b32 s10, s59
    v_exp_f32 v242, v174
    v_mfma_f32_16x16x32_bf16 v[148:151], a[144:147], v[80:83], v[36:39]
    v_exp_f32 v243, v175
    v_mfma_f32_16x16x32_bf16 v[152:155], a[144:147], v[96:99], v[40:43]
    ds_read_b128 a[196:199], v3 offset:1024
    v_or3_b32 v57, v57, v219, v220
    v_mfma_f32_16x16x32_bf16 v[156:159], a[144:147], v[112:115], v[44:47]
    v_exp_f32 v244, v188
    v_mfma_f32_16x16x32_bf16 v[144:147], a[148:151], v[68:71], v[144:147]
    v_cvt_pk_bf16_f32 v221, v242, v243
    v_mfma_f32_16x16x32_bf16 v[148:151], a[148:151], v[84:87], v[148:151]
    buffer_load_dword v7, v230, s[24:27], s54 offen
    v_mfma_f32_16x16x32_bf16 v[152:155], a[148:151], v[100:103], v[152:155]
    v_exp_f32 v245, v189
    v_mfma_f32_16x16x32_bf16 v[156:159], a[148:151], v[116:119], v[156:159]
    s_waitcnt lgkmcnt(2)
    ds_read_b128 a[200:203], v3 offset:2048
    v_cvt_pk_bf16_f32 v222, v244, v245
    v_mfma_f32_16x16x32_bf16 v[144:147], a[152:155], v[72:75], v[144:147]
    v_exp_f32 v246, v190
    v_mfma_f32_16x16x32_bf16 v[148:151], a[152:155], v[88:91], v[148:151]
    v_exp_f32 v247, v191
    v_mfma_f32_16x16x32_bf16 v[152:155], a[152:155], v[104:107], v[152:155]
    ds_read_b128 a[204:207], v3 offset:3072
    v_or3_b32 v57, v57, v221, v222
    v_mfma_f32_16x16x32_bf16 v[156:159], a[152:155], v[120:123], v[156:159]
    v_cvt_pk_bf16_f32 v223, v246, v247
    v_mfma_f32_16x16x32_bf16 v[144:147], a[156:159], v[76:79], v[144:147]
    s_add_u32 s54, s54, 4096
    v_mfma_f32_16x16x32_bf16 v[148:151], a[156:159], v[92:95], v[148:151]
    v_bitop3_b32 v57, v57, v223, s37 bitop3:0xa8
    v_cmp_ne_u32 vcc, 0, v57
    v_mfma_f32_16x16x32_bf16 v[152:155], a[156:159], v[108:111], v[152:155]
    v_mfma_f32_16x16x32_bf16 v[156:159], a[156:159], v[124:127], v[156:159]
    s_cbranch_vccnz k2_tramp_84
k2_ret_85:
    v_mfma_f32_16x16x32_bf16 v[12:15], v[60:63], v[208:211], v[12:15]
    v_exp_f32 v232, v128
    v_mfma_f32_16x16x32_bf16 v[48:51], v[60:63], v[212:215], v[48:51]
    s_mov_b32 m0, s35
    ds_read_b128 a[208:211], v3 offset:4096
    v_mfma_f32_16x16x32_bf16 v[248:251], v[60:63], v[216:219], v[248:251]
    s_add_u32 s53, s53, 8192
    buffer_load_dwordx4 v1, s[20:23], s33 offen offset:0 sc1 lds
    v_mfma_f32_16x16x32_bf16 v[252:255], v[60:63], v[220:223], v[252:255]
    s_waitcnt lgkmcnt(3)
    v_exp_f32 v233, v129
    v_mfma_f32_16x16x32_bf16 a[0:3], a[192:195], v[208:211], a[0:3]
    s_and_b32 s53, s53, 0xffff
    v_exp_f32 v234, v130
    v_mfma_f32_16x16x32_bf16 a[4:7], a[192:195], v[212:215], a[4:7]
    ds_read_b128 a[212:215], v3 offset:5120
    v_cvt_pk_bf16_f32 v192, v232, v233
    v_mfma_f32_16x16x32_bf16 a[8:11], a[192:195], v[216:219], a[8:11]
    v_exp_f32 v235, v131
    v_mfma_f32_16x16x32_bf16 a[12:15], a[192:195], v[220:223], a[12:15]
    v_exp_f32 v236, v144
    v_mfma_f32_16x16x32_bf16 a[16:19], a[196:199], v[208:211], a[16:19]
    ds_read_b128 a[216:219], v3 offset:6144
    v_cvt_pk_bf16_f32 v193, v234, v235
    v_mfma_f32_16x16x32_bf16 a[20:23], a[196:199], v[212:215], a[20:23]
    v_exp_f32 v237, v145
    v_mfma_f32_16x16x32_bf16 a[24:27], a[196:199], v[216:219], a[24:27]
    v_mfma_f32_16x16x32_bf16 a[28:31], a[196:199], v[220:223], a[28:31]
    s_waitcnt lgkmcnt(3)
    v_exp_f32 v238, v146
    v_mfma_f32_16x16x32_bf16 a[32:35], a[200:203], v[208:211], a[32:35]
    ds_read_b128 a[220:223], v3 offset:7168
    v_cvt_pk_bf16_f32 v194, v236, v237
    v_mfma_f32_16x16x32_bf16 a[36:39], a[200:203], v[212:215], a[36:39]
    v_exp_f32 v239, v147
    v_mfma_f32_16x16x32_bf16 a[40:43], a[200:203], v[216:219], a[40:43]
    v_or3_b32 v57, v192, v193, v194
    v_mfma_f32_16x16x32_bf16 a[44:47], a[200:203], v[220:223], a[44:47]
    s_add_u32 s35, s35, 0x4000
    v_add_u32 v3, s53, v56
    v_cvt_pk_bf16_f32 v195, v238, v239
    v_mfma_f32_16x16x32_bf16 a[48:51], a[204:207], v[208:211], a[48:51]
    v_exp_f32 v240, v132
    v_mfma_f32_16x16x32_bf16 a[52:55], a[204:207], v[212:215], a[52:55]
    buffer_load_dwordx4 v1, s[20:23], s33 offen offset:1024 sc1 lds
    ds_read_b128 a[128:131], v2 offset:0
    v_mfma_f32_16x16x32_bf16 a[56:59], a[204:207], v[216:219], a[56:59]
    v_exp_f32 v241, v133
    v_mfma_f32_16x16x32_bf16 a[60:63], a[204:207], v[220:223], a[60:63]
    s_waitcnt lgkmcnt(3)
    v_exp_f32 v242, v134
    v_mfma_f32_16x16x32_bf16 a[64:67], a[208:211], v[208:211], a[64:67]
    ds_read_b128 a[132:135], v2 offset:1024
    v_cvt_pk_bf16_f32 v196, v240, v241
    v_mfma_f32_16x16x32_bf16 a[68:71], a[208:211], v[212:215], a[68:71]
    v_exp_f32 v243, v135
    v_mfma_f32_16x16x32_bf16 a[72:75], a[208:211], v[216:219], a[72:75]
    v_or3_b32 v57, v57, v195, v196
    v_mfma_f32_16x16x32_bf16 a[76:79], a[208:211], v[220:223], a[76:79]
    v_exp_f32 v244, v148
    v_mfma_f32_16x16x32_bf16 a[80:83], a[212:215], v[208:211], a[80:83]
    ds_read_b128 a[136:139], v2 offset:2048
    v_cvt_pk_bf16_f32 v197, v242, v243
    v_mfma_f32_16x16x32_bf16 a[84:87], a[212:215], v[212:215], a[84:87]
    v_exp_f32 v245, v149
    v_mfma_f32_16x16x32_bf16 a[88:91], a[212:215], v[216:219], a[88:91]
    v_mfma_f32_16x16x32_bf16 a[92:95], a[212:215], v[220:223], a[92:95]
    s_waitcnt lgkmcnt(3)
    v_exp_f32 v246, v150
    v_mfma_f32_16x16x32_bf16 a[96:99], a[216:219], v[208:211], a[96:99]
    ds_read_b128 a[140:143], v2 offset:3072
    v_cvt_pk_bf16_f32 v198, v244, v245
    v_mfma_f32_16x16x32_bf16 a[100:103], a[216:219], v[212:215], a[100:103]
    v_exp_f32 v247, v151
    v_mfma_f32_16x16x32_bf16 a[104:107], a[216:219], v[216:219], a[104:107]
    v_or3_b32 v57, v57, v197, v198
    v_mfma_f32_16x16x32_bf16 a[108:111], a[216:219], v[220:223], a[108:111]
    s_and_b32 s35, s35, 0xffff
    v_exp_f32 v232, v136
    v_mfma_f32_16x16x32_bf16 a[112:115], a[220:223], v[208:211], a[112:115]
    ds_read_b128 a[144:147], v2 offset:4096
    v_cvt_pk_bf16_f32 v199, v246, v247
    v_mfma_f32_16x16x32_bf16 a[116:119], a[220:223], v[212:215], a[116:119]
    buffer_load_dwordx4 v1, s[20:23], s33 offen offset:2048 sc1 lds
    v_mfma_f32_16x16x32_bf16 a[120:123], a[220:223], v[216:219], a[120:123]
    v_exp_f32 v233, v137
    v_mfma_f32_16x16x32_bf16 a[124:127], a[220:223], v[220:223], a[124:127]
    s_waitcnt lgkmcnt(3)
    v_exp_f32 v234, v138
    v_mfma_f32_16x16x32_bf16 v[160:163], a[128:131], v[64:67], v[16:19]
    ds_read_b128 a[148:151], v2 offset:5120
    v_cvt_pk_bf16_f32 v200, v232, v233
    v_mfma_f32_16x16x32_bf16 v[164:167], a[128:131], v[80:83], v[20:23]
    v_exp_f32 v235, v139
    v_mfma_f32_16x16x32_bf16 v[168:171], a[128:131], v[96:99], v[24:27]
    v_or3_b32 v57, v57, v199, v200
    v_mfma_f32_16x16x32_bf16 v[172:175], a[128:131], v[112:115], v[28:31]
    s_or_b32 s35, s35, 0x10000
    v_exp_f32 v236, v152
    v_mfma_f32_16x16x32_bf16 v[160:163], a[132:135], v[68:71], v[160:163]
    s_add_u32 s36, s36, 32
    ds_read_b128 a[152:155], v2 offset:6144
    v_cvt_pk_bf16_f32 v201, v234, v235
    v_mfma_f32_16x16x32_bf16 v[164:167], a[132:135], v[84:87], v[164:167]
    v_exp_f32 v237, v153
    v_mfma_f32_16x16x32_bf16 v[168:171], a[132:135], v[100:103], v[168:171]
    s_add_u32 s52, s52, 8192
    v_mfma_f32_16x16x32_bf16 v[172:175], a[132:135], v[116:119], v[172:175]
    s_waitcnt lgkmcnt(3)
    v_exp_f32 v238, v154
    v_mfma_f32_16x16x32_bf16 v[160:163], a[136:139], v[72:75], v[160:163]
    s_and_b32 s52, s52, 0xffff
    ds_read_b128 a[156:159], v2 offset:7168
    v_cvt_pk_bf16_f32 v202, v236, v237
    v_mfma_f32_16x16x32_bf16 v[164:167], a[136:139], v[88:91], v[164:167]
    v_exp_f32 v239, v155
    v_mfma_f32_16x16x32_bf16 v[168:171], a[136:139], v[104:107], v[168:171]
    v_or3_b32 v57, v57, v201, v202
    v_mfma_f32_16x16x32_bf16 v[172:175], a[136:139], v[120:123], v[172:175]
    v_add_u32 v2, s52, v1
    v_cvt_pk_bf16_f32 v203, v238, v239
    v_mfma_f32_16x16x32_bf16 v[160:163], a[140:143], v[76:79], v[160:163]
    v_exp_f32 v240, v140
    v_mfma_f32_16x16x32_bf16 v[164:167], a[140:143], v[92:95], v[164:167]
    buffer_load_dwordx4 v1, s[20:23], s33 offen offset:3072 sc1 lds
    v_mfma_f32_16x16x32_bf16 v[168:171], a[140:143], v[108:111], v[168:171]
    s_add_u32 s33, s33, 0x80000
    v_exp_f32 v241, v141
    v_mfma_f32_16x16x32_bf16 v[172:175], a[140:143], v[124:127], v[172:175]
    s_waitcnt lgkmcnt(2)
    ds_read_b128 a[192:195], v3 offset:0
    v_cvt_pk_bf16_f32 v204, v240, v241
    v_mfma_f32_16x16x32_bf16 v[176:179], a[144:147], v[64:67], v[32:35]
    v_exp_f32 v242, v142
    v_mfma_f32_16x16x32_bf16 v[180:183], a[144:147], v[80:83], v[36:39]
    v_exp_f32 v243, v143
    v_mfma_f32_16x16x32_bf16 v[184:187], a[144:147], v[96:99], v[40:43]
    ds_read_b128 a[196:199], v3 offset:1024
    v_or3_b32 v57, v57, v203, v204
    v_mfma_f32_16x16x32_bf16 v[188:191], a[144:147], v[112:115], v[44:47]
    v_exp_f32 v244, v156
    v_mfma_f32_16x16x32_bf16 v[176:179], a[148:151], v[68:71], v[176:179]
    v_cvt_pk_bf16_f32 v205, v242, v243
    v_mfma_f32_16x16x32_bf16 v[180:183], a[148:151], v[84:87], v[180:183]
    v_exp_f32 v245, v157
    v_mfma_f32_16x16x32_bf16 v[184:187], a[148:151], v[100:103], v[184:187]
    ds_read_b128 a[200:203], v3 offset:2048
    v_mfma_f32_16x16x32_bf16 v[188:191], a[148:151], v[116:119], v[188:191]
    s_waitcnt lgkmcnt(3)
    v_exp_f32 v246, v158
    v_mfma_f32_16x16x32_bf16 v[176:179], a[152:155], v[72:75], v[176:179]
    s_sub_u32 s63, s63, 1
    v_cvt_pk_bf16_f32 v206, v244, v245
    v_mfma_f32_16x16x32_bf16 v[180:183], a[152:155], v[88:91], v[180:183]
    v_exp_f32 v247, v159
    v_mfma_f32_16x16x32_bf16 v[184:187], a[152:155], v[104:107], v[184:187]
    ds_read_b128 a[204:207], v3 offset:3072
    v_or3_b32 v57, v57, v205, v206
    v_mfma_f32_16x16x32_bf16 v[188:191], a[152:155], v[120:123], v[188:191]
    v_cvt_pk_bf16_f32 v207, v246, v247
    v_mfma_f32_16x16x32_bf16 v[176:179], a[156:159], v[76:79], v[176:179]
    v_mfma_f32_16x16x32_bf16 v[180:183], a[156:159], v[92:95], v[180:183]
    v_bitop3_b32 v57, v57, v207, s37 bitop3:0xa8
    v_cmp_ne_u32 vcc, 0, v57
    v_mfma_f32_16x16x32_bf16 v[184:187], a[156:159], v[108:111], v[184:187]
    v_mfma_f32_16x16x32_bf16 v[188:191], a[156:159], v[124:127], v[188:191]
    s_waitcnt vmcnt(13)
    s_barrier
    s_cbranch_vccnz k2_tramp_86
k2_ret_87:
    s_cmp_lg_u32 s63, 0
    s_cbranch_scc1 k2_dloop_82
    v_mfma_f32_16x16x32_bf16 v[12:15], v[60:63], v[192:195], v[12:15]
    v_exp_f32 v232, v160
    v_mfma_f32_16x16x32_bf16 v[48:51], v[60:63], v[196:199], v[48:51]
    s_mov_b32 m0, s34
    ds_read_b128 a[208:211], v3 offset:4096
    v_mfma_f32_16x16x32_bf16 v[248:251], v[60:63], v[200:203], v[248:251]
    s_add_u32 s53, s53, 8192
    buffer_load_dwordx4 v1, s[16:19], s32 offen offset:0 sc1 lds
    v_mfma_f32_16x16x32_bf16 v[252:255], v[60:63], v[204:207], v[252:255]
    s_waitcnt lgkmcnt(3)
    v_exp_f32 v233, v161
    v_mfma_f32_16x16x32_bf16 a[0:3], a[192:195], v[192:195], a[0:3]
    s_sub_u32 s40, s36, s38
    v_exp_f32 v234, v162
    v_mfma_f32_16x16x32_bf16 a[4:7], a[192:195], v[196:199], a[4:7]
    s_and_b32 s53, s53, 0xffff
    ds_read_b128 a[212:215], v3 offset:5120
    v_cvt_pk_bf16_f32 v208, v232, v233
    v_mfma_f32_16x16x32_bf16 a[8:11], a[192:195], v[200:203], a[8:11]
    s_add_u32 s34, s34, 0x4000
    v_subrev_u32 v6, s40, v4
    v_cmp_gt_i32 s[44:45], 0, v6
    v_mfma_f32_16x16x32_bf16 a[12:15], a[192:195], v[204:207], a[12:15]
    v_exp_f32 v235, v163
    v_mfma_f32_16x16x32_bf16 a[16:19], a[196:199], v[192:195], a[16:19]
    buffer_load_dwordx4 v1, s[16:19], s32 offen offset:1024 sc1 lds
    ds_read_b128 a[216:219], v3 offset:6144
    v_mfma_f32_16x16x32_bf16 a[20:23], a[196:199], v[196:199], a[20:23]
    v_exp_f32 v236, v176
    v_mfma_f32_16x16x32_bf16 a[24:27], a[196:199], v[200:203], a[24:27]
    v_cmp_gt_i32 s[46:47], 1, v6
    v_cvt_pk_bf16_f32 v209, v234, v235
    v_mfma_f32_16x16x32_bf16 a[28:31], a[196:199], v[204:207], a[28:31]
    s_waitcnt lgkmcnt(3)
    v_cmp_gt_i32 s[48:49], 2, v6
    v_cmp_gt_i32 s[50:51], 3, v6
    v_mfma_f32_16x16x32_bf16 a[32:35], a[200:203], v[192:195], a[32:35]
    s_and_b32 s34, s34, 0xffff
    v_exp_f32 v237, v177
    v_mfma_f32_16x16x32_bf16 a[36:39], a[200:203], v[196:199], a[36:39]
    s_and_b32 s60, s62, 31
    v_exp_f32 v238, v178
    v_mfma_f32_16x16x32_bf16 a[40:43], a[200:203], v[200:203], a[40:43]
    ds_read_b128 a[220:223], v3 offset:7168
    v_cvt_pk_bf16_f32 v210, v236, v237
    v_mfma_f32_16x16x32_bf16 a[44:47], a[200:203], v[204:207], a[44:47]
    s_lshr_b32 s61, s62, 5
    buffer_load_dwordx4 v1, s[16:19], s32 offen offset:2048 sc1 lds
    v_mfma_f32_16x16x32_bf16 a[48:51], a[204:207], v[192:195], a[48:51]
    v_cndmask_b32 v16, v8, v5, s[44:45]
    v_or3_b32 v57, v208, v209, v210
    v_mfma_f32_16x16x32_bf16 a[52:55], a[204:207], v[196:199], a[52:55]
    v_exp_f32 v239, v179
    v_mfma_f32_16x16x32_bf16 a[56:59], a[204:207], v[200:203], a[56:59]
    s_mul_i32 s57, s60, 229376
    v_cndmask_b32 v17, v8, v5, s[46:47]
    v_add_u32 v3, s53, v56
    v_mfma_f32_16x16x32_bf16 a[60:63], a[204:207], v[204:207], a[60:63]
    s_waitcnt lgkmcnt(2)
    v_exp_f32 v240, v164
    v_mfma_f32_16x16x32_bf16 a[64:67], a[208:211], v[192:195], a[64:67]
    v_cvt_pk_bf16_f32 v211, v238, v239
    v_cndmask_b32 v18, v8, v5, s[48:49]
    v_mfma_f32_16x16x32_bf16 a[68:71], a[208:211], v[196:199], a[68:71]
    s_lshl_b32 s4, s61, 7
    ds_read_b128 a[128:131], v2 offset:0
    v_cndmask_b32 v19, v8, v5, s[50:51]
    v_mfma_f32_16x16x32_bf16 a[72:75], a[208:211], v[200:203], a[72:75]
    v_exp_f32 v241, v165
    v_mfma_f32_16x16x32_bf16 a[76:79], a[208:211], v[204:207], a[76:79]
    s_add_u32 s57, s57, s4
    buffer_load_dwordx4 v1, s[16:19], s32 offen offset:3072 sc1 lds
    s_add_u32 s32, s32, 0x80000
    v_mfma_f32_16x16x32_bf16 a[80:83], a[212:215], v[192:195], a[80:83]
    s_waitcnt vmcnt(8)
    v_cmp_gt_i32 s[44:45], 16, v6
    v_exp_f32 v242, v166
    v_mfma_f32_16x16x32_bf16 a[84:87], a[212:215], v[196:199], a[84:87]
    ds_read_b128 a[132:135], v2 offset:1024
    v_cvt_pk_bf16_f32 v212, v240, v241
    v_mfma_f32_16x16x32_bf16 a[88:91], a[212:215], v[200:203], a[88:91]
    s_add_u32 s56, s57, 57344
    v_cmp_gt_i32 s[46:47], 17, v6
    v_exp_f32 v243, v167
    v_mfma_f32_16x16x32_bf16 a[92:95], a[212:215], v[204:207], a[92:95]
    s_waitcnt lgkmcnt(2)
    v_or3_b32 v57, v57, v211, v212
    v_cmp_gt_i32 s[48:49], 18, v6
    v_mfma_f32_16x16x32_bf16 a[96:99], a[216:219], v[192:195], a[96:99]
    v_exp_f32 v244, v180
    v_mfma_f32_16x16x32_bf16 a[100:103], a[216:219], v[196:199], a[100:103]
    s_add_u32 s62, s62, 1
    v_cvt_pk_bf16_f32 v213, v242, v243
    v_cmp_gt_i32 s[50:51], 19, v6
    v_mfma_f32_16x16x32_bf16 a[104:107], a[216:219], v[200:203], a[104:107]
    buffer_store_dwordx4 a[224:227], v229, s[8:11], s58 offen offset:0 sc1
    ds_read_b128 a[136:139], v2 offset:2048
    v_mfma_f32_16x16x32_bf16 a[108:111], a[216:219], v[204:207], a[108:111]
    v_exp_f32 v245, v181
    v_mfma_f32_16x16x32_bf16 a[112:115], a[220:223], v[192:195], a[112:115]
    v_cndmask_b32 v32, v8, v5, s[44:45]
    v_exp_f32 v246, v182
    v_mfma_f32_16x16x32_bf16 a[116:119], a[220:223], v[196:199], a[116:119]
    ds_read_b128 a[140:143], v2 offset:3072
    v_cndmask_b32 v33, v8, v5, s[46:47]
    v_cvt_pk_bf16_f32 v214, v244, v245
    v_cndmask_b32 v34, v8, v5, s[48:49]
    v_cndmask_b32 v35, v8, v5, s[50:51]
    v_mfma_f32_16x16x32_bf16 a[120:123], a[220:223], v[200:203], a[120:123]
    v_exp_f32 v247, v183
    v_mfma_f32_16x16x32_bf16 a[124:127], a[220:223], v[204:207], a[124:127]
    s_waitcnt lgkmcnt(2)
    v_or3_b32 v57, v57, v213, v214
    v_cvt_pk_bf16_f32 v215, v246, v247
    v_mfma_f32_16x16x32_bf16 v[128:131], a[128:131], v[64:67], v[16:19]
    v_exp_f32 v232, v168
    v_mfma_f32_16x16x32_bf16 v[132:135], a[128:131], v[80:83], v[20:23]
    buffer_store_dwordx4 a[228:231], v229, s[8:11], s58 offen offset:256 sc1
    ds_read_b128 a[144:147], v2 offset:4096
    v_mfma_f32_16x16x32_bf16 v[136:139], a[128:131], v[96:99], v[24:27]
    v_exp_f32 v233, v169
    v_mfma_f32_16x16x32_bf16 v[140:143], a[128:131], v[112:115], v[28:31]
    s_add_u32 s36, s36, 32
    v_exp_f32 v234, v170
    v_mfma_f32_16x16x32_bf16 v[128:131], a[132:135], v[68:71], v[128:131]
    ds_read_b128 a[148:151], v2 offset:5120
    v_cvt_pk_bf16_f32 v216, v232, v233
    v_mfma_f32_16x16x32_bf16 v[132:135], a[132:135], v[84:87], v[132:135]
    s_lshl_b32 s58, s61, 17
    v_exp_f32 v235, v171
    v_mfma_f32_16x16x32_bf16 v[136:139], a[132:135], v[100:103], v[136:139]
    s_add_u32 s52, s52, 8192
    v_or3_b32 v57, v57, v215, v216
    v_cvt_pk_bf16_f32 v217, v234, v235
    v_mfma_f32_16x16x32_bf16 v[140:143], a[132:135], v[116:119], v[140:143]
    s_waitcnt lgkmcnt(2)
    v_exp_f32 v236, v184
    v_mfma_f32_16x16x32_bf16 v[128:131], a[136:139], v[72:75], v[128:131]
    s_lshl_b32 s60, s60, 10
    buffer_load_dwordx4 a[224:227], v228, s[12:15], s57 offen
    ds_read_b128 a[152:155], v2 offset:6144
    v_mfma_f32_16x16x32_bf16 v[132:135], a[136:139], v[88:91], v[132:135]
    s_and_b32 s52, s52, 0xffff
    v_exp_f32 v237, v185
    v_mfma_f32_16x16x32_bf16 v[136:139], a[136:139], v[104:107], v[136:139]
    v_exp_f32 v238, v186
    v_mfma_f32_16x16x32_bf16 v[140:143], a[136:139], v[120:123], v[140:143]
    ds_read_b128 a[156:159], v2 offset:7168
    v_cvt_pk_bf16_f32 v218, v236, v237
    v_mfma_f32_16x16x32_bf16 v[128:131], a[140:143], v[76:79], v[128:131]
    s_add_u32 s58, s58, s60
    v_exp_f32 v239, v187
    v_mfma_f32_16x16x32_bf16 v[132:135], a[140:143], v[92:95], v[132:135]
    v_or3_b32 v57, v57, v217, v218
    v_add_u32 v2, s52, v1
    v_mfma_f32_16x16x32_bf16 v[136:139], a[140:143], v[108:111], v[136:139]
    v_exp_f32 v240, v172
    v_mfma_f32_16x16x32_bf16 v[140:143], a[140:143], v[124:127], v[140:143]
    s_waitcnt lgkmcnt(2)
    ds_read_b128 a[192:195], v3 offset:0
    v_cvt_pk_bf16_f32 v219, v238, v239
    v_mfma_f32_16x16x32_bf16 v[144:147], a[144:147], v[64:67], v[32:35]
    s_mov_b32 s10, s59
    buffer_load_dwordx4 a[228:231], v228, s[12:15], s56 offen
    v_mfma_f32_16x16x32_bf16 v[148:151], a[144:147], v[80:83], v[36:39]
    v_exp_f32 v241, v173
    v_mfma_f32_16x16x32_bf16 v[152:155], a[144:147], v[96:99], v[40:43]
    v_exp_f32 v242, v174
    v_mfma_f32_16x16x32_bf16 v[156:159], a[144:147], v[112:115], v[44:47]
    v_cvt_pk_bf16_f32 v220, v240, v241
    v_or3_b32 v57, v57, v219, v220
    v_mfma_f32_16x16x32_bf16 v[144:147], a[148:151], v[68:71], v[144:147]
    v_exp_f32 v243, v175
    v_mfma_f32_16x16x32_bf16 v[148:151], a[148:151], v[84:87], v[148:151]
    ds_read_b128 a[196:199], v3 offset:1024
    v_cvt_pk_bf16_f32 v221, v242, v243
    v_mfma_f32_16x16x32_bf16 v[152:155], a[148:151], v[100:103], v[152:155]
    v_exp_f32 v244, v188
    v_mfma_f32_16x16x32_bf16 v[156:159], a[148:151], v[116:119], v[156:159]
    s_waitcnt lgkmcnt(2)
    buffer_load_dword v7, v230, s[24:27], s54 offen
    ds_read_b128 a[200:203], v3 offset:2048
    v_mfma_f32_16x16x32_bf16 v[144:147], a[152:155], v[72:75], v[144:147]
    v_exp_f32 v245, v189
    v_mfma_f32_16x16x32_bf16 v[148:151], a[152:155], v[88:91], v[148:151]
    v_exp_f32 v246, v190
    v_mfma_f32_16x16x32_bf16 v[152:155], a[152:155], v[104:107], v[152:155]
    v_cvt_pk_bf16_f32 v222, v244, v245
    v_or3_b32 v57, v57, v221, v222
    v_mfma_f32_16x16x32_bf16 v[156:159], a[152:155], v[120:123], v[156:159]
    v_exp_f32 v247, v191
    v_mfma_f32_16x16x32_bf16 v[144:147], a[156:159], v[76:79], v[144:147]
    s_add_u32 s54, s54, 4096
    ds_read_b128 a[204:207], v3 offset:3072
    v_cvt_pk_bf16_f32 v223, v246, v247
    v_mfma_f32_16x16x32_bf16 v[148:151], a[156:159], v[92:95], v[148:151]
    v_bitop3_b32 v57, v57, v223, s37 bitop3:0xa8
    v_cmp_ne_u32 vcc, 0, v57
    v_mfma_f32_16x16x32_bf16 v[152:155], a[156:159], v[108:111], v[152:155]
    v_mfma_f32_16x16x32_bf16 v[156:159], a[156:159], v[124:127], v[156:159]
    s_cbranch_vccnz k2_tramp_88
k2_ret_89:
    v_mfma_f32_16x16x32_bf16 v[12:15], v[60:63], v[208:211], v[12:15]
    v_exp_f32 v232, v128
    v_mfma_f32_16x16x32_bf16 v[48:51], v[60:63], v[212:215], v[48:51]
    s_mov_b32 m0, s35
    ds_read_b128 a[208:211], v3 offset:4096
    v_mfma_f32_16x16x32_bf16 v[248:251], v[60:63], v[216:219], v[248:251]
    s_add_u32 s53, s53, 8192
    buffer_load_dwordx4 v1, s[20:23], s33 offen offset:0 sc1 lds
    v_mfma_f32_16x16x32_bf16 v[252:255], v[60:63], v[220:223], v[252:255]
    s_waitcnt lgkmcnt(3)
    v_exp_f32 v233, v129
    v_mfma_f32_16x16x32_bf16 a[0:3], a[192:195], v[208:211], a[0:3]
    s_sub_u32 s40, s36, s38
    v_exp_f32 v234, v130
    v_mfma_f32_16x16x32_bf16 a[4:7], a[192:195], v[212:215], a[4:7]
    s_and_b32 s53, s53, 0xffff
    ds_read_b128 a[212:215], v3 offset:5120
    v_cvt_pk_bf16_f32 v192, v232, v233
    v_mfma_f32_16x16x32_bf16 a[8:11], a[192:195], v[216:219], a[8:11]
    v_subrev_u32 v6, s40, v4
    v_cmp_gt_i32 s[44:45], 0, v6
    v_mfma_f32_16x16x32_bf16 a[12:15], a[192:195], v[220:223], a[12:15]
    v_exp_f32 v235, v131
    v_mfma_f32_16x16x32_bf16 a[16:19], a[196:199], v[208:211], a[16:19]
    v_exp_f32 v236, v144
    v_mfma_f32_16x16x32_bf16 a[20:23], a[196:199], v[212:215], a[20:23]
    v_cmp_gt_i32 s[46:47], 1, v6
    v_cvt_pk_bf16_f32 v193, v234, v235
    v_mfma_f32_16x16x32_bf16 a[24:27], a[196:199], v[216:219], a[24:27]
    ds_read_b128 a[216:219], v3 offset:6144
    v_cmp_gt_i32 s[48:49], 2, v6
    v_mfma_f32_16x16x32_bf16 a[28:31], a[196:199], v[220:223], a[28:31]
    s_waitcnt lgkmcnt(3)
    v_exp_f32 v237, v145
    v_mfma_f32_16x16x32_bf16 a[32:35], a[200:203], v[208:211], a[32:35]
    v_cmp_gt_i32 s[50:51], 3, v6
    v_cvt_pk_bf16_f32 v194, v236, v237
    v_mfma_f32_16x16x32_bf16 a[36:39], a[200:203], v[212:215], a[36:39]
    v_exp_f32 v238, v146
    v_mfma_f32_16x16x32_bf16 a[40:43], a[200:203], v[216:219], a[40:43]
    ds_read_b128 a[220:223], v3 offset:7168
    v_cndmask_b32 v16, v8, v5, s[44:45]
    v_mfma_f32_16x16x32_bf16 a[44:47], a[200:203], v[220:223], a[44:47]
    s_add_u32 s35, s35, 0x4000
    v_exp_f32 v239, v147
    v_mfma_f32_16x16x32_bf16 a[48:51], a[204:207], v[208:211], a[48:51]
    v_or3_b32 v57, v192, v193, v194
    v_cndmask_b32 v17, v8, v5, s[46:47]
    v_mfma_f32_16x16x32_bf16 a[52:55], a[204:207], v[212:215], a[52:55]
    v_add_u32 v3, s53, v56
    v_cvt_pk_bf16_f32 v195, v238, v239
    v_mfma_f32_16x16x32_bf16 a[56:59], a[204:207], v[216:219], a[56:59]
    v_exp_f32 v240, v132
    v_mfma_f32_16x16x32_bf16 a[60:63], a[204:207], v[220:223], a[60:63]
    s_waitcnt lgkmcnt(2)
    ds_read_b128 a[128:131], v2 offset:0
    v_cndmask_b32 v18, v8, v5, s[48:49]
    v_mfma_f32_16x16x32_bf16 a[64:67], a[208:211], v[208:211], a[64:67]
    buffer_load_dwordx4 v1, s[20:23], s33 offen offset:1024 sc1 lds
    ds_read_b128 a[132:135], v2 offset:1024
    v_mfma_f32_16x16x32_bf16 a[68:71], a[208:211], v[212:215], a[68:71]
    v_exp_f32 v241, v133
    v_mfma_f32_16x16x32_bf16 a[72:75], a[208:211], v[216:219], a[72:75]
    v_cndmask_b32 v19, v8, v5, s[50:51]
    v_cmp_gt_i32 s[44:45], 16, v6
    v_mfma_f32_16x16x32_bf16 a[76:79], a[208:211], v[220:223], a[76:79]
    v_exp_f32 v242, v134
    v_mfma_f32_16x16x32_bf16 a[80:83], a[212:215], v[208:211], a[80:83]
    v_cvt_pk_bf16_f32 v196, v240, v241
    v_cmp_gt_i32 s[46:47], 17, v6
    v_mfma_f32_16x16x32_bf16 a[84:87], a[212:215], v[212:215], a[84:87]
    v_exp_f32 v243, v135
    v_mfma_f32_16x16x32_bf16 a[88:91], a[212:215], v[216:219], a[88:91]
    v_or3_b32 v57, v57, v195, v196
    v_cmp_gt_i32 s[48:49], 18, v6
    v_mfma_f32_16x16x32_bf16 a[92:95], a[212:215], v[220:223], a[92:95]
    s_waitcnt lgkmcnt(2)
    v_exp_f32 v244, v148
    v_mfma_f32_16x16x32_bf16 a[96:99], a[216:219], v[208:211], a[96:99]
    v_cvt_pk_bf16_f32 v197, v242, v243
    v_cmp_gt_i32 s[50:51], 19, v6
    v_mfma_f32_16x16x32_bf16 a[100:103], a[216:219], v[212:215], a[100:103]
    ds_read_b128 a[136:139], v2 offset:2048
    v_cndmask_b32 v32, v8, v5, s[44:45]
    v_mfma_f32_16x16x32_bf16 a[104:107], a[216:219], v[216:219], a[104:107]
    v_exp_f32 v245, v149
    v_mfma_f32_16x16x32_bf16 a[108:111], a[216:219], v[220:223], a[108:111]
    s_and_b32 s35, s35, 0xffff
    v_exp_f32 v246, v150
    v_mfma_f32_16x16x32_bf16 a[112:115], a[220:223], v[208:211], a[112:115]
    v_cndmask_b32 v33, v8, v5, s[46:47]
    v_cvt_pk_bf16_f32 v198, v244, v245
    v_mfma_f32_16x16x32_bf16 a[116:119], a[220:223], v[212:215], a[116:119]
    ds_read_b128 a[140:143], v2 offset:3072
    v_cndmask_b32 v34, v8, v5, s[48:49]
    v_cndmask_b32 v35, v8, v5, s[50:51]
    v_mfma_f32_16x16x32_bf16 a[120:123], a[220:223], v[216:219], a[120:123]
    v_exp_f32 v247, v151
    v_mfma_f32_16x16x32_bf16 a[124:127], a[220:223], v[220:223], a[124:127]
    s_waitcnt lgkmcnt(2)
    v_or3_b32 v57, v57, v197, v198
    v_cvt_pk_bf16_f32 v199, v246, v247
    v_mfma_f32_16x16x32_bf16 v[160:163], a[128:131], v[64:67], v[16:19]
    v_exp_f32 v232, v136
    v_mfma_f32_16x16x32_bf16 v[164:167], a[128:131], v[80:83], v[20:23]
    buffer_load_dwordx4 v1, s[20:23], s33 offen offset:2048 sc1 lds
    ds_read_b128 a[144:147], v2 offset:4096
    v_mfma_f32_16x16x32_bf16 v[168:171], a[128:131], v[96:99], v[24:27]
    v_exp_f32 v233, v137
    v_mfma_f32_16x16x32_bf16 v[172:175], a[128:131], v[112:115], v[28:31]
    s_or_b32 s35, s35, 0x10000
    v_exp_f32 v234, v138
    v_mfma_f32_16x16x32_bf16 v[160:163], a[132:135], v[68:71], v[160:163]
    s_add_u32 s36, s36, 32
    ds_read_b128 a[148:151], v2 offset:5120
    v_cvt_pk_bf16_f32 v200, v232, v233
    v_mfma_f32_16x16x32_bf16 v[164:167], a[132:135], v[84:87], v[164:167]
    v_exp_f32 v235, v139
    v_mfma_f32_16x16x32_bf16 v[168:171], a[132:135], v[100:103], v[168:171]
    s_add_u32 s52, s52, 8192
    v_or3_b32 v57, v57, v199, v200
    v_cvt_pk_bf16_f32 v201, v234, v235
    v_mfma_f32_16x16x32_bf16 v[172:175], a[132:135], v[116:119], v[172:175]
    s_waitcnt lgkmcnt(2)
    v_exp_f32 v236, v152
    v_mfma_f32_16x16x32_bf16 v[160:163], a[136:139], v[72:75], v[160:163]
    s_and_b32 s52, s52, 0xffff
    ds_read_b128 a[152:155], v2 offset:6144
    ds_read_b128 a[156:159], v2 offset:7168
    v_mfma_f32_16x16x32_bf16 v[164:167], a[136:139], v[88:91], v[164:167]
    v_exp_f32 v237, v153
    v_mfma_f32_16x16x32_bf16 v[168:171], a[136:139], v[104:107], v[168:171]
    v_exp_f32 v238, v154
    v_mfma_f32_16x16x32_bf16 v[172:175], a[136:139], v[120:123], v[172:175]
    v_cvt_pk_bf16_f32 v202, v236, v237
    v_or3_b32 v57, v57, v201, v202
    v_mfma_f32_16x16x32_bf16 v[160:163], a[140:143], v[76:79], v[160:163]
    v_exp_f32 v239, v155
    v_mfma_f32_16x16x32_bf16 v[164:167], a[140:143], v[92:95], v[164:167]
    v_add_u32 v2, s52, v1
    v_cvt_pk_bf16_f32 v203, v238, v239
    v_mfma_f32_16x16x32_bf16 v[168:171], a[140:143], v[108:111], v[168:171]
    v_exp_f32 v240, v140
    v_mfma_f32_16x16x32_bf16 v[172:175], a[140:143], v[124:127], v[172:175]
    s_waitcnt lgkmcnt(2)
    buffer_load_dwordx4 v1, s[20:23], s33 offen offset:3072 sc1 lds
    s_add_u32 s33, s33, 0x80000
    v_mfma_f32_16x16x32_bf16 v[176:179], a[144:147], v[64:67], v[32:35]
    v_exp_f32 v241, v141
    v_mfma_f32_16x16x32_bf16 v[180:183], a[144:147], v[80:83], v[36:39]
    ds_read_b128 a[192:195], v3 offset:0
    v_cvt_pk_bf16_f32 v204, v240, v241
    v_mfma_f32_16x16x32_bf16 v[184:187], a[144:147], v[96:99], v[40:43]
    v_exp_f32 v242, v142
    v_mfma_f32_16x16x32_bf16 v[188:191], a[144:147], v[112:115], v[44:47]
    v_exp_f32 v243, v143
    v_mfma_f32_16x16x32_bf16 v[176:179], a[148:151], v[68:71], v[176:179]
    ds_read_b128 a[196:199], v3 offset:1024
    v_or3_b32 v57, v57, v203, v204
    v_mfma_f32_16x16x32_bf16 v[180:183], a[148:151], v[84:87], v[180:183]
    v_exp_f32 v244, v156
    v_mfma_f32_16x16x32_bf16 v[184:187], a[148:151], v[100:103], v[184:187]
    ds_read_b128 a[200:203], v3 offset:2048
    v_cvt_pk_bf16_f32 v205, v242, v243
    v_mfma_f32_16x16x32_bf16 v[188:191], a[148:151], v[116:119], v[188:191]
    s_waitcnt lgkmcnt(3)
    v_exp_f32 v245, v157
    v_mfma_f32_16x16x32_bf16 v[176:179], a[152:155], v[72:75], v[176:179]
    v_exp_f32 v246, v158
    v_mfma_f32_16x16x32_bf16 v[180:183], a[152:155], v[88:91], v[180:183]
    v_cvt_pk_bf16_f32 v206, v244, v245
    v_or3_b32 v57, v57, v205, v206
    v_mfma_f32_16x16x32_bf16 v[184:187], a[152:155], v[104:107], v[184:187]
    v_exp_f32 v247, v159
    v_mfma_f32_16x16x32_bf16 v[188:191], a[152:155], v[120:123], v[188:191]
    ds_read_b128 a[204:207], v3 offset:3072
    v_cvt_pk_bf16_f32 v207, v246, v247
    v_mfma_f32_16x16x32_bf16 v[176:179], a[156:159], v[76:79], v[176:179]
    v_mfma_f32_16x16x32_bf16 v[180:183], a[156:159], v[92:95], v[180:183]
    v_bitop3_b32 v57, v57, v207, s37 bitop3:0xa8
    v_cmp_ne_u32 vcc, 0, v57
    v_mfma_f32_16x16x32_bf16 v[184:187], a[156:159], v[108:111], v[184:187]
    v_mfma_f32_16x16x32_bf16 v[188:191], a[156:159], v[124:127], v[188:191]
    s_waitcnt vmcnt(13)
    s_barrier
    s_cbranch_vccnz k2_tramp_90
k2_ret_91:
k2_dm3_83:
    v_mfma_f32_16x16x32_bf16 v[12:15], v[60:63], v[192:195], v[12:15]
    v_exp_f32 v232, v160
    v_mfma_f32_16x16x32_bf16 v[48:51], v[60:63], v[196:199], v[48:51]
    s_mov_b32 m0, s34
    ds_read_b128 a[208:211], v3 offset:4096
    v_mfma_f32_16x16x32_bf16 v[248:251], v[60:63], v[200:203], v[248:251]
    s_add_u32 s53, s53, 8192
    v_exp_f32 v233, v161
    v_mfma_f32_16x16x32_bf16 v[252:255], v[60:63], v[204:207], v[252:255]
    s_waitcnt lgkmcnt(3)
    buffer_load_dwordx4 v1, s[16:19], s32 offen offset:0 sc1 lds
    v_mfma_f32_16x16x32_bf16 a[0:3], a[192:195], v[192:195], a[0:3]
    s_sub_u32 s40, s36, s38
    s_sub_u32 s40, s40, 64
    v_exp_f32 v234, v162
    v_cvt_pk_bf16_f32 v208, v232, v233
    v_mfma_f32_16x16x32_bf16 a[4:7], a[192:195], v[196:199], a[4:7]
    s_and_b32 s53, s53, 0xffff
    ds_read_b128 a[212:215], v3 offset:5120
    v_subrev_u32 v6, s40, v4
    v_mfma_f32_16x16x32_bf16 a[8:11], a[192:195], v[200:203], a[8:11]
    s_add_u32 s34, s34, 0x4000
    v_exp_f32 v235, v163
    v_cmp_gt_i32 s[44:45], 0, v6
    v_mfma_f32_16x16x32_bf16 a[12:15], a[192:195], v[204:207], a[12:15]
    v_exp_f32 v236, v176
    v_cvt_pk_bf16_f32 v209, v234, v235
    v_mfma_f32_16x16x32_bf16 a[16:19], a[196:199], v[192:195], a[16:19]
    buffer_load_dwordx4 v1, s[16:19], s32 offen offset:1024 sc1 lds
    ds_read_b128 a[216:219], v3 offset:6144
    v_mfma_f32_16x16x32_bf16 a[20:23], a[196:199], v[196:199], a[20:23]
    v_cmp_gt_i32 s[46:47], 1, v6
    v_exp_f32 v237, v177
    v_mfma_f32_16x16x32_bf16 a[24:27], a[196:199], v[200:203], a[24:27]
    v_cmp_gt_i32 s[48:49], 2, v6
    v_exp_f32 v238, v178
    v_mfma_f32_16x16x32_bf16 a[28:31], a[196:199], v[204:207], a[28:31]
    s_waitcnt lgkmcnt(3)
    v_cvt_pk_bf16_f32 v210, v236, v237
    v_cmp_gt_i32 s[50:51], 3, v6
    v_mfma_f32_16x16x32_bf16 a[32:35], a[200:203], v[192:195], a[32:35]
    s_and_b32 s34, s34, 0xffff
    v_exp_f32 v239, v179
    v_mfma_f32_16x16x32_bf16 a[36:39], a[200:203], v[196:199], a[36:39]
    s_and_b32 s60, s62, 31
    ds_read_b128 a[220:223], v3 offset:7168
    v_or3_b32 v57, v208, v209, v210
    v_cndmask_b32 v20, v9, v5, s[44:45]
    v_mfma_f32_16x16x32_bf16 a[40:43], a[200:203], v[200:203], a[40:43]
    buffer_load_dwordx4 v1, s[16:19], s32 offen offset:2048 sc1 lds
    v_mfma_f32_16x16x32_bf16 a[44:47], a[200:203], v[204:207], a[44:47]
    s_lshr_b32 s61, s62, 5
    v_exp_f32 v240, v164
    v_cvt_pk_bf16_f32 v211, v238, v239
    v_mfma_f32_16x16x32_bf16 a[48:51], a[204:207], v[192:195], a[48:51]
    v_cndmask_b32 v21, v9, v5, s[46:47]
    v_add_u32 v3, s53, v56
    v_mfma_f32_16x16x32_bf16 a[52:55], a[204:207], v[196:199], a[52:55]
    s_mul_i32 s57, s60, 229376
    v_exp_f32 v241, v165
    v_mfma_f32_16x16x32_bf16 a[56:59], a[204:207], v[200:203], a[56:59]
    ds_read_b128 a[128:131], v2 offset:0
    v_cndmask_b32 v22, v9, v5, s[48:49]
    v_cvt_pk_bf16_f32 v212, v240, v241
    v_mfma_f32_16x16x32_bf16 a[60:63], a[204:207], v[204:207], a[60:63]
    s_waitcnt lgkmcnt(3)
    v_exp_f32 v242, v166
    v_mfma_f32_16x16x32_bf16 a[64:67], a[208:211], v[192:195], a[64:67]
    s_lshl_b32 s4, s61, 7
    v_cndmask_b32 v23, v9, v5, s[50:51]
    v_or3_b32 v57, v57, v211, v212
    v_mfma_f32_16x16x32_bf16 a[68:71], a[208:211], v[196:199], a[68:71]
    buffer_load_dwordx4 v1, s[16:19], s32 offen offset:3072 sc1 lds
    ds_read_b128 a[132:135], v2 offset:1024
    s_add_u32 s32, s32, 0x80000
    v_mfma_f32_16x16x32_bf16 a[72:75], a[208:211], v[200:203], a[72:75]
    v_exp_f32 v243, v167
    v_mfma_f32_16x16x32_bf16 a[76:79], a[208:211], v[204:207], a[76:79]
    s_add_u32 s57, s57, s4
    v_cmp_gt_i32 s[44:45], 16, v6
    v_cvt_pk_bf16_f32 v213, v242, v243
    v_mfma_f32_16x16x32_bf16 a[80:83], a[212:215], v[192:195], a[80:83]
    s_waitcnt vmcnt(8)
    v_exp_f32 v244, v180
    v_mfma_f32_16x16x32_bf16 a[84:87], a[212:215], v[196:199], a[84:87]
    s_add_u32 s56, s57, 57344
    ds_read_b128 a[136:139], v2 offset:2048
    v_cmp_gt_i32 s[46:47], 17, v6
    v_mfma_f32_16x16x32_bf16 a[88:91], a[212:215], v[200:203], a[88:91]
    v_exp_f32 v245, v181
    v_cmp_gt_i32 s[48:49], 18, v6
    v_mfma_f32_16x16x32_bf16 a[92:95], a[212:215], v[204:207], a[92:95]
    s_waitcnt lgkmcnt(3)
    v_exp_f32 v246, v182
    v_mfma_f32_16x16x32_bf16 a[96:99], a[216:219], v[192:195], a[96:99]
    s_add_u32 s62, s62, 1
    v_cmp_gt_i32 s[50:51], 19, v6
    v_cvt_pk_bf16_f32 v214, v244, v245
    v_mfma_f32_16x16x32_bf16 a[100:103], a[216:219], v[196:199], a[100:103]
    buffer_store_dwordx4 a[224:227], v229, s[8:11], s58 offen offset:0 sc1
    ds_read_b128 a[140:143], v2 offset:3072
    ds_read_b128 a[144:147], v2 offset:4096
    v_mfma_f32_16x16x32_bf16 a[104:107], a[216:219], v[200:203], a[104:107]
    v_exp_f32 v247, v183
    v_mfma_f32_16x16x32_bf16 a[108:111], a[216:219], v[204:207], a[108:111]
    v_cndmask_b32 v36, v9, v5, s[44:45]
    v_or3_b32 v57, v57, v213, v214
    v_mfma_f32_16x16x32_bf16 a[112:115], a[220:223], v[192:195], a[112:115]
    v_exp_f32 v232, v168
    v_mfma_f32_16x16x32_bf16 a[116:119], a[220:223], v[196:199], a[116:119]
    v_cndmask_b32 v37, v9, v5, s[46:47]
    v_cvt_pk_bf16_f32 v215, v246, v247
    v_cndmask_b32 v38, v9, v5, s[48:49]
    v_cndmask_b32 v39, v9, v5, s[50:51]
    v_mfma_f32_16x16x32_bf16 a[120:123], a[220:223], v[200:203], a[120:123]
    v_exp_f32 v233, v169
    v_mfma_f32_16x16x32_bf16 a[124:127], a[220:223], v[204:207], a[124:127]
    s_waitcnt lgkmcnt(3)
    buffer_store_dwordx4 a[228:231], v229, s[8:11], s58 offen offset:256 sc1
    v_exp_f32 v234, v170
    v_mfma_f32_16x16x32_bf16 v[132:135], a[128:131], v[80:83], v[20:23]
    ds_read_b128 a[148:151], v2 offset:5120
    v_cvt_pk_bf16_f32 v216, v232, v233
    v_mfma_f32_16x16x32_bf16 v[136:139], a[128:131], v[96:99], v[24:27]
    v_exp_f32 v235, v171
    v_mfma_f32_16x16x32_bf16 v[140:143], a[128:131], v[112:115], v[28:31]
    s_lshl_b32 s58, s61, 17
    ds_read_b128 a[152:155], v2 offset:6144
    v_or3_b32 v57, v57, v215, v216
    v_mfma_f32_16x16x32_bf16 v[132:135], a[132:135], v[84:87], v[132:135]
    s_add_u32 s36, s36, 32
    v_exp_f32 v236, v184
    v_mfma_f32_16x16x32_bf16 v[136:139], a[132:135], v[100:103], v[136:139]
    s_lshl_b32 s60, s60, 10
    v_cvt_pk_bf16_f32 v217, v234, v235
    v_exp_f32 v237, v185
    v_mfma_f32_16x16x32_bf16 v[140:143], a[132:135], v[116:119], v[140:143]
    s_waitcnt lgkmcnt(3)
    buffer_load_dwordx4 a[224:227], v228, s[12:15], s57 offen
    ds_read_b128 a[156:159], v2 offset:7168
    v_mfma_f32_16x16x32_bf16 v[132:135], a[136:139], v[88:91], v[132:135]
    s_add_u32 s52, s52, 8192
    v_exp_f32 v238, v186
    v_mfma_f32_16x16x32_bf16 v[136:139], a[136:139], v[104:107], v[136:139]
    s_add_u32 s58, s58, s60
    v_cvt_pk_bf16_f32 v218, v236, v237
    v_or3_b32 v57, v57, v217, v218
    v_mfma_f32_16x16x32_bf16 v[140:143], a[136:139], v[120:123], v[140:143]
    s_and_b32 s52, s52, 0xffff
    v_exp_f32 v239, v187
    v_mfma_f32_16x16x32_bf16 v[132:135], a[140:143], v[92:95], v[132:135]
    v_add_u32 v2, s52, v1
    v_cvt_pk_bf16_f32 v219, v238, v239
    v_mfma_f32_16x16x32_bf16 v[136:139], a[140:143], v[108:111], v[136:139]
    s_mov_b32 s10, s59
    v_exp_f32 v240, v172
    v_mfma_f32_16x16x32_bf16 v[140:143], a[140:143], v[124:127], v[140:143]
    s_waitcnt lgkmcnt(2)
    ds_read_b128 a[192:195], v3 offset:0
    v_exp_f32 v241, v173
    v_mfma_f32_16x16x32_bf16 v[148:151], a[144:147], v[80:83], v[36:39]
    buffer_load_dwordx4 a[228:231], v228, s[12:15], s56 offen
    ds_read_b128 a[196:199], v3 offset:1024
    v_mfma_f32_16x16x32_bf16 v[152:155], a[144:147], v[96:99], v[40:43]
    v_exp_f32 v242, v174
    v_mfma_f32_16x16x32_bf16 v[156:159], a[144:147], v[112:115], v[44:47]
    v_cvt_pk_bf16_f32 v220, v240, v241
    v_or3_b32 v57, v57, v219, v220
    v_mfma_f32_16x16x32_bf16 v[148:151], a[148:151], v[84:87], v[148:151]
    v_exp_f32 v243, v175
    v_mfma_f32_16x16x32_bf16 v[152:155], a[148:151], v[100:103], v[152:155]
    v_exp_f32 v244, v188
    v_mfma_f32_16x16x32_bf16 v[156:159], a[148:151], v[116:119], v[156:159]
    s_waitcnt lgkmcnt(2)
    v_cvt_pk_bf16_f32 v221, v242, v243
    v_exp_f32 v245, v189
    v_mfma_f32_16x16x32_bf16 v[148:151], a[152:155], v[88:91], v[148:151]
    buffer_load_dword v7, v230, s[24:27], s54 offen
    ds_read_b128 a[200:203], v3 offset:2048
    v_mfma_f32_16x16x32_bf16 v[152:155], a[152:155], v[104:107], v[152:155]
    v_exp_f32 v246, v190
    v_mfma_f32_16x16x32_bf16 v[156:159], a[152:155], v[120:123], v[156:159]
    s_add_u32 s54, s54, 4096
    v_cvt_pk_bf16_f32 v222, v244, v245
    v_or3_b32 v57, v57, v221, v222
    v_mfma_f32_16x16x32_bf16 v[148:151], a[156:159], v[92:95], v[148:151]
    v_exp_f32 v247, v191
    v_mfma_f32_16x16x32_bf16 v[152:155], a[156:159], v[108:111], v[152:155]
    ds_read_b128 a[204:207], v3 offset:3072
    v_cvt_pk_bf16_f32 v223, v246, v247
    v_bitop3_b32 v57, v57, v223, s37 bitop3:0xa8
    v_mfma_f32_16x16x32_bf16 v[156:159], a[156:159], v[124:127], v[156:159]
    v_cmp_ne_u32 vcc, 0, v57
    s_cbranch_vccnz k2_tramp_92
k2_ret_93:
    v_mfma_f32_16x16x32_bf16 v[12:15], v[60:63], v[208:211], v[12:15]
    v_exp_f32 v232, v132
    v_mfma_f32_16x16x32_bf16 v[48:51], v[60:63], v[212:215], v[48:51]
    s_mov_b32 m0, s35
    ds_read_b128 a[208:211], v3 offset:4096
    v_mfma_f32_16x16x32_bf16 v[248:251], v[60:63], v[216:219], v[248:251]
    s_add_u32 s53, s53, 8192
    buffer_load_dwordx4 v1, s[20:23], s33 offen offset:0 sc1 lds
    v_mfma_f32_16x16x32_bf16 v[252:255], v[60:63], v[220:223], v[252:255]
    s_waitcnt lgkmcnt(3)
    v_exp_f32 v233, v133
    v_mfma_f32_16x16x32_bf16 a[0:3], a[192:195], v[208:211], a[0:3]
    s_sub_u32 s40, s36, s38
    s_sub_u32 s40, s40, 64
    v_exp_f32 v234, v134
    v_mfma_f32_16x16x32_bf16 a[4:7], a[192:195], v[212:215], a[4:7]
    s_and_b32 s53, s53, 0xffff
    ds_read_b128 a[212:215], v3 offset:5120
    v_subrev_u32 v6, s40, v4
    v_mfma_f32_16x16x32_bf16 a[8:11], a[192:195], v[216:219], a[8:11]
    v_cvt_pk_bf16_f32 v196, v232, v233
    v_cmp_gt_i32 s[44:45], 0, v6
    v_mfma_f32_16x16x32_bf16 a[12:15], a[192:195], v[220:223], a[12:15]
    v_exp_f32 v235, v135
    v_mfma_f32_16x16x32_bf16 a[16:19], a[196:199], v[208:211], a[16:19]
    ds_read_b128 a[216:219], v3 offset:6144
    v_cmp_gt_i32 s[46:47], 1, v6
    v_mfma_f32_16x16x32_bf16 a[20:23], a[196:199], v[212:215], a[20:23]
    v_exp_f32 v236, v148
    v_mfma_f32_16x16x32_bf16 a[24:27], a[196:199], v[216:219], a[24:27]
    v_cvt_pk_bf16_f32 v197, v234, v235
    v_cmp_gt_i32 s[48:49], 2, v6
    v_mfma_f32_16x16x32_bf16 a[28:31], a[196:199], v[220:223], a[28:31]
    s_waitcnt lgkmcnt(3)
    v_cmp_gt_i32 s[50:51], 3, v6
    v_mfma_f32_16x16x32_bf16 a[32:35], a[200:203], v[208:211], a[32:35]
    v_exp_f32 v237, v149
    v_mfma_f32_16x16x32_bf16 a[36:39], a[200:203], v[212:215], a[36:39]
    s_add_u32 s35, s35, 0x4000
    ds_read_b128 a[220:223], v3 offset:7168
    v_cndmask_b32 v20, v9, v5, s[44:45]
    v_mfma_f32_16x16x32_bf16 a[40:43], a[200:203], v[216:219], a[40:43]
    v_exp_f32 v238, v150
    v_mfma_f32_16x16x32_bf16 a[44:47], a[200:203], v[220:223], a[44:47]
    v_cvt_pk_bf16_f32 v198, v236, v237
    v_cndmask_b32 v21, v9, v5, s[46:47]
    v_mfma_f32_16x16x32_bf16 a[48:51], a[204:207], v[208:211], a[48:51]
    buffer_load_dwordx4 v1, s[20:23], s33 offen offset:1024 sc1 lds
    ds_read_b128 a[128:131], v2 offset:0
    v_mfma_f32_16x16x32_bf16 a[52:55], a[204:207], v[212:215], a[52:55]
    v_add_u32 v3, s53, v56
    v_cndmask_b32 v22, v9, v5, s[48:49]
    v_mfma_f32_16x16x32_bf16 a[56:59], a[204:207], v[216:219], a[56:59]
    v_exp_f32 v239, v151
    v_mfma_f32_16x16x32_bf16 a[60:63], a[204:207], v[220:223], a[60:63]
    s_waitcnt lgkmcnt(3)
    v_or3_b32 v57, v196, v197, v198
    v_cndmask_b32 v23, v9, v5, s[50:51]
    v_mfma_f32_16x16x32_bf16 a[64:67], a[208:211], v[208:211], a[64:67]
    v_exp_f32 v240, v136
    v_mfma_f32_16x16x32_bf16 a[68:71], a[208:211], v[212:215], a[68:71]
    v_cvt_pk_bf16_f32 v199, v238, v239
    v_cmp_gt_i32 s[44:45], 16, v6
    v_mfma_f32_16x16x32_bf16 a[72:75], a[208:211], v[216:219], a[72:75]
    ds_read_b128 a[132:135], v2 offset:1024
    v_cmp_gt_i32 s[46:47], 17, v6
    v_mfma_f32_16x16x32_bf16 a[76:79], a[208:211], v[220:223], a[76:79]
    v_exp_f32 v241, v137
    v_mfma_f32_16x16x32_bf16 a[80:83], a[212:215], v[208:211], a[80:83]
    ds_read_b128 a[136:139], v2 offset:2048
    v_cmp_gt_i32 s[48:49], 18, v6
    v_mfma_f32_16x16x32_bf16 a[84:87], a[212:215], v[212:215], a[84:87]
    v_exp_f32 v242, v138
    v_mfma_f32_16x16x32_bf16 a[88:91], a[212:215], v[216:219], a[88:91]
    v_cvt_pk_bf16_f32 v200, v240, v241
    v_cmp_gt_i32 s[50:51], 19, v6
    v_mfma_f32_16x16x32_bf16 a[92:95], a[212:215], v[220:223], a[92:95]
    s_waitcnt lgkmcnt(3)
    v_exp_f32 v243, v139
    v_mfma_f32_16x16x32_bf16 a[96:99], a[216:219], v[208:211], a[96:99]
    s_and_b32 s35, s35, 0xffff
    ds_read_b128 a[140:143], v2 offset:3072
    v_or3_b32 v57, v57, v199, v200
    v_mfma_f32_16x16x32_bf16 a[100:103], a[216:219], v[212:215], a[100:103]
    v_cndmask_b32 v36, v9, v5, s[44:45]
    v_cndmask_b32 v37, v9, v5, s[46:47]
    v_mfma_f32_16x16x32_bf16 a[104:107], a[216:219], v[216:219], a[104:107]
    v_exp_f32 v244, v152
    v_mfma_f32_16x16x32_bf16 a[108:111], a[216:219], v[220:223], a[108:111]
    ds_read_b128 a[144:147], v2 offset:4096
    v_cvt_pk_bf16_f32 v201, v242, v243
    v_mfma_f32_16x16x32_bf16 a[112:115], a[220:223], v[208:211], a[112:115]
    buffer_load_dwordx4 v1, s[20:23], s33 offen offset:2048 sc1 lds
    ds_read_b128 a[148:151], v2 offset:5120
    v_mfma_f32_16x16x32_bf16 a[116:119], a[220:223], v[212:215], a[116:119]
    v_cndmask_b32 v38, v9, v5, s[48:49]
    v_cndmask_b32 v39, v9, v5, s[50:51]
    v_mfma_f32_16x16x32_bf16 a[120:123], a[220:223], v[216:219], a[120:123]
    s_or_b32 s35, s35, 0x10000
    v_exp_f32 v245, v153
    v_mfma_f32_16x16x32_bf16 a[124:127], a[220:223], v[220:223], a[124:127]
    s_waitcnt lgkmcnt(4)
    v_exp_f32 v246, v154
    v_mfma_f32_16x16x32_bf16 v[164:167], a[128:131], v[80:83], v[20:23]
    ds_read_b128 a[152:155], v2 offset:6144
    v_cvt_pk_bf16_f32 v202, v244, v245
    v_mfma_f32_16x16x32_bf16 v[168:171], a[128:131], v[96:99], v[24:27]
    v_exp_f32 v247, v155
    v_mfma_f32_16x16x32_bf16 v[172:175], a[128:131], v[112:115], v[28:31]
    v_or3_b32 v57, v57, v201, v202
    v_cvt_pk_bf16_f32 v203, v246, v247
    v_mfma_f32_16x16x32_bf16 v[164:167], a[132:135], v[84:87], v[164:167]
    s_add_u32 s36, s36, 32
    v_exp_f32 v232, v140
    v_mfma_f32_16x16x32_bf16 v[168:171], a[132:135], v[100:103], v[168:171]
    ds_read_b128 a[156:159], v2 offset:7168
    v_mfma_f32_16x16x32_bf16 v[172:175], a[132:135], v[116:119], v[172:175]
    s_waitcnt lgkmcnt(4)
    v_exp_f32 v233, v141
    v_mfma_f32_16x16x32_bf16 v[164:167], a[136:139], v[88:91], v[164:167]
    s_add_u32 s52, s52, 8192
    v_exp_f32 v234, v142
    v_mfma_f32_16x16x32_bf16 v[168:171], a[136:139], v[104:107], v[168:171]
    ds_read_b128 a[192:195], v3 offset:0
    v_cvt_pk_bf16_f32 v204, v232, v233
    v_mfma_f32_16x16x32_bf16 v[172:175], a[136:139], v[120:123], v[172:175]
    s_and_b32 s52, s52, 0xffff
    v_add_u32 v2, s52, v1
    v_or3_b32 v57, v57, v203, v204
    v_mfma_f32_16x16x32_bf16 v[164:167], a[140:143], v[92:95], v[164:167]
    buffer_load_dwordx4 v1, s[20:23], s33 offen offset:3072 sc1 lds
    s_add_u32 s33, s33, 0x80000
    v_mfma_f32_16x16x32_bf16 v[168:171], a[140:143], v[108:111], v[168:171]
    v_exp_f32 v235, v143
    v_mfma_f32_16x16x32_bf16 v[172:175], a[140:143], v[124:127], v[172:175]
    s_waitcnt lgkmcnt(3)
    v_exp_f32 v236, v156
    v_mfma_f32_16x16x32_bf16 v[180:183], a[144:147], v[80:83], v[36:39]
    ds_read_b128 a[196:199], v3 offset:1024
    v_cvt_pk_bf16_f32 v205, v234, v235
    v_mfma_f32_16x16x32_bf16 v[184:187], a[144:147], v[96:99], v[40:43]
    v_exp_f32 v237, v157
    v_mfma_f32_16x16x32_bf16 v[188:191], a[144:147], v[112:115], v[44:47]
    ds_read_b128 a[200:203], v3 offset:2048
    v_mfma_f32_16x16x32_bf16 v[180:183], a[148:151], v[84:87], v[180:183]
    v_exp_f32 v238, v158
    v_mfma_f32_16x16x32_bf16 v[184:187], a[148:151], v[100:103], v[184:187]
    v_cvt_pk_bf16_f32 v206, v236, v237
    v_mfma_f32_16x16x32_bf16 v[188:191], a[148:151], v[116:119], v[188:191]
    s_waitcnt lgkmcnt(3)
    v_exp_f32 v239, v159
    v_mfma_f32_16x16x32_bf16 v[180:183], a[152:155], v[88:91], v[180:183]
    ds_read_b128 a[204:207], v3 offset:3072
    v_or3_b32 v57, v57, v205, v206
    v_mfma_f32_16x16x32_bf16 v[184:187], a[152:155], v[104:107], v[184:187]
    v_cvt_pk_bf16_f32 v207, v238, v239
    v_mfma_f32_16x16x32_bf16 v[188:191], a[152:155], v[120:123], v[188:191]
    v_mfma_f32_16x16x32_bf16 v[180:183], a[156:159], v[92:95], v[180:183]
    v_bitop3_b32 v57, v57, v207, s37 bitop3:0xa8
    v_cmp_ne_u32 vcc, 0, v57
    v_mfma_f32_16x16x32_bf16 v[184:187], a[156:159], v[108:111], v[184:187]
    v_mfma_f32_16x16x32_bf16 v[188:191], a[156:159], v[124:127], v[188:191]
    s_waitcnt vmcnt(13)
    s_barrier
    s_cbranch_vccnz k2_tramp_94
k2_ret_95:
    v_mfma_f32_16x16x32_bf16 v[48:51], v[60:63], v[196:199], v[48:51]
    ds_read_b128 a[208:211], v3 offset:4096
    ds_read_b128 a[212:215], v3 offset:5120
    v_mfma_f32_16x16x32_bf16 v[248:251], v[60:63], v[200:203], v[248:251]
    s_mov_b32 m0, s34
    v_exp_f32 v232, v164
    v_mfma_f32_16x16x32_bf16 v[252:255], v[60:63], v[204:207], v[252:255]
    s_waitcnt lgkmcnt(4)
    buffer_load_dwordx4 v1, s[16:19], s32 offen offset:0 sc1 lds
    ds_read_b128 a[216:219], v3 offset:6144
    v_mfma_f32_16x16x32_bf16 a[4:7], a[192:195], v[196:199], a[4:7]
    s_add_u32 s53, s53, 8192
    v_exp_f32 v233, v165
    v_mfma_f32_16x16x32_bf16 a[8:11], a[192:195], v[200:203], a[8:11]
    s_and_b32 s53, s53, 0xffff
    v_mov_b32 v16, v10
    v_mov_b32 v17, v10
    v_mfma_f32_16x16x32_bf16 a[12:15], a[192:195], v[204:207], a[12:15]
    s_add_u32 s34, s34, 0x4000
    v_exp_f32 v234, v166
    v_mfma_f32_16x16x32_bf16 a[20:23], a[196:199], v[196:199], a[20:23]
    ds_read_b128 a[220:223], v3 offset:7168
    v_cvt_pk_bf16_f32 v212, v232, v233
    v_mfma_f32_16x16x32_bf16 a[24:27], a[196:199], v[200:203], a[24:27]
    v_mov_b32 v18, v10
    v_mov_b32 v19, v10
    v_mfma_f32_16x16x32_bf16 a[28:31], a[196:199], v[204:207], a[28:31]
    s_waitcnt lgkmcnt(4)
    v_exp_f32 v235, v167
    v_mfma_f32_16x16x32_bf16 a[36:39], a[200:203], v[196:199], a[36:39]
    buffer_load_dwordx4 v1, s[16:19], s32 offen offset:1024 sc1 lds
    ds_read_b128 a[128:131], v2 offset:0
    v_mfma_f32_16x16x32_bf16 a[40:43], a[200:203], v[200:203], a[40:43]
    v_mov_b32 v20, v11
    v_add_u32 v3, s53, v56
    v_mfma_f32_16x16x32_bf16 a[44:47], a[200:203], v[204:207], a[44:47]
    s_and_b32 s34, s34, 0xffff
    v_mov_b32 v21, v11
    v_mov_b32 v22, v11
    v_mfma_f32_16x16x32_bf16 a[52:55], a[204:207], v[196:199], a[52:55]
    v_exp_f32 v236, v180
    v_mfma_f32_16x16x32_bf16 a[56:59], a[204:207], v[200:203], a[56:59]
    ds_read_b128 a[132:135], v2 offset:1024
    v_cvt_pk_bf16_f32 v213, v234, v235
    v_mfma_f32_16x16x32_bf16 a[60:63], a[204:207], v[204:207], a[60:63]
    s_waitcnt lgkmcnt(4)
    v_mov_b32 v23, v11
    v_mov_b32 v32, v10
    v_mfma_f32_16x16x32_bf16 a[68:71], a[208:211], v[196:199], a[68:71]
    v_exp_f32 v237, v181
    v_mfma_f32_16x16x32_bf16 a[72:75], a[208:211], v[200:203], a[72:75]
    ds_read_b128 a[136:139], v2 offset:2048
    v_mov_b32 v33, v10
    v_mfma_f32_16x16x32_bf16 a[76:79], a[208:211], v[204:207], a[76:79]
    buffer_load_dwordx4 v1, s[16:19], s32 offen offset:2048 sc1 lds
    v_mov_b32 v34, v10
    v_mfma_f32_16x16x32_bf16 a[84:87], a[212:215], v[196:199], a[84:87]
    v_exp_f32 v238, v182
    v_mfma_f32_16x16x32_bf16 a[88:91], a[212:215], v[200:203], a[88:91]
    ds_read_b128 a[140:143], v2 offset:3072
    v_cvt_pk_bf16_f32 v214, v236, v237
    v_mfma_f32_16x16x32_bf16 a[92:95], a[212:215], v[204:207], a[92:95]
    s_waitcnt lgkmcnt(4)
    v_mov_b32 v35, v10
    v_mov_b32 v36, v11
    v_mfma_f32_16x16x32_bf16 a[100:103], a[216:219], v[196:199], a[100:103]
    ds_read_b128 a[144:147], v2 offset:4096
    v_exp_f32 v239, v183
    v_mfma_f32_16x16x32_bf16 a[104:107], a[216:219], v[200:203], a[104:107]
    v_mov_b32 v37, v11
    v_or3_b32 v57, v212, v213, v214
    v_mov_b32 v38, v11
    v_mov_b32 v39, v11
    v_mfma_f32_16x16x32_bf16 a[108:111], a[216:219], v[204:207], a[108:111]
    buffer_load_dwordx4 v1, s[16:19], s32 offen offset:3072 sc1 lds
    ds_read_b128 a[148:151], v2 offset:5120
    v_mfma_f32_16x16x32_bf16 a[116:119], a[220:223], v[196:199], a[116:119]
    s_add_u32 s32, s32, 0x80000
    s_cmp_ge_u32 s36, s43
    s_cbranch_scc1 k2_prep_96
k2_prepret_97:
    v_mfma_f32_16x16x32_bf16 a[120:123], a[220:223], v[200:203], a[120:123]
    s_waitcnt vmcnt(8)
    v_exp_f32 v240, v168
    v_mfma_f32_16x16x32_bf16 a[124:127], a[220:223], v[204:207], a[124:127]
    s_waitcnt lgkmcnt(4)
    ds_read_b128 a[152:155], v2 offset:6144
    v_cvt_pk_bf16_f32 v215, v238, v239
    v_mfma_f32_16x16x32_bf16 v[128:131], a[128:131], v[96:99], v[16:19]
    v_exp_f32 v241, v169
    v_mfma_f32_16x16x32_bf16 v[132:135], a[128:131], v[112:115], v[20:23]
    ds_read_b128 a[156:159], v2 offset:7168
    v_exp_f32 v242, v170
    v_mfma_f32_16x16x32_bf16 v[128:131], a[132:135], v[100:103], v[128:131]
    ds_read_b128 a[160:163], v2 offset:8192
    v_cvt_pk_bf16_f32 v216, v240, v241
    v_mfma_f32_16x16x32_bf16 v[132:135], a[132:135], v[116:119], v[132:135]
    s_waitcnt lgkmcnt(5)
    buffer_store_dwordx4 a[224:227], v229, s[8:11], s58 offen offset:0 sc1
    v_exp_f32 v243, v171
    v_mfma_f32_16x16x32_bf16 v[128:131], a[136:139], v[104:107], v[128:131]
    s_add_u32 s36, s36, 64
    ds_read_b128 a[164:167], v2 offset:9216
    v_or3_b32 v57, v57, v215, v216
    v_mfma_f32_16x16x32_bf16 v[132:135], a[136:139], v[120:123], v[132:135]
    v_exp_f32 v244, v184
    v_mfma_f32_16x16x32_bf16 v[128:131], a[140:143], v[108:111], v[128:131]
    s_add_u32 s52, s52, 16384
    ds_read_b128 a[168:171], v2 offset:10240
    v_cvt_pk_bf16_f32 v217, v242, v243
    v_mfma_f32_16x16x32_bf16 v[132:135], a[140:143], v[124:127], v[132:135]
    s_waitcnt lgkmcnt(5)
    v_exp_f32 v245, v185
    v_mfma_f32_16x16x32_bf16 v[144:147], a[144:147], v[96:99], v[32:35]
    s_and_b32 s52, s52, 0xffff
    ds_read_b128 a[172:175], v2 offset:11264
    ds_read_b128 a[176:179], v2 offset:12288
    v_mfma_f32_16x16x32_bf16 v[148:151], a[144:147], v[112:115], v[36:39]
    v_exp_f32 v246, v186
    v_mfma_f32_16x16x32_bf16 v[144:147], a[148:151], v[100:103], v[144:147]
    ds_read_b128 a[180:183], v2 offset:13312
    v_cvt_pk_bf16_f32 v218, v244, v245
    v_mfma_f32_16x16x32_bf16 v[148:151], a[148:151], v[116:119], v[148:151]
    s_waitcnt lgkmcnt(6)
    v_exp_f32 v247, v187
    v_mfma_f32_16x16x32_bf16 v[144:147], a[152:155], v[104:107], v[144:147]
    ds_read_b128 a[184:187], v2 offset:14336
    v_or3_b32 v57, v57, v217, v218
    v_mfma_f32_16x16x32_bf16 v[148:151], a[152:155], v[120:123], v[148:151]
    v_exp_f32 v232, v172
    v_mfma_f32_16x16x32_bf16 v[144:147], a[156:159], v[108:111], v[144:147]
    ds_read_b128 a[188:191], v2 offset:15360
    v_cvt_pk_bf16_f32 v219, v246, v247
    v_mfma_f32_16x16x32_bf16 v[148:151], a[156:159], v[124:127], v[148:151]
    s_waitcnt lgkmcnt(6)
    v_exp_f32 v233, v173
    v_mfma_f32_16x16x32_bf16 v[136:139], a[160:163], v[96:99], v[24:27]
    buffer_store_dwordx4 a[228:231], v229, s[8:11], s58 offen offset:256 sc1
    ds_read_b128 a[192:195], v3 offset:0
    v_mfma_f32_16x16x32_bf16 v[140:143], a[160:163], v[112:115], v[28:31]
    v_add_u32 v2, s52, v1
    v_cvt_pk_bf16_f32 v220, v232, v233
    v_mfma_f32_16x16x32_bf16 v[136:139], a[164:167], v[100:103], v[136:139]
    v_exp_f32 v234, v174
    v_mfma_f32_16x16x32_bf16 v[140:143], a[164:167], v[116:119], v[140:143]
    s_waitcnt lgkmcnt(5)
    v_exp_f32 v235, v175
    v_mfma_f32_16x16x32_bf16 v[136:139], a[168:171], v[104:107], v[136:139]
    ds_read_b128 a[196:199], v3 offset:1024
    v_or3_b32 v57, v57, v219, v220
    v_mfma_f32_16x16x32_bf16 v[140:143], a[168:171], v[120:123], v[140:143]
    v_exp_f32 v236, v188
    v_mfma_f32_16x16x32_bf16 v[136:139], a[172:175], v[108:111], v[136:139]
    ds_read_b128 a[200:203], v3 offset:2048
    v_cvt_pk_bf16_f32 v221, v234, v235
    v_mfma_f32_16x16x32_bf16 v[140:143], a[172:175], v[124:127], v[140:143]
    s_waitcnt lgkmcnt(5)
    v_exp_f32 v237, v189
    v_mfma_f32_16x16x32_bf16 v[152:155], a[176:179], v[96:99], v[40:43]
    v_exp_f32 v238, v190
    v_mfma_f32_16x16x32_bf16 v[156:159], a[176:179], v[112:115], v[44:47]
    v_cvt_pk_bf16_f32 v222, v236, v237
    v_or3_b32 v57, v57, v221, v222
    v_mfma_f32_16x16x32_bf16 v[152:155], a[180:183], v[100:103], v[152:155]
    v_exp_f32 v239, v191
    v_mfma_f32_16x16x32_bf16 v[156:159], a[180:183], v[116:119], v[156:159]
    s_waitcnt lgkmcnt(3)
    ds_read_b128 a[204:207], v3 offset:3072
    v_cvt_pk_bf16_f32 v223, v238, v239
    v_mfma_f32_16x16x32_bf16 v[152:155], a[184:187], v[104:107], v[152:155]
    v_mfma_f32_16x16x32_bf16 v[156:159], a[184:187], v[120:123], v[156:159]
    v_bitop3_b32 v57, v57, v223, s37 bitop3:0xa8
    v_cmp_ne_u32 vcc, 0, v57
    v_mfma_f32_16x16x32_bf16 v[152:155], a[188:191], v[108:111], v[152:155]
    v_mfma_f32_16x16x32_bf16 v[156:159], a[188:191], v[124:127], v[156:159]
    s_cbranch_vccnz k2_tramp_98
k2_ret_99:
    v_mfma_f32_16x16x32_bf16 v[48:51], v[60:63], v[212:215], v[48:51]
    ds_read_b128 a[208:211], v3 offset:4096
    ds_read_b128 a[212:215], v3 offset:5120
    v_mfma_f32_16x16x32_bf16 v[248:251], v[60:63], v[216:219], v[248:251]
    s_mov_b32 m0, s35
    v_exp_f32 v232, v128
    v_mfma_f32_16x16x32_bf16 v[252:255], v[60:63], v[220:223], v[252:255]
    s_waitcnt lgkmcnt(4)
    ds_read_b128 a[216:219], v3 offset:6144
    v_exp_f32 v233, v129
    v_mfma_f32_16x16x32_bf16 a[4:7], a[192:195], v[212:215], a[4:7]
    s_add_u32 s53, s53, 8192
    buffer_load_dwordx4 v1, s[20:23], s33 offen offset:0 sc1 lds
    v_mfma_f32_16x16x32_bf16 a[8:11], a[192:195], v[216:219], a[8:11]
    s_and_b32 s53, s53, 0xffff
    v_exp_f32 v234, v130
    v_cvt_pk_bf16_f32 v192, v232, v233
    v_mfma_f32_16x16x32_bf16 a[12:15], a[192:195], v[220:223], a[12:15]
    ds_read_b128 a[220:223], v3 offset:7168
    v_mfma_f32_16x16x32_bf16 a[20:23], a[196:199], v[212:215], a[20:23]
    s_add_u32 s35, s35, 0x4000
    v_exp_f32 v235, v131
    v_mfma_f32_16x16x32_bf16 a[24:27], a[196:199], v[216:219], a[24:27]
    v_exp_f32 v236, v144
    v_cvt_pk_bf16_f32 v193, v234, v235
    v_mfma_f32_16x16x32_bf16 a[28:31], a[196:199], v[220:223], a[28:31]
    s_waitcnt lgkmcnt(4)
    buffer_load_dwordx4 v1, s[20:23], s33 offen offset:1024 sc1 lds
    ds_read_b128 a[128:131], v2 offset:0
    v_mfma_f32_16x16x32_bf16 a[36:39], a[200:203], v[212:215], a[36:39]
    v_add_u32 v3, s53, v56
    v_exp_f32 v237, v145
    v_mfma_f32_16x16x32_bf16 a[40:43], a[200:203], v[216:219], a[40:43]
    ds_read_b128 a[132:135], v2 offset:1024
    v_cvt_pk_bf16_f32 v194, v236, v237
    v_mfma_f32_16x16x32_bf16 a[44:47], a[200:203], v[220:223], a[44:47]
    ds_read_b128 a[136:139], v2 offset:2048
    v_exp_f32 v238, v146
    v_mfma_f32_16x16x32_bf16 a[52:55], a[204:207], v[212:215], a[52:55]
    s_and_b32 s35, s35, 0xffff
    v_exp_f32 v239, v147
    v_mfma_f32_16x16x32_bf16 a[56:59], a[204:207], v[216:219], a[56:59]
    ds_read_b128 a[140:143], v2 offset:3072
    v_or3_b32 v57, v192, v193, v194
    v_mfma_f32_16x16x32_bf16 a[60:63], a[204:207], v[220:223], a[60:63]
    s_waitcnt lgkmcnt(6)
    v_exp_f32 v240, v132
    v_mfma_f32_16x16x32_bf16 a[68:71], a[208:211], v[212:215], a[68:71]
    s_or_b32 s35, s35, 0x10000
    buffer_load_dwordx4 v1, s[20:23], s33 offen offset:2048 sc1 lds
    ds_read_b128 a[144:147], v2 offset:4096
    v_mfma_f32_16x16x32_bf16 a[72:75], a[208:211], v[216:219], a[72:75]
    v_cvt_pk_bf16_f32 v195, v238, v239
    v_exp_f32 v241, v133
    v_mfma_f32_16x16x32_bf16 a[76:79], a[208:211], v[220:223], a[76:79]
    v_exp_f32 v242, v134
    v_mfma_f32_16x16x32_bf16 a[84:87], a[212:215], v[212:215], a[84:87]
    ds_read_b128 a[148:151], v2 offset:5120
    v_cvt_pk_bf16_f32 v196, v240, v241
    v_mfma_f32_16x16x32_bf16 a[88:91], a[212:215], v[216:219], a[88:91]
    v_exp_f32 v243, v135
    v_mfma_f32_16x16x32_bf16 a[92:95], a[212:215], v[220:223], a[92:95]
    s_waitcnt lgkmcnt(6)
    ds_read_b128 a[152:155], v2 offset:6144
    v_or3_b32 v57, v57, v195, v196
    v_cvt_pk_bf16_f32 v197, v242, v243
    v_mfma_f32_16x16x32_bf16 a[100:103], a[216:219], v[212:215], a[100:103]
    buffer_load_dwordx4 v1, s[20:23], s33 offen offset:3072 sc1 lds
    ds_read_b128 a[156:159], v2 offset:7168
    v_mfma_f32_16x16x32_bf16 a[104:107], a[216:219], v[216:219], a[104:107]
    s_add_u32 s33, s33, 0x80000
    v_exp_f32 v244, v148
    v_mfma_f32_16x16x32_bf16 a[108:111], a[216:219], v[220:223], a[108:111]
    v_exp_f32 v245, v149
    v_mfma_f32_16x16x32_bf16 a[116:119], a[220:223], v[212:215], a[116:119]
    ds_read_b128 a[160:163], v2 offset:8192
    s_cmp_ge_u32 s36, s43
    s_cbranch_scc1 k2_prep_100
k2_prepret_101:
    v_mfma_f32_16x16x32_bf16 a[120:123], a[220:223], v[216:219], a[120:123]
    v_exp_f32 v246, v150
    v_mfma_f32_16x16x32_bf16 a[124:127], a[220:223], v[220:223], a[124:127]
    s_waitcnt lgkmcnt(7)
    ds_read_b128 a[164:167], v2 offset:9216
    v_cvt_pk_bf16_f32 v198, v244, v245
    v_mfma_f32_16x16x32_bf16 v[160:163], a[128:131], v[96:99], v[16:19]
    s_waitcnt vmcnt(12)
    s_barrier
    v_exp_f32 v247, v151
    v_mfma_f32_16x16x32_bf16 v[164:167], a[128:131], v[112:115], v[20:23]
    s_mov_b32 m0, s34
    v_or3_b32 v57, v57, v197, v198
    v_cvt_pk_bf16_f32 v199, v246, v247
    v_mfma_f32_16x16x32_bf16 v[160:163], a[132:135], v[100:103], v[160:163]
    ds_read_b128 a[168:171], v2 offset:10240
    v_exp_f32 v232, v136
    v_mfma_f32_16x16x32_bf16 v[164:167], a[132:135], v[116:119], v[164:167]
    s_waitcnt lgkmcnt(7)
    buffer_load_dwordx4 v1, s[16:19], s32 offen offset:0 sc1 lds
    ds_read_b128 a[172:175], v2 offset:11264
    v_mfma_f32_16x16x32_bf16 v[160:163], a[136:139], v[104:107], v[160:163]
    s_add_u32 s36, s36, 64
    v_exp_f32 v233, v137
    v_mfma_f32_16x16x32_bf16 v[164:167], a[136:139], v[120:123], v[164:167]
    v_exp_f32 v234, v138
    v_mfma_f32_16x16x32_bf16 v[160:163], a[140:143], v[108:111], v[160:163]
    s_add_u32 s52, s52, 16384
    ds_read_b128 a[176:179], v2 offset:12288
    v_cvt_pk_bf16_f32 v200, v232, v233
    v_mfma_f32_16x16x32_bf16 v[164:167], a[140:143], v[124:127], v[164:167]
    s_waitcnt lgkmcnt(7)
    v_exp_f32 v235, v139
    v_or3_b32 v57, v57, v199, v200
    v_mfma_f32_16x16x32_bf16 v[176:179], a[144:147], v[96:99], v[32:35]
    s_add_u32 s34, s34, 0x4000
    ds_read_b128 a[180:183], v2 offset:13312
    v_cvt_pk_bf16_f32 v201, v234, v235
    v_mfma_f32_16x16x32_bf16 v[180:183], a[144:147], v[112:115], v[36:39]
    s_and_b32 s52, s52, 0xffff
    v_exp_f32 v236, v152
    v_mfma_f32_16x16x32_bf16 v[176:179], a[148:151], v[100:103], v[176:179]
    buffer_load_dwordx4 v1, s[16:19], s32 offen offset:1024 sc1 lds
    ds_read_b128 a[184:187], v2 offset:14336
    v_mfma_f32_16x16x32_bf16 v[180:183], a[148:151], v[116:119], v[180:183]
    s_waitcnt lgkmcnt(7)
    ds_read_b128 a[188:191], v2 offset:15360
    v_exp_f32 v237, v153
    v_mfma_f32_16x16x32_bf16 v[176:179], a[152:155], v[104:107], v[176:179]
    v_exp_f32 v238, v154
    v_mfma_f32_16x16x32_bf16 v[180:183], a[152:155], v[120:123], v[180:183]
    v_cvt_pk_bf16_f32 v202, v236, v237
    v_or3_b32 v57, v57, v201, v202
    v_mfma_f32_16x16x32_bf16 v[176:179], a[156:159], v[108:111], v[176:179]
    s_and_b32 s34, s34, 0xffff
    v_exp_f32 v239, v155
    v_mfma_f32_16x16x32_bf16 v[180:183], a[156:159], v[124:127], v[180:183]
    s_waitcnt lgkmcnt(6)
    v_add_u32 v2, s52, v1
    v_cvt_pk_bf16_f32 v203, v238, v239
    v_mfma_f32_16x16x32_bf16 v[168:171], a[160:163], v[96:99], v[24:27]
    ds_read_b128 a[192:195], v3 offset:0
    v_exp_f32 v240, v140
    v_mfma_f32_16x16x32_bf16 v[172:175], a[160:163], v[112:115], v[28:31]
    v_exp_f32 v241, v141
    v_mfma_f32_16x16x32_bf16 v[168:171], a[164:167], v[100:103], v[168:171]
    buffer_load_dwordx4 v1, s[16:19], s32 offen offset:2048 sc1 lds
    ds_read_b128 a[196:199], v3 offset:1024
    v_mfma_f32_16x16x32_bf16 v[172:175], a[164:167], v[116:119], v[172:175]
    s_waitcnt lgkmcnt(6)
    v_exp_f32 v242, v142
    v_mfma_f32_16x16x32_bf16 v[168:171], a[168:171], v[104:107], v[168:171]
    ds_read_b128 a[200:203], v3 offset:2048
    v_cvt_pk_bf16_f32 v204, v240, v241
    v_or3_b32 v57, v57, v203, v204
    v_mfma_f32_16x16x32_bf16 v[172:175], a[168:171], v[120:123], v[172:175]
    v_exp_f32 v243, v143
    v_mfma_f32_16x16x32_bf16 v[168:171], a[172:175], v[108:111], v[168:171]
    ds_read_b128 a[204:207], v3 offset:3072
    v_cvt_pk_bf16_f32 v205, v242, v243
    v_mfma_f32_16x16x32_bf16 v[172:175], a[172:175], v[124:127], v[172:175]
    s_waitcnt lgkmcnt(6)
    v_exp_f32 v244, v156
    v_mfma_f32_16x16x32_bf16 v[184:187], a[176:179], v[96:99], v[40:43]
    v_exp_f32 v245, v157
    v_mfma_f32_16x16x32_bf16 v[188:191], a[176:179], v[112:115], v[44:47]
    buffer_load_dwordx4 v1, s[16:19], s32 offen offset:3072 sc1 lds
    ds_read_b128 a[208:211], v3 offset:4096
    ds_read_b128 a[212:215], v3 offset:5120
    v_mfma_f32_16x16x32_bf16 v[184:187], a[180:183], v[100:103], v[184:187]
    s_add_u32 s32, s32, 0x80000
    v_exp_f32 v246, v158
    v_mfma_f32_16x16x32_bf16 v[188:191], a[180:183], v[116:119], v[188:191]
    s_waitcnt lgkmcnt(6)
    v_cvt_pk_bf16_f32 v206, v244, v245
    v_or3_b32 v57, v57, v205, v206
    v_mfma_f32_16x16x32_bf16 v[184:187], a[184:187], v[104:107], v[184:187]
    v_exp_f32 v247, v159
    v_mfma_f32_16x16x32_bf16 v[188:191], a[184:187], v[120:123], v[188:191]
    ds_read_b128 a[216:219], v3 offset:6144
    ds_read_b128 a[220:223], v3 offset:7168
    v_cvt_pk_bf16_f32 v207, v246, v247
    v_mfma_f32_16x16x32_bf16 v[184:187], a[188:191], v[108:111], v[184:187]
    v_bitop3_b32 v57, v57, v207, s37 bitop3:0xa8
    v_cmp_ne_u32 vcc, 0, v57
    v_mfma_f32_16x16x32_bf16 v[188:191], a[188:191], v[124:127], v[188:191]
    s_cbranch_vccnz k2_tramp_102
k2_ret_103:
    s_load_dwordx2 s[4:5], s[0:1], 40
    s_add_u32 s24, s6, 0x3000000
    s_addc_u32 s25, s7, 0
    s_and_b32 s25, s25, 0xffff
    s_mov_b32 s26, 0x1000000
    s_mov_b32 s27, 0x00020000
    s_lshl_b32 s31, s28, 19
    s_lshl_b32 s44, s38, 6
    s_add_u32 s44, s44, s31
    s_add_u32 s45, s44, 131072
    s_add_u32 s46, s44, 262144
    s_add_u32 s47, s44, 393216
    s_add_u32 s48, s44, 4096
    s_add_u32 s49, s44, 135168
    s_add_u32 s50, s44, 266240
    s_add_u32 s51, s44, 397312
    v_mov_b32 v13, v12
    v_mov_b32 v49, v48
    s_nop 1
    v_permlane16_swap_b32 v12, v13
    v_permlane16_swap_b32 v48, v49
    s_nop 1
    v_add_f32 v12, v12, v13
    v_add_f32 v48, v48, v49
    v_mov_b32 v13, v12
    v_mov_b32 v49, v48
    s_nop 1
    v_permlane32_swap_b32 v12, v13
    v_permlane32_swap_b32 v48, v49
    s_nop 1
    v_add_f32 v12, v12, v13
    v_add_f32 v48, v48, v49
    v_rcp_f32 v13, v12
    v_rcp_f32 v49, v48
    v_rcp_f32 v12, v12
    v_rcp_f32 v48, v48
    s_nop 0
    v_accvgpr_read_b32 v68, a0
    v_accvgpr_read_b32 v69, a1
    v_accvgpr_read_b32 v70, a2
    v_accvgpr_read_b32 v71, a3
    v_accvgpr_read_b32 v72, a16
    v_accvgpr_read_b32 v73, a17
    v_accvgpr_read_b32 v74, a18
    v_accvgpr_read_b32 v75, a19
    v_pk_mul_f32 v[68:69], v[68:69], v[12:13]
    v_pk_mul_f32 v[70:71], v[70:71], v[12:13]
    v_pk_mul_f32 v[72:73], v[72:73], v[12:13]
    v_pk_mul_f32 v[74:75], v[74:75], v[12:13]
    v_cvt_pk_bf16_f32 v64, v68, v69
    v_cvt_pk_bf16_f32 v65, v70, v71
    v_cvt_pk_bf16_f32 v66, v72, v73
    v_cvt_pk_bf16_f32 v67, v74, v75
    buffer_store_dwordx4 v[64:67], v1, s[24:27], s44 offen sc1
    v_accvgpr_read_b32 v80, a32
    v_accvgpr_read_b32 v81, a33
    v_accvgpr_read_b32 v82, a34
    v_accvgpr_read_b32 v83, a35
    v_accvgpr_read_b32 v84, a48
    v_accvgpr_read_b32 v85, a49
    v_accvgpr_read_b32 v86, a50
    v_accvgpr_read_b32 v87, a51
    v_pk_mul_f32 v[80:81], v[80:81], v[12:13]
    v_pk_mul_f32 v[82:83], v[82:83], v[12:13]
    v_pk_mul_f32 v[84:85], v[84:85], v[12:13]
    v_pk_mul_f32 v[86:87], v[86:87], v[12:13]
    v_cvt_pk_bf16_f32 v76, v80, v81
    v_cvt_pk_bf16_f32 v77, v82, v83
    v_cvt_pk_bf16_f32 v78, v84, v85
    v_cvt_pk_bf16_f32 v79, v86, v87
    buffer_store_dwordx4 v[76:79], v1, s[24:27], s45 offen sc1
    v_accvgpr_read_b32 v68, a64
    v_accvgpr_read_b32 v69, a65
    v_accvgpr_read_b32 v70, a66
    v_accvgpr_read_b32 v71, a67
    v_accvgpr_read_b32 v72, a80
    v_accvgpr_read_b32 v73, a81
    v_accvgpr_read_b32 v74, a82
    v_accvgpr_read_b32 v75, a83
    v_pk_mul_f32 v[68:69], v[68:69], v[12:13]
    v_pk_mul_f32 v[70:71], v[70:71], v[12:13]
    v_pk_mul_f32 v[72:73], v[72:73], v[12:13]
    v_pk_mul_f32 v[74:75], v[74:75], v[12:13]
    v_cvt_pk_bf16_f32 v64, v68, v69
    v_cvt_pk_bf16_f32 v65, v70, v71
    v_cvt_pk_bf16_f32 v66, v72, v73
    v_cvt_pk_bf16_f32 v67, v74, v75
    buffer_store_dwordx4 v[64:67], v1, s[24:27], s46 offen sc1
    v_accvgpr_read_b32 v80, a96
    v_accvgpr_read_b32 v81, a97
    v_accvgpr_read_b32 v82, a98
    v_accvgpr_read_b32 v83, a99
    v_accvgpr_read_b32 v84, a112
    v_accvgpr_read_b32 v85, a113
    v_accvgpr_read_b32 v86, a114
    v_accvgpr_read_b32 v87, a115
    v_pk_mul_f32 v[80:81], v[80:81], v[12:13]
    v_pk_mul_f32 v[82:83], v[82:83], v[12:13]
    v_pk_mul_f32 v[84:85], v[84:85], v[12:13]
    v_pk_mul_f32 v[86:87], v[86:87], v[12:13]
    v_cvt_pk_bf16_f32 v76, v80, v81
    v_cvt_pk_bf16_f32 v77, v82, v83
    v_cvt_pk_bf16_f32 v78, v84, v85
    v_cvt_pk_bf16_f32 v79, v86, v87
    buffer_store_dwordx4 v[76:79], v1, s[24:27], s47 offen sc1
    v_accvgpr_read_b32 v68, a4
    v_accvgpr_read_b32 v69, a5
    v_accvgpr_read_b32 v70, a6
    v_accvgpr_read_b32 v71, a7
    v_accvgpr_read_b32 v72, a20
    v_accvgpr_read_b32 v73, a21
    v_accvgpr_read_b32 v74, a22
    v_accvgpr_read_b32 v75, a23
    v_pk_mul_f32 v[68:69], v[68:69], v[48:49]
    v_pk_mul_f32 v[70:71], v[70:71], v[48:49]
    v_pk_mul_f32 v[72:73], v[72:73], v[48:49]
    v_pk_mul_f32 v[74:75], v[74:75], v[48:49]
    v_cvt_pk_bf16_f32 v64, v68, v69
    v_cvt_pk_bf16_f32 v65, v70, v71
    v_cvt_pk_bf16_f32 v66, v72, v73
    v_cvt_pk_bf16_f32 v67, v74, v75
    buffer_store_dwordx4 v[64:67], v1, s[24:27], s48 offen sc1
    v_accvgpr_read_b32 v80, a36
    v_accvgpr_read_b32 v81, a37
    v_accvgpr_read_b32 v82, a38
    v_accvgpr_read_b32 v83, a39
    v_accvgpr_read_b32 v84, a52
    v_accvgpr_read_b32 v85, a53
    v_accvgpr_read_b32 v86, a54
    v_accvgpr_read_b32 v87, a55
    v_pk_mul_f32 v[80:81], v[80:81], v[48:49]
    v_pk_mul_f32 v[82:83], v[82:83], v[48:49]
    v_pk_mul_f32 v[84:85], v[84:85], v[48:49]
    v_pk_mul_f32 v[86:87], v[86:87], v[48:49]
    v_cvt_pk_bf16_f32 v76, v80, v81
    v_cvt_pk_bf16_f32 v77, v82, v83
    v_cvt_pk_bf16_f32 v78, v84, v85
    v_cvt_pk_bf16_f32 v79, v86, v87
    buffer_store_dwordx4 v[76:79], v1, s[24:27], s49 offen sc1
    v_accvgpr_read_b32 v68, a68
    v_accvgpr_read_b32 v69, a69
    v_accvgpr_read_b32 v70, a70
    v_accvgpr_read_b32 v71, a71
    v_accvgpr_read_b32 v72, a84
    v_accvgpr_read_b32 v73, a85
    v_accvgpr_read_b32 v74, a86
    v_accvgpr_read_b32 v75, a87
    v_pk_mul_f32 v[68:69], v[68:69], v[48:49]
    v_pk_mul_f32 v[70:71], v[70:71], v[48:49]
    v_pk_mul_f32 v[72:73], v[72:73], v[48:49]
    v_pk_mul_f32 v[74:75], v[74:75], v[48:49]
    v_cvt_pk_bf16_f32 v64, v68, v69
    v_cvt_pk_bf16_f32 v65, v70, v71
    v_cvt_pk_bf16_f32 v66, v72, v73
    v_cvt_pk_bf16_f32 v67, v74, v75
    buffer_store_dwordx4 v[64:67], v1, s[24:27], s50 offen sc1
    v_accvgpr_read_b32 v80, a100
    v_accvgpr_read_b32 v81, a101
    v_accvgpr_read_b32 v82, a102
    v_accvgpr_read_b32 v83, a103
    v_accvgpr_read_b32 v84, a116
    v_accvgpr_read_b32 v85, a117
    v_accvgpr_read_b32 v86, a118
    v_accvgpr_read_b32 v87, a119
    v_pk_mul_f32 v[80:81], v[80:81], v[48:49]
    v_pk_mul_f32 v[82:83], v[82:83], v[48:49]
    v_pk_mul_f32 v[84:85], v[84:85], v[48:49]
    v_pk_mul_f32 v[86:87], v[86:87], v[48:49]
    v_cvt_pk_bf16_f32 v76, v80, v81
    v_cvt_pk_bf16_f32 v77, v82, v83
    v_cvt_pk_bf16_f32 v78, v84, v85
    v_cvt_pk_bf16_f32 v79, v86, v87
    buffer_store_dwordx4 v[76:79], v1, s[24:27], s51 offen sc1
    s_nop 1
    s_lshr_b32 s31, s2, 3
    s_bfe_u32 s56, s2, 0x10002
    s_and_b32 s54, s2, 1
    s_lshl_b32 s54, s54, 3
    s_and_b32 s55, s31, 7
    s_add_u32 s54, s54, s55
    s_and_b32 s55, s2, 2
    s_lshl_b32 s55, s55, 1
    s_lshr_b32 s31, s31, 3
    s_add_u32 s55, s55, s31
    v_lshrrev_b32 v87, 4, v1
    v_lshrrev_b32 v72, 4, v87
    s_lshl_b32 s57, s54, 7
    s_lshl_b32 s31, s30, 5
    s_add_u32 s57, s57, s31
    s_lshl_b32 s31, s57, 6
    v_add_u32 v88, s31, v1
    v_add_u32 v89, 0x20000, v88
    v_bfe_u32 v84, v87, 1, 3
    v_xor_b32 v84, v84, v72
    v_and_b32 v85, 16, v1
    v_lshl_add_u32 v85, v72, 11, v85
    s_lshl_b32 s31, s30, 15
    s_lshl_b32 s58, s55, 8
    s_add_u32 s31, s31, s58
    v_add_u32 v85, s31, v85
    v_xor_b32 v86, 0, v84
    v_lshl_add_u32 v86, v86, 5, v85
    v_add_u32 v90, 0, v86
    v_xor_b32 v86, 4, v84
    v_lshl_add_u32 v86, v86, 5, v85
    v_add_u32 v91, 7168, v86
    v_xor_b32 v86, 0, v84
    v_lshl_add_u32 v86, v86, 5, v85
    v_add_u32 v92, 14336, v86
    v_xor_b32 v86, 4, v84
    v_lshl_add_u32 v86, v86, 5, v85
    v_add_u32 v93, 21504, v86
    v_and_b32 v84, 15, v87
    v_add_u32 v85, s57, v84
    v_lshlrev_b32 v77, 2, v85
    v_lshl_add_u32 v77, v72, 13, v77
    s_lshl_b32 s31, s56, 7
    s_add_u32 s58, s58, s31
    v_lshl_add_u32 v80, v72, 3, s58
    v_lshl_add_u32 v78, v85, 11, v80
    v_add_u32 v79, 0x8000, v78
    v_lshrrev_b32 v85, 2, v84
    v_lshl_add_u32 v85, v72, 2, v85
    v_and_b32 v84, 7, v85
    s_lshl_b32 s31, s56, 2
    v_xor_b32 v84, s31, v84
    v_lshlrev_b32 v85, 8, v85
    v_and_b32 v86, 3, v87
    v_lshl_add_u32 v85, v86, 3, v85
    s_add_u32 s31, s2, 1
    s_and_b32 s31, s31, 3
    v_add_u32 v73, s31, v86
    v_and_b32 v73, 3, v73
    v_lshlrev_b32 v73, 7, v73
    v_xor_b32 v86, 0, v84
    v_lshl_add_u32 v64, v86, 5, v85
    v_xor_b32 v86, 1, v84
    v_lshl_add_u32 v65, v86, 5, v85
    v_xor_b32 v86, 2, v84
    v_lshl_add_u32 v66, v86, 5, v85
    v_xor_b32 v86, 3, v84
    v_lshl_add_u32 v67, v86, 5, v85
    v_xor_b32 v86, 4, v84
    v_lshl_add_u32 v68, v86, 5, v85
    v_xor_b32 v86, 5, v84
    v_lshl_add_u32 v69, v86, 5, v85
    v_xor_b32 v86, 6, v84
    v_lshl_add_u32 v70, v86, 5, v85
    v_xor_b32 v86, 7, v84
    v_lshl_add_u32 v71, v86, 5, v85
    s_lshl_b32 s61, s31, 20
    s_lshl_b32 s62, s31, 21
    s_lshl_b32 s60, s30, 12
    s_lshl_b32 s59, s54, 10
    s_lshl_b32 s31, s56, 9
    s_add_u32 s59, s59, s31
    s_lshr_b32 s31, s28, 2
    s_lshl_b32 s31, s31, 7
    s_lshl_b32 s57, s29, 10
    s_sub_u32 s58, 0x3c00, s57
    s_add_u32 s57, s57, s31
    s_add_u32 s58, s58, s31
    v_mov_b32 v75, 0
    v_mov_b32 v76, 1
    s_lshl_b32 s31, s56, 23
    s_add_u32 s31, s31, 0x3000000
    s_add_u32 s8, s6, s31
    s_addc_u32 s9, s7, 0
    s_and_b32 s9, s9, 0xffff
    s_mov_b32 s10, 0x800000
    s_lshl_b32 s31, s56, 22
    s_waitcnt lgkmcnt(0)
    s_add_u32 s12, s4, s31
    s_addc_u32 s13, s5, 0
    s_and_b32 s13, s13, 0xffff
    s_mov_b32 s14, 0x400000
    s_load_dwordx2 s[4:5], s[0:1], 80
    v_mov_b32 v12, -1
    v_mov_b32 v13, -1
    v_mov_b32 v14, -1
    v_mov_b32 v15, -1
    s_waitcnt lgkmcnt(0)
    s_mov_b32 s26, -1
    s_lshl_b32 s31, s2, 14
    s_add_u32 s31, s31, s60
    s_add_u32 s40, s31, 0x2000000
    buffer_store_dwordx4 v[12:15], v1, s[24:27], s40 offen offset:0 sc1
    buffer_store_dwordx4 v[12:15], v1, s[24:27], s40 offen offset:1024 sc1
    buffer_store_dwordx4 v[12:15], v1, s[24:27], s40 offen offset:2048 sc1
    buffer_store_dwordx4 v[12:15], v1, s[24:27], s40 offen offset:3072 sc1
    s_lshr_b32 s31, s31, 1
    s_add_u32 s40, s31, 0x1900000
    buffer_store_dwordx4 v[12:15], v1, s[24:27], s40 offen offset:0 sc1
    buffer_store_dwordx4 v[12:15], v1, s[24:27], s40 offen offset:1024 sc1
    s_mov_b32 s26, 0x1000000
    s_and_b32 s31, s2, 7
    s_mul_i32 s31, s31, 28
    s_lshr_b32 s40, s2, 3
    s_add_u32 s31, s31, s40
    s_lshl_b32 s31, s31, 15
    s_lshl_b32 s40, s30, 13
    s_add_u32 s31, s31, s40
    s_mov_b32 s44, s4
    s_mov_b32 s47, 0x00020000
    s_and_b32 s45, s5, 0xffff
    s_cmp_ge_u32 s2, 224
    s_cselect_b32 s46, 0, 7340032
    s_add_u32 m0, s40, 131072
    s_nop 0
    buffer_load_dwordx4 v1, s[44:47], s31 offen offset:0 lds
    buffer_load_dwordx4 v1, s[44:47], s31 offen offset:1024 lds
    buffer_load_dwordx4 v1, s[44:47], s31 offen offset:2048 lds
    buffer_load_dwordx4 v1, s[44:47], s31 offen offset:3072 lds
    s_add_u32 s31, s31, 4096
    s_add_u32 m0, s40, 135168
    s_nop 0
    buffer_load_dwordx4 v1, s[44:47], s31 offen offset:0 lds
    buffer_load_dwordx4 v1, s[44:47], s31 offen offset:1024 lds
    buffer_load_dwordx4 v1, s[44:47], s31 offen offset:2048 lds
    buffer_load_dwordx4 v1, s[44:47], s31 offen offset:3072 lds
    s_add_u32 s31, s31, 4096
    s_lshl_b32 s63, s29, 1
    s_sub_u32 s63, 13, s63
    s_cbranch_scc1 k2_sdone_105
k2_sloop_104:
    v_mfma_f32_16x16x32_bf16 v[248:251], v[60:63], v[192:195], v[248:251]
    v_exp_f32 v232, v160
    v_mfma_f32_16x16x32_bf16 v[252:255], v[60:63], v[196:199], v[252:255]
    s_mov_b32 m0, s35
    ds_read_b128 a[224:227], v3 offset:8192
    v_mfma_f32_16x16x32_bf16 v[248:251], v[60:63], v[200:203], v[248:251]
    s_add_u32 s53, s53, 16384
    buffer_load_dwordx4 v1, s[20:23], s33 offen offset:0 sc1 lds
    ds_read_b128 a[228:231], v3 offset:9216
    v_mfma_f32_16x16x32_bf16 v[252:255], v[60:63], v[204:207], v[252:255]
    s_waitcnt lgkmcnt(8)
    v_exp_f32 v233, v161
    v_mfma_f32_16x16x32_bf16 a[8:11], a[192:195], v[192:195], a[8:11]
    s_and_b32 s53, s53, 0xffff
    v_exp_f32 v234, v162
    v_mfma_f32_16x16x32_bf16 a[12:15], a[192:195], v[196:199], a[12:15]
    ds_read_b128 a[232:235], v3 offset:10240
    v_cvt_pk_bf16_f32 v208, v232, v233
    v_mfma_f32_16x16x32_bf16 a[24:27], a[196:199], v[192:195], a[24:27]
    v_exp_f32 v235, v163
    v_mfma_f32_16x16x32_bf16 a[28:31], a[196:199], v[196:199], a[28:31]
    s_waitcnt lgkmcnt(7)
    ds_read_b128 a[236:239], v3 offset:11264
    v_cvt_pk_bf16_f32 v209, v234, v235
    v_mfma_f32_16x16x32_bf16 a[40:43], a[200:203], v[192:195], a[40:43]
    s_add_u32 s35, s35, 0x4000
    v_exp_f32 v236, v176
    v_mfma_f32_16x16x32_bf16 a[44:47], a[200:203], v[196:199], a[44:47]
    buffer_load_dwordx4 v1, s[20:23], s33 offen offset:1024 sc1 lds
    ds_read_b128 a[240:243], v3 offset:12288
    v_mfma_f32_16x16x32_bf16 a[56:59], a[204:207], v[192:195], a[56:59]
    v_exp_f32 v237, v177
    v_mfma_f32_16x16x32_bf16 a[60:63], a[204:207], v[196:199], a[60:63]
    s_waitcnt lgkmcnt(7)
    ds_read_b128 a[244:247], v3 offset:13312
    v_cvt_pk_bf16_f32 v210, v236, v237
    v_mfma_f32_16x16x32_bf16 a[72:75], a[208:211], v[192:195], a[72:75]
    v_exp_f32 v238, v178
    v_mfma_f32_16x16x32_bf16 a[76:79], a[208:211], v[196:199], a[76:79]
    ds_read_b128 a[248:251], v3 offset:14336
    v_or3_b32 v57, v208, v209, v210
    v_mfma_f32_16x16x32_bf16 a[88:91], a[212:215], v[192:195], a[88:91]
    v_exp_f32 v239, v179
    v_mfma_f32_16x16x32_bf16 a[92:95], a[212:215], v[196:199], a[92:95]
    s_waitcnt lgkmcnt(7)
    ds_read_b128 a[252:255], v3 offset:15360
    v_cvt_pk_bf16_f32 v211, v238, v239
    v_mfma_f32_16x16x32_bf16 a[104:107], a[216:219], v[192:195], a[104:107]
    s_and_b32 s35, s35, 0xffff
    v_exp_f32 v240, v164
    v_mfma_f32_16x16x32_bf16 a[108:111], a[216:219], v[196:199], a[108:111]
    ds_read_b128 a[128:131], v2 offset:0
    v_add_u32 v3, s53, v56
    v_mfma_f32_16x16x32_bf16 a[120:123], a[220:223], v[192:195], a[120:123]
    v_exp_f32 v241, v165
    v_mfma_f32_16x16x32_bf16 a[124:127], a[220:223], v[196:199], a[124:127]
    s_waitcnt lgkmcnt(7)
    buffer_load_dwordx4 v1, s[20:23], s33 offen offset:2048 sc1 lds
    ds_read_b128 a[132:135], v2 offset:1024
    v_mfma_f32_16x16x32_bf16 a[8:11], a[224:227], v[200:203], a[8:11]
    v_exp_f32 v242, v166
    v_mfma_f32_16x16x32_bf16 a[12:15], a[224:227], v[204:207], a[12:15]
    s_or_b32 s35, s35, 0x10000
    ds_read_b128 a[136:139], v2 offset:2048
    v_cvt_pk_bf16_f32 v212, v240, v241
    v_mfma_f32_16x16x32_bf16 a[24:27], a[228:231], v[200:203], a[24:27]
    v_exp_f32 v243, v167
    v_mfma_f32_16x16x32_bf16 a[28:31], a[228:231], v[204:207], a[28:31]
    s_waitcnt lgkmcnt(7)
    ds_read_b128 a[140:143], v2 offset:3072
    v_or3_b32 v57, v57, v211, v212
    v_mfma_f32_16x16x32_bf16 a[40:43], a[232:235], v[200:203], a[40:43]
    v_exp_f32 v244, v180
    v_mfma_f32_16x16x32_bf16 a[44:47], a[232:235], v[204:207], a[44:47]
    ds_read_b128 a[144:147], v2 offset:4096
    v_cvt_pk_bf16_f32 v213, v242, v243
    v_mfma_f32_16x16x32_bf16 a[56:59], a[236:239], v[200:203], a[56:59]
    v_exp_f32 v245, v181
    v_mfma_f32_16x16x32_bf16 a[60:63], a[236:239], v[204:207], a[60:63]
    s_waitcnt lgkmcnt(7)
    buffer_load_dwordx4 v1, s[20:23], s33 offen offset:3072 sc1 lds
    ds_read_b128 a[148:151], v2 offset:5120
    v_mfma_f32_16x16x32_bf16 a[72:75], a[240:243], v[200:203], a[72:75]
    s_add_u32 s33, s33, 0x80000
    v_exp_f32 v246, v182
    v_mfma_f32_16x16x32_bf16 a[76:79], a[240:243], v[204:207], a[76:79]
    ds_read_b128 a[152:155], v2 offset:6144
    v_cvt_pk_bf16_f32 v214, v244, v245
    v_mfma_f32_16x16x32_bf16 a[88:91], a[244:247], v[200:203], a[88:91]
    v_exp_f32 v247, v183
    v_mfma_f32_16x16x32_bf16 a[92:95], a[244:247], v[204:207], a[92:95]
    s_waitcnt lgkmcnt(7)
    ds_read_b128 a[156:159], v2 offset:7168
    v_or3_b32 v57, v57, v213, v214
    v_mfma_f32_16x16x32_bf16 a[104:107], a[248:251], v[200:203], a[104:107]
    v_exp_f32 v232, v168
    v_mfma_f32_16x16x32_bf16 a[108:111], a[248:251], v[204:207], a[108:111]
    ds_read_b128 a[160:163], v2 offset:8192
    v_cvt_pk_bf16_f32 v215, v246, v247
    v_mfma_f32_16x16x32_bf16 a[120:123], a[252:255], v[200:203], a[120:123]
    v_exp_f32 v233, v169
    v_mfma_f32_16x16x32_bf16 a[124:127], a[252:255], v[204:207], a[124:127]
    s_waitcnt lgkmcnt(7)
    ds_read_b128 a[164:167], v2 offset:9216
    v_cvt_pk_bf16_f32 v216, v232, v233
    v_mfma_f32_16x16x32_bf16 v[128:131], a[128:131], v[96:99], v[16:19]
    s_waitcnt vmcnt(12)
    s_barrier
    v_exp_f32 v234, v170
    v_mfma_f32_16x16x32_bf16 v[132:135], a[128:131], v[112:115], v[20:23]
    s_mov_b32 m0, s34
    ds_read_b128 a[168:171], v2 offset:10240
    v_or3_b32 v57, v57, v215, v216
    v_mfma_f32_16x16x32_bf16 v[128:131], a[132:135], v[100:103], v[128:131]
    buffer_load_dwordx4 v1, s[16:19], s32 offen offset:0 sc1 lds
    ds_read_b128 a[172:175], v2 offset:11264
    v_mfma_f32_16x16x32_bf16 v[132:135], a[132:135], v[116:119], v[132:135]
    s_waitcnt lgkmcnt(8)
    v_exp_f32 v235, v171
    v_mfma_f32_16x16x32_bf16 v[128:131], a[136:139], v[104:107], v[128:131]
    s_add_u32 s36, s36, 64
    v_exp_f32 v236, v184
    v_mfma_f32_16x16x32_bf16 v[132:135], a[136:139], v[120:123], v[132:135]
    ds_read_b128 a[176:179], v2 offset:12288
    v_cvt_pk_bf16_f32 v217, v234, v235
    v_mfma_f32_16x16x32_bf16 v[128:131], a[140:143], v[108:111], v[128:131]
    s_add_u32 s52, s52, 16384
    v_exp_f32 v237, v185
    v_mfma_f32_16x16x32_bf16 v[132:135], a[140:143], v[124:127], v[132:135]
    s_waitcnt lgkmcnt(7)
    ds_read_b128 a[180:183], v2 offset:13312
    v_cvt_pk_bf16_f32 v218, v236, v237
    v_mfma_f32_16x16x32_bf16 v[144:147], a[144:147], v[96:99], v[32:35]
    s_add_u32 s34, s34, 0x4000
    v_exp_f32 v238, v186
    v_mfma_f32_16x16x32_bf16 v[148:151], a[144:147], v[112:115], v[36:39]
    s_and_b32 s52, s52, 0xffff
    buffer_load_dwordx4 v1, s[16:19], s32 offen offset:1024 sc1 lds
    ds_read_b128 a[184:187], v2 offset:14336
    v_mfma_f32_16x16x32_bf16 v[144:147], a[148:151], v[100:103], v[144:147]
    v_exp_f32 v239, v187
    v_mfma_f32_16x16x32_bf16 v[148:151], a[148:151], v[116:119], v[148:151]
    s_waitcnt lgkmcnt(7)
    ds_read_b128 a[188:191], v2 offset:15360
    v_or3_b32 v57, v57, v217, v218
    v_mfma_f32_16x16x32_bf16 v[144:147], a[152:155], v[104:107], v[144:147]
    v_exp_f32 v240, v172
    v_mfma_f32_16x16x32_bf16 v[148:151], a[152:155], v[120:123], v[148:151]
    v_cvt_pk_bf16_f32 v219, v238, v239
    v_add_u32 v2, s52, v1
    v_mfma_f32_16x16x32_bf16 v[144:147], a[156:159], v[108:111], v[144:147]
    s_and_b32 s34, s34, 0xffff
    v_exp_f32 v241, v173
    v_mfma_f32_16x16x32_bf16 v[148:151], a[156:159], v[124:127], v[148:151]
    s_waitcnt lgkmcnt(6)
    ds_read_b128 a[192:195], v3 offset:0
    v_cvt_pk_bf16_f32 v220, v240, v241
    v_mfma_f32_16x16x32_bf16 v[136:139], a[160:163], v[96:99], v[24:27]
    v_exp_f32 v242, v174
    v_mfma_f32_16x16x32_bf16 v[140:143], a[160:163], v[112:115], v[28:31]
    buffer_load_dwordx4 v1, s[16:19], s32 offen offset:2048 sc1 lds
    ds_read_b128 a[196:199], v3 offset:1024
    v_mfma_f32_16x16x32_bf16 v[136:139], a[164:167], v[100:103], v[136:139]
    v_exp_f32 v243, v175
    v_mfma_f32_16x16x32_bf16 v[140:143], a[164:167], v[116:119], v[140:143]
    s_waitcnt lgkmcnt(6)
    ds_read_b128 a[200:203], v3 offset:2048
    v_or3_b32 v57, v57, v219, v220
    v_mfma_f32_16x16x32_bf16 v[136:139], a[168:171], v[104:107], v[136:139]
    v_exp_f32 v244, v188
    v_mfma_f32_16x16x32_bf16 v[140:143], a[168:171], v[120:123], v[140:143]
    ds_read_b128 a[204:207], v3 offset:3072
    v_cvt_pk_bf16_f32 v221, v242, v243
    v_mfma_f32_16x16x32_bf16 v[136:139], a[172:175], v[108:111], v[136:139]
    v_exp_f32 v245, v189
    v_mfma_f32_16x16x32_bf16 v[140:143], a[172:175], v[124:127], v[140:143]
    s_waitcnt lgkmcnt(6)
    buffer_load_dwordx4 v1, s[16:19], s32 offen offset:3072 sc1 lds
    ds_read_b128 a[208:211], v3 offset:4096
    v_mfma_f32_16x16x32_bf16 v[152:155], a[176:179], v[96:99], v[40:43]
    s_add_u32 s32, s32, 0x80000
    v_exp_f32 v246, v190
    v_mfma_f32_16x16x32_bf16 v[156:159], a[176:179], v[112:115], v[44:47]
    ds_read_b128 a[212:215], v3 offset:5120
    v_cvt_pk_bf16_f32 v222, v244, v245
    v_mfma_f32_16x16x32_bf16 v[152:155], a[180:183], v[100:103], v[152:155]
    v_exp_f32 v247, v191
    v_mfma_f32_16x16x32_bf16 v[156:159], a[180:183], v[116:119], v[156:159]
    s_waitcnt lgkmcnt(6)
    ds_read_b128 a[216:219], v3 offset:6144
    v_or3_b32 v57, v57, v221, v222
    v_mfma_f32_16x16x32_bf16 v[152:155], a[184:187], v[104:107], v[152:155]
    ds_read_b128 a[220:223], v3 offset:7168
    v_cvt_pk_bf16_f32 v223, v246, v247
    v_mfma_f32_16x16x32_bf16 v[156:159], a[184:187], v[120:123], v[156:159]
    v_bitop3_b32 v57, v57, v223, s37 bitop3:0xa8
    v_cmp_ne_u32 vcc, 0, v57
    v_mfma_f32_16x16x32_bf16 v[152:155], a[188:191], v[108:111], v[152:155]
    v_mfma_f32_16x16x32_bf16 v[156:159], a[188:191], v[124:127], v[156:159]
    s_cbranch_vccnz k2_tramp_106
k2_ret_107:
    v_mfma_f32_16x16x32_bf16 v[248:251], v[60:63], v[208:211], v[248:251]
    v_exp_f32 v232, v128
    v_mfma_f32_16x16x32_bf16 v[252:255], v[60:63], v[212:215], v[252:255]
    s_mov_b32 m0, s35
    ds_read_b128 a[224:227], v3 offset:8192
    v_mfma_f32_16x16x32_bf16 v[248:251], v[60:63], v[216:219], v[248:251]
    s_add_u32 s53, s53, 16384
    buffer_load_dwordx4 v1, s[20:23], s33 offen offset:0 sc1 lds
    ds_read_b128 a[228:231], v3 offset:9216
    v_mfma_f32_16x16x32_bf16 v[252:255], v[60:63], v[220:223], v[252:255]
    s_waitcnt lgkmcnt(8)
    v_exp_f32 v233, v129
    v_mfma_f32_16x16x32_bf16 a[8:11], a[192:195], v[208:211], a[8:11]
    s_and_b32 s53, s53, 0xffff
    v_exp_f32 v234, v130
    v_mfma_f32_16x16x32_bf16 a[12:15], a[192:195], v[212:215], a[12:15]
    ds_read_b128 a[232:235], v3 offset:10240
    v_cvt_pk_bf16_f32 v192, v232, v233
    v_mfma_f32_16x16x32_bf16 a[24:27], a[196:199], v[208:211], a[24:27]
    v_exp_f32 v235, v131
    v_mfma_f32_16x16x32_bf16 a[28:31], a[196:199], v[212:215], a[28:31]
    s_waitcnt lgkmcnt(7)
    ds_read_b128 a[236:239], v3 offset:11264
    v_cvt_pk_bf16_f32 v193, v234, v235
    v_mfma_f32_16x16x32_bf16 a[40:43], a[200:203], v[208:211], a[40:43]
    s_add_u32 s35, s35, 0x4000
    v_exp_f32 v236, v144
    v_mfma_f32_16x16x32_bf16 a[44:47], a[200:203], v[212:215], a[44:47]
    buffer_load_dwordx4 v1, s[20:23], s33 offen offset:1024 sc1 lds
    ds_read_b128 a[240:243], v3 offset:12288
    v_mfma_f32_16x16x32_bf16 a[56:59], a[204:207], v[208:211], a[56:59]
    v_exp_f32 v237, v145
    v_mfma_f32_16x16x32_bf16 a[60:63], a[204:207], v[212:215], a[60:63]
    s_waitcnt lgkmcnt(7)
    ds_read_b128 a[244:247], v3 offset:13312
    v_cvt_pk_bf16_f32 v194, v236, v237
    v_mfma_f32_16x16x32_bf16 a[72:75], a[208:211], v[208:211], a[72:75]
    v_exp_f32 v238, v146
    v_mfma_f32_16x16x32_bf16 a[76:79], a[208:211], v[212:215], a[76:79]
    ds_read_b128 a[248:251], v3 offset:14336
    v_or3_b32 v57, v192, v193, v194
    v_mfma_f32_16x16x32_bf16 a[88:91], a[212:215], v[208:211], a[88:91]
    v_exp_f32 v239, v147
    v_mfma_f32_16x16x32_bf16 a[92:95], a[212:215], v[212:215], a[92:95]
    s_waitcnt lgkmcnt(7)
    ds_read_b128 a[252:255], v3 offset:15360
    v_cvt_pk_bf16_f32 v195, v238, v239
    v_mfma_f32_16x16x32_bf16 a[104:107], a[216:219], v[208:211], a[104:107]
    s_and_b32 s35, s35, 0xffff
    v_exp_f32 v240, v132
    v_mfma_f32_16x16x32_bf16 a[108:111], a[216:219], v[212:215], a[108:111]
    ds_read_b128 a[128:131], v2 offset:0
    v_add_u32 v3, s53, v56
    v_mfma_f32_16x16x32_bf16 a[120:123], a[220:223], v[208:211], a[120:123]
    v_exp_f32 v241, v133
    v_mfma_f32_16x16x32_bf16 a[124:127], a[220:223], v[212:215], a[124:127]
    s_waitcnt lgkmcnt(7)
    buffer_load_dwordx4 v1, s[20:23], s33 offen offset:2048 sc1 lds
    ds_read_b128 a[132:135], v2 offset:1024
    v_mfma_f32_16x16x32_bf16 a[8:11], a[224:227], v[216:219], a[8:11]
    v_exp_f32 v242, v134
    v_mfma_f32_16x16x32_bf16 a[12:15], a[224:227], v[220:223], a[12:15]
    s_or_b32 s35, s35, 0x10000
    ds_read_b128 a[136:139], v2 offset:2048
    v_cvt_pk_bf16_f32 v196, v240, v241
    v_mfma_f32_16x16x32_bf16 a[24:27], a[228:231], v[216:219], a[24:27]
    v_exp_f32 v243, v135
    v_mfma_f32_16x16x32_bf16 a[28:31], a[228:231], v[220:223], a[28:31]
    s_waitcnt lgkmcnt(7)
    ds_read_b128 a[140:143], v2 offset:3072
    v_or3_b32 v57, v57, v195, v196
    v_mfma_f32_16x16x32_bf16 a[40:43], a[232:235], v[216:219], a[40:43]
    v_exp_f32 v244, v148
    v_mfma_f32_16x16x32_bf16 a[44:47], a[232:235], v[220:223], a[44:47]
    ds_read_b128 a[144:147], v2 offset:4096
    v_cvt_pk_bf16_f32 v197, v242, v243
    v_mfma_f32_16x16x32_bf16 a[56:59], a[236:239], v[216:219], a[56:59]
    v_exp_f32 v245, v149
    v_mfma_f32_16x16x32_bf16 a[60:63], a[236:239], v[220:223], a[60:63]
    s_waitcnt lgkmcnt(7)
    buffer_load_dwordx4 v1, s[20:23], s33 offen offset:3072 sc1 lds
    ds_read_b128 a[148:151], v2 offset:5120
    v_mfma_f32_16x16x32_bf16 a[72:75], a[240:243], v[216:219], a[72:75]
    s_add_u32 s33, s33, 0x80000
    v_exp_f32 v246, v150
    v_mfma_f32_16x16x32_bf16 a[76:79], a[240:243], v[220:223], a[76:79]
    ds_read_b128 a[152:155], v2 offset:6144
    v_cvt_pk_bf16_f32 v198, v244, v245
    v_mfma_f32_16x16x32_bf16 a[88:91], a[244:247], v[216:219], a[88:91]
    v_exp_f32 v247, v151
    v_mfma_f32_16x16x32_bf16 a[92:95], a[244:247], v[220:223], a[92:95]
    s_waitcnt lgkmcnt(7)
    ds_read_b128 a[156:159], v2 offset:7168
    v_or3_b32 v57, v57, v197, v198
    v_mfma_f32_16x16x32_bf16 a[104:107], a[248:251], v[216:219], a[104:107]
    v_exp_f32 v232, v136
    v_mfma_f32_16x16x32_bf16 a[108:111], a[248:251], v[220:223], a[108:111]
    ds_read_b128 a[160:163], v2 offset:8192
    v_cvt_pk_bf16_f32 v199, v246, v247
    v_mfma_f32_16x16x32_bf16 a[120:123], a[252:255], v[216:219], a[120:123]
    v_exp_f32 v233, v137
    v_mfma_f32_16x16x32_bf16 a[124:127], a[252:255], v[220:223], a[124:127]
    s_waitcnt lgkmcnt(7)
    ds_read_b128 a[164:167], v2 offset:9216
    v_cvt_pk_bf16_f32 v200, v232, v233
    v_mfma_f32_16x16x32_bf16 v[160:163], a[128:131], v[96:99], v[16:19]
    s_waitcnt vmcnt(12)
    s_barrier
    v_exp_f32 v234, v138
    v_mfma_f32_16x16x32_bf16 v[164:167], a[128:131], v[112:115], v[20:23]
    s_mov_b32 m0, s34
    ds_read_b128 a[168:171], v2 offset:10240
    v_or3_b32 v57, v57, v199, v200
    v_mfma_f32_16x16x32_bf16 v[160:163], a[132:135], v[100:103], v[160:163]
    buffer_load_dwordx4 v1, s[16:19], s32 offen offset:0 sc1 lds
    ds_read_b128 a[172:175], v2 offset:11264
    v_mfma_f32_16x16x32_bf16 v[164:167], a[132:135], v[116:119], v[164:167]
    s_waitcnt lgkmcnt(8)
    v_exp_f32 v235, v139
    v_mfma_f32_16x16x32_bf16 v[160:163], a[136:139], v[104:107], v[160:163]
    s_add_u32 s36, s36, 64
    v_exp_f32 v236, v152
    v_mfma_f32_16x16x32_bf16 v[164:167], a[136:139], v[120:123], v[164:167]
    ds_read_b128 a[176:179], v2 offset:12288
    v_cvt_pk_bf16_f32 v201, v234, v235
    v_mfma_f32_16x16x32_bf16 v[160:163], a[140:143], v[108:111], v[160:163]
    s_add_u32 s52, s52, 16384
    v_exp_f32 v237, v153
    v_mfma_f32_16x16x32_bf16 v[164:167], a[140:143], v[124:127], v[164:167]
    s_waitcnt lgkmcnt(7)
    ds_read_b128 a[180:183], v2 offset:13312
    v_cvt_pk_bf16_f32 v202, v236, v237
    v_mfma_f32_16x16x32_bf16 v[176:179], a[144:147], v[96:99], v[32:35]
    s_add_u32 s34, s34, 0x4000
    v_exp_f32 v238, v154
    v_mfma_f32_16x16x32_bf16 v[180:183], a[144:147], v[112:115], v[36:39]
    s_and_b32 s52, s52, 0xffff
    buffer_load_dwordx4 v1, s[16:19], s32 offen offset:1024 sc1 lds
    ds_read_b128 a[184:187], v2 offset:14336
    v_mfma_f32_16x16x32_bf16 v[176:179], a[148:151], v[100:103], v[176:179]
    v_exp_f32 v239, v155
    v_mfma_f32_16x16x32_bf16 v[180:183], a[148:151], v[116:119], v[180:183]
    s_waitcnt lgkmcnt(7)
    ds_read_b128 a[188:191], v2 offset:15360
    v_or3_b32 v57, v57, v201, v202
    v_mfma_f32_16x16x32_bf16 v[176:179], a[152:155], v[104:107], v[176:179]
    v_exp_f32 v240, v140
    v_mfma_f32_16x16x32_bf16 v[180:183], a[152:155], v[120:123], v[180:183]
    v_cvt_pk_bf16_f32 v203, v238, v239
    v_add_u32 v2, s52, v1
    v_mfma_f32_16x16x32_bf16 v[176:179], a[156:159], v[108:111], v[176:179]
    s_and_b32 s34, s34, 0xffff
    v_exp_f32 v241, v141
    v_mfma_f32_16x16x32_bf16 v[180:183], a[156:159], v[124:127], v[180:183]
    s_waitcnt lgkmcnt(6)
    ds_read_b128 a[192:195], v3 offset:0
    v_cvt_pk_bf16_f32 v204, v240, v241
    v_mfma_f32_16x16x32_bf16 v[168:171], a[160:163], v[96:99], v[24:27]
    v_exp_f32 v242, v142
    v_mfma_f32_16x16x32_bf16 v[172:175], a[160:163], v[112:115], v[28:31]
    buffer_load_dwordx4 v1, s[16:19], s32 offen offset:2048 sc1 lds
    ds_read_b128 a[196:199], v3 offset:1024
    v_mfma_f32_16x16x32_bf16 v[168:171], a[164:167], v[100:103], v[168:171]
    v_exp_f32 v243, v143
    v_mfma_f32_16x16x32_bf16 v[172:175], a[164:167], v[116:119], v[172:175]
    s_waitcnt lgkmcnt(6)
    ds_read_b128 a[200:203], v3 offset:2048
    v_or3_b32 v57, v57, v203, v204
    v_mfma_f32_16x16x32_bf16 v[168:171], a[168:171], v[104:107], v[168:171]
    v_exp_f32 v244, v156
    v_mfma_f32_16x16x32_bf16 v[172:175], a[168:171], v[120:123], v[172:175]
    ds_read_b128 a[204:207], v3 offset:3072
    v_cvt_pk_bf16_f32 v205, v242, v243
    v_mfma_f32_16x16x32_bf16 v[168:171], a[172:175], v[108:111], v[168:171]
    v_exp_f32 v245, v157
    v_mfma_f32_16x16x32_bf16 v[172:175], a[172:175], v[124:127], v[172:175]
    s_waitcnt lgkmcnt(6)
    buffer_load_dwordx4 v1, s[16:19], s32 offen offset:3072 sc1 lds
    ds_read_b128 a[208:211], v3 offset:4096
    v_mfma_f32_16x16x32_bf16 v[184:187], a[176:179], v[96:99], v[40:43]
    s_sub_u32 s63, s63, 1
    v_exp_f32 v246, v158
    v_mfma_f32_16x16x32_bf16 v[188:191], a[176:179], v[112:115], v[44:47]
    s_add_u32 s32, s32, 0x80000
    ds_read_b128 a[212:215], v3 offset:5120
    v_cvt_pk_bf16_f32 v206, v244, v245
    v_mfma_f32_16x16x32_bf16 v[184:187], a[180:183], v[100:103], v[184:187]
    v_exp_f32 v247, v159
    v_mfma_f32_16x16x32_bf16 v[188:191], a[180:183], v[116:119], v[188:191]
    s_waitcnt lgkmcnt(6)
    ds_read_b128 a[216:219], v3 offset:6144
    v_or3_b32 v57, v57, v205, v206
    v_mfma_f32_16x16x32_bf16 v[184:187], a[184:187], v[104:107], v[184:187]
    ds_read_b128 a[220:223], v3 offset:7168
    v_cvt_pk_bf16_f32 v207, v246, v247
    v_mfma_f32_16x16x32_bf16 v[188:191], a[184:187], v[120:123], v[188:191]
    v_bitop3_b32 v57, v57, v207, s37 bitop3:0xa8
    v_cmp_ne_u32 vcc, 0, v57
    v_mfma_f32_16x16x32_bf16 v[184:187], a[188:191], v[108:111], v[184:187]
    v_mfma_f32_16x16x32_bf16 v[188:191], a[188:191], v[124:127], v[188:191]
    s_cbranch_vccnz k2_tramp_108
k2_ret_109:
    s_cmp_lg_u32 s63, 0
    s_cbranch_scc1 k2_sloop_104
    v_mfma_f32_16x16x32_bf16 v[248:251], v[60:63], v[192:195], v[248:251]
    v_exp_f32 v232, v160
    v_mfma_f32_16x16x32_bf16 v[252:255], v[60:63], v[196:199], v[252:255]
    s_mov_b32 m0, s35
    ds_read_b128 a[224:227], v3 offset:8192
    v_exp_f32 v233, v161
    v_mfma_f32_16x16x32_bf16 v[248:251], v[60:63], v[200:203], v[248:251]
    s_add_u32 s53, s53, 16384
    buffer_load_dwordx4 v1, s[20:23], s33 offen offset:0 sc1 lds
    ds_read_b128 a[228:231], v3 offset:9216
    v_mfma_f32_16x16x32_bf16 v[252:255], v[60:63], v[204:207], v[252:255]
    s_waitcnt lgkmcnt(8)
    v_exp_f32 v234, v162
    v_cvt_pk_bf16_f32 v208, v232, v233
    v_mfma_f32_16x16x32_bf16 a[8:11], a[192:195], v[192:195], a[8:11]
    s_sub_u32 s40, s36, s39
    ds_read_b128 a[232:235], v3 offset:10240
    v_mfma_f32_16x16x32_bf16 a[12:15], a[192:195], v[196:199], a[12:15]
    s_and_b32 s53, s53, 0xffff
    v_subrev_u32 v6, s40, v4
    v_cmp_gt_i32 s[44:45], 0, v6
    v_mfma_f32_16x16x32_bf16 a[24:27], a[196:199], v[192:195], a[24:27]
    v_exp_f32 v235, v163
    v_cmp_gt_i32 s[46:47], 1, v6
    v_mfma_f32_16x16x32_bf16 a[28:31], a[196:199], v[196:199], a[28:31]
    s_waitcnt lgkmcnt(7)
    ds_read_b128 a[236:239], v3 offset:11264
    v_cmp_gt_i32 s[48:49], 2, v6
    v_cmp_gt_i32 s[50:51], 3, v6
    v_mfma_f32_16x16x32_bf16 a[40:43], a[200:203], v[192:195], a[40:43]
    s_add_u32 s35, s35, 0x4000
    v_exp_f32 v236, v176
    v_mfma_f32_16x16x32_bf16 a[44:47], a[200:203], v[196:199], a[44:47]
    ds_read_b128 a[240:243], v3 offset:12288
    v_cvt_pk_bf16_f32 v209, v234, v235
    v_cndmask_b32 v16, v10, v5, s[44:45]
    v_mfma_f32_16x16x32_bf16 a[56:59], a[204:207], v[192:195], a[56:59]
    v_exp_f32 v237, v177
    v_mfma_f32_16x16x32_bf16 a[60:63], a[204:207], v[196:199], a[60:63]
    s_waitcnt lgkmcnt(7)
    ds_read_b128 a[244:247], v3 offset:13312
    v_cndmask_b32 v17, v10, v5, s[46:47]
    v_cndmask_b32 v18, v10, v5, s[48:49]
    v_mfma_f32_16x16x32_bf16 a[72:75], a[208:211], v[192:195], a[72:75]
    buffer_load_dwordx4 v1, s[20:23], s33 offen offset:1024 sc1 lds
    ds_read_b128 a[248:251], v3 offset:14336
    v_mfma_f32_16x16x32_bf16 a[76:79], a[208:211], v[196:199], a[76:79]
    v_cndmask_b32 v19, v10, v5, s[50:51]
    v_cvt_pk_bf16_f32 v210, v236, v237
    v_mfma_f32_16x16x32_bf16 a[88:91], a[212:215], v[192:195], a[88:91]
    v_exp_f32 v238, v178
    v_cmp_gt_i32 s[44:45], 16, v6
    v_mfma_f32_16x16x32_bf16 a[92:95], a[212:215], v[196:199], a[92:95]
    s_waitcnt lgkmcnt(7)
    v_cmp_gt_i32 s[46:47], 17, v6
    v_cmp_gt_i32 s[48:49], 18, v6
    v_mfma_f32_16x16x32_bf16 a[104:107], a[216:219], v[192:195], a[104:107]
    s_and_b32 s35, s35, 0xffff
    v_exp_f32 v239, v179
    v_mfma_f32_16x16x32_bf16 a[108:111], a[216:219], v[196:199], a[108:111]
    ds_read_b128 a[252:255], v3 offset:15360
    v_or3_b32 v57, v208, v209, v210
    v_cmp_gt_i32 s[50:51], 19, v6
    v_mfma_f32_16x16x32_bf16 a[120:123], a[220:223], v[192:195], a[120:123]
    v_exp_f32 v240, v164
    v_mfma_f32_16x16x32_bf16 a[124:127], a[220:223], v[196:199], a[124:127]
    s_waitcnt lgkmcnt(6)
    v_cndmask_b32 v32, v10, v5, s[44:45]
    v_cvt_pk_bf16_f32 v211, v238, v239
    v_cndmask_b32 v33, v10, v5, s[46:47]
    v_mfma_f32_16x16x32_bf16 a[8:11], a[224:227], v[200:203], a[8:11]
    ds_read_b128 a[128:131], v2 offset:0
    v_cndmask_b32 v34, v10, v5, s[48:49]
    v_mfma_f32_16x16x32_bf16 a[12:15], a[224:227], v[204:207], a[12:15]
    s_or_b32 s35, s35, 0x10000
    v_add_u32 v3, s53, v56
    v_cndmask_b32 v35, v10, v5, s[50:51]
    v_mfma_f32_16x16x32_bf16 a[24:27], a[228:231], v[200:203], a[24:27]
    buffer_load_dwordx4 v1, s[20:23], s33 offen offset:2048 sc1 lds
    v_exp_f32 v241, v165
    v_mfma_f32_16x16x32_bf16 a[28:31], a[228:231], v[204:207], a[28:31]
    s_waitcnt lgkmcnt(5)
    ds_read_b128 a[132:135], v2 offset:1024
    v_cmp_gt_i32 s[44:45], 32, v6
    v_mfma_f32_16x16x32_bf16 a[40:43], a[232:235], v[200:203], a[40:43]
    v_exp_f32 v242, v166
    v_cmp_gt_i32 s[46:47], 33, v6
    v_mfma_f32_16x16x32_bf16 a[44:47], a[232:235], v[204:207], a[44:47]
    ds_read_b128 a[136:139], v2 offset:2048
    v_cvt_pk_bf16_f32 v212, v240, v241
    v_mfma_f32_16x16x32_bf16 a[56:59], a[236:239], v[200:203], a[56:59]
    v_cmp_gt_i32 s[48:49], 34, v6
    v_cmp_gt_i32 s[50:51], 35, v6
    v_mfma_f32_16x16x32_bf16 a[60:63], a[236:239], v[204:207], a[60:63]
    s_waitcnt lgkmcnt(5)
    v_exp_f32 v243, v167
    v_or3_b32 v57, v57, v211, v212
    v_mfma_f32_16x16x32_bf16 a[72:75], a[240:243], v[200:203], a[72:75]
    ds_read_b128 a[140:143], v2 offset:3072
    v_cndmask_b32 v24, v10, v5, s[44:45]
    v_mfma_f32_16x16x32_bf16 a[76:79], a[240:243], v[204:207], a[76:79]
    v_cndmask_b32 v25, v10, v5, s[46:47]
    v_exp_f32 v244, v180
    v_mfma_f32_16x16x32_bf16 a[88:91], a[244:247], v[200:203], a[88:91]
    v_cvt_pk_bf16_f32 v213, v242, v243
    v_cndmask_b32 v26, v10, v5, s[48:49]
    v_mfma_f32_16x16x32_bf16 a[92:95], a[244:247], v[204:207], a[92:95]
    s_waitcnt lgkmcnt(4)
    ds_read_b128 a[144:147], v2 offset:4096
    v_cndmask_b32 v27, v10, v5, s[50:51]
    v_mfma_f32_16x16x32_bf16 a[104:107], a[248:251], v[200:203], a[104:107]
    v_exp_f32 v245, v181
    v_cmp_gt_i32 s[44:45], 48, v6
    v_mfma_f32_16x16x32_bf16 a[108:111], a[248:251], v[204:207], a[108:111]
    buffer_load_dwordx4 v1, s[20:23], s33 offen offset:3072 sc1 lds
    ds_read_b128 a[148:151], v2 offset:5120
    ds_read_b128 a[152:155], v2 offset:6144
    v_cmp_gt_i32 s[46:47], 49, v6
    s_add_u32 s33, s33, 0x80000
    v_cmp_gt_i32 s[48:49], 50, v6
    v_exp_f32 v246, v182
    v_cvt_pk_bf16_f32 v214, v244, v245
    v_cmp_gt_i32 s[50:51], 51, v6
    v_cndmask_b32 v40, v10, v5, s[44:45]
    v_mfma_f32_16x16x32_bf16 a[120:123], a[252:255], v[200:203], a[120:123]
    v_exp_f32 v247, v183
    v_or3_b32 v57, v57, v213, v214
    v_cndmask_b32 v41, v10, v5, s[46:47]
    v_mfma_f32_16x16x32_bf16 a[124:127], a[252:255], v[204:207], a[124:127]
    s_waitcnt lgkmcnt(5)
    ds_read_b128 a[156:159], v2 offset:7168
    v_cndmask_b32 v42, v10, v5, s[48:49]
    v_cndmask_b32 v43, v10, v5, s[50:51]
    v_mfma_f32_16x16x32_bf16 v[128:131], a[128:131], v[96:99], v[16:19]
    s_waitcnt vmcnt(4)
    s_barrier
    v_exp_f32 v232, v168
    v_mfma_f32_16x16x32_bf16 v[132:135], a[128:131], v[112:115], v[20:23]
    ds_read_b128 a[160:163], v2 offset:8192
    v_cvt_pk_bf16_f32 v215, v246, v247
    v_mfma_f32_16x16x32_bf16 v[128:131], a[132:135], v[100:103], v[128:131]
    v_exp_f32 v233, v169
    v_mfma_f32_16x16x32_bf16 v[132:135], a[132:135], v[116:119], v[132:135]
    s_waitcnt lgkmcnt(5)
    ds_read_b128 a[164:167], v2 offset:9216
    v_cvt_pk_bf16_f32 v216, v232, v233
    v_mfma_f32_16x16x32_bf16 v[128:131], a[136:139], v[104:107], v[128:131]
    s_add_u32 s36, s36, 64
    v_exp_f32 v234, v170
    v_mfma_f32_16x16x32_bf16 v[132:135], a[136:139], v[120:123], v[132:135]
    ds_read_b128 a[168:171], v2 offset:10240
    v_or3_b32 v57, v57, v215, v216
    v_mfma_f32_16x16x32_bf16 v[128:131], a[140:143], v[108:111], v[128:131]
    s_add_u32 s52, s52, 16384
    v_exp_f32 v235, v171
    v_mfma_f32_16x16x32_bf16 v[132:135], a[140:143], v[124:127], v[132:135]
    s_waitcnt lgkmcnt(5)
    ds_read_b128 a[172:175], v2 offset:11264
    v_cvt_pk_bf16_f32 v217, v234, v235
    v_mfma_f32_16x16x32_bf16 v[144:147], a[144:147], v[96:99], v[32:35]
    s_and_b32 s52, s52, 0xffff
    v_exp_f32 v236, v184
    v_mfma_f32_16x16x32_bf16 v[148:151], a[144:147], v[112:115], v[36:39]
    ds_read_b128 a[176:179], v2 offset:12288
    ds_read_b128 a[180:183], v2 offset:13312
    v_mfma_f32_16x16x32_bf16 v[144:147], a[148:151], v[100:103], v[144:147]
    v_exp_f32 v237, v185
    v_mfma_f32_16x16x32_bf16 v[148:151], a[148:151], v[116:119], v[148:151]
    s_waitcnt lgkmcnt(6)
    v_exp_f32 v238, v186
    v_mfma_f32_16x16x32_bf16 v[144:147], a[152:155], v[104:107], v[144:147]
    ds_read_b128 a[184:187], v2 offset:14336
    v_cvt_pk_bf16_f32 v218, v236, v237
    v_mfma_f32_16x16x32_bf16 v[148:151], a[152:155], v[120:123], v[148:151]
    v_exp_f32 v239, v187
    v_mfma_f32_16x16x32_bf16 v[144:147], a[156:159], v[108:111], v[144:147]
    ds_read_b128 a[188:191], v2 offset:15360
    v_or3_b32 v57, v57, v217, v218
    v_mfma_f32_16x16x32_bf16 v[148:151], a[156:159], v[124:127], v[148:151]
    s_waitcnt lgkmcnt(6)
    v_exp_f32 v240, v172
    v_mfma_f32_16x16x32_bf16 v[136:139], a[160:163], v[96:99], v[24:27]
    v_cvt_pk_bf16_f32 v219, v238, v239
    v_add_u32 v2, s52, v1
    v_mfma_f32_16x16x32_bf16 v[140:143], a[160:163], v[112:115], v[28:31]
    v_exp_f32 v241, v173
    v_mfma_f32_16x16x32_bf16 v[136:139], a[164:167], v[100:103], v[136:139]
    ds_read_b128 a[192:195], v3 offset:0
    v_cvt_pk_bf16_f32 v220, v240, v241
    v_mfma_f32_16x16x32_bf16 v[140:143], a[164:167], v[116:119], v[140:143]
    s_waitcnt lgkmcnt(5)
    v_exp_f32 v242, v174
    v_mfma_f32_16x16x32_bf16 v[136:139], a[168:171], v[104:107], v[136:139]
    ds_read_b128 a[196:199], v3 offset:1024
    v_or3_b32 v57, v57, v219, v220
    v_mfma_f32_16x16x32_bf16 v[140:143], a[168:171], v[120:123], v[140:143]
    v_exp_f32 v243, v175
    v_mfma_f32_16x16x32_bf16 v[136:139], a[172:175], v[108:111], v[136:139]
    ds_read_b128 a[200:203], v3 offset:2048
    v_cvt_pk_bf16_f32 v221, v242, v243
    v_mfma_f32_16x16x32_bf16 v[140:143], a[172:175], v[124:127], v[140:143]
    s_waitcnt lgkmcnt(5)
    v_exp_f32 v244, v188
    v_mfma_f32_16x16x32_bf16 v[152:155], a[176:179], v[96:99], v[40:43]
    ds_read_b128 a[204:207], v3 offset:3072
    ds_read_b128 a[208:211], v3 offset:4096
    v_mfma_f32_16x16x32_bf16 v[156:159], a[176:179], v[112:115], v[44:47]
    v_exp_f32 v245, v189
    v_mfma_f32_16x16x32_bf16 v[152:155], a[180:183], v[100:103], v[152:155]
    v_exp_f32 v246, v190
    v_mfma_f32_16x16x32_bf16 v[156:159], a[180:183], v[116:119], v[156:159]
    s_waitcnt lgkmcnt(5)
    ds_read_b128 a[212:215], v3 offset:5120
    v_cvt_pk_bf16_f32 v222, v244, v245
    v_mfma_f32_16x16x32_bf16 v[152:155], a[184:187], v[104:107], v[152:155]
    v_exp_f32 v247, v191
    v_mfma_f32_16x16x32_bf16 v[156:159], a[184:187], v[120:123], v[156:159]
    ds_read_b128 a[216:219], v3 offset:6144
    v_or3_b32 v57, v57, v221, v222
    v_mfma_f32_16x16x32_bf16 v[152:155], a[188:191], v[108:111], v[152:155]
    ds_read_b128 a[220:223], v3 offset:7168
    v_cvt_pk_bf16_f32 v223, v246, v247
    v_bitop3_b32 v57, v57, v223, s37 bitop3:0xa8
    v_mfma_f32_16x16x32_bf16 v[156:159], a[188:191], v[124:127], v[156:159]
    v_cmp_ne_u32 vcc, 0, v57
    s_cbranch_vccnz k2_tramp_110
k2_ret_111:
    v_mfma_f32_16x16x32_bf16 v[248:251], v[60:63], v[208:211], v[248:251]
    ds_read_b128 a[224:227], v3 offset:8192
    v_exp_f32 v232, v128
    v_mfma_f32_16x16x32_bf16 v[252:255], v[60:63], v[212:215], v[252:255]
    v_exp_f32 v233, v129
    v_mfma_f32_16x16x32_bf16 v[248:251], v[60:63], v[216:219], v[248:251]
    s_add_u32 s53, s53, 16384
    ds_read_b128 a[228:231], v3 offset:9216
    v_exp_f32 v234, v130
    v_mfma_f32_16x16x32_bf16 v[252:255], v[60:63], v[220:223], v[252:255]
    s_waitcnt lgkmcnt(8)
    v_cvt_pk_bf16_f32 v192, v232, v233
    v_exp_f32 v235, v131
    v_mfma_f32_16x16x32_bf16 a[8:11], a[192:195], v[208:211], a[8:11]
    s_sub_u32 s40, s36, s39
    s_sub_u32 s40, s40, 64
    ds_read_b128 a[232:235], v3 offset:10240
    v_mfma_f32_16x16x32_bf16 a[12:15], a[192:195], v[212:215], a[12:15]
    s_and_b32 s53, s53, 0xffff
    v_subrev_u32 v6, s40, v4
    v_cmp_gt_i32 s[44:45], 0, v6
    v_cvt_pk_bf16_f32 v193, v234, v235
    v_mfma_f32_16x16x32_bf16 a[24:27], a[196:199], v[208:211], a[24:27]
    v_exp_f32 v236, v144
    v_cmp_gt_i32 s[46:47], 1, v6
    v_mfma_f32_16x16x32_bf16 a[28:31], a[196:199], v[212:215], a[28:31]
    s_waitcnt lgkmcnt(7)
    ds_read_b128 a[236:239], v3 offset:11264
    v_exp_f32 v237, v145
    v_mfma_f32_16x16x32_bf16 a[40:43], a[200:203], v[208:211], a[40:43]
    ds_read_b128 a[240:243], v3 offset:12288
    v_cmp_gt_i32 s[48:49], 2, v6
    v_cmp_gt_i32 s[50:51], 3, v6
    v_mfma_f32_16x16x32_bf16 a[44:47], a[200:203], v[212:215], a[44:47]
    v_exp_f32 v238, v146
    v_cndmask_b32 v20, v11, v5, s[44:45]
    v_mfma_f32_16x16x32_bf16 a[56:59], a[204:207], v[208:211], a[56:59]
    v_cvt_pk_bf16_f32 v194, v236, v237
    v_cndmask_b32 v21, v11, v5, s[46:47]
    v_or3_b32 v57, v192, v193, v194
    v_mfma_f32_16x16x32_bf16 a[60:63], a[204:207], v[212:215], a[60:63]
    s_waitcnt lgkmcnt(7)
    v_exp_f32 v239, v147
    v_cndmask_b32 v22, v11, v5, s[48:49]
    v_mfma_f32_16x16x32_bf16 a[72:75], a[208:211], v[208:211], a[72:75]
    ds_read_b128 a[244:247], v3 offset:13312
    v_cndmask_b32 v23, v11, v5, s[50:51]
    v_cvt_pk_bf16_f32 v195, v238, v239
    v_mfma_f32_16x16x32_bf16 a[76:79], a[208:211], v[212:215], a[76:79]
    v_exp_f32 v240, v132
    v_cmp_gt_i32 s[44:45], 16, v6
    v_mfma_f32_16x16x32_bf16 a[88:91], a[212:215], v[208:211], a[88:91]
    ds_read_b128 a[248:251], v3 offset:14336
    v_cmp_gt_i32 s[46:47], 17, v6
    v_cmp_gt_i32 s[48:49], 18, v6
    v_mfma_f32_16x16x32_bf16 a[92:95], a[212:215], v[212:215], a[92:95]
    s_waitcnt lgkmcnt(7)
    ds_read_b128 a[252:255], v3 offset:15360
    v_exp_f32 v241, v133
    v_mfma_f32_16x16x32_bf16 a[104:107], a[216:219], v[208:211], a[104:107]
    v_exp_f32 v242, v134
    v_cmp_gt_i32 s[50:51], 19, v6
    v_mfma_f32_16x16x32_bf16 a[108:111], a[216:219], v[212:215], a[108:111]
    v_cvt_pk_bf16_f32 v196, v240, v241
    v_cndmask_b32 v36, v11, v5, s[44:45]
    v_or3_b32 v57, v57, v195, v196
    v_mfma_f32_16x16x32_bf16 a[120:123], a[220:223], v[208:211], a[120:123]
    v_exp_f32 v243, v135
    v_cndmask_b32 v37, v11, v5, s[46:47]
    v_mfma_f32_16x16x32_bf16 a[124:127], a[220:223], v[212:215], a[124:127]
    s_waitcnt lgkmcnt(6)
    ds_read_b128 a[128:131], v2 offset:0
    v_cndmask_b32 v38, v11, v5, s[48:49]
    v_add_u32 v3, s53, v56
    v_mfma_f32_16x16x32_bf16 a[8:11], a[224:227], v[216:219], a[8:11]
    ds_read_b128 a[132:135], v2 offset:1024
    v_exp_f32 v244, v148
    v_mfma_f32_16x16x32_bf16 a[12:15], a[224:227], v[220:223], a[12:15]
    ds_read_b128 a[136:139], v2 offset:2048
    v_cvt_pk_bf16_f32 v197, v242, v243
    v_cndmask_b32 v39, v11, v5, s[50:51]
    v_mfma_f32_16x16x32_bf16 a[24:27], a[228:231], v[216:219], a[24:27]
    v_cmp_gt_i32 s[44:45], 32, v6
    v_exp_f32 v245, v149
    v_mfma_f32_16x16x32_bf16 a[28:31], a[228:231], v[220:223], a[28:31]
    s_waitcnt lgkmcnt(7)
    ds_read_b128 a[140:143], v2 offset:3072
    ds_read_b128 a[144:147], v2 offset:4096
    v_cmp_gt_i32 s[46:47], 33, v6
    v_mfma_f32_16x16x32_bf16 a[40:43], a[232:235], v[216:219], a[40:43]
    v_exp_f32 v246, v150
    v_cmp_gt_i32 s[48:49], 34, v6
    v_mfma_f32_16x16x32_bf16 a[44:47], a[232:235], v[220:223], a[44:47]
    ds_read_b128 a[148:151], v2 offset:5120
    v_cvt_pk_bf16_f32 v198, v244, v245
    v_cmp_gt_i32 s[50:51], 35, v6
    v_mfma_f32_16x16x32_bf16 a[56:59], a[236:239], v[216:219], a[56:59]
    v_exp_f32 v247, v151
    v_or3_b32 v57, v57, v197, v198
    v_mfma_f32_16x16x32_bf16 a[60:63], a[236:239], v[220:223], a[60:63]
    s_waitcnt lgkmcnt(8)
    ds_read_b128 a[152:155], v2 offset:6144
    v_cndmask_b32 v28, v11, v5, s[44:45]
    v_cndmask_b32 v29, v11, v5, s[46:47]
    v_mfma_f32_16x16x32_bf16 a[72:75], a[240:243], v[216:219], a[72:75]
    ds_read_b128 a[156:159], v2 offset:7168
    v_exp_f32 v232, v136
    v_mfma_f32_16x16x32_bf16 a[76:79], a[240:243], v[220:223], a[76:79]
    ds_read_b128 a[160:163], v2 offset:8192
    v_cvt_pk_bf16_f32 v199, v246, v247
    v_cndmask_b32 v30, v11, v5, s[48:49]
    v_mfma_f32_16x16x32_bf16 a[88:91], a[244:247], v[216:219], a[88:91]
    v_cndmask_b32 v31, v11, v5, s[50:51]
    v_exp_f32 v233, v137
    v_mfma_f32_16x16x32_bf16 a[92:95], a[244:247], v[220:223], a[92:95]
    s_waitcnt lgkmcnt(9)
    ds_read_b128 a[164:167], v2 offset:9216
    ds_read_b128 a[168:171], v2 offset:10240
    v_cmp_gt_i32 s[44:45], 48, v6
    v_mfma_f32_16x16x32_bf16 a[104:107], a[248:251], v[216:219], a[104:107]
    v_exp_f32 v234, v138
    v_cmp_gt_i32 s[46:47], 49, v6
    v_mfma_f32_16x16x32_bf16 a[108:111], a[248:251], v[220:223], a[108:111]
    ds_read_b128 a[172:175], v2 offset:11264
    ds_read_b128 a[176:179], v2 offset:12288
    v_cvt_pk_bf16_f32 v200, v232, v233
    v_cmp_gt_i32 s[48:49], 50, v6
    v_exp_f32 v235, v139
    v_cmp_gt_i32 s[50:51], 51, v6
    v_or3_b32 v57, v57, v199, v200
    v_cndmask_b32 v44, v11, v5, s[44:45]
    v_mfma_f32_16x16x32_bf16 a[120:123], a[252:255], v[216:219], a[120:123]
    ds_read_b128 a[180:183], v2 offset:13312
    v_exp_f32 v236, v152
    v_cvt_pk_bf16_f32 v201, v234, v235
    v_cndmask_b32 v45, v11, v5, s[46:47]
    v_mfma_f32_16x16x32_bf16 a[124:127], a[252:255], v[220:223], a[124:127]
    s_waitcnt lgkmcnt(12)
    ds_read_b128 a[184:187], v2 offset:14336
    v_cndmask_b32 v46, v11, v5, s[48:49]
    v_cndmask_b32 v47, v11, v5, s[50:51]
    v_mfma_f32_16x16x32_bf16 v[164:167], a[128:131], v[112:115], v[20:23]
    v_exp_f32 v237, v153
    v_mfma_f32_16x16x32_bf16 v[164:167], a[132:135], v[116:119], v[164:167]
    s_waitcnt lgkmcnt(11)
    ds_read_b128 a[188:191], v2 offset:15360
    v_exp_f32 v238, v154
    v_mfma_f32_16x16x32_bf16 v[164:167], a[136:139], v[120:123], v[164:167]
    v_cvt_pk_bf16_f32 v202, v236, v237
    v_exp_f32 v239, v155
    v_mfma_f32_16x16x32_bf16 v[164:167], a[140:143], v[124:127], v[164:167]
    s_waitcnt lgkmcnt(10)
    ds_read_b128 a[192:195], v3 offset:0
    v_or3_b32 v57, v57, v201, v202
    v_mfma_f32_16x16x32_bf16 v[180:183], a[144:147], v[112:115], v[36:39]
    s_add_u32 s36, s36, 64
    v_exp_f32 v240, v140
    v_mfma_f32_16x16x32_bf16 v[180:183], a[148:151], v[116:119], v[180:183]
    s_waitcnt lgkmcnt(9)
    ds_read_b128 a[196:199], v3 offset:1024
    v_cvt_pk_bf16_f32 v203, v238, v239
    v_exp_f32 v241, v141
    v_mfma_f32_16x16x32_bf16 v[180:183], a[152:155], v[120:123], v[180:183]
    s_add_u32 s52, s52, 16384
    ds_read_b128 a[200:203], v3 offset:2048
    v_cvt_pk_bf16_f32 v204, v240, v241
    v_mfma_f32_16x16x32_bf16 v[180:183], a[156:159], v[124:127], v[180:183]
    s_waitcnt lgkmcnt(9)
    v_exp_f32 v242, v142
    v_or3_b32 v57, v57, v203, v204
    v_mfma_f32_16x16x32_bf16 v[172:175], a[160:163], v[112:115], v[28:31]
    s_and_b32 s52, s52, 0xffff
    v_add_u32 v2, s52, v1
    v_exp_f32 v243, v143
    v_mfma_f32_16x16x32_bf16 v[172:175], a[164:167], v[116:119], v[172:175]
    s_waitcnt lgkmcnt(7)
    ds_read_b128 a[204:207], v3 offset:3072
    v_exp_f32 v244, v156
    v_mfma_f32_16x16x32_bf16 v[172:175], a[168:171], v[120:123], v[172:175]
    ds_read_b128 a[208:211], v3 offset:4096
    ds_read_b128 a[212:215], v3 offset:5120
    v_cvt_pk_bf16_f32 v205, v242, v243
    v_mfma_f32_16x16x32_bf16 v[172:175], a[172:175], v[124:127], v[172:175]
    s_waitcnt lgkmcnt(8)
    ds_read_b128 a[216:219], v3 offset:6144
    v_exp_f32 v245, v157
    v_mfma_f32_16x16x32_bf16 v[188:191], a[176:179], v[112:115], v[44:47]
    v_exp_f32 v246, v158
    v_cvt_pk_bf16_f32 v206, v244, v245
    v_mfma_f32_16x16x32_bf16 v[188:191], a[180:183], v[116:119], v[188:191]
    s_waitcnt lgkmcnt(7)
    v_exp_f32 v247, v159
    v_or3_b32 v57, v57, v205, v206
    v_mfma_f32_16x16x32_bf16 v[188:191], a[184:187], v[120:123], v[188:191]
    ds_read_b128 a[220:223], v3 offset:7168
    v_cvt_pk_bf16_f32 v207, v246, v247
    v_bitop3_b32 v57, v57, v207, s37 bitop3:0xa8
    v_mfma_f32_16x16x32_bf16 v[188:191], a[188:191], v[124:127], v[188:191]
    v_cmp_ne_u32 vcc, 0, v57
    s_cbranch_vccnz k2_tramp_112
k2_ret_113:
k2_sdone_105:
    s_add_u32 s16, s6, 0x4811000
    s_addc_u32 s17, s7, 0
    s_and_b32 s17, s17, 0xffff
    s_mov_b32 s18, 0x4000
    s_mov_b32 s19, 0x00020000
    v_mfma_f32_16x16x32_bf16 v[248:251], v[60:63], v[192:195], v[248:251]
    s_waitcnt vmcnt(0)
    s_barrier
    v_exp_f32 v232, v164
    v_mfma_f32_16x16x32_bf16 v[252:255], v[60:63], v[196:199], v[252:255]
    ds_read_b128 a[224:227], v3 offset:8192
    s_cmp_eq_u32 s30, 0
    s_cbranch_scc1 k12_ool_116
k12_oolret_117:
    v_mfma_f32_16x16x32_bf16 v[248:251], v[60:63], v[200:203], v[248:251]
    s_add_u32 m0, s60, 0
    v_exp_f32 v233, v165
    v_mfma_f32_16x16x32_bf16 v[252:255], v[60:63], v[204:207], v[252:255]
    s_waitcnt lgkmcnt(7)
    buffer_load_dwordx4 v90, s[12:15], s61 offen offset:0 lds
    ds_read_b128 a[228:231], v3 offset:9216
    v_mfma_f32_16x16x32_bf16 a[8:11], a[192:195], v[192:195], a[8:11]
    s_add_u32 s53, s53, 16384
    v_exp_f32 v234, v166
    v_cvt_pk_bf16_f32 v212, v232, v233
    v_mfma_f32_16x16x32_bf16 a[12:15], a[192:195], v[196:199], a[12:15]
    s_and_b32 s53, s53, 0xffff
    buffer_load_dwordx4 v91, s[12:15], s61 offen offset:1024 lds
    ds_read_b128 a[232:235], v3 offset:10240
    v_mfma_f32_16x16x32_bf16 a[24:27], a[196:199], v[192:195], a[24:27]
    ds_read_b128 a[236:239], v3 offset:11264
    v_exp_f32 v235, v167
    v_mfma_f32_16x16x32_bf16 a[28:31], a[196:199], v[196:199], a[28:31]
    s_waitcnt lgkmcnt(8)
    v_exp_f32 v236, v180
    v_mfma_f32_16x16x32_bf16 a[40:43], a[200:203], v[192:195], a[40:43]
    buffer_load_dwordx4 v92, s[12:15], s61 offen offset:2048 lds
    ds_read_b128 a[240:243], v3 offset:12288
    v_mfma_f32_16x16x32_bf16 a[44:47], a[200:203], v[196:199], a[44:47]
    v_cvt_pk_bf16_f32 v213, v234, v235
    v_exp_f32 v237, v181
    v_mfma_f32_16x16x32_bf16 a[56:59], a[204:207], v[192:195], a[56:59]
    buffer_load_dwordx4 v93, s[12:15], s61 offen offset:3072 lds
    ds_read_b128 a[244:247], v3 offset:13312
    v_mfma_f32_16x16x32_bf16 a[60:63], a[204:207], v[196:199], a[60:63]
    s_waitcnt lgkmcnt(8)
    v_exp_f32 v238, v182
    v_cvt_pk_bf16_f32 v214, v236, v237
    v_mfma_f32_16x16x32_bf16 a[72:75], a[208:211], v[192:195], a[72:75]
    s_add_u32 s61, s61, 0x20000
    s_and_b32 s61, s61, 0x3fffff
    ds_read_b128 a[248:251], v3 offset:14336
    v_mfma_f32_16x16x32_bf16 a[76:79], a[208:211], v[196:199], a[76:79]
    s_add_u32 m0, s60, 16384
    v_exp_f32 v239, v183
    v_or3_b32 v57, v212, v213, v214
    v_mfma_f32_16x16x32_bf16 a[88:91], a[212:215], v[192:195], a[88:91]
    buffer_load_dwordx4 v90, s[12:15], s61 offen offset:0 lds
    buffer_load_dwordx4 v91, s[12:15], s61 offen offset:1024 lds
    ds_read_b128 a[252:255], v3 offset:15360
    v_mfma_f32_16x16x32_bf16 a[92:95], a[212:215], v[196:199], a[92:95]
    s_waitcnt lgkmcnt(8)
    v_exp_f32 v240, v172
    v_cvt_pk_bf16_f32 v215, v238, v239
    v_mfma_f32_16x16x32_bf16 a[104:107], a[216:219], v[192:195], a[104:107]
    v_mfma_f32_16x16x32_bf16 a[108:111], a[216:219], v[196:199], a[108:111]
    v_add_u32 v3, s53, v56
    ds_read_b128 a[192:195], v3 offset:0
    v_mfma_f32_16x16x32_bf16 a[120:123], a[220:223], v[192:195], a[120:123]
    ds_read_b128 a[196:199], v3 offset:1024
    v_exp_f32 v241, v173
    v_mfma_f32_16x16x32_bf16 a[124:127], a[220:223], v[196:199], a[124:127]
    s_waitcnt lgkmcnt(8)
    buffer_load_dwordx4 v92, s[12:15], s61 offen offset:2048 lds
    buffer_load_dwordx4 v93, s[12:15], s61 offen offset:3072 lds
    ds_read_b128 a[200:203], v3 offset:2048
    v_mfma_f32_16x16x32_bf16 a[8:11], a[224:227], v[200:203], a[8:11]
    v_exp_f32 v242, v174
    v_cvt_pk_bf16_f32 v220, v240, v241
    v_mfma_f32_16x16x32_bf16 a[12:15], a[224:227], v[204:207], a[12:15]
    ds_read_b128 a[204:207], v3 offset:3072
    ds_read_b128 a[208:211], v3 offset:4096
    v_or3_b32 v57, v57, v215, v220
    v_mfma_f32_16x16x32_bf16 a[24:27], a[228:231], v[200:203], a[24:27]
    s_add_u32 s61, s61, 0x20000
    s_and_b32 s61, s61, 0x3fffff
    ds_read_b128 a[212:215], v3 offset:5120
    v_exp_f32 v243, v175
    v_mfma_f32_16x16x32_bf16 a[28:31], a[228:231], v[204:207], a[28:31]
    s_waitcnt lgkmcnt(10)
    ds_read_b128 a[216:219], v3 offset:6144
    s_add_u32 m0, s60, 32768
    v_mfma_f32_16x16x32_bf16 a[40:43], a[232:235], v[200:203], a[40:43]
    buffer_load_dwordx4 v90, s[12:15], s61 offen offset:0 lds
    ds_read_b128 a[220:223], v3 offset:7168
    v_mfma_f32_16x16x32_bf16 a[44:47], a[232:235], v[204:207], a[44:47]
    v_exp_f32 v244, v188
    v_cvt_pk_bf16_f32 v221, v242, v243
    v_mfma_f32_16x16x32_bf16 a[56:59], a[236:239], v[200:203], a[56:59]
    buffer_load_dwordx4 v91, s[12:15], s61 offen offset:1024 lds
    ds_read_b128 a[224:227], v3 offset:8192
    v_mfma_f32_16x16x32_bf16 a[60:63], a[236:239], v[204:207], a[60:63]
    s_waitcnt lgkmcnt(11)
    ds_read_b128 a[228:231], v3 offset:9216
    v_exp_f32 v245, v189
    v_mfma_f32_16x16x32_bf16 a[72:75], a[240:243], v[200:203], a[72:75]
    buffer_load_dwordx4 v92, s[12:15], s61 offen offset:2048 lds
    ds_read_b128 a[232:235], v3 offset:10240
    v_mfma_f32_16x16x32_bf16 a[76:79], a[240:243], v[204:207], a[76:79]
    v_exp_f32 v246, v190
    v_mfma_f32_16x16x32_bf16 a[88:91], a[244:247], v[200:203], a[88:91]
    ds_read_b128 a[236:239], v3 offset:11264
    ds_read_b128 a[240:243], v3 offset:12288
    v_cvt_pk_bf16_f32 v222, v244, v245
    v_mfma_f32_16x16x32_bf16 a[92:95], a[244:247], v[204:207], a[92:95]
    s_waitcnt lgkmcnt(13)
    v_exp_f32 v247, v191
    v_mfma_f32_16x16x32_bf16 a[104:107], a[248:251], v[200:203], a[104:107]
    ds_read_b128 a[244:247], v3 offset:13312
    v_or3_b32 v57, v57, v221, v222
    v_cvt_pk_bf16_f32 v223, v246, v247
    v_mfma_f32_16x16x32_bf16 a[108:111], a[248:251], v[204:207], a[108:111]
    buffer_load_dwordx4 v93, s[12:15], s61 offen offset:3072 lds
    v_mfma_f32_16x16x32_bf16 a[120:123], a[252:255], v[200:203], a[120:123]
    s_add_u32 s61, s61, 0x20000
    s_and_b32 s61, s61, 0x3fffff
    ds_read_b128 a[248:251], v3 offset:14336
    v_bitop3_b32 v57, v57, v223, s37 bitop3:0xa8
    v_cmp_ne_u32 vcc, 0, v57
    v_mfma_f32_16x16x32_bf16 a[124:127], a[252:255], v[204:207], a[124:127]
    buffer_load_dword v74, v73, s[16:19], s59 offen sc1
    ds_read_b128 a[252:255], v3 offset:15360
    s_cbranch_vccnz k2_tramp_114
k2_ret_115:
    v_lshrrev_b32 v6, 4, v1
    v_and_b32 v6, 31, v6
    s_getpc_b64 s[40:41]
pc_118:
    s_add_u32 s40, s40, op_head-pc_118
    s_addc_u32 s41, s41, 0
    v_lshlrev_b32 v224, 7, v6
    v_mov_b32 v225, s41
    v_add_co_u32 v224, vcc, s40, v224
    s_nop 1
    v_addc_co_u32 v225, vcc, 0, v225, vcc
    global_load_dword v7, v[224:225], off
    v_mfma_f32_16x16x32_bf16 v[252:255], v[60:63], v[212:215], v[252:255]
    s_lshl_b32 s31, s28, 19
    v_mov_b32 v249, v248
    s_nop 1
    v_permlane16_swap_b32 v248, v249
    v_mfma_f32_16x16x32_bf16 v[252:255], v[60:63], v[220:223], v[252:255]
    s_waitcnt lgkmcnt(0)
    s_nop 1
    v_add_f32 v248, v248, v249
    v_mov_b32 v249, v248
    v_mfma_f32_16x16x32_bf16 a[12:15], a[192:195], v[212:215], a[12:15]
    s_lshl_b32 s44, s39, 6
    s_nop 1
    v_permlane32_swap_b32 v248, v249
    s_nop 1
    v_mfma_f32_16x16x32_bf16 a[12:15], a[224:227], v[220:223], a[12:15]
    s_add_u32 s44, s44, s31
    s_add_u32 s45, s44, 131072
    v_add_f32 v248, v248, v249
    v_rcp_f32 v249, v248
    v_mfma_f32_16x16x32_bf16 a[28:31], a[196:199], v[212:215], a[28:31]
    s_add_u32 s46, s44, 262144
    v_rcp_f32 v248, v248
    s_nop 0
    s_add_u32 s47, s44, 393216
    v_mfma_f32_16x16x32_bf16 a[28:31], a[228:231], v[220:223], a[28:31]
    s_add_u32 s48, s44, 4096
    v_accvgpr_read_b32 v132, a8
    v_accvgpr_read_b32 v133, a9
    v_accvgpr_read_b32 v134, a10
    v_mfma_f32_16x16x32_bf16 a[44:47], a[200:203], v[212:215], a[44:47]
    s_add_u32 s49, s44, 135168
    v_accvgpr_read_b32 v135, a11
    v_accvgpr_read_b32 v136, a24
    v_accvgpr_read_b32 v137, a25
    v_mfma_f32_16x16x32_bf16 a[44:47], a[232:235], v[220:223], a[44:47]
    s_add_u32 s50, s44, 266240
    v_accvgpr_read_b32 v138, a26
    v_accvgpr_read_b32 v139, a27
    v_mul_f32 v132, v132, v248
    v_mfma_f32_16x16x32_bf16 a[60:63], a[204:207], v[212:215], a[60:63]
    s_add_u32 s51, s44, 397312
    v_mul_f32 v133, v133, v248
    v_mul_f32 v134, v134, v248
    v_mul_f32 v135, v135, v248
    v_mfma_f32_16x16x32_bf16 a[60:63], a[236:239], v[220:223], a[60:63]
    v_mul_f32 v136, v136, v248
    v_mul_f32 v137, v137, v248
    v_mul_f32 v138, v138, v248
    v_mfma_f32_16x16x32_bf16 a[76:79], a[208:211], v[212:215], a[76:79]
    v_mul_f32 v139, v139, v248
    v_cvt_pk_bf16_f32 v128, v132, v133
    v_cvt_pk_bf16_f32 v129, v134, v135
    v_mfma_f32_16x16x32_bf16 a[76:79], a[240:243], v[220:223], a[76:79]
    v_cvt_pk_bf16_f32 v130, v136, v137
    v_cvt_pk_bf16_f32 v131, v138, v139
    buffer_store_dwordx4 v[128:131], v1, s[24:27], s44 offen sc1
    v_mfma_f32_16x16x32_bf16 a[92:95], a[212:215], v[212:215], a[92:95]
    v_accvgpr_read_b32 v144, a40
    v_accvgpr_read_b32 v145, a41
    v_accvgpr_read_b32 v146, a42
    v_mfma_f32_16x16x32_bf16 a[92:95], a[244:247], v[220:223], a[92:95]
    v_accvgpr_read_b32 v147, a43
    v_accvgpr_read_b32 v148, a56
    v_mov_b32 v253, v252
    v_mfma_f32_16x16x32_bf16 a[108:111], a[216:219], v[212:215], a[108:111]
    v_accvgpr_read_b32 v149, a57
    v_accvgpr_read_b32 v150, a58
    s_nop 1
    v_mfma_f32_16x16x32_bf16 a[108:111], a[248:251], v[220:223], a[108:111]
    v_accvgpr_read_b32 v151, a59
    v_permlane16_swap_b32 v252, v253
    v_mul_f32 v144, v144, v248
    v_mfma_f32_16x16x32_bf16 a[124:127], a[220:223], v[212:215], a[124:127]
    s_nop 1
    v_mul_f32 v145, v145, v248
    v_add_f32 v252, v252, v253
    v_mfma_f32_16x16x32_bf16 a[124:127], a[252:255], v[220:223], a[124:127]
    v_mul_f32 v146, v146, v248
    v_mov_b32 v253, v252
    v_mul_f32 v147, v147, v248
    s_nop 1
    v_mul_f32 v148, v148, v248
    v_mul_f32 v149, v149, v248
    v_permlane32_swap_b32 v252, v253
    v_mul_f32 v150, v150, v248
    s_nop 1
    v_mul_f32 v151, v151, v248
    v_add_f32 v252, v252, v253
    v_cvt_pk_bf16_f32 v140, v144, v145
    v_rcp_f32 v253, v252
    v_cvt_pk_bf16_f32 v141, v146, v147
    v_rcp_f32 v252, v252
    v_cvt_pk_bf16_f32 v142, v148, v149
    s_nop 0
    v_cvt_pk_bf16_f32 v143, v150, v151
    buffer_store_dwordx4 v[140:143], v1, s[24:27], s45 offen sc1
    v_accvgpr_read_b32 v156, a72
    v_accvgpr_read_b32 v157, a73
    v_accvgpr_read_b32 v158, a74
    v_accvgpr_read_b32 v159, a75
    v_accvgpr_read_b32 v160, a88
    v_accvgpr_read_b32 v161, a89
    v_accvgpr_read_b32 v162, a90
    v_accvgpr_read_b32 v163, a91
    v_mul_f32 v156, v156, v248
    v_mul_f32 v157, v157, v248
    v_mul_f32 v158, v158, v248
    v_mul_f32 v159, v159, v248
    v_mul_f32 v160, v160, v248
    v_mul_f32 v161, v161, v248
    v_mul_f32 v162, v162, v248
    v_mul_f32 v163, v163, v248
    v_cvt_pk_bf16_f32 v152, v156, v157
    v_cvt_pk_bf16_f32 v153, v158, v159
    v_cvt_pk_bf16_f32 v154, v160, v161
    v_cvt_pk_bf16_f32 v155, v162, v163
    buffer_store_dwordx4 v[152:155], v1, s[24:27], s46 offen sc1
    v_accvgpr_read_b32 v168, a104
    v_accvgpr_read_b32 v169, a105
    v_accvgpr_read_b32 v170, a106
    v_accvgpr_read_b32 v171, a107
    v_accvgpr_read_b32 v172, a120
    v_accvgpr_read_b32 v173, a121
    v_accvgpr_read_b32 v174, a122
    v_accvgpr_read_b32 v175, a123
    v_mul_f32 v168, v168, v248
    v_mul_f32 v169, v169, v248
    v_mul_f32 v170, v170, v248
    v_mul_f32 v171, v171, v248
    v_mul_f32 v172, v172, v248
    v_mul_f32 v173, v173, v248
    v_mul_f32 v174, v174, v248
    v_mul_f32 v175, v175, v248
    v_cvt_pk_bf16_f32 v164, v168, v169
    v_cvt_pk_bf16_f32 v165, v170, v171
    v_cvt_pk_bf16_f32 v166, v172, v173
    v_cvt_pk_bf16_f32 v167, v174, v175
    buffer_store_dwordx4 v[164:167], v1, s[24:27], s47 offen sc1
    v_accvgpr_read_b32 v132, a12
    v_accvgpr_read_b32 v133, a13
    v_accvgpr_read_b32 v134, a14
    v_accvgpr_read_b32 v135, a15
    v_accvgpr_read_b32 v136, a28
    v_accvgpr_read_b32 v137, a29
    v_accvgpr_read_b32 v138, a30
    v_accvgpr_read_b32 v139, a31
    v_pk_mul_f32 v[132:133], v[132:133], v[252:253]
    v_pk_mul_f32 v[134:135], v[134:135], v[252:253]
    v_pk_mul_f32 v[136:137], v[136:137], v[252:253]
    v_pk_mul_f32 v[138:139], v[138:139], v[252:253]
    v_cvt_pk_bf16_f32 v128, v132, v133
    v_cvt_pk_bf16_f32 v129, v134, v135
    v_cvt_pk_bf16_f32 v130, v136, v137
    v_cvt_pk_bf16_f32 v131, v138, v139
    v_accvgpr_read_b32 v144, a44
    v_accvgpr_read_b32 v145, a45
    v_accvgpr_read_b32 v146, a46
    v_accvgpr_read_b32 v147, a47
    v_accvgpr_read_b32 v148, a60
    v_accvgpr_read_b32 v149, a61
    v_accvgpr_read_b32 v150, a62
    v_accvgpr_read_b32 v151, a63
    v_pk_mul_f32 v[144:145], v[144:145], v[252:253]
    v_pk_mul_f32 v[146:147], v[146:147], v[252:253]
    v_pk_mul_f32 v[148:149], v[148:149], v[252:253]
    v_pk_mul_f32 v[150:151], v[150:151], v[252:253]
    v_cvt_pk_bf16_f32 v140, v144, v145
    v_cvt_pk_bf16_f32 v141, v146, v147
    v_cvt_pk_bf16_f32 v142, v148, v149
    v_cvt_pk_bf16_f32 v143, v150, v151
    v_accvgpr_read_b32 v156, a76
    v_accvgpr_read_b32 v157, a77
    v_accvgpr_read_b32 v158, a78
    v_accvgpr_read_b32 v159, a79
    v_accvgpr_read_b32 v160, a92
    v_accvgpr_read_b32 v161, a93
    v_accvgpr_read_b32 v162, a94
    v_accvgpr_read_b32 v163, a95
    v_pk_mul_f32 v[156:157], v[156:157], v[252:253]
    v_pk_mul_f32 v[158:159], v[158:159], v[252:253]
    v_pk_mul_f32 v[160:161], v[160:161], v[252:253]
    v_pk_mul_f32 v[162:163], v[162:163], v[252:253]
    v_cvt_pk_bf16_f32 v152, v156, v157
    v_cvt_pk_bf16_f32 v153, v158, v159
    v_cvt_pk_bf16_f32 v154, v160, v161
    v_cvt_pk_bf16_f32 v155, v162, v163
    v_accvgpr_read_b32 v168, a108
    v_accvgpr_read_b32 v169, a109
    v_accvgpr_read_b32 v170, a110
    v_accvgpr_read_b32 v171, a111
    v_accvgpr_read_b32 v172, a124
    v_accvgpr_read_b32 v173, a125
    v_accvgpr_read_b32 v174, a126
    v_accvgpr_read_b32 v175, a127
    v_pk_mul_f32 v[168:169], v[168:169], v[252:253]
    v_pk_mul_f32 v[170:171], v[170:171], v[252:253]
    v_pk_mul_f32 v[172:173], v[172:173], v[252:253]
    v_pk_mul_f32 v[174:175], v[174:175], v[252:253]
    v_cvt_pk_bf16_f32 v164, v168, v169
    v_cvt_pk_bf16_f32 v165, v170, v171
    v_cvt_pk_bf16_f32 v166, v172, v173
    v_cvt_pk_bf16_f32 v167, v174, v175
    buffer_store_dwordx4 v[128:131], v1, s[24:27], s48 offen sc1
    buffer_store_dwordx4 v[140:143], v1, s[24:27], s49 offen sc1
    buffer_store_dwordx4 v[152:155], v1, s[24:27], s50 offen sc1
    buffer_store_dwordx4 v[164:167], v1, s[24:27], s51 offen sc1
op_head:
    s_load_dwordx2 s[28:29], s[0:1], 0
    s_load_dwordx2 s[42:43], s[0:1], 56
    s_waitcnt vmcnt(8)
    v_cmp_le_u32 vcc, 4, v74
    v_mov_b32 v56, 0
    v_mov_b32 v57, 0
    v_mov_b32 v58, 0
    v_mov_b32 v59, 0
    s_nop 1
    v_mfma_f32_32x32x16_bf16 v[128:143], v[56:59], v[56:59], 0
    v_mfma_f32_32x32x16_bf16 v[144:159], v[56:59], v[56:59], 0
    v_mfma_f32_32x32x16_bf16 v[160:175], v[56:59], v[56:59], 0
    v_mfma_f32_32x32x16_bf16 v[176:191], v[56:59], v[56:59], 0
    s_mov_b32 s33, vcc_lo
    s_bitcmp1_b32 s33, 0
    s_cbranch_scc0 op_late_119
    buffer_load_dwordx4 a[128:131], v88, s[8:11], s62 offen offset:0 sc1
    buffer_load_dwordx4 a[132:135], v88, s[8:11], s62 offen offset:1024 sc1
    buffer_load_dwordx4 a[136:139], v89, s[8:11], s62 offen offset:0 sc1
    buffer_load_dwordx4 a[140:143], v89, s[8:11], s62 offen offset:1024 sc1
    s_add_u32 s62, s62, 0x40000
    s_and_b32 s62, s62, 0x7fffff
    buffer_load_dwordx4 a[144:147], v88, s[8:11], s62 offen offset:0 sc1
    buffer_load_dwordx4 a[148:151], v88, s[8:11], s62 offen offset:1024 sc1
    buffer_load_dwordx4 a[152:155], v89, s[8:11], s62 offen offset:0 sc1
    buffer_load_dwordx4 a[156:159], v89, s[8:11], s62 offen offset:1024 sc1
    s_add_u32 s62, s62, 0x40000
    s_and_b32 s62, s62, 0x7fffff
    buffer_load_dwordx4 a[160:163], v88, s[8:11], s62 offen offset:0 sc1
    buffer_load_dwordx4 a[164:167], v88, s[8:11], s62 offen offset:1024 sc1
    buffer_load_dwordx4 a[168:171], v89, s[8:11], s62 offen offset:0 sc1
    buffer_load_dwordx4 a[172:175], v89, s[8:11], s62 offen offset:1024 sc1
    s_add_u32 s62, s62, 0x40000
    s_and_b32 s62, s62, 0x7fffff
    s_waitcnt vmcnt(12)
    s_branch op_join_120
op_late_119:
    s_waitcnt vmcnt(0)
op_join_120:
    s_barrier
    s_cmp_eq_u32 s30, 0
    s_cbranch_scc1 k12_ool_121
k12_oolret_122:
    s_bitcmp0_b32 s33, 0
    s_cbranch_scc1 k12_ool_125
k12_oolret_126:
    ds_read_b64_tr_b16 a[0:1], v64 offset:0
    ds_read_b64_tr_b16 a[2:3], v64 offset:4096
    ds_read_b64_tr_b16 a[4:5], v65 offset:0
    ds_read_b64_tr_b16 a[6:7], v65 offset:4096
    ds_read_b64_tr_b16 a[8:9], v66 offset:0
    ds_read_b64_tr_b16 a[10:11], v66 offset:4096
    ds_read_b64_tr_b16 a[12:13], v67 offset:0
    ds_read_b64_tr_b16 a[14:15], v67 offset:4096
    ds_read_b64_tr_b16 a[16:17], v68 offset:0
    ds_read_b64_tr_b16 a[18:19], v68 offset:4096
    ds_read_b64_tr_b16 a[20:21], v69 offset:0
    ds_read_b64_tr_b16 a[22:23], v69 offset:4096
    ds_read_b64_tr_b16 a[24:25], v70 offset:0
    ds_read_b64_tr_b16 a[26:27], v70 offset:4096
    ds_read_b64_tr_b16 a[28:29], v71 offset:0
    ds_read_b64_tr_b16 a[30:31], v71 offset:4096
    ds_read_b64_tr_b16 a[32:33], v64 offset:8192
    ds_read_b64_tr_b16 a[34:35], v64 offset:12288
    ds_read_b64_tr_b16 a[36:37], v65 offset:8192
    ds_read_b64_tr_b16 a[38:39], v65 offset:12288
    ds_read_b64_tr_b16 a[40:41], v66 offset:8192
    ds_read_b64_tr_b16 a[42:43], v66 offset:12288
    ds_read_b64_tr_b16 a[44:45], v67 offset:8192
    ds_read_b64_tr_b16 a[46:47], v67 offset:12288
    ds_read_b64_tr_b16 a[48:49], v68 offset:8192
    ds_read_b64_tr_b16 a[50:51], v68 offset:12288
    ds_read_b64_tr_b16 a[52:53], v69 offset:8192
    ds_read_b64_tr_b16 a[54:55], v69 offset:12288
    ds_read_b64_tr_b16 a[56:57], v70 offset:8192
    ds_read_b64_tr_b16 a[58:59], v70 offset:12288
    ds_read_b64_tr_b16 a[60:61], v71 offset:8192
    ds_read_b64_tr_b16 a[62:63], v71 offset:12288
    s_add_u32 s24, s6, 0x4000000
    s_addc_u32 s25, s7, 0
    s_and_b32 s25, s25, 0xffff
    s_mov_b32 s26, 0x400000
    s_mov_b32 s27, 0x00020000
    s_add_u32 s36, s6, 0x5000000
    s_addc_u32 s37, s7, 0
    s_and_b32 s37, s37, 0xffff
    s_mov_b32 s38, 0x800000
    s_mov_b32 s39, 0x00020000
    s_add_u32 s48, s6, 0x4807000
    s_addc_u32 s49, s7, 0
    s_and_b32 s49, s49, 0xffff
    s_mov_b32 s50, 0x8000
    s_mov_b32 s51, 0x00020000
    s_lshl_b32 s52, s2, 14
    s_add_u32 s52, s52, s60
    s_xor_b32 s53, s52, 0x10000
    s_lshl_b32 s57, s2, 7
    s_xor_b32 s58, s57, 0x200
    v_lshrrev_b32 v56, 4, v1
    s_lshl_b32 s31, s30, 6
    s_and_b32 s31, s31, 64
    v_add_u32 v56, s31, v56
    s_mov_b32 s31, (code_end-op_tail)/128
    v_min_u32 v56, s31, v56
    s_getpc_b64 s[40:41]
pc_127:
    s_add_u32 s40, s40, op_tail-pc_127
    s_addc_u32 s41, s41, 0
    v_lshlrev_b32 v82, 7, v56
    v_mov_b32 v83, s41
    v_add_co_u32 v82, vcc, s40, v82
    s_nop 1
    v_addc_co_u32 v83, vcc, 0, v83, vcc
    v_lshlrev_b32 v94, 3, v1
    s_and_b32 s35, s2, 7
    s_mul_i32 s35, s35, 28
    s_lshr_b32 s31, s2, 3
    s_add_u32 s55, s35, s31
    s_lshl_b32 s3, s55, 15
    s_lshl_b32 s31, s30, 13
    s_add_u32 s3, s3, s31
    s_add_u32 s35, s31, 65536
    s_mov_b32 s63, 0
    s_waitcnt vmcnt(8) lgkmcnt(0)
    s_mov_b32 s20, s28
    s_and_b32 s21, s29, 0xffff
    s_mov_b32 s22, 0x400000
    s_mov_b32 s23, 0x00020000
    s_mov_b32 s44, s42
    s_and_b32 s45, s43, 0xffff
    s_mov_b32 s46, 0x800
    s_mov_b32 s47, 0x00020000
op_loop_128:
    v_mfma_f32_16x16x32_bf16 v[160:163], a[16:19], a[128:131], v[160:163]
    s_add_u32 m0, s60, 49152
    ds_read_b64_tr_b16 a[64:65], v64 offset:16384
    ds_read_b64_tr_b16 a[66:67], v64 offset:20480
    v_mfma_f32_16x16x32_bf16 v[164:167], a[16:19], a[132:135], v[164:167]
    buffer_load_dwordx4 v90, s[12:15], s61 offen offset:0 lds
    ds_read_b64_tr_b16 a[68:69], v65 offset:16384
    v_mfma_f32_16x16x32_bf16 v[168:171], a[20:23], a[128:131], v[168:171]
    ds_read_b64_tr_b16 a[70:71], v65 offset:20480
    ds_read_b64_tr_b16 a[72:73], v66 offset:16384
    v_mfma_f32_16x16x32_bf16 v[172:175], a[20:23], a[132:135], v[172:175]
    buffer_load_dwordx4 v91, s[12:15], s61 offen offset:1024 lds
    ds_read_b64_tr_b16 a[74:75], v66 offset:20480
    v_mfma_f32_16x16x32_bf16 v[176:179], a[24:27], a[128:131], v[176:179]
    ds_read_b64_tr_b16 a[76:77], v67 offset:16384
    ds_read_b64_tr_b16 a[78:79], v67 offset:20480
    v_mfma_f32_16x16x32_bf16 v[180:183], a[24:27], a[132:135], v[180:183]
    ds_read_b64_tr_b16 a[80:81], v68 offset:16384
    v_mfma_f32_16x16x32_bf16 v[184:187], a[28:31], a[128:131], v[184:187]
    ds_read_b64_tr_b16 a[82:83], v68 offset:20480
    v_mfma_f32_16x16x32_bf16 v[188:191], a[28:31], a[132:135], v[188:191]
    buffer_load_dwordx4 v92, s[12:15], s61 offen offset:2048 lds
    ds_read_b64_tr_b16 a[84:85], v69 offset:16384
    v_mfma_f32_16x16x32_bf16 v[128:131], a[0:3], a[128:131], v[128:131]
    ds_read_b64_tr_b16 a[86:87], v69 offset:20480
    ds_read_b64_tr_b16 a[88:89], v70 offset:16384
    v_mfma_f32_16x16x32_bf16 v[132:135], a[0:3], a[132:135], v[132:135]
    ds_read_b64_tr_b16 a[90:91], v70 offset:20480
    v_mfma_f32_16x16x32_bf16 v[136:139], a[4:7], a[128:131], v[136:139]
    buffer_load_dwordx4 v93, s[12:15], s61 offen offset:3072 lds
    ds_read_b64_tr_b16 a[92:93], v71 offset:16384
    v_mfma_f32_16x16x32_bf16 v[140:143], a[4:7], a[132:135], v[140:143]
    ds_read_b64_tr_b16 a[94:95], v71 offset:20480
    ds_read_b64_tr_b16 a[96:97], v64 offset:24576
    v_mfma_f32_16x16x32_bf16 v[144:147], a[8:11], a[128:131], v[144:147]
    ds_read_b64_tr_b16 a[98:99], v64 offset:28672
    v_mfma_f32_16x16x32_bf16 v[148:151], a[8:11], a[132:135], v[148:151]
    ds_read_b64_tr_b16 a[100:101], v65 offset:24576
    v_mfma_f32_16x16x32_bf16 v[152:155], a[12:15], a[128:131], v[152:155]
    buffer_load_dwordx4 a[176:179], v88, s[8:11], s62 offen offset:0 sc1
    ds_read_b64_tr_b16 a[102:103], v65 offset:28672
    v_mfma_f32_16x16x32_bf16 v[156:159], a[12:15], a[132:135], v[156:159]
    s_add_u32 s61, s61, 0x20000
    s_and_b32 s61, s61, 0x3fffff
    ds_read_b64_tr_b16 a[104:105], v66 offset:24576
    ds_read_b64_tr_b16 a[106:107], v66 offset:28672
    v_mfma_f32_16x16x32_bf16 v[160:163], a[48:51], a[136:139], v[160:163]
    ds_read_b64_tr_b16 a[108:109], v67 offset:24576
    v_mfma_f32_16x16x32_bf16 v[164:167], a[48:51], a[140:143], v[164:167]
    buffer_load_dwordx4 a[180:183], v88, s[8:11], s62 offen offset:1024 sc1
    ds_read_b64_tr_b16 a[110:111], v67 offset:28672
    v_mfma_f32_16x16x32_bf16 v[168:171], a[52:55], a[136:139], v[168:171]
    ds_read_b64_tr_b16 a[112:113], v68 offset:24576
    v_mfma_f32_16x16x32_bf16 v[172:175], a[52:55], a[140:143], v[172:175]
    ds_read_b64_tr_b16 a[114:115], v68 offset:28672
    ds_read_b64_tr_b16 a[116:117], v69 offset:24576
    v_mfma_f32_16x16x32_bf16 v[176:179], a[56:59], a[136:139], v[176:179]
    ds_read_b64_tr_b16 a[118:119], v69 offset:28672
    v_mfma_f32_16x16x32_bf16 v[180:183], a[56:59], a[140:143], v[180:183]
    buffer_load_dwordx4 a[184:187], v89, s[8:11], s62 offen offset:0 sc1
    ds_read_b64_tr_b16 a[120:121], v70 offset:24576
    v_mfma_f32_16x16x32_bf16 v[184:187], a[60:63], a[136:139], v[184:187]
    ds_read_b64_tr_b16 a[122:123], v70 offset:28672
    ds_read_b64_tr_b16 a[124:125], v71 offset:24576
    v_mfma_f32_16x16x32_bf16 v[188:191], a[60:63], a[140:143], v[188:191]
    ds_read_b64_tr_b16 a[126:127], v71 offset:28672
    v_mfma_f32_16x16x32_bf16 v[128:131], a[32:35], a[136:139], v[128:131]
    buffer_load_dwordx4 a[188:191], v89, s[8:11], s62 offen offset:1024 sc1
    v_mfma_f32_16x16x32_bf16 v[132:135], a[32:35], a[140:143], v[132:135]
    v_mfma_f32_16x16x32_bf16 v[136:139], a[36:39], a[136:139], v[136:139]
    v_mfma_f32_16x16x32_bf16 v[140:143], a[36:39], a[140:143], v[140:143]
    v_mfma_f32_16x16x32_bf16 v[144:147], a[40:43], a[136:139], v[144:147]
    s_cmp_eq_u32 s63, 7
    s_cbranch_scc1 k12_ool_131
k12_oolret_132:
    v_mfma_f32_16x16x32_bf16 v[148:151], a[40:43], a[140:143], v[148:151]
    s_add_u32 s62, s62, 0x40000
    s_and_b32 s62, s62, 0x7fffff
    v_mfma_f32_16x16x32_bf16 v[152:155], a[44:47], a[136:139], v[152:155]
    v_mfma_f32_16x16x32_bf16 v[156:159], a[44:47], a[140:143], v[156:159]
    s_waitcnt vmcnt(12) lgkmcnt(0)
    s_barrier
    v_mfma_f32_16x16x32_bf16 v[160:163], a[80:83], a[144:147], v[160:163]
    s_add_u32 s32, s63, 1
    s_lshr_b32 s32, s32, 1
    ds_read_b64_tr_b16 a[0:1], v64 offset:32768
    v_cmp_le_u32 vcc, 4, v74
    v_mfma_f32_16x16x32_bf16 v[164:167], a[80:83], a[148:151], v[164:167]
    s_add_u32 m0, s60, 0
    ds_read_b64_tr_b16 a[2:3], v64 offset:36864
    ds_read_b64_tr_b16 a[4:5], v65 offset:32768
    v_mfma_f32_16x16x32_bf16 v[168:171], a[84:87], a[144:147], v[168:171]
    s_or_b32 s33, vcc_lo, 16
    buffer_load_dwordx4 v90, s[12:15], s61 offen offset:0 lds
    ds_read_b64_tr_b16 a[6:7], v65 offset:36864
    v_mfma_f32_16x16x32_bf16 v[172:175], a[84:87], a[148:151], v[172:175]
    ds_read_b64_tr_b16 a[8:9], v66 offset:32768
    ds_read_b64_tr_b16 a[10:11], v66 offset:36864
    v_mfma_f32_16x16x32_bf16 v[176:179], a[88:91], a[144:147], v[176:179]
    buffer_load_dwordx4 v91, s[12:15], s61 offen offset:1024 lds
    ds_read_b64_tr_b16 a[12:13], v67 offset:32768
    v_mfma_f32_16x16x32_bf16 v[180:183], a[88:91], a[148:151], v[180:183]
    ds_read_b64_tr_b16 a[14:15], v67 offset:36864
    ds_read_b64_tr_b16 a[16:17], v68 offset:32768
    v_mfma_f32_16x16x32_bf16 v[184:187], a[92:95], a[144:147], v[184:187]
    s_bitcmp0_b32 s33, s32
    s_cbranch_scc1 k12_ool_135
k12_oolret_136:
    v_mfma_f32_16x16x32_bf16 v[188:191], a[92:95], a[148:151], v[188:191]
    ds_read_b64_tr_b16 a[18:19], v68 offset:36864
    ds_read_b64_tr_b16 a[20:21], v69 offset:32768
    v_mfma_f32_16x16x32_bf16 v[128:131], a[64:67], a[144:147], v[128:131]
    buffer_load_dwordx4 v92, s[12:15], s61 offen offset:2048 lds
    ds_read_b64_tr_b16 a[22:23], v69 offset:36864
    v_mfma_f32_16x16x32_bf16 v[132:135], a[64:67], a[148:151], v[132:135]
    ds_read_b64_tr_b16 a[24:25], v70 offset:32768
    ds_read_b64_tr_b16 a[26:27], v70 offset:36864
    v_mfma_f32_16x16x32_bf16 v[136:139], a[68:71], a[144:147], v[136:139]
    buffer_load_dwordx4 v93, s[12:15], s61 offen offset:3072 lds
    ds_read_b64_tr_b16 a[28:29], v71 offset:32768
    v_mfma_f32_16x16x32_bf16 v[140:143], a[68:71], a[148:151], v[140:143]
    ds_read_b64_tr_b16 a[30:31], v71 offset:36864
    ds_read_b64_tr_b16 a[32:33], v64 offset:40960
    v_mfma_f32_16x16x32_bf16 v[144:147], a[72:75], a[144:147], v[144:147]
    ds_read_b64_tr_b16 a[34:35], v64 offset:45056
    v_mfma_f32_16x16x32_bf16 v[148:151], a[72:75], a[148:151], v[148:151]
    ds_read_b64_tr_b16 a[36:37], v65 offset:40960
    v_mfma_f32_16x16x32_bf16 v[152:155], a[76:79], a[144:147], v[152:155]
    buffer_load_dwordx4 a[128:131], v88, s[8:11], s62 offen offset:0 sc1
    ds_read_b64_tr_b16 a[38:39], v65 offset:45056
    v_mfma_f32_16x16x32_bf16 v[156:159], a[76:79], a[148:151], v[156:159]
    s_add_u32 s61, s61, 0x20000
    s_and_b32 s61, s61, 0x3fffff
    ds_read_b64_tr_b16 a[40:41], v66 offset:40960
    ds_read_b64_tr_b16 a[42:43], v66 offset:45056
    v_mfma_f32_16x16x32_bf16 v[160:163], a[112:115], a[152:155], v[160:163]
    ds_read_b64_tr_b16 a[44:45], v67 offset:40960
    v_mfma_f32_16x16x32_bf16 v[164:167], a[112:115], a[156:159], v[164:167]
    buffer_load_dwordx4 a[132:135], v88, s[8:11], s62 offen offset:1024 sc1
    ds_read_b64_tr_b16 a[46:47], v67 offset:45056
    v_mfma_f32_16x16x32_bf16 v[168:171], a[116:119], a[152:155], v[168:171]
    ds_read_b64_tr_b16 a[48:49], v68 offset:40960
    v_mfma_f32_16x16x32_bf16 v[172:175], a[116:119], a[156:159], v[172:175]
    ds_read_b64_tr_b16 a[50:51], v68 offset:45056
    ds_read_b64_tr_b16 a[52:53], v69 offset:40960
    v_mfma_f32_16x16x32_bf16 v[176:179], a[120:123], a[152:155], v[176:179]
    ds_read_b64_tr_b16 a[54:55], v69 offset:45056
    v_mfma_f32_16x16x32_bf16 v[180:183], a[120:123], a[156:159], v[180:183]
    buffer_load_dwordx4 a[136:139], v89, s[8:11], s62 offen offset:0 sc1
    ds_read_b64_tr_b16 a[56:57], v70 offset:40960
    v_mfma_f32_16x16x32_bf16 v[184:187], a[124:127], a[152:155], v[184:187]
    ds_read_b64_tr_b16 a[58:59], v70 offset:45056
    ds_read_b64_tr_b16 a[60:61], v71 offset:40960
    v_mfma_f32_16x16x32_bf16 v[188:191], a[124:127], a[156:159], v[188:191]
    ds_read_b64_tr_b16 a[62:63], v71 offset:45056
    v_mfma_f32_16x16x32_bf16 v[128:131], a[96:99], a[152:155], v[128:131]
    buffer_load_dwordx4 a[140:143], v89, s[8:11], s62 offen offset:1024 sc1
    v_mfma_f32_16x16x32_bf16 v[132:135], a[96:99], a[156:159], v[132:135]
    v_mfma_f32_16x16x32_bf16 v[136:139], a[100:103], a[152:155], v[136:139]
    s_cmp_eq_u32 s63, 6
    s_cbranch_scc1 k12_ool_137
k12_oolret_138:
    v_mfma_f32_16x16x32_bf16 v[140:143], a[100:103], a[156:159], v[140:143]
    v_mfma_f32_16x16x32_bf16 v[144:147], a[104:107], a[152:155], v[144:147]
    v_mfma_f32_16x16x32_bf16 v[148:151], a[104:107], a[156:159], v[148:151]
    s_add_u32 s62, s62, 0x40000
    s_and_b32 s62, s62, 0x7fffff
    v_mfma_f32_16x16x32_bf16 v[152:155], a[108:111], a[152:155], v[152:155]
    v_mfma_f32_16x16x32_bf16 v[156:159], a[108:111], a[156:159], v[156:159]
    s_waitcnt vmcnt(12) lgkmcnt(0)
    s_barrier
    v_mfma_f32_16x16x32_bf16 v[160:163], a[16:19], a[160:163], v[160:163]
    s_add_u32 m0, s60, 16384
    buffer_load_dword v74, v73, s[16:19], s59 offen sc1
    ds_read_b64_tr_b16 a[64:65], v64 offset:49152
    v_mfma_f32_16x16x32_bf16 v[164:167], a[16:19], a[164:167], v[164:167]
    buffer_load_dwordx4 v90, s[12:15], s61 offen offset:0 lds
    ds_read_b64_tr_b16 a[66:67], v64 offset:53248
    v_mfma_f32_16x16x32_bf16 v[168:171], a[20:23], a[160:163], v[168:171]
    ds_read_b64_tr_b16 a[68:69], v65 offset:49152
    ds_read_b64_tr_b16 a[70:71], v65 offset:53248
    v_mfma_f32_16x16x32_bf16 v[172:175], a[20:23], a[164:167], v[172:175]
    ds_read_b64_tr_b16 a[72:73], v66 offset:49152
    ds_read_b64_tr_b16 a[74:75], v66 offset:53248
    v_mfma_f32_16x16x32_bf16 v[176:179], a[24:27], a[160:163], v[176:179]
    buffer_load_dwordx4 v91, s[12:15], s61 offen offset:1024 lds
    ds_read_b64_tr_b16 a[76:77], v67 offset:49152
    v_mfma_f32_16x16x32_bf16 v[180:183], a[24:27], a[164:167], v[180:183]
    ds_read_b64_tr_b16 a[78:79], v67 offset:53248
    ds_read_b64_tr_b16 a[80:81], v68 offset:49152
    v_mfma_f32_16x16x32_bf16 v[184:187], a[28:31], a[160:163], v[184:187]
    ds_read_b64_tr_b16 a[82:83], v68 offset:53248
    v_mfma_f32_16x16x32_bf16 v[188:191], a[28:31], a[164:167], v[188:191]
    buffer_load_dwordx4 v92, s[12:15], s61 offen offset:2048 lds
    ds_read_b64_tr_b16 a[84:85], v69 offset:49152
    v_mfma_f32_16x16x32_bf16 v[128:131], a[0:3], a[160:163], v[128:131]
    ds_read_b64_tr_b16 a[86:87], v69 offset:53248
    ds_read_b64_tr_b16 a[88:89], v70 offset:49152
    v_mfma_f32_16x16x32_bf16 v[132:135], a[0:3], a[164:167], v[132:135]
    ds_read_b64_tr_b16 a[90:91], v70 offset:53248
    v_mfma_f32_16x16x32_bf16 v[136:139], a[4:7], a[160:163], v[136:139]
    buffer_load_dwordx4 v93, s[12:15], s61 offen offset:3072 lds
    ds_read_b64_tr_b16 a[92:93], v71 offset:49152
    v_mfma_f32_16x16x32_bf16 v[140:143], a[4:7], a[164:167], v[140:143]
    ds_read_b64_tr_b16 a[94:95], v71 offset:53248
    ds_read_b64_tr_b16 a[96:97], v64 offset:57344
    v_mfma_f32_16x16x32_bf16 v[144:147], a[8:11], a[160:163], v[144:147]
    ds_read_b64_tr_b16 a[98:99], v64 offset:61440
    v_mfma_f32_16x16x32_bf16 v[148:151], a[8:11], a[164:167], v[148:151]
    ds_read_b64_tr_b16 a[100:101], v65 offset:57344
    v_mfma_f32_16x16x32_bf16 v[152:155], a[12:15], a[160:163], v[152:155]
    buffer_load_dwordx4 a[144:147], v88, s[8:11], s62 offen offset:0 sc1
    ds_read_b64_tr_b16 a[102:103], v65 offset:61440
    v_mfma_f32_16x16x32_bf16 v[156:159], a[12:15], a[164:167], v[156:159]
    s_add_u32 s61, s61, 0x20000
    s_and_b32 s61, s61, 0x3fffff
    ds_read_b64_tr_b16 a[104:105], v66 offset:57344
    ds_read_b64_tr_b16 a[106:107], v66 offset:61440
    v_mfma_f32_16x16x32_bf16 v[160:163], a[48:51], a[168:171], v[160:163]
    ds_read_b64_tr_b16 a[108:109], v67 offset:57344
    v_mfma_f32_16x16x32_bf16 v[164:167], a[48:51], a[172:175], v[164:167]
    buffer_load_dwordx4 a[148:151], v88, s[8:11], s62 offen offset:1024 sc1
    ds_read_b64_tr_b16 a[110:111], v67 offset:61440
    v_mfma_f32_16x16x32_bf16 v[168:171], a[52:55], a[168:171], v[168:171]
    ds_read_b64_tr_b16 a[112:113], v68 offset:57344
    v_mfma_f32_16x16x32_bf16 v[172:175], a[52:55], a[172:175], v[172:175]
    ds_read_b64_tr_b16 a[114:115], v68 offset:61440
    ds_read_b64_tr_b16 a[116:117], v69 offset:57344
    v_mfma_f32_16x16x32_bf16 v[176:179], a[56:59], a[168:171], v[176:179]
    ds_read_b64_tr_b16 a[118:119], v69 offset:61440
    v_mfma_f32_16x16x32_bf16 v[180:183], a[56:59], a[172:175], v[180:183]
    buffer_load_dwordx4 a[152:155], v89, s[8:11], s62 offen offset:0 sc1
    ds_read_b64_tr_b16 a[120:121], v70 offset:57344
    v_mfma_f32_16x16x32_bf16 v[184:187], a[60:63], a[168:171], v[184:187]
    ds_read_b64_tr_b16 a[122:123], v70 offset:61440
    ds_read_b64_tr_b16 a[124:125], v71 offset:57344
    v_mfma_f32_16x16x32_bf16 v[188:191], a[60:63], a[172:175], v[188:191]
    ds_read_b64_tr_b16 a[126:127], v71 offset:61440
    v_mfma_f32_16x16x32_bf16 v[128:131], a[32:35], a[168:171], v[128:131]
    buffer_load_dwordx4 a[156:159], v89, s[8:11], s62 offen offset:1024 sc1
    v_mfma_f32_16x16x32_bf16 v[132:135], a[32:35], a[172:175], v[132:135]
    v_mfma_f32_16x16x32_bf16 v[136:139], a[36:39], a[168:171], v[136:139]
    v_mfma_f32_16x16x32_bf16 v[140:143], a[36:39], a[172:175], v[140:143]
    v_mfma_f32_16x16x32_bf16 v[144:147], a[40:43], a[168:171], v[144:147]
    v_mfma_f32_16x16x32_bf16 v[148:151], a[40:43], a[172:175], v[148:151]
    s_add_u32 s62, s62, 0x40000
    s_and_b32 s62, s62, 0x7fffff
    v_mfma_f32_16x16x32_bf16 v[152:155], a[44:47], a[168:171], v[152:155]
    v_mfma_f32_16x16x32_bf16 v[156:159], a[44:47], a[172:175], v[156:159]
    s_waitcnt vmcnt(12) lgkmcnt(0)
    s_barrier
    v_mfma_f32_16x16x32_bf16 v[160:163], a[80:83], a[176:179], v[160:163]
    s_add_u32 m0, s60, 32768
    ds_read_b64_tr_b16 a[0:1], v64 offset:0
    ds_read_b64_tr_b16 a[2:3], v64 offset:4096
    v_mfma_f32_16x16x32_bf16 v[164:167], a[80:83], a[180:183], v[164:167]
    buffer_load_dwordx4 v90, s[12:15], s61 offen offset:0 lds
    ds_read_b64_tr_b16 a[4:5], v65 offset:0
    v_mfma_f32_16x16x32_bf16 v[168:171], a[84:87], a[176:179], v[168:171]
    ds_read_b64_tr_b16 a[6:7], v65 offset:4096
    ds_read_b64_tr_b16 a[8:9], v66 offset:0
    v_mfma_f32_16x16x32_bf16 v[172:175], a[84:87], a[180:183], v[172:175]
    buffer_load_dwordx4 v91, s[12:15], s61 offen offset:1024 lds
    ds_read_b64_tr_b16 a[10:11], v66 offset:4096
    v_mfma_f32_16x16x32_bf16 v[176:179], a[88:91], a[176:179], v[176:179]
    ds_read_b64_tr_b16 a[12:13], v67 offset:0
    ds_read_b64_tr_b16 a[14:15], v67 offset:4096
    v_mfma_f32_16x16x32_bf16 v[180:183], a[88:91], a[180:183], v[180:183]
    ds_read_b64_tr_b16 a[16:17], v68 offset:0
    v_mfma_f32_16x16x32_bf16 v[184:187], a[92:95], a[176:179], v[184:187]
    ds_read_b64_tr_b16 a[18:19], v68 offset:4096
    v_mfma_f32_16x16x32_bf16 v[188:191], a[92:95], a[180:183], v[188:191]
    buffer_load_dwordx4 v92, s[12:15], s61 offen offset:2048 lds
    ds_read_b64_tr_b16 a[20:21], v69 offset:0
    v_mfma_f32_16x16x32_bf16 v[128:131], a[64:67], a[176:179], v[128:131]
    ds_read_b64_tr_b16 a[22:23], v69 offset:4096
    ds_read_b64_tr_b16 a[24:25], v70 offset:0
    v_mfma_f32_16x16x32_bf16 v[132:135], a[64:67], a[180:183], v[132:135]
    ds_read_b64_tr_b16 a[26:27], v70 offset:4096
    v_mfma_f32_16x16x32_bf16 v[136:139], a[68:71], a[176:179], v[136:139]
    buffer_load_dwordx4 v93, s[12:15], s61 offen offset:3072 lds
    ds_read_b64_tr_b16 a[28:29], v71 offset:0
    v_mfma_f32_16x16x32_bf16 v[140:143], a[68:71], a[180:183], v[140:143]
    ds_read_b64_tr_b16 a[30:31], v71 offset:4096
    ds_read_b64_tr_b16 a[32:33], v64 offset:8192
    v_mfma_f32_16x16x32_bf16 v[144:147], a[72:75], a[176:179], v[144:147]
    ds_read_b64_tr_b16 a[34:35], v64 offset:12288
    v_mfma_f32_16x16x32_bf16 v[148:151], a[72:75], a[180:183], v[148:151]
    ds_read_b64_tr_b16 a[36:37], v65 offset:8192
    v_mfma_f32_16x16x32_bf16 v[152:155], a[76:79], a[176:179], v[152:155]
    buffer_load_dwordx4 a[160:163], v88, s[8:11], s62 offen offset:0 sc1
    ds_read_b64_tr_b16 a[38:39], v65 offset:12288
    v_mfma_f32_16x16x32_bf16 v[156:159], a[76:79], a[180:183], v[156:159]
    s_add_u32 s61, s61, 0x20000
    s_and_b32 s61, s61, 0x3fffff
    ds_read_b64_tr_b16 a[40:41], v66 offset:8192
    ds_read_b64_tr_b16 a[42:43], v66 offset:12288
    v_mfma_f32_16x16x32_bf16 v[160:163], a[112:115], a[184:187], v[160:163]
    ds_read_b64_tr_b16 a[44:45], v67 offset:8192
    v_mfma_f32_16x16x32_bf16 v[164:167], a[112:115], a[188:191], v[164:167]
    buffer_load_dwordx4 a[164:167], v88, s[8:11], s62 offen offset:1024 sc1
    ds_read_b64_tr_b16 a[46:47], v67 offset:12288
    v_mfma_f32_16x16x32_bf16 v[168:171], a[116:119], a[184:187], v[168:171]
    ds_read_b64_tr_b16 a[48:49], v68 offset:8192
    v_mfma_f32_16x16x32_bf16 v[172:175], a[116:119], a[188:191], v[172:175]
    ds_read_b64_tr_b16 a[50:51], v68 offset:12288
    ds_read_b64_tr_b16 a[52:53], v69 offset:8192
    v_mfma_f32_16x16x32_bf16 v[176:179], a[120:123], a[184:187], v[176:179]
    ds_read_b64_tr_b16 a[54:55], v69 offset:12288
    v_mfma_f32_16x16x32_bf16 v[180:183], a[120:123], a[188:191], v[180:183]
    buffer_load_dwordx4 a[168:171], v89, s[8:11], s62 offen offset:0 sc1
    ds_read_b64_tr_b16 a[56:57], v70 offset:8192
    v_mfma_f32_16x16x32_bf16 v[184:187], a[124:127], a[184:187], v[184:187]
    ds_read_b64_tr_b16 a[58:59], v70 offset:12288
    ds_read_b64_tr_b16 a[60:61], v71 offset:8192
    v_mfma_f32_16x16x32_bf16 v[188:191], a[124:127], a[188:191], v[188:191]
    ds_read_b64_tr_b16 a[62:63], v71 offset:12288
    v_mfma_f32_16x16x32_bf16 v[128:131], a[96:99], a[184:187], v[128:131]
    buffer_load_dwordx4 a[172:175], v89, s[8:11], s62 offen offset:1024 sc1
    v_mfma_f32_16x16x32_bf16 v[132:135], a[96:99], a[188:191], v[132:135]
    v_mfma_f32_16x16x32_bf16 v[136:139], a[100:103], a[184:187], v[136:139]
    v_mfma_f32_16x16x32_bf16 v[140:143], a[100:103], a[188:191], v[140:143]
    v_mfma_f32_16x16x32_bf16 v[144:147], a[104:107], a[184:187], v[144:147]
    v_mfma_f32_16x16x32_bf16 v[148:151], a[104:107], a[188:191], v[148:151]
    s_add_u32 s62, s62, 0x40000
    s_and_b32 s62, s62, 0x7fffff
    v_mfma_f32_16x16x32_bf16 v[152:155], a[108:111], a[184:187], v[152:155]
    s_add_u32 s63, s63, 1
    v_mfma_f32_16x16x32_bf16 v[156:159], a[108:111], a[188:191], v[156:159]
    s_waitcnt vmcnt(12) lgkmcnt(0)
    s_barrier
    s_cmp_lt_u32 s63, 8
    s_cbranch_scc1 op_loop_128
op_tail:
    s_nop 1
    v_cvt_pk_bf16_f32 v160, v160, v161
    v_cvt_pk_bf16_f32 v161, v162, v163
    v_cvt_pk_bf16_f32 v162, v164, v165
    v_cvt_pk_bf16_f32 v163, v166, v167
    v_min_u32 v160, -2, v160
    v_min_u32 v161, -2, v161
    v_min_u32 v162, -2, v162
    v_min_u32 v163, -2, v163
    buffer_store_dwordx4 v[160:163], v1, s[36:39], s52 offen offset:0 sc1
    v_cvt_pk_bf16_f32 v168, v168, v169
    v_cvt_pk_bf16_f32 v169, v170, v171
    v_cvt_pk_bf16_f32 v170, v172, v173
    v_cvt_pk_bf16_f32 v171, v174, v175
    v_min_u32 v168, -2, v168
    v_min_u32 v169, -2, v169
    v_min_u32 v170, -2, v170
    v_min_u32 v171, -2, v171
    buffer_store_dwordx4 v[168:171], v1, s[36:39], s52 offen offset:1024 sc1
    v_cvt_pk_bf16_f32 v176, v176, v177
    v_cvt_pk_bf16_f32 v177, v178, v179
    v_cvt_pk_bf16_f32 v178, v180, v181
    v_cvt_pk_bf16_f32 v179, v182, v183
    v_min_u32 v176, -2, v176
    v_min_u32 v177, -2, v177
    v_min_u32 v178, -2, v178
    v_min_u32 v179, -2, v179
    buffer_store_dwordx4 v[176:179], v1, s[36:39], s52 offen offset:2048 sc1
    v_cvt_pk_bf16_f32 v184, v184, v185
    v_cvt_pk_bf16_f32 v185, v186, v187
    v_cvt_pk_bf16_f32 v186, v188, v189
    v_cvt_pk_bf16_f32 v187, v190, v191
    v_min_u32 v184, -2, v184
    v_min_u32 v185, -2, v185
    v_min_u32 v186, -2, v186
    v_min_u32 v187, -2, v187
    buffer_store_dwordx4 v[184:187], v1, s[36:39], s52 offen offset:3072 sc1
    s_add_u32 s32, s6, 0x4800000
    s_addc_u32 s33, s7, 0
    s_and_b32 s33, s33, 0xffff
    s_mov_b32 s34, 0x6000
    s_mov_b32 s35, 0x00020000
    s_waitcnt vmcnt(4) lgkmcnt(0)
    v_lshlrev_b32 v58, 16, v192
    v_and_b32 v59, 0xffff0000, v192
    v_pk_add_f32 v[128:129], v[128:129], v[58:59]
    v_lshlrev_b32 v58, 16, v193
    v_and_b32 v59, 0xffff0000, v193
    v_pk_add_f32 v[130:131], v[130:131], v[58:59]
    v_lshlrev_b32 v58, 16, v200
    v_and_b32 v59, 0xffff0000, v200
    v_pk_add_f32 v[132:133], v[132:133], v[58:59]
    v_lshlrev_b32 v58, 16, v201
    v_and_b32 v59, 0xffff0000, v201
    v_pk_add_f32 v[134:135], v[134:135], v[58:59]
    v_lshlrev_b32 v58, 16, v194
    v_and_b32 v59, 0xffff0000, v194
    v_pk_add_f32 v[136:137], v[136:137], v[58:59]
    v_lshlrev_b32 v58, 16, v195
    v_and_b32 v59, 0xffff0000, v195
    v_pk_add_f32 v[138:139], v[138:139], v[58:59]
    v_lshlrev_b32 v58, 16, v202
    v_and_b32 v59, 0xffff0000, v202
    v_pk_add_f32 v[140:141], v[140:141], v[58:59]
    v_lshlrev_b32 v58, 16, v203
    v_and_b32 v59, 0xffff0000, v203
    v_pk_add_f32 v[142:143], v[142:143], v[58:59]
    v_lshlrev_b32 v58, 16, v196
    v_and_b32 v59, 0xffff0000, v196
    v_pk_add_f32 v[144:145], v[144:145], v[58:59]
    v_lshlrev_b32 v58, 16, v197
    v_and_b32 v59, 0xffff0000, v197
    v_pk_add_f32 v[146:147], v[146:147], v[58:59]
    v_lshlrev_b32 v58, 16, v204
    v_and_b32 v59, 0xffff0000, v204
    v_pk_add_f32 v[148:149], v[148:149], v[58:59]
    v_lshlrev_b32 v58, 16, v205
    v_and_b32 v59, 0xffff0000, v205
    v_pk_add_f32 v[150:151], v[150:151], v[58:59]
    v_lshlrev_b32 v58, 16, v198
    v_and_b32 v59, 0xffff0000, v198
    v_pk_add_f32 v[152:153], v[152:153], v[58:59]
    v_lshlrev_b32 v58, 16, v199
    v_and_b32 v59, 0xffff0000, v199
    v_pk_add_f32 v[154:155], v[154:155], v[58:59]
    v_lshlrev_b32 v58, 16, v206
    v_and_b32 v59, 0xffff0000, v206
    v_pk_add_f32 v[156:157], v[156:157], v[58:59]
    v_lshlrev_b32 v58, 16, v207
    v_and_b32 v59, 0xffff0000, v207
    v_pk_add_f32 v[158:159], v[158:159], v[58:59]
    v_and_b32 v58, 1, v72
    v_lshrrev_b32 v59, 1, v72
    v_lshlrev_b32 v58, 5, v58
    v_lshl_add_u32 v58, v59, 4, v58
    v_lshlrev_b32 v59, 3, v72
    v_sub_u32 v58, v58, v59
    v_add_u32 v78, v78, v58
    v_add_u32 v79, v79, v58
    v_lshlrev_b32 v32, 16, v208
    v_and_b32 v33, 0xffff0000, v208
    v_lshlrev_b32 v34, 16, v209
    v_and_b32 v35, 0xffff0000, v209
    v_lshlrev_b32 v36, 16, v210
    v_and_b32 v37, 0xffff0000, v210
    v_lshlrev_b32 v38, 16, v211
    v_and_b32 v39, 0xffff0000, v211
    v_lshlrev_b32 v40, 16, v212
    v_and_b32 v41, 0xffff0000, v212
    v_lshlrev_b32 v42, 16, v213
    v_and_b32 v43, 0xffff0000, v213
    v_lshlrev_b32 v44, 16, v214
    v_and_b32 v45, 0xffff0000, v214
    v_lshlrev_b32 v46, 16, v215
    v_and_b32 v47, 0xffff0000, v215
    s_or_b32 s31, s54, s30
    s_cbranch_scc1 op_nowr_139
    v_pk_add_f32 v[56:57], v[32:33], v[34:35]
    v_pk_add_f32 v[56:57], v[56:57], v[36:37]
    v_pk_add_f32 v[56:57], v[56:57], v[38:39]
    v_pk_add_f32 v[56:57], v[56:57], v[40:41]
    v_pk_add_f32 v[56:57], v[56:57], v[42:43]
    v_pk_add_f32 v[56:57], v[56:57], v[44:45]
    v_pk_add_f32 v[56:57], v[56:57], v[46:47]
    v_add_f32 v56, v56, v57
    v_mov_b32 v57, v56
    s_nop 1
    v_permlane16_swap_b32 v56, v57
    s_nop 1
    v_add_f32 v56, v56, v57
    v_mov_b32 v57, v56
    s_nop 1
    v_permlane32_swap_b32 v56, v57
    s_nop 1
    v_add_f32 v56, v56, v57
    s_mov_b32 s31, 24704
    s_mov_b32 s34, 24708
    s_mov_b64 exec, 1
    buffer_atomic_add_f32 v56, v75, s[32:35], s31 offen
    s_mov_b64 exec, -1
    s_mov_b32 s34, 24576
op_nowr_139:
    v_mov_b32 v208, 0
    v_mov_b32 v209, 0
    v_mov_b32 v210, 0
    v_mov_b32 v211, 0
    v_mov_b32 v212, 0
    v_mov_b32 v213, 0
    v_mov_b32 v214, 0
    v_mov_b32 v215, 0
    v_mov_b32 v216, 0
    v_mov_b32 v217, 0
    v_mov_b32 v218, 0
    v_mov_b32 v219, 0
    s_mov_b32 s40, 1048576
op_xspin_140:
    buffer_load_dwordx4 v[224:227], v1, s[36:39], s53 offen offset:0 sc1
    buffer_load_dwordx4 v[228:231], v1, s[36:39], s53 offen offset:1024 sc1
    buffer_load_dwordx4 v[232:235], v1, s[36:39], s53 offen offset:2048 sc1
    buffer_load_dwordx4 v[236:239], v1, s[36:39], s53 offen offset:3072 sc1
    s_sub_u32 s40, s40, 1
    s_waitcnt vmcnt(0)
    s_cbranch_scc1 op_xok_141
    v_max3_u32 v56, v224, v225, v226
    v_max3_u32 v56, v56, v227, v228
    v_max3_u32 v56, v56, v229, v230
    v_max3_u32 v56, v56, v231, v232
    v_max3_u32 v56, v56, v233, v234
    v_max3_u32 v56, v56, v235, v236
    v_max3_u32 v56, v56, v237, v238
    v_max_u32 v56, v56, v239
    v_cmp_eq_u32 vcc, -1, v56
    s_cbranch_vccz op_xok_141
    s_sleep 2
    s_branch op_xspin_140
op_xok_141:
    v_lshlrev_b32 v56, 16, v224
    v_and_b32 v57, 0xffff0000, v224
    v_lshlrev_b32 v58, 16, v225
    v_and_b32 v59, 0xffff0000, v225
    v_pk_add_f32 v[128:129], v[128:129], v[56:57]
    v_pk_add_f32 v[130:131], v[130:131], v[58:59]
    v_cvt_pk_bf16_f32 v192, v128, v129
    v_cvt_pk_bf16_f32 v193, v130, v131
    v_lshlrev_b32 v128, 16, v192
    v_and_b32 v129, 0xffff0000, v192
    v_lshlrev_b32 v130, 16, v193
    v_and_b32 v131, 0xffff0000, v193
    v_pk_add_f32 v[208:209], v[208:209], v[128:129]
    v_pk_fma_f32 v[210:211], v[128:129], v[128:129], v[210:211]
    v_pk_fma_f32 v[212:213], v[128:129], v[32:33], v[212:213]
    v_pk_add_f32 v[208:209], v[208:209], v[130:131]
    v_pk_fma_f32 v[210:211], v[130:131], v[130:131], v[210:211]
    v_pk_fma_f32 v[212:213], v[130:131], v[34:35], v[212:213]
    v_lshlrev_b32 v56, 16, v226
    v_and_b32 v57, 0xffff0000, v226
    v_lshlrev_b32 v58, 16, v227
    v_and_b32 v59, 0xffff0000, v227
    v_pk_add_f32 v[132:133], v[132:133], v[56:57]
    v_pk_add_f32 v[134:135], v[134:135], v[58:59]
    v_cvt_pk_bf16_f32 v200, v132, v133
    v_cvt_pk_bf16_f32 v201, v134, v135
    v_lshlrev_b32 v132, 16, v200
    v_and_b32 v133, 0xffff0000, v200
    v_lshlrev_b32 v134, 16, v201
    v_and_b32 v135, 0xffff0000, v201
    v_pk_add_f32 v[214:215], v[214:215], v[132:133]
    v_pk_fma_f32 v[216:217], v[132:133], v[132:133], v[216:217]
    v_pk_fma_f32 v[218:219], v[132:133], v[32:33], v[218:219]
    v_pk_add_f32 v[214:215], v[214:215], v[134:135]
    v_pk_fma_f32 v[216:217], v[134:135], v[134:135], v[216:217]
    v_pk_fma_f32 v[218:219], v[134:135], v[34:35], v[218:219]
    v_lshlrev_b32 v56, 16, v228
    v_and_b32 v57, 0xffff0000, v228
    v_lshlrev_b32 v58, 16, v229
    v_and_b32 v59, 0xffff0000, v229
    v_pk_add_f32 v[136:137], v[136:137], v[56:57]
    v_pk_add_f32 v[138:139], v[138:139], v[58:59]
    v_cvt_pk_bf16_f32 v194, v136, v137
    v_cvt_pk_bf16_f32 v195, v138, v139
    v_lshlrev_b32 v136, 16, v194
    v_and_b32 v137, 0xffff0000, v194
    v_lshlrev_b32 v138, 16, v195
    v_and_b32 v139, 0xffff0000, v195
    v_permlane16_swap_b32 v192, v194
    v_permlane16_swap_b32 v193, v195
    buffer_store_dwordx4 v[192:195], v78, s[24:27], 0 offen offset:0 sc1
    v_pk_add_f32 v[208:209], v[208:209], v[136:137]
    v_pk_fma_f32 v[210:211], v[136:137], v[136:137], v[210:211]
    v_pk_fma_f32 v[212:213], v[136:137], v[36:37], v[212:213]
    v_pk_add_f32 v[208:209], v[208:209], v[138:139]
    v_pk_fma_f32 v[210:211], v[138:139], v[138:139], v[210:211]
    v_pk_fma_f32 v[212:213], v[138:139], v[38:39], v[212:213]
    v_lshlrev_b32 v56, 16, v230
    v_and_b32 v57, 0xffff0000, v230
    v_lshlrev_b32 v58, 16, v231
    v_and_b32 v59, 0xffff0000, v231
    v_pk_add_f32 v[140:141], v[140:141], v[56:57]
    v_pk_add_f32 v[142:143], v[142:143], v[58:59]
    v_cvt_pk_bf16_f32 v202, v140, v141
    v_cvt_pk_bf16_f32 v203, v142, v143
    v_lshlrev_b32 v140, 16, v202
    v_and_b32 v141, 0xffff0000, v202
    v_lshlrev_b32 v142, 16, v203
    v_and_b32 v143, 0xffff0000, v203
    v_permlane16_swap_b32 v200, v202
    v_permlane16_swap_b32 v201, v203
    buffer_store_dwordx4 v[200:203], v79, s[24:27], 0 offen offset:0 sc1
    v_pk_add_f32 v[214:215], v[214:215], v[140:141]
    v_pk_fma_f32 v[216:217], v[140:141], v[140:141], v[216:217]
    v_pk_fma_f32 v[218:219], v[140:141], v[36:37], v[218:219]
    v_pk_add_f32 v[214:215], v[214:215], v[142:143]
    v_pk_fma_f32 v[216:217], v[142:143], v[142:143], v[216:217]
    v_pk_fma_f32 v[218:219], v[142:143], v[38:39], v[218:219]
    v_lshlrev_b32 v56, 16, v232
    v_and_b32 v57, 0xffff0000, v232
    v_lshlrev_b32 v58, 16, v233
    v_and_b32 v59, 0xffff0000, v233
    v_pk_add_f32 v[144:145], v[144:145], v[56:57]
    v_pk_add_f32 v[146:147], v[146:147], v[58:59]
    v_cvt_pk_bf16_f32 v196, v144, v145
    v_cvt_pk_bf16_f32 v197, v146, v147
    v_lshlrev_b32 v144, 16, v196
    v_and_b32 v145, 0xffff0000, v196
    v_lshlrev_b32 v146, 16, v197
    v_and_b32 v147, 0xffff0000, v197
    v_pk_add_f32 v[208:209], v[208:209], v[144:145]
    v_pk_fma_f32 v[210:211], v[144:145], v[144:145], v[210:211]
    v_pk_fma_f32 v[212:213], v[144:145], v[40:41], v[212:213]
    v_pk_add_f32 v[208:209], v[208:209], v[146:147]
    v_pk_fma_f32 v[210:211], v[146:147], v[146:147], v[210:211]
    v_pk_fma_f32 v[212:213], v[146:147], v[42:43], v[212:213]
    v_lshlrev_b32 v56, 16, v234
    v_and_b32 v57, 0xffff0000, v234
    v_lshlrev_b32 v58, 16, v235
    v_and_b32 v59, 0xffff0000, v235
    v_pk_add_f32 v[148:149], v[148:149], v[56:57]
    v_pk_add_f32 v[150:151], v[150:151], v[58:59]
    v_cvt_pk_bf16_f32 v204, v148, v149
    v_cvt_pk_bf16_f32 v205, v150, v151
    v_lshlrev_b32 v148, 16, v204
    v_and_b32 v149, 0xffff0000, v204
    v_lshlrev_b32 v150, 16, v205
    v_and_b32 v151, 0xffff0000, v205
    v_pk_add_f32 v[214:215], v[214:215], v[148:149]
    v_pk_fma_f32 v[216:217], v[148:149], v[148:149], v[216:217]
    v_pk_fma_f32 v[218:219], v[148:149], v[40:41], v[218:219]
    v_pk_add_f32 v[214:215], v[214:215], v[150:151]
    v_pk_fma_f32 v[216:217], v[150:151], v[150:151], v[216:217]
    v_pk_fma_f32 v[218:219], v[150:151], v[42:43], v[218:219]
    v_lshlrev_b32 v56, 16, v236
    v_and_b32 v57, 0xffff0000, v236
    v_lshlrev_b32 v58, 16, v237
    v_and_b32 v59, 0xffff0000, v237
    v_pk_add_f32 v[152:153], v[152:153], v[56:57]
    v_pk_add_f32 v[154:155], v[154:155], v[58:59]
    v_cvt_pk_bf16_f32 v198, v152, v153
    v_cvt_pk_bf16_f32 v199, v154, v155
    v_lshlrev_b32 v152, 16, v198
    v_and_b32 v153, 0xffff0000, v198
    v_lshlrev_b32 v154, 16, v199
    v_and_b32 v155, 0xffff0000, v199
    v_permlane16_swap_b32 v196, v198
    v_permlane16_swap_b32 v197, v199
    buffer_store_dwordx4 v[196:199], v78, s[24:27], 0 offen offset:64 sc1
    v_pk_add_f32 v[208:209], v[208:209], v[152:153]
    v_pk_fma_f32 v[210:211], v[152:153], v[152:153], v[210:211]
    v_pk_fma_f32 v[212:213], v[152:153], v[44:45], v[212:213]
    v_pk_add_f32 v[208:209], v[208:209], v[154:155]
    v_pk_fma_f32 v[210:211], v[154:155], v[154:155], v[210:211]
    v_pk_fma_f32 v[212:213], v[154:155], v[46:47], v[212:213]
    v_lshlrev_b32 v56, 16, v238
    v_and_b32 v57, 0xffff0000, v238
    v_lshlrev_b32 v58, 16, v239
    v_and_b32 v59, 0xffff0000, v239
    v_pk_add_f32 v[156:157], v[156:157], v[56:57]
    v_pk_add_f32 v[158:159], v[158:159], v[58:59]
    v_cvt_pk_bf16_f32 v206, v156, v157
    v_cvt_pk_bf16_f32 v207, v158, v159
    v_lshlrev_b32 v156, 16, v206
    v_and_b32 v157, 0xffff0000, v206
    v_lshlrev_b32 v158, 16, v207
    v_and_b32 v159, 0xffff0000, v207
    v_permlane16_swap_b32 v204, v206
    v_permlane16_swap_b32 v205, v207
    buffer_store_dwordx4 v[204:207], v79, s[24:27], 0 offen offset:64 sc1
    v_pk_add_f32 v[214:215], v[214:215], v[156:157]
    v_pk_fma_f32 v[216:217], v[156:157], v[156:157], v[216:217]
    v_pk_fma_f32 v[218:219], v[156:157], v[44:45], v[218:219]
    v_pk_add_f32 v[214:215], v[214:215], v[158:159]
    v_pk_fma_f32 v[216:217], v[158:159], v[158:159], v[216:217]
    v_pk_fma_f32 v[218:219], v[158:159], v[46:47], v[218:219]
    v_add_f32 v48, v208, v209
    v_add_f32 v49, v210, v211
    v_add_f32 v50, v212, v213
    v_add_f32 v52, v214, v215
    v_add_f32 v53, v216, v217
    v_add_f32 v54, v218, v219
    v_mov_b32 v56, v48
    v_mov_b32 v57, v49
    v_mov_b32 v58, v50
    v_mov_b32 v59, v52
    v_mov_b32 v60, v53
    v_mov_b32 v61, v54
    s_nop 1
    v_permlane16_swap_b32 v48, v56
    v_permlane16_swap_b32 v49, v57
    v_permlane16_swap_b32 v50, v58
    v_permlane16_swap_b32 v52, v59
    v_permlane16_swap_b32 v53, v60
    v_permlane16_swap_b32 v54, v61
    s_nop 1
    v_add_f32 v48, v48, v56
    v_add_f32 v49, v49, v57
    v_add_f32 v50, v50, v58
    v_add_f32 v52, v52, v59
    v_add_f32 v53, v53, v60
    v_add_f32 v54, v54, v61
    v_mov_b32 v56, v48
    v_mov_b32 v57, v49
    v_mov_b32 v58, v50
    v_mov_b32 v59, v52
    v_mov_b32 v60, v53
    v_mov_b32 v61, v54
    s_nop 1
    v_permlane32_swap_b32 v48, v56
    v_permlane32_swap_b32 v49, v57
    v_permlane32_swap_b32 v50, v58
    v_permlane32_swap_b32 v52, v59
    v_permlane32_swap_b32 v53, v60
    v_permlane32_swap_b32 v54, v61
    s_nop 1
    v_add_f32 v48, v48, v56
    v_add_f32 v49, v49, v57
    v_add_f32 v50, v50, v58
    v_add_f32 v52, v52, v59
    v_add_f32 v53, v53, v60
    v_add_f32 v54, v54, v61
    v_cmp_eq_u32 s[40:41], 1, v72
    v_cmp_eq_u32 s[42:43], 2, v72
    s_nop 1
    v_cndmask_b32 v48, v48, v49, s[40:41]
    v_cndmask_b32 v48, v48, v50, s[42:43]
    buffer_atomic_add_f32 v48, v77, s[32:35], 0 offen offset:0
    v_cndmask_b32 v52, v52, v53, s[40:41]
    v_cndmask_b32 v52, v52, v54, s[42:43]
    buffer_atomic_add_f32 v52, v77, s[32:35], 0 offen offset:64
    s_load_dwordx2 s[42:43], s[0:1], 88
    s_load_dwordx2 s[56:57], s[0:1], 56
    s_add_u32 s16, s6, 0x4815000
    s_addc_u32 s17, s7, 0
    s_and_b32 s17, s17, 0xffff
    s_mov_b32 s18, 0x1000
    s_mov_b32 s19, 0x00020000
    v_lshrrev_b32 v3, 4, v1
    v_lshl_add_u32 v2, s30, 6, v3
    v_and_b32 v4, 31, v3
    v_lshrrev_b32 v5, 5, v3
    v_lshlrev_b32 v7, 4, v4
    v_and_b32 v8, 15, v3
    v_lshlrev_b32 v6, 7, v8
    s_bfe_u32 s31, s2, 0x20003
    s_lshl_b32 s31, s31, 7
    v_lshlrev_b32 v12, 9, v3
    v_and_b32 v14, 3, v3
    v_lshlrev_b32 v14, 7, v14
    s_and_b32 s59, s2, 7
    s_lshl_b32 s59, s59, 9
    s_setreg_imm32_b32 hwreg(HW_REG_MODE, 4, 2), 3
    s_waitcnt vmcnt(0) lgkmcnt(0)
    s_barrier
    s_cmp_lg_u32 s30, 0
    s_cbranch_scc1 ff_nosig_142
    s_mov_b64 exec, 0xff
    buffer_atomic_add v76, v12, s[16:19], s31 offen sc1
    s_mov_b64 exec, -1
ff_nosig_142:
    s_lshl_b32 s40, s30, 13
    s_add_u32 m0, s40, 65536
    s_add_u32 s41, s3, 0
    buffer_load_dwordx4 v1, s[44:47], s41 offen offset:0 sc1 lds
    buffer_load_dwordx4 v1, s[44:47], s41 offen offset:1024 sc1 lds
    buffer_load_dwordx4 v1, s[44:47], s41 offen offset:2048 sc1 lds
    buffer_load_dwordx4 v1, s[44:47], s41 offen offset:3072 sc1 lds
    s_lshl_b32 s40, s30, 13
    s_add_u32 m0, s40, 69632
    s_add_u32 s41, s3, 4096
    buffer_load_dwordx4 v1, s[44:47], s41 offen offset:0 sc1 lds
    buffer_load_dwordx4 v1, s[44:47], s41 offen offset:1024 sc1 lds
    buffer_load_dwordx4 v1, s[44:47], s41 offen offset:2048 sc1 lds
    buffer_load_dwordx4 v1, s[44:47], s41 offen offset:3072 sc1 lds
    s_lshl_b32 s40, s30, 13
    s_add_u32 m0, s40, 98304
    s_add_u32 s41, s3, 8388608
    buffer_load_dwordx4 v1, s[44:47], s41 offen offset:0 sc1 lds
    buffer_load_dwordx4 v1, s[44:47], s41 offen offset:1024 sc1 lds
    buffer_load_dwordx4 v1, s[44:47], s41 offen offset:2048 sc1 lds
    buffer_load_dwordx4 v1, s[44:47], s41 offen offset:3072 sc1 lds
    s_lshl_b32 s40, s30, 13
    s_add_u32 m0, s40, 102400
    s_add_u32 s41, s3, 8392704
    buffer_load_dwordx4 v1, s[44:47], s41 offen offset:0 sc1 lds
    buffer_load_dwordx4 v1, s[44:47], s41 offen offset:1024 sc1 lds
    buffer_load_dwordx4 v1, s[44:47], s41 offen offset:2048 sc1 lds
    buffer_load_dwordx4 v1, s[44:47], s41 offen offset:3072 sc1 lds
    s_lshl_b32 s41, s30, 9
    s_add_u32 s41, s41, 131072
    v_lshrrev_b32 v9, 1, v1
    v_add_u32 v9, s41, v9
    ds_read_b64 v[96:97], v9 offset:0
    ds_read_b64 v[98:99], v9 offset:2048
    ds_read_b64 v[100:101], v9 offset:4096
    ds_read_b64 v[102:103], v9 offset:6144
    ds_read_b64 v[104:105], v9 offset:8192
    ds_read_b64 v[106:107], v9 offset:10240
    ds_read_b64 v[108:109], v9 offset:12288
    ds_read_b64 v[110:111], v9 offset:14336
    ds_read_b64 v[112:113], v9 offset:16384
    ds_read_b64 v[114:115], v9 offset:18432
    ds_read_b64 v[116:117], v9 offset:20480
    ds_read_b64 v[118:119], v9 offset:22528
    ds_read_b64 v[120:121], v9 offset:24576
    ds_read_b64 v[122:123], v9 offset:26624
    ds_read_b64 v[124:125], v9 offset:28672
    ds_read_b64 v[126:127], v9 offset:30720
    s_mov_b32 s54, 0x05040100
    s_mov_b32 s53, 0x07060302
    s_waitcnt lgkmcnt(0)
    v_perm_b32 v144, v98, v96, s54
    v_perm_b32 v145, v98, v96, s53
    v_perm_b32 v146, v99, v97, s54
    v_perm_b32 v147, v99, v97, s53
    v_perm_b32 v148, v102, v100, s54
    v_perm_b32 v149, v102, v100, s53
    v_perm_b32 v150, v103, v101, s54
    v_perm_b32 v151, v103, v101, s53
    v_perm_b32 v152, v106, v104, s54
    v_perm_b32 v153, v106, v104, s53
    v_perm_b32 v154, v107, v105, s54
    v_perm_b32 v155, v107, v105, s53
    v_perm_b32 v156, v110, v108, s54
    v_perm_b32 v157, v110, v108, s53
    v_perm_b32 v158, v111, v109, s54
    v_perm_b32 v159, v111, v109, s53
    v_perm_b32 v160, v114, v112, s54
    v_perm_b32 v161, v114, v112, s53
    v_perm_b32 v162, v115, v113, s54
    v_perm_b32 v163, v115, v113, s53
    v_perm_b32 v164, v118, v116, s54
    v_perm_b32 v165, v118, v116, s53
    v_perm_b32 v166, v119, v117, s54
    v_perm_b32 v167, v119, v117, s53
    v_perm_b32 v168, v122, v120, s54
    v_perm_b32 v169, v122, v120, s53
    v_perm_b32 v170, v123, v121, s54
    v_perm_b32 v171, v123, v121, s53
    v_perm_b32 v172, v126, v124, s54
    v_perm_b32 v173, v126, v124, s53
    v_perm_b32 v174, v127, v125, s54
    v_perm_b32 v175, v127, v125, s53
    s_mov_b32 s34, 24708
    s_mov_b32 s36, s42
    s_and_b32 s37, s43, 0xffff
    s_mov_b32 s38, 0x400000
    s_mov_b32 s39, 0x00020000
    s_add_u32 s48, s6, 0x4900000
    s_addc_u32 s49, s7, 0
    s_and_b32 s49, s49, 0xffff
    s_mov_b32 s50, 0x1c0000
    s_mov_b32 s51, 0x00020000
    v_lshlrev_b32 v10, 5, v2
    v_lshl_add_u32 v11, s30, 1, v5
    s_lshl_b32 s31, s2, 3
    v_add_u32 v11, s31, v11
    v_lshl_add_u32 v0, v11, 11, v7
    s_cmp_lg_u32 s30, 0
    s_cbranch_scc1 ff_go_143
    s_mov_b32 s52, 1048576
ff_poll_144:
    buffer_load_dword v13, v14, s[16:19], s59 offen sc1
    s_sub_u32 s52, s52, 1
    s_cbranch_scc1 ff_go_143
    s_waitcnt vmcnt(0)
    v_cmp_gt_u32 vcc, 64, v13
    s_cbranch_vccz ff_go_143
    s_sleep 4
    s_branch ff_poll_144
ff_go_143:
    s_barrier
    s_mov_b32 s31, 0
    buffer_load_dwordx4 v[16:19], v10, s[32:35], s31 offen sc1
    buffer_load_dwordx4 v[20:23], v10, s[32:35], s31 offen offset:16 sc1
    s_mov_b32 s31, 8192
    buffer_load_dwordx4 v[24:27], v10, s[32:35], s31 offen sc1
    buffer_load_dwordx4 v[28:31], v10, s[32:35], s31 offen offset:16 sc1
    s_mov_b32 s31, 16384
    buffer_load_dwordx4 v[32:35], v10, s[32:35], s31 offen sc1
    buffer_load_dwordx4 v[36:39], v10, s[32:35], s31 offen offset:16 sc1
    s_mov_b32 s31, 24704
    buffer_load_dword v10, v75, s[32:35], s31 offen sc1
    s_mov_b32 s52, 0x3a800000
    s_mov_b32 s53, 0x3a800000
    s_mov_b32 s54, 0x7ff
    v_mov_b32 v14, 0x3727c5ac
    v_mov_b32 v15, v14
    v_mov_b32 v12, 0xff800000
    v_mov_b32 v13, v12
    s_waitcnt vmcnt(0)
    v_sub_f32 v56, 0, v10
    v_sub_f32 v57, 0, v10
    v_pk_mul_f32 v[16:17], v[16:17], s[52:53]
    v_pk_fma_f32 v[24:25], v[24:25], s[52:53], v[14:15]
    v_pk_fma_f32 v[32:33], v[16:17], v[56:57], v[32:33]
    v_pk_fma_f32 v[24:25], v[16:17], v[16:17], v[24:25] neg_lo:[1,0,0] neg_hi:[1,0,0]
    v_pk_mul_f32 v[18:19], v[18:19], s[52:53]
    v_pk_fma_f32 v[26:27], v[26:27], s[52:53], v[14:15]
    v_pk_fma_f32 v[34:35], v[18:19], v[56:57], v[34:35]
    v_pk_fma_f32 v[26:27], v[18:19], v[18:19], v[26:27] neg_lo:[1,0,0] neg_hi:[1,0,0]
    v_pk_mul_f32 v[20:21], v[20:21], s[52:53]
    v_pk_fma_f32 v[28:29], v[28:29], s[52:53], v[14:15]
    v_pk_fma_f32 v[36:37], v[20:21], v[56:57], v[36:37]
    v_pk_fma_f32 v[28:29], v[20:21], v[20:21], v[28:29] neg_lo:[1,0,0] neg_hi:[1,0,0]
    v_pk_mul_f32 v[22:23], v[22:23], s[52:53]
    v_pk_fma_f32 v[30:31], v[30:31], s[52:53], v[14:15]
    v_pk_fma_f32 v[38:39], v[22:23], v[56:57], v[38:39]
    v_pk_fma_f32 v[30:31], v[22:23], v[22:23], v[30:31] neg_lo:[1,0,0] neg_hi:[1,0,0]
    v_max_f32 v24, v14, v24
    v_max_f32 v25, v14, v25
    v_max_f32 v26, v14, v26
    v_max_f32 v27, v14, v27
    v_max_f32 v28, v14, v28
    v_max_f32 v29, v14, v29
    v_max_f32 v30, v14, v30
    v_max_f32 v31, v14, v31
    v_rsq_f32 v24, v24
    v_rsq_f32 v25, v25
    v_rsq_f32 v26, v26
    v_rsq_f32 v27, v27
    v_rsq_f32 v28, v28
    v_rsq_f32 v29, v29
    v_rsq_f32 v30, v30
    v_rsq_f32 v31, v31
    v_pk_mul_f32 v[32:33], v[32:33], v[24:25]
    v_pk_mul_f32 v[34:35], v[34:35], v[26:27]
    v_pk_mul_f32 v[36:37], v[36:37], v[28:29]
    v_pk_mul_f32 v[38:39], v[38:39], v[30:31]
    v_bfi_b32 v32, s54, 0, v32
    v_med3_f32 v13, v12, v13, v32
    v_max_f32 v12, v12, v32
    v_bfi_b32 v33, s54, 1, v33
    v_med3_f32 v13, v12, v13, v33
    v_max_f32 v12, v12, v33
    v_bfi_b32 v34, s54, 2, v34
    v_med3_f32 v13, v12, v13, v34
    v_max_f32 v12, v12, v34
    v_bfi_b32 v35, s54, 3, v35
    v_med3_f32 v13, v12, v13, v35
    v_max_f32 v12, v12, v35
    v_bfi_b32 v36, s54, 4, v36
    v_med3_f32 v13, v12, v13, v36
    v_max_f32 v12, v12, v36
    v_bfi_b32 v37, s54, 5, v37
    v_med3_f32 v13, v12, v13, v37
    v_max_f32 v12, v12, v37
    v_bfi_b32 v38, s54, 6, v38
    v_med3_f32 v13, v12, v13, v38
    v_max_f32 v12, v12, v38
    v_bfi_b32 v39, s54, 7, v39
    v_med3_f32 v13, v12, v13, v39
    v_max_f32 v12, v12, v39
    v_lshl_or_b32 v12, v2, 3, v12
    v_lshl_or_b32 v13, v2, 3, v13
    s_nop 1
    v_mov_b32_dpp v14, v12 quad_perm:[1,0,3,2] row_mask:0xf bank_mask:0xf
    v_mov_b32_dpp v15, v13 quad_perm:[1,0,3,2] row_mask:0xf bank_mask:0xf
    v_max_f32 v15, v15, v13
    v_med3_f32 v13, v12, v14, v15
    v_max_f32 v12, v12, v14
    s_nop 1
    v_mov_b32_dpp v14, v12 quad_perm:[2,3,0,1] row_mask:0xf bank_mask:0xf
    v_mov_b32_dpp v15, v13 quad_perm:[2,3,0,1] row_mask:0xf bank_mask:0xf
    v_max_f32 v15, v15, v13
    v_med3_f32 v13, v12, v14, v15
    v_max_f32 v12, v12, v14
    s_nop 1
    v_mov_b32_dpp v14, v12 row_half_mirror row_mask:0xf bank_mask:0xf
    v_mov_b32_dpp v15, v13 row_half_mirror row_mask:0xf bank_mask:0xf
    v_max_f32 v15, v15, v13
    v_med3_f32 v13, v12, v14, v15
    v_max_f32 v12, v12, v14
    s_nop 1
    v_mov_b32_dpp v14, v12 row_mirror row_mask:0xf bank_mask:0xf
    v_mov_b32_dpp v15, v13 row_mirror row_mask:0xf bank_mask:0xf
    v_max_f32 v15, v15, v13
    v_med3_f32 v13, v12, v14, v15
    v_max_f32 v12, v12, v14
    v_mov_b32 v14, v12
    v_mov_b32 v15, v13
    s_nop 1
    v_permlane16_swap_b32 v12, v14
    v_permlane16_swap_b32 v13, v15
    s_nop 1
    v_max_f32 v15, v15, v13
    v_med3_f32 v13, v12, v14, v15
    v_max_f32 v12, v12, v14
    v_mov_b32 v14, v12
    v_mov_b32 v15, v13
    s_nop 1
    v_permlane32_swap_b32 v12, v14
    v_permlane32_swap_b32 v13, v15
    s_nop 1
    v_max_f32 v15, v15, v13
    v_med3_f32 v13, v12, v14, v15
    v_max_f32 v12, v12, v14
    s_lshl_b32 s31, s30, 3
    s_add_u32 s31, s31, 8192
    v_mov_b32 v14, s31
    ds_write_b64 v14, v[12:13]
    v_mov_b32 v14, 8192
    s_waitcnt lgkmcnt(0)
    s_barrier
    ds_read_b128 v[16:19], v14
    ds_read_b128 v[20:23], v14 offset:16
    v_cmp_eq_u32 vcc, 0, v5
    s_waitcnt lgkmcnt(0)
    v_max_f32 v19, v19, v17
    v_med3_f32 v17, v16, v18, v19
    v_max_f32 v16, v16, v18
    v_max_f32 v23, v23, v21
    v_med3_f32 v21, v20, v22, v23
    v_max_f32 v20, v20, v22
    v_max_f32 v21, v21, v17
    v_med3_f32 v17, v16, v20, v21
    v_max_f32 v16, v16, v20
    v_and_b32 v16, 0x7ff, v16
    v_and_b32 v17, 0x7ff, v17
    v_cndmask_b32 v15, v17, v16, vcc
    v_lshl_add_u32 v12, v15, 11, v7
    buffer_load_dwordx4 v[40:43], v12, s[24:27], 0 offen offset:0 sc1
    buffer_load_dwordx4 v[44:47], v12, s[24:27], 0 offen offset:512 sc1
    buffer_load_dwordx4 v[48:51], v12, s[24:27], 0 offen offset:1024 sc1
    buffer_load_dwordx4 v[52:55], v12, s[24:27], 0 offen offset:1536 sc1
    buffer_load_dwordx4 v[128:131], v0, s[24:27], 0 offen offset:0 sc1
    buffer_load_dwordx4 v[132:135], v0, s[24:27], 0 offen offset:512 sc1
    buffer_load_dwordx4 v[136:139], v0, s[24:27], 0 offen offset:1024 sc1
    buffer_load_dwordx4 v[140:143], v0, s[24:27], 0 offen offset:1536 sc1
    v_cmp_eq_u32 vcc, v16, v11
    v_cmp_eq_u32 s[52:53], v17, v11
    v_mov_b32 v13, 0x7fffffff
    s_or_b64 vcc, vcc, s[52:53]
    v_cndmask_b32 v0, v0, v13, vcc
    v_lshl_add_u32 v12, v5, 11, v7
    v_add_u32 v12, 4096, v12
    s_mov_b32 s58, 0
    s_waitcnt vmcnt(4)
ff_ln_145:
    v_lshlrev_b32 v216, 16, v40
    v_and_b32 v217, 0xffff0000, v40
    v_lshlrev_b32 v218, 16, v41
    v_and_b32 v219, 0xffff0000, v41
    v_lshlrev_b32 v220, 16, v42
    v_and_b32 v221, 0xffff0000, v42
    v_lshlrev_b32 v222, 16, v43
    v_and_b32 v223, 0xffff0000, v43
    v_lshlrev_b32 v224, 16, v44
    v_and_b32 v225, 0xffff0000, v44
    v_lshlrev_b32 v226, 16, v45
    v_and_b32 v227, 0xffff0000, v45
    v_lshlrev_b32 v228, 16, v46
    v_and_b32 v229, 0xffff0000, v46
    v_lshlrev_b32 v230, 16, v47
    v_and_b32 v231, 0xffff0000, v47
    v_lshlrev_b32 v232, 16, v48
    v_and_b32 v233, 0xffff0000, v48
    v_lshlrev_b32 v234, 16, v49
    v_and_b32 v235, 0xffff0000, v49
    v_lshlrev_b32 v236, 16, v50
    v_and_b32 v237, 0xffff0000, v50
    v_lshlrev_b32 v238, 16, v51
    v_and_b32 v239, 0xffff0000, v51
    v_lshlrev_b32 v240, 16, v52
    v_and_b32 v241, 0xffff0000, v52
    v_lshlrev_b32 v242, 16, v53
    v_and_b32 v243, 0xffff0000, v53
    v_lshlrev_b32 v244, 16, v54
    v_and_b32 v245, 0xffff0000, v54
    v_lshlrev_b32 v246, 16, v55
    v_and_b32 v247, 0xffff0000, v55
    v_pk_add_f32 v[208:209], v[216:217], v[218:219]
    v_pk_add_f32 v[210:211], v[220:221], v[222:223]
    v_pk_add_f32 v[208:209], v[208:209], v[224:225]
    v_pk_add_f32 v[210:211], v[210:211], v[226:227]
    v_pk_add_f32 v[208:209], v[208:209], v[228:229]
    v_pk_add_f32 v[210:211], v[210:211], v[230:231]
    v_pk_add_f32 v[208:209], v[208:209], v[232:233]
    v_pk_add_f32 v[210:211], v[210:211], v[234:235]
    v_pk_add_f32 v[208:209], v[208:209], v[236:237]
    v_pk_add_f32 v[210:211], v[210:211], v[238:239]
    v_pk_add_f32 v[208:209], v[208:209], v[240:241]
    v_pk_add_f32 v[210:211], v[210:211], v[242:243]
    v_pk_add_f32 v[208:209], v[208:209], v[244:245]
    v_pk_add_f32 v[210:211], v[210:211], v[246:247]
    v_pk_add_f32 v[208:209], v[208:209], v[210:211]
    v_add_f32 v208, v208, v209
    s_nop 1
    v_add_f32_dpp v208, v208, v208 quad_perm:[1,0,3,2] row_mask:0xf bank_mask:0xf
    s_nop 1
    v_add_f32_dpp v208, v208, v208 quad_perm:[2,3,0,1] row_mask:0xf bank_mask:0xf
    s_nop 1
    v_add_f32_dpp v208, v208, v208 row_half_mirror row_mask:0xf bank_mask:0xf
    s_nop 1
    v_add_f32_dpp v208, v208, v208 row_mirror row_mask:0xf bank_mask:0xf
    v_mov_b32 v210, v208
    s_nop 1
    v_permlane16_swap_b32 v208, v210
    s_nop 1
    v_add_f32 v208, v208, v210
    v_mul_f32 v208, 0xba800000, v208
    v_mov_b32 v209, v208
    v_pk_add_f32 v[210:211], v[216:217], v[208:209]
    v_pk_add_f32 v[214:215], v[218:219], v[208:209]
    v_pk_mul_f32 v[212:213], v[210:211], v[210:211]
    v_pk_fma_f32 v[212:213], v[214:215], v[214:215], v[212:213]
    v_pk_add_f32 v[210:211], v[220:221], v[208:209]
    v_pk_add_f32 v[214:215], v[222:223], v[208:209]
    v_pk_fma_f32 v[212:213], v[210:211], v[210:211], v[212:213]
    v_pk_fma_f32 v[212:213], v[214:215], v[214:215], v[212:213]
    v_pk_add_f32 v[210:211], v[224:225], v[208:209]
    v_pk_add_f32 v[214:215], v[226:227], v[208:209]
    v_pk_fma_f32 v[212:213], v[210:211], v[210:211], v[212:213]
    v_pk_fma_f32 v[212:213], v[214:215], v[214:215], v[212:213]
    v_pk_add_f32 v[210:211], v[228:229], v[208:209]
    v_pk_add_f32 v[214:215], v[230:231], v[208:209]
    v_pk_fma_f32 v[212:213], v[210:211], v[210:211], v[212:213]
    v_pk_fma_f32 v[212:213], v[214:215], v[214:215], v[212:213]
    v_pk_add_f32 v[210:211], v[232:233], v[208:209]
    v_pk_add_f32 v[214:215], v[234:235], v[208:209]
    v_pk_fma_f32 v[212:213], v[210:211], v[210:211], v[212:213]
    v_pk_fma_f32 v[212:213], v[214:215], v[214:215], v[212:213]
    v_pk_add_f32 v[210:211], v[236:237], v[208:209]
    v_pk_add_f32 v[214:215], v[238:239], v[208:209]
    v_pk_fma_f32 v[212:213], v[210:211], v[210:211], v[212:213]
    v_pk_fma_f32 v[212:213], v[214:215], v[214:215], v[212:213]
    v_pk_add_f32 v[210:211], v[240:241], v[208:209]
    v_pk_add_f32 v[214:215], v[242:243], v[208:209]
    v_pk_fma_f32 v[212:213], v[210:211], v[210:211], v[212:213]
    v_pk_fma_f32 v[212:213], v[214:215], v[214:215], v[212:213]
    v_pk_add_f32 v[210:211], v[244:245], v[208:209]
    v_pk_add_f32 v[214:215], v[246:247], v[208:209]
    v_pk_fma_f32 v[212:213], v[210:211], v[210:211], v[212:213]
    v_pk_fma_f32 v[212:213], v[214:215], v[214:215], v[212:213]
    v_add_f32 v212, v212, v213
    s_nop 1
    v_add_f32_dpp v212, v212, v212 quad_perm:[1,0,3,2] row_mask:0xf bank_mask:0xf
    s_nop 1
    v_add_f32_dpp v212, v212, v212 quad_perm:[2,3,0,1] row_mask:0xf bank_mask:0xf
    s_nop 1
    v_add_f32_dpp v212, v212, v212 row_half_mirror row_mask:0xf bank_mask:0xf
    s_nop 1
    v_add_f32_dpp v212, v212, v212 row_mirror row_mask:0xf bank_mask:0xf
    v_mov_b32 v210, v212
    s_nop 1
    v_permlane16_swap_b32 v212, v210
    s_nop 1
    v_add_f32 v212, v212, v210
    v_mul_f32 v212, 0x3a800000, v212
    v_cvt_pk_bf16_f32 v214, v208, v212
    v_and_b32 v212, 0xffff0000, v214
    v_lshlrev_b32 v214, 16, v214
    v_add_f32 v212, 0x3727c5ac, v212
    v_mov_b32 v215, v214
    v_cvt_pk_bf16_f32 v212, v212, v212
    v_and_b32 v212, 0xffff0000, v212
    v_sqrt_f32 v212, v212
    v_pk_add_f32 v[176:177], v[216:217], v[214:215]
    v_pk_add_f32 v[178:179], v[218:219], v[214:215]
    v_pk_add_f32 v[180:181], v[220:221], v[214:215]
    v_pk_add_f32 v[182:183], v[222:223], v[214:215]
    v_pk_add_f32 v[184:185], v[224:225], v[214:215]
    v_pk_add_f32 v[186:187], v[226:227], v[214:215]
    v_pk_add_f32 v[188:189], v[228:229], v[214:215]
    v_pk_add_f32 v[190:191], v[230:231], v[214:215]
    v_pk_add_f32 v[192:193], v[232:233], v[214:215]
    v_pk_add_f32 v[194:195], v[234:235], v[214:215]
    v_pk_add_f32 v[196:197], v[236:237], v[214:215]
    v_pk_add_f32 v[198:199], v[238:239], v[214:215]
    v_pk_add_f32 v[200:201], v[240:241], v[214:215]
    v_pk_add_f32 v[202:203], v[242:243], v[214:215]
    v_pk_add_f32 v[204:205], v[244:245], v[214:215]
    v_pk_add_f32 v[206:207], v[246:247], v[214:215]
    v_cvt_pk_bf16_f32 v212, v212, v212
    v_and_b32 v212, 0xffff0000, v212
    v_rcp_f32 v212, v212
    v_cvt_pk_bf16_f32 v40, v176, v177
    v_cvt_pk_bf16_f32 v41, v178, v179
    v_cvt_pk_bf16_f32 v42, v180, v181
    v_cvt_pk_bf16_f32 v43, v182, v183
    v_cvt_pk_bf16_f32 v44, v184, v185
    v_cvt_pk_bf16_f32 v45, v186, v187
    v_cvt_pk_bf16_f32 v46, v188, v189
    v_cvt_pk_bf16_f32 v47, v190, v191
    v_cvt_pk_bf16_f32 v48, v192, v193
    v_cvt_pk_bf16_f32 v49, v194, v195
    v_cvt_pk_bf16_f32 v50, v196, v197
    v_cvt_pk_bf16_f32 v51, v198, v199
    v_cvt_pk_bf16_f32 v52, v200, v201
    v_cvt_pk_bf16_f32 v53, v202, v203
    v_cvt_pk_bf16_f32 v54, v204, v205
    v_cvt_pk_bf16_f32 v55, v206, v207
    v_mov_b32 v213, v212
    v_lshlrev_b32 v176, 16, v40
    v_and_b32 v177, 0xffff0000, v40
    v_lshlrev_b32 v178, 16, v41
    v_and_b32 v179, 0xffff0000, v41
    v_lshlrev_b32 v180, 16, v42
    v_and_b32 v181, 0xffff0000, v42
    v_lshlrev_b32 v182, 16, v43
    v_and_b32 v183, 0xffff0000, v43
    v_lshlrev_b32 v184, 16, v44
    v_and_b32 v185, 0xffff0000, v44
    v_lshlrev_b32 v186, 16, v45
    v_and_b32 v187, 0xffff0000, v45
    v_lshlrev_b32 v188, 16, v46
    v_and_b32 v189, 0xffff0000, v46
    v_lshlrev_b32 v190, 16, v47
    v_and_b32 v191, 0xffff0000, v47
    v_lshlrev_b32 v192, 16, v48
    v_and_b32 v193, 0xffff0000, v48
    v_lshlrev_b32 v194, 16, v49
    v_and_b32 v195, 0xffff0000, v49
    v_lshlrev_b32 v196, 16, v50
    v_and_b32 v197, 0xffff0000, v50
    v_lshlrev_b32 v198, 16, v51
    v_and_b32 v199, 0xffff0000, v51
    v_lshlrev_b32 v200, 16, v52
    v_and_b32 v201, 0xffff0000, v52
    v_lshlrev_b32 v202, 16, v53
    v_and_b32 v203, 0xffff0000, v53
    v_lshlrev_b32 v204, 16, v54
    v_and_b32 v205, 0xffff0000, v54
    v_lshlrev_b32 v206, 16, v55
    v_and_b32 v207, 0xffff0000, v55
    v_pk_mul_f32 v[176:177], v[176:177], v[212:213]
    v_pk_mul_f32 v[178:179], v[178:179], v[212:213]
    v_pk_mul_f32 v[180:181], v[180:181], v[212:213]
    v_pk_mul_f32 v[182:183], v[182:183], v[212:213]
    v_pk_mul_f32 v[184:185], v[184:185], v[212:213]
    v_pk_mul_f32 v[186:187], v[186:187], v[212:213]
    v_pk_mul_f32 v[188:189], v[188:189], v[212:213]
    v_pk_mul_f32 v[190:191], v[190:191], v[212:213]
    v_pk_mul_f32 v[192:193], v[192:193], v[212:213]
    v_pk_mul_f32 v[194:195], v[194:195], v[212:213]
    v_pk_mul_f32 v[196:197], v[196:197], v[212:213]
    v_pk_mul_f32 v[198:199], v[198:199], v[212:213]
    v_pk_mul_f32 v[200:201], v[200:201], v[212:213]
    v_pk_mul_f32 v[202:203], v[202:203], v[212:213]
    v_pk_mul_f32 v[204:205], v[204:205], v[212:213]
    v_pk_mul_f32 v[206:207], v[206:207], v[212:213]
    v_cvt_pk_bf16_f32 v40, v176, v177
    v_cvt_pk_bf16_f32 v41, v178, v179
    v_cvt_pk_bf16_f32 v42, v180, v181
    v_cvt_pk_bf16_f32 v43, v182, v183
    v_cvt_pk_bf16_f32 v44, v184, v185
    v_cvt_pk_bf16_f32 v45, v186, v187
    v_cvt_pk_bf16_f32 v46, v188, v189
    v_cvt_pk_bf16_f32 v47, v190, v191
    v_cvt_pk_bf16_f32 v48, v192, v193
    v_cvt_pk_bf16_f32 v49, v194, v195
    v_cvt_pk_bf16_f32 v50, v196, v197
    v_cvt_pk_bf16_f32 v51, v198, v199
    v_cvt_pk_bf16_f32 v52, v200, v201
    v_cvt_pk_bf16_f32 v53, v202, v203
    v_cvt_pk_bf16_f32 v54, v204, v205
    v_cvt_pk_bf16_f32 v55, v206, v207
    s_cmp_lg_u32 s58, 0
    s_cbranch_scc1 ff_own_146
    ds_write_b128 v12, v[40:43] offset:0
    ds_write_b128 v12, v[44:47] offset:512
    ds_write_b128 v12, v[48:51] offset:1024
    ds_write_b128 v12, v[52:55] offset:1536
    s_cmp_ge_u32 s2, 224
    s_cbranch_scc1 ff_red_147
    v_lshrrev_b32 v12, 4, v3
    v_and_b32 v13, 1, v3
    v_lshlrev_b32 v13, 11, v13
    v_lshl_add_u32 v13, v12, 3, v13
    s_lshl_b32 s54, s30, 9
    s_add_u32 s54, s54, 4096
    v_add_u32 v13, s54, v13
    v_lshlrev_b32 v14, 3, v3
    s_lshl_b32 s54, s30, 13
    s_add_u32 s54, s54, 65536
    v_add_u32 v14, s54, v14
    ds_read_b64_tr_b16 a[0:1], v14 offset:0
    ds_read_b64_tr_b16 a[2:3], v14 offset:512
    ds_read_b64_tr_b16 a[4:5], v14 offset:1024
    ds_read_b64_tr_b16 a[6:7], v14 offset:1536
    ds_read_b64_tr_b16 a[8:9], v14 offset:2048
    ds_read_b64_tr_b16 a[10:11], v14 offset:2560
    ds_read_b64_tr_b16 a[12:13], v14 offset:3072
    ds_read_b64_tr_b16 a[14:15], v14 offset:3584
    ds_read_b64_tr_b16 a[16:17], v14 offset:4096
    ds_read_b64_tr_b16 a[18:19], v14 offset:4608
    ds_read_b64_tr_b16 a[20:21], v14 offset:5120
    ds_read_b64_tr_b16 a[22:23], v14 offset:5632
    ds_read_b64_tr_b16 a[24:25], v14 offset:6144
    ds_read_b64_tr_b16 a[26:27], v14 offset:6656
    ds_read_b64_tr_b16 a[28:29], v14 offset:7168
    ds_read_b64_tr_b16 a[30:31], v14 offset:7680
    ds_read_b64_tr_b16 a[32:33], v14 offset:32768
    ds_read_b64_tr_b16 a[34:35], v14 offset:33280
    ds_read_b64_tr_b16 a[36:37], v14 offset:33792
    ds_read_b64_tr_b16 a[38:39], v14 offset:34304
    ds_read_b64_tr_b16 a[40:41], v14 offset:34816
    ds_read_b64_tr_b16 a[42:43], v14 offset:35328
    ds_read_b64_tr_b16 a[44:45], v14 offset:35840
    ds_read_b64_tr_b16 a[46:47], v14 offset:36352
    ds_read_b64_tr_b16 a[48:49], v14 offset:36864
    ds_read_b64_tr_b16 a[50:51], v14 offset:37376
    ds_read_b64_tr_b16 a[52:53], v14 offset:37888
    ds_read_b64_tr_b16 a[54:55], v14 offset:38400
    ds_read_b64_tr_b16 a[56:57], v14 offset:38912
    ds_read_b64_tr_b16 a[58:59], v14 offset:39424
    ds_read_b64_tr_b16 a[60:61], v14 offset:39936
    ds_read_b64_tr_b16 a[62:63], v14 offset:40448
    ds_read_b64 a[64:65], v13 offset:0
    ds_read_b64 a[66:67], v13 offset:32
    ds_read_b64 a[68:69], v13 offset:64
    ds_read_b64 a[70:71], v13 offset:96
    ds_read_b64 a[72:73], v13 offset:128
    ds_read_b64 a[74:75], v13 offset:160
    ds_read_b64 a[76:77], v13 offset:192
    ds_read_b64 a[78:79], v13 offset:224
    ds_read_b64 a[80:81], v13 offset:256
    ds_read_b64 a[82:83], v13 offset:288
    ds_read_b64 a[84:85], v13 offset:320
    ds_read_b64 a[86:87], v13 offset:352
    ds_read_b64 a[88:89], v13 offset:384
    ds_read_b64 a[90:91], v13 offset:416
    ds_read_b64 a[92:93], v13 offset:448
    ds_read_b64 a[94:95], v13 offset:480
    v_lshlrev_b32 v13, 6, v8
    v_lshl_add_u32 v13, v12, 4, v13
    s_lshl_b32 s54, s30, 11
    s_add_u32 s54, s54, 8448
    v_add_u32 v13, s54, v13
    s_waitcnt lgkmcnt(0)
    v_mfma_f32_16x16x32_bf16 v[16:19], a[0:3], a[64:67], 0
    v_mfma_f32_16x16x32_bf16 v[20:23], a[32:35], a[64:67], 0
    v_mfma_f32_16x16x32_bf16 v[16:19], a[4:7], a[68:71], v[16:19]
    v_mfma_f32_16x16x32_bf16 v[20:23], a[36:39], a[68:71], v[20:23]
    v_mfma_f32_16x16x32_bf16 v[16:19], a[8:11], a[72:75], v[16:19]
    v_mfma_f32_16x16x32_bf16 v[20:23], a[40:43], a[72:75], v[20:23]
    v_mfma_f32_16x16x32_bf16 v[16:19], a[12:15], a[76:79], v[16:19]
    v_mfma_f32_16x16x32_bf16 v[20:23], a[44:47], a[76:79], v[20:23]
    v_mfma_f32_16x16x32_bf16 v[16:19], a[16:19], a[80:83], v[16:19]
    v_mfma_f32_16x16x32_bf16 v[20:23], a[48:51], a[80:83], v[20:23]
    v_mfma_f32_16x16x32_bf16 v[16:19], a[20:23], a[84:87], v[16:19]
    v_mfma_f32_16x16x32_bf16 v[20:23], a[52:55], a[84:87], v[20:23]
    v_mfma_f32_16x16x32_bf16 v[16:19], a[24:27], a[88:91], v[16:19]
    v_mfma_f32_16x16x32_bf16 v[20:23], a[56:59], a[88:91], v[20:23]
    v_mfma_f32_16x16x32_bf16 v[16:19], a[28:31], a[92:95], v[16:19]
    v_mfma_f32_16x16x32_bf16 v[20:23], a[60:63], a[92:95], v[20:23]
    s_nop 7
    ds_write_b128 v13, v[16:19]
    ds_write_b128 v13, v[20:23] offset:1024
    v_lshlrev_b32 v13, 2, v4
    v_add_u32 v13, 8448, v13
    s_waitcnt lgkmcnt(0)
    s_barrier
    ds_read2st64_b32 v[16:17], v13 offset0:0 offset1:4
    ds_read2st64_b32 v[18:19], v13 offset0:8 offset1:12
    ds_read2st64_b32 v[20:21], v13 offset0:16 offset1:20
    ds_read2st64_b32 v[22:23], v13 offset0:24 offset1:28
    s_waitcnt lgkmcnt(0)
    v_pk_add_f32 v[16:17], v[16:17], v[20:21]
    v_pk_add_f32 v[18:19], v[18:19], v[22:23]
    v_pk_add_f32 v[16:17], v[16:17], v[18:19]
    v_cvt_pk_bf16_f32 v16, v16, v17
    v_and_b32 v20, 0xffff0000, v16
    v_lshlrev_b32 v16, 16, v16
    v_mul_f32 v17, 0xbfb8aa3b, v16
    v_exp_f32 v17, v17
    s_lshl_b32 s54, s55, 13
    v_add_f32 v17, 1.0, v17
    v_rcp_f32 v17, v17
    s_add_u32 s53, s54, 4096
    v_mul_f32 v16, v16, v17
    v_cvt_pk_bf16_f32 v16, v16, v16
    v_and_b32 v16, 0xffff0000, v16
    v_mul_f32 v16, v16, v20
    s_nop 1
    v_mov_b32_dpp v17, v16 quad_perm:[1,0,3,2] row_mask:0xf bank_mask:0xf
    v_cvt_pk_bf16_f32 v16, v16, v17
    v_lshlrev_b32 v13, 4, v2
    v_readlane_b32 s8, v16, 0
    v_readlane_b32 s9, v16, 2
    v_readlane_b32 s10, v16, 4
    v_readlane_b32 s11, v16, 6
    v_readlane_b32 s12, v16, 8
    v_readlane_b32 s13, v16, 10
    v_readlane_b32 s14, v16, 12
    v_readlane_b32 s15, v16, 14
    v_readlane_b32 s16, v16, 16
    v_readlane_b32 s17, v16, 18
    v_readlane_b32 s18, v16, 20
    v_readlane_b32 s19, v16, 22
    v_readlane_b32 s20, v16, 24
    v_readlane_b32 s21, v16, 26
    v_readlane_b32 s22, v16, 28
    v_readlane_b32 s23, v16, 30
    v_dot2_f32_bf16 v24, v144, s8, 0
    v_dot2_f32_bf16 v25, v145, s8, 0
    v_dot2_f32_bf16 v26, v146, s8, 0
    v_dot2_f32_bf16 v27, v147, s8, 0
    v_dot2_f32_bf16 v24, v148, s9, v24
    v_dot2_f32_bf16 v25, v149, s9, v25
    v_dot2_f32_bf16 v26, v150, s9, v26
    v_dot2_f32_bf16 v27, v151, s9, v27
    v_dot2_f32_bf16 v24, v152, s10, v24
    v_dot2_f32_bf16 v25, v153, s10, v25
    v_dot2_f32_bf16 v26, v154, s10, v26
    v_dot2_f32_bf16 v27, v155, s10, v27
    v_dot2_f32_bf16 v24, v156, s11, v24
    v_dot2_f32_bf16 v25, v157, s11, v25
    v_dot2_f32_bf16 v26, v158, s11, v26
    v_dot2_f32_bf16 v27, v159, s11, v27
    v_dot2_f32_bf16 v24, v160, s12, v24
    v_dot2_f32_bf16 v25, v161, s12, v25
    v_dot2_f32_bf16 v26, v162, s12, v26
    v_dot2_f32_bf16 v27, v163, s12, v27
    v_dot2_f32_bf16 v24, v164, s13, v24
    v_dot2_f32_bf16 v25, v165, s13, v25
    v_dot2_f32_bf16 v26, v166, s13, v26
    v_dot2_f32_bf16 v27, v167, s13, v27
    v_dot2_f32_bf16 v24, v168, s14, v24
    v_dot2_f32_bf16 v25, v169, s14, v25
    v_dot2_f32_bf16 v26, v170, s14, v26
    v_dot2_f32_bf16 v27, v171, s14, v27
    v_dot2_f32_bf16 v24, v172, s15, v24
    v_dot2_f32_bf16 v25, v173, s15, v25
    v_dot2_f32_bf16 v26, v174, s15, v26
    v_dot2_f32_bf16 v27, v175, s15, v27
    v_dot2_f32_bf16 v28, v144, s16, 0
    v_dot2_f32_bf16 v29, v145, s16, 0
    v_dot2_f32_bf16 v30, v146, s16, 0
    v_dot2_f32_bf16 v31, v147, s16, 0
    v_dot2_f32_bf16 v28, v148, s17, v28
    v_dot2_f32_bf16 v29, v149, s17, v29
    v_dot2_f32_bf16 v30, v150, s17, v30
    v_dot2_f32_bf16 v31, v151, s17, v31
    v_dot2_f32_bf16 v28, v152, s18, v28
    v_dot2_f32_bf16 v29, v153, s18, v29
    v_dot2_f32_bf16 v30, v154, s18, v30
    v_dot2_f32_bf16 v31, v155, s18, v31
    v_dot2_f32_bf16 v28, v156, s19, v28
    v_dot2_f32_bf16 v29, v157, s19, v29
    v_dot2_f32_bf16 v30, v158, s19, v30
    v_dot2_f32_bf16 v31, v159, s19, v31
    v_dot2_f32_bf16 v28, v160, s20, v28
    v_dot2_f32_bf16 v29, v161, s20, v29
    v_dot2_f32_bf16 v30, v162, s20, v30
    v_dot2_f32_bf16 v31, v163, s20, v31
    v_dot2_f32_bf16 v28, v164, s21, v28
    v_dot2_f32_bf16 v29, v165, s21, v29
    v_dot2_f32_bf16 v30, v166, s21, v30
    v_dot2_f32_bf16 v31, v167, s21, v31
    v_dot2_f32_bf16 v28, v168, s22, v28
    v_dot2_f32_bf16 v29, v169, s22, v29
    v_dot2_f32_bf16 v30, v170, s22, v30
    v_dot2_f32_bf16 v31, v171, s22, v31
    v_dot2_f32_bf16 v28, v172, s23, v28
    v_dot2_f32_bf16 v29, v173, s23, v29
    v_dot2_f32_bf16 v30, v174, s23, v30
    v_dot2_f32_bf16 v31, v175, s23, v31
    s_nop 2
    v_min_u32 v24, -2, v24
    v_min_u32 v25, -2, v25
    v_min_u32 v26, -2, v26
    v_min_u32 v27, -2, v27
    v_min_u32 v28, -2, v28
    v_min_u32 v29, -2, v29
    v_min_u32 v30, -2, v30
    v_min_u32 v31, -2, v31
    buffer_store_dwordx4 v[24:27], v13, s[48:51], s54 offen sc1
    buffer_store_dwordx4 v[28:31], v13, s[48:51], s53 offen sc1
    s_waitcnt vmcnt(2)
    v_mov_b32 v40, v128
    v_mov_b32 v41, v129
    v_mov_b32 v42, v130
    v_mov_b32 v43, v131
    v_mov_b32 v44, v132
    v_mov_b32 v45, v133
    v_mov_b32 v46, v134
    v_mov_b32 v47, v135
    v_mov_b32 v48, v136
    v_mov_b32 v49, v137
    v_mov_b32 v50, v138
    v_mov_b32 v51, v139
    v_mov_b32 v52, v140
    v_mov_b32 v53, v141
    v_mov_b32 v54, v142
    v_mov_b32 v55, v143
    s_mov_b32 s58, 1
    s_branch ff_ln_145
ff_own_146:
    v_lshlrev_b32 v176, 16, v40
    v_and_b32 v177, 0xffff0000, v40
    v_lshlrev_b32 v178, 16, v41
    v_and_b32 v179, 0xffff0000, v41
    v_lshlrev_b32 v180, 16, v42
    v_and_b32 v181, 0xffff0000, v42
    v_lshlrev_b32 v182, 16, v43
    v_and_b32 v183, 0xffff0000, v43
    v_lshlrev_b32 v184, 16, v44
    v_and_b32 v185, 0xffff0000, v44
    v_lshlrev_b32 v186, 16, v45
    v_and_b32 v187, 0xffff0000, v45
    v_lshlrev_b32 v188, 16, v46
    v_and_b32 v189, 0xffff0000, v46
    v_lshlrev_b32 v190, 16, v47
    v_and_b32 v191, 0xffff0000, v47
    v_lshlrev_b32 v192, 16, v48
    v_and_b32 v193, 0xffff0000, v48
    v_lshlrev_b32 v194, 16, v49
    v_and_b32 v195, 0xffff0000, v49
    v_lshlrev_b32 v196, 16, v50
    v_and_b32 v197, 0xffff0000, v50
    v_lshlrev_b32 v198, 16, v51
    v_and_b32 v199, 0xffff0000, v51
    v_lshlrev_b32 v200, 16, v52
    v_and_b32 v201, 0xffff0000, v52
    v_lshlrev_b32 v202, 16, v53
    v_and_b32 v203, 0xffff0000, v53
    v_lshlrev_b32 v204, 16, v54
    v_and_b32 v205, 0xffff0000, v54
    v_lshlrev_b32 v206, 16, v55
    v_and_b32 v207, 0xffff0000, v55
    v_pk_add_f32 v[176:177], v[176:177], v[216:217]
    v_pk_add_f32 v[178:179], v[178:179], v[218:219]
    v_pk_add_f32 v[180:181], v[180:181], v[220:221]
    v_pk_add_f32 v[182:183], v[182:183], v[222:223]
    v_pk_add_f32 v[184:185], v[184:185], v[224:225]
    v_pk_add_f32 v[186:187], v[186:187], v[226:227]
    v_pk_add_f32 v[188:189], v[188:189], v[228:229]
    v_pk_add_f32 v[190:191], v[190:191], v[230:231]
    v_pk_add_f32 v[192:193], v[192:193], v[232:233]
    v_pk_add_f32 v[194:195], v[194:195], v[234:235]
    v_pk_add_f32 v[196:197], v[196:197], v[236:237]
    v_pk_add_f32 v[198:199], v[198:199], v[238:239]
    v_pk_add_f32 v[200:201], v[200:201], v[240:241]
    v_pk_add_f32 v[202:203], v[202:203], v[242:243]
    v_pk_add_f32 v[204:205], v[204:205], v[244:245]
    v_pk_add_f32 v[206:207], v[206:207], v[246:247]
    v_cvt_pk_bf16_f32 v40, v176, v177
    v_cvt_pk_bf16_f32 v41, v178, v179
    v_cvt_pk_bf16_f32 v42, v180, v181
    v_cvt_pk_bf16_f32 v43, v182, v183
    v_cvt_pk_bf16_f32 v44, v184, v185
    v_cvt_pk_bf16_f32 v45, v186, v187
    v_cvt_pk_bf16_f32 v46, v188, v189
    v_cvt_pk_bf16_f32 v47, v190, v191
    v_cvt_pk_bf16_f32 v48, v192, v193
    v_cvt_pk_bf16_f32 v49, v194, v195
    v_cvt_pk_bf16_f32 v50, v196, v197
    v_cvt_pk_bf16_f32 v51, v198, v199
    v_cvt_pk_bf16_f32 v52, v200, v201
    v_cvt_pk_bf16_f32 v53, v202, v203
    v_cvt_pk_bf16_f32 v54, v204, v205
    v_cvt_pk_bf16_f32 v55, v206, v207
    buffer_store_dwordx4 v[40:43], v0, s[36:39], 0 offen offset:0 sc1
    buffer_store_dwordx4 v[44:47], v0, s[36:39], 0 offen offset:512 sc1
    buffer_store_dwordx4 v[48:51], v0, s[36:39], 0 offen offset:1024 sc1
    buffer_store_dwordx4 v[52:55], v0, s[36:39], 0 offen offset:1536 sc1
    s_cmp_ge_u32 s2, 224
    s_cbranch_scc1 ff_red2_148
    s_branch ff_fin_149
ff_red_147:
    s_sub_u32 s40, s2, 224
    s_lshr_b32 s41, s40, 4
    s_and_b32 s42, s40, 15
    s_mov_b32 s8, s56
    s_and_b32 s9, s57, 0xffff
    s_mov_b32 s10, 0x800
    s_mov_b32 s11, 0x00020000
    buffer_load_dwordx4 v[96:99], v7, s[8:11], 0 offen offset:0
    buffer_load_dwordx4 v[100:103], v7, s[8:11], 0 offen offset:512
    buffer_load_dwordx4 v[104:107], v7, s[8:11], 0 offen offset:1024
    buffer_load_dwordx4 v[108:111], v7, s[8:11], 0 offen offset:1536
    s_lshl_b32 s43, s41, 5
    v_readlane_b32 s46, v15, s43
    s_lshl_b32 s47, s42, 7
    v_lshl_add_u32 v9, v8, 3, s47
    s_lshl_b32 s46, s46, 11
    s_lshl_b32 s31, s41, 11
    s_add_u32 s31, s31, 4096
    v_add_u32 v12, s31, v9
    s_waitcnt lgkmcnt(0)
    ds_read_b64 v[32:33], v12
    buffer_load_dwordx2 v[34:35], v9, s[24:27], s46 offen sc1
    v_lshrrev_b32 v10, 4, v2
    v_lshlrev_b32 v10, 13, v10
    v_lshl_add_u32 v10, v8, 4, v10
    s_lshl_b32 s47, s40, 8
    s_waitcnt vmcnt(1)
    v_dot2_f32_bf16 v12, v40, v96, 0
    v_dot2_f32_bf16 v12, v41, v97, v12
    v_dot2_f32_bf16 v12, v42, v98, v12
    v_dot2_f32_bf16 v12, v43, v99, v12
    v_dot2_f32_bf16 v12, v44, v100, v12
    v_dot2_f32_bf16 v12, v45, v101, v12
    v_dot2_f32_bf16 v12, v46, v102, v12
    v_dot2_f32_bf16 v12, v47, v103, v12
    v_dot2_f32_bf16 v12, v48, v104, v12
    v_dot2_f32_bf16 v12, v49, v105, v12
    v_dot2_f32_bf16 v12, v50, v106, v12
    v_dot2_f32_bf16 v12, v51, v107, v12
    v_dot2_f32_bf16 v12, v52, v108, v12
    v_dot2_f32_bf16 v12, v53, v109, v12
    v_dot2_f32_bf16 v12, v54, v110, v12
    v_dot2_f32_bf16 v12, v55, v111, v12
    s_nop 2
    s_nop 1
    v_add_f32_dpp v12, v12, v12 quad_perm:[1,0,3,2] row_mask:0xf bank_mask:0xf
    s_nop 1
    v_add_f32_dpp v12, v12, v12 quad_perm:[2,3,0,1] row_mask:0xf bank_mask:0xf
    s_nop 1
    v_add_f32_dpp v12, v12, v12 row_half_mirror row_mask:0xf bank_mask:0xf
    s_nop 1
    v_add_f32_dpp v12, v12, v12 row_mirror row_mask:0xf bank_mask:0xf
    v_mov_b32 v13, v12
    s_nop 1
    v_permlane16_swap_b32 v12, v13
    s_nop 1
    v_add_f32 v12, v12, v13
    v_cvt_pk_bf16_f32 v12, v12, v12
    v_and_b32 v12, 0xffff0000, v12
    v_mul_f32 v12, 0xbfb8aa3b, v12
    v_exp_f32 v12, v12
    s_lshl_b32 s44, s42, 1
    v_add_f32 v12, 1.0, v12
    v_rcp_f32 v12, v12
    s_add_u32 s44, s44, s41
    s_lshl_b32 s44, s44, 11
    v_cvt_pk_bf16_f32 v12, v12, v12
    v_and_b32 v12, 0xffff0000, v12
    v_mov_b32 v40, v128
    v_mov_b32 v41, v129
    v_mov_b32 v42, v130
    v_mov_b32 v43, v131
    v_mov_b32 v44, v132
    v_mov_b32 v45, v133
    v_mov_b32 v46, v134
    v_mov_b32 v47, v135
    v_mov_b32 v48, v136
    v_mov_b32 v49, v137
    v_mov_b32 v50, v138
    v_mov_b32 v51, v139
    v_mov_b32 v52, v140
    v_mov_b32 v53, v141
    v_mov_b32 v54, v142
    v_mov_b32 v55, v143
    v_readlane_b32 s45, v12, s43
    s_mov_b32 s58, 1
    s_branch ff_ln_145
ff_red2_148:
    s_mov_b32 s52, 1048576
ff_rpoll_151:
    s_mov_b32 s53, s47
    buffer_load_dwordx4 v[96:99], v10, s[48:51], s53 offen sc1
    s_add_u32 s53, s53, 0x20000
    buffer_load_dwordx4 v[100:103], v10, s[48:51], s53 offen sc1
    s_add_u32 s53, s53, 0x20000
    buffer_load_dwordx4 v[104:107], v10, s[48:51], s53 offen sc1
    s_add_u32 s53, s53, 0x20000
    buffer_load_dwordx4 v[108:111], v10, s[48:51], s53 offen sc1
    s_add_u32 s53, s53, 0x20000
    buffer_load_dwordx4 v[112:115], v10, s[48:51], s53 offen sc1
    s_add_u32 s53, s53, 0x20000
    buffer_load_dwordx4 v[116:119], v10, s[48:51], s53 offen sc1
    s_add_u32 s53, s53, 0x20000
    buffer_load_dwordx4 v[120:123], v10, s[48:51], s53 offen sc1
    s_add_u32 s53, s53, 0x20000
    buffer_load_dwordx4 v[124:127], v10, s[48:51], s53 offen sc1
    s_add_u32 s53, s53, 0x20000
    buffer_load_dwordx4 v[128:131], v10, s[48:51], s53 offen sc1
    s_add_u32 s53, s53, 0x20000
    buffer_load_dwordx4 v[132:135], v10, s[48:51], s53 offen sc1
    s_add_u32 s53, s53, 0x20000
    buffer_load_dwordx4 v[136:139], v10, s[48:51], s53 offen sc1
    s_add_u32 s53, s53, 0x20000
    buffer_load_dwordx4 v[140:143], v10, s[48:51], s53 offen sc1
    s_add_u32 s53, s53, 0x20000
    buffer_load_dwordx4 v[144:147], v10, s[48:51], s53 offen sc1
    s_add_u32 s53, s53, 0x20000
    buffer_load_dwordx4 v[148:151], v10, s[48:51], s53 offen sc1
    s_add_u32 s53, s53, 0x20000
    v_mov_b32 v13, 0
    s_waitcnt vmcnt(13)
    v_max3_u32 v13, v13, v96, v97
    v_max3_u32 v13, v13, v98, v99
    s_waitcnt vmcnt(12)
    v_max3_u32 v13, v13, v100, v101
    v_max3_u32 v13, v13, v102, v103
    s_waitcnt vmcnt(11)
    v_max3_u32 v13, v13, v104, v105
    v_max3_u32 v13, v13, v106, v107
    s_waitcnt vmcnt(10)
    v_max3_u32 v13, v13, v108, v109
    v_max3_u32 v13, v13, v110, v111
    s_waitcnt vmcnt(9)
    v_max3_u32 v13, v13, v112, v113
    v_max3_u32 v13, v13, v114, v115
    s_waitcnt vmcnt(8)
    v_max3_u32 v13, v13, v116, v117
    v_max3_u32 v13, v13, v118, v119
    s_waitcnt vmcnt(7)
    v_max3_u32 v13, v13, v120, v121
    v_max3_u32 v13, v13, v122, v123
    s_waitcnt vmcnt(6)
    v_max3_u32 v13, v13, v124, v125
    v_max3_u32 v13, v13, v126, v127
    s_waitcnt vmcnt(5)
    v_max3_u32 v13, v13, v128, v129
    v_max3_u32 v13, v13, v130, v131
    s_waitcnt vmcnt(4)
    v_max3_u32 v13, v13, v132, v133
    v_max3_u32 v13, v13, v134, v135
    s_waitcnt vmcnt(3)
    v_max3_u32 v13, v13, v136, v137
    v_max3_u32 v13, v13, v138, v139
    s_waitcnt vmcnt(2)
    v_max3_u32 v13, v13, v140, v141
    v_max3_u32 v13, v13, v142, v143
    s_waitcnt vmcnt(1)
    v_max3_u32 v13, v13, v144, v145
    v_max3_u32 v13, v13, v146, v147
    s_waitcnt vmcnt(0)
    v_max3_u32 v13, v13, v148, v149
    v_max3_u32 v13, v13, v150, v151
    s_sub_u32 s52, s52, 1
    s_cbranch_scc1 ff_rgo_150
    v_cmp_eq_u32 vcc, -1, v13
    s_cbranch_vccnz ff_rpoll_151
ff_rgo_150:
    v_pk_add_f32 v[96:97], v[96:97], v[100:101]
    v_pk_add_f32 v[98:99], v[98:99], v[102:103]
    v_pk_add_f32 v[96:97], v[96:97], v[104:105]
    v_pk_add_f32 v[98:99], v[98:99], v[106:107]
    v_pk_add_f32 v[96:97], v[96:97], v[108:109]
    v_pk_add_f32 v[98:99], v[98:99], v[110:111]
    v_pk_add_f32 v[96:97], v[96:97], v[112:113]
    v_pk_add_f32 v[98:99], v[98:99], v[114:115]
    v_pk_add_f32 v[96:97], v[96:97], v[116:117]
    v_pk_add_f32 v[98:99], v[98:99], v[118:119]
    v_pk_add_f32 v[96:97], v[96:97], v[120:121]
    v_pk_add_f32 v[98:99], v[98:99], v[122:123]
    v_pk_add_f32 v[96:97], v[96:97], v[124:125]
    v_pk_add_f32 v[98:99], v[98:99], v[126:127]
    v_pk_add_f32 v[96:97], v[96:97], v[128:129]
    v_pk_add_f32 v[98:99], v[98:99], v[130:131]
    v_pk_add_f32 v[96:97], v[96:97], v[132:133]
    v_pk_add_f32 v[98:99], v[98:99], v[134:135]
    v_pk_add_f32 v[96:97], v[96:97], v[136:137]
    v_pk_add_f32 v[98:99], v[98:99], v[138:139]
    v_pk_add_f32 v[96:97], v[96:97], v[140:141]
    v_pk_add_f32 v[98:99], v[98:99], v[142:143]
    v_pk_add_f32 v[96:97], v[96:97], v[144:145]
    v_pk_add_f32 v[98:99], v[98:99], v[146:147]
    v_pk_add_f32 v[96:97], v[96:97], v[148:149]
    v_pk_add_f32 v[98:99], v[98:99], v[150:151]
    v_mov_b32 v100, v96
    v_mov_b32 v101, v97
    v_mov_b32 v102, v98
    v_mov_b32 v103, v99
    s_nop 1
    v_permlane16_swap_b32 v96, v100
    v_permlane16_swap_b32 v97, v101
    v_permlane16_swap_b32 v98, v102
    v_permlane16_swap_b32 v99, v103
    s_nop 1
    v_add_f32 v96, v96, v100
    v_add_f32 v97, v97, v101
    v_add_f32 v98, v98, v102
    v_add_f32 v99, v99, v103
    v_mov_b32 v100, v96
    v_mov_b32 v101, v97
    v_mov_b32 v102, v98
    v_mov_b32 v103, v99
    s_nop 1
    v_permlane32_swap_b32 v96, v100
    v_permlane32_swap_b32 v97, v101
    v_permlane32_swap_b32 v98, v102
    v_permlane32_swap_b32 v99, v103
    s_nop 1
    v_add_f32 v96, v96, v100
    v_add_f32 v97, v97, v101
    v_add_f32 v98, v98, v102
    v_add_f32 v99, v99, v103
    v_lshlrev_b32 v14, 4, v8
    s_lshl_b32 s31, s30, 8
    v_add_u32 v13, s31, v14
    ds_write_b128 v13, v[96:99]
    s_waitcnt lgkmcnt(0)
    s_barrier
    ds_read_b128 v[96:99], v14 offset:0
    ds_read_b128 v[100:103], v14 offset:256
    ds_read_b128 v[104:107], v14 offset:512
    ds_read_b128 v[108:111], v14 offset:768
    s_waitcnt lgkmcnt(0)
    v_pk_add_f32 v[96:97], v[96:97], v[100:101]
    v_pk_add_f32 v[98:99], v[98:99], v[102:103]
    v_pk_add_f32 v[96:97], v[96:97], v[104:105]
    v_pk_add_f32 v[98:99], v[98:99], v[106:107]
    v_pk_add_f32 v[96:97], v[96:97], v[108:109]
    v_pk_add_f32 v[98:99], v[98:99], v[110:111]
    v_cvt_pk_bf16_f32 v20, v96, v97
    v_lshlrev_b32 v21, 16, v20
    v_and_b32 v22, 0xffff0000, v20
    v_mul_f32 v21, s45, v21
    v_mul_f32 v22, s45, v22
    v_cvt_pk_bf16_f32 v20, v21, v22
    v_lshlrev_b32 v21, 16, v20
    v_and_b32 v22, 0xffff0000, v20
    v_lshlrev_b32 v23, 16, v32
    v_and_b32 v24, 0xffff0000, v32
    v_add_f32 v21, v21, v23
    v_add_f32 v22, v22, v24
    v_cvt_pk_bf16_f32 v20, v21, v22
    v_lshlrev_b32 v21, 16, v20
    v_and_b32 v22, 0xffff0000, v20
    v_lshlrev_b32 v23, 16, v34
    v_and_b32 v24, 0xffff0000, v34
    v_add_f32 v21, v21, v23
    v_add_f32 v22, v22, v24
    v_cvt_pk_bf16_f32 v26, v21, v22
    v_cvt_pk_bf16_f32 v20, v98, v99
    v_lshlrev_b32 v21, 16, v20
    v_and_b32 v22, 0xffff0000, v20
    v_mul_f32 v21, s45, v21
    v_mul_f32 v22, s45, v22
    v_cvt_pk_bf16_f32 v20, v21, v22
    v_lshlrev_b32 v21, 16, v20
    v_and_b32 v22, 0xffff0000, v20
    v_lshlrev_b32 v23, 16, v33
    v_and_b32 v24, 0xffff0000, v33
    v_add_f32 v21, v21, v23
    v_add_f32 v22, v22, v24
    v_cvt_pk_bf16_f32 v20, v21, v22
    v_lshlrev_b32 v21, 16, v20
    v_and_b32 v22, 0xffff0000, v20
    v_lshlrev_b32 v23, 16, v35
    v_and_b32 v24, 0xffff0000, v35
    v_add_f32 v21, v21, v23
    v_add_f32 v22, v22, v24
    v_cvt_pk_bf16_f32 v27, v21, v22
    v_cmp_gt_u32 vcc, 16, v2
    s_and_saveexec_b64 s[52:53], vcc
    s_cbranch_execz ff_fin_149
    buffer_store_dwordx2 v[26:27], v9, s[36:39], s46 offen sc1
ff_fin_149:
    s_mov_b64 exec, -1
k12_end_1:
    s_endpgm
k2_prep_70:
    s_sub_u32 s40, s36, s38
    v_subrev_u32 v6, s40, v4
    v_cmp_gt_i32 s[44:45], 0, v6
    v_cmp_gt_i32 s[46:47], 1, v6
    v_cmp_gt_i32 s[48:49], 2, v6
    v_cmp_gt_i32 s[50:51], 3, v6
    v_cndmask_b32 v16, v8, v5, s[44:45]
    v_cndmask_b32 v17, v8, v5, s[46:47]
    v_cndmask_b32 v18, v8, v5, s[48:49]
    v_cndmask_b32 v19, v8, v5, s[50:51]
    v_cmp_gt_i32 s[44:45], 16, v6
    v_cmp_gt_i32 s[46:47], 17, v6
    v_cmp_gt_i32 s[48:49], 18, v6
    v_cmp_gt_i32 s[50:51], 19, v6
    v_cndmask_b32 v32, v8, v5, s[44:45]
    v_cndmask_b32 v33, v8, v5, s[46:47]
    v_cndmask_b32 v34, v8, v5, s[48:49]
    v_cndmask_b32 v35, v8, v5, s[50:51]
    s_nop 1
    s_branch k2_prepret_71
k2_prep_78:
    s_sub_u32 s40, s36, s38
    v_subrev_u32 v6, s40, v4
    v_cmp_gt_i32 s[44:45], 0, v6
    v_cmp_gt_i32 s[46:47], 1, v6
    v_cmp_gt_i32 s[48:49], 2, v6
    v_cmp_gt_i32 s[50:51], 3, v6
    v_cndmask_b32 v16, v8, v5, s[44:45]
    v_cndmask_b32 v17, v8, v5, s[46:47]
    v_cndmask_b32 v18, v8, v5, s[48:49]
    v_cndmask_b32 v19, v8, v5, s[50:51]
    v_cmp_gt_i32 s[44:45], 16, v6
    v_cmp_gt_i32 s[46:47], 17, v6
    v_cmp_gt_i32 s[48:49], 18, v6
    v_cmp_gt_i32 s[50:51], 19, v6
    v_cndmask_b32 v32, v8, v5, s[44:45]
    v_cndmask_b32 v33, v8, v5, s[46:47]
    v_cndmask_b32 v34, v8, v5, s[48:49]
    v_cndmask_b32 v35, v8, v5, s[50:51]
    s_nop 1
    s_branch k2_prepret_79
k2_prep_96:
    s_sub_u32 s40, s36, s39
    v_subrev_u32 v6, s40, v4
    v_cmp_gt_i32 s[44:45], 0, v6
    v_cmp_gt_i32 s[46:47], 1, v6
    v_cmp_gt_i32 s[48:49], 2, v6
    v_cmp_gt_i32 s[50:51], 3, v6
    v_cndmask_b32 v16, v10, v5, s[44:45]
    v_cndmask_b32 v17, v10, v5, s[46:47]
    v_cndmask_b32 v18, v10, v5, s[48:49]
    v_cndmask_b32 v19, v10, v5, s[50:51]
    v_cmp_gt_i32 s[44:45], 16, v6
    v_cmp_gt_i32 s[46:47], 17, v6
    v_cmp_gt_i32 s[48:49], 18, v6
    v_cmp_gt_i32 s[50:51], 19, v6
    v_cndmask_b32 v32, v10, v5, s[44:45]
    v_cndmask_b32 v33, v10, v5, s[46:47]
    v_cndmask_b32 v34, v10, v5, s[48:49]
    v_cndmask_b32 v35, v10, v5, s[50:51]
    v_cmp_gt_i32 s[44:45], 32, v6
    v_cmp_gt_i32 s[46:47], 33, v6
    v_cmp_gt_i32 s[48:49], 34, v6
    v_cmp_gt_i32 s[50:51], 35, v6
    v_cndmask_b32 v24, v10, v5, s[44:45]
    v_cndmask_b32 v25, v10, v5, s[46:47]
    v_cndmask_b32 v26, v10, v5, s[48:49]
    v_cndmask_b32 v27, v10, v5, s[50:51]
    v_cmp_gt_i32 s[44:45], 48, v6
    v_cmp_gt_i32 s[46:47], 49, v6
    v_cmp_gt_i32 s[48:49], 50, v6
    v_cmp_gt_i32 s[50:51], 51, v6
    v_cndmask_b32 v40, v10, v5, s[44:45]
    v_cndmask_b32 v41, v10, v5, s[46:47]
    v_cndmask_b32 v42, v10, v5, s[48:49]
    v_cndmask_b32 v43, v10, v5, s[50:51]
    s_nop 1
    s_branch k2_prepret_97
k2_prep_100:
    s_sub_u32 s40, s36, s39
    s_sub_u32 s40, s40, 64
    v_subrev_u32 v6, s40, v4
    v_cmp_gt_i32 s[44:45], 0, v6
    v_cmp_gt_i32 s[46:47], 1, v6
    v_cmp_gt_i32 s[48:49], 2, v6
    v_cmp_gt_i32 s[50:51], 3, v6
    v_cndmask_b32 v20, v11, v5, s[44:45]
    v_cndmask_b32 v21, v11, v5, s[46:47]
    v_cndmask_b32 v22, v11, v5, s[48:49]
    v_cndmask_b32 v23, v11, v5, s[50:51]
    v_cmp_gt_i32 s[44:45], 16, v6
    v_cmp_gt_i32 s[46:47], 17, v6
    v_cmp_gt_i32 s[48:49], 18, v6
    v_cmp_gt_i32 s[50:51], 19, v6
    v_cndmask_b32 v36, v11, v5, s[44:45]
    v_cndmask_b32 v37, v11, v5, s[46:47]
    v_cndmask_b32 v38, v11, v5, s[48:49]
    v_cndmask_b32 v39, v11, v5, s[50:51]
    v_cmp_gt_i32 s[44:45], 32, v6
    v_cmp_gt_i32 s[46:47], 33, v6
    v_cmp_gt_i32 s[48:49], 34, v6
    v_cmp_gt_i32 s[50:51], 35, v6
    v_cndmask_b32 v28, v11, v5, s[44:45]
    v_cndmask_b32 v29, v11, v5, s[46:47]
    v_cndmask_b32 v30, v11, v5, s[48:49]
    v_cndmask_b32 v31, v11, v5, s[50:51]
    v_cmp_gt_i32 s[44:45], 48, v6
    v_cmp_gt_i32 s[46:47], 49, v6
    v_cmp_gt_i32 s[48:49], 50, v6
    v_cmp_gt_i32 s[50:51], 51, v6
    v_cndmask_b32 v44, v11, v5, s[44:45]
    v_cndmask_b32 v45, v11, v5, s[46:47]
    v_cndmask_b32 v46, v11, v5, s[48:49]
    v_cndmask_b32 v47, v11, v5, s[50:51]
    s_nop 1
    s_branch k2_prepret_101
k12_ool_10:
    buffer_load_dword v52, v8, s[24:27], 0 offen sc1
    s_branch k12_oolret_11
k12_ool_12:
    s_mov_b64 exec, 1
    buffer_atomic_add v9, v8, s[24:27], 0 offen sc1
    s_mov_b64 exec, -1
    s_branch k12_oolret_13
k12_ool_14:
    buffer_load_dword v51, v50, s[12:15], s56 offen
    s_branch k12_oolret_15
k12_ool_18:
    v_readfirstlane_b32 s31, v52
    s_cmp_ge_u32 s31, 256
    s_cbranch_scc1 spin_ok_16
    s_mov_b32 s40, 1048576
spin_17:
    s_sleep 8
    buffer_load_dword v52, v8, s[24:27], 0 offen sc1
    s_waitcnt vmcnt(0)
    v_readfirstlane_b32 s31, v52
    s_sub_u32 s40, s40, 1
    s_cselect_b32 s31, -1, s31
    s_cmp_lt_u32 s31, 256
    s_cbranch_scc1 spin_17
spin_ok_16:
    s_branch k12_oolret_19
k12_ool_20:
    s_mov_b64 exec, 1
    buffer_atomic_add v9, v8, s[24:27], 0 offen sc1
    s_mov_b64 exec, -1
    s_branch k12_oolret_21
k12_ool_22:
    global_load_dword v51, v[2:3], off
    s_branch k12_oolret_23
k12_ool_26:
    buffer_load_dword v52, v8, s[24:27], 0 offen sc1
    s_branch k12_oolret_27
k12_ool_28:
    s_mov_b64 exec, 1
    buffer_atomic_add v9, v8, s[24:27], 0 offen sc1
    s_mov_b64 exec, -1
    s_branch k12_oolret_29
k12_ool_30:
    buffer_load_dword v51, v50, s[12:15], s56 offen
    s_branch k12_oolret_31
k12_ool_34:
    v_readfirstlane_b32 s31, v52
    s_cmp_ge_u32 s31, 256
    s_cbranch_scc1 spin_ok_32
    s_mov_b32 s40, 1048576
spin_33:
    s_sleep 8
    buffer_load_dword v52, v8, s[24:27], 0 offen sc1
    s_waitcnt vmcnt(0)
    v_readfirstlane_b32 s31, v52
    s_sub_u32 s40, s40, 1
    s_cselect_b32 s31, -1, s31
    s_cmp_lt_u32 s31, 256
    s_cbranch_scc1 spin_33
spin_ok_32:
    s_branch k12_oolret_35
k12_ool_36:
    s_mov_b64 exec, 1
    buffer_atomic_add v9, v8, s[24:27], 0 offen sc1
    s_mov_b64 exec, -1
    s_branch k12_oolret_37
k12_ool_38:
    global_load_dword v51, v[2:3], off
    s_branch k12_oolret_39
k12_ool_40:
    s_add_u32 s52, s47, 528384
    buffer_store_dwordx4 v[156:159], v1, s[48:51], s52 offen offset:3072 sc1
    s_branch k12_oolret_41
k12_ool_42:
    s_add_u32 s52, s47, 532480
    buffer_store_dwordx4 v[160:163], v1, s[48:51], s52 offen offset:0 sc1
    s_branch k12_oolret_43
k12_ool_44:
    s_add_u32 s52, s47, 532480
    buffer_store_dwordx4 v[164:167], v1, s[48:51], s52 offen offset:1024 sc1
    s_branch k12_oolret_45
k12_ool_46:
    s_add_u32 s52, s47, 532480
    buffer_store_dwordx4 v[168:171], v1, s[48:51], s52 offen offset:2048 sc1
    s_branch k12_oolret_47
k12_ool_48:
    s_add_u32 s52, s47, 532480
    buffer_store_dwordx4 v[172:175], v1, s[48:51], s52 offen offset:3072 sc1
    s_branch k12_oolret_49
k12_ool_50:
    s_add_u32 s52, s47, 536576
    buffer_store_dwordx4 v[176:179], v1, s[48:51], s52 offen offset:0 sc1
    s_branch k12_oolret_51
k12_ool_52:
    s_add_u32 s52, s47, 536576
    buffer_store_dwordx4 v[180:183], v1, s[48:51], s52 offen offset:1024 sc1
    s_branch k12_oolret_53
k12_ool_54:
    s_add_u32 s52, s47, 536576
    buffer_store_dwordx4 v[184:187], v1, s[48:51], s52 offen offset:2048 sc1
    s_branch k12_oolret_55
k12_ool_56:
    s_add_u32 s52, s47, 536576
    buffer_store_dwordx4 v[188:191], v1, s[48:51], s52 offen offset:3072 sc1
    s_branch k12_oolret_57
k12_ool_58:
    s_mov_b32 s50, 0
    s_branch k12_oolret_59
k12_ool_60:
    s_mov_b64 exec, 1
    buffer_atomic_add v9, v8, s[24:27], s54 offen sc1
    s_mov_b64 exec, -1
    s_branch k12_oolret_61
k12_ool_62:
    buffer_load_dword v52, v8, s[24:27], s55 offen sc1
    s_branch k12_oolret_63
k12_ool_66:
    s_waitcnt vmcnt(14)
    v_readfirstlane_b32 s31, v52
    s_cmp_ge_u32 s31, 2
    s_cbranch_scc1 spin_ok_64
    s_mov_b32 s40, 1048576
spin_65:
    s_sleep 8
    buffer_load_dword v52, v8, s[24:27], s55 offen sc1
    s_waitcnt vmcnt(0)
    v_readfirstlane_b32 s31, v52
    s_sub_u32 s40, s40, 1
    s_cselect_b32 s31, -1, s31
    s_cmp_lt_u32 s31, 2
    s_cbranch_scc1 spin_65
spin_ok_64:
    s_branch k12_oolret_67
k12_ool_68:
    s_mov_b64 exec, 1
    buffer_atomic_add v9, v8, s[24:27], s3 offen sc1
    s_mov_b64 exec, -1
    s_branch k12_oolret_69
k12_ool_72:
    buffer_load_dword v58, v59, s[24:27], s5 offen sc1
    s_branch k12_oolret_73
k12_ool_76:
    s_waitcnt vmcnt(0)
    v_readfirstlane_b32 s31, v58
    s_cmp_ge_u32 s31, 14
    s_cbranch_scc1 spin_ok_74
    s_mov_b32 s40, 1048576
spin_75:
    s_sleep 8
    buffer_load_dword v58, v59, s[24:27], s5 offen sc1
    s_waitcnt vmcnt(0)
    v_readfirstlane_b32 s31, v58
    s_sub_u32 s40, s40, 1
    s_cselect_b32 s31, -1, s31
    s_cmp_lt_u32 s31, 14
    s_cbranch_scc1 spin_75
spin_ok_74:
    s_branch k12_oolret_77
k12_ool_116:
    s_mov_b64 exec, 1
    buffer_atomic_add v76, v75, s[16:19], s57 offen sc1
    s_mov_b64 exec, -1
    s_branch k12_oolret_117
k12_ool_121:
    s_mov_b64 exec, 1
    buffer_atomic_add v76, v75, s[16:19], s58 offen sc1
    s_mov_b64 exec, -1
    s_branch k12_oolret_122
k12_ool_125:
    s_mov_b32 s34, 1048576
op_spin_123:
    buffer_load_dword v74, v73, s[16:19], s59 offen sc1
    s_waitcnt vmcnt(0)
    v_cmp_le_u32 vcc, 4, v74
    s_sub_u32 s34, s34, 1
    s_cbranch_scc1 op_ok_124
    s_mov_b32 s33, vcc_lo
    s_bitcmp1_b32 s33, 0
    s_cbranch_scc1 op_ok_124
    s_sleep 4
    s_branch op_spin_123
op_ok_124:
    buffer_load_dwordx4 a[128:131], v88, s[8:11], s62 offen offset:0 sc1
    buffer_load_dwordx4 a[132:135], v88, s[8:11], s62 offen offset:1024 sc1
    buffer_load_dwordx4 a[136:139], v89, s[8:11], s62 offen offset:0 sc1
    buffer_load_dwordx4 a[140:143], v89, s[8:11], s62 offen offset:1024 sc1
    s_add_u32 s62, s62, 0x40000
    s_and_b32 s62, s62, 0x7fffff
    buffer_load_dwordx4 a[144:147], v88, s[8:11], s62 offen offset:0 sc1
    buffer_load_dwordx4 a[148:151], v88, s[8:11], s62 offen offset:1024 sc1
    buffer_load_dwordx4 a[152:155], v89, s[8:11], s62 offen offset:0 sc1
    buffer_load_dwordx4 a[156:159], v89, s[8:11], s62 offen offset:1024 sc1
    s_add_u32 s62, s62, 0x40000
    s_and_b32 s62, s62, 0x7fffff
    buffer_load_dwordx4 a[160:163], v88, s[8:11], s62 offen offset:0 sc1
    buffer_load_dwordx4 a[164:167], v88, s[8:11], s62 offen offset:1024 sc1
    buffer_load_dwordx4 a[168:171], v89, s[8:11], s62 offen offset:0 sc1
    buffer_load_dwordx4 a[172:175], v89, s[8:11], s62 offen offset:1024 sc1
    s_add_u32 s62, s62, 0x40000
    s_and_b32 s62, s62, 0x7fffff
    s_branch k12_oolret_126
k12_ool_131:
    buffer_load_dwordx2 v[192:193], v78, s[20:23], 0 offen offset:0
    buffer_load_dwordx2 v[194:195], v78, s[20:23], 0 offen offset:32
    buffer_load_dwordx2 v[196:197], v78, s[20:23], 0 offen offset:64
    buffer_load_dwordx2 v[198:199], v78, s[20:23], 0 offen offset:96
    buffer_load_dwordx2 v[200:201], v79, s[20:23], 0 offen offset:0
    buffer_load_dwordx2 v[202:203], v79, s[20:23], 0 offen offset:32
    buffer_load_dwordx2 v[204:205], v79, s[20:23], 0 offen offset:64
    buffer_load_dwordx2 v[206:207], v79, s[20:23], 0 offen offset:96
    buffer_load_dwordx2 v[208:209], v80, s[44:47], 0 offen offset:0
    buffer_load_dwordx2 v[210:211], v80, s[44:47], 0 offen offset:32
    buffer_load_dwordx2 v[212:213], v80, s[44:47], 0 offen offset:64
    buffer_load_dwordx2 v[214:215], v80, s[44:47], 0 offen offset:96
    global_load_dword v84, v[82:83], off
    s_mov_b32 s10, 0
    s_mov_b32 s14, 0
    s_mov_b32 s34, 1048576
ff_spin_129:
    v_cmp_gt_u32 vcc, 4, v95
    s_cbranch_vccz ff_ok_130
    s_sub_u32 s34, s34, 1
    s_cbranch_scc1 ff_ok_130
    s_sleep 4
    buffer_load_dword v95, v94, s[16:19], 0 offen sc1
    s_waitcnt vmcnt(0)
    s_branch ff_spin_129
ff_ok_130:
    s_add_u32 s44, s6, 0x6000000
    s_addc_u32 s45, s7, 0
    s_and_b32 s45, s45, 0xffff
    s_cmp_ge_u32 s2, 224
    s_cselect_b32 s46, 0, 0x1000000
    s_branch k12_oolret_132
k12_ool_135:
    s_mov_b32 s34, 1048576
op_spin_133:
    buffer_load_dword v74, v73, s[16:19], s59 offen sc1
    s_waitcnt vmcnt(0)
    v_cmp_le_u32 vcc, 4, v74
    s_sub_u32 s34, s34, 1
    s_cbranch_scc1 op_ok_134
    s_mov_b32 s33, vcc_lo
    s_bitcmp1_b32 s33, s32
    s_cbranch_scc1 op_ok_134
    s_sleep 4
    s_branch op_spin_133
op_ok_134:
    s_branch k12_oolret_136
k12_ool_137:
    buffer_load_dword v95, v94, s[16:19], 0 offen sc1
    s_branch k12_oolret_138
k2_tramp_80:
    s_call_b64 s[40:41], k2_rare_152
    s_branch k2_ret_81
k2_tramp_84:
    s_call_b64 s[40:41], k2_rare_153
    s_branch k2_ret_85
k2_tramp_86:
    s_call_b64 s[40:41], k2_rare_152
    s_branch k2_ret_87
k2_tramp_88:
    s_call_b64 s[40:41], k2_rare_153
    s_branch k2_ret_89
k2_tramp_90:
    s_call_b64 s[40:41], k2_rare_152
    s_branch k2_ret_91
k2_tramp_92:
    s_call_b64 s[40:41], k2_rare_153
    s_branch k2_ret_93
k2_tramp_94:
    s_call_b64 s[40:41], k2_rare_158
    s_branch k2_ret_95
k2_tramp_98:
    s_call_b64 s[40:41], k2_rare_159
    s_branch k2_ret_99
k2_tramp_102:
    s_call_b64 s[40:41], k2_rare_160
    s_branch k2_ret_103
k2_tramp_106:
    s_call_b64 s[40:41], k2_rare_161
    s_branch k2_ret_107
k2_tramp_108:
    s_call_b64 s[40:41], k2_rare_160
    s_branch k2_ret_109
k2_tramp_110:
    s_call_b64 s[40:41], k2_rare_161
    s_branch k2_ret_111
k2_tramp_112:
    s_call_b64 s[40:41], k2_rare_160
    s_branch k2_ret_113
k2_tramp_114:
    s_call_b64 s[40:41], k2_rare_165
    s_branch k2_ret_115
k2_rare_152:
    s_nop 7
    v_max_f32 v52, v128, v129
    v_max3_f32 v52, v52, v130, v131
    v_max3_f32 v52, v52, v144, v145
    v_max3_f32 v52, v52, v146, v147
    v_max_f32 v53, v132, v133
    v_max3_f32 v53, v53, v134, v135
    v_max3_f32 v53, v53, v148, v149
    v_max3_f32 v53, v53, v150, v151
    v_max_f32 v54, v136, v137
    v_max3_f32 v54, v54, v138, v139
    v_max3_f32 v54, v54, v152, v153
    v_max3_f32 v54, v54, v154, v155
    v_max_f32 v55, v140, v141
    v_max3_f32 v55, v55, v142, v143
    v_max3_f32 v55, v55, v156, v157
    v_max3_f32 v55, v55, v158, v159
    v_mov_b32 v224, v52
    v_mov_b32 v225, v53
    v_mov_b32 v226, v54
    v_mov_b32 v227, v55
    s_nop 1
    v_permlane16_swap_b32 v52, v224
    v_permlane16_swap_b32 v53, v225
    v_permlane16_swap_b32 v54, v226
    v_permlane16_swap_b32 v55, v227
    s_nop 1
    v_max_f32 v52, v52, v224
    v_max_f32 v53, v53, v225
    v_max_f32 v54, v54, v226
    v_max_f32 v55, v55, v227
    v_mov_b32 v224, v52
    v_mov_b32 v225, v53
    v_mov_b32 v226, v54
    v_mov_b32 v227, v55
    s_nop 1
    v_permlane32_swap_b32 v52, v224
    v_permlane32_swap_b32 v53, v225
    v_permlane32_swap_b32 v54, v226
    v_permlane32_swap_b32 v55, v227
    s_nop 1
    v_max_f32 v52, v52, v224
    v_max_f32 v53, v53, v225
    v_max_f32 v54, v54, v226
    v_max_f32 v55, v55, v227
    v_add_f32 v52, 0x41400000, v52
    v_max_f32 v52, 0, v52
    v_add_f32 v53, 0x41400000, v53
    v_max_f32 v53, 0, v53
    v_add_f32 v54, 0x41400000, v54
    v_max_f32 v54, 0, v54
    v_add_f32 v55, 0x41400000, v55
    v_max_f32 v55, 0, v55
    v_sub_f32 v128, v128, v52
    v_sub_f32 v129, v129, v52
    v_sub_f32 v130, v130, v52
    v_sub_f32 v131, v131, v52
    v_sub_f32 v132, v132, v53
    v_sub_f32 v133, v133, v53
    v_sub_f32 v134, v134, v53
    v_sub_f32 v135, v135, v53
    v_sub_f32 v136, v136, v54
    v_sub_f32 v137, v137, v54
    v_sub_f32 v138, v138, v54
    v_sub_f32 v139, v139, v54
    v_sub_f32 v140, v140, v55
    v_sub_f32 v141, v141, v55
    v_sub_f32 v142, v142, v55
    v_sub_f32 v143, v143, v55
    v_sub_f32 v144, v144, v52
    v_sub_f32 v145, v145, v52
    v_sub_f32 v146, v146, v52
    v_sub_f32 v147, v147, v52
    v_sub_f32 v148, v148, v53
    v_sub_f32 v149, v149, v53
    v_sub_f32 v150, v150, v53
    v_sub_f32 v151, v151, v53
    v_sub_f32 v152, v152, v54
    v_sub_f32 v153, v153, v54
    v_sub_f32 v154, v154, v54
    v_sub_f32 v155, v155, v54
    v_sub_f32 v156, v156, v55
    v_sub_f32 v157, v157, v55
    v_sub_f32 v158, v158, v55
    v_sub_f32 v159, v159, v55
    v_sub_f32 v160, v160, v52
    v_sub_f32 v16, v16, v52
    v_sub_f32 v161, v161, v52
    v_sub_f32 v17, v17, v52
    v_sub_f32 v162, v162, v52
    v_sub_f32 v18, v18, v52
    v_sub_f32 v163, v163, v52
    v_sub_f32 v19, v19, v52
    v_sub_f32 v164, v164, v53
    v_sub_f32 v20, v20, v53
    v_sub_f32 v165, v165, v53
    v_sub_f32 v21, v21, v53
    v_sub_f32 v166, v166, v53
    v_sub_f32 v22, v22, v53
    v_sub_f32 v167, v167, v53
    v_sub_f32 v23, v23, v53
    v_sub_f32 v168, v168, v54
    v_sub_f32 v24, v24, v54
    v_sub_f32 v169, v169, v54
    v_sub_f32 v25, v25, v54
    v_sub_f32 v170, v170, v54
    v_sub_f32 v26, v26, v54
    v_sub_f32 v171, v171, v54
    v_sub_f32 v27, v27, v54
    v_sub_f32 v172, v172, v55
    v_sub_f32 v28, v28, v55
    v_sub_f32 v173, v173, v55
    v_sub_f32 v29, v29, v55
    v_sub_f32 v174, v174, v55
    v_sub_f32 v30, v30, v55
    v_sub_f32 v175, v175, v55
    v_sub_f32 v31, v31, v55
    v_sub_f32 v176, v176, v52
    v_sub_f32 v32, v32, v52
    v_sub_f32 v177, v177, v52
    v_sub_f32 v33, v33, v52
    v_sub_f32 v178, v178, v52
    v_sub_f32 v34, v34, v52
    v_sub_f32 v179, v179, v52
    v_sub_f32 v35, v35, v52
    v_sub_f32 v180, v180, v53
    v_sub_f32 v36, v36, v53
    v_sub_f32 v181, v181, v53
    v_sub_f32 v37, v37, v53
    v_sub_f32 v182, v182, v53
    v_sub_f32 v38, v38, v53
    v_sub_f32 v183, v183, v53
    v_sub_f32 v39, v39, v53
    v_sub_f32 v184, v184, v54
    v_sub_f32 v40, v40, v54
    v_sub_f32 v185, v185, v54
    v_sub_f32 v41, v41, v54
    v_sub_f32 v186, v186, v54
    v_sub_f32 v42, v42, v54
    v_sub_f32 v187, v187, v54
    v_sub_f32 v43, v43, v54
    v_sub_f32 v188, v188, v55
    v_sub_f32 v44, v44, v55
    v_sub_f32 v189, v189, v55
    v_sub_f32 v45, v45, v55
    v_sub_f32 v190, v190, v55
    v_sub_f32 v46, v46, v55
    v_sub_f32 v191, v191, v55
    v_sub_f32 v47, v47, v55
    v_sub_f32 v8, v8, v52
    v_exp_f32 v52, -v52
    v_sub_f32 v9, v9, v53
    v_exp_f32 v53, -v53
    v_sub_f32 v10, v10, v54
    v_exp_f32 v54, -v54
    v_sub_f32 v11, v11, v55
    v_exp_f32 v55, -v55
    s_nop 0
    v_mul_f32 v12, v12, v52
    v_mul_f32 v48, v48, v53
    v_mul_f32 v248, v248, v54
    v_mul_f32 v252, v252, v55
    v_accvgpr_read_b32 v224, a0
    v_accvgpr_read_b32 v225, a1
    v_accvgpr_read_b32 v226, a2
    v_accvgpr_read_b32 v227, a3
    v_mul_f32 v224, v224, v52
    v_mul_f32 v225, v225, v52
    v_mul_f32 v226, v226, v52
    v_mul_f32 v227, v227, v52
    v_accvgpr_write_b32 a0, v224
    v_accvgpr_write_b32 a1, v225
    v_accvgpr_write_b32 a2, v226
    v_accvgpr_write_b32 a3, v227
    v_accvgpr_read_b32 v224, a4
    v_accvgpr_read_b32 v225, a5
    v_accvgpr_read_b32 v226, a6
    v_accvgpr_read_b32 v227, a7
    v_mul_f32 v224, v224, v53
    v_mul_f32 v225, v225, v53
    v_mul_f32 v226, v226, v53
    v_mul_f32 v227, v227, v53
    v_accvgpr_write_b32 a4, v224
    v_accvgpr_write_b32 a5, v225
    v_accvgpr_write_b32 a6, v226
    v_accvgpr_write_b32 a7, v227
    v_accvgpr_read_b32 v224, a8
    v_accvgpr_read_b32 v225, a9
    v_accvgpr_read_b32 v226, a10
    v_accvgpr_read_b32 v227, a11
    v_mul_f32 v224, v224, v54
    v_mul_f32 v225, v225, v54
    v_mul_f32 v226, v226, v54
    v_mul_f32 v227, v227, v54
    v_accvgpr_write_b32 a8, v224
    v_accvgpr_write_b32 a9, v225
    v_accvgpr_write_b32 a10, v226
    v_accvgpr_write_b32 a11, v227
    v_accvgpr_read_b32 v224, a12
    v_accvgpr_read_b32 v225, a13
    v_accvgpr_read_b32 v226, a14
    v_accvgpr_read_b32 v227, a15
    v_mul_f32 v224, v224, v55
    v_mul_f32 v225, v225, v55
    v_mul_f32 v226, v226, v55
    v_mul_f32 v227, v227, v55
    v_accvgpr_write_b32 a12, v224
    v_accvgpr_write_b32 a13, v225
    v_accvgpr_write_b32 a14, v226
    v_accvgpr_write_b32 a15, v227
    v_accvgpr_read_b32 v224, a16
    v_accvgpr_read_b32 v225, a17
    v_accvgpr_read_b32 v226, a18
    v_accvgpr_read_b32 v227, a19
    v_mul_f32 v224, v224, v52
    v_mul_f32 v225, v225, v52
    v_mul_f32 v226, v226, v52
    v_mul_f32 v227, v227, v52
    v_accvgpr_write_b32 a16, v224
    v_accvgpr_write_b32 a17, v225
    v_accvgpr_write_b32 a18, v226
    v_accvgpr_write_b32 a19, v227
    v_accvgpr_read_b32 v224, a20
    v_accvgpr_read_b32 v225, a21
    v_accvgpr_read_b32 v226, a22
    v_accvgpr_read_b32 v227, a23
    v_mul_f32 v224, v224, v53
    v_mul_f32 v225, v225, v53
    v_mul_f32 v226, v226, v53
    v_mul_f32 v227, v227, v53
    v_accvgpr_write_b32 a20, v224
    v_accvgpr_write_b32 a21, v225
    v_accvgpr_write_b32 a22, v226
    v_accvgpr_write_b32 a23, v227
    v_accvgpr_read_b32 v224, a24
    v_accvgpr_read_b32 v225, a25
    v_accvgpr_read_b32 v226, a26
    v_accvgpr_read_b32 v227, a27
    v_mul_f32 v224, v224, v54
    v_mul_f32 v225, v225, v54
    v_mul_f32 v226, v226, v54
    v_mul_f32 v227, v227, v54
    v_accvgpr_write_b32 a24, v224
    v_accvgpr_write_b32 a25, v225
    v_accvgpr_write_b32 a26, v226
    v_accvgpr_write_b32 a27, v227
    v_accvgpr_read_b32 v224, a28
    v_accvgpr_read_b32 v225, a29
    v_accvgpr_read_b32 v226, a30
    v_accvgpr_read_b32 v227, a31
    v_mul_f32 v224, v224, v55
    v_mul_f32 v225, v225, v55
    v_mul_f32 v226, v226, v55
    v_mul_f32 v227, v227, v55
    v_accvgpr_write_b32 a28, v224
    v_accvgpr_write_b32 a29, v225
    v_accvgpr_write_b32 a30, v226
    v_accvgpr_write_b32 a31, v227
    v_accvgpr_read_b32 v224, a32
    v_accvgpr_read_b32 v225, a33
    v_accvgpr_read_b32 v226, a34
    v_accvgpr_read_b32 v227, a35
    v_mul_f32 v224, v224, v52
    v_mul_f32 v225, v225, v52
    v_mul_f32 v226, v226, v52
    v_mul_f32 v227, v227, v52
    v_accvgpr_write_b32 a32, v224
    v_accvgpr_write_b32 a33, v225
    v_accvgpr_write_b32 a34, v226
    v_accvgpr_write_b32 a35, v227
    v_accvgpr_read_b32 v224, a36
    v_accvgpr_read_b32 v225, a37
    v_accvgpr_read_b32 v226, a38
    v_accvgpr_read_b32 v227, a39
    v_mul_f32 v224, v224, v53
    v_mul_f32 v225, v225, v53
    v_mul_f32 v226, v226, v53
    v_mul_f32 v227, v227, v53
    v_accvgpr_write_b32 a36, v224
    v_accvgpr_write_b32 a37, v225
    v_accvgpr_write_b32 a38, v226
    v_accvgpr_write_b32 a39, v227
    v_accvgpr_read_b32 v224, a40
    v_accvgpr_read_b32 v225, a41
    v_accvgpr_read_b32 v226, a42
    v_accvgpr_read_b32 v227, a43
    v_mul_f32 v224, v224, v54
    v_mul_f32 v225, v225, v54
    v_mul_f32 v226, v226, v54
    v_mul_f32 v227, v227, v54
    v_accvgpr_write_b32 a40, v224
    v_accvgpr_write_b32 a41, v225
    v_accvgpr_write_b32 a42, v226
    v_accvgpr_write_b32 a43, v227
    v_accvgpr_read_b32 v224, a44
    v_accvgpr_read_b32 v225, a45
    v_accvgpr_read_b32 v226, a46
    v_accvgpr_read_b32 v227, a47
    v_mul_f32 v224, v224, v55
    v_mul_f32 v225, v225, v55
    v_mul_f32 v226, v226, v55
    v_mul_f32 v227, v227, v55
    v_accvgpr_write_b32 a44, v224
    v_accvgpr_write_b32 a45, v225
    v_accvgpr_write_b32 a46, v226
    v_accvgpr_write_b32 a47, v227
    v_accvgpr_read_b32 v224, a48
    v_accvgpr_read_b32 v225, a49
    v_accvgpr_read_b32 v226, a50
    v_accvgpr_read_b32 v227, a51
    v_mul_f32 v224, v224, v52
    v_mul_f32 v225, v225, v52
    v_mul_f32 v226, v226, v52
    v_mul_f32 v227, v227, v52
    v_accvgpr_write_b32 a48, v224
    v_accvgpr_write_b32 a49, v225
    v_accvgpr_write_b32 a50, v226
    v_accvgpr_write_b32 a51, v227
    v_accvgpr_read_b32 v224, a52
    v_accvgpr_read_b32 v225, a53
    v_accvgpr_read_b32 v226, a54
    v_accvgpr_read_b32 v227, a55
    v_mul_f32 v224, v224, v53
    v_mul_f32 v225, v225, v53
    v_mul_f32 v226, v226, v53
    v_mul_f32 v227, v227, v53
    v_accvgpr_write_b32 a52, v224
    v_accvgpr_write_b32 a53, v225
    v_accvgpr_write_b32 a54, v226
    v_accvgpr_write_b32 a55, v227
    v_accvgpr_read_b32 v224, a56
    v_accvgpr_read_b32 v225, a57
    v_accvgpr_read_b32 v226, a58
    v_accvgpr_read_b32 v227, a59
    v_mul_f32 v224, v224, v54
    v_mul_f32 v225, v225, v54
    v_mul_f32 v226, v226, v54
    v_mul_f32 v227, v227, v54
    v_accvgpr_write_b32 a56, v224
    v_accvgpr_write_b32 a57, v225
    v_accvgpr_write_b32 a58, v226
    v_accvgpr_write_b32 a59, v227
    v_accvgpr_read_b32 v224, a60
    v_accvgpr_read_b32 v225, a61
    v_accvgpr_read_b32 v226, a62
    v_accvgpr_read_b32 v227, a63
    v_mul_f32 v224, v224, v55
    v_mul_f32 v225, v225, v55
    v_mul_f32 v226, v226, v55
    v_mul_f32 v227, v227, v55
    v_accvgpr_write_b32 a60, v224
    v_accvgpr_write_b32 a61, v225
    v_accvgpr_write_b32 a62, v226
    v_accvgpr_write_b32 a63, v227
    v_accvgpr_read_b32 v224, a64
    v_accvgpr_read_b32 v225, a65
    v_accvgpr_read_b32 v226, a66
    v_accvgpr_read_b32 v227, a67
    v_mul_f32 v224, v224, v52
    v_mul_f32 v225, v225, v52
    v_mul_f32 v226, v226, v52
    v_mul_f32 v227, v227, v52
    v_accvgpr_write_b32 a64, v224
    v_accvgpr_write_b32 a65, v225
    v_accvgpr_write_b32 a66, v226
    v_accvgpr_write_b32 a67, v227
    v_accvgpr_read_b32 v224, a68
    v_accvgpr_read_b32 v225, a69
    v_accvgpr_read_b32 v226, a70
    v_accvgpr_read_b32 v227, a71
    v_mul_f32 v224, v224, v53
    v_mul_f32 v225, v225, v53
    v_mul_f32 v226, v226, v53
    v_mul_f32 v227, v227, v53
    v_accvgpr_write_b32 a68, v224
    v_accvgpr_write_b32 a69, v225
    v_accvgpr_write_b32 a70, v226
    v_accvgpr_write_b32 a71, v227
    v_accvgpr_read_b32 v224, a72
    v_accvgpr_read_b32 v225, a73
    v_accvgpr_read_b32 v226, a74
    v_accvgpr_read_b32 v227, a75
    v_mul_f32 v224, v224, v54
    v_mul_f32 v225, v225, v54
    v_mul_f32 v226, v226, v54
    v_mul_f32 v227, v227, v54
    v_accvgpr_write_b32 a72, v224
    v_accvgpr_write_b32 a73, v225
    v_accvgpr_write_b32 a74, v226
    v_accvgpr_write_b32 a75, v227
    v_accvgpr_read_b32 v224, a76
    v_accvgpr_read_b32 v225, a77
    v_accvgpr_read_b32 v226, a78
    v_accvgpr_read_b32 v227, a79
    v_mul_f32 v224, v224, v55
    v_mul_f32 v225, v225, v55
    v_mul_f32 v226, v226, v55
    v_mul_f32 v227, v227, v55
    v_accvgpr_write_b32 a76, v224
    v_accvgpr_write_b32 a77, v225
    v_accvgpr_write_b32 a78, v226
    v_accvgpr_write_b32 a79, v227
    v_accvgpr_read_b32 v224, a80
    v_accvgpr_read_b32 v225, a81
    v_accvgpr_read_b32 v226, a82
    v_accvgpr_read_b32 v227, a83
    v_mul_f32 v224, v224, v52
    v_mul_f32 v225, v225, v52
    v_mul_f32 v226, v226, v52
    v_mul_f32 v227, v227, v52
    v_accvgpr_write_b32 a80, v224
    v_accvgpr_write_b32 a81, v225
    v_accvgpr_write_b32 a82, v226
    v_accvgpr_write_b32 a83, v227
    v_accvgpr_read_b32 v224, a84
    v_accvgpr_read_b32 v225, a85
    v_accvgpr_read_b32 v226, a86
    v_accvgpr_read_b32 v227, a87
    v_mul_f32 v224, v224, v53
    v_mul_f32 v225, v225, v53
    v_mul_f32 v226, v226, v53
    v_mul_f32 v227, v227, v53
    v_accvgpr_write_b32 a84, v224
    v_accvgpr_write_b32 a85, v225
    v_accvgpr_write_b32 a86, v226
    v_accvgpr_write_b32 a87, v227
    v_accvgpr_read_b32 v224, a88
    v_accvgpr_read_b32 v225, a89
    v_accvgpr_read_b32 v226, a90
    v_accvgpr_read_b32 v227, a91
    v_mul_f32 v224, v224, v54
    v_mul_f32 v225, v225, v54
    v_mul_f32 v226, v226, v54
    v_mul_f32 v227, v227, v54
    v_accvgpr_write_b32 a88, v224
    v_accvgpr_write_b32 a89, v225
    v_accvgpr_write_b32 a90, v226
    v_accvgpr_write_b32 a91, v227
    v_accvgpr_read_b32 v224, a92
    v_accvgpr_read_b32 v225, a93
    v_accvgpr_read_b32 v226, a94
    v_accvgpr_read_b32 v227, a95
    v_mul_f32 v224, v224, v55
    v_mul_f32 v225, v225, v55
    v_mul_f32 v226, v226, v55
    v_mul_f32 v227, v227, v55
    v_accvgpr_write_b32 a92, v224
    v_accvgpr_write_b32 a93, v225
    v_accvgpr_write_b32 a94, v226
    v_accvgpr_write_b32 a95, v227
    v_accvgpr_read_b32 v224, a96
    v_accvgpr_read_b32 v225, a97
    v_accvgpr_read_b32 v226, a98
    v_accvgpr_read_b32 v227, a99
    v_mul_f32 v224, v224, v52
    v_mul_f32 v225, v225, v52
    v_mul_f32 v226, v226, v52
    v_mul_f32 v227, v227, v52
    v_accvgpr_write_b32 a96, v224
    v_accvgpr_write_b32 a97, v225
    v_accvgpr_write_b32 a98, v226
    v_accvgpr_write_b32 a99, v227
    v_accvgpr_read_b32 v224, a100
    v_accvgpr_read_b32 v225, a101
    v_accvgpr_read_b32 v226, a102
    v_accvgpr_read_b32 v227, a103
    v_mul_f32 v224, v224, v53
    v_mul_f32 v225, v225, v53
    v_mul_f32 v226, v226, v53
    v_mul_f32 v227, v227, v53
    v_accvgpr_write_b32 a100, v224
    v_accvgpr_write_b32 a101, v225
    v_accvgpr_write_b32 a102, v226
    v_accvgpr_write_b32 a103, v227
    v_accvgpr_read_b32 v224, a104
    v_accvgpr_read_b32 v225, a105
    v_accvgpr_read_b32 v226, a106
    v_accvgpr_read_b32 v227, a107
    v_mul_f32 v224, v224, v54
    v_mul_f32 v225, v225, v54
    v_mul_f32 v226, v226, v54
    v_mul_f32 v227, v227, v54
    v_accvgpr_write_b32 a104, v224
    v_accvgpr_write_b32 a105, v225
    v_accvgpr_write_b32 a106, v226
    v_accvgpr_write_b32 a107, v227
    v_accvgpr_read_b32 v224, a108
    v_accvgpr_read_b32 v225, a109
    v_accvgpr_read_b32 v226, a110
    v_accvgpr_read_b32 v227, a111
    v_mul_f32 v224, v224, v55
    v_mul_f32 v225, v225, v55
    v_mul_f32 v226, v226, v55
    v_mul_f32 v227, v227, v55
    v_accvgpr_write_b32 a108, v224
    v_accvgpr_write_b32 a109, v225
    v_accvgpr_write_b32 a110, v226
    v_accvgpr_write_b32 a111, v227
    v_accvgpr_read_b32 v224, a112
    v_accvgpr_read_b32 v225, a113
    v_accvgpr_read_b32 v226, a114
    v_accvgpr_read_b32 v227, a115
    v_mul_f32 v224, v224, v52
    v_mul_f32 v225, v225, v52
    v_mul_f32 v226, v226, v52
    v_mul_f32 v227, v227, v52
    v_accvgpr_write_b32 a112, v224
    v_accvgpr_write_b32 a113, v225
    v_accvgpr_write_b32 a114, v226
    v_accvgpr_write_b32 a115, v227
    v_accvgpr_read_b32 v224, a116
    v_accvgpr_read_b32 v225, a117
    v_accvgpr_read_b32 v226, a118
    v_accvgpr_read_b32 v227, a119
    v_mul_f32 v224, v224, v53
    v_mul_f32 v225, v225, v53
    v_mul_f32 v226, v226, v53
    v_mul_f32 v227, v227, v53
    v_accvgpr_write_b32 a116, v224
    v_accvgpr_write_b32 a117, v225
    v_accvgpr_write_b32 a118, v226
    v_accvgpr_write_b32 a119, v227
    v_accvgpr_read_b32 v224, a120
    v_accvgpr_read_b32 v225, a121
    v_accvgpr_read_b32 v226, a122
    v_accvgpr_read_b32 v227, a123
    v_mul_f32 v224, v224, v54
    v_mul_f32 v225, v225, v54
    v_mul_f32 v226, v226, v54
    v_mul_f32 v227, v227, v54
    v_accvgpr_write_b32 a120, v224
    v_accvgpr_write_b32 a121, v225
    v_accvgpr_write_b32 a122, v226
    v_accvgpr_write_b32 a123, v227
    v_accvgpr_read_b32 v224, a124
    v_accvgpr_read_b32 v225, a125
    v_accvgpr_read_b32 v226, a126
    v_accvgpr_read_b32 v227, a127
    v_mul_f32 v224, v224, v55
    v_mul_f32 v225, v225, v55
    v_mul_f32 v226, v226, v55
    v_mul_f32 v227, v227, v55
    v_accvgpr_write_b32 a124, v224
    v_accvgpr_write_b32 a125, v225
    v_accvgpr_write_b32 a126, v226
    v_accvgpr_write_b32 a127, v227
    v_exp_f32 v232, v128
    v_exp_f32 v233, v129
    v_exp_f32 v234, v130
    v_exp_f32 v235, v131
    s_nop 0
    v_cvt_pk_bf16_f32 v192, v232, v233
    v_cvt_pk_bf16_f32 v193, v234, v235
    v_exp_f32 v232, v144
    v_exp_f32 v233, v145
    v_exp_f32 v234, v146
    v_exp_f32 v235, v147
    s_nop 0
    v_cvt_pk_bf16_f32 v194, v232, v233
    v_cvt_pk_bf16_f32 v195, v234, v235
    v_exp_f32 v232, v132
    v_exp_f32 v233, v133
    v_exp_f32 v234, v134
    v_exp_f32 v235, v135
    s_nop 0
    v_cvt_pk_bf16_f32 v196, v232, v233
    v_cvt_pk_bf16_f32 v197, v234, v235
    v_exp_f32 v232, v148
    v_exp_f32 v233, v149
    v_exp_f32 v234, v150
    v_exp_f32 v235, v151
    s_nop 0
    v_cvt_pk_bf16_f32 v198, v232, v233
    v_cvt_pk_bf16_f32 v199, v234, v235
    v_exp_f32 v232, v136
    v_exp_f32 v233, v137
    v_exp_f32 v234, v138
    v_exp_f32 v235, v139
    s_nop 0
    v_cvt_pk_bf16_f32 v200, v232, v233
    v_cvt_pk_bf16_f32 v201, v234, v235
    v_exp_f32 v232, v152
    v_exp_f32 v233, v153
    v_exp_f32 v234, v154
    v_exp_f32 v235, v155
    s_nop 0
    v_cvt_pk_bf16_f32 v202, v232, v233
    v_cvt_pk_bf16_f32 v203, v234, v235
    v_exp_f32 v232, v140
    v_exp_f32 v233, v141
    v_exp_f32 v234, v142
    v_exp_f32 v235, v143
    s_nop 0
    v_cvt_pk_bf16_f32 v204, v232, v233
    v_cvt_pk_bf16_f32 v205, v234, v235
    v_exp_f32 v232, v156
    v_exp_f32 v233, v157
    v_exp_f32 v234, v158
    v_exp_f32 v235, v159
    s_nop 0
    v_cvt_pk_bf16_f32 v206, v232, v233
    v_cvt_pk_bf16_f32 v207, v234, v235
    s_nop 3
    s_setpc_b64 s[40:41]
k2_rare_153:
    s_nop 7
    v_max_f32 v52, v160, v161
    v_max3_f32 v52, v52, v162, v163
    v_max3_f32 v52, v52, v176, v177
    v_max3_f32 v52, v52, v178, v179
    v_max_f32 v53, v164, v165
    v_max3_f32 v53, v53, v166, v167
    v_max3_f32 v53, v53, v180, v181
    v_max3_f32 v53, v53, v182, v183
    v_max_f32 v54, v168, v169
    v_max3_f32 v54, v54, v170, v171
    v_max3_f32 v54, v54, v184, v185
    v_max3_f32 v54, v54, v186, v187
    v_max_f32 v55, v172, v173
    v_max3_f32 v55, v55, v174, v175
    v_max3_f32 v55, v55, v188, v189
    v_max3_f32 v55, v55, v190, v191
    v_mov_b32 v224, v52
    v_mov_b32 v225, v53
    v_mov_b32 v226, v54
    v_mov_b32 v227, v55
    s_nop 1
    v_permlane16_swap_b32 v52, v224
    v_permlane16_swap_b32 v53, v225
    v_permlane16_swap_b32 v54, v226
    v_permlane16_swap_b32 v55, v227
    s_nop 1
    v_max_f32 v52, v52, v224
    v_max_f32 v53, v53, v225
    v_max_f32 v54, v54, v226
    v_max_f32 v55, v55, v227
    v_mov_b32 v224, v52
    v_mov_b32 v225, v53
    v_mov_b32 v226, v54
    v_mov_b32 v227, v55
    s_nop 1
    v_permlane32_swap_b32 v52, v224
    v_permlane32_swap_b32 v53, v225
    v_permlane32_swap_b32 v54, v226
    v_permlane32_swap_b32 v55, v227
    s_nop 1
    v_max_f32 v52, v52, v224
    v_max_f32 v53, v53, v225
    v_max_f32 v54, v54, v226
    v_max_f32 v55, v55, v227
    v_add_f32 v52, 0x41400000, v52
    v_max_f32 v52, 0, v52
    v_add_f32 v53, 0x41400000, v53
    v_max_f32 v53, 0, v53
    v_add_f32 v54, 0x41400000, v54
    v_max_f32 v54, 0, v54
    v_add_f32 v55, 0x41400000, v55
    v_max_f32 v55, 0, v55
    v_sub_f32 v160, v160, v52
    v_sub_f32 v161, v161, v52
    v_sub_f32 v162, v162, v52
    v_sub_f32 v163, v163, v52
    v_sub_f32 v164, v164, v53
    v_sub_f32 v165, v165, v53
    v_sub_f32 v166, v166, v53
    v_sub_f32 v167, v167, v53
    v_sub_f32 v168, v168, v54
    v_sub_f32 v169, v169, v54
    v_sub_f32 v170, v170, v54
    v_sub_f32 v171, v171, v54
    v_sub_f32 v172, v172, v55
    v_sub_f32 v173, v173, v55
    v_sub_f32 v174, v174, v55
    v_sub_f32 v175, v175, v55
    v_sub_f32 v176, v176, v52
    v_sub_f32 v177, v177, v52
    v_sub_f32 v178, v178, v52
    v_sub_f32 v179, v179, v52
    v_sub_f32 v180, v180, v53
    v_sub_f32 v181, v181, v53
    v_sub_f32 v182, v182, v53
    v_sub_f32 v183, v183, v53
    v_sub_f32 v184, v184, v54
    v_sub_f32 v185, v185, v54
    v_sub_f32 v186, v186, v54
    v_sub_f32 v187, v187, v54
    v_sub_f32 v188, v188, v55
    v_sub_f32 v189, v189, v55
    v_sub_f32 v190, v190, v55
    v_sub_f32 v191, v191, v55
    v_sub_f32 v128, v128, v52
    v_sub_f32 v16, v16, v52
    v_sub_f32 v129, v129, v52
    v_sub_f32 v17, v17, v52
    v_sub_f32 v130, v130, v52
    v_sub_f32 v18, v18, v52
    v_sub_f32 v131, v131, v52
    v_sub_f32 v19, v19, v52
    v_sub_f32 v132, v132, v53
    v_sub_f32 v20, v20, v53
    v_sub_f32 v133, v133, v53
    v_sub_f32 v21, v21, v53
    v_sub_f32 v134, v134, v53
    v_sub_f32 v22, v22, v53
    v_sub_f32 v135, v135, v53
    v_sub_f32 v23, v23, v53
    v_sub_f32 v136, v136, v54
    v_sub_f32 v24, v24, v54
    v_sub_f32 v137, v137, v54
    v_sub_f32 v25, v25, v54
    v_sub_f32 v138, v138, v54
    v_sub_f32 v26, v26, v54
    v_sub_f32 v139, v139, v54
    v_sub_f32 v27, v27, v54
    v_sub_f32 v140, v140, v55
    v_sub_f32 v28, v28, v55
    v_sub_f32 v141, v141, v55
    v_sub_f32 v29, v29, v55
    v_sub_f32 v142, v142, v55
    v_sub_f32 v30, v30, v55
    v_sub_f32 v143, v143, v55
    v_sub_f32 v31, v31, v55
    v_sub_f32 v144, v144, v52
    v_sub_f32 v32, v32, v52
    v_sub_f32 v145, v145, v52
    v_sub_f32 v33, v33, v52
    v_sub_f32 v146, v146, v52
    v_sub_f32 v34, v34, v52
    v_sub_f32 v147, v147, v52
    v_sub_f32 v35, v35, v52
    v_sub_f32 v148, v148, v53
    v_sub_f32 v36, v36, v53
    v_sub_f32 v149, v149, v53
    v_sub_f32 v37, v37, v53
    v_sub_f32 v150, v150, v53
    v_sub_f32 v38, v38, v53
    v_sub_f32 v151, v151, v53
    v_sub_f32 v39, v39, v53
    v_sub_f32 v152, v152, v54
    v_sub_f32 v40, v40, v54
    v_sub_f32 v153, v153, v54
    v_sub_f32 v41, v41, v54
    v_sub_f32 v154, v154, v54
    v_sub_f32 v42, v42, v54
    v_sub_f32 v155, v155, v54
    v_sub_f32 v43, v43, v54
    v_sub_f32 v156, v156, v55
    v_sub_f32 v44, v44, v55
    v_sub_f32 v157, v157, v55
    v_sub_f32 v45, v45, v55
    v_sub_f32 v158, v158, v55
    v_sub_f32 v46, v46, v55
    v_sub_f32 v159, v159, v55
    v_sub_f32 v47, v47, v55
    v_sub_f32 v8, v8, v52
    v_exp_f32 v52, -v52
    v_sub_f32 v9, v9, v53
    v_exp_f32 v53, -v53
    v_sub_f32 v10, v10, v54
    v_exp_f32 v54, -v54
    v_sub_f32 v11, v11, v55
    v_exp_f32 v55, -v55
    s_nop 0
    v_mul_f32 v12, v12, v52
    v_mul_f32 v48, v48, v53
    v_mul_f32 v248, v248, v54
    v_mul_f32 v252, v252, v55
    v_accvgpr_read_b32 v224, a0
    v_accvgpr_read_b32 v225, a1
    v_accvgpr_read_b32 v226, a2
    v_accvgpr_read_b32 v227, a3
    v_mul_f32 v224, v224, v52
    v_mul_f32 v225, v225, v52
    v_mul_f32 v226, v226, v52
    v_mul_f32 v227, v227, v52
    v_accvgpr_write_b32 a0, v224
    v_accvgpr_write_b32 a1, v225
    v_accvgpr_write_b32 a2, v226
    v_accvgpr_write_b32 a3, v227
    v_accvgpr_read_b32 v224, a4
    v_accvgpr_read_b32 v225, a5
    v_accvgpr_read_b32 v226, a6
    v_accvgpr_read_b32 v227, a7
    v_mul_f32 v224, v224, v53
    v_mul_f32 v225, v225, v53
    v_mul_f32 v226, v226, v53
    v_mul_f32 v227, v227, v53
    v_accvgpr_write_b32 a4, v224
    v_accvgpr_write_b32 a5, v225
    v_accvgpr_write_b32 a6, v226
    v_accvgpr_write_b32 a7, v227
    v_accvgpr_read_b32 v224, a8
    v_accvgpr_read_b32 v225, a9
    v_accvgpr_read_b32 v226, a10
    v_accvgpr_read_b32 v227, a11
    v_mul_f32 v224, v224, v54
    v_mul_f32 v225, v225, v54
    v_mul_f32 v226, v226, v54
    v_mul_f32 v227, v227, v54
    v_accvgpr_write_b32 a8, v224
    v_accvgpr_write_b32 a9, v225
    v_accvgpr_write_b32 a10, v226
    v_accvgpr_write_b32 a11, v227
    v_accvgpr_read_b32 v224, a12
    v_accvgpr_read_b32 v225, a13
    v_accvgpr_read_b32 v226, a14
    v_accvgpr_read_b32 v227, a15
    v_mul_f32 v224, v224, v55
    v_mul_f32 v225, v225, v55
    v_mul_f32 v226, v226, v55
    v_mul_f32 v227, v227, v55
    v_accvgpr_write_b32 a12, v224
    v_accvgpr_write_b32 a13, v225
    v_accvgpr_write_b32 a14, v226
    v_accvgpr_write_b32 a15, v227
    v_accvgpr_read_b32 v224, a16
    v_accvgpr_read_b32 v225, a17
    v_accvgpr_read_b32 v226, a18
    v_accvgpr_read_b32 v227, a19
    v_mul_f32 v224, v224, v52
    v_mul_f32 v225, v225, v52
    v_mul_f32 v226, v226, v52
    v_mul_f32 v227, v227, v52
    v_accvgpr_write_b32 a16, v224
    v_accvgpr_write_b32 a17, v225
    v_accvgpr_write_b32 a18, v226
    v_accvgpr_write_b32 a19, v227
    v_accvgpr_read_b32 v224, a20
    v_accvgpr_read_b32 v225, a21
    v_accvgpr_read_b32 v226, a22
    v_accvgpr_read_b32 v227, a23
    v_mul_f32 v224, v224, v53
    v_mul_f32 v225, v225, v53
    v_mul_f32 v226, v226, v53
    v_mul_f32 v227, v227, v53
    v_accvgpr_write_b32 a20, v224
    v_accvgpr_write_b32 a21, v225
    v_accvgpr_write_b32 a22, v226
    v_accvgpr_write_b32 a23, v227
    v_accvgpr_read_b32 v224, a24
    v_accvgpr_read_b32 v225, a25
    v_accvgpr_read_b32 v226, a26
    v_accvgpr_read_b32 v227, a27
    v_mul_f32 v224, v224, v54
    v_mul_f32 v225, v225, v54
    v_mul_f32 v226, v226, v54
    v_mul_f32 v227, v227, v54
    v_accvgpr_write_b32 a24, v224
    v_accvgpr_write_b32 a25, v225
    v_accvgpr_write_b32 a26, v226
    v_accvgpr_write_b32 a27, v227
    v_accvgpr_read_b32 v224, a28
    v_accvgpr_read_b32 v225, a29
    v_accvgpr_read_b32 v226, a30
    v_accvgpr_read_b32 v227, a31
    v_mul_f32 v224, v224, v55
    v_mul_f32 v225, v225, v55
    v_mul_f32 v226, v226, v55
    v_mul_f32 v227, v227, v55
    v_accvgpr_write_b32 a28, v224
    v_accvgpr_write_b32 a29, v225
    v_accvgpr_write_b32 a30, v226
    v_accvgpr_write_b32 a31, v227
    v_accvgpr_read_b32 v224, a32
    v_accvgpr_read_b32 v225, a33
    v_accvgpr_read_b32 v226, a34
    v_accvgpr_read_b32 v227, a35
    v_mul_f32 v224, v224, v52
    v_mul_f32 v225, v225, v52
    v_mul_f32 v226, v226, v52
    v_mul_f32 v227, v227, v52
    v_accvgpr_write_b32 a32, v224
    v_accvgpr_write_b32 a33, v225
    v_accvgpr_write_b32 a34, v226
    v_accvgpr_write_b32 a35, v227
    v_accvgpr_read_b32 v224, a36
    v_accvgpr_read_b32 v225, a37
    v_accvgpr_read_b32 v226, a38
    v_accvgpr_read_b32 v227, a39
    v_mul_f32 v224, v224, v53
    v_mul_f32 v225, v225, v53
    v_mul_f32 v226, v226, v53
    v_mul_f32 v227, v227, v53
    v_accvgpr_write_b32 a36, v224
    v_accvgpr_write_b32 a37, v225
    v_accvgpr_write_b32 a38, v226
    v_accvgpr_write_b32 a39, v227
    v_accvgpr_read_b32 v224, a40
    v_accvgpr_read_b32 v225, a41
    v_accvgpr_read_b32 v226, a42
    v_accvgpr_read_b32 v227, a43
    v_mul_f32 v224, v224, v54
    v_mul_f32 v225, v225, v54
    v_mul_f32 v226, v226, v54
    v_mul_f32 v227, v227, v54
    v_accvgpr_write_b32 a40, v224
    v_accvgpr_write_b32 a41, v225
    v_accvgpr_write_b32 a42, v226
    v_accvgpr_write_b32 a43, v227
    v_accvgpr_read_b32 v224, a44
    v_accvgpr_read_b32 v225, a45
    v_accvgpr_read_b32 v226, a46
    v_accvgpr_read_b32 v227, a47
    v_mul_f32 v224, v224, v55
    v_mul_f32 v225, v225, v55
    v_mul_f32 v226, v226, v55
    v_mul_f32 v227, v227, v55
    v_accvgpr_write_b32 a44, v224
    v_accvgpr_write_b32 a45, v225
    v_accvgpr_write_b32 a46, v226
    v_accvgpr_write_b32 a47, v227
    v_accvgpr_read_b32 v224, a48
    v_accvgpr_read_b32 v225, a49
    v_accvgpr_read_b32 v226, a50
    v_accvgpr_read_b32 v227, a51
    v_mul_f32 v224, v224, v52
    v_mul_f32 v225, v225, v52
    v_mul_f32 v226, v226, v52
    v_mul_f32 v227, v227, v52
    v_accvgpr_write_b32 a48, v224
    v_accvgpr_write_b32 a49, v225
    v_accvgpr_write_b32 a50, v226
    v_accvgpr_write_b32 a51, v227
    v_accvgpr_read_b32 v224, a52
    v_accvgpr_read_b32 v225, a53
    v_accvgpr_read_b32 v226, a54
    v_accvgpr_read_b32 v227, a55
    v_mul_f32 v224, v224, v53
    v_mul_f32 v225, v225, v53
    v_mul_f32 v226, v226, v53
    v_mul_f32 v227, v227, v53
    v_accvgpr_write_b32 a52, v224
    v_accvgpr_write_b32 a53, v225
    v_accvgpr_write_b32 a54, v226
    v_accvgpr_write_b32 a55, v227
    v_accvgpr_read_b32 v224, a56
    v_accvgpr_read_b32 v225, a57
    v_accvgpr_read_b32 v226, a58
    v_accvgpr_read_b32 v227, a59
    v_mul_f32 v224, v224, v54
    v_mul_f32 v225, v225, v54
    v_mul_f32 v226, v226, v54
    v_mul_f32 v227, v227, v54
    v_accvgpr_write_b32 a56, v224
    v_accvgpr_write_b32 a57, v225
    v_accvgpr_write_b32 a58, v226
    v_accvgpr_write_b32 a59, v227
    v_accvgpr_read_b32 v224, a60
    v_accvgpr_read_b32 v225, a61
    v_accvgpr_read_b32 v226, a62
    v_accvgpr_read_b32 v227, a63
    v_mul_f32 v224, v224, v55
    v_mul_f32 v225, v225, v55
    v_mul_f32 v226, v226, v55
    v_mul_f32 v227, v227, v55
    v_accvgpr_write_b32 a60, v224
    v_accvgpr_write_b32 a61, v225
    v_accvgpr_write_b32 a62, v226
    v_accvgpr_write_b32 a63, v227
    v_accvgpr_read_b32 v224, a64
    v_accvgpr_read_b32 v225, a65
    v_accvgpr_read_b32 v226, a66
    v_accvgpr_read_b32 v227, a67
    v_mul_f32 v224, v224, v52
    v_mul_f32 v225, v225, v52
    v_mul_f32 v226, v226, v52
    v_mul_f32 v227, v227, v52
    v_accvgpr_write_b32 a64, v224
    v_accvgpr_write_b32 a65, v225
    v_accvgpr_write_b32 a66, v226
    v_accvgpr_write_b32 a67, v227
    v_accvgpr_read_b32 v224, a68
    v_accvgpr_read_b32 v225, a69
    v_accvgpr_read_b32 v226, a70
    v_accvgpr_read_b32 v227, a71
    v_mul_f32 v224, v224, v53
    v_mul_f32 v225, v225, v53
    v_mul_f32 v226, v226, v53
    v_mul_f32 v227, v227, v53
    v_accvgpr_write_b32 a68, v224
    v_accvgpr_write_b32 a69, v225
    v_accvgpr_write_b32 a70, v226
    v_accvgpr_write_b32 a71, v227
    v_accvgpr_read_b32 v224, a72
    v_accvgpr_read_b32 v225, a73
    v_accvgpr_read_b32 v226, a74
    v_accvgpr_read_b32 v227, a75
    v_mul_f32 v224, v224, v54
    v_mul_f32 v225, v225, v54
    v_mul_f32 v226, v226, v54
    v_mul_f32 v227, v227, v54
    v_accvgpr_write_b32 a72, v224
    v_accvgpr_write_b32 a73, v225
    v_accvgpr_write_b32 a74, v226
    v_accvgpr_write_b32 a75, v227
    v_accvgpr_read_b32 v224, a76
    v_accvgpr_read_b32 v225, a77
    v_accvgpr_read_b32 v226, a78
    v_accvgpr_read_b32 v227, a79
    v_mul_f32 v224, v224, v55
    v_mul_f32 v225, v225, v55
    v_mul_f32 v226, v226, v55
    v_mul_f32 v227, v227, v55
    v_accvgpr_write_b32 a76, v224
    v_accvgpr_write_b32 a77, v225
    v_accvgpr_write_b32 a78, v226
    v_accvgpr_write_b32 a79, v227
    v_accvgpr_read_b32 v224, a80
    v_accvgpr_read_b32 v225, a81
    v_accvgpr_read_b32 v226, a82
    v_accvgpr_read_b32 v227, a83
    v_mul_f32 v224, v224, v52
    v_mul_f32 v225, v225, v52
    v_mul_f32 v226, v226, v52
    v_mul_f32 v227, v227, v52
    v_accvgpr_write_b32 a80, v224
    v_accvgpr_write_b32 a81, v225
    v_accvgpr_write_b32 a82, v226
    v_accvgpr_write_b32 a83, v227
    v_accvgpr_read_b32 v224, a84
    v_accvgpr_read_b32 v225, a85
    v_accvgpr_read_b32 v226, a86
    v_accvgpr_read_b32 v227, a87
    v_mul_f32 v224, v224, v53
    v_mul_f32 v225, v225, v53
    v_mul_f32 v226, v226, v53
    v_mul_f32 v227, v227, v53
    v_accvgpr_write_b32 a84, v224
    v_accvgpr_write_b32 a85, v225
    v_accvgpr_write_b32 a86, v226
    v_accvgpr_write_b32 a87, v227
    v_accvgpr_read_b32 v224, a88
    v_accvgpr_read_b32 v225, a89
    v_accvgpr_read_b32 v226, a90
    v_accvgpr_read_b32 v227, a91
    v_mul_f32 v224, v224, v54
    v_mul_f32 v225, v225, v54
    v_mul_f32 v226, v226, v54
    v_mul_f32 v227, v227, v54
    v_accvgpr_write_b32 a88, v224
    v_accvgpr_write_b32 a89, v225
    v_accvgpr_write_b32 a90, v226
    v_accvgpr_write_b32 a91, v227
    v_accvgpr_read_b32 v224, a92
    v_accvgpr_read_b32 v225, a93
    v_accvgpr_read_b32 v226, a94
    v_accvgpr_read_b32 v227, a95
    v_mul_f32 v224, v224, v55
    v_mul_f32 v225, v225, v55
    v_mul_f32 v226, v226, v55
    v_mul_f32 v227, v227, v55
    v_accvgpr_write_b32 a92, v224
    v_accvgpr_write_b32 a93, v225
    v_accvgpr_write_b32 a94, v226
    v_accvgpr_write_b32 a95, v227
    v_accvgpr_read_b32 v224, a96
    v_accvgpr_read_b32 v225, a97
    v_accvgpr_read_b32 v226, a98
    v_accvgpr_read_b32 v227, a99
    v_mul_f32 v224, v224, v52
    v_mul_f32 v225, v225, v52
    v_mul_f32 v226, v226, v52
    v_mul_f32 v227, v227, v52
    v_accvgpr_write_b32 a96, v224
    v_accvgpr_write_b32 a97, v225
    v_accvgpr_write_b32 a98, v226
    v_accvgpr_write_b32 a99, v227
    v_accvgpr_read_b32 v224, a100
    v_accvgpr_read_b32 v225, a101
    v_accvgpr_read_b32 v226, a102
    v_accvgpr_read_b32 v227, a103
    v_mul_f32 v224, v224, v53
    v_mul_f32 v225, v225, v53
    v_mul_f32 v226, v226, v53
    v_mul_f32 v227, v227, v53
    v_accvgpr_write_b32 a100, v224
    v_accvgpr_write_b32 a101, v225
    v_accvgpr_write_b32 a102, v226
    v_accvgpr_write_b32 a103, v227
    v_accvgpr_read_b32 v224, a104
    v_accvgpr_read_b32 v225, a105
    v_accvgpr_read_b32 v226, a106
    v_accvgpr_read_b32 v227, a107
    v_mul_f32 v224, v224, v54
    v_mul_f32 v225, v225, v54
    v_mul_f32 v226, v226, v54
    v_mul_f32 v227, v227, v54
    v_accvgpr_write_b32 a104, v224
    v_accvgpr_write_b32 a105, v225
    v_accvgpr_write_b32 a106, v226
    v_accvgpr_write_b32 a107, v227
    v_accvgpr_read_b32 v224, a108
    v_accvgpr_read_b32 v225, a109
    v_accvgpr_read_b32 v226, a110
    v_accvgpr_read_b32 v227, a111
    v_mul_f32 v224, v224, v55
    v_mul_f32 v225, v225, v55
    v_mul_f32 v226, v226, v55
    v_mul_f32 v227, v227, v55
    v_accvgpr_write_b32 a108, v224
    v_accvgpr_write_b32 a109, v225
    v_accvgpr_write_b32 a110, v226
    v_accvgpr_write_b32 a111, v227
    v_accvgpr_read_b32 v224, a112
    v_accvgpr_read_b32 v225, a113
    v_accvgpr_read_b32 v226, a114
    v_accvgpr_read_b32 v227, a115
    v_mul_f32 v224, v224, v52
    v_mul_f32 v225, v225, v52
    v_mul_f32 v226, v226, v52
    v_mul_f32 v227, v227, v52
    v_accvgpr_write_b32 a112, v224
    v_accvgpr_write_b32 a113, v225
    v_accvgpr_write_b32 a114, v226
    v_accvgpr_write_b32 a115, v227
    v_accvgpr_read_b32 v224, a116
    v_accvgpr_read_b32 v225, a117
    v_accvgpr_read_b32 v226, a118
    v_accvgpr_read_b32 v227, a119
    v_mul_f32 v224, v224, v53
    v_mul_f32 v225, v225, v53
    v_mul_f32 v226, v226, v53
    v_mul_f32 v227, v227, v53
    v_accvgpr_write_b32 a116, v224
    v_accvgpr_write_b32 a117, v225
    v_accvgpr_write_b32 a118, v226
    v_accvgpr_write_b32 a119, v227
    v_accvgpr_read_b32 v224, a120
    v_accvgpr_read_b32 v225, a121
    v_accvgpr_read_b32 v226, a122
    v_accvgpr_read_b32 v227, a123
    v_mul_f32 v224, v224, v54
    v_mul_f32 v225, v225, v54
    v_mul_f32 v226, v226, v54
    v_mul_f32 v227, v227, v54
    v_accvgpr_write_b32 a120, v224
    v_accvgpr_write_b32 a121, v225
    v_accvgpr_write_b32 a122, v226
    v_accvgpr_write_b32 a123, v227
    v_accvgpr_read_b32 v224, a124
    v_accvgpr_read_b32 v225, a125
    v_accvgpr_read_b32 v226, a126
    v_accvgpr_read_b32 v227, a127
    v_mul_f32 v224, v224, v55
    v_mul_f32 v225, v225, v55
    v_mul_f32 v226, v226, v55
    v_mul_f32 v227, v227, v55
    v_accvgpr_write_b32 a124, v224
    v_accvgpr_write_b32 a125, v225
    v_accvgpr_write_b32 a126, v226
    v_accvgpr_write_b32 a127, v227
    v_exp_f32 v232, v160
    v_exp_f32 v233, v161
    v_exp_f32 v234, v162
    v_exp_f32 v235, v163
    s_nop 0
    v_cvt_pk_bf16_f32 v208, v232, v233
    v_cvt_pk_bf16_f32 v209, v234, v235
    v_exp_f32 v232, v176
    v_exp_f32 v233, v177
    v_exp_f32 v234, v178
    v_exp_f32 v235, v179
    s_nop 0
    v_cvt_pk_bf16_f32 v210, v232, v233
    v_cvt_pk_bf16_f32 v211, v234, v235
    v_exp_f32 v232, v164
    v_exp_f32 v233, v165
    v_exp_f32 v234, v166
    v_exp_f32 v235, v167
    s_nop 0
    v_cvt_pk_bf16_f32 v212, v232, v233
    v_cvt_pk_bf16_f32 v213, v234, v235
    v_exp_f32 v232, v180
    v_exp_f32 v233, v181
    v_exp_f32 v234, v182
    v_exp_f32 v235, v183
    s_nop 0
    v_cvt_pk_bf16_f32 v214, v232, v233
    v_cvt_pk_bf16_f32 v215, v234, v235
    v_exp_f32 v232, v168
    v_exp_f32 v233, v169
    v_exp_f32 v234, v170
    v_exp_f32 v235, v171
    s_nop 0
    v_cvt_pk_bf16_f32 v216, v232, v233
    v_cvt_pk_bf16_f32 v217, v234, v235
    v_exp_f32 v232, v184
    v_exp_f32 v233, v185
    v_exp_f32 v234, v186
    v_exp_f32 v235, v187
    s_nop 0
    v_cvt_pk_bf16_f32 v218, v232, v233
    v_cvt_pk_bf16_f32 v219, v234, v235
    v_exp_f32 v232, v172
    v_exp_f32 v233, v173
    v_exp_f32 v234, v174
    v_exp_f32 v235, v175
    s_nop 0
    v_cvt_pk_bf16_f32 v220, v232, v233
    v_cvt_pk_bf16_f32 v221, v234, v235
    v_exp_f32 v232, v188
    v_exp_f32 v233, v189
    v_exp_f32 v234, v190
    v_exp_f32 v235, v191
    s_nop 0
    v_cvt_pk_bf16_f32 v222, v232, v233
    v_cvt_pk_bf16_f32 v223, v234, v235
    s_nop 3
    s_setpc_b64 s[40:41]
k2_rare_158:
    s_nop 7
    v_max_f32 v53, v132, v133
    v_max3_f32 v53, v53, v134, v135
    v_max3_f32 v53, v53, v148, v149
    v_max3_f32 v53, v53, v150, v151
    v_max_f32 v54, v136, v137
    v_max3_f32 v54, v54, v138, v139
    v_max3_f32 v54, v54, v152, v153
    v_max3_f32 v54, v54, v154, v155
    v_max_f32 v55, v140, v141
    v_max3_f32 v55, v55, v142, v143
    v_max3_f32 v55, v55, v156, v157
    v_max3_f32 v55, v55, v158, v159
    v_mov_b32 v225, v53
    v_mov_b32 v226, v54
    v_mov_b32 v227, v55
    s_nop 1
    v_permlane16_swap_b32 v53, v225
    v_permlane16_swap_b32 v54, v226
    v_permlane16_swap_b32 v55, v227
    s_nop 1
    v_max_f32 v53, v53, v225
    v_max_f32 v54, v54, v226
    v_max_f32 v55, v55, v227
    v_mov_b32 v225, v53
    v_mov_b32 v226, v54
    v_mov_b32 v227, v55
    s_nop 1
    v_permlane32_swap_b32 v53, v225
    v_permlane32_swap_b32 v54, v226
    v_permlane32_swap_b32 v55, v227
    s_nop 1
    v_max_f32 v53, v53, v225
    v_max_f32 v54, v54, v226
    v_max_f32 v55, v55, v227
    v_add_f32 v53, 0x41400000, v53
    v_max_f32 v53, 0, v53
    v_add_f32 v54, 0x41400000, v54
    v_max_f32 v54, 0, v54
    v_add_f32 v55, 0x41400000, v55
    v_max_f32 v55, 0, v55
    v_sub_f32 v132, v132, v53
    v_sub_f32 v133, v133, v53
    v_sub_f32 v134, v134, v53
    v_sub_f32 v135, v135, v53
    v_sub_f32 v136, v136, v54
    v_sub_f32 v137, v137, v54
    v_sub_f32 v138, v138, v54
    v_sub_f32 v139, v139, v54
    v_sub_f32 v140, v140, v55
    v_sub_f32 v141, v141, v55
    v_sub_f32 v142, v142, v55
    v_sub_f32 v143, v143, v55
    v_sub_f32 v148, v148, v53
    v_sub_f32 v149, v149, v53
    v_sub_f32 v150, v150, v53
    v_sub_f32 v151, v151, v53
    v_sub_f32 v152, v152, v54
    v_sub_f32 v153, v153, v54
    v_sub_f32 v154, v154, v54
    v_sub_f32 v155, v155, v54
    v_sub_f32 v156, v156, v55
    v_sub_f32 v157, v157, v55
    v_sub_f32 v158, v158, v55
    v_sub_f32 v159, v159, v55
    v_sub_f32 v164, v164, v53
    v_sub_f32 v20, v20, v53
    v_sub_f32 v165, v165, v53
    v_sub_f32 v21, v21, v53
    v_sub_f32 v166, v166, v53
    v_sub_f32 v22, v22, v53
    v_sub_f32 v167, v167, v53
    v_sub_f32 v23, v23, v53
    v_sub_f32 v168, v168, v54
    v_sub_f32 v24, v24, v54
    v_sub_f32 v169, v169, v54
    v_sub_f32 v25, v25, v54
    v_sub_f32 v170, v170, v54
    v_sub_f32 v26, v26, v54
    v_sub_f32 v171, v171, v54
    v_sub_f32 v27, v27, v54
    v_sub_f32 v172, v172, v55
    v_sub_f32 v28, v28, v55
    v_sub_f32 v173, v173, v55
    v_sub_f32 v29, v29, v55
    v_sub_f32 v174, v174, v55
    v_sub_f32 v30, v30, v55
    v_sub_f32 v175, v175, v55
    v_sub_f32 v31, v31, v55
    v_sub_f32 v180, v180, v53
    v_sub_f32 v36, v36, v53
    v_sub_f32 v181, v181, v53
    v_sub_f32 v37, v37, v53
    v_sub_f32 v182, v182, v53
    v_sub_f32 v38, v38, v53
    v_sub_f32 v183, v183, v53
    v_sub_f32 v39, v39, v53
    v_sub_f32 v184, v184, v54
    v_sub_f32 v40, v40, v54
    v_sub_f32 v185, v185, v54
    v_sub_f32 v41, v41, v54
    v_sub_f32 v186, v186, v54
    v_sub_f32 v42, v42, v54
    v_sub_f32 v187, v187, v54
    v_sub_f32 v43, v43, v54
    v_sub_f32 v188, v188, v55
    v_sub_f32 v44, v44, v55
    v_sub_f32 v189, v189, v55
    v_sub_f32 v45, v45, v55
    v_sub_f32 v190, v190, v55
    v_sub_f32 v46, v46, v55
    v_sub_f32 v191, v191, v55
    v_sub_f32 v47, v47, v55
    v_sub_f32 v9, v9, v53
    v_exp_f32 v53, -v53
    v_sub_f32 v10, v10, v54
    v_exp_f32 v54, -v54
    v_sub_f32 v11, v11, v55
    v_exp_f32 v55, -v55
    s_nop 0
    v_mul_f32 v48, v48, v53
    v_mul_f32 v248, v248, v54
    v_mul_f32 v252, v252, v55
    v_accvgpr_read_b32 v224, a4
    v_accvgpr_read_b32 v225, a5
    v_accvgpr_read_b32 v226, a6
    v_accvgpr_read_b32 v227, a7
    v_mul_f32 v224, v224, v53
    v_mul_f32 v225, v225, v53
    v_mul_f32 v226, v226, v53
    v_mul_f32 v227, v227, v53
    v_accvgpr_write_b32 a4, v224
    v_accvgpr_write_b32 a5, v225
    v_accvgpr_write_b32 a6, v226
    v_accvgpr_write_b32 a7, v227
    v_accvgpr_read_b32 v224, a8
    v_accvgpr_read_b32 v225, a9
    v_accvgpr_read_b32 v226, a10
    v_accvgpr_read_b32 v227, a11
    v_mul_f32 v224, v224, v54
    v_mul_f32 v225, v225, v54
    v_mul_f32 v226, v226, v54
    v_mul_f32 v227, v227, v54
    v_accvgpr_write_b32 a8, v224
    v_accvgpr_write_b32 a9, v225
    v_accvgpr_write_b32 a10, v226
    v_accvgpr_write_b32 a11, v227
    v_accvgpr_read_b32 v224, a12
    v_accvgpr_read_b32 v225, a13
    v_accvgpr_read_b32 v226, a14
    v_accvgpr_read_b32 v227, a15
    v_mul_f32 v224, v224, v55
    v_mul_f32 v225, v225, v55
    v_mul_f32 v226, v226, v55
    v_mul_f32 v227, v227, v55
    v_accvgpr_write_b32 a12, v224
    v_accvgpr_write_b32 a13, v225
    v_accvgpr_write_b32 a14, v226
    v_accvgpr_write_b32 a15, v227
    v_accvgpr_read_b32 v224, a20
    v_accvgpr_read_b32 v225, a21
    v_accvgpr_read_b32 v226, a22
    v_accvgpr_read_b32 v227, a23
    v_mul_f32 v224, v224, v53
    v_mul_f32 v225, v225, v53
    v_mul_f32 v226, v226, v53
    v_mul_f32 v227, v227, v53
    v_accvgpr_write_b32 a20, v224
    v_accvgpr_write_b32 a21, v225
    v_accvgpr_write_b32 a22, v226
    v_accvgpr_write_b32 a23, v227
    v_accvgpr_read_b32 v224, a24
    v_accvgpr_read_b32 v225, a25
    v_accvgpr_read_b32 v226, a26
    v_accvgpr_read_b32 v227, a27
    v_mul_f32 v224, v224, v54
    v_mul_f32 v225, v225, v54
    v_mul_f32 v226, v226, v54
    v_mul_f32 v227, v227, v54
    v_accvgpr_write_b32 a24, v224
    v_accvgpr_write_b32 a25, v225
    v_accvgpr_write_b32 a26, v226
    v_accvgpr_write_b32 a27, v227
    v_accvgpr_read_b32 v224, a28
    v_accvgpr_read_b32 v225, a29
    v_accvgpr_read_b32 v226, a30
    v_accvgpr_read_b32 v227, a31
    v_mul_f32 v224, v224, v55
    v_mul_f32 v225, v225, v55
    v_mul_f32 v226, v226, v55
    v_mul_f32 v227, v227, v55
    v_accvgpr_write_b32 a28, v224
    v_accvgpr_write_b32 a29, v225
    v_accvgpr_write_b32 a30, v226
    v_accvgpr_write_b32 a31, v227
    v_accvgpr_read_b32 v224, a36
    v_accvgpr_read_b32 v225, a37
    v_accvgpr_read_b32 v226, a38
    v_accvgpr_read_b32 v227, a39
    v_mul_f32 v224, v224, v53
    v_mul_f32 v225, v225, v53
    v_mul_f32 v226, v226, v53
    v_mul_f32 v227, v227, v53
    v_accvgpr_write_b32 a36, v224
    v_accvgpr_write_b32 a37, v225
    v_accvgpr_write_b32 a38, v226
    v_accvgpr_write_b32 a39, v227
    v_accvgpr_read_b32 v224, a40
    v_accvgpr_read_b32 v225, a41
    v_accvgpr_read_b32 v226, a42
    v_accvgpr_read_b32 v227, a43
    v_mul_f32 v224, v224, v54
    v_mul_f32 v225, v225, v54
    v_mul_f32 v226, v226, v54
    v_mul_f32 v227, v227, v54
    v_accvgpr_write_b32 a40, v224
    v_accvgpr_write_b32 a41, v225
    v_accvgpr_write_b32 a42, v226
    v_accvgpr_write_b32 a43, v227
    v_accvgpr_read_b32 v224, a44
    v_accvgpr_read_b32 v225, a45
    v_accvgpr_read_b32 v226, a46
    v_accvgpr_read_b32 v227, a47
    v_mul_f32 v224, v224, v55
    v_mul_f32 v225, v225, v55
    v_mul_f32 v226, v226, v55
    v_mul_f32 v227, v227, v55
    v_accvgpr_write_b32 a44, v224
    v_accvgpr_write_b32 a45, v225
    v_accvgpr_write_b32 a46, v226
    v_accvgpr_write_b32 a47, v227
    v_accvgpr_read_b32 v224, a52
    v_accvgpr_read_b32 v225, a53
    v_accvgpr_read_b32 v226, a54
    v_accvgpr_read_b32 v227, a55
    v_mul_f32 v224, v224, v53
    v_mul_f32 v225, v225, v53
    v_mul_f32 v226, v226, v53
    v_mul_f32 v227, v227, v53
    v_accvgpr_write_b32 a52, v224
    v_accvgpr_write_b32 a53, v225
    v_accvgpr_write_b32 a54, v226
    v_accvgpr_write_b32 a55, v227
    v_accvgpr_read_b32 v224, a56
    v_accvgpr_read_b32 v225, a57
    v_accvgpr_read_b32 v226, a58
    v_accvgpr_read_b32 v227, a59
    v_mul_f32 v224, v224, v54
    v_mul_f32 v225, v225, v54
    v_mul_f32 v226, v226, v54
    v_mul_f32 v227, v227, v54
    v_accvgpr_write_b32 a56, v224
    v_accvgpr_write_b32 a57, v225
    v_accvgpr_write_b32 a58, v226
    v_accvgpr_write_b32 a59, v227
    v_accvgpr_read_b32 v224, a60
    v_accvgpr_read_b32 v225, a61
    v_accvgpr_read_b32 v226, a62
    v_accvgpr_read_b32 v227, a63
    v_mul_f32 v224, v224, v55
    v_mul_f32 v225, v225, v55
    v_mul_f32 v226, v226, v55
    v_mul_f32 v227, v227, v55
    v_accvgpr_write_b32 a60, v224
    v_accvgpr_write_b32 a61, v225
    v_accvgpr_write_b32 a62, v226
    v_accvgpr_write_b32 a63, v227
    v_accvgpr_read_b32 v224, a68
    v_accvgpr_read_b32 v225, a69
    v_accvgpr_read_b32 v226, a70
    v_accvgpr_read_b32 v227, a71
    v_mul_f32 v224, v224, v53
    v_mul_f32 v225, v225, v53
    v_mul_f32 v226, v226, v53
    v_mul_f32 v227, v227, v53
    v_accvgpr_write_b32 a68, v224
    v_accvgpr_write_b32 a69, v225
    v_accvgpr_write_b32 a70, v226
    v_accvgpr_write_b32 a71, v227
    v_accvgpr_read_b32 v224, a72
    v_accvgpr_read_b32 v225, a73
    v_accvgpr_read_b32 v226, a74
    v_accvgpr_read_b32 v227, a75
    v_mul_f32 v224, v224, v54
    v_mul_f32 v225, v225, v54
    v_mul_f32 v226, v226, v54
    v_mul_f32 v227, v227, v54
    v_accvgpr_write_b32 a72, v224
    v_accvgpr_write_b32 a73, v225
    v_accvgpr_write_b32 a74, v226
    v_accvgpr_write_b32 a75, v227
    v_accvgpr_read_b32 v224, a76
    v_accvgpr_read_b32 v225, a77
    v_accvgpr_read_b32 v226, a78
    v_accvgpr_read_b32 v227, a79
    v_mul_f32 v224, v224, v55
    v_mul_f32 v225, v225, v55
    v_mul_f32 v226, v226, v55
    v_mul_f32 v227, v227, v55
    v_accvgpr_write_b32 a76, v224
    v_accvgpr_write_b32 a77, v225
    v_accvgpr_write_b32 a78, v226
    v_accvgpr_write_b32 a79, v227
    v_accvgpr_read_b32 v224, a84
    v_accvgpr_read_b32 v225, a85
    v_accvgpr_read_b32 v226, a86
    v_accvgpr_read_b32 v227, a87
    v_mul_f32 v224, v224, v53
    v_mul_f32 v225, v225, v53
    v_mul_f32 v226, v226, v53
    v_mul_f32 v227, v227, v53
    v_accvgpr_write_b32 a84, v224
    v_accvgpr_write_b32 a85, v225
    v_accvgpr_write_b32 a86, v226
    v_accvgpr_write_b32 a87, v227
    v_accvgpr_read_b32 v224, a88
    v_accvgpr_read_b32 v225, a89
    v_accvgpr_read_b32 v226, a90
    v_accvgpr_read_b32 v227, a91
    v_mul_f32 v224, v224, v54
    v_mul_f32 v225, v225, v54
    v_mul_f32 v226, v226, v54
    v_mul_f32 v227, v227, v54
    v_accvgpr_write_b32 a88, v224
    v_accvgpr_write_b32 a89, v225
    v_accvgpr_write_b32 a90, v226
    v_accvgpr_write_b32 a91, v227
    v_accvgpr_read_b32 v224, a92
    v_accvgpr_read_b32 v225, a93
    v_accvgpr_read_b32 v226, a94
    v_accvgpr_read_b32 v227, a95
    v_mul_f32 v224, v224, v55
    v_mul_f32 v225, v225, v55
    v_mul_f32 v226, v226, v55
    v_mul_f32 v227, v227, v55
    v_accvgpr_write_b32 a92, v224
    v_accvgpr_write_b32 a93, v225
    v_accvgpr_write_b32 a94, v226
    v_accvgpr_write_b32 a95, v227
    v_accvgpr_read_b32 v224, a100
    v_accvgpr_read_b32 v225, a101
    v_accvgpr_read_b32 v226, a102
    v_accvgpr_read_b32 v227, a103
    v_mul_f32 v224, v224, v53
    v_mul_f32 v225, v225, v53
    v_mul_f32 v226, v226, v53
    v_mul_f32 v227, v227, v53
    v_accvgpr_write_b32 a100, v224
    v_accvgpr_write_b32 a101, v225
    v_accvgpr_write_b32 a102, v226
    v_accvgpr_write_b32 a103, v227
    v_accvgpr_read_b32 v224, a104
    v_accvgpr_read_b32 v225, a105
    v_accvgpr_read_b32 v226, a106
    v_accvgpr_read_b32 v227, a107
    v_mul_f32 v224, v224, v54
    v_mul_f32 v225, v225, v54
    v_mul_f32 v226, v226, v54
    v_mul_f32 v227, v227, v54
    v_accvgpr_write_b32 a104, v224
    v_accvgpr_write_b32 a105, v225
    v_accvgpr_write_b32 a106, v226
    v_accvgpr_write_b32 a107, v227
    v_accvgpr_read_b32 v224, a108
    v_accvgpr_read_b32 v225, a109
    v_accvgpr_read_b32 v226, a110
    v_accvgpr_read_b32 v227, a111
    v_mul_f32 v224, v224, v55
    v_mul_f32 v225, v225, v55
    v_mul_f32 v226, v226, v55
    v_mul_f32 v227, v227, v55
    v_accvgpr_write_b32 a108, v224
    v_accvgpr_write_b32 a109, v225
    v_accvgpr_write_b32 a110, v226
    v_accvgpr_write_b32 a111, v227
    v_accvgpr_read_b32 v224, a116
    v_accvgpr_read_b32 v225, a117
    v_accvgpr_read_b32 v226, a118
    v_accvgpr_read_b32 v227, a119
    v_mul_f32 v224, v224, v53
    v_mul_f32 v225, v225, v53
    v_mul_f32 v226, v226, v53
    v_mul_f32 v227, v227, v53
    v_accvgpr_write_b32 a116, v224
    v_accvgpr_write_b32 a117, v225
    v_accvgpr_write_b32 a118, v226
    v_accvgpr_write_b32 a119, v227
    v_accvgpr_read_b32 v224, a120
    v_accvgpr_read_b32 v225, a121
    v_accvgpr_read_b32 v226, a122
    v_accvgpr_read_b32 v227, a123
    v_mul_f32 v224, v224, v54
    v_mul_f32 v225, v225, v54
    v_mul_f32 v226, v226, v54
    v_mul_f32 v227, v227, v54
    v_accvgpr_write_b32 a120, v224
    v_accvgpr_write_b32 a121, v225
    v_accvgpr_write_b32 a122, v226
    v_accvgpr_write_b32 a123, v227
    v_accvgpr_read_b32 v224, a124
    v_accvgpr_read_b32 v225, a125
    v_accvgpr_read_b32 v226, a126
    v_accvgpr_read_b32 v227, a127
    v_mul_f32 v224, v224, v55
    v_mul_f32 v225, v225, v55
    v_mul_f32 v226, v226, v55
    v_mul_f32 v227, v227, v55
    v_accvgpr_write_b32 a124, v224
    v_accvgpr_write_b32 a125, v225
    v_accvgpr_write_b32 a126, v226
    v_accvgpr_write_b32 a127, v227
    v_exp_f32 v232, v132
    v_exp_f32 v233, v133
    v_exp_f32 v234, v134
    v_exp_f32 v235, v135
    s_nop 0
    v_cvt_pk_bf16_f32 v196, v232, v233
    v_cvt_pk_bf16_f32 v197, v234, v235
    v_exp_f32 v232, v148
    v_exp_f32 v233, v149
    v_exp_f32 v234, v150
    v_exp_f32 v235, v151
    s_nop 0
    v_cvt_pk_bf16_f32 v198, v232, v233
    v_cvt_pk_bf16_f32 v199, v234, v235
    v_exp_f32 v232, v136
    v_exp_f32 v233, v137
    v_exp_f32 v234, v138
    v_exp_f32 v235, v139
    s_nop 0
    v_cvt_pk_bf16_f32 v200, v232, v233
    v_cvt_pk_bf16_f32 v201, v234, v235
    v_exp_f32 v232, v152
    v_exp_f32 v233, v153
    v_exp_f32 v234, v154
    v_exp_f32 v235, v155
    s_nop 0
    v_cvt_pk_bf16_f32 v202, v232, v233
    v_cvt_pk_bf16_f32 v203, v234, v235
    v_exp_f32 v232, v140
    v_exp_f32 v233, v141
    v_exp_f32 v234, v142
    v_exp_f32 v235, v143
    s_nop 0
    v_cvt_pk_bf16_f32 v204, v232, v233
    v_cvt_pk_bf16_f32 v205, v234, v235
    v_exp_f32 v232, v156
    v_exp_f32 v233, v157
    v_exp_f32 v234, v158
    v_exp_f32 v235, v159
    s_nop 0
    v_cvt_pk_bf16_f32 v206, v232, v233
    v_cvt_pk_bf16_f32 v207, v234, v235
    s_nop 3
    s_setpc_b64 s[40:41]
k2_rare_159:
    s_nop 7
    v_max_f32 v53, v164, v165
    v_max3_f32 v53, v53, v166, v167
    v_max3_f32 v53, v53, v180, v181
    v_max3_f32 v53, v53, v182, v183
    v_max_f32 v54, v168, v169
    v_max3_f32 v54, v54, v170, v171
    v_max3_f32 v54, v54, v184, v185
    v_max3_f32 v54, v54, v186, v187
    v_max_f32 v55, v172, v173
    v_max3_f32 v55, v55, v174, v175
    v_max3_f32 v55, v55, v188, v189
    v_max3_f32 v55, v55, v190, v191
    v_mov_b32 v225, v53
    v_mov_b32 v226, v54
    v_mov_b32 v227, v55
    s_nop 1
    v_permlane16_swap_b32 v53, v225
    v_permlane16_swap_b32 v54, v226
    v_permlane16_swap_b32 v55, v227
    s_nop 1
    v_max_f32 v53, v53, v225
    v_max_f32 v54, v54, v226
    v_max_f32 v55, v55, v227
    v_mov_b32 v225, v53
    v_mov_b32 v226, v54
    v_mov_b32 v227, v55
    s_nop 1
    v_permlane32_swap_b32 v53, v225
    v_permlane32_swap_b32 v54, v226
    v_permlane32_swap_b32 v55, v227
    s_nop 1
    v_max_f32 v53, v53, v225
    v_max_f32 v54, v54, v226
    v_max_f32 v55, v55, v227
    v_add_f32 v53, 0x41400000, v53
    v_max_f32 v53, 0, v53
    v_add_f32 v54, 0x41400000, v54
    v_max_f32 v54, 0, v54
    v_add_f32 v55, 0x41400000, v55
    v_max_f32 v55, 0, v55
    v_sub_f32 v164, v164, v53
    v_sub_f32 v165, v165, v53
    v_sub_f32 v166, v166, v53
    v_sub_f32 v167, v167, v53
    v_sub_f32 v168, v168, v54
    v_sub_f32 v169, v169, v54
    v_sub_f32 v170, v170, v54
    v_sub_f32 v171, v171, v54
    v_sub_f32 v172, v172, v55
    v_sub_f32 v173, v173, v55
    v_sub_f32 v174, v174, v55
    v_sub_f32 v175, v175, v55
    v_sub_f32 v180, v180, v53
    v_sub_f32 v181, v181, v53
    v_sub_f32 v182, v182, v53
    v_sub_f32 v183, v183, v53
    v_sub_f32 v184, v184, v54
    v_sub_f32 v185, v185, v54
    v_sub_f32 v186, v186, v54
    v_sub_f32 v187, v187, v54
    v_sub_f32 v188, v188, v55
    v_sub_f32 v189, v189, v55
    v_sub_f32 v190, v190, v55
    v_sub_f32 v191, v191, v55
    v_sub_f32 v128, v128, v54
    v_sub_f32 v16, v16, v54
    v_sub_f32 v129, v129, v54
    v_sub_f32 v17, v17, v54
    v_sub_f32 v130, v130, v54
    v_sub_f32 v18, v18, v54
    v_sub_f32 v131, v131, v54
    v_sub_f32 v19, v19, v54
    v_sub_f32 v132, v132, v55
    v_sub_f32 v20, v20, v55
    v_sub_f32 v133, v133, v55
    v_sub_f32 v21, v21, v55
    v_sub_f32 v134, v134, v55
    v_sub_f32 v22, v22, v55
    v_sub_f32 v135, v135, v55
    v_sub_f32 v23, v23, v55
    v_sub_f32 v136, v136, v54
    v_sub_f32 v24, v24, v54
    v_sub_f32 v137, v137, v54
    v_sub_f32 v25, v25, v54
    v_sub_f32 v138, v138, v54
    v_sub_f32 v26, v26, v54
    v_sub_f32 v139, v139, v54
    v_sub_f32 v27, v27, v54
    v_sub_f32 v140, v140, v55
    v_sub_f32 v28, v28, v55
    v_sub_f32 v141, v141, v55
    v_sub_f32 v29, v29, v55
    v_sub_f32 v142, v142, v55
    v_sub_f32 v30, v30, v55
    v_sub_f32 v143, v143, v55
    v_sub_f32 v31, v31, v55
    v_sub_f32 v144, v144, v54
    v_sub_f32 v32, v32, v54
    v_sub_f32 v145, v145, v54
    v_sub_f32 v33, v33, v54
    v_sub_f32 v146, v146, v54
    v_sub_f32 v34, v34, v54
    v_sub_f32 v147, v147, v54
    v_sub_f32 v35, v35, v54
    v_sub_f32 v148, v148, v55
    v_sub_f32 v36, v36, v55
    v_sub_f32 v149, v149, v55
    v_sub_f32 v37, v37, v55
    v_sub_f32 v150, v150, v55
    v_sub_f32 v38, v38, v55
    v_sub_f32 v151, v151, v55
    v_sub_f32 v39, v39, v55
    v_sub_f32 v152, v152, v54
    v_sub_f32 v40, v40, v54
    v_sub_f32 v153, v153, v54
    v_sub_f32 v41, v41, v54
    v_sub_f32 v154, v154, v54
    v_sub_f32 v42, v42, v54
    v_sub_f32 v155, v155, v54
    v_sub_f32 v43, v43, v54
    v_sub_f32 v156, v156, v55
    v_sub_f32 v44, v44, v55
    v_sub_f32 v157, v157, v55
    v_sub_f32 v45, v45, v55
    v_sub_f32 v158, v158, v55
    v_sub_f32 v46, v46, v55
    v_sub_f32 v159, v159, v55
    v_sub_f32 v47, v47, v55
    v_sub_f32 v9, v9, v53
    v_exp_f32 v53, -v53
    v_sub_f32 v10, v10, v54
    v_exp_f32 v54, -v54
    v_sub_f32 v11, v11, v55
    v_exp_f32 v55, -v55
    s_nop 0
    v_mul_f32 v48, v48, v53
    v_mul_f32 v248, v248, v54
    v_mul_f32 v252, v252, v55
    v_accvgpr_read_b32 v224, a4
    v_accvgpr_read_b32 v225, a5
    v_accvgpr_read_b32 v226, a6
    v_accvgpr_read_b32 v227, a7
    v_mul_f32 v224, v224, v53
    v_mul_f32 v225, v225, v53
    v_mul_f32 v226, v226, v53
    v_mul_f32 v227, v227, v53
    v_accvgpr_write_b32 a4, v224
    v_accvgpr_write_b32 a5, v225
    v_accvgpr_write_b32 a6, v226
    v_accvgpr_write_b32 a7, v227
    v_accvgpr_read_b32 v224, a8
    v_accvgpr_read_b32 v225, a9
    v_accvgpr_read_b32 v226, a10
    v_accvgpr_read_b32 v227, a11
    v_mul_f32 v224, v224, v54
    v_mul_f32 v225, v225, v54
    v_mul_f32 v226, v226, v54
    v_mul_f32 v227, v227, v54
    v_accvgpr_write_b32 a8, v224
    v_accvgpr_write_b32 a9, v225
    v_accvgpr_write_b32 a10, v226
    v_accvgpr_write_b32 a11, v227
    v_accvgpr_read_b32 v224, a12
    v_accvgpr_read_b32 v225, a13
    v_accvgpr_read_b32 v226, a14
    v_accvgpr_read_b32 v227, a15
    v_mul_f32 v224, v224, v55
    v_mul_f32 v225, v225, v55
    v_mul_f32 v226, v226, v55
    v_mul_f32 v227, v227, v55
    v_accvgpr_write_b32 a12, v224
    v_accvgpr_write_b32 a13, v225
    v_accvgpr_write_b32 a14, v226
    v_accvgpr_write_b32 a15, v227
    v_accvgpr_read_b32 v224, a20
    v_accvgpr_read_b32 v225, a21
    v_accvgpr_read_b32 v226, a22
    v_accvgpr_read_b32 v227, a23
    v_mul_f32 v224, v224, v53
    v_mul_f32 v225, v225, v53
    v_mul_f32 v226, v226, v53
    v_mul_f32 v227, v227, v53
    v_accvgpr_write_b32 a20, v224
    v_accvgpr_write_b32 a21, v225
    v_accvgpr_write_b32 a22, v226
    v_accvgpr_write_b32 a23, v227
    v_accvgpr_read_b32 v224, a24
    v_accvgpr_read_b32 v225, a25
    v_accvgpr_read_b32 v226, a26
    v_accvgpr_read_b32 v227, a27
    v_mul_f32 v224, v224, v54
    v_mul_f32 v225, v225, v54
    v_mul_f32 v226, v226, v54
    v_mul_f32 v227, v227, v54
    v_accvgpr_write_b32 a24, v224
    v_accvgpr_write_b32 a25, v225
    v_accvgpr_write_b32 a26, v226
    v_accvgpr_write_b32 a27, v227
    v_accvgpr_read_b32 v224, a28
    v_accvgpr_read_b32 v225, a29
    v_accvgpr_read_b32 v226, a30
    v_accvgpr_read_b32 v227, a31
    v_mul_f32 v224, v224, v55
    v_mul_f32 v225, v225, v55
    v_mul_f32 v226, v226, v55
    v_mul_f32 v227, v227, v55
    v_accvgpr_write_b32 a28, v224
    v_accvgpr_write_b32 a29, v225
    v_accvgpr_write_b32 a30, v226
    v_accvgpr_write_b32 a31, v227
    v_accvgpr_read_b32 v224, a36
    v_accvgpr_read_b32 v225, a37
    v_accvgpr_read_b32 v226, a38
    v_accvgpr_read_b32 v227, a39
    v_mul_f32 v224, v224, v53
    v_mul_f32 v225, v225, v53
    v_mul_f32 v226, v226, v53
    v_mul_f32 v227, v227, v53
    v_accvgpr_write_b32 a36, v224
    v_accvgpr_write_b32 a37, v225
    v_accvgpr_write_b32 a38, v226
    v_accvgpr_write_b32 a39, v227
    v_accvgpr_read_b32 v224, a40
    v_accvgpr_read_b32 v225, a41
    v_accvgpr_read_b32 v226, a42
    v_accvgpr_read_b32 v227, a43
    v_mul_f32 v224, v224, v54
    v_mul_f32 v225, v225, v54
    v_mul_f32 v226, v226, v54
    v_mul_f32 v227, v227, v54
    v_accvgpr_write_b32 a40, v224
    v_accvgpr_write_b32 a41, v225
    v_accvgpr_write_b32 a42, v226
    v_accvgpr_write_b32 a43, v227
    v_accvgpr_read_b32 v224, a44
    v_accvgpr_read_b32 v225, a45
    v_accvgpr_read_b32 v226, a46
    v_accvgpr_read_b32 v227, a47
    v_mul_f32 v224, v224, v55
    v_mul_f32 v225, v225, v55
    v_mul_f32 v226, v226, v55
    v_mul_f32 v227, v227, v55
    v_accvgpr_write_b32 a44, v224
    v_accvgpr_write_b32 a45, v225
    v_accvgpr_write_b32 a46, v226
    v_accvgpr_write_b32 a47, v227
    v_accvgpr_read_b32 v224, a52
    v_accvgpr_read_b32 v225, a53
    v_accvgpr_read_b32 v226, a54
    v_accvgpr_read_b32 v227, a55
    v_mul_f32 v224, v224, v53
    v_mul_f32 v225, v225, v53
    v_mul_f32 v226, v226, v53
    v_mul_f32 v227, v227, v53
    v_accvgpr_write_b32 a52, v224
    v_accvgpr_write_b32 a53, v225
    v_accvgpr_write_b32 a54, v226
    v_accvgpr_write_b32 a55, v227
    v_accvgpr_read_b32 v224, a56
    v_accvgpr_read_b32 v225, a57
    v_accvgpr_read_b32 v226, a58
    v_accvgpr_read_b32 v227, a59
    v_mul_f32 v224, v224, v54
    v_mul_f32 v225, v225, v54
    v_mul_f32 v226, v226, v54
    v_mul_f32 v227, v227, v54
    v_accvgpr_write_b32 a56, v224
    v_accvgpr_write_b32 a57, v225
    v_accvgpr_write_b32 a58, v226
    v_accvgpr_write_b32 a59, v227
    v_accvgpr_read_b32 v224, a60
    v_accvgpr_read_b32 v225, a61
    v_accvgpr_read_b32 v226, a62
    v_accvgpr_read_b32 v227, a63
    v_mul_f32 v224, v224, v55
    v_mul_f32 v225, v225, v55
    v_mul_f32 v226, v226, v55
    v_mul_f32 v227, v227, v55
    v_accvgpr_write_b32 a60, v224
    v_accvgpr_write_b32 a61, v225
    v_accvgpr_write_b32 a62, v226
    v_accvgpr_write_b32 a63, v227
    v_accvgpr_read_b32 v224, a68
    v_accvgpr_read_b32 v225, a69
    v_accvgpr_read_b32 v226, a70
    v_accvgpr_read_b32 v227, a71
    v_mul_f32 v224, v224, v53
    v_mul_f32 v225, v225, v53
    v_mul_f32 v226, v226, v53
    v_mul_f32 v227, v227, v53
    v_accvgpr_write_b32 a68, v224
    v_accvgpr_write_b32 a69, v225
    v_accvgpr_write_b32 a70, v226
    v_accvgpr_write_b32 a71, v227
    v_accvgpr_read_b32 v224, a72
    v_accvgpr_read_b32 v225, a73
    v_accvgpr_read_b32 v226, a74
    v_accvgpr_read_b32 v227, a75
    v_mul_f32 v224, v224, v54
    v_mul_f32 v225, v225, v54
    v_mul_f32 v226, v226, v54
    v_mul_f32 v227, v227, v54
    v_accvgpr_write_b32 a72, v224
    v_accvgpr_write_b32 a73, v225
    v_accvgpr_write_b32 a74, v226
    v_accvgpr_write_b32 a75, v227
    v_accvgpr_read_b32 v224, a76
    v_accvgpr_read_b32 v225, a77
    v_accvgpr_read_b32 v226, a78
    v_accvgpr_read_b32 v227, a79
    v_mul_f32 v224, v224, v55
    v_mul_f32 v225, v225, v55
    v_mul_f32 v226, v226, v55
    v_mul_f32 v227, v227, v55
    v_accvgpr_write_b32 a76, v224
    v_accvgpr_write_b32 a77, v225
    v_accvgpr_write_b32 a78, v226
    v_accvgpr_write_b32 a79, v227
    v_accvgpr_read_b32 v224, a84
    v_accvgpr_read_b32 v225, a85
    v_accvgpr_read_b32 v226, a86
    v_accvgpr_read_b32 v227, a87
    v_mul_f32 v224, v224, v53
    v_mul_f32 v225, v225, v53
    v_mul_f32 v226, v226, v53
    v_mul_f32 v227, v227, v53
    v_accvgpr_write_b32 a84, v224
    v_accvgpr_write_b32 a85, v225
    v_accvgpr_write_b32 a86, v226
    v_accvgpr_write_b32 a87, v227
    v_accvgpr_read_b32 v224, a88
    v_accvgpr_read_b32 v225, a89
    v_accvgpr_read_b32 v226, a90
    v_accvgpr_read_b32 v227, a91
    v_mul_f32 v224, v224, v54
    v_mul_f32 v225, v225, v54
    v_mul_f32 v226, v226, v54
    v_mul_f32 v227, v227, v54
    v_accvgpr_write_b32 a88, v224
    v_accvgpr_write_b32 a89, v225
    v_accvgpr_write_b32 a90, v226
    v_accvgpr_write_b32 a91, v227
    v_accvgpr_read_b32 v224, a92
    v_accvgpr_read_b32 v225, a93
    v_accvgpr_read_b32 v226, a94
    v_accvgpr_read_b32 v227, a95
    v_mul_f32 v224, v224, v55
    v_mul_f32 v225, v225, v55
    v_mul_f32 v226, v226, v55
    v_mul_f32 v227, v227, v55
    v_accvgpr_write_b32 a92, v224
    v_accvgpr_write_b32 a93, v225
    v_accvgpr_write_b32 a94, v226
    v_accvgpr_write_b32 a95, v227
    v_accvgpr_read_b32 v224, a100
    v_accvgpr_read_b32 v225, a101
    v_accvgpr_read_b32 v226, a102
    v_accvgpr_read_b32 v227, a103
    v_mul_f32 v224, v224, v53
    v_mul_f32 v225, v225, v53
    v_mul_f32 v226, v226, v53
    v_mul_f32 v227, v227, v53
    v_accvgpr_write_b32 a100, v224
    v_accvgpr_write_b32 a101, v225
    v_accvgpr_write_b32 a102, v226
    v_accvgpr_write_b32 a103, v227
    v_accvgpr_read_b32 v224, a104
    v_accvgpr_read_b32 v225, a105
    v_accvgpr_read_b32 v226, a106
    v_accvgpr_read_b32 v227, a107
    v_mul_f32 v224, v224, v54
    v_mul_f32 v225, v225, v54
    v_mul_f32 v226, v226, v54
    v_mul_f32 v227, v227, v54
    v_accvgpr_write_b32 a104, v224
    v_accvgpr_write_b32 a105, v225
    v_accvgpr_write_b32 a106, v226
    v_accvgpr_write_b32 a107, v227
    v_accvgpr_read_b32 v224, a108
    v_accvgpr_read_b32 v225, a109
    v_accvgpr_read_b32 v226, a110
    v_accvgpr_read_b32 v227, a111
    v_mul_f32 v224, v224, v55
    v_mul_f32 v225, v225, v55
    v_mul_f32 v226, v226, v55
    v_mul_f32 v227, v227, v55
    v_accvgpr_write_b32 a108, v224
    v_accvgpr_write_b32 a109, v225
    v_accvgpr_write_b32 a110, v226
    v_accvgpr_write_b32 a111, v227
    v_accvgpr_read_b32 v224, a116
    v_accvgpr_read_b32 v225, a117
    v_accvgpr_read_b32 v226, a118
    v_accvgpr_read_b32 v227, a119
    v_mul_f32 v224, v224, v53
    v_mul_f32 v225, v225, v53
    v_mul_f32 v226, v226, v53
    v_mul_f32 v227, v227, v53
    v_accvgpr_write_b32 a116, v224
    v_accvgpr_write_b32 a117, v225
    v_accvgpr_write_b32 a118, v226
    v_accvgpr_write_b32 a119, v227
    v_accvgpr_read_b32 v224, a120
    v_accvgpr_read_b32 v225, a121
    v_accvgpr_read_b32 v226, a122
    v_accvgpr_read_b32 v227, a123
    v_mul_f32 v224, v224, v54
    v_mul_f32 v225, v225, v54
    v_mul_f32 v226, v226, v54
    v_mul_f32 v227, v227, v54
    v_accvgpr_write_b32 a120, v224
    v_accvgpr_write_b32 a121, v225
    v_accvgpr_write_b32 a122, v226
    v_accvgpr_write_b32 a123, v227
    v_accvgpr_read_b32 v224, a124
    v_accvgpr_read_b32 v225, a125
    v_accvgpr_read_b32 v226, a126
    v_accvgpr_read_b32 v227, a127
    v_mul_f32 v224, v224, v55
    v_mul_f32 v225, v225, v55
    v_mul_f32 v226, v226, v55
    v_mul_f32 v227, v227, v55
    v_accvgpr_write_b32 a124, v224
    v_accvgpr_write_b32 a125, v225
    v_accvgpr_write_b32 a126, v226
    v_accvgpr_write_b32 a127, v227
    v_exp_f32 v232, v164
    v_exp_f32 v233, v165
    v_exp_f32 v234, v166
    v_exp_f32 v235, v167
    s_nop 0
    v_cvt_pk_bf16_f32 v212, v232, v233
    v_cvt_pk_bf16_f32 v213, v234, v235
    v_exp_f32 v232, v180
    v_exp_f32 v233, v181
    v_exp_f32 v234, v182
    v_exp_f32 v235, v183
    s_nop 0
    v_cvt_pk_bf16_f32 v214, v232, v233
    v_cvt_pk_bf16_f32 v215, v234, v235
    v_exp_f32 v232, v168
    v_exp_f32 v233, v169
    v_exp_f32 v234, v170
    v_exp_f32 v235, v171
    s_nop 0
    v_cvt_pk_bf16_f32 v216, v232, v233
    v_cvt_pk_bf16_f32 v217, v234, v235
    v_exp_f32 v232, v184
    v_exp_f32 v233, v185
    v_exp_f32 v234, v186
    v_exp_f32 v235, v187
    s_nop 0
    v_cvt_pk_bf16_f32 v218, v232, v233
    v_cvt_pk_bf16_f32 v219, v234, v235
    v_exp_f32 v232, v172
    v_exp_f32 v233, v173
    v_exp_f32 v234, v174
    v_exp_f32 v235, v175
    s_nop 0
    v_cvt_pk_bf16_f32 v220, v232, v233
    v_cvt_pk_bf16_f32 v221, v234, v235
    v_exp_f32 v232, v188
    v_exp_f32 v233, v189
    v_exp_f32 v234, v190
    v_exp_f32 v235, v191
    s_nop 0
    v_cvt_pk_bf16_f32 v222, v232, v233
    v_cvt_pk_bf16_f32 v223, v234, v235
    s_nop 3
    s_setpc_b64 s[40:41]
k2_rare_160:
    s_nop 7
    v_max_f32 v54, v128, v129
    v_max3_f32 v54, v54, v130, v131
    v_max3_f32 v54, v54, v144, v145
    v_max3_f32 v54, v54, v146, v147
    v_max3_f32 v54, v54, v136, v137
    v_max3_f32 v54, v54, v138, v139
    v_max3_f32 v54, v54, v152, v153
    v_max3_f32 v54, v54, v154, v155
    v_max_f32 v55, v132, v133
    v_max3_f32 v55, v55, v134, v135
    v_max3_f32 v55, v55, v148, v149
    v_max3_f32 v55, v55, v150, v151
    v_max3_f32 v55, v55, v140, v141
    v_max3_f32 v55, v55, v142, v143
    v_max3_f32 v55, v55, v156, v157
    v_max3_f32 v55, v55, v158, v159
    v_mov_b32 v226, v54
    v_mov_b32 v227, v55
    s_nop 1
    v_permlane16_swap_b32 v54, v226
    v_permlane16_swap_b32 v55, v227
    s_nop 1
    v_max_f32 v54, v54, v226
    v_max_f32 v55, v55, v227
    v_mov_b32 v226, v54
    v_mov_b32 v227, v55
    s_nop 1
    v_permlane32_swap_b32 v54, v226
    v_permlane32_swap_b32 v55, v227
    s_nop 1
    v_max_f32 v54, v54, v226
    v_max_f32 v55, v55, v227
    v_add_f32 v54, 0x41400000, v54
    v_max_f32 v54, 0, v54
    v_add_f32 v55, 0x41400000, v55
    v_max_f32 v55, 0, v55
    v_sub_f32 v128, v128, v54
    v_sub_f32 v129, v129, v54
    v_sub_f32 v130, v130, v54
    v_sub_f32 v131, v131, v54
    v_sub_f32 v132, v132, v55
    v_sub_f32 v133, v133, v55
    v_sub_f32 v134, v134, v55
    v_sub_f32 v135, v135, v55
    v_sub_f32 v136, v136, v54
    v_sub_f32 v137, v137, v54
    v_sub_f32 v138, v138, v54
    v_sub_f32 v139, v139, v54
    v_sub_f32 v140, v140, v55
    v_sub_f32 v141, v141, v55
    v_sub_f32 v142, v142, v55
    v_sub_f32 v143, v143, v55
    v_sub_f32 v144, v144, v54
    v_sub_f32 v145, v145, v54
    v_sub_f32 v146, v146, v54
    v_sub_f32 v147, v147, v54
    v_sub_f32 v148, v148, v55
    v_sub_f32 v149, v149, v55
    v_sub_f32 v150, v150, v55
    v_sub_f32 v151, v151, v55
    v_sub_f32 v152, v152, v54
    v_sub_f32 v153, v153, v54
    v_sub_f32 v154, v154, v54
    v_sub_f32 v155, v155, v54
    v_sub_f32 v156, v156, v55
    v_sub_f32 v157, v157, v55
    v_sub_f32 v158, v158, v55
    v_sub_f32 v159, v159, v55
    v_sub_f32 v160, v160, v54
    v_sub_f32 v16, v16, v54
    v_sub_f32 v161, v161, v54
    v_sub_f32 v17, v17, v54
    v_sub_f32 v162, v162, v54
    v_sub_f32 v18, v18, v54
    v_sub_f32 v163, v163, v54
    v_sub_f32 v19, v19, v54
    v_sub_f32 v164, v164, v55
    v_sub_f32 v20, v20, v55
    v_sub_f32 v165, v165, v55
    v_sub_f32 v21, v21, v55
    v_sub_f32 v166, v166, v55
    v_sub_f32 v22, v22, v55
    v_sub_f32 v167, v167, v55
    v_sub_f32 v23, v23, v55
    v_sub_f32 v168, v168, v54
    v_sub_f32 v24, v24, v54
    v_sub_f32 v169, v169, v54
    v_sub_f32 v25, v25, v54
    v_sub_f32 v170, v170, v54
    v_sub_f32 v26, v26, v54
    v_sub_f32 v171, v171, v54
    v_sub_f32 v27, v27, v54
    v_sub_f32 v172, v172, v55
    v_sub_f32 v28, v28, v55
    v_sub_f32 v173, v173, v55
    v_sub_f32 v29, v29, v55
    v_sub_f32 v174, v174, v55
    v_sub_f32 v30, v30, v55
    v_sub_f32 v175, v175, v55
    v_sub_f32 v31, v31, v55
    v_sub_f32 v176, v176, v54
    v_sub_f32 v32, v32, v54
    v_sub_f32 v177, v177, v54
    v_sub_f32 v33, v33, v54
    v_sub_f32 v178, v178, v54
    v_sub_f32 v34, v34, v54
    v_sub_f32 v179, v179, v54
    v_sub_f32 v35, v35, v54
    v_sub_f32 v180, v180, v55
    v_sub_f32 v36, v36, v55
    v_sub_f32 v181, v181, v55
    v_sub_f32 v37, v37, v55
    v_sub_f32 v182, v182, v55
    v_sub_f32 v38, v38, v55
    v_sub_f32 v183, v183, v55
    v_sub_f32 v39, v39, v55
    v_sub_f32 v184, v184, v54
    v_sub_f32 v40, v40, v54
    v_sub_f32 v185, v185, v54
    v_sub_f32 v41, v41, v54
    v_sub_f32 v186, v186, v54
    v_sub_f32 v42, v42, v54
    v_sub_f32 v187, v187, v54
    v_sub_f32 v43, v43, v54
    v_sub_f32 v188, v188, v55
    v_sub_f32 v44, v44, v55
    v_sub_f32 v189, v189, v55
    v_sub_f32 v45, v45, v55
    v_sub_f32 v190, v190, v55
    v_sub_f32 v46, v46, v55
    v_sub_f32 v191, v191, v55
    v_sub_f32 v47, v47, v55
    v_sub_f32 v10, v10, v54
    v_exp_f32 v54, -v54
    v_sub_f32 v11, v11, v55
    v_exp_f32 v55, -v55
    s_nop 0
    v_mul_f32 v248, v248, v54
    v_mul_f32 v252, v252, v55
    v_accvgpr_read_b32 v224, a8
    v_accvgpr_read_b32 v225, a9
    v_accvgpr_read_b32 v226, a10
    v_accvgpr_read_b32 v227, a11
    v_mul_f32 v224, v224, v54
    v_mul_f32 v225, v225, v54
    v_mul_f32 v226, v226, v54
    v_mul_f32 v227, v227, v54
    v_accvgpr_write_b32 a8, v224
    v_accvgpr_write_b32 a9, v225
    v_accvgpr_write_b32 a10, v226
    v_accvgpr_write_b32 a11, v227
    v_accvgpr_read_b32 v224, a12
    v_accvgpr_read_b32 v225, a13
    v_accvgpr_read_b32 v226, a14
    v_accvgpr_read_b32 v227, a15
    v_mul_f32 v224, v224, v55
    v_mul_f32 v225, v225, v55
    v_mul_f32 v226, v226, v55
    v_mul_f32 v227, v227, v55
    v_accvgpr_write_b32 a12, v224
    v_accvgpr_write_b32 a13, v225
    v_accvgpr_write_b32 a14, v226
    v_accvgpr_write_b32 a15, v227
    v_accvgpr_read_b32 v224, a24
    v_accvgpr_read_b32 v225, a25
    v_accvgpr_read_b32 v226, a26
    v_accvgpr_read_b32 v227, a27
    v_mul_f32 v224, v224, v54
    v_mul_f32 v225, v225, v54
    v_mul_f32 v226, v226, v54
    v_mul_f32 v227, v227, v54
    v_accvgpr_write_b32 a24, v224
    v_accvgpr_write_b32 a25, v225
    v_accvgpr_write_b32 a26, v226
    v_accvgpr_write_b32 a27, v227
    v_accvgpr_read_b32 v224, a28
    v_accvgpr_read_b32 v225, a29
    v_accvgpr_read_b32 v226, a30
    v_accvgpr_read_b32 v227, a31
    v_mul_f32 v224, v224, v55
    v_mul_f32 v225, v225, v55
    v_mul_f32 v226, v226, v55
    v_mul_f32 v227, v227, v55
    v_accvgpr_write_b32 a28, v224
    v_accvgpr_write_b32 a29, v225
    v_accvgpr_write_b32 a30, v226
    v_accvgpr_write_b32 a31, v227
    v_accvgpr_read_b32 v224, a40
    v_accvgpr_read_b32 v225, a41
    v_accvgpr_read_b32 v226, a42
    v_accvgpr_read_b32 v227, a43
    v_mul_f32 v224, v224, v54
    v_mul_f32 v225, v225, v54
    v_mul_f32 v226, v226, v54
    v_mul_f32 v227, v227, v54
    v_accvgpr_write_b32 a40, v224
    v_accvgpr_write_b32 a41, v225
    v_accvgpr_write_b32 a42, v226
    v_accvgpr_write_b32 a43, v227
    v_accvgpr_read_b32 v224, a44
    v_accvgpr_read_b32 v225, a45
    v_accvgpr_read_b32 v226, a46
    v_accvgpr_read_b32 v227, a47
    v_mul_f32 v224, v224, v55
    v_mul_f32 v225, v225, v55
    v_mul_f32 v226, v226, v55
    v_mul_f32 v227, v227, v55
    v_accvgpr_write_b32 a44, v224
    v_accvgpr_write_b32 a45, v225
    v_accvgpr_write_b32 a46, v226
    v_accvgpr_write_b32 a47, v227
    v_accvgpr_read_b32 v224, a56
    v_accvgpr_read_b32 v225, a57
    v_accvgpr_read_b32 v226, a58
    v_accvgpr_read_b32 v227, a59
    v_mul_f32 v224, v224, v54
    v_mul_f32 v225, v225, v54
    v_mul_f32 v226, v226, v54
    v_mul_f32 v227, v227, v54
    v_accvgpr_write_b32 a56, v224
    v_accvgpr_write_b32 a57, v225
    v_accvgpr_write_b32 a58, v226
    v_accvgpr_write_b32 a59, v227
    v_accvgpr_read_b32 v224, a60
    v_accvgpr_read_b32 v225, a61
    v_accvgpr_read_b32 v226, a62
    v_accvgpr_read_b32 v227, a63
    v_mul_f32 v224, v224, v55
    v_mul_f32 v225, v225, v55
    v_mul_f32 v226, v226, v55
    v_mul_f32 v227, v227, v55
    v_accvgpr_write_b32 a60, v224
    v_accvgpr_write_b32 a61, v225
    v_accvgpr_write_b32 a62, v226
    v_accvgpr_write_b32 a63, v227
    v_accvgpr_read_b32 v224, a72
    v_accvgpr_read_b32 v225, a73
    v_accvgpr_read_b32 v226, a74
    v_accvgpr_read_b32 v227, a75
    v_mul_f32 v224, v224, v54
    v_mul_f32 v225, v225, v54
    v_mul_f32 v226, v226, v54
    v_mul_f32 v227, v227, v54
    v_accvgpr_write_b32 a72, v224
    v_accvgpr_write_b32 a73, v225
    v_accvgpr_write_b32 a74, v226
    v_accvgpr_write_b32 a75, v227
    v_accvgpr_read_b32 v224, a76
    v_accvgpr_read_b32 v225, a77
    v_accvgpr_read_b32 v226, a78
    v_accvgpr_read_b32 v227, a79
    v_mul_f32 v224, v224, v55
    v_mul_f32 v225, v225, v55
    v_mul_f32 v226, v226, v55
    v_mul_f32 v227, v227, v55
    v_accvgpr_write_b32 a76, v224
    v_accvgpr_write_b32 a77, v225
    v_accvgpr_write_b32 a78, v226
    v_accvgpr_write_b32 a79, v227
    v_accvgpr_read_b32 v224, a88
    v_accvgpr_read_b32 v225, a89
    v_accvgpr_read_b32 v226, a90
    v_accvgpr_read_b32 v227, a91
    v_mul_f32 v224, v224, v54
    v_mul_f32 v225, v225, v54
    v_mul_f32 v226, v226, v54
    v_mul_f32 v227, v227, v54
    v_accvgpr_write_b32 a88, v224
    v_accvgpr_write_b32 a89, v225
    v_accvgpr_write_b32 a90, v226
    v_accvgpr_write_b32 a91, v227
    v_accvgpr_read_b32 v224, a92
    v_accvgpr_read_b32 v225, a93
    v_accvgpr_read_b32 v226, a94
    v_accvgpr_read_b32 v227, a95
    v_mul_f32 v224, v224, v55
    v_mul_f32 v225, v225, v55
    v_mul_f32 v226, v226, v55
    v_mul_f32 v227, v227, v55
    v_accvgpr_write_b32 a92, v224
    v_accvgpr_write_b32 a93, v225
    v_accvgpr_write_b32 a94, v226
    v_accvgpr_write_b32 a95, v227
    v_accvgpr_read_b32 v224, a104
    v_accvgpr_read_b32 v225, a105
    v_accvgpr_read_b32 v226, a106
    v_accvgpr_read_b32 v227, a107
    v_mul_f32 v224, v224, v54
    v_mul_f32 v225, v225, v54
    v_mul_f32 v226, v226, v54
    v_mul_f32 v227, v227, v54
    v_accvgpr_write_b32 a104, v224
    v_accvgpr_write_b32 a105, v225
    v_accvgpr_write_b32 a106, v226
    v_accvgpr_write_b32 a107, v227
    v_accvgpr_read_b32 v224, a108
    v_accvgpr_read_b32 v225, a109
    v_accvgpr_read_b32 v226, a110
    v_accvgpr_read_b32 v227, a111
    v_mul_f32 v224, v224, v55
    v_mul_f32 v225, v225, v55
    v_mul_f32 v226, v226, v55
    v_mul_f32 v227, v227, v55
    v_accvgpr_write_b32 a108, v224
    v_accvgpr_write_b32 a109, v225
    v_accvgpr_write_b32 a110, v226
    v_accvgpr_write_b32 a111, v227
    v_accvgpr_read_b32 v224, a120
    v_accvgpr_read_b32 v225, a121
    v_accvgpr_read_b32 v226, a122
    v_accvgpr_read_b32 v227, a123
    v_mul_f32 v224, v224, v54
    v_mul_f32 v225, v225, v54
    v_mul_f32 v226, v226, v54
    v_mul_f32 v227, v227, v54
    v_accvgpr_write_b32 a120, v224
    v_accvgpr_write_b32 a121, v225
    v_accvgpr_write_b32 a122, v226
    v_accvgpr_write_b32 a123, v227
    v_accvgpr_read_b32 v224, a124
    v_accvgpr_read_b32 v225, a125
    v_accvgpr_read_b32 v226, a126
    v_accvgpr_read_b32 v227, a127
    v_mul_f32 v224, v224, v55
    v_mul_f32 v225, v225, v55
    v_mul_f32 v226, v226, v55
    v_mul_f32 v227, v227, v55
    v_accvgpr_write_b32 a124, v224
    v_accvgpr_write_b32 a125, v225
    v_accvgpr_write_b32 a126, v226
    v_accvgpr_write_b32 a127, v227
    v_exp_f32 v232, v128
    v_exp_f32 v233, v129
    v_exp_f32 v234, v130
    v_exp_f32 v235, v131
    s_nop 0
    v_cvt_pk_bf16_f32 v192, v232, v233
    v_cvt_pk_bf16_f32 v193, v234, v235
    v_exp_f32 v232, v144
    v_exp_f32 v233, v145
    v_exp_f32 v234, v146
    v_exp_f32 v235, v147
    s_nop 0
    v_cvt_pk_bf16_f32 v194, v232, v233
    v_cvt_pk_bf16_f32 v195, v234, v235
    v_exp_f32 v232, v132
    v_exp_f32 v233, v133
    v_exp_f32 v234, v134
    v_exp_f32 v235, v135
    s_nop 0
    v_cvt_pk_bf16_f32 v196, v232, v233
    v_cvt_pk_bf16_f32 v197, v234, v235
    v_exp_f32 v232, v148
    v_exp_f32 v233, v149
    v_exp_f32 v234, v150
    v_exp_f32 v235, v151
    s_nop 0
    v_cvt_pk_bf16_f32 v198, v232, v233
    v_cvt_pk_bf16_f32 v199, v234, v235
    v_exp_f32 v232, v136
    v_exp_f32 v233, v137
    v_exp_f32 v234, v138
    v_exp_f32 v235, v139
    s_nop 0
    v_cvt_pk_bf16_f32 v200, v232, v233
    v_cvt_pk_bf16_f32 v201, v234, v235
    v_exp_f32 v232, v152
    v_exp_f32 v233, v153
    v_exp_f32 v234, v154
    v_exp_f32 v235, v155
    s_nop 0
    v_cvt_pk_bf16_f32 v202, v232, v233
    v_cvt_pk_bf16_f32 v203, v234, v235
    v_exp_f32 v232, v140
    v_exp_f32 v233, v141
    v_exp_f32 v234, v142
    v_exp_f32 v235, v143
    s_nop 0
    v_cvt_pk_bf16_f32 v204, v232, v233
    v_cvt_pk_bf16_f32 v205, v234, v235
    v_exp_f32 v232, v156
    v_exp_f32 v233, v157
    v_exp_f32 v234, v158
    v_exp_f32 v235, v159
    s_nop 0
    v_cvt_pk_bf16_f32 v206, v232, v233
    v_cvt_pk_bf16_f32 v207, v234, v235
    s_nop 3
    s_setpc_b64 s[40:41]
k2_rare_161:
    s_nop 7
    v_max_f32 v54, v160, v161
    v_max3_f32 v54, v54, v162, v163
    v_max3_f32 v54, v54, v176, v177
    v_max3_f32 v54, v54, v178, v179
    v_max3_f32 v54, v54, v168, v169
    v_max3_f32 v54, v54, v170, v171
    v_max3_f32 v54, v54, v184, v185
    v_max3_f32 v54, v54, v186, v187
    v_max_f32 v55, v164, v165
    v_max3_f32 v55, v55, v166, v167
    v_max3_f32 v55, v55, v180, v181
    v_max3_f32 v55, v55, v182, v183
    v_max3_f32 v55, v55, v172, v173
    v_max3_f32 v55, v55, v174, v175
    v_max3_f32 v55, v55, v188, v189
    v_max3_f32 v55, v55, v190, v191
    v_mov_b32 v226, v54
    v_mov_b32 v227, v55
    s_nop 1
    v_permlane16_swap_b32 v54, v226
    v_permlane16_swap_b32 v55, v227
    s_nop 1
    v_max_f32 v54, v54, v226
    v_max_f32 v55, v55, v227
    v_mov_b32 v226, v54
    v_mov_b32 v227, v55
    s_nop 1
    v_permlane32_swap_b32 v54, v226
    v_permlane32_swap_b32 v55, v227
    s_nop 1
    v_max_f32 v54, v54, v226
    v_max_f32 v55, v55, v227
    v_add_f32 v54, 0x41400000, v54
    v_max_f32 v54, 0, v54
    v_add_f32 v55, 0x41400000, v55
    v_max_f32 v55, 0, v55
    v_sub_f32 v160, v160, v54
    v_sub_f32 v161, v161, v54
    v_sub_f32 v162, v162, v54
    v_sub_f32 v163, v163, v54
    v_sub_f32 v164, v164, v55
    v_sub_f32 v165, v165, v55
    v_sub_f32 v166, v166, v55
    v_sub_f32 v167, v167, v55
    v_sub_f32 v168, v168, v54
    v_sub_f32 v169, v169, v54
    v_sub_f32 v170, v170, v54
    v_sub_f32 v171, v171, v54
    v_sub_f32 v172, v172, v55
    v_sub_f32 v173, v173, v55
    v_sub_f32 v174, v174, v55
    v_sub_f32 v175, v175, v55
    v_sub_f32 v176, v176, v54
    v_sub_f32 v177, v177, v54
    v_sub_f32 v178, v178, v54
    v_sub_f32 v179, v179, v54
    v_sub_f32 v180, v180, v55
    v_sub_f32 v181, v181, v55
    v_sub_f32 v182, v182, v55
    v_sub_f32 v183, v183, v55
    v_sub_f32 v184, v184, v54
    v_sub_f32 v185, v185, v54
    v_sub_f32 v186, v186, v54
    v_sub_f32 v187, v187, v54
    v_sub_f32 v188, v188, v55
    v_sub_f32 v189, v189, v55
    v_sub_f32 v190, v190, v55
    v_sub_f32 v191, v191, v55
    v_sub_f32 v128, v128, v54
    v_sub_f32 v16, v16, v54
    v_sub_f32 v129, v129, v54
    v_sub_f32 v17, v17, v54
    v_sub_f32 v130, v130, v54
    v_sub_f32 v18, v18, v54
    v_sub_f32 v131, v131, v54
    v_sub_f32 v19, v19, v54
    v_sub_f32 v132, v132, v55
    v_sub_f32 v20, v20, v55
    v_sub_f32 v133, v133, v55
    v_sub_f32 v21, v21, v55
    v_sub_f32 v134, v134, v55
    v_sub_f32 v22, v22, v55
    v_sub_f32 v135, v135, v55
    v_sub_f32 v23, v23, v55
    v_sub_f32 v136, v136, v54
    v_sub_f32 v24, v24, v54
    v_sub_f32 v137, v137, v54
    v_sub_f32 v25, v25, v54
    v_sub_f32 v138, v138, v54
    v_sub_f32 v26, v26, v54
    v_sub_f32 v139, v139, v54
    v_sub_f32 v27, v27, v54
    v_sub_f32 v140, v140, v55
    v_sub_f32 v28, v28, v55
    v_sub_f32 v141, v141, v55
    v_sub_f32 v29, v29, v55
    v_sub_f32 v142, v142, v55
    v_sub_f32 v30, v30, v55
    v_sub_f32 v143, v143, v55
    v_sub_f32 v31, v31, v55
    v_sub_f32 v144, v144, v54
    v_sub_f32 v32, v32, v54
    v_sub_f32 v145, v145, v54
    v_sub_f32 v33, v33, v54
    v_sub_f32 v146, v146, v54
    v_sub_f32 v34, v34, v54
    v_sub_f32 v147, v147, v54
    v_sub_f32 v35, v35, v54
    v_sub_f32 v148, v148, v55
    v_sub_f32 v36, v36, v55
    v_sub_f32 v149, v149, v55
    v_sub_f32 v37, v37, v55
    v_sub_f32 v150, v150, v55
    v_sub_f32 v38, v38, v55
    v_sub_f32 v151, v151, v55
    v_sub_f32 v39, v39, v55
    v_sub_f32 v152, v152, v54
    v_sub_f32 v40, v40, v54
    v_sub_f32 v153, v153, v54
    v_sub_f32 v41, v41, v54
    v_sub_f32 v154, v154, v54
    v_sub_f32 v42, v42, v54
    v_sub_f32 v155, v155, v54
    v_sub_f32 v43, v43, v54
    v_sub_f32 v156, v156, v55
    v_sub_f32 v44, v44, v55
    v_sub_f32 v157, v157, v55
    v_sub_f32 v45, v45, v55
    v_sub_f32 v158, v158, v55
    v_sub_f32 v46, v46, v55
    v_sub_f32 v159, v159, v55
    v_sub_f32 v47, v47, v55
    v_sub_f32 v10, v10, v54
    v_exp_f32 v54, -v54
    v_sub_f32 v11, v11, v55
    v_exp_f32 v55, -v55
    s_nop 0
    v_mul_f32 v248, v248, v54
    v_mul_f32 v252, v252, v55
    v_accvgpr_read_b32 v224, a8
    v_accvgpr_read_b32 v225, a9
    v_accvgpr_read_b32 v226, a10
    v_accvgpr_read_b32 v227, a11
    v_mul_f32 v224, v224, v54
    v_mul_f32 v225, v225, v54
    v_mul_f32 v226, v226, v54
    v_mul_f32 v227, v227, v54
    v_accvgpr_write_b32 a8, v224
    v_accvgpr_write_b32 a9, v225
    v_accvgpr_write_b32 a10, v226
    v_accvgpr_write_b32 a11, v227
    v_accvgpr_read_b32 v224, a12
    v_accvgpr_read_b32 v225, a13
    v_accvgpr_read_b32 v226, a14
    v_accvgpr_read_b32 v227, a15
    v_mul_f32 v224, v224, v55
    v_mul_f32 v225, v225, v55
    v_mul_f32 v226, v226, v55
    v_mul_f32 v227, v227, v55
    v_accvgpr_write_b32 a12, v224
    v_accvgpr_write_b32 a13, v225
    v_accvgpr_write_b32 a14, v226
    v_accvgpr_write_b32 a15, v227
    v_accvgpr_read_b32 v224, a24
    v_accvgpr_read_b32 v225, a25
    v_accvgpr_read_b32 v226, a26
    v_accvgpr_read_b32 v227, a27
    v_mul_f32 v224, v224, v54
    v_mul_f32 v225, v225, v54
    v_mul_f32 v226, v226, v54
    v_mul_f32 v227, v227, v54
    v_accvgpr_write_b32 a24, v224
    v_accvgpr_write_b32 a25, v225
    v_accvgpr_write_b32 a26, v226
    v_accvgpr_write_b32 a27, v227
    v_accvgpr_read_b32 v224, a28
    v_accvgpr_read_b32 v225, a29
    v_accvgpr_read_b32 v226, a30
    v_accvgpr_read_b32 v227, a31
    v_mul_f32 v224, v224, v55
    v_mul_f32 v225, v225, v55
    v_mul_f32 v226, v226, v55
    v_mul_f32 v227, v227, v55
    v_accvgpr_write_b32 a28, v224
    v_accvgpr_write_b32 a29, v225
    v_accvgpr_write_b32 a30, v226
    v_accvgpr_write_b32 a31, v227
    v_accvgpr_read_b32 v224, a40
    v_accvgpr_read_b32 v225, a41
    v_accvgpr_read_b32 v226, a42
    v_accvgpr_read_b32 v227, a43
    v_mul_f32 v224, v224, v54
    v_mul_f32 v225, v225, v54
    v_mul_f32 v226, v226, v54
    v_mul_f32 v227, v227, v54
    v_accvgpr_write_b32 a40, v224
    v_accvgpr_write_b32 a41, v225
    v_accvgpr_write_b32 a42, v226
    v_accvgpr_write_b32 a43, v227
    v_accvgpr_read_b32 v224, a44
    v_accvgpr_read_b32 v225, a45
    v_accvgpr_read_b32 v226, a46
    v_accvgpr_read_b32 v227, a47
    v_mul_f32 v224, v224, v55
    v_mul_f32 v225, v225, v55
    v_mul_f32 v226, v226, v55
    v_mul_f32 v227, v227, v55
    v_accvgpr_write_b32 a44, v224
    v_accvgpr_write_b32 a45, v225
    v_accvgpr_write_b32 a46, v226
    v_accvgpr_write_b32 a47, v227
    v_accvgpr_read_b32 v224, a56
    v_accvgpr_read_b32 v225, a57
    v_accvgpr_read_b32 v226, a58
    v_accvgpr_read_b32 v227, a59
    v_mul_f32 v224, v224, v54
    v_mul_f32 v225, v225, v54
    v_mul_f32 v226, v226, v54
    v_mul_f32 v227, v227, v54
    v_accvgpr_write_b32 a56, v224
    v_accvgpr_write_b32 a57, v225
    v_accvgpr_write_b32 a58, v226
    v_accvgpr_write_b32 a59, v227
    v_accvgpr_read_b32 v224, a60
    v_accvgpr_read_b32 v225, a61
    v_accvgpr_read_b32 v226, a62
    v_accvgpr_read_b32 v227, a63
    v_mul_f32 v224, v224, v55
    v_mul_f32 v225, v225, v55
    v_mul_f32 v226, v226, v55
    v_mul_f32 v227, v227, v55
    v_accvgpr_write_b32 a60, v224
    v_accvgpr_write_b32 a61, v225
    v_accvgpr_write_b32 a62, v226
    v_accvgpr_write_b32 a63, v227
    v_accvgpr_read_b32 v224, a72
    v_accvgpr_read_b32 v225, a73
    v_accvgpr_read_b32 v226, a74
    v_accvgpr_read_b32 v227, a75
    v_mul_f32 v224, v224, v54
    v_mul_f32 v225, v225, v54
    v_mul_f32 v226, v226, v54
    v_mul_f32 v227, v227, v54
    v_accvgpr_write_b32 a72, v224
    v_accvgpr_write_b32 a73, v225
    v_accvgpr_write_b32 a74, v226
    v_accvgpr_write_b32 a75, v227
    v_accvgpr_read_b32 v224, a76
    v_accvgpr_read_b32 v225, a77
    v_accvgpr_read_b32 v226, a78
    v_accvgpr_read_b32 v227, a79
    v_mul_f32 v224, v224, v55
    v_mul_f32 v225, v225, v55
    v_mul_f32 v226, v226, v55
    v_mul_f32 v227, v227, v55
    v_accvgpr_write_b32 a76, v224
    v_accvgpr_write_b32 a77, v225
    v_accvgpr_write_b32 a78, v226
    v_accvgpr_write_b32 a79, v227
    v_accvgpr_read_b32 v224, a88
    v_accvgpr_read_b32 v225, a89
    v_accvgpr_read_b32 v226, a90
    v_accvgpr_read_b32 v227, a91
    v_mul_f32 v224, v224, v54
    v_mul_f32 v225, v225, v54
    v_mul_f32 v226, v226, v54
    v_mul_f32 v227, v227, v54
    v_accvgpr_write_b32 a88, v224
    v_accvgpr_write_b32 a89, v225
    v_accvgpr_write_b32 a90, v226
    v_accvgpr_write_b32 a91, v227
    v_accvgpr_read_b32 v224, a92
    v_accvgpr_read_b32 v225, a93
    v_accvgpr_read_b32 v226, a94
    v_accvgpr_read_b32 v227, a95
    v_mul_f32 v224, v224, v55
    v_mul_f32 v225, v225, v55
    v_mul_f32 v226, v226, v55
    v_mul_f32 v227, v227, v55
    v_accvgpr_write_b32 a92, v224
    v_accvgpr_write_b32 a93, v225
    v_accvgpr_write_b32 a94, v226
    v_accvgpr_write_b32 a95, v227
    v_accvgpr_read_b32 v224, a104
    v_accvgpr_read_b32 v225, a105
    v_accvgpr_read_b32 v226, a106
    v_accvgpr_read_b32 v227, a107
    v_mul_f32 v224, v224, v54
    v_mul_f32 v225, v225, v54
    v_mul_f32 v226, v226, v54
    v_mul_f32 v227, v227, v54
    v_accvgpr_write_b32 a104, v224
    v_accvgpr_write_b32 a105, v225
    v_accvgpr_write_b32 a106, v226
    v_accvgpr_write_b32 a107, v227
    v_accvgpr_read_b32 v224, a108
    v_accvgpr_read_b32 v225, a109
    v_accvgpr_read_b32 v226, a110
    v_accvgpr_read_b32 v227, a111
    v_mul_f32 v224, v224, v55
    v_mul_f32 v225, v225, v55
    v_mul_f32 v226, v226, v55
    v_mul_f32 v227, v227, v55
    v_accvgpr_write_b32 a108, v224
    v_accvgpr_write_b32 a109, v225
    v_accvgpr_write_b32 a110, v226
    v_accvgpr_write_b32 a111, v227
    v_accvgpr_read_b32 v224, a120
    v_accvgpr_read_b32 v225, a121
    v_accvgpr_read_b32 v226, a122
    v_accvgpr_read_b32 v227, a123
    v_mul_f32 v224, v224, v54
    v_mul_f32 v225, v225, v54
    v_mul_f32 v226, v226, v54
    v_mul_f32 v227, v227, v54
    v_accvgpr_write_b32 a120, v224
    v_accvgpr_write_b32 a121, v225
    v_accvgpr_write_b32 a122, v226
    v_accvgpr_write_b32 a123, v227
    v_accvgpr_read_b32 v224, a124
    v_accvgpr_read_b32 v225, a125
    v_accvgpr_read_b32 v226, a126
    v_accvgpr_read_b32 v227, a127
    v_mul_f32 v224, v224, v55
    v_mul_f32 v225, v225, v55
    v_mul_f32 v226, v226, v55
    v_mul_f32 v227, v227, v55
    v_accvgpr_write_b32 a124, v224
    v_accvgpr_write_b32 a125, v225
    v_accvgpr_write_b32 a126, v226
    v_accvgpr_write_b32 a127, v227
    v_exp_f32 v232, v160
    v_exp_f32 v233, v161
    v_exp_f32 v234, v162
    v_exp_f32 v235, v163
    s_nop 0
    v_cvt_pk_bf16_f32 v208, v232, v233
    v_cvt_pk_bf16_f32 v209, v234, v235
    v_exp_f32 v232, v176
    v_exp_f32 v233, v177
    v_exp_f32 v234, v178
    v_exp_f32 v235, v179
    s_nop 0
    v_cvt_pk_bf16_f32 v210, v232, v233
    v_cvt_pk_bf16_f32 v211, v234, v235
    v_exp_f32 v232, v164
    v_exp_f32 v233, v165
    v_exp_f32 v234, v166
    v_exp_f32 v235, v167
    s_nop 0
    v_cvt_pk_bf16_f32 v212, v232, v233
    v_cvt_pk_bf16_f32 v213, v234, v235
    v_exp_f32 v232, v180
    v_exp_f32 v233, v181
    v_exp_f32 v234, v182
    v_exp_f32 v235, v183
    s_nop 0
    v_cvt_pk_bf16_f32 v214, v232, v233
    v_cvt_pk_bf16_f32 v215, v234, v235
    v_exp_f32 v232, v168
    v_exp_f32 v233, v169
    v_exp_f32 v234, v170
    v_exp_f32 v235, v171
    s_nop 0
    v_cvt_pk_bf16_f32 v216, v232, v233
    v_cvt_pk_bf16_f32 v217, v234, v235
    v_exp_f32 v232, v184
    v_exp_f32 v233, v185
    v_exp_f32 v234, v186
    v_exp_f32 v235, v187
    s_nop 0
    v_cvt_pk_bf16_f32 v218, v232, v233
    v_cvt_pk_bf16_f32 v219, v234, v235
    v_exp_f32 v232, v172
    v_exp_f32 v233, v173
    v_exp_f32 v234, v174
    v_exp_f32 v235, v175
    s_nop 0
    v_cvt_pk_bf16_f32 v220, v232, v233
    v_cvt_pk_bf16_f32 v221, v234, v235
    v_exp_f32 v232, v188
    v_exp_f32 v233, v189
    v_exp_f32 v234, v190
    v_exp_f32 v235, v191
    s_nop 0
    v_cvt_pk_bf16_f32 v222, v232, v233
    v_cvt_pk_bf16_f32 v223, v234, v235
    s_nop 3
    s_setpc_b64 s[40:41]
k2_rare_165:
    s_nop 7
    v_max_f32 v55, v164, v165
    v_max3_f32 v55, v55, v166, v167
    v_max3_f32 v55, v55, v180, v181
    v_max3_f32 v55, v55, v182, v183
    v_max3_f32 v55, v55, v172, v173
    v_max3_f32 v55, v55, v174, v175
    v_max3_f32 v55, v55, v188, v189
    v_max3_f32 v55, v55, v190, v191
    v_mov_b32 v227, v55
    s_nop 1
    v_permlane16_swap_b32 v55, v227
    s_nop 1
    v_max_f32 v55, v55, v227
    v_mov_b32 v227, v55
    s_nop 1
    v_permlane32_swap_b32 v55, v227
    s_nop 1
    v_max_f32 v55, v55, v227
    v_add_f32 v55, 0x41400000, v55
    v_max_f32 v55, 0, v55
    v_sub_f32 v164, v164, v55
    v_sub_f32 v165, v165, v55
    v_sub_f32 v166, v166, v55
    v_sub_f32 v167, v167, v55
    v_sub_f32 v172, v172, v55
    v_sub_f32 v173, v173, v55
    v_sub_f32 v174, v174, v55
    v_sub_f32 v175, v175, v55
    v_sub_f32 v180, v180, v55
    v_sub_f32 v181, v181, v55
    v_sub_f32 v182, v182, v55
    v_sub_f32 v183, v183, v55
    v_sub_f32 v188, v188, v55
    v_sub_f32 v189, v189, v55
    v_sub_f32 v190, v190, v55
    v_sub_f32 v191, v191, v55
    v_sub_f32 v11, v11, v55
    v_exp_f32 v55, -v55
    s_nop 0
    v_mul_f32 v252, v252, v55
    v_accvgpr_read_b32 v224, a12
    v_accvgpr_read_b32 v225, a13
    v_accvgpr_read_b32 v226, a14
    v_accvgpr_read_b32 v227, a15
    v_mul_f32 v224, v224, v55
    v_mul_f32 v225, v225, v55
    v_mul_f32 v226, v226, v55
    v_mul_f32 v227, v227, v55
    v_accvgpr_write_b32 a12, v224
    v_accvgpr_write_b32 a13, v225
    v_accvgpr_write_b32 a14, v226
    v_accvgpr_write_b32 a15, v227
    v_accvgpr_read_b32 v224, a28
    v_accvgpr_read_b32 v225, a29
    v_accvgpr_read_b32 v226, a30
    v_accvgpr_read_b32 v227, a31
    v_mul_f32 v224, v224, v55
    v_mul_f32 v225, v225, v55
    v_mul_f32 v226, v226, v55
    v_mul_f32 v227, v227, v55
    v_accvgpr_write_b32 a28, v224
    v_accvgpr_write_b32 a29, v225
    v_accvgpr_write_b32 a30, v226
    v_accvgpr_write_b32 a31, v227
    v_accvgpr_read_b32 v224, a44
    v_accvgpr_read_b32 v225, a45
    v_accvgpr_read_b32 v226, a46
    v_accvgpr_read_b32 v227, a47
    v_mul_f32 v224, v224, v55
    v_mul_f32 v225, v225, v55
    v_mul_f32 v226, v226, v55
    v_mul_f32 v227, v227, v55
    v_accvgpr_write_b32 a44, v224
    v_accvgpr_write_b32 a45, v225
    v_accvgpr_write_b32 a46, v226
    v_accvgpr_write_b32 a47, v227
    v_accvgpr_read_b32 v224, a60
    v_accvgpr_read_b32 v225, a61
    v_accvgpr_read_b32 v226, a62
    v_accvgpr_read_b32 v227, a63
    v_mul_f32 v224, v224, v55
    v_mul_f32 v225, v225, v55
    v_mul_f32 v226, v226, v55
    v_mul_f32 v227, v227, v55
    v_accvgpr_write_b32 a60, v224
    v_accvgpr_write_b32 a61, v225
    v_accvgpr_write_b32 a62, v226
    v_accvgpr_write_b32 a63, v227
    v_accvgpr_read_b32 v224, a76
    v_accvgpr_read_b32 v225, a77
    v_accvgpr_read_b32 v226, a78
    v_accvgpr_read_b32 v227, a79
    v_mul_f32 v224, v224, v55
    v_mul_f32 v225, v225, v55
    v_mul_f32 v226, v226, v55
    v_mul_f32 v227, v227, v55
    v_accvgpr_write_b32 a76, v224
    v_accvgpr_write_b32 a77, v225
    v_accvgpr_write_b32 a78, v226
    v_accvgpr_write_b32 a79, v227
    v_accvgpr_read_b32 v224, a92
    v_accvgpr_read_b32 v225, a93
    v_accvgpr_read_b32 v226, a94
    v_accvgpr_read_b32 v227, a95
    v_mul_f32 v224, v224, v55
    v_mul_f32 v225, v225, v55
    v_mul_f32 v226, v226, v55
    v_mul_f32 v227, v227, v55
    v_accvgpr_write_b32 a92, v224
    v_accvgpr_write_b32 a93, v225
    v_accvgpr_write_b32 a94, v226
    v_accvgpr_write_b32 a95, v227
    v_accvgpr_read_b32 v224, a108
    v_accvgpr_read_b32 v225, a109
    v_accvgpr_read_b32 v226, a110
    v_accvgpr_read_b32 v227, a111
    v_mul_f32 v224, v224, v55
    v_mul_f32 v225, v225, v55
    v_mul_f32 v226, v226, v55
    v_mul_f32 v227, v227, v55
    v_accvgpr_write_b32 a108, v224
    v_accvgpr_write_b32 a109, v225
    v_accvgpr_write_b32 a110, v226
    v_accvgpr_write_b32 a111, v227
    v_accvgpr_read_b32 v224, a124
    v_accvgpr_read_b32 v225, a125
    v_accvgpr_read_b32 v226, a126
    v_accvgpr_read_b32 v227, a127
    v_mul_f32 v224, v224, v55
    v_mul_f32 v225, v225, v55
    v_mul_f32 v226, v226, v55
    v_mul_f32 v227, v227, v55
    v_accvgpr_write_b32 a124, v224
    v_accvgpr_write_b32 a125, v225
    v_accvgpr_write_b32 a126, v226
    v_accvgpr_write_b32 a127, v227
    v_exp_f32 v232, v164
    v_exp_f32 v233, v165
    v_exp_f32 v234, v166
    v_exp_f32 v235, v167
    s_nop 0
    v_cvt_pk_bf16_f32 v212, v232, v233
    v_cvt_pk_bf16_f32 v213, v234, v235
    v_exp_f32 v232, v180
    v_exp_f32 v233, v181
    v_exp_f32 v234, v182
    v_exp_f32 v235, v183
    s_nop 0
    v_cvt_pk_bf16_f32 v214, v232, v233
    v_cvt_pk_bf16_f32 v215, v234, v235
    v_exp_f32 v232, v172
    v_exp_f32 v233, v173
    v_exp_f32 v234, v174
    v_exp_f32 v235, v175
    s_nop 0
    v_cvt_pk_bf16_f32 v220, v232, v233
    v_cvt_pk_bf16_f32 v221, v234, v235
    v_exp_f32 v232, v188
    v_exp_f32 v233, v189
    v_exp_f32 v234, v190
    v_exp_f32 v235, v191
    s_nop 0
    v_cvt_pk_bf16_f32 v222, v232, v233
    v_cvt_pk_bf16_f32 v223, v234, v235
    s_nop 3
    s_setpc_b64 s[40:41]
code_end:
    s_endpgm
.section .rodata,"a"
.p2align 6
.amdhsa_kernel sequential_preLN__compressed_kv_cla__moe_arch_mod__prompt_kernel
  .amdhsa_next_free_vgpr 512
  .amdhsa_next_free_sgpr 102
  .amdhsa_accum_offset 256
  .amdhsa_group_segment_fixed_size 0
  .amdhsa_kernarg_size 112
  .amdhsa_user_sgpr_count 2
  .amdhsa_user_sgpr_kernarg_segment_ptr 1
  .amdhsa_system_sgpr_workgroup_id_x 1
.end_amdhsa_kernel
```

```asm
; @launch grid=(256,1,1) block=(256,1,1) lds=163840
.amdgcn_target "amdgcn-amd-amdhsa--gfx950"
.text
.globl sequential_preLN__compressed_kv_cla__moe_arch_mod__prompt_kernel
.p2align 8
.type sequential_preLN__compressed_kv_cla__moe_arch_mod__prompt_kernel,@function
sequential_preLN__compressed_kv_cla__moe_arch_mod__prompt_kernel:
    s_cmp_ge_u32 s2, 256
    s_cbranch_scc1 k12_end_1
    s_load_dwordx4 s[36:39], s[0:1], 0
    s_load_dwordx4 s[40:43], s[0:1], 24
    s_load_dwordx2 s[4:5], s[0:1], 16
    s_load_dwordx4 s[60:63], s[0:1], 96
    s_lshr_b32 s59, s2, 3
    s_lshl_b32 s58, s59, 4
    v_add_u32 v6, s58, v0
    v_cmp_gt_u32 vcc, 48, v0
    v_cmp_gt_u32 s[56:57], 64, v0
    s_nop 0
    v_cndmask_b32 v6, v6, v0, vcc
    s_getpc_b64 s[52:53]
pc_2:
    s_add_u32 s52, s52, k12_code0-pc_2
    s_addc_u32 s53, s53, 0
    v_lshlrev_b32 v58, 7, v6
    v_mov_b32 v59, s53
    v_add_co_u32 v58, vcc, s52, v58
    s_nop 1
    v_addc_co_u32 v59, vcc, 0, v59, vcc
k12_code0:
    s_mov_b64 exec, s[56:57]
    s_cbranch_execz k12_nocode_3
    global_load_dword v51, v[58:59], off
k12_nocode_3:
    s_mov_b64 exec, -1
    s_and_b32 s58, s2, 7
    s_lshr_b32 s59, s2, 3
    s_and_b32 s45, s59, 7
    s_lshr_b32 s57, s59, 3
    s_and_b32 s44, s57, 1
    s_lshl_b32 s52, s58, 1
    s_add_u32 s44, s44, s52
    s_lshr_b32 s57, s57, 1
    v_lshrrev_b32 v2, 6, v0
    v_and_b32 v3, 63, v0
    v_readfirstlane_b32 s30, v2
    v_lshlrev_b32 v1, 4, v3
    v_lshrrev_b32 v60, 5, v3
    v_lshl_add_u32 v60, v2, 1, v60
    v_and_b32 v61, 31, v3
    v_lshlrev_b32 v6, 11, v60
    v_lshl_add_u32 v62, v61, 4, v6
    s_lshl_b32 s52, s2, 14
    v_lshrrev_b32 v56, 3, v3
    v_and_b32 v57, 7, v3
    v_lshrrev_b32 v58, 1, v56
    v_xor_b32 v6, v57, v58
    v_xor_b32 v7, 4, v6
    v_lshl_add_u32 v58, v2, 6, v56
    v_lshlrev_b32 v58, 10, v58
    s_lshl_b32 s47, s45, 18
    v_add_u32 v58, s47, v58
    v_lshl_add_u32 v10, v6, 4, v58
    v_lshl_add_u32 v11, v7, 4, v58
    v_add_u32 v17, 54272, v11
    v_add_u32 v16, 47104, v10
    v_add_u32 v15, 39936, v11
    v_add_u32 v14, 32768, v10
    v_add_u32 v13, 21504, v11
    v_add_u32 v12, 14336, v10
    v_add_u32 v11, 7168, v11
    v_add_u32 v10, 0, v10
    v_lshrrev_b32 v6, 5, v3
    v_bfe_u32 v7, v3, 1, 4
    v_and_b32 v59, 1, v3
    v_lshl_add_u32 v58, v2, 4, v6
    v_lshlrev_b32 v58, 13, v58
    v_lshl_add_u32 v58, v59, 4, v58
    s_lshl_b32 s47, s44, 9
    v_add_u32 v58, s47, v58
    v_xor_b32 v7, v7, v6
    v_xor_b32 v6, 0, v7
    v_lshl_add_u32 v6, v6, 5, v58
    v_add_u32 v18, 0, v6
    v_xor_b32 v6, 2, v7
    v_lshl_add_u32 v6, v6, 5, v58
    v_add_u32 v19, 15360, v6
    v_xor_b32 v6, 0, v7
    v_lshl_add_u32 v6, v6, 5, v58
    v_add_u32 v20, 30720, v6
    v_xor_b32 v6, 2, v7
    v_lshl_add_u32 v6, v6, 5, v58
    v_add_u32 v21, 46080, v6
    v_xor_b32 v6, 4, v7
    v_lshl_add_u32 v6, v6, 5, v58
    v_add_u32 v22, 65536, v6
    v_xor_b32 v6, 6, v7
    v_lshl_add_u32 v6, v6, 5, v58
    v_add_u32 v23, 80896, v6
    v_xor_b32 v6, 4, v7
    v_lshl_add_u32 v6, v6, 5, v58
    v_add_u32 v24, 96256, v6
    v_xor_b32 v6, 6, v7
    v_lshl_add_u32 v6, v6, 5, v58
    v_add_u32 v25, 111616, v6
    s_lshl_b32 s48, s30, 13
    s_mov_b32 s49, 0
    s_mov_b32 s50, 0
    s_waitcnt lgkmcnt(0)
    s_mov_b32 s24, s36
    s_and_b32 s25, s37, 0xffff
    s_mov_b32 s26, 0x400000
    s_mov_b32 s27, 0x00020000
    buffer_load_dwordx4 v[64:67], v62, s[24:27], s52 offen offset:0
    buffer_load_dwordx4 v[68:71], v62, s[24:27], s52 offen offset:512
    buffer_load_dwordx4 v[72:75], v62, s[24:27], s52 offen offset:1024
    buffer_load_dwordx4 v[76:79], v62, s[24:27], s52 offen offset:1536
    s_mov_b32 s16, s38
    s_and_b32 s17, s39, 0xffff
    s_mov_b32 s18, 0x200000
    s_mov_b32 s19, 0x00020000
    s_cmp_eq_u32 s57, 0
    s_cselect_b32 s20, s40, s42
    s_cselect_b32 s21, s41, s43
    s_and_b32 s21, s21, 0xffff
    s_mov_b32 s22, 0x400000
    s_mov_b32 s23, 0x00020000
    s_add_u32 m0, s48, 0
    s_nop 0
    buffer_load_dwordx4 v10, s[16:19], s49 offen offset:0 lds
    buffer_load_dwordx4 v11, s[16:19], s49 offen offset:1024 lds
    buffer_load_dwordx4 v12, s[16:19], s49 offen offset:2048 lds
    buffer_load_dwordx4 v13, s[16:19], s49 offen offset:3072 lds
    s_add_u32 m0, s48, 65536
    s_nop 0
    buffer_load_dwordx4 v18, s[20:23], s50 offen offset:0 lds
    buffer_load_dwordx4 v19, s[20:23], s50 offen offset:1024 lds
    buffer_load_dwordx4 v20, s[20:23], s50 offen offset:2048 lds
    buffer_load_dwordx4 v21, s[20:23], s50 offen offset:3072 lds
    s_mov_b64 s[6:7], s[62:63]
    s_add_u32 s8, s6, 0x0
    s_addc_u32 s9, s7, 0
    s_and_b32 s9, s9, 0xffff
    s_mov_b32 s10, 0x400000
    s_mov_b32 s11, 0x00020000
    s_mov_b32 s12, s4
    s_and_b32 s13, s5, 0xffff
    s_mov_b32 s14, 0x800000
    s_mov_b32 s15, 0x00020000
    s_add_u32 s32, s6, 0x1000000
    s_addc_u32 s33, s7, 0
    s_and_b32 s33, s33, 0xffff
    s_mov_b32 s34, 0x2000000
    s_mov_b32 s35, 0x00020000
    s_mov_b32 s24, s60
    s_and_b32 s25, s61, 0xffff
    s_mov_b32 s26, 0x100
    s_mov_b32 s27, 0x00020000
    s_lshl_b32 s28, s58, 2
    s_and_b32 s31, s59, 3
    s_add_u32 s28, s28, s31
    s_lshr_b32 s29, s59, 2
    s_lshl_b32 s42, s29, 7
    s_sub_u32 s43, 1920, s42
    s_lshl_b32 s31, s30, 4
    s_add_u32 s38, s42, s31
    s_add_u32 s39, s43, s31
    s_lshl_b32 s60, s30, 12
    s_mov_b32 s61, 0
    s_mov_b32 s62, 0
    s_lshl_b32 s47, s44, 1
    s_lshr_b32 s52, s30, 1
    s_add_u32 s47, s47, s52
    s_lshl_b32 s47, s47, 14
    s_lshl_b32 s52, s45, 1
    s_and_b32 s53, s30, 1
    s_add_u32 s52, s52, s53
    s_lshl_b32 s52, s52, 20
    s_add_u32 s47, s47, s52
    s_lshl_b32 s52, s57, 24
    s_add_u32 s47, s47, s52
    s_lshl_b32 s54, s44, 8
    s_lshr_b32 s55, s28, 1
    s_lshl_b32 s55, s55, 8
    s_and_b32 s53, s59, 3
    s_add_u32 s53, s53, 1
    s_cmp_eq_u32 s30, 0
    s_cselect_b32 s53, s53, -1
    s_cselect_b32 s46, 6, -1
    v_lshlrev_b32 v6, 13, v56
    v_lshl_add_u32 v50, v57, 7, v6
    s_lshl_b32 s56, s30, 5
    s_add_u32 s56, s56, s59
    s_lshl_b32 s56, s56, 16
    s_lshl_b32 s52, s58, 10
    s_add_u32 s56, s56, s52
    s_lshl_b32 s63, s30, 1
    v_mul_u32_u24 v6, 2064, v60
    v_lshl_add_u32 v6, v61, 4, v6
    v_add_u32 v54, 131072, v6
    v_mul_u32_u24 v7, 2064, v57
    v_lshl_add_u32 v7, v56, 4, v7
    v_lshl_add_u32 v7, v2, 9, v7
    v_add_u32 v55, 131072, v7
    v_lshrrev_b32 v7, 2, v56
    v_lshl_add_u32 v7, v2, 3, v7
    v_lshlrev_b32 v7, 17, v7
    v_and_b32 v6, 3, v56
    v_lshl_add_u32 v7, v6, 8, v7
    v_lshl_add_u32 v7, v57, 4, v7
    s_lshr_b32 s52, s2, 1
    s_lshl_b32 s52, s52, 10
    s_and_b32 s31, s2, 1
    s_lshl_b32 s31, s31, 7
    s_add_u32 s52, s52, s31
    v_add_u32 v53, s52, v7
    v_and_b32 v56, 15, v3
    v_lshrrev_b32 v57, 4, v3
    v_lshrrev_b32 v6, 1, v56
    v_xor_b32 v6, v6, v57
    v_and_b32 v7, 1, v2
    v_lshl_add_u32 v7, v7, 7, v56
    v_lshlrev_b32 v7, 7, v7
    v_lshl_add_u32 v26, v6, 4, v7
    v_xor_b32 v27, 64, v26
    v_lshrrev_b32 v6, 2, v56
    v_and_b32 v58, 1, v57
    v_lshl_add_u32 v58, v58, 2, v6
    v_lshl_add_u32 v59, v57, 3, v6
    v_and_b32 v63, 3, v3
    v_lshlrev_b32 v7, 9, v59
    v_lshrrev_b32 v6, 1, v2
    v_lshl_add_u32 v7, v6, 8, v7
    v_lshl_add_u32 v7, v63, 3, v7
    v_add_u32 v7, 65536, v7
    v_lshlrev_b32 v59, 8, v59
    v_lshl_add_u32 v59, v63, 3, v59
    v_add_u32 v59, 98304, v59
    v_xor_b32 v6, 0, v58
    v_lshl_add_u32 v28, v6, 5, v7
    v_lshl_add_u32 v42, v6, 5, v59
    v_xor_b32 v6, 1, v58
    v_lshl_add_u32 v29, v6, 5, v7
    v_lshl_add_u32 v43, v6, 5, v59
    v_xor_b32 v6, 2, v58
    v_lshl_add_u32 v30, v6, 5, v7
    v_lshl_add_u32 v44, v6, 5, v59
    v_xor_b32 v6, 3, v58
    v_lshl_add_u32 v31, v6, 5, v7
    v_lshl_add_u32 v45, v6, 5, v59
    v_xor_b32 v6, 4, v58
    v_lshl_add_u32 v32, v6, 5, v7
    v_lshl_add_u32 v46, v6, 5, v59
    v_xor_b32 v6, 5, v58
    v_lshl_add_u32 v33, v6, 5, v7
    v_lshl_add_u32 v47, v6, 5, v59
    v_xor_b32 v6, 6, v58
    v_lshl_add_u32 v34, v6, 5, v7
    v_lshl_add_u32 v48, v6, 5, v59
    v_xor_b32 v6, 7, v58
    v_lshl_add_u32 v35, v6, 5, v7
    v_lshl_add_u32 v49, v6, 5, v59
    s_lshl_b32 s31, s38, 6
    v_add_u32 v36, s31, v1
    s_lshl_b32 s31, s39, 6
    v_add_u32 v37, s31, v1
    v_bfe_u32 v6, v3, 1, 3
    v_and_b32 v7, 1, v3
    v_lshl_add_u32 v58, v2, 4, v57
    v_lshlrev_b32 v58, 13, v58
    v_lshl_add_u32 v58, v7, 4, v58
    s_lshl_b32 s31, s28, 8
    v_add_u32 v58, s31, v58
    v_xor_b32 v6, v6, v57
    v_xor_b32 v7, 0, v6
    v_lshl_add_u32 v7, v7, 5, v58
    v_add_u32 v38, 0, v7
    v_xor_b32 v7, 0, v6
    v_lshl_add_u32 v7, v7, 5, v58
    v_add_u32 v39, 31744, v7
    v_xor_b32 v7, 4, v6
    v_lshl_add_u32 v7, v7, 5, v58
    v_add_u32 v40, 63488, v7
    v_xor_b32 v7, 4, v6
    v_lshl_add_u32 v7, v7, 5, v58
    v_add_u32 v41, 95232, v7
    v_lshlrev_b32 v6, 2, v57
    v_sub_u32 v4, v56, v6
    v_mov_b32 v5, 0xff800000
    v_mov_b32 v8, 0
    v_mov_b32 v9, 1
    s_lshl_b32 s52, s59, 2
    s_add_u32 s52, s52, s30
    v_and_b32 v6, 1, v3
    v_lshl_add_u32 v6, s52, 1, v6
    s_getpc_b64 s[40:41]
pc_4:
    s_add_u32 s40, s40, k12_qcode-pc_4
    s_addc_u32 s41, s41, 0
    v_lshlrev_b32 v2, 7, v6
    v_mov_b32 v3, s41
    v_add_co_u32 v2, vcc, s40, v2
    s_nop 1
    v_addc_co_u32 v3, vcc, 0, v3, vcc
    v_mov_b32 v56, 0
    v_mov_b32 v57, 0
    v_mov_b32 v58, 0
    v_mov_b32 v59, 0
    s_nop 1
    v_mfma_f32_32x32x16_bf16 a[128:143], v[56:59], v[56:59], 0
    v_mfma_f32_32x32x16_bf16 a[144:159], v[56:59], v[56:59], 0
    v_mfma_f32_32x32x16_bf16 a[160:175], v[56:59], v[56:59], 0
    v_mfma_f32_32x32x16_bf16 a[176:191], v[56:59], v[56:59], 0
    v_mfma_f32_32x32x16_bf16 v[128:143], v[56:59], v[56:59], 0
    v_mfma_f32_32x32x16_bf16 v[144:159], v[56:59], v[56:59], 0
    v_mfma_f32_32x32x16_bf16 v[160:175], v[56:59], v[56:59], 0
    v_mfma_f32_32x32x16_bf16 v[176:191], v[56:59], v[56:59], 0
    v_mfma_f32_32x32x16_bf16 v[192:207], v[56:59], v[56:59], 0
    v_mfma_f32_32x32x16_bf16 v[208:223], v[56:59], v[56:59], 0
    v_mfma_f32_32x32x16_bf16 v[224:239], v[56:59], v[56:59], 0
    v_mfma_f32_32x32x16_bf16 v[240:255], v[56:59], v[56:59], 0
    s_add_u32 m0, s48, 4096
    s_nop 0
    buffer_load_dwordx4 v14, s[16:19], s49 offen offset:0 lds
    buffer_load_dwordx4 v15, s[16:19], s49 offen offset:1024 lds
    buffer_load_dwordx4 v16, s[16:19], s49 offen offset:2048 lds
    buffer_load_dwordx4 v17, s[16:19], s49 offen offset:3072 lds
    s_add_u32 s49, s49, 128
    s_add_u32 m0, s48, 69632
    s_nop 0
    buffer_load_dwordx4 v22, s[20:23], s50 offen offset:0 lds
    buffer_load_dwordx4 v23, s[20:23], s50 offen offset:1024 lds
    buffer_load_dwordx4 v24, s[20:23], s50 offen offset:2048 lds
    buffer_load_dwordx4 v25, s[20:23], s50 offen offset:3072 lds
    s_add_u32 s50, s50, 0x80000
    s_waitcnt vmcnt(16)
    v_lshlrev_b32 v80, 16, v64
    v_and_b32 v81, 0xffff0000, v64
    v_lshlrev_b32 v82, 16, v65
    v_and_b32 v83, 0xffff0000, v65
    v_lshlrev_b32 v84, 16, v66
    v_and_b32 v85, 0xffff0000, v66
    v_lshlrev_b32 v86, 16, v67
    v_and_b32 v87, 0xffff0000, v67
    v_lshlrev_b32 v88, 16, v68
    v_and_b32 v89, 0xffff0000, v68
    v_lshlrev_b32 v90, 16, v69
    v_and_b32 v91, 0xffff0000, v69
    v_lshlrev_b32 v92, 16, v70
    v_and_b32 v93, 0xffff0000, v70
    v_lshlrev_b32 v94, 16, v71
    v_and_b32 v95, 0xffff0000, v71
    v_lshlrev_b32 v96, 16, v72
    v_and_b32 v97, 0xffff0000, v72
    v_lshlrev_b32 v98, 16, v73
    v_and_b32 v99, 0xffff0000, v73
    v_lshlrev_b32 v100, 16, v74
    v_and_b32 v101, 0xffff0000, v74
    v_lshlrev_b32 v102, 16, v75
    v_and_b32 v103, 0xffff0000, v75
    v_lshlrev_b32 v104, 16, v76
    v_and_b32 v105, 0xffff0000, v76
    v_lshlrev_b32 v106, 16, v77
    v_and_b32 v107, 0xffff0000, v77
    v_lshlrev_b32 v108, 16, v78
    v_and_b32 v109, 0xffff0000, v78
    v_lshlrev_b32 v110, 16, v79
    v_and_b32 v111, 0xffff0000, v79
    v_pk_add_f32 v[112:113], v[80:81], v[82:83]
    v_pk_add_f32 v[114:115], v[84:85], v[86:87]
    v_pk_add_f32 v[112:113], v[112:113], v[88:89]
    v_pk_add_f32 v[114:115], v[114:115], v[90:91]
    v_pk_add_f32 v[112:113], v[112:113], v[92:93]
    v_pk_add_f32 v[114:115], v[114:115], v[94:95]
    v_pk_add_f32 v[112:113], v[112:113], v[96:97]
    v_pk_add_f32 v[114:115], v[114:115], v[98:99]
    v_pk_add_f32 v[112:113], v[112:113], v[100:101]
    v_pk_add_f32 v[114:115], v[114:115], v[102:103]
    v_pk_add_f32 v[112:113], v[112:113], v[104:105]
    v_pk_add_f32 v[114:115], v[114:115], v[106:107]
    s_add_u32 m0, s48, 32768
    s_nop 0
    buffer_load_dwordx4 v10, s[16:19], s49 offen offset:0 lds
    buffer_load_dwordx4 v11, s[16:19], s49 offen offset:1024 lds
    buffer_load_dwordx4 v12, s[16:19], s49 offen offset:2048 lds
    buffer_load_dwordx4 v13, s[16:19], s49 offen offset:3072 lds
    v_pk_add_f32 v[112:113], v[112:113], v[108:109]
    v_pk_add_f32 v[114:115], v[114:115], v[110:111]
    v_pk_add_f32 v[112:113], v[112:113], v[114:115]
    v_add_f32 v112, v112, v113
    s_nop 1
    v_add_f32_dpp v112, v112, v112 quad_perm:[1,0,3,2] row_mask:0xf bank_mask:0xf
    s_nop 1
    v_add_f32_dpp v112, v112, v112 quad_perm:[2,3,0,1] row_mask:0xf bank_mask:0xf
    s_nop 1
    v_add_f32_dpp v112, v112, v112 row_half_mirror row_mask:0xf bank_mask:0xf
    s_nop 1
    v_add_f32_dpp v112, v112, v112 row_mirror row_mask:0xf bank_mask:0xf
    v_mov_b32 v114, v112
    s_nop 1
    v_permlane16_swap_b32 v112, v114
    s_nop 1
    v_add_f32 v112, v112, v114
    v_mul_f32 v112, 0xba800000, v112
    v_mov_b32 v113, v112
    v_pk_add_f32 v[114:115], v[80:81], v[112:113]
    v_pk_add_f32 v[118:119], v[82:83], v[112:113]
    v_pk_mul_f32 v[116:117], v[114:115], v[114:115]
    v_pk_fma_f32 v[116:117], v[118:119], v[118:119], v[116:117]
    v_pk_add_f32 v[114:115], v[84:85], v[112:113]
    v_pk_add_f32 v[118:119], v[86:87], v[112:113]
    v_pk_fma_f32 v[116:117], v[114:115], v[114:115], v[116:117]
    v_pk_fma_f32 v[116:117], v[118:119], v[118:119], v[116:117]
    v_pk_add_f32 v[114:115], v[88:89], v[112:113]
    v_pk_add_f32 v[118:119], v[90:91], v[112:113]
    v_pk_fma_f32 v[116:117], v[114:115], v[114:115], v[116:117]
    v_pk_fma_f32 v[116:117], v[118:119], v[118:119], v[116:117]
    v_pk_add_f32 v[114:115], v[92:93], v[112:113]
    v_pk_add_f32 v[118:119], v[94:95], v[112:113]
    v_pk_fma_f32 v[116:117], v[114:115], v[114:115], v[116:117]
    v_pk_fma_f32 v[116:117], v[118:119], v[118:119], v[116:117]
    v_pk_add_f32 v[114:115], v[96:97], v[112:113]
    v_pk_add_f32 v[118:119], v[98:99], v[112:113]
    v_pk_fma_f32 v[116:117], v[114:115], v[114:115], v[116:117]
    v_pk_fma_f32 v[116:117], v[118:119], v[118:119], v[116:117]
    v_pk_add_f32 v[114:115], v[100:101], v[112:113]
    v_pk_add_f32 v[118:119], v[102:103], v[112:113]
    v_pk_fma_f32 v[116:117], v[114:115], v[114:115], v[116:117]
    v_pk_fma_f32 v[116:117], v[118:119], v[118:119], v[116:117]
    v_pk_add_f32 v[114:115], v[104:105], v[112:113]
    s_add_u32 m0, s48, 98304
    s_nop 0
    buffer_load_dwordx4 v18, s[20:23], s50 offen offset:0 lds
    buffer_load_dwordx4 v19, s[20:23], s50 offen offset:1024 lds
    buffer_load_dwordx4 v20, s[20:23], s50 offen offset:2048 lds
    buffer_load_dwordx4 v21, s[20:23], s50 offen offset:3072 lds
    v_pk_add_f32 v[118:119], v[106:107], v[112:113]
    v_pk_fma_f32 v[116:117], v[114:115], v[114:115], v[116:117]
    v_pk_fma_f32 v[116:117], v[118:119], v[118:119], v[116:117]
    v_pk_add_f32 v[114:115], v[108:109], v[112:113]
    v_pk_add_f32 v[118:119], v[110:111], v[112:113]
    v_pk_fma_f32 v[116:117], v[114:115], v[114:115], v[116:117]
    v_pk_fma_f32 v[116:117], v[118:119], v[118:119], v[116:117]
    v_add_f32 v116, v116, v117
    s_nop 1
    v_add_f32_dpp v116, v116, v116 quad_perm:[1,0,3,2] row_mask:0xf bank_mask:0xf
    s_nop 1
    v_add_f32_dpp v116, v116, v116 quad_perm:[2,3,0,1] row_mask:0xf bank_mask:0xf
    s_nop 1
    v_add_f32_dpp v116, v116, v116 row_half_mirror row_mask:0xf bank_mask:0xf
    s_nop 1
    v_add_f32_dpp v116, v116, v116 row_mirror row_mask:0xf bank_mask:0xf
    v_mov_b32 v114, v116
    s_nop 1
    v_permlane16_swap_b32 v116, v114
    s_nop 1
    v_add_f32 v116, v116, v114
    v_mul_f32 v116, 0x3a800000, v116
    v_cvt_pk_bf16_f32 v118, v112, v116
    v_and_b32 v116, 0xffff0000, v118
    v_lshlrev_b32 v118, 16, v118
    v_add_f32 v116, 0x3727c5ac, v116
    v_mov_b32 v119, v118
    v_cvt_pk_bf16_f32 v116, v116, v116
    v_and_b32 v116, 0xffff0000, v116
    v_sqrt_f32 v116, v116
    v_pk_add_f32 v[80:81], v[80:81], v[118:119]
    v_pk_add_f32 v[82:83], v[82:83], v[118:119]
    v_pk_add_f32 v[84:85], v[84:85], v[118:119]
    v_pk_add_f32 v[86:87], v[86:87], v[118:119]
    v_pk_add_f32 v[88:89], v[88:89], v[118:119]
    v_pk_add_f32 v[90:91], v[90:91], v[118:119]
    v_pk_add_f32 v[92:93], v[92:93], v[118:119]
    v_pk_add_f32 v[94:95], v[94:95], v[118:119]
    v_pk_add_f32 v[96:97], v[96:97], v[118:119]
    v_pk_add_f32 v[98:99], v[98:99], v[118:119]
    v_pk_add_f32 v[100:101], v[100:101], v[118:119]
    v_pk_add_f32 v[102:103], v[102:103], v[118:119]
    v_pk_add_f32 v[104:105], v[104:105], v[118:119]
    s_add_u32 m0, s48, 36864
    s_nop 0
    buffer_load_dwordx4 v14, s[16:19], s49 offen offset:0 lds
    buffer_load_dwordx4 v15, s[16:19], s49 offen offset:1024 lds
    buffer_load_dwordx4 v16, s[16:19], s49 offen offset:2048 lds
    buffer_load_dwordx4 v17, s[16:19], s49 offen offset:3072 lds
    s_add_u32 s49, s49, 128
    v_pk_add_f32 v[106:107], v[106:107], v[118:119]
    v_pk_add_f32 v[108:109], v[108:109], v[118:119]
    v_pk_add_f32 v[110:111], v[110:111], v[118:119]
    v_cvt_pk_bf16_f32 v116, v116, v116
    v_and_b32 v116, 0xffff0000, v116
    v_rcp_f32 v116, v116
    v_cvt_pk_bf16_f32 v64, v80, v81
    v_cvt_pk_bf16_f32 v65, v82, v83
    v_cvt_pk_bf16_f32 v66, v84, v85
    v_cvt_pk_bf16_f32 v67, v86, v87
    v_cvt_pk_bf16_f32 v68, v88, v89
    v_cvt_pk_bf16_f32 v69, v90, v91
    v_cvt_pk_bf16_f32 v70, v92, v93
    v_cvt_pk_bf16_f32 v71, v94, v95
    v_cvt_pk_bf16_f32 v72, v96, v97
    v_cvt_pk_bf16_f32 v73, v98, v99
    v_cvt_pk_bf16_f32 v74, v100, v101
    v_cvt_pk_bf16_f32 v75, v102, v103
    v_cvt_pk_bf16_f32 v76, v104, v105
    v_cvt_pk_bf16_f32 v77, v106, v107
    v_cvt_pk_bf16_f32 v78, v108, v109
    v_cvt_pk_bf16_f32 v79, v110, v111
    v_mov_b32 v117, v116
    v_lshlrev_b32 v80, 16, v64
    v_and_b32 v81, 0xffff0000, v64
    v_lshlrev_b32 v82, 16, v65
    v_and_b32 v83, 0xffff0000, v65
    v_lshlrev_b32 v84, 16, v66
    v_and_b32 v85, 0xffff0000, v66
    v_lshlrev_b32 v86, 16, v67
    v_and_b32 v87, 0xffff0000, v67
    v_lshlrev_b32 v88, 16, v68
    v_and_b32 v89, 0xffff0000, v68
    v_lshlrev_b32 v90, 16, v69
    v_and_b32 v91, 0xffff0000, v69
    v_lshlrev_b32 v92, 16, v70
    v_and_b32 v93, 0xffff0000, v70
    v_lshlrev_b32 v94, 16, v71
    v_and_b32 v95, 0xffff0000, v71
    v_lshlrev_b32 v96, 16, v72
    v_and_b32 v97, 0xffff0000, v72
    v_lshlrev_b32 v98, 16, v73
    v_and_b32 v99, 0xffff0000, v73
    v_lshlrev_b32 v100, 16, v74
    s_add_u32 m0, s48, 102400
    s_nop 0
    buffer_load_dwordx4 v22, s[20:23], s50 offen offset:0 lds
    buffer_load_dwordx4 v23, s[20:23], s50 offen offset:1024 lds
    buffer_load_dwordx4 v24, s[20:23], s50 offen offset:2048 lds
    buffer_load_dwordx4 v25, s[20:23], s50 offen offset:3072 lds
    s_add_u32 s50, s50, 0x80000
    v_and_b32 v101, 0xffff0000, v74
    v_lshlrev_b32 v102, 16, v75
    v_and_b32 v103, 0xffff0000, v75
    v_lshlrev_b32 v104, 16, v76
    v_and_b32 v105, 0xffff0000, v76
    v_lshlrev_b32 v106, 16, v77
    v_and_b32 v107, 0xffff0000, v77
    v_lshlrev_b32 v108, 16, v78
    v_and_b32 v109, 0xffff0000, v78
    v_lshlrev_b32 v110, 16, v79
    v_and_b32 v111, 0xffff0000, v79
    v_pk_mul_f32 v[80:81], v[80:81], v[116:117]
    v_pk_mul_f32 v[82:83], v[82:83], v[116:117]
    v_pk_mul_f32 v[84:85], v[84:85], v[116:117]
    v_pk_mul_f32 v[86:87], v[86:87], v[116:117]
    v_pk_mul_f32 v[88:89], v[88:89], v[116:117]
    v_pk_mul_f32 v[90:91], v[90:91], v[116:117]
    v_pk_mul_f32 v[92:93], v[92:93], v[116:117]
    v_pk_mul_f32 v[94:95], v[94:95], v[116:117]
    v_pk_mul_f32 v[96:97], v[96:97], v[116:117]
    v_pk_mul_f32 v[98:99], v[98:99], v[116:117]
    v_pk_mul_f32 v[100:101], v[100:101], v[116:117]
    v_pk_mul_f32 v[102:103], v[102:103], v[116:117]
    v_pk_mul_f32 v[104:105], v[104:105], v[116:117]
    v_pk_mul_f32 v[106:107], v[106:107], v[116:117]
    v_pk_mul_f32 v[108:109], v[108:109], v[116:117]
    v_pk_mul_f32 v[110:111], v[110:111], v[116:117]
    v_cvt_pk_bf16_f32 v64, v80, v81
    v_cvt_pk_bf16_f32 v65, v82, v83
    v_cvt_pk_bf16_f32 v66, v84, v85
    v_cvt_pk_bf16_f32 v67, v86, v87
    v_cvt_pk_bf16_f32 v68, v88, v89
    v_cvt_pk_bf16_f32 v69, v90, v91
    v_cvt_pk_bf16_f32 v70, v92, v93
    v_cvt_pk_bf16_f32 v71, v94, v95
    v_cvt_pk_bf16_f32 v72, v96, v97
    v_cvt_pk_bf16_f32 v73, v98, v99
    v_cvt_pk_bf16_f32 v74, v100, v101
    v_cvt_pk_bf16_f32 v75, v102, v103
    v_cvt_pk_bf16_f32 v76, v104, v105
    v_cvt_pk_bf16_f32 v77, v106, v107
    v_cvt_pk_bf16_f32 v78, v108, v109
    v_cvt_pk_bf16_f32 v79, v110, v111
    ds_write_b128 v54, v[64:67] offset:0
    ds_write_b128 v54, v[68:71] offset:512
    ds_write_b128 v54, v[72:75] offset:1024
    ds_write_b128 v54, v[76:79] offset:1536
    s_waitcnt vmcnt(16) lgkmcnt(0)
    s_barrier
    ds_read_b128 a[192:195], v55 offset:0
    ds_read_b128 a[196:199], v55 offset:128
    ds_read_b128 a[200:203], v55 offset:256
    ds_read_b128 a[204:207], v55 offset:384
    v_add_u32 v54, 4096, v36
    v_add_u32 v55, 4096, v37
    v_mfma_f32_32x32x16_bf16 v[64:79], v[56:59], v[56:59], 0
    v_mfma_f32_32x32x16_bf16 v[80:95], v[56:59], v[56:59], 0
    v_mfma_f32_32x32x16_bf16 v[96:111], v[56:59], v[56:59], 0
    v_mfma_f32_32x32x16_bf16 v[112:127], v[56:59], v[56:59], 0
    s_cmp_ge_u32 s2, 22
    s_cbranch_scc1 k12_nostat_5
    s_lshl_b32 s52, s2, 12
    s_add_u32 s52, s52, 0x3800000
    s_mov_b32 s34, -1
    v_lshlrev_b32 v6, 4, v0
    buffer_store_dwordx4 v[56:59], v6, s[32:35], s52 offen sc1
    s_mov_b32 s34, 0x2000000
k12_nostat_5:
    ds_read_b128 a[0:3], v26 offset:0
    ds_read_b64_tr_b16 a[32:33], v28 offset:0
    ds_read_b64_tr_b16 a[34:35], v28 offset:2048
    ds_read_b128 a[4:7], v26 offset:2048
    ds_read_b64_tr_b16 a[36:37], v29 offset:0
    ds_read_b64_tr_b16 a[38:39], v29 offset:2048
    ds_read_b128 a[8:11], v26 offset:4096
    ds_read_b64_tr_b16 a[40:41], v30 offset:0
    ds_read_b64_tr_b16 a[42:43], v30 offset:2048
    ds_read_b128 a[12:15], v26 offset:6144
    ds_read_b64_tr_b16 a[44:45], v31 offset:0
    ds_read_b64_tr_b16 a[46:47], v31 offset:2048
    ds_read_b128 a[16:19], v26 offset:8192
    ds_read_b64_tr_b16 a[48:49], v32 offset:0
    ds_read_b64_tr_b16 a[50:51], v32 offset:2048
    ds_read_b128 a[20:23], v26 offset:10240
    ds_read_b64_tr_b16 a[52:53], v33 offset:0
    ds_read_b64_tr_b16 a[54:55], v33 offset:2048
    ds_read_b128 a[24:27], v26 offset:12288
    ds_read_b64_tr_b16 a[56:57], v34 offset:0
    ds_read_b64_tr_b16 a[58:59], v34 offset:2048
    ds_read_b128 a[28:31], v26 offset:14336
    ds_read_b64_tr_b16 a[60:61], v35 offset:0
    ds_read_b64_tr_b16 a[62:63], v35 offset:2048
    s_mov_b32 s51, 0
    s_waitcnt lgkmcnt(15)
    s_mov_b32 s52, 0
    buffer_store_dwordx4 a[192:195], v53, s[8:11], s52 offen sc1
    s_mov_b32 s52, 262144
    buffer_store_dwordx4 a[196:199], v53, s[8:11], s52 offen sc1
    s_mov_b32 s52, 524288
    buffer_store_dwordx4 a[200:203], v53, s[8:11], s52 offen sc1
    s_mov_b32 s52, 786432
    buffer_store_dwordx4 a[204:207], v53, s[8:11], s52 offen sc1
    s_waitcnt lgkmcnt(0)
    s_cmp_lg_u32 s57, 0
    s_cbranch_scc1 k12_v_6
k12_loop_8:
    v_mfma_f32_16x16x32_bf16 v[64:67], a[32:35], a[0:3], v[64:67]
    ds_read_b128 a[64:67], v27 offset:0
    v_mfma_f32_16x16x32_bf16 v[80:83], a[32:35], a[4:7], v[80:83]
    ds_read_b64_tr_b16 a[96:97], v28 offset:16384
    v_mfma_f32_16x16x32_bf16 v[96:99], a[32:35], a[8:11], v[96:99]
    v_mfma_f32_16x16x32_bf16 v[112:115], a[32:35], a[12:15], v[112:115]
    s_cmp_eq_u32 s51, s46
    s_cbranch_scc1 k12_ool_10
k12_oolret_11:
    v_mfma_f32_16x16x32_bf16 v[128:131], a[32:35], a[16:19], v[128:131]
    ds_read_b64_tr_b16 a[98:99], v28 offset:18432
    v_mfma_f32_16x16x32_bf16 v[144:147], a[32:35], a[20:23], v[144:147]
    ds_read_b128 a[68:71], v27 offset:2048
    v_mfma_f32_16x16x32_bf16 a[128:131], a[32:35], a[24:27], a[128:131]
    v_mfma_f32_16x16x32_bf16 a[160:163], a[32:35], a[28:31], a[160:163]
    ds_read_b64_tr_b16 a[100:101], v29 offset:16384
    v_mfma_f32_16x16x32_bf16 v[160:163], a[36:39], a[0:3], v[160:163]
    v_mfma_f32_16x16x32_bf16 v[176:179], a[36:39], a[4:7], v[176:179]
    ds_read_b64_tr_b16 a[102:103], v29 offset:18432
    v_mfma_f32_16x16x32_bf16 v[192:195], a[36:39], a[8:11], v[192:195]
    v_mfma_f32_16x16x32_bf16 v[208:211], a[36:39], a[12:15], v[208:211]
    ds_read_b128 a[72:75], v27 offset:4096
    v_mfma_f32_16x16x32_bf16 v[224:227], a[36:39], a[16:19], v[224:227]
    v_mfma_f32_16x16x32_bf16 v[240:243], a[36:39], a[20:23], v[240:243]
    v_mfma_f32_16x16x32_bf16 a[132:135], a[36:39], a[24:27], a[132:135]
    ds_read_b64_tr_b16 a[104:105], v30 offset:16384
    v_mfma_f32_16x16x32_bf16 a[164:167], a[36:39], a[28:31], a[164:167]
    v_mfma_f32_16x16x32_bf16 v[68:71], a[40:43], a[0:3], v[68:71]
    ds_read_b64_tr_b16 a[106:107], v30 offset:18432
    v_mfma_f32_16x16x32_bf16 v[84:87], a[40:43], a[4:7], v[84:87]
    v_mfma_f32_16x16x32_bf16 v[100:103], a[40:43], a[8:11], v[100:103]
    ds_read_b128 a[76:79], v27 offset:6144
    v_mfma_f32_16x16x32_bf16 v[116:119], a[40:43], a[12:15], v[116:119]
    v_mfma_f32_16x16x32_bf16 v[132:135], a[40:43], a[16:19], v[132:135]
    ds_read_b64_tr_b16 a[108:109], v31 offset:16384
    v_mfma_f32_16x16x32_bf16 v[148:151], a[40:43], a[20:23], v[148:151]
    v_mfma_f32_16x16x32_bf16 a[136:139], a[40:43], a[24:27], a[136:139]
    ds_read_b64_tr_b16 a[110:111], v31 offset:18432
    v_mfma_f32_16x16x32_bf16 a[168:171], a[40:43], a[28:31], a[168:171]
    v_mfma_f32_16x16x32_bf16 v[164:167], a[44:47], a[0:3], v[164:167]
    ds_read_b128 a[80:83], v27 offset:8192
    v_mfma_f32_16x16x32_bf16 v[180:183], a[44:47], a[4:7], v[180:183]
    v_mfma_f32_16x16x32_bf16 v[196:199], a[44:47], a[8:11], v[196:199]
    ds_read_b64_tr_b16 a[112:113], v32 offset:16384
    v_mfma_f32_16x16x32_bf16 v[212:215], a[44:47], a[12:15], v[212:215]
    v_mfma_f32_16x16x32_bf16 v[228:231], a[44:47], a[16:19], v[228:231]
    ds_read_b64_tr_b16 a[114:115], v32 offset:18432
    v_mfma_f32_16x16x32_bf16 v[244:247], a[44:47], a[20:23], v[244:247]
    v_mfma_f32_16x16x32_bf16 a[140:143], a[44:47], a[24:27], a[140:143]
    ds_read_b128 a[84:87], v27 offset:10240
    v_mfma_f32_16x16x32_bf16 a[172:175], a[44:47], a[28:31], a[172:175]
    v_mfma_f32_16x16x32_bf16 v[72:75], a[48:51], a[0:3], v[72:75]
    ds_read_b64_tr_b16 a[116:117], v33 offset:16384
    v_mfma_f32_16x16x32_bf16 v[88:91], a[48:51], a[4:7], v[88:91]
    v_mfma_f32_16x16x32_bf16 v[104:107], a[48:51], a[8:11], v[104:107]
    ds_read_b64_tr_b16 a[118:119], v33 offset:18432
    v_mfma_f32_16x16x32_bf16 v[120:123], a[48:51], a[12:15], v[120:123]
    v_mfma_f32_16x16x32_bf16 v[136:139], a[48:51], a[16:19], v[136:139]
    ds_read_b128 a[88:91], v27 offset:12288
    v_mfma_f32_16x16x32_bf16 v[152:155], a[48:51], a[20:23], v[152:155]
    v_mfma_f32_16x16x32_bf16 a[144:147], a[48:51], a[24:27], a[144:147]
    v_mfma_f32_16x16x32_bf16 a[176:179], a[48:51], a[28:31], a[176:179]
    ds_read_b64_tr_b16 a[120:121], v34 offset:16384
    v_mfma_f32_16x16x32_bf16 v[168:171], a[52:55], a[0:3], v[168:171]
    v_mfma_f32_16x16x32_bf16 v[184:187], a[52:55], a[4:7], v[184:187]
    ds_read_b64_tr_b16 a[122:123], v34 offset:18432
    v_mfma_f32_16x16x32_bf16 v[200:203], a[52:55], a[8:11], v[200:203]
    v_mfma_f32_16x16x32_bf16 v[216:219], a[52:55], a[12:15], v[216:219]
    ds_read_b128 a[92:95], v27 offset:14336
    v_mfma_f32_16x16x32_bf16 v[232:235], a[52:55], a[16:19], v[232:235]
    v_mfma_f32_16x16x32_bf16 v[248:251], a[52:55], a[20:23], v[248:251]
    ds_read_b64_tr_b16 a[124:125], v35 offset:16384
    v_mfma_f32_16x16x32_bf16 a[148:151], a[52:55], a[24:27], a[148:151]
    v_mfma_f32_16x16x32_bf16 a[180:183], a[52:55], a[28:31], a[180:183]
    ds_read_b64_tr_b16 a[126:127], v35 offset:18432
    v_mfma_f32_16x16x32_bf16 v[76:79], a[56:59], a[0:3], v[76:79]
    v_mfma_f32_16x16x32_bf16 v[92:95], a[56:59], a[4:7], v[92:95]
    v_mfma_f32_16x16x32_bf16 v[108:111], a[56:59], a[8:11], v[108:111]
    v_mfma_f32_16x16x32_bf16 v[124:127], a[56:59], a[12:15], v[124:127]
    v_mfma_f32_16x16x32_bf16 v[140:143], a[56:59], a[16:19], v[140:143]
    v_mfma_f32_16x16x32_bf16 v[156:159], a[56:59], a[20:23], v[156:159]
    v_mfma_f32_16x16x32_bf16 a[152:155], a[56:59], a[24:27], a[152:155]
    v_mfma_f32_16x16x32_bf16 a[184:187], a[56:59], a[28:31], a[184:187]
    v_mfma_f32_16x16x32_bf16 v[172:175], a[60:63], a[0:3], v[172:175]
    v_mfma_f32_16x16x32_bf16 v[188:191], a[60:63], a[4:7], v[188:191]
    v_mfma_f32_16x16x32_bf16 v[204:207], a[60:63], a[8:11], v[204:207]
    v_mfma_f32_16x16x32_bf16 v[220:223], a[60:63], a[12:15], v[220:223]
    v_mfma_f32_16x16x32_bf16 v[236:239], a[60:63], a[16:19], v[236:239]
    v_mfma_f32_16x16x32_bf16 v[252:255], a[60:63], a[20:23], v[252:255]
    v_mfma_f32_16x16x32_bf16 a[156:159], a[60:63], a[24:27], a[156:159]
    v_mfma_f32_16x16x32_bf16 a[188:191], a[60:63], a[28:31], a[188:191]
    s_waitcnt vmcnt(0) lgkmcnt(0)
    s_barrier
    v_mfma_f32_16x16x32_bf16 v[64:67], a[96:99], a[64:67], v[64:67]
    s_cmp_ge_u32 s49, 1024
    s_cselect_b32 s18, 0, s18
    s_cselect_b32 s22, 0, s22
    ds_read_b128 a[0:3], v26 offset:32768
    v_mfma_f32_16x16x32_bf16 v[80:83], a[96:99], a[68:71], v[80:83]
    s_add_u32 m0, s48, 0
    ds_read_b64_tr_b16 a[32:33], v28 offset:32768
    v_mfma_f32_16x16x32_bf16 v[96:99], a[96:99], a[72:75], v[96:99]
    buffer_load_dwordx4 v10, s[16:19], s49 offen offset:0 lds
    v_mfma_f32_16x16x32_bf16 v[112:115], a[96:99], a[76:79], v[112:115]
    ds_read_b64_tr_b16 a[34:35], v28 offset:34816
    v_mfma_f32_16x16x32_bf16 v[128:131], a[96:99], a[80:83], v[128:131]
    buffer_load_dwordx4 v11, s[16:19], s49 offen offset:1024 lds
    v_mfma_f32_16x16x32_bf16 v[144:147], a[96:99], a[84:87], v[144:147]
    ds_read_b128 a[4:7], v26 offset:34816
    v_mfma_f32_16x16x32_bf16 a[128:131], a[96:99], a[88:91], a[128:131]
    v_mfma_f32_16x16x32_bf16 a[160:163], a[96:99], a[92:95], a[160:163]
    ds_read_b64_tr_b16 a[36:37], v29 offset:32768
    v_mfma_f32_16x16x32_bf16 v[160:163], a[100:103], a[64:67], v[160:163]
    buffer_load_dwordx4 v12, s[16:19], s49 offen offset:2048 lds
    v_mfma_f32_16x16x32_bf16 v[176:179], a[100:103], a[68:71], v[176:179]
    ds_read_b64_tr_b16 a[38:39], v29 offset:34816
    v_mfma_f32_16x16x32_bf16 v[192:195], a[100:103], a[72:75], v[192:195]
    v_mfma_f32_16x16x32_bf16 v[208:211], a[100:103], a[76:79], v[208:211]
    buffer_load_dwordx4 v13, s[16:19], s49 offen offset:3072 lds
    ds_read_b128 a[8:11], v26 offset:36864
    v_mfma_f32_16x16x32_bf16 v[224:227], a[100:103], a[80:83], v[224:227]
    v_mfma_f32_16x16x32_bf16 v[240:243], a[100:103], a[84:87], v[240:243]
    s_add_u32 m0, s48, 4096
    v_mfma_f32_16x16x32_bf16 a[132:135], a[100:103], a[88:91], a[132:135]
    ds_read_b64_tr_b16 a[40:41], v30 offset:32768
    v_mfma_f32_16x16x32_bf16 a[164:167], a[100:103], a[92:95], a[164:167]
    buffer_load_dwordx4 v14, s[16:19], s49 offen offset:0 lds
    v_mfma_f32_16x16x32_bf16 v[68:71], a[104:107], a[64:67], v[68:71]
    ds_read_b64_tr_b16 a[42:43], v30 offset:34816
    v_mfma_f32_16x16x32_bf16 v[84:87], a[104:107], a[68:71], v[84:87]
    v_mfma_f32_16x16x32_bf16 v[100:103], a[104:107], a[72:75], v[100:103]
    buffer_load_dwordx4 v15, s[16:19], s49 offen offset:1024 lds
    ds_read_b128 a[12:15], v26 offset:38912
    v_mfma_f32_16x16x32_bf16 v[116:119], a[104:107], a[76:79], v[116:119]
    v_mfma_f32_16x16x32_bf16 v[132:135], a[104:107], a[80:83], v[132:135]
    ds_read_b64_tr_b16 a[44:45], v31 offset:32768
    v_mfma_f32_16x16x32_bf16 v[148:151], a[104:107], a[84:87], v[148:151]
    v_mfma_f32_16x16x32_bf16 a[136:139], a[104:107], a[88:91], a[136:139]
    buffer_load_dwordx4 v16, s[16:19], s49 offen offset:2048 lds
    ds_read_b64_tr_b16 a[46:47], v31 offset:34816
    v_mfma_f32_16x16x32_bf16 a[168:171], a[104:107], a[92:95], a[168:171]
    v_mfma_f32_16x16x32_bf16 v[164:167], a[108:111], a[64:67], v[164:167]
    ds_read_b128 a[16:19], v26 offset:40960
    v_mfma_f32_16x16x32_bf16 v[180:183], a[108:111], a[68:71], v[180:183]
    buffer_load_dwordx4 v17, s[16:19], s49 offen offset:3072 lds
    v_mfma_f32_16x16x32_bf16 v[196:199], a[108:111], a[72:75], v[196:199]
    ds_read_b64_tr_b16 a[48:49], v32 offset:32768
    v_mfma_f32_16x16x32_bf16 v[212:215], a[108:111], a[76:79], v[212:215]
    s_add_u32 s49, s49, 128
    v_mfma_f32_16x16x32_bf16 v[228:231], a[108:111], a[80:83], v[228:231]
    s_add_u32 m0, s48, 65536
    ds_read_b64_tr_b16 a[50:51], v32 offset:34816
    v_mfma_f32_16x16x32_bf16 v[244:247], a[108:111], a[84:87], v[244:247]
    buffer_load_dwordx4 v18, s[20:23], s50 offen offset:0 lds
    v_mfma_f32_16x16x32_bf16 a[140:143], a[108:111], a[88:91], a[140:143]
    ds_read_b128 a[20:23], v26 offset:43008
    v_mfma_f32_16x16x32_bf16 a[172:175], a[108:111], a[92:95], a[172:175]
    v_mfma_f32_16x16x32_bf16 v[72:75], a[112:115], a[64:67], v[72:75]
    buffer_load_dwordx4 v19, s[20:23], s50 offen offset:1024 lds
    ds_read_b64_tr_b16 a[52:53], v33 offset:32768
    v_mfma_f32_16x16x32_bf16 v[88:91], a[112:115], a[68:71], v[88:91]
    v_mfma_f32_16x16x32_bf16 v[104:107], a[112:115], a[72:75], v[104:107]
    ds_read_b64_tr_b16 a[54:55], v33 offset:34816
    v_mfma_f32_16x16x32_bf16 v[120:123], a[112:115], a[76:79], v[120:123]
    buffer_load_dwordx4 v20, s[20:23], s50 offen offset:2048 lds
    v_mfma_f32_16x16x32_bf16 v[136:139], a[112:115], a[80:83], v[136:139]
    ds_read_b128 a[24:27], v26 offset:45056
    v_mfma_f32_16x16x32_bf16 v[152:155], a[112:115], a[84:87], v[152:155]
    v_mfma_f32_16x16x32_bf16 a[144:147], a[112:115], a[88:91], a[144:147]
    v_mfma_f32_16x16x32_bf16 a[176:179], a[112:115], a[92:95], a[176:179]
    buffer_load_dwordx4 v21, s[20:23], s50 offen offset:3072 lds
    ds_read_b64_tr_b16 a[56:57], v34 offset:32768
    v_mfma_f32_16x16x32_bf16 v[168:171], a[116:119], a[64:67], v[168:171]
    s_add_u32 m0, s48, 69632
    v_mfma_f32_16x16x32_bf16 v[184:187], a[116:119], a[68:71], v[184:187]
    ds_read_b64_tr_b16 a[58:59], v34 offset:34816
    v_mfma_f32_16x16x32_bf16 v[200:203], a[116:119], a[72:75], v[200:203]
    buffer_load_dwordx4 v22, s[20:23], s50 offen offset:0 lds
    v_mfma_f32_16x16x32_bf16 v[216:219], a[116:119], a[76:79], v[216:219]
    ds_read_b128 a[28:31], v26 offset:47104
    v_mfma_f32_16x16x32_bf16 v[232:235], a[116:119], a[80:83], v[232:235]
    v_mfma_f32_16x16x32_bf16 v[248:251], a[116:119], a[84:87], v[248:251]
    ds_read_b64_tr_b16 a[60:61], v35 offset:32768
    v_mfma_f32_16x16x32_bf16 a[148:151], a[116:119], a[88:91], a[148:151]
    buffer_load_dwordx4 v23, s[20:23], s50 offen offset:1024 lds
    v_mfma_f32_16x16x32_bf16 a[180:183], a[116:119], a[92:95], a[180:183]
    ds_read_b64_tr_b16 a[62:63], v35 offset:34816
    v_mfma_f32_16x16x32_bf16 v[76:79], a[120:123], a[64:67], v[76:79]
    v_mfma_f32_16x16x32_bf16 v[92:95], a[120:123], a[68:71], v[92:95]
    buffer_load_dwordx4 v24, s[20:23], s50 offen offset:2048 lds
    v_mfma_f32_16x16x32_bf16 v[108:111], a[120:123], a[72:75], v[108:111]
    v_mfma_f32_16x16x32_bf16 v[124:127], a[120:123], a[76:79], v[124:127]
    v_mfma_f32_16x16x32_bf16 v[140:143], a[120:123], a[80:83], v[140:143]
    v_mfma_f32_16x16x32_bf16 v[156:159], a[120:123], a[84:87], v[156:159]
    buffer_load_dwordx4 v25, s[20:23], s50 offen offset:3072 lds
    v_mfma_f32_16x16x32_bf16 a[152:155], a[120:123], a[88:91], a[152:155]
    v_mfma_f32_16x16x32_bf16 a[184:187], a[120:123], a[92:95], a[184:187]
    s_add_u32 s50, s50, 0x80000
    v_mfma_f32_16x16x32_bf16 v[172:175], a[124:127], a[64:67], v[172:175]
    v_mfma_f32_16x16x32_bf16 v[188:191], a[124:127], a[68:71], v[188:191]
    s_cmp_eq_u32 s51, s53
    s_cbranch_scc1 k12_ool_12
k12_oolret_13:
    v_mfma_f32_16x16x32_bf16 v[204:207], a[124:127], a[72:75], v[204:207]
    v_mfma_f32_16x16x32_bf16 v[220:223], a[124:127], a[76:79], v[220:223]
    s_cmp_eq_u32 s51, s63
    s_cbranch_scc1 k12_ool_14
k12_oolret_15:
    v_mfma_f32_16x16x32_bf16 v[236:239], a[124:127], a[80:83], v[236:239]
    v_mfma_f32_16x16x32_bf16 v[252:255], a[124:127], a[84:87], v[252:255]
    s_add_u32 s51, s51, 1
    v_mfma_f32_16x16x32_bf16 a[156:159], a[124:127], a[88:91], a[156:159]
    v_mfma_f32_16x16x32_bf16 a[188:191], a[124:127], a[92:95], a[188:191]
    s_waitcnt lgkmcnt(0)
    v_mfma_f32_16x16x32_bf16 v[64:67], a[32:35], a[0:3], v[64:67]
    ds_read_b128 a[64:67], v27 offset:32768
    v_mfma_f32_16x16x32_bf16 v[80:83], a[32:35], a[4:7], v[80:83]
    ds_read_b64_tr_b16 a[96:97], v28 offset:49152
    v_mfma_f32_16x16x32_bf16 v[96:99], a[32:35], a[8:11], v[96:99]
    v_mfma_f32_16x16x32_bf16 v[112:115], a[32:35], a[12:15], v[112:115]
    ds_read_b64_tr_b16 a[98:99], v28 offset:51200
    v_mfma_f32_16x16x32_bf16 v[128:131], a[32:35], a[16:19], v[128:131]
    v_mfma_f32_16x16x32_bf16 v[144:147], a[32:35], a[20:23], v[144:147]
    ds_read_b128 a[68:71], v27 offset:34816
    v_mfma_f32_16x16x32_bf16 a[128:131], a[32:35], a[24:27], a[128:131]
    v_mfma_f32_16x16x32_bf16 a[160:163], a[32:35], a[28:31], a[160:163]
    ds_read_b64_tr_b16 a[100:101], v29 offset:49152
    v_mfma_f32_16x16x32_bf16 v[160:163], a[36:39], a[0:3], v[160:163]
    v_mfma_f32_16x16x32_bf16 v[176:179], a[36:39], a[4:7], v[176:179]
    ds_read_b64_tr_b16 a[102:103], v29 offset:51200
    v_mfma_f32_16x16x32_bf16 v[192:195], a[36:39], a[8:11], v[192:195]
    v_mfma_f32_16x16x32_bf16 v[208:211], a[36:39], a[12:15], v[208:211]
    ds_read_b128 a[72:75], v27 offset:36864
    v_mfma_f32_16x16x32_bf16 v[224:227], a[36:39], a[16:19], v[224:227]
    v_mfma_f32_16x16x32_bf16 v[240:243], a[36:39], a[20:23], v[240:243]
    v_mfma_f32_16x16x32_bf16 a[132:135], a[36:39], a[24:27], a[132:135]
    ds_read_b64_tr_b16 a[104:105], v30 offset:49152
    v_mfma_f32_16x16x32_bf16 a[164:167], a[36:39], a[28:31], a[164:167]
    v_mfma_f32_16x16x32_bf16 v[68:71], a[40:43], a[0:3], v[68:71]
    ds_read_b64_tr_b16 a[106:107], v30 offset:51200
    v_mfma_f32_16x16x32_bf16 v[84:87], a[40:43], a[4:7], v[84:87]
    v_mfma_f32_16x16x32_bf16 v[100:103], a[40:43], a[8:11], v[100:103]
    ds_read_b128 a[76:79], v27 offset:38912
    v_mfma_f32_16x16x32_bf16 v[116:119], a[40:43], a[12:15], v[116:119]
    v_mfma_f32_16x16x32_bf16 v[132:135], a[40:43], a[16:19], v[132:135]
    ds_read_b64_tr_b16 a[108:109], v31 offset:49152
    v_mfma_f32_16x16x32_bf16 v[148:151], a[40:43], a[20:23], v[148:151]
    v_mfma_f32_16x16x32_bf16 a[136:139], a[40:43], a[24:27], a[136:139]
    ds_read_b64_tr_b16 a[110:111], v31 offset:51200
    v_mfma_f32_16x16x32_bf16 a[168:171], a[40:43], a[28:31], a[168:171]
    v_mfma_f32_16x16x32_bf16 v[164:167], a[44:47], a[0:3], v[164:167]
    ds_read_b128 a[80:83], v27 offset:40960
    v_mfma_f32_16x16x32_bf16 v[180:183], a[44:47], a[4:7], v[180:183]
    v_mfma_f32_16x16x32_bf16 v[196:199], a[44:47], a[8:11], v[196:199]
    ds_read_b64_tr_b16 a[112:113], v32 offset:49152
    v_mfma_f32_16x16x32_bf16 v[212:215], a[44:47], a[12:15], v[212:215]
    v_mfma_f32_16x16x32_bf16 v[228:231], a[44:47], a[16:19], v[228:231]
    ds_read_b64_tr_b16 a[114:115], v32 offset:51200
    v_mfma_f32_16x16x32_bf16 v[244:247], a[44:47], a[20:23], v[244:247]
    v_mfma_f32_16x16x32_bf16 a[140:143], a[44:47], a[24:27], a[140:143]
    ds_read_b128 a[84:87], v27 offset:43008
    v_mfma_f32_16x16x32_bf16 a[172:175], a[44:47], a[28:31], a[172:175]
    v_mfma_f32_16x16x32_bf16 v[72:75], a[48:51], a[0:3], v[72:75]
    ds_read_b64_tr_b16 a[116:117], v33 offset:49152
    v_mfma_f32_16x16x32_bf16 v[88:91], a[48:51], a[4:7], v[88:91]
    v_mfma_f32_16x16x32_bf16 v[104:107], a[48:51], a[8:11], v[104:107]
    ds_read_b64_tr_b16 a[118:119], v33 offset:51200
    v_mfma_f32_16x16x32_bf16 v[120:123], a[48:51], a[12:15], v[120:123]
    v_mfma_f32_16x16x32_bf16 v[136:139], a[48:51], a[16:19], v[136:139]
    ds_read_b128 a[88:91], v27 offset:45056
    v_mfma_f32_16x16x32_bf16 v[152:155], a[48:51], a[20:23], v[152:155]
    v_mfma_f32_16x16x32_bf16 a[144:147], a[48:51], a[24:27], a[144:147]
    v_mfma_f32_16x16x32_bf16 a[176:179], a[48:51], a[28:31], a[176:179]
    ds_read_b64_tr_b16 a[120:121], v34 offset:49152
    v_mfma_f32_16x16x32_bf16 v[168:171], a[52:55], a[0:3], v[168:171]
    v_mfma_f32_16x16x32_bf16 v[184:187], a[52:55], a[4:7], v[184:187]
    ds_read_b64_tr_b16 a[122:123], v34 offset:51200
    v_mfma_f32_16x16x32_bf16 v[200:203], a[52:55], a[8:11], v[200:203]
    v_mfma_f32_16x16x32_bf16 v[216:219], a[52:55], a[12:15], v[216:219]
    ds_read_b128 a[92:95], v27 offset:47104
    v_mfma_f32_16x16x32_bf16 v[232:235], a[52:55], a[16:19], v[232:235]
    v_mfma_f32_16x16x32_bf16 v[248:251], a[52:55], a[20:23], v[248:251]
    ds_read_b64_tr_b16 a[124:125], v35 offset:49152
    v_mfma_f32_16x16x32_bf16 a[148:151], a[52:55], a[24:27], a[148:151]
    v_mfma_f32_16x16x32_bf16 a[180:183], a[52:55], a[28:31], a[180:183]
    ds_read_b64_tr_b16 a[126:127], v35 offset:51200
    v_mfma_f32_16x16x32_bf16 v[76:79], a[56:59], a[0:3], v[76:79]
    v_mfma_f32_16x16x32_bf16 v[92:95], a[56:59], a[4:7], v[92:95]
    v_mfma_f32_16x16x32_bf16 v[108:111], a[56:59], a[8:11], v[108:111]
    v_mfma_f32_16x16x32_bf16 v[124:127], a[56:59], a[12:15], v[124:127]
    v_mfma_f32_16x16x32_bf16 v[140:143], a[56:59], a[16:19], v[140:143]
    v_mfma_f32_16x16x32_bf16 v[156:159], a[56:59], a[20:23], v[156:159]
    v_mfma_f32_16x16x32_bf16 a[152:155], a[56:59], a[24:27], a[152:155]
    v_mfma_f32_16x16x32_bf16 a[184:187], a[56:59], a[28:31], a[184:187]
    s_sub_u32 s52, s51, 1
    s_cmp_eq_u32 s52, s46
    s_cbranch_scc1 k12_ool_18
k12_oolret_19:
    v_mfma_f32_16x16x32_bf16 v[172:175], a[60:63], a[0:3], v[172:175]
    v_mfma_f32_16x16x32_bf16 v[188:191], a[60:63], a[4:7], v[188:191]
    v_mfma_f32_16x16x32_bf16 v[204:207], a[60:63], a[8:11], v[204:207]
    v_mfma_f32_16x16x32_bf16 v[220:223], a[60:63], a[12:15], v[220:223]
    v_mfma_f32_16x16x32_bf16 v[236:239], a[60:63], a[16:19], v[236:239]
    v_mfma_f32_16x16x32_bf16 v[252:255], a[60:63], a[20:23], v[252:255]
    v_mfma_f32_16x16x32_bf16 a[156:159], a[60:63], a[24:27], a[156:159]
    v_mfma_f32_16x16x32_bf16 a[188:191], a[60:63], a[28:31], a[188:191]
    s_waitcnt vmcnt(0) lgkmcnt(0)
    s_barrier
    s_cmp_eq_u32 s51, 7
    s_cbranch_scc1 k12_last_9
    v_mfma_f32_16x16x32_bf16 v[64:67], a[96:99], a[64:67], v[64:67]
    ds_read_b128 a[0:3], v26 offset:0
    v_mfma_f32_16x16x32_bf16 v[80:83], a[96:99], a[68:71], v[80:83]
    s_add_u32 m0, s48, 32768
    ds_read_b64_tr_b16 a[32:33], v28 offset:0
    v_mfma_f32_16x16x32_bf16 v[96:99], a[96:99], a[72:75], v[96:99]
    buffer_load_dwordx4 v10, s[16:19], s49 offen offset:0 lds
    v_mfma_f32_16x16x32_bf16 v[112:115], a[96:99], a[76:79], v[112:115]
    ds_read_b64_tr_b16 a[34:35], v28 offset:2048
    v_mfma_f32_16x16x32_bf16 v[128:131], a[96:99], a[80:83], v[128:131]
    buffer_load_dwordx4 v11, s[16:19], s49 offen offset:1024 lds
    v_mfma_f32_16x16x32_bf16 v[144:147], a[96:99], a[84:87], v[144:147]
    ds_read_b128 a[4:7], v26 offset:2048
    v_mfma_f32_16x16x32_bf16 a[128:131], a[96:99], a[88:91], a[128:131]
    v_mfma_f32_16x16x32_bf16 a[160:163], a[96:99], a[92:95], a[160:163]
    ds_read_b64_tr_b16 a[36:37], v29 offset:0
    v_mfma_f32_16x16x32_bf16 v[160:163], a[100:103], a[64:67], v[160:163]
    buffer_load_dwordx4 v12, s[16:19], s49 offen offset:2048 lds
    v_mfma_f32_16x16x32_bf16 v[176:179], a[100:103], a[68:71], v[176:179]
    ds_read_b64_tr_b16 a[38:39], v29 offset:2048
    v_mfma_f32_16x16x32_bf16 v[192:195], a[100:103], a[72:75], v[192:195]
    v_mfma_f32_16x16x32_bf16 v[208:211], a[100:103], a[76:79], v[208:211]
    buffer_load_dwordx4 v13, s[16:19], s49 offen offset:3072 lds
    ds_read_b128 a[8:11], v26 offset:4096
    v_mfma_f32_16x16x32_bf16 v[224:227], a[100:103], a[80:83], v[224:227]
    v_mfma_f32_16x16x32_bf16 v[240:243], a[100:103], a[84:87], v[240:243]
    s_add_u32 m0, s48, 36864
    v_mfma_f32_16x16x32_bf16 a[132:135], a[100:103], a[88:91], a[132:135]
    ds_read_b64_tr_b16 a[40:41], v30 offset:0
    v_mfma_f32_16x16x32_bf16 a[164:167], a[100:103], a[92:95], a[164:167]
    buffer_load_dwordx4 v14, s[16:19], s49 offen offset:0 lds
    v_mfma_f32_16x16x32_bf16 v[68:71], a[104:107], a[64:67], v[68:71]
    ds_read_b64_tr_b16 a[42:43], v30 offset:2048
    v_mfma_f32_16x16x32_bf16 v[84:87], a[104:107], a[68:71], v[84:87]
    v_mfma_f32_16x16x32_bf16 v[100:103], a[104:107], a[72:75], v[100:103]
    buffer_load_dwordx4 v15, s[16:19], s49 offen offset:1024 lds
    ds_read_b128 a[12:15], v26 offset:6144
    v_mfma_f32_16x16x32_bf16 v[116:119], a[104:107], a[76:79], v[116:119]
    v_mfma_f32_16x16x32_bf16 v[132:135], a[104:107], a[80:83], v[132:135]
    ds_read_b64_tr_b16 a[44:45], v31 offset:0
    v_mfma_f32_16x16x32_bf16 v[148:151], a[104:107], a[84:87], v[148:151]
    v_mfma_f32_16x16x32_bf16 a[136:139], a[104:107], a[88:91], a[136:139]
    buffer_load_dwordx4 v16, s[16:19], s49 offen offset:2048 lds
    ds_read_b64_tr_b16 a[46:47], v31 offset:2048
    v_mfma_f32_16x16x32_bf16 a[168:171], a[104:107], a[92:95], a[168:171]
    v_mfma_f32_16x16x32_bf16 v[164:167], a[108:111], a[64:67], v[164:167]
    ds_read_b128 a[16:19], v26 offset:8192
    v_mfma_f32_16x16x32_bf16 v[180:183], a[108:111], a[68:71], v[180:183]
    buffer_load_dwordx4 v17, s[16:19], s49 offen offset:3072 lds
    v_mfma_f32_16x16x32_bf16 v[196:199], a[108:111], a[72:75], v[196:199]
    ds_read_b64_tr_b16 a[48:49], v32 offset:0
    v_mfma_f32_16x16x32_bf16 v[212:215], a[108:111], a[76:79], v[212:215]
    s_add_u32 s49, s49, 128
    v_mfma_f32_16x16x32_bf16 v[228:231], a[108:111], a[80:83], v[228:231]
    s_add_u32 m0, s48, 98304
    ds_read_b64_tr_b16 a[50:51], v32 offset:2048
    v_mfma_f32_16x16x32_bf16 v[244:247], a[108:111], a[84:87], v[244:247]
    buffer_load_dwordx4 v18, s[20:23], s50 offen offset:0 lds
    v_mfma_f32_16x16x32_bf16 a[140:143], a[108:111], a[88:91], a[140:143]
    ds_read_b128 a[20:23], v26 offset:10240
    v_mfma_f32_16x16x32_bf16 a[172:175], a[108:111], a[92:95], a[172:175]
    v_mfma_f32_16x16x32_bf16 v[72:75], a[112:115], a[64:67], v[72:75]
    buffer_load_dwordx4 v19, s[20:23], s50 offen offset:1024 lds
    ds_read_b64_tr_b16 a[52:53], v33 offset:0
    v_mfma_f32_16x16x32_bf16 v[88:91], a[112:115], a[68:71], v[88:91]
    v_mfma_f32_16x16x32_bf16 v[104:107], a[112:115], a[72:75], v[104:107]
    ds_read_b64_tr_b16 a[54:55], v33 offset:2048
    v_mfma_f32_16x16x32_bf16 v[120:123], a[112:115], a[76:79], v[120:123]
    buffer_load_dwordx4 v20, s[20:23], s50 offen offset:2048 lds
    v_mfma_f32_16x16x32_bf16 v[136:139], a[112:115], a[80:83], v[136:139]
    ds_read_b128 a[24:27], v26 offset:12288
    v_mfma_f32_16x16x32_bf16 v[152:155], a[112:115], a[84:87], v[152:155]
    v_mfma_f32_16x16x32_bf16 a[144:147], a[112:115], a[88:91], a[144:147]
    v_mfma_f32_16x16x32_bf16 a[176:179], a[112:115], a[92:95], a[176:179]
    buffer_load_dwordx4 v21, s[20:23], s50 offen offset:3072 lds
    ds_read_b64_tr_b16 a[56:57], v34 offset:0
    v_mfma_f32_16x16x32_bf16 v[168:171], a[116:119], a[64:67], v[168:171]
    s_add_u32 m0, s48, 102400
    v_mfma_f32_16x16x32_bf16 v[184:187], a[116:119], a[68:71], v[184:187]
    ds_read_b64_tr_b16 a[58:59], v34 offset:2048
    v_mfma_f32_16x16x32_bf16 v[200:203], a[116:119], a[72:75], v[200:203]
    buffer_load_dwordx4 v22, s[20:23], s50 offen offset:0 lds
    v_mfma_f32_16x16x32_bf16 v[216:219], a[116:119], a[76:79], v[216:219]
    ds_read_b128 a[28:31], v26 offset:14336
    v_mfma_f32_16x16x32_bf16 v[232:235], a[116:119], a[80:83], v[232:235]
    v_mfma_f32_16x16x32_bf16 v[248:251], a[116:119], a[84:87], v[248:251]
    ds_read_b64_tr_b16 a[60:61], v35 offset:0
    v_mfma_f32_16x16x32_bf16 a[148:151], a[116:119], a[88:91], a[148:151]
    buffer_load_dwordx4 v23, s[20:23], s50 offen offset:1024 lds
    v_mfma_f32_16x16x32_bf16 a[180:183], a[116:119], a[92:95], a[180:183]
    ds_read_b64_tr_b16 a[62:63], v35 offset:2048
    v_mfma_f32_16x16x32_bf16 v[76:79], a[120:123], a[64:67], v[76:79]
    v_mfma_f32_16x16x32_bf16 v[92:95], a[120:123], a[68:71], v[92:95]
    buffer_load_dwordx4 v24, s[20:23], s50 offen offset:2048 lds
    v_mfma_f32_16x16x32_bf16 v[108:111], a[120:123], a[72:75], v[108:111]
    v_mfma_f32_16x16x32_bf16 v[124:127], a[120:123], a[76:79], v[124:127]
    v_mfma_f32_16x16x32_bf16 v[140:143], a[120:123], a[80:83], v[140:143]
    v_mfma_f32_16x16x32_bf16 v[156:159], a[120:123], a[84:87], v[156:159]
    buffer_load_dwordx4 v25, s[20:23], s50 offen offset:3072 lds
    v_mfma_f32_16x16x32_bf16 a[152:155], a[120:123], a[88:91], a[152:155]
    v_mfma_f32_16x16x32_bf16 a[184:187], a[120:123], a[92:95], a[184:187]
    s_add_u32 s50, s50, 0x80000
    v_mfma_f32_16x16x32_bf16 v[172:175], a[124:127], a[64:67], v[172:175]
    v_mfma_f32_16x16x32_bf16 v[188:191], a[124:127], a[68:71], v[188:191]
    s_cmp_eq_u32 s51, s53
    s_cbranch_scc1 k12_ool_20
k12_oolret_21:
    v_mfma_f32_16x16x32_bf16 v[204:207], a[124:127], a[72:75], v[204:207]
    v_mfma_f32_16x16x32_bf16 v[220:223], a[124:127], a[76:79], v[220:223]
    s_cmp_eq_u32 s51, 5
    s_cbranch_scc1 k12_ool_22
k12_oolret_23:
    v_mfma_f32_16x16x32_bf16 v[236:239], a[124:127], a[80:83], v[236:239]
    v_mfma_f32_16x16x32_bf16 v[252:255], a[124:127], a[84:87], v[252:255]
    s_add_u32 s51, s51, 1
    v_mfma_f32_16x16x32_bf16 a[156:159], a[124:127], a[88:91], a[156:159]
    v_mfma_f32_16x16x32_bf16 a[188:191], a[124:127], a[92:95], a[188:191]
    s_waitcnt lgkmcnt(0)
    s_branch k12_loop_8
k12_last_9:
    v_mfma_f32_16x16x32_bf16 v[64:67], a[96:99], a[64:67], v[64:67]
    s_add_u32 m0, s60, 98304
    v_mfma_f32_16x16x32_bf16 v[160:163], a[100:103], a[64:67], v[160:163]
    buffer_load_dwordx4 v38, s[12:15], s61 offen offset:0 lds
    v_mfma_f32_16x16x32_bf16 v[68:71], a[104:107], a[64:67], v[68:71]
    buffer_load_dwordx4 v39, s[12:15], s61 offen offset:1024 lds
    v_mfma_f32_16x16x32_bf16 v[164:167], a[108:111], a[64:67], v[164:167]
    v_mfma_f32_16x16x32_bf16 v[72:75], a[112:115], a[64:67], v[72:75]
    buffer_load_dwordx4 v40, s[12:15], s61 offen offset:2048 lds
    v_mfma_f32_16x16x32_bf16 v[168:171], a[116:119], a[64:67], v[168:171]
    v_cvt_pk_bf16_f32 v64, v64, v65
    v_cvt_pk_bf16_f32 v65, v66, v67
    v_cvt_pk_bf16_f32 v66, v160, v161
    v_mfma_f32_16x16x32_bf16 v[76:79], a[120:123], a[64:67], v[76:79]
    v_cvt_pk_bf16_f32 v67, v162, v163
    v_mfma_f32_16x16x32_bf16 v[172:175], a[124:127], a[64:67], v[172:175]
    v_cvt_pk_bf16_f32 v68, v68, v69
    v_cvt_pk_bf16_f32 v69, v70, v71
    v_cvt_pk_bf16_f32 v70, v164, v165
    v_mfma_f32_16x16x32_bf16 v[80:83], a[96:99], a[68:71], v[80:83]
    buffer_load_dwordx4 v41, s[12:15], s61 offen offset:3072 lds
    v_mfma_f32_16x16x32_bf16 v[176:179], a[100:103], a[68:71], v[176:179]
    s_add_u32 s61, s61, 0x80000
    v_cvt_pk_bf16_f32 v71, v166, v167
    v_cvt_pk_bf16_f32 v72, v72, v73
    v_cvt_pk_bf16_f32 v73, v74, v75
    v_mfma_f32_16x16x32_bf16 v[84:87], a[104:107], a[68:71], v[84:87]
    buffer_load_dwordx4 a[192:195], v36, s[8:11], s62 offen sc1
    buffer_load_dwordx4 a[196:199], v54, s[8:11], s62 offen sc1
    v_mfma_f32_16x16x32_bf16 v[180:183], a[108:111], a[68:71], v[180:183]
    v_cvt_pk_bf16_f32 v74, v168, v169
    v_cvt_pk_bf16_f32 v75, v170, v171
    v_cvt_pk_bf16_f32 v76, v76, v77
    v_mfma_f32_16x16x32_bf16 v[88:91], a[112:115], a[68:71], v[88:91]
    v_cvt_pk_bf16_f32 v77, v78, v79
    v_cvt_pk_bf16_f32 v78, v172, v173
    v_cvt_pk_bf16_f32 v79, v174, v175
    v_mfma_f32_16x16x32_bf16 v[184:187], a[116:119], a[68:71], v[184:187]
    v_cvt_pk_bf16_f32 v80, v80, v81
    v_cvt_pk_bf16_f32 v81, v82, v83
    v_cvt_pk_bf16_f32 v82, v176, v177
    v_mfma_f32_16x16x32_bf16 v[92:95], a[120:123], a[68:71], v[92:95]
    buffer_load_dwordx4 a[200:203], v37, s[8:11], s62 offen sc1
    buffer_load_dwordx4 a[204:207], v55, s[8:11], s62 offen sc1
    v_mfma_f32_16x16x32_bf16 v[188:191], a[124:127], a[68:71], v[188:191]
    s_add_u32 s62, s62, 0x20000
    v_cvt_pk_bf16_f32 v83, v178, v179
    v_cvt_pk_bf16_f32 v84, v84, v85
    v_cvt_pk_bf16_f32 v85, v86, v87
    v_mfma_f32_16x16x32_bf16 a[128:131], a[96:99], a[88:91], a[128:131]
    v_cvt_pk_bf16_f32 v86, v180, v181
    v_cvt_pk_bf16_f32 v87, v182, v183
    v_mfma_f32_16x16x32_bf16 a[132:135], a[100:103], a[88:91], a[132:135]
    v_cvt_pk_bf16_f32 v88, v88, v89
    v_cvt_pk_bf16_f32 v89, v90, v91
    v_cvt_pk_bf16_f32 v90, v184, v185
    v_mfma_f32_16x16x32_bf16 v[96:99], a[96:99], a[72:75], v[96:99]
    buffer_load_dwordx4 a[208:211], v36, s[8:11], s62 offen sc1
    buffer_load_dwordx4 a[212:215], v54, s[8:11], s62 offen sc1
    v_mfma_f32_16x16x32_bf16 v[192:195], a[100:103], a[72:75], v[192:195]
    v_cvt_pk_bf16_f32 v91, v186, v187
    v_cvt_pk_bf16_f32 v92, v92, v93
    v_cvt_pk_bf16_f32 v93, v94, v95
    v_mfma_f32_16x16x32_bf16 v[100:103], a[104:107], a[72:75], v[100:103]
    v_cvt_pk_bf16_f32 v94, v188, v189
    v_cvt_pk_bf16_f32 v95, v190, v191
    v_mfma_f32_16x16x32_bf16 v[196:199], a[108:111], a[72:75], v[196:199]
    v_accvgpr_read_b32 v56, a128
    v_accvgpr_read_b32 v57, a129
    v_accvgpr_read_b32 v58, a130
    v_mfma_f32_16x16x32_bf16 a[136:139], a[104:107], a[88:91], a[136:139]
    buffer_load_dwordx4 a[216:219], v37, s[8:11], s62 offen sc1
    buffer_load_dwordx4 a[220:223], v55, s[8:11], s62 offen sc1
    v_mfma_f32_16x16x32_bf16 a[140:143], a[108:111], a[88:91], a[140:143]
    s_add_u32 s62, s62, 0x20000
    v_accvgpr_read_b32 v59, a131
    v_accvgpr_read_b32 v60, a132
    v_cvt_pk_bf16_f32 v96, v96, v97
    v_mfma_f32_16x16x32_bf16 v[104:107], a[112:115], a[72:75], v[104:107]
    s_add_u32 m0, s60, 114688
    v_accvgpr_read_b32 v61, a133
    v_accvgpr_read_b32 v62, a134
    v_cvt_pk_bf16_f32 v97, v98, v99
    v_mfma_f32_16x16x32_bf16 v[200:203], a[116:119], a[72:75], v[200:203]
    v_accvgpr_read_b32 v63, a135
    v_cvt_pk_bf16_f32 v98, v192, v193
    v_cvt_pk_bf16_f32 v160, v56, v57
    v_mfma_f32_16x16x32_bf16 v[108:111], a[120:123], a[72:75], v[108:111]
    v_cvt_pk_bf16_f32 v99, v194, v195
    v_cvt_pk_bf16_f32 v161, v58, v59
    v_cvt_pk_bf16_f32 v100, v100, v101
    v_mfma_f32_16x16x32_bf16 v[204:207], a[124:127], a[72:75], v[204:207]
    buffer_load_dwordx4 v38, s[12:15], s61 offen offset:0 lds
    buffer_load_dwordx4 v39, s[12:15], s61 offen offset:1024 lds
    v_mfma_f32_16x16x32_bf16 a[144:147], a[112:115], a[88:91], a[144:147]
    v_cvt_pk_bf16_f32 v162, v60, v61
    v_cvt_pk_bf16_f32 v101, v102, v103
    v_cvt_pk_bf16_f32 v163, v62, v63
    v_mfma_f32_16x16x32_bf16 a[148:151], a[116:119], a[88:91], a[148:151]
    v_cvt_pk_bf16_f32 v102, v196, v197
    v_cvt_pk_bf16_f32 v103, v198, v199
    v_accvgpr_read_b32 v56, a136
    v_mfma_f32_16x16x32_bf16 v[112:115], a[96:99], a[76:79], v[112:115]
    v_accvgpr_read_b32 v57, a137
    v_accvgpr_read_b32 v58, a138
    v_accvgpr_read_b32 v59, a139
    v_mfma_f32_16x16x32_bf16 v[208:211], a[100:103], a[76:79], v[208:211]
    v_accvgpr_read_b32 v60, a140
    v_cvt_pk_bf16_f32 v104, v104, v105
    v_accvgpr_read_b32 v61, a141
    v_mfma_f32_16x16x32_bf16 v[116:119], a[104:107], a[76:79], v[116:119]
    buffer_load_dwordx4 v40, s[12:15], s61 offen offset:2048 lds
    buffer_load_dwordx4 v41, s[12:15], s61 offen offset:3072 lds
    v_mfma_f32_16x16x32_bf16 v[212:215], a[108:111], a[76:79], v[212:215]
    s_add_u32 s61, s61, 0x80000
    v_accvgpr_read_b32 v62, a142
    v_cvt_pk_bf16_f32 v105, v106, v107
    v_accvgpr_read_b32 v63, a143
    v_mfma_f32_16x16x32_bf16 a[152:155], a[120:123], a[88:91], a[152:155]
    v_cvt_pk_bf16_f32 v106, v200, v201
    v_cvt_pk_bf16_f32 v164, v56, v57
    v_cvt_pk_bf16_f32 v107, v202, v203
    v_mfma_f32_16x16x32_bf16 a[156:159], a[124:127], a[88:91], a[156:159]
    v_cvt_pk_bf16_f32 v165, v58, v59
    v_cvt_pk_bf16_f32 v108, v108, v109
    v_cvt_pk_bf16_f32 v166, v60, v61
    v_mfma_f32_16x16x32_bf16 v[120:123], a[112:115], a[76:79], v[120:123]
    v_cvt_pk_bf16_f32 v109, v110, v111
    v_cvt_pk_bf16_f32 v167, v62, v63
    v_cvt_pk_bf16_f32 v110, v204, v205
    v_mfma_f32_16x16x32_bf16 v[216:219], a[116:119], a[76:79], v[216:219]
    buffer_load_dwordx4 a[224:227], v36, s[8:11], s62 offen sc1
    v_cvt_pk_bf16_f32 v111, v206, v207
    v_accvgpr_read_b32 v56, a144
    v_mfma_f32_16x16x32_bf16 v[124:127], a[120:123], a[76:79], v[124:127]
    v_accvgpr_read_b32 v57, a145
    v_accvgpr_read_b32 v58, a146
    v_accvgpr_read_b32 v59, a147
    v_mfma_f32_16x16x32_bf16 v[220:223], a[124:127], a[76:79], v[220:223]
    buffer_load_dwordx4 a[228:231], v54, s[8:11], s62 offen sc1
    v_accvgpr_read_b32 v60, a148
    v_cvt_pk_bf16_f32 v112, v112, v113
    v_mfma_f32_16x16x32_bf16 a[160:163], a[96:99], a[92:95], a[160:163]
    v_accvgpr_read_b32 v61, a149
    v_accvgpr_read_b32 v62, a150
    v_cvt_pk_bf16_f32 v113, v114, v115
    v_mfma_f32_16x16x32_bf16 a[164:167], a[100:103], a[92:95], a[164:167]
    v_accvgpr_read_b32 v63, a151
    v_cvt_pk_bf16_f32 v114, v208, v209
    v_cvt_pk_bf16_f32 v168, v56, v57
    v_mfma_f32_16x16x32_bf16 v[128:131], a[96:99], a[80:83], v[128:131]
    v_cvt_pk_bf16_f32 v115, v210, v211
    v_cvt_pk_bf16_f32 v169, v58, v59
    v_cvt_pk_bf16_f32 v116, v116, v117
    v_mfma_f32_16x16x32_bf16 v[224:227], a[100:103], a[80:83], v[224:227]
    buffer_load_dwordx4 a[232:235], v37, s[8:11], s62 offen sc1
    v_cvt_pk_bf16_f32 v170, v60, v61
    v_cvt_pk_bf16_f32 v117, v118, v119
    v_mfma_f32_16x16x32_bf16 v[132:135], a[104:107], a[80:83], v[132:135]
    v_cvt_pk_bf16_f32 v171, v62, v63
    v_cvt_pk_bf16_f32 v118, v212, v213
    v_cvt_pk_bf16_f32 v119, v214, v215
    v_mfma_f32_16x16x32_bf16 v[228:231], a[108:111], a[80:83], v[228:231]
    buffer_load_dwordx4 a[236:239], v55, s[8:11], s62 offen sc1
    v_accvgpr_read_b32 v56, a152
    v_accvgpr_read_b32 v57, a153
    v_mfma_f32_16x16x32_bf16 a[168:171], a[104:107], a[92:95], a[168:171]
    s_add_u32 s62, s62, 0x20000
    v_accvgpr_read_b32 v58, a154
    v_accvgpr_read_b32 v59, a155
    v_accvgpr_read_b32 v60, a156
    v_mfma_f32_16x16x32_bf16 a[172:175], a[108:111], a[92:95], a[172:175]
    s_waitcnt vmcnt(16)
    s_barrier
    v_cvt_pk_bf16_f32 v120, v120, v121
    v_accvgpr_read_b32 v61, a157
    v_accvgpr_read_b32 v62, a158
    v_mfma_f32_16x16x32_bf16 v[136:139], a[112:115], a[80:83], v[136:139]
    v_cvt_pk_bf16_f32 v121, v122, v123
    v_accvgpr_read_b32 v63, a159
    v_cvt_pk_bf16_f32 v122, v216, v217
    v_mfma_f32_16x16x32_bf16 v[232:235], a[116:119], a[80:83], v[232:235]
    v_cvt_pk_bf16_f32 v172, v56, v57
    v_cvt_pk_bf16_f32 v123, v218, v219
    v_cvt_pk_bf16_f32 v173, v58, v59
    v_mfma_f32_16x16x32_bf16 v[140:143], a[120:123], a[80:83], v[140:143]
    v_cvt_pk_bf16_f32 v124, v124, v125
    v_cvt_pk_bf16_f32 v174, v60, v61
    v_cvt_pk_bf16_f32 v125, v126, v127
    v_mfma_f32_16x16x32_bf16 v[236:239], a[124:127], a[80:83], v[236:239]
    v_cvt_pk_bf16_f32 v175, v62, v63
    v_cvt_pk_bf16_f32 v126, v220, v221
    v_cvt_pk_bf16_f32 v127, v222, v223
    v_mfma_f32_16x16x32_bf16 a[176:179], a[112:115], a[92:95], a[176:179]
    ds_read_b64_tr_b16 a[0:1], v42 offset:0
    v_accvgpr_read_b32 v56, a160
    v_accvgpr_read_b32 v57, a161
    v_mfma_f32_16x16x32_bf16 a[180:183], a[116:119], a[92:95], a[180:183]
    ds_read_b64_tr_b16 a[2:3], v42 offset:1024
    v_accvgpr_read_b32 v58, a162
    v_accvgpr_read_b32 v59, a163
    v_mfma_f32_16x16x32_bf16 v[144:147], a[96:99], a[84:87], v[144:147]
    ds_read_b64_tr_b16 a[4:5], v43 offset:0
    v_accvgpr_read_b32 v60, a164
    v_cvt_pk_bf16_f32 v128, v128, v129
    v_mfma_f32_16x16x32_bf16 v[240:243], a[100:103], a[84:87], v[240:243]
    v_accvgpr_read_b32 v61, a165
    v_accvgpr_read_b32 v62, a166
    v_cvt_pk_bf16_f32 v129, v130, v131
    v_mfma_f32_16x16x32_bf16 v[148:151], a[104:107], a[84:87], v[148:151]
    ds_read_b64_tr_b16 a[6:7], v43 offset:1024
    v_accvgpr_read_b32 v63, a167
    v_cvt_pk_bf16_f32 v130, v224, v225
    v_mfma_f32_16x16x32_bf16 v[244:247], a[108:111], a[84:87], v[244:247]
    v_cvt_pk_bf16_f32 v176, v56, v57
    v_cvt_pk_bf16_f32 v131, v226, v227
    v_cvt_pk_bf16_f32 v177, v58, v59
    v_mfma_f32_16x16x32_bf16 a[184:187], a[120:123], a[92:95], a[184:187]
    ds_read_b64_tr_b16 a[8:9], v44 offset:0
    v_cvt_pk_bf16_f32 v132, v132, v133
    v_cvt_pk_bf16_f32 v178, v60, v61
    v_mfma_f32_16x16x32_bf16 a[188:191], a[124:127], a[92:95], a[188:191]
    ds_read_b64_tr_b16 a[10:11], v44 offset:1024
    v_cvt_pk_bf16_f32 v133, v134, v135
    v_cvt_pk_bf16_f32 v179, v62, v63
    v_mfma_f32_16x16x32_bf16 v[152:155], a[112:115], a[84:87], v[152:155]
    ds_read_b64_tr_b16 a[12:13], v45 offset:0
    v_cvt_pk_bf16_f32 v134, v228, v229
    v_cvt_pk_bf16_f32 v135, v230, v231
    v_mfma_f32_16x16x32_bf16 v[248:251], a[116:119], a[84:87], v[248:251]
    ds_read_b64_tr_b16 a[14:15], v45 offset:1024
    v_accvgpr_read_b32 v56, a168
    v_accvgpr_read_b32 v57, a169
    v_mfma_f32_16x16x32_bf16 v[156:159], a[120:123], a[84:87], v[156:159]
    ds_read_b64_tr_b16 a[16:17], v46 offset:0
    v_accvgpr_read_b32 v58, a170
    v_accvgpr_read_b32 v59, a171
    v_mfma_f32_16x16x32_bf16 v[252:255], a[124:127], a[84:87], v[252:255]
    v_accvgpr_read_b32 v60, a172
    v_cvt_pk_bf16_f32 v136, v136, v137
    v_accvgpr_read_b32 v61, a173
    ds_read_b64_tr_b16 a[18:19], v46 offset:1024
    v_accvgpr_read_b32 v62, a174
    v_cvt_pk_bf16_f32 v137, v138, v139
    v_accvgpr_read_b32 v63, a175
    v_cvt_pk_bf16_f32 v138, v232, v233
    v_cvt_pk_bf16_f32 v180, v56, v57
    ds_read_b64_tr_b16 a[20:21], v47 offset:0
    v_cvt_pk_bf16_f32 v139, v234, v235
    v_cvt_pk_bf16_f32 v181, v58, v59
    v_cvt_pk_bf16_f32 v140, v140, v141
    v_cvt_pk_bf16_f32 v182, v60, v61
    ds_read_b64_tr_b16 a[22:23], v47 offset:1024
    v_cvt_pk_bf16_f32 v141, v142, v143
    v_cvt_pk_bf16_f32 v183, v62, v63
    v_cvt_pk_bf16_f32 v142, v236, v237
    ds_read_b64_tr_b16 a[24:25], v48 offset:0
    v_cvt_pk_bf16_f32 v143, v238, v239
    v_accvgpr_read_b32 v56, a176
    ds_read_b64_tr_b16 a[26:27], v48 offset:1024
    v_accvgpr_read_b32 v57, a177
    v_accvgpr_read_b32 v58, a178
    ds_read_b64_tr_b16 a[28:29], v49 offset:0
    v_accvgpr_read_b32 v59, a179
    v_accvgpr_read_b32 v60, a180
    v_cvt_pk_bf16_f32 v144, v144, v145
    ds_read_b64_tr_b16 a[30:31], v49 offset:1024
    v_accvgpr_read_b32 v61, a181
    v_accvgpr_read_b32 v62, a182
    v_cvt_pk_bf16_f32 v145, v146, v147
    v_accvgpr_read_b32 v63, a183
    v_cvt_pk_bf16_f32 v146, v240, v241
    v_cvt_pk_bf16_f32 v184, v56, v57
    v_cvt_pk_bf16_f32 v147, v242, v243
    v_cvt_pk_bf16_f32 v185, v58, v59
    v_cvt_pk_bf16_f32 v148, v148, v149
    v_cvt_pk_bf16_f32 v186, v60, v61
    v_cvt_pk_bf16_f32 v149, v150, v151
    v_cvt_pk_bf16_f32 v187, v62, v63
    v_cvt_pk_bf16_f32 v150, v244, v245
    v_cvt_pk_bf16_f32 v151, v246, v247
    v_accvgpr_read_b32 v56, a184
    v_accvgpr_read_b32 v57, a185
    v_accvgpr_read_b32 v58, a186
    v_accvgpr_read_b32 v59, a187
    v_accvgpr_read_b32 v60, a188
    v_cvt_pk_bf16_f32 v152, v152, v153
    v_accvgpr_read_b32 v61, a189
    v_accvgpr_read_b32 v62, a190
    v_cvt_pk_bf16_f32 v153, v154, v155
    v_accvgpr_read_b32 v63, a191
    v_cvt_pk_bf16_f32 v154, v248, v249
    v_cvt_pk_bf16_f32 v188, v56, v57
    v_cvt_pk_bf16_f32 v155, v250, v251
    v_cvt_pk_bf16_f32 v189, v58, v59
    v_cvt_pk_bf16_f32 v156, v156, v157
    v_cvt_pk_bf16_f32 v190, v60, v61
    v_cvt_pk_bf16_f32 v157, v158, v159
    v_cvt_pk_bf16_f32 v191, v62, v63
    v_cvt_pk_bf16_f32 v158, v252, v253
    v_cvt_pk_bf16_f32 v159, v254, v255
    s_branch k12_join_7
k12_v_6:
k12_loop_24:
    v_mfma_f32_16x16x32_bf16 v[64:67], a[0:3], a[32:35], v[64:67]
    ds_read_b128 a[64:67], v27 offset:0
    v_mfma_f32_16x16x32_bf16 v[68:71], a[0:3], a[36:39], v[68:71]
    ds_read_b64_tr_b16 a[96:97], v28 offset:16384
    v_mfma_f32_16x16x32_bf16 v[72:75], a[0:3], a[40:43], v[72:75]
    v_mfma_f32_16x16x32_bf16 v[76:79], a[0:3], a[44:47], v[76:79]
    s_cmp_eq_u32 s51, s46
    s_cbranch_scc1 k12_ool_26
k12_oolret_27:
    v_mfma_f32_16x16x32_bf16 v[80:83], a[0:3], a[48:51], v[80:83]
    ds_read_b64_tr_b16 a[98:99], v28 offset:18432
    v_mfma_f32_16x16x32_bf16 v[84:87], a[0:3], a[52:55], v[84:87]
    ds_read_b128 a[68:71], v27 offset:2048
    v_mfma_f32_16x16x32_bf16 v[88:91], a[0:3], a[56:59], v[88:91]
    v_mfma_f32_16x16x32_bf16 v[92:95], a[0:3], a[60:63], v[92:95]
    ds_read_b64_tr_b16 a[100:101], v29 offset:16384
    v_mfma_f32_16x16x32_bf16 v[160:163], a[4:7], a[32:35], v[160:163]
    v_mfma_f32_16x16x32_bf16 v[164:167], a[4:7], a[36:39], v[164:167]
    ds_read_b64_tr_b16 a[102:103], v29 offset:18432
    v_mfma_f32_16x16x32_bf16 v[168:171], a[4:7], a[40:43], v[168:171]
    v_mfma_f32_16x16x32_bf16 v[172:175], a[4:7], a[44:47], v[172:175]
    ds_read_b128 a[72:75], v27 offset:4096
    v_mfma_f32_16x16x32_bf16 v[176:179], a[4:7], a[48:51], v[176:179]
    v_mfma_f32_16x16x32_bf16 v[180:183], a[4:7], a[52:55], v[180:183]
    v_mfma_f32_16x16x32_bf16 v[184:187], a[4:7], a[56:59], v[184:187]
    ds_read_b64_tr_b16 a[104:105], v30 offset:16384
    v_mfma_f32_16x16x32_bf16 v[188:191], a[4:7], a[60:63], v[188:191]
    v_mfma_f32_16x16x32_bf16 v[96:99], a[8:11], a[32:35], v[96:99]
    ds_read_b64_tr_b16 a[106:107], v30 offset:18432
    v_mfma_f32_16x16x32_bf16 v[100:103], a[8:11], a[36:39], v[100:103]
    v_mfma_f32_16x16x32_bf16 v[104:107], a[8:11], a[40:43], v[104:107]
    ds_read_b128 a[76:79], v27 offset:6144
    v_mfma_f32_16x16x32_bf16 v[108:111], a[8:11], a[44:47], v[108:111]
    v_mfma_f32_16x16x32_bf16 v[112:115], a[8:11], a[48:51], v[112:115]
    ds_read_b64_tr_b16 a[108:109], v31 offset:16384
    v_mfma_f32_16x16x32_bf16 v[116:119], a[8:11], a[52:55], v[116:119]
    v_mfma_f32_16x16x32_bf16 v[120:123], a[8:11], a[56:59], v[120:123]
    ds_read_b64_tr_b16 a[110:111], v31 offset:18432
    v_mfma_f32_16x16x32_bf16 v[124:127], a[8:11], a[60:63], v[124:127]
    v_mfma_f32_16x16x32_bf16 v[192:195], a[12:15], a[32:35], v[192:195]
    ds_read_b128 a[80:83], v27 offset:8192
    v_mfma_f32_16x16x32_bf16 v[196:199], a[12:15], a[36:39], v[196:199]
    v_mfma_f32_16x16x32_bf16 v[200:203], a[12:15], a[40:43], v[200:203]
    ds_read_b64_tr_b16 a[112:113], v32 offset:16384
    v_mfma_f32_16x16x32_bf16 v[204:207], a[12:15], a[44:47], v[204:207]
    v_mfma_f32_16x16x32_bf16 v[208:211], a[12:15], a[48:51], v[208:211]
    ds_read_b64_tr_b16 a[114:115], v32 offset:18432
    v_mfma_f32_16x16x32_bf16 v[212:215], a[12:15], a[52:55], v[212:215]
    v_mfma_f32_16x16x32_bf16 v[216:219], a[12:15], a[56:59], v[216:219]
    ds_read_b128 a[84:87], v27 offset:10240
    v_mfma_f32_16x16x32_bf16 v[220:223], a[12:15], a[60:63], v[220:223]
    v_mfma_f32_16x16x32_bf16 v[128:131], a[16:19], a[32:35], v[128:131]
    ds_read_b64_tr_b16 a[116:117], v33 offset:16384
    v_mfma_f32_16x16x32_bf16 v[132:135], a[16:19], a[36:39], v[132:135]
    v_mfma_f32_16x16x32_bf16 v[136:139], a[16:19], a[40:43], v[136:139]
    ds_read_b64_tr_b16 a[118:119], v33 offset:18432
    v_mfma_f32_16x16x32_bf16 v[140:143], a[16:19], a[44:47], v[140:143]
    v_mfma_f32_16x16x32_bf16 v[144:147], a[16:19], a[48:51], v[144:147]
    ds_read_b128 a[88:91], v27 offset:12288
    v_mfma_f32_16x16x32_bf16 v[148:151], a[16:19], a[52:55], v[148:151]
    v_mfma_f32_16x16x32_bf16 v[152:155], a[16:19], a[56:59], v[152:155]
    v_mfma_f32_16x16x32_bf16 v[156:159], a[16:19], a[60:63], v[156:159]
    ds_read_b64_tr_b16 a[120:121], v34 offset:16384
    v_mfma_f32_16x16x32_bf16 v[224:227], a[20:23], a[32:35], v[224:227]
    v_mfma_f32_16x16x32_bf16 v[228:231], a[20:23], a[36:39], v[228:231]
    ds_read_b64_tr_b16 a[122:123], v34 offset:18432
    v_mfma_f32_16x16x32_bf16 v[232:235], a[20:23], a[40:43], v[232:235]
    v_mfma_f32_16x16x32_bf16 v[236:239], a[20:23], a[44:47], v[236:239]
    ds_read_b128 a[92:95], v27 offset:14336
    v_mfma_f32_16x16x32_bf16 v[240:243], a[20:23], a[48:51], v[240:243]
    v_mfma_f32_16x16x32_bf16 v[244:247], a[20:23], a[52:55], v[244:247]
    ds_read_b64_tr_b16 a[124:125], v35 offset:16384
    v_mfma_f32_16x16x32_bf16 v[248:251], a[20:23], a[56:59], v[248:251]
    v_mfma_f32_16x16x32_bf16 v[252:255], a[20:23], a[60:63], v[252:255]
    ds_read_b64_tr_b16 a[126:127], v35 offset:18432
    v_mfma_f32_16x16x32_bf16 a[128:131], a[24:27], a[32:35], a[128:131]
    v_mfma_f32_16x16x32_bf16 a[136:139], a[24:27], a[36:39], a[136:139]
    v_mfma_f32_16x16x32_bf16 a[144:147], a[24:27], a[40:43], a[144:147]
    v_mfma_f32_16x16x32_bf16 a[152:155], a[24:27], a[44:47], a[152:155]
    v_mfma_f32_16x16x32_bf16 a[160:163], a[24:27], a[48:51], a[160:163]
    v_mfma_f32_16x16x32_bf16 a[168:171], a[24:27], a[52:55], a[168:171]
    v_mfma_f32_16x16x32_bf16 a[176:179], a[24:27], a[56:59], a[176:179]
    v_mfma_f32_16x16x32_bf16 a[184:187], a[24:27], a[60:63], a[184:187]
    v_mfma_f32_16x16x32_bf16 a[132:135], a[28:31], a[32:35], a[132:135]
    v_mfma_f32_16x16x32_bf16 a[140:143], a[28:31], a[36:39], a[140:143]
    v_mfma_f32_16x16x32_bf16 a[148:151], a[28:31], a[40:43], a[148:151]
    v_mfma_f32_16x16x32_bf16 a[156:159], a[28:31], a[44:47], a[156:159]
    v_mfma_f32_16x16x32_bf16 a[164:167], a[28:31], a[48:51], a[164:167]
    v_mfma_f32_16x16x32_bf16 a[172:175], a[28:31], a[52:55], a[172:175]
    v_mfma_f32_16x16x32_bf16 a[180:183], a[28:31], a[56:59], a[180:183]
    v_mfma_f32_16x16x32_bf16 a[188:191], a[28:31], a[60:63], a[188:191]
    s_waitcnt vmcnt(0) lgkmcnt(0)
    s_barrier
    v_mfma_f32_16x16x32_bf16 v[64:67], a[64:67], a[96:99], v[64:67]
    s_cmp_ge_u32 s49, 1024
    s_cselect_b32 s18, 0, s18
    s_cselect_b32 s22, 0, s22
    ds_read_b128 a[0:3], v26 offset:32768
    v_mfma_f32_16x16x32_bf16 v[68:71], a[64:67], a[100:103], v[68:71]
    s_add_u32 m0, s48, 0
    ds_read_b64_tr_b16 a[32:33], v28 offset:32768
    v_mfma_f32_16x16x32_bf16 v[72:75], a[64:67], a[104:107], v[72:75]
    buffer_load_dwordx4 v10, s[16:19], s49 offen offset:0 lds
    v_mfma_f32_16x16x32_bf16 v[76:79], a[64:67], a[108:111], v[76:79]
    ds_read_b64_tr_b16 a[34:35], v28 offset:34816
    v_mfma_f32_16x16x32_bf16 v[80:83], a[64:67], a[112:115], v[80:83]
    buffer_load_dwordx4 v11, s[16:19], s49 offen offset:1024 lds
    v_mfma_f32_16x16x32_bf16 v[84:87], a[64:67], a[116:119], v[84:87]
    ds_read_b128 a[4:7], v26 offset:34816
    v_mfma_f32_16x16x32_bf16 v[88:91], a[64:67], a[120:123], v[88:91]
    v_mfma_f32_16x16x32_bf16 v[92:95], a[64:67], a[124:127], v[92:95]
    ds_read_b64_tr_b16 a[36:37], v29 offset:32768
    v_mfma_f32_16x16x32_bf16 v[160:163], a[68:71], a[96:99], v[160:163]
    buffer_load_dwordx4 v12, s[16:19], s49 offen offset:2048 lds
    v_mfma_f32_16x16x32_bf16 v[164:167], a[68:71], a[100:103], v[164:167]
    ds_read_b64_tr_b16 a[38:39], v29 offset:34816
    v_mfma_f32_16x16x32_bf16 v[168:171], a[68:71], a[104:107], v[168:171]
    v_mfma_f32_16x16x32_bf16 v[172:175], a[68:71], a[108:111], v[172:175]
    buffer_load_dwordx4 v13, s[16:19], s49 offen offset:3072 lds
    ds_read_b128 a[8:11], v26 offset:36864
    v_mfma_f32_16x16x32_bf16 v[176:179], a[68:71], a[112:115], v[176:179]
    v_mfma_f32_16x16x32_bf16 v[180:183], a[68:71], a[116:119], v[180:183]
    s_add_u32 m0, s48, 4096
    v_mfma_f32_16x16x32_bf16 v[184:187], a[68:71], a[120:123], v[184:187]
    ds_read_b64_tr_b16 a[40:41], v30 offset:32768
    v_mfma_f32_16x16x32_bf16 v[188:191], a[68:71], a[124:127], v[188:191]
    buffer_load_dwordx4 v14, s[16:19], s49 offen offset:0 lds
    v_mfma_f32_16x16x32_bf16 v[96:99], a[72:75], a[96:99], v[96:99]
    ds_read_b64_tr_b16 a[42:43], v30 offset:34816
    v_mfma_f32_16x16x32_bf16 v[100:103], a[72:75], a[100:103], v[100:103]
    v_mfma_f32_16x16x32_bf16 v[104:107], a[72:75], a[104:107], v[104:107]
    buffer_load_dwordx4 v15, s[16:19], s49 offen offset:1024 lds
    ds_read_b128 a[12:15], v26 offset:38912
    v_mfma_f32_16x16x32_bf16 v[108:111], a[72:75], a[108:111], v[108:111]
    v_mfma_f32_16x16x32_bf16 v[112:115], a[72:75], a[112:115], v[112:115]
    ds_read_b64_tr_b16 a[44:45], v31 offset:32768
    v_mfma_f32_16x16x32_bf16 v[116:119], a[72:75], a[116:119], v[116:119]
    v_mfma_f32_16x16x32_bf16 v[120:123], a[72:75], a[120:123], v[120:123]
    buffer_load_dwordx4 v16, s[16:19], s49 offen offset:2048 lds
    ds_read_b64_tr_b16 a[46:47], v31 offset:34816
    v_mfma_f32_16x16x32_bf16 v[124:127], a[72:75], a[124:127], v[124:127]
    v_mfma_f32_16x16x32_bf16 v[192:195], a[76:79], a[96:99], v[192:195]
    ds_read_b128 a[16:19], v26 offset:40960
    v_mfma_f32_16x16x32_bf16 v[196:199], a[76:79], a[100:103], v[196:199]
    buffer_load_dwordx4 v17, s[16:19], s49 offen offset:3072 lds
    v_mfma_f32_16x16x32_bf16 v[200:203], a[76:79], a[104:107], v[200:203]
    ds_read_b64_tr_b16 a[48:49], v32 offset:32768
    v_mfma_f32_16x16x32_bf16 v[204:207], a[76:79], a[108:111], v[204:207]
    s_add_u32 s49, s49, 128
    v_mfma_f32_16x16x32_bf16 v[208:211], a[76:79], a[112:115], v[208:211]
    s_add_u32 m0, s48, 65536
    ds_read_b64_tr_b16 a[50:51], v32 offset:34816
    v_mfma_f32_16x16x32_bf16 v[212:215], a[76:79], a[116:119], v[212:215]
    buffer_load_dwordx4 v18, s[20:23], s50 offen offset:0 lds
    v_mfma_f32_16x16x32_bf16 v[216:219], a[76:79], a[120:123], v[216:219]
    ds_read_b128 a[20:23], v26 offset:43008
    v_mfma_f32_16x16x32_bf16 v[220:223], a[76:79], a[124:127], v[220:223]
    v_mfma_f32_16x16x32_bf16 v[128:131], a[80:83], a[96:99], v[128:131]
    buffer_load_dwordx4 v19, s[20:23], s50 offen offset:1024 lds
    ds_read_b64_tr_b16 a[52:53], v33 offset:32768
    v_mfma_f32_16x16x32_bf16 v[132:135], a[80:83], a[100:103], v[132:135]
    v_mfma_f32_16x16x32_bf16 v[136:139], a[80:83], a[104:107], v[136:139]
    ds_read_b64_tr_b16 a[54:55], v33 offset:34816
    v_mfma_f32_16x16x32_bf16 v[140:143], a[80:83], a[108:111], v[140:143]
    buffer_load_dwordx4 v20, s[20:23], s50 offen offset:2048 lds
    v_mfma_f32_16x16x32_bf16 v[144:147], a[80:83], a[112:115], v[144:147]
    ds_read_b128 a[24:27], v26 offset:45056
    v_mfma_f32_16x16x32_bf16 v[148:151], a[80:83], a[116:119], v[148:151]
    v_mfma_f32_16x16x32_bf16 v[152:155], a[80:83], a[120:123], v[152:155]
    v_mfma_f32_16x16x32_bf16 v[156:159], a[80:83], a[124:127], v[156:159]
    buffer_load_dwordx4 v21, s[20:23], s50 offen offset:3072 lds
    ds_read_b64_tr_b16 a[56:57], v34 offset:32768
    v_mfma_f32_16x16x32_bf16 v[224:227], a[84:87], a[96:99], v[224:227]
    s_add_u32 m0, s48, 69632
    v_mfma_f32_16x16x32_bf16 v[228:231], a[84:87], a[100:103], v[228:231]
    ds_read_b64_tr_b16 a[58:59], v34 offset:34816
    v_mfma_f32_16x16x32_bf16 v[232:235], a[84:87], a[104:107], v[232:235]
    buffer_load_dwordx4 v22, s[20:23], s50 offen offset:0 lds
    v_mfma_f32_16x16x32_bf16 v[236:239], a[84:87], a[108:111], v[236:239]
    ds_read_b128 a[28:31], v26 offset:47104
    v_mfma_f32_16x16x32_bf16 v[240:243], a[84:87], a[112:115], v[240:243]
    v_mfma_f32_16x16x32_bf16 v[244:247], a[84:87], a[116:119], v[244:247]
    ds_read_b64_tr_b16 a[60:61], v35 offset:32768
    v_mfma_f32_16x16x32_bf16 v[248:251], a[84:87], a[120:123], v[248:251]
    buffer_load_dwordx4 v23, s[20:23], s50 offen offset:1024 lds
    v_mfma_f32_16x16x32_bf16 v[252:255], a[84:87], a[124:127], v[252:255]
    ds_read_b64_tr_b16 a[62:63], v35 offset:34816
    v_mfma_f32_16x16x32_bf16 a[128:131], a[88:91], a[96:99], a[128:131]
    v_mfma_f32_16x16x32_bf16 a[136:139], a[88:91], a[100:103], a[136:139]
    buffer_load_dwordx4 v24, s[20:23], s50 offen offset:2048 lds
    v_mfma_f32_16x16x32_bf16 a[144:147], a[88:91], a[104:107], a[144:147]
    v_mfma_f32_16x16x32_bf16 a[152:155], a[88:91], a[108:111], a[152:155]
    v_mfma_f32_16x16x32_bf16 a[160:163], a[88:91], a[112:115], a[160:163]
    v_mfma_f32_16x16x32_bf16 a[168:171], a[88:91], a[116:119], a[168:171]
    buffer_load_dwordx4 v25, s[20:23], s50 offen offset:3072 lds
    v_mfma_f32_16x16x32_bf16 a[176:179], a[88:91], a[120:123], a[176:179]
    v_mfma_f32_16x16x32_bf16 a[184:187], a[88:91], a[124:127], a[184:187]
    s_add_u32 s50, s50, 0x80000
    v_mfma_f32_16x16x32_bf16 a[132:135], a[92:95], a[96:99], a[132:135]
    v_mfma_f32_16x16x32_bf16 a[140:143], a[92:95], a[100:103], a[140:143]
    s_cmp_eq_u32 s51, s53
    s_cbranch_scc1 k12_ool_28
k12_oolret_29:
    v_mfma_f32_16x16x32_bf16 a[148:151], a[92:95], a[104:107], a[148:151]
    v_mfma_f32_16x16x32_bf16 a[156:159], a[92:95], a[108:111], a[156:159]
    s_cmp_eq_u32 s51, s63
    s_cbranch_scc1 k12_ool_30
k12_oolret_31:
    v_mfma_f32_16x16x32_bf16 a[164:167], a[92:95], a[112:115], a[164:167]
    v_mfma_f32_16x16x32_bf16 a[172:175], a[92:95], a[116:119], a[172:175]
    s_add_u32 s51, s51, 1
    v_mfma_f32_16x16x32_bf16 a[180:183], a[92:95], a[120:123], a[180:183]
    v_mfma_f32_16x16x32_bf16 a[188:191], a[92:95], a[124:127], a[188:191]
    s_waitcnt lgkmcnt(0)
    v_mfma_f32_16x16x32_bf16 v[64:67], a[0:3], a[32:35], v[64:67]
    ds_read_b128 a[64:67], v27 offset:32768
    v_mfma_f32_16x16x32_bf16 v[68:71], a[0:3], a[36:39], v[68:71]
    ds_read_b64_tr_b16 a[96:97], v28 offset:49152
    v_mfma_f32_16x16x32_bf16 v[72:75], a[0:3], a[40:43], v[72:75]
    v_mfma_f32_16x16x32_bf16 v[76:79], a[0:3], a[44:47], v[76:79]
    ds_read_b64_tr_b16 a[98:99], v28 offset:51200
    v_mfma_f32_16x16x32_bf16 v[80:83], a[0:3], a[48:51], v[80:83]
    v_mfma_f32_16x16x32_bf16 v[84:87], a[0:3], a[52:55], v[84:87]
    ds_read_b128 a[68:71], v27 offset:34816
    v_mfma_f32_16x16x32_bf16 v[88:91], a[0:3], a[56:59], v[88:91]
    v_mfma_f32_16x16x32_bf16 v[92:95], a[0:3], a[60:63], v[92:95]
    ds_read_b64_tr_b16 a[100:101], v29 offset:49152
    v_mfma_f32_16x16x32_bf16 v[160:163], a[4:7], a[32:35], v[160:163]
    v_mfma_f32_16x16x32_bf16 v[164:167], a[4:7], a[36:39], v[164:167]
    ds_read_b64_tr_b16 a[102:103], v29 offset:51200
    v_mfma_f32_16x16x32_bf16 v[168:171], a[4:7], a[40:43], v[168:171]
    v_mfma_f32_16x16x32_bf16 v[172:175], a[4:7], a[44:47], v[172:175]
    ds_read_b128 a[72:75], v27 offset:36864
    v_mfma_f32_16x16x32_bf16 v[176:179], a[4:7], a[48:51], v[176:179]
    v_mfma_f32_16x16x32_bf16 v[180:183], a[4:7], a[52:55], v[180:183]
    v_mfma_f32_16x16x32_bf16 v[184:187], a[4:7], a[56:59], v[184:187]
    ds_read_b64_tr_b16 a[104:105], v30 offset:49152
    v_mfma_f32_16x16x32_bf16 v[188:191], a[4:7], a[60:63], v[188:191]
    v_mfma_f32_16x16x32_bf16 v[96:99], a[8:11], a[32:35], v[96:99]
    ds_read_b64_tr_b16 a[106:107], v30 offset:51200
    v_mfma_f32_16x16x32_bf16 v[100:103], a[8:11], a[36:39], v[100:103]
    v_mfma_f32_16x16x32_bf16 v[104:107], a[8:11], a[40:43], v[104:107]
    ds_read_b128 a[76:79], v27 offset:38912
    v_mfma_f32_16x16x32_bf16 v[108:111], a[8:11], a[44:47], v[108:111]
    v_mfma_f32_16x16x32_bf16 v[112:115], a[8:11], a[48:51], v[112:115]
    ds_read_b64_tr_b16 a[108:109], v31 offset:49152
    v_mfma_f32_16x16x32_bf16 v[116:119], a[8:11], a[52:55], v[116:119]
    v_mfma_f32_16x16x32_bf16 v[120:123], a[8:11], a[56:59], v[120:123]
    ds_read_b64_tr_b16 a[110:111], v31 offset:51200
    v_mfma_f32_16x16x32_bf16 v[124:127], a[8:11], a[60:63], v[124:127]
    v_mfma_f32_16x16x32_bf16 v[192:195], a[12:15], a[32:35], v[192:195]
    ds_read_b128 a[80:83], v27 offset:40960
    v_mfma_f32_16x16x32_bf16 v[196:199], a[12:15], a[36:39], v[196:199]
    v_mfma_f32_16x16x32_bf16 v[200:203], a[12:15], a[40:43], v[200:203]
    ds_read_b64_tr_b16 a[112:113], v32 offset:49152
    v_mfma_f32_16x16x32_bf16 v[204:207], a[12:15], a[44:47], v[204:207]
    v_mfma_f32_16x16x32_bf16 v[208:211], a[12:15], a[48:51], v[208:211]
    ds_read_b64_tr_b16 a[114:115], v32 offset:51200
    v_mfma_f32_16x16x32_bf16 v[212:215], a[12:15], a[52:55], v[212:215]
    v_mfma_f32_16x16x32_bf16 v[216:219], a[12:15], a[56:59], v[216:219]
    ds_read_b128 a[84:87], v27 offset:43008
    v_mfma_f32_16x16x32_bf16 v[220:223], a[12:15], a[60:63], v[220:223]
    v_mfma_f32_16x16x32_bf16 v[128:131], a[16:19], a[32:35], v[128:131]
    ds_read_b64_tr_b16 a[116:117], v33 offset:49152
    v_mfma_f32_16x16x32_bf16 v[132:135], a[16:19], a[36:39], v[132:135]
    v_mfma_f32_16x16x32_bf16 v[136:139], a[16:19], a[40:43], v[136:139]
    ds_read_b64_tr_b16 a[118:119], v33 offset:51200
    v_mfma_f32_16x16x32_bf16 v[140:143], a[16:19], a[44:47], v[140:143]
    v_mfma_f32_16x16x32_bf16 v[144:147], a[16:19], a[48:51], v[144:147]
    ds_read_b128 a[88:91], v27 offset:45056
    v_mfma_f32_16x16x32_bf16 v[148:151], a[16:19], a[52:55], v[148:151]
    v_mfma_f32_16x16x32_bf16 v[152:155], a[16:19], a[56:59], v[152:155]
    v_mfma_f32_16x16x32_bf16 v[156:159], a[16:19], a[60:63], v[156:159]
    ds_read_b64_tr_b16 a[120:121], v34 offset:49152
    v_mfma_f32_16x16x32_bf16 v[224:227], a[20:23], a[32:35], v[224:227]
    v_mfma_f32_16x16x32_bf16 v[228:231], a[20:23], a[36:39], v[228:231]
    ds_read_b64_tr_b16 a[122:123], v34 offset:51200
    v_mfma_f32_16x16x32_bf16 v[232:235], a[20:23], a[40:43], v[232:235]
    v_mfma_f32_16x16x32_bf16 v[236:239], a[20:23], a[44:47], v[236:239]
    ds_read_b128 a[92:95], v27 offset:47104
    v_mfma_f32_16x16x32_bf16 v[240:243], a[20:23], a[48:51], v[240:243]
    v_mfma_f32_16x16x32_bf16 v[244:247], a[20:23], a[52:55], v[244:247]
    ds_read_b64_tr_b16 a[124:125], v35 offset:49152
    v_mfma_f32_16x16x32_bf16 v[248:251], a[20:23], a[56:59], v[248:251]
    v_mfma_f32_16x16x32_bf16 v[252:255], a[20:23], a[60:63], v[252:255]
    ds_read_b64_tr_b16 a[126:127], v35 offset:51200
    v_mfma_f32_16x16x32_bf16 a[128:131], a[24:27], a[32:35], a[128:131]
    v_mfma_f32_16x16x32_bf16 a[136:139], a[24:27], a[36:39], a[136:139]
    v_mfma_f32_16x16x32_bf16 a[144:147], a[24:27], a[40:43], a[144:147]
    v_mfma_f32_16x16x32_bf16 a[152:155], a[24:27], a[44:47], a[152:155]
    v_mfma_f32_16x16x32_bf16 a[160:163], a[24:27], a[48:51], a[160:163]
    v_mfma_f32_16x16x32_bf16 a[168:171], a[24:27], a[52:55], a[168:171]
    v_mfma_f32_16x16x32_bf16 a[176:179], a[24:27], a[56:59], a[176:179]
    v_mfma_f32_16x16x32_bf16 a[184:187], a[24:27], a[60:63], a[184:187]
    s_sub_u32 s52, s51, 1
    s_cmp_eq_u32 s52, s46
    s_cbranch_scc1 k12_ool_34
k12_oolret_35:
    v_mfma_f32_16x16x32_bf16 a[132:135], a[28:31], a[32:35], a[132:135]
    v_mfma_f32_16x16x32_bf16 a[140:143], a[28:31], a[36:39], a[140:143]
    v_mfma_f32_16x16x32_bf16 a[148:151], a[28:31], a[40:43], a[148:151]
    v_mfma_f32_16x16x32_bf16 a[156:159], a[28:31], a[44:47], a[156:159]
    v_mfma_f32_16x16x32_bf16 a[164:167], a[28:31], a[48:51], a[164:167]
    v_mfma_f32_16x16x32_bf16 a[172:175], a[28:31], a[52:55], a[172:175]
    v_mfma_f32_16x16x32_bf16 a[180:183], a[28:31], a[56:59], a[180:183]
    v_mfma_f32_16x16x32_bf16 a[188:191], a[28:31], a[60:63], a[188:191]
    s_waitcnt vmcnt(0) lgkmcnt(0)
    s_barrier
    s_cmp_eq_u32 s51, 7
    s_cbranch_scc1 k12_last_25
    v_mfma_f32_16x16x32_bf16 v[64:67], a[64:67], a[96:99], v[64:67]
    ds_read_b128 a[0:3], v26 offset:0
    v_mfma_f32_16x16x32_bf16 v[68:71], a[64:67], a[100:103], v[68:71]
    s_add_u32 m0, s48, 32768
    ds_read_b64_tr_b16 a[32:33], v28 offset:0
    v_mfma_f32_16x16x32_bf16 v[72:75], a[64:67], a[104:107], v[72:75]
    buffer_load_dwordx4 v10, s[16:19], s49 offen offset:0 lds
    v_mfma_f32_16x16x32_bf16 v[76:79], a[64:67], a[108:111], v[76:79]
    ds_read_b64_tr_b16 a[34:35], v28 offset:2048
    v_mfma_f32_16x16x32_bf16 v[80:83], a[64:67], a[112:115], v[80:83]
    buffer_load_dwordx4 v11, s[16:19], s49 offen offset:1024 lds
    v_mfma_f32_16x16x32_bf16 v[84:87], a[64:67], a[116:119], v[84:87]
    ds_read_b128 a[4:7], v26 offset:2048
    v_mfma_f32_16x16x32_bf16 v[88:91], a[64:67], a[120:123], v[88:91]
    v_mfma_f32_16x16x32_bf16 v[92:95], a[64:67], a[124:127], v[92:95]
    ds_read_b64_tr_b16 a[36:37], v29 offset:0
    v_mfma_f32_16x16x32_bf16 v[160:163], a[68:71], a[96:99], v[160:163]
    buffer_load_dwordx4 v12, s[16:19], s49 offen offset:2048 lds
    v_mfma_f32_16x16x32_bf16 v[164:167], a[68:71], a[100:103], v[164:167]
    ds_read_b64_tr_b16 a[38:39], v29 offset:2048
    v_mfma_f32_16x16x32_bf16 v[168:171], a[68:71], a[104:107], v[168:171]
    v_mfma_f32_16x16x32_bf16 v[172:175], a[68:71], a[108:111], v[172:175]
    buffer_load_dwordx4 v13, s[16:19], s49 offen offset:3072 lds
    ds_read_b128 a[8:11], v26 offset:4096
    v_mfma_f32_16x16x32_bf16 v[176:179], a[68:71], a[112:115], v[176:179]
    v_mfma_f32_16x16x32_bf16 v[180:183], a[68:71], a[116:119], v[180:183]
    s_add_u32 m0, s48, 36864
    v_mfma_f32_16x16x32_bf16 v[184:187], a[68:71], a[120:123], v[184:187]
    ds_read_b64_tr_b16 a[40:41], v30 offset:0
    v_mfma_f32_16x16x32_bf16 v[188:191], a[68:71], a[124:127], v[188:191]
    buffer_load_dwordx4 v14, s[16:19], s49 offen offset:0 lds
    v_mfma_f32_16x16x32_bf16 v[96:99], a[72:75], a[96:99], v[96:99]
    ds_read_b64_tr_b16 a[42:43], v30 offset:2048
    v_mfma_f32_16x16x32_bf16 v[100:103], a[72:75], a[100:103], v[100:103]
    v_mfma_f32_16x16x32_bf16 v[104:107], a[72:75], a[104:107], v[104:107]
    buffer_load_dwordx4 v15, s[16:19], s49 offen offset:1024 lds
    ds_read_b128 a[12:15], v26 offset:6144
    v_mfma_f32_16x16x32_bf16 v[108:111], a[72:75], a[108:111], v[108:111]
    v_mfma_f32_16x16x32_bf16 v[112:115], a[72:75], a[112:115], v[112:115]
    ds_read_b64_tr_b16 a[44:45], v31 offset:0
    v_mfma_f32_16x16x32_bf16 v[116:119], a[72:75], a[116:119], v[116:119]
    v_mfma_f32_16x16x32_bf16 v[120:123], a[72:75], a[120:123], v[120:123]
    buffer_load_dwordx4 v16, s[16:19], s49 offen offset:2048 lds
    ds_read_b64_tr_b16 a[46:47], v31 offset:2048
    v_mfma_f32_16x16x32_bf16 v[124:127], a[72:75], a[124:127], v[124:127]
    v_mfma_f32_16x16x32_bf16 v[192:195], a[76:79], a[96:99], v[192:195]
    ds_read_b128 a[16:19], v26 offset:8192
    v_mfma_f32_16x16x32_bf16 v[196:199], a[76:79], a[100:103], v[196:199]
    buffer_load_dwordx4 v17, s[16:19], s49 offen offset:3072 lds
    v_mfma_f32_16x16x32_bf16 v[200:203], a[76:79], a[104:107], v[200:203]
    ds_read_b64_tr_b16 a[48:49], v32 offset:0
    v_mfma_f32_16x16x32_bf16 v[204:207], a[76:79], a[108:111], v[204:207]
    s_add_u32 s49, s49, 128
    v_mfma_f32_16x16x32_bf16 v[208:211], a[76:79], a[112:115], v[208:211]
    s_add_u32 m0, s48, 98304
    ds_read_b64_tr_b16 a[50:51], v32 offset:2048
    v_mfma_f32_16x16x32_bf16 v[212:215], a[76:79], a[116:119], v[212:215]
    buffer_load_dwordx4 v18, s[20:23], s50 offen offset:0 lds
    v_mfma_f32_16x16x32_bf16 v[216:219], a[76:79], a[120:123], v[216:219]
    ds_read_b128 a[20:23], v26 offset:10240
    v_mfma_f32_16x16x32_bf16 v[220:223], a[76:79], a[124:127], v[220:223]
    v_mfma_f32_16x16x32_bf16 v[128:131], a[80:83], a[96:99], v[128:131]
    buffer_load_dwordx4 v19, s[20:23], s50 offen offset:1024 lds
    ds_read_b64_tr_b16 a[52:53], v33 offset:0
    v_mfma_f32_16x16x32_bf16 v[132:135], a[80:83], a[100:103], v[132:135]
    v_mfma_f32_16x16x32_bf16 v[136:139], a[80:83], a[104:107], v[136:139]
    ds_read_b64_tr_b16 a[54:55], v33 offset:2048
    v_mfma_f32_16x16x32_bf16 v[140:143], a[80:83], a[108:111], v[140:143]
    buffer_load_dwordx4 v20, s[20:23], s50 offen offset:2048 lds
    v_mfma_f32_16x16x32_bf16 v[144:147], a[80:83], a[112:115], v[144:147]
    ds_read_b128 a[24:27], v26 offset:12288
    v_mfma_f32_16x16x32_bf16 v[148:151], a[80:83], a[116:119], v[148:151]
    v_mfma_f32_16x16x32_bf16 v[152:155], a[80:83], a[120:123], v[152:155]
    v_mfma_f32_16x16x32_bf16 v[156:159], a[80:83], a[124:127], v[156:159]
    buffer_load_dwordx4 v21, s[20:23], s50 offen offset:3072 lds
    ds_read_b64_tr_b16 a[56:57], v34 offset:0
    v_mfma_f32_16x16x32_bf16 v[224:227], a[84:87], a[96:99], v[224:227]
    s_add_u32 m0, s48, 102400
    v_mfma_f32_16x16x32_bf16 v[228:231], a[84:87], a[100:103], v[228:231]
    ds_read_b64_tr_b16 a[58:59], v34 offset:2048
    v_mfma_f32_16x16x32_bf16 v[232:235], a[84:87], a[104:107], v[232:235]
    buffer_load_dwordx4 v22, s[20:23], s50 offen offset:0 lds
    v_mfma_f32_16x16x32_bf16 v[236:239], a[84:87], a[108:111], v[236:239]
    ds_read_b128 a[28:31], v26 offset:14336
    v_mfma_f32_16x16x32_bf16 v[240:243], a[84:87], a[112:115], v[240:243]
    v_mfma_f32_16x16x32_bf16 v[244:247], a[84:87], a[116:119], v[244:247]
    ds_read_b64_tr_b16 a[60:61], v35 offset:0
    v_mfma_f32_16x16x32_bf16 v[248:251], a[84:87], a[120:123], v[248:251]
    buffer_load_dwordx4 v23, s[20:23], s50 offen offset:1024 lds
    v_mfma_f32_16x16x32_bf16 v[252:255], a[84:87], a[124:127], v[252:255]
    ds_read_b64_tr_b16 a[62:63], v35 offset:2048
    v_mfma_f32_16x16x32_bf16 a[128:131], a[88:91], a[96:99], a[128:131]
    v_mfma_f32_16x16x32_bf16 a[136:139], a[88:91], a[100:103], a[136:139]
    buffer_load_dwordx4 v24, s[20:23], s50 offen offset:2048 lds
    v_mfma_f32_16x16x32_bf16 a[144:147], a[88:91], a[104:107], a[144:147]
    v_mfma_f32_16x16x32_bf16 a[152:155], a[88:91], a[108:111], a[152:155]
    v_mfma_f32_16x16x32_bf16 a[160:163], a[88:91], a[112:115], a[160:163]
    v_mfma_f32_16x16x32_bf16 a[168:171], a[88:91], a[116:119], a[168:171]
    buffer_load_dwordx4 v25, s[20:23], s50 offen offset:3072 lds
    v_mfma_f32_16x16x32_bf16 a[176:179], a[88:91], a[120:123], a[176:179]
    v_mfma_f32_16x16x32_bf16 a[184:187], a[88:91], a[124:127], a[184:187]
    s_add_u32 s50, s50, 0x80000
    v_mfma_f32_16x16x32_bf16 a[132:135], a[92:95], a[96:99], a[132:135]
    v_mfma_f32_16x16x32_bf16 a[140:143], a[92:95], a[100:103], a[140:143]
    s_cmp_eq_u32 s51, s53
    s_cbranch_scc1 k12_ool_36
k12_oolret_37:
    v_mfma_f32_16x16x32_bf16 a[148:151], a[92:95], a[104:107], a[148:151]
    v_mfma_f32_16x16x32_bf16 a[156:159], a[92:95], a[108:111], a[156:159]
    s_cmp_eq_u32 s51, 5
    s_cbranch_scc1 k12_ool_38
k12_oolret_39:
    v_mfma_f32_16x16x32_bf16 a[164:167], a[92:95], a[112:115], a[164:167]
    v_mfma_f32_16x16x32_bf16 a[172:175], a[92:95], a[116:119], a[172:175]
    s_add_u32 s51, s51, 1
    v_mfma_f32_16x16x32_bf16 a[180:183], a[92:95], a[120:123], a[180:183]
    v_mfma_f32_16x16x32_bf16 a[188:191], a[92:95], a[124:127], a[188:191]
    s_waitcnt lgkmcnt(0)
    s_branch k12_loop_24
k12_last_25:
    v_mfma_f32_16x16x32_bf16 v[64:67], a[64:67], a[96:99], v[64:67]
    s_add_u32 m0, s60, 98304
    v_mfma_f32_16x16x32_bf16 v[160:163], a[68:71], a[96:99], v[160:163]
    buffer_load_dwordx4 v38, s[12:15], s61 offen offset:0 lds
    v_mfma_f32_16x16x32_bf16 v[68:71], a[64:67], a[100:103], v[68:71]
    buffer_load_dwordx4 v39, s[12:15], s61 offen offset:1024 lds
    v_mfma_f32_16x16x32_bf16 v[164:167], a[68:71], a[100:103], v[164:167]
    v_mfma_f32_16x16x32_bf16 v[72:75], a[64:67], a[104:107], v[72:75]
    buffer_load_dwordx4 v40, s[12:15], s61 offen offset:2048 lds
    v_mfma_f32_16x16x32_bf16 v[168:171], a[68:71], a[104:107], v[168:171]
    v_cvt_pk_bf16_f32 v64, v64, v65
    v_cvt_pk_bf16_f32 v65, v66, v67
    v_cvt_pk_bf16_f32 v66, v160, v161
    v_mfma_f32_16x16x32_bf16 v[76:79], a[64:67], a[108:111], v[76:79]
    v_cvt_pk_bf16_f32 v67, v162, v163
    v_mfma_f32_16x16x32_bf16 v[172:175], a[68:71], a[108:111], v[172:175]
    v_cvt_pk_bf16_f32 v68, v68, v69
    v_cvt_pk_bf16_f32 v69, v70, v71
    v_cvt_pk_bf16_f32 v70, v164, v165
    v_mfma_f32_16x16x32_bf16 v[80:83], a[64:67], a[112:115], v[80:83]
    buffer_load_dwordx4 v41, s[12:15], s61 offen offset:3072 lds
    v_mfma_f32_16x16x32_bf16 v[176:179], a[68:71], a[112:115], v[176:179]
    s_add_u32 s61, s61, 0x80000
    v_cvt_pk_bf16_f32 v71, v166, v167
    v_cvt_pk_bf16_f32 v72, v72, v73
    v_cvt_pk_bf16_f32 v73, v74, v75
    v_mfma_f32_16x16x32_bf16 v[84:87], a[64:67], a[116:119], v[84:87]
    buffer_load_dwordx4 a[192:195], v36, s[8:11], s62 offen sc1
    buffer_load_dwordx4 a[196:199], v54, s[8:11], s62 offen sc1
    v_mfma_f32_16x16x32_bf16 v[180:183], a[68:71], a[116:119], v[180:183]
    v_cvt_pk_bf16_f32 v74, v168, v169
    v_cvt_pk_bf16_f32 v75, v170, v171
    v_cvt_pk_bf16_f32 v76, v76, v77
    v_mfma_f32_16x16x32_bf16 v[88:91], a[64:67], a[120:123], v[88:91]
    v_cvt_pk_bf16_f32 v77, v78, v79
    v_cvt_pk_bf16_f32 v78, v172, v173
    v_cvt_pk_bf16_f32 v79, v174, v175
    v_mfma_f32_16x16x32_bf16 v[184:187], a[68:71], a[120:123], v[184:187]
    v_cvt_pk_bf16_f32 v80, v80, v81
    v_cvt_pk_bf16_f32 v81, v82, v83
    v_cvt_pk_bf16_f32 v82, v176, v177
    v_mfma_f32_16x16x32_bf16 v[92:95], a[64:67], a[124:127], v[92:95]
    buffer_load_dwordx4 a[200:203], v37, s[8:11], s62 offen sc1
    buffer_load_dwordx4 a[204:207], v55, s[8:11], s62 offen sc1
    v_mfma_f32_16x16x32_bf16 v[188:191], a[68:71], a[124:127], v[188:191]
    s_add_u32 s62, s62, 0x20000
    v_cvt_pk_bf16_f32 v83, v178, v179
    v_cvt_pk_bf16_f32 v84, v84, v85
    v_cvt_pk_bf16_f32 v85, v86, v87
    v_mfma_f32_16x16x32_bf16 a[128:131], a[88:91], a[96:99], a[128:131]
    v_cvt_pk_bf16_f32 v86, v180, v181
    v_cvt_pk_bf16_f32 v87, v182, v183
    v_mfma_f32_16x16x32_bf16 a[132:135], a[92:95], a[96:99], a[132:135]
    v_cvt_pk_bf16_f32 v88, v88, v89
    v_cvt_pk_bf16_f32 v89, v90, v91
    v_cvt_pk_bf16_f32 v90, v184, v185
    v_mfma_f32_16x16x32_bf16 v[96:99], a[72:75], a[96:99], v[96:99]
    buffer_load_dwordx4 a[208:211], v36, s[8:11], s62 offen sc1
    buffer_load_dwordx4 a[212:215], v54, s[8:11], s62 offen sc1
    v_mfma_f32_16x16x32_bf16 v[192:195], a[76:79], a[96:99], v[192:195]
    v_cvt_pk_bf16_f32 v91, v186, v187
    v_cvt_pk_bf16_f32 v92, v92, v93
    v_cvt_pk_bf16_f32 v93, v94, v95
    v_mfma_f32_16x16x32_bf16 v[100:103], a[72:75], a[100:103], v[100:103]
    v_cvt_pk_bf16_f32 v94, v188, v189
    v_cvt_pk_bf16_f32 v95, v190, v191
    v_mfma_f32_16x16x32_bf16 v[196:199], a[76:79], a[100:103], v[196:199]
    v_accvgpr_read_b32 v56, a128
    v_accvgpr_read_b32 v57, a129
    v_accvgpr_read_b32 v58, a130
    v_mfma_f32_16x16x32_bf16 a[136:139], a[88:91], a[100:103], a[136:139]
    buffer_load_dwordx4 a[216:219], v37, s[8:11], s62 offen sc1
    buffer_load_dwordx4 a[220:223], v55, s[8:11], s62 offen sc1
    v_mfma_f32_16x16x32_bf16 a[140:143], a[92:95], a[100:103], a[140:143]
    s_add_u32 s62, s62, 0x20000
    v_accvgpr_read_b32 v59, a131
    v_accvgpr_read_b32 v60, a132
    v_cvt_pk_bf16_f32 v96, v96, v97
    v_mfma_f32_16x16x32_bf16 v[104:107], a[72:75], a[104:107], v[104:107]
    s_add_u32 m0, s60, 114688
    v_accvgpr_read_b32 v61, a133
    v_accvgpr_read_b32 v62, a134
    v_cvt_pk_bf16_f32 v97, v98, v99
    v_mfma_f32_16x16x32_bf16 v[200:203], a[76:79], a[104:107], v[200:203]
    v_accvgpr_read_b32 v63, a135
    v_cvt_pk_bf16_f32 v98, v192, v193
    v_cvt_pk_bf16_f32 v160, v56, v57
    v_mfma_f32_16x16x32_bf16 v[108:111], a[72:75], a[108:111], v[108:111]
    v_cvt_pk_bf16_f32 v99, v194, v195
    v_cvt_pk_bf16_f32 v161, v58, v59
    v_cvt_pk_bf16_f32 v100, v100, v101
    v_mfma_f32_16x16x32_bf16 v[204:207], a[76:79], a[108:111], v[204:207]
    buffer_load_dwordx4 v38, s[12:15], s61 offen offset:0 lds
    buffer_load_dwordx4 v39, s[12:15], s61 offen offset:1024 lds
    v_mfma_f32_16x16x32_bf16 a[144:147], a[88:91], a[104:107], a[144:147]
    v_cvt_pk_bf16_f32 v162, v60, v61
    v_cvt_pk_bf16_f32 v101, v102, v103
    v_cvt_pk_bf16_f32 v163, v62, v63
    v_mfma_f32_16x16x32_bf16 a[148:151], a[92:95], a[104:107], a[148:151]
    v_cvt_pk_bf16_f32 v102, v196, v197
    v_cvt_pk_bf16_f32 v103, v198, v199
    v_accvgpr_read_b32 v56, a136
    v_mfma_f32_16x16x32_bf16 v[112:115], a[72:75], a[112:115], v[112:115]
    v_accvgpr_read_b32 v57, a137
    v_accvgpr_read_b32 v58, a138
    v_accvgpr_read_b32 v59, a139
    v_mfma_f32_16x16x32_bf16 v[208:211], a[76:79], a[112:115], v[208:211]
    v_accvgpr_read_b32 v60, a140
    v_cvt_pk_bf16_f32 v104, v104, v105
    v_accvgpr_read_b32 v61, a141
    v_mfma_f32_16x16x32_bf16 v[116:119], a[72:75], a[116:119], v[116:119]
    buffer_load_dwordx4 v40, s[12:15], s61 offen offset:2048 lds
    buffer_load_dwordx4 v41, s[12:15], s61 offen offset:3072 lds
    v_mfma_f32_16x16x32_bf16 v[212:215], a[76:79], a[116:119], v[212:215]
    s_add_u32 s61, s61, 0x80000
    v_accvgpr_read_b32 v62, a142
    v_cvt_pk_bf16_f32 v105, v106, v107
    v_accvgpr_read_b32 v63, a143
    v_mfma_f32_16x16x32_bf16 a[152:155], a[88:91], a[108:111], a[152:155]
    v_cvt_pk_bf16_f32 v106, v200, v201
    v_cvt_pk_bf16_f32 v164, v56, v57
    v_cvt_pk_bf16_f32 v107, v202, v203
    v_mfma_f32_16x16x32_bf16 a[156:159], a[92:95], a[108:111], a[156:159]
    v_cvt_pk_bf16_f32 v165, v58, v59
    v_cvt_pk_bf16_f32 v108, v108, v109
    v_cvt_pk_bf16_f32 v166, v60, v61
    v_mfma_f32_16x16x32_bf16 v[120:123], a[72:75], a[120:123], v[120:123]
    v_cvt_pk_bf16_f32 v109, v110, v111
    v_cvt_pk_bf16_f32 v167, v62, v63
    v_cvt_pk_bf16_f32 v110, v204, v205
    v_mfma_f32_16x16x32_bf16 v[216:219], a[76:79], a[120:123], v[216:219]
    buffer_load_dwordx4 a[224:227], v36, s[8:11], s62 offen sc1
    v_cvt_pk_bf16_f32 v111, v206, v207
    v_accvgpr_read_b32 v56, a144
    v_mfma_f32_16x16x32_bf16 v[124:127], a[72:75], a[124:127], v[124:127]
    v_accvgpr_read_b32 v57, a145
    v_accvgpr_read_b32 v58, a146
    v_accvgpr_read_b32 v59, a147
    v_mfma_f32_16x16x32_bf16 v[220:223], a[76:79], a[124:127], v[220:223]
    buffer_load_dwordx4 a[228:231], v54, s[8:11], s62 offen sc1
    v_accvgpr_read_b32 v60, a148
    v_cvt_pk_bf16_f32 v112, v112, v113
    v_mfma_f32_16x16x32_bf16 a[160:163], a[88:91], a[112:115], a[160:163]
    v_accvgpr_read_b32 v61, a149
    v_accvgpr_read_b32 v62, a150
    v_cvt_pk_bf16_f32 v113, v114, v115
    v_mfma_f32_16x16x32_bf16 a[164:167], a[92:95], a[112:115], a[164:167]
    v_accvgpr_read_b32 v63, a151
    v_cvt_pk_bf16_f32 v114, v208, v209
    v_cvt_pk_bf16_f32 v168, v56, v57
    v_mfma_f32_16x16x32_bf16 v[128:131], a[80:83], a[96:99], v[128:131]
    v_cvt_pk_bf16_f32 v115, v210, v211
    v_cvt_pk_bf16_f32 v169, v58, v59
    v_cvt_pk_bf16_f32 v116, v116, v117
    v_mfma_f32_16x16x32_bf16 v[224:227], a[84:87], a[96:99], v[224:227]
    buffer_load_dwordx4 a[232:235], v37, s[8:11], s62 offen sc1
    v_cvt_pk_bf16_f32 v170, v60, v61
    v_cvt_pk_bf16_f32 v117, v118, v119
    v_mfma_f32_16x16x32_bf16 v[132:135], a[80:83], a[100:103], v[132:135]
    v_cvt_pk_bf16_f32 v171, v62, v63
    v_cvt_pk_bf16_f32 v118, v212, v213
    v_cvt_pk_bf16_f32 v119, v214, v215
    v_mfma_f32_16x16x32_bf16 v[228:231], a[84:87], a[100:103], v[228:231]
    buffer_load_dwordx4 a[236:239], v55, s[8:11], s62 offen sc1
    v_accvgpr_read_b32 v56, a152
    v_accvgpr_read_b32 v57, a153
    v_mfma_f32_16x16x32_bf16 a[168:171], a[88:91], a[116:119], a[168:171]
    s_add_u32 s62, s62, 0x20000
    v_accvgpr_read_b32 v58, a154
    v_accvgpr_read_b32 v59, a155
    v_accvgpr_read_b32 v60, a156
    v_mfma_f32_16x16x32_bf16 a[172:175], a[92:95], a[116:119], a[172:175]
    s_waitcnt vmcnt(16)
    s_barrier
    v_cvt_pk_bf16_f32 v120, v120, v121
    v_accvgpr_read_b32 v61, a157
    v_accvgpr_read_b32 v62, a158
    v_mfma_f32_16x16x32_bf16 v[136:139], a[80:83], a[104:107], v[136:139]
    v_cvt_pk_bf16_f32 v121, v122, v123
    v_accvgpr_read_b32 v63, a159
    v_cvt_pk_bf16_f32 v122, v216, v217
    v_mfma_f32_16x16x32_bf16 v[232:235], a[84:87], a[104:107], v[232:235]
    v_cvt_pk_bf16_f32 v172, v56, v57
    v_cvt_pk_bf16_f32 v123, v218, v219
    v_cvt_pk_bf16_f32 v173, v58, v59
    v_mfma_f32_16x16x32_bf16 v[140:143], a[80:83], a[108:111], v[140:143]
    v_cvt_pk_bf16_f32 v124, v124, v125
    v_cvt_pk_bf16_f32 v174, v60, v61
    v_cvt_pk_bf16_f32 v125, v126, v127
    v_mfma_f32_16x16x32_bf16 v[236:239], a[84:87], a[108:111], v[236:239]
    v_cvt_pk_bf16_f32 v175, v62, v63
    v_cvt_pk_bf16_f32 v126, v220, v221
    v_cvt_pk_bf16_f32 v127, v222, v223
    v_mfma_f32_16x16x32_bf16 a[176:179], a[88:91], a[120:123], a[176:179]
    ds_read_b64_tr_b16 a[0:1], v42 offset:0
    v_accvgpr_read_b32 v56, a160
    v_accvgpr_read_b32 v57, a161
    v_mfma_f32_16x16x32_bf16 a[180:183], a[92:95], a[120:123], a[180:183]
    ds_read_b64_tr_b16 a[2:3], v42 offset:1024
    v_accvgpr_read_b32 v58, a162
    v_accvgpr_read_b32 v59, a163
    v_mfma_f32_16x16x32_bf16 v[144:147], a[80:83], a[112:115], v[144:147]
    ds_read_b64_tr_b16 a[4:5], v43 offset:0
    v_accvgpr_read_b32 v60, a164
    v_cvt_pk_bf16_f32 v128, v128, v129
    v_mfma_f32_16x16x32_bf16 v[240:243], a[84:87], a[112:115], v[240:243]
    v_accvgpr_read_b32 v61, a165
    v_accvgpr_read_b32 v62, a166
    v_cvt_pk_bf16_f32 v129, v130, v131
    v_mfma_f32_16x16x32_bf16 v[148:151], a[80:83], a[116:119], v[148:151]
    ds_read_b64_tr_b16 a[6:7], v43 offset:1024
    v_accvgpr_read_b32 v63, a167
    v_cvt_pk_bf16_f32 v130, v224, v225
    v_mfma_f32_16x16x32_bf16 v[244:247], a[84:87], a[116:119], v[244:247]
    v_cvt_pk_bf16_f32 v176, v56, v57
    v_cvt_pk_bf16_f32 v131, v226, v227
    v_cvt_pk_bf16_f32 v177, v58, v59
    v_mfma_f32_16x16x32_bf16 a[184:187], a[88:91], a[124:127], a[184:187]
    ds_read_b64_tr_b16 a[8:9], v44 offset:0
    v_cvt_pk_bf16_f32 v132, v132, v133
    v_cvt_pk_bf16_f32 v178, v60, v61
    v_mfma_f32_16x16x32_bf16 a[188:191], a[92:95], a[124:127], a[188:191]
    ds_read_b64_tr_b16 a[10:11], v44 offset:1024
    v_cvt_pk_bf16_f32 v133, v134, v135
    v_cvt_pk_bf16_f32 v179, v62, v63
    v_mfma_f32_16x16x32_bf16 v[152:155], a[80:83], a[120:123], v[152:155]
    ds_read_b64_tr_b16 a[12:13], v45 offset:0
    v_cvt_pk_bf16_f32 v134, v228, v229
    v_cvt_pk_bf16_f32 v135, v230, v231
    v_mfma_f32_16x16x32_bf16 v[248:251], a[84:87], a[120:123], v[248:251]
    ds_read_b64_tr_b16 a[14:15], v45 offset:1024
    v_accvgpr_read_b32 v56, a168
    v_accvgpr_read_b32 v57, a169
    v_mfma_f32_16x16x32_bf16 v[156:159], a[80:83], a[124:127], v[156:159]
    ds_read_b64_tr_b16 a[16:17], v46 offset:0
    v_accvgpr_read_b32 v58, a170
    v_accvgpr_read_b32 v59, a171
    v_mfma_f32_16x16x32_bf16 v[252:255], a[84:87], a[124:127], v[252:255]
    v_accvgpr_read_b32 v60, a172
    v_cvt_pk_bf16_f32 v136, v136, v137
    v_accvgpr_read_b32 v61, a173
    ds_read_b64_tr_b16 a[18:19], v46 offset:1024
    v_accvgpr_read_b32 v62, a174
    v_cvt_pk_bf16_f32 v137, v138, v139
    v_accvgpr_read_b32 v63, a175
    v_cvt_pk_bf16_f32 v138, v232, v233
    v_cvt_pk_bf16_f32 v180, v56, v57
    ds_read_b64_tr_b16 a[20:21], v47 offset:0
    v_cvt_pk_bf16_f32 v139, v234, v235
    v_cvt_pk_bf16_f32 v181, v58, v59
    v_cvt_pk_bf16_f32 v140, v140, v141
    v_cvt_pk_bf16_f32 v182, v60, v61
    ds_read_b64_tr_b16 a[22:23], v47 offset:1024
    v_cvt_pk_bf16_f32 v141, v142, v143
    v_cvt_pk_bf16_f32 v183, v62, v63
    v_cvt_pk_bf16_f32 v142, v236, v237
    ds_read_b64_tr_b16 a[24:25], v48 offset:0
    v_cvt_pk_bf16_f32 v143, v238, v239
    v_accvgpr_read_b32 v56, a176
    ds_read_b64_tr_b16 a[26:27], v48 offset:1024
    v_accvgpr_read_b32 v57, a177
    v_accvgpr_read_b32 v58, a178
    ds_read_b64_tr_b16 a[28:29], v49 offset:0
    v_accvgpr_read_b32 v59, a179
    v_accvgpr_read_b32 v60, a180
    v_cvt_pk_bf16_f32 v144, v144, v145
    ds_read_b64_tr_b16 a[30:31], v49 offset:1024
    v_accvgpr_read_b32 v61, a181
    v_accvgpr_read_b32 v62, a182
    v_cvt_pk_bf16_f32 v145, v146, v147
    v_accvgpr_read_b32 v63, a183
    v_cvt_pk_bf16_f32 v146, v240, v241
    v_cvt_pk_bf16_f32 v184, v56, v57
    v_cvt_pk_bf16_f32 v147, v242, v243
    v_cvt_pk_bf16_f32 v185, v58, v59
    v_cvt_pk_bf16_f32 v148, v148, v149
    v_cvt_pk_bf16_f32 v186, v60, v61
    v_cvt_pk_bf16_f32 v149, v150, v151
    v_cvt_pk_bf16_f32 v187, v62, v63
    v_cvt_pk_bf16_f32 v150, v244, v245
    v_cvt_pk_bf16_f32 v151, v246, v247
    v_accvgpr_read_b32 v56, a184
    v_accvgpr_read_b32 v57, a185
    v_accvgpr_read_b32 v58, a186
    v_accvgpr_read_b32 v59, a187
    v_accvgpr_read_b32 v60, a188
    v_cvt_pk_bf16_f32 v152, v152, v153
    v_accvgpr_read_b32 v61, a189
    v_accvgpr_read_b32 v62, a190
    v_cvt_pk_bf16_f32 v153, v154, v155
    v_accvgpr_read_b32 v63, a191
    v_cvt_pk_bf16_f32 v154, v248, v249
    v_cvt_pk_bf16_f32 v188, v56, v57
    v_cvt_pk_bf16_f32 v155, v250, v251
    v_cvt_pk_bf16_f32 v189, v58, v59
    v_cvt_pk_bf16_f32 v156, v156, v157
    v_cvt_pk_bf16_f32 v190, v60, v61
    v_cvt_pk_bf16_f32 v157, v158, v159
    v_cvt_pk_bf16_f32 v191, v62, v63
    v_cvt_pk_bf16_f32 v158, v252, v253
    v_cvt_pk_bf16_f32 v159, v254, v255
k12_join_7:
k12_qcode:
    s_mov_b64 s[48:49], s[32:33]
    s_mov_b32 s51, 0x00020000
    s_cmp_eq_u32 s45, 0
    s_mov_b32 s50, s34
    s_cselect_b32 s56, s30, -1
    s_cselect_b32 s57, -1, s30
    s_waitcnt vmcnt(12) lgkmcnt(0)
    v_mfma_f32_16x16x32_bf16 v[192:195], a[0:3], a[192:195], 0
    ds_read_b64_tr_b16 a[32:33], v42 offset:8192
    ds_read_b64_tr_b16 a[34:35], v42 offset:9216
    v_mfma_f32_16x16x32_bf16 v[196:199], a[0:3], a[196:199], 0
    buffer_load_dwordx4 a[240:243], v36, s[8:11], s62 offen sc1
    v_mfma_f32_16x16x32_bf16 a[64:67], a[0:3], a[200:203], 0
    ds_read_b64_tr_b16 a[36:37], v43 offset:8192
    v_mfma_f32_16x16x32_bf16 a[68:71], a[0:3], a[204:207], 0
    ds_read_b64_tr_b16 a[38:39], v43 offset:9216
    v_mfma_f32_16x16x32_bf16 v[200:203], a[4:7], a[192:195], 0
    ds_read_b64_tr_b16 a[40:41], v44 offset:8192
    v_mfma_f32_16x16x32_bf16 v[204:207], a[4:7], a[196:199], 0
    buffer_load_dwordx4 a[244:247], v54, s[8:11], s62 offen sc1
    v_mfma_f32_16x16x32_bf16 a[72:75], a[4:7], a[200:203], 0
    s_lshl_b32 s31, s28, 14
    ds_read_b64_tr_b16 a[42:43], v44 offset:9216
    v_mfma_f32_16x16x32_bf16 a[76:79], a[4:7], a[204:207], 0
    s_add_u32 s16, s6, s31
    s_addc_u32 s17, s7, 0
    ds_read_b64_tr_b16 a[44:45], v45 offset:8192
    v_mfma_f32_16x16x32_bf16 v[208:211], a[8:11], a[192:195], 0
    v_mfma_f32_16x16x32_bf16 v[212:215], a[8:11], a[196:199], 0
    s_add_u32 s20, s16, 0x2000000
    s_addc_u32 s21, s17, 0
    ds_read_b64_tr_b16 a[46:47], v45 offset:9216
    v_mfma_f32_16x16x32_bf16 a[80:83], a[8:11], a[200:203], 0
    buffer_load_dwordx4 a[248:251], v37, s[8:11], s62 offen sc1
    ds_read_b64_tr_b16 a[48:49], v46 offset:8192
    v_mfma_f32_16x16x32_bf16 a[84:87], a[8:11], a[204:207], 0
    s_add_u32 s16, s16, 0x1000000
    s_addc_u32 s17, s17, 0
    ds_read_b64_tr_b16 a[50:51], v46 offset:9216
    v_mfma_f32_16x16x32_bf16 v[216:219], a[12:15], a[192:195], 0
    v_mfma_f32_16x16x32_bf16 v[220:223], a[12:15], a[196:199], 0
    s_and_b32 s17, s17, 0xffff
    ds_read_b64_tr_b16 a[52:53], v47 offset:8192
    v_mfma_f32_16x16x32_bf16 a[88:91], a[12:15], a[200:203], 0
    buffer_load_dwordx4 a[252:255], v55, s[8:11], s62 offen sc1
    ds_read_b64_tr_b16 a[54:55], v47 offset:9216
    v_mfma_f32_16x16x32_bf16 a[92:95], a[12:15], a[204:207], 0
    s_and_b32 s21, s21, 0xffff
    ds_read_b64_tr_b16 a[56:57], v48 offset:8192
    v_mfma_f32_16x16x32_bf16 v[224:227], a[16:19], a[192:195], 0
    v_mfma_f32_16x16x32_bf16 v[228:231], a[16:19], a[196:199], 0
    s_lshl_b32 s31, s29, 20
    ds_read_b64_tr_b16 a[58:59], v48 offset:9216
    v_mfma_f32_16x16x32_bf16 a[96:99], a[16:19], a[200:203], 0
    s_add_u32 s62, s62, 0x20000
    ds_read_b64_tr_b16 a[60:61], v49 offset:8192
    v_mfma_f32_16x16x32_bf16 a[100:103], a[16:19], a[204:207], 0
    s_add_u32 s52, s47, 0
    v_mfma_f32_16x16x32_bf16 v[232:235], a[20:23], a[192:195], 0
    s_sub_u32 s18, 0xf84000, s31
    buffer_store_dwordx4 v[64:67], v1, s[48:51], s52 offen offset:0 sc1
    ds_read_b64_tr_b16 a[62:63], v49 offset:9216
    v_mfma_f32_16x16x32_bf16 v[236:239], a[20:23], a[196:199], 0
    s_add_u32 s52, s47, 0
    v_mfma_f32_16x16x32_bf16 a[104:107], a[20:23], a[200:203], 0
    s_mov_b32 s22, s18
    v_mfma_f32_16x16x32_bf16 a[108:111], a[20:23], a[204:207], 0
    s_add_u32 s24, s6, 0x4806000
    s_addc_u32 s25, s7, 0
    buffer_store_dwordx4 v[68:71], v1, s[48:51], s52 offen offset:1024 sc1
    v_mfma_f32_16x16x32_bf16 v[240:243], a[24:27], a[192:195], 0
    v_mfma_f32_16x16x32_bf16 v[244:247], a[24:27], a[196:199], 0
    s_and_b32 s25, s25, 0xffff
    v_mfma_f32_16x16x32_bf16 a[112:115], a[24:27], a[200:203], 0
    v_mfma_f32_16x16x32_bf16 a[116:119], a[24:27], a[204:207], 0
    s_mov_b32 s26, 4096
    v_mfma_f32_16x16x32_bf16 v[248:251], a[28:31], a[192:195], 0
    s_cmp_eq_u32 s45, 0
    s_cbranch_scc1 k12_ool_40
k12_oolret_41:
    v_mfma_f32_16x16x32_bf16 v[252:255], a[28:31], a[196:199], 0
    v_mfma_f32_16x16x32_bf16 a[120:123], a[28:31], a[200:203], 0
    v_mfma_f32_16x16x32_bf16 a[124:127], a[28:31], a[204:207], 0
    s_waitcnt vmcnt(10) lgkmcnt(0)
    s_barrier
    v_mfma_f32_16x16x32_bf16 v[192:195], a[32:35], a[208:211], v[192:195]
    ds_read_b64_tr_b16 a[0:1], v42 offset:16384
    ds_read_b64_tr_b16 a[2:3], v42 offset:17408
    v_mfma_f32_16x16x32_bf16 v[196:199], a[32:35], a[212:215], v[196:199]
    s_add_u32 m0, s60, 131072
    v_mfma_f32_16x16x32_bf16 a[64:67], a[32:35], a[216:219], a[64:67]
    buffer_load_dwordx4 v38, s[12:15], s61 offen offset:0 lds
    ds_read_b64_tr_b16 a[4:5], v43 offset:16384
    v_mfma_f32_16x16x32_bf16 a[68:71], a[32:35], a[220:223], a[68:71]
    ds_read_b64_tr_b16 a[6:7], v43 offset:17408
    v_mfma_f32_16x16x32_bf16 v[200:203], a[36:39], a[208:211], v[200:203]
    buffer_load_dwordx4 v39, s[12:15], s61 offen offset:1024 lds
    ds_read_b64_tr_b16 a[8:9], v44 offset:16384
    v_mfma_f32_16x16x32_bf16 v[204:207], a[36:39], a[212:215], v[204:207]
    v_mfma_f32_16x16x32_bf16 a[72:75], a[36:39], a[216:219], a[72:75]
    ds_read_b64_tr_b16 a[10:11], v44 offset:17408
    v_mfma_f32_16x16x32_bf16 a[76:79], a[36:39], a[220:223], a[76:79]
    buffer_load_dwordx4 v40, s[12:15], s61 offen offset:2048 lds
    ds_read_b64_tr_b16 a[12:13], v45 offset:16384
    v_mfma_f32_16x16x32_bf16 v[208:211], a[40:43], a[208:211], v[208:211]
    v_mfma_f32_16x16x32_bf16 v[212:215], a[40:43], a[212:215], v[212:215]
    ds_read_b64_tr_b16 a[14:15], v45 offset:17408
    v_mfma_f32_16x16x32_bf16 a[80:83], a[40:43], a[216:219], a[80:83]
    buffer_load_dwordx4 v41, s[12:15], s61 offen offset:3072 lds
    ds_read_b64_tr_b16 a[16:17], v46 offset:16384
    v_mfma_f32_16x16x32_bf16 a[84:87], a[40:43], a[220:223], a[84:87]
    ds_read_b64_tr_b16 a[18:19], v46 offset:17408
    v_mfma_f32_16x16x32_bf16 v[216:219], a[44:47], a[208:211], v[216:219]
    s_add_u32 s61, s61, 0x80000
    v_mfma_f32_16x16x32_bf16 v[220:223], a[44:47], a[212:215], v[220:223]
    buffer_load_dwordx4 a[128:131], v36, s[8:11], s62 offen sc1
    ds_read_b64_tr_b16 a[20:21], v47 offset:16384
    v_mfma_f32_16x16x32_bf16 a[88:91], a[44:47], a[216:219], a[88:91]
    ds_read_b64_tr_b16 a[22:23], v47 offset:17408
    v_mfma_f32_16x16x32_bf16 a[92:95], a[44:47], a[220:223], a[92:95]
    buffer_load_dwordx4 a[132:135], v54, s[8:11], s62 offen sc1
    ds_read_b64_tr_b16 a[24:25], v48 offset:16384
    v_mfma_f32_16x16x32_bf16 v[224:227], a[48:51], a[208:211], v[224:227]
    v_mfma_f32_16x16x32_bf16 v[228:231], a[48:51], a[212:215], v[228:231]
    ds_read_b64_tr_b16 a[26:27], v48 offset:17408
    v_mfma_f32_16x16x32_bf16 a[96:99], a[48:51], a[216:219], a[96:99]
    buffer_load_dwordx4 a[136:139], v37, s[8:11], s62 offen sc1
    ds_read_b64_tr_b16 a[28:29], v49 offset:16384
    v_mfma_f32_16x16x32_bf16 a[100:103], a[48:51], a[220:223], a[100:103]
    v_mfma_f32_16x16x32_bf16 v[232:235], a[52:55], a[208:211], v[232:235]
    ds_read_b64_tr_b16 a[30:31], v49 offset:17408
    v_mfma_f32_16x16x32_bf16 v[236:239], a[52:55], a[212:215], v[236:239]
    buffer_load_dwordx4 a[140:143], v55, s[8:11], s62 offen sc1
    v_mfma_f32_16x16x32_bf16 a[104:107], a[52:55], a[216:219], a[104:107]
    v_mfma_f32_16x16x32_bf16 a[108:111], a[52:55], a[220:223], a[108:111]
    s_add_u32 s62, s62, 0x20000
    v_mfma_f32_16x16x32_bf16 v[240:243], a[56:59], a[208:211], v[240:243]
    s_add_u32 s52, s47, 0
    v_mfma_f32_16x16x32_bf16 v[244:247], a[56:59], a[212:215], v[244:247]
    buffer_store_dwordx4 v[72:75], v1, s[48:51], s52 offen offset:2048 sc1
    v_mfma_f32_16x16x32_bf16 a[112:115], a[56:59], a[216:219], a[112:115]
    v_mfma_f32_16x16x32_bf16 a[116:119], a[56:59], a[220:223], a[116:119]
    v_mfma_f32_16x16x32_bf16 v[248:251], a[60:63], a[208:211], v[248:251]
    v_mfma_f32_16x16x32_bf16 v[252:255], a[60:63], a[212:215], v[252:255]
    v_mfma_f32_16x16x32_bf16 a[120:123], a[60:63], a[216:219], a[120:123]
    v_mfma_f32_16x16x32_bf16 a[124:127], a[60:63], a[220:223], a[124:127]
    s_waitcnt vmcnt(15) lgkmcnt(0)
    v_mfma_f32_16x16x32_bf16 v[192:195], a[0:3], a[224:227], v[192:195]
    ds_read_b64_tr_b16 a[32:33], v42 offset:24576
    ds_read_b64_tr_b16 a[34:35], v42 offset:25600
    v_mfma_f32_16x16x32_bf16 v[196:199], a[0:3], a[228:231], v[196:199]
    buffer_load_dwordx4 a[144:147], v36, s[8:11], s62 offen sc1
    v_mfma_f32_16x16x32_bf16 a[64:67], a[0:3], a[232:235], a[64:67]
    ds_read_b64_tr_b16 a[36:37], v43 offset:24576
    v_mfma_f32_16x16x32_bf16 a[68:71], a[0:3], a[236:239], a[68:71]
    ds_read_b64_tr_b16 a[38:39], v43 offset:25600
    v_mfma_f32_16x16x32_bf16 v[200:203], a[4:7], a[224:227], v[200:203]
    ds_read_b64_tr_b16 a[40:41], v44 offset:24576
    v_mfma_f32_16x16x32_bf16 v[204:207], a[4:7], a[228:231], v[204:207]
    v_mfma_f32_16x16x32_bf16 a[72:75], a[4:7], a[232:235], a[72:75]
    buffer_load_dwordx4 a[148:151], v54, s[8:11], s62 offen sc1
    ds_read_b64_tr_b16 a[42:43], v44 offset:25600
    v_mfma_f32_16x16x32_bf16 a[76:79], a[4:7], a[236:239], a[76:79]
    ds_read_b64_tr_b16 a[44:45], v45 offset:24576
    v_mfma_f32_16x16x32_bf16 v[208:211], a[8:11], a[224:227], v[208:211]
    v_mfma_f32_16x16x32_bf16 v[212:215], a[8:11], a[228:231], v[212:215]
    ds_read_b64_tr_b16 a[46:47], v45 offset:25600
    v_mfma_f32_16x16x32_bf16 a[80:83], a[8:11], a[232:235], a[80:83]
    ds_read_b64_tr_b16 a[48:49], v46 offset:24576
    v_mfma_f32_16x16x32_bf16 a[84:87], a[8:11], a[236:239], a[84:87]
    buffer_load_dwordx4 a[152:155], v37, s[8:11], s62 offen sc1
    ds_read_b64_tr_b16 a[50:51], v46 offset:25600
    v_mfma_f32_16x16x32_bf16 v[216:219], a[12:15], a[224:227], v[216:219]
    v_mfma_f32_16x16x32_bf16 v[220:223], a[12:15], a[228:231], v[220:223]
    ds_read_b64_tr_b16 a[52:53], v47 offset:24576
    v_mfma_f32_16x16x32_bf16 a[88:91], a[12:15], a[232:235], a[88:91]
    ds_read_b64_tr_b16 a[54:55], v47 offset:25600
    v_mfma_f32_16x16x32_bf16 a[92:95], a[12:15], a[236:239], a[92:95]
    ds_read_b64_tr_b16 a[56:57], v48 offset:24576
    v_mfma_f32_16x16x32_bf16 v[224:227], a[16:19], a[224:227], v[224:227]
    v_mfma_f32_16x16x32_bf16 v[228:231], a[16:19], a[228:231], v[228:231]
    buffer_load_dwordx4 a[156:159], v55, s[8:11], s62 offen sc1
    ds_read_b64_tr_b16 a[58:59], v48 offset:25600
    v_mfma_f32_16x16x32_bf16 a[96:99], a[16:19], a[232:235], a[96:99]
    ds_read_b64_tr_b16 a[60:61], v49 offset:24576
    v_mfma_f32_16x16x32_bf16 a[100:103], a[16:19], a[236:239], a[100:103]
    v_mfma_f32_16x16x32_bf16 v[232:235], a[20:23], a[224:227], v[232:235]
    ds_read_b64_tr_b16 a[62:63], v49 offset:25600
    v_mfma_f32_16x16x32_bf16 v[236:239], a[20:23], a[228:231], v[236:239]
    s_add_u32 s62, s62, 0x20000
    v_mfma_f32_16x16x32_bf16 a[104:107], a[20:23], a[232:235], a[104:107]
    s_add_u32 s52, s47, 0
    v_mfma_f32_16x16x32_bf16 a[108:111], a[20:23], a[236:239], a[108:111]
    buffer_store_dwordx4 v[76:79], v1, s[48:51], s52 offen offset:3072 sc1
    v_mfma_f32_16x16x32_bf16 v[240:243], a[24:27], a[224:227], v[240:243]
    v_mfma_f32_16x16x32_bf16 v[244:247], a[24:27], a[228:231], v[244:247]
    v_mfma_f32_16x16x32_bf16 a[112:115], a[24:27], a[232:235], a[112:115]
    v_mfma_f32_16x16x32_bf16 a[116:119], a[24:27], a[236:239], a[116:119]
    v_mfma_f32_16x16x32_bf16 v[248:251], a[28:31], a[224:227], v[248:251]
    s_cmp_eq_u32 s45, 0
    s_cbranch_scc1 k12_ool_42
k12_oolret_43:
    v_mfma_f32_16x16x32_bf16 v[252:255], a[28:31], a[228:231], v[252:255]
    v_mfma_f32_16x16x32_bf16 a[120:123], a[28:31], a[232:235], a[120:123]
    v_mfma_f32_16x16x32_bf16 a[124:127], a[28:31], a[236:239], a[124:127]
    s_waitcnt vmcnt(10) lgkmcnt(0)
    s_barrier
    v_mfma_f32_16x16x32_bf16 v[192:195], a[32:35], a[240:243], v[192:195]
    ds_read_b64_tr_b16 a[0:1], v42 offset:32768
    ds_read_b64_tr_b16 a[2:3], v42 offset:33792
    v_mfma_f32_16x16x32_bf16 v[196:199], a[32:35], a[244:247], v[196:199]
    s_add_u32 m0, s60, 147456
    v_mfma_f32_16x16x32_bf16 a[64:67], a[32:35], a[248:251], a[64:67]
    buffer_load_dwordx4 v38, s[12:15], s61 offen offset:0 lds
    ds_read_b64_tr_b16 a[4:5], v43 offset:32768
    v_mfma_f32_16x16x32_bf16 a[68:71], a[32:35], a[252:255], a[68:71]
    ds_read_b64_tr_b16 a[6:7], v43 offset:33792
    v_mfma_f32_16x16x32_bf16 v[200:203], a[36:39], a[240:243], v[200:203]
    buffer_load_dwordx4 v39, s[12:15], s61 offen offset:1024 lds
    ds_read_b64_tr_b16 a[8:9], v44 offset:32768
    v_mfma_f32_16x16x32_bf16 v[204:207], a[36:39], a[244:247], v[204:207]
    v_mfma_f32_16x16x32_bf16 a[72:75], a[36:39], a[248:251], a[72:75]
    ds_read_b64_tr_b16 a[10:11], v44 offset:33792
    v_mfma_f32_16x16x32_bf16 a[76:79], a[36:39], a[252:255], a[76:79]
    buffer_load_dwordx4 v40, s[12:15], s61 offen offset:2048 lds
    ds_read_b64_tr_b16 a[12:13], v45 offset:32768
    v_mfma_f32_16x16x32_bf16 v[208:211], a[40:43], a[240:243], v[208:211]
    v_mfma_f32_16x16x32_bf16 v[212:215], a[40:43], a[244:247], v[212:215]
    ds_read_b64_tr_b16 a[14:15], v45 offset:33792
    v_mfma_f32_16x16x32_bf16 a[80:83], a[40:43], a[248:251], a[80:83]
    buffer_load_dwordx4 v41, s[12:15], s61 offen offset:3072 lds
    ds_read_b64_tr_b16 a[16:17], v46 offset:32768
    v_mfma_f32_16x16x32_bf16 a[84:87], a[40:43], a[252:255], a[84:87]
    ds_read_b64_tr_b16 a[18:19], v46 offset:33792
    v_mfma_f32_16x16x32_bf16 v[216:219], a[44:47], a[240:243], v[216:219]
    s_add_u32 s61, s61, 0x80000
    v_mfma_f32_16x16x32_bf16 v[220:223], a[44:47], a[244:247], v[220:223]
    buffer_load_dwordx4 a[160:163], v36, s[8:11], s62 offen sc1
    ds_read_b64_tr_b16 a[20:21], v47 offset:32768
    v_mfma_f32_16x16x32_bf16 a[88:91], a[44:47], a[248:251], a[88:91]
    ds_read_b64_tr_b16 a[22:23], v47 offset:33792
    v_mfma_f32_16x16x32_bf16 a[92:95], a[44:47], a[252:255], a[92:95]
    buffer_load_dwordx4 a[164:167], v54, s[8:11], s62 offen sc1
    ds_read_b64_tr_b16 a[24:25], v48 offset:32768
    v_mfma_f32_16x16x32_bf16 v[224:227], a[48:51], a[240:243], v[224:227]
    v_mfma_f32_16x16x32_bf16 v[228:231], a[48:51], a[244:247], v[228:231]
    ds_read_b64_tr_b16 a[26:27], v48 offset:33792
    v_mfma_f32_16x16x32_bf16 a[96:99], a[48:51], a[248:251], a[96:99]
    buffer_load_dwordx4 a[168:171], v37, s[8:11], s62 offen sc1
    ds_read_b64_tr_b16 a[28:29], v49 offset:32768
    v_mfma_f32_16x16x32_bf16 a[100:103], a[48:51], a[252:255], a[100:103]
    v_mfma_f32_16x16x32_bf16 v[232:235], a[52:55], a[240:243], v[232:235]
    ds_read_b64_tr_b16 a[30:31], v49 offset:33792
    v_mfma_f32_16x16x32_bf16 v[236:239], a[52:55], a[244:247], v[236:239]
    buffer_load_dwordx4 a[172:175], v55, s[8:11], s62 offen sc1
    v_mfma_f32_16x16x32_bf16 a[104:107], a[52:55], a[248:251], a[104:107]
    v_mfma_f32_16x16x32_bf16 a[108:111], a[52:55], a[252:255], a[108:111]
    s_add_u32 s62, s62, 0x20000
    v_mfma_f32_16x16x32_bf16 v[240:243], a[56:59], a[240:243], v[240:243]
    s_add_u32 s52, s47, 4096
    v_mfma_f32_16x16x32_bf16 v[244:247], a[56:59], a[244:247], v[244:247]
    buffer_store_dwordx4 v[80:83], v1, s[48:51], s52 offen offset:0 sc1
    v_mfma_f32_16x16x32_bf16 a[112:115], a[56:59], a[248:251], a[112:115]
    v_mfma_f32_16x16x32_bf16 a[116:119], a[56:59], a[252:255], a[116:119]
    v_mfma_f32_16x16x32_bf16 v[248:251], a[60:63], a[240:243], v[248:251]
    v_mfma_f32_16x16x32_bf16 v[252:255], a[60:63], a[244:247], v[252:255]
    v_mfma_f32_16x16x32_bf16 a[120:123], a[60:63], a[248:251], a[120:123]
    v_mfma_f32_16x16x32_bf16 a[124:127], a[60:63], a[252:255], a[124:127]
    s_waitcnt vmcnt(15) lgkmcnt(0)
    v_mfma_f32_16x16x32_bf16 v[192:195], a[0:3], a[128:131], v[192:195]
    ds_read_b64_tr_b16 a[32:33], v42 offset:40960
    ds_read_b64_tr_b16 a[34:35], v42 offset:41984
    v_mfma_f32_16x16x32_bf16 v[196:199], a[0:3], a[132:135], v[196:199]
    buffer_load_dwordx4 a[176:179], v36, s[8:11], s62 offen sc1
    v_mfma_f32_16x16x32_bf16 a[64:67], a[0:3], a[136:139], a[64:67]
    ds_read_b64_tr_b16 a[36:37], v43 offset:40960
    v_mfma_f32_16x16x32_bf16 a[68:71], a[0:3], a[140:143], a[68:71]
    ds_read_b64_tr_b16 a[38:39], v43 offset:41984
    v_mfma_f32_16x16x32_bf16 v[200:203], a[4:7], a[128:131], v[200:203]
    ds_read_b64_tr_b16 a[40:41], v44 offset:40960
    v_mfma_f32_16x16x32_bf16 v[204:207], a[4:7], a[132:135], v[204:207]
    v_mfma_f32_16x16x32_bf16 a[72:75], a[4:7], a[136:139], a[72:75]
    buffer_load_dwordx4 a[180:183], v54, s[8:11], s62 offen sc1
    ds_read_b64_tr_b16 a[42:43], v44 offset:41984
    v_mfma_f32_16x16x32_bf16 a[76:79], a[4:7], a[140:143], a[76:79]
    ds_read_b64_tr_b16 a[44:45], v45 offset:40960
    v_mfma_f32_16x16x32_bf16 v[208:211], a[8:11], a[128:131], v[208:211]
    v_mfma_f32_16x16x32_bf16 v[212:215], a[8:11], a[132:135], v[212:215]
    ds_read_b64_tr_b16 a[46:47], v45 offset:41984
    v_mfma_f32_16x16x32_bf16 a[80:83], a[8:11], a[136:139], a[80:83]
    ds_read_b64_tr_b16 a[48:49], v46 offset:40960
    v_mfma_f32_16x16x32_bf16 a[84:87], a[8:11], a[140:143], a[84:87]
    buffer_load_dwordx4 a[184:187], v37, s[8:11], s62 offen sc1
    ds_read_b64_tr_b16 a[50:51], v46 offset:41984
    v_mfma_f32_16x16x32_bf16 v[216:219], a[12:15], a[128:131], v[216:219]
    v_mfma_f32_16x16x32_bf16 v[220:223], a[12:15], a[132:135], v[220:223]
    ds_read_b64_tr_b16 a[52:53], v47 offset:40960
    v_mfma_f32_16x16x32_bf16 a[88:91], a[12:15], a[136:139], a[88:91]
    ds_read_b64_tr_b16 a[54:55], v47 offset:41984
    v_mfma_f32_16x16x32_bf16 a[92:95], a[12:15], a[140:143], a[92:95]
    ds_read_b64_tr_b16 a[56:57], v48 offset:40960
    v_mfma_f32_16x16x32_bf16 v[224:227], a[16:19], a[128:131], v[224:227]
    v_mfma_f32_16x16x32_bf16 v[228:231], a[16:19], a[132:135], v[228:231]
    buffer_load_dwordx4 a[188:191], v55, s[8:11], s62 offen sc1
    ds_read_b64_tr_b16 a[58:59], v48 offset:41984
    v_mfma_f32_16x16x32_bf16 a[96:99], a[16:19], a[136:139], a[96:99]
    ds_read_b64_tr_b16 a[60:61], v49 offset:40960
    v_mfma_f32_16x16x32_bf16 a[100:103], a[16:19], a[140:143], a[100:103]
    v_mfma_f32_16x16x32_bf16 v[232:235], a[20:23], a[128:131], v[232:235]
    ds_read_b64_tr_b16 a[62:63], v49 offset:41984
    v_mfma_f32_16x16x32_bf16 v[236:239], a[20:23], a[132:135], v[236:239]
    s_add_u32 s62, s62, 0x20000
    v_mfma_f32_16x16x32_bf16 a[104:107], a[20:23], a[136:139], a[104:107]
    s_add_u32 s52, s47, 4096
    v_mfma_f32_16x16x32_bf16 a[108:111], a[20:23], a[140:143], a[108:111]
    buffer_store_dwordx4 v[84:87], v1, s[48:51], s52 offen offset:1024 sc1
    v_mfma_f32_16x16x32_bf16 v[240:243], a[24:27], a[128:131], v[240:243]
    v_mfma_f32_16x16x32_bf16 v[244:247], a[24:27], a[132:135], v[244:247]
    v_mfma_f32_16x16x32_bf16 a[112:115], a[24:27], a[136:139], a[112:115]
    v_mfma_f32_16x16x32_bf16 a[116:119], a[24:27], a[140:143], a[116:119]
    v_mfma_f32_16x16x32_bf16 v[248:251], a[28:31], a[128:131], v[248:251]
    s_cmp_eq_u32 s45, 0
    s_cbranch_scc1 k12_ool_44
k12_oolret_45:
    v_mfma_f32_16x16x32_bf16 v[252:255], a[28:31], a[132:135], v[252:255]
    v_mfma_f32_16x16x32_bf16 a[120:123], a[28:31], a[136:139], a[120:123]
    v_mfma_f32_16x16x32_bf16 a[124:127], a[28:31], a[140:143], a[124:127]
    s_waitcnt vmcnt(10) lgkmcnt(0)
    s_barrier
    v_mfma_f32_16x16x32_bf16 v[192:195], a[32:35], a[144:147], v[192:195]
    ds_read_b64_tr_b16 a[0:1], v42 offset:49152
    ds_read_b64_tr_b16 a[2:3], v42 offset:50176
    v_mfma_f32_16x16x32_bf16 v[196:199], a[32:35], a[148:151], v[196:199]
    s_add_u32 m0, s60, 98304
    v_mfma_f32_16x16x32_bf16 a[64:67], a[32:35], a[152:155], a[64:67]
    buffer_load_dwordx4 v38, s[12:15], s61 offen offset:0 lds
    ds_read_b64_tr_b16 a[4:5], v43 offset:49152
    v_mfma_f32_16x16x32_bf16 a[68:71], a[32:35], a[156:159], a[68:71]
    ds_read_b64_tr_b16 a[6:7], v43 offset:50176
    v_mfma_f32_16x16x32_bf16 v[200:203], a[36:39], a[144:147], v[200:203]
    buffer_load_dwordx4 v39, s[12:15], s61 offen offset:1024 lds
    ds_read_b64_tr_b16 a[8:9], v44 offset:49152
    v_mfma_f32_16x16x32_bf16 v[204:207], a[36:39], a[148:151], v[204:207]
    v_mfma_f32_16x16x32_bf16 a[72:75], a[36:39], a[152:155], a[72:75]
    ds_read_b64_tr_b16 a[10:11], v44 offset:50176
    v_mfma_f32_16x16x32_bf16 a[76:79], a[36:39], a[156:159], a[76:79]
    buffer_load_dwordx4 v40, s[12:15], s61 offen offset:2048 lds
    ds_read_b64_tr_b16 a[12:13], v45 offset:49152
    v_mfma_f32_16x16x32_bf16 v[208:211], a[40:43], a[144:147], v[208:211]
    v_mfma_f32_16x16x32_bf16 v[212:215], a[40:43], a[148:151], v[212:215]
    ds_read_b64_tr_b16 a[14:15], v45 offset:50176
    v_mfma_f32_16x16x32_bf16 a[80:83], a[40:43], a[152:155], a[80:83]
    buffer_load_dwordx4 v41, s[12:15], s61 offen offset:3072 lds
    ds_read_b64_tr_b16 a[16:17], v46 offset:49152
    v_mfma_f32_16x16x32_bf16 a[84:87], a[40:43], a[156:159], a[84:87]
    ds_read_b64_tr_b16 a[18:19], v46 offset:50176
    v_mfma_f32_16x16x32_bf16 v[216:219], a[44:47], a[144:147], v[216:219]
    s_add_u32 s61, s61, 0x80000
    v_mfma_f32_16x16x32_bf16 v[220:223], a[44:47], a[148:151], v[220:223]
    buffer_load_dwordx4 a[192:195], v36, s[8:11], s62 offen sc1
    ds_read_b64_tr_b16 a[20:21], v47 offset:49152
    v_mfma_f32_16x16x32_bf16 a[88:91], a[44:47], a[152:155], a[88:91]
    ds_read_b64_tr_b16 a[22:23], v47 offset:50176
    v_mfma_f32_16x16x32_bf16 a[92:95], a[44:47], a[156:159], a[92:95]
    buffer_load_dwordx4 a[196:199], v54, s[8:11], s62 offen sc1
    ds_read_b64_tr_b16 a[24:25], v48 offset:49152
    v_mfma_f32_16x16x32_bf16 v[224:227], a[48:51], a[144:147], v[224:227]
    v_mfma_f32_16x16x32_bf16 v[228:231], a[48:51], a[148:151], v[228:231]
    ds_read_b64_tr_b16 a[26:27], v48 offset:50176
    v_mfma_f32_16x16x32_bf16 a[96:99], a[48:51], a[152:155], a[96:99]
    buffer_load_dwordx4 a[200:203], v37, s[8:11], s62 offen sc1
    ds_read_b64_tr_b16 a[28:29], v49 offset:49152
    v_mfma_f32_16x16x32_bf16 a[100:103], a[48:51], a[156:159], a[100:103]
    v_mfma_f32_16x16x32_bf16 v[232:235], a[52:55], a[144:147], v[232:235]
    ds_read_b64_tr_b16 a[30:31], v49 offset:50176
    v_mfma_f32_16x16x32_bf16 v[236:239], a[52:55], a[148:151], v[236:239]
    buffer_load_dwordx4 a[204:207], v55, s[8:11], s62 offen sc1
    v_mfma_f32_16x16x32_bf16 a[104:107], a[52:55], a[152:155], a[104:107]
    v_mfma_f32_16x16x32_bf16 a[108:111], a[52:55], a[156:159], a[108:111]
    s_add_u32 s62, s62, 0x20000
    v_mfma_f32_16x16x32_bf16 v[240:243], a[56:59], a[144:147], v[240:243]
    s_add_u32 s52, s47, 4096
    v_mfma_f32_16x16x32_bf16 v[244:247], a[56:59], a[148:151], v[244:247]
    buffer_store_dwordx4 v[88:91], v1, s[48:51], s52 offen offset:2048 sc1
    v_mfma_f32_16x16x32_bf16 a[112:115], a[56:59], a[152:155], a[112:115]
    v_mfma_f32_16x16x32_bf16 a[116:119], a[56:59], a[156:159], a[116:119]
    v_mfma_f32_16x16x32_bf16 v[248:251], a[60:63], a[144:147], v[248:251]
    v_mfma_f32_16x16x32_bf16 v[252:255], a[60:63], a[148:151], v[252:255]
    v_mfma_f32_16x16x32_bf16 a[120:123], a[60:63], a[152:155], a[120:123]
    v_mfma_f32_16x16x32_bf16 a[124:127], a[60:63], a[156:159], a[124:127]
    s_waitcnt vmcnt(15) lgkmcnt(0)
    v_mfma_f32_16x16x32_bf16 v[192:195], a[0:3], a[160:163], v[192:195]
    ds_read_b64_tr_b16 a[32:33], v42 offset:57344
    ds_read_b64_tr_b16 a[34:35], v42 offset:58368
    v_mfma_f32_16x16x32_bf16 v[196:199], a[0:3], a[164:167], v[196:199]
    buffer_load_dwordx4 a[208:211], v36, s[8:11], s62 offen sc1
    v_mfma_f32_16x16x32_bf16 a[64:67], a[0:3], a[168:171], a[64:67]
    ds_read_b64_tr_b16 a[36:37], v43 offset:57344
    v_mfma_f32_16x16x32_bf16 a[68:71], a[0:3], a[172:175], a[68:71]
    ds_read_b64_tr_b16 a[38:39], v43 offset:58368
    v_mfma_f32_16x16x32_bf16 v[200:203], a[4:7], a[160:163], v[200:203]
    ds_read_b64_tr_b16 a[40:41], v44 offset:57344
    v_mfma_f32_16x16x32_bf16 v[204:207], a[4:7], a[164:167], v[204:207]
    v_mfma_f32_16x16x32_bf16 a[72:75], a[4:7], a[168:171], a[72:75]
    buffer_load_dwordx4 a[212:215], v54, s[8:11], s62 offen sc1
    ds_read_b64_tr_b16 a[42:43], v44 offset:58368
    v_mfma_f32_16x16x32_bf16 a[76:79], a[4:7], a[172:175], a[76:79]
    ds_read_b64_tr_b16 a[44:45], v45 offset:57344
    v_mfma_f32_16x16x32_bf16 v[208:211], a[8:11], a[160:163], v[208:211]
    v_mfma_f32_16x16x32_bf16 v[212:215], a[8:11], a[164:167], v[212:215]
    ds_read_b64_tr_b16 a[46:47], v45 offset:58368
    v_mfma_f32_16x16x32_bf16 a[80:83], a[8:11], a[168:171], a[80:83]
    ds_read_b64_tr_b16 a[48:49], v46 offset:57344
    v_mfma_f32_16x16x32_bf16 a[84:87], a[8:11], a[172:175], a[84:87]
    buffer_load_dwordx4 a[216:219], v37, s[8:11], s62 offen sc1
    ds_read_b64_tr_b16 a[50:51], v46 offset:58368
    v_mfma_f32_16x16x32_bf16 v[216:219], a[12:15], a[160:163], v[216:219]
    v_mfma_f32_16x16x32_bf16 v[220:223], a[12:15], a[164:167], v[220:223]
    ds_read_b64_tr_b16 a[52:53], v47 offset:57344
    v_mfma_f32_16x16x32_bf16 a[88:91], a[12:15], a[168:171], a[88:91]
    ds_read_b64_tr_b16 a[54:55], v47 offset:58368
    v_mfma_f32_16x16x32_bf16 a[92:95], a[12:15], a[172:175], a[92:95]
    ds_read_b64_tr_b16 a[56:57], v48 offset:57344
    v_mfma_f32_16x16x32_bf16 v[224:227], a[16:19], a[160:163], v[224:227]
    v_mfma_f32_16x16x32_bf16 v[228:231], a[16:19], a[164:167], v[228:231]
    buffer_load_dwordx4 a[220:223], v55, s[8:11], s62 offen sc1
    ds_read_b64_tr_b16 a[58:59], v48 offset:58368
    v_mfma_f32_16x16x32_bf16 a[96:99], a[16:19], a[168:171], a[96:99]
    ds_read_b64_tr_b16 a[60:61], v49 offset:57344
    v_mfma_f32_16x16x32_bf16 a[100:103], a[16:19], a[172:175], a[100:103]
    v_mfma_f32_16x16x32_bf16 v[232:235], a[20:23], a[160:163], v[232:235]
    ds_read_b64_tr_b16 a[62:63], v49 offset:58368
    v_mfma_f32_16x16x32_bf16 v[236:239], a[20:23], a[164:167], v[236:239]
    s_add_u32 s62, s62, 0x20000
    v_mfma_f32_16x16x32_bf16 a[104:107], a[20:23], a[168:171], a[104:107]
    s_add_u32 s52, s47, 4096
    v_mfma_f32_16x16x32_bf16 a[108:111], a[20:23], a[172:175], a[108:111]
    buffer_store_dwordx4 v[92:95], v1, s[48:51], s52 offen offset:3072 sc1
    v_mfma_f32_16x16x32_bf16 v[240:243], a[24:27], a[160:163], v[240:243]
    v_mfma_f32_16x16x32_bf16 v[244:247], a[24:27], a[164:167], v[244:247]
    v_mfma_f32_16x16x32_bf16 a[112:115], a[24:27], a[168:171], a[112:115]
    v_mfma_f32_16x16x32_bf16 a[116:119], a[24:27], a[172:175], a[116:119]
    v_mfma_f32_16x16x32_bf16 v[248:251], a[28:31], a[160:163], v[248:251]
    s_cmp_eq_u32 s45, 0
    s_cbranch_scc1 k12_ool_46
k12_oolret_47:
    v_mfma_f32_16x16x32_bf16 v[252:255], a[28:31], a[164:167], v[252:255]
    v_mfma_f32_16x16x32_bf16 a[120:123], a[28:31], a[168:171], a[120:123]
    v_mfma_f32_16x16x32_bf16 a[124:127], a[28:31], a[172:175], a[124:127]
    s_waitcnt vmcnt(10) lgkmcnt(0)
    s_barrier
    v_mfma_f32_16x16x32_bf16 v[192:195], a[32:35], a[176:179], v[192:195]
    ds_read_b64_tr_b16 a[0:1], v42 offset:0
    ds_read_b64_tr_b16 a[2:3], v42 offset:1024
    v_mfma_f32_16x16x32_bf16 v[196:199], a[32:35], a[180:183], v[196:199]
    s_add_u32 m0, s60, 114688
    v_mfma_f32_16x16x32_bf16 a[64:67], a[32:35], a[184:187], a[64:67]
    buffer_load_dwordx4 v38, s[12:15], s61 offen offset:0 lds
    ds_read_b64_tr_b16 a[4:5], v43 offset:0
    v_mfma_f32_16x16x32_bf16 a[68:71], a[32:35], a[188:191], a[68:71]
    ds_read_b64_tr_b16 a[6:7], v43 offset:1024
    v_mfma_f32_16x16x32_bf16 v[200:203], a[36:39], a[176:179], v[200:203]
    buffer_load_dwordx4 v39, s[12:15], s61 offen offset:1024 lds
    ds_read_b64_tr_b16 a[8:9], v44 offset:0
    v_mfma_f32_16x16x32_bf16 v[204:207], a[36:39], a[180:183], v[204:207]
    v_mfma_f32_16x16x32_bf16 a[72:75], a[36:39], a[184:187], a[72:75]
    ds_read_b64_tr_b16 a[10:11], v44 offset:1024
    v_mfma_f32_16x16x32_bf16 a[76:79], a[36:39], a[188:191], a[76:79]
    buffer_load_dwordx4 v40, s[12:15], s61 offen offset:2048 lds
    ds_read_b64_tr_b16 a[12:13], v45 offset:0
    v_mfma_f32_16x16x32_bf16 v[208:211], a[40:43], a[176:179], v[208:211]
    v_mfma_f32_16x16x32_bf16 v[212:215], a[40:43], a[180:183], v[212:215]
    ds_read_b64_tr_b16 a[14:15], v45 offset:1024
    v_mfma_f32_16x16x32_bf16 a[80:83], a[40:43], a[184:187], a[80:83]
    buffer_load_dwordx4 v41, s[12:15], s61 offen offset:3072 lds
    ds_read_b64_tr_b16 a[16:17], v46 offset:0
    v_mfma_f32_16x16x32_bf16 a[84:87], a[40:43], a[188:191], a[84:87]
    ds_read_b64_tr_b16 a[18:19], v46 offset:1024
    v_mfma_f32_16x16x32_bf16 v[216:219], a[44:47], a[176:179], v[216:219]
    s_add_u32 s61, s61, 0x80000
    v_mfma_f32_16x16x32_bf16 v[220:223], a[44:47], a[180:183], v[220:223]
    buffer_load_dwordx4 a[224:227], v36, s[8:11], s62 offen sc1
    ds_read_b64_tr_b16 a[20:21], v47 offset:0
    v_mfma_f32_16x16x32_bf16 a[88:91], a[44:47], a[184:187], a[88:91]
    ds_read_b64_tr_b16 a[22:23], v47 offset:1024
    v_mfma_f32_16x16x32_bf16 a[92:95], a[44:47], a[188:191], a[92:95]
    buffer_load_dwordx4 a[228:231], v54, s[8:11], s62 offen sc1
    ds_read_b64_tr_b16 a[24:25], v48 offset:0
    v_mfma_f32_16x16x32_bf16 v[224:227], a[48:51], a[176:179], v[224:227]
    v_mfma_f32_16x16x32_bf16 v[228:231], a[48:51], a[180:183], v[228:231]
    ds_read_b64_tr_b16 a[26:27], v48 offset:1024
    v_mfma_f32_16x16x32_bf16 a[96:99], a[48:51], a[184:187], a[96:99]
    buffer_load_dwordx4 a[232:235], v37, s[8:11], s62 offen sc1
    ds_read_b64_tr_b16 a[28:29], v49 offset:0
    v_mfma_f32_16x16x32_bf16 a[100:103], a[48:51], a[188:191], a[100:103]
    v_mfma_f32_16x16x32_bf16 v[232:235], a[52:55], a[176:179], v[232:235]
    ds_read_b64_tr_b16 a[30:31], v49 offset:1024
    v_mfma_f32_16x16x32_bf16 v[236:239], a[52:55], a[180:183], v[236:239]
    buffer_load_dwordx4 a[236:239], v55, s[8:11], s62 offen sc1
    v_mfma_f32_16x16x32_bf16 a[104:107], a[52:55], a[184:187], a[104:107]
    v_mfma_f32_16x16x32_bf16 a[108:111], a[52:55], a[188:191], a[108:111]
    s_add_u32 s62, s62, 0x20000
    v_mfma_f32_16x16x32_bf16 v[240:243], a[56:59], a[176:179], v[240:243]
    s_add_u32 s52, s47, 8192
    v_mfma_f32_16x16x32_bf16 v[244:247], a[56:59], a[180:183], v[244:247]
    buffer_store_dwordx4 v[96:99], v1, s[48:51], s52 offen offset:0 sc1
    v_mfma_f32_16x16x32_bf16 a[112:115], a[56:59], a[184:187], a[112:115]
    v_mfma_f32_16x16x32_bf16 a[116:119], a[56:59], a[188:191], a[116:119]
    v_mfma_f32_16x16x32_bf16 v[248:251], a[60:63], a[176:179], v[248:251]
    v_mfma_f32_16x16x32_bf16 v[252:255], a[60:63], a[180:183], v[252:255]
    v_mfma_f32_16x16x32_bf16 a[120:123], a[60:63], a[184:187], a[120:123]
    v_mfma_f32_16x16x32_bf16 a[124:127], a[60:63], a[188:191], a[124:127]
    s_waitcnt vmcnt(15) lgkmcnt(0)
    v_mfma_f32_16x16x32_bf16 v[192:195], a[0:3], a[192:195], v[192:195]
    ds_read_b64_tr_b16 a[32:33], v42 offset:8192
    ds_read_b64_tr_b16 a[34:35], v42 offset:9216
    v_mfma_f32_16x16x32_bf16 v[196:199], a[0:3], a[196:199], v[196:199]
    buffer_load_dwordx4 a[240:243], v36, s[8:11], s62 offen sc1
    v_mfma_f32_16x16x32_bf16 a[64:67], a[0:3], a[200:203], a[64:67]
    ds_read_b64_tr_b16 a[36:37], v43 offset:8192
    v_mfma_f32_16x16x32_bf16 a[68:71], a[0:3], a[204:207], a[68:71]
    ds_read_b64_tr_b16 a[38:39], v43 offset:9216
    v_mfma_f32_16x16x32_bf16 v[200:203], a[4:7], a[192:195], v[200:203]
    ds_read_b64_tr_b16 a[40:41], v44 offset:8192
    v_mfma_f32_16x16x32_bf16 v[204:207], a[4:7], a[196:199], v[204:207]
    v_mfma_f32_16x16x32_bf16 a[72:75], a[4:7], a[200:203], a[72:75]
    buffer_load_dwordx4 a[244:247], v54, s[8:11], s62 offen sc1
    ds_read_b64_tr_b16 a[42:43], v44 offset:9216
    v_mfma_f32_16x16x32_bf16 a[76:79], a[4:7], a[204:207], a[76:79]
    ds_read_b64_tr_b16 a[44:45], v45 offset:8192
    v_mfma_f32_16x16x32_bf16 v[208:211], a[8:11], a[192:195], v[208:211]
    v_mfma_f32_16x16x32_bf16 v[212:215], a[8:11], a[196:199], v[212:215]
    ds_read_b64_tr_b16 a[46:47], v45 offset:9216
    v_mfma_f32_16x16x32_bf16 a[80:83], a[8:11], a[200:203], a[80:83]
    ds_read_b64_tr_b16 a[48:49], v46 offset:8192
    v_mfma_f32_16x16x32_bf16 a[84:87], a[8:11], a[204:207], a[84:87]
    buffer_load_dwordx4 a[248:251], v37, s[8:11], s62 offen sc1
    ds_read_b64_tr_b16 a[50:51], v46 offset:9216
    v_mfma_f32_16x16x32_bf16 v[216:219], a[12:15], a[192:195], v[216:219]
    v_mfma_f32_16x16x32_bf16 v[220:223], a[12:15], a[196:199], v[220:223]
    ds_read_b64_tr_b16 a[52:53], v47 offset:8192
    v_mfma_f32_16x16x32_bf16 a[88:91], a[12:15], a[200:203], a[88:91]
    ds_read_b64_tr_b16 a[54:55], v47 offset:9216
    v_mfma_f32_16x16x32_bf16 a[92:95], a[12:15], a[204:207], a[92:95]
    ds_read_b64_tr_b16 a[56:57], v48 offset:8192
    v_mfma_f32_16x16x32_bf16 v[224:227], a[16:19], a[192:195], v[224:227]
    v_mfma_f32_16x16x32_bf16 v[228:231], a[16:19], a[196:199], v[228:231]
    buffer_load_dwordx4 a[252:255], v55, s[8:11], s62 offen sc1
    ds_read_b64_tr_b16 a[58:59], v48 offset:9216
    v_mfma_f32_16x16x32_bf16 a[96:99], a[16:19], a[200:203], a[96:99]
    ds_read_b64_tr_b16 a[60:61], v49 offset:8192
    v_mfma_f32_16x16x32_bf16 a[100:103], a[16:19], a[204:207], a[100:103]
    v_mfma_f32_16x16x32_bf16 v[232:235], a[20:23], a[192:195], v[232:235]
    ds_read_b64_tr_b16 a[62:63], v49 offset:9216
    v_mfma_f32_16x16x32_bf16 v[236:239], a[20:23], a[196:199], v[236:239]
    s_add_u32 s62, s62, 0x20000
    v_mfma_f32_16x16x32_bf16 a[104:107], a[20:23], a[200:203], a[104:107]
    s_add_u32 s52, s47, 8192
    v_mfma_f32_16x16x32_bf16 a[108:111], a[20:23], a[204:207], a[108:111]
    buffer_store_dwordx4 v[100:103], v1, s[48:51], s52 offen offset:1024 sc1
    v_mfma_f32_16x16x32_bf16 v[240:243], a[24:27], a[192:195], v[240:243]
    v_mfma_f32_16x16x32_bf16 v[244:247], a[24:27], a[196:199], v[244:247]
    v_mfma_f32_16x16x32_bf16 a[112:115], a[24:27], a[200:203], a[112:115]
    v_mfma_f32_16x16x32_bf16 a[116:119], a[24:27], a[204:207], a[116:119]
    v_mfma_f32_16x16x32_bf16 v[248:251], a[28:31], a[192:195], v[248:251]
    s_cmp_eq_u32 s45, 0
    s_cbranch_scc1 k12_ool_48
k12_oolret_49:
    v_mfma_f32_16x16x32_bf16 v[252:255], a[28:31], a[196:199], v[252:255]
    v_mfma_f32_16x16x32_bf16 a[120:123], a[28:31], a[200:203], a[120:123]
    v_mfma_f32_16x16x32_bf16 a[124:127], a[28:31], a[204:207], a[124:127]
    s_waitcnt vmcnt(10) lgkmcnt(0)
    s_barrier
    v_mfma_f32_16x16x32_bf16 v[192:195], a[32:35], a[208:211], v[192:195]
    ds_read_b64_tr_b16 a[0:1], v42 offset:16384
    ds_read_b64_tr_b16 a[2:3], v42 offset:17408
    v_mfma_f32_16x16x32_bf16 v[196:199], a[32:35], a[212:215], v[196:199]
    s_add_u32 m0, s60, 131072
    v_mfma_f32_16x16x32_bf16 a[64:67], a[32:35], a[216:219], a[64:67]
    buffer_load_dwordx4 v38, s[12:15], s61 offen offset:0 lds
    ds_read_b64_tr_b16 a[4:5], v43 offset:16384
    v_mfma_f32_16x16x32_bf16 a[68:71], a[32:35], a[220:223], a[68:71]
    ds_read_b64_tr_b16 a[6:7], v43 offset:17408
    v_mfma_f32_16x16x32_bf16 v[200:203], a[36:39], a[208:211], v[200:203]
    buffer_load_dwordx4 v39, s[12:15], s61 offen offset:1024 lds
    ds_read_b64_tr_b16 a[8:9], v44 offset:16384
    v_mfma_f32_16x16x32_bf16 v[204:207], a[36:39], a[212:215], v[204:207]
    v_mfma_f32_16x16x32_bf16 a[72:75], a[36:39], a[216:219], a[72:75]
    buffer_load_dwordx4 v40, s[12:15], s61 offen offset:2048 lds
    ds_read_b64_tr_b16 a[10:11], v44 offset:17408
    v_mfma_f32_16x16x32_bf16 a[76:79], a[36:39], a[220:223], a[76:79]
    ds_read_b64_tr_b16 a[12:13], v45 offset:16384
    v_mfma_f32_16x16x32_bf16 v[208:211], a[40:43], a[208:211], v[208:211]
    v_mfma_f32_16x16x32_bf16 v[212:215], a[40:43], a[212:215], v[212:215]
    buffer_load_dwordx4 v41, s[12:15], s61 offen offset:3072 lds
    ds_read_b64_tr_b16 a[14:15], v45 offset:17408
    v_mfma_f32_16x16x32_bf16 a[80:83], a[40:43], a[216:219], a[80:83]
    s_add_u32 s61, s61, 0x80000
    ds_read_b64_tr_b16 a[16:17], v46 offset:16384
    v_mfma_f32_16x16x32_bf16 a[84:87], a[40:43], a[220:223], a[84:87]
    buffer_load_dwordx4 a[128:131], v36, s[8:11], s62 offen sc1
    ds_read_b64_tr_b16 a[18:19], v46 offset:17408
    v_mfma_f32_16x16x32_bf16 v[216:219], a[44:47], a[208:211], v[216:219]
    v_mfma_f32_16x16x32_bf16 v[220:223], a[44:47], a[212:215], v[220:223]
    ds_read_b64_tr_b16 a[20:21], v47 offset:16384
    v_mfma_f32_16x16x32_bf16 a[88:91], a[44:47], a[216:219], a[88:91]
    buffer_load_dwordx4 a[132:135], v54, s[8:11], s62 offen sc1
    ds_read_b64_tr_b16 a[22:23], v47 offset:17408
    v_mfma_f32_16x16x32_bf16 a[92:95], a[44:47], a[220:223], a[92:95]
    ds_read_b64_tr_b16 a[24:25], v48 offset:16384
    v_mfma_f32_16x16x32_bf16 v[224:227], a[48:51], a[208:211], v[224:227]
    v_mfma_f32_16x16x32_bf16 v[228:231], a[48:51], a[212:215], v[228:231]
    buffer_load_dwordx4 a[136:139], v37, s[8:11], s62 offen sc1
    ds_read_b64_tr_b16 a[26:27], v48 offset:17408
    v_mfma_f32_16x16x32_bf16 a[96:99], a[48:51], a[216:219], a[96:99]
    ds_read_b64_tr_b16 a[28:29], v49 offset:16384
    v_mfma_f32_16x16x32_bf16 a[100:103], a[48:51], a[220:223], a[100:103]
    buffer_load_dwordx4 a[140:143], v55, s[8:11], s62 offen sc1
    v_mfma_f32_16x16x32_bf16 v[232:235], a[52:55], a[208:211], v[232:235]
    ds_read_b64_tr_b16 a[30:31], v49 offset:17408
    v_mfma_f32_16x16x32_bf16 v[236:239], a[52:55], a[212:215], v[236:239]
    s_add_u32 s62, s62, 0x20000
    v_mfma_f32_16x16x32_bf16 a[104:107], a[52:55], a[216:219], a[104:107]
    s_add_u32 s52, s47, 8192
    v_mfma_f32_16x16x32_bf16 a[108:111], a[52:55], a[220:223], a[108:111]
    buffer_store_dwordx4 v[104:107], v1, s[48:51], s52 offen offset:2048 sc1
    v_mfma_f32_16x16x32_bf16 v[240:243], a[56:59], a[208:211], v[240:243]
    s_add_u32 s52, s47, 8192
    v_mfma_f32_16x16x32_bf16 v[244:247], a[56:59], a[212:215], v[244:247]
    buffer_store_dwordx4 v[108:111], v1, s[48:51], s52 offen offset:3072 sc1
    v_mfma_f32_16x16x32_bf16 a[112:115], a[56:59], a[216:219], a[112:115]
    v_mfma_f32_16x16x32_bf16 a[116:119], a[56:59], a[220:223], a[116:119]
    v_mfma_f32_16x16x32_bf16 v[248:251], a[60:63], a[208:211], v[248:251]
    v_mfma_f32_16x16x32_bf16 v[252:255], a[60:63], a[212:215], v[252:255]
    v_mfma_f32_16x16x32_bf16 a[120:123], a[60:63], a[216:219], a[120:123]
    v_mfma_f32_16x16x32_bf16 a[124:127], a[60:63], a[220:223], a[124:127]
    s_waitcnt vmcnt(16) lgkmcnt(0)
    v_mfma_f32_16x16x32_bf16 v[192:195], a[0:3], a[224:227], v[192:195]
    ds_read_b64_tr_b16 a[32:33], v42 offset:24576
    ds_read_b64_tr_b16 a[34:35], v42 offset:25600
    v_mfma_f32_16x16x32_bf16 v[196:199], a[0:3], a[228:231], v[196:199]
    buffer_load_dwordx4 a[144:147], v36, s[8:11], s62 offen sc1
    v_mfma_f32_16x16x32_bf16 a[64:67], a[0:3], a[232:235], a[64:67]
    ds_read_b64_tr_b16 a[36:37], v43 offset:24576
    v_mfma_f32_16x16x32_bf16 a[68:71], a[0:3], a[236:239], a[68:71]
    ds_read_b64_tr_b16 a[38:39], v43 offset:25600
    v_mfma_f32_16x16x32_bf16 v[200:203], a[4:7], a[224:227], v[200:203]
    ds_read_b64_tr_b16 a[40:41], v44 offset:24576
    v_mfma_f32_16x16x32_bf16 v[204:207], a[4:7], a[228:231], v[204:207]
    v_mfma_f32_16x16x32_bf16 a[72:75], a[4:7], a[232:235], a[72:75]
    buffer_load_dwordx4 a[148:151], v54, s[8:11], s62 offen sc1
    ds_read_b64_tr_b16 a[42:43], v44 offset:25600
    v_mfma_f32_16x16x32_bf16 a[76:79], a[4:7], a[236:239], a[76:79]
    ds_read_b64_tr_b16 a[44:45], v45 offset:24576
    v_mfma_f32_16x16x32_bf16 v[208:211], a[8:11], a[224:227], v[208:211]
    v_mfma_f32_16x16x32_bf16 v[212:215], a[8:11], a[228:231], v[212:215]
    ds_read_b64_tr_b16 a[46:47], v45 offset:25600
    v_mfma_f32_16x16x32_bf16 a[80:83], a[8:11], a[232:235], a[80:83]
    ds_read_b64_tr_b16 a[48:49], v46 offset:24576
    v_mfma_f32_16x16x32_bf16 a[84:87], a[8:11], a[236:239], a[84:87]
    buffer_load_dwordx4 a[152:155], v37, s[8:11], s62 offen sc1
    ds_read_b64_tr_b16 a[50:51], v46 offset:25600
    v_mfma_f32_16x16x32_bf16 v[216:219], a[12:15], a[224:227], v[216:219]
    v_mfma_f32_16x16x32_bf16 v[220:223], a[12:15], a[228:231], v[220:223]
    ds_read_b64_tr_b16 a[52:53], v47 offset:24576
    v_mfma_f32_16x16x32_bf16 a[88:91], a[12:15], a[232:235], a[88:91]
    ds_read_b64_tr_b16 a[54:55], v47 offset:25600
    v_mfma_f32_16x16x32_bf16 a[92:95], a[12:15], a[236:239], a[92:95]
    ds_read_b64_tr_b16 a[56:57], v48 offset:24576
    v_mfma_f32_16x16x32_bf16 v[224:227], a[16:19], a[224:227], v[224:227]
    v_mfma_f32_16x16x32_bf16 v[228:231], a[16:19], a[228:231], v[228:231]
    buffer_load_dwordx4 a[156:159], v55, s[8:11], s62 offen sc1
    ds_read_b64_tr_b16 a[58:59], v48 offset:25600
    v_mfma_f32_16x16x32_bf16 a[96:99], a[16:19], a[232:235], a[96:99]
    ds_read_b64_tr_b16 a[60:61], v49 offset:24576
    v_mfma_f32_16x16x32_bf16 a[100:103], a[16:19], a[236:239], a[100:103]
    v_mfma_f32_16x16x32_bf16 v[232:235], a[20:23], a[224:227], v[232:235]
    ds_read_b64_tr_b16 a[62:63], v49 offset:25600
    v_mfma_f32_16x16x32_bf16 v[236:239], a[20:23], a[228:231], v[236:239]
    s_add_u32 s62, s62, 0x20000
    v_mfma_f32_16x16x32_bf16 a[104:107], a[20:23], a[232:235], a[104:107]
    s_add_u32 s52, s47, 12288
    v_mfma_f32_16x16x32_bf16 a[108:111], a[20:23], a[236:239], a[108:111]
    buffer_store_dwordx4 v[112:115], v1, s[48:51], s52 offen offset:0 sc1
    v_mfma_f32_16x16x32_bf16 v[240:243], a[24:27], a[224:227], v[240:243]
    v_mfma_f32_16x16x32_bf16 v[244:247], a[24:27], a[228:231], v[244:247]
    v_mfma_f32_16x16x32_bf16 a[112:115], a[24:27], a[232:235], a[112:115]
    v_mfma_f32_16x16x32_bf16 a[116:119], a[24:27], a[236:239], a[116:119]
    v_mfma_f32_16x16x32_bf16 v[248:251], a[28:31], a[224:227], v[248:251]
    v_mfma_f32_16x16x32_bf16 v[252:255], a[28:31], a[228:231], v[252:255]
    v_mfma_f32_16x16x32_bf16 a[120:123], a[28:31], a[232:235], a[120:123]
    v_mfma_f32_16x16x32_bf16 a[124:127], a[28:31], a[236:239], a[124:127]
    s_waitcnt vmcnt(11) lgkmcnt(0)
    s_barrier
    v_mfma_f32_16x16x32_bf16 v[192:195], a[32:35], a[240:243], v[192:195]
    ds_read_b64_tr_b16 a[0:1], v42 offset:32768
    ds_read_b64_tr_b16 a[2:3], v42 offset:33792
    v_mfma_f32_16x16x32_bf16 v[196:199], a[32:35], a[244:247], v[196:199]
    s_add_u32 m0, s60, 147456
    v_mfma_f32_16x16x32_bf16 a[64:67], a[32:35], a[248:251], a[64:67]
    buffer_load_dwordx4 v38, s[12:15], s61 offen offset:0 lds
    ds_read_b64_tr_b16 a[4:5], v43 offset:32768
    v_mfma_f32_16x16x32_bf16 a[68:71], a[32:35], a[252:255], a[68:71]
    ds_read_b64_tr_b16 a[6:7], v43 offset:33792
    v_mfma_f32_16x16x32_bf16 v[200:203], a[36:39], a[240:243], v[200:203]
    buffer_load_dwordx4 v39, s[12:15], s61 offen offset:1024 lds
    ds_read_b64_tr_b16 a[8:9], v44 offset:32768
    v_mfma_f32_16x16x32_bf16 v[204:207], a[36:39], a[244:247], v[204:207]
    v_mfma_f32_16x16x32_bf16 a[72:75], a[36:39], a[248:251], a[72:75]
    ds_read_b64_tr_b16 a[10:11], v44 offset:33792
    v_mfma_f32_16x16x32_bf16 a[76:79], a[36:39], a[252:255], a[76:79]
    buffer_load_dwordx4 v40, s[12:15], s61 offen offset:2048 lds
    ds_read_b64_tr_b16 a[12:13], v45 offset:32768
    v_mfma_f32_16x16x32_bf16 v[208:211], a[40:43], a[240:243], v[208:211]
    v_mfma_f32_16x16x32_bf16 v[212:215], a[40:43], a[244:247], v[212:215]
    ds_read_b64_tr_b16 a[14:15], v45 offset:33792
    v_mfma_f32_16x16x32_bf16 a[80:83], a[40:43], a[248:251], a[80:83]
    buffer_load_dwordx4 v41, s[12:15], s61 offen offset:3072 lds
    ds_read_b64_tr_b16 a[16:17], v46 offset:32768
    v_mfma_f32_16x16x32_bf16 a[84:87], a[40:43], a[252:255], a[84:87]
    ds_read_b64_tr_b16 a[18:19], v46 offset:33792
    v_mfma_f32_16x16x32_bf16 v[216:219], a[44:47], a[240:243], v[216:219]
    s_add_u32 s61, s61, 0x80000
    v_mfma_f32_16x16x32_bf16 v[220:223], a[44:47], a[244:247], v[220:223]
    buffer_load_dwordx4 a[160:163], v36, s[8:11], s62 offen sc1
    ds_read_b64_tr_b16 a[20:21], v47 offset:32768
    v_mfma_f32_16x16x32_bf16 a[88:91], a[44:47], a[248:251], a[88:91]
    ds_read_b64_tr_b16 a[22:23], v47 offset:33792
    v_mfma_f32_16x16x32_bf16 a[92:95], a[44:47], a[252:255], a[92:95]
    buffer_load_dwordx4 a[164:167], v54, s[8:11], s62 offen sc1
    ds_read_b64_tr_b16 a[24:25], v48 offset:32768
    v_mfma_f32_16x16x32_bf16 v[224:227], a[48:51], a[240:243], v[224:227]
    v_mfma_f32_16x16x32_bf16 v[228:231], a[48:51], a[244:247], v[228:231]
    ds_read_b64_tr_b16 a[26:27], v48 offset:33792
    v_mfma_f32_16x16x32_bf16 a[96:99], a[48:51], a[248:251], a[96:99]
    buffer_load_dwordx4 a[168:171], v37, s[8:11], s62 offen sc1
    ds_read_b64_tr_b16 a[28:29], v49 offset:32768
    v_mfma_f32_16x16x32_bf16 a[100:103], a[48:51], a[252:255], a[100:103]
    v_mfma_f32_16x16x32_bf16 v[232:235], a[52:55], a[240:243], v[232:235]
    ds_read_b64_tr_b16 a[30:31], v49 offset:33792
    v_mfma_f32_16x16x32_bf16 v[236:239], a[52:55], a[244:247], v[236:239]
    buffer_load_dwordx4 a[172:175], v55, s[8:11], s62 offen sc1
    v_mfma_f32_16x16x32_bf16 a[104:107], a[52:55], a[248:251], a[104:107]
    v_mfma_f32_16x16x32_bf16 a[108:111], a[52:55], a[252:255], a[108:111]
    s_add_u32 s62, s62, 0x20000
    v_mfma_f32_16x16x32_bf16 v[240:243], a[56:59], a[240:243], v[240:243]
    s_add_u32 s52, s47, 12288
    v_mfma_f32_16x16x32_bf16 v[244:247], a[56:59], a[244:247], v[244:247]
    buffer_store_dwordx4 v[116:119], v1, s[48:51], s52 offen offset:1024 sc1
    v_mfma_f32_16x16x32_bf16 a[112:115], a[56:59], a[248:251], a[112:115]
    v_mfma_f32_16x16x32_bf16 a[116:119], a[56:59], a[252:255], a[116:119]
    v_mfma_f32_16x16x32_bf16 v[248:251], a[60:63], a[240:243], v[248:251]
    s_cmp_eq_u32 s45, 0
    s_cbranch_scc1 k12_ool_50
k12_oolret_51:
    v_mfma_f32_16x16x32_bf16 v[252:255], a[60:63], a[244:247], v[252:255]
    v_mfma_f32_16x16x32_bf16 a[120:123], a[60:63], a[248:251], a[120:123]
    v_mfma_f32_16x16x32_bf16 a[124:127], a[60:63], a[252:255], a[124:127]
    s_waitcnt vmcnt(16) lgkmcnt(0)
    v_mfma_f32_16x16x32_bf16 v[192:195], a[0:3], a[128:131], v[192:195]
    ds_read_b64_tr_b16 a[32:33], v42 offset:40960
    ds_read_b64_tr_b16 a[34:35], v42 offset:41984
    v_mfma_f32_16x16x32_bf16 v[196:199], a[0:3], a[132:135], v[196:199]
    buffer_load_dwordx4 a[176:179], v36, s[8:11], s62 offen sc1
    v_mfma_f32_16x16x32_bf16 a[64:67], a[0:3], a[136:139], a[64:67]
    ds_read_b64_tr_b16 a[36:37], v43 offset:40960
    v_mfma_f32_16x16x32_bf16 a[68:71], a[0:3], a[140:143], a[68:71]
    ds_read_b64_tr_b16 a[38:39], v43 offset:41984
    v_mfma_f32_16x16x32_bf16 v[200:203], a[4:7], a[128:131], v[200:203]
    ds_read_b64_tr_b16 a[40:41], v44 offset:40960
    v_mfma_f32_16x16x32_bf16 v[204:207], a[4:7], a[132:135], v[204:207]
    v_mfma_f32_16x16x32_bf16 a[72:75], a[4:7], a[136:139], a[72:75]
    buffer_load_dwordx4 a[180:183], v54, s[8:11], s62 offen sc1
    ds_read_b64_tr_b16 a[42:43], v44 offset:41984
    v_mfma_f32_16x16x32_bf16 a[76:79], a[4:7], a[140:143], a[76:79]
    ds_read_b64_tr_b16 a[44:45], v45 offset:40960
    v_mfma_f32_16x16x32_bf16 v[208:211], a[8:11], a[128:131], v[208:211]
    v_mfma_f32_16x16x32_bf16 v[212:215], a[8:11], a[132:135], v[212:215]
    ds_read_b64_tr_b16 a[46:47], v45 offset:41984
    v_mfma_f32_16x16x32_bf16 a[80:83], a[8:11], a[136:139], a[80:83]
    ds_read_b64_tr_b16 a[48:49], v46 offset:40960
    v_mfma_f32_16x16x32_bf16 a[84:87], a[8:11], a[140:143], a[84:87]
    buffer_load_dwordx4 a[184:187], v37, s[8:11], s62 offen sc1
    ds_read_b64_tr_b16 a[50:51], v46 offset:41984
    v_mfma_f32_16x16x32_bf16 v[216:219], a[12:15], a[128:131], v[216:219]
    v_mfma_f32_16x16x32_bf16 v[220:223], a[12:15], a[132:135], v[220:223]
    ds_read_b64_tr_b16 a[52:53], v47 offset:40960
    v_mfma_f32_16x16x32_bf16 a[88:91], a[12:15], a[136:139], a[88:91]
    ds_read_b64_tr_b16 a[54:55], v47 offset:41984
    v_mfma_f32_16x16x32_bf16 a[92:95], a[12:15], a[140:143], a[92:95]
    ds_read_b64_tr_b16 a[56:57], v48 offset:40960
    v_mfma_f32_16x16x32_bf16 v[224:227], a[16:19], a[128:131], v[224:227]
    v_mfma_f32_16x16x32_bf16 v[228:231], a[16:19], a[132:135], v[228:231]
    buffer_load_dwordx4 a[188:191], v55, s[8:11], s62 offen sc1
    ds_read_b64_tr_b16 a[58:59], v48 offset:41984
    v_mfma_f32_16x16x32_bf16 a[96:99], a[16:19], a[136:139], a[96:99]
    ds_read_b64_tr_b16 a[60:61], v49 offset:40960
    v_mfma_f32_16x16x32_bf16 a[100:103], a[16:19], a[140:143], a[100:103]
    v_mfma_f32_16x16x32_bf16 v[232:235], a[20:23], a[128:131], v[232:235]
    ds_read_b64_tr_b16 a[62:63], v49 offset:41984
    v_mfma_f32_16x16x32_bf16 v[236:239], a[20:23], a[132:135], v[236:239]
    s_add_u32 s62, s62, 0x20000
    v_mfma_f32_16x16x32_bf16 a[104:107], a[20:23], a[136:139], a[104:107]
    s_add_u32 s52, s47, 12288
    v_mfma_f32_16x16x32_bf16 a[108:111], a[20:23], a[140:143], a[108:111]
    buffer_store_dwordx4 v[120:123], v1, s[48:51], s52 offen offset:2048 sc1
    v_mfma_f32_16x16x32_bf16 v[240:243], a[24:27], a[128:131], v[240:243]
    v_mfma_f32_16x16x32_bf16 v[244:247], a[24:27], a[132:135], v[244:247]
    v_mfma_f32_16x16x32_bf16 a[112:115], a[24:27], a[136:139], a[112:115]
    v_mfma_f32_16x16x32_bf16 a[116:119], a[24:27], a[140:143], a[116:119]
    v_mfma_f32_16x16x32_bf16 v[248:251], a[28:31], a[128:131], v[248:251]
    v_mfma_f32_16x16x32_bf16 v[252:255], a[28:31], a[132:135], v[252:255]
    v_mfma_f32_16x16x32_bf16 a[120:123], a[28:31], a[136:139], a[120:123]
    v_mfma_f32_16x16x32_bf16 a[124:127], a[28:31], a[140:143], a[124:127]
    s_waitcnt vmcnt(10) lgkmcnt(0)
    s_barrier
    v_mfma_f32_16x16x32_bf16 v[192:195], a[32:35], a[144:147], v[192:195]
    ds_read_b64_tr_b16 a[0:1], v42 offset:49152
    ds_read_b64_tr_b16 a[2:3], v42 offset:50176
    v_mfma_f32_16x16x32_bf16 v[196:199], a[32:35], a[148:151], v[196:199]
    s_add_u32 m0, s60, 98304
    v_mfma_f32_16x16x32_bf16 a[64:67], a[32:35], a[152:155], a[64:67]
    buffer_load_dwordx4 v38, s[12:15], s61 offen offset:0 lds
    ds_read_b64_tr_b16 a[4:5], v43 offset:49152
    v_mfma_f32_16x16x32_bf16 a[68:71], a[32:35], a[156:159], a[68:71]
    ds_read_b64_tr_b16 a[6:7], v43 offset:50176
    v_mfma_f32_16x16x32_bf16 v[200:203], a[36:39], a[144:147], v[200:203]
    buffer_load_dwordx4 v39, s[12:15], s61 offen offset:1024 lds
    ds_read_b64_tr_b16 a[8:9], v44 offset:49152
    v_mfma_f32_16x16x32_bf16 v[204:207], a[36:39], a[148:151], v[204:207]
    v_mfma_f32_16x16x32_bf16 a[72:75], a[36:39], a[152:155], a[72:75]
    ds_read_b64_tr_b16 a[10:11], v44 offset:50176
    v_mfma_f32_16x16x32_bf16 a[76:79], a[36:39], a[156:159], a[76:79]
    buffer_load_dwordx4 v40, s[12:15], s61 offen offset:2048 lds
    ds_read_b64_tr_b16 a[12:13], v45 offset:49152
    v_mfma_f32_16x16x32_bf16 v[208:211], a[40:43], a[144:147], v[208:211]
    v_mfma_f32_16x16x32_bf16 v[212:215], a[40:43], a[148:151], v[212:215]
    ds_read_b64_tr_b16 a[14:15], v45 offset:50176
    v_mfma_f32_16x16x32_bf16 a[80:83], a[40:43], a[152:155], a[80:83]
    buffer_load_dwordx4 v41, s[12:15], s61 offen offset:3072 lds
    ds_read_b64_tr_b16 a[16:17], v46 offset:49152
    v_mfma_f32_16x16x32_bf16 a[84:87], a[40:43], a[156:159], a[84:87]
    ds_read_b64_tr_b16 a[18:19], v46 offset:50176
    v_mfma_f32_16x16x32_bf16 v[216:219], a[44:47], a[144:147], v[216:219]
    s_add_u32 s61, s61, 0x80000
    v_mfma_f32_16x16x32_bf16 v[220:223], a[44:47], a[148:151], v[220:223]
    buffer_load_dwordx4 a[192:195], v36, s[8:11], s62 offen sc1
    ds_read_b64_tr_b16 a[20:21], v47 offset:49152
    v_mfma_f32_16x16x32_bf16 a[88:91], a[44:47], a[152:155], a[88:91]
    ds_read_b64_tr_b16 a[22:23], v47 offset:50176
    v_mfma_f32_16x16x32_bf16 a[92:95], a[44:47], a[156:159], a[92:95]
    buffer_load_dwordx4 a[196:199], v54, s[8:11], s62 offen sc1
    ds_read_b64_tr_b16 a[24:25], v48 offset:49152
    v_mfma_f32_16x16x32_bf16 v[224:227], a[48:51], a[144:147], v[224:227]
    v_mfma_f32_16x16x32_bf16 v[228:231], a[48:51], a[148:151], v[228:231]
    ds_read_b64_tr_b16 a[26:27], v48 offset:50176
    v_mfma_f32_16x16x32_bf16 a[96:99], a[48:51], a[152:155], a[96:99]
    buffer_load_dwordx4 a[200:203], v37, s[8:11], s62 offen sc1
    ds_read_b64_tr_b16 a[28:29], v49 offset:49152
    v_mfma_f32_16x16x32_bf16 a[100:103], a[48:51], a[156:159], a[100:103]
    v_mfma_f32_16x16x32_bf16 v[232:235], a[52:55], a[144:147], v[232:235]
    ds_read_b64_tr_b16 a[30:31], v49 offset:50176
    v_mfma_f32_16x16x32_bf16 v[236:239], a[52:55], a[148:151], v[236:239]
    buffer_load_dwordx4 a[204:207], v55, s[8:11], s62 offen sc1
    v_mfma_f32_16x16x32_bf16 a[104:107], a[52:55], a[152:155], a[104:107]
    v_mfma_f32_16x16x32_bf16 a[108:111], a[52:55], a[156:159], a[108:111]
    s_add_u32 s62, s62, 0x20000
    v_mfma_f32_16x16x32_bf16 v[240:243], a[56:59], a[144:147], v[240:243]
    s_add_u32 s52, s47, 12288
    v_mfma_f32_16x16x32_bf16 v[244:247], a[56:59], a[148:151], v[244:247]
    buffer_store_dwordx4 v[124:127], v1, s[48:51], s52 offen offset:3072 sc1
    v_mfma_f32_16x16x32_bf16 a[112:115], a[56:59], a[152:155], a[112:115]
    v_mfma_f32_16x16x32_bf16 a[116:119], a[56:59], a[156:159], a[116:119]
    v_mfma_f32_16x16x32_bf16 v[248:251], a[60:63], a[144:147], v[248:251]
    s_cmp_eq_u32 s45, 0
    s_cbranch_scc1 k12_ool_52
k12_oolret_53:
    v_mfma_f32_16x16x32_bf16 v[252:255], a[60:63], a[148:151], v[252:255]
    v_mfma_f32_16x16x32_bf16 a[120:123], a[60:63], a[152:155], a[120:123]
    v_mfma_f32_16x16x32_bf16 a[124:127], a[60:63], a[156:159], a[124:127]
    s_waitcnt vmcnt(15) lgkmcnt(0)
    v_mfma_f32_16x16x32_bf16 v[192:195], a[0:3], a[160:163], v[192:195]
    ds_read_b64_tr_b16 a[32:33], v42 offset:57344
    ds_read_b64_tr_b16 a[34:35], v42 offset:58368
    v_mfma_f32_16x16x32_bf16 v[196:199], a[0:3], a[164:167], v[196:199]
    buffer_load_dwordx4 a[208:211], v36, s[8:11], s62 offen sc1
    v_mfma_f32_16x16x32_bf16 a[64:67], a[0:3], a[168:171], a[64:67]
    ds_read_b64_tr_b16 a[36:37], v43 offset:57344
    v_mfma_f32_16x16x32_bf16 a[68:71], a[0:3], a[172:175], a[68:71]
    ds_read_b64_tr_b16 a[38:39], v43 offset:58368
    v_mfma_f32_16x16x32_bf16 v[200:203], a[4:7], a[160:163], v[200:203]
    ds_read_b64_tr_b16 a[40:41], v44 offset:57344
    v_mfma_f32_16x16x32_bf16 v[204:207], a[4:7], a[164:167], v[204:207]
    v_mfma_f32_16x16x32_bf16 a[72:75], a[4:7], a[168:171], a[72:75]
    buffer_load_dwordx4 a[212:215], v54, s[8:11], s62 offen sc1
    ds_read_b64_tr_b16 a[42:43], v44 offset:58368
    v_mfma_f32_16x16x32_bf16 a[76:79], a[4:7], a[172:175], a[76:79]
    ds_read_b64_tr_b16 a[44:45], v45 offset:57344
    v_mfma_f32_16x16x32_bf16 v[208:211], a[8:11], a[160:163], v[208:211]
    v_mfma_f32_16x16x32_bf16 v[212:215], a[8:11], a[164:167], v[212:215]
    ds_read_b64_tr_b16 a[46:47], v45 offset:58368
    v_mfma_f32_16x16x32_bf16 a[80:83], a[8:11], a[168:171], a[80:83]
    ds_read_b64_tr_b16 a[48:49], v46 offset:57344
    v_mfma_f32_16x16x32_bf16 a[84:87], a[8:11], a[172:175], a[84:87]
    buffer_load_dwordx4 a[216:219], v37, s[8:11], s62 offen sc1
    ds_read_b64_tr_b16 a[50:51], v46 offset:58368
    v_mfma_f32_16x16x32_bf16 v[216:219], a[12:15], a[160:163], v[216:219]
    v_mfma_f32_16x16x32_bf16 v[220:223], a[12:15], a[164:167], v[220:223]
    ds_read_b64_tr_b16 a[52:53], v47 offset:57344
    v_mfma_f32_16x16x32_bf16 a[88:91], a[12:15], a[168:171], a[88:91]
    ds_read_b64_tr_b16 a[54:55], v47 offset:58368
    v_mfma_f32_16x16x32_bf16 a[92:95], a[12:15], a[172:175], a[92:95]
    ds_read_b64_tr_b16 a[56:57], v48 offset:57344
    v_mfma_f32_16x16x32_bf16 v[224:227], a[16:19], a[160:163], v[224:227]
    v_mfma_f32_16x16x32_bf16 v[228:231], a[16:19], a[164:167], v[228:231]
    buffer_load_dwordx4 a[220:223], v55, s[8:11], s62 offen sc1
    ds_read_b64_tr_b16 a[58:59], v48 offset:58368
    v_mfma_f32_16x16x32_bf16 a[96:99], a[16:19], a[168:171], a[96:99]
    ds_read_b64_tr_b16 a[60:61], v49 offset:57344
    v_mfma_f32_16x16x32_bf16 a[100:103], a[16:19], a[172:175], a[100:103]
    v_mfma_f32_16x16x32_bf16 v[232:235], a[20:23], a[160:163], v[232:235]
    ds_read_b64_tr_b16 a[62:63], v49 offset:58368
    v_mfma_f32_16x16x32_bf16 v[236:239], a[20:23], a[164:167], v[236:239]
    s_add_u32 s62, s62, 0x20000
    v_mfma_f32_16x16x32_bf16 a[104:107], a[20:23], a[168:171], a[104:107]
    s_add_u32 s52, s47, 524288
    v_mfma_f32_16x16x32_bf16 a[108:111], a[20:23], a[172:175], a[108:111]
    buffer_store_dwordx4 v[128:131], v1, s[48:51], s52 offen offset:0 sc1
    v_mfma_f32_16x16x32_bf16 v[240:243], a[24:27], a[160:163], v[240:243]
    v_mfma_f32_16x16x32_bf16 v[244:247], a[24:27], a[164:167], v[244:247]
    v_mfma_f32_16x16x32_bf16 a[112:115], a[24:27], a[168:171], a[112:115]
    v_mfma_f32_16x16x32_bf16 a[116:119], a[24:27], a[172:175], a[116:119]
    v_mfma_f32_16x16x32_bf16 v[248:251], a[28:31], a[160:163], v[248:251]
    v_mfma_f32_16x16x32_bf16 v[252:255], a[28:31], a[164:167], v[252:255]
    v_mfma_f32_16x16x32_bf16 a[120:123], a[28:31], a[168:171], a[120:123]
    v_mfma_f32_16x16x32_bf16 a[124:127], a[28:31], a[172:175], a[124:127]
    s_waitcnt vmcnt(10) lgkmcnt(0)
    s_barrier
    v_mfma_f32_16x16x32_bf16 v[192:195], a[32:35], a[176:179], v[192:195]
    ds_read_b64_tr_b16 a[0:1], v42 offset:0
    ds_read_b64_tr_b16 a[2:3], v42 offset:1024
    v_mfma_f32_16x16x32_bf16 v[196:199], a[32:35], a[180:183], v[196:199]
    s_add_u32 m0, s60, 114688
    v_mfma_f32_16x16x32_bf16 a[64:67], a[32:35], a[184:187], a[64:67]
    buffer_load_dwordx4 v38, s[12:15], s61 offen offset:0 lds
    ds_read_b64_tr_b16 a[4:5], v43 offset:0
    v_mfma_f32_16x16x32_bf16 a[68:71], a[32:35], a[188:191], a[68:71]
    ds_read_b64_tr_b16 a[6:7], v43 offset:1024
    v_mfma_f32_16x16x32_bf16 v[200:203], a[36:39], a[176:179], v[200:203]
    buffer_load_dwordx4 v39, s[12:15], s61 offen offset:1024 lds
    ds_read_b64_tr_b16 a[8:9], v44 offset:0
    v_mfma_f32_16x16x32_bf16 v[204:207], a[36:39], a[180:183], v[204:207]
    v_mfma_f32_16x16x32_bf16 a[72:75], a[36:39], a[184:187], a[72:75]
    ds_read_b64_tr_b16 a[10:11], v44 offset:1024
    v_mfma_f32_16x16x32_bf16 a[76:79], a[36:39], a[188:191], a[76:79]
    buffer_load_dwordx4 v40, s[12:15], s61 offen offset:2048 lds
    ds_read_b64_tr_b16 a[12:13], v45 offset:0
    v_mfma_f32_16x16x32_bf16 v[208:211], a[40:43], a[176:179], v[208:211]
    v_mfma_f32_16x16x32_bf16 v[212:215], a[40:43], a[180:183], v[212:215]
    ds_read_b64_tr_b16 a[14:15], v45 offset:1024
    v_mfma_f32_16x16x32_bf16 a[80:83], a[40:43], a[184:187], a[80:83]
    buffer_load_dwordx4 v41, s[12:15], s61 offen offset:3072 lds
    ds_read_b64_tr_b16 a[16:17], v46 offset:0
    v_mfma_f32_16x16x32_bf16 a[84:87], a[40:43], a[188:191], a[84:87]
    ds_read_b64_tr_b16 a[18:19], v46 offset:1024
    v_mfma_f32_16x16x32_bf16 v[216:219], a[44:47], a[176:179], v[216:219]
    s_add_u32 s61, s61, 0x80000
    v_mfma_f32_16x16x32_bf16 v[220:223], a[44:47], a[180:183], v[220:223]
    buffer_load_dwordx4 a[224:227], v36, s[8:11], s62 offen sc1
    ds_read_b64_tr_b16 a[20:21], v47 offset:0
    v_mfma_f32_16x16x32_bf16 a[88:91], a[44:47], a[184:187], a[88:91]
    ds_read_b64_tr_b16 a[22:23], v47 offset:1024
    v_mfma_f32_16x16x32_bf16 a[92:95], a[44:47], a[188:191], a[92:95]
    buffer_load_dwordx4 a[228:231], v54, s[8:11], s62 offen sc1
    ds_read_b64_tr_b16 a[24:25], v48 offset:0
    v_mfma_f32_16x16x32_bf16 v[224:227], a[48:51], a[176:179], v[224:227]
    v_mfma_f32_16x16x32_bf16 v[228:231], a[48:51], a[180:183], v[228:231]
    ds_read_b64_tr_b16 a[26:27], v48 offset:1024
    v_mfma_f32_16x16x32_bf16 a[96:99], a[48:51], a[184:187], a[96:99]
    buffer_load_dwordx4 a[232:235], v37, s[8:11], s62 offen sc1
    ds_read_b64_tr_b16 a[28:29], v49 offset:0
    v_mfma_f32_16x16x32_bf16 a[100:103], a[48:51], a[188:191], a[100:103]
    v_mfma_f32_16x16x32_bf16 v[232:235], a[52:55], a[176:179], v[232:235]
    ds_read_b64_tr_b16 a[30:31], v49 offset:1024
    v_mfma_f32_16x16x32_bf16 v[236:239], a[52:55], a[180:183], v[236:239]
    buffer_load_dwordx4 a[236:239], v55, s[8:11], s62 offen sc1
    v_mfma_f32_16x16x32_bf16 a[104:107], a[52:55], a[184:187], a[104:107]
    v_mfma_f32_16x16x32_bf16 a[108:111], a[52:55], a[188:191], a[108:111]
    s_add_u32 s62, s62, 0x20000
    v_mfma_f32_16x16x32_bf16 v[240:243], a[56:59], a[176:179], v[240:243]
    s_add_u32 s52, s47, 524288
    v_mfma_f32_16x16x32_bf16 v[244:247], a[56:59], a[180:183], v[244:247]
    buffer_store_dwordx4 v[132:135], v1, s[48:51], s52 offen offset:1024 sc1
    v_mfma_f32_16x16x32_bf16 a[112:115], a[56:59], a[184:187], a[112:115]
    v_mfma_f32_16x16x32_bf16 a[116:119], a[56:59], a[188:191], a[116:119]
    v_mfma_f32_16x16x32_bf16 v[248:251], a[60:63], a[176:179], v[248:251]
    s_cmp_eq_u32 s45, 0
    s_cbranch_scc1 k12_ool_54
k12_oolret_55:
    v_mfma_f32_16x16x32_bf16 v[252:255], a[60:63], a[180:183], v[252:255]
    v_mfma_f32_16x16x32_bf16 a[120:123], a[60:63], a[184:187], a[120:123]
    v_mfma_f32_16x16x32_bf16 a[124:127], a[60:63], a[188:191], a[124:127]
    s_waitcnt vmcnt(15) lgkmcnt(0)
    v_mfma_f32_16x16x32_bf16 v[192:195], a[0:3], a[192:195], v[192:195]
    ds_read_b64_tr_b16 a[32:33], v42 offset:8192
    ds_read_b64_tr_b16 a[34:35], v42 offset:9216
    v_mfma_f32_16x16x32_bf16 v[196:199], a[0:3], a[196:199], v[196:199]
    buffer_load_dwordx4 a[240:243], v36, s[8:11], s62 offen sc1
    v_mfma_f32_16x16x32_bf16 a[64:67], a[0:3], a[200:203], a[64:67]
    ds_read_b64_tr_b16 a[36:37], v43 offset:8192
    v_mfma_f32_16x16x32_bf16 a[68:71], a[0:3], a[204:207], a[68:71]
    ds_read_b64_tr_b16 a[38:39], v43 offset:9216
    v_mfma_f32_16x16x32_bf16 v[200:203], a[4:7], a[192:195], v[200:203]
    ds_read_b64_tr_b16 a[40:41], v44 offset:8192
    v_mfma_f32_16x16x32_bf16 v[204:207], a[4:7], a[196:199], v[204:207]
    v_mfma_f32_16x16x32_bf16 a[72:75], a[4:7], a[200:203], a[72:75]
    buffer_load_dwordx4 a[244:247], v54, s[8:11], s62 offen sc1
    ds_read_b64_tr_b16 a[42:43], v44 offset:9216
    v_mfma_f32_16x16x32_bf16 a[76:79], a[4:7], a[204:207], a[76:79]
    ds_read_b64_tr_b16 a[44:45], v45 offset:8192
    v_mfma_f32_16x16x32_bf16 v[208:211], a[8:11], a[192:195], v[208:211]
    v_mfma_f32_16x16x32_bf16 v[212:215], a[8:11], a[196:199], v[212:215]
    ds_read_b64_tr_b16 a[46:47], v45 offset:9216
    v_mfma_f32_16x16x32_bf16 a[80:83], a[8:11], a[200:203], a[80:83]
    ds_read_b64_tr_b16 a[48:49], v46 offset:8192
    v_mfma_f32_16x16x32_bf16 a[84:87], a[8:11], a[204:207], a[84:87]
    buffer_load_dwordx4 a[248:251], v37, s[8:11], s62 offen sc1
    ds_read_b64_tr_b16 a[50:51], v46 offset:9216
    v_mfma_f32_16x16x32_bf16 v[216:219], a[12:15], a[192:195], v[216:219]
    v_mfma_f32_16x16x32_bf16 v[220:223], a[12:15], a[196:199], v[220:223]
    ds_read_b64_tr_b16 a[52:53], v47 offset:8192
    v_mfma_f32_16x16x32_bf16 a[88:91], a[12:15], a[200:203], a[88:91]
    ds_read_b64_tr_b16 a[54:55], v47 offset:9216
    v_mfma_f32_16x16x32_bf16 a[92:95], a[12:15], a[204:207], a[92:95]
    ds_read_b64_tr_b16 a[56:57], v48 offset:8192
    v_mfma_f32_16x16x32_bf16 v[224:227], a[16:19], a[192:195], v[224:227]
    v_mfma_f32_16x16x32_bf16 v[228:231], a[16:19], a[196:199], v[228:231]
    buffer_load_dwordx4 a[252:255], v55, s[8:11], s62 offen sc1
    ds_read_b64_tr_b16 a[58:59], v48 offset:9216
    v_mfma_f32_16x16x32_bf16 a[96:99], a[16:19], a[200:203], a[96:99]
    ds_read_b64_tr_b16 a[60:61], v49 offset:8192
    v_mfma_f32_16x16x32_bf16 a[100:103], a[16:19], a[204:207], a[100:103]
    v_mfma_f32_16x16x32_bf16 v[232:235], a[20:23], a[192:195], v[232:235]
    ds_read_b64_tr_b16 a[62:63], v49 offset:9216
    v_mfma_f32_16x16x32_bf16 v[236:239], a[20:23], a[196:199], v[236:239]
    s_add_u32 s62, s62, 0x20000
    v_mfma_f32_16x16x32_bf16 a[104:107], a[20:23], a[200:203], a[104:107]
    s_add_u32 s52, s47, 524288
    v_mfma_f32_16x16x32_bf16 a[108:111], a[20:23], a[204:207], a[108:111]
    buffer_store_dwordx4 v[136:139], v1, s[48:51], s52 offen offset:2048 sc1
    v_mfma_f32_16x16x32_bf16 v[240:243], a[24:27], a[192:195], v[240:243]
    v_mfma_f32_16x16x32_bf16 v[244:247], a[24:27], a[196:199], v[244:247]
    v_mfma_f32_16x16x32_bf16 a[112:115], a[24:27], a[200:203], a[112:115]
    v_mfma_f32_16x16x32_bf16 a[116:119], a[24:27], a[204:207], a[116:119]
    v_mfma_f32_16x16x32_bf16 v[248:251], a[28:31], a[192:195], v[248:251]
    v_mfma_f32_16x16x32_bf16 v[252:255], a[28:31], a[196:199], v[252:255]
    v_mfma_f32_16x16x32_bf16 a[120:123], a[28:31], a[200:203], a[120:123]
    v_mfma_f32_16x16x32_bf16 a[124:127], a[28:31], a[204:207], a[124:127]
    s_waitcnt vmcnt(10) lgkmcnt(0)
    s_barrier
    v_mfma_f32_16x16x32_bf16 v[192:195], a[32:35], a[208:211], v[192:195]
    ds_read_b64_tr_b16 a[0:1], v42 offset:16384
    ds_read_b64_tr_b16 a[2:3], v42 offset:17408
    v_mfma_f32_16x16x32_bf16 v[196:199], a[32:35], a[212:215], v[196:199]
    s_add_u32 m0, s60, 131072
    v_mfma_f32_16x16x32_bf16 a[64:67], a[32:35], a[216:219], a[64:67]
    buffer_load_dwordx4 v38, s[12:15], s61 offen offset:0 lds
    ds_read_b64_tr_b16 a[4:5], v43 offset:16384
    v_mfma_f32_16x16x32_bf16 a[68:71], a[32:35], a[220:223], a[68:71]
    ds_read_b64_tr_b16 a[6:7], v43 offset:17408
    v_mfma_f32_16x16x32_bf16 v[200:203], a[36:39], a[208:211], v[200:203]
    buffer_load_dwordx4 v39, s[12:15], s61 offen offset:1024 lds
    ds_read_b64_tr_b16 a[8:9], v44 offset:16384
    v_mfma_f32_16x16x32_bf16 v[204:207], a[36:39], a[212:215], v[204:207]
    v_mfma_f32_16x16x32_bf16 a[72:75], a[36:39], a[216:219], a[72:75]
    ds_read_b64_tr_b16 a[10:11], v44 offset:17408
    v_mfma_f32_16x16x32_bf16 a[76:79], a[36:39], a[220:223], a[76:79]
    buffer_load_dwordx4 v40, s[12:15], s61 offen offset:2048 lds
    ds_read_b64_tr_b16 a[12:13], v45 offset:16384
    v_mfma_f32_16x16x32_bf16 v[208:211], a[40:43], a[208:211], v[208:211]
    v_mfma_f32_16x16x32_bf16 v[212:215], a[40:43], a[212:215], v[212:215]
    ds_read_b64_tr_b16 a[14:15], v45 offset:17408
    v_mfma_f32_16x16x32_bf16 a[80:83], a[40:43], a[216:219], a[80:83]
    buffer_load_dwordx4 v41, s[12:15], s61 offen offset:3072 lds
    ds_read_b64_tr_b16 a[16:17], v46 offset:16384
    v_mfma_f32_16x16x32_bf16 a[84:87], a[40:43], a[220:223], a[84:87]
    ds_read_b64_tr_b16 a[18:19], v46 offset:17408
    v_mfma_f32_16x16x32_bf16 v[216:219], a[44:47], a[208:211], v[216:219]
    s_add_u32 s61, s61, 0x80000
    v_mfma_f32_16x16x32_bf16 v[220:223], a[44:47], a[212:215], v[220:223]
    buffer_load_dwordx4 a[128:131], v36, s[8:11], s62 offen sc1
    ds_read_b64_tr_b16 a[20:21], v47 offset:16384
    v_mfma_f32_16x16x32_bf16 a[88:91], a[44:47], a[216:219], a[88:91]
    ds_read_b64_tr_b16 a[22:23], v47 offset:17408
    v_mfma_f32_16x16x32_bf16 a[92:95], a[44:47], a[220:223], a[92:95]
    buffer_load_dwordx4 a[132:135], v54, s[8:11], s62 offen sc1
    ds_read_b64_tr_b16 a[24:25], v48 offset:16384
    v_mfma_f32_16x16x32_bf16 v[224:227], a[48:51], a[208:211], v[224:227]
    v_mfma_f32_16x16x32_bf16 v[228:231], a[48:51], a[212:215], v[228:231]
    ds_read_b64_tr_b16 a[26:27], v48 offset:17408
    v_mfma_f32_16x16x32_bf16 a[96:99], a[48:51], a[216:219], a[96:99]
    buffer_load_dwordx4 a[136:139], v37, s[8:11], s62 offen sc1
    ds_read_b64_tr_b16 a[28:29], v49 offset:16384
    v_mfma_f32_16x16x32_bf16 a[100:103], a[48:51], a[220:223], a[100:103]
    v_mfma_f32_16x16x32_bf16 v[232:235], a[52:55], a[208:211], v[232:235]
    ds_read_b64_tr_b16 a[30:31], v49 offset:17408
    v_mfma_f32_16x16x32_bf16 v[236:239], a[52:55], a[212:215], v[236:239]
    buffer_load_dwordx4 a[140:143], v55, s[8:11], s62 offen sc1
    v_mfma_f32_16x16x32_bf16 a[104:107], a[52:55], a[216:219], a[104:107]
    v_mfma_f32_16x16x32_bf16 a[108:111], a[52:55], a[220:223], a[108:111]
    s_add_u32 s62, s62, 0x20000
    v_mfma_f32_16x16x32_bf16 v[240:243], a[56:59], a[208:211], v[240:243]
    s_add_u32 s52, s47, 524288
    v_mfma_f32_16x16x32_bf16 v[244:247], a[56:59], a[212:215], v[244:247]
    buffer_store_dwordx4 v[140:143], v1, s[48:51], s52 offen offset:3072 sc1
    v_mfma_f32_16x16x32_bf16 a[112:115], a[56:59], a[216:219], a[112:115]
    v_mfma_f32_16x16x32_bf16 a[116:119], a[56:59], a[220:223], a[116:119]
    v_mfma_f32_16x16x32_bf16 v[248:251], a[60:63], a[208:211], v[248:251]
    s_cmp_eq_u32 s45, 0
    s_cbranch_scc1 k12_ool_56
k12_oolret_57:
    v_mfma_f32_16x16x32_bf16 v[252:255], a[60:63], a[212:215], v[252:255]
    v_mfma_f32_16x16x32_bf16 a[120:123], a[60:63], a[216:219], a[120:123]
    v_mfma_f32_16x16x32_bf16 a[124:127], a[60:63], a[220:223], a[124:127]
    s_waitcnt vmcnt(15) lgkmcnt(0)
    v_mfma_f32_16x16x32_bf16 v[192:195], a[0:3], a[224:227], v[192:195]
    ds_read_b64_tr_b16 a[32:33], v42 offset:24576
    ds_read_b64_tr_b16 a[34:35], v42 offset:25600
    v_mfma_f32_16x16x32_bf16 v[196:199], a[0:3], a[228:231], v[196:199]
    buffer_load_dwordx4 a[144:147], v36, s[8:11], s62 offen sc1
    v_mfma_f32_16x16x32_bf16 a[64:67], a[0:3], a[232:235], a[64:67]
    ds_read_b64_tr_b16 a[36:37], v43 offset:24576
    v_mfma_f32_16x16x32_bf16 a[68:71], a[0:3], a[236:239], a[68:71]
    ds_read_b64_tr_b16 a[38:39], v43 offset:25600
    v_mfma_f32_16x16x32_bf16 v[200:203], a[4:7], a[224:227], v[200:203]
    ds_read_b64_tr_b16 a[40:41], v44 offset:24576
    v_mfma_f32_16x16x32_bf16 v[204:207], a[4:7], a[228:231], v[204:207]
    v_mfma_f32_16x16x32_bf16 a[72:75], a[4:7], a[232:235], a[72:75]
    buffer_load_dwordx4 a[148:151], v54, s[8:11], s62 offen sc1
    ds_read_b64_tr_b16 a[42:43], v44 offset:25600
    v_mfma_f32_16x16x32_bf16 a[76:79], a[4:7], a[236:239], a[76:79]
    ds_read_b64_tr_b16 a[44:45], v45 offset:24576
    v_mfma_f32_16x16x32_bf16 v[208:211], a[8:11], a[224:227], v[208:211]
    v_mfma_f32_16x16x32_bf16 v[212:215], a[8:11], a[228:231], v[212:215]
    ds_read_b64_tr_b16 a[46:47], v45 offset:25600
    v_mfma_f32_16x16x32_bf16 a[80:83], a[8:11], a[232:235], a[80:83]
    ds_read_b64_tr_b16 a[48:49], v46 offset:24576
    v_mfma_f32_16x16x32_bf16 a[84:87], a[8:11], a[236:239], a[84:87]
    buffer_load_dwordx4 a[152:155], v37, s[8:11], s62 offen sc1
    ds_read_b64_tr_b16 a[50:51], v46 offset:25600
    v_mfma_f32_16x16x32_bf16 v[216:219], a[12:15], a[224:227], v[216:219]
    v_mfma_f32_16x16x32_bf16 v[220:223], a[12:15], a[228:231], v[220:223]
    ds_read_b64_tr_b16 a[52:53], v47 offset:24576
    v_mfma_f32_16x16x32_bf16 a[88:91], a[12:15], a[232:235], a[88:91]
    ds_read_b64_tr_b16 a[54:55], v47 offset:25600
    v_mfma_f32_16x16x32_bf16 a[92:95], a[12:15], a[236:239], a[92:95]
    ds_read_b64_tr_b16 a[56:57], v48 offset:24576
    v_mfma_f32_16x16x32_bf16 v[224:227], a[16:19], a[224:227], v[224:227]
    v_mfma_f32_16x16x32_bf16 v[228:231], a[16:19], a[228:231], v[228:231]
    buffer_load_dwordx4 a[156:159], v55, s[8:11], s62 offen sc1
    ds_read_b64_tr_b16 a[58:59], v48 offset:25600
    v_mfma_f32_16x16x32_bf16 a[96:99], a[16:19], a[232:235], a[96:99]
    ds_read_b64_tr_b16 a[60:61], v49 offset:24576
    v_mfma_f32_16x16x32_bf16 a[100:103], a[16:19], a[236:239], a[100:103]
    v_mfma_f32_16x16x32_bf16 v[232:235], a[20:23], a[224:227], v[232:235]
    ds_read_b64_tr_b16 a[62:63], v49 offset:25600
    v_mfma_f32_16x16x32_bf16 v[236:239], a[20:23], a[228:231], v[236:239]
    s_add_u32 s62, s62, 0x20000
    v_mfma_f32_16x16x32_bf16 a[104:107], a[20:23], a[232:235], a[104:107]
    s_add_u32 s52, s47, 528384
    v_mfma_f32_16x16x32_bf16 a[108:111], a[20:23], a[236:239], a[108:111]
    buffer_store_dwordx4 v[144:147], v1, s[48:51], s52 offen offset:0 sc1
    v_mfma_f32_16x16x32_bf16 v[240:243], a[24:27], a[224:227], v[240:243]
    v_mfma_f32_16x16x32_bf16 v[244:247], a[24:27], a[228:231], v[244:247]
    v_mfma_f32_16x16x32_bf16 a[112:115], a[24:27], a[232:235], a[112:115]
    v_mfma_f32_16x16x32_bf16 a[116:119], a[24:27], a[236:239], a[116:119]
    v_mfma_f32_16x16x32_bf16 v[248:251], a[28:31], a[224:227], v[248:251]
    v_mfma_f32_16x16x32_bf16 v[252:255], a[28:31], a[228:231], v[252:255]
    v_mfma_f32_16x16x32_bf16 a[120:123], a[28:31], a[232:235], a[120:123]
    v_mfma_f32_16x16x32_bf16 a[124:127], a[28:31], a[236:239], a[124:127]
    s_waitcnt vmcnt(10) lgkmcnt(0)
    s_barrier
    v_mfma_f32_16x16x32_bf16 v[192:195], a[32:35], a[240:243], v[192:195]
    ds_read_b64_tr_b16 a[0:1], v42 offset:32768
    ds_read_b64_tr_b16 a[2:3], v42 offset:33792
    v_mfma_f32_16x16x32_bf16 v[196:199], a[32:35], a[244:247], v[196:199]
    s_add_u32 m0, s60, 147456
    v_mfma_f32_16x16x32_bf16 a[64:67], a[32:35], a[248:251], a[64:67]
    buffer_load_dwordx4 v38, s[12:15], s61 offen offset:0 lds
    ds_read_b64_tr_b16 a[4:5], v43 offset:32768
    v_mfma_f32_16x16x32_bf16 a[68:71], a[32:35], a[252:255], a[68:71]
    ds_read_b64_tr_b16 a[6:7], v43 offset:33792
    v_mfma_f32_16x16x32_bf16 v[200:203], a[36:39], a[240:243], v[200:203]
    buffer_load_dwordx4 v39, s[12:15], s61 offen offset:1024 lds
    ds_read_b64_tr_b16 a[8:9], v44 offset:32768
    v_mfma_f32_16x16x32_bf16 v[204:207], a[36:39], a[244:247], v[204:207]
    v_mfma_f32_16x16x32_bf16 a[72:75], a[36:39], a[248:251], a[72:75]
    buffer_load_dwordx4 v40, s[12:15], s61 offen offset:2048 lds
    ds_read_b64_tr_b16 a[10:11], v44 offset:33792
    v_mfma_f32_16x16x32_bf16 a[76:79], a[36:39], a[252:255], a[76:79]
    ds_read_b64_tr_b16 a[12:13], v45 offset:32768
    v_mfma_f32_16x16x32_bf16 v[208:211], a[40:43], a[240:243], v[208:211]
    v_mfma_f32_16x16x32_bf16 v[212:215], a[40:43], a[244:247], v[212:215]
    buffer_load_dwordx4 v41, s[12:15], s61 offen offset:3072 lds
    ds_read_b64_tr_b16 a[14:15], v45 offset:33792
    v_mfma_f32_16x16x32_bf16 a[80:83], a[40:43], a[248:251], a[80:83]
    s_add_u32 s61, s61, 0x80000
    ds_read_b64_tr_b16 a[16:17], v46 offset:32768
    v_mfma_f32_16x16x32_bf16 a[84:87], a[40:43], a[252:255], a[84:87]
    buffer_load_dwordx4 a[160:163], v36, s[8:11], s62 offen sc1
    ds_read_b64_tr_b16 a[18:19], v46 offset:33792
    v_mfma_f32_16x16x32_bf16 v[216:219], a[44:47], a[240:243], v[216:219]
    v_mfma_f32_16x16x32_bf16 v[220:223], a[44:47], a[244:247], v[220:223]
    ds_read_b64_tr_b16 a[20:21], v47 offset:32768
    v_mfma_f32_16x16x32_bf16 a[88:91], a[44:47], a[248:251], a[88:91]
    buffer_load_dwordx4 a[164:167], v54, s[8:11], s62 offen sc1
    ds_read_b64_tr_b16 a[22:23], v47 offset:33792
    v_mfma_f32_16x16x32_bf16 a[92:95], a[44:47], a[252:255], a[92:95]
    ds_read_b64_tr_b16 a[24:25], v48 offset:32768
    v_mfma_f32_16x16x32_bf16 v[224:227], a[48:51], a[240:243], v[224:227]
    v_mfma_f32_16x16x32_bf16 v[228:231], a[48:51], a[244:247], v[228:231]
    buffer_load_dwordx4 a[168:171], v37, s[8:11], s62 offen sc1
    ds_read_b64_tr_b16 a[26:27], v48 offset:33792
    v_mfma_f32_16x16x32_bf16 a[96:99], a[48:51], a[248:251], a[96:99]
    ds_read_b64_tr_b16 a[28:29], v49 offset:32768
    v_mfma_f32_16x16x32_bf16 a[100:103], a[48:51], a[252:255], a[100:103]
    buffer_load_dwordx4 a[172:175], v55, s[8:11], s62 offen sc1
    v_mfma_f32_16x16x32_bf16 v[232:235], a[52:55], a[240:243], v[232:235]
    ds_read_b64_tr_b16 a[30:31], v49 offset:33792
    v_mfma_f32_16x16x32_bf16 v[236:239], a[52:55], a[244:247], v[236:239]
    s_add_u32 s62, s62, 0x20000
    v_mfma_f32_16x16x32_bf16 a[104:107], a[52:55], a[248:251], a[104:107]
    s_add_u32 s52, s47, 528384
    v_mfma_f32_16x16x32_bf16 a[108:111], a[52:55], a[252:255], a[108:111]
    buffer_store_dwordx4 v[148:151], v1, s[48:51], s52 offen offset:1024 sc1
    v_mfma_f32_16x16x32_bf16 v[240:243], a[56:59], a[240:243], v[240:243]
    s_add_u32 s52, s47, 528384
    v_mfma_f32_16x16x32_bf16 v[244:247], a[56:59], a[244:247], v[244:247]
    buffer_store_dwordx4 v[152:155], v1, s[48:51], s52 offen offset:2048 sc1
    v_mfma_f32_16x16x32_bf16 a[112:115], a[56:59], a[248:251], a[112:115]
    v_mfma_f32_16x16x32_bf16 a[116:119], a[56:59], a[252:255], a[116:119]
    v_mfma_f32_16x16x32_bf16 v[248:251], a[60:63], a[240:243], v[248:251]
    s_cmp_eq_u32 s45, 0
    s_cbranch_scc1 k12_ool_58
k12_oolret_59:
    v_mfma_f32_16x16x32_bf16 v[252:255], a[60:63], a[244:247], v[252:255]
    v_mfma_f32_16x16x32_bf16 a[120:123], a[60:63], a[248:251], a[120:123]
    v_mfma_f32_16x16x32_bf16 a[124:127], a[60:63], a[252:255], a[124:127]
    s_waitcnt vmcnt(16) lgkmcnt(0)
    v_mfma_f32_16x16x32_bf16 v[192:195], a[0:3], a[128:131], v[192:195]
    ds_read_b64_tr_b16 a[32:33], v42 offset:40960
    ds_read_b64_tr_b16 a[34:35], v42 offset:41984
    v_mfma_f32_16x16x32_bf16 v[196:199], a[0:3], a[132:135], v[196:199]
    buffer_load_dwordx4 a[176:179], v36, s[8:11], s62 offen sc1
    v_mfma_f32_16x16x32_bf16 a[64:67], a[0:3], a[136:139], a[64:67]
    ds_read_b64_tr_b16 a[36:37], v43 offset:40960
    v_mfma_f32_16x16x32_bf16 a[68:71], a[0:3], a[140:143], a[68:71]
    ds_read_b64_tr_b16 a[38:39], v43 offset:41984
    v_mfma_f32_16x16x32_bf16 v[200:203], a[4:7], a[128:131], v[200:203]
    ds_read_b64_tr_b16 a[40:41], v44 offset:40960
    v_mfma_f32_16x16x32_bf16 v[204:207], a[4:7], a[132:135], v[204:207]
    v_mfma_f32_16x16x32_bf16 a[72:75], a[4:7], a[136:139], a[72:75]
    buffer_load_dwordx4 a[180:183], v54, s[8:11], s62 offen sc1
    ds_read_b64_tr_b16 a[42:43], v44 offset:41984
    v_mfma_f32_16x16x32_bf16 a[76:79], a[4:7], a[140:143], a[76:79]
    ds_read_b64_tr_b16 a[44:45], v45 offset:40960
    v_mfma_f32_16x16x32_bf16 v[208:211], a[8:11], a[128:131], v[208:211]
    v_mfma_f32_16x16x32_bf16 v[212:215], a[8:11], a[132:135], v[212:215]
    ds_read_b64_tr_b16 a[46:47], v45 offset:41984
    v_mfma_f32_16x16x32_bf16 a[80:83], a[8:11], a[136:139], a[80:83]
    ds_read_b64_tr_b16 a[48:49], v46 offset:40960
    v_mfma_f32_16x16x32_bf16 a[84:87], a[8:11], a[140:143], a[84:87]
    buffer_load_dwordx4 a[184:187], v37, s[8:11], s62 offen sc1
    ds_read_b64_tr_b16 a[50:51], v46 offset:41984
    v_mfma_f32_16x16x32_bf16 v[216:219], a[12:15], a[128:131], v[216:219]
    v_mfma_f32_16x16x32_bf16 v[220:223], a[12:15], a[132:135], v[220:223]
    ds_read_b64_tr_b16 a[52:53], v47 offset:40960
    v_mfma_f32_16x16x32_bf16 a[88:91], a[12:15], a[136:139], a[88:91]
    ds_read_b64_tr_b16 a[54:55], v47 offset:41984
    v_mfma_f32_16x16x32_bf16 a[92:95], a[12:15], a[140:143], a[92:95]
    ds_read_b64_tr_b16 a[56:57], v48 offset:40960
    v_mfma_f32_16x16x32_bf16 v[224:227], a[16:19], a[128:131], v[224:227]
    v_mfma_f32_16x16x32_bf16 v[228:231], a[16:19], a[132:135], v[228:231]
    buffer_load_dwordx4 a[188:191], v55, s[8:11], s62 offen sc1
    ds_read_b64_tr_b16 a[58:59], v48 offset:41984
    v_mfma_f32_16x16x32_bf16 a[96:99], a[16:19], a[136:139], a[96:99]
    ds_read_b64_tr_b16 a[60:61], v49 offset:40960
    v_mfma_f32_16x16x32_bf16 a[100:103], a[16:19], a[140:143], a[100:103]
    v_mfma_f32_16x16x32_bf16 v[232:235], a[20:23], a[128:131], v[232:235]
    ds_read_b64_tr_b16 a[62:63], v49 offset:41984
    v_mfma_f32_16x16x32_bf16 v[236:239], a[20:23], a[132:135], v[236:239]
    s_add_u32 s62, s62, 0x20000
    v_mfma_f32_16x16x32_bf16 a[104:107], a[20:23], a[136:139], a[104:107]
    s_add_u32 s52, s47, 528384
    v_mfma_f32_16x16x32_bf16 a[108:111], a[20:23], a[140:143], a[108:111]
    buffer_store_dwordx4 v[156:159], v1, s[48:51], s52 offen offset:3072 sc1
    v_mfma_f32_16x16x32_bf16 v[240:243], a[24:27], a[128:131], v[240:243]
    v_mfma_f32_16x16x32_bf16 v[244:247], a[24:27], a[132:135], v[244:247]
    v_mfma_f32_16x16x32_bf16 a[112:115], a[24:27], a[136:139], a[112:115]
    v_mfma_f32_16x16x32_bf16 a[116:119], a[24:27], a[140:143], a[116:119]
    v_mfma_f32_16x16x32_bf16 v[248:251], a[28:31], a[128:131], v[248:251]
    v_mfma_f32_16x16x32_bf16 v[252:255], a[28:31], a[132:135], v[252:255]
    v_mfma_f32_16x16x32_bf16 a[120:123], a[28:31], a[136:139], a[120:123]
    v_mfma_f32_16x16x32_bf16 a[124:127], a[28:31], a[140:143], a[124:127]
    s_waitcnt vmcnt(11) lgkmcnt(0)
    s_barrier
    v_mfma_f32_16x16x32_bf16 v[192:195], a[32:35], a[144:147], v[192:195]
    ds_read_b64_tr_b16 a[0:1], v42 offset:49152
    ds_read_b64_tr_b16 a[2:3], v42 offset:50176
    v_mfma_f32_16x16x32_bf16 v[196:199], a[32:35], a[148:151], v[196:199]
    s_add_u32 m0, s60, 98304
    v_mfma_f32_16x16x32_bf16 a[64:67], a[32:35], a[152:155], a[64:67]
    buffer_load_dwordx4 v38, s[12:15], s61 offen offset:0 lds
    ds_read_b64_tr_b16 a[4:5], v43 offset:49152
    v_mfma_f32_16x16x32_bf16 a[68:71], a[32:35], a[156:159], a[68:71]
    ds_read_b64_tr_b16 a[6:7], v43 offset:50176
    v_mfma_f32_16x16x32_bf16 v[200:203], a[36:39], a[144:147], v[200:203]
    buffer_load_dwordx4 v39, s[12:15], s61 offen offset:1024 lds
    ds_read_b64_tr_b16 a[8:9], v44 offset:49152
    v_mfma_f32_16x16x32_bf16 v[204:207], a[36:39], a[148:151], v[204:207]
    v_mfma_f32_16x16x32_bf16 a[72:75], a[36:39], a[152:155], a[72:75]
    ds_read_b64_tr_b16 a[10:11], v44 offset:50176
    v_mfma_f32_16x16x32_bf16 a[76:79], a[36:39], a[156:159], a[76:79]
    buffer_load_dwordx4 v40, s[12:15], s61 offen offset:2048 lds
    ds_read_b64_tr_b16 a[12:13], v45 offset:49152
    v_mfma_f32_16x16x32_bf16 v[208:211], a[40:43], a[144:147], v[208:211]
    v_mfma_f32_16x16x32_bf16 v[212:215], a[40:43], a[148:151], v[212:215]
    ds_read_b64_tr_b16 a[14:15], v45 offset:50176
    v_mfma_f32_16x16x32_bf16 a[80:83], a[40:43], a[152:155], a[80:83]
    buffer_load_dwordx4 v41, s[12:15], s61 offen offset:3072 lds
    ds_read_b64_tr_b16 a[16:17], v46 offset:49152
    v_mfma_f32_16x16x32_bf16 a[84:87], a[40:43], a[156:159], a[84:87]
    ds_read_b64_tr_b16 a[18:19], v46 offset:50176
    v_mfma_f32_16x16x32_bf16 v[216:219], a[44:47], a[144:147], v[216:219]
    s_add_u32 s61, s61, 0x80000
    v_mfma_f32_16x16x32_bf16 v[220:223], a[44:47], a[148:151], v[220:223]
    buffer_load_dwordx4 a[192:195], v36, s[8:11], s62 offen sc1
    ds_read_b64_tr_b16 a[20:21], v47 offset:49152
    v_mfma_f32_16x16x32_bf16 a[88:91], a[44:47], a[152:155], a[88:91]
    ds_read_b64_tr_b16 a[22:23], v47 offset:50176
    v_mfma_f32_16x16x32_bf16 a[92:95], a[44:47], a[156:159], a[92:95]
    buffer_load_dwordx4 a[196:199], v54, s[8:11], s62 offen sc1
    ds_read_b64_tr_b16 a[24:25], v48 offset:49152
    v_mfma_f32_16x16x32_bf16 v[224:227], a[48:51], a[144:147], v[224:227]
    v_mfma_f32_16x16x32_bf16 v[228:231], a[48:51], a[148:151], v[228:231]
    ds_read_b64_tr_b16 a[26:27], v48 offset:50176
    v_mfma_f32_16x16x32_bf16 a[96:99], a[48:51], a[152:155], a[96:99]
    buffer_load_dwordx4 a[200:203], v37, s[8:11], s62 offen sc1
    ds_read_b64_tr_b16 a[28:29], v49 offset:49152
    v_mfma_f32_16x16x32_bf16 a[100:103], a[48:51], a[156:159], a[100:103]
    v_mfma_f32_16x16x32_bf16 v[232:235], a[52:55], a[144:147], v[232:235]
    ds_read_b64_tr_b16 a[30:31], v49 offset:50176
    v_mfma_f32_16x16x32_bf16 v[236:239], a[52:55], a[148:151], v[236:239]
    buffer_load_dwordx4 a[204:207], v55, s[8:11], s62 offen sc1
    v_mfma_f32_16x16x32_bf16 a[104:107], a[52:55], a[152:155], a[104:107]
    v_mfma_f32_16x16x32_bf16 a[108:111], a[52:55], a[156:159], a[108:111]
    s_add_u32 s62, s62, 0x20000
    v_mfma_f32_16x16x32_bf16 v[240:243], a[56:59], a[144:147], v[240:243]
    s_add_u32 s52, s47, 532480
    v_mfma_f32_16x16x32_bf16 v[244:247], a[56:59], a[148:151], v[244:247]
    buffer_store_dwordx4 v[160:163], v1, s[48:51], s52 offen offset:0 sc1
    v_mfma_f32_16x16x32_bf16 a[112:115], a[56:59], a[152:155], a[112:115]
    v_mfma_f32_16x16x32_bf16 a[116:119], a[56:59], a[156:159], a[116:119]
    v_mfma_f32_16x16x32_bf16 v[248:251], a[60:63], a[144:147], v[248:251]
    v_mfma_f32_16x16x32_bf16 v[252:255], a[60:63], a[148:151], v[252:255]
    v_mfma_f32_16x16x32_bf16 a[120:123], a[60:63], a[152:155], a[120:123]
    v_mfma_f32_16x16x32_bf16 a[124:127], a[60:63], a[156:159], a[124:127]
    s_waitcnt vmcnt(16) lgkmcnt(0)
    v_mfma_f32_16x16x32_bf16 v[192:195], a[0:3], a[160:163], v[192:195]
    ds_read_b64_tr_b16 a[32:33], v42 offset:57344
    ds_read_b64_tr_b16 a[34:35], v42 offset:58368
    v_mfma_f32_16x16x32_bf16 v[196:199], a[0:3], a[164:167], v[196:199]
    buffer_load_dwordx4 a[208:211], v36, s[8:11], s62 offen sc1
    v_mfma_f32_16x16x32_bf16 a[64:67], a[0:3], a[168:171], a[64:67]
    ds_read_b64_tr_b16 a[36:37], v43 offset:57344
    v_mfma_f32_16x16x32_bf16 a[68:71], a[0:3], a[172:175], a[68:71]
    ds_read_b64_tr_b16 a[38:39], v43 offset:58368
    v_mfma_f32_16x16x32_bf16 v[200:203], a[4:7], a[160:163], v[200:203]
    ds_read_b64_tr_b16 a[40:41], v44 offset:57344
    v_mfma_f32_16x16x32_bf16 v[204:207], a[4:7], a[164:167], v[204:207]
    v_mfma_f32_16x16x32_bf16 a[72:75], a[4:7], a[168:171], a[72:75]
    buffer_load_dwordx4 a[212:215], v54, s[8:11], s62 offen sc1
    ds_read_b64_tr_b16 a[42:43], v44 offset:58368
    v_mfma_f32_16x16x32_bf16 a[76:79], a[4:7], a[172:175], a[76:79]
    ds_read_b64_tr_b16 a[44:45], v45 offset:57344
    v_mfma_f32_16x16x32_bf16 v[208:211], a[8:11], a[160:163], v[208:211]
    v_mfma_f32_16x16x32_bf16 v[212:215], a[8:11], a[164:167], v[212:215]
    ds_read_b64_tr_b16 a[46:47], v45 offset:58368
    v_mfma_f32_16x16x32_bf16 a[80:83], a[8:11], a[168:171], a[80:83]
    ds_read_b64_tr_b16 a[48:49], v46 offset:57344
    v_mfma_f32_16x16x32_bf16 a[84:87], a[8:11], a[172:175], a[84:87]
    buffer_load_dwordx4 a[216:219], v37, s[8:11], s62 offen sc1
    ds_read_b64_tr_b16 a[50:51], v46 offset:58368
    v_mfma_f32_16x16x32_bf16 v[216:219], a[12:15], a[160:163], v[216:219]
    v_mfma_f32_16x16x32_bf16 v[220:223], a[12:15], a[164:167], v[220:223]
    ds_read_b64_tr_b16 a[52:53], v47 offset:57344
    v_mfma_f32_16x16x32_bf16 a[88:91], a[12:15], a[168:171], a[88:91]
    ds_read_b64_tr_b16 a[54:55], v47 offset:58368
    v_mfma_f32_16x16x32_bf16 a[92:95], a[12:15], a[172:175], a[92:95]
    ds_read_b64_tr_b16 a[56:57], v48 offset:57344
    v_mfma_f32_16x16x32_bf16 v[224:227], a[16:19], a[160:163], v[224:227]
    v_mfma_f32_16x16x32_bf16 v[228:231], a[16:19], a[164:167], v[228:231]
    buffer_load_dwordx4 a[220:223], v55, s[8:11], s62 offen sc1
    ds_read_b64_tr_b16 a[58:59], v48 offset:58368
    v_mfma_f32_16x16x32_bf16 a[96:99], a[16:19], a[168:171], a[96:99]
    ds_read_b64_tr_b16 a[60:61], v49 offset:57344
    v_mfma_f32_16x16x32_bf16 a[100:103], a[16:19], a[172:175], a[100:103]
    v_mfma_f32_16x16x32_bf16 v[232:235], a[20:23], a[160:163], v[232:235]
    ds_read_b64_tr_b16 a[62:63], v49 offset:58368
    v_mfma_f32_16x16x32_bf16 v[236:239], a[20:23], a[164:167], v[236:239]
    s_add_u32 s62, s62, 0x20000
    v_mfma_f32_16x16x32_bf16 a[104:107], a[20:23], a[168:171], a[104:107]
    s_add_u32 s52, s47, 532480
    v_mfma_f32_16x16x32_bf16 a[108:111], a[20:23], a[172:175], a[108:111]
    buffer_store_dwordx4 v[164:167], v1, s[48:51], s52 offen offset:1024 sc1
    v_mfma_f32_16x16x32_bf16 v[240:243], a[24:27], a[160:163], v[240:243]
    v_mfma_f32_16x16x32_bf16 v[244:247], a[24:27], a[164:167], v[244:247]
    v_mfma_f32_16x16x32_bf16 a[112:115], a[24:27], a[168:171], a[112:115]
    v_mfma_f32_16x16x32_bf16 a[116:119], a[24:27], a[172:175], a[116:119]
    v_mfma_f32_16x16x32_bf16 v[248:251], a[28:31], a[160:163], v[248:251]
    v_mfma_f32_16x16x32_bf16 v[252:255], a[28:31], a[164:167], v[252:255]
    v_mfma_f32_16x16x32_bf16 a[120:123], a[28:31], a[168:171], a[120:123]
    v_mfma_f32_16x16x32_bf16 a[124:127], a[28:31], a[172:175], a[124:127]
    s_waitcnt vmcnt(10) lgkmcnt(0)
    s_barrier
    v_mfma_f32_16x16x32_bf16 v[192:195], a[32:35], a[176:179], v[192:195]
    ds_read_b64_tr_b16 a[0:1], v42 offset:0
    ds_read_b64_tr_b16 a[2:3], v42 offset:1024
    v_mfma_f32_16x16x32_bf16 v[196:199], a[32:35], a[180:183], v[196:199]
    s_cmp_eq_u32 s56, 0
    s_cbranch_scc1 k12_ool_60
k12_oolret_61:
    v_mfma_f32_16x16x32_bf16 a[64:67], a[32:35], a[184:187], a[64:67]
    s_add_u32 m0, s60, 114688
    ds_read_b64_tr_b16 a[4:5], v43 offset:0
    v_mfma_f32_16x16x32_bf16 a[68:71], a[32:35], a[188:191], a[68:71]
    buffer_load_dwordx4 v38, s[12:15], s61 offen offset:0 lds
    ds_read_b64_tr_b16 a[6:7], v43 offset:1024
    v_mfma_f32_16x16x32_bf16 v[200:203], a[36:39], a[176:179], v[200:203]
    buffer_load_dwordx4 v39, s[12:15], s61 offen offset:1024 lds
    ds_read_b64_tr_b16 a[8:9], v44 offset:0
    v_mfma_f32_16x16x32_bf16 v[204:207], a[36:39], a[180:183], v[204:207]
    v_mfma_f32_16x16x32_bf16 a[72:75], a[36:39], a[184:187], a[72:75]
    ds_read_b64_tr_b16 a[10:11], v44 offset:1024
    v_mfma_f32_16x16x32_bf16 a[76:79], a[36:39], a[188:191], a[76:79]
    buffer_load_dwordx4 v40, s[12:15], s61 offen offset:2048 lds
    ds_read_b64_tr_b16 a[12:13], v45 offset:0
    v_mfma_f32_16x16x32_bf16 v[208:211], a[40:43], a[176:179], v[208:211]
    s_mov_b32 s32, s60
    v_mfma_f32_16x16x32_bf16 v[212:215], a[40:43], a[180:183], v[212:215]
    ds_read_b64_tr_b16 a[14:15], v45 offset:1024
    v_mfma_f32_16x16x32_bf16 a[80:83], a[40:43], a[184:187], a[80:83]
    s_mov_b32 s34, s60
    buffer_load_dwordx4 v41, s[12:15], s61 offen offset:3072 lds
    ds_read_b64_tr_b16 a[16:17], v46 offset:0
    v_mfma_f32_16x16x32_bf16 a[84:87], a[40:43], a[188:191], a[84:87]
    ds_read_b64_tr_b16 a[18:19], v46 offset:1024
    v_mfma_f32_16x16x32_bf16 v[216:219], a[44:47], a[176:179], v[216:219]
    s_add_u32 s61, s61, 0x80000
    v_mfma_f32_16x16x32_bf16 v[220:223], a[44:47], a[180:183], v[220:223]
    s_mov_b32 s33, s60
    buffer_load_dwordx4 a[224:227], v36, s[8:11], s62 offen sc1
    ds_read_b64_tr_b16 a[20:21], v47 offset:0
    v_mfma_f32_16x16x32_bf16 a[88:91], a[44:47], a[184:187], a[88:91]
    ds_read_b64_tr_b16 a[22:23], v47 offset:1024
    v_mfma_f32_16x16x32_bf16 a[92:95], a[44:47], a[188:191], a[92:95]
    buffer_load_dwordx4 a[228:231], v54, s[8:11], s62 offen sc1
    ds_read_b64_tr_b16 a[24:25], v48 offset:0
    v_mfma_f32_16x16x32_bf16 v[224:227], a[48:51], a[176:179], v[224:227]
    s_add_u32 s35, s60, 0x10000
    v_mfma_f32_16x16x32_bf16 v[228:231], a[48:51], a[180:183], v[228:231]
    ds_read_b64_tr_b16 a[26:27], v48 offset:1024
    v_mfma_f32_16x16x32_bf16 a[96:99], a[48:51], a[184:187], a[96:99]
    buffer_load_dwordx4 a[232:235], v37, s[8:11], s62 offen sc1
    ds_read_b64_tr_b16 a[28:29], v49 offset:0
    v_mfma_f32_16x16x32_bf16 a[100:103], a[48:51], a[188:191], a[100:103]
    v_mfma_f32_16x16x32_bf16 v[232:235], a[52:55], a[176:179], v[232:235]
    ds_read_b64_tr_b16 a[30:31], v49 offset:1024
    v_mfma_f32_16x16x32_bf16 v[236:239], a[52:55], a[180:183], v[236:239]
    buffer_load_dwordx4 a[236:239], v55, s[8:11], s62 offen sc1
    v_mfma_f32_16x16x32_bf16 a[104:107], a[52:55], a[184:187], a[104:107]
    v_mfma_f32_16x16x32_bf16 a[108:111], a[52:55], a[188:191], a[108:111]
    s_add_u32 s62, s62, 0x20000
    v_mfma_f32_16x16x32_bf16 v[240:243], a[56:59], a[176:179], v[240:243]
    s_add_u32 s52, s47, 532480
    v_mfma_f32_16x16x32_bf16 v[244:247], a[56:59], a[180:183], v[244:247]
    buffer_store_dwordx4 v[168:171], v1, s[48:51], s52 offen offset:2048 sc1
    v_mfma_f32_16x16x32_bf16 a[112:115], a[56:59], a[184:187], a[112:115]
    v_mfma_f32_16x16x32_bf16 a[116:119], a[56:59], a[188:191], a[116:119]
    v_mfma_f32_16x16x32_bf16 v[248:251], a[60:63], a[176:179], v[248:251]
    v_mfma_f32_16x16x32_bf16 v[252:255], a[60:63], a[180:183], v[252:255]
    v_mfma_f32_16x16x32_bf16 a[120:123], a[60:63], a[184:187], a[120:123]
    v_mfma_f32_16x16x32_bf16 a[124:127], a[60:63], a[188:191], a[124:127]
    s_waitcnt vmcnt(15) lgkmcnt(0)
    v_mfma_f32_16x16x32_bf16 v[192:195], a[0:3], a[192:195], v[192:195]
    ds_read_b64_tr_b16 a[32:33], v42 offset:8192
    ds_read_b64_tr_b16 a[34:35], v42 offset:9216
    v_mfma_f32_16x16x32_bf16 v[196:199], a[0:3], a[196:199], v[196:199]
    buffer_load_dwordx4 a[240:243], v36, s[8:11], s62 offen sc1
    v_mfma_f32_16x16x32_bf16 a[64:67], a[0:3], a[200:203], a[64:67]
    ds_read_b64_tr_b16 a[36:37], v43 offset:8192
    v_mfma_f32_16x16x32_bf16 a[68:71], a[0:3], a[204:207], a[68:71]
    ds_read_b64_tr_b16 a[38:39], v43 offset:9216
    v_mfma_f32_16x16x32_bf16 v[200:203], a[4:7], a[192:195], v[200:203]
    ds_read_b64_tr_b16 a[40:41], v44 offset:8192
    v_mfma_f32_16x16x32_bf16 v[204:207], a[4:7], a[196:199], v[204:207]
    v_mfma_f32_16x16x32_bf16 a[72:75], a[4:7], a[200:203], a[72:75]
    buffer_load_dwordx4 a[244:247], v54, s[8:11], s62 offen sc1
    ds_read_b64_tr_b16 a[42:43], v44 offset:9216
    v_mfma_f32_16x16x32_bf16 a[76:79], a[4:7], a[204:207], a[76:79]
    ds_read_b64_tr_b16 a[44:45], v45 offset:8192
    v_mfma_f32_16x16x32_bf16 v[208:211], a[8:11], a[192:195], v[208:211]
    v_mfma_f32_16x16x32_bf16 v[212:215], a[8:11], a[196:199], v[212:215]
    ds_read_b64_tr_b16 a[46:47], v45 offset:9216
    v_mfma_f32_16x16x32_bf16 a[80:83], a[8:11], a[200:203], a[80:83]
    ds_read_b64_tr_b16 a[48:49], v46 offset:8192
    v_mfma_f32_16x16x32_bf16 a[84:87], a[8:11], a[204:207], a[84:87]
    buffer_load_dwordx4 a[248:251], v37, s[8:11], s62 offen sc1
    ds_read_b64_tr_b16 a[50:51], v46 offset:9216
    v_mfma_f32_16x16x32_bf16 v[216:219], a[12:15], a[192:195], v[216:219]
    v_mfma_f32_16x16x32_bf16 v[220:223], a[12:15], a[196:199], v[220:223]
    ds_read_b64_tr_b16 a[52:53], v47 offset:8192
    v_mfma_f32_16x16x32_bf16 a[88:91], a[12:15], a[200:203], a[88:91]
    ds_read_b64_tr_b16 a[54:55], v47 offset:9216
    v_mfma_f32_16x16x32_bf16 a[92:95], a[12:15], a[204:207], a[92:95]
    ds_read_b64_tr_b16 a[56:57], v48 offset:8192
    v_mfma_f32_16x16x32_bf16 v[224:227], a[16:19], a[192:195], v[224:227]
    v_mfma_f32_16x16x32_bf16 v[228:231], a[16:19], a[196:199], v[228:231]
    buffer_load_dwordx4 a[252:255], v55, s[8:11], s62 offen sc1
    ds_read_b64_tr_b16 a[58:59], v48 offset:9216
    v_mfma_f32_16x16x32_bf16 a[96:99], a[16:19], a[200:203], a[96:99]
    ds_read_b64_tr_b16 a[60:61], v49 offset:8192
    v_mfma_f32_16x16x32_bf16 a[100:103], a[16:19], a[204:207], a[100:103]
    v_mfma_f32_16x16x32_bf16 v[232:235], a[20:23], a[192:195], v[232:235]
    ds_read_b64_tr_b16 a[62:63], v49 offset:9216
    v_mfma_f32_16x16x32_bf16 v[236:239], a[20:23], a[196:199], v[236:239]
    s_add_u32 s62, s62, 0x20000
    v_mfma_f32_16x16x32_bf16 a[104:107], a[20:23], a[200:203], a[104:107]
    s_add_u32 s52, s47, 532480
    v_mfma_f32_16x16x32_bf16 a[108:111], a[20:23], a[204:207], a[108:111]
    buffer_store_dwordx4 v[172:175], v1, s[48:51], s52 offen offset:3072 sc1
    v_mfma_f32_16x16x32_bf16 v[240:243], a[24:27], a[192:195], v[240:243]
    v_mfma_f32_16x16x32_bf16 v[244:247], a[24:27], a[196:199], v[244:247]
    v_mfma_f32_16x16x32_bf16 a[112:115], a[24:27], a[200:203], a[112:115]
    v_mfma_f32_16x16x32_bf16 a[116:119], a[24:27], a[204:207], a[116:119]
    v_mfma_f32_16x16x32_bf16 v[248:251], a[28:31], a[192:195], v[248:251]
    v_add_co_u32 v2, vcc, 0x4000, v2
    s_nop 1
    v_addc_co_u32 v3, vcc, 0, v3, vcc
    global_load_dword v51, v[2:3], off
    v_mfma_f32_16x16x32_bf16 v[252:255], a[28:31], a[196:199], v[252:255]
    v_mfma_f32_16x16x32_bf16 a[120:123], a[28:31], a[200:203], a[120:123]
    v_mfma_f32_16x16x32_bf16 a[124:127], a[28:31], a[204:207], a[124:127]
    s_waitcnt vmcnt(10) lgkmcnt(0)
    s_barrier
    v_mfma_f32_16x16x32_bf16 v[192:195], a[32:35], a[208:211], v[192:195]
    ds_read_b64_tr_b16 a[0:1], v42 offset:16384
    ds_read_b64_tr_b16 a[2:3], v42 offset:17408
    v_mfma_f32_16x16x32_bf16 v[196:199], a[32:35], a[212:215], v[196:199]
    s_add_u32 m0, s60, 131072
    v_mfma_f32_16x16x32_bf16 a[64:67], a[32:35], a[216:219], a[64:67]
    buffer_load_dwordx4 v38, s[12:15], s61 offen offset:0 lds
    ds_read_b64_tr_b16 a[4:5], v43 offset:16384
    v_mfma_f32_16x16x32_bf16 a[68:71], a[32:35], a[220:223], a[68:71]
    ds_read_b64_tr_b16 a[6:7], v43 offset:17408
    v_mfma_f32_16x16x32_bf16 v[200:203], a[36:39], a[208:211], v[200:203]
    buffer_load_dwordx4 v39, s[12:15], s61 offen offset:1024 lds
    ds_read_b64_tr_b16 a[8:9], v44 offset:16384
    v_mfma_f32_16x16x32_bf16 v[204:207], a[36:39], a[212:215], v[204:207]
    v_mfma_f32_16x16x32_bf16 a[72:75], a[36:39], a[216:219], a[72:75]
    ds_read_b64_tr_b16 a[10:11], v44 offset:17408
    v_mfma_f32_16x16x32_bf16 a[76:79], a[36:39], a[220:223], a[76:79]
    buffer_load_dwordx4 v40, s[12:15], s61 offen offset:2048 lds
    ds_read_b64_tr_b16 a[12:13], v45 offset:16384
    v_mfma_f32_16x16x32_bf16 v[208:211], a[40:43], a[208:211], v[208:211]
    v_mfma_f32_16x16x32_bf16 v[212:215], a[40:43], a[212:215], v[212:215]
    ds_read_b64_tr_b16 a[14:15], v45 offset:17408
    v_mfma_f32_16x16x32_bf16 a[80:83], a[40:43], a[216:219], a[80:83]
    buffer_load_dwordx4 v41, s[12:15], s61 offen offset:3072 lds
    ds_read_b64_tr_b16 a[16:17], v46 offset:16384
    v_mfma_f32_16x16x32_bf16 a[84:87], a[40:43], a[220:223], a[84:87]
    ds_read_b64_tr_b16 a[18:19], v46 offset:17408
    v_mfma_f32_16x16x32_bf16 v[216:219], a[44:47], a[208:211], v[216:219]
    s_add_u32 s61, s61, 0x80000
    v_mfma_f32_16x16x32_bf16 v[220:223], a[44:47], a[212:215], v[220:223]
    buffer_load_dwordx4 a[128:131], v36, s[8:11], s62 offen sc1
    ds_read_b64_tr_b16 a[20:21], v47 offset:16384
    v_mfma_f32_16x16x32_bf16 a[88:91], a[44:47], a[216:219], a[88:91]
    ds_read_b64_tr_b16 a[22:23], v47 offset:17408
    v_mfma_f32_16x16x32_bf16 a[92:95], a[44:47], a[220:223], a[92:95]
    buffer_load_dwordx4 a[132:135], v54, s[8:11], s62 offen sc1
    ds_read_b64_tr_b16 a[24:25], v48 offset:16384
    v_mfma_f32_16x16x32_bf16 v[224:227], a[48:51], a[208:211], v[224:227]
    v_mfma_f32_16x16x32_bf16 v[228:231], a[48:51], a[212:215], v[228:231]
    ds_read_b64_tr_b16 a[26:27], v48 offset:17408
    v_mfma_f32_16x16x32_bf16 a[96:99], a[48:51], a[216:219], a[96:99]
    buffer_load_dwordx4 a[136:139], v37, s[8:11], s62 offen sc1
    ds_read_b64_tr_b16 a[28:29], v49 offset:16384
    v_mfma_f32_16x16x32_bf16 a[100:103], a[48:51], a[220:223], a[100:103]
    v_mfma_f32_16x16x32_bf16 v[232:235], a[52:55], a[208:211], v[232:235]
    ds_read_b64_tr_b16 a[30:31], v49 offset:17408
    v_mfma_f32_16x16x32_bf16 v[236:239], a[52:55], a[212:215], v[236:239]
    buffer_load_dwordx4 a[140:143], v55, s[8:11], s62 offen sc1
    v_mfma_f32_16x16x32_bf16 a[104:107], a[52:55], a[216:219], a[104:107]
    v_mfma_f32_16x16x32_bf16 a[108:111], a[52:55], a[220:223], a[108:111]
    s_add_u32 s62, s62, 0x20000
    v_mfma_f32_16x16x32_bf16 v[240:243], a[56:59], a[208:211], v[240:243]
    s_add_u32 s52, s47, 536576
    v_mfma_f32_16x16x32_bf16 v[244:247], a[56:59], a[212:215], v[244:247]
    buffer_store_dwordx4 v[176:179], v1, s[48:51], s52 offen offset:0 sc1
    v_mfma_f32_16x16x32_bf16 a[112:115], a[56:59], a[216:219], a[112:115]
    v_mfma_f32_16x16x32_bf16 a[116:119], a[56:59], a[220:223], a[116:119]
    v_mfma_f32_16x16x32_bf16 v[248:251], a[60:63], a[208:211], v[248:251]
    v_mfma_f32_16x16x32_bf16 v[252:255], a[60:63], a[212:215], v[252:255]
    v_mfma_f32_16x16x32_bf16 a[120:123], a[60:63], a[216:219], a[120:123]
    v_mfma_f32_16x16x32_bf16 a[124:127], a[60:63], a[220:223], a[124:127]
    s_waitcnt vmcnt(15) lgkmcnt(0)
    v_mfma_f32_16x16x32_bf16 v[192:195], a[0:3], a[224:227], v[192:195]
    ds_read_b64_tr_b16 a[32:33], v42 offset:24576
    ds_read_b64_tr_b16 a[34:35], v42 offset:25600
    v_mfma_f32_16x16x32_bf16 v[196:199], a[0:3], a[228:231], v[196:199]
    buffer_load_dwordx4 a[144:147], v36, s[8:11], s62 offen sc1
    v_mfma_f32_16x16x32_bf16 a[64:67], a[0:3], a[232:235], a[64:67]
    ds_read_b64_tr_b16 a[36:37], v43 offset:24576
    v_mfma_f32_16x16x32_bf16 a[68:71], a[0:3], a[236:239], a[68:71]
    ds_read_b64_tr_b16 a[38:39], v43 offset:25600
    v_mfma_f32_16x16x32_bf16 v[200:203], a[4:7], a[224:227], v[200:203]
    ds_read_b64_tr_b16 a[40:41], v44 offset:24576
    v_mfma_f32_16x16x32_bf16 v[204:207], a[4:7], a[228:231], v[204:207]
    v_mfma_f32_16x16x32_bf16 a[72:75], a[4:7], a[232:235], a[72:75]
    buffer_load_dwordx4 a[148:151], v54, s[8:11], s62 offen sc1
    ds_read_b64_tr_b16 a[42:43], v44 offset:25600
    v_mfma_f32_16x16x32_bf16 a[76:79], a[4:7], a[236:239], a[76:79]
    ds_read_b64_tr_b16 a[44:45], v45 offset:24576
    v_mfma_f32_16x16x32_bf16 v[208:211], a[8:11], a[224:227], v[208:211]
    v_mfma_f32_16x16x32_bf16 v[212:215], a[8:11], a[228:231], v[212:215]
    ds_read_b64_tr_b16 a[46:47], v45 offset:25600
    v_mfma_f32_16x16x32_bf16 a[80:83], a[8:11], a[232:235], a[80:83]
    ds_read_b64_tr_b16 a[48:49], v46 offset:24576
    v_mfma_f32_16x16x32_bf16 a[84:87], a[8:11], a[236:239], a[84:87]
    buffer_load_dwordx4 a[152:155], v37, s[8:11], s62 offen sc1
    ds_read_b64_tr_b16 a[50:51], v46 offset:25600
    v_mfma_f32_16x16x32_bf16 v[216:219], a[12:15], a[224:227], v[216:219]
    v_mfma_f32_16x16x32_bf16 v[220:223], a[12:15], a[228:231], v[220:223]
    ds_read_b64_tr_b16 a[52:53], v47 offset:24576
    v_mfma_f32_16x16x32_bf16 a[88:91], a[12:15], a[232:235], a[88:91]
    ds_read_b64_tr_b16 a[54:55], v47 offset:25600
    v_mfma_f32_16x16x32_bf16 a[92:95], a[12:15], a[236:239], a[92:95]
    ds_read_b64_tr_b16 a[56:57], v48 offset:24576
    v_mfma_f32_16x16x32_bf16 v[224:227], a[16:19], a[224:227], v[224:227]
    v_mfma_f32_16x16x32_bf16 v[228:231], a[16:19], a[228:231], v[228:231]
    buffer_load_dwordx4 a[156:159], v55, s[8:11], s62 offen sc1
    ds_read_b64_tr_b16 a[58:59], v48 offset:25600
    v_mfma_f32_16x16x32_bf16 a[96:99], a[16:19], a[232:235], a[96:99]
    ds_read_b64_tr_b16 a[60:61], v49 offset:24576
    v_mfma_f32_16x16x32_bf16 a[100:103], a[16:19], a[236:239], a[100:103]
    v_mfma_f32_16x16x32_bf16 v[232:235], a[20:23], a[224:227], v[232:235]
    ds_read_b64_tr_b16 a[62:63], v49 offset:25600
    v_mfma_f32_16x16x32_bf16 v[236:239], a[20:23], a[228:231], v[236:239]
    s_add_u32 s62, s62, 0x20000
    v_mfma_f32_16x16x32_bf16 a[104:107], a[20:23], a[232:235], a[104:107]
    s_add_u32 s52, s47, 536576
    v_mfma_f32_16x16x32_bf16 a[108:111], a[20:23], a[236:239], a[108:111]
    buffer_store_dwordx4 v[180:183], v1, s[48:51], s52 offen offset:1024 sc1
    v_mfma_f32_16x16x32_bf16 v[240:243], a[24:27], a[224:227], v[240:243]
    v_mfma_f32_16x16x32_bf16 v[244:247], a[24:27], a[228:231], v[244:247]
    v_mfma_f32_16x16x32_bf16 a[112:115], a[24:27], a[232:235], a[112:115]
    v_mfma_f32_16x16x32_bf16 a[116:119], a[24:27], a[236:239], a[116:119]
    v_mfma_f32_16x16x32_bf16 v[248:251], a[28:31], a[224:227], v[248:251]
    v_mfma_f32_16x16x32_bf16 v[252:255], a[28:31], a[228:231], v[252:255]
    v_mfma_f32_16x16x32_bf16 a[120:123], a[28:31], a[232:235], a[120:123]
    v_mfma_f32_16x16x32_bf16 a[124:127], a[28:31], a[236:239], a[124:127]
    s_waitcnt vmcnt(10) lgkmcnt(0)
    s_barrier
    v_mfma_f32_16x16x32_bf16 v[192:195], a[32:35], a[240:243], v[192:195]
    ds_read_b64_tr_b16 a[0:1], v42 offset:32768
    ds_read_b64_tr_b16 a[2:3], v42 offset:33792
    v_mfma_f32_16x16x32_bf16 v[196:199], a[32:35], a[244:247], v[196:199]
    s_cmp_eq_u32 s30, 0
    s_cbranch_scc1 k12_ool_62
k12_oolret_63:
    v_mfma_f32_16x16x32_bf16 a[64:67], a[32:35], a[248:251], a[64:67]
    s_add_u32 m0, s60, 147456
    ds_read_b64_tr_b16 a[4:5], v43 offset:32768
    v_mfma_f32_16x16x32_bf16 a[68:71], a[32:35], a[252:255], a[68:71]
    buffer_load_dwordx4 v38, s[12:15], s61 offen offset:0 lds
    ds_read_b64_tr_b16 a[6:7], v43 offset:33792
    v_mfma_f32_16x16x32_bf16 v[200:203], a[36:39], a[240:243], v[200:203]
    buffer_load_dwordx4 v39, s[12:15], s61 offen offset:1024 lds
    ds_read_b64_tr_b16 a[8:9], v44 offset:32768
    v_mfma_f32_16x16x32_bf16 v[204:207], a[36:39], a[244:247], v[204:207]
    v_mfma_f32_16x16x32_bf16 a[72:75], a[36:39], a[248:251], a[72:75]
    ds_read_b64_tr_b16 a[10:11], v44 offset:33792
    v_mfma_f32_16x16x32_bf16 a[76:79], a[36:39], a[252:255], a[76:79]
    buffer_load_dwordx4 v40, s[12:15], s61 offen offset:2048 lds
    ds_read_b64_tr_b16 a[12:13], v45 offset:32768
    v_mfma_f32_16x16x32_bf16 v[208:211], a[40:43], a[240:243], v[208:211]
    v_mfma_f32_16x16x32_bf16 v[212:215], a[40:43], a[244:247], v[212:215]
    ds_read_b64_tr_b16 a[14:15], v45 offset:33792
    v_mfma_f32_16x16x32_bf16 a[80:83], a[40:43], a[248:251], a[80:83]
    buffer_load_dwordx4 v41, s[12:15], s61 offen offset:3072 lds
    ds_read_b64_tr_b16 a[16:17], v46 offset:32768
    v_mfma_f32_16x16x32_bf16 a[84:87], a[40:43], a[252:255], a[84:87]
    ds_read_b64_tr_b16 a[18:19], v46 offset:33792
    v_mfma_f32_16x16x32_bf16 v[216:219], a[44:47], a[240:243], v[216:219]
    s_add_u32 s61, s61, 0x80000
    v_mfma_f32_16x16x32_bf16 v[220:223], a[44:47], a[244:247], v[220:223]
    buffer_load_dwordx4 a[160:163], v36, s[8:11], s62 offen sc1
    ds_read_b64_tr_b16 a[20:21], v47 offset:32768
    v_mfma_f32_16x16x32_bf16 a[88:91], a[44:47], a[248:251], a[88:91]
    ds_read_b64_tr_b16 a[22:23], v47 offset:33792
    v_mfma_f32_16x16x32_bf16 a[92:95], a[44:47], a[252:255], a[92:95]
    buffer_load_dwordx4 a[164:167], v54, s[8:11], s62 offen sc1
    ds_read_b64_tr_b16 a[24:25], v48 offset:32768
    v_mfma_f32_16x16x32_bf16 v[224:227], a[48:51], a[240:243], v[224:227]
    v_mfma_f32_16x16x32_bf16 v[228:231], a[48:51], a[244:247], v[228:231]
    ds_read_b64_tr_b16 a[26:27], v48 offset:33792
    v_mfma_f32_16x16x32_bf16 a[96:99], a[48:51], a[248:251], a[96:99]
    buffer_load_dwordx4 a[168:171], v37, s[8:11], s62 offen sc1
    ds_read_b64_tr_b16 a[28:29], v49 offset:32768
    v_mfma_f32_16x16x32_bf16 a[100:103], a[48:51], a[252:255], a[100:103]
    v_mfma_f32_16x16x32_bf16 v[232:235], a[52:55], a[240:243], v[232:235]
    ds_read_b64_tr_b16 a[30:31], v49 offset:33792
    v_mfma_f32_16x16x32_bf16 v[236:239], a[52:55], a[244:247], v[236:239]
    buffer_load_dwordx4 a[172:175], v55, s[8:11], s62 offen sc1
    v_mfma_f32_16x16x32_bf16 a[104:107], a[52:55], a[248:251], a[104:107]
    v_mfma_f32_16x16x32_bf16 a[108:111], a[52:55], a[252:255], a[108:111]
    s_add_u32 s62, s62, 0x20000
    v_mfma_f32_16x16x32_bf16 v[240:243], a[56:59], a[240:243], v[240:243]
    s_add_u32 s52, s47, 536576
    v_mfma_f32_16x16x32_bf16 v[244:247], a[56:59], a[244:247], v[244:247]
    buffer_store_dwordx4 v[184:187], v1, s[48:51], s52 offen offset:2048 sc1
    v_mfma_f32_16x16x32_bf16 a[112:115], a[56:59], a[248:251], a[112:115]
    v_mfma_f32_16x16x32_bf16 a[116:119], a[56:59], a[252:255], a[116:119]
    v_mfma_f32_16x16x32_bf16 v[248:251], a[60:63], a[240:243], v[248:251]
    v_mfma_f32_16x16x32_bf16 v[252:255], a[60:63], a[244:247], v[252:255]
    v_mfma_f32_16x16x32_bf16 a[120:123], a[60:63], a[248:251], a[120:123]
    v_mfma_f32_16x16x32_bf16 a[124:127], a[60:63], a[252:255], a[124:127]
    s_waitcnt vmcnt(15) lgkmcnt(0)
    v_mfma_f32_16x16x32_bf16 v[192:195], a[0:3], a[128:131], v[192:195]
    ds_read_b64_tr_b16 a[32:33], v42 offset:40960
    ds_read_b64_tr_b16 a[34:35], v42 offset:41984
    v_mfma_f32_16x16x32_bf16 v[196:199], a[0:3], a[132:135], v[196:199]
    buffer_load_dwordx4 a[176:179], v36, s[8:11], s62 offen sc1
    v_mfma_f32_16x16x32_bf16 a[64:67], a[0:3], a[136:139], a[64:67]
    ds_read_b64_tr_b16 a[36:37], v43 offset:40960
    v_mfma_f32_16x16x32_bf16 a[68:71], a[0:3], a[140:143], a[68:71]
    ds_read_b64_tr_b16 a[38:39], v43 offset:41984
    v_mfma_f32_16x16x32_bf16 v[200:203], a[4:7], a[128:131], v[200:203]
    ds_read_b64_tr_b16 a[40:41], v44 offset:40960
    v_mfma_f32_16x16x32_bf16 v[204:207], a[4:7], a[132:135], v[204:207]
    v_mfma_f32_16x16x32_bf16 a[72:75], a[4:7], a[136:139], a[72:75]
    buffer_load_dwordx4 a[180:183], v54, s[8:11], s62 offen sc1
    ds_read_b64_tr_b16 a[42:43], v44 offset:41984
    v_mfma_f32_16x16x32_bf16 a[76:79], a[4:7], a[140:143], a[76:79]
    ds_read_b64_tr_b16 a[44:45], v45 offset:40960
    v_mfma_f32_16x16x32_bf16 v[208:211], a[8:11], a[128:131], v[208:211]
    v_mfma_f32_16x16x32_bf16 v[212:215], a[8:11], a[132:135], v[212:215]
    ds_read_b64_tr_b16 a[46:47], v45 offset:41984
    v_mfma_f32_16x16x32_bf16 a[80:83], a[8:11], a[136:139], a[80:83]
    ds_read_b64_tr_b16 a[48:49], v46 offset:40960
    v_mfma_f32_16x16x32_bf16 a[84:87], a[8:11], a[140:143], a[84:87]
    buffer_load_dwordx4 a[184:187], v37, s[8:11], s62 offen sc1
    ds_read_b64_tr_b16 a[50:51], v46 offset:41984
    v_mfma_f32_16x16x32_bf16 v[216:219], a[12:15], a[128:131], v[216:219]
    v_mfma_f32_16x16x32_bf16 v[220:223], a[12:15], a[132:135], v[220:223]
    ds_read_b64_tr_b16 a[52:53], v47 offset:40960
    v_mfma_f32_16x16x32_bf16 a[88:91], a[12:15], a[136:139], a[88:91]
    ds_read_b64_tr_b16 a[54:55], v47 offset:41984
    v_mfma_f32_16x16x32_bf16 a[92:95], a[12:15], a[140:143], a[92:95]
    ds_read_b64_tr_b16 a[56:57], v48 offset:40960
    v_mfma_f32_16x16x32_bf16 v[224:227], a[16:19], a[128:131], v[224:227]
    v_mfma_f32_16x16x32_bf16 v[228:231], a[16:19], a[132:135], v[228:231]
    buffer_load_dwordx4 a[188:191], v55, s[8:11], s62 offen sc1
    ds_read_b64_tr_b16 a[58:59], v48 offset:41984
    v_mfma_f32_16x16x32_bf16 a[96:99], a[16:19], a[136:139], a[96:99]
    ds_read_b64_tr_b16 a[60:61], v49 offset:40960
    v_mfma_f32_16x16x32_bf16 a[100:103], a[16:19], a[140:143], a[100:103]
    v_mfma_f32_16x16x32_bf16 v[232:235], a[20:23], a[128:131], v[232:235]
    ds_read_b64_tr_b16 a[62:63], v49 offset:41984
    v_mfma_f32_16x16x32_bf16 v[236:239], a[20:23], a[132:135], v[236:239]
    s_add_u32 s62, s62, 0x20000
    v_mfma_f32_16x16x32_bf16 a[104:107], a[20:23], a[136:139], a[104:107]
    s_add_u32 s52, s47, 536576
    v_mfma_f32_16x16x32_bf16 a[108:111], a[20:23], a[140:143], a[108:111]
    buffer_store_dwordx4 v[188:191], v1, s[48:51], s52 offen offset:3072 sc1
    v_mfma_f32_16x16x32_bf16 v[240:243], a[24:27], a[128:131], v[240:243]
    v_mfma_f32_16x16x32_bf16 v[244:247], a[24:27], a[132:135], v[244:247]
    v_mfma_f32_16x16x32_bf16 a[112:115], a[24:27], a[136:139], a[112:115]
    v_mfma_f32_16x16x32_bf16 a[116:119], a[24:27], a[140:143], a[116:119]
    v_mfma_f32_16x16x32_bf16 v[248:251], a[28:31], a[128:131], v[248:251]
    s_cmp_eq_u32 s30, 0
    s_cbranch_scc1 k12_ool_66
k12_oolret_67:
    v_mfma_f32_16x16x32_bf16 v[252:255], a[28:31], a[132:135], v[252:255]
    v_mfma_f32_16x16x32_bf16 a[120:123], a[28:31], a[136:139], a[120:123]
    v_mfma_f32_16x16x32_bf16 a[124:127], a[28:31], a[140:143], a[124:127]
    s_waitcnt vmcnt(10) lgkmcnt(0)
    s_barrier
    v_mfma_f32_16x16x32_bf16 v[192:195], a[32:35], a[144:147], v[192:195]
    ds_read_b64_tr_b16 a[0:1], v42 offset:49152
    ds_read_b64_tr_b16 a[2:3], v42 offset:50176
    v_mfma_f32_16x16x32_bf16 v[196:199], a[32:35], a[148:151], v[196:199]
    s_mov_b32 m0, s34
    v_mfma_f32_16x16x32_bf16 a[64:67], a[32:35], a[152:155], a[64:67]
    buffer_load_dwordx4 v1, s[16:19], s32 offen offset:0 sc1 lds
    ds_read_b64_tr_b16 a[4:5], v43 offset:49152
    v_mfma_f32_16x16x32_bf16 a[68:71], a[32:35], a[156:159], a[68:71]
    ds_read_b64_tr_b16 a[6:7], v43 offset:50176
    v_mfma_f32_16x16x32_bf16 v[200:203], a[36:39], a[144:147], v[200:203]
    buffer_load_dwordx4 v1, s[16:19], s32 offen offset:1024 sc1 lds
    ds_read_b64_tr_b16 a[8:9], v44 offset:49152
    v_mfma_f32_16x16x32_bf16 v[204:207], a[36:39], a[148:151], v[204:207]
    v_mfma_f32_16x16x32_bf16 a[72:75], a[36:39], a[152:155], a[72:75]
    ds_read_b64_tr_b16 a[10:11], v44 offset:50176
    v_mfma_f32_16x16x32_bf16 a[76:79], a[36:39], a[156:159], a[76:79]
    buffer_load_dwordx4 v1, s[16:19], s32 offen offset:2048 sc1 lds
    ds_read_b64_tr_b16 a[12:13], v45 offset:49152
    v_mfma_f32_16x16x32_bf16 v[208:211], a[40:43], a[144:147], v[208:211]
    v_mfma_f32_16x16x32_bf16 v[212:215], a[40:43], a[148:151], v[212:215]
    ds_read_b64_tr_b16 a[14:15], v45 offset:50176
    v_mfma_f32_16x16x32_bf16 a[80:83], a[40:43], a[152:155], a[80:83]
    ds_read_b64_tr_b16 a[16:17], v46 offset:49152
    v_mfma_f32_16x16x32_bf16 a[84:87], a[40:43], a[156:159], a[84:87]
    buffer_load_dwordx4 v1, s[16:19], s32 offen offset:3072 sc1 lds
    ds_read_b64_tr_b16 a[18:19], v46 offset:50176
    v_mfma_f32_16x16x32_bf16 v[216:219], a[44:47], a[144:147], v[216:219]
    v_mfma_f32_16x16x32_bf16 v[220:223], a[44:47], a[148:151], v[220:223]
    s_add_u32 s32, s32, 0x80000
    ds_read_b64_tr_b16 a[20:21], v47 offset:49152
    v_mfma_f32_16x16x32_bf16 a[88:91], a[44:47], a[152:155], a[88:91]
    s_add_u32 s34, s34, 0x4000
    ds_read_b64_tr_b16 a[22:23], v47 offset:50176
    s_mov_b32 m0, s34
    v_mfma_f32_16x16x32_bf16 a[92:95], a[44:47], a[156:159], a[92:95]
    buffer_load_dwordx4 v1, s[16:19], s32 offen offset:0 sc1 lds
    ds_read_b64_tr_b16 a[24:25], v48 offset:49152
    v_mfma_f32_16x16x32_bf16 v[224:227], a[48:51], a[144:147], v[224:227]
    v_mfma_f32_16x16x32_bf16 v[228:231], a[48:51], a[148:151], v[228:231]
    buffer_load_dwordx4 v1, s[16:19], s32 offen offset:1024 sc1 lds
    ds_read_b64_tr_b16 a[26:27], v48 offset:50176
    v_mfma_f32_16x16x32_bf16 a[96:99], a[48:51], a[152:155], a[96:99]
    ds_read_b64_tr_b16 a[28:29], v49 offset:49152
    v_mfma_f32_16x16x32_bf16 a[100:103], a[48:51], a[156:159], a[100:103]
    v_mfma_f32_16x16x32_bf16 v[232:235], a[52:55], a[144:147], v[232:235]
    buffer_load_dwordx4 v1, s[16:19], s32 offen offset:2048 sc1 lds
    ds_read_b64_tr_b16 a[30:31], v49 offset:50176
    v_mfma_f32_16x16x32_bf16 v[236:239], a[52:55], a[148:151], v[236:239]
    v_mfma_f32_16x16x32_bf16 a[104:107], a[52:55], a[152:155], a[104:107]
    v_mfma_f32_16x16x32_bf16 a[108:111], a[52:55], a[156:159], a[108:111]
    v_mfma_f32_16x16x32_bf16 v[240:243], a[56:59], a[144:147], v[240:243]
    buffer_load_dwordx4 v1, s[16:19], s32 offen offset:3072 sc1 lds
    v_mfma_f32_16x16x32_bf16 v[244:247], a[56:59], a[148:151], v[244:247]
    v_mfma_f32_16x16x32_bf16 a[112:115], a[56:59], a[152:155], a[112:115]
    s_add_u32 s32, s32, 0x80000
    v_mfma_f32_16x16x32_bf16 a[116:119], a[56:59], a[156:159], a[116:119]
    s_add_u32 s34, s34, 0x4000
    v_mfma_f32_16x16x32_bf16 v[248:251], a[60:63], a[144:147], v[248:251]
    v_mfma_f32_16x16x32_bf16 v[252:255], a[60:63], a[148:151], v[252:255]
    v_mfma_f32_16x16x32_bf16 a[120:123], a[60:63], a[152:155], a[120:123]
    v_mfma_f32_16x16x32_bf16 a[124:127], a[60:63], a[156:159], a[124:127]
    s_waitcnt vmcnt(14) lgkmcnt(0)
    v_mfma_f32_16x16x32_bf16 v[192:195], a[0:3], a[160:163], v[192:195]
    ds_read_b64_tr_b16 a[32:33], v42 offset:57344
    ds_read_b64_tr_b16 a[34:35], v42 offset:58368
    v_mfma_f32_16x16x32_bf16 v[196:199], a[0:3], a[164:167], v[196:199]
    s_mov_b32 m0, s35
    v_mfma_f32_16x16x32_bf16 a[64:67], a[0:3], a[168:171], a[64:67]
    buffer_load_dwordx4 v1, s[20:23], s33 offen offset:0 sc1 lds
    ds_read_b64_tr_b16 a[36:37], v43 offset:57344
    v_mfma_f32_16x16x32_bf16 a[68:71], a[0:3], a[172:175], a[68:71]
    ds_read_b64_tr_b16 a[38:39], v43 offset:58368
    v_mfma_f32_16x16x32_bf16 v[200:203], a[4:7], a[160:163], v[200:203]
    buffer_load_dwordx4 v1, s[20:23], s33 offen offset:1024 sc1 lds
    ds_read_b64_tr_b16 a[40:41], v44 offset:57344
    v_mfma_f32_16x16x32_bf16 v[204:207], a[4:7], a[164:167], v[204:207]
    v_mfma_f32_16x16x32_bf16 a[72:75], a[4:7], a[168:171], a[72:75]
    ds_read_b64_tr_b16 a[42:43], v44 offset:58368
    v_mfma_f32_16x16x32_bf16 a[76:79], a[4:7], a[172:175], a[76:79]
    buffer_load_dwordx4 v1, s[20:23], s33 offen offset:2048 sc1 lds
    ds_read_b64_tr_b16 a[44:45], v45 offset:57344
    v_mfma_f32_16x16x32_bf16 v[208:211], a[8:11], a[160:163], v[208:211]
    v_mfma_f32_16x16x32_bf16 v[212:215], a[8:11], a[164:167], v[212:215]
    ds_read_b64_tr_b16 a[46:47], v45 offset:58368
    v_mfma_f32_16x16x32_bf16 a[80:83], a[8:11], a[168:171], a[80:83]
    ds_read_b64_tr_b16 a[48:49], v46 offset:57344
    v_mfma_f32_16x16x32_bf16 a[84:87], a[8:11], a[172:175], a[84:87]
    buffer_load_dwordx4 v1, s[20:23], s33 offen offset:3072 sc1 lds
    ds_read_b64_tr_b16 a[50:51], v46 offset:58368
    v_mfma_f32_16x16x32_bf16 v[216:219], a[12:15], a[160:163], v[216:219]
    v_mfma_f32_16x16x32_bf16 v[220:223], a[12:15], a[164:167], v[220:223]
    s_add_u32 s33, s33, 0x80000
    ds_read_b64_tr_b16 a[52:53], v47 offset:57344
    v_mfma_f32_16x16x32_bf16 a[88:91], a[12:15], a[168:171], a[88:91]
    s_add_u32 s35, s35, 0x4000
    ds_read_b64_tr_b16 a[54:55], v47 offset:58368
    s_mov_b32 m0, s34
    v_mfma_f32_16x16x32_bf16 a[92:95], a[12:15], a[172:175], a[92:95]
    buffer_load_dwordx4 v1, s[16:19], s32 offen offset:0 sc1 lds
    ds_read_b64_tr_b16 a[56:57], v48 offset:57344
    v_mfma_f32_16x16x32_bf16 v[224:227], a[16:19], a[160:163], v[224:227]
    v_mfma_f32_16x16x32_bf16 v[228:231], a[16:19], a[164:167], v[228:231]
    buffer_load_dwordx4 v1, s[16:19], s32 offen offset:1024 sc1 lds
    ds_read_b64_tr_b16 a[58:59], v48 offset:58368
    v_mfma_f32_16x16x32_bf16 a[96:99], a[16:19], a[168:171], a[96:99]
    ds_read_b64_tr_b16 a[60:61], v49 offset:57344
    v_mfma_f32_16x16x32_bf16 a[100:103], a[16:19], a[172:175], a[100:103]
    v_mfma_f32_16x16x32_bf16 v[232:235], a[20:23], a[160:163], v[232:235]
    buffer_load_dwordx4 v1, s[16:19], s32 offen offset:2048 sc1 lds
    ds_read_b64_tr_b16 a[62:63], v49 offset:58368
    v_mfma_f32_16x16x32_bf16 v[236:239], a[20:23], a[164:167], v[236:239]
    v_mfma_f32_16x16x32_bf16 a[104:107], a[20:23], a[168:171], a[104:107]
    v_mfma_f32_16x16x32_bf16 a[108:111], a[20:23], a[172:175], a[108:111]
    v_mfma_f32_16x16x32_bf16 v[240:243], a[24:27], a[160:163], v[240:243]
    buffer_load_dwordx4 v1, s[16:19], s32 offen offset:3072 sc1 lds
    v_mfma_f32_16x16x32_bf16 v[244:247], a[24:27], a[164:167], v[244:247]
    v_mfma_f32_16x16x32_bf16 a[112:115], a[24:27], a[168:171], a[112:115]
    s_add_u32 s32, s32, 0x80000
    v_mfma_f32_16x16x32_bf16 a[116:119], a[24:27], a[172:175], a[116:119]
    s_add_u32 s34, s34, 0x4000
    v_mfma_f32_16x16x32_bf16 v[248:251], a[28:31], a[160:163], v[248:251]
    v_mfma_f32_16x16x32_bf16 v[252:255], a[28:31], a[164:167], v[252:255]
    v_mfma_f32_16x16x32_bf16 a[120:123], a[28:31], a[168:171], a[120:123]
    v_mfma_f32_16x16x32_bf16 a[124:127], a[28:31], a[172:175], a[124:127]
    s_waitcnt vmcnt(17) lgkmcnt(0)
    s_barrier
    v_mfma_f32_16x16x32_bf16 v[192:195], a[32:35], a[176:179], v[192:195]
    v_mfma_f32_16x16x32_bf16 v[196:199], a[32:35], a[180:183], v[196:199]
    s_mov_b32 m0, s35
    v_mfma_f32_16x16x32_bf16 a[64:67], a[32:35], a[184:187], a[64:67]
    buffer_load_dwordx4 v1, s[20:23], s33 offen offset:0 sc1 lds
    v_mfma_f32_16x16x32_bf16 a[68:71], a[32:35], a[188:191], a[68:71]
    v_mfma_f32_16x16x32_bf16 v[200:203], a[36:39], a[176:179], v[200:203]
    v_mfma_f32_16x16x32_bf16 v[204:207], a[36:39], a[180:183], v[204:207]
    v_mfma_f32_16x16x32_bf16 a[72:75], a[36:39], a[184:187], a[72:75]
    v_mfma_f32_16x16x32_bf16 a[76:79], a[36:39], a[188:191], a[76:79]
    buffer_load_dwordx4 v1, s[20:23], s33 offen offset:1024 sc1 lds
    v_mfma_f32_16x16x32_bf16 v[208:211], a[40:43], a[176:179], v[208:211]
    v_mfma_f32_16x16x32_bf16 v[212:215], a[40:43], a[180:183], v[212:215]
    v_mfma_f32_16x16x32_bf16 a[80:83], a[40:43], a[184:187], a[80:83]
    v_mfma_f32_16x16x32_bf16 a[84:87], a[40:43], a[188:191], a[84:87]
    v_mfma_f32_16x16x32_bf16 v[216:219], a[44:47], a[176:179], v[216:219]
    v_mfma_f32_16x16x32_bf16 v[220:223], a[44:47], a[180:183], v[220:223]
    v_mfma_f32_16x16x32_bf16 a[88:91], a[44:47], a[184:187], a[88:91]
    buffer_load_dwordx4 v1, s[20:23], s33 offen offset:2048 sc1 lds
    v_mfma_f32_16x16x32_bf16 a[92:95], a[44:47], a[188:191], a[92:95]
    v_mfma_f32_16x16x32_bf16 v[224:227], a[48:51], a[176:179], v[224:227]
    v_mfma_f32_16x16x32_bf16 v[228:231], a[48:51], a[180:183], v[228:231]
    v_mfma_f32_16x16x32_bf16 a[96:99], a[48:51], a[184:187], a[96:99]
    v_mfma_f32_16x16x32_bf16 a[100:103], a[48:51], a[188:191], a[100:103]
    v_mfma_f32_16x16x32_bf16 v[232:235], a[52:55], a[176:179], v[232:235]
    buffer_load_dwordx4 v1, s[20:23], s33 offen offset:3072 sc1 lds
    v_mfma_f32_16x16x32_bf16 v[236:239], a[52:55], a[180:183], v[236:239]
    v_mfma_f32_16x16x32_bf16 a[104:107], a[52:55], a[184:187], a[104:107]
    v_mfma_f32_16x16x32_bf16 a[108:111], a[52:55], a[188:191], a[108:111]
    v_mfma_f32_16x16x32_bf16 v[240:243], a[56:59], a[176:179], v[240:243]
    v_mfma_f32_16x16x32_bf16 v[244:247], a[56:59], a[180:183], v[244:247]
    v_mfma_f32_16x16x32_bf16 a[112:115], a[56:59], a[184:187], a[112:115]
    s_add_u32 s33, s33, 0x80000
    v_mfma_f32_16x16x32_bf16 a[116:119], a[56:59], a[188:191], a[116:119]
    s_add_u32 s35, s35, 0x4000
    v_mfma_f32_16x16x32_bf16 v[248:251], a[60:63], a[176:179], v[248:251]
    v_mfma_f32_16x16x32_bf16 v[252:255], a[60:63], a[180:183], v[252:255]
    v_mfma_f32_16x16x32_bf16 a[120:123], a[60:63], a[184:187], a[120:123]
    v_mfma_f32_16x16x32_bf16 a[124:127], a[60:63], a[188:191], a[124:127]
    s_add_u32 s3, s54, 64
    s_add_u32 s5, s55, 64
    s_mov_b32 s63, s57
    s_load_dwordx2 s[44:45], s[0:1], 40
    s_load_dwordx2 s[46:47], s[0:1], 64
    s_load_dwordx4 s[48:51], s[0:1], 72
    s_mov_b32 s40, 0x3e0293ee
    s_mov_b32 s41, 0x3e0293ee
    s_mov_b32 m0, s34
    s_nop 0
    buffer_load_dwordx4 v1, s[16:19], s32 offen offset:0 sc1 lds
    buffer_load_dwordx4 v1, s[16:19], s32 offen offset:1024 sc1 lds
    buffer_load_dwordx4 v1, s[16:19], s32 offen offset:2048 sc1 lds
    buffer_load_dwordx4 v1, s[16:19], s32 offen offset:3072 sc1 lds
    s_mov_b32 m0, s35
    s_nop 0
    buffer_load_dwordx4 v1, s[20:23], s33 offen offset:0 sc1 lds
    buffer_load_dwordx4 v1, s[20:23], s33 offen offset:1024 sc1 lds
    buffer_load_dwordx4 v1, s[20:23], s33 offen offset:2048 sc1 lds
    buffer_load_dwordx4 v1, s[20:23], s33 offen offset:3072 sc1 lds
    s_add_u32 s32, s32, 0x80000
    s_add_u32 s33, s33, 0x80000
    s_add_u32 s34, s34, 0x4000
    s_and_b32 s34, s34, 0xffff
    s_add_u32 s35, s35, 0x4000
    s_and_b32 s35, s35, 0xffff
    s_or_b32 s35, s35, 0x10000
    v_mov_b32 v2, v1
    v_or_b32 v3, 0x10000, v1
    v_mov_b32 v56, v3
    s_mov_b32 s52, 0x4000
    s_mov_b32 s53, 0
    s_lshl_b32 s62, s28, 6
    s_mul_i32 s31, s29, s29
    s_add_u32 s62, s62, s31
    s_lshr_b32 s31, s30, 1
    s_lshl_b32 s4, s31, 23
    s_add_u32 s4, s4, 0x6000000
    s_add_u32 s8, s6, s4
    s_addc_u32 s9, s7, 0
    s_and_b32 s9, s9, 0xffff
    s_mov_b32 s10, 0
    s_mov_b32 s58, 0
    s_mov_b32 s14, 0x700000
    s_mov_b32 s59, 0x700000
    s_lshl_b32 s54, s62, 12
    s_waitcnt vmcnt(16) lgkmcnt(0)
    s_barrier
    s_cmp_eq_u32 s63, 0
    s_cbranch_scc1 k12_ool_68
k12_oolret_69:
    v_mov_b32 v59, 0
    ds_read_b128 a[128:131], v2 offset:0
    ds_read_b128 a[132:135], v2 offset:1024
    ds_read_b128 a[136:139], v2 offset:2048
    ds_read_b128 a[140:143], v2 offset:3072
    ds_read_b128 a[144:147], v2 offset:4096
    ds_read_b128 a[148:151], v2 offset:5120
    ds_read_b128 a[152:155], v2 offset:6144
    ds_read_b128 a[156:159], v2 offset:7168
    ds_read_b128 a[160:163], v2 offset:8192
    ds_read_b128 a[164:167], v2 offset:9216
    ds_read_b128 a[168:171], v2 offset:10240
    ds_read_b128 a[172:175], v2 offset:11264
    ds_read_b128 a[176:179], v2 offset:12288
    ds_read_b128 a[180:183], v2 offset:13312
    ds_read_b128 a[184:187], v2 offset:14336
    ds_read_b128 a[188:191], v2 offset:15360
    s_cmp_lt_u32 s30, 2
    s_cselect_b64 s[12:13], s[46:47], s[48:49]
    s_cselect_b64 s[60:61], s[44:45], s[50:51]
    s_cselect_b32 s55, 0x800000, s14
    s_and_b32 s13, s13, 0xffff
    v_accvgpr_read_b32 v128, a64
    v_accvgpr_read_b32 v129, a65
    v_accvgpr_read_b32 v130, a66
    v_accvgpr_read_b32 v131, a67
    v_pk_mul_f32 v[128:129], v[128:129], s[40:41]
    v_pk_mul_f32 v[130:131], v[130:131], s[40:41]
    v_cvt_pk_bf16_f32 v96, v128, v129
    v_cvt_pk_bf16_f32 v97, v130, v131
    v_accvgpr_read_b32 v132, a72
    v_accvgpr_read_b32 v133, a73
    v_accvgpr_read_b32 v134, a74
    v_accvgpr_read_b32 v135, a75
    v_pk_mul_f32 v[132:133], v[132:133], s[40:41]
    v_pk_mul_f32 v[134:135], v[134:135], s[40:41]
    v_cvt_pk_bf16_f32 v98, v132, v133
    v_cvt_pk_bf16_f32 v99, v134, v135
    v_accvgpr_read_b32 v136, a80
    v_accvgpr_read_b32 v137, a81
    v_accvgpr_read_b32 v138, a82
    v_accvgpr_read_b32 v139, a83
    v_pk_mul_f32 v[136:137], v[136:137], s[40:41]
    v_pk_mul_f32 v[138:139], v[138:139], s[40:41]
    v_cvt_pk_bf16_f32 v100, v136, v137
    v_cvt_pk_bf16_f32 v101, v138, v139
    v_accvgpr_read_b32 v140, a88
    v_accvgpr_read_b32 v141, a89
    v_accvgpr_read_b32 v142, a90
    v_accvgpr_read_b32 v143, a91
    v_pk_mul_f32 v[140:141], v[140:141], s[40:41]
    v_pk_mul_f32 v[142:143], v[142:143], s[40:41]
    v_cvt_pk_bf16_f32 v102, v140, v141
    v_cvt_pk_bf16_f32 v103, v142, v143
    v_accvgpr_read_b32 v128, a96
    v_accvgpr_read_b32 v129, a97
    v_accvgpr_read_b32 v130, a98
    v_accvgpr_read_b32 v131, a99
    v_pk_mul_f32 v[128:129], v[128:129], s[40:41]
    v_pk_mul_f32 v[130:131], v[130:131], s[40:41]
    v_cvt_pk_bf16_f32 v104, v128, v129
    v_cvt_pk_bf16_f32 v105, v130, v131
    v_accvgpr_read_b32 v132, a104
    v_accvgpr_read_b32 v133, a105
    v_accvgpr_read_b32 v134, a106
    v_accvgpr_read_b32 v135, a107
    v_pk_mul_f32 v[132:133], v[132:133], s[40:41]
    v_pk_mul_f32 v[134:135], v[134:135], s[40:41]
    v_cvt_pk_bf16_f32 v106, v132, v133
    v_cvt_pk_bf16_f32 v107, v134, v135
    v_accvgpr_read_b32 v136, a112
    v_accvgpr_read_b32 v137, a113
    v_accvgpr_read_b32 v138, a114
    v_accvgpr_read_b32 v139, a115
    v_pk_mul_f32 v[136:137], v[136:137], s[40:41]
    v_pk_mul_f32 v[138:139], v[138:139], s[40:41]
    v_cvt_pk_bf16_f32 v108, v136, v137
    v_cvt_pk_bf16_f32 v109, v138, v139
    v_accvgpr_read_b32 v140, a120
    v_accvgpr_read_b32 v141, a121
    v_accvgpr_read_b32 v142, a122
    v_accvgpr_read_b32 v143, a123
    v_pk_mul_f32 v[140:141], v[140:141], s[40:41]
    v_pk_mul_f32 v[142:143], v[142:143], s[40:41]
    v_cvt_pk_bf16_f32 v110, v140, v141
    v_cvt_pk_bf16_f32 v111, v142, v143
    v_accvgpr_read_b32 v128, a68
    v_accvgpr_read_b32 v129, a69
    v_accvgpr_read_b32 v130, a70
    v_accvgpr_read_b32 v131, a71
    v_pk_mul_f32 v[128:129], v[128:129], s[40:41]
    v_pk_mul_f32 v[130:131], v[130:131], s[40:41]
    v_cvt_pk_bf16_f32 v112, v128, v129
    v_cvt_pk_bf16_f32 v113, v130, v131
    v_accvgpr_read_b32 v132, a76
    v_accvgpr_read_b32 v133, a77
    v_accvgpr_read_b32 v134, a78
    v_accvgpr_read_b32 v135, a79
    v_pk_mul_f32 v[132:133], v[132:133], s[40:41]
    v_pk_mul_f32 v[134:135], v[134:135], s[40:41]
    v_cvt_pk_bf16_f32 v114, v132, v133
    v_cvt_pk_bf16_f32 v115, v134, v135
    v_accvgpr_read_b32 v136, a84
    v_accvgpr_read_b32 v137, a85
    v_accvgpr_read_b32 v138, a86
    v_accvgpr_read_b32 v139, a87
    v_pk_mul_f32 v[136:137], v[136:137], s[40:41]
    v_pk_mul_f32 v[138:139], v[138:139], s[40:41]
    v_cvt_pk_bf16_f32 v116, v136, v137
    v_cvt_pk_bf16_f32 v117, v138, v139
    v_accvgpr_read_b32 v140, a92
    v_accvgpr_read_b32 v141, a93
    v_accvgpr_read_b32 v142, a94
    v_accvgpr_read_b32 v143, a95
    v_pk_mul_f32 v[140:141], v[140:141], s[40:41]
    v_pk_mul_f32 v[142:143], v[142:143], s[40:41]
    v_cvt_pk_bf16_f32 v118, v140, v141
    v_cvt_pk_bf16_f32 v119, v142, v143
    v_accvgpr_read_b32 v128, a100
    v_accvgpr_read_b32 v129, a101
    v_accvgpr_read_b32 v130, a102
    v_accvgpr_read_b32 v131, a103
    v_pk_mul_f32 v[128:129], v[128:129], s[40:41]
    v_pk_mul_f32 v[130:131], v[130:131], s[40:41]
    v_cvt_pk_bf16_f32 v120, v128, v129
    v_cvt_pk_bf16_f32 v121, v130, v131
    v_accvgpr_read_b32 v132, a108
    v_accvgpr_read_b32 v133, a109
    v_accvgpr_read_b32 v134, a110
    v_accvgpr_read_b32 v135, a111
    v_pk_mul_f32 v[132:133], v[132:133], s[40:41]
    v_pk_mul_f32 v[134:135], v[134:135], s[40:41]
    v_cvt_pk_bf16_f32 v122, v132, v133
    v_cvt_pk_bf16_f32 v123, v134, v135
    v_accvgpr_read_b32 v136, a116
    v_accvgpr_read_b32 v137, a117
    v_accvgpr_read_b32 v138, a118
    v_accvgpr_read_b32 v139, a119
    v_pk_mul_f32 v[136:137], v[136:137], s[40:41]
    v_pk_mul_f32 v[138:139], v[138:139], s[40:41]
    v_cvt_pk_bf16_f32 v124, v136, v137
    v_cvt_pk_bf16_f32 v125, v138, v139
    v_accvgpr_read_b32 v140, a124
    v_accvgpr_read_b32 v141, a125
    v_accvgpr_read_b32 v142, a126
    v_accvgpr_read_b32 v143, a127
    v_pk_mul_f32 v[140:141], v[140:141], s[40:41]
    v_pk_mul_f32 v[142:143], v[142:143], s[40:41]
    v_cvt_pk_bf16_f32 v126, v140, v141
    v_cvt_pk_bf16_f32 v127, v142, v143
    v_pk_mul_f32 v[192:193], v[192:193], s[40:41]
    v_pk_mul_f32 v[194:195], v[194:195], s[40:41]
    v_cvt_pk_bf16_f32 v64, v192, v193
    v_cvt_pk_bf16_f32 v65, v194, v195
    v_pk_mul_f32 v[200:201], v[200:201], s[40:41]
    v_pk_mul_f32 v[202:203], v[202:203], s[40:41]
    v_cvt_pk_bf16_f32 v66, v200, v201
    v_cvt_pk_bf16_f32 v67, v202, v203
    v_pk_mul_f32 v[208:209], v[208:209], s[40:41]
    v_pk_mul_f32 v[210:211], v[210:211], s[40:41]
    v_cvt_pk_bf16_f32 v68, v208, v209
    v_cvt_pk_bf16_f32 v69, v210, v211
    v_pk_mul_f32 v[216:217], v[216:217], s[40:41]
    v_pk_mul_f32 v[218:219], v[218:219], s[40:41]
    v_cvt_pk_bf16_f32 v70, v216, v217
    v_cvt_pk_bf16_f32 v71, v218, v219
    v_pk_mul_f32 v[224:225], v[224:225], s[40:41]
    v_pk_mul_f32 v[226:227], v[226:227], s[40:41]
    v_cvt_pk_bf16_f32 v72, v224, v225
    v_cvt_pk_bf16_f32 v73, v226, v227
    v_pk_mul_f32 v[232:233], v[232:233], s[40:41]
    v_pk_mul_f32 v[234:235], v[234:235], s[40:41]
    v_cvt_pk_bf16_f32 v74, v232, v233
    v_cvt_pk_bf16_f32 v75, v234, v235
    v_pk_mul_f32 v[240:241], v[240:241], s[40:41]
    v_pk_mul_f32 v[242:243], v[242:243], s[40:41]
    v_cvt_pk_bf16_f32 v76, v240, v241
    v_cvt_pk_bf16_f32 v77, v242, v243
    v_pk_mul_f32 v[248:249], v[248:249], s[40:41]
    v_pk_mul_f32 v[250:251], v[250:251], s[40:41]
    v_cvt_pk_bf16_f32 v78, v248, v249
    v_cvt_pk_bf16_f32 v79, v250, v251
    v_pk_mul_f32 v[196:197], v[196:197], s[40:41]
    v_pk_mul_f32 v[198:199], v[198:199], s[40:41]
    v_cvt_pk_bf16_f32 v80, v196, v197
    v_cvt_pk_bf16_f32 v81, v198, v199
    v_pk_mul_f32 v[204:205], v[204:205], s[40:41]
    v_pk_mul_f32 v[206:207], v[206:207], s[40:41]
    v_cvt_pk_bf16_f32 v82, v204, v205
    v_cvt_pk_bf16_f32 v83, v206, v207
    v_pk_mul_f32 v[212:213], v[212:213], s[40:41]
    v_pk_mul_f32 v[214:215], v[214:215], s[40:41]
    v_cvt_pk_bf16_f32 v84, v212, v213
    v_cvt_pk_bf16_f32 v85, v214, v215
    v_pk_mul_f32 v[220:221], v[220:221], s[40:41]
    v_pk_mul_f32 v[222:223], v[222:223], s[40:41]
    v_cvt_pk_bf16_f32 v86, v220, v221
    v_cvt_pk_bf16_f32 v87, v222, v223
    v_pk_mul_f32 v[228:229], v[228:229], s[40:41]
    v_pk_mul_f32 v[230:231], v[230:231], s[40:41]
    v_cvt_pk_bf16_f32 v88, v228, v229
    v_cvt_pk_bf16_f32 v89, v230, v231
    v_pk_mul_f32 v[236:237], v[236:237], s[40:41]
    v_pk_mul_f32 v[238:239], v[238:239], s[40:41]
    v_cvt_pk_bf16_f32 v90, v236, v237
    v_cvt_pk_bf16_f32 v91, v238, v239
    v_pk_mul_f32 v[244:245], v[244:245], s[40:41]
    v_pk_mul_f32 v[246:247], v[246:247], s[40:41]
    v_cvt_pk_bf16_f32 v92, v244, v245
    v_cvt_pk_bf16_f32 v93, v246, v247
    v_pk_mul_f32 v[252:253], v[252:253], s[40:41]
    v_pk_mul_f32 v[254:255], v[254:255], s[40:41]
    v_cvt_pk_bf16_f32 v94, v252, v253
    v_cvt_pk_bf16_f32 v95, v254, v255
    v_add_u32 v2, 0x4000, v1
    v_mov_b32 v8, 0
    v_mov_b32 v232, 0
    v_mov_b32 v9, 0
    v_mov_b32 v233, 0
    v_mov_b32 v10, 0
    v_mov_b32 v234, 0
    v_mov_b32 v11, 0
    v_mov_b32 v235, 0
    s_mov_b32 s36, 0
    s_mov_b32 s37, 0x40004000
    v_mfma_f32_32x32x16_bf16 v[16:31], v[232:235], v[232:235], 0
    v_mfma_f32_32x32x16_bf16 v[32:47], v[232:235], v[232:235], 0
    v_and_b32 v6, 0xf0, v1
    v_cmp_eq_u32 vcc, 0, v6
    v_mov_b32 v6, 0x3f803f80
    v_lshrrev_b32 v229, 7, v1
    s_and_b32 s4, s30, 1
    s_lshl_b32 s31, s4, 11
    v_lshl_add_u32 v230, v1, 1, s31
    v_lshl_add_u32 v229, s4, 4, v229
    v_mul_u32_u24 v228, 7168, v229
    v_and_b32 v7, 0x70, v1
    v_add_u32 v228, v228, v7
    v_lshlrev_b32 v229, 5, v229
    v_and_b32 v57, 0x10, v1
    v_add_u32 v229, v229, v57
    v_lshrrev_b32 v7, 5, v7
    v_lshl_add_u32 v229, v7, 15, v229
    v_cndmask_b32 v60, 0, v6, vcc
    v_cndmask_b32 v61, 0, v6, vcc
    v_cndmask_b32 v62, 0, v6, vcc
    v_cndmask_b32 v63, 0, v6, vcc
    v_mov_b32 v12, 0
    v_mov_b32 v13, 0
    v_mov_b32 v14, 0
    v_mov_b32 v15, 0
    v_mov_b32 v48, 0
    v_mov_b32 v49, 0
    v_mov_b32 v50, 0
    v_mov_b32 v51, 0
    v_mov_b32 v248, 0
    v_mov_b32 v249, 0
    v_mov_b32 v250, 0
    v_mov_b32 v251, 0
    v_mov_b32 v252, 0
    v_mov_b32 v253, 0
    v_mov_b32 v254, 0
    v_mov_b32 v255, 0
    s_waitcnt lgkmcnt(0)
    s_cmp_ge_u32 s36, s42
    s_cbranch_scc1 k2_prep_70
k2_prepret_71:
    v_mfma_f32_16x16x32_bf16 v[128:131], a[128:131], v[64:67], v[16:19]
    v_mfma_f32_16x16x32_bf16 v[128:131], a[132:135], v[68:71], v[128:131]
    v_mfma_f32_16x16x32_bf16 v[128:131], a[136:139], v[72:75], v[128:131]
    v_mfma_f32_16x16x32_bf16 v[128:131], a[140:143], v[76:79], v[128:131]
    s_add_u32 s36, s36, 32
    v_mfma_f32_16x16x32_bf16 v[132:135], a[128:131], v[80:83], v[20:23]
    v_mfma_f32_16x16x32_bf16 v[132:135], a[132:135], v[84:87], v[132:135]
    v_mfma_f32_16x16x32_bf16 v[132:135], a[136:139], v[88:91], v[132:135]
    v_mfma_f32_16x16x32_bf16 v[132:135], a[140:143], v[92:95], v[132:135]
    v_mfma_f32_16x16x32_bf16 v[136:139], a[128:131], v[96:99], v[24:27]
    v_mfma_f32_16x16x32_bf16 v[136:139], a[132:135], v[100:103], v[136:139]
    v_mfma_f32_16x16x32_bf16 v[136:139], a[136:139], v[104:107], v[136:139]
    v_mfma_f32_16x16x32_bf16 v[136:139], a[140:143], v[108:111], v[136:139]
    v_mfma_f32_16x16x32_bf16 v[140:143], a[128:131], v[112:115], v[28:31]
    v_mfma_f32_16x16x32_bf16 v[140:143], a[132:135], v[116:119], v[140:143]
    v_mfma_f32_16x16x32_bf16 v[140:143], a[136:139], v[120:123], v[140:143]
    v_mfma_f32_16x16x32_bf16 v[140:143], a[140:143], v[124:127], v[140:143]
    v_mfma_f32_16x16x32_bf16 v[144:147], a[144:147], v[64:67], v[32:35]
    v_mfma_f32_16x16x32_bf16 v[144:147], a[148:151], v[68:71], v[144:147]
    v_mfma_f32_16x16x32_bf16 v[144:147], a[152:155], v[72:75], v[144:147]
    v_mfma_f32_16x16x32_bf16 v[144:147], a[156:159], v[76:79], v[144:147]
    v_mfma_f32_16x16x32_bf16 v[148:151], a[144:147], v[80:83], v[36:39]
    v_mfma_f32_16x16x32_bf16 v[148:151], a[148:151], v[84:87], v[148:151]
    v_mfma_f32_16x16x32_bf16 v[148:151], a[152:155], v[88:91], v[148:151]
    v_mfma_f32_16x16x32_bf16 v[148:151], a[156:159], v[92:95], v[148:151]
    v_mfma_f32_16x16x32_bf16 v[152:155], a[144:147], v[96:99], v[40:43]
    v_mfma_f32_16x16x32_bf16 v[152:155], a[148:151], v[100:103], v[152:155]
    v_mfma_f32_16x16x32_bf16 v[152:155], a[152:155], v[104:107], v[152:155]
    v_mfma_f32_16x16x32_bf16 v[152:155], a[156:159], v[108:111], v[152:155]
    v_mfma_f32_16x16x32_bf16 v[156:159], a[144:147], v[112:115], v[44:47]
    v_mfma_f32_16x16x32_bf16 v[156:159], a[148:151], v[116:119], v[156:159]
    v_mfma_f32_16x16x32_bf16 v[156:159], a[152:155], v[120:123], v[156:159]
    v_mfma_f32_16x16x32_bf16 v[156:159], a[156:159], v[124:127], v[156:159]
    v_mfma_f32_32x32x16_bf16 a[0:15], v[232:235], v[232:235], 0
    v_mfma_f32_32x32x16_bf16 a[16:31], v[232:235], v[232:235], 0
    v_mfma_f32_32x32x16_bf16 a[32:47], v[232:235], v[232:235], 0
    v_mfma_f32_32x32x16_bf16 a[48:63], v[232:235], v[232:235], 0
    v_mfma_f32_32x32x16_bf16 a[64:79], v[232:235], v[232:235], 0
    v_mfma_f32_32x32x16_bf16 a[80:95], v[232:235], v[232:235], 0
    v_mfma_f32_32x32x16_bf16 a[96:111], v[232:235], v[232:235], 0
    v_mfma_f32_32x32x16_bf16 a[112:127], v[232:235], v[232:235], 0
    v_max_f32 v52, v128, v129
    v_max3_f32 v52, v52, v130, v131
    v_max3_f32 v52, v52, v144, v145
    v_max3_f32 v52, v52, v146, v147
    v_max_f32 v53, v132, v133
    v_max3_f32 v53, v53, v134, v135
    v_max3_f32 v53, v53, v148, v149
    v_max3_f32 v53, v53, v150, v151
    v_max_f32 v54, v136, v137
    v_max3_f32 v54, v54, v138, v139
    v_max3_f32 v54, v54, v152, v153
    v_max3_f32 v54, v54, v154, v155
    v_max_f32 v55, v140, v141
    v_max3_f32 v55, v55, v142, v143
    v_max3_f32 v55, v55, v156, v157
    v_max3_f32 v55, v55, v158, v159
    v_mov_b32 v224, v52
    v_mov_b32 v225, v53
    v_mov_b32 v226, v54
    v_mov_b32 v227, v55
    s_nop 1
    v_permlane16_swap_b32 v52, v224
    v_permlane16_swap_b32 v53, v225
    v_permlane16_swap_b32 v54, v226
    v_permlane16_swap_b32 v55, v227
    s_nop 1
    v_max_f32 v52, v52, v224
    v_max_f32 v53, v53, v225
    v_max_f32 v54, v54, v226
    v_max_f32 v55, v55, v227
    v_mov_b32 v224, v52
    v_mov_b32 v225, v53
    v_mov_b32 v226, v54
    v_mov_b32 v227, v55
    s_nop 1
    v_permlane32_swap_b32 v52, v224
    v_permlane32_swap_b32 v53, v225
    v_permlane32_swap_b32 v54, v226
    v_permlane32_swap_b32 v55, v227
    s_nop 1
    v_max_f32 v52, v52, v224
    v_max_f32 v53, v53, v225
    v_max_f32 v54, v54, v226
    v_max_f32 v55, v55, v227
    v_add_f32 v52, 0x41400000, v52
    v_add_f32 v53, 0x41400000, v53
    v_add_f32 v54, 0x41400000, v54
    v_add_f32 v55, 0x41400000, v55
    v_sub_f32 v16, 0, v52
    v_sub_f32 v17, 0, v52
    v_sub_f32 v18, 0, v52
    v_sub_f32 v19, 0, v52
    v_sub_f32 v20, 0, v53
    v_sub_f32 v21, 0, v53
    v_sub_f32 v22, 0, v53
    v_sub_f32 v23, 0, v53
    v_sub_f32 v24, 0, v54
    v_sub_f32 v25, 0, v54
    v_sub_f32 v26, 0, v54
    v_sub_f32 v27, 0, v54
    v_sub_f32 v28, 0, v55
    v_sub_f32 v29, 0, v55
    v_sub_f32 v30, 0, v55
    v_sub_f32 v31, 0, v55
    v_sub_f32 v32, 0, v52
    v_sub_f32 v33, 0, v52
    v_sub_f32 v34, 0, v52
    v_sub_f32 v35, 0, v52
    v_sub_f32 v36, 0, v53
    v_sub_f32 v37, 0, v53
    v_sub_f32 v38, 0, v53
    v_sub_f32 v39, 0, v53
    v_sub_f32 v40, 0, v54
    v_sub_f32 v41, 0, v54
    v_sub_f32 v42, 0, v54
    v_sub_f32 v43, 0, v54
    v_sub_f32 v44, 0, v55
    v_sub_f32 v45, 0, v55
    v_sub_f32 v46, 0, v55
    v_sub_f32 v47, 0, v55
    v_sub_f32 v8, 0, v52
    v_sub_f32 v9, 0, v53
    v_sub_f32 v10, 0, v54
    v_sub_f32 v11, 0, v55
    s_cmp_ge_u32 s36, s42
    s_cbranch_scc1 k2_prep_78
k2_prepret_79:
    v_mfma_f32_16x16x32_bf16 v[160:163], a[160:163], v[64:67], v[16:19]
    v_sub_f32 v128, v128, v52
    v_sub_f32 v129, v129, v52
    v_sub_f32 v130, v130, v52
    v_mfma_f32_16x16x32_bf16 v[160:163], a[164:167], v[68:71], v[160:163]
    v_exp_f32 v232, v128
    v_sub_f32 v131, v131, v52
    v_mfma_f32_16x16x32_bf16 v[160:163], a[168:171], v[72:75], v[160:163]
    v_exp_f32 v233, v129
    v_sub_f32 v144, v144, v52
    v_mfma_f32_16x16x32_bf16 v[160:163], a[172:175], v[76:79], v[160:163]
    s_add_u32 s36, s36, 32
    s_cmp_eq_u32 s30, 0
    s_cbranch_scc1 k12_ool_72
k12_oolret_73:
    v_sub_f32 v145, v145, v52
    v_mfma_f32_16x16x32_bf16 v[164:167], a[160:163], v[80:83], v[20:23]
    v_exp_f32 v234, v130
    v_cvt_pk_bf16_f32 v192, v232, v233
    v_mfma_f32_16x16x32_bf16 v[164:167], a[164:167], v[84:87], v[164:167]
    v_exp_f32 v235, v131
    v_sub_f32 v146, v146, v52
    v_mfma_f32_16x16x32_bf16 v[164:167], a[168:171], v[88:91], v[164:167]
    v_exp_f32 v236, v144
    v_sub_f32 v147, v147, v52
    v_mfma_f32_16x16x32_bf16 v[164:167], a[172:175], v[92:95], v[164:167]
    v_cvt_pk_bf16_f32 v193, v234, v235
    v_exp_f32 v237, v145
    v_mfma_f32_16x16x32_bf16 v[168:171], a[160:163], v[96:99], v[24:27]
    v_exp_f32 v238, v146
    v_sub_f32 v132, v132, v53
    v_mfma_f32_16x16x32_bf16 v[168:171], a[164:167], v[100:103], v[168:171]
    v_sub_f32 v133, v133, v53
    v_cvt_pk_bf16_f32 v194, v236, v237
    v_or3_b32 v57, v192, v193, v194
    v_mfma_f32_16x16x32_bf16 v[168:171], a[168:171], v[104:107], v[168:171]
    v_exp_f32 v239, v147
    v_sub_f32 v134, v134, v53
    v_mfma_f32_16x16x32_bf16 v[168:171], a[172:175], v[108:111], v[168:171]
    v_exp_f32 v240, v132
    v_sub_f32 v135, v135, v53
    v_mfma_f32_16x16x32_bf16 v[172:175], a[160:163], v[112:115], v[28:31]
    v_cvt_pk_bf16_f32 v195, v238, v239
    v_exp_f32 v241, v133
    v_mfma_f32_16x16x32_bf16 v[172:175], a[164:167], v[116:119], v[172:175]
    v_exp_f32 v242, v134
    v_sub_f32 v148, v148, v53
    v_mfma_f32_16x16x32_bf16 v[172:175], a[168:171], v[120:123], v[172:175]
    v_sub_f32 v149, v149, v53
    v_cvt_pk_bf16_f32 v196, v240, v241
    v_exp_f32 v243, v135
    v_mfma_f32_16x16x32_bf16 v[172:175], a[172:175], v[124:127], v[172:175]
    v_or3_b32 v57, v57, v195, v196
    v_exp_f32 v244, v148
    v_mfma_f32_16x16x32_bf16 v[176:179], a[176:179], v[64:67], v[32:35]
    v_sub_f32 v150, v150, v53
    v_sub_f32 v151, v151, v53
    v_cvt_pk_bf16_f32 v197, v242, v243
    v_mfma_f32_16x16x32_bf16 v[176:179], a[180:183], v[68:71], v[176:179]
    v_exp_f32 v245, v149
    v_exp_f32 v246, v150
    v_mfma_f32_16x16x32_bf16 v[176:179], a[184:187], v[72:75], v[176:179]
    v_sub_f32 v136, v136, v54
    v_sub_f32 v137, v137, v54
    v_cvt_pk_bf16_f32 v198, v244, v245
    v_mfma_f32_16x16x32_bf16 v[176:179], a[188:191], v[76:79], v[176:179]
    v_exp_f32 v247, v151
    v_or3_b32 v57, v57, v197, v198
    v_mfma_f32_16x16x32_bf16 v[180:183], a[176:179], v[80:83], v[36:39]
    v_exp_f32 v232, v136
    v_sub_f32 v138, v138, v54
    v_mfma_f32_16x16x32_bf16 v[180:183], a[180:183], v[84:87], v[180:183]
    ds_read_b128 a[192:195], v3 offset:0
    v_sub_f32 v139, v139, v54
    v_cvt_pk_bf16_f32 v199, v246, v247
    v_mfma_f32_16x16x32_bf16 v[180:183], a[184:187], v[88:91], v[180:183]
    v_exp_f32 v233, v137
    v_exp_f32 v234, v138
    v_mfma_f32_16x16x32_bf16 v[180:183], a[188:191], v[92:95], v[180:183]
    v_sub_f32 v152, v152, v54
    v_sub_f32 v153, v153, v54
    v_cvt_pk_bf16_f32 v200, v232, v233
    v_mfma_f32_16x16x32_bf16 v[184:187], a[176:179], v[96:99], v[40:43]
    v_exp_f32 v235, v139
    v_or3_b32 v57, v57, v199, v200
    v_mfma_f32_16x16x32_bf16 v[184:187], a[180:183], v[100:103], v[184:187]
    v_exp_f32 v236, v152
    v_sub_f32 v154, v154, v54
    v_mfma_f32_16x16x32_bf16 v[184:187], a[184:187], v[104:107], v[184:187]
    v_sub_f32 v155, v155, v54
    v_cvt_pk_bf16_f32 v201, v234, v235
    v_exp_f32 v237, v153
    v_mfma_f32_16x16x32_bf16 v[184:187], a[188:191], v[108:111], v[184:187]
    ds_read_b128 a[196:199], v3 offset:1024
    v_exp_f32 v238, v154
    v_mfma_f32_16x16x32_bf16 v[188:191], a[176:179], v[112:115], v[44:47]
    v_sub_f32 v140, v140, v55
    v_sub_f32 v141, v141, v55
    v_cvt_pk_bf16_f32 v202, v236, v237
    v_mfma_f32_16x16x32_bf16 v[188:191], a[180:183], v[116:119], v[188:191]
    v_exp_f32 v239, v155
    v_or3_b32 v57, v57, v201, v202
    v_mfma_f32_16x16x32_bf16 v[188:191], a[184:187], v[120:123], v[188:191]
    s_cmp_eq_u32 s30, 0
    s_cbranch_scc1 k12_ool_76
k12_oolret_77:
    v_exp_f32 v240, v140
    v_mfma_f32_16x16x32_bf16 v[188:191], a[188:191], v[124:127], v[188:191]
    s_waitcnt vmcnt(8)
    s_barrier
    v_sub_f32 v142, v142, v55
    v_sub_f32 v143, v143, v55
    v_cvt_pk_bf16_f32 v203, v238, v239
    v_exp_f32 v241, v141
    v_exp_f32 v242, v142
    v_sub_f32 v156, v156, v55
    v_sub_f32 v157, v157, v55
    ds_read_b128 a[200:203], v3 offset:2048
    v_cvt_pk_bf16_f32 v204, v240, v241
    v_exp_f32 v243, v143
    v_or3_b32 v57, v57, v203, v204
    v_exp_f32 v244, v156
    v_sub_f32 v158, v158, v55
    v_sub_f32 v159, v159, v55
    v_cvt_pk_bf16_f32 v205, v242, v243
    v_exp_f32 v245, v157
    v_exp_f32 v246, v158
    v_cvt_pk_bf16_f32 v206, v244, v245
    ds_read_b128 a[204:207], v3 offset:3072
    v_exp_f32 v247, v159
    v_or3_b32 v57, v57, v205, v206
    v_cvt_pk_bf16_f32 v207, v246, v247
    v_bitop3_b32 v57, v57, v207, s37 bitop3:0xa8
    v_cmp_ne_u32 vcc, 0, v57
    s_cbranch_vccnz k2_tramp_80
k2_ret_81:
    s_mov_b32 s24, s60
    s_and_b32 s25, s61, 0xffff
    s_mov_b32 s26, s55
    s_lshl_b32 s63, s29, 1
    s_sub_u32 s63, s63, 1
    s_cbranch_scc1 k2_dm3_83
k2_dloop_82:
    v_mfma_f32_16x16x32_bf16 v[12:15], v[60:63], v[192:195], v[12:15]
    v_exp_f32 v232, v160
    v_mfma_f32_16x16x32_bf16 v[48:51], v[60:63], v[196:199], v[48:51]
    s_mov_b32 m0, s34
    ds_read_b128 a[208:211], v3 offset:4096
    v_mfma_f32_16x16x32_bf16 v[248:251], v[60:63], v[200:203], v[248:251]
    s_add_u32 s53, s53, 8192
    buffer_load_dwordx4 v1, s[16:19], s32 offen offset:0 sc1 lds
    v_mfma_f32_16x16x32_bf16 v[252:255], v[60:63], v[204:207], v[252:255]
    s_waitcnt lgkmcnt(3)
    v_exp_f32 v233, v161
    v_mfma_f32_16x16x32_bf16 a[0:3], a[192:195], v[192:195], a[0:3]
    s_and_b32 s53, s53, 0xffff
    v_exp_f32 v234, v162
    v_mfma_f32_16x16x32_bf16 a[4:7], a[192:195], v[196:199], a[4:7]
    s_add_u32 s34, s34, 0x4000
    ds_read_b128 a[212:215], v3 offset:5120
    v_cvt_pk_bf16_f32 v208, v232, v233
    v_mfma_f32_16x16x32_bf16 a[8:11], a[192:195], v[200:203], a[8:11]
    v_exp_f32 v235, v163
    v_mfma_f32_16x16x32_bf16 a[12:15], a[192:195], v[204:207], a[12:15]
    buffer_load_dwordx4 v1, s[16:19], s32 offen offset:1024 sc1 lds
    v_mfma_f32_16x16x32_bf16 a[16:19], a[196:199], v[192:195], a[16:19]
    v_exp_f32 v236, v176
    v_mfma_f32_16x16x32_bf16 a[20:23], a[196:199], v[196:199], a[20:23]
    ds_read_b128 a[216:219], v3 offset:6144
    v_cvt_pk_bf16_f32 v209, v234, v235
    v_mfma_f32_16x16x32_bf16 a[24:27], a[196:199], v[200:203], a[24:27]
    v_exp_f32 v237, v177
    v_mfma_f32_16x16x32_bf16 a[28:31], a[196:199], v[204:207], a[28:31]
    s_waitcnt lgkmcnt(3)
    v_exp_f32 v238, v178
    v_mfma_f32_16x16x32_bf16 a[32:35], a[200:203], v[192:195], a[32:35]
    s_and_b32 s34, s34, 0xffff
    ds_read_b128 a[220:223], v3 offset:7168
    v_cvt_pk_bf16_f32 v210, v236, v237
    v_mfma_f32_16x16x32_bf16 a[36:39], a[200:203], v[196:199], a[36:39]
    s_and_b32 s60, s62, 31
    buffer_load_dwordx4 v1, s[16:19], s32 offen offset:2048 sc1 lds
    v_mfma_f32_16x16x32_bf16 a[40:43], a[200:203], v[200:203], a[40:43]
    v_exp_f32 v239, v179
    v_mfma_f32_16x16x32_bf16 a[44:47], a[200:203], v[204:207], a[44:47]
    s_lshr_b32 s61, s62, 5
    v_or3_b32 v57, v208, v209, v210
    v_add_u32 v3, s53, v56
    v_mfma_f32_16x16x32_bf16 a[48:51], a[204:207], v[192:195], a[48:51]
    v_exp_f32 v240, v164
    v_mfma_f32_16x16x32_bf16 a[52:55], a[204:207], v[196:199], a[52:55]
    ds_read_b128 a[128:131], v2 offset:0
    v_cvt_pk_bf16_f32 v211, v238, v239
    v_mfma_f32_16x16x32_bf16 a[56:59], a[204:207], v[200:203], a[56:59]
    s_mul_i32 s57, s60, 229376
    v_exp_f32 v241, v165
    v_mfma_f32_16x16x32_bf16 a[60:63], a[204:207], v[204:207], a[60:63]
    s_waitcnt lgkmcnt(3)
    buffer_load_dwordx4 v1, s[16:19], s32 offen offset:3072 sc1 lds
    v_mfma_f32_16x16x32_bf16 a[64:67], a[208:211], v[192:195], a[64:67]
    s_add_u32 s32, s32, 0x80000
    v_exp_f32 v242, v166
    v_mfma_f32_16x16x32_bf16 a[68:71], a[208:211], v[196:199], a[68:71]
    s_lshl_b32 s4, s61, 7
    ds_read_b128 a[132:135], v2 offset:1024
    v_cvt_pk_bf16_f32 v212, v240, v241
    v_mfma_f32_16x16x32_bf16 a[72:75], a[208:211], v[200:203], a[72:75]
    v_exp_f32 v243, v167
    v_mfma_f32_16x16x32_bf16 a[76:79], a[208:211], v[204:207], a[76:79]
    s_add_u32 s57, s57, s4
    v_or3_b32 v57, v57, v211, v212
    v_cvt_pk_bf16_f32 v213, v242, v243
    v_mfma_f32_16x16x32_bf16 a[80:83], a[212:215], v[192:195], a[80:83]
    s_waitcnt vmcnt(8)
    v_exp_f32 v244, v180
    v_mfma_f32_16x16x32_bf16 a[84:87], a[212:215], v[196:199], a[84:87]
    buffer_store_dwordx4 a[224:227], v229, s[8:11], s58 offen offset:0 sc1
    ds_read_b128 a[136:139], v2 offset:2048
    v_mfma_f32_16x16x32_bf16 a[88:91], a[212:215], v[200:203], a[88:91]
    s_add_u32 s56, s57, 57344
    v_exp_f32 v245, v181
    v_mfma_f32_16x16x32_bf16 a[92:95], a[212:215], v[204:207], a[92:95]
    s_waitcnt lgkmcnt(3)
    v_exp_f32 v246, v182
    v_mfma_f32_16x16x32_bf16 a[96:99], a[216:219], v[192:195], a[96:99]
    ds_read_b128 a[140:143], v2 offset:3072
    v_cvt_pk_bf16_f32 v214, v244, v245
    v_mfma_f32_16x16x32_bf16 a[100:103], a[216:219], v[196:199], a[100:103]
    s_add_u32 s62, s62, 1
    v_exp_f32 v247, v183
    v_mfma_f32_16x16x32_bf16 a[104:107], a[216:219], v[200:203], a[104:107]
    v_or3_b32 v57, v57, v213, v214
    v_mfma_f32_16x16x32_bf16 a[108:111], a[216:219], v[204:207], a[108:111]
    v_exp_f32 v232, v168
    v_mfma_f32_16x16x32_bf16 a[112:115], a[220:223], v[192:195], a[112:115]
    ds_read_b128 a[144:147], v2 offset:4096
    v_cvt_pk_bf16_f32 v215, v246, v247
    v_mfma_f32_16x16x32_bf16 a[116:119], a[220:223], v[196:199], a[116:119]
    buffer_store_dwordx4 a[228:231], v229, s[8:11], s58 offen offset:256 sc1
    v_mfma_f32_16x16x32_bf16 a[120:123], a[220:223], v[200:203], a[120:123]
    v_exp_f32 v233, v169
    v_mfma_f32_16x16x32_bf16 a[124:127], a[220:223], v[204:207], a[124:127]
    s_waitcnt lgkmcnt(3)
    v_exp_f32 v234, v170
    v_mfma_f32_16x16x32_bf16 v[128:131], a[128:131], v[64:67], v[16:19]
    ds_read_b128 a[148:151], v2 offset:5120
    v_cvt_pk_bf16_f32 v216, v232, v233
    v_mfma_f32_16x16x32_bf16 v[128:131], a[132:135], v[68:71], v[128:131]
    s_waitcnt lgkmcnt(2)
    v_exp_f32 v235, v171
    v_mfma_f32_16x16x32_bf16 v[128:131], a[136:139], v[72:75], v[128:131]
    v_or3_b32 v57, v57, v215, v216
    v_mfma_f32_16x16x32_bf16 v[128:131], a[140:143], v[76:79], v[128:131]
    s_add_u32 s36, s36, 32
    v_exp_f32 v236, v184
    v_mfma_f32_16x16x32_bf16 v[132:135], a[128:131], v[80:83], v[20:23]
    ds_read_b128 a[152:155], v2 offset:6144
    v_cvt_pk_bf16_f32 v217, v234, v235
    v_mfma_f32_16x16x32_bf16 v[132:135], a[132:135], v[84:87], v[132:135]
    s_lshl_b32 s58, s61, 17
    buffer_load_dwordx4 a[224:227], v228, s[12:15], s57 offen
    v_mfma_f32_16x16x32_bf16 v[132:135], a[136:139], v[88:91], v[132:135]
    s_add_u32 s52, s52, 8192
    v_exp_f32 v237, v185
    v_mfma_f32_16x16x32_bf16 v[132:135], a[140:143], v[92:95], v[132:135]
    v_exp_f32 v238, v186
    v_mfma_f32_16x16x32_bf16 v[136:139], a[128:131], v[96:99], v[24:27]
    s_lshl_b32 s60, s60, 10
    ds_read_b128 a[156:159], v2 offset:7168
    v_cvt_pk_bf16_f32 v218, v236, v237
    v_mfma_f32_16x16x32_bf16 v[136:139], a[132:135], v[100:103], v[136:139]
    s_and_b32 s52, s52, 0xffff
    v_exp_f32 v239, v187
    v_mfma_f32_16x16x32_bf16 v[136:139], a[136:139], v[104:107], v[136:139]
    v_or3_b32 v57, v57, v217, v218
    v_mfma_f32_16x16x32_bf16 v[136:139], a[140:143], v[108:111], v[136:139]
    v_add_u32 v2, s52, v1
    v_cvt_pk_bf16_f32 v219, v238, v239
    v_mfma_f32_16x16x32_bf16 v[140:143], a[128:131], v[112:115], v[28:31]
    s_add_u32 s58, s58, s60
    v_exp_f32 v240, v172
    v_mfma_f32_16x16x32_bf16 v[140:143], a[132:135], v[116:119], v[140:143]
    buffer_load_dwordx4 a[228:231], v228, s[12:15], s56 offen
    v_mfma_f32_16x16x32_bf16 v[140:143], a[136:139], v[120:123], v[140:143]
    v_exp_f32 v241, v173
    v_mfma_f32_16x16x32_bf16 v[140:143], a[140:143], v[124:127], v[140:143]
    s_waitcnt lgkmcnt(2)
    ds_read_b128 a[192:195], v3 offset:0
    v_cvt_pk_bf16_f32 v220, v240, v241
    v_mfma_f32_16x16x32_bf16 v[144:147], a[144:147], v[64:67], v[32:35]
    s_mov_b32 s10, s59
    v_exp_f32 v242, v174
    v_mfma_f32_16x16x32_bf16 v[144:147], a[148:151], v[68:71], v[144:147]
    s_waitcnt lgkmcnt(1)
    v_exp_f32 v243, v175
    v_mfma_f32_16x16x32_bf16 v[144:147], a[152:155], v[72:75], v[144:147]
    ds_read_b128 a[196:199], v3 offset:1024
    v_or3_b32 v57, v57, v219, v220
    v_mfma_f32_16x16x32_bf16 v[144:147], a[156:159], v[76:79], v[144:147]
    v_exp_f32 v244, v188
    v_mfma_f32_16x16x32_bf16 v[148:151], a[144:147], v[80:83], v[36:39]
    v_cvt_pk_bf16_f32 v221, v242, v243
    v_mfma_f32_16x16x32_bf16 v[148:151], a[148:151], v[84:87], v[148:151]
    buffer_load_dword v7, v230, s[24:27], s54 offen
    v_mfma_f32_16x16x32_bf16 v[148:151], a[152:155], v[88:91], v[148:151]
    v_exp_f32 v245, v189
    v_mfma_f32_16x16x32_bf16 v[148:151], a[156:159], v[92:95], v[148:151]
    ds_read_b128 a[200:203], v3 offset:2048
    v_cvt_pk_bf16_f32 v222, v244, v245
    v_mfma_f32_16x16x32_bf16 v[152:155], a[144:147], v[96:99], v[40:43]
    v_exp_f32 v246, v190
    v_mfma_f32_16x16x32_bf16 v[152:155], a[148:151], v[100:103], v[152:155]
    v_exp_f32 v247, v191
    v_mfma_f32_16x16x32_bf16 v[152:155], a[152:155], v[104:107], v[152:155]
    ds_read_b128 a[204:207], v3 offset:3072
    v_or3_b32 v57, v57, v221, v222
    v_mfma_f32_16x16x32_bf16 v[152:155], a[156:159], v[108:111], v[152:155]
    v_cvt_pk_bf16_f32 v223, v246, v247
    v_mfma_f32_16x16x32_bf16 v[156:159], a[144:147], v[112:115], v[44:47]
    s_add_u32 s54, s54, 4096
    v_mfma_f32_16x16x32_bf16 v[156:159], a[148:151], v[116:119], v[156:159]
    v_bitop3_b32 v57, v57, v223, s37 bitop3:0xa8
    v_cmp_ne_u32 vcc, 0, v57
    v_mfma_f32_16x16x32_bf16 v[156:159], a[152:155], v[120:123], v[156:159]
    v_mfma_f32_16x16x32_bf16 v[156:159], a[156:159], v[124:127], v[156:159]
    s_cbranch_vccnz k2_tramp_84
k2_ret_85:
    v_mfma_f32_16x16x32_bf16 v[12:15], v[60:63], v[208:211], v[12:15]
    v_exp_f32 v232, v128
    v_mfma_f32_16x16x32_bf16 v[48:51], v[60:63], v[212:215], v[48:51]
    s_mov_b32 m0, s35
    ds_read_b128 a[208:211], v3 offset:4096
    v_mfma_f32_16x16x32_bf16 v[248:251], v[60:63], v[216:219], v[248:251]
    s_add_u32 s53, s53, 8192
    buffer_load_dwordx4 v1, s[20:23], s33 offen offset:0 sc1 lds
    v_mfma_f32_16x16x32_bf16 v[252:255], v[60:63], v[220:223], v[252:255]
    s_waitcnt lgkmcnt(3)
    v_exp_f32 v233, v129
    v_mfma_f32_16x16x32_bf16 a[0:3], a[192:195], v[208:211], a[0:3]
    s_and_b32 s53, s53, 0xffff
    v_exp_f32 v234, v130
    v_mfma_f32_16x16x32_bf16 a[4:7], a[192:195], v[212:215], a[4:7]
    ds_read_b128 a[212:215], v3 offset:5120
    v_cvt_pk_bf16_f32 v192, v232, v233
    v_mfma_f32_16x16x32_bf16 a[8:11], a[192:195], v[216:219], a[8:11]
    v_exp_f32 v235, v131
    v_mfma_f32_16x16x32_bf16 a[12:15], a[192:195], v[220:223], a[12:15]
    v_exp_f32 v236, v144
    v_mfma_f32_16x16x32_bf16 a[16:19], a[196:199], v[208:211], a[16:19]
    ds_read_b128 a[216:219], v3 offset:6144
    v_cvt_pk_bf16_f32 v193, v234, v235
    v_mfma_f32_16x16x32_bf16 a[20:23], a[196:199], v[212:215], a[20:23]
    v_exp_f32 v237, v145
    v_mfma_f32_16x16x32_bf16 a[24:27], a[196:199], v[216:219], a[24:27]
    v_mfma_f32_16x16x32_bf16 a[28:31], a[196:199], v[220:223], a[28:31]
    s_waitcnt lgkmcnt(3)
    v_exp_f32 v238, v146
    v_mfma_f32_16x16x32_bf16 a[32:35], a[200:203], v[208:211], a[32:35]
    ds_read_b128 a[220:223], v3 offset:7168
    v_cvt_pk_bf16_f32 v194, v236, v237
    v_mfma_f32_16x16x32_bf16 a[36:39], a[200:203], v[212:215], a[36:39]
    v_exp_f32 v239, v147
    v_mfma_f32_16x16x32_bf16 a[40:43], a[200:203], v[216:219], a[40:43]
    v_or3_b32 v57, v192, v193, v194
    v_mfma_f32_16x16x32_bf16 a[44:47], a[200:203], v[220:223], a[44:47]
    s_add_u32 s35, s35, 0x4000
    v_add_u32 v3, s53, v56
    v_cvt_pk_bf16_f32 v195, v238, v239
    v_mfma_f32_16x16x32_bf16 a[48:51], a[204:207], v[208:211], a[48:51]
    v_exp_f32 v240, v132
    v_mfma_f32_16x16x32_bf16 a[52:55], a[204:207], v[212:215], a[52:55]
    buffer_load_dwordx4 v1, s[20:23], s33 offen offset:1024 sc1 lds
    ds_read_b128 a[128:131], v2 offset:0
    v_mfma_f32_16x16x32_bf16 a[56:59], a[204:207], v[216:219], a[56:59]
    v_exp_f32 v241, v133
    v_mfma_f32_16x16x32_bf16 a[60:63], a[204:207], v[220:223], a[60:63]
    s_waitcnt lgkmcnt(3)
    v_exp_f32 v242, v134
    v_mfma_f32_16x16x32_bf16 a[64:67], a[208:211], v[208:211], a[64:67]
    ds_read_b128 a[132:135], v2 offset:1024
    v_cvt_pk_bf16_f32 v196, v240, v241
    v_mfma_f32_16x16x32_bf16 a[68:71], a[208:211], v[212:215], a[68:71]
    v_exp_f32 v243, v135
    v_mfma_f32_16x16x32_bf16 a[72:75], a[208:211], v[216:219], a[72:75]
    v_or3_b32 v57, v57, v195, v196
    v_mfma_f32_16x16x32_bf16 a[76:79], a[208:211], v[220:223], a[76:79]
    v_exp_f32 v244, v148
    v_mfma_f32_16x16x32_bf16 a[80:83], a[212:215], v[208:211], a[80:83]
    ds_read_b128 a[136:139], v2 offset:2048
    v_cvt_pk_bf16_f32 v197, v242, v243
    v_mfma_f32_16x16x32_bf16 a[84:87], a[212:215], v[212:215], a[84:87]
    v_exp_f32 v245, v149
    v_mfma_f32_16x16x32_bf16 a[88:91], a[212:215], v[216:219], a[88:91]
    v_mfma_f32_16x16x32_bf16 a[92:95], a[212:215], v[220:223], a[92:95]
    s_waitcnt lgkmcnt(3)
    v_exp_f32 v246, v150
    v_mfma_f32_16x16x32_bf16 a[96:99], a[216:219], v[208:211], a[96:99]
    ds_read_b128 a[140:143], v2 offset:3072
    v_cvt_pk_bf16_f32 v198, v244, v245
    v_mfma_f32_16x16x32_bf16 a[100:103], a[216:219], v[212:215], a[100:103]
    v_exp_f32 v247, v151
    v_mfma_f32_16x16x32_bf16 a[104:107], a[216:219], v[216:219], a[104:107]
    v_or3_b32 v57, v57, v197, v198
    v_mfma_f32_16x16x32_bf16 a[108:111], a[216:219], v[220:223], a[108:111]
    s_and_b32 s35, s35, 0xffff
    v_exp_f32 v232, v136
    v_mfma_f32_16x16x32_bf16 a[112:115], a[220:223], v[208:211], a[112:115]
    ds_read_b128 a[144:147], v2 offset:4096
    v_cvt_pk_bf16_f32 v199, v246, v247
    v_mfma_f32_16x16x32_bf16 a[116:119], a[220:223], v[212:215], a[116:119]
    buffer_load_dwordx4 v1, s[20:23], s33 offen offset:2048 sc1 lds
    v_mfma_f32_16x16x32_bf16 a[120:123], a[220:223], v[216:219], a[120:123]
    v_exp_f32 v233, v137
    v_mfma_f32_16x16x32_bf16 a[124:127], a[220:223], v[220:223], a[124:127]
    s_waitcnt lgkmcnt(3)
    v_exp_f32 v234, v138
    v_mfma_f32_16x16x32_bf16 v[160:163], a[128:131], v[64:67], v[16:19]
    ds_read_b128 a[148:151], v2 offset:5120
    v_cvt_pk_bf16_f32 v200, v232, v233
    v_mfma_f32_16x16x32_bf16 v[160:163], a[132:135], v[68:71], v[160:163]
    s_waitcnt lgkmcnt(2)
    v_exp_f32 v235, v139
    v_mfma_f32_16x16x32_bf16 v[160:163], a[136:139], v[72:75], v[160:163]
    v_or3_b32 v57, v57, v199, v200
    v_mfma_f32_16x16x32_bf16 v[160:163], a[140:143], v[76:79], v[160:163]
    s_or_b32 s35, s35, 0x10000
    v_exp_f32 v236, v152
    v_mfma_f32_16x16x32_bf16 v[164:167], a[128:131], v[80:83], v[20:23]
    s_add_u32 s36, s36, 32
    ds_read_b128 a[152:155], v2 offset:6144
    v_cvt_pk_bf16_f32 v201, v234, v235
    v_mfma_f32_16x16x32_bf16 v[164:167], a[132:135], v[84:87], v[164:167]
    v_exp_f32 v237, v153
    v_mfma_f32_16x16x32_bf16 v[164:167], a[136:139], v[88:91], v[164:167]
    s_add_u32 s52, s52, 8192
    v_mfma_f32_16x16x32_bf16 v[164:167], a[140:143], v[92:95], v[164:167]
    v_exp_f32 v238, v154
    v_mfma_f32_16x16x32_bf16 v[168:171], a[128:131], v[96:99], v[24:27]
    s_and_b32 s52, s52, 0xffff
    ds_read_b128 a[156:159], v2 offset:7168
    v_cvt_pk_bf16_f32 v202, v236, v237
    v_mfma_f32_16x16x32_bf16 v[168:171], a[132:135], v[100:103], v[168:171]
    v_exp_f32 v239, v155
    v_mfma_f32_16x16x32_bf16 v[168:171], a[136:139], v[104:107], v[168:171]
    v_or3_b32 v57, v57, v201, v202
    v_mfma_f32_16x16x32_bf16 v[168:171], a[140:143], v[108:111], v[168:171]
    v_add_u32 v2, s52, v1
    v_cvt_pk_bf16_f32 v203, v238, v239
    v_mfma_f32_16x16x32_bf16 v[172:175], a[128:131], v[112:115], v[28:31]
    v_exp_f32 v240, v140
    v_mfma_f32_16x16x32_bf16 v[172:175], a[132:135], v[116:119], v[172:175]
    buffer_load_dwordx4 v1, s[20:23], s33 offen offset:3072 sc1 lds
    v_mfma_f32_16x16x32_bf16 v[172:175], a[136:139], v[120:123], v[172:175]
    s_add_u32 s33, s33, 0x80000
    v_exp_f32 v241, v141
    v_mfma_f32_16x16x32_bf16 v[172:175], a[140:143], v[124:127], v[172:175]
    s_waitcnt lgkmcnt(2)
    ds_read_b128 a[192:195], v3 offset:0
    v_cvt_pk_bf16_f32 v204, v240, v241
    v_mfma_f32_16x16x32_bf16 v[176:179], a[144:147], v[64:67], v[32:35]
    v_exp_f32 v242, v142
    v_mfma_f32_16x16x32_bf16 v[176:179], a[148:151], v[68:71], v[176:179]
    s_waitcnt lgkmcnt(1)
    v_exp_f32 v243, v143
    v_mfma_f32_16x16x32_bf16 v[176:179], a[152:155], v[72:75], v[176:179]
    ds_read_b128 a[196:199], v3 offset:1024
    v_or3_b32 v57, v57, v203, v204
    v_mfma_f32_16x16x32_bf16 v[176:179], a[156:159], v[76:79], v[176:179]
    v_exp_f32 v244, v156
    v_mfma_f32_16x16x32_bf16 v[180:183], a[144:147], v[80:83], v[36:39]
    v_cvt_pk_bf16_f32 v205, v242, v243
    v_mfma_f32_16x16x32_bf16 v[180:183], a[148:151], v[84:87], v[180:183]
    v_exp_f32 v245, v157
    v_mfma_f32_16x16x32_bf16 v[180:183], a[152:155], v[88:91], v[180:183]
    ds_read_b128 a[200:203], v3 offset:2048
    v_mfma_f32_16x16x32_bf16 v[180:183], a[156:159], v[92:95], v[180:183]
    s_sub_u32 s63, s63, 1
    v_exp_f32 v246, v158
    v_mfma_f32_16x16x32_bf16 v[184:187], a[144:147], v[96:99], v[40:43]
    v_cvt_pk_bf16_f32 v206, v244, v245
    v_mfma_f32_16x16x32_bf16 v[184:187], a[148:151], v[100:103], v[184:187]
    v_exp_f32 v247, v159
    v_mfma_f32_16x16x32_bf16 v[184:187], a[152:155], v[104:107], v[184:187]
    ds_read_b128 a[204:207], v3 offset:3072
    v_or3_b32 v57, v57, v205, v206
    v_mfma_f32_16x16x32_bf16 v[184:187], a[156:159], v[108:111], v[184:187]
    v_cvt_pk_bf16_f32 v207, v246, v247
    v_mfma_f32_16x16x32_bf16 v[188:191], a[144:147], v[112:115], v[44:47]
    v_mfma_f32_16x16x32_bf16 v[188:191], a[148:151], v[116:119], v[188:191]
    v_bitop3_b32 v57, v57, v207, s37 bitop3:0xa8
    v_cmp_ne_u32 vcc, 0, v57
    v_mfma_f32_16x16x32_bf16 v[188:191], a[152:155], v[120:123], v[188:191]
    v_mfma_f32_16x16x32_bf16 v[188:191], a[156:159], v[124:127], v[188:191]
    s_waitcnt vmcnt(13)
    s_barrier
    s_cbranch_vccnz k2_tramp_86
k2_ret_87:
    s_cmp_lg_u32 s63, 0
    s_cbranch_scc1 k2_dloop_82
    v_mfma_f32_16x16x32_bf16 v[12:15], v[60:63], v[192:195], v[12:15]
    v_exp_f32 v232, v160
    v_mfma_f32_16x16x32_bf16 v[48:51], v[60:63], v[196:199], v[48:51]
    s_mov_b32 m0, s34
    ds_read_b128 a[208:211], v3 offset:4096
    v_mfma_f32_16x16x32_bf16 v[248:251], v[60:63], v[200:203], v[248:251]
    s_add_u32 s53, s53, 8192
    buffer_load_dwordx4 v1, s[16:19], s32 offen offset:0 sc1 lds
    v_mfma_f32_16x16x32_bf16 v[252:255], v[60:63], v[204:207], v[252:255]
    s_waitcnt lgkmcnt(3)
    v_exp_f32 v233, v161
    v_mfma_f32_16x16x32_bf16 a[0:3], a[192:195], v[192:195], a[0:3]
    s_sub_u32 s40, s36, s38
    v_exp_f32 v234, v162
    v_mfma_f32_16x16x32_bf16 a[4:7], a[192:195], v[196:199], a[4:7]
    s_and_b32 s53, s53, 0xffff
    ds_read_b128 a[212:215], v3 offset:5120
    v_cvt_pk_bf16_f32 v208, v232, v233
    v_mfma_f32_16x16x32_bf16 a[8:11], a[192:195], v[200:203], a[8:11]
    s_add_u32 s34, s34, 0x4000
    v_subrev_u32 v6, s40, v4
    v_cmp_gt_i32 s[44:45], 0, v6
    v_mfma_f32_16x16x32_bf16 a[12:15], a[192:195], v[204:207], a[12:15]
    v_exp_f32 v235, v163
    v_mfma_f32_16x16x32_bf16 a[16:19], a[196:199], v[192:195], a[16:19]
    buffer_load_dwordx4 v1, s[16:19], s32 offen offset:1024 sc1 lds
    ds_read_b128 a[216:219], v3 offset:6144
    v_mfma_f32_16x16x32_bf16 a[20:23], a[196:199], v[196:199], a[20:23]
    v_exp_f32 v236, v176
    v_mfma_f32_16x16x32_bf16 a[24:27], a[196:199], v[200:203], a[24:27]
    v_cmp_gt_i32 s[46:47], 1, v6
    v_cvt_pk_bf16_f32 v209, v234, v235
    v_mfma_f32_16x16x32_bf16 a[28:31], a[196:199], v[204:207], a[28:31]
    s_waitcnt lgkmcnt(3)
    v_cmp_gt_i32 s[48:49], 2, v6
    v_cmp_gt_i32 s[50:51], 3, v6
    v_mfma_f32_16x16x32_bf16 a[32:35], a[200:203], v[192:195], a[32:35]
    s_and_b32 s34, s34, 0xffff
    v_exp_f32 v237, v177
    v_mfma_f32_16x16x32_bf16 a[36:39], a[200:203], v[196:199], a[36:39]
    s_and_b32 s60, s62, 31
    v_exp_f32 v238, v178
    v_mfma_f32_16x16x32_bf16 a[40:43], a[200:203], v[200:203], a[40:43]
    ds_read_b128 a[220:223], v3 offset:7168
    v_cvt_pk_bf16_f32 v210, v236, v237
    v_mfma_f32_16x16x32_bf16 a[44:47], a[200:203], v[204:207], a[44:47]
    s_lshr_b32 s61, s62, 5
    buffer_load_dwordx4 v1, s[16:19], s32 offen offset:2048 sc1 lds
    v_mfma_f32_16x16x32_bf16 a[48:51], a[204:207], v[192:195], a[48:51]
    v_cndmask_b32 v16, v8, v5, s[44:45]
    v_or3_b32 v57, v208, v209, v210
    v_mfma_f32_16x16x32_bf16 a[52:55], a[204:207], v[196:199], a[52:55]
    v_exp_f32 v239, v179
    v_mfma_f32_16x16x32_bf16 a[56:59], a[204:207], v[200:203], a[56:59]
    s_mul_i32 s57, s60, 229376
    v_cndmask_b32 v17, v8, v5, s[46:47]
    v_add_u32 v3, s53, v56
    v_mfma_f32_16x16x32_bf16 a[60:63], a[204:207], v[204:207], a[60:63]
    s_waitcnt lgkmcnt(2)
    v_exp_f32 v240, v164
    v_mfma_f32_16x16x32_bf16 a[64:67], a[208:211], v[192:195], a[64:67]
    v_cvt_pk_bf16_f32 v211, v238, v239
    v_cndmask_b32 v18, v8, v5, s[48:49]
    v_mfma_f32_16x16x32_bf16 a[68:71], a[208:211], v[196:199], a[68:71]
    s_lshl_b32 s4, s61, 7
    ds_read_b128 a[128:131], v2 offset:0
    v_cndmask_b32 v19, v8, v5, s[50:51]
    v_mfma_f32_16x16x32_bf16 a[72:75], a[208:211], v[200:203], a[72:75]
    v_exp_f32 v241, v165
    v_mfma_f32_16x16x32_bf16 a[76:79], a[208:211], v[204:207], a[76:79]
    s_add_u32 s57, s57, s4
    buffer_load_dwordx4 v1, s[16:19], s32 offen offset:3072 sc1 lds
    s_add_u32 s32, s32, 0x80000
    v_mfma_f32_16x16x32_bf16 a[80:83], a[212:215], v[192:195], a[80:83]
    s_waitcnt vmcnt(8)
    v_cmp_gt_i32 s[44:45], 16, v6
    v_exp_f32 v242, v166
    v_mfma_f32_16x16x32_bf16 a[84:87], a[212:215], v[196:199], a[84:87]
    ds_read_b128 a[132:135], v2 offset:1024
    v_cvt_pk_bf16_f32 v212, v240, v241
    v_mfma_f32_16x16x32_bf16 a[88:91], a[212:215], v[200:203], a[88:91]
    s_add_u32 s56, s57, 57344
    v_cmp_gt_i32 s[46:47], 17, v6
    v_exp_f32 v243, v167
    v_mfma_f32_16x16x32_bf16 a[92:95], a[212:215], v[204:207], a[92:95]
    s_waitcnt lgkmcnt(2)
    v_or3_b32 v57, v57, v211, v212
    v_cmp_gt_i32 s[48:49], 18, v6
    v_mfma_f32_16x16x32_bf16 a[96:99], a[216:219], v[192:195], a[96:99]
    v_exp_f32 v244, v180
    v_mfma_f32_16x16x32_bf16 a[100:103], a[216:219], v[196:199], a[100:103]
    s_add_u32 s62, s62, 1
    v_cvt_pk_bf16_f32 v213, v242, v243
    v_cmp_gt_i32 s[50:51], 19, v6
    v_mfma_f32_16x16x32_bf16 a[104:107], a[216:219], v[200:203], a[104:107]
    buffer_store_dwordx4 a[224:227], v229, s[8:11], s58 offen offset:0 sc1
    ds_read_b128 a[136:139], v2 offset:2048
    v_mfma_f32_16x16x32_bf16 a[108:111], a[216:219], v[204:207], a[108:111]
    v_exp_f32 v245, v181
    v_mfma_f32_16x16x32_bf16 a[112:115], a[220:223], v[192:195], a[112:115]
    v_cndmask_b32 v32, v8, v5, s[44:45]
    v_exp_f32 v246, v182
    v_mfma_f32_16x16x32_bf16 a[116:119], a[220:223], v[196:199], a[116:119]
    ds_read_b128 a[140:143], v2 offset:3072
    v_cndmask_b32 v33, v8, v5, s[46:47]
    v_cvt_pk_bf16_f32 v214, v244, v245
    v_cndmask_b32 v34, v8, v5, s[48:49]
    v_cndmask_b32 v35, v8, v5, s[50:51]
    v_mfma_f32_16x16x32_bf16 a[120:123], a[220:223], v[200:203], a[120:123]
    v_exp_f32 v247, v183
    v_mfma_f32_16x16x32_bf16 a[124:127], a[220:223], v[204:207], a[124:127]
    s_waitcnt lgkmcnt(2)
    v_or3_b32 v57, v57, v213, v214
    v_cvt_pk_bf16_f32 v215, v246, v247
    v_mfma_f32_16x16x32_bf16 v[128:131], a[128:131], v[64:67], v[16:19]
    v_exp_f32 v232, v168
    v_mfma_f32_16x16x32_bf16 v[128:131], a[132:135], v[68:71], v[128:131]
    s_waitcnt lgkmcnt(0)
    buffer_store_dwordx4 a[228:231], v229, s[8:11], s58 offen offset:256 sc1
    ds_read_b128 a[144:147], v2 offset:4096
    v_mfma_f32_16x16x32_bf16 v[128:131], a[136:139], v[72:75], v[128:131]
    v_exp_f32 v233, v169
    v_mfma_f32_16x16x32_bf16 v[128:131], a[140:143], v[76:79], v[128:131]
    s_add_u32 s36, s36, 32
    v_exp_f32 v234, v170
    v_mfma_f32_16x16x32_bf16 v[132:135], a[128:131], v[80:83], v[20:23]
    ds_read_b128 a[148:151], v2 offset:5120
    v_cvt_pk_bf16_f32 v216, v232, v233
    v_mfma_f32_16x16x32_bf16 v[132:135], a[132:135], v[84:87], v[132:135]
    s_lshl_b32 s58, s61, 17
    v_exp_f32 v235, v171
    v_mfma_f32_16x16x32_bf16 v[132:135], a[136:139], v[88:91], v[132:135]
    s_add_u32 s52, s52, 8192
    v_or3_b32 v57, v57, v215, v216
    v_cvt_pk_bf16_f32 v217, v234, v235
    v_mfma_f32_16x16x32_bf16 v[132:135], a[140:143], v[92:95], v[132:135]
    v_exp_f32 v236, v184
    v_mfma_f32_16x16x32_bf16 v[136:139], a[128:131], v[96:99], v[24:27]
    s_lshl_b32 s60, s60, 10
    buffer_load_dwordx4 a[224:227], v228, s[12:15], s57 offen
    ds_read_b128 a[152:155], v2 offset:6144
    v_mfma_f32_16x16x32_bf16 v[136:139], a[132:135], v[100:103], v[136:139]
    s_and_b32 s52, s52, 0xffff
    v_exp_f32 v237, v185
    v_mfma_f32_16x16x32_bf16 v[136:139], a[136:139], v[104:107], v[136:139]
    v_exp_f32 v238, v186
    v_mfma_f32_16x16x32_bf16 v[136:139], a[140:143], v[108:111], v[136:139]
    ds_read_b128 a[156:159], v2 offset:7168
    v_cvt_pk_bf16_f32 v218, v236, v237
    v_mfma_f32_16x16x32_bf16 v[140:143], a[128:131], v[112:115], v[28:31]
    s_add_u32 s58, s58, s60
    v_exp_f32 v239, v187
    v_mfma_f32_16x16x32_bf16 v[140:143], a[132:135], v[116:119], v[140:143]
    v_or3_b32 v57, v57, v217, v218
    v_add_u32 v2, s52, v1
    v_mfma_f32_16x16x32_bf16 v[140:143], a[136:139], v[120:123], v[140:143]
    v_exp_f32 v240, v172
    v_mfma_f32_16x16x32_bf16 v[140:143], a[140:143], v[124:127], v[140:143]
    s_waitcnt lgkmcnt(2)
    ds_read_b128 a[192:195], v3 offset:0
    v_cvt_pk_bf16_f32 v219, v238, v239
    v_mfma_f32_16x16x32_bf16 v[144:147], a[144:147], v[64:67], v[32:35]
    s_mov_b32 s10, s59
    buffer_load_dwordx4 a[228:231], v228, s[12:15], s56 offen
    v_mfma_f32_16x16x32_bf16 v[144:147], a[148:151], v[68:71], v[144:147]
    s_waitcnt lgkmcnt(1)
    v_exp_f32 v241, v173
    v_mfma_f32_16x16x32_bf16 v[144:147], a[152:155], v[72:75], v[144:147]
    v_exp_f32 v242, v174
    v_mfma_f32_16x16x32_bf16 v[144:147], a[156:159], v[76:79], v[144:147]
    v_cvt_pk_bf16_f32 v220, v240, v241
    v_or3_b32 v57, v57, v219, v220
    v_mfma_f32_16x16x32_bf16 v[148:151], a[144:147], v[80:83], v[36:39]
    v_exp_f32 v243, v175
    v_mfma_f32_16x16x32_bf16 v[148:151], a[148:151], v[84:87], v[148:151]
    ds_read_b128 a[196:199], v3 offset:1024
    v_cvt_pk_bf16_f32 v221, v242, v243
    v_mfma_f32_16x16x32_bf16 v[148:151], a[152:155], v[88:91], v[148:151]
    v_exp_f32 v244, v188
    v_mfma_f32_16x16x32_bf16 v[148:151], a[156:159], v[92:95], v[148:151]
    buffer_load_dword v7, v230, s[24:27], s54 offen
    ds_read_b128 a[200:203], v3 offset:2048
    v_mfma_f32_16x16x32_bf16 v[152:155], a[144:147], v[96:99], v[40:43]
    v_exp_f32 v245, v189
    v_mfma_f32_16x16x32_bf16 v[152:155], a[148:151], v[100:103], v[152:155]
    v_exp_f32 v246, v190
    v_mfma_f32_16x16x32_bf16 v[152:155], a[152:155], v[104:107], v[152:155]
    v_cvt_pk_bf16_f32 v222, v244, v245
    v_or3_b32 v57, v57, v221, v222
    v_mfma_f32_16x16x32_bf16 v[152:155], a[156:159], v[108:111], v[152:155]
    v_exp_f32 v247, v191
    v_mfma_f32_16x16x32_bf16 v[156:159], a[144:147], v[112:115], v[44:47]
    s_add_u32 s54, s54, 4096
    ds_read_b128 a[204:207], v3 offset:3072
    v_cvt_pk_bf16_f32 v223, v246, v247
    v_mfma_f32_16x16x32_bf16 v[156:159], a[148:151], v[116:119], v[156:159]
    v_bitop3_b32 v57, v57, v223, s37 bitop3:0xa8
    v_cmp_ne_u32 vcc, 0, v57
    v_mfma_f32_16x16x32_bf16 v[156:159], a[152:155], v[120:123], v[156:159]
    v_mfma_f32_16x16x32_bf16 v[156:159], a[156:159], v[124:127], v[156:159]
    s_cbranch_vccnz k2_tramp_88
k2_ret_89:
    v_mfma_f32_16x16x32_bf16 v[12:15], v[60:63], v[208:211], v[12:15]
    v_exp_f32 v232, v128
    v_mfma_f32_16x16x32_bf16 v[48:51], v[60:63], v[212:215], v[48:51]
    s_mov_b32 m0, s35
    ds_read_b128 a[208:211], v3 offset:4096
    v_mfma_f32_16x16x32_bf16 v[248:251], v[60:63], v[216:219], v[248:251]
    s_add_u32 s53, s53, 8192
    buffer_load_dwordx4 v1, s[20:23], s33 offen offset:0 sc1 lds
    v_mfma_f32_16x16x32_bf16 v[252:255], v[60:63], v[220:223], v[252:255]
    s_waitcnt lgkmcnt(3)
    v_exp_f32 v233, v129
    v_mfma_f32_16x16x32_bf16 a[0:3], a[192:195], v[208:211], a[0:3]
    s_sub_u32 s40, s36, s38
    v_exp_f32 v234, v130
    v_mfma_f32_16x16x32_bf16 a[4:7], a[192:195], v[212:215], a[4:7]
    s_and_b32 s53, s53, 0xffff
    ds_read_b128 a[212:215], v3 offset:5120
    v_cvt_pk_bf16_f32 v192, v232, v233
    v_mfma_f32_16x16x32_bf16 a[8:11], a[192:195], v[216:219], a[8:11]
    v_subrev_u32 v6, s40, v4
    v_cmp_gt_i32 s[44:45], 0, v6
    v_mfma_f32_16x16x32_bf16 a[12:15], a[192:195], v[220:223], a[12:15]
    v_exp_f32 v235, v131
    v_mfma_f32_16x16x32_bf16 a[16:19], a[196:199], v[208:211], a[16:19]
    v_exp_f32 v236, v144
    v_mfma_f32_16x16x32_bf16 a[20:23], a[196:199], v[212:215], a[20:23]
    v_cmp_gt_i32 s[46:47], 1, v6
    v_cvt_pk_bf16_f32 v193, v234, v235
    v_mfma_f32_16x16x32_bf16 a[24:27], a[196:199], v[216:219], a[24:27]
    ds_read_b128 a[216:219], v3 offset:6144
    v_cmp_gt_i32 s[48:49], 2, v6
    v_mfma_f32_16x16x32_bf16 a[28:31], a[196:199], v[220:223], a[28:31]
    s_waitcnt lgkmcnt(3)
    v_exp_f32 v237, v145
    v_mfma_f32_16x16x32_bf16 a[32:35], a[200:203], v[208:211], a[32:35]
    v_cmp_gt_i32 s[50:51], 3, v6
    v_cvt_pk_bf16_f32 v194, v236, v237
    v_mfma_f32_16x16x32_bf16 a[36:39], a[200:203], v[212:215], a[36:39]
    v_exp_f32 v238, v146
    v_mfma_f32_16x16x32_bf16 a[40:43], a[200:203], v[216:219], a[40:43]
    ds_read_b128 a[220:223], v3 offset:7168
    v_cndmask_b32 v16, v8, v5, s[44:45]
    v_mfma_f32_16x16x32_bf16 a[44:47], a[200:203], v[220:223], a[44:47]
    s_add_u32 s35, s35, 0x4000
    v_exp_f32 v239, v147
    v_mfma_f32_16x16x32_bf16 a[48:51], a[204:207], v[208:211], a[48:51]
    v_or3_b32 v57, v192, v193, v194
    v_cndmask_b32 v17, v8, v5, s[46:47]
    v_mfma_f32_16x16x32_bf16 a[52:55], a[204:207], v[212:215], a[52:55]
    v_add_u32 v3, s53, v56
    v_cvt_pk_bf16_f32 v195, v238, v239
    v_mfma_f32_16x16x32_bf16 a[56:59], a[204:207], v[216:219], a[56:59]
    v_exp_f32 v240, v132
    v_mfma_f32_16x16x32_bf16 a[60:63], a[204:207], v[220:223], a[60:63]
    s_waitcnt lgkmcnt(2)
    ds_read_b128 a[128:131], v2 offset:0
    v_cndmask_b32 v18, v8, v5, s[48:49]
    v_mfma_f32_16x16x32_bf16 a[64:67], a[208:211], v[208:211], a[64:67]
    buffer_load_dwordx4 v1, s[20:23], s33 offen offset:1024 sc1 lds
    ds_read_b128 a[132:135], v2 offset:1024
    v_mfma_f32_16x16x32_bf16 a[68:71], a[208:211], v[212:215], a[68:71]
    v_exp_f32 v241, v133
    v_mfma_f32_16x16x32_bf16 a[72:75], a[208:211], v[216:219], a[72:75]
    v_cndmask_b32 v19, v8, v5, s[50:51]
    v_cmp_gt_i32 s[44:45], 16, v6
    v_mfma_f32_16x16x32_bf16 a[76:79], a[208:211], v[220:223], a[76:79]
    v_exp_f32 v242, v134
    v_mfma_f32_16x16x32_bf16 a[80:83], a[212:215], v[208:211], a[80:83]
    v_cvt_pk_bf16_f32 v196, v240, v241
    v_cmp_gt_i32 s[46:47], 17, v6
    v_mfma_f32_16x16x32_bf16 a[84:87], a[212:215], v[212:215], a[84:87]
    v_exp_f32 v243, v135
    v_mfma_f32_16x16x32_bf16 a[88:91], a[212:215], v[216:219], a[88:91]
    v_or3_b32 v57, v57, v195, v196
    v_cmp_gt_i32 s[48:49], 18, v6
    v_mfma_f32_16x16x32_bf16 a[92:95], a[212:215], v[220:223], a[92:95]
    s_waitcnt lgkmcnt(2)
    v_exp_f32 v244, v148
    v_mfma_f32_16x16x32_bf16 a[96:99], a[216:219], v[208:211], a[96:99]
    v_cvt_pk_bf16_f32 v197, v242, v243
    v_cmp_gt_i32 s[50:51], 19, v6
    v_mfma_f32_16x16x32_bf16 a[100:103], a[216:219], v[212:215], a[100:103]
    ds_read_b128 a[136:139], v2 offset:2048
    v_cndmask_b32 v32, v8, v5, s[44:45]
    v_mfma_f32_16x16x32_bf16 a[104:107], a[216:219], v[216:219], a[104:107]
    v_exp_f32 v245, v149
    v_mfma_f32_16x16x32_bf16 a[108:111], a[216:219], v[220:223], a[108:111]
    s_and_b32 s35, s35, 0xffff
    v_exp_f32 v246, v150
    v_mfma_f32_16x16x32_bf16 a[112:115], a[220:223], v[208:211], a[112:115]
    v_cndmask_b32 v33, v8, v5, s[46:47]
    v_cvt_pk_bf16_f32 v198, v244, v245
    v_mfma_f32_16x16x32_bf16 a[116:119], a[220:223], v[212:215], a[116:119]
    ds_read_b128 a[140:143], v2 offset:3072
    v_cndmask_b32 v34, v8, v5, s[48:49]
    v_cndmask_b32 v35, v8, v5, s[50:51]
    v_mfma_f32_16x16x32_bf16 a[120:123], a[220:223], v[216:219], a[120:123]
    v_exp_f32 v247, v151
    v_mfma_f32_16x16x32_bf16 a[124:127], a[220:223], v[220:223], a[124:127]
    s_waitcnt lgkmcnt(2)
    v_or3_b32 v57, v57, v197, v198
    v_cvt_pk_bf16_f32 v199, v246, v247
    v_mfma_f32_16x16x32_bf16 v[160:163], a[128:131], v[64:67], v[16:19]
    v_exp_f32 v232, v136
    v_mfma_f32_16x16x32_bf16 v[160:163], a[132:135], v[68:71], v[160:163]
    s_waitcnt lgkmcnt(0)
    buffer_load_dwordx4 v1, s[20:23], s33 offen offset:2048 sc1 lds
    ds_read_b128 a[144:147], v2 offset:4096
    v_mfma_f32_16x16x32_bf16 v[160:163], a[136:139], v[72:75], v[160:163]
    v_exp_f32 v233, v137
    v_mfma_f32_16x16x32_bf16 v[160:163], a[140:143], v[76:79], v[160:163]
    s_or_b32 s35, s35, 0x10000
    v_exp_f32 v234, v138
    v_mfma_f32_16x16x32_bf16 v[164:167], a[128:131], v[80:83], v[20:23]
    s_add_u32 s36, s36, 32
    ds_read_b128 a[148:151], v2 offset:5120
    v_cvt_pk_bf16_f32 v200, v232, v233
    v_mfma_f32_16x16x32_bf16 v[164:167], a[132:135], v[84:87], v[164:167]
    v_exp_f32 v235, v139
    v_mfma_f32_16x16x32_bf16 v[164:167], a[136:139], v[88:91], v[164:167]
    s_add_u32 s52, s52, 8192
    v_or3_b32 v57, v57, v199, v200
    v_cvt_pk_bf16_f32 v201, v234, v235
    v_mfma_f32_16x16x32_bf16 v[164:167], a[140:143], v[92:95], v[164:167]
    v_exp_f32 v236, v152
    v_mfma_f32_16x16x32_bf16 v[168:171], a[128:131], v[96:99], v[24:27]
    s_and_b32 s52, s52, 0xffff
    ds_read_b128 a[152:155], v2 offset:6144
    ds_read_b128 a[156:159], v2 offset:7168
    v_mfma_f32_16x16x32_bf16 v[168:171], a[132:135], v[100:103], v[168:171]
    v_exp_f32 v237, v153
    v_mfma_f32_16x16x32_bf16 v[168:171], a[136:139], v[104:107], v[168:171]
    v_exp_f32 v238, v154
    v_mfma_f32_16x16x32_bf16 v[168:171], a[140:143], v[108:111], v[168:171]
    v_cvt_pk_bf16_f32 v202, v236, v237
    v_or3_b32 v57, v57, v201, v202
    v_mfma_f32_16x16x32_bf16 v[172:175], a[128:131], v[112:115], v[28:31]
    v_exp_f32 v239, v155
    v_mfma_f32_16x16x32_bf16 v[172:175], a[132:135], v[116:119], v[172:175]
    v_add_u32 v2, s52, v1
    v_cvt_pk_bf16_f32 v203, v238, v239
    v_mfma_f32_16x16x32_bf16 v[172:175], a[136:139], v[120:123], v[172:175]
    v_exp_f32 v240, v140
    v_mfma_f32_16x16x32_bf16 v[172:175], a[140:143], v[124:127], v[172:175]
    s_waitcnt lgkmcnt(2)
    buffer_load_dwordx4 v1, s[20:23], s33 offen offset:3072 sc1 lds
    s_add_u32 s33, s33, 0x80000
    v_mfma_f32_16x16x32_bf16 v[176:179], a[144:147], v[64:67], v[32:35]
    v_exp_f32 v241, v141
    v_mfma_f32_16x16x32_bf16 v[176:179], a[148:151], v[68:71], v[176:179]
    s_waitcnt lgkmcnt(0)
    ds_read_b128 a[192:195], v3 offset:0
    v_cvt_pk_bf16_f32 v204, v240, v241
    v_mfma_f32_16x16x32_bf16 v[176:179], a[152:155], v[72:75], v[176:179]
    v_exp_f32 v242, v142
    v_mfma_f32_16x16x32_bf16 v[176:179], a[156:159], v[76:79], v[176:179]
    v_exp_f32 v243, v143
    v_mfma_f32_16x16x32_bf16 v[180:183], a[144:147], v[80:83], v[36:39]
    ds_read_b128 a[196:199], v3 offset:1024
    v_or3_b32 v57, v57, v203, v204
    v_mfma_f32_16x16x32_bf16 v[180:183], a[148:151], v[84:87], v[180:183]
    v_exp_f32 v244, v156
    v_mfma_f32_16x16x32_bf16 v[180:183], a[152:155], v[88:91], v[180:183]
    ds_read_b128 a[200:203], v3 offset:2048
    v_cvt_pk_bf16_f32 v205, v242, v243
    v_mfma_f32_16x16x32_bf16 v[180:183], a[156:159], v[92:95], v[180:183]
    v_exp_f32 v245, v157
    v_mfma_f32_16x16x32_bf16 v[184:187], a[144:147], v[96:99], v[40:43]
    v_exp_f32 v246, v158
    v_mfma_f32_16x16x32_bf16 v[184:187], a[148:151], v[100:103], v[184:187]
    v_cvt_pk_bf16_f32 v206, v244, v245
    v_or3_b32 v57, v57, v205, v206
    v_mfma_f32_16x16x32_bf16 v[184:187], a[152:155], v[104:107], v[184:187]
    v_exp_f32 v247, v159
    v_mfma_f32_16x16x32_bf16 v[184:187], a[156:159], v[108:111], v[184:187]
    ds_read_b128 a[204:207], v3 offset:3072
    v_cvt_pk_bf16_f32 v207, v246, v247
    v_mfma_f32_16x16x32_bf16 v[188:191], a[144:147], v[112:115], v[44:47]
    v_mfma_f32_16x16x32_bf16 v[188:191], a[148:151], v[116:119], v[188:191]
    v_bitop3_b32 v57, v57, v207, s37 bitop3:0xa8
    v_cmp_ne_u32 vcc, 0, v57
    v_mfma_f32_16x16x32_bf16 v[188:191], a[152:155], v[120:123], v[188:191]
    v_mfma_f32_16x16x32_bf16 v[188:191], a[156:159], v[124:127], v[188:191]
    s_waitcnt vmcnt(13)
    s_barrier
    s_cbranch_vccnz k2_tramp_90
k2_ret_91:
k2_dm3_83:
    v_mfma_f32_16x16x32_bf16 v[12:15], v[60:63], v[192:195], v[12:15]
    v_exp_f32 v232, v160
    v_mfma_f32_16x16x32_bf16 v[48:51], v[60:63], v[196:199], v[48:51]
    s_mov_b32 m0, s34
    ds_read_b128 a[208:211], v3 offset:4096
    v_mfma_f32_16x16x32_bf16 v[248:251], v[60:63], v[200:203], v[248:251]
    s_add_u32 s53, s53, 8192
    v_exp_f32 v233, v161
    v_mfma_f32_16x16x32_bf16 v[252:255], v[60:63], v[204:207], v[252:255]
    s_waitcnt lgkmcnt(3)
    buffer_load_dwordx4 v1, s[16:19], s32 offen offset:0 sc1 lds
    v_mfma_f32_16x16x32_bf16 a[0:3], a[192:195], v[192:195], a[0:3]
    s_sub_u32 s40, s36, s38
    s_sub_u32 s40, s40, 64
    v_exp_f32 v234, v162
    v_cvt_pk_bf16_f32 v208, v232, v233
    v_mfma_f32_16x16x32_bf16 a[4:7], a[192:195], v[196:199], a[4:7]
    s_and_b32 s53, s53, 0xffff
    ds_read_b128 a[212:215], v3 offset:5120
    v_subrev_u32 v6, s40, v4
    v_mfma_f32_16x16x32_bf16 a[8:11], a[192:195], v[200:203], a[8:11]
    s_add_u32 s34, s34, 0x4000
    v_exp_f32 v235, v163
    v_cmp_gt_i32 s[44:45], 0, v6
    v_mfma_f32_16x16x32_bf16 a[12:15], a[192:195], v[204:207], a[12:15]
    v_exp_f32 v236, v176
    v_cvt_pk_bf16_f32 v209, v234, v235
    v_mfma_f32_16x16x32_bf16 a[16:19], a[196:199], v[192:195], a[16:19]
    buffer_load_dwordx4 v1, s[16:19], s32 offen offset:1024 sc1 lds
    ds_read_b128 a[216:219], v3 offset:6144
    v_mfma_f32_16x16x32_bf16 a[20:23], a[196:199], v[196:199], a[20:23]
    v_cmp_gt_i32 s[46:47], 1, v6
    v_exp_f32 v237, v177
    v_mfma_f32_16x16x32_bf16 a[24:27], a[196:199], v[200:203], a[24:27]
    v_cmp_gt_i32 s[48:49], 2, v6
    v_exp_f32 v238, v178
    v_mfma_f32_16x16x32_bf16 a[28:31], a[196:199], v[204:207], a[28:31]
    s_waitcnt lgkmcnt(3)
    v_cvt_pk_bf16_f32 v210, v236, v237
    v_cmp_gt_i32 s[50:51], 3, v6
    v_mfma_f32_16x16x32_bf16 a[32:35], a[200:203], v[192:195], a[32:35]
    s_and_b32 s34, s34, 0xffff
    v_exp_f32 v239, v179
    v_mfma_f32_16x16x32_bf16 a[36:39], a[200:203], v[196:199], a[36:39]
    s_and_b32 s60, s62, 31
    ds_read_b128 a[220:223], v3 offset:7168
    v_or3_b32 v57, v208, v209, v210
    v_cndmask_b32 v20, v9, v5, s[44:45]
    v_mfma_f32_16x16x32_bf16 a[40:43], a[200:203], v[200:203], a[40:43]
    buffer_load_dwordx4 v1, s[16:19], s32 offen offset:2048 sc1 lds
    v_mfma_f32_16x16x32_bf16 a[44:47], a[200:203], v[204:207], a[44:47]
    s_lshr_b32 s61, s62, 5
    v_exp_f32 v240, v164
    v_cvt_pk_bf16_f32 v211, v238, v239
    v_mfma_f32_16x16x32_bf16 a[48:51], a[204:207], v[192:195], a[48:51]
    v_cndmask_b32 v21, v9, v5, s[46:47]
    v_add_u32 v3, s53, v56
    v_mfma_f32_16x16x32_bf16 a[52:55], a[204:207], v[196:199], a[52:55]
    s_mul_i32 s57, s60, 229376
    v_exp_f32 v241, v165
    v_mfma_f32_16x16x32_bf16 a[56:59], a[204:207], v[200:203], a[56:59]
    ds_read_b128 a[128:131], v2 offset:0
    v_cndmask_b32 v22, v9, v5, s[48:49]
    v_cvt_pk_bf16_f32 v212, v240, v241
    v_mfma_f32_16x16x32_bf16 a[60:63], a[204:207], v[204:207], a[60:63]
    s_waitcnt lgkmcnt(3)
    v_exp_f32 v242, v166
    v_mfma_f32_16x16x32_bf16 a[64:67], a[208:211], v[192:195], a[64:67]
    s_lshl_b32 s4, s61, 7
    v_cndmask_b32 v23, v9, v5, s[50:51]
    v_or3_b32 v57, v57, v211, v212
    v_mfma_f32_16x16x32_bf16 a[68:71], a[208:211], v[196:199], a[68:71]
    buffer_load_dwordx4 v1, s[16:19], s32 offen offset:3072 sc1 lds
    ds_read_b128 a[132:135], v2 offset:1024
    s_add_u32 s32, s32, 0x80000
    v_mfma_f32_16x16x32_bf16 a[72:75], a[208:211], v[200:203], a[72:75]
    v_exp_f32 v243, v167
    v_mfma_f32_16x16x32_bf16 a[76:79], a[208:211], v[204:207], a[76:79]
    s_add_u32 s57, s57, s4
    v_cmp_gt_i32 s[44:45], 16, v6
    v_cvt_pk_bf16_f32 v213, v242, v243
    v_mfma_f32_16x16x32_bf16 a[80:83], a[212:215], v[192:195], a[80:83]
    s_waitcnt vmcnt(8)
    v_exp_f32 v244, v180
    v_mfma_f32_16x16x32_bf16 a[84:87], a[212:215], v[196:199], a[84:87]
    s_add_u32 s56, s57, 57344
    ds_read_b128 a[136:139], v2 offset:2048
    v_cmp_gt_i32 s[46:47], 17, v6
    v_mfma_f32_16x16x32_bf16 a[88:91], a[212:215], v[200:203], a[88:91]
    v_exp_f32 v245, v181
    v_cmp_gt_i32 s[48:49], 18, v6
    v_mfma_f32_16x16x32_bf16 a[92:95], a[212:215], v[204:207], a[92:95]
    s_waitcnt lgkmcnt(3)
    v_exp_f32 v246, v182
    v_mfma_f32_16x16x32_bf16 a[96:99], a[216:219], v[192:195], a[96:99]
    s_add_u32 s62, s62, 1
    v_cmp_gt_i32 s[50:51], 19, v6
    v_cvt_pk_bf16_f32 v214, v244, v245
    v_mfma_f32_16x16x32_bf16 a[100:103], a[216:219], v[196:199], a[100:103]
    buffer_store_dwordx4 a[224:227], v229, s[8:11], s58 offen offset:0 sc1
    ds_read_b128 a[140:143], v2 offset:3072
    ds_read_b128 a[144:147], v2 offset:4096
    v_mfma_f32_16x16x32_bf16 a[104:107], a[216:219], v[200:203], a[104:107]
    v_exp_f32 v247, v183
    v_mfma_f32_16x16x32_bf16 a[108:111], a[216:219], v[204:207], a[108:111]
    v_cndmask_b32 v36, v9, v5, s[44:45]
    v_or3_b32 v57, v57, v213, v214
    v_mfma_f32_16x16x32_bf16 a[112:115], a[220:223], v[192:195], a[112:115]
    v_exp_f32 v232, v168
    v_mfma_f32_16x16x32_bf16 a[116:119], a[220:223], v[196:199], a[116:119]
    v_cndmask_b32 v37, v9, v5, s[46:47]
    v_cvt_pk_bf16_f32 v215, v246, v247
    v_cndmask_b32 v38, v9, v5, s[48:49]
    v_cndmask_b32 v39, v9, v5, s[50:51]
    v_mfma_f32_16x16x32_bf16 a[120:123], a[220:223], v[200:203], a[120:123]
    v_exp_f32 v233, v169
    v_mfma_f32_16x16x32_bf16 a[124:127], a[220:223], v[204:207], a[124:127]
    s_waitcnt lgkmcnt(3)
    buffer_store_dwordx4 a[228:231], v229, s[8:11], s58 offen offset:256 sc1
    v_exp_f32 v234, v170
    v_mfma_f32_16x16x32_bf16 v[132:135], a[128:131], v[80:83], v[20:23]
    ds_read_b128 a[148:151], v2 offset:5120
    v_cvt_pk_bf16_f32 v216, v232, v233
    v_mfma_f32_16x16x32_bf16 v[132:135], a[132:135], v[84:87], v[132:135]
    s_waitcnt lgkmcnt(2)
    v_exp_f32 v235, v171
    v_mfma_f32_16x16x32_bf16 v[132:135], a[136:139], v[88:91], v[132:135]
    s_lshl_b32 s58, s61, 17
    ds_read_b128 a[152:155], v2 offset:6144
    v_or3_b32 v57, v57, v215, v216
    v_mfma_f32_16x16x32_bf16 v[132:135], a[140:143], v[92:95], v[132:135]
    s_add_u32 s36, s36, 32
    v_exp_f32 v236, v184
    v_mfma_f32_16x16x32_bf16 v[136:139], a[128:131], v[96:99], v[24:27]
    s_lshl_b32 s60, s60, 10
    v_cvt_pk_bf16_f32 v217, v234, v235
    v_exp_f32 v237, v185
    v_mfma_f32_16x16x32_bf16 v[136:139], a[132:135], v[100:103], v[136:139]
    buffer_load_dwordx4 a[224:227], v228, s[12:15], s57 offen
    ds_read_b128 a[156:159], v2 offset:7168
    v_mfma_f32_16x16x32_bf16 v[136:139], a[136:139], v[104:107], v[136:139]
    s_add_u32 s52, s52, 8192
    v_exp_f32 v238, v186
    v_mfma_f32_16x16x32_bf16 v[136:139], a[140:143], v[108:111], v[136:139]
    s_add_u32 s58, s58, s60
    v_cvt_pk_bf16_f32 v218, v236, v237
    v_or3_b32 v57, v57, v217, v218
    v_mfma_f32_16x16x32_bf16 v[140:143], a[128:131], v[112:115], v[28:31]
    s_and_b32 s52, s52, 0xffff
    v_exp_f32 v239, v187
    v_mfma_f32_16x16x32_bf16 v[140:143], a[132:135], v[116:119], v[140:143]
    v_add_u32 v2, s52, v1
    v_cvt_pk_bf16_f32 v219, v238, v239
    v_mfma_f32_16x16x32_bf16 v[140:143], a[136:139], v[120:123], v[140:143]
    s_mov_b32 s10, s59
    v_exp_f32 v240, v172
    v_mfma_f32_16x16x32_bf16 v[140:143], a[140:143], v[124:127], v[140:143]
    s_waitcnt lgkmcnt(2)
    ds_read_b128 a[192:195], v3 offset:0
    v_exp_f32 v241, v173
    v_mfma_f32_16x16x32_bf16 v[148:151], a[144:147], v[80:83], v[36:39]
    buffer_load_dwordx4 a[228:231], v228, s[12:15], s56 offen
    ds_read_b128 a[196:199], v3 offset:1024
    v_mfma_f32_16x16x32_bf16 v[148:151], a[148:151], v[84:87], v[148:151]
    s_waitcnt lgkmcnt(2)
    v_exp_f32 v242, v174
    v_mfma_f32_16x16x32_bf16 v[148:151], a[152:155], v[88:91], v[148:151]
    v_cvt_pk_bf16_f32 v220, v240, v241
    v_or3_b32 v57, v57, v219, v220
    v_mfma_f32_16x16x32_bf16 v[148:151], a[156:159], v[92:95], v[148:151]
    v_exp_f32 v243, v175
    v_mfma_f32_16x16x32_bf16 v[152:155], a[144:147], v[96:99], v[40:43]
    v_exp_f32 v244, v188
    v_mfma_f32_16x16x32_bf16 v[152:155], a[148:151], v[100:103], v[152:155]
    v_cvt_pk_bf16_f32 v221, v242, v243
    v_exp_f32 v245, v189
    v_mfma_f32_16x16x32_bf16 v[152:155], a[152:155], v[104:107], v[152:155]
    buffer_load_dword v7, v230, s[24:27], s54 offen
    ds_read_b128 a[200:203], v3 offset:2048
    v_mfma_f32_16x16x32_bf16 v[152:155], a[156:159], v[108:111], v[152:155]
    v_exp_f32 v246, v190
    v_mfma_f32_16x16x32_bf16 v[156:159], a[144:147], v[112:115], v[44:47]
    s_add_u32 s54, s54, 4096
    v_cvt_pk_bf16_f32 v222, v244, v245
    v_or3_b32 v57, v57, v221, v222
    v_mfma_f32_16x16x32_bf16 v[156:159], a[148:151], v[116:119], v[156:159]
    v_exp_f32 v247, v191
    v_mfma_f32_16x16x32_bf16 v[156:159], a[152:155], v[120:123], v[156:159]
    ds_read_b128 a[204:207], v3 offset:3072
    v_cvt_pk_bf16_f32 v223, v246, v247
    v_bitop3_b32 v57, v57, v223, s37 bitop3:0xa8
    v_mfma_f32_16x16x32_bf16 v[156:159], a[156:159], v[124:127], v[156:159]
    v_cmp_ne_u32 vcc, 0, v57
    s_cbranch_vccnz k2_tramp_92
k2_ret_93:
    v_mfma_f32_16x16x32_bf16 v[12:15], v[60:63], v[208:211], v[12:15]
    v_exp_f32 v232, v132
    v_mfma_f32_16x16x32_bf16 v[48:51], v[60:63], v[212:215], v[48:51]
    s_mov_b32 m0, s35
    ds_read_b128 a[208:211], v3 offset:4096
    v_mfma_f32_16x16x32_bf16 v[248:251], v[60:63], v[216:219], v[248:251]
    s_add_u32 s53, s53, 8192
    buffer_load_dwordx4 v1, s[20:23], s33 offen offset:0 sc1 lds
    v_mfma_f32_16x16x32_bf16 v[252:255], v[60:63], v[220:223], v[252:255]
    s_waitcnt lgkmcnt(3)
    v_exp_f32 v233, v133
    v_mfma_f32_16x16x32_bf16 a[0:3], a[192:195], v[208:211], a[0:3]
    s_sub_u32 s40, s36, s38
    s_sub_u32 s40, s40, 64
    v_exp_f32 v234, v134
    v_mfma_f32_16x16x32_bf16 a[4:7], a[192:195], v[212:215], a[4:7]
    s_and_b32 s53, s53, 0xffff
    ds_read_b128 a[212:215], v3 offset:5120
    v_subrev_u32 v6, s40, v4
    v_mfma_f32_16x16x32_bf16 a[8:11], a[192:195], v[216:219], a[8:11]
    v_cvt_pk_bf16_f32 v196, v232, v233
    v_cmp_gt_i32 s[44:45], 0, v6
    v_mfma_f32_16x16x32_bf16 a[12:15], a[192:195], v[220:223], a[12:15]
    v_exp_f32 v235, v135
    v_mfma_f32_16x16x32_bf16 a[16:19], a[196:199], v[208:211], a[16:19]
    ds_read_b128 a[216:219], v3 offset:6144
    v_cmp_gt_i32 s[46:47], 1, v6
    v_mfma_f32_16x16x32_bf16 a[20:23], a[196:199], v[212:215], a[20:23]
    v_exp_f32 v236, v148
    v_mfma_f32_16x16x32_bf16 a[24:27], a[196:199], v[216:219], a[24:27]
    v_cvt_pk_bf16_f32 v197, v234, v235
    v_cmp_gt_i32 s[48:49], 2, v6
    v_mfma_f32_16x16x32_bf16 a[28:31], a[196:199], v[220:223], a[28:31]
    s_waitcnt lgkmcnt(3)
    v_cmp_gt_i32 s[50:51], 3, v6
    v_mfma_f32_16x16x32_bf16 a[32:35], a[200:203], v[208:211], a[32:35]
    v_exp_f32 v237, v149
    v_mfma_f32_16x16x32_bf16 a[36:39], a[200:203], v[212:215], a[36:39]
    s_add_u32 s35, s35, 0x4000
    ds_read_b128 a[220:223], v3 offset:7168
    v_cndmask_b32 v20, v9, v5, s[44:45]
    v_mfma_f32_16x16x32_bf16 a[40:43], a[200:203], v[216:219], a[40:43]
    v_exp_f32 v238, v150
    v_mfma_f32_16x16x32_bf16 a[44:47], a[200:203], v[220:223], a[44:47]
    v_cvt_pk_bf16_f32 v198, v236, v237
    v_cndmask_b32 v21, v9, v5, s[46:47]
    v_mfma_f32_16x16x32_bf16 a[48:51], a[204:207], v[208:211], a[48:51]
    buffer_load_dwordx4 v1, s[20:23], s33 offen offset:1024 sc1 lds
    ds_read_b128 a[128:131], v2 offset:0
    v_mfma_f32_16x16x32_bf16 a[52:55], a[204:207], v[212:215], a[52:55]
    v_add_u32 v3, s53, v56
    v_cndmask_b32 v22, v9, v5, s[48:49]
    v_mfma_f32_16x16x32_bf16 a[56:59], a[204:207], v[216:219], a[56:59]
    v_exp_f32 v239, v151
    v_mfma_f32_16x16x32_bf16 a[60:63], a[204:207], v[220:223], a[60:63]
    s_waitcnt lgkmcnt(3)
    v_or3_b32 v57, v196, v197, v198
    v_cndmask_b32 v23, v9, v5, s[50:51]
    v_mfma_f32_16x16x32_bf16 a[64:67], a[208:211], v[208:211], a[64:67]
    v_exp_f32 v240, v136
    v_mfma_f32_16x16x32_bf16 a[68:71], a[208:211], v[212:215], a[68:71]
    v_cvt_pk_bf16_f32 v199, v238, v239
    v_cmp_gt_i32 s[44:45], 16, v6
    v_mfma_f32_16x16x32_bf16 a[72:75], a[208:211], v[216:219], a[72:75]
    ds_read_b128 a[132:135], v2 offset:1024
    v_cmp_gt_i32 s[46:47], 17, v6
    v_mfma_f32_16x16x32_bf16 a[76:79], a[208:211], v[220:223], a[76:79]
    v_exp_f32 v241, v137
    v_mfma_f32_16x16x32_bf16 a[80:83], a[212:215], v[208:211], a[80:83]
    ds_read_b128 a[136:139], v2 offset:2048
    v_cmp_gt_i32 s[48:49], 18, v6
    v_mfma_f32_16x16x32_bf16 a[84:87], a[212:215], v[212:215], a[84:87]
    v_exp_f32 v242, v138
    v_mfma_f32_16x16x32_bf16 a[88:91], a[212:215], v[216:219], a[88:91]
    v_cvt_pk_bf16_f32 v200, v240, v241
    v_cmp_gt_i32 s[50:51], 19, v6
    v_mfma_f32_16x16x32_bf16 a[92:95], a[212:215], v[220:223], a[92:95]
    s_waitcnt lgkmcnt(3)
    v_exp_f32 v243, v139
    v_mfma_f32_16x16x32_bf16 a[96:99], a[216:219], v[208:211], a[96:99]
    s_and_b32 s35, s35, 0xffff
    ds_read_b128 a[140:143], v2 offset:3072
    v_or3_b32 v57, v57, v199, v200
    v_mfma_f32_16x16x32_bf16 a[100:103], a[216:219], v[212:215], a[100:103]
    v_cndmask_b32 v36, v9, v5, s[44:45]
    v_cndmask_b32 v37, v9, v5, s[46:47]
    v_mfma_f32_16x16x32_bf16 a[104:107], a[216:219], v[216:219], a[104:107]
    v_exp_f32 v244, v152
    v_mfma_f32_16x16x32_bf16 a[108:111], a[216:219], v[220:223], a[108:111]
    ds_read_b128 a[144:147], v2 offset:4096
    v_cvt_pk_bf16_f32 v201, v242, v243
    v_mfma_f32_16x16x32_bf16 a[112:115], a[220:223], v[208:211], a[112:115]
    buffer_load_dwordx4 v1, s[20:23], s33 offen offset:2048 sc1 lds
    ds_read_b128 a[148:151], v2 offset:5120
    v_mfma_f32_16x16x32_bf16 a[116:119], a[220:223], v[212:215], a[116:119]
    v_cndmask_b32 v38, v9, v5, s[48:49]
    v_cndmask_b32 v39, v9, v5, s[50:51]
    v_mfma_f32_16x16x32_bf16 a[120:123], a[220:223], v[216:219], a[120:123]
    s_or_b32 s35, s35, 0x10000
    v_exp_f32 v245, v153
    v_mfma_f32_16x16x32_bf16 a[124:127], a[220:223], v[220:223], a[124:127]
    s_waitcnt lgkmcnt(4)
    v_exp_f32 v246, v154
    v_mfma_f32_16x16x32_bf16 v[164:167], a[128:131], v[80:83], v[20:23]
    ds_read_b128 a[152:155], v2 offset:6144
    v_cvt_pk_bf16_f32 v202, v244, v245
    v_mfma_f32_16x16x32_bf16 v[164:167], a[132:135], v[84:87], v[164:167]
    s_waitcnt lgkmcnt(3)
    v_exp_f32 v247, v155
    v_mfma_f32_16x16x32_bf16 v[164:167], a[136:139], v[88:91], v[164:167]
    v_or3_b32 v57, v57, v201, v202
    v_cvt_pk_bf16_f32 v203, v246, v247
    v_mfma_f32_16x16x32_bf16 v[164:167], a[140:143], v[92:95], v[164:167]
    s_add_u32 s36, s36, 32
    v_exp_f32 v232, v140
    v_mfma_f32_16x16x32_bf16 v[168:171], a[128:131], v[96:99], v[24:27]
    ds_read_b128 a[156:159], v2 offset:7168
    v_mfma_f32_16x16x32_bf16 v[168:171], a[132:135], v[100:103], v[168:171]
    v_exp_f32 v233, v141
    v_mfma_f32_16x16x32_bf16 v[168:171], a[136:139], v[104:107], v[168:171]
    s_add_u32 s52, s52, 8192
    v_exp_f32 v234, v142
    v_mfma_f32_16x16x32_bf16 v[168:171], a[140:143], v[108:111], v[168:171]
    ds_read_b128 a[192:195], v3 offset:0
    v_cvt_pk_bf16_f32 v204, v232, v233
    v_mfma_f32_16x16x32_bf16 v[172:175], a[128:131], v[112:115], v[28:31]
    s_and_b32 s52, s52, 0xffff
    v_add_u32 v2, s52, v1
    v_or3_b32 v57, v57, v203, v204
    v_mfma_f32_16x16x32_bf16 v[172:175], a[132:135], v[116:119], v[172:175]
    buffer_load_dwordx4 v1, s[20:23], s33 offen offset:3072 sc1 lds
    s_add_u32 s33, s33, 0x80000
    v_mfma_f32_16x16x32_bf16 v[172:175], a[136:139], v[120:123], v[172:175]
    v_exp_f32 v235, v143
    v_mfma_f32_16x16x32_bf16 v[172:175], a[140:143], v[124:127], v[172:175]
    s_waitcnt lgkmcnt(3)
    v_exp_f32 v236, v156
    v_mfma_f32_16x16x32_bf16 v[180:183], a[144:147], v[80:83], v[36:39]
    ds_read_b128 a[196:199], v3 offset:1024
    v_cvt_pk_bf16_f32 v205, v234, v235
    v_mfma_f32_16x16x32_bf16 v[180:183], a[148:151], v[84:87], v[180:183]
    s_waitcnt lgkmcnt(2)
    v_exp_f32 v237, v157
    v_mfma_f32_16x16x32_bf16 v[180:183], a[152:155], v[88:91], v[180:183]
    ds_read_b128 a[200:203], v3 offset:2048
    v_mfma_f32_16x16x32_bf16 v[180:183], a[156:159], v[92:95], v[180:183]
    v_exp_f32 v238, v158
    v_mfma_f32_16x16x32_bf16 v[184:187], a[144:147], v[96:99], v[40:43]
    v_cvt_pk_bf16_f32 v206, v236, v237
    v_mfma_f32_16x16x32_bf16 v[184:187], a[148:151], v[100:103], v[184:187]
    v_exp_f32 v239, v159
    v_mfma_f32_16x16x32_bf16 v[184:187], a[152:155], v[104:107], v[184:187]
    ds_read_b128 a[204:207], v3 offset:3072
    v_or3_b32 v57, v57, v205, v206
    v_mfma_f32_16x16x32_bf16 v[184:187], a[156:159], v[108:111], v[184:187]
    v_cvt_pk_bf16_f32 v207, v238, v239
    v_mfma_f32_16x16x32_bf16 v[188:191], a[144:147], v[112:115], v[44:47]
    v_mfma_f32_16x16x32_bf16 v[188:191], a[148:151], v[116:119], v[188:191]
    v_bitop3_b32 v57, v57, v207, s37 bitop3:0xa8
    v_cmp_ne_u32 vcc, 0, v57
    v_mfma_f32_16x16x32_bf16 v[188:191], a[152:155], v[120:123], v[188:191]
    v_mfma_f32_16x16x32_bf16 v[188:191], a[156:159], v[124:127], v[188:191]
    s_waitcnt vmcnt(13)
    s_barrier
    s_cbranch_vccnz k2_tramp_94
k2_ret_95:
    v_mfma_f32_16x16x32_bf16 v[48:51], v[60:63], v[196:199], v[48:51]
    ds_read_b128 a[208:211], v3 offset:4096
    ds_read_b128 a[212:215], v3 offset:5120
    v_mfma_f32_16x16x32_bf16 v[248:251], v[60:63], v[200:203], v[248:251]
    s_mov_b32 m0, s34
    v_exp_f32 v232, v164
    v_mfma_f32_16x16x32_bf16 v[252:255], v[60:63], v[204:207], v[252:255]
    s_waitcnt lgkmcnt(4)
    buffer_load_dwordx4 v1, s[16:19], s32 offen offset:0 sc1 lds
    ds_read_b128 a[216:219], v3 offset:6144
    v_mfma_f32_16x16x32_bf16 a[4:7], a[192:195], v[196:199], a[4:7]
    s_add_u32 s53, s53, 8192
    v_exp_f32 v233, v165
    v_mfma_f32_16x16x32_bf16 a[8:11], a[192:195], v[200:203], a[8:11]
    s_and_b32 s53, s53, 0xffff
    v_mov_b32 v16, v10
    v_mov_b32 v17, v10
    v_mfma_f32_16x16x32_bf16 a[12:15], a[192:195], v[204:207], a[12:15]
    s_add_u32 s34, s34, 0x4000
    v_exp_f32 v234, v166
    v_mfma_f32_16x16x32_bf16 a[20:23], a[196:199], v[196:199], a[20:23]
    ds_read_b128 a[220:223], v3 offset:7168
    v_cvt_pk_bf16_f32 v212, v232, v233
    v_mfma_f32_16x16x32_bf16 a[24:27], a[196:199], v[200:203], a[24:27]
    v_mov_b32 v18, v10
    v_mov_b32 v19, v10
    v_mfma_f32_16x16x32_bf16 a[28:31], a[196:199], v[204:207], a[28:31]
    s_waitcnt lgkmcnt(4)
    v_exp_f32 v235, v167
    v_mfma_f32_16x16x32_bf16 a[36:39], a[200:203], v[196:199], a[36:39]
    buffer_load_dwordx4 v1, s[16:19], s32 offen offset:1024 sc1 lds
    ds_read_b128 a[128:131], v2 offset:0
    v_mfma_f32_16x16x32_bf16 a[40:43], a[200:203], v[200:203], a[40:43]
    v_mov_b32 v20, v11
    v_add_u32 v3, s53, v56
    v_mfma_f32_16x16x32_bf16 a[44:47], a[200:203], v[204:207], a[44:47]
    s_and_b32 s34, s34, 0xffff
    v_mov_b32 v21, v11
    v_mov_b32 v22, v11
    v_mfma_f32_16x16x32_bf16 a[52:55], a[204:207], v[196:199], a[52:55]
    v_exp_f32 v236, v180
    v_mfma_f32_16x16x32_bf16 a[56:59], a[204:207], v[200:203], a[56:59]
    ds_read_b128 a[132:135], v2 offset:1024
    v_cvt_pk_bf16_f32 v213, v234, v235
    v_mfma_f32_16x16x32_bf16 a[60:63], a[204:207], v[204:207], a[60:63]
    s_waitcnt lgkmcnt(4)
    v_mov_b32 v23, v11
    v_mov_b32 v32, v10
    v_mfma_f32_16x16x32_bf16 a[68:71], a[208:211], v[196:199], a[68:71]
    v_exp_f32 v237, v181
    v_mfma_f32_16x16x32_bf16 a[72:75], a[208:211], v[200:203], a[72:75]
    ds_read_b128 a[136:139], v2 offset:2048
    v_mov_b32 v33, v10
    v_mfma_f32_16x16x32_bf16 a[76:79], a[208:211], v[204:207], a[76:79]
    buffer_load_dwordx4 v1, s[16:19], s32 offen offset:2048 sc1 lds
    v_mov_b32 v34, v10
    v_mfma_f32_16x16x32_bf16 a[84:87], a[212:215], v[196:199], a[84:87]
    v_exp_f32 v238, v182
    v_mfma_f32_16x16x32_bf16 a[88:91], a[212:215], v[200:203], a[88:91]
    ds_read_b128 a[140:143], v2 offset:3072
    v_cvt_pk_bf16_f32 v214, v236, v237
    v_mfma_f32_16x16x32_bf16 a[92:95], a[212:215], v[204:207], a[92:95]
    s_waitcnt lgkmcnt(4)
    v_mov_b32 v35, v10
    v_mov_b32 v36, v11
    v_mfma_f32_16x16x32_bf16 a[100:103], a[216:219], v[196:199], a[100:103]
    ds_read_b128 a[144:147], v2 offset:4096
    v_exp_f32 v239, v183
    v_mfma_f32_16x16x32_bf16 a[104:107], a[216:219], v[200:203], a[104:107]
    v_mov_b32 v37, v11
    v_or3_b32 v57, v212, v213, v214
    v_mov_b32 v38, v11
    v_mov_b32 v39, v11
    v_mfma_f32_16x16x32_bf16 a[108:111], a[216:219], v[204:207], a[108:111]
    buffer_load_dwordx4 v1, s[16:19], s32 offen offset:3072 sc1 lds
    ds_read_b128 a[148:151], v2 offset:5120
    v_mfma_f32_16x16x32_bf16 a[116:119], a[220:223], v[196:199], a[116:119]
    s_add_u32 s32, s32, 0x80000
    s_cmp_ge_u32 s36, s43
    s_cbranch_scc1 k2_prep_96
k2_prepret_97:
    v_mfma_f32_16x16x32_bf16 a[120:123], a[220:223], v[200:203], a[120:123]
    s_waitcnt vmcnt(8)
    v_exp_f32 v240, v168
    v_mfma_f32_16x16x32_bf16 a[124:127], a[220:223], v[204:207], a[124:127]
    s_waitcnt lgkmcnt(4)
    ds_read_b128 a[152:155], v2 offset:6144
    v_cvt_pk_bf16_f32 v215, v238, v239
    v_mfma_f32_16x16x32_bf16 v[128:131], a[128:131], v[96:99], v[16:19]
    v_exp_f32 v241, v169
    v_mfma_f32_16x16x32_bf16 v[128:131], a[132:135], v[100:103], v[128:131]
    s_waitcnt lgkmcnt(3)
    ds_read_b128 a[156:159], v2 offset:7168
    v_exp_f32 v242, v170
    v_mfma_f32_16x16x32_bf16 v[128:131], a[136:139], v[104:107], v[128:131]
    ds_read_b128 a[160:163], v2 offset:8192
    v_cvt_pk_bf16_f32 v216, v240, v241
    v_mfma_f32_16x16x32_bf16 v[128:131], a[140:143], v[108:111], v[128:131]
    s_add_u32 s36, s36, 64
    buffer_store_dwordx4 a[224:227], v229, s[8:11], s58 offen offset:0 sc1
    v_exp_f32 v243, v171
    v_mfma_f32_16x16x32_bf16 v[132:135], a[128:131], v[112:115], v[20:23]
    ds_read_b128 a[164:167], v2 offset:9216
    v_or3_b32 v57, v57, v215, v216
    v_mfma_f32_16x16x32_bf16 v[132:135], a[132:135], v[116:119], v[132:135]
    v_exp_f32 v244, v184
    v_mfma_f32_16x16x32_bf16 v[132:135], a[136:139], v[120:123], v[132:135]
    s_add_u32 s52, s52, 16384
    ds_read_b128 a[168:171], v2 offset:10240
    v_cvt_pk_bf16_f32 v217, v242, v243
    v_mfma_f32_16x16x32_bf16 v[132:135], a[140:143], v[124:127], v[132:135]
    s_waitcnt lgkmcnt(5)
    v_exp_f32 v245, v185
    v_mfma_f32_16x16x32_bf16 v[144:147], a[144:147], v[96:99], v[32:35]
    s_and_b32 s52, s52, 0xffff
    ds_read_b128 a[172:175], v2 offset:11264
    ds_read_b128 a[176:179], v2 offset:12288
    v_mfma_f32_16x16x32_bf16 v[144:147], a[148:151], v[100:103], v[144:147]
    s_waitcnt lgkmcnt(5)
    v_exp_f32 v246, v186
    v_mfma_f32_16x16x32_bf16 v[144:147], a[152:155], v[104:107], v[144:147]
    ds_read_b128 a[180:183], v2 offset:13312
    v_cvt_pk_bf16_f32 v218, v244, v245
    v_mfma_f32_16x16x32_bf16 v[144:147], a[156:159], v[108:111], v[144:147]
    v_exp_f32 v247, v187
    v_mfma_f32_16x16x32_bf16 v[148:151], a[144:147], v[112:115], v[36:39]
    ds_read_b128 a[184:187], v2 offset:14336
    v_or3_b32 v57, v57, v217, v218
    v_mfma_f32_16x16x32_bf16 v[148:151], a[148:151], v[116:119], v[148:151]
    v_exp_f32 v232, v172
    v_mfma_f32_16x16x32_bf16 v[148:151], a[152:155], v[120:123], v[148:151]
    ds_read_b128 a[188:191], v2 offset:15360
    v_cvt_pk_bf16_f32 v219, v246, v247
    v_mfma_f32_16x16x32_bf16 v[148:151], a[156:159], v[124:127], v[148:151]
    s_waitcnt lgkmcnt(6)
    v_exp_f32 v233, v173
    v_mfma_f32_16x16x32_bf16 v[136:139], a[160:163], v[96:99], v[24:27]
    buffer_store_dwordx4 a[228:231], v229, s[8:11], s58 offen offset:256 sc1
    ds_read_b128 a[192:195], v3 offset:0
    v_mfma_f32_16x16x32_bf16 v[136:139], a[164:167], v[100:103], v[136:139]
    s_waitcnt lgkmcnt(5)
    v_add_u32 v2, s52, v1
    v_cvt_pk_bf16_f32 v220, v232, v233
    v_mfma_f32_16x16x32_bf16 v[136:139], a[168:171], v[104:107], v[136:139]
    v_exp_f32 v234, v174
    v_mfma_f32_16x16x32_bf16 v[136:139], a[172:175], v[108:111], v[136:139]
    v_exp_f32 v235, v175
    v_mfma_f32_16x16x32_bf16 v[140:143], a[160:163], v[112:115], v[28:31]
    ds_read_b128 a[196:199], v3 offset:1024
    v_or3_b32 v57, v57, v219, v220
    v_mfma_f32_16x16x32_bf16 v[140:143], a[164:167], v[116:119], v[140:143]
    v_exp_f32 v236, v188
    v_mfma_f32_16x16x32_bf16 v[140:143], a[168:171], v[120:123], v[140:143]
    ds_read_b128 a[200:203], v3 offset:2048
    v_cvt_pk_bf16_f32 v221, v234, v235
    v_mfma_f32_16x16x32_bf16 v[140:143], a[172:175], v[124:127], v[140:143]
    s_waitcnt lgkmcnt(5)
    v_exp_f32 v237, v189
    v_mfma_f32_16x16x32_bf16 v[152:155], a[176:179], v[96:99], v[40:43]
    v_exp_f32 v238, v190
    v_mfma_f32_16x16x32_bf16 v[152:155], a[180:183], v[100:103], v[152:155]
    s_waitcnt lgkmcnt(3)
    v_cvt_pk_bf16_f32 v222, v236, v237
    v_or3_b32 v57, v57, v221, v222
    v_mfma_f32_16x16x32_bf16 v[152:155], a[184:187], v[104:107], v[152:155]
    v_exp_f32 v239, v191
    v_mfma_f32_16x16x32_bf16 v[152:155], a[188:191], v[108:111], v[152:155]
    ds_read_b128 a[204:207], v3 offset:3072
    v_cvt_pk_bf16_f32 v223, v238, v239
    v_mfma_f32_16x16x32_bf16 v[156:159], a[176:179], v[112:115], v[44:47]
    v_mfma_f32_16x16x32_bf16 v[156:159], a[180:183], v[116:119], v[156:159]
    v_bitop3_b32 v57, v57, v223, s37 bitop3:0xa8
    v_cmp_ne_u32 vcc, 0, v57
    v_mfma_f32_16x16x32_bf16 v[156:159], a[184:187], v[120:123], v[156:159]
    v_mfma_f32_16x16x32_bf16 v[156:159], a[188:191], v[124:127], v[156:159]
    s_cbranch_vccnz k2_tramp_98
k2_ret_99:
    v_mfma_f32_16x16x32_bf16 v[48:51], v[60:63], v[212:215], v[48:51]
    ds_read_b128 a[208:211], v3 offset:4096
    ds_read_b128 a[212:215], v3 offset:5120
    v_mfma_f32_16x16x32_bf16 v[248:251], v[60:63], v[216:219], v[248:251]
    s_mov_b32 m0, s35
    v_exp_f32 v232, v128
    v_mfma_f32_16x16x32_bf16 v[252:255], v[60:63], v[220:223], v[252:255]
    s_waitcnt lgkmcnt(4)
    ds_read_b128 a[216:219], v3 offset:6144
    v_exp_f32 v233, v129
    v_mfma_f32_16x16x32_bf16 a[4:7], a[192:195], v[212:215], a[4:7]
    s_add_u32 s53, s53, 8192
    buffer_load_dwordx4 v1, s[20:23], s33 offen offset:0 sc1 lds
    v_mfma_f32_16x16x32_bf16 a[8:11], a[192:195], v[216:219], a[8:11]
    s_and_b32 s53, s53, 0xffff
    v_exp_f32 v234, v130
    v_cvt_pk_bf16_f32 v192, v232, v233
    v_mfma_f32_16x16x32_bf16 a[12:15], a[192:195], v[220:223], a[12:15]
    ds_read_b128 a[220:223], v3 offset:7168
    v_mfma_f32_16x16x32_bf16 a[20:23], a[196:199], v[212:215], a[20:23]
    s_add_u32 s35, s35, 0x4000
    v_exp_f32 v235, v131
    v_mfma_f32_16x16x32_bf16 a[24:27], a[196:199], v[216:219], a[24:27]
    v_exp_f32 v236, v144
    v_cvt_pk_bf16_f32 v193, v234, v235
    v_mfma_f32_16x16x32_bf16 a[28:31], a[196:199], v[220:223], a[28:31]
    s_waitcnt lgkmcnt(4)
    buffer_load_dwordx4 v1, s[20:23], s33 offen offset:1024 sc1 lds
    ds_read_b128 a[128:131], v2 offset:0
    v_mfma_f32_16x16x32_bf16 a[36:39], a[200:203], v[212:215], a[36:39]
    v_add_u32 v3, s53, v56
    v_exp_f32 v237, v145
    v_mfma_f32_16x16x32_bf16 a[40:43], a[200:203], v[216:219], a[40:43]
    ds_read_b128 a[132:135], v2 offset:1024
    v_cvt_pk_bf16_f32 v194, v236, v237
    v_mfma_f32_16x16x32_bf16 a[44:47], a[200:203], v[220:223], a[44:47]
    ds_read_b128 a[136:139], v2 offset:2048
    v_exp_f32 v238, v146
    v_mfma_f32_16x16x32_bf16 a[52:55], a[204:207], v[212:215], a[52:55]
    s_and_b32 s35, s35, 0xffff
    v_exp_f32 v239, v147
    v_mfma_f32_16x16x32_bf16 a[56:59], a[204:207], v[216:219], a[56:59]
    ds_read_b128 a[140:143], v2 offset:3072
    v_or3_b32 v57, v192, v193, v194
    v_mfma_f32_16x16x32_bf16 a[60:63], a[204:207], v[220:223], a[60:63]
    s_waitcnt lgkmcnt(6)
    v_exp_f32 v240, v132
    v_mfma_f32_16x16x32_bf16 a[68:71], a[208:211], v[212:215], a[68:71]
    s_or_b32 s35, s35, 0x10000
    buffer_load_dwordx4 v1, s[20:23], s33 offen offset:2048 sc1 lds
    ds_read_b128 a[144:147], v2 offset:4096
    v_mfma_f32_16x16x32_bf16 a[72:75], a[208:211], v[216:219], a[72:75]
    v_cvt_pk_bf16_f32 v195, v238, v239
    v_exp_f32 v241, v133
    v_mfma_f32_16x16x32_bf16 a[76:79], a[208:211], v[220:223], a[76:79]
    v_exp_f32 v242, v134
    v_mfma_f32_16x16x32_bf16 a[84:87], a[212:215], v[212:215], a[84:87]
    ds_read_b128 a[148:151], v2 offset:5120
    v_cvt_pk_bf16_f32 v196, v240, v241
    v_mfma_f32_16x16x32_bf16 a[88:91], a[212:215], v[216:219], a[88:91]
    v_exp_f32 v243, v135
    v_mfma_f32_16x16x32_bf16 a[92:95], a[212:215], v[220:223], a[92:95]
    s_waitcnt lgkmcnt(6)
    ds_read_b128 a[152:155], v2 offset:6144
    v_or3_b32 v57, v57, v195, v196
    v_cvt_pk_bf16_f32 v197, v242, v243
    v_mfma_f32_16x16x32_bf16 a[100:103], a[216:219], v[212:215], a[100:103]
    buffer_load_dwordx4 v1, s[20:23], s33 offen offset:3072 sc1 lds
    ds_read_b128 a[156:159], v2 offset:7168
    v_mfma_f32_16x16x32_bf16 a[104:107], a[216:219], v[216:219], a[104:107]
    s_add_u32 s33, s33, 0x80000
    v_exp_f32 v244, v148
    v_mfma_f32_16x16x32_bf16 a[108:111], a[216:219], v[220:223], a[108:111]
    v_exp_f32 v245, v149
    v_mfma_f32_16x16x32_bf16 a[116:119], a[220:223], v[212:215], a[116:119]
    ds_read_b128 a[160:163], v2 offset:8192
    s_cmp_ge_u32 s36, s43
    s_cbranch_scc1 k2_prep_100
k2_prepret_101:
    v_mfma_f32_16x16x32_bf16 a[120:123], a[220:223], v[216:219], a[120:123]
    v_exp_f32 v246, v150
    v_mfma_f32_16x16x32_bf16 a[124:127], a[220:223], v[220:223], a[124:127]
    s_waitcnt lgkmcnt(7)
    ds_read_b128 a[164:167], v2 offset:9216
    v_cvt_pk_bf16_f32 v198, v244, v245
    v_mfma_f32_16x16x32_bf16 v[160:163], a[128:131], v[96:99], v[16:19]
    s_waitcnt vmcnt(12)
    s_barrier
    v_exp_f32 v247, v151
    v_mfma_f32_16x16x32_bf16 v[160:163], a[132:135], v[100:103], v[160:163]
    s_waitcnt lgkmcnt(6)
    v_or3_b32 v57, v57, v197, v198
    v_cvt_pk_bf16_f32 v199, v246, v247
    v_mfma_f32_16x16x32_bf16 v[160:163], a[136:139], v[104:107], v[160:163]
    s_mov_b32 m0, s34
    ds_read_b128 a[168:171], v2 offset:10240
    v_exp_f32 v232, v136
    v_mfma_f32_16x16x32_bf16 v[160:163], a[140:143], v[108:111], v[160:163]
    s_add_u32 s36, s36, 64
    buffer_load_dwordx4 v1, s[16:19], s32 offen offset:0 sc1 lds
    ds_read_b128 a[172:175], v2 offset:11264
    v_mfma_f32_16x16x32_bf16 v[164:167], a[128:131], v[112:115], v[20:23]
    v_exp_f32 v233, v137
    v_mfma_f32_16x16x32_bf16 v[164:167], a[132:135], v[116:119], v[164:167]
    v_exp_f32 v234, v138
    v_mfma_f32_16x16x32_bf16 v[164:167], a[136:139], v[120:123], v[164:167]
    s_add_u32 s52, s52, 16384
    ds_read_b128 a[176:179], v2 offset:12288
    v_cvt_pk_bf16_f32 v200, v232, v233
    v_mfma_f32_16x16x32_bf16 v[164:167], a[140:143], v[124:127], v[164:167]
    s_waitcnt lgkmcnt(7)
    v_exp_f32 v235, v139
    v_or3_b32 v57, v57, v199, v200
    v_mfma_f32_16x16x32_bf16 v[176:179], a[144:147], v[96:99], v[32:35]
    s_add_u32 s34, s34, 0x4000
    ds_read_b128 a[180:183], v2 offset:13312
    v_cvt_pk_bf16_f32 v201, v234, v235
    v_mfma_f32_16x16x32_bf16 v[176:179], a[148:151], v[100:103], v[176:179]
    s_waitcnt lgkmcnt(6)
    v_exp_f32 v236, v152
    v_mfma_f32_16x16x32_bf16 v[176:179], a[152:155], v[104:107], v[176:179]
    s_and_b32 s52, s52, 0xffff
    buffer_load_dwordx4 v1, s[16:19], s32 offen offset:1024 sc1 lds
    ds_read_b128 a[184:187], v2 offset:14336
    v_mfma_f32_16x16x32_bf16 v[176:179], a[156:159], v[108:111], v[176:179]
    ds_read_b128 a[188:191], v2 offset:15360
    v_exp_f32 v237, v153
    v_mfma_f32_16x16x32_bf16 v[180:183], a[144:147], v[112:115], v[36:39]
    v_exp_f32 v238, v154
    v_mfma_f32_16x16x32_bf16 v[180:183], a[148:151], v[116:119], v[180:183]
    v_cvt_pk_bf16_f32 v202, v236, v237
    v_or3_b32 v57, v57, v201, v202
    v_mfma_f32_16x16x32_bf16 v[180:183], a[152:155], v[120:123], v[180:183]
    s_and_b32 s34, s34, 0xffff
    v_exp_f32 v239, v155
    v_mfma_f32_16x16x32_bf16 v[180:183], a[156:159], v[124:127], v[180:183]
    s_waitcnt lgkmcnt(6)
    v_add_u32 v2, s52, v1
    v_cvt_pk_bf16_f32 v203, v238, v239
    v_mfma_f32_16x16x32_bf16 v[168:171], a[160:163], v[96:99], v[24:27]
    ds_read_b128 a[192:195], v3 offset:0
    v_exp_f32 v240, v140
    v_mfma_f32_16x16x32_bf16 v[168:171], a[164:167], v[100:103], v[168:171]
    s_waitcnt lgkmcnt(5)
    v_exp_f32 v241, v141
    v_mfma_f32_16x16x32_bf16 v[168:171], a[168:171], v[104:107], v[168:171]
    buffer_load_dwordx4 v1, s[16:19], s32 offen offset:2048 sc1 lds
    ds_read_b128 a[196:199], v3 offset:8192
    v_mfma_f32_16x16x32_bf16 v[168:171], a[172:175], v[108:111], v[168:171]
    v_exp_f32 v242, v142
    v_mfma_f32_16x16x32_bf16 v[172:175], a[160:163], v[112:115], v[28:31]
    ds_read_b128 a[200:203], v3 offset:1024
    v_cvt_pk_bf16_f32 v204, v240, v241
    v_or3_b32 v57, v57, v203, v204
    v_mfma_f32_16x16x32_bf16 v[172:175], a[164:167], v[116:119], v[172:175]
    v_exp_f32 v243, v143
    v_mfma_f32_16x16x32_bf16 v[172:175], a[168:171], v[120:123], v[172:175]
    ds_read_b128 a[204:207], v3 offset:9216
    v_cvt_pk_bf16_f32 v205, v242, v243
    v_mfma_f32_16x16x32_bf16 v[172:175], a[172:175], v[124:127], v[172:175]
    s_waitcnt lgkmcnt(6)
    v_exp_f32 v244, v156
    v_mfma_f32_16x16x32_bf16 v[184:187], a[176:179], v[96:99], v[40:43]
    v_exp_f32 v245, v157
    v_mfma_f32_16x16x32_bf16 v[184:187], a[180:183], v[100:103], v[184:187]
    s_waitcnt lgkmcnt(4)
    buffer_load_dwordx4 v1, s[16:19], s32 offen offset:3072 sc1 lds
    ds_read_b128 a[208:211], v3 offset:2048
    ds_read_b128 a[212:215], v3 offset:10240
    v_mfma_f32_16x16x32_bf16 v[184:187], a[184:187], v[104:107], v[184:187]
    s_add_u32 s32, s32, 0x80000
    v_exp_f32 v246, v158
    v_mfma_f32_16x16x32_bf16 v[184:187], a[188:191], v[108:111], v[184:187]
    v_cvt_pk_bf16_f32 v206, v244, v245
    v_or3_b32 v57, v57, v205, v206
    v_mfma_f32_16x16x32_bf16 v[188:191], a[176:179], v[112:115], v[44:47]
    v_exp_f32 v247, v159
    v_mfma_f32_16x16x32_bf16 v[188:191], a[180:183], v[116:119], v[188:191]
    ds_read_b128 a[216:219], v3 offset:3072
    ds_read_b128 a[220:223], v3 offset:11264
    v_cvt_pk_bf16_f32 v207, v246, v247
    v_mfma_f32_16x16x32_bf16 v[188:191], a[184:187], v[120:123], v[188:191]
    v_bitop3_b32 v57, v57, v207, s37 bitop3:0xa8
    v_cmp_ne_u32 vcc, 0, v57
    v_mfma_f32_16x16x32_bf16 v[188:191], a[188:191], v[124:127], v[188:191]
    s_cbranch_vccnz k2_tramp_102
k2_ret_103:
    s_load_dwordx2 s[4:5], s[0:1], 40
    s_add_u32 s24, s6, 0x3000000
    s_addc_u32 s25, s7, 0
    s_and_b32 s25, s25, 0xffff
    s_mov_b32 s26, 0x1000000
    s_mov_b32 s27, 0x00020000
    s_lshl_b32 s31, s28, 19
    s_lshl_b32 s44, s38, 6
    s_add_u32 s44, s44, s31
    s_add_u32 s45, s44, 131072
    s_add_u32 s46, s44, 262144
    s_add_u32 s47, s44, 393216
    s_add_u32 s48, s44, 4096
    s_add_u32 s49, s44, 135168
    s_add_u32 s50, s44, 266240
    s_add_u32 s51, s44, 397312
    v_mov_b32 v13, v12
    v_mov_b32 v49, v48
    s_nop 1
    v_permlane16_swap_b32 v12, v13
    v_permlane16_swap_b32 v48, v49
    s_nop 1
    v_add_f32 v12, v12, v13
    v_add_f32 v48, v48, v49
    v_mov_b32 v13, v12
    v_mov_b32 v49, v48
    s_nop 1
    v_permlane32_swap_b32 v12, v13
    v_permlane32_swap_b32 v48, v49
    s_nop 1
    v_add_f32 v12, v12, v13
    v_add_f32 v48, v48, v49
    v_rcp_f32 v13, v12
    v_rcp_f32 v49, v48
    v_rcp_f32 v12, v12
    v_rcp_f32 v48, v48
    s_nop 0
    v_accvgpr_read_b32 v68, a0
    v_accvgpr_read_b32 v69, a1
    v_accvgpr_read_b32 v70, a2
    v_accvgpr_read_b32 v71, a3
    v_accvgpr_read_b32 v72, a16
    v_accvgpr_read_b32 v73, a17
    v_accvgpr_read_b32 v74, a18
    v_accvgpr_read_b32 v75, a19
    v_pk_mul_f32 v[68:69], v[68:69], v[12:13]
    v_pk_mul_f32 v[70:71], v[70:71], v[12:13]
    v_pk_mul_f32 v[72:73], v[72:73], v[12:13]
    v_pk_mul_f32 v[74:75], v[74:75], v[12:13]
    v_cvt_pk_bf16_f32 v64, v68, v69
    v_cvt_pk_bf16_f32 v65, v70, v71
    v_cvt_pk_bf16_f32 v66, v72, v73
    v_cvt_pk_bf16_f32 v67, v74, v75
    buffer_store_dwordx4 v[64:67], v1, s[24:27], s44 offen sc1
    v_accvgpr_read_b32 v80, a32
    v_accvgpr_read_b32 v81, a33
    v_accvgpr_read_b32 v82, a34
    v_accvgpr_read_b32 v83, a35
    v_accvgpr_read_b32 v84, a48
    v_accvgpr_read_b32 v85, a49
    v_accvgpr_read_b32 v86, a50
    v_accvgpr_read_b32 v87, a51
    v_pk_mul_f32 v[80:81], v[80:81], v[12:13]
    v_pk_mul_f32 v[82:83], v[82:83], v[12:13]
    v_pk_mul_f32 v[84:85], v[84:85], v[12:13]
    v_pk_mul_f32 v[86:87], v[86:87], v[12:13]
    v_cvt_pk_bf16_f32 v76, v80, v81
    v_cvt_pk_bf16_f32 v77, v82, v83
    v_cvt_pk_bf16_f32 v78, v84, v85
    v_cvt_pk_bf16_f32 v79, v86, v87
    buffer_store_dwordx4 v[76:79], v1, s[24:27], s45 offen sc1
    v_accvgpr_read_b32 v68, a64
    v_accvgpr_read_b32 v69, a65
    v_accvgpr_read_b32 v70, a66
    v_accvgpr_read_b32 v71, a67
    v_accvgpr_read_b32 v72, a80
    v_accvgpr_read_b32 v73, a81
    v_accvgpr_read_b32 v74, a82
    v_accvgpr_read_b32 v75, a83
    v_pk_mul_f32 v[68:69], v[68:69], v[12:13]
    v_pk_mul_f32 v[70:71], v[70:71], v[12:13]
    v_pk_mul_f32 v[72:73], v[72:73], v[12:13]
    v_pk_mul_f32 v[74:75], v[74:75], v[12:13]
    v_cvt_pk_bf16_f32 v64, v68, v69
    v_cvt_pk_bf16_f32 v65, v70, v71
    v_cvt_pk_bf16_f32 v66, v72, v73
    v_cvt_pk_bf16_f32 v67, v74, v75
    buffer_store_dwordx4 v[64:67], v1, s[24:27], s46 offen sc1
    v_accvgpr_read_b32 v80, a96
    v_accvgpr_read_b32 v81, a97
    v_accvgpr_read_b32 v82, a98
    v_accvgpr_read_b32 v83, a99
    v_accvgpr_read_b32 v84, a112
    v_accvgpr_read_b32 v85, a113
    v_accvgpr_read_b32 v86, a114
    v_accvgpr_read_b32 v87, a115
    v_pk_mul_f32 v[80:81], v[80:81], v[12:13]
    v_pk_mul_f32 v[82:83], v[82:83], v[12:13]
    v_pk_mul_f32 v[84:85], v[84:85], v[12:13]
    v_pk_mul_f32 v[86:87], v[86:87], v[12:13]
    v_cvt_pk_bf16_f32 v76, v80, v81
    v_cvt_pk_bf16_f32 v77, v82, v83
    v_cvt_pk_bf16_f32 v78, v84, v85
    v_cvt_pk_bf16_f32 v79, v86, v87
    buffer_store_dwordx4 v[76:79], v1, s[24:27], s47 offen sc1
    v_accvgpr_read_b32 v68, a4
    v_accvgpr_read_b32 v69, a5
    v_accvgpr_read_b32 v70, a6
    v_accvgpr_read_b32 v71, a7
    v_accvgpr_read_b32 v72, a20
    v_accvgpr_read_b32 v73, a21
    v_accvgpr_read_b32 v74, a22
    v_accvgpr_read_b32 v75, a23
    v_pk_mul_f32 v[68:69], v[68:69], v[48:49]
    v_pk_mul_f32 v[70:71], v[70:71], v[48:49]
    v_pk_mul_f32 v[72:73], v[72:73], v[48:49]
    v_pk_mul_f32 v[74:75], v[74:75], v[48:49]
    v_cvt_pk_bf16_f32 v64, v68, v69
    v_cvt_pk_bf16_f32 v65, v70, v71
    v_cvt_pk_bf16_f32 v66, v72, v73
    v_cvt_pk_bf16_f32 v67, v74, v75
    buffer_store_dwordx4 v[64:67], v1, s[24:27], s48 offen sc1
    v_accvgpr_read_b32 v80, a36
    v_accvgpr_read_b32 v81, a37
    v_accvgpr_read_b32 v82, a38
    v_accvgpr_read_b32 v83, a39
    v_accvgpr_read_b32 v84, a52
    v_accvgpr_read_b32 v85, a53
    v_accvgpr_read_b32 v86, a54
    v_accvgpr_read_b32 v87, a55
    v_pk_mul_f32 v[80:81], v[80:81], v[48:49]
    v_pk_mul_f32 v[82:83], v[82:83], v[48:49]
    v_pk_mul_f32 v[84:85], v[84:85], v[48:49]
    v_pk_mul_f32 v[86:87], v[86:87], v[48:49]
    v_cvt_pk_bf16_f32 v76, v80, v81
    v_cvt_pk_bf16_f32 v77, v82, v83
    v_cvt_pk_bf16_f32 v78, v84, v85
    v_cvt_pk_bf16_f32 v79, v86, v87
    buffer_store_dwordx4 v[76:79], v1, s[24:27], s49 offen sc1
    v_accvgpr_read_b32 v68, a68
    v_accvgpr_read_b32 v69, a69
    v_accvgpr_read_b32 v70, a70
    v_accvgpr_read_b32 v71, a71
    v_accvgpr_read_b32 v72, a84
    v_accvgpr_read_b32 v73, a85
    v_accvgpr_read_b32 v74, a86
    v_accvgpr_read_b32 v75, a87
    v_pk_mul_f32 v[68:69], v[68:69], v[48:49]
    v_pk_mul_f32 v[70:71], v[70:71], v[48:49]
    v_pk_mul_f32 v[72:73], v[72:73], v[48:49]
    v_pk_mul_f32 v[74:75], v[74:75], v[48:49]
    v_cvt_pk_bf16_f32 v64, v68, v69
    v_cvt_pk_bf16_f32 v65, v70, v71
    v_cvt_pk_bf16_f32 v66, v72, v73
    v_cvt_pk_bf16_f32 v67, v74, v75
    buffer_store_dwordx4 v[64:67], v1, s[24:27], s50 offen sc1
    v_accvgpr_read_b32 v80, a100
    v_accvgpr_read_b32 v81, a101
    v_accvgpr_read_b32 v82, a102
    v_accvgpr_read_b32 v83, a103
    v_accvgpr_read_b32 v84, a116
    v_accvgpr_read_b32 v85, a117
    v_accvgpr_read_b32 v86, a118
    v_accvgpr_read_b32 v87, a119
    v_pk_mul_f32 v[80:81], v[80:81], v[48:49]
    v_pk_mul_f32 v[82:83], v[82:83], v[48:49]
    v_pk_mul_f32 v[84:85], v[84:85], v[48:49]
    v_pk_mul_f32 v[86:87], v[86:87], v[48:49]
    v_cvt_pk_bf16_f32 v76, v80, v81
    v_cvt_pk_bf16_f32 v77, v82, v83
    v_cvt_pk_bf16_f32 v78, v84, v85
    v_cvt_pk_bf16_f32 v79, v86, v87
    buffer_store_dwordx4 v[76:79], v1, s[24:27], s51 offen sc1
    s_nop 1
    s_lshr_b32 s31, s2, 3
    s_bfe_u32 s56, s2, 0x10002
    s_and_b32 s54, s2, 1
    s_lshl_b32 s54, s54, 3
    s_and_b32 s55, s31, 7
    s_add_u32 s54, s54, s55
    s_and_b32 s55, s2, 2
    s_lshl_b32 s55, s55, 1
    s_lshr_b32 s31, s31, 3
    s_add_u32 s55, s55, s31
    v_lshrrev_b32 v87, 4, v1
    v_lshrrev_b32 v72, 4, v87
    s_lshl_b32 s57, s54, 7
    s_lshl_b32 s31, s30, 5
    s_add_u32 s57, s57, s31
    s_lshl_b32 s31, s57, 6
    v_add_u32 v88, s31, v1
    v_add_u32 v89, 0x20000, v88
    v_bfe_u32 v84, v87, 1, 3
    v_xor_b32 v84, v84, v72
    v_and_b32 v85, 16, v1
    v_lshl_add_u32 v85, v72, 11, v85
    s_lshl_b32 s31, s30, 15
    s_lshl_b32 s58, s55, 8
    s_add_u32 s31, s31, s58
    v_add_u32 v85, s31, v85
    v_xor_b32 v86, 0, v84
    v_lshl_add_u32 v86, v86, 5, v85
    v_add_u32 v90, 0, v86
    v_xor_b32 v86, 4, v84
    v_lshl_add_u32 v86, v86, 5, v85
    v_add_u32 v91, 7168, v86
    v_xor_b32 v86, 0, v84
    v_lshl_add_u32 v86, v86, 5, v85
    v_add_u32 v92, 14336, v86
    v_xor_b32 v86, 4, v84
    v_lshl_add_u32 v86, v86, 5, v85
    v_add_u32 v93, 21504, v86
    v_and_b32 v84, 15, v87
    v_add_u32 v85, s57, v84
    v_lshlrev_b32 v77, 2, v85
    v_lshl_add_u32 v77, v72, 13, v77
    s_lshl_b32 s31, s56, 7
    s_add_u32 s58, s58, s31
    v_lshl_add_u32 v80, v72, 3, s58
    v_lshl_add_u32 v78, v85, 11, v80
    v_add_u32 v79, 0x8000, v78
    v_lshrrev_b32 v85, 2, v84
    v_lshl_add_u32 v85, v72, 2, v85
    v_and_b32 v84, 7, v85
    s_lshl_b32 s31, s56, 2
    v_xor_b32 v84, s31, v84
    v_lshlrev_b32 v85, 8, v85
    v_and_b32 v86, 3, v87
    v_lshl_add_u32 v85, v86, 3, v85
    s_add_u32 s31, s2, 1
    s_and_b32 s31, s31, 3
    v_add_u32 v73, s31, v86
    v_and_b32 v73, 3, v73
    v_lshlrev_b32 v73, 7, v73
    v_xor_b32 v86, 0, v84
    v_lshl_add_u32 v64, v86, 5, v85
    v_xor_b32 v86, 1, v84
    v_lshl_add_u32 v65, v86, 5, v85
    v_xor_b32 v86, 2, v84
    v_lshl_add_u32 v66, v86, 5, v85
    v_xor_b32 v86, 3, v84
    v_lshl_add_u32 v67, v86, 5, v85
    v_xor_b32 v86, 4, v84
    v_lshl_add_u32 v68, v86, 5, v85
    v_xor_b32 v86, 5, v84
    v_lshl_add_u32 v69, v86, 5, v85
    v_xor_b32 v86, 6, v84
    v_lshl_add_u32 v70, v86, 5, v85
    v_xor_b32 v86, 7, v84
    v_lshl_add_u32 v71, v86, 5, v85
    s_lshl_b32 s61, s31, 20
    s_lshl_b32 s62, s31, 21
    s_lshl_b32 s60, s30, 12
    s_lshl_b32 s59, s54, 10
    s_lshl_b32 s31, s56, 9
    s_add_u32 s59, s59, s31
    s_lshr_b32 s31, s28, 2
    s_lshl_b32 s31, s31, 7
    s_lshl_b32 s57, s29, 10
    s_sub_u32 s58, 0x3c00, s57
    s_add_u32 s57, s57, s31
    s_add_u32 s58, s58, s31
    v_mov_b32 v75, 0
    v_mov_b32 v76, 1
    s_lshl_b32 s31, s56, 23
    s_add_u32 s31, s31, 0x3000000
    s_add_u32 s8, s6, s31
    s_addc_u32 s9, s7, 0
    s_and_b32 s9, s9, 0xffff
    s_mov_b32 s10, 0x800000
    s_lshl_b32 s31, s56, 22
    s_waitcnt lgkmcnt(0)
    s_add_u32 s12, s4, s31
    s_addc_u32 s13, s5, 0
    s_and_b32 s13, s13, 0xffff
    s_mov_b32 s14, 0x400000
    s_load_dwordx2 s[4:5], s[0:1], 80
    v_mov_b32 v12, -1
    v_mov_b32 v13, -1
    v_mov_b32 v14, -1
    v_mov_b32 v15, -1
    s_waitcnt lgkmcnt(0)
    s_mov_b32 s26, -1
    s_lshl_b32 s31, s2, 14
    s_add_u32 s31, s31, s60
    s_add_u32 s40, s31, 0x2000000
    buffer_store_dwordx4 v[12:15], v1, s[24:27], s40 offen offset:0 sc1
    buffer_store_dwordx4 v[12:15], v1, s[24:27], s40 offen offset:1024 sc1
    buffer_store_dwordx4 v[12:15], v1, s[24:27], s40 offen offset:2048 sc1
    buffer_store_dwordx4 v[12:15], v1, s[24:27], s40 offen offset:3072 sc1
    s_lshr_b32 s31, s31, 1
    s_add_u32 s40, s31, 0x1900000
    buffer_store_dwordx4 v[12:15], v1, s[24:27], s40 offen offset:0 sc1
    buffer_store_dwordx4 v[12:15], v1, s[24:27], s40 offen offset:1024 sc1
    s_mov_b32 s26, 0x1000000
    s_and_b32 s31, s2, 7
    s_mul_i32 s31, s31, 28
    s_lshr_b32 s40, s2, 3
    s_add_u32 s31, s31, s40
    s_lshl_b32 s31, s31, 15
    s_lshl_b32 s40, s30, 13
    s_add_u32 s31, s31, s40
    s_mov_b32 s44, s4
    s_mov_b32 s47, 0x00020000
    s_and_b32 s45, s5, 0xffff
    s_cmp_ge_u32 s2, 224
    s_cselect_b32 s46, 0, 7340032
    s_add_u32 m0, s40, 131072
    s_nop 0
    buffer_load_dwordx4 v1, s[44:47], s31 offen offset:0 lds
    buffer_load_dwordx4 v1, s[44:47], s31 offen offset:1024 lds
    buffer_load_dwordx4 v1, s[44:47], s31 offen offset:2048 lds
    buffer_load_dwordx4 v1, s[44:47], s31 offen offset:3072 lds
    s_add_u32 s31, s31, 4096
    s_add_u32 m0, s40, 135168
    s_nop 0
    buffer_load_dwordx4 v1, s[44:47], s31 offen offset:0 lds
    buffer_load_dwordx4 v1, s[44:47], s31 offen offset:1024 lds
    buffer_load_dwordx4 v1, s[44:47], s31 offen offset:2048 lds
    buffer_load_dwordx4 v1, s[44:47], s31 offen offset:3072 lds
    s_add_u32 s31, s31, 4096
    s_lshl_b32 s63, s29, 1
    s_sub_u32 s63, 13, s63
    s_cbranch_scc1 k2_sdone_105
k2_sloop_104:
    v_mfma_f32_16x16x32_bf16 v[248:251], v[60:63], v[192:195], v[248:251]
    v_exp_f32 v232, v160
    v_mfma_f32_16x16x32_bf16 v[248:251], v[60:63], v[200:203], v[248:251]
    s_mov_b32 m0, s35
    ds_read_b128 a[224:227], v3 offset:4096
    v_mfma_f32_16x16x32_bf16 v[252:255], v[60:63], v[196:199], v[252:255]
    s_add_u32 s53, s53, 16384
    buffer_load_dwordx4 v1, s[20:23], s33 offen offset:0 sc1 lds
    ds_read_b128 a[228:231], v3 offset:12288
    v_mfma_f32_16x16x32_bf16 v[252:255], v[60:63], v[204:207], v[252:255]
    s_waitcnt lgkmcnt(8)
    v_exp_f32 v233, v161
    v_mfma_f32_16x16x32_bf16 a[8:11], a[192:195], v[192:195], a[8:11]
    s_and_b32 s53, s53, 0xffff
    v_exp_f32 v234, v162
    v_mfma_f32_16x16x32_bf16 a[8:11], a[196:199], v[200:203], a[8:11]
    ds_read_b128 a[232:235], v3 offset:5120
    v_cvt_pk_bf16_f32 v208, v232, v233
    v_mfma_f32_16x16x32_bf16 a[12:15], a[192:195], v[196:199], a[12:15]
    v_exp_f32 v235, v163
    v_mfma_f32_16x16x32_bf16 a[12:15], a[196:199], v[204:207], a[12:15]
    s_waitcnt lgkmcnt(7)
    ds_read_b128 a[236:239], v3 offset:13312
    v_cvt_pk_bf16_f32 v209, v234, v235
    v_mfma_f32_16x16x32_bf16 a[24:27], a[200:203], v[192:195], a[24:27]
    s_add_u32 s35, s35, 0x4000
    v_exp_f32 v236, v176
    v_mfma_f32_16x16x32_bf16 a[24:27], a[204:207], v[200:203], a[24:27]
    buffer_load_dwordx4 v1, s[20:23], s33 offen offset:1024 sc1 lds
    ds_read_b128 a[240:243], v3 offset:6144
    v_mfma_f32_16x16x32_bf16 a[28:31], a[200:203], v[196:199], a[28:31]
    v_exp_f32 v237, v177
    v_mfma_f32_16x16x32_bf16 a[28:31], a[204:207], v[204:207], a[28:31]
    s_waitcnt lgkmcnt(7)
    ds_read_b128 a[244:247], v3 offset:14336
    v_cvt_pk_bf16_f32 v210, v236, v237
    v_mfma_f32_16x16x32_bf16 a[40:43], a[208:211], v[192:195], a[40:43]
    v_exp_f32 v238, v178
    v_mfma_f32_16x16x32_bf16 a[40:43], a[212:215], v[200:203], a[40:43]
    ds_read_b128 a[248:251], v3 offset:7168
    v_or3_b32 v57, v208, v209, v210
    v_mfma_f32_16x16x32_bf16 a[44:47], a[208:211], v[196:199], a[44:47]
    v_exp_f32 v239, v179
    v_mfma_f32_16x16x32_bf16 a[44:47], a[212:215], v[204:207], a[44:47]
    s_waitcnt lgkmcnt(7)
    ds_read_b128 a[252:255], v3 offset:15360
    v_cvt_pk_bf16_f32 v211, v238, v239
    v_mfma_f32_16x16x32_bf16 a[56:59], a[216:219], v[192:195], a[56:59]
    s_and_b32 s35, s35, 0xffff
    v_exp_f32 v240, v164
    v_mfma_f32_16x16x32_bf16 a[56:59], a[220:223], v[200:203], a[56:59]
    ds_read_b128 a[128:131], v2 offset:0
    v_add_u32 v3, s53, v56
    v_mfma_f32_16x16x32_bf16 a[60:63], a[216:219], v[196:199], a[60:63]
    v_exp_f32 v241, v165
    v_mfma_f32_16x16x32_bf16 a[60:63], a[220:223], v[204:207], a[60:63]
    s_waitcnt lgkmcnt(7)
    buffer_load_dwordx4 v1, s[20:23], s33 offen offset:2048 sc1 lds
    ds_read_b128 a[132:135], v2 offset:1024
    v_mfma_f32_16x16x32_bf16 a[72:75], a[224:227], v[192:195], a[72:75]
    v_exp_f32 v242, v166
    v_mfma_f32_16x16x32_bf16 a[72:75], a[228:231], v[200:203], a[72:75]
    s_or_b32 s35, s35, 0x10000
    ds_read_b128 a[136:139], v2 offset:2048
    v_cvt_pk_bf16_f32 v212, v240, v241
    v_mfma_f32_16x16x32_bf16 a[76:79], a[224:227], v[196:199], a[76:79]
    v_exp_f32 v243, v167
    v_mfma_f32_16x16x32_bf16 a[76:79], a[228:231], v[204:207], a[76:79]
    s_waitcnt lgkmcnt(7)
    ds_read_b128 a[140:143], v2 offset:3072
    v_or3_b32 v57, v57, v211, v212
    v_mfma_f32_16x16x32_bf16 a[88:91], a[232:235], v[192:195], a[88:91]
    v_exp_f32 v244, v180
    v_mfma_f32_16x16x32_bf16 a[88:91], a[236:239], v[200:203], a[88:91]
    ds_read_b128 a[144:147], v2 offset:4096
    v_cvt_pk_bf16_f32 v213, v242, v243
    v_mfma_f32_16x16x32_bf16 a[92:95], a[232:235], v[196:199], a[92:95]
    v_exp_f32 v245, v181
    v_mfma_f32_16x16x32_bf16 a[92:95], a[236:239], v[204:207], a[92:95]
    s_waitcnt lgkmcnt(7)
    buffer_load_dwordx4 v1, s[20:23], s33 offen offset:3072 sc1 lds
    ds_read_b128 a[148:151], v2 offset:5120
    v_mfma_f32_16x16x32_bf16 a[104:107], a[240:243], v[192:195], a[104:107]
    s_add_u32 s33, s33, 0x80000
    v_exp_f32 v246, v182
    v_mfma_f32_16x16x32_bf16 a[104:107], a[244:247], v[200:203], a[104:107]
    ds_read_b128 a[152:155], v2 offset:6144
    v_cvt_pk_bf16_f32 v214, v244, v245
    v_mfma_f32_16x16x32_bf16 a[108:111], a[240:243], v[196:199], a[108:111]
    v_exp_f32 v247, v183
    v_mfma_f32_16x16x32_bf16 a[108:111], a[244:247], v[204:207], a[108:111]
    s_waitcnt lgkmcnt(7)
    ds_read_b128 a[156:159], v2 offset:7168
    v_or3_b32 v57, v57, v213, v214
    v_mfma_f32_16x16x32_bf16 a[120:123], a[248:251], v[192:195], a[120:123]
    v_exp_f32 v232, v168
    v_mfma_f32_16x16x32_bf16 a[120:123], a[252:255], v[200:203], a[120:123]
    ds_read_b128 a[160:163], v2 offset:8192
    v_cvt_pk_bf16_f32 v215, v246, v247
    v_mfma_f32_16x16x32_bf16 a[124:127], a[248:251], v[196:199], a[124:127]
    v_exp_f32 v233, v169
    v_mfma_f32_16x16x32_bf16 a[124:127], a[252:255], v[204:207], a[124:127]
    s_waitcnt lgkmcnt(7)
    ds_read_b128 a[164:167], v2 offset:9216
    v_cvt_pk_bf16_f32 v216, v232, v233
    v_mfma_f32_16x16x32_bf16 v[128:131], a[128:131], v[96:99], v[16:19]
    s_waitcnt vmcnt(12)
    s_barrier
    v_exp_f32 v234, v170
    v_mfma_f32_16x16x32_bf16 v[128:131], a[132:135], v[100:103], v[128:131]
    s_waitcnt lgkmcnt(6)
    ds_read_b128 a[168:171], v2 offset:10240
    v_or3_b32 v57, v57, v215, v216
    v_mfma_f32_16x16x32_bf16 v[128:131], a[136:139], v[104:107], v[128:131]
    s_mov_b32 m0, s34
    v_exp_f32 v235, v171
    v_mfma_f32_16x16x32_bf16 v[128:131], a[140:143], v[108:111], v[128:131]
    s_add_u32 s36, s36, 64
    buffer_load_dwordx4 v1, s[16:19], s32 offen offset:0 sc1 lds
    ds_read_b128 a[172:175], v2 offset:11264
    v_mfma_f32_16x16x32_bf16 v[132:135], a[128:131], v[112:115], v[20:23]
    v_exp_f32 v236, v184
    v_mfma_f32_16x16x32_bf16 v[132:135], a[132:135], v[116:119], v[132:135]
    ds_read_b128 a[176:179], v2 offset:12288
    v_cvt_pk_bf16_f32 v217, v234, v235
    v_mfma_f32_16x16x32_bf16 v[132:135], a[136:139], v[120:123], v[132:135]
    s_add_u32 s52, s52, 16384
    v_exp_f32 v237, v185
    v_mfma_f32_16x16x32_bf16 v[132:135], a[140:143], v[124:127], v[132:135]
    s_waitcnt lgkmcnt(7)
    ds_read_b128 a[180:183], v2 offset:13312
    v_cvt_pk_bf16_f32 v218, v236, v237
    v_mfma_f32_16x16x32_bf16 v[144:147], a[144:147], v[96:99], v[32:35]
    s_add_u32 s34, s34, 0x4000
    v_exp_f32 v238, v186
    v_mfma_f32_16x16x32_bf16 v[144:147], a[148:151], v[100:103], v[144:147]
    s_waitcnt lgkmcnt(6)
    buffer_load_dwordx4 v1, s[16:19], s32 offen offset:1024 sc1 lds
    ds_read_b128 a[184:187], v2 offset:14336
    v_mfma_f32_16x16x32_bf16 v[144:147], a[152:155], v[104:107], v[144:147]
    s_and_b32 s52, s52, 0xffff
    v_exp_f32 v239, v187
    v_mfma_f32_16x16x32_bf16 v[144:147], a[156:159], v[108:111], v[144:147]
    ds_read_b128 a[188:191], v2 offset:15360
    v_or3_b32 v57, v57, v217, v218
    v_mfma_f32_16x16x32_bf16 v[148:151], a[144:147], v[112:115], v[36:39]
    v_exp_f32 v240, v172
    v_mfma_f32_16x16x32_bf16 v[148:151], a[148:151], v[116:119], v[148:151]
    v_cvt_pk_bf16_f32 v219, v238, v239
    v_add_u32 v2, s52, v1
    v_mfma_f32_16x16x32_bf16 v[148:151], a[152:155], v[120:123], v[148:151]
    s_and_b32 s34, s34, 0xffff
    v_exp_f32 v241, v173
    v_mfma_f32_16x16x32_bf16 v[148:151], a[156:159], v[124:127], v[148:151]
    s_waitcnt lgkmcnt(6)
    ds_read_b128 a[192:195], v3 offset:0
    v_cvt_pk_bf16_f32 v220, v240, v241
    v_mfma_f32_16x16x32_bf16 v[136:139], a[160:163], v[96:99], v[24:27]
    v_exp_f32 v242, v174
    v_mfma_f32_16x16x32_bf16 v[136:139], a[164:167], v[100:103], v[136:139]
    s_waitcnt lgkmcnt(5)
    buffer_load_dwordx4 v1, s[16:19], s32 offen offset:2048 sc1 lds
    ds_read_b128 a[196:199], v3 offset:8192
    v_mfma_f32_16x16x32_bf16 v[136:139], a[168:171], v[104:107], v[136:139]
    v_exp_f32 v243, v175
    v_mfma_f32_16x16x32_bf16 v[136:139], a[172:175], v[108:111], v[136:139]
    ds_read_b128 a[200:203], v3 offset:1024
    v_or3_b32 v57, v57, v219, v220
    v_mfma_f32_16x16x32_bf16 v[140:143], a[160:163], v[112:115], v[28:31]
    v_exp_f32 v244, v188
    v_mfma_f32_16x16x32_bf16 v[140:143], a[164:167], v[116:119], v[140:143]
    ds_read_b128 a[204:207], v3 offset:9216
    v_cvt_pk_bf16_f32 v221, v242, v243
    v_mfma_f32_16x16x32_bf16 v[140:143], a[168:171], v[120:123], v[140:143]
    v_exp_f32 v245, v189
    v_mfma_f32_16x16x32_bf16 v[140:143], a[172:175], v[124:127], v[140:143]
    s_waitcnt lgkmcnt(6)
    buffer_load_dwordx4 v1, s[16:19], s32 offen offset:3072 sc1 lds
    ds_read_b128 a[208:211], v3 offset:2048
    v_mfma_f32_16x16x32_bf16 v[152:155], a[176:179], v[96:99], v[40:43]
    s_add_u32 s32, s32, 0x80000
    v_exp_f32 v246, v190
    v_mfma_f32_16x16x32_bf16 v[152:155], a[180:183], v[100:103], v[152:155]
    s_waitcnt lgkmcnt(5)
    ds_read_b128 a[212:215], v3 offset:10240
    v_cvt_pk_bf16_f32 v222, v244, v245
    v_mfma_f32_16x16x32_bf16 v[152:155], a[184:187], v[104:107], v[152:155]
    v_exp_f32 v247, v191
    v_mfma_f32_16x16x32_bf16 v[152:155], a[188:191], v[108:111], v[152:155]
    ds_read_b128 a[216:219], v3 offset:3072
    v_or3_b32 v57, v57, v221, v222
    v_mfma_f32_16x16x32_bf16 v[156:159], a[176:179], v[112:115], v[44:47]
    ds_read_b128 a[220:223], v3 offset:11264
    v_cvt_pk_bf16_f32 v223, v246, v247
    v_mfma_f32_16x16x32_bf16 v[156:159], a[180:183], v[116:119], v[156:159]
    v_bitop3_b32 v57, v57, v223, s37 bitop3:0xa8
    v_cmp_ne_u32 vcc, 0, v57
    v_mfma_f32_16x16x32_bf16 v[156:159], a[184:187], v[120:123], v[156:159]
    v_mfma_f32_16x16x32_bf16 v[156:159], a[188:191], v[124:127], v[156:159]
    s_cbranch_vccnz k2_tramp_106
k2_ret_107:
    v_mfma_f32_16x16x32_bf16 v[248:251], v[60:63], v[208:211], v[248:251]
    v_exp_f32 v232, v128
    v_mfma_f32_16x16x32_bf16 v[248:251], v[60:63], v[216:219], v[248:251]
    s_mov_b32 m0, s35
    ds_read_b128 a[224:227], v3 offset:4096
    v_mfma_f32_16x16x32_bf16 v[252:255], v[60:63], v[212:215], v[252:255]
    s_add_u32 s53, s53, 16384
    buffer_load_dwordx4 v1, s[20:23], s33 offen offset:0 sc1 lds
    ds_read_b128 a[228:231], v3 offset:12288
    v_mfma_f32_16x16x32_bf16 v[252:255], v[60:63], v[220:223], v[252:255]
    s_waitcnt lgkmcnt(8)
    v_exp_f32 v233, v129
    v_mfma_f32_16x16x32_bf16 a[8:11], a[192:195], v[208:211], a[8:11]
    s_and_b32 s53, s53, 0xffff
    v_exp_f32 v234, v130
    v_mfma_f32_16x16x32_bf16 a[8:11], a[196:199], v[216:219], a[8:11]
    ds_read_b128 a[232:235], v3 offset:5120
    v_cvt_pk_bf16_f32 v192, v232, v233
    v_mfma_f32_16x16x32_bf16 a[12:15], a[192:195], v[212:215], a[12:15]
    v_exp_f32 v235, v131
    v_mfma_f32_16x16x32_bf16 a[12:15], a[196:199], v[220:223], a[12:15]
    s_waitcnt lgkmcnt(7)
    ds_read_b128 a[236:239], v3 offset:13312
    v_cvt_pk_bf16_f32 v193, v234, v235
    v_mfma_f32_16x16x32_bf16 a[24:27], a[200:203], v[208:211], a[24:27]
    s_add_u32 s35, s35, 0x4000
    v_exp_f32 v236, v144
    v_mfma_f32_16x16x32_bf16 a[24:27], a[204:207], v[216:219], a[24:27]
    buffer_load_dwordx4 v1, s[20:23], s33 offen offset:1024 sc1 lds
    ds_read_b128 a[240:243], v3 offset:6144
    v_mfma_f32_16x16x32_bf16 a[28:31], a[200:203], v[212:215], a[28:31]
    v_exp_f32 v237, v145
    v_mfma_f32_16x16x32_bf16 a[28:31], a[204:207], v[220:223], a[28:31]
    s_waitcnt lgkmcnt(7)
    ds_read_b128 a[244:247], v3 offset:14336
    v_cvt_pk_bf16_f32 v194, v236, v237
    v_mfma_f32_16x16x32_bf16 a[40:43], a[208:211], v[208:211], a[40:43]
    v_exp_f32 v238, v146
    v_mfma_f32_16x16x32_bf16 a[40:43], a[212:215], v[216:219], a[40:43]
    ds_read_b128 a[248:251], v3 offset:7168
    v_or3_b32 v57, v192, v193, v194
    v_mfma_f32_16x16x32_bf16 a[44:47], a[208:211], v[212:215], a[44:47]
    v_exp_f32 v239, v147
    v_mfma_f32_16x16x32_bf16 a[44:47], a[212:215], v[220:223], a[44:47]
    s_waitcnt lgkmcnt(7)
    ds_read_b128 a[252:255], v3 offset:15360
    v_cvt_pk_bf16_f32 v195, v238, v239
    v_mfma_f32_16x16x32_bf16 a[56:59], a[216:219], v[208:211], a[56:59]
    s_and_b32 s35, s35, 0xffff
    v_exp_f32 v240, v132
    v_mfma_f32_16x16x32_bf16 a[56:59], a[220:223], v[216:219], a[56:59]
    ds_read_b128 a[128:131], v2 offset:0
    v_add_u32 v3, s53, v56
    v_mfma_f32_16x16x32_bf16 a[60:63], a[216:219], v[212:215], a[60:63]
    v_exp_f32 v241, v133
    v_mfma_f32_16x16x32_bf16 a[60:63], a[220:223], v[220:223], a[60:63]
    s_waitcnt lgkmcnt(7)
    buffer_load_dwordx4 v1, s[20:23], s33 offen offset:2048 sc1 lds
    ds_read_b128 a[132:135], v2 offset:1024
    v_mfma_f32_16x16x32_bf16 a[72:75], a[224:227], v[208:211], a[72:75]
    v_exp_f32 v242, v134
    v_mfma_f32_16x16x32_bf16 a[72:75], a[228:231], v[216:219], a[72:75]
    s_or_b32 s35, s35, 0x10000
    ds_read_b128 a[136:139], v2 offset:2048
    v_cvt_pk_bf16_f32 v196, v240, v241
    v_mfma_f32_16x16x32_bf16 a[76:79], a[224:227], v[212:215], a[76:79]
    v_exp_f32 v243, v135
    v_mfma_f32_16x16x32_bf16 a[76:79], a[228:231], v[220:223], a[76:79]
    s_waitcnt lgkmcnt(7)
    ds_read_b128 a[140:143], v2 offset:3072
    v_or3_b32 v57, v57, v195, v196
    v_mfma_f32_16x16x32_bf16 a[88:91], a[232:235], v[208:211], a[88:91]
    v_exp_f32 v244, v148
    v_mfma_f32_16x16x32_bf16 a[88:91], a[236:239], v[216:219], a[88:91]
    ds_read_b128 a[144:147], v2 offset:4096
    v_cvt_pk_bf16_f32 v197, v242, v243
    v_mfma_f32_16x16x32_bf16 a[92:95], a[232:235], v[212:215], a[92:95]
    v_exp_f32 v245, v149
    v_mfma_f32_16x16x32_bf16 a[92:95], a[236:239], v[220:223], a[92:95]
    s_waitcnt lgkmcnt(7)
    buffer_load_dwordx4 v1, s[20:23], s33 offen offset:3072 sc1 lds
    ds_read_b128 a[148:151], v2 offset:5120
    v_mfma_f32_16x16x32_bf16 a[104:107], a[240:243], v[208:211], a[104:107]
    s_add_u32 s33, s33, 0x80000
    v_exp_f32 v246, v150
    v_mfma_f32_16x16x32_bf16 a[104:107], a[244:247], v[216:219], a[104:107]
    ds_read_b128 a[152:155], v2 offset:6144
    v_cvt_pk_bf16_f32 v198, v244, v245
    v_mfma_f32_16x16x32_bf16 a[108:111], a[240:243], v[212:215], a[108:111]
    v_exp_f32 v247, v151
    v_mfma_f32_16x16x32_bf16 a[108:111], a[244:247], v[220:223], a[108:111]
    s_waitcnt lgkmcnt(7)
    ds_read_b128 a[156:159], v2 offset:7168
    v_or3_b32 v57, v57, v197, v198
    v_mfma_f32_16x16x32_bf16 a[120:123], a[248:251], v[208:211], a[120:123]
    v_exp_f32 v232, v136
    v_mfma_f32_16x16x32_bf16 a[120:123], a[252:255], v[216:219], a[120:123]
    ds_read_b128 a[160:163], v2 offset:8192
    v_cvt_pk_bf16_f32 v199, v246, v247
    v_mfma_f32_16x16x32_bf16 a[124:127], a[248:251], v[212:215], a[124:127]
    v_exp_f32 v233, v137
    v_mfma_f32_16x16x32_bf16 a[124:127], a[252:255], v[220:223], a[124:127]
    s_waitcnt lgkmcnt(7)
    ds_read_b128 a[164:167], v2 offset:9216
    v_cvt_pk_bf16_f32 v200, v232, v233
    v_mfma_f32_16x16x32_bf16 v[160:163], a[128:131], v[96:99], v[16:19]
    s_waitcnt vmcnt(12)
    s_barrier
    v_exp_f32 v234, v138
    v_mfma_f32_16x16x32_bf16 v[160:163], a[132:135], v[100:103], v[160:163]
    s_waitcnt lgkmcnt(6)
    ds_read_b128 a[168:171], v2 offset:10240
    v_or3_b32 v57, v57, v199, v200
    v_mfma_f32_16x16x32_bf16 v[160:163], a[136:139], v[104:107], v[160:163]
    s_mov_b32 m0, s34
    v_exp_f32 v235, v139
    v_mfma_f32_16x16x32_bf16 v[160:163], a[140:143], v[108:111], v[160:163]
    s_add_u32 s36, s36, 64
    buffer_load_dwordx4 v1, s[16:19], s32 offen offset:0 sc1 lds
    ds_read_b128 a[172:175], v2 offset:11264
    v_mfma_f32_16x16x32_bf16 v[164:167], a[128:131], v[112:115], v[20:23]
    v_exp_f32 v236, v152
    v_mfma_f32_16x16x32_bf16 v[164:167], a[132:135], v[116:119], v[164:167]
    ds_read_b128 a[176:179], v2 offset:12288
    v_cvt_pk_bf16_f32 v201, v234, v235
    v_mfma_f32_16x16x32_bf16 v[164:167], a[136:139], v[120:123], v[164:167]
    s_add_u32 s52, s52, 16384
    v_exp_f32 v237, v153
    v_mfma_f32_16x16x32_bf16 v[164:167], a[140:143], v[124:127], v[164:167]
    s_waitcnt lgkmcnt(7)
    ds_read_b128 a[180:183], v2 offset:13312
    v_cvt_pk_bf16_f32 v202, v236, v237
    v_mfma_f32_16x16x32_bf16 v[176:179], a[144:147], v[96:99], v[32:35]
    s_add_u32 s34, s34, 0x4000
    v_exp_f32 v238, v154
    v_mfma_f32_16x16x32_bf16 v[176:179], a[148:151], v[100:103], v[176:179]
    s_waitcnt lgkmcnt(6)
    buffer_load_dwordx4 v1, s[16:19], s32 offen offset:1024 sc1 lds
    ds_read_b128 a[184:187], v2 offset:14336
    v_mfma_f32_16x16x32_bf16 v[176:179], a[152:155], v[104:107], v[176:179]
    s_and_b32 s52, s52, 0xffff
    v_exp_f32 v239, v155
    v_mfma_f32_16x16x32_bf16 v[176:179], a[156:159], v[108:111], v[176:179]
    ds_read_b128 a[188:191], v2 offset:15360
    v_or3_b32 v57, v57, v201, v202
    v_mfma_f32_16x16x32_bf16 v[180:183], a[144:147], v[112:115], v[36:39]
    v_exp_f32 v240, v140
    v_mfma_f32_16x16x32_bf16 v[180:183], a[148:151], v[116:119], v[180:183]
    v_cvt_pk_bf16_f32 v203, v238, v239
    v_add_u32 v2, s52, v1
    v_mfma_f32_16x16x32_bf16 v[180:183], a[152:155], v[120:123], v[180:183]
    s_and_b32 s34, s34, 0xffff
    v_exp_f32 v241, v141
    v_mfma_f32_16x16x32_bf16 v[180:183], a[156:159], v[124:127], v[180:183]
    s_waitcnt lgkmcnt(6)
    ds_read_b128 a[192:195], v3 offset:0
    v_cvt_pk_bf16_f32 v204, v240, v241
    v_mfma_f32_16x16x32_bf16 v[168:171], a[160:163], v[96:99], v[24:27]
    v_exp_f32 v242, v142
    v_mfma_f32_16x16x32_bf16 v[168:171], a[164:167], v[100:103], v[168:171]
    s_waitcnt lgkmcnt(5)
    buffer_load_dwordx4 v1, s[16:19], s32 offen offset:2048 sc1 lds
    ds_read_b128 a[196:199], v3 offset:8192
    v_mfma_f32_16x16x32_bf16 v[168:171], a[168:171], v[104:107], v[168:171]
    v_exp_f32 v243, v143
    v_mfma_f32_16x16x32_bf16 v[168:171], a[172:175], v[108:111], v[168:171]
    ds_read_b128 a[200:203], v3 offset:1024
    v_or3_b32 v57, v57, v203, v204
    v_mfma_f32_16x16x32_bf16 v[172:175], a[160:163], v[112:115], v[28:31]
    v_exp_f32 v244, v156
    v_mfma_f32_16x16x32_bf16 v[172:175], a[164:167], v[116:119], v[172:175]
    ds_read_b128 a[204:207], v3 offset:9216
    v_cvt_pk_bf16_f32 v205, v242, v243
    v_mfma_f32_16x16x32_bf16 v[172:175], a[168:171], v[120:123], v[172:175]
    v_exp_f32 v245, v157
    v_mfma_f32_16x16x32_bf16 v[172:175], a[172:175], v[124:127], v[172:175]
    s_waitcnt lgkmcnt(6)
    buffer_load_dwordx4 v1, s[16:19], s32 offen offset:3072 sc1 lds
    ds_read_b128 a[208:211], v3 offset:2048
    v_mfma_f32_16x16x32_bf16 v[184:187], a[176:179], v[96:99], v[40:43]
    s_sub_u32 s63, s63, 1
    v_exp_f32 v246, v158
    v_mfma_f32_16x16x32_bf16 v[184:187], a[180:183], v[100:103], v[184:187]
    s_waitcnt lgkmcnt(5)
    ds_read_b128 a[212:215], v3 offset:10240
    v_cvt_pk_bf16_f32 v206, v244, v245
    v_mfma_f32_16x16x32_bf16 v[184:187], a[184:187], v[104:107], v[184:187]
    s_add_u32 s32, s32, 0x80000
    v_exp_f32 v247, v159
    v_mfma_f32_16x16x32_bf16 v[184:187], a[188:191], v[108:111], v[184:187]
    ds_read_b128 a[216:219], v3 offset:3072
    v_or3_b32 v57, v57, v205, v206
    v_mfma_f32_16x16x32_bf16 v[188:191], a[176:179], v[112:115], v[44:47]
    ds_read_b128 a[220:223], v3 offset:11264
    v_cvt_pk_bf16_f32 v207, v246, v247
    v_mfma_f32_16x16x32_bf16 v[188:191], a[180:183], v[116:119], v[188:191]
    v_bitop3_b32 v57, v57, v207, s37 bitop3:0xa8
    v_cmp_ne_u32 vcc, 0, v57
    v_mfma_f32_16x16x32_bf16 v[188:191], a[184:187], v[120:123], v[188:191]
    v_mfma_f32_16x16x32_bf16 v[188:191], a[188:191], v[124:127], v[188:191]
    s_cbranch_vccnz k2_tramp_108
k2_ret_109:
    s_cmp_lg_u32 s63, 0
    s_cbranch_scc1 k2_sloop_104
    v_mfma_f32_16x16x32_bf16 v[248:251], v[60:63], v[192:195], v[248:251]
    v_exp_f32 v232, v160
    v_mfma_f32_16x16x32_bf16 v[248:251], v[60:63], v[200:203], v[248:251]
    s_mov_b32 m0, s35
    ds_read_b128 a[224:227], v3 offset:4096
    v_exp_f32 v233, v161
    v_mfma_f32_16x16x32_bf16 v[252:255], v[60:63], v[196:199], v[252:255]
    s_add_u32 s53, s53, 16384
    buffer_load_dwordx4 v1, s[20:23], s33 offen offset:0 sc1 lds
    ds_read_b128 a[228:231], v3 offset:12288
    v_mfma_f32_16x16x32_bf16 v[252:255], v[60:63], v[204:207], v[252:255]
    s_waitcnt lgkmcnt(8)
    v_exp_f32 v234, v162
    v_cvt_pk_bf16_f32 v208, v232, v233
    v_mfma_f32_16x16x32_bf16 a[8:11], a[192:195], v[192:195], a[8:11]
    s_sub_u32 s40, s36, s39
    ds_read_b128 a[232:235], v3 offset:5120
    v_mfma_f32_16x16x32_bf16 a[8:11], a[196:199], v[200:203], a[8:11]
    s_and_b32 s53, s53, 0xffff
    v_subrev_u32 v6, s40, v4
    v_cmp_gt_i32 s[44:45], 0, v6
    v_mfma_f32_16x16x32_bf16 a[12:15], a[192:195], v[196:199], a[12:15]
    v_exp_f32 v235, v163
    v_cmp_gt_i32 s[46:47], 1, v6
    v_mfma_f32_16x16x32_bf16 a[12:15], a[196:199], v[204:207], a[12:15]
    s_waitcnt lgkmcnt(7)
    ds_read_b128 a[236:239], v3 offset:13312
    v_cmp_gt_i32 s[48:49], 2, v6
    v_cmp_gt_i32 s[50:51], 3, v6
    v_mfma_f32_16x16x32_bf16 a[24:27], a[200:203], v[192:195], a[24:27]
    s_add_u32 s35, s35, 0x4000
    v_exp_f32 v236, v176
    v_mfma_f32_16x16x32_bf16 a[24:27], a[204:207], v[200:203], a[24:27]
    ds_read_b128 a[240:243], v3 offset:6144
    v_cvt_pk_bf16_f32 v209, v234, v235
    v_cndmask_b32 v16, v10, v5, s[44:45]
    v_mfma_f32_16x16x32_bf16 a[28:31], a[200:203], v[196:199], a[28:31]
    v_exp_f32 v237, v177
    v_mfma_f32_16x16x32_bf16 a[28:31], a[204:207], v[204:207], a[28:31]
    s_waitcnt lgkmcnt(7)
    ds_read_b128 a[244:247], v3 offset:14336
    v_cndmask_b32 v17, v10, v5, s[46:47]
    v_cndmask_b32 v18, v10, v5, s[48:49]
    v_mfma_f32_16x16x32_bf16 a[40:43], a[208:211], v[192:195], a[40:43]
    buffer_load_dwordx4 v1, s[20:23], s33 offen offset:1024 sc1 lds
    ds_read_b128 a[248:251], v3 offset:7168
    v_mfma_f32_16x16x32_bf16 a[40:43], a[212:215], v[200:203], a[40:43]
    v_cndmask_b32 v19, v10, v5, s[50:51]
    v_cvt_pk_bf16_f32 v210, v236, v237
    v_mfma_f32_16x16x32_bf16 a[44:47], a[208:211], v[196:199], a[44:47]
    v_exp_f32 v238, v178
    v_cmp_gt_i32 s[44:45], 16, v6
    v_mfma_f32_16x16x32_bf16 a[44:47], a[212:215], v[204:207], a[44:47]
    s_waitcnt lgkmcnt(7)
    v_cmp_gt_i32 s[46:47], 17, v6
    v_cmp_gt_i32 s[48:49], 18, v6
    v_mfma_f32_16x16x32_bf16 a[56:59], a[216:219], v[192:195], a[56:59]
    s_and_b32 s35, s35, 0xffff
    v_exp_f32 v239, v179
    v_mfma_f32_16x16x32_bf16 a[56:59], a[220:223], v[200:203], a[56:59]
    ds_read_b128 a[252:255], v3 offset:15360
    v_or3_b32 v57, v208, v209, v210
    v_cmp_gt_i32 s[50:51], 19, v6
    v_mfma_f32_16x16x32_bf16 a[60:63], a[216:219], v[196:199], a[60:63]
    v_exp_f32 v240, v164
    v_mfma_f32_16x16x32_bf16 a[60:63], a[220:223], v[204:207], a[60:63]
    s_waitcnt lgkmcnt(6)
    v_cndmask_b32 v32, v10, v5, s[44:45]
    v_cvt_pk_bf16_f32 v211, v238, v239
    v_cndmask_b32 v33, v10, v5, s[46:47]
    v_mfma_f32_16x16x32_bf16 a[72:75], a[224:227], v[192:195], a[72:75]
    ds_read_b128 a[128:131], v2 offset:0
    v_cndmask_b32 v34, v10, v5, s[48:49]
    v_mfma_f32_16x16x32_bf16 a[72:75], a[228:231], v[200:203], a[72:75]
    s_or_b32 s35, s35, 0x10000
    v_add_u32 v3, s53, v56
    v_cndmask_b32 v35, v10, v5, s[50:51]
    v_mfma_f32_16x16x32_bf16 a[76:79], a[224:227], v[196:199], a[76:79]
    buffer_load_dwordx4 v1, s[20:23], s33 offen offset:2048 sc1 lds
    v_exp_f32 v241, v165
    v_mfma_f32_16x16x32_bf16 a[76:79], a[228:231], v[204:207], a[76:79]
    s_waitcnt lgkmcnt(5)
    ds_read_b128 a[132:135], v2 offset:1024
    v_cmp_gt_i32 s[44:45], 32, v6
    v_mfma_f32_16x16x32_bf16 a[88:91], a[232:235], v[192:195], a[88:91]
    v_exp_f32 v242, v166
    v_cmp_gt_i32 s[46:47], 33, v6
    v_mfma_f32_16x16x32_bf16 a[88:91], a[236:239], v[200:203], a[88:91]
    ds_read_b128 a[136:139], v2 offset:2048
    v_cvt_pk_bf16_f32 v212, v240, v241
    v_mfma_f32_16x16x32_bf16 a[92:95], a[232:235], v[196:199], a[92:95]
    v_cmp_gt_i32 s[48:49], 34, v6
    v_cmp_gt_i32 s[50:51], 35, v6
    v_mfma_f32_16x16x32_bf16 a[92:95], a[236:239], v[204:207], a[92:95]
    s_waitcnt lgkmcnt(5)
    v_exp_f32 v243, v167
    v_or3_b32 v57, v57, v211, v212
    v_mfma_f32_16x16x32_bf16 a[104:107], a[240:243], v[192:195], a[104:107]
    ds_read_b128 a[140:143], v2 offset:3072
    v_cndmask_b32 v24, v10, v5, s[44:45]
    v_mfma_f32_16x16x32_bf16 a[104:107], a[244:247], v[200:203], a[104:107]
    v_cndmask_b32 v25, v10, v5, s[46:47]
    v_exp_f32 v244, v180
    v_mfma_f32_16x16x32_bf16 a[108:111], a[240:243], v[196:199], a[108:111]
    v_cvt_pk_bf16_f32 v213, v242, v243
    v_cndmask_b32 v26, v10, v5, s[48:49]
    v_mfma_f32_16x16x32_bf16 a[108:111], a[244:247], v[204:207], a[108:111]
    s_waitcnt lgkmcnt(4)
    ds_read_b128 a[144:147], v2 offset:4096
    v_cndmask_b32 v27, v10, v5, s[50:51]
    v_mfma_f32_16x16x32_bf16 a[120:123], a[248:251], v[192:195], a[120:123]
    v_exp_f32 v245, v181
    v_cmp_gt_i32 s[44:45], 48, v6
    v_mfma_f32_16x16x32_bf16 a[120:123], a[252:255], v[200:203], a[120:123]
    buffer_load_dwordx4 v1, s[20:23], s33 offen offset:3072 sc1 lds
    ds_read_b128 a[148:151], v2 offset:5120
    ds_read_b128 a[152:155], v2 offset:6144
    v_cmp_gt_i32 s[46:47], 49, v6
    s_add_u32 s33, s33, 0x80000
    v_cmp_gt_i32 s[48:49], 50, v6
    v_exp_f32 v246, v182
    v_cvt_pk_bf16_f32 v214, v244, v245
    v_cmp_gt_i32 s[50:51], 51, v6
    v_cndmask_b32 v40, v10, v5, s[44:45]
    v_mfma_f32_16x16x32_bf16 a[124:127], a[248:251], v[196:199], a[124:127]
    v_exp_f32 v247, v183
    v_or3_b32 v57, v57, v213, v214
    v_cndmask_b32 v41, v10, v5, s[46:47]
    v_mfma_f32_16x16x32_bf16 a[124:127], a[252:255], v[204:207], a[124:127]
    s_waitcnt lgkmcnt(5)
    ds_read_b128 a[156:159], v2 offset:7168
    v_cndmask_b32 v42, v10, v5, s[48:49]
    v_cndmask_b32 v43, v10, v5, s[50:51]
    v_mfma_f32_16x16x32_bf16 v[128:131], a[128:131], v[96:99], v[16:19]
    s_waitcnt vmcnt(4)
    s_barrier
    v_exp_f32 v232, v168
    v_mfma_f32_16x16x32_bf16 v[128:131], a[132:135], v[100:103], v[128:131]
    s_waitcnt lgkmcnt(4)
    ds_read_b128 a[160:163], v2 offset:8192
    v_cvt_pk_bf16_f32 v215, v246, v247
    v_mfma_f32_16x16x32_bf16 v[128:131], a[136:139], v[104:107], v[128:131]
    v_exp_f32 v233, v169
    v_mfma_f32_16x16x32_bf16 v[128:131], a[140:143], v[108:111], v[128:131]
    s_add_u32 s36, s36, 64
    ds_read_b128 a[164:167], v2 offset:9216
    v_cvt_pk_bf16_f32 v216, v232, v233
    v_mfma_f32_16x16x32_bf16 v[132:135], a[128:131], v[112:115], v[20:23]
    v_exp_f32 v234, v170
    v_mfma_f32_16x16x32_bf16 v[132:135], a[132:135], v[116:119], v[132:135]
    ds_read_b128 a[168:171], v2 offset:10240
    v_or3_b32 v57, v57, v215, v216
    v_mfma_f32_16x16x32_bf16 v[132:135], a[136:139], v[120:123], v[132:135]
    s_add_u32 s52, s52, 16384
    v_exp_f32 v235, v171
    v_mfma_f32_16x16x32_bf16 v[132:135], a[140:143], v[124:127], v[132:135]
    s_waitcnt lgkmcnt(5)
    ds_read_b128 a[172:175], v2 offset:11264
    v_cvt_pk_bf16_f32 v217, v234, v235
    v_mfma_f32_16x16x32_bf16 v[144:147], a[144:147], v[96:99], v[32:35]
    s_and_b32 s52, s52, 0xffff
    v_exp_f32 v236, v184
    v_mfma_f32_16x16x32_bf16 v[144:147], a[148:151], v[100:103], v[144:147]
    s_waitcnt lgkmcnt(4)
    ds_read_b128 a[176:179], v2 offset:12288
    ds_read_b128 a[180:183], v2 offset:13312
    v_mfma_f32_16x16x32_bf16 v[144:147], a[152:155], v[104:107], v[144:147]
    v_exp_f32 v237, v185
    v_mfma_f32_16x16x32_bf16 v[144:147], a[156:159], v[108:111], v[144:147]
    v_exp_f32 v238, v186
    v_mfma_f32_16x16x32_bf16 v[148:151], a[144:147], v[112:115], v[36:39]
    ds_read_b128 a[184:187], v2 offset:14336
    v_cvt_pk_bf16_f32 v218, v236, v237
    v_mfma_f32_16x16x32_bf16 v[148:151], a[148:151], v[116:119], v[148:151]
    v_exp_f32 v239, v187
    v_mfma_f32_16x16x32_bf16 v[148:151], a[152:155], v[120:123], v[148:151]
    ds_read_b128 a[188:191], v2 offset:15360
    v_or3_b32 v57, v57, v217, v218
    v_mfma_f32_16x16x32_bf16 v[148:151], a[156:159], v[124:127], v[148:151]
    s_waitcnt lgkmcnt(6)
    v_exp_f32 v240, v172
    v_mfma_f32_16x16x32_bf16 v[136:139], a[160:163], v[96:99], v[24:27]
    v_cvt_pk_bf16_f32 v219, v238, v239
    v_add_u32 v2, s52, v1
    v_mfma_f32_16x16x32_bf16 v[136:139], a[164:167], v[100:103], v[136:139]
    s_waitcnt lgkmcnt(4)
    v_exp_f32 v241, v173
    v_mfma_f32_16x16x32_bf16 v[136:139], a[168:171], v[104:107], v[136:139]
    ds_read_b128 a[192:195], v3 offset:0
    v_cvt_pk_bf16_f32 v220, v240, v241
    v_mfma_f32_16x16x32_bf16 v[136:139], a[172:175], v[108:111], v[136:139]
    v_exp_f32 v242, v174
    v_mfma_f32_16x16x32_bf16 v[140:143], a[160:163], v[112:115], v[28:31]
    ds_read_b128 a[196:199], v3 offset:8192
    v_or3_b32 v57, v57, v219, v220
    v_mfma_f32_16x16x32_bf16 v[140:143], a[164:167], v[116:119], v[140:143]
    v_exp_f32 v243, v175
    v_mfma_f32_16x16x32_bf16 v[140:143], a[168:171], v[120:123], v[140:143]
    ds_read_b128 a[200:203], v3 offset:1024
    v_cvt_pk_bf16_f32 v221, v242, v243
    v_mfma_f32_16x16x32_bf16 v[140:143], a[172:175], v[124:127], v[140:143]
    s_waitcnt lgkmcnt(5)
    v_exp_f32 v244, v188
    v_mfma_f32_16x16x32_bf16 v[152:155], a[176:179], v[96:99], v[40:43]
    ds_read_b128 a[204:207], v3 offset:9216
    ds_read_b128 a[208:211], v3 offset:2048
    v_mfma_f32_16x16x32_bf16 v[152:155], a[180:183], v[100:103], v[152:155]
    s_waitcnt lgkmcnt(5)
    v_exp_f32 v245, v189
    v_mfma_f32_16x16x32_bf16 v[152:155], a[184:187], v[104:107], v[152:155]
    v_exp_f32 v246, v190
    v_mfma_f32_16x16x32_bf16 v[152:155], a[188:191], v[108:111], v[152:155]
    ds_read_b128 a[212:215], v3 offset:10240
    v_cvt_pk_bf16_f32 v222, v244, v245
    v_mfma_f32_16x16x32_bf16 v[156:159], a[176:179], v[112:115], v[44:47]
    v_exp_f32 v247, v191
    v_mfma_f32_16x16x32_bf16 v[156:159], a[180:183], v[116:119], v[156:159]
    ds_read_b128 a[216:219], v3 offset:3072
    v_or3_b32 v57, v57, v221, v222
    v_mfma_f32_16x16x32_bf16 v[156:159], a[184:187], v[120:123], v[156:159]
    ds_read_b128 a[220:223], v3 offset:11264
    v_cvt_pk_bf16_f32 v223, v246, v247
    v_bitop3_b32 v57, v57, v223, s37 bitop3:0xa8
    v_mfma_f32_16x16x32_bf16 v[156:159], a[188:191], v[124:127], v[156:159]
    v_cmp_ne_u32 vcc, 0, v57
    s_cbranch_vccnz k2_tramp_110
k2_ret_111:
    v_mfma_f32_16x16x32_bf16 v[248:251], v[60:63], v[208:211], v[248:251]
    ds_read_b128 a[224:227], v3 offset:4096
    v_exp_f32 v232, v128
    v_mfma_f32_16x16x32_bf16 v[248:251], v[60:63], v[216:219], v[248:251]
    v_exp_f32 v233, v129
    v_mfma_f32_16x16x32_bf16 v[252:255], v[60:63], v[212:215], v[252:255]
    s_add_u32 s53, s53, 16384
    ds_read_b128 a[228:231], v3 offset:12288
    v_exp_f32 v234, v130
    v_mfma_f32_16x16x32_bf16 v[252:255], v[60:63], v[220:223], v[252:255]
    s_waitcnt lgkmcnt(8)
    v_cvt_pk_bf16_f32 v192, v232, v233
    v_exp_f32 v235, v131
    v_mfma_f32_16x16x32_bf16 a[8:11], a[192:195], v[208:211], a[8:11]
    s_sub_u32 s40, s36, s39
    s_sub_u32 s40, s40, 64
    ds_read_b128 a[232:235], v3 offset:5120
    v_mfma_f32_16x16x32_bf16 a[8:11], a[196:199], v[216:219], a[8:11]
    s_and_b32 s53, s53, 0xffff
    v_subrev_u32 v6, s40, v4
    v_cmp_gt_i32 s[44:45], 0, v6
    v_cvt_pk_bf16_f32 v193, v234, v235
    v_mfma_f32_16x16x32_bf16 a[12:15], a[192:195], v[212:215], a[12:15]
    v_exp_f32 v236, v144
    v_cmp_gt_i32 s[46:47], 1, v6
    v_mfma_f32_16x16x32_bf16 a[12:15], a[196:199], v[220:223], a[12:15]
    s_waitcnt lgkmcnt(7)
    ds_read_b128 a[236:239], v3 offset:13312
    v_exp_f32 v237, v145
    v_mfma_f32_16x16x32_bf16 a[24:27], a[200:203], v[208:211], a[24:27]
    ds_read_b128 a[240:243], v3 offset:6144
    v_cmp_gt_i32 s[48:49], 2, v6
    v_cmp_gt_i32 s[50:51], 3, v6
    v_mfma_f32_16x16x32_bf16 a[24:27], a[204:207], v[216:219], a[24:27]
    v_exp_f32 v238, v146
    v_cndmask_b32 v20, v11, v5, s[44:45]
    v_mfma_f32_16x16x32_bf16 a[28:31], a[200:203], v[212:215], a[28:31]
    v_cvt_pk_bf16_f32 v194, v236, v237
    v_cndmask_b32 v21, v11, v5, s[46:47]
    v_or3_b32 v57, v192, v193, v194
    v_mfma_f32_16x16x32_bf16 a[28:31], a[204:207], v[220:223], a[28:31]
    s_waitcnt lgkmcnt(7)
    v_exp_f32 v239, v147
    v_cndmask_b32 v22, v11, v5, s[48:49]
    v_mfma_f32_16x16x32_bf16 a[40:43], a[208:211], v[208:211], a[40:43]
    ds_read_b128 a[244:247], v3 offset:14336
    v_cndmask_b32 v23, v11, v5, s[50:51]
    v_cvt_pk_bf16_f32 v195, v238, v239
    v_mfma_f32_16x16x32_bf16 a[40:43], a[212:215], v[216:219], a[40:43]
    v_exp_f32 v240, v132
    v_cmp_gt_i32 s[44:45], 16, v6
    v_mfma_f32_16x16x32_bf16 a[44:47], a[208:211], v[212:215], a[44:47]
    ds_read_b128 a[248:251], v3 offset:7168
    v_cmp_gt_i32 s[46:47], 17, v6
    v_cmp_gt_i32 s[48:49], 18, v6
    v_mfma_f32_16x16x32_bf16 a[44:47], a[212:215], v[220:223], a[44:47]
    s_waitcnt lgkmcnt(7)
    ds_read_b128 a[252:255], v3 offset:15360
    v_exp_f32 v241, v133
    v_mfma_f32_16x16x32_bf16 a[56:59], a[216:219], v[208:211], a[56:59]
    v_exp_f32 v242, v134
    v_cmp_gt_i32 s[50:51], 19, v6
    v_mfma_f32_16x16x32_bf16 a[56:59], a[220:223], v[216:219], a[56:59]
    v_cvt_pk_bf16_f32 v196, v240, v241
    v_cndmask_b32 v36, v11, v5, s[44:45]
    v_or3_b32 v57, v57, v195, v196
    v_mfma_f32_16x16x32_bf16 a[60:63], a[216:219], v[212:215], a[60:63]
    v_exp_f32 v243, v135
    v_cndmask_b32 v37, v11, v5, s[46:47]
    v_mfma_f32_16x16x32_bf16 a[60:63], a[220:223], v[220:223], a[60:63]
    s_waitcnt lgkmcnt(6)
    ds_read_b128 a[128:131], v2 offset:0
    v_cndmask_b32 v38, v11, v5, s[48:49]
    v_add_u32 v3, s53, v56
    v_mfma_f32_16x16x32_bf16 a[72:75], a[224:227], v[208:211], a[72:75]
    ds_read_b128 a[132:135], v2 offset:1024
    v_exp_f32 v244, v148
    v_mfma_f32_16x16x32_bf16 a[72:75], a[228:231], v[216:219], a[72:75]
    ds_read_b128 a[136:139], v2 offset:2048
    v_cvt_pk_bf16_f32 v197, v242, v243
    v_cndmask_b32 v39, v11, v5, s[50:51]
    v_mfma_f32_16x16x32_bf16 a[76:79], a[224:227], v[212:215], a[76:79]
    v_cmp_gt_i32 s[44:45], 32, v6
    v_exp_f32 v245, v149
    v_mfma_f32_16x16x32_bf16 a[76:79], a[228:231], v[220:223], a[76:79]
    s_waitcnt lgkmcnt(7)
    ds_read_b128 a[140:143], v2 offset:3072
    ds_read_b128 a[144:147], v2 offset:4096
    v_cmp_gt_i32 s[46:47], 33, v6
    v_mfma_f32_16x16x32_bf16 a[88:91], a[232:235], v[208:211], a[88:91]
    v_exp_f32 v246, v150
    v_cmp_gt_i32 s[48:49], 34, v6
    v_mfma_f32_16x16x32_bf16 a[88:91], a[236:239], v[216:219], a[88:91]
    ds_read_b128 a[148:151], v2 offset:5120
    v_cvt_pk_bf16_f32 v198, v244, v245
    v_cmp_gt_i32 s[50:51], 35, v6
    v_mfma_f32_16x16x32_bf16 a[92:95], a[232:235], v[212:215], a[92:95]
    v_exp_f32 v247, v151
    v_or3_b32 v57, v57, v197, v198
    v_mfma_f32_16x16x32_bf16 a[92:95], a[236:239], v[220:223], a[92:95]
    s_waitcnt lgkmcnt(8)
    ds_read_b128 a[152:155], v2 offset:6144
    v_cndmask_b32 v28, v11, v5, s[44:45]
    v_cndmask_b32 v29, v11, v5, s[46:47]
    v_mfma_f32_16x16x32_bf16 a[104:107], a[240:243], v[208:211], a[104:107]
    ds_read_b128 a[156:159], v2 offset:7168
    v_exp_f32 v232, v136
    v_mfma_f32_16x16x32_bf16 a[104:107], a[244:247], v[216:219], a[104:107]
    ds_read_b128 a[160:163], v2 offset:8192
    v_cvt_pk_bf16_f32 v199, v246, v247
    v_cndmask_b32 v30, v11, v5, s[48:49]
    v_mfma_f32_16x16x32_bf16 a[108:111], a[240:243], v[212:215], a[108:111]
    v_cndmask_b32 v31, v11, v5, s[50:51]
    v_exp_f32 v233, v137
    v_mfma_f32_16x16x32_bf16 a[108:111], a[244:247], v[220:223], a[108:111]
    s_waitcnt lgkmcnt(9)
    ds_read_b128 a[164:167], v2 offset:9216
    ds_read_b128 a[168:171], v2 offset:10240
    v_cmp_gt_i32 s[44:45], 48, v6
    v_mfma_f32_16x16x32_bf16 a[120:123], a[248:251], v[208:211], a[120:123]
    v_exp_f32 v234, v138
    v_cmp_gt_i32 s[46:47], 49, v6
    v_mfma_f32_16x16x32_bf16 a[120:123], a[252:255], v[216:219], a[120:123]
    ds_read_b128 a[172:175], v2 offset:11264
    ds_read_b128 a[176:179], v2 offset:12288
    v_cvt_pk_bf16_f32 v200, v232, v233
    v_cmp_gt_i32 s[48:49], 50, v6
    v_exp_f32 v235, v139
    v_cmp_gt_i32 s[50:51], 51, v6
    v_or3_b32 v57, v57, v199, v200
    v_cndmask_b32 v44, v11, v5, s[44:45]
    v_mfma_f32_16x16x32_bf16 a[124:127], a[248:251], v[212:215], a[124:127]
    ds_read_b128 a[180:183], v2 offset:13312
    v_exp_f32 v236, v152
    v_cvt_pk_bf16_f32 v201, v234, v235
    v_cndmask_b32 v45, v11, v5, s[46:47]
    v_mfma_f32_16x16x32_bf16 a[124:127], a[252:255], v[220:223], a[124:127]
    s_waitcnt lgkmcnt(12)
    ds_read_b128 a[184:187], v2 offset:14336
    v_cndmask_b32 v46, v11, v5, s[48:49]
    v_cndmask_b32 v47, v11, v5, s[50:51]
    v_mfma_f32_16x16x32_bf16 v[164:167], a[128:131], v[112:115], v[20:23]
    v_exp_f32 v237, v153
    v_mfma_f32_16x16x32_bf16 v[164:167], a[132:135], v[116:119], v[164:167]
    s_waitcnt lgkmcnt(11)
    ds_read_b128 a[188:191], v2 offset:15360
    v_exp_f32 v238, v154
    v_mfma_f32_16x16x32_bf16 v[164:167], a[136:139], v[120:123], v[164:167]
    v_cvt_pk_bf16_f32 v202, v236, v237
    v_exp_f32 v239, v155
    v_mfma_f32_16x16x32_bf16 v[164:167], a[140:143], v[124:127], v[164:167]
    s_waitcnt lgkmcnt(10)
    ds_read_b128 a[192:195], v3 offset:0
    v_or3_b32 v57, v57, v201, v202
    v_mfma_f32_16x16x32_bf16 v[180:183], a[144:147], v[112:115], v[36:39]
    s_add_u32 s36, s36, 64
    v_exp_f32 v240, v140
    v_mfma_f32_16x16x32_bf16 v[180:183], a[148:151], v[116:119], v[180:183]
    s_waitcnt lgkmcnt(9)
    ds_read_b128 a[196:199], v3 offset:8192
    v_cvt_pk_bf16_f32 v203, v238, v239
    v_exp_f32 v241, v141
    v_mfma_f32_16x16x32_bf16 v[180:183], a[152:155], v[120:123], v[180:183]
    s_add_u32 s52, s52, 16384
    ds_read_b128 a[200:203], v3 offset:1024
    v_cvt_pk_bf16_f32 v204, v240, v241
    v_mfma_f32_16x16x32_bf16 v[180:183], a[156:159], v[124:127], v[180:183]
    s_waitcnt lgkmcnt(9)
    v_exp_f32 v242, v142
    v_or3_b32 v57, v57, v203, v204
    v_mfma_f32_16x16x32_bf16 v[172:175], a[160:163], v[112:115], v[28:31]
    s_and_b32 s52, s52, 0xffff
    v_add_u32 v2, s52, v1
    v_exp_f32 v243, v143
    v_mfma_f32_16x16x32_bf16 v[172:175], a[164:167], v[116:119], v[172:175]
    s_waitcnt lgkmcnt(7)
    ds_read_b128 a[204:207], v3 offset:9216
    v_exp_f32 v244, v156
    v_mfma_f32_16x16x32_bf16 v[172:175], a[168:171], v[120:123], v[172:175]
    ds_read_b128 a[208:211], v3 offset:2048
    ds_read_b128 a[212:215], v3 offset:10240
    v_cvt_pk_bf16_f32 v205, v242, v243
    v_mfma_f32_16x16x32_bf16 v[172:175], a[172:175], v[124:127], v[172:175]
    s_waitcnt lgkmcnt(8)
    ds_read_b128 a[216:219], v3 offset:3072
    v_exp_f32 v245, v157
    v_mfma_f32_16x16x32_bf16 v[188:191], a[176:179], v[112:115], v[44:47]
    v_exp_f32 v246, v158
    v_cvt_pk_bf16_f32 v206, v244, v245
    v_mfma_f32_16x16x32_bf16 v[188:191], a[180:183], v[116:119], v[188:191]
    s_waitcnt lgkmcnt(7)
    v_exp_f32 v247, v159
    v_or3_b32 v57, v57, v205, v206
    v_mfma_f32_16x16x32_bf16 v[188:191], a[184:187], v[120:123], v[188:191]
    ds_read_b128 a[220:223], v3 offset:11264
    v_cvt_pk_bf16_f32 v207, v246, v247
    v_bitop3_b32 v57, v57, v207, s37 bitop3:0xa8
    v_mfma_f32_16x16x32_bf16 v[188:191], a[188:191], v[124:127], v[188:191]
    v_cmp_ne_u32 vcc, 0, v57
    s_cbranch_vccnz k2_tramp_112
k2_ret_113:
k2_sdone_105:
    s_add_u32 s16, s6, 0x4811000
    s_addc_u32 s17, s7, 0
    s_and_b32 s17, s17, 0xffff
    s_mov_b32 s18, 0x4000
    s_mov_b32 s19, 0x00020000
    v_mfma_f32_16x16x32_bf16 v[248:251], v[60:63], v[192:195], v[248:251]
    s_waitcnt vmcnt(0)
    s_barrier
    v_exp_f32 v232, v164
    v_mfma_f32_16x16x32_bf16 v[248:251], v[60:63], v[200:203], v[248:251]
    ds_read_b128 a[224:227], v3 offset:4096
    s_cmp_eq_u32 s30, 0
    s_cbranch_scc1 k12_ool_116
k12_oolret_117:
    v_mfma_f32_16x16x32_bf16 v[252:255], v[60:63], v[196:199], v[252:255]
    s_add_u32 m0, s60, 0
    v_exp_f32 v233, v165
    v_mfma_f32_16x16x32_bf16 v[252:255], v[60:63], v[204:207], v[252:255]
    s_waitcnt lgkmcnt(7)
    buffer_load_dwordx4 v90, s[12:15], s61 offen offset:0 lds
    ds_read_b128 a[228:231], v3 offset:12288
    v_mfma_f32_16x16x32_bf16 a[8:11], a[192:195], v[192:195], a[8:11]
    s_add_u32 s53, s53, 16384
    v_exp_f32 v234, v166
    v_cvt_pk_bf16_f32 v212, v232, v233
    v_mfma_f32_16x16x32_bf16 a[8:11], a[196:199], v[200:203], a[8:11]
    s_and_b32 s53, s53, 0xffff
    buffer_load_dwordx4 v91, s[12:15], s61 offen offset:1024 lds
    ds_read_b128 a[232:235], v3 offset:5120
    v_mfma_f32_16x16x32_bf16 a[12:15], a[192:195], v[196:199], a[12:15]
    ds_read_b128 a[236:239], v3 offset:13312
    v_exp_f32 v235, v167
    v_mfma_f32_16x16x32_bf16 a[12:15], a[196:199], v[204:207], a[12:15]
    s_waitcnt lgkmcnt(8)
    v_exp_f32 v236, v180
    v_mfma_f32_16x16x32_bf16 a[24:27], a[200:203], v[192:195], a[24:27]
    buffer_load_dwordx4 v92, s[12:15], s61 offen offset:2048 lds
    ds_read_b128 a[240:243], v3 offset:6144
    v_mfma_f32_16x16x32_bf16 a[24:27], a[204:207], v[200:203], a[24:27]
    v_cvt_pk_bf16_f32 v213, v234, v235
    v_exp_f32 v237, v181
    v_mfma_f32_16x16x32_bf16 a[28:31], a[200:203], v[196:199], a[28:31]
    buffer_load_dwordx4 v93, s[12:15], s61 offen offset:3072 lds
    ds_read_b128 a[244:247], v3 offset:14336
    v_mfma_f32_16x16x32_bf16 a[28:31], a[204:207], v[204:207], a[28:31]
    s_waitcnt lgkmcnt(8)
    v_exp_f32 v238, v182
    v_cvt_pk_bf16_f32 v214, v236, v237
    v_mfma_f32_16x16x32_bf16 a[40:43], a[208:211], v[192:195], a[40:43]
    s_add_u32 s61, s61, 0x20000
    s_and_b32 s61, s61, 0x3fffff
    ds_read_b128 a[248:251], v3 offset:7168
    v_mfma_f32_16x16x32_bf16 a[40:43], a[212:215], v[200:203], a[40:43]
    s_add_u32 m0, s60, 16384
    v_exp_f32 v239, v183
    v_or3_b32 v57, v212, v213, v214
    v_mfma_f32_16x16x32_bf16 a[44:47], a[208:211], v[196:199], a[44:47]
    buffer_load_dwordx4 v90, s[12:15], s61 offen offset:0 lds
    buffer_load_dwordx4 v91, s[12:15], s61 offen offset:1024 lds
    ds_read_b128 a[252:255], v3 offset:15360
    v_mfma_f32_16x16x32_bf16 a[44:47], a[212:215], v[204:207], a[44:47]
    s_waitcnt lgkmcnt(8)
    v_exp_f32 v240, v172
    v_cvt_pk_bf16_f32 v215, v238, v239
    v_mfma_f32_16x16x32_bf16 a[56:59], a[216:219], v[192:195], a[56:59]
    v_mfma_f32_16x16x32_bf16 a[56:59], a[220:223], v[200:203], a[56:59]
    v_add_u32 v3, s53, v56
    ds_read_b128 a[192:195], v3 offset:0
    v_mfma_f32_16x16x32_bf16 a[60:63], a[216:219], v[196:199], a[60:63]
    ds_read_b128 a[196:199], v3 offset:8192
    v_exp_f32 v241, v173
    v_mfma_f32_16x16x32_bf16 a[60:63], a[220:223], v[204:207], a[60:63]
    s_waitcnt lgkmcnt(8)
    buffer_load_dwordx4 v92, s[12:15], s61 offen offset:2048 lds
    buffer_load_dwordx4 v93, s[12:15], s61 offen offset:3072 lds
    ds_read_b128 a[200:203], v3 offset:1024
    v_mfma_f32_16x16x32_bf16 a[72:75], a[224:227], v[192:195], a[72:75]
    v_exp_f32 v242, v174
    v_cvt_pk_bf16_f32 v220, v240, v241
    v_mfma_f32_16x16x32_bf16 a[72:75], a[228:231], v[200:203], a[72:75]
    ds_read_b128 a[204:207], v3 offset:9216
    ds_read_b128 a[208:211], v3 offset:2048
    v_or3_b32 v57, v57, v215, v220
    v_mfma_f32_16x16x32_bf16 a[76:79], a[224:227], v[196:199], a[76:79]
    s_add_u32 s61, s61, 0x20000
    s_and_b32 s61, s61, 0x3fffff
    ds_read_b128 a[212:215], v3 offset:10240
    v_exp_f32 v243, v175
    v_mfma_f32_16x16x32_bf16 a[76:79], a[228:231], v[204:207], a[76:79]
    s_waitcnt lgkmcnt(10)
    ds_read_b128 a[216:219], v3 offset:3072
    s_add_u32 m0, s60, 32768
    v_mfma_f32_16x16x32_bf16 a[88:91], a[232:235], v[192:195], a[88:91]
    buffer_load_dwordx4 v90, s[12:15], s61 offen offset:0 lds
    ds_read_b128 a[220:223], v3 offset:11264
    v_mfma_f32_16x16x32_bf16 a[88:91], a[236:239], v[200:203], a[88:91]
    v_exp_f32 v244, v188
    v_cvt_pk_bf16_f32 v221, v242, v243
    v_mfma_f32_16x16x32_bf16 a[92:95], a[232:235], v[196:199], a[92:95]
    buffer_load_dwordx4 v91, s[12:15], s61 offen offset:1024 lds
    ds_read_b128 a[224:227], v3 offset:4096
    v_mfma_f32_16x16x32_bf16 a[92:95], a[236:239], v[204:207], a[92:95]
    s_waitcnt lgkmcnt(11)
    ds_read_b128 a[228:231], v3 offset:12288
    v_exp_f32 v245, v189
    v_mfma_f32_16x16x32_bf16 a[104:107], a[240:243], v[192:195], a[104:107]
    buffer_load_dwordx4 v92, s[12:15], s61 offen offset:2048 lds
    ds_read_b128 a[232:235], v3 offset:5120
    v_mfma_f32_16x16x32_bf16 a[104:107], a[244:247], v[200:203], a[104:107]
    v_exp_f32 v246, v190
    v_mfma_f32_16x16x32_bf16 a[108:111], a[240:243], v[196:199], a[108:111]
    ds_read_b128 a[236:239], v3 offset:13312
    v_cvt_pk_bf16_f32 v222, v244, v245
    v_or3_b32 v57, v57, v221, v222
    v_mfma_f32_16x16x32_bf16 a[108:111], a[244:247], v[204:207], a[108:111]
    s_waitcnt lgkmcnt(12)
    v_exp_f32 v247, v191
    v_mfma_f32_16x16x32_bf16 a[120:123], a[248:251], v[192:195], a[120:123]
    buffer_load_dwordx4 v93, s[12:15], s61 offen offset:3072 lds
    ds_read_b128 a[240:243], v3 offset:6144
    ds_read_b128 a[244:247], v3 offset:14336
    v_mfma_f32_16x16x32_bf16 a[120:123], a[252:255], v[200:203], a[120:123]
    s_add_u32 s61, s61, 0x20000
    s_and_b32 s61, s61, 0x3fffff
    v_cvt_pk_bf16_f32 v223, v246, v247
    v_bitop3_b32 v57, v57, v223, s37 bitop3:0xa8
    v_mfma_f32_16x16x32_bf16 a[124:127], a[248:251], v[196:199], a[124:127]
    v_cmp_ne_u32 vcc, 0, v57
    v_mfma_f32_16x16x32_bf16 a[124:127], a[252:255], v[204:207], a[124:127]
    buffer_load_dword v74, v73, s[16:19], s59 offen sc1
    ds_read_b128 a[248:251], v3 offset:7168
    ds_read_b128 a[252:255], v3 offset:15360
    s_cbranch_vccnz k2_tramp_114
k2_ret_115:
    v_lshrrev_b32 v6, 4, v1
    v_and_b32 v6, 31, v6
    s_getpc_b64 s[40:41]
pc_118:
    s_add_u32 s40, s40, op_head-pc_118
    s_addc_u32 s41, s41, 0
    v_lshlrev_b32 v224, 7, v6
    v_mov_b32 v225, s41
    v_add_co_u32 v224, vcc, s40, v224
    s_nop 1
    v_addc_co_u32 v225, vcc, 0, v225, vcc
    global_load_dword v7, v[224:225], off
    v_mfma_f32_16x16x32_bf16 v[252:255], v[60:63], v[212:215], v[252:255]
    s_lshl_b32 s31, s28, 19
    v_mov_b32 v249, v248
    s_nop 1
    v_permlane16_swap_b32 v248, v249
    v_mfma_f32_16x16x32_bf16 v[252:255], v[60:63], v[220:223], v[252:255]
    s_waitcnt lgkmcnt(0)
    s_nop 1
    v_add_f32 v248, v248, v249
    v_mov_b32 v249, v248
    v_mfma_f32_16x16x32_bf16 a[12:15], a[192:195], v[212:215], a[12:15]
    s_lshl_b32 s44, s39, 6
    s_nop 1
    v_permlane32_swap_b32 v248, v249
    s_nop 1
    v_mfma_f32_16x16x32_bf16 a[12:15], a[196:199], v[220:223], a[12:15]
    s_add_u32 s44, s44, s31
    s_add_u32 s45, s44, 131072
    v_add_f32 v248, v248, v249
    v_rcp_f32 v249, v248
    v_mfma_f32_16x16x32_bf16 a[28:31], a[200:203], v[212:215], a[28:31]
    s_add_u32 s46, s44, 262144
    v_rcp_f32 v248, v248
    s_nop 0
    s_add_u32 s47, s44, 393216
    v_mfma_f32_16x16x32_bf16 a[28:31], a[204:207], v[220:223], a[28:31]
    s_add_u32 s48, s44, 4096
    v_accvgpr_read_b32 v132, a8
    v_accvgpr_read_b32 v133, a9
    v_accvgpr_read_b32 v134, a10
    v_mfma_f32_16x16x32_bf16 a[44:47], a[208:211], v[212:215], a[44:47]
    s_add_u32 s49, s44, 135168
    v_accvgpr_read_b32 v135, a11
    v_accvgpr_read_b32 v136, a24
    v_accvgpr_read_b32 v137, a25
    v_mfma_f32_16x16x32_bf16 a[44:47], a[212:215], v[220:223], a[44:47]
    s_add_u32 s50, s44, 266240
    v_accvgpr_read_b32 v138, a26
    v_accvgpr_read_b32 v139, a27
    v_mul_f32 v132, v132, v248
    v_mfma_f32_16x16x32_bf16 a[60:63], a[216:219], v[212:215], a[60:63]
    s_add_u32 s51, s44, 397312
    v_mul_f32 v133, v133, v248
    v_mul_f32 v134, v134, v248
    v_mul_f32 v135, v135, v248
    v_mfma_f32_16x16x32_bf16 a[60:63], a[220:223], v[220:223], a[60:63]
    v_mul_f32 v136, v136, v248
    v_mul_f32 v137, v137, v248
    v_mul_f32 v138, v138, v248
    v_mfma_f32_16x16x32_bf16 a[76:79], a[224:227], v[212:215], a[76:79]
    v_mul_f32 v139, v139, v248
    v_cvt_pk_bf16_f32 v128, v132, v133
    v_cvt_pk_bf16_f32 v129, v134, v135
    v_mfma_f32_16x16x32_bf16 a[76:79], a[228:231], v[220:223], a[76:79]
    v_cvt_pk_bf16_f32 v130, v136, v137
    v_cvt_pk_bf16_f32 v131, v138, v139
    buffer_store_dwordx4 v[128:131], v1, s[24:27], s44 offen sc1
    v_mfma_f32_16x16x32_bf16 a[92:95], a[232:235], v[212:215], a[92:95]
    v_accvgpr_read_b32 v144, a40
    v_accvgpr_read_b32 v145, a41
    v_accvgpr_read_b32 v146, a42
    v_mfma_f32_16x16x32_bf16 a[92:95], a[236:239], v[220:223], a[92:95]
    v_accvgpr_read_b32 v147, a43
    v_accvgpr_read_b32 v148, a56
    v_mov_b32 v253, v252
    v_mfma_f32_16x16x32_bf16 a[108:111], a[240:243], v[212:215], a[108:111]
    v_accvgpr_read_b32 v149, a57
    v_accvgpr_read_b32 v150, a58
    s_nop 1
    v_mfma_f32_16x16x32_bf16 a[108:111], a[244:247], v[220:223], a[108:111]
    v_accvgpr_read_b32 v151, a59
    v_permlane16_swap_b32 v252, v253
    v_mul_f32 v144, v144, v248
    v_mfma_f32_16x16x32_bf16 a[124:127], a[248:251], v[212:215], a[124:127]
    s_nop 1
    v_mul_f32 v145, v145, v248
    v_add_f32 v252, v252, v253
    v_mfma_f32_16x16x32_bf16 a[124:127], a[252:255], v[220:223], a[124:127]
    v_mul_f32 v146, v146, v248
    v_mov_b32 v253, v252
    v_mul_f32 v147, v147, v248
    s_nop 1
    v_mul_f32 v148, v148, v248
    v_mul_f32 v149, v149, v248
    v_permlane32_swap_b32 v252, v253
    v_mul_f32 v150, v150, v248
    s_nop 1
    v_mul_f32 v151, v151, v248
    v_add_f32 v252, v252, v253
    v_cvt_pk_bf16_f32 v140, v144, v145
    v_rcp_f32 v253, v252
    v_cvt_pk_bf16_f32 v141, v146, v147
    v_rcp_f32 v252, v252
    v_cvt_pk_bf16_f32 v142, v148, v149
    s_nop 0
    v_cvt_pk_bf16_f32 v143, v150, v151
    buffer_store_dwordx4 v[140:143], v1, s[24:27], s45 offen sc1
    v_accvgpr_read_b32 v156, a72
    v_accvgpr_read_b32 v157, a73
    v_accvgpr_read_b32 v158, a74
    v_accvgpr_read_b32 v159, a75
    v_accvgpr_read_b32 v160, a88
    v_accvgpr_read_b32 v161, a89
    v_accvgpr_read_b32 v162, a90
    v_accvgpr_read_b32 v163, a91
    v_mul_f32 v156, v156, v248
    v_mul_f32 v157, v157, v248
    v_mul_f32 v158, v158, v248
    v_mul_f32 v159, v159, v248
    v_mul_f32 v160, v160, v248
    v_mul_f32 v161, v161, v248
    v_mul_f32 v162, v162, v248
    v_mul_f32 v163, v163, v248
    v_cvt_pk_bf16_f32 v152, v156, v157
    v_cvt_pk_bf16_f32 v153, v158, v159
    v_cvt_pk_bf16_f32 v154, v160, v161
    v_cvt_pk_bf16_f32 v155, v162, v163
    buffer_store_dwordx4 v[152:155], v1, s[24:27], s46 offen sc1
    v_accvgpr_read_b32 v168, a104
    v_accvgpr_read_b32 v169, a105
    v_accvgpr_read_b32 v170, a106
    v_accvgpr_read_b32 v171, a107
    v_accvgpr_read_b32 v172, a120
    v_accvgpr_read_b32 v173, a121
    v_accvgpr_read_b32 v174, a122
    v_accvgpr_read_b32 v175, a123
    v_mul_f32 v168, v168, v248
    v_mul_f32 v169, v169, v248
    v_mul_f32 v170, v170, v248
    v_mul_f32 v171, v171, v248
    v_mul_f32 v172, v172, v248
    v_mul_f32 v173, v173, v248
    v_mul_f32 v174, v174, v248
    v_mul_f32 v175, v175, v248
    v_cvt_pk_bf16_f32 v164, v168, v169
    v_cvt_pk_bf16_f32 v165, v170, v171
    v_cvt_pk_bf16_f32 v166, v172, v173
    v_cvt_pk_bf16_f32 v167, v174, v175
    buffer_store_dwordx4 v[164:167], v1, s[24:27], s47 offen sc1
    v_accvgpr_read_b32 v132, a12
    v_accvgpr_read_b32 v133, a13
    v_accvgpr_read_b32 v134, a14
    v_accvgpr_read_b32 v135, a15
    v_accvgpr_read_b32 v136, a28
    v_accvgpr_read_b32 v137, a29
    v_accvgpr_read_b32 v138, a30
    v_accvgpr_read_b32 v139, a31
    v_pk_mul_f32 v[132:133], v[132:133], v[252:253]
    v_pk_mul_f32 v[134:135], v[134:135], v[252:253]
    v_pk_mul_f32 v[136:137], v[136:137], v[252:253]
    v_pk_mul_f32 v[138:139], v[138:139], v[252:253]
    v_cvt_pk_bf16_f32 v128, v132, v133
    v_cvt_pk_bf16_f32 v129, v134, v135
    v_cvt_pk_bf16_f32 v130, v136, v137
    v_cvt_pk_bf16_f32 v131, v138, v139
    v_accvgpr_read_b32 v144, a44
    v_accvgpr_read_b32 v145, a45
    v_accvgpr_read_b32 v146, a46
    v_accvgpr_read_b32 v147, a47
    v_accvgpr_read_b32 v148, a60
    v_accvgpr_read_b32 v149, a61
    v_accvgpr_read_b32 v150, a62
    v_accvgpr_read_b32 v151, a63
    v_pk_mul_f32 v[144:145], v[144:145], v[252:253]
    v_pk_mul_f32 v[146:147], v[146:147], v[252:253]
    v_pk_mul_f32 v[148:149], v[148:149], v[252:253]
    v_pk_mul_f32 v[150:151], v[150:151], v[252:253]
    v_cvt_pk_bf16_f32 v140, v144, v145
    v_cvt_pk_bf16_f32 v141, v146, v147
    v_cvt_pk_bf16_f32 v142, v148, v149
    v_cvt_pk_bf16_f32 v143, v150, v151
    v_accvgpr_read_b32 v156, a76
    v_accvgpr_read_b32 v157, a77
    v_accvgpr_read_b32 v158, a78
    v_accvgpr_read_b32 v159, a79
    v_accvgpr_read_b32 v160, a92
    v_accvgpr_read_b32 v161, a93
    v_accvgpr_read_b32 v162, a94
    v_accvgpr_read_b32 v163, a95
    v_pk_mul_f32 v[156:157], v[156:157], v[252:253]
    v_pk_mul_f32 v[158:159], v[158:159], v[252:253]
    v_pk_mul_f32 v[160:161], v[160:161], v[252:253]
    v_pk_mul_f32 v[162:163], v[162:163], v[252:253]
    v_cvt_pk_bf16_f32 v152, v156, v157
    v_cvt_pk_bf16_f32 v153, v158, v159
    v_cvt_pk_bf16_f32 v154, v160, v161
    v_cvt_pk_bf16_f32 v155, v162, v163
    v_accvgpr_read_b32 v168, a108
    v_accvgpr_read_b32 v169, a109
    v_accvgpr_read_b32 v170, a110
    v_accvgpr_read_b32 v171, a111
    v_accvgpr_read_b32 v172, a124
    v_accvgpr_read_b32 v173, a125
    v_accvgpr_read_b32 v174, a126
    v_accvgpr_read_b32 v175, a127
    v_pk_mul_f32 v[168:169], v[168:169], v[252:253]
    v_pk_mul_f32 v[170:171], v[170:171], v[252:253]
    v_pk_mul_f32 v[172:173], v[172:173], v[252:253]
    v_pk_mul_f32 v[174:175], v[174:175], v[252:253]
    v_cvt_pk_bf16_f32 v164, v168, v169
    v_cvt_pk_bf16_f32 v165, v170, v171
    v_cvt_pk_bf16_f32 v166, v172, v173
    v_cvt_pk_bf16_f32 v167, v174, v175
    buffer_store_dwordx4 v[128:131], v1, s[24:27], s48 offen sc1
    buffer_store_dwordx4 v[140:143], v1, s[24:27], s49 offen sc1
    buffer_store_dwordx4 v[152:155], v1, s[24:27], s50 offen sc1
    buffer_store_dwordx4 v[164:167], v1, s[24:27], s51 offen sc1
op_head:
    s_load_dwordx2 s[28:29], s[0:1], 0
    s_load_dwordx2 s[42:43], s[0:1], 56
    s_waitcnt vmcnt(8)
    v_cmp_le_u32 vcc, 4, v74
    v_mov_b32 v56, 0
    v_mov_b32 v57, 0
    v_mov_b32 v58, 0
    v_mov_b32 v59, 0
    s_nop 1
    v_mfma_f32_32x32x16_bf16 v[128:143], v[56:59], v[56:59], 0
    v_mfma_f32_32x32x16_bf16 v[144:159], v[56:59], v[56:59], 0
    v_mfma_f32_32x32x16_bf16 v[160:175], v[56:59], v[56:59], 0
    v_mfma_f32_32x32x16_bf16 v[176:191], v[56:59], v[56:59], 0
    s_mov_b32 s33, vcc_lo
    s_bitcmp1_b32 s33, 0
    s_cbranch_scc0 op_late_119
    buffer_load_dwordx4 a[128:131], v88, s[8:11], s62 offen offset:0 sc1
    buffer_load_dwordx4 a[132:135], v88, s[8:11], s62 offen offset:1024 sc1
    buffer_load_dwordx4 a[136:139], v89, s[8:11], s62 offen offset:0 sc1
    buffer_load_dwordx4 a[140:143], v89, s[8:11], s62 offen offset:1024 sc1
    s_add_u32 s62, s62, 0x40000
    s_and_b32 s62, s62, 0x7fffff
    buffer_load_dwordx4 a[144:147], v88, s[8:11], s62 offen offset:0 sc1
    buffer_load_dwordx4 a[148:151], v88, s[8:11], s62 offen offset:1024 sc1
    buffer_load_dwordx4 a[152:155], v89, s[8:11], s62 offen offset:0 sc1
    buffer_load_dwordx4 a[156:159], v89, s[8:11], s62 offen offset:1024 sc1
    s_add_u32 s62, s62, 0x40000
    s_and_b32 s62, s62, 0x7fffff
    buffer_load_dwordx4 a[160:163], v88, s[8:11], s62 offen offset:0 sc1
    buffer_load_dwordx4 a[164:167], v88, s[8:11], s62 offen offset:1024 sc1
    buffer_load_dwordx4 a[168:171], v89, s[8:11], s62 offen offset:0 sc1
    buffer_load_dwordx4 a[172:175], v89, s[8:11], s62 offen offset:1024 sc1
    s_add_u32 s62, s62, 0x40000
    s_and_b32 s62, s62, 0x7fffff
    s_waitcnt vmcnt(12)
    s_branch op_join_120
op_late_119:
    s_waitcnt vmcnt(0)
op_join_120:
    s_barrier
    s_cmp_eq_u32 s30, 0
    s_cbranch_scc1 k12_ool_121
k12_oolret_122:
    s_bitcmp0_b32 s33, 0
    s_cbranch_scc1 k12_ool_125
k12_oolret_126:
    ds_read_b64_tr_b16 a[0:1], v64 offset:0
    ds_read_b64_tr_b16 a[2:3], v64 offset:4096
    ds_read_b64_tr_b16 a[4:5], v65 offset:0
    ds_read_b64_tr_b16 a[6:7], v65 offset:4096
    ds_read_b64_tr_b16 a[8:9], v66 offset:0
    ds_read_b64_tr_b16 a[10:11], v66 offset:4096
    ds_read_b64_tr_b16 a[12:13], v67 offset:0
    ds_read_b64_tr_b16 a[14:15], v67 offset:4096
    ds_read_b64_tr_b16 a[16:17], v68 offset:0
    ds_read_b64_tr_b16 a[18:19], v68 offset:4096
    ds_read_b64_tr_b16 a[20:21], v69 offset:0
    ds_read_b64_tr_b16 a[22:23], v69 offset:4096
    ds_read_b64_tr_b16 a[24:25], v70 offset:0
    ds_read_b64_tr_b16 a[26:27], v70 offset:4096
    ds_read_b64_tr_b16 a[28:29], v71 offset:0
    ds_read_b64_tr_b16 a[30:31], v71 offset:4096
    ds_read_b64_tr_b16 a[32:33], v64 offset:8192
    ds_read_b64_tr_b16 a[34:35], v64 offset:12288
    ds_read_b64_tr_b16 a[36:37], v65 offset:8192
    ds_read_b64_tr_b16 a[38:39], v65 offset:12288
    ds_read_b64_tr_b16 a[40:41], v66 offset:8192
    ds_read_b64_tr_b16 a[42:43], v66 offset:12288
    ds_read_b64_tr_b16 a[44:45], v67 offset:8192
    ds_read_b64_tr_b16 a[46:47], v67 offset:12288
    ds_read_b64_tr_b16 a[48:49], v68 offset:8192
    ds_read_b64_tr_b16 a[50:51], v68 offset:12288
    ds_read_b64_tr_b16 a[52:53], v69 offset:8192
    ds_read_b64_tr_b16 a[54:55], v69 offset:12288
    ds_read_b64_tr_b16 a[56:57], v70 offset:8192
    ds_read_b64_tr_b16 a[58:59], v70 offset:12288
    ds_read_b64_tr_b16 a[60:61], v71 offset:8192
    ds_read_b64_tr_b16 a[62:63], v71 offset:12288
    s_add_u32 s24, s6, 0x4000000
    s_addc_u32 s25, s7, 0
    s_and_b32 s25, s25, 0xffff
    s_mov_b32 s26, 0x400000
    s_mov_b32 s27, 0x00020000
    s_add_u32 s36, s6, 0x5000000
    s_addc_u32 s37, s7, 0
    s_and_b32 s37, s37, 0xffff
    s_mov_b32 s38, 0x800000
    s_mov_b32 s39, 0x00020000
    s_add_u32 s48, s6, 0x4807000
    s_addc_u32 s49, s7, 0
    s_and_b32 s49, s49, 0xffff
    s_mov_b32 s50, 0x8000
    s_mov_b32 s51, 0x00020000
    s_lshl_b32 s52, s2, 14
    s_add_u32 s52, s52, s60
    s_xor_b32 s53, s52, 0x10000
    s_lshl_b32 s57, s2, 7
    s_xor_b32 s58, s57, 0x200
    v_lshrrev_b32 v56, 4, v1
    s_lshl_b32 s31, s30, 6
    s_and_b32 s31, s31, 64
    v_add_u32 v56, s31, v56
    s_mov_b32 s31, (code_end-op_tail)/128
    v_min_u32 v56, s31, v56
    s_getpc_b64 s[40:41]
pc_127:
    s_add_u32 s40, s40, op_tail-pc_127
    s_addc_u32 s41, s41, 0
    v_lshlrev_b32 v82, 7, v56
    v_mov_b32 v83, s41
    v_add_co_u32 v82, vcc, s40, v82
    s_nop 1
    v_addc_co_u32 v83, vcc, 0, v83, vcc
    v_lshlrev_b32 v94, 3, v1
    s_and_b32 s35, s2, 7
    s_mul_i32 s35, s35, 28
    s_lshr_b32 s31, s2, 3
    s_add_u32 s55, s35, s31
    s_lshl_b32 s3, s55, 15
    s_lshl_b32 s31, s30, 13
    s_add_u32 s3, s3, s31
    s_add_u32 s35, s31, 65536
    s_mov_b32 s63, 0
    s_waitcnt vmcnt(8) lgkmcnt(0)
    s_mov_b32 s20, s28
    s_and_b32 s21, s29, 0xffff
    s_mov_b32 s22, 0x400000
    s_mov_b32 s23, 0x00020000
    s_mov_b32 s44, s42
    s_and_b32 s45, s43, 0xffff
    s_mov_b32 s46, 0x800
    s_mov_b32 s47, 0x00020000
op_loop_128:
    v_mfma_f32_16x16x32_bf16 v[160:163], a[16:19], a[128:131], v[160:163]
    s_add_u32 m0, s60, 49152
    ds_read_b64_tr_b16 a[64:65], v64 offset:16384
    ds_read_b64_tr_b16 a[66:67], v64 offset:20480
    v_mfma_f32_16x16x32_bf16 v[160:163], a[48:51], a[136:139], v[160:163]
    buffer_load_dwordx4 v90, s[12:15], s61 offen offset:0 lds
    ds_read_b64_tr_b16 a[68:69], v65 offset:16384
    v_mfma_f32_16x16x32_bf16 v[164:167], a[16:19], a[132:135], v[164:167]
    ds_read_b64_tr_b16 a[70:71], v65 offset:20480
    ds_read_b64_tr_b16 a[72:73], v66 offset:16384
    v_mfma_f32_16x16x32_bf16 v[164:167], a[48:51], a[140:143], v[164:167]
    buffer_load_dwordx4 v91, s[12:15], s61 offen offset:1024 lds
    ds_read_b64_tr_b16 a[74:75], v66 offset:20480
    v_mfma_f32_16x16x32_bf16 v[168:171], a[20:23], a[128:131], v[168:171]
    ds_read_b64_tr_b16 a[76:77], v67 offset:16384
    ds_read_b64_tr_b16 a[78:79], v67 offset:20480
    v_mfma_f32_16x16x32_bf16 v[168:171], a[52:55], a[136:139], v[168:171]
    ds_read_b64_tr_b16 a[80:81], v68 offset:16384
    v_mfma_f32_16x16x32_bf16 v[172:175], a[20:23], a[132:135], v[172:175]
    ds_read_b64_tr_b16 a[82:83], v68 offset:20480
    v_mfma_f32_16x16x32_bf16 v[172:175], a[52:55], a[140:143], v[172:175]
    buffer_load_dwordx4 v92, s[12:15], s61 offen offset:2048 lds
    ds_read_b64_tr_b16 a[84:85], v69 offset:16384
    v_mfma_f32_16x16x32_bf16 v[176:179], a[24:27], a[128:131], v[176:179]
    ds_read_b64_tr_b16 a[86:87], v69 offset:20480
    ds_read_b64_tr_b16 a[88:89], v70 offset:16384
    v_mfma_f32_16x16x32_bf16 v[176:179], a[56:59], a[136:139], v[176:179]
    ds_read_b64_tr_b16 a[90:91], v70 offset:20480
    v_mfma_f32_16x16x32_bf16 v[180:183], a[24:27], a[132:135], v[180:183]
    buffer_load_dwordx4 v93, s[12:15], s61 offen offset:3072 lds
    ds_read_b64_tr_b16 a[92:93], v71 offset:16384
    v_mfma_f32_16x16x32_bf16 v[180:183], a[56:59], a[140:143], v[180:183]
    ds_read_b64_tr_b16 a[94:95], v71 offset:20480
    ds_read_b64_tr_b16 a[96:97], v64 offset:24576
    v_mfma_f32_16x16x32_bf16 v[184:187], a[28:31], a[128:131], v[184:187]
    ds_read_b64_tr_b16 a[98:99], v64 offset:28672
    v_mfma_f32_16x16x32_bf16 v[184:187], a[60:63], a[136:139], v[184:187]
    ds_read_b64_tr_b16 a[100:101], v65 offset:24576
    v_mfma_f32_16x16x32_bf16 v[188:191], a[28:31], a[132:135], v[188:191]
    buffer_load_dwordx4 a[176:179], v88, s[8:11], s62 offen offset:0 sc1
    ds_read_b64_tr_b16 a[102:103], v65 offset:28672
    v_mfma_f32_16x16x32_bf16 v[188:191], a[60:63], a[140:143], v[188:191]
    s_add_u32 s61, s61, 0x20000
    s_and_b32 s61, s61, 0x3fffff
    ds_read_b64_tr_b16 a[104:105], v66 offset:24576
    ds_read_b64_tr_b16 a[106:107], v66 offset:28672
    v_mfma_f32_16x16x32_bf16 v[128:131], a[0:3], a[128:131], v[128:131]
    ds_read_b64_tr_b16 a[108:109], v67 offset:24576
    v_mfma_f32_16x16x32_bf16 v[128:131], a[32:35], a[136:139], v[128:131]
    buffer_load_dwordx4 a[180:183], v88, s[8:11], s62 offen offset:1024 sc1
    ds_read_b64_tr_b16 a[110:111], v67 offset:28672
    v_mfma_f32_16x16x32_bf16 v[132:135], a[0:3], a[132:135], v[132:135]
    ds_read_b64_tr_b16 a[112:113], v68 offset:24576
    v_mfma_f32_16x16x32_bf16 v[132:135], a[32:35], a[140:143], v[132:135]
    ds_read_b64_tr_b16 a[114:115], v68 offset:28672
    ds_read_b64_tr_b16 a[116:117], v69 offset:24576
    v_mfma_f32_16x16x32_bf16 v[136:139], a[4:7], a[128:131], v[136:139]
    ds_read_b64_tr_b16 a[118:119], v69 offset:28672
    v_mfma_f32_16x16x32_bf16 v[136:139], a[36:39], a[136:139], v[136:139]
    buffer_load_dwordx4 a[184:187], v89, s[8:11], s62 offen offset:0 sc1
    ds_read_b64_tr_b16 a[120:121], v70 offset:24576
    v_mfma_f32_16x16x32_bf16 v[140:143], a[4:7], a[132:135], v[140:143]
    ds_read_b64_tr_b16 a[122:123], v70 offset:28672
    ds_read_b64_tr_b16 a[124:125], v71 offset:24576
    v_mfma_f32_16x16x32_bf16 v[140:143], a[36:39], a[140:143], v[140:143]
    ds_read_b64_tr_b16 a[126:127], v71 offset:28672
    v_mfma_f32_16x16x32_bf16 v[144:147], a[8:11], a[128:131], v[144:147]
    buffer_load_dwordx4 a[188:191], v89, s[8:11], s62 offen offset:1024 sc1
    v_mfma_f32_16x16x32_bf16 v[144:147], a[40:43], a[136:139], v[144:147]
    v_mfma_f32_16x16x32_bf16 v[148:151], a[8:11], a[132:135], v[148:151]
    v_mfma_f32_16x16x32_bf16 v[148:151], a[40:43], a[140:143], v[148:151]
    v_mfma_f32_16x16x32_bf16 v[152:155], a[12:15], a[128:131], v[152:155]
    s_cmp_eq_u32 s63, 7
    s_cbranch_scc1 k12_ool_131
k12_oolret_132:
    v_mfma_f32_16x16x32_bf16 v[152:155], a[44:47], a[136:139], v[152:155]
    s_add_u32 s62, s62, 0x40000
    s_and_b32 s62, s62, 0x7fffff
    v_mfma_f32_16x16x32_bf16 v[156:159], a[12:15], a[132:135], v[156:159]
    v_mfma_f32_16x16x32_bf16 v[156:159], a[44:47], a[140:143], v[156:159]
    s_waitcnt vmcnt(12) lgkmcnt(0)
    s_barrier
    v_mfma_f32_16x16x32_bf16 v[160:163], a[80:83], a[144:147], v[160:163]
    s_add_u32 s32, s63, 1
    s_lshr_b32 s32, s32, 1
    ds_read_b64_tr_b16 a[0:1], v64 offset:32768
    v_cmp_le_u32 vcc, 4, v74
    v_mfma_f32_16x16x32_bf16 v[160:163], a[112:115], a[152:155], v[160:163]
    s_add_u32 m0, s60, 0
    ds_read_b64_tr_b16 a[2:3], v64 offset:36864
    ds_read_b64_tr_b16 a[4:5], v65 offset:32768
    v_mfma_f32_16x16x32_bf16 v[164:167], a[80:83], a[148:151], v[164:167]
    s_or_b32 s33, vcc_lo, 16
    buffer_load_dwordx4 v90, s[12:15], s61 offen offset:0 lds
    ds_read_b64_tr_b16 a[6:7], v65 offset:36864
    v_mfma_f32_16x16x32_bf16 v[164:167], a[112:115], a[156:159], v[164:167]
    ds_read_b64_tr_b16 a[8:9], v66 offset:32768
    ds_read_b64_tr_b16 a[10:11], v66 offset:36864
    v_mfma_f32_16x16x32_bf16 v[168:171], a[84:87], a[144:147], v[168:171]
    buffer_load_dwordx4 v91, s[12:15], s61 offen offset:1024 lds
    ds_read_b64_tr_b16 a[12:13], v67 offset:32768
    v_mfma_f32_16x16x32_bf16 v[168:171], a[116:119], a[152:155], v[168:171]
    ds_read_b64_tr_b16 a[14:15], v67 offset:36864
    ds_read_b64_tr_b16 a[16:17], v68 offset:32768
    v_mfma_f32_16x16x32_bf16 v[172:175], a[84:87], a[148:151], v[172:175]
    s_bitcmp0_b32 s33, s32
    s_cbranch_scc1 k12_ool_135
k12_oolret_136:
    v_mfma_f32_16x16x32_bf16 v[172:175], a[116:119], a[156:159], v[172:175]
    ds_read_b64_tr_b16 a[18:19], v68 offset:36864
    ds_read_b64_tr_b16 a[20:21], v69 offset:32768
    v_mfma_f32_16x16x32_bf16 v[176:179], a[88:91], a[144:147], v[176:179]
    buffer_load_dwordx4 v92, s[12:15], s61 offen offset:2048 lds
    ds_read_b64_tr_b16 a[22:23], v69 offset:36864
    v_mfma_f32_16x16x32_bf16 v[176:179], a[120:123], a[152:155], v[176:179]
    ds_read_b64_tr_b16 a[24:25], v70 offset:32768
    ds_read_b64_tr_b16 a[26:27], v70 offset:36864
    v_mfma_f32_16x16x32_bf16 v[180:183], a[88:91], a[148:151], v[180:183]
    buffer_load_dwordx4 v93, s[12:15], s61 offen offset:3072 lds
    ds_read_b64_tr_b16 a[28:29], v71 offset:32768
    v_mfma_f32_16x16x32_bf16 v[180:183], a[120:123], a[156:159], v[180:183]
    ds_read_b64_tr_b16 a[30:31], v71 offset:36864
    ds_read_b64_tr_b16 a[32:33], v64 offset:40960
    v_mfma_f32_16x16x32_bf16 v[184:187], a[92:95], a[144:147], v[184:187]
    ds_read_b64_tr_b16 a[34:35], v64 offset:45056
    v_mfma_f32_16x16x32_bf16 v[184:187], a[124:127], a[152:155], v[184:187]
    ds_read_b64_tr_b16 a[36:37], v65 offset:40960
    v_mfma_f32_16x16x32_bf16 v[188:191], a[92:95], a[148:151], v[188:191]
    buffer_load_dwordx4 a[128:131], v88, s[8:11], s62 offen offset:0 sc1
    ds_read_b64_tr_b16 a[38:39], v65 offset:45056
    v_mfma_f32_16x16x32_bf16 v[188:191], a[124:127], a[156:159], v[188:191]
    s_add_u32 s61, s61, 0x20000
    s_and_b32 s61, s61, 0x3fffff
    ds_read_b64_tr_b16 a[40:41], v66 offset:40960
    ds_read_b64_tr_b16 a[42:43], v66 offset:45056
    v_mfma_f32_16x16x32_bf16 v[128:131], a[64:67], a[144:147], v[128:131]
    ds_read_b64_tr_b16 a[44:45], v67 offset:40960
    v_mfma_f32_16x16x32_bf16 v[128:131], a[96:99], a[152:155], v[128:131]
    buffer_load_dwordx4 a[132:135], v88, s[8:11], s62 offen offset:1024 sc1
    ds_read_b64_tr_b16 a[46:47], v67 offset:45056
    v_mfma_f32_16x16x32_bf16 v[132:135], a[64:67], a[148:151], v[132:135]
    ds_read_b64_tr_b16 a[48:49], v68 offset:40960
    v_mfma_f32_16x16x32_bf16 v[132:135], a[96:99], a[156:159], v[132:135]
    ds_read_b64_tr_b16 a[50:51], v68 offset:45056
    ds_read_b64_tr_b16 a[52:53], v69 offset:40960
    v_mfma_f32_16x16x32_bf16 v[136:139], a[68:71], a[144:147], v[136:139]
    ds_read_b64_tr_b16 a[54:55], v69 offset:45056
    v_mfma_f32_16x16x32_bf16 v[136:139], a[100:103], a[152:155], v[136:139]
    buffer_load_dwordx4 a[136:139], v89, s[8:11], s62 offen offset:0 sc1
    ds_read_b64_tr_b16 a[56:57], v70 offset:40960
    v_mfma_f32_16x16x32_bf16 v[140:143], a[68:71], a[148:151], v[140:143]
    ds_read_b64_tr_b16 a[58:59], v70 offset:45056
    ds_read_b64_tr_b16 a[60:61], v71 offset:40960
    v_mfma_f32_16x16x32_bf16 v[140:143], a[100:103], a[156:159], v[140:143]
    ds_read_b64_tr_b16 a[62:63], v71 offset:45056
    v_mfma_f32_16x16x32_bf16 v[144:147], a[72:75], a[144:147], v[144:147]
    buffer_load_dwordx4 a[140:143], v89, s[8:11], s62 offen offset:1024 sc1
    v_mfma_f32_16x16x32_bf16 v[144:147], a[104:107], a[152:155], v[144:147]
    v_mfma_f32_16x16x32_bf16 v[148:151], a[72:75], a[148:151], v[148:151]
    s_cmp_eq_u32 s63, 6
    s_cbranch_scc1 k12_ool_137
k12_oolret_138:
    v_mfma_f32_16x16x32_bf16 v[148:151], a[104:107], a[156:159], v[148:151]
    v_mfma_f32_16x16x32_bf16 v[152:155], a[76:79], a[144:147], v[152:155]
    v_mfma_f32_16x16x32_bf16 v[152:155], a[108:111], a[152:155], v[152:155]
    s_add_u32 s62, s62, 0x40000
    s_and_b32 s62, s62, 0x7fffff
    v_mfma_f32_16x16x32_bf16 v[156:159], a[76:79], a[148:151], v[156:159]
    v_mfma_f32_16x16x32_bf16 v[156:159], a[108:111], a[156:159], v[156:159]
    s_waitcnt vmcnt(12) lgkmcnt(0)
    s_barrier
    v_mfma_f32_16x16x32_bf16 v[160:163], a[16:19], a[160:163], v[160:163]
    s_add_u32 m0, s60, 16384
    buffer_load_dword v74, v73, s[16:19], s59 offen sc1
    ds_read_b64_tr_b16 a[64:65], v64 offset:49152
    v_mfma_f32_16x16x32_bf16 v[160:163], a[48:51], a[168:171], v[160:163]
    buffer_load_dwordx4 v90, s[12:15], s61 offen offset:0 lds
    ds_read_b64_tr_b16 a[66:67], v64 offset:53248
    v_mfma_f32_16x16x32_bf16 v[164:167], a[16:19], a[164:167], v[164:167]
    ds_read_b64_tr_b16 a[68:69], v65 offset:49152
    ds_read_b64_tr_b16 a[70:71], v65 offset:53248
    v_mfma_f32_16x16x32_bf16 v[164:167], a[48:51], a[172:175], v[164:167]
    ds_read_b64_tr_b16 a[72:73], v66 offset:49152
    ds_read_b64_tr_b16 a[74:75], v66 offset:53248
    v_mfma_f32_16x16x32_bf16 v[168:171], a[20:23], a[160:163], v[168:171]
    buffer_load_dwordx4 v91, s[12:15], s61 offen offset:1024 lds
    ds_read_b64_tr_b16 a[76:77], v67 offset:49152
    v_mfma_f32_16x16x32_bf16 v[168:171], a[52:55], a[168:171], v[168:171]
    ds_read_b64_tr_b16 a[78:79], v67 offset:53248
    ds_read_b64_tr_b16 a[80:81], v68 offset:49152
    v_mfma_f32_16x16x32_bf16 v[172:175], a[20:23], a[164:167], v[172:175]
    ds_read_b64_tr_b16 a[82:83], v68 offset:53248
    v_mfma_f32_16x16x32_bf16 v[172:175], a[52:55], a[172:175], v[172:175]
    buffer_load_dwordx4 v92, s[12:15], s61 offen offset:2048 lds
    ds_read_b64_tr_b16 a[84:85], v69 offset:49152
    v_mfma_f32_16x16x32_bf16 v[176:179], a[24:27], a[160:163], v[176:179]
    ds_read_b64_tr_b16 a[86:87], v69 offset:53248
    ds_read_b64_tr_b16 a[88:89], v70 offset:49152
    v_mfma_f32_16x16x32_bf16 v[176:179], a[56:59], a[168:171], v[176:179]
    ds_read_b64_tr_b16 a[90:91], v70 offset:53248
    v_mfma_f32_16x16x32_bf16 v[180:183], a[24:27], a[164:167], v[180:183]
    buffer_load_dwordx4 v93, s[12:15], s61 offen offset:3072 lds
    ds_read_b64_tr_b16 a[92:93], v71 offset:49152
    v_mfma_f32_16x16x32_bf16 v[180:183], a[56:59], a[172:175], v[180:183]
    ds_read_b64_tr_b16 a[94:95], v71 offset:53248
    ds_read_b64_tr_b16 a[96:97], v64 offset:57344
    v_mfma_f32_16x16x32_bf16 v[184:187], a[28:31], a[160:163], v[184:187]
    ds_read_b64_tr_b16 a[98:99], v64 offset:61440
    v_mfma_f32_16x16x32_bf16 v[184:187], a[60:63], a[168:171], v[184:187]
    ds_read_b64_tr_b16 a[100:101], v65 offset:57344
    v_mfma_f32_16x16x32_bf16 v[188:191], a[28:31], a[164:167], v[188:191]
    buffer_load_dwordx4 a[144:147], v88, s[8:11], s62 offen offset:0 sc1
    ds_read_b64_tr_b16 a[102:103], v65 offset:61440
    v_mfma_f32_16x16x32_bf16 v[188:191], a[60:63], a[172:175], v[188:191]
    s_add_u32 s61, s61, 0x20000
    s_and_b32 s61, s61, 0x3fffff
    ds_read_b64_tr_b16 a[104:105], v66 offset:57344
    ds_read_b64_tr_b16 a[106:107], v66 offset:61440
    v_mfma_f32_16x16x32_bf16 v[128:131], a[0:3], a[160:163], v[128:131]
    ds_read_b64_tr_b16 a[108:109], v67 offset:57344
    v_mfma_f32_16x16x32_bf16 v[128:131], a[32:35], a[168:171], v[128:131]
    buffer_load_dwordx4 a[148:151], v88, s[8:11], s62 offen offset:1024 sc1
    ds_read_b64_tr_b16 a[110:111], v67 offset:61440
    v_mfma_f32_16x16x32_bf16 v[132:135], a[0:3], a[164:167], v[132:135]
    ds_read_b64_tr_b16 a[112:113], v68 offset:57344
    v_mfma_f32_16x16x32_bf16 v[132:135], a[32:35], a[172:175], v[132:135]
    ds_read_b64_tr_b16 a[114:115], v68 offset:61440
    ds_read_b64_tr_b16 a[116:117], v69 offset:57344
    v_mfma_f32_16x16x32_bf16 v[136:139], a[4:7], a[160:163], v[136:139]
    ds_read_b64_tr_b16 a[118:119], v69 offset:61440
    v_mfma_f32_16x16x32_bf16 v[136:139], a[36:39], a[168:171], v[136:139]
    buffer_load_dwordx4 a[152:155], v89, s[8:11], s62 offen offset:0 sc1
    ds_read_b64_tr_b16 a[120:121], v70 offset:57344
    v_mfma_f32_16x16x32_bf16 v[140:143], a[4:7], a[164:167], v[140:143]
    ds_read_b64_tr_b16 a[122:123], v70 offset:61440
    ds_read_b64_tr_b16 a[124:125], v71 offset:57344
    v_mfma_f32_16x16x32_bf16 v[140:143], a[36:39], a[172:175], v[140:143]
    ds_read_b64_tr_b16 a[126:127], v71 offset:61440
    v_mfma_f32_16x16x32_bf16 v[144:147], a[8:11], a[160:163], v[144:147]
    buffer_load_dwordx4 a[156:159], v89, s[8:11], s62 offen offset:1024 sc1
    v_mfma_f32_16x16x32_bf16 v[144:147], a[40:43], a[168:171], v[144:147]
    v_mfma_f32_16x16x32_bf16 v[148:151], a[8:11], a[164:167], v[148:151]
    v_mfma_f32_16x16x32_bf16 v[148:151], a[40:43], a[172:175], v[148:151]
    v_mfma_f32_16x16x32_bf16 v[152:155], a[12:15], a[160:163], v[152:155]
    v_mfma_f32_16x16x32_bf16 v[152:155], a[44:47], a[168:171], v[152:155]
    s_add_u32 s62, s62, 0x40000
    s_and_b32 s62, s62, 0x7fffff
    v_mfma_f32_16x16x32_bf16 v[156:159], a[12:15], a[164:167], v[156:159]
    v_mfma_f32_16x16x32_bf16 v[156:159], a[44:47], a[172:175], v[156:159]
    s_waitcnt vmcnt(12) lgkmcnt(0)
    s_barrier
    v_mfma_f32_16x16x32_bf16 v[160:163], a[80:83], a[176:179], v[160:163]
    s_add_u32 m0, s60, 32768
    ds_read_b64_tr_b16 a[0:1], v64 offset:0
    ds_read_b64_tr_b16 a[2:3], v64 offset:4096
    v_mfma_f32_16x16x32_bf16 v[160:163], a[112:115], a[184:187], v[160:163]
    buffer_load_dwordx4 v90, s[12:15], s61 offen offset:0 lds
    ds_read_b64_tr_b16 a[4:5], v65 offset:0
    v_mfma_f32_16x16x32_bf16 v[164:167], a[80:83], a[180:183], v[164:167]
    ds_read_b64_tr_b16 a[6:7], v65 offset:4096
    ds_read_b64_tr_b16 a[8:9], v66 offset:0
    v_mfma_f32_16x16x32_bf16 v[164:167], a[112:115], a[188:191], v[164:167]
    buffer_load_dwordx4 v91, s[12:15], s61 offen offset:1024 lds
    ds_read_b64_tr_b16 a[10:11], v66 offset:4096
    v_mfma_f32_16x16x32_bf16 v[168:171], a[84:87], a[176:179], v[168:171]
    ds_read_b64_tr_b16 a[12:13], v67 offset:0
    ds_read_b64_tr_b16 a[14:15], v67 offset:4096
    v_mfma_f32_16x16x32_bf16 v[168:171], a[116:119], a[184:187], v[168:171]
    ds_read_b64_tr_b16 a[16:17], v68 offset:0
    v_mfma_f32_16x16x32_bf16 v[172:175], a[84:87], a[180:183], v[172:175]
    ds_read_b64_tr_b16 a[18:19], v68 offset:4096
    v_mfma_f32_16x16x32_bf16 v[172:175], a[116:119], a[188:191], v[172:175]
    buffer_load_dwordx4 v92, s[12:15], s61 offen offset:2048 lds
    ds_read_b64_tr_b16 a[20:21], v69 offset:0
    v_mfma_f32_16x16x32_bf16 v[176:179], a[88:91], a[176:179], v[176:179]
    ds_read_b64_tr_b16 a[22:23], v69 offset:4096
    ds_read_b64_tr_b16 a[24:25], v70 offset:0
    v_mfma_f32_16x16x32_bf16 v[176:179], a[120:123], a[184:187], v[176:179]
    ds_read_b64_tr_b16 a[26:27], v70 offset:4096
    v_mfma_f32_16x16x32_bf16 v[180:183], a[88:91], a[180:183], v[180:183]
    buffer_load_dwordx4 v93, s[12:15], s61 offen offset:3072 lds
    ds_read_b64_tr_b16 a[28:29], v71 offset:0
    v_mfma_f32_16x16x32_bf16 v[180:183], a[120:123], a[188:191], v[180:183]
    ds_read_b64_tr_b16 a[30:31], v71 offset:4096
    ds_read_b64_tr_b16 a[32:33], v64 offset:8192
    v_mfma_f32_16x16x32_bf16 v[184:187], a[92:95], a[176:179], v[184:187]
    ds_read_b64_tr_b16 a[34:35], v64 offset:12288
    v_mfma_f32_16x16x32_bf16 v[184:187], a[124:127], a[184:187], v[184:187]
    ds_read_b64_tr_b16 a[36:37], v65 offset:8192
    v_mfma_f32_16x16x32_bf16 v[188:191], a[92:95], a[180:183], v[188:191]
    buffer_load_dwordx4 a[160:163], v88, s[8:11], s62 offen offset:0 sc1
    ds_read_b64_tr_b16 a[38:39], v65 offset:12288
    v_mfma_f32_16x16x32_bf16 v[188:191], a[124:127], a[188:191], v[188:191]
    s_add_u32 s61, s61, 0x20000
    s_and_b32 s61, s61, 0x3fffff
    ds_read_b64_tr_b16 a[40:41], v66 offset:8192
    ds_read_b64_tr_b16 a[42:43], v66 offset:12288
    v_mfma_f32_16x16x32_bf16 v[128:131], a[64:67], a[176:179], v[128:131]
    ds_read_b64_tr_b16 a[44:45], v67 offset:8192
    v_mfma_f32_16x16x32_bf16 v[128:131], a[96:99], a[184:187], v[128:131]
    buffer_load_dwordx4 a[164:167], v88, s[8:11], s62 offen offset:1024 sc1
    ds_read_b64_tr_b16 a[46:47], v67 offset:12288
    v_mfma_f32_16x16x32_bf16 v[132:135], a[64:67], a[180:183], v[132:135]
    ds_read_b64_tr_b16 a[48:49], v68 offset:8192
    v_mfma_f32_16x16x32_bf16 v[132:135], a[96:99], a[188:191], v[132:135]
    ds_read_b64_tr_b16 a[50:51], v68 offset:12288
    ds_read_b64_tr_b16 a[52:53], v69 offset:8192
    v_mfma_f32_16x16x32_bf16 v[136:139], a[68:71], a[176:179], v[136:139]
    ds_read_b64_tr_b16 a[54:55], v69 offset:12288
    v_mfma_f32_16x16x32_bf16 v[136:139], a[100:103], a[184:187], v[136:139]
    buffer_load_dwordx4 a[168:171], v89, s[8:11], s62 offen offset:0 sc1
    ds_read_b64_tr_b16 a[56:57], v70 offset:8192
    v_mfma_f32_16x16x32_bf16 v[140:143], a[68:71], a[180:183], v[140:143]
    ds_read_b64_tr_b16 a[58:59], v70 offset:12288
    ds_read_b64_tr_b16 a[60:61], v71 offset:8192
    v_mfma_f32_16x16x32_bf16 v[140:143], a[100:103], a[188:191], v[140:143]
    ds_read_b64_tr_b16 a[62:63], v71 offset:12288
    v_mfma_f32_16x16x32_bf16 v[144:147], a[72:75], a[176:179], v[144:147]
    buffer_load_dwordx4 a[172:175], v89, s[8:11], s62 offen offset:1024 sc1
    v_mfma_f32_16x16x32_bf16 v[144:147], a[104:107], a[184:187], v[144:147]
    v_mfma_f32_16x16x32_bf16 v[148:151], a[72:75], a[180:183], v[148:151]
    v_mfma_f32_16x16x32_bf16 v[148:151], a[104:107], a[188:191], v[148:151]
    v_mfma_f32_16x16x32_bf16 v[152:155], a[76:79], a[176:179], v[152:155]
    v_mfma_f32_16x16x32_bf16 v[152:155], a[108:111], a[184:187], v[152:155]
    s_add_u32 s62, s62, 0x40000
    s_and_b32 s62, s62, 0x7fffff
    v_mfma_f32_16x16x32_bf16 v[156:159], a[76:79], a[180:183], v[156:159]
    s_add_u32 s63, s63, 1
    v_mfma_f32_16x16x32_bf16 v[156:159], a[108:111], a[188:191], v[156:159]
    s_waitcnt vmcnt(12) lgkmcnt(0)
    s_barrier
    s_cmp_lt_u32 s63, 8
    s_cbranch_scc1 op_loop_128
op_tail:
    s_nop 1
    v_cvt_pk_bf16_f32 v160, v160, v161
    v_cvt_pk_bf16_f32 v161, v162, v163
    v_cvt_pk_bf16_f32 v162, v164, v165
    v_cvt_pk_bf16_f32 v163, v166, v167
    v_min_u32 v160, -2, v160
    v_min_u32 v161, -2, v161
    v_min_u32 v162, -2, v162
    v_min_u32 v163, -2, v163
    buffer_store_dwordx4 v[160:163], v1, s[36:39], s52 offen offset:0 sc1
    v_cvt_pk_bf16_f32 v168, v168, v169
    v_cvt_pk_bf16_f32 v169, v170, v171
    v_cvt_pk_bf16_f32 v170, v172, v173
    v_cvt_pk_bf16_f32 v171, v174, v175
    v_min_u32 v168, -2, v168
    v_min_u32 v169, -2, v169
    v_min_u32 v170, -2, v170
    v_min_u32 v171, -2, v171
    buffer_store_dwordx4 v[168:171], v1, s[36:39], s52 offen offset:1024 sc1
    v_cvt_pk_bf16_f32 v176, v176, v177
    v_cvt_pk_bf16_f32 v177, v178, v179
    v_cvt_pk_bf16_f32 v178, v180, v181
    v_cvt_pk_bf16_f32 v179, v182, v183
    v_min_u32 v176, -2, v176
    v_min_u32 v177, -2, v177
    v_min_u32 v178, -2, v178
    v_min_u32 v179, -2, v179
    buffer_store_dwordx4 v[176:179], v1, s[36:39], s52 offen offset:2048 sc1
    v_cvt_pk_bf16_f32 v184, v184, v185
    v_cvt_pk_bf16_f32 v185, v186, v187
    v_cvt_pk_bf16_f32 v186, v188, v189
    v_cvt_pk_bf16_f32 v187, v190, v191
    v_min_u32 v184, -2, v184
    v_min_u32 v185, -2, v185
    v_min_u32 v186, -2, v186
    v_min_u32 v187, -2, v187
    buffer_store_dwordx4 v[184:187], v1, s[36:39], s52 offen offset:3072 sc1
    s_add_u32 s32, s6, 0x4800000
    s_addc_u32 s33, s7, 0
    s_and_b32 s33, s33, 0xffff
    s_mov_b32 s34, 0x6000
    s_mov_b32 s35, 0x00020000
    s_waitcnt vmcnt(4) lgkmcnt(0)
    v_lshlrev_b32 v58, 16, v192
    v_and_b32 v59, 0xffff0000, v192
    v_pk_add_f32 v[128:129], v[128:129], v[58:59]
    v_lshlrev_b32 v58, 16, v193
    v_and_b32 v59, 0xffff0000, v193
    v_pk_add_f32 v[130:131], v[130:131], v[58:59]
    v_lshlrev_b32 v58, 16, v200
    v_and_b32 v59, 0xffff0000, v200
    v_pk_add_f32 v[132:133], v[132:133], v[58:59]
    v_lshlrev_b32 v58, 16, v201
    v_and_b32 v59, 0xffff0000, v201
    v_pk_add_f32 v[134:135], v[134:135], v[58:59]
    v_lshlrev_b32 v58, 16, v194
    v_and_b32 v59, 0xffff0000, v194
    v_pk_add_f32 v[136:137], v[136:137], v[58:59]
    v_lshlrev_b32 v58, 16, v195
    v_and_b32 v59, 0xffff0000, v195
    v_pk_add_f32 v[138:139], v[138:139], v[58:59]
    v_lshlrev_b32 v58, 16, v202
    v_and_b32 v59, 0xffff0000, v202
    v_pk_add_f32 v[140:141], v[140:141], v[58:59]
    v_lshlrev_b32 v58, 16, v203
    v_and_b32 v59, 0xffff0000, v203
    v_pk_add_f32 v[142:143], v[142:143], v[58:59]
    v_lshlrev_b32 v58, 16, v196
    v_and_b32 v59, 0xffff0000, v196
    v_pk_add_f32 v[144:145], v[144:145], v[58:59]
    v_lshlrev_b32 v58, 16, v197
    v_and_b32 v59, 0xffff0000, v197
    v_pk_add_f32 v[146:147], v[146:147], v[58:59]
    v_lshlrev_b32 v58, 16, v204
    v_and_b32 v59, 0xffff0000, v204
    v_pk_add_f32 v[148:149], v[148:149], v[58:59]
    v_lshlrev_b32 v58, 16, v205
    v_and_b32 v59, 0xffff0000, v205
    v_pk_add_f32 v[150:151], v[150:151], v[58:59]
    v_lshlrev_b32 v58, 16, v198
    v_and_b32 v59, 0xffff0000, v198
    v_pk_add_f32 v[152:153], v[152:153], v[58:59]
    v_lshlrev_b32 v58, 16, v199
    v_and_b32 v59, 0xffff0000, v199
    v_pk_add_f32 v[154:155], v[154:155], v[58:59]
    v_lshlrev_b32 v58, 16, v206
    v_and_b32 v59, 0xffff0000, v206
    v_pk_add_f32 v[156:157], v[156:157], v[58:59]
    v_lshlrev_b32 v58, 16, v207
    v_and_b32 v59, 0xffff0000, v207
    v_pk_add_f32 v[158:159], v[158:159], v[58:59]
    v_and_b32 v58, 1, v72
    v_lshrrev_b32 v59, 1, v72
    v_lshlrev_b32 v58, 5, v58
    v_lshl_add_u32 v58, v59, 4, v58
    v_lshlrev_b32 v59, 3, v72
    v_sub_u32 v58, v58, v59
    v_add_u32 v78, v78, v58
    v_add_u32 v79, v79, v58
    v_lshlrev_b32 v32, 16, v208
    v_and_b32 v33, 0xffff0000, v208
    v_lshlrev_b32 v34, 16, v209
    v_and_b32 v35, 0xffff0000, v209
    v_lshlrev_b32 v36, 16, v210
    v_and_b32 v37, 0xffff0000, v210
    v_lshlrev_b32 v38, 16, v211
    v_and_b32 v39, 0xffff0000, v211
    v_lshlrev_b32 v40, 16, v212
    v_and_b32 v41, 0xffff0000, v212
    v_lshlrev_b32 v42, 16, v213
    v_and_b32 v43, 0xffff0000, v213
    v_lshlrev_b32 v44, 16, v214
    v_and_b32 v45, 0xffff0000, v214
    v_lshlrev_b32 v46, 16, v215
    v_and_b32 v47, 0xffff0000, v215
    s_or_b32 s31, s54, s30
    s_cbranch_scc1 op_nowr_139
    v_pk_add_f32 v[56:57], v[32:33], v[34:35]
    v_pk_add_f32 v[56:57], v[56:57], v[36:37]
    v_pk_add_f32 v[56:57], v[56:57], v[38:39]
    v_pk_add_f32 v[56:57], v[56:57], v[40:41]
    v_pk_add_f32 v[56:57], v[56:57], v[42:43]
    v_pk_add_f32 v[56:57], v[56:57], v[44:45]
    v_pk_add_f32 v[56:57], v[56:57], v[46:47]
    v_add_f32 v56, v56, v57
    v_mov_b32 v57, v56
    s_nop 1
    v_permlane16_swap_b32 v56, v57
    s_nop 1
    v_add_f32 v56, v56, v57
    v_mov_b32 v57, v56
    s_nop 1
    v_permlane32_swap_b32 v56, v57
    s_nop 1
    v_add_f32 v56, v56, v57
    s_mov_b32 s31, 24704
    s_mov_b32 s34, 24708
    s_mov_b64 exec, 1
    buffer_atomic_add_f32 v56, v75, s[32:35], s31 offen
    s_mov_b64 exec, -1
    s_mov_b32 s34, 24576
op_nowr_139:
    v_mov_b32 v208, 0
    v_mov_b32 v209, 0
    v_mov_b32 v210, 0
    v_mov_b32 v211, 0
    v_mov_b32 v212, 0
    v_mov_b32 v213, 0
    v_mov_b32 v214, 0
    v_mov_b32 v215, 0
    v_mov_b32 v216, 0
    v_mov_b32 v217, 0
    v_mov_b32 v218, 0
    v_mov_b32 v219, 0
    s_mov_b32 s40, 1048576
op_xspin_140:
    buffer_load_dwordx4 v[224:227], v1, s[36:39], s53 offen offset:0 sc1
    buffer_load_dwordx4 v[228:231], v1, s[36:39], s53 offen offset:1024 sc1
    buffer_load_dwordx4 v[232:235], v1, s[36:39], s53 offen offset:2048 sc1
    buffer_load_dwordx4 v[236:239], v1, s[36:39], s53 offen offset:3072 sc1
    s_sub_u32 s40, s40, 1
    s_waitcnt vmcnt(0)
    s_cbranch_scc1 op_xok_141
    v_max3_u32 v56, v224, v225, v226
    v_max3_u32 v56, v56, v227, v228
    v_max3_u32 v56, v56, v229, v230
    v_max3_u32 v56, v56, v231, v232
    v_max3_u32 v56, v56, v233, v234
    v_max3_u32 v56, v56, v235, v236
    v_max3_u32 v56, v56, v237, v238
    v_max_u32 v56, v56, v239
    v_cmp_eq_u32 vcc, -1, v56
    s_cbranch_vccz op_xok_141
    s_sleep 2
    s_branch op_xspin_140
op_xok_141:
    v_lshlrev_b32 v56, 16, v224
    v_and_b32 v57, 0xffff0000, v224
    v_lshlrev_b32 v58, 16, v225
    v_and_b32 v59, 0xffff0000, v225
    v_pk_add_f32 v[128:129], v[128:129], v[56:57]
    v_pk_add_f32 v[130:131], v[130:131], v[58:59]
    v_cvt_pk_bf16_f32 v192, v128, v129
    v_cvt_pk_bf16_f32 v193, v130, v131
    v_lshlrev_b32 v128, 16, v192
    v_and_b32 v129, 0xffff0000, v192
    v_lshlrev_b32 v130, 16, v193
    v_and_b32 v131, 0xffff0000, v193
    v_pk_add_f32 v[208:209], v[208:209], v[128:129]
    v_pk_fma_f32 v[210:211], v[128:129], v[128:129], v[210:211]
    v_pk_fma_f32 v[212:213], v[128:129], v[32:33], v[212:213]
    v_pk_add_f32 v[208:209], v[208:209], v[130:131]
    v_pk_fma_f32 v[210:211], v[130:131], v[130:131], v[210:211]
    v_pk_fma_f32 v[212:213], v[130:131], v[34:35], v[212:213]
    v_lshlrev_b32 v56, 16, v226
    v_and_b32 v57, 0xffff0000, v226
    v_lshlrev_b32 v58, 16, v227
    v_and_b32 v59, 0xffff0000, v227
    v_pk_add_f32 v[132:133], v[132:133], v[56:57]
    v_pk_add_f32 v[134:135], v[134:135], v[58:59]
    v_cvt_pk_bf16_f32 v200, v132, v133
    v_cvt_pk_bf16_f32 v201, v134, v135
    v_lshlrev_b32 v132, 16, v200
    v_and_b32 v133, 0xffff0000, v200
    v_lshlrev_b32 v134, 16, v201
    v_and_b32 v135, 0xffff0000, v201
    v_pk_add_f32 v[214:215], v[214:215], v[132:133]
    v_pk_fma_f32 v[216:217], v[132:133], v[132:133], v[216:217]
    v_pk_fma_f32 v[218:219], v[132:133], v[32:33], v[218:219]
    v_pk_add_f32 v[214:215], v[214:215], v[134:135]
    v_pk_fma_f32 v[216:217], v[134:135], v[134:135], v[216:217]
    v_pk_fma_f32 v[218:219], v[134:135], v[34:35], v[218:219]
    v_lshlrev_b32 v56, 16, v228
    v_and_b32 v57, 0xffff0000, v228
    v_lshlrev_b32 v58, 16, v229
    v_and_b32 v59, 0xffff0000, v229
    v_pk_add_f32 v[136:137], v[136:137], v[56:57]
    v_pk_add_f32 v[138:139], v[138:139], v[58:59]
    v_cvt_pk_bf16_f32 v194, v136, v137
    v_cvt_pk_bf16_f32 v195, v138, v139
    v_lshlrev_b32 v136, 16, v194
    v_and_b32 v137, 0xffff0000, v194
    v_lshlrev_b32 v138, 16, v195
    v_and_b32 v139, 0xffff0000, v195
    v_permlane16_swap_b32 v192, v194
    v_permlane16_swap_b32 v193, v195
    buffer_store_dwordx4 v[192:195], v78, s[24:27], 0 offen offset:0 sc1
    v_pk_add_f32 v[208:209], v[208:209], v[136:137]
    v_pk_fma_f32 v[210:211], v[136:137], v[136:137], v[210:211]
    v_pk_fma_f32 v[212:213], v[136:137], v[36:37], v[212:213]
    v_pk_add_f32 v[208:209], v[208:209], v[138:139]
    v_pk_fma_f32 v[210:211], v[138:139], v[138:139], v[210:211]
    v_pk_fma_f32 v[212:213], v[138:139], v[38:39], v[212:213]
    v_lshlrev_b32 v56, 16, v230
    v_and_b32 v57, 0xffff0000, v230
    v_lshlrev_b32 v58, 16, v231
    v_and_b32 v59, 0xffff0000, v231
    v_pk_add_f32 v[140:141], v[140:141], v[56:57]
    v_pk_add_f32 v[142:143], v[142:143], v[58:59]
    v_cvt_pk_bf16_f32 v202, v140, v141
    v_cvt_pk_bf16_f32 v203, v142, v143
    v_lshlrev_b32 v140, 16, v202
    v_and_b32 v141, 0xffff0000, v202
    v_lshlrev_b32 v142, 16, v203
    v_and_b32 v143, 0xffff0000, v203
    v_permlane16_swap_b32 v200, v202
    v_permlane16_swap_b32 v201, v203
    buffer_store_dwordx4 v[200:203], v79, s[24:27], 0 offen offset:0 sc1
    v_pk_add_f32 v[214:215], v[214:215], v[140:141]
    v_pk_fma_f32 v[216:217], v[140:141], v[140:141], v[216:217]
    v_pk_fma_f32 v[218:219], v[140:141], v[36:37], v[218:219]
    v_pk_add_f32 v[214:215], v[214:215], v[142:143]
    v_pk_fma_f32 v[216:217], v[142:143], v[142:143], v[216:217]
    v_pk_fma_f32 v[218:219], v[142:143], v[38:39], v[218:219]
    v_lshlrev_b32 v56, 16, v232
    v_and_b32 v57, 0xffff0000, v232
    v_lshlrev_b32 v58, 16, v233
    v_and_b32 v59, 0xffff0000, v233
    v_pk_add_f32 v[144:145], v[144:145], v[56:57]
    v_pk_add_f32 v[146:147], v[146:147], v[58:59]
    v_cvt_pk_bf16_f32 v196, v144, v145
    v_cvt_pk_bf16_f32 v197, v146, v147
    v_lshlrev_b32 v144, 16, v196
    v_and_b32 v145, 0xffff0000, v196
    v_lshlrev_b32 v146, 16, v197
    v_and_b32 v147, 0xffff0000, v197
    v_pk_add_f32 v[208:209], v[208:209], v[144:145]
    v_pk_fma_f32 v[210:211], v[144:145], v[144:145], v[210:211]
    v_pk_fma_f32 v[212:213], v[144:145], v[40:41], v[212:213]
    v_pk_add_f32 v[208:209], v[208:209], v[146:147]
    v_pk_fma_f32 v[210:211], v[146:147], v[146:147], v[210:211]
    v_pk_fma_f32 v[212:213], v[146:147], v[42:43], v[212:213]
    v_lshlrev_b32 v56, 16, v234
    v_and_b32 v57, 0xffff0000, v234
    v_lshlrev_b32 v58, 16, v235
    v_and_b32 v59, 0xffff0000, v235
    v_pk_add_f32 v[148:149], v[148:149], v[56:57]
    v_pk_add_f32 v[150:151], v[150:151], v[58:59]
    v_cvt_pk_bf16_f32 v204, v148, v149
    v_cvt_pk_bf16_f32 v205, v150, v151
    v_lshlrev_b32 v148, 16, v204
    v_and_b32 v149, 0xffff0000, v204
    v_lshlrev_b32 v150, 16, v205
    v_and_b32 v151, 0xffff0000, v205
    v_pk_add_f32 v[214:215], v[214:215], v[148:149]
    v_pk_fma_f32 v[216:217], v[148:149], v[148:149], v[216:217]
    v_pk_fma_f32 v[218:219], v[148:149], v[40:41], v[218:219]
    v_pk_add_f32 v[214:215], v[214:215], v[150:151]
    v_pk_fma_f32 v[216:217], v[150:151], v[150:151], v[216:217]
    v_pk_fma_f32 v[218:219], v[150:151], v[42:43], v[218:219]
    v_lshlrev_b32 v56, 16, v236
    v_and_b32 v57, 0xffff0000, v236
    v_lshlrev_b32 v58, 16, v237
    v_and_b32 v59, 0xffff0000, v237
    v_pk_add_f32 v[152:153], v[152:153], v[56:57]
    v_pk_add_f32 v[154:155], v[154:155], v[58:59]
    v_cvt_pk_bf16_f32 v198, v152, v153
    v_cvt_pk_bf16_f32 v199, v154, v155
    v_lshlrev_b32 v152, 16, v198
    v_and_b32 v153, 0xffff0000, v198
    v_lshlrev_b32 v154, 16, v199
    v_and_b32 v155, 0xffff0000, v199
    v_permlane16_swap_b32 v196, v198
    v_permlane16_swap_b32 v197, v199
    buffer_store_dwordx4 v[196:199], v78, s[24:27], 0 offen offset:64 sc1
    v_pk_add_f32 v[208:209], v[208:209], v[152:153]
    v_pk_fma_f32 v[210:211], v[152:153], v[152:153], v[210:211]
    v_pk_fma_f32 v[212:213], v[152:153], v[44:45], v[212:213]
    v_pk_add_f32 v[208:209], v[208:209], v[154:155]
    v_pk_fma_f32 v[210:211], v[154:155], v[154:155], v[210:211]
    v_pk_fma_f32 v[212:213], v[154:155], v[46:47], v[212:213]
    v_lshlrev_b32 v56, 16, v238
    v_and_b32 v57, 0xffff0000, v238
    v_lshlrev_b32 v58, 16, v239
    v_and_b32 v59, 0xffff0000, v239
    v_pk_add_f32 v[156:157], v[156:157], v[56:57]
    v_pk_add_f32 v[158:159], v[158:159], v[58:59]
    v_cvt_pk_bf16_f32 v206, v156, v157
    v_cvt_pk_bf16_f32 v207, v158, v159
    v_lshlrev_b32 v156, 16, v206
    v_and_b32 v157, 0xffff0000, v206
    v_lshlrev_b32 v158, 16, v207
    v_and_b32 v159, 0xffff0000, v207
    v_permlane16_swap_b32 v204, v206
    v_permlane16_swap_b32 v205, v207
    buffer_store_dwordx4 v[204:207], v79, s[24:27], 0 offen offset:64 sc1
    v_pk_add_f32 v[214:215], v[214:215], v[156:157]
    v_pk_fma_f32 v[216:217], v[156:157], v[156:157], v[216:217]
    v_pk_fma_f32 v[218:219], v[156:157], v[44:45], v[218:219]
    v_pk_add_f32 v[214:215], v[214:215], v[158:159]
    v_pk_fma_f32 v[216:217], v[158:159], v[158:159], v[216:217]
    v_pk_fma_f32 v[218:219], v[158:159], v[46:47], v[218:219]
    v_add_f32 v48, v208, v209
    v_add_f32 v49, v210, v211
    v_add_f32 v50, v212, v213
    v_add_f32 v52, v214, v215
    v_add_f32 v53, v216, v217
    v_add_f32 v54, v218, v219
    v_mov_b32 v56, v48
    v_mov_b32 v57, v49
    v_mov_b32 v58, v50
    v_mov_b32 v59, v52
    v_mov_b32 v60, v53
    v_mov_b32 v61, v54
    s_nop 1
    v_permlane16_swap_b32 v48, v56
    v_permlane16_swap_b32 v49, v57
    v_permlane16_swap_b32 v50, v58
    v_permlane16_swap_b32 v52, v59
    v_permlane16_swap_b32 v53, v60
    v_permlane16_swap_b32 v54, v61
    s_nop 1
    v_add_f32 v48, v48, v56
    v_add_f32 v49, v49, v57
    v_add_f32 v50, v50, v58
    v_add_f32 v52, v52, v59
    v_add_f32 v53, v53, v60
    v_add_f32 v54, v54, v61
    v_mov_b32 v56, v48
    v_mov_b32 v57, v49
    v_mov_b32 v58, v50
    v_mov_b32 v59, v52
    v_mov_b32 v60, v53
    v_mov_b32 v61, v54
    s_nop 1
    v_permlane32_swap_b32 v48, v56
    v_permlane32_swap_b32 v49, v57
    v_permlane32_swap_b32 v50, v58
    v_permlane32_swap_b32 v52, v59
    v_permlane32_swap_b32 v53, v60
    v_permlane32_swap_b32 v54, v61
    s_nop 1
    v_add_f32 v48, v48, v56
    v_add_f32 v49, v49, v57
    v_add_f32 v50, v50, v58
    v_add_f32 v52, v52, v59
    v_add_f32 v53, v53, v60
    v_add_f32 v54, v54, v61
    v_cmp_eq_u32 s[40:41], 1, v72
    v_cmp_eq_u32 s[42:43], 2, v72
    s_nop 1
    v_cndmask_b32 v48, v48, v49, s[40:41]
    v_cndmask_b32 v48, v48, v50, s[42:43]
    buffer_atomic_add_f32 v48, v77, s[32:35], 0 offen offset:0
    v_cndmask_b32 v52, v52, v53, s[40:41]
    v_cndmask_b32 v52, v52, v54, s[42:43]
    buffer_atomic_add_f32 v52, v77, s[32:35], 0 offen offset:64
    s_load_dwordx2 s[42:43], s[0:1], 88
    s_load_dwordx2 s[56:57], s[0:1], 56
    s_add_u32 s16, s6, 0x4815000
    s_addc_u32 s17, s7, 0
    s_and_b32 s17, s17, 0xffff
    s_mov_b32 s18, 0x1000
    s_mov_b32 s19, 0x00020000
    v_lshrrev_b32 v3, 4, v1
    v_lshl_add_u32 v2, s30, 6, v3
    v_and_b32 v4, 31, v3
    v_lshrrev_b32 v5, 5, v3
    v_lshlrev_b32 v7, 4, v4
    v_and_b32 v8, 15, v3
    v_lshlrev_b32 v6, 7, v8
    s_bfe_u32 s31, s2, 0x20003
    s_lshl_b32 s31, s31, 7
    v_lshlrev_b32 v12, 9, v3
    v_and_b32 v14, 3, v3
    v_lshlrev_b32 v14, 7, v14
    s_and_b32 s59, s2, 7
    s_lshl_b32 s59, s59, 9
    s_setreg_imm32_b32 hwreg(HW_REG_MODE, 4, 2), 3
    s_waitcnt vmcnt(0) lgkmcnt(0)
    s_barrier
    s_cmp_lg_u32 s30, 0
    s_cbranch_scc1 ff_nosig_142
    s_mov_b64 exec, 0xff
    buffer_atomic_add v76, v12, s[16:19], s31 offen sc1
    s_mov_b64 exec, -1
ff_nosig_142:
    s_lshl_b32 s40, s30, 13
    s_add_u32 m0, s40, 65536
    s_add_u32 s41, s3, 0
    buffer_load_dwordx4 v1, s[44:47], s41 offen offset:0 sc1 lds
    buffer_load_dwordx4 v1, s[44:47], s41 offen offset:1024 sc1 lds
    buffer_load_dwordx4 v1, s[44:47], s41 offen offset:2048 sc1 lds
    buffer_load_dwordx4 v1, s[44:47], s41 offen offset:3072 sc1 lds
    s_lshl_b32 s40, s30, 13
    s_add_u32 m0, s40, 69632
    s_add_u32 s41, s3, 4096
    buffer_load_dwordx4 v1, s[44:47], s41 offen offset:0 sc1 lds
    buffer_load_dwordx4 v1, s[44:47], s41 offen offset:1024 sc1 lds
    buffer_load_dwordx4 v1, s[44:47], s41 offen offset:2048 sc1 lds
    buffer_load_dwordx4 v1, s[44:47], s41 offen offset:3072 sc1 lds
    s_lshl_b32 s40, s30, 13
    s_add_u32 m0, s40, 98304
    s_add_u32 s41, s3, 8388608
    buffer_load_dwordx4 v1, s[44:47], s41 offen offset:0 sc1 lds
    buffer_load_dwordx4 v1, s[44:47], s41 offen offset:1024 sc1 lds
    buffer_load_dwordx4 v1, s[44:47], s41 offen offset:2048 sc1 lds
    buffer_load_dwordx4 v1, s[44:47], s41 offen offset:3072 sc1 lds
    s_lshl_b32 s40, s30, 13
    s_add_u32 m0, s40, 102400
    s_add_u32 s41, s3, 8392704
    buffer_load_dwordx4 v1, s[44:47], s41 offen offset:0 sc1 lds
    buffer_load_dwordx4 v1, s[44:47], s41 offen offset:1024 sc1 lds
    buffer_load_dwordx4 v1, s[44:47], s41 offen offset:2048 sc1 lds
    buffer_load_dwordx4 v1, s[44:47], s41 offen offset:3072 sc1 lds
    s_lshl_b32 s41, s30, 9
    s_add_u32 s41, s41, 131072
    v_lshrrev_b32 v9, 1, v1
    v_add_u32 v9, s41, v9
    ds_read_b64 v[96:97], v9 offset:0
    ds_read_b64 v[98:99], v9 offset:2048
    ds_read_b64 v[100:101], v9 offset:4096
    ds_read_b64 v[102:103], v9 offset:6144
    ds_read_b64 v[104:105], v9 offset:8192
    ds_read_b64 v[106:107], v9 offset:10240
    ds_read_b64 v[108:109], v9 offset:12288
    ds_read_b64 v[110:111], v9 offset:14336
    ds_read_b64 v[112:113], v9 offset:16384
    ds_read_b64 v[114:115], v9 offset:18432
    ds_read_b64 v[116:117], v9 offset:20480
    ds_read_b64 v[118:119], v9 offset:22528
    ds_read_b64 v[120:121], v9 offset:24576
    ds_read_b64 v[122:123], v9 offset:26624
    ds_read_b64 v[124:125], v9 offset:28672
    ds_read_b64 v[126:127], v9 offset:30720
    s_mov_b32 s54, 0x05040100
    s_mov_b32 s53, 0x07060302
    s_waitcnt lgkmcnt(0)
    v_perm_b32 v144, v98, v96, s54
    v_perm_b32 v145, v98, v96, s53
    v_perm_b32 v146, v99, v97, s54
    v_perm_b32 v147, v99, v97, s53
    v_perm_b32 v148, v102, v100, s54
    v_perm_b32 v149, v102, v100, s53
    v_perm_b32 v150, v103, v101, s54
    v_perm_b32 v151, v103, v101, s53
    v_perm_b32 v152, v106, v104, s54
    v_perm_b32 v153, v106, v104, s53
    v_perm_b32 v154, v107, v105, s54
    v_perm_b32 v155, v107, v105, s53
    v_perm_b32 v156, v110, v108, s54
    v_perm_b32 v157, v110, v108, s53
    v_perm_b32 v158, v111, v109, s54
    v_perm_b32 v159, v111, v109, s53
    v_perm_b32 v160, v114, v112, s54
    v_perm_b32 v161, v114, v112, s53
    v_perm_b32 v162, v115, v113, s54
    v_perm_b32 v163, v115, v113, s53
    v_perm_b32 v164, v118, v116, s54
    v_perm_b32 v165, v118, v116, s53
    v_perm_b32 v166, v119, v117, s54
    v_perm_b32 v167, v119, v117, s53
    v_perm_b32 v168, v122, v120, s54
    v_perm_b32 v169, v122, v120, s53
    v_perm_b32 v170, v123, v121, s54
    v_perm_b32 v171, v123, v121, s53
    v_perm_b32 v172, v126, v124, s54
    v_perm_b32 v173, v126, v124, s53
    v_perm_b32 v174, v127, v125, s54
    v_perm_b32 v175, v127, v125, s53
    s_mov_b32 s34, 24708
    s_mov_b32 s36, s42
    s_and_b32 s37, s43, 0xffff
    s_mov_b32 s38, 0x400000
    s_mov_b32 s39, 0x00020000
    s_add_u32 s48, s6, 0x4900000
    s_addc_u32 s49, s7, 0
    s_and_b32 s49, s49, 0xffff
    s_mov_b32 s50, 0x1c0000
    s_mov_b32 s51, 0x00020000
    v_lshlrev_b32 v10, 5, v2
    v_lshl_add_u32 v11, s30, 1, v5
    s_lshl_b32 s31, s2, 3
    v_add_u32 v11, s31, v11
    v_lshl_add_u32 v0, v11, 11, v7
    s_cmp_lg_u32 s30, 0
    s_cbranch_scc1 ff_go_143
    s_mov_b32 s52, 1048576
ff_poll_144:
    buffer_load_dword v13, v14, s[16:19], s59 offen sc1
    s_sub_u32 s52, s52, 1
    s_cbranch_scc1 ff_go_143
    s_waitcnt vmcnt(0)
    v_cmp_gt_u32 vcc, 64, v13
    s_cbranch_vccz ff_go_143
    s_sleep 4
    s_branch ff_poll_144
ff_go_143:
    s_barrier
    s_mov_b32 s31, 0
    buffer_load_dwordx4 v[16:19], v10, s[32:35], s31 offen sc1
    buffer_load_dwordx4 v[20:23], v10, s[32:35], s31 offen offset:16 sc1
    s_mov_b32 s31, 8192
    buffer_load_dwordx4 v[24:27], v10, s[32:35], s31 offen sc1
    buffer_load_dwordx4 v[28:31], v10, s[32:35], s31 offen offset:16 sc1
    s_mov_b32 s31, 16384
    buffer_load_dwordx4 v[32:35], v10, s[32:35], s31 offen sc1
    buffer_load_dwordx4 v[36:39], v10, s[32:35], s31 offen offset:16 sc1
    s_mov_b32 s31, 24704
    buffer_load_dword v10, v75, s[32:35], s31 offen sc1
    s_mov_b32 s52, 0x3a800000
    s_mov_b32 s53, 0x3a800000
    s_mov_b32 s54, 0x7ff
    v_mov_b32 v14, 0x3727c5ac
    v_mov_b32 v15, v14
    v_mov_b32 v12, 0xff800000
    v_mov_b32 v13, v12
    s_waitcnt vmcnt(0)
    v_sub_f32 v56, 0, v10
    v_sub_f32 v57, 0, v10
    v_pk_mul_f32 v[16:17], v[16:17], s[52:53]
    v_pk_fma_f32 v[24:25], v[24:25], s[52:53], v[14:15]
    v_pk_fma_f32 v[32:33], v[16:17], v[56:57], v[32:33]
    v_pk_fma_f32 v[24:25], v[16:17], v[16:17], v[24:25] neg_lo:[1,0,0] neg_hi:[1,0,0]
    v_pk_mul_f32 v[18:19], v[18:19], s[52:53]
    v_pk_fma_f32 v[26:27], v[26:27], s[52:53], v[14:15]
    v_pk_fma_f32 v[34:35], v[18:19], v[56:57], v[34:35]
    v_pk_fma_f32 v[26:27], v[18:19], v[18:19], v[26:27] neg_lo:[1,0,0] neg_hi:[1,0,0]
    v_pk_mul_f32 v[20:21], v[20:21], s[52:53]
    v_pk_fma_f32 v[28:29], v[28:29], s[52:53], v[14:15]
    v_pk_fma_f32 v[36:37], v[20:21], v[56:57], v[36:37]
    v_pk_fma_f32 v[28:29], v[20:21], v[20:21], v[28:29] neg_lo:[1,0,0] neg_hi:[1,0,0]
    v_pk_mul_f32 v[22:23], v[22:23], s[52:53]
    v_pk_fma_f32 v[30:31], v[30:31], s[52:53], v[14:15]
    v_pk_fma_f32 v[38:39], v[22:23], v[56:57], v[38:39]
    v_pk_fma_f32 v[30:31], v[22:23], v[22:23], v[30:31] neg_lo:[1,0,0] neg_hi:[1,0,0]
    v_max_f32 v24, v14, v24
    v_max_f32 v25, v14, v25
    v_max_f32 v26, v14, v26
    v_max_f32 v27, v14, v27
    v_max_f32 v28, v14, v28
    v_max_f32 v29, v14, v29
    v_max_f32 v30, v14, v30
    v_max_f32 v31, v14, v31
    v_rsq_f32 v24, v24
    v_rsq_f32 v25, v25
    v_rsq_f32 v26, v26
    v_rsq_f32 v27, v27
    v_rsq_f32 v28, v28
    v_rsq_f32 v29, v29
    v_rsq_f32 v30, v30
    v_rsq_f32 v31, v31
    v_pk_mul_f32 v[32:33], v[32:33], v[24:25]
    v_pk_mul_f32 v[34:35], v[34:35], v[26:27]
    v_pk_mul_f32 v[36:37], v[36:37], v[28:29]
    v_pk_mul_f32 v[38:39], v[38:39], v[30:31]
    v_bfi_b32 v32, s54, 0, v32
    v_med3_f32 v13, v12, v13, v32
    v_max_f32 v12, v12, v32
    v_bfi_b32 v33, s54, 1, v33
    v_med3_f32 v13, v12, v13, v33
    v_max_f32 v12, v12, v33
    v_bfi_b32 v34, s54, 2, v34
    v_med3_f32 v13, v12, v13, v34
    v_max_f32 v12, v12, v34
    v_bfi_b32 v35, s54, 3, v35
    v_med3_f32 v13, v12, v13, v35
    v_max_f32 v12, v12, v35
    v_bfi_b32 v36, s54, 4, v36
    v_med3_f32 v13, v12, v13, v36
    v_max_f32 v12, v12, v36
    v_bfi_b32 v37, s54, 5, v37
    v_med3_f32 v13, v12, v13, v37
    v_max_f32 v12, v12, v37
    v_bfi_b32 v38, s54, 6, v38
    v_med3_f32 v13, v12, v13, v38
    v_max_f32 v12, v12, v38
    v_bfi_b32 v39, s54, 7, v39
    v_med3_f32 v13, v12, v13, v39
    v_max_f32 v12, v12, v39
    v_lshl_or_b32 v12, v2, 3, v12
    v_lshl_or_b32 v13, v2, 3, v13
    s_nop 1
    v_mov_b32_dpp v14, v12 quad_perm:[1,0,3,2] row_mask:0xf bank_mask:0xf
    v_mov_b32_dpp v15, v13 quad_perm:[1,0,3,2] row_mask:0xf bank_mask:0xf
    v_max_f32 v15, v15, v13
    v_med3_f32 v13, v12, v14, v15
    v_max_f32 v12, v12, v14
    s_nop 1
    v_mov_b32_dpp v14, v12 quad_perm:[2,3,0,1] row_mask:0xf bank_mask:0xf
    v_mov_b32_dpp v15, v13 quad_perm:[2,3,0,1] row_mask:0xf bank_mask:0xf
    v_max_f32 v15, v15, v13
    v_med3_f32 v13, v12, v14, v15
    v_max_f32 v12, v12, v14
    s_nop 1
    v_mov_b32_dpp v14, v12 row_half_mirror row_mask:0xf bank_mask:0xf
    v_mov_b32_dpp v15, v13 row_half_mirror row_mask:0xf bank_mask:0xf
    v_max_f32 v15, v15, v13
    v_med3_f32 v13, v12, v14, v15
    v_max_f32 v12, v12, v14
    s_nop 1
    v_mov_b32_dpp v14, v12 row_mirror row_mask:0xf bank_mask:0xf
    v_mov_b32_dpp v15, v13 row_mirror row_mask:0xf bank_mask:0xf
    v_max_f32 v15, v15, v13
    v_med3_f32 v13, v12, v14, v15
    v_max_f32 v12, v12, v14
    v_mov_b32 v14, v12
    v_mov_b32 v15, v13
    s_nop 1
    v_permlane16_swap_b32 v12, v14
    v_permlane16_swap_b32 v13, v15
    s_nop 1
    v_max_f32 v15, v15, v13
    v_med3_f32 v13, v12, v14, v15
    v_max_f32 v12, v12, v14
    v_mov_b32 v14, v12
    v_mov_b32 v15, v13
    s_nop 1
    v_permlane32_swap_b32 v12, v14
    v_permlane32_swap_b32 v13, v15
    s_nop 1
    v_max_f32 v15, v15, v13
    v_med3_f32 v13, v12, v14, v15
    v_max_f32 v12, v12, v14
    s_lshl_b32 s31, s30, 3
    s_add_u32 s31, s31, 8192
    v_mov_b32 v14, s31
    ds_write_b64 v14, v[12:13]
    v_mov_b32 v14, 8192
    s_waitcnt lgkmcnt(0)
    s_barrier
    ds_read_b128 v[16:19], v14
    ds_read_b128 v[20:23], v14 offset:16
    v_cmp_eq_u32 vcc, 0, v5
    s_waitcnt lgkmcnt(0)
    v_max_f32 v19, v19, v17
    v_med3_f32 v17, v16, v18, v19
    v_max_f32 v16, v16, v18
    v_max_f32 v23, v23, v21
    v_med3_f32 v21, v20, v22, v23
    v_max_f32 v20, v20, v22
    v_max_f32 v21, v21, v17
    v_med3_f32 v17, v16, v20, v21
    v_max_f32 v16, v16, v20
    v_and_b32 v16, 0x7ff, v16
    v_and_b32 v17, 0x7ff, v17
    v_cndmask_b32 v15, v17, v16, vcc
    v_lshl_add_u32 v12, v15, 11, v7
    buffer_load_dwordx4 v[40:43], v12, s[24:27], 0 offen offset:0 sc1
    buffer_load_dwordx4 v[44:47], v12, s[24:27], 0 offen offset:512 sc1
    buffer_load_dwordx4 v[48:51], v12, s[24:27], 0 offen offset:1024 sc1
    buffer_load_dwordx4 v[52:55], v12, s[24:27], 0 offen offset:1536 sc1
    buffer_load_dwordx4 v[128:131], v0, s[24:27], 0 offen offset:0 sc1
    buffer_load_dwordx4 v[132:135], v0, s[24:27], 0 offen offset:512 sc1
    buffer_load_dwordx4 v[136:139], v0, s[24:27], 0 offen offset:1024 sc1
    buffer_load_dwordx4 v[140:143], v0, s[24:27], 0 offen offset:1536 sc1
    v_cmp_eq_u32 vcc, v16, v11
    v_cmp_eq_u32 s[52:53], v17, v11
    v_mov_b32 v13, 0x7fffffff
    s_or_b64 vcc, vcc, s[52:53]
    v_cndmask_b32 v0, v0, v13, vcc
    v_lshl_add_u32 v12, v5, 11, v7
    v_add_u32 v12, 4096, v12
    s_mov_b32 s58, 0
    s_waitcnt vmcnt(4)
ff_ln_145:
    v_lshlrev_b32 v216, 16, v40
    v_and_b32 v217, 0xffff0000, v40
    v_lshlrev_b32 v218, 16, v41
    v_and_b32 v219, 0xffff0000, v41
    v_lshlrev_b32 v220, 16, v42
    v_and_b32 v221, 0xffff0000, v42
    v_lshlrev_b32 v222, 16, v43
    v_and_b32 v223, 0xffff0000, v43
    v_lshlrev_b32 v224, 16, v44
    v_and_b32 v225, 0xffff0000, v44
    v_lshlrev_b32 v226, 16, v45
    v_and_b32 v227, 0xffff0000, v45
    v_lshlrev_b32 v228, 16, v46
    v_and_b32 v229, 0xffff0000, v46
    v_lshlrev_b32 v230, 16, v47
    v_and_b32 v231, 0xffff0000, v47
    v_lshlrev_b32 v232, 16, v48
    v_and_b32 v233, 0xffff0000, v48
    v_lshlrev_b32 v234, 16, v49
    v_and_b32 v235, 0xffff0000, v49
    v_lshlrev_b32 v236, 16, v50
    v_and_b32 v237, 0xffff0000, v50
    v_lshlrev_b32 v238, 16, v51
    v_and_b32 v239, 0xffff0000, v51
    v_lshlrev_b32 v240, 16, v52
    v_and_b32 v241, 0xffff0000, v52
    v_lshlrev_b32 v242, 16, v53
    v_and_b32 v243, 0xffff0000, v53
    v_lshlrev_b32 v244, 16, v54
    v_and_b32 v245, 0xffff0000, v54
    v_lshlrev_b32 v246, 16, v55
    v_and_b32 v247, 0xffff0000, v55
    v_pk_add_f32 v[208:209], v[216:217], v[218:219]
    v_pk_add_f32 v[210:211], v[220:221], v[222:223]
    v_pk_add_f32 v[208:209], v[208:209], v[224:225]
    v_pk_add_f32 v[210:211], v[210:211], v[226:227]
    v_pk_add_f32 v[208:209], v[208:209], v[228:229]
    v_pk_add_f32 v[210:211], v[210:211], v[230:231]
    v_pk_add_f32 v[208:209], v[208:209], v[232:233]
    v_pk_add_f32 v[210:211], v[210:211], v[234:235]
    v_pk_add_f32 v[208:209], v[208:209], v[236:237]
    v_pk_add_f32 v[210:211], v[210:211], v[238:239]
    v_pk_add_f32 v[208:209], v[208:209], v[240:241]
    v_pk_add_f32 v[210:211], v[210:211], v[242:243]
    v_pk_add_f32 v[208:209], v[208:209], v[244:245]
    v_pk_add_f32 v[210:211], v[210:211], v[246:247]
    v_pk_add_f32 v[208:209], v[208:209], v[210:211]
    v_add_f32 v208, v208, v209
    s_nop 1
    v_add_f32_dpp v208, v208, v208 quad_perm:[1,0,3,2] row_mask:0xf bank_mask:0xf
    s_nop 1
    v_add_f32_dpp v208, v208, v208 quad_perm:[2,3,0,1] row_mask:0xf bank_mask:0xf
    s_nop 1
    v_add_f32_dpp v208, v208, v208 row_half_mirror row_mask:0xf bank_mask:0xf
    s_nop 1
    v_add_f32_dpp v208, v208, v208 row_mirror row_mask:0xf bank_mask:0xf
    v_mov_b32 v210, v208
    s_nop 1
    v_permlane16_swap_b32 v208, v210
    s_nop 1
    v_add_f32 v208, v208, v210
    v_mul_f32 v208, 0xba800000, v208
    v_mov_b32 v209, v208
    v_pk_add_f32 v[210:211], v[216:217], v[208:209]
    v_pk_add_f32 v[214:215], v[218:219], v[208:209]
    v_pk_mul_f32 v[212:213], v[210:211], v[210:211]
    v_pk_fma_f32 v[212:213], v[214:215], v[214:215], v[212:213]
    v_pk_add_f32 v[210:211], v[220:221], v[208:209]
    v_pk_add_f32 v[214:215], v[222:223], v[208:209]
    v_pk_fma_f32 v[212:213], v[210:211], v[210:211], v[212:213]
    v_pk_fma_f32 v[212:213], v[214:215], v[214:215], v[212:213]
    v_pk_add_f32 v[210:211], v[224:225], v[208:209]
    v_pk_add_f32 v[214:215], v[226:227], v[208:209]
    v_pk_fma_f32 v[212:213], v[210:211], v[210:211], v[212:213]
    v_pk_fma_f32 v[212:213], v[214:215], v[214:215], v[212:213]
    v_pk_add_f32 v[210:211], v[228:229], v[208:209]
    v_pk_add_f32 v[214:215], v[230:231], v[208:209]
    v_pk_fma_f32 v[212:213], v[210:211], v[210:211], v[212:213]
    v_pk_fma_f32 v[212:213], v[214:215], v[214:215], v[212:213]
    v_pk_add_f32 v[210:211], v[232:233], v[208:209]
    v_pk_add_f32 v[214:215], v[234:235], v[208:209]
    v_pk_fma_f32 v[212:213], v[210:211], v[210:211], v[212:213]
    v_pk_fma_f32 v[212:213], v[214:215], v[214:215], v[212:213]
    v_pk_add_f32 v[210:211], v[236:237], v[208:209]
    v_pk_add_f32 v[214:215], v[238:239], v[208:209]
    v_pk_fma_f32 v[212:213], v[210:211], v[210:211], v[212:213]
    v_pk_fma_f32 v[212:213], v[214:215], v[214:215], v[212:213]
    v_pk_add_f32 v[210:211], v[240:241], v[208:209]
    v_pk_add_f32 v[214:215], v[242:243], v[208:209]
    v_pk_fma_f32 v[212:213], v[210:211], v[210:211], v[212:213]
    v_pk_fma_f32 v[212:213], v[214:215], v[214:215], v[212:213]
    v_pk_add_f32 v[210:211], v[244:245], v[208:209]
    v_pk_add_f32 v[214:215], v[246:247], v[208:209]
    v_pk_fma_f32 v[212:213], v[210:211], v[210:211], v[212:213]
    v_pk_fma_f32 v[212:213], v[214:215], v[214:215], v[212:213]
    v_add_f32 v212, v212, v213
    s_nop 1
    v_add_f32_dpp v212, v212, v212 quad_perm:[1,0,3,2] row_mask:0xf bank_mask:0xf
    s_nop 1
    v_add_f32_dpp v212, v212, v212 quad_perm:[2,3,0,1] row_mask:0xf bank_mask:0xf
    s_nop 1
    v_add_f32_dpp v212, v212, v212 row_half_mirror row_mask:0xf bank_mask:0xf
    s_nop 1
    v_add_f32_dpp v212, v212, v212 row_mirror row_mask:0xf bank_mask:0xf
    v_mov_b32 v210, v212
    s_nop 1
    v_permlane16_swap_b32 v212, v210
    s_nop 1
    v_add_f32 v212, v212, v210
    v_mul_f32 v212, 0x3a800000, v212
    v_cvt_pk_bf16_f32 v214, v208, v212
    v_and_b32 v212, 0xffff0000, v214
    v_lshlrev_b32 v214, 16, v214
    v_add_f32 v212, 0x3727c5ac, v212
    v_mov_b32 v215, v214
    v_cvt_pk_bf16_f32 v212, v212, v212
    v_and_b32 v212, 0xffff0000, v212
    v_sqrt_f32 v212, v212
    v_pk_add_f32 v[176:177], v[216:217], v[214:215]
    v_pk_add_f32 v[178:179], v[218:219], v[214:215]
    v_pk_add_f32 v[180:181], v[220:221], v[214:215]
    v_pk_add_f32 v[182:183], v[222:223], v[214:215]
    v_pk_add_f32 v[184:185], v[224:225], v[214:215]
    v_pk_add_f32 v[186:187], v[226:227], v[214:215]
    v_pk_add_f32 v[188:189], v[228:229], v[214:215]
    v_pk_add_f32 v[190:191], v[230:231], v[214:215]
    v_pk_add_f32 v[192:193], v[232:233], v[214:215]
    v_pk_add_f32 v[194:195], v[234:235], v[214:215]
    v_pk_add_f32 v[196:197], v[236:237], v[214:215]
    v_pk_add_f32 v[198:199], v[238:239], v[214:215]
    v_pk_add_f32 v[200:201], v[240:241], v[214:215]
    v_pk_add_f32 v[202:203], v[242:243], v[214:215]
    v_pk_add_f32 v[204:205], v[244:245], v[214:215]
    v_pk_add_f32 v[206:207], v[246:247], v[214:215]
    v_cvt_pk_bf16_f32 v212, v212, v212
    v_and_b32 v212, 0xffff0000, v212
    v_rcp_f32 v212, v212
    v_cvt_pk_bf16_f32 v40, v176, v177
    v_cvt_pk_bf16_f32 v41, v178, v179
    v_cvt_pk_bf16_f32 v42, v180, v181
    v_cvt_pk_bf16_f32 v43, v182, v183
    v_cvt_pk_bf16_f32 v44, v184, v185
    v_cvt_pk_bf16_f32 v45, v186, v187
    v_cvt_pk_bf16_f32 v46, v188, v189
    v_cvt_pk_bf16_f32 v47, v190, v191
    v_cvt_pk_bf16_f32 v48, v192, v193
    v_cvt_pk_bf16_f32 v49, v194, v195
    v_cvt_pk_bf16_f32 v50, v196, v197
    v_cvt_pk_bf16_f32 v51, v198, v199
    v_cvt_pk_bf16_f32 v52, v200, v201
    v_cvt_pk_bf16_f32 v53, v202, v203
    v_cvt_pk_bf16_f32 v54, v204, v205
    v_cvt_pk_bf16_f32 v55, v206, v207
    v_mov_b32 v213, v212
    v_lshlrev_b32 v176, 16, v40
    v_and_b32 v177, 0xffff0000, v40
    v_lshlrev_b32 v178, 16, v41
    v_and_b32 v179, 0xffff0000, v41
    v_lshlrev_b32 v180, 16, v42
    v_and_b32 v181, 0xffff0000, v42
    v_lshlrev_b32 v182, 16, v43
    v_and_b32 v183, 0xffff0000, v43
    v_lshlrev_b32 v184, 16, v44
    v_and_b32 v185, 0xffff0000, v44
    v_lshlrev_b32 v186, 16, v45
    v_and_b32 v187, 0xffff0000, v45
    v_lshlrev_b32 v188, 16, v46
    v_and_b32 v189, 0xffff0000, v46
    v_lshlrev_b32 v190, 16, v47
    v_and_b32 v191, 0xffff0000, v47
    v_lshlrev_b32 v192, 16, v48
    v_and_b32 v193, 0xffff0000, v48
    v_lshlrev_b32 v194, 16, v49
    v_and_b32 v195, 0xffff0000, v49
    v_lshlrev_b32 v196, 16, v50
    v_and_b32 v197, 0xffff0000, v50
    v_lshlrev_b32 v198, 16, v51
    v_and_b32 v199, 0xffff0000, v51
    v_lshlrev_b32 v200, 16, v52
    v_and_b32 v201, 0xffff0000, v52
    v_lshlrev_b32 v202, 16, v53
    v_and_b32 v203, 0xffff0000, v53
    v_lshlrev_b32 v204, 16, v54
    v_and_b32 v205, 0xffff0000, v54
    v_lshlrev_b32 v206, 16, v55
    v_and_b32 v207, 0xffff0000, v55
    v_pk_mul_f32 v[176:177], v[176:177], v[212:213]
    v_pk_mul_f32 v[178:179], v[178:179], v[212:213]
    v_pk_mul_f32 v[180:181], v[180:181], v[212:213]
    v_pk_mul_f32 v[182:183], v[182:183], v[212:213]
    v_pk_mul_f32 v[184:185], v[184:185], v[212:213]
    v_pk_mul_f32 v[186:187], v[186:187], v[212:213]
    v_pk_mul_f32 v[188:189], v[188:189], v[212:213]
    v_pk_mul_f32 v[190:191], v[190:191], v[212:213]
    v_pk_mul_f32 v[192:193], v[192:193], v[212:213]
    v_pk_mul_f32 v[194:195], v[194:195], v[212:213]
    v_pk_mul_f32 v[196:197], v[196:197], v[212:213]
    v_pk_mul_f32 v[198:199], v[198:199], v[212:213]
    v_pk_mul_f32 v[200:201], v[200:201], v[212:213]
    v_pk_mul_f32 v[202:203], v[202:203], v[212:213]
    v_pk_mul_f32 v[204:205], v[204:205], v[212:213]
    v_pk_mul_f32 v[206:207], v[206:207], v[212:213]
    v_cvt_pk_bf16_f32 v40, v176, v177
    v_cvt_pk_bf16_f32 v41, v178, v179
    v_cvt_pk_bf16_f32 v42, v180, v181
    v_cvt_pk_bf16_f32 v43, v182, v183
    v_cvt_pk_bf16_f32 v44, v184, v185
    v_cvt_pk_bf16_f32 v45, v186, v187
    v_cvt_pk_bf16_f32 v46, v188, v189
    v_cvt_pk_bf16_f32 v47, v190, v191
    v_cvt_pk_bf16_f32 v48, v192, v193
    v_cvt_pk_bf16_f32 v49, v194, v195
    v_cvt_pk_bf16_f32 v50, v196, v197
    v_cvt_pk_bf16_f32 v51, v198, v199
    v_cvt_pk_bf16_f32 v52, v200, v201
    v_cvt_pk_bf16_f32 v53, v202, v203
    v_cvt_pk_bf16_f32 v54, v204, v205
    v_cvt_pk_bf16_f32 v55, v206, v207
    s_cmp_lg_u32 s58, 0
    s_cbranch_scc1 ff_own_146
    ds_write_b128 v12, v[40:43] offset:0
    ds_write_b128 v12, v[44:47] offset:512
    ds_write_b128 v12, v[48:51] offset:1024
    ds_write_b128 v12, v[52:55] offset:1536
    s_cmp_ge_u32 s2, 224
    s_cbranch_scc1 ff_red_147
    v_lshrrev_b32 v12, 4, v3
    v_and_b32 v13, 1, v3
    v_lshlrev_b32 v13, 11, v13
    v_lshl_add_u32 v13, v12, 3, v13
    s_lshl_b32 s54, s30, 9
    s_add_u32 s54, s54, 4096
    v_add_u32 v13, s54, v13
    v_lshlrev_b32 v14, 3, v3
    s_lshl_b32 s54, s30, 13
    s_add_u32 s54, s54, 65536
    v_add_u32 v14, s54, v14
    ds_read_b64_tr_b16 a[0:1], v14 offset:0
    ds_read_b64_tr_b16 a[2:3], v14 offset:512
    ds_read_b64_tr_b16 a[4:5], v14 offset:1024
    ds_read_b64_tr_b16 a[6:7], v14 offset:1536
    ds_read_b64_tr_b16 a[8:9], v14 offset:2048
    ds_read_b64_tr_b16 a[10:11], v14 offset:2560
    ds_read_b64_tr_b16 a[12:13], v14 offset:3072
    ds_read_b64_tr_b16 a[14:15], v14 offset:3584
    ds_read_b64_tr_b16 a[16:17], v14 offset:4096
    ds_read_b64_tr_b16 a[18:19], v14 offset:4608
    ds_read_b64_tr_b16 a[20:21], v14 offset:5120
    ds_read_b64_tr_b16 a[22:23], v14 offset:5632
    ds_read_b64_tr_b16 a[24:25], v14 offset:6144
    ds_read_b64_tr_b16 a[26:27], v14 offset:6656
    ds_read_b64_tr_b16 a[28:29], v14 offset:7168
    ds_read_b64_tr_b16 a[30:31], v14 offset:7680
    ds_read_b64_tr_b16 a[32:33], v14 offset:32768
    ds_read_b64_tr_b16 a[34:35], v14 offset:33280
    ds_read_b64_tr_b16 a[36:37], v14 offset:33792
    ds_read_b64_tr_b16 a[38:39], v14 offset:34304
    ds_read_b64_tr_b16 a[40:41], v14 offset:34816
    ds_read_b64_tr_b16 a[42:43], v14 offset:35328
    ds_read_b64_tr_b16 a[44:45], v14 offset:35840
    ds_read_b64_tr_b16 a[46:47], v14 offset:36352
    ds_read_b64_tr_b16 a[48:49], v14 offset:36864
    ds_read_b64_tr_b16 a[50:51], v14 offset:37376
    ds_read_b64_tr_b16 a[52:53], v14 offset:37888
    ds_read_b64_tr_b16 a[54:55], v14 offset:38400
    ds_read_b64_tr_b16 a[56:57], v14 offset:38912
    ds_read_b64_tr_b16 a[58:59], v14 offset:39424
    ds_read_b64_tr_b16 a[60:61], v14 offset:39936
    ds_read_b64_tr_b16 a[62:63], v14 offset:40448
    ds_read_b64 a[64:65], v13 offset:0
    ds_read_b64 a[66:67], v13 offset:32
    ds_read_b64 a[68:69], v13 offset:64
    ds_read_b64 a[70:71], v13 offset:96
    ds_read_b64 a[72:73], v13 offset:128
    ds_read_b64 a[74:75], v13 offset:160
    ds_read_b64 a[76:77], v13 offset:192
    ds_read_b64 a[78:79], v13 offset:224
    ds_read_b64 a[80:81], v13 offset:256
    ds_read_b64 a[82:83], v13 offset:288
    ds_read_b64 a[84:85], v13 offset:320
    ds_read_b64 a[86:87], v13 offset:352
    ds_read_b64 a[88:89], v13 offset:384
    ds_read_b64 a[90:91], v13 offset:416
    ds_read_b64 a[92:93], v13 offset:448
    ds_read_b64 a[94:95], v13 offset:480
    v_lshlrev_b32 v13, 6, v8
    v_lshl_add_u32 v13, v12, 4, v13
    s_lshl_b32 s54, s30, 11
    s_add_u32 s54, s54, 8448
    v_add_u32 v13, s54, v13
    s_waitcnt lgkmcnt(0)
    v_mfma_f32_16x16x32_bf16 v[16:19], a[0:3], a[64:67], 0
    v_mfma_f32_16x16x32_bf16 v[20:23], a[32:35], a[64:67], 0
    v_mfma_f32_16x16x32_bf16 v[16:19], a[4:7], a[68:71], v[16:19]
    v_mfma_f32_16x16x32_bf16 v[20:23], a[36:39], a[68:71], v[20:23]
    v_mfma_f32_16x16x32_bf16 v[16:19], a[8:11], a[72:75], v[16:19]
    v_mfma_f32_16x16x32_bf16 v[20:23], a[40:43], a[72:75], v[20:23]
    v_mfma_f32_16x16x32_bf16 v[16:19], a[12:15], a[76:79], v[16:19]
    v_mfma_f32_16x16x32_bf16 v[20:23], a[44:47], a[76:79], v[20:23]
    v_mfma_f32_16x16x32_bf16 v[16:19], a[16:19], a[80:83], v[16:19]
    v_mfma_f32_16x16x32_bf16 v[20:23], a[48:51], a[80:83], v[20:23]
    v_mfma_f32_16x16x32_bf16 v[16:19], a[20:23], a[84:87], v[16:19]
    v_mfma_f32_16x16x32_bf16 v[20:23], a[52:55], a[84:87], v[20:23]
    v_mfma_f32_16x16x32_bf16 v[16:19], a[24:27], a[88:91], v[16:19]
    v_mfma_f32_16x16x32_bf16 v[20:23], a[56:59], a[88:91], v[20:23]
    v_mfma_f32_16x16x32_bf16 v[16:19], a[28:31], a[92:95], v[16:19]
    v_mfma_f32_16x16x32_bf16 v[20:23], a[60:63], a[92:95], v[20:23]
    s_nop 7
    ds_write_b128 v13, v[16:19]
    ds_write_b128 v13, v[20:23] offset:1024
    v_lshlrev_b32 v13, 2, v4
    v_add_u32 v13, 8448, v13
    s_waitcnt lgkmcnt(0)
    s_barrier
    ds_read2st64_b32 v[16:17], v13 offset0:0 offset1:4
    ds_read2st64_b32 v[18:19], v13 offset0:8 offset1:12
    ds_read2st64_b32 v[20:21], v13 offset0:16 offset1:20
    ds_read2st64_b32 v[22:23], v13 offset0:24 offset1:28
    s_waitcnt lgkmcnt(0)
    v_pk_add_f32 v[16:17], v[16:17], v[20:21]
    v_pk_add_f32 v[18:19], v[18:19], v[22:23]
    v_pk_add_f32 v[16:17], v[16:17], v[18:19]
    v_cvt_pk_bf16_f32 v16, v16, v17
    v_and_b32 v20, 0xffff0000, v16
    v_lshlrev_b32 v16, 16, v16
    v_mul_f32 v17, 0xbfb8aa3b, v16
    v_exp_f32 v17, v17
    s_lshl_b32 s54, s55, 13
    v_add_f32 v17, 1.0, v17
    v_rcp_f32 v17, v17
    s_add_u32 s53, s54, 4096
    v_mul_f32 v16, v16, v17
    v_cvt_pk_bf16_f32 v16, v16, v16
    v_and_b32 v16, 0xffff0000, v16
    v_mul_f32 v16, v16, v20
    s_nop 1
    v_mov_b32_dpp v17, v16 quad_perm:[1,0,3,2] row_mask:0xf bank_mask:0xf
    v_cvt_pk_bf16_f32 v16, v16, v17
    v_lshlrev_b32 v13, 4, v2
    v_readlane_b32 s8, v16, 0
    v_readlane_b32 s9, v16, 2
    v_readlane_b32 s10, v16, 4
    v_readlane_b32 s11, v16, 6
    v_readlane_b32 s12, v16, 8
    v_readlane_b32 s13, v16, 10
    v_readlane_b32 s14, v16, 12
    v_readlane_b32 s15, v16, 14
    v_readlane_b32 s16, v16, 16
    v_readlane_b32 s17, v16, 18
    v_readlane_b32 s18, v16, 20
    v_readlane_b32 s19, v16, 22
    v_readlane_b32 s20, v16, 24
    v_readlane_b32 s21, v16, 26
    v_readlane_b32 s22, v16, 28
    v_readlane_b32 s23, v16, 30
    v_dot2_f32_bf16 v24, v144, s8, 0
    v_dot2_f32_bf16 v25, v145, s8, 0
    v_dot2_f32_bf16 v26, v146, s8, 0
    v_dot2_f32_bf16 v27, v147, s8, 0
    v_dot2_f32_bf16 v24, v148, s9, v24
    v_dot2_f32_bf16 v25, v149, s9, v25
    v_dot2_f32_bf16 v26, v150, s9, v26
    v_dot2_f32_bf16 v27, v151, s9, v27
    v_dot2_f32_bf16 v24, v152, s10, v24
    v_dot2_f32_bf16 v25, v153, s10, v25
    v_dot2_f32_bf16 v26, v154, s10, v26
    v_dot2_f32_bf16 v27, v155, s10, v27
    v_dot2_f32_bf16 v24, v156, s11, v24
    v_dot2_f32_bf16 v25, v157, s11, v25
    v_dot2_f32_bf16 v26, v158, s11, v26
    v_dot2_f32_bf16 v27, v159, s11, v27
    v_dot2_f32_bf16 v24, v160, s12, v24
    v_dot2_f32_bf16 v25, v161, s12, v25
    v_dot2_f32_bf16 v26, v162, s12, v26
    v_dot2_f32_bf16 v27, v163, s12, v27
    v_dot2_f32_bf16 v24, v164, s13, v24
    v_dot2_f32_bf16 v25, v165, s13, v25
    v_dot2_f32_bf16 v26, v166, s13, v26
    v_dot2_f32_bf16 v27, v167, s13, v27
    v_dot2_f32_bf16 v24, v168, s14, v24
    v_dot2_f32_bf16 v25, v169, s14, v25
    v_dot2_f32_bf16 v26, v170, s14, v26
    v_dot2_f32_bf16 v27, v171, s14, v27
    v_dot2_f32_bf16 v24, v172, s15, v24
    v_dot2_f32_bf16 v25, v173, s15, v25
    v_dot2_f32_bf16 v26, v174, s15, v26
    v_dot2_f32_bf16 v27, v175, s15, v27
    v_dot2_f32_bf16 v28, v144, s16, 0
    v_dot2_f32_bf16 v29, v145, s16, 0
    v_dot2_f32_bf16 v30, v146, s16, 0
    v_dot2_f32_bf16 v31, v147, s16, 0
    v_dot2_f32_bf16 v28, v148, s17, v28
    v_dot2_f32_bf16 v29, v149, s17, v29
    v_dot2_f32_bf16 v30, v150, s17, v30
    v_dot2_f32_bf16 v31, v151, s17, v31
    v_dot2_f32_bf16 v28, v152, s18, v28
    v_dot2_f32_bf16 v29, v153, s18, v29
    v_dot2_f32_bf16 v30, v154, s18, v30
    v_dot2_f32_bf16 v31, v155, s18, v31
    v_dot2_f32_bf16 v28, v156, s19, v28
    v_dot2_f32_bf16 v29, v157, s19, v29
    v_dot2_f32_bf16 v30, v158, s19, v30
    v_dot2_f32_bf16 v31, v159, s19, v31
    v_dot2_f32_bf16 v28, v160, s20, v28
    v_dot2_f32_bf16 v29, v161, s20, v29
    v_dot2_f32_bf16 v30, v162, s20, v30
    v_dot2_f32_bf16 v31, v163, s20, v31
    v_dot2_f32_bf16 v28, v164, s21, v28
    v_dot2_f32_bf16 v29, v165, s21, v29
    v_dot2_f32_bf16 v30, v166, s21, v30
    v_dot2_f32_bf16 v31, v167, s21, v31
    v_dot2_f32_bf16 v28, v168, s22, v28
    v_dot2_f32_bf16 v29, v169, s22, v29
    v_dot2_f32_bf16 v30, v170, s22, v30
    v_dot2_f32_bf16 v31, v171, s22, v31
    v_dot2_f32_bf16 v28, v172, s23, v28
    v_dot2_f32_bf16 v29, v173, s23, v29
    v_dot2_f32_bf16 v30, v174, s23, v30
    v_dot2_f32_bf16 v31, v175, s23, v31
    s_nop 2
    v_min_u32 v24, -2, v24
    v_min_u32 v25, -2, v25
    v_min_u32 v26, -2, v26
    v_min_u32 v27, -2, v27
    v_min_u32 v28, -2, v28
    v_min_u32 v29, -2, v29
    v_min_u32 v30, -2, v30
    v_min_u32 v31, -2, v31
    buffer_store_dwordx4 v[24:27], v13, s[48:51], s54 offen sc1
    buffer_store_dwordx4 v[28:31], v13, s[48:51], s53 offen sc1
    s_waitcnt vmcnt(2)
    v_mov_b32 v40, v128
    v_mov_b32 v41, v129
    v_mov_b32 v42, v130
    v_mov_b32 v43, v131
    v_mov_b32 v44, v132
    v_mov_b32 v45, v133
    v_mov_b32 v46, v134
    v_mov_b32 v47, v135
    v_mov_b32 v48, v136
    v_mov_b32 v49, v137
    v_mov_b32 v50, v138
    v_mov_b32 v51, v139
    v_mov_b32 v52, v140
    v_mov_b32 v53, v141
    v_mov_b32 v54, v142
    v_mov_b32 v55, v143
    s_mov_b32 s58, 1
    s_branch ff_ln_145
ff_own_146:
    v_lshlrev_b32 v176, 16, v40
    v_and_b32 v177, 0xffff0000, v40
    v_lshlrev_b32 v178, 16, v41
    v_and_b32 v179, 0xffff0000, v41
    v_lshlrev_b32 v180, 16, v42
    v_and_b32 v181, 0xffff0000, v42
    v_lshlrev_b32 v182, 16, v43
    v_and_b32 v183, 0xffff0000, v43
    v_lshlrev_b32 v184, 16, v44
    v_and_b32 v185, 0xffff0000, v44
    v_lshlrev_b32 v186, 16, v45
    v_and_b32 v187, 0xffff0000, v45
    v_lshlrev_b32 v188, 16, v46
    v_and_b32 v189, 0xffff0000, v46
    v_lshlrev_b32 v190, 16, v47
    v_and_b32 v191, 0xffff0000, v47
    v_lshlrev_b32 v192, 16, v48
    v_and_b32 v193, 0xffff0000, v48
    v_lshlrev_b32 v194, 16, v49
    v_and_b32 v195, 0xffff0000, v49
    v_lshlrev_b32 v196, 16, v50
    v_and_b32 v197, 0xffff0000, v50
    v_lshlrev_b32 v198, 16, v51
    v_and_b32 v199, 0xffff0000, v51
    v_lshlrev_b32 v200, 16, v52
    v_and_b32 v201, 0xffff0000, v52
    v_lshlrev_b32 v202, 16, v53
    v_and_b32 v203, 0xffff0000, v53
    v_lshlrev_b32 v204, 16, v54
    v_and_b32 v205, 0xffff0000, v54
    v_lshlrev_b32 v206, 16, v55
    v_and_b32 v207, 0xffff0000, v55
    v_pk_add_f32 v[176:177], v[176:177], v[216:217]
    v_pk_add_f32 v[178:179], v[178:179], v[218:219]
    v_pk_add_f32 v[180:181], v[180:181], v[220:221]
    v_pk_add_f32 v[182:183], v[182:183], v[222:223]
    v_pk_add_f32 v[184:185], v[184:185], v[224:225]
    v_pk_add_f32 v[186:187], v[186:187], v[226:227]
    v_pk_add_f32 v[188:189], v[188:189], v[228:229]
    v_pk_add_f32 v[190:191], v[190:191], v[230:231]
    v_pk_add_f32 v[192:193], v[192:193], v[232:233]
    v_pk_add_f32 v[194:195], v[194:195], v[234:235]
    v_pk_add_f32 v[196:197], v[196:197], v[236:237]
    v_pk_add_f32 v[198:199], v[198:199], v[238:239]
    v_pk_add_f32 v[200:201], v[200:201], v[240:241]
    v_pk_add_f32 v[202:203], v[202:203], v[242:243]
    v_pk_add_f32 v[204:205], v[204:205], v[244:245]
    v_pk_add_f32 v[206:207], v[206:207], v[246:247]
    v_cvt_pk_bf16_f32 v40, v176, v177
    v_cvt_pk_bf16_f32 v41, v178, v179
    v_cvt_pk_bf16_f32 v42, v180, v181
    v_cvt_pk_bf16_f32 v43, v182, v183
    v_cvt_pk_bf16_f32 v44, v184, v185
    v_cvt_pk_bf16_f32 v45, v186, v187
    v_cvt_pk_bf16_f32 v46, v188, v189
    v_cvt_pk_bf16_f32 v47, v190, v191
    v_cvt_pk_bf16_f32 v48, v192, v193
    v_cvt_pk_bf16_f32 v49, v194, v195
    v_cvt_pk_bf16_f32 v50, v196, v197
    v_cvt_pk_bf16_f32 v51, v198, v199
    v_cvt_pk_bf16_f32 v52, v200, v201
    v_cvt_pk_bf16_f32 v53, v202, v203
    v_cvt_pk_bf16_f32 v54, v204, v205
    v_cvt_pk_bf16_f32 v55, v206, v207
    buffer_store_dwordx4 v[40:43], v0, s[36:39], 0 offen offset:0 sc1
    buffer_store_dwordx4 v[44:47], v0, s[36:39], 0 offen offset:512 sc1
    buffer_store_dwordx4 v[48:51], v0, s[36:39], 0 offen offset:1024 sc1
    buffer_store_dwordx4 v[52:55], v0, s[36:39], 0 offen offset:1536 sc1
    s_cmp_ge_u32 s2, 224
    s_cbranch_scc1 ff_red2_148
    s_branch ff_fin_149
ff_red_147:
    s_sub_u32 s40, s2, 224
    s_lshr_b32 s41, s40, 4
    s_and_b32 s42, s40, 15
    s_mov_b32 s8, s56
    s_and_b32 s9, s57, 0xffff
    s_mov_b32 s10, 0x800
    s_mov_b32 s11, 0x00020000
    buffer_load_dwordx4 v[96:99], v7, s[8:11], 0 offen offset:0
    buffer_load_dwordx4 v[100:103], v7, s[8:11], 0 offen offset:512
    buffer_load_dwordx4 v[104:107], v7, s[8:11], 0 offen offset:1024
    buffer_load_dwordx4 v[108:111], v7, s[8:11], 0 offen offset:1536
    s_lshl_b32 s43, s41, 5
    v_readlane_b32 s46, v15, s43
    s_lshl_b32 s47, s42, 7
    v_lshl_add_u32 v9, v8, 3, s47
    s_lshl_b32 s46, s46, 11
    s_lshl_b32 s31, s41, 11
    s_add_u32 s31, s31, 4096
    v_add_u32 v12, s31, v9
    s_waitcnt lgkmcnt(0)
    ds_read_b64 v[32:33], v12
    buffer_load_dwordx2 v[34:35], v9, s[24:27], s46 offen sc1
    v_lshrrev_b32 v10, 4, v2
    v_lshlrev_b32 v10, 13, v10
    v_lshl_add_u32 v10, v8, 4, v10
    s_lshl_b32 s47, s40, 8
    s_waitcnt vmcnt(1)
    v_dot2_f32_bf16 v12, v40, v96, 0
    v_dot2_f32_bf16 v12, v41, v97, v12
    v_dot2_f32_bf16 v12, v42, v98, v12
    v_dot2_f32_bf16 v12, v43, v99, v12
    v_dot2_f32_bf16 v12, v44, v100, v12
    v_dot2_f32_bf16 v12, v45, v101, v12
    v_dot2_f32_bf16 v12, v46, v102, v12
    v_dot2_f32_bf16 v12, v47, v103, v12
    v_dot2_f32_bf16 v12, v48, v104, v12
    v_dot2_f32_bf16 v12, v49, v105, v12
    v_dot2_f32_bf16 v12, v50, v106, v12
    v_dot2_f32_bf16 v12, v51, v107, v12
    v_dot2_f32_bf16 v12, v52, v108, v12
    v_dot2_f32_bf16 v12, v53, v109, v12
    v_dot2_f32_bf16 v12, v54, v110, v12
    v_dot2_f32_bf16 v12, v55, v111, v12
    s_nop 2
    s_nop 1
    v_add_f32_dpp v12, v12, v12 quad_perm:[1,0,3,2] row_mask:0xf bank_mask:0xf
    s_nop 1
    v_add_f32_dpp v12, v12, v12 quad_perm:[2,3,0,1] row_mask:0xf bank_mask:0xf
    s_nop 1
    v_add_f32_dpp v12, v12, v12 row_half_mirror row_mask:0xf bank_mask:0xf
    s_nop 1
    v_add_f32_dpp v12, v12, v12 row_mirror row_mask:0xf bank_mask:0xf
    v_mov_b32 v13, v12
    s_nop 1
    v_permlane16_swap_b32 v12, v13
    s_nop 1
    v_add_f32 v12, v12, v13
    v_cvt_pk_bf16_f32 v12, v12, v12
    v_and_b32 v12, 0xffff0000, v12
    v_mul_f32 v12, 0xbfb8aa3b, v12
    v_exp_f32 v12, v12
    s_lshl_b32 s44, s42, 1
    v_add_f32 v12, 1.0, v12
    v_rcp_f32 v12, v12
    s_add_u32 s44, s44, s41
    s_lshl_b32 s44, s44, 11
    v_cvt_pk_bf16_f32 v12, v12, v12
    v_and_b32 v12, 0xffff0000, v12
    v_mov_b32 v40, v128
    v_mov_b32 v41, v129
    v_mov_b32 v42, v130
    v_mov_b32 v43, v131
    v_mov_b32 v44, v132
    v_mov_b32 v45, v133
    v_mov_b32 v46, v134
    v_mov_b32 v47, v135
    v_mov_b32 v48, v136
    v_mov_b32 v49, v137
    v_mov_b32 v50, v138
    v_mov_b32 v51, v139
    v_mov_b32 v52, v140
    v_mov_b32 v53, v141
    v_mov_b32 v54, v142
    v_mov_b32 v55, v143
    v_readlane_b32 s45, v12, s43
    s_mov_b32 s58, 1
    s_branch ff_ln_145
ff_red2_148:
    s_mov_b32 s52, 1048576
ff_rpoll_151:
    s_mov_b32 s53, s47
    buffer_load_dwordx4 v[96:99], v10, s[48:51], s53 offen sc1
    s_add_u32 s53, s53, 0x20000
    buffer_load_dwordx4 v[100:103], v10, s[48:51], s53 offen sc1
    s_add_u32 s53, s53, 0x20000
    buffer_load_dwordx4 v[104:107], v10, s[48:51], s53 offen sc1
    s_add_u32 s53, s53, 0x20000
    buffer_load_dwordx4 v[108:111], v10, s[48:51], s53 offen sc1
    s_add_u32 s53, s53, 0x20000
    buffer_load_dwordx4 v[112:115], v10, s[48:51], s53 offen sc1
    s_add_u32 s53, s53, 0x20000
    buffer_load_dwordx4 v[116:119], v10, s[48:51], s53 offen sc1
    s_add_u32 s53, s53, 0x20000
    buffer_load_dwordx4 v[120:123], v10, s[48:51], s53 offen sc1
    s_add_u32 s53, s53, 0x20000
    buffer_load_dwordx4 v[124:127], v10, s[48:51], s53 offen sc1
    s_add_u32 s53, s53, 0x20000
    buffer_load_dwordx4 v[128:131], v10, s[48:51], s53 offen sc1
    s_add_u32 s53, s53, 0x20000
    buffer_load_dwordx4 v[132:135], v10, s[48:51], s53 offen sc1
    s_add_u32 s53, s53, 0x20000
    buffer_load_dwordx4 v[136:139], v10, s[48:51], s53 offen sc1
    s_add_u32 s53, s53, 0x20000
    buffer_load_dwordx4 v[140:143], v10, s[48:51], s53 offen sc1
    s_add_u32 s53, s53, 0x20000
    buffer_load_dwordx4 v[144:147], v10, s[48:51], s53 offen sc1
    s_add_u32 s53, s53, 0x20000
    buffer_load_dwordx4 v[148:151], v10, s[48:51], s53 offen sc1
    s_add_u32 s53, s53, 0x20000
    v_mov_b32 v13, 0
    s_waitcnt vmcnt(13)
    v_max3_u32 v13, v13, v96, v97
    v_max3_u32 v13, v13, v98, v99
    s_waitcnt vmcnt(12)
    v_max3_u32 v13, v13, v100, v101
    v_max3_u32 v13, v13, v102, v103
    s_waitcnt vmcnt(11)
    v_max3_u32 v13, v13, v104, v105
    v_max3_u32 v13, v13, v106, v107
    s_waitcnt vmcnt(10)
    v_max3_u32 v13, v13, v108, v109
    v_max3_u32 v13, v13, v110, v111
    s_waitcnt vmcnt(9)
    v_max3_u32 v13, v13, v112, v113
    v_max3_u32 v13, v13, v114, v115
    s_waitcnt vmcnt(8)
    v_max3_u32 v13, v13, v116, v117
    v_max3_u32 v13, v13, v118, v119
    s_waitcnt vmcnt(7)
    v_max3_u32 v13, v13, v120, v121
    v_max3_u32 v13, v13, v122, v123
    s_waitcnt vmcnt(6)
    v_max3_u32 v13, v13, v124, v125
    v_max3_u32 v13, v13, v126, v127
    s_waitcnt vmcnt(5)
    v_max3_u32 v13, v13, v128, v129
    v_max3_u32 v13, v13, v130, v131
    s_waitcnt vmcnt(4)
    v_max3_u32 v13, v13, v132, v133
    v_max3_u32 v13, v13, v134, v135
    s_waitcnt vmcnt(3)
    v_max3_u32 v13, v13, v136, v137
    v_max3_u32 v13, v13, v138, v139
    s_waitcnt vmcnt(2)
    v_max3_u32 v13, v13, v140, v141
    v_max3_u32 v13, v13, v142, v143
    s_waitcnt vmcnt(1)
    v_max3_u32 v13, v13, v144, v145
    v_max3_u32 v13, v13, v146, v147
    s_waitcnt vmcnt(0)
    v_max3_u32 v13, v13, v148, v149
    v_max3_u32 v13, v13, v150, v151
    s_sub_u32 s52, s52, 1
    s_cbranch_scc1 ff_rgo_150
    v_cmp_eq_u32 vcc, -1, v13
    s_cbranch_vccnz ff_rpoll_151
ff_rgo_150:
    v_pk_add_f32 v[96:97], v[96:97], v[100:101]
    v_pk_add_f32 v[98:99], v[98:99], v[102:103]
    v_pk_add_f32 v[96:97], v[96:97], v[104:105]
    v_pk_add_f32 v[98:99], v[98:99], v[106:107]
    v_pk_add_f32 v[96:97], v[96:97], v[108:109]
    v_pk_add_f32 v[98:99], v[98:99], v[110:111]
    v_pk_add_f32 v[96:97], v[96:97], v[112:113]
    v_pk_add_f32 v[98:99], v[98:99], v[114:115]
    v_pk_add_f32 v[96:97], v[96:97], v[116:117]
    v_pk_add_f32 v[98:99], v[98:99], v[118:119]
    v_pk_add_f32 v[96:97], v[96:97], v[120:121]
    v_pk_add_f32 v[98:99], v[98:99], v[122:123]
    v_pk_add_f32 v[96:97], v[96:97], v[124:125]
    v_pk_add_f32 v[98:99], v[98:99], v[126:127]
    v_pk_add_f32 v[96:97], v[96:97], v[128:129]
    v_pk_add_f32 v[98:99], v[98:99], v[130:131]
    v_pk_add_f32 v[96:97], v[96:97], v[132:133]
    v_pk_add_f32 v[98:99], v[98:99], v[134:135]
    v_pk_add_f32 v[96:97], v[96:97], v[136:137]
    v_pk_add_f32 v[98:99], v[98:99], v[138:139]
    v_pk_add_f32 v[96:97], v[96:97], v[140:141]
    v_pk_add_f32 v[98:99], v[98:99], v[142:143]
    v_pk_add_f32 v[96:97], v[96:97], v[144:145]
    v_pk_add_f32 v[98:99], v[98:99], v[146:147]
    v_pk_add_f32 v[96:97], v[96:97], v[148:149]
    v_pk_add_f32 v[98:99], v[98:99], v[150:151]
    v_mov_b32 v100, v96
    v_mov_b32 v101, v97
    v_mov_b32 v102, v98
    v_mov_b32 v103, v99
    s_nop 1
    v_permlane16_swap_b32 v96, v100
    v_permlane16_swap_b32 v97, v101
    v_permlane16_swap_b32 v98, v102
    v_permlane16_swap_b32 v99, v103
    s_nop 1
    v_add_f32 v96, v96, v100
    v_add_f32 v97, v97, v101
    v_add_f32 v98, v98, v102
    v_add_f32 v99, v99, v103
    v_mov_b32 v100, v96
    v_mov_b32 v101, v97
    v_mov_b32 v102, v98
    v_mov_b32 v103, v99
    s_nop 1
    v_permlane32_swap_b32 v96, v100
    v_permlane32_swap_b32 v97, v101
    v_permlane32_swap_b32 v98, v102
    v_permlane32_swap_b32 v99, v103
    s_nop 1
    v_add_f32 v96, v96, v100
    v_add_f32 v97, v97, v101
    v_add_f32 v98, v98, v102
    v_add_f32 v99, v99, v103
    v_lshlrev_b32 v14, 4, v8
    s_lshl_b32 s31, s30, 8
    v_add_u32 v13, s31, v14
    ds_write_b128 v13, v[96:99]
    s_waitcnt lgkmcnt(0)
    s_barrier
    ds_read_b128 v[96:99], v14 offset:0
    ds_read_b128 v[100:103], v14 offset:256
    ds_read_b128 v[104:107], v14 offset:512
    ds_read_b128 v[108:111], v14 offset:768
    s_waitcnt lgkmcnt(0)
    v_pk_add_f32 v[96:97], v[96:97], v[100:101]
    v_pk_add_f32 v[98:99], v[98:99], v[102:103]
    v_pk_add_f32 v[96:97], v[96:97], v[104:105]
    v_pk_add_f32 v[98:99], v[98:99], v[106:107]
    v_pk_add_f32 v[96:97], v[96:97], v[108:109]
    v_pk_add_f32 v[98:99], v[98:99], v[110:111]
    v_cvt_pk_bf16_f32 v20, v96, v97
    v_lshlrev_b32 v21, 16, v20
    v_and_b32 v22, 0xffff0000, v20
    v_mul_f32 v21, s45, v21
    v_mul_f32 v22, s45, v22
    v_cvt_pk_bf16_f32 v20, v21, v22
    v_lshlrev_b32 v21, 16, v20
    v_and_b32 v22, 0xffff0000, v20
    v_lshlrev_b32 v23, 16, v32
    v_and_b32 v24, 0xffff0000, v32
    v_add_f32 v21, v21, v23
    v_add_f32 v22, v22, v24
    v_cvt_pk_bf16_f32 v20, v21, v22
    v_lshlrev_b32 v21, 16, v20
    v_and_b32 v22, 0xffff0000, v20
    v_lshlrev_b32 v23, 16, v34
    v_and_b32 v24, 0xffff0000, v34
    v_add_f32 v21, v21, v23
    v_add_f32 v22, v22, v24
    v_cvt_pk_bf16_f32 v26, v21, v22
    v_cvt_pk_bf16_f32 v20, v98, v99
    v_lshlrev_b32 v21, 16, v20
    v_and_b32 v22, 0xffff0000, v20
    v_mul_f32 v21, s45, v21
    v_mul_f32 v22, s45, v22
    v_cvt_pk_bf16_f32 v20, v21, v22
    v_lshlrev_b32 v21, 16, v20
    v_and_b32 v22, 0xffff0000, v20
    v_lshlrev_b32 v23, 16, v33
    v_and_b32 v24, 0xffff0000, v33
    v_add_f32 v21, v21, v23
    v_add_f32 v22, v22, v24
    v_cvt_pk_bf16_f32 v20, v21, v22
    v_lshlrev_b32 v21, 16, v20
    v_and_b32 v22, 0xffff0000, v20
    v_lshlrev_b32 v23, 16, v35
    v_and_b32 v24, 0xffff0000, v35
    v_add_f32 v21, v21, v23
    v_add_f32 v22, v22, v24
    v_cvt_pk_bf16_f32 v27, v21, v22
    v_cmp_gt_u32 vcc, 16, v2
    s_and_saveexec_b64 s[52:53], vcc
    s_cbranch_execz ff_fin_149
    buffer_store_dwordx2 v[26:27], v9, s[36:39], s46 offen sc1
ff_fin_149:
    s_mov_b64 exec, -1
k12_end_1:
    s_endpgm
k2_prep_70:
    s_sub_u32 s40, s36, s38
    v_subrev_u32 v6, s40, v4
    v_cmp_gt_i32 s[44:45], 0, v6
    v_cmp_gt_i32 s[46:47], 1, v6
    v_cmp_gt_i32 s[48:49], 2, v6
    v_cmp_gt_i32 s[50:51], 3, v6
    v_cndmask_b32 v16, v8, v5, s[44:45]
    v_cndmask_b32 v17, v8, v5, s[46:47]
    v_cndmask_b32 v18, v8, v5, s[48:49]
    v_cndmask_b32 v19, v8, v5, s[50:51]
    v_cmp_gt_i32 s[44:45], 16, v6
    v_cmp_gt_i32 s[46:47], 17, v6
    v_cmp_gt_i32 s[48:49], 18, v6
    v_cmp_gt_i32 s[50:51], 19, v6
    v_cndmask_b32 v32, v8, v5, s[44:45]
    v_cndmask_b32 v33, v8, v5, s[46:47]
    v_cndmask_b32 v34, v8, v5, s[48:49]
    v_cndmask_b32 v35, v8, v5, s[50:51]
    s_nop 1
    s_branch k2_prepret_71
k2_prep_78:
    s_sub_u32 s40, s36, s38
    v_subrev_u32 v6, s40, v4
    v_cmp_gt_i32 s[44:45], 0, v6
    v_cmp_gt_i32 s[46:47], 1, v6
    v_cmp_gt_i32 s[48:49], 2, v6
    v_cmp_gt_i32 s[50:51], 3, v6
    v_cndmask_b32 v16, v8, v5, s[44:45]
    v_cndmask_b32 v17, v8, v5, s[46:47]
    v_cndmask_b32 v18, v8, v5, s[48:49]
    v_cndmask_b32 v19, v8, v5, s[50:51]
    v_cmp_gt_i32 s[44:45], 16, v6
    v_cmp_gt_i32 s[46:47], 17, v6
    v_cmp_gt_i32 s[48:49], 18, v6
    v_cmp_gt_i32 s[50:51], 19, v6
    v_cndmask_b32 v32, v8, v5, s[44:45]
    v_cndmask_b32 v33, v8, v5, s[46:47]
    v_cndmask_b32 v34, v8, v5, s[48:49]
    v_cndmask_b32 v35, v8, v5, s[50:51]
    s_nop 1
    s_branch k2_prepret_79
k2_prep_96:
    s_sub_u32 s40, s36, s39
    v_subrev_u32 v6, s40, v4
    v_cmp_gt_i32 s[44:45], 0, v6
    v_cmp_gt_i32 s[46:47], 1, v6
    v_cmp_gt_i32 s[48:49], 2, v6
    v_cmp_gt_i32 s[50:51], 3, v6
    v_cndmask_b32 v16, v10, v5, s[44:45]
    v_cndmask_b32 v17, v10, v5, s[46:47]
    v_cndmask_b32 v18, v10, v5, s[48:49]
    v_cndmask_b32 v19, v10, v5, s[50:51]
    v_cmp_gt_i32 s[44:45], 16, v6
    v_cmp_gt_i32 s[46:47], 17, v6
    v_cmp_gt_i32 s[48:49], 18, v6
    v_cmp_gt_i32 s[50:51], 19, v6
    v_cndmask_b32 v32, v10, v5, s[44:45]
    v_cndmask_b32 v33, v10, v5, s[46:47]
    v_cndmask_b32 v34, v10, v5, s[48:49]
    v_cndmask_b32 v35, v10, v5, s[50:51]
    v_cmp_gt_i32 s[44:45], 32, v6
    v_cmp_gt_i32 s[46:47], 33, v6
    v_cmp_gt_i32 s[48:49], 34, v6
    v_cmp_gt_i32 s[50:51], 35, v6
    v_cndmask_b32 v24, v10, v5, s[44:45]
    v_cndmask_b32 v25, v10, v5, s[46:47]
    v_cndmask_b32 v26, v10, v5, s[48:49]
    v_cndmask_b32 v27, v10, v5, s[50:51]
    v_cmp_gt_i32 s[44:45], 48, v6
    v_cmp_gt_i32 s[46:47], 49, v6
    v_cmp_gt_i32 s[48:49], 50, v6
    v_cmp_gt_i32 s[50:51], 51, v6
    v_cndmask_b32 v40, v10, v5, s[44:45]
    v_cndmask_b32 v41, v10, v5, s[46:47]
    v_cndmask_b32 v42, v10, v5, s[48:49]
    v_cndmask_b32 v43, v10, v5, s[50:51]
    s_nop 1
    s_branch k2_prepret_97
k2_prep_100:
    s_sub_u32 s40, s36, s39
    s_sub_u32 s40, s40, 64
    v_subrev_u32 v6, s40, v4
    v_cmp_gt_i32 s[44:45], 0, v6
    v_cmp_gt_i32 s[46:47], 1, v6
    v_cmp_gt_i32 s[48:49], 2, v6
    v_cmp_gt_i32 s[50:51], 3, v6
    v_cndmask_b32 v20, v11, v5, s[44:45]
    v_cndmask_b32 v21, v11, v5, s[46:47]
    v_cndmask_b32 v22, v11, v5, s[48:49]
    v_cndmask_b32 v23, v11, v5, s[50:51]
    v_cmp_gt_i32 s[44:45], 16, v6
    v_cmp_gt_i32 s[46:47], 17, v6
    v_cmp_gt_i32 s[48:49], 18, v6
    v_cmp_gt_i32 s[50:51], 19, v6
    v_cndmask_b32 v36, v11, v5, s[44:45]
    v_cndmask_b32 v37, v11, v5, s[46:47]
    v_cndmask_b32 v38, v11, v5, s[48:49]
    v_cndmask_b32 v39, v11, v5, s[50:51]
    v_cmp_gt_i32 s[44:45], 32, v6
    v_cmp_gt_i32 s[46:47], 33, v6
    v_cmp_gt_i32 s[48:49], 34, v6
    v_cmp_gt_i32 s[50:51], 35, v6
    v_cndmask_b32 v28, v11, v5, s[44:45]
    v_cndmask_b32 v29, v11, v5, s[46:47]
    v_cndmask_b32 v30, v11, v5, s[48:49]
    v_cndmask_b32 v31, v11, v5, s[50:51]
    v_cmp_gt_i32 s[44:45], 48, v6
    v_cmp_gt_i32 s[46:47], 49, v6
    v_cmp_gt_i32 s[48:49], 50, v6
    v_cmp_gt_i32 s[50:51], 51, v6
    v_cndmask_b32 v44, v11, v5, s[44:45]
    v_cndmask_b32 v45, v11, v5, s[46:47]
    v_cndmask_b32 v46, v11, v5, s[48:49]
    v_cndmask_b32 v47, v11, v5, s[50:51]
    s_nop 1
    s_branch k2_prepret_101
k12_ool_10:
    buffer_load_dword v52, v8, s[24:27], 0 offen sc1
    s_branch k12_oolret_11
k12_ool_12:
    s_mov_b64 exec, 1
    buffer_atomic_add v9, v8, s[24:27], 0 offen sc1
    s_mov_b64 exec, -1
    s_branch k12_oolret_13
k12_ool_14:
    buffer_load_dword v51, v50, s[12:15], s56 offen
    s_branch k12_oolret_15
k12_ool_18:
    v_readfirstlane_b32 s31, v52
    s_cmp_ge_u32 s31, 256
    s_cbranch_scc1 spin_ok_16
    s_mov_b32 s40, 1048576
spin_17:
    s_sleep 8
    buffer_load_dword v52, v8, s[24:27], 0 offen sc1
    s_waitcnt vmcnt(0)
    v_readfirstlane_b32 s31, v52
    s_sub_u32 s40, s40, 1
    s_cselect_b32 s31, -1, s31
    s_cmp_lt_u32 s31, 256
    s_cbranch_scc1 spin_17
spin_ok_16:
    s_branch k12_oolret_19
k12_ool_20:
    s_mov_b64 exec, 1
    buffer_atomic_add v9, v8, s[24:27], 0 offen sc1
    s_mov_b64 exec, -1
    s_branch k12_oolret_21
k12_ool_22:
    global_load_dword v51, v[2:3], off
    s_branch k12_oolret_23
k12_ool_26:
    buffer_load_dword v52, v8, s[24:27], 0 offen sc1
    s_branch k12_oolret_27
k12_ool_28:
    s_mov_b64 exec, 1
    buffer_atomic_add v9, v8, s[24:27], 0 offen sc1
    s_mov_b64 exec, -1
    s_branch k12_oolret_29
k12_ool_30:
    buffer_load_dword v51, v50, s[12:15], s56 offen
    s_branch k12_oolret_31
k12_ool_34:
    v_readfirstlane_b32 s31, v52
    s_cmp_ge_u32 s31, 256
    s_cbranch_scc1 spin_ok_32
    s_mov_b32 s40, 1048576
spin_33:
    s_sleep 8
    buffer_load_dword v52, v8, s[24:27], 0 offen sc1
    s_waitcnt vmcnt(0)
    v_readfirstlane_b32 s31, v52
    s_sub_u32 s40, s40, 1
    s_cselect_b32 s31, -1, s31
    s_cmp_lt_u32 s31, 256
    s_cbranch_scc1 spin_33
spin_ok_32:
    s_branch k12_oolret_35
k12_ool_36:
    s_mov_b64 exec, 1
    buffer_atomic_add v9, v8, s[24:27], 0 offen sc1
    s_mov_b64 exec, -1
    s_branch k12_oolret_37
k12_ool_38:
    global_load_dword v51, v[2:3], off
    s_branch k12_oolret_39
k12_ool_40:
    s_add_u32 s52, s47, 528384
    buffer_store_dwordx4 v[156:159], v1, s[48:51], s52 offen offset:3072 sc1
    s_branch k12_oolret_41
k12_ool_42:
    s_add_u32 s52, s47, 532480
    buffer_store_dwordx4 v[160:163], v1, s[48:51], s52 offen offset:0 sc1
    s_branch k12_oolret_43
k12_ool_44:
    s_add_u32 s52, s47, 532480
    buffer_store_dwordx4 v[164:167], v1, s[48:51], s52 offen offset:1024 sc1
    s_branch k12_oolret_45
k12_ool_46:
    s_add_u32 s52, s47, 532480
    buffer_store_dwordx4 v[168:171], v1, s[48:51], s52 offen offset:2048 sc1
    s_branch k12_oolret_47
k12_ool_48:
    s_add_u32 s52, s47, 532480
    buffer_store_dwordx4 v[172:175], v1, s[48:51], s52 offen offset:3072 sc1
    s_branch k12_oolret_49
k12_ool_50:
    s_add_u32 s52, s47, 536576
    buffer_store_dwordx4 v[176:179], v1, s[48:51], s52 offen offset:0 sc1
    s_branch k12_oolret_51
k12_ool_52:
    s_add_u32 s52, s47, 536576
    buffer_store_dwordx4 v[180:183], v1, s[48:51], s52 offen offset:1024 sc1
    s_branch k12_oolret_53
k12_ool_54:
    s_add_u32 s52, s47, 536576
    buffer_store_dwordx4 v[184:187], v1, s[48:51], s52 offen offset:2048 sc1
    s_branch k12_oolret_55
k12_ool_56:
    s_add_u32 s52, s47, 536576
    buffer_store_dwordx4 v[188:191], v1, s[48:51], s52 offen offset:3072 sc1
    s_branch k12_oolret_57
k12_ool_58:
    s_mov_b32 s50, 0
    s_branch k12_oolret_59
k12_ool_60:
    s_mov_b64 exec, 1
    buffer_atomic_add v9, v8, s[24:27], s54 offen sc1
    s_mov_b64 exec, -1
    s_branch k12_oolret_61
k12_ool_62:
    buffer_load_dword v52, v8, s[24:27], s55 offen sc1
    s_branch k12_oolret_63
k12_ool_66:
    s_waitcnt vmcnt(14)
    v_readfirstlane_b32 s31, v52
    s_cmp_ge_u32 s31, 2
    s_cbranch_scc1 spin_ok_64
    s_mov_b32 s40, 1048576
spin_65:
    s_sleep 8
    buffer_load_dword v52, v8, s[24:27], s55 offen sc1
    s_waitcnt vmcnt(0)
    v_readfirstlane_b32 s31, v52
    s_sub_u32 s40, s40, 1
    s_cselect_b32 s31, -1, s31
    s_cmp_lt_u32 s31, 2
    s_cbranch_scc1 spin_65
spin_ok_64:
    s_branch k12_oolret_67
k12_ool_68:
    s_mov_b64 exec, 1
    buffer_atomic_add v9, v8, s[24:27], s3 offen sc1
    s_mov_b64 exec, -1
    s_branch k12_oolret_69
k12_ool_72:
    buffer_load_dword v58, v59, s[24:27], s5 offen sc1
    s_branch k12_oolret_73
k12_ool_76:
    s_waitcnt vmcnt(0)
    v_readfirstlane_b32 s31, v58
    s_cmp_ge_u32 s31, 14
    s_cbranch_scc1 spin_ok_74
    s_mov_b32 s40, 1048576
spin_75:
    s_sleep 8
    buffer_load_dword v58, v59, s[24:27], s5 offen sc1
    s_waitcnt vmcnt(0)
    v_readfirstlane_b32 s31, v58
    s_sub_u32 s40, s40, 1
    s_cselect_b32 s31, -1, s31
    s_cmp_lt_u32 s31, 14
    s_cbranch_scc1 spin_75
spin_ok_74:
    s_branch k12_oolret_77
k12_ool_116:
    s_mov_b64 exec, 1
    buffer_atomic_add v76, v75, s[16:19], s57 offen sc1
    s_mov_b64 exec, -1
    s_branch k12_oolret_117
k12_ool_121:
    s_mov_b64 exec, 1
    buffer_atomic_add v76, v75, s[16:19], s58 offen sc1
    s_mov_b64 exec, -1
    s_branch k12_oolret_122
k12_ool_125:
    s_mov_b32 s34, 1048576
op_spin_123:
    buffer_load_dword v74, v73, s[16:19], s59 offen sc1
    s_waitcnt vmcnt(0)
    v_cmp_le_u32 vcc, 4, v74
    s_sub_u32 s34, s34, 1
    s_cbranch_scc1 op_ok_124
    s_mov_b32 s33, vcc_lo
    s_bitcmp1_b32 s33, 0
    s_cbranch_scc1 op_ok_124
    s_sleep 4
    s_branch op_spin_123
op_ok_124:
    buffer_load_dwordx4 a[128:131], v88, s[8:11], s62 offen offset:0 sc1
    buffer_load_dwordx4 a[132:135], v88, s[8:11], s62 offen offset:1024 sc1
    buffer_load_dwordx4 a[136:139], v89, s[8:11], s62 offen offset:0 sc1
    buffer_load_dwordx4 a[140:143], v89, s[8:11], s62 offen offset:1024 sc1
    s_add_u32 s62, s62, 0x40000
    s_and_b32 s62, s62, 0x7fffff
    buffer_load_dwordx4 a[144:147], v88, s[8:11], s62 offen offset:0 sc1
    buffer_load_dwordx4 a[148:151], v88, s[8:11], s62 offen offset:1024 sc1
    buffer_load_dwordx4 a[152:155], v89, s[8:11], s62 offen offset:0 sc1
    buffer_load_dwordx4 a[156:159], v89, s[8:11], s62 offen offset:1024 sc1
    s_add_u32 s62, s62, 0x40000
    s_and_b32 s62, s62, 0x7fffff
    buffer_load_dwordx4 a[160:163], v88, s[8:11], s62 offen offset:0 sc1
    buffer_load_dwordx4 a[164:167], v88, s[8:11], s62 offen offset:1024 sc1
    buffer_load_dwordx4 a[168:171], v89, s[8:11], s62 offen offset:0 sc1
    buffer_load_dwordx4 a[172:175], v89, s[8:11], s62 offen offset:1024 sc1
    s_add_u32 s62, s62, 0x40000
    s_and_b32 s62, s62, 0x7fffff
    s_branch k12_oolret_126
k12_ool_131:
    buffer_load_dwordx2 v[192:193], v78, s[20:23], 0 offen offset:0
    buffer_load_dwordx2 v[194:195], v78, s[20:23], 0 offen offset:32
    buffer_load_dwordx2 v[196:197], v78, s[20:23], 0 offen offset:64
    buffer_load_dwordx2 v[198:199], v78, s[20:23], 0 offen offset:96
    buffer_load_dwordx2 v[200:201], v79, s[20:23], 0 offen offset:0
    buffer_load_dwordx2 v[202:203], v79, s[20:23], 0 offen offset:32
    buffer_load_dwordx2 v[204:205], v79, s[20:23], 0 offen offset:64
    buffer_load_dwordx2 v[206:207], v79, s[20:23], 0 offen offset:96
    buffer_load_dwordx2 v[208:209], v80, s[44:47], 0 offen offset:0
    buffer_load_dwordx2 v[210:211], v80, s[44:47], 0 offen offset:32
    buffer_load_dwordx2 v[212:213], v80, s[44:47], 0 offen offset:64
    buffer_load_dwordx2 v[214:215], v80, s[44:47], 0 offen offset:96
    global_load_dword v84, v[82:83], off
    s_mov_b32 s10, 0
    s_mov_b32 s14, 0
    s_mov_b32 s34, 1048576
ff_spin_129:
    v_cmp_gt_u32 vcc, 4, v95
    s_cbranch_vccz ff_ok_130
    s_sub_u32 s34, s34, 1
    s_cbranch_scc1 ff_ok_130
    s_sleep 4
    buffer_load_dword v95, v94, s[16:19], 0 offen sc1
    s_waitcnt vmcnt(0)
    s_branch ff_spin_129
ff_ok_130:
    s_add_u32 s44, s6, 0x6000000
    s_addc_u32 s45, s7, 0
    s_and_b32 s45, s45, 0xffff
    s_cmp_ge_u32 s2, 224
    s_cselect_b32 s46, 0, 0x1000000
    s_branch k12_oolret_132
k12_ool_135:
    s_mov_b32 s34, 1048576
op_spin_133:
    buffer_load_dword v74, v73, s[16:19], s59 offen sc1
    s_waitcnt vmcnt(0)
    v_cmp_le_u32 vcc, 4, v74
    s_sub_u32 s34, s34, 1
    s_cbranch_scc1 op_ok_134
    s_mov_b32 s33, vcc_lo
    s_bitcmp1_b32 s33, s32
    s_cbranch_scc1 op_ok_134
    s_sleep 4
    s_branch op_spin_133
op_ok_134:
    s_branch k12_oolret_136
k12_ool_137:
    buffer_load_dword v95, v94, s[16:19], 0 offen sc1
    s_branch k12_oolret_138
k2_tramp_80:
    s_call_b64 s[40:41], k2_rare_152
    s_branch k2_ret_81
k2_tramp_84:
    s_call_b64 s[40:41], k2_rare_153
    s_branch k2_ret_85
k2_tramp_86:
    s_call_b64 s[40:41], k2_rare_152
    s_branch k2_ret_87
k2_tramp_88:
    s_call_b64 s[40:41], k2_rare_153
    s_branch k2_ret_89
k2_tramp_90:
    s_call_b64 s[40:41], k2_rare_152
    s_branch k2_ret_91
k2_tramp_92:
    s_call_b64 s[40:41], k2_rare_153
    s_branch k2_ret_93
k2_tramp_94:
    s_call_b64 s[40:41], k2_rare_158
    s_branch k2_ret_95
k2_tramp_98:
    s_call_b64 s[40:41], k2_rare_159
    s_branch k2_ret_99
k2_tramp_102:
    s_call_b64 s[40:41], k2_rare_160
    s_branch k2_ret_103
k2_tramp_106:
    s_call_b64 s[40:41], k2_rare_161
    s_branch k2_ret_107
k2_tramp_108:
    s_call_b64 s[40:41], k2_rare_160
    s_branch k2_ret_109
k2_tramp_110:
    s_call_b64 s[40:41], k2_rare_161
    s_branch k2_ret_111
k2_tramp_112:
    s_call_b64 s[40:41], k2_rare_160
    s_branch k2_ret_113
k2_tramp_114:
    s_call_b64 s[40:41], k2_rare_165
    s_branch k2_ret_115
k2_rare_152:
    s_nop 7
    v_max_f32 v52, v128, v129
    v_max3_f32 v52, v52, v130, v131
    v_max3_f32 v52, v52, v144, v145
    v_max3_f32 v52, v52, v146, v147
    v_max_f32 v53, v132, v133
    v_max3_f32 v53, v53, v134, v135
    v_max3_f32 v53, v53, v148, v149
    v_max3_f32 v53, v53, v150, v151
    v_max_f32 v54, v136, v137
    v_max3_f32 v54, v54, v138, v139
    v_max3_f32 v54, v54, v152, v153
    v_max3_f32 v54, v54, v154, v155
    v_max_f32 v55, v140, v141
    v_max3_f32 v55, v55, v142, v143
    v_max3_f32 v55, v55, v156, v157
    v_max3_f32 v55, v55, v158, v159
    v_mov_b32 v224, v52
    v_mov_b32 v225, v53
    v_mov_b32 v226, v54
    v_mov_b32 v227, v55
    s_nop 1
    v_permlane16_swap_b32 v52, v224
    v_permlane16_swap_b32 v53, v225
    v_permlane16_swap_b32 v54, v226
    v_permlane16_swap_b32 v55, v227
    s_nop 1
    v_max_f32 v52, v52, v224
    v_max_f32 v53, v53, v225
    v_max_f32 v54, v54, v226
    v_max_f32 v55, v55, v227
    v_mov_b32 v224, v52
    v_mov_b32 v225, v53
    v_mov_b32 v226, v54
    v_mov_b32 v227, v55
    s_nop 1
    v_permlane32_swap_b32 v52, v224
    v_permlane32_swap_b32 v53, v225
    v_permlane32_swap_b32 v54, v226
    v_permlane32_swap_b32 v55, v227
    s_nop 1
    v_max_f32 v52, v52, v224
    v_max_f32 v53, v53, v225
    v_max_f32 v54, v54, v226
    v_max_f32 v55, v55, v227
    v_add_f32 v52, 0x41400000, v52
    v_max_f32 v52, 0, v52
    v_add_f32 v53, 0x41400000, v53
    v_max_f32 v53, 0, v53
    v_add_f32 v54, 0x41400000, v54
    v_max_f32 v54, 0, v54
    v_add_f32 v55, 0x41400000, v55
    v_max_f32 v55, 0, v55
    v_sub_f32 v128, v128, v52
    v_sub_f32 v129, v129, v52
    v_sub_f32 v130, v130, v52
    v_sub_f32 v131, v131, v52
    v_sub_f32 v132, v132, v53
    v_sub_f32 v133, v133, v53
    v_sub_f32 v134, v134, v53
    v_sub_f32 v135, v135, v53
    v_sub_f32 v136, v136, v54
    v_sub_f32 v137, v137, v54
    v_sub_f32 v138, v138, v54
    v_sub_f32 v139, v139, v54
    v_sub_f32 v140, v140, v55
    v_sub_f32 v141, v141, v55
    v_sub_f32 v142, v142, v55
    v_sub_f32 v143, v143, v55
    v_sub_f32 v144, v144, v52
    v_sub_f32 v145, v145, v52
    v_sub_f32 v146, v146, v52
    v_sub_f32 v147, v147, v52
    v_sub_f32 v148, v148, v53
    v_sub_f32 v149, v149, v53
    v_sub_f32 v150, v150, v53
    v_sub_f32 v151, v151, v53
    v_sub_f32 v152, v152, v54
    v_sub_f32 v153, v153, v54
    v_sub_f32 v154, v154, v54
    v_sub_f32 v155, v155, v54
    v_sub_f32 v156, v156, v55
    v_sub_f32 v157, v157, v55
    v_sub_f32 v158, v158, v55
    v_sub_f32 v159, v159, v55
    v_sub_f32 v160, v160, v52
    v_sub_f32 v16, v16, v52
    v_sub_f32 v161, v161, v52
    v_sub_f32 v17, v17, v52
    v_sub_f32 v162, v162, v52
    v_sub_f32 v18, v18, v52
    v_sub_f32 v163, v163, v52
    v_sub_f32 v19, v19, v52
    v_sub_f32 v164, v164, v53
    v_sub_f32 v20, v20, v53
    v_sub_f32 v165, v165, v53
    v_sub_f32 v21, v21, v53
    v_sub_f32 v166, v166, v53
    v_sub_f32 v22, v22, v53
    v_sub_f32 v167, v167, v53
    v_sub_f32 v23, v23, v53
    v_sub_f32 v168, v168, v54
    v_sub_f32 v24, v24, v54
    v_sub_f32 v169, v169, v54
    v_sub_f32 v25, v25, v54
    v_sub_f32 v170, v170, v54
    v_sub_f32 v26, v26, v54
    v_sub_f32 v171, v171, v54
    v_sub_f32 v27, v27, v54
    v_sub_f32 v172, v172, v55
    v_sub_f32 v28, v28, v55
    v_sub_f32 v173, v173, v55
    v_sub_f32 v29, v29, v55
    v_sub_f32 v174, v174, v55
    v_sub_f32 v30, v30, v55
    v_sub_f32 v175, v175, v55
    v_sub_f32 v31, v31, v55
    v_sub_f32 v176, v176, v52
    v_sub_f32 v32, v32, v52
    v_sub_f32 v177, v177, v52
    v_sub_f32 v33, v33, v52
    v_sub_f32 v178, v178, v52
    v_sub_f32 v34, v34, v52
    v_sub_f32 v179, v179, v52
    v_sub_f32 v35, v35, v52
    v_sub_f32 v180, v180, v53
    v_sub_f32 v36, v36, v53
    v_sub_f32 v181, v181, v53
    v_sub_f32 v37, v37, v53
    v_sub_f32 v182, v182, v53
    v_sub_f32 v38, v38, v53
    v_sub_f32 v183, v183, v53
    v_sub_f32 v39, v39, v53
    v_sub_f32 v184, v184, v54
    v_sub_f32 v40, v40, v54
    v_sub_f32 v185, v185, v54
    v_sub_f32 v41, v41, v54
    v_sub_f32 v186, v186, v54
    v_sub_f32 v42, v42, v54
    v_sub_f32 v187, v187, v54
    v_sub_f32 v43, v43, v54
    v_sub_f32 v188, v188, v55
    v_sub_f32 v44, v44, v55
    v_sub_f32 v189, v189, v55
    v_sub_f32 v45, v45, v55
    v_sub_f32 v190, v190, v55
    v_sub_f32 v46, v46, v55
    v_sub_f32 v191, v191, v55
    v_sub_f32 v47, v47, v55
    v_sub_f32 v8, v8, v52
    v_exp_f32 v52, -v52
    v_sub_f32 v9, v9, v53
    v_exp_f32 v53, -v53
    v_sub_f32 v10, v10, v54
    v_exp_f32 v54, -v54
    v_sub_f32 v11, v11, v55
    v_exp_f32 v55, -v55
    s_nop 0
    v_mul_f32 v12, v12, v52
    v_mul_f32 v48, v48, v53
    v_mul_f32 v248, v248, v54
    v_mul_f32 v252, v252, v55
    v_accvgpr_read_b32 v224, a0
    v_accvgpr_read_b32 v225, a1
    v_accvgpr_read_b32 v226, a2
    v_accvgpr_read_b32 v227, a3
    v_mul_f32 v224, v224, v52
    v_mul_f32 v225, v225, v52
    v_mul_f32 v226, v226, v52
    v_mul_f32 v227, v227, v52
    v_accvgpr_write_b32 a0, v224
    v_accvgpr_write_b32 a1, v225
    v_accvgpr_write_b32 a2, v226
    v_accvgpr_write_b32 a3, v227
    v_accvgpr_read_b32 v224, a4
    v_accvgpr_read_b32 v225, a5
    v_accvgpr_read_b32 v226, a6
    v_accvgpr_read_b32 v227, a7
    v_mul_f32 v224, v224, v53
    v_mul_f32 v225, v225, v53
    v_mul_f32 v226, v226, v53
    v_mul_f32 v227, v227, v53
    v_accvgpr_write_b32 a4, v224
    v_accvgpr_write_b32 a5, v225
    v_accvgpr_write_b32 a6, v226
    v_accvgpr_write_b32 a7, v227
    v_accvgpr_read_b32 v224, a8
    v_accvgpr_read_b32 v225, a9
    v_accvgpr_read_b32 v226, a10
    v_accvgpr_read_b32 v227, a11
    v_mul_f32 v224, v224, v54
    v_mul_f32 v225, v225, v54
    v_mul_f32 v226, v226, v54
    v_mul_f32 v227, v227, v54
    v_accvgpr_write_b32 a8, v224
    v_accvgpr_write_b32 a9, v225
    v_accvgpr_write_b32 a10, v226
    v_accvgpr_write_b32 a11, v227
    v_accvgpr_read_b32 v224, a12
    v_accvgpr_read_b32 v225, a13
    v_accvgpr_read_b32 v226, a14
    v_accvgpr_read_b32 v227, a15
    v_mul_f32 v224, v224, v55
    v_mul_f32 v225, v225, v55
    v_mul_f32 v226, v226, v55
    v_mul_f32 v227, v227, v55
    v_accvgpr_write_b32 a12, v224
    v_accvgpr_write_b32 a13, v225
    v_accvgpr_write_b32 a14, v226
    v_accvgpr_write_b32 a15, v227
    v_accvgpr_read_b32 v224, a16
    v_accvgpr_read_b32 v225, a17
    v_accvgpr_read_b32 v226, a18
    v_accvgpr_read_b32 v227, a19
    v_mul_f32 v224, v224, v52
    v_mul_f32 v225, v225, v52
    v_mul_f32 v226, v226, v52
    v_mul_f32 v227, v227, v52
    v_accvgpr_write_b32 a16, v224
    v_accvgpr_write_b32 a17, v225
    v_accvgpr_write_b32 a18, v226
    v_accvgpr_write_b32 a19, v227
    v_accvgpr_read_b32 v224, a20
    v_accvgpr_read_b32 v225, a21
    v_accvgpr_read_b32 v226, a22
    v_accvgpr_read_b32 v227, a23
    v_mul_f32 v224, v224, v53
    v_mul_f32 v225, v225, v53
    v_mul_f32 v226, v226, v53
    v_mul_f32 v227, v227, v53
    v_accvgpr_write_b32 a20, v224
    v_accvgpr_write_b32 a21, v225
    v_accvgpr_write_b32 a22, v226
    v_accvgpr_write_b32 a23, v227
    v_accvgpr_read_b32 v224, a24
    v_accvgpr_read_b32 v225, a25
    v_accvgpr_read_b32 v226, a26
    v_accvgpr_read_b32 v227, a27
    v_mul_f32 v224, v224, v54
    v_mul_f32 v225, v225, v54
    v_mul_f32 v226, v226, v54
    v_mul_f32 v227, v227, v54
    v_accvgpr_write_b32 a24, v224
    v_accvgpr_write_b32 a25, v225
    v_accvgpr_write_b32 a26, v226
    v_accvgpr_write_b32 a27, v227
    v_accvgpr_read_b32 v224, a28
    v_accvgpr_read_b32 v225, a29
    v_accvgpr_read_b32 v226, a30
    v_accvgpr_read_b32 v227, a31
    v_mul_f32 v224, v224, v55
    v_mul_f32 v225, v225, v55
    v_mul_f32 v226, v226, v55
    v_mul_f32 v227, v227, v55
    v_accvgpr_write_b32 a28, v224
    v_accvgpr_write_b32 a29, v225
    v_accvgpr_write_b32 a30, v226
    v_accvgpr_write_b32 a31, v227
    v_accvgpr_read_b32 v224, a32
    v_accvgpr_read_b32 v225, a33
    v_accvgpr_read_b32 v226, a34
    v_accvgpr_read_b32 v227, a35
    v_mul_f32 v224, v224, v52
    v_mul_f32 v225, v225, v52
    v_mul_f32 v226, v226, v52
    v_mul_f32 v227, v227, v52
    v_accvgpr_write_b32 a32, v224
    v_accvgpr_write_b32 a33, v225
    v_accvgpr_write_b32 a34, v226
    v_accvgpr_write_b32 a35, v227
    v_accvgpr_read_b32 v224, a36
    v_accvgpr_read_b32 v225, a37
    v_accvgpr_read_b32 v226, a38
    v_accvgpr_read_b32 v227, a39
    v_mul_f32 v224, v224, v53
    v_mul_f32 v225, v225, v53
    v_mul_f32 v226, v226, v53
    v_mul_f32 v227, v227, v53
    v_accvgpr_write_b32 a36, v224
    v_accvgpr_write_b32 a37, v225
    v_accvgpr_write_b32 a38, v226
    v_accvgpr_write_b32 a39, v227
    v_accvgpr_read_b32 v224, a40
    v_accvgpr_read_b32 v225, a41
    v_accvgpr_read_b32 v226, a42
    v_accvgpr_read_b32 v227, a43
    v_mul_f32 v224, v224, v54
    v_mul_f32 v225, v225, v54
    v_mul_f32 v226, v226, v54
    v_mul_f32 v227, v227, v54
    v_accvgpr_write_b32 a40, v224
    v_accvgpr_write_b32 a41, v225
    v_accvgpr_write_b32 a42, v226
    v_accvgpr_write_b32 a43, v227
    v_accvgpr_read_b32 v224, a44
    v_accvgpr_read_b32 v225, a45
    v_accvgpr_read_b32 v226, a46
    v_accvgpr_read_b32 v227, a47
    v_mul_f32 v224, v224, v55
    v_mul_f32 v225, v225, v55
    v_mul_f32 v226, v226, v55
    v_mul_f32 v227, v227, v55
    v_accvgpr_write_b32 a44, v224
    v_accvgpr_write_b32 a45, v225
    v_accvgpr_write_b32 a46, v226
    v_accvgpr_write_b32 a47, v227
    v_accvgpr_read_b32 v224, a48
    v_accvgpr_read_b32 v225, a49
    v_accvgpr_read_b32 v226, a50
    v_accvgpr_read_b32 v227, a51
    v_mul_f32 v224, v224, v52
    v_mul_f32 v225, v225, v52
    v_mul_f32 v226, v226, v52
    v_mul_f32 v227, v227, v52
    v_accvgpr_write_b32 a48, v224
    v_accvgpr_write_b32 a49, v225
    v_accvgpr_write_b32 a50, v226
    v_accvgpr_write_b32 a51, v227
    v_accvgpr_read_b32 v224, a52
    v_accvgpr_read_b32 v225, a53
    v_accvgpr_read_b32 v226, a54
    v_accvgpr_read_b32 v227, a55
    v_mul_f32 v224, v224, v53
    v_mul_f32 v225, v225, v53
    v_mul_f32 v226, v226, v53
    v_mul_f32 v227, v227, v53
    v_accvgpr_write_b32 a52, v224
    v_accvgpr_write_b32 a53, v225
    v_accvgpr_write_b32 a54, v226
    v_accvgpr_write_b32 a55, v227
    v_accvgpr_read_b32 v224, a56
    v_accvgpr_read_b32 v225, a57
    v_accvgpr_read_b32 v226, a58
    v_accvgpr_read_b32 v227, a59
    v_mul_f32 v224, v224, v54
    v_mul_f32 v225, v225, v54
    v_mul_f32 v226, v226, v54
    v_mul_f32 v227, v227, v54
    v_accvgpr_write_b32 a56, v224
    v_accvgpr_write_b32 a57, v225
    v_accvgpr_write_b32 a58, v226
    v_accvgpr_write_b32 a59, v227
    v_accvgpr_read_b32 v224, a60
    v_accvgpr_read_b32 v225, a61
    v_accvgpr_read_b32 v226, a62
    v_accvgpr_read_b32 v227, a63
    v_mul_f32 v224, v224, v55
    v_mul_f32 v225, v225, v55
    v_mul_f32 v226, v226, v55
    v_mul_f32 v227, v227, v55
    v_accvgpr_write_b32 a60, v224
    v_accvgpr_write_b32 a61, v225
    v_accvgpr_write_b32 a62, v226
    v_accvgpr_write_b32 a63, v227
    v_accvgpr_read_b32 v224, a64
    v_accvgpr_read_b32 v225, a65
    v_accvgpr_read_b32 v226, a66
    v_accvgpr_read_b32 v227, a67
    v_mul_f32 v224, v224, v52
    v_mul_f32 v225, v225, v52
    v_mul_f32 v226, v226, v52
    v_mul_f32 v227, v227, v52
    v_accvgpr_write_b32 a64, v224
    v_accvgpr_write_b32 a65, v225
    v_accvgpr_write_b32 a66, v226
    v_accvgpr_write_b32 a67, v227
    v_accvgpr_read_b32 v224, a68
    v_accvgpr_read_b32 v225, a69
    v_accvgpr_read_b32 v226, a70
    v_accvgpr_read_b32 v227, a71
    v_mul_f32 v224, v224, v53
    v_mul_f32 v225, v225, v53
    v_mul_f32 v226, v226, v53
    v_mul_f32 v227, v227, v53
    v_accvgpr_write_b32 a68, v224
    v_accvgpr_write_b32 a69, v225
    v_accvgpr_write_b32 a70, v226
    v_accvgpr_write_b32 a71, v227
    v_accvgpr_read_b32 v224, a72
    v_accvgpr_read_b32 v225, a73
    v_accvgpr_read_b32 v226, a74
    v_accvgpr_read_b32 v227, a75
    v_mul_f32 v224, v224, v54
    v_mul_f32 v225, v225, v54
    v_mul_f32 v226, v226, v54
    v_mul_f32 v227, v227, v54
    v_accvgpr_write_b32 a72, v224
    v_accvgpr_write_b32 a73, v225
    v_accvgpr_write_b32 a74, v226
    v_accvgpr_write_b32 a75, v227
    v_accvgpr_read_b32 v224, a76
    v_accvgpr_read_b32 v225, a77
    v_accvgpr_read_b32 v226, a78
    v_accvgpr_read_b32 v227, a79
    v_mul_f32 v224, v224, v55
    v_mul_f32 v225, v225, v55
    v_mul_f32 v226, v226, v55
    v_mul_f32 v227, v227, v55
    v_accvgpr_write_b32 a76, v224
    v_accvgpr_write_b32 a77, v225
    v_accvgpr_write_b32 a78, v226
    v_accvgpr_write_b32 a79, v227
    v_accvgpr_read_b32 v224, a80
    v_accvgpr_read_b32 v225, a81
    v_accvgpr_read_b32 v226, a82
    v_accvgpr_read_b32 v227, a83
    v_mul_f32 v224, v224, v52
    v_mul_f32 v225, v225, v52
    v_mul_f32 v226, v226, v52
    v_mul_f32 v227, v227, v52
    v_accvgpr_write_b32 a80, v224
    v_accvgpr_write_b32 a81, v225
    v_accvgpr_write_b32 a82, v226
    v_accvgpr_write_b32 a83, v227
    v_accvgpr_read_b32 v224, a84
    v_accvgpr_read_b32 v225, a85
    v_accvgpr_read_b32 v226, a86
    v_accvgpr_read_b32 v227, a87
    v_mul_f32 v224, v224, v53
    v_mul_f32 v225, v225, v53
    v_mul_f32 v226, v226, v53
    v_mul_f32 v227, v227, v53
    v_accvgpr_write_b32 a84, v224
    v_accvgpr_write_b32 a85, v225
    v_accvgpr_write_b32 a86, v226
    v_accvgpr_write_b32 a87, v227
    v_accvgpr_read_b32 v224, a88
    v_accvgpr_read_b32 v225, a89
    v_accvgpr_read_b32 v226, a90
    v_accvgpr_read_b32 v227, a91
    v_mul_f32 v224, v224, v54
    v_mul_f32 v225, v225, v54
    v_mul_f32 v226, v226, v54
    v_mul_f32 v227, v227, v54
    v_accvgpr_write_b32 a88, v224
    v_accvgpr_write_b32 a89, v225
    v_accvgpr_write_b32 a90, v226
    v_accvgpr_write_b32 a91, v227
    v_accvgpr_read_b32 v224, a92
    v_accvgpr_read_b32 v225, a93
    v_accvgpr_read_b32 v226, a94
    v_accvgpr_read_b32 v227, a95
    v_mul_f32 v224, v224, v55
    v_mul_f32 v225, v225, v55
    v_mul_f32 v226, v226, v55
    v_mul_f32 v227, v227, v55
    v_accvgpr_write_b32 a92, v224
    v_accvgpr_write_b32 a93, v225
    v_accvgpr_write_b32 a94, v226
    v_accvgpr_write_b32 a95, v227
    v_accvgpr_read_b32 v224, a96
    v_accvgpr_read_b32 v225, a97
    v_accvgpr_read_b32 v226, a98
    v_accvgpr_read_b32 v227, a99
    v_mul_f32 v224, v224, v52
    v_mul_f32 v225, v225, v52
    v_mul_f32 v226, v226, v52
    v_mul_f32 v227, v227, v52
    v_accvgpr_write_b32 a96, v224
    v_accvgpr_write_b32 a97, v225
    v_accvgpr_write_b32 a98, v226
    v_accvgpr_write_b32 a99, v227
    v_accvgpr_read_b32 v224, a100
    v_accvgpr_read_b32 v225, a101
    v_accvgpr_read_b32 v226, a102
    v_accvgpr_read_b32 v227, a103
    v_mul_f32 v224, v224, v53
    v_mul_f32 v225, v225, v53
    v_mul_f32 v226, v226, v53
    v_mul_f32 v227, v227, v53
    v_accvgpr_write_b32 a100, v224
    v_accvgpr_write_b32 a101, v225
    v_accvgpr_write_b32 a102, v226
    v_accvgpr_write_b32 a103, v227
    v_accvgpr_read_b32 v224, a104
    v_accvgpr_read_b32 v225, a105
    v_accvgpr_read_b32 v226, a106
    v_accvgpr_read_b32 v227, a107
    v_mul_f32 v224, v224, v54
    v_mul_f32 v225, v225, v54
    v_mul_f32 v226, v226, v54
    v_mul_f32 v227, v227, v54
    v_accvgpr_write_b32 a104, v224
    v_accvgpr_write_b32 a105, v225
    v_accvgpr_write_b32 a106, v226
    v_accvgpr_write_b32 a107, v227
    v_accvgpr_read_b32 v224, a108
    v_accvgpr_read_b32 v225, a109
    v_accvgpr_read_b32 v226, a110
    v_accvgpr_read_b32 v227, a111
    v_mul_f32 v224, v224, v55
    v_mul_f32 v225, v225, v55
    v_mul_f32 v226, v226, v55
    v_mul_f32 v227, v227, v55
    v_accvgpr_write_b32 a108, v224
    v_accvgpr_write_b32 a109, v225
    v_accvgpr_write_b32 a110, v226
    v_accvgpr_write_b32 a111, v227
    v_accvgpr_read_b32 v224, a112
    v_accvgpr_read_b32 v225, a113
    v_accvgpr_read_b32 v226, a114
    v_accvgpr_read_b32 v227, a115
    v_mul_f32 v224, v224, v52
    v_mul_f32 v225, v225, v52
    v_mul_f32 v226, v226, v52
    v_mul_f32 v227, v227, v52
    v_accvgpr_write_b32 a112, v224
    v_accvgpr_write_b32 a113, v225
    v_accvgpr_write_b32 a114, v226
    v_accvgpr_write_b32 a115, v227
    v_accvgpr_read_b32 v224, a116
    v_accvgpr_read_b32 v225, a117
    v_accvgpr_read_b32 v226, a118
    v_accvgpr_read_b32 v227, a119
    v_mul_f32 v224, v224, v53
    v_mul_f32 v225, v225, v53
    v_mul_f32 v226, v226, v53
    v_mul_f32 v227, v227, v53
    v_accvgpr_write_b32 a116, v224
    v_accvgpr_write_b32 a117, v225
    v_accvgpr_write_b32 a118, v226
    v_accvgpr_write_b32 a119, v227
    v_accvgpr_read_b32 v224, a120
    v_accvgpr_read_b32 v225, a121
    v_accvgpr_read_b32 v226, a122
    v_accvgpr_read_b32 v227, a123
    v_mul_f32 v224, v224, v54
    v_mul_f32 v225, v225, v54
    v_mul_f32 v226, v226, v54
    v_mul_f32 v227, v227, v54
    v_accvgpr_write_b32 a120, v224
    v_accvgpr_write_b32 a121, v225
    v_accvgpr_write_b32 a122, v226
    v_accvgpr_write_b32 a123, v227
    v_accvgpr_read_b32 v224, a124
    v_accvgpr_read_b32 v225, a125
    v_accvgpr_read_b32 v226, a126
    v_accvgpr_read_b32 v227, a127
    v_mul_f32 v224, v224, v55
    v_mul_f32 v225, v225, v55
    v_mul_f32 v226, v226, v55
    v_mul_f32 v227, v227, v55
    v_accvgpr_write_b32 a124, v224
    v_accvgpr_write_b32 a125, v225
    v_accvgpr_write_b32 a126, v226
    v_accvgpr_write_b32 a127, v227
    v_exp_f32 v232, v128
    v_exp_f32 v233, v129
    v_exp_f32 v234, v130
    v_exp_f32 v235, v131
    s_nop 0
    v_cvt_pk_bf16_f32 v192, v232, v233
    v_cvt_pk_bf16_f32 v193, v234, v235
    v_exp_f32 v232, v144
    v_exp_f32 v233, v145
    v_exp_f32 v234, v146
    v_exp_f32 v235, v147
    s_nop 0
    v_cvt_pk_bf16_f32 v194, v232, v233
    v_cvt_pk_bf16_f32 v195, v234, v235
    v_exp_f32 v232, v132
    v_exp_f32 v233, v133
    v_exp_f32 v234, v134
    v_exp_f32 v235, v135
    s_nop 0
    v_cvt_pk_bf16_f32 v196, v232, v233
    v_cvt_pk_bf16_f32 v197, v234, v235
    v_exp_f32 v232, v148
    v_exp_f32 v233, v149
    v_exp_f32 v234, v150
    v_exp_f32 v235, v151
    s_nop 0
    v_cvt_pk_bf16_f32 v198, v232, v233
    v_cvt_pk_bf16_f32 v199, v234, v235
    v_exp_f32 v232, v136
    v_exp_f32 v233, v137
    v_exp_f32 v234, v138
    v_exp_f32 v235, v139
    s_nop 0
    v_cvt_pk_bf16_f32 v200, v232, v233
    v_cvt_pk_bf16_f32 v201, v234, v235
    v_exp_f32 v232, v152
    v_exp_f32 v233, v153
    v_exp_f32 v234, v154
    v_exp_f32 v235, v155
    s_nop 0
    v_cvt_pk_bf16_f32 v202, v232, v233
    v_cvt_pk_bf16_f32 v203, v234, v235
    v_exp_f32 v232, v140
    v_exp_f32 v233, v141
    v_exp_f32 v234, v142
    v_exp_f32 v235, v143
    s_nop 0
    v_cvt_pk_bf16_f32 v204, v232, v233
    v_cvt_pk_bf16_f32 v205, v234, v235
    v_exp_f32 v232, v156
    v_exp_f32 v233, v157
    v_exp_f32 v234, v158
    v_exp_f32 v235, v159
    s_nop 0
    v_cvt_pk_bf16_f32 v206, v232, v233
    v_cvt_pk_bf16_f32 v207, v234, v235
    s_nop 3
    s_setpc_b64 s[40:41]
k2_rare_153:
    s_nop 7
    v_max_f32 v52, v160, v161
    v_max3_f32 v52, v52, v162, v163
    v_max3_f32 v52, v52, v176, v177
    v_max3_f32 v52, v52, v178, v179
    v_max_f32 v53, v164, v165
    v_max3_f32 v53, v53, v166, v167
    v_max3_f32 v53, v53, v180, v181
    v_max3_f32 v53, v53, v182, v183
    v_max_f32 v54, v168, v169
    v_max3_f32 v54, v54, v170, v171
    v_max3_f32 v54, v54, v184, v185
    v_max3_f32 v54, v54, v186, v187
    v_max_f32 v55, v172, v173
    v_max3_f32 v55, v55, v174, v175
    v_max3_f32 v55, v55, v188, v189
    v_max3_f32 v55, v55, v190, v191
    v_mov_b32 v224, v52
    v_mov_b32 v225, v53
    v_mov_b32 v226, v54
    v_mov_b32 v227, v55
    s_nop 1
    v_permlane16_swap_b32 v52, v224
    v_permlane16_swap_b32 v53, v225
    v_permlane16_swap_b32 v54, v226
    v_permlane16_swap_b32 v55, v227
    s_nop 1
    v_max_f32 v52, v52, v224
    v_max_f32 v53, v53, v225
    v_max_f32 v54, v54, v226
    v_max_f32 v55, v55, v227
    v_mov_b32 v224, v52
    v_mov_b32 v225, v53
    v_mov_b32 v226, v54
    v_mov_b32 v227, v55
    s_nop 1
    v_permlane32_swap_b32 v52, v224
    v_permlane32_swap_b32 v53, v225
    v_permlane32_swap_b32 v54, v226
    v_permlane32_swap_b32 v55, v227
    s_nop 1
    v_max_f32 v52, v52, v224
    v_max_f32 v53, v53, v225
    v_max_f32 v54, v54, v226
    v_max_f32 v55, v55, v227
    v_add_f32 v52, 0x41400000, v52
    v_max_f32 v52, 0, v52
    v_add_f32 v53, 0x41400000, v53
    v_max_f32 v53, 0, v53
    v_add_f32 v54, 0x41400000, v54
    v_max_f32 v54, 0, v54
    v_add_f32 v55, 0x41400000, v55
    v_max_f32 v55, 0, v55
    v_sub_f32 v160, v160, v52
    v_sub_f32 v161, v161, v52
    v_sub_f32 v162, v162, v52
    v_sub_f32 v163, v163, v52
    v_sub_f32 v164, v164, v53
    v_sub_f32 v165, v165, v53
    v_sub_f32 v166, v166, v53
    v_sub_f32 v167, v167, v53
    v_sub_f32 v168, v168, v54
    v_sub_f32 v169, v169, v54
    v_sub_f32 v170, v170, v54
    v_sub_f32 v171, v171, v54
    v_sub_f32 v172, v172, v55
    v_sub_f32 v173, v173, v55
    v_sub_f32 v174, v174, v55
    v_sub_f32 v175, v175, v55
    v_sub_f32 v176, v176, v52
    v_sub_f32 v177, v177, v52
    v_sub_f32 v178, v178, v52
    v_sub_f32 v179, v179, v52
    v_sub_f32 v180, v180, v53
    v_sub_f32 v181, v181, v53
    v_sub_f32 v182, v182, v53
    v_sub_f32 v183, v183, v53
    v_sub_f32 v184, v184, v54
    v_sub_f32 v185, v185, v54
    v_sub_f32 v186, v186, v54
    v_sub_f32 v187, v187, v54
    v_sub_f32 v188, v188, v55
    v_sub_f32 v189, v189, v55
    v_sub_f32 v190, v190, v55
    v_sub_f32 v191, v191, v55
    v_sub_f32 v128, v128, v52
    v_sub_f32 v16, v16, v52
    v_sub_f32 v129, v129, v52
    v_sub_f32 v17, v17, v52
    v_sub_f32 v130, v130, v52
    v_sub_f32 v18, v18, v52
    v_sub_f32 v131, v131, v52
    v_sub_f32 v19, v19, v52
    v_sub_f32 v132, v132, v53
    v_sub_f32 v20, v20, v53
    v_sub_f32 v133, v133, v53
    v_sub_f32 v21, v21, v53
    v_sub_f32 v134, v134, v53
    v_sub_f32 v22, v22, v53
    v_sub_f32 v135, v135, v53
    v_sub_f32 v23, v23, v53
    v_sub_f32 v136, v136, v54
    v_sub_f32 v24, v24, v54
    v_sub_f32 v137, v137, v54
    v_sub_f32 v25, v25, v54
    v_sub_f32 v138, v138, v54
    v_sub_f32 v26, v26, v54
    v_sub_f32 v139, v139, v54
    v_sub_f32 v27, v27, v54
    v_sub_f32 v140, v140, v55
    v_sub_f32 v28, v28, v55
    v_sub_f32 v141, v141, v55
    v_sub_f32 v29, v29, v55
    v_sub_f32 v142, v142, v55
    v_sub_f32 v30, v30, v55
    v_sub_f32 v143, v143, v55
    v_sub_f32 v31, v31, v55
    v_sub_f32 v144, v144, v52
    v_sub_f32 v32, v32, v52
    v_sub_f32 v145, v145, v52
    v_sub_f32 v33, v33, v52
    v_sub_f32 v146, v146, v52
    v_sub_f32 v34, v34, v52
    v_sub_f32 v147, v147, v52
    v_sub_f32 v35, v35, v52
    v_sub_f32 v148, v148, v53
    v_sub_f32 v36, v36, v53
    v_sub_f32 v149, v149, v53
    v_sub_f32 v37, v37, v53
    v_sub_f32 v150, v150, v53
    v_sub_f32 v38, v38, v53
    v_sub_f32 v151, v151, v53
    v_sub_f32 v39, v39, v53
    v_sub_f32 v152, v152, v54
    v_sub_f32 v40, v40, v54
    v_sub_f32 v153, v153, v54
    v_sub_f32 v41, v41, v54
    v_sub_f32 v154, v154, v54
    v_sub_f32 v42, v42, v54
    v_sub_f32 v155, v155, v54
    v_sub_f32 v43, v43, v54
    v_sub_f32 v156, v156, v55
    v_sub_f32 v44, v44, v55
    v_sub_f32 v157, v157, v55
    v_sub_f32 v45, v45, v55
    v_sub_f32 v158, v158, v55
    v_sub_f32 v46, v46, v55
    v_sub_f32 v159, v159, v55
    v_sub_f32 v47, v47, v55
    v_sub_f32 v8, v8, v52
    v_exp_f32 v52, -v52
    v_sub_f32 v9, v9, v53
    v_exp_f32 v53, -v53
    v_sub_f32 v10, v10, v54
    v_exp_f32 v54, -v54
    v_sub_f32 v11, v11, v55
    v_exp_f32 v55, -v55
    s_nop 0
    v_mul_f32 v12, v12, v52
    v_mul_f32 v48, v48, v53
    v_mul_f32 v248, v248, v54
    v_mul_f32 v252, v252, v55
    v_accvgpr_read_b32 v224, a0
    v_accvgpr_read_b32 v225, a1
    v_accvgpr_read_b32 v226, a2
    v_accvgpr_read_b32 v227, a3
    v_mul_f32 v224, v224, v52
    v_mul_f32 v225, v225, v52
    v_mul_f32 v226, v226, v52
    v_mul_f32 v227, v227, v52
    v_accvgpr_write_b32 a0, v224
    v_accvgpr_write_b32 a1, v225
    v_accvgpr_write_b32 a2, v226
    v_accvgpr_write_b32 a3, v227
    v_accvgpr_read_b32 v224, a4
    v_accvgpr_read_b32 v225, a5
    v_accvgpr_read_b32 v226, a6
    v_accvgpr_read_b32 v227, a7
    v_mul_f32 v224, v224, v53
    v_mul_f32 v225, v225, v53
    v_mul_f32 v226, v226, v53
    v_mul_f32 v227, v227, v53
    v_accvgpr_write_b32 a4, v224
    v_accvgpr_write_b32 a5, v225
    v_accvgpr_write_b32 a6, v226
    v_accvgpr_write_b32 a7, v227
    v_accvgpr_read_b32 v224, a8
    v_accvgpr_read_b32 v225, a9
    v_accvgpr_read_b32 v226, a10
    v_accvgpr_read_b32 v227, a11
    v_mul_f32 v224, v224, v54
    v_mul_f32 v225, v225, v54
    v_mul_f32 v226, v226, v54
    v_mul_f32 v227, v227, v54
    v_accvgpr_write_b32 a8, v224
    v_accvgpr_write_b32 a9, v225
    v_accvgpr_write_b32 a10, v226
    v_accvgpr_write_b32 a11, v227
    v_accvgpr_read_b32 v224, a12
    v_accvgpr_read_b32 v225, a13
    v_accvgpr_read_b32 v226, a14
    v_accvgpr_read_b32 v227, a15
    v_mul_f32 v224, v224, v55
    v_mul_f32 v225, v225, v55
    v_mul_f32 v226, v226, v55
    v_mul_f32 v227, v227, v55
    v_accvgpr_write_b32 a12, v224
    v_accvgpr_write_b32 a13, v225
    v_accvgpr_write_b32 a14, v226
    v_accvgpr_write_b32 a15, v227
    v_accvgpr_read_b32 v224, a16
    v_accvgpr_read_b32 v225, a17
    v_accvgpr_read_b32 v226, a18
    v_accvgpr_read_b32 v227, a19
    v_mul_f32 v224, v224, v52
    v_mul_f32 v225, v225, v52
    v_mul_f32 v226, v226, v52
    v_mul_f32 v227, v227, v52
    v_accvgpr_write_b32 a16, v224
    v_accvgpr_write_b32 a17, v225
    v_accvgpr_write_b32 a18, v226
    v_accvgpr_write_b32 a19, v227
    v_accvgpr_read_b32 v224, a20
    v_accvgpr_read_b32 v225, a21
    v_accvgpr_read_b32 v226, a22
    v_accvgpr_read_b32 v227, a23
    v_mul_f32 v224, v224, v53
    v_mul_f32 v225, v225, v53
    v_mul_f32 v226, v226, v53
    v_mul_f32 v227, v227, v53
    v_accvgpr_write_b32 a20, v224
    v_accvgpr_write_b32 a21, v225
    v_accvgpr_write_b32 a22, v226
    v_accvgpr_write_b32 a23, v227
    v_accvgpr_read_b32 v224, a24
    v_accvgpr_read_b32 v225, a25
    v_accvgpr_read_b32 v226, a26
    v_accvgpr_read_b32 v227, a27
    v_mul_f32 v224, v224, v54
    v_mul_f32 v225, v225, v54
    v_mul_f32 v226, v226, v54
    v_mul_f32 v227, v227, v54
    v_accvgpr_write_b32 a24, v224
    v_accvgpr_write_b32 a25, v225
    v_accvgpr_write_b32 a26, v226
    v_accvgpr_write_b32 a27, v227
    v_accvgpr_read_b32 v224, a28
    v_accvgpr_read_b32 v225, a29
    v_accvgpr_read_b32 v226, a30
    v_accvgpr_read_b32 v227, a31
    v_mul_f32 v224, v224, v55
    v_mul_f32 v225, v225, v55
    v_mul_f32 v226, v226, v55
    v_mul_f32 v227, v227, v55
    v_accvgpr_write_b32 a28, v224
    v_accvgpr_write_b32 a29, v225
    v_accvgpr_write_b32 a30, v226
    v_accvgpr_write_b32 a31, v227
    v_accvgpr_read_b32 v224, a32
    v_accvgpr_read_b32 v225, a33
    v_accvgpr_read_b32 v226, a34
    v_accvgpr_read_b32 v227, a35
    v_mul_f32 v224, v224, v52
    v_mul_f32 v225, v225, v52
    v_mul_f32 v226, v226, v52
    v_mul_f32 v227, v227, v52
    v_accvgpr_write_b32 a32, v224
    v_accvgpr_write_b32 a33, v225
    v_accvgpr_write_b32 a34, v226
    v_accvgpr_write_b32 a35, v227
    v_accvgpr_read_b32 v224, a36
    v_accvgpr_read_b32 v225, a37
    v_accvgpr_read_b32 v226, a38
    v_accvgpr_read_b32 v227, a39
    v_mul_f32 v224, v224, v53
    v_mul_f32 v225, v225, v53
    v_mul_f32 v226, v226, v53
    v_mul_f32 v227, v227, v53
    v_accvgpr_write_b32 a36, v224
    v_accvgpr_write_b32 a37, v225
    v_accvgpr_write_b32 a38, v226
    v_accvgpr_write_b32 a39, v227
    v_accvgpr_read_b32 v224, a40
    v_accvgpr_read_b32 v225, a41
    v_accvgpr_read_b32 v226, a42
    v_accvgpr_read_b32 v227, a43
    v_mul_f32 v224, v224, v54
    v_mul_f32 v225, v225, v54
    v_mul_f32 v226, v226, v54
    v_mul_f32 v227, v227, v54
    v_accvgpr_write_b32 a40, v224
    v_accvgpr_write_b32 a41, v225
    v_accvgpr_write_b32 a42, v226
    v_accvgpr_write_b32 a43, v227
    v_accvgpr_read_b32 v224, a44
    v_accvgpr_read_b32 v225, a45
    v_accvgpr_read_b32 v226, a46
    v_accvgpr_read_b32 v227, a47
    v_mul_f32 v224, v224, v55
    v_mul_f32 v225, v225, v55
    v_mul_f32 v226, v226, v55
    v_mul_f32 v227, v227, v55
    v_accvgpr_write_b32 a44, v224
    v_accvgpr_write_b32 a45, v225
    v_accvgpr_write_b32 a46, v226
    v_accvgpr_write_b32 a47, v227
    v_accvgpr_read_b32 v224, a48
    v_accvgpr_read_b32 v225, a49
    v_accvgpr_read_b32 v226, a50
    v_accvgpr_read_b32 v227, a51
    v_mul_f32 v224, v224, v52
    v_mul_f32 v225, v225, v52
    v_mul_f32 v226, v226, v52
    v_mul_f32 v227, v227, v52
    v_accvgpr_write_b32 a48, v224
    v_accvgpr_write_b32 a49, v225
    v_accvgpr_write_b32 a50, v226
    v_accvgpr_write_b32 a51, v227
    v_accvgpr_read_b32 v224, a52
    v_accvgpr_read_b32 v225, a53
    v_accvgpr_read_b32 v226, a54
    v_accvgpr_read_b32 v227, a55
    v_mul_f32 v224, v224, v53
    v_mul_f32 v225, v225, v53
    v_mul_f32 v226, v226, v53
    v_mul_f32 v227, v227, v53
    v_accvgpr_write_b32 a52, v224
    v_accvgpr_write_b32 a53, v225
    v_accvgpr_write_b32 a54, v226
    v_accvgpr_write_b32 a55, v227
    v_accvgpr_read_b32 v224, a56
    v_accvgpr_read_b32 v225, a57
    v_accvgpr_read_b32 v226, a58
    v_accvgpr_read_b32 v227, a59
    v_mul_f32 v224, v224, v54
    v_mul_f32 v225, v225, v54
    v_mul_f32 v226, v226, v54
    v_mul_f32 v227, v227, v54
    v_accvgpr_write_b32 a56, v224
    v_accvgpr_write_b32 a57, v225
    v_accvgpr_write_b32 a58, v226
    v_accvgpr_write_b32 a59, v227
    v_accvgpr_read_b32 v224, a60
    v_accvgpr_read_b32 v225, a61
    v_accvgpr_read_b32 v226, a62
    v_accvgpr_read_b32 v227, a63
    v_mul_f32 v224, v224, v55
    v_mul_f32 v225, v225, v55
    v_mul_f32 v226, v226, v55
    v_mul_f32 v227, v227, v55
    v_accvgpr_write_b32 a60, v224
    v_accvgpr_write_b32 a61, v225
    v_accvgpr_write_b32 a62, v226
    v_accvgpr_write_b32 a63, v227
    v_accvgpr_read_b32 v224, a64
    v_accvgpr_read_b32 v225, a65
    v_accvgpr_read_b32 v226, a66
    v_accvgpr_read_b32 v227, a67
    v_mul_f32 v224, v224, v52
    v_mul_f32 v225, v225, v52
    v_mul_f32 v226, v226, v52
    v_mul_f32 v227, v227, v52
    v_accvgpr_write_b32 a64, v224
    v_accvgpr_write_b32 a65, v225
    v_accvgpr_write_b32 a66, v226
    v_accvgpr_write_b32 a67, v227
    v_accvgpr_read_b32 v224, a68
    v_accvgpr_read_b32 v225, a69
    v_accvgpr_read_b32 v226, a70
    v_accvgpr_read_b32 v227, a71
    v_mul_f32 v224, v224, v53
    v_mul_f32 v225, v225, v53
    v_mul_f32 v226, v226, v53
    v_mul_f32 v227, v227, v53
    v_accvgpr_write_b32 a68, v224
    v_accvgpr_write_b32 a69, v225
    v_accvgpr_write_b32 a70, v226
    v_accvgpr_write_b32 a71, v227
    v_accvgpr_read_b32 v224, a72
    v_accvgpr_read_b32 v225, a73
    v_accvgpr_read_b32 v226, a74
    v_accvgpr_read_b32 v227, a75
    v_mul_f32 v224, v224, v54
    v_mul_f32 v225, v225, v54
    v_mul_f32 v226, v226, v54
    v_mul_f32 v227, v227, v54
    v_accvgpr_write_b32 a72, v224
    v_accvgpr_write_b32 a73, v225
    v_accvgpr_write_b32 a74, v226
    v_accvgpr_write_b32 a75, v227
    v_accvgpr_read_b32 v224, a76
    v_accvgpr_read_b32 v225, a77
    v_accvgpr_read_b32 v226, a78
    v_accvgpr_read_b32 v227, a79
    v_mul_f32 v224, v224, v55
    v_mul_f32 v225, v225, v55
    v_mul_f32 v226, v226, v55
    v_mul_f32 v227, v227, v55
    v_accvgpr_write_b32 a76, v224
    v_accvgpr_write_b32 a77, v225
    v_accvgpr_write_b32 a78, v226
    v_accvgpr_write_b32 a79, v227
    v_accvgpr_read_b32 v224, a80
    v_accvgpr_read_b32 v225, a81
    v_accvgpr_read_b32 v226, a82
    v_accvgpr_read_b32 v227, a83
    v_mul_f32 v224, v224, v52
    v_mul_f32 v225, v225, v52
    v_mul_f32 v226, v226, v52
    v_mul_f32 v227, v227, v52
    v_accvgpr_write_b32 a80, v224
    v_accvgpr_write_b32 a81, v225
    v_accvgpr_write_b32 a82, v226
    v_accvgpr_write_b32 a83, v227
    v_accvgpr_read_b32 v224, a84
    v_accvgpr_read_b32 v225, a85
    v_accvgpr_read_b32 v226, a86
    v_accvgpr_read_b32 v227, a87
    v_mul_f32 v224, v224, v53
    v_mul_f32 v225, v225, v53
    v_mul_f32 v226, v226, v53
    v_mul_f32 v227, v227, v53
    v_accvgpr_write_b32 a84, v224
    v_accvgpr_write_b32 a85, v225
    v_accvgpr_write_b32 a86, v226
    v_accvgpr_write_b32 a87, v227
    v_accvgpr_read_b32 v224, a88
    v_accvgpr_read_b32 v225, a89
    v_accvgpr_read_b32 v226, a90
    v_accvgpr_read_b32 v227, a91
    v_mul_f32 v224, v224, v54
    v_mul_f32 v225, v225, v54
    v_mul_f32 v226, v226, v54
    v_mul_f32 v227, v227, v54
    v_accvgpr_write_b32 a88, v224
    v_accvgpr_write_b32 a89, v225
    v_accvgpr_write_b32 a90, v226
    v_accvgpr_write_b32 a91, v227
    v_accvgpr_read_b32 v224, a92
    v_accvgpr_read_b32 v225, a93
    v_accvgpr_read_b32 v226, a94
    v_accvgpr_read_b32 v227, a95
    v_mul_f32 v224, v224, v55
    v_mul_f32 v225, v225, v55
    v_mul_f32 v226, v226, v55
    v_mul_f32 v227, v227, v55
    v_accvgpr_write_b32 a92, v224
    v_accvgpr_write_b32 a93, v225
    v_accvgpr_write_b32 a94, v226
    v_accvgpr_write_b32 a95, v227
    v_accvgpr_read_b32 v224, a96
    v_accvgpr_read_b32 v225, a97
    v_accvgpr_read_b32 v226, a98
    v_accvgpr_read_b32 v227, a99
    v_mul_f32 v224, v224, v52
    v_mul_f32 v225, v225, v52
    v_mul_f32 v226, v226, v52
    v_mul_f32 v227, v227, v52
    v_accvgpr_write_b32 a96, v224
    v_accvgpr_write_b32 a97, v225
    v_accvgpr_write_b32 a98, v226
    v_accvgpr_write_b32 a99, v227
    v_accvgpr_read_b32 v224, a100
    v_accvgpr_read_b32 v225, a101
    v_accvgpr_read_b32 v226, a102
    v_accvgpr_read_b32 v227, a103
    v_mul_f32 v224, v224, v53
    v_mul_f32 v225, v225, v53
    v_mul_f32 v226, v226, v53
    v_mul_f32 v227, v227, v53
    v_accvgpr_write_b32 a100, v224
    v_accvgpr_write_b32 a101, v225
    v_accvgpr_write_b32 a102, v226
    v_accvgpr_write_b32 a103, v227
    v_accvgpr_read_b32 v224, a104
    v_accvgpr_read_b32 v225, a105
    v_accvgpr_read_b32 v226, a106
    v_accvgpr_read_b32 v227, a107
    v_mul_f32 v224, v224, v54
    v_mul_f32 v225, v225, v54
    v_mul_f32 v226, v226, v54
    v_mul_f32 v227, v227, v54
    v_accvgpr_write_b32 a104, v224
    v_accvgpr_write_b32 a105, v225
    v_accvgpr_write_b32 a106, v226
    v_accvgpr_write_b32 a107, v227
    v_accvgpr_read_b32 v224, a108
    v_accvgpr_read_b32 v225, a109
    v_accvgpr_read_b32 v226, a110
    v_accvgpr_read_b32 v227, a111
    v_mul_f32 v224, v224, v55
    v_mul_f32 v225, v225, v55
    v_mul_f32 v226, v226, v55
    v_mul_f32 v227, v227, v55
    v_accvgpr_write_b32 a108, v224
    v_accvgpr_write_b32 a109, v225
    v_accvgpr_write_b32 a110, v226
    v_accvgpr_write_b32 a111, v227
    v_accvgpr_read_b32 v224, a112
    v_accvgpr_read_b32 v225, a113
    v_accvgpr_read_b32 v226, a114
    v_accvgpr_read_b32 v227, a115
    v_mul_f32 v224, v224, v52
    v_mul_f32 v225, v225, v52
    v_mul_f32 v226, v226, v52
    v_mul_f32 v227, v227, v52
    v_accvgpr_write_b32 a112, v224
    v_accvgpr_write_b32 a113, v225
    v_accvgpr_write_b32 a114, v226
    v_accvgpr_write_b32 a115, v227
    v_accvgpr_read_b32 v224, a116
    v_accvgpr_read_b32 v225, a117
    v_accvgpr_read_b32 v226, a118
    v_accvgpr_read_b32 v227, a119
    v_mul_f32 v224, v224, v53
    v_mul_f32 v225, v225, v53
    v_mul_f32 v226, v226, v53
    v_mul_f32 v227, v227, v53
    v_accvgpr_write_b32 a116, v224
    v_accvgpr_write_b32 a117, v225
    v_accvgpr_write_b32 a118, v226
    v_accvgpr_write_b32 a119, v227
    v_accvgpr_read_b32 v224, a120
    v_accvgpr_read_b32 v225, a121
    v_accvgpr_read_b32 v226, a122
    v_accvgpr_read_b32 v227, a123
    v_mul_f32 v224, v224, v54
    v_mul_f32 v225, v225, v54
    v_mul_f32 v226, v226, v54
    v_mul_f32 v227, v227, v54
    v_accvgpr_write_b32 a120, v224
    v_accvgpr_write_b32 a121, v225
    v_accvgpr_write_b32 a122, v226
    v_accvgpr_write_b32 a123, v227
    v_accvgpr_read_b32 v224, a124
    v_accvgpr_read_b32 v225, a125
    v_accvgpr_read_b32 v226, a126
    v_accvgpr_read_b32 v227, a127
    v_mul_f32 v224, v224, v55
    v_mul_f32 v225, v225, v55
    v_mul_f32 v226, v226, v55
    v_mul_f32 v227, v227, v55
    v_accvgpr_write_b32 a124, v224
    v_accvgpr_write_b32 a125, v225
    v_accvgpr_write_b32 a126, v226
    v_accvgpr_write_b32 a127, v227
    v_exp_f32 v232, v160
    v_exp_f32 v233, v161
    v_exp_f32 v234, v162
    v_exp_f32 v235, v163
    s_nop 0
    v_cvt_pk_bf16_f32 v208, v232, v233
    v_cvt_pk_bf16_f32 v209, v234, v235
    v_exp_f32 v232, v176
    v_exp_f32 v233, v177
    v_exp_f32 v234, v178
    v_exp_f32 v235, v179
    s_nop 0
    v_cvt_pk_bf16_f32 v210, v232, v233
    v_cvt_pk_bf16_f32 v211, v234, v235
    v_exp_f32 v232, v164
    v_exp_f32 v233, v165
    v_exp_f32 v234, v166
    v_exp_f32 v235, v167
    s_nop 0
    v_cvt_pk_bf16_f32 v212, v232, v233
    v_cvt_pk_bf16_f32 v213, v234, v235
    v_exp_f32 v232, v180
    v_exp_f32 v233, v181
    v_exp_f32 v234, v182
    v_exp_f32 v235, v183
    s_nop 0
    v_cvt_pk_bf16_f32 v214, v232, v233
    v_cvt_pk_bf16_f32 v215, v234, v235
    v_exp_f32 v232, v168
    v_exp_f32 v233, v169
    v_exp_f32 v234, v170
    v_exp_f32 v235, v171
    s_nop 0
    v_cvt_pk_bf16_f32 v216, v232, v233
    v_cvt_pk_bf16_f32 v217, v234, v235
    v_exp_f32 v232, v184
    v_exp_f32 v233, v185
    v_exp_f32 v234, v186
    v_exp_f32 v235, v187
    s_nop 0
    v_cvt_pk_bf16_f32 v218, v232, v233
    v_cvt_pk_bf16_f32 v219, v234, v235
    v_exp_f32 v232, v172
    v_exp_f32 v233, v173
    v_exp_f32 v234, v174
    v_exp_f32 v235, v175
    s_nop 0
    v_cvt_pk_bf16_f32 v220, v232, v233
    v_cvt_pk_bf16_f32 v221, v234, v235
    v_exp_f32 v232, v188
    v_exp_f32 v233, v189
    v_exp_f32 v234, v190
    v_exp_f32 v235, v191
    s_nop 0
    v_cvt_pk_bf16_f32 v222, v232, v233
    v_cvt_pk_bf16_f32 v223, v234, v235
    s_nop 3
    s_setpc_b64 s[40:41]
k2_rare_158:
    s_nop 7
    v_max_f32 v53, v132, v133
    v_max3_f32 v53, v53, v134, v135
    v_max3_f32 v53, v53, v148, v149
    v_max3_f32 v53, v53, v150, v151
    v_max_f32 v54, v136, v137
    v_max3_f32 v54, v54, v138, v139
    v_max3_f32 v54, v54, v152, v153
    v_max3_f32 v54, v54, v154, v155
    v_max_f32 v55, v140, v141
    v_max3_f32 v55, v55, v142, v143
    v_max3_f32 v55, v55, v156, v157
    v_max3_f32 v55, v55, v158, v159
    v_mov_b32 v225, v53
    v_mov_b32 v226, v54
    v_mov_b32 v227, v55
    s_nop 1
    v_permlane16_swap_b32 v53, v225
    v_permlane16_swap_b32 v54, v226
    v_permlane16_swap_b32 v55, v227
    s_nop 1
    v_max_f32 v53, v53, v225
    v_max_f32 v54, v54, v226
    v_max_f32 v55, v55, v227
    v_mov_b32 v225, v53
    v_mov_b32 v226, v54
    v_mov_b32 v227, v55
    s_nop 1
    v_permlane32_swap_b32 v53, v225
    v_permlane32_swap_b32 v54, v226
    v_permlane32_swap_b32 v55, v227
    s_nop 1
    v_max_f32 v53, v53, v225
    v_max_f32 v54, v54, v226
    v_max_f32 v55, v55, v227
    v_add_f32 v53, 0x41400000, v53
    v_max_f32 v53, 0, v53
    v_add_f32 v54, 0x41400000, v54
    v_max_f32 v54, 0, v54
    v_add_f32 v55, 0x41400000, v55
    v_max_f32 v55, 0, v55
    v_sub_f32 v132, v132, v53
    v_sub_f32 v133, v133, v53
    v_sub_f32 v134, v134, v53
    v_sub_f32 v135, v135, v53
    v_sub_f32 v136, v136, v54
    v_sub_f32 v137, v137, v54
    v_sub_f32 v138, v138, v54
    v_sub_f32 v139, v139, v54
    v_sub_f32 v140, v140, v55
    v_sub_f32 v141, v141, v55
    v_sub_f32 v142, v142, v55
    v_sub_f32 v143, v143, v55
    v_sub_f32 v148, v148, v53
    v_sub_f32 v149, v149, v53
    v_sub_f32 v150, v150, v53
    v_sub_f32 v151, v151, v53
    v_sub_f32 v152, v152, v54
    v_sub_f32 v153, v153, v54
    v_sub_f32 v154, v154, v54
    v_sub_f32 v155, v155, v54
    v_sub_f32 v156, v156, v55
    v_sub_f32 v157, v157, v55
    v_sub_f32 v158, v158, v55
    v_sub_f32 v159, v159, v55
    v_sub_f32 v164, v164, v53
    v_sub_f32 v20, v20, v53
    v_sub_f32 v165, v165, v53
    v_sub_f32 v21, v21, v53
    v_sub_f32 v166, v166, v53
    v_sub_f32 v22, v22, v53
    v_sub_f32 v167, v167, v53
    v_sub_f32 v23, v23, v53
    v_sub_f32 v168, v168, v54
    v_sub_f32 v24, v24, v54
    v_sub_f32 v169, v169, v54
    v_sub_f32 v25, v25, v54
    v_sub_f32 v170, v170, v54
    v_sub_f32 v26, v26, v54
    v_sub_f32 v171, v171, v54
    v_sub_f32 v27, v27, v54
    v_sub_f32 v172, v172, v55
    v_sub_f32 v28, v28, v55
    v_sub_f32 v173, v173, v55
    v_sub_f32 v29, v29, v55
    v_sub_f32 v174, v174, v55
    v_sub_f32 v30, v30, v55
    v_sub_f32 v175, v175, v55
    v_sub_f32 v31, v31, v55
    v_sub_f32 v180, v180, v53
    v_sub_f32 v36, v36, v53
    v_sub_f32 v181, v181, v53
    v_sub_f32 v37, v37, v53
    v_sub_f32 v182, v182, v53
    v_sub_f32 v38, v38, v53
    v_sub_f32 v183, v183, v53
    v_sub_f32 v39, v39, v53
    v_sub_f32 v184, v184, v54
    v_sub_f32 v40, v40, v54
    v_sub_f32 v185, v185, v54
    v_sub_f32 v41, v41, v54
    v_sub_f32 v186, v186, v54
    v_sub_f32 v42, v42, v54
    v_sub_f32 v187, v187, v54
    v_sub_f32 v43, v43, v54
    v_sub_f32 v188, v188, v55
    v_sub_f32 v44, v44, v55
    v_sub_f32 v189, v189, v55
    v_sub_f32 v45, v45, v55
    v_sub_f32 v190, v190, v55
    v_sub_f32 v46, v46, v55
    v_sub_f32 v191, v191, v55
    v_sub_f32 v47, v47, v55
    v_sub_f32 v9, v9, v53
    v_exp_f32 v53, -v53
    v_sub_f32 v10, v10, v54
    v_exp_f32 v54, -v54
    v_sub_f32 v11, v11, v55
    v_exp_f32 v55, -v55
    s_nop 0
    v_mul_f32 v48, v48, v53
    v_mul_f32 v248, v248, v54
    v_mul_f32 v252, v252, v55
    v_accvgpr_read_b32 v224, a4
    v_accvgpr_read_b32 v225, a5
    v_accvgpr_read_b32 v226, a6
    v_accvgpr_read_b32 v227, a7
    v_mul_f32 v224, v224, v53
    v_mul_f32 v225, v225, v53
    v_mul_f32 v226, v226, v53
    v_mul_f32 v227, v227, v53
    v_accvgpr_write_b32 a4, v224
    v_accvgpr_write_b32 a5, v225
    v_accvgpr_write_b32 a6, v226
    v_accvgpr_write_b32 a7, v227
    v_accvgpr_read_b32 v224, a8
    v_accvgpr_read_b32 v225, a9
    v_accvgpr_read_b32 v226, a10
    v_accvgpr_read_b32 v227, a11
    v_mul_f32 v224, v224, v54
    v_mul_f32 v225, v225, v54
    v_mul_f32 v226, v226, v54
    v_mul_f32 v227, v227, v54
    v_accvgpr_write_b32 a8, v224
    v_accvgpr_write_b32 a9, v225
    v_accvgpr_write_b32 a10, v226
    v_accvgpr_write_b32 a11, v227
    v_accvgpr_read_b32 v224, a12
    v_accvgpr_read_b32 v225, a13
    v_accvgpr_read_b32 v226, a14
    v_accvgpr_read_b32 v227, a15
    v_mul_f32 v224, v224, v55
    v_mul_f32 v225, v225, v55
    v_mul_f32 v226, v226, v55
    v_mul_f32 v227, v227, v55
    v_accvgpr_write_b32 a12, v224
    v_accvgpr_write_b32 a13, v225
    v_accvgpr_write_b32 a14, v226
    v_accvgpr_write_b32 a15, v227
    v_accvgpr_read_b32 v224, a20
    v_accvgpr_read_b32 v225, a21
    v_accvgpr_read_b32 v226, a22
    v_accvgpr_read_b32 v227, a23
    v_mul_f32 v224, v224, v53
    v_mul_f32 v225, v225, v53
    v_mul_f32 v226, v226, v53
    v_mul_f32 v227, v227, v53
    v_accvgpr_write_b32 a20, v224
    v_accvgpr_write_b32 a21, v225
    v_accvgpr_write_b32 a22, v226
    v_accvgpr_write_b32 a23, v227
    v_accvgpr_read_b32 v224, a24
    v_accvgpr_read_b32 v225, a25
    v_accvgpr_read_b32 v226, a26
    v_accvgpr_read_b32 v227, a27
    v_mul_f32 v224, v224, v54
    v_mul_f32 v225, v225, v54
    v_mul_f32 v226, v226, v54
    v_mul_f32 v227, v227, v54
    v_accvgpr_write_b32 a24, v224
    v_accvgpr_write_b32 a25, v225
    v_accvgpr_write_b32 a26, v226
    v_accvgpr_write_b32 a27, v227
    v_accvgpr_read_b32 v224, a28
    v_accvgpr_read_b32 v225, a29
    v_accvgpr_read_b32 v226, a30
    v_accvgpr_read_b32 v227, a31
    v_mul_f32 v224, v224, v55
    v_mul_f32 v225, v225, v55
    v_mul_f32 v226, v226, v55
    v_mul_f32 v227, v227, v55
    v_accvgpr_write_b32 a28, v224
    v_accvgpr_write_b32 a29, v225
    v_accvgpr_write_b32 a30, v226
    v_accvgpr_write_b32 a31, v227
    v_accvgpr_read_b32 v224, a36
    v_accvgpr_read_b32 v225, a37
    v_accvgpr_read_b32 v226, a38
    v_accvgpr_read_b32 v227, a39
    v_mul_f32 v224, v224, v53
    v_mul_f32 v225, v225, v53
    v_mul_f32 v226, v226, v53
    v_mul_f32 v227, v227, v53
    v_accvgpr_write_b32 a36, v224
    v_accvgpr_write_b32 a37, v225
    v_accvgpr_write_b32 a38, v226
    v_accvgpr_write_b32 a39, v227
    v_accvgpr_read_b32 v224, a40
    v_accvgpr_read_b32 v225, a41
    v_accvgpr_read_b32 v226, a42
    v_accvgpr_read_b32 v227, a43
    v_mul_f32 v224, v224, v54
    v_mul_f32 v225, v225, v54
    v_mul_f32 v226, v226, v54
    v_mul_f32 v227, v227, v54
    v_accvgpr_write_b32 a40, v224
    v_accvgpr_write_b32 a41, v225
    v_accvgpr_write_b32 a42, v226
    v_accvgpr_write_b32 a43, v227
    v_accvgpr_read_b32 v224, a44
    v_accvgpr_read_b32 v225, a45
    v_accvgpr_read_b32 v226, a46
    v_accvgpr_read_b32 v227, a47
    v_mul_f32 v224, v224, v55
    v_mul_f32 v225, v225, v55
    v_mul_f32 v226, v226, v55
    v_mul_f32 v227, v227, v55
    v_accvgpr_write_b32 a44, v224
    v_accvgpr_write_b32 a45, v225
    v_accvgpr_write_b32 a46, v226
    v_accvgpr_write_b32 a47, v227
    v_accvgpr_read_b32 v224, a52
    v_accvgpr_read_b32 v225, a53
    v_accvgpr_read_b32 v226, a54
    v_accvgpr_read_b32 v227, a55
    v_mul_f32 v224, v224, v53
    v_mul_f32 v225, v225, v53
    v_mul_f32 v226, v226, v53
    v_mul_f32 v227, v227, v53
    v_accvgpr_write_b32 a52, v224
    v_accvgpr_write_b32 a53, v225
    v_accvgpr_write_b32 a54, v226
    v_accvgpr_write_b32 a55, v227
    v_accvgpr_read_b32 v224, a56
    v_accvgpr_read_b32 v225, a57
    v_accvgpr_read_b32 v226, a58
    v_accvgpr_read_b32 v227, a59
    v_mul_f32 v224, v224, v54
    v_mul_f32 v225, v225, v54
    v_mul_f32 v226, v226, v54
    v_mul_f32 v227, v227, v54
    v_accvgpr_write_b32 a56, v224
    v_accvgpr_write_b32 a57, v225
    v_accvgpr_write_b32 a58, v226
    v_accvgpr_write_b32 a59, v227
    v_accvgpr_read_b32 v224, a60
    v_accvgpr_read_b32 v225, a61
    v_accvgpr_read_b32 v226, a62
    v_accvgpr_read_b32 v227, a63
    v_mul_f32 v224, v224, v55
    v_mul_f32 v225, v225, v55
    v_mul_f32 v226, v226, v55
    v_mul_f32 v227, v227, v55
    v_accvgpr_write_b32 a60, v224
    v_accvgpr_write_b32 a61, v225
    v_accvgpr_write_b32 a62, v226
    v_accvgpr_write_b32 a63, v227
    v_accvgpr_read_b32 v224, a68
    v_accvgpr_read_b32 v225, a69
    v_accvgpr_read_b32 v226, a70
    v_accvgpr_read_b32 v227, a71
    v_mul_f32 v224, v224, v53
    v_mul_f32 v225, v225, v53
    v_mul_f32 v226, v226, v53
    v_mul_f32 v227, v227, v53
    v_accvgpr_write_b32 a68, v224
    v_accvgpr_write_b32 a69, v225
    v_accvgpr_write_b32 a70, v226
    v_accvgpr_write_b32 a71, v227
    v_accvgpr_read_b32 v224, a72
    v_accvgpr_read_b32 v225, a73
    v_accvgpr_read_b32 v226, a74
    v_accvgpr_read_b32 v227, a75
    v_mul_f32 v224, v224, v54
    v_mul_f32 v225, v225, v54
    v_mul_f32 v226, v226, v54
    v_mul_f32 v227, v227, v54
    v_accvgpr_write_b32 a72, v224
    v_accvgpr_write_b32 a73, v225
    v_accvgpr_write_b32 a74, v226
    v_accvgpr_write_b32 a75, v227
    v_accvgpr_read_b32 v224, a76
    v_accvgpr_read_b32 v225, a77
    v_accvgpr_read_b32 v226, a78
    v_accvgpr_read_b32 v227, a79
    v_mul_f32 v224, v224, v55
    v_mul_f32 v225, v225, v55
    v_mul_f32 v226, v226, v55
    v_mul_f32 v227, v227, v55
    v_accvgpr_write_b32 a76, v224
    v_accvgpr_write_b32 a77, v225
    v_accvgpr_write_b32 a78, v226
    v_accvgpr_write_b32 a79, v227
    v_accvgpr_read_b32 v224, a84
    v_accvgpr_read_b32 v225, a85
    v_accvgpr_read_b32 v226, a86
    v_accvgpr_read_b32 v227, a87
    v_mul_f32 v224, v224, v53
    v_mul_f32 v225, v225, v53
    v_mul_f32 v226, v226, v53
    v_mul_f32 v227, v227, v53
    v_accvgpr_write_b32 a84, v224
    v_accvgpr_write_b32 a85, v225
    v_accvgpr_write_b32 a86, v226
    v_accvgpr_write_b32 a87, v227
    v_accvgpr_read_b32 v224, a88
    v_accvgpr_read_b32 v225, a89
    v_accvgpr_read_b32 v226, a90
    v_accvgpr_read_b32 v227, a91
    v_mul_f32 v224, v224, v54
    v_mul_f32 v225, v225, v54
    v_mul_f32 v226, v226, v54
    v_mul_f32 v227, v227, v54
    v_accvgpr_write_b32 a88, v224
    v_accvgpr_write_b32 a89, v225
    v_accvgpr_write_b32 a90, v226
    v_accvgpr_write_b32 a91, v227
    v_accvgpr_read_b32 v224, a92
    v_accvgpr_read_b32 v225, a93
    v_accvgpr_read_b32 v226, a94
    v_accvgpr_read_b32 v227, a95
    v_mul_f32 v224, v224, v55
    v_mul_f32 v225, v225, v55
    v_mul_f32 v226, v226, v55
    v_mul_f32 v227, v227, v55
    v_accvgpr_write_b32 a92, v224
    v_accvgpr_write_b32 a93, v225
    v_accvgpr_write_b32 a94, v226
    v_accvgpr_write_b32 a95, v227
    v_accvgpr_read_b32 v224, a100
    v_accvgpr_read_b32 v225, a101
    v_accvgpr_read_b32 v226, a102
    v_accvgpr_read_b32 v227, a103
    v_mul_f32 v224, v224, v53
    v_mul_f32 v225, v225, v53
    v_mul_f32 v226, v226, v53
    v_mul_f32 v227, v227, v53
    v_accvgpr_write_b32 a100, v224
    v_accvgpr_write_b32 a101, v225
    v_accvgpr_write_b32 a102, v226
    v_accvgpr_write_b32 a103, v227
    v_accvgpr_read_b32 v224, a104
    v_accvgpr_read_b32 v225, a105
    v_accvgpr_read_b32 v226, a106
    v_accvgpr_read_b32 v227, a107
    v_mul_f32 v224, v224, v54
    v_mul_f32 v225, v225, v54
    v_mul_f32 v226, v226, v54
    v_mul_f32 v227, v227, v54
    v_accvgpr_write_b32 a104, v224
    v_accvgpr_write_b32 a105, v225
    v_accvgpr_write_b32 a106, v226
    v_accvgpr_write_b32 a107, v227
    v_accvgpr_read_b32 v224, a108
    v_accvgpr_read_b32 v225, a109
    v_accvgpr_read_b32 v226, a110
    v_accvgpr_read_b32 v227, a111
    v_mul_f32 v224, v224, v55
    v_mul_f32 v225, v225, v55
    v_mul_f32 v226, v226, v55
    v_mul_f32 v227, v227, v55
    v_accvgpr_write_b32 a108, v224
    v_accvgpr_write_b32 a109, v225
    v_accvgpr_write_b32 a110, v226
    v_accvgpr_write_b32 a111, v227
    v_accvgpr_read_b32 v224, a116
    v_accvgpr_read_b32 v225, a117
    v_accvgpr_read_b32 v226, a118
    v_accvgpr_read_b32 v227, a119
    v_mul_f32 v224, v224, v53
    v_mul_f32 v225, v225, v53
    v_mul_f32 v226, v226, v53
    v_mul_f32 v227, v227, v53
    v_accvgpr_write_b32 a116, v224
    v_accvgpr_write_b32 a117, v225
    v_accvgpr_write_b32 a118, v226
    v_accvgpr_write_b32 a119, v227
    v_accvgpr_read_b32 v224, a120
    v_accvgpr_read_b32 v225, a121
    v_accvgpr_read_b32 v226, a122
    v_accvgpr_read_b32 v227, a123
    v_mul_f32 v224, v224, v54
    v_mul_f32 v225, v225, v54
    v_mul_f32 v226, v226, v54
    v_mul_f32 v227, v227, v54
    v_accvgpr_write_b32 a120, v224
    v_accvgpr_write_b32 a121, v225
    v_accvgpr_write_b32 a122, v226
    v_accvgpr_write_b32 a123, v227
    v_accvgpr_read_b32 v224, a124
    v_accvgpr_read_b32 v225, a125
    v_accvgpr_read_b32 v226, a126
    v_accvgpr_read_b32 v227, a127
    v_mul_f32 v224, v224, v55
    v_mul_f32 v225, v225, v55
    v_mul_f32 v226, v226, v55
    v_mul_f32 v227, v227, v55
    v_accvgpr_write_b32 a124, v224
    v_accvgpr_write_b32 a125, v225
    v_accvgpr_write_b32 a126, v226
    v_accvgpr_write_b32 a127, v227
    v_exp_f32 v232, v132
    v_exp_f32 v233, v133
    v_exp_f32 v234, v134
    v_exp_f32 v235, v135
    s_nop 0
    v_cvt_pk_bf16_f32 v196, v232, v233
    v_cvt_pk_bf16_f32 v197, v234, v235
    v_exp_f32 v232, v148
    v_exp_f32 v233, v149
    v_exp_f32 v234, v150
    v_exp_f32 v235, v151
    s_nop 0
    v_cvt_pk_bf16_f32 v198, v232, v233
    v_cvt_pk_bf16_f32 v199, v234, v235
    v_exp_f32 v232, v136
    v_exp_f32 v233, v137
    v_exp_f32 v234, v138
    v_exp_f32 v235, v139
    s_nop 0
    v_cvt_pk_bf16_f32 v200, v232, v233
    v_cvt_pk_bf16_f32 v201, v234, v235
    v_exp_f32 v232, v152
    v_exp_f32 v233, v153
    v_exp_f32 v234, v154
    v_exp_f32 v235, v155
    s_nop 0
    v_cvt_pk_bf16_f32 v202, v232, v233
    v_cvt_pk_bf16_f32 v203, v234, v235
    v_exp_f32 v232, v140
    v_exp_f32 v233, v141
    v_exp_f32 v234, v142
    v_exp_f32 v235, v143
    s_nop 0
    v_cvt_pk_bf16_f32 v204, v232, v233
    v_cvt_pk_bf16_f32 v205, v234, v235
    v_exp_f32 v232, v156
    v_exp_f32 v233, v157
    v_exp_f32 v234, v158
    v_exp_f32 v235, v159
    s_nop 0
    v_cvt_pk_bf16_f32 v206, v232, v233
    v_cvt_pk_bf16_f32 v207, v234, v235
    s_nop 3
    s_setpc_b64 s[40:41]
k2_rare_159:
    s_nop 7
    v_max_f32 v53, v164, v165
    v_max3_f32 v53, v53, v166, v167
    v_max3_f32 v53, v53, v180, v181
    v_max3_f32 v53, v53, v182, v183
    v_max_f32 v54, v168, v169
    v_max3_f32 v54, v54, v170, v171
    v_max3_f32 v54, v54, v184, v185
    v_max3_f32 v54, v54, v186, v187
    v_max_f32 v55, v172, v173
    v_max3_f32 v55, v55, v174, v175
    v_max3_f32 v55, v55, v188, v189
    v_max3_f32 v55, v55, v190, v191
    v_mov_b32 v225, v53
    v_mov_b32 v226, v54
    v_mov_b32 v227, v55
    s_nop 1
    v_permlane16_swap_b32 v53, v225
    v_permlane16_swap_b32 v54, v226
    v_permlane16_swap_b32 v55, v227
    s_nop 1
    v_max_f32 v53, v53, v225
    v_max_f32 v54, v54, v226
    v_max_f32 v55, v55, v227
    v_mov_b32 v225, v53
    v_mov_b32 v226, v54
    v_mov_b32 v227, v55
    s_nop 1
    v_permlane32_swap_b32 v53, v225
    v_permlane32_swap_b32 v54, v226
    v_permlane32_swap_b32 v55, v227
    s_nop 1
    v_max_f32 v53, v53, v225
    v_max_f32 v54, v54, v226
    v_max_f32 v55, v55, v227
    v_add_f32 v53, 0x41400000, v53
    v_max_f32 v53, 0, v53
    v_add_f32 v54, 0x41400000, v54
    v_max_f32 v54, 0, v54
    v_add_f32 v55, 0x41400000, v55
    v_max_f32 v55, 0, v55
    v_sub_f32 v164, v164, v53
    v_sub_f32 v165, v165, v53
    v_sub_f32 v166, v166, v53
    v_sub_f32 v167, v167, v53
    v_sub_f32 v168, v168, v54
    v_sub_f32 v169, v169, v54
    v_sub_f32 v170, v170, v54
    v_sub_f32 v171, v171, v54
    v_sub_f32 v172, v172, v55
    v_sub_f32 v173, v173, v55
    v_sub_f32 v174, v174, v55
    v_sub_f32 v175, v175, v55
    v_sub_f32 v180, v180, v53
    v_sub_f32 v181, v181, v53
    v_sub_f32 v182, v182, v53
    v_sub_f32 v183, v183, v53
    v_sub_f32 v184, v184, v54
    v_sub_f32 v185, v185, v54
    v_sub_f32 v186, v186, v54
    v_sub_f32 v187, v187, v54
    v_sub_f32 v188, v188, v55
    v_sub_f32 v189, v189, v55
    v_sub_f32 v190, v190, v55
    v_sub_f32 v191, v191, v55
    v_sub_f32 v128, v128, v54
    v_sub_f32 v16, v16, v54
    v_sub_f32 v129, v129, v54
    v_sub_f32 v17, v17, v54
    v_sub_f32 v130, v130, v54
    v_sub_f32 v18, v18, v54
    v_sub_f32 v131, v131, v54
    v_sub_f32 v19, v19, v54
    v_sub_f32 v132, v132, v55
    v_sub_f32 v20, v20, v55
    v_sub_f32 v133, v133, v55
    v_sub_f32 v21, v21, v55
    v_sub_f32 v134, v134, v55
    v_sub_f32 v22, v22, v55
    v_sub_f32 v135, v135, v55
    v_sub_f32 v23, v23, v55
    v_sub_f32 v136, v136, v54
    v_sub_f32 v24, v24, v54
    v_sub_f32 v137, v137, v54
    v_sub_f32 v25, v25, v54
    v_sub_f32 v138, v138, v54
    v_sub_f32 v26, v26, v54
    v_sub_f32 v139, v139, v54
    v_sub_f32 v27, v27, v54
    v_sub_f32 v140, v140, v55
    v_sub_f32 v28, v28, v55
    v_sub_f32 v141, v141, v55
    v_sub_f32 v29, v29, v55
    v_sub_f32 v142, v142, v55
    v_sub_f32 v30, v30, v55
    v_sub_f32 v143, v143, v55
    v_sub_f32 v31, v31, v55
    v_sub_f32 v144, v144, v54
    v_sub_f32 v32, v32, v54
    v_sub_f32 v145, v145, v54
    v_sub_f32 v33, v33, v54
    v_sub_f32 v146, v146, v54
    v_sub_f32 v34, v34, v54
    v_sub_f32 v147, v147, v54
    v_sub_f32 v35, v35, v54
    v_sub_f32 v148, v148, v55
    v_sub_f32 v36, v36, v55
    v_sub_f32 v149, v149, v55
    v_sub_f32 v37, v37, v55
    v_sub_f32 v150, v150, v55
    v_sub_f32 v38, v38, v55
    v_sub_f32 v151, v151, v55
    v_sub_f32 v39, v39, v55
    v_sub_f32 v152, v152, v54
    v_sub_f32 v40, v40, v54
    v_sub_f32 v153, v153, v54
    v_sub_f32 v41, v41, v54
    v_sub_f32 v154, v154, v54
    v_sub_f32 v42, v42, v54
    v_sub_f32 v155, v155, v54
    v_sub_f32 v43, v43, v54
    v_sub_f32 v156, v156, v55
    v_sub_f32 v44, v44, v55
    v_sub_f32 v157, v157, v55
    v_sub_f32 v45, v45, v55
    v_sub_f32 v158, v158, v55
    v_sub_f32 v46, v46, v55
    v_sub_f32 v159, v159, v55
    v_sub_f32 v47, v47, v55
    v_sub_f32 v9, v9, v53
    v_exp_f32 v53, -v53
    v_sub_f32 v10, v10, v54
    v_exp_f32 v54, -v54
    v_sub_f32 v11, v11, v55
    v_exp_f32 v55, -v55
    s_nop 0
    v_mul_f32 v48, v48, v53
    v_mul_f32 v248, v248, v54
    v_mul_f32 v252, v252, v55
    v_accvgpr_read_b32 v224, a4
    v_accvgpr_read_b32 v225, a5
    v_accvgpr_read_b32 v226, a6
    v_accvgpr_read_b32 v227, a7
    v_mul_f32 v224, v224, v53
    v_mul_f32 v225, v225, v53
    v_mul_f32 v226, v226, v53
    v_mul_f32 v227, v227, v53
    v_accvgpr_write_b32 a4, v224
    v_accvgpr_write_b32 a5, v225
    v_accvgpr_write_b32 a6, v226
    v_accvgpr_write_b32 a7, v227
    v_accvgpr_read_b32 v224, a8
    v_accvgpr_read_b32 v225, a9
    v_accvgpr_read_b32 v226, a10
    v_accvgpr_read_b32 v227, a11
    v_mul_f32 v224, v224, v54
    v_mul_f32 v225, v225, v54
    v_mul_f32 v226, v226, v54
    v_mul_f32 v227, v227, v54
    v_accvgpr_write_b32 a8, v224
    v_accvgpr_write_b32 a9, v225
    v_accvgpr_write_b32 a10, v226
    v_accvgpr_write_b32 a11, v227
    v_accvgpr_read_b32 v224, a12
    v_accvgpr_read_b32 v225, a13
    v_accvgpr_read_b32 v226, a14
    v_accvgpr_read_b32 v227, a15
    v_mul_f32 v224, v224, v55
    v_mul_f32 v225, v225, v55
    v_mul_f32 v226, v226, v55
    v_mul_f32 v227, v227, v55
    v_accvgpr_write_b32 a12, v224
    v_accvgpr_write_b32 a13, v225
    v_accvgpr_write_b32 a14, v226
    v_accvgpr_write_b32 a15, v227
    v_accvgpr_read_b32 v224, a20
    v_accvgpr_read_b32 v225, a21
    v_accvgpr_read_b32 v226, a22
    v_accvgpr_read_b32 v227, a23
    v_mul_f32 v224, v224, v53
    v_mul_f32 v225, v225, v53
    v_mul_f32 v226, v226, v53
    v_mul_f32 v227, v227, v53
    v_accvgpr_write_b32 a20, v224
    v_accvgpr_write_b32 a21, v225
    v_accvgpr_write_b32 a22, v226
    v_accvgpr_write_b32 a23, v227
    v_accvgpr_read_b32 v224, a24
    v_accvgpr_read_b32 v225, a25
    v_accvgpr_read_b32 v226, a26
    v_accvgpr_read_b32 v227, a27
    v_mul_f32 v224, v224, v54
    v_mul_f32 v225, v225, v54
    v_mul_f32 v226, v226, v54
    v_mul_f32 v227, v227, v54
    v_accvgpr_write_b32 a24, v224
    v_accvgpr_write_b32 a25, v225
    v_accvgpr_write_b32 a26, v226
    v_accvgpr_write_b32 a27, v227
    v_accvgpr_read_b32 v224, a28
    v_accvgpr_read_b32 v225, a29
    v_accvgpr_read_b32 v226, a30
    v_accvgpr_read_b32 v227, a31
    v_mul_f32 v224, v224, v55
    v_mul_f32 v225, v225, v55
    v_mul_f32 v226, v226, v55
    v_mul_f32 v227, v227, v55
    v_accvgpr_write_b32 a28, v224
    v_accvgpr_write_b32 a29, v225
    v_accvgpr_write_b32 a30, v226
    v_accvgpr_write_b32 a31, v227
    v_accvgpr_read_b32 v224, a36
    v_accvgpr_read_b32 v225, a37
    v_accvgpr_read_b32 v226, a38
    v_accvgpr_read_b32 v227, a39
    v_mul_f32 v224, v224, v53
    v_mul_f32 v225, v225, v53
    v_mul_f32 v226, v226, v53
    v_mul_f32 v227, v227, v53
    v_accvgpr_write_b32 a36, v224
    v_accvgpr_write_b32 a37, v225
    v_accvgpr_write_b32 a38, v226
    v_accvgpr_write_b32 a39, v227
    v_accvgpr_read_b32 v224, a40
    v_accvgpr_read_b32 v225, a41
    v_accvgpr_read_b32 v226, a42
    v_accvgpr_read_b32 v227, a43
    v_mul_f32 v224, v224, v54
    v_mul_f32 v225, v225, v54
    v_mul_f32 v226, v226, v54
    v_mul_f32 v227, v227, v54
    v_accvgpr_write_b32 a40, v224
    v_accvgpr_write_b32 a41, v225
    v_accvgpr_write_b32 a42, v226
    v_accvgpr_write_b32 a43, v227
    v_accvgpr_read_b32 v224, a44
    v_accvgpr_read_b32 v225, a45
    v_accvgpr_read_b32 v226, a46
    v_accvgpr_read_b32 v227, a47
    v_mul_f32 v224, v224, v55
    v_mul_f32 v225, v225, v55
    v_mul_f32 v226, v226, v55
    v_mul_f32 v227, v227, v55
    v_accvgpr_write_b32 a44, v224
    v_accvgpr_write_b32 a45, v225
    v_accvgpr_write_b32 a46, v226
    v_accvgpr_write_b32 a47, v227
    v_accvgpr_read_b32 v224, a52
    v_accvgpr_read_b32 v225, a53
    v_accvgpr_read_b32 v226, a54
    v_accvgpr_read_b32 v227, a55
    v_mul_f32 v224, v224, v53
    v_mul_f32 v225, v225, v53
    v_mul_f32 v226, v226, v53
    v_mul_f32 v227, v227, v53
    v_accvgpr_write_b32 a52, v224
    v_accvgpr_write_b32 a53, v225
    v_accvgpr_write_b32 a54, v226
    v_accvgpr_write_b32 a55, v227
    v_accvgpr_read_b32 v224, a56
    v_accvgpr_read_b32 v225, a57
    v_accvgpr_read_b32 v226, a58
    v_accvgpr_read_b32 v227, a59
    v_mul_f32 v224, v224, v54
    v_mul_f32 v225, v225, v54
    v_mul_f32 v226, v226, v54
    v_mul_f32 v227, v227, v54
    v_accvgpr_write_b32 a56, v224
    v_accvgpr_write_b32 a57, v225
    v_accvgpr_write_b32 a58, v226
    v_accvgpr_write_b32 a59, v227
    v_accvgpr_read_b32 v224, a60
    v_accvgpr_read_b32 v225, a61
    v_accvgpr_read_b32 v226, a62
    v_accvgpr_read_b32 v227, a63
    v_mul_f32 v224, v224, v55
    v_mul_f32 v225, v225, v55
    v_mul_f32 v226, v226, v55
    v_mul_f32 v227, v227, v55
    v_accvgpr_write_b32 a60, v224
    v_accvgpr_write_b32 a61, v225
    v_accvgpr_write_b32 a62, v226
    v_accvgpr_write_b32 a63, v227
    v_accvgpr_read_b32 v224, a68
    v_accvgpr_read_b32 v225, a69
    v_accvgpr_read_b32 v226, a70
    v_accvgpr_read_b32 v227, a71
    v_mul_f32 v224, v224, v53
    v_mul_f32 v225, v225, v53
    v_mul_f32 v226, v226, v53
    v_mul_f32 v227, v227, v53
    v_accvgpr_write_b32 a68, v224
    v_accvgpr_write_b32 a69, v225
    v_accvgpr_write_b32 a70, v226
    v_accvgpr_write_b32 a71, v227
    v_accvgpr_read_b32 v224, a72
    v_accvgpr_read_b32 v225, a73
    v_accvgpr_read_b32 v226, a74
    v_accvgpr_read_b32 v227, a75
    v_mul_f32 v224, v224, v54
    v_mul_f32 v225, v225, v54
    v_mul_f32 v226, v226, v54
    v_mul_f32 v227, v227, v54
    v_accvgpr_write_b32 a72, v224
    v_accvgpr_write_b32 a73, v225
    v_accvgpr_write_b32 a74, v226
    v_accvgpr_write_b32 a75, v227
    v_accvgpr_read_b32 v224, a76
    v_accvgpr_read_b32 v225, a77
    v_accvgpr_read_b32 v226, a78
    v_accvgpr_read_b32 v227, a79
    v_mul_f32 v224, v224, v55
    v_mul_f32 v225, v225, v55
    v_mul_f32 v226, v226, v55
    v_mul_f32 v227, v227, v55
    v_accvgpr_write_b32 a76, v224
    v_accvgpr_write_b32 a77, v225
    v_accvgpr_write_b32 a78, v226
    v_accvgpr_write_b32 a79, v227
    v_accvgpr_read_b32 v224, a84
    v_accvgpr_read_b32 v225, a85
    v_accvgpr_read_b32 v226, a86
    v_accvgpr_read_b32 v227, a87
    v_mul_f32 v224, v224, v53
    v_mul_f32 v225, v225, v53
    v_mul_f32 v226, v226, v53
    v_mul_f32 v227, v227, v53
    v_accvgpr_write_b32 a84, v224
    v_accvgpr_write_b32 a85, v225
    v_accvgpr_write_b32 a86, v226
    v_accvgpr_write_b32 a87, v227
    v_accvgpr_read_b32 v224, a88
    v_accvgpr_read_b32 v225, a89
    v_accvgpr_read_b32 v226, a90
    v_accvgpr_read_b32 v227, a91
    v_mul_f32 v224, v224, v54
    v_mul_f32 v225, v225, v54
    v_mul_f32 v226, v226, v54
    v_mul_f32 v227, v227, v54
    v_accvgpr_write_b32 a88, v224
    v_accvgpr_write_b32 a89, v225
    v_accvgpr_write_b32 a90, v226
    v_accvgpr_write_b32 a91, v227
    v_accvgpr_read_b32 v224, a92
    v_accvgpr_read_b32 v225, a93
    v_accvgpr_read_b32 v226, a94
    v_accvgpr_read_b32 v227, a95
    v_mul_f32 v224, v224, v55
    v_mul_f32 v225, v225, v55
    v_mul_f32 v226, v226, v55
    v_mul_f32 v227, v227, v55
    v_accvgpr_write_b32 a92, v224
    v_accvgpr_write_b32 a93, v225
    v_accvgpr_write_b32 a94, v226
    v_accvgpr_write_b32 a95, v227
    v_accvgpr_read_b32 v224, a100
    v_accvgpr_read_b32 v225, a101
    v_accvgpr_read_b32 v226, a102
    v_accvgpr_read_b32 v227, a103
    v_mul_f32 v224, v224, v53
    v_mul_f32 v225, v225, v53
    v_mul_f32 v226, v226, v53
    v_mul_f32 v227, v227, v53
    v_accvgpr_write_b32 a100, v224
    v_accvgpr_write_b32 a101, v225
    v_accvgpr_write_b32 a102, v226
    v_accvgpr_write_b32 a103, v227
    v_accvgpr_read_b32 v224, a104
    v_accvgpr_read_b32 v225, a105
    v_accvgpr_read_b32 v226, a106
    v_accvgpr_read_b32 v227, a107
    v_mul_f32 v224, v224, v54
    v_mul_f32 v225, v225, v54
    v_mul_f32 v226, v226, v54
    v_mul_f32 v227, v227, v54
    v_accvgpr_write_b32 a104, v224
    v_accvgpr_write_b32 a105, v225
    v_accvgpr_write_b32 a106, v226
    v_accvgpr_write_b32 a107, v227
    v_accvgpr_read_b32 v224, a108
    v_accvgpr_read_b32 v225, a109
    v_accvgpr_read_b32 v226, a110
    v_accvgpr_read_b32 v227, a111
    v_mul_f32 v224, v224, v55
    v_mul_f32 v225, v225, v55
    v_mul_f32 v226, v226, v55
    v_mul_f32 v227, v227, v55
    v_accvgpr_write_b32 a108, v224
    v_accvgpr_write_b32 a109, v225
    v_accvgpr_write_b32 a110, v226
    v_accvgpr_write_b32 a111, v227
    v_accvgpr_read_b32 v224, a116
    v_accvgpr_read_b32 v225, a117
    v_accvgpr_read_b32 v226, a118
    v_accvgpr_read_b32 v227, a119
    v_mul_f32 v224, v224, v53
    v_mul_f32 v225, v225, v53
    v_mul_f32 v226, v226, v53
    v_mul_f32 v227, v227, v53
    v_accvgpr_write_b32 a116, v224
    v_accvgpr_write_b32 a117, v225
    v_accvgpr_write_b32 a118, v226
    v_accvgpr_write_b32 a119, v227
    v_accvgpr_read_b32 v224, a120
    v_accvgpr_read_b32 v225, a121
    v_accvgpr_read_b32 v226, a122
    v_accvgpr_read_b32 v227, a123
    v_mul_f32 v224, v224, v54
    v_mul_f32 v225, v225, v54
    v_mul_f32 v226, v226, v54
    v_mul_f32 v227, v227, v54
    v_accvgpr_write_b32 a120, v224
    v_accvgpr_write_b32 a121, v225
    v_accvgpr_write_b32 a122, v226
    v_accvgpr_write_b32 a123, v227
    v_accvgpr_read_b32 v224, a124
    v_accvgpr_read_b32 v225, a125
    v_accvgpr_read_b32 v226, a126
    v_accvgpr_read_b32 v227, a127
    v_mul_f32 v224, v224, v55
    v_mul_f32 v225, v225, v55
    v_mul_f32 v226, v226, v55
    v_mul_f32 v227, v227, v55
    v_accvgpr_write_b32 a124, v224
    v_accvgpr_write_b32 a125, v225
    v_accvgpr_write_b32 a126, v226
    v_accvgpr_write_b32 a127, v227
    v_exp_f32 v232, v164
    v_exp_f32 v233, v165
    v_exp_f32 v234, v166
    v_exp_f32 v235, v167
    s_nop 0
    v_cvt_pk_bf16_f32 v212, v232, v233
    v_cvt_pk_bf16_f32 v213, v234, v235
    v_exp_f32 v232, v180
    v_exp_f32 v233, v181
    v_exp_f32 v234, v182
    v_exp_f32 v235, v183
    s_nop 0
    v_cvt_pk_bf16_f32 v214, v232, v233
    v_cvt_pk_bf16_f32 v215, v234, v235
    v_exp_f32 v232, v168
    v_exp_f32 v233, v169
    v_exp_f32 v234, v170
    v_exp_f32 v235, v171
    s_nop 0
    v_cvt_pk_bf16_f32 v216, v232, v233
    v_cvt_pk_bf16_f32 v217, v234, v235
    v_exp_f32 v232, v184
    v_exp_f32 v233, v185
    v_exp_f32 v234, v186
    v_exp_f32 v235, v187
    s_nop 0
    v_cvt_pk_bf16_f32 v218, v232, v233
    v_cvt_pk_bf16_f32 v219, v234, v235
    v_exp_f32 v232, v172
    v_exp_f32 v233, v173
    v_exp_f32 v234, v174
    v_exp_f32 v235, v175
    s_nop 0
    v_cvt_pk_bf16_f32 v220, v232, v233
    v_cvt_pk_bf16_f32 v221, v234, v235
    v_exp_f32 v232, v188
    v_exp_f32 v233, v189
    v_exp_f32 v234, v190
    v_exp_f32 v235, v191
    s_nop 0
    v_cvt_pk_bf16_f32 v222, v232, v233
    v_cvt_pk_bf16_f32 v223, v234, v235
    s_nop 3
    s_setpc_b64 s[40:41]
k2_rare_160:
    s_nop 7
    v_max_f32 v54, v128, v129
    v_max3_f32 v54, v54, v130, v131
    v_max3_f32 v54, v54, v144, v145
    v_max3_f32 v54, v54, v146, v147
    v_max3_f32 v54, v54, v136, v137
    v_max3_f32 v54, v54, v138, v139
    v_max3_f32 v54, v54, v152, v153
    v_max3_f32 v54, v54, v154, v155
    v_max_f32 v55, v132, v133
    v_max3_f32 v55, v55, v134, v135
    v_max3_f32 v55, v55, v148, v149
    v_max3_f32 v55, v55, v150, v151
    v_max3_f32 v55, v55, v140, v141
    v_max3_f32 v55, v55, v142, v143
    v_max3_f32 v55, v55, v156, v157
    v_max3_f32 v55, v55, v158, v159
    v_mov_b32 v226, v54
    v_mov_b32 v227, v55
    s_nop 1
    v_permlane16_swap_b32 v54, v226
    v_permlane16_swap_b32 v55, v227
    s_nop 1
    v_max_f32 v54, v54, v226
    v_max_f32 v55, v55, v227
    v_mov_b32 v226, v54
    v_mov_b32 v227, v55
    s_nop 1
    v_permlane32_swap_b32 v54, v226
    v_permlane32_swap_b32 v55, v227
    s_nop 1
    v_max_f32 v54, v54, v226
    v_max_f32 v55, v55, v227
    v_add_f32 v54, 0x41400000, v54
    v_max_f32 v54, 0, v54
    v_add_f32 v55, 0x41400000, v55
    v_max_f32 v55, 0, v55
    v_sub_f32 v128, v128, v54
    v_sub_f32 v129, v129, v54
    v_sub_f32 v130, v130, v54
    v_sub_f32 v131, v131, v54
    v_sub_f32 v132, v132, v55
    v_sub_f32 v133, v133, v55
    v_sub_f32 v134, v134, v55
    v_sub_f32 v135, v135, v55
    v_sub_f32 v136, v136, v54
    v_sub_f32 v137, v137, v54
    v_sub_f32 v138, v138, v54
    v_sub_f32 v139, v139, v54
    v_sub_f32 v140, v140, v55
    v_sub_f32 v141, v141, v55
    v_sub_f32 v142, v142, v55
    v_sub_f32 v143, v143, v55
    v_sub_f32 v144, v144, v54
    v_sub_f32 v145, v145, v54
    v_sub_f32 v146, v146, v54
    v_sub_f32 v147, v147, v54
    v_sub_f32 v148, v148, v55
    v_sub_f32 v149, v149, v55
    v_sub_f32 v150, v150, v55
    v_sub_f32 v151, v151, v55
    v_sub_f32 v152, v152, v54
    v_sub_f32 v153, v153, v54
    v_sub_f32 v154, v154, v54
    v_sub_f32 v155, v155, v54
    v_sub_f32 v156, v156, v55
    v_sub_f32 v157, v157, v55
    v_sub_f32 v158, v158, v55
    v_sub_f32 v159, v159, v55
    v_sub_f32 v160, v160, v54
    v_sub_f32 v16, v16, v54
    v_sub_f32 v161, v161, v54
    v_sub_f32 v17, v17, v54
    v_sub_f32 v162, v162, v54
    v_sub_f32 v18, v18, v54
    v_sub_f32 v163, v163, v54
    v_sub_f32 v19, v19, v54
    v_sub_f32 v164, v164, v55
    v_sub_f32 v20, v20, v55
    v_sub_f32 v165, v165, v55
    v_sub_f32 v21, v21, v55
    v_sub_f32 v166, v166, v55
    v_sub_f32 v22, v22, v55
    v_sub_f32 v167, v167, v55
    v_sub_f32 v23, v23, v55
    v_sub_f32 v168, v168, v54
    v_sub_f32 v24, v24, v54
    v_sub_f32 v169, v169, v54
    v_sub_f32 v25, v25, v54
    v_sub_f32 v170, v170, v54
    v_sub_f32 v26, v26, v54
    v_sub_f32 v171, v171, v54
    v_sub_f32 v27, v27, v54
    v_sub_f32 v172, v172, v55
    v_sub_f32 v28, v28, v55
    v_sub_f32 v173, v173, v55
    v_sub_f32 v29, v29, v55
    v_sub_f32 v174, v174, v55
    v_sub_f32 v30, v30, v55
    v_sub_f32 v175, v175, v55
    v_sub_f32 v31, v31, v55
    v_sub_f32 v176, v176, v54
    v_sub_f32 v32, v32, v54
    v_sub_f32 v177, v177, v54
    v_sub_f32 v33, v33, v54
    v_sub_f32 v178, v178, v54
    v_sub_f32 v34, v34, v54
    v_sub_f32 v179, v179, v54
    v_sub_f32 v35, v35, v54
    v_sub_f32 v180, v180, v55
    v_sub_f32 v36, v36, v55
    v_sub_f32 v181, v181, v55
    v_sub_f32 v37, v37, v55
    v_sub_f32 v182, v182, v55
    v_sub_f32 v38, v38, v55
    v_sub_f32 v183, v183, v55
    v_sub_f32 v39, v39, v55
    v_sub_f32 v184, v184, v54
    v_sub_f32 v40, v40, v54
    v_sub_f32 v185, v185, v54
    v_sub_f32 v41, v41, v54
    v_sub_f32 v186, v186, v54
    v_sub_f32 v42, v42, v54
    v_sub_f32 v187, v187, v54
    v_sub_f32 v43, v43, v54
    v_sub_f32 v188, v188, v55
    v_sub_f32 v44, v44, v55
    v_sub_f32 v189, v189, v55
    v_sub_f32 v45, v45, v55
    v_sub_f32 v190, v190, v55
    v_sub_f32 v46, v46, v55
    v_sub_f32 v191, v191, v55
    v_sub_f32 v47, v47, v55
    v_sub_f32 v10, v10, v54
    v_exp_f32 v54, -v54
    v_sub_f32 v11, v11, v55
    v_exp_f32 v55, -v55
    s_nop 0
    v_mul_f32 v248, v248, v54
    v_mul_f32 v252, v252, v55
    v_accvgpr_read_b32 v224, a8
    v_accvgpr_read_b32 v225, a9
    v_accvgpr_read_b32 v226, a10
    v_accvgpr_read_b32 v227, a11
    v_mul_f32 v224, v224, v54
    v_mul_f32 v225, v225, v54
    v_mul_f32 v226, v226, v54
    v_mul_f32 v227, v227, v54
    v_accvgpr_write_b32 a8, v224
    v_accvgpr_write_b32 a9, v225
    v_accvgpr_write_b32 a10, v226
    v_accvgpr_write_b32 a11, v227
    v_accvgpr_read_b32 v224, a12
    v_accvgpr_read_b32 v225, a13
    v_accvgpr_read_b32 v226, a14
    v_accvgpr_read_b32 v227, a15
    v_mul_f32 v224, v224, v55
    v_mul_f32 v225, v225, v55
    v_mul_f32 v226, v226, v55
    v_mul_f32 v227, v227, v55
    v_accvgpr_write_b32 a12, v224
    v_accvgpr_write_b32 a13, v225
    v_accvgpr_write_b32 a14, v226
    v_accvgpr_write_b32 a15, v227
    v_accvgpr_read_b32 v224, a24
    v_accvgpr_read_b32 v225, a25
    v_accvgpr_read_b32 v226, a26
    v_accvgpr_read_b32 v227, a27
    v_mul_f32 v224, v224, v54
    v_mul_f32 v225, v225, v54
    v_mul_f32 v226, v226, v54
    v_mul_f32 v227, v227, v54
    v_accvgpr_write_b32 a24, v224
    v_accvgpr_write_b32 a25, v225
    v_accvgpr_write_b32 a26, v226
    v_accvgpr_write_b32 a27, v227
    v_accvgpr_read_b32 v224, a28
    v_accvgpr_read_b32 v225, a29
    v_accvgpr_read_b32 v226, a30
    v_accvgpr_read_b32 v227, a31
    v_mul_f32 v224, v224, v55
    v_mul_f32 v225, v225, v55
    v_mul_f32 v226, v226, v55
    v_mul_f32 v227, v227, v55
    v_accvgpr_write_b32 a28, v224
    v_accvgpr_write_b32 a29, v225
    v_accvgpr_write_b32 a30, v226
    v_accvgpr_write_b32 a31, v227
    v_accvgpr_read_b32 v224, a40
    v_accvgpr_read_b32 v225, a41
    v_accvgpr_read_b32 v226, a42
    v_accvgpr_read_b32 v227, a43
    v_mul_f32 v224, v224, v54
    v_mul_f32 v225, v225, v54
    v_mul_f32 v226, v226, v54
    v_mul_f32 v227, v227, v54
    v_accvgpr_write_b32 a40, v224
    v_accvgpr_write_b32 a41, v225
    v_accvgpr_write_b32 a42, v226
    v_accvgpr_write_b32 a43, v227
    v_accvgpr_read_b32 v224, a44
    v_accvgpr_read_b32 v225, a45
    v_accvgpr_read_b32 v226, a46
    v_accvgpr_read_b32 v227, a47
    v_mul_f32 v224, v224, v55
    v_mul_f32 v225, v225, v55
    v_mul_f32 v226, v226, v55
    v_mul_f32 v227, v227, v55
    v_accvgpr_write_b32 a44, v224
    v_accvgpr_write_b32 a45, v225
    v_accvgpr_write_b32 a46, v226
    v_accvgpr_write_b32 a47, v227
    v_accvgpr_read_b32 v224, a56
    v_accvgpr_read_b32 v225, a57
    v_accvgpr_read_b32 v226, a58
    v_accvgpr_read_b32 v227, a59
    v_mul_f32 v224, v224, v54
    v_mul_f32 v225, v225, v54
    v_mul_f32 v226, v226, v54
    v_mul_f32 v227, v227, v54
    v_accvgpr_write_b32 a56, v224
    v_accvgpr_write_b32 a57, v225
    v_accvgpr_write_b32 a58, v226
    v_accvgpr_write_b32 a59, v227
    v_accvgpr_read_b32 v224, a60
    v_accvgpr_read_b32 v225, a61
    v_accvgpr_read_b32 v226, a62
    v_accvgpr_read_b32 v227, a63
    v_mul_f32 v224, v224, v55
    v_mul_f32 v225, v225, v55
    v_mul_f32 v226, v226, v55
    v_mul_f32 v227, v227, v55
    v_accvgpr_write_b32 a60, v224
    v_accvgpr_write_b32 a61, v225
    v_accvgpr_write_b32 a62, v226
    v_accvgpr_write_b32 a63, v227
    v_accvgpr_read_b32 v224, a72
    v_accvgpr_read_b32 v225, a73
    v_accvgpr_read_b32 v226, a74
    v_accvgpr_read_b32 v227, a75
    v_mul_f32 v224, v224, v54
    v_mul_f32 v225, v225, v54
    v_mul_f32 v226, v226, v54
    v_mul_f32 v227, v227, v54
    v_accvgpr_write_b32 a72, v224
    v_accvgpr_write_b32 a73, v225
    v_accvgpr_write_b32 a74, v226
    v_accvgpr_write_b32 a75, v227
    v_accvgpr_read_b32 v224, a76
    v_accvgpr_read_b32 v225, a77
    v_accvgpr_read_b32 v226, a78
    v_accvgpr_read_b32 v227, a79
    v_mul_f32 v224, v224, v55
    v_mul_f32 v225, v225, v55
    v_mul_f32 v226, v226, v55
    v_mul_f32 v227, v227, v55
    v_accvgpr_write_b32 a76, v224
    v_accvgpr_write_b32 a77, v225
    v_accvgpr_write_b32 a78, v226
    v_accvgpr_write_b32 a79, v227
    v_accvgpr_read_b32 v224, a88
    v_accvgpr_read_b32 v225, a89
    v_accvgpr_read_b32 v226, a90
    v_accvgpr_read_b32 v227, a91
    v_mul_f32 v224, v224, v54
    v_mul_f32 v225, v225, v54
    v_mul_f32 v226, v226, v54
    v_mul_f32 v227, v227, v54
    v_accvgpr_write_b32 a88, v224
    v_accvgpr_write_b32 a89, v225
    v_accvgpr_write_b32 a90, v226
    v_accvgpr_write_b32 a91, v227
    v_accvgpr_read_b32 v224, a92
    v_accvgpr_read_b32 v225, a93
    v_accvgpr_read_b32 v226, a94
    v_accvgpr_read_b32 v227, a95
    v_mul_f32 v224, v224, v55
    v_mul_f32 v225, v225, v55
    v_mul_f32 v226, v226, v55
    v_mul_f32 v227, v227, v55
    v_accvgpr_write_b32 a92, v224
    v_accvgpr_write_b32 a93, v225
    v_accvgpr_write_b32 a94, v226
    v_accvgpr_write_b32 a95, v227
    v_accvgpr_read_b32 v224, a104
    v_accvgpr_read_b32 v225, a105
    v_accvgpr_read_b32 v226, a106
    v_accvgpr_read_b32 v227, a107
    v_mul_f32 v224, v224, v54
    v_mul_f32 v225, v225, v54
    v_mul_f32 v226, v226, v54
    v_mul_f32 v227, v227, v54
    v_accvgpr_write_b32 a104, v224
    v_accvgpr_write_b32 a105, v225
    v_accvgpr_write_b32 a106, v226
    v_accvgpr_write_b32 a107, v227
    v_accvgpr_read_b32 v224, a108
    v_accvgpr_read_b32 v225, a109
    v_accvgpr_read_b32 v226, a110
    v_accvgpr_read_b32 v227, a111
    v_mul_f32 v224, v224, v55
    v_mul_f32 v225, v225, v55
    v_mul_f32 v226, v226, v55
    v_mul_f32 v227, v227, v55
    v_accvgpr_write_b32 a108, v224
    v_accvgpr_write_b32 a109, v225
    v_accvgpr_write_b32 a110, v226
    v_accvgpr_write_b32 a111, v227
    v_accvgpr_read_b32 v224, a120
    v_accvgpr_read_b32 v225, a121
    v_accvgpr_read_b32 v226, a122
    v_accvgpr_read_b32 v227, a123
    v_mul_f32 v224, v224, v54
    v_mul_f32 v225, v225, v54
    v_mul_f32 v226, v226, v54
    v_mul_f32 v227, v227, v54
    v_accvgpr_write_b32 a120, v224
    v_accvgpr_write_b32 a121, v225
    v_accvgpr_write_b32 a122, v226
    v_accvgpr_write_b32 a123, v227
    v_accvgpr_read_b32 v224, a124
    v_accvgpr_read_b32 v225, a125
    v_accvgpr_read_b32 v226, a126
    v_accvgpr_read_b32 v227, a127
    v_mul_f32 v224, v224, v55
    v_mul_f32 v225, v225, v55
    v_mul_f32 v226, v226, v55
    v_mul_f32 v227, v227, v55
    v_accvgpr_write_b32 a124, v224
    v_accvgpr_write_b32 a125, v225
    v_accvgpr_write_b32 a126, v226
    v_accvgpr_write_b32 a127, v227
    v_exp_f32 v232, v128
    v_exp_f32 v233, v129
    v_exp_f32 v234, v130
    v_exp_f32 v235, v131
    s_nop 0
    v_cvt_pk_bf16_f32 v192, v232, v233
    v_cvt_pk_bf16_f32 v193, v234, v235
    v_exp_f32 v232, v144
    v_exp_f32 v233, v145
    v_exp_f32 v234, v146
    v_exp_f32 v235, v147
    s_nop 0
    v_cvt_pk_bf16_f32 v194, v232, v233
    v_cvt_pk_bf16_f32 v195, v234, v235
    v_exp_f32 v232, v132
    v_exp_f32 v233, v133
    v_exp_f32 v234, v134
    v_exp_f32 v235, v135
    s_nop 0
    v_cvt_pk_bf16_f32 v196, v232, v233
    v_cvt_pk_bf16_f32 v197, v234, v235
    v_exp_f32 v232, v148
    v_exp_f32 v233, v149
    v_exp_f32 v234, v150
    v_exp_f32 v235, v151
    s_nop 0
    v_cvt_pk_bf16_f32 v198, v232, v233
    v_cvt_pk_bf16_f32 v199, v234, v235
    v_exp_f32 v232, v136
    v_exp_f32 v233, v137
    v_exp_f32 v234, v138
    v_exp_f32 v235, v139
    s_nop 0
    v_cvt_pk_bf16_f32 v200, v232, v233
    v_cvt_pk_bf16_f32 v201, v234, v235
    v_exp_f32 v232, v152
    v_exp_f32 v233, v153
    v_exp_f32 v234, v154
    v_exp_f32 v235, v155
    s_nop 0
    v_cvt_pk_bf16_f32 v202, v232, v233
    v_cvt_pk_bf16_f32 v203, v234, v235
    v_exp_f32 v232, v140
    v_exp_f32 v233, v141
    v_exp_f32 v234, v142
    v_exp_f32 v235, v143
    s_nop 0
    v_cvt_pk_bf16_f32 v204, v232, v233
    v_cvt_pk_bf16_f32 v205, v234, v235
    v_exp_f32 v232, v156
    v_exp_f32 v233, v157
    v_exp_f32 v234, v158
    v_exp_f32 v235, v159
    s_nop 0
    v_cvt_pk_bf16_f32 v206, v232, v233
    v_cvt_pk_bf16_f32 v207, v234, v235
    s_nop 3
    s_setpc_b64 s[40:41]
k2_rare_161:
    s_nop 7
    v_max_f32 v54, v160, v161
    v_max3_f32 v54, v54, v162, v163
    v_max3_f32 v54, v54, v176, v177
    v_max3_f32 v54, v54, v178, v179
    v_max3_f32 v54, v54, v168, v169
    v_max3_f32 v54, v54, v170, v171
    v_max3_f32 v54, v54, v184, v185
    v_max3_f32 v54, v54, v186, v187
    v_max_f32 v55, v164, v165
    v_max3_f32 v55, v55, v166, v167
    v_max3_f32 v55, v55, v180, v181
    v_max3_f32 v55, v55, v182, v183
    v_max3_f32 v55, v55, v172, v173
    v_max3_f32 v55, v55, v174, v175
    v_max3_f32 v55, v55, v188, v189
    v_max3_f32 v55, v55, v190, v191
    v_mov_b32 v226, v54
    v_mov_b32 v227, v55
    s_nop 1
    v_permlane16_swap_b32 v54, v226
    v_permlane16_swap_b32 v55, v227
    s_nop 1
    v_max_f32 v54, v54, v226
    v_max_f32 v55, v55, v227
    v_mov_b32 v226, v54
    v_mov_b32 v227, v55
    s_nop 1
    v_permlane32_swap_b32 v54, v226
    v_permlane32_swap_b32 v55, v227
    s_nop 1
    v_max_f32 v54, v54, v226
    v_max_f32 v55, v55, v227
    v_add_f32 v54, 0x41400000, v54
    v_max_f32 v54, 0, v54
    v_add_f32 v55, 0x41400000, v55
    v_max_f32 v55, 0, v55
    v_sub_f32 v160, v160, v54
    v_sub_f32 v161, v161, v54
    v_sub_f32 v162, v162, v54
    v_sub_f32 v163, v163, v54
    v_sub_f32 v164, v164, v55
    v_sub_f32 v165, v165, v55
    v_sub_f32 v166, v166, v55
    v_sub_f32 v167, v167, v55
    v_sub_f32 v168, v168, v54
    v_sub_f32 v169, v169, v54
    v_sub_f32 v170, v170, v54
    v_sub_f32 v171, v171, v54
    v_sub_f32 v172, v172, v55
    v_sub_f32 v173, v173, v55
    v_sub_f32 v174, v174, v55
    v_sub_f32 v175, v175, v55
    v_sub_f32 v176, v176, v54
    v_sub_f32 v177, v177, v54
    v_sub_f32 v178, v178, v54
    v_sub_f32 v179, v179, v54
    v_sub_f32 v180, v180, v55
    v_sub_f32 v181, v181, v55
    v_sub_f32 v182, v182, v55
    v_sub_f32 v183, v183, v55
    v_sub_f32 v184, v184, v54
    v_sub_f32 v185, v185, v54
    v_sub_f32 v186, v186, v54
    v_sub_f32 v187, v187, v54
    v_sub_f32 v188, v188, v55
    v_sub_f32 v189, v189, v55
    v_sub_f32 v190, v190, v55
    v_sub_f32 v191, v191, v55
    v_sub_f32 v128, v128, v54
    v_sub_f32 v16, v16, v54
    v_sub_f32 v129, v129, v54
    v_sub_f32 v17, v17, v54
    v_sub_f32 v130, v130, v54
    v_sub_f32 v18, v18, v54
    v_sub_f32 v131, v131, v54
    v_sub_f32 v19, v19, v54
    v_sub_f32 v132, v132, v55
    v_sub_f32 v20, v20, v55
    v_sub_f32 v133, v133, v55
    v_sub_f32 v21, v21, v55
    v_sub_f32 v134, v134, v55
    v_sub_f32 v22, v22, v55
    v_sub_f32 v135, v135, v55
    v_sub_f32 v23, v23, v55
    v_sub_f32 v136, v136, v54
    v_sub_f32 v24, v24, v54
    v_sub_f32 v137, v137, v54
    v_sub_f32 v25, v25, v54
    v_sub_f32 v138, v138, v54
    v_sub_f32 v26, v26, v54
    v_sub_f32 v139, v139, v54
    v_sub_f32 v27, v27, v54
    v_sub_f32 v140, v140, v55
    v_sub_f32 v28, v28, v55
    v_sub_f32 v141, v141, v55
    v_sub_f32 v29, v29, v55
    v_sub_f32 v142, v142, v55
    v_sub_f32 v30, v30, v55
    v_sub_f32 v143, v143, v55
    v_sub_f32 v31, v31, v55
    v_sub_f32 v144, v144, v54
    v_sub_f32 v32, v32, v54
    v_sub_f32 v145, v145, v54
    v_sub_f32 v33, v33, v54
    v_sub_f32 v146, v146, v54
    v_sub_f32 v34, v34, v54
    v_sub_f32 v147, v147, v54
    v_sub_f32 v35, v35, v54
    v_sub_f32 v148, v148, v55
    v_sub_f32 v36, v36, v55
    v_sub_f32 v149, v149, v55
    v_sub_f32 v37, v37, v55
    v_sub_f32 v150, v150, v55
    v_sub_f32 v38, v38, v55
    v_sub_f32 v151, v151, v55
    v_sub_f32 v39, v39, v55
    v_sub_f32 v152, v152, v54
    v_sub_f32 v40, v40, v54
    v_sub_f32 v153, v153, v54
    v_sub_f32 v41, v41, v54
    v_sub_f32 v154, v154, v54
    v_sub_f32 v42, v42, v54
    v_sub_f32 v155, v155, v54
    v_sub_f32 v43, v43, v54
    v_sub_f32 v156, v156, v55
    v_sub_f32 v44, v44, v55
    v_sub_f32 v157, v157, v55
    v_sub_f32 v45, v45, v55
    v_sub_f32 v158, v158, v55
    v_sub_f32 v46, v46, v55
    v_sub_f32 v159, v159, v55
    v_sub_f32 v47, v47, v55
    v_sub_f32 v10, v10, v54
    v_exp_f32 v54, -v54
    v_sub_f32 v11, v11, v55
    v_exp_f32 v55, -v55
    s_nop 0
    v_mul_f32 v248, v248, v54
    v_mul_f32 v252, v252, v55
    v_accvgpr_read_b32 v224, a8
    v_accvgpr_read_b32 v225, a9
    v_accvgpr_read_b32 v226, a10
    v_accvgpr_read_b32 v227, a11
    v_mul_f32 v224, v224, v54
    v_mul_f32 v225, v225, v54
    v_mul_f32 v226, v226, v54
    v_mul_f32 v227, v227, v54
    v_accvgpr_write_b32 a8, v224
    v_accvgpr_write_b32 a9, v225
    v_accvgpr_write_b32 a10, v226
    v_accvgpr_write_b32 a11, v227
    v_accvgpr_read_b32 v224, a12
    v_accvgpr_read_b32 v225, a13
    v_accvgpr_read_b32 v226, a14
    v_accvgpr_read_b32 v227, a15
    v_mul_f32 v224, v224, v55
    v_mul_f32 v225, v225, v55
    v_mul_f32 v226, v226, v55
    v_mul_f32 v227, v227, v55
    v_accvgpr_write_b32 a12, v224
    v_accvgpr_write_b32 a13, v225
    v_accvgpr_write_b32 a14, v226
    v_accvgpr_write_b32 a15, v227
    v_accvgpr_read_b32 v224, a24
    v_accvgpr_read_b32 v225, a25
    v_accvgpr_read_b32 v226, a26
    v_accvgpr_read_b32 v227, a27
    v_mul_f32 v224, v224, v54
    v_mul_f32 v225, v225, v54
    v_mul_f32 v226, v226, v54
    v_mul_f32 v227, v227, v54
    v_accvgpr_write_b32 a24, v224
    v_accvgpr_write_b32 a25, v225
    v_accvgpr_write_b32 a26, v226
    v_accvgpr_write_b32 a27, v227
    v_accvgpr_read_b32 v224, a28
    v_accvgpr_read_b32 v225, a29
    v_accvgpr_read_b32 v226, a30
    v_accvgpr_read_b32 v227, a31
    v_mul_f32 v224, v224, v55
    v_mul_f32 v225, v225, v55
    v_mul_f32 v226, v226, v55
    v_mul_f32 v227, v227, v55
    v_accvgpr_write_b32 a28, v224
    v_accvgpr_write_b32 a29, v225
    v_accvgpr_write_b32 a30, v226
    v_accvgpr_write_b32 a31, v227
    v_accvgpr_read_b32 v224, a40
    v_accvgpr_read_b32 v225, a41
    v_accvgpr_read_b32 v226, a42
    v_accvgpr_read_b32 v227, a43
    v_mul_f32 v224, v224, v54
    v_mul_f32 v225, v225, v54
    v_mul_f32 v226, v226, v54
    v_mul_f32 v227, v227, v54
    v_accvgpr_write_b32 a40, v224
    v_accvgpr_write_b32 a41, v225
    v_accvgpr_write_b32 a42, v226
    v_accvgpr_write_b32 a43, v227
    v_accvgpr_read_b32 v224, a44
    v_accvgpr_read_b32 v225, a45
    v_accvgpr_read_b32 v226, a46
    v_accvgpr_read_b32 v227, a47
    v_mul_f32 v224, v224, v55
    v_mul_f32 v225, v225, v55
    v_mul_f32 v226, v226, v55
    v_mul_f32 v227, v227, v55
    v_accvgpr_write_b32 a44, v224
    v_accvgpr_write_b32 a45, v225
    v_accvgpr_write_b32 a46, v226
    v_accvgpr_write_b32 a47, v227
    v_accvgpr_read_b32 v224, a56
    v_accvgpr_read_b32 v225, a57
    v_accvgpr_read_b32 v226, a58
    v_accvgpr_read_b32 v227, a59
    v_mul_f32 v224, v224, v54
    v_mul_f32 v225, v225, v54
    v_mul_f32 v226, v226, v54
    v_mul_f32 v227, v227, v54
    v_accvgpr_write_b32 a56, v224
    v_accvgpr_write_b32 a57, v225
    v_accvgpr_write_b32 a58, v226
    v_accvgpr_write_b32 a59, v227
    v_accvgpr_read_b32 v224, a60
    v_accvgpr_read_b32 v225, a61
    v_accvgpr_read_b32 v226, a62
    v_accvgpr_read_b32 v227, a63
    v_mul_f32 v224, v224, v55
    v_mul_f32 v225, v225, v55
    v_mul_f32 v226, v226, v55
    v_mul_f32 v227, v227, v55
    v_accvgpr_write_b32 a60, v224
    v_accvgpr_write_b32 a61, v225
    v_accvgpr_write_b32 a62, v226
    v_accvgpr_write_b32 a63, v227
    v_accvgpr_read_b32 v224, a72
    v_accvgpr_read_b32 v225, a73
    v_accvgpr_read_b32 v226, a74
    v_accvgpr_read_b32 v227, a75
    v_mul_f32 v224, v224, v54
    v_mul_f32 v225, v225, v54
    v_mul_f32 v226, v226, v54
    v_mul_f32 v227, v227, v54
    v_accvgpr_write_b32 a72, v224
    v_accvgpr_write_b32 a73, v225
    v_accvgpr_write_b32 a74, v226
    v_accvgpr_write_b32 a75, v227
    v_accvgpr_read_b32 v224, a76
    v_accvgpr_read_b32 v225, a77
    v_accvgpr_read_b32 v226, a78
    v_accvgpr_read_b32 v227, a79
    v_mul_f32 v224, v224, v55
    v_mul_f32 v225, v225, v55
    v_mul_f32 v226, v226, v55
    v_mul_f32 v227, v227, v55
    v_accvgpr_write_b32 a76, v224
    v_accvgpr_write_b32 a77, v225
    v_accvgpr_write_b32 a78, v226
    v_accvgpr_write_b32 a79, v227
    v_accvgpr_read_b32 v224, a88
    v_accvgpr_read_b32 v225, a89
    v_accvgpr_read_b32 v226, a90
    v_accvgpr_read_b32 v227, a91
    v_mul_f32 v224, v224, v54
    v_mul_f32 v225, v225, v54
    v_mul_f32 v226, v226, v54
    v_mul_f32 v227, v227, v54
    v_accvgpr_write_b32 a88, v224
    v_accvgpr_write_b32 a89, v225
    v_accvgpr_write_b32 a90, v226
    v_accvgpr_write_b32 a91, v227
    v_accvgpr_read_b32 v224, a92
    v_accvgpr_read_b32 v225, a93
    v_accvgpr_read_b32 v226, a94
    v_accvgpr_read_b32 v227, a95
    v_mul_f32 v224, v224, v55
    v_mul_f32 v225, v225, v55
    v_mul_f32 v226, v226, v55
    v_mul_f32 v227, v227, v55
    v_accvgpr_write_b32 a92, v224
    v_accvgpr_write_b32 a93, v225
    v_accvgpr_write_b32 a94, v226
    v_accvgpr_write_b32 a95, v227
    v_accvgpr_read_b32 v224, a104
    v_accvgpr_read_b32 v225, a105
    v_accvgpr_read_b32 v226, a106
    v_accvgpr_read_b32 v227, a107
    v_mul_f32 v224, v224, v54
    v_mul_f32 v225, v225, v54
    v_mul_f32 v226, v226, v54
    v_mul_f32 v227, v227, v54
    v_accvgpr_write_b32 a104, v224
    v_accvgpr_write_b32 a105, v225
    v_accvgpr_write_b32 a106, v226
    v_accvgpr_write_b32 a107, v227
    v_accvgpr_read_b32 v224, a108
    v_accvgpr_read_b32 v225, a109
    v_accvgpr_read_b32 v226, a110
    v_accvgpr_read_b32 v227, a111
    v_mul_f32 v224, v224, v55
    v_mul_f32 v225, v225, v55
    v_mul_f32 v226, v226, v55
    v_mul_f32 v227, v227, v55
    v_accvgpr_write_b32 a108, v224
    v_accvgpr_write_b32 a109, v225
    v_accvgpr_write_b32 a110, v226
    v_accvgpr_write_b32 a111, v227
    v_accvgpr_read_b32 v224, a120
    v_accvgpr_read_b32 v225, a121
    v_accvgpr_read_b32 v226, a122
    v_accvgpr_read_b32 v227, a123
    v_mul_f32 v224, v224, v54
    v_mul_f32 v225, v225, v54
    v_mul_f32 v226, v226, v54
    v_mul_f32 v227, v227, v54
    v_accvgpr_write_b32 a120, v224
    v_accvgpr_write_b32 a121, v225
    v_accvgpr_write_b32 a122, v226
    v_accvgpr_write_b32 a123, v227
    v_accvgpr_read_b32 v224, a124
    v_accvgpr_read_b32 v225, a125
    v_accvgpr_read_b32 v226, a126
    v_accvgpr_read_b32 v227, a127
    v_mul_f32 v224, v224, v55
    v_mul_f32 v225, v225, v55
    v_mul_f32 v226, v226, v55
    v_mul_f32 v227, v227, v55
    v_accvgpr_write_b32 a124, v224
    v_accvgpr_write_b32 a125, v225
    v_accvgpr_write_b32 a126, v226
    v_accvgpr_write_b32 a127, v227
    v_exp_f32 v232, v160
    v_exp_f32 v233, v161
    v_exp_f32 v234, v162
    v_exp_f32 v235, v163
    s_nop 0
    v_cvt_pk_bf16_f32 v208, v232, v233
    v_cvt_pk_bf16_f32 v209, v234, v235
    v_exp_f32 v232, v176
    v_exp_f32 v233, v177
    v_exp_f32 v234, v178
    v_exp_f32 v235, v179
    s_nop 0
    v_cvt_pk_bf16_f32 v210, v232, v233
    v_cvt_pk_bf16_f32 v211, v234, v235
    v_exp_f32 v232, v164
    v_exp_f32 v233, v165
    v_exp_f32 v234, v166
    v_exp_f32 v235, v167
    s_nop 0
    v_cvt_pk_bf16_f32 v212, v232, v233
    v_cvt_pk_bf16_f32 v213, v234, v235
    v_exp_f32 v232, v180
    v_exp_f32 v233, v181
    v_exp_f32 v234, v182
    v_exp_f32 v235, v183
    s_nop 0
    v_cvt_pk_bf16_f32 v214, v232, v233
    v_cvt_pk_bf16_f32 v215, v234, v235
    v_exp_f32 v232, v168
    v_exp_f32 v233, v169
    v_exp_f32 v234, v170
    v_exp_f32 v235, v171
    s_nop 0
    v_cvt_pk_bf16_f32 v216, v232, v233
    v_cvt_pk_bf16_f32 v217, v234, v235
    v_exp_f32 v232, v184
    v_exp_f32 v233, v185
    v_exp_f32 v234, v186
    v_exp_f32 v235, v187
    s_nop 0
    v_cvt_pk_bf16_f32 v218, v232, v233
    v_cvt_pk_bf16_f32 v219, v234, v235
    v_exp_f32 v232, v172
    v_exp_f32 v233, v173
    v_exp_f32 v234, v174
    v_exp_f32 v235, v175
    s_nop 0
    v_cvt_pk_bf16_f32 v220, v232, v233
    v_cvt_pk_bf16_f32 v221, v234, v235
    v_exp_f32 v232, v188
    v_exp_f32 v233, v189
    v_exp_f32 v234, v190
    v_exp_f32 v235, v191
    s_nop 0
    v_cvt_pk_bf16_f32 v222, v232, v233
    v_cvt_pk_bf16_f32 v223, v234, v235
    s_nop 3
    s_setpc_b64 s[40:41]
k2_rare_165:
    s_nop 7
    v_max_f32 v55, v164, v165
    v_max3_f32 v55, v55, v166, v167
    v_max3_f32 v55, v55, v180, v181
    v_max3_f32 v55, v55, v182, v183
    v_max3_f32 v55, v55, v172, v173
    v_max3_f32 v55, v55, v174, v175
    v_max3_f32 v55, v55, v188, v189
    v_max3_f32 v55, v55, v190, v191
    v_mov_b32 v227, v55
    s_nop 1
    v_permlane16_swap_b32 v55, v227
    s_nop 1
    v_max_f32 v55, v55, v227
    v_mov_b32 v227, v55
    s_nop 1
    v_permlane32_swap_b32 v55, v227
    s_nop 1
    v_max_f32 v55, v55, v227
    v_add_f32 v55, 0x41400000, v55
    v_max_f32 v55, 0, v55
    v_sub_f32 v164, v164, v55
    v_sub_f32 v165, v165, v55
    v_sub_f32 v166, v166, v55
    v_sub_f32 v167, v167, v55
    v_sub_f32 v172, v172, v55
    v_sub_f32 v173, v173, v55
    v_sub_f32 v174, v174, v55
    v_sub_f32 v175, v175, v55
    v_sub_f32 v180, v180, v55
    v_sub_f32 v181, v181, v55
    v_sub_f32 v182, v182, v55
    v_sub_f32 v183, v183, v55
    v_sub_f32 v188, v188, v55
    v_sub_f32 v189, v189, v55
    v_sub_f32 v190, v190, v55
    v_sub_f32 v191, v191, v55
    v_sub_f32 v11, v11, v55
    v_exp_f32 v55, -v55
    s_nop 0
    v_mul_f32 v252, v252, v55
    v_accvgpr_read_b32 v224, a12
    v_accvgpr_read_b32 v225, a13
    v_accvgpr_read_b32 v226, a14
    v_accvgpr_read_b32 v227, a15
    v_mul_f32 v224, v224, v55
    v_mul_f32 v225, v225, v55
    v_mul_f32 v226, v226, v55
    v_mul_f32 v227, v227, v55
    v_accvgpr_write_b32 a12, v224
    v_accvgpr_write_b32 a13, v225
    v_accvgpr_write_b32 a14, v226
    v_accvgpr_write_b32 a15, v227
    v_accvgpr_read_b32 v224, a28
    v_accvgpr_read_b32 v225, a29
    v_accvgpr_read_b32 v226, a30
    v_accvgpr_read_b32 v227, a31
    v_mul_f32 v224, v224, v55
    v_mul_f32 v225, v225, v55
    v_mul_f32 v226, v226, v55
    v_mul_f32 v227, v227, v55
    v_accvgpr_write_b32 a28, v224
    v_accvgpr_write_b32 a29, v225
    v_accvgpr_write_b32 a30, v226
    v_accvgpr_write_b32 a31, v227
    v_accvgpr_read_b32 v224, a44
    v_accvgpr_read_b32 v225, a45
    v_accvgpr_read_b32 v226, a46
    v_accvgpr_read_b32 v227, a47
    v_mul_f32 v224, v224, v55
    v_mul_f32 v225, v225, v55
    v_mul_f32 v226, v226, v55
    v_mul_f32 v227, v227, v55
    v_accvgpr_write_b32 a44, v224
    v_accvgpr_write_b32 a45, v225
    v_accvgpr_write_b32 a46, v226
    v_accvgpr_write_b32 a47, v227
    v_accvgpr_read_b32 v224, a60
    v_accvgpr_read_b32 v225, a61
    v_accvgpr_read_b32 v226, a62
    v_accvgpr_read_b32 v227, a63
    v_mul_f32 v224, v224, v55
    v_mul_f32 v225, v225, v55
    v_mul_f32 v226, v226, v55
    v_mul_f32 v227, v227, v55
    v_accvgpr_write_b32 a60, v224
    v_accvgpr_write_b32 a61, v225
    v_accvgpr_write_b32 a62, v226
    v_accvgpr_write_b32 a63, v227
    v_accvgpr_read_b32 v224, a76
    v_accvgpr_read_b32 v225, a77
    v_accvgpr_read_b32 v226, a78
    v_accvgpr_read_b32 v227, a79
    v_mul_f32 v224, v224, v55
    v_mul_f32 v225, v225, v55
    v_mul_f32 v226, v226, v55
    v_mul_f32 v227, v227, v55
    v_accvgpr_write_b32 a76, v224
    v_accvgpr_write_b32 a77, v225
    v_accvgpr_write_b32 a78, v226
    v_accvgpr_write_b32 a79, v227
    v_accvgpr_read_b32 v224, a92
    v_accvgpr_read_b32 v225, a93
    v_accvgpr_read_b32 v226, a94
    v_accvgpr_read_b32 v227, a95
    v_mul_f32 v224, v224, v55
    v_mul_f32 v225, v225, v55
    v_mul_f32 v226, v226, v55
    v_mul_f32 v227, v227, v55
    v_accvgpr_write_b32 a92, v224
    v_accvgpr_write_b32 a93, v225
    v_accvgpr_write_b32 a94, v226
    v_accvgpr_write_b32 a95, v227
    v_accvgpr_read_b32 v224, a108
    v_accvgpr_read_b32 v225, a109
    v_accvgpr_read_b32 v226, a110
    v_accvgpr_read_b32 v227, a111
    v_mul_f32 v224, v224, v55
    v_mul_f32 v225, v225, v55
    v_mul_f32 v226, v226, v55
    v_mul_f32 v227, v227, v55
    v_accvgpr_write_b32 a108, v224
    v_accvgpr_write_b32 a109, v225
    v_accvgpr_write_b32 a110, v226
    v_accvgpr_write_b32 a111, v227
    v_accvgpr_read_b32 v224, a124
    v_accvgpr_read_b32 v225, a125
    v_accvgpr_read_b32 v226, a126
    v_accvgpr_read_b32 v227, a127
    v_mul_f32 v224, v224, v55
    v_mul_f32 v225, v225, v55
    v_mul_f32 v226, v226, v55
    v_mul_f32 v227, v227, v55
    v_accvgpr_write_b32 a124, v224
    v_accvgpr_write_b32 a125, v225
    v_accvgpr_write_b32 a126, v226
    v_accvgpr_write_b32 a127, v227
    v_exp_f32 v232, v164
    v_exp_f32 v233, v165
    v_exp_f32 v234, v166
    v_exp_f32 v235, v167
    s_nop 0
    v_cvt_pk_bf16_f32 v212, v232, v233
    v_cvt_pk_bf16_f32 v213, v234, v235
    v_exp_f32 v232, v180
    v_exp_f32 v233, v181
    v_exp_f32 v234, v182
    v_exp_f32 v235, v183
    s_nop 0
    v_cvt_pk_bf16_f32 v214, v232, v233
    v_cvt_pk_bf16_f32 v215, v234, v235
    v_exp_f32 v232, v172
    v_exp_f32 v233, v173
    v_exp_f32 v234, v174
    v_exp_f32 v235, v175
    s_nop 0
    v_cvt_pk_bf16_f32 v220, v232, v233
    v_cvt_pk_bf16_f32 v221, v234, v235
    v_exp_f32 v232, v188
    v_exp_f32 v233, v189
    v_exp_f32 v234, v190
    v_exp_f32 v235, v191
    s_nop 0
    v_cvt_pk_bf16_f32 v222, v232, v233
    v_cvt_pk_bf16_f32 v223, v234, v235
    s_nop 3
    s_setpc_b64 s[40:41]
code_end:
    s_endpgm
.section .rodata,"a"
.p2align 6
.amdhsa_kernel sequential_preLN__compressed_kv_cla__moe_arch_mod__prompt_kernel
  .amdhsa_next_free_vgpr 512
  .amdhsa_next_free_sgpr 102
  .amdhsa_accum_offset 256
  .amdhsa_group_segment_fixed_size 0
  .amdhsa_kernarg_size 112
  .amdhsa_user_sgpr_count 2
  .amdhsa_user_sgpr_kernarg_segment_ptr 1
  .amdhsa_system_sgpr_workgroup_id_x 1
.end_amdhsa_kernel
```

```asm
; @launch grid=(256,1,1) block=(256,1,1) lds=163840
.amdgcn_target "amdgcn-amd-amdhsa--gfx950"
.text
.globl sequential_preLN__compressed_kv_cla__moe_arch_mod__prompt_kernel
.p2align 8
.type sequential_preLN__compressed_kv_cla__moe_arch_mod__prompt_kernel,@function
sequential_preLN__compressed_kv_cla__moe_arch_mod__prompt_kernel:
    s_cmp_ge_u32 s2, 256
    s_cbranch_scc1 k12_end_1
    s_load_dwordx4 s[36:39], s[0:1], 0
    s_load_dwordx4 s[40:43], s[0:1], 24
    s_load_dwordx2 s[4:5], s[0:1], 16
    s_load_dwordx4 s[60:63], s[0:1], 96
    s_lshr_b32 s59, s2, 3
    s_lshl_b32 s58, s59, 4
    v_add_u32 v6, s58, v0
    v_cmp_gt_u32 vcc, 48, v0
    v_cmp_gt_u32 s[56:57], 64, v0
    s_nop 0
    v_cndmask_b32 v6, v6, v0, vcc
    s_getpc_b64 s[52:53]
pc_2:
    s_add_u32 s52, s52, k12_code0-pc_2
    s_addc_u32 s53, s53, 0
    v_lshlrev_b32 v58, 7, v6
    v_mov_b32 v59, s53
    v_add_co_u32 v58, vcc, s52, v58
    s_nop 1
    v_addc_co_u32 v59, vcc, 0, v59, vcc
k12_code0:
    s_mov_b64 exec, s[56:57]
    s_cbranch_execz k12_nocode_3
    global_load_dword v51, v[58:59], off
k12_nocode_3:
    s_mov_b64 exec, -1
    s_and_b32 s58, s2, 7
    s_lshr_b32 s59, s2, 3
    s_and_b32 s45, s59, 7
    s_lshr_b32 s57, s59, 3
    s_and_b32 s44, s57, 1
    s_lshl_b32 s52, s58, 1
    s_add_u32 s44, s44, s52
    s_lshr_b32 s57, s57, 1
    v_lshrrev_b32 v2, 6, v0
    v_and_b32 v3, 63, v0
    v_readfirstlane_b32 s30, v2
    v_lshlrev_b32 v1, 4, v3
    v_lshrrev_b32 v60, 5, v3
    v_lshl_add_u32 v60, v2, 1, v60
    v_and_b32 v61, 31, v3
    v_lshlrev_b32 v6, 11, v60
    v_lshl_add_u32 v62, v61, 4, v6
    s_lshl_b32 s52, s2, 14
    v_lshrrev_b32 v56, 3, v3
    v_and_b32 v57, 7, v3
    v_lshrrev_b32 v58, 1, v56
    v_xor_b32 v6, v57, v58
    v_xor_b32 v7, 4, v6
    v_lshl_add_u32 v58, v2, 6, v56
    v_lshlrev_b32 v58, 10, v58
    s_lshl_b32 s47, s45, 18
    v_add_u32 v58, s47, v58
    v_lshl_add_u32 v10, v6, 4, v58
    v_lshl_add_u32 v11, v7, 4, v58
    v_add_u32 v17, 54272, v11
    v_add_u32 v16, 47104, v10
    v_add_u32 v15, 39936, v11
    v_add_u32 v14, 32768, v10
    v_add_u32 v13, 21504, v11
    v_add_u32 v12, 14336, v10
    v_add_u32 v11, 7168, v11
    v_add_u32 v10, 0, v10
    v_lshrrev_b32 v6, 5, v3
    v_bfe_u32 v7, v3, 1, 4
    v_and_b32 v59, 1, v3
    v_lshl_add_u32 v58, v2, 4, v6
    v_lshlrev_b32 v58, 13, v58
    v_lshl_add_u32 v58, v59, 4, v58
    s_lshl_b32 s47, s44, 9
    v_add_u32 v58, s47, v58
    v_xor_b32 v7, v7, v6
    v_xor_b32 v6, 0, v7
    v_lshl_add_u32 v6, v6, 5, v58
    v_add_u32 v18, 0, v6
    v_xor_b32 v6, 2, v7
    v_lshl_add_u32 v6, v6, 5, v58
    v_add_u32 v19, 15360, v6
    v_xor_b32 v6, 0, v7
    v_lshl_add_u32 v6, v6, 5, v58
    v_add_u32 v20, 30720, v6
    v_xor_b32 v6, 2, v7
    v_lshl_add_u32 v6, v6, 5, v58
    v_add_u32 v21, 46080, v6
    v_xor_b32 v6, 4, v7
    v_lshl_add_u32 v6, v6, 5, v58
    v_add_u32 v22, 65536, v6
    v_xor_b32 v6, 6, v7
    v_lshl_add_u32 v6, v6, 5, v58
    v_add_u32 v23, 80896, v6
    v_xor_b32 v6, 4, v7
    v_lshl_add_u32 v6, v6, 5, v58
    v_add_u32 v24, 96256, v6
    v_xor_b32 v6, 6, v7
    v_lshl_add_u32 v6, v6, 5, v58
    v_add_u32 v25, 111616, v6
    s_lshl_b32 s48, s30, 13
    s_mov_b32 s49, 0
    s_mov_b32 s50, 0
    s_waitcnt lgkmcnt(0)
    s_mov_b32 s24, s36
    s_and_b32 s25, s37, 0xffff
    s_mov_b32 s26, 0x400000
    s_mov_b32 s27, 0x00020000
    buffer_load_dwordx4 v[64:67], v62, s[24:27], s52 offen offset:0
    buffer_load_dwordx4 v[68:71], v62, s[24:27], s52 offen offset:512
    buffer_load_dwordx4 v[72:75], v62, s[24:27], s52 offen offset:1024
    buffer_load_dwordx4 v[76:79], v62, s[24:27], s52 offen offset:1536
    s_mov_b32 s16, s38
    s_and_b32 s17, s39, 0xffff
    s_mov_b32 s18, 0x200000
    s_mov_b32 s19, 0x00020000
    s_cmp_eq_u32 s57, 0
    s_cselect_b32 s20, s40, s42
    s_cselect_b32 s21, s41, s43
    s_and_b32 s21, s21, 0xffff
    s_mov_b32 s22, 0x400000
    s_mov_b32 s23, 0x00020000
    s_add_u32 m0, s48, 0
    s_nop 0
    buffer_load_dwordx4 v10, s[16:19], s49 offen offset:0 lds
    buffer_load_dwordx4 v11, s[16:19], s49 offen offset:1024 lds
    buffer_load_dwordx4 v12, s[16:19], s49 offen offset:2048 lds
    buffer_load_dwordx4 v13, s[16:19], s49 offen offset:3072 lds
    s_add_u32 m0, s48, 65536
    s_nop 0
    buffer_load_dwordx4 v18, s[20:23], s50 offen offset:0 lds
    buffer_load_dwordx4 v19, s[20:23], s50 offen offset:1024 lds
    buffer_load_dwordx4 v20, s[20:23], s50 offen offset:2048 lds
    buffer_load_dwordx4 v21, s[20:23], s50 offen offset:3072 lds
    s_mov_b64 s[6:7], s[62:63]
    s_add_u32 s8, s6, 0x0
    s_addc_u32 s9, s7, 0
    s_and_b32 s9, s9, 0xffff
    s_mov_b32 s10, 0x400000
    s_mov_b32 s11, 0x00020000
    s_mov_b32 s12, s4
    s_and_b32 s13, s5, 0xffff
    s_mov_b32 s14, 0x800000
    s_mov_b32 s15, 0x00020000
    s_add_u32 s32, s6, 0x1000000
    s_addc_u32 s33, s7, 0
    s_and_b32 s33, s33, 0xffff
    s_mov_b32 s34, 0x2000000
    s_mov_b32 s35, 0x00020000
    s_mov_b32 s24, s60
    s_and_b32 s25, s61, 0xffff
    s_mov_b32 s26, 0x100
    s_mov_b32 s27, 0x00020000
    s_lshl_b32 s28, s58, 2
    s_and_b32 s31, s59, 3
    s_add_u32 s28, s28, s31
    s_lshr_b32 s29, s59, 2
    s_lshl_b32 s42, s29, 7
    s_sub_u32 s43, 1920, s42
    s_lshl_b32 s31, s30, 4
    s_add_u32 s38, s42, s31
    s_add_u32 s39, s43, s31
    s_lshl_b32 s60, s30, 12
    s_mov_b32 s61, 0
    s_mov_b32 s62, 0
    s_lshl_b32 s47, s44, 1
    s_lshr_b32 s52, s30, 1
    s_add_u32 s47, s47, s52
    s_lshl_b32 s47, s47, 14
    s_lshl_b32 s52, s45, 1
    s_and_b32 s53, s30, 1
    s_add_u32 s52, s52, s53
    s_lshl_b32 s52, s52, 20
    s_add_u32 s47, s47, s52
    s_lshl_b32 s52, s57, 24
    s_add_u32 s47, s47, s52
    s_lshl_b32 s54, s44, 8
    s_lshr_b32 s55, s28, 1
    s_lshl_b32 s55, s55, 8
    s_and_b32 s53, s59, 3
    s_add_u32 s53, s53, 1
    s_cmp_eq_u32 s30, 0
    s_cselect_b32 s53, s53, -1
    s_cselect_b32 s46, 6, -1
    v_lshlrev_b32 v6, 13, v56
    v_lshl_add_u32 v50, v57, 7, v6
    s_lshl_b32 s56, s30, 5
    s_add_u32 s56, s56, s59
    s_lshl_b32 s56, s56, 16
    s_lshl_b32 s52, s58, 10
    s_add_u32 s56, s56, s52
    s_add_u32 s63, s30, 1
    v_mul_u32_u24 v6, 2064, v60
    v_lshl_add_u32 v6, v61, 4, v6
    v_add_u32 v54, 131072, v6
    v_mul_u32_u24 v7, 2064, v57
    v_lshl_add_u32 v7, v56, 4, v7
    v_lshl_add_u32 v7, v2, 9, v7
    v_add_u32 v55, 131072, v7
    v_lshrrev_b32 v7, 2, v56
    v_lshl_add_u32 v7, v2, 3, v7
    v_lshlrev_b32 v7, 17, v7
    v_and_b32 v6, 3, v56
    v_lshl_add_u32 v7, v6, 8, v7
    v_lshl_add_u32 v7, v57, 4, v7
    s_lshr_b32 s52, s2, 1
    s_lshl_b32 s52, s52, 10
    s_and_b32 s31, s2, 1
    s_lshl_b32 s31, s31, 7
    s_add_u32 s52, s52, s31
    v_add_u32 v53, s52, v7
    v_and_b32 v56, 15, v3
    v_lshrrev_b32 v57, 4, v3
    v_lshrrev_b32 v6, 1, v56
    v_xor_b32 v6, v6, v57
    v_and_b32 v7, 1, v2
    v_lshl_add_u32 v7, v7, 7, v56
    v_lshlrev_b32 v7, 7, v7
    v_lshl_add_u32 v26, v6, 4, v7
    v_xor_b32 v27, 64, v26
    v_lshrrev_b32 v6, 2, v56
    v_and_b32 v58, 1, v57
    v_lshl_add_u32 v58, v58, 2, v6
    v_lshl_add_u32 v59, v57, 3, v6
    v_and_b32 v63, 3, v3
    v_lshlrev_b32 v7, 9, v59
    v_lshrrev_b32 v6, 1, v2
    v_lshl_add_u32 v7, v6, 8, v7
    v_lshl_add_u32 v7, v63, 3, v7
    v_add_u32 v7, 65536, v7
    v_lshlrev_b32 v59, 8, v59
    v_lshl_add_u32 v59, v63, 3, v59
    v_add_u32 v59, 98304, v59
    v_xor_b32 v6, 0, v58
    v_lshl_add_u32 v28, v6, 5, v7
    v_lshl_add_u32 v42, v6, 5, v59
    v_xor_b32 v6, 1, v58
    v_lshl_add_u32 v29, v6, 5, v7
    v_lshl_add_u32 v43, v6, 5, v59
    v_xor_b32 v6, 2, v58
    v_lshl_add_u32 v30, v6, 5, v7
    v_lshl_add_u32 v44, v6, 5, v59
    v_xor_b32 v6, 3, v58
    v_lshl_add_u32 v31, v6, 5, v7
    v_lshl_add_u32 v45, v6, 5, v59
    v_xor_b32 v6, 4, v58
    v_lshl_add_u32 v32, v6, 5, v7
    v_lshl_add_u32 v46, v6, 5, v59
    v_xor_b32 v6, 5, v58
    v_lshl_add_u32 v33, v6, 5, v7
    v_lshl_add_u32 v47, v6, 5, v59
    v_xor_b32 v6, 6, v58
    v_lshl_add_u32 v34, v6, 5, v7
    v_lshl_add_u32 v48, v6, 5, v59
    v_xor_b32 v6, 7, v58
    v_lshl_add_u32 v35, v6, 5, v7
    v_lshl_add_u32 v49, v6, 5, v59
    s_lshl_b32 s31, s38, 6
    v_add_u32 v36, s31, v1
    s_lshl_b32 s31, s39, 6
    v_add_u32 v37, s31, v1
    v_bfe_u32 v6, v3, 1, 3
    v_and_b32 v7, 1, v3
    v_lshl_add_u32 v58, v2, 4, v57
    v_lshlrev_b32 v58, 13, v58
    v_lshl_add_u32 v58, v7, 4, v58
    s_lshl_b32 s31, s28, 8
    v_add_u32 v58, s31, v58
    v_xor_b32 v6, v6, v57
    v_xor_b32 v7, 0, v6
    v_lshl_add_u32 v7, v7, 5, v58
    v_add_u32 v38, 0, v7
    v_xor_b32 v7, 0, v6
    v_lshl_add_u32 v7, v7, 5, v58
    v_add_u32 v39, 31744, v7
    v_xor_b32 v7, 4, v6
    v_lshl_add_u32 v7, v7, 5, v58
    v_add_u32 v40, 63488, v7
    v_xor_b32 v7, 4, v6
    v_lshl_add_u32 v7, v7, 5, v58
    v_add_u32 v41, 95232, v7
    v_lshlrev_b32 v6, 2, v57
    v_sub_u32 v4, v56, v6
    v_mov_b32 v5, 0xff800000
    v_mov_b32 v8, 0
    v_mov_b32 v9, 1
    s_lshl_b32 s52, s59, 2
    s_add_u32 s52, s52, s30
    v_and_b32 v6, 1, v3
    v_lshl_add_u32 v6, s52, 1, v6
    s_getpc_b64 s[40:41]
pc_4:
    s_add_u32 s40, s40, k12_qcode-pc_4
    s_addc_u32 s41, s41, 0
    v_lshlrev_b32 v2, 7, v6
    v_mov_b32 v3, s41
    v_add_co_u32 v2, vcc, s40, v2
    s_nop 1
    v_addc_co_u32 v3, vcc, 0, v3, vcc
    v_mov_b32 v56, 0
    v_mov_b32 v57, 0
    v_mov_b32 v58, 0
    v_mov_b32 v59, 0
    s_nop 1
    v_mfma_f32_32x32x16_bf16 a[128:143], v[56:59], v[56:59], 0
    v_mfma_f32_32x32x16_bf16 a[144:159], v[56:59], v[56:59], 0
    v_mfma_f32_32x32x16_bf16 a[160:175], v[56:59], v[56:59], 0
    v_mfma_f32_32x32x16_bf16 a[176:191], v[56:59], v[56:59], 0
    v_mfma_f32_32x32x16_bf16 v[128:143], v[56:59], v[56:59], 0
    v_mfma_f32_32x32x16_bf16 v[144:159], v[56:59], v[56:59], 0
    v_mfma_f32_32x32x16_bf16 v[160:175], v[56:59], v[56:59], 0
    v_mfma_f32_32x32x16_bf16 v[176:191], v[56:59], v[56:59], 0
    v_mfma_f32_32x32x16_bf16 v[192:207], v[56:59], v[56:59], 0
    v_mfma_f32_32x32x16_bf16 v[208:223], v[56:59], v[56:59], 0
    v_mfma_f32_32x32x16_bf16 v[224:239], v[56:59], v[56:59], 0
    v_mfma_f32_32x32x16_bf16 v[240:255], v[56:59], v[56:59], 0
    s_add_u32 m0, s48, 4096
    s_nop 0
    buffer_load_dwordx4 v14, s[16:19], s49 offen offset:0 lds
    buffer_load_dwordx4 v15, s[16:19], s49 offen offset:1024 lds
    buffer_load_dwordx4 v16, s[16:19], s49 offen offset:2048 lds
    buffer_load_dwordx4 v17, s[16:19], s49 offen offset:3072 lds
    s_add_u32 s49, s49, 128
    s_add_u32 m0, s48, 69632
    s_nop 0
    buffer_load_dwordx4 v22, s[20:23], s50 offen offset:0 lds
    buffer_load_dwordx4 v23, s[20:23], s50 offen offset:1024 lds
    buffer_load_dwordx4 v24, s[20:23], s50 offen offset:2048 lds
    buffer_load_dwordx4 v25, s[20:23], s50 offen offset:3072 lds
    s_add_u32 s50, s50, 0x80000
    s_waitcnt vmcnt(16)
    v_lshlrev_b32 v80, 16, v64
    v_and_b32 v81, 0xffff0000, v64
    v_lshlrev_b32 v82, 16, v65
    v_and_b32 v83, 0xffff0000, v65
    v_lshlrev_b32 v84, 16, v66
    v_and_b32 v85, 0xffff0000, v66
    v_lshlrev_b32 v86, 16, v67
    v_and_b32 v87, 0xffff0000, v67
    v_lshlrev_b32 v88, 16, v68
    v_and_b32 v89, 0xffff0000, v68
    v_lshlrev_b32 v90, 16, v69
    v_and_b32 v91, 0xffff0000, v69
    v_lshlrev_b32 v92, 16, v70
    v_and_b32 v93, 0xffff0000, v70
    v_lshlrev_b32 v94, 16, v71
    v_and_b32 v95, 0xffff0000, v71
    v_lshlrev_b32 v96, 16, v72
    v_and_b32 v97, 0xffff0000, v72
    v_lshlrev_b32 v98, 16, v73
    v_and_b32 v99, 0xffff0000, v73
    v_lshlrev_b32 v100, 16, v74
    v_and_b32 v101, 0xffff0000, v74
    v_lshlrev_b32 v102, 16, v75
    v_and_b32 v103, 0xffff0000, v75
    v_lshlrev_b32 v104, 16, v76
    v_and_b32 v105, 0xffff0000, v76
    v_lshlrev_b32 v106, 16, v77
    v_and_b32 v107, 0xffff0000, v77
    v_lshlrev_b32 v108, 16, v78
    v_and_b32 v109, 0xffff0000, v78
    v_lshlrev_b32 v110, 16, v79
    v_and_b32 v111, 0xffff0000, v79
    v_pk_add_f32 v[112:113], v[80:81], v[82:83]
    v_pk_add_f32 v[114:115], v[84:85], v[86:87]
    v_pk_add_f32 v[112:113], v[112:113], v[88:89]
    v_pk_add_f32 v[114:115], v[114:115], v[90:91]
    v_pk_add_f32 v[112:113], v[112:113], v[92:93]
    v_pk_add_f32 v[114:115], v[114:115], v[94:95]
    v_pk_add_f32 v[112:113], v[112:113], v[96:97]
    v_pk_add_f32 v[114:115], v[114:115], v[98:99]
    v_pk_add_f32 v[112:113], v[112:113], v[100:101]
    v_pk_add_f32 v[114:115], v[114:115], v[102:103]
    v_pk_add_f32 v[112:113], v[112:113], v[104:105]
    v_pk_add_f32 v[114:115], v[114:115], v[106:107]
    s_add_u32 m0, s48, 32768
    s_nop 0
    buffer_load_dwordx4 v10, s[16:19], s49 offen offset:0 lds
    buffer_load_dwordx4 v11, s[16:19], s49 offen offset:1024 lds
    buffer_load_dwordx4 v12, s[16:19], s49 offen offset:2048 lds
    buffer_load_dwordx4 v13, s[16:19], s49 offen offset:3072 lds
    v_pk_add_f32 v[112:113], v[112:113], v[108:109]
    v_pk_add_f32 v[114:115], v[114:115], v[110:111]
    v_pk_add_f32 v[112:113], v[112:113], v[114:115]
    v_add_f32 v112, v112, v113
    s_nop 1
    v_add_f32_dpp v112, v112, v112 quad_perm:[1,0,3,2] row_mask:0xf bank_mask:0xf
    s_nop 1
    v_add_f32_dpp v112, v112, v112 quad_perm:[2,3,0,1] row_mask:0xf bank_mask:0xf
    s_nop 1
    v_add_f32_dpp v112, v112, v112 row_half_mirror row_mask:0xf bank_mask:0xf
    s_nop 1
    v_add_f32_dpp v112, v112, v112 row_mirror row_mask:0xf bank_mask:0xf
    v_mov_b32 v114, v112
    s_nop 1
    v_permlane16_swap_b32 v112, v114
    s_nop 1
    v_add_f32 v112, v112, v114
    v_mul_f32 v112, 0xba800000, v112
    v_mov_b32 v113, v112
    v_pk_add_f32 v[114:115], v[80:81], v[112:113]
    v_pk_add_f32 v[118:119], v[82:83], v[112:113]
    v_pk_mul_f32 v[116:117], v[114:115], v[114:115]
    v_pk_fma_f32 v[116:117], v[118:119], v[118:119], v[116:117]
    v_pk_add_f32 v[114:115], v[84:85], v[112:113]
    v_pk_add_f32 v[118:119], v[86:87], v[112:113]
    v_pk_fma_f32 v[116:117], v[114:115], v[114:115], v[116:117]
    v_pk_fma_f32 v[116:117], v[118:119], v[118:119], v[116:117]
    v_pk_add_f32 v[114:115], v[88:89], v[112:113]
    v_pk_add_f32 v[118:119], v[90:91], v[112:113]
    v_pk_fma_f32 v[116:117], v[114:115], v[114:115], v[116:117]
    v_pk_fma_f32 v[116:117], v[118:119], v[118:119], v[116:117]
    v_pk_add_f32 v[114:115], v[92:93], v[112:113]
    v_pk_add_f32 v[118:119], v[94:95], v[112:113]
    v_pk_fma_f32 v[116:117], v[114:115], v[114:115], v[116:117]
    v_pk_fma_f32 v[116:117], v[118:119], v[118:119], v[116:117]
    v_pk_add_f32 v[114:115], v[96:97], v[112:113]
    v_pk_add_f32 v[118:119], v[98:99], v[112:113]
    v_pk_fma_f32 v[116:117], v[114:115], v[114:115], v[116:117]
    v_pk_fma_f32 v[116:117], v[118:119], v[118:119], v[116:117]
    v_pk_add_f32 v[114:115], v[100:101], v[112:113]
    v_pk_add_f32 v[118:119], v[102:103], v[112:113]
    v_pk_fma_f32 v[116:117], v[114:115], v[114:115], v[116:117]
    v_pk_fma_f32 v[116:117], v[118:119], v[118:119], v[116:117]
    v_pk_add_f32 v[114:115], v[104:105], v[112:113]
    s_add_u32 m0, s48, 98304
    s_nop 0
    buffer_load_dwordx4 v18, s[20:23], s50 offen offset:0 lds
    buffer_load_dwordx4 v19, s[20:23], s50 offen offset:1024 lds
    buffer_load_dwordx4 v20, s[20:23], s50 offen offset:2048 lds
    buffer_load_dwordx4 v21, s[20:23], s50 offen offset:3072 lds
    v_pk_add_f32 v[118:119], v[106:107], v[112:113]
    v_pk_fma_f32 v[116:117], v[114:115], v[114:115], v[116:117]
    v_pk_fma_f32 v[116:117], v[118:119], v[118:119], v[116:117]
    v_pk_add_f32 v[114:115], v[108:109], v[112:113]
    v_pk_add_f32 v[118:119], v[110:111], v[112:113]
    v_pk_fma_f32 v[116:117], v[114:115], v[114:115], v[116:117]
    v_pk_fma_f32 v[116:117], v[118:119], v[118:119], v[116:117]
    v_add_f32 v116, v116, v117
    s_nop 1
    v_add_f32_dpp v116, v116, v116 quad_perm:[1,0,3,2] row_mask:0xf bank_mask:0xf
    s_nop 1
    v_add_f32_dpp v116, v116, v116 quad_perm:[2,3,0,1] row_mask:0xf bank_mask:0xf
    s_nop 1
    v_add_f32_dpp v116, v116, v116 row_half_mirror row_mask:0xf bank_mask:0xf
    s_nop 1
    v_add_f32_dpp v116, v116, v116 row_mirror row_mask:0xf bank_mask:0xf
    v_mov_b32 v114, v116
    s_nop 1
    v_permlane16_swap_b32 v116, v114
    s_nop 1
    v_add_f32 v116, v116, v114
    v_mul_f32 v116, 0x3a800000, v116
    v_cvt_pk_bf16_f32 v118, v112, v116
    v_and_b32 v116, 0xffff0000, v118
    v_lshlrev_b32 v118, 16, v118
    v_add_f32 v116, 0x3727c5ac, v116
    v_mov_b32 v119, v118
    v_cvt_pk_bf16_f32 v116, v116, v116
    v_and_b32 v116, 0xffff0000, v116
    v_sqrt_f32 v116, v116
    v_pk_add_f32 v[80:81], v[80:81], v[118:119]
    v_pk_add_f32 v[82:83], v[82:83], v[118:119]
    v_pk_add_f32 v[84:85], v[84:85], v[118:119]
    v_pk_add_f32 v[86:87], v[86:87], v[118:119]
    v_pk_add_f32 v[88:89], v[88:89], v[118:119]
    v_pk_add_f32 v[90:91], v[90:91], v[118:119]
    v_pk_add_f32 v[92:93], v[92:93], v[118:119]
    v_pk_add_f32 v[94:95], v[94:95], v[118:119]
    v_pk_add_f32 v[96:97], v[96:97], v[118:119]
    v_pk_add_f32 v[98:99], v[98:99], v[118:119]
    v_pk_add_f32 v[100:101], v[100:101], v[118:119]
    v_pk_add_f32 v[102:103], v[102:103], v[118:119]
    v_pk_add_f32 v[104:105], v[104:105], v[118:119]
    s_add_u32 m0, s48, 36864
    s_nop 0
    buffer_load_dwordx4 v14, s[16:19], s49 offen offset:0 lds
    buffer_load_dwordx4 v15, s[16:19], s49 offen offset:1024 lds
    buffer_load_dwordx4 v16, s[16:19], s49 offen offset:2048 lds
    buffer_load_dwordx4 v17, s[16:19], s49 offen offset:3072 lds
    s_add_u32 s49, s49, 128
    v_pk_add_f32 v[106:107], v[106:107], v[118:119]
    v_pk_add_f32 v[108:109], v[108:109], v[118:119]
    v_pk_add_f32 v[110:111], v[110:111], v[118:119]
    v_cvt_pk_bf16_f32 v116, v116, v116
    v_and_b32 v116, 0xffff0000, v116
    v_rcp_f32 v116, v116
    v_cvt_pk_bf16_f32 v64, v80, v81
    v_cvt_pk_bf16_f32 v65, v82, v83
    v_cvt_pk_bf16_f32 v66, v84, v85
    v_cvt_pk_bf16_f32 v67, v86, v87
    v_cvt_pk_bf16_f32 v68, v88, v89
    v_cvt_pk_bf16_f32 v69, v90, v91
    v_cvt_pk_bf16_f32 v70, v92, v93
    v_cvt_pk_bf16_f32 v71, v94, v95
    v_cvt_pk_bf16_f32 v72, v96, v97
    v_cvt_pk_bf16_f32 v73, v98, v99
    v_cvt_pk_bf16_f32 v74, v100, v101
    v_cvt_pk_bf16_f32 v75, v102, v103
    v_cvt_pk_bf16_f32 v76, v104, v105
    v_cvt_pk_bf16_f32 v77, v106, v107
    v_cvt_pk_bf16_f32 v78, v108, v109
    v_cvt_pk_bf16_f32 v79, v110, v111
    v_mov_b32 v117, v116
    v_lshlrev_b32 v80, 16, v64
    v_and_b32 v81, 0xffff0000, v64
    v_lshlrev_b32 v82, 16, v65
    v_and_b32 v83, 0xffff0000, v65
    v_lshlrev_b32 v84, 16, v66
    v_and_b32 v85, 0xffff0000, v66
    v_lshlrev_b32 v86, 16, v67
    v_and_b32 v87, 0xffff0000, v67
    v_lshlrev_b32 v88, 16, v68
    v_and_b32 v89, 0xffff0000, v68
    v_lshlrev_b32 v90, 16, v69
    v_and_b32 v91, 0xffff0000, v69
    v_lshlrev_b32 v92, 16, v70
    v_and_b32 v93, 0xffff0000, v70
    v_lshlrev_b32 v94, 16, v71
    v_and_b32 v95, 0xffff0000, v71
    v_lshlrev_b32 v96, 16, v72
    v_and_b32 v97, 0xffff0000, v72
    v_lshlrev_b32 v98, 16, v73
    v_and_b32 v99, 0xffff0000, v73
    v_lshlrev_b32 v100, 16, v74
    s_add_u32 m0, s48, 102400
    s_nop 0
    buffer_load_dwordx4 v22, s[20:23], s50 offen offset:0 lds
    buffer_load_dwordx4 v23, s[20:23], s50 offen offset:1024 lds
    buffer_load_dwordx4 v24, s[20:23], s50 offen offset:2048 lds
    buffer_load_dwordx4 v25, s[20:23], s50 offen offset:3072 lds
    s_add_u32 s50, s50, 0x80000
    v_and_b32 v101, 0xffff0000, v74
    v_lshlrev_b32 v102, 16, v75
    v_and_b32 v103, 0xffff0000, v75
    v_lshlrev_b32 v104, 16, v76
    v_and_b32 v105, 0xffff0000, v76
    v_lshlrev_b32 v106, 16, v77
    v_and_b32 v107, 0xffff0000, v77
    v_lshlrev_b32 v108, 16, v78
    v_and_b32 v109, 0xffff0000, v78
    v_lshlrev_b32 v110, 16, v79
    v_and_b32 v111, 0xffff0000, v79
    v_pk_mul_f32 v[80:81], v[80:81], v[116:117]
    v_pk_mul_f32 v[82:83], v[82:83], v[116:117]
    v_pk_mul_f32 v[84:85], v[84:85], v[116:117]
    v_pk_mul_f32 v[86:87], v[86:87], v[116:117]
    v_pk_mul_f32 v[88:89], v[88:89], v[116:117]
    v_pk_mul_f32 v[90:91], v[90:91], v[116:117]
    v_pk_mul_f32 v[92:93], v[92:93], v[116:117]
    v_pk_mul_f32 v[94:95], v[94:95], v[116:117]
    v_pk_mul_f32 v[96:97], v[96:97], v[116:117]
    v_pk_mul_f32 v[98:99], v[98:99], v[116:117]
    v_pk_mul_f32 v[100:101], v[100:101], v[116:117]
    v_pk_mul_f32 v[102:103], v[102:103], v[116:117]
    v_pk_mul_f32 v[104:105], v[104:105], v[116:117]
    v_pk_mul_f32 v[106:107], v[106:107], v[116:117]
    v_pk_mul_f32 v[108:109], v[108:109], v[116:117]
    v_pk_mul_f32 v[110:111], v[110:111], v[116:117]
    v_cvt_pk_bf16_f32 v64, v80, v81
    v_cvt_pk_bf16_f32 v65, v82, v83
    v_cvt_pk_bf16_f32 v66, v84, v85
    v_cvt_pk_bf16_f32 v67, v86, v87
    v_cvt_pk_bf16_f32 v68, v88, v89
    v_cvt_pk_bf16_f32 v69, v90, v91
    v_cvt_pk_bf16_f32 v70, v92, v93
    v_cvt_pk_bf16_f32 v71, v94, v95
    v_cvt_pk_bf16_f32 v72, v96, v97
    v_cvt_pk_bf16_f32 v73, v98, v99
    v_cvt_pk_bf16_f32 v74, v100, v101
    v_cvt_pk_bf16_f32 v75, v102, v103
    v_cvt_pk_bf16_f32 v76, v104, v105
    v_cvt_pk_bf16_f32 v77, v106, v107
    v_cvt_pk_bf16_f32 v78, v108, v109
    v_cvt_pk_bf16_f32 v79, v110, v111
    ds_write_b128 v54, v[64:67] offset:0
    ds_write_b128 v54, v[68:71] offset:512
    ds_write_b128 v54, v[72:75] offset:1024
    ds_write_b128 v54, v[76:79] offset:1536
    s_waitcnt vmcnt(16) lgkmcnt(0)
    s_barrier
    ds_read_b128 a[64:67], v55 offset:0
    ds_read_b128 a[68:71], v55 offset:128
    ds_read_b128 a[72:75], v55 offset:256
    ds_read_b128 a[76:79], v55 offset:384
    v_add_u32 v54, 4096, v36
    v_add_u32 v55, 4096, v37
    v_mfma_f32_32x32x16_bf16 v[64:79], v[56:59], v[56:59], 0
    v_mfma_f32_32x32x16_bf16 v[80:95], v[56:59], v[56:59], 0
    v_mfma_f32_32x32x16_bf16 v[96:111], v[56:59], v[56:59], 0
    v_mfma_f32_32x32x16_bf16 v[112:127], v[56:59], v[56:59], 0
    s_cmp_ge_u32 s2, 22
    s_cbranch_scc1 k12_nostat_5
    s_lshl_b32 s52, s2, 12
    s_add_u32 s52, s52, 0x3800000
    s_mov_b32 s34, -1
    v_lshlrev_b32 v6, 4, v0
    buffer_store_dwordx4 v[56:59], v6, s[32:35], s52 offen sc1
    s_mov_b32 s34, 0x2000000
k12_nostat_5:
    ds_read_b128 a[192:195], v26 offset:0
    ds_read_b64_tr_b16 a[0:1], v28 offset:0
    ds_read_b128 a[196:199], v27 offset:0
    ds_read_b64_tr_b16 a[2:3], v28 offset:2048
    ds_read_b128 a[200:203], v26 offset:2048
    ds_read_b64_tr_b16 a[4:5], v28 offset:16384
    ds_read_b128 a[204:207], v27 offset:2048
    ds_read_b64_tr_b16 a[6:7], v28 offset:18432
    ds_read_b128 a[208:211], v26 offset:4096
    ds_read_b64_tr_b16 a[8:9], v29 offset:0
    ds_read_b128 a[212:215], v27 offset:4096
    ds_read_b64_tr_b16 a[10:11], v29 offset:2048
    ds_read_b128 a[216:219], v26 offset:6144
    ds_read_b64_tr_b16 a[12:13], v29 offset:16384
    ds_read_b128 a[220:223], v27 offset:6144
    ds_read_b64_tr_b16 a[14:15], v29 offset:18432
    ds_read_b128 a[224:227], v26 offset:8192
    ds_read_b64_tr_b16 a[16:17], v30 offset:0
    ds_read_b128 a[228:231], v27 offset:8192
    ds_read_b64_tr_b16 a[18:19], v30 offset:2048
    ds_read_b128 a[232:235], v26 offset:10240
    ds_read_b64_tr_b16 a[20:21], v30 offset:16384
    ds_read_b128 a[236:239], v27 offset:10240
    ds_read_b64_tr_b16 a[22:23], v30 offset:18432
    ds_read_b128 a[240:243], v26 offset:12288
    ds_read_b64_tr_b16 a[24:25], v31 offset:0
    ds_read_b128 a[244:247], v27 offset:12288
    ds_read_b64_tr_b16 a[26:27], v31 offset:2048
    ds_read_b128 a[248:251], v26 offset:14336
    ds_read_b64_tr_b16 a[28:29], v31 offset:16384
    ds_read_b128 a[252:255], v27 offset:14336
    ds_read_b64_tr_b16 a[30:31], v31 offset:18432
    s_mov_b32 s51, 0
    s_waitcnt lgkmcnt(15)
    s_mov_b32 s52, 0
    buffer_store_dwordx4 a[64:67], v53, s[8:11], s52 offen sc1
    s_mov_b32 s52, 262144
    buffer_store_dwordx4 a[68:71], v53, s[8:11], s52 offen sc1
    s_mov_b32 s52, 524288
    buffer_store_dwordx4 a[72:75], v53, s[8:11], s52 offen sc1
    s_mov_b32 s52, 786432
    buffer_store_dwordx4 a[76:79], v53, s[8:11], s52 offen sc1
    s_waitcnt lgkmcnt(0)
    s_cmp_lg_u32 s57, 0
    s_cbranch_scc1 k12_v_6
k12_loop_8:
    v_mfma_f32_16x16x32_bf16 v[64:67], a[0:3], a[192:195], v[64:67]
    v_mfma_f32_16x16x32_bf16 v[64:67], a[4:7], a[196:199], v[64:67]
    ds_read_b64_tr_b16 a[32:33], v32 offset:0
    v_mfma_f32_16x16x32_bf16 v[80:83], a[0:3], a[200:203], v[80:83]
    v_mfma_f32_16x16x32_bf16 v[80:83], a[4:7], a[204:207], v[80:83]
    ds_read_b64_tr_b16 a[34:35], v32 offset:2048
    v_mfma_f32_16x16x32_bf16 v[96:99], a[0:3], a[208:211], v[96:99]
    s_cmp_eq_u32 s51, s46
    s_cbranch_scc1 k12_ool_10
k12_oolret_11:
    v_mfma_f32_16x16x32_bf16 v[96:99], a[4:7], a[212:215], v[96:99]
    v_mfma_f32_16x16x32_bf16 v[112:115], a[0:3], a[216:219], v[112:115]
    ds_read_b64_tr_b16 a[36:37], v32 offset:16384
    v_mfma_f32_16x16x32_bf16 v[112:115], a[4:7], a[220:223], v[112:115]
    v_mfma_f32_16x16x32_bf16 v[128:131], a[0:3], a[224:227], v[128:131]
    v_mfma_f32_16x16x32_bf16 v[128:131], a[4:7], a[228:231], v[128:131]
    ds_read_b64_tr_b16 a[38:39], v32 offset:18432
    v_mfma_f32_16x16x32_bf16 v[144:147], a[0:3], a[232:235], v[144:147]
    v_mfma_f32_16x16x32_bf16 v[144:147], a[4:7], a[236:239], v[144:147]
    v_mfma_f32_16x16x32_bf16 a[128:131], a[0:3], a[240:243], a[128:131]
    ds_read_b64_tr_b16 a[40:41], v33 offset:0
    v_mfma_f32_16x16x32_bf16 a[128:131], a[4:7], a[244:247], a[128:131]
    v_mfma_f32_16x16x32_bf16 a[160:163], a[0:3], a[248:251], a[160:163]
    v_mfma_f32_16x16x32_bf16 a[160:163], a[4:7], a[252:255], a[160:163]
    ds_read_b64_tr_b16 a[42:43], v33 offset:2048
    v_mfma_f32_16x16x32_bf16 v[160:163], a[8:11], a[192:195], v[160:163]
    v_mfma_f32_16x16x32_bf16 v[160:163], a[12:15], a[196:199], v[160:163]
    v_mfma_f32_16x16x32_bf16 v[176:179], a[8:11], a[200:203], v[176:179]
    ds_read_b64_tr_b16 a[44:45], v33 offset:16384
    v_mfma_f32_16x16x32_bf16 v[176:179], a[12:15], a[204:207], v[176:179]
    v_mfma_f32_16x16x32_bf16 v[192:195], a[8:11], a[208:211], v[192:195]
    v_mfma_f32_16x16x32_bf16 v[192:195], a[12:15], a[212:215], v[192:195]
    ds_read_b64_tr_b16 a[46:47], v33 offset:18432
    v_mfma_f32_16x16x32_bf16 v[208:211], a[8:11], a[216:219], v[208:211]
    v_mfma_f32_16x16x32_bf16 v[208:211], a[12:15], a[220:223], v[208:211]
    ds_read_b64_tr_b16 a[48:49], v34 offset:0
    v_mfma_f32_16x16x32_bf16 v[224:227], a[8:11], a[224:227], v[224:227]
    v_mfma_f32_16x16x32_bf16 v[224:227], a[12:15], a[228:231], v[224:227]
    v_mfma_f32_16x16x32_bf16 v[240:243], a[8:11], a[232:235], v[240:243]
    ds_read_b64_tr_b16 a[50:51], v34 offset:2048
    v_mfma_f32_16x16x32_bf16 v[240:243], a[12:15], a[236:239], v[240:243]
    v_mfma_f32_16x16x32_bf16 a[132:135], a[8:11], a[240:243], a[132:135]
    v_mfma_f32_16x16x32_bf16 a[132:135], a[12:15], a[244:247], a[132:135]
    ds_read_b64_tr_b16 a[52:53], v34 offset:16384
    v_mfma_f32_16x16x32_bf16 a[164:167], a[8:11], a[248:251], a[164:167]
    v_mfma_f32_16x16x32_bf16 a[164:167], a[12:15], a[252:255], a[164:167]
    v_mfma_f32_16x16x32_bf16 v[68:71], a[16:19], a[192:195], v[68:71]
    ds_read_b64_tr_b16 a[54:55], v34 offset:18432
    v_mfma_f32_16x16x32_bf16 v[68:71], a[20:23], a[196:199], v[68:71]
    v_mfma_f32_16x16x32_bf16 v[84:87], a[16:19], a[200:203], v[84:87]
    v_mfma_f32_16x16x32_bf16 v[84:87], a[20:23], a[204:207], v[84:87]
    ds_read_b64_tr_b16 a[56:57], v35 offset:0
    v_mfma_f32_16x16x32_bf16 v[100:103], a[16:19], a[208:211], v[100:103]
    v_mfma_f32_16x16x32_bf16 v[100:103], a[20:23], a[212:215], v[100:103]
    v_mfma_f32_16x16x32_bf16 v[116:119], a[16:19], a[216:219], v[116:119]
    ds_read_b64_tr_b16 a[58:59], v35 offset:2048
    v_mfma_f32_16x16x32_bf16 v[116:119], a[20:23], a[220:223], v[116:119]
    v_mfma_f32_16x16x32_bf16 v[132:135], a[16:19], a[224:227], v[132:135]
    v_mfma_f32_16x16x32_bf16 v[132:135], a[20:23], a[228:231], v[132:135]
    ds_read_b64_tr_b16 a[60:61], v35 offset:16384
    v_mfma_f32_16x16x32_bf16 v[148:151], a[16:19], a[232:235], v[148:151]
    v_mfma_f32_16x16x32_bf16 v[148:151], a[20:23], a[236:239], v[148:151]
    v_mfma_f32_16x16x32_bf16 a[136:139], a[16:19], a[240:243], a[136:139]
    ds_read_b64_tr_b16 a[62:63], v35 offset:18432
    v_mfma_f32_16x16x32_bf16 a[136:139], a[20:23], a[244:247], a[136:139]
    v_mfma_f32_16x16x32_bf16 a[168:171], a[16:19], a[248:251], a[168:171]
    v_mfma_f32_16x16x32_bf16 a[168:171], a[20:23], a[252:255], a[168:171]
    v_mfma_f32_16x16x32_bf16 v[164:167], a[24:27], a[192:195], v[164:167]
    v_mfma_f32_16x16x32_bf16 v[164:167], a[28:31], a[196:199], v[164:167]
    v_mfma_f32_16x16x32_bf16 v[180:183], a[24:27], a[200:203], v[180:183]
    v_mfma_f32_16x16x32_bf16 v[180:183], a[28:31], a[204:207], v[180:183]
    v_mfma_f32_16x16x32_bf16 v[196:199], a[24:27], a[208:211], v[196:199]
    v_mfma_f32_16x16x32_bf16 v[196:199], a[28:31], a[212:215], v[196:199]
    v_mfma_f32_16x16x32_bf16 v[212:215], a[24:27], a[216:219], v[212:215]
    v_mfma_f32_16x16x32_bf16 v[212:215], a[28:31], a[220:223], v[212:215]
    v_mfma_f32_16x16x32_bf16 v[228:231], a[24:27], a[224:227], v[228:231]
    v_mfma_f32_16x16x32_bf16 v[228:231], a[28:31], a[228:231], v[228:231]
    v_mfma_f32_16x16x32_bf16 v[244:247], a[24:27], a[232:235], v[244:247]
    v_mfma_f32_16x16x32_bf16 v[244:247], a[28:31], a[236:239], v[244:247]
    v_mfma_f32_16x16x32_bf16 a[140:143], a[24:27], a[240:243], a[140:143]
    v_mfma_f32_16x16x32_bf16 a[140:143], a[28:31], a[244:247], a[140:143]
    v_mfma_f32_16x16x32_bf16 a[172:175], a[24:27], a[248:251], a[172:175]
    v_mfma_f32_16x16x32_bf16 a[172:175], a[28:31], a[252:255], a[172:175]
    s_waitcnt vmcnt(0) lgkmcnt(0)
    s_cmp_eq_u32 s51, s46
    s_cbranch_scc1 k12_ool_14
k12_oolret_15:
    s_barrier
    v_mfma_f32_16x16x32_bf16 v[72:75], a[32:35], a[192:195], v[72:75]
    s_cmp_ge_u32 s49, 1024
    s_cselect_b32 s18, 0, s18
    s_cselect_b32 s22, 0, s22
    v_mfma_f32_16x16x32_bf16 v[72:75], a[36:39], a[196:199], v[72:75]
    s_add_u32 m0, s48, 0
    ds_read_b128 a[64:67], v26 offset:32768
    v_mfma_f32_16x16x32_bf16 v[88:91], a[32:35], a[200:203], v[88:91]
    buffer_load_dwordx4 v10, s[16:19], s49 offen offset:0 lds
    ds_read_b64_tr_b16 a[0:1], v28 offset:32768
    v_mfma_f32_16x16x32_bf16 v[88:91], a[36:39], a[204:207], v[88:91]
    ds_read_b128 a[68:71], v27 offset:32768
    v_mfma_f32_16x16x32_bf16 v[104:107], a[32:35], a[208:211], v[104:107]
    buffer_load_dwordx4 v11, s[16:19], s49 offen offset:1024 lds
    v_mfma_f32_16x16x32_bf16 v[104:107], a[36:39], a[212:215], v[104:107]
    ds_read_b64_tr_b16 a[2:3], v28 offset:34816
    v_mfma_f32_16x16x32_bf16 v[120:123], a[32:35], a[216:219], v[120:123]
    v_mfma_f32_16x16x32_bf16 v[120:123], a[36:39], a[220:223], v[120:123]
    ds_read_b128 a[72:75], v26 offset:34816
    v_mfma_f32_16x16x32_bf16 v[136:139], a[32:35], a[224:227], v[136:139]
    buffer_load_dwordx4 v12, s[16:19], s49 offen offset:2048 lds
    ds_read_b64_tr_b16 a[4:5], v28 offset:49152
    v_mfma_f32_16x16x32_bf16 v[136:139], a[36:39], a[228:231], v[136:139]
    v_mfma_f32_16x16x32_bf16 v[152:155], a[32:35], a[232:235], v[152:155]
    ds_read_b128 a[76:79], v27 offset:34816
    v_mfma_f32_16x16x32_bf16 v[152:155], a[36:39], a[236:239], v[152:155]
    buffer_load_dwordx4 v13, s[16:19], s49 offen offset:3072 lds
    v_mfma_f32_16x16x32_bf16 a[144:147], a[32:35], a[240:243], a[144:147]
    ds_read_b64_tr_b16 a[6:7], v28 offset:51200
    v_mfma_f32_16x16x32_bf16 a[144:147], a[36:39], a[244:247], a[144:147]
    s_add_u32 m0, s48, 4096
    ds_read_b128 a[80:83], v26 offset:36864
    v_mfma_f32_16x16x32_bf16 a[176:179], a[32:35], a[248:251], a[176:179]
    v_mfma_f32_16x16x32_bf16 a[176:179], a[36:39], a[252:255], a[176:179]
    buffer_load_dwordx4 v14, s[16:19], s49 offen offset:0 lds
    ds_read_b64_tr_b16 a[8:9], v29 offset:32768
    v_mfma_f32_16x16x32_bf16 v[168:171], a[40:43], a[192:195], v[168:171]
    v_mfma_f32_16x16x32_bf16 v[168:171], a[44:47], a[196:199], v[168:171]
    ds_read_b128 a[84:87], v27 offset:36864
    v_mfma_f32_16x16x32_bf16 v[184:187], a[40:43], a[200:203], v[184:187]
    buffer_load_dwordx4 v15, s[16:19], s49 offen offset:1024 lds
    ds_read_b64_tr_b16 a[10:11], v29 offset:34816
    v_mfma_f32_16x16x32_bf16 v[184:187], a[44:47], a[204:207], v[184:187]
    v_mfma_f32_16x16x32_bf16 v[200:203], a[40:43], a[208:211], v[200:203]
    ds_read_b128 a[88:91], v26 offset:38912
    v_mfma_f32_16x16x32_bf16 v[200:203], a[44:47], a[212:215], v[200:203]
    v_mfma_f32_16x16x32_bf16 v[216:219], a[40:43], a[216:219], v[216:219]
    buffer_load_dwordx4 v16, s[16:19], s49 offen offset:2048 lds
    ds_read_b64_tr_b16 a[12:13], v29 offset:49152
    v_mfma_f32_16x16x32_bf16 v[216:219], a[44:47], a[220:223], v[216:219]
    ds_read_b128 a[92:95], v27 offset:38912
    v_mfma_f32_16x16x32_bf16 v[232:235], a[40:43], a[224:227], v[232:235]
    v_mfma_f32_16x16x32_bf16 v[232:235], a[44:47], a[228:231], v[232:235]
    buffer_load_dwordx4 v17, s[16:19], s49 offen offset:3072 lds
    ds_read_b64_tr_b16 a[14:15], v29 offset:51200
    v_mfma_f32_16x16x32_bf16 v[248:251], a[40:43], a[232:235], v[248:251]
    ds_read_b128 a[96:99], v26 offset:40960
    v_mfma_f32_16x16x32_bf16 v[248:251], a[44:47], a[236:239], v[248:251]
    s_add_u32 s49, s49, 128
    v_mfma_f32_16x16x32_bf16 a[148:151], a[40:43], a[240:243], a[148:151]
    s_add_u32 m0, s48, 65536
    ds_read_b64_tr_b16 a[16:17], v30 offset:32768
    v_mfma_f32_16x16x32_bf16 a[148:151], a[44:47], a[244:247], a[148:151]
    buffer_load_dwordx4 v18, s[20:23], s50 offen offset:0 lds
    v_mfma_f32_16x16x32_bf16 a[180:183], a[40:43], a[248:251], a[180:183]
    ds_read_b128 a[100:103], v27 offset:40960
    v_mfma_f32_16x16x32_bf16 a[180:183], a[44:47], a[252:255], a[180:183]
    ds_read_b64_tr_b16 a[18:19], v30 offset:34816
    v_mfma_f32_16x16x32_bf16 v[76:79], a[48:51], a[192:195], v[76:79]
    buffer_load_dwordx4 v19, s[20:23], s50 offen offset:1024 lds
    v_mfma_f32_16x16x32_bf16 v[76:79], a[52:55], a[196:199], v[76:79]
    ds_read_b128 a[104:107], v26 offset:43008
    v_mfma_f32_16x16x32_bf16 v[92:95], a[48:51], a[200:203], v[92:95]
    v_mfma_f32_16x16x32_bf16 v[92:95], a[52:55], a[204:207], v[92:95]
    buffer_load_dwordx4 v20, s[20:23], s50 offen offset:2048 lds
    ds_read_b64_tr_b16 a[20:21], v30 offset:49152
    v_mfma_f32_16x16x32_bf16 v[108:111], a[48:51], a[208:211], v[108:111]
    ds_read_b128 a[108:111], v27 offset:43008
    v_mfma_f32_16x16x32_bf16 v[108:111], a[52:55], a[212:215], v[108:111]
    v_mfma_f32_16x16x32_bf16 v[124:127], a[48:51], a[216:219], v[124:127]
    ds_read_b64_tr_b16 a[22:23], v30 offset:51200
    v_mfma_f32_16x16x32_bf16 v[124:127], a[52:55], a[220:223], v[124:127]
    buffer_load_dwordx4 v21, s[20:23], s50 offen offset:3072 lds
    v_mfma_f32_16x16x32_bf16 v[140:143], a[48:51], a[224:227], v[140:143]
    s_add_u32 m0, s48, 69632
    ds_read_b128 a[112:115], v26 offset:45056
    v_mfma_f32_16x16x32_bf16 v[140:143], a[52:55], a[228:231], v[140:143]
    ds_read_b64_tr_b16 a[24:25], v31 offset:32768
    v_mfma_f32_16x16x32_bf16 v[156:159], a[48:51], a[232:235], v[156:159]
    buffer_load_dwordx4 v22, s[20:23], s50 offen offset:0 lds
    v_mfma_f32_16x16x32_bf16 v[156:159], a[52:55], a[236:239], v[156:159]
    ds_read_b128 a[116:119], v27 offset:45056
    v_mfma_f32_16x16x32_bf16 a[152:155], a[48:51], a[240:243], a[152:155]
    v_mfma_f32_16x16x32_bf16 a[152:155], a[52:55], a[244:247], a[152:155]
    ds_read_b64_tr_b16 a[26:27], v31 offset:34816
    v_mfma_f32_16x16x32_bf16 a[184:187], a[48:51], a[248:251], a[184:187]
    buffer_load_dwordx4 v23, s[20:23], s50 offen offset:1024 lds
    ds_read_b128 a[120:123], v26 offset:47104
    v_mfma_f32_16x16x32_bf16 a[184:187], a[52:55], a[252:255], a[184:187]
    v_mfma_f32_16x16x32_bf16 v[172:175], a[56:59], a[192:195], v[172:175]
    ds_read_b64_tr_b16 a[28:29], v31 offset:49152
    v_mfma_f32_16x16x32_bf16 v[172:175], a[60:63], a[196:199], v[172:175]
    buffer_load_dwordx4 v24, s[20:23], s50 offen offset:2048 lds
    v_mfma_f32_16x16x32_bf16 v[188:191], a[56:59], a[200:203], v[188:191]
    ds_read_b128 a[124:127], v27 offset:47104
    v_mfma_f32_16x16x32_bf16 v[188:191], a[60:63], a[204:207], v[188:191]
    ds_read_b64_tr_b16 a[30:31], v31 offset:51200
    v_mfma_f32_16x16x32_bf16 v[204:207], a[56:59], a[208:211], v[204:207]
    v_mfma_f32_16x16x32_bf16 v[204:207], a[60:63], a[212:215], v[204:207]
    buffer_load_dwordx4 v25, s[20:23], s50 offen offset:3072 lds
    v_mfma_f32_16x16x32_bf16 v[220:223], a[56:59], a[216:219], v[220:223]
    v_mfma_f32_16x16x32_bf16 v[220:223], a[60:63], a[220:223], v[220:223]
    s_add_u32 s50, s50, 0x80000
    v_mfma_f32_16x16x32_bf16 v[236:239], a[56:59], a[224:227], v[236:239]
    v_mfma_f32_16x16x32_bf16 v[236:239], a[60:63], a[228:231], v[236:239]
    s_cmp_eq_u32 s51, s53
    s_cbranch_scc1 k12_ool_16
k12_oolret_17:
    v_mfma_f32_16x16x32_bf16 v[252:255], a[56:59], a[232:235], v[252:255]
    s_cmp_eq_u32 s51, s63
    s_cbranch_scc1 k12_ool_18
k12_oolret_19:
    v_mfma_f32_16x16x32_bf16 v[252:255], a[60:63], a[236:239], v[252:255]
    s_cmp_eq_u32 s51, 6
    s_cbranch_scc1 k12_ool_20
k12_oolret_21:
    v_mfma_f32_16x16x32_bf16 a[156:159], a[56:59], a[240:243], a[156:159]
    v_mfma_f32_16x16x32_bf16 a[156:159], a[60:63], a[244:247], a[156:159]
    s_add_u32 s51, s51, 1
    v_mfma_f32_16x16x32_bf16 a[188:191], a[56:59], a[248:251], a[188:191]
    v_mfma_f32_16x16x32_bf16 a[188:191], a[60:63], a[252:255], a[188:191]
    s_waitcnt lgkmcnt(0)
    s_cmp_eq_u32 s51, 7
    s_cbranch_scc1 k12_last_9
    v_mfma_f32_16x16x32_bf16 v[64:67], a[0:3], a[64:67], v[64:67]
    v_mfma_f32_16x16x32_bf16 v[64:67], a[4:7], a[68:71], v[64:67]
    ds_read_b64_tr_b16 a[32:33], v32 offset:32768
    v_mfma_f32_16x16x32_bf16 v[80:83], a[0:3], a[72:75], v[80:83]
    v_mfma_f32_16x16x32_bf16 v[80:83], a[4:7], a[76:79], v[80:83]
    ds_read_b64_tr_b16 a[34:35], v32 offset:34816
    v_mfma_f32_16x16x32_bf16 v[96:99], a[0:3], a[80:83], v[96:99]
    v_mfma_f32_16x16x32_bf16 v[96:99], a[4:7], a[84:87], v[96:99]
    v_mfma_f32_16x16x32_bf16 v[112:115], a[0:3], a[88:91], v[112:115]
    ds_read_b64_tr_b16 a[36:37], v32 offset:49152
    v_mfma_f32_16x16x32_bf16 v[112:115], a[4:7], a[92:95], v[112:115]
    v_mfma_f32_16x16x32_bf16 v[128:131], a[0:3], a[96:99], v[128:131]
    v_mfma_f32_16x16x32_bf16 v[128:131], a[4:7], a[100:103], v[128:131]
    ds_read_b64_tr_b16 a[38:39], v32 offset:51200
    v_mfma_f32_16x16x32_bf16 v[144:147], a[0:3], a[104:107], v[144:147]
    v_mfma_f32_16x16x32_bf16 v[144:147], a[4:7], a[108:111], v[144:147]
    v_mfma_f32_16x16x32_bf16 a[128:131], a[0:3], a[112:115], a[128:131]
    ds_read_b64_tr_b16 a[40:41], v33 offset:32768
    v_mfma_f32_16x16x32_bf16 a[128:131], a[4:7], a[116:119], a[128:131]
    v_mfma_f32_16x16x32_bf16 a[160:163], a[0:3], a[120:123], a[160:163]
    v_mfma_f32_16x16x32_bf16 a[160:163], a[4:7], a[124:127], a[160:163]
    ds_read_b64_tr_b16 a[42:43], v33 offset:34816
    v_mfma_f32_16x16x32_bf16 v[160:163], a[8:11], a[64:67], v[160:163]
    v_mfma_f32_16x16x32_bf16 v[160:163], a[12:15], a[68:71], v[160:163]
    v_mfma_f32_16x16x32_bf16 v[176:179], a[8:11], a[72:75], v[176:179]
    ds_read_b64_tr_b16 a[44:45], v33 offset:49152
    v_mfma_f32_16x16x32_bf16 v[176:179], a[12:15], a[76:79], v[176:179]
    v_mfma_f32_16x16x32_bf16 v[192:195], a[8:11], a[80:83], v[192:195]
    v_mfma_f32_16x16x32_bf16 v[192:195], a[12:15], a[84:87], v[192:195]
    ds_read_b64_tr_b16 a[46:47], v33 offset:51200
    v_mfma_f32_16x16x32_bf16 v[208:211], a[8:11], a[88:91], v[208:211]
    v_mfma_f32_16x16x32_bf16 v[208:211], a[12:15], a[92:95], v[208:211]
    ds_read_b64_tr_b16 a[48:49], v34 offset:32768
    v_mfma_f32_16x16x32_bf16 v[224:227], a[8:11], a[96:99], v[224:227]
    v_mfma_f32_16x16x32_bf16 v[224:227], a[12:15], a[100:103], v[224:227]
    v_mfma_f32_16x16x32_bf16 v[240:243], a[8:11], a[104:107], v[240:243]
    ds_read_b64_tr_b16 a[50:51], v34 offset:34816
    v_mfma_f32_16x16x32_bf16 v[240:243], a[12:15], a[108:111], v[240:243]
    v_mfma_f32_16x16x32_bf16 a[132:135], a[8:11], a[112:115], a[132:135]
    v_mfma_f32_16x16x32_bf16 a[132:135], a[12:15], a[116:119], a[132:135]
    ds_read_b64_tr_b16 a[52:53], v34 offset:49152
    v_mfma_f32_16x16x32_bf16 a[164:167], a[8:11], a[120:123], a[164:167]
    v_mfma_f32_16x16x32_bf16 a[164:167], a[12:15], a[124:127], a[164:167]
    v_mfma_f32_16x16x32_bf16 v[68:71], a[16:19], a[64:67], v[68:71]
    ds_read_b64_tr_b16 a[54:55], v34 offset:51200
    v_mfma_f32_16x16x32_bf16 v[68:71], a[20:23], a[68:71], v[68:71]
    v_mfma_f32_16x16x32_bf16 v[84:87], a[16:19], a[72:75], v[84:87]
    v_mfma_f32_16x16x32_bf16 v[84:87], a[20:23], a[76:79], v[84:87]
    ds_read_b64_tr_b16 a[56:57], v35 offset:32768
    v_mfma_f32_16x16x32_bf16 v[100:103], a[16:19], a[80:83], v[100:103]
    v_mfma_f32_16x16x32_bf16 v[100:103], a[20:23], a[84:87], v[100:103]
    v_mfma_f32_16x16x32_bf16 v[116:119], a[16:19], a[88:91], v[116:119]
    ds_read_b64_tr_b16 a[58:59], v35 offset:34816
    v_mfma_f32_16x16x32_bf16 v[116:119], a[20:23], a[92:95], v[116:119]
    v_mfma_f32_16x16x32_bf16 v[132:135], a[16:19], a[96:99], v[132:135]
    v_mfma_f32_16x16x32_bf16 v[132:135], a[20:23], a[100:103], v[132:135]
    ds_read_b64_tr_b16 a[60:61], v35 offset:49152
    v_mfma_f32_16x16x32_bf16 v[148:151], a[16:19], a[104:107], v[148:151]
    v_mfma_f32_16x16x32_bf16 v[148:151], a[20:23], a[108:111], v[148:151]
    v_mfma_f32_16x16x32_bf16 a[136:139], a[16:19], a[112:115], a[136:139]
    ds_read_b64_tr_b16 a[62:63], v35 offset:51200
    v_mfma_f32_16x16x32_bf16 a[136:139], a[20:23], a[116:119], a[136:139]
    v_mfma_f32_16x16x32_bf16 a[168:171], a[16:19], a[120:123], a[168:171]
    v_mfma_f32_16x16x32_bf16 a[168:171], a[20:23], a[124:127], a[168:171]
    v_mfma_f32_16x16x32_bf16 v[164:167], a[24:27], a[64:67], v[164:167]
    v_mfma_f32_16x16x32_bf16 v[164:167], a[28:31], a[68:71], v[164:167]
    v_mfma_f32_16x16x32_bf16 v[180:183], a[24:27], a[72:75], v[180:183]
    v_mfma_f32_16x16x32_bf16 v[180:183], a[28:31], a[76:79], v[180:183]
    v_mfma_f32_16x16x32_bf16 v[196:199], a[24:27], a[80:83], v[196:199]
    v_mfma_f32_16x16x32_bf16 v[196:199], a[28:31], a[84:87], v[196:199]
    v_mfma_f32_16x16x32_bf16 v[212:215], a[24:27], a[88:91], v[212:215]
    v_mfma_f32_16x16x32_bf16 v[212:215], a[28:31], a[92:95], v[212:215]
    v_mfma_f32_16x16x32_bf16 v[228:231], a[24:27], a[96:99], v[228:231]
    v_mfma_f32_16x16x32_bf16 v[228:231], a[28:31], a[100:103], v[228:231]
    v_mfma_f32_16x16x32_bf16 v[244:247], a[24:27], a[104:107], v[244:247]
    v_mfma_f32_16x16x32_bf16 v[244:247], a[28:31], a[108:111], v[244:247]
    v_mfma_f32_16x16x32_bf16 a[140:143], a[24:27], a[112:115], a[140:143]
    v_mfma_f32_16x16x32_bf16 a[140:143], a[28:31], a[116:119], a[140:143]
    v_mfma_f32_16x16x32_bf16 a[172:175], a[24:27], a[120:123], a[172:175]
    v_mfma_f32_16x16x32_bf16 a[172:175], a[28:31], a[124:127], a[172:175]
    s_waitcnt vmcnt(0) lgkmcnt(0)
    s_barrier
    v_mfma_f32_16x16x32_bf16 v[72:75], a[32:35], a[64:67], v[72:75]
    v_mfma_f32_16x16x32_bf16 v[72:75], a[36:39], a[68:71], v[72:75]
    s_add_u32 m0, s48, 32768
    ds_read_b128 a[192:195], v26 offset:0
    v_mfma_f32_16x16x32_bf16 v[88:91], a[32:35], a[72:75], v[88:91]
    buffer_load_dwordx4 v10, s[16:19], s49 offen offset:0 lds
    ds_read_b64_tr_b16 a[0:1], v28 offset:0
    v_mfma_f32_16x16x32_bf16 v[88:91], a[36:39], a[76:79], v[88:91]
    ds_read_b128 a[196:199], v27 offset:0
    v_mfma_f32_16x16x32_bf16 v[104:107], a[32:35], a[80:83], v[104:107]
    buffer_load_dwordx4 v11, s[16:19], s49 offen offset:1024 lds
    v_mfma_f32_16x16x32_bf16 v[104:107], a[36:39], a[84:87], v[104:107]
    ds_read_b64_tr_b16 a[2:3], v28 offset:2048
    v_mfma_f32_16x16x32_bf16 v[120:123], a[32:35], a[88:91], v[120:123]
    v_mfma_f32_16x16x32_bf16 v[120:123], a[36:39], a[92:95], v[120:123]
    ds_read_b128 a[200:203], v26 offset:2048
    v_mfma_f32_16x16x32_bf16 v[136:139], a[32:35], a[96:99], v[136:139]
    buffer_load_dwordx4 v12, s[16:19], s49 offen offset:2048 lds
    ds_read_b64_tr_b16 a[4:5], v28 offset:16384
    v_mfma_f32_16x16x32_bf16 v[136:139], a[36:39], a[100:103], v[136:139]
    v_mfma_f32_16x16x32_bf16 v[152:155], a[32:35], a[104:107], v[152:155]
    ds_read_b128 a[204:207], v27 offset:2048
    v_mfma_f32_16x16x32_bf16 v[152:155], a[36:39], a[108:111], v[152:155]
    buffer_load_dwordx4 v13, s[16:19], s49 offen offset:3072 lds
    v_mfma_f32_16x16x32_bf16 a[144:147], a[32:35], a[112:115], a[144:147]
    ds_read_b64_tr_b16 a[6:7], v28 offset:18432
    v_mfma_f32_16x16x32_bf16 a[144:147], a[36:39], a[116:119], a[144:147]
    s_add_u32 m0, s48, 36864
    ds_read_b128 a[208:211], v26 offset:4096
    v_mfma_f32_16x16x32_bf16 a[176:179], a[32:35], a[120:123], a[176:179]
    v_mfma_f32_16x16x32_bf16 a[176:179], a[36:39], a[124:127], a[176:179]
    buffer_load_dwordx4 v14, s[16:19], s49 offen offset:0 lds
    ds_read_b64_tr_b16 a[8:9], v29 offset:0
    v_mfma_f32_16x16x32_bf16 v[168:171], a[40:43], a[64:67], v[168:171]
    v_mfma_f32_16x16x32_bf16 v[168:171], a[44:47], a[68:71], v[168:171]
    ds_read_b128 a[212:215], v27 offset:4096
    v_mfma_f32_16x16x32_bf16 v[184:187], a[40:43], a[72:75], v[184:187]
    buffer_load_dwordx4 v15, s[16:19], s49 offen offset:1024 lds
    ds_read_b64_tr_b16 a[10:11], v29 offset:2048
    v_mfma_f32_16x16x32_bf16 v[184:187], a[44:47], a[76:79], v[184:187]
    v_mfma_f32_16x16x32_bf16 v[200:203], a[40:43], a[80:83], v[200:203]
    ds_read_b128 a[216:219], v26 offset:6144
    v_mfma_f32_16x16x32_bf16 v[200:203], a[44:47], a[84:87], v[200:203]
    v_mfma_f32_16x16x32_bf16 v[216:219], a[40:43], a[88:91], v[216:219]
    buffer_load_dwordx4 v16, s[16:19], s49 offen offset:2048 lds
    ds_read_b64_tr_b16 a[12:13], v29 offset:16384
    v_mfma_f32_16x16x32_bf16 v[216:219], a[44:47], a[92:95], v[216:219]
    ds_read_b128 a[220:223], v27 offset:6144
    v_mfma_f32_16x16x32_bf16 v[232:235], a[40:43], a[96:99], v[232:235]
    v_mfma_f32_16x16x32_bf16 v[232:235], a[44:47], a[100:103], v[232:235]
    buffer_load_dwordx4 v17, s[16:19], s49 offen offset:3072 lds
    ds_read_b64_tr_b16 a[14:15], v29 offset:18432
    v_mfma_f32_16x16x32_bf16 v[248:251], a[40:43], a[104:107], v[248:251]
    ds_read_b128 a[224:227], v26 offset:8192
    v_mfma_f32_16x16x32_bf16 v[248:251], a[44:47], a[108:111], v[248:251]
    s_add_u32 s49, s49, 128
    v_mfma_f32_16x16x32_bf16 a[148:151], a[40:43], a[112:115], a[148:151]
    s_add_u32 m0, s48, 98304
    ds_read_b64_tr_b16 a[16:17], v30 offset:0
    v_mfma_f32_16x16x32_bf16 a[148:151], a[44:47], a[116:119], a[148:151]
    buffer_load_dwordx4 v18, s[20:23], s50 offen offset:0 lds
    v_mfma_f32_16x16x32_bf16 a[180:183], a[40:43], a[120:123], a[180:183]
    ds_read_b128 a[228:231], v27 offset:8192
    v_mfma_f32_16x16x32_bf16 a[180:183], a[44:47], a[124:127], a[180:183]
    ds_read_b64_tr_b16 a[18:19], v30 offset:2048
    v_mfma_f32_16x16x32_bf16 v[76:79], a[48:51], a[64:67], v[76:79]
    buffer_load_dwordx4 v19, s[20:23], s50 offen offset:1024 lds
    v_mfma_f32_16x16x32_bf16 v[76:79], a[52:55], a[68:71], v[76:79]
    ds_read_b128 a[232:235], v26 offset:10240
    v_mfma_f32_16x16x32_bf16 v[92:95], a[48:51], a[72:75], v[92:95]
    v_mfma_f32_16x16x32_bf16 v[92:95], a[52:55], a[76:79], v[92:95]
    buffer_load_dwordx4 v20, s[20:23], s50 offen offset:2048 lds
    ds_read_b64_tr_b16 a[20:21], v30 offset:16384
    v_mfma_f32_16x16x32_bf16 v[108:111], a[48:51], a[80:83], v[108:111]
    ds_read_b128 a[236:239], v27 offset:10240
    v_mfma_f32_16x16x32_bf16 v[108:111], a[52:55], a[84:87], v[108:111]
    v_mfma_f32_16x16x32_bf16 v[124:127], a[48:51], a[88:91], v[124:127]
    ds_read_b64_tr_b16 a[22:23], v30 offset:18432
    v_mfma_f32_16x16x32_bf16 v[124:127], a[52:55], a[92:95], v[124:127]
    buffer_load_dwordx4 v21, s[20:23], s50 offen offset:3072 lds
    v_mfma_f32_16x16x32_bf16 v[140:143], a[48:51], a[96:99], v[140:143]
    s_add_u32 m0, s48, 102400
    ds_read_b128 a[240:243], v26 offset:12288
    v_mfma_f32_16x16x32_bf16 v[140:143], a[52:55], a[100:103], v[140:143]
    ds_read_b64_tr_b16 a[24:25], v31 offset:0
    v_mfma_f32_16x16x32_bf16 v[156:159], a[48:51], a[104:107], v[156:159]
    buffer_load_dwordx4 v22, s[20:23], s50 offen offset:0 lds
    v_mfma_f32_16x16x32_bf16 v[156:159], a[52:55], a[108:111], v[156:159]
    ds_read_b128 a[244:247], v27 offset:12288
    v_mfma_f32_16x16x32_bf16 a[152:155], a[48:51], a[112:115], a[152:155]
    v_mfma_f32_16x16x32_bf16 a[152:155], a[52:55], a[116:119], a[152:155]
    ds_read_b64_tr_b16 a[26:27], v31 offset:2048
    v_mfma_f32_16x16x32_bf16 a[184:187], a[48:51], a[120:123], a[184:187]
    buffer_load_dwordx4 v23, s[20:23], s50 offen offset:1024 lds
    ds_read_b128 a[248:251], v26 offset:14336
    v_mfma_f32_16x16x32_bf16 a[184:187], a[52:55], a[124:127], a[184:187]
    v_mfma_f32_16x16x32_bf16 v[172:175], a[56:59], a[64:67], v[172:175]
    ds_read_b64_tr_b16 a[28:29], v31 offset:16384
    v_mfma_f32_16x16x32_bf16 v[172:175], a[60:63], a[68:71], v[172:175]
    buffer_load_dwordx4 v24, s[20:23], s50 offen offset:2048 lds
    v_mfma_f32_16x16x32_bf16 v[188:191], a[56:59], a[72:75], v[188:191]
    ds_read_b128 a[252:255], v27 offset:14336
    v_mfma_f32_16x16x32_bf16 v[188:191], a[60:63], a[76:79], v[188:191]
    ds_read_b64_tr_b16 a[30:31], v31 offset:18432
    v_mfma_f32_16x16x32_bf16 v[204:207], a[56:59], a[80:83], v[204:207]
    v_mfma_f32_16x16x32_bf16 v[204:207], a[60:63], a[84:87], v[204:207]
    buffer_load_dwordx4 v25, s[20:23], s50 offen offset:3072 lds
    v_mfma_f32_16x16x32_bf16 v[220:223], a[56:59], a[88:91], v[220:223]
    v_mfma_f32_16x16x32_bf16 v[220:223], a[60:63], a[92:95], v[220:223]
    s_add_u32 s50, s50, 0x80000
    v_mfma_f32_16x16x32_bf16 v[236:239], a[56:59], a[96:99], v[236:239]
    v_mfma_f32_16x16x32_bf16 v[236:239], a[60:63], a[100:103], v[236:239]
    s_cmp_eq_u32 s51, s53
    s_cbranch_scc1 k12_ool_22
k12_oolret_23:
    v_mfma_f32_16x16x32_bf16 v[252:255], a[56:59], a[104:107], v[252:255]
    s_cmp_eq_u32 s51, s63
    s_cbranch_scc1 k12_ool_24
k12_oolret_25:
    v_mfma_f32_16x16x32_bf16 v[252:255], a[60:63], a[108:111], v[252:255]
    s_cmp_eq_u32 s51, 5
    s_cbranch_scc1 k12_ool_26
k12_oolret_27:
    v_mfma_f32_16x16x32_bf16 a[156:159], a[56:59], a[112:115], a[156:159]
    v_mfma_f32_16x16x32_bf16 a[156:159], a[60:63], a[116:119], a[156:159]
    s_add_u32 s51, s51, 1
    v_mfma_f32_16x16x32_bf16 a[188:191], a[56:59], a[120:123], a[188:191]
    v_mfma_f32_16x16x32_bf16 a[188:191], a[60:63], a[124:127], a[188:191]
    s_waitcnt lgkmcnt(0)
    s_branch k12_loop_8
k12_last_9:
    v_mfma_f32_16x16x32_bf16 v[64:67], a[0:3], a[64:67], v[64:67]
    buffer_load_dwordx4 a[192:195], v36, s[8:11], s62 offen sc1
    v_mfma_f32_16x16x32_bf16 v[64:67], a[4:7], a[68:71], v[64:67]
    ds_read_b64_tr_b16 a[32:33], v32 offset:32768
    v_mfma_f32_16x16x32_bf16 v[160:163], a[8:11], a[64:67], v[160:163]
    buffer_load_dwordx4 a[196:199], v54, s[8:11], s62 offen sc1
    ds_read_b64_tr_b16 a[34:35], v32 offset:34816
    v_mfma_f32_16x16x32_bf16 v[160:163], a[12:15], a[68:71], v[160:163]
    v_mfma_f32_16x16x32_bf16 v[80:83], a[0:3], a[72:75], v[80:83]
    buffer_load_dwordx4 a[200:203], v37, s[8:11], s62 offen sc1
    v_mfma_f32_16x16x32_bf16 v[80:83], a[4:7], a[76:79], v[80:83]
    ds_read_b64_tr_b16 a[36:37], v32 offset:49152
    v_mfma_f32_16x16x32_bf16 v[176:179], a[8:11], a[72:75], v[176:179]
    buffer_load_dwordx4 a[204:207], v55, s[8:11], s62 offen sc1
    v_mfma_f32_16x16x32_bf16 v[176:179], a[12:15], a[76:79], v[176:179]
    s_add_u32 s62, s62, 0x20000
    ds_read_b64_tr_b16 a[38:39], v32 offset:51200
    v_mfma_f32_16x16x32_bf16 v[96:99], a[0:3], a[80:83], v[96:99]
    buffer_load_dwordx4 a[208:211], v36, s[8:11], s62 offen sc1
    v_mfma_f32_16x16x32_bf16 v[96:99], a[4:7], a[84:87], v[96:99]
    v_cvt_pk_bf16_f32 v64, v64, v65
    v_cvt_pk_bf16_f32 v65, v66, v67
    v_mfma_f32_16x16x32_bf16 v[192:195], a[8:11], a[80:83], v[192:195]
    v_cvt_pk_bf16_f32 v66, v160, v161
    v_cvt_pk_bf16_f32 v67, v162, v163
    v_mfma_f32_16x16x32_bf16 v[192:195], a[12:15], a[84:87], v[192:195]
    buffer_load_dwordx4 a[212:215], v54, s[8:11], s62 offen sc1
    ds_read_b64_tr_b16 a[40:41], v33 offset:32768
    v_mfma_f32_16x16x32_bf16 v[112:115], a[0:3], a[88:91], v[112:115]
    buffer_load_dwordx4 a[216:219], v37, s[8:11], s62 offen sc1
    ds_read_b64_tr_b16 a[42:43], v33 offset:34816
    v_mfma_f32_16x16x32_bf16 v[112:115], a[4:7], a[92:95], v[112:115]
    v_cvt_pk_bf16_f32 v80, v80, v81
    v_cvt_pk_bf16_f32 v81, v82, v83
    v_mfma_f32_16x16x32_bf16 v[208:211], a[8:11], a[88:91], v[208:211]
    v_cvt_pk_bf16_f32 v82, v176, v177
    v_cvt_pk_bf16_f32 v83, v178, v179
    v_mfma_f32_16x16x32_bf16 v[208:211], a[12:15], a[92:95], v[208:211]
    buffer_load_dwordx4 a[220:223], v55, s[8:11], s62 offen sc1
    ds_read_b64_tr_b16 a[44:45], v33 offset:49152
    v_mfma_f32_16x16x32_bf16 v[128:131], a[0:3], a[96:99], v[128:131]
    s_add_u32 s62, s62, 0x20000
    buffer_load_dwordx4 a[224:227], v36, s[8:11], s62 offen sc1
    v_mfma_f32_16x16x32_bf16 v[128:131], a[4:7], a[100:103], v[128:131]
    v_cvt_pk_bf16_f32 v96, v96, v97
    v_cvt_pk_bf16_f32 v97, v98, v99
    v_mfma_f32_16x16x32_bf16 v[224:227], a[8:11], a[96:99], v[224:227]
    ds_read_b64_tr_b16 a[46:47], v33 offset:51200
    v_cvt_pk_bf16_f32 v98, v192, v193
    v_mfma_f32_16x16x32_bf16 v[224:227], a[12:15], a[100:103], v[224:227]
    ds_read_b64_tr_b16 a[48:49], v34 offset:32768
    v_cvt_pk_bf16_f32 v99, v194, v195
    v_mfma_f32_16x16x32_bf16 v[144:147], a[0:3], a[104:107], v[144:147]
    buffer_load_dwordx4 a[228:231], v54, s[8:11], s62 offen sc1
    buffer_load_dwordx4 a[232:235], v37, s[8:11], s62 offen sc1
    v_mfma_f32_16x16x32_bf16 v[144:147], a[4:7], a[108:111], v[144:147]
    v_cvt_pk_bf16_f32 v112, v112, v113
    v_cvt_pk_bf16_f32 v113, v114, v115
    v_mfma_f32_16x16x32_bf16 v[240:243], a[8:11], a[104:107], v[240:243]
    v_cvt_pk_bf16_f32 v114, v208, v209
    v_cvt_pk_bf16_f32 v115, v210, v211
    v_mfma_f32_16x16x32_bf16 v[240:243], a[12:15], a[108:111], v[240:243]
    buffer_load_dwordx4 a[236:239], v55, s[8:11], s62 offen sc1
    ds_read_b64_tr_b16 a[50:51], v34 offset:34816
    v_mfma_f32_16x16x32_bf16 a[128:131], a[0:3], a[112:115], a[128:131]
    s_add_u32 s62, s62, 0x20000
    ds_read_b64_tr_b16 a[52:53], v34 offset:49152
    v_mfma_f32_16x16x32_bf16 a[128:131], a[4:7], a[116:119], a[128:131]
    v_cvt_pk_bf16_f32 v128, v128, v129
    v_cvt_pk_bf16_f32 v129, v130, v131
    v_mfma_f32_16x16x32_bf16 a[132:135], a[8:11], a[112:115], a[132:135]
    s_add_u32 s52, s47, 0
    v_cvt_pk_bf16_f32 v130, v224, v225
    v_cvt_pk_bf16_f32 v131, v226, v227
    v_mfma_f32_16x16x32_bf16 a[132:135], a[12:15], a[116:119], a[132:135]
    buffer_store_dwordx4 v[64:67], v1, s[32:35], s52 offen offset:0 sc1
    ds_read_b64_tr_b16 a[54:55], v34 offset:51200
    v_mfma_f32_16x16x32_bf16 a[160:163], a[0:3], a[120:123], a[160:163]
    v_mfma_f32_16x16x32_bf16 a[160:163], a[4:7], a[124:127], a[160:163]
    v_cvt_pk_bf16_f32 v144, v144, v145
    v_cvt_pk_bf16_f32 v145, v146, v147
    v_mfma_f32_16x16x32_bf16 a[164:167], a[8:11], a[120:123], a[164:167]
    ds_read_b64_tr_b16 a[56:57], v35 offset:32768
    v_cvt_pk_bf16_f32 v146, v240, v241
    v_mfma_f32_16x16x32_bf16 a[164:167], a[12:15], a[124:127], a[164:167]
    v_cvt_pk_bf16_f32 v147, v242, v243
    v_mfma_f32_16x16x32_bf16 v[68:71], a[16:19], a[64:67], v[68:71]
    ds_read_b64_tr_b16 a[58:59], v35 offset:34816
    v_mfma_f32_16x16x32_bf16 v[68:71], a[20:23], a[68:71], v[68:71]
    v_accvgpr_read_b32 v56, a128
    v_accvgpr_read_b32 v57, a129
    v_mfma_f32_16x16x32_bf16 v[164:167], a[24:27], a[64:67], v[164:167]
    v_accvgpr_read_b32 v58, a130
    v_accvgpr_read_b32 v59, a131
    v_mfma_f32_16x16x32_bf16 v[164:167], a[28:31], a[68:71], v[164:167]
    v_accvgpr_read_b32 v60, a132
    v_accvgpr_read_b32 v61, a133
    v_mfma_f32_16x16x32_bf16 v[84:87], a[16:19], a[72:75], v[84:87]
    ds_read_b64_tr_b16 a[60:61], v35 offset:49152
    v_accvgpr_read_b32 v62, a134
    v_mfma_f32_16x16x32_bf16 v[84:87], a[20:23], a[76:79], v[84:87]
    v_accvgpr_read_b32 v63, a135
    v_cvt_pk_bf16_f32 v160, v56, v57
    v_mfma_f32_16x16x32_bf16 v[180:183], a[24:27], a[72:75], v[180:183]
    s_add_u32 s52, s47, 8192
    v_cvt_pk_bf16_f32 v161, v58, v59
    v_cvt_pk_bf16_f32 v162, v60, v61
    v_mfma_f32_16x16x32_bf16 v[180:183], a[28:31], a[76:79], v[180:183]
    ds_read_b64_tr_b16 a[62:63], v35 offset:51200
    v_cvt_pk_bf16_f32 v163, v62, v63
    v_mfma_f32_16x16x32_bf16 v[100:103], a[16:19], a[80:83], v[100:103]
    v_accvgpr_read_b32 v56, a160
    v_accvgpr_read_b32 v57, a161
    v_mfma_f32_16x16x32_bf16 v[100:103], a[20:23], a[84:87], v[100:103]
    v_accvgpr_read_b32 v58, a162
    v_accvgpr_read_b32 v59, a163
    v_mfma_f32_16x16x32_bf16 v[196:199], a[24:27], a[80:83], v[196:199]
    v_accvgpr_read_b32 v60, a164
    v_accvgpr_read_b32 v61, a165
    v_mfma_f32_16x16x32_bf16 v[196:199], a[28:31], a[84:87], v[196:199]
    v_accvgpr_read_b32 v62, a166
    v_accvgpr_read_b32 v63, a167
    v_mfma_f32_16x16x32_bf16 v[116:119], a[16:19], a[88:91], v[116:119]
    buffer_store_dwordx4 v[96:99], v1, s[32:35], s52 offen offset:0 sc1
    v_cvt_pk_bf16_f32 v176, v56, v57
    v_mfma_f32_16x16x32_bf16 v[116:119], a[20:23], a[92:95], v[116:119]
    v_cvt_pk_bf16_f32 v177, v58, v59
    v_cvt_pk_bf16_f32 v68, v68, v69
    v_mfma_f32_16x16x32_bf16 v[212:215], a[24:27], a[88:91], v[212:215]
    v_cvt_pk_bf16_f32 v178, v60, v61
    v_cvt_pk_bf16_f32 v69, v70, v71
    v_mfma_f32_16x16x32_bf16 v[212:215], a[28:31], a[92:95], v[212:215]
    v_cvt_pk_bf16_f32 v179, v62, v63
    v_cvt_pk_bf16_f32 v70, v164, v165
    v_mfma_f32_16x16x32_bf16 v[132:135], a[16:19], a[96:99], v[132:135]
    v_cvt_pk_bf16_f32 v71, v166, v167
    v_cvt_pk_bf16_f32 v84, v84, v85
    v_mfma_f32_16x16x32_bf16 v[132:135], a[20:23], a[100:103], v[132:135]
    v_cvt_pk_bf16_f32 v85, v86, v87
    v_cvt_pk_bf16_f32 v86, v180, v181
    v_mfma_f32_16x16x32_bf16 v[228:231], a[24:27], a[96:99], v[228:231]
    s_add_u32 s52, s47, 524288
    v_cvt_pk_bf16_f32 v87, v182, v183
    v_cvt_pk_bf16_f32 v100, v100, v101
    v_mfma_f32_16x16x32_bf16 v[228:231], a[28:31], a[100:103], v[228:231]
    v_cvt_pk_bf16_f32 v101, v102, v103
    v_cvt_pk_bf16_f32 v102, v196, v197
    v_mfma_f32_16x16x32_bf16 v[148:151], a[16:19], a[104:107], v[148:151]
    v_cvt_pk_bf16_f32 v103, v198, v199
    v_mfma_f32_16x16x32_bf16 v[148:151], a[20:23], a[108:111], v[148:151]
    buffer_store_dwordx4 v[128:131], v1, s[32:35], s52 offen offset:0 sc1
    v_mfma_f32_16x16x32_bf16 v[244:247], a[24:27], a[104:107], v[244:247]
    v_cvt_pk_bf16_f32 v116, v116, v117
    v_cvt_pk_bf16_f32 v117, v118, v119
    v_mfma_f32_16x16x32_bf16 v[244:247], a[28:31], a[108:111], v[244:247]
    v_cvt_pk_bf16_f32 v118, v212, v213
    v_cvt_pk_bf16_f32 v119, v214, v215
    v_mfma_f32_16x16x32_bf16 a[136:139], a[16:19], a[112:115], a[136:139]
    v_mfma_f32_16x16x32_bf16 a[136:139], a[20:23], a[116:119], a[136:139]
    v_cvt_pk_bf16_f32 v132, v132, v133
    v_cvt_pk_bf16_f32 v133, v134, v135
    v_mfma_f32_16x16x32_bf16 a[140:143], a[24:27], a[112:115], a[140:143]
    v_cvt_pk_bf16_f32 v134, v228, v229
    v_cvt_pk_bf16_f32 v135, v230, v231
    v_mfma_f32_16x16x32_bf16 a[140:143], a[28:31], a[116:119], a[140:143]
    v_mfma_f32_16x16x32_bf16 a[168:171], a[16:19], a[120:123], a[168:171]
    s_waitcnt lgkmcnt(0)
    v_mfma_f32_16x16x32_bf16 a[168:171], a[20:23], a[124:127], a[168:171]
    v_cvt_pk_bf16_f32 v148, v148, v149
    v_cvt_pk_bf16_f32 v149, v150, v151
    v_mfma_f32_16x16x32_bf16 a[172:175], a[24:27], a[120:123], a[172:175]
    v_cvt_pk_bf16_f32 v150, v244, v245
    v_cvt_pk_bf16_f32 v151, v246, v247
    v_mfma_f32_16x16x32_bf16 a[172:175], a[28:31], a[124:127], a[172:175]
    s_add_u32 s52, s47, 532480
    v_mfma_f32_16x16x32_bf16 v[72:75], a[32:35], a[64:67], v[72:75]
    buffer_store_dwordx4 v[160:163], v1, s[32:35], s52 offen offset:0 sc1
    v_mfma_f32_16x16x32_bf16 v[72:75], a[36:39], a[68:71], v[72:75]
    v_accvgpr_read_b32 v56, a136
    v_accvgpr_read_b32 v57, a137
    v_mfma_f32_16x16x32_bf16 v[168:171], a[40:43], a[64:67], v[168:171]
    v_accvgpr_read_b32 v58, a138
    v_accvgpr_read_b32 v59, a139
    v_mfma_f32_16x16x32_bf16 v[168:171], a[44:47], a[68:71], v[168:171]
    v_accvgpr_read_b32 v60, a140
    v_accvgpr_read_b32 v61, a141
    v_mfma_f32_16x16x32_bf16 v[88:91], a[32:35], a[72:75], v[88:91]
    v_accvgpr_read_b32 v62, a142
    v_accvgpr_read_b32 v63, a143
    v_mfma_f32_16x16x32_bf16 v[88:91], a[36:39], a[76:79], v[88:91]
    v_cvt_pk_bf16_f32 v164, v56, v57
    v_cvt_pk_bf16_f32 v165, v58, v59
    v_mfma_f32_16x16x32_bf16 v[184:187], a[40:43], a[72:75], v[184:187]
    v_cvt_pk_bf16_f32 v166, v60, v61
    v_cvt_pk_bf16_f32 v167, v62, v63
    v_mfma_f32_16x16x32_bf16 v[184:187], a[44:47], a[76:79], v[184:187]
    v_accvgpr_read_b32 v56, a168
    v_accvgpr_read_b32 v57, a169
    v_mfma_f32_16x16x32_bf16 v[104:107], a[32:35], a[80:83], v[104:107]
    v_accvgpr_read_b32 v58, a170
    v_accvgpr_read_b32 v59, a171
    v_mfma_f32_16x16x32_bf16 v[104:107], a[36:39], a[84:87], v[104:107]
    v_accvgpr_read_b32 v60, a172
    v_accvgpr_read_b32 v61, a173
    v_mfma_f32_16x16x32_bf16 v[200:203], a[40:43], a[80:83], v[200:203]
    v_accvgpr_read_b32 v62, a174
    v_accvgpr_read_b32 v63, a175
    v_mfma_f32_16x16x32_bf16 v[200:203], a[44:47], a[84:87], v[200:203]
    s_add_u32 s52, s47, 0
    v_cvt_pk_bf16_f32 v180, v56, v57
    v_cvt_pk_bf16_f32 v181, v58, v59
    v_mfma_f32_16x16x32_bf16 v[120:123], a[32:35], a[88:91], v[120:123]
    v_cvt_pk_bf16_f32 v72, v72, v73
    v_cvt_pk_bf16_f32 v182, v60, v61
    v_mfma_f32_16x16x32_bf16 v[120:123], a[36:39], a[92:95], v[120:123]
    v_cvt_pk_bf16_f32 v73, v74, v75
    v_cvt_pk_bf16_f32 v183, v62, v63
    v_mfma_f32_16x16x32_bf16 v[216:219], a[40:43], a[88:91], v[216:219]
    v_cvt_pk_bf16_f32 v74, v168, v169
    v_cvt_pk_bf16_f32 v75, v170, v171
    v_mfma_f32_16x16x32_bf16 v[216:219], a[44:47], a[92:95], v[216:219]
    v_cvt_pk_bf16_f32 v88, v88, v89
    v_cvt_pk_bf16_f32 v89, v90, v91
    v_mfma_f32_16x16x32_bf16 v[136:139], a[32:35], a[96:99], v[136:139]
    buffer_store_dwordx4 v[68:71], v1, s[32:35], s52 offen offset:1024 sc1
    v_mfma_f32_16x16x32_bf16 v[136:139], a[36:39], a[100:103], v[136:139]
    v_cvt_pk_bf16_f32 v90, v184, v185
    v_cvt_pk_bf16_f32 v91, v186, v187
    v_mfma_f32_16x16x32_bf16 v[232:235], a[40:43], a[96:99], v[232:235]
    v_cvt_pk_bf16_f32 v104, v104, v105
    v_cvt_pk_bf16_f32 v105, v106, v107
    v_mfma_f32_16x16x32_bf16 v[232:235], a[44:47], a[100:103], v[232:235]
    v_cvt_pk_bf16_f32 v106, v200, v201
    v_cvt_pk_bf16_f32 v107, v202, v203
    v_mfma_f32_16x16x32_bf16 v[152:155], a[32:35], a[104:107], v[152:155]
    v_mfma_f32_16x16x32_bf16 v[152:155], a[36:39], a[108:111], v[152:155]
    v_cvt_pk_bf16_f32 v120, v120, v121
    v_cvt_pk_bf16_f32 v121, v122, v123
    v_mfma_f32_16x16x32_bf16 v[248:251], a[40:43], a[104:107], v[248:251]
    v_cvt_pk_bf16_f32 v122, v216, v217
    v_cvt_pk_bf16_f32 v123, v218, v219
    v_mfma_f32_16x16x32_bf16 v[248:251], a[44:47], a[108:111], v[248:251]
    s_add_u32 s52, s47, 8192
    v_mfma_f32_16x16x32_bf16 a[144:147], a[32:35], a[112:115], a[144:147]
    buffer_store_dwordx4 v[100:103], v1, s[32:35], s52 offen offset:1024 sc1
    v_mfma_f32_16x16x32_bf16 a[144:147], a[36:39], a[116:119], a[144:147]
    v_cvt_pk_bf16_f32 v136, v136, v137
    v_cvt_pk_bf16_f32 v137, v138, v139
    v_mfma_f32_16x16x32_bf16 a[148:151], a[40:43], a[112:115], a[148:151]
    v_cvt_pk_bf16_f32 v138, v232, v233
    v_cvt_pk_bf16_f32 v139, v234, v235
    v_mfma_f32_16x16x32_bf16 a[148:151], a[44:47], a[116:119], a[148:151]
    v_mfma_f32_16x16x32_bf16 a[176:179], a[32:35], a[120:123], a[176:179]
    v_mfma_f32_16x16x32_bf16 a[176:179], a[36:39], a[124:127], a[176:179]
    v_cvt_pk_bf16_f32 v152, v152, v153
    v_cvt_pk_bf16_f32 v153, v154, v155
    v_mfma_f32_16x16x32_bf16 a[180:183], a[40:43], a[120:123], a[180:183]
    v_cvt_pk_bf16_f32 v154, v248, v249
    v_cvt_pk_bf16_f32 v155, v250, v251
    v_mfma_f32_16x16x32_bf16 a[180:183], a[44:47], a[124:127], a[180:183]
    v_mfma_f32_16x16x32_bf16 v[76:79], a[48:51], a[64:67], v[76:79]
    s_waitcnt vmcnt(12)
    s_barrier
    v_mfma_f32_16x16x32_bf16 v[76:79], a[52:55], a[68:71], v[76:79]
    ds_read_b64_tr_b16 a[0:1], v42 offset:32768
    v_accvgpr_read_b32 v56, a144
    v_mfma_f32_16x16x32_bf16 v[172:175], a[56:59], a[64:67], v[172:175]
    v_accvgpr_read_b32 v57, a145
    v_accvgpr_read_b32 v58, a146
    v_mfma_f32_16x16x32_bf16 v[172:175], a[60:63], a[68:71], v[172:175]
    s_add_u32 s52, s47, 524288
    ds_read_b64_tr_b16 a[2:3], v42 offset:33792
    v_accvgpr_read_b32 v59, a147
    v_mfma_f32_16x16x32_bf16 v[92:95], a[48:51], a[72:75], v[92:95]
    v_accvgpr_read_b32 v60, a148
    v_accvgpr_read_b32 v61, a149
    v_mfma_f32_16x16x32_bf16 v[92:95], a[52:55], a[76:79], v[92:95]
    ds_read_b64_tr_b16 a[4:5], v43 offset:32768
    v_accvgpr_read_b32 v62, a150
    v_mfma_f32_16x16x32_bf16 v[188:191], a[56:59], a[72:75], v[188:191]
    v_accvgpr_read_b32 v63, a151
    v_cvt_pk_bf16_f32 v168, v56, v57
    v_mfma_f32_16x16x32_bf16 v[188:191], a[60:63], a[76:79], v[188:191]
    v_cvt_pk_bf16_f32 v169, v58, v59
    v_cvt_pk_bf16_f32 v170, v60, v61
    v_mfma_f32_16x16x32_bf16 v[108:111], a[48:51], a[80:83], v[108:111]
    buffer_store_dwordx4 v[132:135], v1, s[32:35], s52 offen offset:1024 sc1
    ds_read_b64_tr_b16 a[6:7], v43 offset:33792
    v_mfma_f32_16x16x32_bf16 v[108:111], a[52:55], a[84:87], v[108:111]
    v_cvt_pk_bf16_f32 v171, v62, v63
    v_accvgpr_read_b32 v56, a176
    v_mfma_f32_16x16x32_bf16 v[204:207], a[56:59], a[80:83], v[204:207]
    v_accvgpr_read_b32 v57, a177
    v_accvgpr_read_b32 v58, a178
    v_mfma_f32_16x16x32_bf16 v[204:207], a[60:63], a[84:87], v[204:207]
    v_accvgpr_read_b32 v59, a179
    v_accvgpr_read_b32 v60, a180
    v_mfma_f32_16x16x32_bf16 v[124:127], a[48:51], a[88:91], v[124:127]
    ds_read_b64_tr_b16 a[8:9], v44 offset:32768
    v_accvgpr_read_b32 v61, a181
    v_mfma_f32_16x16x32_bf16 v[124:127], a[52:55], a[92:95], v[124:127]
    v_accvgpr_read_b32 v62, a182
    v_accvgpr_read_b32 v63, a183
    v_mfma_f32_16x16x32_bf16 v[220:223], a[56:59], a[88:91], v[220:223]
    ds_read_b64_tr_b16 a[10:11], v44 offset:33792
    v_cvt_pk_bf16_f32 v184, v56, v57
    v_mfma_f32_16x16x32_bf16 v[220:223], a[60:63], a[92:95], v[220:223]
    v_cvt_pk_bf16_f32 v185, v58, v59
    v_cvt_pk_bf16_f32 v76, v76, v77
    v_mfma_f32_16x16x32_bf16 v[140:143], a[48:51], a[96:99], v[140:143]
    s_add_u32 s52, s47, 532480
    v_cvt_pk_bf16_f32 v186, v60, v61
    v_cvt_pk_bf16_f32 v77, v78, v79
    v_mfma_f32_16x16x32_bf16 v[140:143], a[52:55], a[100:103], v[140:143]
    ds_read_b64_tr_b16 a[12:13], v45 offset:32768
    v_cvt_pk_bf16_f32 v187, v62, v63
    v_mfma_f32_16x16x32_bf16 v[236:239], a[56:59], a[96:99], v[236:239]
    v_cvt_pk_bf16_f32 v78, v172, v173
    v_cvt_pk_bf16_f32 v79, v174, v175
    v_mfma_f32_16x16x32_bf16 v[236:239], a[60:63], a[100:103], v[236:239]
    ds_read_b64_tr_b16 a[14:15], v45 offset:33792
    ds_read_b64_tr_b16 a[16:17], v46 offset:32768
    v_mfma_f32_16x16x32_bf16 v[156:159], a[48:51], a[104:107], v[156:159]
    v_cvt_pk_bf16_f32 v92, v92, v93
    v_cvt_pk_bf16_f32 v93, v94, v95
    v_mfma_f32_16x16x32_bf16 v[156:159], a[52:55], a[108:111], v[156:159]
    ds_read_b64_tr_b16 a[18:19], v46 offset:33792
    v_cvt_pk_bf16_f32 v94, v188, v189
    v_mfma_f32_16x16x32_bf16 v[252:255], a[56:59], a[104:107], v[252:255]
    ds_read_b64_tr_b16 a[20:21], v47 offset:32768
    v_cvt_pk_bf16_f32 v95, v190, v191
    v_mfma_f32_16x16x32_bf16 v[252:255], a[60:63], a[108:111], v[252:255]
    ds_read_b64_tr_b16 a[22:23], v47 offset:33792
    v_cvt_pk_bf16_f32 v108, v108, v109
    v_mfma_f32_16x16x32_bf16 a[152:155], a[48:51], a[112:115], a[152:155]
    buffer_store_dwordx4 v[164:167], v1, s[32:35], s52 offen offset:1024 sc1
    v_cvt_pk_bf16_f32 v109, v110, v111
    v_mfma_f32_16x16x32_bf16 a[152:155], a[52:55], a[116:119], a[152:155]
    ds_read_b64_tr_b16 a[24:25], v48 offset:32768
    v_cvt_pk_bf16_f32 v110, v204, v205
    v_mfma_f32_16x16x32_bf16 a[156:159], a[56:59], a[112:115], a[156:159]
    ds_read_b64_tr_b16 a[26:27], v48 offset:33792
    v_cvt_pk_bf16_f32 v111, v206, v207
    v_mfma_f32_16x16x32_bf16 a[156:159], a[60:63], a[116:119], a[156:159]
    ds_read_b64_tr_b16 a[28:29], v49 offset:32768
    v_cvt_pk_bf16_f32 v124, v124, v125
    v_mfma_f32_16x16x32_bf16 a[184:187], a[48:51], a[120:123], a[184:187]
    v_cvt_pk_bf16_f32 v125, v126, v127
    v_cvt_pk_bf16_f32 v126, v220, v221
    v_mfma_f32_16x16x32_bf16 a[184:187], a[52:55], a[124:127], a[184:187]
    ds_read_b64_tr_b16 a[30:31], v49 offset:33792
    v_cvt_pk_bf16_f32 v127, v222, v223
    v_mfma_f32_16x16x32_bf16 a[188:191], a[56:59], a[120:123], a[188:191]
    v_cvt_pk_bf16_f32 v140, v140, v141
    v_cvt_pk_bf16_f32 v141, v142, v143
    v_mfma_f32_16x16x32_bf16 a[188:191], a[60:63], a[124:127], a[188:191]
    v_cvt_pk_bf16_f32 v142, v236, v237
    v_cvt_pk_bf16_f32 v143, v238, v239
    v_cvt_pk_bf16_f32 v156, v156, v157
    v_cvt_pk_bf16_f32 v157, v158, v159
    v_cvt_pk_bf16_f32 v158, v252, v253
    v_cvt_pk_bf16_f32 v159, v254, v255
    v_accvgpr_read_b32 v56, a152
    v_accvgpr_read_b32 v57, a153
    v_accvgpr_read_b32 v58, a154
    v_accvgpr_read_b32 v59, a155
    v_accvgpr_read_b32 v60, a156
    v_accvgpr_read_b32 v61, a157
    v_accvgpr_read_b32 v62, a158
    v_accvgpr_read_b32 v63, a159
    v_cvt_pk_bf16_f32 v172, v56, v57
    v_cvt_pk_bf16_f32 v173, v58, v59
    v_cvt_pk_bf16_f32 v174, v60, v61
    v_cvt_pk_bf16_f32 v175, v62, v63
    v_accvgpr_read_b32 v56, a184
    v_accvgpr_read_b32 v57, a185
    v_accvgpr_read_b32 v58, a186
    v_accvgpr_read_b32 v59, a187
    v_accvgpr_read_b32 v60, a188
    v_accvgpr_read_b32 v61, a189
    v_accvgpr_read_b32 v62, a190
    v_accvgpr_read_b32 v63, a191
    v_cvt_pk_bf16_f32 v188, v56, v57
    v_cvt_pk_bf16_f32 v189, v58, v59
    v_cvt_pk_bf16_f32 v190, v60, v61
    v_cvt_pk_bf16_f32 v191, v62, v63
    s_branch k12_join_7
k12_v_6:
k12_loop_28:
    v_mfma_f32_16x16x32_bf16 v[64:67], a[192:195], a[0:3], v[64:67]
    v_mfma_f32_16x16x32_bf16 v[64:67], a[196:199], a[4:7], v[64:67]
    ds_read_b64_tr_b16 a[32:33], v32 offset:0
    v_mfma_f32_16x16x32_bf16 v[160:163], a[200:203], a[0:3], v[160:163]
    v_mfma_f32_16x16x32_bf16 v[160:163], a[204:207], a[4:7], v[160:163]
    ds_read_b64_tr_b16 a[34:35], v32 offset:2048
    v_mfma_f32_16x16x32_bf16 v[96:99], a[208:211], a[0:3], v[96:99]
    s_cmp_eq_u32 s51, s46
    s_cbranch_scc1 k12_ool_30
k12_oolret_31:
    v_mfma_f32_16x16x32_bf16 v[96:99], a[212:215], a[4:7], v[96:99]
    v_mfma_f32_16x16x32_bf16 v[192:195], a[216:219], a[0:3], v[192:195]
    ds_read_b64_tr_b16 a[36:37], v32 offset:16384
    v_mfma_f32_16x16x32_bf16 v[192:195], a[220:223], a[4:7], v[192:195]
    v_mfma_f32_16x16x32_bf16 v[128:131], a[224:227], a[0:3], v[128:131]
    v_mfma_f32_16x16x32_bf16 v[128:131], a[228:231], a[4:7], v[128:131]
    ds_read_b64_tr_b16 a[38:39], v32 offset:18432
    v_mfma_f32_16x16x32_bf16 v[224:227], a[232:235], a[0:3], v[224:227]
    v_mfma_f32_16x16x32_bf16 v[224:227], a[236:239], a[4:7], v[224:227]
    v_mfma_f32_16x16x32_bf16 a[128:131], a[240:243], a[0:3], a[128:131]
    ds_read_b64_tr_b16 a[40:41], v33 offset:0
    v_mfma_f32_16x16x32_bf16 a[128:131], a[244:247], a[4:7], a[128:131]
    v_mfma_f32_16x16x32_bf16 a[132:135], a[248:251], a[0:3], a[132:135]
    v_mfma_f32_16x16x32_bf16 a[132:135], a[252:255], a[4:7], a[132:135]
    ds_read_b64_tr_b16 a[42:43], v33 offset:2048
    v_mfma_f32_16x16x32_bf16 v[68:71], a[192:195], a[8:11], v[68:71]
    v_mfma_f32_16x16x32_bf16 v[68:71], a[196:199], a[12:15], v[68:71]
    v_mfma_f32_16x16x32_bf16 v[164:167], a[200:203], a[8:11], v[164:167]
    ds_read_b64_tr_b16 a[44:45], v33 offset:16384
    v_mfma_f32_16x16x32_bf16 v[164:167], a[204:207], a[12:15], v[164:167]
    v_mfma_f32_16x16x32_bf16 v[100:103], a[208:211], a[8:11], v[100:103]
    v_mfma_f32_16x16x32_bf16 v[100:103], a[212:215], a[12:15], v[100:103]
    ds_read_b64_tr_b16 a[46:47], v33 offset:18432
    v_mfma_f32_16x16x32_bf16 v[196:199], a[216:219], a[8:11], v[196:199]
    v_mfma_f32_16x16x32_bf16 v[196:199], a[220:223], a[12:15], v[196:199]
    ds_read_b64_tr_b16 a[48:49], v34 offset:0
    v_mfma_f32_16x16x32_bf16 v[132:135], a[224:227], a[8:11], v[132:135]
    v_mfma_f32_16x16x32_bf16 v[132:135], a[228:231], a[12:15], v[132:135]
    v_mfma_f32_16x16x32_bf16 v[228:231], a[232:235], a[8:11], v[228:231]
    ds_read_b64_tr_b16 a[50:51], v34 offset:2048
    v_mfma_f32_16x16x32_bf16 v[228:231], a[236:239], a[12:15], v[228:231]
    v_mfma_f32_16x16x32_bf16 a[136:139], a[240:243], a[8:11], a[136:139]
    v_mfma_f32_16x16x32_bf16 a[136:139], a[244:247], a[12:15], a[136:139]
    ds_read_b64_tr_b16 a[52:53], v34 offset:16384
    v_mfma_f32_16x16x32_bf16 a[140:143], a[248:251], a[8:11], a[140:143]
    v_mfma_f32_16x16x32_bf16 a[140:143], a[252:255], a[12:15], a[140:143]
    v_mfma_f32_16x16x32_bf16 v[72:75], a[192:195], a[16:19], v[72:75]
    ds_read_b64_tr_b16 a[54:55], v34 offset:18432
    v_mfma_f32_16x16x32_bf16 v[72:75], a[196:199], a[20:23], v[72:75]
    v_mfma_f32_16x16x32_bf16 v[168:171], a[200:203], a[16:19], v[168:171]
    v_mfma_f32_16x16x32_bf16 v[168:171], a[204:207], a[20:23], v[168:171]
    ds_read_b64_tr_b16 a[56:57], v35 offset:0
    v_mfma_f32_16x16x32_bf16 v[104:107], a[208:211], a[16:19], v[104:107]
    v_mfma_f32_16x16x32_bf16 v[104:107], a[212:215], a[20:23], v[104:107]
    v_mfma_f32_16x16x32_bf16 v[200:203], a[216:219], a[16:19], v[200:203]
    ds_read_b64_tr_b16 a[58:59], v35 offset:2048
    v_mfma_f32_16x16x32_bf16 v[200:203], a[220:223], a[20:23], v[200:203]
    v_mfma_f32_16x16x32_bf16 v[136:139], a[224:227], a[16:19], v[136:139]
    v_mfma_f32_16x16x32_bf16 v[136:139], a[228:231], a[20:23], v[136:139]
    ds_read_b64_tr_b16 a[60:61], v35 offset:16384
    v_mfma_f32_16x16x32_bf16 v[232:235], a[232:235], a[16:19], v[232:235]
    v_mfma_f32_16x16x32_bf16 v[232:235], a[236:239], a[20:23], v[232:235]
    v_mfma_f32_16x16x32_bf16 a[144:147], a[240:243], a[16:19], a[144:147]
    ds_read_b64_tr_b16 a[62:63], v35 offset:18432
    v_mfma_f32_16x16x32_bf16 a[144:147], a[244:247], a[20:23], a[144:147]
    v_mfma_f32_16x16x32_bf16 a[148:151], a[248:251], a[16:19], a[148:151]
    v_mfma_f32_16x16x32_bf16 a[148:151], a[252:255], a[20:23], a[148:151]
    v_mfma_f32_16x16x32_bf16 v[76:79], a[192:195], a[24:27], v[76:79]
    v_mfma_f32_16x16x32_bf16 v[76:79], a[196:199], a[28:31], v[76:79]
    v_mfma_f32_16x16x32_bf16 v[172:175], a[200:203], a[24:27], v[172:175]
    v_mfma_f32_16x16x32_bf16 v[172:175], a[204:207], a[28:31], v[172:175]
    v_mfma_f32_16x16x32_bf16 v[108:111], a[208:211], a[24:27], v[108:111]
    v_mfma_f32_16x16x32_bf16 v[108:111], a[212:215], a[28:31], v[108:111]
    v_mfma_f32_16x16x32_bf16 v[204:207], a[216:219], a[24:27], v[204:207]
    v_mfma_f32_16x16x32_bf16 v[204:207], a[220:223], a[28:31], v[204:207]
    v_mfma_f32_16x16x32_bf16 v[140:143], a[224:227], a[24:27], v[140:143]
    v_mfma_f32_16x16x32_bf16 v[140:143], a[228:231], a[28:31], v[140:143]
    v_mfma_f32_16x16x32_bf16 v[236:239], a[232:235], a[24:27], v[236:239]
    v_mfma_f32_16x16x32_bf16 v[236:239], a[236:239], a[28:31], v[236:239]
    v_mfma_f32_16x16x32_bf16 a[152:155], a[240:243], a[24:27], a[152:155]
    v_mfma_f32_16x16x32_bf16 a[152:155], a[244:247], a[28:31], a[152:155]
    v_mfma_f32_16x16x32_bf16 a[156:159], a[248:251], a[24:27], a[156:159]
    v_mfma_f32_16x16x32_bf16 a[156:159], a[252:255], a[28:31], a[156:159]
    s_waitcnt vmcnt(0) lgkmcnt(0)
    s_cmp_eq_u32 s51, s46
    s_cbranch_scc1 k12_ool_34
k12_oolret_35:
    s_barrier
    v_mfma_f32_16x16x32_bf16 v[80:83], a[192:195], a[32:35], v[80:83]
    s_cmp_ge_u32 s49, 1024
    s_cselect_b32 s18, 0, s18
    s_cselect_b32 s22, 0, s22
    v_mfma_f32_16x16x32_bf16 v[80:83], a[196:199], a[36:39], v[80:83]
    s_add_u32 m0, s48, 0
    ds_read_b128 a[64:67], v26 offset:32768
    v_mfma_f32_16x16x32_bf16 v[176:179], a[200:203], a[32:35], v[176:179]
    buffer_load_dwordx4 v10, s[16:19], s49 offen offset:0 lds
    ds_read_b64_tr_b16 a[0:1], v28 offset:32768
    v_mfma_f32_16x16x32_bf16 v[176:179], a[204:207], a[36:39], v[176:179]
    ds_read_b128 a[68:71], v27 offset:32768
    v_mfma_f32_16x16x32_bf16 v[112:115], a[208:211], a[32:35], v[112:115]
    buffer_load_dwordx4 v11, s[16:19], s49 offen offset:1024 lds
    v_mfma_f32_16x16x32_bf16 v[112:115], a[212:215], a[36:39], v[112:115]
    ds_read_b64_tr_b16 a[2:3], v28 offset:34816
    v_mfma_f32_16x16x32_bf16 v[208:211], a[216:219], a[32:35], v[208:211]
    v_mfma_f32_16x16x32_bf16 v[208:211], a[220:223], a[36:39], v[208:211]
    ds_read_b128 a[72:75], v26 offset:34816
    v_mfma_f32_16x16x32_bf16 v[144:147], a[224:227], a[32:35], v[144:147]
    buffer_load_dwordx4 v12, s[16:19], s49 offen offset:2048 lds
    ds_read_b64_tr_b16 a[4:5], v28 offset:49152
    v_mfma_f32_16x16x32_bf16 v[144:147], a[228:231], a[36:39], v[144:147]
    v_mfma_f32_16x16x32_bf16 v[240:243], a[232:235], a[32:35], v[240:243]
    ds_read_b128 a[76:79], v27 offset:34816
    v_mfma_f32_16x16x32_bf16 v[240:243], a[236:239], a[36:39], v[240:243]
    buffer_load_dwordx4 v13, s[16:19], s49 offen offset:3072 lds
    v_mfma_f32_16x16x32_bf16 a[160:163], a[240:243], a[32:35], a[160:163]
    ds_read_b64_tr_b16 a[6:7], v28 offset:51200
    v_mfma_f32_16x16x32_bf16 a[160:163], a[244:247], a[36:39], a[160:163]
    s_add_u32 m0, s48, 4096
    ds_read_b128 a[80:83], v26 offset:36864
    v_mfma_f32_16x16x32_bf16 a[164:167], a[248:251], a[32:35], a[164:167]
    v_mfma_f32_16x16x32_bf16 a[164:167], a[252:255], a[36:39], a[164:167]
    buffer_load_dwordx4 v14, s[16:19], s49 offen offset:0 lds
    ds_read_b64_tr_b16 a[8:9], v29 offset:32768
    v_mfma_f32_16x16x32_bf16 v[84:87], a[192:195], a[40:43], v[84:87]
    v_mfma_f32_16x16x32_bf16 v[84:87], a[196:199], a[44:47], v[84:87]
    ds_read_b128 a[84:87], v27 offset:36864
    v_mfma_f32_16x16x32_bf16 v[180:183], a[200:203], a[40:43], v[180:183]
    buffer_load_dwordx4 v15, s[16:19], s49 offen offset:1024 lds
    ds_read_b64_tr_b16 a[10:11], v29 offset:34816
    v_mfma_f32_16x16x32_bf16 v[180:183], a[204:207], a[44:47], v[180:183]
    v_mfma_f32_16x16x32_bf16 v[116:119], a[208:211], a[40:43], v[116:119]
    ds_read_b128 a[88:91], v26 offset:38912
    v_mfma_f32_16x16x32_bf16 v[116:119], a[212:215], a[44:47], v[116:119]
    v_mfma_f32_16x16x32_bf16 v[212:215], a[216:219], a[40:43], v[212:215]
    buffer_load_dwordx4 v16, s[16:19], s49 offen offset:2048 lds
    ds_read_b64_tr_b16 a[12:13], v29 offset:49152
    v_mfma_f32_16x16x32_bf16 v[212:215], a[220:223], a[44:47], v[212:215]
    ds_read_b128 a[92:95], v27 offset:38912
    v_mfma_f32_16x16x32_bf16 v[148:151], a[224:227], a[40:43], v[148:151]
    v_mfma_f32_16x16x32_bf16 v[148:151], a[228:231], a[44:47], v[148:151]
    buffer_load_dwordx4 v17, s[16:19], s49 offen offset:3072 lds
    ds_read_b64_tr_b16 a[14:15], v29 offset:51200
    v_mfma_f32_16x16x32_bf16 v[244:247], a[232:235], a[40:43], v[244:247]
    ds_read_b128 a[96:99], v26 offset:40960
    v_mfma_f32_16x16x32_bf16 v[244:247], a[236:239], a[44:47], v[244:247]
    s_add_u32 s49, s49, 128
    v_mfma_f32_16x16x32_bf16 a[168:171], a[240:243], a[40:43], a[168:171]
    s_add_u32 m0, s48, 65536
    ds_read_b64_tr_b16 a[16:17], v30 offset:32768
    v_mfma_f32_16x16x32_bf16 a[168:171], a[244:247], a[44:47], a[168:171]
    buffer_load_dwordx4 v18, s[20:23], s50 offen offset:0 lds
    v_mfma_f32_16x16x32_bf16 a[172:175], a[248:251], a[40:43], a[172:175]
    ds_read_b128 a[100:103], v27 offset:40960
    v_mfma_f32_16x16x32_bf16 a[172:175], a[252:255], a[44:47], a[172:175]
    ds_read_b64_tr_b16 a[18:19], v30 offset:34816
    v_mfma_f32_16x16x32_bf16 v[88:91], a[192:195], a[48:51], v[88:91]
    buffer_load_dwordx4 v19, s[20:23], s50 offen offset:1024 lds
    v_mfma_f32_16x16x32_bf16 v[88:91], a[196:199], a[52:55], v[88:91]
    ds_read_b128 a[104:107], v26 offset:43008
    v_mfma_f32_16x16x32_bf16 v[184:187], a[200:203], a[48:51], v[184:187]
    v_mfma_f32_16x16x32_bf16 v[184:187], a[204:207], a[52:55], v[184:187]
    buffer_load_dwordx4 v20, s[20:23], s50 offen offset:2048 lds
    ds_read_b64_tr_b16 a[20:21], v30 offset:49152
    v_mfma_f32_16x16x32_bf16 v[120:123], a[208:211], a[48:51], v[120:123]
    ds_read_b128 a[108:111], v27 offset:43008
    v_mfma_f32_16x16x32_bf16 v[120:123], a[212:215], a[52:55], v[120:123]
    v_mfma_f32_16x16x32_bf16 v[216:219], a[216:219], a[48:51], v[216:219]
    ds_read_b64_tr_b16 a[22:23], v30 offset:51200
    v_mfma_f32_16x16x32_bf16 v[216:219], a[220:223], a[52:55], v[216:219]
    buffer_load_dwordx4 v21, s[20:23], s50 offen offset:3072 lds
    v_mfma_f32_16x16x32_bf16 v[152:155], a[224:227], a[48:51], v[152:155]
    s_add_u32 m0, s48, 69632
    ds_read_b128 a[112:115], v26 offset:45056
    v_mfma_f32_16x16x32_bf16 v[152:155], a[228:231], a[52:55], v[152:155]
    ds_read_b64_tr_b16 a[24:25], v31 offset:32768
    v_mfma_f32_16x16x32_bf16 v[248:251], a[232:235], a[48:51], v[248:251]
    buffer_load_dwordx4 v22, s[20:23], s50 offen offset:0 lds
    v_mfma_f32_16x16x32_bf16 v[248:251], a[236:239], a[52:55], v[248:251]
    ds_read_b128 a[116:119], v27 offset:45056
    v_mfma_f32_16x16x32_bf16 a[176:179], a[240:243], a[48:51], a[176:179]
    v_mfma_f32_16x16x32_bf16 a[176:179], a[244:247], a[52:55], a[176:179]
    ds_read_b64_tr_b16 a[26:27], v31 offset:34816
    v_mfma_f32_16x16x32_bf16 a[180:183], a[248:251], a[48:51], a[180:183]
    buffer_load_dwordx4 v23, s[20:23], s50 offen offset:1024 lds
    ds_read_b128 a[120:123], v26 offset:47104
    v_mfma_f32_16x16x32_bf16 a[180:183], a[252:255], a[52:55], a[180:183]
    v_mfma_f32_16x16x32_bf16 v[92:95], a[192:195], a[56:59], v[92:95]
    ds_read_b64_tr_b16 a[28:29], v31 offset:49152
    v_mfma_f32_16x16x32_bf16 v[92:95], a[196:199], a[60:63], v[92:95]
    buffer_load_dwordx4 v24, s[20:23], s50 offen offset:2048 lds
    v_mfma_f32_16x16x32_bf16 v[188:191], a[200:203], a[56:59], v[188:191]
    ds_read_b128 a[124:127], v27 offset:47104
    v_mfma_f32_16x16x32_bf16 v[188:191], a[204:207], a[60:63], v[188:191]
    ds_read_b64_tr_b16 a[30:31], v31 offset:51200
    v_mfma_f32_16x16x32_bf16 v[124:127], a[208:211], a[56:59], v[124:127]
    v_mfma_f32_16x16x32_bf16 v[124:127], a[212:215], a[60:63], v[124:127]
    buffer_load_dwordx4 v25, s[20:23], s50 offen offset:3072 lds
    v_mfma_f32_16x16x32_bf16 v[220:223], a[216:219], a[56:59], v[220:223]
    v_mfma_f32_16x16x32_bf16 v[220:223], a[220:223], a[60:63], v[220:223]
    s_add_u32 s50, s50, 0x80000
    v_mfma_f32_16x16x32_bf16 v[156:159], a[224:227], a[56:59], v[156:159]
    v_mfma_f32_16x16x32_bf16 v[156:159], a[228:231], a[60:63], v[156:159]
    s_cmp_eq_u32 s51, s53
    s_cbranch_scc1 k12_ool_36
k12_oolret_37:
    v_mfma_f32_16x16x32_bf16 v[252:255], a[232:235], a[56:59], v[252:255]
    s_cmp_eq_u32 s51, s63
    s_cbranch_scc1 k12_ool_38
k12_oolret_39:
    v_mfma_f32_16x16x32_bf16 v[252:255], a[236:239], a[60:63], v[252:255]
    s_cmp_eq_u32 s51, 6
    s_cbranch_scc1 k12_ool_40
k12_oolret_41:
    v_mfma_f32_16x16x32_bf16 a[184:187], a[240:243], a[56:59], a[184:187]
    v_mfma_f32_16x16x32_bf16 a[184:187], a[244:247], a[60:63], a[184:187]
    s_add_u32 s51, s51, 1
    v_mfma_f32_16x16x32_bf16 a[188:191], a[248:251], a[56:59], a[188:191]
    v_mfma_f32_16x16x32_bf16 a[188:191], a[252:255], a[60:63], a[188:191]
    s_waitcnt lgkmcnt(0)
    s_cmp_eq_u32 s51, 7
    s_cbranch_scc1 k12_last_29
    v_mfma_f32_16x16x32_bf16 v[64:67], a[64:67], a[0:3], v[64:67]
    v_mfma_f32_16x16x32_bf16 v[64:67], a[68:71], a[4:7], v[64:67]
    ds_read_b64_tr_b16 a[32:33], v32 offset:32768
    v_mfma_f32_16x16x32_bf16 v[160:163], a[72:75], a[0:3], v[160:163]
    v_mfma_f32_16x16x32_bf16 v[160:163], a[76:79], a[4:7], v[160:163]
    ds_read_b64_tr_b16 a[34:35], v32 offset:34816
    v_mfma_f32_16x16x32_bf16 v[96:99], a[80:83], a[0:3], v[96:99]
    v_mfma_f32_16x16x32_bf16 v[96:99], a[84:87], a[4:7], v[96:99]
    v_mfma_f32_16x16x32_bf16 v[192:195], a[88:91], a[0:3], v[192:195]
    ds_read_b64_tr_b16 a[36:37], v32 offset:49152
    v_mfma_f32_16x16x32_bf16 v[192:195], a[92:95], a[4:7], v[192:195]
    v_mfma_f32_16x16x32_bf16 v[128:131], a[96:99], a[0:3], v[128:131]
    v_mfma_f32_16x16x32_bf16 v[128:131], a[100:103], a[4:7], v[128:131]
    ds_read_b64_tr_b16 a[38:39], v32 offset:51200
    v_mfma_f32_16x16x32_bf16 v[224:227], a[104:107], a[0:3], v[224:227]
    v_mfma_f32_16x16x32_bf16 v[224:227], a[108:111], a[4:7], v[224:227]
    v_mfma_f32_16x16x32_bf16 a[128:131], a[112:115], a[0:3], a[128:131]
    ds_read_b64_tr_b16 a[40:41], v33 offset:32768
    v_mfma_f32_16x16x32_bf16 a[128:131], a[116:119], a[4:7], a[128:131]
    v_mfma_f32_16x16x32_bf16 a[132:135], a[120:123], a[0:3], a[132:135]
    v_mfma_f32_16x16x32_bf16 a[132:135], a[124:127], a[4:7], a[132:135]
    ds_read_b64_tr_b16 a[42:43], v33 offset:34816
    v_mfma_f32_16x16x32_bf16 v[68:71], a[64:67], a[8:11], v[68:71]
    v_mfma_f32_16x16x32_bf16 v[68:71], a[68:71], a[12:15], v[68:71]
    v_mfma_f32_16x16x32_bf16 v[164:167], a[72:75], a[8:11], v[164:167]
    ds_read_b64_tr_b16 a[44:45], v33 offset:49152
    v_mfma_f32_16x16x32_bf16 v[164:167], a[76:79], a[12:15], v[164:167]
    v_mfma_f32_16x16x32_bf16 v[100:103], a[80:83], a[8:11], v[100:103]
    v_mfma_f32_16x16x32_bf16 v[100:103], a[84:87], a[12:15], v[100:103]
    ds_read_b64_tr_b16 a[46:47], v33 offset:51200
    v_mfma_f32_16x16x32_bf16 v[196:199], a[88:91], a[8:11], v[196:199]
    v_mfma_f32_16x16x32_bf16 v[196:199], a[92:95], a[12:15], v[196:199]
    ds_read_b64_tr_b16 a[48:49], v34 offset:32768
    v_mfma_f32_16x16x32_bf16 v[132:135], a[96:99], a[8:11], v[132:135]
    v_mfma_f32_16x16x32_bf16 v[132:135], a[100:103], a[12:15], v[132:135]
    v_mfma_f32_16x16x32_bf16 v[228:231], a[104:107], a[8:11], v[228:231]
    ds_read_b64_tr_b16 a[50:51], v34 offset:34816
    v_mfma_f32_16x16x32_bf16 v[228:231], a[108:111], a[12:15], v[228:231]
    v_mfma_f32_16x16x32_bf16 a[136:139], a[112:115], a[8:11], a[136:139]
    v_mfma_f32_16x16x32_bf16 a[136:139], a[116:119], a[12:15], a[136:139]
    ds_read_b64_tr_b16 a[52:53], v34 offset:49152
    v_mfma_f32_16x16x32_bf16 a[140:143], a[120:123], a[8:11], a[140:143]
    v_mfma_f32_16x16x32_bf16 a[140:143], a[124:127], a[12:15], a[140:143]
    v_mfma_f32_16x16x32_bf16 v[72:75], a[64:67], a[16:19], v[72:75]
    ds_read_b64_tr_b16 a[54:55], v34 offset:51200
    v_mfma_f32_16x16x32_bf16 v[72:75], a[68:71], a[20:23], v[72:75]
    v_mfma_f32_16x16x32_bf16 v[168:171], a[72:75], a[16:19], v[168:171]
    v_mfma_f32_16x16x32_bf16 v[168:171], a[76:79], a[20:23], v[168:171]
    ds_read_b64_tr_b16 a[56:57], v35 offset:32768
    v_mfma_f32_16x16x32_bf16 v[104:107], a[80:83], a[16:19], v[104:107]
    v_mfma_f32_16x16x32_bf16 v[104:107], a[84:87], a[20:23], v[104:107]
    v_mfma_f32_16x16x32_bf16 v[200:203], a[88:91], a[16:19], v[200:203]
    ds_read_b64_tr_b16 a[58:59], v35 offset:34816
    v_mfma_f32_16x16x32_bf16 v[200:203], a[92:95], a[20:23], v[200:203]
    v_mfma_f32_16x16x32_bf16 v[136:139], a[96:99], a[16:19], v[136:139]
    v_mfma_f32_16x16x32_bf16 v[136:139], a[100:103], a[20:23], v[136:139]
    ds_read_b64_tr_b16 a[60:61], v35 offset:49152
    v_mfma_f32_16x16x32_bf16 v[232:235], a[104:107], a[16:19], v[232:235]
    v_mfma_f32_16x16x32_bf16 v[232:235], a[108:111], a[20:23], v[232:235]
    v_mfma_f32_16x16x32_bf16 a[144:147], a[112:115], a[16:19], a[144:147]
    ds_read_b64_tr_b16 a[62:63], v35 offset:51200
    v_mfma_f32_16x16x32_bf16 a[144:147], a[116:119], a[20:23], a[144:147]
    v_mfma_f32_16x16x32_bf16 a[148:151], a[120:123], a[16:19], a[148:151]
    v_mfma_f32_16x16x32_bf16 a[148:151], a[124:127], a[20:23], a[148:151]
    v_mfma_f32_16x16x32_bf16 v[76:79], a[64:67], a[24:27], v[76:79]
    v_mfma_f32_16x16x32_bf16 v[76:79], a[68:71], a[28:31], v[76:79]
    v_mfma_f32_16x16x32_bf16 v[172:175], a[72:75], a[24:27], v[172:175]
    v_mfma_f32_16x16x32_bf16 v[172:175], a[76:79], a[28:31], v[172:175]
    v_mfma_f32_16x16x32_bf16 v[108:111], a[80:83], a[24:27], v[108:111]
    v_mfma_f32_16x16x32_bf16 v[108:111], a[84:87], a[28:31], v[108:111]
    v_mfma_f32_16x16x32_bf16 v[204:207], a[88:91], a[24:27], v[204:207]
    v_mfma_f32_16x16x32_bf16 v[204:207], a[92:95], a[28:31], v[204:207]
    v_mfma_f32_16x16x32_bf16 v[140:143], a[96:99], a[24:27], v[140:143]
    v_mfma_f32_16x16x32_bf16 v[140:143], a[100:103], a[28:31], v[140:143]
    v_mfma_f32_16x16x32_bf16 v[236:239], a[104:107], a[24:27], v[236:239]
    v_mfma_f32_16x16x32_bf16 v[236:239], a[108:111], a[28:31], v[236:239]
    v_mfma_f32_16x16x32_bf16 a[152:155], a[112:115], a[24:27], a[152:155]
    v_mfma_f32_16x16x32_bf16 a[152:155], a[116:119], a[28:31], a[152:155]
    v_mfma_f32_16x16x32_bf16 a[156:159], a[120:123], a[24:27], a[156:159]
    v_mfma_f32_16x16x32_bf16 a[156:159], a[124:127], a[28:31], a[156:159]
    s_waitcnt vmcnt(0) lgkmcnt(0)
    s_barrier
    v_mfma_f32_16x16x32_bf16 v[80:83], a[64:67], a[32:35], v[80:83]
    v_mfma_f32_16x16x32_bf16 v[80:83], a[68:71], a[36:39], v[80:83]
    s_add_u32 m0, s48, 32768
    ds_read_b128 a[192:195], v26 offset:0
    v_mfma_f32_16x16x32_bf16 v[176:179], a[72:75], a[32:35], v[176:179]
    buffer_load_dwordx4 v10, s[16:19], s49 offen offset:0 lds
    ds_read_b64_tr_b16 a[0:1], v28 offset:0
    v_mfma_f32_16x16x32_bf16 v[176:179], a[76:79], a[36:39], v[176:179]
    ds_read_b128 a[196:199], v27 offset:0
    v_mfma_f32_16x16x32_bf16 v[112:115], a[80:83], a[32:35], v[112:115]
    buffer_load_dwordx4 v11, s[16:19], s49 offen offset:1024 lds
    v_mfma_f32_16x16x32_bf16 v[112:115], a[84:87], a[36:39], v[112:115]
    ds_read_b64_tr_b16 a[2:3], v28 offset:2048
    v_mfma_f32_16x16x32_bf16 v[208:211], a[88:91], a[32:35], v[208:211]
    v_mfma_f32_16x16x32_bf16 v[208:211], a[92:95], a[36:39], v[208:211]
    ds_read_b128 a[200:203], v26 offset:2048
    v_mfma_f32_16x16x32_bf16 v[144:147], a[96:99], a[32:35], v[144:147]
    buffer_load_dwordx4 v12, s[16:19], s49 offen offset:2048 lds
    ds_read_b64_tr_b16 a[4:5], v28 offset:16384
    v_mfma_f32_16x16x32_bf16 v[144:147], a[100:103], a[36:39], v[144:147]
    v_mfma_f32_16x16x32_bf16 v[240:243], a[104:107], a[32:35], v[240:243]
    ds_read_b128 a[204:207], v27 offset:2048
    v_mfma_f32_16x16x32_bf16 v[240:243], a[108:111], a[36:39], v[240:243]
    buffer_load_dwordx4 v13, s[16:19], s49 offen offset:3072 lds
    v_mfma_f32_16x16x32_bf16 a[160:163], a[112:115], a[32:35], a[160:163]
    ds_read_b64_tr_b16 a[6:7], v28 offset:18432
    v_mfma_f32_16x16x32_bf16 a[160:163], a[116:119], a[36:39], a[160:163]
    s_add_u32 m0, s48, 36864
    ds_read_b128 a[208:211], v26 offset:4096
    v_mfma_f32_16x16x32_bf16 a[164:167], a[120:123], a[32:35], a[164:167]
    v_mfma_f32_16x16x32_bf16 a[164:167], a[124:127], a[36:39], a[164:167]
    buffer_load_dwordx4 v14, s[16:19], s49 offen offset:0 lds
    ds_read_b64_tr_b16 a[8:9], v29 offset:0
    v_mfma_f32_16x16x32_bf16 v[84:87], a[64:67], a[40:43], v[84:87]
    v_mfma_f32_16x16x32_bf16 v[84:87], a[68:71], a[44:47], v[84:87]
    ds_read_b128 a[212:215], v27 offset:4096
    v_mfma_f32_16x16x32_bf16 v[180:183], a[72:75], a[40:43], v[180:183]
    buffer_load_dwordx4 v15, s[16:19], s49 offen offset:1024 lds
    ds_read_b64_tr_b16 a[10:11], v29 offset:2048
    v_mfma_f32_16x16x32_bf16 v[180:183], a[76:79], a[44:47], v[180:183]
    v_mfma_f32_16x16x32_bf16 v[116:119], a[80:83], a[40:43], v[116:119]
    ds_read_b128 a[216:219], v26 offset:6144
    v_mfma_f32_16x16x32_bf16 v[116:119], a[84:87], a[44:47], v[116:119]
    v_mfma_f32_16x16x32_bf16 v[212:215], a[88:91], a[40:43], v[212:215]
    buffer_load_dwordx4 v16, s[16:19], s49 offen offset:2048 lds
    ds_read_b64_tr_b16 a[12:13], v29 offset:16384
    v_mfma_f32_16x16x32_bf16 v[212:215], a[92:95], a[44:47], v[212:215]
    ds_read_b128 a[220:223], v27 offset:6144
    v_mfma_f32_16x16x32_bf16 v[148:151], a[96:99], a[40:43], v[148:151]
    v_mfma_f32_16x16x32_bf16 v[148:151], a[100:103], a[44:47], v[148:151]
    buffer_load_dwordx4 v17, s[16:19], s49 offen offset:3072 lds
    ds_read_b64_tr_b16 a[14:15], v29 offset:18432
    v_mfma_f32_16x16x32_bf16 v[244:247], a[104:107], a[40:43], v[244:247]
    ds_read_b128 a[224:227], v26 offset:8192
    v_mfma_f32_16x16x32_bf16 v[244:247], a[108:111], a[44:47], v[244:247]
    s_add_u32 s49, s49, 128
    v_mfma_f32_16x16x32_bf16 a[168:171], a[112:115], a[40:43], a[168:171]
    s_add_u32 m0, s48, 98304
    ds_read_b64_tr_b16 a[16:17], v30 offset:0
    v_mfma_f32_16x16x32_bf16 a[168:171], a[116:119], a[44:47], a[168:171]
    buffer_load_dwordx4 v18, s[20:23], s50 offen offset:0 lds
    v_mfma_f32_16x16x32_bf16 a[172:175], a[120:123], a[40:43], a[172:175]
    ds_read_b128 a[228:231], v27 offset:8192
    v_mfma_f32_16x16x32_bf16 a[172:175], a[124:127], a[44:47], a[172:175]
    ds_read_b64_tr_b16 a[18:19], v30 offset:2048
    v_mfma_f32_16x16x32_bf16 v[88:91], a[64:67], a[48:51], v[88:91]
    buffer_load_dwordx4 v19, s[20:23], s50 offen offset:1024 lds
    v_mfma_f32_16x16x32_bf16 v[88:91], a[68:71], a[52:55], v[88:91]
    ds_read_b128 a[232:235], v26 offset:10240
    v_mfma_f32_16x16x32_bf16 v[184:187], a[72:75], a[48:51], v[184:187]
    v_mfma_f32_16x16x32_bf16 v[184:187], a[76:79], a[52:55], v[184:187]
    buffer_load_dwordx4 v20, s[20:23], s50 offen offset:2048 lds
    ds_read_b64_tr_b16 a[20:21], v30 offset:16384
    v_mfma_f32_16x16x32_bf16 v[120:123], a[80:83], a[48:51], v[120:123]
    ds_read_b128 a[236:239], v27 offset:10240
    v_mfma_f32_16x16x32_bf16 v[120:123], a[84:87], a[52:55], v[120:123]
    v_mfma_f32_16x16x32_bf16 v[216:219], a[88:91], a[48:51], v[216:219]
    ds_read_b64_tr_b16 a[22:23], v30 offset:18432
    v_mfma_f32_16x16x32_bf16 v[216:219], a[92:95], a[52:55], v[216:219]
    buffer_load_dwordx4 v21, s[20:23], s50 offen offset:3072 lds
    v_mfma_f32_16x16x32_bf16 v[152:155], a[96:99], a[48:51], v[152:155]
    s_add_u32 m0, s48, 102400
    ds_read_b128 a[240:243], v26 offset:12288
    v_mfma_f32_16x16x32_bf16 v[152:155], a[100:103], a[52:55], v[152:155]
    ds_read_b64_tr_b16 a[24:25], v31 offset:0
    v_mfma_f32_16x16x32_bf16 v[248:251], a[104:107], a[48:51], v[248:251]
    buffer_load_dwordx4 v22, s[20:23], s50 offen offset:0 lds
    v_mfma_f32_16x16x32_bf16 v[248:251], a[108:111], a[52:55], v[248:251]
    ds_read_b128 a[244:247], v27 offset:12288
    v_mfma_f32_16x16x32_bf16 a[176:179], a[112:115], a[48:51], a[176:179]
    v_mfma_f32_16x16x32_bf16 a[176:179], a[116:119], a[52:55], a[176:179]
    ds_read_b64_tr_b16 a[26:27], v31 offset:2048
    v_mfma_f32_16x16x32_bf16 a[180:183], a[120:123], a[48:51], a[180:183]
    buffer_load_dwordx4 v23, s[20:23], s50 offen offset:1024 lds
    ds_read_b128 a[248:251], v26 offset:14336
    v_mfma_f32_16x16x32_bf16 a[180:183], a[124:127], a[52:55], a[180:183]
    v_mfma_f32_16x16x32_bf16 v[92:95], a[64:67], a[56:59], v[92:95]
    ds_read_b64_tr_b16 a[28:29], v31 offset:16384
    v_mfma_f32_16x16x32_bf16 v[92:95], a[68:71], a[60:63], v[92:95]
    buffer_load_dwordx4 v24, s[20:23], s50 offen offset:2048 lds
    v_mfma_f32_16x16x32_bf16 v[188:191], a[72:75], a[56:59], v[188:191]
    ds_read_b128 a[252:255], v27 offset:14336
    v_mfma_f32_16x16x32_bf16 v[188:191], a[76:79], a[60:63], v[188:191]
    ds_read_b64_tr_b16 a[30:31], v31 offset:18432
    v_mfma_f32_16x16x32_bf16 v[124:127], a[80:83], a[56:59], v[124:127]
    v_mfma_f32_16x16x32_bf16 v[124:127], a[84:87], a[60:63], v[124:127]
    buffer_load_dwordx4 v25, s[20:23], s50 offen offset:3072 lds
    v_mfma_f32_16x16x32_bf16 v[220:223], a[88:91], a[56:59], v[220:223]
    v_mfma_f32_16x16x32_bf16 v[220:223], a[92:95], a[60:63], v[220:223]
    s_add_u32 s50, s50, 0x80000
    v_mfma_f32_16x16x32_bf16 v[156:159], a[96:99], a[56:59], v[156:159]
    v_mfma_f32_16x16x32_bf16 v[156:159], a[100:103], a[60:63], v[156:159]
    s_cmp_eq_u32 s51, s53
    s_cbranch_scc1 k12_ool_42
k12_oolret_43:
    v_mfma_f32_16x16x32_bf16 v[252:255], a[104:107], a[56:59], v[252:255]
    s_cmp_eq_u32 s51, s63
    s_cbranch_scc1 k12_ool_44
k12_oolret_45:
    v_mfma_f32_16x16x32_bf16 v[252:255], a[108:111], a[60:63], v[252:255]
    s_cmp_eq_u32 s51, 5
    s_cbranch_scc1 k12_ool_46
k12_oolret_47:
    v_mfma_f32_16x16x32_bf16 a[184:187], a[112:115], a[56:59], a[184:187]
    v_mfma_f32_16x16x32_bf16 a[184:187], a[116:119], a[60:63], a[184:187]
    s_add_u32 s51, s51, 1
    v_mfma_f32_16x16x32_bf16 a[188:191], a[120:123], a[56:59], a[188:191]
    v_mfma_f32_16x16x32_bf16 a[188:191], a[124:127], a[60:63], a[188:191]
    s_waitcnt lgkmcnt(0)
    s_branch k12_loop_28
k12_last_29:
    v_mfma_f32_16x16x32_bf16 v[64:67], a[64:67], a[0:3], v[64:67]
    buffer_load_dwordx4 a[192:195], v36, s[8:11], s62 offen sc1
    v_mfma_f32_16x16x32_bf16 v[64:67], a[68:71], a[4:7], v[64:67]
    ds_read_b64_tr_b16 a[32:33], v32 offset:32768
    v_mfma_f32_16x16x32_bf16 v[160:163], a[72:75], a[0:3], v[160:163]
    buffer_load_dwordx4 a[196:199], v54, s[8:11], s62 offen sc1
    ds_read_b64_tr_b16 a[34:35], v32 offset:34816
    v_mfma_f32_16x16x32_bf16 v[160:163], a[76:79], a[4:7], v[160:163]
    v_mfma_f32_16x16x32_bf16 v[96:99], a[80:83], a[0:3], v[96:99]
    buffer_load_dwordx4 a[200:203], v37, s[8:11], s62 offen sc1
    v_mfma_f32_16x16x32_bf16 v[96:99], a[84:87], a[4:7], v[96:99]
    ds_read_b64_tr_b16 a[36:37], v32 offset:49152
    v_mfma_f32_16x16x32_bf16 v[192:195], a[88:91], a[0:3], v[192:195]
    buffer_load_dwordx4 a[204:207], v55, s[8:11], s62 offen sc1
    v_mfma_f32_16x16x32_bf16 v[192:195], a[92:95], a[4:7], v[192:195]
    s_add_u32 s62, s62, 0x20000
    ds_read_b64_tr_b16 a[38:39], v32 offset:51200
    v_mfma_f32_16x16x32_bf16 v[128:131], a[96:99], a[0:3], v[128:131]
    buffer_load_dwordx4 a[208:211], v36, s[8:11], s62 offen sc1
    v_mfma_f32_16x16x32_bf16 v[128:131], a[100:103], a[4:7], v[128:131]
    v_cvt_pk_bf16_f32 v64, v64, v65
    v_cvt_pk_bf16_f32 v65, v66, v67
    v_mfma_f32_16x16x32_bf16 v[224:227], a[104:107], a[0:3], v[224:227]
    v_cvt_pk_bf16_f32 v66, v160, v161
    v_cvt_pk_bf16_f32 v67, v162, v163
    v_mfma_f32_16x16x32_bf16 v[224:227], a[108:111], a[4:7], v[224:227]
    buffer_load_dwordx4 a[212:215], v54, s[8:11], s62 offen sc1
    ds_read_b64_tr_b16 a[40:41], v33 offset:32768
    v_mfma_f32_16x16x32_bf16 a[128:131], a[112:115], a[0:3], a[128:131]
    buffer_load_dwordx4 a[216:219], v37, s[8:11], s62 offen sc1
    ds_read_b64_tr_b16 a[42:43], v33 offset:34816
    v_mfma_f32_16x16x32_bf16 a[128:131], a[116:119], a[4:7], a[128:131]
    v_cvt_pk_bf16_f32 v96, v96, v97
    v_cvt_pk_bf16_f32 v97, v98, v99
    v_mfma_f32_16x16x32_bf16 a[132:135], a[120:123], a[0:3], a[132:135]
    v_cvt_pk_bf16_f32 v98, v192, v193
    v_cvt_pk_bf16_f32 v99, v194, v195
    v_mfma_f32_16x16x32_bf16 a[132:135], a[124:127], a[4:7], a[132:135]
    buffer_load_dwordx4 a[220:223], v55, s[8:11], s62 offen sc1
    ds_read_b64_tr_b16 a[44:45], v33 offset:49152
    v_mfma_f32_16x16x32_bf16 v[68:71], a[64:67], a[8:11], v[68:71]
    s_add_u32 s62, s62, 0x20000
    buffer_load_dwordx4 a[224:227], v36, s[8:11], s62 offen sc1
    v_mfma_f32_16x16x32_bf16 v[68:71], a[68:71], a[12:15], v[68:71]
    v_cvt_pk_bf16_f32 v128, v128, v129
    v_cvt_pk_bf16_f32 v129, v130, v131
    v_mfma_f32_16x16x32_bf16 v[164:167], a[72:75], a[8:11], v[164:167]
    ds_read_b64_tr_b16 a[46:47], v33 offset:51200
    v_cvt_pk_bf16_f32 v130, v224, v225
    v_mfma_f32_16x16x32_bf16 v[164:167], a[76:79], a[12:15], v[164:167]
    ds_read_b64_tr_b16 a[48:49], v34 offset:32768
    v_cvt_pk_bf16_f32 v131, v226, v227
    v_mfma_f32_16x16x32_bf16 v[100:103], a[80:83], a[8:11], v[100:103]
    buffer_load_dwordx4 a[228:231], v54, s[8:11], s62 offen sc1
    buffer_load_dwordx4 a[232:235], v37, s[8:11], s62 offen sc1
    v_mfma_f32_16x16x32_bf16 v[100:103], a[84:87], a[12:15], v[100:103]
    v_accvgpr_read_b32 v56, a128
    v_accvgpr_read_b32 v57, a129
    v_mfma_f32_16x16x32_bf16 v[196:199], a[88:91], a[8:11], v[196:199]
    v_accvgpr_read_b32 v58, a130
    v_accvgpr_read_b32 v59, a131
    v_mfma_f32_16x16x32_bf16 v[196:199], a[92:95], a[12:15], v[196:199]
    ds_read_b64_tr_b16 a[50:51], v34 offset:34816
    v_accvgpr_read_b32 v60, a132
    v_mfma_f32_16x16x32_bf16 v[132:135], a[96:99], a[8:11], v[132:135]
    buffer_load_dwordx4 a[236:239], v55, s[8:11], s62 offen sc1
    ds_read_b64_tr_b16 a[52:53], v34 offset:49152
    v_mfma_f32_16x16x32_bf16 v[132:135], a[100:103], a[12:15], v[132:135]
    s_add_u32 s62, s62, 0x20000
    v_accvgpr_read_b32 v61, a133
    v_accvgpr_read_b32 v62, a134
    v_mfma_f32_16x16x32_bf16 v[228:231], a[104:107], a[8:11], v[228:231]
    s_add_u32 s52, s47, 0
    v_accvgpr_read_b32 v63, a135
    v_cvt_pk_bf16_f32 v160, v56, v57
    v_mfma_f32_16x16x32_bf16 v[228:231], a[108:111], a[12:15], v[228:231]
    v_cvt_pk_bf16_f32 v161, v58, v59
    v_cvt_pk_bf16_f32 v68, v68, v69
    v_mfma_f32_16x16x32_bf16 a[136:139], a[112:115], a[8:11], a[136:139]
    v_cvt_pk_bf16_f32 v162, v60, v61
    v_cvt_pk_bf16_f32 v69, v70, v71
    v_mfma_f32_16x16x32_bf16 a[136:139], a[116:119], a[12:15], a[136:139]
    v_cvt_pk_bf16_f32 v163, v62, v63
    v_cvt_pk_bf16_f32 v70, v164, v165
    v_mfma_f32_16x16x32_bf16 a[140:143], a[120:123], a[8:11], a[140:143]
    ds_read_b64_tr_b16 a[54:55], v34 offset:51200
    v_cvt_pk_bf16_f32 v71, v166, v167
    v_mfma_f32_16x16x32_bf16 a[140:143], a[124:127], a[12:15], a[140:143]
    buffer_store_dwordx4 v[64:67], v1, s[32:35], s52 offen offset:0 sc1
    ds_read_b64_tr_b16 a[56:57], v35 offset:32768
    v_mfma_f32_16x16x32_bf16 v[72:75], a[64:67], a[16:19], v[72:75]
    v_cvt_pk_bf16_f32 v100, v100, v101
    v_cvt_pk_bf16_f32 v101, v102, v103
    v_mfma_f32_16x16x32_bf16 v[72:75], a[68:71], a[20:23], v[72:75]
    v_cvt_pk_bf16_f32 v102, v196, v197
    v_cvt_pk_bf16_f32 v103, v198, v199
    v_mfma_f32_16x16x32_bf16 v[168:171], a[72:75], a[16:19], v[168:171]
    ds_read_b64_tr_b16 a[58:59], v35 offset:34816
    v_cvt_pk_bf16_f32 v132, v132, v133
    v_mfma_f32_16x16x32_bf16 v[168:171], a[76:79], a[20:23], v[168:171]
    v_cvt_pk_bf16_f32 v133, v134, v135
    v_cvt_pk_bf16_f32 v134, v228, v229
    v_mfma_f32_16x16x32_bf16 v[104:107], a[80:83], a[16:19], v[104:107]
    ds_read_b64_tr_b16 a[60:61], v35 offset:49152
    v_cvt_pk_bf16_f32 v135, v230, v231
    v_mfma_f32_16x16x32_bf16 v[104:107], a[84:87], a[20:23], v[104:107]
    v_accvgpr_read_b32 v56, a136
    v_accvgpr_read_b32 v57, a137
    v_mfma_f32_16x16x32_bf16 v[200:203], a[88:91], a[16:19], v[200:203]
    s_add_u32 s52, s47, 8192
    ds_read_b64_tr_b16 a[62:63], v35 offset:51200
    v_accvgpr_read_b32 v58, a138
    v_mfma_f32_16x16x32_bf16 v[200:203], a[92:95], a[20:23], v[200:203]
    v_accvgpr_read_b32 v59, a139
    v_accvgpr_read_b32 v60, a140
    v_mfma_f32_16x16x32_bf16 v[136:139], a[96:99], a[16:19], v[136:139]
    v_accvgpr_read_b32 v61, a141
    v_accvgpr_read_b32 v62, a142
    v_mfma_f32_16x16x32_bf16 v[136:139], a[100:103], a[20:23], v[136:139]
    v_accvgpr_read_b32 v63, a143
    v_cvt_pk_bf16_f32 v164, v56, v57
    v_mfma_f32_16x16x32_bf16 v[232:235], a[104:107], a[16:19], v[232:235]
    buffer_store_dwordx4 v[96:99], v1, s[32:35], s52 offen offset:0 sc1
    v_mfma_f32_16x16x32_bf16 v[232:235], a[108:111], a[20:23], v[232:235]
    v_cvt_pk_bf16_f32 v165, v58, v59
    v_cvt_pk_bf16_f32 v72, v72, v73
    v_mfma_f32_16x16x32_bf16 a[144:147], a[112:115], a[16:19], a[144:147]
    v_cvt_pk_bf16_f32 v166, v60, v61
    v_cvt_pk_bf16_f32 v73, v74, v75
    v_mfma_f32_16x16x32_bf16 a[144:147], a[116:119], a[20:23], a[144:147]
    v_cvt_pk_bf16_f32 v167, v62, v63
    v_cvt_pk_bf16_f32 v74, v168, v169
    v_mfma_f32_16x16x32_bf16 a[148:151], a[120:123], a[16:19], a[148:151]
    v_cvt_pk_bf16_f32 v75, v170, v171
    v_cvt_pk_bf16_f32 v104, v104, v105
    v_mfma_f32_16x16x32_bf16 a[148:151], a[124:127], a[20:23], a[148:151]
    v_cvt_pk_bf16_f32 v105, v106, v107
    v_cvt_pk_bf16_f32 v106, v200, v201
    v_mfma_f32_16x16x32_bf16 v[76:79], a[64:67], a[24:27], v[76:79]
    v_cvt_pk_bf16_f32 v107, v202, v203
    v_mfma_f32_16x16x32_bf16 v[76:79], a[68:71], a[28:31], v[76:79]
    v_cvt_pk_bf16_f32 v136, v136, v137
    v_cvt_pk_bf16_f32 v137, v138, v139
    v_mfma_f32_16x16x32_bf16 v[172:175], a[72:75], a[24:27], v[172:175]
    s_add_u32 s52, s47, 524288
    v_cvt_pk_bf16_f32 v138, v232, v233
    v_cvt_pk_bf16_f32 v139, v234, v235
    v_mfma_f32_16x16x32_bf16 v[172:175], a[76:79], a[28:31], v[172:175]
    buffer_store_dwordx4 v[128:131], v1, s[32:35], s52 offen offset:0 sc1
    v_mfma_f32_16x16x32_bf16 v[108:111], a[80:83], a[24:27], v[108:111]
    v_mfma_f32_16x16x32_bf16 v[108:111], a[84:87], a[28:31], v[108:111]
    v_accvgpr_read_b32 v56, a144
    v_accvgpr_read_b32 v57, a145
    v_mfma_f32_16x16x32_bf16 v[204:207], a[88:91], a[24:27], v[204:207]
    v_accvgpr_read_b32 v58, a146
    v_accvgpr_read_b32 v59, a147
    v_mfma_f32_16x16x32_bf16 v[204:207], a[92:95], a[28:31], v[204:207]
    v_accvgpr_read_b32 v60, a148
    v_accvgpr_read_b32 v61, a149
    v_mfma_f32_16x16x32_bf16 v[140:143], a[96:99], a[24:27], v[140:143]
    v_accvgpr_read_b32 v62, a150
    v_accvgpr_read_b32 v63, a151
    v_mfma_f32_16x16x32_bf16 v[140:143], a[100:103], a[28:31], v[140:143]
    v_cvt_pk_bf16_f32 v168, v56, v57
    v_cvt_pk_bf16_f32 v169, v58, v59
    v_mfma_f32_16x16x32_bf16 v[236:239], a[104:107], a[24:27], v[236:239]
    v_cvt_pk_bf16_f32 v76, v76, v77
    v_cvt_pk_bf16_f32 v170, v60, v61
    v_mfma_f32_16x16x32_bf16 v[236:239], a[108:111], a[28:31], v[236:239]
    v_cvt_pk_bf16_f32 v77, v78, v79
    v_cvt_pk_bf16_f32 v171, v62, v63
    v_mfma_f32_16x16x32_bf16 a[152:155], a[112:115], a[24:27], a[152:155]
    s_waitcnt lgkmcnt(0)
    v_cvt_pk_bf16_f32 v78, v172, v173
    v_cvt_pk_bf16_f32 v79, v174, v175
    v_mfma_f32_16x16x32_bf16 a[152:155], a[116:119], a[28:31], a[152:155]
    v_cvt_pk_bf16_f32 v108, v108, v109
    v_cvt_pk_bf16_f32 v109, v110, v111
    v_mfma_f32_16x16x32_bf16 a[156:159], a[120:123], a[24:27], a[156:159]
    v_cvt_pk_bf16_f32 v110, v204, v205
    v_cvt_pk_bf16_f32 v111, v206, v207
    v_mfma_f32_16x16x32_bf16 a[156:159], a[124:127], a[28:31], a[156:159]
    s_add_u32 s52, s47, 532480
    v_mfma_f32_16x16x32_bf16 v[80:83], a[64:67], a[32:35], v[80:83]
    buffer_store_dwordx4 v[160:163], v1, s[32:35], s52 offen offset:0 sc1
    v_mfma_f32_16x16x32_bf16 v[80:83], a[68:71], a[36:39], v[80:83]
    v_cvt_pk_bf16_f32 v140, v140, v141
    v_cvt_pk_bf16_f32 v141, v142, v143
    v_mfma_f32_16x16x32_bf16 v[176:179], a[72:75], a[32:35], v[176:179]
    v_cvt_pk_bf16_f32 v142, v236, v237
    v_cvt_pk_bf16_f32 v143, v238, v239
    v_mfma_f32_16x16x32_bf16 v[176:179], a[76:79], a[36:39], v[176:179]
    v_mfma_f32_16x16x32_bf16 v[112:115], a[80:83], a[32:35], v[112:115]
    v_mfma_f32_16x16x32_bf16 v[112:115], a[84:87], a[36:39], v[112:115]
    v_accvgpr_read_b32 v56, a152
    v_accvgpr_read_b32 v57, a153
    v_mfma_f32_16x16x32_bf16 v[208:211], a[88:91], a[32:35], v[208:211]
    v_accvgpr_read_b32 v58, a154
    v_accvgpr_read_b32 v59, a155
    v_mfma_f32_16x16x32_bf16 v[208:211], a[92:95], a[36:39], v[208:211]
    v_accvgpr_read_b32 v60, a156
    v_accvgpr_read_b32 v61, a157
    v_mfma_f32_16x16x32_bf16 v[144:147], a[96:99], a[32:35], v[144:147]
    v_accvgpr_read_b32 v62, a158
    v_accvgpr_read_b32 v63, a159
    v_mfma_f32_16x16x32_bf16 v[144:147], a[100:103], a[36:39], v[144:147]
    v_cvt_pk_bf16_f32 v172, v56, v57
    v_cvt_pk_bf16_f32 v173, v58, v59
    v_mfma_f32_16x16x32_bf16 v[240:243], a[104:107], a[32:35], v[240:243]
    v_cvt_pk_bf16_f32 v80, v80, v81
    v_cvt_pk_bf16_f32 v174, v60, v61
    v_mfma_f32_16x16x32_bf16 v[240:243], a[108:111], a[36:39], v[240:243]
    s_add_u32 s52, s47, 0
    v_cvt_pk_bf16_f32 v81, v82, v83
    v_cvt_pk_bf16_f32 v175, v62, v63
    v_mfma_f32_16x16x32_bf16 a[160:163], a[112:115], a[32:35], a[160:163]
    v_cvt_pk_bf16_f32 v82, v176, v177
    v_cvt_pk_bf16_f32 v83, v178, v179
    v_mfma_f32_16x16x32_bf16 a[160:163], a[116:119], a[36:39], a[160:163]
    v_cvt_pk_bf16_f32 v112, v112, v113
    v_cvt_pk_bf16_f32 v113, v114, v115
    v_mfma_f32_16x16x32_bf16 a[164:167], a[120:123], a[32:35], a[164:167]
    buffer_store_dwordx4 v[68:71], v1, s[32:35], s52 offen offset:1024 sc1
    v_mfma_f32_16x16x32_bf16 a[164:167], a[124:127], a[36:39], a[164:167]
    v_cvt_pk_bf16_f32 v114, v208, v209
    v_cvt_pk_bf16_f32 v115, v210, v211
    v_mfma_f32_16x16x32_bf16 v[84:87], a[64:67], a[40:43], v[84:87]
    v_mfma_f32_16x16x32_bf16 v[84:87], a[68:71], a[44:47], v[84:87]
    v_cvt_pk_bf16_f32 v144, v144, v145
    v_cvt_pk_bf16_f32 v145, v146, v147
    v_mfma_f32_16x16x32_bf16 v[180:183], a[72:75], a[40:43], v[180:183]
    v_cvt_pk_bf16_f32 v146, v240, v241
    v_cvt_pk_bf16_f32 v147, v242, v243
    v_mfma_f32_16x16x32_bf16 v[180:183], a[76:79], a[44:47], v[180:183]
    v_mfma_f32_16x16x32_bf16 v[116:119], a[80:83], a[40:43], v[116:119]
    v_mfma_f32_16x16x32_bf16 v[116:119], a[84:87], a[44:47], v[116:119]
    v_accvgpr_read_b32 v56, a160
    v_accvgpr_read_b32 v57, a161
    v_mfma_f32_16x16x32_bf16 v[212:215], a[88:91], a[40:43], v[212:215]
    v_accvgpr_read_b32 v58, a162
    v_accvgpr_read_b32 v59, a163
    v_mfma_f32_16x16x32_bf16 v[212:215], a[92:95], a[44:47], v[212:215]
    s_add_u32 s52, s47, 8192
    v_accvgpr_read_b32 v60, a164
    v_accvgpr_read_b32 v61, a165
    v_mfma_f32_16x16x32_bf16 v[148:151], a[96:99], a[40:43], v[148:151]
    v_accvgpr_read_b32 v62, a166
    v_accvgpr_read_b32 v63, a167
    v_mfma_f32_16x16x32_bf16 v[148:151], a[100:103], a[44:47], v[148:151]
    v_cvt_pk_bf16_f32 v176, v56, v57
    v_cvt_pk_bf16_f32 v177, v58, v59
    v_mfma_f32_16x16x32_bf16 v[244:247], a[104:107], a[40:43], v[244:247]
    v_cvt_pk_bf16_f32 v84, v84, v85
    v_cvt_pk_bf16_f32 v178, v60, v61
    v_mfma_f32_16x16x32_bf16 v[244:247], a[108:111], a[44:47], v[244:247]
    buffer_store_dwordx4 v[100:103], v1, s[32:35], s52 offen offset:1024 sc1
    v_mfma_f32_16x16x32_bf16 a[168:171], a[112:115], a[40:43], a[168:171]
    v_cvt_pk_bf16_f32 v85, v86, v87
    v_cvt_pk_bf16_f32 v179, v62, v63
    v_mfma_f32_16x16x32_bf16 a[168:171], a[116:119], a[44:47], a[168:171]
    v_cvt_pk_bf16_f32 v86, v180, v181
    v_cvt_pk_bf16_f32 v87, v182, v183
    v_mfma_f32_16x16x32_bf16 a[172:175], a[120:123], a[40:43], a[172:175]
    v_cvt_pk_bf16_f32 v116, v116, v117
    v_cvt_pk_bf16_f32 v117, v118, v119
    v_mfma_f32_16x16x32_bf16 a[172:175], a[124:127], a[44:47], a[172:175]
    v_cvt_pk_bf16_f32 v118, v212, v213
    v_cvt_pk_bf16_f32 v119, v214, v215
    v_mfma_f32_16x16x32_bf16 v[88:91], a[64:67], a[48:51], v[88:91]
    s_waitcnt vmcnt(12)
    s_barrier
    v_mfma_f32_16x16x32_bf16 v[88:91], a[68:71], a[52:55], v[88:91]
    ds_read_b64_tr_b16 a[0:1], v42 offset:32768
    v_cvt_pk_bf16_f32 v148, v148, v149
    v_mfma_f32_16x16x32_bf16 v[184:187], a[72:75], a[48:51], v[184:187]
    v_cvt_pk_bf16_f32 v149, v150, v151
    v_cvt_pk_bf16_f32 v150, v244, v245
    v_mfma_f32_16x16x32_bf16 v[184:187], a[76:79], a[52:55], v[184:187]
    s_add_u32 s52, s47, 524288
    ds_read_b64_tr_b16 a[2:3], v42 offset:33792
    v_cvt_pk_bf16_f32 v151, v246, v247
    v_mfma_f32_16x16x32_bf16 v[120:123], a[80:83], a[48:51], v[120:123]
    ds_read_b64_tr_b16 a[4:5], v43 offset:32768
    ds_read_b64_tr_b16 a[6:7], v43 offset:33792
    v_mfma_f32_16x16x32_bf16 v[120:123], a[84:87], a[52:55], v[120:123]
    v_accvgpr_read_b32 v56, a168
    v_accvgpr_read_b32 v57, a169
    v_mfma_f32_16x16x32_bf16 v[216:219], a[88:91], a[48:51], v[216:219]
    buffer_store_dwordx4 v[132:135], v1, s[32:35], s52 offen offset:1024 sc1
    ds_read_b64_tr_b16 a[8:9], v44 offset:32768
    v_mfma_f32_16x16x32_bf16 v[216:219], a[92:95], a[52:55], v[216:219]
    v_accvgpr_read_b32 v58, a170
    v_accvgpr_read_b32 v59, a171
    v_mfma_f32_16x16x32_bf16 v[152:155], a[96:99], a[48:51], v[152:155]
    v_accvgpr_read_b32 v60, a172
    v_accvgpr_read_b32 v61, a173
    v_mfma_f32_16x16x32_bf16 v[152:155], a[100:103], a[52:55], v[152:155]
    v_accvgpr_read_b32 v62, a174
    v_accvgpr_read_b32 v63, a175
    v_mfma_f32_16x16x32_bf16 v[248:251], a[104:107], a[48:51], v[248:251]
    ds_read_b64_tr_b16 a[10:11], v44 offset:33792
    v_cvt_pk_bf16_f32 v180, v56, v57
    v_mfma_f32_16x16x32_bf16 v[248:251], a[108:111], a[52:55], v[248:251]
    v_cvt_pk_bf16_f32 v181, v58, v59
    v_cvt_pk_bf16_f32 v88, v88, v89
    v_mfma_f32_16x16x32_bf16 a[176:179], a[112:115], a[48:51], a[176:179]
    v_cvt_pk_bf16_f32 v182, v60, v61
    v_cvt_pk_bf16_f32 v89, v90, v91
    v_mfma_f32_16x16x32_bf16 a[176:179], a[116:119], a[52:55], a[176:179]
    ds_read_b64_tr_b16 a[12:13], v45 offset:32768
    v_cvt_pk_bf16_f32 v183, v62, v63
    v_mfma_f32_16x16x32_bf16 a[180:183], a[120:123], a[48:51], a[180:183]
    v_cvt_pk_bf16_f32 v90, v184, v185
    v_cvt_pk_bf16_f32 v91, v186, v187
    v_mfma_f32_16x16x32_bf16 a[180:183], a[124:127], a[52:55], a[180:183]
    ds_read_b64_tr_b16 a[14:15], v45 offset:33792
    ds_read_b64_tr_b16 a[16:17], v46 offset:32768
    v_mfma_f32_16x16x32_bf16 v[92:95], a[64:67], a[56:59], v[92:95]
    s_add_u32 s52, s47, 532480
    v_cvt_pk_bf16_f32 v120, v120, v121
    v_cvt_pk_bf16_f32 v121, v122, v123
    v_mfma_f32_16x16x32_bf16 v[92:95], a[68:71], a[60:63], v[92:95]
    ds_read_b64_tr_b16 a[18:19], v46 offset:33792
    v_cvt_pk_bf16_f32 v122, v216, v217
    v_mfma_f32_16x16x32_bf16 v[188:191], a[72:75], a[56:59], v[188:191]
    ds_read_b64_tr_b16 a[20:21], v47 offset:32768
    v_cvt_pk_bf16_f32 v123, v218, v219
    v_mfma_f32_16x16x32_bf16 v[188:191], a[76:79], a[60:63], v[188:191]
    ds_read_b64_tr_b16 a[22:23], v47 offset:33792
    v_cvt_pk_bf16_f32 v152, v152, v153
    v_mfma_f32_16x16x32_bf16 v[124:127], a[80:83], a[56:59], v[124:127]
    v_cvt_pk_bf16_f32 v153, v154, v155
    v_cvt_pk_bf16_f32 v154, v248, v249
    v_mfma_f32_16x16x32_bf16 v[124:127], a[84:87], a[60:63], v[124:127]
    buffer_store_dwordx4 v[164:167], v1, s[32:35], s52 offen offset:1024 sc1
    ds_read_b64_tr_b16 a[24:25], v48 offset:32768
    v_mfma_f32_16x16x32_bf16 v[220:223], a[88:91], a[56:59], v[220:223]
    ds_read_b64_tr_b16 a[26:27], v48 offset:33792
    v_cvt_pk_bf16_f32 v155, v250, v251
    v_mfma_f32_16x16x32_bf16 v[220:223], a[92:95], a[60:63], v[220:223]
    ds_read_b64_tr_b16 a[28:29], v49 offset:32768
    v_accvgpr_read_b32 v56, a176
    v_mfma_f32_16x16x32_bf16 v[156:159], a[96:99], a[56:59], v[156:159]
    v_accvgpr_read_b32 v57, a177
    v_accvgpr_read_b32 v58, a178
    v_mfma_f32_16x16x32_bf16 v[156:159], a[100:103], a[60:63], v[156:159]
    ds_read_b64_tr_b16 a[30:31], v49 offset:33792
    v_accvgpr_read_b32 v59, a179
    v_mfma_f32_16x16x32_bf16 v[252:255], a[104:107], a[56:59], v[252:255]
    v_accvgpr_read_b32 v60, a180
    v_accvgpr_read_b32 v61, a181
    v_mfma_f32_16x16x32_bf16 v[252:255], a[108:111], a[60:63], v[252:255]
    v_accvgpr_read_b32 v62, a182
    v_accvgpr_read_b32 v63, a183
    v_mfma_f32_16x16x32_bf16 a[184:187], a[112:115], a[56:59], a[184:187]
    v_cvt_pk_bf16_f32 v184, v56, v57
    v_cvt_pk_bf16_f32 v185, v58, v59
    v_mfma_f32_16x16x32_bf16 a[184:187], a[116:119], a[60:63], a[184:187]
    v_cvt_pk_bf16_f32 v92, v92, v93
    v_cvt_pk_bf16_f32 v186, v60, v61
    v_mfma_f32_16x16x32_bf16 a[188:191], a[120:123], a[56:59], a[188:191]
    v_cvt_pk_bf16_f32 v93, v94, v95
    v_cvt_pk_bf16_f32 v187, v62, v63
    v_mfma_f32_16x16x32_bf16 a[188:191], a[124:127], a[60:63], a[188:191]
    v_cvt_pk_bf16_f32 v94, v188, v189
    v_cvt_pk_bf16_f32 v95, v190, v191
    v_cvt_pk_bf16_f32 v124, v124, v125
    v_cvt_pk_bf16_f32 v125, v126, v127
    v_cvt_pk_bf16_f32 v126, v220, v221
    v_cvt_pk_bf16_f32 v127, v222, v223
    v_cvt_pk_bf16_f32 v156, v156, v157
    v_cvt_pk_bf16_f32 v157, v158, v159
    v_cvt_pk_bf16_f32 v158, v252, v253
    v_cvt_pk_bf16_f32 v159, v254, v255
    v_accvgpr_read_b32 v56, a184
    v_accvgpr_read_b32 v57, a185
    v_accvgpr_read_b32 v58, a186
    v_accvgpr_read_b32 v59, a187
    v_accvgpr_read_b32 v60, a188
    v_accvgpr_read_b32 v61, a189
    v_accvgpr_read_b32 v62, a190
    v_accvgpr_read_b32 v63, a191
    v_cvt_pk_bf16_f32 v188, v56, v57
    v_cvt_pk_bf16_f32 v189, v58, v59
    v_cvt_pk_bf16_f32 v190, v60, v61
    v_cvt_pk_bf16_f32 v191, v62, v63
k12_join_7:
k12_qcode:
    s_mov_b64 s[48:49], s[32:33]
    s_mov_b32 s51, 0x00020000
    s_cmp_eq_u32 s45, 0
    s_mov_b32 s50, s34
    s_cselect_b32 s56, s30, -1
    s_cselect_b32 s57, -1, s30
    s_waitcnt vmcnt(16) lgkmcnt(0)
    v_mfma_f32_16x16x32_bf16 v[192:195], a[0:3], a[192:195], 0
    ds_read_b64_tr_b16 a[32:33], v42 offset:40960
    ds_read_b64_tr_b16 a[34:35], v42 offset:41984
    v_mfma_f32_16x16x32_bf16 v[196:199], a[0:3], a[196:199], 0
    buffer_load_dwordx4 a[240:243], v36, s[8:11], s62 offen sc1
    v_mfma_f32_16x16x32_bf16 a[64:67], a[0:3], a[200:203], 0
    ds_read_b64_tr_b16 a[36:37], v43 offset:40960
    v_mfma_f32_16x16x32_bf16 a[68:71], a[0:3], a[204:207], 0
    ds_read_b64_tr_b16 a[38:39], v43 offset:41984
    v_mfma_f32_16x16x32_bf16 v[200:203], a[4:7], a[192:195], 0
    ds_read_b64_tr_b16 a[40:41], v44 offset:40960
    v_mfma_f32_16x16x32_bf16 v[204:207], a[4:7], a[196:199], 0
    v_mfma_f32_16x16x32_bf16 a[72:75], a[4:7], a[200:203], 0
    s_lshl_b32 s31, s28, 14
    ds_read_b64_tr_b16 a[42:43], v44 offset:41984
    v_mfma_f32_16x16x32_bf16 a[76:79], a[4:7], a[204:207], 0
    s_add_u32 s16, s6, s31
    s_addc_u32 s17, s7, 0
    buffer_load_dwordx4 a[244:247], v54, s[8:11], s62 offen sc1
    ds_read_b64_tr_b16 a[44:45], v45 offset:40960
    v_mfma_f32_16x16x32_bf16 v[208:211], a[8:11], a[192:195], 0
    v_mfma_f32_16x16x32_bf16 v[212:215], a[8:11], a[196:199], 0
    s_add_u32 s20, s16, 0x2000000
    s_addc_u32 s21, s17, 0
    ds_read_b64_tr_b16 a[46:47], v45 offset:41984
    v_mfma_f32_16x16x32_bf16 a[80:83], a[8:11], a[200:203], 0
    ds_read_b64_tr_b16 a[48:49], v46 offset:40960
    v_mfma_f32_16x16x32_bf16 a[84:87], a[8:11], a[204:207], 0
    s_add_u32 s16, s16, 0x1000000
    s_addc_u32 s17, s17, 0
    ds_read_b64_tr_b16 a[50:51], v46 offset:41984
    v_mfma_f32_16x16x32_bf16 v[216:219], a[12:15], a[192:195], 0
    v_mfma_f32_16x16x32_bf16 v[220:223], a[12:15], a[196:199], 0
    s_and_b32 s17, s17, 0xffff
    ds_read_b64_tr_b16 a[52:53], v47 offset:40960
    v_mfma_f32_16x16x32_bf16 a[88:91], a[12:15], a[200:203], 0
    buffer_load_dwordx4 a[248:251], v37, s[8:11], s62 offen sc1
    ds_read_b64_tr_b16 a[54:55], v47 offset:41984
    v_mfma_f32_16x16x32_bf16 a[92:95], a[12:15], a[204:207], 0
    s_and_b32 s21, s21, 0xffff
    ds_read_b64_tr_b16 a[56:57], v48 offset:40960
    v_mfma_f32_16x16x32_bf16 v[224:227], a[16:19], a[192:195], 0
    v_mfma_f32_16x16x32_bf16 v[228:231], a[16:19], a[196:199], 0
    s_lshl_b32 s31, s29, 20
    ds_read_b64_tr_b16 a[58:59], v48 offset:41984
    v_mfma_f32_16x16x32_bf16 a[96:99], a[16:19], a[200:203], 0
    ds_read_b64_tr_b16 a[60:61], v49 offset:40960
    v_mfma_f32_16x16x32_bf16 a[100:103], a[16:19], a[204:207], 0
    s_sub_u32 s18, 0xf84000, s31
    v_mfma_f32_16x16x32_bf16 v[232:235], a[20:23], a[192:195], 0
    buffer_load_dwordx4 a[252:255], v55, s[8:11], s62 offen sc1
    ds_read_b64_tr_b16 a[62:63], v49 offset:41984
    v_mfma_f32_16x16x32_bf16 v[236:239], a[20:23], a[196:199], 0
    s_mov_b32 s22, s18
    v_mfma_f32_16x16x32_bf16 a[104:107], a[20:23], a[200:203], 0
    v_mfma_f32_16x16x32_bf16 a[108:111], a[20:23], a[204:207], 0
    s_add_u32 s24, s6, 0x4806000
    s_addc_u32 s25, s7, 0
    v_mfma_f32_16x16x32_bf16 v[240:243], a[24:27], a[192:195], 0
    v_mfma_f32_16x16x32_bf16 v[244:247], a[24:27], a[196:199], 0
    s_and_b32 s25, s25, 0xffff
    v_mfma_f32_16x16x32_bf16 a[112:115], a[24:27], a[200:203], 0
    s_add_u32 s62, s62, 0x20000
    v_mfma_f32_16x16x32_bf16 a[116:119], a[24:27], a[204:207], 0
    s_mov_b32 s26, 4096
    v_mfma_f32_16x16x32_bf16 v[248:251], a[28:31], a[192:195], 0
    s_cmp_eq_u32 s45, 0
    s_cbranch_scc1 k12_ool_48
k12_oolret_49:
    v_mfma_f32_16x16x32_bf16 v[252:255], a[28:31], a[196:199], 0
    v_mfma_f32_16x16x32_bf16 a[120:123], a[28:31], a[200:203], 0
    v_mfma_f32_16x16x32_bf16 a[124:127], a[28:31], a[204:207], 0
    s_waitcnt vmcnt(16) lgkmcnt(0)
    s_barrier
    v_mfma_f32_16x16x32_bf16 v[192:195], a[32:35], a[208:211], v[192:195]
    ds_read_b64_tr_b16 a[0:1], v42 offset:49152
    ds_read_b64_tr_b16 a[2:3], v42 offset:50176
    v_mfma_f32_16x16x32_bf16 v[196:199], a[32:35], a[212:215], v[196:199]
    s_add_u32 m0, s60, 98304
    v_mfma_f32_16x16x32_bf16 a[64:67], a[32:35], a[216:219], a[64:67]
    buffer_load_dwordx4 v38, s[12:15], s61 offen offset:0 lds
    ds_read_b64_tr_b16 a[4:5], v43 offset:49152
    v_mfma_f32_16x16x32_bf16 a[68:71], a[32:35], a[220:223], a[68:71]
    ds_read_b64_tr_b16 a[6:7], v43 offset:50176
    v_mfma_f32_16x16x32_bf16 v[200:203], a[36:39], a[208:211], v[200:203]
    buffer_load_dwordx4 v39, s[12:15], s61 offen offset:1024 lds
    ds_read_b64_tr_b16 a[8:9], v44 offset:49152
    v_mfma_f32_16x16x32_bf16 v[204:207], a[36:39], a[212:215], v[204:207]
    v_mfma_f32_16x16x32_bf16 a[72:75], a[36:39], a[216:219], a[72:75]
    ds_read_b64_tr_b16 a[10:11], v44 offset:50176
    v_mfma_f32_16x16x32_bf16 a[76:79], a[36:39], a[220:223], a[76:79]
    buffer_load_dwordx4 v40, s[12:15], s61 offen offset:2048 lds
    ds_read_b64_tr_b16 a[12:13], v45 offset:49152
    v_mfma_f32_16x16x32_bf16 v[208:211], a[40:43], a[208:211], v[208:211]
    v_mfma_f32_16x16x32_bf16 v[212:215], a[40:43], a[212:215], v[212:215]
    ds_read_b64_tr_b16 a[14:15], v45 offset:50176
    v_mfma_f32_16x16x32_bf16 a[80:83], a[40:43], a[216:219], a[80:83]
    buffer_load_dwordx4 v41, s[12:15], s61 offen offset:3072 lds
    ds_read_b64_tr_b16 a[16:17], v46 offset:49152
    v_mfma_f32_16x16x32_bf16 a[84:87], a[40:43], a[220:223], a[84:87]
    ds_read_b64_tr_b16 a[18:19], v46 offset:50176
    v_mfma_f32_16x16x32_bf16 v[216:219], a[44:47], a[208:211], v[216:219]
    s_add_u32 s61, s61, 0x80000
    v_mfma_f32_16x16x32_bf16 v[220:223], a[44:47], a[212:215], v[220:223]
    buffer_load_dwordx4 a[128:131], v36, s[8:11], s62 offen sc1
    ds_read_b64_tr_b16 a[20:21], v47 offset:49152
    v_mfma_f32_16x16x32_bf16 a[88:91], a[44:47], a[216:219], a[88:91]
    ds_read_b64_tr_b16 a[22:23], v47 offset:50176
    v_mfma_f32_16x16x32_bf16 a[92:95], a[44:47], a[220:223], a[92:95]
    buffer_load_dwordx4 a[132:135], v54, s[8:11], s62 offen sc1
    ds_read_b64_tr_b16 a[24:25], v48 offset:49152
    v_mfma_f32_16x16x32_bf16 v[224:227], a[48:51], a[208:211], v[224:227]
    v_mfma_f32_16x16x32_bf16 v[228:231], a[48:51], a[212:215], v[228:231]
    ds_read_b64_tr_b16 a[26:27], v48 offset:50176
    v_mfma_f32_16x16x32_bf16 a[96:99], a[48:51], a[216:219], a[96:99]
    buffer_load_dwordx4 a[136:139], v37, s[8:11], s62 offen sc1
    ds_read_b64_tr_b16 a[28:29], v49 offset:49152
    v_mfma_f32_16x16x32_bf16 a[100:103], a[48:51], a[220:223], a[100:103]
    v_mfma_f32_16x16x32_bf16 v[232:235], a[52:55], a[208:211], v[232:235]
    ds_read_b64_tr_b16 a[30:31], v49 offset:50176
    v_mfma_f32_16x16x32_bf16 v[236:239], a[52:55], a[212:215], v[236:239]
    buffer_load_dwordx4 a[140:143], v55, s[8:11], s62 offen sc1
    v_mfma_f32_16x16x32_bf16 a[104:107], a[52:55], a[216:219], a[104:107]
    v_mfma_f32_16x16x32_bf16 a[108:111], a[52:55], a[220:223], a[108:111]
    s_add_u32 s62, s62, 0x20000
    v_mfma_f32_16x16x32_bf16 v[240:243], a[56:59], a[208:211], v[240:243]
    s_add_u32 s52, s47, 0
    v_mfma_f32_16x16x32_bf16 v[244:247], a[56:59], a[212:215], v[244:247]
    buffer_store_dwordx4 v[72:75], v1, s[48:51], s52 offen offset:2048 sc1
    v_mfma_f32_16x16x32_bf16 a[112:115], a[56:59], a[216:219], a[112:115]
    v_mfma_f32_16x16x32_bf16 a[116:119], a[56:59], a[220:223], a[116:119]
    v_mfma_f32_16x16x32_bf16 v[248:251], a[60:63], a[208:211], v[248:251]
    v_mfma_f32_16x16x32_bf16 v[252:255], a[60:63], a[212:215], v[252:255]
    v_mfma_f32_16x16x32_bf16 a[120:123], a[60:63], a[216:219], a[120:123]
    v_mfma_f32_16x16x32_bf16 a[124:127], a[60:63], a[220:223], a[124:127]
    s_waitcnt vmcnt(21) lgkmcnt(0)
    v_mfma_f32_16x16x32_bf16 v[192:195], a[0:3], a[224:227], v[192:195]
    ds_read_b64_tr_b16 a[32:33], v42 offset:57344
    ds_read_b64_tr_b16 a[34:35], v42 offset:58368
    v_mfma_f32_16x16x32_bf16 v[196:199], a[0:3], a[228:231], v[196:199]
    buffer_load_dwordx4 a[144:147], v36, s[8:11], s62 offen sc1
    v_mfma_f32_16x16x32_bf16 a[64:67], a[0:3], a[232:235], a[64:67]
    ds_read_b64_tr_b16 a[36:37], v43 offset:57344
    v_mfma_f32_16x16x32_bf16 a[68:71], a[0:3], a[236:239], a[68:71]
    ds_read_b64_tr_b16 a[38:39], v43 offset:58368
    v_mfma_f32_16x16x32_bf16 v[200:203], a[4:7], a[224:227], v[200:203]
    ds_read_b64_tr_b16 a[40:41], v44 offset:57344
    v_mfma_f32_16x16x32_bf16 v[204:207], a[4:7], a[228:231], v[204:207]
    v_mfma_f32_16x16x32_bf16 a[72:75], a[4:7], a[232:235], a[72:75]
    buffer_load_dwordx4 a[148:151], v54, s[8:11], s62 offen sc1
    ds_read_b64_tr_b16 a[42:43], v44 offset:58368
    v_mfma_f32_16x16x32_bf16 a[76:79], a[4:7], a[236:239], a[76:79]
    ds_read_b64_tr_b16 a[44:45], v45 offset:57344
    v_mfma_f32_16x16x32_bf16 v[208:211], a[8:11], a[224:227], v[208:211]
    v_mfma_f32_16x16x32_bf16 v[212:215], a[8:11], a[228:231], v[212:215]
    ds_read_b64_tr_b16 a[46:47], v45 offset:58368
    v_mfma_f32_16x16x32_bf16 a[80:83], a[8:11], a[232:235], a[80:83]
    ds_read_b64_tr_b16 a[48:49], v46 offset:57344
    v_mfma_f32_16x16x32_bf16 a[84:87], a[8:11], a[236:239], a[84:87]
    buffer_load_dwordx4 a[152:155], v37, s[8:11], s62 offen sc1
    ds_read_b64_tr_b16 a[50:51], v46 offset:58368
    v_mfma_f32_16x16x32_bf16 v[216:219], a[12:15], a[224:227], v[216:219]
    v_mfma_f32_16x16x32_bf16 v[220:223], a[12:15], a[228:231], v[220:223]
    ds_read_b64_tr_b16 a[52:53], v47 offset:57344
    v_mfma_f32_16x16x32_bf16 a[88:91], a[12:15], a[232:235], a[88:91]
    ds_read_b64_tr_b16 a[54:55], v47 offset:58368
    v_mfma_f32_16x16x32_bf16 a[92:95], a[12:15], a[236:239], a[92:95]
    ds_read_b64_tr_b16 a[56:57], v48 offset:57344
    v_mfma_f32_16x16x32_bf16 v[224:227], a[16:19], a[224:227], v[224:227]
    v_mfma_f32_16x16x32_bf16 v[228:231], a[16:19], a[228:231], v[228:231]
    buffer_load_dwordx4 a[156:159], v55, s[8:11], s62 offen sc1
    ds_read_b64_tr_b16 a[58:59], v48 offset:58368
    v_mfma_f32_16x16x32_bf16 a[96:99], a[16:19], a[232:235], a[96:99]
    ds_read_b64_tr_b16 a[60:61], v49 offset:57344
    v_mfma_f32_16x16x32_bf16 a[100:103], a[16:19], a[236:239], a[100:103]
    v_mfma_f32_16x16x32_bf16 v[232:235], a[20:23], a[224:227], v[232:235]
    ds_read_b64_tr_b16 a[62:63], v49 offset:58368
    v_mfma_f32_16x16x32_bf16 v[236:239], a[20:23], a[228:231], v[236:239]
    s_add_u32 s62, s62, 0x20000
    v_mfma_f32_16x16x32_bf16 a[104:107], a[20:23], a[232:235], a[104:107]
    s_add_u32 s52, s47, 0
    v_mfma_f32_16x16x32_bf16 a[108:111], a[20:23], a[236:239], a[108:111]
    buffer_store_dwordx4 v[76:79], v1, s[48:51], s52 offen offset:3072 sc1
    v_mfma_f32_16x16x32_bf16 v[240:243], a[24:27], a[224:227], v[240:243]
    v_mfma_f32_16x16x32_bf16 v[244:247], a[24:27], a[228:231], v[244:247]
    v_mfma_f32_16x16x32_bf16 a[112:115], a[24:27], a[232:235], a[112:115]
    v_mfma_f32_16x16x32_bf16 a[116:119], a[24:27], a[236:239], a[116:119]
    v_mfma_f32_16x16x32_bf16 v[248:251], a[28:31], a[224:227], v[248:251]
    s_cmp_eq_u32 s45, 0
    s_cbranch_scc1 k12_ool_50
k12_oolret_51:
    v_mfma_f32_16x16x32_bf16 v[252:255], a[28:31], a[228:231], v[252:255]
    v_mfma_f32_16x16x32_bf16 a[120:123], a[28:31], a[232:235], a[120:123]
    v_mfma_f32_16x16x32_bf16 a[124:127], a[28:31], a[236:239], a[124:127]
    s_waitcnt vmcnt(10) lgkmcnt(0)
    s_barrier
    v_mfma_f32_16x16x32_bf16 v[192:195], a[32:35], a[240:243], v[192:195]
    ds_read_b64_tr_b16 a[0:1], v42 offset:0
    ds_read_b64_tr_b16 a[2:3], v42 offset:1024
    v_mfma_f32_16x16x32_bf16 v[196:199], a[32:35], a[244:247], v[196:199]
    s_add_u32 m0, s60, 114688
    v_mfma_f32_16x16x32_bf16 a[64:67], a[32:35], a[248:251], a[64:67]
    buffer_load_dwordx4 v38, s[12:15], s61 offen offset:0 lds
    ds_read_b64_tr_b16 a[4:5], v43 offset:0
    v_mfma_f32_16x16x32_bf16 a[68:71], a[32:35], a[252:255], a[68:71]
    ds_read_b64_tr_b16 a[6:7], v43 offset:1024
    v_mfma_f32_16x16x32_bf16 v[200:203], a[36:39], a[240:243], v[200:203]
    buffer_load_dwordx4 v39, s[12:15], s61 offen offset:1024 lds
    ds_read_b64_tr_b16 a[8:9], v44 offset:0
    v_mfma_f32_16x16x32_bf16 v[204:207], a[36:39], a[244:247], v[204:207]
    v_mfma_f32_16x16x32_bf16 a[72:75], a[36:39], a[248:251], a[72:75]
    ds_read_b64_tr_b16 a[10:11], v44 offset:1024
    v_mfma_f32_16x16x32_bf16 a[76:79], a[36:39], a[252:255], a[76:79]
    buffer_load_dwordx4 v40, s[12:15], s61 offen offset:2048 lds
    ds_read_b64_tr_b16 a[12:13], v45 offset:0
    v_mfma_f32_16x16x32_bf16 v[208:211], a[40:43], a[240:243], v[208:211]
    v_mfma_f32_16x16x32_bf16 v[212:215], a[40:43], a[244:247], v[212:215]
    ds_read_b64_tr_b16 a[14:15], v45 offset:1024
    v_mfma_f32_16x16x32_bf16 a[80:83], a[40:43], a[248:251], a[80:83]
    buffer_load_dwordx4 v41, s[12:15], s61 offen offset:3072 lds
    ds_read_b64_tr_b16 a[16:17], v46 offset:0
    v_mfma_f32_16x16x32_bf16 a[84:87], a[40:43], a[252:255], a[84:87]
    ds_read_b64_tr_b16 a[18:19], v46 offset:1024
    v_mfma_f32_16x16x32_bf16 v[216:219], a[44:47], a[240:243], v[216:219]
    s_add_u32 s61, s61, 0x80000
    v_mfma_f32_16x16x32_bf16 v[220:223], a[44:47], a[244:247], v[220:223]
    buffer_load_dwordx4 a[160:163], v36, s[8:11], s62 offen sc1
    ds_read_b64_tr_b16 a[20:21], v47 offset:0
    v_mfma_f32_16x16x32_bf16 a[88:91], a[44:47], a[248:251], a[88:91]
    ds_read_b64_tr_b16 a[22:23], v47 offset:1024
    v_mfma_f32_16x16x32_bf16 a[92:95], a[44:47], a[252:255], a[92:95]
    buffer_load_dwordx4 a[164:167], v54, s[8:11], s62 offen sc1
    ds_read_b64_tr_b16 a[24:25], v48 offset:0
    v_mfma_f32_16x16x32_bf16 v[224:227], a[48:51], a[240:243], v[224:227]
    v_mfma_f32_16x16x32_bf16 v[228:231], a[48:51], a[244:247], v[228:231]
    ds_read_b64_tr_b16 a[26:27], v48 offset:1024
    v_mfma_f32_16x16x32_bf16 a[96:99], a[48:51], a[248:251], a[96:99]
    buffer_load_dwordx4 a[168:171], v37, s[8:11], s62 offen sc1
    ds_read_b64_tr_b16 a[28:29], v49 offset:0
    v_mfma_f32_16x16x32_bf16 a[100:103], a[48:51], a[252:255], a[100:103]
    v_mfma_f32_16x16x32_bf16 v[232:235], a[52:55], a[240:243], v[232:235]
    ds_read_b64_tr_b16 a[30:31], v49 offset:1024
    v_mfma_f32_16x16x32_bf16 v[236:239], a[52:55], a[244:247], v[236:239]
    buffer_load_dwordx4 a[172:175], v55, s[8:11], s62 offen sc1
    v_mfma_f32_16x16x32_bf16 a[104:107], a[52:55], a[248:251], a[104:107]
    v_mfma_f32_16x16x32_bf16 a[108:111], a[52:55], a[252:255], a[108:111]
    s_add_u32 s62, s62, 0x20000
    v_mfma_f32_16x16x32_bf16 v[240:243], a[56:59], a[240:243], v[240:243]
    s_add_u32 s52, s47, 4096
    v_mfma_f32_16x16x32_bf16 v[244:247], a[56:59], a[244:247], v[244:247]
    buffer_store_dwordx4 v[80:83], v1, s[48:51], s52 offen offset:0 sc1
    v_mfma_f32_16x16x32_bf16 a[112:115], a[56:59], a[248:251], a[112:115]
    v_mfma_f32_16x16x32_bf16 a[116:119], a[56:59], a[252:255], a[116:119]
    v_mfma_f32_16x16x32_bf16 v[248:251], a[60:63], a[240:243], v[248:251]
    v_mfma_f32_16x16x32_bf16 v[252:255], a[60:63], a[244:247], v[252:255]
    v_mfma_f32_16x16x32_bf16 a[120:123], a[60:63], a[248:251], a[120:123]
    v_mfma_f32_16x16x32_bf16 a[124:127], a[60:63], a[252:255], a[124:127]
    s_waitcnt vmcnt(15) lgkmcnt(0)
    v_mfma_f32_16x16x32_bf16 v[192:195], a[0:3], a[128:131], v[192:195]
    ds_read_b64_tr_b16 a[32:33], v42 offset:8192
    ds_read_b64_tr_b16 a[34:35], v42 offset:9216
    v_mfma_f32_16x16x32_bf16 v[196:199], a[0:3], a[132:135], v[196:199]
    buffer_load_dwordx4 a[176:179], v36, s[8:11], s62 offen sc1
    v_mfma_f32_16x16x32_bf16 a[64:67], a[0:3], a[136:139], a[64:67]
    ds_read_b64_tr_b16 a[36:37], v43 offset:8192
    v_mfma_f32_16x16x32_bf16 a[68:71], a[0:3], a[140:143], a[68:71]
    ds_read_b64_tr_b16 a[38:39], v43 offset:9216
    v_mfma_f32_16x16x32_bf16 v[200:203], a[4:7], a[128:131], v[200:203]
    ds_read_b64_tr_b16 a[40:41], v44 offset:8192
    v_mfma_f32_16x16x32_bf16 v[204:207], a[4:7], a[132:135], v[204:207]
    v_mfma_f32_16x16x32_bf16 a[72:75], a[4:7], a[136:139], a[72:75]
    buffer_load_dwordx4 a[180:183], v54, s[8:11], s62 offen sc1
    ds_read_b64_tr_b16 a[42:43], v44 offset:9216
    v_mfma_f32_16x16x32_bf16 a[76:79], a[4:7], a[140:143], a[76:79]
    ds_read_b64_tr_b16 a[44:45], v45 offset:8192
    v_mfma_f32_16x16x32_bf16 v[208:211], a[8:11], a[128:131], v[208:211]
    v_mfma_f32_16x16x32_bf16 v[212:215], a[8:11], a[132:135], v[212:215]
    ds_read_b64_tr_b16 a[46:47], v45 offset:9216
    v_mfma_f32_16x16x32_bf16 a[80:83], a[8:11], a[136:139], a[80:83]
    ds_read_b64_tr_b16 a[48:49], v46 offset:8192
    v_mfma_f32_16x16x32_bf16 a[84:87], a[8:11], a[140:143], a[84:87]
    buffer_load_dwordx4 a[184:187], v37, s[8:11], s62 offen sc1
    ds_read_b64_tr_b16 a[50:51], v46 offset:9216
    v_mfma_f32_16x16x32_bf16 v[216:219], a[12:15], a[128:131], v[216:219]
    v_mfma_f32_16x16x32_bf16 v[220:223], a[12:15], a[132:135], v[220:223]
    ds_read_b64_tr_b16 a[52:53], v47 offset:8192
    v_mfma_f32_16x16x32_bf16 a[88:91], a[12:15], a[136:139], a[88:91]
    ds_read_b64_tr_b16 a[54:55], v47 offset:9216
    v_mfma_f32_16x16x32_bf16 a[92:95], a[12:15], a[140:143], a[92:95]
    ds_read_b64_tr_b16 a[56:57], v48 offset:8192
    v_mfma_f32_16x16x32_bf16 v[224:227], a[16:19], a[128:131], v[224:227]
    v_mfma_f32_16x16x32_bf16 v[228:231], a[16:19], a[132:135], v[228:231]
    buffer_load_dwordx4 a[188:191], v55, s[8:11], s62 offen sc1
    ds_read_b64_tr_b16 a[58:59], v48 offset:9216
    v_mfma_f32_16x16x32_bf16 a[96:99], a[16:19], a[136:139], a[96:99]
    ds_read_b64_tr_b16 a[60:61], v49 offset:8192
    v_mfma_f32_16x16x32_bf16 a[100:103], a[16:19], a[140:143], a[100:103]
    v_mfma_f32_16x16x32_bf16 v[232:235], a[20:23], a[128:131], v[232:235]
    ds_read_b64_tr_b16 a[62:63], v49 offset:9216
    v_mfma_f32_16x16x32_bf16 v[236:239], a[20:23], a[132:135], v[236:239]
    s_add_u32 s62, s62, 0x20000
    v_mfma_f32_16x16x32_bf16 a[104:107], a[20:23], a[136:139], a[104:107]
    s_add_u32 s52, s47, 4096
    v_mfma_f32_16x16x32_bf16 a[108:111], a[20:23], a[140:143], a[108:111]
    buffer_store_dwordx4 v[84:87], v1, s[48:51], s52 offen offset:1024 sc1
    v_mfma_f32_16x16x32_bf16 v[240:243], a[24:27], a[128:131], v[240:243]
    v_mfma_f32_16x16x32_bf16 v[244:247], a[24:27], a[132:135], v[244:247]
    v_mfma_f32_16x16x32_bf16 a[112:115], a[24:27], a[136:139], a[112:115]
    v_mfma_f32_16x16x32_bf16 a[116:119], a[24:27], a[140:143], a[116:119]
    v_mfma_f32_16x16x32_bf16 v[248:251], a[28:31], a[128:131], v[248:251]
    v_mfma_f32_16x16x32_bf16 v[252:255], a[28:31], a[132:135], v[252:255]
    v_mfma_f32_16x16x32_bf16 a[120:123], a[28:31], a[136:139], a[120:123]
    v_mfma_f32_16x16x32_bf16 a[124:127], a[28:31], a[140:143], a[124:127]
    s_waitcnt vmcnt(10) lgkmcnt(0)
    s_barrier
    v_mfma_f32_16x16x32_bf16 v[192:195], a[32:35], a[144:147], v[192:195]
    ds_read_b64_tr_b16 a[0:1], v42 offset:16384
    ds_read_b64_tr_b16 a[2:3], v42 offset:17408
    v_mfma_f32_16x16x32_bf16 v[196:199], a[32:35], a[148:151], v[196:199]
    s_add_u32 m0, s60, 131072
    v_mfma_f32_16x16x32_bf16 a[64:67], a[32:35], a[152:155], a[64:67]
    buffer_load_dwordx4 v38, s[12:15], s61 offen offset:0 lds
    ds_read_b64_tr_b16 a[4:5], v43 offset:16384
    v_mfma_f32_16x16x32_bf16 a[68:71], a[32:35], a[156:159], a[68:71]
    ds_read_b64_tr_b16 a[6:7], v43 offset:17408
    v_mfma_f32_16x16x32_bf16 v[200:203], a[36:39], a[144:147], v[200:203]
    buffer_load_dwordx4 v39, s[12:15], s61 offen offset:1024 lds
    ds_read_b64_tr_b16 a[8:9], v44 offset:16384
    v_mfma_f32_16x16x32_bf16 v[204:207], a[36:39], a[148:151], v[204:207]
    v_mfma_f32_16x16x32_bf16 a[72:75], a[36:39], a[152:155], a[72:75]
    ds_read_b64_tr_b16 a[10:11], v44 offset:17408
    v_mfma_f32_16x16x32_bf16 a[76:79], a[36:39], a[156:159], a[76:79]
    buffer_load_dwordx4 v40, s[12:15], s61 offen offset:2048 lds
    ds_read_b64_tr_b16 a[12:13], v45 offset:16384
    v_mfma_f32_16x16x32_bf16 v[208:211], a[40:43], a[144:147], v[208:211]
    v_mfma_f32_16x16x32_bf16 v[212:215], a[40:43], a[148:151], v[212:215]
    ds_read_b64_tr_b16 a[14:15], v45 offset:17408
    v_mfma_f32_16x16x32_bf16 a[80:83], a[40:43], a[152:155], a[80:83]
    ds_read_b64_tr_b16 a[16:17], v46 offset:16384
    v_mfma_f32_16x16x32_bf16 a[84:87], a[40:43], a[156:159], a[84:87]
    buffer_load_dwordx4 v41, s[12:15], s61 offen offset:3072 lds
    ds_read_b64_tr_b16 a[18:19], v46 offset:17408
    v_mfma_f32_16x16x32_bf16 v[216:219], a[44:47], a[144:147], v[216:219]
    v_mfma_f32_16x16x32_bf16 v[220:223], a[44:47], a[148:151], v[220:223]
    s_add_u32 s61, s61, 0x80000
    ds_read_b64_tr_b16 a[20:21], v47 offset:16384
    v_mfma_f32_16x16x32_bf16 a[88:91], a[44:47], a[152:155], a[88:91]
    buffer_load_dwordx4 a[192:195], v36, s[8:11], s62 offen sc1
    ds_read_b64_tr_b16 a[22:23], v47 offset:17408
    v_mfma_f32_16x16x32_bf16 a[92:95], a[44:47], a[156:159], a[92:95]
    ds_read_b64_tr_b16 a[24:25], v48 offset:16384
    v_mfma_f32_16x16x32_bf16 v[224:227], a[48:51], a[144:147], v[224:227]
    v_mfma_f32_16x16x32_bf16 v[228:231], a[48:51], a[148:151], v[228:231]
    buffer_load_dwordx4 a[196:199], v54, s[8:11], s62 offen sc1
    ds_read_b64_tr_b16 a[26:27], v48 offset:17408
    v_mfma_f32_16x16x32_bf16 a[96:99], a[48:51], a[152:155], a[96:99]
    ds_read_b64_tr_b16 a[28:29], v49 offset:16384
    v_mfma_f32_16x16x32_bf16 a[100:103], a[48:51], a[156:159], a[100:103]
    v_mfma_f32_16x16x32_bf16 v[232:235], a[52:55], a[144:147], v[232:235]
    buffer_load_dwordx4 a[200:203], v37, s[8:11], s62 offen sc1
    ds_read_b64_tr_b16 a[30:31], v49 offset:17408
    v_mfma_f32_16x16x32_bf16 v[236:239], a[52:55], a[148:151], v[236:239]
    v_mfma_f32_16x16x32_bf16 a[104:107], a[52:55], a[152:155], a[104:107]
    v_mfma_f32_16x16x32_bf16 a[108:111], a[52:55], a[156:159], a[108:111]
    v_mfma_f32_16x16x32_bf16 v[240:243], a[56:59], a[144:147], v[240:243]
    buffer_load_dwordx4 a[204:207], v55, s[8:11], s62 offen sc1
    v_mfma_f32_16x16x32_bf16 v[244:247], a[56:59], a[148:151], v[244:247]
    v_mfma_f32_16x16x32_bf16 a[112:115], a[56:59], a[152:155], a[112:115]
    s_add_u32 s62, s62, 0x20000
    v_mfma_f32_16x16x32_bf16 a[116:119], a[56:59], a[156:159], a[116:119]
    v_mfma_f32_16x16x32_bf16 v[248:251], a[60:63], a[144:147], v[248:251]
    s_cmp_eq_u32 s45, 0
    s_cbranch_scc1 k12_ool_52
k12_oolret_53:
    v_mfma_f32_16x16x32_bf16 v[252:255], a[60:63], a[148:151], v[252:255]
    v_mfma_f32_16x16x32_bf16 a[120:123], a[60:63], a[152:155], a[120:123]
    v_mfma_f32_16x16x32_bf16 a[124:127], a[60:63], a[156:159], a[124:127]
    s_waitcnt vmcnt(14) lgkmcnt(0)
    v_mfma_f32_16x16x32_bf16 v[192:195], a[0:3], a[160:163], v[192:195]
    ds_read_b64_tr_b16 a[32:33], v42 offset:24576
    ds_read_b64_tr_b16 a[34:35], v42 offset:25600
    v_mfma_f32_16x16x32_bf16 v[196:199], a[0:3], a[164:167], v[196:199]
    buffer_load_dwordx4 a[208:211], v36, s[8:11], s62 offen sc1
    v_mfma_f32_16x16x32_bf16 a[64:67], a[0:3], a[168:171], a[64:67]
    ds_read_b64_tr_b16 a[36:37], v43 offset:24576
    v_mfma_f32_16x16x32_bf16 a[68:71], a[0:3], a[172:175], a[68:71]
    ds_read_b64_tr_b16 a[38:39], v43 offset:25600
    v_mfma_f32_16x16x32_bf16 v[200:203], a[4:7], a[160:163], v[200:203]
    ds_read_b64_tr_b16 a[40:41], v44 offset:24576
    v_mfma_f32_16x16x32_bf16 v[204:207], a[4:7], a[164:167], v[204:207]
    v_mfma_f32_16x16x32_bf16 a[72:75], a[4:7], a[168:171], a[72:75]
    buffer_load_dwordx4 a[212:215], v54, s[8:11], s62 offen sc1
    ds_read_b64_tr_b16 a[42:43], v44 offset:25600
    v_mfma_f32_16x16x32_bf16 a[76:79], a[4:7], a[172:175], a[76:79]
    ds_read_b64_tr_b16 a[44:45], v45 offset:24576
    v_mfma_f32_16x16x32_bf16 v[208:211], a[8:11], a[160:163], v[208:211]
    v_mfma_f32_16x16x32_bf16 v[212:215], a[8:11], a[164:167], v[212:215]
    ds_read_b64_tr_b16 a[46:47], v45 offset:25600
    v_mfma_f32_16x16x32_bf16 a[80:83], a[8:11], a[168:171], a[80:83]
    ds_read_b64_tr_b16 a[48:49], v46 offset:24576
    v_mfma_f32_16x16x32_bf16 a[84:87], a[8:11], a[172:175], a[84:87]
    buffer_load_dwordx4 a[216:219], v37, s[8:11], s62 offen sc1
    ds_read_b64_tr_b16 a[50:51], v46 offset:25600
    v_mfma_f32_16x16x32_bf16 v[216:219], a[12:15], a[160:163], v[216:219]
    v_mfma_f32_16x16x32_bf16 v[220:223], a[12:15], a[164:167], v[220:223]
    ds_read_b64_tr_b16 a[52:53], v47 offset:24576
    v_mfma_f32_16x16x32_bf16 a[88:91], a[12:15], a[168:171], a[88:91]
    ds_read_b64_tr_b16 a[54:55], v47 offset:25600
    v_mfma_f32_16x16x32_bf16 a[92:95], a[12:15], a[172:175], a[92:95]
    ds_read_b64_tr_b16 a[56:57], v48 offset:24576
    v_mfma_f32_16x16x32_bf16 v[224:227], a[16:19], a[160:163], v[224:227]
    v_mfma_f32_16x16x32_bf16 v[228:231], a[16:19], a[164:167], v[228:231]
    buffer_load_dwordx4 a[220:223], v55, s[8:11], s62 offen sc1
    ds_read_b64_tr_b16 a[58:59], v48 offset:25600
    v_mfma_f32_16x16x32_bf16 a[96:99], a[16:19], a[168:171], a[96:99]
    ds_read_b64_tr_b16 a[60:61], v49 offset:24576
    v_mfma_f32_16x16x32_bf16 a[100:103], a[16:19], a[172:175], a[100:103]
    v_mfma_f32_16x16x32_bf16 v[232:235], a[20:23], a[160:163], v[232:235]
    ds_read_b64_tr_b16 a[62:63], v49 offset:25600
    v_mfma_f32_16x16x32_bf16 v[236:239], a[20:23], a[164:167], v[236:239]
    s_add_u32 s62, s62, 0x20000
    v_mfma_f32_16x16x32_bf16 a[104:107], a[20:23], a[168:171], a[104:107]
    s_add_u32 s52, s47, 4096
    v_mfma_f32_16x16x32_bf16 a[108:111], a[20:23], a[172:175], a[108:111]
    buffer_store_dwordx4 v[88:91], v1, s[48:51], s52 offen offset:2048 sc1
    v_mfma_f32_16x16x32_bf16 v[240:243], a[24:27], a[160:163], v[240:243]
    v_mfma_f32_16x16x32_bf16 v[244:247], a[24:27], a[164:167], v[244:247]
    v_mfma_f32_16x16x32_bf16 a[112:115], a[24:27], a[168:171], a[112:115]
    v_mfma_f32_16x16x32_bf16 a[116:119], a[24:27], a[172:175], a[116:119]
    v_mfma_f32_16x16x32_bf16 v[248:251], a[28:31], a[160:163], v[248:251]
    v_mfma_f32_16x16x32_bf16 v[252:255], a[28:31], a[164:167], v[252:255]
    v_mfma_f32_16x16x32_bf16 a[120:123], a[28:31], a[168:171], a[120:123]
    v_mfma_f32_16x16x32_bf16 a[124:127], a[28:31], a[172:175], a[124:127]
    s_waitcnt vmcnt(9) lgkmcnt(0)
    s_barrier
    v_mfma_f32_16x16x32_bf16 v[192:195], a[32:35], a[176:179], v[192:195]
    ds_read_b64_tr_b16 a[0:1], v42 offset:32768
    ds_read_b64_tr_b16 a[2:3], v42 offset:33792
    v_mfma_f32_16x16x32_bf16 v[196:199], a[32:35], a[180:183], v[196:199]
    s_add_u32 m0, s60, 147456
    v_mfma_f32_16x16x32_bf16 a[64:67], a[32:35], a[184:187], a[64:67]
    buffer_load_dwordx4 v38, s[12:15], s61 offen offset:0 lds
    ds_read_b64_tr_b16 a[4:5], v43 offset:32768
    v_mfma_f32_16x16x32_bf16 a[68:71], a[32:35], a[188:191], a[68:71]
    ds_read_b64_tr_b16 a[6:7], v43 offset:33792
    v_mfma_f32_16x16x32_bf16 v[200:203], a[36:39], a[176:179], v[200:203]
    buffer_load_dwordx4 v39, s[12:15], s61 offen offset:1024 lds
    ds_read_b64_tr_b16 a[8:9], v44 offset:32768
    v_mfma_f32_16x16x32_bf16 v[204:207], a[36:39], a[180:183], v[204:207]
    v_mfma_f32_16x16x32_bf16 a[72:75], a[36:39], a[184:187], a[72:75]
    ds_read_b64_tr_b16 a[10:11], v44 offset:33792
    v_mfma_f32_16x16x32_bf16 a[76:79], a[36:39], a[188:191], a[76:79]
    buffer_load_dwordx4 v40, s[12:15], s61 offen offset:2048 lds
    ds_read_b64_tr_b16 a[12:13], v45 offset:32768
    v_mfma_f32_16x16x32_bf16 v[208:211], a[40:43], a[176:179], v[208:211]
    v_mfma_f32_16x16x32_bf16 v[212:215], a[40:43], a[180:183], v[212:215]
    ds_read_b64_tr_b16 a[14:15], v45 offset:33792
    v_mfma_f32_16x16x32_bf16 a[80:83], a[40:43], a[184:187], a[80:83]
    buffer_load_dwordx4 v41, s[12:15], s61 offen offset:3072 lds
    ds_read_b64_tr_b16 a[16:17], v46 offset:32768
    v_mfma_f32_16x16x32_bf16 a[84:87], a[40:43], a[188:191], a[84:87]
    ds_read_b64_tr_b16 a[18:19], v46 offset:33792
    v_mfma_f32_16x16x32_bf16 v[216:219], a[44:47], a[176:179], v[216:219]
    s_add_u32 s61, s61, 0x80000
    v_mfma_f32_16x16x32_bf16 v[220:223], a[44:47], a[180:183], v[220:223]
    buffer_load_dwordx4 a[224:227], v36, s[8:11], s62 offen sc1
    ds_read_b64_tr_b16 a[20:21], v47 offset:32768
    v_mfma_f32_16x16x32_bf16 a[88:91], a[44:47], a[184:187], a[88:91]
    ds_read_b64_tr_b16 a[22:23], v47 offset:33792
    v_mfma_f32_16x16x32_bf16 a[92:95], a[44:47], a[188:191], a[92:95]
    buffer_load_dwordx4 a[228:231], v54, s[8:11], s62 offen sc1
    ds_read_b64_tr_b16 a[24:25], v48 offset:32768
    v_mfma_f32_16x16x32_bf16 v[224:227], a[48:51], a[176:179], v[224:227]
    v_mfma_f32_16x16x32_bf16 v[228:231], a[48:51], a[180:183], v[228:231]
    ds_read_b64_tr_b16 a[26:27], v48 offset:33792
    v_mfma_f32_16x16x32_bf16 a[96:99], a[48:51], a[184:187], a[96:99]
    buffer_load_dwordx4 a[232:235], v37, s[8:11], s62 offen sc1
    ds_read_b64_tr_b16 a[28:29], v49 offset:32768
    v_mfma_f32_16x16x32_bf16 a[100:103], a[48:51], a[188:191], a[100:103]
    v_mfma_f32_16x16x32_bf16 v[232:235], a[52:55], a[176:179], v[232:235]
    ds_read_b64_tr_b16 a[30:31], v49 offset:33792
    v_mfma_f32_16x16x32_bf16 v[236:239], a[52:55], a[180:183], v[236:239]
    buffer_load_dwordx4 a[236:239], v55, s[8:11], s62 offen sc1
    v_mfma_f32_16x16x32_bf16 a[104:107], a[52:55], a[184:187], a[104:107]
    v_mfma_f32_16x16x32_bf16 a[108:111], a[52:55], a[188:191], a[108:111]
    s_add_u32 s62, s62, 0x20000
    v_mfma_f32_16x16x32_bf16 v[240:243], a[56:59], a[176:179], v[240:243]
    s_add_u32 s52, s47, 4096
    v_mfma_f32_16x16x32_bf16 v[244:247], a[56:59], a[180:183], v[244:247]
    buffer_store_dwordx4 v[92:95], v1, s[48:51], s52 offen offset:3072 sc1
    v_mfma_f32_16x16x32_bf16 a[112:115], a[56:59], a[184:187], a[112:115]
    v_mfma_f32_16x16x32_bf16 a[116:119], a[56:59], a[188:191], a[116:119]
    v_mfma_f32_16x16x32_bf16 v[248:251], a[60:63], a[176:179], v[248:251]
    s_cmp_eq_u32 s45, 0
    s_cbranch_scc1 k12_ool_54
k12_oolret_55:
    v_mfma_f32_16x16x32_bf16 v[252:255], a[60:63], a[180:183], v[252:255]
    v_mfma_f32_16x16x32_bf16 a[120:123], a[60:63], a[184:187], a[120:123]
    v_mfma_f32_16x16x32_bf16 a[124:127], a[60:63], a[188:191], a[124:127]
    s_waitcnt vmcnt(14) lgkmcnt(0)
    v_mfma_f32_16x16x32_bf16 v[192:195], a[0:3], a[192:195], v[192:195]
    ds_read_b64_tr_b16 a[32:33], v42 offset:40960
    ds_read_b64_tr_b16 a[34:35], v42 offset:41984
    v_mfma_f32_16x16x32_bf16 v[196:199], a[0:3], a[196:199], v[196:199]
    buffer_load_dwordx4 a[240:243], v36, s[8:11], s62 offen sc1
    v_mfma_f32_16x16x32_bf16 a[64:67], a[0:3], a[200:203], a[64:67]
    ds_read_b64_tr_b16 a[36:37], v43 offset:40960
    v_mfma_f32_16x16x32_bf16 a[68:71], a[0:3], a[204:207], a[68:71]
    ds_read_b64_tr_b16 a[38:39], v43 offset:41984
    v_mfma_f32_16x16x32_bf16 v[200:203], a[4:7], a[192:195], v[200:203]
    ds_read_b64_tr_b16 a[40:41], v44 offset:40960
    v_mfma_f32_16x16x32_bf16 v[204:207], a[4:7], a[196:199], v[204:207]
    v_mfma_f32_16x16x32_bf16 a[72:75], a[4:7], a[200:203], a[72:75]
    buffer_load_dwordx4 a[244:247], v54, s[8:11], s62 offen sc1
    ds_read_b64_tr_b16 a[42:43], v44 offset:41984
    v_mfma_f32_16x16x32_bf16 a[76:79], a[4:7], a[204:207], a[76:79]
    ds_read_b64_tr_b16 a[44:45], v45 offset:40960
    v_mfma_f32_16x16x32_bf16 v[208:211], a[8:11], a[192:195], v[208:211]
    v_mfma_f32_16x16x32_bf16 v[212:215], a[8:11], a[196:199], v[212:215]
    ds_read_b64_tr_b16 a[46:47], v45 offset:41984
    v_mfma_f32_16x16x32_bf16 a[80:83], a[8:11], a[200:203], a[80:83]
    ds_read_b64_tr_b16 a[48:49], v46 offset:40960
    v_mfma_f32_16x16x32_bf16 a[84:87], a[8:11], a[204:207], a[84:87]
    buffer_load_dwordx4 a[248:251], v37, s[8:11], s62 offen sc1
    ds_read_b64_tr_b16 a[50:51], v46 offset:41984
    v_mfma_f32_16x16x32_bf16 v[216:219], a[12:15], a[192:195], v[216:219]
    v_mfma_f32_16x16x32_bf16 v[220:223], a[12:15], a[196:199], v[220:223]
    ds_read_b64_tr_b16 a[52:53], v47 offset:40960
    v_mfma_f32_16x16x32_bf16 a[88:91], a[12:15], a[200:203], a[88:91]
    ds_read_b64_tr_b16 a[54:55], v47 offset:41984
    v_mfma_f32_16x16x32_bf16 a[92:95], a[12:15], a[204:207], a[92:95]
    ds_read_b64_tr_b16 a[56:57], v48 offset:40960
    v_mfma_f32_16x16x32_bf16 v[224:227], a[16:19], a[192:195], v[224:227]
    v_mfma_f32_16x16x32_bf16 v[228:231], a[16:19], a[196:199], v[228:231]
    buffer_load_dwordx4 a[252:255], v55, s[8:11], s62 offen sc1
    ds_read_b64_tr_b16 a[58:59], v48 offset:41984
    v_mfma_f32_16x16x32_bf16 a[96:99], a[16:19], a[200:203], a[96:99]
    ds_read_b64_tr_b16 a[60:61], v49 offset:40960
    v_mfma_f32_16x16x32_bf16 a[100:103], a[16:19], a[204:207], a[100:103]
    v_mfma_f32_16x16x32_bf16 v[232:235], a[20:23], a[192:195], v[232:235]
    ds_read_b64_tr_b16 a[62:63], v49 offset:41984
    v_mfma_f32_16x16x32_bf16 v[236:239], a[20:23], a[196:199], v[236:239]
    s_add_u32 s62, s62, 0x20000
    v_mfma_f32_16x16x32_bf16 a[104:107], a[20:23], a[200:203], a[104:107]
    s_add_u32 s52, s47, 8192
    v_mfma_f32_16x16x32_bf16 a[108:111], a[20:23], a[204:207], a[108:111]
    buffer_store_dwordx4 v[104:107], v1, s[48:51], s52 offen offset:2048 sc1
    v_mfma_f32_16x16x32_bf16 v[240:243], a[24:27], a[192:195], v[240:243]
    v_mfma_f32_16x16x32_bf16 v[244:247], a[24:27], a[196:199], v[244:247]
    v_mfma_f32_16x16x32_bf16 a[112:115], a[24:27], a[200:203], a[112:115]
    v_mfma_f32_16x16x32_bf16 a[116:119], a[24:27], a[204:207], a[116:119]
    v_mfma_f32_16x16x32_bf16 v[248:251], a[28:31], a[192:195], v[248:251]
    v_mfma_f32_16x16x32_bf16 v[252:255], a[28:31], a[196:199], v[252:255]
    v_mfma_f32_16x16x32_bf16 a[120:123], a[28:31], a[200:203], a[120:123]
    v_mfma_f32_16x16x32_bf16 a[124:127], a[28:31], a[204:207], a[124:127]
    s_waitcnt vmcnt(10) lgkmcnt(0)
    s_barrier
    v_mfma_f32_16x16x32_bf16 v[192:195], a[32:35], a[208:211], v[192:195]
    ds_read_b64_tr_b16 a[0:1], v42 offset:49152
    ds_read_b64_tr_b16 a[2:3], v42 offset:50176
    v_mfma_f32_16x16x32_bf16 v[196:199], a[32:35], a[212:215], v[196:199]
    s_add_u32 m0, s60, 98304
    v_mfma_f32_16x16x32_bf16 a[64:67], a[32:35], a[216:219], a[64:67]
    buffer_load_dwordx4 v38, s[12:15], s61 offen offset:0 lds
    ds_read_b64_tr_b16 a[4:5], v43 offset:49152
    v_mfma_f32_16x16x32_bf16 a[68:71], a[32:35], a[220:223], a[68:71]
    ds_read_b64_tr_b16 a[6:7], v43 offset:50176
    v_mfma_f32_16x16x32_bf16 v[200:203], a[36:39], a[208:211], v[200:203]
    buffer_load_dwordx4 v39, s[12:15], s61 offen offset:1024 lds
    ds_read_b64_tr_b16 a[8:9], v44 offset:49152
    v_mfma_f32_16x16x32_bf16 v[204:207], a[36:39], a[212:215], v[204:207]
    v_mfma_f32_16x16x32_bf16 a[72:75], a[36:39], a[216:219], a[72:75]
    ds_read_b64_tr_b16 a[10:11], v44 offset:50176
    v_mfma_f32_16x16x32_bf16 a[76:79], a[36:39], a[220:223], a[76:79]
    buffer_load_dwordx4 v40, s[12:15], s61 offen offset:2048 lds
    ds_read_b64_tr_b16 a[12:13], v45 offset:49152
    v_mfma_f32_16x16x32_bf16 v[208:211], a[40:43], a[208:211], v[208:211]
    v_mfma_f32_16x16x32_bf16 v[212:215], a[40:43], a[212:215], v[212:215]
    ds_read_b64_tr_b16 a[14:15], v45 offset:50176
    v_mfma_f32_16x16x32_bf16 a[80:83], a[40:43], a[216:219], a[80:83]
    buffer_load_dwordx4 v41, s[12:15], s61 offen offset:3072 lds
    ds_read_b64_tr_b16 a[16:17], v46 offset:49152
    v_mfma_f32_16x16x32_bf16 a[84:87], a[40:43], a[220:223], a[84:87]
    ds_read_b64_tr_b16 a[18:19], v46 offset:50176
    v_mfma_f32_16x16x32_bf16 v[216:219], a[44:47], a[208:211], v[216:219]
    s_add_u32 s61, s61, 0x80000
    v_mfma_f32_16x16x32_bf16 v[220:223], a[44:47], a[212:215], v[220:223]
    buffer_load_dwordx4 a[128:131], v36, s[8:11], s62 offen sc1
    ds_read_b64_tr_b16 a[20:21], v47 offset:49152
    v_mfma_f32_16x16x32_bf16 a[88:91], a[44:47], a[216:219], a[88:91]
    ds_read_b64_tr_b16 a[22:23], v47 offset:50176
    v_mfma_f32_16x16x32_bf16 a[92:95], a[44:47], a[220:223], a[92:95]
    buffer_load_dwordx4 a[132:135], v54, s[8:11], s62 offen sc1
    ds_read_b64_tr_b16 a[24:25], v48 offset:49152
    v_mfma_f32_16x16x32_bf16 v[224:227], a[48:51], a[208:211], v[224:227]
    v_mfma_f32_16x16x32_bf16 v[228:231], a[48:51], a[212:215], v[228:231]
    ds_read_b64_tr_b16 a[26:27], v48 offset:50176
    v_mfma_f32_16x16x32_bf16 a[96:99], a[48:51], a[216:219], a[96:99]
    buffer_load_dwordx4 a[136:139], v37, s[8:11], s62 offen sc1
    ds_read_b64_tr_b16 a[28:29], v49 offset:49152
    v_mfma_f32_16x16x32_bf16 a[100:103], a[48:51], a[220:223], a[100:103]
    v_mfma_f32_16x16x32_bf16 v[232:235], a[52:55], a[208:211], v[232:235]
    ds_read_b64_tr_b16 a[30:31], v49 offset:50176
    v_mfma_f32_16x16x32_bf16 v[236:239], a[52:55], a[212:215], v[236:239]
    buffer_load_dwordx4 a[140:143], v55, s[8:11], s62 offen sc1
    v_mfma_f32_16x16x32_bf16 a[104:107], a[52:55], a[216:219], a[104:107]
    v_mfma_f32_16x16x32_bf16 a[108:111], a[52:55], a[220:223], a[108:111]
    s_add_u32 s62, s62, 0x20000
    v_mfma_f32_16x16x32_bf16 v[240:243], a[56:59], a[208:211], v[240:243]
    s_add_u32 s52, s47, 8192
    v_mfma_f32_16x16x32_bf16 v[244:247], a[56:59], a[212:215], v[244:247]
    buffer_store_dwordx4 v[108:111], v1, s[48:51], s52 offen offset:3072 sc1
    v_mfma_f32_16x16x32_bf16 a[112:115], a[56:59], a[216:219], a[112:115]
    v_mfma_f32_16x16x32_bf16 a[116:119], a[56:59], a[220:223], a[116:119]
    v_mfma_f32_16x16x32_bf16 v[248:251], a[60:63], a[208:211], v[248:251]
    v_mfma_f32_16x16x32_bf16 v[252:255], a[60:63], a[212:215], v[252:255]
    v_mfma_f32_16x16x32_bf16 a[120:123], a[60:63], a[216:219], a[120:123]
    v_mfma_f32_16x16x32_bf16 a[124:127], a[60:63], a[220:223], a[124:127]
    s_waitcnt vmcnt(15) lgkmcnt(0)
    v_mfma_f32_16x16x32_bf16 v[192:195], a[0:3], a[224:227], v[192:195]
    ds_read_b64_tr_b16 a[32:33], v42 offset:57344
    ds_read_b64_tr_b16 a[34:35], v42 offset:58368
    v_mfma_f32_16x16x32_bf16 v[196:199], a[0:3], a[228:231], v[196:199]
    buffer_load_dwordx4 a[144:147], v36, s[8:11], s62 offen sc1
    v_mfma_f32_16x16x32_bf16 a[64:67], a[0:3], a[232:235], a[64:67]
    ds_read_b64_tr_b16 a[36:37], v43 offset:57344
    v_mfma_f32_16x16x32_bf16 a[68:71], a[0:3], a[236:239], a[68:71]
    ds_read_b64_tr_b16 a[38:39], v43 offset:58368
    v_mfma_f32_16x16x32_bf16 v[200:203], a[4:7], a[224:227], v[200:203]
    ds_read_b64_tr_b16 a[40:41], v44 offset:57344
    v_mfma_f32_16x16x32_bf16 v[204:207], a[4:7], a[228:231], v[204:207]
    v_mfma_f32_16x16x32_bf16 a[72:75], a[4:7], a[232:235], a[72:75]
    buffer_load_dwordx4 a[148:151], v54, s[8:11], s62 offen sc1
    ds_read_b64_tr_b16 a[42:43], v44 offset:58368
    v_mfma_f32_16x16x32_bf16 a[76:79], a[4:7], a[236:239], a[76:79]
    ds_read_b64_tr_b16 a[44:45], v45 offset:57344
    v_mfma_f32_16x16x32_bf16 v[208:211], a[8:11], a[224:227], v[208:211]
    v_mfma_f32_16x16x32_bf16 v[212:215], a[8:11], a[228:231], v[212:215]
    ds_read_b64_tr_b16 a[46:47], v45 offset:58368
    v_mfma_f32_16x16x32_bf16 a[80:83], a[8:11], a[232:235], a[80:83]
    ds_read_b64_tr_b16 a[48:49], v46 offset:57344
    v_mfma_f32_16x16x32_bf16 a[84:87], a[8:11], a[236:239], a[84:87]
    buffer_load_dwordx4 a[152:155], v37, s[8:11], s62 offen sc1
    ds_read_b64_tr_b16 a[50:51], v46 offset:58368
    v_mfma_f32_16x16x32_bf16 v[216:219], a[12:15], a[224:227], v[216:219]
    v_mfma_f32_16x16x32_bf16 v[220:223], a[12:15], a[228:231], v[220:223]
    ds_read_b64_tr_b16 a[52:53], v47 offset:57344
    v_mfma_f32_16x16x32_bf16 a[88:91], a[12:15], a[232:235], a[88:91]
    ds_read_b64_tr_b16 a[54:55], v47 offset:58368
    v_mfma_f32_16x16x32_bf16 a[92:95], a[12:15], a[236:239], a[92:95]
    ds_read_b64_tr_b16 a[56:57], v48 offset:57344
    v_mfma_f32_16x16x32_bf16 v[224:227], a[16:19], a[224:227], v[224:227]
    v_mfma_f32_16x16x32_bf16 v[228:231], a[16:19], a[228:231], v[228:231]
    buffer_load_dwordx4 a[156:159], v55, s[8:11], s62 offen sc1
    ds_read_b64_tr_b16 a[58:59], v48 offset:58368
    v_mfma_f32_16x16x32_bf16 a[96:99], a[16:19], a[232:235], a[96:99]
    ds_read_b64_tr_b16 a[60:61], v49 offset:57344
    v_mfma_f32_16x16x32_bf16 a[100:103], a[16:19], a[236:239], a[100:103]
    v_mfma_f32_16x16x32_bf16 v[232:235], a[20:23], a[224:227], v[232:235]
    ds_read_b64_tr_b16 a[62:63], v49 offset:58368
    v_mfma_f32_16x16x32_bf16 v[236:239], a[20:23], a[228:231], v[236:239]
    s_add_u32 s62, s62, 0x20000
    v_mfma_f32_16x16x32_bf16 a[104:107], a[20:23], a[232:235], a[104:107]
    s_add_u32 s52, s47, 12288
    v_mfma_f32_16x16x32_bf16 a[108:111], a[20:23], a[236:239], a[108:111]
    buffer_store_dwordx4 v[112:115], v1, s[48:51], s52 offen offset:0 sc1
    v_mfma_f32_16x16x32_bf16 v[240:243], a[24:27], a[224:227], v[240:243]
    v_mfma_f32_16x16x32_bf16 v[244:247], a[24:27], a[228:231], v[244:247]
    v_mfma_f32_16x16x32_bf16 a[112:115], a[24:27], a[232:235], a[112:115]
    v_mfma_f32_16x16x32_bf16 a[116:119], a[24:27], a[236:239], a[116:119]
    v_mfma_f32_16x16x32_bf16 v[248:251], a[28:31], a[224:227], v[248:251]
    s_cmp_eq_u32 s45, 0
    s_cbranch_scc1 k12_ool_56
k12_oolret_57:
    v_mfma_f32_16x16x32_bf16 v[252:255], a[28:31], a[228:231], v[252:255]
    v_mfma_f32_16x16x32_bf16 a[120:123], a[28:31], a[232:235], a[120:123]
    v_mfma_f32_16x16x32_bf16 a[124:127], a[28:31], a[236:239], a[124:127]
    s_waitcnt vmcnt(10) lgkmcnt(0)
    s_barrier
    v_mfma_f32_16x16x32_bf16 v[192:195], a[32:35], a[240:243], v[192:195]
    ds_read_b64_tr_b16 a[0:1], v42 offset:0
    ds_read_b64_tr_b16 a[2:3], v42 offset:1024
    v_mfma_f32_16x16x32_bf16 v[196:199], a[32:35], a[244:247], v[196:199]
    s_add_u32 m0, s60, 114688
    v_mfma_f32_16x16x32_bf16 a[64:67], a[32:35], a[248:251], a[64:67]
    buffer_load_dwordx4 v38, s[12:15], s61 offen offset:0 lds
    ds_read_b64_tr_b16 a[4:5], v43 offset:0
    v_mfma_f32_16x16x32_bf16 a[68:71], a[32:35], a[252:255], a[68:71]
    ds_read_b64_tr_b16 a[6:7], v43 offset:1024
    v_mfma_f32_16x16x32_bf16 v[200:203], a[36:39], a[240:243], v[200:203]
    buffer_load_dwordx4 v39, s[12:15], s61 offen offset:1024 lds
    ds_read_b64_tr_b16 a[8:9], v44 offset:0
    v_mfma_f32_16x16x32_bf16 v[204:207], a[36:39], a[244:247], v[204:207]
    v_mfma_f32_16x16x32_bf16 a[72:75], a[36:39], a[248:251], a[72:75]
    ds_read_b64_tr_b16 a[10:11], v44 offset:1024
    v_mfma_f32_16x16x32_bf16 a[76:79], a[36:39], a[252:255], a[76:79]
    buffer_load_dwordx4 v40, s[12:15], s61 offen offset:2048 lds
    ds_read_b64_tr_b16 a[12:13], v45 offset:0
    v_mfma_f32_16x16x32_bf16 v[208:211], a[40:43], a[240:243], v[208:211]
    v_mfma_f32_16x16x32_bf16 v[212:215], a[40:43], a[244:247], v[212:215]
    ds_read_b64_tr_b16 a[14:15], v45 offset:1024
    v_mfma_f32_16x16x32_bf16 a[80:83], a[40:43], a[248:251], a[80:83]
    ds_read_b64_tr_b16 a[16:17], v46 offset:0
    v_mfma_f32_16x16x32_bf16 a[84:87], a[40:43], a[252:255], a[84:87]
    buffer_load_dwordx4 v41, s[12:15], s61 offen offset:3072 lds
    ds_read_b64_tr_b16 a[18:19], v46 offset:1024
    v_mfma_f32_16x16x32_bf16 v[216:219], a[44:47], a[240:243], v[216:219]
    v_mfma_f32_16x16x32_bf16 v[220:223], a[44:47], a[244:247], v[220:223]
    s_add_u32 s61, s61, 0x80000
    ds_read_b64_tr_b16 a[20:21], v47 offset:0
    v_mfma_f32_16x16x32_bf16 a[88:91], a[44:47], a[248:251], a[88:91]
    buffer_load_dwordx4 a[160:163], v36, s[8:11], s62 offen sc1
    ds_read_b64_tr_b16 a[22:23], v47 offset:1024
    v_mfma_f32_16x16x32_bf16 a[92:95], a[44:47], a[252:255], a[92:95]
    ds_read_b64_tr_b16 a[24:25], v48 offset:0
    v_mfma_f32_16x16x32_bf16 v[224:227], a[48:51], a[240:243], v[224:227]
    v_mfma_f32_16x16x32_bf16 v[228:231], a[48:51], a[244:247], v[228:231]
    buffer_load_dwordx4 a[164:167], v54, s[8:11], s62 offen sc1
    ds_read_b64_tr_b16 a[26:27], v48 offset:1024
    v_mfma_f32_16x16x32_bf16 a[96:99], a[48:51], a[248:251], a[96:99]
    ds_read_b64_tr_b16 a[28:29], v49 offset:0
    v_mfma_f32_16x16x32_bf16 a[100:103], a[48:51], a[252:255], a[100:103]
    v_mfma_f32_16x16x32_bf16 v[232:235], a[52:55], a[240:243], v[232:235]
    buffer_load_dwordx4 a[168:171], v37, s[8:11], s62 offen sc1
    ds_read_b64_tr_b16 a[30:31], v49 offset:1024
    v_mfma_f32_16x16x32_bf16 v[236:239], a[52:55], a[244:247], v[236:239]
    v_mfma_f32_16x16x32_bf16 a[104:107], a[52:55], a[248:251], a[104:107]
    v_mfma_f32_16x16x32_bf16 a[108:111], a[52:55], a[252:255], a[108:111]
    v_mfma_f32_16x16x32_bf16 v[240:243], a[56:59], a[240:243], v[240:243]
    buffer_load_dwordx4 a[172:175], v55, s[8:11], s62 offen sc1
    v_mfma_f32_16x16x32_bf16 v[244:247], a[56:59], a[244:247], v[244:247]
    v_mfma_f32_16x16x32_bf16 a[112:115], a[56:59], a[248:251], a[112:115]
    s_add_u32 s62, s62, 0x20000
    v_mfma_f32_16x16x32_bf16 a[116:119], a[56:59], a[252:255], a[116:119]
    v_mfma_f32_16x16x32_bf16 v[248:251], a[60:63], a[240:243], v[248:251]
    v_mfma_f32_16x16x32_bf16 v[252:255], a[60:63], a[244:247], v[252:255]
    v_mfma_f32_16x16x32_bf16 a[120:123], a[60:63], a[248:251], a[120:123]
    v_mfma_f32_16x16x32_bf16 a[124:127], a[60:63], a[252:255], a[124:127]
    s_waitcnt vmcnt(14) lgkmcnt(0)
    v_mfma_f32_16x16x32_bf16 v[192:195], a[0:3], a[128:131], v[192:195]
    ds_read_b64_tr_b16 a[32:33], v42 offset:8192
    ds_read_b64_tr_b16 a[34:35], v42 offset:9216
    v_mfma_f32_16x16x32_bf16 v[196:199], a[0:3], a[132:135], v[196:199]
    buffer_load_dwordx4 a[176:179], v36, s[8:11], s62 offen sc1
    v_mfma_f32_16x16x32_bf16 a[64:67], a[0:3], a[136:139], a[64:67]
    ds_read_b64_tr_b16 a[36:37], v43 offset:8192
    v_mfma_f32_16x16x32_bf16 a[68:71], a[0:3], a[140:143], a[68:71]
    ds_read_b64_tr_b16 a[38:39], v43 offset:9216
    v_mfma_f32_16x16x32_bf16 v[200:203], a[4:7], a[128:131], v[200:203]
    ds_read_b64_tr_b16 a[40:41], v44 offset:8192
    v_mfma_f32_16x16x32_bf16 v[204:207], a[4:7], a[132:135], v[204:207]
    v_mfma_f32_16x16x32_bf16 a[72:75], a[4:7], a[136:139], a[72:75]
    buffer_load_dwordx4 a[180:183], v54, s[8:11], s62 offen sc1
    ds_read_b64_tr_b16 a[42:43], v44 offset:9216
    v_mfma_f32_16x16x32_bf16 a[76:79], a[4:7], a[140:143], a[76:79]
    ds_read_b64_tr_b16 a[44:45], v45 offset:8192
    v_mfma_f32_16x16x32_bf16 v[208:211], a[8:11], a[128:131], v[208:211]
    v_mfma_f32_16x16x32_bf16 v[212:215], a[8:11], a[132:135], v[212:215]
    ds_read_b64_tr_b16 a[46:47], v45 offset:9216
    v_mfma_f32_16x16x32_bf16 a[80:83], a[8:11], a[136:139], a[80:83]
    ds_read_b64_tr_b16 a[48:49], v46 offset:8192
    v_mfma_f32_16x16x32_bf16 a[84:87], a[8:11], a[140:143], a[84:87]
    buffer_load_dwordx4 a[184:187], v37, s[8:11], s62 offen sc1
    ds_read_b64_tr_b16 a[50:51], v46 offset:9216
    v_mfma_f32_16x16x32_bf16 v[216:219], a[12:15], a[128:131], v[216:219]
    v_mfma_f32_16x16x32_bf16 v[220:223], a[12:15], a[132:135], v[220:223]
    ds_read_b64_tr_b16 a[52:53], v47 offset:8192
    v_mfma_f32_16x16x32_bf16 a[88:91], a[12:15], a[136:139], a[88:91]
    ds_read_b64_tr_b16 a[54:55], v47 offset:9216
    v_mfma_f32_16x16x32_bf16 a[92:95], a[12:15], a[140:143], a[92:95]
    ds_read_b64_tr_b16 a[56:57], v48 offset:8192
    v_mfma_f32_16x16x32_bf16 v[224:227], a[16:19], a[128:131], v[224:227]
    v_mfma_f32_16x16x32_bf16 v[228:231], a[16:19], a[132:135], v[228:231]
    buffer_load_dwordx4 a[188:191], v55, s[8:11], s62 offen sc1
    ds_read_b64_tr_b16 a[58:59], v48 offset:9216
    v_mfma_f32_16x16x32_bf16 a[96:99], a[16:19], a[136:139], a[96:99]
    ds_read_b64_tr_b16 a[60:61], v49 offset:8192
    v_mfma_f32_16x16x32_bf16 a[100:103], a[16:19], a[140:143], a[100:103]
    v_mfma_f32_16x16x32_bf16 v[232:235], a[20:23], a[128:131], v[232:235]
    ds_read_b64_tr_b16 a[62:63], v49 offset:9216
    v_mfma_f32_16x16x32_bf16 v[236:239], a[20:23], a[132:135], v[236:239]
    s_add_u32 s62, s62, 0x20000
    v_mfma_f32_16x16x32_bf16 a[104:107], a[20:23], a[136:139], a[104:107]
    s_add_u32 s52, s47, 12288
    v_mfma_f32_16x16x32_bf16 a[108:111], a[20:23], a[140:143], a[108:111]
    buffer_store_dwordx4 v[116:119], v1, s[48:51], s52 offen offset:1024 sc1
    v_mfma_f32_16x16x32_bf16 v[240:243], a[24:27], a[128:131], v[240:243]
    v_mfma_f32_16x16x32_bf16 v[244:247], a[24:27], a[132:135], v[244:247]
    v_mfma_f32_16x16x32_bf16 a[112:115], a[24:27], a[136:139], a[112:115]
    v_mfma_f32_16x16x32_bf16 a[116:119], a[24:27], a[140:143], a[116:119]
    v_mfma_f32_16x16x32_bf16 v[248:251], a[28:31], a[128:131], v[248:251]
    s_cmp_eq_u32 s45, 0
    s_cbranch_scc1 k12_ool_58
k12_oolret_59:
    v_mfma_f32_16x16x32_bf16 v[252:255], a[28:31], a[132:135], v[252:255]
    v_mfma_f32_16x16x32_bf16 a[120:123], a[28:31], a[136:139], a[120:123]
    v_mfma_f32_16x16x32_bf16 a[124:127], a[28:31], a[140:143], a[124:127]
    s_waitcnt vmcnt(9) lgkmcnt(0)
    s_barrier
    v_mfma_f32_16x16x32_bf16 v[192:195], a[32:35], a[144:147], v[192:195]
    ds_read_b64_tr_b16 a[0:1], v42 offset:16384
    ds_read_b64_tr_b16 a[2:3], v42 offset:17408
    v_mfma_f32_16x16x32_bf16 v[196:199], a[32:35], a[148:151], v[196:199]
    s_add_u32 m0, s60, 131072
    v_mfma_f32_16x16x32_bf16 a[64:67], a[32:35], a[152:155], a[64:67]
    buffer_load_dwordx4 v38, s[12:15], s61 offen offset:0 lds
    ds_read_b64_tr_b16 a[4:5], v43 offset:16384
    v_mfma_f32_16x16x32_bf16 a[68:71], a[32:35], a[156:159], a[68:71]
    ds_read_b64_tr_b16 a[6:7], v43 offset:17408
    v_mfma_f32_16x16x32_bf16 v[200:203], a[36:39], a[144:147], v[200:203]
    buffer_load_dwordx4 v39, s[12:15], s61 offen offset:1024 lds
    ds_read_b64_tr_b16 a[8:9], v44 offset:16384
    v_mfma_f32_16x16x32_bf16 v[204:207], a[36:39], a[148:151], v[204:207]
    v_mfma_f32_16x16x32_bf16 a[72:75], a[36:39], a[152:155], a[72:75]
    ds_read_b64_tr_b16 a[10:11], v44 offset:17408
    v_mfma_f32_16x16x32_bf16 a[76:79], a[36:39], a[156:159], a[76:79]
    buffer_load_dwordx4 v40, s[12:15], s61 offen offset:2048 lds
    ds_read_b64_tr_b16 a[12:13], v45 offset:16384
    v_mfma_f32_16x16x32_bf16 v[208:211], a[40:43], a[144:147], v[208:211]
    v_mfma_f32_16x16x32_bf16 v[212:215], a[40:43], a[148:151], v[212:215]
    ds_read_b64_tr_b16 a[14:15], v45 offset:17408
    v_mfma_f32_16x16x32_bf16 a[80:83], a[40:43], a[152:155], a[80:83]
    buffer_load_dwordx4 v41, s[12:15], s61 offen offset:3072 lds
    ds_read_b64_tr_b16 a[16:17], v46 offset:16384
    v_mfma_f32_16x16x32_bf16 a[84:87], a[40:43], a[156:159], a[84:87]
    ds_read_b64_tr_b16 a[18:19], v46 offset:17408
    v_mfma_f32_16x16x32_bf16 v[216:219], a[44:47], a[144:147], v[216:219]
    s_add_u32 s61, s61, 0x80000
    v_mfma_f32_16x16x32_bf16 v[220:223], a[44:47], a[148:151], v[220:223]
    buffer_load_dwordx4 a[192:195], v36, s[8:11], s62 offen sc1
    ds_read_b64_tr_b16 a[20:21], v47 offset:16384
    v_mfma_f32_16x16x32_bf16 a[88:91], a[44:47], a[152:155], a[88:91]
    ds_read_b64_tr_b16 a[22:23], v47 offset:17408
    v_mfma_f32_16x16x32_bf16 a[92:95], a[44:47], a[156:159], a[92:95]
    buffer_load_dwordx4 a[196:199], v54, s[8:11], s62 offen sc1
    ds_read_b64_tr_b16 a[24:25], v48 offset:16384
    v_mfma_f32_16x16x32_bf16 v[224:227], a[48:51], a[144:147], v[224:227]
    v_mfma_f32_16x16x32_bf16 v[228:231], a[48:51], a[148:151], v[228:231]
    ds_read_b64_tr_b16 a[26:27], v48 offset:17408
    v_mfma_f32_16x16x32_bf16 a[96:99], a[48:51], a[152:155], a[96:99]
    buffer_load_dwordx4 a[200:203], v37, s[8:11], s62 offen sc1
    ds_read_b64_tr_b16 a[28:29], v49 offset:16384
    v_mfma_f32_16x16x32_bf16 a[100:103], a[48:51], a[156:159], a[100:103]
    v_mfma_f32_16x16x32_bf16 v[232:235], a[52:55], a[144:147], v[232:235]
    ds_read_b64_tr_b16 a[30:31], v49 offset:17408
    v_mfma_f32_16x16x32_bf16 v[236:239], a[52:55], a[148:151], v[236:239]
    buffer_load_dwordx4 a[204:207], v55, s[8:11], s62 offen sc1
    v_mfma_f32_16x16x32_bf16 a[104:107], a[52:55], a[152:155], a[104:107]
    v_mfma_f32_16x16x32_bf16 a[108:111], a[52:55], a[156:159], a[108:111]
    s_add_u32 s62, s62, 0x20000
    v_mfma_f32_16x16x32_bf16 v[240:243], a[56:59], a[144:147], v[240:243]
    s_add_u32 s52, s47, 12288
    v_mfma_f32_16x16x32_bf16 v[244:247], a[56:59], a[148:151], v[244:247]
    buffer_store_dwordx4 v[120:123], v1, s[48:51], s52 offen offset:2048 sc1
    v_mfma_f32_16x16x32_bf16 a[112:115], a[56:59], a[152:155], a[112:115]
    v_mfma_f32_16x16x32_bf16 a[116:119], a[56:59], a[156:159], a[116:119]
    v_mfma_f32_16x16x32_bf16 v[248:251], a[60:63], a[144:147], v[248:251]
    v_mfma_f32_16x16x32_bf16 v[252:255], a[60:63], a[148:151], v[252:255]
    v_mfma_f32_16x16x32_bf16 a[120:123], a[60:63], a[152:155], a[120:123]
    v_mfma_f32_16x16x32_bf16 a[124:127], a[60:63], a[156:159], a[124:127]
    s_waitcnt vmcnt(14) lgkmcnt(0)
    v_mfma_f32_16x16x32_bf16 v[192:195], a[0:3], a[160:163], v[192:195]
    ds_read_b64_tr_b16 a[32:33], v42 offset:24576
    ds_read_b64_tr_b16 a[34:35], v42 offset:25600
    v_mfma_f32_16x16x32_bf16 v[196:199], a[0:3], a[164:167], v[196:199]
    buffer_load_dwordx4 a[208:211], v36, s[8:11], s62 offen sc1
    v_mfma_f32_16x16x32_bf16 a[64:67], a[0:3], a[168:171], a[64:67]
    ds_read_b64_tr_b16 a[36:37], v43 offset:24576
    v_mfma_f32_16x16x32_bf16 a[68:71], a[0:3], a[172:175], a[68:71]
    ds_read_b64_tr_b16 a[38:39], v43 offset:25600
    v_mfma_f32_16x16x32_bf16 v[200:203], a[4:7], a[160:163], v[200:203]
    ds_read_b64_tr_b16 a[40:41], v44 offset:24576
    v_mfma_f32_16x16x32_bf16 v[204:207], a[4:7], a[164:167], v[204:207]
    v_mfma_f32_16x16x32_bf16 a[72:75], a[4:7], a[168:171], a[72:75]
    buffer_load_dwordx4 a[212:215], v54, s[8:11], s62 offen sc1
    ds_read_b64_tr_b16 a[42:43], v44 offset:25600
    v_mfma_f32_16x16x32_bf16 a[76:79], a[4:7], a[172:175], a[76:79]
    ds_read_b64_tr_b16 a[44:45], v45 offset:24576
    v_mfma_f32_16x16x32_bf16 v[208:211], a[8:11], a[160:163], v[208:211]
    v_mfma_f32_16x16x32_bf16 v[212:215], a[8:11], a[164:167], v[212:215]
    ds_read_b64_tr_b16 a[46:47], v45 offset:25600
    v_mfma_f32_16x16x32_bf16 a[80:83], a[8:11], a[168:171], a[80:83]
    ds_read_b64_tr_b16 a[48:49], v46 offset:24576
    v_mfma_f32_16x16x32_bf16 a[84:87], a[8:11], a[172:175], a[84:87]
    buffer_load_dwordx4 a[216:219], v37, s[8:11], s62 offen sc1
    ds_read_b64_tr_b16 a[50:51], v46 offset:25600
    v_mfma_f32_16x16x32_bf16 v[216:219], a[12:15], a[160:163], v[216:219]
    v_mfma_f32_16x16x32_bf16 v[220:223], a[12:15], a[164:167], v[220:223]
    ds_read_b64_tr_b16 a[52:53], v47 offset:24576
    v_mfma_f32_16x16x32_bf16 a[88:91], a[12:15], a[168:171], a[88:91]
    ds_read_b64_tr_b16 a[54:55], v47 offset:25600
    v_mfma_f32_16x16x32_bf16 a[92:95], a[12:15], a[172:175], a[92:95]
    ds_read_b64_tr_b16 a[56:57], v48 offset:24576
    v_mfma_f32_16x16x32_bf16 v[224:227], a[16:19], a[160:163], v[224:227]
    v_mfma_f32_16x16x32_bf16 v[228:231], a[16:19], a[164:167], v[228:231]
    buffer_load_dwordx4 a[220:223], v55, s[8:11], s62 offen sc1
    ds_read_b64_tr_b16 a[58:59], v48 offset:25600
    v_mfma_f32_16x16x32_bf16 a[96:99], a[16:19], a[168:171], a[96:99]
    ds_read_b64_tr_b16 a[60:61], v49 offset:24576
    v_mfma_f32_16x16x32_bf16 a[100:103], a[16:19], a[172:175], a[100:103]
    v_mfma_f32_16x16x32_bf16 v[232:235], a[20:23], a[160:163], v[232:235]
    ds_read_b64_tr_b16 a[62:63], v49 offset:25600
    v_mfma_f32_16x16x32_bf16 v[236:239], a[20:23], a[164:167], v[236:239]
    s_add_u32 s62, s62, 0x20000
    v_mfma_f32_16x16x32_bf16 a[104:107], a[20:23], a[168:171], a[104:107]
    s_add_u32 s52, s47, 12288
    v_mfma_f32_16x16x32_bf16 a[108:111], a[20:23], a[172:175], a[108:111]
    buffer_store_dwordx4 v[124:127], v1, s[48:51], s52 offen offset:3072 sc1
    v_mfma_f32_16x16x32_bf16 v[240:243], a[24:27], a[160:163], v[240:243]
    v_mfma_f32_16x16x32_bf16 v[244:247], a[24:27], a[164:167], v[244:247]
    v_mfma_f32_16x16x32_bf16 a[112:115], a[24:27], a[168:171], a[112:115]
    v_mfma_f32_16x16x32_bf16 a[116:119], a[24:27], a[172:175], a[116:119]
    v_mfma_f32_16x16x32_bf16 v[248:251], a[28:31], a[160:163], v[248:251]
    v_mfma_f32_16x16x32_bf16 v[252:255], a[28:31], a[164:167], v[252:255]
    v_mfma_f32_16x16x32_bf16 a[120:123], a[28:31], a[168:171], a[120:123]
    v_mfma_f32_16x16x32_bf16 a[124:127], a[28:31], a[172:175], a[124:127]
    s_waitcnt vmcnt(10) lgkmcnt(0)
    s_barrier
    v_mfma_f32_16x16x32_bf16 v[192:195], a[32:35], a[176:179], v[192:195]
    ds_read_b64_tr_b16 a[0:1], v42 offset:32768
    ds_read_b64_tr_b16 a[2:3], v42 offset:33792
    v_mfma_f32_16x16x32_bf16 v[196:199], a[32:35], a[180:183], v[196:199]
    s_add_u32 m0, s60, 147456
    v_mfma_f32_16x16x32_bf16 a[64:67], a[32:35], a[184:187], a[64:67]
    buffer_load_dwordx4 v38, s[12:15], s61 offen offset:0 lds
    ds_read_b64_tr_b16 a[4:5], v43 offset:32768
    v_mfma_f32_16x16x32_bf16 a[68:71], a[32:35], a[188:191], a[68:71]
    ds_read_b64_tr_b16 a[6:7], v43 offset:33792
    v_mfma_f32_16x16x32_bf16 v[200:203], a[36:39], a[176:179], v[200:203]
    buffer_load_dwordx4 v39, s[12:15], s61 offen offset:1024 lds
    ds_read_b64_tr_b16 a[8:9], v44 offset:32768
    v_mfma_f32_16x16x32_bf16 v[204:207], a[36:39], a[180:183], v[204:207]
    v_mfma_f32_16x16x32_bf16 a[72:75], a[36:39], a[184:187], a[72:75]
    ds_read_b64_tr_b16 a[10:11], v44 offset:33792
    v_mfma_f32_16x16x32_bf16 a[76:79], a[36:39], a[188:191], a[76:79]
    buffer_load_dwordx4 v40, s[12:15], s61 offen offset:2048 lds
    ds_read_b64_tr_b16 a[12:13], v45 offset:32768
    v_mfma_f32_16x16x32_bf16 v[208:211], a[40:43], a[176:179], v[208:211]
    v_mfma_f32_16x16x32_bf16 v[212:215], a[40:43], a[180:183], v[212:215]
    ds_read_b64_tr_b16 a[14:15], v45 offset:33792
    v_mfma_f32_16x16x32_bf16 a[80:83], a[40:43], a[184:187], a[80:83]
    buffer_load_dwordx4 v41, s[12:15], s61 offen offset:3072 lds
    ds_read_b64_tr_b16 a[16:17], v46 offset:32768
    v_mfma_f32_16x16x32_bf16 a[84:87], a[40:43], a[188:191], a[84:87]
    ds_read_b64_tr_b16 a[18:19], v46 offset:33792
    v_mfma_f32_16x16x32_bf16 v[216:219], a[44:47], a[176:179], v[216:219]
    s_add_u32 s61, s61, 0x80000
    v_mfma_f32_16x16x32_bf16 v[220:223], a[44:47], a[180:183], v[220:223]
    buffer_load_dwordx4 a[224:227], v36, s[8:11], s62 offen sc1
    ds_read_b64_tr_b16 a[20:21], v47 offset:32768
    v_mfma_f32_16x16x32_bf16 a[88:91], a[44:47], a[184:187], a[88:91]
    ds_read_b64_tr_b16 a[22:23], v47 offset:33792
    v_mfma_f32_16x16x32_bf16 a[92:95], a[44:47], a[188:191], a[92:95]
    buffer_load_dwordx4 a[228:231], v54, s[8:11], s62 offen sc1
    ds_read_b64_tr_b16 a[24:25], v48 offset:32768
    v_mfma_f32_16x16x32_bf16 v[224:227], a[48:51], a[176:179], v[224:227]
    v_mfma_f32_16x16x32_bf16 v[228:231], a[48:51], a[180:183], v[228:231]
    ds_read_b64_tr_b16 a[26:27], v48 offset:33792
    v_mfma_f32_16x16x32_bf16 a[96:99], a[48:51], a[184:187], a[96:99]
    buffer_load_dwordx4 a[232:235], v37, s[8:11], s62 offen sc1
    ds_read_b64_tr_b16 a[28:29], v49 offset:32768
    v_mfma_f32_16x16x32_bf16 a[100:103], a[48:51], a[188:191], a[100:103]
    v_mfma_f32_16x16x32_bf16 v[232:235], a[52:55], a[176:179], v[232:235]
    ds_read_b64_tr_b16 a[30:31], v49 offset:33792
    v_mfma_f32_16x16x32_bf16 v[236:239], a[52:55], a[180:183], v[236:239]
    buffer_load_dwordx4 a[236:239], v55, s[8:11], s62 offen sc1
    v_mfma_f32_16x16x32_bf16 a[104:107], a[52:55], a[184:187], a[104:107]
    v_mfma_f32_16x16x32_bf16 a[108:111], a[52:55], a[188:191], a[108:111]
    s_add_u32 s62, s62, 0x20000
    v_mfma_f32_16x16x32_bf16 v[240:243], a[56:59], a[176:179], v[240:243]
    s_add_u32 s52, s47, 524288
    v_mfma_f32_16x16x32_bf16 v[244:247], a[56:59], a[180:183], v[244:247]
    buffer_store_dwordx4 v[136:139], v1, s[48:51], s52 offen offset:2048 sc1
    v_mfma_f32_16x16x32_bf16 a[112:115], a[56:59], a[184:187], a[112:115]
    v_mfma_f32_16x16x32_bf16 a[116:119], a[56:59], a[188:191], a[116:119]
    v_mfma_f32_16x16x32_bf16 v[248:251], a[60:63], a[176:179], v[248:251]
    s_cmp_eq_u32 s45, 0
    s_cbranch_scc1 k12_ool_60
k12_oolret_61:
    v_mfma_f32_16x16x32_bf16 v[252:255], a[60:63], a[180:183], v[252:255]
    v_mfma_f32_16x16x32_bf16 a[120:123], a[60:63], a[184:187], a[120:123]
    v_mfma_f32_16x16x32_bf16 a[124:127], a[60:63], a[188:191], a[124:127]
    s_waitcnt vmcnt(15) lgkmcnt(0)
    v_mfma_f32_16x16x32_bf16 v[192:195], a[0:3], a[192:195], v[192:195]
    ds_read_b64_tr_b16 a[32:33], v42 offset:40960
    ds_read_b64_tr_b16 a[34:35], v42 offset:41984
    v_mfma_f32_16x16x32_bf16 v[196:199], a[0:3], a[196:199], v[196:199]
    buffer_load_dwordx4 a[240:243], v36, s[8:11], s62 offen sc1
    v_mfma_f32_16x16x32_bf16 a[64:67], a[0:3], a[200:203], a[64:67]
    ds_read_b64_tr_b16 a[36:37], v43 offset:40960
    v_mfma_f32_16x16x32_bf16 a[68:71], a[0:3], a[204:207], a[68:71]
    ds_read_b64_tr_b16 a[38:39], v43 offset:41984
    v_mfma_f32_16x16x32_bf16 v[200:203], a[4:7], a[192:195], v[200:203]
    ds_read_b64_tr_b16 a[40:41], v44 offset:40960
    v_mfma_f32_16x16x32_bf16 v[204:207], a[4:7], a[196:199], v[204:207]
    v_mfma_f32_16x16x32_bf16 a[72:75], a[4:7], a[200:203], a[72:75]
    buffer_load_dwordx4 a[244:247], v54, s[8:11], s62 offen sc1
    ds_read_b64_tr_b16 a[42:43], v44 offset:41984
    v_mfma_f32_16x16x32_bf16 a[76:79], a[4:7], a[204:207], a[76:79]
    ds_read_b64_tr_b16 a[44:45], v45 offset:40960
    v_mfma_f32_16x16x32_bf16 v[208:211], a[8:11], a[192:195], v[208:211]
    v_mfma_f32_16x16x32_bf16 v[212:215], a[8:11], a[196:199], v[212:215]
    ds_read_b64_tr_b16 a[46:47], v45 offset:41984
    v_mfma_f32_16x16x32_bf16 a[80:83], a[8:11], a[200:203], a[80:83]
    ds_read_b64_tr_b16 a[48:49], v46 offset:40960
    v_mfma_f32_16x16x32_bf16 a[84:87], a[8:11], a[204:207], a[84:87]
    buffer_load_dwordx4 a[248:251], v37, s[8:11], s62 offen sc1
    ds_read_b64_tr_b16 a[50:51], v46 offset:41984
    v_mfma_f32_16x16x32_bf16 v[216:219], a[12:15], a[192:195], v[216:219]
    v_mfma_f32_16x16x32_bf16 v[220:223], a[12:15], a[196:199], v[220:223]
    ds_read_b64_tr_b16 a[52:53], v47 offset:40960
    v_mfma_f32_16x16x32_bf16 a[88:91], a[12:15], a[200:203], a[88:91]
    ds_read_b64_tr_b16 a[54:55], v47 offset:41984
    v_mfma_f32_16x16x32_bf16 a[92:95], a[12:15], a[204:207], a[92:95]
    ds_read_b64_tr_b16 a[56:57], v48 offset:40960
    v_mfma_f32_16x16x32_bf16 v[224:227], a[16:19], a[192:195], v[224:227]
    v_mfma_f32_16x16x32_bf16 v[228:231], a[16:19], a[196:199], v[228:231]
    buffer_load_dwordx4 a[252:255], v55, s[8:11], s62 offen sc1
    ds_read_b64_tr_b16 a[58:59], v48 offset:41984
    v_mfma_f32_16x16x32_bf16 a[96:99], a[16:19], a[200:203], a[96:99]
    ds_read_b64_tr_b16 a[60:61], v49 offset:40960
    v_mfma_f32_16x16x32_bf16 a[100:103], a[16:19], a[204:207], a[100:103]
    v_mfma_f32_16x16x32_bf16 v[232:235], a[20:23], a[192:195], v[232:235]
    ds_read_b64_tr_b16 a[62:63], v49 offset:41984
    v_mfma_f32_16x16x32_bf16 v[236:239], a[20:23], a[196:199], v[236:239]
    s_add_u32 s62, s62, 0x20000
    v_mfma_f32_16x16x32_bf16 a[104:107], a[20:23], a[200:203], a[104:107]
    s_add_u32 s52, s47, 524288
    v_mfma_f32_16x16x32_bf16 a[108:111], a[20:23], a[204:207], a[108:111]
    buffer_store_dwordx4 v[140:143], v1, s[48:51], s52 offen offset:3072 sc1
    v_mfma_f32_16x16x32_bf16 v[240:243], a[24:27], a[192:195], v[240:243]
    v_mfma_f32_16x16x32_bf16 v[244:247], a[24:27], a[196:199], v[244:247]
    v_mfma_f32_16x16x32_bf16 a[112:115], a[24:27], a[200:203], a[112:115]
    v_mfma_f32_16x16x32_bf16 a[116:119], a[24:27], a[204:207], a[116:119]
    v_mfma_f32_16x16x32_bf16 v[248:251], a[28:31], a[192:195], v[248:251]
    v_mfma_f32_16x16x32_bf16 v[252:255], a[28:31], a[196:199], v[252:255]
    v_mfma_f32_16x16x32_bf16 a[120:123], a[28:31], a[200:203], a[120:123]
    v_mfma_f32_16x16x32_bf16 a[124:127], a[28:31], a[204:207], a[124:127]
    s_waitcnt vmcnt(10) lgkmcnt(0)
    s_barrier
    v_mfma_f32_16x16x32_bf16 v[192:195], a[32:35], a[208:211], v[192:195]
    ds_read_b64_tr_b16 a[0:1], v42 offset:49152
    ds_read_b64_tr_b16 a[2:3], v42 offset:50176
    v_mfma_f32_16x16x32_bf16 v[196:199], a[32:35], a[212:215], v[196:199]
    s_add_u32 m0, s60, 98304
    v_mfma_f32_16x16x32_bf16 a[64:67], a[32:35], a[216:219], a[64:67]
    buffer_load_dwordx4 v38, s[12:15], s61 offen offset:0 lds
    ds_read_b64_tr_b16 a[4:5], v43 offset:49152
    v_mfma_f32_16x16x32_bf16 a[68:71], a[32:35], a[220:223], a[68:71]
    ds_read_b64_tr_b16 a[6:7], v43 offset:50176
    v_mfma_f32_16x16x32_bf16 v[200:203], a[36:39], a[208:211], v[200:203]
    buffer_load_dwordx4 v39, s[12:15], s61 offen offset:1024 lds
    ds_read_b64_tr_b16 a[8:9], v44 offset:49152
    v_mfma_f32_16x16x32_bf16 v[204:207], a[36:39], a[212:215], v[204:207]
    v_mfma_f32_16x16x32_bf16 a[72:75], a[36:39], a[216:219], a[72:75]
    ds_read_b64_tr_b16 a[10:11], v44 offset:50176
    v_mfma_f32_16x16x32_bf16 a[76:79], a[36:39], a[220:223], a[76:79]
    buffer_load_dwordx4 v40, s[12:15], s61 offen offset:2048 lds
    ds_read_b64_tr_b16 a[12:13], v45 offset:49152
    v_mfma_f32_16x16x32_bf16 v[208:211], a[40:43], a[208:211], v[208:211]
    v_mfma_f32_16x16x32_bf16 v[212:215], a[40:43], a[212:215], v[212:215]
    ds_read_b64_tr_b16 a[14:15], v45 offset:50176
    v_mfma_f32_16x16x32_bf16 a[80:83], a[40:43], a[216:219], a[80:83]
    ds_read_b64_tr_b16 a[16:17], v46 offset:49152
    v_mfma_f32_16x16x32_bf16 a[84:87], a[40:43], a[220:223], a[84:87]
    buffer_load_dwordx4 v41, s[12:15], s61 offen offset:3072 lds
    ds_read_b64_tr_b16 a[18:19], v46 offset:50176
    v_mfma_f32_16x16x32_bf16 v[216:219], a[44:47], a[208:211], v[216:219]
    v_mfma_f32_16x16x32_bf16 v[220:223], a[44:47], a[212:215], v[220:223]
    s_add_u32 s61, s61, 0x80000
    ds_read_b64_tr_b16 a[20:21], v47 offset:49152
    v_mfma_f32_16x16x32_bf16 a[88:91], a[44:47], a[216:219], a[88:91]
    buffer_load_dwordx4 a[128:131], v36, s[8:11], s62 offen sc1
    ds_read_b64_tr_b16 a[22:23], v47 offset:50176
    v_mfma_f32_16x16x32_bf16 a[92:95], a[44:47], a[220:223], a[92:95]
    ds_read_b64_tr_b16 a[24:25], v48 offset:49152
    v_mfma_f32_16x16x32_bf16 v[224:227], a[48:51], a[208:211], v[224:227]
    v_mfma_f32_16x16x32_bf16 v[228:231], a[48:51], a[212:215], v[228:231]
    buffer_load_dwordx4 a[132:135], v54, s[8:11], s62 offen sc1
    ds_read_b64_tr_b16 a[26:27], v48 offset:50176
    v_mfma_f32_16x16x32_bf16 a[96:99], a[48:51], a[216:219], a[96:99]
    ds_read_b64_tr_b16 a[28:29], v49 offset:49152
    v_mfma_f32_16x16x32_bf16 a[100:103], a[48:51], a[220:223], a[100:103]
    v_mfma_f32_16x16x32_bf16 v[232:235], a[52:55], a[208:211], v[232:235]
    buffer_load_dwordx4 a[136:139], v37, s[8:11], s62 offen sc1
    ds_read_b64_tr_b16 a[30:31], v49 offset:50176
    v_mfma_f32_16x16x32_bf16 v[236:239], a[52:55], a[212:215], v[236:239]
    v_mfma_f32_16x16x32_bf16 a[104:107], a[52:55], a[216:219], a[104:107]
    v_mfma_f32_16x16x32_bf16 a[108:111], a[52:55], a[220:223], a[108:111]
    v_mfma_f32_16x16x32_bf16 v[240:243], a[56:59], a[208:211], v[240:243]
    buffer_load_dwordx4 a[140:143], v55, s[8:11], s62 offen sc1
    v_mfma_f32_16x16x32_bf16 v[244:247], a[56:59], a[212:215], v[244:247]
    v_mfma_f32_16x16x32_bf16 a[112:115], a[56:59], a[216:219], a[112:115]
    s_add_u32 s62, s62, 0x20000
    v_mfma_f32_16x16x32_bf16 a[116:119], a[56:59], a[220:223], a[116:119]
    v_mfma_f32_16x16x32_bf16 v[248:251], a[60:63], a[208:211], v[248:251]
    s_cmp_eq_u32 s45, 0
    s_cbranch_scc1 k12_ool_62
k12_oolret_63:
    v_mfma_f32_16x16x32_bf16 v[252:255], a[60:63], a[212:215], v[252:255]
    v_mfma_f32_16x16x32_bf16 a[120:123], a[60:63], a[216:219], a[120:123]
    v_mfma_f32_16x16x32_bf16 a[124:127], a[60:63], a[220:223], a[124:127]
    s_waitcnt vmcnt(14) lgkmcnt(0)
    v_mfma_f32_16x16x32_bf16 v[192:195], a[0:3], a[224:227], v[192:195]
    ds_read_b64_tr_b16 a[32:33], v42 offset:57344
    ds_read_b64_tr_b16 a[34:35], v42 offset:58368
    v_mfma_f32_16x16x32_bf16 v[196:199], a[0:3], a[228:231], v[196:199]
    buffer_load_dwordx4 a[144:147], v36, s[8:11], s62 offen sc1
    v_mfma_f32_16x16x32_bf16 a[64:67], a[0:3], a[232:235], a[64:67]
    ds_read_b64_tr_b16 a[36:37], v43 offset:57344
    v_mfma_f32_16x16x32_bf16 a[68:71], a[0:3], a[236:239], a[68:71]
    ds_read_b64_tr_b16 a[38:39], v43 offset:58368
    v_mfma_f32_16x16x32_bf16 v[200:203], a[4:7], a[224:227], v[200:203]
    ds_read_b64_tr_b16 a[40:41], v44 offset:57344
    v_mfma_f32_16x16x32_bf16 v[204:207], a[4:7], a[228:231], v[204:207]
    v_mfma_f32_16x16x32_bf16 a[72:75], a[4:7], a[232:235], a[72:75]
    buffer_load_dwordx4 a[148:151], v54, s[8:11], s62 offen sc1
    ds_read_b64_tr_b16 a[42:43], v44 offset:58368
    v_mfma_f32_16x16x32_bf16 a[76:79], a[4:7], a[236:239], a[76:79]
    ds_read_b64_tr_b16 a[44:45], v45 offset:57344
    v_mfma_f32_16x16x32_bf16 v[208:211], a[8:11], a[224:227], v[208:211]
    v_mfma_f32_16x16x32_bf16 v[212:215], a[8:11], a[228:231], v[212:215]
    ds_read_b64_tr_b16 a[46:47], v45 offset:58368
    v_mfma_f32_16x16x32_bf16 a[80:83], a[8:11], a[232:235], a[80:83]
    ds_read_b64_tr_b16 a[48:49], v46 offset:57344
    v_mfma_f32_16x16x32_bf16 a[84:87], a[8:11], a[236:239], a[84:87]
    buffer_load_dwordx4 a[152:155], v37, s[8:11], s62 offen sc1
    ds_read_b64_tr_b16 a[50:51], v46 offset:58368
    v_mfma_f32_16x16x32_bf16 v[216:219], a[12:15], a[224:227], v[216:219]
    v_mfma_f32_16x16x32_bf16 v[220:223], a[12:15], a[228:231], v[220:223]
    ds_read_b64_tr_b16 a[52:53], v47 offset:57344
    v_mfma_f32_16x16x32_bf16 a[88:91], a[12:15], a[232:235], a[88:91]
    ds_read_b64_tr_b16 a[54:55], v47 offset:58368
    v_mfma_f32_16x16x32_bf16 a[92:95], a[12:15], a[236:239], a[92:95]
    ds_read_b64_tr_b16 a[56:57], v48 offset:57344
    v_mfma_f32_16x16x32_bf16 v[224:227], a[16:19], a[224:227], v[224:227]
    v_mfma_f32_16x16x32_bf16 v[228:231], a[16:19], a[228:231], v[228:231]
    buffer_load_dwordx4 a[156:159], v55, s[8:11], s62 offen sc1
    ds_read_b64_tr_b16 a[58:59], v48 offset:58368
    v_mfma_f32_16x16x32_bf16 a[96:99], a[16:19], a[232:235], a[96:99]
    ds_read_b64_tr_b16 a[60:61], v49 offset:57344
    v_mfma_f32_16x16x32_bf16 a[100:103], a[16:19], a[236:239], a[100:103]
    v_mfma_f32_16x16x32_bf16 v[232:235], a[20:23], a[224:227], v[232:235]
    ds_read_b64_tr_b16 a[62:63], v49 offset:58368
    v_mfma_f32_16x16x32_bf16 v[236:239], a[20:23], a[228:231], v[236:239]
    s_add_u32 s62, s62, 0x20000
    v_mfma_f32_16x16x32_bf16 a[104:107], a[20:23], a[232:235], a[104:107]
    s_add_u32 s52, s47, 528384
    v_mfma_f32_16x16x32_bf16 a[108:111], a[20:23], a[236:239], a[108:111]
    buffer_store_dwordx4 v[144:147], v1, s[48:51], s52 offen offset:0 sc1
    v_mfma_f32_16x16x32_bf16 v[240:243], a[24:27], a[224:227], v[240:243]
    v_mfma_f32_16x16x32_bf16 v[244:247], a[24:27], a[228:231], v[244:247]
    v_mfma_f32_16x16x32_bf16 a[112:115], a[24:27], a[232:235], a[112:115]
    v_mfma_f32_16x16x32_bf16 a[116:119], a[24:27], a[236:239], a[116:119]
    v_mfma_f32_16x16x32_bf16 v[248:251], a[28:31], a[224:227], v[248:251]
    v_mfma_f32_16x16x32_bf16 v[252:255], a[28:31], a[228:231], v[252:255]
    v_mfma_f32_16x16x32_bf16 a[120:123], a[28:31], a[232:235], a[120:123]
    v_mfma_f32_16x16x32_bf16 a[124:127], a[28:31], a[236:239], a[124:127]
    s_waitcnt vmcnt(9) lgkmcnt(0)
    s_barrier
    v_mfma_f32_16x16x32_bf16 v[192:195], a[32:35], a[240:243], v[192:195]
    ds_read_b64_tr_b16 a[0:1], v42 offset:0
    ds_read_b64_tr_b16 a[2:3], v42 offset:1024
    v_mfma_f32_16x16x32_bf16 v[196:199], a[32:35], a[244:247], v[196:199]
    s_add_u32 m0, s60, 114688
    v_mfma_f32_16x16x32_bf16 a[64:67], a[32:35], a[248:251], a[64:67]
    buffer_load_dwordx4 v38, s[12:15], s61 offen offset:0 lds
    ds_read_b64_tr_b16 a[4:5], v43 offset:0
    v_mfma_f32_16x16x32_bf16 a[68:71], a[32:35], a[252:255], a[68:71]
    ds_read_b64_tr_b16 a[6:7], v43 offset:1024
    v_mfma_f32_16x16x32_bf16 v[200:203], a[36:39], a[240:243], v[200:203]
    buffer_load_dwordx4 v39, s[12:15], s61 offen offset:1024 lds
    ds_read_b64_tr_b16 a[8:9], v44 offset:0
    v_mfma_f32_16x16x32_bf16 v[204:207], a[36:39], a[244:247], v[204:207]
    v_mfma_f32_16x16x32_bf16 a[72:75], a[36:39], a[248:251], a[72:75]
    ds_read_b64_tr_b16 a[10:11], v44 offset:1024
    v_mfma_f32_16x16x32_bf16 a[76:79], a[36:39], a[252:255], a[76:79]
    buffer_load_dwordx4 v40, s[12:15], s61 offen offset:2048 lds
    ds_read_b64_tr_b16 a[12:13], v45 offset:0
    v_mfma_f32_16x16x32_bf16 v[208:211], a[40:43], a[240:243], v[208:211]
    v_mfma_f32_16x16x32_bf16 v[212:215], a[40:43], a[244:247], v[212:215]
    ds_read_b64_tr_b16 a[14:15], v45 offset:1024
    v_mfma_f32_16x16x32_bf16 a[80:83], a[40:43], a[248:251], a[80:83]
    buffer_load_dwordx4 v41, s[12:15], s61 offen offset:3072 lds
    ds_read_b64_tr_b16 a[16:17], v46 offset:0
    v_mfma_f32_16x16x32_bf16 a[84:87], a[40:43], a[252:255], a[84:87]
    ds_read_b64_tr_b16 a[18:19], v46 offset:1024
    v_mfma_f32_16x16x32_bf16 v[216:219], a[44:47], a[240:243], v[216:219]
    s_add_u32 s61, s61, 0x80000
    v_mfma_f32_16x16x32_bf16 v[220:223], a[44:47], a[244:247], v[220:223]
    buffer_load_dwordx4 a[160:163], v36, s[8:11], s62 offen sc1
    ds_read_b64_tr_b16 a[20:21], v47 offset:0
    v_mfma_f32_16x16x32_bf16 a[88:91], a[44:47], a[248:251], a[88:91]
    ds_read_b64_tr_b16 a[22:23], v47 offset:1024
    v_mfma_f32_16x16x32_bf16 a[92:95], a[44:47], a[252:255], a[92:95]
    buffer_load_dwordx4 a[164:167], v54, s[8:11], s62 offen sc1
    ds_read_b64_tr_b16 a[24:25], v48 offset:0
    v_mfma_f32_16x16x32_bf16 v[224:227], a[48:51], a[240:243], v[224:227]
    v_mfma_f32_16x16x32_bf16 v[228:231], a[48:51], a[244:247], v[228:231]
    ds_read_b64_tr_b16 a[26:27], v48 offset:1024
    v_mfma_f32_16x16x32_bf16 a[96:99], a[48:51], a[248:251], a[96:99]
    buffer_load_dwordx4 a[168:171], v37, s[8:11], s62 offen sc1
    ds_read_b64_tr_b16 a[28:29], v49 offset:0
    v_mfma_f32_16x16x32_bf16 a[100:103], a[48:51], a[252:255], a[100:103]
    v_mfma_f32_16x16x32_bf16 v[232:235], a[52:55], a[240:243], v[232:235]
    ds_read_b64_tr_b16 a[30:31], v49 offset:1024
    v_mfma_f32_16x16x32_bf16 v[236:239], a[52:55], a[244:247], v[236:239]
    buffer_load_dwordx4 a[172:175], v55, s[8:11], s62 offen sc1
    v_mfma_f32_16x16x32_bf16 a[104:107], a[52:55], a[248:251], a[104:107]
    v_mfma_f32_16x16x32_bf16 a[108:111], a[52:55], a[252:255], a[108:111]
    s_add_u32 s62, s62, 0x20000
    v_mfma_f32_16x16x32_bf16 v[240:243], a[56:59], a[240:243], v[240:243]
    s_add_u32 s52, s47, 528384
    v_mfma_f32_16x16x32_bf16 v[244:247], a[56:59], a[244:247], v[244:247]
    buffer_store_dwordx4 v[148:151], v1, s[48:51], s52 offen offset:1024 sc1
    v_mfma_f32_16x16x32_bf16 a[112:115], a[56:59], a[248:251], a[112:115]
    v_mfma_f32_16x16x32_bf16 a[116:119], a[56:59], a[252:255], a[116:119]
    v_mfma_f32_16x16x32_bf16 v[248:251], a[60:63], a[240:243], v[248:251]
    s_cmp_eq_u32 s45, 0
    s_cbranch_scc1 k12_ool_64
k12_oolret_65:
    v_mfma_f32_16x16x32_bf16 v[252:255], a[60:63], a[244:247], v[252:255]
    v_mfma_f32_16x16x32_bf16 a[120:123], a[60:63], a[248:251], a[120:123]
    v_mfma_f32_16x16x32_bf16 a[124:127], a[60:63], a[252:255], a[124:127]
    s_waitcnt vmcnt(14) lgkmcnt(0)
    v_mfma_f32_16x16x32_bf16 v[192:195], a[0:3], a[128:131], v[192:195]
    ds_read_b64_tr_b16 a[32:33], v42 offset:8192
    ds_read_b64_tr_b16 a[34:35], v42 offset:9216
    v_mfma_f32_16x16x32_bf16 v[196:199], a[0:3], a[132:135], v[196:199]
    buffer_load_dwordx4 a[176:179], v36, s[8:11], s62 offen sc1
    v_mfma_f32_16x16x32_bf16 a[64:67], a[0:3], a[136:139], a[64:67]
    ds_read_b64_tr_b16 a[36:37], v43 offset:8192
    v_mfma_f32_16x16x32_bf16 a[68:71], a[0:3], a[140:143], a[68:71]
    ds_read_b64_tr_b16 a[38:39], v43 offset:9216
    v_mfma_f32_16x16x32_bf16 v[200:203], a[4:7], a[128:131], v[200:203]
    ds_read_b64_tr_b16 a[40:41], v44 offset:8192
    v_mfma_f32_16x16x32_bf16 v[204:207], a[4:7], a[132:135], v[204:207]
    v_mfma_f32_16x16x32_bf16 a[72:75], a[4:7], a[136:139], a[72:75]
    buffer_load_dwordx4 a[180:183], v54, s[8:11], s62 offen sc1
    ds_read_b64_tr_b16 a[42:43], v44 offset:9216
    v_mfma_f32_16x16x32_bf16 a[76:79], a[4:7], a[140:143], a[76:79]
    ds_read_b64_tr_b16 a[44:45], v45 offset:8192
    v_mfma_f32_16x16x32_bf16 v[208:211], a[8:11], a[128:131], v[208:211]
    v_mfma_f32_16x16x32_bf16 v[212:215], a[8:11], a[132:135], v[212:215]
    ds_read_b64_tr_b16 a[46:47], v45 offset:9216
    v_mfma_f32_16x16x32_bf16 a[80:83], a[8:11], a[136:139], a[80:83]
    ds_read_b64_tr_b16 a[48:49], v46 offset:8192
    v_mfma_f32_16x16x32_bf16 a[84:87], a[8:11], a[140:143], a[84:87]
    buffer_load_dwordx4 a[184:187], v37, s[8:11], s62 offen sc1
    ds_read_b64_tr_b16 a[50:51], v46 offset:9216
    v_mfma_f32_16x16x32_bf16 v[216:219], a[12:15], a[128:131], v[216:219]
    v_mfma_f32_16x16x32_bf16 v[220:223], a[12:15], a[132:135], v[220:223]
    ds_read_b64_tr_b16 a[52:53], v47 offset:8192
    v_mfma_f32_16x16x32_bf16 a[88:91], a[12:15], a[136:139], a[88:91]
    ds_read_b64_tr_b16 a[54:55], v47 offset:9216
    v_mfma_f32_16x16x32_bf16 a[92:95], a[12:15], a[140:143], a[92:95]
    ds_read_b64_tr_b16 a[56:57], v48 offset:8192
    v_mfma_f32_16x16x32_bf16 v[224:227], a[16:19], a[128:131], v[224:227]
    v_mfma_f32_16x16x32_bf16 v[228:231], a[16:19], a[132:135], v[228:231]
    buffer_load_dwordx4 a[188:191], v55, s[8:11], s62 offen sc1
    ds_read_b64_tr_b16 a[58:59], v48 offset:9216
    v_mfma_f32_16x16x32_bf16 a[96:99], a[16:19], a[136:139], a[96:99]
    ds_read_b64_tr_b16 a[60:61], v49 offset:8192
    v_mfma_f32_16x16x32_bf16 a[100:103], a[16:19], a[140:143], a[100:103]
    v_mfma_f32_16x16x32_bf16 v[232:235], a[20:23], a[128:131], v[232:235]
    ds_read_b64_tr_b16 a[62:63], v49 offset:9216
    v_mfma_f32_16x16x32_bf16 v[236:239], a[20:23], a[132:135], v[236:239]
    s_add_u32 s62, s62, 0x20000
    v_mfma_f32_16x16x32_bf16 a[104:107], a[20:23], a[136:139], a[104:107]
    s_add_u32 s52, s47, 528384
    v_mfma_f32_16x16x32_bf16 a[108:111], a[20:23], a[140:143], a[108:111]
    buffer_store_dwordx4 v[152:155], v1, s[48:51], s52 offen offset:2048 sc1
    v_mfma_f32_16x16x32_bf16 v[240:243], a[24:27], a[128:131], v[240:243]
    v_mfma_f32_16x16x32_bf16 v[244:247], a[24:27], a[132:135], v[244:247]
    v_mfma_f32_16x16x32_bf16 a[112:115], a[24:27], a[136:139], a[112:115]
    v_mfma_f32_16x16x32_bf16 a[116:119], a[24:27], a[140:143], a[116:119]
    v_mfma_f32_16x16x32_bf16 v[248:251], a[28:31], a[128:131], v[248:251]
    v_mfma_f32_16x16x32_bf16 v[252:255], a[28:31], a[132:135], v[252:255]
    v_mfma_f32_16x16x32_bf16 a[120:123], a[28:31], a[136:139], a[120:123]
    v_mfma_f32_16x16x32_bf16 a[124:127], a[28:31], a[140:143], a[124:127]
    s_waitcnt vmcnt(10) lgkmcnt(0)
    s_barrier
    v_mfma_f32_16x16x32_bf16 v[192:195], a[32:35], a[144:147], v[192:195]
    ds_read_b64_tr_b16 a[0:1], v42 offset:16384
    ds_read_b64_tr_b16 a[2:3], v42 offset:17408
    v_mfma_f32_16x16x32_bf16 v[196:199], a[32:35], a[148:151], v[196:199]
    s_add_u32 m0, s60, 131072
    v_mfma_f32_16x16x32_bf16 a[64:67], a[32:35], a[152:155], a[64:67]
    buffer_load_dwordx4 v38, s[12:15], s61 offen offset:0 lds
    ds_read_b64_tr_b16 a[4:5], v43 offset:16384
    v_mfma_f32_16x16x32_bf16 a[68:71], a[32:35], a[156:159], a[68:71]
    ds_read_b64_tr_b16 a[6:7], v43 offset:17408
    v_mfma_f32_16x16x32_bf16 v[200:203], a[36:39], a[144:147], v[200:203]
    buffer_load_dwordx4 v39, s[12:15], s61 offen offset:1024 lds
    ds_read_b64_tr_b16 a[8:9], v44 offset:16384
    v_mfma_f32_16x16x32_bf16 v[204:207], a[36:39], a[148:151], v[204:207]
    v_mfma_f32_16x16x32_bf16 a[72:75], a[36:39], a[152:155], a[72:75]
    ds_read_b64_tr_b16 a[10:11], v44 offset:17408
    v_mfma_f32_16x16x32_bf16 a[76:79], a[36:39], a[156:159], a[76:79]
    buffer_load_dwordx4 v40, s[12:15], s61 offen offset:2048 lds
    ds_read_b64_tr_b16 a[12:13], v45 offset:16384
    v_mfma_f32_16x16x32_bf16 v[208:211], a[40:43], a[144:147], v[208:211]
    v_mfma_f32_16x16x32_bf16 v[212:215], a[40:43], a[148:151], v[212:215]
    ds_read_b64_tr_b16 a[14:15], v45 offset:17408
    v_mfma_f32_16x16x32_bf16 a[80:83], a[40:43], a[152:155], a[80:83]
    buffer_load_dwordx4 v41, s[12:15], s61 offen offset:3072 lds
    ds_read_b64_tr_b16 a[16:17], v46 offset:16384
    v_mfma_f32_16x16x32_bf16 a[84:87], a[40:43], a[156:159], a[84:87]
    ds_read_b64_tr_b16 a[18:19], v46 offset:17408
    v_mfma_f32_16x16x32_bf16 v[216:219], a[44:47], a[144:147], v[216:219]
    s_add_u32 s61, s61, 0x80000
    v_mfma_f32_16x16x32_bf16 v[220:223], a[44:47], a[148:151], v[220:223]
    buffer_load_dwordx4 a[192:195], v36, s[8:11], s62 offen sc1
    ds_read_b64_tr_b16 a[20:21], v47 offset:16384
    v_mfma_f32_16x16x32_bf16 a[88:91], a[44:47], a[152:155], a[88:91]
    ds_read_b64_tr_b16 a[22:23], v47 offset:17408
    v_mfma_f32_16x16x32_bf16 a[92:95], a[44:47], a[156:159], a[92:95]
    buffer_load_dwordx4 a[196:199], v54, s[8:11], s62 offen sc1
    ds_read_b64_tr_b16 a[24:25], v48 offset:16384
    v_mfma_f32_16x16x32_bf16 v[224:227], a[48:51], a[144:147], v[224:227]
    v_mfma_f32_16x16x32_bf16 v[228:231], a[48:51], a[148:151], v[228:231]
    ds_read_b64_tr_b16 a[26:27], v48 offset:17408
    v_mfma_f32_16x16x32_bf16 a[96:99], a[48:51], a[152:155], a[96:99]
    buffer_load_dwordx4 a[200:203], v37, s[8:11], s62 offen sc1
    ds_read_b64_tr_b16 a[28:29], v49 offset:16384
    v_mfma_f32_16x16x32_bf16 a[100:103], a[48:51], a[156:159], a[100:103]
    v_mfma_f32_16x16x32_bf16 v[232:235], a[52:55], a[144:147], v[232:235]
    ds_read_b64_tr_b16 a[30:31], v49 offset:17408
    v_mfma_f32_16x16x32_bf16 v[236:239], a[52:55], a[148:151], v[236:239]
    buffer_load_dwordx4 a[204:207], v55, s[8:11], s62 offen sc1
    v_mfma_f32_16x16x32_bf16 a[104:107], a[52:55], a[152:155], a[104:107]
    v_mfma_f32_16x16x32_bf16 a[108:111], a[52:55], a[156:159], a[108:111]
    s_add_u32 s62, s62, 0x20000
    v_mfma_f32_16x16x32_bf16 v[240:243], a[56:59], a[144:147], v[240:243]
    s_add_u32 s52, s47, 528384
    v_mfma_f32_16x16x32_bf16 v[244:247], a[56:59], a[148:151], v[244:247]
    buffer_store_dwordx4 v[156:159], v1, s[48:51], s52 offen offset:3072 sc1
    v_mfma_f32_16x16x32_bf16 a[112:115], a[56:59], a[152:155], a[112:115]
    v_mfma_f32_16x16x32_bf16 a[116:119], a[56:59], a[156:159], a[116:119]
    v_mfma_f32_16x16x32_bf16 v[248:251], a[60:63], a[144:147], v[248:251]
    v_mfma_f32_16x16x32_bf16 v[252:255], a[60:63], a[148:151], v[252:255]
    v_mfma_f32_16x16x32_bf16 a[120:123], a[60:63], a[152:155], a[120:123]
    v_mfma_f32_16x16x32_bf16 a[124:127], a[60:63], a[156:159], a[124:127]
    s_waitcnt vmcnt(15) lgkmcnt(0)
    v_mfma_f32_16x16x32_bf16 v[192:195], a[0:3], a[160:163], v[192:195]
    ds_read_b64_tr_b16 a[32:33], v42 offset:24576
    ds_read_b64_tr_b16 a[34:35], v42 offset:25600
    v_mfma_f32_16x16x32_bf16 v[196:199], a[0:3], a[164:167], v[196:199]
    buffer_load_dwordx4 a[208:211], v36, s[8:11], s62 offen sc1
    v_mfma_f32_16x16x32_bf16 a[64:67], a[0:3], a[168:171], a[64:67]
    ds_read_b64_tr_b16 a[36:37], v43 offset:24576
    v_mfma_f32_16x16x32_bf16 a[68:71], a[0:3], a[172:175], a[68:71]
    ds_read_b64_tr_b16 a[38:39], v43 offset:25600
    v_mfma_f32_16x16x32_bf16 v[200:203], a[4:7], a[160:163], v[200:203]
    ds_read_b64_tr_b16 a[40:41], v44 offset:24576
    v_mfma_f32_16x16x32_bf16 v[204:207], a[4:7], a[164:167], v[204:207]
    v_mfma_f32_16x16x32_bf16 a[72:75], a[4:7], a[168:171], a[72:75]
    buffer_load_dwordx4 a[212:215], v54, s[8:11], s62 offen sc1
    ds_read_b64_tr_b16 a[42:43], v44 offset:25600
    v_mfma_f32_16x16x32_bf16 a[76:79], a[4:7], a[172:175], a[76:79]
    ds_read_b64_tr_b16 a[44:45], v45 offset:24576
    v_mfma_f32_16x16x32_bf16 v[208:211], a[8:11], a[160:163], v[208:211]
    v_mfma_f32_16x16x32_bf16 v[212:215], a[8:11], a[164:167], v[212:215]
    ds_read_b64_tr_b16 a[46:47], v45 offset:25600
    v_mfma_f32_16x16x32_bf16 a[80:83], a[8:11], a[168:171], a[80:83]
    ds_read_b64_tr_b16 a[48:49], v46 offset:24576
    v_mfma_f32_16x16x32_bf16 a[84:87], a[8:11], a[172:175], a[84:87]
    buffer_load_dwordx4 a[216:219], v37, s[8:11], s62 offen sc1
    ds_read_b64_tr_b16 a[50:51], v46 offset:25600
    v_mfma_f32_16x16x32_bf16 v[216:219], a[12:15], a[160:163], v[216:219]
    v_mfma_f32_16x16x32_bf16 v[220:223], a[12:15], a[164:167], v[220:223]
    ds_read_b64_tr_b16 a[52:53], v47 offset:24576
    v_mfma_f32_16x16x32_bf16 a[88:91], a[12:15], a[168:171], a[88:91]
    ds_read_b64_tr_b16 a[54:55], v47 offset:25600
    v_mfma_f32_16x16x32_bf16 a[92:95], a[12:15], a[172:175], a[92:95]
    ds_read_b64_tr_b16 a[56:57], v48 offset:24576
    v_mfma_f32_16x16x32_bf16 v[224:227], a[16:19], a[160:163], v[224:227]
    v_mfma_f32_16x16x32_bf16 v[228:231], a[16:19], a[164:167], v[228:231]
    buffer_load_dwordx4 a[220:223], v55, s[8:11], s62 offen sc1
    ds_read_b64_tr_b16 a[58:59], v48 offset:25600
    v_mfma_f32_16x16x32_bf16 a[96:99], a[16:19], a[168:171], a[96:99]
    ds_read_b64_tr_b16 a[60:61], v49 offset:24576
    v_mfma_f32_16x16x32_bf16 a[100:103], a[16:19], a[172:175], a[100:103]
    v_mfma_f32_16x16x32_bf16 v[232:235], a[20:23], a[160:163], v[232:235]
    ds_read_b64_tr_b16 a[62:63], v49 offset:25600
    v_mfma_f32_16x16x32_bf16 v[236:239], a[20:23], a[164:167], v[236:239]
    s_add_u32 s62, s62, 0x20000
    v_mfma_f32_16x16x32_bf16 a[104:107], a[20:23], a[168:171], a[104:107]
    s_add_u32 s52, s47, 532480
    v_mfma_f32_16x16x32_bf16 a[108:111], a[20:23], a[172:175], a[108:111]
    buffer_store_dwordx4 v[168:171], v1, s[48:51], s52 offen offset:2048 sc1
    v_mfma_f32_16x16x32_bf16 v[240:243], a[24:27], a[160:163], v[240:243]
    v_mfma_f32_16x16x32_bf16 v[244:247], a[24:27], a[164:167], v[244:247]
    v_mfma_f32_16x16x32_bf16 a[112:115], a[24:27], a[168:171], a[112:115]
    v_mfma_f32_16x16x32_bf16 a[116:119], a[24:27], a[172:175], a[116:119]
    v_mfma_f32_16x16x32_bf16 v[248:251], a[28:31], a[160:163], v[248:251]
    v_mfma_f32_16x16x32_bf16 v[252:255], a[28:31], a[164:167], v[252:255]
    v_mfma_f32_16x16x32_bf16 a[120:123], a[28:31], a[168:171], a[120:123]
    v_mfma_f32_16x16x32_bf16 a[124:127], a[28:31], a[172:175], a[124:127]
    s_waitcnt vmcnt(10) lgkmcnt(0)
    s_barrier
    v_mfma_f32_16x16x32_bf16 v[192:195], a[32:35], a[176:179], v[192:195]
    ds_read_b64_tr_b16 a[0:1], v42 offset:32768
    ds_read_b64_tr_b16 a[2:3], v42 offset:33792
    v_mfma_f32_16x16x32_bf16 v[196:199], a[32:35], a[180:183], v[196:199]
    s_cmp_eq_u32 s56, 0
    s_cbranch_scc1 k12_ool_66
k12_oolret_67:
    v_mfma_f32_16x16x32_bf16 a[64:67], a[32:35], a[184:187], a[64:67]
    s_add_u32 m0, s60, 147456
    ds_read_b64_tr_b16 a[4:5], v43 offset:32768
    v_mfma_f32_16x16x32_bf16 a[68:71], a[32:35], a[188:191], a[68:71]
    buffer_load_dwordx4 v38, s[12:15], s61 offen offset:0 lds
    ds_read_b64_tr_b16 a[6:7], v43 offset:33792
    v_mfma_f32_16x16x32_bf16 v[200:203], a[36:39], a[176:179], v[200:203]
    buffer_load_dwordx4 v39, s[12:15], s61 offen offset:1024 lds
    ds_read_b64_tr_b16 a[8:9], v44 offset:32768
    v_mfma_f32_16x16x32_bf16 v[204:207], a[36:39], a[180:183], v[204:207]
    v_mfma_f32_16x16x32_bf16 a[72:75], a[36:39], a[184:187], a[72:75]
    ds_read_b64_tr_b16 a[10:11], v44 offset:33792
    v_mfma_f32_16x16x32_bf16 a[76:79], a[36:39], a[188:191], a[76:79]
    buffer_load_dwordx4 v40, s[12:15], s61 offen offset:2048 lds
    ds_read_b64_tr_b16 a[12:13], v45 offset:32768
    v_mfma_f32_16x16x32_bf16 v[208:211], a[40:43], a[176:179], v[208:211]
    s_mov_b32 s32, s60
    v_mfma_f32_16x16x32_bf16 v[212:215], a[40:43], a[180:183], v[212:215]
    ds_read_b64_tr_b16 a[14:15], v45 offset:33792
    v_mfma_f32_16x16x32_bf16 a[80:83], a[40:43], a[184:187], a[80:83]
    s_mov_b32 s34, s60
    ds_read_b64_tr_b16 a[16:17], v46 offset:32768
    v_mfma_f32_16x16x32_bf16 a[84:87], a[40:43], a[188:191], a[84:87]
    buffer_load_dwordx4 v41, s[12:15], s61 offen offset:3072 lds
    ds_read_b64_tr_b16 a[18:19], v46 offset:33792
    v_mfma_f32_16x16x32_bf16 v[216:219], a[44:47], a[176:179], v[216:219]
    v_mfma_f32_16x16x32_bf16 v[220:223], a[44:47], a[180:183], v[220:223]
    s_mov_b32 s33, s60
    ds_read_b64_tr_b16 a[20:21], v47 offset:32768
    v_mfma_f32_16x16x32_bf16 a[88:91], a[44:47], a[184:187], a[88:91]
    s_add_u32 s61, s61, 0x80000
    buffer_load_dwordx4 a[224:227], v36, s[8:11], s62 offen sc1
    ds_read_b64_tr_b16 a[22:23], v47 offset:33792
    v_mfma_f32_16x16x32_bf16 a[92:95], a[44:47], a[188:191], a[92:95]
    ds_read_b64_tr_b16 a[24:25], v48 offset:32768
    v_mfma_f32_16x16x32_bf16 v[224:227], a[48:51], a[176:179], v[224:227]
    s_add_u32 s35, s60, 0x10000
    v_mfma_f32_16x16x32_bf16 v[228:231], a[48:51], a[180:183], v[228:231]
    buffer_load_dwordx4 a[228:231], v54, s[8:11], s62 offen sc1
    ds_read_b64_tr_b16 a[26:27], v48 offset:33792
    v_mfma_f32_16x16x32_bf16 a[96:99], a[48:51], a[184:187], a[96:99]
    ds_read_b64_tr_b16 a[28:29], v49 offset:32768
    v_mfma_f32_16x16x32_bf16 a[100:103], a[48:51], a[188:191], a[100:103]
    v_mfma_f32_16x16x32_bf16 v[232:235], a[52:55], a[176:179], v[232:235]
    buffer_load_dwordx4 a[232:235], v37, s[8:11], s62 offen sc1
    ds_read_b64_tr_b16 a[30:31], v49 offset:33792
    v_mfma_f32_16x16x32_bf16 v[236:239], a[52:55], a[180:183], v[236:239]
    v_mfma_f32_16x16x32_bf16 a[104:107], a[52:55], a[184:187], a[104:107]
    v_mfma_f32_16x16x32_bf16 a[108:111], a[52:55], a[188:191], a[108:111]
    v_mfma_f32_16x16x32_bf16 v[240:243], a[56:59], a[176:179], v[240:243]
    buffer_load_dwordx4 a[236:239], v55, s[8:11], s62 offen sc1
    v_mfma_f32_16x16x32_bf16 v[244:247], a[56:59], a[180:183], v[244:247]
    v_mfma_f32_16x16x32_bf16 a[112:115], a[56:59], a[184:187], a[112:115]
    s_add_u32 s62, s62, 0x20000
    v_mfma_f32_16x16x32_bf16 a[116:119], a[56:59], a[188:191], a[116:119]
    v_mfma_f32_16x16x32_bf16 v[248:251], a[60:63], a[176:179], v[248:251]
    v_mfma_f32_16x16x32_bf16 v[252:255], a[60:63], a[180:183], v[252:255]
    v_mfma_f32_16x16x32_bf16 a[120:123], a[60:63], a[184:187], a[120:123]
    v_mfma_f32_16x16x32_bf16 a[124:127], a[60:63], a[188:191], a[124:127]
    s_waitcnt vmcnt(14) lgkmcnt(0)
    v_mfma_f32_16x16x32_bf16 v[192:195], a[0:3], a[192:195], v[192:195]
    ds_read_b64_tr_b16 a[32:33], v42 offset:40960
    ds_read_b64_tr_b16 a[34:35], v42 offset:41984
    v_mfma_f32_16x16x32_bf16 v[196:199], a[0:3], a[196:199], v[196:199]
    buffer_load_dwordx4 a[240:243], v36, s[8:11], s62 offen sc1
    v_mfma_f32_16x16x32_bf16 a[64:67], a[0:3], a[200:203], a[64:67]
    ds_read_b64_tr_b16 a[36:37], v43 offset:40960
    v_mfma_f32_16x16x32_bf16 a[68:71], a[0:3], a[204:207], a[68:71]
    ds_read_b64_tr_b16 a[38:39], v43 offset:41984
    v_mfma_f32_16x16x32_bf16 v[200:203], a[4:7], a[192:195], v[200:203]
    ds_read_b64_tr_b16 a[40:41], v44 offset:40960
    v_mfma_f32_16x16x32_bf16 v[204:207], a[4:7], a[196:199], v[204:207]
    v_mfma_f32_16x16x32_bf16 a[72:75], a[4:7], a[200:203], a[72:75]
    buffer_load_dwordx4 a[244:247], v54, s[8:11], s62 offen sc1
    ds_read_b64_tr_b16 a[42:43], v44 offset:41984
    v_mfma_f32_16x16x32_bf16 a[76:79], a[4:7], a[204:207], a[76:79]
    ds_read_b64_tr_b16 a[44:45], v45 offset:40960
    v_mfma_f32_16x16x32_bf16 v[208:211], a[8:11], a[192:195], v[208:211]
    v_mfma_f32_16x16x32_bf16 v[212:215], a[8:11], a[196:199], v[212:215]
    ds_read_b64_tr_b16 a[46:47], v45 offset:41984
    v_mfma_f32_16x16x32_bf16 a[80:83], a[8:11], a[200:203], a[80:83]
    ds_read_b64_tr_b16 a[48:49], v46 offset:40960
    v_mfma_f32_16x16x32_bf16 a[84:87], a[8:11], a[204:207], a[84:87]
    buffer_load_dwordx4 a[248:251], v37, s[8:11], s62 offen sc1
    ds_read_b64_tr_b16 a[50:51], v46 offset:41984
    v_mfma_f32_16x16x32_bf16 v[216:219], a[12:15], a[192:195], v[216:219]
    v_mfma_f32_16x16x32_bf16 v[220:223], a[12:15], a[196:199], v[220:223]
    ds_read_b64_tr_b16 a[52:53], v47 offset:40960
    v_mfma_f32_16x16x32_bf16 a[88:91], a[12:15], a[200:203], a[88:91]
    ds_read_b64_tr_b16 a[54:55], v47 offset:41984
    v_mfma_f32_16x16x32_bf16 a[92:95], a[12:15], a[204:207], a[92:95]
    ds_read_b64_tr_b16 a[56:57], v48 offset:40960
    v_mfma_f32_16x16x32_bf16 v[224:227], a[16:19], a[192:195], v[224:227]
    v_mfma_f32_16x16x32_bf16 v[228:231], a[16:19], a[196:199], v[228:231]
    buffer_load_dwordx4 a[252:255], v55, s[8:11], s62 offen sc1
    ds_read_b64_tr_b16 a[58:59], v48 offset:41984
    v_mfma_f32_16x16x32_bf16 a[96:99], a[16:19], a[200:203], a[96:99]
    ds_read_b64_tr_b16 a[60:61], v49 offset:40960
    v_mfma_f32_16x16x32_bf16 a[100:103], a[16:19], a[204:207], a[100:103]
    v_mfma_f32_16x16x32_bf16 v[232:235], a[20:23], a[192:195], v[232:235]
    ds_read_b64_tr_b16 a[62:63], v49 offset:41984
    v_mfma_f32_16x16x32_bf16 v[236:239], a[20:23], a[196:199], v[236:239]
    s_add_u32 s62, s62, 0x20000
    v_mfma_f32_16x16x32_bf16 a[104:107], a[20:23], a[200:203], a[104:107]
    s_add_u32 s52, s47, 532480
    v_mfma_f32_16x16x32_bf16 a[108:111], a[20:23], a[204:207], a[108:111]
    buffer_store_dwordx4 v[172:175], v1, s[48:51], s52 offen offset:3072 sc1
    v_mfma_f32_16x16x32_bf16 v[240:243], a[24:27], a[192:195], v[240:243]
    v_mfma_f32_16x16x32_bf16 v[244:247], a[24:27], a[196:199], v[244:247]
    v_mfma_f32_16x16x32_bf16 a[112:115], a[24:27], a[200:203], a[112:115]
    v_mfma_f32_16x16x32_bf16 a[116:119], a[24:27], a[204:207], a[116:119]
    v_mfma_f32_16x16x32_bf16 v[248:251], a[28:31], a[192:195], v[248:251]
    v_add_co_u32 v2, vcc, 0x4000, v2
    s_nop 1
    v_addc_co_u32 v3, vcc, 0, v3, vcc
    global_load_dword v51, v[2:3], off
    v_mfma_f32_16x16x32_bf16 v[252:255], a[28:31], a[196:199], v[252:255]
    v_mfma_f32_16x16x32_bf16 a[120:123], a[28:31], a[200:203], a[120:123]
    v_mfma_f32_16x16x32_bf16 a[124:127], a[28:31], a[204:207], a[124:127]
    s_waitcnt vmcnt(9) lgkmcnt(0)
    s_barrier
    v_mfma_f32_16x16x32_bf16 v[192:195], a[32:35], a[208:211], v[192:195]
    ds_read_b64_tr_b16 a[0:1], v42 offset:49152
    ds_read_b64_tr_b16 a[2:3], v42 offset:50176
    v_mfma_f32_16x16x32_bf16 v[196:199], a[32:35], a[212:215], v[196:199]
    s_add_u32 m0, s60, 98304
    v_mfma_f32_16x16x32_bf16 a[64:67], a[32:35], a[216:219], a[64:67]
    buffer_load_dwordx4 v38, s[12:15], s61 offen offset:0 lds
    ds_read_b64_tr_b16 a[4:5], v43 offset:49152
    v_mfma_f32_16x16x32_bf16 a[68:71], a[32:35], a[220:223], a[68:71]
    ds_read_b64_tr_b16 a[6:7], v43 offset:50176
    v_mfma_f32_16x16x32_bf16 v[200:203], a[36:39], a[208:211], v[200:203]
    buffer_load_dwordx4 v39, s[12:15], s61 offen offset:1024 lds
    ds_read_b64_tr_b16 a[8:9], v44 offset:49152
    v_mfma_f32_16x16x32_bf16 v[204:207], a[36:39], a[212:215], v[204:207]
    v_mfma_f32_16x16x32_bf16 a[72:75], a[36:39], a[216:219], a[72:75]
    ds_read_b64_tr_b16 a[10:11], v44 offset:50176
    v_mfma_f32_16x16x32_bf16 a[76:79], a[36:39], a[220:223], a[76:79]
    buffer_load_dwordx4 v40, s[12:15], s61 offen offset:2048 lds
    ds_read_b64_tr_b16 a[12:13], v45 offset:49152
    v_mfma_f32_16x16x32_bf16 v[208:211], a[40:43], a[208:211], v[208:211]
    v_mfma_f32_16x16x32_bf16 v[212:215], a[40:43], a[212:215], v[212:215]
    ds_read_b64_tr_b16 a[14:15], v45 offset:50176
    v_mfma_f32_16x16x32_bf16 a[80:83], a[40:43], a[216:219], a[80:83]
    buffer_load_dwordx4 v41, s[12:15], s61 offen offset:3072 lds
    ds_read_b64_tr_b16 a[16:17], v46 offset:49152
    v_mfma_f32_16x16x32_bf16 a[84:87], a[40:43], a[220:223], a[84:87]
    ds_read_b64_tr_b16 a[18:19], v46 offset:50176
    v_mfma_f32_16x16x32_bf16 v[216:219], a[44:47], a[208:211], v[216:219]
    s_add_u32 s61, s61, 0x80000
    v_mfma_f32_16x16x32_bf16 v[220:223], a[44:47], a[212:215], v[220:223]
    buffer_load_dwordx4 a[128:131], v36, s[8:11], s62 offen sc1
    ds_read_b64_tr_b16 a[20:21], v47 offset:49152
    v_mfma_f32_16x16x32_bf16 a[88:91], a[44:47], a[216:219], a[88:91]
    ds_read_b64_tr_b16 a[22:23], v47 offset:50176
    v_mfma_f32_16x16x32_bf16 a[92:95], a[44:47], a[220:223], a[92:95]
    buffer_load_dwordx4 a[132:135], v54, s[8:11], s62 offen sc1
    ds_read_b64_tr_b16 a[24:25], v48 offset:49152
    v_mfma_f32_16x16x32_bf16 v[224:227], a[48:51], a[208:211], v[224:227]
    v_mfma_f32_16x16x32_bf16 v[228:231], a[48:51], a[212:215], v[228:231]
    ds_read_b64_tr_b16 a[26:27], v48 offset:50176
    v_mfma_f32_16x16x32_bf16 a[96:99], a[48:51], a[216:219], a[96:99]
    buffer_load_dwordx4 a[136:139], v37, s[8:11], s62 offen sc1
    ds_read_b64_tr_b16 a[28:29], v49 offset:49152
    v_mfma_f32_16x16x32_bf16 a[100:103], a[48:51], a[220:223], a[100:103]
    v_mfma_f32_16x16x32_bf16 v[232:235], a[52:55], a[208:211], v[232:235]
    ds_read_b64_tr_b16 a[30:31], v49 offset:50176
    v_mfma_f32_16x16x32_bf16 v[236:239], a[52:55], a[212:215], v[236:239]
    buffer_load_dwordx4 a[140:143], v55, s[8:11], s62 offen sc1
    v_mfma_f32_16x16x32_bf16 a[104:107], a[52:55], a[216:219], a[104:107]
    v_mfma_f32_16x16x32_bf16 a[108:111], a[52:55], a[220:223], a[108:111]
    s_add_u32 s62, s62, 0x20000
    v_mfma_f32_16x16x32_bf16 v[240:243], a[56:59], a[208:211], v[240:243]
    s_add_u32 s52, s47, 536576
    v_mfma_f32_16x16x32_bf16 v[244:247], a[56:59], a[212:215], v[244:247]
    buffer_store_dwordx4 v[176:179], v1, s[48:51], s52 offen offset:0 sc1
    v_mfma_f32_16x16x32_bf16 a[112:115], a[56:59], a[216:219], a[112:115]
    v_mfma_f32_16x16x32_bf16 a[116:119], a[56:59], a[220:223], a[116:119]
    v_mfma_f32_16x16x32_bf16 v[248:251], a[60:63], a[208:211], v[248:251]
    v_mfma_f32_16x16x32_bf16 v[252:255], a[60:63], a[212:215], v[252:255]
    v_mfma_f32_16x16x32_bf16 a[120:123], a[60:63], a[216:219], a[120:123]
    v_mfma_f32_16x16x32_bf16 a[124:127], a[60:63], a[220:223], a[124:127]
    s_waitcnt vmcnt(14) lgkmcnt(0)
    v_mfma_f32_16x16x32_bf16 v[192:195], a[0:3], a[224:227], v[192:195]
    ds_read_b64_tr_b16 a[32:33], v42 offset:57344
    ds_read_b64_tr_b16 a[34:35], v42 offset:58368
    v_mfma_f32_16x16x32_bf16 v[196:199], a[0:3], a[228:231], v[196:199]
    buffer_load_dwordx4 a[144:147], v36, s[8:11], s62 offen sc1
    v_mfma_f32_16x16x32_bf16 a[64:67], a[0:3], a[232:235], a[64:67]
    ds_read_b64_tr_b16 a[36:37], v43 offset:57344
    v_mfma_f32_16x16x32_bf16 a[68:71], a[0:3], a[236:239], a[68:71]
    ds_read_b64_tr_b16 a[38:39], v43 offset:58368
    v_mfma_f32_16x16x32_bf16 v[200:203], a[4:7], a[224:227], v[200:203]
    ds_read_b64_tr_b16 a[40:41], v44 offset:57344
    v_mfma_f32_16x16x32_bf16 v[204:207], a[4:7], a[228:231], v[204:207]
    v_mfma_f32_16x16x32_bf16 a[72:75], a[4:7], a[232:235], a[72:75]
    buffer_load_dwordx4 a[148:151], v54, s[8:11], s62 offen sc1
    ds_read_b64_tr_b16 a[42:43], v44 offset:58368
    v_mfma_f32_16x16x32_bf16 a[76:79], a[4:7], a[236:239], a[76:79]
    ds_read_b64_tr_b16 a[44:45], v45 offset:57344
    v_mfma_f32_16x16x32_bf16 v[208:211], a[8:11], a[224:227], v[208:211]
    v_mfma_f32_16x16x32_bf16 v[212:215], a[8:11], a[228:231], v[212:215]
    ds_read_b64_tr_b16 a[46:47], v45 offset:58368
    v_mfma_f32_16x16x32_bf16 a[80:83], a[8:11], a[232:235], a[80:83]
    ds_read_b64_tr_b16 a[48:49], v46 offset:57344
    v_mfma_f32_16x16x32_bf16 a[84:87], a[8:11], a[236:239], a[84:87]
    buffer_load_dwordx4 a[152:155], v37, s[8:11], s62 offen sc1
    ds_read_b64_tr_b16 a[50:51], v46 offset:58368
    v_mfma_f32_16x16x32_bf16 v[216:219], a[12:15], a[224:227], v[216:219]
    v_mfma_f32_16x16x32_bf16 v[220:223], a[12:15], a[228:231], v[220:223]
    ds_read_b64_tr_b16 a[52:53], v47 offset:57344
    v_mfma_f32_16x16x32_bf16 a[88:91], a[12:15], a[232:235], a[88:91]
    ds_read_b64_tr_b16 a[54:55], v47 offset:58368
    v_mfma_f32_16x16x32_bf16 a[92:95], a[12:15], a[236:239], a[92:95]
    ds_read_b64_tr_b16 a[56:57], v48 offset:57344
    v_mfma_f32_16x16x32_bf16 v[224:227], a[16:19], a[224:227], v[224:227]
    v_mfma_f32_16x16x32_bf16 v[228:231], a[16:19], a[228:231], v[228:231]
    buffer_load_dwordx4 a[156:159], v55, s[8:11], s62 offen sc1
    ds_read_b64_tr_b16 a[58:59], v48 offset:58368
    v_mfma_f32_16x16x32_bf16 a[96:99], a[16:19], a[232:235], a[96:99]
    ds_read_b64_tr_b16 a[60:61], v49 offset:57344
    v_mfma_f32_16x16x32_bf16 a[100:103], a[16:19], a[236:239], a[100:103]
    v_mfma_f32_16x16x32_bf16 v[232:235], a[20:23], a[224:227], v[232:235]
    ds_read_b64_tr_b16 a[62:63], v49 offset:58368
    v_mfma_f32_16x16x32_bf16 v[236:239], a[20:23], a[228:231], v[236:239]
    s_add_u32 s62, s62, 0x20000
    v_mfma_f32_16x16x32_bf16 a[104:107], a[20:23], a[232:235], a[104:107]
    s_add_u32 s52, s47, 536576
    v_mfma_f32_16x16x32_bf16 a[108:111], a[20:23], a[236:239], a[108:111]
    buffer_store_dwordx4 v[180:183], v1, s[48:51], s52 offen offset:1024 sc1
    v_mfma_f32_16x16x32_bf16 v[240:243], a[24:27], a[224:227], v[240:243]
    v_mfma_f32_16x16x32_bf16 v[244:247], a[24:27], a[228:231], v[244:247]
    v_mfma_f32_16x16x32_bf16 a[112:115], a[24:27], a[232:235], a[112:115]
    v_mfma_f32_16x16x32_bf16 a[116:119], a[24:27], a[236:239], a[116:119]
    v_mfma_f32_16x16x32_bf16 v[248:251], a[28:31], a[224:227], v[248:251]
    v_mfma_f32_16x16x32_bf16 v[252:255], a[28:31], a[228:231], v[252:255]
    v_mfma_f32_16x16x32_bf16 a[120:123], a[28:31], a[232:235], a[120:123]
    v_mfma_f32_16x16x32_bf16 a[124:127], a[28:31], a[236:239], a[124:127]
    s_waitcnt vmcnt(10) lgkmcnt(0)
    s_barrier
    v_mfma_f32_16x16x32_bf16 v[192:195], a[32:35], a[240:243], v[192:195]
    ds_read_b64_tr_b16 a[0:1], v42 offset:0
    ds_read_b64_tr_b16 a[2:3], v42 offset:1024
    v_mfma_f32_16x16x32_bf16 v[196:199], a[32:35], a[244:247], v[196:199]
    s_cmp_eq_u32 s30, 0
    s_cbranch_scc1 k12_ool_68
k12_oolret_69:
    v_mfma_f32_16x16x32_bf16 a[64:67], a[32:35], a[248:251], a[64:67]
    s_add_u32 m0, s60, 114688
    ds_read_b64_tr_b16 a[4:5], v43 offset:0
    v_mfma_f32_16x16x32_bf16 a[68:71], a[32:35], a[252:255], a[68:71]
    buffer_load_dwordx4 v38, s[12:15], s61 offen offset:0 lds
    ds_read_b64_tr_b16 a[6:7], v43 offset:1024
    v_mfma_f32_16x16x32_bf16 v[200:203], a[36:39], a[240:243], v[200:203]
    buffer_load_dwordx4 v39, s[12:15], s61 offen offset:1024 lds
    ds_read_b64_tr_b16 a[8:9], v44 offset:0
    v_mfma_f32_16x16x32_bf16 v[204:207], a[36:39], a[244:247], v[204:207]
    v_mfma_f32_16x16x32_bf16 a[72:75], a[36:39], a[248:251], a[72:75]
    ds_read_b64_tr_b16 a[10:11], v44 offset:1024
    v_mfma_f32_16x16x32_bf16 a[76:79], a[36:39], a[252:255], a[76:79]
    buffer_load_dwordx4 v40, s[12:15], s61 offen offset:2048 lds
    ds_read_b64_tr_b16 a[12:13], v45 offset:0
    v_mfma_f32_16x16x32_bf16 v[208:211], a[40:43], a[240:243], v[208:211]
    v_mfma_f32_16x16x32_bf16 v[212:215], a[40:43], a[244:247], v[212:215]
    ds_read_b64_tr_b16 a[14:15], v45 offset:1024
    v_mfma_f32_16x16x32_bf16 a[80:83], a[40:43], a[248:251], a[80:83]
    buffer_load_dwordx4 v41, s[12:15], s61 offen offset:3072 lds
    ds_read_b64_tr_b16 a[16:17], v46 offset:0
    v_mfma_f32_16x16x32_bf16 a[84:87], a[40:43], a[252:255], a[84:87]
    ds_read_b64_tr_b16 a[18:19], v46 offset:1024
    v_mfma_f32_16x16x32_bf16 v[216:219], a[44:47], a[240:243], v[216:219]
    s_add_u32 s61, s61, 0x80000
    v_mfma_f32_16x16x32_bf16 v[220:223], a[44:47], a[244:247], v[220:223]
    buffer_load_dwordx4 a[160:163], v36, s[8:11], s62 offen sc1
    ds_read_b64_tr_b16 a[20:21], v47 offset:0
    v_mfma_f32_16x16x32_bf16 a[88:91], a[44:47], a[248:251], a[88:91]
    ds_read_b64_tr_b16 a[22:23], v47 offset:1024
    v_mfma_f32_16x16x32_bf16 a[92:95], a[44:47], a[252:255], a[92:95]
    buffer_load_dwordx4 a[164:167], v54, s[8:11], s62 offen sc1
    ds_read_b64_tr_b16 a[24:25], v48 offset:0
    v_mfma_f32_16x16x32_bf16 v[224:227], a[48:51], a[240:243], v[224:227]
    v_mfma_f32_16x16x32_bf16 v[228:231], a[48:51], a[244:247], v[228:231]
    ds_read_b64_tr_b16 a[26:27], v48 offset:1024
    v_mfma_f32_16x16x32_bf16 a[96:99], a[48:51], a[248:251], a[96:99]
    buffer_load_dwordx4 a[168:171], v37, s[8:11], s62 offen sc1
    ds_read_b64_tr_b16 a[28:29], v49 offset:0
    v_mfma_f32_16x16x32_bf16 a[100:103], a[48:51], a[252:255], a[100:103]
    v_mfma_f32_16x16x32_bf16 v[232:235], a[52:55], a[240:243], v[232:235]
    ds_read_b64_tr_b16 a[30:31], v49 offset:1024
    v_mfma_f32_16x16x32_bf16 v[236:239], a[52:55], a[244:247], v[236:239]
    buffer_load_dwordx4 a[172:175], v55, s[8:11], s62 offen sc1
    v_mfma_f32_16x16x32_bf16 a[104:107], a[52:55], a[248:251], a[104:107]
    v_mfma_f32_16x16x32_bf16 a[108:111], a[52:55], a[252:255], a[108:111]
    s_add_u32 s62, s62, 0x20000
    v_mfma_f32_16x16x32_bf16 v[240:243], a[56:59], a[240:243], v[240:243]
    s_add_u32 s52, s47, 536576
    v_mfma_f32_16x16x32_bf16 v[244:247], a[56:59], a[244:247], v[244:247]
    buffer_store_dwordx4 v[184:187], v1, s[48:51], s52 offen offset:2048 sc1
    v_mfma_f32_16x16x32_bf16 a[112:115], a[56:59], a[248:251], a[112:115]
    v_mfma_f32_16x16x32_bf16 a[116:119], a[56:59], a[252:255], a[116:119]
    v_mfma_f32_16x16x32_bf16 v[248:251], a[60:63], a[240:243], v[248:251]
    v_mfma_f32_16x16x32_bf16 v[252:255], a[60:63], a[244:247], v[252:255]
    v_mfma_f32_16x16x32_bf16 a[120:123], a[60:63], a[248:251], a[120:123]
    v_mfma_f32_16x16x32_bf16 a[124:127], a[60:63], a[252:255], a[124:127]
    s_waitcnt vmcnt(15) lgkmcnt(0)
    v_mfma_f32_16x16x32_bf16 v[192:195], a[0:3], a[128:131], v[192:195]
    ds_read_b64_tr_b16 a[32:33], v42 offset:8192
    ds_read_b64_tr_b16 a[34:35], v42 offset:9216
    v_mfma_f32_16x16x32_bf16 v[196:199], a[0:3], a[132:135], v[196:199]
    buffer_load_dwordx4 a[176:179], v36, s[8:11], s62 offen sc1
    v_mfma_f32_16x16x32_bf16 a[64:67], a[0:3], a[136:139], a[64:67]
    ds_read_b64_tr_b16 a[36:37], v43 offset:8192
    v_mfma_f32_16x16x32_bf16 a[68:71], a[0:3], a[140:143], a[68:71]
    ds_read_b64_tr_b16 a[38:39], v43 offset:9216
    v_mfma_f32_16x16x32_bf16 v[200:203], a[4:7], a[128:131], v[200:203]
    ds_read_b64_tr_b16 a[40:41], v44 offset:8192
    v_mfma_f32_16x16x32_bf16 v[204:207], a[4:7], a[132:135], v[204:207]
    v_mfma_f32_16x16x32_bf16 a[72:75], a[4:7], a[136:139], a[72:75]
    buffer_load_dwordx4 a[180:183], v54, s[8:11], s62 offen sc1
    ds_read_b64_tr_b16 a[42:43], v44 offset:9216
    v_mfma_f32_16x16x32_bf16 a[76:79], a[4:7], a[140:143], a[76:79]
    ds_read_b64_tr_b16 a[44:45], v45 offset:8192
    v_mfma_f32_16x16x32_bf16 v[208:211], a[8:11], a[128:131], v[208:211]
    v_mfma_f32_16x16x32_bf16 v[212:215], a[8:11], a[132:135], v[212:215]
    ds_read_b64_tr_b16 a[46:47], v45 offset:9216
    v_mfma_f32_16x16x32_bf16 a[80:83], a[8:11], a[136:139], a[80:83]
    ds_read_b64_tr_b16 a[48:49], v46 offset:8192
    v_mfma_f32_16x16x32_bf16 a[84:87], a[8:11], a[140:143], a[84:87]
    buffer_load_dwordx4 a[184:187], v37, s[8:11], s62 offen sc1
    ds_read_b64_tr_b16 a[50:51], v46 offset:9216
    v_mfma_f32_16x16x32_bf16 v[216:219], a[12:15], a[128:131], v[216:219]
    v_mfma_f32_16x16x32_bf16 v[220:223], a[12:15], a[132:135], v[220:223]
    ds_read_b64_tr_b16 a[52:53], v47 offset:8192
    v_mfma_f32_16x16x32_bf16 a[88:91], a[12:15], a[136:139], a[88:91]
    ds_read_b64_tr_b16 a[54:55], v47 offset:9216
    v_mfma_f32_16x16x32_bf16 a[92:95], a[12:15], a[140:143], a[92:95]
    ds_read_b64_tr_b16 a[56:57], v48 offset:8192
    v_mfma_f32_16x16x32_bf16 v[224:227], a[16:19], a[128:131], v[224:227]
    v_mfma_f32_16x16x32_bf16 v[228:231], a[16:19], a[132:135], v[228:231]
    buffer_load_dwordx4 a[188:191], v55, s[8:11], s62 offen sc1
    ds_read_b64_tr_b16 a[58:59], v48 offset:9216
    v_mfma_f32_16x16x32_bf16 a[96:99], a[16:19], a[136:139], a[96:99]
    ds_read_b64_tr_b16 a[60:61], v49 offset:8192
    v_mfma_f32_16x16x32_bf16 a[100:103], a[16:19], a[140:143], a[100:103]
    v_mfma_f32_16x16x32_bf16 v[232:235], a[20:23], a[128:131], v[232:235]
    ds_read_b64_tr_b16 a[62:63], v49 offset:9216
    v_mfma_f32_16x16x32_bf16 v[236:239], a[20:23], a[132:135], v[236:239]
    s_add_u32 s62, s62, 0x20000
    v_mfma_f32_16x16x32_bf16 a[104:107], a[20:23], a[136:139], a[104:107]
    s_add_u32 s52, s47, 536576
    v_mfma_f32_16x16x32_bf16 a[108:111], a[20:23], a[140:143], a[108:111]
    buffer_store_dwordx4 v[188:191], v1, s[48:51], s52 offen offset:3072 sc1
    v_mfma_f32_16x16x32_bf16 v[240:243], a[24:27], a[128:131], v[240:243]
    v_mfma_f32_16x16x32_bf16 v[244:247], a[24:27], a[132:135], v[244:247]
    v_mfma_f32_16x16x32_bf16 a[112:115], a[24:27], a[136:139], a[112:115]
    v_mfma_f32_16x16x32_bf16 a[116:119], a[24:27], a[140:143], a[116:119]
    v_mfma_f32_16x16x32_bf16 v[248:251], a[28:31], a[128:131], v[248:251]
    s_cmp_eq_u32 s30, 0
    s_cbranch_scc1 k12_ool_72
k12_oolret_73:
    v_mfma_f32_16x16x32_bf16 v[252:255], a[28:31], a[132:135], v[252:255]
    v_mfma_f32_16x16x32_bf16 a[120:123], a[28:31], a[136:139], a[120:123]
    v_mfma_f32_16x16x32_bf16 a[124:127], a[28:31], a[140:143], a[124:127]
    s_waitcnt vmcnt(10) lgkmcnt(0)
    s_barrier
    v_mfma_f32_16x16x32_bf16 v[192:195], a[32:35], a[144:147], v[192:195]
    ds_read_b64_tr_b16 a[0:1], v42 offset:16384
    ds_read_b64_tr_b16 a[2:3], v42 offset:17408
    v_mfma_f32_16x16x32_bf16 v[196:199], a[32:35], a[148:151], v[196:199]
    s_mov_b32 m0, s34
    v_mfma_f32_16x16x32_bf16 a[64:67], a[32:35], a[152:155], a[64:67]
    buffer_load_dwordx4 v1, s[16:19], s32 offen offset:0 sc1 lds
    ds_read_b64_tr_b16 a[4:5], v43 offset:16384
    v_mfma_f32_16x16x32_bf16 a[68:71], a[32:35], a[156:159], a[68:71]
    ds_read_b64_tr_b16 a[6:7], v43 offset:17408
    v_mfma_f32_16x16x32_bf16 v[200:203], a[36:39], a[144:147], v[200:203]
    buffer_load_dwordx4 v1, s[16:19], s32 offen offset:1024 sc1 lds
    ds_read_b64_tr_b16 a[8:9], v44 offset:16384
    v_mfma_f32_16x16x32_bf16 v[204:207], a[36:39], a[148:151], v[204:207]
    v_mfma_f32_16x16x32_bf16 a[72:75], a[36:39], a[152:155], a[72:75]
    ds_read_b64_tr_b16 a[10:11], v44 offset:17408
    v_mfma_f32_16x16x32_bf16 a[76:79], a[36:39], a[156:159], a[76:79]
    buffer_load_dwordx4 v1, s[16:19], s32 offen offset:2048 sc1 lds
    ds_read_b64_tr_b16 a[12:13], v45 offset:16384
    v_mfma_f32_16x16x32_bf16 v[208:211], a[40:43], a[144:147], v[208:211]
    v_mfma_f32_16x16x32_bf16 v[212:215], a[40:43], a[148:151], v[212:215]
    ds_read_b64_tr_b16 a[14:15], v45 offset:17408
    v_mfma_f32_16x16x32_bf16 a[80:83], a[40:43], a[152:155], a[80:83]
    ds_read_b64_tr_b16 a[16:17], v46 offset:16384
    v_mfma_f32_16x16x32_bf16 a[84:87], a[40:43], a[156:159], a[84:87]
    buffer_load_dwordx4 v1, s[16:19], s32 offen offset:3072 sc1 lds
    ds_read_b64_tr_b16 a[18:19], v46 offset:17408
    v_mfma_f32_16x16x32_bf16 v[216:219], a[44:47], a[144:147], v[216:219]
    v_mfma_f32_16x16x32_bf16 v[220:223], a[44:47], a[148:151], v[220:223]
    s_add_u32 s32, s32, 0x80000
    ds_read_b64_tr_b16 a[20:21], v47 offset:16384
    v_mfma_f32_16x16x32_bf16 a[88:91], a[44:47], a[152:155], a[88:91]
    s_add_u32 s34, s34, 0x4000
    ds_read_b64_tr_b16 a[22:23], v47 offset:17408
    s_mov_b32 m0, s34
    v_mfma_f32_16x16x32_bf16 a[92:95], a[44:47], a[156:159], a[92:95]
    buffer_load_dwordx4 v1, s[16:19], s32 offen offset:0 sc1 lds
    ds_read_b64_tr_b16 a[24:25], v48 offset:16384
    v_mfma_f32_16x16x32_bf16 v[224:227], a[48:51], a[144:147], v[224:227]
    v_mfma_f32_16x16x32_bf16 v[228:231], a[48:51], a[148:151], v[228:231]
    buffer_load_dwordx4 v1, s[16:19], s32 offen offset:1024 sc1 lds
    ds_read_b64_tr_b16 a[26:27], v48 offset:17408
    v_mfma_f32_16x16x32_bf16 a[96:99], a[48:51], a[152:155], a[96:99]
    ds_read_b64_tr_b16 a[28:29], v49 offset:16384
    v_mfma_f32_16x16x32_bf16 a[100:103], a[48:51], a[156:159], a[100:103]
    v_mfma_f32_16x16x32_bf16 v[232:235], a[52:55], a[144:147], v[232:235]
    buffer_load_dwordx4 v1, s[16:19], s32 offen offset:2048 sc1 lds
    ds_read_b64_tr_b16 a[30:31], v49 offset:17408
    v_mfma_f32_16x16x32_bf16 v[236:239], a[52:55], a[148:151], v[236:239]
    v_mfma_f32_16x16x32_bf16 a[104:107], a[52:55], a[152:155], a[104:107]
    v_mfma_f32_16x16x32_bf16 a[108:111], a[52:55], a[156:159], a[108:111]
    v_mfma_f32_16x16x32_bf16 v[240:243], a[56:59], a[144:147], v[240:243]
    buffer_load_dwordx4 v1, s[16:19], s32 offen offset:3072 sc1 lds
    v_mfma_f32_16x16x32_bf16 v[244:247], a[56:59], a[148:151], v[244:247]
    v_mfma_f32_16x16x32_bf16 a[112:115], a[56:59], a[152:155], a[112:115]
    s_add_u32 s32, s32, 0x80000
    v_mfma_f32_16x16x32_bf16 a[116:119], a[56:59], a[156:159], a[116:119]
    s_add_u32 s34, s34, 0x4000
    v_mfma_f32_16x16x32_bf16 v[248:251], a[60:63], a[144:147], v[248:251]
    v_mfma_f32_16x16x32_bf16 v[252:255], a[60:63], a[148:151], v[252:255]
    v_mfma_f32_16x16x32_bf16 a[120:123], a[60:63], a[152:155], a[120:123]
    v_mfma_f32_16x16x32_bf16 a[124:127], a[60:63], a[156:159], a[124:127]
    s_waitcnt vmcnt(14) lgkmcnt(0)
    v_mfma_f32_16x16x32_bf16 v[192:195], a[0:3], a[160:163], v[192:195]
    ds_read_b64_tr_b16 a[32:33], v42 offset:24576
    ds_read_b64_tr_b16 a[34:35], v42 offset:25600
    v_mfma_f32_16x16x32_bf16 v[196:199], a[0:3], a[164:167], v[196:199]
    s_mov_b32 m0, s35
    v_mfma_f32_16x16x32_bf16 a[64:67], a[0:3], a[168:171], a[64:67]
    buffer_load_dwordx4 v1, s[20:23], s33 offen offset:0 sc1 lds
    ds_read_b64_tr_b16 a[36:37], v43 offset:24576
    v_mfma_f32_16x16x32_bf16 a[68:71], a[0:3], a[172:175], a[68:71]
    ds_read_b64_tr_b16 a[38:39], v43 offset:25600
    v_mfma_f32_16x16x32_bf16 v[200:203], a[4:7], a[160:163], v[200:203]
    buffer_load_dwordx4 v1, s[20:23], s33 offen offset:1024 sc1 lds
    ds_read_b64_tr_b16 a[40:41], v44 offset:24576
    v_mfma_f32_16x16x32_bf16 v[204:207], a[4:7], a[164:167], v[204:207]
    v_mfma_f32_16x16x32_bf16 a[72:75], a[4:7], a[168:171], a[72:75]
    ds_read_b64_tr_b16 a[42:43], v44 offset:25600
    v_mfma_f32_16x16x32_bf16 a[76:79], a[4:7], a[172:175], a[76:79]
    buffer_load_dwordx4 v1, s[20:23], s33 offen offset:2048 sc1 lds
    ds_read_b64_tr_b16 a[44:45], v45 offset:24576
    v_mfma_f32_16x16x32_bf16 v[208:211], a[8:11], a[160:163], v[208:211]
    v_mfma_f32_16x16x32_bf16 v[212:215], a[8:11], a[164:167], v[212:215]
    ds_read_b64_tr_b16 a[46:47], v45 offset:25600
    v_mfma_f32_16x16x32_bf16 a[80:83], a[8:11], a[168:171], a[80:83]
    ds_read_b64_tr_b16 a[48:49], v46 offset:24576
    v_mfma_f32_16x16x32_bf16 a[84:87], a[8:11], a[172:175], a[84:87]
    buffer_load_dwordx4 v1, s[20:23], s33 offen offset:3072 sc1 lds
    ds_read_b64_tr_b16 a[50:51], v46 offset:25600
    v_mfma_f32_16x16x32_bf16 v[216:219], a[12:15], a[160:163], v[216:219]
    v_mfma_f32_16x16x32_bf16 v[220:223], a[12:15], a[164:167], v[220:223]
    s_add_u32 s33, s33, 0x80000
    ds_read_b64_tr_b16 a[52:53], v47 offset:24576
    v_mfma_f32_16x16x32_bf16 a[88:91], a[12:15], a[168:171], a[88:91]
    s_add_u32 s35, s35, 0x4000
    ds_read_b64_tr_b16 a[54:55], v47 offset:25600
    s_mov_b32 m0, s34
    v_mfma_f32_16x16x32_bf16 a[92:95], a[12:15], a[172:175], a[92:95]
    buffer_load_dwordx4 v1, s[16:19], s32 offen offset:0 sc1 lds
    ds_read_b64_tr_b16 a[56:57], v48 offset:24576
    v_mfma_f32_16x16x32_bf16 v[224:227], a[16:19], a[160:163], v[224:227]
    v_mfma_f32_16x16x32_bf16 v[228:231], a[16:19], a[164:167], v[228:231]
    buffer_load_dwordx4 v1, s[16:19], s32 offen offset:1024 sc1 lds
    ds_read_b64_tr_b16 a[58:59], v48 offset:25600
    v_mfma_f32_16x16x32_bf16 a[96:99], a[16:19], a[168:171], a[96:99]
    ds_read_b64_tr_b16 a[60:61], v49 offset:24576
    v_mfma_f32_16x16x32_bf16 a[100:103], a[16:19], a[172:175], a[100:103]
    v_mfma_f32_16x16x32_bf16 v[232:235], a[20:23], a[160:163], v[232:235]
    buffer_load_dwordx4 v1, s[16:19], s32 offen offset:2048 sc1 lds
    ds_read_b64_tr_b16 a[62:63], v49 offset:25600
    v_mfma_f32_16x16x32_bf16 v[236:239], a[20:23], a[164:167], v[236:239]
    v_mfma_f32_16x16x32_bf16 a[104:107], a[20:23], a[168:171], a[104:107]
    v_mfma_f32_16x16x32_bf16 a[108:111], a[20:23], a[172:175], a[108:111]
    v_mfma_f32_16x16x32_bf16 v[240:243], a[24:27], a[160:163], v[240:243]
    buffer_load_dwordx4 v1, s[16:19], s32 offen offset:3072 sc1 lds
    v_mfma_f32_16x16x32_bf16 v[244:247], a[24:27], a[164:167], v[244:247]
    v_mfma_f32_16x16x32_bf16 a[112:115], a[24:27], a[168:171], a[112:115]
    s_add_u32 s32, s32, 0x80000
    v_mfma_f32_16x16x32_bf16 a[116:119], a[24:27], a[172:175], a[116:119]
    s_add_u32 s34, s34, 0x4000
    v_mfma_f32_16x16x32_bf16 v[248:251], a[28:31], a[160:163], v[248:251]
    v_mfma_f32_16x16x32_bf16 v[252:255], a[28:31], a[164:167], v[252:255]
    v_mfma_f32_16x16x32_bf16 a[120:123], a[28:31], a[168:171], a[120:123]
    v_mfma_f32_16x16x32_bf16 a[124:127], a[28:31], a[172:175], a[124:127]
    s_waitcnt vmcnt(17) lgkmcnt(0)
    s_barrier
    v_mfma_f32_16x16x32_bf16 v[192:195], a[32:35], a[176:179], v[192:195]
    v_mfma_f32_16x16x32_bf16 v[196:199], a[32:35], a[180:183], v[196:199]
    s_mov_b32 m0, s35
    v_mfma_f32_16x16x32_bf16 a[64:67], a[32:35], a[184:187], a[64:67]
    buffer_load_dwordx4 v1, s[20:23], s33 offen offset:0 sc1 lds
    v_mfma_f32_16x16x32_bf16 a[68:71], a[32:35], a[188:191], a[68:71]
    v_mfma_f32_16x16x32_bf16 v[200:203], a[36:39], a[176:179], v[200:203]
    v_mfma_f32_16x16x32_bf16 v[204:207], a[36:39], a[180:183], v[204:207]
    v_mfma_f32_16x16x32_bf16 a[72:75], a[36:39], a[184:187], a[72:75]
    v_mfma_f32_16x16x32_bf16 a[76:79], a[36:39], a[188:191], a[76:79]
    buffer_load_dwordx4 v1, s[20:23], s33 offen offset:1024 sc1 lds
    v_mfma_f32_16x16x32_bf16 v[208:211], a[40:43], a[176:179], v[208:211]
    v_mfma_f32_16x16x32_bf16 v[212:215], a[40:43], a[180:183], v[212:215]
    v_mfma_f32_16x16x32_bf16 a[80:83], a[40:43], a[184:187], a[80:83]
    v_mfma_f32_16x16x32_bf16 a[84:87], a[40:43], a[188:191], a[84:87]
    v_mfma_f32_16x16x32_bf16 v[216:219], a[44:47], a[176:179], v[216:219]
    v_mfma_f32_16x16x32_bf16 v[220:223], a[44:47], a[180:183], v[220:223]
    v_mfma_f32_16x16x32_bf16 a[88:91], a[44:47], a[184:187], a[88:91]
    buffer_load_dwordx4 v1, s[20:23], s33 offen offset:2048 sc1 lds
    v_mfma_f32_16x16x32_bf16 a[92:95], a[44:47], a[188:191], a[92:95]
    v_mfma_f32_16x16x32_bf16 v[224:227], a[48:51], a[176:179], v[224:227]
    v_mfma_f32_16x16x32_bf16 v[228:231], a[48:51], a[180:183], v[228:231]
    v_mfma_f32_16x16x32_bf16 a[96:99], a[48:51], a[184:187], a[96:99]
    v_mfma_f32_16x16x32_bf16 a[100:103], a[48:51], a[188:191], a[100:103]
    v_mfma_f32_16x16x32_bf16 v[232:235], a[52:55], a[176:179], v[232:235]
    buffer_load_dwordx4 v1, s[20:23], s33 offen offset:3072 sc1 lds
    v_mfma_f32_16x16x32_bf16 v[236:239], a[52:55], a[180:183], v[236:239]
    v_mfma_f32_16x16x32_bf16 a[104:107], a[52:55], a[184:187], a[104:107]
    v_mfma_f32_16x16x32_bf16 a[108:111], a[52:55], a[188:191], a[108:111]
    v_mfma_f32_16x16x32_bf16 v[240:243], a[56:59], a[176:179], v[240:243]
    v_mfma_f32_16x16x32_bf16 v[244:247], a[56:59], a[180:183], v[244:247]
    v_mfma_f32_16x16x32_bf16 a[112:115], a[56:59], a[184:187], a[112:115]
    s_add_u32 s33, s33, 0x80000
    v_mfma_f32_16x16x32_bf16 a[116:119], a[56:59], a[188:191], a[116:119]
    s_add_u32 s35, s35, 0x4000
    v_mfma_f32_16x16x32_bf16 v[248:251], a[60:63], a[176:179], v[248:251]
    v_mfma_f32_16x16x32_bf16 v[252:255], a[60:63], a[180:183], v[252:255]
    v_mfma_f32_16x16x32_bf16 a[120:123], a[60:63], a[184:187], a[120:123]
    v_mfma_f32_16x16x32_bf16 a[124:127], a[60:63], a[188:191], a[124:127]
    s_add_u32 s3, s54, 64
    s_add_u32 s5, s55, 64
    s_mov_b32 s63, s57
    s_load_dwordx2 s[44:45], s[0:1], 40
    s_load_dwordx2 s[46:47], s[0:1], 64
    s_load_dwordx4 s[48:51], s[0:1], 72
    s_mov_b32 s40, 0x3e0293ee
    s_mov_b32 s41, 0x3e0293ee
    s_mov_b32 m0, s34
    s_nop 0
    buffer_load_dwordx4 v1, s[16:19], s32 offen offset:0 sc1 lds
    buffer_load_dwordx4 v1, s[16:19], s32 offen offset:1024 sc1 lds
    buffer_load_dwordx4 v1, s[16:19], s32 offen offset:2048 sc1 lds
    buffer_load_dwordx4 v1, s[16:19], s32 offen offset:3072 sc1 lds
    s_mov_b32 m0, s35
    s_nop 0
    buffer_load_dwordx4 v1, s[20:23], s33 offen offset:0 sc1 lds
    buffer_load_dwordx4 v1, s[20:23], s33 offen offset:1024 sc1 lds
    buffer_load_dwordx4 v1, s[20:23], s33 offen offset:2048 sc1 lds
    buffer_load_dwordx4 v1, s[20:23], s33 offen offset:3072 sc1 lds
    s_add_u32 s32, s32, 0x80000
    s_add_u32 s33, s33, 0x80000
    s_add_u32 s34, s34, 0x4000
    s_and_b32 s34, s34, 0xffff
    s_add_u32 s35, s35, 0x4000
    s_and_b32 s35, s35, 0xffff
    s_or_b32 s35, s35, 0x10000
    v_mov_b32 v2, v1
    v_or_b32 v3, 0x10000, v1
    v_mov_b32 v56, v3
    s_mov_b32 s52, 0x4000
    s_mov_b32 s53, 0
    s_lshl_b32 s62, s28, 6
    s_mul_i32 s31, s29, s29
    s_add_u32 s62, s62, s31
    s_lshr_b32 s31, s30, 1
    s_lshl_b32 s4, s31, 23
    s_add_u32 s4, s4, 0x6000000
    s_add_u32 s8, s6, s4
    s_addc_u32 s9, s7, 0
    s_and_b32 s9, s9, 0xffff
    s_mov_b32 s10, 0
    s_mov_b32 s58, 0
    s_mov_b32 s14, 0x700000
    s_mov_b32 s59, 0x700000
    s_lshl_b32 s54, s62, 12
    s_waitcnt vmcnt(16) lgkmcnt(0)
    s_barrier
    s_cmp_eq_u32 s63, 0
    s_cbranch_scc1 k12_ool_74
k12_oolret_75:
    v_mov_b32 v59, 0
    ds_read_b128 a[128:131], v2 offset:0
    ds_read_b128 a[132:135], v2 offset:1024
    ds_read_b128 a[136:139], v2 offset:2048
    ds_read_b128 a[140:143], v2 offset:3072
    ds_read_b128 a[144:147], v2 offset:4096
    ds_read_b128 a[148:151], v2 offset:5120
    ds_read_b128 a[152:155], v2 offset:6144
    ds_read_b128 a[156:159], v2 offset:7168
    ds_read_b128 a[160:163], v2 offset:8192
    ds_read_b128 a[164:167], v2 offset:9216
    ds_read_b128 a[168:171], v2 offset:10240
    ds_read_b128 a[172:175], v2 offset:11264
    ds_read_b128 a[176:179], v2 offset:12288
    ds_read_b128 a[180:183], v2 offset:13312
    ds_read_b128 a[184:187], v2 offset:14336
    ds_read_b128 a[188:191], v2 offset:15360
    s_cmp_lt_u32 s30, 2
    s_cselect_b64 s[12:13], s[46:47], s[48:49]
    s_cselect_b64 s[60:61], s[44:45], s[50:51]
    s_cselect_b32 s55, 0x800000, s14
    s_and_b32 s13, s13, 0xffff
    v_accvgpr_read_b32 v128, a64
    v_accvgpr_read_b32 v129, a65
    v_accvgpr_read_b32 v130, a66
    v_accvgpr_read_b32 v131, a67
    v_pk_mul_f32 v[128:129], v[128:129], s[40:41]
    v_pk_mul_f32 v[130:131], v[130:131], s[40:41]
    v_cvt_pk_bf16_f32 v96, v128, v129
    v_cvt_pk_bf16_f32 v97, v130, v131
    v_accvgpr_read_b32 v132, a72
    v_accvgpr_read_b32 v133, a73
    v_accvgpr_read_b32 v134, a74
    v_accvgpr_read_b32 v135, a75
    v_pk_mul_f32 v[132:133], v[132:133], s[40:41]
    v_pk_mul_f32 v[134:135], v[134:135], s[40:41]
    v_cvt_pk_bf16_f32 v98, v132, v133
    v_cvt_pk_bf16_f32 v99, v134, v135
    v_accvgpr_read_b32 v136, a80
    v_accvgpr_read_b32 v137, a81
    v_accvgpr_read_b32 v138, a82
    v_accvgpr_read_b32 v139, a83
    v_pk_mul_f32 v[136:137], v[136:137], s[40:41]
    v_pk_mul_f32 v[138:139], v[138:139], s[40:41]
    v_cvt_pk_bf16_f32 v100, v136, v137
    v_cvt_pk_bf16_f32 v101, v138, v139
    v_accvgpr_read_b32 v140, a88
    v_accvgpr_read_b32 v141, a89
    v_accvgpr_read_b32 v142, a90
    v_accvgpr_read_b32 v143, a91
    v_pk_mul_f32 v[140:141], v[140:141], s[40:41]
    v_pk_mul_f32 v[142:143], v[142:143], s[40:41]
    v_cvt_pk_bf16_f32 v102, v140, v141
    v_cvt_pk_bf16_f32 v103, v142, v143
    v_accvgpr_read_b32 v128, a96
    v_accvgpr_read_b32 v129, a97
    v_accvgpr_read_b32 v130, a98
    v_accvgpr_read_b32 v131, a99
    v_pk_mul_f32 v[128:129], v[128:129], s[40:41]
    v_pk_mul_f32 v[130:131], v[130:131], s[40:41]
    v_cvt_pk_bf16_f32 v104, v128, v129
    v_cvt_pk_bf16_f32 v105, v130, v131
    v_accvgpr_read_b32 v132, a104
    v_accvgpr_read_b32 v133, a105
    v_accvgpr_read_b32 v134, a106
    v_accvgpr_read_b32 v135, a107
    v_pk_mul_f32 v[132:133], v[132:133], s[40:41]
    v_pk_mul_f32 v[134:135], v[134:135], s[40:41]
    v_cvt_pk_bf16_f32 v106, v132, v133
    v_cvt_pk_bf16_f32 v107, v134, v135
    v_accvgpr_read_b32 v136, a112
    v_accvgpr_read_b32 v137, a113
    v_accvgpr_read_b32 v138, a114
    v_accvgpr_read_b32 v139, a115
    v_pk_mul_f32 v[136:137], v[136:137], s[40:41]
    v_pk_mul_f32 v[138:139], v[138:139], s[40:41]
    v_cvt_pk_bf16_f32 v108, v136, v137
    v_cvt_pk_bf16_f32 v109, v138, v139
    v_accvgpr_read_b32 v140, a120
    v_accvgpr_read_b32 v141, a121
    v_accvgpr_read_b32 v142, a122
    v_accvgpr_read_b32 v143, a123
    v_pk_mul_f32 v[140:141], v[140:141], s[40:41]
    v_pk_mul_f32 v[142:143], v[142:143], s[40:41]
    v_cvt_pk_bf16_f32 v110, v140, v141
    v_cvt_pk_bf16_f32 v111, v142, v143
    v_accvgpr_read_b32 v128, a68
    v_accvgpr_read_b32 v129, a69
    v_accvgpr_read_b32 v130, a70
    v_accvgpr_read_b32 v131, a71
    v_pk_mul_f32 v[128:129], v[128:129], s[40:41]
    v_pk_mul_f32 v[130:131], v[130:131], s[40:41]
    v_cvt_pk_bf16_f32 v112, v128, v129
    v_cvt_pk_bf16_f32 v113, v130, v131
    v_accvgpr_read_b32 v132, a76
    v_accvgpr_read_b32 v133, a77
    v_accvgpr_read_b32 v134, a78
    v_accvgpr_read_b32 v135, a79
    v_pk_mul_f32 v[132:133], v[132:133], s[40:41]
    v_pk_mul_f32 v[134:135], v[134:135], s[40:41]
    v_cvt_pk_bf16_f32 v114, v132, v133
    v_cvt_pk_bf16_f32 v115, v134, v135
    v_accvgpr_read_b32 v136, a84
    v_accvgpr_read_b32 v137, a85
    v_accvgpr_read_b32 v138, a86
    v_accvgpr_read_b32 v139, a87
    v_pk_mul_f32 v[136:137], v[136:137], s[40:41]
    v_pk_mul_f32 v[138:139], v[138:139], s[40:41]
    v_cvt_pk_bf16_f32 v116, v136, v137
    v_cvt_pk_bf16_f32 v117, v138, v139
    v_accvgpr_read_b32 v140, a92
    v_accvgpr_read_b32 v141, a93
    v_accvgpr_read_b32 v142, a94
    v_accvgpr_read_b32 v143, a95
    v_pk_mul_f32 v[140:141], v[140:141], s[40:41]
    v_pk_mul_f32 v[142:143], v[142:143], s[40:41]
    v_cvt_pk_bf16_f32 v118, v140, v141
    v_cvt_pk_bf16_f32 v119, v142, v143
    v_accvgpr_read_b32 v128, a100
    v_accvgpr_read_b32 v129, a101
    v_accvgpr_read_b32 v130, a102
    v_accvgpr_read_b32 v131, a103
    v_pk_mul_f32 v[128:129], v[128:129], s[40:41]
    v_pk_mul_f32 v[130:131], v[130:131], s[40:41]
    v_cvt_pk_bf16_f32 v120, v128, v129
    v_cvt_pk_bf16_f32 v121, v130, v131
    v_accvgpr_read_b32 v132, a108
    v_accvgpr_read_b32 v133, a109
    v_accvgpr_read_b32 v134, a110
    v_accvgpr_read_b32 v135, a111
    v_pk_mul_f32 v[132:133], v[132:133], s[40:41]
    v_pk_mul_f32 v[134:135], v[134:135], s[40:41]
    v_cvt_pk_bf16_f32 v122, v132, v133
    v_cvt_pk_bf16_f32 v123, v134, v135
    v_accvgpr_read_b32 v136, a116
    v_accvgpr_read_b32 v137, a117
    v_accvgpr_read_b32 v138, a118
    v_accvgpr_read_b32 v139, a119
    v_pk_mul_f32 v[136:137], v[136:137], s[40:41]
    v_pk_mul_f32 v[138:139], v[138:139], s[40:41]
    v_cvt_pk_bf16_f32 v124, v136, v137
    v_cvt_pk_bf16_f32 v125, v138, v139
    v_accvgpr_read_b32 v140, a124
    v_accvgpr_read_b32 v141, a125
    v_accvgpr_read_b32 v142, a126
    v_accvgpr_read_b32 v143, a127
    v_pk_mul_f32 v[140:141], v[140:141], s[40:41]
    v_pk_mul_f32 v[142:143], v[142:143], s[40:41]
    v_cvt_pk_bf16_f32 v126, v140, v141
    v_cvt_pk_bf16_f32 v127, v142, v143
    v_pk_mul_f32 v[192:193], v[192:193], s[40:41]
    v_pk_mul_f32 v[194:195], v[194:195], s[40:41]
    v_cvt_pk_bf16_f32 v64, v192, v193
    v_cvt_pk_bf16_f32 v65, v194, v195
    v_pk_mul_f32 v[200:201], v[200:201], s[40:41]
    v_pk_mul_f32 v[202:203], v[202:203], s[40:41]
    v_cvt_pk_bf16_f32 v66, v200, v201
    v_cvt_pk_bf16_f32 v67, v202, v203
    v_pk_mul_f32 v[208:209], v[208:209], s[40:41]
    v_pk_mul_f32 v[210:211], v[210:211], s[40:41]
    v_cvt_pk_bf16_f32 v68, v208, v209
    v_cvt_pk_bf16_f32 v69, v210, v211
    v_pk_mul_f32 v[216:217], v[216:217], s[40:41]
    v_pk_mul_f32 v[218:219], v[218:219], s[40:41]
    v_cvt_pk_bf16_f32 v70, v216, v217
    v_cvt_pk_bf16_f32 v71, v218, v219
    v_pk_mul_f32 v[224:225], v[224:225], s[40:41]
    v_pk_mul_f32 v[226:227], v[226:227], s[40:41]
    v_cvt_pk_bf16_f32 v72, v224, v225
    v_cvt_pk_bf16_f32 v73, v226, v227
    v_pk_mul_f32 v[232:233], v[232:233], s[40:41]
    v_pk_mul_f32 v[234:235], v[234:235], s[40:41]
    v_cvt_pk_bf16_f32 v74, v232, v233
    v_cvt_pk_bf16_f32 v75, v234, v235
    v_pk_mul_f32 v[240:241], v[240:241], s[40:41]
    v_pk_mul_f32 v[242:243], v[242:243], s[40:41]
    v_cvt_pk_bf16_f32 v76, v240, v241
    v_cvt_pk_bf16_f32 v77, v242, v243
    v_pk_mul_f32 v[248:249], v[248:249], s[40:41]
    v_pk_mul_f32 v[250:251], v[250:251], s[40:41]
    v_cvt_pk_bf16_f32 v78, v248, v249
    v_cvt_pk_bf16_f32 v79, v250, v251
    v_pk_mul_f32 v[196:197], v[196:197], s[40:41]
    v_pk_mul_f32 v[198:199], v[198:199], s[40:41]
    v_cvt_pk_bf16_f32 v80, v196, v197
    v_cvt_pk_bf16_f32 v81, v198, v199
    v_pk_mul_f32 v[204:205], v[204:205], s[40:41]
    v_pk_mul_f32 v[206:207], v[206:207], s[40:41]
    v_cvt_pk_bf16_f32 v82, v204, v205
    v_cvt_pk_bf16_f32 v83, v206, v207
    v_pk_mul_f32 v[212:213], v[212:213], s[40:41]
    v_pk_mul_f32 v[214:215], v[214:215], s[40:41]
    v_cvt_pk_bf16_f32 v84, v212, v213
    v_cvt_pk_bf16_f32 v85, v214, v215
    v_pk_mul_f32 v[220:221], v[220:221], s[40:41]
    v_pk_mul_f32 v[222:223], v[222:223], s[40:41]
    v_cvt_pk_bf16_f32 v86, v220, v221
    v_cvt_pk_bf16_f32 v87, v222, v223
    v_pk_mul_f32 v[228:229], v[228:229], s[40:41]
    v_pk_mul_f32 v[230:231], v[230:231], s[40:41]
    v_cvt_pk_bf16_f32 v88, v228, v229
    v_cvt_pk_bf16_f32 v89, v230, v231
    v_pk_mul_f32 v[236:237], v[236:237], s[40:41]
    v_pk_mul_f32 v[238:239], v[238:239], s[40:41]
    v_cvt_pk_bf16_f32 v90, v236, v237
    v_cvt_pk_bf16_f32 v91, v238, v239
    v_pk_mul_f32 v[244:245], v[244:245], s[40:41]
    v_pk_mul_f32 v[246:247], v[246:247], s[40:41]
    v_cvt_pk_bf16_f32 v92, v244, v245
    v_cvt_pk_bf16_f32 v93, v246, v247
    v_pk_mul_f32 v[252:253], v[252:253], s[40:41]
    v_pk_mul_f32 v[254:255], v[254:255], s[40:41]
    v_cvt_pk_bf16_f32 v94, v252, v253
    v_cvt_pk_bf16_f32 v95, v254, v255
    v_add_u32 v2, 0x4000, v1
    v_mov_b32 v8, 0
    v_mov_b32 v232, 0
    v_mov_b32 v9, 0
    v_mov_b32 v233, 0
    v_mov_b32 v10, 0
    v_mov_b32 v234, 0
    v_mov_b32 v11, 0
    v_mov_b32 v235, 0
    s_mov_b32 s36, 0
    s_mov_b32 s37, 0x40004000
    v_mfma_f32_32x32x16_bf16 v[16:31], v[232:235], v[232:235], 0
    v_mfma_f32_32x32x16_bf16 v[32:47], v[232:235], v[232:235], 0
    v_and_b32 v6, 0xf0, v1
    v_cmp_eq_u32 vcc, 0, v6
    v_mov_b32 v6, 0x3f803f80
    v_lshrrev_b32 v229, 7, v1
    s_and_b32 s4, s30, 1
    s_lshl_b32 s31, s4, 11
    v_lshl_add_u32 v230, v1, 1, s31
    v_lshl_add_u32 v229, s4, 4, v229
    v_mul_u32_u24 v228, 7168, v229
    v_and_b32 v7, 0x70, v1
    v_add_u32 v228, v228, v7
    v_lshlrev_b32 v229, 5, v229
    v_and_b32 v57, 0x10, v1
    v_add_u32 v229, v229, v57
    v_lshrrev_b32 v7, 5, v7
    v_lshl_add_u32 v229, v7, 15, v229
    v_cndmask_b32 v60, 0, v6, vcc
    v_cndmask_b32 v61, 0, v6, vcc
    v_cndmask_b32 v62, 0, v6, vcc
    v_cndmask_b32 v63, 0, v6, vcc
    v_mov_b32 v12, 0
    v_mov_b32 v13, 0
    v_mov_b32 v14, 0
    v_mov_b32 v15, 0
    v_mov_b32 v48, 0
    v_mov_b32 v49, 0
    v_mov_b32 v50, 0
    v_mov_b32 v51, 0
    v_mov_b32 v248, 0
    v_mov_b32 v249, 0
    v_mov_b32 v250, 0
    v_mov_b32 v251, 0
    v_mov_b32 v252, 0
    v_mov_b32 v253, 0
    v_mov_b32 v254, 0
    v_mov_b32 v255, 0
    s_waitcnt lgkmcnt(0)
    s_cmp_ge_u32 s36, s42
    s_cbranch_scc1 k2_prep_76
k2_prepret_77:
    v_mfma_f32_16x16x32_bf16 v[128:131], a[128:131], v[64:67], v[16:19]
    v_mfma_f32_16x16x32_bf16 v[128:131], a[132:135], v[68:71], v[128:131]
    v_mfma_f32_16x16x32_bf16 v[128:131], a[136:139], v[72:75], v[128:131]
    v_mfma_f32_16x16x32_bf16 v[128:131], a[140:143], v[76:79], v[128:131]
    s_add_u32 s36, s36, 32
    v_mfma_f32_16x16x32_bf16 v[132:135], a[128:131], v[80:83], v[20:23]
    v_mfma_f32_16x16x32_bf16 v[132:135], a[132:135], v[84:87], v[132:135]
    v_mfma_f32_16x16x32_bf16 v[132:135], a[136:139], v[88:91], v[132:135]
    v_mfma_f32_16x16x32_bf16 v[132:135], a[140:143], v[92:95], v[132:135]
    v_mfma_f32_16x16x32_bf16 v[136:139], a[128:131], v[96:99], v[24:27]
    v_mfma_f32_16x16x32_bf16 v[136:139], a[132:135], v[100:103], v[136:139]
    v_mfma_f32_16x16x32_bf16 v[136:139], a[136:139], v[104:107], v[136:139]
    v_mfma_f32_16x16x32_bf16 v[136:139], a[140:143], v[108:111], v[136:139]
    v_mfma_f32_16x16x32_bf16 v[140:143], a[128:131], v[112:115], v[28:31]
    v_mfma_f32_16x16x32_bf16 v[140:143], a[132:135], v[116:119], v[140:143]
    v_mfma_f32_16x16x32_bf16 v[140:143], a[136:139], v[120:123], v[140:143]
    v_mfma_f32_16x16x32_bf16 v[140:143], a[140:143], v[124:127], v[140:143]
    v_mfma_f32_16x16x32_bf16 v[144:147], a[144:147], v[64:67], v[32:35]
    v_mfma_f32_16x16x32_bf16 v[144:147], a[148:151], v[68:71], v[144:147]
    v_mfma_f32_16x16x32_bf16 v[144:147], a[152:155], v[72:75], v[144:147]
    v_mfma_f32_16x16x32_bf16 v[144:147], a[156:159], v[76:79], v[144:147]
    v_mfma_f32_16x16x32_bf16 v[148:151], a[144:147], v[80:83], v[36:39]
    v_mfma_f32_16x16x32_bf16 v[148:151], a[148:151], v[84:87], v[148:151]
    v_mfma_f32_16x16x32_bf16 v[148:151], a[152:155], v[88:91], v[148:151]
    v_mfma_f32_16x16x32_bf16 v[148:151], a[156:159], v[92:95], v[148:151]
    v_mfma_f32_16x16x32_bf16 v[152:155], a[144:147], v[96:99], v[40:43]
    v_mfma_f32_16x16x32_bf16 v[152:155], a[148:151], v[100:103], v[152:155]
    v_mfma_f32_16x16x32_bf16 v[152:155], a[152:155], v[104:107], v[152:155]
    v_mfma_f32_16x16x32_bf16 v[152:155], a[156:159], v[108:111], v[152:155]
    v_mfma_f32_16x16x32_bf16 v[156:159], a[144:147], v[112:115], v[44:47]
    v_mfma_f32_16x16x32_bf16 v[156:159], a[148:151], v[116:119], v[156:159]
    v_mfma_f32_16x16x32_bf16 v[156:159], a[152:155], v[120:123], v[156:159]
    v_mfma_f32_16x16x32_bf16 v[156:159], a[156:159], v[124:127], v[156:159]
    v_mfma_f32_32x32x16_bf16 a[0:15], v[232:235], v[232:235], 0
    v_mfma_f32_32x32x16_bf16 a[16:31], v[232:235], v[232:235], 0
    v_mfma_f32_32x32x16_bf16 a[32:47], v[232:235], v[232:235], 0
    v_mfma_f32_32x32x16_bf16 a[48:63], v[232:235], v[232:235], 0
    v_mfma_f32_32x32x16_bf16 a[64:79], v[232:235], v[232:235], 0
    v_mfma_f32_32x32x16_bf16 a[80:95], v[232:235], v[232:235], 0
    v_mfma_f32_32x32x16_bf16 a[96:111], v[232:235], v[232:235], 0
    v_mfma_f32_32x32x16_bf16 a[112:127], v[232:235], v[232:235], 0
    v_max_f32 v52, v128, v129
    v_max3_f32 v52, v52, v130, v131
    v_max3_f32 v52, v52, v144, v145
    v_max3_f32 v52, v52, v146, v147
    v_max_f32 v53, v132, v133
    v_max3_f32 v53, v53, v134, v135
    v_max3_f32 v53, v53, v148, v149
    v_max3_f32 v53, v53, v150, v151
    v_max_f32 v54, v136, v137
    v_max3_f32 v54, v54, v138, v139
    v_max3_f32 v54, v54, v152, v153
    v_max3_f32 v54, v54, v154, v155
    v_max_f32 v55, v140, v141
    v_max3_f32 v55, v55, v142, v143
    v_max3_f32 v55, v55, v156, v157
    v_max3_f32 v55, v55, v158, v159
    v_mov_b32 v224, v52
    v_mov_b32 v225, v53
    v_mov_b32 v226, v54
    v_mov_b32 v227, v55
    s_nop 1
    v_permlane16_swap_b32 v52, v224
    v_permlane16_swap_b32 v53, v225
    v_permlane16_swap_b32 v54, v226
    v_permlane16_swap_b32 v55, v227
    s_nop 1
    v_max_f32 v52, v52, v224
    v_max_f32 v53, v53, v225
    v_max_f32 v54, v54, v226
    v_max_f32 v55, v55, v227
    v_mov_b32 v224, v52
    v_mov_b32 v225, v53
    v_mov_b32 v226, v54
    v_mov_b32 v227, v55
    s_nop 1
    v_permlane32_swap_b32 v52, v224
    v_permlane32_swap_b32 v53, v225
    v_permlane32_swap_b32 v54, v226
    v_permlane32_swap_b32 v55, v227
    s_nop 1
    v_max_f32 v52, v52, v224
    v_max_f32 v53, v53, v225
    v_max_f32 v54, v54, v226
    v_max_f32 v55, v55, v227
    v_add_f32 v52, 0x41400000, v52
    v_add_f32 v53, 0x41400000, v53
    v_add_f32 v54, 0x41400000, v54
    v_add_f32 v55, 0x41400000, v55
    v_sub_f32 v16, 0, v52
    v_sub_f32 v17, 0, v52
    v_sub_f32 v18, 0, v52
    v_sub_f32 v19, 0, v52
    v_sub_f32 v20, 0, v53
    v_sub_f32 v21, 0, v53
    v_sub_f32 v22, 0, v53
    v_sub_f32 v23, 0, v53
    v_sub_f32 v24, 0, v54
    v_sub_f32 v25, 0, v54
    v_sub_f32 v26, 0, v54
    v_sub_f32 v27, 0, v54
    v_sub_f32 v28, 0, v55
    v_sub_f32 v29, 0, v55
    v_sub_f32 v30, 0, v55
    v_sub_f32 v31, 0, v55
    v_sub_f32 v32, 0, v52
    v_sub_f32 v33, 0, v52
    v_sub_f32 v34, 0, v52
    v_sub_f32 v35, 0, v52
    v_sub_f32 v36, 0, v53
    v_sub_f32 v37, 0, v53
    v_sub_f32 v38, 0, v53
    v_sub_f32 v39, 0, v53
    v_sub_f32 v40, 0, v54
    v_sub_f32 v41, 0, v54
    v_sub_f32 v42, 0, v54
    v_sub_f32 v43, 0, v54
    v_sub_f32 v44, 0, v55
    v_sub_f32 v45, 0, v55
    v_sub_f32 v46, 0, v55
    v_sub_f32 v47, 0, v55
    v_sub_f32 v8, 0, v52
    v_sub_f32 v9, 0, v53
    v_sub_f32 v10, 0, v54
    v_sub_f32 v11, 0, v55
    s_cmp_ge_u32 s36, s42
    s_cbranch_scc1 k2_prep_84
k2_prepret_85:
    v_mfma_f32_16x16x32_bf16 v[160:163], a[160:163], v[64:67], v[16:19]
    v_sub_f32 v128, v128, v52
    v_sub_f32 v129, v129, v52
    v_sub_f32 v130, v130, v52
    v_mfma_f32_16x16x32_bf16 v[160:163], a[164:167], v[68:71], v[160:163]
    v_exp_f32 v232, v128
    v_sub_f32 v131, v131, v52
    v_mfma_f32_16x16x32_bf16 v[160:163], a[168:171], v[72:75], v[160:163]
    v_exp_f32 v233, v129
    v_sub_f32 v144, v144, v52
    v_mfma_f32_16x16x32_bf16 v[160:163], a[172:175], v[76:79], v[160:163]
    s_add_u32 s36, s36, 32
    s_cmp_eq_u32 s30, 0
    s_cbranch_scc1 k12_ool_78
k12_oolret_79:
    v_sub_f32 v145, v145, v52
    v_mfma_f32_16x16x32_bf16 v[164:167], a[160:163], v[80:83], v[20:23]
    v_exp_f32 v234, v130
    v_cvt_pk_bf16_f32 v192, v232, v233
    v_mfma_f32_16x16x32_bf16 v[164:167], a[164:167], v[84:87], v[164:167]
    v_exp_f32 v235, v131
    v_sub_f32 v146, v146, v52
    v_mfma_f32_16x16x32_bf16 v[164:167], a[168:171], v[88:91], v[164:167]
    v_exp_f32 v236, v144
    v_sub_f32 v147, v147, v52
    v_mfma_f32_16x16x32_bf16 v[164:167], a[172:175], v[92:95], v[164:167]
    v_cvt_pk_bf16_f32 v193, v234, v235
    v_exp_f32 v237, v145
    v_mfma_f32_16x16x32_bf16 v[168:171], a[160:163], v[96:99], v[24:27]
    v_exp_f32 v238, v146
    v_sub_f32 v132, v132, v53
    v_mfma_f32_16x16x32_bf16 v[168:171], a[164:167], v[100:103], v[168:171]
    v_sub_f32 v133, v133, v53
    v_cvt_pk_bf16_f32 v194, v236, v237
    v_or3_b32 v57, v192, v193, v194
    v_mfma_f32_16x16x32_bf16 v[168:171], a[168:171], v[104:107], v[168:171]
    v_exp_f32 v239, v147
    v_sub_f32 v134, v134, v53
    v_mfma_f32_16x16x32_bf16 v[168:171], a[172:175], v[108:111], v[168:171]
    v_exp_f32 v240, v132
    v_sub_f32 v135, v135, v53
    v_mfma_f32_16x16x32_bf16 v[172:175], a[160:163], v[112:115], v[28:31]
    v_cvt_pk_bf16_f32 v195, v238, v239
    v_exp_f32 v241, v133
    v_mfma_f32_16x16x32_bf16 v[172:175], a[164:167], v[116:119], v[172:175]
    v_exp_f32 v242, v134
    v_sub_f32 v148, v148, v53
    v_mfma_f32_16x16x32_bf16 v[172:175], a[168:171], v[120:123], v[172:175]
    v_sub_f32 v149, v149, v53
    v_cvt_pk_bf16_f32 v196, v240, v241
    v_exp_f32 v243, v135
    v_mfma_f32_16x16x32_bf16 v[172:175], a[172:175], v[124:127], v[172:175]
    v_or3_b32 v57, v57, v195, v196
    v_exp_f32 v244, v148
    v_mfma_f32_16x16x32_bf16 v[176:179], a[176:179], v[64:67], v[32:35]
    v_sub_f32 v150, v150, v53
    v_sub_f32 v151, v151, v53
    v_cvt_pk_bf16_f32 v197, v242, v243
    v_mfma_f32_16x16x32_bf16 v[176:179], a[180:183], v[68:71], v[176:179]
    v_exp_f32 v245, v149
    v_exp_f32 v246, v150
    v_mfma_f32_16x16x32_bf16 v[176:179], a[184:187], v[72:75], v[176:179]
    v_sub_f32 v136, v136, v54
    v_sub_f32 v137, v137, v54
    v_cvt_pk_bf16_f32 v198, v244, v245
    v_mfma_f32_16x16x32_bf16 v[176:179], a[188:191], v[76:79], v[176:179]
    v_exp_f32 v247, v151
    v_or3_b32 v57, v57, v197, v198
    v_mfma_f32_16x16x32_bf16 v[180:183], a[176:179], v[80:83], v[36:39]
    v_exp_f32 v232, v136
    v_sub_f32 v138, v138, v54
    v_mfma_f32_16x16x32_bf16 v[180:183], a[180:183], v[84:87], v[180:183]
    ds_read_b128 a[192:195], v3 offset:0
    v_sub_f32 v139, v139, v54
    v_cvt_pk_bf16_f32 v199, v246, v247
    v_mfma_f32_16x16x32_bf16 v[180:183], a[184:187], v[88:91], v[180:183]
    v_exp_f32 v233, v137
    v_exp_f32 v234, v138
    v_mfma_f32_16x16x32_bf16 v[180:183], a[188:191], v[92:95], v[180:183]
    v_sub_f32 v152, v152, v54
    v_sub_f32 v153, v153, v54
    v_cvt_pk_bf16_f32 v200, v232, v233
    v_mfma_f32_16x16x32_bf16 v[184:187], a[176:179], v[96:99], v[40:43]
    v_exp_f32 v235, v139
    v_or3_b32 v57, v57, v199, v200
    v_mfma_f32_16x16x32_bf16 v[184:187], a[180:183], v[100:103], v[184:187]
    v_exp_f32 v236, v152
    v_sub_f32 v154, v154, v54
    v_mfma_f32_16x16x32_bf16 v[184:187], a[184:187], v[104:107], v[184:187]
    v_sub_f32 v155, v155, v54
    v_cvt_pk_bf16_f32 v201, v234, v235
    v_exp_f32 v237, v153
    v_mfma_f32_16x16x32_bf16 v[184:187], a[188:191], v[108:111], v[184:187]
    ds_read_b128 a[196:199], v3 offset:1024
    v_exp_f32 v238, v154
    v_mfma_f32_16x16x32_bf16 v[188:191], a[176:179], v[112:115], v[44:47]
    v_sub_f32 v140, v140, v55
    v_sub_f32 v141, v141, v55
    v_cvt_pk_bf16_f32 v202, v236, v237
    v_mfma_f32_16x16x32_bf16 v[188:191], a[180:183], v[116:119], v[188:191]
    v_exp_f32 v239, v155
    v_or3_b32 v57, v57, v201, v202
    v_mfma_f32_16x16x32_bf16 v[188:191], a[184:187], v[120:123], v[188:191]
    s_cmp_eq_u32 s30, 0
    s_cbranch_scc1 k12_ool_82
k12_oolret_83:
    v_exp_f32 v240, v140
    v_mfma_f32_16x16x32_bf16 v[188:191], a[188:191], v[124:127], v[188:191]
    s_waitcnt vmcnt(8)
    s_barrier
    v_sub_f32 v142, v142, v55
    v_sub_f32 v143, v143, v55
    v_cvt_pk_bf16_f32 v203, v238, v239
    v_exp_f32 v241, v141
    v_exp_f32 v242, v142
    v_sub_f32 v156, v156, v55
    v_sub_f32 v157, v157, v55
    ds_read_b128 a[200:203], v3 offset:2048
    v_cvt_pk_bf16_f32 v204, v240, v241
    v_exp_f32 v243, v143
    v_or3_b32 v57, v57, v203, v204
    v_exp_f32 v244, v156
    v_sub_f32 v158, v158, v55
    v_sub_f32 v159, v159, v55
    v_cvt_pk_bf16_f32 v205, v242, v243
    v_exp_f32 v245, v157
    v_exp_f32 v246, v158
    v_cvt_pk_bf16_f32 v206, v244, v245
    ds_read_b128 a[204:207], v3 offset:3072
    v_exp_f32 v247, v159
    v_or3_b32 v57, v57, v205, v206
    v_cvt_pk_bf16_f32 v207, v246, v247
    v_bitop3_b32 v57, v57, v207, s37 bitop3:0xa8
    v_cmp_ne_u32 vcc, 0, v57
    s_cbranch_vccnz k2_tramp_86
k2_ret_87:
    s_mov_b32 s24, s60
    s_and_b32 s25, s61, 0xffff
    s_mov_b32 s26, s55
    s_lshl_b32 s63, s29, 1
    s_sub_u32 s63, s63, 1
    s_cbranch_scc1 k2_dm3_89
k2_dloop_88:
    v_mfma_f32_16x16x32_bf16 v[12:15], v[60:63], v[192:195], v[12:15]
    v_exp_f32 v232, v160
    v_mfma_f32_16x16x32_bf16 v[48:51], v[60:63], v[196:199], v[48:51]
    s_mov_b32 m0, s34
    ds_read_b128 a[208:211], v3 offset:4096
    v_mfma_f32_16x16x32_bf16 v[248:251], v[60:63], v[200:203], v[248:251]
    s_add_u32 s53, s53, 8192
    buffer_load_dwordx4 v1, s[16:19], s32 offen offset:0 sc1 lds
    v_mfma_f32_16x16x32_bf16 v[252:255], v[60:63], v[204:207], v[252:255]
    s_waitcnt lgkmcnt(3)
    v_exp_f32 v233, v161
    v_mfma_f32_16x16x32_bf16 a[0:3], a[192:195], v[192:195], a[0:3]
    s_and_b32 s53, s53, 0xffff
    v_exp_f32 v234, v162
    v_mfma_f32_16x16x32_bf16 a[4:7], a[192:195], v[196:199], a[4:7]
    s_add_u32 s34, s34, 0x4000
    ds_read_b128 a[212:215], v3 offset:5120
    v_cvt_pk_bf16_f32 v208, v232, v233
    v_mfma_f32_16x16x32_bf16 a[8:11], a[192:195], v[200:203], a[8:11]
    v_exp_f32 v235, v163
    v_mfma_f32_16x16x32_bf16 a[12:15], a[192:195], v[204:207], a[12:15]
    buffer_load_dwordx4 v1, s[16:19], s32 offen offset:1024 sc1 lds
    v_mfma_f32_16x16x32_bf16 a[16:19], a[196:199], v[192:195], a[16:19]
    v_exp_f32 v236, v176
    v_mfma_f32_16x16x32_bf16 a[20:23], a[196:199], v[196:199], a[20:23]
    ds_read_b128 a[216:219], v3 offset:6144
    v_cvt_pk_bf16_f32 v209, v234, v235
    v_mfma_f32_16x16x32_bf16 a[24:27], a[196:199], v[200:203], a[24:27]
    v_exp_f32 v237, v177
    v_mfma_f32_16x16x32_bf16 a[28:31], a[196:199], v[204:207], a[28:31]
    s_waitcnt lgkmcnt(3)
    v_exp_f32 v238, v178
    v_mfma_f32_16x16x32_bf16 a[32:35], a[200:203], v[192:195], a[32:35]
    s_and_b32 s34, s34, 0xffff
    ds_read_b128 a[220:223], v3 offset:7168
    v_cvt_pk_bf16_f32 v210, v236, v237
    v_mfma_f32_16x16x32_bf16 a[36:39], a[200:203], v[196:199], a[36:39]
    s_and_b32 s60, s62, 31
    buffer_load_dwordx4 v1, s[16:19], s32 offen offset:2048 sc1 lds
    v_mfma_f32_16x16x32_bf16 a[40:43], a[200:203], v[200:203], a[40:43]
    v_exp_f32 v239, v179
    v_mfma_f32_16x16x32_bf16 a[44:47], a[200:203], v[204:207], a[44:47]
    s_lshr_b32 s61, s62, 5
    v_or3_b32 v57, v208, v209, v210
    v_add_u32 v3, s53, v56
    v_mfma_f32_16x16x32_bf16 a[48:51], a[204:207], v[192:195], a[48:51]
    v_exp_f32 v240, v164
    v_mfma_f32_16x16x32_bf16 a[52:55], a[204:207], v[196:199], a[52:55]
    ds_read_b128 a[128:131], v2 offset:0
    v_cvt_pk_bf16_f32 v211, v238, v239
    v_mfma_f32_16x16x32_bf16 a[56:59], a[204:207], v[200:203], a[56:59]
    s_mul_i32 s57, s60, 229376
    v_exp_f32 v241, v165
    v_mfma_f32_16x16x32_bf16 a[60:63], a[204:207], v[204:207], a[60:63]
    s_waitcnt lgkmcnt(3)
    buffer_load_dwordx4 v1, s[16:19], s32 offen offset:3072 sc1 lds
    v_mfma_f32_16x16x32_bf16 a[64:67], a[208:211], v[192:195], a[64:67]
    s_add_u32 s32, s32, 0x80000
    v_exp_f32 v242, v166
    v_mfma_f32_16x16x32_bf16 a[68:71], a[208:211], v[196:199], a[68:71]
    s_lshl_b32 s4, s61, 7
    ds_read_b128 a[132:135], v2 offset:1024
    v_cvt_pk_bf16_f32 v212, v240, v241
    v_mfma_f32_16x16x32_bf16 a[72:75], a[208:211], v[200:203], a[72:75]
    v_exp_f32 v243, v167
    v_mfma_f32_16x16x32_bf16 a[76:79], a[208:211], v[204:207], a[76:79]
    s_add_u32 s57, s57, s4
    v_or3_b32 v57, v57, v211, v212
    v_cvt_pk_bf16_f32 v213, v242, v243
    v_mfma_f32_16x16x32_bf16 a[80:83], a[212:215], v[192:195], a[80:83]
    s_waitcnt vmcnt(8)
    v_exp_f32 v244, v180
    v_mfma_f32_16x16x32_bf16 a[84:87], a[212:215], v[196:199], a[84:87]
    buffer_store_dwordx4 a[224:227], v229, s[8:11], s58 offen offset:0 sc1
    ds_read_b128 a[136:139], v2 offset:2048
    v_mfma_f32_16x16x32_bf16 a[88:91], a[212:215], v[200:203], a[88:91]
    s_add_u32 s56, s57, 57344
    v_exp_f32 v245, v181
    v_mfma_f32_16x16x32_bf16 a[92:95], a[212:215], v[204:207], a[92:95]
    s_waitcnt lgkmcnt(3)
    v_exp_f32 v246, v182
    v_mfma_f32_16x16x32_bf16 a[96:99], a[216:219], v[192:195], a[96:99]
    ds_read_b128 a[140:143], v2 offset:3072
    v_cvt_pk_bf16_f32 v214, v244, v245
    v_mfma_f32_16x16x32_bf16 a[100:103], a[216:219], v[196:199], a[100:103]
    s_add_u32 s62, s62, 1
    v_exp_f32 v247, v183
    v_mfma_f32_16x16x32_bf16 a[104:107], a[216:219], v[200:203], a[104:107]
    v_or3_b32 v57, v57, v213, v214
    v_mfma_f32_16x16x32_bf16 a[108:111], a[216:219], v[204:207], a[108:111]
    v_exp_f32 v232, v168
    v_mfma_f32_16x16x32_bf16 a[112:115], a[220:223], v[192:195], a[112:115]
    ds_read_b128 a[144:147], v2 offset:4096
    v_cvt_pk_bf16_f32 v215, v246, v247
    v_mfma_f32_16x16x32_bf16 a[116:119], a[220:223], v[196:199], a[116:119]
    buffer_store_dwordx4 a[228:231], v229, s[8:11], s58 offen offset:256 sc1
    v_mfma_f32_16x16x32_bf16 a[120:123], a[220:223], v[200:203], a[120:123]
    v_exp_f32 v233, v169
    v_mfma_f32_16x16x32_bf16 a[124:127], a[220:223], v[204:207], a[124:127]
    s_waitcnt lgkmcnt(3)
    v_exp_f32 v234, v170
    v_mfma_f32_16x16x32_bf16 v[128:131], a[128:131], v[64:67], v[16:19]
    ds_read_b128 a[148:151], v2 offset:5120
    v_cvt_pk_bf16_f32 v216, v232, v233
    v_mfma_f32_16x16x32_bf16 v[128:131], a[132:135], v[68:71], v[128:131]
    s_waitcnt lgkmcnt(2)
    v_exp_f32 v235, v171
    v_mfma_f32_16x16x32_bf16 v[128:131], a[136:139], v[72:75], v[128:131]
    v_or3_b32 v57, v57, v215, v216
    v_mfma_f32_16x16x32_bf16 v[128:131], a[140:143], v[76:79], v[128:131]
    s_add_u32 s36, s36, 32
    v_exp_f32 v236, v184
    v_mfma_f32_16x16x32_bf16 v[132:135], a[128:131], v[80:83], v[20:23]
    ds_read_b128 a[152:155], v2 offset:6144
    v_cvt_pk_bf16_f32 v217, v234, v235
    v_mfma_f32_16x16x32_bf16 v[132:135], a[132:135], v[84:87], v[132:135]
    s_lshl_b32 s58, s61, 17
    buffer_load_dwordx4 a[224:227], v228, s[12:15], s57 offen
    v_mfma_f32_16x16x32_bf16 v[132:135], a[136:139], v[88:91], v[132:135]
    s_add_u32 s52, s52, 8192
    v_exp_f32 v237, v185
    v_mfma_f32_16x16x32_bf16 v[132:135], a[140:143], v[92:95], v[132:135]
    v_exp_f32 v238, v186
    v_mfma_f32_16x16x32_bf16 v[136:139], a[128:131], v[96:99], v[24:27]
    s_lshl_b32 s60, s60, 10
    ds_read_b128 a[156:159], v2 offset:7168
    v_cvt_pk_bf16_f32 v218, v236, v237
    v_mfma_f32_16x16x32_bf16 v[136:139], a[132:135], v[100:103], v[136:139]
    s_and_b32 s52, s52, 0xffff
    v_exp_f32 v239, v187
    v_mfma_f32_16x16x32_bf16 v[136:139], a[136:139], v[104:107], v[136:139]
    v_or3_b32 v57, v57, v217, v218
    v_mfma_f32_16x16x32_bf16 v[136:139], a[140:143], v[108:111], v[136:139]
    v_add_u32 v2, s52, v1
    v_cvt_pk_bf16_f32 v219, v238, v239
    v_mfma_f32_16x16x32_bf16 v[140:143], a[128:131], v[112:115], v[28:31]
    s_add_u32 s58, s58, s60
    v_exp_f32 v240, v172
    v_mfma_f32_16x16x32_bf16 v[140:143], a[132:135], v[116:119], v[140:143]
    buffer_load_dwordx4 a[228:231], v228, s[12:15], s56 offen
    v_mfma_f32_16x16x32_bf16 v[140:143], a[136:139], v[120:123], v[140:143]
    v_exp_f32 v241, v173
    v_mfma_f32_16x16x32_bf16 v[140:143], a[140:143], v[124:127], v[140:143]
    s_waitcnt lgkmcnt(2)
    ds_read_b128 a[192:195], v3 offset:0
    v_cvt_pk_bf16_f32 v220, v240, v241
    v_mfma_f32_16x16x32_bf16 v[144:147], a[144:147], v[64:67], v[32:35]
    s_mov_b32 s10, s59
    v_exp_f32 v242, v174
    v_mfma_f32_16x16x32_bf16 v[144:147], a[148:151], v[68:71], v[144:147]
    s_waitcnt lgkmcnt(1)
    v_exp_f32 v243, v175
    v_mfma_f32_16x16x32_bf16 v[144:147], a[152:155], v[72:75], v[144:147]
    ds_read_b128 a[196:199], v3 offset:1024
    v_or3_b32 v57, v57, v219, v220
    v_mfma_f32_16x16x32_bf16 v[144:147], a[156:159], v[76:79], v[144:147]
    v_exp_f32 v244, v188
    v_mfma_f32_16x16x32_bf16 v[148:151], a[144:147], v[80:83], v[36:39]
    v_cvt_pk_bf16_f32 v221, v242, v243
    v_mfma_f32_16x16x32_bf16 v[148:151], a[148:151], v[84:87], v[148:151]
    buffer_load_dword v7, v230, s[24:27], s54 offen
    v_mfma_f32_16x16x32_bf16 v[148:151], a[152:155], v[88:91], v[148:151]
    v_exp_f32 v245, v189
    v_mfma_f32_16x16x32_bf16 v[148:151], a[156:159], v[92:95], v[148:151]
    ds_read_b128 a[200:203], v3 offset:2048
    v_cvt_pk_bf16_f32 v222, v244, v245
    v_mfma_f32_16x16x32_bf16 v[152:155], a[144:147], v[96:99], v[40:43]
    v_exp_f32 v246, v190
    v_mfma_f32_16x16x32_bf16 v[152:155], a[148:151], v[100:103], v[152:155]
    v_exp_f32 v247, v191
    v_mfma_f32_16x16x32_bf16 v[152:155], a[152:155], v[104:107], v[152:155]
    ds_read_b128 a[204:207], v3 offset:3072
    v_or3_b32 v57, v57, v221, v222
    v_mfma_f32_16x16x32_bf16 v[152:155], a[156:159], v[108:111], v[152:155]
    v_cvt_pk_bf16_f32 v223, v246, v247
    v_mfma_f32_16x16x32_bf16 v[156:159], a[144:147], v[112:115], v[44:47]
    s_add_u32 s54, s54, 4096
    v_mfma_f32_16x16x32_bf16 v[156:159], a[148:151], v[116:119], v[156:159]
    v_bitop3_b32 v57, v57, v223, s37 bitop3:0xa8
    v_cmp_ne_u32 vcc, 0, v57
    v_mfma_f32_16x16x32_bf16 v[156:159], a[152:155], v[120:123], v[156:159]
    v_mfma_f32_16x16x32_bf16 v[156:159], a[156:159], v[124:127], v[156:159]
    s_cbranch_vccnz k2_tramp_90
k2_ret_91:
    v_mfma_f32_16x16x32_bf16 v[12:15], v[60:63], v[208:211], v[12:15]
    v_exp_f32 v232, v128
    v_mfma_f32_16x16x32_bf16 v[48:51], v[60:63], v[212:215], v[48:51]
    s_mov_b32 m0, s35
    ds_read_b128 a[208:211], v3 offset:4096
    v_mfma_f32_16x16x32_bf16 v[248:251], v[60:63], v[216:219], v[248:251]
    s_add_u32 s53, s53, 8192
    buffer_load_dwordx4 v1, s[20:23], s33 offen offset:0 sc1 lds
    v_mfma_f32_16x16x32_bf16 v[252:255], v[60:63], v[220:223], v[252:255]
    s_waitcnt lgkmcnt(3)
    v_exp_f32 v233, v129
    v_mfma_f32_16x16x32_bf16 a[0:3], a[192:195], v[208:211], a[0:3]
    s_and_b32 s53, s53, 0xffff
    v_exp_f32 v234, v130
    v_mfma_f32_16x16x32_bf16 a[4:7], a[192:195], v[212:215], a[4:7]
    ds_read_b128 a[212:215], v3 offset:5120
    v_cvt_pk_bf16_f32 v192, v232, v233
    v_mfma_f32_16x16x32_bf16 a[8:11], a[192:195], v[216:219], a[8:11]
    v_exp_f32 v235, v131
    v_mfma_f32_16x16x32_bf16 a[12:15], a[192:195], v[220:223], a[12:15]
    v_exp_f32 v236, v144
    v_mfma_f32_16x16x32_bf16 a[16:19], a[196:199], v[208:211], a[16:19]
    ds_read_b128 a[216:219], v3 offset:6144
    v_cvt_pk_bf16_f32 v193, v234, v235
    v_mfma_f32_16x16x32_bf16 a[20:23], a[196:199], v[212:215], a[20:23]
    v_exp_f32 v237, v145
    v_mfma_f32_16x16x32_bf16 a[24:27], a[196:199], v[216:219], a[24:27]
    v_mfma_f32_16x16x32_bf16 a[28:31], a[196:199], v[220:223], a[28:31]
    s_waitcnt lgkmcnt(3)
    v_exp_f32 v238, v146
    v_mfma_f32_16x16x32_bf16 a[32:35], a[200:203], v[208:211], a[32:35]
    ds_read_b128 a[220:223], v3 offset:7168
    v_cvt_pk_bf16_f32 v194, v236, v237
    v_mfma_f32_16x16x32_bf16 a[36:39], a[200:203], v[212:215], a[36:39]
    v_exp_f32 v239, v147
    v_mfma_f32_16x16x32_bf16 a[40:43], a[200:203], v[216:219], a[40:43]
    v_or3_b32 v57, v192, v193, v194
    v_mfma_f32_16x16x32_bf16 a[44:47], a[200:203], v[220:223], a[44:47]
    s_add_u32 s35, s35, 0x4000
    v_add_u32 v3, s53, v56
    v_cvt_pk_bf16_f32 v195, v238, v239
    v_mfma_f32_16x16x32_bf16 a[48:51], a[204:207], v[208:211], a[48:51]
    v_exp_f32 v240, v132
    v_mfma_f32_16x16x32_bf16 a[52:55], a[204:207], v[212:215], a[52:55]
    buffer_load_dwordx4 v1, s[20:23], s33 offen offset:1024 sc1 lds
    ds_read_b128 a[128:131], v2 offset:0
    v_mfma_f32_16x16x32_bf16 a[56:59], a[204:207], v[216:219], a[56:59]
    v_exp_f32 v241, v133
    v_mfma_f32_16x16x32_bf16 a[60:63], a[204:207], v[220:223], a[60:63]
    s_waitcnt lgkmcnt(3)
    v_exp_f32 v242, v134
    v_mfma_f32_16x16x32_bf16 a[64:67], a[208:211], v[208:211], a[64:67]
    ds_read_b128 a[132:135], v2 offset:1024
    v_cvt_pk_bf16_f32 v196, v240, v241
    v_mfma_f32_16x16x32_bf16 a[68:71], a[208:211], v[212:215], a[68:71]
    v_exp_f32 v243, v135
    v_mfma_f32_16x16x32_bf16 a[72:75], a[208:211], v[216:219], a[72:75]
    v_or3_b32 v57, v57, v195, v196
    v_mfma_f32_16x16x32_bf16 a[76:79], a[208:211], v[220:223], a[76:79]
    v_exp_f32 v244, v148
    v_mfma_f32_16x16x32_bf16 a[80:83], a[212:215], v[208:211], a[80:83]
    ds_read_b128 a[136:139], v2 offset:2048
    v_cvt_pk_bf16_f32 v197, v242, v243
    v_mfma_f32_16x16x32_bf16 a[84:87], a[212:215], v[212:215], a[84:87]
    v_exp_f32 v245, v149
    v_mfma_f32_16x16x32_bf16 a[88:91], a[212:215], v[216:219], a[88:91]
    v_mfma_f32_16x16x32_bf16 a[92:95], a[212:215], v[220:223], a[92:95]
    s_waitcnt lgkmcnt(3)
    v_exp_f32 v246, v150
    v_mfma_f32_16x16x32_bf16 a[96:99], a[216:219], v[208:211], a[96:99]
    ds_read_b128 a[140:143], v2 offset:3072
    v_cvt_pk_bf16_f32 v198, v244, v245
    v_mfma_f32_16x16x32_bf16 a[100:103], a[216:219], v[212:215], a[100:103]
    v_exp_f32 v247, v151
    v_mfma_f32_16x16x32_bf16 a[104:107], a[216:219], v[216:219], a[104:107]
    v_or3_b32 v57, v57, v197, v198
    v_mfma_f32_16x16x32_bf16 a[108:111], a[216:219], v[220:223], a[108:111]
    s_and_b32 s35, s35, 0xffff
    v_exp_f32 v232, v136
    v_mfma_f32_16x16x32_bf16 a[112:115], a[220:223], v[208:211], a[112:115]
    ds_read_b128 a[144:147], v2 offset:4096
    v_cvt_pk_bf16_f32 v199, v246, v247
    v_mfma_f32_16x16x32_bf16 a[116:119], a[220:223], v[212:215], a[116:119]
    buffer_load_dwordx4 v1, s[20:23], s33 offen offset:2048 sc1 lds
    v_mfma_f32_16x16x32_bf16 a[120:123], a[220:223], v[216:219], a[120:123]
    v_exp_f32 v233, v137
    v_mfma_f32_16x16x32_bf16 a[124:127], a[220:223], v[220:223], a[124:127]
    s_waitcnt lgkmcnt(3)
    v_exp_f32 v234, v138
    v_mfma_f32_16x16x32_bf16 v[160:163], a[128:131], v[64:67], v[16:19]
    ds_read_b128 a[148:151], v2 offset:5120
    v_cvt_pk_bf16_f32 v200, v232, v233
    v_mfma_f32_16x16x32_bf16 v[160:163], a[132:135], v[68:71], v[160:163]
    s_waitcnt lgkmcnt(2)
    v_exp_f32 v235, v139
    v_mfma_f32_16x16x32_bf16 v[160:163], a[136:139], v[72:75], v[160:163]
    v_or3_b32 v57, v57, v199, v200
    v_mfma_f32_16x16x32_bf16 v[160:163], a[140:143], v[76:79], v[160:163]
    s_or_b32 s35, s35, 0x10000
    v_exp_f32 v236, v152
    v_mfma_f32_16x16x32_bf16 v[164:167], a[128:131], v[80:83], v[20:23]
    s_add_u32 s36, s36, 32
    ds_read_b128 a[152:155], v2 offset:6144
    v_cvt_pk_bf16_f32 v201, v234, v235
    v_mfma_f32_16x16x32_bf16 v[164:167], a[132:135], v[84:87], v[164:167]
    v_exp_f32 v237, v153
    v_mfma_f32_16x16x32_bf16 v[164:167], a[136:139], v[88:91], v[164:167]
    s_add_u32 s52, s52, 8192
    v_mfma_f32_16x16x32_bf16 v[164:167], a[140:143], v[92:95], v[164:167]
    v_exp_f32 v238, v154
    v_mfma_f32_16x16x32_bf16 v[168:171], a[128:131], v[96:99], v[24:27]
    s_and_b32 s52, s52, 0xffff
    ds_read_b128 a[156:159], v2 offset:7168
    v_cvt_pk_bf16_f32 v202, v236, v237
    v_mfma_f32_16x16x32_bf16 v[168:171], a[132:135], v[100:103], v[168:171]
    v_exp_f32 v239, v155
    v_mfma_f32_16x16x32_bf16 v[168:171], a[136:139], v[104:107], v[168:171]
    v_or3_b32 v57, v57, v201, v202
    v_mfma_f32_16x16x32_bf16 v[168:171], a[140:143], v[108:111], v[168:171]
    v_add_u32 v2, s52, v1
    v_cvt_pk_bf16_f32 v203, v238, v239
    v_mfma_f32_16x16x32_bf16 v[172:175], a[128:131], v[112:115], v[28:31]
    v_exp_f32 v240, v140
    v_mfma_f32_16x16x32_bf16 v[172:175], a[132:135], v[116:119], v[172:175]
    buffer_load_dwordx4 v1, s[20:23], s33 offen offset:3072 sc1 lds
    v_mfma_f32_16x16x32_bf16 v[172:175], a[136:139], v[120:123], v[172:175]
    s_add_u32 s33, s33, 0x80000
    v_exp_f32 v241, v141
    v_mfma_f32_16x16x32_bf16 v[172:175], a[140:143], v[124:127], v[172:175]
    s_waitcnt lgkmcnt(2)
    ds_read_b128 a[192:195], v3 offset:0
    v_cvt_pk_bf16_f32 v204, v240, v241
    v_mfma_f32_16x16x32_bf16 v[176:179], a[144:147], v[64:67], v[32:35]
    v_exp_f32 v242, v142
    v_mfma_f32_16x16x32_bf16 v[176:179], a[148:151], v[68:71], v[176:179]
    s_waitcnt lgkmcnt(1)
    v_exp_f32 v243, v143
    v_mfma_f32_16x16x32_bf16 v[176:179], a[152:155], v[72:75], v[176:179]
    ds_read_b128 a[196:199], v3 offset:1024
    v_or3_b32 v57, v57, v203, v204
    v_mfma_f32_16x16x32_bf16 v[176:179], a[156:159], v[76:79], v[176:179]
    v_exp_f32 v244, v156
    v_mfma_f32_16x16x32_bf16 v[180:183], a[144:147], v[80:83], v[36:39]
    v_cvt_pk_bf16_f32 v205, v242, v243
    v_mfma_f32_16x16x32_bf16 v[180:183], a[148:151], v[84:87], v[180:183]
    v_exp_f32 v245, v157
    v_mfma_f32_16x16x32_bf16 v[180:183], a[152:155], v[88:91], v[180:183]
    ds_read_b128 a[200:203], v3 offset:2048
    v_mfma_f32_16x16x32_bf16 v[180:183], a[156:159], v[92:95], v[180:183]
    s_sub_u32 s63, s63, 1
    v_exp_f32 v246, v158
    v_mfma_f32_16x16x32_bf16 v[184:187], a[144:147], v[96:99], v[40:43]
    v_cvt_pk_bf16_f32 v206, v244, v245
    v_mfma_f32_16x16x32_bf16 v[184:187], a[148:151], v[100:103], v[184:187]
    v_exp_f32 v247, v159
    v_mfma_f32_16x16x32_bf16 v[184:187], a[152:155], v[104:107], v[184:187]
    ds_read_b128 a[204:207], v3 offset:3072
    v_or3_b32 v57, v57, v205, v206
    v_mfma_f32_16x16x32_bf16 v[184:187], a[156:159], v[108:111], v[184:187]
    v_cvt_pk_bf16_f32 v207, v246, v247
    v_mfma_f32_16x16x32_bf16 v[188:191], a[144:147], v[112:115], v[44:47]
    v_mfma_f32_16x16x32_bf16 v[188:191], a[148:151], v[116:119], v[188:191]
    v_bitop3_b32 v57, v57, v207, s37 bitop3:0xa8
    v_cmp_ne_u32 vcc, 0, v57
    v_mfma_f32_16x16x32_bf16 v[188:191], a[152:155], v[120:123], v[188:191]
    v_mfma_f32_16x16x32_bf16 v[188:191], a[156:159], v[124:127], v[188:191]
    s_waitcnt vmcnt(13)
    s_barrier
    s_cbranch_vccnz k2_tramp_92
k2_ret_93:
    s_cmp_lg_u32 s63, 0
    s_cbranch_scc1 k2_dloop_88
    v_mfma_f32_16x16x32_bf16 v[12:15], v[60:63], v[192:195], v[12:15]
    v_exp_f32 v232, v160
    v_mfma_f32_16x16x32_bf16 v[48:51], v[60:63], v[196:199], v[48:51]
    s_mov_b32 m0, s34
    ds_read_b128 a[208:211], v3 offset:4096
    v_mfma_f32_16x16x32_bf16 v[248:251], v[60:63], v[200:203], v[248:251]
    s_add_u32 s53, s53, 8192
    buffer_load_dwordx4 v1, s[16:19], s32 offen offset:0 sc1 lds
    v_mfma_f32_16x16x32_bf16 v[252:255], v[60:63], v[204:207], v[252:255]
    s_waitcnt lgkmcnt(3)
    v_exp_f32 v233, v161
    v_mfma_f32_16x16x32_bf16 a[0:3], a[192:195], v[192:195], a[0:3]
    s_sub_u32 s40, s36, s38
    v_exp_f32 v234, v162
    v_mfma_f32_16x16x32_bf16 a[4:7], a[192:195], v[196:199], a[4:7]
    s_and_b32 s53, s53, 0xffff
    ds_read_b128 a[212:215], v3 offset:5120
    v_cvt_pk_bf16_f32 v208, v232, v233
    v_mfma_f32_16x16x32_bf16 a[8:11], a[192:195], v[200:203], a[8:11]
    s_add_u32 s34, s34, 0x4000
    v_subrev_u32 v6, s40, v4
    v_cmp_gt_i32 s[44:45], 0, v6
    v_mfma_f32_16x16x32_bf16 a[12:15], a[192:195], v[204:207], a[12:15]
    v_exp_f32 v235, v163
    v_mfma_f32_16x16x32_bf16 a[16:19], a[196:199], v[192:195], a[16:19]
    buffer_load_dwordx4 v1, s[16:19], s32 offen offset:1024 sc1 lds
    ds_read_b128 a[216:219], v3 offset:6144
    v_mfma_f32_16x16x32_bf16 a[20:23], a[196:199], v[196:199], a[20:23]
    v_exp_f32 v236, v176
    v_mfma_f32_16x16x32_bf16 a[24:27], a[196:199], v[200:203], a[24:27]
    v_cmp_gt_i32 s[46:47], 1, v6
    v_cvt_pk_bf16_f32 v209, v234, v235
    v_mfma_f32_16x16x32_bf16 a[28:31], a[196:199], v[204:207], a[28:31]
    s_waitcnt lgkmcnt(3)
    v_cmp_gt_i32 s[48:49], 2, v6
    v_cmp_gt_i32 s[50:51], 3, v6
    v_mfma_f32_16x16x32_bf16 a[32:35], a[200:203], v[192:195], a[32:35]
    s_and_b32 s34, s34, 0xffff
    v_exp_f32 v237, v177
    v_mfma_f32_16x16x32_bf16 a[36:39], a[200:203], v[196:199], a[36:39]
    s_and_b32 s60, s62, 31
    v_exp_f32 v238, v178
    v_mfma_f32_16x16x32_bf16 a[40:43], a[200:203], v[200:203], a[40:43]
    ds_read_b128 a[220:223], v3 offset:7168
    v_cvt_pk_bf16_f32 v210, v236, v237
    v_mfma_f32_16x16x32_bf16 a[44:47], a[200:203], v[204:207], a[44:47]
    s_lshr_b32 s61, s62, 5
    buffer_load_dwordx4 v1, s[16:19], s32 offen offset:2048 sc1 lds
    v_mfma_f32_16x16x32_bf16 a[48:51], a[204:207], v[192:195], a[48:51]
    v_cndmask_b32 v16, v8, v5, s[44:45]
    v_or3_b32 v57, v208, v209, v210
    v_mfma_f32_16x16x32_bf16 a[52:55], a[204:207], v[196:199], a[52:55]
    v_exp_f32 v239, v179
    v_mfma_f32_16x16x32_bf16 a[56:59], a[204:207], v[200:203], a[56:59]
    s_mul_i32 s57, s60, 229376
    v_cndmask_b32 v17, v8, v5, s[46:47]
    v_add_u32 v3, s53, v56
    v_mfma_f32_16x16x32_bf16 a[60:63], a[204:207], v[204:207], a[60:63]
    s_waitcnt lgkmcnt(2)
    v_exp_f32 v240, v164
    v_mfma_f32_16x16x32_bf16 a[64:67], a[208:211], v[192:195], a[64:67]
    v_cvt_pk_bf16_f32 v211, v238, v239
    v_cndmask_b32 v18, v8, v5, s[48:49]
    v_mfma_f32_16x16x32_bf16 a[68:71], a[208:211], v[196:199], a[68:71]
    s_lshl_b32 s4, s61, 7
    ds_read_b128 a[128:131], v2 offset:0
    v_cndmask_b32 v19, v8, v5, s[50:51]
    v_mfma_f32_16x16x32_bf16 a[72:75], a[208:211], v[200:203], a[72:75]
    v_exp_f32 v241, v165
    v_mfma_f32_16x16x32_bf16 a[76:79], a[208:211], v[204:207], a[76:79]
    s_add_u32 s57, s57, s4
    buffer_load_dwordx4 v1, s[16:19], s32 offen offset:3072 sc1 lds
    s_add_u32 s32, s32, 0x80000
    v_mfma_f32_16x16x32_bf16 a[80:83], a[212:215], v[192:195], a[80:83]
    s_waitcnt vmcnt(8)
    v_cmp_gt_i32 s[44:45], 16, v6
    v_exp_f32 v242, v166
    v_mfma_f32_16x16x32_bf16 a[84:87], a[212:215], v[196:199], a[84:87]
    ds_read_b128 a[132:135], v2 offset:1024
    v_cvt_pk_bf16_f32 v212, v240, v241
    v_mfma_f32_16x16x32_bf16 a[88:91], a[212:215], v[200:203], a[88:91]
    s_add_u32 s56, s57, 57344
    v_cmp_gt_i32 s[46:47], 17, v6
    v_exp_f32 v243, v167
    v_mfma_f32_16x16x32_bf16 a[92:95], a[212:215], v[204:207], a[92:95]
    s_waitcnt lgkmcnt(2)
    v_or3_b32 v57, v57, v211, v212
    v_cmp_gt_i32 s[48:49], 18, v6
    v_mfma_f32_16x16x32_bf16 a[96:99], a[216:219], v[192:195], a[96:99]
    v_exp_f32 v244, v180
    v_mfma_f32_16x16x32_bf16 a[100:103], a[216:219], v[196:199], a[100:103]
    s_add_u32 s62, s62, 1
    v_cvt_pk_bf16_f32 v213, v242, v243
    v_cmp_gt_i32 s[50:51], 19, v6
    v_mfma_f32_16x16x32_bf16 a[104:107], a[216:219], v[200:203], a[104:107]
    buffer_store_dwordx4 a[224:227], v229, s[8:11], s58 offen offset:0 sc1
    ds_read_b128 a[136:139], v2 offset:2048
    v_mfma_f32_16x16x32_bf16 a[108:111], a[216:219], v[204:207], a[108:111]
    v_exp_f32 v245, v181
    v_mfma_f32_16x16x32_bf16 a[112:115], a[220:223], v[192:195], a[112:115]
    v_cndmask_b32 v32, v8, v5, s[44:45]
    v_exp_f32 v246, v182
    v_mfma_f32_16x16x32_bf16 a[116:119], a[220:223], v[196:199], a[116:119]
    ds_read_b128 a[140:143], v2 offset:3072
    v_cndmask_b32 v33, v8, v5, s[46:47]
    v_cvt_pk_bf16_f32 v214, v244, v245
    v_cndmask_b32 v34, v8, v5, s[48:49]
    v_cndmask_b32 v35, v8, v5, s[50:51]
    v_mfma_f32_16x16x32_bf16 a[120:123], a[220:223], v[200:203], a[120:123]
    v_exp_f32 v247, v183
    v_mfma_f32_16x16x32_bf16 a[124:127], a[220:223], v[204:207], a[124:127]
    s_waitcnt lgkmcnt(2)
    v_or3_b32 v57, v57, v213, v214
    v_cvt_pk_bf16_f32 v215, v246, v247
    v_mfma_f32_16x16x32_bf16 v[128:131], a[128:131], v[64:67], v[16:19]
    v_exp_f32 v232, v168
    v_mfma_f32_16x16x32_bf16 v[128:131], a[132:135], v[68:71], v[128:131]
    s_waitcnt lgkmcnt(0)
    buffer_store_dwordx4 a[228:231], v229, s[8:11], s58 offen offset:256 sc1
    ds_read_b128 a[144:147], v2 offset:4096
    v_mfma_f32_16x16x32_bf16 v[128:131], a[136:139], v[72:75], v[128:131]
    v_exp_f32 v233, v169
    v_mfma_f32_16x16x32_bf16 v[128:131], a[140:143], v[76:79], v[128:131]
    s_add_u32 s36, s36, 32
    v_exp_f32 v234, v170
    v_mfma_f32_16x16x32_bf16 v[132:135], a[128:131], v[80:83], v[20:23]
    ds_read_b128 a[148:151], v2 offset:5120
    v_cvt_pk_bf16_f32 v216, v232, v233
    v_mfma_f32_16x16x32_bf16 v[132:135], a[132:135], v[84:87], v[132:135]
    s_lshl_b32 s58, s61, 17
    v_exp_f32 v235, v171
    v_mfma_f32_16x16x32_bf16 v[132:135], a[136:139], v[88:91], v[132:135]
    s_add_u32 s52, s52, 8192
    v_or3_b32 v57, v57, v215, v216
    v_cvt_pk_bf16_f32 v217, v234, v235
    v_mfma_f32_16x16x32_bf16 v[132:135], a[140:143], v[92:95], v[132:135]
    v_exp_f32 v236, v184
    v_mfma_f32_16x16x32_bf16 v[136:139], a[128:131], v[96:99], v[24:27]
    s_lshl_b32 s60, s60, 10
    buffer_load_dwordx4 a[224:227], v228, s[12:15], s57 offen
    ds_read_b128 a[152:155], v2 offset:6144
    v_mfma_f32_16x16x32_bf16 v[136:139], a[132:135], v[100:103], v[136:139]
    s_and_b32 s52, s52, 0xffff
    v_exp_f32 v237, v185
    v_mfma_f32_16x16x32_bf16 v[136:139], a[136:139], v[104:107], v[136:139]
    v_exp_f32 v238, v186
    v_mfma_f32_16x16x32_bf16 v[136:139], a[140:143], v[108:111], v[136:139]
    ds_read_b128 a[156:159], v2 offset:7168
    v_cvt_pk_bf16_f32 v218, v236, v237
    v_mfma_f32_16x16x32_bf16 v[140:143], a[128:131], v[112:115], v[28:31]
    s_add_u32 s58, s58, s60
    v_exp_f32 v239, v187
    v_mfma_f32_16x16x32_bf16 v[140:143], a[132:135], v[116:119], v[140:143]
    v_or3_b32 v57, v57, v217, v218
    v_add_u32 v2, s52, v1
    v_mfma_f32_16x16x32_bf16 v[140:143], a[136:139], v[120:123], v[140:143]
    v_exp_f32 v240, v172
    v_mfma_f32_16x16x32_bf16 v[140:143], a[140:143], v[124:127], v[140:143]
    s_waitcnt lgkmcnt(2)
    ds_read_b128 a[192:195], v3 offset:0
    v_cvt_pk_bf16_f32 v219, v238, v239
    v_mfma_f32_16x16x32_bf16 v[144:147], a[144:147], v[64:67], v[32:35]
    s_mov_b32 s10, s59
    buffer_load_dwordx4 a[228:231], v228, s[12:15], s56 offen
    v_mfma_f32_16x16x32_bf16 v[144:147], a[148:151], v[68:71], v[144:147]
    s_waitcnt lgkmcnt(1)
    v_exp_f32 v241, v173
    v_mfma_f32_16x16x32_bf16 v[144:147], a[152:155], v[72:75], v[144:147]
    v_exp_f32 v242, v174
    v_mfma_f32_16x16x32_bf16 v[144:147], a[156:159], v[76:79], v[144:147]
    v_cvt_pk_bf16_f32 v220, v240, v241
    v_or3_b32 v57, v57, v219, v220
    v_mfma_f32_16x16x32_bf16 v[148:151], a[144:147], v[80:83], v[36:39]
    v_exp_f32 v243, v175
    v_mfma_f32_16x16x32_bf16 v[148:151], a[148:151], v[84:87], v[148:151]
    ds_read_b128 a[196:199], v3 offset:1024
    v_cvt_pk_bf16_f32 v221, v242, v243
    v_mfma_f32_16x16x32_bf16 v[148:151], a[152:155], v[88:91], v[148:151]
    v_exp_f32 v244, v188
    v_mfma_f32_16x16x32_bf16 v[148:151], a[156:159], v[92:95], v[148:151]
    buffer_load_dword v7, v230, s[24:27], s54 offen
    ds_read_b128 a[200:203], v3 offset:2048
    v_mfma_f32_16x16x32_bf16 v[152:155], a[144:147], v[96:99], v[40:43]
    v_exp_f32 v245, v189
    v_mfma_f32_16x16x32_bf16 v[152:155], a[148:151], v[100:103], v[152:155]
    v_exp_f32 v246, v190
    v_mfma_f32_16x16x32_bf16 v[152:155], a[152:155], v[104:107], v[152:155]
    v_cvt_pk_bf16_f32 v222, v244, v245
    v_or3_b32 v57, v57, v221, v222
    v_mfma_f32_16x16x32_bf16 v[152:155], a[156:159], v[108:111], v[152:155]
    v_exp_f32 v247, v191
    v_mfma_f32_16x16x32_bf16 v[156:159], a[144:147], v[112:115], v[44:47]
    s_add_u32 s54, s54, 4096
    ds_read_b128 a[204:207], v3 offset:3072
    v_cvt_pk_bf16_f32 v223, v246, v247
    v_mfma_f32_16x16x32_bf16 v[156:159], a[148:151], v[116:119], v[156:159]
    v_bitop3_b32 v57, v57, v223, s37 bitop3:0xa8
    v_cmp_ne_u32 vcc, 0, v57
    v_mfma_f32_16x16x32_bf16 v[156:159], a[152:155], v[120:123], v[156:159]
    v_mfma_f32_16x16x32_bf16 v[156:159], a[156:159], v[124:127], v[156:159]
    s_cbranch_vccnz k2_tramp_94
k2_ret_95:
    v_mfma_f32_16x16x32_bf16 v[12:15], v[60:63], v[208:211], v[12:15]
    v_exp_f32 v232, v128
    v_mfma_f32_16x16x32_bf16 v[48:51], v[60:63], v[212:215], v[48:51]
    s_mov_b32 m0, s35
    ds_read_b128 a[208:211], v3 offset:4096
    v_mfma_f32_16x16x32_bf16 v[248:251], v[60:63], v[216:219], v[248:251]
    s_add_u32 s53, s53, 8192
    buffer_load_dwordx4 v1, s[20:23], s33 offen offset:0 sc1 lds
    v_mfma_f32_16x16x32_bf16 v[252:255], v[60:63], v[220:223], v[252:255]
    s_waitcnt lgkmcnt(3)
    v_exp_f32 v233, v129
    v_mfma_f32_16x16x32_bf16 a[0:3], a[192:195], v[208:211], a[0:3]
    s_sub_u32 s40, s36, s38
    v_exp_f32 v234, v130
    v_mfma_f32_16x16x32_bf16 a[4:7], a[192:195], v[212:215], a[4:7]
    s_and_b32 s53, s53, 0xffff
    ds_read_b128 a[212:215], v3 offset:5120
    v_cvt_pk_bf16_f32 v192, v232, v233
    v_mfma_f32_16x16x32_bf16 a[8:11], a[192:195], v[216:219], a[8:11]
    v_subrev_u32 v6, s40, v4
    v_cmp_gt_i32 s[44:45], 0, v6
    v_mfma_f32_16x16x32_bf16 a[12:15], a[192:195], v[220:223], a[12:15]
    v_exp_f32 v235, v131
    v_mfma_f32_16x16x32_bf16 a[16:19], a[196:199], v[208:211], a[16:19]
    v_exp_f32 v236, v144
    v_mfma_f32_16x16x32_bf16 a[20:23], a[196:199], v[212:215], a[20:23]
    v_cmp_gt_i32 s[46:47], 1, v6
    v_cvt_pk_bf16_f32 v193, v234, v235
    v_mfma_f32_16x16x32_bf16 a[24:27], a[196:199], v[216:219], a[24:27]
    ds_read_b128 a[216:219], v3 offset:6144
    v_cmp_gt_i32 s[48:49], 2, v6
    v_mfma_f32_16x16x32_bf16 a[28:31], a[196:199], v[220:223], a[28:31]
    s_waitcnt lgkmcnt(3)
    v_exp_f32 v237, v145
    v_mfma_f32_16x16x32_bf16 a[32:35], a[200:203], v[208:211], a[32:35]
    v_cmp_gt_i32 s[50:51], 3, v6
    v_cvt_pk_bf16_f32 v194, v236, v237
    v_mfma_f32_16x16x32_bf16 a[36:39], a[200:203], v[212:215], a[36:39]
    v_exp_f32 v238, v146
    v_mfma_f32_16x16x32_bf16 a[40:43], a[200:203], v[216:219], a[40:43]
    ds_read_b128 a[220:223], v3 offset:7168
    v_cndmask_b32 v16, v8, v5, s[44:45]
    v_mfma_f32_16x16x32_bf16 a[44:47], a[200:203], v[220:223], a[44:47]
    s_add_u32 s35, s35, 0x4000
    v_exp_f32 v239, v147
    v_mfma_f32_16x16x32_bf16 a[48:51], a[204:207], v[208:211], a[48:51]
    v_or3_b32 v57, v192, v193, v194
    v_cndmask_b32 v17, v8, v5, s[46:47]
    v_mfma_f32_16x16x32_bf16 a[52:55], a[204:207], v[212:215], a[52:55]
    v_add_u32 v3, s53, v56
    v_cvt_pk_bf16_f32 v195, v238, v239
    v_mfma_f32_16x16x32_bf16 a[56:59], a[204:207], v[216:219], a[56:59]
    v_exp_f32 v240, v132
    v_mfma_f32_16x16x32_bf16 a[60:63], a[204:207], v[220:223], a[60:63]
    s_waitcnt lgkmcnt(2)
    ds_read_b128 a[128:131], v2 offset:0
    v_cndmask_b32 v18, v8, v5, s[48:49]
    v_mfma_f32_16x16x32_bf16 a[64:67], a[208:211], v[208:211], a[64:67]
    buffer_load_dwordx4 v1, s[20:23], s33 offen offset:1024 sc1 lds
    ds_read_b128 a[132:135], v2 offset:1024
    v_mfma_f32_16x16x32_bf16 a[68:71], a[208:211], v[212:215], a[68:71]
    v_exp_f32 v241, v133
    v_mfma_f32_16x16x32_bf16 a[72:75], a[208:211], v[216:219], a[72:75]
    v_cndmask_b32 v19, v8, v5, s[50:51]
    v_cmp_gt_i32 s[44:45], 16, v6
    v_mfma_f32_16x16x32_bf16 a[76:79], a[208:211], v[220:223], a[76:79]
    v_exp_f32 v242, v134
    v_mfma_f32_16x16x32_bf16 a[80:83], a[212:215], v[208:211], a[80:83]
    v_cvt_pk_bf16_f32 v196, v240, v241
    v_cmp_gt_i32 s[46:47], 17, v6
    v_mfma_f32_16x16x32_bf16 a[84:87], a[212:215], v[212:215], a[84:87]
    v_exp_f32 v243, v135
    v_mfma_f32_16x16x32_bf16 a[88:91], a[212:215], v[216:219], a[88:91]
    v_or3_b32 v57, v57, v195, v196
    v_cmp_gt_i32 s[48:49], 18, v6
    v_mfma_f32_16x16x32_bf16 a[92:95], a[212:215], v[220:223], a[92:95]
    s_waitcnt lgkmcnt(2)
    v_exp_f32 v244, v148
    v_mfma_f32_16x16x32_bf16 a[96:99], a[216:219], v[208:211], a[96:99]
    v_cvt_pk_bf16_f32 v197, v242, v243
    v_cmp_gt_i32 s[50:51], 19, v6
    v_mfma_f32_16x16x32_bf16 a[100:103], a[216:219], v[212:215], a[100:103]
    ds_read_b128 a[136:139], v2 offset:2048
    v_cndmask_b32 v32, v8, v5, s[44:45]
    v_mfma_f32_16x16x32_bf16 a[104:107], a[216:219], v[216:219], a[104:107]
    v_exp_f32 v245, v149
    v_mfma_f32_16x16x32_bf16 a[108:111], a[216:219], v[220:223], a[108:111]
    s_and_b32 s35, s35, 0xffff
    v_exp_f32 v246, v150
    v_mfma_f32_16x16x32_bf16 a[112:115], a[220:223], v[208:211], a[112:115]
    v_cndmask_b32 v33, v8, v5, s[46:47]
    v_cvt_pk_bf16_f32 v198, v244, v245
    v_mfma_f32_16x16x32_bf16 a[116:119], a[220:223], v[212:215], a[116:119]
    ds_read_b128 a[140:143], v2 offset:3072
    v_cndmask_b32 v34, v8, v5, s[48:49]
    v_cndmask_b32 v35, v8, v5, s[50:51]
    v_mfma_f32_16x16x32_bf16 a[120:123], a[220:223], v[216:219], a[120:123]
    v_exp_f32 v247, v151
    v_mfma_f32_16x16x32_bf16 a[124:127], a[220:223], v[220:223], a[124:127]
    s_waitcnt lgkmcnt(2)
    v_or3_b32 v57, v57, v197, v198
    v_cvt_pk_bf16_f32 v199, v246, v247
    v_mfma_f32_16x16x32_bf16 v[160:163], a[128:131], v[64:67], v[16:19]
    v_exp_f32 v232, v136
    v_mfma_f32_16x16x32_bf16 v[160:163], a[132:135], v[68:71], v[160:163]
    s_waitcnt lgkmcnt(0)
    buffer_load_dwordx4 v1, s[20:23], s33 offen offset:2048 sc1 lds
    ds_read_b128 a[144:147], v2 offset:4096
    v_mfma_f32_16x16x32_bf16 v[160:163], a[136:139], v[72:75], v[160:163]
    v_exp_f32 v233, v137
    v_mfma_f32_16x16x32_bf16 v[160:163], a[140:143], v[76:79], v[160:163]
    s_or_b32 s35, s35, 0x10000
    v_exp_f32 v234, v138
    v_mfma_f32_16x16x32_bf16 v[164:167], a[128:131], v[80:83], v[20:23]
    s_add_u32 s36, s36, 32
    ds_read_b128 a[148:151], v2 offset:5120
    v_cvt_pk_bf16_f32 v200, v232, v233
    v_mfma_f32_16x16x32_bf16 v[164:167], a[132:135], v[84:87], v[164:167]
    v_exp_f32 v235, v139
    v_mfma_f32_16x16x32_bf16 v[164:167], a[136:139], v[88:91], v[164:167]
    s_add_u32 s52, s52, 8192
    v_or3_b32 v57, v57, v199, v200
    v_cvt_pk_bf16_f32 v201, v234, v235
    v_mfma_f32_16x16x32_bf16 v[164:167], a[140:143], v[92:95], v[164:167]
    v_exp_f32 v236, v152
    v_mfma_f32_16x16x32_bf16 v[168:171], a[128:131], v[96:99], v[24:27]
    s_and_b32 s52, s52, 0xffff
    ds_read_b128 a[152:155], v2 offset:6144
    ds_read_b128 a[156:159], v2 offset:7168
    v_mfma_f32_16x16x32_bf16 v[168:171], a[132:135], v[100:103], v[168:171]
    v_exp_f32 v237, v153
    v_mfma_f32_16x16x32_bf16 v[168:171], a[136:139], v[104:107], v[168:171]
    v_exp_f32 v238, v154
    v_mfma_f32_16x16x32_bf16 v[168:171], a[140:143], v[108:111], v[168:171]
    v_cvt_pk_bf16_f32 v202, v236, v237
    v_or3_b32 v57, v57, v201, v202
    v_mfma_f32_16x16x32_bf16 v[172:175], a[128:131], v[112:115], v[28:31]
    v_exp_f32 v239, v155
    v_mfma_f32_16x16x32_bf16 v[172:175], a[132:135], v[116:119], v[172:175]
    v_add_u32 v2, s52, v1
    v_cvt_pk_bf16_f32 v203, v238, v239
    v_mfma_f32_16x16x32_bf16 v[172:175], a[136:139], v[120:123], v[172:175]
    v_exp_f32 v240, v140
    v_mfma_f32_16x16x32_bf16 v[172:175], a[140:143], v[124:127], v[172:175]
    s_waitcnt lgkmcnt(2)
    buffer_load_dwordx4 v1, s[20:23], s33 offen offset:3072 sc1 lds
    s_add_u32 s33, s33, 0x80000
    v_mfma_f32_16x16x32_bf16 v[176:179], a[144:147], v[64:67], v[32:35]
    v_exp_f32 v241, v141
    v_mfma_f32_16x16x32_bf16 v[176:179], a[148:151], v[68:71], v[176:179]
    s_waitcnt lgkmcnt(0)
    ds_read_b128 a[192:195], v3 offset:0
    v_cvt_pk_bf16_f32 v204, v240, v241
    v_mfma_f32_16x16x32_bf16 v[176:179], a[152:155], v[72:75], v[176:179]
    v_exp_f32 v242, v142
    v_mfma_f32_16x16x32_bf16 v[176:179], a[156:159], v[76:79], v[176:179]
    v_exp_f32 v243, v143
    v_mfma_f32_16x16x32_bf16 v[180:183], a[144:147], v[80:83], v[36:39]
    ds_read_b128 a[196:199], v3 offset:1024
    v_or3_b32 v57, v57, v203, v204
    v_mfma_f32_16x16x32_bf16 v[180:183], a[148:151], v[84:87], v[180:183]
    v_exp_f32 v244, v156
    v_mfma_f32_16x16x32_bf16 v[180:183], a[152:155], v[88:91], v[180:183]
    ds_read_b128 a[200:203], v3 offset:2048
    v_cvt_pk_bf16_f32 v205, v242, v243
    v_mfma_f32_16x16x32_bf16 v[180:183], a[156:159], v[92:95], v[180:183]
    v_exp_f32 v245, v157
    v_mfma_f32_16x16x32_bf16 v[184:187], a[144:147], v[96:99], v[40:43]
    v_exp_f32 v246, v158
    v_mfma_f32_16x16x32_bf16 v[184:187], a[148:151], v[100:103], v[184:187]
    v_cvt_pk_bf16_f32 v206, v244, v245
    v_or3_b32 v57, v57, v205, v206
    v_mfma_f32_16x16x32_bf16 v[184:187], a[152:155], v[104:107], v[184:187]
    v_exp_f32 v247, v159
    v_mfma_f32_16x16x32_bf16 v[184:187], a[156:159], v[108:111], v[184:187]
    ds_read_b128 a[204:207], v3 offset:3072
    v_cvt_pk_bf16_f32 v207, v246, v247
    v_mfma_f32_16x16x32_bf16 v[188:191], a[144:147], v[112:115], v[44:47]
    v_mfma_f32_16x16x32_bf16 v[188:191], a[148:151], v[116:119], v[188:191]
    v_bitop3_b32 v57, v57, v207, s37 bitop3:0xa8
    v_cmp_ne_u32 vcc, 0, v57
    v_mfma_f32_16x16x32_bf16 v[188:191], a[152:155], v[120:123], v[188:191]
    v_mfma_f32_16x16x32_bf16 v[188:191], a[156:159], v[124:127], v[188:191]
    s_waitcnt vmcnt(13)
    s_barrier
    s_cbranch_vccnz k2_tramp_96
k2_ret_97:
k2_dm3_89:
    v_mfma_f32_16x16x32_bf16 v[12:15], v[60:63], v[192:195], v[12:15]
    v_exp_f32 v232, v160
    v_mfma_f32_16x16x32_bf16 v[48:51], v[60:63], v[196:199], v[48:51]
    s_mov_b32 m0, s34
    ds_read_b128 a[208:211], v3 offset:4096
    v_mfma_f32_16x16x32_bf16 v[248:251], v[60:63], v[200:203], v[248:251]
    s_add_u32 s53, s53, 8192
    v_exp_f32 v233, v161
    v_mfma_f32_16x16x32_bf16 v[252:255], v[60:63], v[204:207], v[252:255]
    s_waitcnt lgkmcnt(3)
    buffer_load_dwordx4 v1, s[16:19], s32 offen offset:0 sc1 lds
    v_mfma_f32_16x16x32_bf16 a[0:3], a[192:195], v[192:195], a[0:3]
    s_sub_u32 s40, s36, s38
    s_sub_u32 s40, s40, 64
    v_exp_f32 v234, v162
    v_cvt_pk_bf16_f32 v208, v232, v233
    v_mfma_f32_16x16x32_bf16 a[4:7], a[192:195], v[196:199], a[4:7]
    s_and_b32 s53, s53, 0xffff
    ds_read_b128 a[212:215], v3 offset:5120
    v_subrev_u32 v6, s40, v4
    v_mfma_f32_16x16x32_bf16 a[8:11], a[192:195], v[200:203], a[8:11]
    s_add_u32 s34, s34, 0x4000
    v_exp_f32 v235, v163
    v_cmp_gt_i32 s[44:45], 0, v6
    v_mfma_f32_16x16x32_bf16 a[12:15], a[192:195], v[204:207], a[12:15]
    v_exp_f32 v236, v176
    v_cvt_pk_bf16_f32 v209, v234, v235
    v_mfma_f32_16x16x32_bf16 a[16:19], a[196:199], v[192:195], a[16:19]
    buffer_load_dwordx4 v1, s[16:19], s32 offen offset:1024 sc1 lds
    ds_read_b128 a[216:219], v3 offset:6144
    v_mfma_f32_16x16x32_bf16 a[20:23], a[196:199], v[196:199], a[20:23]
    v_cmp_gt_i32 s[46:47], 1, v6
    v_exp_f32 v237, v177
    v_mfma_f32_16x16x32_bf16 a[24:27], a[196:199], v[200:203], a[24:27]
    v_cmp_gt_i32 s[48:49], 2, v6
    v_exp_f32 v238, v178
    v_mfma_f32_16x16x32_bf16 a[28:31], a[196:199], v[204:207], a[28:31]
    s_waitcnt lgkmcnt(3)
    v_cvt_pk_bf16_f32 v210, v236, v237
    v_cmp_gt_i32 s[50:51], 3, v6
    v_mfma_f32_16x16x32_bf16 a[32:35], a[200:203], v[192:195], a[32:35]
    s_and_b32 s34, s34, 0xffff
    v_exp_f32 v239, v179
    v_mfma_f32_16x16x32_bf16 a[36:39], a[200:203], v[196:199], a[36:39]
    s_and_b32 s60, s62, 31
    ds_read_b128 a[220:223], v3 offset:7168
    v_or3_b32 v57, v208, v209, v210
    v_cndmask_b32 v20, v9, v5, s[44:45]
    v_mfma_f32_16x16x32_bf16 a[40:43], a[200:203], v[200:203], a[40:43]
    buffer_load_dwordx4 v1, s[16:19], s32 offen offset:2048 sc1 lds
    v_mfma_f32_16x16x32_bf16 a[44:47], a[200:203], v[204:207], a[44:47]
    s_lshr_b32 s61, s62, 5
    v_exp_f32 v240, v164
    v_cvt_pk_bf16_f32 v211, v238, v239
    v_mfma_f32_16x16x32_bf16 a[48:51], a[204:207], v[192:195], a[48:51]
    v_cndmask_b32 v21, v9, v5, s[46:47]
    v_add_u32 v3, s53, v56
    v_mfma_f32_16x16x32_bf16 a[52:55], a[204:207], v[196:199], a[52:55]
    s_mul_i32 s57, s60, 229376
    v_exp_f32 v241, v165
    v_mfma_f32_16x16x32_bf16 a[56:59], a[204:207], v[200:203], a[56:59]
    ds_read_b128 a[128:131], v2 offset:0
    v_cndmask_b32 v22, v9, v5, s[48:49]
    v_cvt_pk_bf16_f32 v212, v240, v241
    v_mfma_f32_16x16x32_bf16 a[60:63], a[204:207], v[204:207], a[60:63]
    s_waitcnt lgkmcnt(3)
    v_exp_f32 v242, v166
    v_mfma_f32_16x16x32_bf16 a[64:67], a[208:211], v[192:195], a[64:67]
    s_lshl_b32 s4, s61, 7
    v_cndmask_b32 v23, v9, v5, s[50:51]
    v_or3_b32 v57, v57, v211, v212
    v_mfma_f32_16x16x32_bf16 a[68:71], a[208:211], v[196:199], a[68:71]
    buffer_load_dwordx4 v1, s[16:19], s32 offen offset:3072 sc1 lds
    ds_read_b128 a[132:135], v2 offset:1024
    s_add_u32 s32, s32, 0x80000
    v_mfma_f32_16x16x32_bf16 a[72:75], a[208:211], v[200:203], a[72:75]
    v_exp_f32 v243, v167
    v_mfma_f32_16x16x32_bf16 a[76:79], a[208:211], v[204:207], a[76:79]
    s_add_u32 s57, s57, s4
    v_cmp_gt_i32 s[44:45], 16, v6
    v_cvt_pk_bf16_f32 v213, v242, v243
    v_mfma_f32_16x16x32_bf16 a[80:83], a[212:215], v[192:195], a[80:83]
    s_waitcnt vmcnt(8)
    v_exp_f32 v244, v180
    v_mfma_f32_16x16x32_bf16 a[84:87], a[212:215], v[196:199], a[84:87]
    s_add_u32 s56, s57, 57344
    ds_read_b128 a[136:139], v2 offset:2048
    v_cmp_gt_i32 s[46:47], 17, v6
    v_mfma_f32_16x16x32_bf16 a[88:91], a[212:215], v[200:203], a[88:91]
    v_exp_f32 v245, v181
    v_cmp_gt_i32 s[48:49], 18, v6
    v_mfma_f32_16x16x32_bf16 a[92:95], a[212:215], v[204:207], a[92:95]
    s_waitcnt lgkmcnt(3)
    v_exp_f32 v246, v182
    v_mfma_f32_16x16x32_bf16 a[96:99], a[216:219], v[192:195], a[96:99]
    s_add_u32 s62, s62, 1
    v_cmp_gt_i32 s[50:51], 19, v6
    v_cvt_pk_bf16_f32 v214, v244, v245
    v_mfma_f32_16x16x32_bf16 a[100:103], a[216:219], v[196:199], a[100:103]
    buffer_store_dwordx4 a[224:227], v229, s[8:11], s58 offen offset:0 sc1
    ds_read_b128 a[140:143], v2 offset:3072
    ds_read_b128 a[144:147], v2 offset:4096
    v_mfma_f32_16x16x32_bf16 a[104:107], a[216:219], v[200:203], a[104:107]
    v_exp_f32 v247, v183
    v_mfma_f32_16x16x32_bf16 a[108:111], a[216:219], v[204:207], a[108:111]
    v_cndmask_b32 v36, v9, v5, s[44:45]
    v_or3_b32 v57, v57, v213, v214
    v_mfma_f32_16x16x32_bf16 a[112:115], a[220:223], v[192:195], a[112:115]
    v_exp_f32 v232, v168
    v_mfma_f32_16x16x32_bf16 a[116:119], a[220:223], v[196:199], a[116:119]
    v_cndmask_b32 v37, v9, v5, s[46:47]
    v_cvt_pk_bf16_f32 v215, v246, v247
    v_cndmask_b32 v38, v9, v5, s[48:49]
    v_cndmask_b32 v39, v9, v5, s[50:51]
    v_mfma_f32_16x16x32_bf16 a[120:123], a[220:223], v[200:203], a[120:123]
    v_exp_f32 v233, v169
    v_mfma_f32_16x16x32_bf16 a[124:127], a[220:223], v[204:207], a[124:127]
    s_waitcnt lgkmcnt(3)
    buffer_store_dwordx4 a[228:231], v229, s[8:11], s58 offen offset:256 sc1
    v_exp_f32 v234, v170
    v_mfma_f32_16x16x32_bf16 v[132:135], a[128:131], v[80:83], v[20:23]
    ds_read_b128 a[148:151], v2 offset:5120
    v_cvt_pk_bf16_f32 v216, v232, v233
    v_mfma_f32_16x16x32_bf16 v[132:135], a[132:135], v[84:87], v[132:135]
    s_waitcnt lgkmcnt(2)
    v_exp_f32 v235, v171
    v_mfma_f32_16x16x32_bf16 v[132:135], a[136:139], v[88:91], v[132:135]
    s_lshl_b32 s58, s61, 17
    ds_read_b128 a[152:155], v2 offset:6144
    v_or3_b32 v57, v57, v215, v216
    v_mfma_f32_16x16x32_bf16 v[132:135], a[140:143], v[92:95], v[132:135]
    s_add_u32 s36, s36, 32
    v_exp_f32 v236, v184
    v_mfma_f32_16x16x32_bf16 v[136:139], a[128:131], v[96:99], v[24:27]
    s_lshl_b32 s60, s60, 10
    v_cvt_pk_bf16_f32 v217, v234, v235
    v_exp_f32 v237, v185
    v_mfma_f32_16x16x32_bf16 v[136:139], a[132:135], v[100:103], v[136:139]
    buffer_load_dwordx4 a[224:227], v228, s[12:15], s57 offen
    ds_read_b128 a[156:159], v2 offset:7168
    v_mfma_f32_16x16x32_bf16 v[136:139], a[136:139], v[104:107], v[136:139]
    s_add_u32 s52, s52, 8192
    v_exp_f32 v238, v186
    v_mfma_f32_16x16x32_bf16 v[136:139], a[140:143], v[108:111], v[136:139]
    s_add_u32 s58, s58, s60
    v_cvt_pk_bf16_f32 v218, v236, v237
    v_or3_b32 v57, v57, v217, v218
    v_mfma_f32_16x16x32_bf16 v[140:143], a[128:131], v[112:115], v[28:31]
    s_and_b32 s52, s52, 0xffff
    v_exp_f32 v239, v187
    v_mfma_f32_16x16x32_bf16 v[140:143], a[132:135], v[116:119], v[140:143]
    v_add_u32 v2, s52, v1
    v_cvt_pk_bf16_f32 v219, v238, v239
    v_mfma_f32_16x16x32_bf16 v[140:143], a[136:139], v[120:123], v[140:143]
    s_mov_b32 s10, s59
    v_exp_f32 v240, v172
    v_mfma_f32_16x16x32_bf16 v[140:143], a[140:143], v[124:127], v[140:143]
    s_waitcnt lgkmcnt(2)
    ds_read_b128 a[192:195], v3 offset:0
    v_exp_f32 v241, v173
    v_mfma_f32_16x16x32_bf16 v[148:151], a[144:147], v[80:83], v[36:39]
    buffer_load_dwordx4 a[228:231], v228, s[12:15], s56 offen
    ds_read_b128 a[196:199], v3 offset:1024
    v_mfma_f32_16x16x32_bf16 v[148:151], a[148:151], v[84:87], v[148:151]
    s_waitcnt lgkmcnt(2)
    v_exp_f32 v242, v174
    v_mfma_f32_16x16x32_bf16 v[148:151], a[152:155], v[88:91], v[148:151]
    v_cvt_pk_bf16_f32 v220, v240, v241
    v_or3_b32 v57, v57, v219, v220
    v_mfma_f32_16x16x32_bf16 v[148:151], a[156:159], v[92:95], v[148:151]
    v_exp_f32 v243, v175
    v_mfma_f32_16x16x32_bf16 v[152:155], a[144:147], v[96:99], v[40:43]
    v_exp_f32 v244, v188
    v_mfma_f32_16x16x32_bf16 v[152:155], a[148:151], v[100:103], v[152:155]
    v_cvt_pk_bf16_f32 v221, v242, v243
    v_exp_f32 v245, v189
    v_mfma_f32_16x16x32_bf16 v[152:155], a[152:155], v[104:107], v[152:155]
    buffer_load_dword v7, v230, s[24:27], s54 offen
    ds_read_b128 a[200:203], v3 offset:2048
    v_mfma_f32_16x16x32_bf16 v[152:155], a[156:159], v[108:111], v[152:155]
    v_exp_f32 v246, v190
    v_mfma_f32_16x16x32_bf16 v[156:159], a[144:147], v[112:115], v[44:47]
    s_add_u32 s54, s54, 4096
    v_cvt_pk_bf16_f32 v222, v244, v245
    v_or3_b32 v57, v57, v221, v222
    v_mfma_f32_16x16x32_bf16 v[156:159], a[148:151], v[116:119], v[156:159]
    v_exp_f32 v247, v191
    v_mfma_f32_16x16x32_bf16 v[156:159], a[152:155], v[120:123], v[156:159]
    ds_read_b128 a[204:207], v3 offset:3072
    v_cvt_pk_bf16_f32 v223, v246, v247
    v_bitop3_b32 v57, v57, v223, s37 bitop3:0xa8
    v_mfma_f32_16x16x32_bf16 v[156:159], a[156:159], v[124:127], v[156:159]
    v_cmp_ne_u32 vcc, 0, v57
    s_cbranch_vccnz k2_tramp_98
k2_ret_99:
    v_mfma_f32_16x16x32_bf16 v[12:15], v[60:63], v[208:211], v[12:15]
    v_exp_f32 v232, v132
    v_mfma_f32_16x16x32_bf16 v[48:51], v[60:63], v[212:215], v[48:51]
    s_mov_b32 m0, s35
    ds_read_b128 a[208:211], v3 offset:4096
    v_mfma_f32_16x16x32_bf16 v[248:251], v[60:63], v[216:219], v[248:251]
    s_add_u32 s53, s53, 8192
    buffer_load_dwordx4 v1, s[20:23], s33 offen offset:0 sc1 lds
    v_mfma_f32_16x16x32_bf16 v[252:255], v[60:63], v[220:223], v[252:255]
    s_waitcnt lgkmcnt(3)
    v_exp_f32 v233, v133
    v_mfma_f32_16x16x32_bf16 a[0:3], a[192:195], v[208:211], a[0:3]
    s_sub_u32 s40, s36, s38
    s_sub_u32 s40, s40, 64
    v_exp_f32 v234, v134
    v_mfma_f32_16x16x32_bf16 a[4:7], a[192:195], v[212:215], a[4:7]
    s_and_b32 s53, s53, 0xffff
    ds_read_b128 a[212:215], v3 offset:5120
    v_subrev_u32 v6, s40, v4
    v_mfma_f32_16x16x32_bf16 a[8:11], a[192:195], v[216:219], a[8:11]
    v_cvt_pk_bf16_f32 v196, v232, v233
    v_cmp_gt_i32 s[44:45], 0, v6
    v_mfma_f32_16x16x32_bf16 a[12:15], a[192:195], v[220:223], a[12:15]
    v_exp_f32 v235, v135
    v_mfma_f32_16x16x32_bf16 a[16:19], a[196:199], v[208:211], a[16:19]
    ds_read_b128 a[216:219], v3 offset:6144
    v_cmp_gt_i32 s[46:47], 1, v6
    v_mfma_f32_16x16x32_bf16 a[20:23], a[196:199], v[212:215], a[20:23]
    v_exp_f32 v236, v148
    v_mfma_f32_16x16x32_bf16 a[24:27], a[196:199], v[216:219], a[24:27]
    v_cvt_pk_bf16_f32 v197, v234, v235
    v_cmp_gt_i32 s[48:49], 2, v6
    v_mfma_f32_16x16x32_bf16 a[28:31], a[196:199], v[220:223], a[28:31]
    s_waitcnt lgkmcnt(3)
    v_cmp_gt_i32 s[50:51], 3, v6
    v_mfma_f32_16x16x32_bf16 a[32:35], a[200:203], v[208:211], a[32:35]
    v_exp_f32 v237, v149
    v_mfma_f32_16x16x32_bf16 a[36:39], a[200:203], v[212:215], a[36:39]
    s_add_u32 s35, s35, 0x4000
    ds_read_b128 a[220:223], v3 offset:7168
    v_cndmask_b32 v20, v9, v5, s[44:45]
    v_mfma_f32_16x16x32_bf16 a[40:43], a[200:203], v[216:219], a[40:43]
    v_exp_f32 v238, v150
    v_mfma_f32_16x16x32_bf16 a[44:47], a[200:203], v[220:223], a[44:47]
    v_cvt_pk_bf16_f32 v198, v236, v237
    v_cndmask_b32 v21, v9, v5, s[46:47]
    v_mfma_f32_16x16x32_bf16 a[48:51], a[204:207], v[208:211], a[48:51]
    buffer_load_dwordx4 v1, s[20:23], s33 offen offset:1024 sc1 lds
    ds_read_b128 a[128:131], v2 offset:0
    v_mfma_f32_16x16x32_bf16 a[52:55], a[204:207], v[212:215], a[52:55]
    v_add_u32 v3, s53, v56
    v_cndmask_b32 v22, v9, v5, s[48:49]
    v_mfma_f32_16x16x32_bf16 a[56:59], a[204:207], v[216:219], a[56:59]
    v_exp_f32 v239, v151
    v_mfma_f32_16x16x32_bf16 a[60:63], a[204:207], v[220:223], a[60:63]
    s_waitcnt lgkmcnt(3)
    v_or3_b32 v57, v196, v197, v198
    v_cndmask_b32 v23, v9, v5, s[50:51]
    v_mfma_f32_16x16x32_bf16 a[64:67], a[208:211], v[208:211], a[64:67]
    v_exp_f32 v240, v136
    v_mfma_f32_16x16x32_bf16 a[68:71], a[208:211], v[212:215], a[68:71]
    v_cvt_pk_bf16_f32 v199, v238, v239
    v_cmp_gt_i32 s[44:45], 16, v6
    v_mfma_f32_16x16x32_bf16 a[72:75], a[208:211], v[216:219], a[72:75]
    ds_read_b128 a[132:135], v2 offset:1024
    v_cmp_gt_i32 s[46:47], 17, v6
    v_mfma_f32_16x16x32_bf16 a[76:79], a[208:211], v[220:223], a[76:79]
    v_exp_f32 v241, v137
    v_mfma_f32_16x16x32_bf16 a[80:83], a[212:215], v[208:211], a[80:83]
    ds_read_b128 a[136:139], v2 offset:2048
    v_cmp_gt_i32 s[48:49], 18, v6
    v_mfma_f32_16x16x32_bf16 a[84:87], a[212:215], v[212:215], a[84:87]
    v_exp_f32 v242, v138
    v_mfma_f32_16x16x32_bf16 a[88:91], a[212:215], v[216:219], a[88:91]
    v_cvt_pk_bf16_f32 v200, v240, v241
    v_cmp_gt_i32 s[50:51], 19, v6
    v_mfma_f32_16x16x32_bf16 a[92:95], a[212:215], v[220:223], a[92:95]
    s_waitcnt lgkmcnt(3)
    v_exp_f32 v243, v139
    v_mfma_f32_16x16x32_bf16 a[96:99], a[216:219], v[208:211], a[96:99]
    s_and_b32 s35, s35, 0xffff
    ds_read_b128 a[140:143], v2 offset:3072
    v_or3_b32 v57, v57, v199, v200
    v_mfma_f32_16x16x32_bf16 a[100:103], a[216:219], v[212:215], a[100:103]
    v_cndmask_b32 v36, v9, v5, s[44:45]
    v_cndmask_b32 v37, v9, v5, s[46:47]
    v_mfma_f32_16x16x32_bf16 a[104:107], a[216:219], v[216:219], a[104:107]
    v_exp_f32 v244, v152
    v_mfma_f32_16x16x32_bf16 a[108:111], a[216:219], v[220:223], a[108:111]
    ds_read_b128 a[144:147], v2 offset:4096
    v_cvt_pk_bf16_f32 v201, v242, v243
    v_mfma_f32_16x16x32_bf16 a[112:115], a[220:223], v[208:211], a[112:115]
    buffer_load_dwordx4 v1, s[20:23], s33 offen offset:2048 sc1 lds
    ds_read_b128 a[148:151], v2 offset:5120
    v_mfma_f32_16x16x32_bf16 a[116:119], a[220:223], v[212:215], a[116:119]
    v_cndmask_b32 v38, v9, v5, s[48:49]
    v_cndmask_b32 v39, v9, v5, s[50:51]
    v_mfma_f32_16x16x32_bf16 a[120:123], a[220:223], v[216:219], a[120:123]
    s_or_b32 s35, s35, 0x10000
    v_exp_f32 v245, v153
    v_mfma_f32_16x16x32_bf16 a[124:127], a[220:223], v[220:223], a[124:127]
    s_waitcnt lgkmcnt(4)
    v_exp_f32 v246, v154
    v_mfma_f32_16x16x32_bf16 v[164:167], a[128:131], v[80:83], v[20:23]
    ds_read_b128 a[152:155], v2 offset:6144
    v_cvt_pk_bf16_f32 v202, v244, v245
    v_mfma_f32_16x16x32_bf16 v[164:167], a[132:135], v[84:87], v[164:167]
    s_waitcnt lgkmcnt(3)
    v_exp_f32 v247, v155
    v_mfma_f32_16x16x32_bf16 v[164:167], a[136:139], v[88:91], v[164:167]
    v_or3_b32 v57, v57, v201, v202
    v_cvt_pk_bf16_f32 v203, v246, v247
    v_mfma_f32_16x16x32_bf16 v[164:167], a[140:143], v[92:95], v[164:167]
    s_add_u32 s36, s36, 32
    v_exp_f32 v232, v140
    v_mfma_f32_16x16x32_bf16 v[168:171], a[128:131], v[96:99], v[24:27]
    ds_read_b128 a[156:159], v2 offset:7168
    v_mfma_f32_16x16x32_bf16 v[168:171], a[132:135], v[100:103], v[168:171]
    v_exp_f32 v233, v141
    v_mfma_f32_16x16x32_bf16 v[168:171], a[136:139], v[104:107], v[168:171]
    s_add_u32 s52, s52, 8192
    v_exp_f32 v234, v142
    v_mfma_f32_16x16x32_bf16 v[168:171], a[140:143], v[108:111], v[168:171]
    ds_read_b128 a[192:195], v3 offset:0
    v_cvt_pk_bf16_f32 v204, v232, v233
    v_mfma_f32_16x16x32_bf16 v[172:175], a[128:131], v[112:115], v[28:31]
    s_and_b32 s52, s52, 0xffff
    v_add_u32 v2, s52, v1
    v_or3_b32 v57, v57, v203, v204
    v_mfma_f32_16x16x32_bf16 v[172:175], a[132:135], v[116:119], v[172:175]
    buffer_load_dwordx4 v1, s[20:23], s33 offen offset:3072 sc1 lds
    s_add_u32 s33, s33, 0x80000
    v_mfma_f32_16x16x32_bf16 v[172:175], a[136:139], v[120:123], v[172:175]
    v_exp_f32 v235, v143
    v_mfma_f32_16x16x32_bf16 v[172:175], a[140:143], v[124:127], v[172:175]
    s_waitcnt lgkmcnt(3)
    v_exp_f32 v236, v156
    v_mfma_f32_16x16x32_bf16 v[180:183], a[144:147], v[80:83], v[36:39]
    ds_read_b128 a[196:199], v3 offset:1024
    v_cvt_pk_bf16_f32 v205, v234, v235
    v_mfma_f32_16x16x32_bf16 v[180:183], a[148:151], v[84:87], v[180:183]
    s_waitcnt lgkmcnt(2)
    v_exp_f32 v237, v157
    v_mfma_f32_16x16x32_bf16 v[180:183], a[152:155], v[88:91], v[180:183]
    ds_read_b128 a[200:203], v3 offset:2048
    v_mfma_f32_16x16x32_bf16 v[180:183], a[156:159], v[92:95], v[180:183]
    v_exp_f32 v238, v158
    v_mfma_f32_16x16x32_bf16 v[184:187], a[144:147], v[96:99], v[40:43]
    v_cvt_pk_bf16_f32 v206, v236, v237
    v_mfma_f32_16x16x32_bf16 v[184:187], a[148:151], v[100:103], v[184:187]
    v_exp_f32 v239, v159
    v_mfma_f32_16x16x32_bf16 v[184:187], a[152:155], v[104:107], v[184:187]
    ds_read_b128 a[204:207], v3 offset:3072
    v_or3_b32 v57, v57, v205, v206
    v_mfma_f32_16x16x32_bf16 v[184:187], a[156:159], v[108:111], v[184:187]
    v_cvt_pk_bf16_f32 v207, v238, v239
    v_mfma_f32_16x16x32_bf16 v[188:191], a[144:147], v[112:115], v[44:47]
    v_mfma_f32_16x16x32_bf16 v[188:191], a[148:151], v[116:119], v[188:191]
    v_bitop3_b32 v57, v57, v207, s37 bitop3:0xa8
    v_cmp_ne_u32 vcc, 0, v57
    v_mfma_f32_16x16x32_bf16 v[188:191], a[152:155], v[120:123], v[188:191]
    v_mfma_f32_16x16x32_bf16 v[188:191], a[156:159], v[124:127], v[188:191]
    s_waitcnt vmcnt(13)
    s_barrier
    s_cbranch_vccnz k2_tramp_100
k2_ret_101:
    v_mfma_f32_16x16x32_bf16 v[48:51], v[60:63], v[196:199], v[48:51]
    ds_read_b128 a[208:211], v3 offset:4096
    ds_read_b128 a[212:215], v3 offset:5120
    v_mfma_f32_16x16x32_bf16 v[248:251], v[60:63], v[200:203], v[248:251]
    s_mov_b32 m0, s34
    v_exp_f32 v232, v164
    v_mfma_f32_16x16x32_bf16 v[252:255], v[60:63], v[204:207], v[252:255]
    s_waitcnt lgkmcnt(4)
    buffer_load_dwordx4 v1, s[16:19], s32 offen offset:0 sc1 lds
    ds_read_b128 a[216:219], v3 offset:6144
    v_mfma_f32_16x16x32_bf16 a[4:7], a[192:195], v[196:199], a[4:7]
    s_add_u32 s53, s53, 8192
    v_exp_f32 v233, v165
    v_mfma_f32_16x16x32_bf16 a[8:11], a[192:195], v[200:203], a[8:11]
    s_and_b32 s53, s53, 0xffff
    v_mov_b32 v16, v10
    v_mov_b32 v17, v10
    v_mfma_f32_16x16x32_bf16 a[12:15], a[192:195], v[204:207], a[12:15]
    s_add_u32 s34, s34, 0x4000
    v_exp_f32 v234, v166
    v_mfma_f32_16x16x32_bf16 a[20:23], a[196:199], v[196:199], a[20:23]
    ds_read_b128 a[220:223], v3 offset:7168
    v_cvt_pk_bf16_f32 v212, v232, v233
    v_mfma_f32_16x16x32_bf16 a[24:27], a[196:199], v[200:203], a[24:27]
    v_mov_b32 v18, v10
    v_mov_b32 v19, v10
    v_mfma_f32_16x16x32_bf16 a[28:31], a[196:199], v[204:207], a[28:31]
    s_waitcnt lgkmcnt(4)
    v_exp_f32 v235, v167
    v_mfma_f32_16x16x32_bf16 a[36:39], a[200:203], v[196:199], a[36:39]
    buffer_load_dwordx4 v1, s[16:19], s32 offen offset:1024 sc1 lds
    ds_read_b128 a[128:131], v2 offset:0
    v_mfma_f32_16x16x32_bf16 a[40:43], a[200:203], v[200:203], a[40:43]
    v_mov_b32 v20, v11
    v_add_u32 v3, s53, v56
    v_mfma_f32_16x16x32_bf16 a[44:47], a[200:203], v[204:207], a[44:47]
    s_and_b32 s34, s34, 0xffff
    v_mov_b32 v21, v11
    v_mov_b32 v22, v11
    v_mfma_f32_16x16x32_bf16 a[52:55], a[204:207], v[196:199], a[52:55]
    v_exp_f32 v236, v180
    v_mfma_f32_16x16x32_bf16 a[56:59], a[204:207], v[200:203], a[56:59]
    ds_read_b128 a[132:135], v2 offset:1024
    v_cvt_pk_bf16_f32 v213, v234, v235
    v_mfma_f32_16x16x32_bf16 a[60:63], a[204:207], v[204:207], a[60:63]
    s_waitcnt lgkmcnt(4)
    v_mov_b32 v23, v11
    v_mov_b32 v32, v10
    v_mfma_f32_16x16x32_bf16 a[68:71], a[208:211], v[196:199], a[68:71]
    v_exp_f32 v237, v181
    v_mfma_f32_16x16x32_bf16 a[72:75], a[208:211], v[200:203], a[72:75]
    ds_read_b128 a[136:139], v2 offset:2048
    v_mov_b32 v33, v10
    v_mfma_f32_16x16x32_bf16 a[76:79], a[208:211], v[204:207], a[76:79]
    buffer_load_dwordx4 v1, s[16:19], s32 offen offset:2048 sc1 lds
    v_mov_b32 v34, v10
    v_mfma_f32_16x16x32_bf16 a[84:87], a[212:215], v[196:199], a[84:87]
    v_exp_f32 v238, v182
    v_mfma_f32_16x16x32_bf16 a[88:91], a[212:215], v[200:203], a[88:91]
    ds_read_b128 a[140:143], v2 offset:3072
    v_cvt_pk_bf16_f32 v214, v236, v237
    v_mfma_f32_16x16x32_bf16 a[92:95], a[212:215], v[204:207], a[92:95]
    s_waitcnt lgkmcnt(4)
    v_mov_b32 v35, v10
    v_mov_b32 v36, v11
    v_mfma_f32_16x16x32_bf16 a[100:103], a[216:219], v[196:199], a[100:103]
    ds_read_b128 a[144:147], v2 offset:4096
    v_exp_f32 v239, v183
    v_mfma_f32_16x16x32_bf16 a[104:107], a[216:219], v[200:203], a[104:107]
    v_mov_b32 v37, v11
    v_or3_b32 v57, v212, v213, v214
    v_mov_b32 v38, v11
    v_mov_b32 v39, v11
    v_mfma_f32_16x16x32_bf16 a[108:111], a[216:219], v[204:207], a[108:111]
    buffer_load_dwordx4 v1, s[16:19], s32 offen offset:3072 sc1 lds
    ds_read_b128 a[148:151], v2 offset:5120
    v_mfma_f32_16x16x32_bf16 a[116:119], a[220:223], v[196:199], a[116:119]
    s_add_u32 s32, s32, 0x80000
    s_cmp_ge_u32 s36, s43
    s_cbranch_scc1 k2_prep_102
k2_prepret_103:
    v_mfma_f32_16x16x32_bf16 a[120:123], a[220:223], v[200:203], a[120:123]
    s_waitcnt vmcnt(8)
    v_exp_f32 v240, v168
    v_mfma_f32_16x16x32_bf16 a[124:127], a[220:223], v[204:207], a[124:127]
    s_waitcnt lgkmcnt(4)
    ds_read_b128 a[152:155], v2 offset:6144
    v_cvt_pk_bf16_f32 v215, v238, v239
    v_mfma_f32_16x16x32_bf16 v[128:131], a[128:131], v[96:99], v[16:19]
    v_exp_f32 v241, v169
    v_mfma_f32_16x16x32_bf16 v[128:131], a[132:135], v[100:103], v[128:131]
    s_waitcnt lgkmcnt(3)
    ds_read_b128 a[156:159], v2 offset:7168
    v_exp_f32 v242, v170
    v_mfma_f32_16x16x32_bf16 v[128:131], a[136:139], v[104:107], v[128:131]
    ds_read_b128 a[160:163], v2 offset:8192
    v_cvt_pk_bf16_f32 v216, v240, v241
    v_mfma_f32_16x16x32_bf16 v[128:131], a[140:143], v[108:111], v[128:131]
    s_add_u32 s36, s36, 64
    buffer_store_dwordx4 a[224:227], v229, s[8:11], s58 offen offset:0 sc1
    v_exp_f32 v243, v171
    v_mfma_f32_16x16x32_bf16 v[132:135], a[128:131], v[112:115], v[20:23]
    ds_read_b128 a[164:167], v2 offset:9216
    v_or3_b32 v57, v57, v215, v216
    v_mfma_f32_16x16x32_bf16 v[132:135], a[132:135], v[116:119], v[132:135]
    v_exp_f32 v244, v184
    v_mfma_f32_16x16x32_bf16 v[132:135], a[136:139], v[120:123], v[132:135]
    s_add_u32 s52, s52, 16384
    ds_read_b128 a[168:171], v2 offset:10240
    v_cvt_pk_bf16_f32 v217, v242, v243
    v_mfma_f32_16x16x32_bf16 v[132:135], a[140:143], v[124:127], v[132:135]
    s_waitcnt lgkmcnt(5)
    v_exp_f32 v245, v185
    v_mfma_f32_16x16x32_bf16 v[144:147], a[144:147], v[96:99], v[32:35]
    s_and_b32 s52, s52, 0xffff
    ds_read_b128 a[172:175], v2 offset:11264
    ds_read_b128 a[176:179], v2 offset:12288
    v_mfma_f32_16x16x32_bf16 v[144:147], a[148:151], v[100:103], v[144:147]
    s_waitcnt lgkmcnt(5)
    v_exp_f32 v246, v186
    v_mfma_f32_16x16x32_bf16 v[144:147], a[152:155], v[104:107], v[144:147]
    ds_read_b128 a[180:183], v2 offset:13312
    v_cvt_pk_bf16_f32 v218, v244, v245
    v_mfma_f32_16x16x32_bf16 v[144:147], a[156:159], v[108:111], v[144:147]
    v_exp_f32 v247, v187
    v_mfma_f32_16x16x32_bf16 v[148:151], a[144:147], v[112:115], v[36:39]
    ds_read_b128 a[184:187], v2 offset:14336
    v_or3_b32 v57, v57, v217, v218
    v_mfma_f32_16x16x32_bf16 v[148:151], a[148:151], v[116:119], v[148:151]
    v_exp_f32 v232, v172
    v_mfma_f32_16x16x32_bf16 v[148:151], a[152:155], v[120:123], v[148:151]
    ds_read_b128 a[188:191], v2 offset:15360
    v_cvt_pk_bf16_f32 v219, v246, v247
    v_mfma_f32_16x16x32_bf16 v[148:151], a[156:159], v[124:127], v[148:151]
    s_waitcnt lgkmcnt(6)
    v_exp_f32 v233, v173
    v_mfma_f32_16x16x32_bf16 v[136:139], a[160:163], v[96:99], v[24:27]
    buffer_store_dwordx4 a[228:231], v229, s[8:11], s58 offen offset:256 sc1
    ds_read_b128 a[192:195], v3 offset:0
    v_mfma_f32_16x16x32_bf16 v[136:139], a[164:167], v[100:103], v[136:139]
    s_waitcnt lgkmcnt(5)
    v_add_u32 v2, s52, v1
    v_cvt_pk_bf16_f32 v220, v232, v233
    v_mfma_f32_16x16x32_bf16 v[136:139], a[168:171], v[104:107], v[136:139]
    v_exp_f32 v234, v174
    v_mfma_f32_16x16x32_bf16 v[136:139], a[172:175], v[108:111], v[136:139]
    v_exp_f32 v235, v175
    v_mfma_f32_16x16x32_bf16 v[140:143], a[160:163], v[112:115], v[28:31]
    ds_read_b128 a[196:199], v3 offset:1024
    v_or3_b32 v57, v57, v219, v220
    v_mfma_f32_16x16x32_bf16 v[140:143], a[164:167], v[116:119], v[140:143]
    v_exp_f32 v236, v188
    v_mfma_f32_16x16x32_bf16 v[140:143], a[168:171], v[120:123], v[140:143]
    ds_read_b128 a[200:203], v3 offset:2048
    v_cvt_pk_bf16_f32 v221, v234, v235
    v_mfma_f32_16x16x32_bf16 v[140:143], a[172:175], v[124:127], v[140:143]
    s_waitcnt lgkmcnt(5)
    v_exp_f32 v237, v189
    v_mfma_f32_16x16x32_bf16 v[152:155], a[176:179], v[96:99], v[40:43]
    v_exp_f32 v238, v190
    v_mfma_f32_16x16x32_bf16 v[152:155], a[180:183], v[100:103], v[152:155]
    s_waitcnt lgkmcnt(3)
    v_cvt_pk_bf16_f32 v222, v236, v237
    v_or3_b32 v57, v57, v221, v222
    v_mfma_f32_16x16x32_bf16 v[152:155], a[184:187], v[104:107], v[152:155]
    v_exp_f32 v239, v191
    v_mfma_f32_16x16x32_bf16 v[152:155], a[188:191], v[108:111], v[152:155]
    ds_read_b128 a[204:207], v3 offset:3072
    v_cvt_pk_bf16_f32 v223, v238, v239
    v_mfma_f32_16x16x32_bf16 v[156:159], a[176:179], v[112:115], v[44:47]
    v_mfma_f32_16x16x32_bf16 v[156:159], a[180:183], v[116:119], v[156:159]
    v_bitop3_b32 v57, v57, v223, s37 bitop3:0xa8
    v_cmp_ne_u32 vcc, 0, v57
    v_mfma_f32_16x16x32_bf16 v[156:159], a[184:187], v[120:123], v[156:159]
    v_mfma_f32_16x16x32_bf16 v[156:159], a[188:191], v[124:127], v[156:159]
    s_cbranch_vccnz k2_tramp_104
k2_ret_105:
    v_mfma_f32_16x16x32_bf16 v[48:51], v[60:63], v[212:215], v[48:51]
    ds_read_b128 a[208:211], v3 offset:4096
    ds_read_b128 a[212:215], v3 offset:5120
    v_mfma_f32_16x16x32_bf16 v[248:251], v[60:63], v[216:219], v[248:251]
    s_mov_b32 m0, s35
    v_exp_f32 v232, v128
    v_mfma_f32_16x16x32_bf16 v[252:255], v[60:63], v[220:223], v[252:255]
    s_waitcnt lgkmcnt(4)
    ds_read_b128 a[216:219], v3 offset:6144
    v_exp_f32 v233, v129
    v_mfma_f32_16x16x32_bf16 a[4:7], a[192:195], v[212:215], a[4:7]
    s_add_u32 s53, s53, 8192
    buffer_load_dwordx4 v1, s[20:23], s33 offen offset:0 sc1 lds
    v_mfma_f32_16x16x32_bf16 a[8:11], a[192:195], v[216:219], a[8:11]
    s_and_b32 s53, s53, 0xffff
    v_exp_f32 v234, v130
    v_cvt_pk_bf16_f32 v192, v232, v233
    v_mfma_f32_16x16x32_bf16 a[12:15], a[192:195], v[220:223], a[12:15]
    ds_read_b128 a[220:223], v3 offset:7168
    v_mfma_f32_16x16x32_bf16 a[20:23], a[196:199], v[212:215], a[20:23]
    s_add_u32 s35, s35, 0x4000
    v_exp_f32 v235, v131
    v_mfma_f32_16x16x32_bf16 a[24:27], a[196:199], v[216:219], a[24:27]
    v_exp_f32 v236, v144
    v_cvt_pk_bf16_f32 v193, v234, v235
    v_mfma_f32_16x16x32_bf16 a[28:31], a[196:199], v[220:223], a[28:31]
    s_waitcnt lgkmcnt(4)
    buffer_load_dwordx4 v1, s[20:23], s33 offen offset:1024 sc1 lds
    ds_read_b128 a[128:131], v2 offset:0
    v_mfma_f32_16x16x32_bf16 a[36:39], a[200:203], v[212:215], a[36:39]
    v_add_u32 v3, s53, v56
    v_exp_f32 v237, v145
    v_mfma_f32_16x16x32_bf16 a[40:43], a[200:203], v[216:219], a[40:43]
    ds_read_b128 a[132:135], v2 offset:1024
    v_cvt_pk_bf16_f32 v194, v236, v237
    v_mfma_f32_16x16x32_bf16 a[44:47], a[200:203], v[220:223], a[44:47]
    ds_read_b128 a[136:139], v2 offset:2048
    v_exp_f32 v238, v146
    v_mfma_f32_16x16x32_bf16 a[52:55], a[204:207], v[212:215], a[52:55]
    s_and_b32 s35, s35, 0xffff
    v_exp_f32 v239, v147
    v_mfma_f32_16x16x32_bf16 a[56:59], a[204:207], v[216:219], a[56:59]
    ds_read_b128 a[140:143], v2 offset:3072
    v_or3_b32 v57, v192, v193, v194
    v_mfma_f32_16x16x32_bf16 a[60:63], a[204:207], v[220:223], a[60:63]
    s_waitcnt lgkmcnt(6)
    v_exp_f32 v240, v132
    v_mfma_f32_16x16x32_bf16 a[68:71], a[208:211], v[212:215], a[68:71]
    s_or_b32 s35, s35, 0x10000
    buffer_load_dwordx4 v1, s[20:23], s33 offen offset:2048 sc1 lds
    ds_read_b128 a[144:147], v2 offset:4096
    v_mfma_f32_16x16x32_bf16 a[72:75], a[208:211], v[216:219], a[72:75]
    v_cvt_pk_bf16_f32 v195, v238, v239
    v_exp_f32 v241, v133
    v_mfma_f32_16x16x32_bf16 a[76:79], a[208:211], v[220:223], a[76:79]
    v_exp_f32 v242, v134
    v_mfma_f32_16x16x32_bf16 a[84:87], a[212:215], v[212:215], a[84:87]
    ds_read_b128 a[148:151], v2 offset:5120
    v_cvt_pk_bf16_f32 v196, v240, v241
    v_mfma_f32_16x16x32_bf16 a[88:91], a[212:215], v[216:219], a[88:91]
    v_exp_f32 v243, v135
    v_mfma_f32_16x16x32_bf16 a[92:95], a[212:215], v[220:223], a[92:95]
    s_waitcnt lgkmcnt(6)
    ds_read_b128 a[152:155], v2 offset:6144
    v_or3_b32 v57, v57, v195, v196
    v_cvt_pk_bf16_f32 v197, v242, v243
    v_mfma_f32_16x16x32_bf16 a[100:103], a[216:219], v[212:215], a[100:103]
    buffer_load_dwordx4 v1, s[20:23], s33 offen offset:3072 sc1 lds
    ds_read_b128 a[156:159], v2 offset:7168
    v_mfma_f32_16x16x32_bf16 a[104:107], a[216:219], v[216:219], a[104:107]
    s_add_u32 s33, s33, 0x80000
    v_exp_f32 v244, v148
    v_mfma_f32_16x16x32_bf16 a[108:111], a[216:219], v[220:223], a[108:111]
    v_exp_f32 v245, v149
    v_mfma_f32_16x16x32_bf16 a[116:119], a[220:223], v[212:215], a[116:119]
    ds_read_b128 a[160:163], v2 offset:8192
    s_cmp_ge_u32 s36, s43
    s_cbranch_scc1 k2_prep_106
k2_prepret_107:
    v_mfma_f32_16x16x32_bf16 a[120:123], a[220:223], v[216:219], a[120:123]
    v_exp_f32 v246, v150
    v_mfma_f32_16x16x32_bf16 a[124:127], a[220:223], v[220:223], a[124:127]
    s_waitcnt lgkmcnt(7)
    ds_read_b128 a[164:167], v2 offset:9216
    v_cvt_pk_bf16_f32 v198, v244, v245
    v_mfma_f32_16x16x32_bf16 v[160:163], a[128:131], v[96:99], v[16:19]
    s_waitcnt vmcnt(12)
    s_barrier
    v_exp_f32 v247, v151
    v_mfma_f32_16x16x32_bf16 v[160:163], a[132:135], v[100:103], v[160:163]
    s_waitcnt lgkmcnt(6)
    v_or3_b32 v57, v57, v197, v198
    v_cvt_pk_bf16_f32 v199, v246, v247
    v_mfma_f32_16x16x32_bf16 v[160:163], a[136:139], v[104:107], v[160:163]
    s_mov_b32 m0, s34
    ds_read_b128 a[168:171], v2 offset:10240
    v_exp_f32 v232, v136
    v_mfma_f32_16x16x32_bf16 v[160:163], a[140:143], v[108:111], v[160:163]
    s_add_u32 s36, s36, 64
    buffer_load_dwordx4 v1, s[16:19], s32 offen offset:0 sc1 lds
    ds_read_b128 a[172:175], v2 offset:11264
    v_mfma_f32_16x16x32_bf16 v[164:167], a[128:131], v[112:115], v[20:23]
    v_exp_f32 v233, v137
    v_mfma_f32_16x16x32_bf16 v[164:167], a[132:135], v[116:119], v[164:167]
    v_exp_f32 v234, v138
    v_mfma_f32_16x16x32_bf16 v[164:167], a[136:139], v[120:123], v[164:167]
    s_add_u32 s52, s52, 16384
    ds_read_b128 a[176:179], v2 offset:12288
    v_cvt_pk_bf16_f32 v200, v232, v233
    v_mfma_f32_16x16x32_bf16 v[164:167], a[140:143], v[124:127], v[164:167]
    s_waitcnt lgkmcnt(7)
    v_exp_f32 v235, v139
    v_or3_b32 v57, v57, v199, v200
    v_mfma_f32_16x16x32_bf16 v[176:179], a[144:147], v[96:99], v[32:35]
    s_add_u32 s34, s34, 0x4000
    ds_read_b128 a[180:183], v2 offset:13312
    v_cvt_pk_bf16_f32 v201, v234, v235
    v_mfma_f32_16x16x32_bf16 v[176:179], a[148:151], v[100:103], v[176:179]
    s_waitcnt lgkmcnt(6)
    v_exp_f32 v236, v152
    v_mfma_f32_16x16x32_bf16 v[176:179], a[152:155], v[104:107], v[176:179]
    s_and_b32 s52, s52, 0xffff
    buffer_load_dwordx4 v1, s[16:19], s32 offen offset:1024 sc1 lds
    ds_read_b128 a[184:187], v2 offset:14336
    v_mfma_f32_16x16x32_bf16 v[176:179], a[156:159], v[108:111], v[176:179]
    ds_read_b128 a[188:191], v2 offset:15360
    v_exp_f32 v237, v153
    v_mfma_f32_16x16x32_bf16 v[180:183], a[144:147], v[112:115], v[36:39]
    v_exp_f32 v238, v154
    v_mfma_f32_16x16x32_bf16 v[180:183], a[148:151], v[116:119], v[180:183]
    v_cvt_pk_bf16_f32 v202, v236, v237
    v_or3_b32 v57, v57, v201, v202
    v_mfma_f32_16x16x32_bf16 v[180:183], a[152:155], v[120:123], v[180:183]
    s_and_b32 s34, s34, 0xffff
    v_exp_f32 v239, v155
    v_mfma_f32_16x16x32_bf16 v[180:183], a[156:159], v[124:127], v[180:183]
    s_waitcnt lgkmcnt(6)
    v_add_u32 v2, s52, v1
    v_cvt_pk_bf16_f32 v203, v238, v239
    v_mfma_f32_16x16x32_bf16 v[168:171], a[160:163], v[96:99], v[24:27]
    ds_read_b128 a[192:195], v3 offset:0
    v_exp_f32 v240, v140
    v_mfma_f32_16x16x32_bf16 v[168:171], a[164:167], v[100:103], v[168:171]
    s_waitcnt lgkmcnt(5)
    v_exp_f32 v241, v141
    v_mfma_f32_16x16x32_bf16 v[168:171], a[168:171], v[104:107], v[168:171]
    buffer_load_dwordx4 v1, s[16:19], s32 offen offset:2048 sc1 lds
    ds_read_b128 a[196:199], v3 offset:8192
    v_mfma_f32_16x16x32_bf16 v[168:171], a[172:175], v[108:111], v[168:171]
    v_exp_f32 v242, v142
    v_mfma_f32_16x16x32_bf16 v[172:175], a[160:163], v[112:115], v[28:31]
    ds_read_b128 a[200:203], v3 offset:1024
    v_cvt_pk_bf16_f32 v204, v240, v241
    v_or3_b32 v57, v57, v203, v204
    v_mfma_f32_16x16x32_bf16 v[172:175], a[164:167], v[116:119], v[172:175]
    v_exp_f32 v243, v143
    v_mfma_f32_16x16x32_bf16 v[172:175], a[168:171], v[120:123], v[172:175]
    ds_read_b128 a[204:207], v3 offset:9216
    v_cvt_pk_bf16_f32 v205, v242, v243
    v_mfma_f32_16x16x32_bf16 v[172:175], a[172:175], v[124:127], v[172:175]
    s_waitcnt lgkmcnt(6)
    v_exp_f32 v244, v156
    v_mfma_f32_16x16x32_bf16 v[184:187], a[176:179], v[96:99], v[40:43]
    v_exp_f32 v245, v157
    v_mfma_f32_16x16x32_bf16 v[184:187], a[180:183], v[100:103], v[184:187]
    s_waitcnt lgkmcnt(4)
    buffer_load_dwordx4 v1, s[16:19], s32 offen offset:3072 sc1 lds
    ds_read_b128 a[208:211], v3 offset:2048
    ds_read_b128 a[212:215], v3 offset:10240
    v_mfma_f32_16x16x32_bf16 v[184:187], a[184:187], v[104:107], v[184:187]
    s_add_u32 s32, s32, 0x80000
    v_exp_f32 v246, v158
    v_mfma_f32_16x16x32_bf16 v[184:187], a[188:191], v[108:111], v[184:187]
    v_cvt_pk_bf16_f32 v206, v244, v245
    v_or3_b32 v57, v57, v205, v206
    v_mfma_f32_16x16x32_bf16 v[188:191], a[176:179], v[112:115], v[44:47]
    v_exp_f32 v247, v159
    v_mfma_f32_16x16x32_bf16 v[188:191], a[180:183], v[116:119], v[188:191]
    ds_read_b128 a[216:219], v3 offset:3072
    ds_read_b128 a[220:223], v3 offset:11264
    v_cvt_pk_bf16_f32 v207, v246, v247
    v_mfma_f32_16x16x32_bf16 v[188:191], a[184:187], v[120:123], v[188:191]
    v_bitop3_b32 v57, v57, v207, s37 bitop3:0xa8
    v_cmp_ne_u32 vcc, 0, v57
    v_mfma_f32_16x16x32_bf16 v[188:191], a[188:191], v[124:127], v[188:191]
    s_cbranch_vccnz k2_tramp_108
k2_ret_109:
    s_load_dwordx2 s[4:5], s[0:1], 40
    s_add_u32 s24, s6, 0x3000000
    s_addc_u32 s25, s7, 0
    s_and_b32 s25, s25, 0xffff
    s_mov_b32 s26, 0x1000000
    s_mov_b32 s27, 0x00020000
    s_lshl_b32 s31, s28, 19
    s_lshl_b32 s44, s38, 6
    s_add_u32 s44, s44, s31
    s_add_u32 s45, s44, 131072
    s_add_u32 s46, s44, 262144
    s_add_u32 s47, s44, 393216
    s_add_u32 s48, s44, 4096
    s_add_u32 s49, s44, 135168
    s_add_u32 s50, s44, 266240
    s_add_u32 s51, s44, 397312
    v_mov_b32 v13, v12
    v_mov_b32 v49, v48
    s_nop 1
    v_permlane16_swap_b32 v12, v13
    v_permlane16_swap_b32 v48, v49
    s_nop 1
    v_add_f32 v12, v12, v13
    v_add_f32 v48, v48, v49
    v_mov_b32 v13, v12
    v_mov_b32 v49, v48
    s_nop 1
    v_permlane32_swap_b32 v12, v13
    v_permlane32_swap_b32 v48, v49
    s_nop 1
    v_add_f32 v12, v12, v13
    v_add_f32 v48, v48, v49
    v_rcp_f32 v13, v12
    v_rcp_f32 v49, v48
    v_rcp_f32 v12, v12
    v_rcp_f32 v48, v48
    s_nop 0
    v_accvgpr_read_b32 v68, a0
    v_accvgpr_read_b32 v69, a1
    v_accvgpr_read_b32 v70, a2
    v_accvgpr_read_b32 v71, a3
    v_accvgpr_read_b32 v72, a16
    v_accvgpr_read_b32 v73, a17
    v_accvgpr_read_b32 v74, a18
    v_accvgpr_read_b32 v75, a19
    v_pk_mul_f32 v[68:69], v[68:69], v[12:13]
    v_pk_mul_f32 v[70:71], v[70:71], v[12:13]
    v_pk_mul_f32 v[72:73], v[72:73], v[12:13]
    v_pk_mul_f32 v[74:75], v[74:75], v[12:13]
    v_cvt_pk_bf16_f32 v64, v68, v69
    v_cvt_pk_bf16_f32 v65, v70, v71
    v_cvt_pk_bf16_f32 v66, v72, v73
    v_cvt_pk_bf16_f32 v67, v74, v75
    buffer_store_dwordx4 v[64:67], v1, s[24:27], s44 offen sc1
    v_accvgpr_read_b32 v80, a32
    v_accvgpr_read_b32 v81, a33
    v_accvgpr_read_b32 v82, a34
    v_accvgpr_read_b32 v83, a35
    v_accvgpr_read_b32 v84, a48
    v_accvgpr_read_b32 v85, a49
    v_accvgpr_read_b32 v86, a50
    v_accvgpr_read_b32 v87, a51
    v_pk_mul_f32 v[80:81], v[80:81], v[12:13]
    v_pk_mul_f32 v[82:83], v[82:83], v[12:13]
    v_pk_mul_f32 v[84:85], v[84:85], v[12:13]
    v_pk_mul_f32 v[86:87], v[86:87], v[12:13]
    v_cvt_pk_bf16_f32 v76, v80, v81
    v_cvt_pk_bf16_f32 v77, v82, v83
    v_cvt_pk_bf16_f32 v78, v84, v85
    v_cvt_pk_bf16_f32 v79, v86, v87
    buffer_store_dwordx4 v[76:79], v1, s[24:27], s45 offen sc1
    v_accvgpr_read_b32 v68, a64
    v_accvgpr_read_b32 v69, a65
    v_accvgpr_read_b32 v70, a66
    v_accvgpr_read_b32 v71, a67
    v_accvgpr_read_b32 v72, a80
    v_accvgpr_read_b32 v73, a81
    v_accvgpr_read_b32 v74, a82
    v_accvgpr_read_b32 v75, a83
    v_pk_mul_f32 v[68:69], v[68:69], v[12:13]
    v_pk_mul_f32 v[70:71], v[70:71], v[12:13]
    v_pk_mul_f32 v[72:73], v[72:73], v[12:13]
    v_pk_mul_f32 v[74:75], v[74:75], v[12:13]
    v_cvt_pk_bf16_f32 v64, v68, v69
    v_cvt_pk_bf16_f32 v65, v70, v71
    v_cvt_pk_bf16_f32 v66, v72, v73
    v_cvt_pk_bf16_f32 v67, v74, v75
    buffer_store_dwordx4 v[64:67], v1, s[24:27], s46 offen sc1
    v_accvgpr_read_b32 v80, a96
    v_accvgpr_read_b32 v81, a97
    v_accvgpr_read_b32 v82, a98
    v_accvgpr_read_b32 v83, a99
    v_accvgpr_read_b32 v84, a112
    v_accvgpr_read_b32 v85, a113
    v_accvgpr_read_b32 v86, a114
    v_accvgpr_read_b32 v87, a115
    v_pk_mul_f32 v[80:81], v[80:81], v[12:13]
    v_pk_mul_f32 v[82:83], v[82:83], v[12:13]
    v_pk_mul_f32 v[84:85], v[84:85], v[12:13]
    v_pk_mul_f32 v[86:87], v[86:87], v[12:13]
    v_cvt_pk_bf16_f32 v76, v80, v81
    v_cvt_pk_bf16_f32 v77, v82, v83
    v_cvt_pk_bf16_f32 v78, v84, v85
    v_cvt_pk_bf16_f32 v79, v86, v87
    buffer_store_dwordx4 v[76:79], v1, s[24:27], s47 offen sc1
    v_accvgpr_read_b32 v68, a4
    v_accvgpr_read_b32 v69, a5
    v_accvgpr_read_b32 v70, a6
    v_accvgpr_read_b32 v71, a7
    v_accvgpr_read_b32 v72, a20
    v_accvgpr_read_b32 v73, a21
    v_accvgpr_read_b32 v74, a22
    v_accvgpr_read_b32 v75, a23
    v_pk_mul_f32 v[68:69], v[68:69], v[48:49]
    v_pk_mul_f32 v[70:71], v[70:71], v[48:49]
    v_pk_mul_f32 v[72:73], v[72:73], v[48:49]
    v_pk_mul_f32 v[74:75], v[74:75], v[48:49]
    v_cvt_pk_bf16_f32 v64, v68, v69
    v_cvt_pk_bf16_f32 v65, v70, v71
    v_cvt_pk_bf16_f32 v66, v72, v73
    v_cvt_pk_bf16_f32 v67, v74, v75
    buffer_store_dwordx4 v[64:67], v1, s[24:27], s48 offen sc1
    v_accvgpr_read_b32 v80, a36
    v_accvgpr_read_b32 v81, a37
    v_accvgpr_read_b32 v82, a38
    v_accvgpr_read_b32 v83, a39
    v_accvgpr_read_b32 v84, a52
    v_accvgpr_read_b32 v85, a53
    v_accvgpr_read_b32 v86, a54
    v_accvgpr_read_b32 v87, a55
    v_pk_mul_f32 v[80:81], v[80:81], v[48:49]
    v_pk_mul_f32 v[82:83], v[82:83], v[48:49]
    v_pk_mul_f32 v[84:85], v[84:85], v[48:49]
    v_pk_mul_f32 v[86:87], v[86:87], v[48:49]
    v_cvt_pk_bf16_f32 v76, v80, v81
    v_cvt_pk_bf16_f32 v77, v82, v83
    v_cvt_pk_bf16_f32 v78, v84, v85
    v_cvt_pk_bf16_f32 v79, v86, v87
    buffer_store_dwordx4 v[76:79], v1, s[24:27], s49 offen sc1
    v_accvgpr_read_b32 v68, a68
    v_accvgpr_read_b32 v69, a69
    v_accvgpr_read_b32 v70, a70
    v_accvgpr_read_b32 v71, a71
    v_accvgpr_read_b32 v72, a84
    v_accvgpr_read_b32 v73, a85
    v_accvgpr_read_b32 v74, a86
    v_accvgpr_read_b32 v75, a87
    v_pk_mul_f32 v[68:69], v[68:69], v[48:49]
    v_pk_mul_f32 v[70:71], v[70:71], v[48:49]
    v_pk_mul_f32 v[72:73], v[72:73], v[48:49]
    v_pk_mul_f32 v[74:75], v[74:75], v[48:49]
    v_cvt_pk_bf16_f32 v64, v68, v69
    v_cvt_pk_bf16_f32 v65, v70, v71
    v_cvt_pk_bf16_f32 v66, v72, v73
    v_cvt_pk_bf16_f32 v67, v74, v75
    buffer_store_dwordx4 v[64:67], v1, s[24:27], s50 offen sc1
    v_accvgpr_read_b32 v80, a100
    v_accvgpr_read_b32 v81, a101
    v_accvgpr_read_b32 v82, a102
    v_accvgpr_read_b32 v83, a103
    v_accvgpr_read_b32 v84, a116
    v_accvgpr_read_b32 v85, a117
    v_accvgpr_read_b32 v86, a118
    v_accvgpr_read_b32 v87, a119
    v_pk_mul_f32 v[80:81], v[80:81], v[48:49]
    v_pk_mul_f32 v[82:83], v[82:83], v[48:49]
    v_pk_mul_f32 v[84:85], v[84:85], v[48:49]
    v_pk_mul_f32 v[86:87], v[86:87], v[48:49]
    v_cvt_pk_bf16_f32 v76, v80, v81
    v_cvt_pk_bf16_f32 v77, v82, v83
    v_cvt_pk_bf16_f32 v78, v84, v85
    v_cvt_pk_bf16_f32 v79, v86, v87
    buffer_store_dwordx4 v[76:79], v1, s[24:27], s51 offen sc1
    s_nop 1
    s_lshr_b32 s31, s2, 3
    s_bfe_u32 s56, s2, 0x10002
    s_and_b32 s54, s2, 1
    s_lshl_b32 s54, s54, 3
    s_and_b32 s55, s31, 7
    s_add_u32 s54, s54, s55
    s_and_b32 s55, s2, 2
    s_lshl_b32 s55, s55, 1
    s_lshr_b32 s31, s31, 3
    s_add_u32 s55, s55, s31
    v_lshrrev_b32 v87, 4, v1
    v_lshrrev_b32 v72, 4, v87
    s_lshl_b32 s57, s54, 7
    s_lshl_b32 s31, s30, 5
    s_add_u32 s57, s57, s31
    s_lshl_b32 s31, s57, 6
    v_add_u32 v88, s31, v1
    v_add_u32 v89, 0x20000, v88
    v_bfe_u32 v84, v87, 1, 3
    v_xor_b32 v84, v84, v72
    v_and_b32 v85, 16, v1
    v_lshl_add_u32 v85, v72, 11, v85
    s_lshl_b32 s31, s30, 15
    s_lshl_b32 s58, s55, 8
    s_add_u32 s31, s31, s58
    v_add_u32 v85, s31, v85
    v_xor_b32 v86, 0, v84
    v_lshl_add_u32 v86, v86, 5, v85
    v_add_u32 v90, 0, v86
    v_xor_b32 v86, 4, v84
    v_lshl_add_u32 v86, v86, 5, v85
    v_add_u32 v91, 7168, v86
    v_xor_b32 v86, 0, v84
    v_lshl_add_u32 v86, v86, 5, v85
    v_add_u32 v92, 14336, v86
    v_xor_b32 v86, 4, v84
    v_lshl_add_u32 v86, v86, 5, v85
    v_add_u32 v93, 21504, v86
    v_and_b32 v84, 15, v87
    v_add_u32 v85, s57, v84
    v_lshlrev_b32 v77, 2, v85
    v_lshl_add_u32 v77, v72, 13, v77
    s_lshl_b32 s31, s56, 7
    s_add_u32 s58, s58, s31
    v_lshl_add_u32 v80, v72, 3, s58
    v_lshl_add_u32 v78, v85, 11, v80
    v_add_u32 v79, 0x8000, v78
    v_lshrrev_b32 v85, 2, v84
    v_lshl_add_u32 v85, v72, 2, v85
    v_and_b32 v84, 7, v85
    s_lshl_b32 s31, s56, 2
    v_xor_b32 v84, s31, v84
    v_lshlrev_b32 v85, 8, v85
    v_and_b32 v86, 3, v87
    v_lshl_add_u32 v85, v86, 3, v85
    s_add_u32 s31, s2, 1
    s_and_b32 s31, s31, 3
    v_add_u32 v73, s31, v86
    v_and_b32 v73, 3, v73
    v_lshlrev_b32 v73, 7, v73
    v_xor_b32 v86, 0, v84
    v_lshl_add_u32 v64, v86, 5, v85
    v_xor_b32 v86, 1, v84
    v_lshl_add_u32 v65, v86, 5, v85
    v_xor_b32 v86, 2, v84
    v_lshl_add_u32 v66, v86, 5, v85
    v_xor_b32 v86, 3, v84
    v_lshl_add_u32 v67, v86, 5, v85
    v_xor_b32 v86, 4, v84
    v_lshl_add_u32 v68, v86, 5, v85
    v_xor_b32 v86, 5, v84
    v_lshl_add_u32 v69, v86, 5, v85
    v_xor_b32 v86, 6, v84
    v_lshl_add_u32 v70, v86, 5, v85
    v_xor_b32 v86, 7, v84
    v_lshl_add_u32 v71, v86, 5, v85
    s_lshl_b32 s61, s31, 20
    s_lshl_b32 s62, s31, 21
    s_lshl_b32 s60, s30, 12
    s_lshl_b32 s59, s54, 10
    s_lshl_b32 s31, s56, 9
    s_add_u32 s59, s59, s31
    s_lshr_b32 s31, s28, 2
    s_lshl_b32 s31, s31, 7
    s_lshl_b32 s57, s29, 10
    s_sub_u32 s58, 0x3c00, s57
    s_add_u32 s57, s57, s31
    s_add_u32 s58, s58, s31
    v_mov_b32 v75, 0
    v_mov_b32 v76, 1
    s_lshl_b32 s31, s56, 23
    s_add_u32 s31, s31, 0x3000000
    s_add_u32 s8, s6, s31
    s_addc_u32 s9, s7, 0
    s_and_b32 s9, s9, 0xffff
    s_mov_b32 s10, 0x800000
    s_lshl_b32 s31, s56, 22
    s_waitcnt lgkmcnt(0)
    s_add_u32 s12, s4, s31
    s_addc_u32 s13, s5, 0
    s_and_b32 s13, s13, 0xffff
    s_mov_b32 s14, 0x400000
    s_load_dwordx2 s[4:5], s[0:1], 80
    v_mov_b32 v12, -1
    v_mov_b32 v13, -1
    v_mov_b32 v14, -1
    v_mov_b32 v15, -1
    s_waitcnt lgkmcnt(0)
    s_mov_b32 s26, -1
    s_lshl_b32 s31, s2, 14
    s_add_u32 s31, s31, s60
    s_add_u32 s40, s31, 0x2000000
    buffer_store_dwordx4 v[12:15], v1, s[24:27], s40 offen offset:0 sc1
    buffer_store_dwordx4 v[12:15], v1, s[24:27], s40 offen offset:1024 sc1
    buffer_store_dwordx4 v[12:15], v1, s[24:27], s40 offen offset:2048 sc1
    buffer_store_dwordx4 v[12:15], v1, s[24:27], s40 offen offset:3072 sc1
    s_lshr_b32 s31, s31, 1
    s_add_u32 s40, s31, 0x1900000
    buffer_store_dwordx4 v[12:15], v1, s[24:27], s40 offen offset:0 sc1
    buffer_store_dwordx4 v[12:15], v1, s[24:27], s40 offen offset:1024 sc1
    s_mov_b32 s26, 0x1000000
    s_and_b32 s31, s2, 7
    s_mul_i32 s31, s31, 28
    s_lshr_b32 s40, s2, 3
    s_add_u32 s31, s31, s40
    s_lshl_b32 s31, s31, 15
    s_lshl_b32 s40, s30, 13
    s_add_u32 s31, s31, s40
    s_mov_b32 s44, s4
    s_mov_b32 s47, 0x00020000
    s_and_b32 s45, s5, 0xffff
    s_cmp_ge_u32 s2, 224
    s_cselect_b32 s46, 0, 7340032
    s_add_u32 m0, s40, 131072
    s_nop 0
    buffer_load_dwordx4 v1, s[44:47], s31 offen offset:0 lds
    buffer_load_dwordx4 v1, s[44:47], s31 offen offset:1024 lds
    buffer_load_dwordx4 v1, s[44:47], s31 offen offset:2048 lds
    buffer_load_dwordx4 v1, s[44:47], s31 offen offset:3072 lds
    s_add_u32 s31, s31, 4096
    s_add_u32 m0, s40, 135168
    s_nop 0
    buffer_load_dwordx4 v1, s[44:47], s31 offen offset:0 lds
    buffer_load_dwordx4 v1, s[44:47], s31 offen offset:1024 lds
    buffer_load_dwordx4 v1, s[44:47], s31 offen offset:2048 lds
    buffer_load_dwordx4 v1, s[44:47], s31 offen offset:3072 lds
    s_add_u32 s31, s31, 4096
    s_lshl_b32 s63, s29, 1
    s_sub_u32 s63, 13, s63
    s_cbranch_scc1 k2_sdone_111
k2_sloop_110:
    v_mfma_f32_16x16x32_bf16 v[248:251], v[60:63], v[192:195], v[248:251]
    v_exp_f32 v232, v160
    v_mfma_f32_16x16x32_bf16 v[248:251], v[60:63], v[200:203], v[248:251]
    s_mov_b32 m0, s35
    ds_read_b128 a[224:227], v3 offset:4096
    v_mfma_f32_16x16x32_bf16 v[252:255], v[60:63], v[196:199], v[252:255]
    s_add_u32 s53, s53, 16384
    buffer_load_dwordx4 v1, s[20:23], s33 offen offset:0 sc1 lds
    ds_read_b128 a[228:231], v3 offset:12288
    v_mfma_f32_16x16x32_bf16 v[252:255], v[60:63], v[204:207], v[252:255]
    s_waitcnt lgkmcnt(8)
    v_exp_f32 v233, v161
    v_mfma_f32_16x16x32_bf16 a[8:11], a[192:195], v[192:195], a[8:11]
    s_and_b32 s53, s53, 0xffff
    v_exp_f32 v234, v162
    v_mfma_f32_16x16x32_bf16 a[8:11], a[196:199], v[200:203], a[8:11]
    ds_read_b128 a[232:235], v3 offset:5120
    v_cvt_pk_bf16_f32 v208, v232, v233
    v_mfma_f32_16x16x32_bf16 a[12:15], a[192:195], v[196:199], a[12:15]
    v_exp_f32 v235, v163
    v_mfma_f32_16x16x32_bf16 a[12:15], a[196:199], v[204:207], a[12:15]
    s_waitcnt lgkmcnt(7)
    ds_read_b128 a[236:239], v3 offset:13312
    v_cvt_pk_bf16_f32 v209, v234, v235
    v_mfma_f32_16x16x32_bf16 a[24:27], a[200:203], v[192:195], a[24:27]
    s_add_u32 s35, s35, 0x4000
    v_exp_f32 v236, v176
    v_mfma_f32_16x16x32_bf16 a[24:27], a[204:207], v[200:203], a[24:27]
    buffer_load_dwordx4 v1, s[20:23], s33 offen offset:1024 sc1 lds
    ds_read_b128 a[240:243], v3 offset:6144
    v_mfma_f32_16x16x32_bf16 a[28:31], a[200:203], v[196:199], a[28:31]
    v_exp_f32 v237, v177
    v_mfma_f32_16x16x32_bf16 a[28:31], a[204:207], v[204:207], a[28:31]
    s_waitcnt lgkmcnt(7)
    ds_read_b128 a[244:247], v3 offset:14336
    v_cvt_pk_bf16_f32 v210, v236, v237
    v_mfma_f32_16x16x32_bf16 a[40:43], a[208:211], v[192:195], a[40:43]
    v_exp_f32 v238, v178
    v_mfma_f32_16x16x32_bf16 a[40:43], a[212:215], v[200:203], a[40:43]
    ds_read_b128 a[248:251], v3 offset:7168
    v_or3_b32 v57, v208, v209, v210
    v_mfma_f32_16x16x32_bf16 a[44:47], a[208:211], v[196:199], a[44:47]
    v_exp_f32 v239, v179
    v_mfma_f32_16x16x32_bf16 a[44:47], a[212:215], v[204:207], a[44:47]
    s_waitcnt lgkmcnt(7)
    ds_read_b128 a[252:255], v3 offset:15360
    v_cvt_pk_bf16_f32 v211, v238, v239
    v_mfma_f32_16x16x32_bf16 a[56:59], a[216:219], v[192:195], a[56:59]
    s_and_b32 s35, s35, 0xffff
    v_exp_f32 v240, v164
    v_mfma_f32_16x16x32_bf16 a[56:59], a[220:223], v[200:203], a[56:59]
    ds_read_b128 a[128:131], v2 offset:0
    v_add_u32 v3, s53, v56
    v_mfma_f32_16x16x32_bf16 a[60:63], a[216:219], v[196:199], a[60:63]
    v_exp_f32 v241, v165
    v_mfma_f32_16x16x32_bf16 a[60:63], a[220:223], v[204:207], a[60:63]
    s_waitcnt lgkmcnt(7)
    buffer_load_dwordx4 v1, s[20:23], s33 offen offset:2048 sc1 lds
    ds_read_b128 a[132:135], v2 offset:1024
    v_mfma_f32_16x16x32_bf16 a[72:75], a[224:227], v[192:195], a[72:75]
    v_exp_f32 v242, v166
    v_mfma_f32_16x16x32_bf16 a[72:75], a[228:231], v[200:203], a[72:75]
    s_or_b32 s35, s35, 0x10000
    ds_read_b128 a[136:139], v2 offset:2048
    v_cvt_pk_bf16_f32 v212, v240, v241
    v_mfma_f32_16x16x32_bf16 a[76:79], a[224:227], v[196:199], a[76:79]
    v_exp_f32 v243, v167
    v_mfma_f32_16x16x32_bf16 a[76:79], a[228:231], v[204:207], a[76:79]
    s_waitcnt lgkmcnt(7)
    ds_read_b128 a[140:143], v2 offset:3072
    v_or3_b32 v57, v57, v211, v212
    v_mfma_f32_16x16x32_bf16 a[88:91], a[232:235], v[192:195], a[88:91]
    v_exp_f32 v244, v180
    v_mfma_f32_16x16x32_bf16 a[88:91], a[236:239], v[200:203], a[88:91]
    ds_read_b128 a[144:147], v2 offset:4096
    v_cvt_pk_bf16_f32 v213, v242, v243
    v_mfma_f32_16x16x32_bf16 a[92:95], a[232:235], v[196:199], a[92:95]
    v_exp_f32 v245, v181
    v_mfma_f32_16x16x32_bf16 a[92:95], a[236:239], v[204:207], a[92:95]
    s_waitcnt lgkmcnt(7)
    buffer_load_dwordx4 v1, s[20:23], s33 offen offset:3072 sc1 lds
    ds_read_b128 a[148:151], v2 offset:5120
    v_mfma_f32_16x16x32_bf16 a[104:107], a[240:243], v[192:195], a[104:107]
    s_add_u32 s33, s33, 0x80000
    v_exp_f32 v246, v182
    v_mfma_f32_16x16x32_bf16 a[104:107], a[244:247], v[200:203], a[104:107]
    ds_read_b128 a[152:155], v2 offset:6144
    v_cvt_pk_bf16_f32 v214, v244, v245
    v_mfma_f32_16x16x32_bf16 a[108:111], a[240:243], v[196:199], a[108:111]
    v_exp_f32 v247, v183
    v_mfma_f32_16x16x32_bf16 a[108:111], a[244:247], v[204:207], a[108:111]
    s_waitcnt lgkmcnt(7)
    ds_read_b128 a[156:159], v2 offset:7168
    v_or3_b32 v57, v57, v213, v214
    v_mfma_f32_16x16x32_bf16 a[120:123], a[248:251], v[192:195], a[120:123]
    v_exp_f32 v232, v168
    v_mfma_f32_16x16x32_bf16 a[120:123], a[252:255], v[200:203], a[120:123]
    ds_read_b128 a[160:163], v2 offset:8192
    v_cvt_pk_bf16_f32 v215, v246, v247
    v_mfma_f32_16x16x32_bf16 a[124:127], a[248:251], v[196:199], a[124:127]
    v_exp_f32 v233, v169
    v_mfma_f32_16x16x32_bf16 a[124:127], a[252:255], v[204:207], a[124:127]
    s_waitcnt lgkmcnt(7)
    ds_read_b128 a[164:167], v2 offset:9216
    v_cvt_pk_bf16_f32 v216, v232, v233
    v_mfma_f32_16x16x32_bf16 v[128:131], a[128:131], v[96:99], v[16:19]
    s_waitcnt vmcnt(12)
    s_barrier
    v_exp_f32 v234, v170
    v_mfma_f32_16x16x32_bf16 v[128:131], a[132:135], v[100:103], v[128:131]
    s_waitcnt lgkmcnt(6)
    ds_read_b128 a[168:171], v2 offset:10240
    v_or3_b32 v57, v57, v215, v216
    v_mfma_f32_16x16x32_bf16 v[128:131], a[136:139], v[104:107], v[128:131]
    s_mov_b32 m0, s34
    v_exp_f32 v235, v171
    v_mfma_f32_16x16x32_bf16 v[128:131], a[140:143], v[108:111], v[128:131]
    s_add_u32 s36, s36, 64
    buffer_load_dwordx4 v1, s[16:19], s32 offen offset:0 sc1 lds
    ds_read_b128 a[172:175], v2 offset:11264
    v_mfma_f32_16x16x32_bf16 v[132:135], a[128:131], v[112:115], v[20:23]
    v_exp_f32 v236, v184
    v_mfma_f32_16x16x32_bf16 v[132:135], a[132:135], v[116:119], v[132:135]
    ds_read_b128 a[176:179], v2 offset:12288
    v_cvt_pk_bf16_f32 v217, v234, v235
    v_mfma_f32_16x16x32_bf16 v[132:135], a[136:139], v[120:123], v[132:135]
    s_add_u32 s52, s52, 16384
    v_exp_f32 v237, v185
    v_mfma_f32_16x16x32_bf16 v[132:135], a[140:143], v[124:127], v[132:135]
    s_waitcnt lgkmcnt(7)
    ds_read_b128 a[180:183], v2 offset:13312
    v_cvt_pk_bf16_f32 v218, v236, v237
    v_mfma_f32_16x16x32_bf16 v[144:147], a[144:147], v[96:99], v[32:35]
    s_add_u32 s34, s34, 0x4000
    v_exp_f32 v238, v186
    v_mfma_f32_16x16x32_bf16 v[144:147], a[148:151], v[100:103], v[144:147]
    s_waitcnt lgkmcnt(6)
    buffer_load_dwordx4 v1, s[16:19], s32 offen offset:1024 sc1 lds
    ds_read_b128 a[184:187], v2 offset:14336
    v_mfma_f32_16x16x32_bf16 v[144:147], a[152:155], v[104:107], v[144:147]
    s_and_b32 s52, s52, 0xffff
    v_exp_f32 v239, v187
    v_mfma_f32_16x16x32_bf16 v[144:147], a[156:159], v[108:111], v[144:147]
    ds_read_b128 a[188:191], v2 offset:15360
    v_or3_b32 v57, v57, v217, v218
    v_mfma_f32_16x16x32_bf16 v[148:151], a[144:147], v[112:115], v[36:39]
    v_exp_f32 v240, v172
    v_mfma_f32_16x16x32_bf16 v[148:151], a[148:151], v[116:119], v[148:151]
    v_cvt_pk_bf16_f32 v219, v238, v239
    v_add_u32 v2, s52, v1
    v_mfma_f32_16x16x32_bf16 v[148:151], a[152:155], v[120:123], v[148:151]
    s_and_b32 s34, s34, 0xffff
    v_exp_f32 v241, v173
    v_mfma_f32_16x16x32_bf16 v[148:151], a[156:159], v[124:127], v[148:151]
    s_waitcnt lgkmcnt(6)
    ds_read_b128 a[192:195], v3 offset:0
    v_cvt_pk_bf16_f32 v220, v240, v241
    v_mfma_f32_16x16x32_bf16 v[136:139], a[160:163], v[96:99], v[24:27]
    v_exp_f32 v242, v174
    v_mfma_f32_16x16x32_bf16 v[136:139], a[164:167], v[100:103], v[136:139]
    s_waitcnt lgkmcnt(5)
    buffer_load_dwordx4 v1, s[16:19], s32 offen offset:2048 sc1 lds
    ds_read_b128 a[196:199], v3 offset:8192
    v_mfma_f32_16x16x32_bf16 v[136:139], a[168:171], v[104:107], v[136:139]
    v_exp_f32 v243, v175
    v_mfma_f32_16x16x32_bf16 v[136:139], a[172:175], v[108:111], v[136:139]
    ds_read_b128 a[200:203], v3 offset:1024
    v_or3_b32 v57, v57, v219, v220
    v_mfma_f32_16x16x32_bf16 v[140:143], a[160:163], v[112:115], v[28:31]
    v_exp_f32 v244, v188
    v_mfma_f32_16x16x32_bf16 v[140:143], a[164:167], v[116:119], v[140:143]
    ds_read_b128 a[204:207], v3 offset:9216
    v_cvt_pk_bf16_f32 v221, v242, v243
    v_mfma_f32_16x16x32_bf16 v[140:143], a[168:171], v[120:123], v[140:143]
    v_exp_f32 v245, v189
    v_mfma_f32_16x16x32_bf16 v[140:143], a[172:175], v[124:127], v[140:143]
    s_waitcnt lgkmcnt(6)
    buffer_load_dwordx4 v1, s[16:19], s32 offen offset:3072 sc1 lds
    ds_read_b128 a[208:211], v3 offset:2048
    v_mfma_f32_16x16x32_bf16 v[152:155], a[176:179], v[96:99], v[40:43]
    s_add_u32 s32, s32, 0x80000
    v_exp_f32 v246, v190
    v_mfma_f32_16x16x32_bf16 v[152:155], a[180:183], v[100:103], v[152:155]
    s_waitcnt lgkmcnt(5)
    ds_read_b128 a[212:215], v3 offset:10240
    v_cvt_pk_bf16_f32 v222, v244, v245
    v_mfma_f32_16x16x32_bf16 v[152:155], a[184:187], v[104:107], v[152:155]
    v_exp_f32 v247, v191
    v_mfma_f32_16x16x32_bf16 v[152:155], a[188:191], v[108:111], v[152:155]
    ds_read_b128 a[216:219], v3 offset:3072
    v_or3_b32 v57, v57, v221, v222
    v_mfma_f32_16x16x32_bf16 v[156:159], a[176:179], v[112:115], v[44:47]
    ds_read_b128 a[220:223], v3 offset:11264
    v_cvt_pk_bf16_f32 v223, v246, v247
    v_mfma_f32_16x16x32_bf16 v[156:159], a[180:183], v[116:119], v[156:159]
    v_bitop3_b32 v57, v57, v223, s37 bitop3:0xa8
    v_cmp_ne_u32 vcc, 0, v57
    v_mfma_f32_16x16x32_bf16 v[156:159], a[184:187], v[120:123], v[156:159]
    v_mfma_f32_16x16x32_bf16 v[156:159], a[188:191], v[124:127], v[156:159]
    s_cbranch_vccnz k2_tramp_112
k2_ret_113:
    v_mfma_f32_16x16x32_bf16 v[248:251], v[60:63], v[208:211], v[248:251]
    v_exp_f32 v232, v128
    v_mfma_f32_16x16x32_bf16 v[248:251], v[60:63], v[216:219], v[248:251]
    s_mov_b32 m0, s35
    ds_read_b128 a[224:227], v3 offset:4096
    v_mfma_f32_16x16x32_bf16 v[252:255], v[60:63], v[212:215], v[252:255]
    s_add_u32 s53, s53, 16384
    buffer_load_dwordx4 v1, s[20:23], s33 offen offset:0 sc1 lds
    ds_read_b128 a[228:231], v3 offset:12288
    v_mfma_f32_16x16x32_bf16 v[252:255], v[60:63], v[220:223], v[252:255]
    s_waitcnt lgkmcnt(8)
    v_exp_f32 v233, v129
    v_mfma_f32_16x16x32_bf16 a[8:11], a[192:195], v[208:211], a[8:11]
    s_and_b32 s53, s53, 0xffff
    v_exp_f32 v234, v130
    v_mfma_f32_16x16x32_bf16 a[8:11], a[196:199], v[216:219], a[8:11]
    ds_read_b128 a[232:235], v3 offset:5120
    v_cvt_pk_bf16_f32 v192, v232, v233
    v_mfma_f32_16x16x32_bf16 a[12:15], a[192:195], v[212:215], a[12:15]
    v_exp_f32 v235, v131
    v_mfma_f32_16x16x32_bf16 a[12:15], a[196:199], v[220:223], a[12:15]
    s_waitcnt lgkmcnt(7)
    ds_read_b128 a[236:239], v3 offset:13312
    v_cvt_pk_bf16_f32 v193, v234, v235
    v_mfma_f32_16x16x32_bf16 a[24:27], a[200:203], v[208:211], a[24:27]
    s_add_u32 s35, s35, 0x4000
    v_exp_f32 v236, v144
    v_mfma_f32_16x16x32_bf16 a[24:27], a[204:207], v[216:219], a[24:27]
    buffer_load_dwordx4 v1, s[20:23], s33 offen offset:1024 sc1 lds
    ds_read_b128 a[240:243], v3 offset:6144
    v_mfma_f32_16x16x32_bf16 a[28:31], a[200:203], v[212:215], a[28:31]
    v_exp_f32 v237, v145
    v_mfma_f32_16x16x32_bf16 a[28:31], a[204:207], v[220:223], a[28:31]
    s_waitcnt lgkmcnt(7)
    ds_read_b128 a[244:247], v3 offset:14336
    v_cvt_pk_bf16_f32 v194, v236, v237
    v_mfma_f32_16x16x32_bf16 a[40:43], a[208:211], v[208:211], a[40:43]
    v_exp_f32 v238, v146
    v_mfma_f32_16x16x32_bf16 a[40:43], a[212:215], v[216:219], a[40:43]
    ds_read_b128 a[248:251], v3 offset:7168
    v_or3_b32 v57, v192, v193, v194
    v_mfma_f32_16x16x32_bf16 a[44:47], a[208:211], v[212:215], a[44:47]
    v_exp_f32 v239, v147
    v_mfma_f32_16x16x32_bf16 a[44:47], a[212:215], v[220:223], a[44:47]
    s_waitcnt lgkmcnt(7)
    ds_read_b128 a[252:255], v3 offset:15360
    v_cvt_pk_bf16_f32 v195, v238, v239
    v_mfma_f32_16x16x32_bf16 a[56:59], a[216:219], v[208:211], a[56:59]
    s_and_b32 s35, s35, 0xffff
    v_exp_f32 v240, v132
    v_mfma_f32_16x16x32_bf16 a[56:59], a[220:223], v[216:219], a[56:59]
    ds_read_b128 a[128:131], v2 offset:0
    v_add_u32 v3, s53, v56
    v_mfma_f32_16x16x32_bf16 a[60:63], a[216:219], v[212:215], a[60:63]
    v_exp_f32 v241, v133
    v_mfma_f32_16x16x32_bf16 a[60:63], a[220:223], v[220:223], a[60:63]
    s_waitcnt lgkmcnt(7)
    buffer_load_dwordx4 v1, s[20:23], s33 offen offset:2048 sc1 lds
    ds_read_b128 a[132:135], v2 offset:1024
    v_mfma_f32_16x16x32_bf16 a[72:75], a[224:227], v[208:211], a[72:75]
    v_exp_f32 v242, v134
    v_mfma_f32_16x16x32_bf16 a[72:75], a[228:231], v[216:219], a[72:75]
    s_or_b32 s35, s35, 0x10000
    ds_read_b128 a[136:139], v2 offset:2048
    v_cvt_pk_bf16_f32 v196, v240, v241
    v_mfma_f32_16x16x32_bf16 a[76:79], a[224:227], v[212:215], a[76:79]
    v_exp_f32 v243, v135
    v_mfma_f32_16x16x32_bf16 a[76:79], a[228:231], v[220:223], a[76:79]
    s_waitcnt lgkmcnt(7)
    ds_read_b128 a[140:143], v2 offset:3072
    v_or3_b32 v57, v57, v195, v196
    v_mfma_f32_16x16x32_bf16 a[88:91], a[232:235], v[208:211], a[88:91]
    v_exp_f32 v244, v148
    v_mfma_f32_16x16x32_bf16 a[88:91], a[236:239], v[216:219], a[88:91]
    ds_read_b128 a[144:147], v2 offset:4096
    v_cvt_pk_bf16_f32 v197, v242, v243
    v_mfma_f32_16x16x32_bf16 a[92:95], a[232:235], v[212:215], a[92:95]
    v_exp_f32 v245, v149
    v_mfma_f32_16x16x32_bf16 a[92:95], a[236:239], v[220:223], a[92:95]
    s_waitcnt lgkmcnt(7)
    buffer_load_dwordx4 v1, s[20:23], s33 offen offset:3072 sc1 lds
    ds_read_b128 a[148:151], v2 offset:5120
    v_mfma_f32_16x16x32_bf16 a[104:107], a[240:243], v[208:211], a[104:107]
    s_add_u32 s33, s33, 0x80000
    v_exp_f32 v246, v150
    v_mfma_f32_16x16x32_bf16 a[104:107], a[244:247], v[216:219], a[104:107]
    ds_read_b128 a[152:155], v2 offset:6144
    v_cvt_pk_bf16_f32 v198, v244, v245
    v_mfma_f32_16x16x32_bf16 a[108:111], a[240:243], v[212:215], a[108:111]
    v_exp_f32 v247, v151
    v_mfma_f32_16x16x32_bf16 a[108:111], a[244:247], v[220:223], a[108:111]
    s_waitcnt lgkmcnt(7)
    ds_read_b128 a[156:159], v2 offset:7168
    v_or3_b32 v57, v57, v197, v198
    v_mfma_f32_16x16x32_bf16 a[120:123], a[248:251], v[208:211], a[120:123]
    v_exp_f32 v232, v136
    v_mfma_f32_16x16x32_bf16 a[120:123], a[252:255], v[216:219], a[120:123]
    ds_read_b128 a[160:163], v2 offset:8192
    v_cvt_pk_bf16_f32 v199, v246, v247
    v_mfma_f32_16x16x32_bf16 a[124:127], a[248:251], v[212:215], a[124:127]
    v_exp_f32 v233, v137
    v_mfma_f32_16x16x32_bf16 a[124:127], a[252:255], v[220:223], a[124:127]
    s_waitcnt lgkmcnt(7)
    ds_read_b128 a[164:167], v2 offset:9216
    v_cvt_pk_bf16_f32 v200, v232, v233
    v_mfma_f32_16x16x32_bf16 v[160:163], a[128:131], v[96:99], v[16:19]
    s_waitcnt vmcnt(12)
    s_barrier
    v_exp_f32 v234, v138
    v_mfma_f32_16x16x32_bf16 v[160:163], a[132:135], v[100:103], v[160:163]
    s_waitcnt lgkmcnt(6)
    ds_read_b128 a[168:171], v2 offset:10240
    v_or3_b32 v57, v57, v199, v200
    v_mfma_f32_16x16x32_bf16 v[160:163], a[136:139], v[104:107], v[160:163]
    s_mov_b32 m0, s34
    v_exp_f32 v235, v139
    v_mfma_f32_16x16x32_bf16 v[160:163], a[140:143], v[108:111], v[160:163]
    s_add_u32 s36, s36, 64
    buffer_load_dwordx4 v1, s[16:19], s32 offen offset:0 sc1 lds
    ds_read_b128 a[172:175], v2 offset:11264
    v_mfma_f32_16x16x32_bf16 v[164:167], a[128:131], v[112:115], v[20:23]
    v_exp_f32 v236, v152
    v_mfma_f32_16x16x32_bf16 v[164:167], a[132:135], v[116:119], v[164:167]
    ds_read_b128 a[176:179], v2 offset:12288
    v_cvt_pk_bf16_f32 v201, v234, v235
    v_mfma_f32_16x16x32_bf16 v[164:167], a[136:139], v[120:123], v[164:167]
    s_add_u32 s52, s52, 16384
    v_exp_f32 v237, v153
    v_mfma_f32_16x16x32_bf16 v[164:167], a[140:143], v[124:127], v[164:167]
    s_waitcnt lgkmcnt(7)
    ds_read_b128 a[180:183], v2 offset:13312
    v_cvt_pk_bf16_f32 v202, v236, v237
    v_mfma_f32_16x16x32_bf16 v[176:179], a[144:147], v[96:99], v[32:35]
    s_add_u32 s34, s34, 0x4000
    v_exp_f32 v238, v154
    v_mfma_f32_16x16x32_bf16 v[176:179], a[148:151], v[100:103], v[176:179]
    s_waitcnt lgkmcnt(6)
    buffer_load_dwordx4 v1, s[16:19], s32 offen offset:1024 sc1 lds
    ds_read_b128 a[184:187], v2 offset:14336
    v_mfma_f32_16x16x32_bf16 v[176:179], a[152:155], v[104:107], v[176:179]
    s_and_b32 s52, s52, 0xffff
    v_exp_f32 v239, v155
    v_mfma_f32_16x16x32_bf16 v[176:179], a[156:159], v[108:111], v[176:179]
    ds_read_b128 a[188:191], v2 offset:15360
    v_or3_b32 v57, v57, v201, v202
    v_mfma_f32_16x16x32_bf16 v[180:183], a[144:147], v[112:115], v[36:39]
    v_exp_f32 v240, v140
    v_mfma_f32_16x16x32_bf16 v[180:183], a[148:151], v[116:119], v[180:183]
    v_cvt_pk_bf16_f32 v203, v238, v239
    v_add_u32 v2, s52, v1
    v_mfma_f32_16x16x32_bf16 v[180:183], a[152:155], v[120:123], v[180:183]
    s_and_b32 s34, s34, 0xffff
    v_exp_f32 v241, v141
    v_mfma_f32_16x16x32_bf16 v[180:183], a[156:159], v[124:127], v[180:183]
    s_waitcnt lgkmcnt(6)
    ds_read_b128 a[192:195], v3 offset:0
    v_cvt_pk_bf16_f32 v204, v240, v241
    v_mfma_f32_16x16x32_bf16 v[168:171], a[160:163], v[96:99], v[24:27]
    v_exp_f32 v242, v142
    v_mfma_f32_16x16x32_bf16 v[168:171], a[164:167], v[100:103], v[168:171]
    s_waitcnt lgkmcnt(5)
    buffer_load_dwordx4 v1, s[16:19], s32 offen offset:2048 sc1 lds
    ds_read_b128 a[196:199], v3 offset:8192
    v_mfma_f32_16x16x32_bf16 v[168:171], a[168:171], v[104:107], v[168:171]
    v_exp_f32 v243, v143
    v_mfma_f32_16x16x32_bf16 v[168:171], a[172:175], v[108:111], v[168:171]
    ds_read_b128 a[200:203], v3 offset:1024
    v_or3_b32 v57, v57, v203, v204
    v_mfma_f32_16x16x32_bf16 v[172:175], a[160:163], v[112:115], v[28:31]
    v_exp_f32 v244, v156
    v_mfma_f32_16x16x32_bf16 v[172:175], a[164:167], v[116:119], v[172:175]
    ds_read_b128 a[204:207], v3 offset:9216
    v_cvt_pk_bf16_f32 v205, v242, v243
    v_mfma_f32_16x16x32_bf16 v[172:175], a[168:171], v[120:123], v[172:175]
    v_exp_f32 v245, v157
    v_mfma_f32_16x16x32_bf16 v[172:175], a[172:175], v[124:127], v[172:175]
    s_waitcnt lgkmcnt(6)
    buffer_load_dwordx4 v1, s[16:19], s32 offen offset:3072 sc1 lds
    ds_read_b128 a[208:211], v3 offset:2048
    v_mfma_f32_16x16x32_bf16 v[184:187], a[176:179], v[96:99], v[40:43]
    s_sub_u32 s63, s63, 1
    v_exp_f32 v246, v158
    v_mfma_f32_16x16x32_bf16 v[184:187], a[180:183], v[100:103], v[184:187]
    s_waitcnt lgkmcnt(5)
    ds_read_b128 a[212:215], v3 offset:10240
    v_cvt_pk_bf16_f32 v206, v244, v245
    v_mfma_f32_16x16x32_bf16 v[184:187], a[184:187], v[104:107], v[184:187]
    s_add_u32 s32, s32, 0x80000
    v_exp_f32 v247, v159
    v_mfma_f32_16x16x32_bf16 v[184:187], a[188:191], v[108:111], v[184:187]
    ds_read_b128 a[216:219], v3 offset:3072
    v_or3_b32 v57, v57, v205, v206
    v_mfma_f32_16x16x32_bf16 v[188:191], a[176:179], v[112:115], v[44:47]
    ds_read_b128 a[220:223], v3 offset:11264
    v_cvt_pk_bf16_f32 v207, v246, v247
    v_mfma_f32_16x16x32_bf16 v[188:191], a[180:183], v[116:119], v[188:191]
    v_bitop3_b32 v57, v57, v207, s37 bitop3:0xa8
    v_cmp_ne_u32 vcc, 0, v57
    v_mfma_f32_16x16x32_bf16 v[188:191], a[184:187], v[120:123], v[188:191]
    v_mfma_f32_16x16x32_bf16 v[188:191], a[188:191], v[124:127], v[188:191]
    s_cbranch_vccnz k2_tramp_114
k2_ret_115:
    s_cmp_lg_u32 s63, 0
    s_cbranch_scc1 k2_sloop_110
    v_mfma_f32_16x16x32_bf16 v[248:251], v[60:63], v[192:195], v[248:251]
    v_exp_f32 v232, v160
    v_mfma_f32_16x16x32_bf16 v[248:251], v[60:63], v[200:203], v[248:251]
    s_mov_b32 m0, s35
    ds_read_b128 a[224:227], v3 offset:4096
    v_exp_f32 v233, v161
    v_mfma_f32_16x16x32_bf16 v[252:255], v[60:63], v[196:199], v[252:255]
    s_add_u32 s53, s53, 16384
    buffer_load_dwordx4 v1, s[20:23], s33 offen offset:0 sc1 lds
    ds_read_b128 a[228:231], v3 offset:12288
    v_mfma_f32_16x16x32_bf16 v[252:255], v[60:63], v[204:207], v[252:255]
    s_waitcnt lgkmcnt(8)
    v_exp_f32 v234, v162
    v_cvt_pk_bf16_f32 v208, v232, v233
    v_mfma_f32_16x16x32_bf16 a[8:11], a[192:195], v[192:195], a[8:11]
    s_sub_u32 s40, s36, s39
    ds_read_b128 a[232:235], v3 offset:5120
    v_mfma_f32_16x16x32_bf16 a[8:11], a[196:199], v[200:203], a[8:11]
    s_and_b32 s53, s53, 0xffff
    v_subrev_u32 v6, s40, v4
    v_cmp_gt_i32 s[44:45], 0, v6
    v_mfma_f32_16x16x32_bf16 a[12:15], a[192:195], v[196:199], a[12:15]
    v_exp_f32 v235, v163
    v_cmp_gt_i32 s[46:47], 1, v6
    v_mfma_f32_16x16x32_bf16 a[12:15], a[196:199], v[204:207], a[12:15]
    s_waitcnt lgkmcnt(7)
    ds_read_b128 a[236:239], v3 offset:13312
    v_cmp_gt_i32 s[48:49], 2, v6
    v_cmp_gt_i32 s[50:51], 3, v6
    v_mfma_f32_16x16x32_bf16 a[24:27], a[200:203], v[192:195], a[24:27]
    s_add_u32 s35, s35, 0x4000
    v_exp_f32 v236, v176
    v_mfma_f32_16x16x32_bf16 a[24:27], a[204:207], v[200:203], a[24:27]
    ds_read_b128 a[240:243], v3 offset:6144
    v_cvt_pk_bf16_f32 v209, v234, v235
    v_cndmask_b32 v16, v10, v5, s[44:45]
    v_mfma_f32_16x16x32_bf16 a[28:31], a[200:203], v[196:199], a[28:31]
    v_exp_f32 v237, v177
    v_mfma_f32_16x16x32_bf16 a[28:31], a[204:207], v[204:207], a[28:31]
    s_waitcnt lgkmcnt(7)
    ds_read_b128 a[244:247], v3 offset:14336
    v_cndmask_b32 v17, v10, v5, s[46:47]
    v_cndmask_b32 v18, v10, v5, s[48:49]
    v_mfma_f32_16x16x32_bf16 a[40:43], a[208:211], v[192:195], a[40:43]
    buffer_load_dwordx4 v1, s[20:23], s33 offen offset:1024 sc1 lds
    ds_read_b128 a[248:251], v3 offset:7168
    v_mfma_f32_16x16x32_bf16 a[40:43], a[212:215], v[200:203], a[40:43]
    v_cndmask_b32 v19, v10, v5, s[50:51]
    v_cvt_pk_bf16_f32 v210, v236, v237
    v_mfma_f32_16x16x32_bf16 a[44:47], a[208:211], v[196:199], a[44:47]
    v_exp_f32 v238, v178
    v_cmp_gt_i32 s[44:45], 16, v6
    v_mfma_f32_16x16x32_bf16 a[44:47], a[212:215], v[204:207], a[44:47]
    s_waitcnt lgkmcnt(7)
    v_cmp_gt_i32 s[46:47], 17, v6
    v_cmp_gt_i32 s[48:49], 18, v6
    v_mfma_f32_16x16x32_bf16 a[56:59], a[216:219], v[192:195], a[56:59]
    s_and_b32 s35, s35, 0xffff
    v_exp_f32 v239, v179
    v_mfma_f32_16x16x32_bf16 a[56:59], a[220:223], v[200:203], a[56:59]
    ds_read_b128 a[252:255], v3 offset:15360
    v_or3_b32 v57, v208, v209, v210
    v_cmp_gt_i32 s[50:51], 19, v6
    v_mfma_f32_16x16x32_bf16 a[60:63], a[216:219], v[196:199], a[60:63]
    v_exp_f32 v240, v164
    v_mfma_f32_16x16x32_bf16 a[60:63], a[220:223], v[204:207], a[60:63]
    s_waitcnt lgkmcnt(6)
    v_cndmask_b32 v32, v10, v5, s[44:45]
    v_cvt_pk_bf16_f32 v211, v238, v239
    v_cndmask_b32 v33, v10, v5, s[46:47]
    v_mfma_f32_16x16x32_bf16 a[72:75], a[224:227], v[192:195], a[72:75]
    ds_read_b128 a[128:131], v2 offset:0
    v_cndmask_b32 v34, v10, v5, s[48:49]
    v_mfma_f32_16x16x32_bf16 a[72:75], a[228:231], v[200:203], a[72:75]
    s_or_b32 s35, s35, 0x10000
    v_add_u32 v3, s53, v56
    v_cndmask_b32 v35, v10, v5, s[50:51]
    v_mfma_f32_16x16x32_bf16 a[76:79], a[224:227], v[196:199], a[76:79]
    buffer_load_dwordx4 v1, s[20:23], s33 offen offset:2048 sc1 lds
    v_exp_f32 v241, v165
    v_mfma_f32_16x16x32_bf16 a[76:79], a[228:231], v[204:207], a[76:79]
    s_waitcnt lgkmcnt(5)
    ds_read_b128 a[132:135], v2 offset:1024
    v_cmp_gt_i32 s[44:45], 32, v6
    v_mfma_f32_16x16x32_bf16 a[88:91], a[232:235], v[192:195], a[88:91]
    v_exp_f32 v242, v166
    v_cmp_gt_i32 s[46:47], 33, v6
    v_mfma_f32_16x16x32_bf16 a[88:91], a[236:239], v[200:203], a[88:91]
    ds_read_b128 a[136:139], v2 offset:2048
    v_cvt_pk_bf16_f32 v212, v240, v241
    v_mfma_f32_16x16x32_bf16 a[92:95], a[232:235], v[196:199], a[92:95]
    v_cmp_gt_i32 s[48:49], 34, v6
    v_cmp_gt_i32 s[50:51], 35, v6
    v_mfma_f32_16x16x32_bf16 a[92:95], a[236:239], v[204:207], a[92:95]
    s_waitcnt lgkmcnt(5)
    v_exp_f32 v243, v167
    v_or3_b32 v57, v57, v211, v212
    v_mfma_f32_16x16x32_bf16 a[104:107], a[240:243], v[192:195], a[104:107]
    ds_read_b128 a[140:143], v2 offset:3072
    v_cndmask_b32 v24, v10, v5, s[44:45]
    v_mfma_f32_16x16x32_bf16 a[104:107], a[244:247], v[200:203], a[104:107]
    v_cndmask_b32 v25, v10, v5, s[46:47]
    v_exp_f32 v244, v180
    v_mfma_f32_16x16x32_bf16 a[108:111], a[240:243], v[196:199], a[108:111]
    v_cvt_pk_bf16_f32 v213, v242, v243
    v_cndmask_b32 v26, v10, v5, s[48:49]
    v_mfma_f32_16x16x32_bf16 a[108:111], a[244:247], v[204:207], a[108:111]
    s_waitcnt lgkmcnt(4)
    ds_read_b128 a[144:147], v2 offset:4096
    v_cndmask_b32 v27, v10, v5, s[50:51]
    v_mfma_f32_16x16x32_bf16 a[120:123], a[248:251], v[192:195], a[120:123]
    v_exp_f32 v245, v181
    v_cmp_gt_i32 s[44:45], 48, v6
    v_mfma_f32_16x16x32_bf16 a[120:123], a[252:255], v[200:203], a[120:123]
    buffer_load_dwordx4 v1, s[20:23], s33 offen offset:3072 sc1 lds
    ds_read_b128 a[148:151], v2 offset:5120
    ds_read_b128 a[152:155], v2 offset:6144
    v_cmp_gt_i32 s[46:47], 49, v6
    s_add_u32 s33, s33, 0x80000
    v_cmp_gt_i32 s[48:49], 50, v6
    v_exp_f32 v246, v182
    v_cvt_pk_bf16_f32 v214, v244, v245
    v_cmp_gt_i32 s[50:51], 51, v6
    v_cndmask_b32 v40, v10, v5, s[44:45]
    v_mfma_f32_16x16x32_bf16 a[124:127], a[248:251], v[196:199], a[124:127]
    v_exp_f32 v247, v183
    v_or3_b32 v57, v57, v213, v214
    v_cndmask_b32 v41, v10, v5, s[46:47]
    v_mfma_f32_16x16x32_bf16 a[124:127], a[252:255], v[204:207], a[124:127]
    s_waitcnt lgkmcnt(5)
    ds_read_b128 a[156:159], v2 offset:7168
    v_cndmask_b32 v42, v10, v5, s[48:49]
    v_cndmask_b32 v43, v10, v5, s[50:51]
    v_mfma_f32_16x16x32_bf16 v[128:131], a[128:131], v[96:99], v[16:19]
    s_waitcnt vmcnt(4)
    s_barrier
    v_exp_f32 v232, v168
    v_mfma_f32_16x16x32_bf16 v[128:131], a[132:135], v[100:103], v[128:131]
    s_waitcnt lgkmcnt(4)
    ds_read_b128 a[160:163], v2 offset:8192
    v_cvt_pk_bf16_f32 v215, v246, v247
    v_mfma_f32_16x16x32_bf16 v[128:131], a[136:139], v[104:107], v[128:131]
    v_exp_f32 v233, v169
    v_mfma_f32_16x16x32_bf16 v[128:131], a[140:143], v[108:111], v[128:131]
    s_add_u32 s36, s36, 64
    ds_read_b128 a[164:167], v2 offset:9216
    v_cvt_pk_bf16_f32 v216, v232, v233
    v_mfma_f32_16x16x32_bf16 v[132:135], a[128:131], v[112:115], v[20:23]
    v_exp_f32 v234, v170
    v_mfma_f32_16x16x32_bf16 v[132:135], a[132:135], v[116:119], v[132:135]
    ds_read_b128 a[168:171], v2 offset:10240
    v_or3_b32 v57, v57, v215, v216
    v_mfma_f32_16x16x32_bf16 v[132:135], a[136:139], v[120:123], v[132:135]
    s_add_u32 s52, s52, 16384
    v_exp_f32 v235, v171
    v_mfma_f32_16x16x32_bf16 v[132:135], a[140:143], v[124:127], v[132:135]
    s_waitcnt lgkmcnt(5)
    ds_read_b128 a[172:175], v2 offset:11264
    v_cvt_pk_bf16_f32 v217, v234, v235
    v_mfma_f32_16x16x32_bf16 v[144:147], a[144:147], v[96:99], v[32:35]
    s_and_b32 s52, s52, 0xffff
    v_exp_f32 v236, v184
    v_mfma_f32_16x16x32_bf16 v[144:147], a[148:151], v[100:103], v[144:147]
    s_waitcnt lgkmcnt(4)
    ds_read_b128 a[176:179], v2 offset:12288
    ds_read_b128 a[180:183], v2 offset:13312
    v_mfma_f32_16x16x32_bf16 v[144:147], a[152:155], v[104:107], v[144:147]
    v_exp_f32 v237, v185
    v_mfma_f32_16x16x32_bf16 v[144:147], a[156:159], v[108:111], v[144:147]
    v_exp_f32 v238, v186
    v_mfma_f32_16x16x32_bf16 v[148:151], a[144:147], v[112:115], v[36:39]
    ds_read_b128 a[184:187], v2 offset:14336
    v_cvt_pk_bf16_f32 v218, v236, v237
    v_mfma_f32_16x16x32_bf16 v[148:151], a[148:151], v[116:119], v[148:151]
    v_exp_f32 v239, v187
    v_mfma_f32_16x16x32_bf16 v[148:151], a[152:155], v[120:123], v[148:151]
    ds_read_b128 a[188:191], v2 offset:15360
    v_or3_b32 v57, v57, v217, v218
    v_mfma_f32_16x16x32_bf16 v[148:151], a[156:159], v[124:127], v[148:151]
    s_waitcnt lgkmcnt(6)
    v_exp_f32 v240, v172
    v_mfma_f32_16x16x32_bf16 v[136:139], a[160:163], v[96:99], v[24:27]
    v_cvt_pk_bf16_f32 v219, v238, v239
    v_add_u32 v2, s52, v1
    v_mfma_f32_16x16x32_bf16 v[136:139], a[164:167], v[100:103], v[136:139]
    s_waitcnt lgkmcnt(4)
    v_exp_f32 v241, v173
    v_mfma_f32_16x16x32_bf16 v[136:139], a[168:171], v[104:107], v[136:139]
    ds_read_b128 a[192:195], v3 offset:0
    v_cvt_pk_bf16_f32 v220, v240, v241
    v_mfma_f32_16x16x32_bf16 v[136:139], a[172:175], v[108:111], v[136:139]
    v_exp_f32 v242, v174
    v_mfma_f32_16x16x32_bf16 v[140:143], a[160:163], v[112:115], v[28:31]
    ds_read_b128 a[196:199], v3 offset:8192
    v_or3_b32 v57, v57, v219, v220
    v_mfma_f32_16x16x32_bf16 v[140:143], a[164:167], v[116:119], v[140:143]
    v_exp_f32 v243, v175
    v_mfma_f32_16x16x32_bf16 v[140:143], a[168:171], v[120:123], v[140:143]
    ds_read_b128 a[200:203], v3 offset:1024
    v_cvt_pk_bf16_f32 v221, v242, v243
    v_mfma_f32_16x16x32_bf16 v[140:143], a[172:175], v[124:127], v[140:143]
    s_waitcnt lgkmcnt(5)
    v_exp_f32 v244, v188
    v_mfma_f32_16x16x32_bf16 v[152:155], a[176:179], v[96:99], v[40:43]
    ds_read_b128 a[204:207], v3 offset:9216
    ds_read_b128 a[208:211], v3 offset:2048
    v_mfma_f32_16x16x32_bf16 v[152:155], a[180:183], v[100:103], v[152:155]
    s_waitcnt lgkmcnt(5)
    v_exp_f32 v245, v189
    v_mfma_f32_16x16x32_bf16 v[152:155], a[184:187], v[104:107], v[152:155]
    v_exp_f32 v246, v190
    v_mfma_f32_16x16x32_bf16 v[152:155], a[188:191], v[108:111], v[152:155]
    ds_read_b128 a[212:215], v3 offset:10240
    v_cvt_pk_bf16_f32 v222, v244, v245
    v_mfma_f32_16x16x32_bf16 v[156:159], a[176:179], v[112:115], v[44:47]
    v_exp_f32 v247, v191
    v_mfma_f32_16x16x32_bf16 v[156:159], a[180:183], v[116:119], v[156:159]
    ds_read_b128 a[216:219], v3 offset:3072
    v_or3_b32 v57, v57, v221, v222
    v_mfma_f32_16x16x32_bf16 v[156:159], a[184:187], v[120:123], v[156:159]
    ds_read_b128 a[220:223], v3 offset:11264
    v_cvt_pk_bf16_f32 v223, v246, v247
    v_bitop3_b32 v57, v57, v223, s37 bitop3:0xa8
    v_mfma_f32_16x16x32_bf16 v[156:159], a[188:191], v[124:127], v[156:159]
    v_cmp_ne_u32 vcc, 0, v57
    s_cbranch_vccnz k2_tramp_116
k2_ret_117:
    v_mfma_f32_16x16x32_bf16 v[248:251], v[60:63], v[208:211], v[248:251]
    ds_read_b128 a[224:227], v3 offset:4096
    v_exp_f32 v232, v128
    v_mfma_f32_16x16x32_bf16 v[248:251], v[60:63], v[216:219], v[248:251]
    v_exp_f32 v233, v129
    v_mfma_f32_16x16x32_bf16 v[252:255], v[60:63], v[212:215], v[252:255]
    s_add_u32 s53, s53, 16384
    ds_read_b128 a[228:231], v3 offset:12288
    v_exp_f32 v234, v130
    v_mfma_f32_16x16x32_bf16 v[252:255], v[60:63], v[220:223], v[252:255]
    s_waitcnt lgkmcnt(8)
    v_cvt_pk_bf16_f32 v192, v232, v233
    v_exp_f32 v235, v131
    v_mfma_f32_16x16x32_bf16 a[8:11], a[192:195], v[208:211], a[8:11]
    s_sub_u32 s40, s36, s39
    s_sub_u32 s40, s40, 64
    ds_read_b128 a[232:235], v3 offset:5120
    v_mfma_f32_16x16x32_bf16 a[8:11], a[196:199], v[216:219], a[8:11]
    s_and_b32 s53, s53, 0xffff
    v_subrev_u32 v6, s40, v4
    v_cmp_gt_i32 s[44:45], 0, v6
    v_cvt_pk_bf16_f32 v193, v234, v235
    v_mfma_f32_16x16x32_bf16 a[12:15], a[192:195], v[212:215], a[12:15]
    v_exp_f32 v236, v144
    v_cmp_gt_i32 s[46:47], 1, v6
    v_mfma_f32_16x16x32_bf16 a[12:15], a[196:199], v[220:223], a[12:15]
    s_waitcnt lgkmcnt(7)
    ds_read_b128 a[236:239], v3 offset:13312
    v_exp_f32 v237, v145
    v_mfma_f32_16x16x32_bf16 a[24:27], a[200:203], v[208:211], a[24:27]
    ds_read_b128 a[240:243], v3 offset:6144
    v_cmp_gt_i32 s[48:49], 2, v6
    v_cmp_gt_i32 s[50:51], 3, v6
    v_mfma_f32_16x16x32_bf16 a[24:27], a[204:207], v[216:219], a[24:27]
    v_exp_f32 v238, v146
    v_cndmask_b32 v20, v11, v5, s[44:45]
    v_mfma_f32_16x16x32_bf16 a[28:31], a[200:203], v[212:215], a[28:31]
    v_cvt_pk_bf16_f32 v194, v236, v237
    v_cndmask_b32 v21, v11, v5, s[46:47]
    v_or3_b32 v57, v192, v193, v194
    v_mfma_f32_16x16x32_bf16 a[28:31], a[204:207], v[220:223], a[28:31]
    s_waitcnt lgkmcnt(7)
    v_exp_f32 v239, v147
    v_cndmask_b32 v22, v11, v5, s[48:49]
    v_mfma_f32_16x16x32_bf16 a[40:43], a[208:211], v[208:211], a[40:43]
    ds_read_b128 a[244:247], v3 offset:14336
    v_cndmask_b32 v23, v11, v5, s[50:51]
    v_cvt_pk_bf16_f32 v195, v238, v239
    v_mfma_f32_16x16x32_bf16 a[40:43], a[212:215], v[216:219], a[40:43]
    v_exp_f32 v240, v132
    v_cmp_gt_i32 s[44:45], 16, v6
    v_mfma_f32_16x16x32_bf16 a[44:47], a[208:211], v[212:215], a[44:47]
    ds_read_b128 a[248:251], v3 offset:7168
    v_cmp_gt_i32 s[46:47], 17, v6
    v_cmp_gt_i32 s[48:49], 18, v6
    v_mfma_f32_16x16x32_bf16 a[44:47], a[212:215], v[220:223], a[44:47]
    s_waitcnt lgkmcnt(7)
    ds_read_b128 a[252:255], v3 offset:15360
    v_exp_f32 v241, v133
    v_mfma_f32_16x16x32_bf16 a[56:59], a[216:219], v[208:211], a[56:59]
    v_exp_f32 v242, v134
    v_cmp_gt_i32 s[50:51], 19, v6
    v_mfma_f32_16x16x32_bf16 a[56:59], a[220:223], v[216:219], a[56:59]
    v_cvt_pk_bf16_f32 v196, v240, v241
    v_cndmask_b32 v36, v11, v5, s[44:45]
    v_or3_b32 v57, v57, v195, v196
    v_mfma_f32_16x16x32_bf16 a[60:63], a[216:219], v[212:215], a[60:63]
    v_exp_f32 v243, v135
    v_cndmask_b32 v37, v11, v5, s[46:47]
    v_mfma_f32_16x16x32_bf16 a[60:63], a[220:223], v[220:223], a[60:63]
    s_waitcnt lgkmcnt(6)
    ds_read_b128 a[128:131], v2 offset:0
    v_cndmask_b32 v38, v11, v5, s[48:49]
    v_add_u32 v3, s53, v56
    v_mfma_f32_16x16x32_bf16 a[72:75], a[224:227], v[208:211], a[72:75]
    ds_read_b128 a[132:135], v2 offset:1024
    v_exp_f32 v244, v148
    v_mfma_f32_16x16x32_bf16 a[72:75], a[228:231], v[216:219], a[72:75]
    ds_read_b128 a[136:139], v2 offset:2048
    v_cvt_pk_bf16_f32 v197, v242, v243
    v_cndmask_b32 v39, v11, v5, s[50:51]
    v_mfma_f32_16x16x32_bf16 a[76:79], a[224:227], v[212:215], a[76:79]
    v_cmp_gt_i32 s[44:45], 32, v6
    v_exp_f32 v245, v149
    v_mfma_f32_16x16x32_bf16 a[76:79], a[228:231], v[220:223], a[76:79]
    s_waitcnt lgkmcnt(7)
    ds_read_b128 a[140:143], v2 offset:3072
    ds_read_b128 a[144:147], v2 offset:4096
    v_cmp_gt_i32 s[46:47], 33, v6
    v_mfma_f32_16x16x32_bf16 a[88:91], a[232:235], v[208:211], a[88:91]
    v_exp_f32 v246, v150
    v_cmp_gt_i32 s[48:49], 34, v6
    v_mfma_f32_16x16x32_bf16 a[88:91], a[236:239], v[216:219], a[88:91]
    ds_read_b128 a[148:151], v2 offset:5120
    v_cvt_pk_bf16_f32 v198, v244, v245
    v_cmp_gt_i32 s[50:51], 35, v6
    v_mfma_f32_16x16x32_bf16 a[92:95], a[232:235], v[212:215], a[92:95]
    v_exp_f32 v247, v151
    v_or3_b32 v57, v57, v197, v198
    v_mfma_f32_16x16x32_bf16 a[92:95], a[236:239], v[220:223], a[92:95]
    s_waitcnt lgkmcnt(8)
    ds_read_b128 a[152:155], v2 offset:6144
    v_cndmask_b32 v28, v11, v5, s[44:45]
    v_cndmask_b32 v29, v11, v5, s[46:47]
    v_mfma_f32_16x16x32_bf16 a[104:107], a[240:243], v[208:211], a[104:107]
    ds_read_b128 a[156:159], v2 offset:7168
    v_exp_f32 v232, v136
    v_mfma_f32_16x16x32_bf16 a[104:107], a[244:247], v[216:219], a[104:107]
    ds_read_b128 a[160:163], v2 offset:8192
    v_cvt_pk_bf16_f32 v199, v246, v247
    v_cndmask_b32 v30, v11, v5, s[48:49]
    v_mfma_f32_16x16x32_bf16 a[108:111], a[240:243], v[212:215], a[108:111]
    v_cndmask_b32 v31, v11, v5, s[50:51]
    v_exp_f32 v233, v137
    v_mfma_f32_16x16x32_bf16 a[108:111], a[244:247], v[220:223], a[108:111]
    s_waitcnt lgkmcnt(9)
    ds_read_b128 a[164:167], v2 offset:9216
    ds_read_b128 a[168:171], v2 offset:10240
    v_cmp_gt_i32 s[44:45], 48, v6
    v_mfma_f32_16x16x32_bf16 a[120:123], a[248:251], v[208:211], a[120:123]
    v_exp_f32 v234, v138
    v_cmp_gt_i32 s[46:47], 49, v6
    v_mfma_f32_16x16x32_bf16 a[120:123], a[252:255], v[216:219], a[120:123]
    ds_read_b128 a[172:175], v2 offset:11264
    ds_read_b128 a[176:179], v2 offset:12288
    v_cvt_pk_bf16_f32 v200, v232, v233
    v_cmp_gt_i32 s[48:49], 50, v6
    v_exp_f32 v235, v139
    v_cmp_gt_i32 s[50:51], 51, v6
    v_or3_b32 v57, v57, v199, v200
    v_cndmask_b32 v44, v11, v5, s[44:45]
    v_mfma_f32_16x16x32_bf16 a[124:127], a[248:251], v[212:215], a[124:127]
    ds_read_b128 a[180:183], v2 offset:13312
    v_exp_f32 v236, v152
    v_cvt_pk_bf16_f32 v201, v234, v235
    v_cndmask_b32 v45, v11, v5, s[46:47]
    v_mfma_f32_16x16x32_bf16 a[124:127], a[252:255], v[220:223], a[124:127]
    s_waitcnt lgkmcnt(12)
    ds_read_b128 a[184:187], v2 offset:14336
    v_cndmask_b32 v46, v11, v5, s[48:49]
    v_cndmask_b32 v47, v11, v5, s[50:51]
    v_mfma_f32_16x16x32_bf16 v[164:167], a[128:131], v[112:115], v[20:23]
    v_exp_f32 v237, v153
    v_mfma_f32_16x16x32_bf16 v[164:167], a[132:135], v[116:119], v[164:167]
    s_waitcnt lgkmcnt(11)
    ds_read_b128 a[188:191], v2 offset:15360
    v_exp_f32 v238, v154
    v_mfma_f32_16x16x32_bf16 v[164:167], a[136:139], v[120:123], v[164:167]
    v_cvt_pk_bf16_f32 v202, v236, v237
    v_exp_f32 v239, v155
    v_mfma_f32_16x16x32_bf16 v[164:167], a[140:143], v[124:127], v[164:167]
    s_waitcnt lgkmcnt(10)
    ds_read_b128 a[192:195], v3 offset:0
    v_or3_b32 v57, v57, v201, v202
    v_mfma_f32_16x16x32_bf16 v[180:183], a[144:147], v[112:115], v[36:39]
    s_add_u32 s36, s36, 64
    v_exp_f32 v240, v140
    v_mfma_f32_16x16x32_bf16 v[180:183], a[148:151], v[116:119], v[180:183]
    s_waitcnt lgkmcnt(9)
    ds_read_b128 a[196:199], v3 offset:8192
    v_cvt_pk_bf16_f32 v203, v238, v239
    v_exp_f32 v241, v141
    v_mfma_f32_16x16x32_bf16 v[180:183], a[152:155], v[120:123], v[180:183]
    s_add_u32 s52, s52, 16384
    ds_read_b128 a[200:203], v3 offset:1024
    v_cvt_pk_bf16_f32 v204, v240, v241
    v_mfma_f32_16x16x32_bf16 v[180:183], a[156:159], v[124:127], v[180:183]
    s_waitcnt lgkmcnt(9)
    v_exp_f32 v242, v142
    v_or3_b32 v57, v57, v203, v204
    v_mfma_f32_16x16x32_bf16 v[172:175], a[160:163], v[112:115], v[28:31]
    s_and_b32 s52, s52, 0xffff
    v_add_u32 v2, s52, v1
    v_exp_f32 v243, v143
    v_mfma_f32_16x16x32_bf16 v[172:175], a[164:167], v[116:119], v[172:175]
    s_waitcnt lgkmcnt(7)
    ds_read_b128 a[204:207], v3 offset:9216
    v_exp_f32 v244, v156
    v_mfma_f32_16x16x32_bf16 v[172:175], a[168:171], v[120:123], v[172:175]
    ds_read_b128 a[208:211], v3 offset:2048
    ds_read_b128 a[212:215], v3 offset:10240
    v_cvt_pk_bf16_f32 v205, v242, v243
    v_mfma_f32_16x16x32_bf16 v[172:175], a[172:175], v[124:127], v[172:175]
    s_waitcnt lgkmcnt(8)
    ds_read_b128 a[216:219], v3 offset:3072
    v_exp_f32 v245, v157
    v_mfma_f32_16x16x32_bf16 v[188:191], a[176:179], v[112:115], v[44:47]
    v_exp_f32 v246, v158
    v_cvt_pk_bf16_f32 v206, v244, v245
    v_mfma_f32_16x16x32_bf16 v[188:191], a[180:183], v[116:119], v[188:191]
    s_waitcnt lgkmcnt(7)
    v_exp_f32 v247, v159
    v_or3_b32 v57, v57, v205, v206
    v_mfma_f32_16x16x32_bf16 v[188:191], a[184:187], v[120:123], v[188:191]
    ds_read_b128 a[220:223], v3 offset:11264
    v_cvt_pk_bf16_f32 v207, v246, v247
    v_bitop3_b32 v57, v57, v207, s37 bitop3:0xa8
    v_mfma_f32_16x16x32_bf16 v[188:191], a[188:191], v[124:127], v[188:191]
    v_cmp_ne_u32 vcc, 0, v57
    s_cbranch_vccnz k2_tramp_118
k2_ret_119:
k2_sdone_111:
    s_add_u32 s16, s6, 0x4811000
    s_addc_u32 s17, s7, 0
    s_and_b32 s17, s17, 0xffff
    s_mov_b32 s18, 0x4000
    s_mov_b32 s19, 0x00020000
    v_mfma_f32_16x16x32_bf16 v[248:251], v[60:63], v[192:195], v[248:251]
    s_waitcnt vmcnt(0)
    s_barrier
    v_exp_f32 v232, v164
    v_mfma_f32_16x16x32_bf16 v[248:251], v[60:63], v[200:203], v[248:251]
    ds_read_b128 a[224:227], v3 offset:4096
    s_cmp_eq_u32 s30, 0
    s_cbranch_scc1 k12_ool_122
k12_oolret_123:
    v_mfma_f32_16x16x32_bf16 v[252:255], v[60:63], v[196:199], v[252:255]
    s_add_u32 m0, s60, 0
    v_exp_f32 v233, v165
    v_mfma_f32_16x16x32_bf16 v[252:255], v[60:63], v[204:207], v[252:255]
    s_waitcnt lgkmcnt(7)
    buffer_load_dwordx4 v90, s[12:15], s61 offen offset:0 lds
    ds_read_b128 a[228:231], v3 offset:12288
    v_mfma_f32_16x16x32_bf16 a[8:11], a[192:195], v[192:195], a[8:11]
    s_add_u32 s53, s53, 16384
    v_exp_f32 v234, v166
    v_cvt_pk_bf16_f32 v212, v232, v233
    v_mfma_f32_16x16x32_bf16 a[8:11], a[196:199], v[200:203], a[8:11]
    s_and_b32 s53, s53, 0xffff
    buffer_load_dwordx4 v91, s[12:15], s61 offen offset:1024 lds
    ds_read_b128 a[232:235], v3 offset:5120
    v_mfma_f32_16x16x32_bf16 a[12:15], a[192:195], v[196:199], a[12:15]
    ds_read_b128 a[236:239], v3 offset:13312
    v_exp_f32 v235, v167
    v_mfma_f32_16x16x32_bf16 a[12:15], a[196:199], v[204:207], a[12:15]
    s_waitcnt lgkmcnt(8)
    v_exp_f32 v236, v180
    v_mfma_f32_16x16x32_bf16 a[24:27], a[200:203], v[192:195], a[24:27]
    buffer_load_dwordx4 v92, s[12:15], s61 offen offset:2048 lds
    ds_read_b128 a[240:243], v3 offset:6144
    v_mfma_f32_16x16x32_bf16 a[24:27], a[204:207], v[200:203], a[24:27]
    v_cvt_pk_bf16_f32 v213, v234, v235
    v_exp_f32 v237, v181
    v_mfma_f32_16x16x32_bf16 a[28:31], a[200:203], v[196:199], a[28:31]
    buffer_load_dwordx4 v93, s[12:15], s61 offen offset:3072 lds
    ds_read_b128 a[244:247], v3 offset:14336
    v_mfma_f32_16x16x32_bf16 a[28:31], a[204:207], v[204:207], a[28:31]
    s_waitcnt lgkmcnt(8)
    v_exp_f32 v238, v182
    v_cvt_pk_bf16_f32 v214, v236, v237
    v_mfma_f32_16x16x32_bf16 a[40:43], a[208:211], v[192:195], a[40:43]
    s_add_u32 s61, s61, 0x20000
    s_and_b32 s61, s61, 0x3fffff
    ds_read_b128 a[248:251], v3 offset:7168
    v_mfma_f32_16x16x32_bf16 a[40:43], a[212:215], v[200:203], a[40:43]
    s_add_u32 m0, s60, 16384
    v_exp_f32 v239, v183
    v_or3_b32 v57, v212, v213, v214
    v_mfma_f32_16x16x32_bf16 a[44:47], a[208:211], v[196:199], a[44:47]
    buffer_load_dwordx4 v90, s[12:15], s61 offen offset:0 lds
    buffer_load_dwordx4 v91, s[12:15], s61 offen offset:1024 lds
    ds_read_b128 a[252:255], v3 offset:15360
    v_mfma_f32_16x16x32_bf16 a[44:47], a[212:215], v[204:207], a[44:47]
    s_waitcnt lgkmcnt(8)
    v_exp_f32 v240, v172
    v_cvt_pk_bf16_f32 v215, v238, v239
    v_mfma_f32_16x16x32_bf16 a[56:59], a[216:219], v[192:195], a[56:59]
    v_mfma_f32_16x16x32_bf16 a[56:59], a[220:223], v[200:203], a[56:59]
    v_add_u32 v3, s53, v56
    ds_read_b128 a[192:195], v3 offset:0
    v_mfma_f32_16x16x32_bf16 a[60:63], a[216:219], v[196:199], a[60:63]
    ds_read_b128 a[196:199], v3 offset:8192
    v_exp_f32 v241, v173
    v_mfma_f32_16x16x32_bf16 a[60:63], a[220:223], v[204:207], a[60:63]
    s_waitcnt lgkmcnt(8)
    buffer_load_dwordx4 v92, s[12:15], s61 offen offset:2048 lds
    buffer_load_dwordx4 v93, s[12:15], s61 offen offset:3072 lds
    ds_read_b128 a[200:203], v3 offset:1024
    v_mfma_f32_16x16x32_bf16 a[72:75], a[224:227], v[192:195], a[72:75]
    v_exp_f32 v242, v174
    v_cvt_pk_bf16_f32 v220, v240, v241
    v_mfma_f32_16x16x32_bf16 a[72:75], a[228:231], v[200:203], a[72:75]
    ds_read_b128 a[204:207], v3 offset:9216
    ds_read_b128 a[208:211], v3 offset:2048
    v_or3_b32 v57, v57, v215, v220
    v_mfma_f32_16x16x32_bf16 a[76:79], a[224:227], v[196:199], a[76:79]
    s_add_u32 s61, s61, 0x20000
    s_and_b32 s61, s61, 0x3fffff
    ds_read_b128 a[212:215], v3 offset:10240
    v_exp_f32 v243, v175
    v_mfma_f32_16x16x32_bf16 a[76:79], a[228:231], v[204:207], a[76:79]
    s_waitcnt lgkmcnt(10)
    ds_read_b128 a[216:219], v3 offset:3072
    s_add_u32 m0, s60, 32768
    v_mfma_f32_16x16x32_bf16 a[88:91], a[232:235], v[192:195], a[88:91]
    buffer_load_dwordx4 v90, s[12:15], s61 offen offset:0 lds
    ds_read_b128 a[220:223], v3 offset:11264
    v_mfma_f32_16x16x32_bf16 a[88:91], a[236:239], v[200:203], a[88:91]
    v_exp_f32 v244, v188
    v_cvt_pk_bf16_f32 v221, v242, v243
    v_mfma_f32_16x16x32_bf16 a[92:95], a[232:235], v[196:199], a[92:95]
    buffer_load_dwordx4 v91, s[12:15], s61 offen offset:1024 lds
    ds_read_b128 a[224:227], v3 offset:4096
    v_mfma_f32_16x16x32_bf16 a[92:95], a[236:239], v[204:207], a[92:95]
    s_waitcnt lgkmcnt(11)
    ds_read_b128 a[228:231], v3 offset:12288
    v_exp_f32 v245, v189
    v_mfma_f32_16x16x32_bf16 a[104:107], a[240:243], v[192:195], a[104:107]
    buffer_load_dwordx4 v92, s[12:15], s61 offen offset:2048 lds
    ds_read_b128 a[232:235], v3 offset:5120
    v_mfma_f32_16x16x32_bf16 a[104:107], a[244:247], v[200:203], a[104:107]
    v_exp_f32 v246, v190
    v_mfma_f32_16x16x32_bf16 a[108:111], a[240:243], v[196:199], a[108:111]
    ds_read_b128 a[236:239], v3 offset:13312
    v_cvt_pk_bf16_f32 v222, v244, v245
    v_or3_b32 v57, v57, v221, v222
    v_mfma_f32_16x16x32_bf16 a[108:111], a[244:247], v[204:207], a[108:111]
    s_waitcnt lgkmcnt(12)
    v_exp_f32 v247, v191
    v_mfma_f32_16x16x32_bf16 a[120:123], a[248:251], v[192:195], a[120:123]
    buffer_load_dwordx4 v93, s[12:15], s61 offen offset:3072 lds
    ds_read_b128 a[240:243], v3 offset:6144
    ds_read_b128 a[244:247], v3 offset:14336
    v_mfma_f32_16x16x32_bf16 a[120:123], a[252:255], v[200:203], a[120:123]
    s_add_u32 s61, s61, 0x20000
    s_and_b32 s61, s61, 0x3fffff
    v_cvt_pk_bf16_f32 v223, v246, v247
    v_bitop3_b32 v57, v57, v223, s37 bitop3:0xa8
    v_mfma_f32_16x16x32_bf16 a[124:127], a[248:251], v[196:199], a[124:127]
    v_cmp_ne_u32 vcc, 0, v57
    v_mfma_f32_16x16x32_bf16 a[124:127], a[252:255], v[204:207], a[124:127]
    buffer_load_dword v74, v73, s[16:19], s59 offen sc1
    ds_read_b128 a[248:251], v3 offset:7168
    ds_read_b128 a[252:255], v3 offset:15360
    s_cbranch_vccnz k2_tramp_120
k2_ret_121:
    v_lshrrev_b32 v6, 4, v1
    v_and_b32 v6, 31, v6
    s_getpc_b64 s[40:41]
pc_124:
    s_add_u32 s40, s40, op_head-pc_124
    s_addc_u32 s41, s41, 0
    v_lshlrev_b32 v224, 7, v6
    v_mov_b32 v225, s41
    v_add_co_u32 v224, vcc, s40, v224
    s_nop 1
    v_addc_co_u32 v225, vcc, 0, v225, vcc
    global_load_dword v7, v[224:225], off
    v_mfma_f32_16x16x32_bf16 v[252:255], v[60:63], v[212:215], v[252:255]
    s_lshl_b32 s31, s28, 19
    v_mov_b32 v249, v248
    s_nop 1
    v_permlane16_swap_b32 v248, v249
    v_mfma_f32_16x16x32_bf16 v[252:255], v[60:63], v[220:223], v[252:255]
    s_waitcnt lgkmcnt(0)
    s_nop 1
    v_add_f32 v248, v248, v249
    v_mov_b32 v249, v248
    v_mfma_f32_16x16x32_bf16 a[12:15], a[192:195], v[212:215], a[12:15]
    s_lshl_b32 s44, s39, 6
    s_nop 1
    v_permlane32_swap_b32 v248, v249
    s_nop 1
    v_mfma_f32_16x16x32_bf16 a[12:15], a[196:199], v[220:223], a[12:15]
    s_add_u32 s44, s44, s31
    s_add_u32 s45, s44, 131072
    v_add_f32 v248, v248, v249
    v_rcp_f32 v249, v248
    v_mfma_f32_16x16x32_bf16 a[28:31], a[200:203], v[212:215], a[28:31]
    s_add_u32 s46, s44, 262144
    v_rcp_f32 v248, v248
    s_nop 0
    s_add_u32 s47, s44, 393216
    v_mfma_f32_16x16x32_bf16 a[28:31], a[204:207], v[220:223], a[28:31]
    s_add_u32 s48, s44, 4096
    v_accvgpr_read_b32 v132, a8
    v_accvgpr_read_b32 v133, a9
    v_accvgpr_read_b32 v134, a10
    v_mfma_f32_16x16x32_bf16 a[44:47], a[208:211], v[212:215], a[44:47]
    s_add_u32 s49, s44, 135168
    v_accvgpr_read_b32 v135, a11
    v_accvgpr_read_b32 v136, a24
    v_accvgpr_read_b32 v137, a25
    v_mfma_f32_16x16x32_bf16 a[44:47], a[212:215], v[220:223], a[44:47]
    s_add_u32 s50, s44, 266240
    v_accvgpr_read_b32 v138, a26
    v_accvgpr_read_b32 v139, a27
    v_mul_f32 v132, v132, v248
    v_mfma_f32_16x16x32_bf16 a[60:63], a[216:219], v[212:215], a[60:63]
    s_add_u32 s51, s44, 397312
    v_mul_f32 v133, v133, v248
    v_mul_f32 v134, v134, v248
    v_mul_f32 v135, v135, v248
    v_mfma_f32_16x16x32_bf16 a[60:63], a[220:223], v[220:223], a[60:63]
    v_mul_f32 v136, v136, v248
    v_mul_f32 v137, v137, v248
    v_mul_f32 v138, v138, v248
    v_mfma_f32_16x16x32_bf16 a[76:79], a[224:227], v[212:215], a[76:79]
    v_mul_f32 v139, v139, v248
    v_cvt_pk_bf16_f32 v128, v132, v133
    v_cvt_pk_bf16_f32 v129, v134, v135
    v_mfma_f32_16x16x32_bf16 a[76:79], a[228:231], v[220:223], a[76:79]
    v_cvt_pk_bf16_f32 v130, v136, v137
    v_cvt_pk_bf16_f32 v131, v138, v139
    buffer_store_dwordx4 v[128:131], v1, s[24:27], s44 offen sc1
    v_mfma_f32_16x16x32_bf16 a[92:95], a[232:235], v[212:215], a[92:95]
    v_accvgpr_read_b32 v144, a40
    v_accvgpr_read_b32 v145, a41
    v_accvgpr_read_b32 v146, a42
    v_mfma_f32_16x16x32_bf16 a[92:95], a[236:239], v[220:223], a[92:95]
    v_accvgpr_read_b32 v147, a43
    v_accvgpr_read_b32 v148, a56
    v_mov_b32 v253, v252
    v_mfma_f32_16x16x32_bf16 a[108:111], a[240:243], v[212:215], a[108:111]
    v_accvgpr_read_b32 v149, a57
    v_accvgpr_read_b32 v150, a58
    s_nop 1
    v_mfma_f32_16x16x32_bf16 a[108:111], a[244:247], v[220:223], a[108:111]
    v_accvgpr_read_b32 v151, a59
    v_permlane16_swap_b32 v252, v253
    v_mul_f32 v144, v144, v248
    v_mfma_f32_16x16x32_bf16 a[124:127], a[248:251], v[212:215], a[124:127]
    s_nop 1
    v_mul_f32 v145, v145, v248
    v_add_f32 v252, v252, v253
    v_mfma_f32_16x16x32_bf16 a[124:127], a[252:255], v[220:223], a[124:127]
    v_mul_f32 v146, v146, v248
    v_mov_b32 v253, v252
    v_mul_f32 v147, v147, v248
    s_nop 1
    v_mul_f32 v148, v148, v248
    v_mul_f32 v149, v149, v248
    v_permlane32_swap_b32 v252, v253
    v_mul_f32 v150, v150, v248
    s_nop 1
    v_mul_f32 v151, v151, v248
    v_add_f32 v252, v252, v253
    v_cvt_pk_bf16_f32 v140, v144, v145
    v_rcp_f32 v253, v252
    v_cvt_pk_bf16_f32 v141, v146, v147
    v_rcp_f32 v252, v252
    v_cvt_pk_bf16_f32 v142, v148, v149
    s_nop 0
    v_cvt_pk_bf16_f32 v143, v150, v151
    buffer_store_dwordx4 v[140:143], v1, s[24:27], s45 offen sc1
    v_accvgpr_read_b32 v156, a72
    v_accvgpr_read_b32 v157, a73
    v_accvgpr_read_b32 v158, a74
    v_accvgpr_read_b32 v159, a75
    v_accvgpr_read_b32 v160, a88
    v_accvgpr_read_b32 v161, a89
    v_accvgpr_read_b32 v162, a90
    v_accvgpr_read_b32 v163, a91
    v_mul_f32 v156, v156, v248
    v_mul_f32 v157, v157, v248
    v_mul_f32 v158, v158, v248
    v_mul_f32 v159, v159, v248
    v_mul_f32 v160, v160, v248
    v_mul_f32 v161, v161, v248
    v_mul_f32 v162, v162, v248
    v_mul_f32 v163, v163, v248
    v_cvt_pk_bf16_f32 v152, v156, v157
    v_cvt_pk_bf16_f32 v153, v158, v159
    v_cvt_pk_bf16_f32 v154, v160, v161
    v_cvt_pk_bf16_f32 v155, v162, v163
    buffer_store_dwordx4 v[152:155], v1, s[24:27], s46 offen sc1
    v_accvgpr_read_b32 v168, a104
    v_accvgpr_read_b32 v169, a105
    v_accvgpr_read_b32 v170, a106
    v_accvgpr_read_b32 v171, a107
    v_accvgpr_read_b32 v172, a120
    v_accvgpr_read_b32 v173, a121
    v_accvgpr_read_b32 v174, a122
    v_accvgpr_read_b32 v175, a123
    v_mul_f32 v168, v168, v248
    v_mul_f32 v169, v169, v248
    v_mul_f32 v170, v170, v248
    v_mul_f32 v171, v171, v248
    v_mul_f32 v172, v172, v248
    v_mul_f32 v173, v173, v248
    v_mul_f32 v174, v174, v248
    v_mul_f32 v175, v175, v248
    v_cvt_pk_bf16_f32 v164, v168, v169
    v_cvt_pk_bf16_f32 v165, v170, v171
    v_cvt_pk_bf16_f32 v166, v172, v173
    v_cvt_pk_bf16_f32 v167, v174, v175
    buffer_store_dwordx4 v[164:167], v1, s[24:27], s47 offen sc1
    v_accvgpr_read_b32 v132, a12
    v_accvgpr_read_b32 v133, a13
    v_accvgpr_read_b32 v134, a14
    v_accvgpr_read_b32 v135, a15
    v_accvgpr_read_b32 v136, a28
    v_accvgpr_read_b32 v137, a29
    v_accvgpr_read_b32 v138, a30
    v_accvgpr_read_b32 v139, a31
    v_pk_mul_f32 v[132:133], v[132:133], v[252:253]
    v_pk_mul_f32 v[134:135], v[134:135], v[252:253]
    v_pk_mul_f32 v[136:137], v[136:137], v[252:253]
    v_pk_mul_f32 v[138:139], v[138:139], v[252:253]
    v_cvt_pk_bf16_f32 v128, v132, v133
    v_cvt_pk_bf16_f32 v129, v134, v135
    v_cvt_pk_bf16_f32 v130, v136, v137
    v_cvt_pk_bf16_f32 v131, v138, v139
    v_accvgpr_read_b32 v144, a44
    v_accvgpr_read_b32 v145, a45
    v_accvgpr_read_b32 v146, a46
    v_accvgpr_read_b32 v147, a47
    v_accvgpr_read_b32 v148, a60
    v_accvgpr_read_b32 v149, a61
    v_accvgpr_read_b32 v150, a62
    v_accvgpr_read_b32 v151, a63
    v_pk_mul_f32 v[144:145], v[144:145], v[252:253]
    v_pk_mul_f32 v[146:147], v[146:147], v[252:253]
    v_pk_mul_f32 v[148:149], v[148:149], v[252:253]
    v_pk_mul_f32 v[150:151], v[150:151], v[252:253]
    v_cvt_pk_bf16_f32 v140, v144, v145
    v_cvt_pk_bf16_f32 v141, v146, v147
    v_cvt_pk_bf16_f32 v142, v148, v149
    v_cvt_pk_bf16_f32 v143, v150, v151
    v_accvgpr_read_b32 v156, a76
    v_accvgpr_read_b32 v157, a77
    v_accvgpr_read_b32 v158, a78
    v_accvgpr_read_b32 v159, a79
    v_accvgpr_read_b32 v160, a92
    v_accvgpr_read_b32 v161, a93
    v_accvgpr_read_b32 v162, a94
    v_accvgpr_read_b32 v163, a95
    v_pk_mul_f32 v[156:157], v[156:157], v[252:253]
    v_pk_mul_f32 v[158:159], v[158:159], v[252:253]
    v_pk_mul_f32 v[160:161], v[160:161], v[252:253]
    v_pk_mul_f32 v[162:163], v[162:163], v[252:253]
    v_cvt_pk_bf16_f32 v152, v156, v157
    v_cvt_pk_bf16_f32 v153, v158, v159
    v_cvt_pk_bf16_f32 v154, v160, v161
    v_cvt_pk_bf16_f32 v155, v162, v163
    v_accvgpr_read_b32 v168, a108
    v_accvgpr_read_b32 v169, a109
    v_accvgpr_read_b32 v170, a110
    v_accvgpr_read_b32 v171, a111
    v_accvgpr_read_b32 v172, a124
    v_accvgpr_read_b32 v173, a125
    v_accvgpr_read_b32 v174, a126
    v_accvgpr_read_b32 v175, a127
    v_pk_mul_f32 v[168:169], v[168:169], v[252:253]
    v_pk_mul_f32 v[170:171], v[170:171], v[252:253]
    v_pk_mul_f32 v[172:173], v[172:173], v[252:253]
    v_pk_mul_f32 v[174:175], v[174:175], v[252:253]
    v_cvt_pk_bf16_f32 v164, v168, v169
    v_cvt_pk_bf16_f32 v165, v170, v171
    v_cvt_pk_bf16_f32 v166, v172, v173
    v_cvt_pk_bf16_f32 v167, v174, v175
    buffer_store_dwordx4 v[128:131], v1, s[24:27], s48 offen sc1
    buffer_store_dwordx4 v[140:143], v1, s[24:27], s49 offen sc1
    buffer_store_dwordx4 v[152:155], v1, s[24:27], s50 offen sc1
    buffer_store_dwordx4 v[164:167], v1, s[24:27], s51 offen sc1
op_head:
    s_load_dwordx2 s[28:29], s[0:1], 0
    s_load_dwordx2 s[42:43], s[0:1], 56
    s_waitcnt vmcnt(8)
    v_cmp_le_u32 vcc, 4, v74
    v_mov_b32 v56, 0
    v_mov_b32 v57, 0
    v_mov_b32 v58, 0
    v_mov_b32 v59, 0
    s_nop 1
    v_mfma_f32_32x32x16_bf16 v[128:143], v[56:59], v[56:59], 0
    v_mfma_f32_32x32x16_bf16 v[144:159], v[56:59], v[56:59], 0
    v_mfma_f32_32x32x16_bf16 v[160:175], v[56:59], v[56:59], 0
    v_mfma_f32_32x32x16_bf16 v[176:191], v[56:59], v[56:59], 0
    s_mov_b32 s33, vcc_lo
    s_bitcmp1_b32 s33, 0
    s_cbranch_scc0 op_late_125
    buffer_load_dwordx4 a[128:131], v88, s[8:11], s62 offen offset:0 sc1
    buffer_load_dwordx4 a[132:135], v88, s[8:11], s62 offen offset:1024 sc1
    buffer_load_dwordx4 a[136:139], v89, s[8:11], s62 offen offset:0 sc1
    buffer_load_dwordx4 a[140:143], v89, s[8:11], s62 offen offset:1024 sc1
    s_add_u32 s62, s62, 0x40000
    s_and_b32 s62, s62, 0x7fffff
    buffer_load_dwordx4 a[144:147], v88, s[8:11], s62 offen offset:0 sc1
    buffer_load_dwordx4 a[148:151], v88, s[8:11], s62 offen offset:1024 sc1
    buffer_load_dwordx4 a[152:155], v89, s[8:11], s62 offen offset:0 sc1
    buffer_load_dwordx4 a[156:159], v89, s[8:11], s62 offen offset:1024 sc1
    s_add_u32 s62, s62, 0x40000
    s_and_b32 s62, s62, 0x7fffff
    buffer_load_dwordx4 a[160:163], v88, s[8:11], s62 offen offset:0 sc1
    buffer_load_dwordx4 a[164:167], v88, s[8:11], s62 offen offset:1024 sc1
    buffer_load_dwordx4 a[168:171], v89, s[8:11], s62 offen offset:0 sc1
    buffer_load_dwordx4 a[172:175], v89, s[8:11], s62 offen offset:1024 sc1
    s_add_u32 s62, s62, 0x40000
    s_and_b32 s62, s62, 0x7fffff
    s_waitcnt vmcnt(12)
    s_branch op_join_126
op_late_125:
    s_waitcnt vmcnt(0)
op_join_126:
    s_barrier
    s_cmp_eq_u32 s30, 0
    s_cbranch_scc1 k12_ool_127
k12_oolret_128:
    s_bitcmp0_b32 s33, 0
    s_cbranch_scc1 k12_ool_131
k12_oolret_132:
    ds_read_b64_tr_b16 a[0:1], v64 offset:0
    ds_read_b64_tr_b16 a[2:3], v64 offset:4096
    ds_read_b64_tr_b16 a[4:5], v65 offset:0
    ds_read_b64_tr_b16 a[6:7], v65 offset:4096
    ds_read_b64_tr_b16 a[8:9], v66 offset:0
    ds_read_b64_tr_b16 a[10:11], v66 offset:4096
    ds_read_b64_tr_b16 a[12:13], v67 offset:0
    ds_read_b64_tr_b16 a[14:15], v67 offset:4096
    ds_read_b64_tr_b16 a[16:17], v68 offset:0
    ds_read_b64_tr_b16 a[18:19], v68 offset:4096
    ds_read_b64_tr_b16 a[20:21], v69 offset:0
    ds_read_b64_tr_b16 a[22:23], v69 offset:4096
    ds_read_b64_tr_b16 a[24:25], v70 offset:0
    ds_read_b64_tr_b16 a[26:27], v70 offset:4096
    ds_read_b64_tr_b16 a[28:29], v71 offset:0
    ds_read_b64_tr_b16 a[30:31], v71 offset:4096
    ds_read_b64_tr_b16 a[32:33], v64 offset:8192
    ds_read_b64_tr_b16 a[34:35], v64 offset:12288
    ds_read_b64_tr_b16 a[36:37], v65 offset:8192
    ds_read_b64_tr_b16 a[38:39], v65 offset:12288
    ds_read_b64_tr_b16 a[40:41], v66 offset:8192
    ds_read_b64_tr_b16 a[42:43], v66 offset:12288
    ds_read_b64_tr_b16 a[44:45], v67 offset:8192
    ds_read_b64_tr_b16 a[46:47], v67 offset:12288
    ds_read_b64_tr_b16 a[48:49], v68 offset:8192
    ds_read_b64_tr_b16 a[50:51], v68 offset:12288
    ds_read_b64_tr_b16 a[52:53], v69 offset:8192
    ds_read_b64_tr_b16 a[54:55], v69 offset:12288
    ds_read_b64_tr_b16 a[56:57], v70 offset:8192
    ds_read_b64_tr_b16 a[58:59], v70 offset:12288
    ds_read_b64_tr_b16 a[60:61], v71 offset:8192
    ds_read_b64_tr_b16 a[62:63], v71 offset:12288
    s_add_u32 s24, s6, 0x4000000
    s_addc_u32 s25, s7, 0
    s_and_b32 s25, s25, 0xffff
    s_mov_b32 s26, 0x400000
    s_mov_b32 s27, 0x00020000
    s_add_u32 s36, s6, 0x5000000
    s_addc_u32 s37, s7, 0
    s_and_b32 s37, s37, 0xffff
    s_mov_b32 s38, 0x800000
    s_mov_b32 s39, 0x00020000
    s_add_u32 s48, s6, 0x4807000
    s_addc_u32 s49, s7, 0
    s_and_b32 s49, s49, 0xffff
    s_mov_b32 s50, 0x8000
    s_mov_b32 s51, 0x00020000
    s_lshl_b32 s52, s2, 14
    s_add_u32 s52, s52, s60
    s_xor_b32 s53, s52, 0x10000
    s_lshl_b32 s57, s2, 7
    s_xor_b32 s58, s57, 0x200
    v_lshrrev_b32 v56, 4, v1
    s_lshl_b32 s31, s30, 6
    s_and_b32 s31, s31, 64
    v_add_u32 v56, s31, v56
    s_mov_b32 s31, (code_end-op_tail)/128
    v_min_u32 v56, s31, v56
    s_getpc_b64 s[40:41]
pc_133:
    s_add_u32 s40, s40, op_tail-pc_133
    s_addc_u32 s41, s41, 0
    v_lshlrev_b32 v82, 7, v56
    v_mov_b32 v83, s41
    v_add_co_u32 v82, vcc, s40, v82
    s_nop 1
    v_addc_co_u32 v83, vcc, 0, v83, vcc
    v_lshlrev_b32 v94, 3, v1
    s_and_b32 s35, s2, 7
    s_mul_i32 s35, s35, 28
    s_lshr_b32 s31, s2, 3
    s_add_u32 s55, s35, s31
    s_lshl_b32 s3, s55, 15
    s_lshl_b32 s31, s30, 13
    s_add_u32 s3, s3, s31
    s_add_u32 s35, s31, 65536
    s_mov_b32 s63, 0
    s_waitcnt vmcnt(8) lgkmcnt(0)
    s_mov_b32 s20, s28
    s_and_b32 s21, s29, 0xffff
    s_mov_b32 s22, 0x400000
    s_mov_b32 s23, 0x00020000
    s_mov_b32 s44, s42
    s_and_b32 s45, s43, 0xffff
    s_mov_b32 s46, 0x800
    s_mov_b32 s47, 0x00020000
op_loop_134:
    v_mfma_f32_16x16x32_bf16 v[160:163], a[16:19], a[128:131], v[160:163]
    s_add_u32 m0, s60, 49152
    ds_read_b64_tr_b16 a[64:65], v64 offset:16384
    ds_read_b64_tr_b16 a[66:67], v64 offset:20480
    v_mfma_f32_16x16x32_bf16 v[160:163], a[48:51], a[136:139], v[160:163]
    buffer_load_dwordx4 v90, s[12:15], s61 offen offset:0 lds
    ds_read_b64_tr_b16 a[68:69], v65 offset:16384
    v_mfma_f32_16x16x32_bf16 v[164:167], a[16:19], a[132:135], v[164:167]
    ds_read_b64_tr_b16 a[70:71], v65 offset:20480
    ds_read_b64_tr_b16 a[72:73], v66 offset:16384
    v_mfma_f32_16x16x32_bf16 v[164:167], a[48:51], a[140:143], v[164:167]
    buffer_load_dwordx4 v91, s[12:15], s61 offen offset:1024 lds
    ds_read_b64_tr_b16 a[74:75], v66 offset:20480
    v_mfma_f32_16x16x32_bf16 v[168:171], a[20:23], a[128:131], v[168:171]
    ds_read_b64_tr_b16 a[76:77], v67 offset:16384
    ds_read_b64_tr_b16 a[78:79], v67 offset:20480
    v_mfma_f32_16x16x32_bf16 v[168:171], a[52:55], a[136:139], v[168:171]
    ds_read_b64_tr_b16 a[80:81], v68 offset:16384
    v_mfma_f32_16x16x32_bf16 v[172:175], a[20:23], a[132:135], v[172:175]
    ds_read_b64_tr_b16 a[82:83], v68 offset:20480
    v_mfma_f32_16x16x32_bf16 v[172:175], a[52:55], a[140:143], v[172:175]
    buffer_load_dwordx4 v92, s[12:15], s61 offen offset:2048 lds
    ds_read_b64_tr_b16 a[84:85], v69 offset:16384
    v_mfma_f32_16x16x32_bf16 v[176:179], a[24:27], a[128:131], v[176:179]
    ds_read_b64_tr_b16 a[86:87], v69 offset:20480
    ds_read_b64_tr_b16 a[88:89], v70 offset:16384
    v_mfma_f32_16x16x32_bf16 v[176:179], a[56:59], a[136:139], v[176:179]
    ds_read_b64_tr_b16 a[90:91], v70 offset:20480
    v_mfma_f32_16x16x32_bf16 v[180:183], a[24:27], a[132:135], v[180:183]
    buffer_load_dwordx4 v93, s[12:15], s61 offen offset:3072 lds
    ds_read_b64_tr_b16 a[92:93], v71 offset:16384
    v_mfma_f32_16x16x32_bf16 v[180:183], a[56:59], a[140:143], v[180:183]
    ds_read_b64_tr_b16 a[94:95], v71 offset:20480
    ds_read_b64_tr_b16 a[96:97], v64 offset:24576
    v_mfma_f32_16x16x32_bf16 v[184:187], a[28:31], a[128:131], v[184:187]
    ds_read_b64_tr_b16 a[98:99], v64 offset:28672
    v_mfma_f32_16x16x32_bf16 v[184:187], a[60:63], a[136:139], v[184:187]
    ds_read_b64_tr_b16 a[100:101], v65 offset:24576
    v_mfma_f32_16x16x32_bf16 v[188:191], a[28:31], a[132:135], v[188:191]
    buffer_load_dwordx4 a[176:179], v88, s[8:11], s62 offen offset:0 sc1
    ds_read_b64_tr_b16 a[102:103], v65 offset:28672
    v_mfma_f32_16x16x32_bf16 v[188:191], a[60:63], a[140:143], v[188:191]
    s_add_u32 s61, s61, 0x20000
    s_and_b32 s61, s61, 0x3fffff
    ds_read_b64_tr_b16 a[104:105], v66 offset:24576
    ds_read_b64_tr_b16 a[106:107], v66 offset:28672
    v_mfma_f32_16x16x32_bf16 v[128:131], a[0:3], a[128:131], v[128:131]
    ds_read_b64_tr_b16 a[108:109], v67 offset:24576
    v_mfma_f32_16x16x32_bf16 v[128:131], a[32:35], a[136:139], v[128:131]
    buffer_load_dwordx4 a[180:183], v88, s[8:11], s62 offen offset:1024 sc1
    ds_read_b64_tr_b16 a[110:111], v67 offset:28672
    v_mfma_f32_16x16x32_bf16 v[132:135], a[0:3], a[132:135], v[132:135]
    ds_read_b64_tr_b16 a[112:113], v68 offset:24576
    v_mfma_f32_16x16x32_bf16 v[132:135], a[32:35], a[140:143], v[132:135]
    ds_read_b64_tr_b16 a[114:115], v68 offset:28672
    ds_read_b64_tr_b16 a[116:117], v69 offset:24576
    v_mfma_f32_16x16x32_bf16 v[136:139], a[4:7], a[128:131], v[136:139]
    ds_read_b64_tr_b16 a[118:119], v69 offset:28672
    v_mfma_f32_16x16x32_bf16 v[136:139], a[36:39], a[136:139], v[136:139]
    buffer_load_dwordx4 a[184:187], v89, s[8:11], s62 offen offset:0 sc1
    ds_read_b64_tr_b16 a[120:121], v70 offset:24576
    v_mfma_f32_16x16x32_bf16 v[140:143], a[4:7], a[132:135], v[140:143]
    ds_read_b64_tr_b16 a[122:123], v70 offset:28672
    ds_read_b64_tr_b16 a[124:125], v71 offset:24576
    v_mfma_f32_16x16x32_bf16 v[140:143], a[36:39], a[140:143], v[140:143]
    ds_read_b64_tr_b16 a[126:127], v71 offset:28672
    v_mfma_f32_16x16x32_bf16 v[144:147], a[8:11], a[128:131], v[144:147]
    buffer_load_dwordx4 a[188:191], v89, s[8:11], s62 offen offset:1024 sc1
    v_mfma_f32_16x16x32_bf16 v[144:147], a[40:43], a[136:139], v[144:147]
    v_mfma_f32_16x16x32_bf16 v[148:151], a[8:11], a[132:135], v[148:151]
    v_mfma_f32_16x16x32_bf16 v[148:151], a[40:43], a[140:143], v[148:151]
    v_mfma_f32_16x16x32_bf16 v[152:155], a[12:15], a[128:131], v[152:155]
    s_cmp_eq_u32 s63, 7
    s_cbranch_scc1 k12_ool_137
k12_oolret_138:
    v_mfma_f32_16x16x32_bf16 v[152:155], a[44:47], a[136:139], v[152:155]
    s_add_u32 s62, s62, 0x40000
    s_and_b32 s62, s62, 0x7fffff
    v_mfma_f32_16x16x32_bf16 v[156:159], a[12:15], a[132:135], v[156:159]
    v_mfma_f32_16x16x32_bf16 v[156:159], a[44:47], a[140:143], v[156:159]
    s_waitcnt vmcnt(12) lgkmcnt(0)
    s_barrier
    v_mfma_f32_16x16x32_bf16 v[160:163], a[80:83], a[144:147], v[160:163]
    s_add_u32 s32, s63, 1
    s_lshr_b32 s32, s32, 1
    ds_read_b64_tr_b16 a[0:1], v64 offset:32768
    v_cmp_le_u32 vcc, 4, v74
    v_mfma_f32_16x16x32_bf16 v[160:163], a[112:115], a[152:155], v[160:163]
    s_add_u32 m0, s60, 0
    ds_read_b64_tr_b16 a[2:3], v64 offset:36864
    ds_read_b64_tr_b16 a[4:5], v65 offset:32768
    v_mfma_f32_16x16x32_bf16 v[164:167], a[80:83], a[148:151], v[164:167]
    s_or_b32 s33, vcc_lo, 16
    buffer_load_dwordx4 v90, s[12:15], s61 offen offset:0 lds
    ds_read_b64_tr_b16 a[6:7], v65 offset:36864
    v_mfma_f32_16x16x32_bf16 v[164:167], a[112:115], a[156:159], v[164:167]
    ds_read_b64_tr_b16 a[8:9], v66 offset:32768
    ds_read_b64_tr_b16 a[10:11], v66 offset:36864
    v_mfma_f32_16x16x32_bf16 v[168:171], a[84:87], a[144:147], v[168:171]
    buffer_load_dwordx4 v91, s[12:15], s61 offen offset:1024 lds
    ds_read_b64_tr_b16 a[12:13], v67 offset:32768
    v_mfma_f32_16x16x32_bf16 v[168:171], a[116:119], a[152:155], v[168:171]
    ds_read_b64_tr_b16 a[14:15], v67 offset:36864
    ds_read_b64_tr_b16 a[16:17], v68 offset:32768
    v_mfma_f32_16x16x32_bf16 v[172:175], a[84:87], a[148:151], v[172:175]
    s_bitcmp0_b32 s33, s32
    s_cbranch_scc1 k12_ool_141
k12_oolret_142:
    v_mfma_f32_16x16x32_bf16 v[172:175], a[116:119], a[156:159], v[172:175]
    ds_read_b64_tr_b16 a[18:19], v68 offset:36864
    ds_read_b64_tr_b16 a[20:21], v69 offset:32768
    v_mfma_f32_16x16x32_bf16 v[176:179], a[88:91], a[144:147], v[176:179]
    buffer_load_dwordx4 v92, s[12:15], s61 offen offset:2048 lds
    ds_read_b64_tr_b16 a[22:23], v69 offset:36864
    v_mfma_f32_16x16x32_bf16 v[176:179], a[120:123], a[152:155], v[176:179]
    ds_read_b64_tr_b16 a[24:25], v70 offset:32768
    ds_read_b64_tr_b16 a[26:27], v70 offset:36864
    v_mfma_f32_16x16x32_bf16 v[180:183], a[88:91], a[148:151], v[180:183]
    buffer_load_dwordx4 v93, s[12:15], s61 offen offset:3072 lds
    ds_read_b64_tr_b16 a[28:29], v71 offset:32768
    v_mfma_f32_16x16x32_bf16 v[180:183], a[120:123], a[156:159], v[180:183]
    ds_read_b64_tr_b16 a[30:31], v71 offset:36864
    ds_read_b64_tr_b16 a[32:33], v64 offset:40960
    v_mfma_f32_16x16x32_bf16 v[184:187], a[92:95], a[144:147], v[184:187]
    ds_read_b64_tr_b16 a[34:35], v64 offset:45056
    v_mfma_f32_16x16x32_bf16 v[184:187], a[124:127], a[152:155], v[184:187]
    ds_read_b64_tr_b16 a[36:37], v65 offset:40960
    v_mfma_f32_16x16x32_bf16 v[188:191], a[92:95], a[148:151], v[188:191]
    buffer_load_dwordx4 a[128:131], v88, s[8:11], s62 offen offset:0 sc1
    ds_read_b64_tr_b16 a[38:39], v65 offset:45056
    v_mfma_f32_16x16x32_bf16 v[188:191], a[124:127], a[156:159], v[188:191]
    s_add_u32 s61, s61, 0x20000
    s_and_b32 s61, s61, 0x3fffff
    ds_read_b64_tr_b16 a[40:41], v66 offset:40960
    ds_read_b64_tr_b16 a[42:43], v66 offset:45056
    v_mfma_f32_16x16x32_bf16 v[128:131], a[64:67], a[144:147], v[128:131]
    ds_read_b64_tr_b16 a[44:45], v67 offset:40960
    v_mfma_f32_16x16x32_bf16 v[128:131], a[96:99], a[152:155], v[128:131]
    buffer_load_dwordx4 a[132:135], v88, s[8:11], s62 offen offset:1024 sc1
    ds_read_b64_tr_b16 a[46:47], v67 offset:45056
    v_mfma_f32_16x16x32_bf16 v[132:135], a[64:67], a[148:151], v[132:135]
    ds_read_b64_tr_b16 a[48:49], v68 offset:40960
    v_mfma_f32_16x16x32_bf16 v[132:135], a[96:99], a[156:159], v[132:135]
    ds_read_b64_tr_b16 a[50:51], v68 offset:45056
    ds_read_b64_tr_b16 a[52:53], v69 offset:40960
    v_mfma_f32_16x16x32_bf16 v[136:139], a[68:71], a[144:147], v[136:139]
    ds_read_b64_tr_b16 a[54:55], v69 offset:45056
    v_mfma_f32_16x16x32_bf16 v[136:139], a[100:103], a[152:155], v[136:139]
    buffer_load_dwordx4 a[136:139], v89, s[8:11], s62 offen offset:0 sc1
    ds_read_b64_tr_b16 a[56:57], v70 offset:40960
    v_mfma_f32_16x16x32_bf16 v[140:143], a[68:71], a[148:151], v[140:143]
    ds_read_b64_tr_b16 a[58:59], v70 offset:45056
    ds_read_b64_tr_b16 a[60:61], v71 offset:40960
    v_mfma_f32_16x16x32_bf16 v[140:143], a[100:103], a[156:159], v[140:143]
    ds_read_b64_tr_b16 a[62:63], v71 offset:45056
    v_mfma_f32_16x16x32_bf16 v[144:147], a[72:75], a[144:147], v[144:147]
    buffer_load_dwordx4 a[140:143], v89, s[8:11], s62 offen offset:1024 sc1
    v_mfma_f32_16x16x32_bf16 v[144:147], a[104:107], a[152:155], v[144:147]
    v_mfma_f32_16x16x32_bf16 v[148:151], a[72:75], a[148:151], v[148:151]
    s_cmp_eq_u32 s63, 6
    s_cbranch_scc1 k12_ool_143
k12_oolret_144:
    v_mfma_f32_16x16x32_bf16 v[148:151], a[104:107], a[156:159], v[148:151]
    v_mfma_f32_16x16x32_bf16 v[152:155], a[76:79], a[144:147], v[152:155]
    v_mfma_f32_16x16x32_bf16 v[152:155], a[108:111], a[152:155], v[152:155]
    s_add_u32 s62, s62, 0x40000
    s_and_b32 s62, s62, 0x7fffff
    v_mfma_f32_16x16x32_bf16 v[156:159], a[76:79], a[148:151], v[156:159]
    v_mfma_f32_16x16x32_bf16 v[156:159], a[108:111], a[156:159], v[156:159]
    s_waitcnt vmcnt(12) lgkmcnt(0)
    s_barrier
    v_mfma_f32_16x16x32_bf16 v[160:163], a[16:19], a[160:163], v[160:163]
    s_add_u32 m0, s60, 16384
    buffer_load_dword v74, v73, s[16:19], s59 offen sc1
    ds_read_b64_tr_b16 a[64:65], v64 offset:49152
    v_mfma_f32_16x16x32_bf16 v[160:163], a[48:51], a[168:171], v[160:163]
    buffer_load_dwordx4 v90, s[12:15], s61 offen offset:0 lds
    ds_read_b64_tr_b16 a[66:67], v64 offset:53248
    v_mfma_f32_16x16x32_bf16 v[164:167], a[16:19], a[164:167], v[164:167]
    ds_read_b64_tr_b16 a[68:69], v65 offset:49152
    ds_read_b64_tr_b16 a[70:71], v65 offset:53248
    v_mfma_f32_16x16x32_bf16 v[164:167], a[48:51], a[172:175], v[164:167]
    ds_read_b64_tr_b16 a[72:73], v66 offset:49152
    ds_read_b64_tr_b16 a[74:75], v66 offset:53248
    v_mfma_f32_16x16x32_bf16 v[168:171], a[20:23], a[160:163], v[168:171]
    buffer_load_dwordx4 v91, s[12:15], s61 offen offset:1024 lds
    ds_read_b64_tr_b16 a[76:77], v67 offset:49152
    v_mfma_f32_16x16x32_bf16 v[168:171], a[52:55], a[168:171], v[168:171]
    ds_read_b64_tr_b16 a[78:79], v67 offset:53248
    ds_read_b64_tr_b16 a[80:81], v68 offset:49152
    v_mfma_f32_16x16x32_bf16 v[172:175], a[20:23], a[164:167], v[172:175]
    ds_read_b64_tr_b16 a[82:83], v68 offset:53248
    v_mfma_f32_16x16x32_bf16 v[172:175], a[52:55], a[172:175], v[172:175]
    buffer_load_dwordx4 v92, s[12:15], s61 offen offset:2048 lds
    ds_read_b64_tr_b16 a[84:85], v69 offset:49152
    v_mfma_f32_16x16x32_bf16 v[176:179], a[24:27], a[160:163], v[176:179]
    ds_read_b64_tr_b16 a[86:87], v69 offset:53248
    ds_read_b64_tr_b16 a[88:89], v70 offset:49152
    v_mfma_f32_16x16x32_bf16 v[176:179], a[56:59], a[168:171], v[176:179]
    ds_read_b64_tr_b16 a[90:91], v70 offset:53248
    v_mfma_f32_16x16x32_bf16 v[180:183], a[24:27], a[164:167], v[180:183]
    buffer_load_dwordx4 v93, s[12:15], s61 offen offset:3072 lds
    ds_read_b64_tr_b16 a[92:93], v71 offset:49152
    v_mfma_f32_16x16x32_bf16 v[180:183], a[56:59], a[172:175], v[180:183]
    ds_read_b64_tr_b16 a[94:95], v71 offset:53248
    ds_read_b64_tr_b16 a[96:97], v64 offset:57344
    v_mfma_f32_16x16x32_bf16 v[184:187], a[28:31], a[160:163], v[184:187]
    ds_read_b64_tr_b16 a[98:99], v64 offset:61440
    v_mfma_f32_16x16x32_bf16 v[184:187], a[60:63], a[168:171], v[184:187]
    ds_read_b64_tr_b16 a[100:101], v65 offset:57344
    v_mfma_f32_16x16x32_bf16 v[188:191], a[28:31], a[164:167], v[188:191]
    buffer_load_dwordx4 a[144:147], v88, s[8:11], s62 offen offset:0 sc1
    ds_read_b64_tr_b16 a[102:103], v65 offset:61440
    v_mfma_f32_16x16x32_bf16 v[188:191], a[60:63], a[172:175], v[188:191]
    s_add_u32 s61, s61, 0x20000
    s_and_b32 s61, s61, 0x3fffff
    ds_read_b64_tr_b16 a[104:105], v66 offset:57344
    ds_read_b64_tr_b16 a[106:107], v66 offset:61440
    v_mfma_f32_16x16x32_bf16 v[128:131], a[0:3], a[160:163], v[128:131]
    ds_read_b64_tr_b16 a[108:109], v67 offset:57344
    v_mfma_f32_16x16x32_bf16 v[128:131], a[32:35], a[168:171], v[128:131]
    buffer_load_dwordx4 a[148:151], v88, s[8:11], s62 offen offset:1024 sc1
    ds_read_b64_tr_b16 a[110:111], v67 offset:61440
    v_mfma_f32_16x16x32_bf16 v[132:135], a[0:3], a[164:167], v[132:135]
    ds_read_b64_tr_b16 a[112:113], v68 offset:57344
    v_mfma_f32_16x16x32_bf16 v[132:135], a[32:35], a[172:175], v[132:135]
    ds_read_b64_tr_b16 a[114:115], v68 offset:61440
    ds_read_b64_tr_b16 a[116:117], v69 offset:57344
    v_mfma_f32_16x16x32_bf16 v[136:139], a[4:7], a[160:163], v[136:139]
    ds_read_b64_tr_b16 a[118:119], v69 offset:61440
    v_mfma_f32_16x16x32_bf16 v[136:139], a[36:39], a[168:171], v[136:139]
    buffer_load_dwordx4 a[152:155], v89, s[8:11], s62 offen offset:0 sc1
    ds_read_b64_tr_b16 a[120:121], v70 offset:57344
    v_mfma_f32_16x16x32_bf16 v[140:143], a[4:7], a[164:167], v[140:143]
    ds_read_b64_tr_b16 a[122:123], v70 offset:61440
    ds_read_b64_tr_b16 a[124:125], v71 offset:57344
    v_mfma_f32_16x16x32_bf16 v[140:143], a[36:39], a[172:175], v[140:143]
    ds_read_b64_tr_b16 a[126:127], v71 offset:61440
    v_mfma_f32_16x16x32_bf16 v[144:147], a[8:11], a[160:163], v[144:147]
    buffer_load_dwordx4 a[156:159], v89, s[8:11], s62 offen offset:1024 sc1
    v_mfma_f32_16x16x32_bf16 v[144:147], a[40:43], a[168:171], v[144:147]
    v_mfma_f32_16x16x32_bf16 v[148:151], a[8:11], a[164:167], v[148:151]
    v_mfma_f32_16x16x32_bf16 v[148:151], a[40:43], a[172:175], v[148:151]
    v_mfma_f32_16x16x32_bf16 v[152:155], a[12:15], a[160:163], v[152:155]
    v_mfma_f32_16x16x32_bf16 v[152:155], a[44:47], a[168:171], v[152:155]
    s_add_u32 s62, s62, 0x40000
    s_and_b32 s62, s62, 0x7fffff
    v_mfma_f32_16x16x32_bf16 v[156:159], a[12:15], a[164:167], v[156:159]
    v_mfma_f32_16x16x32_bf16 v[156:159], a[44:47], a[172:175], v[156:159]
    s_waitcnt vmcnt(12) lgkmcnt(0)
    s_barrier
    v_mfma_f32_16x16x32_bf16 v[160:163], a[80:83], a[176:179], v[160:163]
    s_add_u32 m0, s60, 32768
    ds_read_b64_tr_b16 a[0:1], v64 offset:0
    ds_read_b64_tr_b16 a[2:3], v64 offset:4096
    v_mfma_f32_16x16x32_bf16 v[160:163], a[112:115], a[184:187], v[160:163]
    buffer_load_dwordx4 v90, s[12:15], s61 offen offset:0 lds
    ds_read_b64_tr_b16 a[4:5], v65 offset:0
    v_mfma_f32_16x16x32_bf16 v[164:167], a[80:83], a[180:183], v[164:167]
    ds_read_b64_tr_b16 a[6:7], v65 offset:4096
    ds_read_b64_tr_b16 a[8:9], v66 offset:0
    v_mfma_f32_16x16x32_bf16 v[164:167], a[112:115], a[188:191], v[164:167]
    buffer_load_dwordx4 v91, s[12:15], s61 offen offset:1024 lds
    ds_read_b64_tr_b16 a[10:11], v66 offset:4096
    v_mfma_f32_16x16x32_bf16 v[168:171], a[84:87], a[176:179], v[168:171]
    ds_read_b64_tr_b16 a[12:13], v67 offset:0
    ds_read_b64_tr_b16 a[14:15], v67 offset:4096
    v_mfma_f32_16x16x32_bf16 v[168:171], a[116:119], a[184:187], v[168:171]
    ds_read_b64_tr_b16 a[16:17], v68 offset:0
    v_mfma_f32_16x16x32_bf16 v[172:175], a[84:87], a[180:183], v[172:175]
    ds_read_b64_tr_b16 a[18:19], v68 offset:4096
    v_mfma_f32_16x16x32_bf16 v[172:175], a[116:119], a[188:191], v[172:175]
    buffer_load_dwordx4 v92, s[12:15], s61 offen offset:2048 lds
    ds_read_b64_tr_b16 a[20:21], v69 offset:0
    v_mfma_f32_16x16x32_bf16 v[176:179], a[88:91], a[176:179], v[176:179]
    ds_read_b64_tr_b16 a[22:23], v69 offset:4096
    ds_read_b64_tr_b16 a[24:25], v70 offset:0
    v_mfma_f32_16x16x32_bf16 v[176:179], a[120:123], a[184:187], v[176:179]
    ds_read_b64_tr_b16 a[26:27], v70 offset:4096
    v_mfma_f32_16x16x32_bf16 v[180:183], a[88:91], a[180:183], v[180:183]
    buffer_load_dwordx4 v93, s[12:15], s61 offen offset:3072 lds
    ds_read_b64_tr_b16 a[28:29], v71 offset:0
    v_mfma_f32_16x16x32_bf16 v[180:183], a[120:123], a[188:191], v[180:183]
    ds_read_b64_tr_b16 a[30:31], v71 offset:4096
    ds_read_b64_tr_b16 a[32:33], v64 offset:8192
    v_mfma_f32_16x16x32_bf16 v[184:187], a[92:95], a[176:179], v[184:187]
    ds_read_b64_tr_b16 a[34:35], v64 offset:12288
    v_mfma_f32_16x16x32_bf16 v[184:187], a[124:127], a[184:187], v[184:187]
    ds_read_b64_tr_b16 a[36:37], v65 offset:8192
    v_mfma_f32_16x16x32_bf16 v[188:191], a[92:95], a[180:183], v[188:191]
    buffer_load_dwordx4 a[160:163], v88, s[8:11], s62 offen offset:0 sc1
    ds_read_b64_tr_b16 a[38:39], v65 offset:12288
    v_mfma_f32_16x16x32_bf16 v[188:191], a[124:127], a[188:191], v[188:191]
    s_add_u32 s61, s61, 0x20000
    s_and_b32 s61, s61, 0x3fffff
    ds_read_b64_tr_b16 a[40:41], v66 offset:8192
    ds_read_b64_tr_b16 a[42:43], v66 offset:12288
    v_mfma_f32_16x16x32_bf16 v[128:131], a[64:67], a[176:179], v[128:131]
    ds_read_b64_tr_b16 a[44:45], v67 offset:8192
    v_mfma_f32_16x16x32_bf16 v[128:131], a[96:99], a[184:187], v[128:131]
    buffer_load_dwordx4 a[164:167], v88, s[8:11], s62 offen offset:1024 sc1
    ds_read_b64_tr_b16 a[46:47], v67 offset:12288
    v_mfma_f32_16x16x32_bf16 v[132:135], a[64:67], a[180:183], v[132:135]
    ds_read_b64_tr_b16 a[48:49], v68 offset:8192
    v_mfma_f32_16x16x32_bf16 v[132:135], a[96:99], a[188:191], v[132:135]
    ds_read_b64_tr_b16 a[50:51], v68 offset:12288
    ds_read_b64_tr_b16 a[52:53], v69 offset:8192
    v_mfma_f32_16x16x32_bf16 v[136:139], a[68:71], a[176:179], v[136:139]
    ds_read_b64_tr_b16 a[54:55], v69 offset:12288
    v_mfma_f32_16x16x32_bf16 v[136:139], a[100:103], a[184:187], v[136:139]
    buffer_load_dwordx4 a[168:171], v89, s[8:11], s62 offen offset:0 sc1
    ds_read_b64_tr_b16 a[56:57], v70 offset:8192
    v_mfma_f32_16x16x32_bf16 v[140:143], a[68:71], a[180:183], v[140:143]
    ds_read_b64_tr_b16 a[58:59], v70 offset:12288
    ds_read_b64_tr_b16 a[60:61], v71 offset:8192
    v_mfma_f32_16x16x32_bf16 v[140:143], a[100:103], a[188:191], v[140:143]
    ds_read_b64_tr_b16 a[62:63], v71 offset:12288
    v_mfma_f32_16x16x32_bf16 v[144:147], a[72:75], a[176:179], v[144:147]
    buffer_load_dwordx4 a[172:175], v89, s[8:11], s62 offen offset:1024 sc1
    v_mfma_f32_16x16x32_bf16 v[144:147], a[104:107], a[184:187], v[144:147]
    v_mfma_f32_16x16x32_bf16 v[148:151], a[72:75], a[180:183], v[148:151]
    v_mfma_f32_16x16x32_bf16 v[148:151], a[104:107], a[188:191], v[148:151]
    v_mfma_f32_16x16x32_bf16 v[152:155], a[76:79], a[176:179], v[152:155]
    v_mfma_f32_16x16x32_bf16 v[152:155], a[108:111], a[184:187], v[152:155]
    s_add_u32 s62, s62, 0x40000
    s_and_b32 s62, s62, 0x7fffff
    v_mfma_f32_16x16x32_bf16 v[156:159], a[76:79], a[180:183], v[156:159]
    s_add_u32 s63, s63, 1
    v_mfma_f32_16x16x32_bf16 v[156:159], a[108:111], a[188:191], v[156:159]
    s_waitcnt vmcnt(12) lgkmcnt(0)
    s_barrier
    s_cmp_lt_u32 s63, 8
    s_cbranch_scc1 op_loop_134
op_tail:
    s_nop 1
    v_cvt_pk_bf16_f32 v160, v160, v161
    v_cvt_pk_bf16_f32 v161, v162, v163
    v_cvt_pk_bf16_f32 v162, v164, v165
    v_cvt_pk_bf16_f32 v163, v166, v167
    v_min_u32 v160, -2, v160
    v_min_u32 v161, -2, v161
    v_min_u32 v162, -2, v162
    v_min_u32 v163, -2, v163
    buffer_store_dwordx4 v[160:163], v1, s[36:39], s52 offen offset:0 sc1
    v_cvt_pk_bf16_f32 v168, v168, v169
    v_cvt_pk_bf16_f32 v169, v170, v171
    v_cvt_pk_bf16_f32 v170, v172, v173
    v_cvt_pk_bf16_f32 v171, v174, v175
    v_min_u32 v168, -2, v168
    v_min_u32 v169, -2, v169
    v_min_u32 v170, -2, v170
    v_min_u32 v171, -2, v171
    buffer_store_dwordx4 v[168:171], v1, s[36:39], s52 offen offset:1024 sc1
    v_cvt_pk_bf16_f32 v176, v176, v177
    v_cvt_pk_bf16_f32 v177, v178, v179
    v_cvt_pk_bf16_f32 v178, v180, v181
    v_cvt_pk_bf16_f32 v179, v182, v183
    v_min_u32 v176, -2, v176
    v_min_u32 v177, -2, v177
    v_min_u32 v178, -2, v178
    v_min_u32 v179, -2, v179
    buffer_store_dwordx4 v[176:179], v1, s[36:39], s52 offen offset:2048 sc1
    v_cvt_pk_bf16_f32 v184, v184, v185
    v_cvt_pk_bf16_f32 v185, v186, v187
    v_cvt_pk_bf16_f32 v186, v188, v189
    v_cvt_pk_bf16_f32 v187, v190, v191
    v_min_u32 v184, -2, v184
    v_min_u32 v185, -2, v185
    v_min_u32 v186, -2, v186
    v_min_u32 v187, -2, v187
    buffer_store_dwordx4 v[184:187], v1, s[36:39], s52 offen offset:3072 sc1
    s_add_u32 s32, s6, 0x4800000
    s_addc_u32 s33, s7, 0
    s_and_b32 s33, s33, 0xffff
    s_mov_b32 s34, 0x6000
    s_mov_b32 s35, 0x00020000
    s_waitcnt vmcnt(4) lgkmcnt(0)
    v_lshlrev_b32 v58, 16, v192
    v_and_b32 v59, 0xffff0000, v192
    v_pk_add_f32 v[128:129], v[128:129], v[58:59]
    v_lshlrev_b32 v58, 16, v193
    v_and_b32 v59, 0xffff0000, v193
    v_pk_add_f32 v[130:131], v[130:131], v[58:59]
    v_lshlrev_b32 v58, 16, v200
    v_and_b32 v59, 0xffff0000, v200
    v_pk_add_f32 v[132:133], v[132:133], v[58:59]
    v_lshlrev_b32 v58, 16, v201
    v_and_b32 v59, 0xffff0000, v201
    v_pk_add_f32 v[134:135], v[134:135], v[58:59]
    v_lshlrev_b32 v58, 16, v194
    v_and_b32 v59, 0xffff0000, v194
    v_pk_add_f32 v[136:137], v[136:137], v[58:59]
    v_lshlrev_b32 v58, 16, v195
    v_and_b32 v59, 0xffff0000, v195
    v_pk_add_f32 v[138:139], v[138:139], v[58:59]
    v_lshlrev_b32 v58, 16, v202
    v_and_b32 v59, 0xffff0000, v202
    v_pk_add_f32 v[140:141], v[140:141], v[58:59]
    v_lshlrev_b32 v58, 16, v203
    v_and_b32 v59, 0xffff0000, v203
    v_pk_add_f32 v[142:143], v[142:143], v[58:59]
    v_lshlrev_b32 v58, 16, v196
    v_and_b32 v59, 0xffff0000, v196
    v_pk_add_f32 v[144:145], v[144:145], v[58:59]
    v_lshlrev_b32 v58, 16, v197
    v_and_b32 v59, 0xffff0000, v197
    v_pk_add_f32 v[146:147], v[146:147], v[58:59]
    v_lshlrev_b32 v58, 16, v204
    v_and_b32 v59, 0xffff0000, v204
    v_pk_add_f32 v[148:149], v[148:149], v[58:59]
    v_lshlrev_b32 v58, 16, v205
    v_and_b32 v59, 0xffff0000, v205
    v_pk_add_f32 v[150:151], v[150:151], v[58:59]
    v_lshlrev_b32 v58, 16, v198
    v_and_b32 v59, 0xffff0000, v198
    v_pk_add_f32 v[152:153], v[152:153], v[58:59]
    v_lshlrev_b32 v58, 16, v199
    v_and_b32 v59, 0xffff0000, v199
    v_pk_add_f32 v[154:155], v[154:155], v[58:59]
    v_lshlrev_b32 v58, 16, v206
    v_and_b32 v59, 0xffff0000, v206
    v_pk_add_f32 v[156:157], v[156:157], v[58:59]
    v_lshlrev_b32 v58, 16, v207
    v_and_b32 v59, 0xffff0000, v207
    v_pk_add_f32 v[158:159], v[158:159], v[58:59]
    v_and_b32 v58, 1, v72
    v_lshrrev_b32 v59, 1, v72
    v_lshlrev_b32 v58, 5, v58
    v_lshl_add_u32 v58, v59, 4, v58
    v_lshlrev_b32 v59, 3, v72
    v_sub_u32 v58, v58, v59
    v_add_u32 v78, v78, v58
    v_add_u32 v79, v79, v58
    v_lshlrev_b32 v32, 16, v208
    v_and_b32 v33, 0xffff0000, v208
    v_lshlrev_b32 v34, 16, v209
    v_and_b32 v35, 0xffff0000, v209
    v_lshlrev_b32 v36, 16, v210
    v_and_b32 v37, 0xffff0000, v210
    v_lshlrev_b32 v38, 16, v211
    v_and_b32 v39, 0xffff0000, v211
    v_lshlrev_b32 v40, 16, v212
    v_and_b32 v41, 0xffff0000, v212
    v_lshlrev_b32 v42, 16, v213
    v_and_b32 v43, 0xffff0000, v213
    v_lshlrev_b32 v44, 16, v214
    v_and_b32 v45, 0xffff0000, v214
    v_lshlrev_b32 v46, 16, v215
    v_and_b32 v47, 0xffff0000, v215
    s_or_b32 s31, s54, s30
    s_cbranch_scc1 op_nowr_145
    v_pk_add_f32 v[56:57], v[32:33], v[34:35]
    v_pk_add_f32 v[56:57], v[56:57], v[36:37]
    v_pk_add_f32 v[56:57], v[56:57], v[38:39]
    v_pk_add_f32 v[56:57], v[56:57], v[40:41]
    v_pk_add_f32 v[56:57], v[56:57], v[42:43]
    v_pk_add_f32 v[56:57], v[56:57], v[44:45]
    v_pk_add_f32 v[56:57], v[56:57], v[46:47]
    v_add_f32 v56, v56, v57
    v_mov_b32 v57, v56
    s_nop 1
    v_permlane16_swap_b32 v56, v57
    s_nop 1
    v_add_f32 v56, v56, v57
    v_mov_b32 v57, v56
    s_nop 1
    v_permlane32_swap_b32 v56, v57
    s_nop 1
    v_add_f32 v56, v56, v57
    s_mov_b32 s31, 24704
    s_mov_b32 s34, 24708
    s_mov_b64 exec, 1
    buffer_atomic_add_f32 v56, v75, s[32:35], s31 offen
    s_mov_b64 exec, -1
    s_mov_b32 s34, 24576
op_nowr_145:
    v_mov_b32 v208, 0
    v_mov_b32 v209, 0
    v_mov_b32 v210, 0
    v_mov_b32 v211, 0
    v_mov_b32 v212, 0
    v_mov_b32 v213, 0
    v_mov_b32 v214, 0
    v_mov_b32 v215, 0
    v_mov_b32 v216, 0
    v_mov_b32 v217, 0
    v_mov_b32 v218, 0
    v_mov_b32 v219, 0
    s_mov_b32 s40, 1048576
op_xspin_146:
    buffer_load_dwordx4 v[224:227], v1, s[36:39], s53 offen offset:0 sc1
    buffer_load_dwordx4 v[228:231], v1, s[36:39], s53 offen offset:1024 sc1
    buffer_load_dwordx4 v[232:235], v1, s[36:39], s53 offen offset:2048 sc1
    buffer_load_dwordx4 v[236:239], v1, s[36:39], s53 offen offset:3072 sc1
    s_sub_u32 s40, s40, 1
    s_waitcnt vmcnt(0)
    s_cbranch_scc1 op_xok_147
    v_max3_u32 v56, v224, v225, v226
    v_max3_u32 v56, v56, v227, v228
    v_max3_u32 v56, v56, v229, v230
    v_max3_u32 v56, v56, v231, v232
    v_max3_u32 v56, v56, v233, v234
    v_max3_u32 v56, v56, v235, v236
    v_max3_u32 v56, v56, v237, v238
    v_max_u32 v56, v56, v239
    v_cmp_eq_u32 vcc, -1, v56
    s_cbranch_vccz op_xok_147
    s_sleep 2
    s_branch op_xspin_146
op_xok_147:
    v_lshlrev_b32 v56, 16, v224
    v_and_b32 v57, 0xffff0000, v224
    v_lshlrev_b32 v58, 16, v225
    v_and_b32 v59, 0xffff0000, v225
    v_pk_add_f32 v[128:129], v[128:129], v[56:57]
    v_pk_add_f32 v[130:131], v[130:131], v[58:59]
    v_cvt_pk_bf16_f32 v192, v128, v129
    v_cvt_pk_bf16_f32 v193, v130, v131
    v_lshlrev_b32 v128, 16, v192
    v_and_b32 v129, 0xffff0000, v192
    v_lshlrev_b32 v130, 16, v193
    v_and_b32 v131, 0xffff0000, v193
    v_pk_add_f32 v[208:209], v[208:209], v[128:129]
    v_pk_fma_f32 v[210:211], v[128:129], v[128:129], v[210:211]
    v_pk_fma_f32 v[212:213], v[128:129], v[32:33], v[212:213]
    v_pk_add_f32 v[208:209], v[208:209], v[130:131]
    v_pk_fma_f32 v[210:211], v[130:131], v[130:131], v[210:211]
    v_pk_fma_f32 v[212:213], v[130:131], v[34:35], v[212:213]
    v_lshlrev_b32 v56, 16, v226
    v_and_b32 v57, 0xffff0000, v226
    v_lshlrev_b32 v58, 16, v227
    v_and_b32 v59, 0xffff0000, v227
    v_pk_add_f32 v[132:133], v[132:133], v[56:57]
    v_pk_add_f32 v[134:135], v[134:135], v[58:59]
    v_cvt_pk_bf16_f32 v200, v132, v133
    v_cvt_pk_bf16_f32 v201, v134, v135
    v_lshlrev_b32 v132, 16, v200
    v_and_b32 v133, 0xffff0000, v200
    v_lshlrev_b32 v134, 16, v201
    v_and_b32 v135, 0xffff0000, v201
    v_pk_add_f32 v[214:215], v[214:215], v[132:133]
    v_pk_fma_f32 v[216:217], v[132:133], v[132:133], v[216:217]
    v_pk_fma_f32 v[218:219], v[132:133], v[32:33], v[218:219]
    v_pk_add_f32 v[214:215], v[214:215], v[134:135]
    v_pk_fma_f32 v[216:217], v[134:135], v[134:135], v[216:217]
    v_pk_fma_f32 v[218:219], v[134:135], v[34:35], v[218:219]
    v_lshlrev_b32 v56, 16, v228
    v_and_b32 v57, 0xffff0000, v228
    v_lshlrev_b32 v58, 16, v229
    v_and_b32 v59, 0xffff0000, v229
    v_pk_add_f32 v[136:137], v[136:137], v[56:57]
    v_pk_add_f32 v[138:139], v[138:139], v[58:59]
    v_cvt_pk_bf16_f32 v194, v136, v137
    v_cvt_pk_bf16_f32 v195, v138, v139
    v_lshlrev_b32 v136, 16, v194
    v_and_b32 v137, 0xffff0000, v194
    v_lshlrev_b32 v138, 16, v195
    v_and_b32 v139, 0xffff0000, v195
    v_permlane16_swap_b32 v192, v194
    v_permlane16_swap_b32 v193, v195
    buffer_store_dwordx4 v[192:195], v78, s[24:27], 0 offen offset:0 sc1
    v_pk_add_f32 v[208:209], v[208:209], v[136:137]
    v_pk_fma_f32 v[210:211], v[136:137], v[136:137], v[210:211]
    v_pk_fma_f32 v[212:213], v[136:137], v[36:37], v[212:213]
    v_pk_add_f32 v[208:209], v[208:209], v[138:139]
    v_pk_fma_f32 v[210:211], v[138:139], v[138:139], v[210:211]
    v_pk_fma_f32 v[212:213], v[138:139], v[38:39], v[212:213]
    v_lshlrev_b32 v56, 16, v230
    v_and_b32 v57, 0xffff0000, v230
    v_lshlrev_b32 v58, 16, v231
    v_and_b32 v59, 0xffff0000, v231
    v_pk_add_f32 v[140:141], v[140:141], v[56:57]
    v_pk_add_f32 v[142:143], v[142:143], v[58:59]
    v_cvt_pk_bf16_f32 v202, v140, v141
    v_cvt_pk_bf16_f32 v203, v142, v143
    v_lshlrev_b32 v140, 16, v202
    v_and_b32 v141, 0xffff0000, v202
    v_lshlrev_b32 v142, 16, v203
    v_and_b32 v143, 0xffff0000, v203
    v_permlane16_swap_b32 v200, v202
    v_permlane16_swap_b32 v201, v203
    buffer_store_dwordx4 v[200:203], v79, s[24:27], 0 offen offset:0 sc1
    v_pk_add_f32 v[214:215], v[214:215], v[140:141]
    v_pk_fma_f32 v[216:217], v[140:141], v[140:141], v[216:217]
    v_pk_fma_f32 v[218:219], v[140:141], v[36:37], v[218:219]
    v_pk_add_f32 v[214:215], v[214:215], v[142:143]
    v_pk_fma_f32 v[216:217], v[142:143], v[142:143], v[216:217]
    v_pk_fma_f32 v[218:219], v[142:143], v[38:39], v[218:219]
    v_lshlrev_b32 v56, 16, v232
    v_and_b32 v57, 0xffff0000, v232
    v_lshlrev_b32 v58, 16, v233
    v_and_b32 v59, 0xffff0000, v233
    v_pk_add_f32 v[144:145], v[144:145], v[56:57]
    v_pk_add_f32 v[146:147], v[146:147], v[58:59]
    v_cvt_pk_bf16_f32 v196, v144, v145
    v_cvt_pk_bf16_f32 v197, v146, v147
    v_lshlrev_b32 v144, 16, v196
    v_and_b32 v145, 0xffff0000, v196
    v_lshlrev_b32 v146, 16, v197
    v_and_b32 v147, 0xffff0000, v197
    v_pk_add_f32 v[208:209], v[208:209], v[144:145]
    v_pk_fma_f32 v[210:211], v[144:145], v[144:145], v[210:211]
    v_pk_fma_f32 v[212:213], v[144:145], v[40:41], v[212:213]
    v_pk_add_f32 v[208:209], v[208:209], v[146:147]
    v_pk_fma_f32 v[210:211], v[146:147], v[146:147], v[210:211]
    v_pk_fma_f32 v[212:213], v[146:147], v[42:43], v[212:213]
    v_lshlrev_b32 v56, 16, v234
    v_and_b32 v57, 0xffff0000, v234
    v_lshlrev_b32 v58, 16, v235
    v_and_b32 v59, 0xffff0000, v235
    v_pk_add_f32 v[148:149], v[148:149], v[56:57]
    v_pk_add_f32 v[150:151], v[150:151], v[58:59]
    v_cvt_pk_bf16_f32 v204, v148, v149
    v_cvt_pk_bf16_f32 v205, v150, v151
    v_lshlrev_b32 v148, 16, v204
    v_and_b32 v149, 0xffff0000, v204
    v_lshlrev_b32 v150, 16, v205
    v_and_b32 v151, 0xffff0000, v205
    v_pk_add_f32 v[214:215], v[214:215], v[148:149]
    v_pk_fma_f32 v[216:217], v[148:149], v[148:149], v[216:217]
    v_pk_fma_f32 v[218:219], v[148:149], v[40:41], v[218:219]
    v_pk_add_f32 v[214:215], v[214:215], v[150:151]
    v_pk_fma_f32 v[216:217], v[150:151], v[150:151], v[216:217]
    v_pk_fma_f32 v[218:219], v[150:151], v[42:43], v[218:219]
    v_lshlrev_b32 v56, 16, v236
    v_and_b32 v57, 0xffff0000, v236
    v_lshlrev_b32 v58, 16, v237
    v_and_b32 v59, 0xffff0000, v237
    v_pk_add_f32 v[152:153], v[152:153], v[56:57]
    v_pk_add_f32 v[154:155], v[154:155], v[58:59]
    v_cvt_pk_bf16_f32 v198, v152, v153
    v_cvt_pk_bf16_f32 v199, v154, v155
    v_lshlrev_b32 v152, 16, v198
    v_and_b32 v153, 0xffff0000, v198
    v_lshlrev_b32 v154, 16, v199
    v_and_b32 v155, 0xffff0000, v199
    v_permlane16_swap_b32 v196, v198
    v_permlane16_swap_b32 v197, v199
    buffer_store_dwordx4 v[196:199], v78, s[24:27], 0 offen offset:64 sc1
    v_pk_add_f32 v[208:209], v[208:209], v[152:153]
    v_pk_fma_f32 v[210:211], v[152:153], v[152:153], v[210:211]
    v_pk_fma_f32 v[212:213], v[152:153], v[44:45], v[212:213]
    v_pk_add_f32 v[208:209], v[208:209], v[154:155]
    v_pk_fma_f32 v[210:211], v[154:155], v[154:155], v[210:211]
    v_pk_fma_f32 v[212:213], v[154:155], v[46:47], v[212:213]
    v_lshlrev_b32 v56, 16, v238
    v_and_b32 v57, 0xffff0000, v238
    v_lshlrev_b32 v58, 16, v239
    v_and_b32 v59, 0xffff0000, v239
    v_pk_add_f32 v[156:157], v[156:157], v[56:57]
    v_pk_add_f32 v[158:159], v[158:159], v[58:59]
    v_cvt_pk_bf16_f32 v206, v156, v157
    v_cvt_pk_bf16_f32 v207, v158, v159
    v_lshlrev_b32 v156, 16, v206
    v_and_b32 v157, 0xffff0000, v206
    v_lshlrev_b32 v158, 16, v207
    v_and_b32 v159, 0xffff0000, v207
    v_permlane16_swap_b32 v204, v206
    v_permlane16_swap_b32 v205, v207
    buffer_store_dwordx4 v[204:207], v79, s[24:27], 0 offen offset:64 sc1
    v_pk_add_f32 v[214:215], v[214:215], v[156:157]
    v_pk_fma_f32 v[216:217], v[156:157], v[156:157], v[216:217]
    v_pk_fma_f32 v[218:219], v[156:157], v[44:45], v[218:219]
    v_pk_add_f32 v[214:215], v[214:215], v[158:159]
    v_pk_fma_f32 v[216:217], v[158:159], v[158:159], v[216:217]
    v_pk_fma_f32 v[218:219], v[158:159], v[46:47], v[218:219]
    v_add_f32 v48, v208, v209
    v_add_f32 v49, v210, v211
    v_add_f32 v50, v212, v213
    v_add_f32 v52, v214, v215
    v_add_f32 v53, v216, v217
    v_add_f32 v54, v218, v219
    v_mov_b32 v56, v48
    v_mov_b32 v57, v49
    v_mov_b32 v58, v50
    v_mov_b32 v59, v52
    v_mov_b32 v60, v53
    v_mov_b32 v61, v54
    s_nop 1
    v_permlane16_swap_b32 v48, v56
    v_permlane16_swap_b32 v49, v57
    v_permlane16_swap_b32 v50, v58
    v_permlane16_swap_b32 v52, v59
    v_permlane16_swap_b32 v53, v60
    v_permlane16_swap_b32 v54, v61
    s_nop 1
    v_add_f32 v48, v48, v56
    v_add_f32 v49, v49, v57
    v_add_f32 v50, v50, v58
    v_add_f32 v52, v52, v59
    v_add_f32 v53, v53, v60
    v_add_f32 v54, v54, v61
    v_mov_b32 v56, v48
    v_mov_b32 v57, v49
    v_mov_b32 v58, v50
    v_mov_b32 v59, v52
    v_mov_b32 v60, v53
    v_mov_b32 v61, v54
    s_nop 1
    v_permlane32_swap_b32 v48, v56
    v_permlane32_swap_b32 v49, v57
    v_permlane32_swap_b32 v50, v58
    v_permlane32_swap_b32 v52, v59
    v_permlane32_swap_b32 v53, v60
    v_permlane32_swap_b32 v54, v61
    s_nop 1
    v_add_f32 v48, v48, v56
    v_add_f32 v49, v49, v57
    v_add_f32 v50, v50, v58
    v_add_f32 v52, v52, v59
    v_add_f32 v53, v53, v60
    v_add_f32 v54, v54, v61
    v_cmp_eq_u32 s[40:41], 1, v72
    v_cmp_eq_u32 s[42:43], 2, v72
    s_nop 1
    v_cndmask_b32 v48, v48, v49, s[40:41]
    v_cndmask_b32 v48, v48, v50, s[42:43]
    buffer_atomic_add_f32 v48, v77, s[32:35], 0 offen offset:0
    v_cndmask_b32 v52, v52, v53, s[40:41]
    v_cndmask_b32 v52, v52, v54, s[42:43]
    buffer_atomic_add_f32 v52, v77, s[32:35], 0 offen offset:64
    s_load_dwordx2 s[42:43], s[0:1], 88
    s_load_dwordx2 s[56:57], s[0:1], 56
    s_add_u32 s16, s6, 0x4815000
    s_addc_u32 s17, s7, 0
    s_and_b32 s17, s17, 0xffff
    s_mov_b32 s18, 0x1000
    s_mov_b32 s19, 0x00020000
    v_lshrrev_b32 v3, 4, v1
    v_lshl_add_u32 v2, s30, 6, v3
    v_and_b32 v4, 31, v3
    v_lshrrev_b32 v5, 5, v3
    v_lshlrev_b32 v7, 4, v4
    v_and_b32 v8, 15, v3
    v_lshlrev_b32 v6, 7, v8
    s_bfe_u32 s31, s2, 0x20003
    s_lshl_b32 s31, s31, 7
    v_lshlrev_b32 v12, 9, v3
    v_and_b32 v14, 3, v3
    v_lshlrev_b32 v14, 7, v14
    s_and_b32 s59, s2, 7
    s_lshl_b32 s59, s59, 9
    s_setreg_imm32_b32 hwreg(HW_REG_MODE, 4, 2), 3
    s_waitcnt vmcnt(0) lgkmcnt(0)
    s_barrier
    s_cmp_lg_u32 s30, 0
    s_cbranch_scc1 ff_nosig_148
    s_mov_b64 exec, 0xff
    buffer_atomic_add v76, v12, s[16:19], s31 offen sc1
    s_mov_b64 exec, -1
ff_nosig_148:
    s_lshl_b32 s40, s30, 13
    s_add_u32 m0, s40, 65536
    s_add_u32 s41, s3, 0
    buffer_load_dwordx4 v1, s[44:47], s41 offen offset:0 sc1 lds
    buffer_load_dwordx4 v1, s[44:47], s41 offen offset:1024 sc1 lds
    buffer_load_dwordx4 v1, s[44:47], s41 offen offset:2048 sc1 lds
    buffer_load_dwordx4 v1, s[44:47], s41 offen offset:3072 sc1 lds
    s_lshl_b32 s40, s30, 13
    s_add_u32 m0, s40, 69632
    s_add_u32 s41, s3, 4096
    buffer_load_dwordx4 v1, s[44:47], s41 offen offset:0 sc1 lds
    buffer_load_dwordx4 v1, s[44:47], s41 offen offset:1024 sc1 lds
    buffer_load_dwordx4 v1, s[44:47], s41 offen offset:2048 sc1 lds
    buffer_load_dwordx4 v1, s[44:47], s41 offen offset:3072 sc1 lds
    s_lshl_b32 s40, s30, 13
    s_add_u32 m0, s40, 98304
    s_add_u32 s41, s3, 8388608
    buffer_load_dwordx4 v1, s[44:47], s41 offen offset:0 sc1 lds
    buffer_load_dwordx4 v1, s[44:47], s41 offen offset:1024 sc1 lds
    buffer_load_dwordx4 v1, s[44:47], s41 offen offset:2048 sc1 lds
    buffer_load_dwordx4 v1, s[44:47], s41 offen offset:3072 sc1 lds
    s_lshl_b32 s40, s30, 13
    s_add_u32 m0, s40, 102400
    s_add_u32 s41, s3, 8392704
    buffer_load_dwordx4 v1, s[44:47], s41 offen offset:0 sc1 lds
    buffer_load_dwordx4 v1, s[44:47], s41 offen offset:1024 sc1 lds
    buffer_load_dwordx4 v1, s[44:47], s41 offen offset:2048 sc1 lds
    buffer_load_dwordx4 v1, s[44:47], s41 offen offset:3072 sc1 lds
    s_lshl_b32 s41, s30, 9
    s_add_u32 s41, s41, 131072
    v_lshrrev_b32 v9, 1, v1
    v_add_u32 v9, s41, v9
    ds_read_b64 v[96:97], v9 offset:0
    ds_read_b64 v[98:99], v9 offset:2048
    ds_read_b64 v[100:101], v9 offset:4096
    ds_read_b64 v[102:103], v9 offset:6144
    ds_read_b64 v[104:105], v9 offset:8192
    ds_read_b64 v[106:107], v9 offset:10240
    ds_read_b64 v[108:109], v9 offset:12288
    ds_read_b64 v[110:111], v9 offset:14336
    ds_read_b64 v[112:113], v9 offset:16384
    ds_read_b64 v[114:115], v9 offset:18432
    ds_read_b64 v[116:117], v9 offset:20480
    ds_read_b64 v[118:119], v9 offset:22528
    ds_read_b64 v[120:121], v9 offset:24576
    ds_read_b64 v[122:123], v9 offset:26624
    ds_read_b64 v[124:125], v9 offset:28672
    ds_read_b64 v[126:127], v9 offset:30720
    s_mov_b32 s54, 0x05040100
    s_mov_b32 s53, 0x07060302
    s_waitcnt lgkmcnt(0)
    v_perm_b32 v144, v98, v96, s54
    v_perm_b32 v145, v98, v96, s53
    v_perm_b32 v146, v99, v97, s54
    v_perm_b32 v147, v99, v97, s53
    v_perm_b32 v148, v102, v100, s54
    v_perm_b32 v149, v102, v100, s53
    v_perm_b32 v150, v103, v101, s54
    v_perm_b32 v151, v103, v101, s53
    v_perm_b32 v152, v106, v104, s54
    v_perm_b32 v153, v106, v104, s53
    v_perm_b32 v154, v107, v105, s54
    v_perm_b32 v155, v107, v105, s53
    v_perm_b32 v156, v110, v108, s54
    v_perm_b32 v157, v110, v108, s53
    v_perm_b32 v158, v111, v109, s54
    v_perm_b32 v159, v111, v109, s53
    v_perm_b32 v160, v114, v112, s54
    v_perm_b32 v161, v114, v112, s53
    v_perm_b32 v162, v115, v113, s54
    v_perm_b32 v163, v115, v113, s53
    v_perm_b32 v164, v118, v116, s54
    v_perm_b32 v165, v118, v116, s53
    v_perm_b32 v166, v119, v117, s54
    v_perm_b32 v167, v119, v117, s53
    v_perm_b32 v168, v122, v120, s54
    v_perm_b32 v169, v122, v120, s53
    v_perm_b32 v170, v123, v121, s54
    v_perm_b32 v171, v123, v121, s53
    v_perm_b32 v172, v126, v124, s54
    v_perm_b32 v173, v126, v124, s53
    v_perm_b32 v174, v127, v125, s54
    v_perm_b32 v175, v127, v125, s53
    s_mov_b32 s34, 24708
    s_mov_b32 s36, s42
    s_and_b32 s37, s43, 0xffff
    s_mov_b32 s38, 0x400000
    s_mov_b32 s39, 0x00020000
    s_add_u32 s48, s6, 0x4900000
    s_addc_u32 s49, s7, 0
    s_and_b32 s49, s49, 0xffff
    s_mov_b32 s50, 0x1c0000
    s_mov_b32 s51, 0x00020000
    v_lshlrev_b32 v10, 5, v2
    v_lshl_add_u32 v11, s30, 1, v5
    s_lshl_b32 s31, s2, 3
    v_add_u32 v11, s31, v11
    v_lshl_add_u32 v0, v11, 11, v7
    s_cmp_lg_u32 s30, 0
    s_cbranch_scc1 ff_go_149
    s_mov_b32 s52, 1048576
ff_poll_150:
    buffer_load_dword v13, v14, s[16:19], s59 offen sc1
    s_sub_u32 s52, s52, 1
    s_cbranch_scc1 ff_go_149
    s_waitcnt vmcnt(0)
    v_cmp_gt_u32 vcc, 64, v13
    s_cbranch_vccz ff_go_149
    s_sleep 4
    s_branch ff_poll_150
ff_go_149:
    s_barrier
    s_mov_b32 s31, 0
    buffer_load_dwordx4 v[16:19], v10, s[32:35], s31 offen sc1
    buffer_load_dwordx4 v[20:23], v10, s[32:35], s31 offen offset:16 sc1
    s_mov_b32 s31, 8192
    buffer_load_dwordx4 v[24:27], v10, s[32:35], s31 offen sc1
    buffer_load_dwordx4 v[28:31], v10, s[32:35], s31 offen offset:16 sc1
    s_mov_b32 s31, 16384
    buffer_load_dwordx4 v[32:35], v10, s[32:35], s31 offen sc1
    buffer_load_dwordx4 v[36:39], v10, s[32:35], s31 offen offset:16 sc1
    s_mov_b32 s31, 24704
    buffer_load_dword v10, v75, s[32:35], s31 offen sc1
    s_mov_b32 s52, 0x3a800000
    s_mov_b32 s53, 0x3a800000
    s_mov_b32 s54, 0x7ff
    v_mov_b32 v14, 0x3727c5ac
    v_mov_b32 v15, v14
    v_mov_b32 v12, 0xff800000
    v_mov_b32 v13, v12
    s_waitcnt vmcnt(0)
    v_sub_f32 v56, 0, v10
    v_sub_f32 v57, 0, v10
    v_pk_mul_f32 v[16:17], v[16:17], s[52:53]
    v_pk_fma_f32 v[24:25], v[24:25], s[52:53], v[14:15]
    v_pk_fma_f32 v[32:33], v[16:17], v[56:57], v[32:33]
    v_pk_fma_f32 v[24:25], v[16:17], v[16:17], v[24:25] neg_lo:[1,0,0] neg_hi:[1,0,0]
    v_pk_mul_f32 v[18:19], v[18:19], s[52:53]
    v_pk_fma_f32 v[26:27], v[26:27], s[52:53], v[14:15]
    v_pk_fma_f32 v[34:35], v[18:19], v[56:57], v[34:35]
    v_pk_fma_f32 v[26:27], v[18:19], v[18:19], v[26:27] neg_lo:[1,0,0] neg_hi:[1,0,0]
    v_pk_mul_f32 v[20:21], v[20:21], s[52:53]
    v_pk_fma_f32 v[28:29], v[28:29], s[52:53], v[14:15]
    v_pk_fma_f32 v[36:37], v[20:21], v[56:57], v[36:37]
    v_pk_fma_f32 v[28:29], v[20:21], v[20:21], v[28:29] neg_lo:[1,0,0] neg_hi:[1,0,0]
    v_pk_mul_f32 v[22:23], v[22:23], s[52:53]
    v_pk_fma_f32 v[30:31], v[30:31], s[52:53], v[14:15]
    v_pk_fma_f32 v[38:39], v[22:23], v[56:57], v[38:39]
    v_pk_fma_f32 v[30:31], v[22:23], v[22:23], v[30:31] neg_lo:[1,0,0] neg_hi:[1,0,0]
    v_max_f32 v24, v14, v24
    v_max_f32 v25, v14, v25
    v_max_f32 v26, v14, v26
    v_max_f32 v27, v14, v27
    v_max_f32 v28, v14, v28
    v_max_f32 v29, v14, v29
    v_max_f32 v30, v14, v30
    v_max_f32 v31, v14, v31
    v_rsq_f32 v24, v24
    v_rsq_f32 v25, v25
    v_rsq_f32 v26, v26
    v_rsq_f32 v27, v27
    v_rsq_f32 v28, v28
    v_rsq_f32 v29, v29
    v_rsq_f32 v30, v30
    v_rsq_f32 v31, v31
    v_pk_mul_f32 v[32:33], v[32:33], v[24:25]
    v_pk_mul_f32 v[34:35], v[34:35], v[26:27]
    v_pk_mul_f32 v[36:37], v[36:37], v[28:29]
    v_pk_mul_f32 v[38:39], v[38:39], v[30:31]
    v_bfi_b32 v32, s54, 0, v32
    v_med3_f32 v13, v12, v13, v32
    v_max_f32 v12, v12, v32
    v_bfi_b32 v33, s54, 1, v33
    v_med3_f32 v13, v12, v13, v33
    v_max_f32 v12, v12, v33
    v_bfi_b32 v34, s54, 2, v34
    v_med3_f32 v13, v12, v13, v34
    v_max_f32 v12, v12, v34
    v_bfi_b32 v35, s54, 3, v35
    v_med3_f32 v13, v12, v13, v35
    v_max_f32 v12, v12, v35
    v_bfi_b32 v36, s54, 4, v36
    v_med3_f32 v13, v12, v13, v36
    v_max_f32 v12, v12, v36
    v_bfi_b32 v37, s54, 5, v37
    v_med3_f32 v13, v12, v13, v37
    v_max_f32 v12, v12, v37
    v_bfi_b32 v38, s54, 6, v38
    v_med3_f32 v13, v12, v13, v38
    v_max_f32 v12, v12, v38
    v_bfi_b32 v39, s54, 7, v39
    v_med3_f32 v13, v12, v13, v39
    v_max_f32 v12, v12, v39
    v_lshl_or_b32 v12, v2, 3, v12
    v_lshl_or_b32 v13, v2, 3, v13
    s_nop 1
    v_mov_b32_dpp v14, v12 quad_perm:[1,0,3,2] row_mask:0xf bank_mask:0xf
    v_mov_b32_dpp v15, v13 quad_perm:[1,0,3,2] row_mask:0xf bank_mask:0xf
    v_max_f32 v15, v15, v13
    v_med3_f32 v13, v12, v14, v15
    v_max_f32 v12, v12, v14
    s_nop 1
    v_mov_b32_dpp v14, v12 quad_perm:[2,3,0,1] row_mask:0xf bank_mask:0xf
    v_mov_b32_dpp v15, v13 quad_perm:[2,3,0,1] row_mask:0xf bank_mask:0xf
    v_max_f32 v15, v15, v13
    v_med3_f32 v13, v12, v14, v15
    v_max_f32 v12, v12, v14
    s_nop 1
    v_mov_b32_dpp v14, v12 row_half_mirror row_mask:0xf bank_mask:0xf
    v_mov_b32_dpp v15, v13 row_half_mirror row_mask:0xf bank_mask:0xf
    v_max_f32 v15, v15, v13
    v_med3_f32 v13, v12, v14, v15
    v_max_f32 v12, v12, v14
    s_nop 1
    v_mov_b32_dpp v14, v12 row_mirror row_mask:0xf bank_mask:0xf
    v_mov_b32_dpp v15, v13 row_mirror row_mask:0xf bank_mask:0xf
    v_max_f32 v15, v15, v13
    v_med3_f32 v13, v12, v14, v15
    v_max_f32 v12, v12, v14
    v_mov_b32 v14, v12
    v_mov_b32 v15, v13
    s_nop 1
    v_permlane16_swap_b32 v12, v14
    v_permlane16_swap_b32 v13, v15
    s_nop 1
    v_max_f32 v15, v15, v13
    v_med3_f32 v13, v12, v14, v15
    v_max_f32 v12, v12, v14
    v_mov_b32 v14, v12
    v_mov_b32 v15, v13
    s_nop 1
    v_permlane32_swap_b32 v12, v14
    v_permlane32_swap_b32 v13, v15
    s_nop 1
    v_max_f32 v15, v15, v13
    v_med3_f32 v13, v12, v14, v15
    v_max_f32 v12, v12, v14
    s_lshl_b32 s31, s30, 3
    s_add_u32 s31, s31, 8192
    v_mov_b32 v14, s31
    ds_write_b64 v14, v[12:13]
    v_mov_b32 v14, 8192
    s_waitcnt lgkmcnt(0)
    s_barrier
    ds_read_b128 v[16:19], v14
    ds_read_b128 v[20:23], v14 offset:16
    v_cmp_eq_u32 vcc, 0, v5
    s_waitcnt lgkmcnt(0)
    v_max_f32 v19, v19, v17
    v_med3_f32 v17, v16, v18, v19
    v_max_f32 v16, v16, v18
    v_max_f32 v23, v23, v21
    v_med3_f32 v21, v20, v22, v23
    v_max_f32 v20, v20, v22
    v_max_f32 v21, v21, v17
    v_med3_f32 v17, v16, v20, v21
    v_max_f32 v16, v16, v20
    v_and_b32 v16, 0x7ff, v16
    v_and_b32 v17, 0x7ff, v17
    v_cndmask_b32 v15, v17, v16, vcc
    v_lshl_add_u32 v12, v15, 11, v7
    buffer_load_dwordx4 v[40:43], v12, s[24:27], 0 offen offset:0 sc1
    buffer_load_dwordx4 v[44:47], v12, s[24:27], 0 offen offset:512 sc1
    buffer_load_dwordx4 v[48:51], v12, s[24:27], 0 offen offset:1024 sc1
    buffer_load_dwordx4 v[52:55], v12, s[24:27], 0 offen offset:1536 sc1
    buffer_load_dwordx4 v[128:131], v0, s[24:27], 0 offen offset:0 sc1
    buffer_load_dwordx4 v[132:135], v0, s[24:27], 0 offen offset:512 sc1
    buffer_load_dwordx4 v[136:139], v0, s[24:27], 0 offen offset:1024 sc1
    buffer_load_dwordx4 v[140:143], v0, s[24:27], 0 offen offset:1536 sc1
    v_cmp_eq_u32 vcc, v16, v11
    v_cmp_eq_u32 s[52:53], v17, v11
    v_mov_b32 v13, 0x7fffffff
    s_or_b64 vcc, vcc, s[52:53]
    v_cndmask_b32 v0, v0, v13, vcc
    v_lshl_add_u32 v12, v5, 11, v7
    v_add_u32 v12, 4096, v12
    s_mov_b32 s58, 0
    s_waitcnt vmcnt(4)
ff_ln_151:
    v_lshlrev_b32 v216, 16, v40
    v_and_b32 v217, 0xffff0000, v40
    v_lshlrev_b32 v218, 16, v41
    v_and_b32 v219, 0xffff0000, v41
    v_lshlrev_b32 v220, 16, v42
    v_and_b32 v221, 0xffff0000, v42
    v_lshlrev_b32 v222, 16, v43
    v_and_b32 v223, 0xffff0000, v43
    v_lshlrev_b32 v224, 16, v44
    v_and_b32 v225, 0xffff0000, v44
    v_lshlrev_b32 v226, 16, v45
    v_and_b32 v227, 0xffff0000, v45
    v_lshlrev_b32 v228, 16, v46
    v_and_b32 v229, 0xffff0000, v46
    v_lshlrev_b32 v230, 16, v47
    v_and_b32 v231, 0xffff0000, v47
    v_lshlrev_b32 v232, 16, v48
    v_and_b32 v233, 0xffff0000, v48
    v_lshlrev_b32 v234, 16, v49
    v_and_b32 v235, 0xffff0000, v49
    v_lshlrev_b32 v236, 16, v50
    v_and_b32 v237, 0xffff0000, v50
    v_lshlrev_b32 v238, 16, v51
    v_and_b32 v239, 0xffff0000, v51
    v_lshlrev_b32 v240, 16, v52
    v_and_b32 v241, 0xffff0000, v52
    v_lshlrev_b32 v242, 16, v53
    v_and_b32 v243, 0xffff0000, v53
    v_lshlrev_b32 v244, 16, v54
    v_and_b32 v245, 0xffff0000, v54
    v_lshlrev_b32 v246, 16, v55
    v_and_b32 v247, 0xffff0000, v55
    v_pk_add_f32 v[208:209], v[216:217], v[218:219]
    v_pk_add_f32 v[210:211], v[220:221], v[222:223]
    v_pk_add_f32 v[208:209], v[208:209], v[224:225]
    v_pk_add_f32 v[210:211], v[210:211], v[226:227]
    v_pk_add_f32 v[208:209], v[208:209], v[228:229]
    v_pk_add_f32 v[210:211], v[210:211], v[230:231]
    v_pk_add_f32 v[208:209], v[208:209], v[232:233]
    v_pk_add_f32 v[210:211], v[210:211], v[234:235]
    v_pk_add_f32 v[208:209], v[208:209], v[236:237]
    v_pk_add_f32 v[210:211], v[210:211], v[238:239]
    v_pk_add_f32 v[208:209], v[208:209], v[240:241]
    v_pk_add_f32 v[210:211], v[210:211], v[242:243]
    v_pk_add_f32 v[208:209], v[208:209], v[244:245]
    v_pk_add_f32 v[210:211], v[210:211], v[246:247]
    v_pk_add_f32 v[208:209], v[208:209], v[210:211]
    v_add_f32 v208, v208, v209
    s_nop 1
    v_add_f32_dpp v208, v208, v208 quad_perm:[1,0,3,2] row_mask:0xf bank_mask:0xf
    s_nop 1
    v_add_f32_dpp v208, v208, v208 quad_perm:[2,3,0,1] row_mask:0xf bank_mask:0xf
    s_nop 1
    v_add_f32_dpp v208, v208, v208 row_half_mirror row_mask:0xf bank_mask:0xf
    s_nop 1
    v_add_f32_dpp v208, v208, v208 row_mirror row_mask:0xf bank_mask:0xf
    v_mov_b32 v210, v208
    s_nop 1
    v_permlane16_swap_b32 v208, v210
    s_nop 1
    v_add_f32 v208, v208, v210
    v_mul_f32 v208, 0xba800000, v208
    v_mov_b32 v209, v208
    v_pk_add_f32 v[210:211], v[216:217], v[208:209]
    v_pk_add_f32 v[214:215], v[218:219], v[208:209]
    v_pk_mul_f32 v[212:213], v[210:211], v[210:211]
    v_pk_fma_f32 v[212:213], v[214:215], v[214:215], v[212:213]
    v_pk_add_f32 v[210:211], v[220:221], v[208:209]
    v_pk_add_f32 v[214:215], v[222:223], v[208:209]
    v_pk_fma_f32 v[212:213], v[210:211], v[210:211], v[212:213]
    v_pk_fma_f32 v[212:213], v[214:215], v[214:215], v[212:213]
    v_pk_add_f32 v[210:211], v[224:225], v[208:209]
    v_pk_add_f32 v[214:215], v[226:227], v[208:209]
    v_pk_fma_f32 v[212:213], v[210:211], v[210:211], v[212:213]
    v_pk_fma_f32 v[212:213], v[214:215], v[214:215], v[212:213]
    v_pk_add_f32 v[210:211], v[228:229], v[208:209]
    v_pk_add_f32 v[214:215], v[230:231], v[208:209]
    v_pk_fma_f32 v[212:213], v[210:211], v[210:211], v[212:213]
    v_pk_fma_f32 v[212:213], v[214:215], v[214:215], v[212:213]
    v_pk_add_f32 v[210:211], v[232:233], v[208:209]
    v_pk_add_f32 v[214:215], v[234:235], v[208:209]
    v_pk_fma_f32 v[212:213], v[210:211], v[210:211], v[212:213]
    v_pk_fma_f32 v[212:213], v[214:215], v[214:215], v[212:213]
    v_pk_add_f32 v[210:211], v[236:237], v[208:209]
    v_pk_add_f32 v[214:215], v[238:239], v[208:209]
    v_pk_fma_f32 v[212:213], v[210:211], v[210:211], v[212:213]
    v_pk_fma_f32 v[212:213], v[214:215], v[214:215], v[212:213]
    v_pk_add_f32 v[210:211], v[240:241], v[208:209]
    v_pk_add_f32 v[214:215], v[242:243], v[208:209]
    v_pk_fma_f32 v[212:213], v[210:211], v[210:211], v[212:213]
    v_pk_fma_f32 v[212:213], v[214:215], v[214:215], v[212:213]
    v_pk_add_f32 v[210:211], v[244:245], v[208:209]
    v_pk_add_f32 v[214:215], v[246:247], v[208:209]
    v_pk_fma_f32 v[212:213], v[210:211], v[210:211], v[212:213]
    v_pk_fma_f32 v[212:213], v[214:215], v[214:215], v[212:213]
    v_add_f32 v212, v212, v213
    s_nop 1
    v_add_f32_dpp v212, v212, v212 quad_perm:[1,0,3,2] row_mask:0xf bank_mask:0xf
    s_nop 1
    v_add_f32_dpp v212, v212, v212 quad_perm:[2,3,0,1] row_mask:0xf bank_mask:0xf
    s_nop 1
    v_add_f32_dpp v212, v212, v212 row_half_mirror row_mask:0xf bank_mask:0xf
    s_nop 1
    v_add_f32_dpp v212, v212, v212 row_mirror row_mask:0xf bank_mask:0xf
    v_mov_b32 v210, v212
    s_nop 1
    v_permlane16_swap_b32 v212, v210
    s_nop 1
    v_add_f32 v212, v212, v210
    v_mul_f32 v212, 0x3a800000, v212
    v_cvt_pk_bf16_f32 v214, v208, v212
    v_and_b32 v212, 0xffff0000, v214
    v_lshlrev_b32 v214, 16, v214
    v_add_f32 v212, 0x3727c5ac, v212
    v_mov_b32 v215, v214
    v_cvt_pk_bf16_f32 v212, v212, v212
    v_and_b32 v212, 0xffff0000, v212
    v_sqrt_f32 v212, v212
    v_pk_add_f32 v[176:177], v[216:217], v[214:215]
    v_pk_add_f32 v[178:179], v[218:219], v[214:215]
    v_pk_add_f32 v[180:181], v[220:221], v[214:215]
    v_pk_add_f32 v[182:183], v[222:223], v[214:215]
    v_pk_add_f32 v[184:185], v[224:225], v[214:215]
    v_pk_add_f32 v[186:187], v[226:227], v[214:215]
    v_pk_add_f32 v[188:189], v[228:229], v[214:215]
    v_pk_add_f32 v[190:191], v[230:231], v[214:215]
    v_pk_add_f32 v[192:193], v[232:233], v[214:215]
    v_pk_add_f32 v[194:195], v[234:235], v[214:215]
    v_pk_add_f32 v[196:197], v[236:237], v[214:215]
    v_pk_add_f32 v[198:199], v[238:239], v[214:215]
    v_pk_add_f32 v[200:201], v[240:241], v[214:215]
    v_pk_add_f32 v[202:203], v[242:243], v[214:215]
    v_pk_add_f32 v[204:205], v[244:245], v[214:215]
    v_pk_add_f32 v[206:207], v[246:247], v[214:215]
    v_cvt_pk_bf16_f32 v212, v212, v212
    v_and_b32 v212, 0xffff0000, v212
    v_rcp_f32 v212, v212
    v_cvt_pk_bf16_f32 v40, v176, v177
    v_cvt_pk_bf16_f32 v41, v178, v179
    v_cvt_pk_bf16_f32 v42, v180, v181
    v_cvt_pk_bf16_f32 v43, v182, v183
    v_cvt_pk_bf16_f32 v44, v184, v185
    v_cvt_pk_bf16_f32 v45, v186, v187
    v_cvt_pk_bf16_f32 v46, v188, v189
    v_cvt_pk_bf16_f32 v47, v190, v191
    v_cvt_pk_bf16_f32 v48, v192, v193
    v_cvt_pk_bf16_f32 v49, v194, v195
    v_cvt_pk_bf16_f32 v50, v196, v197
    v_cvt_pk_bf16_f32 v51, v198, v199
    v_cvt_pk_bf16_f32 v52, v200, v201
    v_cvt_pk_bf16_f32 v53, v202, v203
    v_cvt_pk_bf16_f32 v54, v204, v205
    v_cvt_pk_bf16_f32 v55, v206, v207
    v_mov_b32 v213, v212
    v_lshlrev_b32 v176, 16, v40
    v_and_b32 v177, 0xffff0000, v40
    v_lshlrev_b32 v178, 16, v41
    v_and_b32 v179, 0xffff0000, v41
    v_lshlrev_b32 v180, 16, v42
    v_and_b32 v181, 0xffff0000, v42
    v_lshlrev_b32 v182, 16, v43
    v_and_b32 v183, 0xffff0000, v43
    v_lshlrev_b32 v184, 16, v44
    v_and_b32 v185, 0xffff0000, v44
    v_lshlrev_b32 v186, 16, v45
    v_and_b32 v187, 0xffff0000, v45
    v_lshlrev_b32 v188, 16, v46
    v_and_b32 v189, 0xffff0000, v46
    v_lshlrev_b32 v190, 16, v47
    v_and_b32 v191, 0xffff0000, v47
    v_lshlrev_b32 v192, 16, v48
    v_and_b32 v193, 0xffff0000, v48
    v_lshlrev_b32 v194, 16, v49
    v_and_b32 v195, 0xffff0000, v49
    v_lshlrev_b32 v196, 16, v50
    v_and_b32 v197, 0xffff0000, v50
    v_lshlrev_b32 v198, 16, v51
    v_and_b32 v199, 0xffff0000, v51
    v_lshlrev_b32 v200, 16, v52
    v_and_b32 v201, 0xffff0000, v52
    v_lshlrev_b32 v202, 16, v53
    v_and_b32 v203, 0xffff0000, v53
    v_lshlrev_b32 v204, 16, v54
    v_and_b32 v205, 0xffff0000, v54
    v_lshlrev_b32 v206, 16, v55
    v_and_b32 v207, 0xffff0000, v55
    v_pk_mul_f32 v[176:177], v[176:177], v[212:213]
    v_pk_mul_f32 v[178:179], v[178:179], v[212:213]
    v_pk_mul_f32 v[180:181], v[180:181], v[212:213]
    v_pk_mul_f32 v[182:183], v[182:183], v[212:213]
    v_pk_mul_f32 v[184:185], v[184:185], v[212:213]
    v_pk_mul_f32 v[186:187], v[186:187], v[212:213]
    v_pk_mul_f32 v[188:189], v[188:189], v[212:213]
    v_pk_mul_f32 v[190:191], v[190:191], v[212:213]
    v_pk_mul_f32 v[192:193], v[192:193], v[212:213]
    v_pk_mul_f32 v[194:195], v[194:195], v[212:213]
    v_pk_mul_f32 v[196:197], v[196:197], v[212:213]
    v_pk_mul_f32 v[198:199], v[198:199], v[212:213]
    v_pk_mul_f32 v[200:201], v[200:201], v[212:213]
    v_pk_mul_f32 v[202:203], v[202:203], v[212:213]
    v_pk_mul_f32 v[204:205], v[204:205], v[212:213]
    v_pk_mul_f32 v[206:207], v[206:207], v[212:213]
    v_cvt_pk_bf16_f32 v40, v176, v177
    v_cvt_pk_bf16_f32 v41, v178, v179
    v_cvt_pk_bf16_f32 v42, v180, v181
    v_cvt_pk_bf16_f32 v43, v182, v183
    v_cvt_pk_bf16_f32 v44, v184, v185
    v_cvt_pk_bf16_f32 v45, v186, v187
    v_cvt_pk_bf16_f32 v46, v188, v189
    v_cvt_pk_bf16_f32 v47, v190, v191
    v_cvt_pk_bf16_f32 v48, v192, v193
    v_cvt_pk_bf16_f32 v49, v194, v195
    v_cvt_pk_bf16_f32 v50, v196, v197
    v_cvt_pk_bf16_f32 v51, v198, v199
    v_cvt_pk_bf16_f32 v52, v200, v201
    v_cvt_pk_bf16_f32 v53, v202, v203
    v_cvt_pk_bf16_f32 v54, v204, v205
    v_cvt_pk_bf16_f32 v55, v206, v207
    s_cmp_lg_u32 s58, 0
    s_cbranch_scc1 ff_own_152
    ds_write_b128 v12, v[40:43] offset:0
    ds_write_b128 v12, v[44:47] offset:512
    ds_write_b128 v12, v[48:51] offset:1024
    ds_write_b128 v12, v[52:55] offset:1536
    s_cmp_ge_u32 s2, 224
    s_cbranch_scc1 ff_red_153
    v_lshrrev_b32 v12, 4, v3
    v_and_b32 v13, 1, v3
    v_lshlrev_b32 v13, 11, v13
    v_lshl_add_u32 v13, v12, 3, v13
    s_lshl_b32 s54, s30, 9
    s_add_u32 s54, s54, 4096
    v_add_u32 v13, s54, v13
    v_lshlrev_b32 v14, 3, v3
    s_lshl_b32 s54, s30, 13
    s_add_u32 s54, s54, 65536
    v_add_u32 v14, s54, v14
    ds_read_b64_tr_b16 a[0:1], v14 offset:0
    ds_read_b64_tr_b16 a[2:3], v14 offset:512
    ds_read_b64_tr_b16 a[4:5], v14 offset:1024
    ds_read_b64_tr_b16 a[6:7], v14 offset:1536
    ds_read_b64_tr_b16 a[8:9], v14 offset:2048
    ds_read_b64_tr_b16 a[10:11], v14 offset:2560
    ds_read_b64_tr_b16 a[12:13], v14 offset:3072
    ds_read_b64_tr_b16 a[14:15], v14 offset:3584
    ds_read_b64_tr_b16 a[16:17], v14 offset:4096
    ds_read_b64_tr_b16 a[18:19], v14 offset:4608
    ds_read_b64_tr_b16 a[20:21], v14 offset:5120
    ds_read_b64_tr_b16 a[22:23], v14 offset:5632
    ds_read_b64_tr_b16 a[24:25], v14 offset:6144
    ds_read_b64_tr_b16 a[26:27], v14 offset:6656
    ds_read_b64_tr_b16 a[28:29], v14 offset:7168
    ds_read_b64_tr_b16 a[30:31], v14 offset:7680
    ds_read_b64_tr_b16 a[32:33], v14 offset:32768
    ds_read_b64_tr_b16 a[34:35], v14 offset:33280
    ds_read_b64_tr_b16 a[36:37], v14 offset:33792
    ds_read_b64_tr_b16 a[38:39], v14 offset:34304
    ds_read_b64_tr_b16 a[40:41], v14 offset:34816
    ds_read_b64_tr_b16 a[42:43], v14 offset:35328
    ds_read_b64_tr_b16 a[44:45], v14 offset:35840
    ds_read_b64_tr_b16 a[46:47], v14 offset:36352
    ds_read_b64_tr_b16 a[48:49], v14 offset:36864
    ds_read_b64_tr_b16 a[50:51], v14 offset:37376
    ds_read_b64_tr_b16 a[52:53], v14 offset:37888
    ds_read_b64_tr_b16 a[54:55], v14 offset:38400
    ds_read_b64_tr_b16 a[56:57], v14 offset:38912
    ds_read_b64_tr_b16 a[58:59], v14 offset:39424
    ds_read_b64_tr_b16 a[60:61], v14 offset:39936
    ds_read_b64_tr_b16 a[62:63], v14 offset:40448
    ds_read_b64 a[64:65], v13 offset:0
    ds_read_b64 a[66:67], v13 offset:32
    ds_read_b64 a[68:69], v13 offset:64
    ds_read_b64 a[70:71], v13 offset:96
    ds_read_b64 a[72:73], v13 offset:128
    ds_read_b64 a[74:75], v13 offset:160
    ds_read_b64 a[76:77], v13 offset:192
    ds_read_b64 a[78:79], v13 offset:224
    ds_read_b64 a[80:81], v13 offset:256
    ds_read_b64 a[82:83], v13 offset:288
    ds_read_b64 a[84:85], v13 offset:320
    ds_read_b64 a[86:87], v13 offset:352
    ds_read_b64 a[88:89], v13 offset:384
    ds_read_b64 a[90:91], v13 offset:416
    ds_read_b64 a[92:93], v13 offset:448
    ds_read_b64 a[94:95], v13 offset:480
    v_lshlrev_b32 v13, 6, v8
    v_lshl_add_u32 v13, v12, 4, v13
    s_lshl_b32 s54, s30, 11
    s_add_u32 s54, s54, 8448
    v_add_u32 v13, s54, v13
    s_waitcnt lgkmcnt(0)
    v_mfma_f32_16x16x32_bf16 v[16:19], a[0:3], a[64:67], 0
    v_mfma_f32_16x16x32_bf16 v[20:23], a[32:35], a[64:67], 0
    v_mfma_f32_16x16x32_bf16 v[16:19], a[4:7], a[68:71], v[16:19]
    v_mfma_f32_16x16x32_bf16 v[20:23], a[36:39], a[68:71], v[20:23]
    v_mfma_f32_16x16x32_bf16 v[16:19], a[8:11], a[72:75], v[16:19]
    v_mfma_f32_16x16x32_bf16 v[20:23], a[40:43], a[72:75], v[20:23]
    v_mfma_f32_16x16x32_bf16 v[16:19], a[12:15], a[76:79], v[16:19]
    v_mfma_f32_16x16x32_bf16 v[20:23], a[44:47], a[76:79], v[20:23]
    v_mfma_f32_16x16x32_bf16 v[16:19], a[16:19], a[80:83], v[16:19]
    v_mfma_f32_16x16x32_bf16 v[20:23], a[48:51], a[80:83], v[20:23]
    v_mfma_f32_16x16x32_bf16 v[16:19], a[20:23], a[84:87], v[16:19]
    v_mfma_f32_16x16x32_bf16 v[20:23], a[52:55], a[84:87], v[20:23]
    v_mfma_f32_16x16x32_bf16 v[16:19], a[24:27], a[88:91], v[16:19]
    v_mfma_f32_16x16x32_bf16 v[20:23], a[56:59], a[88:91], v[20:23]
    v_mfma_f32_16x16x32_bf16 v[16:19], a[28:31], a[92:95], v[16:19]
    v_mfma_f32_16x16x32_bf16 v[20:23], a[60:63], a[92:95], v[20:23]
    s_nop 7
    ds_write_b128 v13, v[16:19]
    ds_write_b128 v13, v[20:23] offset:1024
    v_lshlrev_b32 v13, 2, v4
    v_add_u32 v13, 8448, v13
    s_waitcnt lgkmcnt(0)
    s_barrier
    ds_read2st64_b32 v[16:17], v13 offset0:0 offset1:4
    ds_read2st64_b32 v[18:19], v13 offset0:8 offset1:12
    ds_read2st64_b32 v[20:21], v13 offset0:16 offset1:20
    ds_read2st64_b32 v[22:23], v13 offset0:24 offset1:28
    s_waitcnt lgkmcnt(0)
    v_pk_add_f32 v[16:17], v[16:17], v[20:21]
    v_pk_add_f32 v[18:19], v[18:19], v[22:23]
    v_pk_add_f32 v[16:17], v[16:17], v[18:19]
    v_cvt_pk_bf16_f32 v16, v16, v17
    v_and_b32 v20, 0xffff0000, v16
    v_lshlrev_b32 v16, 16, v16
    v_mul_f32 v17, 0xbfb8aa3b, v16
    v_exp_f32 v17, v17
    s_lshl_b32 s54, s55, 13
    v_add_f32 v17, 1.0, v17
    v_rcp_f32 v17, v17
    s_add_u32 s53, s54, 4096
    v_mul_f32 v16, v16, v17
    v_cvt_pk_bf16_f32 v16, v16, v16
    v_and_b32 v16, 0xffff0000, v16
    v_mul_f32 v16, v16, v20
    s_nop 1
    v_mov_b32_dpp v17, v16 quad_perm:[1,0,3,2] row_mask:0xf bank_mask:0xf
    v_cvt_pk_bf16_f32 v16, v16, v17
    v_lshlrev_b32 v13, 4, v2
    v_readlane_b32 s8, v16, 0
    v_readlane_b32 s9, v16, 2
    v_readlane_b32 s10, v16, 4
    v_readlane_b32 s11, v16, 6
    v_readlane_b32 s12, v16, 8
    v_readlane_b32 s13, v16, 10
    v_readlane_b32 s14, v16, 12
    v_readlane_b32 s15, v16, 14
    v_readlane_b32 s16, v16, 16
    v_readlane_b32 s17, v16, 18
    v_readlane_b32 s18, v16, 20
    v_readlane_b32 s19, v16, 22
    v_readlane_b32 s20, v16, 24
    v_readlane_b32 s21, v16, 26
    v_readlane_b32 s22, v16, 28
    v_readlane_b32 s23, v16, 30
    v_dot2_f32_bf16 v24, v144, s8, 0
    v_dot2_f32_bf16 v25, v145, s8, 0
    v_dot2_f32_bf16 v26, v146, s8, 0
    v_dot2_f32_bf16 v27, v147, s8, 0
    v_dot2_f32_bf16 v24, v148, s9, v24
    v_dot2_f32_bf16 v25, v149, s9, v25
    v_dot2_f32_bf16 v26, v150, s9, v26
    v_dot2_f32_bf16 v27, v151, s9, v27
    v_dot2_f32_bf16 v24, v152, s10, v24
    v_dot2_f32_bf16 v25, v153, s10, v25
    v_dot2_f32_bf16 v26, v154, s10, v26
    v_dot2_f32_bf16 v27, v155, s10, v27
    v_dot2_f32_bf16 v24, v156, s11, v24
    v_dot2_f32_bf16 v25, v157, s11, v25
    v_dot2_f32_bf16 v26, v158, s11, v26
    v_dot2_f32_bf16 v27, v159, s11, v27
    v_dot2_f32_bf16 v24, v160, s12, v24
    v_dot2_f32_bf16 v25, v161, s12, v25
    v_dot2_f32_bf16 v26, v162, s12, v26
    v_dot2_f32_bf16 v27, v163, s12, v27
    v_dot2_f32_bf16 v24, v164, s13, v24
    v_dot2_f32_bf16 v25, v165, s13, v25
    v_dot2_f32_bf16 v26, v166, s13, v26
    v_dot2_f32_bf16 v27, v167, s13, v27
    v_dot2_f32_bf16 v24, v168, s14, v24
    v_dot2_f32_bf16 v25, v169, s14, v25
    v_dot2_f32_bf16 v26, v170, s14, v26
    v_dot2_f32_bf16 v27, v171, s14, v27
    v_dot2_f32_bf16 v24, v172, s15, v24
    v_dot2_f32_bf16 v25, v173, s15, v25
    v_dot2_f32_bf16 v26, v174, s15, v26
    v_dot2_f32_bf16 v27, v175, s15, v27
    v_dot2_f32_bf16 v28, v144, s16, 0
    v_dot2_f32_bf16 v29, v145, s16, 0
    v_dot2_f32_bf16 v30, v146, s16, 0
    v_dot2_f32_bf16 v31, v147, s16, 0
    v_dot2_f32_bf16 v28, v148, s17, v28
    v_dot2_f32_bf16 v29, v149, s17, v29
    v_dot2_f32_bf16 v30, v150, s17, v30
    v_dot2_f32_bf16 v31, v151, s17, v31
    v_dot2_f32_bf16 v28, v152, s18, v28
    v_dot2_f32_bf16 v29, v153, s18, v29
    v_dot2_f32_bf16 v30, v154, s18, v30
    v_dot2_f32_bf16 v31, v155, s18, v31
    v_dot2_f32_bf16 v28, v156, s19, v28
    v_dot2_f32_bf16 v29, v157, s19, v29
    v_dot2_f32_bf16 v30, v158, s19, v30
    v_dot2_f32_bf16 v31, v159, s19, v31
    v_dot2_f32_bf16 v28, v160, s20, v28
    v_dot2_f32_bf16 v29, v161, s20, v29
    v_dot2_f32_bf16 v30, v162, s20, v30
    v_dot2_f32_bf16 v31, v163, s20, v31
    v_dot2_f32_bf16 v28, v164, s21, v28
    v_dot2_f32_bf16 v29, v165, s21, v29
    v_dot2_f32_bf16 v30, v166, s21, v30
    v_dot2_f32_bf16 v31, v167, s21, v31
    v_dot2_f32_bf16 v28, v168, s22, v28
    v_dot2_f32_bf16 v29, v169, s22, v29
    v_dot2_f32_bf16 v30, v170, s22, v30
    v_dot2_f32_bf16 v31, v171, s22, v31
    v_dot2_f32_bf16 v28, v172, s23, v28
    v_dot2_f32_bf16 v29, v173, s23, v29
    v_dot2_f32_bf16 v30, v174, s23, v30
    v_dot2_f32_bf16 v31, v175, s23, v31
    s_nop 2
    v_min_u32 v24, -2, v24
    v_min_u32 v25, -2, v25
    v_min_u32 v26, -2, v26
    v_min_u32 v27, -2, v27
    v_min_u32 v28, -2, v28
    v_min_u32 v29, -2, v29
    v_min_u32 v30, -2, v30
    v_min_u32 v31, -2, v31
    buffer_store_dwordx4 v[24:27], v13, s[48:51], s54 offen sc1
    buffer_store_dwordx4 v[28:31], v13, s[48:51], s53 offen sc1
    s_waitcnt vmcnt(2)
    v_mov_b32 v40, v128
    v_mov_b32 v41, v129
    v_mov_b32 v42, v130
    v_mov_b32 v43, v131
    v_mov_b32 v44, v132
    v_mov_b32 v45, v133
    v_mov_b32 v46, v134
    v_mov_b32 v47, v135
    v_mov_b32 v48, v136
    v_mov_b32 v49, v137
    v_mov_b32 v50, v138
    v_mov_b32 v51, v139
    v_mov_b32 v52, v140
    v_mov_b32 v53, v141
    v_mov_b32 v54, v142
    v_mov_b32 v55, v143
    s_mov_b32 s58, 1
    s_branch ff_ln_151
ff_own_152:
    v_lshlrev_b32 v176, 16, v40
    v_and_b32 v177, 0xffff0000, v40
    v_lshlrev_b32 v178, 16, v41
    v_and_b32 v179, 0xffff0000, v41
    v_lshlrev_b32 v180, 16, v42
    v_and_b32 v181, 0xffff0000, v42
    v_lshlrev_b32 v182, 16, v43
    v_and_b32 v183, 0xffff0000, v43
    v_lshlrev_b32 v184, 16, v44
    v_and_b32 v185, 0xffff0000, v44
    v_lshlrev_b32 v186, 16, v45
    v_and_b32 v187, 0xffff0000, v45
    v_lshlrev_b32 v188, 16, v46
    v_and_b32 v189, 0xffff0000, v46
    v_lshlrev_b32 v190, 16, v47
    v_and_b32 v191, 0xffff0000, v47
    v_lshlrev_b32 v192, 16, v48
    v_and_b32 v193, 0xffff0000, v48
    v_lshlrev_b32 v194, 16, v49
    v_and_b32 v195, 0xffff0000, v49
    v_lshlrev_b32 v196, 16, v50
    v_and_b32 v197, 0xffff0000, v50
    v_lshlrev_b32 v198, 16, v51
    v_and_b32 v199, 0xffff0000, v51
    v_lshlrev_b32 v200, 16, v52
    v_and_b32 v201, 0xffff0000, v52
    v_lshlrev_b32 v202, 16, v53
    v_and_b32 v203, 0xffff0000, v53
    v_lshlrev_b32 v204, 16, v54
    v_and_b32 v205, 0xffff0000, v54
    v_lshlrev_b32 v206, 16, v55
    v_and_b32 v207, 0xffff0000, v55
    v_pk_add_f32 v[176:177], v[176:177], v[216:217]
    v_pk_add_f32 v[178:179], v[178:179], v[218:219]
    v_pk_add_f32 v[180:181], v[180:181], v[220:221]
    v_pk_add_f32 v[182:183], v[182:183], v[222:223]
    v_pk_add_f32 v[184:185], v[184:185], v[224:225]
    v_pk_add_f32 v[186:187], v[186:187], v[226:227]
    v_pk_add_f32 v[188:189], v[188:189], v[228:229]
    v_pk_add_f32 v[190:191], v[190:191], v[230:231]
    v_pk_add_f32 v[192:193], v[192:193], v[232:233]
    v_pk_add_f32 v[194:195], v[194:195], v[234:235]
    v_pk_add_f32 v[196:197], v[196:197], v[236:237]
    v_pk_add_f32 v[198:199], v[198:199], v[238:239]
    v_pk_add_f32 v[200:201], v[200:201], v[240:241]
    v_pk_add_f32 v[202:203], v[202:203], v[242:243]
    v_pk_add_f32 v[204:205], v[204:205], v[244:245]
    v_pk_add_f32 v[206:207], v[206:207], v[246:247]
    v_cvt_pk_bf16_f32 v40, v176, v177
    v_cvt_pk_bf16_f32 v41, v178, v179
    v_cvt_pk_bf16_f32 v42, v180, v181
    v_cvt_pk_bf16_f32 v43, v182, v183
    v_cvt_pk_bf16_f32 v44, v184, v185
    v_cvt_pk_bf16_f32 v45, v186, v187
    v_cvt_pk_bf16_f32 v46, v188, v189
    v_cvt_pk_bf16_f32 v47, v190, v191
    v_cvt_pk_bf16_f32 v48, v192, v193
    v_cvt_pk_bf16_f32 v49, v194, v195
    v_cvt_pk_bf16_f32 v50, v196, v197
    v_cvt_pk_bf16_f32 v51, v198, v199
    v_cvt_pk_bf16_f32 v52, v200, v201
    v_cvt_pk_bf16_f32 v53, v202, v203
    v_cvt_pk_bf16_f32 v54, v204, v205
    v_cvt_pk_bf16_f32 v55, v206, v207
    buffer_store_dwordx4 v[40:43], v0, s[36:39], 0 offen offset:0 sc1
    buffer_store_dwordx4 v[44:47], v0, s[36:39], 0 offen offset:512 sc1
    buffer_store_dwordx4 v[48:51], v0, s[36:39], 0 offen offset:1024 sc1
    buffer_store_dwordx4 v[52:55], v0, s[36:39], 0 offen offset:1536 sc1
    s_cmp_ge_u32 s2, 224
    s_cbranch_scc1 ff_red2_154
    s_branch ff_fin_155
ff_red_153:
    s_sub_u32 s40, s2, 224
    s_lshr_b32 s41, s40, 4
    s_and_b32 s42, s40, 15
    s_mov_b32 s8, s56
    s_and_b32 s9, s57, 0xffff
    s_mov_b32 s10, 0x800
    s_mov_b32 s11, 0x00020000
    buffer_load_dwordx4 v[96:99], v7, s[8:11], 0 offen offset:0
    buffer_load_dwordx4 v[100:103], v7, s[8:11], 0 offen offset:512
    buffer_load_dwordx4 v[104:107], v7, s[8:11], 0 offen offset:1024
    buffer_load_dwordx4 v[108:111], v7, s[8:11], 0 offen offset:1536
    s_lshl_b32 s43, s41, 5
    v_readlane_b32 s46, v15, s43
    s_lshl_b32 s47, s42, 7
    v_lshl_add_u32 v9, v8, 3, s47
    s_lshl_b32 s46, s46, 11
    s_lshl_b32 s31, s41, 11
    s_add_u32 s31, s31, 4096
    v_add_u32 v12, s31, v9
    s_waitcnt lgkmcnt(0)
    ds_read_b64 v[32:33], v12
    buffer_load_dwordx2 v[34:35], v9, s[24:27], s46 offen sc1
    v_lshrrev_b32 v10, 4, v2
    v_lshlrev_b32 v10, 13, v10
    v_lshl_add_u32 v10, v8, 4, v10
    s_lshl_b32 s47, s40, 8
    s_waitcnt vmcnt(1)
    v_dot2_f32_bf16 v12, v40, v96, 0
    v_dot2_f32_bf16 v12, v41, v97, v12
    v_dot2_f32_bf16 v12, v42, v98, v12
    v_dot2_f32_bf16 v12, v43, v99, v12
    v_dot2_f32_bf16 v12, v44, v100, v12
    v_dot2_f32_bf16 v12, v45, v101, v12
    v_dot2_f32_bf16 v12, v46, v102, v12
    v_dot2_f32_bf16 v12, v47, v103, v12
    v_dot2_f32_bf16 v12, v48, v104, v12
    v_dot2_f32_bf16 v12, v49, v105, v12
    v_dot2_f32_bf16 v12, v50, v106, v12
    v_dot2_f32_bf16 v12, v51, v107, v12
    v_dot2_f32_bf16 v12, v52, v108, v12
    v_dot2_f32_bf16 v12, v53, v109, v12
    v_dot2_f32_bf16 v12, v54, v110, v12
    v_dot2_f32_bf16 v12, v55, v111, v12
    s_nop 2
    s_nop 1
    v_add_f32_dpp v12, v12, v12 quad_perm:[1,0,3,2] row_mask:0xf bank_mask:0xf
    s_nop 1
    v_add_f32_dpp v12, v12, v12 quad_perm:[2,3,0,1] row_mask:0xf bank_mask:0xf
    s_nop 1
    v_add_f32_dpp v12, v12, v12 row_half_mirror row_mask:0xf bank_mask:0xf
    s_nop 1
    v_add_f32_dpp v12, v12, v12 row_mirror row_mask:0xf bank_mask:0xf
    v_mov_b32 v13, v12
    s_nop 1
    v_permlane16_swap_b32 v12, v13
    s_nop 1
    v_add_f32 v12, v12, v13
    v_cvt_pk_bf16_f32 v12, v12, v12
    v_and_b32 v12, 0xffff0000, v12
    v_mul_f32 v12, 0xbfb8aa3b, v12
    v_exp_f32 v12, v12
    s_lshl_b32 s44, s42, 1
    v_add_f32 v12, 1.0, v12
    v_rcp_f32 v12, v12
    s_add_u32 s44, s44, s41
    s_lshl_b32 s44, s44, 11
    v_cvt_pk_bf16_f32 v12, v12, v12
    v_and_b32 v12, 0xffff0000, v12
    v_mov_b32 v40, v128
    v_mov_b32 v41, v129
    v_mov_b32 v42, v130
    v_mov_b32 v43, v131
    v_mov_b32 v44, v132
    v_mov_b32 v45, v133
    v_mov_b32 v46, v134
    v_mov_b32 v47, v135
    v_mov_b32 v48, v136
    v_mov_b32 v49, v137
    v_mov_b32 v50, v138
    v_mov_b32 v51, v139
    v_mov_b32 v52, v140
    v_mov_b32 v53, v141
    v_mov_b32 v54, v142
    v_mov_b32 v55, v143
    v_readlane_b32 s45, v12, s43
    s_mov_b32 s58, 1
    s_branch ff_ln_151
ff_red2_154:
    s_mov_b32 s52, 1048576
ff_rpoll_157:
    s_mov_b32 s53, s47
    buffer_load_dwordx4 v[96:99], v10, s[48:51], s53 offen sc1
    s_add_u32 s53, s53, 0x20000
    buffer_load_dwordx4 v[100:103], v10, s[48:51], s53 offen sc1
    s_add_u32 s53, s53, 0x20000
    buffer_load_dwordx4 v[104:107], v10, s[48:51], s53 offen sc1
    s_add_u32 s53, s53, 0x20000
    buffer_load_dwordx4 v[108:111], v10, s[48:51], s53 offen sc1
    s_add_u32 s53, s53, 0x20000
    buffer_load_dwordx4 v[112:115], v10, s[48:51], s53 offen sc1
    s_add_u32 s53, s53, 0x20000
    buffer_load_dwordx4 v[116:119], v10, s[48:51], s53 offen sc1
    s_add_u32 s53, s53, 0x20000
    buffer_load_dwordx4 v[120:123], v10, s[48:51], s53 offen sc1
    s_add_u32 s53, s53, 0x20000
    buffer_load_dwordx4 v[124:127], v10, s[48:51], s53 offen sc1
    s_add_u32 s53, s53, 0x20000
    buffer_load_dwordx4 v[128:131], v10, s[48:51], s53 offen sc1
    s_add_u32 s53, s53, 0x20000
    buffer_load_dwordx4 v[132:135], v10, s[48:51], s53 offen sc1
    s_add_u32 s53, s53, 0x20000
    buffer_load_dwordx4 v[136:139], v10, s[48:51], s53 offen sc1
    s_add_u32 s53, s53, 0x20000
    buffer_load_dwordx4 v[140:143], v10, s[48:51], s53 offen sc1
    s_add_u32 s53, s53, 0x20000
    buffer_load_dwordx4 v[144:147], v10, s[48:51], s53 offen sc1
    s_add_u32 s53, s53, 0x20000
    buffer_load_dwordx4 v[148:151], v10, s[48:51], s53 offen sc1
    s_add_u32 s53, s53, 0x20000
    v_mov_b32 v13, 0
    s_waitcnt vmcnt(13)
    v_max3_u32 v13, v13, v96, v97
    v_max3_u32 v13, v13, v98, v99
    s_waitcnt vmcnt(12)
    v_max3_u32 v13, v13, v100, v101
    v_max3_u32 v13, v13, v102, v103
    s_waitcnt vmcnt(11)
    v_max3_u32 v13, v13, v104, v105
    v_max3_u32 v13, v13, v106, v107
    s_waitcnt vmcnt(10)
    v_max3_u32 v13, v13, v108, v109
    v_max3_u32 v13, v13, v110, v111
    s_waitcnt vmcnt(9)
    v_max3_u32 v13, v13, v112, v113
    v_max3_u32 v13, v13, v114, v115
    s_waitcnt vmcnt(8)
    v_max3_u32 v13, v13, v116, v117
    v_max3_u32 v13, v13, v118, v119
    s_waitcnt vmcnt(7)
    v_max3_u32 v13, v13, v120, v121
    v_max3_u32 v13, v13, v122, v123
    s_waitcnt vmcnt(6)
    v_max3_u32 v13, v13, v124, v125
    v_max3_u32 v13, v13, v126, v127
    s_waitcnt vmcnt(5)
    v_max3_u32 v13, v13, v128, v129
    v_max3_u32 v13, v13, v130, v131
    s_waitcnt vmcnt(4)
    v_max3_u32 v13, v13, v132, v133
    v_max3_u32 v13, v13, v134, v135
    s_waitcnt vmcnt(3)
    v_max3_u32 v13, v13, v136, v137
    v_max3_u32 v13, v13, v138, v139
    s_waitcnt vmcnt(2)
    v_max3_u32 v13, v13, v140, v141
    v_max3_u32 v13, v13, v142, v143
    s_waitcnt vmcnt(1)
    v_max3_u32 v13, v13, v144, v145
    v_max3_u32 v13, v13, v146, v147
    s_waitcnt vmcnt(0)
    v_max3_u32 v13, v13, v148, v149
    v_max3_u32 v13, v13, v150, v151
    s_sub_u32 s52, s52, 1
    s_cbranch_scc1 ff_rgo_156
    v_cmp_eq_u32 vcc, -1, v13
    s_cbranch_vccnz ff_rpoll_157
ff_rgo_156:
    v_pk_add_f32 v[96:97], v[96:97], v[100:101]
    v_pk_add_f32 v[98:99], v[98:99], v[102:103]
    v_pk_add_f32 v[96:97], v[96:97], v[104:105]
    v_pk_add_f32 v[98:99], v[98:99], v[106:107]
    v_pk_add_f32 v[96:97], v[96:97], v[108:109]
    v_pk_add_f32 v[98:99], v[98:99], v[110:111]
    v_pk_add_f32 v[96:97], v[96:97], v[112:113]
    v_pk_add_f32 v[98:99], v[98:99], v[114:115]
    v_pk_add_f32 v[96:97], v[96:97], v[116:117]
    v_pk_add_f32 v[98:99], v[98:99], v[118:119]
    v_pk_add_f32 v[96:97], v[96:97], v[120:121]
    v_pk_add_f32 v[98:99], v[98:99], v[122:123]
    v_pk_add_f32 v[96:97], v[96:97], v[124:125]
    v_pk_add_f32 v[98:99], v[98:99], v[126:127]
    v_pk_add_f32 v[96:97], v[96:97], v[128:129]
    v_pk_add_f32 v[98:99], v[98:99], v[130:131]
    v_pk_add_f32 v[96:97], v[96:97], v[132:133]
    v_pk_add_f32 v[98:99], v[98:99], v[134:135]
    v_pk_add_f32 v[96:97], v[96:97], v[136:137]
    v_pk_add_f32 v[98:99], v[98:99], v[138:139]
    v_pk_add_f32 v[96:97], v[96:97], v[140:141]
    v_pk_add_f32 v[98:99], v[98:99], v[142:143]
    v_pk_add_f32 v[96:97], v[96:97], v[144:145]
    v_pk_add_f32 v[98:99], v[98:99], v[146:147]
    v_pk_add_f32 v[96:97], v[96:97], v[148:149]
    v_pk_add_f32 v[98:99], v[98:99], v[150:151]
    v_mov_b32 v100, v96
    v_mov_b32 v101, v97
    v_mov_b32 v102, v98
    v_mov_b32 v103, v99
    s_nop 1
    v_permlane16_swap_b32 v96, v100
    v_permlane16_swap_b32 v97, v101
    v_permlane16_swap_b32 v98, v102
    v_permlane16_swap_b32 v99, v103
    s_nop 1
    v_add_f32 v96, v96, v100
    v_add_f32 v97, v97, v101
    v_add_f32 v98, v98, v102
    v_add_f32 v99, v99, v103
    v_mov_b32 v100, v96
    v_mov_b32 v101, v97
    v_mov_b32 v102, v98
    v_mov_b32 v103, v99
    s_nop 1
    v_permlane32_swap_b32 v96, v100
    v_permlane32_swap_b32 v97, v101
    v_permlane32_swap_b32 v98, v102
    v_permlane32_swap_b32 v99, v103
    s_nop 1
    v_add_f32 v96, v96, v100
    v_add_f32 v97, v97, v101
    v_add_f32 v98, v98, v102
    v_add_f32 v99, v99, v103
    v_lshlrev_b32 v14, 4, v8
    s_lshl_b32 s31, s30, 8
    v_add_u32 v13, s31, v14
    ds_write_b128 v13, v[96:99]
    s_waitcnt lgkmcnt(0)
    s_barrier
    ds_read_b128 v[96:99], v14 offset:0
    ds_read_b128 v[100:103], v14 offset:256
    ds_read_b128 v[104:107], v14 offset:512
    ds_read_b128 v[108:111], v14 offset:768
    s_waitcnt lgkmcnt(0)
    v_pk_add_f32 v[96:97], v[96:97], v[100:101]
    v_pk_add_f32 v[98:99], v[98:99], v[102:103]
    v_pk_add_f32 v[96:97], v[96:97], v[104:105]
    v_pk_add_f32 v[98:99], v[98:99], v[106:107]
    v_pk_add_f32 v[96:97], v[96:97], v[108:109]
    v_pk_add_f32 v[98:99], v[98:99], v[110:111]
    v_cvt_pk_bf16_f32 v20, v96, v97
    v_lshlrev_b32 v21, 16, v20
    v_and_b32 v22, 0xffff0000, v20
    v_mul_f32 v21, s45, v21
    v_mul_f32 v22, s45, v22
    v_cvt_pk_bf16_f32 v20, v21, v22
    v_lshlrev_b32 v21, 16, v20
    v_and_b32 v22, 0xffff0000, v20
    v_lshlrev_b32 v23, 16, v32
    v_and_b32 v24, 0xffff0000, v32
    v_add_f32 v21, v21, v23
    v_add_f32 v22, v22, v24
    v_cvt_pk_bf16_f32 v20, v21, v22
    v_lshlrev_b32 v21, 16, v20
    v_and_b32 v22, 0xffff0000, v20
    v_lshlrev_b32 v23, 16, v34
    v_and_b32 v24, 0xffff0000, v34
    v_add_f32 v21, v21, v23
    v_add_f32 v22, v22, v24
    v_cvt_pk_bf16_f32 v26, v21, v22
    v_cvt_pk_bf16_f32 v20, v98, v99
    v_lshlrev_b32 v21, 16, v20
    v_and_b32 v22, 0xffff0000, v20
    v_mul_f32 v21, s45, v21
    v_mul_f32 v22, s45, v22
    v_cvt_pk_bf16_f32 v20, v21, v22
    v_lshlrev_b32 v21, 16, v20
    v_and_b32 v22, 0xffff0000, v20
    v_lshlrev_b32 v23, 16, v33
    v_and_b32 v24, 0xffff0000, v33
    v_add_f32 v21, v21, v23
    v_add_f32 v22, v22, v24
    v_cvt_pk_bf16_f32 v20, v21, v22
    v_lshlrev_b32 v21, 16, v20
    v_and_b32 v22, 0xffff0000, v20
    v_lshlrev_b32 v23, 16, v35
    v_and_b32 v24, 0xffff0000, v35
    v_add_f32 v21, v21, v23
    v_add_f32 v22, v22, v24
    v_cvt_pk_bf16_f32 v27, v21, v22
    v_cmp_gt_u32 vcc, 16, v2
    s_and_saveexec_b64 s[52:53], vcc
    s_cbranch_execz ff_fin_155
    buffer_store_dwordx2 v[26:27], v9, s[36:39], s46 offen sc1
ff_fin_155:
    s_mov_b64 exec, -1
k12_end_1:
    s_endpgm
k2_prep_76:
    s_sub_u32 s40, s36, s38
    v_subrev_u32 v6, s40, v4
    v_cmp_gt_i32 s[44:45], 0, v6
    v_cmp_gt_i32 s[46:47], 1, v6
    v_cmp_gt_i32 s[48:49], 2, v6
    v_cmp_gt_i32 s[50:51], 3, v6
    v_cndmask_b32 v16, v8, v5, s[44:45]
    v_cndmask_b32 v17, v8, v5, s[46:47]
    v_cndmask_b32 v18, v8, v5, s[48:49]
    v_cndmask_b32 v19, v8, v5, s[50:51]
    v_cmp_gt_i32 s[44:45], 16, v6
    v_cmp_gt_i32 s[46:47], 17, v6
    v_cmp_gt_i32 s[48:49], 18, v6
    v_cmp_gt_i32 s[50:51], 19, v6
    v_cndmask_b32 v32, v8, v5, s[44:45]
    v_cndmask_b32 v33, v8, v5, s[46:47]
    v_cndmask_b32 v34, v8, v5, s[48:49]
    v_cndmask_b32 v35, v8, v5, s[50:51]
    s_nop 1
    s_branch k2_prepret_77
k2_prep_84:
    s_sub_u32 s40, s36, s38
    v_subrev_u32 v6, s40, v4
    v_cmp_gt_i32 s[44:45], 0, v6
    v_cmp_gt_i32 s[46:47], 1, v6
    v_cmp_gt_i32 s[48:49], 2, v6
    v_cmp_gt_i32 s[50:51], 3, v6
    v_cndmask_b32 v16, v8, v5, s[44:45]
    v_cndmask_b32 v17, v8, v5, s[46:47]
    v_cndmask_b32 v18, v8, v5, s[48:49]
    v_cndmask_b32 v19, v8, v5, s[50:51]
    v_cmp_gt_i32 s[44:45], 16, v6
    v_cmp_gt_i32 s[46:47], 17, v6
    v_cmp_gt_i32 s[48:49], 18, v6
    v_cmp_gt_i32 s[50:51], 19, v6
    v_cndmask_b32 v32, v8, v5, s[44:45]
    v_cndmask_b32 v33, v8, v5, s[46:47]
    v_cndmask_b32 v34, v8, v5, s[48:49]
    v_cndmask_b32 v35, v8, v5, s[50:51]
    s_nop 1
    s_branch k2_prepret_85
k2_prep_102:
    s_sub_u32 s40, s36, s39
    v_subrev_u32 v6, s40, v4
    v_cmp_gt_i32 s[44:45], 0, v6
    v_cmp_gt_i32 s[46:47], 1, v6
    v_cmp_gt_i32 s[48:49], 2, v6
    v_cmp_gt_i32 s[50:51], 3, v6
    v_cndmask_b32 v16, v10, v5, s[44:45]
    v_cndmask_b32 v17, v10, v5, s[46:47]
    v_cndmask_b32 v18, v10, v5, s[48:49]
    v_cndmask_b32 v19, v10, v5, s[50:51]
    v_cmp_gt_i32 s[44:45], 16, v6
    v_cmp_gt_i32 s[46:47], 17, v6
    v_cmp_gt_i32 s[48:49], 18, v6
    v_cmp_gt_i32 s[50:51], 19, v6
    v_cndmask_b32 v32, v10, v5, s[44:45]
    v_cndmask_b32 v33, v10, v5, s[46:47]
    v_cndmask_b32 v34, v10, v5, s[48:49]
    v_cndmask_b32 v35, v10, v5, s[50:51]
    v_cmp_gt_i32 s[44:45], 32, v6
    v_cmp_gt_i32 s[46:47], 33, v6
    v_cmp_gt_i32 s[48:49], 34, v6
    v_cmp_gt_i32 s[50:51], 35, v6
    v_cndmask_b32 v24, v10, v5, s[44:45]
    v_cndmask_b32 v25, v10, v5, s[46:47]
    v_cndmask_b32 v26, v10, v5, s[48:49]
    v_cndmask_b32 v27, v10, v5, s[50:51]
    v_cmp_gt_i32 s[44:45], 48, v6
    v_cmp_gt_i32 s[46:47], 49, v6
    v_cmp_gt_i32 s[48:49], 50, v6
    v_cmp_gt_i32 s[50:51], 51, v6
    v_cndmask_b32 v40, v10, v5, s[44:45]
    v_cndmask_b32 v41, v10, v5, s[46:47]
    v_cndmask_b32 v42, v10, v5, s[48:49]
    v_cndmask_b32 v43, v10, v5, s[50:51]
    s_nop 1
    s_branch k2_prepret_103
k2_prep_106:
    s_sub_u32 s40, s36, s39
    s_sub_u32 s40, s40, 64
    v_subrev_u32 v6, s40, v4
    v_cmp_gt_i32 s[44:45], 0, v6
    v_cmp_gt_i32 s[46:47], 1, v6
    v_cmp_gt_i32 s[48:49], 2, v6
    v_cmp_gt_i32 s[50:51], 3, v6
    v_cndmask_b32 v20, v11, v5, s[44:45]
    v_cndmask_b32 v21, v11, v5, s[46:47]
    v_cndmask_b32 v22, v11, v5, s[48:49]
    v_cndmask_b32 v23, v11, v5, s[50:51]
    v_cmp_gt_i32 s[44:45], 16, v6
    v_cmp_gt_i32 s[46:47], 17, v6
    v_cmp_gt_i32 s[48:49], 18, v6
    v_cmp_gt_i32 s[50:51], 19, v6
    v_cndmask_b32 v36, v11, v5, s[44:45]
    v_cndmask_b32 v37, v11, v5, s[46:47]
    v_cndmask_b32 v38, v11, v5, s[48:49]
    v_cndmask_b32 v39, v11, v5, s[50:51]
    v_cmp_gt_i32 s[44:45], 32, v6
    v_cmp_gt_i32 s[46:47], 33, v6
    v_cmp_gt_i32 s[48:49], 34, v6
    v_cmp_gt_i32 s[50:51], 35, v6
    v_cndmask_b32 v28, v11, v5, s[44:45]
    v_cndmask_b32 v29, v11, v5, s[46:47]
    v_cndmask_b32 v30, v11, v5, s[48:49]
    v_cndmask_b32 v31, v11, v5, s[50:51]
    v_cmp_gt_i32 s[44:45], 48, v6
    v_cmp_gt_i32 s[46:47], 49, v6
    v_cmp_gt_i32 s[48:49], 50, v6
    v_cmp_gt_i32 s[50:51], 51, v6
    v_cndmask_b32 v44, v11, v5, s[44:45]
    v_cndmask_b32 v45, v11, v5, s[46:47]
    v_cndmask_b32 v46, v11, v5, s[48:49]
    v_cndmask_b32 v47, v11, v5, s[50:51]
    s_nop 1
    s_branch k2_prepret_107
k12_ool_10:
    buffer_load_dword v52, v8, s[24:27], 0 offen sc1
    s_branch k12_oolret_11
k12_ool_14:
    v_readfirstlane_b32 s31, v52
    s_cmp_ge_u32 s31, 256
    s_cbranch_scc1 spin_ok_12
    s_mov_b32 s40, 1048576
spin_13:
    s_sleep 8
    buffer_load_dword v52, v8, s[24:27], 0 offen sc1
    s_waitcnt vmcnt(0)
    v_readfirstlane_b32 s31, v52
    s_sub_u32 s40, s40, 1
    s_cselect_b32 s31, -1, s31
    s_cmp_lt_u32 s31, 256
    s_cbranch_scc1 spin_13
spin_ok_12:
    s_branch k12_oolret_15
k12_ool_16:
    s_mov_b64 exec, 1
    buffer_atomic_add v9, v8, s[24:27], 0 offen sc1
    s_mov_b64 exec, -1
    s_branch k12_oolret_17
k12_ool_18:
    buffer_load_dword v51, v50, s[12:15], s56 offen
    s_branch k12_oolret_19
k12_ool_20:
    s_add_u32 m0, s60, 131072
    s_nop 0
    buffer_load_dwordx4 v38, s[12:15], s61 offen offset:0 lds
    buffer_load_dwordx4 v39, s[12:15], s61 offen offset:1024 lds
    buffer_load_dwordx4 v40, s[12:15], s61 offen offset:2048 lds
    buffer_load_dwordx4 v41, s[12:15], s61 offen offset:3072 lds
    s_add_u32 s61, s61, 0x80000
    s_add_u32 m0, s60, 147456
    s_nop 0
    buffer_load_dwordx4 v38, s[12:15], s61 offen offset:0 lds
    buffer_load_dwordx4 v39, s[12:15], s61 offen offset:1024 lds
    buffer_load_dwordx4 v40, s[12:15], s61 offen offset:2048 lds
    buffer_load_dwordx4 v41, s[12:15], s61 offen offset:3072 lds
    s_add_u32 s61, s61, 0x80000
    s_branch k12_oolret_21
k12_ool_22:
    s_mov_b64 exec, 1
    buffer_atomic_add v9, v8, s[24:27], 0 offen sc1
    s_mov_b64 exec, -1
    s_branch k12_oolret_23
k12_ool_24:
    buffer_load_dword v51, v50, s[12:15], s56 offen
    s_branch k12_oolret_25
k12_ool_26:
    global_load_dword v51, v[2:3], off
    s_branch k12_oolret_27
k12_ool_30:
    buffer_load_dword v52, v8, s[24:27], 0 offen sc1
    s_branch k12_oolret_31
k12_ool_34:
    v_readfirstlane_b32 s31, v52
    s_cmp_ge_u32 s31, 256
    s_cbranch_scc1 spin_ok_32
    s_mov_b32 s40, 1048576
spin_33:
    s_sleep 8
    buffer_load_dword v52, v8, s[24:27], 0 offen sc1
    s_waitcnt vmcnt(0)
    v_readfirstlane_b32 s31, v52
    s_sub_u32 s40, s40, 1
    s_cselect_b32 s31, -1, s31
    s_cmp_lt_u32 s31, 256
    s_cbranch_scc1 spin_33
spin_ok_32:
    s_branch k12_oolret_35
k12_ool_36:
    s_mov_b64 exec, 1
    buffer_atomic_add v9, v8, s[24:27], 0 offen sc1
    s_mov_b64 exec, -1
    s_branch k12_oolret_37
k12_ool_38:
    buffer_load_dword v51, v50, s[12:15], s56 offen
    s_branch k12_oolret_39
k12_ool_40:
    s_add_u32 m0, s60, 131072
    s_nop 0
    buffer_load_dwordx4 v38, s[12:15], s61 offen offset:0 lds
    buffer_load_dwordx4 v39, s[12:15], s61 offen offset:1024 lds
    buffer_load_dwordx4 v40, s[12:15], s61 offen offset:2048 lds
    buffer_load_dwordx4 v41, s[12:15], s61 offen offset:3072 lds
    s_add_u32 s61, s61, 0x80000
    s_add_u32 m0, s60, 147456
    s_nop 0
    buffer_load_dwordx4 v38, s[12:15], s61 offen offset:0 lds
    buffer_load_dwordx4 v39, s[12:15], s61 offen offset:1024 lds
    buffer_load_dwordx4 v40, s[12:15], s61 offen offset:2048 lds
    buffer_load_dwordx4 v41, s[12:15], s61 offen offset:3072 lds
    s_add_u32 s61, s61, 0x80000
    s_branch k12_oolret_41
k12_ool_42:
    s_mov_b64 exec, 1
    buffer_atomic_add v9, v8, s[24:27], 0 offen sc1
    s_mov_b64 exec, -1
    s_branch k12_oolret_43
k12_ool_44:
    buffer_load_dword v51, v50, s[12:15], s56 offen
    s_branch k12_oolret_45
k12_ool_46:
    global_load_dword v51, v[2:3], off
    s_branch k12_oolret_47
k12_ool_48:
    s_add_u32 s52, s47, 528384
    buffer_store_dwordx4 v[152:155], v1, s[48:51], s52 offen offset:2048 sc1
    s_branch k12_oolret_49
k12_ool_50:
    s_add_u32 s52, s47, 528384
    buffer_store_dwordx4 v[156:159], v1, s[48:51], s52 offen offset:3072 sc1
    s_branch k12_oolret_51
k12_ool_52:
    s_add_u32 s52, s47, 532480
    buffer_store_dwordx4 v[168:171], v1, s[48:51], s52 offen offset:2048 sc1
    s_branch k12_oolret_53
k12_ool_54:
    s_add_u32 s52, s47, 532480
    buffer_store_dwordx4 v[172:175], v1, s[48:51], s52 offen offset:3072 sc1
    s_branch k12_oolret_55
k12_ool_56:
    s_add_u32 s52, s47, 536576
    buffer_store_dwordx4 v[176:179], v1, s[48:51], s52 offen offset:0 sc1
    s_branch k12_oolret_57
k12_ool_58:
    s_add_u32 s52, s47, 536576
    buffer_store_dwordx4 v[180:183], v1, s[48:51], s52 offen offset:1024 sc1
    s_branch k12_oolret_59
k12_ool_60:
    s_add_u32 s52, s47, 536576
    buffer_store_dwordx4 v[184:187], v1, s[48:51], s52 offen offset:2048 sc1
    s_branch k12_oolret_61
k12_ool_62:
    s_add_u32 s52, s47, 536576
    buffer_store_dwordx4 v[188:191], v1, s[48:51], s52 offen offset:3072 sc1
    s_branch k12_oolret_63
k12_ool_64:
    s_mov_b32 s50, 0
    s_branch k12_oolret_65
k12_ool_66:
    s_mov_b64 exec, 1
    buffer_atomic_add v9, v8, s[24:27], s54 offen sc1
    s_mov_b64 exec, -1
    s_branch k12_oolret_67
k12_ool_68:
    buffer_load_dword v52, v8, s[24:27], s55 offen sc1
    s_branch k12_oolret_69
k12_ool_72:
    s_waitcnt vmcnt(14)
    v_readfirstlane_b32 s31, v52
    s_cmp_ge_u32 s31, 2
    s_cbranch_scc1 spin_ok_70
    s_mov_b32 s40, 1048576
spin_71:
    s_sleep 8
    buffer_load_dword v52, v8, s[24:27], s55 offen sc1
    s_waitcnt vmcnt(0)
    v_readfirstlane_b32 s31, v52
    s_sub_u32 s40, s40, 1
    s_cselect_b32 s31, -1, s31
    s_cmp_lt_u32 s31, 2
    s_cbranch_scc1 spin_71
spin_ok_70:
    s_branch k12_oolret_73
k12_ool_74:
    s_mov_b64 exec, 1
    buffer_atomic_add v9, v8, s[24:27], s3 offen sc1
    s_mov_b64 exec, -1
    s_branch k12_oolret_75
k12_ool_78:
    buffer_load_dword v58, v59, s[24:27], s5 offen sc1
    s_branch k12_oolret_79
k12_ool_82:
    s_waitcnt vmcnt(0)
    v_readfirstlane_b32 s31, v58
    s_cmp_ge_u32 s31, 14
    s_cbranch_scc1 spin_ok_80
    s_mov_b32 s40, 1048576
spin_81:
    s_sleep 8
    buffer_load_dword v58, v59, s[24:27], s5 offen sc1
    s_waitcnt vmcnt(0)
    v_readfirstlane_b32 s31, v58
    s_sub_u32 s40, s40, 1
    s_cselect_b32 s31, -1, s31
    s_cmp_lt_u32 s31, 14
    s_cbranch_scc1 spin_81
spin_ok_80:
    s_branch k12_oolret_83
k12_ool_122:
    s_mov_b64 exec, 1
    buffer_atomic_add v76, v75, s[16:19], s57 offen sc1
    s_mov_b64 exec, -1
    s_branch k12_oolret_123
k12_ool_127:
    s_mov_b64 exec, 1
    buffer_atomic_add v76, v75, s[16:19], s58 offen sc1
    s_mov_b64 exec, -1
    s_branch k12_oolret_128
k12_ool_131:
    s_mov_b32 s34, 1048576
op_spin_129:
    buffer_load_dword v74, v73, s[16:19], s59 offen sc1
    s_waitcnt vmcnt(0)
    v_cmp_le_u32 vcc, 4, v74
    s_sub_u32 s34, s34, 1
    s_cbranch_scc1 op_ok_130
    s_mov_b32 s33, vcc_lo
    s_bitcmp1_b32 s33, 0
    s_cbranch_scc1 op_ok_130
    s_sleep 4
    s_branch op_spin_129
op_ok_130:
    buffer_load_dwordx4 a[128:131], v88, s[8:11], s62 offen offset:0 sc1
    buffer_load_dwordx4 a[132:135], v88, s[8:11], s62 offen offset:1024 sc1
    buffer_load_dwordx4 a[136:139], v89, s[8:11], s62 offen offset:0 sc1
    buffer_load_dwordx4 a[140:143], v89, s[8:11], s62 offen offset:1024 sc1
    s_add_u32 s62, s62, 0x40000
    s_and_b32 s62, s62, 0x7fffff
    buffer_load_dwordx4 a[144:147], v88, s[8:11], s62 offen offset:0 sc1
    buffer_load_dwordx4 a[148:151], v88, s[8:11], s62 offen offset:1024 sc1
    buffer_load_dwordx4 a[152:155], v89, s[8:11], s62 offen offset:0 sc1
    buffer_load_dwordx4 a[156:159], v89, s[8:11], s62 offen offset:1024 sc1
    s_add_u32 s62, s62, 0x40000
    s_and_b32 s62, s62, 0x7fffff
    buffer_load_dwordx4 a[160:163], v88, s[8:11], s62 offen offset:0 sc1
    buffer_load_dwordx4 a[164:167], v88, s[8:11], s62 offen offset:1024 sc1
    buffer_load_dwordx4 a[168:171], v89, s[8:11], s62 offen offset:0 sc1
    buffer_load_dwordx4 a[172:175], v89, s[8:11], s62 offen offset:1024 sc1
    s_add_u32 s62, s62, 0x40000
    s_and_b32 s62, s62, 0x7fffff
    s_branch k12_oolret_132
k12_ool_137:
    buffer_load_dwordx2 v[192:193], v78, s[20:23], 0 offen offset:0
    buffer_load_dwordx2 v[194:195], v78, s[20:23], 0 offen offset:32
    buffer_load_dwordx2 v[196:197], v78, s[20:23], 0 offen offset:64
    buffer_load_dwordx2 v[198:199], v78, s[20:23], 0 offen offset:96
    buffer_load_dwordx2 v[200:201], v79, s[20:23], 0 offen offset:0
    buffer_load_dwordx2 v[202:203], v79, s[20:23], 0 offen offset:32
    buffer_load_dwordx2 v[204:205], v79, s[20:23], 0 offen offset:64
    buffer_load_dwordx2 v[206:207], v79, s[20:23], 0 offen offset:96
    buffer_load_dwordx2 v[208:209], v80, s[44:47], 0 offen offset:0
    buffer_load_dwordx2 v[210:211], v80, s[44:47], 0 offen offset:32
    buffer_load_dwordx2 v[212:213], v80, s[44:47], 0 offen offset:64
    buffer_load_dwordx2 v[214:215], v80, s[44:47], 0 offen offset:96
    global_load_dword v84, v[82:83], off
    s_mov_b32 s10, 0
    s_mov_b32 s14, 0
    s_mov_b32 s34, 1048576
ff_spin_135:
    v_cmp_gt_u32 vcc, 4, v95
    s_cbranch_vccz ff_ok_136
    s_sub_u32 s34, s34, 1
    s_cbranch_scc1 ff_ok_136
    s_sleep 4
    buffer_load_dword v95, v94, s[16:19], 0 offen sc1
    s_waitcnt vmcnt(0)
    s_branch ff_spin_135
ff_ok_136:
    s_add_u32 s44, s6, 0x6000000
    s_addc_u32 s45, s7, 0
    s_and_b32 s45, s45, 0xffff
    s_cmp_ge_u32 s2, 224
    s_cselect_b32 s46, 0, 0x1000000
    s_branch k12_oolret_138
k12_ool_141:
    s_mov_b32 s34, 1048576
op_spin_139:
    buffer_load_dword v74, v73, s[16:19], s59 offen sc1
    s_waitcnt vmcnt(0)
    v_cmp_le_u32 vcc, 4, v74
    s_sub_u32 s34, s34, 1
    s_cbranch_scc1 op_ok_140
    s_mov_b32 s33, vcc_lo
    s_bitcmp1_b32 s33, s32
    s_cbranch_scc1 op_ok_140
    s_sleep 4
    s_branch op_spin_139
op_ok_140:
    s_branch k12_oolret_142
k12_ool_143:
    buffer_load_dword v95, v94, s[16:19], 0 offen sc1
    s_branch k12_oolret_144
k2_tramp_86:
    s_call_b64 s[40:41], k2_rare_158
    s_branch k2_ret_87
k2_tramp_90:
    s_call_b64 s[40:41], k2_rare_159
    s_branch k2_ret_91
k2_tramp_92:
    s_call_b64 s[40:41], k2_rare_158
    s_branch k2_ret_93
k2_tramp_94:
    s_call_b64 s[40:41], k2_rare_159
    s_branch k2_ret_95
k2_tramp_96:
    s_call_b64 s[40:41], k2_rare_158
    s_branch k2_ret_97
k2_tramp_98:
    s_call_b64 s[40:41], k2_rare_159
    s_branch k2_ret_99
k2_tramp_100:
    s_call_b64 s[40:41], k2_rare_164
    s_branch k2_ret_101
k2_tramp_104:
    s_call_b64 s[40:41], k2_rare_165
    s_branch k2_ret_105
k2_tramp_108:
    s_call_b64 s[40:41], k2_rare_166
    s_branch k2_ret_109
k2_tramp_112:
    s_call_b64 s[40:41], k2_rare_167
    s_branch k2_ret_113
k2_tramp_114:
    s_call_b64 s[40:41], k2_rare_166
    s_branch k2_ret_115
k2_tramp_116:
    s_call_b64 s[40:41], k2_rare_167
    s_branch k2_ret_117
k2_tramp_118:
    s_call_b64 s[40:41], k2_rare_166
    s_branch k2_ret_119
k2_tramp_120:
    s_call_b64 s[40:41], k2_rare_171
    s_branch k2_ret_121
k2_rare_158:
    s_nop 7
    v_max_f32 v52, v128, v129
    v_max3_f32 v52, v52, v130, v131
    v_max3_f32 v52, v52, v144, v145
    v_max3_f32 v52, v52, v146, v147
    v_max_f32 v53, v132, v133
    v_max3_f32 v53, v53, v134, v135
    v_max3_f32 v53, v53, v148, v149
    v_max3_f32 v53, v53, v150, v151
    v_max_f32 v54, v136, v137
    v_max3_f32 v54, v54, v138, v139
    v_max3_f32 v54, v54, v152, v153
    v_max3_f32 v54, v54, v154, v155
    v_max_f32 v55, v140, v141
    v_max3_f32 v55, v55, v142, v143
    v_max3_f32 v55, v55, v156, v157
    v_max3_f32 v55, v55, v158, v159
    v_mov_b32 v224, v52
    v_mov_b32 v225, v53
    v_mov_b32 v226, v54
    v_mov_b32 v227, v55
    s_nop 1
    v_permlane16_swap_b32 v52, v224
    v_permlane16_swap_b32 v53, v225
    v_permlane16_swap_b32 v54, v226
    v_permlane16_swap_b32 v55, v227
    s_nop 1
    v_max_f32 v52, v52, v224
    v_max_f32 v53, v53, v225
    v_max_f32 v54, v54, v226
    v_max_f32 v55, v55, v227
    v_mov_b32 v224, v52
    v_mov_b32 v225, v53
    v_mov_b32 v226, v54
    v_mov_b32 v227, v55
    s_nop 1
    v_permlane32_swap_b32 v52, v224
    v_permlane32_swap_b32 v53, v225
    v_permlane32_swap_b32 v54, v226
    v_permlane32_swap_b32 v55, v227
    s_nop 1
    v_max_f32 v52, v52, v224
    v_max_f32 v53, v53, v225
    v_max_f32 v54, v54, v226
    v_max_f32 v55, v55, v227
    v_add_f32 v52, 0x41400000, v52
    v_max_f32 v52, 0, v52
    v_add_f32 v53, 0x41400000, v53
    v_max_f32 v53, 0, v53
    v_add_f32 v54, 0x41400000, v54
    v_max_f32 v54, 0, v54
    v_add_f32 v55, 0x41400000, v55
    v_max_f32 v55, 0, v55
    v_sub_f32 v128, v128, v52
    v_sub_f32 v129, v129, v52
    v_sub_f32 v130, v130, v52
    v_sub_f32 v131, v131, v52
    v_sub_f32 v132, v132, v53
    v_sub_f32 v133, v133, v53
    v_sub_f32 v134, v134, v53
    v_sub_f32 v135, v135, v53
    v_sub_f32 v136, v136, v54
    v_sub_f32 v137, v137, v54
    v_sub_f32 v138, v138, v54
    v_sub_f32 v139, v139, v54
    v_sub_f32 v140, v140, v55
    v_sub_f32 v141, v141, v55
    v_sub_f32 v142, v142, v55
    v_sub_f32 v143, v143, v55
    v_sub_f32 v144, v144, v52
    v_sub_f32 v145, v145, v52
    v_sub_f32 v146, v146, v52
    v_sub_f32 v147, v147, v52
    v_sub_f32 v148, v148, v53
    v_sub_f32 v149, v149, v53
    v_sub_f32 v150, v150, v53
    v_sub_f32 v151, v151, v53
    v_sub_f32 v152, v152, v54
    v_sub_f32 v153, v153, v54
    v_sub_f32 v154, v154, v54
    v_sub_f32 v155, v155, v54
    v_sub_f32 v156, v156, v55
    v_sub_f32 v157, v157, v55
    v_sub_f32 v158, v158, v55
    v_sub_f32 v159, v159, v55
    v_sub_f32 v160, v160, v52
    v_sub_f32 v16, v16, v52
    v_sub_f32 v161, v161, v52
    v_sub_f32 v17, v17, v52
    v_sub_f32 v162, v162, v52
    v_sub_f32 v18, v18, v52
    v_sub_f32 v163, v163, v52
    v_sub_f32 v19, v19, v52
    v_sub_f32 v164, v164, v53
    v_sub_f32 v20, v20, v53
    v_sub_f32 v165, v165, v53
    v_sub_f32 v21, v21, v53
    v_sub_f32 v166, v166, v53
    v_sub_f32 v22, v22, v53
    v_sub_f32 v167, v167, v53
    v_sub_f32 v23, v23, v53
    v_sub_f32 v168, v168, v54
    v_sub_f32 v24, v24, v54
    v_sub_f32 v169, v169, v54
    v_sub_f32 v25, v25, v54
    v_sub_f32 v170, v170, v54
    v_sub_f32 v26, v26, v54
    v_sub_f32 v171, v171, v54
    v_sub_f32 v27, v27, v54
    v_sub_f32 v172, v172, v55
    v_sub_f32 v28, v28, v55
    v_sub_f32 v173, v173, v55
    v_sub_f32 v29, v29, v55
    v_sub_f32 v174, v174, v55
    v_sub_f32 v30, v30, v55
    v_sub_f32 v175, v175, v55
    v_sub_f32 v31, v31, v55
    v_sub_f32 v176, v176, v52
    v_sub_f32 v32, v32, v52
    v_sub_f32 v177, v177, v52
    v_sub_f32 v33, v33, v52
    v_sub_f32 v178, v178, v52
    v_sub_f32 v34, v34, v52
    v_sub_f32 v179, v179, v52
    v_sub_f32 v35, v35, v52
    v_sub_f32 v180, v180, v53
    v_sub_f32 v36, v36, v53
    v_sub_f32 v181, v181, v53
    v_sub_f32 v37, v37, v53
    v_sub_f32 v182, v182, v53
    v_sub_f32 v38, v38, v53
    v_sub_f32 v183, v183, v53
    v_sub_f32 v39, v39, v53
    v_sub_f32 v184, v184, v54
    v_sub_f32 v40, v40, v54
    v_sub_f32 v185, v185, v54
    v_sub_f32 v41, v41, v54
    v_sub_f32 v186, v186, v54
    v_sub_f32 v42, v42, v54
    v_sub_f32 v187, v187, v54
    v_sub_f32 v43, v43, v54
    v_sub_f32 v188, v188, v55
    v_sub_f32 v44, v44, v55
    v_sub_f32 v189, v189, v55
    v_sub_f32 v45, v45, v55
    v_sub_f32 v190, v190, v55
    v_sub_f32 v46, v46, v55
    v_sub_f32 v191, v191, v55
    v_sub_f32 v47, v47, v55
    v_sub_f32 v8, v8, v52
    v_exp_f32 v52, -v52
    v_sub_f32 v9, v9, v53
    v_exp_f32 v53, -v53
    v_sub_f32 v10, v10, v54
    v_exp_f32 v54, -v54
    v_sub_f32 v11, v11, v55
    v_exp_f32 v55, -v55
    s_nop 0
    v_mul_f32 v12, v12, v52
    v_mul_f32 v48, v48, v53
    v_mul_f32 v248, v248, v54
    v_mul_f32 v252, v252, v55
    v_accvgpr_read_b32 v224, a0
    v_accvgpr_read_b32 v225, a1
    v_accvgpr_read_b32 v226, a2
    v_accvgpr_read_b32 v227, a3
    v_mul_f32 v224, v224, v52
    v_mul_f32 v225, v225, v52
    v_mul_f32 v226, v226, v52
    v_mul_f32 v227, v227, v52
    v_accvgpr_write_b32 a0, v224
    v_accvgpr_write_b32 a1, v225
    v_accvgpr_write_b32 a2, v226
    v_accvgpr_write_b32 a3, v227
    v_accvgpr_read_b32 v224, a4
    v_accvgpr_read_b32 v225, a5
    v_accvgpr_read_b32 v226, a6
    v_accvgpr_read_b32 v227, a7
    v_mul_f32 v224, v224, v53
    v_mul_f32 v225, v225, v53
    v_mul_f32 v226, v226, v53
    v_mul_f32 v227, v227, v53
    v_accvgpr_write_b32 a4, v224
    v_accvgpr_write_b32 a5, v225
    v_accvgpr_write_b32 a6, v226
    v_accvgpr_write_b32 a7, v227
    v_accvgpr_read_b32 v224, a8
    v_accvgpr_read_b32 v225, a9
    v_accvgpr_read_b32 v226, a10
    v_accvgpr_read_b32 v227, a11
    v_mul_f32 v224, v224, v54
    v_mul_f32 v225, v225, v54
    v_mul_f32 v226, v226, v54
    v_mul_f32 v227, v227, v54
    v_accvgpr_write_b32 a8, v224
    v_accvgpr_write_b32 a9, v225
    v_accvgpr_write_b32 a10, v226
    v_accvgpr_write_b32 a11, v227
    v_accvgpr_read_b32 v224, a12
    v_accvgpr_read_b32 v225, a13
    v_accvgpr_read_b32 v226, a14
    v_accvgpr_read_b32 v227, a15
    v_mul_f32 v224, v224, v55
    v_mul_f32 v225, v225, v55
    v_mul_f32 v226, v226, v55
    v_mul_f32 v227, v227, v55
    v_accvgpr_write_b32 a12, v224
    v_accvgpr_write_b32 a13, v225
    v_accvgpr_write_b32 a14, v226
    v_accvgpr_write_b32 a15, v227
    v_accvgpr_read_b32 v224, a16
    v_accvgpr_read_b32 v225, a17
    v_accvgpr_read_b32 v226, a18
    v_accvgpr_read_b32 v227, a19
    v_mul_f32 v224, v224, v52
    v_mul_f32 v225, v225, v52
    v_mul_f32 v226, v226, v52
    v_mul_f32 v227, v227, v52
    v_accvgpr_write_b32 a16, v224
    v_accvgpr_write_b32 a17, v225
    v_accvgpr_write_b32 a18, v226
    v_accvgpr_write_b32 a19, v227
    v_accvgpr_read_b32 v224, a20
    v_accvgpr_read_b32 v225, a21
    v_accvgpr_read_b32 v226, a22
    v_accvgpr_read_b32 v227, a23
    v_mul_f32 v224, v224, v53
    v_mul_f32 v225, v225, v53
    v_mul_f32 v226, v226, v53
    v_mul_f32 v227, v227, v53
    v_accvgpr_write_b32 a20, v224
    v_accvgpr_write_b32 a21, v225
    v_accvgpr_write_b32 a22, v226
    v_accvgpr_write_b32 a23, v227
    v_accvgpr_read_b32 v224, a24
    v_accvgpr_read_b32 v225, a25
    v_accvgpr_read_b32 v226, a26
    v_accvgpr_read_b32 v227, a27
    v_mul_f32 v224, v224, v54
    v_mul_f32 v225, v225, v54
    v_mul_f32 v226, v226, v54
    v_mul_f32 v227, v227, v54
    v_accvgpr_write_b32 a24, v224
    v_accvgpr_write_b32 a25, v225
    v_accvgpr_write_b32 a26, v226
    v_accvgpr_write_b32 a27, v227
    v_accvgpr_read_b32 v224, a28
    v_accvgpr_read_b32 v225, a29
    v_accvgpr_read_b32 v226, a30
    v_accvgpr_read_b32 v227, a31
    v_mul_f32 v224, v224, v55
    v_mul_f32 v225, v225, v55
    v_mul_f32 v226, v226, v55
    v_mul_f32 v227, v227, v55
    v_accvgpr_write_b32 a28, v224
    v_accvgpr_write_b32 a29, v225
    v_accvgpr_write_b32 a30, v226
    v_accvgpr_write_b32 a31, v227
    v_accvgpr_read_b32 v224, a32
    v_accvgpr_read_b32 v225, a33
    v_accvgpr_read_b32 v226, a34
    v_accvgpr_read_b32 v227, a35
    v_mul_f32 v224, v224, v52
    v_mul_f32 v225, v225, v52
    v_mul_f32 v226, v226, v52
    v_mul_f32 v227, v227, v52
    v_accvgpr_write_b32 a32, v224
    v_accvgpr_write_b32 a33, v225
    v_accvgpr_write_b32 a34, v226
    v_accvgpr_write_b32 a35, v227
    v_accvgpr_read_b32 v224, a36
    v_accvgpr_read_b32 v225, a37
    v_accvgpr_read_b32 v226, a38
    v_accvgpr_read_b32 v227, a39
    v_mul_f32 v224, v224, v53
    v_mul_f32 v225, v225, v53
    v_mul_f32 v226, v226, v53
    v_mul_f32 v227, v227, v53
    v_accvgpr_write_b32 a36, v224
    v_accvgpr_write_b32 a37, v225
    v_accvgpr_write_b32 a38, v226
    v_accvgpr_write_b32 a39, v227
    v_accvgpr_read_b32 v224, a40
    v_accvgpr_read_b32 v225, a41
    v_accvgpr_read_b32 v226, a42
    v_accvgpr_read_b32 v227, a43
    v_mul_f32 v224, v224, v54
    v_mul_f32 v225, v225, v54
    v_mul_f32 v226, v226, v54
    v_mul_f32 v227, v227, v54
    v_accvgpr_write_b32 a40, v224
    v_accvgpr_write_b32 a41, v225
    v_accvgpr_write_b32 a42, v226
    v_accvgpr_write_b32 a43, v227
    v_accvgpr_read_b32 v224, a44
    v_accvgpr_read_b32 v225, a45
    v_accvgpr_read_b32 v226, a46
    v_accvgpr_read_b32 v227, a47
    v_mul_f32 v224, v224, v55
    v_mul_f32 v225, v225, v55
    v_mul_f32 v226, v226, v55
    v_mul_f32 v227, v227, v55
    v_accvgpr_write_b32 a44, v224
    v_accvgpr_write_b32 a45, v225
    v_accvgpr_write_b32 a46, v226
    v_accvgpr_write_b32 a47, v227
    v_accvgpr_read_b32 v224, a48
    v_accvgpr_read_b32 v225, a49
    v_accvgpr_read_b32 v226, a50
    v_accvgpr_read_b32 v227, a51
    v_mul_f32 v224, v224, v52
    v_mul_f32 v225, v225, v52
    v_mul_f32 v226, v226, v52
    v_mul_f32 v227, v227, v52
    v_accvgpr_write_b32 a48, v224
    v_accvgpr_write_b32 a49, v225
    v_accvgpr_write_b32 a50, v226
    v_accvgpr_write_b32 a51, v227
    v_accvgpr_read_b32 v224, a52
    v_accvgpr_read_b32 v225, a53
    v_accvgpr_read_b32 v226, a54
    v_accvgpr_read_b32 v227, a55
    v_mul_f32 v224, v224, v53
    v_mul_f32 v225, v225, v53
    v_mul_f32 v226, v226, v53
    v_mul_f32 v227, v227, v53
    v_accvgpr_write_b32 a52, v224
    v_accvgpr_write_b32 a53, v225
    v_accvgpr_write_b32 a54, v226
    v_accvgpr_write_b32 a55, v227
    v_accvgpr_read_b32 v224, a56
    v_accvgpr_read_b32 v225, a57
    v_accvgpr_read_b32 v226, a58
    v_accvgpr_read_b32 v227, a59
    v_mul_f32 v224, v224, v54
    v_mul_f32 v225, v225, v54
    v_mul_f32 v226, v226, v54
    v_mul_f32 v227, v227, v54
    v_accvgpr_write_b32 a56, v224
    v_accvgpr_write_b32 a57, v225
    v_accvgpr_write_b32 a58, v226
    v_accvgpr_write_b32 a59, v227
    v_accvgpr_read_b32 v224, a60
    v_accvgpr_read_b32 v225, a61
    v_accvgpr_read_b32 v226, a62
    v_accvgpr_read_b32 v227, a63
    v_mul_f32 v224, v224, v55
    v_mul_f32 v225, v225, v55
    v_mul_f32 v226, v226, v55
    v_mul_f32 v227, v227, v55
    v_accvgpr_write_b32 a60, v224
    v_accvgpr_write_b32 a61, v225
    v_accvgpr_write_b32 a62, v226
    v_accvgpr_write_b32 a63, v227
    v_accvgpr_read_b32 v224, a64
    v_accvgpr_read_b32 v225, a65
    v_accvgpr_read_b32 v226, a66
    v_accvgpr_read_b32 v227, a67
    v_mul_f32 v224, v224, v52
    v_mul_f32 v225, v225, v52
    v_mul_f32 v226, v226, v52
    v_mul_f32 v227, v227, v52
    v_accvgpr_write_b32 a64, v224
    v_accvgpr_write_b32 a65, v225
    v_accvgpr_write_b32 a66, v226
    v_accvgpr_write_b32 a67, v227
    v_accvgpr_read_b32 v224, a68
    v_accvgpr_read_b32 v225, a69
    v_accvgpr_read_b32 v226, a70
    v_accvgpr_read_b32 v227, a71
    v_mul_f32 v224, v224, v53
    v_mul_f32 v225, v225, v53
    v_mul_f32 v226, v226, v53
    v_mul_f32 v227, v227, v53
    v_accvgpr_write_b32 a68, v224
    v_accvgpr_write_b32 a69, v225
    v_accvgpr_write_b32 a70, v226
    v_accvgpr_write_b32 a71, v227
    v_accvgpr_read_b32 v224, a72
    v_accvgpr_read_b32 v225, a73
    v_accvgpr_read_b32 v226, a74
    v_accvgpr_read_b32 v227, a75
    v_mul_f32 v224, v224, v54
    v_mul_f32 v225, v225, v54
    v_mul_f32 v226, v226, v54
    v_mul_f32 v227, v227, v54
    v_accvgpr_write_b32 a72, v224
    v_accvgpr_write_b32 a73, v225
    v_accvgpr_write_b32 a74, v226
    v_accvgpr_write_b32 a75, v227
    v_accvgpr_read_b32 v224, a76
    v_accvgpr_read_b32 v225, a77
    v_accvgpr_read_b32 v226, a78
    v_accvgpr_read_b32 v227, a79
    v_mul_f32 v224, v224, v55
    v_mul_f32 v225, v225, v55
    v_mul_f32 v226, v226, v55
    v_mul_f32 v227, v227, v55
    v_accvgpr_write_b32 a76, v224
    v_accvgpr_write_b32 a77, v225
    v_accvgpr_write_b32 a78, v226
    v_accvgpr_write_b32 a79, v227
    v_accvgpr_read_b32 v224, a80
    v_accvgpr_read_b32 v225, a81
    v_accvgpr_read_b32 v226, a82
    v_accvgpr_read_b32 v227, a83
    v_mul_f32 v224, v224, v52
    v_mul_f32 v225, v225, v52
    v_mul_f32 v226, v226, v52
    v_mul_f32 v227, v227, v52
    v_accvgpr_write_b32 a80, v224
    v_accvgpr_write_b32 a81, v225
    v_accvgpr_write_b32 a82, v226
    v_accvgpr_write_b32 a83, v227
    v_accvgpr_read_b32 v224, a84
    v_accvgpr_read_b32 v225, a85
    v_accvgpr_read_b32 v226, a86
    v_accvgpr_read_b32 v227, a87
    v_mul_f32 v224, v224, v53
    v_mul_f32 v225, v225, v53
    v_mul_f32 v226, v226, v53
    v_mul_f32 v227, v227, v53
    v_accvgpr_write_b32 a84, v224
    v_accvgpr_write_b32 a85, v225
    v_accvgpr_write_b32 a86, v226
    v_accvgpr_write_b32 a87, v227
    v_accvgpr_read_b32 v224, a88
    v_accvgpr_read_b32 v225, a89
    v_accvgpr_read_b32 v226, a90
    v_accvgpr_read_b32 v227, a91
    v_mul_f32 v224, v224, v54
    v_mul_f32 v225, v225, v54
    v_mul_f32 v226, v226, v54
    v_mul_f32 v227, v227, v54
    v_accvgpr_write_b32 a88, v224
    v_accvgpr_write_b32 a89, v225
    v_accvgpr_write_b32 a90, v226
    v_accvgpr_write_b32 a91, v227
    v_accvgpr_read_b32 v224, a92
    v_accvgpr_read_b32 v225, a93
    v_accvgpr_read_b32 v226, a94
    v_accvgpr_read_b32 v227, a95
    v_mul_f32 v224, v224, v55
    v_mul_f32 v225, v225, v55
    v_mul_f32 v226, v226, v55
    v_mul_f32 v227, v227, v55
    v_accvgpr_write_b32 a92, v224
    v_accvgpr_write_b32 a93, v225
    v_accvgpr_write_b32 a94, v226
    v_accvgpr_write_b32 a95, v227
    v_accvgpr_read_b32 v224, a96
    v_accvgpr_read_b32 v225, a97
    v_accvgpr_read_b32 v226, a98
    v_accvgpr_read_b32 v227, a99
    v_mul_f32 v224, v224, v52
    v_mul_f32 v225, v225, v52
    v_mul_f32 v226, v226, v52
    v_mul_f32 v227, v227, v52
    v_accvgpr_write_b32 a96, v224
    v_accvgpr_write_b32 a97, v225
    v_accvgpr_write_b32 a98, v226
    v_accvgpr_write_b32 a99, v227
    v_accvgpr_read_b32 v224, a100
    v_accvgpr_read_b32 v225, a101
    v_accvgpr_read_b32 v226, a102
    v_accvgpr_read_b32 v227, a103
    v_mul_f32 v224, v224, v53
    v_mul_f32 v225, v225, v53
    v_mul_f32 v226, v226, v53
    v_mul_f32 v227, v227, v53
    v_accvgpr_write_b32 a100, v224
    v_accvgpr_write_b32 a101, v225
    v_accvgpr_write_b32 a102, v226
    v_accvgpr_write_b32 a103, v227
    v_accvgpr_read_b32 v224, a104
    v_accvgpr_read_b32 v225, a105
    v_accvgpr_read_b32 v226, a106
    v_accvgpr_read_b32 v227, a107
    v_mul_f32 v224, v224, v54
    v_mul_f32 v225, v225, v54
    v_mul_f32 v226, v226, v54
    v_mul_f32 v227, v227, v54
    v_accvgpr_write_b32 a104, v224
    v_accvgpr_write_b32 a105, v225
    v_accvgpr_write_b32 a106, v226
    v_accvgpr_write_b32 a107, v227
    v_accvgpr_read_b32 v224, a108
    v_accvgpr_read_b32 v225, a109
    v_accvgpr_read_b32 v226, a110
    v_accvgpr_read_b32 v227, a111
    v_mul_f32 v224, v224, v55
    v_mul_f32 v225, v225, v55
    v_mul_f32 v226, v226, v55
    v_mul_f32 v227, v227, v55
    v_accvgpr_write_b32 a108, v224
    v_accvgpr_write_b32 a109, v225
    v_accvgpr_write_b32 a110, v226
    v_accvgpr_write_b32 a111, v227
    v_accvgpr_read_b32 v224, a112
    v_accvgpr_read_b32 v225, a113
    v_accvgpr_read_b32 v226, a114
    v_accvgpr_read_b32 v227, a115
    v_mul_f32 v224, v224, v52
    v_mul_f32 v225, v225, v52
    v_mul_f32 v226, v226, v52
    v_mul_f32 v227, v227, v52
    v_accvgpr_write_b32 a112, v224
    v_accvgpr_write_b32 a113, v225
    v_accvgpr_write_b32 a114, v226
    v_accvgpr_write_b32 a115, v227
    v_accvgpr_read_b32 v224, a116
    v_accvgpr_read_b32 v225, a117
    v_accvgpr_read_b32 v226, a118
    v_accvgpr_read_b32 v227, a119
    v_mul_f32 v224, v224, v53
    v_mul_f32 v225, v225, v53
    v_mul_f32 v226, v226, v53
    v_mul_f32 v227, v227, v53
    v_accvgpr_write_b32 a116, v224
    v_accvgpr_write_b32 a117, v225
    v_accvgpr_write_b32 a118, v226
    v_accvgpr_write_b32 a119, v227
    v_accvgpr_read_b32 v224, a120
    v_accvgpr_read_b32 v225, a121
    v_accvgpr_read_b32 v226, a122
    v_accvgpr_read_b32 v227, a123
    v_mul_f32 v224, v224, v54
    v_mul_f32 v225, v225, v54
    v_mul_f32 v226, v226, v54
    v_mul_f32 v227, v227, v54
    v_accvgpr_write_b32 a120, v224
    v_accvgpr_write_b32 a121, v225
    v_accvgpr_write_b32 a122, v226
    v_accvgpr_write_b32 a123, v227
    v_accvgpr_read_b32 v224, a124
    v_accvgpr_read_b32 v225, a125
    v_accvgpr_read_b32 v226, a126
    v_accvgpr_read_b32 v227, a127
    v_mul_f32 v224, v224, v55
    v_mul_f32 v225, v225, v55
    v_mul_f32 v226, v226, v55
    v_mul_f32 v227, v227, v55
    v_accvgpr_write_b32 a124, v224
    v_accvgpr_write_b32 a125, v225
    v_accvgpr_write_b32 a126, v226
    v_accvgpr_write_b32 a127, v227
    v_exp_f32 v232, v128
    v_exp_f32 v233, v129
    v_exp_f32 v234, v130
    v_exp_f32 v235, v131
    s_nop 0
    v_cvt_pk_bf16_f32 v192, v232, v233
    v_cvt_pk_bf16_f32 v193, v234, v235
    v_exp_f32 v232, v144
    v_exp_f32 v233, v145
    v_exp_f32 v234, v146
    v_exp_f32 v235, v147
    s_nop 0
    v_cvt_pk_bf16_f32 v194, v232, v233
    v_cvt_pk_bf16_f32 v195, v234, v235
    v_exp_f32 v232, v132
    v_exp_f32 v233, v133
    v_exp_f32 v234, v134
    v_exp_f32 v235, v135
    s_nop 0
    v_cvt_pk_bf16_f32 v196, v232, v233
    v_cvt_pk_bf16_f32 v197, v234, v235
    v_exp_f32 v232, v148
    v_exp_f32 v233, v149
    v_exp_f32 v234, v150
    v_exp_f32 v235, v151
    s_nop 0
    v_cvt_pk_bf16_f32 v198, v232, v233
    v_cvt_pk_bf16_f32 v199, v234, v235
    v_exp_f32 v232, v136
    v_exp_f32 v233, v137
    v_exp_f32 v234, v138
    v_exp_f32 v235, v139
    s_nop 0
    v_cvt_pk_bf16_f32 v200, v232, v233
    v_cvt_pk_bf16_f32 v201, v234, v235
    v_exp_f32 v232, v152
    v_exp_f32 v233, v153
    v_exp_f32 v234, v154
    v_exp_f32 v235, v155
    s_nop 0
    v_cvt_pk_bf16_f32 v202, v232, v233
    v_cvt_pk_bf16_f32 v203, v234, v235
    v_exp_f32 v232, v140
    v_exp_f32 v233, v141
    v_exp_f32 v234, v142
    v_exp_f32 v235, v143
    s_nop 0
    v_cvt_pk_bf16_f32 v204, v232, v233
    v_cvt_pk_bf16_f32 v205, v234, v235
    v_exp_f32 v232, v156
    v_exp_f32 v233, v157
    v_exp_f32 v234, v158
    v_exp_f32 v235, v159
    s_nop 0
    v_cvt_pk_bf16_f32 v206, v232, v233
    v_cvt_pk_bf16_f32 v207, v234, v235
    s_nop 3
    s_setpc_b64 s[40:41]
k2_rare_159:
    s_nop 7
    v_max_f32 v52, v160, v161
    v_max3_f32 v52, v52, v162, v163
    v_max3_f32 v52, v52, v176, v177
    v_max3_f32 v52, v52, v178, v179
    v_max_f32 v53, v164, v165
    v_max3_f32 v53, v53, v166, v167
    v_max3_f32 v53, v53, v180, v181
    v_max3_f32 v53, v53, v182, v183
    v_max_f32 v54, v168, v169
    v_max3_f32 v54, v54, v170, v171
    v_max3_f32 v54, v54, v184, v185
    v_max3_f32 v54, v54, v186, v187
    v_max_f32 v55, v172, v173
    v_max3_f32 v55, v55, v174, v175
    v_max3_f32 v55, v55, v188, v189
    v_max3_f32 v55, v55, v190, v191
    v_mov_b32 v224, v52
    v_mov_b32 v225, v53
    v_mov_b32 v226, v54
    v_mov_b32 v227, v55
    s_nop 1
    v_permlane16_swap_b32 v52, v224
    v_permlane16_swap_b32 v53, v225
    v_permlane16_swap_b32 v54, v226
    v_permlane16_swap_b32 v55, v227
    s_nop 1
    v_max_f32 v52, v52, v224
    v_max_f32 v53, v53, v225
    v_max_f32 v54, v54, v226
    v_max_f32 v55, v55, v227
    v_mov_b32 v224, v52
    v_mov_b32 v225, v53
    v_mov_b32 v226, v54
    v_mov_b32 v227, v55
    s_nop 1
    v_permlane32_swap_b32 v52, v224
    v_permlane32_swap_b32 v53, v225
    v_permlane32_swap_b32 v54, v226
    v_permlane32_swap_b32 v55, v227
    s_nop 1
    v_max_f32 v52, v52, v224
    v_max_f32 v53, v53, v225
    v_max_f32 v54, v54, v226
    v_max_f32 v55, v55, v227
    v_add_f32 v52, 0x41400000, v52
    v_max_f32 v52, 0, v52
    v_add_f32 v53, 0x41400000, v53
    v_max_f32 v53, 0, v53
    v_add_f32 v54, 0x41400000, v54
    v_max_f32 v54, 0, v54
    v_add_f32 v55, 0x41400000, v55
    v_max_f32 v55, 0, v55
    v_sub_f32 v160, v160, v52
    v_sub_f32 v161, v161, v52
    v_sub_f32 v162, v162, v52
    v_sub_f32 v163, v163, v52
    v_sub_f32 v164, v164, v53
    v_sub_f32 v165, v165, v53
    v_sub_f32 v166, v166, v53
    v_sub_f32 v167, v167, v53
    v_sub_f32 v168, v168, v54
    v_sub_f32 v169, v169, v54
    v_sub_f32 v170, v170, v54
    v_sub_f32 v171, v171, v54
    v_sub_f32 v172, v172, v55
    v_sub_f32 v173, v173, v55
    v_sub_f32 v174, v174, v55
    v_sub_f32 v175, v175, v55
    v_sub_f32 v176, v176, v52
    v_sub_f32 v177, v177, v52
    v_sub_f32 v178, v178, v52
    v_sub_f32 v179, v179, v52
    v_sub_f32 v180, v180, v53
    v_sub_f32 v181, v181, v53
    v_sub_f32 v182, v182, v53
    v_sub_f32 v183, v183, v53
    v_sub_f32 v184, v184, v54
    v_sub_f32 v185, v185, v54
    v_sub_f32 v186, v186, v54
    v_sub_f32 v187, v187, v54
    v_sub_f32 v188, v188, v55
    v_sub_f32 v189, v189, v55
    v_sub_f32 v190, v190, v55
    v_sub_f32 v191, v191, v55
    v_sub_f32 v128, v128, v52
    v_sub_f32 v16, v16, v52
    v_sub_f32 v129, v129, v52
    v_sub_f32 v17, v17, v52
    v_sub_f32 v130, v130, v52
    v_sub_f32 v18, v18, v52
    v_sub_f32 v131, v131, v52
    v_sub_f32 v19, v19, v52
    v_sub_f32 v132, v132, v53
    v_sub_f32 v20, v20, v53
    v_sub_f32 v133, v133, v53
    v_sub_f32 v21, v21, v53
    v_sub_f32 v134, v134, v53
    v_sub_f32 v22, v22, v53
    v_sub_f32 v135, v135, v53
    v_sub_f32 v23, v23, v53
    v_sub_f32 v136, v136, v54
    v_sub_f32 v24, v24, v54
    v_sub_f32 v137, v137, v54
    v_sub_f32 v25, v25, v54
    v_sub_f32 v138, v138, v54
    v_sub_f32 v26, v26, v54
    v_sub_f32 v139, v139, v54
    v_sub_f32 v27, v27, v54
    v_sub_f32 v140, v140, v55
    v_sub_f32 v28, v28, v55
    v_sub_f32 v141, v141, v55
    v_sub_f32 v29, v29, v55
    v_sub_f32 v142, v142, v55
    v_sub_f32 v30, v30, v55
    v_sub_f32 v143, v143, v55
    v_sub_f32 v31, v31, v55
    v_sub_f32 v144, v144, v52
    v_sub_f32 v32, v32, v52
    v_sub_f32 v145, v145, v52
    v_sub_f32 v33, v33, v52
    v_sub_f32 v146, v146, v52
    v_sub_f32 v34, v34, v52
    v_sub_f32 v147, v147, v52
    v_sub_f32 v35, v35, v52
    v_sub_f32 v148, v148, v53
    v_sub_f32 v36, v36, v53
    v_sub_f32 v149, v149, v53
    v_sub_f32 v37, v37, v53
    v_sub_f32 v150, v150, v53
    v_sub_f32 v38, v38, v53
    v_sub_f32 v151, v151, v53
    v_sub_f32 v39, v39, v53
    v_sub_f32 v152, v152, v54
    v_sub_f32 v40, v40, v54
    v_sub_f32 v153, v153, v54
    v_sub_f32 v41, v41, v54
    v_sub_f32 v154, v154, v54
    v_sub_f32 v42, v42, v54
    v_sub_f32 v155, v155, v54
    v_sub_f32 v43, v43, v54
    v_sub_f32 v156, v156, v55
    v_sub_f32 v44, v44, v55
    v_sub_f32 v157, v157, v55
    v_sub_f32 v45, v45, v55
    v_sub_f32 v158, v158, v55
    v_sub_f32 v46, v46, v55
    v_sub_f32 v159, v159, v55
    v_sub_f32 v47, v47, v55
    v_sub_f32 v8, v8, v52
    v_exp_f32 v52, -v52
    v_sub_f32 v9, v9, v53
    v_exp_f32 v53, -v53
    v_sub_f32 v10, v10, v54
    v_exp_f32 v54, -v54
    v_sub_f32 v11, v11, v55
    v_exp_f32 v55, -v55
    s_nop 0
    v_mul_f32 v12, v12, v52
    v_mul_f32 v48, v48, v53
    v_mul_f32 v248, v248, v54
    v_mul_f32 v252, v252, v55
    v_accvgpr_read_b32 v224, a0
    v_accvgpr_read_b32 v225, a1
    v_accvgpr_read_b32 v226, a2
    v_accvgpr_read_b32 v227, a3
    v_mul_f32 v224, v224, v52
    v_mul_f32 v225, v225, v52
    v_mul_f32 v226, v226, v52
    v_mul_f32 v227, v227, v52
    v_accvgpr_write_b32 a0, v224
    v_accvgpr_write_b32 a1, v225
    v_accvgpr_write_b32 a2, v226
    v_accvgpr_write_b32 a3, v227
    v_accvgpr_read_b32 v224, a4
    v_accvgpr_read_b32 v225, a5
    v_accvgpr_read_b32 v226, a6
    v_accvgpr_read_b32 v227, a7
    v_mul_f32 v224, v224, v53
    v_mul_f32 v225, v225, v53
    v_mul_f32 v226, v226, v53
    v_mul_f32 v227, v227, v53
    v_accvgpr_write_b32 a4, v224
    v_accvgpr_write_b32 a5, v225
    v_accvgpr_write_b32 a6, v226
    v_accvgpr_write_b32 a7, v227
    v_accvgpr_read_b32 v224, a8
    v_accvgpr_read_b32 v225, a9
    v_accvgpr_read_b32 v226, a10
    v_accvgpr_read_b32 v227, a11
    v_mul_f32 v224, v224, v54
    v_mul_f32 v225, v225, v54
    v_mul_f32 v226, v226, v54
    v_mul_f32 v227, v227, v54
    v_accvgpr_write_b32 a8, v224
    v_accvgpr_write_b32 a9, v225
    v_accvgpr_write_b32 a10, v226
    v_accvgpr_write_b32 a11, v227
    v_accvgpr_read_b32 v224, a12
    v_accvgpr_read_b32 v225, a13
    v_accvgpr_read_b32 v226, a14
    v_accvgpr_read_b32 v227, a15
    v_mul_f32 v224, v224, v55
    v_mul_f32 v225, v225, v55
    v_mul_f32 v226, v226, v55
    v_mul_f32 v227, v227, v55
    v_accvgpr_write_b32 a12, v224
    v_accvgpr_write_b32 a13, v225
    v_accvgpr_write_b32 a14, v226
    v_accvgpr_write_b32 a15, v227
    v_accvgpr_read_b32 v224, a16
    v_accvgpr_read_b32 v225, a17
    v_accvgpr_read_b32 v226, a18
    v_accvgpr_read_b32 v227, a19
    v_mul_f32 v224, v224, v52
    v_mul_f32 v225, v225, v52
    v_mul_f32 v226, v226, v52
    v_mul_f32 v227, v227, v52
    v_accvgpr_write_b32 a16, v224
    v_accvgpr_write_b32 a17, v225
    v_accvgpr_write_b32 a18, v226
    v_accvgpr_write_b32 a19, v227
    v_accvgpr_read_b32 v224, a20
    v_accvgpr_read_b32 v225, a21
    v_accvgpr_read_b32 v226, a22
    v_accvgpr_read_b32 v227, a23
    v_mul_f32 v224, v224, v53
    v_mul_f32 v225, v225, v53
    v_mul_f32 v226, v226, v53
    v_mul_f32 v227, v227, v53
    v_accvgpr_write_b32 a20, v224
    v_accvgpr_write_b32 a21, v225
    v_accvgpr_write_b32 a22, v226
    v_accvgpr_write_b32 a23, v227
    v_accvgpr_read_b32 v224, a24
    v_accvgpr_read_b32 v225, a25
    v_accvgpr_read_b32 v226, a26
    v_accvgpr_read_b32 v227, a27
    v_mul_f32 v224, v224, v54
    v_mul_f32 v225, v225, v54
    v_mul_f32 v226, v226, v54
    v_mul_f32 v227, v227, v54
    v_accvgpr_write_b32 a24, v224
    v_accvgpr_write_b32 a25, v225
    v_accvgpr_write_b32 a26, v226
    v_accvgpr_write_b32 a27, v227
    v_accvgpr_read_b32 v224, a28
    v_accvgpr_read_b32 v225, a29
    v_accvgpr_read_b32 v226, a30
    v_accvgpr_read_b32 v227, a31
    v_mul_f32 v224, v224, v55
    v_mul_f32 v225, v225, v55
    v_mul_f32 v226, v226, v55
    v_mul_f32 v227, v227, v55
    v_accvgpr_write_b32 a28, v224
    v_accvgpr_write_b32 a29, v225
    v_accvgpr_write_b32 a30, v226
    v_accvgpr_write_b32 a31, v227
    v_accvgpr_read_b32 v224, a32
    v_accvgpr_read_b32 v225, a33
    v_accvgpr_read_b32 v226, a34
    v_accvgpr_read_b32 v227, a35
    v_mul_f32 v224, v224, v52
    v_mul_f32 v225, v225, v52
    v_mul_f32 v226, v226, v52
    v_mul_f32 v227, v227, v52
    v_accvgpr_write_b32 a32, v224
    v_accvgpr_write_b32 a33, v225
    v_accvgpr_write_b32 a34, v226
    v_accvgpr_write_b32 a35, v227
    v_accvgpr_read_b32 v224, a36
    v_accvgpr_read_b32 v225, a37
    v_accvgpr_read_b32 v226, a38
    v_accvgpr_read_b32 v227, a39
    v_mul_f32 v224, v224, v53
    v_mul_f32 v225, v225, v53
    v_mul_f32 v226, v226, v53
    v_mul_f32 v227, v227, v53
    v_accvgpr_write_b32 a36, v224
    v_accvgpr_write_b32 a37, v225
    v_accvgpr_write_b32 a38, v226
    v_accvgpr_write_b32 a39, v227
    v_accvgpr_read_b32 v224, a40
    v_accvgpr_read_b32 v225, a41
    v_accvgpr_read_b32 v226, a42
    v_accvgpr_read_b32 v227, a43
    v_mul_f32 v224, v224, v54
    v_mul_f32 v225, v225, v54
    v_mul_f32 v226, v226, v54
    v_mul_f32 v227, v227, v54
    v_accvgpr_write_b32 a40, v224
    v_accvgpr_write_b32 a41, v225
    v_accvgpr_write_b32 a42, v226
    v_accvgpr_write_b32 a43, v227
    v_accvgpr_read_b32 v224, a44
    v_accvgpr_read_b32 v225, a45
    v_accvgpr_read_b32 v226, a46
    v_accvgpr_read_b32 v227, a47
    v_mul_f32 v224, v224, v55
    v_mul_f32 v225, v225, v55
    v_mul_f32 v226, v226, v55
    v_mul_f32 v227, v227, v55
    v_accvgpr_write_b32 a44, v224
    v_accvgpr_write_b32 a45, v225
    v_accvgpr_write_b32 a46, v226
    v_accvgpr_write_b32 a47, v227
    v_accvgpr_read_b32 v224, a48
    v_accvgpr_read_b32 v225, a49
    v_accvgpr_read_b32 v226, a50
    v_accvgpr_read_b32 v227, a51
    v_mul_f32 v224, v224, v52
    v_mul_f32 v225, v225, v52
    v_mul_f32 v226, v226, v52
    v_mul_f32 v227, v227, v52
    v_accvgpr_write_b32 a48, v224
    v_accvgpr_write_b32 a49, v225
    v_accvgpr_write_b32 a50, v226
    v_accvgpr_write_b32 a51, v227
    v_accvgpr_read_b32 v224, a52
    v_accvgpr_read_b32 v225, a53
    v_accvgpr_read_b32 v226, a54
    v_accvgpr_read_b32 v227, a55
    v_mul_f32 v224, v224, v53
    v_mul_f32 v225, v225, v53
    v_mul_f32 v226, v226, v53
    v_mul_f32 v227, v227, v53
    v_accvgpr_write_b32 a52, v224
    v_accvgpr_write_b32 a53, v225
    v_accvgpr_write_b32 a54, v226
    v_accvgpr_write_b32 a55, v227
    v_accvgpr_read_b32 v224, a56
    v_accvgpr_read_b32 v225, a57
    v_accvgpr_read_b32 v226, a58
    v_accvgpr_read_b32 v227, a59
    v_mul_f32 v224, v224, v54
    v_mul_f32 v225, v225, v54
    v_mul_f32 v226, v226, v54
    v_mul_f32 v227, v227, v54
    v_accvgpr_write_b32 a56, v224
    v_accvgpr_write_b32 a57, v225
    v_accvgpr_write_b32 a58, v226
    v_accvgpr_write_b32 a59, v227
    v_accvgpr_read_b32 v224, a60
    v_accvgpr_read_b32 v225, a61
    v_accvgpr_read_b32 v226, a62
    v_accvgpr_read_b32 v227, a63
    v_mul_f32 v224, v224, v55
    v_mul_f32 v225, v225, v55
    v_mul_f32 v226, v226, v55
    v_mul_f32 v227, v227, v55
    v_accvgpr_write_b32 a60, v224
    v_accvgpr_write_b32 a61, v225
    v_accvgpr_write_b32 a62, v226
    v_accvgpr_write_b32 a63, v227
    v_accvgpr_read_b32 v224, a64
    v_accvgpr_read_b32 v225, a65
    v_accvgpr_read_b32 v226, a66
    v_accvgpr_read_b32 v227, a67
    v_mul_f32 v224, v224, v52
    v_mul_f32 v225, v225, v52
    v_mul_f32 v226, v226, v52
    v_mul_f32 v227, v227, v52
    v_accvgpr_write_b32 a64, v224
    v_accvgpr_write_b32 a65, v225
    v_accvgpr_write_b32 a66, v226
    v_accvgpr_write_b32 a67, v227
    v_accvgpr_read_b32 v224, a68
    v_accvgpr_read_b32 v225, a69
    v_accvgpr_read_b32 v226, a70
    v_accvgpr_read_b32 v227, a71
    v_mul_f32 v224, v224, v53
    v_mul_f32 v225, v225, v53
    v_mul_f32 v226, v226, v53
    v_mul_f32 v227, v227, v53
    v_accvgpr_write_b32 a68, v224
    v_accvgpr_write_b32 a69, v225
    v_accvgpr_write_b32 a70, v226
    v_accvgpr_write_b32 a71, v227
    v_accvgpr_read_b32 v224, a72
    v_accvgpr_read_b32 v225, a73
    v_accvgpr_read_b32 v226, a74
    v_accvgpr_read_b32 v227, a75
    v_mul_f32 v224, v224, v54
    v_mul_f32 v225, v225, v54
    v_mul_f32 v226, v226, v54
    v_mul_f32 v227, v227, v54
    v_accvgpr_write_b32 a72, v224
    v_accvgpr_write_b32 a73, v225
    v_accvgpr_write_b32 a74, v226
    v_accvgpr_write_b32 a75, v227
    v_accvgpr_read_b32 v224, a76
    v_accvgpr_read_b32 v225, a77
    v_accvgpr_read_b32 v226, a78
    v_accvgpr_read_b32 v227, a79
    v_mul_f32 v224, v224, v55
    v_mul_f32 v225, v225, v55
    v_mul_f32 v226, v226, v55
    v_mul_f32 v227, v227, v55
    v_accvgpr_write_b32 a76, v224
    v_accvgpr_write_b32 a77, v225
    v_accvgpr_write_b32 a78, v226
    v_accvgpr_write_b32 a79, v227
    v_accvgpr_read_b32 v224, a80
    v_accvgpr_read_b32 v225, a81
    v_accvgpr_read_b32 v226, a82
    v_accvgpr_read_b32 v227, a83
    v_mul_f32 v224, v224, v52
    v_mul_f32 v225, v225, v52
    v_mul_f32 v226, v226, v52
    v_mul_f32 v227, v227, v52
    v_accvgpr_write_b32 a80, v224
    v_accvgpr_write_b32 a81, v225
    v_accvgpr_write_b32 a82, v226
    v_accvgpr_write_b32 a83, v227
    v_accvgpr_read_b32 v224, a84
    v_accvgpr_read_b32 v225, a85
    v_accvgpr_read_b32 v226, a86
    v_accvgpr_read_b32 v227, a87
    v_mul_f32 v224, v224, v53
    v_mul_f32 v225, v225, v53
    v_mul_f32 v226, v226, v53
    v_mul_f32 v227, v227, v53
    v_accvgpr_write_b32 a84, v224
    v_accvgpr_write_b32 a85, v225
    v_accvgpr_write_b32 a86, v226
    v_accvgpr_write_b32 a87, v227
    v_accvgpr_read_b32 v224, a88
    v_accvgpr_read_b32 v225, a89
    v_accvgpr_read_b32 v226, a90
    v_accvgpr_read_b32 v227, a91
    v_mul_f32 v224, v224, v54
    v_mul_f32 v225, v225, v54
    v_mul_f32 v226, v226, v54
    v_mul_f32 v227, v227, v54
    v_accvgpr_write_b32 a88, v224
    v_accvgpr_write_b32 a89, v225
    v_accvgpr_write_b32 a90, v226
    v_accvgpr_write_b32 a91, v227
    v_accvgpr_read_b32 v224, a92
    v_accvgpr_read_b32 v225, a93
    v_accvgpr_read_b32 v226, a94
    v_accvgpr_read_b32 v227, a95
    v_mul_f32 v224, v224, v55
    v_mul_f32 v225, v225, v55
    v_mul_f32 v226, v226, v55
    v_mul_f32 v227, v227, v55
    v_accvgpr_write_b32 a92, v224
    v_accvgpr_write_b32 a93, v225
    v_accvgpr_write_b32 a94, v226
    v_accvgpr_write_b32 a95, v227
    v_accvgpr_read_b32 v224, a96
    v_accvgpr_read_b32 v225, a97
    v_accvgpr_read_b32 v226, a98
    v_accvgpr_read_b32 v227, a99
    v_mul_f32 v224, v224, v52
    v_mul_f32 v225, v225, v52
    v_mul_f32 v226, v226, v52
    v_mul_f32 v227, v227, v52
    v_accvgpr_write_b32 a96, v224
    v_accvgpr_write_b32 a97, v225
    v_accvgpr_write_b32 a98, v226
    v_accvgpr_write_b32 a99, v227
    v_accvgpr_read_b32 v224, a100
    v_accvgpr_read_b32 v225, a101
    v_accvgpr_read_b32 v226, a102
    v_accvgpr_read_b32 v227, a103
    v_mul_f32 v224, v224, v53
    v_mul_f32 v225, v225, v53
    v_mul_f32 v226, v226, v53
    v_mul_f32 v227, v227, v53
    v_accvgpr_write_b32 a100, v224
    v_accvgpr_write_b32 a101, v225
    v_accvgpr_write_b32 a102, v226
    v_accvgpr_write_b32 a103, v227
    v_accvgpr_read_b32 v224, a104
    v_accvgpr_read_b32 v225, a105
    v_accvgpr_read_b32 v226, a106
    v_accvgpr_read_b32 v227, a107
    v_mul_f32 v224, v224, v54
    v_mul_f32 v225, v225, v54
    v_mul_f32 v226, v226, v54
    v_mul_f32 v227, v227, v54
    v_accvgpr_write_b32 a104, v224
    v_accvgpr_write_b32 a105, v225
    v_accvgpr_write_b32 a106, v226
    v_accvgpr_write_b32 a107, v227
    v_accvgpr_read_b32 v224, a108
    v_accvgpr_read_b32 v225, a109
    v_accvgpr_read_b32 v226, a110
    v_accvgpr_read_b32 v227, a111
    v_mul_f32 v224, v224, v55
    v_mul_f32 v225, v225, v55
    v_mul_f32 v226, v226, v55
    v_mul_f32 v227, v227, v55
    v_accvgpr_write_b32 a108, v224
    v_accvgpr_write_b32 a109, v225
    v_accvgpr_write_b32 a110, v226
    v_accvgpr_write_b32 a111, v227
    v_accvgpr_read_b32 v224, a112
    v_accvgpr_read_b32 v225, a113
    v_accvgpr_read_b32 v226, a114
    v_accvgpr_read_b32 v227, a115
    v_mul_f32 v224, v224, v52
    v_mul_f32 v225, v225, v52
    v_mul_f32 v226, v226, v52
    v_mul_f32 v227, v227, v52
    v_accvgpr_write_b32 a112, v224
    v_accvgpr_write_b32 a113, v225
    v_accvgpr_write_b32 a114, v226
    v_accvgpr_write_b32 a115, v227
    v_accvgpr_read_b32 v224, a116
    v_accvgpr_read_b32 v225, a117
    v_accvgpr_read_b32 v226, a118
    v_accvgpr_read_b32 v227, a119
    v_mul_f32 v224, v224, v53
    v_mul_f32 v225, v225, v53
    v_mul_f32 v226, v226, v53
    v_mul_f32 v227, v227, v53
    v_accvgpr_write_b32 a116, v224
    v_accvgpr_write_b32 a117, v225
    v_accvgpr_write_b32 a118, v226
    v_accvgpr_write_b32 a119, v227
    v_accvgpr_read_b32 v224, a120
    v_accvgpr_read_b32 v225, a121
    v_accvgpr_read_b32 v226, a122
    v_accvgpr_read_b32 v227, a123
    v_mul_f32 v224, v224, v54
    v_mul_f32 v225, v225, v54
    v_mul_f32 v226, v226, v54
    v_mul_f32 v227, v227, v54
    v_accvgpr_write_b32 a120, v224
    v_accvgpr_write_b32 a121, v225
    v_accvgpr_write_b32 a122, v226
    v_accvgpr_write_b32 a123, v227
    v_accvgpr_read_b32 v224, a124
    v_accvgpr_read_b32 v225, a125
    v_accvgpr_read_b32 v226, a126
    v_accvgpr_read_b32 v227, a127
    v_mul_f32 v224, v224, v55
    v_mul_f32 v225, v225, v55
    v_mul_f32 v226, v226, v55
    v_mul_f32 v227, v227, v55
    v_accvgpr_write_b32 a124, v224
    v_accvgpr_write_b32 a125, v225
    v_accvgpr_write_b32 a126, v226
    v_accvgpr_write_b32 a127, v227
    v_exp_f32 v232, v160
    v_exp_f32 v233, v161
    v_exp_f32 v234, v162
    v_exp_f32 v235, v163
    s_nop 0
    v_cvt_pk_bf16_f32 v208, v232, v233
    v_cvt_pk_bf16_f32 v209, v234, v235
    v_exp_f32 v232, v176
    v_exp_f32 v233, v177
    v_exp_f32 v234, v178
    v_exp_f32 v235, v179
    s_nop 0
    v_cvt_pk_bf16_f32 v210, v232, v233
    v_cvt_pk_bf16_f32 v211, v234, v235
    v_exp_f32 v232, v164
    v_exp_f32 v233, v165
    v_exp_f32 v234, v166
    v_exp_f32 v235, v167
    s_nop 0
    v_cvt_pk_bf16_f32 v212, v232, v233
    v_cvt_pk_bf16_f32 v213, v234, v235
    v_exp_f32 v232, v180
    v_exp_f32 v233, v181
    v_exp_f32 v234, v182
    v_exp_f32 v235, v183
    s_nop 0
    v_cvt_pk_bf16_f32 v214, v232, v233
    v_cvt_pk_bf16_f32 v215, v234, v235
    v_exp_f32 v232, v168
    v_exp_f32 v233, v169
    v_exp_f32 v234, v170
    v_exp_f32 v235, v171
    s_nop 0
    v_cvt_pk_bf16_f32 v216, v232, v233
    v_cvt_pk_bf16_f32 v217, v234, v235
    v_exp_f32 v232, v184
    v_exp_f32 v233, v185
    v_exp_f32 v234, v186
    v_exp_f32 v235, v187
    s_nop 0
    v_cvt_pk_bf16_f32 v218, v232, v233
    v_cvt_pk_bf16_f32 v219, v234, v235
    v_exp_f32 v232, v172
    v_exp_f32 v233, v173
    v_exp_f32 v234, v174
    v_exp_f32 v235, v175
    s_nop 0
    v_cvt_pk_bf16_f32 v220, v232, v233
    v_cvt_pk_bf16_f32 v221, v234, v235
    v_exp_f32 v232, v188
    v_exp_f32 v233, v189
    v_exp_f32 v234, v190
    v_exp_f32 v235, v191
    s_nop 0
    v_cvt_pk_bf16_f32 v222, v232, v233
    v_cvt_pk_bf16_f32 v223, v234, v235
    s_nop 3
    s_setpc_b64 s[40:41]
k2_rare_164:
    s_nop 7
    v_max_f32 v53, v132, v133
    v_max3_f32 v53, v53, v134, v135
    v_max3_f32 v53, v53, v148, v149
    v_max3_f32 v53, v53, v150, v151
    v_max_f32 v54, v136, v137
    v_max3_f32 v54, v54, v138, v139
    v_max3_f32 v54, v54, v152, v153
    v_max3_f32 v54, v54, v154, v155
    v_max_f32 v55, v140, v141
    v_max3_f32 v55, v55, v142, v143
    v_max3_f32 v55, v55, v156, v157
    v_max3_f32 v55, v55, v158, v159
    v_mov_b32 v225, v53
    v_mov_b32 v226, v54
    v_mov_b32 v227, v55
    s_nop 1
    v_permlane16_swap_b32 v53, v225
    v_permlane16_swap_b32 v54, v226
    v_permlane16_swap_b32 v55, v227
    s_nop 1
    v_max_f32 v53, v53, v225
    v_max_f32 v54, v54, v226
    v_max_f32 v55, v55, v227
    v_mov_b32 v225, v53
    v_mov_b32 v226, v54
    v_mov_b32 v227, v55
    s_nop 1
    v_permlane32_swap_b32 v53, v225
    v_permlane32_swap_b32 v54, v226
    v_permlane32_swap_b32 v55, v227
    s_nop 1
    v_max_f32 v53, v53, v225
    v_max_f32 v54, v54, v226
    v_max_f32 v55, v55, v227
    v_add_f32 v53, 0x41400000, v53
    v_max_f32 v53, 0, v53
    v_add_f32 v54, 0x41400000, v54
    v_max_f32 v54, 0, v54
    v_add_f32 v55, 0x41400000, v55
    v_max_f32 v55, 0, v55
    v_sub_f32 v132, v132, v53
    v_sub_f32 v133, v133, v53
    v_sub_f32 v134, v134, v53
    v_sub_f32 v135, v135, v53
    v_sub_f32 v136, v136, v54
    v_sub_f32 v137, v137, v54
    v_sub_f32 v138, v138, v54
    v_sub_f32 v139, v139, v54
    v_sub_f32 v140, v140, v55
    v_sub_f32 v141, v141, v55
    v_sub_f32 v142, v142, v55
    v_sub_f32 v143, v143, v55
    v_sub_f32 v148, v148, v53
    v_sub_f32 v149, v149, v53
    v_sub_f32 v150, v150, v53
    v_sub_f32 v151, v151, v53
    v_sub_f32 v152, v152, v54
    v_sub_f32 v153, v153, v54
    v_sub_f32 v154, v154, v54
    v_sub_f32 v155, v155, v54
    v_sub_f32 v156, v156, v55
    v_sub_f32 v157, v157, v55
    v_sub_f32 v158, v158, v55
    v_sub_f32 v159, v159, v55
    v_sub_f32 v164, v164, v53
    v_sub_f32 v20, v20, v53
    v_sub_f32 v165, v165, v53
    v_sub_f32 v21, v21, v53
    v_sub_f32 v166, v166, v53
    v_sub_f32 v22, v22, v53
    v_sub_f32 v167, v167, v53
    v_sub_f32 v23, v23, v53
    v_sub_f32 v168, v168, v54
    v_sub_f32 v24, v24, v54
    v_sub_f32 v169, v169, v54
    v_sub_f32 v25, v25, v54
    v_sub_f32 v170, v170, v54
    v_sub_f32 v26, v26, v54
    v_sub_f32 v171, v171, v54
    v_sub_f32 v27, v27, v54
    v_sub_f32 v172, v172, v55
    v_sub_f32 v28, v28, v55
    v_sub_f32 v173, v173, v55
    v_sub_f32 v29, v29, v55
    v_sub_f32 v174, v174, v55
    v_sub_f32 v30, v30, v55
    v_sub_f32 v175, v175, v55
    v_sub_f32 v31, v31, v55
    v_sub_f32 v180, v180, v53
    v_sub_f32 v36, v36, v53
    v_sub_f32 v181, v181, v53
    v_sub_f32 v37, v37, v53
    v_sub_f32 v182, v182, v53
    v_sub_f32 v38, v38, v53
    v_sub_f32 v183, v183, v53
    v_sub_f32 v39, v39, v53
    v_sub_f32 v184, v184, v54
    v_sub_f32 v40, v40, v54
    v_sub_f32 v185, v185, v54
    v_sub_f32 v41, v41, v54
    v_sub_f32 v186, v186, v54
    v_sub_f32 v42, v42, v54
    v_sub_f32 v187, v187, v54
    v_sub_f32 v43, v43, v54
    v_sub_f32 v188, v188, v55
    v_sub_f32 v44, v44, v55
    v_sub_f32 v189, v189, v55
    v_sub_f32 v45, v45, v55
    v_sub_f32 v190, v190, v55
    v_sub_f32 v46, v46, v55
    v_sub_f32 v191, v191, v55
    v_sub_f32 v47, v47, v55
    v_sub_f32 v9, v9, v53
    v_exp_f32 v53, -v53
    v_sub_f32 v10, v10, v54
    v_exp_f32 v54, -v54
    v_sub_f32 v11, v11, v55
    v_exp_f32 v55, -v55
    s_nop 0
    v_mul_f32 v48, v48, v53
    v_mul_f32 v248, v248, v54
    v_mul_f32 v252, v252, v55
    v_accvgpr_read_b32 v224, a4
    v_accvgpr_read_b32 v225, a5
    v_accvgpr_read_b32 v226, a6
    v_accvgpr_read_b32 v227, a7
    v_mul_f32 v224, v224, v53
    v_mul_f32 v225, v225, v53
    v_mul_f32 v226, v226, v53
    v_mul_f32 v227, v227, v53
    v_accvgpr_write_b32 a4, v224
    v_accvgpr_write_b32 a5, v225
    v_accvgpr_write_b32 a6, v226
    v_accvgpr_write_b32 a7, v227
    v_accvgpr_read_b32 v224, a8
    v_accvgpr_read_b32 v225, a9
    v_accvgpr_read_b32 v226, a10
    v_accvgpr_read_b32 v227, a11
    v_mul_f32 v224, v224, v54
    v_mul_f32 v225, v225, v54
    v_mul_f32 v226, v226, v54
    v_mul_f32 v227, v227, v54
    v_accvgpr_write_b32 a8, v224
    v_accvgpr_write_b32 a9, v225
    v_accvgpr_write_b32 a10, v226
    v_accvgpr_write_b32 a11, v227
    v_accvgpr_read_b32 v224, a12
    v_accvgpr_read_b32 v225, a13
    v_accvgpr_read_b32 v226, a14
    v_accvgpr_read_b32 v227, a15
    v_mul_f32 v224, v224, v55
    v_mul_f32 v225, v225, v55
    v_mul_f32 v226, v226, v55
    v_mul_f32 v227, v227, v55
    v_accvgpr_write_b32 a12, v224
    v_accvgpr_write_b32 a13, v225
    v_accvgpr_write_b32 a14, v226
    v_accvgpr_write_b32 a15, v227
    v_accvgpr_read_b32 v224, a20
    v_accvgpr_read_b32 v225, a21
    v_accvgpr_read_b32 v226, a22
    v_accvgpr_read_b32 v227, a23
    v_mul_f32 v224, v224, v53
    v_mul_f32 v225, v225, v53
    v_mul_f32 v226, v226, v53
    v_mul_f32 v227, v227, v53
    v_accvgpr_write_b32 a20, v224
    v_accvgpr_write_b32 a21, v225
    v_accvgpr_write_b32 a22, v226
    v_accvgpr_write_b32 a23, v227
    v_accvgpr_read_b32 v224, a24
    v_accvgpr_read_b32 v225, a25
    v_accvgpr_read_b32 v226, a26
    v_accvgpr_read_b32 v227, a27
    v_mul_f32 v224, v224, v54
    v_mul_f32 v225, v225, v54
    v_mul_f32 v226, v226, v54
    v_mul_f32 v227, v227, v54
    v_accvgpr_write_b32 a24, v224
    v_accvgpr_write_b32 a25, v225
    v_accvgpr_write_b32 a26, v226
    v_accvgpr_write_b32 a27, v227
    v_accvgpr_read_b32 v224, a28
    v_accvgpr_read_b32 v225, a29
    v_accvgpr_read_b32 v226, a30
    v_accvgpr_read_b32 v227, a31
    v_mul_f32 v224, v224, v55
    v_mul_f32 v225, v225, v55
    v_mul_f32 v226, v226, v55
    v_mul_f32 v227, v227, v55
    v_accvgpr_write_b32 a28, v224
    v_accvgpr_write_b32 a29, v225
    v_accvgpr_write_b32 a30, v226
    v_accvgpr_write_b32 a31, v227
    v_accvgpr_read_b32 v224, a36
    v_accvgpr_read_b32 v225, a37
    v_accvgpr_read_b32 v226, a38
    v_accvgpr_read_b32 v227, a39
    v_mul_f32 v224, v224, v53
    v_mul_f32 v225, v225, v53
    v_mul_f32 v226, v226, v53
    v_mul_f32 v227, v227, v53
    v_accvgpr_write_b32 a36, v224
    v_accvgpr_write_b32 a37, v225
    v_accvgpr_write_b32 a38, v226
    v_accvgpr_write_b32 a39, v227
    v_accvgpr_read_b32 v224, a40
    v_accvgpr_read_b32 v225, a41
    v_accvgpr_read_b32 v226, a42
    v_accvgpr_read_b32 v227, a43
    v_mul_f32 v224, v224, v54
    v_mul_f32 v225, v225, v54
    v_mul_f32 v226, v226, v54
    v_mul_f32 v227, v227, v54
    v_accvgpr_write_b32 a40, v224
    v_accvgpr_write_b32 a41, v225
    v_accvgpr_write_b32 a42, v226
    v_accvgpr_write_b32 a43, v227
    v_accvgpr_read_b32 v224, a44
    v_accvgpr_read_b32 v225, a45
    v_accvgpr_read_b32 v226, a46
    v_accvgpr_read_b32 v227, a47
    v_mul_f32 v224, v224, v55
    v_mul_f32 v225, v225, v55
    v_mul_f32 v226, v226, v55
    v_mul_f32 v227, v227, v55
    v_accvgpr_write_b32 a44, v224
    v_accvgpr_write_b32 a45, v225
    v_accvgpr_write_b32 a46, v226
    v_accvgpr_write_b32 a47, v227
    v_accvgpr_read_b32 v224, a52
    v_accvgpr_read_b32 v225, a53
    v_accvgpr_read_b32 v226, a54
    v_accvgpr_read_b32 v227, a55
    v_mul_f32 v224, v224, v53
    v_mul_f32 v225, v225, v53
    v_mul_f32 v226, v226, v53
    v_mul_f32 v227, v227, v53
    v_accvgpr_write_b32 a52, v224
    v_accvgpr_write_b32 a53, v225
    v_accvgpr_write_b32 a54, v226
    v_accvgpr_write_b32 a55, v227
    v_accvgpr_read_b32 v224, a56
    v_accvgpr_read_b32 v225, a57
    v_accvgpr_read_b32 v226, a58
    v_accvgpr_read_b32 v227, a59
    v_mul_f32 v224, v224, v54
    v_mul_f32 v225, v225, v54
    v_mul_f32 v226, v226, v54
    v_mul_f32 v227, v227, v54
    v_accvgpr_write_b32 a56, v224
    v_accvgpr_write_b32 a57, v225
    v_accvgpr_write_b32 a58, v226
    v_accvgpr_write_b32 a59, v227
    v_accvgpr_read_b32 v224, a60
    v_accvgpr_read_b32 v225, a61
    v_accvgpr_read_b32 v226, a62
    v_accvgpr_read_b32 v227, a63
    v_mul_f32 v224, v224, v55
    v_mul_f32 v225, v225, v55
    v_mul_f32 v226, v226, v55
    v_mul_f32 v227, v227, v55
    v_accvgpr_write_b32 a60, v224
    v_accvgpr_write_b32 a61, v225
    v_accvgpr_write_b32 a62, v226
    v_accvgpr_write_b32 a63, v227
    v_accvgpr_read_b32 v224, a68
    v_accvgpr_read_b32 v225, a69
    v_accvgpr_read_b32 v226, a70
    v_accvgpr_read_b32 v227, a71
    v_mul_f32 v224, v224, v53
    v_mul_f32 v225, v225, v53
    v_mul_f32 v226, v226, v53
    v_mul_f32 v227, v227, v53
    v_accvgpr_write_b32 a68, v224
    v_accvgpr_write_b32 a69, v225
    v_accvgpr_write_b32 a70, v226
    v_accvgpr_write_b32 a71, v227
    v_accvgpr_read_b32 v224, a72
    v_accvgpr_read_b32 v225, a73
    v_accvgpr_read_b32 v226, a74
    v_accvgpr_read_b32 v227, a75
    v_mul_f32 v224, v224, v54
    v_mul_f32 v225, v225, v54
    v_mul_f32 v226, v226, v54
    v_mul_f32 v227, v227, v54
    v_accvgpr_write_b32 a72, v224
    v_accvgpr_write_b32 a73, v225
    v_accvgpr_write_b32 a74, v226
    v_accvgpr_write_b32 a75, v227
    v_accvgpr_read_b32 v224, a76
    v_accvgpr_read_b32 v225, a77
    v_accvgpr_read_b32 v226, a78
    v_accvgpr_read_b32 v227, a79
    v_mul_f32 v224, v224, v55
    v_mul_f32 v225, v225, v55
    v_mul_f32 v226, v226, v55
    v_mul_f32 v227, v227, v55
    v_accvgpr_write_b32 a76, v224
    v_accvgpr_write_b32 a77, v225
    v_accvgpr_write_b32 a78, v226
    v_accvgpr_write_b32 a79, v227
    v_accvgpr_read_b32 v224, a84
    v_accvgpr_read_b32 v225, a85
    v_accvgpr_read_b32 v226, a86
    v_accvgpr_read_b32 v227, a87
    v_mul_f32 v224, v224, v53
    v_mul_f32 v225, v225, v53
    v_mul_f32 v226, v226, v53
    v_mul_f32 v227, v227, v53
    v_accvgpr_write_b32 a84, v224
    v_accvgpr_write_b32 a85, v225
    v_accvgpr_write_b32 a86, v226
    v_accvgpr_write_b32 a87, v227
    v_accvgpr_read_b32 v224, a88
    v_accvgpr_read_b32 v225, a89
    v_accvgpr_read_b32 v226, a90
    v_accvgpr_read_b32 v227, a91
    v_mul_f32 v224, v224, v54
    v_mul_f32 v225, v225, v54
    v_mul_f32 v226, v226, v54
    v_mul_f32 v227, v227, v54
    v_accvgpr_write_b32 a88, v224
    v_accvgpr_write_b32 a89, v225
    v_accvgpr_write_b32 a90, v226
    v_accvgpr_write_b32 a91, v227
    v_accvgpr_read_b32 v224, a92
    v_accvgpr_read_b32 v225, a93
    v_accvgpr_read_b32 v226, a94
    v_accvgpr_read_b32 v227, a95
    v_mul_f32 v224, v224, v55
    v_mul_f32 v225, v225, v55
    v_mul_f32 v226, v226, v55
    v_mul_f32 v227, v227, v55
    v_accvgpr_write_b32 a92, v224
    v_accvgpr_write_b32 a93, v225
    v_accvgpr_write_b32 a94, v226
    v_accvgpr_write_b32 a95, v227
    v_accvgpr_read_b32 v224, a100
    v_accvgpr_read_b32 v225, a101
    v_accvgpr_read_b32 v226, a102
    v_accvgpr_read_b32 v227, a103
    v_mul_f32 v224, v224, v53
    v_mul_f32 v225, v225, v53
    v_mul_f32 v226, v226, v53
    v_mul_f32 v227, v227, v53
    v_accvgpr_write_b32 a100, v224
    v_accvgpr_write_b32 a101, v225
    v_accvgpr_write_b32 a102, v226
    v_accvgpr_write_b32 a103, v227
    v_accvgpr_read_b32 v224, a104
    v_accvgpr_read_b32 v225, a105
    v_accvgpr_read_b32 v226, a106
    v_accvgpr_read_b32 v227, a107
    v_mul_f32 v224, v224, v54
    v_mul_f32 v225, v225, v54
    v_mul_f32 v226, v226, v54
    v_mul_f32 v227, v227, v54
    v_accvgpr_write_b32 a104, v224
    v_accvgpr_write_b32 a105, v225
    v_accvgpr_write_b32 a106, v226
    v_accvgpr_write_b32 a107, v227
    v_accvgpr_read_b32 v224, a108
    v_accvgpr_read_b32 v225, a109
    v_accvgpr_read_b32 v226, a110
    v_accvgpr_read_b32 v227, a111
    v_mul_f32 v224, v224, v55
    v_mul_f32 v225, v225, v55
    v_mul_f32 v226, v226, v55
    v_mul_f32 v227, v227, v55
    v_accvgpr_write_b32 a108, v224
    v_accvgpr_write_b32 a109, v225
    v_accvgpr_write_b32 a110, v226
    v_accvgpr_write_b32 a111, v227
    v_accvgpr_read_b32 v224, a116
    v_accvgpr_read_b32 v225, a117
    v_accvgpr_read_b32 v226, a118
    v_accvgpr_read_b32 v227, a119
    v_mul_f32 v224, v224, v53
    v_mul_f32 v225, v225, v53
    v_mul_f32 v226, v226, v53
    v_mul_f32 v227, v227, v53
    v_accvgpr_write_b32 a116, v224
    v_accvgpr_write_b32 a117, v225
    v_accvgpr_write_b32 a118, v226
    v_accvgpr_write_b32 a119, v227
    v_accvgpr_read_b32 v224, a120
    v_accvgpr_read_b32 v225, a121
    v_accvgpr_read_b32 v226, a122
    v_accvgpr_read_b32 v227, a123
    v_mul_f32 v224, v224, v54
    v_mul_f32 v225, v225, v54
    v_mul_f32 v226, v226, v54
    v_mul_f32 v227, v227, v54
    v_accvgpr_write_b32 a120, v224
    v_accvgpr_write_b32 a121, v225
    v_accvgpr_write_b32 a122, v226
    v_accvgpr_write_b32 a123, v227
    v_accvgpr_read_b32 v224, a124
    v_accvgpr_read_b32 v225, a125
    v_accvgpr_read_b32 v226, a126
    v_accvgpr_read_b32 v227, a127
    v_mul_f32 v224, v224, v55
    v_mul_f32 v225, v225, v55
    v_mul_f32 v226, v226, v55
    v_mul_f32 v227, v227, v55
    v_accvgpr_write_b32 a124, v224
    v_accvgpr_write_b32 a125, v225
    v_accvgpr_write_b32 a126, v226
    v_accvgpr_write_b32 a127, v227
    v_exp_f32 v232, v132
    v_exp_f32 v233, v133
    v_exp_f32 v234, v134
    v_exp_f32 v235, v135
    s_nop 0
    v_cvt_pk_bf16_f32 v196, v232, v233
    v_cvt_pk_bf16_f32 v197, v234, v235
    v_exp_f32 v232, v148
    v_exp_f32 v233, v149
    v_exp_f32 v234, v150
    v_exp_f32 v235, v151
    s_nop 0
    v_cvt_pk_bf16_f32 v198, v232, v233
    v_cvt_pk_bf16_f32 v199, v234, v235
    v_exp_f32 v232, v136
    v_exp_f32 v233, v137
    v_exp_f32 v234, v138
    v_exp_f32 v235, v139
    s_nop 0
    v_cvt_pk_bf16_f32 v200, v232, v233
    v_cvt_pk_bf16_f32 v201, v234, v235
    v_exp_f32 v232, v152
    v_exp_f32 v233, v153
    v_exp_f32 v234, v154
    v_exp_f32 v235, v155
    s_nop 0
    v_cvt_pk_bf16_f32 v202, v232, v233
    v_cvt_pk_bf16_f32 v203, v234, v235
    v_exp_f32 v232, v140
    v_exp_f32 v233, v141
    v_exp_f32 v234, v142
    v_exp_f32 v235, v143
    s_nop 0
    v_cvt_pk_bf16_f32 v204, v232, v233
    v_cvt_pk_bf16_f32 v205, v234, v235
    v_exp_f32 v232, v156
    v_exp_f32 v233, v157
    v_exp_f32 v234, v158
    v_exp_f32 v235, v159
    s_nop 0
    v_cvt_pk_bf16_f32 v206, v232, v233
    v_cvt_pk_bf16_f32 v207, v234, v235
    s_nop 3
    s_setpc_b64 s[40:41]
k2_rare_165:
    s_nop 7
    v_max_f32 v53, v164, v165
    v_max3_f32 v53, v53, v166, v167
    v_max3_f32 v53, v53, v180, v181
    v_max3_f32 v53, v53, v182, v183
    v_max_f32 v54, v168, v169
    v_max3_f32 v54, v54, v170, v171
    v_max3_f32 v54, v54, v184, v185
    v_max3_f32 v54, v54, v186, v187
    v_max_f32 v55, v172, v173
    v_max3_f32 v55, v55, v174, v175
    v_max3_f32 v55, v55, v188, v189
    v_max3_f32 v55, v55, v190, v191
    v_mov_b32 v225, v53
    v_mov_b32 v226, v54
    v_mov_b32 v227, v55
    s_nop 1
    v_permlane16_swap_b32 v53, v225
    v_permlane16_swap_b32 v54, v226
    v_permlane16_swap_b32 v55, v227
    s_nop 1
    v_max_f32 v53, v53, v225
    v_max_f32 v54, v54, v226
    v_max_f32 v55, v55, v227
    v_mov_b32 v225, v53
    v_mov_b32 v226, v54
    v_mov_b32 v227, v55
    s_nop 1
    v_permlane32_swap_b32 v53, v225
    v_permlane32_swap_b32 v54, v226
    v_permlane32_swap_b32 v55, v227
    s_nop 1
    v_max_f32 v53, v53, v225
    v_max_f32 v54, v54, v226
    v_max_f32 v55, v55, v227
    v_add_f32 v53, 0x41400000, v53
    v_max_f32 v53, 0, v53
    v_add_f32 v54, 0x41400000, v54
    v_max_f32 v54, 0, v54
    v_add_f32 v55, 0x41400000, v55
    v_max_f32 v55, 0, v55
    v_sub_f32 v164, v164, v53
    v_sub_f32 v165, v165, v53
    v_sub_f32 v166, v166, v53
    v_sub_f32 v167, v167, v53
    v_sub_f32 v168, v168, v54
    v_sub_f32 v169, v169, v54
    v_sub_f32 v170, v170, v54
    v_sub_f32 v171, v171, v54
    v_sub_f32 v172, v172, v55
    v_sub_f32 v173, v173, v55
    v_sub_f32 v174, v174, v55
    v_sub_f32 v175, v175, v55
    v_sub_f32 v180, v180, v53
    v_sub_f32 v181, v181, v53
    v_sub_f32 v182, v182, v53
    v_sub_f32 v183, v183, v53
    v_sub_f32 v184, v184, v54
    v_sub_f32 v185, v185, v54
    v_sub_f32 v186, v186, v54
    v_sub_f32 v187, v187, v54
    v_sub_f32 v188, v188, v55
    v_sub_f32 v189, v189, v55
    v_sub_f32 v190, v190, v55
    v_sub_f32 v191, v191, v55
    v_sub_f32 v128, v128, v54
    v_sub_f32 v16, v16, v54
    v_sub_f32 v129, v129, v54
    v_sub_f32 v17, v17, v54
    v_sub_f32 v130, v130, v54
    v_sub_f32 v18, v18, v54
    v_sub_f32 v131, v131, v54
    v_sub_f32 v19, v19, v54
    v_sub_f32 v132, v132, v55
    v_sub_f32 v20, v20, v55
    v_sub_f32 v133, v133, v55
    v_sub_f32 v21, v21, v55
    v_sub_f32 v134, v134, v55
    v_sub_f32 v22, v22, v55
    v_sub_f32 v135, v135, v55
    v_sub_f32 v23, v23, v55
    v_sub_f32 v136, v136, v54
    v_sub_f32 v24, v24, v54
    v_sub_f32 v137, v137, v54
    v_sub_f32 v25, v25, v54
    v_sub_f32 v138, v138, v54
    v_sub_f32 v26, v26, v54
    v_sub_f32 v139, v139, v54
    v_sub_f32 v27, v27, v54
    v_sub_f32 v140, v140, v55
    v_sub_f32 v28, v28, v55
    v_sub_f32 v141, v141, v55
    v_sub_f32 v29, v29, v55
    v_sub_f32 v142, v142, v55
    v_sub_f32 v30, v30, v55
    v_sub_f32 v143, v143, v55
    v_sub_f32 v31, v31, v55
    v_sub_f32 v144, v144, v54
    v_sub_f32 v32, v32, v54
    v_sub_f32 v145, v145, v54
    v_sub_f32 v33, v33, v54
    v_sub_f32 v146, v146, v54
    v_sub_f32 v34, v34, v54
    v_sub_f32 v147, v147, v54
    v_sub_f32 v35, v35, v54
    v_sub_f32 v148, v148, v55
    v_sub_f32 v36, v36, v55
    v_sub_f32 v149, v149, v55
    v_sub_f32 v37, v37, v55
    v_sub_f32 v150, v150, v55
    v_sub_f32 v38, v38, v55
    v_sub_f32 v151, v151, v55
    v_sub_f32 v39, v39, v55
    v_sub_f32 v152, v152, v54
    v_sub_f32 v40, v40, v54
    v_sub_f32 v153, v153, v54
    v_sub_f32 v41, v41, v54
    v_sub_f32 v154, v154, v54
    v_sub_f32 v42, v42, v54
    v_sub_f32 v155, v155, v54
    v_sub_f32 v43, v43, v54
    v_sub_f32 v156, v156, v55
    v_sub_f32 v44, v44, v55
    v_sub_f32 v157, v157, v55
    v_sub_f32 v45, v45, v55
    v_sub_f32 v158, v158, v55
    v_sub_f32 v46, v46, v55
    v_sub_f32 v159, v159, v55
    v_sub_f32 v47, v47, v55
    v_sub_f32 v9, v9, v53
    v_exp_f32 v53, -v53
    v_sub_f32 v10, v10, v54
    v_exp_f32 v54, -v54
    v_sub_f32 v11, v11, v55
    v_exp_f32 v55, -v55
    s_nop 0
    v_mul_f32 v48, v48, v53
    v_mul_f32 v248, v248, v54
    v_mul_f32 v252, v252, v55
    v_accvgpr_read_b32 v224, a4
    v_accvgpr_read_b32 v225, a5
    v_accvgpr_read_b32 v226, a6
    v_accvgpr_read_b32 v227, a7
    v_mul_f32 v224, v224, v53
    v_mul_f32 v225, v225, v53
    v_mul_f32 v226, v226, v53
    v_mul_f32 v227, v227, v53
    v_accvgpr_write_b32 a4, v224
    v_accvgpr_write_b32 a5, v225
    v_accvgpr_write_b32 a6, v226
    v_accvgpr_write_b32 a7, v227
    v_accvgpr_read_b32 v224, a8
    v_accvgpr_read_b32 v225, a9
    v_accvgpr_read_b32 v226, a10
    v_accvgpr_read_b32 v227, a11
    v_mul_f32 v224, v224, v54
    v_mul_f32 v225, v225, v54
    v_mul_f32 v226, v226, v54
    v_mul_f32 v227, v227, v54
    v_accvgpr_write_b32 a8, v224
    v_accvgpr_write_b32 a9, v225
    v_accvgpr_write_b32 a10, v226
    v_accvgpr_write_b32 a11, v227
    v_accvgpr_read_b32 v224, a12
    v_accvgpr_read_b32 v225, a13
    v_accvgpr_read_b32 v226, a14
    v_accvgpr_read_b32 v227, a15
    v_mul_f32 v224, v224, v55
    v_mul_f32 v225, v225, v55
    v_mul_f32 v226, v226, v55
    v_mul_f32 v227, v227, v55
    v_accvgpr_write_b32 a12, v224
    v_accvgpr_write_b32 a13, v225
    v_accvgpr_write_b32 a14, v226
    v_accvgpr_write_b32 a15, v227
    v_accvgpr_read_b32 v224, a20
    v_accvgpr_read_b32 v225, a21
    v_accvgpr_read_b32 v226, a22
    v_accvgpr_read_b32 v227, a23
    v_mul_f32 v224, v224, v53
    v_mul_f32 v225, v225, v53
    v_mul_f32 v226, v226, v53
    v_mul_f32 v227, v227, v53
    v_accvgpr_write_b32 a20, v224
    v_accvgpr_write_b32 a21, v225
    v_accvgpr_write_b32 a22, v226
    v_accvgpr_write_b32 a23, v227
    v_accvgpr_read_b32 v224, a24
    v_accvgpr_read_b32 v225, a25
    v_accvgpr_read_b32 v226, a26
    v_accvgpr_read_b32 v227, a27
    v_mul_f32 v224, v224, v54
    v_mul_f32 v225, v225, v54
    v_mul_f32 v226, v226, v54
    v_mul_f32 v227, v227, v54
    v_accvgpr_write_b32 a24, v224
    v_accvgpr_write_b32 a25, v225
    v_accvgpr_write_b32 a26, v226
    v_accvgpr_write_b32 a27, v227
    v_accvgpr_read_b32 v224, a28
    v_accvgpr_read_b32 v225, a29
    v_accvgpr_read_b32 v226, a30
    v_accvgpr_read_b32 v227, a31
    v_mul_f32 v224, v224, v55
    v_mul_f32 v225, v225, v55
    v_mul_f32 v226, v226, v55
    v_mul_f32 v227, v227, v55
    v_accvgpr_write_b32 a28, v224
    v_accvgpr_write_b32 a29, v225
    v_accvgpr_write_b32 a30, v226
    v_accvgpr_write_b32 a31, v227
    v_accvgpr_read_b32 v224, a36
    v_accvgpr_read_b32 v225, a37
    v_accvgpr_read_b32 v226, a38
    v_accvgpr_read_b32 v227, a39
    v_mul_f32 v224, v224, v53
    v_mul_f32 v225, v225, v53
    v_mul_f32 v226, v226, v53
    v_mul_f32 v227, v227, v53
    v_accvgpr_write_b32 a36, v224
    v_accvgpr_write_b32 a37, v225
    v_accvgpr_write_b32 a38, v226
    v_accvgpr_write_b32 a39, v227
    v_accvgpr_read_b32 v224, a40
    v_accvgpr_read_b32 v225, a41
    v_accvgpr_read_b32 v226, a42
    v_accvgpr_read_b32 v227, a43
    v_mul_f32 v224, v224, v54
    v_mul_f32 v225, v225, v54
    v_mul_f32 v226, v226, v54
    v_mul_f32 v227, v227, v54
    v_accvgpr_write_b32 a40, v224
    v_accvgpr_write_b32 a41, v225
    v_accvgpr_write_b32 a42, v226
    v_accvgpr_write_b32 a43, v227
    v_accvgpr_read_b32 v224, a44
    v_accvgpr_read_b32 v225, a45
    v_accvgpr_read_b32 v226, a46
    v_accvgpr_read_b32 v227, a47
    v_mul_f32 v224, v224, v55
    v_mul_f32 v225, v225, v55
    v_mul_f32 v226, v226, v55
    v_mul_f32 v227, v227, v55
    v_accvgpr_write_b32 a44, v224
    v_accvgpr_write_b32 a45, v225
    v_accvgpr_write_b32 a46, v226
    v_accvgpr_write_b32 a47, v227
    v_accvgpr_read_b32 v224, a52
    v_accvgpr_read_b32 v225, a53
    v_accvgpr_read_b32 v226, a54
    v_accvgpr_read_b32 v227, a55
    v_mul_f32 v224, v224, v53
    v_mul_f32 v225, v225, v53
    v_mul_f32 v226, v226, v53
    v_mul_f32 v227, v227, v53
    v_accvgpr_write_b32 a52, v224
    v_accvgpr_write_b32 a53, v225
    v_accvgpr_write_b32 a54, v226
    v_accvgpr_write_b32 a55, v227
    v_accvgpr_read_b32 v224, a56
    v_accvgpr_read_b32 v225, a57
    v_accvgpr_read_b32 v226, a58
    v_accvgpr_read_b32 v227, a59
    v_mul_f32 v224, v224, v54
    v_mul_f32 v225, v225, v54
    v_mul_f32 v226, v226, v54
    v_mul_f32 v227, v227, v54
    v_accvgpr_write_b32 a56, v224
    v_accvgpr_write_b32 a57, v225
    v_accvgpr_write_b32 a58, v226
    v_accvgpr_write_b32 a59, v227
    v_accvgpr_read_b32 v224, a60
    v_accvgpr_read_b32 v225, a61
    v_accvgpr_read_b32 v226, a62
    v_accvgpr_read_b32 v227, a63
    v_mul_f32 v224, v224, v55
    v_mul_f32 v225, v225, v55
    v_mul_f32 v226, v226, v55
    v_mul_f32 v227, v227, v55
    v_accvgpr_write_b32 a60, v224
    v_accvgpr_write_b32 a61, v225
    v_accvgpr_write_b32 a62, v226
    v_accvgpr_write_b32 a63, v227
    v_accvgpr_read_b32 v224, a68
    v_accvgpr_read_b32 v225, a69
    v_accvgpr_read_b32 v226, a70
    v_accvgpr_read_b32 v227, a71
    v_mul_f32 v224, v224, v53
    v_mul_f32 v225, v225, v53
    v_mul_f32 v226, v226, v53
    v_mul_f32 v227, v227, v53
    v_accvgpr_write_b32 a68, v224
    v_accvgpr_write_b32 a69, v225
    v_accvgpr_write_b32 a70, v226
    v_accvgpr_write_b32 a71, v227
    v_accvgpr_read_b32 v224, a72
    v_accvgpr_read_b32 v225, a73
    v_accvgpr_read_b32 v226, a74
    v_accvgpr_read_b32 v227, a75
    v_mul_f32 v224, v224, v54
    v_mul_f32 v225, v225, v54
    v_mul_f32 v226, v226, v54
    v_mul_f32 v227, v227, v54
    v_accvgpr_write_b32 a72, v224
    v_accvgpr_write_b32 a73, v225
    v_accvgpr_write_b32 a74, v226
    v_accvgpr_write_b32 a75, v227
    v_accvgpr_read_b32 v224, a76
    v_accvgpr_read_b32 v225, a77
    v_accvgpr_read_b32 v226, a78
    v_accvgpr_read_b32 v227, a79
    v_mul_f32 v224, v224, v55
    v_mul_f32 v225, v225, v55
    v_mul_f32 v226, v226, v55
    v_mul_f32 v227, v227, v55
    v_accvgpr_write_b32 a76, v224
    v_accvgpr_write_b32 a77, v225
    v_accvgpr_write_b32 a78, v226
    v_accvgpr_write_b32 a79, v227
    v_accvgpr_read_b32 v224, a84
    v_accvgpr_read_b32 v225, a85
    v_accvgpr_read_b32 v226, a86
    v_accvgpr_read_b32 v227, a87
    v_mul_f32 v224, v224, v53
    v_mul_f32 v225, v225, v53
    v_mul_f32 v226, v226, v53
    v_mul_f32 v227, v227, v53
    v_accvgpr_write_b32 a84, v224
    v_accvgpr_write_b32 a85, v225
    v_accvgpr_write_b32 a86, v226
    v_accvgpr_write_b32 a87, v227
    v_accvgpr_read_b32 v224, a88
    v_accvgpr_read_b32 v225, a89
    v_accvgpr_read_b32 v226, a90
    v_accvgpr_read_b32 v227, a91
    v_mul_f32 v224, v224, v54
    v_mul_f32 v225, v225, v54
    v_mul_f32 v226, v226, v54
    v_mul_f32 v227, v227, v54
    v_accvgpr_write_b32 a88, v224
    v_accvgpr_write_b32 a89, v225
    v_accvgpr_write_b32 a90, v226
    v_accvgpr_write_b32 a91, v227
    v_accvgpr_read_b32 v224, a92
    v_accvgpr_read_b32 v225, a93
    v_accvgpr_read_b32 v226, a94
    v_accvgpr_read_b32 v227, a95
    v_mul_f32 v224, v224, v55
    v_mul_f32 v225, v225, v55
    v_mul_f32 v226, v226, v55
    v_mul_f32 v227, v227, v55
    v_accvgpr_write_b32 a92, v224
    v_accvgpr_write_b32 a93, v225
    v_accvgpr_write_b32 a94, v226
    v_accvgpr_write_b32 a95, v227
    v_accvgpr_read_b32 v224, a100
    v_accvgpr_read_b32 v225, a101
    v_accvgpr_read_b32 v226, a102
    v_accvgpr_read_b32 v227, a103
    v_mul_f32 v224, v224, v53
    v_mul_f32 v225, v225, v53
    v_mul_f32 v226, v226, v53
    v_mul_f32 v227, v227, v53
    v_accvgpr_write_b32 a100, v224
    v_accvgpr_write_b32 a101, v225
    v_accvgpr_write_b32 a102, v226
    v_accvgpr_write_b32 a103, v227
    v_accvgpr_read_b32 v224, a104
    v_accvgpr_read_b32 v225, a105
    v_accvgpr_read_b32 v226, a106
    v_accvgpr_read_b32 v227, a107
    v_mul_f32 v224, v224, v54
    v_mul_f32 v225, v225, v54
    v_mul_f32 v226, v226, v54
    v_mul_f32 v227, v227, v54
    v_accvgpr_write_b32 a104, v224
    v_accvgpr_write_b32 a105, v225
    v_accvgpr_write_b32 a106, v226
    v_accvgpr_write_b32 a107, v227
    v_accvgpr_read_b32 v224, a108
    v_accvgpr_read_b32 v225, a109
    v_accvgpr_read_b32 v226, a110
    v_accvgpr_read_b32 v227, a111
    v_mul_f32 v224, v224, v55
    v_mul_f32 v225, v225, v55
    v_mul_f32 v226, v226, v55
    v_mul_f32 v227, v227, v55
    v_accvgpr_write_b32 a108, v224
    v_accvgpr_write_b32 a109, v225
    v_accvgpr_write_b32 a110, v226
    v_accvgpr_write_b32 a111, v227
    v_accvgpr_read_b32 v224, a116
    v_accvgpr_read_b32 v225, a117
    v_accvgpr_read_b32 v226, a118
    v_accvgpr_read_b32 v227, a119
    v_mul_f32 v224, v224, v53
    v_mul_f32 v225, v225, v53
    v_mul_f32 v226, v226, v53
    v_mul_f32 v227, v227, v53
    v_accvgpr_write_b32 a116, v224
    v_accvgpr_write_b32 a117, v225
    v_accvgpr_write_b32 a118, v226
    v_accvgpr_write_b32 a119, v227
    v_accvgpr_read_b32 v224, a120
    v_accvgpr_read_b32 v225, a121
    v_accvgpr_read_b32 v226, a122
    v_accvgpr_read_b32 v227, a123
    v_mul_f32 v224, v224, v54
    v_mul_f32 v225, v225, v54
    v_mul_f32 v226, v226, v54
    v_mul_f32 v227, v227, v54
    v_accvgpr_write_b32 a120, v224
    v_accvgpr_write_b32 a121, v225
    v_accvgpr_write_b32 a122, v226
    v_accvgpr_write_b32 a123, v227
    v_accvgpr_read_b32 v224, a124
    v_accvgpr_read_b32 v225, a125
    v_accvgpr_read_b32 v226, a126
    v_accvgpr_read_b32 v227, a127
    v_mul_f32 v224, v224, v55
    v_mul_f32 v225, v225, v55
    v_mul_f32 v226, v226, v55
    v_mul_f32 v227, v227, v55
    v_accvgpr_write_b32 a124, v224
    v_accvgpr_write_b32 a125, v225
    v_accvgpr_write_b32 a126, v226
    v_accvgpr_write_b32 a127, v227
    v_exp_f32 v232, v164
    v_exp_f32 v233, v165
    v_exp_f32 v234, v166
    v_exp_f32 v235, v167
    s_nop 0
    v_cvt_pk_bf16_f32 v212, v232, v233
    v_cvt_pk_bf16_f32 v213, v234, v235
    v_exp_f32 v232, v180
    v_exp_f32 v233, v181
    v_exp_f32 v234, v182
    v_exp_f32 v235, v183
    s_nop 0
    v_cvt_pk_bf16_f32 v214, v232, v233
    v_cvt_pk_bf16_f32 v215, v234, v235
    v_exp_f32 v232, v168
    v_exp_f32 v233, v169
    v_exp_f32 v234, v170
    v_exp_f32 v235, v171
    s_nop 0
    v_cvt_pk_bf16_f32 v216, v232, v233
    v_cvt_pk_bf16_f32 v217, v234, v235
    v_exp_f32 v232, v184
    v_exp_f32 v233, v185
    v_exp_f32 v234, v186
    v_exp_f32 v235, v187
    s_nop 0
    v_cvt_pk_bf16_f32 v218, v232, v233
    v_cvt_pk_bf16_f32 v219, v234, v235
    v_exp_f32 v232, v172
    v_exp_f32 v233, v173
    v_exp_f32 v234, v174
    v_exp_f32 v235, v175
    s_nop 0
    v_cvt_pk_bf16_f32 v220, v232, v233
    v_cvt_pk_bf16_f32 v221, v234, v235
    v_exp_f32 v232, v188
    v_exp_f32 v233, v189
    v_exp_f32 v234, v190
    v_exp_f32 v235, v191
    s_nop 0
    v_cvt_pk_bf16_f32 v222, v232, v233
    v_cvt_pk_bf16_f32 v223, v234, v235
    s_nop 3
    s_setpc_b64 s[40:41]
k2_rare_166:
    s_nop 7
    v_max_f32 v54, v128, v129
    v_max3_f32 v54, v54, v130, v131
    v_max3_f32 v54, v54, v144, v145
    v_max3_f32 v54, v54, v146, v147
    v_max3_f32 v54, v54, v136, v137
    v_max3_f32 v54, v54, v138, v139
    v_max3_f32 v54, v54, v152, v153
    v_max3_f32 v54, v54, v154, v155
    v_max_f32 v55, v132, v133
    v_max3_f32 v55, v55, v134, v135
    v_max3_f32 v55, v55, v148, v149
    v_max3_f32 v55, v55, v150, v151
    v_max3_f32 v55, v55, v140, v141
    v_max3_f32 v55, v55, v142, v143
    v_max3_f32 v55, v55, v156, v157
    v_max3_f32 v55, v55, v158, v159
    v_mov_b32 v226, v54
    v_mov_b32 v227, v55
    s_nop 1
    v_permlane16_swap_b32 v54, v226
    v_permlane16_swap_b32 v55, v227
    s_nop 1
    v_max_f32 v54, v54, v226
    v_max_f32 v55, v55, v227
    v_mov_b32 v226, v54
    v_mov_b32 v227, v55
    s_nop 1
    v_permlane32_swap_b32 v54, v226
    v_permlane32_swap_b32 v55, v227
    s_nop 1
    v_max_f32 v54, v54, v226
    v_max_f32 v55, v55, v227
    v_add_f32 v54, 0x41400000, v54
    v_max_f32 v54, 0, v54
    v_add_f32 v55, 0x41400000, v55
    v_max_f32 v55, 0, v55
    v_sub_f32 v128, v128, v54
    v_sub_f32 v129, v129, v54
    v_sub_f32 v130, v130, v54
    v_sub_f32 v131, v131, v54
    v_sub_f32 v132, v132, v55
    v_sub_f32 v133, v133, v55
    v_sub_f32 v134, v134, v55
    v_sub_f32 v135, v135, v55
    v_sub_f32 v136, v136, v54
    v_sub_f32 v137, v137, v54
    v_sub_f32 v138, v138, v54
    v_sub_f32 v139, v139, v54
    v_sub_f32 v140, v140, v55
    v_sub_f32 v141, v141, v55
    v_sub_f32 v142, v142, v55
    v_sub_f32 v143, v143, v55
    v_sub_f32 v144, v144, v54
    v_sub_f32 v145, v145, v54
    v_sub_f32 v146, v146, v54
    v_sub_f32 v147, v147, v54
    v_sub_f32 v148, v148, v55
    v_sub_f32 v149, v149, v55
    v_sub_f32 v150, v150, v55
    v_sub_f32 v151, v151, v55
    v_sub_f32 v152, v152, v54
    v_sub_f32 v153, v153, v54
    v_sub_f32 v154, v154, v54
    v_sub_f32 v155, v155, v54
    v_sub_f32 v156, v156, v55
    v_sub_f32 v157, v157, v55
    v_sub_f32 v158, v158, v55
    v_sub_f32 v159, v159, v55
    v_sub_f32 v160, v160, v54
    v_sub_f32 v16, v16, v54
    v_sub_f32 v161, v161, v54
    v_sub_f32 v17, v17, v54
    v_sub_f32 v162, v162, v54
    v_sub_f32 v18, v18, v54
    v_sub_f32 v163, v163, v54
    v_sub_f32 v19, v19, v54
    v_sub_f32 v164, v164, v55
    v_sub_f32 v20, v20, v55
    v_sub_f32 v165, v165, v55
    v_sub_f32 v21, v21, v55
    v_sub_f32 v166, v166, v55
    v_sub_f32 v22, v22, v55
    v_sub_f32 v167, v167, v55
    v_sub_f32 v23, v23, v55
    v_sub_f32 v168, v168, v54
    v_sub_f32 v24, v24, v54
    v_sub_f32 v169, v169, v54
    v_sub_f32 v25, v25, v54
    v_sub_f32 v170, v170, v54
    v_sub_f32 v26, v26, v54
    v_sub_f32 v171, v171, v54
    v_sub_f32 v27, v27, v54
    v_sub_f32 v172, v172, v55
    v_sub_f32 v28, v28, v55
    v_sub_f32 v173, v173, v55
    v_sub_f32 v29, v29, v55
    v_sub_f32 v174, v174, v55
    v_sub_f32 v30, v30, v55
    v_sub_f32 v175, v175, v55
    v_sub_f32 v31, v31, v55
    v_sub_f32 v176, v176, v54
    v_sub_f32 v32, v32, v54
    v_sub_f32 v177, v177, v54
    v_sub_f32 v33, v33, v54
    v_sub_f32 v178, v178, v54
    v_sub_f32 v34, v34, v54
    v_sub_f32 v179, v179, v54
    v_sub_f32 v35, v35, v54
    v_sub_f32 v180, v180, v55
    v_sub_f32 v36, v36, v55
    v_sub_f32 v181, v181, v55
    v_sub_f32 v37, v37, v55
    v_sub_f32 v182, v182, v55
    v_sub_f32 v38, v38, v55
    v_sub_f32 v183, v183, v55
    v_sub_f32 v39, v39, v55
    v_sub_f32 v184, v184, v54
    v_sub_f32 v40, v40, v54
    v_sub_f32 v185, v185, v54
    v_sub_f32 v41, v41, v54
    v_sub_f32 v186, v186, v54
    v_sub_f32 v42, v42, v54
    v_sub_f32 v187, v187, v54
    v_sub_f32 v43, v43, v54
    v_sub_f32 v188, v188, v55
    v_sub_f32 v44, v44, v55
    v_sub_f32 v189, v189, v55
    v_sub_f32 v45, v45, v55
    v_sub_f32 v190, v190, v55
    v_sub_f32 v46, v46, v55
    v_sub_f32 v191, v191, v55
    v_sub_f32 v47, v47, v55
    v_sub_f32 v10, v10, v54
    v_exp_f32 v54, -v54
    v_sub_f32 v11, v11, v55
    v_exp_f32 v55, -v55
    s_nop 0
    v_mul_f32 v248, v248, v54
    v_mul_f32 v252, v252, v55
    v_accvgpr_read_b32 v224, a8
    v_accvgpr_read_b32 v225, a9
    v_accvgpr_read_b32 v226, a10
    v_accvgpr_read_b32 v227, a11
    v_mul_f32 v224, v224, v54
    v_mul_f32 v225, v225, v54
    v_mul_f32 v226, v226, v54
    v_mul_f32 v227, v227, v54
    v_accvgpr_write_b32 a8, v224
    v_accvgpr_write_b32 a9, v225
    v_accvgpr_write_b32 a10, v226
    v_accvgpr_write_b32 a11, v227
    v_accvgpr_read_b32 v224, a12
    v_accvgpr_read_b32 v225, a13
    v_accvgpr_read_b32 v226, a14
    v_accvgpr_read_b32 v227, a15
    v_mul_f32 v224, v224, v55
    v_mul_f32 v225, v225, v55
    v_mul_f32 v226, v226, v55
    v_mul_f32 v227, v227, v55
    v_accvgpr_write_b32 a12, v224
    v_accvgpr_write_b32 a13, v225
    v_accvgpr_write_b32 a14, v226
    v_accvgpr_write_b32 a15, v227
    v_accvgpr_read_b32 v224, a24
    v_accvgpr_read_b32 v225, a25
    v_accvgpr_read_b32 v226, a26
    v_accvgpr_read_b32 v227, a27
    v_mul_f32 v224, v224, v54
    v_mul_f32 v225, v225, v54
    v_mul_f32 v226, v226, v54
    v_mul_f32 v227, v227, v54
    v_accvgpr_write_b32 a24, v224
    v_accvgpr_write_b32 a25, v225
    v_accvgpr_write_b32 a26, v226
    v_accvgpr_write_b32 a27, v227
    v_accvgpr_read_b32 v224, a28
    v_accvgpr_read_b32 v225, a29
    v_accvgpr_read_b32 v226, a30
    v_accvgpr_read_b32 v227, a31
    v_mul_f32 v224, v224, v55
    v_mul_f32 v225, v225, v55
    v_mul_f32 v226, v226, v55
    v_mul_f32 v227, v227, v55
    v_accvgpr_write_b32 a28, v224
    v_accvgpr_write_b32 a29, v225
    v_accvgpr_write_b32 a30, v226
    v_accvgpr_write_b32 a31, v227
    v_accvgpr_read_b32 v224, a40
    v_accvgpr_read_b32 v225, a41
    v_accvgpr_read_b32 v226, a42
    v_accvgpr_read_b32 v227, a43
    v_mul_f32 v224, v224, v54
    v_mul_f32 v225, v225, v54
    v_mul_f32 v226, v226, v54
    v_mul_f32 v227, v227, v54
    v_accvgpr_write_b32 a40, v224
    v_accvgpr_write_b32 a41, v225
    v_accvgpr_write_b32 a42, v226
    v_accvgpr_write_b32 a43, v227
    v_accvgpr_read_b32 v224, a44
    v_accvgpr_read_b32 v225, a45
    v_accvgpr_read_b32 v226, a46
    v_accvgpr_read_b32 v227, a47
    v_mul_f32 v224, v224, v55
    v_mul_f32 v225, v225, v55
    v_mul_f32 v226, v226, v55
    v_mul_f32 v227, v227, v55
    v_accvgpr_write_b32 a44, v224
    v_accvgpr_write_b32 a45, v225
    v_accvgpr_write_b32 a46, v226
    v_accvgpr_write_b32 a47, v227
    v_accvgpr_read_b32 v224, a56
    v_accvgpr_read_b32 v225, a57
    v_accvgpr_read_b32 v226, a58
    v_accvgpr_read_b32 v227, a59
    v_mul_f32 v224, v224, v54
    v_mul_f32 v225, v225, v54
    v_mul_f32 v226, v226, v54
    v_mul_f32 v227, v227, v54
    v_accvgpr_write_b32 a56, v224
    v_accvgpr_write_b32 a57, v225
    v_accvgpr_write_b32 a58, v226
    v_accvgpr_write_b32 a59, v227
    v_accvgpr_read_b32 v224, a60
    v_accvgpr_read_b32 v225, a61
    v_accvgpr_read_b32 v226, a62
    v_accvgpr_read_b32 v227, a63
    v_mul_f32 v224, v224, v55
    v_mul_f32 v225, v225, v55
    v_mul_f32 v226, v226, v55
    v_mul_f32 v227, v227, v55
    v_accvgpr_write_b32 a60, v224
    v_accvgpr_write_b32 a61, v225
    v_accvgpr_write_b32 a62, v226
    v_accvgpr_write_b32 a63, v227
    v_accvgpr_read_b32 v224, a72
    v_accvgpr_read_b32 v225, a73
    v_accvgpr_read_b32 v226, a74
    v_accvgpr_read_b32 v227, a75
    v_mul_f32 v224, v224, v54
    v_mul_f32 v225, v225, v54
    v_mul_f32 v226, v226, v54
    v_mul_f32 v227, v227, v54
    v_accvgpr_write_b32 a72, v224
    v_accvgpr_write_b32 a73, v225
    v_accvgpr_write_b32 a74, v226
    v_accvgpr_write_b32 a75, v227
    v_accvgpr_read_b32 v224, a76
    v_accvgpr_read_b32 v225, a77
    v_accvgpr_read_b32 v226, a78
    v_accvgpr_read_b32 v227, a79
    v_mul_f32 v224, v224, v55
    v_mul_f32 v225, v225, v55
    v_mul_f32 v226, v226, v55
    v_mul_f32 v227, v227, v55
    v_accvgpr_write_b32 a76, v224
    v_accvgpr_write_b32 a77, v225
    v_accvgpr_write_b32 a78, v226
    v_accvgpr_write_b32 a79, v227
    v_accvgpr_read_b32 v224, a88
    v_accvgpr_read_b32 v225, a89
    v_accvgpr_read_b32 v226, a90
    v_accvgpr_read_b32 v227, a91
    v_mul_f32 v224, v224, v54
    v_mul_f32 v225, v225, v54
    v_mul_f32 v226, v226, v54
    v_mul_f32 v227, v227, v54
    v_accvgpr_write_b32 a88, v224
    v_accvgpr_write_b32 a89, v225
    v_accvgpr_write_b32 a90, v226
    v_accvgpr_write_b32 a91, v227
    v_accvgpr_read_b32 v224, a92
    v_accvgpr_read_b32 v225, a93
    v_accvgpr_read_b32 v226, a94
    v_accvgpr_read_b32 v227, a95
    v_mul_f32 v224, v224, v55
    v_mul_f32 v225, v225, v55
    v_mul_f32 v226, v226, v55
    v_mul_f32 v227, v227, v55
    v_accvgpr_write_b32 a92, v224
    v_accvgpr_write_b32 a93, v225
    v_accvgpr_write_b32 a94, v226
    v_accvgpr_write_b32 a95, v227
    v_accvgpr_read_b32 v224, a104
    v_accvgpr_read_b32 v225, a105
    v_accvgpr_read_b32 v226, a106
    v_accvgpr_read_b32 v227, a107
    v_mul_f32 v224, v224, v54
    v_mul_f32 v225, v225, v54
    v_mul_f32 v226, v226, v54
    v_mul_f32 v227, v227, v54
    v_accvgpr_write_b32 a104, v224
    v_accvgpr_write_b32 a105, v225
    v_accvgpr_write_b32 a106, v226
    v_accvgpr_write_b32 a107, v227
    v_accvgpr_read_b32 v224, a108
    v_accvgpr_read_b32 v225, a109
    v_accvgpr_read_b32 v226, a110
    v_accvgpr_read_b32 v227, a111
    v_mul_f32 v224, v224, v55
    v_mul_f32 v225, v225, v55
    v_mul_f32 v226, v226, v55
    v_mul_f32 v227, v227, v55
    v_accvgpr_write_b32 a108, v224
    v_accvgpr_write_b32 a109, v225
    v_accvgpr_write_b32 a110, v226
    v_accvgpr_write_b32 a111, v227
    v_accvgpr_read_b32 v224, a120
    v_accvgpr_read_b32 v225, a121
    v_accvgpr_read_b32 v226, a122
    v_accvgpr_read_b32 v227, a123
    v_mul_f32 v224, v224, v54
    v_mul_f32 v225, v225, v54
    v_mul_f32 v226, v226, v54
    v_mul_f32 v227, v227, v54
    v_accvgpr_write_b32 a120, v224
    v_accvgpr_write_b32 a121, v225
    v_accvgpr_write_b32 a122, v226
    v_accvgpr_write_b32 a123, v227
    v_accvgpr_read_b32 v224, a124
    v_accvgpr_read_b32 v225, a125
    v_accvgpr_read_b32 v226, a126
    v_accvgpr_read_b32 v227, a127
    v_mul_f32 v224, v224, v55
    v_mul_f32 v225, v225, v55
    v_mul_f32 v226, v226, v55
    v_mul_f32 v227, v227, v55
    v_accvgpr_write_b32 a124, v224
    v_accvgpr_write_b32 a125, v225
    v_accvgpr_write_b32 a126, v226
    v_accvgpr_write_b32 a127, v227
    v_exp_f32 v232, v128
    v_exp_f32 v233, v129
    v_exp_f32 v234, v130
    v_exp_f32 v235, v131
    s_nop 0
    v_cvt_pk_bf16_f32 v192, v232, v233
    v_cvt_pk_bf16_f32 v193, v234, v235
    v_exp_f32 v232, v144
    v_exp_f32 v233, v145
    v_exp_f32 v234, v146
    v_exp_f32 v235, v147
    s_nop 0
    v_cvt_pk_bf16_f32 v194, v232, v233
    v_cvt_pk_bf16_f32 v195, v234, v235
    v_exp_f32 v232, v132
    v_exp_f32 v233, v133
    v_exp_f32 v234, v134
    v_exp_f32 v235, v135
    s_nop 0
    v_cvt_pk_bf16_f32 v196, v232, v233
    v_cvt_pk_bf16_f32 v197, v234, v235
    v_exp_f32 v232, v148
    v_exp_f32 v233, v149
    v_exp_f32 v234, v150
    v_exp_f32 v235, v151
    s_nop 0
    v_cvt_pk_bf16_f32 v198, v232, v233
    v_cvt_pk_bf16_f32 v199, v234, v235
    v_exp_f32 v232, v136
    v_exp_f32 v233, v137
    v_exp_f32 v234, v138
    v_exp_f32 v235, v139
    s_nop 0
    v_cvt_pk_bf16_f32 v200, v232, v233
    v_cvt_pk_bf16_f32 v201, v234, v235
    v_exp_f32 v232, v152
    v_exp_f32 v233, v153
    v_exp_f32 v234, v154
    v_exp_f32 v235, v155
    s_nop 0
    v_cvt_pk_bf16_f32 v202, v232, v233
    v_cvt_pk_bf16_f32 v203, v234, v235
    v_exp_f32 v232, v140
    v_exp_f32 v233, v141
    v_exp_f32 v234, v142
    v_exp_f32 v235, v143
    s_nop 0
    v_cvt_pk_bf16_f32 v204, v232, v233
    v_cvt_pk_bf16_f32 v205, v234, v235
    v_exp_f32 v232, v156
    v_exp_f32 v233, v157
    v_exp_f32 v234, v158
    v_exp_f32 v235, v159
    s_nop 0
    v_cvt_pk_bf16_f32 v206, v232, v233
    v_cvt_pk_bf16_f32 v207, v234, v235
    s_nop 3
    s_setpc_b64 s[40:41]
k2_rare_167:
    s_nop 7
    v_max_f32 v54, v160, v161
    v_max3_f32 v54, v54, v162, v163
    v_max3_f32 v54, v54, v176, v177
    v_max3_f32 v54, v54, v178, v179
    v_max3_f32 v54, v54, v168, v169
    v_max3_f32 v54, v54, v170, v171
    v_max3_f32 v54, v54, v184, v185
    v_max3_f32 v54, v54, v186, v187
    v_max_f32 v55, v164, v165
    v_max3_f32 v55, v55, v166, v167
    v_max3_f32 v55, v55, v180, v181
    v_max3_f32 v55, v55, v182, v183
    v_max3_f32 v55, v55, v172, v173
    v_max3_f32 v55, v55, v174, v175
    v_max3_f32 v55, v55, v188, v189
    v_max3_f32 v55, v55, v190, v191
    v_mov_b32 v226, v54
    v_mov_b32 v227, v55
    s_nop 1
    v_permlane16_swap_b32 v54, v226
    v_permlane16_swap_b32 v55, v227
    s_nop 1
    v_max_f32 v54, v54, v226
    v_max_f32 v55, v55, v227
    v_mov_b32 v226, v54
    v_mov_b32 v227, v55
    s_nop 1
    v_permlane32_swap_b32 v54, v226
    v_permlane32_swap_b32 v55, v227
    s_nop 1
    v_max_f32 v54, v54, v226
    v_max_f32 v55, v55, v227
    v_add_f32 v54, 0x41400000, v54
    v_max_f32 v54, 0, v54
    v_add_f32 v55, 0x41400000, v55
    v_max_f32 v55, 0, v55
    v_sub_f32 v160, v160, v54
    v_sub_f32 v161, v161, v54
    v_sub_f32 v162, v162, v54
    v_sub_f32 v163, v163, v54
    v_sub_f32 v164, v164, v55
    v_sub_f32 v165, v165, v55
    v_sub_f32 v166, v166, v55
    v_sub_f32 v167, v167, v55
    v_sub_f32 v168, v168, v54
    v_sub_f32 v169, v169, v54
    v_sub_f32 v170, v170, v54
    v_sub_f32 v171, v171, v54
    v_sub_f32 v172, v172, v55
    v_sub_f32 v173, v173, v55
    v_sub_f32 v174, v174, v55
    v_sub_f32 v175, v175, v55
    v_sub_f32 v176, v176, v54
    v_sub_f32 v177, v177, v54
    v_sub_f32 v178, v178, v54
    v_sub_f32 v179, v179, v54
    v_sub_f32 v180, v180, v55
    v_sub_f32 v181, v181, v55
    v_sub_f32 v182, v182, v55
    v_sub_f32 v183, v183, v55
    v_sub_f32 v184, v184, v54
    v_sub_f32 v185, v185, v54
    v_sub_f32 v186, v186, v54
    v_sub_f32 v187, v187, v54
    v_sub_f32 v188, v188, v55
    v_sub_f32 v189, v189, v55
    v_sub_f32 v190, v190, v55
    v_sub_f32 v191, v191, v55
    v_sub_f32 v128, v128, v54
    v_sub_f32 v16, v16, v54
    v_sub_f32 v129, v129, v54
    v_sub_f32 v17, v17, v54
    v_sub_f32 v130, v130, v54
    v_sub_f32 v18, v18, v54
    v_sub_f32 v131, v131, v54
    v_sub_f32 v19, v19, v54
    v_sub_f32 v132, v132, v55
    v_sub_f32 v20, v20, v55
    v_sub_f32 v133, v133, v55
    v_sub_f32 v21, v21, v55
    v_sub_f32 v134, v134, v55
    v_sub_f32 v22, v22, v55
    v_sub_f32 v135, v135, v55
    v_sub_f32 v23, v23, v55
    v_sub_f32 v136, v136, v54
    v_sub_f32 v24, v24, v54
    v_sub_f32 v137, v137, v54
    v_sub_f32 v25, v25, v54
    v_sub_f32 v138, v138, v54
    v_sub_f32 v26, v26, v54
    v_sub_f32 v139, v139, v54
    v_sub_f32 v27, v27, v54
    v_sub_f32 v140, v140, v55
    v_sub_f32 v28, v28, v55
    v_sub_f32 v141, v141, v55
    v_sub_f32 v29, v29, v55
    v_sub_f32 v142, v142, v55
    v_sub_f32 v30, v30, v55
    v_sub_f32 v143, v143, v55
    v_sub_f32 v31, v31, v55
    v_sub_f32 v144, v144, v54
    v_sub_f32 v32, v32, v54
    v_sub_f32 v145, v145, v54
    v_sub_f32 v33, v33, v54
    v_sub_f32 v146, v146, v54
    v_sub_f32 v34, v34, v54
    v_sub_f32 v147, v147, v54
    v_sub_f32 v35, v35, v54
    v_sub_f32 v148, v148, v55
    v_sub_f32 v36, v36, v55
    v_sub_f32 v149, v149, v55
    v_sub_f32 v37, v37, v55
    v_sub_f32 v150, v150, v55
    v_sub_f32 v38, v38, v55
    v_sub_f32 v151, v151, v55
    v_sub_f32 v39, v39, v55
    v_sub_f32 v152, v152, v54
    v_sub_f32 v40, v40, v54
    v_sub_f32 v153, v153, v54
    v_sub_f32 v41, v41, v54
    v_sub_f32 v154, v154, v54
    v_sub_f32 v42, v42, v54
    v_sub_f32 v155, v155, v54
    v_sub_f32 v43, v43, v54
    v_sub_f32 v156, v156, v55
    v_sub_f32 v44, v44, v55
    v_sub_f32 v157, v157, v55
    v_sub_f32 v45, v45, v55
    v_sub_f32 v158, v158, v55
    v_sub_f32 v46, v46, v55
    v_sub_f32 v159, v159, v55
    v_sub_f32 v47, v47, v55
    v_sub_f32 v10, v10, v54
    v_exp_f32 v54, -v54
    v_sub_f32 v11, v11, v55
    v_exp_f32 v55, -v55
    s_nop 0
    v_mul_f32 v248, v248, v54
    v_mul_f32 v252, v252, v55
    v_accvgpr_read_b32 v224, a8
    v_accvgpr_read_b32 v225, a9
    v_accvgpr_read_b32 v226, a10
    v_accvgpr_read_b32 v227, a11
    v_mul_f32 v224, v224, v54
    v_mul_f32 v225, v225, v54
    v_mul_f32 v226, v226, v54
    v_mul_f32 v227, v227, v54
    v_accvgpr_write_b32 a8, v224
    v_accvgpr_write_b32 a9, v225
    v_accvgpr_write_b32 a10, v226
    v_accvgpr_write_b32 a11, v227
    v_accvgpr_read_b32 v224, a12
    v_accvgpr_read_b32 v225, a13
    v_accvgpr_read_b32 v226, a14
    v_accvgpr_read_b32 v227, a15
    v_mul_f32 v224, v224, v55
    v_mul_f32 v225, v225, v55
    v_mul_f32 v226, v226, v55
    v_mul_f32 v227, v227, v55
    v_accvgpr_write_b32 a12, v224
    v_accvgpr_write_b32 a13, v225
    v_accvgpr_write_b32 a14, v226
    v_accvgpr_write_b32 a15, v227
    v_accvgpr_read_b32 v224, a24
    v_accvgpr_read_b32 v225, a25
    v_accvgpr_read_b32 v226, a26
    v_accvgpr_read_b32 v227, a27
    v_mul_f32 v224, v224, v54
    v_mul_f32 v225, v225, v54
    v_mul_f32 v226, v226, v54
    v_mul_f32 v227, v227, v54
    v_accvgpr_write_b32 a24, v224
    v_accvgpr_write_b32 a25, v225
    v_accvgpr_write_b32 a26, v226
    v_accvgpr_write_b32 a27, v227
    v_accvgpr_read_b32 v224, a28
    v_accvgpr_read_b32 v225, a29
    v_accvgpr_read_b32 v226, a30
    v_accvgpr_read_b32 v227, a31
    v_mul_f32 v224, v224, v55
    v_mul_f32 v225, v225, v55
    v_mul_f32 v226, v226, v55
    v_mul_f32 v227, v227, v55
    v_accvgpr_write_b32 a28, v224
    v_accvgpr_write_b32 a29, v225
    v_accvgpr_write_b32 a30, v226
    v_accvgpr_write_b32 a31, v227
    v_accvgpr_read_b32 v224, a40
    v_accvgpr_read_b32 v225, a41
    v_accvgpr_read_b32 v226, a42
    v_accvgpr_read_b32 v227, a43
    v_mul_f32 v224, v224, v54
    v_mul_f32 v225, v225, v54
    v_mul_f32 v226, v226, v54
    v_mul_f32 v227, v227, v54
    v_accvgpr_write_b32 a40, v224
    v_accvgpr_write_b32 a41, v225
    v_accvgpr_write_b32 a42, v226
    v_accvgpr_write_b32 a43, v227
    v_accvgpr_read_b32 v224, a44
    v_accvgpr_read_b32 v225, a45
    v_accvgpr_read_b32 v226, a46
    v_accvgpr_read_b32 v227, a47
    v_mul_f32 v224, v224, v55
    v_mul_f32 v225, v225, v55
    v_mul_f32 v226, v226, v55
    v_mul_f32 v227, v227, v55
    v_accvgpr_write_b32 a44, v224
    v_accvgpr_write_b32 a45, v225
    v_accvgpr_write_b32 a46, v226
    v_accvgpr_write_b32 a47, v227
    v_accvgpr_read_b32 v224, a56
    v_accvgpr_read_b32 v225, a57
    v_accvgpr_read_b32 v226, a58
    v_accvgpr_read_b32 v227, a59
    v_mul_f32 v224, v224, v54
    v_mul_f32 v225, v225, v54
    v_mul_f32 v226, v226, v54
    v_mul_f32 v227, v227, v54
    v_accvgpr_write_b32 a56, v224
    v_accvgpr_write_b32 a57, v225
    v_accvgpr_write_b32 a58, v226
    v_accvgpr_write_b32 a59, v227
    v_accvgpr_read_b32 v224, a60
    v_accvgpr_read_b32 v225, a61
    v_accvgpr_read_b32 v226, a62
    v_accvgpr_read_b32 v227, a63
    v_mul_f32 v224, v224, v55
    v_mul_f32 v225, v225, v55
    v_mul_f32 v226, v226, v55
    v_mul_f32 v227, v227, v55
    v_accvgpr_write_b32 a60, v224
    v_accvgpr_write_b32 a61, v225
    v_accvgpr_write_b32 a62, v226
    v_accvgpr_write_b32 a63, v227
    v_accvgpr_read_b32 v224, a72
    v_accvgpr_read_b32 v225, a73
    v_accvgpr_read_b32 v226, a74
    v_accvgpr_read_b32 v227, a75
    v_mul_f32 v224, v224, v54
    v_mul_f32 v225, v225, v54
    v_mul_f32 v226, v226, v54
    v_mul_f32 v227, v227, v54
    v_accvgpr_write_b32 a72, v224
    v_accvgpr_write_b32 a73, v225
    v_accvgpr_write_b32 a74, v226
    v_accvgpr_write_b32 a75, v227
    v_accvgpr_read_b32 v224, a76
    v_accvgpr_read_b32 v225, a77
    v_accvgpr_read_b32 v226, a78
    v_accvgpr_read_b32 v227, a79
    v_mul_f32 v224, v224, v55
    v_mul_f32 v225, v225, v55
    v_mul_f32 v226, v226, v55
    v_mul_f32 v227, v227, v55
    v_accvgpr_write_b32 a76, v224
    v_accvgpr_write_b32 a77, v225
    v_accvgpr_write_b32 a78, v226
    v_accvgpr_write_b32 a79, v227
    v_accvgpr_read_b32 v224, a88
    v_accvgpr_read_b32 v225, a89
    v_accvgpr_read_b32 v226, a90
    v_accvgpr_read_b32 v227, a91
    v_mul_f32 v224, v224, v54
    v_mul_f32 v225, v225, v54
    v_mul_f32 v226, v226, v54
    v_mul_f32 v227, v227, v54
    v_accvgpr_write_b32 a88, v224
    v_accvgpr_write_b32 a89, v225
    v_accvgpr_write_b32 a90, v226
    v_accvgpr_write_b32 a91, v227
    v_accvgpr_read_b32 v224, a92
    v_accvgpr_read_b32 v225, a93
    v_accvgpr_read_b32 v226, a94
    v_accvgpr_read_b32 v227, a95
    v_mul_f32 v224, v224, v55
    v_mul_f32 v225, v225, v55
    v_mul_f32 v226, v226, v55
    v_mul_f32 v227, v227, v55
    v_accvgpr_write_b32 a92, v224
    v_accvgpr_write_b32 a93, v225
    v_accvgpr_write_b32 a94, v226
    v_accvgpr_write_b32 a95, v227
    v_accvgpr_read_b32 v224, a104
    v_accvgpr_read_b32 v225, a105
    v_accvgpr_read_b32 v226, a106
    v_accvgpr_read_b32 v227, a107
    v_mul_f32 v224, v224, v54
    v_mul_f32 v225, v225, v54
    v_mul_f32 v226, v226, v54
    v_mul_f32 v227, v227, v54
    v_accvgpr_write_b32 a104, v224
    v_accvgpr_write_b32 a105, v225
    v_accvgpr_write_b32 a106, v226
    v_accvgpr_write_b32 a107, v227
    v_accvgpr_read_b32 v224, a108
    v_accvgpr_read_b32 v225, a109
    v_accvgpr_read_b32 v226, a110
    v_accvgpr_read_b32 v227, a111
    v_mul_f32 v224, v224, v55
    v_mul_f32 v225, v225, v55
    v_mul_f32 v226, v226, v55
    v_mul_f32 v227, v227, v55
    v_accvgpr_write_b32 a108, v224
    v_accvgpr_write_b32 a109, v225
    v_accvgpr_write_b32 a110, v226
    v_accvgpr_write_b32 a111, v227
    v_accvgpr_read_b32 v224, a120
    v_accvgpr_read_b32 v225, a121
    v_accvgpr_read_b32 v226, a122
    v_accvgpr_read_b32 v227, a123
    v_mul_f32 v224, v224, v54
    v_mul_f32 v225, v225, v54
    v_mul_f32 v226, v226, v54
    v_mul_f32 v227, v227, v54
    v_accvgpr_write_b32 a120, v224
    v_accvgpr_write_b32 a121, v225
    v_accvgpr_write_b32 a122, v226
    v_accvgpr_write_b32 a123, v227
    v_accvgpr_read_b32 v224, a124
    v_accvgpr_read_b32 v225, a125
    v_accvgpr_read_b32 v226, a126
    v_accvgpr_read_b32 v227, a127
    v_mul_f32 v224, v224, v55
    v_mul_f32 v225, v225, v55
    v_mul_f32 v226, v226, v55
    v_mul_f32 v227, v227, v55
    v_accvgpr_write_b32 a124, v224
    v_accvgpr_write_b32 a125, v225
    v_accvgpr_write_b32 a126, v226
    v_accvgpr_write_b32 a127, v227
    v_exp_f32 v232, v160
    v_exp_f32 v233, v161
    v_exp_f32 v234, v162
    v_exp_f32 v235, v163
    s_nop 0
    v_cvt_pk_bf16_f32 v208, v232, v233
    v_cvt_pk_bf16_f32 v209, v234, v235
    v_exp_f32 v232, v176
    v_exp_f32 v233, v177
    v_exp_f32 v234, v178
    v_exp_f32 v235, v179
    s_nop 0
    v_cvt_pk_bf16_f32 v210, v232, v233
    v_cvt_pk_bf16_f32 v211, v234, v235
    v_exp_f32 v232, v164
    v_exp_f32 v233, v165
    v_exp_f32 v234, v166
    v_exp_f32 v235, v167
    s_nop 0
    v_cvt_pk_bf16_f32 v212, v232, v233
    v_cvt_pk_bf16_f32 v213, v234, v235
    v_exp_f32 v232, v180
    v_exp_f32 v233, v181
    v_exp_f32 v234, v182
    v_exp_f32 v235, v183
    s_nop 0
    v_cvt_pk_bf16_f32 v214, v232, v233
    v_cvt_pk_bf16_f32 v215, v234, v235
    v_exp_f32 v232, v168
    v_exp_f32 v233, v169
    v_exp_f32 v234, v170
    v_exp_f32 v235, v171
    s_nop 0
    v_cvt_pk_bf16_f32 v216, v232, v233
    v_cvt_pk_bf16_f32 v217, v234, v235
    v_exp_f32 v232, v184
    v_exp_f32 v233, v185
    v_exp_f32 v234, v186
    v_exp_f32 v235, v187
    s_nop 0
    v_cvt_pk_bf16_f32 v218, v232, v233
    v_cvt_pk_bf16_f32 v219, v234, v235
    v_exp_f32 v232, v172
    v_exp_f32 v233, v173
    v_exp_f32 v234, v174
    v_exp_f32 v235, v175
    s_nop 0
    v_cvt_pk_bf16_f32 v220, v232, v233
    v_cvt_pk_bf16_f32 v221, v234, v235
    v_exp_f32 v232, v188
    v_exp_f32 v233, v189
    v_exp_f32 v234, v190
    v_exp_f32 v235, v191
    s_nop 0
    v_cvt_pk_bf16_f32 v222, v232, v233
    v_cvt_pk_bf16_f32 v223, v234, v235
    s_nop 3
    s_setpc_b64 s[40:41]
k2_rare_171:
    s_nop 7
    v_max_f32 v55, v164, v165
    v_max3_f32 v55, v55, v166, v167
    v_max3_f32 v55, v55, v180, v181
    v_max3_f32 v55, v55, v182, v183
    v_max3_f32 v55, v55, v172, v173
    v_max3_f32 v55, v55, v174, v175
    v_max3_f32 v55, v55, v188, v189
    v_max3_f32 v55, v55, v190, v191
    v_mov_b32 v227, v55
    s_nop 1
    v_permlane16_swap_b32 v55, v227
    s_nop 1
    v_max_f32 v55, v55, v227
    v_mov_b32 v227, v55
    s_nop 1
    v_permlane32_swap_b32 v55, v227
    s_nop 1
    v_max_f32 v55, v55, v227
    v_add_f32 v55, 0x41400000, v55
    v_max_f32 v55, 0, v55
    v_sub_f32 v164, v164, v55
    v_sub_f32 v165, v165, v55
    v_sub_f32 v166, v166, v55
    v_sub_f32 v167, v167, v55
    v_sub_f32 v172, v172, v55
    v_sub_f32 v173, v173, v55
    v_sub_f32 v174, v174, v55
    v_sub_f32 v175, v175, v55
    v_sub_f32 v180, v180, v55
    v_sub_f32 v181, v181, v55
    v_sub_f32 v182, v182, v55
    v_sub_f32 v183, v183, v55
    v_sub_f32 v188, v188, v55
    v_sub_f32 v189, v189, v55
    v_sub_f32 v190, v190, v55
    v_sub_f32 v191, v191, v55
    v_sub_f32 v11, v11, v55
    v_exp_f32 v55, -v55
    s_nop 0
    v_mul_f32 v252, v252, v55
    v_accvgpr_read_b32 v224, a12
    v_accvgpr_read_b32 v225, a13
    v_accvgpr_read_b32 v226, a14
    v_accvgpr_read_b32 v227, a15
    v_mul_f32 v224, v224, v55
    v_mul_f32 v225, v225, v55
    v_mul_f32 v226, v226, v55
    v_mul_f32 v227, v227, v55
    v_accvgpr_write_b32 a12, v224
    v_accvgpr_write_b32 a13, v225
    v_accvgpr_write_b32 a14, v226
    v_accvgpr_write_b32 a15, v227
    v_accvgpr_read_b32 v224, a28
    v_accvgpr_read_b32 v225, a29
    v_accvgpr_read_b32 v226, a30
    v_accvgpr_read_b32 v227, a31
    v_mul_f32 v224, v224, v55
    v_mul_f32 v225, v225, v55
    v_mul_f32 v226, v226, v55
    v_mul_f32 v227, v227, v55
    v_accvgpr_write_b32 a28, v224
    v_accvgpr_write_b32 a29, v225
    v_accvgpr_write_b32 a30, v226
    v_accvgpr_write_b32 a31, v227
    v_accvgpr_read_b32 v224, a44
    v_accvgpr_read_b32 v225, a45
    v_accvgpr_read_b32 v226, a46
    v_accvgpr_read_b32 v227, a47
    v_mul_f32 v224, v224, v55
    v_mul_f32 v225, v225, v55
    v_mul_f32 v226, v226, v55
    v_mul_f32 v227, v227, v55
    v_accvgpr_write_b32 a44, v224
    v_accvgpr_write_b32 a45, v225
    v_accvgpr_write_b32 a46, v226
    v_accvgpr_write_b32 a47, v227
    v_accvgpr_read_b32 v224, a60
    v_accvgpr_read_b32 v225, a61
    v_accvgpr_read_b32 v226, a62
    v_accvgpr_read_b32 v227, a63
    v_mul_f32 v224, v224, v55
    v_mul_f32 v225, v225, v55
    v_mul_f32 v226, v226, v55
    v_mul_f32 v227, v227, v55
    v_accvgpr_write_b32 a60, v224
    v_accvgpr_write_b32 a61, v225
    v_accvgpr_write_b32 a62, v226
    v_accvgpr_write_b32 a63, v227
    v_accvgpr_read_b32 v224, a76
    v_accvgpr_read_b32 v225, a77
    v_accvgpr_read_b32 v226, a78
    v_accvgpr_read_b32 v227, a79
    v_mul_f32 v224, v224, v55
    v_mul_f32 v225, v225, v55
    v_mul_f32 v226, v226, v55
    v_mul_f32 v227, v227, v55
    v_accvgpr_write_b32 a76, v224
    v_accvgpr_write_b32 a77, v225
    v_accvgpr_write_b32 a78, v226
    v_accvgpr_write_b32 a79, v227
    v_accvgpr_read_b32 v224, a92
    v_accvgpr_read_b32 v225, a93
    v_accvgpr_read_b32 v226, a94
    v_accvgpr_read_b32 v227, a95
    v_mul_f32 v224, v224, v55
    v_mul_f32 v225, v225, v55
    v_mul_f32 v226, v226, v55
    v_mul_f32 v227, v227, v55
    v_accvgpr_write_b32 a92, v224
    v_accvgpr_write_b32 a93, v225
    v_accvgpr_write_b32 a94, v226
    v_accvgpr_write_b32 a95, v227
    v_accvgpr_read_b32 v224, a108
    v_accvgpr_read_b32 v225, a109
    v_accvgpr_read_b32 v226, a110
    v_accvgpr_read_b32 v227, a111
    v_mul_f32 v224, v224, v55
    v_mul_f32 v225, v225, v55
    v_mul_f32 v226, v226, v55
    v_mul_f32 v227, v227, v55
    v_accvgpr_write_b32 a108, v224
    v_accvgpr_write_b32 a109, v225
    v_accvgpr_write_b32 a110, v226
    v_accvgpr_write_b32 a111, v227
    v_accvgpr_read_b32 v224, a124
    v_accvgpr_read_b32 v225, a125
    v_accvgpr_read_b32 v226, a126
    v_accvgpr_read_b32 v227, a127
    v_mul_f32 v224, v224, v55
    v_mul_f32 v225, v225, v55
    v_mul_f32 v226, v226, v55
    v_mul_f32 v227, v227, v55
    v_accvgpr_write_b32 a124, v224
    v_accvgpr_write_b32 a125, v225
    v_accvgpr_write_b32 a126, v226
    v_accvgpr_write_b32 a127, v227
    v_exp_f32 v232, v164
    v_exp_f32 v233, v165
    v_exp_f32 v234, v166
    v_exp_f32 v235, v167
    s_nop 0
    v_cvt_pk_bf16_f32 v212, v232, v233
    v_cvt_pk_bf16_f32 v213, v234, v235
    v_exp_f32 v232, v180
    v_exp_f32 v233, v181
    v_exp_f32 v234, v182
    v_exp_f32 v235, v183
    s_nop 0
    v_cvt_pk_bf16_f32 v214, v232, v233
    v_cvt_pk_bf16_f32 v215, v234, v235
    v_exp_f32 v232, v172
    v_exp_f32 v233, v173
    v_exp_f32 v234, v174
    v_exp_f32 v235, v175
    s_nop 0
    v_cvt_pk_bf16_f32 v220, v232, v233
    v_cvt_pk_bf16_f32 v221, v234, v235
    v_exp_f32 v232, v188
    v_exp_f32 v233, v189
    v_exp_f32 v234, v190
    v_exp_f32 v235, v191
    s_nop 0
    v_cvt_pk_bf16_f32 v222, v232, v233
    v_cvt_pk_bf16_f32 v223, v234, v235
    s_nop 3
    s_setpc_b64 s[40:41]
code_end:
    s_endpgm
.section .rodata,"a"
.p2align 6
.amdhsa_kernel sequential_preLN__compressed_kv_cla__moe_arch_mod__prompt_kernel
  .amdhsa_next_free_vgpr 512
  .amdhsa_next_free_sgpr 102
  .amdhsa_accum_offset 256
  .amdhsa_group_segment_fixed_size 0
  .amdhsa_kernarg_size 112
  .amdhsa_user_sgpr_count 2
  .amdhsa_user_sgpr_kernarg_segment_ptr 1
  .amdhsa_system_sgpr_workgroup_id_x 1
.end_amdhsa_kernel
```

```asm
; @launch grid=(256,1,1) block=(256,1,1) lds=163840
.amdgcn_target "amdgcn-amd-amdhsa--gfx950"
.text
.globl sequential_preLN__compressed_kv_cla__moe_arch_mod__prompt_kernel
.p2align 8
.type sequential_preLN__compressed_kv_cla__moe_arch_mod__prompt_kernel,@function
sequential_preLN__compressed_kv_cla__moe_arch_mod__prompt_kernel:
    s_cmp_ge_u32 s2, 256
    s_cbranch_scc1 k12_end_1
    s_load_dwordx4 s[36:39], s[0:1], 0
    s_load_dwordx4 s[40:43], s[0:1], 24
    s_load_dwordx2 s[4:5], s[0:1], 16
    s_load_dwordx4 s[60:63], s[0:1], 96
    s_lshr_b32 s59, s2, 3
    s_lshl_b32 s58, s59, 4
    v_add_u32 v6, s58, v0
    v_cmp_gt_u32 vcc, 48, v0
    v_cmp_gt_u32 s[56:57], 64, v0
    s_nop 0
    v_cndmask_b32 v6, v6, v0, vcc
    s_getpc_b64 s[52:53]
pc_2:
    s_add_u32 s52, s52, k12_code0-pc_2
    s_addc_u32 s53, s53, 0
    v_lshlrev_b32 v58, 7, v6
    v_mov_b32 v59, s53
    v_add_co_u32 v58, vcc, s52, v58
    s_nop 1
    v_addc_co_u32 v59, vcc, 0, v59, vcc
k12_code0:
    s_mov_b64 exec, s[56:57]
    s_cbranch_execz k12_nocode_3
    global_load_dword v51, v[58:59], off
k12_nocode_3:
    s_mov_b64 exec, -1
    s_and_b32 s58, s2, 7
    s_lshr_b32 s59, s2, 3
    s_and_b32 s45, s59, 7
    s_lshr_b32 s57, s59, 3
    s_and_b32 s44, s57, 1
    s_lshl_b32 s52, s58, 1
    s_add_u32 s44, s44, s52
    s_lshr_b32 s57, s57, 1
    v_lshrrev_b32 v2, 6, v0
    v_and_b32 v3, 63, v0
    v_readfirstlane_b32 s30, v2
    v_lshlrev_b32 v1, 4, v3
    v_lshrrev_b32 v60, 5, v3
    v_lshl_add_u32 v60, v2, 1, v60
    v_and_b32 v61, 31, v3
    v_lshlrev_b32 v6, 11, v60
    v_lshl_add_u32 v62, v61, 4, v6
    s_lshl_b32 s52, s2, 14
    v_lshrrev_b32 v56, 3, v3
    v_and_b32 v57, 7, v3
    v_lshrrev_b32 v58, 1, v56
    v_xor_b32 v6, v57, v58
    v_xor_b32 v7, 4, v6
    v_lshl_add_u32 v58, v2, 6, v56
    v_lshlrev_b32 v58, 10, v58
    s_lshl_b32 s47, s45, 18
    v_add_u32 v58, s47, v58
    v_lshl_add_u32 v10, v6, 4, v58
    v_lshl_add_u32 v11, v7, 4, v58
    v_add_u32 v17, 54272, v11
    v_add_u32 v16, 47104, v10
    v_add_u32 v15, 39936, v11
    v_add_u32 v14, 32768, v10
    v_add_u32 v13, 21504, v11
    v_add_u32 v12, 14336, v10
    v_add_u32 v11, 7168, v11
    v_add_u32 v10, 0, v10
    v_lshrrev_b32 v6, 5, v3
    v_bfe_u32 v7, v3, 1, 4
    v_and_b32 v59, 1, v3
    v_lshl_add_u32 v58, v2, 4, v6
    v_lshlrev_b32 v58, 13, v58
    v_lshl_add_u32 v58, v59, 4, v58
    s_lshl_b32 s47, s44, 9
    v_add_u32 v58, s47, v58
    v_xor_b32 v7, v7, v6
    v_xor_b32 v6, 0, v7
    v_lshl_add_u32 v6, v6, 5, v58
    v_add_u32 v18, 0, v6
    v_xor_b32 v6, 2, v7
    v_lshl_add_u32 v6, v6, 5, v58
    v_add_u32 v19, 15360, v6
    v_xor_b32 v6, 0, v7
    v_lshl_add_u32 v6, v6, 5, v58
    v_add_u32 v20, 30720, v6
    v_xor_b32 v6, 2, v7
    v_lshl_add_u32 v6, v6, 5, v58
    v_add_u32 v21, 46080, v6
    v_xor_b32 v6, 4, v7
    v_lshl_add_u32 v6, v6, 5, v58
    v_add_u32 v22, 65536, v6
    v_xor_b32 v6, 6, v7
    v_lshl_add_u32 v6, v6, 5, v58
    v_add_u32 v23, 80896, v6
    v_xor_b32 v6, 4, v7
    v_lshl_add_u32 v6, v6, 5, v58
    v_add_u32 v24, 96256, v6
    v_xor_b32 v6, 6, v7
    v_lshl_add_u32 v6, v6, 5, v58
    v_add_u32 v25, 111616, v6
    s_lshl_b32 s48, s30, 13
    s_mov_b32 s49, 0
    s_mov_b32 s50, 0
    s_waitcnt lgkmcnt(0)
    s_mov_b32 s24, s36
    s_and_b32 s25, s37, 0xffff
    s_mov_b32 s26, 0x400000
    s_mov_b32 s27, 0x00020000
    buffer_load_dwordx4 v[64:67], v62, s[24:27], s52 offen offset:0
    buffer_load_dwordx4 v[68:71], v62, s[24:27], s52 offen offset:512
    buffer_load_dwordx4 v[72:75], v62, s[24:27], s52 offen offset:1024
    buffer_load_dwordx4 v[76:79], v62, s[24:27], s52 offen offset:1536
    s_mov_b32 s16, s38
    s_and_b32 s17, s39, 0xffff
    s_mov_b32 s18, 0x200000
    s_mov_b32 s19, 0x00020000
    s_cmp_eq_u32 s57, 0
    s_cselect_b32 s20, s40, s42
    s_cselect_b32 s21, s41, s43
    s_and_b32 s21, s21, 0xffff
    s_mov_b32 s22, 0x400000
    s_mov_b32 s23, 0x00020000
    s_add_u32 m0, s48, 0
    s_nop 0
    buffer_load_dwordx4 v10, s[16:19], s49 offen offset:0 lds
    buffer_load_dwordx4 v11, s[16:19], s49 offen offset:1024 lds
    buffer_load_dwordx4 v12, s[16:19], s49 offen offset:2048 lds
    buffer_load_dwordx4 v13, s[16:19], s49 offen offset:3072 lds
    s_add_u32 m0, s48, 65536
    s_nop 0
    buffer_load_dwordx4 v18, s[20:23], s50 offen offset:0 lds
    buffer_load_dwordx4 v19, s[20:23], s50 offen offset:1024 lds
    buffer_load_dwordx4 v20, s[20:23], s50 offen offset:2048 lds
    buffer_load_dwordx4 v21, s[20:23], s50 offen offset:3072 lds
    s_mov_b64 s[6:7], s[62:63]
    s_add_u32 s8, s6, 0x0
    s_addc_u32 s9, s7, 0
    s_and_b32 s9, s9, 0xffff
    s_mov_b32 s10, 0x400000
    s_mov_b32 s11, 0x00020000
    s_mov_b32 s12, s4
    s_and_b32 s13, s5, 0xffff
    s_mov_b32 s14, 0x800000
    s_mov_b32 s15, 0x00020000
    s_add_u32 s32, s6, 0x1000000
    s_addc_u32 s33, s7, 0
    s_and_b32 s33, s33, 0xffff
    s_mov_b32 s34, 0x2000000
    s_mov_b32 s35, 0x00020000
    s_mov_b32 s24, s60
    s_and_b32 s25, s61, 0xffff
    s_mov_b32 s26, 0x100
    s_mov_b32 s27, 0x00020000
    s_lshl_b32 s28, s58, 2
    s_and_b32 s31, s59, 3
    s_add_u32 s28, s28, s31
    s_lshr_b32 s29, s59, 2
    s_lshl_b32 s42, s29, 7
    s_sub_u32 s43, 1920, s42
    s_lshl_b32 s31, s30, 4
    s_add_u32 s38, s42, s31
    s_add_u32 s39, s43, s31
    s_lshl_b32 s60, s30, 12
    s_mov_b32 s61, 0
    s_mov_b32 s62, 0
    s_lshl_b32 s47, s44, 1
    s_lshr_b32 s52, s30, 1
    s_add_u32 s47, s47, s52
    s_lshl_b32 s47, s47, 14
    s_lshl_b32 s52, s45, 1
    s_and_b32 s53, s30, 1
    s_add_u32 s52, s52, s53
    s_lshl_b32 s52, s52, 20
    s_add_u32 s47, s47, s52
    s_lshl_b32 s52, s57, 24
    s_add_u32 s47, s47, s52
    s_lshl_b32 s54, s44, 8
    s_lshr_b32 s55, s28, 1
    s_lshl_b32 s55, s55, 8
    s_and_b32 s53, s59, 3
    s_add_u32 s53, s53, 1
    s_cmp_eq_u32 s30, 0
    s_cselect_b32 s53, s53, -1
    s_cselect_b32 s46, 6, -1
    v_lshlrev_b32 v6, 13, v56
    v_lshl_add_u32 v50, v57, 7, v6
    s_lshl_b32 s56, s30, 5
    s_add_u32 s56, s56, s59
    s_lshl_b32 s56, s56, 16
    s_lshl_b32 s52, s58, 10
    s_add_u32 s56, s56, s52
    s_add_u32 s63, s30, 1
    v_mul_u32_u24 v6, 2064, v60
    v_lshl_add_u32 v6, v61, 4, v6
    v_add_u32 v54, 131072, v6
    v_mul_u32_u24 v7, 2064, v57
    v_lshl_add_u32 v7, v56, 4, v7
    v_lshl_add_u32 v7, v2, 9, v7
    v_add_u32 v55, 131072, v7
    v_lshrrev_b32 v7, 2, v56
    v_lshl_add_u32 v7, v2, 3, v7
    v_lshlrev_b32 v7, 17, v7
    v_and_b32 v6, 3, v56
    v_lshl_add_u32 v7, v6, 8, v7
    v_lshl_add_u32 v7, v57, 4, v7
    s_lshr_b32 s52, s2, 1
    s_lshl_b32 s52, s52, 10
    s_and_b32 s31, s2, 1
    s_lshl_b32 s31, s31, 7
    s_add_u32 s52, s52, s31
    v_add_u32 v53, s52, v7
    v_and_b32 v56, 15, v3
    v_lshrrev_b32 v57, 4, v3
    v_lshrrev_b32 v6, 1, v56
    v_xor_b32 v6, v6, v57
    v_and_b32 v7, 1, v2
    v_lshl_add_u32 v7, v7, 7, v56
    v_lshlrev_b32 v7, 7, v7
    v_lshl_add_u32 v26, v6, 4, v7
    v_xor_b32 v27, 64, v26
    v_lshrrev_b32 v6, 2, v56
    v_and_b32 v58, 1, v57
    v_lshl_add_u32 v58, v58, 2, v6
    v_lshl_add_u32 v59, v57, 3, v6
    v_and_b32 v63, 3, v3
    v_lshlrev_b32 v7, 9, v59
    v_lshrrev_b32 v6, 1, v2
    v_lshl_add_u32 v7, v6, 8, v7
    v_lshl_add_u32 v7, v63, 3, v7
    v_add_u32 v7, 65536, v7
    v_lshlrev_b32 v59, 8, v59
    v_lshl_add_u32 v59, v63, 3, v59
    v_add_u32 v59, 98304, v59
    v_xor_b32 v6, 0, v58
    v_lshl_add_u32 v28, v6, 5, v7
    v_lshl_add_u32 v42, v6, 5, v59
    v_xor_b32 v6, 1, v58
    v_lshl_add_u32 v29, v6, 5, v7
    v_lshl_add_u32 v43, v6, 5, v59
    v_xor_b32 v6, 2, v58
    v_lshl_add_u32 v30, v6, 5, v7
    v_lshl_add_u32 v44, v6, 5, v59
    v_xor_b32 v6, 3, v58
    v_lshl_add_u32 v31, v6, 5, v7
    v_lshl_add_u32 v45, v6, 5, v59
    v_xor_b32 v6, 4, v58
    v_lshl_add_u32 v32, v6, 5, v7
    v_lshl_add_u32 v46, v6, 5, v59
    v_xor_b32 v6, 5, v58
    v_lshl_add_u32 v33, v6, 5, v7
    v_lshl_add_u32 v47, v6, 5, v59
    v_xor_b32 v6, 6, v58
    v_lshl_add_u32 v34, v6, 5, v7
    v_lshl_add_u32 v48, v6, 5, v59
    v_xor_b32 v6, 7, v58
    v_lshl_add_u32 v35, v6, 5, v7
    v_lshl_add_u32 v49, v6, 5, v59
    s_lshl_b32 s31, s38, 6
    v_add_u32 v36, s31, v1
    s_lshl_b32 s31, s39, 6
    v_add_u32 v37, s31, v1
    v_bfe_u32 v6, v3, 1, 3
    v_and_b32 v7, 1, v3
    v_lshl_add_u32 v58, v2, 4, v57
    v_lshlrev_b32 v58, 13, v58
    v_lshl_add_u32 v58, v7, 4, v58
    s_lshl_b32 s31, s28, 8
    v_add_u32 v58, s31, v58
    v_xor_b32 v6, v6, v57
    v_xor_b32 v7, 0, v6
    v_lshl_add_u32 v7, v7, 5, v58
    v_add_u32 v38, 0, v7
    v_xor_b32 v7, 0, v6
    v_lshl_add_u32 v7, v7, 5, v58
    v_add_u32 v39, 31744, v7
    v_xor_b32 v7, 4, v6
    v_lshl_add_u32 v7, v7, 5, v58
    v_add_u32 v40, 63488, v7
    v_xor_b32 v7, 4, v6
    v_lshl_add_u32 v7, v7, 5, v58
    v_add_u32 v41, 95232, v7
    v_lshlrev_b32 v6, 2, v57
    v_sub_u32 v4, v56, v6
    v_mov_b32 v5, 0xff800000
    v_mov_b32 v8, 0
    v_mov_b32 v9, 1
    s_lshl_b32 s52, s59, 2
    s_add_u32 s52, s52, s30
    v_and_b32 v6, 1, v3
    v_lshl_add_u32 v6, s52, 1, v6
    s_getpc_b64 s[40:41]
pc_4:
    s_add_u32 s40, s40, k12_qcode-pc_4
    s_addc_u32 s41, s41, 0
    v_lshlrev_b32 v2, 7, v6
    v_mov_b32 v3, s41
    v_add_co_u32 v2, vcc, s40, v2
    s_nop 1
    v_addc_co_u32 v3, vcc, 0, v3, vcc
    v_mov_b32 v56, 0
    v_mov_b32 v57, 0
    v_mov_b32 v58, 0
    v_mov_b32 v59, 0
    s_nop 1
    v_mfma_f32_32x32x16_bf16 a[128:143], v[56:59], v[56:59], 0
    v_mfma_f32_32x32x16_bf16 a[144:159], v[56:59], v[56:59], 0
    v_mfma_f32_32x32x16_bf16 a[160:175], v[56:59], v[56:59], 0
    v_mfma_f32_32x32x16_bf16 a[176:191], v[56:59], v[56:59], 0
    v_mfma_f32_32x32x16_bf16 v[128:143], v[56:59], v[56:59], 0
    v_mfma_f32_32x32x16_bf16 v[144:159], v[56:59], v[56:59], 0
    v_mfma_f32_32x32x16_bf16 v[160:175], v[56:59], v[56:59], 0
    v_mfma_f32_32x32x16_bf16 v[176:191], v[56:59], v[56:59], 0
    v_mfma_f32_32x32x16_bf16 v[192:207], v[56:59], v[56:59], 0
    v_mfma_f32_32x32x16_bf16 v[208:223], v[56:59], v[56:59], 0
    v_mfma_f32_32x32x16_bf16 v[224:239], v[56:59], v[56:59], 0
    v_mfma_f32_32x32x16_bf16 v[240:255], v[56:59], v[56:59], 0
    s_add_u32 m0, s48, 4096
    s_nop 0
    buffer_load_dwordx4 v14, s[16:19], s49 offen offset:0 lds
    buffer_load_dwordx4 v15, s[16:19], s49 offen offset:1024 lds
    buffer_load_dwordx4 v16, s[16:19], s49 offen offset:2048 lds
    buffer_load_dwordx4 v17, s[16:19], s49 offen offset:3072 lds
    s_add_u32 s49, s49, 128
    s_add_u32 m0, s48, 69632
    s_nop 0
    buffer_load_dwordx4 v22, s[20:23], s50 offen offset:0 lds
    buffer_load_dwordx4 v23, s[20:23], s50 offen offset:1024 lds
    buffer_load_dwordx4 v24, s[20:23], s50 offen offset:2048 lds
    buffer_load_dwordx4 v25, s[20:23], s50 offen offset:3072 lds
    s_add_u32 s50, s50, 0x80000
    s_waitcnt vmcnt(16)
    v_lshlrev_b32 v80, 16, v64
    v_and_b32 v81, 0xffff0000, v64
    v_lshlrev_b32 v82, 16, v65
    v_and_b32 v83, 0xffff0000, v65
    v_lshlrev_b32 v84, 16, v66
    v_and_b32 v85, 0xffff0000, v66
    v_lshlrev_b32 v86, 16, v67
    v_and_b32 v87, 0xffff0000, v67
    v_lshlrev_b32 v88, 16, v68
    v_and_b32 v89, 0xffff0000, v68
    v_lshlrev_b32 v90, 16, v69
    v_and_b32 v91, 0xffff0000, v69
    v_lshlrev_b32 v92, 16, v70
    v_and_b32 v93, 0xffff0000, v70
    v_lshlrev_b32 v94, 16, v71
    v_and_b32 v95, 0xffff0000, v71
    v_lshlrev_b32 v96, 16, v72
    v_and_b32 v97, 0xffff0000, v72
    v_lshlrev_b32 v98, 16, v73
    v_and_b32 v99, 0xffff0000, v73
    v_lshlrev_b32 v100, 16, v74
    v_and_b32 v101, 0xffff0000, v74
    v_lshlrev_b32 v102, 16, v75
    v_and_b32 v103, 0xffff0000, v75
    v_lshlrev_b32 v104, 16, v76
    v_and_b32 v105, 0xffff0000, v76
    v_lshlrev_b32 v106, 16, v77
    v_and_b32 v107, 0xffff0000, v77
    v_lshlrev_b32 v108, 16, v78
    v_and_b32 v109, 0xffff0000, v78
    v_lshlrev_b32 v110, 16, v79
    v_and_b32 v111, 0xffff0000, v79
    v_pk_add_f32 v[112:113], v[80:81], v[82:83]
    v_pk_add_f32 v[114:115], v[84:85], v[86:87]
    v_pk_add_f32 v[112:113], v[112:113], v[88:89]
    v_pk_add_f32 v[114:115], v[114:115], v[90:91]
    v_pk_add_f32 v[112:113], v[112:113], v[92:93]
    v_pk_add_f32 v[114:115], v[114:115], v[94:95]
    v_pk_add_f32 v[112:113], v[112:113], v[96:97]
    v_pk_add_f32 v[114:115], v[114:115], v[98:99]
    v_pk_add_f32 v[112:113], v[112:113], v[100:101]
    v_pk_add_f32 v[114:115], v[114:115], v[102:103]
    v_pk_add_f32 v[112:113], v[112:113], v[104:105]
    v_pk_add_f32 v[114:115], v[114:115], v[106:107]
    s_add_u32 m0, s48, 32768
    s_nop 0
    buffer_load_dwordx4 v10, s[16:19], s49 offen offset:0 lds
    buffer_load_dwordx4 v11, s[16:19], s49 offen offset:1024 lds
    buffer_load_dwordx4 v12, s[16:19], s49 offen offset:2048 lds
    buffer_load_dwordx4 v13, s[16:19], s49 offen offset:3072 lds
    v_pk_add_f32 v[112:113], v[112:113], v[108:109]
    v_pk_add_f32 v[114:115], v[114:115], v[110:111]
    v_pk_add_f32 v[112:113], v[112:113], v[114:115]
    v_add_f32 v112, v112, v113
    s_nop 1
    v_add_f32_dpp v112, v112, v112 quad_perm:[1,0,3,2] row_mask:0xf bank_mask:0xf
    s_nop 1
    v_add_f32_dpp v112, v112, v112 quad_perm:[2,3,0,1] row_mask:0xf bank_mask:0xf
    s_nop 1
    v_add_f32_dpp v112, v112, v112 row_half_mirror row_mask:0xf bank_mask:0xf
    s_nop 1
    v_add_f32_dpp v112, v112, v112 row_mirror row_mask:0xf bank_mask:0xf
    v_mov_b32 v114, v112
    s_nop 1
    v_permlane16_swap_b32 v112, v114
    s_nop 1
    v_add_f32 v112, v112, v114
    v_mul_f32 v112, 0xba800000, v112
    v_mov_b32 v113, v112
    v_pk_add_f32 v[114:115], v[80:81], v[112:113]
    v_pk_add_f32 v[118:119], v[82:83], v[112:113]
    v_pk_mul_f32 v[116:117], v[114:115], v[114:115]
    v_pk_fma_f32 v[116:117], v[118:119], v[118:119], v[116:117]
    v_pk_add_f32 v[114:115], v[84:85], v[112:113]
    v_pk_add_f32 v[118:119], v[86:87], v[112:113]
    v_pk_fma_f32 v[116:117], v[114:115], v[114:115], v[116:117]
    v_pk_fma_f32 v[116:117], v[118:119], v[118:119], v[116:117]
    v_pk_add_f32 v[114:115], v[88:89], v[112:113]
    v_pk_add_f32 v[118:119], v[90:91], v[112:113]
    v_pk_fma_f32 v[116:117], v[114:115], v[114:115], v[116:117]
    v_pk_fma_f32 v[116:117], v[118:119], v[118:119], v[116:117]
    v_pk_add_f32 v[114:115], v[92:93], v[112:113]
    v_pk_add_f32 v[118:119], v[94:95], v[112:113]
    v_pk_fma_f32 v[116:117], v[114:115], v[114:115], v[116:117]
    v_pk_fma_f32 v[116:117], v[118:119], v[118:119], v[116:117]
    v_pk_add_f32 v[114:115], v[96:97], v[112:113]
    v_pk_add_f32 v[118:119], v[98:99], v[112:113]
    v_pk_fma_f32 v[116:117], v[114:115], v[114:115], v[116:117]
    v_pk_fma_f32 v[116:117], v[118:119], v[118:119], v[116:117]
    v_pk_add_f32 v[114:115], v[100:101], v[112:113]
    v_pk_add_f32 v[118:119], v[102:103], v[112:113]
    v_pk_fma_f32 v[116:117], v[114:115], v[114:115], v[116:117]
    v_pk_fma_f32 v[116:117], v[118:119], v[118:119], v[116:117]
    v_pk_add_f32 v[114:115], v[104:105], v[112:113]
    s_add_u32 m0, s48, 98304
    s_nop 0
    buffer_load_dwordx4 v18, s[20:23], s50 offen offset:0 lds
    buffer_load_dwordx4 v19, s[20:23], s50 offen offset:1024 lds
    buffer_load_dwordx4 v20, s[20:23], s50 offen offset:2048 lds
    buffer_load_dwordx4 v21, s[20:23], s50 offen offset:3072 lds
    v_pk_add_f32 v[118:119], v[106:107], v[112:113]
    v_pk_fma_f32 v[116:117], v[114:115], v[114:115], v[116:117]
    v_pk_fma_f32 v[116:117], v[118:119], v[118:119], v[116:117]
    v_pk_add_f32 v[114:115], v[108:109], v[112:113]
    v_pk_add_f32 v[118:119], v[110:111], v[112:113]
    v_pk_fma_f32 v[116:117], v[114:115], v[114:115], v[116:117]
    v_pk_fma_f32 v[116:117], v[118:119], v[118:119], v[116:117]
    v_add_f32 v116, v116, v117
    s_nop 1
    v_add_f32_dpp v116, v116, v116 quad_perm:[1,0,3,2] row_mask:0xf bank_mask:0xf
    s_nop 1
    v_add_f32_dpp v116, v116, v116 quad_perm:[2,3,0,1] row_mask:0xf bank_mask:0xf
    s_nop 1
    v_add_f32_dpp v116, v116, v116 row_half_mirror row_mask:0xf bank_mask:0xf
    s_nop 1
    v_add_f32_dpp v116, v116, v116 row_mirror row_mask:0xf bank_mask:0xf
    v_mov_b32 v114, v116
    s_nop 1
    v_permlane16_swap_b32 v116, v114
    s_nop 1
    v_add_f32 v116, v116, v114
    v_mul_f32 v116, 0x3a800000, v116
    v_cvt_pk_bf16_f32 v118, v112, v116
    v_and_b32 v116, 0xffff0000, v118
    v_lshlrev_b32 v118, 16, v118
    v_add_f32 v116, 0x3727c5ac, v116
    v_mov_b32 v119, v118
    v_cvt_pk_bf16_f32 v116, v116, v116
    v_and_b32 v116, 0xffff0000, v116
    v_sqrt_f32 v116, v116
    v_pk_add_f32 v[80:81], v[80:81], v[118:119]
    v_pk_add_f32 v[82:83], v[82:83], v[118:119]
    v_pk_add_f32 v[84:85], v[84:85], v[118:119]
    v_pk_add_f32 v[86:87], v[86:87], v[118:119]
    v_pk_add_f32 v[88:89], v[88:89], v[118:119]
    v_pk_add_f32 v[90:91], v[90:91], v[118:119]
    v_pk_add_f32 v[92:93], v[92:93], v[118:119]
    v_pk_add_f32 v[94:95], v[94:95], v[118:119]
    v_pk_add_f32 v[96:97], v[96:97], v[118:119]
    v_pk_add_f32 v[98:99], v[98:99], v[118:119]
    v_pk_add_f32 v[100:101], v[100:101], v[118:119]
    v_pk_add_f32 v[102:103], v[102:103], v[118:119]
    v_pk_add_f32 v[104:105], v[104:105], v[118:119]
    s_add_u32 m0, s48, 36864
    s_nop 0
    buffer_load_dwordx4 v14, s[16:19], s49 offen offset:0 lds
    buffer_load_dwordx4 v15, s[16:19], s49 offen offset:1024 lds
    buffer_load_dwordx4 v16, s[16:19], s49 offen offset:2048 lds
    buffer_load_dwordx4 v17, s[16:19], s49 offen offset:3072 lds
    s_add_u32 s49, s49, 128
    v_pk_add_f32 v[106:107], v[106:107], v[118:119]
    v_pk_add_f32 v[108:109], v[108:109], v[118:119]
    v_pk_add_f32 v[110:111], v[110:111], v[118:119]
    v_cvt_pk_bf16_f32 v116, v116, v116
    v_and_b32 v116, 0xffff0000, v116
    v_rcp_f32 v116, v116
    v_cvt_pk_bf16_f32 v64, v80, v81
    v_cvt_pk_bf16_f32 v65, v82, v83
    v_cvt_pk_bf16_f32 v66, v84, v85
    v_cvt_pk_bf16_f32 v67, v86, v87
    v_cvt_pk_bf16_f32 v68, v88, v89
    v_cvt_pk_bf16_f32 v69, v90, v91
    v_cvt_pk_bf16_f32 v70, v92, v93
    v_cvt_pk_bf16_f32 v71, v94, v95
    v_cvt_pk_bf16_f32 v72, v96, v97
    v_cvt_pk_bf16_f32 v73, v98, v99
    v_cvt_pk_bf16_f32 v74, v100, v101
    v_cvt_pk_bf16_f32 v75, v102, v103
    v_cvt_pk_bf16_f32 v76, v104, v105
    v_cvt_pk_bf16_f32 v77, v106, v107
    v_cvt_pk_bf16_f32 v78, v108, v109
    v_cvt_pk_bf16_f32 v79, v110, v111
    v_mov_b32 v117, v116
    v_lshlrev_b32 v80, 16, v64
    v_and_b32 v81, 0xffff0000, v64
    v_lshlrev_b32 v82, 16, v65
    v_and_b32 v83, 0xffff0000, v65
    v_lshlrev_b32 v84, 16, v66
    v_and_b32 v85, 0xffff0000, v66
    v_lshlrev_b32 v86, 16, v67
    v_and_b32 v87, 0xffff0000, v67
    v_lshlrev_b32 v88, 16, v68
    v_and_b32 v89, 0xffff0000, v68
    v_lshlrev_b32 v90, 16, v69
    v_and_b32 v91, 0xffff0000, v69
    v_lshlrev_b32 v92, 16, v70
    v_and_b32 v93, 0xffff0000, v70
    v_lshlrev_b32 v94, 16, v71
    v_and_b32 v95, 0xffff0000, v71
    v_lshlrev_b32 v96, 16, v72
    v_and_b32 v97, 0xffff0000, v72
    v_lshlrev_b32 v98, 16, v73
    v_and_b32 v99, 0xffff0000, v73
    v_lshlrev_b32 v100, 16, v74
    s_add_u32 m0, s48, 102400
    s_nop 0
    buffer_load_dwordx4 v22, s[20:23], s50 offen offset:0 lds
    buffer_load_dwordx4 v23, s[20:23], s50 offen offset:1024 lds
    buffer_load_dwordx4 v24, s[20:23], s50 offen offset:2048 lds
    buffer_load_dwordx4 v25, s[20:23], s50 offen offset:3072 lds
    s_add_u32 s50, s50, 0x80000
    v_and_b32 v101, 0xffff0000, v74
    v_lshlrev_b32 v102, 16, v75
    v_and_b32 v103, 0xffff0000, v75
    v_lshlrev_b32 v104, 16, v76
    v_and_b32 v105, 0xffff0000, v76
    v_lshlrev_b32 v106, 16, v77
    v_and_b32 v107, 0xffff0000, v77
    v_lshlrev_b32 v108, 16, v78
    v_and_b32 v109, 0xffff0000, v78
    v_lshlrev_b32 v110, 16, v79
    v_and_b32 v111, 0xffff0000, v79
    v_pk_mul_f32 v[80:81], v[80:81], v[116:117]
    v_pk_mul_f32 v[82:83], v[82:83], v[116:117]
    v_pk_mul_f32 v[84:85], v[84:85], v[116:117]
    v_pk_mul_f32 v[86:87], v[86:87], v[116:117]
    v_pk_mul_f32 v[88:89], v[88:89], v[116:117]
    v_pk_mul_f32 v[90:91], v[90:91], v[116:117]
    v_pk_mul_f32 v[92:93], v[92:93], v[116:117]
    v_pk_mul_f32 v[94:95], v[94:95], v[116:117]
    v_pk_mul_f32 v[96:97], v[96:97], v[116:117]
    v_pk_mul_f32 v[98:99], v[98:99], v[116:117]
    v_pk_mul_f32 v[100:101], v[100:101], v[116:117]
    v_pk_mul_f32 v[102:103], v[102:103], v[116:117]
    v_pk_mul_f32 v[104:105], v[104:105], v[116:117]
    v_pk_mul_f32 v[106:107], v[106:107], v[116:117]
    v_pk_mul_f32 v[108:109], v[108:109], v[116:117]
    v_pk_mul_f32 v[110:111], v[110:111], v[116:117]
    v_cvt_pk_bf16_f32 v64, v80, v81
    v_cvt_pk_bf16_f32 v65, v82, v83
    v_cvt_pk_bf16_f32 v66, v84, v85
    v_cvt_pk_bf16_f32 v67, v86, v87
    v_cvt_pk_bf16_f32 v68, v88, v89
    v_cvt_pk_bf16_f32 v69, v90, v91
    v_cvt_pk_bf16_f32 v70, v92, v93
    v_cvt_pk_bf16_f32 v71, v94, v95
    v_cvt_pk_bf16_f32 v72, v96, v97
    v_cvt_pk_bf16_f32 v73, v98, v99
    v_cvt_pk_bf16_f32 v74, v100, v101
    v_cvt_pk_bf16_f32 v75, v102, v103
    v_cvt_pk_bf16_f32 v76, v104, v105
    v_cvt_pk_bf16_f32 v77, v106, v107
    v_cvt_pk_bf16_f32 v78, v108, v109
    v_cvt_pk_bf16_f32 v79, v110, v111
    ds_write_b128 v54, v[64:67] offset:0
    ds_write_b128 v54, v[68:71] offset:512
    ds_write_b128 v54, v[72:75] offset:1024
    ds_write_b128 v54, v[76:79] offset:1536
    s_waitcnt vmcnt(16) lgkmcnt(0)
    s_barrier
    ds_read_b128 a[64:67], v55 offset:0
    ds_read_b128 a[68:71], v55 offset:128
    ds_read_b128 a[72:75], v55 offset:256
    ds_read_b128 a[76:79], v55 offset:384
    v_add_u32 v54, 4096, v36
    v_add_u32 v55, 4096, v37
    v_mfma_f32_32x32x16_bf16 v[64:79], v[56:59], v[56:59], 0
    v_mfma_f32_32x32x16_bf16 v[80:95], v[56:59], v[56:59], 0
    v_mfma_f32_32x32x16_bf16 v[96:111], v[56:59], v[56:59], 0
    v_mfma_f32_32x32x16_bf16 v[112:127], v[56:59], v[56:59], 0
    s_cmp_ge_u32 s2, 22
    s_cbranch_scc1 k12_nostat_5
    s_lshl_b32 s52, s2, 12
    s_add_u32 s52, s52, 0x3800000
    s_mov_b32 s34, -1
    v_lshlrev_b32 v6, 4, v0
    buffer_store_dwordx4 v[56:59], v6, s[32:35], s52 offen sc1
    s_mov_b32 s34, 0x2000000
k12_nostat_5:
    ds_read_b128 a[192:195], v26 offset:0
    ds_read_b64_tr_b16 a[0:1], v28 offset:0
    ds_read_b128 a[196:199], v27 offset:0
    ds_read_b64_tr_b16 a[2:3], v28 offset:2048
    ds_read_b128 a[200:203], v26 offset:2048
    ds_read_b64_tr_b16 a[4:5], v28 offset:16384
    ds_read_b128 a[204:207], v27 offset:2048
    ds_read_b64_tr_b16 a[6:7], v28 offset:18432
    ds_read_b128 a[208:211], v26 offset:4096
    ds_read_b64_tr_b16 a[8:9], v29 offset:0
    ds_read_b128 a[212:215], v27 offset:4096
    ds_read_b64_tr_b16 a[10:11], v29 offset:2048
    ds_read_b128 a[216:219], v26 offset:6144
    ds_read_b64_tr_b16 a[12:13], v29 offset:16384
    ds_read_b128 a[220:223], v27 offset:6144
    ds_read_b64_tr_b16 a[14:15], v29 offset:18432
    ds_read_b128 a[224:227], v26 offset:8192
    ds_read_b64_tr_b16 a[16:17], v30 offset:0
    ds_read_b128 a[228:231], v27 offset:8192
    ds_read_b64_tr_b16 a[18:19], v30 offset:2048
    ds_read_b128 a[232:235], v26 offset:10240
    ds_read_b64_tr_b16 a[20:21], v30 offset:16384
    ds_read_b128 a[236:239], v27 offset:10240
    ds_read_b64_tr_b16 a[22:23], v30 offset:18432
    ds_read_b128 a[240:243], v26 offset:12288
    ds_read_b64_tr_b16 a[24:25], v31 offset:0
    ds_read_b128 a[244:247], v27 offset:12288
    ds_read_b64_tr_b16 a[26:27], v31 offset:2048
    ds_read_b128 a[248:251], v26 offset:14336
    ds_read_b64_tr_b16 a[28:29], v31 offset:16384
    ds_read_b128 a[252:255], v27 offset:14336
    ds_read_b64_tr_b16 a[30:31], v31 offset:18432
    s_mov_b32 s51, 0
    s_waitcnt lgkmcnt(15)
    s_mov_b32 s52, 0
    buffer_store_dwordx4 a[64:67], v53, s[8:11], s52 offen sc1
    s_mov_b32 s52, 262144
    buffer_store_dwordx4 a[68:71], v53, s[8:11], s52 offen sc1
    s_mov_b32 s52, 524288
    buffer_store_dwordx4 a[72:75], v53, s[8:11], s52 offen sc1
    s_mov_b32 s52, 786432
    buffer_store_dwordx4 a[76:79], v53, s[8:11], s52 offen sc1
    s_waitcnt lgkmcnt(0)
    s_cmp_lg_u32 s57, 0
    s_cbranch_scc1 k12_v_6
k12_loop_8:
    v_mfma_f32_16x16x32_bf16 v[64:67], a[0:3], a[192:195], v[64:67]
    v_mfma_f32_16x16x32_bf16 v[64:67], a[4:7], a[196:199], v[64:67]
    ds_read_b64_tr_b16 a[32:33], v32 offset:0
    v_mfma_f32_16x16x32_bf16 v[80:83], a[0:3], a[200:203], v[80:83]
    v_mfma_f32_16x16x32_bf16 v[80:83], a[4:7], a[204:207], v[80:83]
    ds_read_b64_tr_b16 a[34:35], v32 offset:2048
    v_mfma_f32_16x16x32_bf16 v[96:99], a[0:3], a[208:211], v[96:99]
    s_cmp_eq_u32 s51, s46
    s_cbranch_scc1 k12_ool_10
k12_oolret_11:
    v_mfma_f32_16x16x32_bf16 v[96:99], a[4:7], a[212:215], v[96:99]
    v_mfma_f32_16x16x32_bf16 v[112:115], a[0:3], a[216:219], v[112:115]
    ds_read_b64_tr_b16 a[36:37], v32 offset:16384
    v_mfma_f32_16x16x32_bf16 v[112:115], a[4:7], a[220:223], v[112:115]
    v_mfma_f32_16x16x32_bf16 v[128:131], a[0:3], a[224:227], v[128:131]
    v_mfma_f32_16x16x32_bf16 v[128:131], a[4:7], a[228:231], v[128:131]
    ds_read_b64_tr_b16 a[38:39], v32 offset:18432
    v_mfma_f32_16x16x32_bf16 v[144:147], a[0:3], a[232:235], v[144:147]
    v_mfma_f32_16x16x32_bf16 v[144:147], a[4:7], a[236:239], v[144:147]
    v_mfma_f32_16x16x32_bf16 a[128:131], a[0:3], a[240:243], a[128:131]
    ds_read_b64_tr_b16 a[40:41], v33 offset:0
    v_mfma_f32_16x16x32_bf16 a[128:131], a[4:7], a[244:247], a[128:131]
    v_mfma_f32_16x16x32_bf16 a[160:163], a[0:3], a[248:251], a[160:163]
    v_mfma_f32_16x16x32_bf16 a[160:163], a[4:7], a[252:255], a[160:163]
    ds_read_b64_tr_b16 a[42:43], v33 offset:2048
    v_mfma_f32_16x16x32_bf16 v[160:163], a[8:11], a[192:195], v[160:163]
    v_mfma_f32_16x16x32_bf16 v[160:163], a[12:15], a[196:199], v[160:163]
    v_mfma_f32_16x16x32_bf16 v[176:179], a[8:11], a[200:203], v[176:179]
    ds_read_b64_tr_b16 a[44:45], v33 offset:16384
    v_mfma_f32_16x16x32_bf16 v[176:179], a[12:15], a[204:207], v[176:179]
    v_mfma_f32_16x16x32_bf16 v[192:195], a[8:11], a[208:211], v[192:195]
    v_mfma_f32_16x16x32_bf16 v[192:195], a[12:15], a[212:215], v[192:195]
    ds_read_b64_tr_b16 a[46:47], v33 offset:18432
    v_mfma_f32_16x16x32_bf16 v[208:211], a[8:11], a[216:219], v[208:211]
    v_mfma_f32_16x16x32_bf16 v[208:211], a[12:15], a[220:223], v[208:211]
    ds_read_b64_tr_b16 a[48:49], v34 offset:0
    v_mfma_f32_16x16x32_bf16 v[224:227], a[8:11], a[224:227], v[224:227]
    v_mfma_f32_16x16x32_bf16 v[224:227], a[12:15], a[228:231], v[224:227]
    v_mfma_f32_16x16x32_bf16 v[240:243], a[8:11], a[232:235], v[240:243]
    ds_read_b64_tr_b16 a[50:51], v34 offset:2048
    v_mfma_f32_16x16x32_bf16 v[240:243], a[12:15], a[236:239], v[240:243]
    v_mfma_f32_16x16x32_bf16 a[132:135], a[8:11], a[240:243], a[132:135]
    v_mfma_f32_16x16x32_bf16 a[132:135], a[12:15], a[244:247], a[132:135]
    ds_read_b64_tr_b16 a[52:53], v34 offset:16384
    v_mfma_f32_16x16x32_bf16 a[164:167], a[8:11], a[248:251], a[164:167]
    v_mfma_f32_16x16x32_bf16 a[164:167], a[12:15], a[252:255], a[164:167]
    v_mfma_f32_16x16x32_bf16 v[68:71], a[16:19], a[192:195], v[68:71]
    ds_read_b64_tr_b16 a[54:55], v34 offset:18432
    v_mfma_f32_16x16x32_bf16 v[68:71], a[20:23], a[196:199], v[68:71]
    v_mfma_f32_16x16x32_bf16 v[84:87], a[16:19], a[200:203], v[84:87]
    v_mfma_f32_16x16x32_bf16 v[84:87], a[20:23], a[204:207], v[84:87]
    ds_read_b64_tr_b16 a[56:57], v35 offset:0
    v_mfma_f32_16x16x32_bf16 v[100:103], a[16:19], a[208:211], v[100:103]
    v_mfma_f32_16x16x32_bf16 v[100:103], a[20:23], a[212:215], v[100:103]
    v_mfma_f32_16x16x32_bf16 v[116:119], a[16:19], a[216:219], v[116:119]
    ds_read_b64_tr_b16 a[58:59], v35 offset:2048
    v_mfma_f32_16x16x32_bf16 v[116:119], a[20:23], a[220:223], v[116:119]
    v_mfma_f32_16x16x32_bf16 v[132:135], a[16:19], a[224:227], v[132:135]
    v_mfma_f32_16x16x32_bf16 v[132:135], a[20:23], a[228:231], v[132:135]
    ds_read_b64_tr_b16 a[60:61], v35 offset:16384
    v_mfma_f32_16x16x32_bf16 v[148:151], a[16:19], a[232:235], v[148:151]
    v_mfma_f32_16x16x32_bf16 v[148:151], a[20:23], a[236:239], v[148:151]
    v_mfma_f32_16x16x32_bf16 a[136:139], a[16:19], a[240:243], a[136:139]
    ds_read_b64_tr_b16 a[62:63], v35 offset:18432
    v_mfma_f32_16x16x32_bf16 a[136:139], a[20:23], a[244:247], a[136:139]
    v_mfma_f32_16x16x32_bf16 a[168:171], a[16:19], a[248:251], a[168:171]
    v_mfma_f32_16x16x32_bf16 a[168:171], a[20:23], a[252:255], a[168:171]
    v_mfma_f32_16x16x32_bf16 v[164:167], a[24:27], a[192:195], v[164:167]
    v_mfma_f32_16x16x32_bf16 v[164:167], a[28:31], a[196:199], v[164:167]
    v_mfma_f32_16x16x32_bf16 v[180:183], a[24:27], a[200:203], v[180:183]
    v_mfma_f32_16x16x32_bf16 v[180:183], a[28:31], a[204:207], v[180:183]
    v_mfma_f32_16x16x32_bf16 v[196:199], a[24:27], a[208:211], v[196:199]
    v_mfma_f32_16x16x32_bf16 v[196:199], a[28:31], a[212:215], v[196:199]
    v_mfma_f32_16x16x32_bf16 v[212:215], a[24:27], a[216:219], v[212:215]
    v_mfma_f32_16x16x32_bf16 v[212:215], a[28:31], a[220:223], v[212:215]
    v_mfma_f32_16x16x32_bf16 v[228:231], a[24:27], a[224:227], v[228:231]
    v_mfma_f32_16x16x32_bf16 v[228:231], a[28:31], a[228:231], v[228:231]
    v_mfma_f32_16x16x32_bf16 v[244:247], a[24:27], a[232:235], v[244:247]
    v_mfma_f32_16x16x32_bf16 v[244:247], a[28:31], a[236:239], v[244:247]
    v_mfma_f32_16x16x32_bf16 a[140:143], a[24:27], a[240:243], a[140:143]
    v_mfma_f32_16x16x32_bf16 a[140:143], a[28:31], a[244:247], a[140:143]
    v_mfma_f32_16x16x32_bf16 a[172:175], a[24:27], a[248:251], a[172:175]
    v_mfma_f32_16x16x32_bf16 a[172:175], a[28:31], a[252:255], a[172:175]
    s_waitcnt vmcnt(0) lgkmcnt(0)
    s_cmp_eq_u32 s51, s46
    s_cbranch_scc1 k12_ool_14
k12_oolret_15:
    s_barrier
    v_mfma_f32_16x16x32_bf16 v[72:75], a[32:35], a[192:195], v[72:75]
    s_cmp_ge_u32 s49, 1024
    s_cselect_b32 s18, 0, s18
    s_cselect_b32 s22, 0, s22
    v_mfma_f32_16x16x32_bf16 v[72:75], a[36:39], a[196:199], v[72:75]
    s_add_u32 m0, s48, 0
    ds_read_b128 a[64:67], v26 offset:32768
    v_mfma_f32_16x16x32_bf16 v[88:91], a[32:35], a[200:203], v[88:91]
    buffer_load_dwordx4 v10, s[16:19], s49 offen offset:0 lds
    ds_read_b64_tr_b16 a[0:1], v28 offset:32768
    v_mfma_f32_16x16x32_bf16 v[88:91], a[36:39], a[204:207], v[88:91]
    ds_read_b128 a[68:71], v27 offset:32768
    v_mfma_f32_16x16x32_bf16 v[104:107], a[32:35], a[208:211], v[104:107]
    buffer_load_dwordx4 v11, s[16:19], s49 offen offset:1024 lds
    v_mfma_f32_16x16x32_bf16 v[104:107], a[36:39], a[212:215], v[104:107]
    ds_read_b64_tr_b16 a[2:3], v28 offset:34816
    v_mfma_f32_16x16x32_bf16 v[120:123], a[32:35], a[216:219], v[120:123]
    v_mfma_f32_16x16x32_bf16 v[120:123], a[36:39], a[220:223], v[120:123]
    ds_read_b128 a[72:75], v26 offset:34816
    v_mfma_f32_16x16x32_bf16 v[136:139], a[32:35], a[224:227], v[136:139]
    buffer_load_dwordx4 v12, s[16:19], s49 offen offset:2048 lds
    ds_read_b64_tr_b16 a[4:5], v28 offset:49152
    v_mfma_f32_16x16x32_bf16 v[136:139], a[36:39], a[228:231], v[136:139]
    v_mfma_f32_16x16x32_bf16 v[152:155], a[32:35], a[232:235], v[152:155]
    ds_read_b128 a[76:79], v27 offset:34816
    v_mfma_f32_16x16x32_bf16 v[152:155], a[36:39], a[236:239], v[152:155]
    buffer_load_dwordx4 v13, s[16:19], s49 offen offset:3072 lds
    v_mfma_f32_16x16x32_bf16 a[144:147], a[32:35], a[240:243], a[144:147]
    ds_read_b64_tr_b16 a[6:7], v28 offset:51200
    v_mfma_f32_16x16x32_bf16 a[144:147], a[36:39], a[244:247], a[144:147]
    s_add_u32 m0, s48, 4096
    ds_read_b128 a[80:83], v26 offset:36864
    v_mfma_f32_16x16x32_bf16 a[176:179], a[32:35], a[248:251], a[176:179]
    v_mfma_f32_16x16x32_bf16 a[176:179], a[36:39], a[252:255], a[176:179]
    buffer_load_dwordx4 v14, s[16:19], s49 offen offset:0 lds
    ds_read_b64_tr_b16 a[8:9], v29 offset:32768
    v_mfma_f32_16x16x32_bf16 v[168:171], a[40:43], a[192:195], v[168:171]
    v_mfma_f32_16x16x32_bf16 v[168:171], a[44:47], a[196:199], v[168:171]
    ds_read_b128 a[84:87], v27 offset:36864
    v_mfma_f32_16x16x32_bf16 v[184:187], a[40:43], a[200:203], v[184:187]
    buffer_load_dwordx4 v15, s[16:19], s49 offen offset:1024 lds
    ds_read_b64_tr_b16 a[10:11], v29 offset:34816
    v_mfma_f32_16x16x32_bf16 v[184:187], a[44:47], a[204:207], v[184:187]
    v_mfma_f32_16x16x32_bf16 v[200:203], a[40:43], a[208:211], v[200:203]
    ds_read_b128 a[88:91], v26 offset:38912
    v_mfma_f32_16x16x32_bf16 v[200:203], a[44:47], a[212:215], v[200:203]
    v_mfma_f32_16x16x32_bf16 v[216:219], a[40:43], a[216:219], v[216:219]
    buffer_load_dwordx4 v16, s[16:19], s49 offen offset:2048 lds
    ds_read_b64_tr_b16 a[12:13], v29 offset:49152
    v_mfma_f32_16x16x32_bf16 v[216:219], a[44:47], a[220:223], v[216:219]
    ds_read_b128 a[92:95], v27 offset:38912
    v_mfma_f32_16x16x32_bf16 v[232:235], a[40:43], a[224:227], v[232:235]
    v_mfma_f32_16x16x32_bf16 v[232:235], a[44:47], a[228:231], v[232:235]
    buffer_load_dwordx4 v17, s[16:19], s49 offen offset:3072 lds
    ds_read_b64_tr_b16 a[14:15], v29 offset:51200
    v_mfma_f32_16x16x32_bf16 v[248:251], a[40:43], a[232:235], v[248:251]
    ds_read_b128 a[96:99], v26 offset:40960
    v_mfma_f32_16x16x32_bf16 v[248:251], a[44:47], a[236:239], v[248:251]
    s_add_u32 s49, s49, 128
    v_mfma_f32_16x16x32_bf16 a[148:151], a[40:43], a[240:243], a[148:151]
    s_add_u32 m0, s48, 65536
    ds_read_b64_tr_b16 a[16:17], v30 offset:32768
    v_mfma_f32_16x16x32_bf16 a[148:151], a[44:47], a[244:247], a[148:151]
    buffer_load_dwordx4 v18, s[20:23], s50 offen offset:0 lds
    v_mfma_f32_16x16x32_bf16 a[180:183], a[40:43], a[248:251], a[180:183]
    ds_read_b128 a[100:103], v27 offset:40960
    v_mfma_f32_16x16x32_bf16 a[180:183], a[44:47], a[252:255], a[180:183]
    ds_read_b64_tr_b16 a[18:19], v30 offset:34816
    v_mfma_f32_16x16x32_bf16 v[76:79], a[48:51], a[192:195], v[76:79]
    buffer_load_dwordx4 v19, s[20:23], s50 offen offset:1024 lds
    v_mfma_f32_16x16x32_bf16 v[76:79], a[52:55], a[196:199], v[76:79]
    ds_read_b128 a[104:107], v26 offset:43008
    v_mfma_f32_16x16x32_bf16 v[92:95], a[48:51], a[200:203], v[92:95]
    v_mfma_f32_16x16x32_bf16 v[92:95], a[52:55], a[204:207], v[92:95]
    buffer_load_dwordx4 v20, s[20:23], s50 offen offset:2048 lds
    ds_read_b64_tr_b16 a[20:21], v30 offset:49152
    v_mfma_f32_16x16x32_bf16 v[108:111], a[48:51], a[208:211], v[108:111]
    ds_read_b128 a[108:111], v27 offset:43008
    v_mfma_f32_16x16x32_bf16 v[108:111], a[52:55], a[212:215], v[108:111]
    v_mfma_f32_16x16x32_bf16 v[124:127], a[48:51], a[216:219], v[124:127]
    ds_read_b64_tr_b16 a[22:23], v30 offset:51200
    v_mfma_f32_16x16x32_bf16 v[124:127], a[52:55], a[220:223], v[124:127]
    buffer_load_dwordx4 v21, s[20:23], s50 offen offset:3072 lds
    v_mfma_f32_16x16x32_bf16 v[140:143], a[48:51], a[224:227], v[140:143]
    s_add_u32 m0, s48, 69632
    ds_read_b128 a[112:115], v26 offset:45056
    v_mfma_f32_16x16x32_bf16 v[140:143], a[52:55], a[228:231], v[140:143]
    ds_read_b64_tr_b16 a[24:25], v31 offset:32768
    v_mfma_f32_16x16x32_bf16 v[156:159], a[48:51], a[232:235], v[156:159]
    buffer_load_dwordx4 v22, s[20:23], s50 offen offset:0 lds
    v_mfma_f32_16x16x32_bf16 v[156:159], a[52:55], a[236:239], v[156:159]
    ds_read_b128 a[116:119], v27 offset:45056
    v_mfma_f32_16x16x32_bf16 a[152:155], a[48:51], a[240:243], a[152:155]
    v_mfma_f32_16x16x32_bf16 a[152:155], a[52:55], a[244:247], a[152:155]
    ds_read_b64_tr_b16 a[26:27], v31 offset:34816
    v_mfma_f32_16x16x32_bf16 a[184:187], a[48:51], a[248:251], a[184:187]
    buffer_load_dwordx4 v23, s[20:23], s50 offen offset:1024 lds
    ds_read_b128 a[120:123], v26 offset:47104
    v_mfma_f32_16x16x32_bf16 a[184:187], a[52:55], a[252:255], a[184:187]
    v_mfma_f32_16x16x32_bf16 v[172:175], a[56:59], a[192:195], v[172:175]
    ds_read_b64_tr_b16 a[28:29], v31 offset:49152
    v_mfma_f32_16x16x32_bf16 v[172:175], a[60:63], a[196:199], v[172:175]
    buffer_load_dwordx4 v24, s[20:23], s50 offen offset:2048 lds
    v_mfma_f32_16x16x32_bf16 v[188:191], a[56:59], a[200:203], v[188:191]
    ds_read_b128 a[124:127], v27 offset:47104
    v_mfma_f32_16x16x32_bf16 v[188:191], a[60:63], a[204:207], v[188:191]
    ds_read_b64_tr_b16 a[30:31], v31 offset:51200
    v_mfma_f32_16x16x32_bf16 v[204:207], a[56:59], a[208:211], v[204:207]
    v_mfma_f32_16x16x32_bf16 v[204:207], a[60:63], a[212:215], v[204:207]
    buffer_load_dwordx4 v25, s[20:23], s50 offen offset:3072 lds
    v_mfma_f32_16x16x32_bf16 v[220:223], a[56:59], a[216:219], v[220:223]
    v_mfma_f32_16x16x32_bf16 v[220:223], a[60:63], a[220:223], v[220:223]
    s_add_u32 s50, s50, 0x80000
    v_mfma_f32_16x16x32_bf16 v[236:239], a[56:59], a[224:227], v[236:239]
    v_mfma_f32_16x16x32_bf16 v[236:239], a[60:63], a[228:231], v[236:239]
    s_cmp_eq_u32 s51, s53
    s_cbranch_scc1 k12_ool_16
k12_oolret_17:
    v_mfma_f32_16x16x32_bf16 v[252:255], a[56:59], a[232:235], v[252:255]
    s_cmp_eq_u32 s51, s63
    s_cbranch_scc1 k12_ool_18
k12_oolret_19:
    v_mfma_f32_16x16x32_bf16 v[252:255], a[60:63], a[236:239], v[252:255]
    s_cmp_eq_u32 s51, 6
    s_cbranch_scc1 k12_ool_20
k12_oolret_21:
    v_mfma_f32_16x16x32_bf16 a[156:159], a[56:59], a[240:243], a[156:159]
    v_mfma_f32_16x16x32_bf16 a[156:159], a[60:63], a[244:247], a[156:159]
    s_add_u32 s51, s51, 1
    v_mfma_f32_16x16x32_bf16 a[188:191], a[56:59], a[248:251], a[188:191]
    v_mfma_f32_16x16x32_bf16 a[188:191], a[60:63], a[252:255], a[188:191]
    s_waitcnt lgkmcnt(0)
    s_cmp_eq_u32 s51, 7
    s_cbranch_scc1 k12_last_9
    v_mfma_f32_16x16x32_bf16 v[64:67], a[0:3], a[64:67], v[64:67]
    v_mfma_f32_16x16x32_bf16 v[64:67], a[4:7], a[68:71], v[64:67]
    ds_read_b64_tr_b16 a[32:33], v32 offset:32768
    v_mfma_f32_16x16x32_bf16 v[80:83], a[0:3], a[72:75], v[80:83]
    v_mfma_f32_16x16x32_bf16 v[80:83], a[4:7], a[76:79], v[80:83]
    ds_read_b64_tr_b16 a[34:35], v32 offset:34816
    v_mfma_f32_16x16x32_bf16 v[96:99], a[0:3], a[80:83], v[96:99]
    v_mfma_f32_16x16x32_bf16 v[96:99], a[4:7], a[84:87], v[96:99]
    v_mfma_f32_16x16x32_bf16 v[112:115], a[0:3], a[88:91], v[112:115]
    ds_read_b64_tr_b16 a[36:37], v32 offset:49152
    v_mfma_f32_16x16x32_bf16 v[112:115], a[4:7], a[92:95], v[112:115]
    v_mfma_f32_16x16x32_bf16 v[128:131], a[0:3], a[96:99], v[128:131]
    v_mfma_f32_16x16x32_bf16 v[128:131], a[4:7], a[100:103], v[128:131]
    ds_read_b64_tr_b16 a[38:39], v32 offset:51200
    v_mfma_f32_16x16x32_bf16 v[144:147], a[0:3], a[104:107], v[144:147]
    v_mfma_f32_16x16x32_bf16 v[144:147], a[4:7], a[108:111], v[144:147]
    v_mfma_f32_16x16x32_bf16 a[128:131], a[0:3], a[112:115], a[128:131]
    ds_read_b64_tr_b16 a[40:41], v33 offset:32768
    v_mfma_f32_16x16x32_bf16 a[128:131], a[4:7], a[116:119], a[128:131]
    v_mfma_f32_16x16x32_bf16 a[160:163], a[0:3], a[120:123], a[160:163]
    v_mfma_f32_16x16x32_bf16 a[160:163], a[4:7], a[124:127], a[160:163]
    ds_read_b64_tr_b16 a[42:43], v33 offset:34816
    v_mfma_f32_16x16x32_bf16 v[160:163], a[8:11], a[64:67], v[160:163]
    v_mfma_f32_16x16x32_bf16 v[160:163], a[12:15], a[68:71], v[160:163]
    v_mfma_f32_16x16x32_bf16 v[176:179], a[8:11], a[72:75], v[176:179]
    ds_read_b64_tr_b16 a[44:45], v33 offset:49152
    v_mfma_f32_16x16x32_bf16 v[176:179], a[12:15], a[76:79], v[176:179]
    v_mfma_f32_16x16x32_bf16 v[192:195], a[8:11], a[80:83], v[192:195]
    v_mfma_f32_16x16x32_bf16 v[192:195], a[12:15], a[84:87], v[192:195]
    ds_read_b64_tr_b16 a[46:47], v33 offset:51200
    v_mfma_f32_16x16x32_bf16 v[208:211], a[8:11], a[88:91], v[208:211]
    v_mfma_f32_16x16x32_bf16 v[208:211], a[12:15], a[92:95], v[208:211]
    ds_read_b64_tr_b16 a[48:49], v34 offset:32768
    v_mfma_f32_16x16x32_bf16 v[224:227], a[8:11], a[96:99], v[224:227]
    v_mfma_f32_16x16x32_bf16 v[224:227], a[12:15], a[100:103], v[224:227]
    v_mfma_f32_16x16x32_bf16 v[240:243], a[8:11], a[104:107], v[240:243]
    ds_read_b64_tr_b16 a[50:51], v34 offset:34816
    v_mfma_f32_16x16x32_bf16 v[240:243], a[12:15], a[108:111], v[240:243]
    v_mfma_f32_16x16x32_bf16 a[132:135], a[8:11], a[112:115], a[132:135]
    v_mfma_f32_16x16x32_bf16 a[132:135], a[12:15], a[116:119], a[132:135]
    ds_read_b64_tr_b16 a[52:53], v34 offset:49152
    v_mfma_f32_16x16x32_bf16 a[164:167], a[8:11], a[120:123], a[164:167]
    v_mfma_f32_16x16x32_bf16 a[164:167], a[12:15], a[124:127], a[164:167]
    v_mfma_f32_16x16x32_bf16 v[68:71], a[16:19], a[64:67], v[68:71]
    ds_read_b64_tr_b16 a[54:55], v34 offset:51200
    v_mfma_f32_16x16x32_bf16 v[68:71], a[20:23], a[68:71], v[68:71]
    v_mfma_f32_16x16x32_bf16 v[84:87], a[16:19], a[72:75], v[84:87]
    v_mfma_f32_16x16x32_bf16 v[84:87], a[20:23], a[76:79], v[84:87]
    ds_read_b64_tr_b16 a[56:57], v35 offset:32768
    v_mfma_f32_16x16x32_bf16 v[100:103], a[16:19], a[80:83], v[100:103]
    v_mfma_f32_16x16x32_bf16 v[100:103], a[20:23], a[84:87], v[100:103]
    v_mfma_f32_16x16x32_bf16 v[116:119], a[16:19], a[88:91], v[116:119]
    ds_read_b64_tr_b16 a[58:59], v35 offset:34816
    v_mfma_f32_16x16x32_bf16 v[116:119], a[20:23], a[92:95], v[116:119]
    v_mfma_f32_16x16x32_bf16 v[132:135], a[16:19], a[96:99], v[132:135]
    v_mfma_f32_16x16x32_bf16 v[132:135], a[20:23], a[100:103], v[132:135]
    ds_read_b64_tr_b16 a[60:61], v35 offset:49152
    v_mfma_f32_16x16x32_bf16 v[148:151], a[16:19], a[104:107], v[148:151]
    v_mfma_f32_16x16x32_bf16 v[148:151], a[20:23], a[108:111], v[148:151]
    v_mfma_f32_16x16x32_bf16 a[136:139], a[16:19], a[112:115], a[136:139]
    ds_read_b64_tr_b16 a[62:63], v35 offset:51200
    v_mfma_f32_16x16x32_bf16 a[136:139], a[20:23], a[116:119], a[136:139]
    v_mfma_f32_16x16x32_bf16 a[168:171], a[16:19], a[120:123], a[168:171]
    v_mfma_f32_16x16x32_bf16 a[168:171], a[20:23], a[124:127], a[168:171]
    v_mfma_f32_16x16x32_bf16 v[164:167], a[24:27], a[64:67], v[164:167]
    v_mfma_f32_16x16x32_bf16 v[164:167], a[28:31], a[68:71], v[164:167]
    v_mfma_f32_16x16x32_bf16 v[180:183], a[24:27], a[72:75], v[180:183]
    v_mfma_f32_16x16x32_bf16 v[180:183], a[28:31], a[76:79], v[180:183]
    v_mfma_f32_16x16x32_bf16 v[196:199], a[24:27], a[80:83], v[196:199]
    v_mfma_f32_16x16x32_bf16 v[196:199], a[28:31], a[84:87], v[196:199]
    v_mfma_f32_16x16x32_bf16 v[212:215], a[24:27], a[88:91], v[212:215]
    v_mfma_f32_16x16x32_bf16 v[212:215], a[28:31], a[92:95], v[212:215]
    v_mfma_f32_16x16x32_bf16 v[228:231], a[24:27], a[96:99], v[228:231]
    v_mfma_f32_16x16x32_bf16 v[228:231], a[28:31], a[100:103], v[228:231]
    v_mfma_f32_16x16x32_bf16 v[244:247], a[24:27], a[104:107], v[244:247]
    v_mfma_f32_16x16x32_bf16 v[244:247], a[28:31], a[108:111], v[244:247]
    v_mfma_f32_16x16x32_bf16 a[140:143], a[24:27], a[112:115], a[140:143]
    v_mfma_f32_16x16x32_bf16 a[140:143], a[28:31], a[116:119], a[140:143]
    v_mfma_f32_16x16x32_bf16 a[172:175], a[24:27], a[120:123], a[172:175]
    v_mfma_f32_16x16x32_bf16 a[172:175], a[28:31], a[124:127], a[172:175]
    s_waitcnt vmcnt(0) lgkmcnt(0)
    s_barrier
    v_mfma_f32_16x16x32_bf16 v[72:75], a[32:35], a[64:67], v[72:75]
    v_mfma_f32_16x16x32_bf16 v[72:75], a[36:39], a[68:71], v[72:75]
    s_add_u32 m0, s48, 32768
    ds_read_b128 a[192:195], v26 offset:0
    v_mfma_f32_16x16x32_bf16 v[88:91], a[32:35], a[72:75], v[88:91]
    buffer_load_dwordx4 v10, s[16:19], s49 offen offset:0 lds
    ds_read_b64_tr_b16 a[0:1], v28 offset:0
    v_mfma_f32_16x16x32_bf16 v[88:91], a[36:39], a[76:79], v[88:91]
    ds_read_b128 a[196:199], v27 offset:0
    v_mfma_f32_16x16x32_bf16 v[104:107], a[32:35], a[80:83], v[104:107]
    buffer_load_dwordx4 v11, s[16:19], s49 offen offset:1024 lds
    v_mfma_f32_16x16x32_bf16 v[104:107], a[36:39], a[84:87], v[104:107]
    ds_read_b64_tr_b16 a[2:3], v28 offset:2048
    v_mfma_f32_16x16x32_bf16 v[120:123], a[32:35], a[88:91], v[120:123]
    v_mfma_f32_16x16x32_bf16 v[120:123], a[36:39], a[92:95], v[120:123]
    ds_read_b128 a[200:203], v26 offset:2048
    v_mfma_f32_16x16x32_bf16 v[136:139], a[32:35], a[96:99], v[136:139]
    buffer_load_dwordx4 v12, s[16:19], s49 offen offset:2048 lds
    ds_read_b64_tr_b16 a[4:5], v28 offset:16384
    v_mfma_f32_16x16x32_bf16 v[136:139], a[36:39], a[100:103], v[136:139]
    v_mfma_f32_16x16x32_bf16 v[152:155], a[32:35], a[104:107], v[152:155]
    ds_read_b128 a[204:207], v27 offset:2048
    v_mfma_f32_16x16x32_bf16 v[152:155], a[36:39], a[108:111], v[152:155]
    buffer_load_dwordx4 v13, s[16:19], s49 offen offset:3072 lds
    v_mfma_f32_16x16x32_bf16 a[144:147], a[32:35], a[112:115], a[144:147]
    ds_read_b64_tr_b16 a[6:7], v28 offset:18432
    v_mfma_f32_16x16x32_bf16 a[144:147], a[36:39], a[116:119], a[144:147]
    s_add_u32 m0, s48, 36864
    ds_read_b128 a[208:211], v26 offset:4096
    v_mfma_f32_16x16x32_bf16 a[176:179], a[32:35], a[120:123], a[176:179]
    v_mfma_f32_16x16x32_bf16 a[176:179], a[36:39], a[124:127], a[176:179]
    buffer_load_dwordx4 v14, s[16:19], s49 offen offset:0 lds
    ds_read_b64_tr_b16 a[8:9], v29 offset:0
    v_mfma_f32_16x16x32_bf16 v[168:171], a[40:43], a[64:67], v[168:171]
    v_mfma_f32_16x16x32_bf16 v[168:171], a[44:47], a[68:71], v[168:171]
    ds_read_b128 a[212:215], v27 offset:4096
    v_mfma_f32_16x16x32_bf16 v[184:187], a[40:43], a[72:75], v[184:187]
    buffer_load_dwordx4 v15, s[16:19], s49 offen offset:1024 lds
    ds_read_b64_tr_b16 a[10:11], v29 offset:2048
    v_mfma_f32_16x16x32_bf16 v[184:187], a[44:47], a[76:79], v[184:187]
    v_mfma_f32_16x16x32_bf16 v[200:203], a[40:43], a[80:83], v[200:203]
    ds_read_b128 a[216:219], v26 offset:6144
    v_mfma_f32_16x16x32_bf16 v[200:203], a[44:47], a[84:87], v[200:203]
    v_mfma_f32_16x16x32_bf16 v[216:219], a[40:43], a[88:91], v[216:219]
    buffer_load_dwordx4 v16, s[16:19], s49 offen offset:2048 lds
    ds_read_b64_tr_b16 a[12:13], v29 offset:16384
    v_mfma_f32_16x16x32_bf16 v[216:219], a[44:47], a[92:95], v[216:219]
    ds_read_b128 a[220:223], v27 offset:6144
    v_mfma_f32_16x16x32_bf16 v[232:235], a[40:43], a[96:99], v[232:235]
    v_mfma_f32_16x16x32_bf16 v[232:235], a[44:47], a[100:103], v[232:235]
    buffer_load_dwordx4 v17, s[16:19], s49 offen offset:3072 lds
    ds_read_b64_tr_b16 a[14:15], v29 offset:18432
    v_mfma_f32_16x16x32_bf16 v[248:251], a[40:43], a[104:107], v[248:251]
    ds_read_b128 a[224:227], v26 offset:8192
    v_mfma_f32_16x16x32_bf16 v[248:251], a[44:47], a[108:111], v[248:251]
    s_add_u32 s49, s49, 128
    v_mfma_f32_16x16x32_bf16 a[148:151], a[40:43], a[112:115], a[148:151]
    s_add_u32 m0, s48, 98304
    ds_read_b64_tr_b16 a[16:17], v30 offset:0
    v_mfma_f32_16x16x32_bf16 a[148:151], a[44:47], a[116:119], a[148:151]
    buffer_load_dwordx4 v18, s[20:23], s50 offen offset:0 lds
    v_mfma_f32_16x16x32_bf16 a[180:183], a[40:43], a[120:123], a[180:183]
    ds_read_b128 a[228:231], v27 offset:8192
    v_mfma_f32_16x16x32_bf16 a[180:183], a[44:47], a[124:127], a[180:183]
    ds_read_b64_tr_b16 a[18:19], v30 offset:2048
    v_mfma_f32_16x16x32_bf16 v[76:79], a[48:51], a[64:67], v[76:79]
    buffer_load_dwordx4 v19, s[20:23], s50 offen offset:1024 lds
    v_mfma_f32_16x16x32_bf16 v[76:79], a[52:55], a[68:71], v[76:79]
    ds_read_b128 a[232:235], v26 offset:10240
    v_mfma_f32_16x16x32_bf16 v[92:95], a[48:51], a[72:75], v[92:95]
    v_mfma_f32_16x16x32_bf16 v[92:95], a[52:55], a[76:79], v[92:95]
    buffer_load_dwordx4 v20, s[20:23], s50 offen offset:2048 lds
    ds_read_b64_tr_b16 a[20:21], v30 offset:16384
    v_mfma_f32_16x16x32_bf16 v[108:111], a[48:51], a[80:83], v[108:111]
    ds_read_b128 a[236:239], v27 offset:10240
    v_mfma_f32_16x16x32_bf16 v[108:111], a[52:55], a[84:87], v[108:111]
    v_mfma_f32_16x16x32_bf16 v[124:127], a[48:51], a[88:91], v[124:127]
    ds_read_b64_tr_b16 a[22:23], v30 offset:18432
    v_mfma_f32_16x16x32_bf16 v[124:127], a[52:55], a[92:95], v[124:127]
    buffer_load_dwordx4 v21, s[20:23], s50 offen offset:3072 lds
    v_mfma_f32_16x16x32_bf16 v[140:143], a[48:51], a[96:99], v[140:143]
    s_add_u32 m0, s48, 102400
    ds_read_b128 a[240:243], v26 offset:12288
    v_mfma_f32_16x16x32_bf16 v[140:143], a[52:55], a[100:103], v[140:143]
    ds_read_b64_tr_b16 a[24:25], v31 offset:0
    v_mfma_f32_16x16x32_bf16 v[156:159], a[48:51], a[104:107], v[156:159]
    buffer_load_dwordx4 v22, s[20:23], s50 offen offset:0 lds
    v_mfma_f32_16x16x32_bf16 v[156:159], a[52:55], a[108:111], v[156:159]
    ds_read_b128 a[244:247], v27 offset:12288
    v_mfma_f32_16x16x32_bf16 a[152:155], a[48:51], a[112:115], a[152:155]
    v_mfma_f32_16x16x32_bf16 a[152:155], a[52:55], a[116:119], a[152:155]
    ds_read_b64_tr_b16 a[26:27], v31 offset:2048
    v_mfma_f32_16x16x32_bf16 a[184:187], a[48:51], a[120:123], a[184:187]
    buffer_load_dwordx4 v23, s[20:23], s50 offen offset:1024 lds
    ds_read_b128 a[248:251], v26 offset:14336
    v_mfma_f32_16x16x32_bf16 a[184:187], a[52:55], a[124:127], a[184:187]
    v_mfma_f32_16x16x32_bf16 v[172:175], a[56:59], a[64:67], v[172:175]
    ds_read_b64_tr_b16 a[28:29], v31 offset:16384
    v_mfma_f32_16x16x32_bf16 v[172:175], a[60:63], a[68:71], v[172:175]
    buffer_load_dwordx4 v24, s[20:23], s50 offen offset:2048 lds
    v_mfma_f32_16x16x32_bf16 v[188:191], a[56:59], a[72:75], v[188:191]
    ds_read_b128 a[252:255], v27 offset:14336
    v_mfma_f32_16x16x32_bf16 v[188:191], a[60:63], a[76:79], v[188:191]
    ds_read_b64_tr_b16 a[30:31], v31 offset:18432
    v_mfma_f32_16x16x32_bf16 v[204:207], a[56:59], a[80:83], v[204:207]
    v_mfma_f32_16x16x32_bf16 v[204:207], a[60:63], a[84:87], v[204:207]
    buffer_load_dwordx4 v25, s[20:23], s50 offen offset:3072 lds
    v_mfma_f32_16x16x32_bf16 v[220:223], a[56:59], a[88:91], v[220:223]
    v_mfma_f32_16x16x32_bf16 v[220:223], a[60:63], a[92:95], v[220:223]
    s_add_u32 s50, s50, 0x80000
    v_mfma_f32_16x16x32_bf16 v[236:239], a[56:59], a[96:99], v[236:239]
    v_mfma_f32_16x16x32_bf16 v[236:239], a[60:63], a[100:103], v[236:239]
    s_cmp_eq_u32 s51, s53
    s_cbranch_scc1 k12_ool_22
k12_oolret_23:
    v_mfma_f32_16x16x32_bf16 v[252:255], a[56:59], a[104:107], v[252:255]
    s_cmp_eq_u32 s51, s63
    s_cbranch_scc1 k12_ool_24
k12_oolret_25:
    v_mfma_f32_16x16x32_bf16 v[252:255], a[60:63], a[108:111], v[252:255]
    s_cmp_eq_u32 s51, 5
    s_cbranch_scc1 k12_ool_26
k12_oolret_27:
    v_mfma_f32_16x16x32_bf16 a[156:159], a[56:59], a[112:115], a[156:159]
    v_mfma_f32_16x16x32_bf16 a[156:159], a[60:63], a[116:119], a[156:159]
    s_add_u32 s51, s51, 1
    v_mfma_f32_16x16x32_bf16 a[188:191], a[56:59], a[120:123], a[188:191]
    v_mfma_f32_16x16x32_bf16 a[188:191], a[60:63], a[124:127], a[188:191]
    s_waitcnt lgkmcnt(0)
    s_branch k12_loop_8
k12_last_9:
    v_mfma_f32_16x16x32_bf16 v[64:67], a[0:3], a[64:67], v[64:67]
    buffer_load_dwordx4 a[192:195], v36, s[8:11], s62 offen sc1
    v_mfma_f32_16x16x32_bf16 v[64:67], a[4:7], a[68:71], v[64:67]
    ds_read_b64_tr_b16 a[32:33], v32 offset:32768
    v_mfma_f32_16x16x32_bf16 v[160:163], a[8:11], a[64:67], v[160:163]
    buffer_load_dwordx4 a[196:199], v54, s[8:11], s62 offen sc1
    ds_read_b64_tr_b16 a[34:35], v32 offset:34816
    v_mfma_f32_16x16x32_bf16 v[160:163], a[12:15], a[68:71], v[160:163]
    v_mfma_f32_16x16x32_bf16 v[80:83], a[0:3], a[72:75], v[80:83]
    buffer_load_dwordx4 a[200:203], v37, s[8:11], s62 offen sc1
    v_mfma_f32_16x16x32_bf16 v[80:83], a[4:7], a[76:79], v[80:83]
    ds_read_b64_tr_b16 a[36:37], v32 offset:49152
    v_mfma_f32_16x16x32_bf16 v[176:179], a[8:11], a[72:75], v[176:179]
    buffer_load_dwordx4 a[204:207], v55, s[8:11], s62 offen sc1
    v_mfma_f32_16x16x32_bf16 v[176:179], a[12:15], a[76:79], v[176:179]
    s_add_u32 s62, s62, 0x20000
    ds_read_b64_tr_b16 a[38:39], v32 offset:51200
    v_mfma_f32_16x16x32_bf16 v[96:99], a[0:3], a[80:83], v[96:99]
    buffer_load_dwordx4 a[208:211], v36, s[8:11], s62 offen sc1
    v_mfma_f32_16x16x32_bf16 v[96:99], a[4:7], a[84:87], v[96:99]
    v_cvt_pk_bf16_f32 v64, v64, v65
    v_cvt_pk_bf16_f32 v65, v66, v67
    v_mfma_f32_16x16x32_bf16 v[192:195], a[8:11], a[80:83], v[192:195]
    v_cvt_pk_bf16_f32 v66, v160, v161
    v_cvt_pk_bf16_f32 v67, v162, v163
    v_mfma_f32_16x16x32_bf16 v[192:195], a[12:15], a[84:87], v[192:195]
    buffer_load_dwordx4 a[212:215], v54, s[8:11], s62 offen sc1
    ds_read_b64_tr_b16 a[40:41], v33 offset:32768
    v_mfma_f32_16x16x32_bf16 v[112:115], a[0:3], a[88:91], v[112:115]
    buffer_load_dwordx4 a[216:219], v37, s[8:11], s62 offen sc1
    ds_read_b64_tr_b16 a[42:43], v33 offset:34816
    v_mfma_f32_16x16x32_bf16 v[112:115], a[4:7], a[92:95], v[112:115]
    v_cvt_pk_bf16_f32 v80, v80, v81
    v_cvt_pk_bf16_f32 v81, v82, v83
    v_mfma_f32_16x16x32_bf16 v[208:211], a[8:11], a[88:91], v[208:211]
    v_cvt_pk_bf16_f32 v82, v176, v177
    v_cvt_pk_bf16_f32 v83, v178, v179
    v_mfma_f32_16x16x32_bf16 v[208:211], a[12:15], a[92:95], v[208:211]
    buffer_load_dwordx4 a[220:223], v55, s[8:11], s62 offen sc1
    ds_read_b64_tr_b16 a[44:45], v33 offset:49152
    v_mfma_f32_16x16x32_bf16 v[128:131], a[0:3], a[96:99], v[128:131]
    s_add_u32 s62, s62, 0x20000
    buffer_load_dwordx4 a[224:227], v36, s[8:11], s62 offen sc1
    v_mfma_f32_16x16x32_bf16 v[128:131], a[4:7], a[100:103], v[128:131]
    v_cvt_pk_bf16_f32 v96, v96, v97
    v_cvt_pk_bf16_f32 v97, v98, v99
    v_mfma_f32_16x16x32_bf16 v[224:227], a[8:11], a[96:99], v[224:227]
    ds_read_b64_tr_b16 a[46:47], v33 offset:51200
    v_cvt_pk_bf16_f32 v98, v192, v193
    v_mfma_f32_16x16x32_bf16 v[224:227], a[12:15], a[100:103], v[224:227]
    ds_read_b64_tr_b16 a[48:49], v34 offset:32768
    v_cvt_pk_bf16_f32 v99, v194, v195
    v_mfma_f32_16x16x32_bf16 v[144:147], a[0:3], a[104:107], v[144:147]
    buffer_load_dwordx4 a[228:231], v54, s[8:11], s62 offen sc1
    buffer_load_dwordx4 a[232:235], v37, s[8:11], s62 offen sc1
    v_mfma_f32_16x16x32_bf16 v[144:147], a[4:7], a[108:111], v[144:147]
    v_cvt_pk_bf16_f32 v112, v112, v113
    v_cvt_pk_bf16_f32 v113, v114, v115
    v_mfma_f32_16x16x32_bf16 v[240:243], a[8:11], a[104:107], v[240:243]
    v_cvt_pk_bf16_f32 v114, v208, v209
    v_cvt_pk_bf16_f32 v115, v210, v211
    v_mfma_f32_16x16x32_bf16 v[240:243], a[12:15], a[108:111], v[240:243]
    buffer_load_dwordx4 a[236:239], v55, s[8:11], s62 offen sc1
    ds_read_b64_tr_b16 a[50:51], v34 offset:34816
    v_mfma_f32_16x16x32_bf16 a[128:131], a[0:3], a[112:115], a[128:131]
    s_add_u32 s62, s62, 0x20000
    ds_read_b64_tr_b16 a[52:53], v34 offset:49152
    v_mfma_f32_16x16x32_bf16 a[128:131], a[4:7], a[116:119], a[128:131]
    v_cvt_pk_bf16_f32 v128, v128, v129
    v_cvt_pk_bf16_f32 v129, v130, v131
    v_mfma_f32_16x16x32_bf16 a[132:135], a[8:11], a[112:115], a[132:135]
    s_add_u32 s52, s47, 0
    v_cvt_pk_bf16_f32 v130, v224, v225
    v_cvt_pk_bf16_f32 v131, v226, v227
    v_mfma_f32_16x16x32_bf16 a[132:135], a[12:15], a[116:119], a[132:135]
    buffer_store_dwordx4 v[64:67], v1, s[32:35], s52 offen offset:0 sc1
    ds_read_b64_tr_b16 a[54:55], v34 offset:51200
    v_mfma_f32_16x16x32_bf16 a[160:163], a[0:3], a[120:123], a[160:163]
    v_mfma_f32_16x16x32_bf16 a[160:163], a[4:7], a[124:127], a[160:163]
    v_cvt_pk_bf16_f32 v144, v144, v145
    v_cvt_pk_bf16_f32 v145, v146, v147
    v_mfma_f32_16x16x32_bf16 a[164:167], a[8:11], a[120:123], a[164:167]
    ds_read_b64_tr_b16 a[56:57], v35 offset:32768
    v_cvt_pk_bf16_f32 v146, v240, v241
    v_mfma_f32_16x16x32_bf16 a[164:167], a[12:15], a[124:127], a[164:167]
    v_cvt_pk_bf16_f32 v147, v242, v243
    v_mfma_f32_16x16x32_bf16 v[68:71], a[16:19], a[64:67], v[68:71]
    ds_read_b64_tr_b16 a[58:59], v35 offset:34816
    v_mfma_f32_16x16x32_bf16 v[68:71], a[20:23], a[68:71], v[68:71]
    v_accvgpr_read_b32 v56, a128
    v_accvgpr_read_b32 v57, a129
    v_mfma_f32_16x16x32_bf16 v[164:167], a[24:27], a[64:67], v[164:167]
    v_accvgpr_read_b32 v58, a130
    v_accvgpr_read_b32 v59, a131
    v_mfma_f32_16x16x32_bf16 v[164:167], a[28:31], a[68:71], v[164:167]
    v_accvgpr_read_b32 v60, a132
    v_accvgpr_read_b32 v61, a133
    v_mfma_f32_16x16x32_bf16 v[84:87], a[16:19], a[72:75], v[84:87]
    ds_read_b64_tr_b16 a[60:61], v35 offset:49152
    v_accvgpr_read_b32 v62, a134
    v_mfma_f32_16x16x32_bf16 v[84:87], a[20:23], a[76:79], v[84:87]
    v_accvgpr_read_b32 v63, a135
    v_cvt_pk_bf16_f32 v160, v56, v57
    v_mfma_f32_16x16x32_bf16 v[180:183], a[24:27], a[72:75], v[180:183]
    s_add_u32 s52, s47, 8192
    v_cvt_pk_bf16_f32 v161, v58, v59
    v_cvt_pk_bf16_f32 v162, v60, v61
    v_mfma_f32_16x16x32_bf16 v[180:183], a[28:31], a[76:79], v[180:183]
    ds_read_b64_tr_b16 a[62:63], v35 offset:51200
    v_cvt_pk_bf16_f32 v163, v62, v63
    v_mfma_f32_16x16x32_bf16 v[100:103], a[16:19], a[80:83], v[100:103]
    v_accvgpr_read_b32 v56, a160
    v_accvgpr_read_b32 v57, a161
    v_mfma_f32_16x16x32_bf16 v[100:103], a[20:23], a[84:87], v[100:103]
    v_accvgpr_read_b32 v58, a162
    v_accvgpr_read_b32 v59, a163
    v_mfma_f32_16x16x32_bf16 v[196:199], a[24:27], a[80:83], v[196:199]
    v_accvgpr_read_b32 v60, a164
    v_accvgpr_read_b32 v61, a165
    v_mfma_f32_16x16x32_bf16 v[196:199], a[28:31], a[84:87], v[196:199]
    v_accvgpr_read_b32 v62, a166
    v_accvgpr_read_b32 v63, a167
    v_mfma_f32_16x16x32_bf16 v[116:119], a[16:19], a[88:91], v[116:119]
    buffer_store_dwordx4 v[96:99], v1, s[32:35], s52 offen offset:0 sc1
    v_cvt_pk_bf16_f32 v176, v56, v57
    v_mfma_f32_16x16x32_bf16 v[116:119], a[20:23], a[92:95], v[116:119]
    v_cvt_pk_bf16_f32 v177, v58, v59
    v_cvt_pk_bf16_f32 v68, v68, v69
    v_mfma_f32_16x16x32_bf16 v[212:215], a[24:27], a[88:91], v[212:215]
    v_cvt_pk_bf16_f32 v178, v60, v61
    v_cvt_pk_bf16_f32 v69, v70, v71
    v_mfma_f32_16x16x32_bf16 v[212:215], a[28:31], a[92:95], v[212:215]
    v_cvt_pk_bf16_f32 v179, v62, v63
    v_cvt_pk_bf16_f32 v70, v164, v165
    v_mfma_f32_16x16x32_bf16 v[132:135], a[16:19], a[96:99], v[132:135]
    v_cvt_pk_bf16_f32 v71, v166, v167
    v_cvt_pk_bf16_f32 v84, v84, v85
    v_mfma_f32_16x16x32_bf16 v[132:135], a[20:23], a[100:103], v[132:135]
    v_cvt_pk_bf16_f32 v85, v86, v87
    v_cvt_pk_bf16_f32 v86, v180, v181
    v_mfma_f32_16x16x32_bf16 v[228:231], a[24:27], a[96:99], v[228:231]
    s_add_u32 s52, s47, 524288
    v_cvt_pk_bf16_f32 v87, v182, v183
    v_cvt_pk_bf16_f32 v100, v100, v101
    v_mfma_f32_16x16x32_bf16 v[228:231], a[28:31], a[100:103], v[228:231]
    v_cvt_pk_bf16_f32 v101, v102, v103
    v_cvt_pk_bf16_f32 v102, v196, v197
    v_mfma_f32_16x16x32_bf16 v[148:151], a[16:19], a[104:107], v[148:151]
    v_cvt_pk_bf16_f32 v103, v198, v199
    v_mfma_f32_16x16x32_bf16 v[148:151], a[20:23], a[108:111], v[148:151]
    buffer_store_dwordx4 v[128:131], v1, s[32:35], s52 offen offset:0 sc1
    v_mfma_f32_16x16x32_bf16 v[244:247], a[24:27], a[104:107], v[244:247]
    v_cvt_pk_bf16_f32 v116, v116, v117
    v_cvt_pk_bf16_f32 v117, v118, v119
    v_mfma_f32_16x16x32_bf16 v[244:247], a[28:31], a[108:111], v[244:247]
    v_cvt_pk_bf16_f32 v118, v212, v213
    v_cvt_pk_bf16_f32 v119, v214, v215
    v_mfma_f32_16x16x32_bf16 a[136:139], a[16:19], a[112:115], a[136:139]
    v_mfma_f32_16x16x32_bf16 a[136:139], a[20:23], a[116:119], a[136:139]
    v_cvt_pk_bf16_f32 v132, v132, v133
    v_cvt_pk_bf16_f32 v133, v134, v135
    v_mfma_f32_16x16x32_bf16 a[140:143], a[24:27], a[112:115], a[140:143]
    v_cvt_pk_bf16_f32 v134, v228, v229
    v_cvt_pk_bf16_f32 v135, v230, v231
    v_mfma_f32_16x16x32_bf16 a[140:143], a[28:31], a[116:119], a[140:143]
    v_mfma_f32_16x16x32_bf16 a[168:171], a[16:19], a[120:123], a[168:171]
    s_waitcnt lgkmcnt(0)
    v_mfma_f32_16x16x32_bf16 a[168:171], a[20:23], a[124:127], a[168:171]
    v_cvt_pk_bf16_f32 v148, v148, v149
    v_cvt_pk_bf16_f32 v149, v150, v151
    v_mfma_f32_16x16x32_bf16 a[172:175], a[24:27], a[120:123], a[172:175]
    v_cvt_pk_bf16_f32 v150, v244, v245
    v_cvt_pk_bf16_f32 v151, v246, v247
    v_mfma_f32_16x16x32_bf16 a[172:175], a[28:31], a[124:127], a[172:175]
    s_add_u32 s52, s47, 532480
    v_mfma_f32_16x16x32_bf16 v[72:75], a[32:35], a[64:67], v[72:75]
    buffer_store_dwordx4 v[160:163], v1, s[32:35], s52 offen offset:0 sc1
    v_mfma_f32_16x16x32_bf16 v[72:75], a[36:39], a[68:71], v[72:75]
    v_accvgpr_read_b32 v56, a136
    v_accvgpr_read_b32 v57, a137
    v_mfma_f32_16x16x32_bf16 v[168:171], a[40:43], a[64:67], v[168:171]
    v_accvgpr_read_b32 v58, a138
    v_accvgpr_read_b32 v59, a139
    v_mfma_f32_16x16x32_bf16 v[168:171], a[44:47], a[68:71], v[168:171]
    v_accvgpr_read_b32 v60, a140
    v_accvgpr_read_b32 v61, a141
    v_mfma_f32_16x16x32_bf16 v[88:91], a[32:35], a[72:75], v[88:91]
    v_accvgpr_read_b32 v62, a142
    v_accvgpr_read_b32 v63, a143
    v_mfma_f32_16x16x32_bf16 v[88:91], a[36:39], a[76:79], v[88:91]
    v_cvt_pk_bf16_f32 v164, v56, v57
    v_cvt_pk_bf16_f32 v165, v58, v59
    v_mfma_f32_16x16x32_bf16 v[184:187], a[40:43], a[72:75], v[184:187]
    v_cvt_pk_bf16_f32 v166, v60, v61
    v_cvt_pk_bf16_f32 v167, v62, v63
    v_mfma_f32_16x16x32_bf16 v[184:187], a[44:47], a[76:79], v[184:187]
    v_accvgpr_read_b32 v56, a168
    v_accvgpr_read_b32 v57, a169
    v_mfma_f32_16x16x32_bf16 v[104:107], a[32:35], a[80:83], v[104:107]
    v_accvgpr_read_b32 v58, a170
    v_accvgpr_read_b32 v59, a171
    v_mfma_f32_16x16x32_bf16 v[104:107], a[36:39], a[84:87], v[104:107]
    v_accvgpr_read_b32 v60, a172
    v_accvgpr_read_b32 v61, a173
    v_mfma_f32_16x16x32_bf16 v[200:203], a[40:43], a[80:83], v[200:203]
    v_accvgpr_read_b32 v62, a174
    v_accvgpr_read_b32 v63, a175
    v_mfma_f32_16x16x32_bf16 v[200:203], a[44:47], a[84:87], v[200:203]
    s_add_u32 s52, s47, 0
    v_cvt_pk_bf16_f32 v180, v56, v57
    v_cvt_pk_bf16_f32 v181, v58, v59
    v_mfma_f32_16x16x32_bf16 v[120:123], a[32:35], a[88:91], v[120:123]
    v_cvt_pk_bf16_f32 v72, v72, v73
    v_cvt_pk_bf16_f32 v182, v60, v61
    v_mfma_f32_16x16x32_bf16 v[120:123], a[36:39], a[92:95], v[120:123]
    v_cvt_pk_bf16_f32 v73, v74, v75
    v_cvt_pk_bf16_f32 v183, v62, v63
    v_mfma_f32_16x16x32_bf16 v[216:219], a[40:43], a[88:91], v[216:219]
    v_cvt_pk_bf16_f32 v74, v168, v169
    v_cvt_pk_bf16_f32 v75, v170, v171
    v_mfma_f32_16x16x32_bf16 v[216:219], a[44:47], a[92:95], v[216:219]
    v_cvt_pk_bf16_f32 v88, v88, v89
    v_cvt_pk_bf16_f32 v89, v90, v91
    v_mfma_f32_16x16x32_bf16 v[136:139], a[32:35], a[96:99], v[136:139]
    buffer_store_dwordx4 v[68:71], v1, s[32:35], s52 offen offset:1024 sc1
    v_mfma_f32_16x16x32_bf16 v[136:139], a[36:39], a[100:103], v[136:139]
    v_cvt_pk_bf16_f32 v90, v184, v185
    v_cvt_pk_bf16_f32 v91, v186, v187
    v_mfma_f32_16x16x32_bf16 v[232:235], a[40:43], a[96:99], v[232:235]
    v_cvt_pk_bf16_f32 v104, v104, v105
    v_cvt_pk_bf16_f32 v105, v106, v107
    v_mfma_f32_16x16x32_bf16 v[232:235], a[44:47], a[100:103], v[232:235]
    v_cvt_pk_bf16_f32 v106, v200, v201
    v_cvt_pk_bf16_f32 v107, v202, v203
    v_mfma_f32_16x16x32_bf16 v[152:155], a[32:35], a[104:107], v[152:155]
    v_mfma_f32_16x16x32_bf16 v[152:155], a[36:39], a[108:111], v[152:155]
    v_cvt_pk_bf16_f32 v120, v120, v121
    v_cvt_pk_bf16_f32 v121, v122, v123
    v_mfma_f32_16x16x32_bf16 v[248:251], a[40:43], a[104:107], v[248:251]
    v_cvt_pk_bf16_f32 v122, v216, v217
    v_cvt_pk_bf16_f32 v123, v218, v219
    v_mfma_f32_16x16x32_bf16 v[248:251], a[44:47], a[108:111], v[248:251]
    s_add_u32 s52, s47, 8192
    v_mfma_f32_16x16x32_bf16 a[144:147], a[32:35], a[112:115], a[144:147]
    buffer_store_dwordx4 v[100:103], v1, s[32:35], s52 offen offset:1024 sc1
    v_mfma_f32_16x16x32_bf16 a[144:147], a[36:39], a[116:119], a[144:147]
    v_cvt_pk_bf16_f32 v136, v136, v137
    v_cvt_pk_bf16_f32 v137, v138, v139
    v_mfma_f32_16x16x32_bf16 a[148:151], a[40:43], a[112:115], a[148:151]
    v_cvt_pk_bf16_f32 v138, v232, v233
    v_cvt_pk_bf16_f32 v139, v234, v235
    v_mfma_f32_16x16x32_bf16 a[148:151], a[44:47], a[116:119], a[148:151]
    v_mfma_f32_16x16x32_bf16 a[176:179], a[32:35], a[120:123], a[176:179]
    v_mfma_f32_16x16x32_bf16 a[176:179], a[36:39], a[124:127], a[176:179]
    v_cvt_pk_bf16_f32 v152, v152, v153
    v_cvt_pk_bf16_f32 v153, v154, v155
    v_mfma_f32_16x16x32_bf16 a[180:183], a[40:43], a[120:123], a[180:183]
    v_cvt_pk_bf16_f32 v154, v248, v249
    v_cvt_pk_bf16_f32 v155, v250, v251
    v_mfma_f32_16x16x32_bf16 a[180:183], a[44:47], a[124:127], a[180:183]
    v_mfma_f32_16x16x32_bf16 v[76:79], a[48:51], a[64:67], v[76:79]
    s_waitcnt vmcnt(12)
    s_barrier
    v_mfma_f32_16x16x32_bf16 v[76:79], a[52:55], a[68:71], v[76:79]
    ds_read_b64_tr_b16 a[0:1], v42 offset:32768
    v_accvgpr_read_b32 v56, a144
    v_mfma_f32_16x16x32_bf16 v[172:175], a[56:59], a[64:67], v[172:175]
    v_accvgpr_read_b32 v57, a145
    v_accvgpr_read_b32 v58, a146
    v_mfma_f32_16x16x32_bf16 v[172:175], a[60:63], a[68:71], v[172:175]
    s_add_u32 s52, s47, 524288
    ds_read_b64_tr_b16 a[2:3], v42 offset:33792
    v_accvgpr_read_b32 v59, a147
    v_mfma_f32_16x16x32_bf16 v[92:95], a[48:51], a[72:75], v[92:95]
    v_accvgpr_read_b32 v60, a148
    v_accvgpr_read_b32 v61, a149
    v_mfma_f32_16x16x32_bf16 v[92:95], a[52:55], a[76:79], v[92:95]
    ds_read_b64_tr_b16 a[4:5], v43 offset:32768
    v_accvgpr_read_b32 v62, a150
    v_mfma_f32_16x16x32_bf16 v[188:191], a[56:59], a[72:75], v[188:191]
    v_accvgpr_read_b32 v63, a151
    v_cvt_pk_bf16_f32 v168, v56, v57
    v_mfma_f32_16x16x32_bf16 v[188:191], a[60:63], a[76:79], v[188:191]
    v_cvt_pk_bf16_f32 v169, v58, v59
    v_cvt_pk_bf16_f32 v170, v60, v61
    v_mfma_f32_16x16x32_bf16 v[108:111], a[48:51], a[80:83], v[108:111]
    buffer_store_dwordx4 v[132:135], v1, s[32:35], s52 offen offset:1024 sc1
    ds_read_b64_tr_b16 a[6:7], v43 offset:33792
    v_mfma_f32_16x16x32_bf16 v[108:111], a[52:55], a[84:87], v[108:111]
    v_cvt_pk_bf16_f32 v171, v62, v63
    v_accvgpr_read_b32 v56, a176
    v_mfma_f32_16x16x32_bf16 v[204:207], a[56:59], a[80:83], v[204:207]
    v_accvgpr_read_b32 v57, a177
    v_accvgpr_read_b32 v58, a178
    v_mfma_f32_16x16x32_bf16 v[204:207], a[60:63], a[84:87], v[204:207]
    v_accvgpr_read_b32 v59, a179
    v_accvgpr_read_b32 v60, a180
    v_mfma_f32_16x16x32_bf16 v[124:127], a[48:51], a[88:91], v[124:127]
    ds_read_b64_tr_b16 a[8:9], v44 offset:32768
    v_accvgpr_read_b32 v61, a181
    v_mfma_f32_16x16x32_bf16 v[124:127], a[52:55], a[92:95], v[124:127]
    v_accvgpr_read_b32 v62, a182
    v_accvgpr_read_b32 v63, a183
    v_mfma_f32_16x16x32_bf16 v[220:223], a[56:59], a[88:91], v[220:223]
    ds_read_b64_tr_b16 a[10:11], v44 offset:33792
    v_cvt_pk_bf16_f32 v184, v56, v57
    v_mfma_f32_16x16x32_bf16 v[220:223], a[60:63], a[92:95], v[220:223]
    v_cvt_pk_bf16_f32 v185, v58, v59
    v_cvt_pk_bf16_f32 v76, v76, v77
    v_mfma_f32_16x16x32_bf16 v[140:143], a[48:51], a[96:99], v[140:143]
    s_add_u32 s52, s47, 532480
    v_cvt_pk_bf16_f32 v186, v60, v61
    v_cvt_pk_bf16_f32 v77, v78, v79
    v_mfma_f32_16x16x32_bf16 v[140:143], a[52:55], a[100:103], v[140:143]
    ds_read_b64_tr_b16 a[12:13], v45 offset:32768
    v_cvt_pk_bf16_f32 v187, v62, v63
    v_mfma_f32_16x16x32_bf16 v[236:239], a[56:59], a[96:99], v[236:239]
    v_cvt_pk_bf16_f32 v78, v172, v173
    v_cvt_pk_bf16_f32 v79, v174, v175
    v_mfma_f32_16x16x32_bf16 v[236:239], a[60:63], a[100:103], v[236:239]
    ds_read_b64_tr_b16 a[14:15], v45 offset:33792
    ds_read_b64_tr_b16 a[16:17], v46 offset:32768
    v_mfma_f32_16x16x32_bf16 v[156:159], a[48:51], a[104:107], v[156:159]
    v_cvt_pk_bf16_f32 v92, v92, v93
    v_cvt_pk_bf16_f32 v93, v94, v95
    v_mfma_f32_16x16x32_bf16 v[156:159], a[52:55], a[108:111], v[156:159]
    ds_read_b64_tr_b16 a[18:19], v46 offset:33792
    v_cvt_pk_bf16_f32 v94, v188, v189
    v_mfma_f32_16x16x32_bf16 v[252:255], a[56:59], a[104:107], v[252:255]
    ds_read_b64_tr_b16 a[20:21], v47 offset:32768
    v_cvt_pk_bf16_f32 v95, v190, v191
    v_mfma_f32_16x16x32_bf16 v[252:255], a[60:63], a[108:111], v[252:255]
    ds_read_b64_tr_b16 a[22:23], v47 offset:33792
    v_cvt_pk_bf16_f32 v108, v108, v109
    v_mfma_f32_16x16x32_bf16 a[152:155], a[48:51], a[112:115], a[152:155]
    buffer_store_dwordx4 v[164:167], v1, s[32:35], s52 offen offset:1024 sc1
    v_cvt_pk_bf16_f32 v109, v110, v111
    v_mfma_f32_16x16x32_bf16 a[152:155], a[52:55], a[116:119], a[152:155]
    ds_read_b64_tr_b16 a[24:25], v48 offset:32768
    v_cvt_pk_bf16_f32 v110, v204, v205
    v_mfma_f32_16x16x32_bf16 a[156:159], a[56:59], a[112:115], a[156:159]
    ds_read_b64_tr_b16 a[26:27], v48 offset:33792
    v_cvt_pk_bf16_f32 v111, v206, v207
    v_mfma_f32_16x16x32_bf16 a[156:159], a[60:63], a[116:119], a[156:159]
    ds_read_b64_tr_b16 a[28:29], v49 offset:32768
    v_cvt_pk_bf16_f32 v124, v124, v125
    v_mfma_f32_16x16x32_bf16 a[184:187], a[48:51], a[120:123], a[184:187]
    v_cvt_pk_bf16_f32 v125, v126, v127
    v_cvt_pk_bf16_f32 v126, v220, v221
    v_mfma_f32_16x16x32_bf16 a[184:187], a[52:55], a[124:127], a[184:187]
    ds_read_b64_tr_b16 a[30:31], v49 offset:33792
    v_cvt_pk_bf16_f32 v127, v222, v223
    v_mfma_f32_16x16x32_bf16 a[188:191], a[56:59], a[120:123], a[188:191]
    v_cvt_pk_bf16_f32 v140, v140, v141
    v_cvt_pk_bf16_f32 v141, v142, v143
    v_mfma_f32_16x16x32_bf16 a[188:191], a[60:63], a[124:127], a[188:191]
    v_cvt_pk_bf16_f32 v142, v236, v237
    v_cvt_pk_bf16_f32 v143, v238, v239
    v_cvt_pk_bf16_f32 v156, v156, v157
    v_cvt_pk_bf16_f32 v157, v158, v159
    v_cvt_pk_bf16_f32 v158, v252, v253
    v_cvt_pk_bf16_f32 v159, v254, v255
    v_accvgpr_read_b32 v56, a152
    v_accvgpr_read_b32 v57, a153
    v_accvgpr_read_b32 v58, a154
    v_accvgpr_read_b32 v59, a155
    v_accvgpr_read_b32 v60, a156
    v_accvgpr_read_b32 v61, a157
    v_accvgpr_read_b32 v62, a158
    v_accvgpr_read_b32 v63, a159
    v_cvt_pk_bf16_f32 v172, v56, v57
    v_cvt_pk_bf16_f32 v173, v58, v59
    v_cvt_pk_bf16_f32 v174, v60, v61
    v_cvt_pk_bf16_f32 v175, v62, v63
    v_accvgpr_read_b32 v56, a184
    v_accvgpr_read_b32 v57, a185
    v_accvgpr_read_b32 v58, a186
    v_accvgpr_read_b32 v59, a187
    v_accvgpr_read_b32 v60, a188
    v_accvgpr_read_b32 v61, a189
    v_accvgpr_read_b32 v62, a190
    v_accvgpr_read_b32 v63, a191
    v_cvt_pk_bf16_f32 v188, v56, v57
    v_cvt_pk_bf16_f32 v189, v58, v59
    v_cvt_pk_bf16_f32 v190, v60, v61
    v_cvt_pk_bf16_f32 v191, v62, v63
    s_branch k12_join_7
k12_v_6:
k12_loop_28:
    v_mfma_f32_16x16x32_bf16 v[64:67], a[192:195], a[0:3], v[64:67]
    v_mfma_f32_16x16x32_bf16 v[64:67], a[196:199], a[4:7], v[64:67]
    ds_read_b64_tr_b16 a[32:33], v32 offset:0
    v_mfma_f32_16x16x32_bf16 v[160:163], a[200:203], a[0:3], v[160:163]
    v_mfma_f32_16x16x32_bf16 v[160:163], a[204:207], a[4:7], v[160:163]
    ds_read_b64_tr_b16 a[34:35], v32 offset:2048
    v_mfma_f32_16x16x32_bf16 v[96:99], a[208:211], a[0:3], v[96:99]
    s_cmp_eq_u32 s51, s46
    s_cbranch_scc1 k12_ool_30
k12_oolret_31:
    v_mfma_f32_16x16x32_bf16 v[96:99], a[212:215], a[4:7], v[96:99]
    v_mfma_f32_16x16x32_bf16 v[192:195], a[216:219], a[0:3], v[192:195]
    ds_read_b64_tr_b16 a[36:37], v32 offset:16384
    v_mfma_f32_16x16x32_bf16 v[192:195], a[220:223], a[4:7], v[192:195]
    v_mfma_f32_16x16x32_bf16 v[128:131], a[224:227], a[0:3], v[128:131]
    v_mfma_f32_16x16x32_bf16 v[128:131], a[228:231], a[4:7], v[128:131]
    ds_read_b64_tr_b16 a[38:39], v32 offset:18432
    v_mfma_f32_16x16x32_bf16 v[224:227], a[232:235], a[0:3], v[224:227]
    v_mfma_f32_16x16x32_bf16 v[224:227], a[236:239], a[4:7], v[224:227]
    v_mfma_f32_16x16x32_bf16 a[128:131], a[240:243], a[0:3], a[128:131]
    ds_read_b64_tr_b16 a[40:41], v33 offset:0
    v_mfma_f32_16x16x32_bf16 a[128:131], a[244:247], a[4:7], a[128:131]
    v_mfma_f32_16x16x32_bf16 a[132:135], a[248:251], a[0:3], a[132:135]
    v_mfma_f32_16x16x32_bf16 a[132:135], a[252:255], a[4:7], a[132:135]
    ds_read_b64_tr_b16 a[42:43], v33 offset:2048
    v_mfma_f32_16x16x32_bf16 v[68:71], a[192:195], a[8:11], v[68:71]
    v_mfma_f32_16x16x32_bf16 v[68:71], a[196:199], a[12:15], v[68:71]
    v_mfma_f32_16x16x32_bf16 v[164:167], a[200:203], a[8:11], v[164:167]
    ds_read_b64_tr_b16 a[44:45], v33 offset:16384
    v_mfma_f32_16x16x32_bf16 v[164:167], a[204:207], a[12:15], v[164:167]
    v_mfma_f32_16x16x32_bf16 v[100:103], a[208:211], a[8:11], v[100:103]
    v_mfma_f32_16x16x32_bf16 v[100:103], a[212:215], a[12:15], v[100:103]
    ds_read_b64_tr_b16 a[46:47], v33 offset:18432
    v_mfma_f32_16x16x32_bf16 v[196:199], a[216:219], a[8:11], v[196:199]
    v_mfma_f32_16x16x32_bf16 v[196:199], a[220:223], a[12:15], v[196:199]
    ds_read_b64_tr_b16 a[48:49], v34 offset:0
    v_mfma_f32_16x16x32_bf16 v[132:135], a[224:227], a[8:11], v[132:135]
    v_mfma_f32_16x16x32_bf16 v[132:135], a[228:231], a[12:15], v[132:135]
    v_mfma_f32_16x16x32_bf16 v[228:231], a[232:235], a[8:11], v[228:231]
    ds_read_b64_tr_b16 a[50:51], v34 offset:2048
    v_mfma_f32_16x16x32_bf16 v[228:231], a[236:239], a[12:15], v[228:231]
    v_mfma_f32_16x16x32_bf16 a[136:139], a[240:243], a[8:11], a[136:139]
    v_mfma_f32_16x16x32_bf16 a[136:139], a[244:247], a[12:15], a[136:139]
    ds_read_b64_tr_b16 a[52:53], v34 offset:16384
    v_mfma_f32_16x16x32_bf16 a[140:143], a[248:251], a[8:11], a[140:143]
    v_mfma_f32_16x16x32_bf16 a[140:143], a[252:255], a[12:15], a[140:143]
    v_mfma_f32_16x16x32_bf16 v[72:75], a[192:195], a[16:19], v[72:75]
    ds_read_b64_tr_b16 a[54:55], v34 offset:18432
    v_mfma_f32_16x16x32_bf16 v[72:75], a[196:199], a[20:23], v[72:75]
    v_mfma_f32_16x16x32_bf16 v[168:171], a[200:203], a[16:19], v[168:171]
    v_mfma_f32_16x16x32_bf16 v[168:171], a[204:207], a[20:23], v[168:171]
    ds_read_b64_tr_b16 a[56:57], v35 offset:0
    v_mfma_f32_16x16x32_bf16 v[104:107], a[208:211], a[16:19], v[104:107]
    v_mfma_f32_16x16x32_bf16 v[104:107], a[212:215], a[20:23], v[104:107]
    v_mfma_f32_16x16x32_bf16 v[200:203], a[216:219], a[16:19], v[200:203]
    ds_read_b64_tr_b16 a[58:59], v35 offset:2048
    v_mfma_f32_16x16x32_bf16 v[200:203], a[220:223], a[20:23], v[200:203]
    v_mfma_f32_16x16x32_bf16 v[136:139], a[224:227], a[16:19], v[136:139]
    v_mfma_f32_16x16x32_bf16 v[136:139], a[228:231], a[20:23], v[136:139]
    ds_read_b64_tr_b16 a[60:61], v35 offset:16384
    v_mfma_f32_16x16x32_bf16 v[232:235], a[232:235], a[16:19], v[232:235]
    v_mfma_f32_16x16x32_bf16 v[232:235], a[236:239], a[20:23], v[232:235]
    v_mfma_f32_16x16x32_bf16 a[144:147], a[240:243], a[16:19], a[144:147]
    ds_read_b64_tr_b16 a[62:63], v35 offset:18432
    v_mfma_f32_16x16x32_bf16 a[144:147], a[244:247], a[20:23], a[144:147]
    v_mfma_f32_16x16x32_bf16 a[148:151], a[248:251], a[16:19], a[148:151]
    v_mfma_f32_16x16x32_bf16 a[148:151], a[252:255], a[20:23], a[148:151]
    v_mfma_f32_16x16x32_bf16 v[76:79], a[192:195], a[24:27], v[76:79]
    v_mfma_f32_16x16x32_bf16 v[76:79], a[196:199], a[28:31], v[76:79]
    v_mfma_f32_16x16x32_bf16 v[172:175], a[200:203], a[24:27], v[172:175]
    v_mfma_f32_16x16x32_bf16 v[172:175], a[204:207], a[28:31], v[172:175]
    v_mfma_f32_16x16x32_bf16 v[108:111], a[208:211], a[24:27], v[108:111]
    v_mfma_f32_16x16x32_bf16 v[108:111], a[212:215], a[28:31], v[108:111]
    v_mfma_f32_16x16x32_bf16 v[204:207], a[216:219], a[24:27], v[204:207]
    v_mfma_f32_16x16x32_bf16 v[204:207], a[220:223], a[28:31], v[204:207]
    v_mfma_f32_16x16x32_bf16 v[140:143], a[224:227], a[24:27], v[140:143]
    v_mfma_f32_16x16x32_bf16 v[140:143], a[228:231], a[28:31], v[140:143]
    v_mfma_f32_16x16x32_bf16 v[236:239], a[232:235], a[24:27], v[236:239]
    v_mfma_f32_16x16x32_bf16 v[236:239], a[236:239], a[28:31], v[236:239]
    v_mfma_f32_16x16x32_bf16 a[152:155], a[240:243], a[24:27], a[152:155]
    v_mfma_f32_16x16x32_bf16 a[152:155], a[244:247], a[28:31], a[152:155]
    v_mfma_f32_16x16x32_bf16 a[156:159], a[248:251], a[24:27], a[156:159]
    v_mfma_f32_16x16x32_bf16 a[156:159], a[252:255], a[28:31], a[156:159]
    s_waitcnt vmcnt(0) lgkmcnt(0)
    s_cmp_eq_u32 s51, s46
    s_cbranch_scc1 k12_ool_34
k12_oolret_35:
    s_barrier
    v_mfma_f32_16x16x32_bf16 v[80:83], a[192:195], a[32:35], v[80:83]
    s_cmp_ge_u32 s49, 1024
    s_cselect_b32 s18, 0, s18
    s_cselect_b32 s22, 0, s22
    v_mfma_f32_16x16x32_bf16 v[80:83], a[196:199], a[36:39], v[80:83]
    s_add_u32 m0, s48, 0
    ds_read_b128 a[64:67], v26 offset:32768
    v_mfma_f32_16x16x32_bf16 v[176:179], a[200:203], a[32:35], v[176:179]
    buffer_load_dwordx4 v10, s[16:19], s49 offen offset:0 lds
    ds_read_b64_tr_b16 a[0:1], v28 offset:32768
    v_mfma_f32_16x16x32_bf16 v[176:179], a[204:207], a[36:39], v[176:179]
    ds_read_b128 a[68:71], v27 offset:32768
    v_mfma_f32_16x16x32_bf16 v[112:115], a[208:211], a[32:35], v[112:115]
    buffer_load_dwordx4 v11, s[16:19], s49 offen offset:1024 lds
    v_mfma_f32_16x16x32_bf16 v[112:115], a[212:215], a[36:39], v[112:115]
    ds_read_b64_tr_b16 a[2:3], v28 offset:34816
    v_mfma_f32_16x16x32_bf16 v[208:211], a[216:219], a[32:35], v[208:211]
    v_mfma_f32_16x16x32_bf16 v[208:211], a[220:223], a[36:39], v[208:211]
    ds_read_b128 a[72:75], v26 offset:34816
    v_mfma_f32_16x16x32_bf16 v[144:147], a[224:227], a[32:35], v[144:147]
    buffer_load_dwordx4 v12, s[16:19], s49 offen offset:2048 lds
    ds_read_b64_tr_b16 a[4:5], v28 offset:49152
    v_mfma_f32_16x16x32_bf16 v[144:147], a[228:231], a[36:39], v[144:147]
    v_mfma_f32_16x16x32_bf16 v[240:243], a[232:235], a[32:35], v[240:243]
    ds_read_b128 a[76:79], v27 offset:34816
    v_mfma_f32_16x16x32_bf16 v[240:243], a[236:239], a[36:39], v[240:243]
    buffer_load_dwordx4 v13, s[16:19], s49 offen offset:3072 lds
    v_mfma_f32_16x16x32_bf16 a[160:163], a[240:243], a[32:35], a[160:163]
    ds_read_b64_tr_b16 a[6:7], v28 offset:51200
    v_mfma_f32_16x16x32_bf16 a[160:163], a[244:247], a[36:39], a[160:163]
    s_add_u32 m0, s48, 4096
    ds_read_b128 a[80:83], v26 offset:36864
    v_mfma_f32_16x16x32_bf16 a[164:167], a[248:251], a[32:35], a[164:167]
    v_mfma_f32_16x16x32_bf16 a[164:167], a[252:255], a[36:39], a[164:167]
    buffer_load_dwordx4 v14, s[16:19], s49 offen offset:0 lds
    ds_read_b64_tr_b16 a[8:9], v29 offset:32768
    v_mfma_f32_16x16x32_bf16 v[84:87], a[192:195], a[40:43], v[84:87]
    v_mfma_f32_16x16x32_bf16 v[84:87], a[196:199], a[44:47], v[84:87]
    ds_read_b128 a[84:87], v27 offset:36864
    v_mfma_f32_16x16x32_bf16 v[180:183], a[200:203], a[40:43], v[180:183]
    buffer_load_dwordx4 v15, s[16:19], s49 offen offset:1024 lds
    ds_read_b64_tr_b16 a[10:11], v29 offset:34816
    v_mfma_f32_16x16x32_bf16 v[180:183], a[204:207], a[44:47], v[180:183]
    v_mfma_f32_16x16x32_bf16 v[116:119], a[208:211], a[40:43], v[116:119]
    ds_read_b128 a[88:91], v26 offset:38912
    v_mfma_f32_16x16x32_bf16 v[116:119], a[212:215], a[44:47], v[116:119]
    v_mfma_f32_16x16x32_bf16 v[212:215], a[216:219], a[40:43], v[212:215]
    buffer_load_dwordx4 v16, s[16:19], s49 offen offset:2048 lds
    ds_read_b64_tr_b16 a[12:13], v29 offset:49152
    v_mfma_f32_16x16x32_bf16 v[212:215], a[220:223], a[44:47], v[212:215]
    ds_read_b128 a[92:95], v27 offset:38912
    v_mfma_f32_16x16x32_bf16 v[148:151], a[224:227], a[40:43], v[148:151]
    v_mfma_f32_16x16x32_bf16 v[148:151], a[228:231], a[44:47], v[148:151]
    buffer_load_dwordx4 v17, s[16:19], s49 offen offset:3072 lds
    ds_read_b64_tr_b16 a[14:15], v29 offset:51200
    v_mfma_f32_16x16x32_bf16 v[244:247], a[232:235], a[40:43], v[244:247]
    ds_read_b128 a[96:99], v26 offset:40960
    v_mfma_f32_16x16x32_bf16 v[244:247], a[236:239], a[44:47], v[244:247]
    s_add_u32 s49, s49, 128
    v_mfma_f32_16x16x32_bf16 a[168:171], a[240:243], a[40:43], a[168:171]
    s_add_u32 m0, s48, 65536
    ds_read_b64_tr_b16 a[16:17], v30 offset:32768
    v_mfma_f32_16x16x32_bf16 a[168:171], a[244:247], a[44:47], a[168:171]
    buffer_load_dwordx4 v18, s[20:23], s50 offen offset:0 lds
    v_mfma_f32_16x16x32_bf16 a[172:175], a[248:251], a[40:43], a[172:175]
    ds_read_b128 a[100:103], v27 offset:40960
    v_mfma_f32_16x16x32_bf16 a[172:175], a[252:255], a[44:47], a[172:175]
    ds_read_b64_tr_b16 a[18:19], v30 offset:34816
    v_mfma_f32_16x16x32_bf16 v[88:91], a[192:195], a[48:51], v[88:91]
    buffer_load_dwordx4 v19, s[20:23], s50 offen offset:1024 lds
    v_mfma_f32_16x16x32_bf16 v[88:91], a[196:199], a[52:55], v[88:91]
    ds_read_b128 a[104:107], v26 offset:43008
    v_mfma_f32_16x16x32_bf16 v[184:187], a[200:203], a[48:51], v[184:187]
    v_mfma_f32_16x16x32_bf16 v[184:187], a[204:207], a[52:55], v[184:187]
    buffer_load_dwordx4 v20, s[20:23], s50 offen offset:2048 lds
    ds_read_b64_tr_b16 a[20:21], v30 offset:49152
    v_mfma_f32_16x16x32_bf16 v[120:123], a[208:211], a[48:51], v[120:123]
    ds_read_b128 a[108:111], v27 offset:43008
    v_mfma_f32_16x16x32_bf16 v[120:123], a[212:215], a[52:55], v[120:123]
    v_mfma_f32_16x16x32_bf16 v[216:219], a[216:219], a[48:51], v[216:219]
    ds_read_b64_tr_b16 a[22:23], v30 offset:51200
    v_mfma_f32_16x16x32_bf16 v[216:219], a[220:223], a[52:55], v[216:219]
    buffer_load_dwordx4 v21, s[20:23], s50 offen offset:3072 lds
    v_mfma_f32_16x16x32_bf16 v[152:155], a[224:227], a[48:51], v[152:155]
    s_add_u32 m0, s48, 69632
    ds_read_b128 a[112:115], v26 offset:45056
    v_mfma_f32_16x16x32_bf16 v[152:155], a[228:231], a[52:55], v[152:155]
    ds_read_b64_tr_b16 a[24:25], v31 offset:32768
    v_mfma_f32_16x16x32_bf16 v[248:251], a[232:235], a[48:51], v[248:251]
    buffer_load_dwordx4 v22, s[20:23], s50 offen offset:0 lds
    v_mfma_f32_16x16x32_bf16 v[248:251], a[236:239], a[52:55], v[248:251]
    ds_read_b128 a[116:119], v27 offset:45056
    v_mfma_f32_16x16x32_bf16 a[176:179], a[240:243], a[48:51], a[176:179]
    v_mfma_f32_16x16x32_bf16 a[176:179], a[244:247], a[52:55], a[176:179]
    ds_read_b64_tr_b16 a[26:27], v31 offset:34816
    v_mfma_f32_16x16x32_bf16 a[180:183], a[248:251], a[48:51], a[180:183]
    buffer_load_dwordx4 v23, s[20:23], s50 offen offset:1024 lds
    ds_read_b128 a[120:123], v26 offset:47104
    v_mfma_f32_16x16x32_bf16 a[180:183], a[252:255], a[52:55], a[180:183]
    v_mfma_f32_16x16x32_bf16 v[92:95], a[192:195], a[56:59], v[92:95]
    ds_read_b64_tr_b16 a[28:29], v31 offset:49152
    v_mfma_f32_16x16x32_bf16 v[92:95], a[196:199], a[60:63], v[92:95]
    buffer_load_dwordx4 v24, s[20:23], s50 offen offset:2048 lds
    v_mfma_f32_16x16x32_bf16 v[188:191], a[200:203], a[56:59], v[188:191]
    ds_read_b128 a[124:127], v27 offset:47104
    v_mfma_f32_16x16x32_bf16 v[188:191], a[204:207], a[60:63], v[188:191]
    ds_read_b64_tr_b16 a[30:31], v31 offset:51200
    v_mfma_f32_16x16x32_bf16 v[124:127], a[208:211], a[56:59], v[124:127]
    v_mfma_f32_16x16x32_bf16 v[124:127], a[212:215], a[60:63], v[124:127]
    buffer_load_dwordx4 v25, s[20:23], s50 offen offset:3072 lds
    v_mfma_f32_16x16x32_bf16 v[220:223], a[216:219], a[56:59], v[220:223]
    v_mfma_f32_16x16x32_bf16 v[220:223], a[220:223], a[60:63], v[220:223]
    s_add_u32 s50, s50, 0x80000
    v_mfma_f32_16x16x32_bf16 v[156:159], a[224:227], a[56:59], v[156:159]
    v_mfma_f32_16x16x32_bf16 v[156:159], a[228:231], a[60:63], v[156:159]
    s_cmp_eq_u32 s51, s53
    s_cbranch_scc1 k12_ool_36
k12_oolret_37:
    v_mfma_f32_16x16x32_bf16 v[252:255], a[232:235], a[56:59], v[252:255]
    s_cmp_eq_u32 s51, s63
    s_cbranch_scc1 k12_ool_38
k12_oolret_39:
    v_mfma_f32_16x16x32_bf16 v[252:255], a[236:239], a[60:63], v[252:255]
    s_cmp_eq_u32 s51, 6
    s_cbranch_scc1 k12_ool_40
k12_oolret_41:
    v_mfma_f32_16x16x32_bf16 a[184:187], a[240:243], a[56:59], a[184:187]
    v_mfma_f32_16x16x32_bf16 a[184:187], a[244:247], a[60:63], a[184:187]
    s_add_u32 s51, s51, 1
    v_mfma_f32_16x16x32_bf16 a[188:191], a[248:251], a[56:59], a[188:191]
    v_mfma_f32_16x16x32_bf16 a[188:191], a[252:255], a[60:63], a[188:191]
    s_waitcnt lgkmcnt(0)
    s_cmp_eq_u32 s51, 7
    s_cbranch_scc1 k12_last_29
    v_mfma_f32_16x16x32_bf16 v[64:67], a[64:67], a[0:3], v[64:67]
    v_mfma_f32_16x16x32_bf16 v[64:67], a[68:71], a[4:7], v[64:67]
    ds_read_b64_tr_b16 a[32:33], v32 offset:32768
    v_mfma_f32_16x16x32_bf16 v[160:163], a[72:75], a[0:3], v[160:163]
    v_mfma_f32_16x16x32_bf16 v[160:163], a[76:79], a[4:7], v[160:163]
    ds_read_b64_tr_b16 a[34:35], v32 offset:34816
    v_mfma_f32_16x16x32_bf16 v[96:99], a[80:83], a[0:3], v[96:99]
    v_mfma_f32_16x16x32_bf16 v[96:99], a[84:87], a[4:7], v[96:99]
    v_mfma_f32_16x16x32_bf16 v[192:195], a[88:91], a[0:3], v[192:195]
    ds_read_b64_tr_b16 a[36:37], v32 offset:49152
    v_mfma_f32_16x16x32_bf16 v[192:195], a[92:95], a[4:7], v[192:195]
    v_mfma_f32_16x16x32_bf16 v[128:131], a[96:99], a[0:3], v[128:131]
    v_mfma_f32_16x16x32_bf16 v[128:131], a[100:103], a[4:7], v[128:131]
    ds_read_b64_tr_b16 a[38:39], v32 offset:51200
    v_mfma_f32_16x16x32_bf16 v[224:227], a[104:107], a[0:3], v[224:227]
    v_mfma_f32_16x16x32_bf16 v[224:227], a[108:111], a[4:7], v[224:227]
    v_mfma_f32_16x16x32_bf16 a[128:131], a[112:115], a[0:3], a[128:131]
    ds_read_b64_tr_b16 a[40:41], v33 offset:32768
    v_mfma_f32_16x16x32_bf16 a[128:131], a[116:119], a[4:7], a[128:131]
    v_mfma_f32_16x16x32_bf16 a[132:135], a[120:123], a[0:3], a[132:135]
    v_mfma_f32_16x16x32_bf16 a[132:135], a[124:127], a[4:7], a[132:135]
    ds_read_b64_tr_b16 a[42:43], v33 offset:34816
    v_mfma_f32_16x16x32_bf16 v[68:71], a[64:67], a[8:11], v[68:71]
    v_mfma_f32_16x16x32_bf16 v[68:71], a[68:71], a[12:15], v[68:71]
    v_mfma_f32_16x16x32_bf16 v[164:167], a[72:75], a[8:11], v[164:167]
    ds_read_b64_tr_b16 a[44:45], v33 offset:49152
    v_mfma_f32_16x16x32_bf16 v[164:167], a[76:79], a[12:15], v[164:167]
    v_mfma_f32_16x16x32_bf16 v[100:103], a[80:83], a[8:11], v[100:103]
    v_mfma_f32_16x16x32_bf16 v[100:103], a[84:87], a[12:15], v[100:103]
    ds_read_b64_tr_b16 a[46:47], v33 offset:51200
    v_mfma_f32_16x16x32_bf16 v[196:199], a[88:91], a[8:11], v[196:199]
    v_mfma_f32_16x16x32_bf16 v[196:199], a[92:95], a[12:15], v[196:199]
    ds_read_b64_tr_b16 a[48:49], v34 offset:32768
    v_mfma_f32_16x16x32_bf16 v[132:135], a[96:99], a[8:11], v[132:135]
    v_mfma_f32_16x16x32_bf16 v[132:135], a[100:103], a[12:15], v[132:135]
    v_mfma_f32_16x16x32_bf16 v[228:231], a[104:107], a[8:11], v[228:231]
    ds_read_b64_tr_b16 a[50:51], v34 offset:34816
    v_mfma_f32_16x16x32_bf16 v[228:231], a[108:111], a[12:15], v[228:231]
    v_mfma_f32_16x16x32_bf16 a[136:139], a[112:115], a[8:11], a[136:139]
    v_mfma_f32_16x16x32_bf16 a[136:139], a[116:119], a[12:15], a[136:139]
    ds_read_b64_tr_b16 a[52:53], v34 offset:49152
    v_mfma_f32_16x16x32_bf16 a[140:143], a[120:123], a[8:11], a[140:143]
    v_mfma_f32_16x16x32_bf16 a[140:143], a[124:127], a[12:15], a[140:143]
    v_mfma_f32_16x16x32_bf16 v[72:75], a[64:67], a[16:19], v[72:75]
    ds_read_b64_tr_b16 a[54:55], v34 offset:51200
    v_mfma_f32_16x16x32_bf16 v[72:75], a[68:71], a[20:23], v[72:75]
    v_mfma_f32_16x16x32_bf16 v[168:171], a[72:75], a[16:19], v[168:171]
    v_mfma_f32_16x16x32_bf16 v[168:171], a[76:79], a[20:23], v[168:171]
    ds_read_b64_tr_b16 a[56:57], v35 offset:32768
    v_mfma_f32_16x16x32_bf16 v[104:107], a[80:83], a[16:19], v[104:107]
    v_mfma_f32_16x16x32_bf16 v[104:107], a[84:87], a[20:23], v[104:107]
    v_mfma_f32_16x16x32_bf16 v[200:203], a[88:91], a[16:19], v[200:203]
    ds_read_b64_tr_b16 a[58:59], v35 offset:34816
    v_mfma_f32_16x16x32_bf16 v[200:203], a[92:95], a[20:23], v[200:203]
    v_mfma_f32_16x16x32_bf16 v[136:139], a[96:99], a[16:19], v[136:139]
    v_mfma_f32_16x16x32_bf16 v[136:139], a[100:103], a[20:23], v[136:139]
    ds_read_b64_tr_b16 a[60:61], v35 offset:49152
    v_mfma_f32_16x16x32_bf16 v[232:235], a[104:107], a[16:19], v[232:235]
    v_mfma_f32_16x16x32_bf16 v[232:235], a[108:111], a[20:23], v[232:235]
    v_mfma_f32_16x16x32_bf16 a[144:147], a[112:115], a[16:19], a[144:147]
    ds_read_b64_tr_b16 a[62:63], v35 offset:51200
    v_mfma_f32_16x16x32_bf16 a[144:147], a[116:119], a[20:23], a[144:147]
    v_mfma_f32_16x16x32_bf16 a[148:151], a[120:123], a[16:19], a[148:151]
    v_mfma_f32_16x16x32_bf16 a[148:151], a[124:127], a[20:23], a[148:151]
    v_mfma_f32_16x16x32_bf16 v[76:79], a[64:67], a[24:27], v[76:79]
    v_mfma_f32_16x16x32_bf16 v[76:79], a[68:71], a[28:31], v[76:79]
    v_mfma_f32_16x16x32_bf16 v[172:175], a[72:75], a[24:27], v[172:175]
    v_mfma_f32_16x16x32_bf16 v[172:175], a[76:79], a[28:31], v[172:175]
    v_mfma_f32_16x16x32_bf16 v[108:111], a[80:83], a[24:27], v[108:111]
    v_mfma_f32_16x16x32_bf16 v[108:111], a[84:87], a[28:31], v[108:111]
    v_mfma_f32_16x16x32_bf16 v[204:207], a[88:91], a[24:27], v[204:207]
    v_mfma_f32_16x16x32_bf16 v[204:207], a[92:95], a[28:31], v[204:207]
    v_mfma_f32_16x16x32_bf16 v[140:143], a[96:99], a[24:27], v[140:143]
    v_mfma_f32_16x16x32_bf16 v[140:143], a[100:103], a[28:31], v[140:143]
    v_mfma_f32_16x16x32_bf16 v[236:239], a[104:107], a[24:27], v[236:239]
    v_mfma_f32_16x16x32_bf16 v[236:239], a[108:111], a[28:31], v[236:239]
    v_mfma_f32_16x16x32_bf16 a[152:155], a[112:115], a[24:27], a[152:155]
    v_mfma_f32_16x16x32_bf16 a[152:155], a[116:119], a[28:31], a[152:155]
    v_mfma_f32_16x16x32_bf16 a[156:159], a[120:123], a[24:27], a[156:159]
    v_mfma_f32_16x16x32_bf16 a[156:159], a[124:127], a[28:31], a[156:159]
    s_waitcnt vmcnt(0) lgkmcnt(0)
    s_barrier
    v_mfma_f32_16x16x32_bf16 v[80:83], a[64:67], a[32:35], v[80:83]
    v_mfma_f32_16x16x32_bf16 v[80:83], a[68:71], a[36:39], v[80:83]
    s_add_u32 m0, s48, 32768
    ds_read_b128 a[192:195], v26 offset:0
    v_mfma_f32_16x16x32_bf16 v[176:179], a[72:75], a[32:35], v[176:179]
    buffer_load_dwordx4 v10, s[16:19], s49 offen offset:0 lds
    ds_read_b64_tr_b16 a[0:1], v28 offset:0
    v_mfma_f32_16x16x32_bf16 v[176:179], a[76:79], a[36:39], v[176:179]
    ds_read_b128 a[196:199], v27 offset:0
    v_mfma_f32_16x16x32_bf16 v[112:115], a[80:83], a[32:35], v[112:115]
    buffer_load_dwordx4 v11, s[16:19], s49 offen offset:1024 lds
    v_mfma_f32_16x16x32_bf16 v[112:115], a[84:87], a[36:39], v[112:115]
    ds_read_b64_tr_b16 a[2:3], v28 offset:2048
    v_mfma_f32_16x16x32_bf16 v[208:211], a[88:91], a[32:35], v[208:211]
    v_mfma_f32_16x16x32_bf16 v[208:211], a[92:95], a[36:39], v[208:211]
    ds_read_b128 a[200:203], v26 offset:2048
    v_mfma_f32_16x16x32_bf16 v[144:147], a[96:99], a[32:35], v[144:147]
    buffer_load_dwordx4 v12, s[16:19], s49 offen offset:2048 lds
    ds_read_b64_tr_b16 a[4:5], v28 offset:16384
    v_mfma_f32_16x16x32_bf16 v[144:147], a[100:103], a[36:39], v[144:147]
    v_mfma_f32_16x16x32_bf16 v[240:243], a[104:107], a[32:35], v[240:243]
    ds_read_b128 a[204:207], v27 offset:2048
    v_mfma_f32_16x16x32_bf16 v[240:243], a[108:111], a[36:39], v[240:243]
    buffer_load_dwordx4 v13, s[16:19], s49 offen offset:3072 lds
    v_mfma_f32_16x16x32_bf16 a[160:163], a[112:115], a[32:35], a[160:163]
    ds_read_b64_tr_b16 a[6:7], v28 offset:18432
    v_mfma_f32_16x16x32_bf16 a[160:163], a[116:119], a[36:39], a[160:163]
    s_add_u32 m0, s48, 36864
    ds_read_b128 a[208:211], v26 offset:4096
    v_mfma_f32_16x16x32_bf16 a[164:167], a[120:123], a[32:35], a[164:167]
    v_mfma_f32_16x16x32_bf16 a[164:167], a[124:127], a[36:39], a[164:167]
    buffer_load_dwordx4 v14, s[16:19], s49 offen offset:0 lds
    ds_read_b64_tr_b16 a[8:9], v29 offset:0
    v_mfma_f32_16x16x32_bf16 v[84:87], a[64:67], a[40:43], v[84:87]
    v_mfma_f32_16x16x32_bf16 v[84:87], a[68:71], a[44:47], v[84:87]
    ds_read_b128 a[212:215], v27 offset:4096
    v_mfma_f32_16x16x32_bf16 v[180:183], a[72:75], a[40:43], v[180:183]
    buffer_load_dwordx4 v15, s[16:19], s49 offen offset:1024 lds
    ds_read_b64_tr_b16 a[10:11], v29 offset:2048
    v_mfma_f32_16x16x32_bf16 v[180:183], a[76:79], a[44:47], v[180:183]
    v_mfma_f32_16x16x32_bf16 v[116:119], a[80:83], a[40:43], v[116:119]
    ds_read_b128 a[216:219], v26 offset:6144
    v_mfma_f32_16x16x32_bf16 v[116:119], a[84:87], a[44:47], v[116:119]
    v_mfma_f32_16x16x32_bf16 v[212:215], a[88:91], a[40:43], v[212:215]
    buffer_load_dwordx4 v16, s[16:19], s49 offen offset:2048 lds
    ds_read_b64_tr_b16 a[12:13], v29 offset:16384
    v_mfma_f32_16x16x32_bf16 v[212:215], a[92:95], a[44:47], v[212:215]
    ds_read_b128 a[220:223], v27 offset:6144
    v_mfma_f32_16x16x32_bf16 v[148:151], a[96:99], a[40:43], v[148:151]
    v_mfma_f32_16x16x32_bf16 v[148:151], a[100:103], a[44:47], v[148:151]
    buffer_load_dwordx4 v17, s[16:19], s49 offen offset:3072 lds
    ds_read_b64_tr_b16 a[14:15], v29 offset:18432
    v_mfma_f32_16x16x32_bf16 v[244:247], a[104:107], a[40:43], v[244:247]
    ds_read_b128 a[224:227], v26 offset:8192
    v_mfma_f32_16x16x32_bf16 v[244:247], a[108:111], a[44:47], v[244:247]
    s_add_u32 s49, s49, 128
    v_mfma_f32_16x16x32_bf16 a[168:171], a[112:115], a[40:43], a[168:171]
    s_add_u32 m0, s48, 98304
    ds_read_b64_tr_b16 a[16:17], v30 offset:0
    v_mfma_f32_16x16x32_bf16 a[168:171], a[116:119], a[44:47], a[168:171]
    buffer_load_dwordx4 v18, s[20:23], s50 offen offset:0 lds
    v_mfma_f32_16x16x32_bf16 a[172:175], a[120:123], a[40:43], a[172:175]
    ds_read_b128 a[228:231], v27 offset:8192
    v_mfma_f32_16x16x32_bf16 a[172:175], a[124:127], a[44:47], a[172:175]
    ds_read_b64_tr_b16 a[18:19], v30 offset:2048
    v_mfma_f32_16x16x32_bf16 v[88:91], a[64:67], a[48:51], v[88:91]
    buffer_load_dwordx4 v19, s[20:23], s50 offen offset:1024 lds
    v_mfma_f32_16x16x32_bf16 v[88:91], a[68:71], a[52:55], v[88:91]
    ds_read_b128 a[232:235], v26 offset:10240
    v_mfma_f32_16x16x32_bf16 v[184:187], a[72:75], a[48:51], v[184:187]
    v_mfma_f32_16x16x32_bf16 v[184:187], a[76:79], a[52:55], v[184:187]
    buffer_load_dwordx4 v20, s[20:23], s50 offen offset:2048 lds
    ds_read_b64_tr_b16 a[20:21], v30 offset:16384
    v_mfma_f32_16x16x32_bf16 v[120:123], a[80:83], a[48:51], v[120:123]
    ds_read_b128 a[236:239], v27 offset:10240
    v_mfma_f32_16x16x32_bf16 v[120:123], a[84:87], a[52:55], v[120:123]
    v_mfma_f32_16x16x32_bf16 v[216:219], a[88:91], a[48:51], v[216:219]
    ds_read_b64_tr_b16 a[22:23], v30 offset:18432
    v_mfma_f32_16x16x32_bf16 v[216:219], a[92:95], a[52:55], v[216:219]
    buffer_load_dwordx4 v21, s[20:23], s50 offen offset:3072 lds
    v_mfma_f32_16x16x32_bf16 v[152:155], a[96:99], a[48:51], v[152:155]
    s_add_u32 m0, s48, 102400
    ds_read_b128 a[240:243], v26 offset:12288
    v_mfma_f32_16x16x32_bf16 v[152:155], a[100:103], a[52:55], v[152:155]
    ds_read_b64_tr_b16 a[24:25], v31 offset:0
    v_mfma_f32_16x16x32_bf16 v[248:251], a[104:107], a[48:51], v[248:251]
    buffer_load_dwordx4 v22, s[20:23], s50 offen offset:0 lds
    v_mfma_f32_16x16x32_bf16 v[248:251], a[108:111], a[52:55], v[248:251]
    ds_read_b128 a[244:247], v27 offset:12288
    v_mfma_f32_16x16x32_bf16 a[176:179], a[112:115], a[48:51], a[176:179]
    v_mfma_f32_16x16x32_bf16 a[176:179], a[116:119], a[52:55], a[176:179]
    ds_read_b64_tr_b16 a[26:27], v31 offset:2048
    v_mfma_f32_16x16x32_bf16 a[180:183], a[120:123], a[48:51], a[180:183]
    buffer_load_dwordx4 v23, s[20:23], s50 offen offset:1024 lds
    ds_read_b128 a[248:251], v26 offset:14336
    v_mfma_f32_16x16x32_bf16 a[180:183], a[124:127], a[52:55], a[180:183]
    v_mfma_f32_16x16x32_bf16 v[92:95], a[64:67], a[56:59], v[92:95]
    ds_read_b64_tr_b16 a[28:29], v31 offset:16384
    v_mfma_f32_16x16x32_bf16 v[92:95], a[68:71], a[60:63], v[92:95]
    buffer_load_dwordx4 v24, s[20:23], s50 offen offset:2048 lds
    v_mfma_f32_16x16x32_bf16 v[188:191], a[72:75], a[56:59], v[188:191]
    ds_read_b128 a[252:255], v27 offset:14336
    v_mfma_f32_16x16x32_bf16 v[188:191], a[76:79], a[60:63], v[188:191]
    ds_read_b64_tr_b16 a[30:31], v31 offset:18432
    v_mfma_f32_16x16x32_bf16 v[124:127], a[80:83], a[56:59], v[124:127]
    v_mfma_f32_16x16x32_bf16 v[124:127], a[84:87], a[60:63], v[124:127]
    buffer_load_dwordx4 v25, s[20:23], s50 offen offset:3072 lds
    v_mfma_f32_16x16x32_bf16 v[220:223], a[88:91], a[56:59], v[220:223]
    v_mfma_f32_16x16x32_bf16 v[220:223], a[92:95], a[60:63], v[220:223]
    s_add_u32 s50, s50, 0x80000
    v_mfma_f32_16x16x32_bf16 v[156:159], a[96:99], a[56:59], v[156:159]
    v_mfma_f32_16x16x32_bf16 v[156:159], a[100:103], a[60:63], v[156:159]
    s_cmp_eq_u32 s51, s53
    s_cbranch_scc1 k12_ool_42
k12_oolret_43:
    v_mfma_f32_16x16x32_bf16 v[252:255], a[104:107], a[56:59], v[252:255]
    s_cmp_eq_u32 s51, s63
    s_cbranch_scc1 k12_ool_44
k12_oolret_45:
    v_mfma_f32_16x16x32_bf16 v[252:255], a[108:111], a[60:63], v[252:255]
    s_cmp_eq_u32 s51, 5
    s_cbranch_scc1 k12_ool_46
k12_oolret_47:
    v_mfma_f32_16x16x32_bf16 a[184:187], a[112:115], a[56:59], a[184:187]
    v_mfma_f32_16x16x32_bf16 a[184:187], a[116:119], a[60:63], a[184:187]
    s_add_u32 s51, s51, 1
    v_mfma_f32_16x16x32_bf16 a[188:191], a[120:123], a[56:59], a[188:191]
    v_mfma_f32_16x16x32_bf16 a[188:191], a[124:127], a[60:63], a[188:191]
    s_waitcnt lgkmcnt(0)
    s_branch k12_loop_28
k12_last_29:
    v_mfma_f32_16x16x32_bf16 v[64:67], a[64:67], a[0:3], v[64:67]
    buffer_load_dwordx4 a[192:195], v36, s[8:11], s62 offen sc1
    v_mfma_f32_16x16x32_bf16 v[64:67], a[68:71], a[4:7], v[64:67]
    ds_read_b64_tr_b16 a[32:33], v32 offset:32768
    v_mfma_f32_16x16x32_bf16 v[160:163], a[72:75], a[0:3], v[160:163]
    buffer_load_dwordx4 a[196:199], v54, s[8:11], s62 offen sc1
    ds_read_b64_tr_b16 a[34:35], v32 offset:34816
    v_mfma_f32_16x16x32_bf16 v[160:163], a[76:79], a[4:7], v[160:163]
    v_mfma_f32_16x16x32_bf16 v[96:99], a[80:83], a[0:3], v[96:99]
    buffer_load_dwordx4 a[200:203], v37, s[8:11], s62 offen sc1
    v_mfma_f32_16x16x32_bf16 v[96:99], a[84:87], a[4:7], v[96:99]
    ds_read_b64_tr_b16 a[36:37], v32 offset:49152
    v_mfma_f32_16x16x32_bf16 v[192:195], a[88:91], a[0:3], v[192:195]
    buffer_load_dwordx4 a[204:207], v55, s[8:11], s62 offen sc1
    v_mfma_f32_16x16x32_bf16 v[192:195], a[92:95], a[4:7], v[192:195]
    s_add_u32 s62, s62, 0x20000
    ds_read_b64_tr_b16 a[38:39], v32 offset:51200
    v_mfma_f32_16x16x32_bf16 v[128:131], a[96:99], a[0:3], v[128:131]
    buffer_load_dwordx4 a[208:211], v36, s[8:11], s62 offen sc1
    v_mfma_f32_16x16x32_bf16 v[128:131], a[100:103], a[4:7], v[128:131]
    v_cvt_pk_bf16_f32 v64, v64, v65
    v_cvt_pk_bf16_f32 v65, v66, v67
    v_mfma_f32_16x16x32_bf16 v[224:227], a[104:107], a[0:3], v[224:227]
    v_cvt_pk_bf16_f32 v66, v160, v161
    v_cvt_pk_bf16_f32 v67, v162, v163
    v_mfma_f32_16x16x32_bf16 v[224:227], a[108:111], a[4:7], v[224:227]
    buffer_load_dwordx4 a[212:215], v54, s[8:11], s62 offen sc1
    ds_read_b64_tr_b16 a[40:41], v33 offset:32768
    v_mfma_f32_16x16x32_bf16 a[128:131], a[112:115], a[0:3], a[128:131]
    buffer_load_dwordx4 a[216:219], v37, s[8:11], s62 offen sc1
    ds_read_b64_tr_b16 a[42:43], v33 offset:34816
    v_mfma_f32_16x16x32_bf16 a[128:131], a[116:119], a[4:7], a[128:131]
    v_cvt_pk_bf16_f32 v96, v96, v97
    v_cvt_pk_bf16_f32 v97, v98, v99
    v_mfma_f32_16x16x32_bf16 a[132:135], a[120:123], a[0:3], a[132:135]
    v_cvt_pk_bf16_f32 v98, v192, v193
    v_cvt_pk_bf16_f32 v99, v194, v195
    v_mfma_f32_16x16x32_bf16 a[132:135], a[124:127], a[4:7], a[132:135]
    buffer_load_dwordx4 a[220:223], v55, s[8:11], s62 offen sc1
    ds_read_b64_tr_b16 a[44:45], v33 offset:49152
    v_mfma_f32_16x16x32_bf16 v[68:71], a[64:67], a[8:11], v[68:71]
    s_add_u32 s62, s62, 0x20000
    buffer_load_dwordx4 a[224:227], v36, s[8:11], s62 offen sc1
    v_mfma_f32_16x16x32_bf16 v[68:71], a[68:71], a[12:15], v[68:71]
    v_cvt_pk_bf16_f32 v128, v128, v129
    v_cvt_pk_bf16_f32 v129, v130, v131
    v_mfma_f32_16x16x32_bf16 v[164:167], a[72:75], a[8:11], v[164:167]
    ds_read_b64_tr_b16 a[46:47], v33 offset:51200
    v_cvt_pk_bf16_f32 v130, v224, v225
    v_mfma_f32_16x16x32_bf16 v[164:167], a[76:79], a[12:15], v[164:167]
    ds_read_b64_tr_b16 a[48:49], v34 offset:32768
    v_cvt_pk_bf16_f32 v131, v226, v227
    v_mfma_f32_16x16x32_bf16 v[100:103], a[80:83], a[8:11], v[100:103]
    buffer_load_dwordx4 a[228:231], v54, s[8:11], s62 offen sc1
    buffer_load_dwordx4 a[232:235], v37, s[8:11], s62 offen sc1
    v_mfma_f32_16x16x32_bf16 v[100:103], a[84:87], a[12:15], v[100:103]
    v_accvgpr_read_b32 v56, a128
    v_accvgpr_read_b32 v57, a129
    v_mfma_f32_16x16x32_bf16 v[196:199], a[88:91], a[8:11], v[196:199]
    v_accvgpr_read_b32 v58, a130
    v_accvgpr_read_b32 v59, a131
    v_mfma_f32_16x16x32_bf16 v[196:199], a[92:95], a[12:15], v[196:199]
    ds_read_b64_tr_b16 a[50:51], v34 offset:34816
    v_accvgpr_read_b32 v60, a132
    v_mfma_f32_16x16x32_bf16 v[132:135], a[96:99], a[8:11], v[132:135]
    buffer_load_dwordx4 a[236:239], v55, s[8:11], s62 offen sc1
    ds_read_b64_tr_b16 a[52:53], v34 offset:49152
    v_mfma_f32_16x16x32_bf16 v[132:135], a[100:103], a[12:15], v[132:135]
    s_add_u32 s62, s62, 0x20000
    v_accvgpr_read_b32 v61, a133
    v_accvgpr_read_b32 v62, a134
    v_mfma_f32_16x16x32_bf16 v[228:231], a[104:107], a[8:11], v[228:231]
    s_add_u32 s52, s47, 0
    v_accvgpr_read_b32 v63, a135
    v_cvt_pk_bf16_f32 v160, v56, v57
    v_mfma_f32_16x16x32_bf16 v[228:231], a[108:111], a[12:15], v[228:231]
    v_cvt_pk_bf16_f32 v161, v58, v59
    v_cvt_pk_bf16_f32 v68, v68, v69
    v_mfma_f32_16x16x32_bf16 a[136:139], a[112:115], a[8:11], a[136:139]
    v_cvt_pk_bf16_f32 v162, v60, v61
    v_cvt_pk_bf16_f32 v69, v70, v71
    v_mfma_f32_16x16x32_bf16 a[136:139], a[116:119], a[12:15], a[136:139]
    v_cvt_pk_bf16_f32 v163, v62, v63
    v_cvt_pk_bf16_f32 v70, v164, v165
    v_mfma_f32_16x16x32_bf16 a[140:143], a[120:123], a[8:11], a[140:143]
    ds_read_b64_tr_b16 a[54:55], v34 offset:51200
    v_cvt_pk_bf16_f32 v71, v166, v167
    v_mfma_f32_16x16x32_bf16 a[140:143], a[124:127], a[12:15], a[140:143]
    buffer_store_dwordx4 v[64:67], v1, s[32:35], s52 offen offset:0 sc1
    ds_read_b64_tr_b16 a[56:57], v35 offset:32768
    v_mfma_f32_16x16x32_bf16 v[72:75], a[64:67], a[16:19], v[72:75]
    v_cvt_pk_bf16_f32 v100, v100, v101
    v_cvt_pk_bf16_f32 v101, v102, v103
    v_mfma_f32_16x16x32_bf16 v[72:75], a[68:71], a[20:23], v[72:75]
    v_cvt_pk_bf16_f32 v102, v196, v197
    v_cvt_pk_bf16_f32 v103, v198, v199
    v_mfma_f32_16x16x32_bf16 v[168:171], a[72:75], a[16:19], v[168:171]
    ds_read_b64_tr_b16 a[58:59], v35 offset:34816
    v_cvt_pk_bf16_f32 v132, v132, v133
    v_mfma_f32_16x16x32_bf16 v[168:171], a[76:79], a[20:23], v[168:171]
    v_cvt_pk_bf16_f32 v133, v134, v135
    v_cvt_pk_bf16_f32 v134, v228, v229
    v_mfma_f32_16x16x32_bf16 v[104:107], a[80:83], a[16:19], v[104:107]
    ds_read_b64_tr_b16 a[60:61], v35 offset:49152
    v_cvt_pk_bf16_f32 v135, v230, v231
    v_mfma_f32_16x16x32_bf16 v[104:107], a[84:87], a[20:23], v[104:107]
    v_accvgpr_read_b32 v56, a136
    v_accvgpr_read_b32 v57, a137
    v_mfma_f32_16x16x32_bf16 v[200:203], a[88:91], a[16:19], v[200:203]
    s_add_u32 s52, s47, 8192
    ds_read_b64_tr_b16 a[62:63], v35 offset:51200
    v_accvgpr_read_b32 v58, a138
    v_mfma_f32_16x16x32_bf16 v[200:203], a[92:95], a[20:23], v[200:203]
    v_accvgpr_read_b32 v59, a139
    v_accvgpr_read_b32 v60, a140
    v_mfma_f32_16x16x32_bf16 v[136:139], a[96:99], a[16:19], v[136:139]
    v_accvgpr_read_b32 v61, a141
    v_accvgpr_read_b32 v62, a142
    v_mfma_f32_16x16x32_bf16 v[136:139], a[100:103], a[20:23], v[136:139]
    v_accvgpr_read_b32 v63, a143
    v_cvt_pk_bf16_f32 v164, v56, v57
    v_mfma_f32_16x16x32_bf16 v[232:235], a[104:107], a[16:19], v[232:235]
    buffer_store_dwordx4 v[96:99], v1, s[32:35], s52 offen offset:0 sc1
    v_mfma_f32_16x16x32_bf16 v[232:235], a[108:111], a[20:23], v[232:235]
    v_cvt_pk_bf16_f32 v165, v58, v59
    v_cvt_pk_bf16_f32 v72, v72, v73
    v_mfma_f32_16x16x32_bf16 a[144:147], a[112:115], a[16:19], a[144:147]
    v_cvt_pk_bf16_f32 v166, v60, v61
    v_cvt_pk_bf16_f32 v73, v74, v75
    v_mfma_f32_16x16x32_bf16 a[144:147], a[116:119], a[20:23], a[144:147]
    v_cvt_pk_bf16_f32 v167, v62, v63
    v_cvt_pk_bf16_f32 v74, v168, v169
    v_mfma_f32_16x16x32_bf16 a[148:151], a[120:123], a[16:19], a[148:151]
    v_cvt_pk_bf16_f32 v75, v170, v171
    v_cvt_pk_bf16_f32 v104, v104, v105
    v_mfma_f32_16x16x32_bf16 a[148:151], a[124:127], a[20:23], a[148:151]
    v_cvt_pk_bf16_f32 v105, v106, v107
    v_cvt_pk_bf16_f32 v106, v200, v201
    v_mfma_f32_16x16x32_bf16 v[76:79], a[64:67], a[24:27], v[76:79]
    v_cvt_pk_bf16_f32 v107, v202, v203
    v_mfma_f32_16x16x32_bf16 v[76:79], a[68:71], a[28:31], v[76:79]
    v_cvt_pk_bf16_f32 v136, v136, v137
    v_cvt_pk_bf16_f32 v137, v138, v139
    v_mfma_f32_16x16x32_bf16 v[172:175], a[72:75], a[24:27], v[172:175]
    s_add_u32 s52, s47, 524288
    v_cvt_pk_bf16_f32 v138, v232, v233
    v_cvt_pk_bf16_f32 v139, v234, v235
    v_mfma_f32_16x16x32_bf16 v[172:175], a[76:79], a[28:31], v[172:175]
    buffer_store_dwordx4 v[128:131], v1, s[32:35], s52 offen offset:0 sc1
    v_mfma_f32_16x16x32_bf16 v[108:111], a[80:83], a[24:27], v[108:111]
    v_mfma_f32_16x16x32_bf16 v[108:111], a[84:87], a[28:31], v[108:111]
    v_accvgpr_read_b32 v56, a144
    v_accvgpr_read_b32 v57, a145
    v_mfma_f32_16x16x32_bf16 v[204:207], a[88:91], a[24:27], v[204:207]
    v_accvgpr_read_b32 v58, a146
    v_accvgpr_read_b32 v59, a147
    v_mfma_f32_16x16x32_bf16 v[204:207], a[92:95], a[28:31], v[204:207]
    v_accvgpr_read_b32 v60, a148
    v_accvgpr_read_b32 v61, a149
    v_mfma_f32_16x16x32_bf16 v[140:143], a[96:99], a[24:27], v[140:143]
    v_accvgpr_read_b32 v62, a150
    v_accvgpr_read_b32 v63, a151
    v_mfma_f32_16x16x32_bf16 v[140:143], a[100:103], a[28:31], v[140:143]
    v_cvt_pk_bf16_f32 v168, v56, v57
    v_cvt_pk_bf16_f32 v169, v58, v59
    v_mfma_f32_16x16x32_bf16 v[236:239], a[104:107], a[24:27], v[236:239]
    v_cvt_pk_bf16_f32 v76, v76, v77
    v_cvt_pk_bf16_f32 v170, v60, v61
    v_mfma_f32_16x16x32_bf16 v[236:239], a[108:111], a[28:31], v[236:239]
    v_cvt_pk_bf16_f32 v77, v78, v79
    v_cvt_pk_bf16_f32 v171, v62, v63
    v_mfma_f32_16x16x32_bf16 a[152:155], a[112:115], a[24:27], a[152:155]
    s_waitcnt lgkmcnt(0)
    v_cvt_pk_bf16_f32 v78, v172, v173
    v_cvt_pk_bf16_f32 v79, v174, v175
    v_mfma_f32_16x16x32_bf16 a[152:155], a[116:119], a[28:31], a[152:155]
    v_cvt_pk_bf16_f32 v108, v108, v109
    v_cvt_pk_bf16_f32 v109, v110, v111
    v_mfma_f32_16x16x32_bf16 a[156:159], a[120:123], a[24:27], a[156:159]
    v_cvt_pk_bf16_f32 v110, v204, v205
    v_cvt_pk_bf16_f32 v111, v206, v207
    v_mfma_f32_16x16x32_bf16 a[156:159], a[124:127], a[28:31], a[156:159]
    s_add_u32 s52, s47, 532480
    v_mfma_f32_16x16x32_bf16 v[80:83], a[64:67], a[32:35], v[80:83]
    buffer_store_dwordx4 v[160:163], v1, s[32:35], s52 offen offset:0 sc1
    v_mfma_f32_16x16x32_bf16 v[80:83], a[68:71], a[36:39], v[80:83]
    v_cvt_pk_bf16_f32 v140, v140, v141
    v_cvt_pk_bf16_f32 v141, v142, v143
    v_mfma_f32_16x16x32_bf16 v[176:179], a[72:75], a[32:35], v[176:179]
    v_cvt_pk_bf16_f32 v142, v236, v237
    v_cvt_pk_bf16_f32 v143, v238, v239
    v_mfma_f32_16x16x32_bf16 v[176:179], a[76:79], a[36:39], v[176:179]
    v_mfma_f32_16x16x32_bf16 v[112:115], a[80:83], a[32:35], v[112:115]
    v_mfma_f32_16x16x32_bf16 v[112:115], a[84:87], a[36:39], v[112:115]
    v_accvgpr_read_b32 v56, a152
    v_accvgpr_read_b32 v57, a153
    v_mfma_f32_16x16x32_bf16 v[208:211], a[88:91], a[32:35], v[208:211]
    v_accvgpr_read_b32 v58, a154
    v_accvgpr_read_b32 v59, a155
    v_mfma_f32_16x16x32_bf16 v[208:211], a[92:95], a[36:39], v[208:211]
    v_accvgpr_read_b32 v60, a156
    v_accvgpr_read_b32 v61, a157
    v_mfma_f32_16x16x32_bf16 v[144:147], a[96:99], a[32:35], v[144:147]
    v_accvgpr_read_b32 v62, a158
    v_accvgpr_read_b32 v63, a159
    v_mfma_f32_16x16x32_bf16 v[144:147], a[100:103], a[36:39], v[144:147]
    v_cvt_pk_bf16_f32 v172, v56, v57
    v_cvt_pk_bf16_f32 v173, v58, v59
    v_mfma_f32_16x16x32_bf16 v[240:243], a[104:107], a[32:35], v[240:243]
    v_cvt_pk_bf16_f32 v80, v80, v81
    v_cvt_pk_bf16_f32 v174, v60, v61
    v_mfma_f32_16x16x32_bf16 v[240:243], a[108:111], a[36:39], v[240:243]
    s_add_u32 s52, s47, 0
    v_cvt_pk_bf16_f32 v81, v82, v83
    v_cvt_pk_bf16_f32 v175, v62, v63
    v_mfma_f32_16x16x32_bf16 a[160:163], a[112:115], a[32:35], a[160:163]
    v_cvt_pk_bf16_f32 v82, v176, v177
    v_cvt_pk_bf16_f32 v83, v178, v179
    v_mfma_f32_16x16x32_bf16 a[160:163], a[116:119], a[36:39], a[160:163]
    v_cvt_pk_bf16_f32 v112, v112, v113
    v_cvt_pk_bf16_f32 v113, v114, v115
    v_mfma_f32_16x16x32_bf16 a[164:167], a[120:123], a[32:35], a[164:167]
    buffer_store_dwordx4 v[68:71], v1, s[32:35], s52 offen offset:1024 sc1
    v_mfma_f32_16x16x32_bf16 a[164:167], a[124:127], a[36:39], a[164:167]
    v_cvt_pk_bf16_f32 v114, v208, v209
    v_cvt_pk_bf16_f32 v115, v210, v211
    v_mfma_f32_16x16x32_bf16 v[84:87], a[64:67], a[40:43], v[84:87]
    v_mfma_f32_16x16x32_bf16 v[84:87], a[68:71], a[44:47], v[84:87]
    v_cvt_pk_bf16_f32 v144, v144, v145
    v_cvt_pk_bf16_f32 v145, v146, v147
    v_mfma_f32_16x16x32_bf16 v[180:183], a[72:75], a[40:43], v[180:183]
    v_cvt_pk_bf16_f32 v146, v240, v241
    v_cvt_pk_bf16_f32 v147, v242, v243
    v_mfma_f32_16x16x32_bf16 v[180:183], a[76:79], a[44:47], v[180:183]
    v_mfma_f32_16x16x32_bf16 v[116:119], a[80:83], a[40:43], v[116:119]
    v_mfma_f32_16x16x32_bf16 v[116:119], a[84:87], a[44:47], v[116:119]
    v_accvgpr_read_b32 v56, a160
    v_accvgpr_read_b32 v57, a161
    v_mfma_f32_16x16x32_bf16 v[212:215], a[88:91], a[40:43], v[212:215]
    v_accvgpr_read_b32 v58, a162
    v_accvgpr_read_b32 v59, a163
    v_mfma_f32_16x16x32_bf16 v[212:215], a[92:95], a[44:47], v[212:215]
    s_add_u32 s52, s47, 8192
    v_accvgpr_read_b32 v60, a164
    v_accvgpr_read_b32 v61, a165
    v_mfma_f32_16x16x32_bf16 v[148:151], a[96:99], a[40:43], v[148:151]
    v_accvgpr_read_b32 v62, a166
    v_accvgpr_read_b32 v63, a167
    v_mfma_f32_16x16x32_bf16 v[148:151], a[100:103], a[44:47], v[148:151]
    v_cvt_pk_bf16_f32 v176, v56, v57
    v_cvt_pk_bf16_f32 v177, v58, v59
    v_mfma_f32_16x16x32_bf16 v[244:247], a[104:107], a[40:43], v[244:247]
    v_cvt_pk_bf16_f32 v84, v84, v85
    v_cvt_pk_bf16_f32 v178, v60, v61
    v_mfma_f32_16x16x32_bf16 v[244:247], a[108:111], a[44:47], v[244:247]
    buffer_store_dwordx4 v[100:103], v1, s[32:35], s52 offen offset:1024 sc1
    v_mfma_f32_16x16x32_bf16 a[168:171], a[112:115], a[40:43], a[168:171]
    v_cvt_pk_bf16_f32 v85, v86, v87
    v_cvt_pk_bf16_f32 v179, v62, v63
    v_mfma_f32_16x16x32_bf16 a[168:171], a[116:119], a[44:47], a[168:171]
    v_cvt_pk_bf16_f32 v86, v180, v181
    v_cvt_pk_bf16_f32 v87, v182, v183
    v_mfma_f32_16x16x32_bf16 a[172:175], a[120:123], a[40:43], a[172:175]
    v_cvt_pk_bf16_f32 v116, v116, v117
    v_cvt_pk_bf16_f32 v117, v118, v119
    v_mfma_f32_16x16x32_bf16 a[172:175], a[124:127], a[44:47], a[172:175]
    v_cvt_pk_bf16_f32 v118, v212, v213
    v_cvt_pk_bf16_f32 v119, v214, v215
    v_mfma_f32_16x16x32_bf16 v[88:91], a[64:67], a[48:51], v[88:91]
    s_waitcnt vmcnt(12)
    s_barrier
    v_mfma_f32_16x16x32_bf16 v[88:91], a[68:71], a[52:55], v[88:91]
    ds_read_b64_tr_b16 a[0:1], v42 offset:32768
    v_cvt_pk_bf16_f32 v148, v148, v149
    v_mfma_f32_16x16x32_bf16 v[184:187], a[72:75], a[48:51], v[184:187]
    v_cvt_pk_bf16_f32 v149, v150, v151
    v_cvt_pk_bf16_f32 v150, v244, v245
    v_mfma_f32_16x16x32_bf16 v[184:187], a[76:79], a[52:55], v[184:187]
    s_add_u32 s52, s47, 524288
    ds_read_b64_tr_b16 a[2:3], v42 offset:33792
    v_cvt_pk_bf16_f32 v151, v246, v247
    v_mfma_f32_16x16x32_bf16 v[120:123], a[80:83], a[48:51], v[120:123]
    ds_read_b64_tr_b16 a[4:5], v43 offset:32768
    ds_read_b64_tr_b16 a[6:7], v43 offset:33792
    v_mfma_f32_16x16x32_bf16 v[120:123], a[84:87], a[52:55], v[120:123]
    v_accvgpr_read_b32 v56, a168
    v_accvgpr_read_b32 v57, a169
    v_mfma_f32_16x16x32_bf16 v[216:219], a[88:91], a[48:51], v[216:219]
    buffer_store_dwordx4 v[132:135], v1, s[32:35], s52 offen offset:1024 sc1
    ds_read_b64_tr_b16 a[8:9], v44 offset:32768
    v_mfma_f32_16x16x32_bf16 v[216:219], a[92:95], a[52:55], v[216:219]
    v_accvgpr_read_b32 v58, a170
    v_accvgpr_read_b32 v59, a171
    v_mfma_f32_16x16x32_bf16 v[152:155], a[96:99], a[48:51], v[152:155]
    v_accvgpr_read_b32 v60, a172
    v_accvgpr_read_b32 v61, a173
    v_mfma_f32_16x16x32_bf16 v[152:155], a[100:103], a[52:55], v[152:155]
    v_accvgpr_read_b32 v62, a174
    v_accvgpr_read_b32 v63, a175
    v_mfma_f32_16x16x32_bf16 v[248:251], a[104:107], a[48:51], v[248:251]
    ds_read_b64_tr_b16 a[10:11], v44 offset:33792
    v_cvt_pk_bf16_f32 v180, v56, v57
    v_mfma_f32_16x16x32_bf16 v[248:251], a[108:111], a[52:55], v[248:251]
    v_cvt_pk_bf16_f32 v181, v58, v59
    v_cvt_pk_bf16_f32 v88, v88, v89
    v_mfma_f32_16x16x32_bf16 a[176:179], a[112:115], a[48:51], a[176:179]
    v_cvt_pk_bf16_f32 v182, v60, v61
    v_cvt_pk_bf16_f32 v89, v90, v91
    v_mfma_f32_16x16x32_bf16 a[176:179], a[116:119], a[52:55], a[176:179]
    ds_read_b64_tr_b16 a[12:13], v45 offset:32768
    v_cvt_pk_bf16_f32 v183, v62, v63
    v_mfma_f32_16x16x32_bf16 a[180:183], a[120:123], a[48:51], a[180:183]
    v_cvt_pk_bf16_f32 v90, v184, v185
    v_cvt_pk_bf16_f32 v91, v186, v187
    v_mfma_f32_16x16x32_bf16 a[180:183], a[124:127], a[52:55], a[180:183]
    ds_read_b64_tr_b16 a[14:15], v45 offset:33792
    ds_read_b64_tr_b16 a[16:17], v46 offset:32768
    v_mfma_f32_16x16x32_bf16 v[92:95], a[64:67], a[56:59], v[92:95]
    s_add_u32 s52, s47, 532480
    v_cvt_pk_bf16_f32 v120, v120, v121
    v_cvt_pk_bf16_f32 v121, v122, v123
    v_mfma_f32_16x16x32_bf16 v[92:95], a[68:71], a[60:63], v[92:95]
    ds_read_b64_tr_b16 a[18:19], v46 offset:33792
    v_cvt_pk_bf16_f32 v122, v216, v217
    v_mfma_f32_16x16x32_bf16 v[188:191], a[72:75], a[56:59], v[188:191]
    ds_read_b64_tr_b16 a[20:21], v47 offset:32768
    v_cvt_pk_bf16_f32 v123, v218, v219
    v_mfma_f32_16x16x32_bf16 v[188:191], a[76:79], a[60:63], v[188:191]
    ds_read_b64_tr_b16 a[22:23], v47 offset:33792
    v_cvt_pk_bf16_f32 v152, v152, v153
    v_mfma_f32_16x16x32_bf16 v[124:127], a[80:83], a[56:59], v[124:127]
    v_cvt_pk_bf16_f32 v153, v154, v155
    v_cvt_pk_bf16_f32 v154, v248, v249
    v_mfma_f32_16x16x32_bf16 v[124:127], a[84:87], a[60:63], v[124:127]
    buffer_store_dwordx4 v[164:167], v1, s[32:35], s52 offen offset:1024 sc1
    ds_read_b64_tr_b16 a[24:25], v48 offset:32768
    v_mfma_f32_16x16x32_bf16 v[220:223], a[88:91], a[56:59], v[220:223]
    ds_read_b64_tr_b16 a[26:27], v48 offset:33792
    v_cvt_pk_bf16_f32 v155, v250, v251
    v_mfma_f32_16x16x32_bf16 v[220:223], a[92:95], a[60:63], v[220:223]
    ds_read_b64_tr_b16 a[28:29], v49 offset:32768
    v_accvgpr_read_b32 v56, a176
    v_mfma_f32_16x16x32_bf16 v[156:159], a[96:99], a[56:59], v[156:159]
    v_accvgpr_read_b32 v57, a177
    v_accvgpr_read_b32 v58, a178
    v_mfma_f32_16x16x32_bf16 v[156:159], a[100:103], a[60:63], v[156:159]
    ds_read_b64_tr_b16 a[30:31], v49 offset:33792
    v_accvgpr_read_b32 v59, a179
    v_mfma_f32_16x16x32_bf16 v[252:255], a[104:107], a[56:59], v[252:255]
    v_accvgpr_read_b32 v60, a180
    v_accvgpr_read_b32 v61, a181
    v_mfma_f32_16x16x32_bf16 v[252:255], a[108:111], a[60:63], v[252:255]
    v_accvgpr_read_b32 v62, a182
    v_accvgpr_read_b32 v63, a183
    v_mfma_f32_16x16x32_bf16 a[184:187], a[112:115], a[56:59], a[184:187]
    v_cvt_pk_bf16_f32 v184, v56, v57
    v_cvt_pk_bf16_f32 v185, v58, v59
    v_mfma_f32_16x16x32_bf16 a[184:187], a[116:119], a[60:63], a[184:187]
    v_cvt_pk_bf16_f32 v92, v92, v93
    v_cvt_pk_bf16_f32 v186, v60, v61
    v_mfma_f32_16x16x32_bf16 a[188:191], a[120:123], a[56:59], a[188:191]
    v_cvt_pk_bf16_f32 v93, v94, v95
    v_cvt_pk_bf16_f32 v187, v62, v63
    v_mfma_f32_16x16x32_bf16 a[188:191], a[124:127], a[60:63], a[188:191]
    v_cvt_pk_bf16_f32 v94, v188, v189
    v_cvt_pk_bf16_f32 v95, v190, v191
    v_cvt_pk_bf16_f32 v124, v124, v125
    v_cvt_pk_bf16_f32 v125, v126, v127
    v_cvt_pk_bf16_f32 v126, v220, v221
    v_cvt_pk_bf16_f32 v127, v222, v223
    v_cvt_pk_bf16_f32 v156, v156, v157
    v_cvt_pk_bf16_f32 v157, v158, v159
    v_cvt_pk_bf16_f32 v158, v252, v253
    v_cvt_pk_bf16_f32 v159, v254, v255
    v_accvgpr_read_b32 v56, a184
    v_accvgpr_read_b32 v57, a185
    v_accvgpr_read_b32 v58, a186
    v_accvgpr_read_b32 v59, a187
    v_accvgpr_read_b32 v60, a188
    v_accvgpr_read_b32 v61, a189
    v_accvgpr_read_b32 v62, a190
    v_accvgpr_read_b32 v63, a191
    v_cvt_pk_bf16_f32 v188, v56, v57
    v_cvt_pk_bf16_f32 v189, v58, v59
    v_cvt_pk_bf16_f32 v190, v60, v61
    v_cvt_pk_bf16_f32 v191, v62, v63
k12_join_7:
k12_qcode:
    s_mov_b64 s[48:49], s[32:33]
    s_mov_b32 s51, 0x00020000
    s_cmp_eq_u32 s45, 0
    s_mov_b32 s50, s34
    s_cselect_b32 s56, s30, -1
    s_cselect_b32 s57, -1, s30
    s_waitcnt vmcnt(16) lgkmcnt(0)
    v_mfma_f32_16x16x32_bf16 v[192:195], a[0:3], a[192:195], 0
    ds_read_b64_tr_b16 a[32:33], v42 offset:40960
    ds_read_b64_tr_b16 a[34:35], v42 offset:41984
    v_mfma_f32_16x16x32_bf16 v[196:199], a[0:3], a[196:199], 0
    buffer_load_dwordx4 a[240:243], v36, s[8:11], s62 offen sc1
    v_mfma_f32_16x16x32_bf16 a[64:67], a[0:3], a[200:203], 0
    ds_read_b64_tr_b16 a[36:37], v43 offset:40960
    v_mfma_f32_16x16x32_bf16 a[68:71], a[0:3], a[204:207], 0
    ds_read_b64_tr_b16 a[38:39], v43 offset:41984
    v_mfma_f32_16x16x32_bf16 v[200:203], a[4:7], a[192:195], 0
    ds_read_b64_tr_b16 a[40:41], v44 offset:40960
    v_mfma_f32_16x16x32_bf16 v[204:207], a[4:7], a[196:199], 0
    v_mfma_f32_16x16x32_bf16 a[72:75], a[4:7], a[200:203], 0
    s_lshl_b32 s31, s28, 14
    ds_read_b64_tr_b16 a[42:43], v44 offset:41984
    v_mfma_f32_16x16x32_bf16 a[76:79], a[4:7], a[204:207], 0
    s_add_u32 s16, s6, s31
    s_addc_u32 s17, s7, 0
    buffer_load_dwordx4 a[244:247], v54, s[8:11], s62 offen sc1
    ds_read_b64_tr_b16 a[44:45], v45 offset:40960
    v_mfma_f32_16x16x32_bf16 v[208:211], a[8:11], a[192:195], 0
    v_mfma_f32_16x16x32_bf16 v[212:215], a[8:11], a[196:199], 0
    s_add_u32 s20, s16, 0x2000000
    s_addc_u32 s21, s17, 0
    ds_read_b64_tr_b16 a[46:47], v45 offset:41984
    v_mfma_f32_16x16x32_bf16 a[80:83], a[8:11], a[200:203], 0
    ds_read_b64_tr_b16 a[48:49], v46 offset:40960
    v_mfma_f32_16x16x32_bf16 a[84:87], a[8:11], a[204:207], 0
    s_add_u32 s16, s16, 0x1000000
    s_addc_u32 s17, s17, 0
    ds_read_b64_tr_b16 a[50:51], v46 offset:41984
    v_mfma_f32_16x16x32_bf16 v[216:219], a[12:15], a[192:195], 0
    v_mfma_f32_16x16x32_bf16 v[220:223], a[12:15], a[196:199], 0
    s_and_b32 s17, s17, 0xffff
    ds_read_b64_tr_b16 a[52:53], v47 offset:40960
    v_mfma_f32_16x16x32_bf16 a[88:91], a[12:15], a[200:203], 0
    buffer_load_dwordx4 a[248:251], v37, s[8:11], s62 offen sc1
    ds_read_b64_tr_b16 a[54:55], v47 offset:41984
    v_mfma_f32_16x16x32_bf16 a[92:95], a[12:15], a[204:207], 0
    s_and_b32 s21, s21, 0xffff
    ds_read_b64_tr_b16 a[56:57], v48 offset:40960
    v_mfma_f32_16x16x32_bf16 v[224:227], a[16:19], a[192:195], 0
    v_mfma_f32_16x16x32_bf16 v[228:231], a[16:19], a[196:199], 0
    s_lshl_b32 s31, s29, 20
    ds_read_b64_tr_b16 a[58:59], v48 offset:41984
    v_mfma_f32_16x16x32_bf16 a[96:99], a[16:19], a[200:203], 0
    ds_read_b64_tr_b16 a[60:61], v49 offset:40960
    v_mfma_f32_16x16x32_bf16 a[100:103], a[16:19], a[204:207], 0
    s_sub_u32 s18, 0xf84000, s31
    v_mfma_f32_16x16x32_bf16 v[232:235], a[20:23], a[192:195], 0
    buffer_load_dwordx4 a[252:255], v55, s[8:11], s62 offen sc1
    ds_read_b64_tr_b16 a[62:63], v49 offset:41984
    v_mfma_f32_16x16x32_bf16 v[236:239], a[20:23], a[196:199], 0
    s_mov_b32 s22, s18
    v_mfma_f32_16x16x32_bf16 a[104:107], a[20:23], a[200:203], 0
    v_mfma_f32_16x16x32_bf16 a[108:111], a[20:23], a[204:207], 0
    s_add_u32 s24, s6, 0x4806000
    s_addc_u32 s25, s7, 0
    v_mfma_f32_16x16x32_bf16 v[240:243], a[24:27], a[192:195], 0
    v_mfma_f32_16x16x32_bf16 v[244:247], a[24:27], a[196:199], 0
    s_and_b32 s25, s25, 0xffff
    v_mfma_f32_16x16x32_bf16 a[112:115], a[24:27], a[200:203], 0
    s_add_u32 s62, s62, 0x20000
    v_mfma_f32_16x16x32_bf16 a[116:119], a[24:27], a[204:207], 0
    s_mov_b32 s26, 4096
    v_mfma_f32_16x16x32_bf16 v[248:251], a[28:31], a[192:195], 0
    s_cmp_eq_u32 s45, 0
    s_cbranch_scc1 k12_ool_48
k12_oolret_49:
    v_mfma_f32_16x16x32_bf16 v[252:255], a[28:31], a[196:199], 0
    v_mfma_f32_16x16x32_bf16 a[120:123], a[28:31], a[200:203], 0
    v_mfma_f32_16x16x32_bf16 a[124:127], a[28:31], a[204:207], 0
    s_waitcnt vmcnt(16) lgkmcnt(0)
    s_barrier
    v_mfma_f32_16x16x32_bf16 v[192:195], a[32:35], a[208:211], v[192:195]
    ds_read_b64_tr_b16 a[0:1], v42 offset:49152
    ds_read_b64_tr_b16 a[2:3], v42 offset:50176
    v_mfma_f32_16x16x32_bf16 v[196:199], a[32:35], a[212:215], v[196:199]
    s_add_u32 m0, s60, 98304
    v_mfma_f32_16x16x32_bf16 a[64:67], a[32:35], a[216:219], a[64:67]
    buffer_load_dwordx4 v38, s[12:15], s61 offen offset:0 lds
    ds_read_b64_tr_b16 a[4:5], v43 offset:49152
    v_mfma_f32_16x16x32_bf16 a[68:71], a[32:35], a[220:223], a[68:71]
    ds_read_b64_tr_b16 a[6:7], v43 offset:50176
    v_mfma_f32_16x16x32_bf16 v[200:203], a[36:39], a[208:211], v[200:203]
    buffer_load_dwordx4 v39, s[12:15], s61 offen offset:1024 lds
    ds_read_b64_tr_b16 a[8:9], v44 offset:49152
    v_mfma_f32_16x16x32_bf16 v[204:207], a[36:39], a[212:215], v[204:207]
    v_mfma_f32_16x16x32_bf16 a[72:75], a[36:39], a[216:219], a[72:75]
    ds_read_b64_tr_b16 a[10:11], v44 offset:50176
    v_mfma_f32_16x16x32_bf16 a[76:79], a[36:39], a[220:223], a[76:79]
    buffer_load_dwordx4 v40, s[12:15], s61 offen offset:2048 lds
    ds_read_b64_tr_b16 a[12:13], v45 offset:49152
    v_mfma_f32_16x16x32_bf16 v[208:211], a[40:43], a[208:211], v[208:211]
    v_mfma_f32_16x16x32_bf16 v[212:215], a[40:43], a[212:215], v[212:215]
    ds_read_b64_tr_b16 a[14:15], v45 offset:50176
    v_mfma_f32_16x16x32_bf16 a[80:83], a[40:43], a[216:219], a[80:83]
    buffer_load_dwordx4 v41, s[12:15], s61 offen offset:3072 lds
    ds_read_b64_tr_b16 a[16:17], v46 offset:49152
    v_mfma_f32_16x16x32_bf16 a[84:87], a[40:43], a[220:223], a[84:87]
    ds_read_b64_tr_b16 a[18:19], v46 offset:50176
    v_mfma_f32_16x16x32_bf16 v[216:219], a[44:47], a[208:211], v[216:219]
    s_add_u32 s61, s61, 0x80000
    v_mfma_f32_16x16x32_bf16 v[220:223], a[44:47], a[212:215], v[220:223]
    buffer_load_dwordx4 a[128:131], v36, s[8:11], s62 offen sc1
    ds_read_b64_tr_b16 a[20:21], v47 offset:49152
    v_mfma_f32_16x16x32_bf16 a[88:91], a[44:47], a[216:219], a[88:91]
    ds_read_b64_tr_b16 a[22:23], v47 offset:50176
    v_mfma_f32_16x16x32_bf16 a[92:95], a[44:47], a[220:223], a[92:95]
    buffer_load_dwordx4 a[132:135], v54, s[8:11], s62 offen sc1
    ds_read_b64_tr_b16 a[24:25], v48 offset:49152
    v_mfma_f32_16x16x32_bf16 v[224:227], a[48:51], a[208:211], v[224:227]
    v_mfma_f32_16x16x32_bf16 v[228:231], a[48:51], a[212:215], v[228:231]
    ds_read_b64_tr_b16 a[26:27], v48 offset:50176
    v_mfma_f32_16x16x32_bf16 a[96:99], a[48:51], a[216:219], a[96:99]
    buffer_load_dwordx4 a[136:139], v37, s[8:11], s62 offen sc1
    ds_read_b64_tr_b16 a[28:29], v49 offset:49152
    v_mfma_f32_16x16x32_bf16 a[100:103], a[48:51], a[220:223], a[100:103]
    v_mfma_f32_16x16x32_bf16 v[232:235], a[52:55], a[208:211], v[232:235]
    ds_read_b64_tr_b16 a[30:31], v49 offset:50176
    v_mfma_f32_16x16x32_bf16 v[236:239], a[52:55], a[212:215], v[236:239]
    buffer_load_dwordx4 a[140:143], v55, s[8:11], s62 offen sc1
    v_mfma_f32_16x16x32_bf16 a[104:107], a[52:55], a[216:219], a[104:107]
    v_mfma_f32_16x16x32_bf16 a[108:111], a[52:55], a[220:223], a[108:111]
    s_add_u32 s62, s62, 0x20000
    v_mfma_f32_16x16x32_bf16 v[240:243], a[56:59], a[208:211], v[240:243]
    s_add_u32 s52, s47, 0
    v_mfma_f32_16x16x32_bf16 v[244:247], a[56:59], a[212:215], v[244:247]
    buffer_store_dwordx4 v[72:75], v1, s[48:51], s52 offen offset:2048 sc1
    v_mfma_f32_16x16x32_bf16 a[112:115], a[56:59], a[216:219], a[112:115]
    v_mfma_f32_16x16x32_bf16 a[116:119], a[56:59], a[220:223], a[116:119]
    v_mfma_f32_16x16x32_bf16 v[248:251], a[60:63], a[208:211], v[248:251]
    v_mfma_f32_16x16x32_bf16 v[252:255], a[60:63], a[212:215], v[252:255]
    v_mfma_f32_16x16x32_bf16 a[120:123], a[60:63], a[216:219], a[120:123]
    v_mfma_f32_16x16x32_bf16 a[124:127], a[60:63], a[220:223], a[124:127]
    s_waitcnt vmcnt(21) lgkmcnt(0)
    v_mfma_f32_16x16x32_bf16 v[192:195], a[0:3], a[224:227], v[192:195]
    ds_read_b64_tr_b16 a[32:33], v42 offset:57344
    ds_read_b64_tr_b16 a[34:35], v42 offset:58368
    v_mfma_f32_16x16x32_bf16 v[196:199], a[0:3], a[228:231], v[196:199]
    buffer_load_dwordx4 a[144:147], v36, s[8:11], s62 offen sc1
    v_mfma_f32_16x16x32_bf16 a[64:67], a[0:3], a[232:235], a[64:67]
    ds_read_b64_tr_b16 a[36:37], v43 offset:57344
    v_mfma_f32_16x16x32_bf16 a[68:71], a[0:3], a[236:239], a[68:71]
    ds_read_b64_tr_b16 a[38:39], v43 offset:58368
    v_mfma_f32_16x16x32_bf16 v[200:203], a[4:7], a[224:227], v[200:203]
    ds_read_b64_tr_b16 a[40:41], v44 offset:57344
    v_mfma_f32_16x16x32_bf16 v[204:207], a[4:7], a[228:231], v[204:207]
    v_mfma_f32_16x16x32_bf16 a[72:75], a[4:7], a[232:235], a[72:75]
    buffer_load_dwordx4 a[148:151], v54, s[8:11], s62 offen sc1
    ds_read_b64_tr_b16 a[42:43], v44 offset:58368
    v_mfma_f32_16x16x32_bf16 a[76:79], a[4:7], a[236:239], a[76:79]
    ds_read_b64_tr_b16 a[44:45], v45 offset:57344
    v_mfma_f32_16x16x32_bf16 v[208:211], a[8:11], a[224:227], v[208:211]
    v_mfma_f32_16x16x32_bf16 v[212:215], a[8:11], a[228:231], v[212:215]
    ds_read_b64_tr_b16 a[46:47], v45 offset:58368
    v_mfma_f32_16x16x32_bf16 a[80:83], a[8:11], a[232:235], a[80:83]
    ds_read_b64_tr_b16 a[48:49], v46 offset:57344
    v_mfma_f32_16x16x32_bf16 a[84:87], a[8:11], a[236:239], a[84:87]
    buffer_load_dwordx4 a[152:155], v37, s[8:11], s62 offen sc1
    ds_read_b64_tr_b16 a[50:51], v46 offset:58368
    v_mfma_f32_16x16x32_bf16 v[216:219], a[12:15], a[224:227], v[216:219]
    v_mfma_f32_16x16x32_bf16 v[220:223], a[12:15], a[228:231], v[220:223]
    ds_read_b64_tr_b16 a[52:53], v47 offset:57344
    v_mfma_f32_16x16x32_bf16 a[88:91], a[12:15], a[232:235], a[88:91]
    ds_read_b64_tr_b16 a[54:55], v47 offset:58368
    v_mfma_f32_16x16x32_bf16 a[92:95], a[12:15], a[236:239], a[92:95]
    ds_read_b64_tr_b16 a[56:57], v48 offset:57344
    v_mfma_f32_16x16x32_bf16 v[224:227], a[16:19], a[224:227], v[224:227]
    v_mfma_f32_16x16x32_bf16 v[228:231], a[16:19], a[228:231], v[228:231]
    buffer_load_dwordx4 a[156:159], v55, s[8:11], s62 offen sc1
    ds_read_b64_tr_b16 a[58:59], v48 offset:58368
    v_mfma_f32_16x16x32_bf16 a[96:99], a[16:19], a[232:235], a[96:99]
    ds_read_b64_tr_b16 a[60:61], v49 offset:57344
    v_mfma_f32_16x16x32_bf16 a[100:103], a[16:19], a[236:239], a[100:103]
    v_mfma_f32_16x16x32_bf16 v[232:235], a[20:23], a[224:227], v[232:235]
    ds_read_b64_tr_b16 a[62:63], v49 offset:58368
    v_mfma_f32_16x16x32_bf16 v[236:239], a[20:23], a[228:231], v[236:239]
    s_add_u32 s62, s62, 0x20000
    v_mfma_f32_16x16x32_bf16 a[104:107], a[20:23], a[232:235], a[104:107]
    s_add_u32 s52, s47, 0
    v_mfma_f32_16x16x32_bf16 a[108:111], a[20:23], a[236:239], a[108:111]
    buffer_store_dwordx4 v[76:79], v1, s[48:51], s52 offen offset:3072 sc1
    v_mfma_f32_16x16x32_bf16 v[240:243], a[24:27], a[224:227], v[240:243]
    v_mfma_f32_16x16x32_bf16 v[244:247], a[24:27], a[228:231], v[244:247]
    v_mfma_f32_16x16x32_bf16 a[112:115], a[24:27], a[232:235], a[112:115]
    v_mfma_f32_16x16x32_bf16 a[116:119], a[24:27], a[236:239], a[116:119]
    v_mfma_f32_16x16x32_bf16 v[248:251], a[28:31], a[224:227], v[248:251]
    s_cmp_eq_u32 s45, 0
    s_cbranch_scc1 k12_ool_50
k12_oolret_51:
    v_mfma_f32_16x16x32_bf16 v[252:255], a[28:31], a[228:231], v[252:255]
    v_mfma_f32_16x16x32_bf16 a[120:123], a[28:31], a[232:235], a[120:123]
    v_mfma_f32_16x16x32_bf16 a[124:127], a[28:31], a[236:239], a[124:127]
    s_waitcnt vmcnt(10) lgkmcnt(0)
    s_barrier
    v_mfma_f32_16x16x32_bf16 v[192:195], a[32:35], a[240:243], v[192:195]
    ds_read_b64_tr_b16 a[0:1], v42 offset:0
    ds_read_b64_tr_b16 a[2:3], v42 offset:1024
    v_mfma_f32_16x16x32_bf16 v[196:199], a[32:35], a[244:247], v[196:199]
    s_add_u32 m0, s60, 114688
    v_mfma_f32_16x16x32_bf16 a[64:67], a[32:35], a[248:251], a[64:67]
    buffer_load_dwordx4 v38, s[12:15], s61 offen offset:0 lds
    ds_read_b64_tr_b16 a[4:5], v43 offset:0
    v_mfma_f32_16x16x32_bf16 a[68:71], a[32:35], a[252:255], a[68:71]
    ds_read_b64_tr_b16 a[6:7], v43 offset:1024
    v_mfma_f32_16x16x32_bf16 v[200:203], a[36:39], a[240:243], v[200:203]
    buffer_load_dwordx4 v39, s[12:15], s61 offen offset:1024 lds
    ds_read_b64_tr_b16 a[8:9], v44 offset:0
    v_mfma_f32_16x16x32_bf16 v[204:207], a[36:39], a[244:247], v[204:207]
    v_mfma_f32_16x16x32_bf16 a[72:75], a[36:39], a[248:251], a[72:75]
    ds_read_b64_tr_b16 a[10:11], v44 offset:1024
    v_mfma_f32_16x16x32_bf16 a[76:79], a[36:39], a[252:255], a[76:79]
    buffer_load_dwordx4 v40, s[12:15], s61 offen offset:2048 lds
    ds_read_b64_tr_b16 a[12:13], v45 offset:0
    v_mfma_f32_16x16x32_bf16 v[208:211], a[40:43], a[240:243], v[208:211]
    v_mfma_f32_16x16x32_bf16 v[212:215], a[40:43], a[244:247], v[212:215]
    ds_read_b64_tr_b16 a[14:15], v45 offset:1024
    v_mfma_f32_16x16x32_bf16 a[80:83], a[40:43], a[248:251], a[80:83]
    buffer_load_dwordx4 v41, s[12:15], s61 offen offset:3072 lds
    ds_read_b64_tr_b16 a[16:17], v46 offset:0
    v_mfma_f32_16x16x32_bf16 a[84:87], a[40:43], a[252:255], a[84:87]
    ds_read_b64_tr_b16 a[18:19], v46 offset:1024
    v_mfma_f32_16x16x32_bf16 v[216:219], a[44:47], a[240:243], v[216:219]
    s_add_u32 s61, s61, 0x80000
    v_mfma_f32_16x16x32_bf16 v[220:223], a[44:47], a[244:247], v[220:223]
    buffer_load_dwordx4 a[160:163], v36, s[8:11], s62 offen sc1
    ds_read_b64_tr_b16 a[20:21], v47 offset:0
    v_mfma_f32_16x16x32_bf16 a[88:91], a[44:47], a[248:251], a[88:91]
    ds_read_b64_tr_b16 a[22:23], v47 offset:1024
    v_mfma_f32_16x16x32_bf16 a[92:95], a[44:47], a[252:255], a[92:95]
    buffer_load_dwordx4 a[164:167], v54, s[8:11], s62 offen sc1
    ds_read_b64_tr_b16 a[24:25], v48 offset:0
    v_mfma_f32_16x16x32_bf16 v[224:227], a[48:51], a[240:243], v[224:227]
    v_mfma_f32_16x16x32_bf16 v[228:231], a[48:51], a[244:247], v[228:231]
    ds_read_b64_tr_b16 a[26:27], v48 offset:1024
    v_mfma_f32_16x16x32_bf16 a[96:99], a[48:51], a[248:251], a[96:99]
    buffer_load_dwordx4 a[168:171], v37, s[8:11], s62 offen sc1
    ds_read_b64_tr_b16 a[28:29], v49 offset:0
    v_mfma_f32_16x16x32_bf16 a[100:103], a[48:51], a[252:255], a[100:103]
    v_mfma_f32_16x16x32_bf16 v[232:235], a[52:55], a[240:243], v[232:235]
    ds_read_b64_tr_b16 a[30:31], v49 offset:1024
    v_mfma_f32_16x16x32_bf16 v[236:239], a[52:55], a[244:247], v[236:239]
    buffer_load_dwordx4 a[172:175], v55, s[8:11], s62 offen sc1
    v_mfma_f32_16x16x32_bf16 a[104:107], a[52:55], a[248:251], a[104:107]
    v_mfma_f32_16x16x32_bf16 a[108:111], a[52:55], a[252:255], a[108:111]
    s_add_u32 s62, s62, 0x20000
    v_mfma_f32_16x16x32_bf16 v[240:243], a[56:59], a[240:243], v[240:243]
    s_add_u32 s52, s47, 4096
    v_mfma_f32_16x16x32_bf16 v[244:247], a[56:59], a[244:247], v[244:247]
    buffer_store_dwordx4 v[80:83], v1, s[48:51], s52 offen offset:0 sc1
    v_mfma_f32_16x16x32_bf16 a[112:115], a[56:59], a[248:251], a[112:115]
    v_mfma_f32_16x16x32_bf16 a[116:119], a[56:59], a[252:255], a[116:119]
    v_mfma_f32_16x16x32_bf16 v[248:251], a[60:63], a[240:243], v[248:251]
    v_mfma_f32_16x16x32_bf16 v[252:255], a[60:63], a[244:247], v[252:255]
    v_mfma_f32_16x16x32_bf16 a[120:123], a[60:63], a[248:251], a[120:123]
    v_mfma_f32_16x16x32_bf16 a[124:127], a[60:63], a[252:255], a[124:127]
    s_waitcnt vmcnt(15) lgkmcnt(0)
    v_mfma_f32_16x16x32_bf16 v[192:195], a[0:3], a[128:131], v[192:195]
    ds_read_b64_tr_b16 a[32:33], v42 offset:8192
    ds_read_b64_tr_b16 a[34:35], v42 offset:9216
    v_mfma_f32_16x16x32_bf16 v[196:199], a[0:3], a[132:135], v[196:199]
    buffer_load_dwordx4 a[176:179], v36, s[8:11], s62 offen sc1
    v_mfma_f32_16x16x32_bf16 a[64:67], a[0:3], a[136:139], a[64:67]
    ds_read_b64_tr_b16 a[36:37], v43 offset:8192
    v_mfma_f32_16x16x32_bf16 a[68:71], a[0:3], a[140:143], a[68:71]
    ds_read_b64_tr_b16 a[38:39], v43 offset:9216
    v_mfma_f32_16x16x32_bf16 v[200:203], a[4:7], a[128:131], v[200:203]
    ds_read_b64_tr_b16 a[40:41], v44 offset:8192
    v_mfma_f32_16x16x32_bf16 v[204:207], a[4:7], a[132:135], v[204:207]
    v_mfma_f32_16x16x32_bf16 a[72:75], a[4:7], a[136:139], a[72:75]
    buffer_load_dwordx4 a[180:183], v54, s[8:11], s62 offen sc1
    ds_read_b64_tr_b16 a[42:43], v44 offset:9216
    v_mfma_f32_16x16x32_bf16 a[76:79], a[4:7], a[140:143], a[76:79]
    ds_read_b64_tr_b16 a[44:45], v45 offset:8192
    v_mfma_f32_16x16x32_bf16 v[208:211], a[8:11], a[128:131], v[208:211]
    v_mfma_f32_16x16x32_bf16 v[212:215], a[8:11], a[132:135], v[212:215]
    ds_read_b64_tr_b16 a[46:47], v45 offset:9216
    v_mfma_f32_16x16x32_bf16 a[80:83], a[8:11], a[136:139], a[80:83]
    ds_read_b64_tr_b16 a[48:49], v46 offset:8192
    v_mfma_f32_16x16x32_bf16 a[84:87], a[8:11], a[140:143], a[84:87]
    buffer_load_dwordx4 a[184:187], v37, s[8:11], s62 offen sc1
    ds_read_b64_tr_b16 a[50:51], v46 offset:9216
    v_mfma_f32_16x16x32_bf16 v[216:219], a[12:15], a[128:131], v[216:219]
    v_mfma_f32_16x16x32_bf16 v[220:223], a[12:15], a[132:135], v[220:223]
    ds_read_b64_tr_b16 a[52:53], v47 offset:8192
    v_mfma_f32_16x16x32_bf16 a[88:91], a[12:15], a[136:139], a[88:91]
    ds_read_b64_tr_b16 a[54:55], v47 offset:9216
    v_mfma_f32_16x16x32_bf16 a[92:95], a[12:15], a[140:143], a[92:95]
    ds_read_b64_tr_b16 a[56:57], v48 offset:8192
    v_mfma_f32_16x16x32_bf16 v[224:227], a[16:19], a[128:131], v[224:227]
    v_mfma_f32_16x16x32_bf16 v[228:231], a[16:19], a[132:135], v[228:231]
    buffer_load_dwordx4 a[188:191], v55, s[8:11], s62 offen sc1
    ds_read_b64_tr_b16 a[58:59], v48 offset:9216
    v_mfma_f32_16x16x32_bf16 a[96:99], a[16:19], a[136:139], a[96:99]
    ds_read_b64_tr_b16 a[60:61], v49 offset:8192
    v_mfma_f32_16x16x32_bf16 a[100:103], a[16:19], a[140:143], a[100:103]
    v_mfma_f32_16x16x32_bf16 v[232:235], a[20:23], a[128:131], v[232:235]
    ds_read_b64_tr_b16 a[62:63], v49 offset:9216
    v_mfma_f32_16x16x32_bf16 v[236:239], a[20:23], a[132:135], v[236:239]
    s_add_u32 s62, s62, 0x20000
    v_mfma_f32_16x16x32_bf16 a[104:107], a[20:23], a[136:139], a[104:107]
    s_add_u32 s52, s47, 4096
    v_mfma_f32_16x16x32_bf16 a[108:111], a[20:23], a[140:143], a[108:111]
    buffer_store_dwordx4 v[84:87], v1, s[48:51], s52 offen offset:1024 sc1
    v_mfma_f32_16x16x32_bf16 v[240:243], a[24:27], a[128:131], v[240:243]
    v_mfma_f32_16x16x32_bf16 v[244:247], a[24:27], a[132:135], v[244:247]
    v_mfma_f32_16x16x32_bf16 a[112:115], a[24:27], a[136:139], a[112:115]
    v_mfma_f32_16x16x32_bf16 a[116:119], a[24:27], a[140:143], a[116:119]
    v_mfma_f32_16x16x32_bf16 v[248:251], a[28:31], a[128:131], v[248:251]
    v_mfma_f32_16x16x32_bf16 v[252:255], a[28:31], a[132:135], v[252:255]
    v_mfma_f32_16x16x32_bf16 a[120:123], a[28:31], a[136:139], a[120:123]
    v_mfma_f32_16x16x32_bf16 a[124:127], a[28:31], a[140:143], a[124:127]
    s_waitcnt vmcnt(10) lgkmcnt(0)
    s_barrier
    v_mfma_f32_16x16x32_bf16 v[192:195], a[32:35], a[144:147], v[192:195]
    ds_read_b64_tr_b16 a[0:1], v42 offset:16384
    ds_read_b64_tr_b16 a[2:3], v42 offset:17408
    v_mfma_f32_16x16x32_bf16 v[196:199], a[32:35], a[148:151], v[196:199]
    s_add_u32 m0, s60, 131072
    v_mfma_f32_16x16x32_bf16 a[64:67], a[32:35], a[152:155], a[64:67]
    buffer_load_dwordx4 v38, s[12:15], s61 offen offset:0 lds
    ds_read_b64_tr_b16 a[4:5], v43 offset:16384
    v_mfma_f32_16x16x32_bf16 a[68:71], a[32:35], a[156:159], a[68:71]
    ds_read_b64_tr_b16 a[6:7], v43 offset:17408
    v_mfma_f32_16x16x32_bf16 v[200:203], a[36:39], a[144:147], v[200:203]
    buffer_load_dwordx4 v39, s[12:15], s61 offen offset:1024 lds
    ds_read_b64_tr_b16 a[8:9], v44 offset:16384
    v_mfma_f32_16x16x32_bf16 v[204:207], a[36:39], a[148:151], v[204:207]
    v_mfma_f32_16x16x32_bf16 a[72:75], a[36:39], a[152:155], a[72:75]
    ds_read_b64_tr_b16 a[10:11], v44 offset:17408
    v_mfma_f32_16x16x32_bf16 a[76:79], a[36:39], a[156:159], a[76:79]
    buffer_load_dwordx4 v40, s[12:15], s61 offen offset:2048 lds
    ds_read_b64_tr_b16 a[12:13], v45 offset:16384
    v_mfma_f32_16x16x32_bf16 v[208:211], a[40:43], a[144:147], v[208:211]
    v_mfma_f32_16x16x32_bf16 v[212:215], a[40:43], a[148:151], v[212:215]
    ds_read_b64_tr_b16 a[14:15], v45 offset:17408
    v_mfma_f32_16x16x32_bf16 a[80:83], a[40:43], a[152:155], a[80:83]
    ds_read_b64_tr_b16 a[16:17], v46 offset:16384
    v_mfma_f32_16x16x32_bf16 a[84:87], a[40:43], a[156:159], a[84:87]
    buffer_load_dwordx4 v41, s[12:15], s61 offen offset:3072 lds
    ds_read_b64_tr_b16 a[18:19], v46 offset:17408
    v_mfma_f32_16x16x32_bf16 v[216:219], a[44:47], a[144:147], v[216:219]
    v_mfma_f32_16x16x32_bf16 v[220:223], a[44:47], a[148:151], v[220:223]
    s_add_u32 s61, s61, 0x80000
    ds_read_b64_tr_b16 a[20:21], v47 offset:16384
    v_mfma_f32_16x16x32_bf16 a[88:91], a[44:47], a[152:155], a[88:91]
    buffer_load_dwordx4 a[192:195], v36, s[8:11], s62 offen sc1
    ds_read_b64_tr_b16 a[22:23], v47 offset:17408
    v_mfma_f32_16x16x32_bf16 a[92:95], a[44:47], a[156:159], a[92:95]
    ds_read_b64_tr_b16 a[24:25], v48 offset:16384
    v_mfma_f32_16x16x32_bf16 v[224:227], a[48:51], a[144:147], v[224:227]
    v_mfma_f32_16x16x32_bf16 v[228:231], a[48:51], a[148:151], v[228:231]
    buffer_load_dwordx4 a[196:199], v54, s[8:11], s62 offen sc1
    ds_read_b64_tr_b16 a[26:27], v48 offset:17408
    v_mfma_f32_16x16x32_bf16 a[96:99], a[48:51], a[152:155], a[96:99]
    ds_read_b64_tr_b16 a[28:29], v49 offset:16384
    v_mfma_f32_16x16x32_bf16 a[100:103], a[48:51], a[156:159], a[100:103]
    v_mfma_f32_16x16x32_bf16 v[232:235], a[52:55], a[144:147], v[232:235]
    buffer_load_dwordx4 a[200:203], v37, s[8:11], s62 offen sc1
    ds_read_b64_tr_b16 a[30:31], v49 offset:17408
    v_mfma_f32_16x16x32_bf16 v[236:239], a[52:55], a[148:151], v[236:239]
    v_mfma_f32_16x16x32_bf16 a[104:107], a[52:55], a[152:155], a[104:107]
    v_mfma_f32_16x16x32_bf16 a[108:111], a[52:55], a[156:159], a[108:111]
    v_mfma_f32_16x16x32_bf16 v[240:243], a[56:59], a[144:147], v[240:243]
    buffer_load_dwordx4 a[204:207], v55, s[8:11], s62 offen sc1
    v_mfma_f32_16x16x32_bf16 v[244:247], a[56:59], a[148:151], v[244:247]
    v_mfma_f32_16x16x32_bf16 a[112:115], a[56:59], a[152:155], a[112:115]
    s_add_u32 s62, s62, 0x20000
    v_mfma_f32_16x16x32_bf16 a[116:119], a[56:59], a[156:159], a[116:119]
    v_mfma_f32_16x16x32_bf16 v[248:251], a[60:63], a[144:147], v[248:251]
    s_cmp_eq_u32 s45, 0
    s_cbranch_scc1 k12_ool_52
k12_oolret_53:
    v_mfma_f32_16x16x32_bf16 v[252:255], a[60:63], a[148:151], v[252:255]
    v_mfma_f32_16x16x32_bf16 a[120:123], a[60:63], a[152:155], a[120:123]
    v_mfma_f32_16x16x32_bf16 a[124:127], a[60:63], a[156:159], a[124:127]
    s_waitcnt vmcnt(14) lgkmcnt(0)
    v_mfma_f32_16x16x32_bf16 v[192:195], a[0:3], a[160:163], v[192:195]
    ds_read_b64_tr_b16 a[32:33], v42 offset:24576
    ds_read_b64_tr_b16 a[34:35], v42 offset:25600
    v_mfma_f32_16x16x32_bf16 v[196:199], a[0:3], a[164:167], v[196:199]
    buffer_load_dwordx4 a[208:211], v36, s[8:11], s62 offen sc1
    v_mfma_f32_16x16x32_bf16 a[64:67], a[0:3], a[168:171], a[64:67]
    ds_read_b64_tr_b16 a[36:37], v43 offset:24576
    v_mfma_f32_16x16x32_bf16 a[68:71], a[0:3], a[172:175], a[68:71]
    ds_read_b64_tr_b16 a[38:39], v43 offset:25600
    v_mfma_f32_16x16x32_bf16 v[200:203], a[4:7], a[160:163], v[200:203]
    ds_read_b64_tr_b16 a[40:41], v44 offset:24576
    v_mfma_f32_16x16x32_bf16 v[204:207], a[4:7], a[164:167], v[204:207]
    v_mfma_f32_16x16x32_bf16 a[72:75], a[4:7], a[168:171], a[72:75]
    buffer_load_dwordx4 a[212:215], v54, s[8:11], s62 offen sc1
    ds_read_b64_tr_b16 a[42:43], v44 offset:25600
    v_mfma_f32_16x16x32_bf16 a[76:79], a[4:7], a[172:175], a[76:79]
    ds_read_b64_tr_b16 a[44:45], v45 offset:24576
    v_mfma_f32_16x16x32_bf16 v[208:211], a[8:11], a[160:163], v[208:211]
    v_mfma_f32_16x16x32_bf16 v[212:215], a[8:11], a[164:167], v[212:215]
    ds_read_b64_tr_b16 a[46:47], v45 offset:25600
    v_mfma_f32_16x16x32_bf16 a[80:83], a[8:11], a[168:171], a[80:83]
    ds_read_b64_tr_b16 a[48:49], v46 offset:24576
    v_mfma_f32_16x16x32_bf16 a[84:87], a[8:11], a[172:175], a[84:87]
    buffer_load_dwordx4 a[216:219], v37, s[8:11], s62 offen sc1
    ds_read_b64_tr_b16 a[50:51], v46 offset:25600
    v_mfma_f32_16x16x32_bf16 v[216:219], a[12:15], a[160:163], v[216:219]
    v_mfma_f32_16x16x32_bf16 v[220:223], a[12:15], a[164:167], v[220:223]
    ds_read_b64_tr_b16 a[52:53], v47 offset:24576
    v_mfma_f32_16x16x32_bf16 a[88:91], a[12:15], a[168:171], a[88:91]
    ds_read_b64_tr_b16 a[54:55], v47 offset:25600
    v_mfma_f32_16x16x32_bf16 a[92:95], a[12:15], a[172:175], a[92:95]
    ds_read_b64_tr_b16 a[56:57], v48 offset:24576
    v_mfma_f32_16x16x32_bf16 v[224:227], a[16:19], a[160:163], v[224:227]
    v_mfma_f32_16x16x32_bf16 v[228:231], a[16:19], a[164:167], v[228:231]
    buffer_load_dwordx4 a[220:223], v55, s[8:11], s62 offen sc1
    ds_read_b64_tr_b16 a[58:59], v48 offset:25600
    v_mfma_f32_16x16x32_bf16 a[96:99], a[16:19], a[168:171], a[96:99]
    ds_read_b64_tr_b16 a[60:61], v49 offset:24576
    v_mfma_f32_16x16x32_bf16 a[100:103], a[16:19], a[172:175], a[100:103]
    v_mfma_f32_16x16x32_bf16 v[232:235], a[20:23], a[160:163], v[232:235]
    ds_read_b64_tr_b16 a[62:63], v49 offset:25600
    v_mfma_f32_16x16x32_bf16 v[236:239], a[20:23], a[164:167], v[236:239]
    s_add_u32 s62, s62, 0x20000
    v_mfma_f32_16x16x32_bf16 a[104:107], a[20:23], a[168:171], a[104:107]
    s_add_u32 s52, s47, 4096
    v_mfma_f32_16x16x32_bf16 a[108:111], a[20:23], a[172:175], a[108:111]
    buffer_store_dwordx4 v[88:91], v1, s[48:51], s52 offen offset:2048 sc1
    v_mfma_f32_16x16x32_bf16 v[240:243], a[24:27], a[160:163], v[240:243]
    v_mfma_f32_16x16x32_bf16 v[244:247], a[24:27], a[164:167], v[244:247]
    v_mfma_f32_16x16x32_bf16 a[112:115], a[24:27], a[168:171], a[112:115]
    v_mfma_f32_16x16x32_bf16 a[116:119], a[24:27], a[172:175], a[116:119]
    v_mfma_f32_16x16x32_bf16 v[248:251], a[28:31], a[160:163], v[248:251]
    v_mfma_f32_16x16x32_bf16 v[252:255], a[28:31], a[164:167], v[252:255]
    v_mfma_f32_16x16x32_bf16 a[120:123], a[28:31], a[168:171], a[120:123]
    v_mfma_f32_16x16x32_bf16 a[124:127], a[28:31], a[172:175], a[124:127]
    s_waitcnt vmcnt(9) lgkmcnt(0)
    s_barrier
    v_mfma_f32_16x16x32_bf16 v[192:195], a[32:35], a[176:179], v[192:195]
    ds_read_b64_tr_b16 a[0:1], v42 offset:32768
    ds_read_b64_tr_b16 a[2:3], v42 offset:33792
    v_mfma_f32_16x16x32_bf16 v[196:199], a[32:35], a[180:183], v[196:199]
    s_add_u32 m0, s60, 147456
    v_mfma_f32_16x16x32_bf16 a[64:67], a[32:35], a[184:187], a[64:67]
    buffer_load_dwordx4 v38, s[12:15], s61 offen offset:0 lds
    ds_read_b64_tr_b16 a[4:5], v43 offset:32768
    v_mfma_f32_16x16x32_bf16 a[68:71], a[32:35], a[188:191], a[68:71]
    ds_read_b64_tr_b16 a[6:7], v43 offset:33792
    v_mfma_f32_16x16x32_bf16 v[200:203], a[36:39], a[176:179], v[200:203]
    buffer_load_dwordx4 v39, s[12:15], s61 offen offset:1024 lds
    ds_read_b64_tr_b16 a[8:9], v44 offset:32768
    v_mfma_f32_16x16x32_bf16 v[204:207], a[36:39], a[180:183], v[204:207]
    v_mfma_f32_16x16x32_bf16 a[72:75], a[36:39], a[184:187], a[72:75]
    ds_read_b64_tr_b16 a[10:11], v44 offset:33792
    v_mfma_f32_16x16x32_bf16 a[76:79], a[36:39], a[188:191], a[76:79]
    buffer_load_dwordx4 v40, s[12:15], s61 offen offset:2048 lds
    ds_read_b64_tr_b16 a[12:13], v45 offset:32768
    v_mfma_f32_16x16x32_bf16 v[208:211], a[40:43], a[176:179], v[208:211]
    v_mfma_f32_16x16x32_bf16 v[212:215], a[40:43], a[180:183], v[212:215]
    ds_read_b64_tr_b16 a[14:15], v45 offset:33792
    v_mfma_f32_16x16x32_bf16 a[80:83], a[40:43], a[184:187], a[80:83]
    buffer_load_dwordx4 v41, s[12:15], s61 offen offset:3072 lds
    ds_read_b64_tr_b16 a[16:17], v46 offset:32768
    v_mfma_f32_16x16x32_bf16 a[84:87], a[40:43], a[188:191], a[84:87]
    ds_read_b64_tr_b16 a[18:19], v46 offset:33792
    v_mfma_f32_16x16x32_bf16 v[216:219], a[44:47], a[176:179], v[216:219]
    s_add_u32 s61, s61, 0x80000
    v_mfma_f32_16x16x32_bf16 v[220:223], a[44:47], a[180:183], v[220:223]
    buffer_load_dwordx4 a[224:227], v36, s[8:11], s62 offen sc1
    ds_read_b64_tr_b16 a[20:21], v47 offset:32768
    v_mfma_f32_16x16x32_bf16 a[88:91], a[44:47], a[184:187], a[88:91]
    ds_read_b64_tr_b16 a[22:23], v47 offset:33792
    v_mfma_f32_16x16x32_bf16 a[92:95], a[44:47], a[188:191], a[92:95]
    buffer_load_dwordx4 a[228:231], v54, s[8:11], s62 offen sc1
    ds_read_b64_tr_b16 a[24:25], v48 offset:32768
    v_mfma_f32_16x16x32_bf16 v[224:227], a[48:51], a[176:179], v[224:227]
    v_mfma_f32_16x16x32_bf16 v[228:231], a[48:51], a[180:183], v[228:231]
    ds_read_b64_tr_b16 a[26:27], v48 offset:33792
    v_mfma_f32_16x16x32_bf16 a[96:99], a[48:51], a[184:187], a[96:99]
    buffer_load_dwordx4 a[232:235], v37, s[8:11], s62 offen sc1
    ds_read_b64_tr_b16 a[28:29], v49 offset:32768
    v_mfma_f32_16x16x32_bf16 a[100:103], a[48:51], a[188:191], a[100:103]
    v_mfma_f32_16x16x32_bf16 v[232:235], a[52:55], a[176:179], v[232:235]
    ds_read_b64_tr_b16 a[30:31], v49 offset:33792
    v_mfma_f32_16x16x32_bf16 v[236:239], a[52:55], a[180:183], v[236:239]
    buffer_load_dwordx4 a[236:239], v55, s[8:11], s62 offen sc1
    v_mfma_f32_16x16x32_bf16 a[104:107], a[52:55], a[184:187], a[104:107]
    v_mfma_f32_16x16x32_bf16 a[108:111], a[52:55], a[188:191], a[108:111]
    s_add_u32 s62, s62, 0x20000
    v_mfma_f32_16x16x32_bf16 v[240:243], a[56:59], a[176:179], v[240:243]
    s_add_u32 s52, s47, 4096
    v_mfma_f32_16x16x32_bf16 v[244:247], a[56:59], a[180:183], v[244:247]
    buffer_store_dwordx4 v[92:95], v1, s[48:51], s52 offen offset:3072 sc1
    v_mfma_f32_16x16x32_bf16 a[112:115], a[56:59], a[184:187], a[112:115]
    v_mfma_f32_16x16x32_bf16 a[116:119], a[56:59], a[188:191], a[116:119]
    v_mfma_f32_16x16x32_bf16 v[248:251], a[60:63], a[176:179], v[248:251]
    s_cmp_eq_u32 s45, 0
    s_cbranch_scc1 k12_ool_54
k12_oolret_55:
    v_mfma_f32_16x16x32_bf16 v[252:255], a[60:63], a[180:183], v[252:255]
    v_mfma_f32_16x16x32_bf16 a[120:123], a[60:63], a[184:187], a[120:123]
    v_mfma_f32_16x16x32_bf16 a[124:127], a[60:63], a[188:191], a[124:127]
    s_waitcnt vmcnt(14) lgkmcnt(0)
    v_mfma_f32_16x16x32_bf16 v[192:195], a[0:3], a[192:195], v[192:195]
    ds_read_b64_tr_b16 a[32:33], v42 offset:40960
    ds_read_b64_tr_b16 a[34:35], v42 offset:41984
    v_mfma_f32_16x16x32_bf16 v[196:199], a[0:3], a[196:199], v[196:199]
    buffer_load_dwordx4 a[240:243], v36, s[8:11], s62 offen sc1
    v_mfma_f32_16x16x32_bf16 a[64:67], a[0:3], a[200:203], a[64:67]
    ds_read_b64_tr_b16 a[36:37], v43 offset:40960
    v_mfma_f32_16x16x32_bf16 a[68:71], a[0:3], a[204:207], a[68:71]
    ds_read_b64_tr_b16 a[38:39], v43 offset:41984
    v_mfma_f32_16x16x32_bf16 v[200:203], a[4:7], a[192:195], v[200:203]
    ds_read_b64_tr_b16 a[40:41], v44 offset:40960
    v_mfma_f32_16x16x32_bf16 v[204:207], a[4:7], a[196:199], v[204:207]
    v_mfma_f32_16x16x32_bf16 a[72:75], a[4:7], a[200:203], a[72:75]
    buffer_load_dwordx4 a[244:247], v54, s[8:11], s62 offen sc1
    ds_read_b64_tr_b16 a[42:43], v44 offset:41984
    v_mfma_f32_16x16x32_bf16 a[76:79], a[4:7], a[204:207], a[76:79]
    ds_read_b64_tr_b16 a[44:45], v45 offset:40960
    v_mfma_f32_16x16x32_bf16 v[208:211], a[8:11], a[192:195], v[208:211]
    v_mfma_f32_16x16x32_bf16 v[212:215], a[8:11], a[196:199], v[212:215]
    ds_read_b64_tr_b16 a[46:47], v45 offset:41984
    v_mfma_f32_16x16x32_bf16 a[80:83], a[8:11], a[200:203], a[80:83]
    ds_read_b64_tr_b16 a[48:49], v46 offset:40960
    v_mfma_f32_16x16x32_bf16 a[84:87], a[8:11], a[204:207], a[84:87]
    buffer_load_dwordx4 a[248:251], v37, s[8:11], s62 offen sc1
    ds_read_b64_tr_b16 a[50:51], v46 offset:41984
    v_mfma_f32_16x16x32_bf16 v[216:219], a[12:15], a[192:195], v[216:219]
    v_mfma_f32_16x16x32_bf16 v[220:223], a[12:15], a[196:199], v[220:223]
    ds_read_b64_tr_b16 a[52:53], v47 offset:40960
    v_mfma_f32_16x16x32_bf16 a[88:91], a[12:15], a[200:203], a[88:91]
    ds_read_b64_tr_b16 a[54:55], v47 offset:41984
    v_mfma_f32_16x16x32_bf16 a[92:95], a[12:15], a[204:207], a[92:95]
    ds_read_b64_tr_b16 a[56:57], v48 offset:40960
    v_mfma_f32_16x16x32_bf16 v[224:227], a[16:19], a[192:195], v[224:227]
    v_mfma_f32_16x16x32_bf16 v[228:231], a[16:19], a[196:199], v[228:231]
    buffer_load_dwordx4 a[252:255], v55, s[8:11], s62 offen sc1
    ds_read_b64_tr_b16 a[58:59], v48 offset:41984
    v_mfma_f32_16x16x32_bf16 a[96:99], a[16:19], a[200:203], a[96:99]
    ds_read_b64_tr_b16 a[60:61], v49 offset:40960
    v_mfma_f32_16x16x32_bf16 a[100:103], a[16:19], a[204:207], a[100:103]
    v_mfma_f32_16x16x32_bf16 v[232:235], a[20:23], a[192:195], v[232:235]
    ds_read_b64_tr_b16 a[62:63], v49 offset:41984
    v_mfma_f32_16x16x32_bf16 v[236:239], a[20:23], a[196:199], v[236:239]
    s_add_u32 s62, s62, 0x20000
    v_mfma_f32_16x16x32_bf16 a[104:107], a[20:23], a[200:203], a[104:107]
    s_add_u32 s52, s47, 8192
    v_mfma_f32_16x16x32_bf16 a[108:111], a[20:23], a[204:207], a[108:111]
    buffer_store_dwordx4 v[104:107], v1, s[48:51], s52 offen offset:2048 sc1
    v_mfma_f32_16x16x32_bf16 v[240:243], a[24:27], a[192:195], v[240:243]
    v_mfma_f32_16x16x32_bf16 v[244:247], a[24:27], a[196:199], v[244:247]
    v_mfma_f32_16x16x32_bf16 a[112:115], a[24:27], a[200:203], a[112:115]
    v_mfma_f32_16x16x32_bf16 a[116:119], a[24:27], a[204:207], a[116:119]
    v_mfma_f32_16x16x32_bf16 v[248:251], a[28:31], a[192:195], v[248:251]
    v_mfma_f32_16x16x32_bf16 v[252:255], a[28:31], a[196:199], v[252:255]
    v_mfma_f32_16x16x32_bf16 a[120:123], a[28:31], a[200:203], a[120:123]
    v_mfma_f32_16x16x32_bf16 a[124:127], a[28:31], a[204:207], a[124:127]
    s_waitcnt vmcnt(10) lgkmcnt(0)
    s_barrier
    v_mfma_f32_16x16x32_bf16 v[192:195], a[32:35], a[208:211], v[192:195]
    ds_read_b64_tr_b16 a[0:1], v42 offset:49152
    ds_read_b64_tr_b16 a[2:3], v42 offset:50176
    v_mfma_f32_16x16x32_bf16 v[196:199], a[32:35], a[212:215], v[196:199]
    s_add_u32 m0, s60, 98304
    v_mfma_f32_16x16x32_bf16 a[64:67], a[32:35], a[216:219], a[64:67]
    buffer_load_dwordx4 v38, s[12:15], s61 offen offset:0 lds
    ds_read_b64_tr_b16 a[4:5], v43 offset:49152
    v_mfma_f32_16x16x32_bf16 a[68:71], a[32:35], a[220:223], a[68:71]
    ds_read_b64_tr_b16 a[6:7], v43 offset:50176
    v_mfma_f32_16x16x32_bf16 v[200:203], a[36:39], a[208:211], v[200:203]
    buffer_load_dwordx4 v39, s[12:15], s61 offen offset:1024 lds
    ds_read_b64_tr_b16 a[8:9], v44 offset:49152
    v_mfma_f32_16x16x32_bf16 v[204:207], a[36:39], a[212:215], v[204:207]
    v_mfma_f32_16x16x32_bf16 a[72:75], a[36:39], a[216:219], a[72:75]
    ds_read_b64_tr_b16 a[10:11], v44 offset:50176
    v_mfma_f32_16x16x32_bf16 a[76:79], a[36:39], a[220:223], a[76:79]
    buffer_load_dwordx4 v40, s[12:15], s61 offen offset:2048 lds
    ds_read_b64_tr_b16 a[12:13], v45 offset:49152
    v_mfma_f32_16x16x32_bf16 v[208:211], a[40:43], a[208:211], v[208:211]
    v_mfma_f32_16x16x32_bf16 v[212:215], a[40:43], a[212:215], v[212:215]
    ds_read_b64_tr_b16 a[14:15], v45 offset:50176
    v_mfma_f32_16x16x32_bf16 a[80:83], a[40:43], a[216:219], a[80:83]
    buffer_load_dwordx4 v41, s[12:15], s61 offen offset:3072 lds
    ds_read_b64_tr_b16 a[16:17], v46 offset:49152
    v_mfma_f32_16x16x32_bf16 a[84:87], a[40:43], a[220:223], a[84:87]
    ds_read_b64_tr_b16 a[18:19], v46 offset:50176
    v_mfma_f32_16x16x32_bf16 v[216:219], a[44:47], a[208:211], v[216:219]
    s_add_u32 s61, s61, 0x80000
    v_mfma_f32_16x16x32_bf16 v[220:223], a[44:47], a[212:215], v[220:223]
    buffer_load_dwordx4 a[128:131], v36, s[8:11], s62 offen sc1
    ds_read_b64_tr_b16 a[20:21], v47 offset:49152
    v_mfma_f32_16x16x32_bf16 a[88:91], a[44:47], a[216:219], a[88:91]
    ds_read_b64_tr_b16 a[22:23], v47 offset:50176
    v_mfma_f32_16x16x32_bf16 a[92:95], a[44:47], a[220:223], a[92:95]
    buffer_load_dwordx4 a[132:135], v54, s[8:11], s62 offen sc1
    ds_read_b64_tr_b16 a[24:25], v48 offset:49152
    v_mfma_f32_16x16x32_bf16 v[224:227], a[48:51], a[208:211], v[224:227]
    v_mfma_f32_16x16x32_bf16 v[228:231], a[48:51], a[212:215], v[228:231]
    ds_read_b64_tr_b16 a[26:27], v48 offset:50176
    v_mfma_f32_16x16x32_bf16 a[96:99], a[48:51], a[216:219], a[96:99]
    buffer_load_dwordx4 a[136:139], v37, s[8:11], s62 offen sc1
    ds_read_b64_tr_b16 a[28:29], v49 offset:49152
    v_mfma_f32_16x16x32_bf16 a[100:103], a[48:51], a[220:223], a[100:103]
    v_mfma_f32_16x16x32_bf16 v[232:235], a[52:55], a[208:211], v[232:235]
    ds_read_b64_tr_b16 a[30:31], v49 offset:50176
    v_mfma_f32_16x16x32_bf16 v[236:239], a[52:55], a[212:215], v[236:239]
    buffer_load_dwordx4 a[140:143], v55, s[8:11], s62 offen sc1
    v_mfma_f32_16x16x32_bf16 a[104:107], a[52:55], a[216:219], a[104:107]
    v_mfma_f32_16x16x32_bf16 a[108:111], a[52:55], a[220:223], a[108:111]
    s_add_u32 s62, s62, 0x20000
    v_mfma_f32_16x16x32_bf16 v[240:243], a[56:59], a[208:211], v[240:243]
    s_add_u32 s52, s47, 8192
    v_mfma_f32_16x16x32_bf16 v[244:247], a[56:59], a[212:215], v[244:247]
    buffer_store_dwordx4 v[108:111], v1, s[48:51], s52 offen offset:3072 sc1
    v_mfma_f32_16x16x32_bf16 a[112:115], a[56:59], a[216:219], a[112:115]
    v_mfma_f32_16x16x32_bf16 a[116:119], a[56:59], a[220:223], a[116:119]
    v_mfma_f32_16x16x32_bf16 v[248:251], a[60:63], a[208:211], v[248:251]
    v_mfma_f32_16x16x32_bf16 v[252:255], a[60:63], a[212:215], v[252:255]
    v_mfma_f32_16x16x32_bf16 a[120:123], a[60:63], a[216:219], a[120:123]
    v_mfma_f32_16x16x32_bf16 a[124:127], a[60:63], a[220:223], a[124:127]
    s_waitcnt vmcnt(15) lgkmcnt(0)
    v_mfma_f32_16x16x32_bf16 v[192:195], a[0:3], a[224:227], v[192:195]
    ds_read_b64_tr_b16 a[32:33], v42 offset:57344
    ds_read_b64_tr_b16 a[34:35], v42 offset:58368
    v_mfma_f32_16x16x32_bf16 v[196:199], a[0:3], a[228:231], v[196:199]
    buffer_load_dwordx4 a[144:147], v36, s[8:11], s62 offen sc1
    v_mfma_f32_16x16x32_bf16 a[64:67], a[0:3], a[232:235], a[64:67]
    ds_read_b64_tr_b16 a[36:37], v43 offset:57344
    v_mfma_f32_16x16x32_bf16 a[68:71], a[0:3], a[236:239], a[68:71]
    ds_read_b64_tr_b16 a[38:39], v43 offset:58368
    v_mfma_f32_16x16x32_bf16 v[200:203], a[4:7], a[224:227], v[200:203]
    ds_read_b64_tr_b16 a[40:41], v44 offset:57344
    v_mfma_f32_16x16x32_bf16 v[204:207], a[4:7], a[228:231], v[204:207]
    v_mfma_f32_16x16x32_bf16 a[72:75], a[4:7], a[232:235], a[72:75]
    buffer_load_dwordx4 a[148:151], v54, s[8:11], s62 offen sc1
    ds_read_b64_tr_b16 a[42:43], v44 offset:58368
    v_mfma_f32_16x16x32_bf16 a[76:79], a[4:7], a[236:239], a[76:79]
    ds_read_b64_tr_b16 a[44:45], v45 offset:57344
    v_mfma_f32_16x16x32_bf16 v[208:211], a[8:11], a[224:227], v[208:211]
    v_mfma_f32_16x16x32_bf16 v[212:215], a[8:11], a[228:231], v[212:215]
    ds_read_b64_tr_b16 a[46:47], v45 offset:58368
    v_mfma_f32_16x16x32_bf16 a[80:83], a[8:11], a[232:235], a[80:83]
    ds_read_b64_tr_b16 a[48:49], v46 offset:57344
    v_mfma_f32_16x16x32_bf16 a[84:87], a[8:11], a[236:239], a[84:87]
    buffer_load_dwordx4 a[152:155], v37, s[8:11], s62 offen sc1
    ds_read_b64_tr_b16 a[50:51], v46 offset:58368
    v_mfma_f32_16x16x32_bf16 v[216:219], a[12:15], a[224:227], v[216:219]
    v_mfma_f32_16x16x32_bf16 v[220:223], a[12:15], a[228:231], v[220:223]
    ds_read_b64_tr_b16 a[52:53], v47 offset:57344
    v_mfma_f32_16x16x32_bf16 a[88:91], a[12:15], a[232:235], a[88:91]
    ds_read_b64_tr_b16 a[54:55], v47 offset:58368
    v_mfma_f32_16x16x32_bf16 a[92:95], a[12:15], a[236:239], a[92:95]
    ds_read_b64_tr_b16 a[56:57], v48 offset:57344
    v_mfma_f32_16x16x32_bf16 v[224:227], a[16:19], a[224:227], v[224:227]
    v_mfma_f32_16x16x32_bf16 v[228:231], a[16:19], a[228:231], v[228:231]
    buffer_load_dwordx4 a[156:159], v55, s[8:11], s62 offen sc1
    ds_read_b64_tr_b16 a[58:59], v48 offset:58368
    v_mfma_f32_16x16x32_bf16 a[96:99], a[16:19], a[232:235], a[96:99]
    ds_read_b64_tr_b16 a[60:61], v49 offset:57344
    v_mfma_f32_16x16x32_bf16 a[100:103], a[16:19], a[236:239], a[100:103]
    v_mfma_f32_16x16x32_bf16 v[232:235], a[20:23], a[224:227], v[232:235]
    ds_read_b64_tr_b16 a[62:63], v49 offset:58368
    v_mfma_f32_16x16x32_bf16 v[236:239], a[20:23], a[228:231], v[236:239]
    s_add_u32 s62, s62, 0x20000
    v_mfma_f32_16x16x32_bf16 a[104:107], a[20:23], a[232:235], a[104:107]
    s_add_u32 s52, s47, 12288
    v_mfma_f32_16x16x32_bf16 a[108:111], a[20:23], a[236:239], a[108:111]
    buffer_store_dwordx4 v[112:115], v1, s[48:51], s52 offen offset:0 sc1
    v_mfma_f32_16x16x32_bf16 v[240:243], a[24:27], a[224:227], v[240:243]
    v_mfma_f32_16x16x32_bf16 v[244:247], a[24:27], a[228:231], v[244:247]
    v_mfma_f32_16x16x32_bf16 a[112:115], a[24:27], a[232:235], a[112:115]
    v_mfma_f32_16x16x32_bf16 a[116:119], a[24:27], a[236:239], a[116:119]
    v_mfma_f32_16x16x32_bf16 v[248:251], a[28:31], a[224:227], v[248:251]
    s_cmp_eq_u32 s45, 0
    s_cbranch_scc1 k12_ool_56
k12_oolret_57:
    v_mfma_f32_16x16x32_bf16 v[252:255], a[28:31], a[228:231], v[252:255]
    v_mfma_f32_16x16x32_bf16 a[120:123], a[28:31], a[232:235], a[120:123]
    v_mfma_f32_16x16x32_bf16 a[124:127], a[28:31], a[236:239], a[124:127]
    s_waitcnt vmcnt(10) lgkmcnt(0)
    s_barrier
    v_mfma_f32_16x16x32_bf16 v[192:195], a[32:35], a[240:243], v[192:195]
    ds_read_b64_tr_b16 a[0:1], v42 offset:0
    ds_read_b64_tr_b16 a[2:3], v42 offset:1024
    v_mfma_f32_16x16x32_bf16 v[196:199], a[32:35], a[244:247], v[196:199]
    s_add_u32 m0, s60, 114688
    v_mfma_f32_16x16x32_bf16 a[64:67], a[32:35], a[248:251], a[64:67]
    buffer_load_dwordx4 v38, s[12:15], s61 offen offset:0 lds
    ds_read_b64_tr_b16 a[4:5], v43 offset:0
    v_mfma_f32_16x16x32_bf16 a[68:71], a[32:35], a[252:255], a[68:71]
    ds_read_b64_tr_b16 a[6:7], v43 offset:1024
    v_mfma_f32_16x16x32_bf16 v[200:203], a[36:39], a[240:243], v[200:203]
    buffer_load_dwordx4 v39, s[12:15], s61 offen offset:1024 lds
    ds_read_b64_tr_b16 a[8:9], v44 offset:0
    v_mfma_f32_16x16x32_bf16 v[204:207], a[36:39], a[244:247], v[204:207]
    v_mfma_f32_16x16x32_bf16 a[72:75], a[36:39], a[248:251], a[72:75]
    ds_read_b64_tr_b16 a[10:11], v44 offset:1024
    v_mfma_f32_16x16x32_bf16 a[76:79], a[36:39], a[252:255], a[76:79]
    buffer_load_dwordx4 v40, s[12:15], s61 offen offset:2048 lds
    ds_read_b64_tr_b16 a[12:13], v45 offset:0
    v_mfma_f32_16x16x32_bf16 v[208:211], a[40:43], a[240:243], v[208:211]
    v_mfma_f32_16x16x32_bf16 v[212:215], a[40:43], a[244:247], v[212:215]
    ds_read_b64_tr_b16 a[14:15], v45 offset:1024
    v_mfma_f32_16x16x32_bf16 a[80:83], a[40:43], a[248:251], a[80:83]
    ds_read_b64_tr_b16 a[16:17], v46 offset:0
    v_mfma_f32_16x16x32_bf16 a[84:87], a[40:43], a[252:255], a[84:87]
    buffer_load_dwordx4 v41, s[12:15], s61 offen offset:3072 lds
    ds_read_b64_tr_b16 a[18:19], v46 offset:1024
    v_mfma_f32_16x16x32_bf16 v[216:219], a[44:47], a[240:243], v[216:219]
    v_mfma_f32_16x16x32_bf16 v[220:223], a[44:47], a[244:247], v[220:223]
    s_add_u32 s61, s61, 0x80000
    ds_read_b64_tr_b16 a[20:21], v47 offset:0
    v_mfma_f32_16x16x32_bf16 a[88:91], a[44:47], a[248:251], a[88:91]
    buffer_load_dwordx4 a[160:163], v36, s[8:11], s62 offen sc1
    ds_read_b64_tr_b16 a[22:23], v47 offset:1024
    v_mfma_f32_16x16x32_bf16 a[92:95], a[44:47], a[252:255], a[92:95]
    ds_read_b64_tr_b16 a[24:25], v48 offset:0
    v_mfma_f32_16x16x32_bf16 v[224:227], a[48:51], a[240:243], v[224:227]
    v_mfma_f32_16x16x32_bf16 v[228:231], a[48:51], a[244:247], v[228:231]
    buffer_load_dwordx4 a[164:167], v54, s[8:11], s62 offen sc1
    ds_read_b64_tr_b16 a[26:27], v48 offset:1024
    v_mfma_f32_16x16x32_bf16 a[96:99], a[48:51], a[248:251], a[96:99]
    ds_read_b64_tr_b16 a[28:29], v49 offset:0
    v_mfma_f32_16x16x32_bf16 a[100:103], a[48:51], a[252:255], a[100:103]
    v_mfma_f32_16x16x32_bf16 v[232:235], a[52:55], a[240:243], v[232:235]
    buffer_load_dwordx4 a[168:171], v37, s[8:11], s62 offen sc1
    ds_read_b64_tr_b16 a[30:31], v49 offset:1024
    v_mfma_f32_16x16x32_bf16 v[236:239], a[52:55], a[244:247], v[236:239]
    v_mfma_f32_16x16x32_bf16 a[104:107], a[52:55], a[248:251], a[104:107]
    v_mfma_f32_16x16x32_bf16 a[108:111], a[52:55], a[252:255], a[108:111]
    v_mfma_f32_16x16x32_bf16 v[240:243], a[56:59], a[240:243], v[240:243]
    buffer_load_dwordx4 a[172:175], v55, s[8:11], s62 offen sc1
    v_mfma_f32_16x16x32_bf16 v[244:247], a[56:59], a[244:247], v[244:247]
    v_mfma_f32_16x16x32_bf16 a[112:115], a[56:59], a[248:251], a[112:115]
    s_add_u32 s62, s62, 0x20000
    v_mfma_f32_16x16x32_bf16 a[116:119], a[56:59], a[252:255], a[116:119]
    v_mfma_f32_16x16x32_bf16 v[248:251], a[60:63], a[240:243], v[248:251]
    v_mfma_f32_16x16x32_bf16 v[252:255], a[60:63], a[244:247], v[252:255]
    v_mfma_f32_16x16x32_bf16 a[120:123], a[60:63], a[248:251], a[120:123]
    v_mfma_f32_16x16x32_bf16 a[124:127], a[60:63], a[252:255], a[124:127]
    s_waitcnt vmcnt(14) lgkmcnt(0)
    v_mfma_f32_16x16x32_bf16 v[192:195], a[0:3], a[128:131], v[192:195]
    ds_read_b64_tr_b16 a[32:33], v42 offset:8192
    ds_read_b64_tr_b16 a[34:35], v42 offset:9216
    v_mfma_f32_16x16x32_bf16 v[196:199], a[0:3], a[132:135], v[196:199]
    buffer_load_dwordx4 a[176:179], v36, s[8:11], s62 offen sc1
    v_mfma_f32_16x16x32_bf16 a[64:67], a[0:3], a[136:139], a[64:67]
    ds_read_b64_tr_b16 a[36:37], v43 offset:8192
    v_mfma_f32_16x16x32_bf16 a[68:71], a[0:3], a[140:143], a[68:71]
    ds_read_b64_tr_b16 a[38:39], v43 offset:9216
    v_mfma_f32_16x16x32_bf16 v[200:203], a[4:7], a[128:131], v[200:203]
    ds_read_b64_tr_b16 a[40:41], v44 offset:8192
    v_mfma_f32_16x16x32_bf16 v[204:207], a[4:7], a[132:135], v[204:207]
    v_mfma_f32_16x16x32_bf16 a[72:75], a[4:7], a[136:139], a[72:75]
    buffer_load_dwordx4 a[180:183], v54, s[8:11], s62 offen sc1
    ds_read_b64_tr_b16 a[42:43], v44 offset:9216
    v_mfma_f32_16x16x32_bf16 a[76:79], a[4:7], a[140:143], a[76:79]
    ds_read_b64_tr_b16 a[44:45], v45 offset:8192
    v_mfma_f32_16x16x32_bf16 v[208:211], a[8:11], a[128:131], v[208:211]
    v_mfma_f32_16x16x32_bf16 v[212:215], a[8:11], a[132:135], v[212:215]
    ds_read_b64_tr_b16 a[46:47], v45 offset:9216
    v_mfma_f32_16x16x32_bf16 a[80:83], a[8:11], a[136:139], a[80:83]
    ds_read_b64_tr_b16 a[48:49], v46 offset:8192
    v_mfma_f32_16x16x32_bf16 a[84:87], a[8:11], a[140:143], a[84:87]
    buffer_load_dwordx4 a[184:187], v37, s[8:11], s62 offen sc1
    ds_read_b64_tr_b16 a[50:51], v46 offset:9216
    v_mfma_f32_16x16x32_bf16 v[216:219], a[12:15], a[128:131], v[216:219]
    v_mfma_f32_16x16x32_bf16 v[220:223], a[12:15], a[132:135], v[220:223]
    ds_read_b64_tr_b16 a[52:53], v47 offset:8192
    v_mfma_f32_16x16x32_bf16 a[88:91], a[12:15], a[136:139], a[88:91]
    ds_read_b64_tr_b16 a[54:55], v47 offset:9216
    v_mfma_f32_16x16x32_bf16 a[92:95], a[12:15], a[140:143], a[92:95]
    ds_read_b64_tr_b16 a[56:57], v48 offset:8192
    v_mfma_f32_16x16x32_bf16 v[224:227], a[16:19], a[128:131], v[224:227]
    v_mfma_f32_16x16x32_bf16 v[228:231], a[16:19], a[132:135], v[228:231]
    buffer_load_dwordx4 a[188:191], v55, s[8:11], s62 offen sc1
    ds_read_b64_tr_b16 a[58:59], v48 offset:9216
    v_mfma_f32_16x16x32_bf16 a[96:99], a[16:19], a[136:139], a[96:99]
    ds_read_b64_tr_b16 a[60:61], v49 offset:8192
    v_mfma_f32_16x16x32_bf16 a[100:103], a[16:19], a[140:143], a[100:103]
    v_mfma_f32_16x16x32_bf16 v[232:235], a[20:23], a[128:131], v[232:235]
    ds_read_b64_tr_b16 a[62:63], v49 offset:9216
    v_mfma_f32_16x16x32_bf16 v[236:239], a[20:23], a[132:135], v[236:239]
    s_add_u32 s62, s62, 0x20000
    v_mfma_f32_16x16x32_bf16 a[104:107], a[20:23], a[136:139], a[104:107]
    s_add_u32 s52, s47, 12288
    v_mfma_f32_16x16x32_bf16 a[108:111], a[20:23], a[140:143], a[108:111]
    buffer_store_dwordx4 v[116:119], v1, s[48:51], s52 offen offset:1024 sc1
    v_mfma_f32_16x16x32_bf16 v[240:243], a[24:27], a[128:131], v[240:243]
    v_mfma_f32_16x16x32_bf16 v[244:247], a[24:27], a[132:135], v[244:247]
    v_mfma_f32_16x16x32_bf16 a[112:115], a[24:27], a[136:139], a[112:115]
    v_mfma_f32_16x16x32_bf16 a[116:119], a[24:27], a[140:143], a[116:119]
    v_mfma_f32_16x16x32_bf16 v[248:251], a[28:31], a[128:131], v[248:251]
    s_cmp_eq_u32 s45, 0
    s_cbranch_scc1 k12_ool_58
k12_oolret_59:
    v_mfma_f32_16x16x32_bf16 v[252:255], a[28:31], a[132:135], v[252:255]
    v_mfma_f32_16x16x32_bf16 a[120:123], a[28:31], a[136:139], a[120:123]
    v_mfma_f32_16x16x32_bf16 a[124:127], a[28:31], a[140:143], a[124:127]
    s_waitcnt vmcnt(9) lgkmcnt(0)
    s_barrier
    v_mfma_f32_16x16x32_bf16 v[192:195], a[32:35], a[144:147], v[192:195]
    ds_read_b64_tr_b16 a[0:1], v42 offset:16384
    ds_read_b64_tr_b16 a[2:3], v42 offset:17408
    v_mfma_f32_16x16x32_bf16 v[196:199], a[32:35], a[148:151], v[196:199]
    s_add_u32 m0, s60, 131072
    v_mfma_f32_16x16x32_bf16 a[64:67], a[32:35], a[152:155], a[64:67]
    buffer_load_dwordx4 v38, s[12:15], s61 offen offset:0 lds
    ds_read_b64_tr_b16 a[4:5], v43 offset:16384
    v_mfma_f32_16x16x32_bf16 a[68:71], a[32:35], a[156:159], a[68:71]
    ds_read_b64_tr_b16 a[6:7], v43 offset:17408
    v_mfma_f32_16x16x32_bf16 v[200:203], a[36:39], a[144:147], v[200:203]
    buffer_load_dwordx4 v39, s[12:15], s61 offen offset:1024 lds
    ds_read_b64_tr_b16 a[8:9], v44 offset:16384
    v_mfma_f32_16x16x32_bf16 v[204:207], a[36:39], a[148:151], v[204:207]
    v_mfma_f32_16x16x32_bf16 a[72:75], a[36:39], a[152:155], a[72:75]
    ds_read_b64_tr_b16 a[10:11], v44 offset:17408
    v_mfma_f32_16x16x32_bf16 a[76:79], a[36:39], a[156:159], a[76:79]
    buffer_load_dwordx4 v40, s[12:15], s61 offen offset:2048 lds
    ds_read_b64_tr_b16 a[12:13], v45 offset:16384
    v_mfma_f32_16x16x32_bf16 v[208:211], a[40:43], a[144:147], v[208:211]
    v_mfma_f32_16x16x32_bf16 v[212:215], a[40:43], a[148:151], v[212:215]
    ds_read_b64_tr_b16 a[14:15], v45 offset:17408
    v_mfma_f32_16x16x32_bf16 a[80:83], a[40:43], a[152:155], a[80:83]
    buffer_load_dwordx4 v41, s[12:15], s61 offen offset:3072 lds
    ds_read_b64_tr_b16 a[16:17], v46 offset:16384
    v_mfma_f32_16x16x32_bf16 a[84:87], a[40:43], a[156:159], a[84:87]
    ds_read_b64_tr_b16 a[18:19], v46 offset:17408
    v_mfma_f32_16x16x32_bf16 v[216:219], a[44:47], a[144:147], v[216:219]
    s_add_u32 s61, s61, 0x80000
    v_mfma_f32_16x16x32_bf16 v[220:223], a[44:47], a[148:151], v[220:223]
    buffer_load_dwordx4 a[192:195], v36, s[8:11], s62 offen sc1
    ds_read_b64_tr_b16 a[20:21], v47 offset:16384
    v_mfma_f32_16x16x32_bf16 a[88:91], a[44:47], a[152:155], a[88:91]
    ds_read_b64_tr_b16 a[22:23], v47 offset:17408
    v_mfma_f32_16x16x32_bf16 a[92:95], a[44:47], a[156:159], a[92:95]
    buffer_load_dwordx4 a[196:199], v54, s[8:11], s62 offen sc1
    ds_read_b64_tr_b16 a[24:25], v48 offset:16384
    v_mfma_f32_16x16x32_bf16 v[224:227], a[48:51], a[144:147], v[224:227]
    v_mfma_f32_16x16x32_bf16 v[228:231], a[48:51], a[148:151], v[228:231]
    ds_read_b64_tr_b16 a[26:27], v48 offset:17408
    v_mfma_f32_16x16x32_bf16 a[96:99], a[48:51], a[152:155], a[96:99]
    buffer_load_dwordx4 a[200:203], v37, s[8:11], s62 offen sc1
    ds_read_b64_tr_b16 a[28:29], v49 offset:16384
    v_mfma_f32_16x16x32_bf16 a[100:103], a[48:51], a[156:159], a[100:103]
    v_mfma_f32_16x16x32_bf16 v[232:235], a[52:55], a[144:147], v[232:235]
    ds_read_b64_tr_b16 a[30:31], v49 offset:17408
    v_mfma_f32_16x16x32_bf16 v[236:239], a[52:55], a[148:151], v[236:239]
    buffer_load_dwordx4 a[204:207], v55, s[8:11], s62 offen sc1
    v_mfma_f32_16x16x32_bf16 a[104:107], a[52:55], a[152:155], a[104:107]
    v_mfma_f32_16x16x32_bf16 a[108:111], a[52:55], a[156:159], a[108:111]
    s_add_u32 s62, s62, 0x20000
    v_mfma_f32_16x16x32_bf16 v[240:243], a[56:59], a[144:147], v[240:243]
    s_add_u32 s52, s47, 12288
    v_mfma_f32_16x16x32_bf16 v[244:247], a[56:59], a[148:151], v[244:247]
    buffer_store_dwordx4 v[120:123], v1, s[48:51], s52 offen offset:2048 sc1
    v_mfma_f32_16x16x32_bf16 a[112:115], a[56:59], a[152:155], a[112:115]
    v_mfma_f32_16x16x32_bf16 a[116:119], a[56:59], a[156:159], a[116:119]
    v_mfma_f32_16x16x32_bf16 v[248:251], a[60:63], a[144:147], v[248:251]
    v_mfma_f32_16x16x32_bf16 v[252:255], a[60:63], a[148:151], v[252:255]
    v_mfma_f32_16x16x32_bf16 a[120:123], a[60:63], a[152:155], a[120:123]
    v_mfma_f32_16x16x32_bf16 a[124:127], a[60:63], a[156:159], a[124:127]
    s_waitcnt vmcnt(14) lgkmcnt(0)
    v_mfma_f32_16x16x32_bf16 v[192:195], a[0:3], a[160:163], v[192:195]
    ds_read_b64_tr_b16 a[32:33], v42 offset:24576
    ds_read_b64_tr_b16 a[34:35], v42 offset:25600
    v_mfma_f32_16x16x32_bf16 v[196:199], a[0:3], a[164:167], v[196:199]
    buffer_load_dwordx4 a[208:211], v36, s[8:11], s62 offen sc1
    v_mfma_f32_16x16x32_bf16 a[64:67], a[0:3], a[168:171], a[64:67]
    ds_read_b64_tr_b16 a[36:37], v43 offset:24576
    v_mfma_f32_16x16x32_bf16 a[68:71], a[0:3], a[172:175], a[68:71]
    ds_read_b64_tr_b16 a[38:39], v43 offset:25600
    v_mfma_f32_16x16x32_bf16 v[200:203], a[4:7], a[160:163], v[200:203]
    ds_read_b64_tr_b16 a[40:41], v44 offset:24576
    v_mfma_f32_16x16x32_bf16 v[204:207], a[4:7], a[164:167], v[204:207]
    v_mfma_f32_16x16x32_bf16 a[72:75], a[4:7], a[168:171], a[72:75]
    buffer_load_dwordx4 a[212:215], v54, s[8:11], s62 offen sc1
    ds_read_b64_tr_b16 a[42:43], v44 offset:25600
    v_mfma_f32_16x16x32_bf16 a[76:79], a[4:7], a[172:175], a[76:79]
    ds_read_b64_tr_b16 a[44:45], v45 offset:24576
    v_mfma_f32_16x16x32_bf16 v[208:211], a[8:11], a[160:163], v[208:211]
    v_mfma_f32_16x16x32_bf16 v[212:215], a[8:11], a[164:167], v[212:215]
    ds_read_b64_tr_b16 a[46:47], v45 offset:25600
    v_mfma_f32_16x16x32_bf16 a[80:83], a[8:11], a[168:171], a[80:83]
    ds_read_b64_tr_b16 a[48:49], v46 offset:24576
    v_mfma_f32_16x16x32_bf16 a[84:87], a[8:11], a[172:175], a[84:87]
    buffer_load_dwordx4 a[216:219], v37, s[8:11], s62 offen sc1
    ds_read_b64_tr_b16 a[50:51], v46 offset:25600
    v_mfma_f32_16x16x32_bf16 v[216:219], a[12:15], a[160:163], v[216:219]
    v_mfma_f32_16x16x32_bf16 v[220:223], a[12:15], a[164:167], v[220:223]
    ds_read_b64_tr_b16 a[52:53], v47 offset:24576
    v_mfma_f32_16x16x32_bf16 a[88:91], a[12:15], a[168:171], a[88:91]
    ds_read_b64_tr_b16 a[54:55], v47 offset:25600
    v_mfma_f32_16x16x32_bf16 a[92:95], a[12:15], a[172:175], a[92:95]
    ds_read_b64_tr_b16 a[56:57], v48 offset:24576
    v_mfma_f32_16x16x32_bf16 v[224:227], a[16:19], a[160:163], v[224:227]
    v_mfma_f32_16x16x32_bf16 v[228:231], a[16:19], a[164:167], v[228:231]
    buffer_load_dwordx4 a[220:223], v55, s[8:11], s62 offen sc1
    ds_read_b64_tr_b16 a[58:59], v48 offset:25600
    v_mfma_f32_16x16x32_bf16 a[96:99], a[16:19], a[168:171], a[96:99]
    ds_read_b64_tr_b16 a[60:61], v49 offset:24576
    v_mfma_f32_16x16x32_bf16 a[100:103], a[16:19], a[172:175], a[100:103]
    v_mfma_f32_16x16x32_bf16 v[232:235], a[20:23], a[160:163], v[232:235]
    ds_read_b64_tr_b16 a[62:63], v49 offset:25600
    v_mfma_f32_16x16x32_bf16 v[236:239], a[20:23], a[164:167], v[236:239]
    s_add_u32 s62, s62, 0x20000
    v_mfma_f32_16x16x32_bf16 a[104:107], a[20:23], a[168:171], a[104:107]
    s_add_u32 s52, s47, 12288
    v_mfma_f32_16x16x32_bf16 a[108:111], a[20:23], a[172:175], a[108:111]
    buffer_store_dwordx4 v[124:127], v1, s[48:51], s52 offen offset:3072 sc1
    v_mfma_f32_16x16x32_bf16 v[240:243], a[24:27], a[160:163], v[240:243]
    v_mfma_f32_16x16x32_bf16 v[244:247], a[24:27], a[164:167], v[244:247]
    v_mfma_f32_16x16x32_bf16 a[112:115], a[24:27], a[168:171], a[112:115]
    v_mfma_f32_16x16x32_bf16 a[116:119], a[24:27], a[172:175], a[116:119]
    v_mfma_f32_16x16x32_bf16 v[248:251], a[28:31], a[160:163], v[248:251]
    v_mfma_f32_16x16x32_bf16 v[252:255], a[28:31], a[164:167], v[252:255]
    v_mfma_f32_16x16x32_bf16 a[120:123], a[28:31], a[168:171], a[120:123]
    v_mfma_f32_16x16x32_bf16 a[124:127], a[28:31], a[172:175], a[124:127]
    s_waitcnt vmcnt(10) lgkmcnt(0)
    s_barrier
    v_mfma_f32_16x16x32_bf16 v[192:195], a[32:35], a[176:179], v[192:195]
    ds_read_b64_tr_b16 a[0:1], v42 offset:32768
    ds_read_b64_tr_b16 a[2:3], v42 offset:33792
    v_mfma_f32_16x16x32_bf16 v[196:199], a[32:35], a[180:183], v[196:199]
    s_add_u32 m0, s60, 147456
    v_mfma_f32_16x16x32_bf16 a[64:67], a[32:35], a[184:187], a[64:67]
    buffer_load_dwordx4 v38, s[12:15], s61 offen offset:0 lds
    ds_read_b64_tr_b16 a[4:5], v43 offset:32768
    v_mfma_f32_16x16x32_bf16 a[68:71], a[32:35], a[188:191], a[68:71]
    ds_read_b64_tr_b16 a[6:7], v43 offset:33792
    v_mfma_f32_16x16x32_bf16 v[200:203], a[36:39], a[176:179], v[200:203]
    buffer_load_dwordx4 v39, s[12:15], s61 offen offset:1024 lds
    ds_read_b64_tr_b16 a[8:9], v44 offset:32768
    v_mfma_f32_16x16x32_bf16 v[204:207], a[36:39], a[180:183], v[204:207]
    v_mfma_f32_16x16x32_bf16 a[72:75], a[36:39], a[184:187], a[72:75]
    ds_read_b64_tr_b16 a[10:11], v44 offset:33792
    v_mfma_f32_16x16x32_bf16 a[76:79], a[36:39], a[188:191], a[76:79]
    buffer_load_dwordx4 v40, s[12:15], s61 offen offset:2048 lds
    ds_read_b64_tr_b16 a[12:13], v45 offset:32768
    v_mfma_f32_16x16x32_bf16 v[208:211], a[40:43], a[176:179], v[208:211]
    v_mfma_f32_16x16x32_bf16 v[212:215], a[40:43], a[180:183], v[212:215]
    ds_read_b64_tr_b16 a[14:15], v45 offset:33792
    v_mfma_f32_16x16x32_bf16 a[80:83], a[40:43], a[184:187], a[80:83]
    buffer_load_dwordx4 v41, s[12:15], s61 offen offset:3072 lds
    ds_read_b64_tr_b16 a[16:17], v46 offset:32768
    v_mfma_f32_16x16x32_bf16 a[84:87], a[40:43], a[188:191], a[84:87]
    ds_read_b64_tr_b16 a[18:19], v46 offset:33792
    v_mfma_f32_16x16x32_bf16 v[216:219], a[44:47], a[176:179], v[216:219]
    s_add_u32 s61, s61, 0x80000
    v_mfma_f32_16x16x32_bf16 v[220:223], a[44:47], a[180:183], v[220:223]
    buffer_load_dwordx4 a[224:227], v36, s[8:11], s62 offen sc1
    ds_read_b64_tr_b16 a[20:21], v47 offset:32768
    v_mfma_f32_16x16x32_bf16 a[88:91], a[44:47], a[184:187], a[88:91]
    ds_read_b64_tr_b16 a[22:23], v47 offset:33792
    v_mfma_f32_16x16x32_bf16 a[92:95], a[44:47], a[188:191], a[92:95]
    buffer_load_dwordx4 a[228:231], v54, s[8:11], s62 offen sc1
    ds_read_b64_tr_b16 a[24:25], v48 offset:32768
    v_mfma_f32_16x16x32_bf16 v[224:227], a[48:51], a[176:179], v[224:227]
    v_mfma_f32_16x16x32_bf16 v[228:231], a[48:51], a[180:183], v[228:231]
    ds_read_b64_tr_b16 a[26:27], v48 offset:33792
    v_mfma_f32_16x16x32_bf16 a[96:99], a[48:51], a[184:187], a[96:99]
    buffer_load_dwordx4 a[232:235], v37, s[8:11], s62 offen sc1
    ds_read_b64_tr_b16 a[28:29], v49 offset:32768
    v_mfma_f32_16x16x32_bf16 a[100:103], a[48:51], a[188:191], a[100:103]
    v_mfma_f32_16x16x32_bf16 v[232:235], a[52:55], a[176:179], v[232:235]
    ds_read_b64_tr_b16 a[30:31], v49 offset:33792
    v_mfma_f32_16x16x32_bf16 v[236:239], a[52:55], a[180:183], v[236:239]
    buffer_load_dwordx4 a[236:239], v55, s[8:11], s62 offen sc1
    v_mfma_f32_16x16x32_bf16 a[104:107], a[52:55], a[184:187], a[104:107]
    v_mfma_f32_16x16x32_bf16 a[108:111], a[52:55], a[188:191], a[108:111]
    s_add_u32 s62, s62, 0x20000
    v_mfma_f32_16x16x32_bf16 v[240:243], a[56:59], a[176:179], v[240:243]
    s_add_u32 s52, s47, 524288
    v_mfma_f32_16x16x32_bf16 v[244:247], a[56:59], a[180:183], v[244:247]
    buffer_store_dwordx4 v[136:139], v1, s[48:51], s52 offen offset:2048 sc1
    v_mfma_f32_16x16x32_bf16 a[112:115], a[56:59], a[184:187], a[112:115]
    v_mfma_f32_16x16x32_bf16 a[116:119], a[56:59], a[188:191], a[116:119]
    v_mfma_f32_16x16x32_bf16 v[248:251], a[60:63], a[176:179], v[248:251]
    s_cmp_eq_u32 s45, 0
    s_cbranch_scc1 k12_ool_60
k12_oolret_61:
    v_mfma_f32_16x16x32_bf16 v[252:255], a[60:63], a[180:183], v[252:255]
    v_mfma_f32_16x16x32_bf16 a[120:123], a[60:63], a[184:187], a[120:123]
    v_mfma_f32_16x16x32_bf16 a[124:127], a[60:63], a[188:191], a[124:127]
    s_waitcnt vmcnt(15) lgkmcnt(0)
    v_mfma_f32_16x16x32_bf16 v[192:195], a[0:3], a[192:195], v[192:195]
    ds_read_b64_tr_b16 a[32:33], v42 offset:40960
    ds_read_b64_tr_b16 a[34:35], v42 offset:41984
    v_mfma_f32_16x16x32_bf16 v[196:199], a[0:3], a[196:199], v[196:199]
    buffer_load_dwordx4 a[240:243], v36, s[8:11], s62 offen sc1
    v_mfma_f32_16x16x32_bf16 a[64:67], a[0:3], a[200:203], a[64:67]
    ds_read_b64_tr_b16 a[36:37], v43 offset:40960
    v_mfma_f32_16x16x32_bf16 a[68:71], a[0:3], a[204:207], a[68:71]
    ds_read_b64_tr_b16 a[38:39], v43 offset:41984
    v_mfma_f32_16x16x32_bf16 v[200:203], a[4:7], a[192:195], v[200:203]
    ds_read_b64_tr_b16 a[40:41], v44 offset:40960
    v_mfma_f32_16x16x32_bf16 v[204:207], a[4:7], a[196:199], v[204:207]
    v_mfma_f32_16x16x32_bf16 a[72:75], a[4:7], a[200:203], a[72:75]
    buffer_load_dwordx4 a[244:247], v54, s[8:11], s62 offen sc1
    ds_read_b64_tr_b16 a[42:43], v44 offset:41984
    v_mfma_f32_16x16x32_bf16 a[76:79], a[4:7], a[204:207], a[76:79]
    ds_read_b64_tr_b16 a[44:45], v45 offset:40960
    v_mfma_f32_16x16x32_bf16 v[208:211], a[8:11], a[192:195], v[208:211]
    v_mfma_f32_16x16x32_bf16 v[212:215], a[8:11], a[196:199], v[212:215]
    ds_read_b64_tr_b16 a[46:47], v45 offset:41984
    v_mfma_f32_16x16x32_bf16 a[80:83], a[8:11], a[200:203], a[80:83]
    ds_read_b64_tr_b16 a[48:49], v46 offset:40960
    v_mfma_f32_16x16x32_bf16 a[84:87], a[8:11], a[204:207], a[84:87]
    buffer_load_dwordx4 a[248:251], v37, s[8:11], s62 offen sc1
    ds_read_b64_tr_b16 a[50:51], v46 offset:41984
    v_mfma_f32_16x16x32_bf16 v[216:219], a[12:15], a[192:195], v[216:219]
    v_mfma_f32_16x16x32_bf16 v[220:223], a[12:15], a[196:199], v[220:223]
    ds_read_b64_tr_b16 a[52:53], v47 offset:40960
    v_mfma_f32_16x16x32_bf16 a[88:91], a[12:15], a[200:203], a[88:91]
    ds_read_b64_tr_b16 a[54:55], v47 offset:41984
    v_mfma_f32_16x16x32_bf16 a[92:95], a[12:15], a[204:207], a[92:95]
    ds_read_b64_tr_b16 a[56:57], v48 offset:40960
    v_mfma_f32_16x16x32_bf16 v[224:227], a[16:19], a[192:195], v[224:227]
    v_mfma_f32_16x16x32_bf16 v[228:231], a[16:19], a[196:199], v[228:231]
    buffer_load_dwordx4 a[252:255], v55, s[8:11], s62 offen sc1
    ds_read_b64_tr_b16 a[58:59], v48 offset:41984
    v_mfma_f32_16x16x32_bf16 a[96:99], a[16:19], a[200:203], a[96:99]
    ds_read_b64_tr_b16 a[60:61], v49 offset:40960
    v_mfma_f32_16x16x32_bf16 a[100:103], a[16:19], a[204:207], a[100:103]
    v_mfma_f32_16x16x32_bf16 v[232:235], a[20:23], a[192:195], v[232:235]
    ds_read_b64_tr_b16 a[62:63], v49 offset:41984
    v_mfma_f32_16x16x32_bf16 v[236:239], a[20:23], a[196:199], v[236:239]
    s_add_u32 s62, s62, 0x20000
    v_mfma_f32_16x16x32_bf16 a[104:107], a[20:23], a[200:203], a[104:107]
    s_add_u32 s52, s47, 524288
    v_mfma_f32_16x16x32_bf16 a[108:111], a[20:23], a[204:207], a[108:111]
    buffer_store_dwordx4 v[140:143], v1, s[48:51], s52 offen offset:3072 sc1
    v_mfma_f32_16x16x32_bf16 v[240:243], a[24:27], a[192:195], v[240:243]
    v_mfma_f32_16x16x32_bf16 v[244:247], a[24:27], a[196:199], v[244:247]
    v_mfma_f32_16x16x32_bf16 a[112:115], a[24:27], a[200:203], a[112:115]
    v_mfma_f32_16x16x32_bf16 a[116:119], a[24:27], a[204:207], a[116:119]
    v_mfma_f32_16x16x32_bf16 v[248:251], a[28:31], a[192:195], v[248:251]
    v_mfma_f32_16x16x32_bf16 v[252:255], a[28:31], a[196:199], v[252:255]
    v_mfma_f32_16x16x32_bf16 a[120:123], a[28:31], a[200:203], a[120:123]
    v_mfma_f32_16x16x32_bf16 a[124:127], a[28:31], a[204:207], a[124:127]
    s_waitcnt vmcnt(10) lgkmcnt(0)
    s_barrier
    v_mfma_f32_16x16x32_bf16 v[192:195], a[32:35], a[208:211], v[192:195]
    ds_read_b64_tr_b16 a[0:1], v42 offset:49152
    ds_read_b64_tr_b16 a[2:3], v42 offset:50176
    v_mfma_f32_16x16x32_bf16 v[196:199], a[32:35], a[212:215], v[196:199]
    s_add_u32 m0, s60, 98304
    v_mfma_f32_16x16x32_bf16 a[64:67], a[32:35], a[216:219], a[64:67]
    buffer_load_dwordx4 v38, s[12:15], s61 offen offset:0 lds
    ds_read_b64_tr_b16 a[4:5], v43 offset:49152
    v_mfma_f32_16x16x32_bf16 a[68:71], a[32:35], a[220:223], a[68:71]
    ds_read_b64_tr_b16 a[6:7], v43 offset:50176
    v_mfma_f32_16x16x32_bf16 v[200:203], a[36:39], a[208:211], v[200:203]
    buffer_load_dwordx4 v39, s[12:15], s61 offen offset:1024 lds
    ds_read_b64_tr_b16 a[8:9], v44 offset:49152
    v_mfma_f32_16x16x32_bf16 v[204:207], a[36:39], a[212:215], v[204:207]
    v_mfma_f32_16x16x32_bf16 a[72:75], a[36:39], a[216:219], a[72:75]
    ds_read_b64_tr_b16 a[10:11], v44 offset:50176
    v_mfma_f32_16x16x32_bf16 a[76:79], a[36:39], a[220:223], a[76:79]
    buffer_load_dwordx4 v40, s[12:15], s61 offen offset:2048 lds
    ds_read_b64_tr_b16 a[12:13], v45 offset:49152
    v_mfma_f32_16x16x32_bf16 v[208:211], a[40:43], a[208:211], v[208:211]
    v_mfma_f32_16x16x32_bf16 v[212:215], a[40:43], a[212:215], v[212:215]
    ds_read_b64_tr_b16 a[14:15], v45 offset:50176
    v_mfma_f32_16x16x32_bf16 a[80:83], a[40:43], a[216:219], a[80:83]
    ds_read_b64_tr_b16 a[16:17], v46 offset:49152
    v_mfma_f32_16x16x32_bf16 a[84:87], a[40:43], a[220:223], a[84:87]
    buffer_load_dwordx4 v41, s[12:15], s61 offen offset:3072 lds
    ds_read_b64_tr_b16 a[18:19], v46 offset:50176
    v_mfma_f32_16x16x32_bf16 v[216:219], a[44:47], a[208:211], v[216:219]
    v_mfma_f32_16x16x32_bf16 v[220:223], a[44:47], a[212:215], v[220:223]
    s_add_u32 s61, s61, 0x80000
    ds_read_b64_tr_b16 a[20:21], v47 offset:49152
    v_mfma_f32_16x16x32_bf16 a[88:91], a[44:47], a[216:219], a[88:91]
    buffer_load_dwordx4 a[128:131], v36, s[8:11], s62 offen sc1
    ds_read_b64_tr_b16 a[22:23], v47 offset:50176
    v_mfma_f32_16x16x32_bf16 a[92:95], a[44:47], a[220:223], a[92:95]
    ds_read_b64_tr_b16 a[24:25], v48 offset:49152
    v_mfma_f32_16x16x32_bf16 v[224:227], a[48:51], a[208:211], v[224:227]
    v_mfma_f32_16x16x32_bf16 v[228:231], a[48:51], a[212:215], v[228:231]
    buffer_load_dwordx4 a[132:135], v54, s[8:11], s62 offen sc1
    ds_read_b64_tr_b16 a[26:27], v48 offset:50176
    v_mfma_f32_16x16x32_bf16 a[96:99], a[48:51], a[216:219], a[96:99]
    ds_read_b64_tr_b16 a[28:29], v49 offset:49152
    v_mfma_f32_16x16x32_bf16 a[100:103], a[48:51], a[220:223], a[100:103]
    v_mfma_f32_16x16x32_bf16 v[232:235], a[52:55], a[208:211], v[232:235]
    buffer_load_dwordx4 a[136:139], v37, s[8:11], s62 offen sc1
    ds_read_b64_tr_b16 a[30:31], v49 offset:50176
    v_mfma_f32_16x16x32_bf16 v[236:239], a[52:55], a[212:215], v[236:239]
    v_mfma_f32_16x16x32_bf16 a[104:107], a[52:55], a[216:219], a[104:107]
    v_mfma_f32_16x16x32_bf16 a[108:111], a[52:55], a[220:223], a[108:111]
    v_mfma_f32_16x16x32_bf16 v[240:243], a[56:59], a[208:211], v[240:243]
    buffer_load_dwordx4 a[140:143], v55, s[8:11], s62 offen sc1
    v_mfma_f32_16x16x32_bf16 v[244:247], a[56:59], a[212:215], v[244:247]
    v_mfma_f32_16x16x32_bf16 a[112:115], a[56:59], a[216:219], a[112:115]
    s_add_u32 s62, s62, 0x20000
    v_mfma_f32_16x16x32_bf16 a[116:119], a[56:59], a[220:223], a[116:119]
    v_mfma_f32_16x16x32_bf16 v[248:251], a[60:63], a[208:211], v[248:251]
    s_cmp_eq_u32 s45, 0
    s_cbranch_scc1 k12_ool_62
k12_oolret_63:
    v_mfma_f32_16x16x32_bf16 v[252:255], a[60:63], a[212:215], v[252:255]
    v_mfma_f32_16x16x32_bf16 a[120:123], a[60:63], a[216:219], a[120:123]
    v_mfma_f32_16x16x32_bf16 a[124:127], a[60:63], a[220:223], a[124:127]
    s_waitcnt vmcnt(14) lgkmcnt(0)
    v_mfma_f32_16x16x32_bf16 v[192:195], a[0:3], a[224:227], v[192:195]
    ds_read_b64_tr_b16 a[32:33], v42 offset:57344
    ds_read_b64_tr_b16 a[34:35], v42 offset:58368
    v_mfma_f32_16x16x32_bf16 v[196:199], a[0:3], a[228:231], v[196:199]
    buffer_load_dwordx4 a[144:147], v36, s[8:11], s62 offen sc1
    v_mfma_f32_16x16x32_bf16 a[64:67], a[0:3], a[232:235], a[64:67]
    ds_read_b64_tr_b16 a[36:37], v43 offset:57344
    v_mfma_f32_16x16x32_bf16 a[68:71], a[0:3], a[236:239], a[68:71]
    ds_read_b64_tr_b16 a[38:39], v43 offset:58368
    v_mfma_f32_16x16x32_bf16 v[200:203], a[4:7], a[224:227], v[200:203]
    ds_read_b64_tr_b16 a[40:41], v44 offset:57344
    v_mfma_f32_16x16x32_bf16 v[204:207], a[4:7], a[228:231], v[204:207]
    v_mfma_f32_16x16x32_bf16 a[72:75], a[4:7], a[232:235], a[72:75]
    buffer_load_dwordx4 a[148:151], v54, s[8:11], s62 offen sc1
    ds_read_b64_tr_b16 a[42:43], v44 offset:58368
    v_mfma_f32_16x16x32_bf16 a[76:79], a[4:7], a[236:239], a[76:79]
    ds_read_b64_tr_b16 a[44:45], v45 offset:57344
    v_mfma_f32_16x16x32_bf16 v[208:211], a[8:11], a[224:227], v[208:211]
    v_mfma_f32_16x16x32_bf16 v[212:215], a[8:11], a[228:231], v[212:215]
    ds_read_b64_tr_b16 a[46:47], v45 offset:58368
    v_mfma_f32_16x16x32_bf16 a[80:83], a[8:11], a[232:235], a[80:83]
    ds_read_b64_tr_b16 a[48:49], v46 offset:57344
    v_mfma_f32_16x16x32_bf16 a[84:87], a[8:11], a[236:239], a[84:87]
    buffer_load_dwordx4 a[152:155], v37, s[8:11], s62 offen sc1
    ds_read_b64_tr_b16 a[50:51], v46 offset:58368
    v_mfma_f32_16x16x32_bf16 v[216:219], a[12:15], a[224:227], v[216:219]
    v_mfma_f32_16x16x32_bf16 v[220:223], a[12:15], a[228:231], v[220:223]
    ds_read_b64_tr_b16 a[52:53], v47 offset:57344
    v_mfma_f32_16x16x32_bf16 a[88:91], a[12:15], a[232:235], a[88:91]
    ds_read_b64_tr_b16 a[54:55], v47 offset:58368
    v_mfma_f32_16x16x32_bf16 a[92:95], a[12:15], a[236:239], a[92:95]
    ds_read_b64_tr_b16 a[56:57], v48 offset:57344
    v_mfma_f32_16x16x32_bf16 v[224:227], a[16:19], a[224:227], v[224:227]
    v_mfma_f32_16x16x32_bf16 v[228:231], a[16:19], a[228:231], v[228:231]
    buffer_load_dwordx4 a[156:159], v55, s[8:11], s62 offen sc1
    ds_read_b64_tr_b16 a[58:59], v48 offset:58368
    v_mfma_f32_16x16x32_bf16 a[96:99], a[16:19], a[232:235], a[96:99]
    ds_read_b64_tr_b16 a[60:61], v49 offset:57344
    v_mfma_f32_16x16x32_bf16 a[100:103], a[16:19], a[236:239], a[100:103]
    v_mfma_f32_16x16x32_bf16 v[232:235], a[20:23], a[224:227], v[232:235]
    ds_read_b64_tr_b16 a[62:63], v49 offset:58368
    v_mfma_f32_16x16x32_bf16 v[236:239], a[20:23], a[228:231], v[236:239]
    s_add_u32 s62, s62, 0x20000
    v_mfma_f32_16x16x32_bf16 a[104:107], a[20:23], a[232:235], a[104:107]
    s_add_u32 s52, s47, 528384
    v_mfma_f32_16x16x32_bf16 a[108:111], a[20:23], a[236:239], a[108:111]
    buffer_store_dwordx4 v[144:147], v1, s[48:51], s52 offen offset:0 sc1
    v_mfma_f32_16x16x32_bf16 v[240:243], a[24:27], a[224:227], v[240:243]
    v_mfma_f32_16x16x32_bf16 v[244:247], a[24:27], a[228:231], v[244:247]
    v_mfma_f32_16x16x32_bf16 a[112:115], a[24:27], a[232:235], a[112:115]
    v_mfma_f32_16x16x32_bf16 a[116:119], a[24:27], a[236:239], a[116:119]
    v_mfma_f32_16x16x32_bf16 v[248:251], a[28:31], a[224:227], v[248:251]
    v_mfma_f32_16x16x32_bf16 v[252:255], a[28:31], a[228:231], v[252:255]
    v_mfma_f32_16x16x32_bf16 a[120:123], a[28:31], a[232:235], a[120:123]
    v_mfma_f32_16x16x32_bf16 a[124:127], a[28:31], a[236:239], a[124:127]
    s_waitcnt vmcnt(9) lgkmcnt(0)
    s_barrier
    v_mfma_f32_16x16x32_bf16 v[192:195], a[32:35], a[240:243], v[192:195]
    ds_read_b64_tr_b16 a[0:1], v42 offset:0
    ds_read_b64_tr_b16 a[2:3], v42 offset:1024
    v_mfma_f32_16x16x32_bf16 v[196:199], a[32:35], a[244:247], v[196:199]
    s_add_u32 m0, s60, 114688
    v_mfma_f32_16x16x32_bf16 a[64:67], a[32:35], a[248:251], a[64:67]
    buffer_load_dwordx4 v38, s[12:15], s61 offen offset:0 lds
    ds_read_b64_tr_b16 a[4:5], v43 offset:0
    v_mfma_f32_16x16x32_bf16 a[68:71], a[32:35], a[252:255], a[68:71]
    ds_read_b64_tr_b16 a[6:7], v43 offset:1024
    v_mfma_f32_16x16x32_bf16 v[200:203], a[36:39], a[240:243], v[200:203]
    buffer_load_dwordx4 v39, s[12:15], s61 offen offset:1024 lds
    ds_read_b64_tr_b16 a[8:9], v44 offset:0
    v_mfma_f32_16x16x32_bf16 v[204:207], a[36:39], a[244:247], v[204:207]
    v_mfma_f32_16x16x32_bf16 a[72:75], a[36:39], a[248:251], a[72:75]
    ds_read_b64_tr_b16 a[10:11], v44 offset:1024
    v_mfma_f32_16x16x32_bf16 a[76:79], a[36:39], a[252:255], a[76:79]
    buffer_load_dwordx4 v40, s[12:15], s61 offen offset:2048 lds
    ds_read_b64_tr_b16 a[12:13], v45 offset:0
    v_mfma_f32_16x16x32_bf16 v[208:211], a[40:43], a[240:243], v[208:211]
    v_mfma_f32_16x16x32_bf16 v[212:215], a[40:43], a[244:247], v[212:215]
    ds_read_b64_tr_b16 a[14:15], v45 offset:1024
    v_mfma_f32_16x16x32_bf16 a[80:83], a[40:43], a[248:251], a[80:83]
    buffer_load_dwordx4 v41, s[12:15], s61 offen offset:3072 lds
    ds_read_b64_tr_b16 a[16:17], v46 offset:0
    v_mfma_f32_16x16x32_bf16 a[84:87], a[40:43], a[252:255], a[84:87]
    ds_read_b64_tr_b16 a[18:19], v46 offset:1024
    v_mfma_f32_16x16x32_bf16 v[216:219], a[44:47], a[240:243], v[216:219]
    s_add_u32 s61, s61, 0x80000
    v_mfma_f32_16x16x32_bf16 v[220:223], a[44:47], a[244:247], v[220:223]
    buffer_load_dwordx4 a[160:163], v36, s[8:11], s62 offen sc1
    ds_read_b64_tr_b16 a[20:21], v47 offset:0
    v_mfma_f32_16x16x32_bf16 a[88:91], a[44:47], a[248:251], a[88:91]
    ds_read_b64_tr_b16 a[22:23], v47 offset:1024
    v_mfma_f32_16x16x32_bf16 a[92:95], a[44:47], a[252:255], a[92:95]
    buffer_load_dwordx4 a[164:167], v54, s[8:11], s62 offen sc1
    ds_read_b64_tr_b16 a[24:25], v48 offset:0
    v_mfma_f32_16x16x32_bf16 v[224:227], a[48:51], a[240:243], v[224:227]
    v_mfma_f32_16x16x32_bf16 v[228:231], a[48:51], a[244:247], v[228:231]
    ds_read_b64_tr_b16 a[26:27], v48 offset:1024
    v_mfma_f32_16x16x32_bf16 a[96:99], a[48:51], a[248:251], a[96:99]
    buffer_load_dwordx4 a[168:171], v37, s[8:11], s62 offen sc1
    ds_read_b64_tr_b16 a[28:29], v49 offset:0
    v_mfma_f32_16x16x32_bf16 a[100:103], a[48:51], a[252:255], a[100:103]
    v_mfma_f32_16x16x32_bf16 v[232:235], a[52:55], a[240:243], v[232:235]
    ds_read_b64_tr_b16 a[30:31], v49 offset:1024
    v_mfma_f32_16x16x32_bf16 v[236:239], a[52:55], a[244:247], v[236:239]
    buffer_load_dwordx4 a[172:175], v55, s[8:11], s62 offen sc1
    v_mfma_f32_16x16x32_bf16 a[104:107], a[52:55], a[248:251], a[104:107]
    v_mfma_f32_16x16x32_bf16 a[108:111], a[52:55], a[252:255], a[108:111]
    s_add_u32 s62, s62, 0x20000
    v_mfma_f32_16x16x32_bf16 v[240:243], a[56:59], a[240:243], v[240:243]
    s_add_u32 s52, s47, 528384
    v_mfma_f32_16x16x32_bf16 v[244:247], a[56:59], a[244:247], v[244:247]
    buffer_store_dwordx4 v[148:151], v1, s[48:51], s52 offen offset:1024 sc1
    v_mfma_f32_16x16x32_bf16 a[112:115], a[56:59], a[248:251], a[112:115]
    v_mfma_f32_16x16x32_bf16 a[116:119], a[56:59], a[252:255], a[116:119]
    v_mfma_f32_16x16x32_bf16 v[248:251], a[60:63], a[240:243], v[248:251]
    s_cmp_eq_u32 s45, 0
    s_cbranch_scc1 k12_ool_64
k12_oolret_65:
    v_mfma_f32_16x16x32_bf16 v[252:255], a[60:63], a[244:247], v[252:255]
    v_mfma_f32_16x16x32_bf16 a[120:123], a[60:63], a[248:251], a[120:123]
    v_mfma_f32_16x16x32_bf16 a[124:127], a[60:63], a[252:255], a[124:127]
    s_waitcnt vmcnt(14) lgkmcnt(0)
    v_mfma_f32_16x16x32_bf16 v[192:195], a[0:3], a[128:131], v[192:195]
    ds_read_b64_tr_b16 a[32:33], v42 offset:8192
    ds_read_b64_tr_b16 a[34:35], v42 offset:9216
    v_mfma_f32_16x16x32_bf16 v[196:199], a[0:3], a[132:135], v[196:199]
    buffer_load_dwordx4 a[176:179], v36, s[8:11], s62 offen sc1
    v_mfma_f32_16x16x32_bf16 a[64:67], a[0:3], a[136:139], a[64:67]
    ds_read_b64_tr_b16 a[36:37], v43 offset:8192
    v_mfma_f32_16x16x32_bf16 a[68:71], a[0:3], a[140:143], a[68:71]
    ds_read_b64_tr_b16 a[38:39], v43 offset:9216
    v_mfma_f32_16x16x32_bf16 v[200:203], a[4:7], a[128:131], v[200:203]
    ds_read_b64_tr_b16 a[40:41], v44 offset:8192
    v_mfma_f32_16x16x32_bf16 v[204:207], a[4:7], a[132:135], v[204:207]
    v_mfma_f32_16x16x32_bf16 a[72:75], a[4:7], a[136:139], a[72:75]
    buffer_load_dwordx4 a[180:183], v54, s[8:11], s62 offen sc1
    ds_read_b64_tr_b16 a[42:43], v44 offset:9216
    v_mfma_f32_16x16x32_bf16 a[76:79], a[4:7], a[140:143], a[76:79]
    ds_read_b64_tr_b16 a[44:45], v45 offset:8192
    v_mfma_f32_16x16x32_bf16 v[208:211], a[8:11], a[128:131], v[208:211]
    v_mfma_f32_16x16x32_bf16 v[212:215], a[8:11], a[132:135], v[212:215]
    ds_read_b64_tr_b16 a[46:47], v45 offset:9216
    v_mfma_f32_16x16x32_bf16 a[80:83], a[8:11], a[136:139], a[80:83]
    ds_read_b64_tr_b16 a[48:49], v46 offset:8192
    v_mfma_f32_16x16x32_bf16 a[84:87], a[8:11], a[140:143], a[84:87]
    buffer_load_dwordx4 a[184:187], v37, s[8:11], s62 offen sc1
    ds_read_b64_tr_b16 a[50:51], v46 offset:9216
    v_mfma_f32_16x16x32_bf16 v[216:219], a[12:15], a[128:131], v[216:219]
    v_mfma_f32_16x16x32_bf16 v[220:223], a[12:15], a[132:135], v[220:223]
    ds_read_b64_tr_b16 a[52:53], v47 offset:8192
    v_mfma_f32_16x16x32_bf16 a[88:91], a[12:15], a[136:139], a[88:91]
    ds_read_b64_tr_b16 a[54:55], v47 offset:9216
    v_mfma_f32_16x16x32_bf16 a[92:95], a[12:15], a[140:143], a[92:95]
    ds_read_b64_tr_b16 a[56:57], v48 offset:8192
    v_mfma_f32_16x16x32_bf16 v[224:227], a[16:19], a[128:131], v[224:227]
    v_mfma_f32_16x16x32_bf16 v[228:231], a[16:19], a[132:135], v[228:231]
    buffer_load_dwordx4 a[188:191], v55, s[8:11], s62 offen sc1
    ds_read_b64_tr_b16 a[58:59], v48 offset:9216
    v_mfma_f32_16x16x32_bf16 a[96:99], a[16:19], a[136:139], a[96:99]
    ds_read_b64_tr_b16 a[60:61], v49 offset:8192
    v_mfma_f32_16x16x32_bf16 a[100:103], a[16:19], a[140:143], a[100:103]
    v_mfma_f32_16x16x32_bf16 v[232:235], a[20:23], a[128:131], v[232:235]
    ds_read_b64_tr_b16 a[62:63], v49 offset:9216
    v_mfma_f32_16x16x32_bf16 v[236:239], a[20:23], a[132:135], v[236:239]
    s_add_u32 s62, s62, 0x20000
    v_mfma_f32_16x16x32_bf16 a[104:107], a[20:23], a[136:139], a[104:107]
    s_add_u32 s52, s47, 528384
    v_mfma_f32_16x16x32_bf16 a[108:111], a[20:23], a[140:143], a[108:111]
    buffer_store_dwordx4 v[152:155], v1, s[48:51], s52 offen offset:2048 sc1
    v_mfma_f32_16x16x32_bf16 v[240:243], a[24:27], a[128:131], v[240:243]
    v_mfma_f32_16x16x32_bf16 v[244:247], a[24:27], a[132:135], v[244:247]
    v_mfma_f32_16x16x32_bf16 a[112:115], a[24:27], a[136:139], a[112:115]
    v_mfma_f32_16x16x32_bf16 a[116:119], a[24:27], a[140:143], a[116:119]
    v_mfma_f32_16x16x32_bf16 v[248:251], a[28:31], a[128:131], v[248:251]
    v_mfma_f32_16x16x32_bf16 v[252:255], a[28:31], a[132:135], v[252:255]
    v_mfma_f32_16x16x32_bf16 a[120:123], a[28:31], a[136:139], a[120:123]
    v_mfma_f32_16x16x32_bf16 a[124:127], a[28:31], a[140:143], a[124:127]
    s_waitcnt vmcnt(10) lgkmcnt(0)
    s_barrier
    v_mfma_f32_16x16x32_bf16 v[192:195], a[32:35], a[144:147], v[192:195]
    ds_read_b64_tr_b16 a[0:1], v42 offset:16384
    ds_read_b64_tr_b16 a[2:3], v42 offset:17408
    v_mfma_f32_16x16x32_bf16 v[196:199], a[32:35], a[148:151], v[196:199]
    s_add_u32 m0, s60, 131072
    v_mfma_f32_16x16x32_bf16 a[64:67], a[32:35], a[152:155], a[64:67]
    buffer_load_dwordx4 v38, s[12:15], s61 offen offset:0 lds
    ds_read_b64_tr_b16 a[4:5], v43 offset:16384
    v_mfma_f32_16x16x32_bf16 a[68:71], a[32:35], a[156:159], a[68:71]
    ds_read_b64_tr_b16 a[6:7], v43 offset:17408
    v_mfma_f32_16x16x32_bf16 v[200:203], a[36:39], a[144:147], v[200:203]
    buffer_load_dwordx4 v39, s[12:15], s61 offen offset:1024 lds
    ds_read_b64_tr_b16 a[8:9], v44 offset:16384
    v_mfma_f32_16x16x32_bf16 v[204:207], a[36:39], a[148:151], v[204:207]
    v_mfma_f32_16x16x32_bf16 a[72:75], a[36:39], a[152:155], a[72:75]
    ds_read_b64_tr_b16 a[10:11], v44 offset:17408
    v_mfma_f32_16x16x32_bf16 a[76:79], a[36:39], a[156:159], a[76:79]
    buffer_load_dwordx4 v40, s[12:15], s61 offen offset:2048 lds
    ds_read_b64_tr_b16 a[12:13], v45 offset:16384
    v_mfma_f32_16x16x32_bf16 v[208:211], a[40:43], a[144:147], v[208:211]
    v_mfma_f32_16x16x32_bf16 v[212:215], a[40:43], a[148:151], v[212:215]
    ds_read_b64_tr_b16 a[14:15], v45 offset:17408
    v_mfma_f32_16x16x32_bf16 a[80:83], a[40:43], a[152:155], a[80:83]
    buffer_load_dwordx4 v41, s[12:15], s61 offen offset:3072 lds
    ds_read_b64_tr_b16 a[16:17], v46 offset:16384
    v_mfma_f32_16x16x32_bf16 a[84:87], a[40:43], a[156:159], a[84:87]
    ds_read_b64_tr_b16 a[18:19], v46 offset:17408
    v_mfma_f32_16x16x32_bf16 v[216:219], a[44:47], a[144:147], v[216:219]
    s_add_u32 s61, s61, 0x80000
    v_mfma_f32_16x16x32_bf16 v[220:223], a[44:47], a[148:151], v[220:223]
    buffer_load_dwordx4 a[192:195], v36, s[8:11], s62 offen sc1
    ds_read_b64_tr_b16 a[20:21], v47 offset:16384
    v_mfma_f32_16x16x32_bf16 a[88:91], a[44:47], a[152:155], a[88:91]
    ds_read_b64_tr_b16 a[22:23], v47 offset:17408
    v_mfma_f32_16x16x32_bf16 a[92:95], a[44:47], a[156:159], a[92:95]
    buffer_load_dwordx4 a[196:199], v54, s[8:11], s62 offen sc1
    ds_read_b64_tr_b16 a[24:25], v48 offset:16384
    v_mfma_f32_16x16x32_bf16 v[224:227], a[48:51], a[144:147], v[224:227]
    v_mfma_f32_16x16x32_bf16 v[228:231], a[48:51], a[148:151], v[228:231]
    ds_read_b64_tr_b16 a[26:27], v48 offset:17408
    v_mfma_f32_16x16x32_bf16 a[96:99], a[48:51], a[152:155], a[96:99]
    buffer_load_dwordx4 a[200:203], v37, s[8:11], s62 offen sc1
    ds_read_b64_tr_b16 a[28:29], v49 offset:16384
    v_mfma_f32_16x16x32_bf16 a[100:103], a[48:51], a[156:159], a[100:103]
    v_mfma_f32_16x16x32_bf16 v[232:235], a[52:55], a[144:147], v[232:235]
    ds_read_b64_tr_b16 a[30:31], v49 offset:17408
    v_mfma_f32_16x16x32_bf16 v[236:239], a[52:55], a[148:151], v[236:239]
    buffer_load_dwordx4 a[204:207], v55, s[8:11], s62 offen sc1
    v_mfma_f32_16x16x32_bf16 a[104:107], a[52:55], a[152:155], a[104:107]
    v_mfma_f32_16x16x32_bf16 a[108:111], a[52:55], a[156:159], a[108:111]
    s_add_u32 s62, s62, 0x20000
    v_mfma_f32_16x16x32_bf16 v[240:243], a[56:59], a[144:147], v[240:243]
    s_add_u32 s52, s47, 528384
    v_mfma_f32_16x16x32_bf16 v[244:247], a[56:59], a[148:151], v[244:247]
    buffer_store_dwordx4 v[156:159], v1, s[48:51], s52 offen offset:3072 sc1
    v_mfma_f32_16x16x32_bf16 a[112:115], a[56:59], a[152:155], a[112:115]
    v_mfma_f32_16x16x32_bf16 a[116:119], a[56:59], a[156:159], a[116:119]
    v_mfma_f32_16x16x32_bf16 v[248:251], a[60:63], a[144:147], v[248:251]
    v_mfma_f32_16x16x32_bf16 v[252:255], a[60:63], a[148:151], v[252:255]
    v_mfma_f32_16x16x32_bf16 a[120:123], a[60:63], a[152:155], a[120:123]
    v_mfma_f32_16x16x32_bf16 a[124:127], a[60:63], a[156:159], a[124:127]
    s_waitcnt vmcnt(15) lgkmcnt(0)
    v_mfma_f32_16x16x32_bf16 v[192:195], a[0:3], a[160:163], v[192:195]
    ds_read_b64_tr_b16 a[32:33], v42 offset:24576
    ds_read_b64_tr_b16 a[34:35], v42 offset:25600
    v_mfma_f32_16x16x32_bf16 v[196:199], a[0:3], a[164:167], v[196:199]
    buffer_load_dwordx4 a[208:211], v36, s[8:11], s62 offen sc1
    v_mfma_f32_16x16x32_bf16 a[64:67], a[0:3], a[168:171], a[64:67]
    ds_read_b64_tr_b16 a[36:37], v43 offset:24576
    v_mfma_f32_16x16x32_bf16 a[68:71], a[0:3], a[172:175], a[68:71]
    ds_read_b64_tr_b16 a[38:39], v43 offset:25600
    v_mfma_f32_16x16x32_bf16 v[200:203], a[4:7], a[160:163], v[200:203]
    ds_read_b64_tr_b16 a[40:41], v44 offset:24576
    v_mfma_f32_16x16x32_bf16 v[204:207], a[4:7], a[164:167], v[204:207]
    v_mfma_f32_16x16x32_bf16 a[72:75], a[4:7], a[168:171], a[72:75]
    buffer_load_dwordx4 a[212:215], v54, s[8:11], s62 offen sc1
    ds_read_b64_tr_b16 a[42:43], v44 offset:25600
    v_mfma_f32_16x16x32_bf16 a[76:79], a[4:7], a[172:175], a[76:79]
    ds_read_b64_tr_b16 a[44:45], v45 offset:24576
    v_mfma_f32_16x16x32_bf16 v[208:211], a[8:11], a[160:163], v[208:211]
    v_mfma_f32_16x16x32_bf16 v[212:215], a[8:11], a[164:167], v[212:215]
    ds_read_b64_tr_b16 a[46:47], v45 offset:25600
    v_mfma_f32_16x16x32_bf16 a[80:83], a[8:11], a[168:171], a[80:83]
    ds_read_b64_tr_b16 a[48:49], v46 offset:24576
    v_mfma_f32_16x16x32_bf16 a[84:87], a[8:11], a[172:175], a[84:87]
    buffer_load_dwordx4 a[216:219], v37, s[8:11], s62 offen sc1
    ds_read_b64_tr_b16 a[50:51], v46 offset:25600
    v_mfma_f32_16x16x32_bf16 v[216:219], a[12:15], a[160:163], v[216:219]
    v_mfma_f32_16x16x32_bf16 v[220:223], a[12:15], a[164:167], v[220:223]
    ds_read_b64_tr_b16 a[52:53], v47 offset:24576
    v_mfma_f32_16x16x32_bf16 a[88:91], a[12:15], a[168:171], a[88:91]
    ds_read_b64_tr_b16 a[54:55], v47 offset:25600
    v_mfma_f32_16x16x32_bf16 a[92:95], a[12:15], a[172:175], a[92:95]
    ds_read_b64_tr_b16 a[56:57], v48 offset:24576
    v_mfma_f32_16x16x32_bf16 v[224:227], a[16:19], a[160:163], v[224:227]
    v_mfma_f32_16x16x32_bf16 v[228:231], a[16:19], a[164:167], v[228:231]
    buffer_load_dwordx4 a[220:223], v55, s[8:11], s62 offen sc1
    ds_read_b64_tr_b16 a[58:59], v48 offset:25600
    v_mfma_f32_16x16x32_bf16 a[96:99], a[16:19], a[168:171], a[96:99]
    ds_read_b64_tr_b16 a[60:61], v49 offset:24576
    v_mfma_f32_16x16x32_bf16 a[100:103], a[16:19], a[172:175], a[100:103]
    v_mfma_f32_16x16x32_bf16 v[232:235], a[20:23], a[160:163], v[232:235]
    ds_read_b64_tr_b16 a[62:63], v49 offset:25600
    v_mfma_f32_16x16x32_bf16 v[236:239], a[20:23], a[164:167], v[236:239]
    s_add_u32 s62, s62, 0x20000
    v_mfma_f32_16x16x32_bf16 a[104:107], a[20:23], a[168:171], a[104:107]
    s_add_u32 s52, s47, 532480
    v_mfma_f32_16x16x32_bf16 a[108:111], a[20:23], a[172:175], a[108:111]
    buffer_store_dwordx4 v[168:171], v1, s[48:51], s52 offen offset:2048 sc1
    v_mfma_f32_16x16x32_bf16 v[240:243], a[24:27], a[160:163], v[240:243]
    v_mfma_f32_16x16x32_bf16 v[244:247], a[24:27], a[164:167], v[244:247]
    v_mfma_f32_16x16x32_bf16 a[112:115], a[24:27], a[168:171], a[112:115]
    v_mfma_f32_16x16x32_bf16 a[116:119], a[24:27], a[172:175], a[116:119]
    v_mfma_f32_16x16x32_bf16 v[248:251], a[28:31], a[160:163], v[248:251]
    v_mfma_f32_16x16x32_bf16 v[252:255], a[28:31], a[164:167], v[252:255]
    v_mfma_f32_16x16x32_bf16 a[120:123], a[28:31], a[168:171], a[120:123]
    v_mfma_f32_16x16x32_bf16 a[124:127], a[28:31], a[172:175], a[124:127]
    s_waitcnt vmcnt(10) lgkmcnt(0)
    s_barrier
    v_mfma_f32_16x16x32_bf16 v[192:195], a[32:35], a[176:179], v[192:195]
    ds_read_b64_tr_b16 a[0:1], v42 offset:32768
    ds_read_b64_tr_b16 a[2:3], v42 offset:33792
    v_mfma_f32_16x16x32_bf16 v[196:199], a[32:35], a[180:183], v[196:199]
    s_cmp_eq_u32 s56, 0
    s_cbranch_scc1 k12_ool_66
k12_oolret_67:
    v_mfma_f32_16x16x32_bf16 a[64:67], a[32:35], a[184:187], a[64:67]
    s_add_u32 m0, s60, 147456
    ds_read_b64_tr_b16 a[4:5], v43 offset:32768
    v_mfma_f32_16x16x32_bf16 a[68:71], a[32:35], a[188:191], a[68:71]
    buffer_load_dwordx4 v38, s[12:15], s61 offen offset:0 lds
    ds_read_b64_tr_b16 a[6:7], v43 offset:33792
    v_mfma_f32_16x16x32_bf16 v[200:203], a[36:39], a[176:179], v[200:203]
    buffer_load_dwordx4 v39, s[12:15], s61 offen offset:1024 lds
    ds_read_b64_tr_b16 a[8:9], v44 offset:32768
    v_mfma_f32_16x16x32_bf16 v[204:207], a[36:39], a[180:183], v[204:207]
    v_mfma_f32_16x16x32_bf16 a[72:75], a[36:39], a[184:187], a[72:75]
    ds_read_b64_tr_b16 a[10:11], v44 offset:33792
    v_mfma_f32_16x16x32_bf16 a[76:79], a[36:39], a[188:191], a[76:79]
    buffer_load_dwordx4 v40, s[12:15], s61 offen offset:2048 lds
    ds_read_b64_tr_b16 a[12:13], v45 offset:32768
    v_mfma_f32_16x16x32_bf16 v[208:211], a[40:43], a[176:179], v[208:211]
    s_mov_b32 s32, s60
    v_mfma_f32_16x16x32_bf16 v[212:215], a[40:43], a[180:183], v[212:215]
    ds_read_b64_tr_b16 a[14:15], v45 offset:33792
    v_mfma_f32_16x16x32_bf16 a[80:83], a[40:43], a[184:187], a[80:83]
    s_mov_b32 s34, s60
    ds_read_b64_tr_b16 a[16:17], v46 offset:32768
    v_mfma_f32_16x16x32_bf16 a[84:87], a[40:43], a[188:191], a[84:87]
    buffer_load_dwordx4 v41, s[12:15], s61 offen offset:3072 lds
    ds_read_b64_tr_b16 a[18:19], v46 offset:33792
    v_mfma_f32_16x16x32_bf16 v[216:219], a[44:47], a[176:179], v[216:219]
    v_mfma_f32_16x16x32_bf16 v[220:223], a[44:47], a[180:183], v[220:223]
    s_mov_b32 s33, s60
    ds_read_b64_tr_b16 a[20:21], v47 offset:32768
    v_mfma_f32_16x16x32_bf16 a[88:91], a[44:47], a[184:187], a[88:91]
    s_add_u32 s61, s61, 0x80000
    buffer_load_dwordx4 a[224:227], v36, s[8:11], s62 offen sc1
    ds_read_b64_tr_b16 a[22:23], v47 offset:33792
    v_mfma_f32_16x16x32_bf16 a[92:95], a[44:47], a[188:191], a[92:95]
    ds_read_b64_tr_b16 a[24:25], v48 offset:32768
    v_mfma_f32_16x16x32_bf16 v[224:227], a[48:51], a[176:179], v[224:227]
    s_add_u32 s35, s60, 0x10000
    v_mfma_f32_16x16x32_bf16 v[228:231], a[48:51], a[180:183], v[228:231]
    buffer_load_dwordx4 a[228:231], v54, s[8:11], s62 offen sc1
    ds_read_b64_tr_b16 a[26:27], v48 offset:33792
    v_mfma_f32_16x16x32_bf16 a[96:99], a[48:51], a[184:187], a[96:99]
    ds_read_b64_tr_b16 a[28:29], v49 offset:32768
    v_mfma_f32_16x16x32_bf16 a[100:103], a[48:51], a[188:191], a[100:103]
    v_mfma_f32_16x16x32_bf16 v[232:235], a[52:55], a[176:179], v[232:235]
    buffer_load_dwordx4 a[232:235], v37, s[8:11], s62 offen sc1
    ds_read_b64_tr_b16 a[30:31], v49 offset:33792
    v_mfma_f32_16x16x32_bf16 v[236:239], a[52:55], a[180:183], v[236:239]
    v_mfma_f32_16x16x32_bf16 a[104:107], a[52:55], a[184:187], a[104:107]
    v_mfma_f32_16x16x32_bf16 a[108:111], a[52:55], a[188:191], a[108:111]
    v_mfma_f32_16x16x32_bf16 v[240:243], a[56:59], a[176:179], v[240:243]
    buffer_load_dwordx4 a[236:239], v55, s[8:11], s62 offen sc1
    v_mfma_f32_16x16x32_bf16 v[244:247], a[56:59], a[180:183], v[244:247]
    v_mfma_f32_16x16x32_bf16 a[112:115], a[56:59], a[184:187], a[112:115]
    s_add_u32 s62, s62, 0x20000
    v_mfma_f32_16x16x32_bf16 a[116:119], a[56:59], a[188:191], a[116:119]
    v_mfma_f32_16x16x32_bf16 v[248:251], a[60:63], a[176:179], v[248:251]
    v_mfma_f32_16x16x32_bf16 v[252:255], a[60:63], a[180:183], v[252:255]
    v_mfma_f32_16x16x32_bf16 a[120:123], a[60:63], a[184:187], a[120:123]
    v_mfma_f32_16x16x32_bf16 a[124:127], a[60:63], a[188:191], a[124:127]
    s_waitcnt vmcnt(14) lgkmcnt(0)
    v_mfma_f32_16x16x32_bf16 v[192:195], a[0:3], a[192:195], v[192:195]
    ds_read_b64_tr_b16 a[32:33], v42 offset:40960
    ds_read_b64_tr_b16 a[34:35], v42 offset:41984
    v_mfma_f32_16x16x32_bf16 v[196:199], a[0:3], a[196:199], v[196:199]
    buffer_load_dwordx4 a[240:243], v36, s[8:11], s62 offen sc1
    v_mfma_f32_16x16x32_bf16 a[64:67], a[0:3], a[200:203], a[64:67]
    ds_read_b64_tr_b16 a[36:37], v43 offset:40960
    v_mfma_f32_16x16x32_bf16 a[68:71], a[0:3], a[204:207], a[68:71]
    ds_read_b64_tr_b16 a[38:39], v43 offset:41984
    v_mfma_f32_16x16x32_bf16 v[200:203], a[4:7], a[192:195], v[200:203]
    ds_read_b64_tr_b16 a[40:41], v44 offset:40960
    v_mfma_f32_16x16x32_bf16 v[204:207], a[4:7], a[196:199], v[204:207]
    v_mfma_f32_16x16x32_bf16 a[72:75], a[4:7], a[200:203], a[72:75]
    buffer_load_dwordx4 a[244:247], v54, s[8:11], s62 offen sc1
    ds_read_b64_tr_b16 a[42:43], v44 offset:41984
    v_mfma_f32_16x16x32_bf16 a[76:79], a[4:7], a[204:207], a[76:79]
    ds_read_b64_tr_b16 a[44:45], v45 offset:40960
    v_mfma_f32_16x16x32_bf16 v[208:211], a[8:11], a[192:195], v[208:211]
    v_mfma_f32_16x16x32_bf16 v[212:215], a[8:11], a[196:199], v[212:215]
    ds_read_b64_tr_b16 a[46:47], v45 offset:41984
    v_mfma_f32_16x16x32_bf16 a[80:83], a[8:11], a[200:203], a[80:83]
    ds_read_b64_tr_b16 a[48:49], v46 offset:40960
    v_mfma_f32_16x16x32_bf16 a[84:87], a[8:11], a[204:207], a[84:87]
    buffer_load_dwordx4 a[248:251], v37, s[8:11], s62 offen sc1
    ds_read_b64_tr_b16 a[50:51], v46 offset:41984
    v_mfma_f32_16x16x32_bf16 v[216:219], a[12:15], a[192:195], v[216:219]
    v_mfma_f32_16x16x32_bf16 v[220:223], a[12:15], a[196:199], v[220:223]
    ds_read_b64_tr_b16 a[52:53], v47 offset:40960
    v_mfma_f32_16x16x32_bf16 a[88:91], a[12:15], a[200:203], a[88:91]
    ds_read_b64_tr_b16 a[54:55], v47 offset:41984
    v_mfma_f32_16x16x32_bf16 a[92:95], a[12:15], a[204:207], a[92:95]
    ds_read_b64_tr_b16 a[56:57], v48 offset:40960
    v_mfma_f32_16x16x32_bf16 v[224:227], a[16:19], a[192:195], v[224:227]
    v_mfma_f32_16x16x32_bf16 v[228:231], a[16:19], a[196:199], v[228:231]
    buffer_load_dwordx4 a[252:255], v55, s[8:11], s62 offen sc1
    ds_read_b64_tr_b16 a[58:59], v48 offset:41984
    v_mfma_f32_16x16x32_bf16 a[96:99], a[16:19], a[200:203], a[96:99]
    ds_read_b64_tr_b16 a[60:61], v49 offset:40960
    v_mfma_f32_16x16x32_bf16 a[100:103], a[16:19], a[204:207], a[100:103]
    v_mfma_f32_16x16x32_bf16 v[232:235], a[20:23], a[192:195], v[232:235]
    ds_read_b64_tr_b16 a[62:63], v49 offset:41984
    v_mfma_f32_16x16x32_bf16 v[236:239], a[20:23], a[196:199], v[236:239]
    s_add_u32 s62, s62, 0x20000
    v_mfma_f32_16x16x32_bf16 a[104:107], a[20:23], a[200:203], a[104:107]
    s_add_u32 s52, s47, 532480
    v_mfma_f32_16x16x32_bf16 a[108:111], a[20:23], a[204:207], a[108:111]
    buffer_store_dwordx4 v[172:175], v1, s[48:51], s52 offen offset:3072 sc1
    v_mfma_f32_16x16x32_bf16 v[240:243], a[24:27], a[192:195], v[240:243]
    v_mfma_f32_16x16x32_bf16 v[244:247], a[24:27], a[196:199], v[244:247]
    v_mfma_f32_16x16x32_bf16 a[112:115], a[24:27], a[200:203], a[112:115]
    v_mfma_f32_16x16x32_bf16 a[116:119], a[24:27], a[204:207], a[116:119]
    v_mfma_f32_16x16x32_bf16 v[248:251], a[28:31], a[192:195], v[248:251]
    v_add_co_u32 v2, vcc, 0x4000, v2
    s_nop 1
    v_addc_co_u32 v3, vcc, 0, v3, vcc
    global_load_dword v51, v[2:3], off
    v_mfma_f32_16x16x32_bf16 v[252:255], a[28:31], a[196:199], v[252:255]
    v_mfma_f32_16x16x32_bf16 a[120:123], a[28:31], a[200:203], a[120:123]
    v_mfma_f32_16x16x32_bf16 a[124:127], a[28:31], a[204:207], a[124:127]
    s_waitcnt vmcnt(9) lgkmcnt(0)
    s_barrier
    v_mfma_f32_16x16x32_bf16 v[192:195], a[32:35], a[208:211], v[192:195]
    ds_read_b64_tr_b16 a[0:1], v42 offset:49152
    ds_read_b64_tr_b16 a[2:3], v42 offset:50176
    v_mfma_f32_16x16x32_bf16 v[196:199], a[32:35], a[212:215], v[196:199]
    s_add_u32 m0, s60, 98304
    v_mfma_f32_16x16x32_bf16 a[64:67], a[32:35], a[216:219], a[64:67]
    buffer_load_dwordx4 v38, s[12:15], s61 offen offset:0 lds
    ds_read_b64_tr_b16 a[4:5], v43 offset:49152
    v_mfma_f32_16x16x32_bf16 a[68:71], a[32:35], a[220:223], a[68:71]
    ds_read_b64_tr_b16 a[6:7], v43 offset:50176
    v_mfma_f32_16x16x32_bf16 v[200:203], a[36:39], a[208:211], v[200:203]
    buffer_load_dwordx4 v39, s[12:15], s61 offen offset:1024 lds
    ds_read_b64_tr_b16 a[8:9], v44 offset:49152
    v_mfma_f32_16x16x32_bf16 v[204:207], a[36:39], a[212:215], v[204:207]
    v_mfma_f32_16x16x32_bf16 a[72:75], a[36:39], a[216:219], a[72:75]
    ds_read_b64_tr_b16 a[10:11], v44 offset:50176
    v_mfma_f32_16x16x32_bf16 a[76:79], a[36:39], a[220:223], a[76:79]
    buffer_load_dwordx4 v40, s[12:15], s61 offen offset:2048 lds
    ds_read_b64_tr_b16 a[12:13], v45 offset:49152
    v_mfma_f32_16x16x32_bf16 v[208:211], a[40:43], a[208:211], v[208:211]
    v_mfma_f32_16x16x32_bf16 v[212:215], a[40:43], a[212:215], v[212:215]
    ds_read_b64_tr_b16 a[14:15], v45 offset:50176
    v_mfma_f32_16x16x32_bf16 a[80:83], a[40:43], a[216:219], a[80:83]
    buffer_load_dwordx4 v41, s[12:15], s61 offen offset:3072 lds
    ds_read_b64_tr_b16 a[16:17], v46 offset:49152
    v_mfma_f32_16x16x32_bf16 a[84:87], a[40:43], a[220:223], a[84:87]
    ds_read_b64_tr_b16 a[18:19], v46 offset:50176
    v_mfma_f32_16x16x32_bf16 v[216:219], a[44:47], a[208:211], v[216:219]
    s_add_u32 s61, s61, 0x80000
    v_mfma_f32_16x16x32_bf16 v[220:223], a[44:47], a[212:215], v[220:223]
    buffer_load_dwordx4 a[128:131], v36, s[8:11], s62 offen sc1
    ds_read_b64_tr_b16 a[20:21], v47 offset:49152
    v_mfma_f32_16x16x32_bf16 a[88:91], a[44:47], a[216:219], a[88:91]
    ds_read_b64_tr_b16 a[22:23], v47 offset:50176
    v_mfma_f32_16x16x32_bf16 a[92:95], a[44:47], a[220:223], a[92:95]
    buffer_load_dwordx4 a[132:135], v54, s[8:11], s62 offen sc1
    ds_read_b64_tr_b16 a[24:25], v48 offset:49152
    v_mfma_f32_16x16x32_bf16 v[224:227], a[48:51], a[208:211], v[224:227]
    v_mfma_f32_16x16x32_bf16 v[228:231], a[48:51], a[212:215], v[228:231]
    ds_read_b64_tr_b16 a[26:27], v48 offset:50176
    v_mfma_f32_16x16x32_bf16 a[96:99], a[48:51], a[216:219], a[96:99]
    buffer_load_dwordx4 a[136:139], v37, s[8:11], s62 offen sc1
    ds_read_b64_tr_b16 a[28:29], v49 offset:49152
    v_mfma_f32_16x16x32_bf16 a[100:103], a[48:51], a[220:223], a[100:103]
    v_mfma_f32_16x16x32_bf16 v[232:235], a[52:55], a[208:211], v[232:235]
    ds_read_b64_tr_b16 a[30:31], v49 offset:50176
    v_mfma_f32_16x16x32_bf16 v[236:239], a[52:55], a[212:215], v[236:239]
    buffer_load_dwordx4 a[140:143], v55, s[8:11], s62 offen sc1
    v_mfma_f32_16x16x32_bf16 a[104:107], a[52:55], a[216:219], a[104:107]
    v_mfma_f32_16x16x32_bf16 a[108:111], a[52:55], a[220:223], a[108:111]
    s_add_u32 s62, s62, 0x20000
    v_mfma_f32_16x16x32_bf16 v[240:243], a[56:59], a[208:211], v[240:243]
    s_add_u32 s52, s47, 536576
    v_mfma_f32_16x16x32_bf16 v[244:247], a[56:59], a[212:215], v[244:247]
    buffer_store_dwordx4 v[176:179], v1, s[48:51], s52 offen offset:0 sc1
    v_mfma_f32_16x16x32_bf16 a[112:115], a[56:59], a[216:219], a[112:115]
    v_mfma_f32_16x16x32_bf16 a[116:119], a[56:59], a[220:223], a[116:119]
    v_mfma_f32_16x16x32_bf16 v[248:251], a[60:63], a[208:211], v[248:251]
    v_mfma_f32_16x16x32_bf16 v[252:255], a[60:63], a[212:215], v[252:255]
    v_mfma_f32_16x16x32_bf16 a[120:123], a[60:63], a[216:219], a[120:123]
    v_mfma_f32_16x16x32_bf16 a[124:127], a[60:63], a[220:223], a[124:127]
    s_waitcnt vmcnt(14) lgkmcnt(0)
    v_mfma_f32_16x16x32_bf16 v[192:195], a[0:3], a[224:227], v[192:195]
    ds_read_b64_tr_b16 a[32:33], v42 offset:57344
    ds_read_b64_tr_b16 a[34:35], v42 offset:58368
    v_mfma_f32_16x16x32_bf16 v[196:199], a[0:3], a[228:231], v[196:199]
    buffer_load_dwordx4 a[144:147], v36, s[8:11], s62 offen sc1
    v_mfma_f32_16x16x32_bf16 a[64:67], a[0:3], a[232:235], a[64:67]
    ds_read_b64_tr_b16 a[36:37], v43 offset:57344
    v_mfma_f32_16x16x32_bf16 a[68:71], a[0:3], a[236:239], a[68:71]
    ds_read_b64_tr_b16 a[38:39], v43 offset:58368
    v_mfma_f32_16x16x32_bf16 v[200:203], a[4:7], a[224:227], v[200:203]
    ds_read_b64_tr_b16 a[40:41], v44 offset:57344
    v_mfma_f32_16x16x32_bf16 v[204:207], a[4:7], a[228:231], v[204:207]
    v_mfma_f32_16x16x32_bf16 a[72:75], a[4:7], a[232:235], a[72:75]
    buffer_load_dwordx4 a[148:151], v54, s[8:11], s62 offen sc1
    ds_read_b64_tr_b16 a[42:43], v44 offset:58368
    v_mfma_f32_16x16x32_bf16 a[76:79], a[4:7], a[236:239], a[76:79]
    ds_read_b64_tr_b16 a[44:45], v45 offset:57344
    v_mfma_f32_16x16x32_bf16 v[208:211], a[8:11], a[224:227], v[208:211]
    v_mfma_f32_16x16x32_bf16 v[212:215], a[8:11], a[228:231], v[212:215]
    ds_read_b64_tr_b16 a[46:47], v45 offset:58368
    v_mfma_f32_16x16x32_bf16 a[80:83], a[8:11], a[232:235], a[80:83]
    ds_read_b64_tr_b16 a[48:49], v46 offset:57344
    v_mfma_f32_16x16x32_bf16 a[84:87], a[8:11], a[236:239], a[84:87]
    buffer_load_dwordx4 a[152:155], v37, s[8:11], s62 offen sc1
    ds_read_b64_tr_b16 a[50:51], v46 offset:58368
    v_mfma_f32_16x16x32_bf16 v[216:219], a[12:15], a[224:227], v[216:219]
    v_mfma_f32_16x16x32_bf16 v[220:223], a[12:15], a[228:231], v[220:223]
    ds_read_b64_tr_b16 a[52:53], v47 offset:57344
    v_mfma_f32_16x16x32_bf16 a[88:91], a[12:15], a[232:235], a[88:91]
    ds_read_b64_tr_b16 a[54:55], v47 offset:58368
    v_mfma_f32_16x16x32_bf16 a[92:95], a[12:15], a[236:239], a[92:95]
    ds_read_b64_tr_b16 a[56:57], v48 offset:57344
    v_mfma_f32_16x16x32_bf16 v[224:227], a[16:19], a[224:227], v[224:227]
    v_mfma_f32_16x16x32_bf16 v[228:231], a[16:19], a[228:231], v[228:231]
    buffer_load_dwordx4 a[156:159], v55, s[8:11], s62 offen sc1
    ds_read_b64_tr_b16 a[58:59], v48 offset:58368
    v_mfma_f32_16x16x32_bf16 a[96:99], a[16:19], a[232:235], a[96:99]
    ds_read_b64_tr_b16 a[60:61], v49 offset:57344
    v_mfma_f32_16x16x32_bf16 a[100:103], a[16:19], a[236:239], a[100:103]
    v_mfma_f32_16x16x32_bf16 v[232:235], a[20:23], a[224:227], v[232:235]
    ds_read_b64_tr_b16 a[62:63], v49 offset:58368
    v_mfma_f32_16x16x32_bf16 v[236:239], a[20:23], a[228:231], v[236:239]
    s_add_u32 s62, s62, 0x20000
    v_mfma_f32_16x16x32_bf16 a[104:107], a[20:23], a[232:235], a[104:107]
    s_add_u32 s52, s47, 536576
    v_mfma_f32_16x16x32_bf16 a[108:111], a[20:23], a[236:239], a[108:111]
    buffer_store_dwordx4 v[180:183], v1, s[48:51], s52 offen offset:1024 sc1
    v_mfma_f32_16x16x32_bf16 v[240:243], a[24:27], a[224:227], v[240:243]
    v_mfma_f32_16x16x32_bf16 v[244:247], a[24:27], a[228:231], v[244:247]
    v_mfma_f32_16x16x32_bf16 a[112:115], a[24:27], a[232:235], a[112:115]
    v_mfma_f32_16x16x32_bf16 a[116:119], a[24:27], a[236:239], a[116:119]
    v_mfma_f32_16x16x32_bf16 v[248:251], a[28:31], a[224:227], v[248:251]
    v_mfma_f32_16x16x32_bf16 v[252:255], a[28:31], a[228:231], v[252:255]
    v_mfma_f32_16x16x32_bf16 a[120:123], a[28:31], a[232:235], a[120:123]
    v_mfma_f32_16x16x32_bf16 a[124:127], a[28:31], a[236:239], a[124:127]
    s_waitcnt vmcnt(10) lgkmcnt(0)
    s_barrier
    v_mfma_f32_16x16x32_bf16 v[192:195], a[32:35], a[240:243], v[192:195]
    ds_read_b64_tr_b16 a[0:1], v42 offset:0
    ds_read_b64_tr_b16 a[2:3], v42 offset:1024
    v_mfma_f32_16x16x32_bf16 v[196:199], a[32:35], a[244:247], v[196:199]
    s_cmp_eq_u32 s30, 0
    s_cbranch_scc1 k12_ool_68
k12_oolret_69:
    v_mfma_f32_16x16x32_bf16 a[64:67], a[32:35], a[248:251], a[64:67]
    s_add_u32 m0, s60, 114688
    ds_read_b64_tr_b16 a[4:5], v43 offset:0
    v_mfma_f32_16x16x32_bf16 a[68:71], a[32:35], a[252:255], a[68:71]
    buffer_load_dwordx4 v38, s[12:15], s61 offen offset:0 lds
    ds_read_b64_tr_b16 a[6:7], v43 offset:1024
    v_mfma_f32_16x16x32_bf16 v[200:203], a[36:39], a[240:243], v[200:203]
    buffer_load_dwordx4 v39, s[12:15], s61 offen offset:1024 lds
    ds_read_b64_tr_b16 a[8:9], v44 offset:0
    v_mfma_f32_16x16x32_bf16 v[204:207], a[36:39], a[244:247], v[204:207]
    v_mfma_f32_16x16x32_bf16 a[72:75], a[36:39], a[248:251], a[72:75]
    ds_read_b64_tr_b16 a[10:11], v44 offset:1024
    v_mfma_f32_16x16x32_bf16 a[76:79], a[36:39], a[252:255], a[76:79]
    buffer_load_dwordx4 v40, s[12:15], s61 offen offset:2048 lds
    ds_read_b64_tr_b16 a[12:13], v45 offset:0
    v_mfma_f32_16x16x32_bf16 v[208:211], a[40:43], a[240:243], v[208:211]
    v_mfma_f32_16x16x32_bf16 v[212:215], a[40:43], a[244:247], v[212:215]
    ds_read_b64_tr_b16 a[14:15], v45 offset:1024
    v_mfma_f32_16x16x32_bf16 a[80:83], a[40:43], a[248:251], a[80:83]
    buffer_load_dwordx4 v41, s[12:15], s61 offen offset:3072 lds
    ds_read_b64_tr_b16 a[16:17], v46 offset:0
    v_mfma_f32_16x16x32_bf16 a[84:87], a[40:43], a[252:255], a[84:87]
    ds_read_b64_tr_b16 a[18:19], v46 offset:1024
    v_mfma_f32_16x16x32_bf16 v[216:219], a[44:47], a[240:243], v[216:219]
    s_add_u32 s61, s61, 0x80000
    v_mfma_f32_16x16x32_bf16 v[220:223], a[44:47], a[244:247], v[220:223]
    buffer_load_dwordx4 a[160:163], v36, s[8:11], s62 offen sc1
    ds_read_b64_tr_b16 a[20:21], v47 offset:0
    v_mfma_f32_16x16x32_bf16 a[88:91], a[44:47], a[248:251], a[88:91]
    ds_read_b64_tr_b16 a[22:23], v47 offset:1024
    v_mfma_f32_16x16x32_bf16 a[92:95], a[44:47], a[252:255], a[92:95]
    buffer_load_dwordx4 a[164:167], v54, s[8:11], s62 offen sc1
    ds_read_b64_tr_b16 a[24:25], v48 offset:0
    v_mfma_f32_16x16x32_bf16 v[224:227], a[48:51], a[240:243], v[224:227]
    v_mfma_f32_16x16x32_bf16 v[228:231], a[48:51], a[244:247], v[228:231]
    ds_read_b64_tr_b16 a[26:27], v48 offset:1024
    v_mfma_f32_16x16x32_bf16 a[96:99], a[48:51], a[248:251], a[96:99]
    buffer_load_dwordx4 a[168:171], v37, s[8:11], s62 offen sc1
    ds_read_b64_tr_b16 a[28:29], v49 offset:0
    v_mfma_f32_16x16x32_bf16 a[100:103], a[48:51], a[252:255], a[100:103]
    v_mfma_f32_16x16x32_bf16 v[232:235], a[52:55], a[240:243], v[232:235]
    ds_read_b64_tr_b16 a[30:31], v49 offset:1024
    v_mfma_f32_16x16x32_bf16 v[236:239], a[52:55], a[244:247], v[236:239]
    buffer_load_dwordx4 a[172:175], v55, s[8:11], s62 offen sc1
    v_mfma_f32_16x16x32_bf16 a[104:107], a[52:55], a[248:251], a[104:107]
    v_mfma_f32_16x16x32_bf16 a[108:111], a[52:55], a[252:255], a[108:111]
    s_add_u32 s62, s62, 0x20000
    v_mfma_f32_16x16x32_bf16 v[240:243], a[56:59], a[240:243], v[240:243]
    s_add_u32 s52, s47, 536576
    v_mfma_f32_16x16x32_bf16 v[244:247], a[56:59], a[244:247], v[244:247]
    buffer_store_dwordx4 v[184:187], v1, s[48:51], s52 offen offset:2048 sc1
    v_mfma_f32_16x16x32_bf16 a[112:115], a[56:59], a[248:251], a[112:115]
    v_mfma_f32_16x16x32_bf16 a[116:119], a[56:59], a[252:255], a[116:119]
    v_mfma_f32_16x16x32_bf16 v[248:251], a[60:63], a[240:243], v[248:251]
    v_mfma_f32_16x16x32_bf16 v[252:255], a[60:63], a[244:247], v[252:255]
    v_mfma_f32_16x16x32_bf16 a[120:123], a[60:63], a[248:251], a[120:123]
    v_mfma_f32_16x16x32_bf16 a[124:127], a[60:63], a[252:255], a[124:127]
    s_waitcnt vmcnt(15) lgkmcnt(0)
    v_mfma_f32_16x16x32_bf16 v[192:195], a[0:3], a[128:131], v[192:195]
    ds_read_b64_tr_b16 a[32:33], v42 offset:8192
    ds_read_b64_tr_b16 a[34:35], v42 offset:9216
    v_mfma_f32_16x16x32_bf16 v[196:199], a[0:3], a[132:135], v[196:199]
    buffer_load_dwordx4 a[176:179], v36, s[8:11], s62 offen sc1
    v_mfma_f32_16x16x32_bf16 a[64:67], a[0:3], a[136:139], a[64:67]
    ds_read_b64_tr_b16 a[36:37], v43 offset:8192
    v_mfma_f32_16x16x32_bf16 a[68:71], a[0:3], a[140:143], a[68:71]
    ds_read_b64_tr_b16 a[38:39], v43 offset:9216
    v_mfma_f32_16x16x32_bf16 v[200:203], a[4:7], a[128:131], v[200:203]
    ds_read_b64_tr_b16 a[40:41], v44 offset:8192
    v_mfma_f32_16x16x32_bf16 v[204:207], a[4:7], a[132:135], v[204:207]
    v_mfma_f32_16x16x32_bf16 a[72:75], a[4:7], a[136:139], a[72:75]
    buffer_load_dwordx4 a[180:183], v54, s[8:11], s62 offen sc1
    ds_read_b64_tr_b16 a[42:43], v44 offset:9216
    v_mfma_f32_16x16x32_bf16 a[76:79], a[4:7], a[140:143], a[76:79]
    ds_read_b64_tr_b16 a[44:45], v45 offset:8192
    v_mfma_f32_16x16x32_bf16 v[208:211], a[8:11], a[128:131], v[208:211]
    v_mfma_f32_16x16x32_bf16 v[212:215], a[8:11], a[132:135], v[212:215]
    ds_read_b64_tr_b16 a[46:47], v45 offset:9216
    v_mfma_f32_16x16x32_bf16 a[80:83], a[8:11], a[136:139], a[80:83]
    ds_read_b64_tr_b16 a[48:49], v46 offset:8192
    v_mfma_f32_16x16x32_bf16 a[84:87], a[8:11], a[140:143], a[84:87]
    buffer_load_dwordx4 a[184:187], v37, s[8:11], s62 offen sc1
    ds_read_b64_tr_b16 a[50:51], v46 offset:9216
    v_mfma_f32_16x16x32_bf16 v[216:219], a[12:15], a[128:131], v[216:219]
    v_mfma_f32_16x16x32_bf16 v[220:223], a[12:15], a[132:135], v[220:223]
    ds_read_b64_tr_b16 a[52:53], v47 offset:8192
    v_mfma_f32_16x16x32_bf16 a[88:91], a[12:15], a[136:139], a[88:91]
    ds_read_b64_tr_b16 a[54:55], v47 offset:9216
    v_mfma_f32_16x16x32_bf16 a[92:95], a[12:15], a[140:143], a[92:95]
    ds_read_b64_tr_b16 a[56:57], v48 offset:8192
    v_mfma_f32_16x16x32_bf16 v[224:227], a[16:19], a[128:131], v[224:227]
    v_mfma_f32_16x16x32_bf16 v[228:231], a[16:19], a[132:135], v[228:231]
    buffer_load_dwordx4 a[188:191], v55, s[8:11], s62 offen sc1
    ds_read_b64_tr_b16 a[58:59], v48 offset:9216
    v_mfma_f32_16x16x32_bf16 a[96:99], a[16:19], a[136:139], a[96:99]
    ds_read_b64_tr_b16 a[60:61], v49 offset:8192
    v_mfma_f32_16x16x32_bf16 a[100:103], a[16:19], a[140:143], a[100:103]
    v_mfma_f32_16x16x32_bf16 v[232:235], a[20:23], a[128:131], v[232:235]
    ds_read_b64_tr_b16 a[62:63], v49 offset:9216
    v_mfma_f32_16x16x32_bf16 v[236:239], a[20:23], a[132:135], v[236:239]
    s_add_u32 s62, s62, 0x20000
    v_mfma_f32_16x16x32_bf16 a[104:107], a[20:23], a[136:139], a[104:107]
    s_add_u32 s52, s47, 536576
    v_mfma_f32_16x16x32_bf16 a[108:111], a[20:23], a[140:143], a[108:111]
    buffer_store_dwordx4 v[188:191], v1, s[48:51], s52 offen offset:3072 sc1
    v_mfma_f32_16x16x32_bf16 v[240:243], a[24:27], a[128:131], v[240:243]
    v_mfma_f32_16x16x32_bf16 v[244:247], a[24:27], a[132:135], v[244:247]
    v_mfma_f32_16x16x32_bf16 a[112:115], a[24:27], a[136:139], a[112:115]
    v_mfma_f32_16x16x32_bf16 a[116:119], a[24:27], a[140:143], a[116:119]
    v_mfma_f32_16x16x32_bf16 v[248:251], a[28:31], a[128:131], v[248:251]
    s_cmp_eq_u32 s30, 0
    s_cbranch_scc1 k12_ool_72
k12_oolret_73:
    v_mfma_f32_16x16x32_bf16 v[252:255], a[28:31], a[132:135], v[252:255]
    v_mfma_f32_16x16x32_bf16 a[120:123], a[28:31], a[136:139], a[120:123]
    v_mfma_f32_16x16x32_bf16 a[124:127], a[28:31], a[140:143], a[124:127]
    s_waitcnt vmcnt(10) lgkmcnt(0)
    s_barrier
    v_mfma_f32_16x16x32_bf16 v[192:195], a[32:35], a[144:147], v[192:195]
    ds_read_b64_tr_b16 a[0:1], v42 offset:16384
    ds_read_b64_tr_b16 a[2:3], v42 offset:17408
    v_mfma_f32_16x16x32_bf16 v[196:199], a[32:35], a[148:151], v[196:199]
    s_mov_b32 m0, s34
    v_mfma_f32_16x16x32_bf16 a[64:67], a[32:35], a[152:155], a[64:67]
    buffer_load_dwordx4 v1, s[16:19], s32 offen offset:0 sc1 lds
    ds_read_b64_tr_b16 a[4:5], v43 offset:16384
    v_mfma_f32_16x16x32_bf16 a[68:71], a[32:35], a[156:159], a[68:71]
    ds_read_b64_tr_b16 a[6:7], v43 offset:17408
    v_mfma_f32_16x16x32_bf16 v[200:203], a[36:39], a[144:147], v[200:203]
    buffer_load_dwordx4 v1, s[16:19], s32 offen offset:1024 sc1 lds
    ds_read_b64_tr_b16 a[8:9], v44 offset:16384
    v_mfma_f32_16x16x32_bf16 v[204:207], a[36:39], a[148:151], v[204:207]
    v_mfma_f32_16x16x32_bf16 a[72:75], a[36:39], a[152:155], a[72:75]
    ds_read_b64_tr_b16 a[10:11], v44 offset:17408
    v_mfma_f32_16x16x32_bf16 a[76:79], a[36:39], a[156:159], a[76:79]
    buffer_load_dwordx4 v1, s[16:19], s32 offen offset:2048 sc1 lds
    ds_read_b64_tr_b16 a[12:13], v45 offset:16384
    v_mfma_f32_16x16x32_bf16 v[208:211], a[40:43], a[144:147], v[208:211]
    v_mfma_f32_16x16x32_bf16 v[212:215], a[40:43], a[148:151], v[212:215]
    ds_read_b64_tr_b16 a[14:15], v45 offset:17408
    v_mfma_f32_16x16x32_bf16 a[80:83], a[40:43], a[152:155], a[80:83]
    ds_read_b64_tr_b16 a[16:17], v46 offset:16384
    v_mfma_f32_16x16x32_bf16 a[84:87], a[40:43], a[156:159], a[84:87]
    buffer_load_dwordx4 v1, s[16:19], s32 offen offset:3072 sc1 lds
    ds_read_b64_tr_b16 a[18:19], v46 offset:17408
    v_mfma_f32_16x16x32_bf16 v[216:219], a[44:47], a[144:147], v[216:219]
    v_mfma_f32_16x16x32_bf16 v[220:223], a[44:47], a[148:151], v[220:223]
    s_add_u32 s32, s32, 0x80000
    ds_read_b64_tr_b16 a[20:21], v47 offset:16384
    v_mfma_f32_16x16x32_bf16 a[88:91], a[44:47], a[152:155], a[88:91]
    s_add_u32 s34, s34, 0x4000
    ds_read_b64_tr_b16 a[22:23], v47 offset:17408
    s_mov_b32 m0, s34
    v_mfma_f32_16x16x32_bf16 a[92:95], a[44:47], a[156:159], a[92:95]
    buffer_load_dwordx4 v1, s[16:19], s32 offen offset:0 sc1 lds
    ds_read_b64_tr_b16 a[24:25], v48 offset:16384
    v_mfma_f32_16x16x32_bf16 v[224:227], a[48:51], a[144:147], v[224:227]
    v_mfma_f32_16x16x32_bf16 v[228:231], a[48:51], a[148:151], v[228:231]
    buffer_load_dwordx4 v1, s[16:19], s32 offen offset:1024 sc1 lds
    ds_read_b64_tr_b16 a[26:27], v48 offset:17408
    v_mfma_f32_16x16x32_bf16 a[96:99], a[48:51], a[152:155], a[96:99]
    ds_read_b64_tr_b16 a[28:29], v49 offset:16384
    v_mfma_f32_16x16x32_bf16 a[100:103], a[48:51], a[156:159], a[100:103]
    v_mfma_f32_16x16x32_bf16 v[232:235], a[52:55], a[144:147], v[232:235]
    buffer_load_dwordx4 v1, s[16:19], s32 offen offset:2048 sc1 lds
    ds_read_b64_tr_b16 a[30:31], v49 offset:17408
    v_mfma_f32_16x16x32_bf16 v[236:239], a[52:55], a[148:151], v[236:239]
    v_mfma_f32_16x16x32_bf16 a[104:107], a[52:55], a[152:155], a[104:107]
    v_mfma_f32_16x16x32_bf16 a[108:111], a[52:55], a[156:159], a[108:111]
    v_mfma_f32_16x16x32_bf16 v[240:243], a[56:59], a[144:147], v[240:243]
    buffer_load_dwordx4 v1, s[16:19], s32 offen offset:3072 sc1 lds
    v_mfma_f32_16x16x32_bf16 v[244:247], a[56:59], a[148:151], v[244:247]
    v_mfma_f32_16x16x32_bf16 a[112:115], a[56:59], a[152:155], a[112:115]
    s_add_u32 s32, s32, 0x80000
    v_mfma_f32_16x16x32_bf16 a[116:119], a[56:59], a[156:159], a[116:119]
    s_add_u32 s34, s34, 0x4000
    v_mfma_f32_16x16x32_bf16 v[248:251], a[60:63], a[144:147], v[248:251]
    v_mfma_f32_16x16x32_bf16 v[252:255], a[60:63], a[148:151], v[252:255]
    v_mfma_f32_16x16x32_bf16 a[120:123], a[60:63], a[152:155], a[120:123]
    v_mfma_f32_16x16x32_bf16 a[124:127], a[60:63], a[156:159], a[124:127]
    s_waitcnt vmcnt(14) lgkmcnt(0)
    v_mfma_f32_16x16x32_bf16 v[192:195], a[0:3], a[160:163], v[192:195]
    ds_read_b64_tr_b16 a[32:33], v42 offset:24576
    ds_read_b64_tr_b16 a[34:35], v42 offset:25600
    v_mfma_f32_16x16x32_bf16 v[196:199], a[0:3], a[164:167], v[196:199]
    s_mov_b32 m0, s35
    v_mfma_f32_16x16x32_bf16 a[64:67], a[0:3], a[168:171], a[64:67]
    buffer_load_dwordx4 v1, s[20:23], s33 offen offset:0 sc1 lds
    ds_read_b64_tr_b16 a[36:37], v43 offset:24576
    v_mfma_f32_16x16x32_bf16 a[68:71], a[0:3], a[172:175], a[68:71]
    ds_read_b64_tr_b16 a[38:39], v43 offset:25600
    v_mfma_f32_16x16x32_bf16 v[200:203], a[4:7], a[160:163], v[200:203]
    buffer_load_dwordx4 v1, s[20:23], s33 offen offset:1024 sc1 lds
    ds_read_b64_tr_b16 a[40:41], v44 offset:24576
    v_mfma_f32_16x16x32_bf16 v[204:207], a[4:7], a[164:167], v[204:207]
    v_mfma_f32_16x16x32_bf16 a[72:75], a[4:7], a[168:171], a[72:75]
    ds_read_b64_tr_b16 a[42:43], v44 offset:25600
    v_mfma_f32_16x16x32_bf16 a[76:79], a[4:7], a[172:175], a[76:79]
    buffer_load_dwordx4 v1, s[20:23], s33 offen offset:2048 sc1 lds
    ds_read_b64_tr_b16 a[44:45], v45 offset:24576
    v_mfma_f32_16x16x32_bf16 v[208:211], a[8:11], a[160:163], v[208:211]
    v_mfma_f32_16x16x32_bf16 v[212:215], a[8:11], a[164:167], v[212:215]
    ds_read_b64_tr_b16 a[46:47], v45 offset:25600
    v_mfma_f32_16x16x32_bf16 a[80:83], a[8:11], a[168:171], a[80:83]
    ds_read_b64_tr_b16 a[48:49], v46 offset:24576
    v_mfma_f32_16x16x32_bf16 a[84:87], a[8:11], a[172:175], a[84:87]
    buffer_load_dwordx4 v1, s[20:23], s33 offen offset:3072 sc1 lds
    ds_read_b64_tr_b16 a[50:51], v46 offset:25600
    v_mfma_f32_16x16x32_bf16 v[216:219], a[12:15], a[160:163], v[216:219]
    v_mfma_f32_16x16x32_bf16 v[220:223], a[12:15], a[164:167], v[220:223]
    s_add_u32 s33, s33, 0x80000
    ds_read_b64_tr_b16 a[52:53], v47 offset:24576
    v_mfma_f32_16x16x32_bf16 a[88:91], a[12:15], a[168:171], a[88:91]
    s_add_u32 s35, s35, 0x4000
    ds_read_b64_tr_b16 a[54:55], v47 offset:25600
    s_mov_b32 m0, s34
    v_mfma_f32_16x16x32_bf16 a[92:95], a[12:15], a[172:175], a[92:95]
    buffer_load_dwordx4 v1, s[16:19], s32 offen offset:0 sc1 lds
    ds_read_b64_tr_b16 a[56:57], v48 offset:24576
    v_mfma_f32_16x16x32_bf16 v[224:227], a[16:19], a[160:163], v[224:227]
    v_mfma_f32_16x16x32_bf16 v[228:231], a[16:19], a[164:167], v[228:231]
    buffer_load_dwordx4 v1, s[16:19], s32 offen offset:1024 sc1 lds
    ds_read_b64_tr_b16 a[58:59], v48 offset:25600
    v_mfma_f32_16x16x32_bf16 a[96:99], a[16:19], a[168:171], a[96:99]
    ds_read_b64_tr_b16 a[60:61], v49 offset:24576
    v_mfma_f32_16x16x32_bf16 a[100:103], a[16:19], a[172:175], a[100:103]
    v_mfma_f32_16x16x32_bf16 v[232:235], a[20:23], a[160:163], v[232:235]
    buffer_load_dwordx4 v1, s[16:19], s32 offen offset:2048 sc1 lds
    ds_read_b64_tr_b16 a[62:63], v49 offset:25600
    v_mfma_f32_16x16x32_bf16 v[236:239], a[20:23], a[164:167], v[236:239]
    v_mfma_f32_16x16x32_bf16 a[104:107], a[20:23], a[168:171], a[104:107]
    v_mfma_f32_16x16x32_bf16 a[108:111], a[20:23], a[172:175], a[108:111]
    v_mfma_f32_16x16x32_bf16 v[240:243], a[24:27], a[160:163], v[240:243]
    buffer_load_dwordx4 v1, s[16:19], s32 offen offset:3072 sc1 lds
    v_mfma_f32_16x16x32_bf16 v[244:247], a[24:27], a[164:167], v[244:247]
    v_mfma_f32_16x16x32_bf16 a[112:115], a[24:27], a[168:171], a[112:115]
    s_add_u32 s32, s32, 0x80000
    v_mfma_f32_16x16x32_bf16 a[116:119], a[24:27], a[172:175], a[116:119]
    s_add_u32 s34, s34, 0x4000
    v_mfma_f32_16x16x32_bf16 v[248:251], a[28:31], a[160:163], v[248:251]
    v_mfma_f32_16x16x32_bf16 v[252:255], a[28:31], a[164:167], v[252:255]
    v_mfma_f32_16x16x32_bf16 a[120:123], a[28:31], a[168:171], a[120:123]
    v_mfma_f32_16x16x32_bf16 a[124:127], a[28:31], a[172:175], a[124:127]
    s_waitcnt vmcnt(17) lgkmcnt(0)
    s_barrier
    v_mfma_f32_16x16x32_bf16 v[192:195], a[32:35], a[176:179], v[192:195]
    v_mfma_f32_16x16x32_bf16 v[196:199], a[32:35], a[180:183], v[196:199]
    s_mov_b32 m0, s35
    v_mfma_f32_16x16x32_bf16 a[64:67], a[32:35], a[184:187], a[64:67]
    buffer_load_dwordx4 v1, s[20:23], s33 offen offset:0 sc1 lds
    v_mfma_f32_16x16x32_bf16 a[68:71], a[32:35], a[188:191], a[68:71]
    v_mfma_f32_16x16x32_bf16 v[200:203], a[36:39], a[176:179], v[200:203]
    v_mfma_f32_16x16x32_bf16 v[204:207], a[36:39], a[180:183], v[204:207]
    v_mfma_f32_16x16x32_bf16 a[72:75], a[36:39], a[184:187], a[72:75]
    v_mfma_f32_16x16x32_bf16 a[76:79], a[36:39], a[188:191], a[76:79]
    buffer_load_dwordx4 v1, s[20:23], s33 offen offset:1024 sc1 lds
    v_mfma_f32_16x16x32_bf16 v[208:211], a[40:43], a[176:179], v[208:211]
    v_mfma_f32_16x16x32_bf16 v[212:215], a[40:43], a[180:183], v[212:215]
    v_mfma_f32_16x16x32_bf16 a[80:83], a[40:43], a[184:187], a[80:83]
    v_mfma_f32_16x16x32_bf16 a[84:87], a[40:43], a[188:191], a[84:87]
    v_mfma_f32_16x16x32_bf16 v[216:219], a[44:47], a[176:179], v[216:219]
    v_mfma_f32_16x16x32_bf16 v[220:223], a[44:47], a[180:183], v[220:223]
    v_mfma_f32_16x16x32_bf16 a[88:91], a[44:47], a[184:187], a[88:91]
    buffer_load_dwordx4 v1, s[20:23], s33 offen offset:2048 sc1 lds
    v_mfma_f32_16x16x32_bf16 a[92:95], a[44:47], a[188:191], a[92:95]
    v_mfma_f32_16x16x32_bf16 v[224:227], a[48:51], a[176:179], v[224:227]
    v_mfma_f32_16x16x32_bf16 v[228:231], a[48:51], a[180:183], v[228:231]
    v_mfma_f32_16x16x32_bf16 a[96:99], a[48:51], a[184:187], a[96:99]
    v_mfma_f32_16x16x32_bf16 a[100:103], a[48:51], a[188:191], a[100:103]
    v_mfma_f32_16x16x32_bf16 v[232:235], a[52:55], a[176:179], v[232:235]
    buffer_load_dwordx4 v1, s[20:23], s33 offen offset:3072 sc1 lds
    v_mfma_f32_16x16x32_bf16 v[236:239], a[52:55], a[180:183], v[236:239]
    v_mfma_f32_16x16x32_bf16 a[104:107], a[52:55], a[184:187], a[104:107]
    v_mfma_f32_16x16x32_bf16 a[108:111], a[52:55], a[188:191], a[108:111]
    v_mfma_f32_16x16x32_bf16 v[240:243], a[56:59], a[176:179], v[240:243]
    v_mfma_f32_16x16x32_bf16 v[244:247], a[56:59], a[180:183], v[244:247]
    v_mfma_f32_16x16x32_bf16 a[112:115], a[56:59], a[184:187], a[112:115]
    s_add_u32 s33, s33, 0x80000
    v_mfma_f32_16x16x32_bf16 a[116:119], a[56:59], a[188:191], a[116:119]
    s_add_u32 s35, s35, 0x4000
    v_mfma_f32_16x16x32_bf16 v[248:251], a[60:63], a[176:179], v[248:251]
    v_mfma_f32_16x16x32_bf16 v[252:255], a[60:63], a[180:183], v[252:255]
    v_mfma_f32_16x16x32_bf16 a[120:123], a[60:63], a[184:187], a[120:123]
    v_mfma_f32_16x16x32_bf16 a[124:127], a[60:63], a[188:191], a[124:127]
    s_add_u32 s3, s54, 64
    s_add_u32 s5, s55, 64
    s_mov_b32 s63, s57
    s_load_dwordx2 s[44:45], s[0:1], 40
    s_load_dwordx2 s[46:47], s[0:1], 64
    s_load_dwordx4 s[48:51], s[0:1], 72
    s_mov_b32 s40, 0x3e0293ee
    s_mov_b32 s41, 0x3e0293ee
    s_mov_b32 m0, s34
    s_nop 0
    buffer_load_dwordx4 v1, s[16:19], s32 offen offset:0 sc1 lds
    buffer_load_dwordx4 v1, s[16:19], s32 offen offset:1024 sc1 lds
    buffer_load_dwordx4 v1, s[16:19], s32 offen offset:2048 sc1 lds
    buffer_load_dwordx4 v1, s[16:19], s32 offen offset:3072 sc1 lds
    s_mov_b32 m0, s35
    s_nop 0
    buffer_load_dwordx4 v1, s[20:23], s33 offen offset:0 sc1 lds
    buffer_load_dwordx4 v1, s[20:23], s33 offen offset:1024 sc1 lds
    buffer_load_dwordx4 v1, s[20:23], s33 offen offset:2048 sc1 lds
    buffer_load_dwordx4 v1, s[20:23], s33 offen offset:3072 sc1 lds
    s_add_u32 s32, s32, 0x80000
    s_add_u32 s33, s33, 0x80000
    s_add_u32 s34, s34, 0x4000
    s_and_b32 s34, s34, 0xffff
    s_add_u32 s35, s35, 0x4000
    s_and_b32 s35, s35, 0xffff
    s_or_b32 s35, s35, 0x10000
    v_mov_b32 v2, v1
    v_or_b32 v3, 0x10000, v1
    v_mov_b32 v56, v3
    s_mov_b32 s52, 0x4000
    s_mov_b32 s53, 0
    s_lshl_b32 s62, s28, 6
    s_mul_i32 s31, s29, s29
    s_add_u32 s62, s62, s31
    s_lshr_b32 s31, s30, 1
    s_lshl_b32 s4, s31, 23
    s_add_u32 s4, s4, 0x6000000
    s_add_u32 s8, s6, s4
    s_addc_u32 s9, s7, 0
    s_and_b32 s9, s9, 0xffff
    s_mov_b32 s10, 0
    s_mov_b32 s58, 0
    s_mov_b32 s14, 0x700000
    s_mov_b32 s59, 0x700000
    s_lshl_b32 s54, s62, 12
    s_waitcnt vmcnt(16) lgkmcnt(0)
    s_barrier
    s_cmp_eq_u32 s63, 0
    s_cbranch_scc1 k12_ool_74
k12_oolret_75:
    v_mov_b32 v59, 0
    ds_read_b128 a[128:131], v2 offset:0
    ds_read_b128 a[132:135], v2 offset:1024
    ds_read_b128 a[136:139], v2 offset:2048
    ds_read_b128 a[140:143], v2 offset:3072
    ds_read_b128 a[144:147], v2 offset:4096
    ds_read_b128 a[148:151], v2 offset:5120
    ds_read_b128 a[152:155], v2 offset:6144
    ds_read_b128 a[156:159], v2 offset:7168
    ds_read_b128 a[160:163], v2 offset:8192
    ds_read_b128 a[164:167], v2 offset:9216
    ds_read_b128 a[168:171], v2 offset:10240
    ds_read_b128 a[172:175], v2 offset:11264
    ds_read_b128 a[176:179], v2 offset:12288
    ds_read_b128 a[180:183], v2 offset:13312
    ds_read_b128 a[184:187], v2 offset:14336
    ds_read_b128 a[188:191], v2 offset:15360
    s_cmp_lt_u32 s30, 2
    s_cselect_b64 s[12:13], s[46:47], s[48:49]
    s_cselect_b64 s[60:61], s[44:45], s[50:51]
    s_cselect_b32 s55, 0x800000, s14
    s_and_b32 s13, s13, 0xffff
    v_accvgpr_read_b32 v128, a64
    v_accvgpr_read_b32 v129, a65
    v_accvgpr_read_b32 v130, a66
    v_accvgpr_read_b32 v131, a67
    v_pk_mul_f32 v[128:129], v[128:129], s[40:41]
    v_pk_mul_f32 v[130:131], v[130:131], s[40:41]
    v_cvt_pk_bf16_f32 v96, v128, v129
    v_cvt_pk_bf16_f32 v97, v130, v131
    v_accvgpr_read_b32 v132, a72
    v_accvgpr_read_b32 v133, a73
    v_accvgpr_read_b32 v134, a74
    v_accvgpr_read_b32 v135, a75
    v_pk_mul_f32 v[132:133], v[132:133], s[40:41]
    v_pk_mul_f32 v[134:135], v[134:135], s[40:41]
    v_cvt_pk_bf16_f32 v98, v132, v133
    v_cvt_pk_bf16_f32 v99, v134, v135
    v_accvgpr_read_b32 v136, a80
    v_accvgpr_read_b32 v137, a81
    v_accvgpr_read_b32 v138, a82
    v_accvgpr_read_b32 v139, a83
    v_pk_mul_f32 v[136:137], v[136:137], s[40:41]
    v_pk_mul_f32 v[138:139], v[138:139], s[40:41]
    v_cvt_pk_bf16_f32 v100, v136, v137
    v_cvt_pk_bf16_f32 v101, v138, v139
    v_accvgpr_read_b32 v140, a88
    v_accvgpr_read_b32 v141, a89
    v_accvgpr_read_b32 v142, a90
    v_accvgpr_read_b32 v143, a91
    v_pk_mul_f32 v[140:141], v[140:141], s[40:41]
    v_pk_mul_f32 v[142:143], v[142:143], s[40:41]
    v_cvt_pk_bf16_f32 v102, v140, v141
    v_cvt_pk_bf16_f32 v103, v142, v143
    v_accvgpr_read_b32 v128, a96
    v_accvgpr_read_b32 v129, a97
    v_accvgpr_read_b32 v130, a98
    v_accvgpr_read_b32 v131, a99
    v_pk_mul_f32 v[128:129], v[128:129], s[40:41]
    v_pk_mul_f32 v[130:131], v[130:131], s[40:41]
    v_cvt_pk_bf16_f32 v104, v128, v129
    v_cvt_pk_bf16_f32 v105, v130, v131
    v_accvgpr_read_b32 v132, a104
    v_accvgpr_read_b32 v133, a105
    v_accvgpr_read_b32 v134, a106
    v_accvgpr_read_b32 v135, a107
    v_pk_mul_f32 v[132:133], v[132:133], s[40:41]
    v_pk_mul_f32 v[134:135], v[134:135], s[40:41]
    v_cvt_pk_bf16_f32 v106, v132, v133
    v_cvt_pk_bf16_f32 v107, v134, v135
    v_accvgpr_read_b32 v136, a112
    v_accvgpr_read_b32 v137, a113
    v_accvgpr_read_b32 v138, a114
    v_accvgpr_read_b32 v139, a115
    v_pk_mul_f32 v[136:137], v[136:137], s[40:41]
    v_pk_mul_f32 v[138:139], v[138:139], s[40:41]
    v_cvt_pk_bf16_f32 v108, v136, v137
    v_cvt_pk_bf16_f32 v109, v138, v139
    v_accvgpr_read_b32 v140, a120
    v_accvgpr_read_b32 v141, a121
    v_accvgpr_read_b32 v142, a122
    v_accvgpr_read_b32 v143, a123
    v_pk_mul_f32 v[140:141], v[140:141], s[40:41]
    v_pk_mul_f32 v[142:143], v[142:143], s[40:41]
    v_cvt_pk_bf16_f32 v110, v140, v141
    v_cvt_pk_bf16_f32 v111, v142, v143
    v_accvgpr_read_b32 v128, a68
    v_accvgpr_read_b32 v129, a69
    v_accvgpr_read_b32 v130, a70
    v_accvgpr_read_b32 v131, a71
    v_pk_mul_f32 v[128:129], v[128:129], s[40:41]
    v_pk_mul_f32 v[130:131], v[130:131], s[40:41]
    v_cvt_pk_bf16_f32 v112, v128, v129
    v_cvt_pk_bf16_f32 v113, v130, v131
    v_accvgpr_read_b32 v132, a76
    v_accvgpr_read_b32 v133, a77
    v_accvgpr_read_b32 v134, a78
    v_accvgpr_read_b32 v135, a79
    v_pk_mul_f32 v[132:133], v[132:133], s[40:41]
    v_pk_mul_f32 v[134:135], v[134:135], s[40:41]
    v_cvt_pk_bf16_f32 v114, v132, v133
    v_cvt_pk_bf16_f32 v115, v134, v135
    v_accvgpr_read_b32 v136, a84
    v_accvgpr_read_b32 v137, a85
    v_accvgpr_read_b32 v138, a86
    v_accvgpr_read_b32 v139, a87
    v_pk_mul_f32 v[136:137], v[136:137], s[40:41]
    v_pk_mul_f32 v[138:139], v[138:139], s[40:41]
    v_cvt_pk_bf16_f32 v116, v136, v137
    v_cvt_pk_bf16_f32 v117, v138, v139
    v_accvgpr_read_b32 v140, a92
    v_accvgpr_read_b32 v141, a93
    v_accvgpr_read_b32 v142, a94
    v_accvgpr_read_b32 v143, a95
    v_pk_mul_f32 v[140:141], v[140:141], s[40:41]
    v_pk_mul_f32 v[142:143], v[142:143], s[40:41]
    v_cvt_pk_bf16_f32 v118, v140, v141
    v_cvt_pk_bf16_f32 v119, v142, v143
    v_accvgpr_read_b32 v128, a100
    v_accvgpr_read_b32 v129, a101
    v_accvgpr_read_b32 v130, a102
    v_accvgpr_read_b32 v131, a103
    v_pk_mul_f32 v[128:129], v[128:129], s[40:41]
    v_pk_mul_f32 v[130:131], v[130:131], s[40:41]
    v_cvt_pk_bf16_f32 v120, v128, v129
    v_cvt_pk_bf16_f32 v121, v130, v131
    v_accvgpr_read_b32 v132, a108
    v_accvgpr_read_b32 v133, a109
    v_accvgpr_read_b32 v134, a110
    v_accvgpr_read_b32 v135, a111
    v_pk_mul_f32 v[132:133], v[132:133], s[40:41]
    v_pk_mul_f32 v[134:135], v[134:135], s[40:41]
    v_cvt_pk_bf16_f32 v122, v132, v133
    v_cvt_pk_bf16_f32 v123, v134, v135
    v_accvgpr_read_b32 v136, a116
    v_accvgpr_read_b32 v137, a117
    v_accvgpr_read_b32 v138, a118
    v_accvgpr_read_b32 v139, a119
    v_pk_mul_f32 v[136:137], v[136:137], s[40:41]
    v_pk_mul_f32 v[138:139], v[138:139], s[40:41]
    v_cvt_pk_bf16_f32 v124, v136, v137
    v_cvt_pk_bf16_f32 v125, v138, v139
    v_accvgpr_read_b32 v140, a124
    v_accvgpr_read_b32 v141, a125
    v_accvgpr_read_b32 v142, a126
    v_accvgpr_read_b32 v143, a127
    v_pk_mul_f32 v[140:141], v[140:141], s[40:41]
    v_pk_mul_f32 v[142:143], v[142:143], s[40:41]
    v_cvt_pk_bf16_f32 v126, v140, v141
    v_cvt_pk_bf16_f32 v127, v142, v143
    v_pk_mul_f32 v[192:193], v[192:193], s[40:41]
    v_pk_mul_f32 v[194:195], v[194:195], s[40:41]
    v_cvt_pk_bf16_f32 v64, v192, v193
    v_cvt_pk_bf16_f32 v65, v194, v195
    v_pk_mul_f32 v[200:201], v[200:201], s[40:41]
    v_pk_mul_f32 v[202:203], v[202:203], s[40:41]
    v_cvt_pk_bf16_f32 v66, v200, v201
    v_cvt_pk_bf16_f32 v67, v202, v203
    v_pk_mul_f32 v[208:209], v[208:209], s[40:41]
    v_pk_mul_f32 v[210:211], v[210:211], s[40:41]
    v_cvt_pk_bf16_f32 v68, v208, v209
    v_cvt_pk_bf16_f32 v69, v210, v211
    v_pk_mul_f32 v[216:217], v[216:217], s[40:41]
    v_pk_mul_f32 v[218:219], v[218:219], s[40:41]
    v_cvt_pk_bf16_f32 v70, v216, v217
    v_cvt_pk_bf16_f32 v71, v218, v219
    v_pk_mul_f32 v[224:225], v[224:225], s[40:41]
    v_pk_mul_f32 v[226:227], v[226:227], s[40:41]
    v_cvt_pk_bf16_f32 v72, v224, v225
    v_cvt_pk_bf16_f32 v73, v226, v227
    v_pk_mul_f32 v[232:233], v[232:233], s[40:41]
    v_pk_mul_f32 v[234:235], v[234:235], s[40:41]
    v_cvt_pk_bf16_f32 v74, v232, v233
    v_cvt_pk_bf16_f32 v75, v234, v235
    v_pk_mul_f32 v[240:241], v[240:241], s[40:41]
    v_pk_mul_f32 v[242:243], v[242:243], s[40:41]
    v_cvt_pk_bf16_f32 v76, v240, v241
    v_cvt_pk_bf16_f32 v77, v242, v243
    v_pk_mul_f32 v[248:249], v[248:249], s[40:41]
    v_pk_mul_f32 v[250:251], v[250:251], s[40:41]
    v_cvt_pk_bf16_f32 v78, v248, v249
    v_cvt_pk_bf16_f32 v79, v250, v251
    v_pk_mul_f32 v[196:197], v[196:197], s[40:41]
    v_pk_mul_f32 v[198:199], v[198:199], s[40:41]
    v_cvt_pk_bf16_f32 v80, v196, v197
    v_cvt_pk_bf16_f32 v81, v198, v199
    v_pk_mul_f32 v[204:205], v[204:205], s[40:41]
    v_pk_mul_f32 v[206:207], v[206:207], s[40:41]
    v_cvt_pk_bf16_f32 v82, v204, v205
    v_cvt_pk_bf16_f32 v83, v206, v207
    v_pk_mul_f32 v[212:213], v[212:213], s[40:41]
    v_pk_mul_f32 v[214:215], v[214:215], s[40:41]
    v_cvt_pk_bf16_f32 v84, v212, v213
    v_cvt_pk_bf16_f32 v85, v214, v215
    v_pk_mul_f32 v[220:221], v[220:221], s[40:41]
    v_pk_mul_f32 v[222:223], v[222:223], s[40:41]
    v_cvt_pk_bf16_f32 v86, v220, v221
    v_cvt_pk_bf16_f32 v87, v222, v223
    v_pk_mul_f32 v[228:229], v[228:229], s[40:41]
    v_pk_mul_f32 v[230:231], v[230:231], s[40:41]
    v_cvt_pk_bf16_f32 v88, v228, v229
    v_cvt_pk_bf16_f32 v89, v230, v231
    v_pk_mul_f32 v[236:237], v[236:237], s[40:41]
    v_pk_mul_f32 v[238:239], v[238:239], s[40:41]
    v_cvt_pk_bf16_f32 v90, v236, v237
    v_cvt_pk_bf16_f32 v91, v238, v239
    v_pk_mul_f32 v[244:245], v[244:245], s[40:41]
    v_pk_mul_f32 v[246:247], v[246:247], s[40:41]
    v_cvt_pk_bf16_f32 v92, v244, v245
    v_cvt_pk_bf16_f32 v93, v246, v247
    v_pk_mul_f32 v[252:253], v[252:253], s[40:41]
    v_pk_mul_f32 v[254:255], v[254:255], s[40:41]
    v_cvt_pk_bf16_f32 v94, v252, v253
    v_cvt_pk_bf16_f32 v95, v254, v255
    v_add_u32 v2, 0x4000, v1
    v_mov_b32 v8, 0
    v_mov_b32 v232, 0
    v_mov_b32 v9, 0
    v_mov_b32 v233, 0
    v_mov_b32 v10, 0
    v_mov_b32 v234, 0
    v_mov_b32 v11, 0
    v_mov_b32 v235, 0
    s_mov_b32 s36, 0
    s_mov_b32 s37, 0x40004000
    v_mfma_f32_32x32x16_bf16 v[16:31], v[232:235], v[232:235], 0
    v_mfma_f32_32x32x16_bf16 v[32:47], v[232:235], v[232:235], 0
    v_and_b32 v6, 0xf0, v1
    v_cmp_eq_u32 vcc, 0, v6
    v_mov_b32 v6, 0x3f803f80
    v_lshrrev_b32 v229, 7, v1
    s_and_b32 s4, s30, 1
    s_lshl_b32 s31, s4, 11
    v_lshl_add_u32 v230, v1, 1, s31
    v_lshl_add_u32 v229, s4, 4, v229
    v_mul_u32_u24 v228, 7168, v229
    v_and_b32 v7, 0x70, v1
    v_add_u32 v228, v228, v7
    v_lshlrev_b32 v229, 5, v229
    v_and_b32 v57, 0x10, v1
    v_add_u32 v229, v229, v57
    v_lshrrev_b32 v7, 5, v7
    v_lshl_add_u32 v229, v7, 15, v229
    v_cndmask_b32 v60, 0, v6, vcc
    v_cndmask_b32 v61, 0, v6, vcc
    v_cndmask_b32 v62, 0, v6, vcc
    v_cndmask_b32 v63, 0, v6, vcc
    v_mov_b32 v12, 0
    v_mov_b32 v13, 0
    v_mov_b32 v14, 0
    v_mov_b32 v15, 0
    v_mov_b32 v48, 0
    v_mov_b32 v49, 0
    v_mov_b32 v50, 0
    v_mov_b32 v51, 0
    v_mov_b32 v248, 0
    v_mov_b32 v249, 0
    v_mov_b32 v250, 0
    v_mov_b32 v251, 0
    v_mov_b32 v252, 0
    v_mov_b32 v253, 0
    v_mov_b32 v254, 0
    v_mov_b32 v255, 0
    s_waitcnt lgkmcnt(0)
    s_cmp_ge_u32 s36, s42
    s_cbranch_scc1 k2_prep_76
k2_prepret_77:
    v_mfma_f32_16x16x32_bf16 v[128:131], a[128:131], v[64:67], v[16:19]
    v_mfma_f32_16x16x32_bf16 v[128:131], a[132:135], v[68:71], v[128:131]
    v_mfma_f32_16x16x32_bf16 v[128:131], a[136:139], v[72:75], v[128:131]
    v_mfma_f32_16x16x32_bf16 v[128:131], a[140:143], v[76:79], v[128:131]
    s_add_u32 s36, s36, 32
    v_mfma_f32_16x16x32_bf16 v[132:135], a[128:131], v[80:83], v[20:23]
    v_mfma_f32_16x16x32_bf16 v[132:135], a[132:135], v[84:87], v[132:135]
    v_mfma_f32_16x16x32_bf16 v[132:135], a[136:139], v[88:91], v[132:135]
    v_mfma_f32_16x16x32_bf16 v[132:135], a[140:143], v[92:95], v[132:135]
    v_mfma_f32_16x16x32_bf16 v[136:139], a[128:131], v[96:99], v[24:27]
    v_mfma_f32_16x16x32_bf16 v[136:139], a[132:135], v[100:103], v[136:139]
    v_mfma_f32_16x16x32_bf16 v[136:139], a[136:139], v[104:107], v[136:139]
    v_mfma_f32_16x16x32_bf16 v[136:139], a[140:143], v[108:111], v[136:139]
    v_mfma_f32_16x16x32_bf16 v[140:143], a[128:131], v[112:115], v[28:31]
    v_mfma_f32_16x16x32_bf16 v[140:143], a[132:135], v[116:119], v[140:143]
    v_mfma_f32_16x16x32_bf16 v[140:143], a[136:139], v[120:123], v[140:143]
    v_mfma_f32_16x16x32_bf16 v[140:143], a[140:143], v[124:127], v[140:143]
    v_mfma_f32_16x16x32_bf16 v[144:147], a[144:147], v[64:67], v[32:35]
    v_mfma_f32_16x16x32_bf16 v[144:147], a[148:151], v[68:71], v[144:147]
    v_mfma_f32_16x16x32_bf16 v[144:147], a[152:155], v[72:75], v[144:147]
    v_mfma_f32_16x16x32_bf16 v[144:147], a[156:159], v[76:79], v[144:147]
    v_mfma_f32_16x16x32_bf16 v[148:151], a[144:147], v[80:83], v[36:39]
    v_mfma_f32_16x16x32_bf16 v[148:151], a[148:151], v[84:87], v[148:151]
    v_mfma_f32_16x16x32_bf16 v[148:151], a[152:155], v[88:91], v[148:151]
    v_mfma_f32_16x16x32_bf16 v[148:151], a[156:159], v[92:95], v[148:151]
    v_mfma_f32_16x16x32_bf16 v[152:155], a[144:147], v[96:99], v[40:43]
    v_mfma_f32_16x16x32_bf16 v[152:155], a[148:151], v[100:103], v[152:155]
    v_mfma_f32_16x16x32_bf16 v[152:155], a[152:155], v[104:107], v[152:155]
    v_mfma_f32_16x16x32_bf16 v[152:155], a[156:159], v[108:111], v[152:155]
    v_mfma_f32_16x16x32_bf16 v[156:159], a[144:147], v[112:115], v[44:47]
    v_mfma_f32_16x16x32_bf16 v[156:159], a[148:151], v[116:119], v[156:159]
    v_mfma_f32_16x16x32_bf16 v[156:159], a[152:155], v[120:123], v[156:159]
    v_mfma_f32_16x16x32_bf16 v[156:159], a[156:159], v[124:127], v[156:159]
    v_mfma_f32_32x32x16_bf16 a[0:15], v[232:235], v[232:235], 0
    v_mfma_f32_32x32x16_bf16 a[16:31], v[232:235], v[232:235], 0
    v_mfma_f32_32x32x16_bf16 a[32:47], v[232:235], v[232:235], 0
    v_mfma_f32_32x32x16_bf16 a[48:63], v[232:235], v[232:235], 0
    v_mfma_f32_32x32x16_bf16 a[64:79], v[232:235], v[232:235], 0
    v_mfma_f32_32x32x16_bf16 a[80:95], v[232:235], v[232:235], 0
    v_mfma_f32_32x32x16_bf16 a[96:111], v[232:235], v[232:235], 0
    v_mfma_f32_32x32x16_bf16 a[112:127], v[232:235], v[232:235], 0
    v_max_f32 v52, v128, v129
    v_max3_f32 v52, v52, v130, v131
    v_max3_f32 v52, v52, v144, v145
    v_max3_f32 v52, v52, v146, v147
    v_max_f32 v53, v132, v133
    v_max3_f32 v53, v53, v134, v135
    v_max3_f32 v53, v53, v148, v149
    v_max3_f32 v53, v53, v150, v151
    v_max_f32 v54, v136, v137
    v_max3_f32 v54, v54, v138, v139
    v_max3_f32 v54, v54, v152, v153
    v_max3_f32 v54, v54, v154, v155
    v_max_f32 v55, v140, v141
    v_max3_f32 v55, v55, v142, v143
    v_max3_f32 v55, v55, v156, v157
    v_max3_f32 v55, v55, v158, v159
    v_mov_b32 v224, v52
    v_mov_b32 v225, v53
    v_mov_b32 v226, v54
    v_mov_b32 v227, v55
    s_nop 1
    v_permlane16_swap_b32 v52, v224
    v_permlane16_swap_b32 v53, v225
    v_permlane16_swap_b32 v54, v226
    v_permlane16_swap_b32 v55, v227
    s_nop 1
    v_max_f32 v52, v52, v224
    v_max_f32 v53, v53, v225
    v_max_f32 v54, v54, v226
    v_max_f32 v55, v55, v227
    v_mov_b32 v224, v52
    v_mov_b32 v225, v53
    v_mov_b32 v226, v54
    v_mov_b32 v227, v55
    s_nop 1
    v_permlane32_swap_b32 v52, v224
    v_permlane32_swap_b32 v53, v225
    v_permlane32_swap_b32 v54, v226
    v_permlane32_swap_b32 v55, v227
    s_nop 1
    v_max_f32 v52, v52, v224
    v_max_f32 v53, v53, v225
    v_max_f32 v54, v54, v226
    v_max_f32 v55, v55, v227
    v_add_f32 v52, 0x41400000, v52
    v_add_f32 v53, 0x41400000, v53
    v_add_f32 v54, 0x41400000, v54
    v_add_f32 v55, 0x41400000, v55
    v_sub_f32 v16, 0, v52
    v_sub_f32 v17, 0, v52
    v_sub_f32 v18, 0, v52
    v_sub_f32 v19, 0, v52
    v_sub_f32 v20, 0, v53
    v_sub_f32 v21, 0, v53
    v_sub_f32 v22, 0, v53
    v_sub_f32 v23, 0, v53
    v_sub_f32 v24, 0, v54
    v_sub_f32 v25, 0, v54
    v_sub_f32 v26, 0, v54
    v_sub_f32 v27, 0, v54
    v_sub_f32 v28, 0, v55
    v_sub_f32 v29, 0, v55
    v_sub_f32 v30, 0, v55
    v_sub_f32 v31, 0, v55
    v_sub_f32 v32, 0, v52
    v_sub_f32 v33, 0, v52
    v_sub_f32 v34, 0, v52
    v_sub_f32 v35, 0, v52
    v_sub_f32 v36, 0, v53
    v_sub_f32 v37, 0, v53
    v_sub_f32 v38, 0, v53
    v_sub_f32 v39, 0, v53
    v_sub_f32 v40, 0, v54
    v_sub_f32 v41, 0, v54
    v_sub_f32 v42, 0, v54
    v_sub_f32 v43, 0, v54
    v_sub_f32 v44, 0, v55
    v_sub_f32 v45, 0, v55
    v_sub_f32 v46, 0, v55
    v_sub_f32 v47, 0, v55
    v_sub_f32 v8, 0, v52
    v_sub_f32 v9, 0, v53
    v_sub_f32 v10, 0, v54
    v_sub_f32 v11, 0, v55
    s_cmp_ge_u32 s36, s42
    s_cbranch_scc1 k2_prep_84
k2_prepret_85:
    v_mfma_f32_16x16x32_bf16 v[160:163], a[160:163], v[64:67], v[16:19]
    v_sub_f32 v128, v128, v52
    v_sub_f32 v129, v129, v52
    v_sub_f32 v130, v130, v52
    v_mfma_f32_16x16x32_bf16 v[160:163], a[164:167], v[68:71], v[160:163]
    v_exp_f32 v232, v128
    v_sub_f32 v131, v131, v52
    v_mfma_f32_16x16x32_bf16 v[160:163], a[168:171], v[72:75], v[160:163]
    v_exp_f32 v233, v129
    v_sub_f32 v144, v144, v52
    v_mfma_f32_16x16x32_bf16 v[160:163], a[172:175], v[76:79], v[160:163]
    s_add_u32 s36, s36, 32
    s_cmp_eq_u32 s30, 0
    s_cbranch_scc1 k12_ool_78
k12_oolret_79:
    v_sub_f32 v145, v145, v52
    v_mfma_f32_16x16x32_bf16 v[164:167], a[160:163], v[80:83], v[20:23]
    v_exp_f32 v234, v130
    v_cvt_pk_bf16_f32 v192, v232, v233
    v_mfma_f32_16x16x32_bf16 v[164:167], a[164:167], v[84:87], v[164:167]
    v_exp_f32 v235, v131
    v_sub_f32 v146, v146, v52
    v_mfma_f32_16x16x32_bf16 v[164:167], a[168:171], v[88:91], v[164:167]
    v_exp_f32 v236, v144
    v_sub_f32 v147, v147, v52
    v_mfma_f32_16x16x32_bf16 v[164:167], a[172:175], v[92:95], v[164:167]
    v_cvt_pk_bf16_f32 v193, v234, v235
    v_exp_f32 v237, v145
    v_mfma_f32_16x16x32_bf16 v[168:171], a[160:163], v[96:99], v[24:27]
    v_exp_f32 v238, v146
    v_sub_f32 v132, v132, v53
    v_mfma_f32_16x16x32_bf16 v[168:171], a[164:167], v[100:103], v[168:171]
    v_sub_f32 v133, v133, v53
    v_cvt_pk_bf16_f32 v194, v236, v237
    v_or3_b32 v57, v192, v193, v194
    v_mfma_f32_16x16x32_bf16 v[168:171], a[168:171], v[104:107], v[168:171]
    v_exp_f32 v239, v147
    v_sub_f32 v134, v134, v53
    v_mfma_f32_16x16x32_bf16 v[168:171], a[172:175], v[108:111], v[168:171]
    v_exp_f32 v240, v132
    v_sub_f32 v135, v135, v53
    v_mfma_f32_16x16x32_bf16 v[172:175], a[160:163], v[112:115], v[28:31]
    v_cvt_pk_bf16_f32 v195, v238, v239
    v_exp_f32 v241, v133
    v_mfma_f32_16x16x32_bf16 v[172:175], a[164:167], v[116:119], v[172:175]
    v_exp_f32 v242, v134
    v_sub_f32 v148, v148, v53
    v_mfma_f32_16x16x32_bf16 v[172:175], a[168:171], v[120:123], v[172:175]
    v_sub_f32 v149, v149, v53
    v_cvt_pk_bf16_f32 v196, v240, v241
    v_exp_f32 v243, v135
    v_mfma_f32_16x16x32_bf16 v[172:175], a[172:175], v[124:127], v[172:175]
    v_or3_b32 v57, v57, v195, v196
    v_exp_f32 v244, v148
    v_mfma_f32_16x16x32_bf16 v[176:179], a[176:179], v[64:67], v[32:35]
    v_sub_f32 v150, v150, v53
    v_sub_f32 v151, v151, v53
    v_cvt_pk_bf16_f32 v197, v242, v243
    v_mfma_f32_16x16x32_bf16 v[176:179], a[180:183], v[68:71], v[176:179]
    v_exp_f32 v245, v149
    v_exp_f32 v246, v150
    v_mfma_f32_16x16x32_bf16 v[176:179], a[184:187], v[72:75], v[176:179]
    v_sub_f32 v136, v136, v54
    v_sub_f32 v137, v137, v54
    v_cvt_pk_bf16_f32 v198, v244, v245
    v_mfma_f32_16x16x32_bf16 v[176:179], a[188:191], v[76:79], v[176:179]
    v_exp_f32 v247, v151
    v_or3_b32 v57, v57, v197, v198
    v_mfma_f32_16x16x32_bf16 v[180:183], a[176:179], v[80:83], v[36:39]
    v_exp_f32 v232, v136
    v_sub_f32 v138, v138, v54
    v_mfma_f32_16x16x32_bf16 v[180:183], a[180:183], v[84:87], v[180:183]
    ds_read_b128 a[192:195], v3 offset:0
    v_sub_f32 v139, v139, v54
    v_cvt_pk_bf16_f32 v199, v246, v247
    v_mfma_f32_16x16x32_bf16 v[180:183], a[184:187], v[88:91], v[180:183]
    v_exp_f32 v233, v137
    v_exp_f32 v234, v138
    v_mfma_f32_16x16x32_bf16 v[180:183], a[188:191], v[92:95], v[180:183]
    v_sub_f32 v152, v152, v54
    v_sub_f32 v153, v153, v54
    v_cvt_pk_bf16_f32 v200, v232, v233
    v_mfma_f32_16x16x32_bf16 v[184:187], a[176:179], v[96:99], v[40:43]
    v_exp_f32 v235, v139
    v_or3_b32 v57, v57, v199, v200
    v_mfma_f32_16x16x32_bf16 v[184:187], a[180:183], v[100:103], v[184:187]
    v_exp_f32 v236, v152
    v_sub_f32 v154, v154, v54
    v_mfma_f32_16x16x32_bf16 v[184:187], a[184:187], v[104:107], v[184:187]
    v_sub_f32 v155, v155, v54
    v_cvt_pk_bf16_f32 v201, v234, v235
    v_exp_f32 v237, v153
    v_mfma_f32_16x16x32_bf16 v[184:187], a[188:191], v[108:111], v[184:187]
    ds_read_b128 a[196:199], v3 offset:1024
    v_exp_f32 v238, v154
    v_mfma_f32_16x16x32_bf16 v[188:191], a[176:179], v[112:115], v[44:47]
    v_sub_f32 v140, v140, v55
    v_sub_f32 v141, v141, v55
    v_cvt_pk_bf16_f32 v202, v236, v237
    v_mfma_f32_16x16x32_bf16 v[188:191], a[180:183], v[116:119], v[188:191]
    v_exp_f32 v239, v155
    v_or3_b32 v57, v57, v201, v202
    v_mfma_f32_16x16x32_bf16 v[188:191], a[184:187], v[120:123], v[188:191]
    s_cmp_eq_u32 s30, 0
    s_cbranch_scc1 k12_ool_82
k12_oolret_83:
    v_exp_f32 v240, v140
    v_mfma_f32_16x16x32_bf16 v[188:191], a[188:191], v[124:127], v[188:191]
    s_waitcnt vmcnt(8)
    s_barrier
    v_sub_f32 v142, v142, v55
    v_sub_f32 v143, v143, v55
    v_cvt_pk_bf16_f32 v203, v238, v239
    v_exp_f32 v241, v141
    v_exp_f32 v242, v142
    v_sub_f32 v156, v156, v55
    v_sub_f32 v157, v157, v55
    ds_read_b128 a[200:203], v3 offset:2048
    v_cvt_pk_bf16_f32 v204, v240, v241
    v_exp_f32 v243, v143
    v_or3_b32 v57, v57, v203, v204
    v_exp_f32 v244, v156
    v_sub_f32 v158, v158, v55
    v_sub_f32 v159, v159, v55
    v_cvt_pk_bf16_f32 v205, v242, v243
    v_exp_f32 v245, v157
    v_exp_f32 v246, v158
    v_cvt_pk_bf16_f32 v206, v244, v245
    ds_read_b128 a[204:207], v3 offset:3072
    v_exp_f32 v247, v159
    v_or3_b32 v57, v57, v205, v206
    v_cvt_pk_bf16_f32 v207, v246, v247
    v_bitop3_b32 v57, v57, v207, s37 bitop3:0xa8
    v_cmp_ne_u32 vcc, 0, v57
    s_cbranch_vccnz k2_tramp_86
k2_ret_87:
    s_mov_b32 s24, s60
    s_and_b32 s25, s61, 0xffff
    s_mov_b32 s26, s55
    s_lshl_b32 s63, s29, 1
    s_sub_u32 s63, s63, 1
    s_cbranch_scc1 k2_dm3_89
k2_dloop_88:
    v_mfma_f32_16x16x32_bf16 v[12:15], v[60:63], v[192:195], v[12:15]
    v_exp_f32 v232, v160
    v_mfma_f32_16x16x32_bf16 v[48:51], v[60:63], v[196:199], v[48:51]
    s_mov_b32 m0, s34
    ds_read_b128 a[208:211], v3 offset:4096
    v_mfma_f32_16x16x32_bf16 v[248:251], v[60:63], v[200:203], v[248:251]
    s_add_u32 s53, s53, 8192
    buffer_load_dwordx4 v1, s[16:19], s32 offen offset:0 sc1 lds
    v_mfma_f32_16x16x32_bf16 v[252:255], v[60:63], v[204:207], v[252:255]
    s_waitcnt lgkmcnt(3)
    v_exp_f32 v233, v161
    v_mfma_f32_16x16x32_bf16 a[0:3], a[192:195], v[192:195], a[0:3]
    s_and_b32 s53, s53, 0xffff
    v_exp_f32 v234, v162
    v_mfma_f32_16x16x32_bf16 a[4:7], a[192:195], v[196:199], a[4:7]
    s_add_u32 s34, s34, 0x4000
    ds_read_b128 a[212:215], v3 offset:5120
    v_cvt_pk_bf16_f32 v208, v232, v233
    v_mfma_f32_16x16x32_bf16 a[8:11], a[192:195], v[200:203], a[8:11]
    v_exp_f32 v235, v163
    v_mfma_f32_16x16x32_bf16 a[12:15], a[192:195], v[204:207], a[12:15]
    buffer_load_dwordx4 v1, s[16:19], s32 offen offset:1024 sc1 lds
    v_mfma_f32_16x16x32_bf16 a[16:19], a[196:199], v[192:195], a[16:19]
    v_exp_f32 v236, v176
    v_mfma_f32_16x16x32_bf16 a[20:23], a[196:199], v[196:199], a[20:23]
    ds_read_b128 a[216:219], v3 offset:6144
    v_cvt_pk_bf16_f32 v209, v234, v235
    v_mfma_f32_16x16x32_bf16 a[24:27], a[196:199], v[200:203], a[24:27]
    v_exp_f32 v237, v177
    v_mfma_f32_16x16x32_bf16 a[28:31], a[196:199], v[204:207], a[28:31]
    s_waitcnt lgkmcnt(3)
    v_exp_f32 v238, v178
    v_mfma_f32_16x16x32_bf16 a[32:35], a[200:203], v[192:195], a[32:35]
    s_and_b32 s34, s34, 0xffff
    ds_read_b128 a[220:223], v3 offset:7168
    v_cvt_pk_bf16_f32 v210, v236, v237
    v_mfma_f32_16x16x32_bf16 a[36:39], a[200:203], v[196:199], a[36:39]
    s_and_b32 s60, s62, 31
    buffer_load_dwordx4 v1, s[16:19], s32 offen offset:2048 sc1 lds
    v_mfma_f32_16x16x32_bf16 a[40:43], a[200:203], v[200:203], a[40:43]
    v_exp_f32 v239, v179
    v_mfma_f32_16x16x32_bf16 a[44:47], a[200:203], v[204:207], a[44:47]
    s_lshr_b32 s61, s62, 5
    v_or3_b32 v57, v208, v209, v210
    v_add_u32 v3, s53, v56
    v_mfma_f32_16x16x32_bf16 a[48:51], a[204:207], v[192:195], a[48:51]
    v_exp_f32 v240, v164
    v_mfma_f32_16x16x32_bf16 a[52:55], a[204:207], v[196:199], a[52:55]
    ds_read_b128 a[128:131], v2 offset:0
    v_cvt_pk_bf16_f32 v211, v238, v239
    v_mfma_f32_16x16x32_bf16 a[56:59], a[204:207], v[200:203], a[56:59]
    s_mul_i32 s57, s60, 229376
    v_exp_f32 v241, v165
    v_mfma_f32_16x16x32_bf16 a[60:63], a[204:207], v[204:207], a[60:63]
    s_waitcnt lgkmcnt(3)
    buffer_load_dwordx4 v1, s[16:19], s32 offen offset:3072 sc1 lds
    v_mfma_f32_16x16x32_bf16 a[64:67], a[208:211], v[192:195], a[64:67]
    s_add_u32 s32, s32, 0x80000
    v_exp_f32 v242, v166
    v_mfma_f32_16x16x32_bf16 a[68:71], a[208:211], v[196:199], a[68:71]
    s_lshl_b32 s4, s61, 7
    ds_read_b128 a[132:135], v2 offset:1024
    v_cvt_pk_bf16_f32 v212, v240, v241
    v_mfma_f32_16x16x32_bf16 a[72:75], a[208:211], v[200:203], a[72:75]
    v_exp_f32 v243, v167
    v_mfma_f32_16x16x32_bf16 a[76:79], a[208:211], v[204:207], a[76:79]
    s_add_u32 s57, s57, s4
    v_or3_b32 v57, v57, v211, v212
    v_cvt_pk_bf16_f32 v213, v242, v243
    v_mfma_f32_16x16x32_bf16 a[80:83], a[212:215], v[192:195], a[80:83]
    s_waitcnt vmcnt(8)
    v_exp_f32 v244, v180
    v_mfma_f32_16x16x32_bf16 a[84:87], a[212:215], v[196:199], a[84:87]
    buffer_store_dwordx4 a[224:227], v229, s[8:11], s58 offen offset:0 sc1
    ds_read_b128 a[136:139], v2 offset:2048
    v_mfma_f32_16x16x32_bf16 a[88:91], a[212:215], v[200:203], a[88:91]
    s_add_u32 s56, s57, 57344
    v_exp_f32 v245, v181
    v_mfma_f32_16x16x32_bf16 a[92:95], a[212:215], v[204:207], a[92:95]
    s_waitcnt lgkmcnt(3)
    v_exp_f32 v246, v182
    v_mfma_f32_16x16x32_bf16 a[96:99], a[216:219], v[192:195], a[96:99]
    ds_read_b128 a[140:143], v2 offset:3072
    v_cvt_pk_bf16_f32 v214, v244, v245
    v_mfma_f32_16x16x32_bf16 a[100:103], a[216:219], v[196:199], a[100:103]
    s_add_u32 s62, s62, 1
    v_exp_f32 v247, v183
    v_mfma_f32_16x16x32_bf16 a[104:107], a[216:219], v[200:203], a[104:107]
    v_or3_b32 v57, v57, v213, v214
    v_mfma_f32_16x16x32_bf16 a[108:111], a[216:219], v[204:207], a[108:111]
    v_exp_f32 v232, v168
    v_mfma_f32_16x16x32_bf16 a[112:115], a[220:223], v[192:195], a[112:115]
    ds_read_b128 a[144:147], v2 offset:4096
    v_cvt_pk_bf16_f32 v215, v246, v247
    v_mfma_f32_16x16x32_bf16 a[116:119], a[220:223], v[196:199], a[116:119]
    buffer_store_dwordx4 a[228:231], v229, s[8:11], s58 offen offset:256 sc1
    v_mfma_f32_16x16x32_bf16 a[120:123], a[220:223], v[200:203], a[120:123]
    v_exp_f32 v233, v169
    v_mfma_f32_16x16x32_bf16 a[124:127], a[220:223], v[204:207], a[124:127]
    s_waitcnt lgkmcnt(3)
    v_exp_f32 v234, v170
    v_mfma_f32_16x16x32_bf16 v[128:131], a[128:131], v[64:67], v[16:19]
    ds_read_b128 a[148:151], v2 offset:5120
    v_cvt_pk_bf16_f32 v216, v232, v233
    v_mfma_f32_16x16x32_bf16 v[128:131], a[132:135], v[68:71], v[128:131]
    s_waitcnt lgkmcnt(2)
    v_exp_f32 v235, v171
    v_mfma_f32_16x16x32_bf16 v[128:131], a[136:139], v[72:75], v[128:131]
    v_or3_b32 v57, v57, v215, v216
    v_mfma_f32_16x16x32_bf16 v[128:131], a[140:143], v[76:79], v[128:131]
    s_add_u32 s36, s36, 32
    v_exp_f32 v236, v184
    v_mfma_f32_16x16x32_bf16 v[132:135], a[128:131], v[80:83], v[20:23]
    ds_read_b128 a[152:155], v2 offset:6144
    v_cvt_pk_bf16_f32 v217, v234, v235
    v_mfma_f32_16x16x32_bf16 v[132:135], a[132:135], v[84:87], v[132:135]
    s_lshl_b32 s58, s61, 17
    buffer_load_dwordx4 a[224:227], v228, s[12:15], s57 offen
    v_mfma_f32_16x16x32_bf16 v[132:135], a[136:139], v[88:91], v[132:135]
    s_add_u32 s52, s52, 8192
    v_exp_f32 v237, v185
    v_mfma_f32_16x16x32_bf16 v[132:135], a[140:143], v[92:95], v[132:135]
    v_exp_f32 v238, v186
    v_mfma_f32_16x16x32_bf16 v[136:139], a[128:131], v[96:99], v[24:27]
    s_lshl_b32 s60, s60, 10
    ds_read_b128 a[156:159], v2 offset:7168
    v_cvt_pk_bf16_f32 v218, v236, v237
    v_mfma_f32_16x16x32_bf16 v[136:139], a[132:135], v[100:103], v[136:139]
    s_and_b32 s52, s52, 0xffff
    v_exp_f32 v239, v187
    v_mfma_f32_16x16x32_bf16 v[136:139], a[136:139], v[104:107], v[136:139]
    v_or3_b32 v57, v57, v217, v218
    v_mfma_f32_16x16x32_bf16 v[136:139], a[140:143], v[108:111], v[136:139]
    v_add_u32 v2, s52, v1
    v_cvt_pk_bf16_f32 v219, v238, v239
    v_mfma_f32_16x16x32_bf16 v[140:143], a[128:131], v[112:115], v[28:31]
    s_add_u32 s58, s58, s60
    v_exp_f32 v240, v172
    v_mfma_f32_16x16x32_bf16 v[140:143], a[132:135], v[116:119], v[140:143]
    buffer_load_dwordx4 a[228:231], v228, s[12:15], s56 offen
    v_mfma_f32_16x16x32_bf16 v[140:143], a[136:139], v[120:123], v[140:143]
    v_exp_f32 v241, v173
    v_mfma_f32_16x16x32_bf16 v[140:143], a[140:143], v[124:127], v[140:143]
    s_waitcnt lgkmcnt(2)
    ds_read_b128 a[192:195], v3 offset:0
    v_cvt_pk_bf16_f32 v220, v240, v241
    v_mfma_f32_16x16x32_bf16 v[144:147], a[144:147], v[64:67], v[32:35]
    s_mov_b32 s10, s59
    v_exp_f32 v242, v174
    v_mfma_f32_16x16x32_bf16 v[144:147], a[148:151], v[68:71], v[144:147]
    s_waitcnt lgkmcnt(1)
    v_exp_f32 v243, v175
    v_mfma_f32_16x16x32_bf16 v[144:147], a[152:155], v[72:75], v[144:147]
    ds_read_b128 a[196:199], v3 offset:1024
    v_or3_b32 v57, v57, v219, v220
    v_mfma_f32_16x16x32_bf16 v[144:147], a[156:159], v[76:79], v[144:147]
    v_exp_f32 v244, v188
    v_mfma_f32_16x16x32_bf16 v[148:151], a[144:147], v[80:83], v[36:39]
    v_cvt_pk_bf16_f32 v221, v242, v243
    v_mfma_f32_16x16x32_bf16 v[148:151], a[148:151], v[84:87], v[148:151]
    buffer_load_dword v7, v230, s[24:27], s54 offen
    v_mfma_f32_16x16x32_bf16 v[148:151], a[152:155], v[88:91], v[148:151]
    v_exp_f32 v245, v189
    v_mfma_f32_16x16x32_bf16 v[148:151], a[156:159], v[92:95], v[148:151]
    ds_read_b128 a[200:203], v3 offset:2048
    v_cvt_pk_bf16_f32 v222, v244, v245
    v_mfma_f32_16x16x32_bf16 v[152:155], a[144:147], v[96:99], v[40:43]
    v_exp_f32 v246, v190
    v_mfma_f32_16x16x32_bf16 v[152:155], a[148:151], v[100:103], v[152:155]
    v_exp_f32 v247, v191
    v_mfma_f32_16x16x32_bf16 v[152:155], a[152:155], v[104:107], v[152:155]
    ds_read_b128 a[204:207], v3 offset:3072
    v_or3_b32 v57, v57, v221, v222
    v_mfma_f32_16x16x32_bf16 v[152:155], a[156:159], v[108:111], v[152:155]
    v_cvt_pk_bf16_f32 v223, v246, v247
    v_mfma_f32_16x16x32_bf16 v[156:159], a[144:147], v[112:115], v[44:47]
    s_add_u32 s54, s54, 4096
    v_mfma_f32_16x16x32_bf16 v[156:159], a[148:151], v[116:119], v[156:159]
    v_bitop3_b32 v57, v57, v223, s37 bitop3:0xa8
    v_cmp_ne_u32 vcc, 0, v57
    v_mfma_f32_16x16x32_bf16 v[156:159], a[152:155], v[120:123], v[156:159]
    v_mfma_f32_16x16x32_bf16 v[156:159], a[156:159], v[124:127], v[156:159]
    s_cbranch_vccnz k2_tramp_90
k2_ret_91:
    v_mfma_f32_16x16x32_bf16 v[12:15], v[60:63], v[208:211], v[12:15]
    v_exp_f32 v232, v128
    v_mfma_f32_16x16x32_bf16 v[48:51], v[60:63], v[212:215], v[48:51]
    s_mov_b32 m0, s35
    ds_read_b128 a[208:211], v3 offset:4096
    v_mfma_f32_16x16x32_bf16 v[248:251], v[60:63], v[216:219], v[248:251]
    s_add_u32 s53, s53, 8192
    buffer_load_dwordx4 v1, s[20:23], s33 offen offset:0 sc1 lds
    v_mfma_f32_16x16x32_bf16 v[252:255], v[60:63], v[220:223], v[252:255]
    s_waitcnt lgkmcnt(3)
    v_exp_f32 v233, v129
    v_mfma_f32_16x16x32_bf16 a[0:3], a[192:195], v[208:211], a[0:3]
    s_and_b32 s53, s53, 0xffff
    v_exp_f32 v234, v130
    v_mfma_f32_16x16x32_bf16 a[4:7], a[192:195], v[212:215], a[4:7]
    ds_read_b128 a[212:215], v3 offset:5120
    v_cvt_pk_bf16_f32 v192, v232, v233
    v_mfma_f32_16x16x32_bf16 a[8:11], a[192:195], v[216:219], a[8:11]
    v_exp_f32 v235, v131
    v_mfma_f32_16x16x32_bf16 a[12:15], a[192:195], v[220:223], a[12:15]
    v_exp_f32 v236, v144
    v_mfma_f32_16x16x32_bf16 a[16:19], a[196:199], v[208:211], a[16:19]
    ds_read_b128 a[216:219], v3 offset:6144
    v_cvt_pk_bf16_f32 v193, v234, v235
    v_mfma_f32_16x16x32_bf16 a[20:23], a[196:199], v[212:215], a[20:23]
    v_exp_f32 v237, v145
    v_mfma_f32_16x16x32_bf16 a[24:27], a[196:199], v[216:219], a[24:27]
    v_mfma_f32_16x16x32_bf16 a[28:31], a[196:199], v[220:223], a[28:31]
    s_waitcnt lgkmcnt(3)
    v_exp_f32 v238, v146
    v_mfma_f32_16x16x32_bf16 a[32:35], a[200:203], v[208:211], a[32:35]
    ds_read_b128 a[220:223], v3 offset:7168
    v_cvt_pk_bf16_f32 v194, v236, v237
    v_mfma_f32_16x16x32_bf16 a[36:39], a[200:203], v[212:215], a[36:39]
    v_exp_f32 v239, v147
    v_mfma_f32_16x16x32_bf16 a[40:43], a[200:203], v[216:219], a[40:43]
    v_or3_b32 v57, v192, v193, v194
    v_mfma_f32_16x16x32_bf16 a[44:47], a[200:203], v[220:223], a[44:47]
    s_add_u32 s35, s35, 0x4000
    v_add_u32 v3, s53, v56
    v_cvt_pk_bf16_f32 v195, v238, v239
    v_mfma_f32_16x16x32_bf16 a[48:51], a[204:207], v[208:211], a[48:51]
    v_exp_f32 v240, v132
    v_mfma_f32_16x16x32_bf16 a[52:55], a[204:207], v[212:215], a[52:55]
    buffer_load_dwordx4 v1, s[20:23], s33 offen offset:1024 sc1 lds
    ds_read_b128 a[128:131], v2 offset:0
    v_mfma_f32_16x16x32_bf16 a[56:59], a[204:207], v[216:219], a[56:59]
    v_exp_f32 v241, v133
    v_mfma_f32_16x16x32_bf16 a[60:63], a[204:207], v[220:223], a[60:63]
    s_waitcnt lgkmcnt(3)
    v_exp_f32 v242, v134
    v_mfma_f32_16x16x32_bf16 a[64:67], a[208:211], v[208:211], a[64:67]
    ds_read_b128 a[132:135], v2 offset:1024
    v_cvt_pk_bf16_f32 v196, v240, v241
    v_mfma_f32_16x16x32_bf16 a[68:71], a[208:211], v[212:215], a[68:71]
    v_exp_f32 v243, v135
    v_mfma_f32_16x16x32_bf16 a[72:75], a[208:211], v[216:219], a[72:75]
    v_or3_b32 v57, v57, v195, v196
    v_mfma_f32_16x16x32_bf16 a[76:79], a[208:211], v[220:223], a[76:79]
    v_exp_f32 v244, v148
    v_mfma_f32_16x16x32_bf16 a[80:83], a[212:215], v[208:211], a[80:83]
    ds_read_b128 a[136:139], v2 offset:2048
    v_cvt_pk_bf16_f32 v197, v242, v243
    v_mfma_f32_16x16x32_bf16 a[84:87], a[212:215], v[212:215], a[84:87]
    v_exp_f32 v245, v149
    v_mfma_f32_16x16x32_bf16 a[88:91], a[212:215], v[216:219], a[88:91]
    v_mfma_f32_16x16x32_bf16 a[92:95], a[212:215], v[220:223], a[92:95]
    s_waitcnt lgkmcnt(3)
    v_exp_f32 v246, v150
    v_mfma_f32_16x16x32_bf16 a[96:99], a[216:219], v[208:211], a[96:99]
    ds_read_b128 a[140:143], v2 offset:3072
    v_cvt_pk_bf16_f32 v198, v244, v245
    v_mfma_f32_16x16x32_bf16 a[100:103], a[216:219], v[212:215], a[100:103]
    v_exp_f32 v247, v151
    v_mfma_f32_16x16x32_bf16 a[104:107], a[216:219], v[216:219], a[104:107]
    v_or3_b32 v57, v57, v197, v198
    v_mfma_f32_16x16x32_bf16 a[108:111], a[216:219], v[220:223], a[108:111]
    s_and_b32 s35, s35, 0xffff
    v_exp_f32 v232, v136
    v_mfma_f32_16x16x32_bf16 a[112:115], a[220:223], v[208:211], a[112:115]
    ds_read_b128 a[144:147], v2 offset:4096
    v_cvt_pk_bf16_f32 v199, v246, v247
    v_mfma_f32_16x16x32_bf16 a[116:119], a[220:223], v[212:215], a[116:119]
    buffer_load_dwordx4 v1, s[20:23], s33 offen offset:2048 sc1 lds
    v_mfma_f32_16x16x32_bf16 a[120:123], a[220:223], v[216:219], a[120:123]
    v_exp_f32 v233, v137
    v_mfma_f32_16x16x32_bf16 a[124:127], a[220:223], v[220:223], a[124:127]
    s_waitcnt lgkmcnt(3)
    v_exp_f32 v234, v138
    v_mfma_f32_16x16x32_bf16 v[160:163], a[128:131], v[64:67], v[16:19]
    ds_read_b128 a[148:151], v2 offset:5120
    v_cvt_pk_bf16_f32 v200, v232, v233
    v_mfma_f32_16x16x32_bf16 v[160:163], a[132:135], v[68:71], v[160:163]
    s_waitcnt lgkmcnt(2)
    v_exp_f32 v235, v139
    v_mfma_f32_16x16x32_bf16 v[160:163], a[136:139], v[72:75], v[160:163]
    v_or3_b32 v57, v57, v199, v200
    v_mfma_f32_16x16x32_bf16 v[160:163], a[140:143], v[76:79], v[160:163]
    s_or_b32 s35, s35, 0x10000
    v_exp_f32 v236, v152
    v_mfma_f32_16x16x32_bf16 v[164:167], a[128:131], v[80:83], v[20:23]
    s_add_u32 s36, s36, 32
    ds_read_b128 a[152:155], v2 offset:6144
    v_cvt_pk_bf16_f32 v201, v234, v235
    v_mfma_f32_16x16x32_bf16 v[164:167], a[132:135], v[84:87], v[164:167]
    v_exp_f32 v237, v153
    v_mfma_f32_16x16x32_bf16 v[164:167], a[136:139], v[88:91], v[164:167]
    s_add_u32 s52, s52, 8192
    v_mfma_f32_16x16x32_bf16 v[164:167], a[140:143], v[92:95], v[164:167]
    v_exp_f32 v238, v154
    v_mfma_f32_16x16x32_bf16 v[168:171], a[128:131], v[96:99], v[24:27]
    s_and_b32 s52, s52, 0xffff
    ds_read_b128 a[156:159], v2 offset:7168
    v_cvt_pk_bf16_f32 v202, v236, v237
    v_mfma_f32_16x16x32_bf16 v[168:171], a[132:135], v[100:103], v[168:171]
    v_exp_f32 v239, v155
    v_mfma_f32_16x16x32_bf16 v[168:171], a[136:139], v[104:107], v[168:171]
    v_or3_b32 v57, v57, v201, v202
    v_mfma_f32_16x16x32_bf16 v[168:171], a[140:143], v[108:111], v[168:171]
    v_add_u32 v2, s52, v1
    v_cvt_pk_bf16_f32 v203, v238, v239
    v_mfma_f32_16x16x32_bf16 v[172:175], a[128:131], v[112:115], v[28:31]
    v_exp_f32 v240, v140
    v_mfma_f32_16x16x32_bf16 v[172:175], a[132:135], v[116:119], v[172:175]
    buffer_load_dwordx4 v1, s[20:23], s33 offen offset:3072 sc1 lds
    v_mfma_f32_16x16x32_bf16 v[172:175], a[136:139], v[120:123], v[172:175]
    s_add_u32 s33, s33, 0x80000
    v_exp_f32 v241, v141
    v_mfma_f32_16x16x32_bf16 v[172:175], a[140:143], v[124:127], v[172:175]
    s_waitcnt lgkmcnt(2)
    ds_read_b128 a[192:195], v3 offset:0
    v_cvt_pk_bf16_f32 v204, v240, v241
    v_mfma_f32_16x16x32_bf16 v[176:179], a[144:147], v[64:67], v[32:35]
    v_exp_f32 v242, v142
    v_mfma_f32_16x16x32_bf16 v[176:179], a[148:151], v[68:71], v[176:179]
    s_waitcnt lgkmcnt(1)
    v_exp_f32 v243, v143
    v_mfma_f32_16x16x32_bf16 v[176:179], a[152:155], v[72:75], v[176:179]
    ds_read_b128 a[196:199], v3 offset:1024
    v_or3_b32 v57, v57, v203, v204
    v_mfma_f32_16x16x32_bf16 v[176:179], a[156:159], v[76:79], v[176:179]
    v_exp_f32 v244, v156
    v_mfma_f32_16x16x32_bf16 v[180:183], a[144:147], v[80:83], v[36:39]
    v_cvt_pk_bf16_f32 v205, v242, v243
    v_mfma_f32_16x16x32_bf16 v[180:183], a[148:151], v[84:87], v[180:183]
    v_exp_f32 v245, v157
    v_mfma_f32_16x16x32_bf16 v[180:183], a[152:155], v[88:91], v[180:183]
    ds_read_b128 a[200:203], v3 offset:2048
    v_mfma_f32_16x16x32_bf16 v[180:183], a[156:159], v[92:95], v[180:183]
    s_sub_u32 s63, s63, 1
    v_exp_f32 v246, v158
    v_mfma_f32_16x16x32_bf16 v[184:187], a[144:147], v[96:99], v[40:43]
    v_cvt_pk_bf16_f32 v206, v244, v245
    v_mfma_f32_16x16x32_bf16 v[184:187], a[148:151], v[100:103], v[184:187]
    v_exp_f32 v247, v159
    v_mfma_f32_16x16x32_bf16 v[184:187], a[152:155], v[104:107], v[184:187]
    ds_read_b128 a[204:207], v3 offset:3072
    v_or3_b32 v57, v57, v205, v206
    v_mfma_f32_16x16x32_bf16 v[184:187], a[156:159], v[108:111], v[184:187]
    v_cvt_pk_bf16_f32 v207, v246, v247
    v_mfma_f32_16x16x32_bf16 v[188:191], a[144:147], v[112:115], v[44:47]
    v_mfma_f32_16x16x32_bf16 v[188:191], a[148:151], v[116:119], v[188:191]
    v_bitop3_b32 v57, v57, v207, s37 bitop3:0xa8
    v_cmp_ne_u32 vcc, 0, v57
    v_mfma_f32_16x16x32_bf16 v[188:191], a[152:155], v[120:123], v[188:191]
    v_mfma_f32_16x16x32_bf16 v[188:191], a[156:159], v[124:127], v[188:191]
    s_waitcnt vmcnt(13)
    s_barrier
    s_cbranch_vccnz k2_tramp_92
k2_ret_93:
    s_cmp_lg_u32 s63, 0
    s_cbranch_scc1 k2_dloop_88
    v_mfma_f32_16x16x32_bf16 v[12:15], v[60:63], v[192:195], v[12:15]
    v_exp_f32 v232, v160
    v_mfma_f32_16x16x32_bf16 v[48:51], v[60:63], v[196:199], v[48:51]
    s_mov_b32 m0, s34
    ds_read_b128 a[208:211], v3 offset:4096
    v_mfma_f32_16x16x32_bf16 v[248:251], v[60:63], v[200:203], v[248:251]
    s_add_u32 s53, s53, 8192
    buffer_load_dwordx4 v1, s[16:19], s32 offen offset:0 sc1 lds
    v_mfma_f32_16x16x32_bf16 v[252:255], v[60:63], v[204:207], v[252:255]
    s_waitcnt lgkmcnt(3)
    v_exp_f32 v233, v161
    v_mfma_f32_16x16x32_bf16 a[0:3], a[192:195], v[192:195], a[0:3]
    s_sub_u32 s40, s36, s38
    v_exp_f32 v234, v162
    v_mfma_f32_16x16x32_bf16 a[4:7], a[192:195], v[196:199], a[4:7]
    s_and_b32 s53, s53, 0xffff
    ds_read_b128 a[212:215], v3 offset:5120
    v_cvt_pk_bf16_f32 v208, v232, v233
    v_mfma_f32_16x16x32_bf16 a[8:11], a[192:195], v[200:203], a[8:11]
    s_add_u32 s34, s34, 0x4000
    v_subrev_u32 v6, s40, v4
    v_cmp_gt_i32 s[44:45], 0, v6
    v_mfma_f32_16x16x32_bf16 a[12:15], a[192:195], v[204:207], a[12:15]
    v_exp_f32 v235, v163
    v_mfma_f32_16x16x32_bf16 a[16:19], a[196:199], v[192:195], a[16:19]
    buffer_load_dwordx4 v1, s[16:19], s32 offen offset:1024 sc1 lds
    ds_read_b128 a[216:219], v3 offset:6144
    v_mfma_f32_16x16x32_bf16 a[20:23], a[196:199], v[196:199], a[20:23]
    v_exp_f32 v236, v176
    v_mfma_f32_16x16x32_bf16 a[24:27], a[196:199], v[200:203], a[24:27]
    v_cmp_gt_i32 s[46:47], 1, v6
    v_cvt_pk_bf16_f32 v209, v234, v235
    v_mfma_f32_16x16x32_bf16 a[28:31], a[196:199], v[204:207], a[28:31]
    s_waitcnt lgkmcnt(3)
    v_cmp_gt_i32 s[48:49], 2, v6
    v_cmp_gt_i32 s[50:51], 3, v6
    v_mfma_f32_16x16x32_bf16 a[32:35], a[200:203], v[192:195], a[32:35]
    s_and_b32 s34, s34, 0xffff
    v_exp_f32 v237, v177
    v_mfma_f32_16x16x32_bf16 a[36:39], a[200:203], v[196:199], a[36:39]
    s_and_b32 s60, s62, 31
    v_exp_f32 v238, v178
    v_mfma_f32_16x16x32_bf16 a[40:43], a[200:203], v[200:203], a[40:43]
    ds_read_b128 a[220:223], v3 offset:7168
    v_cvt_pk_bf16_f32 v210, v236, v237
    v_mfma_f32_16x16x32_bf16 a[44:47], a[200:203], v[204:207], a[44:47]
    s_lshr_b32 s61, s62, 5
    buffer_load_dwordx4 v1, s[16:19], s32 offen offset:2048 sc1 lds
    v_mfma_f32_16x16x32_bf16 a[48:51], a[204:207], v[192:195], a[48:51]
    v_cndmask_b32 v16, v8, v5, s[44:45]
    v_or3_b32 v57, v208, v209, v210
    v_mfma_f32_16x16x32_bf16 a[52:55], a[204:207], v[196:199], a[52:55]
    v_exp_f32 v239, v179
    v_mfma_f32_16x16x32_bf16 a[56:59], a[204:207], v[200:203], a[56:59]
    s_mul_i32 s57, s60, 229376
    v_cndmask_b32 v17, v8, v5, s[46:47]
    v_add_u32 v3, s53, v56
    v_mfma_f32_16x16x32_bf16 a[60:63], a[204:207], v[204:207], a[60:63]
    s_waitcnt lgkmcnt(2)
    v_exp_f32 v240, v164
    v_mfma_f32_16x16x32_bf16 a[64:67], a[208:211], v[192:195], a[64:67]
    v_cvt_pk_bf16_f32 v211, v238, v239
    v_cndmask_b32 v18, v8, v5, s[48:49]
    v_mfma_f32_16x16x32_bf16 a[68:71], a[208:211], v[196:199], a[68:71]
    s_lshl_b32 s4, s61, 7
    ds_read_b128 a[128:131], v2 offset:0
    v_cndmask_b32 v19, v8, v5, s[50:51]
    v_mfma_f32_16x16x32_bf16 a[72:75], a[208:211], v[200:203], a[72:75]
    v_exp_f32 v241, v165
    v_mfma_f32_16x16x32_bf16 a[76:79], a[208:211], v[204:207], a[76:79]
    s_add_u32 s57, s57, s4
    buffer_load_dwordx4 v1, s[16:19], s32 offen offset:3072 sc1 lds
    s_add_u32 s32, s32, 0x80000
    v_mfma_f32_16x16x32_bf16 a[80:83], a[212:215], v[192:195], a[80:83]
    s_waitcnt vmcnt(8)
    v_cmp_gt_i32 s[44:45], 16, v6
    v_exp_f32 v242, v166
    v_mfma_f32_16x16x32_bf16 a[84:87], a[212:215], v[196:199], a[84:87]
    ds_read_b128 a[132:135], v2 offset:1024
    v_cvt_pk_bf16_f32 v212, v240, v241
    v_mfma_f32_16x16x32_bf16 a[88:91], a[212:215], v[200:203], a[88:91]
    s_add_u32 s56, s57, 57344
    v_cmp_gt_i32 s[46:47], 17, v6
    v_exp_f32 v243, v167
    v_mfma_f32_16x16x32_bf16 a[92:95], a[212:215], v[204:207], a[92:95]
    s_waitcnt lgkmcnt(2)
    v_or3_b32 v57, v57, v211, v212
    v_cmp_gt_i32 s[48:49], 18, v6
    v_mfma_f32_16x16x32_bf16 a[96:99], a[216:219], v[192:195], a[96:99]
    v_exp_f32 v244, v180
    v_mfma_f32_16x16x32_bf16 a[100:103], a[216:219], v[196:199], a[100:103]
    s_add_u32 s62, s62, 1
    v_cvt_pk_bf16_f32 v213, v242, v243
    v_cmp_gt_i32 s[50:51], 19, v6
    v_mfma_f32_16x16x32_bf16 a[104:107], a[216:219], v[200:203], a[104:107]
    buffer_store_dwordx4 a[224:227], v229, s[8:11], s58 offen offset:0 sc1
    ds_read_b128 a[136:139], v2 offset:2048
    v_mfma_f32_16x16x32_bf16 a[108:111], a[216:219], v[204:207], a[108:111]
    v_exp_f32 v245, v181
    v_mfma_f32_16x16x32_bf16 a[112:115], a[220:223], v[192:195], a[112:115]
    v_cndmask_b32 v32, v8, v5, s[44:45]
    v_exp_f32 v246, v182
    v_mfma_f32_16x16x32_bf16 a[116:119], a[220:223], v[196:199], a[116:119]
    ds_read_b128 a[140:143], v2 offset:3072
    v_cndmask_b32 v33, v8, v5, s[46:47]
    v_cvt_pk_bf16_f32 v214, v244, v245
    v_cndmask_b32 v34, v8, v5, s[48:49]
    v_cndmask_b32 v35, v8, v5, s[50:51]
    v_mfma_f32_16x16x32_bf16 a[120:123], a[220:223], v[200:203], a[120:123]
    v_exp_f32 v247, v183
    v_mfma_f32_16x16x32_bf16 a[124:127], a[220:223], v[204:207], a[124:127]
    s_waitcnt lgkmcnt(2)
    v_or3_b32 v57, v57, v213, v214
    v_cvt_pk_bf16_f32 v215, v246, v247
    v_mfma_f32_16x16x32_bf16 v[128:131], a[128:131], v[64:67], v[16:19]
    v_exp_f32 v232, v168
    v_mfma_f32_16x16x32_bf16 v[128:131], a[132:135], v[68:71], v[128:131]
    s_waitcnt lgkmcnt(0)
    buffer_store_dwordx4 a[228:231], v229, s[8:11], s58 offen offset:256 sc1
    ds_read_b128 a[144:147], v2 offset:4096
    v_mfma_f32_16x16x32_bf16 v[128:131], a[136:139], v[72:75], v[128:131]
    v_exp_f32 v233, v169
    v_mfma_f32_16x16x32_bf16 v[128:131], a[140:143], v[76:79], v[128:131]
    s_add_u32 s36, s36, 32
    v_exp_f32 v234, v170
    v_mfma_f32_16x16x32_bf16 v[132:135], a[128:131], v[80:83], v[20:23]
    ds_read_b128 a[148:151], v2 offset:5120
    v_cvt_pk_bf16_f32 v216, v232, v233
    v_mfma_f32_16x16x32_bf16 v[132:135], a[132:135], v[84:87], v[132:135]
    s_lshl_b32 s58, s61, 17
    v_exp_f32 v235, v171
    v_mfma_f32_16x16x32_bf16 v[132:135], a[136:139], v[88:91], v[132:135]
    s_add_u32 s52, s52, 8192
    v_or3_b32 v57, v57, v215, v216
    v_cvt_pk_bf16_f32 v217, v234, v235
    v_mfma_f32_16x16x32_bf16 v[132:135], a[140:143], v[92:95], v[132:135]
    v_exp_f32 v236, v184
    v_mfma_f32_16x16x32_bf16 v[136:139], a[128:131], v[96:99], v[24:27]
    s_lshl_b32 s60, s60, 10
    buffer_load_dwordx4 a[224:227], v228, s[12:15], s57 offen
    ds_read_b128 a[152:155], v2 offset:6144
    v_mfma_f32_16x16x32_bf16 v[136:139], a[132:135], v[100:103], v[136:139]
    s_and_b32 s52, s52, 0xffff
    v_exp_f32 v237, v185
    v_mfma_f32_16x16x32_bf16 v[136:139], a[136:139], v[104:107], v[136:139]
    v_exp_f32 v238, v186
    v_mfma_f32_16x16x32_bf16 v[136:139], a[140:143], v[108:111], v[136:139]
    ds_read_b128 a[156:159], v2 offset:7168
    v_cvt_pk_bf16_f32 v218, v236, v237
    v_mfma_f32_16x16x32_bf16 v[140:143], a[128:131], v[112:115], v[28:31]
    s_add_u32 s58, s58, s60
    v_exp_f32 v239, v187
    v_mfma_f32_16x16x32_bf16 v[140:143], a[132:135], v[116:119], v[140:143]
    v_or3_b32 v57, v57, v217, v218
    v_add_u32 v2, s52, v1
    v_mfma_f32_16x16x32_bf16 v[140:143], a[136:139], v[120:123], v[140:143]
    v_exp_f32 v240, v172
    v_mfma_f32_16x16x32_bf16 v[140:143], a[140:143], v[124:127], v[140:143]
    s_waitcnt lgkmcnt(2)
    ds_read_b128 a[192:195], v3 offset:0
    v_cvt_pk_bf16_f32 v219, v238, v239
    v_mfma_f32_16x16x32_bf16 v[144:147], a[144:147], v[64:67], v[32:35]
    s_mov_b32 s10, s59
    buffer_load_dwordx4 a[228:231], v228, s[12:15], s56 offen
    v_mfma_f32_16x16x32_bf16 v[144:147], a[148:151], v[68:71], v[144:147]
    s_waitcnt lgkmcnt(1)
    v_exp_f32 v241, v173
    v_mfma_f32_16x16x32_bf16 v[144:147], a[152:155], v[72:75], v[144:147]
    v_exp_f32 v242, v174
    v_mfma_f32_16x16x32_bf16 v[144:147], a[156:159], v[76:79], v[144:147]
    v_cvt_pk_bf16_f32 v220, v240, v241
    v_or3_b32 v57, v57, v219, v220
    v_mfma_f32_16x16x32_bf16 v[148:151], a[144:147], v[80:83], v[36:39]
    v_exp_f32 v243, v175
    v_mfma_f32_16x16x32_bf16 v[148:151], a[148:151], v[84:87], v[148:151]
    ds_read_b128 a[196:199], v3 offset:1024
    v_cvt_pk_bf16_f32 v221, v242, v243
    v_mfma_f32_16x16x32_bf16 v[148:151], a[152:155], v[88:91], v[148:151]
    v_exp_f32 v244, v188
    v_mfma_f32_16x16x32_bf16 v[148:151], a[156:159], v[92:95], v[148:151]
    buffer_load_dword v7, v230, s[24:27], s54 offen
    ds_read_b128 a[200:203], v3 offset:2048
    v_mfma_f32_16x16x32_bf16 v[152:155], a[144:147], v[96:99], v[40:43]
    v_exp_f32 v245, v189
    v_mfma_f32_16x16x32_bf16 v[152:155], a[148:151], v[100:103], v[152:155]
    v_exp_f32 v246, v190
    v_mfma_f32_16x16x32_bf16 v[152:155], a[152:155], v[104:107], v[152:155]
    v_cvt_pk_bf16_f32 v222, v244, v245
    v_or3_b32 v57, v57, v221, v222
    v_mfma_f32_16x16x32_bf16 v[152:155], a[156:159], v[108:111], v[152:155]
    v_exp_f32 v247, v191
    v_mfma_f32_16x16x32_bf16 v[156:159], a[144:147], v[112:115], v[44:47]
    s_add_u32 s54, s54, 4096
    ds_read_b128 a[204:207], v3 offset:3072
    v_cvt_pk_bf16_f32 v223, v246, v247
    v_mfma_f32_16x16x32_bf16 v[156:159], a[148:151], v[116:119], v[156:159]
    v_bitop3_b32 v57, v57, v223, s37 bitop3:0xa8
    v_cmp_ne_u32 vcc, 0, v57
    v_mfma_f32_16x16x32_bf16 v[156:159], a[152:155], v[120:123], v[156:159]
    v_mfma_f32_16x16x32_bf16 v[156:159], a[156:159], v[124:127], v[156:159]
    s_cbranch_vccnz k2_tramp_94
k2_ret_95:
    v_mfma_f32_16x16x32_bf16 v[12:15], v[60:63], v[208:211], v[12:15]
    v_exp_f32 v232, v128
    v_mfma_f32_16x16x32_bf16 v[48:51], v[60:63], v[212:215], v[48:51]
    s_mov_b32 m0, s35
    ds_read_b128 a[208:211], v3 offset:4096
    v_mfma_f32_16x16x32_bf16 v[248:251], v[60:63], v[216:219], v[248:251]
    s_add_u32 s53, s53, 8192
    buffer_load_dwordx4 v1, s[20:23], s33 offen offset:0 sc1 lds
    v_mfma_f32_16x16x32_bf16 v[252:255], v[60:63], v[220:223], v[252:255]
    s_waitcnt lgkmcnt(3)
    v_exp_f32 v233, v129
    v_mfma_f32_16x16x32_bf16 a[0:3], a[192:195], v[208:211], a[0:3]
    s_sub_u32 s40, s36, s38
    v_exp_f32 v234, v130
    v_mfma_f32_16x16x32_bf16 a[4:7], a[192:195], v[212:215], a[4:7]
    s_and_b32 s53, s53, 0xffff
    ds_read_b128 a[212:215], v3 offset:5120
    v_cvt_pk_bf16_f32 v192, v232, v233
    v_mfma_f32_16x16x32_bf16 a[8:11], a[192:195], v[216:219], a[8:11]
    v_subrev_u32 v6, s40, v4
    v_cmp_gt_i32 s[44:45], 0, v6
    v_mfma_f32_16x16x32_bf16 a[12:15], a[192:195], v[220:223], a[12:15]
    v_exp_f32 v235, v131
    v_mfma_f32_16x16x32_bf16 a[16:19], a[196:199], v[208:211], a[16:19]
    v_exp_f32 v236, v144
    v_mfma_f32_16x16x32_bf16 a[20:23], a[196:199], v[212:215], a[20:23]
    v_cmp_gt_i32 s[46:47], 1, v6
    v_cvt_pk_bf16_f32 v193, v234, v235
    v_mfma_f32_16x16x32_bf16 a[24:27], a[196:199], v[216:219], a[24:27]
    ds_read_b128 a[216:219], v3 offset:6144
    v_cmp_gt_i32 s[48:49], 2, v6
    v_mfma_f32_16x16x32_bf16 a[28:31], a[196:199], v[220:223], a[28:31]
    s_waitcnt lgkmcnt(3)
    v_exp_f32 v237, v145
    v_mfma_f32_16x16x32_bf16 a[32:35], a[200:203], v[208:211], a[32:35]
    v_cmp_gt_i32 s[50:51], 3, v6
    v_cvt_pk_bf16_f32 v194, v236, v237
    v_mfma_f32_16x16x32_bf16 a[36:39], a[200:203], v[212:215], a[36:39]
    v_exp_f32 v238, v146
    v_mfma_f32_16x16x32_bf16 a[40:43], a[200:203], v[216:219], a[40:43]
    ds_read_b128 a[220:223], v3 offset:7168
    v_cndmask_b32 v16, v8, v5, s[44:45]
    v_mfma_f32_16x16x32_bf16 a[44:47], a[200:203], v[220:223], a[44:47]
    s_add_u32 s35, s35, 0x4000
    v_exp_f32 v239, v147
    v_mfma_f32_16x16x32_bf16 a[48:51], a[204:207], v[208:211], a[48:51]
    v_or3_b32 v57, v192, v193, v194
    v_cndmask_b32 v17, v8, v5, s[46:47]
    v_mfma_f32_16x16x32_bf16 a[52:55], a[204:207], v[212:215], a[52:55]
    v_add_u32 v3, s53, v56
    v_cvt_pk_bf16_f32 v195, v238, v239
    v_mfma_f32_16x16x32_bf16 a[56:59], a[204:207], v[216:219], a[56:59]
    v_exp_f32 v240, v132
    v_mfma_f32_16x16x32_bf16 a[60:63], a[204:207], v[220:223], a[60:63]
    s_waitcnt lgkmcnt(2)
    ds_read_b128 a[128:131], v2 offset:0
    v_cndmask_b32 v18, v8, v5, s[48:49]
    v_mfma_f32_16x16x32_bf16 a[64:67], a[208:211], v[208:211], a[64:67]
    buffer_load_dwordx4 v1, s[20:23], s33 offen offset:1024 sc1 lds
    ds_read_b128 a[132:135], v2 offset:1024
    v_mfma_f32_16x16x32_bf16 a[68:71], a[208:211], v[212:215], a[68:71]
    v_exp_f32 v241, v133
    v_mfma_f32_16x16x32_bf16 a[72:75], a[208:211], v[216:219], a[72:75]
    v_cndmask_b32 v19, v8, v5, s[50:51]
    v_cmp_gt_i32 s[44:45], 16, v6
    v_mfma_f32_16x16x32_bf16 a[76:79], a[208:211], v[220:223], a[76:79]
    v_exp_f32 v242, v134
    v_mfma_f32_16x16x32_bf16 a[80:83], a[212:215], v[208:211], a[80:83]
    v_cvt_pk_bf16_f32 v196, v240, v241
    v_cmp_gt_i32 s[46:47], 17, v6
    v_mfma_f32_16x16x32_bf16 a[84:87], a[212:215], v[212:215], a[84:87]
    v_exp_f32 v243, v135
    v_mfma_f32_16x16x32_bf16 a[88:91], a[212:215], v[216:219], a[88:91]
    v_or3_b32 v57, v57, v195, v196
    v_cmp_gt_i32 s[48:49], 18, v6
    v_mfma_f32_16x16x32_bf16 a[92:95], a[212:215], v[220:223], a[92:95]
    s_waitcnt lgkmcnt(2)
    v_exp_f32 v244, v148
    v_mfma_f32_16x16x32_bf16 a[96:99], a[216:219], v[208:211], a[96:99]
    v_cvt_pk_bf16_f32 v197, v242, v243
    v_cmp_gt_i32 s[50:51], 19, v6
    v_mfma_f32_16x16x32_bf16 a[100:103], a[216:219], v[212:215], a[100:103]
    ds_read_b128 a[136:139], v2 offset:2048
    v_cndmask_b32 v32, v8, v5, s[44:45]
    v_mfma_f32_16x16x32_bf16 a[104:107], a[216:219], v[216:219], a[104:107]
    v_exp_f32 v245, v149
    v_mfma_f32_16x16x32_bf16 a[108:111], a[216:219], v[220:223], a[108:111]
    s_and_b32 s35, s35, 0xffff
    v_exp_f32 v246, v150
    v_mfma_f32_16x16x32_bf16 a[112:115], a[220:223], v[208:211], a[112:115]
    v_cndmask_b32 v33, v8, v5, s[46:47]
    v_cvt_pk_bf16_f32 v198, v244, v245
    v_mfma_f32_16x16x32_bf16 a[116:119], a[220:223], v[212:215], a[116:119]
    ds_read_b128 a[140:143], v2 offset:3072
    v_cndmask_b32 v34, v8, v5, s[48:49]
    v_cndmask_b32 v35, v8, v5, s[50:51]
    v_mfma_f32_16x16x32_bf16 a[120:123], a[220:223], v[216:219], a[120:123]
    v_exp_f32 v247, v151
    v_mfma_f32_16x16x32_bf16 a[124:127], a[220:223], v[220:223], a[124:127]
    s_waitcnt lgkmcnt(2)
    v_or3_b32 v57, v57, v197, v198
    v_cvt_pk_bf16_f32 v199, v246, v247
    v_mfma_f32_16x16x32_bf16 v[160:163], a[128:131], v[64:67], v[16:19]
    v_exp_f32 v232, v136
    v_mfma_f32_16x16x32_bf16 v[160:163], a[132:135], v[68:71], v[160:163]
    s_waitcnt lgkmcnt(0)
    buffer_load_dwordx4 v1, s[20:23], s33 offen offset:2048 sc1 lds
    ds_read_b128 a[144:147], v2 offset:4096
    v_mfma_f32_16x16x32_bf16 v[160:163], a[136:139], v[72:75], v[160:163]
    v_exp_f32 v233, v137
    v_mfma_f32_16x16x32_bf16 v[160:163], a[140:143], v[76:79], v[160:163]
    s_or_b32 s35, s35, 0x10000
    v_exp_f32 v234, v138
    v_mfma_f32_16x16x32_bf16 v[164:167], a[128:131], v[80:83], v[20:23]
    s_add_u32 s36, s36, 32
    ds_read_b128 a[148:151], v2 offset:5120
    v_cvt_pk_bf16_f32 v200, v232, v233
    v_mfma_f32_16x16x32_bf16 v[164:167], a[132:135], v[84:87], v[164:167]
    v_exp_f32 v235, v139
    v_mfma_f32_16x16x32_bf16 v[164:167], a[136:139], v[88:91], v[164:167]
    s_add_u32 s52, s52, 8192
    v_or3_b32 v57, v57, v199, v200
    v_cvt_pk_bf16_f32 v201, v234, v235
    v_mfma_f32_16x16x32_bf16 v[164:167], a[140:143], v[92:95], v[164:167]
    v_exp_f32 v236, v152
    v_mfma_f32_16x16x32_bf16 v[168:171], a[128:131], v[96:99], v[24:27]
    s_and_b32 s52, s52, 0xffff
    ds_read_b128 a[152:155], v2 offset:6144
    ds_read_b128 a[156:159], v2 offset:7168
    v_mfma_f32_16x16x32_bf16 v[168:171], a[132:135], v[100:103], v[168:171]
    v_exp_f32 v237, v153
    v_mfma_f32_16x16x32_bf16 v[168:171], a[136:139], v[104:107], v[168:171]
    v_exp_f32 v238, v154
    v_mfma_f32_16x16x32_bf16 v[168:171], a[140:143], v[108:111], v[168:171]
    v_cvt_pk_bf16_f32 v202, v236, v237
    v_or3_b32 v57, v57, v201, v202
    v_mfma_f32_16x16x32_bf16 v[172:175], a[128:131], v[112:115], v[28:31]
    v_exp_f32 v239, v155
    v_mfma_f32_16x16x32_bf16 v[172:175], a[132:135], v[116:119], v[172:175]
    v_add_u32 v2, s52, v1
    v_cvt_pk_bf16_f32 v203, v238, v239
    v_mfma_f32_16x16x32_bf16 v[172:175], a[136:139], v[120:123], v[172:175]
    v_exp_f32 v240, v140
    v_mfma_f32_16x16x32_bf16 v[172:175], a[140:143], v[124:127], v[172:175]
    s_waitcnt lgkmcnt(2)
    buffer_load_dwordx4 v1, s[20:23], s33 offen offset:3072 sc1 lds
    s_add_u32 s33, s33, 0x80000
    v_mfma_f32_16x16x32_bf16 v[176:179], a[144:147], v[64:67], v[32:35]
    v_exp_f32 v241, v141
    v_mfma_f32_16x16x32_bf16 v[176:179], a[148:151], v[68:71], v[176:179]
    s_waitcnt lgkmcnt(0)
    ds_read_b128 a[192:195], v3 offset:0
    v_cvt_pk_bf16_f32 v204, v240, v241
    v_mfma_f32_16x16x32_bf16 v[176:179], a[152:155], v[72:75], v[176:179]
    v_exp_f32 v242, v142
    v_mfma_f32_16x16x32_bf16 v[176:179], a[156:159], v[76:79], v[176:179]
    v_exp_f32 v243, v143
    v_mfma_f32_16x16x32_bf16 v[180:183], a[144:147], v[80:83], v[36:39]
    ds_read_b128 a[196:199], v3 offset:1024
    v_or3_b32 v57, v57, v203, v204
    v_mfma_f32_16x16x32_bf16 v[180:183], a[148:151], v[84:87], v[180:183]
    v_exp_f32 v244, v156
    v_mfma_f32_16x16x32_bf16 v[180:183], a[152:155], v[88:91], v[180:183]
    ds_read_b128 a[200:203], v3 offset:2048
    v_cvt_pk_bf16_f32 v205, v242, v243
    v_mfma_f32_16x16x32_bf16 v[180:183], a[156:159], v[92:95], v[180:183]
    v_exp_f32 v245, v157
    v_mfma_f32_16x16x32_bf16 v[184:187], a[144:147], v[96:99], v[40:43]
    v_exp_f32 v246, v158
    v_mfma_f32_16x16x32_bf16 v[184:187], a[148:151], v[100:103], v[184:187]
    v_cvt_pk_bf16_f32 v206, v244, v245
    v_or3_b32 v57, v57, v205, v206
    v_mfma_f32_16x16x32_bf16 v[184:187], a[152:155], v[104:107], v[184:187]
    v_exp_f32 v247, v159
    v_mfma_f32_16x16x32_bf16 v[184:187], a[156:159], v[108:111], v[184:187]
    ds_read_b128 a[204:207], v3 offset:3072
    v_cvt_pk_bf16_f32 v207, v246, v247
    v_mfma_f32_16x16x32_bf16 v[188:191], a[144:147], v[112:115], v[44:47]
    v_mfma_f32_16x16x32_bf16 v[188:191], a[148:151], v[116:119], v[188:191]
    v_bitop3_b32 v57, v57, v207, s37 bitop3:0xa8
    v_cmp_ne_u32 vcc, 0, v57
    v_mfma_f32_16x16x32_bf16 v[188:191], a[152:155], v[120:123], v[188:191]
    v_mfma_f32_16x16x32_bf16 v[188:191], a[156:159], v[124:127], v[188:191]
    s_waitcnt vmcnt(13)
    s_barrier
    s_cbranch_vccnz k2_tramp_96
k2_ret_97:
k2_dm3_89:
    v_mfma_f32_16x16x32_bf16 v[12:15], v[60:63], v[192:195], v[12:15]
    v_exp_f32 v232, v160
    v_mfma_f32_16x16x32_bf16 v[48:51], v[60:63], v[196:199], v[48:51]
    s_mov_b32 m0, s34
    ds_read_b128 a[208:211], v3 offset:4096
    v_mfma_f32_16x16x32_bf16 v[248:251], v[60:63], v[200:203], v[248:251]
    s_add_u32 s53, s53, 8192
    v_exp_f32 v233, v161
    v_mfma_f32_16x16x32_bf16 v[252:255], v[60:63], v[204:207], v[252:255]
    s_waitcnt lgkmcnt(3)
    buffer_load_dwordx4 v1, s[16:19], s32 offen offset:0 sc1 lds
    v_mfma_f32_16x16x32_bf16 a[0:3], a[192:195], v[192:195], a[0:3]
    s_sub_u32 s40, s36, s38
    s_sub_u32 s40, s40, 64
    v_exp_f32 v234, v162
    v_cvt_pk_bf16_f32 v208, v232, v233
    v_mfma_f32_16x16x32_bf16 a[4:7], a[192:195], v[196:199], a[4:7]
    s_and_b32 s53, s53, 0xffff
    ds_read_b128 a[212:215], v3 offset:5120
    v_subrev_u32 v6, s40, v4
    v_mfma_f32_16x16x32_bf16 a[8:11], a[192:195], v[200:203], a[8:11]
    s_add_u32 s34, s34, 0x4000
    v_exp_f32 v235, v163
    v_cmp_gt_i32 s[44:45], 0, v6
    v_mfma_f32_16x16x32_bf16 a[12:15], a[192:195], v[204:207], a[12:15]
    v_exp_f32 v236, v176
    v_cvt_pk_bf16_f32 v209, v234, v235
    v_mfma_f32_16x16x32_bf16 a[16:19], a[196:199], v[192:195], a[16:19]
    buffer_load_dwordx4 v1, s[16:19], s32 offen offset:1024 sc1 lds
    ds_read_b128 a[216:219], v3 offset:6144
    v_mfma_f32_16x16x32_bf16 a[20:23], a[196:199], v[196:199], a[20:23]
    v_cmp_gt_i32 s[46:47], 1, v6
    v_exp_f32 v237, v177
    v_mfma_f32_16x16x32_bf16 a[24:27], a[196:199], v[200:203], a[24:27]
    v_cmp_gt_i32 s[48:49], 2, v6
    v_exp_f32 v238, v178
    v_mfma_f32_16x16x32_bf16 a[28:31], a[196:199], v[204:207], a[28:31]
    s_waitcnt lgkmcnt(3)
    v_cvt_pk_bf16_f32 v210, v236, v237
    v_cmp_gt_i32 s[50:51], 3, v6
    v_mfma_f32_16x16x32_bf16 a[32:35], a[200:203], v[192:195], a[32:35]
    s_and_b32 s34, s34, 0xffff
    v_exp_f32 v239, v179
    v_mfma_f32_16x16x32_bf16 a[36:39], a[200:203], v[196:199], a[36:39]
    s_and_b32 s60, s62, 31
    ds_read_b128 a[220:223], v3 offset:7168
    v_or3_b32 v57, v208, v209, v210
    v_cndmask_b32 v20, v9, v5, s[44:45]
    v_mfma_f32_16x16x32_bf16 a[40:43], a[200:203], v[200:203], a[40:43]
    buffer_load_dwordx4 v1, s[16:19], s32 offen offset:2048 sc1 lds
    v_mfma_f32_16x16x32_bf16 a[44:47], a[200:203], v[204:207], a[44:47]
    s_lshr_b32 s61, s62, 5
    v_exp_f32 v240, v164
    v_cvt_pk_bf16_f32 v211, v238, v239
    v_mfma_f32_16x16x32_bf16 a[48:51], a[204:207], v[192:195], a[48:51]
    v_cndmask_b32 v21, v9, v5, s[46:47]
    v_add_u32 v3, s53, v56
    v_mfma_f32_16x16x32_bf16 a[52:55], a[204:207], v[196:199], a[52:55]
    s_mul_i32 s57, s60, 229376
    v_exp_f32 v241, v165
    v_mfma_f32_16x16x32_bf16 a[56:59], a[204:207], v[200:203], a[56:59]
    ds_read_b128 a[128:131], v2 offset:0
    v_cndmask_b32 v22, v9, v5, s[48:49]
    v_cvt_pk_bf16_f32 v212, v240, v241
    v_mfma_f32_16x16x32_bf16 a[60:63], a[204:207], v[204:207], a[60:63]
    s_waitcnt lgkmcnt(3)
    v_exp_f32 v242, v166
    v_mfma_f32_16x16x32_bf16 a[64:67], a[208:211], v[192:195], a[64:67]
    s_lshl_b32 s4, s61, 7
    v_cndmask_b32 v23, v9, v5, s[50:51]
    v_or3_b32 v57, v57, v211, v212
    v_mfma_f32_16x16x32_bf16 a[68:71], a[208:211], v[196:199], a[68:71]
    buffer_load_dwordx4 v1, s[16:19], s32 offen offset:3072 sc1 lds
    ds_read_b128 a[132:135], v2 offset:1024
    s_add_u32 s32, s32, 0x80000
    v_mfma_f32_16x16x32_bf16 a[72:75], a[208:211], v[200:203], a[72:75]
    v_exp_f32 v243, v167
    v_mfma_f32_16x16x32_bf16 a[76:79], a[208:211], v[204:207], a[76:79]
    s_add_u32 s57, s57, s4
    v_cmp_gt_i32 s[44:45], 16, v6
    v_cvt_pk_bf16_f32 v213, v242, v243
    v_mfma_f32_16x16x32_bf16 a[80:83], a[212:215], v[192:195], a[80:83]
    s_waitcnt vmcnt(8)
    v_exp_f32 v244, v180
    v_mfma_f32_16x16x32_bf16 a[84:87], a[212:215], v[196:199], a[84:87]
    s_add_u32 s56, s57, 57344
    ds_read_b128 a[136:139], v2 offset:2048
    v_cmp_gt_i32 s[46:47], 17, v6
    v_mfma_f32_16x16x32_bf16 a[88:91], a[212:215], v[200:203], a[88:91]
    v_exp_f32 v245, v181
    v_cmp_gt_i32 s[48:49], 18, v6
    v_mfma_f32_16x16x32_bf16 a[92:95], a[212:215], v[204:207], a[92:95]
    s_waitcnt lgkmcnt(3)
    v_exp_f32 v246, v182
    v_mfma_f32_16x16x32_bf16 a[96:99], a[216:219], v[192:195], a[96:99]
    s_add_u32 s62, s62, 1
    v_cmp_gt_i32 s[50:51], 19, v6
    v_cvt_pk_bf16_f32 v214, v244, v245
    v_mfma_f32_16x16x32_bf16 a[100:103], a[216:219], v[196:199], a[100:103]
    buffer_store_dwordx4 a[224:227], v229, s[8:11], s58 offen offset:0 sc1
    ds_read_b128 a[140:143], v2 offset:3072
    ds_read_b128 a[144:147], v2 offset:4096
    v_mfma_f32_16x16x32_bf16 a[104:107], a[216:219], v[200:203], a[104:107]
    v_exp_f32 v247, v183
    v_mfma_f32_16x16x32_bf16 a[108:111], a[216:219], v[204:207], a[108:111]
    v_cndmask_b32 v36, v9, v5, s[44:45]
    v_or3_b32 v57, v57, v213, v214
    v_mfma_f32_16x16x32_bf16 a[112:115], a[220:223], v[192:195], a[112:115]
    v_exp_f32 v232, v168
    v_mfma_f32_16x16x32_bf16 a[116:119], a[220:223], v[196:199], a[116:119]
    v_cndmask_b32 v37, v9, v5, s[46:47]
    v_cvt_pk_bf16_f32 v215, v246, v247
    v_cndmask_b32 v38, v9, v5, s[48:49]
    v_cndmask_b32 v39, v9, v5, s[50:51]
    v_mfma_f32_16x16x32_bf16 a[120:123], a[220:223], v[200:203], a[120:123]
    v_exp_f32 v233, v169
    v_mfma_f32_16x16x32_bf16 a[124:127], a[220:223], v[204:207], a[124:127]
    s_waitcnt lgkmcnt(3)
    buffer_store_dwordx4 a[228:231], v229, s[8:11], s58 offen offset:256 sc1
    v_exp_f32 v234, v170
    v_mfma_f32_16x16x32_bf16 v[132:135], a[128:131], v[80:83], v[20:23]
    ds_read_b128 a[148:151], v2 offset:5120
    v_cvt_pk_bf16_f32 v216, v232, v233
    v_mfma_f32_16x16x32_bf16 v[132:135], a[132:135], v[84:87], v[132:135]
    s_waitcnt lgkmcnt(2)
    v_exp_f32 v235, v171
    v_mfma_f32_16x16x32_bf16 v[132:135], a[136:139], v[88:91], v[132:135]
    s_lshl_b32 s58, s61, 17
    ds_read_b128 a[152:155], v2 offset:6144
    v_or3_b32 v57, v57, v215, v216
    v_mfma_f32_16x16x32_bf16 v[132:135], a[140:143], v[92:95], v[132:135]
    s_add_u32 s36, s36, 32
    v_exp_f32 v236, v184
    v_mfma_f32_16x16x32_bf16 v[136:139], a[128:131], v[96:99], v[24:27]
    s_lshl_b32 s60, s60, 10
    v_cvt_pk_bf16_f32 v217, v234, v235
    v_exp_f32 v237, v185
    v_mfma_f32_16x16x32_bf16 v[136:139], a[132:135], v[100:103], v[136:139]
    buffer_load_dwordx4 a[224:227], v228, s[12:15], s57 offen
    ds_read_b128 a[156:159], v2 offset:7168
    v_mfma_f32_16x16x32_bf16 v[136:139], a[136:139], v[104:107], v[136:139]
    s_add_u32 s52, s52, 8192
    v_exp_f32 v238, v186
    v_mfma_f32_16x16x32_bf16 v[136:139], a[140:143], v[108:111], v[136:139]
    s_add_u32 s58, s58, s60
    v_cvt_pk_bf16_f32 v218, v236, v237
    v_or3_b32 v57, v57, v217, v218
    v_mfma_f32_16x16x32_bf16 v[140:143], a[128:131], v[112:115], v[28:31]
    s_and_b32 s52, s52, 0xffff
    v_exp_f32 v239, v187
    v_mfma_f32_16x16x32_bf16 v[140:143], a[132:135], v[116:119], v[140:143]
    v_add_u32 v2, s52, v1
    v_cvt_pk_bf16_f32 v219, v238, v239
    v_mfma_f32_16x16x32_bf16 v[140:143], a[136:139], v[120:123], v[140:143]
    s_mov_b32 s10, s59
    v_exp_f32 v240, v172
    v_mfma_f32_16x16x32_bf16 v[140:143], a[140:143], v[124:127], v[140:143]
    s_waitcnt lgkmcnt(2)
    ds_read_b128 a[192:195], v3 offset:0
    v_exp_f32 v241, v173
    v_mfma_f32_16x16x32_bf16 v[148:151], a[144:147], v[80:83], v[36:39]
    buffer_load_dwordx4 a[228:231], v228, s[12:15], s56 offen
    ds_read_b128 a[196:199], v3 offset:1024
    v_mfma_f32_16x16x32_bf16 v[148:151], a[148:151], v[84:87], v[148:151]
    s_waitcnt lgkmcnt(2)
    v_exp_f32 v242, v174
    v_mfma_f32_16x16x32_bf16 v[148:151], a[152:155], v[88:91], v[148:151]
    v_cvt_pk_bf16_f32 v220, v240, v241
    v_or3_b32 v57, v57, v219, v220
    v_mfma_f32_16x16x32_bf16 v[148:151], a[156:159], v[92:95], v[148:151]
    v_exp_f32 v243, v175
    v_mfma_f32_16x16x32_bf16 v[152:155], a[144:147], v[96:99], v[40:43]
    v_exp_f32 v244, v188
    v_mfma_f32_16x16x32_bf16 v[152:155], a[148:151], v[100:103], v[152:155]
    v_cvt_pk_bf16_f32 v221, v242, v243
    v_exp_f32 v245, v189
    v_mfma_f32_16x16x32_bf16 v[152:155], a[152:155], v[104:107], v[152:155]
    buffer_load_dword v7, v230, s[24:27], s54 offen
    ds_read_b128 a[200:203], v3 offset:2048
    v_mfma_f32_16x16x32_bf16 v[152:155], a[156:159], v[108:111], v[152:155]
    v_exp_f32 v246, v190
    v_mfma_f32_16x16x32_bf16 v[156:159], a[144:147], v[112:115], v[44:47]
    s_add_u32 s54, s54, 4096
    v_cvt_pk_bf16_f32 v222, v244, v245
    v_or3_b32 v57, v57, v221, v222
    v_mfma_f32_16x16x32_bf16 v[156:159], a[148:151], v[116:119], v[156:159]
    v_exp_f32 v247, v191
    v_mfma_f32_16x16x32_bf16 v[156:159], a[152:155], v[120:123], v[156:159]
    ds_read_b128 a[204:207], v3 offset:3072
    v_cvt_pk_bf16_f32 v223, v246, v247
    v_bitop3_b32 v57, v57, v223, s37 bitop3:0xa8
    v_mfma_f32_16x16x32_bf16 v[156:159], a[156:159], v[124:127], v[156:159]
    v_cmp_ne_u32 vcc, 0, v57
    s_cbranch_vccnz k2_tramp_98
k2_ret_99:
    v_mfma_f32_16x16x32_bf16 v[12:15], v[60:63], v[208:211], v[12:15]
    v_exp_f32 v232, v132
    v_mfma_f32_16x16x32_bf16 v[48:51], v[60:63], v[212:215], v[48:51]
    s_mov_b32 m0, s35
    ds_read_b128 a[208:211], v3 offset:4096
    v_mfma_f32_16x16x32_bf16 v[248:251], v[60:63], v[216:219], v[248:251]
    s_add_u32 s53, s53, 8192
    buffer_load_dwordx4 v1, s[20:23], s33 offen offset:0 sc1 lds
    v_mfma_f32_16x16x32_bf16 v[252:255], v[60:63], v[220:223], v[252:255]
    s_waitcnt lgkmcnt(3)
    v_exp_f32 v233, v133
    v_mfma_f32_16x16x32_bf16 a[0:3], a[192:195], v[208:211], a[0:3]
    s_sub_u32 s40, s36, s38
    s_sub_u32 s40, s40, 64
    v_exp_f32 v234, v134
    v_mfma_f32_16x16x32_bf16 a[4:7], a[192:195], v[212:215], a[4:7]
    s_and_b32 s53, s53, 0xffff
    ds_read_b128 a[212:215], v3 offset:5120
    v_subrev_u32 v6, s40, v4
    v_mfma_f32_16x16x32_bf16 a[8:11], a[192:195], v[216:219], a[8:11]
    v_cvt_pk_bf16_f32 v196, v232, v233
    v_cmp_gt_i32 s[44:45], 0, v6
    v_mfma_f32_16x16x32_bf16 a[12:15], a[192:195], v[220:223], a[12:15]
    v_exp_f32 v235, v135
    v_mfma_f32_16x16x32_bf16 a[16:19], a[196:199], v[208:211], a[16:19]
    ds_read_b128 a[216:219], v3 offset:6144
    v_cmp_gt_i32 s[46:47], 1, v6
    v_mfma_f32_16x16x32_bf16 a[20:23], a[196:199], v[212:215], a[20:23]
    v_exp_f32 v236, v148
    v_mfma_f32_16x16x32_bf16 a[24:27], a[196:199], v[216:219], a[24:27]
    v_cvt_pk_bf16_f32 v197, v234, v235
    v_cmp_gt_i32 s[48:49], 2, v6
    v_mfma_f32_16x16x32_bf16 a[28:31], a[196:199], v[220:223], a[28:31]
    s_waitcnt lgkmcnt(3)
    v_cmp_gt_i32 s[50:51], 3, v6
    v_mfma_f32_16x16x32_bf16 a[32:35], a[200:203], v[208:211], a[32:35]
    v_exp_f32 v237, v149
    v_mfma_f32_16x16x32_bf16 a[36:39], a[200:203], v[212:215], a[36:39]
    s_add_u32 s35, s35, 0x4000
    ds_read_b128 a[220:223], v3 offset:7168
    v_cndmask_b32 v20, v9, v5, s[44:45]
    v_mfma_f32_16x16x32_bf16 a[40:43], a[200:203], v[216:219], a[40:43]
    v_exp_f32 v238, v150
    v_mfma_f32_16x16x32_bf16 a[44:47], a[200:203], v[220:223], a[44:47]
    v_cvt_pk_bf16_f32 v198, v236, v237
    v_cndmask_b32 v21, v9, v5, s[46:47]
    v_mfma_f32_16x16x32_bf16 a[48:51], a[204:207], v[208:211], a[48:51]
    buffer_load_dwordx4 v1, s[20:23], s33 offen offset:1024 sc1 lds
    ds_read_b128 a[128:131], v2 offset:0
    v_mfma_f32_16x16x32_bf16 a[52:55], a[204:207], v[212:215], a[52:55]
    v_add_u32 v3, s53, v56
    v_cndmask_b32 v22, v9, v5, s[48:49]
    v_mfma_f32_16x16x32_bf16 a[56:59], a[204:207], v[216:219], a[56:59]
    v_exp_f32 v239, v151
    v_mfma_f32_16x16x32_bf16 a[60:63], a[204:207], v[220:223], a[60:63]
    s_waitcnt lgkmcnt(3)
    v_or3_b32 v57, v196, v197, v198
    v_cndmask_b32 v23, v9, v5, s[50:51]
    v_mfma_f32_16x16x32_bf16 a[64:67], a[208:211], v[208:211], a[64:67]
    v_exp_f32 v240, v136
    v_mfma_f32_16x16x32_bf16 a[68:71], a[208:211], v[212:215], a[68:71]
    v_cvt_pk_bf16_f32 v199, v238, v239
    v_cmp_gt_i32 s[44:45], 16, v6
    v_mfma_f32_16x16x32_bf16 a[72:75], a[208:211], v[216:219], a[72:75]
    ds_read_b128 a[132:135], v2 offset:1024
    v_cmp_gt_i32 s[46:47], 17, v6
    v_mfma_f32_16x16x32_bf16 a[76:79], a[208:211], v[220:223], a[76:79]
    v_exp_f32 v241, v137
    v_mfma_f32_16x16x32_bf16 a[80:83], a[212:215], v[208:211], a[80:83]
    ds_read_b128 a[136:139], v2 offset:2048
    v_cmp_gt_i32 s[48:49], 18, v6
    v_mfma_f32_16x16x32_bf16 a[84:87], a[212:215], v[212:215], a[84:87]
    v_exp_f32 v242, v138
    v_mfma_f32_16x16x32_bf16 a[88:91], a[212:215], v[216:219], a[88:91]
    v_cvt_pk_bf16_f32 v200, v240, v241
    v_cmp_gt_i32 s[50:51], 19, v6
    v_mfma_f32_16x16x32_bf16 a[92:95], a[212:215], v[220:223], a[92:95]
    s_waitcnt lgkmcnt(3)
    v_exp_f32 v243, v139
    v_mfma_f32_16x16x32_bf16 a[96:99], a[216:219], v[208:211], a[96:99]
    s_and_b32 s35, s35, 0xffff
    ds_read_b128 a[140:143], v2 offset:3072
    v_or3_b32 v57, v57, v199, v200
    v_mfma_f32_16x16x32_bf16 a[100:103], a[216:219], v[212:215], a[100:103]
    v_cndmask_b32 v36, v9, v5, s[44:45]
    v_cndmask_b32 v37, v9, v5, s[46:47]
    v_mfma_f32_16x16x32_bf16 a[104:107], a[216:219], v[216:219], a[104:107]
    v_exp_f32 v244, v152
    v_mfma_f32_16x16x32_bf16 a[108:111], a[216:219], v[220:223], a[108:111]
    ds_read_b128 a[144:147], v2 offset:4096
    v_cvt_pk_bf16_f32 v201, v242, v243
    v_mfma_f32_16x16x32_bf16 a[112:115], a[220:223], v[208:211], a[112:115]
    buffer_load_dwordx4 v1, s[20:23], s33 offen offset:2048 sc1 lds
    ds_read_b128 a[148:151], v2 offset:5120
    v_mfma_f32_16x16x32_bf16 a[116:119], a[220:223], v[212:215], a[116:119]
    v_cndmask_b32 v38, v9, v5, s[48:49]
    v_cndmask_b32 v39, v9, v5, s[50:51]
    v_mfma_f32_16x16x32_bf16 a[120:123], a[220:223], v[216:219], a[120:123]
    s_or_b32 s35, s35, 0x10000
    v_exp_f32 v245, v153
    v_mfma_f32_16x16x32_bf16 a[124:127], a[220:223], v[220:223], a[124:127]
    s_waitcnt lgkmcnt(4)
    v_exp_f32 v246, v154
    v_mfma_f32_16x16x32_bf16 v[164:167], a[128:131], v[80:83], v[20:23]
    ds_read_b128 a[152:155], v2 offset:6144
    v_cvt_pk_bf16_f32 v202, v244, v245
    v_mfma_f32_16x16x32_bf16 v[164:167], a[132:135], v[84:87], v[164:167]
    s_waitcnt lgkmcnt(3)
    v_exp_f32 v247, v155
    v_mfma_f32_16x16x32_bf16 v[164:167], a[136:139], v[88:91], v[164:167]
    v_or3_b32 v57, v57, v201, v202
    v_cvt_pk_bf16_f32 v203, v246, v247
    v_mfma_f32_16x16x32_bf16 v[164:167], a[140:143], v[92:95], v[164:167]
    s_add_u32 s36, s36, 32
    v_exp_f32 v232, v140
    v_mfma_f32_16x16x32_bf16 v[168:171], a[128:131], v[96:99], v[24:27]
    ds_read_b128 a[156:159], v2 offset:7168
    v_mfma_f32_16x16x32_bf16 v[168:171], a[132:135], v[100:103], v[168:171]
    v_exp_f32 v233, v141
    v_mfma_f32_16x16x32_bf16 v[168:171], a[136:139], v[104:107], v[168:171]
    s_add_u32 s52, s52, 8192
    v_exp_f32 v234, v142
    v_mfma_f32_16x16x32_bf16 v[168:171], a[140:143], v[108:111], v[168:171]
    ds_read_b128 a[192:195], v3 offset:0
    v_cvt_pk_bf16_f32 v204, v232, v233
    v_mfma_f32_16x16x32_bf16 v[172:175], a[128:131], v[112:115], v[28:31]
    s_and_b32 s52, s52, 0xffff
    v_add_u32 v2, s52, v1
    v_or3_b32 v57, v57, v203, v204
    v_mfma_f32_16x16x32_bf16 v[172:175], a[132:135], v[116:119], v[172:175]
    buffer_load_dwordx4 v1, s[20:23], s33 offen offset:3072 sc1 lds
    s_add_u32 s33, s33, 0x80000
    v_mfma_f32_16x16x32_bf16 v[172:175], a[136:139], v[120:123], v[172:175]
    v_exp_f32 v235, v143
    v_mfma_f32_16x16x32_bf16 v[172:175], a[140:143], v[124:127], v[172:175]
    s_waitcnt lgkmcnt(3)
    v_exp_f32 v236, v156
    v_mfma_f32_16x16x32_bf16 v[180:183], a[144:147], v[80:83], v[36:39]
    ds_read_b128 a[196:199], v3 offset:1024
    v_cvt_pk_bf16_f32 v205, v234, v235
    v_mfma_f32_16x16x32_bf16 v[180:183], a[148:151], v[84:87], v[180:183]
    s_waitcnt lgkmcnt(2)
    v_exp_f32 v237, v157
    v_mfma_f32_16x16x32_bf16 v[180:183], a[152:155], v[88:91], v[180:183]
    ds_read_b128 a[200:203], v3 offset:2048
    v_mfma_f32_16x16x32_bf16 v[180:183], a[156:159], v[92:95], v[180:183]
    v_exp_f32 v238, v158
    v_mfma_f32_16x16x32_bf16 v[184:187], a[144:147], v[96:99], v[40:43]
    v_cvt_pk_bf16_f32 v206, v236, v237
    v_mfma_f32_16x16x32_bf16 v[184:187], a[148:151], v[100:103], v[184:187]
    v_exp_f32 v239, v159
    v_mfma_f32_16x16x32_bf16 v[184:187], a[152:155], v[104:107], v[184:187]
    ds_read_b128 a[204:207], v3 offset:3072
    v_or3_b32 v57, v57, v205, v206
    v_mfma_f32_16x16x32_bf16 v[184:187], a[156:159], v[108:111], v[184:187]
    v_cvt_pk_bf16_f32 v207, v238, v239
    v_mfma_f32_16x16x32_bf16 v[188:191], a[144:147], v[112:115], v[44:47]
    v_mfma_f32_16x16x32_bf16 v[188:191], a[148:151], v[116:119], v[188:191]
    v_bitop3_b32 v57, v57, v207, s37 bitop3:0xa8
    v_cmp_ne_u32 vcc, 0, v57
    v_mfma_f32_16x16x32_bf16 v[188:191], a[152:155], v[120:123], v[188:191]
    v_mfma_f32_16x16x32_bf16 v[188:191], a[156:159], v[124:127], v[188:191]
    s_waitcnt vmcnt(13)
    s_barrier
    s_cbranch_vccnz k2_tramp_100
k2_ret_101:
    v_mfma_f32_16x16x32_bf16 v[48:51], v[60:63], v[196:199], v[48:51]
    ds_read_b128 a[208:211], v3 offset:4096
    ds_read_b128 a[212:215], v3 offset:5120
    v_mfma_f32_16x16x32_bf16 v[248:251], v[60:63], v[200:203], v[248:251]
    s_mov_b32 m0, s34
    v_exp_f32 v232, v164
    v_mfma_f32_16x16x32_bf16 v[252:255], v[60:63], v[204:207], v[252:255]
    s_waitcnt lgkmcnt(4)
    buffer_load_dwordx4 v1, s[16:19], s32 offen offset:0 sc1 lds
    ds_read_b128 a[216:219], v3 offset:6144
    v_mfma_f32_16x16x32_bf16 a[4:7], a[192:195], v[196:199], a[4:7]
    s_add_u32 s53, s53, 8192
    v_exp_f32 v233, v165
    v_mfma_f32_16x16x32_bf16 a[8:11], a[192:195], v[200:203], a[8:11]
    s_and_b32 s53, s53, 0xffff
    v_mov_b32 v16, v10
    v_mov_b32 v17, v10
    v_mfma_f32_16x16x32_bf16 a[12:15], a[192:195], v[204:207], a[12:15]
    s_add_u32 s34, s34, 0x4000
    v_exp_f32 v234, v166
    v_mfma_f32_16x16x32_bf16 a[20:23], a[196:199], v[196:199], a[20:23]
    ds_read_b128 a[220:223], v3 offset:7168
    v_cvt_pk_bf16_f32 v212, v232, v233
    v_mfma_f32_16x16x32_bf16 a[24:27], a[196:199], v[200:203], a[24:27]
    v_mov_b32 v18, v10
    v_mov_b32 v19, v10
    v_mfma_f32_16x16x32_bf16 a[28:31], a[196:199], v[204:207], a[28:31]
    s_waitcnt lgkmcnt(4)
    v_exp_f32 v235, v167
    v_mfma_f32_16x16x32_bf16 a[36:39], a[200:203], v[196:199], a[36:39]
    buffer_load_dwordx4 v1, s[16:19], s32 offen offset:1024 sc1 lds
    ds_read_b128 a[128:131], v2 offset:0
    v_mfma_f32_16x16x32_bf16 a[40:43], a[200:203], v[200:203], a[40:43]
    v_mov_b32 v20, v11
    v_add_u32 v3, s53, v56
    v_mfma_f32_16x16x32_bf16 a[44:47], a[200:203], v[204:207], a[44:47]
    s_and_b32 s34, s34, 0xffff
    v_mov_b32 v21, v11
    v_mov_b32 v22, v11
    v_mfma_f32_16x16x32_bf16 a[52:55], a[204:207], v[196:199], a[52:55]
    v_exp_f32 v236, v180
    v_mfma_f32_16x16x32_bf16 a[56:59], a[204:207], v[200:203], a[56:59]
    ds_read_b128 a[132:135], v2 offset:1024
    v_cvt_pk_bf16_f32 v213, v234, v235
    v_mfma_f32_16x16x32_bf16 a[60:63], a[204:207], v[204:207], a[60:63]
    s_waitcnt lgkmcnt(4)
    v_mov_b32 v23, v11
    v_mov_b32 v32, v10
    v_mfma_f32_16x16x32_bf16 a[68:71], a[208:211], v[196:199], a[68:71]
    v_exp_f32 v237, v181
    v_mfma_f32_16x16x32_bf16 a[72:75], a[208:211], v[200:203], a[72:75]
    ds_read_b128 a[136:139], v2 offset:2048
    v_mov_b32 v33, v10
    v_mfma_f32_16x16x32_bf16 a[76:79], a[208:211], v[204:207], a[76:79]
    buffer_load_dwordx4 v1, s[16:19], s32 offen offset:2048 sc1 lds
    v_mov_b32 v34, v10
    v_mfma_f32_16x16x32_bf16 a[84:87], a[212:215], v[196:199], a[84:87]
    v_exp_f32 v238, v182
    v_mfma_f32_16x16x32_bf16 a[88:91], a[212:215], v[200:203], a[88:91]
    ds_read_b128 a[140:143], v2 offset:3072
    v_cvt_pk_bf16_f32 v214, v236, v237
    v_mfma_f32_16x16x32_bf16 a[92:95], a[212:215], v[204:207], a[92:95]
    s_waitcnt lgkmcnt(4)
    v_mov_b32 v35, v10
    v_mov_b32 v36, v11
    v_mfma_f32_16x16x32_bf16 a[100:103], a[216:219], v[196:199], a[100:103]
    ds_read_b128 a[144:147], v2 offset:4096
    v_exp_f32 v239, v183
    v_mfma_f32_16x16x32_bf16 a[104:107], a[216:219], v[200:203], a[104:107]
    v_mov_b32 v37, v11
    v_or3_b32 v57, v212, v213, v214
    v_mov_b32 v38, v11
    v_mov_b32 v39, v11
    v_mfma_f32_16x16x32_bf16 a[108:111], a[216:219], v[204:207], a[108:111]
    buffer_load_dwordx4 v1, s[16:19], s32 offen offset:3072 sc1 lds
    ds_read_b128 a[148:151], v2 offset:5120
    v_mfma_f32_16x16x32_bf16 a[116:119], a[220:223], v[196:199], a[116:119]
    s_add_u32 s32, s32, 0x80000
    s_cmp_ge_u32 s36, s43
    s_cbranch_scc1 k2_prep_102
k2_prepret_103:
    v_mfma_f32_16x16x32_bf16 a[120:123], a[220:223], v[200:203], a[120:123]
    s_waitcnt vmcnt(8)
    v_exp_f32 v240, v168
    v_mfma_f32_16x16x32_bf16 a[124:127], a[220:223], v[204:207], a[124:127]
    s_waitcnt lgkmcnt(4)
    ds_read_b128 a[152:155], v2 offset:6144
    v_cvt_pk_bf16_f32 v215, v238, v239
    v_mfma_f32_16x16x32_bf16 v[128:131], a[128:131], v[96:99], v[16:19]
    v_exp_f32 v241, v169
    v_mfma_f32_16x16x32_bf16 v[128:131], a[132:135], v[100:103], v[128:131]
    s_waitcnt lgkmcnt(3)
    ds_read_b128 a[156:159], v2 offset:7168
    v_exp_f32 v242, v170
    v_mfma_f32_16x16x32_bf16 v[128:131], a[136:139], v[104:107], v[128:131]
    ds_read_b128 a[160:163], v2 offset:8192
    v_cvt_pk_bf16_f32 v216, v240, v241
    v_mfma_f32_16x16x32_bf16 v[128:131], a[140:143], v[108:111], v[128:131]
    s_add_u32 s36, s36, 64
    buffer_store_dwordx4 a[224:227], v229, s[8:11], s58 offen offset:0 sc1
    v_exp_f32 v243, v171
    v_mfma_f32_16x16x32_bf16 v[132:135], a[128:131], v[112:115], v[20:23]
    ds_read_b128 a[164:167], v2 offset:9216
    v_or3_b32 v57, v57, v215, v216
    v_mfma_f32_16x16x32_bf16 v[132:135], a[132:135], v[116:119], v[132:135]
    v_exp_f32 v244, v184
    v_mfma_f32_16x16x32_bf16 v[132:135], a[136:139], v[120:123], v[132:135]
    s_add_u32 s52, s52, 16384
    ds_read_b128 a[168:171], v2 offset:10240
    v_cvt_pk_bf16_f32 v217, v242, v243
    v_mfma_f32_16x16x32_bf16 v[132:135], a[140:143], v[124:127], v[132:135]
    s_waitcnt lgkmcnt(5)
    v_exp_f32 v245, v185
    v_mfma_f32_16x16x32_bf16 v[144:147], a[144:147], v[96:99], v[32:35]
    s_and_b32 s52, s52, 0xffff
    ds_read_b128 a[172:175], v2 offset:11264
    ds_read_b128 a[176:179], v2 offset:12288
    v_mfma_f32_16x16x32_bf16 v[144:147], a[148:151], v[100:103], v[144:147]
    s_waitcnt lgkmcnt(5)
    v_exp_f32 v246, v186
    v_mfma_f32_16x16x32_bf16 v[144:147], a[152:155], v[104:107], v[144:147]
    ds_read_b128 a[180:183], v2 offset:13312
    v_cvt_pk_bf16_f32 v218, v244, v245
    v_mfma_f32_16x16x32_bf16 v[144:147], a[156:159], v[108:111], v[144:147]
    v_exp_f32 v247, v187
    v_mfma_f32_16x16x32_bf16 v[148:151], a[144:147], v[112:115], v[36:39]
    ds_read_b128 a[184:187], v2 offset:14336
    v_or3_b32 v57, v57, v217, v218
    v_mfma_f32_16x16x32_bf16 v[148:151], a[148:151], v[116:119], v[148:151]
    v_exp_f32 v232, v172
    v_mfma_f32_16x16x32_bf16 v[148:151], a[152:155], v[120:123], v[148:151]
    ds_read_b128 a[188:191], v2 offset:15360
    v_cvt_pk_bf16_f32 v219, v246, v247
    v_mfma_f32_16x16x32_bf16 v[148:151], a[156:159], v[124:127], v[148:151]
    s_waitcnt lgkmcnt(6)
    v_exp_f32 v233, v173
    v_mfma_f32_16x16x32_bf16 v[136:139], a[160:163], v[96:99], v[24:27]
    buffer_store_dwordx4 a[228:231], v229, s[8:11], s58 offen offset:256 sc1
    ds_read_b128 a[192:195], v3 offset:0
    v_mfma_f32_16x16x32_bf16 v[136:139], a[164:167], v[100:103], v[136:139]
    s_waitcnt lgkmcnt(5)
    v_add_u32 v2, s52, v1
    v_cvt_pk_bf16_f32 v220, v232, v233
    v_mfma_f32_16x16x32_bf16 v[136:139], a[168:171], v[104:107], v[136:139]
    v_exp_f32 v234, v174
    v_mfma_f32_16x16x32_bf16 v[136:139], a[172:175], v[108:111], v[136:139]
    v_exp_f32 v235, v175
    v_mfma_f32_16x16x32_bf16 v[140:143], a[160:163], v[112:115], v[28:31]
    ds_read_b128 a[196:199], v3 offset:1024
    v_or3_b32 v57, v57, v219, v220
    v_mfma_f32_16x16x32_bf16 v[140:143], a[164:167], v[116:119], v[140:143]
    v_exp_f32 v236, v188
    v_mfma_f32_16x16x32_bf16 v[140:143], a[168:171], v[120:123], v[140:143]
    ds_read_b128 a[200:203], v3 offset:2048
    v_cvt_pk_bf16_f32 v221, v234, v235
    v_mfma_f32_16x16x32_bf16 v[140:143], a[172:175], v[124:127], v[140:143]
    s_waitcnt lgkmcnt(5)
    v_exp_f32 v237, v189
    v_mfma_f32_16x16x32_bf16 v[152:155], a[176:179], v[96:99], v[40:43]
    v_exp_f32 v238, v190
    v_mfma_f32_16x16x32_bf16 v[152:155], a[180:183], v[100:103], v[152:155]
    s_waitcnt lgkmcnt(3)
    v_cvt_pk_bf16_f32 v222, v236, v237
    v_or3_b32 v57, v57, v221, v222
    v_mfma_f32_16x16x32_bf16 v[152:155], a[184:187], v[104:107], v[152:155]
    v_exp_f32 v239, v191
    v_mfma_f32_16x16x32_bf16 v[152:155], a[188:191], v[108:111], v[152:155]
    ds_read_b128 a[204:207], v3 offset:3072
    v_cvt_pk_bf16_f32 v223, v238, v239
    v_mfma_f32_16x16x32_bf16 v[156:159], a[176:179], v[112:115], v[44:47]
    v_mfma_f32_16x16x32_bf16 v[156:159], a[180:183], v[116:119], v[156:159]
    v_bitop3_b32 v57, v57, v223, s37 bitop3:0xa8
    v_cmp_ne_u32 vcc, 0, v57
    v_mfma_f32_16x16x32_bf16 v[156:159], a[184:187], v[120:123], v[156:159]
    v_mfma_f32_16x16x32_bf16 v[156:159], a[188:191], v[124:127], v[156:159]
    s_cbranch_vccnz k2_tramp_104
k2_ret_105:
    v_mfma_f32_16x16x32_bf16 v[48:51], v[60:63], v[212:215], v[48:51]
    ds_read_b128 a[208:211], v3 offset:4096
    ds_read_b128 a[212:215], v3 offset:5120
    v_mfma_f32_16x16x32_bf16 v[248:251], v[60:63], v[216:219], v[248:251]
    s_mov_b32 m0, s35
    v_exp_f32 v232, v128
    v_mfma_f32_16x16x32_bf16 v[252:255], v[60:63], v[220:223], v[252:255]
    s_waitcnt lgkmcnt(4)
    ds_read_b128 a[216:219], v3 offset:6144
    v_exp_f32 v233, v129
    v_mfma_f32_16x16x32_bf16 a[4:7], a[192:195], v[212:215], a[4:7]
    s_add_u32 s53, s53, 8192
    buffer_load_dwordx4 v1, s[20:23], s33 offen offset:0 sc1 lds
    v_mfma_f32_16x16x32_bf16 a[8:11], a[192:195], v[216:219], a[8:11]
    s_and_b32 s53, s53, 0xffff
    v_exp_f32 v234, v130
    v_cvt_pk_bf16_f32 v192, v232, v233
    v_mfma_f32_16x16x32_bf16 a[12:15], a[192:195], v[220:223], a[12:15]
    ds_read_b128 a[220:223], v3 offset:7168
    v_mfma_f32_16x16x32_bf16 a[20:23], a[196:199], v[212:215], a[20:23]
    s_add_u32 s35, s35, 0x4000
    v_exp_f32 v235, v131
    v_mfma_f32_16x16x32_bf16 a[24:27], a[196:199], v[216:219], a[24:27]
    v_exp_f32 v236, v144
    v_cvt_pk_bf16_f32 v193, v234, v235
    v_mfma_f32_16x16x32_bf16 a[28:31], a[196:199], v[220:223], a[28:31]
    s_waitcnt lgkmcnt(4)
    buffer_load_dwordx4 v1, s[20:23], s33 offen offset:1024 sc1 lds
    ds_read_b128 a[128:131], v2 offset:0
    v_mfma_f32_16x16x32_bf16 a[36:39], a[200:203], v[212:215], a[36:39]
    v_add_u32 v3, s53, v56
    v_exp_f32 v237, v145
    v_mfma_f32_16x16x32_bf16 a[40:43], a[200:203], v[216:219], a[40:43]
    ds_read_b128 a[132:135], v2 offset:1024
    v_cvt_pk_bf16_f32 v194, v236, v237
    v_mfma_f32_16x16x32_bf16 a[44:47], a[200:203], v[220:223], a[44:47]
    ds_read_b128 a[136:139], v2 offset:2048
    v_exp_f32 v238, v146
    v_mfma_f32_16x16x32_bf16 a[52:55], a[204:207], v[212:215], a[52:55]
    s_and_b32 s35, s35, 0xffff
    v_exp_f32 v239, v147
    v_mfma_f32_16x16x32_bf16 a[56:59], a[204:207], v[216:219], a[56:59]
    ds_read_b128 a[140:143], v2 offset:3072
    v_or3_b32 v57, v192, v193, v194
    v_mfma_f32_16x16x32_bf16 a[60:63], a[204:207], v[220:223], a[60:63]
    s_waitcnt lgkmcnt(6)
    v_exp_f32 v240, v132
    v_mfma_f32_16x16x32_bf16 a[68:71], a[208:211], v[212:215], a[68:71]
    s_or_b32 s35, s35, 0x10000
    buffer_load_dwordx4 v1, s[20:23], s33 offen offset:2048 sc1 lds
    ds_read_b128 a[144:147], v2 offset:4096
    v_mfma_f32_16x16x32_bf16 a[72:75], a[208:211], v[216:219], a[72:75]
    v_cvt_pk_bf16_f32 v195, v238, v239
    v_exp_f32 v241, v133
    v_mfma_f32_16x16x32_bf16 a[76:79], a[208:211], v[220:223], a[76:79]
    v_exp_f32 v242, v134
    v_mfma_f32_16x16x32_bf16 a[84:87], a[212:215], v[212:215], a[84:87]
    ds_read_b128 a[148:151], v2 offset:5120
    v_cvt_pk_bf16_f32 v196, v240, v241
    v_mfma_f32_16x16x32_bf16 a[88:91], a[212:215], v[216:219], a[88:91]
    v_exp_f32 v243, v135
    v_mfma_f32_16x16x32_bf16 a[92:95], a[212:215], v[220:223], a[92:95]
    s_waitcnt lgkmcnt(6)
    ds_read_b128 a[152:155], v2 offset:6144
    v_or3_b32 v57, v57, v195, v196
    v_cvt_pk_bf16_f32 v197, v242, v243
    v_mfma_f32_16x16x32_bf16 a[100:103], a[216:219], v[212:215], a[100:103]
    buffer_load_dwordx4 v1, s[20:23], s33 offen offset:3072 sc1 lds
    ds_read_b128 a[156:159], v2 offset:7168
    v_mfma_f32_16x16x32_bf16 a[104:107], a[216:219], v[216:219], a[104:107]
    s_add_u32 s33, s33, 0x80000
    v_exp_f32 v244, v148
    v_mfma_f32_16x16x32_bf16 a[108:111], a[216:219], v[220:223], a[108:111]
    v_exp_f32 v245, v149
    v_mfma_f32_16x16x32_bf16 a[116:119], a[220:223], v[212:215], a[116:119]
    ds_read_b128 a[160:163], v2 offset:8192
    s_cmp_ge_u32 s36, s43
    s_cbranch_scc1 k2_prep_106
k2_prepret_107:
    v_mfma_f32_16x16x32_bf16 a[120:123], a[220:223], v[216:219], a[120:123]
    v_exp_f32 v246, v150
    v_mfma_f32_16x16x32_bf16 a[124:127], a[220:223], v[220:223], a[124:127]
    s_waitcnt lgkmcnt(7)
    ds_read_b128 a[164:167], v2 offset:9216
    v_cvt_pk_bf16_f32 v198, v244, v245
    v_mfma_f32_16x16x32_bf16 v[160:163], a[128:131], v[96:99], v[16:19]
    s_waitcnt vmcnt(12)
    s_barrier
    v_exp_f32 v247, v151
    v_mfma_f32_16x16x32_bf16 v[160:163], a[132:135], v[100:103], v[160:163]
    s_waitcnt lgkmcnt(6)
    v_or3_b32 v57, v57, v197, v198
    v_cvt_pk_bf16_f32 v199, v246, v247
    v_mfma_f32_16x16x32_bf16 v[160:163], a[136:139], v[104:107], v[160:163]
    s_mov_b32 m0, s34
    ds_read_b128 a[168:171], v2 offset:10240
    v_exp_f32 v232, v136
    v_mfma_f32_16x16x32_bf16 v[160:163], a[140:143], v[108:111], v[160:163]
    s_add_u32 s36, s36, 64
    buffer_load_dwordx4 v1, s[16:19], s32 offen offset:0 sc1 lds
    ds_read_b128 a[172:175], v2 offset:11264
    v_mfma_f32_16x16x32_bf16 v[164:167], a[128:131], v[112:115], v[20:23]
    v_exp_f32 v233, v137
    v_mfma_f32_16x16x32_bf16 v[164:167], a[132:135], v[116:119], v[164:167]
    v_exp_f32 v234, v138
    v_mfma_f32_16x16x32_bf16 v[164:167], a[136:139], v[120:123], v[164:167]
    s_add_u32 s52, s52, 16384
    ds_read_b128 a[176:179], v2 offset:12288
    v_cvt_pk_bf16_f32 v200, v232, v233
    v_mfma_f32_16x16x32_bf16 v[164:167], a[140:143], v[124:127], v[164:167]
    s_waitcnt lgkmcnt(7)
    v_exp_f32 v235, v139
    v_or3_b32 v57, v57, v199, v200
    v_mfma_f32_16x16x32_bf16 v[176:179], a[144:147], v[96:99], v[32:35]
    s_add_u32 s34, s34, 0x4000
    ds_read_b128 a[180:183], v2 offset:13312
    v_cvt_pk_bf16_f32 v201, v234, v235
    v_mfma_f32_16x16x32_bf16 v[176:179], a[148:151], v[100:103], v[176:179]
    s_waitcnt lgkmcnt(6)
    v_exp_f32 v236, v152
    v_mfma_f32_16x16x32_bf16 v[176:179], a[152:155], v[104:107], v[176:179]
    s_and_b32 s52, s52, 0xffff
    buffer_load_dwordx4 v1, s[16:19], s32 offen offset:1024 sc1 lds
    ds_read_b128 a[184:187], v2 offset:14336
    v_mfma_f32_16x16x32_bf16 v[176:179], a[156:159], v[108:111], v[176:179]
    ds_read_b128 a[188:191], v2 offset:15360
    v_exp_f32 v237, v153
    v_mfma_f32_16x16x32_bf16 v[180:183], a[144:147], v[112:115], v[36:39]
    v_exp_f32 v238, v154
    v_mfma_f32_16x16x32_bf16 v[180:183], a[148:151], v[116:119], v[180:183]
    v_cvt_pk_bf16_f32 v202, v236, v237
    v_or3_b32 v57, v57, v201, v202
    v_mfma_f32_16x16x32_bf16 v[180:183], a[152:155], v[120:123], v[180:183]
    s_and_b32 s34, s34, 0xffff
    v_exp_f32 v239, v155
    v_mfma_f32_16x16x32_bf16 v[180:183], a[156:159], v[124:127], v[180:183]
    s_waitcnt lgkmcnt(6)
    v_add_u32 v2, s52, v1
    v_cvt_pk_bf16_f32 v203, v238, v239
    v_mfma_f32_16x16x32_bf16 v[168:171], a[160:163], v[96:99], v[24:27]
    ds_read_b128 a[192:195], v3 offset:0
    v_exp_f32 v240, v140
    v_mfma_f32_16x16x32_bf16 v[168:171], a[164:167], v[100:103], v[168:171]
    s_waitcnt lgkmcnt(5)
    v_exp_f32 v241, v141
    v_mfma_f32_16x16x32_bf16 v[168:171], a[168:171], v[104:107], v[168:171]
    buffer_load_dwordx4 v1, s[16:19], s32 offen offset:2048 sc1 lds
    ds_read_b128 a[196:199], v3 offset:8192
    v_mfma_f32_16x16x32_bf16 v[168:171], a[172:175], v[108:111], v[168:171]
    v_exp_f32 v242, v142
    v_mfma_f32_16x16x32_bf16 v[172:175], a[160:163], v[112:115], v[28:31]
    ds_read_b128 a[200:203], v3 offset:1024
    v_cvt_pk_bf16_f32 v204, v240, v241
    v_or3_b32 v57, v57, v203, v204
    v_mfma_f32_16x16x32_bf16 v[172:175], a[164:167], v[116:119], v[172:175]
    v_exp_f32 v243, v143
    v_mfma_f32_16x16x32_bf16 v[172:175], a[168:171], v[120:123], v[172:175]
    ds_read_b128 a[204:207], v3 offset:9216
    v_cvt_pk_bf16_f32 v205, v242, v243
    v_mfma_f32_16x16x32_bf16 v[172:175], a[172:175], v[124:127], v[172:175]
    s_waitcnt lgkmcnt(6)
    v_exp_f32 v244, v156
    v_mfma_f32_16x16x32_bf16 v[184:187], a[176:179], v[96:99], v[40:43]
    v_exp_f32 v245, v157
    v_mfma_f32_16x16x32_bf16 v[184:187], a[180:183], v[100:103], v[184:187]
    s_waitcnt lgkmcnt(4)
    buffer_load_dwordx4 v1, s[16:19], s32 offen offset:3072 sc1 lds
    ds_read_b128 a[208:211], v3 offset:2048
    ds_read_b128 a[212:215], v3 offset:10240
    v_mfma_f32_16x16x32_bf16 v[184:187], a[184:187], v[104:107], v[184:187]
    s_add_u32 s32, s32, 0x80000
    v_exp_f32 v246, v158
    v_mfma_f32_16x16x32_bf16 v[184:187], a[188:191], v[108:111], v[184:187]
    v_cvt_pk_bf16_f32 v206, v244, v245
    v_or3_b32 v57, v57, v205, v206
    v_mfma_f32_16x16x32_bf16 v[188:191], a[176:179], v[112:115], v[44:47]
    v_exp_f32 v247, v159
    v_mfma_f32_16x16x32_bf16 v[188:191], a[180:183], v[116:119], v[188:191]
    ds_read_b128 a[216:219], v3 offset:3072
    ds_read_b128 a[220:223], v3 offset:11264
    v_cvt_pk_bf16_f32 v207, v246, v247
    v_mfma_f32_16x16x32_bf16 v[188:191], a[184:187], v[120:123], v[188:191]
    v_bitop3_b32 v57, v57, v207, s37 bitop3:0xa8
    v_cmp_ne_u32 vcc, 0, v57
    v_mfma_f32_16x16x32_bf16 v[188:191], a[188:191], v[124:127], v[188:191]
    s_cbranch_vccnz k2_tramp_108
k2_ret_109:
    s_load_dwordx2 s[4:5], s[0:1], 40
    s_add_u32 s24, s6, 0x3000000
    s_addc_u32 s25, s7, 0
    s_and_b32 s25, s25, 0xffff
    s_mov_b32 s26, 0x1000000
    s_mov_b32 s27, 0x00020000
    s_lshl_b32 s31, s28, 19
    s_lshl_b32 s44, s38, 6
    s_add_u32 s44, s44, s31
    s_add_u32 s45, s44, 131072
    s_add_u32 s46, s44, 262144
    s_add_u32 s47, s44, 393216
    s_add_u32 s48, s44, 4096
    s_add_u32 s49, s44, 135168
    s_add_u32 s50, s44, 266240
    s_add_u32 s51, s44, 397312
    v_mov_b32 v13, v12
    v_mov_b32 v49, v48
    s_nop 1
    v_permlane16_swap_b32 v12, v13
    v_permlane16_swap_b32 v48, v49
    s_nop 1
    v_add_f32 v12, v12, v13
    v_add_f32 v48, v48, v49
    v_mov_b32 v13, v12
    v_mov_b32 v49, v48
    s_nop 1
    v_permlane32_swap_b32 v12, v13
    v_permlane32_swap_b32 v48, v49
    s_nop 1
    v_add_f32 v12, v12, v13
    v_add_f32 v48, v48, v49
    v_rcp_f32 v13, v12
    v_rcp_f32 v49, v48
    v_rcp_f32 v12, v12
    v_rcp_f32 v48, v48
    s_nop 0
    v_accvgpr_read_b32 v68, a0
    v_accvgpr_read_b32 v69, a1
    v_accvgpr_read_b32 v70, a2
    v_accvgpr_read_b32 v71, a3
    v_accvgpr_read_b32 v72, a16
    v_accvgpr_read_b32 v73, a17
    v_accvgpr_read_b32 v74, a18
    v_accvgpr_read_b32 v75, a19
    v_pk_mul_f32 v[68:69], v[68:69], v[12:13]
    v_pk_mul_f32 v[70:71], v[70:71], v[12:13]
    v_pk_mul_f32 v[72:73], v[72:73], v[12:13]
    v_pk_mul_f32 v[74:75], v[74:75], v[12:13]
    v_cvt_pk_bf16_f32 v64, v68, v69
    v_cvt_pk_bf16_f32 v65, v70, v71
    v_cvt_pk_bf16_f32 v66, v72, v73
    v_cvt_pk_bf16_f32 v67, v74, v75
    buffer_store_dwordx4 v[64:67], v1, s[24:27], s44 offen sc1
    v_accvgpr_read_b32 v80, a32
    v_accvgpr_read_b32 v81, a33
    v_accvgpr_read_b32 v82, a34
    v_accvgpr_read_b32 v83, a35
    v_accvgpr_read_b32 v84, a48
    v_accvgpr_read_b32 v85, a49
    v_accvgpr_read_b32 v86, a50
    v_accvgpr_read_b32 v87, a51
    v_pk_mul_f32 v[80:81], v[80:81], v[12:13]
    v_pk_mul_f32 v[82:83], v[82:83], v[12:13]
    v_pk_mul_f32 v[84:85], v[84:85], v[12:13]
    v_pk_mul_f32 v[86:87], v[86:87], v[12:13]
    v_cvt_pk_bf16_f32 v76, v80, v81
    v_cvt_pk_bf16_f32 v77, v82, v83
    v_cvt_pk_bf16_f32 v78, v84, v85
    v_cvt_pk_bf16_f32 v79, v86, v87
    buffer_store_dwordx4 v[76:79], v1, s[24:27], s45 offen sc1
    v_accvgpr_read_b32 v68, a64
    v_accvgpr_read_b32 v69, a65
    v_accvgpr_read_b32 v70, a66
    v_accvgpr_read_b32 v71, a67
    v_accvgpr_read_b32 v72, a80
    v_accvgpr_read_b32 v73, a81
    v_accvgpr_read_b32 v74, a82
    v_accvgpr_read_b32 v75, a83
    v_pk_mul_f32 v[68:69], v[68:69], v[12:13]
    v_pk_mul_f32 v[70:71], v[70:71], v[12:13]
    v_pk_mul_f32 v[72:73], v[72:73], v[12:13]
    v_pk_mul_f32 v[74:75], v[74:75], v[12:13]
    v_cvt_pk_bf16_f32 v64, v68, v69
    v_cvt_pk_bf16_f32 v65, v70, v71
    v_cvt_pk_bf16_f32 v66, v72, v73
    v_cvt_pk_bf16_f32 v67, v74, v75
    buffer_store_dwordx4 v[64:67], v1, s[24:27], s46 offen sc1
    v_accvgpr_read_b32 v80, a96
    v_accvgpr_read_b32 v81, a97
    v_accvgpr_read_b32 v82, a98
    v_accvgpr_read_b32 v83, a99
    v_accvgpr_read_b32 v84, a112
    v_accvgpr_read_b32 v85, a113
    v_accvgpr_read_b32 v86, a114
    v_accvgpr_read_b32 v87, a115
    v_pk_mul_f32 v[80:81], v[80:81], v[12:13]
    v_pk_mul_f32 v[82:83], v[82:83], v[12:13]
    v_pk_mul_f32 v[84:85], v[84:85], v[12:13]
    v_pk_mul_f32 v[86:87], v[86:87], v[12:13]
    v_cvt_pk_bf16_f32 v76, v80, v81
    v_cvt_pk_bf16_f32 v77, v82, v83
    v_cvt_pk_bf16_f32 v78, v84, v85
    v_cvt_pk_bf16_f32 v79, v86, v87
    buffer_store_dwordx4 v[76:79], v1, s[24:27], s47 offen sc1
    v_accvgpr_read_b32 v68, a4
    v_accvgpr_read_b32 v69, a5
    v_accvgpr_read_b32 v70, a6
    v_accvgpr_read_b32 v71, a7
    v_accvgpr_read_b32 v72, a20
    v_accvgpr_read_b32 v73, a21
    v_accvgpr_read_b32 v74, a22
    v_accvgpr_read_b32 v75, a23
    v_pk_mul_f32 v[68:69], v[68:69], v[48:49]
    v_pk_mul_f32 v[70:71], v[70:71], v[48:49]
    v_pk_mul_f32 v[72:73], v[72:73], v[48:49]
    v_pk_mul_f32 v[74:75], v[74:75], v[48:49]
    v_cvt_pk_bf16_f32 v64, v68, v69
    v_cvt_pk_bf16_f32 v65, v70, v71
    v_cvt_pk_bf16_f32 v66, v72, v73
    v_cvt_pk_bf16_f32 v67, v74, v75
    buffer_store_dwordx4 v[64:67], v1, s[24:27], s48 offen sc1
    v_accvgpr_read_b32 v80, a36
    v_accvgpr_read_b32 v81, a37
    v_accvgpr_read_b32 v82, a38
    v_accvgpr_read_b32 v83, a39
    v_accvgpr_read_b32 v84, a52
    v_accvgpr_read_b32 v85, a53
    v_accvgpr_read_b32 v86, a54
    v_accvgpr_read_b32 v87, a55
    v_pk_mul_f32 v[80:81], v[80:81], v[48:49]
    v_pk_mul_f32 v[82:83], v[82:83], v[48:49]
    v_pk_mul_f32 v[84:85], v[84:85], v[48:49]
    v_pk_mul_f32 v[86:87], v[86:87], v[48:49]
    v_cvt_pk_bf16_f32 v76, v80, v81
    v_cvt_pk_bf16_f32 v77, v82, v83
    v_cvt_pk_bf16_f32 v78, v84, v85
    v_cvt_pk_bf16_f32 v79, v86, v87
    buffer_store_dwordx4 v[76:79], v1, s[24:27], s49 offen sc1
    v_accvgpr_read_b32 v68, a68
    v_accvgpr_read_b32 v69, a69
    v_accvgpr_read_b32 v70, a70
    v_accvgpr_read_b32 v71, a71
    v_accvgpr_read_b32 v72, a84
    v_accvgpr_read_b32 v73, a85
    v_accvgpr_read_b32 v74, a86
    v_accvgpr_read_b32 v75, a87
    v_pk_mul_f32 v[68:69], v[68:69], v[48:49]
    v_pk_mul_f32 v[70:71], v[70:71], v[48:49]
    v_pk_mul_f32 v[72:73], v[72:73], v[48:49]
    v_pk_mul_f32 v[74:75], v[74:75], v[48:49]
    v_cvt_pk_bf16_f32 v64, v68, v69
    v_cvt_pk_bf16_f32 v65, v70, v71
    v_cvt_pk_bf16_f32 v66, v72, v73
    v_cvt_pk_bf16_f32 v67, v74, v75
    buffer_store_dwordx4 v[64:67], v1, s[24:27], s50 offen sc1
    v_accvgpr_read_b32 v80, a100
    v_accvgpr_read_b32 v81, a101
    v_accvgpr_read_b32 v82, a102
    v_accvgpr_read_b32 v83, a103
    v_accvgpr_read_b32 v84, a116
    v_accvgpr_read_b32 v85, a117
    v_accvgpr_read_b32 v86, a118
    v_accvgpr_read_b32 v87, a119
    v_pk_mul_f32 v[80:81], v[80:81], v[48:49]
    v_pk_mul_f32 v[82:83], v[82:83], v[48:49]
    v_pk_mul_f32 v[84:85], v[84:85], v[48:49]
    v_pk_mul_f32 v[86:87], v[86:87], v[48:49]
    v_cvt_pk_bf16_f32 v76, v80, v81
    v_cvt_pk_bf16_f32 v77, v82, v83
    v_cvt_pk_bf16_f32 v78, v84, v85
    v_cvt_pk_bf16_f32 v79, v86, v87
    buffer_store_dwordx4 v[76:79], v1, s[24:27], s51 offen sc1
    s_nop 1
    s_lshr_b32 s31, s2, 3
    s_bfe_u32 s56, s2, 0x10002
    s_and_b32 s54, s2, 1
    s_and_b32 s55, s31, 7
    s_lshl_b32 s54, s54, 3
    s_add_u32 s54, s54, s55
    s_and_b32 s55, s2, 2
    s_lshl_b32 s55, s55, 1
    s_lshr_b32 s31, s31, 3
    s_add_u32 s55, s55, s31
    v_lshrrev_b32 v87, 4, v1
    v_lshrrev_b32 v72, 4, v87
    s_lshl_b32 s57, s54, 7
    s_lshl_b32 s31, s30, 5
    s_add_u32 s57, s57, s31
    s_lshl_b32 s31, s57, 6
    v_add_u32 v88, s31, v1
    v_add_u32 v89, 0x20000, v88
    v_bfe_u32 v84, v87, 1, 3
    v_xor_b32 v84, v84, v72
    v_and_b32 v85, 16, v1
    v_lshl_add_u32 v85, v72, 11, v85
    s_lshl_b32 s31, s30, 15
    s_lshl_b32 s58, s55, 8
    s_add_u32 s31, s31, s58
    v_add_u32 v85, s31, v85
    v_xor_b32 v86, 0, v84
    v_lshl_add_u32 v86, v86, 5, v85
    v_add_u32 v90, 0, v86
    v_xor_b32 v86, 4, v84
    v_lshl_add_u32 v86, v86, 5, v85
    v_add_u32 v91, 7168, v86
    v_xor_b32 v86, 0, v84
    v_lshl_add_u32 v86, v86, 5, v85
    v_add_u32 v92, 14336, v86
    v_xor_b32 v86, 4, v84
    v_lshl_add_u32 v86, v86, 5, v85
    v_add_u32 v93, 21504, v86
    v_and_b32 v84, 15, v87
    v_add_u32 v85, s57, v84
    v_lshlrev_b32 v77, 2, v85
    v_lshl_add_u32 v77, v72, 13, v77
    s_lshl_b32 s31, s56, 7
    s_add_u32 s58, s58, s31
    v_lshl_add_u32 v80, v72, 3, s58
    v_lshl_add_u32 v78, v85, 11, v80
    v_add_u32 v79, 0x8000, v78
    v_lshrrev_b32 v85, 2, v84
    v_lshl_add_u32 v85, v72, 2, v85
    v_and_b32 v84, 7, v85
    s_lshl_b32 s31, s56, 2
    v_xor_b32 v84, s31, v84
    v_lshlrev_b32 v85, 8, v85
    v_and_b32 v86, 3, v87
    v_lshl_add_u32 v85, v86, 3, v85
    s_add_u32 s31, s2, 1
    s_and_b32 s31, s31, 3
    v_add_u32 v73, s31, v86
    v_and_b32 v73, 3, v73
    v_lshlrev_b32 v73, 7, v73
    v_xor_b32 v86, 0, v84
    v_lshl_add_u32 v64, v86, 5, v85
    v_xor_b32 v86, 1, v84
    v_lshl_add_u32 v65, v86, 5, v85
    v_xor_b32 v86, 2, v84
    v_lshl_add_u32 v66, v86, 5, v85
    v_xor_b32 v86, 3, v84
    v_lshl_add_u32 v67, v86, 5, v85
    v_xor_b32 v86, 4, v84
    v_lshl_add_u32 v68, v86, 5, v85
    v_xor_b32 v86, 5, v84
    v_lshl_add_u32 v69, v86, 5, v85
    v_xor_b32 v86, 6, v84
    v_lshl_add_u32 v70, v86, 5, v85
    v_xor_b32 v86, 7, v84
    v_lshl_add_u32 v71, v86, 5, v85
    s_lshl_b32 s61, s31, 20
    s_lshl_b32 s62, s31, 21
    s_lshl_b32 s60, s30, 12
    s_lshl_b32 s59, s54, 10
    s_lshl_b32 s31, s56, 9
    s_add_u32 s59, s59, s31
    s_lshr_b32 s31, s28, 2
    s_lshl_b32 s31, s31, 7
    s_lshl_b32 s57, s29, 10
    s_sub_u32 s58, 0x3c00, s57
    s_add_u32 s57, s57, s31
    s_add_u32 s58, s58, s31
    v_mov_b32 v75, 0
    v_mov_b32 v76, 1
    s_lshl_b32 s31, s56, 23
    s_add_u32 s31, s31, 0x3000000
    s_add_u32 s8, s6, s31
    s_addc_u32 s9, s7, 0
    s_and_b32 s9, s9, 0xffff
    s_mov_b32 s10, 0x800000
    s_lshl_b32 s31, s56, 22
    s_waitcnt lgkmcnt(0)
    s_add_u32 s12, s4, s31
    s_addc_u32 s13, s5, 0
    s_and_b32 s13, s13, 0xffff
    s_mov_b32 s14, 0x400000
    s_load_dwordx2 s[4:5], s[0:1], 80
    v_mov_b32 v12, -1
    v_mov_b32 v13, -1
    v_mov_b32 v14, -1
    v_mov_b32 v15, -1
    s_waitcnt lgkmcnt(0)
    s_mov_b32 s26, -1
    s_lshl_b32 s31, s2, 14
    s_add_u32 s31, s31, s60
    s_add_u32 s40, s31, 0x2000000
    buffer_store_dwordx4 v[12:15], v1, s[24:27], s40 offen offset:0 sc1
    buffer_store_dwordx4 v[12:15], v1, s[24:27], s40 offen offset:1024 sc1
    buffer_store_dwordx4 v[12:15], v1, s[24:27], s40 offen offset:2048 sc1
    buffer_store_dwordx4 v[12:15], v1, s[24:27], s40 offen offset:3072 sc1
    s_lshr_b32 s31, s31, 1
    s_add_u32 s40, s31, 0x1900000
    buffer_store_dwordx4 v[12:15], v1, s[24:27], s40 offen offset:0 sc1
    buffer_store_dwordx4 v[12:15], v1, s[24:27], s40 offen offset:1024 sc1
    s_mov_b32 s26, 0x1000000
    s_and_b32 s31, s2, 7
    s_mul_i32 s31, s31, 28
    s_lshr_b32 s40, s2, 3
    s_add_u32 s31, s31, s40
    s_lshl_b32 s31, s31, 15
    s_lshl_b32 s40, s30, 13
    s_add_u32 s31, s31, s40
    s_mov_b32 s44, s4
    s_mov_b32 s47, 0x00020000
    s_and_b32 s45, s5, 0xffff
    s_cmp_ge_u32 s2, 224
    s_cselect_b32 s46, 0, 7340032
    s_add_u32 m0, s40, 131072
    s_nop 0
    buffer_load_dwordx4 v1, s[44:47], s31 offen offset:0 lds
    buffer_load_dwordx4 v1, s[44:47], s31 offen offset:1024 lds
    buffer_load_dwordx4 v1, s[44:47], s31 offen offset:2048 lds
    buffer_load_dwordx4 v1, s[44:47], s31 offen offset:3072 lds
    s_add_u32 s31, s31, 4096
    s_add_u32 m0, s40, 135168
    s_nop 0
    buffer_load_dwordx4 v1, s[44:47], s31 offen offset:0 lds
    buffer_load_dwordx4 v1, s[44:47], s31 offen offset:1024 lds
    buffer_load_dwordx4 v1, s[44:47], s31 offen offset:2048 lds
    buffer_load_dwordx4 v1, s[44:47], s31 offen offset:3072 lds
    s_add_u32 s31, s31, 4096
    s_lshl_b32 s63, s29, 1
    s_sub_u32 s63, 13, s63
    s_cbranch_scc1 k2_sdone_111
k2_sloop_110:
    v_mfma_f32_16x16x32_bf16 v[248:251], v[60:63], v[192:195], v[248:251]
    v_exp_f32 v232, v160
    v_mfma_f32_16x16x32_bf16 v[248:251], v[60:63], v[200:203], v[248:251]
    s_mov_b32 m0, s35
    ds_read_b128 a[224:227], v3 offset:4096
    v_mfma_f32_16x16x32_bf16 v[252:255], v[60:63], v[196:199], v[252:255]
    s_add_u32 s53, s53, 16384
    buffer_load_dwordx4 v1, s[20:23], s33 offen offset:0 sc1 lds
    ds_read_b128 a[228:231], v3 offset:12288
    v_mfma_f32_16x16x32_bf16 v[252:255], v[60:63], v[204:207], v[252:255]
    s_waitcnt lgkmcnt(8)
    v_exp_f32 v233, v161
    v_mfma_f32_16x16x32_bf16 a[8:11], a[192:195], v[192:195], a[8:11]
    s_and_b32 s53, s53, 0xffff
    v_exp_f32 v234, v162
    v_mfma_f32_16x16x32_bf16 a[8:11], a[196:199], v[200:203], a[8:11]
    ds_read_b128 a[232:235], v3 offset:5120
    v_cvt_pk_bf16_f32 v208, v232, v233
    v_mfma_f32_16x16x32_bf16 a[12:15], a[192:195], v[196:199], a[12:15]
    v_exp_f32 v235, v163
    v_mfma_f32_16x16x32_bf16 a[12:15], a[196:199], v[204:207], a[12:15]
    s_waitcnt lgkmcnt(7)
    ds_read_b128 a[236:239], v3 offset:13312
    v_cvt_pk_bf16_f32 v209, v234, v235
    v_mfma_f32_16x16x32_bf16 a[24:27], a[200:203], v[192:195], a[24:27]
    s_add_u32 s35, s35, 0x4000
    v_exp_f32 v236, v176
    v_mfma_f32_16x16x32_bf16 a[24:27], a[204:207], v[200:203], a[24:27]
    buffer_load_dwordx4 v1, s[20:23], s33 offen offset:1024 sc1 lds
    ds_read_b128 a[240:243], v3 offset:6144
    v_mfma_f32_16x16x32_bf16 a[28:31], a[200:203], v[196:199], a[28:31]
    v_exp_f32 v237, v177
    v_mfma_f32_16x16x32_bf16 a[28:31], a[204:207], v[204:207], a[28:31]
    s_waitcnt lgkmcnt(7)
    ds_read_b128 a[244:247], v3 offset:14336
    v_cvt_pk_bf16_f32 v210, v236, v237
    v_mfma_f32_16x16x32_bf16 a[40:43], a[208:211], v[192:195], a[40:43]
    v_exp_f32 v238, v178
    v_mfma_f32_16x16x32_bf16 a[40:43], a[212:215], v[200:203], a[40:43]
    ds_read_b128 a[248:251], v3 offset:7168
    v_or3_b32 v57, v208, v209, v210
    v_mfma_f32_16x16x32_bf16 a[44:47], a[208:211], v[196:199], a[44:47]
    v_exp_f32 v239, v179
    v_mfma_f32_16x16x32_bf16 a[44:47], a[212:215], v[204:207], a[44:47]
    s_waitcnt lgkmcnt(7)
    ds_read_b128 a[252:255], v3 offset:15360
    v_cvt_pk_bf16_f32 v211, v238, v239
    v_mfma_f32_16x16x32_bf16 a[56:59], a[216:219], v[192:195], a[56:59]
    s_and_b32 s35, s35, 0xffff
    v_exp_f32 v240, v164
    v_mfma_f32_16x16x32_bf16 a[56:59], a[220:223], v[200:203], a[56:59]
    ds_read_b128 a[128:131], v2 offset:0
    v_add_u32 v3, s53, v56
    v_mfma_f32_16x16x32_bf16 a[60:63], a[216:219], v[196:199], a[60:63]
    v_exp_f32 v241, v165
    v_mfma_f32_16x16x32_bf16 a[60:63], a[220:223], v[204:207], a[60:63]
    s_waitcnt lgkmcnt(7)
    buffer_load_dwordx4 v1, s[20:23], s33 offen offset:2048 sc1 lds
    ds_read_b128 a[132:135], v2 offset:1024
    v_mfma_f32_16x16x32_bf16 a[72:75], a[224:227], v[192:195], a[72:75]
    v_exp_f32 v242, v166
    v_mfma_f32_16x16x32_bf16 a[72:75], a[228:231], v[200:203], a[72:75]
    s_or_b32 s35, s35, 0x10000
    ds_read_b128 a[136:139], v2 offset:2048
    v_cvt_pk_bf16_f32 v212, v240, v241
    v_mfma_f32_16x16x32_bf16 a[76:79], a[224:227], v[196:199], a[76:79]
    v_exp_f32 v243, v167
    v_mfma_f32_16x16x32_bf16 a[76:79], a[228:231], v[204:207], a[76:79]
    s_waitcnt lgkmcnt(7)
    ds_read_b128 a[140:143], v2 offset:3072
    v_or3_b32 v57, v57, v211, v212
    v_mfma_f32_16x16x32_bf16 a[88:91], a[232:235], v[192:195], a[88:91]
    v_exp_f32 v244, v180
    v_mfma_f32_16x16x32_bf16 a[88:91], a[236:239], v[200:203], a[88:91]
    ds_read_b128 a[144:147], v2 offset:4096
    v_cvt_pk_bf16_f32 v213, v242, v243
    v_mfma_f32_16x16x32_bf16 a[92:95], a[232:235], v[196:199], a[92:95]
    v_exp_f32 v245, v181
    v_mfma_f32_16x16x32_bf16 a[92:95], a[236:239], v[204:207], a[92:95]
    s_waitcnt lgkmcnt(7)
    buffer_load_dwordx4 v1, s[20:23], s33 offen offset:3072 sc1 lds
    ds_read_b128 a[148:151], v2 offset:5120
    v_mfma_f32_16x16x32_bf16 a[104:107], a[240:243], v[192:195], a[104:107]
    s_add_u32 s33, s33, 0x80000
    v_exp_f32 v246, v182
    v_mfma_f32_16x16x32_bf16 a[104:107], a[244:247], v[200:203], a[104:107]
    ds_read_b128 a[152:155], v2 offset:6144
    v_cvt_pk_bf16_f32 v214, v244, v245
    v_mfma_f32_16x16x32_bf16 a[108:111], a[240:243], v[196:199], a[108:111]
    v_exp_f32 v247, v183
    v_mfma_f32_16x16x32_bf16 a[108:111], a[244:247], v[204:207], a[108:111]
    s_waitcnt lgkmcnt(7)
    ds_read_b128 a[156:159], v2 offset:7168
    v_or3_b32 v57, v57, v213, v214
    v_mfma_f32_16x16x32_bf16 a[120:123], a[248:251], v[192:195], a[120:123]
    v_exp_f32 v232, v168
    v_mfma_f32_16x16x32_bf16 a[120:123], a[252:255], v[200:203], a[120:123]
    ds_read_b128 a[160:163], v2 offset:8192
    v_cvt_pk_bf16_f32 v215, v246, v247
    v_mfma_f32_16x16x32_bf16 a[124:127], a[248:251], v[196:199], a[124:127]
    v_exp_f32 v233, v169
    v_mfma_f32_16x16x32_bf16 a[124:127], a[252:255], v[204:207], a[124:127]
    s_waitcnt lgkmcnt(7)
    ds_read_b128 a[164:167], v2 offset:9216
    v_cvt_pk_bf16_f32 v216, v232, v233
    v_mfma_f32_16x16x32_bf16 v[128:131], a[128:131], v[96:99], v[16:19]
    s_waitcnt vmcnt(12)
    s_barrier
    v_exp_f32 v234, v170
    v_mfma_f32_16x16x32_bf16 v[128:131], a[132:135], v[100:103], v[128:131]
    s_waitcnt lgkmcnt(6)
    ds_read_b128 a[168:171], v2 offset:10240
    v_or3_b32 v57, v57, v215, v216
    v_mfma_f32_16x16x32_bf16 v[128:131], a[136:139], v[104:107], v[128:131]
    s_mov_b32 m0, s34
    v_exp_f32 v235, v171
    v_mfma_f32_16x16x32_bf16 v[128:131], a[140:143], v[108:111], v[128:131]
    s_add_u32 s36, s36, 64
    buffer_load_dwordx4 v1, s[16:19], s32 offen offset:0 sc1 lds
    ds_read_b128 a[172:175], v2 offset:11264
    v_mfma_f32_16x16x32_bf16 v[132:135], a[128:131], v[112:115], v[20:23]
    v_exp_f32 v236, v184
    v_mfma_f32_16x16x32_bf16 v[132:135], a[132:135], v[116:119], v[132:135]
    ds_read_b128 a[176:179], v2 offset:12288
    v_cvt_pk_bf16_f32 v217, v234, v235
    v_mfma_f32_16x16x32_bf16 v[132:135], a[136:139], v[120:123], v[132:135]
    s_add_u32 s52, s52, 16384
    v_exp_f32 v237, v185
    v_mfma_f32_16x16x32_bf16 v[132:135], a[140:143], v[124:127], v[132:135]
    s_waitcnt lgkmcnt(7)
    ds_read_b128 a[180:183], v2 offset:13312
    v_cvt_pk_bf16_f32 v218, v236, v237
    v_mfma_f32_16x16x32_bf16 v[144:147], a[144:147], v[96:99], v[32:35]
    s_add_u32 s34, s34, 0x4000
    v_exp_f32 v238, v186
    v_mfma_f32_16x16x32_bf16 v[144:147], a[148:151], v[100:103], v[144:147]
    s_waitcnt lgkmcnt(6)
    buffer_load_dwordx4 v1, s[16:19], s32 offen offset:1024 sc1 lds
    ds_read_b128 a[184:187], v2 offset:14336
    v_mfma_f32_16x16x32_bf16 v[144:147], a[152:155], v[104:107], v[144:147]
    s_and_b32 s52, s52, 0xffff
    v_exp_f32 v239, v187
    v_mfma_f32_16x16x32_bf16 v[144:147], a[156:159], v[108:111], v[144:147]
    ds_read_b128 a[188:191], v2 offset:15360
    v_or3_b32 v57, v57, v217, v218
    v_mfma_f32_16x16x32_bf16 v[148:151], a[144:147], v[112:115], v[36:39]
    v_exp_f32 v240, v172
    v_mfma_f32_16x16x32_bf16 v[148:151], a[148:151], v[116:119], v[148:151]
    v_cvt_pk_bf16_f32 v219, v238, v239
    v_add_u32 v2, s52, v1
    v_mfma_f32_16x16x32_bf16 v[148:151], a[152:155], v[120:123], v[148:151]
    s_and_b32 s34, s34, 0xffff
    v_exp_f32 v241, v173
    v_mfma_f32_16x16x32_bf16 v[148:151], a[156:159], v[124:127], v[148:151]
    s_waitcnt lgkmcnt(6)
    ds_read_b128 a[192:195], v3 offset:0
    v_cvt_pk_bf16_f32 v220, v240, v241
    v_mfma_f32_16x16x32_bf16 v[136:139], a[160:163], v[96:99], v[24:27]
    v_exp_f32 v242, v174
    v_mfma_f32_16x16x32_bf16 v[136:139], a[164:167], v[100:103], v[136:139]
    s_waitcnt lgkmcnt(5)
    buffer_load_dwordx4 v1, s[16:19], s32 offen offset:2048 sc1 lds
    ds_read_b128 a[196:199], v3 offset:8192
    v_mfma_f32_16x16x32_bf16 v[136:139], a[168:171], v[104:107], v[136:139]
    v_exp_f32 v243, v175
    v_mfma_f32_16x16x32_bf16 v[136:139], a[172:175], v[108:111], v[136:139]
    ds_read_b128 a[200:203], v3 offset:1024
    v_or3_b32 v57, v57, v219, v220
    v_mfma_f32_16x16x32_bf16 v[140:143], a[160:163], v[112:115], v[28:31]
    v_exp_f32 v244, v188
    v_mfma_f32_16x16x32_bf16 v[140:143], a[164:167], v[116:119], v[140:143]
    ds_read_b128 a[204:207], v3 offset:9216
    v_cvt_pk_bf16_f32 v221, v242, v243
    v_mfma_f32_16x16x32_bf16 v[140:143], a[168:171], v[120:123], v[140:143]
    v_exp_f32 v245, v189
    v_mfma_f32_16x16x32_bf16 v[140:143], a[172:175], v[124:127], v[140:143]
    s_waitcnt lgkmcnt(6)
    buffer_load_dwordx4 v1, s[16:19], s32 offen offset:3072 sc1 lds
    ds_read_b128 a[208:211], v3 offset:2048
    v_mfma_f32_16x16x32_bf16 v[152:155], a[176:179], v[96:99], v[40:43]
    s_add_u32 s32, s32, 0x80000
    v_exp_f32 v246, v190
    v_mfma_f32_16x16x32_bf16 v[152:155], a[180:183], v[100:103], v[152:155]
    s_waitcnt lgkmcnt(5)
    ds_read_b128 a[212:215], v3 offset:10240
    v_cvt_pk_bf16_f32 v222, v244, v245
    v_mfma_f32_16x16x32_bf16 v[152:155], a[184:187], v[104:107], v[152:155]
    v_exp_f32 v247, v191
    v_mfma_f32_16x16x32_bf16 v[152:155], a[188:191], v[108:111], v[152:155]
    ds_read_b128 a[216:219], v3 offset:3072
    v_or3_b32 v57, v57, v221, v222
    v_mfma_f32_16x16x32_bf16 v[156:159], a[176:179], v[112:115], v[44:47]
    ds_read_b128 a[220:223], v3 offset:11264
    v_cvt_pk_bf16_f32 v223, v246, v247
    v_mfma_f32_16x16x32_bf16 v[156:159], a[180:183], v[116:119], v[156:159]
    v_bitop3_b32 v57, v57, v223, s37 bitop3:0xa8
    v_cmp_ne_u32 vcc, 0, v57
    v_mfma_f32_16x16x32_bf16 v[156:159], a[184:187], v[120:123], v[156:159]
    v_mfma_f32_16x16x32_bf16 v[156:159], a[188:191], v[124:127], v[156:159]
    s_cbranch_vccnz k2_tramp_112
k2_ret_113:
    v_mfma_f32_16x16x32_bf16 v[248:251], v[60:63], v[208:211], v[248:251]
    v_exp_f32 v232, v128
    v_mfma_f32_16x16x32_bf16 v[248:251], v[60:63], v[216:219], v[248:251]
    s_mov_b32 m0, s35
    ds_read_b128 a[224:227], v3 offset:4096
    v_mfma_f32_16x16x32_bf16 v[252:255], v[60:63], v[212:215], v[252:255]
    s_add_u32 s53, s53, 16384
    buffer_load_dwordx4 v1, s[20:23], s33 offen offset:0 sc1 lds
    ds_read_b128 a[228:231], v3 offset:12288
    v_mfma_f32_16x16x32_bf16 v[252:255], v[60:63], v[220:223], v[252:255]
    s_waitcnt lgkmcnt(8)
    v_exp_f32 v233, v129
    v_mfma_f32_16x16x32_bf16 a[8:11], a[192:195], v[208:211], a[8:11]
    s_and_b32 s53, s53, 0xffff
    v_exp_f32 v234, v130
    v_mfma_f32_16x16x32_bf16 a[8:11], a[196:199], v[216:219], a[8:11]
    ds_read_b128 a[232:235], v3 offset:5120
    v_cvt_pk_bf16_f32 v192, v232, v233
    v_mfma_f32_16x16x32_bf16 a[12:15], a[192:195], v[212:215], a[12:15]
    v_exp_f32 v235, v131
    v_mfma_f32_16x16x32_bf16 a[12:15], a[196:199], v[220:223], a[12:15]
    s_waitcnt lgkmcnt(7)
    ds_read_b128 a[236:239], v3 offset:13312
    v_cvt_pk_bf16_f32 v193, v234, v235
    v_mfma_f32_16x16x32_bf16 a[24:27], a[200:203], v[208:211], a[24:27]
    s_add_u32 s35, s35, 0x4000
    v_exp_f32 v236, v144
    v_mfma_f32_16x16x32_bf16 a[24:27], a[204:207], v[216:219], a[24:27]
    buffer_load_dwordx4 v1, s[20:23], s33 offen offset:1024 sc1 lds
    ds_read_b128 a[240:243], v3 offset:6144
    v_mfma_f32_16x16x32_bf16 a[28:31], a[200:203], v[212:215], a[28:31]
    v_exp_f32 v237, v145
    v_mfma_f32_16x16x32_bf16 a[28:31], a[204:207], v[220:223], a[28:31]
    s_waitcnt lgkmcnt(7)
    ds_read_b128 a[244:247], v3 offset:14336
    v_cvt_pk_bf16_f32 v194, v236, v237
    v_mfma_f32_16x16x32_bf16 a[40:43], a[208:211], v[208:211], a[40:43]
    v_exp_f32 v238, v146
    v_mfma_f32_16x16x32_bf16 a[40:43], a[212:215], v[216:219], a[40:43]
    ds_read_b128 a[248:251], v3 offset:7168
    v_or3_b32 v57, v192, v193, v194
    v_mfma_f32_16x16x32_bf16 a[44:47], a[208:211], v[212:215], a[44:47]
    v_exp_f32 v239, v147
    v_mfma_f32_16x16x32_bf16 a[44:47], a[212:215], v[220:223], a[44:47]
    s_waitcnt lgkmcnt(7)
    ds_read_b128 a[252:255], v3 offset:15360
    v_cvt_pk_bf16_f32 v195, v238, v239
    v_mfma_f32_16x16x32_bf16 a[56:59], a[216:219], v[208:211], a[56:59]
    s_and_b32 s35, s35, 0xffff
    v_exp_f32 v240, v132
    v_mfma_f32_16x16x32_bf16 a[56:59], a[220:223], v[216:219], a[56:59]
    ds_read_b128 a[128:131], v2 offset:0
    v_add_u32 v3, s53, v56
    v_mfma_f32_16x16x32_bf16 a[60:63], a[216:219], v[212:215], a[60:63]
    v_exp_f32 v241, v133
    v_mfma_f32_16x16x32_bf16 a[60:63], a[220:223], v[220:223], a[60:63]
    s_waitcnt lgkmcnt(7)
    buffer_load_dwordx4 v1, s[20:23], s33 offen offset:2048 sc1 lds
    ds_read_b128 a[132:135], v2 offset:1024
    v_mfma_f32_16x16x32_bf16 a[72:75], a[224:227], v[208:211], a[72:75]
    v_exp_f32 v242, v134
    v_mfma_f32_16x16x32_bf16 a[72:75], a[228:231], v[216:219], a[72:75]
    s_or_b32 s35, s35, 0x10000
    ds_read_b128 a[136:139], v2 offset:2048
    v_cvt_pk_bf16_f32 v196, v240, v241
    v_mfma_f32_16x16x32_bf16 a[76:79], a[224:227], v[212:215], a[76:79]
    v_exp_f32 v243, v135
    v_mfma_f32_16x16x32_bf16 a[76:79], a[228:231], v[220:223], a[76:79]
    s_waitcnt lgkmcnt(7)
    ds_read_b128 a[140:143], v2 offset:3072
    v_or3_b32 v57, v57, v195, v196
    v_mfma_f32_16x16x32_bf16 a[88:91], a[232:235], v[208:211], a[88:91]
    v_exp_f32 v244, v148
    v_mfma_f32_16x16x32_bf16 a[88:91], a[236:239], v[216:219], a[88:91]
    ds_read_b128 a[144:147], v2 offset:4096
    v_cvt_pk_bf16_f32 v197, v242, v243
    v_mfma_f32_16x16x32_bf16 a[92:95], a[232:235], v[212:215], a[92:95]
    v_exp_f32 v245, v149
    v_mfma_f32_16x16x32_bf16 a[92:95], a[236:239], v[220:223], a[92:95]
    s_waitcnt lgkmcnt(7)
    buffer_load_dwordx4 v1, s[20:23], s33 offen offset:3072 sc1 lds
    ds_read_b128 a[148:151], v2 offset:5120
    v_mfma_f32_16x16x32_bf16 a[104:107], a[240:243], v[208:211], a[104:107]
    s_add_u32 s33, s33, 0x80000
    v_exp_f32 v246, v150
    v_mfma_f32_16x16x32_bf16 a[104:107], a[244:247], v[216:219], a[104:107]
    ds_read_b128 a[152:155], v2 offset:6144
    v_cvt_pk_bf16_f32 v198, v244, v245
    v_mfma_f32_16x16x32_bf16 a[108:111], a[240:243], v[212:215], a[108:111]
    v_exp_f32 v247, v151
    v_mfma_f32_16x16x32_bf16 a[108:111], a[244:247], v[220:223], a[108:111]
    s_waitcnt lgkmcnt(7)
    ds_read_b128 a[156:159], v2 offset:7168
    v_or3_b32 v57, v57, v197, v198
    v_mfma_f32_16x16x32_bf16 a[120:123], a[248:251], v[208:211], a[120:123]
    v_exp_f32 v232, v136
    v_mfma_f32_16x16x32_bf16 a[120:123], a[252:255], v[216:219], a[120:123]
    ds_read_b128 a[160:163], v2 offset:8192
    v_cvt_pk_bf16_f32 v199, v246, v247
    v_mfma_f32_16x16x32_bf16 a[124:127], a[248:251], v[212:215], a[124:127]
    v_exp_f32 v233, v137
    v_mfma_f32_16x16x32_bf16 a[124:127], a[252:255], v[220:223], a[124:127]
    s_waitcnt lgkmcnt(7)
    ds_read_b128 a[164:167], v2 offset:9216
    v_cvt_pk_bf16_f32 v200, v232, v233
    v_mfma_f32_16x16x32_bf16 v[160:163], a[128:131], v[96:99], v[16:19]
    s_waitcnt vmcnt(12)
    s_barrier
    v_exp_f32 v234, v138
    v_mfma_f32_16x16x32_bf16 v[160:163], a[132:135], v[100:103], v[160:163]
    s_waitcnt lgkmcnt(6)
    ds_read_b128 a[168:171], v2 offset:10240
    v_or3_b32 v57, v57, v199, v200
    v_mfma_f32_16x16x32_bf16 v[160:163], a[136:139], v[104:107], v[160:163]
    s_mov_b32 m0, s34
    v_exp_f32 v235, v139
    v_mfma_f32_16x16x32_bf16 v[160:163], a[140:143], v[108:111], v[160:163]
    s_add_u32 s36, s36, 64
    buffer_load_dwordx4 v1, s[16:19], s32 offen offset:0 sc1 lds
    ds_read_b128 a[172:175], v2 offset:11264
    v_mfma_f32_16x16x32_bf16 v[164:167], a[128:131], v[112:115], v[20:23]
    v_exp_f32 v236, v152
    v_mfma_f32_16x16x32_bf16 v[164:167], a[132:135], v[116:119], v[164:167]
    ds_read_b128 a[176:179], v2 offset:12288
    v_cvt_pk_bf16_f32 v201, v234, v235
    v_mfma_f32_16x16x32_bf16 v[164:167], a[136:139], v[120:123], v[164:167]
    s_add_u32 s52, s52, 16384
    v_exp_f32 v237, v153
    v_mfma_f32_16x16x32_bf16 v[164:167], a[140:143], v[124:127], v[164:167]
    s_waitcnt lgkmcnt(7)
    ds_read_b128 a[180:183], v2 offset:13312
    v_cvt_pk_bf16_f32 v202, v236, v237
    v_mfma_f32_16x16x32_bf16 v[176:179], a[144:147], v[96:99], v[32:35]
    s_add_u32 s34, s34, 0x4000
    v_exp_f32 v238, v154
    v_mfma_f32_16x16x32_bf16 v[176:179], a[148:151], v[100:103], v[176:179]
    s_waitcnt lgkmcnt(6)
    buffer_load_dwordx4 v1, s[16:19], s32 offen offset:1024 sc1 lds
    ds_read_b128 a[184:187], v2 offset:14336
    v_mfma_f32_16x16x32_bf16 v[176:179], a[152:155], v[104:107], v[176:179]
    s_and_b32 s52, s52, 0xffff
    v_exp_f32 v239, v155
    v_mfma_f32_16x16x32_bf16 v[176:179], a[156:159], v[108:111], v[176:179]
    ds_read_b128 a[188:191], v2 offset:15360
    v_or3_b32 v57, v57, v201, v202
    v_mfma_f32_16x16x32_bf16 v[180:183], a[144:147], v[112:115], v[36:39]
    v_exp_f32 v240, v140
    v_mfma_f32_16x16x32_bf16 v[180:183], a[148:151], v[116:119], v[180:183]
    v_cvt_pk_bf16_f32 v203, v238, v239
    v_add_u32 v2, s52, v1
    v_mfma_f32_16x16x32_bf16 v[180:183], a[152:155], v[120:123], v[180:183]
    s_and_b32 s34, s34, 0xffff
    v_exp_f32 v241, v141
    v_mfma_f32_16x16x32_bf16 v[180:183], a[156:159], v[124:127], v[180:183]
    s_waitcnt lgkmcnt(6)
    ds_read_b128 a[192:195], v3 offset:0
    v_cvt_pk_bf16_f32 v204, v240, v241
    v_mfma_f32_16x16x32_bf16 v[168:171], a[160:163], v[96:99], v[24:27]
    v_exp_f32 v242, v142
    v_mfma_f32_16x16x32_bf16 v[168:171], a[164:167], v[100:103], v[168:171]
    s_waitcnt lgkmcnt(5)
    buffer_load_dwordx4 v1, s[16:19], s32 offen offset:2048 sc1 lds
    ds_read_b128 a[196:199], v3 offset:8192
    v_mfma_f32_16x16x32_bf16 v[168:171], a[168:171], v[104:107], v[168:171]
    v_exp_f32 v243, v143
    v_mfma_f32_16x16x32_bf16 v[168:171], a[172:175], v[108:111], v[168:171]
    ds_read_b128 a[200:203], v3 offset:1024
    v_or3_b32 v57, v57, v203, v204
    v_mfma_f32_16x16x32_bf16 v[172:175], a[160:163], v[112:115], v[28:31]
    v_exp_f32 v244, v156
    v_mfma_f32_16x16x32_bf16 v[172:175], a[164:167], v[116:119], v[172:175]
    ds_read_b128 a[204:207], v3 offset:9216
    v_cvt_pk_bf16_f32 v205, v242, v243
    v_mfma_f32_16x16x32_bf16 v[172:175], a[168:171], v[120:123], v[172:175]
    v_exp_f32 v245, v157
    v_mfma_f32_16x16x32_bf16 v[172:175], a[172:175], v[124:127], v[172:175]
    s_waitcnt lgkmcnt(6)
    buffer_load_dwordx4 v1, s[16:19], s32 offen offset:3072 sc1 lds
    ds_read_b128 a[208:211], v3 offset:2048
    v_mfma_f32_16x16x32_bf16 v[184:187], a[176:179], v[96:99], v[40:43]
    s_sub_u32 s63, s63, 1
    v_exp_f32 v246, v158
    v_mfma_f32_16x16x32_bf16 v[184:187], a[180:183], v[100:103], v[184:187]
    s_waitcnt lgkmcnt(5)
    ds_read_b128 a[212:215], v3 offset:10240
    v_cvt_pk_bf16_f32 v206, v244, v245
    v_mfma_f32_16x16x32_bf16 v[184:187], a[184:187], v[104:107], v[184:187]
    s_add_u32 s32, s32, 0x80000
    v_exp_f32 v247, v159
    v_mfma_f32_16x16x32_bf16 v[184:187], a[188:191], v[108:111], v[184:187]
    ds_read_b128 a[216:219], v3 offset:3072
    v_or3_b32 v57, v57, v205, v206
    v_mfma_f32_16x16x32_bf16 v[188:191], a[176:179], v[112:115], v[44:47]
    ds_read_b128 a[220:223], v3 offset:11264
    v_cvt_pk_bf16_f32 v207, v246, v247
    v_mfma_f32_16x16x32_bf16 v[188:191], a[180:183], v[116:119], v[188:191]
    v_bitop3_b32 v57, v57, v207, s37 bitop3:0xa8
    v_cmp_ne_u32 vcc, 0, v57
    v_mfma_f32_16x16x32_bf16 v[188:191], a[184:187], v[120:123], v[188:191]
    v_mfma_f32_16x16x32_bf16 v[188:191], a[188:191], v[124:127], v[188:191]
    s_cbranch_vccnz k2_tramp_114
k2_ret_115:
    s_cmp_lg_u32 s63, 0
    s_cbranch_scc1 k2_sloop_110
    v_mfma_f32_16x16x32_bf16 v[248:251], v[60:63], v[192:195], v[248:251]
    v_exp_f32 v232, v160
    v_mfma_f32_16x16x32_bf16 v[248:251], v[60:63], v[200:203], v[248:251]
    s_mov_b32 m0, s35
    ds_read_b128 a[224:227], v3 offset:4096
    v_exp_f32 v233, v161
    v_mfma_f32_16x16x32_bf16 v[252:255], v[60:63], v[196:199], v[252:255]
    s_add_u32 s53, s53, 16384
    buffer_load_dwordx4 v1, s[20:23], s33 offen offset:0 sc1 lds
    ds_read_b128 a[228:231], v3 offset:12288
    v_mfma_f32_16x16x32_bf16 v[252:255], v[60:63], v[204:207], v[252:255]
    s_waitcnt lgkmcnt(8)
    v_exp_f32 v234, v162
    v_cvt_pk_bf16_f32 v208, v232, v233
    v_mfma_f32_16x16x32_bf16 a[8:11], a[192:195], v[192:195], a[8:11]
    s_sub_u32 s40, s36, s39
    ds_read_b128 a[232:235], v3 offset:5120
    v_mfma_f32_16x16x32_bf16 a[8:11], a[196:199], v[200:203], a[8:11]
    s_and_b32 s53, s53, 0xffff
    v_subrev_u32 v6, s40, v4
    v_cmp_gt_i32 s[44:45], 0, v6
    v_mfma_f32_16x16x32_bf16 a[12:15], a[192:195], v[196:199], a[12:15]
    v_exp_f32 v235, v163
    v_cmp_gt_i32 s[46:47], 1, v6
    v_mfma_f32_16x16x32_bf16 a[12:15], a[196:199], v[204:207], a[12:15]
    s_waitcnt lgkmcnt(7)
    ds_read_b128 a[236:239], v3 offset:13312
    v_cmp_gt_i32 s[48:49], 2, v6
    v_cmp_gt_i32 s[50:51], 3, v6
    v_mfma_f32_16x16x32_bf16 a[24:27], a[200:203], v[192:195], a[24:27]
    s_add_u32 s35, s35, 0x4000
    v_exp_f32 v236, v176
    v_mfma_f32_16x16x32_bf16 a[24:27], a[204:207], v[200:203], a[24:27]
    ds_read_b128 a[240:243], v3 offset:6144
    v_cvt_pk_bf16_f32 v209, v234, v235
    v_cndmask_b32 v16, v10, v5, s[44:45]
    v_mfma_f32_16x16x32_bf16 a[28:31], a[200:203], v[196:199], a[28:31]
    v_exp_f32 v237, v177
    v_mfma_f32_16x16x32_bf16 a[28:31], a[204:207], v[204:207], a[28:31]
    s_waitcnt lgkmcnt(7)
    ds_read_b128 a[244:247], v3 offset:14336
    v_cndmask_b32 v17, v10, v5, s[46:47]
    v_cndmask_b32 v18, v10, v5, s[48:49]
    v_mfma_f32_16x16x32_bf16 a[40:43], a[208:211], v[192:195], a[40:43]
    buffer_load_dwordx4 v1, s[20:23], s33 offen offset:1024 sc1 lds
    ds_read_b128 a[248:251], v3 offset:7168
    v_mfma_f32_16x16x32_bf16 a[40:43], a[212:215], v[200:203], a[40:43]
    v_cndmask_b32 v19, v10, v5, s[50:51]
    v_cvt_pk_bf16_f32 v210, v236, v237
    v_mfma_f32_16x16x32_bf16 a[44:47], a[208:211], v[196:199], a[44:47]
    v_exp_f32 v238, v178
    v_cmp_gt_i32 s[44:45], 16, v6
    v_mfma_f32_16x16x32_bf16 a[44:47], a[212:215], v[204:207], a[44:47]
    s_waitcnt lgkmcnt(7)
    v_cmp_gt_i32 s[46:47], 17, v6
    v_cmp_gt_i32 s[48:49], 18, v6
    v_mfma_f32_16x16x32_bf16 a[56:59], a[216:219], v[192:195], a[56:59]
    s_and_b32 s35, s35, 0xffff
    v_exp_f32 v239, v179
    v_mfma_f32_16x16x32_bf16 a[56:59], a[220:223], v[200:203], a[56:59]
    ds_read_b128 a[252:255], v3 offset:15360
    v_or3_b32 v57, v208, v209, v210
    v_cmp_gt_i32 s[50:51], 19, v6
    v_mfma_f32_16x16x32_bf16 a[60:63], a[216:219], v[196:199], a[60:63]
    v_exp_f32 v240, v164
    v_mfma_f32_16x16x32_bf16 a[60:63], a[220:223], v[204:207], a[60:63]
    s_waitcnt lgkmcnt(6)
    v_cndmask_b32 v32, v10, v5, s[44:45]
    v_cvt_pk_bf16_f32 v211, v238, v239
    v_cndmask_b32 v33, v10, v5, s[46:47]
    v_mfma_f32_16x16x32_bf16 a[72:75], a[224:227], v[192:195], a[72:75]
    ds_read_b128 a[128:131], v2 offset:0
    v_cndmask_b32 v34, v10, v5, s[48:49]
    v_mfma_f32_16x16x32_bf16 a[72:75], a[228:231], v[200:203], a[72:75]
    s_or_b32 s35, s35, 0x10000
    v_add_u32 v3, s53, v56
    v_cndmask_b32 v35, v10, v5, s[50:51]
    v_mfma_f32_16x16x32_bf16 a[76:79], a[224:227], v[196:199], a[76:79]
    buffer_load_dwordx4 v1, s[20:23], s33 offen offset:2048 sc1 lds
    v_exp_f32 v241, v165
    v_mfma_f32_16x16x32_bf16 a[76:79], a[228:231], v[204:207], a[76:79]
    s_waitcnt lgkmcnt(5)
    ds_read_b128 a[132:135], v2 offset:1024
    v_cmp_gt_i32 s[44:45], 32, v6
    v_mfma_f32_16x16x32_bf16 a[88:91], a[232:235], v[192:195], a[88:91]
    v_exp_f32 v242, v166
    v_cmp_gt_i32 s[46:47], 33, v6
    v_mfma_f32_16x16x32_bf16 a[88:91], a[236:239], v[200:203], a[88:91]
    ds_read_b128 a[136:139], v2 offset:2048
    v_cvt_pk_bf16_f32 v212, v240, v241
    v_mfma_f32_16x16x32_bf16 a[92:95], a[232:235], v[196:199], a[92:95]
    v_cmp_gt_i32 s[48:49], 34, v6
    v_cmp_gt_i32 s[50:51], 35, v6
    v_mfma_f32_16x16x32_bf16 a[92:95], a[236:239], v[204:207], a[92:95]
    s_waitcnt lgkmcnt(5)
    v_exp_f32 v243, v167
    v_or3_b32 v57, v57, v211, v212
    v_mfma_f32_16x16x32_bf16 a[104:107], a[240:243], v[192:195], a[104:107]
    ds_read_b128 a[140:143], v2 offset:3072
    v_cndmask_b32 v24, v10, v5, s[44:45]
    v_mfma_f32_16x16x32_bf16 a[104:107], a[244:247], v[200:203], a[104:107]
    v_cndmask_b32 v25, v10, v5, s[46:47]
    v_exp_f32 v244, v180
    v_mfma_f32_16x16x32_bf16 a[108:111], a[240:243], v[196:199], a[108:111]
    v_cvt_pk_bf16_f32 v213, v242, v243
    v_cndmask_b32 v26, v10, v5, s[48:49]
    v_mfma_f32_16x16x32_bf16 a[108:111], a[244:247], v[204:207], a[108:111]
    s_waitcnt lgkmcnt(4)
    ds_read_b128 a[144:147], v2 offset:4096
    v_cndmask_b32 v27, v10, v5, s[50:51]
    v_mfma_f32_16x16x32_bf16 a[120:123], a[248:251], v[192:195], a[120:123]
    v_exp_f32 v245, v181
    v_cmp_gt_i32 s[44:45], 48, v6
    v_mfma_f32_16x16x32_bf16 a[120:123], a[252:255], v[200:203], a[120:123]
    buffer_load_dwordx4 v1, s[20:23], s33 offen offset:3072 sc1 lds
    ds_read_b128 a[148:151], v2 offset:5120
    ds_read_b128 a[152:155], v2 offset:6144
    v_cmp_gt_i32 s[46:47], 49, v6
    s_add_u32 s33, s33, 0x80000
    v_cmp_gt_i32 s[48:49], 50, v6
    v_exp_f32 v246, v182
    v_cvt_pk_bf16_f32 v214, v244, v245
    v_cmp_gt_i32 s[50:51], 51, v6
    v_cndmask_b32 v40, v10, v5, s[44:45]
    v_mfma_f32_16x16x32_bf16 a[124:127], a[248:251], v[196:199], a[124:127]
    v_exp_f32 v247, v183
    v_or3_b32 v57, v57, v213, v214
    v_cndmask_b32 v41, v10, v5, s[46:47]
    v_mfma_f32_16x16x32_bf16 a[124:127], a[252:255], v[204:207], a[124:127]
    s_waitcnt lgkmcnt(5)
    ds_read_b128 a[156:159], v2 offset:7168
    v_cndmask_b32 v42, v10, v5, s[48:49]
    v_cndmask_b32 v43, v10, v5, s[50:51]
    v_mfma_f32_16x16x32_bf16 v[128:131], a[128:131], v[96:99], v[16:19]
    s_waitcnt vmcnt(4)
    s_barrier
    v_exp_f32 v232, v168
    v_mfma_f32_16x16x32_bf16 v[128:131], a[132:135], v[100:103], v[128:131]
    s_waitcnt lgkmcnt(4)
    ds_read_b128 a[160:163], v2 offset:8192
    v_cvt_pk_bf16_f32 v215, v246, v247
    v_mfma_f32_16x16x32_bf16 v[128:131], a[136:139], v[104:107], v[128:131]
    v_exp_f32 v233, v169
    v_mfma_f32_16x16x32_bf16 v[128:131], a[140:143], v[108:111], v[128:131]
    s_add_u32 s36, s36, 64
    ds_read_b128 a[164:167], v2 offset:9216
    v_cvt_pk_bf16_f32 v216, v232, v233
    v_mfma_f32_16x16x32_bf16 v[132:135], a[128:131], v[112:115], v[20:23]
    v_exp_f32 v234, v170
    v_mfma_f32_16x16x32_bf16 v[132:135], a[132:135], v[116:119], v[132:135]
    ds_read_b128 a[168:171], v2 offset:10240
    v_or3_b32 v57, v57, v215, v216
    v_mfma_f32_16x16x32_bf16 v[132:135], a[136:139], v[120:123], v[132:135]
    s_add_u32 s52, s52, 16384
    v_exp_f32 v235, v171
    v_mfma_f32_16x16x32_bf16 v[132:135], a[140:143], v[124:127], v[132:135]
    s_waitcnt lgkmcnt(5)
    ds_read_b128 a[172:175], v2 offset:11264
    v_cvt_pk_bf16_f32 v217, v234, v235
    v_mfma_f32_16x16x32_bf16 v[144:147], a[144:147], v[96:99], v[32:35]
    s_and_b32 s52, s52, 0xffff
    v_exp_f32 v236, v184
    v_mfma_f32_16x16x32_bf16 v[144:147], a[148:151], v[100:103], v[144:147]
    s_waitcnt lgkmcnt(4)
    ds_read_b128 a[176:179], v2 offset:12288
    ds_read_b128 a[180:183], v2 offset:13312
    v_mfma_f32_16x16x32_bf16 v[144:147], a[152:155], v[104:107], v[144:147]
    v_exp_f32 v237, v185
    v_mfma_f32_16x16x32_bf16 v[144:147], a[156:159], v[108:111], v[144:147]
    v_exp_f32 v238, v186
    v_mfma_f32_16x16x32_bf16 v[148:151], a[144:147], v[112:115], v[36:39]
    ds_read_b128 a[184:187], v2 offset:14336
    v_cvt_pk_bf16_f32 v218, v236, v237
    v_mfma_f32_16x16x32_bf16 v[148:151], a[148:151], v[116:119], v[148:151]
    v_exp_f32 v239, v187
    v_mfma_f32_16x16x32_bf16 v[148:151], a[152:155], v[120:123], v[148:151]
    ds_read_b128 a[188:191], v2 offset:15360
    v_or3_b32 v57, v57, v217, v218
    v_mfma_f32_16x16x32_bf16 v[148:151], a[156:159], v[124:127], v[148:151]
    s_waitcnt lgkmcnt(6)
    v_exp_f32 v240, v172
    v_mfma_f32_16x16x32_bf16 v[136:139], a[160:163], v[96:99], v[24:27]
    v_cvt_pk_bf16_f32 v219, v238, v239
    v_add_u32 v2, s52, v1
    v_mfma_f32_16x16x32_bf16 v[136:139], a[164:167], v[100:103], v[136:139]
    s_waitcnt lgkmcnt(4)
    v_exp_f32 v241, v173
    v_mfma_f32_16x16x32_bf16 v[136:139], a[168:171], v[104:107], v[136:139]
    ds_read_b128 a[192:195], v3 offset:0
    v_cvt_pk_bf16_f32 v220, v240, v241
    v_mfma_f32_16x16x32_bf16 v[136:139], a[172:175], v[108:111], v[136:139]
    v_exp_f32 v242, v174
    v_mfma_f32_16x16x32_bf16 v[140:143], a[160:163], v[112:115], v[28:31]
    ds_read_b128 a[196:199], v3 offset:8192
    v_or3_b32 v57, v57, v219, v220
    v_mfma_f32_16x16x32_bf16 v[140:143], a[164:167], v[116:119], v[140:143]
    v_exp_f32 v243, v175
    v_mfma_f32_16x16x32_bf16 v[140:143], a[168:171], v[120:123], v[140:143]
    ds_read_b128 a[200:203], v3 offset:1024
    v_cvt_pk_bf16_f32 v221, v242, v243
    v_mfma_f32_16x16x32_bf16 v[140:143], a[172:175], v[124:127], v[140:143]
    s_waitcnt lgkmcnt(5)
    v_exp_f32 v244, v188
    v_mfma_f32_16x16x32_bf16 v[152:155], a[176:179], v[96:99], v[40:43]
    ds_read_b128 a[204:207], v3 offset:9216
    ds_read_b128 a[208:211], v3 offset:2048
    v_mfma_f32_16x16x32_bf16 v[152:155], a[180:183], v[100:103], v[152:155]
    s_waitcnt lgkmcnt(5)
    v_exp_f32 v245, v189
    v_mfma_f32_16x16x32_bf16 v[152:155], a[184:187], v[104:107], v[152:155]
    v_exp_f32 v246, v190
    v_mfma_f32_16x16x32_bf16 v[152:155], a[188:191], v[108:111], v[152:155]
    ds_read_b128 a[212:215], v3 offset:10240
    v_cvt_pk_bf16_f32 v222, v244, v245
    v_mfma_f32_16x16x32_bf16 v[156:159], a[176:179], v[112:115], v[44:47]
    v_exp_f32 v247, v191
    v_mfma_f32_16x16x32_bf16 v[156:159], a[180:183], v[116:119], v[156:159]
    ds_read_b128 a[216:219], v3 offset:3072
    v_or3_b32 v57, v57, v221, v222
    v_mfma_f32_16x16x32_bf16 v[156:159], a[184:187], v[120:123], v[156:159]
    ds_read_b128 a[220:223], v3 offset:11264
    v_cvt_pk_bf16_f32 v223, v246, v247
    v_bitop3_b32 v57, v57, v223, s37 bitop3:0xa8
    v_mfma_f32_16x16x32_bf16 v[156:159], a[188:191], v[124:127], v[156:159]
    v_cmp_ne_u32 vcc, 0, v57
    s_cbranch_vccnz k2_tramp_116
k2_ret_117:
    v_mfma_f32_16x16x32_bf16 v[248:251], v[60:63], v[208:211], v[248:251]
    ds_read_b128 a[224:227], v3 offset:4096
    v_exp_f32 v232, v128
    v_mfma_f32_16x16x32_bf16 v[248:251], v[60:63], v[216:219], v[248:251]
    v_exp_f32 v233, v129
    v_mfma_f32_16x16x32_bf16 v[252:255], v[60:63], v[212:215], v[252:255]
    s_add_u32 s53, s53, 16384
    ds_read_b128 a[228:231], v3 offset:12288
    v_exp_f32 v234, v130
    v_mfma_f32_16x16x32_bf16 v[252:255], v[60:63], v[220:223], v[252:255]
    s_waitcnt lgkmcnt(8)
    v_cvt_pk_bf16_f32 v192, v232, v233
    v_exp_f32 v235, v131
    v_mfma_f32_16x16x32_bf16 a[8:11], a[192:195], v[208:211], a[8:11]
    s_sub_u32 s40, s36, s39
    s_sub_u32 s40, s40, 64
    ds_read_b128 a[232:235], v3 offset:5120
    v_mfma_f32_16x16x32_bf16 a[8:11], a[196:199], v[216:219], a[8:11]
    s_and_b32 s53, s53, 0xffff
    v_subrev_u32 v6, s40, v4
    v_cmp_gt_i32 s[44:45], 0, v6
    v_cvt_pk_bf16_f32 v193, v234, v235
    v_mfma_f32_16x16x32_bf16 a[12:15], a[192:195], v[212:215], a[12:15]
    v_exp_f32 v236, v144
    v_cmp_gt_i32 s[46:47], 1, v6
    v_mfma_f32_16x16x32_bf16 a[12:15], a[196:199], v[220:223], a[12:15]
    s_waitcnt lgkmcnt(7)
    ds_read_b128 a[236:239], v3 offset:13312
    v_exp_f32 v237, v145
    v_mfma_f32_16x16x32_bf16 a[24:27], a[200:203], v[208:211], a[24:27]
    ds_read_b128 a[240:243], v3 offset:6144
    v_cmp_gt_i32 s[48:49], 2, v6
    v_cmp_gt_i32 s[50:51], 3, v6
    v_mfma_f32_16x16x32_bf16 a[24:27], a[204:207], v[216:219], a[24:27]
    v_exp_f32 v238, v146
    v_cndmask_b32 v20, v11, v5, s[44:45]
    v_mfma_f32_16x16x32_bf16 a[28:31], a[200:203], v[212:215], a[28:31]
    v_cvt_pk_bf16_f32 v194, v236, v237
    v_cndmask_b32 v21, v11, v5, s[46:47]
    v_or3_b32 v57, v192, v193, v194
    v_mfma_f32_16x16x32_bf16 a[28:31], a[204:207], v[220:223], a[28:31]
    s_waitcnt lgkmcnt(7)
    v_exp_f32 v239, v147
    v_cndmask_b32 v22, v11, v5, s[48:49]
    v_mfma_f32_16x16x32_bf16 a[40:43], a[208:211], v[208:211], a[40:43]
    ds_read_b128 a[244:247], v3 offset:14336
    v_cndmask_b32 v23, v11, v5, s[50:51]
    v_cvt_pk_bf16_f32 v195, v238, v239
    v_mfma_f32_16x16x32_bf16 a[40:43], a[212:215], v[216:219], a[40:43]
    v_exp_f32 v240, v132
    v_cmp_gt_i32 s[44:45], 16, v6
    v_mfma_f32_16x16x32_bf16 a[44:47], a[208:211], v[212:215], a[44:47]
    ds_read_b128 a[248:251], v3 offset:7168
    v_cmp_gt_i32 s[46:47], 17, v6
    v_cmp_gt_i32 s[48:49], 18, v6
    v_mfma_f32_16x16x32_bf16 a[44:47], a[212:215], v[220:223], a[44:47]
    s_waitcnt lgkmcnt(7)
    ds_read_b128 a[252:255], v3 offset:15360
    v_exp_f32 v241, v133
    v_mfma_f32_16x16x32_bf16 a[56:59], a[216:219], v[208:211], a[56:59]
    v_exp_f32 v242, v134
    v_cmp_gt_i32 s[50:51], 19, v6
    v_mfma_f32_16x16x32_bf16 a[56:59], a[220:223], v[216:219], a[56:59]
    v_cvt_pk_bf16_f32 v196, v240, v241
    v_cndmask_b32 v36, v11, v5, s[44:45]
    v_or3_b32 v57, v57, v195, v196
    v_mfma_f32_16x16x32_bf16 a[60:63], a[216:219], v[212:215], a[60:63]
    v_exp_f32 v243, v135
    v_cndmask_b32 v37, v11, v5, s[46:47]
    v_mfma_f32_16x16x32_bf16 a[60:63], a[220:223], v[220:223], a[60:63]
    s_waitcnt lgkmcnt(6)
    ds_read_b128 a[128:131], v2 offset:0
    v_cndmask_b32 v38, v11, v5, s[48:49]
    v_add_u32 v3, s53, v56
    v_mfma_f32_16x16x32_bf16 a[72:75], a[224:227], v[208:211], a[72:75]
    ds_read_b128 a[132:135], v2 offset:1024
    v_exp_f32 v244, v148
    v_mfma_f32_16x16x32_bf16 a[72:75], a[228:231], v[216:219], a[72:75]
    ds_read_b128 a[136:139], v2 offset:2048
    v_cvt_pk_bf16_f32 v197, v242, v243
    v_cndmask_b32 v39, v11, v5, s[50:51]
    v_mfma_f32_16x16x32_bf16 a[76:79], a[224:227], v[212:215], a[76:79]
    v_cmp_gt_i32 s[44:45], 32, v6
    v_exp_f32 v245, v149
    v_mfma_f32_16x16x32_bf16 a[76:79], a[228:231], v[220:223], a[76:79]
    s_waitcnt lgkmcnt(7)
    ds_read_b128 a[140:143], v2 offset:3072
    ds_read_b128 a[144:147], v2 offset:4096
    v_cmp_gt_i32 s[46:47], 33, v6
    v_mfma_f32_16x16x32_bf16 a[88:91], a[232:235], v[208:211], a[88:91]
    v_exp_f32 v246, v150
    v_cmp_gt_i32 s[48:49], 34, v6
    v_mfma_f32_16x16x32_bf16 a[88:91], a[236:239], v[216:219], a[88:91]
    ds_read_b128 a[148:151], v2 offset:5120
    v_cvt_pk_bf16_f32 v198, v244, v245
    v_cmp_gt_i32 s[50:51], 35, v6
    v_mfma_f32_16x16x32_bf16 a[92:95], a[232:235], v[212:215], a[92:95]
    v_exp_f32 v247, v151
    v_or3_b32 v57, v57, v197, v198
    v_mfma_f32_16x16x32_bf16 a[92:95], a[236:239], v[220:223], a[92:95]
    s_waitcnt lgkmcnt(8)
    ds_read_b128 a[152:155], v2 offset:6144
    v_cndmask_b32 v28, v11, v5, s[44:45]
    v_cndmask_b32 v29, v11, v5, s[46:47]
    v_mfma_f32_16x16x32_bf16 a[104:107], a[240:243], v[208:211], a[104:107]
    ds_read_b128 a[156:159], v2 offset:7168
    v_exp_f32 v232, v136
    v_mfma_f32_16x16x32_bf16 a[104:107], a[244:247], v[216:219], a[104:107]
    ds_read_b128 a[160:163], v2 offset:8192
    v_cvt_pk_bf16_f32 v199, v246, v247
    v_cndmask_b32 v30, v11, v5, s[48:49]
    v_mfma_f32_16x16x32_bf16 a[108:111], a[240:243], v[212:215], a[108:111]
    v_cndmask_b32 v31, v11, v5, s[50:51]
    v_exp_f32 v233, v137
    v_mfma_f32_16x16x32_bf16 a[108:111], a[244:247], v[220:223], a[108:111]
    s_waitcnt lgkmcnt(9)
    ds_read_b128 a[164:167], v2 offset:9216
    ds_read_b128 a[168:171], v2 offset:10240
    v_cmp_gt_i32 s[44:45], 48, v6
    v_mfma_f32_16x16x32_bf16 a[120:123], a[248:251], v[208:211], a[120:123]
    v_exp_f32 v234, v138
    v_cmp_gt_i32 s[46:47], 49, v6
    v_mfma_f32_16x16x32_bf16 a[120:123], a[252:255], v[216:219], a[120:123]
    ds_read_b128 a[172:175], v2 offset:11264
    ds_read_b128 a[176:179], v2 offset:12288
    v_cvt_pk_bf16_f32 v200, v232, v233
    v_cmp_gt_i32 s[48:49], 50, v6
    v_exp_f32 v235, v139
    v_cmp_gt_i32 s[50:51], 51, v6
    v_or3_b32 v57, v57, v199, v200
    v_cndmask_b32 v44, v11, v5, s[44:45]
    v_mfma_f32_16x16x32_bf16 a[124:127], a[248:251], v[212:215], a[124:127]
    ds_read_b128 a[180:183], v2 offset:13312
    v_exp_f32 v236, v152
    v_cvt_pk_bf16_f32 v201, v234, v235
    v_cndmask_b32 v45, v11, v5, s[46:47]
    v_mfma_f32_16x16x32_bf16 a[124:127], a[252:255], v[220:223], a[124:127]
    s_waitcnt lgkmcnt(12)
    ds_read_b128 a[184:187], v2 offset:14336
    v_cndmask_b32 v46, v11, v5, s[48:49]
    v_cndmask_b32 v47, v11, v5, s[50:51]
    v_mfma_f32_16x16x32_bf16 v[164:167], a[128:131], v[112:115], v[20:23]
    v_exp_f32 v237, v153
    v_mfma_f32_16x16x32_bf16 v[164:167], a[132:135], v[116:119], v[164:167]
    s_waitcnt lgkmcnt(11)
    ds_read_b128 a[188:191], v2 offset:15360
    v_exp_f32 v238, v154
    v_mfma_f32_16x16x32_bf16 v[164:167], a[136:139], v[120:123], v[164:167]
    v_cvt_pk_bf16_f32 v202, v236, v237
    v_exp_f32 v239, v155
    v_mfma_f32_16x16x32_bf16 v[164:167], a[140:143], v[124:127], v[164:167]
    s_waitcnt lgkmcnt(10)
    ds_read_b128 a[192:195], v3 offset:0
    v_or3_b32 v57, v57, v201, v202
    v_mfma_f32_16x16x32_bf16 v[180:183], a[144:147], v[112:115], v[36:39]
    s_add_u32 s36, s36, 64
    v_exp_f32 v240, v140
    v_mfma_f32_16x16x32_bf16 v[180:183], a[148:151], v[116:119], v[180:183]
    s_waitcnt lgkmcnt(9)
    ds_read_b128 a[196:199], v3 offset:8192
    v_cvt_pk_bf16_f32 v203, v238, v239
    v_exp_f32 v241, v141
    v_mfma_f32_16x16x32_bf16 v[180:183], a[152:155], v[120:123], v[180:183]
    s_add_u32 s52, s52, 16384
    ds_read_b128 a[200:203], v3 offset:1024
    v_cvt_pk_bf16_f32 v204, v240, v241
    v_mfma_f32_16x16x32_bf16 v[180:183], a[156:159], v[124:127], v[180:183]
    s_waitcnt lgkmcnt(9)
    v_exp_f32 v242, v142
    v_or3_b32 v57, v57, v203, v204
    v_mfma_f32_16x16x32_bf16 v[172:175], a[160:163], v[112:115], v[28:31]
    s_and_b32 s52, s52, 0xffff
    v_add_u32 v2, s52, v1
    v_exp_f32 v243, v143
    v_mfma_f32_16x16x32_bf16 v[172:175], a[164:167], v[116:119], v[172:175]
    s_waitcnt lgkmcnt(7)
    ds_read_b128 a[204:207], v3 offset:9216
    v_exp_f32 v244, v156
    v_mfma_f32_16x16x32_bf16 v[172:175], a[168:171], v[120:123], v[172:175]
    ds_read_b128 a[208:211], v3 offset:2048
    ds_read_b128 a[212:215], v3 offset:10240
    v_cvt_pk_bf16_f32 v205, v242, v243
    v_mfma_f32_16x16x32_bf16 v[172:175], a[172:175], v[124:127], v[172:175]
    s_waitcnt lgkmcnt(8)
    ds_read_b128 a[216:219], v3 offset:3072
    v_exp_f32 v245, v157
    v_mfma_f32_16x16x32_bf16 v[188:191], a[176:179], v[112:115], v[44:47]
    v_exp_f32 v246, v158
    v_cvt_pk_bf16_f32 v206, v244, v245
    v_mfma_f32_16x16x32_bf16 v[188:191], a[180:183], v[116:119], v[188:191]
    s_waitcnt lgkmcnt(7)
    v_exp_f32 v247, v159
    v_or3_b32 v57, v57, v205, v206
    v_mfma_f32_16x16x32_bf16 v[188:191], a[184:187], v[120:123], v[188:191]
    ds_read_b128 a[220:223], v3 offset:11264
    v_cvt_pk_bf16_f32 v207, v246, v247
    v_bitop3_b32 v57, v57, v207, s37 bitop3:0xa8
    v_mfma_f32_16x16x32_bf16 v[188:191], a[188:191], v[124:127], v[188:191]
    v_cmp_ne_u32 vcc, 0, v57
    s_cbranch_vccnz k2_tramp_118
k2_ret_119:
k2_sdone_111:
    s_add_u32 s16, s6, 0x4811000
    s_addc_u32 s17, s7, 0
    s_and_b32 s17, s17, 0xffff
    s_mov_b32 s18, 0x4000
    s_mov_b32 s19, 0x00020000
    v_mfma_f32_16x16x32_bf16 v[248:251], v[60:63], v[192:195], v[248:251]
    s_waitcnt vmcnt(0)
    s_barrier
    v_exp_f32 v232, v164
    v_mfma_f32_16x16x32_bf16 v[248:251], v[60:63], v[200:203], v[248:251]
    ds_read_b128 a[224:227], v3 offset:4096
    s_cmp_eq_u32 s30, 0
    s_cbranch_scc1 k12_ool_122
k12_oolret_123:
    v_mfma_f32_16x16x32_bf16 v[252:255], v[60:63], v[196:199], v[252:255]
    s_add_u32 m0, s60, 0
    v_exp_f32 v233, v165
    v_mfma_f32_16x16x32_bf16 v[252:255], v[60:63], v[204:207], v[252:255]
    s_waitcnt lgkmcnt(7)
    buffer_load_dwordx4 v90, s[12:15], s61 offen offset:0 lds
    ds_read_b128 a[228:231], v3 offset:12288
    v_mfma_f32_16x16x32_bf16 a[8:11], a[192:195], v[192:195], a[8:11]
    s_add_u32 s53, s53, 16384
    v_exp_f32 v234, v166
    v_cvt_pk_bf16_f32 v212, v232, v233
    v_mfma_f32_16x16x32_bf16 a[8:11], a[196:199], v[200:203], a[8:11]
    s_and_b32 s53, s53, 0xffff
    buffer_load_dwordx4 v91, s[12:15], s61 offen offset:1024 lds
    ds_read_b128 a[232:235], v3 offset:5120
    v_mfma_f32_16x16x32_bf16 a[12:15], a[192:195], v[196:199], a[12:15]
    ds_read_b128 a[236:239], v3 offset:13312
    v_exp_f32 v235, v167
    v_mfma_f32_16x16x32_bf16 a[12:15], a[196:199], v[204:207], a[12:15]
    s_waitcnt lgkmcnt(8)
    v_exp_f32 v236, v180
    v_mfma_f32_16x16x32_bf16 a[24:27], a[200:203], v[192:195], a[24:27]
    buffer_load_dwordx4 v92, s[12:15], s61 offen offset:2048 lds
    ds_read_b128 a[240:243], v3 offset:6144
    v_mfma_f32_16x16x32_bf16 a[24:27], a[204:207], v[200:203], a[24:27]
    v_cvt_pk_bf16_f32 v213, v234, v235
    v_exp_f32 v237, v181
    v_mfma_f32_16x16x32_bf16 a[28:31], a[200:203], v[196:199], a[28:31]
    buffer_load_dwordx4 v93, s[12:15], s61 offen offset:3072 lds
    ds_read_b128 a[244:247], v3 offset:14336
    v_mfma_f32_16x16x32_bf16 a[28:31], a[204:207], v[204:207], a[28:31]
    s_waitcnt lgkmcnt(8)
    v_exp_f32 v238, v182
    v_cvt_pk_bf16_f32 v214, v236, v237
    v_mfma_f32_16x16x32_bf16 a[40:43], a[208:211], v[192:195], a[40:43]
    s_add_u32 s61, s61, 0x20000
    s_and_b32 s61, s61, 0x3fffff
    ds_read_b128 a[248:251], v3 offset:7168
    v_mfma_f32_16x16x32_bf16 a[40:43], a[212:215], v[200:203], a[40:43]
    s_add_u32 m0, s60, 16384
    v_exp_f32 v239, v183
    v_or3_b32 v57, v212, v213, v214
    v_mfma_f32_16x16x32_bf16 a[44:47], a[208:211], v[196:199], a[44:47]
    buffer_load_dwordx4 v90, s[12:15], s61 offen offset:0 lds
    buffer_load_dwordx4 v91, s[12:15], s61 offen offset:1024 lds
    ds_read_b128 a[252:255], v3 offset:15360
    v_mfma_f32_16x16x32_bf16 a[44:47], a[212:215], v[204:207], a[44:47]
    s_waitcnt lgkmcnt(8)
    v_exp_f32 v240, v172
    v_cvt_pk_bf16_f32 v215, v238, v239
    v_mfma_f32_16x16x32_bf16 a[56:59], a[216:219], v[192:195], a[56:59]
    v_mfma_f32_16x16x32_bf16 a[56:59], a[220:223], v[200:203], a[56:59]
    v_add_u32 v3, s53, v56
    ds_read_b128 a[192:195], v3 offset:0
    v_mfma_f32_16x16x32_bf16 a[60:63], a[216:219], v[196:199], a[60:63]
    ds_read_b128 a[196:199], v3 offset:8192
    v_exp_f32 v241, v173
    v_mfma_f32_16x16x32_bf16 a[60:63], a[220:223], v[204:207], a[60:63]
    s_waitcnt lgkmcnt(8)
    buffer_load_dwordx4 v92, s[12:15], s61 offen offset:2048 lds
    buffer_load_dwordx4 v93, s[12:15], s61 offen offset:3072 lds
    ds_read_b128 a[200:203], v3 offset:1024
    v_mfma_f32_16x16x32_bf16 a[72:75], a[224:227], v[192:195], a[72:75]
    v_exp_f32 v242, v174
    v_cvt_pk_bf16_f32 v220, v240, v241
    v_mfma_f32_16x16x32_bf16 a[72:75], a[228:231], v[200:203], a[72:75]
    ds_read_b128 a[204:207], v3 offset:9216
    ds_read_b128 a[208:211], v3 offset:2048
    v_or3_b32 v57, v57, v215, v220
    v_mfma_f32_16x16x32_bf16 a[76:79], a[224:227], v[196:199], a[76:79]
    s_add_u32 s61, s61, 0x20000
    s_and_b32 s61, s61, 0x3fffff
    ds_read_b128 a[212:215], v3 offset:10240
    v_exp_f32 v243, v175
    v_mfma_f32_16x16x32_bf16 a[76:79], a[228:231], v[204:207], a[76:79]
    s_waitcnt lgkmcnt(10)
    ds_read_b128 a[216:219], v3 offset:3072
    s_add_u32 m0, s60, 32768
    v_mfma_f32_16x16x32_bf16 a[88:91], a[232:235], v[192:195], a[88:91]
    buffer_load_dwordx4 v90, s[12:15], s61 offen offset:0 lds
    ds_read_b128 a[220:223], v3 offset:11264
    v_mfma_f32_16x16x32_bf16 a[88:91], a[236:239], v[200:203], a[88:91]
    v_exp_f32 v244, v188
    v_cvt_pk_bf16_f32 v221, v242, v243
    v_mfma_f32_16x16x32_bf16 a[92:95], a[232:235], v[196:199], a[92:95]
    buffer_load_dwordx4 v91, s[12:15], s61 offen offset:1024 lds
    ds_read_b128 a[224:227], v3 offset:4096
    v_mfma_f32_16x16x32_bf16 a[92:95], a[236:239], v[204:207], a[92:95]
    s_waitcnt lgkmcnt(11)
    ds_read_b128 a[228:231], v3 offset:12288
    v_exp_f32 v245, v189
    v_mfma_f32_16x16x32_bf16 a[104:107], a[240:243], v[192:195], a[104:107]
    buffer_load_dwordx4 v92, s[12:15], s61 offen offset:2048 lds
    ds_read_b128 a[232:235], v3 offset:5120
    v_mfma_f32_16x16x32_bf16 a[104:107], a[244:247], v[200:203], a[104:107]
    v_exp_f32 v246, v190
    v_mfma_f32_16x16x32_bf16 a[108:111], a[240:243], v[196:199], a[108:111]
    ds_read_b128 a[236:239], v3 offset:13312
    v_cvt_pk_bf16_f32 v222, v244, v245
    v_or3_b32 v57, v57, v221, v222
    v_mfma_f32_16x16x32_bf16 a[108:111], a[244:247], v[204:207], a[108:111]
    s_waitcnt lgkmcnt(12)
    v_exp_f32 v247, v191
    v_mfma_f32_16x16x32_bf16 a[120:123], a[248:251], v[192:195], a[120:123]
    buffer_load_dwordx4 v93, s[12:15], s61 offen offset:3072 lds
    ds_read_b128 a[240:243], v3 offset:6144
    ds_read_b128 a[244:247], v3 offset:14336
    v_mfma_f32_16x16x32_bf16 a[120:123], a[252:255], v[200:203], a[120:123]
    s_add_u32 s61, s61, 0x20000
    s_and_b32 s61, s61, 0x3fffff
    v_cvt_pk_bf16_f32 v223, v246, v247
    v_bitop3_b32 v57, v57, v223, s37 bitop3:0xa8
    v_mfma_f32_16x16x32_bf16 a[124:127], a[248:251], v[196:199], a[124:127]
    v_cmp_ne_u32 vcc, 0, v57
    v_mfma_f32_16x16x32_bf16 a[124:127], a[252:255], v[204:207], a[124:127]
    buffer_load_dword v74, v73, s[16:19], s59 offen sc1
    ds_read_b128 a[248:251], v3 offset:7168
    ds_read_b128 a[252:255], v3 offset:15360
    s_cbranch_vccnz k2_tramp_120
k2_ret_121:
    v_lshrrev_b32 v6, 4, v1
    v_and_b32 v6, 31, v6
    s_getpc_b64 s[40:41]
pc_124:
    s_add_u32 s40, s40, op_head-pc_124
    s_addc_u32 s41, s41, 0
    v_lshlrev_b32 v224, 7, v6
    v_mov_b32 v225, s41
    v_add_co_u32 v224, vcc, s40, v224
    s_nop 1
    v_addc_co_u32 v225, vcc, 0, v225, vcc
    global_load_dword v7, v[224:225], off
    v_mfma_f32_16x16x32_bf16 v[252:255], v[60:63], v[212:215], v[252:255]
    s_lshl_b32 s31, s28, 19
    v_mov_b32 v249, v248
    s_nop 1
    v_permlane16_swap_b32 v248, v249
    v_mfma_f32_16x16x32_bf16 v[252:255], v[60:63], v[220:223], v[252:255]
    s_waitcnt lgkmcnt(0)
    s_nop 1
    v_add_f32 v248, v248, v249
    v_mov_b32 v249, v248
    v_mfma_f32_16x16x32_bf16 a[12:15], a[192:195], v[212:215], a[12:15]
    s_lshl_b32 s44, s39, 6
    s_nop 1
    v_permlane32_swap_b32 v248, v249
    s_nop 1
    v_mfma_f32_16x16x32_bf16 a[12:15], a[196:199], v[220:223], a[12:15]
    s_add_u32 s44, s44, s31
    s_add_u32 s45, s44, 131072
    v_add_f32 v248, v248, v249
    v_rcp_f32 v249, v248
    v_mfma_f32_16x16x32_bf16 a[28:31], a[200:203], v[212:215], a[28:31]
    s_add_u32 s46, s44, 262144
    v_rcp_f32 v248, v248
    s_nop 0
    s_add_u32 s47, s44, 393216
    v_mfma_f32_16x16x32_bf16 a[28:31], a[204:207], v[220:223], a[28:31]
    s_add_u32 s48, s44, 4096
    v_accvgpr_read_b32 v132, a8
    v_accvgpr_read_b32 v133, a9
    v_accvgpr_read_b32 v134, a10
    v_mfma_f32_16x16x32_bf16 a[44:47], a[208:211], v[212:215], a[44:47]
    s_add_u32 s49, s44, 135168
    v_accvgpr_read_b32 v135, a11
    v_accvgpr_read_b32 v136, a24
    v_accvgpr_read_b32 v137, a25
    v_mfma_f32_16x16x32_bf16 a[44:47], a[212:215], v[220:223], a[44:47]
    s_add_u32 s50, s44, 266240
    v_accvgpr_read_b32 v138, a26
    v_accvgpr_read_b32 v139, a27
    v_mul_f32 v132, v132, v248
    v_mfma_f32_16x16x32_bf16 a[60:63], a[216:219], v[212:215], a[60:63]
    s_add_u32 s51, s44, 397312
    v_mul_f32 v133, v133, v248
    v_mul_f32 v134, v134, v248
    v_mul_f32 v135, v135, v248
    v_mfma_f32_16x16x32_bf16 a[60:63], a[220:223], v[220:223], a[60:63]
    v_mul_f32 v136, v136, v248
    v_mul_f32 v137, v137, v248
    v_mul_f32 v138, v138, v248
    v_mfma_f32_16x16x32_bf16 a[76:79], a[224:227], v[212:215], a[76:79]
    v_mul_f32 v139, v139, v248
    v_cvt_pk_bf16_f32 v128, v132, v133
    v_cvt_pk_bf16_f32 v129, v134, v135
    v_mfma_f32_16x16x32_bf16 a[76:79], a[228:231], v[220:223], a[76:79]
    v_cvt_pk_bf16_f32 v130, v136, v137
    v_cvt_pk_bf16_f32 v131, v138, v139
    buffer_store_dwordx4 v[128:131], v1, s[24:27], s44 offen sc1
    v_mfma_f32_16x16x32_bf16 a[92:95], a[232:235], v[212:215], a[92:95]
    v_accvgpr_read_b32 v144, a40
    v_accvgpr_read_b32 v145, a41
    v_accvgpr_read_b32 v146, a42
    v_mfma_f32_16x16x32_bf16 a[92:95], a[236:239], v[220:223], a[92:95]
    v_accvgpr_read_b32 v147, a43
    v_accvgpr_read_b32 v148, a56
    v_mov_b32 v253, v252
    v_mfma_f32_16x16x32_bf16 a[108:111], a[240:243], v[212:215], a[108:111]
    v_accvgpr_read_b32 v149, a57
    v_accvgpr_read_b32 v150, a58
    s_nop 1
    v_mfma_f32_16x16x32_bf16 a[108:111], a[244:247], v[220:223], a[108:111]
    v_accvgpr_read_b32 v151, a59
    v_permlane16_swap_b32 v252, v253
    v_mul_f32 v144, v144, v248
    v_mfma_f32_16x16x32_bf16 a[124:127], a[248:251], v[212:215], a[124:127]
    s_nop 1
    v_mul_f32 v145, v145, v248
    v_add_f32 v252, v252, v253
    v_mfma_f32_16x16x32_bf16 a[124:127], a[252:255], v[220:223], a[124:127]
    v_mul_f32 v146, v146, v248
    v_mov_b32 v253, v252
    v_mul_f32 v147, v147, v248
    s_nop 1
    v_mul_f32 v148, v148, v248
    v_mul_f32 v149, v149, v248
    v_permlane32_swap_b32 v252, v253
    v_mul_f32 v150, v150, v248
    s_nop 1
    v_mul_f32 v151, v151, v248
    v_add_f32 v252, v252, v253
    v_cvt_pk_bf16_f32 v140, v144, v145
    v_rcp_f32 v253, v252
    v_cvt_pk_bf16_f32 v141, v146, v147
    v_rcp_f32 v252, v252
    v_cvt_pk_bf16_f32 v142, v148, v149
    s_nop 0
    v_cvt_pk_bf16_f32 v143, v150, v151
    buffer_store_dwordx4 v[140:143], v1, s[24:27], s45 offen sc1
    v_accvgpr_read_b32 v156, a72
    v_accvgpr_read_b32 v157, a73
    v_accvgpr_read_b32 v158, a74
    v_accvgpr_read_b32 v159, a75
    v_accvgpr_read_b32 v160, a88
    v_accvgpr_read_b32 v161, a89
    v_accvgpr_read_b32 v162, a90
    v_accvgpr_read_b32 v163, a91
    v_mul_f32 v156, v156, v248
    v_mul_f32 v157, v157, v248
    v_mul_f32 v158, v158, v248
    v_mul_f32 v159, v159, v248
    v_mul_f32 v160, v160, v248
    v_mul_f32 v161, v161, v248
    v_mul_f32 v162, v162, v248
    v_mul_f32 v163, v163, v248
    v_cvt_pk_bf16_f32 v152, v156, v157
    v_cvt_pk_bf16_f32 v153, v158, v159
    v_cvt_pk_bf16_f32 v154, v160, v161
    v_cvt_pk_bf16_f32 v155, v162, v163
    buffer_store_dwordx4 v[152:155], v1, s[24:27], s46 offen sc1
    v_accvgpr_read_b32 v168, a104
    v_accvgpr_read_b32 v169, a105
    v_accvgpr_read_b32 v170, a106
    v_accvgpr_read_b32 v171, a107
    v_accvgpr_read_b32 v172, a120
    v_accvgpr_read_b32 v173, a121
    v_accvgpr_read_b32 v174, a122
    v_accvgpr_read_b32 v175, a123
    v_mul_f32 v168, v168, v248
    v_mul_f32 v169, v169, v248
    v_mul_f32 v170, v170, v248
    v_mul_f32 v171, v171, v248
    v_mul_f32 v172, v172, v248
    v_mul_f32 v173, v173, v248
    v_mul_f32 v174, v174, v248
    v_mul_f32 v175, v175, v248
    v_cvt_pk_bf16_f32 v164, v168, v169
    v_cvt_pk_bf16_f32 v165, v170, v171
    v_cvt_pk_bf16_f32 v166, v172, v173
    v_cvt_pk_bf16_f32 v167, v174, v175
    buffer_store_dwordx4 v[164:167], v1, s[24:27], s47 offen sc1
    v_accvgpr_read_b32 v132, a12
    v_accvgpr_read_b32 v133, a13
    v_accvgpr_read_b32 v134, a14
    v_accvgpr_read_b32 v135, a15
    v_accvgpr_read_b32 v136, a28
    v_accvgpr_read_b32 v137, a29
    v_accvgpr_read_b32 v138, a30
    v_accvgpr_read_b32 v139, a31
    v_pk_mul_f32 v[132:133], v[132:133], v[252:253]
    v_pk_mul_f32 v[134:135], v[134:135], v[252:253]
    v_pk_mul_f32 v[136:137], v[136:137], v[252:253]
    v_pk_mul_f32 v[138:139], v[138:139], v[252:253]
    v_cvt_pk_bf16_f32 v128, v132, v133
    v_cvt_pk_bf16_f32 v129, v134, v135
    v_cvt_pk_bf16_f32 v130, v136, v137
    v_cvt_pk_bf16_f32 v131, v138, v139
    v_accvgpr_read_b32 v144, a44
    v_accvgpr_read_b32 v145, a45
    v_accvgpr_read_b32 v146, a46
    v_accvgpr_read_b32 v147, a47
    v_accvgpr_read_b32 v148, a60
    v_accvgpr_read_b32 v149, a61
    v_accvgpr_read_b32 v150, a62
    v_accvgpr_read_b32 v151, a63
    v_pk_mul_f32 v[144:145], v[144:145], v[252:253]
    v_pk_mul_f32 v[146:147], v[146:147], v[252:253]
    v_pk_mul_f32 v[148:149], v[148:149], v[252:253]
    v_pk_mul_f32 v[150:151], v[150:151], v[252:253]
    v_cvt_pk_bf16_f32 v140, v144, v145
    v_cvt_pk_bf16_f32 v141, v146, v147
    v_cvt_pk_bf16_f32 v142, v148, v149
    v_cvt_pk_bf16_f32 v143, v150, v151
    v_accvgpr_read_b32 v156, a76
    v_accvgpr_read_b32 v157, a77
    v_accvgpr_read_b32 v158, a78
    v_accvgpr_read_b32 v159, a79
    v_accvgpr_read_b32 v160, a92
    v_accvgpr_read_b32 v161, a93
    v_accvgpr_read_b32 v162, a94
    v_accvgpr_read_b32 v163, a95
    v_pk_mul_f32 v[156:157], v[156:157], v[252:253]
    v_pk_mul_f32 v[158:159], v[158:159], v[252:253]
    v_pk_mul_f32 v[160:161], v[160:161], v[252:253]
    v_pk_mul_f32 v[162:163], v[162:163], v[252:253]
    v_cvt_pk_bf16_f32 v152, v156, v157
    v_cvt_pk_bf16_f32 v153, v158, v159
    v_cvt_pk_bf16_f32 v154, v160, v161
    v_cvt_pk_bf16_f32 v155, v162, v163
    v_accvgpr_read_b32 v168, a108
    v_accvgpr_read_b32 v169, a109
    v_accvgpr_read_b32 v170, a110
    v_accvgpr_read_b32 v171, a111
    v_accvgpr_read_b32 v172, a124
    v_accvgpr_read_b32 v173, a125
    v_accvgpr_read_b32 v174, a126
    v_accvgpr_read_b32 v175, a127
    v_pk_mul_f32 v[168:169], v[168:169], v[252:253]
    v_pk_mul_f32 v[170:171], v[170:171], v[252:253]
    v_pk_mul_f32 v[172:173], v[172:173], v[252:253]
    v_pk_mul_f32 v[174:175], v[174:175], v[252:253]
    v_cvt_pk_bf16_f32 v164, v168, v169
    v_cvt_pk_bf16_f32 v165, v170, v171
    v_cvt_pk_bf16_f32 v166, v172, v173
    v_cvt_pk_bf16_f32 v167, v174, v175
    buffer_store_dwordx4 v[128:131], v1, s[24:27], s48 offen sc1
    buffer_store_dwordx4 v[140:143], v1, s[24:27], s49 offen sc1
    buffer_store_dwordx4 v[152:155], v1, s[24:27], s50 offen sc1
    buffer_store_dwordx4 v[164:167], v1, s[24:27], s51 offen sc1
op_head:
    s_load_dwordx2 s[28:29], s[0:1], 0
    s_load_dwordx2 s[42:43], s[0:1], 56
    s_waitcnt vmcnt(8)
    v_cmp_le_u32 vcc, 4, v74
    v_mov_b32 v56, 0
    v_mov_b32 v57, 0
    v_mov_b32 v58, 0
    v_mov_b32 v59, 0
    s_nop 1
    v_mfma_f32_32x32x16_bf16 v[128:143], v[56:59], v[56:59], 0
    v_mfma_f32_32x32x16_bf16 v[144:159], v[56:59], v[56:59], 0
    v_mfma_f32_32x32x16_bf16 v[160:175], v[56:59], v[56:59], 0
    v_mfma_f32_32x32x16_bf16 v[176:191], v[56:59], v[56:59], 0
    s_mov_b32 s33, vcc_lo
    s_bitcmp1_b32 s33, 0
    s_cbranch_scc0 op_late_125
    buffer_load_dwordx4 a[128:131], v88, s[8:11], s62 offen offset:0 sc1
    buffer_load_dwordx4 a[132:135], v88, s[8:11], s62 offen offset:1024 sc1
    buffer_load_dwordx4 a[136:139], v89, s[8:11], s62 offen offset:0 sc1
    buffer_load_dwordx4 a[140:143], v89, s[8:11], s62 offen offset:1024 sc1
    s_add_u32 s62, s62, 0x40000
    s_and_b32 s62, s62, 0x7fffff
    buffer_load_dwordx4 a[144:147], v88, s[8:11], s62 offen offset:0 sc1
    buffer_load_dwordx4 a[148:151], v88, s[8:11], s62 offen offset:1024 sc1
    buffer_load_dwordx4 a[152:155], v89, s[8:11], s62 offen offset:0 sc1
    buffer_load_dwordx4 a[156:159], v89, s[8:11], s62 offen offset:1024 sc1
    s_add_u32 s62, s62, 0x40000
    s_and_b32 s62, s62, 0x7fffff
    buffer_load_dwordx4 a[160:163], v88, s[8:11], s62 offen offset:0 sc1
    buffer_load_dwordx4 a[164:167], v88, s[8:11], s62 offen offset:1024 sc1
    buffer_load_dwordx4 a[168:171], v89, s[8:11], s62 offen offset:0 sc1
    buffer_load_dwordx4 a[172:175], v89, s[8:11], s62 offen offset:1024 sc1
    s_add_u32 s62, s62, 0x40000
    s_and_b32 s62, s62, 0x7fffff
    s_waitcnt vmcnt(12)
    s_branch op_join_126
op_late_125:
    s_waitcnt vmcnt(0)
op_join_126:
    s_barrier
    s_cmp_eq_u32 s30, 0
    s_cbranch_scc1 k12_ool_127
k12_oolret_128:
    s_bitcmp0_b32 s33, 0
    s_cbranch_scc1 k12_ool_131
k12_oolret_132:
    ds_read_b64_tr_b16 a[0:1], v64 offset:0
    ds_read_b64_tr_b16 a[2:3], v64 offset:4096
    ds_read_b64_tr_b16 a[4:5], v65 offset:0
    ds_read_b64_tr_b16 a[6:7], v65 offset:4096
    ds_read_b64_tr_b16 a[8:9], v66 offset:0
    ds_read_b64_tr_b16 a[10:11], v66 offset:4096
    ds_read_b64_tr_b16 a[12:13], v67 offset:0
    ds_read_b64_tr_b16 a[14:15], v67 offset:4096
    ds_read_b64_tr_b16 a[16:17], v68 offset:0
    ds_read_b64_tr_b16 a[18:19], v68 offset:4096
    ds_read_b64_tr_b16 a[20:21], v69 offset:0
    ds_read_b64_tr_b16 a[22:23], v69 offset:4096
    ds_read_b64_tr_b16 a[24:25], v70 offset:0
    ds_read_b64_tr_b16 a[26:27], v70 offset:4096
    ds_read_b64_tr_b16 a[28:29], v71 offset:0
    ds_read_b64_tr_b16 a[30:31], v71 offset:4096
    ds_read_b64_tr_b16 a[32:33], v64 offset:8192
    ds_read_b64_tr_b16 a[34:35], v64 offset:12288
    ds_read_b64_tr_b16 a[36:37], v65 offset:8192
    ds_read_b64_tr_b16 a[38:39], v65 offset:12288
    ds_read_b64_tr_b16 a[40:41], v66 offset:8192
    ds_read_b64_tr_b16 a[42:43], v66 offset:12288
    ds_read_b64_tr_b16 a[44:45], v67 offset:8192
    ds_read_b64_tr_b16 a[46:47], v67 offset:12288
    ds_read_b64_tr_b16 a[48:49], v68 offset:8192
    ds_read_b64_tr_b16 a[50:51], v68 offset:12288
    ds_read_b64_tr_b16 a[52:53], v69 offset:8192
    ds_read_b64_tr_b16 a[54:55], v69 offset:12288
    ds_read_b64_tr_b16 a[56:57], v70 offset:8192
    ds_read_b64_tr_b16 a[58:59], v70 offset:12288
    ds_read_b64_tr_b16 a[60:61], v71 offset:8192
    ds_read_b64_tr_b16 a[62:63], v71 offset:12288
    s_add_u32 s24, s6, 0x4000000
    s_addc_u32 s25, s7, 0
    s_and_b32 s25, s25, 0xffff
    s_mov_b32 s26, 0x400000
    s_mov_b32 s27, 0x00020000
    s_add_u32 s36, s6, 0x5000000
    s_addc_u32 s37, s7, 0
    s_and_b32 s37, s37, 0xffff
    s_mov_b32 s38, 0x800000
    s_mov_b32 s39, 0x00020000
    s_add_u32 s48, s6, 0x4807000
    s_addc_u32 s49, s7, 0
    s_and_b32 s49, s49, 0xffff
    s_mov_b32 s50, 0x8000
    s_mov_b32 s51, 0x00020000
    s_lshl_b32 s52, s2, 14
    s_add_u32 s52, s52, s60
    s_xor_b32 s53, s52, 0x10000
    s_lshl_b32 s57, s2, 7
    s_xor_b32 s58, s57, 0x200
    v_lshrrev_b32 v56, 4, v1
    s_lshl_b32 s31, s30, 6
    s_and_b32 s31, s31, 64
    v_add_u32 v56, s31, v56
    s_mov_b32 s31, (code_end-op_tail)/128
    v_min_u32 v56, s31, v56
    s_getpc_b64 s[40:41]
pc_133:
    s_add_u32 s40, s40, op_tail-pc_133
    s_addc_u32 s41, s41, 0
    v_lshlrev_b32 v82, 7, v56
    v_mov_b32 v83, s41
    v_add_co_u32 v82, vcc, s40, v82
    s_nop 1
    v_addc_co_u32 v83, vcc, 0, v83, vcc
    v_lshlrev_b32 v94, 3, v1
    s_and_b32 s35, s2, 7
    s_mul_i32 s35, s35, 28
    s_lshr_b32 s31, s2, 3
    s_add_u32 s55, s35, s31
    s_lshl_b32 s3, s55, 15
    s_lshl_b32 s31, s30, 13
    s_add_u32 s3, s3, s31
    s_add_u32 s35, s31, 65536
    s_mov_b32 s63, 0
    s_waitcnt vmcnt(8) lgkmcnt(0)
    s_mov_b32 s20, s28
    s_and_b32 s21, s29, 0xffff
    s_mov_b32 s22, 0x400000
    s_mov_b32 s23, 0x00020000
    s_mov_b32 s44, s42
    s_and_b32 s45, s43, 0xffff
    s_mov_b32 s46, 0x800
    s_mov_b32 s47, 0x00020000
op_loop_134:
    v_mfma_f32_16x16x32_bf16 v[160:163], a[16:19], a[128:131], v[160:163]
    s_add_u32 m0, s60, 49152
    ds_read_b64_tr_b16 a[64:65], v64 offset:16384
    ds_read_b64_tr_b16 a[66:67], v64 offset:20480
    v_mfma_f32_16x16x32_bf16 v[160:163], a[48:51], a[136:139], v[160:163]
    buffer_load_dwordx4 v90, s[12:15], s61 offen offset:0 lds
    ds_read_b64_tr_b16 a[68:69], v65 offset:16384
    v_mfma_f32_16x16x32_bf16 v[164:167], a[16:19], a[132:135], v[164:167]
    ds_read_b64_tr_b16 a[70:71], v65 offset:20480
    ds_read_b64_tr_b16 a[72:73], v66 offset:16384
    v_mfma_f32_16x16x32_bf16 v[164:167], a[48:51], a[140:143], v[164:167]
    buffer_load_dwordx4 v91, s[12:15], s61 offen offset:1024 lds
    ds_read_b64_tr_b16 a[74:75], v66 offset:20480
    v_mfma_f32_16x16x32_bf16 v[168:171], a[20:23], a[128:131], v[168:171]
    ds_read_b64_tr_b16 a[76:77], v67 offset:16384
    ds_read_b64_tr_b16 a[78:79], v67 offset:20480
    v_mfma_f32_16x16x32_bf16 v[168:171], a[52:55], a[136:139], v[168:171]
    ds_read_b64_tr_b16 a[80:81], v68 offset:16384
    v_mfma_f32_16x16x32_bf16 v[172:175], a[20:23], a[132:135], v[172:175]
    ds_read_b64_tr_b16 a[82:83], v68 offset:20480
    v_mfma_f32_16x16x32_bf16 v[172:175], a[52:55], a[140:143], v[172:175]
    buffer_load_dwordx4 v92, s[12:15], s61 offen offset:2048 lds
    ds_read_b64_tr_b16 a[84:85], v69 offset:16384
    v_mfma_f32_16x16x32_bf16 v[176:179], a[24:27], a[128:131], v[176:179]
    ds_read_b64_tr_b16 a[86:87], v69 offset:20480
    ds_read_b64_tr_b16 a[88:89], v70 offset:16384
    v_mfma_f32_16x16x32_bf16 v[176:179], a[56:59], a[136:139], v[176:179]
    ds_read_b64_tr_b16 a[90:91], v70 offset:20480
    v_mfma_f32_16x16x32_bf16 v[180:183], a[24:27], a[132:135], v[180:183]
    buffer_load_dwordx4 v93, s[12:15], s61 offen offset:3072 lds
    ds_read_b64_tr_b16 a[92:93], v71 offset:16384
    v_mfma_f32_16x16x32_bf16 v[180:183], a[56:59], a[140:143], v[180:183]
    ds_read_b64_tr_b16 a[94:95], v71 offset:20480
    ds_read_b64_tr_b16 a[96:97], v64 offset:24576
    v_mfma_f32_16x16x32_bf16 v[184:187], a[28:31], a[128:131], v[184:187]
    ds_read_b64_tr_b16 a[98:99], v64 offset:28672
    v_mfma_f32_16x16x32_bf16 v[184:187], a[60:63], a[136:139], v[184:187]
    ds_read_b64_tr_b16 a[100:101], v65 offset:24576
    v_mfma_f32_16x16x32_bf16 v[188:191], a[28:31], a[132:135], v[188:191]
    buffer_load_dwordx4 a[176:179], v88, s[8:11], s62 offen offset:0 sc1
    ds_read_b64_tr_b16 a[102:103], v65 offset:28672
    v_mfma_f32_16x16x32_bf16 v[188:191], a[60:63], a[140:143], v[188:191]
    s_add_u32 s61, s61, 0x20000
    s_and_b32 s61, s61, 0x3fffff
    ds_read_b64_tr_b16 a[104:105], v66 offset:24576
    ds_read_b64_tr_b16 a[106:107], v66 offset:28672
    v_mfma_f32_16x16x32_bf16 v[128:131], a[0:3], a[128:131], v[128:131]
    ds_read_b64_tr_b16 a[108:109], v67 offset:24576
    v_mfma_f32_16x16x32_bf16 v[128:131], a[32:35], a[136:139], v[128:131]
    buffer_load_dwordx4 a[180:183], v88, s[8:11], s62 offen offset:1024 sc1
    ds_read_b64_tr_b16 a[110:111], v67 offset:28672
    v_mfma_f32_16x16x32_bf16 v[132:135], a[0:3], a[132:135], v[132:135]
    ds_read_b64_tr_b16 a[112:113], v68 offset:24576
    v_mfma_f32_16x16x32_bf16 v[132:135], a[32:35], a[140:143], v[132:135]
    ds_read_b64_tr_b16 a[114:115], v68 offset:28672
    ds_read_b64_tr_b16 a[116:117], v69 offset:24576
    v_mfma_f32_16x16x32_bf16 v[136:139], a[4:7], a[128:131], v[136:139]
    ds_read_b64_tr_b16 a[118:119], v69 offset:28672
    v_mfma_f32_16x16x32_bf16 v[136:139], a[36:39], a[136:139], v[136:139]
    buffer_load_dwordx4 a[184:187], v89, s[8:11], s62 offen offset:0 sc1
    ds_read_b64_tr_b16 a[120:121], v70 offset:24576
    v_mfma_f32_16x16x32_bf16 v[140:143], a[4:7], a[132:135], v[140:143]
    ds_read_b64_tr_b16 a[122:123], v70 offset:28672
    ds_read_b64_tr_b16 a[124:125], v71 offset:24576
    v_mfma_f32_16x16x32_bf16 v[140:143], a[36:39], a[140:143], v[140:143]
    ds_read_b64_tr_b16 a[126:127], v71 offset:28672
    v_mfma_f32_16x16x32_bf16 v[144:147], a[8:11], a[128:131], v[144:147]
    buffer_load_dwordx4 a[188:191], v89, s[8:11], s62 offen offset:1024 sc1
    v_mfma_f32_16x16x32_bf16 v[144:147], a[40:43], a[136:139], v[144:147]
    v_mfma_f32_16x16x32_bf16 v[148:151], a[8:11], a[132:135], v[148:151]
    v_mfma_f32_16x16x32_bf16 v[148:151], a[40:43], a[140:143], v[148:151]
    v_mfma_f32_16x16x32_bf16 v[152:155], a[12:15], a[128:131], v[152:155]
    s_cmp_eq_u32 s63, 7
    s_cbranch_scc1 k12_ool_137
k12_oolret_138:
    v_mfma_f32_16x16x32_bf16 v[152:155], a[44:47], a[136:139], v[152:155]
    s_add_u32 s62, s62, 0x40000
    s_and_b32 s62, s62, 0x7fffff
    v_mfma_f32_16x16x32_bf16 v[156:159], a[12:15], a[132:135], v[156:159]
    v_mfma_f32_16x16x32_bf16 v[156:159], a[44:47], a[140:143], v[156:159]
    s_waitcnt vmcnt(12) lgkmcnt(0)
    s_barrier
    v_mfma_f32_16x16x32_bf16 v[160:163], a[80:83], a[144:147], v[160:163]
    s_add_u32 s32, s63, 1
    s_lshr_b32 s32, s32, 1
    ds_read_b64_tr_b16 a[0:1], v64 offset:32768
    v_cmp_le_u32 vcc, 4, v74
    v_mfma_f32_16x16x32_bf16 v[160:163], a[112:115], a[152:155], v[160:163]
    s_add_u32 m0, s60, 0
    ds_read_b64_tr_b16 a[2:3], v64 offset:36864
    ds_read_b64_tr_b16 a[4:5], v65 offset:32768
    v_mfma_f32_16x16x32_bf16 v[164:167], a[80:83], a[148:151], v[164:167]
    s_or_b32 s33, vcc_lo, 16
    buffer_load_dwordx4 v90, s[12:15], s61 offen offset:0 lds
    ds_read_b64_tr_b16 a[6:7], v65 offset:36864
    v_mfma_f32_16x16x32_bf16 v[164:167], a[112:115], a[156:159], v[164:167]
    ds_read_b64_tr_b16 a[8:9], v66 offset:32768
    ds_read_b64_tr_b16 a[10:11], v66 offset:36864
    v_mfma_f32_16x16x32_bf16 v[168:171], a[84:87], a[144:147], v[168:171]
    buffer_load_dwordx4 v91, s[12:15], s61 offen offset:1024 lds
    ds_read_b64_tr_b16 a[12:13], v67 offset:32768
    v_mfma_f32_16x16x32_bf16 v[168:171], a[116:119], a[152:155], v[168:171]
    ds_read_b64_tr_b16 a[14:15], v67 offset:36864
    ds_read_b64_tr_b16 a[16:17], v68 offset:32768
    v_mfma_f32_16x16x32_bf16 v[172:175], a[84:87], a[148:151], v[172:175]
    s_bitcmp0_b32 s33, s32
    s_cbranch_scc1 k12_ool_141
k12_oolret_142:
    v_mfma_f32_16x16x32_bf16 v[172:175], a[116:119], a[156:159], v[172:175]
    ds_read_b64_tr_b16 a[18:19], v68 offset:36864
    ds_read_b64_tr_b16 a[20:21], v69 offset:32768
    v_mfma_f32_16x16x32_bf16 v[176:179], a[88:91], a[144:147], v[176:179]
    buffer_load_dwordx4 v92, s[12:15], s61 offen offset:2048 lds
    ds_read_b64_tr_b16 a[22:23], v69 offset:36864
    v_mfma_f32_16x16x32_bf16 v[176:179], a[120:123], a[152:155], v[176:179]
    ds_read_b64_tr_b16 a[24:25], v70 offset:32768
    ds_read_b64_tr_b16 a[26:27], v70 offset:36864
    v_mfma_f32_16x16x32_bf16 v[180:183], a[88:91], a[148:151], v[180:183]
    buffer_load_dwordx4 v93, s[12:15], s61 offen offset:3072 lds
    ds_read_b64_tr_b16 a[28:29], v71 offset:32768
    v_mfma_f32_16x16x32_bf16 v[180:183], a[120:123], a[156:159], v[180:183]
    ds_read_b64_tr_b16 a[30:31], v71 offset:36864
    ds_read_b64_tr_b16 a[32:33], v64 offset:40960
    v_mfma_f32_16x16x32_bf16 v[184:187], a[92:95], a[144:147], v[184:187]
    ds_read_b64_tr_b16 a[34:35], v64 offset:45056
    v_mfma_f32_16x16x32_bf16 v[184:187], a[124:127], a[152:155], v[184:187]
    ds_read_b64_tr_b16 a[36:37], v65 offset:40960
    v_mfma_f32_16x16x32_bf16 v[188:191], a[92:95], a[148:151], v[188:191]
    buffer_load_dwordx4 a[128:131], v88, s[8:11], s62 offen offset:0 sc1
    ds_read_b64_tr_b16 a[38:39], v65 offset:45056
    v_mfma_f32_16x16x32_bf16 v[188:191], a[124:127], a[156:159], v[188:191]
    s_add_u32 s61, s61, 0x20000
    s_and_b32 s61, s61, 0x3fffff
    ds_read_b64_tr_b16 a[40:41], v66 offset:40960
    ds_read_b64_tr_b16 a[42:43], v66 offset:45056
    v_mfma_f32_16x16x32_bf16 v[128:131], a[64:67], a[144:147], v[128:131]
    ds_read_b64_tr_b16 a[44:45], v67 offset:40960
    v_mfma_f32_16x16x32_bf16 v[128:131], a[96:99], a[152:155], v[128:131]
    buffer_load_dwordx4 a[132:135], v88, s[8:11], s62 offen offset:1024 sc1
    ds_read_b64_tr_b16 a[46:47], v67 offset:45056
    v_mfma_f32_16x16x32_bf16 v[132:135], a[64:67], a[148:151], v[132:135]
    ds_read_b64_tr_b16 a[48:49], v68 offset:40960
    v_mfma_f32_16x16x32_bf16 v[132:135], a[96:99], a[156:159], v[132:135]
    ds_read_b64_tr_b16 a[50:51], v68 offset:45056
    ds_read_b64_tr_b16 a[52:53], v69 offset:40960
    v_mfma_f32_16x16x32_bf16 v[136:139], a[68:71], a[144:147], v[136:139]
    ds_read_b64_tr_b16 a[54:55], v69 offset:45056
    v_mfma_f32_16x16x32_bf16 v[136:139], a[100:103], a[152:155], v[136:139]
    buffer_load_dwordx4 a[136:139], v89, s[8:11], s62 offen offset:0 sc1
    ds_read_b64_tr_b16 a[56:57], v70 offset:40960
    v_mfma_f32_16x16x32_bf16 v[140:143], a[68:71], a[148:151], v[140:143]
    ds_read_b64_tr_b16 a[58:59], v70 offset:45056
    ds_read_b64_tr_b16 a[60:61], v71 offset:40960
    v_mfma_f32_16x16x32_bf16 v[140:143], a[100:103], a[156:159], v[140:143]
    ds_read_b64_tr_b16 a[62:63], v71 offset:45056
    v_mfma_f32_16x16x32_bf16 v[144:147], a[72:75], a[144:147], v[144:147]
    buffer_load_dwordx4 a[140:143], v89, s[8:11], s62 offen offset:1024 sc1
    v_mfma_f32_16x16x32_bf16 v[144:147], a[104:107], a[152:155], v[144:147]
    v_mfma_f32_16x16x32_bf16 v[148:151], a[72:75], a[148:151], v[148:151]
    s_cmp_eq_u32 s63, 6
    s_cbranch_scc1 k12_ool_143
k12_oolret_144:
    v_mfma_f32_16x16x32_bf16 v[148:151], a[104:107], a[156:159], v[148:151]
    v_mfma_f32_16x16x32_bf16 v[152:155], a[76:79], a[144:147], v[152:155]
    v_mfma_f32_16x16x32_bf16 v[152:155], a[108:111], a[152:155], v[152:155]
    s_add_u32 s62, s62, 0x40000
    s_and_b32 s62, s62, 0x7fffff
    v_mfma_f32_16x16x32_bf16 v[156:159], a[76:79], a[148:151], v[156:159]
    v_mfma_f32_16x16x32_bf16 v[156:159], a[108:111], a[156:159], v[156:159]
    s_waitcnt vmcnt(12) lgkmcnt(0)
    s_barrier
    v_mfma_f32_16x16x32_bf16 v[160:163], a[16:19], a[160:163], v[160:163]
    s_add_u32 m0, s60, 16384
    buffer_load_dword v74, v73, s[16:19], s59 offen sc1
    ds_read_b64_tr_b16 a[64:65], v64 offset:49152
    v_mfma_f32_16x16x32_bf16 v[160:163], a[48:51], a[168:171], v[160:163]
    buffer_load_dwordx4 v90, s[12:15], s61 offen offset:0 lds
    ds_read_b64_tr_b16 a[66:67], v64 offset:53248
    v_mfma_f32_16x16x32_bf16 v[164:167], a[16:19], a[164:167], v[164:167]
    ds_read_b64_tr_b16 a[68:69], v65 offset:49152
    ds_read_b64_tr_b16 a[70:71], v65 offset:53248
    v_mfma_f32_16x16x32_bf16 v[164:167], a[48:51], a[172:175], v[164:167]
    ds_read_b64_tr_b16 a[72:73], v66 offset:49152
    ds_read_b64_tr_b16 a[74:75], v66 offset:53248
    v_mfma_f32_16x16x32_bf16 v[168:171], a[20:23], a[160:163], v[168:171]
    buffer_load_dwordx4 v91, s[12:15], s61 offen offset:1024 lds
    ds_read_b64_tr_b16 a[76:77], v67 offset:49152
    v_mfma_f32_16x16x32_bf16 v[168:171], a[52:55], a[168:171], v[168:171]
    ds_read_b64_tr_b16 a[78:79], v67 offset:53248
    ds_read_b64_tr_b16 a[80:81], v68 offset:49152
    v_mfma_f32_16x16x32_bf16 v[172:175], a[20:23], a[164:167], v[172:175]
    ds_read_b64_tr_b16 a[82:83], v68 offset:53248
    v_mfma_f32_16x16x32_bf16 v[172:175], a[52:55], a[172:175], v[172:175]
    buffer_load_dwordx4 v92, s[12:15], s61 offen offset:2048 lds
    ds_read_b64_tr_b16 a[84:85], v69 offset:49152
    v_mfma_f32_16x16x32_bf16 v[176:179], a[24:27], a[160:163], v[176:179]
    ds_read_b64_tr_b16 a[86:87], v69 offset:53248
    ds_read_b64_tr_b16 a[88:89], v70 offset:49152
    v_mfma_f32_16x16x32_bf16 v[176:179], a[56:59], a[168:171], v[176:179]
    ds_read_b64_tr_b16 a[90:91], v70 offset:53248
    v_mfma_f32_16x16x32_bf16 v[180:183], a[24:27], a[164:167], v[180:183]
    buffer_load_dwordx4 v93, s[12:15], s61 offen offset:3072 lds
    ds_read_b64_tr_b16 a[92:93], v71 offset:49152
    v_mfma_f32_16x16x32_bf16 v[180:183], a[56:59], a[172:175], v[180:183]
    ds_read_b64_tr_b16 a[94:95], v71 offset:53248
    ds_read_b64_tr_b16 a[96:97], v64 offset:57344
    v_mfma_f32_16x16x32_bf16 v[184:187], a[28:31], a[160:163], v[184:187]
    ds_read_b64_tr_b16 a[98:99], v64 offset:61440
    v_mfma_f32_16x16x32_bf16 v[184:187], a[60:63], a[168:171], v[184:187]
    ds_read_b64_tr_b16 a[100:101], v65 offset:57344
    v_mfma_f32_16x16x32_bf16 v[188:191], a[28:31], a[164:167], v[188:191]
    buffer_load_dwordx4 a[144:147], v88, s[8:11], s62 offen offset:0 sc1
    ds_read_b64_tr_b16 a[102:103], v65 offset:61440
    v_mfma_f32_16x16x32_bf16 v[188:191], a[60:63], a[172:175], v[188:191]
    s_add_u32 s61, s61, 0x20000
    s_and_b32 s61, s61, 0x3fffff
    ds_read_b64_tr_b16 a[104:105], v66 offset:57344
    ds_read_b64_tr_b16 a[106:107], v66 offset:61440
    v_mfma_f32_16x16x32_bf16 v[128:131], a[0:3], a[160:163], v[128:131]
    ds_read_b64_tr_b16 a[108:109], v67 offset:57344
    v_mfma_f32_16x16x32_bf16 v[128:131], a[32:35], a[168:171], v[128:131]
    buffer_load_dwordx4 a[148:151], v88, s[8:11], s62 offen offset:1024 sc1
    ds_read_b64_tr_b16 a[110:111], v67 offset:61440
    v_mfma_f32_16x16x32_bf16 v[132:135], a[0:3], a[164:167], v[132:135]
    ds_read_b64_tr_b16 a[112:113], v68 offset:57344
    v_mfma_f32_16x16x32_bf16 v[132:135], a[32:35], a[172:175], v[132:135]
    ds_read_b64_tr_b16 a[114:115], v68 offset:61440
    ds_read_b64_tr_b16 a[116:117], v69 offset:57344
    v_mfma_f32_16x16x32_bf16 v[136:139], a[4:7], a[160:163], v[136:139]
    ds_read_b64_tr_b16 a[118:119], v69 offset:61440
    v_mfma_f32_16x16x32_bf16 v[136:139], a[36:39], a[168:171], v[136:139]
    buffer_load_dwordx4 a[152:155], v89, s[8:11], s62 offen offset:0 sc1
    ds_read_b64_tr_b16 a[120:121], v70 offset:57344
    v_mfma_f32_16x16x32_bf16 v[140:143], a[4:7], a[164:167], v[140:143]
    ds_read_b64_tr_b16 a[122:123], v70 offset:61440
    ds_read_b64_tr_b16 a[124:125], v71 offset:57344
    v_mfma_f32_16x16x32_bf16 v[140:143], a[36:39], a[172:175], v[140:143]
    ds_read_b64_tr_b16 a[126:127], v71 offset:61440
    v_mfma_f32_16x16x32_bf16 v[144:147], a[8:11], a[160:163], v[144:147]
    buffer_load_dwordx4 a[156:159], v89, s[8:11], s62 offen offset:1024 sc1
    v_mfma_f32_16x16x32_bf16 v[144:147], a[40:43], a[168:171], v[144:147]
    v_mfma_f32_16x16x32_bf16 v[148:151], a[8:11], a[164:167], v[148:151]
    v_mfma_f32_16x16x32_bf16 v[148:151], a[40:43], a[172:175], v[148:151]
    v_mfma_f32_16x16x32_bf16 v[152:155], a[12:15], a[160:163], v[152:155]
    v_mfma_f32_16x16x32_bf16 v[152:155], a[44:47], a[168:171], v[152:155]
    s_add_u32 s62, s62, 0x40000
    s_and_b32 s62, s62, 0x7fffff
    v_mfma_f32_16x16x32_bf16 v[156:159], a[12:15], a[164:167], v[156:159]
    v_mfma_f32_16x16x32_bf16 v[156:159], a[44:47], a[172:175], v[156:159]
    s_waitcnt vmcnt(12) lgkmcnt(0)
    s_barrier
    v_mfma_f32_16x16x32_bf16 v[160:163], a[80:83], a[176:179], v[160:163]
    s_add_u32 m0, s60, 32768
    ds_read_b64_tr_b16 a[0:1], v64 offset:0
    ds_read_b64_tr_b16 a[2:3], v64 offset:4096
    v_mfma_f32_16x16x32_bf16 v[160:163], a[112:115], a[184:187], v[160:163]
    buffer_load_dwordx4 v90, s[12:15], s61 offen offset:0 lds
    ds_read_b64_tr_b16 a[4:5], v65 offset:0
    v_mfma_f32_16x16x32_bf16 v[164:167], a[80:83], a[180:183], v[164:167]
    ds_read_b64_tr_b16 a[6:7], v65 offset:4096
    ds_read_b64_tr_b16 a[8:9], v66 offset:0
    v_mfma_f32_16x16x32_bf16 v[164:167], a[112:115], a[188:191], v[164:167]
    buffer_load_dwordx4 v91, s[12:15], s61 offen offset:1024 lds
    ds_read_b64_tr_b16 a[10:11], v66 offset:4096
    v_mfma_f32_16x16x32_bf16 v[168:171], a[84:87], a[176:179], v[168:171]
    ds_read_b64_tr_b16 a[12:13], v67 offset:0
    ds_read_b64_tr_b16 a[14:15], v67 offset:4096
    v_mfma_f32_16x16x32_bf16 v[168:171], a[116:119], a[184:187], v[168:171]
    ds_read_b64_tr_b16 a[16:17], v68 offset:0
    v_mfma_f32_16x16x32_bf16 v[172:175], a[84:87], a[180:183], v[172:175]
    ds_read_b64_tr_b16 a[18:19], v68 offset:4096
    v_mfma_f32_16x16x32_bf16 v[172:175], a[116:119], a[188:191], v[172:175]
    buffer_load_dwordx4 v92, s[12:15], s61 offen offset:2048 lds
    ds_read_b64_tr_b16 a[20:21], v69 offset:0
    v_mfma_f32_16x16x32_bf16 v[176:179], a[88:91], a[176:179], v[176:179]
    ds_read_b64_tr_b16 a[22:23], v69 offset:4096
    ds_read_b64_tr_b16 a[24:25], v70 offset:0
    v_mfma_f32_16x16x32_bf16 v[176:179], a[120:123], a[184:187], v[176:179]
    ds_read_b64_tr_b16 a[26:27], v70 offset:4096
    v_mfma_f32_16x16x32_bf16 v[180:183], a[88:91], a[180:183], v[180:183]
    buffer_load_dwordx4 v93, s[12:15], s61 offen offset:3072 lds
    ds_read_b64_tr_b16 a[28:29], v71 offset:0
    v_mfma_f32_16x16x32_bf16 v[180:183], a[120:123], a[188:191], v[180:183]
    ds_read_b64_tr_b16 a[30:31], v71 offset:4096
    ds_read_b64_tr_b16 a[32:33], v64 offset:8192
    v_mfma_f32_16x16x32_bf16 v[184:187], a[92:95], a[176:179], v[184:187]
    ds_read_b64_tr_b16 a[34:35], v64 offset:12288
    v_mfma_f32_16x16x32_bf16 v[184:187], a[124:127], a[184:187], v[184:187]
    ds_read_b64_tr_b16 a[36:37], v65 offset:8192
    v_mfma_f32_16x16x32_bf16 v[188:191], a[92:95], a[180:183], v[188:191]
    buffer_load_dwordx4 a[160:163], v88, s[8:11], s62 offen offset:0 sc1
    ds_read_b64_tr_b16 a[38:39], v65 offset:12288
    v_mfma_f32_16x16x32_bf16 v[188:191], a[124:127], a[188:191], v[188:191]
    s_add_u32 s61, s61, 0x20000
    s_and_b32 s61, s61, 0x3fffff
    ds_read_b64_tr_b16 a[40:41], v66 offset:8192
    ds_read_b64_tr_b16 a[42:43], v66 offset:12288
    v_mfma_f32_16x16x32_bf16 v[128:131], a[64:67], a[176:179], v[128:131]
    ds_read_b64_tr_b16 a[44:45], v67 offset:8192
    v_mfma_f32_16x16x32_bf16 v[128:131], a[96:99], a[184:187], v[128:131]
    buffer_load_dwordx4 a[164:167], v88, s[8:11], s62 offen offset:1024 sc1
    ds_read_b64_tr_b16 a[46:47], v67 offset:12288
    v_mfma_f32_16x16x32_bf16 v[132:135], a[64:67], a[180:183], v[132:135]
    ds_read_b64_tr_b16 a[48:49], v68 offset:8192
    v_mfma_f32_16x16x32_bf16 v[132:135], a[96:99], a[188:191], v[132:135]
    ds_read_b64_tr_b16 a[50:51], v68 offset:12288
    ds_read_b64_tr_b16 a[52:53], v69 offset:8192
    v_mfma_f32_16x16x32_bf16 v[136:139], a[68:71], a[176:179], v[136:139]
    ds_read_b64_tr_b16 a[54:55], v69 offset:12288
    v_mfma_f32_16x16x32_bf16 v[136:139], a[100:103], a[184:187], v[136:139]
    buffer_load_dwordx4 a[168:171], v89, s[8:11], s62 offen offset:0 sc1
    ds_read_b64_tr_b16 a[56:57], v70 offset:8192
    v_mfma_f32_16x16x32_bf16 v[140:143], a[68:71], a[180:183], v[140:143]
    ds_read_b64_tr_b16 a[58:59], v70 offset:12288
    ds_read_b64_tr_b16 a[60:61], v71 offset:8192
    v_mfma_f32_16x16x32_bf16 v[140:143], a[100:103], a[188:191], v[140:143]
    ds_read_b64_tr_b16 a[62:63], v71 offset:12288
    v_mfma_f32_16x16x32_bf16 v[144:147], a[72:75], a[176:179], v[144:147]
    buffer_load_dwordx4 a[172:175], v89, s[8:11], s62 offen offset:1024 sc1
    v_mfma_f32_16x16x32_bf16 v[144:147], a[104:107], a[184:187], v[144:147]
    v_mfma_f32_16x16x32_bf16 v[148:151], a[72:75], a[180:183], v[148:151]
    v_mfma_f32_16x16x32_bf16 v[148:151], a[104:107], a[188:191], v[148:151]
    v_mfma_f32_16x16x32_bf16 v[152:155], a[76:79], a[176:179], v[152:155]
    v_mfma_f32_16x16x32_bf16 v[152:155], a[108:111], a[184:187], v[152:155]
    s_add_u32 s62, s62, 0x40000
    s_and_b32 s62, s62, 0x7fffff
    v_mfma_f32_16x16x32_bf16 v[156:159], a[76:79], a[180:183], v[156:159]
    s_add_u32 s63, s63, 1
    v_mfma_f32_16x16x32_bf16 v[156:159], a[108:111], a[188:191], v[156:159]
    s_waitcnt vmcnt(12) lgkmcnt(0)
    s_barrier
    s_cmp_lt_u32 s63, 8
    s_cbranch_scc1 op_loop_134
op_tail:
    s_nop 1
    v_cvt_pk_bf16_f32 v160, v160, v161
    v_cvt_pk_bf16_f32 v161, v162, v163
    v_cvt_pk_bf16_f32 v162, v164, v165
    v_cvt_pk_bf16_f32 v163, v166, v167
    v_min_u32 v160, -2, v160
    v_min_u32 v161, -2, v161
    v_min_u32 v162, -2, v162
    v_min_u32 v163, -2, v163
    buffer_store_dwordx4 v[160:163], v1, s[36:39], s52 offen offset:0 sc1
    v_cvt_pk_bf16_f32 v168, v168, v169
    v_cvt_pk_bf16_f32 v169, v170, v171
    v_cvt_pk_bf16_f32 v170, v172, v173
    v_cvt_pk_bf16_f32 v171, v174, v175
    v_min_u32 v168, -2, v168
    v_min_u32 v169, -2, v169
    v_min_u32 v170, -2, v170
    v_min_u32 v171, -2, v171
    buffer_store_dwordx4 v[168:171], v1, s[36:39], s52 offen offset:1024 sc1
    v_cvt_pk_bf16_f32 v176, v176, v177
    v_cvt_pk_bf16_f32 v177, v178, v179
    v_cvt_pk_bf16_f32 v178, v180, v181
    v_cvt_pk_bf16_f32 v179, v182, v183
    v_min_u32 v176, -2, v176
    v_min_u32 v177, -2, v177
    v_min_u32 v178, -2, v178
    v_min_u32 v179, -2, v179
    buffer_store_dwordx4 v[176:179], v1, s[36:39], s52 offen offset:2048 sc1
    v_cvt_pk_bf16_f32 v184, v184, v185
    v_cvt_pk_bf16_f32 v185, v186, v187
    v_cvt_pk_bf16_f32 v186, v188, v189
    v_cvt_pk_bf16_f32 v187, v190, v191
    v_min_u32 v184, -2, v184
    v_min_u32 v185, -2, v185
    v_min_u32 v186, -2, v186
    v_min_u32 v187, -2, v187
    buffer_store_dwordx4 v[184:187], v1, s[36:39], s52 offen offset:3072 sc1
    s_add_u32 s32, s6, 0x4800000
    s_addc_u32 s33, s7, 0
    s_and_b32 s33, s33, 0xffff
    s_mov_b32 s34, 0x6000
    s_mov_b32 s35, 0x00020000
    s_waitcnt vmcnt(4) lgkmcnt(0)
    v_lshlrev_b32 v58, 16, v192
    v_and_b32 v59, 0xffff0000, v192
    v_pk_add_f32 v[128:129], v[128:129], v[58:59]
    v_lshlrev_b32 v58, 16, v193
    v_and_b32 v59, 0xffff0000, v193
    v_pk_add_f32 v[130:131], v[130:131], v[58:59]
    v_lshlrev_b32 v58, 16, v200
    v_and_b32 v59, 0xffff0000, v200
    v_pk_add_f32 v[132:133], v[132:133], v[58:59]
    v_lshlrev_b32 v58, 16, v201
    v_and_b32 v59, 0xffff0000, v201
    v_pk_add_f32 v[134:135], v[134:135], v[58:59]
    v_lshlrev_b32 v58, 16, v194
    v_and_b32 v59, 0xffff0000, v194
    v_pk_add_f32 v[136:137], v[136:137], v[58:59]
    v_lshlrev_b32 v58, 16, v195
    v_and_b32 v59, 0xffff0000, v195
    v_pk_add_f32 v[138:139], v[138:139], v[58:59]
    v_lshlrev_b32 v58, 16, v202
    v_and_b32 v59, 0xffff0000, v202
    v_pk_add_f32 v[140:141], v[140:141], v[58:59]
    v_lshlrev_b32 v58, 16, v203
    v_and_b32 v59, 0xffff0000, v203
    v_pk_add_f32 v[142:143], v[142:143], v[58:59]
    v_lshlrev_b32 v58, 16, v196
    v_and_b32 v59, 0xffff0000, v196
    v_pk_add_f32 v[144:145], v[144:145], v[58:59]
    v_lshlrev_b32 v58, 16, v197
    v_and_b32 v59, 0xffff0000, v197
    v_pk_add_f32 v[146:147], v[146:147], v[58:59]
    v_lshlrev_b32 v58, 16, v204
    v_and_b32 v59, 0xffff0000, v204
    v_pk_add_f32 v[148:149], v[148:149], v[58:59]
    v_lshlrev_b32 v58, 16, v205
    v_and_b32 v59, 0xffff0000, v205
    v_pk_add_f32 v[150:151], v[150:151], v[58:59]
    v_lshlrev_b32 v58, 16, v198
    v_and_b32 v59, 0xffff0000, v198
    v_pk_add_f32 v[152:153], v[152:153], v[58:59]
    v_lshlrev_b32 v58, 16, v199
    v_and_b32 v59, 0xffff0000, v199
    v_pk_add_f32 v[154:155], v[154:155], v[58:59]
    v_lshlrev_b32 v58, 16, v206
    v_and_b32 v59, 0xffff0000, v206
    v_pk_add_f32 v[156:157], v[156:157], v[58:59]
    v_lshlrev_b32 v58, 16, v207
    v_and_b32 v59, 0xffff0000, v207
    v_pk_add_f32 v[158:159], v[158:159], v[58:59]
    v_and_b32 v58, 1, v72
    v_lshrrev_b32 v59, 1, v72
    v_lshlrev_b32 v58, 5, v58
    v_lshl_add_u32 v58, v59, 4, v58
    v_lshlrev_b32 v59, 3, v72
    v_sub_u32 v58, v58, v59
    v_add_u32 v78, v78, v58
    v_add_u32 v79, v79, v58
    v_lshlrev_b32 v32, 16, v208
    v_and_b32 v33, 0xffff0000, v208
    v_lshlrev_b32 v34, 16, v209
    v_and_b32 v35, 0xffff0000, v209
    v_lshlrev_b32 v36, 16, v210
    v_and_b32 v37, 0xffff0000, v210
    v_lshlrev_b32 v38, 16, v211
    v_and_b32 v39, 0xffff0000, v211
    v_lshlrev_b32 v40, 16, v212
    v_and_b32 v41, 0xffff0000, v212
    v_lshlrev_b32 v42, 16, v213
    v_and_b32 v43, 0xffff0000, v213
    v_lshlrev_b32 v44, 16, v214
    v_and_b32 v45, 0xffff0000, v214
    v_lshlrev_b32 v46, 16, v215
    v_and_b32 v47, 0xffff0000, v215
    s_or_b32 s31, s54, s30
    s_cbranch_scc1 op_nowr_145
    v_pk_add_f32 v[56:57], v[32:33], v[34:35]
    v_pk_add_f32 v[56:57], v[56:57], v[36:37]
    v_pk_add_f32 v[56:57], v[56:57], v[38:39]
    v_pk_add_f32 v[56:57], v[56:57], v[40:41]
    v_pk_add_f32 v[56:57], v[56:57], v[42:43]
    v_pk_add_f32 v[56:57], v[56:57], v[44:45]
    v_pk_add_f32 v[56:57], v[56:57], v[46:47]
    v_add_f32 v56, v56, v57
    v_mov_b32 v57, v56
    s_nop 1
    v_permlane16_swap_b32 v56, v57
    s_nop 1
    v_add_f32 v56, v56, v57
    v_mov_b32 v57, v56
    s_nop 1
    v_permlane32_swap_b32 v56, v57
    s_nop 1
    v_add_f32 v56, v56, v57
    s_mov_b32 s31, 24704
    s_mov_b32 s34, 24708
    s_mov_b64 exec, 1
    buffer_atomic_add_f32 v56, v75, s[32:35], s31 offen
    s_mov_b64 exec, -1
    s_mov_b32 s34, 24576
op_nowr_145:
    v_mov_b32 v208, 0
    v_mov_b32 v209, 0
    v_mov_b32 v210, 0
    v_mov_b32 v211, 0
    v_mov_b32 v212, 0
    v_mov_b32 v213, 0
    v_mov_b32 v214, 0
    v_mov_b32 v215, 0
    v_mov_b32 v216, 0
    v_mov_b32 v217, 0
    v_mov_b32 v218, 0
    v_mov_b32 v219, 0
    s_mov_b32 s40, 1048576
op_xspin_146:
    buffer_load_dwordx4 v[224:227], v1, s[36:39], s53 offen offset:0 sc1
    buffer_load_dwordx4 v[228:231], v1, s[36:39], s53 offen offset:1024 sc1
    buffer_load_dwordx4 v[232:235], v1, s[36:39], s53 offen offset:2048 sc1
    buffer_load_dwordx4 v[236:239], v1, s[36:39], s53 offen offset:3072 sc1
    s_sub_u32 s40, s40, 1
    s_waitcnt vmcnt(0)
    s_cbranch_scc1 op_xok_147
    v_max3_u32 v56, v224, v225, v226
    v_max3_u32 v56, v56, v227, v228
    v_max3_u32 v56, v56, v229, v230
    v_max3_u32 v56, v56, v231, v232
    v_max3_u32 v56, v56, v233, v234
    v_max3_u32 v56, v56, v235, v236
    v_max3_u32 v56, v56, v237, v238
    v_max_u32 v56, v56, v239
    v_cmp_eq_u32 vcc, -1, v56
    s_cbranch_vccz op_xok_147
    s_sleep 2
    s_branch op_xspin_146
op_xok_147:
    v_lshlrev_b32 v56, 16, v224
    v_and_b32 v57, 0xffff0000, v224
    v_lshlrev_b32 v58, 16, v225
    v_and_b32 v59, 0xffff0000, v225
    v_pk_add_f32 v[128:129], v[128:129], v[56:57]
    v_pk_add_f32 v[130:131], v[130:131], v[58:59]
    v_cvt_pk_bf16_f32 v192, v128, v129
    v_cvt_pk_bf16_f32 v193, v130, v131
    v_lshlrev_b32 v128, 16, v192
    v_and_b32 v129, 0xffff0000, v192
    v_lshlrev_b32 v130, 16, v193
    v_and_b32 v131, 0xffff0000, v193
    v_pk_add_f32 v[208:209], v[208:209], v[128:129]
    v_pk_fma_f32 v[210:211], v[128:129], v[128:129], v[210:211]
    v_pk_fma_f32 v[212:213], v[128:129], v[32:33], v[212:213]
    v_pk_add_f32 v[208:209], v[208:209], v[130:131]
    v_pk_fma_f32 v[210:211], v[130:131], v[130:131], v[210:211]
    v_pk_fma_f32 v[212:213], v[130:131], v[34:35], v[212:213]
    v_lshlrev_b32 v56, 16, v226
    v_and_b32 v57, 0xffff0000, v226
    v_lshlrev_b32 v58, 16, v227
    v_and_b32 v59, 0xffff0000, v227
    v_pk_add_f32 v[132:133], v[132:133], v[56:57]
    v_pk_add_f32 v[134:135], v[134:135], v[58:59]
    v_cvt_pk_bf16_f32 v200, v132, v133
    v_cvt_pk_bf16_f32 v201, v134, v135
    v_lshlrev_b32 v132, 16, v200
    v_and_b32 v133, 0xffff0000, v200
    v_lshlrev_b32 v134, 16, v201
    v_and_b32 v135, 0xffff0000, v201
    v_pk_add_f32 v[214:215], v[214:215], v[132:133]
    v_pk_fma_f32 v[216:217], v[132:133], v[132:133], v[216:217]
    v_pk_fma_f32 v[218:219], v[132:133], v[32:33], v[218:219]
    v_pk_add_f32 v[214:215], v[214:215], v[134:135]
    v_pk_fma_f32 v[216:217], v[134:135], v[134:135], v[216:217]
    v_pk_fma_f32 v[218:219], v[134:135], v[34:35], v[218:219]
    v_lshlrev_b32 v56, 16, v228
    v_and_b32 v57, 0xffff0000, v228
    v_lshlrev_b32 v58, 16, v229
    v_and_b32 v59, 0xffff0000, v229
    v_pk_add_f32 v[136:137], v[136:137], v[56:57]
    v_pk_add_f32 v[138:139], v[138:139], v[58:59]
    v_cvt_pk_bf16_f32 v194, v136, v137
    v_cvt_pk_bf16_f32 v195, v138, v139
    v_lshlrev_b32 v136, 16, v194
    v_and_b32 v137, 0xffff0000, v194
    v_lshlrev_b32 v138, 16, v195
    v_and_b32 v139, 0xffff0000, v195
    v_permlane16_swap_b32 v192, v194
    v_permlane16_swap_b32 v193, v195
    buffer_store_dwordx4 v[192:195], v78, s[24:27], 0 offen offset:0 sc1
    v_pk_add_f32 v[208:209], v[208:209], v[136:137]
    v_pk_fma_f32 v[210:211], v[136:137], v[136:137], v[210:211]
    v_pk_fma_f32 v[212:213], v[136:137], v[36:37], v[212:213]
    v_pk_add_f32 v[208:209], v[208:209], v[138:139]
    v_pk_fma_f32 v[210:211], v[138:139], v[138:139], v[210:211]
    v_pk_fma_f32 v[212:213], v[138:139], v[38:39], v[212:213]
    v_lshlrev_b32 v56, 16, v230
    v_and_b32 v57, 0xffff0000, v230
    v_lshlrev_b32 v58, 16, v231
    v_and_b32 v59, 0xffff0000, v231
    v_pk_add_f32 v[140:141], v[140:141], v[56:57]
    v_pk_add_f32 v[142:143], v[142:143], v[58:59]
    v_cvt_pk_bf16_f32 v202, v140, v141
    v_cvt_pk_bf16_f32 v203, v142, v143
    v_lshlrev_b32 v140, 16, v202
    v_and_b32 v141, 0xffff0000, v202
    v_lshlrev_b32 v142, 16, v203
    v_and_b32 v143, 0xffff0000, v203
    v_permlane16_swap_b32 v200, v202
    v_permlane16_swap_b32 v201, v203
    buffer_store_dwordx4 v[200:203], v79, s[24:27], 0 offen offset:0 sc1
    v_pk_add_f32 v[214:215], v[214:215], v[140:141]
    v_pk_fma_f32 v[216:217], v[140:141], v[140:141], v[216:217]
    v_pk_fma_f32 v[218:219], v[140:141], v[36:37], v[218:219]
    v_pk_add_f32 v[214:215], v[214:215], v[142:143]
    v_pk_fma_f32 v[216:217], v[142:143], v[142:143], v[216:217]
    v_pk_fma_f32 v[218:219], v[142:143], v[38:39], v[218:219]
    v_lshlrev_b32 v56, 16, v232
    v_and_b32 v57, 0xffff0000, v232
    v_lshlrev_b32 v58, 16, v233
    v_and_b32 v59, 0xffff0000, v233
    v_pk_add_f32 v[144:145], v[144:145], v[56:57]
    v_pk_add_f32 v[146:147], v[146:147], v[58:59]
    v_cvt_pk_bf16_f32 v196, v144, v145
    v_cvt_pk_bf16_f32 v197, v146, v147
    v_lshlrev_b32 v144, 16, v196
    v_and_b32 v145, 0xffff0000, v196
    v_lshlrev_b32 v146, 16, v197
    v_and_b32 v147, 0xffff0000, v197
    v_pk_add_f32 v[208:209], v[208:209], v[144:145]
    v_pk_fma_f32 v[210:211], v[144:145], v[144:145], v[210:211]
    v_pk_fma_f32 v[212:213], v[144:145], v[40:41], v[212:213]
    v_pk_add_f32 v[208:209], v[208:209], v[146:147]
    v_pk_fma_f32 v[210:211], v[146:147], v[146:147], v[210:211]
    v_pk_fma_f32 v[212:213], v[146:147], v[42:43], v[212:213]
    v_lshlrev_b32 v56, 16, v234
    v_and_b32 v57, 0xffff0000, v234
    v_lshlrev_b32 v58, 16, v235
    v_and_b32 v59, 0xffff0000, v235
    v_pk_add_f32 v[148:149], v[148:149], v[56:57]
    v_pk_add_f32 v[150:151], v[150:151], v[58:59]
    v_cvt_pk_bf16_f32 v204, v148, v149
    v_cvt_pk_bf16_f32 v205, v150, v151
    v_lshlrev_b32 v148, 16, v204
    v_and_b32 v149, 0xffff0000, v204
    v_lshlrev_b32 v150, 16, v205
    v_and_b32 v151, 0xffff0000, v205
    v_pk_add_f32 v[214:215], v[214:215], v[148:149]
    v_pk_fma_f32 v[216:217], v[148:149], v[148:149], v[216:217]
    v_pk_fma_f32 v[218:219], v[148:149], v[40:41], v[218:219]
    v_pk_add_f32 v[214:215], v[214:215], v[150:151]
    v_pk_fma_f32 v[216:217], v[150:151], v[150:151], v[216:217]
    v_pk_fma_f32 v[218:219], v[150:151], v[42:43], v[218:219]
    v_lshlrev_b32 v56, 16, v236
    v_and_b32 v57, 0xffff0000, v236
    v_lshlrev_b32 v58, 16, v237
    v_and_b32 v59, 0xffff0000, v237
    v_pk_add_f32 v[152:153], v[152:153], v[56:57]
    v_pk_add_f32 v[154:155], v[154:155], v[58:59]
    v_cvt_pk_bf16_f32 v198, v152, v153
    v_cvt_pk_bf16_f32 v199, v154, v155
    v_lshlrev_b32 v152, 16, v198
    v_and_b32 v153, 0xffff0000, v198
    v_lshlrev_b32 v154, 16, v199
    v_and_b32 v155, 0xffff0000, v199
    v_permlane16_swap_b32 v196, v198
    v_permlane16_swap_b32 v197, v199
    buffer_store_dwordx4 v[196:199], v78, s[24:27], 0 offen offset:64 sc1
    v_pk_add_f32 v[208:209], v[208:209], v[152:153]
    v_pk_fma_f32 v[210:211], v[152:153], v[152:153], v[210:211]
    v_pk_fma_f32 v[212:213], v[152:153], v[44:45], v[212:213]
    v_pk_add_f32 v[208:209], v[208:209], v[154:155]
    v_pk_fma_f32 v[210:211], v[154:155], v[154:155], v[210:211]
    v_pk_fma_f32 v[212:213], v[154:155], v[46:47], v[212:213]
    v_lshlrev_b32 v56, 16, v238
    v_and_b32 v57, 0xffff0000, v238
    v_lshlrev_b32 v58, 16, v239
    v_and_b32 v59, 0xffff0000, v239
    v_pk_add_f32 v[156:157], v[156:157], v[56:57]
    v_pk_add_f32 v[158:159], v[158:159], v[58:59]
    v_cvt_pk_bf16_f32 v206, v156, v157
    v_cvt_pk_bf16_f32 v207, v158, v159
    v_lshlrev_b32 v156, 16, v206
    v_and_b32 v157, 0xffff0000, v206
    v_lshlrev_b32 v158, 16, v207
    v_and_b32 v159, 0xffff0000, v207
    v_permlane16_swap_b32 v204, v206
    v_permlane16_swap_b32 v205, v207
    buffer_store_dwordx4 v[204:207], v79, s[24:27], 0 offen offset:64 sc1
    v_pk_add_f32 v[214:215], v[214:215], v[156:157]
    v_pk_fma_f32 v[216:217], v[156:157], v[156:157], v[216:217]
    v_pk_fma_f32 v[218:219], v[156:157], v[44:45], v[218:219]
    v_pk_add_f32 v[214:215], v[214:215], v[158:159]
    v_pk_fma_f32 v[216:217], v[158:159], v[158:159], v[216:217]
    v_pk_fma_f32 v[218:219], v[158:159], v[46:47], v[218:219]
    v_add_f32 v48, v208, v209
    v_add_f32 v49, v210, v211
    v_add_f32 v50, v212, v213
    v_add_f32 v52, v214, v215
    v_add_f32 v53, v216, v217
    v_add_f32 v54, v218, v219
    v_mov_b32 v56, v48
    v_mov_b32 v57, v49
    v_mov_b32 v58, v50
    v_mov_b32 v59, v52
    v_mov_b32 v60, v53
    v_mov_b32 v61, v54
    s_nop 1
    v_permlane16_swap_b32 v48, v56
    v_permlane16_swap_b32 v49, v57
    v_permlane16_swap_b32 v50, v58
    v_permlane16_swap_b32 v52, v59
    v_permlane16_swap_b32 v53, v60
    v_permlane16_swap_b32 v54, v61
    s_nop 1
    v_add_f32 v48, v48, v56
    v_add_f32 v49, v49, v57
    v_add_f32 v50, v50, v58
    v_add_f32 v52, v52, v59
    v_add_f32 v53, v53, v60
    v_add_f32 v54, v54, v61
    v_mov_b32 v56, v48
    v_mov_b32 v57, v49
    v_mov_b32 v58, v50
    v_mov_b32 v59, v52
    v_mov_b32 v60, v53
    v_mov_b32 v61, v54
    s_nop 1
    v_permlane32_swap_b32 v48, v56
    v_permlane32_swap_b32 v49, v57
    v_permlane32_swap_b32 v50, v58
    v_permlane32_swap_b32 v52, v59
    v_permlane32_swap_b32 v53, v60
    v_permlane32_swap_b32 v54, v61
    s_nop 1
    v_add_f32 v48, v48, v56
    v_add_f32 v49, v49, v57
    v_add_f32 v50, v50, v58
    v_add_f32 v52, v52, v59
    v_add_f32 v53, v53, v60
    v_add_f32 v54, v54, v61
    v_cmp_eq_u32 s[40:41], 1, v72
    v_cmp_eq_u32 s[42:43], 2, v72
    s_nop 1
    v_cndmask_b32 v48, v48, v49, s[40:41]
    v_cndmask_b32 v48, v48, v50, s[42:43]
    buffer_atomic_add_f32 v48, v77, s[32:35], 0 offen offset:0
    v_cndmask_b32 v52, v52, v53, s[40:41]
    v_cndmask_b32 v52, v52, v54, s[42:43]
    buffer_atomic_add_f32 v52, v77, s[32:35], 0 offen offset:64
    s_load_dwordx2 s[42:43], s[0:1], 88
    s_load_dwordx2 s[56:57], s[0:1], 56
    s_add_u32 s16, s6, 0x4815000
    s_addc_u32 s17, s7, 0
    s_and_b32 s17, s17, 0xffff
    s_mov_b32 s18, 0x1000
    s_mov_b32 s19, 0x00020000
    v_lshrrev_b32 v3, 4, v1
    v_lshl_add_u32 v2, s30, 6, v3
    v_and_b32 v4, 31, v3
    v_lshrrev_b32 v5, 5, v3
    v_lshlrev_b32 v7, 4, v4
    v_and_b32 v8, 15, v3
    v_lshlrev_b32 v6, 7, v8
    s_bfe_u32 s31, s2, 0x20003
    s_lshl_b32 s31, s31, 7
    v_lshlrev_b32 v12, 9, v3
    v_and_b32 v14, 3, v3
    v_lshlrev_b32 v14, 7, v14
    s_and_b32 s59, s2, 7
    s_lshl_b32 s59, s59, 9
    s_setreg_imm32_b32 hwreg(HW_REG_MODE, 4, 2), 3
    s_waitcnt vmcnt(0) lgkmcnt(0)
    s_barrier
    s_cmp_lg_u32 s30, 0
    s_cbranch_scc1 ff_nosig_148
    s_mov_b64 exec, 0xff
    buffer_atomic_add v76, v12, s[16:19], s31 offen sc1
    s_mov_b64 exec, -1
ff_nosig_148:
    s_lshl_b32 s40, s30, 13
    s_add_u32 m0, s40, 65536
    s_add_u32 s41, s3, 0
    buffer_load_dwordx4 v1, s[44:47], s41 offen offset:0 sc1 lds
    buffer_load_dwordx4 v1, s[44:47], s41 offen offset:1024 sc1 lds
    buffer_load_dwordx4 v1, s[44:47], s41 offen offset:2048 sc1 lds
    buffer_load_dwordx4 v1, s[44:47], s41 offen offset:3072 sc1 lds
    s_waitcnt vmcnt(0)
    s_lshl_b32 s40, s30, 13
    s_add_u32 m0, s40, 69632
    s_add_u32 s41, s3, 4096
    buffer_load_dwordx4 v1, s[44:47], s41 offen offset:0 sc1 lds
    buffer_load_dwordx4 v1, s[44:47], s41 offen offset:1024 sc1 lds
    buffer_load_dwordx4 v1, s[44:47], s41 offen offset:2048 sc1 lds
    buffer_load_dwordx4 v1, s[44:47], s41 offen offset:3072 sc1 lds
    s_waitcnt vmcnt(0)
    s_lshl_b32 s40, s30, 13
    s_add_u32 m0, s40, 98304
    s_add_u32 s41, s3, 8388608
    buffer_load_dwordx4 v1, s[44:47], s41 offen offset:0 sc1 lds
    buffer_load_dwordx4 v1, s[44:47], s41 offen offset:1024 sc1 lds
    buffer_load_dwordx4 v1, s[44:47], s41 offen offset:2048 sc1 lds
    buffer_load_dwordx4 v1, s[44:47], s41 offen offset:3072 sc1 lds
    s_waitcnt vmcnt(0)
    s_lshl_b32 s40, s30, 13
    s_add_u32 m0, s40, 102400
    s_add_u32 s41, s3, 8392704
    buffer_load_dwordx4 v1, s[44:47], s41 offen offset:0 sc1 lds
    buffer_load_dwordx4 v1, s[44:47], s41 offen offset:1024 sc1 lds
    buffer_load_dwordx4 v1, s[44:47], s41 offen offset:2048 sc1 lds
    buffer_load_dwordx4 v1, s[44:47], s41 offen offset:3072 sc1 lds
    s_lshl_b32 s41, s30, 9
    s_add_u32 s41, s41, 131072
    v_lshrrev_b32 v9, 1, v1
    v_add_u32 v9, s41, v9
    ds_read_b64 v[96:97], v9 offset:0
    ds_read_b64 v[98:99], v9 offset:2048
    ds_read_b64 v[100:101], v9 offset:4096
    ds_read_b64 v[102:103], v9 offset:6144
    ds_read_b64 v[104:105], v9 offset:8192
    ds_read_b64 v[106:107], v9 offset:10240
    ds_read_b64 v[108:109], v9 offset:12288
    ds_read_b64 v[110:111], v9 offset:14336
    ds_read_b64 v[112:113], v9 offset:16384
    ds_read_b64 v[114:115], v9 offset:18432
    ds_read_b64 v[116:117], v9 offset:20480
    ds_read_b64 v[118:119], v9 offset:22528
    ds_read_b64 v[120:121], v9 offset:24576
    ds_read_b64 v[122:123], v9 offset:26624
    ds_read_b64 v[124:125], v9 offset:28672
    ds_read_b64 v[126:127], v9 offset:30720
    s_mov_b32 s54, 0x05040100
    s_mov_b32 s53, 0x07060302
    s_waitcnt lgkmcnt(0)
    v_perm_b32 v144, v98, v96, s54
    v_perm_b32 v145, v98, v96, s53
    v_perm_b32 v146, v99, v97, s54
    v_perm_b32 v147, v99, v97, s53
    v_perm_b32 v148, v102, v100, s54
    v_perm_b32 v149, v102, v100, s53
    v_perm_b32 v150, v103, v101, s54
    v_perm_b32 v151, v103, v101, s53
    v_perm_b32 v152, v106, v104, s54
    v_perm_b32 v153, v106, v104, s53
    v_perm_b32 v154, v107, v105, s54
    v_perm_b32 v155, v107, v105, s53
    v_perm_b32 v156, v110, v108, s54
    v_perm_b32 v157, v110, v108, s53
    v_perm_b32 v158, v111, v109, s54
    v_perm_b32 v159, v111, v109, s53
    v_perm_b32 v160, v114, v112, s54
    v_perm_b32 v161, v114, v112, s53
    v_perm_b32 v162, v115, v113, s54
    v_perm_b32 v163, v115, v113, s53
    v_perm_b32 v164, v118, v116, s54
    v_perm_b32 v165, v118, v116, s53
    v_perm_b32 v166, v119, v117, s54
    v_perm_b32 v167, v119, v117, s53
    v_perm_b32 v168, v122, v120, s54
    v_perm_b32 v169, v122, v120, s53
    v_perm_b32 v170, v123, v121, s54
    v_perm_b32 v171, v123, v121, s53
    v_perm_b32 v172, v126, v124, s54
    v_perm_b32 v173, v126, v124, s53
    v_perm_b32 v174, v127, v125, s54
    v_perm_b32 v175, v127, v125, s53
    s_mov_b32 s34, 24708
    s_mov_b32 s36, s42
    s_and_b32 s37, s43, 0xffff
    s_mov_b32 s38, 0x400000
    s_mov_b32 s39, 0x00020000
    s_add_u32 s48, s6, 0x4900000
    s_addc_u32 s49, s7, 0
    s_and_b32 s49, s49, 0xffff
    s_mov_b32 s50, 0x1c0000
    s_mov_b32 s51, 0x00020000
    v_lshlrev_b32 v10, 5, v2
    v_lshl_add_u32 v11, s30, 1, v5
    s_lshl_b32 s31, s2, 3
    v_add_u32 v11, s31, v11
    v_lshl_add_u32 v0, v11, 11, v7
    s_cmp_lg_u32 s30, 0
    s_cbranch_scc1 ff_go_149
    s_mov_b32 s52, 1048576
ff_poll_150:
    buffer_load_dword v13, v14, s[16:19], s59 offen sc1
    s_sub_u32 s52, s52, 1
    s_cbranch_scc1 ff_go_149
    s_waitcnt vmcnt(0)
    v_cmp_gt_u32 vcc, 64, v13
    s_cbranch_vccz ff_go_149
    s_sleep 4
    s_branch ff_poll_150
ff_go_149:
    s_barrier
    s_mov_b32 s31, 0
    buffer_load_dwordx4 v[16:19], v10, s[32:35], s31 offen sc1
    buffer_load_dwordx4 v[20:23], v10, s[32:35], s31 offen offset:16 sc1
    s_mov_b32 s31, 8192
    buffer_load_dwordx4 v[24:27], v10, s[32:35], s31 offen sc1
    buffer_load_dwordx4 v[28:31], v10, s[32:35], s31 offen offset:16 sc1
    s_mov_b32 s31, 16384
    buffer_load_dwordx4 v[32:35], v10, s[32:35], s31 offen sc1
    buffer_load_dwordx4 v[36:39], v10, s[32:35], s31 offen offset:16 sc1
    s_mov_b32 s31, 24704
    buffer_load_dword v10, v75, s[32:35], s31 offen sc1
    s_mov_b32 s52, 0x3a800000
    s_mov_b32 s53, 0x3a800000
    s_mov_b32 s54, 0x7ff
    v_mov_b32 v14, 0x3727c5ac
    v_mov_b32 v15, v14
    v_mov_b32 v12, 0xff800000
    v_mov_b32 v13, v12
    s_waitcnt vmcnt(0)
    v_sub_f32 v56, 0, v10
    v_sub_f32 v57, 0, v10
    v_pk_mul_f32 v[16:17], v[16:17], s[52:53]
    v_pk_fma_f32 v[24:25], v[24:25], s[52:53], v[14:15]
    v_pk_fma_f32 v[32:33], v[16:17], v[56:57], v[32:33]
    v_pk_fma_f32 v[24:25], v[16:17], v[16:17], v[24:25] neg_lo:[1,0,0] neg_hi:[1,0,0]
    v_pk_mul_f32 v[18:19], v[18:19], s[52:53]
    v_pk_fma_f32 v[26:27], v[26:27], s[52:53], v[14:15]
    v_pk_fma_f32 v[34:35], v[18:19], v[56:57], v[34:35]
    v_pk_fma_f32 v[26:27], v[18:19], v[18:19], v[26:27] neg_lo:[1,0,0] neg_hi:[1,0,0]
    v_pk_mul_f32 v[20:21], v[20:21], s[52:53]
    v_pk_fma_f32 v[28:29], v[28:29], s[52:53], v[14:15]
    v_pk_fma_f32 v[36:37], v[20:21], v[56:57], v[36:37]
    v_pk_fma_f32 v[28:29], v[20:21], v[20:21], v[28:29] neg_lo:[1,0,0] neg_hi:[1,0,0]
    v_pk_mul_f32 v[22:23], v[22:23], s[52:53]
    v_pk_fma_f32 v[30:31], v[30:31], s[52:53], v[14:15]
    v_pk_fma_f32 v[38:39], v[22:23], v[56:57], v[38:39]
    v_pk_fma_f32 v[30:31], v[22:23], v[22:23], v[30:31] neg_lo:[1,0,0] neg_hi:[1,0,0]
    v_max_f32 v24, v14, v24
    v_max_f32 v25, v14, v25
    v_max_f32 v26, v14, v26
    v_max_f32 v27, v14, v27
    v_max_f32 v28, v14, v28
    v_max_f32 v29, v14, v29
    v_max_f32 v30, v14, v30
    v_max_f32 v31, v14, v31
    v_rsq_f32 v24, v24
    v_rsq_f32 v25, v25
    v_rsq_f32 v26, v26
    v_rsq_f32 v27, v27
    v_rsq_f32 v28, v28
    v_rsq_f32 v29, v29
    v_rsq_f32 v30, v30
    v_rsq_f32 v31, v31
    v_pk_mul_f32 v[32:33], v[32:33], v[24:25]
    v_pk_mul_f32 v[34:35], v[34:35], v[26:27]
    v_pk_mul_f32 v[36:37], v[36:37], v[28:29]
    v_pk_mul_f32 v[38:39], v[38:39], v[30:31]
    v_bfi_b32 v32, s54, 0, v32
    v_med3_f32 v13, v12, v13, v32
    v_max_f32 v12, v12, v32
    v_bfi_b32 v33, s54, 1, v33
    v_med3_f32 v13, v12, v13, v33
    v_max_f32 v12, v12, v33
    v_bfi_b32 v34, s54, 2, v34
    v_med3_f32 v13, v12, v13, v34
    v_max_f32 v12, v12, v34
    v_bfi_b32 v35, s54, 3, v35
    v_med3_f32 v13, v12, v13, v35
    v_max_f32 v12, v12, v35
    v_bfi_b32 v36, s54, 4, v36
    v_med3_f32 v13, v12, v13, v36
    v_max_f32 v12, v12, v36
    v_bfi_b32 v37, s54, 5, v37
    v_med3_f32 v13, v12, v13, v37
    v_max_f32 v12, v12, v37
    v_bfi_b32 v38, s54, 6, v38
    v_med3_f32 v13, v12, v13, v38
    v_max_f32 v12, v12, v38
    v_bfi_b32 v39, s54, 7, v39
    v_med3_f32 v13, v12, v13, v39
    v_max_f32 v12, v12, v39
    v_lshl_or_b32 v12, v2, 3, v12
    v_lshl_or_b32 v13, v2, 3, v13
    s_nop 1
    v_mov_b32_dpp v14, v12 quad_perm:[1,0,3,2] row_mask:0xf bank_mask:0xf
    v_mov_b32_dpp v15, v13 quad_perm:[1,0,3,2] row_mask:0xf bank_mask:0xf
    v_max_f32 v15, v15, v13
    v_med3_f32 v13, v12, v14, v15
    v_max_f32 v12, v12, v14
    s_nop 1
    v_mov_b32_dpp v14, v12 quad_perm:[2,3,0,1] row_mask:0xf bank_mask:0xf
    v_mov_b32_dpp v15, v13 quad_perm:[2,3,0,1] row_mask:0xf bank_mask:0xf
    v_max_f32 v15, v15, v13
    v_med3_f32 v13, v12, v14, v15
    v_max_f32 v12, v12, v14
    s_nop 1
    v_mov_b32_dpp v14, v12 row_half_mirror row_mask:0xf bank_mask:0xf
    v_mov_b32_dpp v15, v13 row_half_mirror row_mask:0xf bank_mask:0xf
    v_max_f32 v15, v15, v13
    v_med3_f32 v13, v12, v14, v15
    v_max_f32 v12, v12, v14
    s_nop 1
    v_mov_b32_dpp v14, v12 row_mirror row_mask:0xf bank_mask:0xf
    v_mov_b32_dpp v15, v13 row_mirror row_mask:0xf bank_mask:0xf
    v_max_f32 v15, v15, v13
    v_med3_f32 v13, v12, v14, v15
    v_max_f32 v12, v12, v14
    v_mov_b32 v14, v12
    v_mov_b32 v15, v13
    s_nop 1
    v_permlane16_swap_b32 v12, v14
    v_permlane16_swap_b32 v13, v15
    s_nop 1
    v_max_f32 v15, v15, v13
    v_med3_f32 v13, v12, v14, v15
    v_max_f32 v12, v12, v14
    v_mov_b32 v14, v12
    v_mov_b32 v15, v13
    s_nop 1
    v_permlane32_swap_b32 v12, v14
    v_permlane32_swap_b32 v13, v15
    s_nop 1
    v_max_f32 v15, v15, v13
    v_med3_f32 v13, v12, v14, v15
    v_max_f32 v12, v12, v14
    s_lshl_b32 s31, s30, 3
    s_add_u32 s31, s31, 8192
    v_mov_b32 v14, s31
    ds_write_b64 v14, v[12:13]
    v_mov_b32 v14, 8192
    s_waitcnt lgkmcnt(0)
    s_barrier
    ds_read_b128 v[16:19], v14
    ds_read_b128 v[20:23], v14 offset:16
    v_cmp_eq_u32 vcc, 0, v5
    s_waitcnt lgkmcnt(0)
    v_max_f32 v19, v19, v17
    v_med3_f32 v17, v16, v18, v19
    v_max_f32 v16, v16, v18
    v_max_f32 v23, v23, v21
    v_med3_f32 v21, v20, v22, v23
    v_max_f32 v20, v20, v22
    v_max_f32 v21, v21, v17
    v_med3_f32 v17, v16, v20, v21
    v_max_f32 v16, v16, v20
    v_and_b32 v16, 0x7ff, v16
    v_and_b32 v17, 0x7ff, v17
    v_cndmask_b32 v15, v17, v16, vcc
    v_lshl_add_u32 v12, v15, 11, v7
    buffer_load_dwordx4 v[40:43], v12, s[24:27], 0 offen offset:0 sc1
    buffer_load_dwordx4 v[44:47], v12, s[24:27], 0 offen offset:512 sc1
    buffer_load_dwordx4 v[48:51], v12, s[24:27], 0 offen offset:1024 sc1
    buffer_load_dwordx4 v[52:55], v12, s[24:27], 0 offen offset:1536 sc1
    buffer_load_dwordx4 v[128:131], v0, s[24:27], 0 offen offset:0 sc1
    buffer_load_dwordx4 v[132:135], v0, s[24:27], 0 offen offset:512 sc1
    buffer_load_dwordx4 v[136:139], v0, s[24:27], 0 offen offset:1024 sc1
    buffer_load_dwordx4 v[140:143], v0, s[24:27], 0 offen offset:1536 sc1
    v_cmp_eq_u32 vcc, v16, v11
    v_cmp_eq_u32 s[52:53], v17, v11
    v_mov_b32 v13, 0x7fffffff
    s_or_b64 vcc, vcc, s[52:53]
    v_cndmask_b32 v0, v0, v13, vcc
    v_lshl_add_u32 v12, v5, 11, v7
    v_add_u32 v12, 4096, v12
    s_mov_b32 s58, 0
    s_waitcnt vmcnt(4)
ff_ln_151:
    v_lshlrev_b32 v216, 16, v40
    v_and_b32 v217, 0xffff0000, v40
    v_lshlrev_b32 v218, 16, v41
    v_and_b32 v219, 0xffff0000, v41
    v_lshlrev_b32 v220, 16, v42
    v_and_b32 v221, 0xffff0000, v42
    v_lshlrev_b32 v222, 16, v43
    v_and_b32 v223, 0xffff0000, v43
    v_lshlrev_b32 v224, 16, v44
    v_and_b32 v225, 0xffff0000, v44
    v_lshlrev_b32 v226, 16, v45
    v_and_b32 v227, 0xffff0000, v45
    v_lshlrev_b32 v228, 16, v46
    v_and_b32 v229, 0xffff0000, v46
    v_lshlrev_b32 v230, 16, v47
    v_and_b32 v231, 0xffff0000, v47
    v_lshlrev_b32 v232, 16, v48
    v_and_b32 v233, 0xffff0000, v48
    v_lshlrev_b32 v234, 16, v49
    v_and_b32 v235, 0xffff0000, v49
    v_lshlrev_b32 v236, 16, v50
    v_and_b32 v237, 0xffff0000, v50
    v_lshlrev_b32 v238, 16, v51
    v_and_b32 v239, 0xffff0000, v51
    v_lshlrev_b32 v240, 16, v52
    v_and_b32 v241, 0xffff0000, v52
    v_lshlrev_b32 v242, 16, v53
    v_and_b32 v243, 0xffff0000, v53
    v_lshlrev_b32 v244, 16, v54
    v_and_b32 v245, 0xffff0000, v54
    v_lshlrev_b32 v246, 16, v55
    v_and_b32 v247, 0xffff0000, v55
    v_pk_add_f32 v[208:209], v[216:217], v[218:219]
    v_pk_add_f32 v[210:211], v[220:221], v[222:223]
    v_pk_add_f32 v[208:209], v[208:209], v[224:225]
    v_pk_add_f32 v[210:211], v[210:211], v[226:227]
    v_pk_add_f32 v[208:209], v[208:209], v[228:229]
    v_pk_add_f32 v[210:211], v[210:211], v[230:231]
    v_pk_add_f32 v[208:209], v[208:209], v[232:233]
    v_pk_add_f32 v[210:211], v[210:211], v[234:235]
    v_pk_add_f32 v[208:209], v[208:209], v[236:237]
    v_pk_add_f32 v[210:211], v[210:211], v[238:239]
    v_pk_add_f32 v[208:209], v[208:209], v[240:241]
    v_pk_add_f32 v[210:211], v[210:211], v[242:243]
    v_pk_add_f32 v[208:209], v[208:209], v[244:245]
    v_pk_add_f32 v[210:211], v[210:211], v[246:247]
    v_pk_add_f32 v[208:209], v[208:209], v[210:211]
    v_add_f32 v208, v208, v209
    s_nop 1
    v_add_f32_dpp v208, v208, v208 quad_perm:[1,0,3,2] row_mask:0xf bank_mask:0xf
    s_nop 1
    v_add_f32_dpp v208, v208, v208 quad_perm:[2,3,0,1] row_mask:0xf bank_mask:0xf
    s_nop 1
    v_add_f32_dpp v208, v208, v208 row_half_mirror row_mask:0xf bank_mask:0xf
    s_nop 1
    v_add_f32_dpp v208, v208, v208 row_mirror row_mask:0xf bank_mask:0xf
    v_mov_b32 v210, v208
    s_nop 1
    v_permlane16_swap_b32 v208, v210
    s_nop 1
    v_add_f32 v208, v208, v210
    v_mul_f32 v208, 0xba800000, v208
    v_mov_b32 v209, v208
    v_pk_add_f32 v[210:211], v[216:217], v[208:209]
    v_pk_add_f32 v[214:215], v[218:219], v[208:209]
    v_pk_mul_f32 v[212:213], v[210:211], v[210:211]
    v_pk_fma_f32 v[212:213], v[214:215], v[214:215], v[212:213]
    v_pk_add_f32 v[210:211], v[220:221], v[208:209]
    v_pk_add_f32 v[214:215], v[222:223], v[208:209]
    v_pk_fma_f32 v[212:213], v[210:211], v[210:211], v[212:213]
    v_pk_fma_f32 v[212:213], v[214:215], v[214:215], v[212:213]
    v_pk_add_f32 v[210:211], v[224:225], v[208:209]
    v_pk_add_f32 v[214:215], v[226:227], v[208:209]
    v_pk_fma_f32 v[212:213], v[210:211], v[210:211], v[212:213]
    v_pk_fma_f32 v[212:213], v[214:215], v[214:215], v[212:213]
    v_pk_add_f32 v[210:211], v[228:229], v[208:209]
    v_pk_add_f32 v[214:215], v[230:231], v[208:209]
    v_pk_fma_f32 v[212:213], v[210:211], v[210:211], v[212:213]
    v_pk_fma_f32 v[212:213], v[214:215], v[214:215], v[212:213]
    v_pk_add_f32 v[210:211], v[232:233], v[208:209]
    v_pk_add_f32 v[214:215], v[234:235], v[208:209]
    v_pk_fma_f32 v[212:213], v[210:211], v[210:211], v[212:213]
    v_pk_fma_f32 v[212:213], v[214:215], v[214:215], v[212:213]
    v_pk_add_f32 v[210:211], v[236:237], v[208:209]
    v_pk_add_f32 v[214:215], v[238:239], v[208:209]
    v_pk_fma_f32 v[212:213], v[210:211], v[210:211], v[212:213]
    v_pk_fma_f32 v[212:213], v[214:215], v[214:215], v[212:213]
    v_pk_add_f32 v[210:211], v[240:241], v[208:209]
    v_pk_add_f32 v[214:215], v[242:243], v[208:209]
    v_pk_fma_f32 v[212:213], v[210:211], v[210:211], v[212:213]
    v_pk_fma_f32 v[212:213], v[214:215], v[214:215], v[212:213]
    v_pk_add_f32 v[210:211], v[244:245], v[208:209]
    v_pk_add_f32 v[214:215], v[246:247], v[208:209]
    v_pk_fma_f32 v[212:213], v[210:211], v[210:211], v[212:213]
    v_pk_fma_f32 v[212:213], v[214:215], v[214:215], v[212:213]
    v_add_f32 v212, v212, v213
    s_nop 1
    v_add_f32_dpp v212, v212, v212 quad_perm:[1,0,3,2] row_mask:0xf bank_mask:0xf
    s_nop 1
    v_add_f32_dpp v212, v212, v212 quad_perm:[2,3,0,1] row_mask:0xf bank_mask:0xf
    s_nop 1
    v_add_f32_dpp v212, v212, v212 row_half_mirror row_mask:0xf bank_mask:0xf
    s_nop 1
    v_add_f32_dpp v212, v212, v212 row_mirror row_mask:0xf bank_mask:0xf
    v_mov_b32 v210, v212
    s_nop 1
    v_permlane16_swap_b32 v212, v210
    s_nop 1
    v_add_f32 v212, v212, v210
    v_mul_f32 v212, 0x3a800000, v212
    v_cvt_pk_bf16_f32 v214, v208, v212
    v_and_b32 v212, 0xffff0000, v214
    v_lshlrev_b32 v214, 16, v214
    v_add_f32 v212, 0x3727c5ac, v212
    v_mov_b32 v215, v214
    v_cvt_pk_bf16_f32 v212, v212, v212
    v_and_b32 v212, 0xffff0000, v212
    v_sqrt_f32 v212, v212
    v_pk_add_f32 v[176:177], v[216:217], v[214:215]
    v_pk_add_f32 v[178:179], v[218:219], v[214:215]
    v_pk_add_f32 v[180:181], v[220:221], v[214:215]
    v_pk_add_f32 v[182:183], v[222:223], v[214:215]
    v_pk_add_f32 v[184:185], v[224:225], v[214:215]
    v_pk_add_f32 v[186:187], v[226:227], v[214:215]
    v_pk_add_f32 v[188:189], v[228:229], v[214:215]
    v_pk_add_f32 v[190:191], v[230:231], v[214:215]
    v_pk_add_f32 v[192:193], v[232:233], v[214:215]
    v_pk_add_f32 v[194:195], v[234:235], v[214:215]
    v_pk_add_f32 v[196:197], v[236:237], v[214:215]
    v_pk_add_f32 v[198:199], v[238:239], v[214:215]
    v_pk_add_f32 v[200:201], v[240:241], v[214:215]
    v_pk_add_f32 v[202:203], v[242:243], v[214:215]
    v_pk_add_f32 v[204:205], v[244:245], v[214:215]
    v_pk_add_f32 v[206:207], v[246:247], v[214:215]
    v_cvt_pk_bf16_f32 v212, v212, v212
    v_and_b32 v212, 0xffff0000, v212
    v_rcp_f32 v212, v212
    v_cvt_pk_bf16_f32 v40, v176, v177
    v_cvt_pk_bf16_f32 v41, v178, v179
    v_cvt_pk_bf16_f32 v42, v180, v181
    v_cvt_pk_bf16_f32 v43, v182, v183
    v_cvt_pk_bf16_f32 v44, v184, v185
    v_cvt_pk_bf16_f32 v45, v186, v187
    v_cvt_pk_bf16_f32 v46, v188, v189
    v_cvt_pk_bf16_f32 v47, v190, v191
    v_cvt_pk_bf16_f32 v48, v192, v193
    v_cvt_pk_bf16_f32 v49, v194, v195
    v_cvt_pk_bf16_f32 v50, v196, v197
    v_cvt_pk_bf16_f32 v51, v198, v199
    v_cvt_pk_bf16_f32 v52, v200, v201
    v_cvt_pk_bf16_f32 v53, v202, v203
    v_cvt_pk_bf16_f32 v54, v204, v205
    v_cvt_pk_bf16_f32 v55, v206, v207
    v_mov_b32 v213, v212
    v_lshlrev_b32 v176, 16, v40
    v_and_b32 v177, 0xffff0000, v40
    v_lshlrev_b32 v178, 16, v41
    v_and_b32 v179, 0xffff0000, v41
    v_lshlrev_b32 v180, 16, v42
    v_and_b32 v181, 0xffff0000, v42
    v_lshlrev_b32 v182, 16, v43
    v_and_b32 v183, 0xffff0000, v43
    v_lshlrev_b32 v184, 16, v44
    v_and_b32 v185, 0xffff0000, v44
    v_lshlrev_b32 v186, 16, v45
    v_and_b32 v187, 0xffff0000, v45
    v_lshlrev_b32 v188, 16, v46
    v_and_b32 v189, 0xffff0000, v46
    v_lshlrev_b32 v190, 16, v47
    v_and_b32 v191, 0xffff0000, v47
    v_lshlrev_b32 v192, 16, v48
    v_and_b32 v193, 0xffff0000, v48
    v_lshlrev_b32 v194, 16, v49
    v_and_b32 v195, 0xffff0000, v49
    v_lshlrev_b32 v196, 16, v50
    v_and_b32 v197, 0xffff0000, v50
    v_lshlrev_b32 v198, 16, v51
    v_and_b32 v199, 0xffff0000, v51
    v_lshlrev_b32 v200, 16, v52
    v_and_b32 v201, 0xffff0000, v52
    v_lshlrev_b32 v202, 16, v53
    v_and_b32 v203, 0xffff0000, v53
    v_lshlrev_b32 v204, 16, v54
    v_and_b32 v205, 0xffff0000, v54
    v_lshlrev_b32 v206, 16, v55
    v_and_b32 v207, 0xffff0000, v55
    v_pk_mul_f32 v[176:177], v[176:177], v[212:213]
    v_pk_mul_f32 v[178:179], v[178:179], v[212:213]
    v_pk_mul_f32 v[180:181], v[180:181], v[212:213]
    v_pk_mul_f32 v[182:183], v[182:183], v[212:213]
    v_pk_mul_f32 v[184:185], v[184:185], v[212:213]
    v_pk_mul_f32 v[186:187], v[186:187], v[212:213]
    v_pk_mul_f32 v[188:189], v[188:189], v[212:213]
    v_pk_mul_f32 v[190:191], v[190:191], v[212:213]
    v_pk_mul_f32 v[192:193], v[192:193], v[212:213]
    v_pk_mul_f32 v[194:195], v[194:195], v[212:213]
    v_pk_mul_f32 v[196:197], v[196:197], v[212:213]
    v_pk_mul_f32 v[198:199], v[198:199], v[212:213]
    v_pk_mul_f32 v[200:201], v[200:201], v[212:213]
    v_pk_mul_f32 v[202:203], v[202:203], v[212:213]
    v_pk_mul_f32 v[204:205], v[204:205], v[212:213]
    v_pk_mul_f32 v[206:207], v[206:207], v[212:213]
    v_cvt_pk_bf16_f32 v40, v176, v177
    v_cvt_pk_bf16_f32 v41, v178, v179
    v_cvt_pk_bf16_f32 v42, v180, v181
    v_cvt_pk_bf16_f32 v43, v182, v183
    v_cvt_pk_bf16_f32 v44, v184, v185
    v_cvt_pk_bf16_f32 v45, v186, v187
    v_cvt_pk_bf16_f32 v46, v188, v189
    v_cvt_pk_bf16_f32 v47, v190, v191
    v_cvt_pk_bf16_f32 v48, v192, v193
    v_cvt_pk_bf16_f32 v49, v194, v195
    v_cvt_pk_bf16_f32 v50, v196, v197
    v_cvt_pk_bf16_f32 v51, v198, v199
    v_cvt_pk_bf16_f32 v52, v200, v201
    v_cvt_pk_bf16_f32 v53, v202, v203
    v_cvt_pk_bf16_f32 v54, v204, v205
    v_cvt_pk_bf16_f32 v55, v206, v207
    s_cmp_lg_u32 s58, 0
    s_cbranch_scc1 ff_own_152
    ds_write_b128 v12, v[40:43] offset:0
    ds_write_b128 v12, v[44:47] offset:512
    ds_write_b128 v12, v[48:51] offset:1024
    ds_write_b128 v12, v[52:55] offset:1536
    s_cmp_ge_u32 s2, 224
    s_cbranch_scc1 ff_red_153
    v_lshrrev_b32 v12, 4, v3
    v_and_b32 v13, 1, v3
    v_lshlrev_b32 v13, 11, v13
    v_lshl_add_u32 v13, v12, 3, v13
    s_lshl_b32 s54, s30, 9
    s_add_u32 s54, s54, 4096
    v_add_u32 v13, s54, v13
    v_lshlrev_b32 v14, 3, v3
    s_lshl_b32 s54, s30, 13
    s_add_u32 s54, s54, 65536
    v_add_u32 v14, s54, v14
    ds_read_b64_tr_b16 a[0:1], v14 offset:0
    ds_read_b64_tr_b16 a[2:3], v14 offset:512
    ds_read_b64_tr_b16 a[4:5], v14 offset:1024
    ds_read_b64_tr_b16 a[6:7], v14 offset:1536
    ds_read_b64_tr_b16 a[8:9], v14 offset:2048
    ds_read_b64_tr_b16 a[10:11], v14 offset:2560
    ds_read_b64_tr_b16 a[12:13], v14 offset:3072
    ds_read_b64_tr_b16 a[14:15], v14 offset:3584
    ds_read_b64_tr_b16 a[16:17], v14 offset:4096
    ds_read_b64_tr_b16 a[18:19], v14 offset:4608
    ds_read_b64_tr_b16 a[20:21], v14 offset:5120
    ds_read_b64_tr_b16 a[22:23], v14 offset:5632
    ds_read_b64_tr_b16 a[24:25], v14 offset:6144
    ds_read_b64_tr_b16 a[26:27], v14 offset:6656
    ds_read_b64_tr_b16 a[28:29], v14 offset:7168
    ds_read_b64_tr_b16 a[30:31], v14 offset:7680
    ds_read_b64_tr_b16 a[32:33], v14 offset:32768
    ds_read_b64_tr_b16 a[34:35], v14 offset:33280
    ds_read_b64_tr_b16 a[36:37], v14 offset:33792
    ds_read_b64_tr_b16 a[38:39], v14 offset:34304
    ds_read_b64_tr_b16 a[40:41], v14 offset:34816
    ds_read_b64_tr_b16 a[42:43], v14 offset:35328
    ds_read_b64_tr_b16 a[44:45], v14 offset:35840
    ds_read_b64_tr_b16 a[46:47], v14 offset:36352
    ds_read_b64_tr_b16 a[48:49], v14 offset:36864
    ds_read_b64_tr_b16 a[50:51], v14 offset:37376
    ds_read_b64_tr_b16 a[52:53], v14 offset:37888
    ds_read_b64_tr_b16 a[54:55], v14 offset:38400
    ds_read_b64_tr_b16 a[56:57], v14 offset:38912
    ds_read_b64_tr_b16 a[58:59], v14 offset:39424
    ds_read_b64_tr_b16 a[60:61], v14 offset:39936
    ds_read_b64_tr_b16 a[62:63], v14 offset:40448
    ds_read_b64 a[64:65], v13 offset:0
    ds_read_b64 a[66:67], v13 offset:32
    ds_read_b64 a[68:69], v13 offset:64
    ds_read_b64 a[70:71], v13 offset:96
    ds_read_b64 a[72:73], v13 offset:128
    ds_read_b64 a[74:75], v13 offset:160
    ds_read_b64 a[76:77], v13 offset:192
    ds_read_b64 a[78:79], v13 offset:224
    ds_read_b64 a[80:81], v13 offset:256
    ds_read_b64 a[82:83], v13 offset:288
    ds_read_b64 a[84:85], v13 offset:320
    ds_read_b64 a[86:87], v13 offset:352
    ds_read_b64 a[88:89], v13 offset:384
    ds_read_b64 a[90:91], v13 offset:416
    ds_read_b64 a[92:93], v13 offset:448
    ds_read_b64 a[94:95], v13 offset:480
    v_lshlrev_b32 v13, 6, v8
    v_lshl_add_u32 v13, v12, 4, v13
    s_lshl_b32 s54, s30, 11
    s_add_u32 s54, s54, 8448
    v_add_u32 v13, s54, v13
    s_waitcnt lgkmcnt(0)
    v_mfma_f32_16x16x32_bf16 v[16:19], a[0:3], a[64:67], 0
    v_mfma_f32_16x16x32_bf16 v[20:23], a[32:35], a[64:67], 0
    v_mfma_f32_16x16x32_bf16 v[16:19], a[4:7], a[68:71], v[16:19]
    v_mfma_f32_16x16x32_bf16 v[20:23], a[36:39], a[68:71], v[20:23]
    v_mfma_f32_16x16x32_bf16 v[16:19], a[8:11], a[72:75], v[16:19]
    v_mfma_f32_16x16x32_bf16 v[20:23], a[40:43], a[72:75], v[20:23]
    v_mfma_f32_16x16x32_bf16 v[16:19], a[12:15], a[76:79], v[16:19]
    v_mfma_f32_16x16x32_bf16 v[20:23], a[44:47], a[76:79], v[20:23]
    v_mfma_f32_16x16x32_bf16 v[16:19], a[16:19], a[80:83], v[16:19]
    v_mfma_f32_16x16x32_bf16 v[20:23], a[48:51], a[80:83], v[20:23]
    v_mfma_f32_16x16x32_bf16 v[16:19], a[20:23], a[84:87], v[16:19]
    v_mfma_f32_16x16x32_bf16 v[20:23], a[52:55], a[84:87], v[20:23]
    v_mfma_f32_16x16x32_bf16 v[16:19], a[24:27], a[88:91], v[16:19]
    v_mfma_f32_16x16x32_bf16 v[20:23], a[56:59], a[88:91], v[20:23]
    v_mfma_f32_16x16x32_bf16 v[16:19], a[28:31], a[92:95], v[16:19]
    v_mfma_f32_16x16x32_bf16 v[20:23], a[60:63], a[92:95], v[20:23]
    s_nop 7
    ds_write_b128 v13, v[16:19]
    ds_write_b128 v13, v[20:23] offset:1024
    v_lshlrev_b32 v13, 2, v4
    v_add_u32 v13, 8448, v13
    s_waitcnt lgkmcnt(0)
    s_barrier
    ds_read2st64_b32 v[16:17], v13 offset0:0 offset1:4
    ds_read2st64_b32 v[18:19], v13 offset0:8 offset1:12
    ds_read2st64_b32 v[20:21], v13 offset0:16 offset1:20
    ds_read2st64_b32 v[22:23], v13 offset0:24 offset1:28
    s_waitcnt lgkmcnt(0)
    v_pk_add_f32 v[16:17], v[16:17], v[20:21]
    v_pk_add_f32 v[18:19], v[18:19], v[22:23]
    v_pk_add_f32 v[16:17], v[16:17], v[18:19]
    v_cvt_pk_bf16_f32 v16, v16, v17
    v_and_b32 v20, 0xffff0000, v16
    v_lshlrev_b32 v16, 16, v16
    v_mul_f32 v17, 0xbfb8aa3b, v16
    v_exp_f32 v17, v17
    s_lshl_b32 s54, s55, 13
    v_add_f32 v17, 1.0, v17
    v_rcp_f32 v17, v17
    s_add_u32 s53, s54, 4096
    v_mul_f32 v16, v16, v17
    v_cvt_pk_bf16_f32 v16, v16, v16
    v_and_b32 v16, 0xffff0000, v16
    v_mul_f32 v16, v16, v20
    s_nop 1
    v_mov_b32_dpp v17, v16 quad_perm:[1,0,3,2] row_mask:0xf bank_mask:0xf
    v_cvt_pk_bf16_f32 v16, v16, v17
    v_lshlrev_b32 v13, 4, v2
    v_readlane_b32 s8, v16, 0
    v_readlane_b32 s9, v16, 2
    v_readlane_b32 s10, v16, 4
    v_readlane_b32 s11, v16, 6
    v_readlane_b32 s12, v16, 8
    v_readlane_b32 s13, v16, 10
    v_readlane_b32 s14, v16, 12
    v_readlane_b32 s15, v16, 14
    v_readlane_b32 s16, v16, 16
    v_readlane_b32 s17, v16, 18
    v_readlane_b32 s18, v16, 20
    v_readlane_b32 s19, v16, 22
    v_readlane_b32 s20, v16, 24
    v_readlane_b32 s21, v16, 26
    v_readlane_b32 s22, v16, 28
    v_readlane_b32 s23, v16, 30
    v_dot2_f32_bf16 v24, v144, s8, 0
    v_dot2_f32_bf16 v25, v145, s8, 0
    v_dot2_f32_bf16 v26, v146, s8, 0
    v_dot2_f32_bf16 v27, v147, s8, 0
    v_dot2_f32_bf16 v24, v148, s9, v24
    v_dot2_f32_bf16 v25, v149, s9, v25
    v_dot2_f32_bf16 v26, v150, s9, v26
    v_dot2_f32_bf16 v27, v151, s9, v27
    v_dot2_f32_bf16 v24, v152, s10, v24
    v_dot2_f32_bf16 v25, v153, s10, v25
    v_dot2_f32_bf16 v26, v154, s10, v26
    v_dot2_f32_bf16 v27, v155, s10, v27
    v_dot2_f32_bf16 v24, v156, s11, v24
    v_dot2_f32_bf16 v25, v157, s11, v25
    v_dot2_f32_bf16 v26, v158, s11, v26
    v_dot2_f32_bf16 v27, v159, s11, v27
    v_dot2_f32_bf16 v24, v160, s12, v24
    v_dot2_f32_bf16 v25, v161, s12, v25
    v_dot2_f32_bf16 v26, v162, s12, v26
    v_dot2_f32_bf16 v27, v163, s12, v27
    v_dot2_f32_bf16 v24, v164, s13, v24
    v_dot2_f32_bf16 v25, v165, s13, v25
    v_dot2_f32_bf16 v26, v166, s13, v26
    v_dot2_f32_bf16 v27, v167, s13, v27
    v_dot2_f32_bf16 v24, v168, s14, v24
    v_dot2_f32_bf16 v25, v169, s14, v25
    v_dot2_f32_bf16 v26, v170, s14, v26
    v_dot2_f32_bf16 v27, v171, s14, v27
    v_dot2_f32_bf16 v24, v172, s15, v24
    v_dot2_f32_bf16 v25, v173, s15, v25
    v_dot2_f32_bf16 v26, v174, s15, v26
    v_dot2_f32_bf16 v27, v175, s15, v27
    v_dot2_f32_bf16 v28, v144, s16, 0
    v_dot2_f32_bf16 v29, v145, s16, 0
    v_dot2_f32_bf16 v30, v146, s16, 0
    v_dot2_f32_bf16 v31, v147, s16, 0
    v_dot2_f32_bf16 v28, v148, s17, v28
    v_dot2_f32_bf16 v29, v149, s17, v29
    v_dot2_f32_bf16 v30, v150, s17, v30
    v_dot2_f32_bf16 v31, v151, s17, v31
    v_dot2_f32_bf16 v28, v152, s18, v28
    v_dot2_f32_bf16 v29, v153, s18, v29
    v_dot2_f32_bf16 v30, v154, s18, v30
    v_dot2_f32_bf16 v31, v155, s18, v31
    v_dot2_f32_bf16 v28, v156, s19, v28
    v_dot2_f32_bf16 v29, v157, s19, v29
    v_dot2_f32_bf16 v30, v158, s19, v30
    v_dot2_f32_bf16 v31, v159, s19, v31
    v_dot2_f32_bf16 v28, v160, s20, v28
    v_dot2_f32_bf16 v29, v161, s20, v29
    v_dot2_f32_bf16 v30, v162, s20, v30
    v_dot2_f32_bf16 v31, v163, s20, v31
    v_dot2_f32_bf16 v28, v164, s21, v28
    v_dot2_f32_bf16 v29, v165, s21, v29
    v_dot2_f32_bf16 v30, v166, s21, v30
    v_dot2_f32_bf16 v31, v167, s21, v31
    v_dot2_f32_bf16 v28, v168, s22, v28
    v_dot2_f32_bf16 v29, v169, s22, v29
    v_dot2_f32_bf16 v30, v170, s22, v30
    v_dot2_f32_bf16 v31, v171, s22, v31
    v_dot2_f32_bf16 v28, v172, s23, v28
    v_dot2_f32_bf16 v29, v173, s23, v29
    v_dot2_f32_bf16 v30, v174, s23, v30
    v_dot2_f32_bf16 v31, v175, s23, v31
    s_nop 2
    v_min_u32 v24, -2, v24
    v_min_u32 v25, -2, v25
    v_min_u32 v26, -2, v26
    v_min_u32 v27, -2, v27
    v_min_u32 v28, -2, v28
    v_min_u32 v29, -2, v29
    v_min_u32 v30, -2, v30
    v_min_u32 v31, -2, v31
    buffer_store_dwordx4 v[24:27], v13, s[48:51], s54 offen sc1
    buffer_store_dwordx4 v[28:31], v13, s[48:51], s53 offen sc1
    s_waitcnt vmcnt(2)
    v_mov_b32 v40, v128
    v_mov_b32 v41, v129
    v_mov_b32 v42, v130
    v_mov_b32 v43, v131
    v_mov_b32 v44, v132
    v_mov_b32 v45, v133
    v_mov_b32 v46, v134
    v_mov_b32 v47, v135
    v_mov_b32 v48, v136
    v_mov_b32 v49, v137
    v_mov_b32 v50, v138
    v_mov_b32 v51, v139
    v_mov_b32 v52, v140
    v_mov_b32 v53, v141
    v_mov_b32 v54, v142
    v_mov_b32 v55, v143
    s_mov_b32 s58, 1
    s_branch ff_ln_151
ff_own_152:
    v_lshlrev_b32 v176, 16, v40
    v_and_b32 v177, 0xffff0000, v40
    v_lshlrev_b32 v178, 16, v41
    v_and_b32 v179, 0xffff0000, v41
    v_lshlrev_b32 v180, 16, v42
    v_and_b32 v181, 0xffff0000, v42
    v_lshlrev_b32 v182, 16, v43
    v_and_b32 v183, 0xffff0000, v43
    v_lshlrev_b32 v184, 16, v44
    v_and_b32 v185, 0xffff0000, v44
    v_lshlrev_b32 v186, 16, v45
    v_and_b32 v187, 0xffff0000, v45
    v_lshlrev_b32 v188, 16, v46
    v_and_b32 v189, 0xffff0000, v46
    v_lshlrev_b32 v190, 16, v47
    v_and_b32 v191, 0xffff0000, v47
    v_lshlrev_b32 v192, 16, v48
    v_and_b32 v193, 0xffff0000, v48
    v_lshlrev_b32 v194, 16, v49
    v_and_b32 v195, 0xffff0000, v49
    v_lshlrev_b32 v196, 16, v50
    v_and_b32 v197, 0xffff0000, v50
    v_lshlrev_b32 v198, 16, v51
    v_and_b32 v199, 0xffff0000, v51
    v_lshlrev_b32 v200, 16, v52
    v_and_b32 v201, 0xffff0000, v52
    v_lshlrev_b32 v202, 16, v53
    v_and_b32 v203, 0xffff0000, v53
    v_lshlrev_b32 v204, 16, v54
    v_and_b32 v205, 0xffff0000, v54
    v_lshlrev_b32 v206, 16, v55
    v_and_b32 v207, 0xffff0000, v55
    v_pk_add_f32 v[176:177], v[176:177], v[216:217]
    v_pk_add_f32 v[178:179], v[178:179], v[218:219]
    v_pk_add_f32 v[180:181], v[180:181], v[220:221]
    v_pk_add_f32 v[182:183], v[182:183], v[222:223]
    v_pk_add_f32 v[184:185], v[184:185], v[224:225]
    v_pk_add_f32 v[186:187], v[186:187], v[226:227]
    v_pk_add_f32 v[188:189], v[188:189], v[228:229]
    v_pk_add_f32 v[190:191], v[190:191], v[230:231]
    v_pk_add_f32 v[192:193], v[192:193], v[232:233]
    v_pk_add_f32 v[194:195], v[194:195], v[234:235]
    v_pk_add_f32 v[196:197], v[196:197], v[236:237]
    v_pk_add_f32 v[198:199], v[198:199], v[238:239]
    v_pk_add_f32 v[200:201], v[200:201], v[240:241]
    v_pk_add_f32 v[202:203], v[202:203], v[242:243]
    v_pk_add_f32 v[204:205], v[204:205], v[244:245]
    v_pk_add_f32 v[206:207], v[206:207], v[246:247]
    v_cvt_pk_bf16_f32 v40, v176, v177
    v_cvt_pk_bf16_f32 v41, v178, v179
    v_cvt_pk_bf16_f32 v42, v180, v181
    v_cvt_pk_bf16_f32 v43, v182, v183
    v_cvt_pk_bf16_f32 v44, v184, v185
    v_cvt_pk_bf16_f32 v45, v186, v187
    v_cvt_pk_bf16_f32 v46, v188, v189
    v_cvt_pk_bf16_f32 v47, v190, v191
    v_cvt_pk_bf16_f32 v48, v192, v193
    v_cvt_pk_bf16_f32 v49, v194, v195
    v_cvt_pk_bf16_f32 v50, v196, v197
    v_cvt_pk_bf16_f32 v51, v198, v199
    v_cvt_pk_bf16_f32 v52, v200, v201
    v_cvt_pk_bf16_f32 v53, v202, v203
    v_cvt_pk_bf16_f32 v54, v204, v205
    v_cvt_pk_bf16_f32 v55, v206, v207
    buffer_store_dwordx4 v[40:43], v0, s[36:39], 0 offen offset:0 sc1
    buffer_store_dwordx4 v[44:47], v0, s[36:39], 0 offen offset:512 sc1
    buffer_store_dwordx4 v[48:51], v0, s[36:39], 0 offen offset:1024 sc1
    buffer_store_dwordx4 v[52:55], v0, s[36:39], 0 offen offset:1536 sc1
    s_cmp_ge_u32 s2, 224
    s_cbranch_scc1 ff_red2_154
    s_branch ff_fin_155
ff_red_153:
    s_sub_u32 s40, s2, 224
    s_lshr_b32 s41, s40, 4
    s_and_b32 s42, s40, 15
    s_mov_b32 s8, s56
    s_and_b32 s9, s57, 0xffff
    s_mov_b32 s10, 0x800
    s_mov_b32 s11, 0x00020000
    buffer_load_dwordx4 v[96:99], v7, s[8:11], 0 offen offset:0
    buffer_load_dwordx4 v[100:103], v7, s[8:11], 0 offen offset:512
    buffer_load_dwordx4 v[104:107], v7, s[8:11], 0 offen offset:1024
    buffer_load_dwordx4 v[108:111], v7, s[8:11], 0 offen offset:1536
    s_lshl_b32 s43, s41, 5
    v_readlane_b32 s46, v15, s43
    s_lshl_b32 s47, s42, 7
    v_lshl_add_u32 v9, v8, 3, s47
    s_lshl_b32 s46, s46, 11
    s_lshl_b32 s31, s41, 11
    s_add_u32 s31, s31, 4096
    v_add_u32 v12, s31, v9
    s_waitcnt lgkmcnt(0)
    ds_read_b64 v[32:33], v12
    buffer_load_dwordx2 v[34:35], v9, s[24:27], s46 offen sc1
    v_lshrrev_b32 v10, 4, v2
    v_lshlrev_b32 v10, 13, v10
    v_lshl_add_u32 v10, v8, 4, v10
    s_lshl_b32 s47, s40, 8
    s_waitcnt vmcnt(1)
    v_dot2_f32_bf16 v12, v40, v96, 0
    v_dot2_f32_bf16 v12, v41, v97, v12
    v_dot2_f32_bf16 v12, v42, v98, v12
    v_dot2_f32_bf16 v12, v43, v99, v12
    v_dot2_f32_bf16 v12, v44, v100, v12
    v_dot2_f32_bf16 v12, v45, v101, v12
    v_dot2_f32_bf16 v12, v46, v102, v12
    v_dot2_f32_bf16 v12, v47, v103, v12
    v_dot2_f32_bf16 v12, v48, v104, v12
    v_dot2_f32_bf16 v12, v49, v105, v12
    v_dot2_f32_bf16 v12, v50, v106, v12
    v_dot2_f32_bf16 v12, v51, v107, v12
    v_dot2_f32_bf16 v12, v52, v108, v12
    v_dot2_f32_bf16 v12, v53, v109, v12
    v_dot2_f32_bf16 v12, v54, v110, v12
    v_dot2_f32_bf16 v12, v55, v111, v12
    s_nop 2
    s_nop 1
    v_add_f32_dpp v12, v12, v12 quad_perm:[1,0,3,2] row_mask:0xf bank_mask:0xf
    s_nop 1
    v_add_f32_dpp v12, v12, v12 quad_perm:[2,3,0,1] row_mask:0xf bank_mask:0xf
    s_nop 1
    v_add_f32_dpp v12, v12, v12 row_half_mirror row_mask:0xf bank_mask:0xf
    s_nop 1
    v_add_f32_dpp v12, v12, v12 row_mirror row_mask:0xf bank_mask:0xf
    v_mov_b32 v13, v12
    s_nop 1
    v_permlane16_swap_b32 v12, v13
    s_nop 1
    v_add_f32 v12, v12, v13
    v_cvt_pk_bf16_f32 v12, v12, v12
    v_and_b32 v12, 0xffff0000, v12
    v_mul_f32 v12, 0xbfb8aa3b, v12
    v_exp_f32 v12, v12
    s_lshl_b32 s44, s42, 1
    v_add_f32 v12, 1.0, v12
    v_rcp_f32 v12, v12
    s_add_u32 s44, s44, s41
    s_lshl_b32 s44, s44, 11
    v_cvt_pk_bf16_f32 v12, v12, v12
    v_and_b32 v12, 0xffff0000, v12
    v_mov_b32 v40, v128
    v_mov_b32 v41, v129
    v_mov_b32 v42, v130
    v_mov_b32 v43, v131
    v_mov_b32 v44, v132
    v_mov_b32 v45, v133
    v_mov_b32 v46, v134
    v_mov_b32 v47, v135
    v_mov_b32 v48, v136
    v_mov_b32 v49, v137
    v_mov_b32 v50, v138
    v_mov_b32 v51, v139
    v_mov_b32 v52, v140
    v_mov_b32 v53, v141
    v_mov_b32 v54, v142
    v_mov_b32 v55, v143
    v_readlane_b32 s45, v12, s43
    s_mov_b32 s58, 1
    s_branch ff_ln_151
ff_red2_154:
    s_mov_b32 s52, 1048576
ff_rpoll_157:
    s_mov_b32 s53, s47
    buffer_load_dwordx4 v[96:99], v10, s[48:51], s53 offen sc1
    s_add_u32 s53, s53, 0x20000
    buffer_load_dwordx4 v[100:103], v10, s[48:51], s53 offen sc1
    s_add_u32 s53, s53, 0x20000
    buffer_load_dwordx4 v[104:107], v10, s[48:51], s53 offen sc1
    s_add_u32 s53, s53, 0x20000
    buffer_load_dwordx4 v[108:111], v10, s[48:51], s53 offen sc1
    s_add_u32 s53, s53, 0x20000
    buffer_load_dwordx4 v[112:115], v10, s[48:51], s53 offen sc1
    s_add_u32 s53, s53, 0x20000
    buffer_load_dwordx4 v[116:119], v10, s[48:51], s53 offen sc1
    s_add_u32 s53, s53, 0x20000
    buffer_load_dwordx4 v[120:123], v10, s[48:51], s53 offen sc1
    s_add_u32 s53, s53, 0x20000
    buffer_load_dwordx4 v[124:127], v10, s[48:51], s53 offen sc1
    s_add_u32 s53, s53, 0x20000
    buffer_load_dwordx4 v[128:131], v10, s[48:51], s53 offen sc1
    s_add_u32 s53, s53, 0x20000
    buffer_load_dwordx4 v[132:135], v10, s[48:51], s53 offen sc1
    s_add_u32 s53, s53, 0x20000
    buffer_load_dwordx4 v[136:139], v10, s[48:51], s53 offen sc1
    s_add_u32 s53, s53, 0x20000
    buffer_load_dwordx4 v[140:143], v10, s[48:51], s53 offen sc1
    s_add_u32 s53, s53, 0x20000
    buffer_load_dwordx4 v[144:147], v10, s[48:51], s53 offen sc1
    s_add_u32 s53, s53, 0x20000
    buffer_load_dwordx4 v[148:151], v10, s[48:51], s53 offen sc1
    s_add_u32 s53, s53, 0x20000
    v_mov_b32 v13, 0
    s_waitcnt vmcnt(13)
    v_max3_u32 v13, v13, v96, v97
    v_max3_u32 v13, v13, v98, v99
    s_waitcnt vmcnt(12)
    v_max3_u32 v13, v13, v100, v101
    v_max3_u32 v13, v13, v102, v103
    s_waitcnt vmcnt(11)
    v_max3_u32 v13, v13, v104, v105
    v_max3_u32 v13, v13, v106, v107
    s_waitcnt vmcnt(10)
    v_max3_u32 v13, v13, v108, v109
    v_max3_u32 v13, v13, v110, v111
    s_waitcnt vmcnt(9)
    v_max3_u32 v13, v13, v112, v113
    v_max3_u32 v13, v13, v114, v115
    s_waitcnt vmcnt(8)
    v_max3_u32 v13, v13, v116, v117
    v_max3_u32 v13, v13, v118, v119
    s_waitcnt vmcnt(7)
    v_max3_u32 v13, v13, v120, v121
    v_max3_u32 v13, v13, v122, v123
    s_waitcnt vmcnt(6)
    v_max3_u32 v13, v13, v124, v125
    v_max3_u32 v13, v13, v126, v127
    s_waitcnt vmcnt(5)
    v_max3_u32 v13, v13, v128, v129
    v_max3_u32 v13, v13, v130, v131
    s_waitcnt vmcnt(4)
    v_max3_u32 v13, v13, v132, v133
    v_max3_u32 v13, v13, v134, v135
    s_waitcnt vmcnt(3)
    v_max3_u32 v13, v13, v136, v137
    v_max3_u32 v13, v13, v138, v139
    s_waitcnt vmcnt(2)
    v_max3_u32 v13, v13, v140, v141
    v_max3_u32 v13, v13, v142, v143
    s_waitcnt vmcnt(1)
    v_max3_u32 v13, v13, v144, v145
    v_max3_u32 v13, v13, v146, v147
    s_waitcnt vmcnt(0)
    v_max3_u32 v13, v13, v148, v149
    v_max3_u32 v13, v13, v150, v151
    s_sub_u32 s52, s52, 1
    s_cbranch_scc1 ff_rgo_156
    v_cmp_eq_u32 vcc, -1, v13
    s_cbranch_vccnz ff_rpoll_157
ff_rgo_156:
    v_pk_add_f32 v[96:97], v[96:97], v[100:101]
    v_pk_add_f32 v[98:99], v[98:99], v[102:103]
    v_pk_add_f32 v[96:97], v[96:97], v[104:105]
    v_pk_add_f32 v[98:99], v[98:99], v[106:107]
    v_pk_add_f32 v[96:97], v[96:97], v[108:109]
    v_pk_add_f32 v[98:99], v[98:99], v[110:111]
    v_pk_add_f32 v[96:97], v[96:97], v[112:113]
    v_pk_add_f32 v[98:99], v[98:99], v[114:115]
    v_pk_add_f32 v[96:97], v[96:97], v[116:117]
    v_pk_add_f32 v[98:99], v[98:99], v[118:119]
    v_pk_add_f32 v[96:97], v[96:97], v[120:121]
    v_pk_add_f32 v[98:99], v[98:99], v[122:123]
    v_pk_add_f32 v[96:97], v[96:97], v[124:125]
    v_pk_add_f32 v[98:99], v[98:99], v[126:127]
    v_pk_add_f32 v[96:97], v[96:97], v[128:129]
    v_pk_add_f32 v[98:99], v[98:99], v[130:131]
    v_pk_add_f32 v[96:97], v[96:97], v[132:133]
    v_pk_add_f32 v[98:99], v[98:99], v[134:135]
    v_pk_add_f32 v[96:97], v[96:97], v[136:137]
    v_pk_add_f32 v[98:99], v[98:99], v[138:139]
    v_pk_add_f32 v[96:97], v[96:97], v[140:141]
    v_pk_add_f32 v[98:99], v[98:99], v[142:143]
    v_pk_add_f32 v[96:97], v[96:97], v[144:145]
    v_pk_add_f32 v[98:99], v[98:99], v[146:147]
    v_pk_add_f32 v[96:97], v[96:97], v[148:149]
    v_pk_add_f32 v[98:99], v[98:99], v[150:151]
    v_mov_b32 v100, v96
    v_mov_b32 v101, v97
    v_mov_b32 v102, v98
    v_mov_b32 v103, v99
    s_nop 1
    v_permlane16_swap_b32 v96, v100
    v_permlane16_swap_b32 v97, v101
    v_permlane16_swap_b32 v98, v102
    v_permlane16_swap_b32 v99, v103
    s_nop 1
    v_add_f32 v96, v96, v100
    v_add_f32 v97, v97, v101
    v_add_f32 v98, v98, v102
    v_add_f32 v99, v99, v103
    v_mov_b32 v100, v96
    v_mov_b32 v101, v97
    v_mov_b32 v102, v98
    v_mov_b32 v103, v99
    s_nop 1
    v_permlane32_swap_b32 v96, v100
    v_permlane32_swap_b32 v97, v101
    v_permlane32_swap_b32 v98, v102
    v_permlane32_swap_b32 v99, v103
    s_nop 1
    v_add_f32 v96, v96, v100
    v_add_f32 v97, v97, v101
    v_add_f32 v98, v98, v102
    v_add_f32 v99, v99, v103
    v_lshlrev_b32 v14, 4, v8
    s_lshl_b32 s31, s30, 8
    v_add_u32 v13, s31, v14
    ds_write_b128 v13, v[96:99]
    s_waitcnt lgkmcnt(0)
    s_barrier
    ds_read_b128 v[96:99], v14 offset:0
    ds_read_b128 v[100:103], v14 offset:256
    ds_read_b128 v[104:107], v14 offset:512
    ds_read_b128 v[108:111], v14 offset:768
    s_waitcnt lgkmcnt(0)
    v_pk_add_f32 v[96:97], v[96:97], v[100:101]
    v_pk_add_f32 v[98:99], v[98:99], v[102:103]
    v_pk_add_f32 v[96:97], v[96:97], v[104:105]
    v_pk_add_f32 v[98:99], v[98:99], v[106:107]
    v_pk_add_f32 v[96:97], v[96:97], v[108:109]
    v_pk_add_f32 v[98:99], v[98:99], v[110:111]
    v_cvt_pk_bf16_f32 v20, v96, v97
    v_lshlrev_b32 v21, 16, v20
    v_and_b32 v22, 0xffff0000, v20
    v_mul_f32 v21, s45, v21
    v_mul_f32 v22, s45, v22
    v_cvt_pk_bf16_f32 v20, v21, v22
    v_lshlrev_b32 v21, 16, v20
    v_and_b32 v22, 0xffff0000, v20
    v_lshlrev_b32 v23, 16, v32
    v_and_b32 v24, 0xffff0000, v32
    v_add_f32 v21, v21, v23
    v_add_f32 v22, v22, v24
    v_cvt_pk_bf16_f32 v20, v21, v22
    v_lshlrev_b32 v21, 16, v20
    v_and_b32 v22, 0xffff0000, v20
    v_lshlrev_b32 v23, 16, v34
    v_and_b32 v24, 0xffff0000, v34
    v_add_f32 v21, v21, v23
    v_add_f32 v22, v22, v24
    v_cvt_pk_bf16_f32 v26, v21, v22
    v_cvt_pk_bf16_f32 v20, v98, v99
    v_lshlrev_b32 v21, 16, v20
    v_and_b32 v22, 0xffff0000, v20
    v_mul_f32 v21, s45, v21
    v_mul_f32 v22, s45, v22
    v_cvt_pk_bf16_f32 v20, v21, v22
    v_lshlrev_b32 v21, 16, v20
    v_and_b32 v22, 0xffff0000, v20
    v_lshlrev_b32 v23, 16, v33
    v_and_b32 v24, 0xffff0000, v33
    v_add_f32 v21, v21, v23
    v_add_f32 v22, v22, v24
    v_cvt_pk_bf16_f32 v20, v21, v22
    v_lshlrev_b32 v21, 16, v20
    v_and_b32 v22, 0xffff0000, v20
    v_lshlrev_b32 v23, 16, v35
    v_and_b32 v24, 0xffff0000, v35
    v_add_f32 v21, v21, v23
    v_add_f32 v22, v22, v24
    v_cvt_pk_bf16_f32 v27, v21, v22
    v_cmp_gt_u32 vcc, 16, v2
    s_and_saveexec_b64 s[52:53], vcc
    s_cbranch_execz ff_fin_155
    buffer_store_dwordx2 v[26:27], v9, s[36:39], s46 offen sc1
ff_fin_155:
    s_mov_b64 exec, -1
k12_end_1:
    s_endpgm
k2_prep_76:
    s_sub_u32 s40, s36, s38
    v_subrev_u32 v6, s40, v4
    v_cmp_gt_i32 s[44:45], 0, v6
    v_cmp_gt_i32 s[46:47], 1, v6
    v_cmp_gt_i32 s[48:49], 2, v6
    v_cmp_gt_i32 s[50:51], 3, v6
    v_cndmask_b32 v16, v8, v5, s[44:45]
    v_cndmask_b32 v17, v8, v5, s[46:47]
    v_cndmask_b32 v18, v8, v5, s[48:49]
    v_cndmask_b32 v19, v8, v5, s[50:51]
    v_cmp_gt_i32 s[44:45], 16, v6
    v_cmp_gt_i32 s[46:47], 17, v6
    v_cmp_gt_i32 s[48:49], 18, v6
    v_cmp_gt_i32 s[50:51], 19, v6
    v_cndmask_b32 v32, v8, v5, s[44:45]
    v_cndmask_b32 v33, v8, v5, s[46:47]
    v_cndmask_b32 v34, v8, v5, s[48:49]
    v_cndmask_b32 v35, v8, v5, s[50:51]
    s_nop 1
    s_branch k2_prepret_77
k2_prep_84:
    s_sub_u32 s40, s36, s38
    v_subrev_u32 v6, s40, v4
    v_cmp_gt_i32 s[44:45], 0, v6
    v_cmp_gt_i32 s[46:47], 1, v6
    v_cmp_gt_i32 s[48:49], 2, v6
    v_cmp_gt_i32 s[50:51], 3, v6
    v_cndmask_b32 v16, v8, v5, s[44:45]
    v_cndmask_b32 v17, v8, v5, s[46:47]
    v_cndmask_b32 v18, v8, v5, s[48:49]
    v_cndmask_b32 v19, v8, v5, s[50:51]
    v_cmp_gt_i32 s[44:45], 16, v6
    v_cmp_gt_i32 s[46:47], 17, v6
    v_cmp_gt_i32 s[48:49], 18, v6
    v_cmp_gt_i32 s[50:51], 19, v6
    v_cndmask_b32 v32, v8, v5, s[44:45]
    v_cndmask_b32 v33, v8, v5, s[46:47]
    v_cndmask_b32 v34, v8, v5, s[48:49]
    v_cndmask_b32 v35, v8, v5, s[50:51]
    s_nop 1
    s_branch k2_prepret_85
k2_prep_102:
    s_sub_u32 s40, s36, s39
    v_subrev_u32 v6, s40, v4
    v_cmp_gt_i32 s[44:45], 0, v6
    v_cmp_gt_i32 s[46:47], 1, v6
    v_cmp_gt_i32 s[48:49], 2, v6
    v_cmp_gt_i32 s[50:51], 3, v6
    v_cndmask_b32 v16, v10, v5, s[44:45]
    v_cndmask_b32 v17, v10, v5, s[46:47]
    v_cndmask_b32 v18, v10, v5, s[48:49]
    v_cndmask_b32 v19, v10, v5, s[50:51]
    v_cmp_gt_i32 s[44:45], 16, v6
    v_cmp_gt_i32 s[46:47], 17, v6
    v_cmp_gt_i32 s[48:49], 18, v6
    v_cmp_gt_i32 s[50:51], 19, v6
    v_cndmask_b32 v32, v10, v5, s[44:45]
    v_cndmask_b32 v33, v10, v5, s[46:47]
    v_cndmask_b32 v34, v10, v5, s[48:49]
    v_cndmask_b32 v35, v10, v5, s[50:51]
    v_cmp_gt_i32 s[44:45], 32, v6
    v_cmp_gt_i32 s[46:47], 33, v6
    v_cmp_gt_i32 s[48:49], 34, v6
    v_cmp_gt_i32 s[50:51], 35, v6
    v_cndmask_b32 v24, v10, v5, s[44:45]
    v_cndmask_b32 v25, v10, v5, s[46:47]
    v_cndmask_b32 v26, v10, v5, s[48:49]
    v_cndmask_b32 v27, v10, v5, s[50:51]
    v_cmp_gt_i32 s[44:45], 48, v6
    v_cmp_gt_i32 s[46:47], 49, v6
    v_cmp_gt_i32 s[48:49], 50, v6
    v_cmp_gt_i32 s[50:51], 51, v6
    v_cndmask_b32 v40, v10, v5, s[44:45]
    v_cndmask_b32 v41, v10, v5, s[46:47]
    v_cndmask_b32 v42, v10, v5, s[48:49]
    v_cndmask_b32 v43, v10, v5, s[50:51]
    s_nop 1
    s_branch k2_prepret_103
k2_prep_106:
    s_sub_u32 s40, s36, s39
    s_sub_u32 s40, s40, 64
    v_subrev_u32 v6, s40, v4
    v_cmp_gt_i32 s[44:45], 0, v6
    v_cmp_gt_i32 s[46:47], 1, v6
    v_cmp_gt_i32 s[48:49], 2, v6
    v_cmp_gt_i32 s[50:51], 3, v6
    v_cndmask_b32 v20, v11, v5, s[44:45]
    v_cndmask_b32 v21, v11, v5, s[46:47]
    v_cndmask_b32 v22, v11, v5, s[48:49]
    v_cndmask_b32 v23, v11, v5, s[50:51]
    v_cmp_gt_i32 s[44:45], 16, v6
    v_cmp_gt_i32 s[46:47], 17, v6
    v_cmp_gt_i32 s[48:49], 18, v6
    v_cmp_gt_i32 s[50:51], 19, v6
    v_cndmask_b32 v36, v11, v5, s[44:45]
    v_cndmask_b32 v37, v11, v5, s[46:47]
    v_cndmask_b32 v38, v11, v5, s[48:49]
    v_cndmask_b32 v39, v11, v5, s[50:51]
    v_cmp_gt_i32 s[44:45], 32, v6
    v_cmp_gt_i32 s[46:47], 33, v6
    v_cmp_gt_i32 s[48:49], 34, v6
    v_cmp_gt_i32 s[50:51], 35, v6
    v_cndmask_b32 v28, v11, v5, s[44:45]
    v_cndmask_b32 v29, v11, v5, s[46:47]
    v_cndmask_b32 v30, v11, v5, s[48:49]
    v_cndmask_b32 v31, v11, v5, s[50:51]
    v_cmp_gt_i32 s[44:45], 48, v6
    v_cmp_gt_i32 s[46:47], 49, v6
    v_cmp_gt_i32 s[48:49], 50, v6
    v_cmp_gt_i32 s[50:51], 51, v6
    v_cndmask_b32 v44, v11, v5, s[44:45]
    v_cndmask_b32 v45, v11, v5, s[46:47]
    v_cndmask_b32 v46, v11, v5, s[48:49]
    v_cndmask_b32 v47, v11, v5, s[50:51]
    s_nop 1
    s_branch k2_prepret_107
k12_ool_10:
    buffer_load_dword v52, v8, s[24:27], 0 offen sc1
    s_branch k12_oolret_11
k12_ool_14:
    v_readfirstlane_b32 s31, v52
    s_cmp_ge_u32 s31, 256
    s_cbranch_scc1 spin_ok_12
    s_mov_b32 s40, 1048576
spin_13:
    s_sleep 8
    buffer_load_dword v52, v8, s[24:27], 0 offen sc1
    s_waitcnt vmcnt(0)
    v_readfirstlane_b32 s31, v52
    s_sub_u32 s40, s40, 1
    s_cselect_b32 s31, -1, s31
    s_cmp_lt_u32 s31, 256
    s_cbranch_scc1 spin_13
spin_ok_12:
    s_branch k12_oolret_15
k12_ool_16:
    s_mov_b64 exec, 1
    buffer_atomic_add v9, v8, s[24:27], 0 offen sc1
    s_mov_b64 exec, -1
    s_branch k12_oolret_17
k12_ool_18:
    buffer_load_dword v51, v50, s[12:15], s56 offen
    s_branch k12_oolret_19
k12_ool_20:
    s_add_u32 m0, s60, 131072
    s_nop 0
    buffer_load_dwordx4 v38, s[12:15], s61 offen offset:0 lds
    buffer_load_dwordx4 v39, s[12:15], s61 offen offset:1024 lds
    buffer_load_dwordx4 v40, s[12:15], s61 offen offset:2048 lds
    buffer_load_dwordx4 v41, s[12:15], s61 offen offset:3072 lds
    s_add_u32 s61, s61, 0x80000
    s_add_u32 m0, s60, 147456
    s_nop 0
    buffer_load_dwordx4 v38, s[12:15], s61 offen offset:0 lds
    buffer_load_dwordx4 v39, s[12:15], s61 offen offset:1024 lds
    buffer_load_dwordx4 v40, s[12:15], s61 offen offset:2048 lds
    buffer_load_dwordx4 v41, s[12:15], s61 offen offset:3072 lds
    s_add_u32 s61, s61, 0x80000
    s_branch k12_oolret_21
k12_ool_22:
    s_mov_b64 exec, 1
    buffer_atomic_add v9, v8, s[24:27], 0 offen sc1
    s_mov_b64 exec, -1
    s_branch k12_oolret_23
k12_ool_24:
    buffer_load_dword v51, v50, s[12:15], s56 offen
    s_branch k12_oolret_25
k12_ool_26:
    global_load_dword v51, v[2:3], off
    s_branch k12_oolret_27
k12_ool_30:
    buffer_load_dword v52, v8, s[24:27], 0 offen sc1
    s_branch k12_oolret_31
k12_ool_34:
    v_readfirstlane_b32 s31, v52
    s_cmp_ge_u32 s31, 256
    s_cbranch_scc1 spin_ok_32
    s_mov_b32 s40, 1048576
spin_33:
    s_sleep 8
    buffer_load_dword v52, v8, s[24:27], 0 offen sc1
    s_waitcnt vmcnt(0)
    v_readfirstlane_b32 s31, v52
    s_sub_u32 s40, s40, 1
    s_cselect_b32 s31, -1, s31
    s_cmp_lt_u32 s31, 256
    s_cbranch_scc1 spin_33
spin_ok_32:
    s_branch k12_oolret_35
k12_ool_36:
    s_mov_b64 exec, 1
    buffer_atomic_add v9, v8, s[24:27], 0 offen sc1
    s_mov_b64 exec, -1
    s_branch k12_oolret_37
k12_ool_38:
    buffer_load_dword v51, v50, s[12:15], s56 offen
    s_branch k12_oolret_39
k12_ool_40:
    s_add_u32 m0, s60, 131072
    s_nop 0
    buffer_load_dwordx4 v38, s[12:15], s61 offen offset:0 lds
    buffer_load_dwordx4 v39, s[12:15], s61 offen offset:1024 lds
    buffer_load_dwordx4 v40, s[12:15], s61 offen offset:2048 lds
    buffer_load_dwordx4 v41, s[12:15], s61 offen offset:3072 lds
    s_add_u32 s61, s61, 0x80000
    s_add_u32 m0, s60, 147456
    s_nop 0
    buffer_load_dwordx4 v38, s[12:15], s61 offen offset:0 lds
    buffer_load_dwordx4 v39, s[12:15], s61 offen offset:1024 lds
    buffer_load_dwordx4 v40, s[12:15], s61 offen offset:2048 lds
    buffer_load_dwordx4 v41, s[12:15], s61 offen offset:3072 lds
    s_add_u32 s61, s61, 0x80000
    s_branch k12_oolret_41
k12_ool_42:
    s_mov_b64 exec, 1
    buffer_atomic_add v9, v8, s[24:27], 0 offen sc1
    s_mov_b64 exec, -1
    s_branch k12_oolret_43
k12_ool_44:
    buffer_load_dword v51, v50, s[12:15], s56 offen
    s_branch k12_oolret_45
k12_ool_46:
    global_load_dword v51, v[2:3], off
    s_branch k12_oolret_47
k12_ool_48:
    s_add_u32 s52, s47, 528384
    buffer_store_dwordx4 v[152:155], v1, s[48:51], s52 offen offset:2048 sc1
    s_branch k12_oolret_49
k12_ool_50:
    s_add_u32 s52, s47, 528384
    buffer_store_dwordx4 v[156:159], v1, s[48:51], s52 offen offset:3072 sc1
    s_branch k12_oolret_51
k12_ool_52:
    s_add_u32 s52, s47, 532480
    buffer_store_dwordx4 v[168:171], v1, s[48:51], s52 offen offset:2048 sc1
    s_branch k12_oolret_53
k12_ool_54:
    s_add_u32 s52, s47, 532480
    buffer_store_dwordx4 v[172:175], v1, s[48:51], s52 offen offset:3072 sc1
    s_branch k12_oolret_55
k12_ool_56:
    s_add_u32 s52, s47, 536576
    buffer_store_dwordx4 v[176:179], v1, s[48:51], s52 offen offset:0 sc1
    s_branch k12_oolret_57
k12_ool_58:
    s_add_u32 s52, s47, 536576
    buffer_store_dwordx4 v[180:183], v1, s[48:51], s52 offen offset:1024 sc1
    s_branch k12_oolret_59
k12_ool_60:
    s_add_u32 s52, s47, 536576
    buffer_store_dwordx4 v[184:187], v1, s[48:51], s52 offen offset:2048 sc1
    s_branch k12_oolret_61
k12_ool_62:
    s_add_u32 s52, s47, 536576
    buffer_store_dwordx4 v[188:191], v1, s[48:51], s52 offen offset:3072 sc1
    s_branch k12_oolret_63
k12_ool_64:
    s_mov_b32 s50, 0
    s_branch k12_oolret_65
k12_ool_66:
    s_mov_b64 exec, 1
    buffer_atomic_add v9, v8, s[24:27], s54 offen sc1
    s_mov_b64 exec, -1
    s_branch k12_oolret_67
k12_ool_68:
    buffer_load_dword v52, v8, s[24:27], s55 offen sc1
    s_branch k12_oolret_69
k12_ool_72:
    s_waitcnt vmcnt(14)
    v_readfirstlane_b32 s31, v52
    s_cmp_ge_u32 s31, 2
    s_cbranch_scc1 spin_ok_70
    s_mov_b32 s40, 1048576
spin_71:
    s_sleep 8
    buffer_load_dword v52, v8, s[24:27], s55 offen sc1
    s_waitcnt vmcnt(0)
    v_readfirstlane_b32 s31, v52
    s_sub_u32 s40, s40, 1
    s_cselect_b32 s31, -1, s31
    s_cmp_lt_u32 s31, 2
    s_cbranch_scc1 spin_71
spin_ok_70:
    s_branch k12_oolret_73
k12_ool_74:
    s_mov_b64 exec, 1
    buffer_atomic_add v9, v8, s[24:27], s3 offen sc1
    s_mov_b64 exec, -1
    s_branch k12_oolret_75
k12_ool_78:
    buffer_load_dword v58, v59, s[24:27], s5 offen sc1
    s_branch k12_oolret_79
k12_ool_82:
    s_waitcnt vmcnt(0)
    v_readfirstlane_b32 s31, v58
    s_cmp_ge_u32 s31, 14
    s_cbranch_scc1 spin_ok_80
    s_mov_b32 s40, 1048576
spin_81:
    s_sleep 8
    buffer_load_dword v58, v59, s[24:27], s5 offen sc1
    s_waitcnt vmcnt(0)
    v_readfirstlane_b32 s31, v58
    s_sub_u32 s40, s40, 1
    s_cselect_b32 s31, -1, s31
    s_cmp_lt_u32 s31, 14
    s_cbranch_scc1 spin_81
spin_ok_80:
    s_branch k12_oolret_83
k12_ool_122:
    s_mov_b64 exec, 1
    buffer_atomic_add v76, v75, s[16:19], s57 offen sc1
    s_mov_b64 exec, -1
    s_branch k12_oolret_123
k12_ool_127:
    s_mov_b64 exec, 1
    buffer_atomic_add v76, v75, s[16:19], s58 offen sc1
    s_mov_b64 exec, -1
    s_branch k12_oolret_128
k12_ool_131:
    s_mov_b32 s34, 1048576
op_spin_129:
    buffer_load_dword v74, v73, s[16:19], s59 offen sc1
    s_waitcnt vmcnt(0)
    v_cmp_le_u32 vcc, 4, v74
    s_sub_u32 s34, s34, 1
    s_cbranch_scc1 op_ok_130
    s_mov_b32 s33, vcc_lo
    s_bitcmp1_b32 s33, 0
    s_cbranch_scc1 op_ok_130
    s_sleep 4
    s_branch op_spin_129
op_ok_130:
    buffer_load_dwordx4 a[128:131], v88, s[8:11], s62 offen offset:0 sc1
    buffer_load_dwordx4 a[132:135], v88, s[8:11], s62 offen offset:1024 sc1
    buffer_load_dwordx4 a[136:139], v89, s[8:11], s62 offen offset:0 sc1
    buffer_load_dwordx4 a[140:143], v89, s[8:11], s62 offen offset:1024 sc1
    s_add_u32 s62, s62, 0x40000
    s_and_b32 s62, s62, 0x7fffff
    buffer_load_dwordx4 a[144:147], v88, s[8:11], s62 offen offset:0 sc1
    buffer_load_dwordx4 a[148:151], v88, s[8:11], s62 offen offset:1024 sc1
    buffer_load_dwordx4 a[152:155], v89, s[8:11], s62 offen offset:0 sc1
    buffer_load_dwordx4 a[156:159], v89, s[8:11], s62 offen offset:1024 sc1
    s_add_u32 s62, s62, 0x40000
    s_and_b32 s62, s62, 0x7fffff
    buffer_load_dwordx4 a[160:163], v88, s[8:11], s62 offen offset:0 sc1
    buffer_load_dwordx4 a[164:167], v88, s[8:11], s62 offen offset:1024 sc1
    buffer_load_dwordx4 a[168:171], v89, s[8:11], s62 offen offset:0 sc1
    buffer_load_dwordx4 a[172:175], v89, s[8:11], s62 offen offset:1024 sc1
    s_add_u32 s62, s62, 0x40000
    s_and_b32 s62, s62, 0x7fffff
    s_branch k12_oolret_132
k12_ool_137:
    buffer_load_dwordx2 v[192:193], v78, s[20:23], 0 offen offset:0
    buffer_load_dwordx2 v[194:195], v78, s[20:23], 0 offen offset:32
    buffer_load_dwordx2 v[196:197], v78, s[20:23], 0 offen offset:64
    buffer_load_dwordx2 v[198:199], v78, s[20:23], 0 offen offset:96
    buffer_load_dwordx2 v[200:201], v79, s[20:23], 0 offen offset:0
    buffer_load_dwordx2 v[202:203], v79, s[20:23], 0 offen offset:32
    buffer_load_dwordx2 v[204:205], v79, s[20:23], 0 offen offset:64
    buffer_load_dwordx2 v[206:207], v79, s[20:23], 0 offen offset:96
    buffer_load_dwordx2 v[208:209], v80, s[44:47], 0 offen offset:0
    buffer_load_dwordx2 v[210:211], v80, s[44:47], 0 offen offset:32
    buffer_load_dwordx2 v[212:213], v80, s[44:47], 0 offen offset:64
    buffer_load_dwordx2 v[214:215], v80, s[44:47], 0 offen offset:96
    global_load_dword v84, v[82:83], off
    s_mov_b32 s10, 0
    s_mov_b32 s14, 0
    s_mov_b32 s34, 1048576
ff_spin_135:
    v_cmp_gt_u32 vcc, 4, v95
    s_cbranch_vccz ff_ok_136
    s_sub_u32 s34, s34, 1
    s_cbranch_scc1 ff_ok_136
    s_sleep 4
    buffer_load_dword v95, v94, s[16:19], 0 offen sc1
    s_waitcnt vmcnt(0)
    s_branch ff_spin_135
ff_ok_136:
    s_add_u32 s44, s6, 0x6000000
    s_addc_u32 s45, s7, 0
    s_and_b32 s45, s45, 0xffff
    s_cmp_ge_u32 s2, 224
    s_cselect_b32 s46, 0, 0x1000000
    s_branch k12_oolret_138
k12_ool_141:
    s_mov_b32 s34, 1048576
op_spin_139:
    buffer_load_dword v74, v73, s[16:19], s59 offen sc1
    s_waitcnt vmcnt(0)
    v_cmp_le_u32 vcc, 4, v74
    s_sub_u32 s34, s34, 1
    s_cbranch_scc1 op_ok_140
    s_mov_b32 s33, vcc_lo
    s_bitcmp1_b32 s33, s32
    s_cbranch_scc1 op_ok_140
    s_sleep 4
    s_branch op_spin_139
op_ok_140:
    s_branch k12_oolret_142
k12_ool_143:
    buffer_load_dword v95, v94, s[16:19], 0 offen sc1
    s_branch k12_oolret_144
k2_tramp_86:
    s_call_b64 s[40:41], k2_rare_158
    s_branch k2_ret_87
k2_tramp_90:
    s_call_b64 s[40:41], k2_rare_159
    s_branch k2_ret_91
k2_tramp_92:
    s_call_b64 s[40:41], k2_rare_158
    s_branch k2_ret_93
k2_tramp_94:
    s_call_b64 s[40:41], k2_rare_159
    s_branch k2_ret_95
k2_tramp_96:
    s_call_b64 s[40:41], k2_rare_158
    s_branch k2_ret_97
k2_tramp_98:
    s_call_b64 s[40:41], k2_rare_159
    s_branch k2_ret_99
k2_tramp_100:
    s_call_b64 s[40:41], k2_rare_164
    s_branch k2_ret_101
k2_tramp_104:
    s_call_b64 s[40:41], k2_rare_165
    s_branch k2_ret_105
k2_tramp_108:
    s_call_b64 s[40:41], k2_rare_166
    s_branch k2_ret_109
k2_tramp_112:
    s_call_b64 s[40:41], k2_rare_167
    s_branch k2_ret_113
k2_tramp_114:
    s_call_b64 s[40:41], k2_rare_166
    s_branch k2_ret_115
k2_tramp_116:
    s_call_b64 s[40:41], k2_rare_167
    s_branch k2_ret_117
k2_tramp_118:
    s_call_b64 s[40:41], k2_rare_166
    s_branch k2_ret_119
k2_tramp_120:
    s_call_b64 s[40:41], k2_rare_171
    s_branch k2_ret_121
k2_rare_158:
    s_nop 7
    v_max_f32 v52, v128, v129
    v_max3_f32 v52, v52, v130, v131
    v_max3_f32 v52, v52, v144, v145
    v_max3_f32 v52, v52, v146, v147
    v_max_f32 v53, v132, v133
    v_max3_f32 v53, v53, v134, v135
    v_max3_f32 v53, v53, v148, v149
    v_max3_f32 v53, v53, v150, v151
    v_max_f32 v54, v136, v137
    v_max3_f32 v54, v54, v138, v139
    v_max3_f32 v54, v54, v152, v153
    v_max3_f32 v54, v54, v154, v155
    v_max_f32 v55, v140, v141
    v_max3_f32 v55, v55, v142, v143
    v_max3_f32 v55, v55, v156, v157
    v_max3_f32 v55, v55, v158, v159
    v_mov_b32 v224, v52
    v_mov_b32 v225, v53
    v_mov_b32 v226, v54
    v_mov_b32 v227, v55
    s_nop 1
    v_permlane16_swap_b32 v52, v224
    v_permlane16_swap_b32 v53, v225
    v_permlane16_swap_b32 v54, v226
    v_permlane16_swap_b32 v55, v227
    s_nop 1
    v_max_f32 v52, v52, v224
    v_max_f32 v53, v53, v225
    v_max_f32 v54, v54, v226
    v_max_f32 v55, v55, v227
    v_mov_b32 v224, v52
    v_mov_b32 v225, v53
    v_mov_b32 v226, v54
    v_mov_b32 v227, v55
    s_nop 1
    v_permlane32_swap_b32 v52, v224
    v_permlane32_swap_b32 v53, v225
    v_permlane32_swap_b32 v54, v226
    v_permlane32_swap_b32 v55, v227
    s_nop 1
    v_max_f32 v52, v52, v224
    v_max_f32 v53, v53, v225
    v_max_f32 v54, v54, v226
    v_max_f32 v55, v55, v227
    v_add_f32 v52, 0x41400000, v52
    v_max_f32 v52, 0, v52
    v_add_f32 v53, 0x41400000, v53
    v_max_f32 v53, 0, v53
    v_add_f32 v54, 0x41400000, v54
    v_max_f32 v54, 0, v54
    v_add_f32 v55, 0x41400000, v55
    v_max_f32 v55, 0, v55
    v_sub_f32 v128, v128, v52
    v_sub_f32 v129, v129, v52
    v_sub_f32 v130, v130, v52
    v_sub_f32 v131, v131, v52
    v_sub_f32 v132, v132, v53
    v_sub_f32 v133, v133, v53
    v_sub_f32 v134, v134, v53
    v_sub_f32 v135, v135, v53
    v_sub_f32 v136, v136, v54
    v_sub_f32 v137, v137, v54
    v_sub_f32 v138, v138, v54
    v_sub_f32 v139, v139, v54
    v_sub_f32 v140, v140, v55
    v_sub_f32 v141, v141, v55
    v_sub_f32 v142, v142, v55
    v_sub_f32 v143, v143, v55
    v_sub_f32 v144, v144, v52
    v_sub_f32 v145, v145, v52
    v_sub_f32 v146, v146, v52
    v_sub_f32 v147, v147, v52
    v_sub_f32 v148, v148, v53
    v_sub_f32 v149, v149, v53
    v_sub_f32 v150, v150, v53
    v_sub_f32 v151, v151, v53
    v_sub_f32 v152, v152, v54
    v_sub_f32 v153, v153, v54
    v_sub_f32 v154, v154, v54
    v_sub_f32 v155, v155, v54
    v_sub_f32 v156, v156, v55
    v_sub_f32 v157, v157, v55
    v_sub_f32 v158, v158, v55
    v_sub_f32 v159, v159, v55
    v_sub_f32 v160, v160, v52
    v_sub_f32 v16, v16, v52
    v_sub_f32 v161, v161, v52
    v_sub_f32 v17, v17, v52
    v_sub_f32 v162, v162, v52
    v_sub_f32 v18, v18, v52
    v_sub_f32 v163, v163, v52
    v_sub_f32 v19, v19, v52
    v_sub_f32 v164, v164, v53
    v_sub_f32 v20, v20, v53
    v_sub_f32 v165, v165, v53
    v_sub_f32 v21, v21, v53
    v_sub_f32 v166, v166, v53
    v_sub_f32 v22, v22, v53
    v_sub_f32 v167, v167, v53
    v_sub_f32 v23, v23, v53
    v_sub_f32 v168, v168, v54
    v_sub_f32 v24, v24, v54
    v_sub_f32 v169, v169, v54
    v_sub_f32 v25, v25, v54
    v_sub_f32 v170, v170, v54
    v_sub_f32 v26, v26, v54
    v_sub_f32 v171, v171, v54
    v_sub_f32 v27, v27, v54
    v_sub_f32 v172, v172, v55
    v_sub_f32 v28, v28, v55
    v_sub_f32 v173, v173, v55
    v_sub_f32 v29, v29, v55
    v_sub_f32 v174, v174, v55
    v_sub_f32 v30, v30, v55
    v_sub_f32 v175, v175, v55
    v_sub_f32 v31, v31, v55
    v_sub_f32 v176, v176, v52
    v_sub_f32 v32, v32, v52
    v_sub_f32 v177, v177, v52
    v_sub_f32 v33, v33, v52
    v_sub_f32 v178, v178, v52
    v_sub_f32 v34, v34, v52
    v_sub_f32 v179, v179, v52
    v_sub_f32 v35, v35, v52
    v_sub_f32 v180, v180, v53
    v_sub_f32 v36, v36, v53
    v_sub_f32 v181, v181, v53
    v_sub_f32 v37, v37, v53
    v_sub_f32 v182, v182, v53
    v_sub_f32 v38, v38, v53
    v_sub_f32 v183, v183, v53
    v_sub_f32 v39, v39, v53
    v_sub_f32 v184, v184, v54
    v_sub_f32 v40, v40, v54
    v_sub_f32 v185, v185, v54
    v_sub_f32 v41, v41, v54
    v_sub_f32 v186, v186, v54
    v_sub_f32 v42, v42, v54
    v_sub_f32 v187, v187, v54
    v_sub_f32 v43, v43, v54
    v_sub_f32 v188, v188, v55
    v_sub_f32 v44, v44, v55
    v_sub_f32 v189, v189, v55
    v_sub_f32 v45, v45, v55
    v_sub_f32 v190, v190, v55
    v_sub_f32 v46, v46, v55
    v_sub_f32 v191, v191, v55
    v_sub_f32 v47, v47, v55
    v_sub_f32 v8, v8, v52
    v_exp_f32 v52, -v52
    v_sub_f32 v9, v9, v53
    v_exp_f32 v53, -v53
    v_sub_f32 v10, v10, v54
    v_exp_f32 v54, -v54
    v_sub_f32 v11, v11, v55
    v_exp_f32 v55, -v55
    s_nop 0
    v_mul_f32 v12, v12, v52
    v_mul_f32 v48, v48, v53
    v_mul_f32 v248, v248, v54
    v_mul_f32 v252, v252, v55
    v_accvgpr_read_b32 v224, a0
    v_accvgpr_read_b32 v225, a1
    v_accvgpr_read_b32 v226, a2
    v_accvgpr_read_b32 v227, a3
    v_mul_f32 v224, v224, v52
    v_mul_f32 v225, v225, v52
    v_mul_f32 v226, v226, v52
    v_mul_f32 v227, v227, v52
    v_accvgpr_write_b32 a0, v224
    v_accvgpr_write_b32 a1, v225
    v_accvgpr_write_b32 a2, v226
    v_accvgpr_write_b32 a3, v227
    v_accvgpr_read_b32 v224, a4
    v_accvgpr_read_b32 v225, a5
    v_accvgpr_read_b32 v226, a6
    v_accvgpr_read_b32 v227, a7
    v_mul_f32 v224, v224, v53
    v_mul_f32 v225, v225, v53
    v_mul_f32 v226, v226, v53
    v_mul_f32 v227, v227, v53
    v_accvgpr_write_b32 a4, v224
    v_accvgpr_write_b32 a5, v225
    v_accvgpr_write_b32 a6, v226
    v_accvgpr_write_b32 a7, v227
    v_accvgpr_read_b32 v224, a8
    v_accvgpr_read_b32 v225, a9
    v_accvgpr_read_b32 v226, a10
    v_accvgpr_read_b32 v227, a11
    v_mul_f32 v224, v224, v54
    v_mul_f32 v225, v225, v54
    v_mul_f32 v226, v226, v54
    v_mul_f32 v227, v227, v54
    v_accvgpr_write_b32 a8, v224
    v_accvgpr_write_b32 a9, v225
    v_accvgpr_write_b32 a10, v226
    v_accvgpr_write_b32 a11, v227
    v_accvgpr_read_b32 v224, a12
    v_accvgpr_read_b32 v225, a13
    v_accvgpr_read_b32 v226, a14
    v_accvgpr_read_b32 v227, a15
    v_mul_f32 v224, v224, v55
    v_mul_f32 v225, v225, v55
    v_mul_f32 v226, v226, v55
    v_mul_f32 v227, v227, v55
    v_accvgpr_write_b32 a12, v224
    v_accvgpr_write_b32 a13, v225
    v_accvgpr_write_b32 a14, v226
    v_accvgpr_write_b32 a15, v227
    v_accvgpr_read_b32 v224, a16
    v_accvgpr_read_b32 v225, a17
    v_accvgpr_read_b32 v226, a18
    v_accvgpr_read_b32 v227, a19
    v_mul_f32 v224, v224, v52
    v_mul_f32 v225, v225, v52
    v_mul_f32 v226, v226, v52
    v_mul_f32 v227, v227, v52
    v_accvgpr_write_b32 a16, v224
    v_accvgpr_write_b32 a17, v225
    v_accvgpr_write_b32 a18, v226
    v_accvgpr_write_b32 a19, v227
    v_accvgpr_read_b32 v224, a20
    v_accvgpr_read_b32 v225, a21
    v_accvgpr_read_b32 v226, a22
    v_accvgpr_read_b32 v227, a23
    v_mul_f32 v224, v224, v53
    v_mul_f32 v225, v225, v53
    v_mul_f32 v226, v226, v53
    v_mul_f32 v227, v227, v53
    v_accvgpr_write_b32 a20, v224
    v_accvgpr_write_b32 a21, v225
    v_accvgpr_write_b32 a22, v226
    v_accvgpr_write_b32 a23, v227
    v_accvgpr_read_b32 v224, a24
    v_accvgpr_read_b32 v225, a25
    v_accvgpr_read_b32 v226, a26
    v_accvgpr_read_b32 v227, a27
    v_mul_f32 v224, v224, v54
    v_mul_f32 v225, v225, v54
    v_mul_f32 v226, v226, v54
    v_mul_f32 v227, v227, v54
    v_accvgpr_write_b32 a24, v224
    v_accvgpr_write_b32 a25, v225
    v_accvgpr_write_b32 a26, v226
    v_accvgpr_write_b32 a27, v227
    v_accvgpr_read_b32 v224, a28
    v_accvgpr_read_b32 v225, a29
    v_accvgpr_read_b32 v226, a30
    v_accvgpr_read_b32 v227, a31
    v_mul_f32 v224, v224, v55
    v_mul_f32 v225, v225, v55
    v_mul_f32 v226, v226, v55
    v_mul_f32 v227, v227, v55
    v_accvgpr_write_b32 a28, v224
    v_accvgpr_write_b32 a29, v225
    v_accvgpr_write_b32 a30, v226
    v_accvgpr_write_b32 a31, v227
    v_accvgpr_read_b32 v224, a32
    v_accvgpr_read_b32 v225, a33
    v_accvgpr_read_b32 v226, a34
    v_accvgpr_read_b32 v227, a35
    v_mul_f32 v224, v224, v52
    v_mul_f32 v225, v225, v52
    v_mul_f32 v226, v226, v52
    v_mul_f32 v227, v227, v52
    v_accvgpr_write_b32 a32, v224
    v_accvgpr_write_b32 a33, v225
    v_accvgpr_write_b32 a34, v226
    v_accvgpr_write_b32 a35, v227
    v_accvgpr_read_b32 v224, a36
    v_accvgpr_read_b32 v225, a37
    v_accvgpr_read_b32 v226, a38
    v_accvgpr_read_b32 v227, a39
    v_mul_f32 v224, v224, v53
    v_mul_f32 v225, v225, v53
    v_mul_f32 v226, v226, v53
    v_mul_f32 v227, v227, v53
    v_accvgpr_write_b32 a36, v224
    v_accvgpr_write_b32 a37, v225
    v_accvgpr_write_b32 a38, v226
    v_accvgpr_write_b32 a39, v227
    v_accvgpr_read_b32 v224, a40
    v_accvgpr_read_b32 v225, a41
    v_accvgpr_read_b32 v226, a42
    v_accvgpr_read_b32 v227, a43
    v_mul_f32 v224, v224, v54
    v_mul_f32 v225, v225, v54
    v_mul_f32 v226, v226, v54
    v_mul_f32 v227, v227, v54
    v_accvgpr_write_b32 a40, v224
    v_accvgpr_write_b32 a41, v225
    v_accvgpr_write_b32 a42, v226
    v_accvgpr_write_b32 a43, v227
    v_accvgpr_read_b32 v224, a44
    v_accvgpr_read_b32 v225, a45
    v_accvgpr_read_b32 v226, a46
    v_accvgpr_read_b32 v227, a47
    v_mul_f32 v224, v224, v55
    v_mul_f32 v225, v225, v55
    v_mul_f32 v226, v226, v55
    v_mul_f32 v227, v227, v55
    v_accvgpr_write_b32 a44, v224
    v_accvgpr_write_b32 a45, v225
    v_accvgpr_write_b32 a46, v226
    v_accvgpr_write_b32 a47, v227
    v_accvgpr_read_b32 v224, a48
    v_accvgpr_read_b32 v225, a49
    v_accvgpr_read_b32 v226, a50
    v_accvgpr_read_b32 v227, a51
    v_mul_f32 v224, v224, v52
    v_mul_f32 v225, v225, v52
    v_mul_f32 v226, v226, v52
    v_mul_f32 v227, v227, v52
    v_accvgpr_write_b32 a48, v224
    v_accvgpr_write_b32 a49, v225
    v_accvgpr_write_b32 a50, v226
    v_accvgpr_write_b32 a51, v227
    v_accvgpr_read_b32 v224, a52
    v_accvgpr_read_b32 v225, a53
    v_accvgpr_read_b32 v226, a54
    v_accvgpr_read_b32 v227, a55
    v_mul_f32 v224, v224, v53
    v_mul_f32 v225, v225, v53
    v_mul_f32 v226, v226, v53
    v_mul_f32 v227, v227, v53
    v_accvgpr_write_b32 a52, v224
    v_accvgpr_write_b32 a53, v225
    v_accvgpr_write_b32 a54, v226
    v_accvgpr_write_b32 a55, v227
    v_accvgpr_read_b32 v224, a56
    v_accvgpr_read_b32 v225, a57
    v_accvgpr_read_b32 v226, a58
    v_accvgpr_read_b32 v227, a59
    v_mul_f32 v224, v224, v54
    v_mul_f32 v225, v225, v54
    v_mul_f32 v226, v226, v54
    v_mul_f32 v227, v227, v54
    v_accvgpr_write_b32 a56, v224
    v_accvgpr_write_b32 a57, v225
    v_accvgpr_write_b32 a58, v226
    v_accvgpr_write_b32 a59, v227
    v_accvgpr_read_b32 v224, a60
    v_accvgpr_read_b32 v225, a61
    v_accvgpr_read_b32 v226, a62
    v_accvgpr_read_b32 v227, a63
    v_mul_f32 v224, v224, v55
    v_mul_f32 v225, v225, v55
    v_mul_f32 v226, v226, v55
    v_mul_f32 v227, v227, v55
    v_accvgpr_write_b32 a60, v224
    v_accvgpr_write_b32 a61, v225
    v_accvgpr_write_b32 a62, v226
    v_accvgpr_write_b32 a63, v227
    v_accvgpr_read_b32 v224, a64
    v_accvgpr_read_b32 v225, a65
    v_accvgpr_read_b32 v226, a66
    v_accvgpr_read_b32 v227, a67
    v_mul_f32 v224, v224, v52
    v_mul_f32 v225, v225, v52
    v_mul_f32 v226, v226, v52
    v_mul_f32 v227, v227, v52
    v_accvgpr_write_b32 a64, v224
    v_accvgpr_write_b32 a65, v225
    v_accvgpr_write_b32 a66, v226
    v_accvgpr_write_b32 a67, v227
    v_accvgpr_read_b32 v224, a68
    v_accvgpr_read_b32 v225, a69
    v_accvgpr_read_b32 v226, a70
    v_accvgpr_read_b32 v227, a71
    v_mul_f32 v224, v224, v53
    v_mul_f32 v225, v225, v53
    v_mul_f32 v226, v226, v53
    v_mul_f32 v227, v227, v53
    v_accvgpr_write_b32 a68, v224
    v_accvgpr_write_b32 a69, v225
    v_accvgpr_write_b32 a70, v226
    v_accvgpr_write_b32 a71, v227
    v_accvgpr_read_b32 v224, a72
    v_accvgpr_read_b32 v225, a73
    v_accvgpr_read_b32 v226, a74
    v_accvgpr_read_b32 v227, a75
    v_mul_f32 v224, v224, v54
    v_mul_f32 v225, v225, v54
    v_mul_f32 v226, v226, v54
    v_mul_f32 v227, v227, v54
    v_accvgpr_write_b32 a72, v224
    v_accvgpr_write_b32 a73, v225
    v_accvgpr_write_b32 a74, v226
    v_accvgpr_write_b32 a75, v227
    v_accvgpr_read_b32 v224, a76
    v_accvgpr_read_b32 v225, a77
    v_accvgpr_read_b32 v226, a78
    v_accvgpr_read_b32 v227, a79
    v_mul_f32 v224, v224, v55
    v_mul_f32 v225, v225, v55
    v_mul_f32 v226, v226, v55
    v_mul_f32 v227, v227, v55
    v_accvgpr_write_b32 a76, v224
    v_accvgpr_write_b32 a77, v225
    v_accvgpr_write_b32 a78, v226
    v_accvgpr_write_b32 a79, v227
    v_accvgpr_read_b32 v224, a80
    v_accvgpr_read_b32 v225, a81
    v_accvgpr_read_b32 v226, a82
    v_accvgpr_read_b32 v227, a83
    v_mul_f32 v224, v224, v52
    v_mul_f32 v225, v225, v52
    v_mul_f32 v226, v226, v52
    v_mul_f32 v227, v227, v52
    v_accvgpr_write_b32 a80, v224
    v_accvgpr_write_b32 a81, v225
    v_accvgpr_write_b32 a82, v226
    v_accvgpr_write_b32 a83, v227
    v_accvgpr_read_b32 v224, a84
    v_accvgpr_read_b32 v225, a85
    v_accvgpr_read_b32 v226, a86
    v_accvgpr_read_b32 v227, a87
    v_mul_f32 v224, v224, v53
    v_mul_f32 v225, v225, v53
    v_mul_f32 v226, v226, v53
    v_mul_f32 v227, v227, v53
    v_accvgpr_write_b32 a84, v224
    v_accvgpr_write_b32 a85, v225
    v_accvgpr_write_b32 a86, v226
    v_accvgpr_write_b32 a87, v227
    v_accvgpr_read_b32 v224, a88
    v_accvgpr_read_b32 v225, a89
    v_accvgpr_read_b32 v226, a90
    v_accvgpr_read_b32 v227, a91
    v_mul_f32 v224, v224, v54
    v_mul_f32 v225, v225, v54
    v_mul_f32 v226, v226, v54
    v_mul_f32 v227, v227, v54
    v_accvgpr_write_b32 a88, v224
    v_accvgpr_write_b32 a89, v225
    v_accvgpr_write_b32 a90, v226
    v_accvgpr_write_b32 a91, v227
    v_accvgpr_read_b32 v224, a92
    v_accvgpr_read_b32 v225, a93
    v_accvgpr_read_b32 v226, a94
    v_accvgpr_read_b32 v227, a95
    v_mul_f32 v224, v224, v55
    v_mul_f32 v225, v225, v55
    v_mul_f32 v226, v226, v55
    v_mul_f32 v227, v227, v55
    v_accvgpr_write_b32 a92, v224
    v_accvgpr_write_b32 a93, v225
    v_accvgpr_write_b32 a94, v226
    v_accvgpr_write_b32 a95, v227
    v_accvgpr_read_b32 v224, a96
    v_accvgpr_read_b32 v225, a97
    v_accvgpr_read_b32 v226, a98
    v_accvgpr_read_b32 v227, a99
    v_mul_f32 v224, v224, v52
    v_mul_f32 v225, v225, v52
    v_mul_f32 v226, v226, v52
    v_mul_f32 v227, v227, v52
    v_accvgpr_write_b32 a96, v224
    v_accvgpr_write_b32 a97, v225
    v_accvgpr_write_b32 a98, v226
    v_accvgpr_write_b32 a99, v227
    v_accvgpr_read_b32 v224, a100
    v_accvgpr_read_b32 v225, a101
    v_accvgpr_read_b32 v226, a102
    v_accvgpr_read_b32 v227, a103
    v_mul_f32 v224, v224, v53
    v_mul_f32 v225, v225, v53
    v_mul_f32 v226, v226, v53
    v_mul_f32 v227, v227, v53
    v_accvgpr_write_b32 a100, v224
    v_accvgpr_write_b32 a101, v225
    v_accvgpr_write_b32 a102, v226
    v_accvgpr_write_b32 a103, v227
    v_accvgpr_read_b32 v224, a104
    v_accvgpr_read_b32 v225, a105
    v_accvgpr_read_b32 v226, a106
    v_accvgpr_read_b32 v227, a107
    v_mul_f32 v224, v224, v54
    v_mul_f32 v225, v225, v54
    v_mul_f32 v226, v226, v54
    v_mul_f32 v227, v227, v54
    v_accvgpr_write_b32 a104, v224
    v_accvgpr_write_b32 a105, v225
    v_accvgpr_write_b32 a106, v226
    v_accvgpr_write_b32 a107, v227
    v_accvgpr_read_b32 v224, a108
    v_accvgpr_read_b32 v225, a109
    v_accvgpr_read_b32 v226, a110
    v_accvgpr_read_b32 v227, a111
    v_mul_f32 v224, v224, v55
    v_mul_f32 v225, v225, v55
    v_mul_f32 v226, v226, v55
    v_mul_f32 v227, v227, v55
    v_accvgpr_write_b32 a108, v224
    v_accvgpr_write_b32 a109, v225
    v_accvgpr_write_b32 a110, v226
    v_accvgpr_write_b32 a111, v227
    v_accvgpr_read_b32 v224, a112
    v_accvgpr_read_b32 v225, a113
    v_accvgpr_read_b32 v226, a114
    v_accvgpr_read_b32 v227, a115
    v_mul_f32 v224, v224, v52
    v_mul_f32 v225, v225, v52
    v_mul_f32 v226, v226, v52
    v_mul_f32 v227, v227, v52
    v_accvgpr_write_b32 a112, v224
    v_accvgpr_write_b32 a113, v225
    v_accvgpr_write_b32 a114, v226
    v_accvgpr_write_b32 a115, v227
    v_accvgpr_read_b32 v224, a116
    v_accvgpr_read_b32 v225, a117
    v_accvgpr_read_b32 v226, a118
    v_accvgpr_read_b32 v227, a119
    v_mul_f32 v224, v224, v53
    v_mul_f32 v225, v225, v53
    v_mul_f32 v226, v226, v53
    v_mul_f32 v227, v227, v53
    v_accvgpr_write_b32 a116, v224
    v_accvgpr_write_b32 a117, v225
    v_accvgpr_write_b32 a118, v226
    v_accvgpr_write_b32 a119, v227
    v_accvgpr_read_b32 v224, a120
    v_accvgpr_read_b32 v225, a121
    v_accvgpr_read_b32 v226, a122
    v_accvgpr_read_b32 v227, a123
    v_mul_f32 v224, v224, v54
    v_mul_f32 v225, v225, v54
    v_mul_f32 v226, v226, v54
    v_mul_f32 v227, v227, v54
    v_accvgpr_write_b32 a120, v224
    v_accvgpr_write_b32 a121, v225
    v_accvgpr_write_b32 a122, v226
    v_accvgpr_write_b32 a123, v227
    v_accvgpr_read_b32 v224, a124
    v_accvgpr_read_b32 v225, a125
    v_accvgpr_read_b32 v226, a126
    v_accvgpr_read_b32 v227, a127
    v_mul_f32 v224, v224, v55
    v_mul_f32 v225, v225, v55
    v_mul_f32 v226, v226, v55
    v_mul_f32 v227, v227, v55
    v_accvgpr_write_b32 a124, v224
    v_accvgpr_write_b32 a125, v225
    v_accvgpr_write_b32 a126, v226
    v_accvgpr_write_b32 a127, v227
    v_exp_f32 v232, v128
    v_exp_f32 v233, v129
    v_exp_f32 v234, v130
    v_exp_f32 v235, v131
    s_nop 0
    v_cvt_pk_bf16_f32 v192, v232, v233
    v_cvt_pk_bf16_f32 v193, v234, v235
    v_exp_f32 v232, v144
    v_exp_f32 v233, v145
    v_exp_f32 v234, v146
    v_exp_f32 v235, v147
    s_nop 0
    v_cvt_pk_bf16_f32 v194, v232, v233
    v_cvt_pk_bf16_f32 v195, v234, v235
    v_exp_f32 v232, v132
    v_exp_f32 v233, v133
    v_exp_f32 v234, v134
    v_exp_f32 v235, v135
    s_nop 0
    v_cvt_pk_bf16_f32 v196, v232, v233
    v_cvt_pk_bf16_f32 v197, v234, v235
    v_exp_f32 v232, v148
    v_exp_f32 v233, v149
    v_exp_f32 v234, v150
    v_exp_f32 v235, v151
    s_nop 0
    v_cvt_pk_bf16_f32 v198, v232, v233
    v_cvt_pk_bf16_f32 v199, v234, v235
    v_exp_f32 v232, v136
    v_exp_f32 v233, v137
    v_exp_f32 v234, v138
    v_exp_f32 v235, v139
    s_nop 0
    v_cvt_pk_bf16_f32 v200, v232, v233
    v_cvt_pk_bf16_f32 v201, v234, v235
    v_exp_f32 v232, v152
    v_exp_f32 v233, v153
    v_exp_f32 v234, v154
    v_exp_f32 v235, v155
    s_nop 0
    v_cvt_pk_bf16_f32 v202, v232, v233
    v_cvt_pk_bf16_f32 v203, v234, v235
    v_exp_f32 v232, v140
    v_exp_f32 v233, v141
    v_exp_f32 v234, v142
    v_exp_f32 v235, v143
    s_nop 0
    v_cvt_pk_bf16_f32 v204, v232, v233
    v_cvt_pk_bf16_f32 v205, v234, v235
    v_exp_f32 v232, v156
    v_exp_f32 v233, v157
    v_exp_f32 v234, v158
    v_exp_f32 v235, v159
    s_nop 0
    v_cvt_pk_bf16_f32 v206, v232, v233
    v_cvt_pk_bf16_f32 v207, v234, v235
    s_nop 3
    s_setpc_b64 s[40:41]
k2_rare_159:
    s_nop 7
    v_max_f32 v52, v160, v161
    v_max3_f32 v52, v52, v162, v163
    v_max3_f32 v52, v52, v176, v177
    v_max3_f32 v52, v52, v178, v179
    v_max_f32 v53, v164, v165
    v_max3_f32 v53, v53, v166, v167
    v_max3_f32 v53, v53, v180, v181
    v_max3_f32 v53, v53, v182, v183
    v_max_f32 v54, v168, v169
    v_max3_f32 v54, v54, v170, v171
    v_max3_f32 v54, v54, v184, v185
    v_max3_f32 v54, v54, v186, v187
    v_max_f32 v55, v172, v173
    v_max3_f32 v55, v55, v174, v175
    v_max3_f32 v55, v55, v188, v189
    v_max3_f32 v55, v55, v190, v191
    v_mov_b32 v224, v52
    v_mov_b32 v225, v53
    v_mov_b32 v226, v54
    v_mov_b32 v227, v55
    s_nop 1
    v_permlane16_swap_b32 v52, v224
    v_permlane16_swap_b32 v53, v225
    v_permlane16_swap_b32 v54, v226
    v_permlane16_swap_b32 v55, v227
    s_nop 1
    v_max_f32 v52, v52, v224
    v_max_f32 v53, v53, v225
    v_max_f32 v54, v54, v226
    v_max_f32 v55, v55, v227
    v_mov_b32 v224, v52
    v_mov_b32 v225, v53
    v_mov_b32 v226, v54
    v_mov_b32 v227, v55
    s_nop 1
    v_permlane32_swap_b32 v52, v224
    v_permlane32_swap_b32 v53, v225
    v_permlane32_swap_b32 v54, v226
    v_permlane32_swap_b32 v55, v227
    s_nop 1
    v_max_f32 v52, v52, v224
    v_max_f32 v53, v53, v225
    v_max_f32 v54, v54, v226
    v_max_f32 v55, v55, v227
    v_add_f32 v52, 0x41400000, v52
    v_max_f32 v52, 0, v52
    v_add_f32 v53, 0x41400000, v53
    v_max_f32 v53, 0, v53
    v_add_f32 v54, 0x41400000, v54
    v_max_f32 v54, 0, v54
    v_add_f32 v55, 0x41400000, v55
    v_max_f32 v55, 0, v55
    v_sub_f32 v160, v160, v52
    v_sub_f32 v161, v161, v52
    v_sub_f32 v162, v162, v52
    v_sub_f32 v163, v163, v52
    v_sub_f32 v164, v164, v53
    v_sub_f32 v165, v165, v53
    v_sub_f32 v166, v166, v53
    v_sub_f32 v167, v167, v53
    v_sub_f32 v168, v168, v54
    v_sub_f32 v169, v169, v54
    v_sub_f32 v170, v170, v54
    v_sub_f32 v171, v171, v54
    v_sub_f32 v172, v172, v55
    v_sub_f32 v173, v173, v55
    v_sub_f32 v174, v174, v55
    v_sub_f32 v175, v175, v55
    v_sub_f32 v176, v176, v52
    v_sub_f32 v177, v177, v52
    v_sub_f32 v178, v178, v52
    v_sub_f32 v179, v179, v52
    v_sub_f32 v180, v180, v53
    v_sub_f32 v181, v181, v53
    v_sub_f32 v182, v182, v53
    v_sub_f32 v183, v183, v53
    v_sub_f32 v184, v184, v54
    v_sub_f32 v185, v185, v54
    v_sub_f32 v186, v186, v54
    v_sub_f32 v187, v187, v54
    v_sub_f32 v188, v188, v55
    v_sub_f32 v189, v189, v55
    v_sub_f32 v190, v190, v55
    v_sub_f32 v191, v191, v55
    v_sub_f32 v128, v128, v52
    v_sub_f32 v16, v16, v52
    v_sub_f32 v129, v129, v52
    v_sub_f32 v17, v17, v52
    v_sub_f32 v130, v130, v52
    v_sub_f32 v18, v18, v52
    v_sub_f32 v131, v131, v52
    v_sub_f32 v19, v19, v52
    v_sub_f32 v132, v132, v53
    v_sub_f32 v20, v20, v53
    v_sub_f32 v133, v133, v53
    v_sub_f32 v21, v21, v53
    v_sub_f32 v134, v134, v53
    v_sub_f32 v22, v22, v53
    v_sub_f32 v135, v135, v53
    v_sub_f32 v23, v23, v53
    v_sub_f32 v136, v136, v54
    v_sub_f32 v24, v24, v54
    v_sub_f32 v137, v137, v54
    v_sub_f32 v25, v25, v54
    v_sub_f32 v138, v138, v54
    v_sub_f32 v26, v26, v54
    v_sub_f32 v139, v139, v54
    v_sub_f32 v27, v27, v54
    v_sub_f32 v140, v140, v55
    v_sub_f32 v28, v28, v55
    v_sub_f32 v141, v141, v55
    v_sub_f32 v29, v29, v55
    v_sub_f32 v142, v142, v55
    v_sub_f32 v30, v30, v55
    v_sub_f32 v143, v143, v55
    v_sub_f32 v31, v31, v55
    v_sub_f32 v144, v144, v52
    v_sub_f32 v32, v32, v52
    v_sub_f32 v145, v145, v52
    v_sub_f32 v33, v33, v52
    v_sub_f32 v146, v146, v52
    v_sub_f32 v34, v34, v52
    v_sub_f32 v147, v147, v52
    v_sub_f32 v35, v35, v52
    v_sub_f32 v148, v148, v53
    v_sub_f32 v36, v36, v53
    v_sub_f32 v149, v149, v53
    v_sub_f32 v37, v37, v53
    v_sub_f32 v150, v150, v53
    v_sub_f32 v38, v38, v53
    v_sub_f32 v151, v151, v53
    v_sub_f32 v39, v39, v53
    v_sub_f32 v152, v152, v54
    v_sub_f32 v40, v40, v54
    v_sub_f32 v153, v153, v54
    v_sub_f32 v41, v41, v54
    v_sub_f32 v154, v154, v54
    v_sub_f32 v42, v42, v54
    v_sub_f32 v155, v155, v54
    v_sub_f32 v43, v43, v54
    v_sub_f32 v156, v156, v55
    v_sub_f32 v44, v44, v55
    v_sub_f32 v157, v157, v55
    v_sub_f32 v45, v45, v55
    v_sub_f32 v158, v158, v55
    v_sub_f32 v46, v46, v55
    v_sub_f32 v159, v159, v55
    v_sub_f32 v47, v47, v55
    v_sub_f32 v8, v8, v52
    v_exp_f32 v52, -v52
    v_sub_f32 v9, v9, v53
    v_exp_f32 v53, -v53
    v_sub_f32 v10, v10, v54
    v_exp_f32 v54, -v54
    v_sub_f32 v11, v11, v55
    v_exp_f32 v55, -v55
    s_nop 0
    v_mul_f32 v12, v12, v52
    v_mul_f32 v48, v48, v53
    v_mul_f32 v248, v248, v54
    v_mul_f32 v252, v252, v55
    v_accvgpr_read_b32 v224, a0
    v_accvgpr_read_b32 v225, a1
    v_accvgpr_read_b32 v226, a2
    v_accvgpr_read_b32 v227, a3
    v_mul_f32 v224, v224, v52
    v_mul_f32 v225, v225, v52
    v_mul_f32 v226, v226, v52
    v_mul_f32 v227, v227, v52
    v_accvgpr_write_b32 a0, v224
    v_accvgpr_write_b32 a1, v225
    v_accvgpr_write_b32 a2, v226
    v_accvgpr_write_b32 a3, v227
    v_accvgpr_read_b32 v224, a4
    v_accvgpr_read_b32 v225, a5
    v_accvgpr_read_b32 v226, a6
    v_accvgpr_read_b32 v227, a7
    v_mul_f32 v224, v224, v53
    v_mul_f32 v225, v225, v53
    v_mul_f32 v226, v226, v53
    v_mul_f32 v227, v227, v53
    v_accvgpr_write_b32 a4, v224
    v_accvgpr_write_b32 a5, v225
    v_accvgpr_write_b32 a6, v226
    v_accvgpr_write_b32 a7, v227
    v_accvgpr_read_b32 v224, a8
    v_accvgpr_read_b32 v225, a9
    v_accvgpr_read_b32 v226, a10
    v_accvgpr_read_b32 v227, a11
    v_mul_f32 v224, v224, v54
    v_mul_f32 v225, v225, v54
    v_mul_f32 v226, v226, v54
    v_mul_f32 v227, v227, v54
    v_accvgpr_write_b32 a8, v224
    v_accvgpr_write_b32 a9, v225
    v_accvgpr_write_b32 a10, v226
    v_accvgpr_write_b32 a11, v227
    v_accvgpr_read_b32 v224, a12
    v_accvgpr_read_b32 v225, a13
    v_accvgpr_read_b32 v226, a14
    v_accvgpr_read_b32 v227, a15
    v_mul_f32 v224, v224, v55
    v_mul_f32 v225, v225, v55
    v_mul_f32 v226, v226, v55
    v_mul_f32 v227, v227, v55
    v_accvgpr_write_b32 a12, v224
    v_accvgpr_write_b32 a13, v225
    v_accvgpr_write_b32 a14, v226
    v_accvgpr_write_b32 a15, v227
    v_accvgpr_read_b32 v224, a16
    v_accvgpr_read_b32 v225, a17
    v_accvgpr_read_b32 v226, a18
    v_accvgpr_read_b32 v227, a19
    v_mul_f32 v224, v224, v52
    v_mul_f32 v225, v225, v52
    v_mul_f32 v226, v226, v52
    v_mul_f32 v227, v227, v52
    v_accvgpr_write_b32 a16, v224
    v_accvgpr_write_b32 a17, v225
    v_accvgpr_write_b32 a18, v226
    v_accvgpr_write_b32 a19, v227
    v_accvgpr_read_b32 v224, a20
    v_accvgpr_read_b32 v225, a21
    v_accvgpr_read_b32 v226, a22
    v_accvgpr_read_b32 v227, a23
    v_mul_f32 v224, v224, v53
    v_mul_f32 v225, v225, v53
    v_mul_f32 v226, v226, v53
    v_mul_f32 v227, v227, v53
    v_accvgpr_write_b32 a20, v224
    v_accvgpr_write_b32 a21, v225
    v_accvgpr_write_b32 a22, v226
    v_accvgpr_write_b32 a23, v227
    v_accvgpr_read_b32 v224, a24
    v_accvgpr_read_b32 v225, a25
    v_accvgpr_read_b32 v226, a26
    v_accvgpr_read_b32 v227, a27
    v_mul_f32 v224, v224, v54
    v_mul_f32 v225, v225, v54
    v_mul_f32 v226, v226, v54
    v_mul_f32 v227, v227, v54
    v_accvgpr_write_b32 a24, v224
    v_accvgpr_write_b32 a25, v225
    v_accvgpr_write_b32 a26, v226
    v_accvgpr_write_b32 a27, v227
    v_accvgpr_read_b32 v224, a28
    v_accvgpr_read_b32 v225, a29
    v_accvgpr_read_b32 v226, a30
    v_accvgpr_read_b32 v227, a31
    v_mul_f32 v224, v224, v55
    v_mul_f32 v225, v225, v55
    v_mul_f32 v226, v226, v55
    v_mul_f32 v227, v227, v55
    v_accvgpr_write_b32 a28, v224
    v_accvgpr_write_b32 a29, v225
    v_accvgpr_write_b32 a30, v226
    v_accvgpr_write_b32 a31, v227
    v_accvgpr_read_b32 v224, a32
    v_accvgpr_read_b32 v225, a33
    v_accvgpr_read_b32 v226, a34
    v_accvgpr_read_b32 v227, a35
    v_mul_f32 v224, v224, v52
    v_mul_f32 v225, v225, v52
    v_mul_f32 v226, v226, v52
    v_mul_f32 v227, v227, v52
    v_accvgpr_write_b32 a32, v224
    v_accvgpr_write_b32 a33, v225
    v_accvgpr_write_b32 a34, v226
    v_accvgpr_write_b32 a35, v227
    v_accvgpr_read_b32 v224, a36
    v_accvgpr_read_b32 v225, a37
    v_accvgpr_read_b32 v226, a38
    v_accvgpr_read_b32 v227, a39
    v_mul_f32 v224, v224, v53
    v_mul_f32 v225, v225, v53
    v_mul_f32 v226, v226, v53
    v_mul_f32 v227, v227, v53
    v_accvgpr_write_b32 a36, v224
    v_accvgpr_write_b32 a37, v225
    v_accvgpr_write_b32 a38, v226
    v_accvgpr_write_b32 a39, v227
    v_accvgpr_read_b32 v224, a40
    v_accvgpr_read_b32 v225, a41
    v_accvgpr_read_b32 v226, a42
    v_accvgpr_read_b32 v227, a43
    v_mul_f32 v224, v224, v54
    v_mul_f32 v225, v225, v54
    v_mul_f32 v226, v226, v54
    v_mul_f32 v227, v227, v54
    v_accvgpr_write_b32 a40, v224
    v_accvgpr_write_b32 a41, v225
    v_accvgpr_write_b32 a42, v226
    v_accvgpr_write_b32 a43, v227
    v_accvgpr_read_b32 v224, a44
    v_accvgpr_read_b32 v225, a45
    v_accvgpr_read_b32 v226, a46
    v_accvgpr_read_b32 v227, a47
    v_mul_f32 v224, v224, v55
    v_mul_f32 v225, v225, v55
    v_mul_f32 v226, v226, v55
    v_mul_f32 v227, v227, v55
    v_accvgpr_write_b32 a44, v224
    v_accvgpr_write_b32 a45, v225
    v_accvgpr_write_b32 a46, v226
    v_accvgpr_write_b32 a47, v227
    v_accvgpr_read_b32 v224, a48
    v_accvgpr_read_b32 v225, a49
    v_accvgpr_read_b32 v226, a50
    v_accvgpr_read_b32 v227, a51
    v_mul_f32 v224, v224, v52
    v_mul_f32 v225, v225, v52
    v_mul_f32 v226, v226, v52
    v_mul_f32 v227, v227, v52
    v_accvgpr_write_b32 a48, v224
    v_accvgpr_write_b32 a49, v225
    v_accvgpr_write_b32 a50, v226
    v_accvgpr_write_b32 a51, v227
    v_accvgpr_read_b32 v224, a52
    v_accvgpr_read_b32 v225, a53
    v_accvgpr_read_b32 v226, a54
    v_accvgpr_read_b32 v227, a55
    v_mul_f32 v224, v224, v53
    v_mul_f32 v225, v225, v53
    v_mul_f32 v226, v226, v53
    v_mul_f32 v227, v227, v53
    v_accvgpr_write_b32 a52, v224
    v_accvgpr_write_b32 a53, v225
    v_accvgpr_write_b32 a54, v226
    v_accvgpr_write_b32 a55, v227
    v_accvgpr_read_b32 v224, a56
    v_accvgpr_read_b32 v225, a57
    v_accvgpr_read_b32 v226, a58
    v_accvgpr_read_b32 v227, a59
    v_mul_f32 v224, v224, v54
    v_mul_f32 v225, v225, v54
    v_mul_f32 v226, v226, v54
    v_mul_f32 v227, v227, v54
    v_accvgpr_write_b32 a56, v224
    v_accvgpr_write_b32 a57, v225
    v_accvgpr_write_b32 a58, v226
    v_accvgpr_write_b32 a59, v227
    v_accvgpr_read_b32 v224, a60
    v_accvgpr_read_b32 v225, a61
    v_accvgpr_read_b32 v226, a62
    v_accvgpr_read_b32 v227, a63
    v_mul_f32 v224, v224, v55
    v_mul_f32 v225, v225, v55
    v_mul_f32 v226, v226, v55
    v_mul_f32 v227, v227, v55
    v_accvgpr_write_b32 a60, v224
    v_accvgpr_write_b32 a61, v225
    v_accvgpr_write_b32 a62, v226
    v_accvgpr_write_b32 a63, v227
    v_accvgpr_read_b32 v224, a64
    v_accvgpr_read_b32 v225, a65
    v_accvgpr_read_b32 v226, a66
    v_accvgpr_read_b32 v227, a67
    v_mul_f32 v224, v224, v52
    v_mul_f32 v225, v225, v52
    v_mul_f32 v226, v226, v52
    v_mul_f32 v227, v227, v52
    v_accvgpr_write_b32 a64, v224
    v_accvgpr_write_b32 a65, v225
    v_accvgpr_write_b32 a66, v226
    v_accvgpr_write_b32 a67, v227
    v_accvgpr_read_b32 v224, a68
    v_accvgpr_read_b32 v225, a69
    v_accvgpr_read_b32 v226, a70
    v_accvgpr_read_b32 v227, a71
    v_mul_f32 v224, v224, v53
    v_mul_f32 v225, v225, v53
    v_mul_f32 v226, v226, v53
    v_mul_f32 v227, v227, v53
    v_accvgpr_write_b32 a68, v224
    v_accvgpr_write_b32 a69, v225
    v_accvgpr_write_b32 a70, v226
    v_accvgpr_write_b32 a71, v227
    v_accvgpr_read_b32 v224, a72
    v_accvgpr_read_b32 v225, a73
    v_accvgpr_read_b32 v226, a74
    v_accvgpr_read_b32 v227, a75
    v_mul_f32 v224, v224, v54
    v_mul_f32 v225, v225, v54
    v_mul_f32 v226, v226, v54
    v_mul_f32 v227, v227, v54
    v_accvgpr_write_b32 a72, v224
    v_accvgpr_write_b32 a73, v225
    v_accvgpr_write_b32 a74, v226
    v_accvgpr_write_b32 a75, v227
    v_accvgpr_read_b32 v224, a76
    v_accvgpr_read_b32 v225, a77
    v_accvgpr_read_b32 v226, a78
    v_accvgpr_read_b32 v227, a79
    v_mul_f32 v224, v224, v55
    v_mul_f32 v225, v225, v55
    v_mul_f32 v226, v226, v55
    v_mul_f32 v227, v227, v55
    v_accvgpr_write_b32 a76, v224
    v_accvgpr_write_b32 a77, v225
    v_accvgpr_write_b32 a78, v226
    v_accvgpr_write_b32 a79, v227
    v_accvgpr_read_b32 v224, a80
    v_accvgpr_read_b32 v225, a81
    v_accvgpr_read_b32 v226, a82
    v_accvgpr_read_b32 v227, a83
    v_mul_f32 v224, v224, v52
    v_mul_f32 v225, v225, v52
    v_mul_f32 v226, v226, v52
    v_mul_f32 v227, v227, v52
    v_accvgpr_write_b32 a80, v224
    v_accvgpr_write_b32 a81, v225
    v_accvgpr_write_b32 a82, v226
    v_accvgpr_write_b32 a83, v227
    v_accvgpr_read_b32 v224, a84
    v_accvgpr_read_b32 v225, a85
    v_accvgpr_read_b32 v226, a86
    v_accvgpr_read_b32 v227, a87
    v_mul_f32 v224, v224, v53
    v_mul_f32 v225, v225, v53
    v_mul_f32 v226, v226, v53
    v_mul_f32 v227, v227, v53
    v_accvgpr_write_b32 a84, v224
    v_accvgpr_write_b32 a85, v225
    v_accvgpr_write_b32 a86, v226
    v_accvgpr_write_b32 a87, v227
    v_accvgpr_read_b32 v224, a88
    v_accvgpr_read_b32 v225, a89
    v_accvgpr_read_b32 v226, a90
    v_accvgpr_read_b32 v227, a91
    v_mul_f32 v224, v224, v54
    v_mul_f32 v225, v225, v54
    v_mul_f32 v226, v226, v54
    v_mul_f32 v227, v227, v54
    v_accvgpr_write_b32 a88, v224
    v_accvgpr_write_b32 a89, v225
    v_accvgpr_write_b32 a90, v226
    v_accvgpr_write_b32 a91, v227
    v_accvgpr_read_b32 v224, a92
    v_accvgpr_read_b32 v225, a93
    v_accvgpr_read_b32 v226, a94
    v_accvgpr_read_b32 v227, a95
    v_mul_f32 v224, v224, v55
    v_mul_f32 v225, v225, v55
    v_mul_f32 v226, v226, v55
    v_mul_f32 v227, v227, v55
    v_accvgpr_write_b32 a92, v224
    v_accvgpr_write_b32 a93, v225
    v_accvgpr_write_b32 a94, v226
    v_accvgpr_write_b32 a95, v227
    v_accvgpr_read_b32 v224, a96
    v_accvgpr_read_b32 v225, a97
    v_accvgpr_read_b32 v226, a98
    v_accvgpr_read_b32 v227, a99
    v_mul_f32 v224, v224, v52
    v_mul_f32 v225, v225, v52
    v_mul_f32 v226, v226, v52
    v_mul_f32 v227, v227, v52
    v_accvgpr_write_b32 a96, v224
    v_accvgpr_write_b32 a97, v225
    v_accvgpr_write_b32 a98, v226
    v_accvgpr_write_b32 a99, v227
    v_accvgpr_read_b32 v224, a100
    v_accvgpr_read_b32 v225, a101
    v_accvgpr_read_b32 v226, a102
    v_accvgpr_read_b32 v227, a103
    v_mul_f32 v224, v224, v53
    v_mul_f32 v225, v225, v53
    v_mul_f32 v226, v226, v53
    v_mul_f32 v227, v227, v53
    v_accvgpr_write_b32 a100, v224
    v_accvgpr_write_b32 a101, v225
    v_accvgpr_write_b32 a102, v226
    v_accvgpr_write_b32 a103, v227
    v_accvgpr_read_b32 v224, a104
    v_accvgpr_read_b32 v225, a105
    v_accvgpr_read_b32 v226, a106
    v_accvgpr_read_b32 v227, a107
    v_mul_f32 v224, v224, v54
    v_mul_f32 v225, v225, v54
    v_mul_f32 v226, v226, v54
    v_mul_f32 v227, v227, v54
    v_accvgpr_write_b32 a104, v224
    v_accvgpr_write_b32 a105, v225
    v_accvgpr_write_b32 a106, v226
    v_accvgpr_write_b32 a107, v227
    v_accvgpr_read_b32 v224, a108
    v_accvgpr_read_b32 v225, a109
    v_accvgpr_read_b32 v226, a110
    v_accvgpr_read_b32 v227, a111
    v_mul_f32 v224, v224, v55
    v_mul_f32 v225, v225, v55
    v_mul_f32 v226, v226, v55
    v_mul_f32 v227, v227, v55
    v_accvgpr_write_b32 a108, v224
    v_accvgpr_write_b32 a109, v225
    v_accvgpr_write_b32 a110, v226
    v_accvgpr_write_b32 a111, v227
    v_accvgpr_read_b32 v224, a112
    v_accvgpr_read_b32 v225, a113
    v_accvgpr_read_b32 v226, a114
    v_accvgpr_read_b32 v227, a115
    v_mul_f32 v224, v224, v52
    v_mul_f32 v225, v225, v52
    v_mul_f32 v226, v226, v52
    v_mul_f32 v227, v227, v52
    v_accvgpr_write_b32 a112, v224
    v_accvgpr_write_b32 a113, v225
    v_accvgpr_write_b32 a114, v226
    v_accvgpr_write_b32 a115, v227
    v_accvgpr_read_b32 v224, a116
    v_accvgpr_read_b32 v225, a117
    v_accvgpr_read_b32 v226, a118
    v_accvgpr_read_b32 v227, a119
    v_mul_f32 v224, v224, v53
    v_mul_f32 v225, v225, v53
    v_mul_f32 v226, v226, v53
    v_mul_f32 v227, v227, v53
    v_accvgpr_write_b32 a116, v224
    v_accvgpr_write_b32 a117, v225
    v_accvgpr_write_b32 a118, v226
    v_accvgpr_write_b32 a119, v227
    v_accvgpr_read_b32 v224, a120
    v_accvgpr_read_b32 v225, a121
    v_accvgpr_read_b32 v226, a122
    v_accvgpr_read_b32 v227, a123
    v_mul_f32 v224, v224, v54
    v_mul_f32 v225, v225, v54
    v_mul_f32 v226, v226, v54
    v_mul_f32 v227, v227, v54
    v_accvgpr_write_b32 a120, v224
    v_accvgpr_write_b32 a121, v225
    v_accvgpr_write_b32 a122, v226
    v_accvgpr_write_b32 a123, v227
    v_accvgpr_read_b32 v224, a124
    v_accvgpr_read_b32 v225, a125
    v_accvgpr_read_b32 v226, a126
    v_accvgpr_read_b32 v227, a127
    v_mul_f32 v224, v224, v55
    v_mul_f32 v225, v225, v55
    v_mul_f32 v226, v226, v55
    v_mul_f32 v227, v227, v55
    v_accvgpr_write_b32 a124, v224
    v_accvgpr_write_b32 a125, v225
    v_accvgpr_write_b32 a126, v226
    v_accvgpr_write_b32 a127, v227
    v_exp_f32 v232, v160
    v_exp_f32 v233, v161
    v_exp_f32 v234, v162
    v_exp_f32 v235, v163
    s_nop 0
    v_cvt_pk_bf16_f32 v208, v232, v233
    v_cvt_pk_bf16_f32 v209, v234, v235
    v_exp_f32 v232, v176
    v_exp_f32 v233, v177
    v_exp_f32 v234, v178
    v_exp_f32 v235, v179
    s_nop 0
    v_cvt_pk_bf16_f32 v210, v232, v233
    v_cvt_pk_bf16_f32 v211, v234, v235
    v_exp_f32 v232, v164
    v_exp_f32 v233, v165
    v_exp_f32 v234, v166
    v_exp_f32 v235, v167
    s_nop 0
    v_cvt_pk_bf16_f32 v212, v232, v233
    v_cvt_pk_bf16_f32 v213, v234, v235
    v_exp_f32 v232, v180
    v_exp_f32 v233, v181
    v_exp_f32 v234, v182
    v_exp_f32 v235, v183
    s_nop 0
    v_cvt_pk_bf16_f32 v214, v232, v233
    v_cvt_pk_bf16_f32 v215, v234, v235
    v_exp_f32 v232, v168
    v_exp_f32 v233, v169
    v_exp_f32 v234, v170
    v_exp_f32 v235, v171
    s_nop 0
    v_cvt_pk_bf16_f32 v216, v232, v233
    v_cvt_pk_bf16_f32 v217, v234, v235
    v_exp_f32 v232, v184
    v_exp_f32 v233, v185
    v_exp_f32 v234, v186
    v_exp_f32 v235, v187
    s_nop 0
    v_cvt_pk_bf16_f32 v218, v232, v233
    v_cvt_pk_bf16_f32 v219, v234, v235
    v_exp_f32 v232, v172
    v_exp_f32 v233, v173
    v_exp_f32 v234, v174
    v_exp_f32 v235, v175
    s_nop 0
    v_cvt_pk_bf16_f32 v220, v232, v233
    v_cvt_pk_bf16_f32 v221, v234, v235
    v_exp_f32 v232, v188
    v_exp_f32 v233, v189
    v_exp_f32 v234, v190
    v_exp_f32 v235, v191
    s_nop 0
    v_cvt_pk_bf16_f32 v222, v232, v233
    v_cvt_pk_bf16_f32 v223, v234, v235
    s_nop 3
    s_setpc_b64 s[40:41]
k2_rare_164:
    s_nop 7
    v_max_f32 v53, v132, v133
    v_max3_f32 v53, v53, v134, v135
    v_max3_f32 v53, v53, v148, v149
    v_max3_f32 v53, v53, v150, v151
    v_max_f32 v54, v136, v137
    v_max3_f32 v54, v54, v138, v139
    v_max3_f32 v54, v54, v152, v153
    v_max3_f32 v54, v54, v154, v155
    v_max_f32 v55, v140, v141
    v_max3_f32 v55, v55, v142, v143
    v_max3_f32 v55, v55, v156, v157
    v_max3_f32 v55, v55, v158, v159
    v_mov_b32 v225, v53
    v_mov_b32 v226, v54
    v_mov_b32 v227, v55
    s_nop 1
    v_permlane16_swap_b32 v53, v225
    v_permlane16_swap_b32 v54, v226
    v_permlane16_swap_b32 v55, v227
    s_nop 1
    v_max_f32 v53, v53, v225
    v_max_f32 v54, v54, v226
    v_max_f32 v55, v55, v227
    v_mov_b32 v225, v53
    v_mov_b32 v226, v54
    v_mov_b32 v227, v55
    s_nop 1
    v_permlane32_swap_b32 v53, v225
    v_permlane32_swap_b32 v54, v226
    v_permlane32_swap_b32 v55, v227
    s_nop 1
    v_max_f32 v53, v53, v225
    v_max_f32 v54, v54, v226
    v_max_f32 v55, v55, v227
    v_add_f32 v53, 0x41400000, v53
    v_max_f32 v53, 0, v53
    v_add_f32 v54, 0x41400000, v54
    v_max_f32 v54, 0, v54
    v_add_f32 v55, 0x41400000, v55
    v_max_f32 v55, 0, v55
    v_sub_f32 v132, v132, v53
    v_sub_f32 v133, v133, v53
    v_sub_f32 v134, v134, v53
    v_sub_f32 v135, v135, v53
    v_sub_f32 v136, v136, v54
    v_sub_f32 v137, v137, v54
    v_sub_f32 v138, v138, v54
    v_sub_f32 v139, v139, v54
    v_sub_f32 v140, v140, v55
    v_sub_f32 v141, v141, v55
    v_sub_f32 v142, v142, v55
    v_sub_f32 v143, v143, v55
    v_sub_f32 v148, v148, v53
    v_sub_f32 v149, v149, v53
    v_sub_f32 v150, v150, v53
    v_sub_f32 v151, v151, v53
    v_sub_f32 v152, v152, v54
    v_sub_f32 v153, v153, v54
    v_sub_f32 v154, v154, v54
    v_sub_f32 v155, v155, v54
    v_sub_f32 v156, v156, v55
    v_sub_f32 v157, v157, v55
    v_sub_f32 v158, v158, v55
    v_sub_f32 v159, v159, v55
    v_sub_f32 v164, v164, v53
    v_sub_f32 v20, v20, v53
    v_sub_f32 v165, v165, v53
    v_sub_f32 v21, v21, v53
    v_sub_f32 v166, v166, v53
    v_sub_f32 v22, v22, v53
    v_sub_f32 v167, v167, v53
    v_sub_f32 v23, v23, v53
    v_sub_f32 v168, v168, v54
    v_sub_f32 v24, v24, v54
    v_sub_f32 v169, v169, v54
    v_sub_f32 v25, v25, v54
    v_sub_f32 v170, v170, v54
    v_sub_f32 v26, v26, v54
    v_sub_f32 v171, v171, v54
    v_sub_f32 v27, v27, v54
    v_sub_f32 v172, v172, v55
    v_sub_f32 v28, v28, v55
    v_sub_f32 v173, v173, v55
    v_sub_f32 v29, v29, v55
    v_sub_f32 v174, v174, v55
    v_sub_f32 v30, v30, v55
    v_sub_f32 v175, v175, v55
    v_sub_f32 v31, v31, v55
    v_sub_f32 v180, v180, v53
    v_sub_f32 v36, v36, v53
    v_sub_f32 v181, v181, v53
    v_sub_f32 v37, v37, v53
    v_sub_f32 v182, v182, v53
    v_sub_f32 v38, v38, v53
    v_sub_f32 v183, v183, v53
    v_sub_f32 v39, v39, v53
    v_sub_f32 v184, v184, v54
    v_sub_f32 v40, v40, v54
    v_sub_f32 v185, v185, v54
    v_sub_f32 v41, v41, v54
    v_sub_f32 v186, v186, v54
    v_sub_f32 v42, v42, v54
    v_sub_f32 v187, v187, v54
    v_sub_f32 v43, v43, v54
    v_sub_f32 v188, v188, v55
    v_sub_f32 v44, v44, v55
    v_sub_f32 v189, v189, v55
    v_sub_f32 v45, v45, v55
    v_sub_f32 v190, v190, v55
    v_sub_f32 v46, v46, v55
    v_sub_f32 v191, v191, v55
    v_sub_f32 v47, v47, v55
    v_sub_f32 v9, v9, v53
    v_exp_f32 v53, -v53
    v_sub_f32 v10, v10, v54
    v_exp_f32 v54, -v54
    v_sub_f32 v11, v11, v55
    v_exp_f32 v55, -v55
    s_nop 0
    v_mul_f32 v48, v48, v53
    v_mul_f32 v248, v248, v54
    v_mul_f32 v252, v252, v55
    v_accvgpr_read_b32 v224, a4
    v_accvgpr_read_b32 v225, a5
    v_accvgpr_read_b32 v226, a6
    v_accvgpr_read_b32 v227, a7
    v_mul_f32 v224, v224, v53
    v_mul_f32 v225, v225, v53
    v_mul_f32 v226, v226, v53
    v_mul_f32 v227, v227, v53
    v_accvgpr_write_b32 a4, v224
    v_accvgpr_write_b32 a5, v225
    v_accvgpr_write_b32 a6, v226
    v_accvgpr_write_b32 a7, v227
    v_accvgpr_read_b32 v224, a8
    v_accvgpr_read_b32 v225, a9
    v_accvgpr_read_b32 v226, a10
    v_accvgpr_read_b32 v227, a11
    v_mul_f32 v224, v224, v54
    v_mul_f32 v225, v225, v54
    v_mul_f32 v226, v226, v54
    v_mul_f32 v227, v227, v54
    v_accvgpr_write_b32 a8, v224
    v_accvgpr_write_b32 a9, v225
    v_accvgpr_write_b32 a10, v226
    v_accvgpr_write_b32 a11, v227
    v_accvgpr_read_b32 v224, a12
    v_accvgpr_read_b32 v225, a13
    v_accvgpr_read_b32 v226, a14
    v_accvgpr_read_b32 v227, a15
    v_mul_f32 v224, v224, v55
    v_mul_f32 v225, v225, v55
    v_mul_f32 v226, v226, v55
    v_mul_f32 v227, v227, v55
    v_accvgpr_write_b32 a12, v224
    v_accvgpr_write_b32 a13, v225
    v_accvgpr_write_b32 a14, v226
    v_accvgpr_write_b32 a15, v227
    v_accvgpr_read_b32 v224, a20
    v_accvgpr_read_b32 v225, a21
    v_accvgpr_read_b32 v226, a22
    v_accvgpr_read_b32 v227, a23
    v_mul_f32 v224, v224, v53
    v_mul_f32 v225, v225, v53
    v_mul_f32 v226, v226, v53
    v_mul_f32 v227, v227, v53
    v_accvgpr_write_b32 a20, v224
    v_accvgpr_write_b32 a21, v225
    v_accvgpr_write_b32 a22, v226
    v_accvgpr_write_b32 a23, v227
    v_accvgpr_read_b32 v224, a24
    v_accvgpr_read_b32 v225, a25
    v_accvgpr_read_b32 v226, a26
    v_accvgpr_read_b32 v227, a27
    v_mul_f32 v224, v224, v54
    v_mul_f32 v225, v225, v54
    v_mul_f32 v226, v226, v54
    v_mul_f32 v227, v227, v54
    v_accvgpr_write_b32 a24, v224
    v_accvgpr_write_b32 a25, v225
    v_accvgpr_write_b32 a26, v226
    v_accvgpr_write_b32 a27, v227
    v_accvgpr_read_b32 v224, a28
    v_accvgpr_read_b32 v225, a29
    v_accvgpr_read_b32 v226, a30
    v_accvgpr_read_b32 v227, a31
    v_mul_f32 v224, v224, v55
    v_mul_f32 v225, v225, v55
    v_mul_f32 v226, v226, v55
    v_mul_f32 v227, v227, v55
    v_accvgpr_write_b32 a28, v224
    v_accvgpr_write_b32 a29, v225
    v_accvgpr_write_b32 a30, v226
    v_accvgpr_write_b32 a31, v227
    v_accvgpr_read_b32 v224, a36
    v_accvgpr_read_b32 v225, a37
    v_accvgpr_read_b32 v226, a38
    v_accvgpr_read_b32 v227, a39
    v_mul_f32 v224, v224, v53
    v_mul_f32 v225, v225, v53
    v_mul_f32 v226, v226, v53
    v_mul_f32 v227, v227, v53
    v_accvgpr_write_b32 a36, v224
    v_accvgpr_write_b32 a37, v225
    v_accvgpr_write_b32 a38, v226
    v_accvgpr_write_b32 a39, v227
    v_accvgpr_read_b32 v224, a40
    v_accvgpr_read_b32 v225, a41
    v_accvgpr_read_b32 v226, a42
    v_accvgpr_read_b32 v227, a43
    v_mul_f32 v224, v224, v54
    v_mul_f32 v225, v225, v54
    v_mul_f32 v226, v226, v54
    v_mul_f32 v227, v227, v54
    v_accvgpr_write_b32 a40, v224
    v_accvgpr_write_b32 a41, v225
    v_accvgpr_write_b32 a42, v226
    v_accvgpr_write_b32 a43, v227
    v_accvgpr_read_b32 v224, a44
    v_accvgpr_read_b32 v225, a45
    v_accvgpr_read_b32 v226, a46
    v_accvgpr_read_b32 v227, a47
    v_mul_f32 v224, v224, v55
    v_mul_f32 v225, v225, v55
    v_mul_f32 v226, v226, v55
    v_mul_f32 v227, v227, v55
    v_accvgpr_write_b32 a44, v224
    v_accvgpr_write_b32 a45, v225
    v_accvgpr_write_b32 a46, v226
    v_accvgpr_write_b32 a47, v227
    v_accvgpr_read_b32 v224, a52
    v_accvgpr_read_b32 v225, a53
    v_accvgpr_read_b32 v226, a54
    v_accvgpr_read_b32 v227, a55
    v_mul_f32 v224, v224, v53
    v_mul_f32 v225, v225, v53
    v_mul_f32 v226, v226, v53
    v_mul_f32 v227, v227, v53
    v_accvgpr_write_b32 a52, v224
    v_accvgpr_write_b32 a53, v225
    v_accvgpr_write_b32 a54, v226
    v_accvgpr_write_b32 a55, v227
    v_accvgpr_read_b32 v224, a56
    v_accvgpr_read_b32 v225, a57
    v_accvgpr_read_b32 v226, a58
    v_accvgpr_read_b32 v227, a59
    v_mul_f32 v224, v224, v54
    v_mul_f32 v225, v225, v54
    v_mul_f32 v226, v226, v54
    v_mul_f32 v227, v227, v54
    v_accvgpr_write_b32 a56, v224
    v_accvgpr_write_b32 a57, v225
    v_accvgpr_write_b32 a58, v226
    v_accvgpr_write_b32 a59, v227
    v_accvgpr_read_b32 v224, a60
    v_accvgpr_read_b32 v225, a61
    v_accvgpr_read_b32 v226, a62
    v_accvgpr_read_b32 v227, a63
    v_mul_f32 v224, v224, v55
    v_mul_f32 v225, v225, v55
    v_mul_f32 v226, v226, v55
    v_mul_f32 v227, v227, v55
    v_accvgpr_write_b32 a60, v224
    v_accvgpr_write_b32 a61, v225
    v_accvgpr_write_b32 a62, v226
    v_accvgpr_write_b32 a63, v227
    v_accvgpr_read_b32 v224, a68
    v_accvgpr_read_b32 v225, a69
    v_accvgpr_read_b32 v226, a70
    v_accvgpr_read_b32 v227, a71
    v_mul_f32 v224, v224, v53
    v_mul_f32 v225, v225, v53
    v_mul_f32 v226, v226, v53
    v_mul_f32 v227, v227, v53
    v_accvgpr_write_b32 a68, v224
    v_accvgpr_write_b32 a69, v225
    v_accvgpr_write_b32 a70, v226
    v_accvgpr_write_b32 a71, v227
    v_accvgpr_read_b32 v224, a72
    v_accvgpr_read_b32 v225, a73
    v_accvgpr_read_b32 v226, a74
    v_accvgpr_read_b32 v227, a75
    v_mul_f32 v224, v224, v54
    v_mul_f32 v225, v225, v54
    v_mul_f32 v226, v226, v54
    v_mul_f32 v227, v227, v54
    v_accvgpr_write_b32 a72, v224
    v_accvgpr_write_b32 a73, v225
    v_accvgpr_write_b32 a74, v226
    v_accvgpr_write_b32 a75, v227
    v_accvgpr_read_b32 v224, a76
    v_accvgpr_read_b32 v225, a77
    v_accvgpr_read_b32 v226, a78
    v_accvgpr_read_b32 v227, a79
    v_mul_f32 v224, v224, v55
    v_mul_f32 v225, v225, v55
    v_mul_f32 v226, v226, v55
    v_mul_f32 v227, v227, v55
    v_accvgpr_write_b32 a76, v224
    v_accvgpr_write_b32 a77, v225
    v_accvgpr_write_b32 a78, v226
    v_accvgpr_write_b32 a79, v227
    v_accvgpr_read_b32 v224, a84
    v_accvgpr_read_b32 v225, a85
    v_accvgpr_read_b32 v226, a86
    v_accvgpr_read_b32 v227, a87
    v_mul_f32 v224, v224, v53
    v_mul_f32 v225, v225, v53
    v_mul_f32 v226, v226, v53
    v_mul_f32 v227, v227, v53
    v_accvgpr_write_b32 a84, v224
    v_accvgpr_write_b32 a85, v225
    v_accvgpr_write_b32 a86, v226
    v_accvgpr_write_b32 a87, v227
    v_accvgpr_read_b32 v224, a88
    v_accvgpr_read_b32 v225, a89
    v_accvgpr_read_b32 v226, a90
    v_accvgpr_read_b32 v227, a91
    v_mul_f32 v224, v224, v54
    v_mul_f32 v225, v225, v54
    v_mul_f32 v226, v226, v54
    v_mul_f32 v227, v227, v54
    v_accvgpr_write_b32 a88, v224
    v_accvgpr_write_b32 a89, v225
    v_accvgpr_write_b32 a90, v226
    v_accvgpr_write_b32 a91, v227
    v_accvgpr_read_b32 v224, a92
    v_accvgpr_read_b32 v225, a93
    v_accvgpr_read_b32 v226, a94
    v_accvgpr_read_b32 v227, a95
    v_mul_f32 v224, v224, v55
    v_mul_f32 v225, v225, v55
    v_mul_f32 v226, v226, v55
    v_mul_f32 v227, v227, v55
    v_accvgpr_write_b32 a92, v224
    v_accvgpr_write_b32 a93, v225
    v_accvgpr_write_b32 a94, v226
    v_accvgpr_write_b32 a95, v227
    v_accvgpr_read_b32 v224, a100
    v_accvgpr_read_b32 v225, a101
    v_accvgpr_read_b32 v226, a102
    v_accvgpr_read_b32 v227, a103
    v_mul_f32 v224, v224, v53
    v_mul_f32 v225, v225, v53
    v_mul_f32 v226, v226, v53
    v_mul_f32 v227, v227, v53
    v_accvgpr_write_b32 a100, v224
    v_accvgpr_write_b32 a101, v225
    v_accvgpr_write_b32 a102, v226
    v_accvgpr_write_b32 a103, v227
    v_accvgpr_read_b32 v224, a104
    v_accvgpr_read_b32 v225, a105
    v_accvgpr_read_b32 v226, a106
    v_accvgpr_read_b32 v227, a107
    v_mul_f32 v224, v224, v54
    v_mul_f32 v225, v225, v54
    v_mul_f32 v226, v226, v54
    v_mul_f32 v227, v227, v54
    v_accvgpr_write_b32 a104, v224
    v_accvgpr_write_b32 a105, v225
    v_accvgpr_write_b32 a106, v226
    v_accvgpr_write_b32 a107, v227
    v_accvgpr_read_b32 v224, a108
    v_accvgpr_read_b32 v225, a109
    v_accvgpr_read_b32 v226, a110
    v_accvgpr_read_b32 v227, a111
    v_mul_f32 v224, v224, v55
    v_mul_f32 v225, v225, v55
    v_mul_f32 v226, v226, v55
    v_mul_f32 v227, v227, v55
    v_accvgpr_write_b32 a108, v224
    v_accvgpr_write_b32 a109, v225
    v_accvgpr_write_b32 a110, v226
    v_accvgpr_write_b32 a111, v227
    v_accvgpr_read_b32 v224, a116
    v_accvgpr_read_b32 v225, a117
    v_accvgpr_read_b32 v226, a118
    v_accvgpr_read_b32 v227, a119
    v_mul_f32 v224, v224, v53
    v_mul_f32 v225, v225, v53
    v_mul_f32 v226, v226, v53
    v_mul_f32 v227, v227, v53
    v_accvgpr_write_b32 a116, v224
    v_accvgpr_write_b32 a117, v225
    v_accvgpr_write_b32 a118, v226
    v_accvgpr_write_b32 a119, v227
    v_accvgpr_read_b32 v224, a120
    v_accvgpr_read_b32 v225, a121
    v_accvgpr_read_b32 v226, a122
    v_accvgpr_read_b32 v227, a123
    v_mul_f32 v224, v224, v54
    v_mul_f32 v225, v225, v54
    v_mul_f32 v226, v226, v54
    v_mul_f32 v227, v227, v54
    v_accvgpr_write_b32 a120, v224
    v_accvgpr_write_b32 a121, v225
    v_accvgpr_write_b32 a122, v226
    v_accvgpr_write_b32 a123, v227
    v_accvgpr_read_b32 v224, a124
    v_accvgpr_read_b32 v225, a125
    v_accvgpr_read_b32 v226, a126
    v_accvgpr_read_b32 v227, a127
    v_mul_f32 v224, v224, v55
    v_mul_f32 v225, v225, v55
    v_mul_f32 v226, v226, v55
    v_mul_f32 v227, v227, v55
    v_accvgpr_write_b32 a124, v224
    v_accvgpr_write_b32 a125, v225
    v_accvgpr_write_b32 a126, v226
    v_accvgpr_write_b32 a127, v227
    v_exp_f32 v232, v132
    v_exp_f32 v233, v133
    v_exp_f32 v234, v134
    v_exp_f32 v235, v135
    s_nop 0
    v_cvt_pk_bf16_f32 v196, v232, v233
    v_cvt_pk_bf16_f32 v197, v234, v235
    v_exp_f32 v232, v148
    v_exp_f32 v233, v149
    v_exp_f32 v234, v150
    v_exp_f32 v235, v151
    s_nop 0
    v_cvt_pk_bf16_f32 v198, v232, v233
    v_cvt_pk_bf16_f32 v199, v234, v235
    v_exp_f32 v232, v136
    v_exp_f32 v233, v137
    v_exp_f32 v234, v138
    v_exp_f32 v235, v139
    s_nop 0
    v_cvt_pk_bf16_f32 v200, v232, v233
    v_cvt_pk_bf16_f32 v201, v234, v235
    v_exp_f32 v232, v152
    v_exp_f32 v233, v153
    v_exp_f32 v234, v154
    v_exp_f32 v235, v155
    s_nop 0
    v_cvt_pk_bf16_f32 v202, v232, v233
    v_cvt_pk_bf16_f32 v203, v234, v235
    v_exp_f32 v232, v140
    v_exp_f32 v233, v141
    v_exp_f32 v234, v142
    v_exp_f32 v235, v143
    s_nop 0
    v_cvt_pk_bf16_f32 v204, v232, v233
    v_cvt_pk_bf16_f32 v205, v234, v235
    v_exp_f32 v232, v156
    v_exp_f32 v233, v157
    v_exp_f32 v234, v158
    v_exp_f32 v235, v159
    s_nop 0
    v_cvt_pk_bf16_f32 v206, v232, v233
    v_cvt_pk_bf16_f32 v207, v234, v235
    s_nop 3
    s_setpc_b64 s[40:41]
k2_rare_165:
    s_nop 7
    v_max_f32 v53, v164, v165
    v_max3_f32 v53, v53, v166, v167
    v_max3_f32 v53, v53, v180, v181
    v_max3_f32 v53, v53, v182, v183
    v_max_f32 v54, v168, v169
    v_max3_f32 v54, v54, v170, v171
    v_max3_f32 v54, v54, v184, v185
    v_max3_f32 v54, v54, v186, v187
    v_max_f32 v55, v172, v173
    v_max3_f32 v55, v55, v174, v175
    v_max3_f32 v55, v55, v188, v189
    v_max3_f32 v55, v55, v190, v191
    v_mov_b32 v225, v53
    v_mov_b32 v226, v54
    v_mov_b32 v227, v55
    s_nop 1
    v_permlane16_swap_b32 v53, v225
    v_permlane16_swap_b32 v54, v226
    v_permlane16_swap_b32 v55, v227
    s_nop 1
    v_max_f32 v53, v53, v225
    v_max_f32 v54, v54, v226
    v_max_f32 v55, v55, v227
    v_mov_b32 v225, v53
    v_mov_b32 v226, v54
    v_mov_b32 v227, v55
    s_nop 1
    v_permlane32_swap_b32 v53, v225
    v_permlane32_swap_b32 v54, v226
    v_permlane32_swap_b32 v55, v227
    s_nop 1
    v_max_f32 v53, v53, v225
    v_max_f32 v54, v54, v226
    v_max_f32 v55, v55, v227
    v_add_f32 v53, 0x41400000, v53
    v_max_f32 v53, 0, v53
    v_add_f32 v54, 0x41400000, v54
    v_max_f32 v54, 0, v54
    v_add_f32 v55, 0x41400000, v55
    v_max_f32 v55, 0, v55
    v_sub_f32 v164, v164, v53
    v_sub_f32 v165, v165, v53
    v_sub_f32 v166, v166, v53
    v_sub_f32 v167, v167, v53
    v_sub_f32 v168, v168, v54
    v_sub_f32 v169, v169, v54
    v_sub_f32 v170, v170, v54
    v_sub_f32 v171, v171, v54
    v_sub_f32 v172, v172, v55
    v_sub_f32 v173, v173, v55
    v_sub_f32 v174, v174, v55
    v_sub_f32 v175, v175, v55
    v_sub_f32 v180, v180, v53
    v_sub_f32 v181, v181, v53
    v_sub_f32 v182, v182, v53
    v_sub_f32 v183, v183, v53
    v_sub_f32 v184, v184, v54
    v_sub_f32 v185, v185, v54
    v_sub_f32 v186, v186, v54
    v_sub_f32 v187, v187, v54
    v_sub_f32 v188, v188, v55
    v_sub_f32 v189, v189, v55
    v_sub_f32 v190, v190, v55
    v_sub_f32 v191, v191, v55
    v_sub_f32 v128, v128, v54
    v_sub_f32 v16, v16, v54
    v_sub_f32 v129, v129, v54
    v_sub_f32 v17, v17, v54
    v_sub_f32 v130, v130, v54
    v_sub_f32 v18, v18, v54
    v_sub_f32 v131, v131, v54
    v_sub_f32 v19, v19, v54
    v_sub_f32 v132, v132, v55
    v_sub_f32 v20, v20, v55
    v_sub_f32 v133, v133, v55
    v_sub_f32 v21, v21, v55
    v_sub_f32 v134, v134, v55
    v_sub_f32 v22, v22, v55
    v_sub_f32 v135, v135, v55
    v_sub_f32 v23, v23, v55
    v_sub_f32 v136, v136, v54
    v_sub_f32 v24, v24, v54
    v_sub_f32 v137, v137, v54
    v_sub_f32 v25, v25, v54
    v_sub_f32 v138, v138, v54
    v_sub_f32 v26, v26, v54
    v_sub_f32 v139, v139, v54
    v_sub_f32 v27, v27, v54
    v_sub_f32 v140, v140, v55
    v_sub_f32 v28, v28, v55
    v_sub_f32 v141, v141, v55
    v_sub_f32 v29, v29, v55
    v_sub_f32 v142, v142, v55
    v_sub_f32 v30, v30, v55
    v_sub_f32 v143, v143, v55
    v_sub_f32 v31, v31, v55
    v_sub_f32 v144, v144, v54
    v_sub_f32 v32, v32, v54
    v_sub_f32 v145, v145, v54
    v_sub_f32 v33, v33, v54
    v_sub_f32 v146, v146, v54
    v_sub_f32 v34, v34, v54
    v_sub_f32 v147, v147, v54
    v_sub_f32 v35, v35, v54
    v_sub_f32 v148, v148, v55
    v_sub_f32 v36, v36, v55
    v_sub_f32 v149, v149, v55
    v_sub_f32 v37, v37, v55
    v_sub_f32 v150, v150, v55
    v_sub_f32 v38, v38, v55
    v_sub_f32 v151, v151, v55
    v_sub_f32 v39, v39, v55
    v_sub_f32 v152, v152, v54
    v_sub_f32 v40, v40, v54
    v_sub_f32 v153, v153, v54
    v_sub_f32 v41, v41, v54
    v_sub_f32 v154, v154, v54
    v_sub_f32 v42, v42, v54
    v_sub_f32 v155, v155, v54
    v_sub_f32 v43, v43, v54
    v_sub_f32 v156, v156, v55
    v_sub_f32 v44, v44, v55
    v_sub_f32 v157, v157, v55
    v_sub_f32 v45, v45, v55
    v_sub_f32 v158, v158, v55
    v_sub_f32 v46, v46, v55
    v_sub_f32 v159, v159, v55
    v_sub_f32 v47, v47, v55
    v_sub_f32 v9, v9, v53
    v_exp_f32 v53, -v53
    v_sub_f32 v10, v10, v54
    v_exp_f32 v54, -v54
    v_sub_f32 v11, v11, v55
    v_exp_f32 v55, -v55
    s_nop 0
    v_mul_f32 v48, v48, v53
    v_mul_f32 v248, v248, v54
    v_mul_f32 v252, v252, v55
    v_accvgpr_read_b32 v224, a4
    v_accvgpr_read_b32 v225, a5
    v_accvgpr_read_b32 v226, a6
    v_accvgpr_read_b32 v227, a7
    v_mul_f32 v224, v224, v53
    v_mul_f32 v225, v225, v53
    v_mul_f32 v226, v226, v53
    v_mul_f32 v227, v227, v53
    v_accvgpr_write_b32 a4, v224
    v_accvgpr_write_b32 a5, v225
    v_accvgpr_write_b32 a6, v226
    v_accvgpr_write_b32 a7, v227
    v_accvgpr_read_b32 v224, a8
    v_accvgpr_read_b32 v225, a9
    v_accvgpr_read_b32 v226, a10
    v_accvgpr_read_b32 v227, a11
    v_mul_f32 v224, v224, v54
    v_mul_f32 v225, v225, v54
    v_mul_f32 v226, v226, v54
    v_mul_f32 v227, v227, v54
    v_accvgpr_write_b32 a8, v224
    v_accvgpr_write_b32 a9, v225
    v_accvgpr_write_b32 a10, v226
    v_accvgpr_write_b32 a11, v227
    v_accvgpr_read_b32 v224, a12
    v_accvgpr_read_b32 v225, a13
    v_accvgpr_read_b32 v226, a14
    v_accvgpr_read_b32 v227, a15
    v_mul_f32 v224, v224, v55
    v_mul_f32 v225, v225, v55
    v_mul_f32 v226, v226, v55
    v_mul_f32 v227, v227, v55
    v_accvgpr_write_b32 a12, v224
    v_accvgpr_write_b32 a13, v225
    v_accvgpr_write_b32 a14, v226
    v_accvgpr_write_b32 a15, v227
    v_accvgpr_read_b32 v224, a20
    v_accvgpr_read_b32 v225, a21
    v_accvgpr_read_b32 v226, a22
    v_accvgpr_read_b32 v227, a23
    v_mul_f32 v224, v224, v53
    v_mul_f32 v225, v225, v53
    v_mul_f32 v226, v226, v53
    v_mul_f32 v227, v227, v53
    v_accvgpr_write_b32 a20, v224
    v_accvgpr_write_b32 a21, v225
    v_accvgpr_write_b32 a22, v226
    v_accvgpr_write_b32 a23, v227
    v_accvgpr_read_b32 v224, a24
    v_accvgpr_read_b32 v225, a25
    v_accvgpr_read_b32 v226, a26
    v_accvgpr_read_b32 v227, a27
    v_mul_f32 v224, v224, v54
    v_mul_f32 v225, v225, v54
    v_mul_f32 v226, v226, v54
    v_mul_f32 v227, v227, v54
    v_accvgpr_write_b32 a24, v224
    v_accvgpr_write_b32 a25, v225
    v_accvgpr_write_b32 a26, v226
    v_accvgpr_write_b32 a27, v227
    v_accvgpr_read_b32 v224, a28
    v_accvgpr_read_b32 v225, a29
    v_accvgpr_read_b32 v226, a30
    v_accvgpr_read_b32 v227, a31
    v_mul_f32 v224, v224, v55
    v_mul_f32 v225, v225, v55
    v_mul_f32 v226, v226, v55
    v_mul_f32 v227, v227, v55
    v_accvgpr_write_b32 a28, v224
    v_accvgpr_write_b32 a29, v225
    v_accvgpr_write_b32 a30, v226
    v_accvgpr_write_b32 a31, v227
    v_accvgpr_read_b32 v224, a36
    v_accvgpr_read_b32 v225, a37
    v_accvgpr_read_b32 v226, a38
    v_accvgpr_read_b32 v227, a39
    v_mul_f32 v224, v224, v53
    v_mul_f32 v225, v225, v53
    v_mul_f32 v226, v226, v53
    v_mul_f32 v227, v227, v53
    v_accvgpr_write_b32 a36, v224
    v_accvgpr_write_b32 a37, v225
    v_accvgpr_write_b32 a38, v226
    v_accvgpr_write_b32 a39, v227
    v_accvgpr_read_b32 v224, a40
    v_accvgpr_read_b32 v225, a41
    v_accvgpr_read_b32 v226, a42
    v_accvgpr_read_b32 v227, a43
    v_mul_f32 v224, v224, v54
    v_mul_f32 v225, v225, v54
    v_mul_f32 v226, v226, v54
    v_mul_f32 v227, v227, v54
    v_accvgpr_write_b32 a40, v224
    v_accvgpr_write_b32 a41, v225
    v_accvgpr_write_b32 a42, v226
    v_accvgpr_write_b32 a43, v227
    v_accvgpr_read_b32 v224, a44
    v_accvgpr_read_b32 v225, a45
    v_accvgpr_read_b32 v226, a46
    v_accvgpr_read_b32 v227, a47
    v_mul_f32 v224, v224, v55
    v_mul_f32 v225, v225, v55
    v_mul_f32 v226, v226, v55
    v_mul_f32 v227, v227, v55
    v_accvgpr_write_b32 a44, v224
    v_accvgpr_write_b32 a45, v225
    v_accvgpr_write_b32 a46, v226
    v_accvgpr_write_b32 a47, v227
    v_accvgpr_read_b32 v224, a52
    v_accvgpr_read_b32 v225, a53
    v_accvgpr_read_b32 v226, a54
    v_accvgpr_read_b32 v227, a55
    v_mul_f32 v224, v224, v53
    v_mul_f32 v225, v225, v53
    v_mul_f32 v226, v226, v53
    v_mul_f32 v227, v227, v53
    v_accvgpr_write_b32 a52, v224
    v_accvgpr_write_b32 a53, v225
    v_accvgpr_write_b32 a54, v226
    v_accvgpr_write_b32 a55, v227
    v_accvgpr_read_b32 v224, a56
    v_accvgpr_read_b32 v225, a57
    v_accvgpr_read_b32 v226, a58
    v_accvgpr_read_b32 v227, a59
    v_mul_f32 v224, v224, v54
    v_mul_f32 v225, v225, v54
    v_mul_f32 v226, v226, v54
    v_mul_f32 v227, v227, v54
    v_accvgpr_write_b32 a56, v224
    v_accvgpr_write_b32 a57, v225
    v_accvgpr_write_b32 a58, v226
    v_accvgpr_write_b32 a59, v227
    v_accvgpr_read_b32 v224, a60
    v_accvgpr_read_b32 v225, a61
    v_accvgpr_read_b32 v226, a62
    v_accvgpr_read_b32 v227, a63
    v_mul_f32 v224, v224, v55
    v_mul_f32 v225, v225, v55
    v_mul_f32 v226, v226, v55
    v_mul_f32 v227, v227, v55
    v_accvgpr_write_b32 a60, v224
    v_accvgpr_write_b32 a61, v225
    v_accvgpr_write_b32 a62, v226
    v_accvgpr_write_b32 a63, v227
    v_accvgpr_read_b32 v224, a68
    v_accvgpr_read_b32 v225, a69
    v_accvgpr_read_b32 v226, a70
    v_accvgpr_read_b32 v227, a71
    v_mul_f32 v224, v224, v53
    v_mul_f32 v225, v225, v53
    v_mul_f32 v226, v226, v53
    v_mul_f32 v227, v227, v53
    v_accvgpr_write_b32 a68, v224
    v_accvgpr_write_b32 a69, v225
    v_accvgpr_write_b32 a70, v226
    v_accvgpr_write_b32 a71, v227
    v_accvgpr_read_b32 v224, a72
    v_accvgpr_read_b32 v225, a73
    v_accvgpr_read_b32 v226, a74
    v_accvgpr_read_b32 v227, a75
    v_mul_f32 v224, v224, v54
    v_mul_f32 v225, v225, v54
    v_mul_f32 v226, v226, v54
    v_mul_f32 v227, v227, v54
    v_accvgpr_write_b32 a72, v224
    v_accvgpr_write_b32 a73, v225
    v_accvgpr_write_b32 a74, v226
    v_accvgpr_write_b32 a75, v227
    v_accvgpr_read_b32 v224, a76
    v_accvgpr_read_b32 v225, a77
    v_accvgpr_read_b32 v226, a78
    v_accvgpr_read_b32 v227, a79
    v_mul_f32 v224, v224, v55
    v_mul_f32 v225, v225, v55
    v_mul_f32 v226, v226, v55
    v_mul_f32 v227, v227, v55
    v_accvgpr_write_b32 a76, v224
    v_accvgpr_write_b32 a77, v225
    v_accvgpr_write_b32 a78, v226
    v_accvgpr_write_b32 a79, v227
    v_accvgpr_read_b32 v224, a84
    v_accvgpr_read_b32 v225, a85
    v_accvgpr_read_b32 v226, a86
    v_accvgpr_read_b32 v227, a87
    v_mul_f32 v224, v224, v53
    v_mul_f32 v225, v225, v53
    v_mul_f32 v226, v226, v53
    v_mul_f32 v227, v227, v53
    v_accvgpr_write_b32 a84, v224
    v_accvgpr_write_b32 a85, v225
    v_accvgpr_write_b32 a86, v226
    v_accvgpr_write_b32 a87, v227
    v_accvgpr_read_b32 v224, a88
    v_accvgpr_read_b32 v225, a89
    v_accvgpr_read_b32 v226, a90
    v_accvgpr_read_b32 v227, a91
    v_mul_f32 v224, v224, v54
    v_mul_f32 v225, v225, v54
    v_mul_f32 v226, v226, v54
    v_mul_f32 v227, v227, v54
    v_accvgpr_write_b32 a88, v224
    v_accvgpr_write_b32 a89, v225
    v_accvgpr_write_b32 a90, v226
    v_accvgpr_write_b32 a91, v227
    v_accvgpr_read_b32 v224, a92
    v_accvgpr_read_b32 v225, a93
    v_accvgpr_read_b32 v226, a94
    v_accvgpr_read_b32 v227, a95
    v_mul_f32 v224, v224, v55
    v_mul_f32 v225, v225, v55
    v_mul_f32 v226, v226, v55
    v_mul_f32 v227, v227, v55
    v_accvgpr_write_b32 a92, v224
    v_accvgpr_write_b32 a93, v225
    v_accvgpr_write_b32 a94, v226
    v_accvgpr_write_b32 a95, v227
    v_accvgpr_read_b32 v224, a100
    v_accvgpr_read_b32 v225, a101
    v_accvgpr_read_b32 v226, a102
    v_accvgpr_read_b32 v227, a103
    v_mul_f32 v224, v224, v53
    v_mul_f32 v225, v225, v53
    v_mul_f32 v226, v226, v53
    v_mul_f32 v227, v227, v53
    v_accvgpr_write_b32 a100, v224
    v_accvgpr_write_b32 a101, v225
    v_accvgpr_write_b32 a102, v226
    v_accvgpr_write_b32 a103, v227
    v_accvgpr_read_b32 v224, a104
    v_accvgpr_read_b32 v225, a105
    v_accvgpr_read_b32 v226, a106
    v_accvgpr_read_b32 v227, a107
    v_mul_f32 v224, v224, v54
    v_mul_f32 v225, v225, v54
    v_mul_f32 v226, v226, v54
    v_mul_f32 v227, v227, v54
    v_accvgpr_write_b32 a104, v224
    v_accvgpr_write_b32 a105, v225
    v_accvgpr_write_b32 a106, v226
    v_accvgpr_write_b32 a107, v227
    v_accvgpr_read_b32 v224, a108
    v_accvgpr_read_b32 v225, a109
    v_accvgpr_read_b32 v226, a110
    v_accvgpr_read_b32 v227, a111
    v_mul_f32 v224, v224, v55
    v_mul_f32 v225, v225, v55
    v_mul_f32 v226, v226, v55
    v_mul_f32 v227, v227, v55
    v_accvgpr_write_b32 a108, v224
    v_accvgpr_write_b32 a109, v225
    v_accvgpr_write_b32 a110, v226
    v_accvgpr_write_b32 a111, v227
    v_accvgpr_read_b32 v224, a116
    v_accvgpr_read_b32 v225, a117
    v_accvgpr_read_b32 v226, a118
    v_accvgpr_read_b32 v227, a119
    v_mul_f32 v224, v224, v53
    v_mul_f32 v225, v225, v53
    v_mul_f32 v226, v226, v53
    v_mul_f32 v227, v227, v53
    v_accvgpr_write_b32 a116, v224
    v_accvgpr_write_b32 a117, v225
    v_accvgpr_write_b32 a118, v226
    v_accvgpr_write_b32 a119, v227
    v_accvgpr_read_b32 v224, a120
    v_accvgpr_read_b32 v225, a121
    v_accvgpr_read_b32 v226, a122
    v_accvgpr_read_b32 v227, a123
    v_mul_f32 v224, v224, v54
    v_mul_f32 v225, v225, v54
    v_mul_f32 v226, v226, v54
    v_mul_f32 v227, v227, v54
    v_accvgpr_write_b32 a120, v224
    v_accvgpr_write_b32 a121, v225
    v_accvgpr_write_b32 a122, v226
    v_accvgpr_write_b32 a123, v227
    v_accvgpr_read_b32 v224, a124
    v_accvgpr_read_b32 v225, a125
    v_accvgpr_read_b32 v226, a126
    v_accvgpr_read_b32 v227, a127
    v_mul_f32 v224, v224, v55
    v_mul_f32 v225, v225, v55
    v_mul_f32 v226, v226, v55
    v_mul_f32 v227, v227, v55
    v_accvgpr_write_b32 a124, v224
    v_accvgpr_write_b32 a125, v225
    v_accvgpr_write_b32 a126, v226
    v_accvgpr_write_b32 a127, v227
    v_exp_f32 v232, v164
    v_exp_f32 v233, v165
    v_exp_f32 v234, v166
    v_exp_f32 v235, v167
    s_nop 0
    v_cvt_pk_bf16_f32 v212, v232, v233
    v_cvt_pk_bf16_f32 v213, v234, v235
    v_exp_f32 v232, v180
    v_exp_f32 v233, v181
    v_exp_f32 v234, v182
    v_exp_f32 v235, v183
    s_nop 0
    v_cvt_pk_bf16_f32 v214, v232, v233
    v_cvt_pk_bf16_f32 v215, v234, v235
    v_exp_f32 v232, v168
    v_exp_f32 v233, v169
    v_exp_f32 v234, v170
    v_exp_f32 v235, v171
    s_nop 0
    v_cvt_pk_bf16_f32 v216, v232, v233
    v_cvt_pk_bf16_f32 v217, v234, v235
    v_exp_f32 v232, v184
    v_exp_f32 v233, v185
    v_exp_f32 v234, v186
    v_exp_f32 v235, v187
    s_nop 0
    v_cvt_pk_bf16_f32 v218, v232, v233
    v_cvt_pk_bf16_f32 v219, v234, v235
    v_exp_f32 v232, v172
    v_exp_f32 v233, v173
    v_exp_f32 v234, v174
    v_exp_f32 v235, v175
    s_nop 0
    v_cvt_pk_bf16_f32 v220, v232, v233
    v_cvt_pk_bf16_f32 v221, v234, v235
    v_exp_f32 v232, v188
    v_exp_f32 v233, v189
    v_exp_f32 v234, v190
    v_exp_f32 v235, v191
    s_nop 0
    v_cvt_pk_bf16_f32 v222, v232, v233
    v_cvt_pk_bf16_f32 v223, v234, v235
    s_nop 3
    s_setpc_b64 s[40:41]
k2_rare_166:
    s_nop 7
    v_max_f32 v54, v128, v129
    v_max3_f32 v54, v54, v130, v131
    v_max3_f32 v54, v54, v144, v145
    v_max3_f32 v54, v54, v146, v147
    v_max3_f32 v54, v54, v136, v137
    v_max3_f32 v54, v54, v138, v139
    v_max3_f32 v54, v54, v152, v153
    v_max3_f32 v54, v54, v154, v155
    v_max_f32 v55, v132, v133
    v_max3_f32 v55, v55, v134, v135
    v_max3_f32 v55, v55, v148, v149
    v_max3_f32 v55, v55, v150, v151
    v_max3_f32 v55, v55, v140, v141
    v_max3_f32 v55, v55, v142, v143
    v_max3_f32 v55, v55, v156, v157
    v_max3_f32 v55, v55, v158, v159
    v_mov_b32 v226, v54
    v_mov_b32 v227, v55
    s_nop 1
    v_permlane16_swap_b32 v54, v226
    v_permlane16_swap_b32 v55, v227
    s_nop 1
    v_max_f32 v54, v54, v226
    v_max_f32 v55, v55, v227
    v_mov_b32 v226, v54
    v_mov_b32 v227, v55
    s_nop 1
    v_permlane32_swap_b32 v54, v226
    v_permlane32_swap_b32 v55, v227
    s_nop 1
    v_max_f32 v54, v54, v226
    v_max_f32 v55, v55, v227
    v_add_f32 v54, 0x41400000, v54
    v_max_f32 v54, 0, v54
    v_add_f32 v55, 0x41400000, v55
    v_max_f32 v55, 0, v55
    v_sub_f32 v128, v128, v54
    v_sub_f32 v129, v129, v54
    v_sub_f32 v130, v130, v54
    v_sub_f32 v131, v131, v54
    v_sub_f32 v132, v132, v55
    v_sub_f32 v133, v133, v55
    v_sub_f32 v134, v134, v55
    v_sub_f32 v135, v135, v55
    v_sub_f32 v136, v136, v54
    v_sub_f32 v137, v137, v54
    v_sub_f32 v138, v138, v54
    v_sub_f32 v139, v139, v54
    v_sub_f32 v140, v140, v55
    v_sub_f32 v141, v141, v55
    v_sub_f32 v142, v142, v55
    v_sub_f32 v143, v143, v55
    v_sub_f32 v144, v144, v54
    v_sub_f32 v145, v145, v54
    v_sub_f32 v146, v146, v54
    v_sub_f32 v147, v147, v54
    v_sub_f32 v148, v148, v55
    v_sub_f32 v149, v149, v55
    v_sub_f32 v150, v150, v55
    v_sub_f32 v151, v151, v55
    v_sub_f32 v152, v152, v54
    v_sub_f32 v153, v153, v54
    v_sub_f32 v154, v154, v54
    v_sub_f32 v155, v155, v54
    v_sub_f32 v156, v156, v55
    v_sub_f32 v157, v157, v55
    v_sub_f32 v158, v158, v55
    v_sub_f32 v159, v159, v55
    v_sub_f32 v160, v160, v54
    v_sub_f32 v16, v16, v54
    v_sub_f32 v161, v161, v54
    v_sub_f32 v17, v17, v54
    v_sub_f32 v162, v162, v54
    v_sub_f32 v18, v18, v54
    v_sub_f32 v163, v163, v54
    v_sub_f32 v19, v19, v54
    v_sub_f32 v164, v164, v55
    v_sub_f32 v20, v20, v55
    v_sub_f32 v165, v165, v55
    v_sub_f32 v21, v21, v55
    v_sub_f32 v166, v166, v55
    v_sub_f32 v22, v22, v55
    v_sub_f32 v167, v167, v55
    v_sub_f32 v23, v23, v55
    v_sub_f32 v168, v168, v54
    v_sub_f32 v24, v24, v54
    v_sub_f32 v169, v169, v54
    v_sub_f32 v25, v25, v54
    v_sub_f32 v170, v170, v54
    v_sub_f32 v26, v26, v54
    v_sub_f32 v171, v171, v54
    v_sub_f32 v27, v27, v54
    v_sub_f32 v172, v172, v55
    v_sub_f32 v28, v28, v55
    v_sub_f32 v173, v173, v55
    v_sub_f32 v29, v29, v55
    v_sub_f32 v174, v174, v55
    v_sub_f32 v30, v30, v55
    v_sub_f32 v175, v175, v55
    v_sub_f32 v31, v31, v55
    v_sub_f32 v176, v176, v54
    v_sub_f32 v32, v32, v54
    v_sub_f32 v177, v177, v54
    v_sub_f32 v33, v33, v54
    v_sub_f32 v178, v178, v54
    v_sub_f32 v34, v34, v54
    v_sub_f32 v179, v179, v54
    v_sub_f32 v35, v35, v54
    v_sub_f32 v180, v180, v55
    v_sub_f32 v36, v36, v55
    v_sub_f32 v181, v181, v55
    v_sub_f32 v37, v37, v55
    v_sub_f32 v182, v182, v55
    v_sub_f32 v38, v38, v55
    v_sub_f32 v183, v183, v55
    v_sub_f32 v39, v39, v55
    v_sub_f32 v184, v184, v54
    v_sub_f32 v40, v40, v54
    v_sub_f32 v185, v185, v54
    v_sub_f32 v41, v41, v54
    v_sub_f32 v186, v186, v54
    v_sub_f32 v42, v42, v54
    v_sub_f32 v187, v187, v54
    v_sub_f32 v43, v43, v54
    v_sub_f32 v188, v188, v55
    v_sub_f32 v44, v44, v55
    v_sub_f32 v189, v189, v55
    v_sub_f32 v45, v45, v55
    v_sub_f32 v190, v190, v55
    v_sub_f32 v46, v46, v55
    v_sub_f32 v191, v191, v55
    v_sub_f32 v47, v47, v55
    v_sub_f32 v10, v10, v54
    v_exp_f32 v54, -v54
    v_sub_f32 v11, v11, v55
    v_exp_f32 v55, -v55
    s_nop 0
    v_mul_f32 v248, v248, v54
    v_mul_f32 v252, v252, v55
    v_accvgpr_read_b32 v224, a8
    v_accvgpr_read_b32 v225, a9
    v_accvgpr_read_b32 v226, a10
    v_accvgpr_read_b32 v227, a11
    v_mul_f32 v224, v224, v54
    v_mul_f32 v225, v225, v54
    v_mul_f32 v226, v226, v54
    v_mul_f32 v227, v227, v54
    v_accvgpr_write_b32 a8, v224
    v_accvgpr_write_b32 a9, v225
    v_accvgpr_write_b32 a10, v226
    v_accvgpr_write_b32 a11, v227
    v_accvgpr_read_b32 v224, a12
    v_accvgpr_read_b32 v225, a13
    v_accvgpr_read_b32 v226, a14
    v_accvgpr_read_b32 v227, a15
    v_mul_f32 v224, v224, v55
    v_mul_f32 v225, v225, v55
    v_mul_f32 v226, v226, v55
    v_mul_f32 v227, v227, v55
    v_accvgpr_write_b32 a12, v224
    v_accvgpr_write_b32 a13, v225
    v_accvgpr_write_b32 a14, v226
    v_accvgpr_write_b32 a15, v227
    v_accvgpr_read_b32 v224, a24
    v_accvgpr_read_b32 v225, a25
    v_accvgpr_read_b32 v226, a26
    v_accvgpr_read_b32 v227, a27
    v_mul_f32 v224, v224, v54
    v_mul_f32 v225, v225, v54
    v_mul_f32 v226, v226, v54
    v_mul_f32 v227, v227, v54
    v_accvgpr_write_b32 a24, v224
    v_accvgpr_write_b32 a25, v225
    v_accvgpr_write_b32 a26, v226
    v_accvgpr_write_b32 a27, v227
    v_accvgpr_read_b32 v224, a28
    v_accvgpr_read_b32 v225, a29
    v_accvgpr_read_b32 v226, a30
    v_accvgpr_read_b32 v227, a31
    v_mul_f32 v224, v224, v55
    v_mul_f32 v225, v225, v55
    v_mul_f32 v226, v226, v55
    v_mul_f32 v227, v227, v55
    v_accvgpr_write_b32 a28, v224
    v_accvgpr_write_b32 a29, v225
    v_accvgpr_write_b32 a30, v226
    v_accvgpr_write_b32 a31, v227
    v_accvgpr_read_b32 v224, a40
    v_accvgpr_read_b32 v225, a41
    v_accvgpr_read_b32 v226, a42
    v_accvgpr_read_b32 v227, a43
    v_mul_f32 v224, v224, v54
    v_mul_f32 v225, v225, v54
    v_mul_f32 v226, v226, v54
    v_mul_f32 v227, v227, v54
    v_accvgpr_write_b32 a40, v224
    v_accvgpr_write_b32 a41, v225
    v_accvgpr_write_b32 a42, v226
    v_accvgpr_write_b32 a43, v227
    v_accvgpr_read_b32 v224, a44
    v_accvgpr_read_b32 v225, a45
    v_accvgpr_read_b32 v226, a46
    v_accvgpr_read_b32 v227, a47
    v_mul_f32 v224, v224, v55
    v_mul_f32 v225, v225, v55
    v_mul_f32 v226, v226, v55
    v_mul_f32 v227, v227, v55
    v_accvgpr_write_b32 a44, v224
    v_accvgpr_write_b32 a45, v225
    v_accvgpr_write_b32 a46, v226
    v_accvgpr_write_b32 a47, v227
    v_accvgpr_read_b32 v224, a56
    v_accvgpr_read_b32 v225, a57
    v_accvgpr_read_b32 v226, a58
    v_accvgpr_read_b32 v227, a59
    v_mul_f32 v224, v224, v54
    v_mul_f32 v225, v225, v54
    v_mul_f32 v226, v226, v54
    v_mul_f32 v227, v227, v54
    v_accvgpr_write_b32 a56, v224
    v_accvgpr_write_b32 a57, v225
    v_accvgpr_write_b32 a58, v226
    v_accvgpr_write_b32 a59, v227
    v_accvgpr_read_b32 v224, a60
    v_accvgpr_read_b32 v225, a61
    v_accvgpr_read_b32 v226, a62
    v_accvgpr_read_b32 v227, a63
    v_mul_f32 v224, v224, v55
    v_mul_f32 v225, v225, v55
    v_mul_f32 v226, v226, v55
    v_mul_f32 v227, v227, v55
    v_accvgpr_write_b32 a60, v224
    v_accvgpr_write_b32 a61, v225
    v_accvgpr_write_b32 a62, v226
    v_accvgpr_write_b32 a63, v227
    v_accvgpr_read_b32 v224, a72
    v_accvgpr_read_b32 v225, a73
    v_accvgpr_read_b32 v226, a74
    v_accvgpr_read_b32 v227, a75
    v_mul_f32 v224, v224, v54
    v_mul_f32 v225, v225, v54
    v_mul_f32 v226, v226, v54
    v_mul_f32 v227, v227, v54
    v_accvgpr_write_b32 a72, v224
    v_accvgpr_write_b32 a73, v225
    v_accvgpr_write_b32 a74, v226
    v_accvgpr_write_b32 a75, v227
    v_accvgpr_read_b32 v224, a76
    v_accvgpr_read_b32 v225, a77
    v_accvgpr_read_b32 v226, a78
    v_accvgpr_read_b32 v227, a79
    v_mul_f32 v224, v224, v55
    v_mul_f32 v225, v225, v55
    v_mul_f32 v226, v226, v55
    v_mul_f32 v227, v227, v55
    v_accvgpr_write_b32 a76, v224
    v_accvgpr_write_b32 a77, v225
    v_accvgpr_write_b32 a78, v226
    v_accvgpr_write_b32 a79, v227
    v_accvgpr_read_b32 v224, a88
    v_accvgpr_read_b32 v225, a89
    v_accvgpr_read_b32 v226, a90
    v_accvgpr_read_b32 v227, a91
    v_mul_f32 v224, v224, v54
    v_mul_f32 v225, v225, v54
    v_mul_f32 v226, v226, v54
    v_mul_f32 v227, v227, v54
    v_accvgpr_write_b32 a88, v224
    v_accvgpr_write_b32 a89, v225
    v_accvgpr_write_b32 a90, v226
    v_accvgpr_write_b32 a91, v227
    v_accvgpr_read_b32 v224, a92
    v_accvgpr_read_b32 v225, a93
    v_accvgpr_read_b32 v226, a94
    v_accvgpr_read_b32 v227, a95
    v_mul_f32 v224, v224, v55
    v_mul_f32 v225, v225, v55
    v_mul_f32 v226, v226, v55
    v_mul_f32 v227, v227, v55
    v_accvgpr_write_b32 a92, v224
    v_accvgpr_write_b32 a93, v225
    v_accvgpr_write_b32 a94, v226
    v_accvgpr_write_b32 a95, v227
    v_accvgpr_read_b32 v224, a104
    v_accvgpr_read_b32 v225, a105
    v_accvgpr_read_b32 v226, a106
    v_accvgpr_read_b32 v227, a107
    v_mul_f32 v224, v224, v54
    v_mul_f32 v225, v225, v54
    v_mul_f32 v226, v226, v54
    v_mul_f32 v227, v227, v54
    v_accvgpr_write_b32 a104, v224
    v_accvgpr_write_b32 a105, v225
    v_accvgpr_write_b32 a106, v226
    v_accvgpr_write_b32 a107, v227
    v_accvgpr_read_b32 v224, a108
    v_accvgpr_read_b32 v225, a109
    v_accvgpr_read_b32 v226, a110
    v_accvgpr_read_b32 v227, a111
    v_mul_f32 v224, v224, v55
    v_mul_f32 v225, v225, v55
    v_mul_f32 v226, v226, v55
    v_mul_f32 v227, v227, v55
    v_accvgpr_write_b32 a108, v224
    v_accvgpr_write_b32 a109, v225
    v_accvgpr_write_b32 a110, v226
    v_accvgpr_write_b32 a111, v227
    v_accvgpr_read_b32 v224, a120
    v_accvgpr_read_b32 v225, a121
    v_accvgpr_read_b32 v226, a122
    v_accvgpr_read_b32 v227, a123
    v_mul_f32 v224, v224, v54
    v_mul_f32 v225, v225, v54
    v_mul_f32 v226, v226, v54
    v_mul_f32 v227, v227, v54
    v_accvgpr_write_b32 a120, v224
    v_accvgpr_write_b32 a121, v225
    v_accvgpr_write_b32 a122, v226
    v_accvgpr_write_b32 a123, v227
    v_accvgpr_read_b32 v224, a124
    v_accvgpr_read_b32 v225, a125
    v_accvgpr_read_b32 v226, a126
    v_accvgpr_read_b32 v227, a127
    v_mul_f32 v224, v224, v55
    v_mul_f32 v225, v225, v55
    v_mul_f32 v226, v226, v55
    v_mul_f32 v227, v227, v55
    v_accvgpr_write_b32 a124, v224
    v_accvgpr_write_b32 a125, v225
    v_accvgpr_write_b32 a126, v226
    v_accvgpr_write_b32 a127, v227
    v_exp_f32 v232, v128
    v_exp_f32 v233, v129
    v_exp_f32 v234, v130
    v_exp_f32 v235, v131
    s_nop 0
    v_cvt_pk_bf16_f32 v192, v232, v233
    v_cvt_pk_bf16_f32 v193, v234, v235
    v_exp_f32 v232, v144
    v_exp_f32 v233, v145
    v_exp_f32 v234, v146
    v_exp_f32 v235, v147
    s_nop 0
    v_cvt_pk_bf16_f32 v194, v232, v233
    v_cvt_pk_bf16_f32 v195, v234, v235
    v_exp_f32 v232, v132
    v_exp_f32 v233, v133
    v_exp_f32 v234, v134
    v_exp_f32 v235, v135
    s_nop 0
    v_cvt_pk_bf16_f32 v196, v232, v233
    v_cvt_pk_bf16_f32 v197, v234, v235
    v_exp_f32 v232, v148
    v_exp_f32 v233, v149
    v_exp_f32 v234, v150
    v_exp_f32 v235, v151
    s_nop 0
    v_cvt_pk_bf16_f32 v198, v232, v233
    v_cvt_pk_bf16_f32 v199, v234, v235
    v_exp_f32 v232, v136
    v_exp_f32 v233, v137
    v_exp_f32 v234, v138
    v_exp_f32 v235, v139
    s_nop 0
    v_cvt_pk_bf16_f32 v200, v232, v233
    v_cvt_pk_bf16_f32 v201, v234, v235
    v_exp_f32 v232, v152
    v_exp_f32 v233, v153
    v_exp_f32 v234, v154
    v_exp_f32 v235, v155
    s_nop 0
    v_cvt_pk_bf16_f32 v202, v232, v233
    v_cvt_pk_bf16_f32 v203, v234, v235
    v_exp_f32 v232, v140
    v_exp_f32 v233, v141
    v_exp_f32 v234, v142
    v_exp_f32 v235, v143
    s_nop 0
    v_cvt_pk_bf16_f32 v204, v232, v233
    v_cvt_pk_bf16_f32 v205, v234, v235
    v_exp_f32 v232, v156
    v_exp_f32 v233, v157
    v_exp_f32 v234, v158
    v_exp_f32 v235, v159
    s_nop 0
    v_cvt_pk_bf16_f32 v206, v232, v233
    v_cvt_pk_bf16_f32 v207, v234, v235
    s_nop 3
    s_setpc_b64 s[40:41]
k2_rare_167:
    s_nop 7
    v_max_f32 v54, v160, v161
    v_max3_f32 v54, v54, v162, v163
    v_max3_f32 v54, v54, v176, v177
    v_max3_f32 v54, v54, v178, v179
    v_max3_f32 v54, v54, v168, v169
    v_max3_f32 v54, v54, v170, v171
    v_max3_f32 v54, v54, v184, v185
    v_max3_f32 v54, v54, v186, v187
    v_max_f32 v55, v164, v165
    v_max3_f32 v55, v55, v166, v167
    v_max3_f32 v55, v55, v180, v181
    v_max3_f32 v55, v55, v182, v183
    v_max3_f32 v55, v55, v172, v173
    v_max3_f32 v55, v55, v174, v175
    v_max3_f32 v55, v55, v188, v189
    v_max3_f32 v55, v55, v190, v191
    v_mov_b32 v226, v54
    v_mov_b32 v227, v55
    s_nop 1
    v_permlane16_swap_b32 v54, v226
    v_permlane16_swap_b32 v55, v227
    s_nop 1
    v_max_f32 v54, v54, v226
    v_max_f32 v55, v55, v227
    v_mov_b32 v226, v54
    v_mov_b32 v227, v55
    s_nop 1
    v_permlane32_swap_b32 v54, v226
    v_permlane32_swap_b32 v55, v227
    s_nop 1
    v_max_f32 v54, v54, v226
    v_max_f32 v55, v55, v227
    v_add_f32 v54, 0x41400000, v54
    v_max_f32 v54, 0, v54
    v_add_f32 v55, 0x41400000, v55
    v_max_f32 v55, 0, v55
    v_sub_f32 v160, v160, v54
    v_sub_f32 v161, v161, v54
    v_sub_f32 v162, v162, v54
    v_sub_f32 v163, v163, v54
    v_sub_f32 v164, v164, v55
    v_sub_f32 v165, v165, v55
    v_sub_f32 v166, v166, v55
    v_sub_f32 v167, v167, v55
    v_sub_f32 v168, v168, v54
    v_sub_f32 v169, v169, v54
    v_sub_f32 v170, v170, v54
    v_sub_f32 v171, v171, v54
    v_sub_f32 v172, v172, v55
    v_sub_f32 v173, v173, v55
    v_sub_f32 v174, v174, v55
    v_sub_f32 v175, v175, v55
    v_sub_f32 v176, v176, v54
    v_sub_f32 v177, v177, v54
    v_sub_f32 v178, v178, v54
    v_sub_f32 v179, v179, v54
    v_sub_f32 v180, v180, v55
    v_sub_f32 v181, v181, v55
    v_sub_f32 v182, v182, v55
    v_sub_f32 v183, v183, v55
    v_sub_f32 v184, v184, v54
    v_sub_f32 v185, v185, v54
    v_sub_f32 v186, v186, v54
    v_sub_f32 v187, v187, v54
    v_sub_f32 v188, v188, v55
    v_sub_f32 v189, v189, v55
    v_sub_f32 v190, v190, v55
    v_sub_f32 v191, v191, v55
    v_sub_f32 v128, v128, v54
    v_sub_f32 v16, v16, v54
    v_sub_f32 v129, v129, v54
    v_sub_f32 v17, v17, v54
    v_sub_f32 v130, v130, v54
    v_sub_f32 v18, v18, v54
    v_sub_f32 v131, v131, v54
    v_sub_f32 v19, v19, v54
    v_sub_f32 v132, v132, v55
    v_sub_f32 v20, v20, v55
    v_sub_f32 v133, v133, v55
    v_sub_f32 v21, v21, v55
    v_sub_f32 v134, v134, v55
    v_sub_f32 v22, v22, v55
    v_sub_f32 v135, v135, v55
    v_sub_f32 v23, v23, v55
    v_sub_f32 v136, v136, v54
    v_sub_f32 v24, v24, v54
    v_sub_f32 v137, v137, v54
    v_sub_f32 v25, v25, v54
    v_sub_f32 v138, v138, v54
    v_sub_f32 v26, v26, v54
    v_sub_f32 v139, v139, v54
    v_sub_f32 v27, v27, v54
    v_sub_f32 v140, v140, v55
    v_sub_f32 v28, v28, v55
    v_sub_f32 v141, v141, v55
    v_sub_f32 v29, v29, v55
    v_sub_f32 v142, v142, v55
    v_sub_f32 v30, v30, v55
    v_sub_f32 v143, v143, v55
    v_sub_f32 v31, v31, v55
    v_sub_f32 v144, v144, v54
    v_sub_f32 v32, v32, v54
    v_sub_f32 v145, v145, v54
    v_sub_f32 v33, v33, v54
    v_sub_f32 v146, v146, v54
    v_sub_f32 v34, v34, v54
    v_sub_f32 v147, v147, v54
    v_sub_f32 v35, v35, v54
    v_sub_f32 v148, v148, v55
    v_sub_f32 v36, v36, v55
    v_sub_f32 v149, v149, v55
    v_sub_f32 v37, v37, v55
    v_sub_f32 v150, v150, v55
    v_sub_f32 v38, v38, v55
    v_sub_f32 v151, v151, v55
    v_sub_f32 v39, v39, v55
    v_sub_f32 v152, v152, v54
    v_sub_f32 v40, v40, v54
    v_sub_f32 v153, v153, v54
    v_sub_f32 v41, v41, v54
    v_sub_f32 v154, v154, v54
    v_sub_f32 v42, v42, v54
    v_sub_f32 v155, v155, v54
    v_sub_f32 v43, v43, v54
    v_sub_f32 v156, v156, v55
    v_sub_f32 v44, v44, v55
    v_sub_f32 v157, v157, v55
    v_sub_f32 v45, v45, v55
    v_sub_f32 v158, v158, v55
    v_sub_f32 v46, v46, v55
    v_sub_f32 v159, v159, v55
    v_sub_f32 v47, v47, v55
    v_sub_f32 v10, v10, v54
    v_exp_f32 v54, -v54
    v_sub_f32 v11, v11, v55
    v_exp_f32 v55, -v55
    s_nop 0
    v_mul_f32 v248, v248, v54
    v_mul_f32 v252, v252, v55
    v_accvgpr_read_b32 v224, a8
    v_accvgpr_read_b32 v225, a9
    v_accvgpr_read_b32 v226, a10
    v_accvgpr_read_b32 v227, a11
    v_mul_f32 v224, v224, v54
    v_mul_f32 v225, v225, v54
    v_mul_f32 v226, v226, v54
    v_mul_f32 v227, v227, v54
    v_accvgpr_write_b32 a8, v224
    v_accvgpr_write_b32 a9, v225
    v_accvgpr_write_b32 a10, v226
    v_accvgpr_write_b32 a11, v227
    v_accvgpr_read_b32 v224, a12
    v_accvgpr_read_b32 v225, a13
    v_accvgpr_read_b32 v226, a14
    v_accvgpr_read_b32 v227, a15
    v_mul_f32 v224, v224, v55
    v_mul_f32 v225, v225, v55
    v_mul_f32 v226, v226, v55
    v_mul_f32 v227, v227, v55
    v_accvgpr_write_b32 a12, v224
    v_accvgpr_write_b32 a13, v225
    v_accvgpr_write_b32 a14, v226
    v_accvgpr_write_b32 a15, v227
    v_accvgpr_read_b32 v224, a24
    v_accvgpr_read_b32 v225, a25
    v_accvgpr_read_b32 v226, a26
    v_accvgpr_read_b32 v227, a27
    v_mul_f32 v224, v224, v54
    v_mul_f32 v225, v225, v54
    v_mul_f32 v226, v226, v54
    v_mul_f32 v227, v227, v54
    v_accvgpr_write_b32 a24, v224
    v_accvgpr_write_b32 a25, v225
    v_accvgpr_write_b32 a26, v226
    v_accvgpr_write_b32 a27, v227
    v_accvgpr_read_b32 v224, a28
    v_accvgpr_read_b32 v225, a29
    v_accvgpr_read_b32 v226, a30
    v_accvgpr_read_b32 v227, a31
    v_mul_f32 v224, v224, v55
    v_mul_f32 v225, v225, v55
    v_mul_f32 v226, v226, v55
    v_mul_f32 v227, v227, v55
    v_accvgpr_write_b32 a28, v224
    v_accvgpr_write_b32 a29, v225
    v_accvgpr_write_b32 a30, v226
    v_accvgpr_write_b32 a31, v227
    v_accvgpr_read_b32 v224, a40
    v_accvgpr_read_b32 v225, a41
    v_accvgpr_read_b32 v226, a42
    v_accvgpr_read_b32 v227, a43
    v_mul_f32 v224, v224, v54
    v_mul_f32 v225, v225, v54
    v_mul_f32 v226, v226, v54
    v_mul_f32 v227, v227, v54
    v_accvgpr_write_b32 a40, v224
    v_accvgpr_write_b32 a41, v225
    v_accvgpr_write_b32 a42, v226
    v_accvgpr_write_b32 a43, v227
    v_accvgpr_read_b32 v224, a44
    v_accvgpr_read_b32 v225, a45
    v_accvgpr_read_b32 v226, a46
    v_accvgpr_read_b32 v227, a47
    v_mul_f32 v224, v224, v55
    v_mul_f32 v225, v225, v55
    v_mul_f32 v226, v226, v55
    v_mul_f32 v227, v227, v55
    v_accvgpr_write_b32 a44, v224
    v_accvgpr_write_b32 a45, v225
    v_accvgpr_write_b32 a46, v226
    v_accvgpr_write_b32 a47, v227
    v_accvgpr_read_b32 v224, a56
    v_accvgpr_read_b32 v225, a57
    v_accvgpr_read_b32 v226, a58
    v_accvgpr_read_b32 v227, a59
    v_mul_f32 v224, v224, v54
    v_mul_f32 v225, v225, v54
    v_mul_f32 v226, v226, v54
    v_mul_f32 v227, v227, v54
    v_accvgpr_write_b32 a56, v224
    v_accvgpr_write_b32 a57, v225
    v_accvgpr_write_b32 a58, v226
    v_accvgpr_write_b32 a59, v227
    v_accvgpr_read_b32 v224, a60
    v_accvgpr_read_b32 v225, a61
    v_accvgpr_read_b32 v226, a62
    v_accvgpr_read_b32 v227, a63
    v_mul_f32 v224, v224, v55
    v_mul_f32 v225, v225, v55
    v_mul_f32 v226, v226, v55
    v_mul_f32 v227, v227, v55
    v_accvgpr_write_b32 a60, v224
    v_accvgpr_write_b32 a61, v225
    v_accvgpr_write_b32 a62, v226
    v_accvgpr_write_b32 a63, v227
    v_accvgpr_read_b32 v224, a72
    v_accvgpr_read_b32 v225, a73
    v_accvgpr_read_b32 v226, a74
    v_accvgpr_read_b32 v227, a75
    v_mul_f32 v224, v224, v54
    v_mul_f32 v225, v225, v54
    v_mul_f32 v226, v226, v54
    v_mul_f32 v227, v227, v54
    v_accvgpr_write_b32 a72, v224
    v_accvgpr_write_b32 a73, v225
    v_accvgpr_write_b32 a74, v226
    v_accvgpr_write_b32 a75, v227
    v_accvgpr_read_b32 v224, a76
    v_accvgpr_read_b32 v225, a77
    v_accvgpr_read_b32 v226, a78
    v_accvgpr_read_b32 v227, a79
    v_mul_f32 v224, v224, v55
    v_mul_f32 v225, v225, v55
    v_mul_f32 v226, v226, v55
    v_mul_f32 v227, v227, v55
    v_accvgpr_write_b32 a76, v224
    v_accvgpr_write_b32 a77, v225
    v_accvgpr_write_b32 a78, v226
    v_accvgpr_write_b32 a79, v227
    v_accvgpr_read_b32 v224, a88
    v_accvgpr_read_b32 v225, a89
    v_accvgpr_read_b32 v226, a90
    v_accvgpr_read_b32 v227, a91
    v_mul_f32 v224, v224, v54
    v_mul_f32 v225, v225, v54
    v_mul_f32 v226, v226, v54
    v_mul_f32 v227, v227, v54
    v_accvgpr_write_b32 a88, v224
    v_accvgpr_write_b32 a89, v225
    v_accvgpr_write_b32 a90, v226
    v_accvgpr_write_b32 a91, v227
    v_accvgpr_read_b32 v224, a92
    v_accvgpr_read_b32 v225, a93
    v_accvgpr_read_b32 v226, a94
    v_accvgpr_read_b32 v227, a95
    v_mul_f32 v224, v224, v55
    v_mul_f32 v225, v225, v55
    v_mul_f32 v226, v226, v55
    v_mul_f32 v227, v227, v55
    v_accvgpr_write_b32 a92, v224
    v_accvgpr_write_b32 a93, v225
    v_accvgpr_write_b32 a94, v226
    v_accvgpr_write_b32 a95, v227
    v_accvgpr_read_b32 v224, a104
    v_accvgpr_read_b32 v225, a105
    v_accvgpr_read_b32 v226, a106
    v_accvgpr_read_b32 v227, a107
    v_mul_f32 v224, v224, v54
    v_mul_f32 v225, v225, v54
    v_mul_f32 v226, v226, v54
    v_mul_f32 v227, v227, v54
    v_accvgpr_write_b32 a104, v224
    v_accvgpr_write_b32 a105, v225
    v_accvgpr_write_b32 a106, v226
    v_accvgpr_write_b32 a107, v227
    v_accvgpr_read_b32 v224, a108
    v_accvgpr_read_b32 v225, a109
    v_accvgpr_read_b32 v226, a110
    v_accvgpr_read_b32 v227, a111
    v_mul_f32 v224, v224, v55
    v_mul_f32 v225, v225, v55
    v_mul_f32 v226, v226, v55
    v_mul_f32 v227, v227, v55
    v_accvgpr_write_b32 a108, v224
    v_accvgpr_write_b32 a109, v225
    v_accvgpr_write_b32 a110, v226
    v_accvgpr_write_b32 a111, v227
    v_accvgpr_read_b32 v224, a120
    v_accvgpr_read_b32 v225, a121
    v_accvgpr_read_b32 v226, a122
    v_accvgpr_read_b32 v227, a123
    v_mul_f32 v224, v224, v54
    v_mul_f32 v225, v225, v54
    v_mul_f32 v226, v226, v54
    v_mul_f32 v227, v227, v54
    v_accvgpr_write_b32 a120, v224
    v_accvgpr_write_b32 a121, v225
    v_accvgpr_write_b32 a122, v226
    v_accvgpr_write_b32 a123, v227
    v_accvgpr_read_b32 v224, a124
    v_accvgpr_read_b32 v225, a125
    v_accvgpr_read_b32 v226, a126
    v_accvgpr_read_b32 v227, a127
    v_mul_f32 v224, v224, v55
    v_mul_f32 v225, v225, v55
    v_mul_f32 v226, v226, v55
    v_mul_f32 v227, v227, v55
    v_accvgpr_write_b32 a124, v224
    v_accvgpr_write_b32 a125, v225
    v_accvgpr_write_b32 a126, v226
    v_accvgpr_write_b32 a127, v227
    v_exp_f32 v232, v160
    v_exp_f32 v233, v161
    v_exp_f32 v234, v162
    v_exp_f32 v235, v163
    s_nop 0
    v_cvt_pk_bf16_f32 v208, v232, v233
    v_cvt_pk_bf16_f32 v209, v234, v235
    v_exp_f32 v232, v176
    v_exp_f32 v233, v177
    v_exp_f32 v234, v178
    v_exp_f32 v235, v179
    s_nop 0
    v_cvt_pk_bf16_f32 v210, v232, v233
    v_cvt_pk_bf16_f32 v211, v234, v235
    v_exp_f32 v232, v164
    v_exp_f32 v233, v165
    v_exp_f32 v234, v166
    v_exp_f32 v235, v167
    s_nop 0
    v_cvt_pk_bf16_f32 v212, v232, v233
    v_cvt_pk_bf16_f32 v213, v234, v235
    v_exp_f32 v232, v180
    v_exp_f32 v233, v181
    v_exp_f32 v234, v182
    v_exp_f32 v235, v183
    s_nop 0
    v_cvt_pk_bf16_f32 v214, v232, v233
    v_cvt_pk_bf16_f32 v215, v234, v235
    v_exp_f32 v232, v168
    v_exp_f32 v233, v169
    v_exp_f32 v234, v170
    v_exp_f32 v235, v171
    s_nop 0
    v_cvt_pk_bf16_f32 v216, v232, v233
    v_cvt_pk_bf16_f32 v217, v234, v235
    v_exp_f32 v232, v184
    v_exp_f32 v233, v185
    v_exp_f32 v234, v186
    v_exp_f32 v235, v187
    s_nop 0
    v_cvt_pk_bf16_f32 v218, v232, v233
    v_cvt_pk_bf16_f32 v219, v234, v235
    v_exp_f32 v232, v172
    v_exp_f32 v233, v173
    v_exp_f32 v234, v174
    v_exp_f32 v235, v175
    s_nop 0
    v_cvt_pk_bf16_f32 v220, v232, v233
    v_cvt_pk_bf16_f32 v221, v234, v235
    v_exp_f32 v232, v188
    v_exp_f32 v233, v189
    v_exp_f32 v234, v190
    v_exp_f32 v235, v191
    s_nop 0
    v_cvt_pk_bf16_f32 v222, v232, v233
    v_cvt_pk_bf16_f32 v223, v234, v235
    s_nop 3
    s_setpc_b64 s[40:41]
k2_rare_171:
    s_nop 7
    v_max_f32 v55, v164, v165
    v_max3_f32 v55, v55, v166, v167
    v_max3_f32 v55, v55, v180, v181
    v_max3_f32 v55, v55, v182, v183
    v_max3_f32 v55, v55, v172, v173
    v_max3_f32 v55, v55, v174, v175
    v_max3_f32 v55, v55, v188, v189
    v_max3_f32 v55, v55, v190, v191
    v_mov_b32 v227, v55
    s_nop 1
    v_permlane16_swap_b32 v55, v227
    s_nop 1
    v_max_f32 v55, v55, v227
    v_mov_b32 v227, v55
    s_nop 1
    v_permlane32_swap_b32 v55, v227
    s_nop 1
    v_max_f32 v55, v55, v227
    v_add_f32 v55, 0x41400000, v55
    v_max_f32 v55, 0, v55
    v_sub_f32 v164, v164, v55
    v_sub_f32 v165, v165, v55
    v_sub_f32 v166, v166, v55
    v_sub_f32 v167, v167, v55
    v_sub_f32 v172, v172, v55
    v_sub_f32 v173, v173, v55
    v_sub_f32 v174, v174, v55
    v_sub_f32 v175, v175, v55
    v_sub_f32 v180, v180, v55
    v_sub_f32 v181, v181, v55
    v_sub_f32 v182, v182, v55
    v_sub_f32 v183, v183, v55
    v_sub_f32 v188, v188, v55
    v_sub_f32 v189, v189, v55
    v_sub_f32 v190, v190, v55
    v_sub_f32 v191, v191, v55
    v_sub_f32 v11, v11, v55
    v_exp_f32 v55, -v55
    s_nop 0
    v_mul_f32 v252, v252, v55
    v_accvgpr_read_b32 v224, a12
    v_accvgpr_read_b32 v225, a13
    v_accvgpr_read_b32 v226, a14
    v_accvgpr_read_b32 v227, a15
    v_mul_f32 v224, v224, v55
    v_mul_f32 v225, v225, v55
    v_mul_f32 v226, v226, v55
    v_mul_f32 v227, v227, v55
    v_accvgpr_write_b32 a12, v224
    v_accvgpr_write_b32 a13, v225
    v_accvgpr_write_b32 a14, v226
    v_accvgpr_write_b32 a15, v227
    v_accvgpr_read_b32 v224, a28
    v_accvgpr_read_b32 v225, a29
    v_accvgpr_read_b32 v226, a30
    v_accvgpr_read_b32 v227, a31
    v_mul_f32 v224, v224, v55
    v_mul_f32 v225, v225, v55
    v_mul_f32 v226, v226, v55
    v_mul_f32 v227, v227, v55
    v_accvgpr_write_b32 a28, v224
    v_accvgpr_write_b32 a29, v225
    v_accvgpr_write_b32 a30, v226
    v_accvgpr_write_b32 a31, v227
    v_accvgpr_read_b32 v224, a44
    v_accvgpr_read_b32 v225, a45
    v_accvgpr_read_b32 v226, a46
    v_accvgpr_read_b32 v227, a47
    v_mul_f32 v224, v224, v55
    v_mul_f32 v225, v225, v55
    v_mul_f32 v226, v226, v55
    v_mul_f32 v227, v227, v55
    v_accvgpr_write_b32 a44, v224
    v_accvgpr_write_b32 a45, v225
    v_accvgpr_write_b32 a46, v226
    v_accvgpr_write_b32 a47, v227
    v_accvgpr_read_b32 v224, a60
    v_accvgpr_read_b32 v225, a61
    v_accvgpr_read_b32 v226, a62
    v_accvgpr_read_b32 v227, a63
    v_mul_f32 v224, v224, v55
    v_mul_f32 v225, v225, v55
    v_mul_f32 v226, v226, v55
    v_mul_f32 v227, v227, v55
    v_accvgpr_write_b32 a60, v224
    v_accvgpr_write_b32 a61, v225
    v_accvgpr_write_b32 a62, v226
    v_accvgpr_write_b32 a63, v227
    v_accvgpr_read_b32 v224, a76
    v_accvgpr_read_b32 v225, a77
    v_accvgpr_read_b32 v226, a78
    v_accvgpr_read_b32 v227, a79
    v_mul_f32 v224, v224, v55
    v_mul_f32 v225, v225, v55
    v_mul_f32 v226, v226, v55
    v_mul_f32 v227, v227, v55
    v_accvgpr_write_b32 a76, v224
    v_accvgpr_write_b32 a77, v225
    v_accvgpr_write_b32 a78, v226
    v_accvgpr_write_b32 a79, v227
    v_accvgpr_read_b32 v224, a92
    v_accvgpr_read_b32 v225, a93
    v_accvgpr_read_b32 v226, a94
    v_accvgpr_read_b32 v227, a95
    v_mul_f32 v224, v224, v55
    v_mul_f32 v225, v225, v55
    v_mul_f32 v226, v226, v55
    v_mul_f32 v227, v227, v55
    v_accvgpr_write_b32 a92, v224
    v_accvgpr_write_b32 a93, v225
    v_accvgpr_write_b32 a94, v226
    v_accvgpr_write_b32 a95, v227
    v_accvgpr_read_b32 v224, a108
    v_accvgpr_read_b32 v225, a109
    v_accvgpr_read_b32 v226, a110
    v_accvgpr_read_b32 v227, a111
    v_mul_f32 v224, v224, v55
    v_mul_f32 v225, v225, v55
    v_mul_f32 v226, v226, v55
    v_mul_f32 v227, v227, v55
    v_accvgpr_write_b32 a108, v224
    v_accvgpr_write_b32 a109, v225
    v_accvgpr_write_b32 a110, v226
    v_accvgpr_write_b32 a111, v227
    v_accvgpr_read_b32 v224, a124
    v_accvgpr_read_b32 v225, a125
    v_accvgpr_read_b32 v226, a126
    v_accvgpr_read_b32 v227, a127
    v_mul_f32 v224, v224, v55
    v_mul_f32 v225, v225, v55
    v_mul_f32 v226, v226, v55
    v_mul_f32 v227, v227, v55
    v_accvgpr_write_b32 a124, v224
    v_accvgpr_write_b32 a125, v225
    v_accvgpr_write_b32 a126, v226
    v_accvgpr_write_b32 a127, v227
    v_exp_f32 v232, v164
    v_exp_f32 v233, v165
    v_exp_f32 v234, v166
    v_exp_f32 v235, v167
    s_nop 0
    v_cvt_pk_bf16_f32 v212, v232, v233
    v_cvt_pk_bf16_f32 v213, v234, v235
    v_exp_f32 v232, v180
    v_exp_f32 v233, v181
    v_exp_f32 v234, v182
    v_exp_f32 v235, v183
    s_nop 0
    v_cvt_pk_bf16_f32 v214, v232, v233
    v_cvt_pk_bf16_f32 v215, v234, v235
    v_exp_f32 v232, v172
    v_exp_f32 v233, v173
    v_exp_f32 v234, v174
    v_exp_f32 v235, v175
    s_nop 0
    v_cvt_pk_bf16_f32 v220, v232, v233
    v_cvt_pk_bf16_f32 v221, v234, v235
    v_exp_f32 v232, v188
    v_exp_f32 v233, v189
    v_exp_f32 v234, v190
    v_exp_f32 v235, v191
    s_nop 0
    v_cvt_pk_bf16_f32 v222, v232, v233
    v_cvt_pk_bf16_f32 v223, v234, v235
    s_nop 3
    s_setpc_b64 s[40:41]
code_end:
    s_endpgm
.section .rodata,"a"
.p2align 6
.amdhsa_kernel sequential_preLN__compressed_kv_cla__moe_arch_mod__prompt_kernel
  .amdhsa_next_free_vgpr 512
  .amdhsa_next_free_sgpr 102
  .amdhsa_accum_offset 256
  .amdhsa_group_segment_fixed_size 0
  .amdhsa_kernarg_size 112
  .amdhsa_user_sgpr_count 2
  .amdhsa_user_sgpr_kernarg_segment_ptr 1
  .amdhsa_system_sgpr_workgroup_id_x 1
.end_amdhsa_kernel
```

```asm
; @launch grid=(256,1,1) block=(256,1,1) lds=163840
.amdgcn_target "amdgcn-amd-amdhsa--gfx950"
.text
.globl sequential_preLN__compressed_kv_cla__moe_arch_mod__prompt_kernel
.p2align 8
.type sequential_preLN__compressed_kv_cla__moe_arch_mod__prompt_kernel,@function
sequential_preLN__compressed_kv_cla__moe_arch_mod__prompt_kernel:
    s_cmp_ge_u32 s2, 256
    s_cbranch_scc1 k12_end_1
    s_load_dwordx4 s[36:39], s[0:1], 0
    s_load_dwordx4 s[40:43], s[0:1], 24
    s_load_dwordx2 s[4:5], s[0:1], 16
    s_load_dwordx4 s[60:63], s[0:1], 96
    s_lshr_b32 s59, s2, 3
    s_lshl_b32 s58, s59, 4
    v_add_u32 v6, s58, v0
    v_cmp_gt_u32 vcc, 48, v0
    v_cmp_gt_u32 s[56:57], 64, v0
    s_nop 0
    v_cndmask_b32 v6, v6, v0, vcc
    s_getpc_b64 s[52:53]
pc_2:
    s_add_u32 s52, s52, k12_code0-pc_2
    s_addc_u32 s53, s53, 0
    v_lshlrev_b32 v58, 7, v6
    v_mov_b32 v59, s53
    v_add_co_u32 v58, vcc, s52, v58
    s_nop 1
    v_addc_co_u32 v59, vcc, 0, v59, vcc
k12_code0:
    s_mov_b64 exec, s[56:57]
    s_cbranch_execz k12_nocode_3
    global_load_dword v51, v[58:59], off
k12_nocode_3:
    s_mov_b64 exec, -1
    s_and_b32 s58, s2, 7
    s_lshr_b32 s59, s2, 3
    s_and_b32 s45, s59, 7
    s_lshr_b32 s57, s59, 3
    s_and_b32 s44, s57, 1
    s_lshl_b32 s52, s58, 1
    s_add_u32 s44, s44, s52
    s_lshr_b32 s57, s57, 1
    v_lshrrev_b32 v2, 6, v0
    v_and_b32 v3, 63, v0
    v_readfirstlane_b32 s30, v2
    v_lshlrev_b32 v1, 4, v3
    v_lshrrev_b32 v60, 5, v3
    v_lshl_add_u32 v60, v2, 1, v60
    v_and_b32 v61, 31, v3
    v_lshlrev_b32 v6, 11, v60
    v_lshl_add_u32 v62, v61, 4, v6
    s_lshl_b32 s52, s2, 14
    v_lshrrev_b32 v56, 3, v3
    v_and_b32 v57, 7, v3
    v_lshrrev_b32 v58, 1, v56
    v_xor_b32 v6, v57, v58
    v_xor_b32 v7, 4, v6
    v_lshl_add_u32 v58, v2, 6, v56
    v_lshlrev_b32 v58, 10, v58
    s_lshl_b32 s47, s45, 18
    v_add_u32 v58, s47, v58
    v_lshl_add_u32 v10, v6, 4, v58
    v_lshl_add_u32 v11, v7, 4, v58
    v_add_u32 v17, 54272, v11
    v_add_u32 v16, 47104, v10
    v_add_u32 v15, 39936, v11
    v_add_u32 v14, 32768, v10
    v_add_u32 v13, 21504, v11
    v_add_u32 v12, 14336, v10
    v_add_u32 v11, 7168, v11
    v_add_u32 v10, 0, v10
    v_lshrrev_b32 v6, 5, v3
    v_bfe_u32 v7, v3, 1, 4
    v_and_b32 v59, 1, v3
    v_lshl_add_u32 v58, v2, 4, v6
    v_lshlrev_b32 v58, 13, v58
    v_lshl_add_u32 v58, v59, 4, v58
    s_lshl_b32 s47, s44, 9
    v_add_u32 v58, s47, v58
    v_xor_b32 v7, v7, v6
    v_xor_b32 v6, 0, v7
    v_lshl_add_u32 v6, v6, 5, v58
    v_add_u32 v18, 0, v6
    v_xor_b32 v6, 2, v7
    v_lshl_add_u32 v6, v6, 5, v58
    v_add_u32 v19, 15360, v6
    v_xor_b32 v6, 0, v7
    v_lshl_add_u32 v6, v6, 5, v58
    v_add_u32 v20, 30720, v6
    v_xor_b32 v6, 2, v7
    v_lshl_add_u32 v6, v6, 5, v58
    v_add_u32 v21, 46080, v6
    v_xor_b32 v6, 4, v7
    v_lshl_add_u32 v6, v6, 5, v58
    v_add_u32 v22, 65536, v6
    v_xor_b32 v6, 6, v7
    v_lshl_add_u32 v6, v6, 5, v58
    v_add_u32 v23, 80896, v6
    v_xor_b32 v6, 4, v7
    v_lshl_add_u32 v6, v6, 5, v58
    v_add_u32 v24, 96256, v6
    v_xor_b32 v6, 6, v7
    v_lshl_add_u32 v6, v6, 5, v58
    v_add_u32 v25, 111616, v6
    s_lshl_b32 s48, s30, 13
    s_mov_b32 s49, 0
    s_mov_b32 s50, 0
    s_waitcnt lgkmcnt(0)
    s_mov_b32 s24, s36
    s_and_b32 s25, s37, 0xffff
    s_mov_b32 s26, 0x400000
    s_mov_b32 s27, 0x00020000
    buffer_load_dwordx4 v[64:67], v62, s[24:27], s52 offen offset:0
    buffer_load_dwordx4 v[68:71], v62, s[24:27], s52 offen offset:512
    buffer_load_dwordx4 v[72:75], v62, s[24:27], s52 offen offset:1024
    buffer_load_dwordx4 v[76:79], v62, s[24:27], s52 offen offset:1536
    s_mov_b32 s16, s38
    s_and_b32 s17, s39, 0xffff
    s_mov_b32 s18, 0x200000
    s_mov_b32 s19, 0x00020000
    s_cmp_eq_u32 s57, 0
    s_cselect_b32 s20, s40, s42
    s_cselect_b32 s21, s41, s43
    s_and_b32 s21, s21, 0xffff
    s_mov_b32 s22, 0x400000
    s_mov_b32 s23, 0x00020000
    s_add_u32 m0, s48, 0
    s_nop 0
    buffer_load_dwordx4 v10, s[16:19], s49 offen offset:0 lds
    buffer_load_dwordx4 v11, s[16:19], s49 offen offset:1024 lds
    buffer_load_dwordx4 v12, s[16:19], s49 offen offset:2048 lds
    buffer_load_dwordx4 v13, s[16:19], s49 offen offset:3072 lds
    s_add_u32 m0, s48, 65536
    s_nop 0
    buffer_load_dwordx4 v18, s[20:23], s50 offen offset:0 lds
    buffer_load_dwordx4 v19, s[20:23], s50 offen offset:1024 lds
    buffer_load_dwordx4 v20, s[20:23], s50 offen offset:2048 lds
    buffer_load_dwordx4 v21, s[20:23], s50 offen offset:3072 lds
    s_mov_b64 s[6:7], s[62:63]
    s_add_u32 s8, s6, 0x0
    s_addc_u32 s9, s7, 0
    s_and_b32 s9, s9, 0xffff
    s_mov_b32 s10, 0x400000
    s_mov_b32 s11, 0x00020000
    s_mov_b32 s12, s4
    s_and_b32 s13, s5, 0xffff
    s_mov_b32 s14, 0x800000
    s_mov_b32 s15, 0x00020000
    s_add_u32 s32, s6, 0x1000000
    s_addc_u32 s33, s7, 0
    s_and_b32 s33, s33, 0xffff
    s_mov_b32 s34, 0x2000000
    s_mov_b32 s35, 0x00020000
    s_mov_b32 s24, s60
    s_and_b32 s25, s61, 0xffff
    s_mov_b32 s26, 0x100
    s_mov_b32 s27, 0x00020000
    s_lshl_b32 s28, s58, 2
    s_and_b32 s31, s59, 3
    s_add_u32 s28, s28, s31
    s_lshr_b32 s29, s59, 2
    s_lshl_b32 s42, s29, 7
    s_sub_u32 s43, 1920, s42
    s_lshl_b32 s31, s30, 4
    s_add_u32 s38, s42, s31
    s_add_u32 s39, s43, s31
    s_lshl_b32 s60, s30, 12
    s_mov_b32 s61, 0
    s_mov_b32 s62, 0
    s_lshl_b32 s47, s44, 1
    s_lshr_b32 s52, s30, 1
    s_add_u32 s47, s47, s52
    s_lshl_b32 s47, s47, 14
    s_lshl_b32 s52, s45, 1
    s_and_b32 s53, s30, 1
    s_add_u32 s52, s52, s53
    s_lshl_b32 s52, s52, 20
    s_add_u32 s47, s47, s52
    s_lshl_b32 s52, s57, 24
    s_add_u32 s47, s47, s52
    s_lshl_b32 s54, s44, 8
    s_lshr_b32 s55, s28, 1
    s_lshl_b32 s55, s55, 8
    s_and_b32 s53, s59, 3
    s_add_u32 s53, s53, 1
    s_cmp_eq_u32 s30, 0
    s_cselect_b32 s53, s53, -1
    s_cselect_b32 s46, 6, -1
    v_lshlrev_b32 v6, 13, v56
    v_lshl_add_u32 v50, v57, 7, v6
    s_lshl_b32 s56, s30, 5
    s_add_u32 s56, s56, s59
    s_lshl_b32 s56, s56, 16
    s_lshl_b32 s52, s58, 10
    s_add_u32 s56, s56, s52
    s_add_u32 s63, s30, 1
    v_mul_u32_u24 v6, 2064, v60
    v_lshl_add_u32 v6, v61, 4, v6
    v_add_u32 v54, 131072, v6
    v_mul_u32_u24 v7, 2064, v57
    v_lshl_add_u32 v7, v56, 4, v7
    v_lshl_add_u32 v7, v2, 9, v7
    v_add_u32 v55, 131072, v7
    v_lshrrev_b32 v7, 2, v56
    v_lshl_add_u32 v7, v2, 3, v7
    v_lshlrev_b32 v7, 17, v7
    v_and_b32 v6, 3, v56
    v_lshl_add_u32 v7, v6, 8, v7
    v_lshl_add_u32 v7, v57, 4, v7
    s_lshr_b32 s52, s2, 1
    s_lshl_b32 s52, s52, 10
    s_and_b32 s31, s2, 1
    s_lshl_b32 s31, s31, 7
    s_add_u32 s52, s52, s31
    v_add_u32 v53, s52, v7
    v_and_b32 v56, 15, v3
    v_lshrrev_b32 v57, 4, v3
    v_lshrrev_b32 v6, 1, v56
    v_xor_b32 v6, v6, v57
    v_and_b32 v7, 1, v2
    v_lshl_add_u32 v7, v7, 7, v56
    v_lshlrev_b32 v7, 7, v7
    v_lshl_add_u32 v26, v6, 4, v7
    v_xor_b32 v27, 64, v26
    v_lshrrev_b32 v6, 2, v56
    v_and_b32 v58, 1, v57
    v_lshl_add_u32 v58, v58, 2, v6
    v_lshl_add_u32 v59, v57, 3, v6
    v_and_b32 v63, 3, v3
    v_lshlrev_b32 v7, 9, v59
    v_lshrrev_b32 v6, 1, v2
    v_lshl_add_u32 v7, v6, 8, v7
    v_lshl_add_u32 v7, v63, 3, v7
    v_add_u32 v7, 65536, v7
    v_lshlrev_b32 v59, 8, v59
    v_lshl_add_u32 v59, v63, 3, v59
    v_add_u32 v59, 98304, v59
    v_xor_b32 v6, 0, v58
    v_lshl_add_u32 v28, v6, 5, v7
    v_lshl_add_u32 v42, v6, 5, v59
    v_xor_b32 v6, 1, v58
    v_lshl_add_u32 v29, v6, 5, v7
    v_lshl_add_u32 v43, v6, 5, v59
    v_xor_b32 v6, 2, v58
    v_lshl_add_u32 v30, v6, 5, v7
    v_lshl_add_u32 v44, v6, 5, v59
    v_xor_b32 v6, 3, v58
    v_lshl_add_u32 v31, v6, 5, v7
    v_lshl_add_u32 v45, v6, 5, v59
    v_xor_b32 v6, 4, v58
    v_lshl_add_u32 v32, v6, 5, v7
    v_lshl_add_u32 v46, v6, 5, v59
    v_xor_b32 v6, 5, v58
    v_lshl_add_u32 v33, v6, 5, v7
    v_lshl_add_u32 v47, v6, 5, v59
    v_xor_b32 v6, 6, v58
    v_lshl_add_u32 v34, v6, 5, v7
    v_lshl_add_u32 v48, v6, 5, v59
    v_xor_b32 v6, 7, v58
    v_lshl_add_u32 v35, v6, 5, v7
    v_lshl_add_u32 v49, v6, 5, v59
    s_lshl_b32 s31, s38, 6
    v_add_u32 v36, s31, v1
    s_lshl_b32 s31, s39, 6
    v_add_u32 v37, s31, v1
    v_bfe_u32 v6, v3, 1, 3
    v_and_b32 v7, 1, v3
    v_lshl_add_u32 v58, v2, 4, v57
    v_lshlrev_b32 v58, 13, v58
    v_lshl_add_u32 v58, v7, 4, v58
    s_lshl_b32 s31, s28, 8
    v_add_u32 v58, s31, v58
    v_xor_b32 v6, v6, v57
    v_xor_b32 v7, 0, v6
    v_lshl_add_u32 v7, v7, 5, v58
    v_add_u32 v38, 0, v7
    v_xor_b32 v7, 0, v6
    v_lshl_add_u32 v7, v7, 5, v58
    v_add_u32 v39, 31744, v7
    v_xor_b32 v7, 4, v6
    v_lshl_add_u32 v7, v7, 5, v58
    v_add_u32 v40, 63488, v7
    v_xor_b32 v7, 4, v6
    v_lshl_add_u32 v7, v7, 5, v58
    v_add_u32 v41, 95232, v7
    v_lshlrev_b32 v6, 2, v57
    v_sub_u32 v4, v56, v6
    v_mov_b32 v5, 0xff800000
    v_mov_b32 v8, 0
    v_mov_b32 v9, 1
    s_lshl_b32 s52, s59, 2
    s_add_u32 s52, s52, s30
    v_and_b32 v6, 1, v3
    v_lshl_add_u32 v6, s52, 1, v6
    s_getpc_b64 s[40:41]
pc_4:
    s_add_u32 s40, s40, k12_qcode-pc_4
    s_addc_u32 s41, s41, 0
    v_lshlrev_b32 v2, 7, v6
    v_mov_b32 v3, s41
    v_add_co_u32 v2, vcc, s40, v2
    s_nop 1
    v_addc_co_u32 v3, vcc, 0, v3, vcc
    v_mov_b32 v56, 0
    v_mov_b32 v57, 0
    v_mov_b32 v58, 0
    v_mov_b32 v59, 0
    s_nop 1
    v_mfma_f32_32x32x16_bf16 a[128:143], v[56:59], v[56:59], 0
    v_mfma_f32_32x32x16_bf16 a[144:159], v[56:59], v[56:59], 0
    v_mfma_f32_32x32x16_bf16 a[160:175], v[56:59], v[56:59], 0
    v_mfma_f32_32x32x16_bf16 a[176:191], v[56:59], v[56:59], 0
    v_mfma_f32_32x32x16_bf16 v[128:143], v[56:59], v[56:59], 0
    v_mfma_f32_32x32x16_bf16 v[144:159], v[56:59], v[56:59], 0
    v_mfma_f32_32x32x16_bf16 v[160:175], v[56:59], v[56:59], 0
    v_mfma_f32_32x32x16_bf16 v[176:191], v[56:59], v[56:59], 0
    v_mfma_f32_32x32x16_bf16 v[192:207], v[56:59], v[56:59], 0
    v_mfma_f32_32x32x16_bf16 v[208:223], v[56:59], v[56:59], 0
    v_mfma_f32_32x32x16_bf16 v[224:239], v[56:59], v[56:59], 0
    v_mfma_f32_32x32x16_bf16 v[240:255], v[56:59], v[56:59], 0
    s_add_u32 m0, s48, 4096
    s_nop 0
    buffer_load_dwordx4 v14, s[16:19], s49 offen offset:0 lds
    buffer_load_dwordx4 v15, s[16:19], s49 offen offset:1024 lds
    buffer_load_dwordx4 v16, s[16:19], s49 offen offset:2048 lds
    buffer_load_dwordx4 v17, s[16:19], s49 offen offset:3072 lds
    s_add_u32 s49, s49, 128
    s_add_u32 m0, s48, 69632
    s_nop 0
    buffer_load_dwordx4 v22, s[20:23], s50 offen offset:0 lds
    buffer_load_dwordx4 v23, s[20:23], s50 offen offset:1024 lds
    buffer_load_dwordx4 v24, s[20:23], s50 offen offset:2048 lds
    buffer_load_dwordx4 v25, s[20:23], s50 offen offset:3072 lds
    s_add_u32 s50, s50, 0x80000
    s_waitcnt vmcnt(16)
    v_lshlrev_b32 v80, 16, v64
    v_and_b32 v81, 0xffff0000, v64
    v_lshlrev_b32 v82, 16, v65
    v_and_b32 v83, 0xffff0000, v65
    v_lshlrev_b32 v84, 16, v66
    v_and_b32 v85, 0xffff0000, v66
    v_lshlrev_b32 v86, 16, v67
    v_and_b32 v87, 0xffff0000, v67
    v_lshlrev_b32 v88, 16, v68
    v_and_b32 v89, 0xffff0000, v68
    v_lshlrev_b32 v90, 16, v69
    v_and_b32 v91, 0xffff0000, v69
    v_lshlrev_b32 v92, 16, v70
    v_and_b32 v93, 0xffff0000, v70
    v_lshlrev_b32 v94, 16, v71
    v_and_b32 v95, 0xffff0000, v71
    v_lshlrev_b32 v96, 16, v72
    v_and_b32 v97, 0xffff0000, v72
    v_lshlrev_b32 v98, 16, v73
    v_and_b32 v99, 0xffff0000, v73
    v_lshlrev_b32 v100, 16, v74
    v_and_b32 v101, 0xffff0000, v74
    v_lshlrev_b32 v102, 16, v75
    v_and_b32 v103, 0xffff0000, v75
    v_lshlrev_b32 v104, 16, v76
    v_and_b32 v105, 0xffff0000, v76
    v_lshlrev_b32 v106, 16, v77
    v_and_b32 v107, 0xffff0000, v77
    v_lshlrev_b32 v108, 16, v78
    v_and_b32 v109, 0xffff0000, v78
    v_lshlrev_b32 v110, 16, v79
    v_and_b32 v111, 0xffff0000, v79
    v_pk_add_f32 v[112:113], v[80:81], v[82:83]
    v_pk_add_f32 v[114:115], v[84:85], v[86:87]
    v_pk_add_f32 v[112:113], v[112:113], v[88:89]
    v_pk_add_f32 v[114:115], v[114:115], v[90:91]
    v_pk_add_f32 v[112:113], v[112:113], v[92:93]
    v_pk_add_f32 v[114:115], v[114:115], v[94:95]
    v_pk_add_f32 v[112:113], v[112:113], v[96:97]
    v_pk_add_f32 v[114:115], v[114:115], v[98:99]
    v_pk_add_f32 v[112:113], v[112:113], v[100:101]
    v_pk_add_f32 v[114:115], v[114:115], v[102:103]
    v_pk_add_f32 v[112:113], v[112:113], v[104:105]
    v_pk_add_f32 v[114:115], v[114:115], v[106:107]
    s_add_u32 m0, s48, 32768
    s_nop 0
    buffer_load_dwordx4 v10, s[16:19], s49 offen offset:0 lds
    buffer_load_dwordx4 v11, s[16:19], s49 offen offset:1024 lds
    buffer_load_dwordx4 v12, s[16:19], s49 offen offset:2048 lds
    buffer_load_dwordx4 v13, s[16:19], s49 offen offset:3072 lds
    v_pk_add_f32 v[112:113], v[112:113], v[108:109]
    v_pk_add_f32 v[114:115], v[114:115], v[110:111]
    v_pk_add_f32 v[112:113], v[112:113], v[114:115]
    v_add_f32 v112, v112, v113
    s_nop 1
    v_add_f32_dpp v112, v112, v112 quad_perm:[1,0,3,2] row_mask:0xf bank_mask:0xf
    s_nop 1
    v_add_f32_dpp v112, v112, v112 quad_perm:[2,3,0,1] row_mask:0xf bank_mask:0xf
    s_nop 1
    v_add_f32_dpp v112, v112, v112 row_half_mirror row_mask:0xf bank_mask:0xf
    s_nop 1
    v_add_f32_dpp v112, v112, v112 row_mirror row_mask:0xf bank_mask:0xf
    v_mov_b32 v114, v112
    s_nop 1
    v_permlane16_swap_b32 v112, v114
    s_nop 1
    v_add_f32 v112, v112, v114
    v_mul_f32 v112, 0xba800000, v112
    v_mov_b32 v113, v112
    v_pk_add_f32 v[114:115], v[80:81], v[112:113]
    v_pk_add_f32 v[118:119], v[82:83], v[112:113]
    v_pk_mul_f32 v[116:117], v[114:115], v[114:115]
    v_pk_fma_f32 v[116:117], v[118:119], v[118:119], v[116:117]
    v_pk_add_f32 v[114:115], v[84:85], v[112:113]
    v_pk_add_f32 v[118:119], v[86:87], v[112:113]
    v_pk_fma_f32 v[116:117], v[114:115], v[114:115], v[116:117]
    v_pk_fma_f32 v[116:117], v[118:119], v[118:119], v[116:117]
    v_pk_add_f32 v[114:115], v[88:89], v[112:113]
    v_pk_add_f32 v[118:119], v[90:91], v[112:113]
    v_pk_fma_f32 v[116:117], v[114:115], v[114:115], v[116:117]
    v_pk_fma_f32 v[116:117], v[118:119], v[118:119], v[116:117]
    v_pk_add_f32 v[114:115], v[92:93], v[112:113]
    v_pk_add_f32 v[118:119], v[94:95], v[112:113]
    v_pk_fma_f32 v[116:117], v[114:115], v[114:115], v[116:117]
    v_pk_fma_f32 v[116:117], v[118:119], v[118:119], v[116:117]
    v_pk_add_f32 v[114:115], v[96:97], v[112:113]
    v_pk_add_f32 v[118:119], v[98:99], v[112:113]
    v_pk_fma_f32 v[116:117], v[114:115], v[114:115], v[116:117]
    v_pk_fma_f32 v[116:117], v[118:119], v[118:119], v[116:117]
    v_pk_add_f32 v[114:115], v[100:101], v[112:113]
    v_pk_add_f32 v[118:119], v[102:103], v[112:113]
    v_pk_fma_f32 v[116:117], v[114:115], v[114:115], v[116:117]
    v_pk_fma_f32 v[116:117], v[118:119], v[118:119], v[116:117]
    v_pk_add_f32 v[114:115], v[104:105], v[112:113]
    s_add_u32 m0, s48, 98304
    s_nop 0
    buffer_load_dwordx4 v18, s[20:23], s50 offen offset:0 lds
    buffer_load_dwordx4 v19, s[20:23], s50 offen offset:1024 lds
    buffer_load_dwordx4 v20, s[20:23], s50 offen offset:2048 lds
    buffer_load_dwordx4 v21, s[20:23], s50 offen offset:3072 lds
    v_pk_add_f32 v[118:119], v[106:107], v[112:113]
    v_pk_fma_f32 v[116:117], v[114:115], v[114:115], v[116:117]
    v_pk_fma_f32 v[116:117], v[118:119], v[118:119], v[116:117]
    v_pk_add_f32 v[114:115], v[108:109], v[112:113]
    v_pk_add_f32 v[118:119], v[110:111], v[112:113]
    v_pk_fma_f32 v[116:117], v[114:115], v[114:115], v[116:117]
    v_pk_fma_f32 v[116:117], v[118:119], v[118:119], v[116:117]
    v_add_f32 v116, v116, v117
    s_nop 1
    v_add_f32_dpp v116, v116, v116 quad_perm:[1,0,3,2] row_mask:0xf bank_mask:0xf
    s_nop 1
    v_add_f32_dpp v116, v116, v116 quad_perm:[2,3,0,1] row_mask:0xf bank_mask:0xf
    s_nop 1
    v_add_f32_dpp v116, v116, v116 row_half_mirror row_mask:0xf bank_mask:0xf
    s_nop 1
    v_add_f32_dpp v116, v116, v116 row_mirror row_mask:0xf bank_mask:0xf
    v_mov_b32 v114, v116
    s_nop 1
    v_permlane16_swap_b32 v116, v114
    s_nop 1
    v_add_f32 v116, v116, v114
    v_mul_f32 v116, 0x3a800000, v116
    v_cvt_pk_bf16_f32 v118, v112, v116
    v_and_b32 v116, 0xffff0000, v118
    v_lshlrev_b32 v118, 16, v118
    v_add_f32 v116, 0x3727c5ac, v116
    v_mov_b32 v119, v118
    v_cvt_pk_bf16_f32 v116, v116, v116
    v_and_b32 v116, 0xffff0000, v116
    v_sqrt_f32 v116, v116
    v_pk_add_f32 v[80:81], v[80:81], v[118:119]
    v_pk_add_f32 v[82:83], v[82:83], v[118:119]
    v_pk_add_f32 v[84:85], v[84:85], v[118:119]
    v_pk_add_f32 v[86:87], v[86:87], v[118:119]
    v_pk_add_f32 v[88:89], v[88:89], v[118:119]
    v_pk_add_f32 v[90:91], v[90:91], v[118:119]
    v_pk_add_f32 v[92:93], v[92:93], v[118:119]
    v_pk_add_f32 v[94:95], v[94:95], v[118:119]
    v_pk_add_f32 v[96:97], v[96:97], v[118:119]
    v_pk_add_f32 v[98:99], v[98:99], v[118:119]
    v_pk_add_f32 v[100:101], v[100:101], v[118:119]
    v_pk_add_f32 v[102:103], v[102:103], v[118:119]
    v_pk_add_f32 v[104:105], v[104:105], v[118:119]
    s_add_u32 m0, s48, 36864
    s_nop 0
    buffer_load_dwordx4 v14, s[16:19], s49 offen offset:0 lds
    buffer_load_dwordx4 v15, s[16:19], s49 offen offset:1024 lds
    buffer_load_dwordx4 v16, s[16:19], s49 offen offset:2048 lds
    buffer_load_dwordx4 v17, s[16:19], s49 offen offset:3072 lds
    s_add_u32 s49, s49, 128
    v_pk_add_f32 v[106:107], v[106:107], v[118:119]
    v_pk_add_f32 v[108:109], v[108:109], v[118:119]
    v_pk_add_f32 v[110:111], v[110:111], v[118:119]
    v_cvt_pk_bf16_f32 v116, v116, v116
    v_and_b32 v116, 0xffff0000, v116
    v_rcp_f32 v116, v116
    v_cvt_pk_bf16_f32 v64, v80, v81
    v_cvt_pk_bf16_f32 v65, v82, v83
    v_cvt_pk_bf16_f32 v66, v84, v85
    v_cvt_pk_bf16_f32 v67, v86, v87
    v_cvt_pk_bf16_f32 v68, v88, v89
    v_cvt_pk_bf16_f32 v69, v90, v91
    v_cvt_pk_bf16_f32 v70, v92, v93
    v_cvt_pk_bf16_f32 v71, v94, v95
    v_cvt_pk_bf16_f32 v72, v96, v97
    v_cvt_pk_bf16_f32 v73, v98, v99
    v_cvt_pk_bf16_f32 v74, v100, v101
    v_cvt_pk_bf16_f32 v75, v102, v103
    v_cvt_pk_bf16_f32 v76, v104, v105
    v_cvt_pk_bf16_f32 v77, v106, v107
    v_cvt_pk_bf16_f32 v78, v108, v109
    v_cvt_pk_bf16_f32 v79, v110, v111
    v_mov_b32 v117, v116
    v_lshlrev_b32 v80, 16, v64
    v_and_b32 v81, 0xffff0000, v64
    v_lshlrev_b32 v82, 16, v65
    v_and_b32 v83, 0xffff0000, v65
    v_lshlrev_b32 v84, 16, v66
    v_and_b32 v85, 0xffff0000, v66
    v_lshlrev_b32 v86, 16, v67
    v_and_b32 v87, 0xffff0000, v67
    v_lshlrev_b32 v88, 16, v68
    v_and_b32 v89, 0xffff0000, v68
    v_lshlrev_b32 v90, 16, v69
    v_and_b32 v91, 0xffff0000, v69
    v_lshlrev_b32 v92, 16, v70
    v_and_b32 v93, 0xffff0000, v70
    v_lshlrev_b32 v94, 16, v71
    v_and_b32 v95, 0xffff0000, v71
    v_lshlrev_b32 v96, 16, v72
    v_and_b32 v97, 0xffff0000, v72
    v_lshlrev_b32 v98, 16, v73
    v_and_b32 v99, 0xffff0000, v73
    v_lshlrev_b32 v100, 16, v74
    s_add_u32 m0, s48, 102400
    s_nop 0
    buffer_load_dwordx4 v22, s[20:23], s50 offen offset:0 lds
    buffer_load_dwordx4 v23, s[20:23], s50 offen offset:1024 lds
    buffer_load_dwordx4 v24, s[20:23], s50 offen offset:2048 lds
    buffer_load_dwordx4 v25, s[20:23], s50 offen offset:3072 lds
    s_add_u32 s50, s50, 0x80000
    v_and_b32 v101, 0xffff0000, v74
    v_lshlrev_b32 v102, 16, v75
    v_and_b32 v103, 0xffff0000, v75
    v_lshlrev_b32 v104, 16, v76
    v_and_b32 v105, 0xffff0000, v76
    v_lshlrev_b32 v106, 16, v77
    v_and_b32 v107, 0xffff0000, v77
    v_lshlrev_b32 v108, 16, v78
    v_and_b32 v109, 0xffff0000, v78
    v_lshlrev_b32 v110, 16, v79
    v_and_b32 v111, 0xffff0000, v79
    v_pk_mul_f32 v[80:81], v[80:81], v[116:117]
    v_pk_mul_f32 v[82:83], v[82:83], v[116:117]
    v_pk_mul_f32 v[84:85], v[84:85], v[116:117]
    v_pk_mul_f32 v[86:87], v[86:87], v[116:117]
    v_pk_mul_f32 v[88:89], v[88:89], v[116:117]
    v_pk_mul_f32 v[90:91], v[90:91], v[116:117]
    v_pk_mul_f32 v[92:93], v[92:93], v[116:117]
    v_pk_mul_f32 v[94:95], v[94:95], v[116:117]
    v_pk_mul_f32 v[96:97], v[96:97], v[116:117]
    v_pk_mul_f32 v[98:99], v[98:99], v[116:117]
    v_pk_mul_f32 v[100:101], v[100:101], v[116:117]
    v_pk_mul_f32 v[102:103], v[102:103], v[116:117]
    v_pk_mul_f32 v[104:105], v[104:105], v[116:117]
    v_pk_mul_f32 v[106:107], v[106:107], v[116:117]
    v_pk_mul_f32 v[108:109], v[108:109], v[116:117]
    v_pk_mul_f32 v[110:111], v[110:111], v[116:117]
    v_cvt_pk_bf16_f32 v64, v80, v81
    v_cvt_pk_bf16_f32 v65, v82, v83
    v_cvt_pk_bf16_f32 v66, v84, v85
    v_cvt_pk_bf16_f32 v67, v86, v87
    v_cvt_pk_bf16_f32 v68, v88, v89
    v_cvt_pk_bf16_f32 v69, v90, v91
    v_cvt_pk_bf16_f32 v70, v92, v93
    v_cvt_pk_bf16_f32 v71, v94, v95
    v_cvt_pk_bf16_f32 v72, v96, v97
    v_cvt_pk_bf16_f32 v73, v98, v99
    v_cvt_pk_bf16_f32 v74, v100, v101
    v_cvt_pk_bf16_f32 v75, v102, v103
    v_cvt_pk_bf16_f32 v76, v104, v105
    v_cvt_pk_bf16_f32 v77, v106, v107
    v_cvt_pk_bf16_f32 v78, v108, v109
    v_cvt_pk_bf16_f32 v79, v110, v111
    ds_write_b128 v54, v[64:67] offset:0
    ds_write_b128 v54, v[68:71] offset:512
    ds_write_b128 v54, v[72:75] offset:1024
    ds_write_b128 v54, v[76:79] offset:1536
    s_waitcnt vmcnt(16) lgkmcnt(0)
    s_barrier
    ds_read_b128 a[64:67], v55 offset:0
    ds_read_b128 a[68:71], v55 offset:128
    ds_read_b128 a[72:75], v55 offset:256
    ds_read_b128 a[76:79], v55 offset:384
    v_add_u32 v54, 4096, v36
    v_add_u32 v55, 4096, v37
    v_mfma_f32_32x32x16_bf16 v[64:79], v[56:59], v[56:59], 0
    v_mfma_f32_32x32x16_bf16 v[80:95], v[56:59], v[56:59], 0
    v_mfma_f32_32x32x16_bf16 v[96:111], v[56:59], v[56:59], 0
    v_mfma_f32_32x32x16_bf16 v[112:127], v[56:59], v[56:59], 0
    s_cmp_ge_u32 s2, 22
    s_cbranch_scc1 k12_nostat_5
    s_lshl_b32 s52, s2, 12
    s_add_u32 s52, s52, 0x3800000
    s_mov_b32 s34, -1
    v_lshlrev_b32 v6, 4, v0
    buffer_store_dwordx4 v[56:59], v6, s[32:35], s52 offen sc1
    s_mov_b32 s34, 0x2000000
k12_nostat_5:
    ds_read_b128 a[192:195], v26 offset:0
    ds_read_b64_tr_b16 a[0:1], v28 offset:0
    ds_read_b128 a[196:199], v27 offset:0
    ds_read_b64_tr_b16 a[2:3], v28 offset:2048
    ds_read_b128 a[200:203], v26 offset:2048
    ds_read_b64_tr_b16 a[4:5], v28 offset:16384
    ds_read_b128 a[204:207], v27 offset:2048
    ds_read_b64_tr_b16 a[6:7], v28 offset:18432
    ds_read_b128 a[208:211], v26 offset:4096
    ds_read_b64_tr_b16 a[8:9], v29 offset:0
    ds_read_b128 a[212:215], v27 offset:4096
    ds_read_b64_tr_b16 a[10:11], v29 offset:2048
    ds_read_b128 a[216:219], v26 offset:6144
    ds_read_b64_tr_b16 a[12:13], v29 offset:16384
    ds_read_b128 a[220:223], v27 offset:6144
    ds_read_b64_tr_b16 a[14:15], v29 offset:18432
    ds_read_b128 a[224:227], v26 offset:8192
    ds_read_b64_tr_b16 a[16:17], v30 offset:0
    ds_read_b128 a[228:231], v27 offset:8192
    ds_read_b64_tr_b16 a[18:19], v30 offset:2048
    ds_read_b128 a[232:235], v26 offset:10240
    ds_read_b64_tr_b16 a[20:21], v30 offset:16384
    ds_read_b128 a[236:239], v27 offset:10240
    ds_read_b64_tr_b16 a[22:23], v30 offset:18432
    ds_read_b128 a[240:243], v26 offset:12288
    ds_read_b64_tr_b16 a[24:25], v31 offset:0
    ds_read_b128 a[244:247], v27 offset:12288
    ds_read_b64_tr_b16 a[26:27], v31 offset:2048
    ds_read_b128 a[248:251], v26 offset:14336
    ds_read_b64_tr_b16 a[28:29], v31 offset:16384
    ds_read_b128 a[252:255], v27 offset:14336
    ds_read_b64_tr_b16 a[30:31], v31 offset:18432
    s_mov_b32 s51, 0
    s_waitcnt lgkmcnt(15)
    s_mov_b32 s52, 0
    buffer_store_dwordx4 a[64:67], v53, s[8:11], s52 offen sc1
    s_mov_b32 s52, 262144
    buffer_store_dwordx4 a[68:71], v53, s[8:11], s52 offen sc1
    s_mov_b32 s52, 524288
    buffer_store_dwordx4 a[72:75], v53, s[8:11], s52 offen sc1
    s_mov_b32 s52, 786432
    buffer_store_dwordx4 a[76:79], v53, s[8:11], s52 offen sc1
    s_waitcnt lgkmcnt(0)
    s_cmp_lg_u32 s57, 0
    s_cbranch_scc1 k12_v_6
k12_loop_8:
    v_mfma_f32_16x16x32_bf16 v[64:67], a[0:3], a[192:195], v[64:67]
    v_mfma_f32_16x16x32_bf16 v[64:67], a[4:7], a[196:199], v[64:67]
    ds_read_b64_tr_b16 a[32:33], v32 offset:0
    v_mfma_f32_16x16x32_bf16 v[80:83], a[0:3], a[200:203], v[80:83]
    v_mfma_f32_16x16x32_bf16 v[80:83], a[4:7], a[204:207], v[80:83]
    ds_read_b64_tr_b16 a[34:35], v32 offset:2048
    v_mfma_f32_16x16x32_bf16 v[96:99], a[0:3], a[208:211], v[96:99]
    s_cmp_eq_u32 s51, s46
    s_cbranch_scc1 k12_ool_10
k12_oolret_11:
    v_mfma_f32_16x16x32_bf16 v[96:99], a[4:7], a[212:215], v[96:99]
    v_mfma_f32_16x16x32_bf16 v[112:115], a[0:3], a[216:219], v[112:115]
    ds_read_b64_tr_b16 a[36:37], v32 offset:16384
    v_mfma_f32_16x16x32_bf16 v[112:115], a[4:7], a[220:223], v[112:115]
    v_mfma_f32_16x16x32_bf16 v[128:131], a[0:3], a[224:227], v[128:131]
    v_mfma_f32_16x16x32_bf16 v[128:131], a[4:7], a[228:231], v[128:131]
    ds_read_b64_tr_b16 a[38:39], v32 offset:18432
    v_mfma_f32_16x16x32_bf16 v[144:147], a[0:3], a[232:235], v[144:147]
    v_mfma_f32_16x16x32_bf16 v[144:147], a[4:7], a[236:239], v[144:147]
    v_mfma_f32_16x16x32_bf16 a[128:131], a[0:3], a[240:243], a[128:131]
    ds_read_b64_tr_b16 a[40:41], v33 offset:0
    v_mfma_f32_16x16x32_bf16 a[128:131], a[4:7], a[244:247], a[128:131]
    v_mfma_f32_16x16x32_bf16 a[160:163], a[0:3], a[248:251], a[160:163]
    v_mfma_f32_16x16x32_bf16 a[160:163], a[4:7], a[252:255], a[160:163]
    ds_read_b64_tr_b16 a[42:43], v33 offset:2048
    v_mfma_f32_16x16x32_bf16 v[160:163], a[8:11], a[192:195], v[160:163]
    v_mfma_f32_16x16x32_bf16 v[160:163], a[12:15], a[196:199], v[160:163]
    v_mfma_f32_16x16x32_bf16 v[176:179], a[8:11], a[200:203], v[176:179]
    ds_read_b64_tr_b16 a[44:45], v33 offset:16384
    v_mfma_f32_16x16x32_bf16 v[176:179], a[12:15], a[204:207], v[176:179]
    v_mfma_f32_16x16x32_bf16 v[192:195], a[8:11], a[208:211], v[192:195]
    v_mfma_f32_16x16x32_bf16 v[192:195], a[12:15], a[212:215], v[192:195]
    ds_read_b64_tr_b16 a[46:47], v33 offset:18432
    v_mfma_f32_16x16x32_bf16 v[208:211], a[8:11], a[216:219], v[208:211]
    v_mfma_f32_16x16x32_bf16 v[208:211], a[12:15], a[220:223], v[208:211]
    ds_read_b64_tr_b16 a[48:49], v34 offset:0
    v_mfma_f32_16x16x32_bf16 v[224:227], a[8:11], a[224:227], v[224:227]
    v_mfma_f32_16x16x32_bf16 v[224:227], a[12:15], a[228:231], v[224:227]
    v_mfma_f32_16x16x32_bf16 v[240:243], a[8:11], a[232:235], v[240:243]
    ds_read_b64_tr_b16 a[50:51], v34 offset:2048
    v_mfma_f32_16x16x32_bf16 v[240:243], a[12:15], a[236:239], v[240:243]
    v_mfma_f32_16x16x32_bf16 a[132:135], a[8:11], a[240:243], a[132:135]
    v_mfma_f32_16x16x32_bf16 a[132:135], a[12:15], a[244:247], a[132:135]
    ds_read_b64_tr_b16 a[52:53], v34 offset:16384
    v_mfma_f32_16x16x32_bf16 a[164:167], a[8:11], a[248:251], a[164:167]
    v_mfma_f32_16x16x32_bf16 a[164:167], a[12:15], a[252:255], a[164:167]
    v_mfma_f32_16x16x32_bf16 v[68:71], a[16:19], a[192:195], v[68:71]
    ds_read_b64_tr_b16 a[54:55], v34 offset:18432
    v_mfma_f32_16x16x32_bf16 v[68:71], a[20:23], a[196:199], v[68:71]
    v_mfma_f32_16x16x32_bf16 v[84:87], a[16:19], a[200:203], v[84:87]
    v_mfma_f32_16x16x32_bf16 v[84:87], a[20:23], a[204:207], v[84:87]
    ds_read_b64_tr_b16 a[56:57], v35 offset:0
    v_mfma_f32_16x16x32_bf16 v[100:103], a[16:19], a[208:211], v[100:103]
    v_mfma_f32_16x16x32_bf16 v[100:103], a[20:23], a[212:215], v[100:103]
    v_mfma_f32_16x16x32_bf16 v[116:119], a[16:19], a[216:219], v[116:119]
    ds_read_b64_tr_b16 a[58:59], v35 offset:2048
    v_mfma_f32_16x16x32_bf16 v[116:119], a[20:23], a[220:223], v[116:119]
    v_mfma_f32_16x16x32_bf16 v[132:135], a[16:19], a[224:227], v[132:135]
    v_mfma_f32_16x16x32_bf16 v[132:135], a[20:23], a[228:231], v[132:135]
    ds_read_b64_tr_b16 a[60:61], v35 offset:16384
    v_mfma_f32_16x16x32_bf16 v[148:151], a[16:19], a[232:235], v[148:151]
    v_mfma_f32_16x16x32_bf16 v[148:151], a[20:23], a[236:239], v[148:151]
    v_mfma_f32_16x16x32_bf16 a[136:139], a[16:19], a[240:243], a[136:139]
    ds_read_b64_tr_b16 a[62:63], v35 offset:18432
    v_mfma_f32_16x16x32_bf16 a[136:139], a[20:23], a[244:247], a[136:139]
    v_mfma_f32_16x16x32_bf16 a[168:171], a[16:19], a[248:251], a[168:171]
    v_mfma_f32_16x16x32_bf16 a[168:171], a[20:23], a[252:255], a[168:171]
    v_mfma_f32_16x16x32_bf16 v[164:167], a[24:27], a[192:195], v[164:167]
    v_mfma_f32_16x16x32_bf16 v[164:167], a[28:31], a[196:199], v[164:167]
    v_mfma_f32_16x16x32_bf16 v[180:183], a[24:27], a[200:203], v[180:183]
    v_mfma_f32_16x16x32_bf16 v[180:183], a[28:31], a[204:207], v[180:183]
    v_mfma_f32_16x16x32_bf16 v[196:199], a[24:27], a[208:211], v[196:199]
    v_mfma_f32_16x16x32_bf16 v[196:199], a[28:31], a[212:215], v[196:199]
    v_mfma_f32_16x16x32_bf16 v[212:215], a[24:27], a[216:219], v[212:215]
    v_mfma_f32_16x16x32_bf16 v[212:215], a[28:31], a[220:223], v[212:215]
    v_mfma_f32_16x16x32_bf16 v[228:231], a[24:27], a[224:227], v[228:231]
    v_mfma_f32_16x16x32_bf16 v[228:231], a[28:31], a[228:231], v[228:231]
    v_mfma_f32_16x16x32_bf16 v[244:247], a[24:27], a[232:235], v[244:247]
    v_mfma_f32_16x16x32_bf16 v[244:247], a[28:31], a[236:239], v[244:247]
    v_mfma_f32_16x16x32_bf16 a[140:143], a[24:27], a[240:243], a[140:143]
    v_mfma_f32_16x16x32_bf16 a[140:143], a[28:31], a[244:247], a[140:143]
    v_mfma_f32_16x16x32_bf16 a[172:175], a[24:27], a[248:251], a[172:175]
    v_mfma_f32_16x16x32_bf16 a[172:175], a[28:31], a[252:255], a[172:175]
    s_waitcnt vmcnt(0) lgkmcnt(0)
    s_cmp_eq_u32 s51, s46
    s_cbranch_scc1 k12_ool_14
k12_oolret_15:
    s_barrier
    v_mfma_f32_16x16x32_bf16 v[72:75], a[32:35], a[192:195], v[72:75]
    s_cmp_ge_u32 s49, 1024
    s_cselect_b32 s18, 0, s18
    s_cselect_b32 s22, 0, s22
    v_mfma_f32_16x16x32_bf16 v[72:75], a[36:39], a[196:199], v[72:75]
    s_add_u32 m0, s48, 0
    ds_read_b128 a[64:67], v26 offset:32768
    v_mfma_f32_16x16x32_bf16 v[88:91], a[32:35], a[200:203], v[88:91]
    buffer_load_dwordx4 v10, s[16:19], s49 offen offset:0 lds
    ds_read_b64_tr_b16 a[0:1], v28 offset:32768
    v_mfma_f32_16x16x32_bf16 v[88:91], a[36:39], a[204:207], v[88:91]
    ds_read_b128 a[68:71], v27 offset:32768
    v_mfma_f32_16x16x32_bf16 v[104:107], a[32:35], a[208:211], v[104:107]
    buffer_load_dwordx4 v11, s[16:19], s49 offen offset:1024 lds
    v_mfma_f32_16x16x32_bf16 v[104:107], a[36:39], a[212:215], v[104:107]
    ds_read_b64_tr_b16 a[2:3], v28 offset:34816
    v_mfma_f32_16x16x32_bf16 v[120:123], a[32:35], a[216:219], v[120:123]
    v_mfma_f32_16x16x32_bf16 v[120:123], a[36:39], a[220:223], v[120:123]
    ds_read_b128 a[72:75], v26 offset:34816
    v_mfma_f32_16x16x32_bf16 v[136:139], a[32:35], a[224:227], v[136:139]
    buffer_load_dwordx4 v12, s[16:19], s49 offen offset:2048 lds
    ds_read_b64_tr_b16 a[4:5], v28 offset:49152
    v_mfma_f32_16x16x32_bf16 v[136:139], a[36:39], a[228:231], v[136:139]
    v_mfma_f32_16x16x32_bf16 v[152:155], a[32:35], a[232:235], v[152:155]
    ds_read_b128 a[76:79], v27 offset:34816
    v_mfma_f32_16x16x32_bf16 v[152:155], a[36:39], a[236:239], v[152:155]
    buffer_load_dwordx4 v13, s[16:19], s49 offen offset:3072 lds
    v_mfma_f32_16x16x32_bf16 a[144:147], a[32:35], a[240:243], a[144:147]
    ds_read_b64_tr_b16 a[6:7], v28 offset:51200
    v_mfma_f32_16x16x32_bf16 a[144:147], a[36:39], a[244:247], a[144:147]
    s_add_u32 m0, s48, 4096
    ds_read_b128 a[80:83], v26 offset:36864
    v_mfma_f32_16x16x32_bf16 a[176:179], a[32:35], a[248:251], a[176:179]
    v_mfma_f32_16x16x32_bf16 a[176:179], a[36:39], a[252:255], a[176:179]
    buffer_load_dwordx4 v14, s[16:19], s49 offen offset:0 lds
    ds_read_b64_tr_b16 a[8:9], v29 offset:32768
    v_mfma_f32_16x16x32_bf16 v[168:171], a[40:43], a[192:195], v[168:171]
    v_mfma_f32_16x16x32_bf16 v[168:171], a[44:47], a[196:199], v[168:171]
    ds_read_b128 a[84:87], v27 offset:36864
    v_mfma_f32_16x16x32_bf16 v[184:187], a[40:43], a[200:203], v[184:187]
    buffer_load_dwordx4 v15, s[16:19], s49 offen offset:1024 lds
    ds_read_b64_tr_b16 a[10:11], v29 offset:34816
    v_mfma_f32_16x16x32_bf16 v[184:187], a[44:47], a[204:207], v[184:187]
    v_mfma_f32_16x16x32_bf16 v[200:203], a[40:43], a[208:211], v[200:203]
    ds_read_b128 a[88:91], v26 offset:38912
    v_mfma_f32_16x16x32_bf16 v[200:203], a[44:47], a[212:215], v[200:203]
    v_mfma_f32_16x16x32_bf16 v[216:219], a[40:43], a[216:219], v[216:219]
    buffer_load_dwordx4 v16, s[16:19], s49 offen offset:2048 lds
    ds_read_b64_tr_b16 a[12:13], v29 offset:49152
    v_mfma_f32_16x16x32_bf16 v[216:219], a[44:47], a[220:223], v[216:219]
    ds_read_b128 a[92:95], v27 offset:38912
    v_mfma_f32_16x16x32_bf16 v[232:235], a[40:43], a[224:227], v[232:235]
    v_mfma_f32_16x16x32_bf16 v[232:235], a[44:47], a[228:231], v[232:235]
    buffer_load_dwordx4 v17, s[16:19], s49 offen offset:3072 lds
    ds_read_b64_tr_b16 a[14:15], v29 offset:51200
    v_mfma_f32_16x16x32_bf16 v[248:251], a[40:43], a[232:235], v[248:251]
    ds_read_b128 a[96:99], v26 offset:40960
    v_mfma_f32_16x16x32_bf16 v[248:251], a[44:47], a[236:239], v[248:251]
    s_add_u32 s49, s49, 128
    v_mfma_f32_16x16x32_bf16 a[148:151], a[40:43], a[240:243], a[148:151]
    s_add_u32 m0, s48, 65536
    ds_read_b64_tr_b16 a[16:17], v30 offset:32768
    v_mfma_f32_16x16x32_bf16 a[148:151], a[44:47], a[244:247], a[148:151]
    buffer_load_dwordx4 v18, s[20:23], s50 offen offset:0 lds
    v_mfma_f32_16x16x32_bf16 a[180:183], a[40:43], a[248:251], a[180:183]
    ds_read_b128 a[100:103], v27 offset:40960
    v_mfma_f32_16x16x32_bf16 a[180:183], a[44:47], a[252:255], a[180:183]
    ds_read_b64_tr_b16 a[18:19], v30 offset:34816
    v_mfma_f32_16x16x32_bf16 v[76:79], a[48:51], a[192:195], v[76:79]
    buffer_load_dwordx4 v19, s[20:23], s50 offen offset:1024 lds
    v_mfma_f32_16x16x32_bf16 v[76:79], a[52:55], a[196:199], v[76:79]
    ds_read_b128 a[104:107], v26 offset:43008
    v_mfma_f32_16x16x32_bf16 v[92:95], a[48:51], a[200:203], v[92:95]
    v_mfma_f32_16x16x32_bf16 v[92:95], a[52:55], a[204:207], v[92:95]
    buffer_load_dwordx4 v20, s[20:23], s50 offen offset:2048 lds
    ds_read_b64_tr_b16 a[20:21], v30 offset:49152
    v_mfma_f32_16x16x32_bf16 v[108:111], a[48:51], a[208:211], v[108:111]
    ds_read_b128 a[108:111], v27 offset:43008
    v_mfma_f32_16x16x32_bf16 v[108:111], a[52:55], a[212:215], v[108:111]
    v_mfma_f32_16x16x32_bf16 v[124:127], a[48:51], a[216:219], v[124:127]
    ds_read_b64_tr_b16 a[22:23], v30 offset:51200
    v_mfma_f32_16x16x32_bf16 v[124:127], a[52:55], a[220:223], v[124:127]
    buffer_load_dwordx4 v21, s[20:23], s50 offen offset:3072 lds
    v_mfma_f32_16x16x32_bf16 v[140:143], a[48:51], a[224:227], v[140:143]
    s_add_u32 m0, s48, 69632
    ds_read_b128 a[112:115], v26 offset:45056
    v_mfma_f32_16x16x32_bf16 v[140:143], a[52:55], a[228:231], v[140:143]
    ds_read_b64_tr_b16 a[24:25], v31 offset:32768
    v_mfma_f32_16x16x32_bf16 v[156:159], a[48:51], a[232:235], v[156:159]
    buffer_load_dwordx4 v22, s[20:23], s50 offen offset:0 lds
    v_mfma_f32_16x16x32_bf16 v[156:159], a[52:55], a[236:239], v[156:159]
    ds_read_b128 a[116:119], v27 offset:45056
    v_mfma_f32_16x16x32_bf16 a[152:155], a[48:51], a[240:243], a[152:155]
    v_mfma_f32_16x16x32_bf16 a[152:155], a[52:55], a[244:247], a[152:155]
    ds_read_b64_tr_b16 a[26:27], v31 offset:34816
    v_mfma_f32_16x16x32_bf16 a[184:187], a[48:51], a[248:251], a[184:187]
    buffer_load_dwordx4 v23, s[20:23], s50 offen offset:1024 lds
    ds_read_b128 a[120:123], v26 offset:47104
    v_mfma_f32_16x16x32_bf16 a[184:187], a[52:55], a[252:255], a[184:187]
    v_mfma_f32_16x16x32_bf16 v[172:175], a[56:59], a[192:195], v[172:175]
    ds_read_b64_tr_b16 a[28:29], v31 offset:49152
    v_mfma_f32_16x16x32_bf16 v[172:175], a[60:63], a[196:199], v[172:175]
    buffer_load_dwordx4 v24, s[20:23], s50 offen offset:2048 lds
    v_mfma_f32_16x16x32_bf16 v[188:191], a[56:59], a[200:203], v[188:191]
    ds_read_b128 a[124:127], v27 offset:47104
    v_mfma_f32_16x16x32_bf16 v[188:191], a[60:63], a[204:207], v[188:191]
    ds_read_b64_tr_b16 a[30:31], v31 offset:51200
    v_mfma_f32_16x16x32_bf16 v[204:207], a[56:59], a[208:211], v[204:207]
    v_mfma_f32_16x16x32_bf16 v[204:207], a[60:63], a[212:215], v[204:207]
    buffer_load_dwordx4 v25, s[20:23], s50 offen offset:3072 lds
    v_mfma_f32_16x16x32_bf16 v[220:223], a[56:59], a[216:219], v[220:223]
    v_mfma_f32_16x16x32_bf16 v[220:223], a[60:63], a[220:223], v[220:223]
    s_add_u32 s50, s50, 0x80000
    v_mfma_f32_16x16x32_bf16 v[236:239], a[56:59], a[224:227], v[236:239]
    v_mfma_f32_16x16x32_bf16 v[236:239], a[60:63], a[228:231], v[236:239]
    s_cmp_eq_u32 s51, s53
    s_cbranch_scc1 k12_ool_16
k12_oolret_17:
    v_mfma_f32_16x16x32_bf16 v[252:255], a[56:59], a[232:235], v[252:255]
    s_cmp_eq_u32 s51, s63
    s_cbranch_scc1 k12_ool_18
k12_oolret_19:
    v_mfma_f32_16x16x32_bf16 v[252:255], a[60:63], a[236:239], v[252:255]
    s_cmp_eq_u32 s51, 6
    s_cbranch_scc1 k12_ool_20
k12_oolret_21:
    v_mfma_f32_16x16x32_bf16 a[156:159], a[56:59], a[240:243], a[156:159]
    v_mfma_f32_16x16x32_bf16 a[156:159], a[60:63], a[244:247], a[156:159]
    s_add_u32 s51, s51, 1
    v_mfma_f32_16x16x32_bf16 a[188:191], a[56:59], a[248:251], a[188:191]
    v_mfma_f32_16x16x32_bf16 a[188:191], a[60:63], a[252:255], a[188:191]
    s_waitcnt lgkmcnt(0)
    s_cmp_eq_u32 s51, 7
    s_cbranch_scc1 k12_last_9
    v_mfma_f32_16x16x32_bf16 v[64:67], a[0:3], a[64:67], v[64:67]
    v_mfma_f32_16x16x32_bf16 v[64:67], a[4:7], a[68:71], v[64:67]
    ds_read_b64_tr_b16 a[32:33], v32 offset:32768
    v_mfma_f32_16x16x32_bf16 v[80:83], a[0:3], a[72:75], v[80:83]
    v_mfma_f32_16x16x32_bf16 v[80:83], a[4:7], a[76:79], v[80:83]
    ds_read_b64_tr_b16 a[34:35], v32 offset:34816
    v_mfma_f32_16x16x32_bf16 v[96:99], a[0:3], a[80:83], v[96:99]
    v_mfma_f32_16x16x32_bf16 v[96:99], a[4:7], a[84:87], v[96:99]
    v_mfma_f32_16x16x32_bf16 v[112:115], a[0:3], a[88:91], v[112:115]
    ds_read_b64_tr_b16 a[36:37], v32 offset:49152
    v_mfma_f32_16x16x32_bf16 v[112:115], a[4:7], a[92:95], v[112:115]
    v_mfma_f32_16x16x32_bf16 v[128:131], a[0:3], a[96:99], v[128:131]
    v_mfma_f32_16x16x32_bf16 v[128:131], a[4:7], a[100:103], v[128:131]
    ds_read_b64_tr_b16 a[38:39], v32 offset:51200
    v_mfma_f32_16x16x32_bf16 v[144:147], a[0:3], a[104:107], v[144:147]
    v_mfma_f32_16x16x32_bf16 v[144:147], a[4:7], a[108:111], v[144:147]
    v_mfma_f32_16x16x32_bf16 a[128:131], a[0:3], a[112:115], a[128:131]
    ds_read_b64_tr_b16 a[40:41], v33 offset:32768
    v_mfma_f32_16x16x32_bf16 a[128:131], a[4:7], a[116:119], a[128:131]
    v_mfma_f32_16x16x32_bf16 a[160:163], a[0:3], a[120:123], a[160:163]
    v_mfma_f32_16x16x32_bf16 a[160:163], a[4:7], a[124:127], a[160:163]
    ds_read_b64_tr_b16 a[42:43], v33 offset:34816
    v_mfma_f32_16x16x32_bf16 v[160:163], a[8:11], a[64:67], v[160:163]
    v_mfma_f32_16x16x32_bf16 v[160:163], a[12:15], a[68:71], v[160:163]
    v_mfma_f32_16x16x32_bf16 v[176:179], a[8:11], a[72:75], v[176:179]
    ds_read_b64_tr_b16 a[44:45], v33 offset:49152
    v_mfma_f32_16x16x32_bf16 v[176:179], a[12:15], a[76:79], v[176:179]
    v_mfma_f32_16x16x32_bf16 v[192:195], a[8:11], a[80:83], v[192:195]
    v_mfma_f32_16x16x32_bf16 v[192:195], a[12:15], a[84:87], v[192:195]
    ds_read_b64_tr_b16 a[46:47], v33 offset:51200
    v_mfma_f32_16x16x32_bf16 v[208:211], a[8:11], a[88:91], v[208:211]
    v_mfma_f32_16x16x32_bf16 v[208:211], a[12:15], a[92:95], v[208:211]
    ds_read_b64_tr_b16 a[48:49], v34 offset:32768
    v_mfma_f32_16x16x32_bf16 v[224:227], a[8:11], a[96:99], v[224:227]
    v_mfma_f32_16x16x32_bf16 v[224:227], a[12:15], a[100:103], v[224:227]
    v_mfma_f32_16x16x32_bf16 v[240:243], a[8:11], a[104:107], v[240:243]
    ds_read_b64_tr_b16 a[50:51], v34 offset:34816
    v_mfma_f32_16x16x32_bf16 v[240:243], a[12:15], a[108:111], v[240:243]
    v_mfma_f32_16x16x32_bf16 a[132:135], a[8:11], a[112:115], a[132:135]
    v_mfma_f32_16x16x32_bf16 a[132:135], a[12:15], a[116:119], a[132:135]
    ds_read_b64_tr_b16 a[52:53], v34 offset:49152
    v_mfma_f32_16x16x32_bf16 a[164:167], a[8:11], a[120:123], a[164:167]
    v_mfma_f32_16x16x32_bf16 a[164:167], a[12:15], a[124:127], a[164:167]
    v_mfma_f32_16x16x32_bf16 v[68:71], a[16:19], a[64:67], v[68:71]
    ds_read_b64_tr_b16 a[54:55], v34 offset:51200
    v_mfma_f32_16x16x32_bf16 v[68:71], a[20:23], a[68:71], v[68:71]
    v_mfma_f32_16x16x32_bf16 v[84:87], a[16:19], a[72:75], v[84:87]
    v_mfma_f32_16x16x32_bf16 v[84:87], a[20:23], a[76:79], v[84:87]
    ds_read_b64_tr_b16 a[56:57], v35 offset:32768
    v_mfma_f32_16x16x32_bf16 v[100:103], a[16:19], a[80:83], v[100:103]
    v_mfma_f32_16x16x32_bf16 v[100:103], a[20:23], a[84:87], v[100:103]
    v_mfma_f32_16x16x32_bf16 v[116:119], a[16:19], a[88:91], v[116:119]
    ds_read_b64_tr_b16 a[58:59], v35 offset:34816
    v_mfma_f32_16x16x32_bf16 v[116:119], a[20:23], a[92:95], v[116:119]
    v_mfma_f32_16x16x32_bf16 v[132:135], a[16:19], a[96:99], v[132:135]
    v_mfma_f32_16x16x32_bf16 v[132:135], a[20:23], a[100:103], v[132:135]
    ds_read_b64_tr_b16 a[60:61], v35 offset:49152
    v_mfma_f32_16x16x32_bf16 v[148:151], a[16:19], a[104:107], v[148:151]
    v_mfma_f32_16x16x32_bf16 v[148:151], a[20:23], a[108:111], v[148:151]
    v_mfma_f32_16x16x32_bf16 a[136:139], a[16:19], a[112:115], a[136:139]
    ds_read_b64_tr_b16 a[62:63], v35 offset:51200
    v_mfma_f32_16x16x32_bf16 a[136:139], a[20:23], a[116:119], a[136:139]
    v_mfma_f32_16x16x32_bf16 a[168:171], a[16:19], a[120:123], a[168:171]
    v_mfma_f32_16x16x32_bf16 a[168:171], a[20:23], a[124:127], a[168:171]
    v_mfma_f32_16x16x32_bf16 v[164:167], a[24:27], a[64:67], v[164:167]
    v_mfma_f32_16x16x32_bf16 v[164:167], a[28:31], a[68:71], v[164:167]
    v_mfma_f32_16x16x32_bf16 v[180:183], a[24:27], a[72:75], v[180:183]
    v_mfma_f32_16x16x32_bf16 v[180:183], a[28:31], a[76:79], v[180:183]
    v_mfma_f32_16x16x32_bf16 v[196:199], a[24:27], a[80:83], v[196:199]
    v_mfma_f32_16x16x32_bf16 v[196:199], a[28:31], a[84:87], v[196:199]
    v_mfma_f32_16x16x32_bf16 v[212:215], a[24:27], a[88:91], v[212:215]
    v_mfma_f32_16x16x32_bf16 v[212:215], a[28:31], a[92:95], v[212:215]
    v_mfma_f32_16x16x32_bf16 v[228:231], a[24:27], a[96:99], v[228:231]
    v_mfma_f32_16x16x32_bf16 v[228:231], a[28:31], a[100:103], v[228:231]
    v_mfma_f32_16x16x32_bf16 v[244:247], a[24:27], a[104:107], v[244:247]
    v_mfma_f32_16x16x32_bf16 v[244:247], a[28:31], a[108:111], v[244:247]
    v_mfma_f32_16x16x32_bf16 a[140:143], a[24:27], a[112:115], a[140:143]
    v_mfma_f32_16x16x32_bf16 a[140:143], a[28:31], a[116:119], a[140:143]
    v_mfma_f32_16x16x32_bf16 a[172:175], a[24:27], a[120:123], a[172:175]
    v_mfma_f32_16x16x32_bf16 a[172:175], a[28:31], a[124:127], a[172:175]
    s_waitcnt vmcnt(0) lgkmcnt(0)
    s_barrier
    v_mfma_f32_16x16x32_bf16 v[72:75], a[32:35], a[64:67], v[72:75]
    v_mfma_f32_16x16x32_bf16 v[72:75], a[36:39], a[68:71], v[72:75]
    s_add_u32 m0, s48, 32768
    ds_read_b128 a[192:195], v26 offset:0
    v_mfma_f32_16x16x32_bf16 v[88:91], a[32:35], a[72:75], v[88:91]
    buffer_load_dwordx4 v10, s[16:19], s49 offen offset:0 lds
    ds_read_b64_tr_b16 a[0:1], v28 offset:0
    v_mfma_f32_16x16x32_bf16 v[88:91], a[36:39], a[76:79], v[88:91]
    ds_read_b128 a[196:199], v27 offset:0
    v_mfma_f32_16x16x32_bf16 v[104:107], a[32:35], a[80:83], v[104:107]
    buffer_load_dwordx4 v11, s[16:19], s49 offen offset:1024 lds
    v_mfma_f32_16x16x32_bf16 v[104:107], a[36:39], a[84:87], v[104:107]
    ds_read_b64_tr_b16 a[2:3], v28 offset:2048
    v_mfma_f32_16x16x32_bf16 v[120:123], a[32:35], a[88:91], v[120:123]
    v_mfma_f32_16x16x32_bf16 v[120:123], a[36:39], a[92:95], v[120:123]
    ds_read_b128 a[200:203], v26 offset:2048
    v_mfma_f32_16x16x32_bf16 v[136:139], a[32:35], a[96:99], v[136:139]
    buffer_load_dwordx4 v12, s[16:19], s49 offen offset:2048 lds
    ds_read_b64_tr_b16 a[4:5], v28 offset:16384
    v_mfma_f32_16x16x32_bf16 v[136:139], a[36:39], a[100:103], v[136:139]
    v_mfma_f32_16x16x32_bf16 v[152:155], a[32:35], a[104:107], v[152:155]
    ds_read_b128 a[204:207], v27 offset:2048
    v_mfma_f32_16x16x32_bf16 v[152:155], a[36:39], a[108:111], v[152:155]
    buffer_load_dwordx4 v13, s[16:19], s49 offen offset:3072 lds
    v_mfma_f32_16x16x32_bf16 a[144:147], a[32:35], a[112:115], a[144:147]
    ds_read_b64_tr_b16 a[6:7], v28 offset:18432
    v_mfma_f32_16x16x32_bf16 a[144:147], a[36:39], a[116:119], a[144:147]
    s_add_u32 m0, s48, 36864
    ds_read_b128 a[208:211], v26 offset:4096
    v_mfma_f32_16x16x32_bf16 a[176:179], a[32:35], a[120:123], a[176:179]
    v_mfma_f32_16x16x32_bf16 a[176:179], a[36:39], a[124:127], a[176:179]
    buffer_load_dwordx4 v14, s[16:19], s49 offen offset:0 lds
    ds_read_b64_tr_b16 a[8:9], v29 offset:0
    v_mfma_f32_16x16x32_bf16 v[168:171], a[40:43], a[64:67], v[168:171]
    v_mfma_f32_16x16x32_bf16 v[168:171], a[44:47], a[68:71], v[168:171]
    ds_read_b128 a[212:215], v27 offset:4096
    v_mfma_f32_16x16x32_bf16 v[184:187], a[40:43], a[72:75], v[184:187]
    buffer_load_dwordx4 v15, s[16:19], s49 offen offset:1024 lds
    ds_read_b64_tr_b16 a[10:11], v29 offset:2048
    v_mfma_f32_16x16x32_bf16 v[184:187], a[44:47], a[76:79], v[184:187]
    v_mfma_f32_16x16x32_bf16 v[200:203], a[40:43], a[80:83], v[200:203]
    ds_read_b128 a[216:219], v26 offset:6144
    v_mfma_f32_16x16x32_bf16 v[200:203], a[44:47], a[84:87], v[200:203]
    v_mfma_f32_16x16x32_bf16 v[216:219], a[40:43], a[88:91], v[216:219]
    buffer_load_dwordx4 v16, s[16:19], s49 offen offset:2048 lds
    ds_read_b64_tr_b16 a[12:13], v29 offset:16384
    v_mfma_f32_16x16x32_bf16 v[216:219], a[44:47], a[92:95], v[216:219]
    ds_read_b128 a[220:223], v27 offset:6144
    v_mfma_f32_16x16x32_bf16 v[232:235], a[40:43], a[96:99], v[232:235]
    v_mfma_f32_16x16x32_bf16 v[232:235], a[44:47], a[100:103], v[232:235]
    buffer_load_dwordx4 v17, s[16:19], s49 offen offset:3072 lds
    ds_read_b64_tr_b16 a[14:15], v29 offset:18432
    v_mfma_f32_16x16x32_bf16 v[248:251], a[40:43], a[104:107], v[248:251]
    ds_read_b128 a[224:227], v26 offset:8192
    v_mfma_f32_16x16x32_bf16 v[248:251], a[44:47], a[108:111], v[248:251]
    s_add_u32 s49, s49, 128
    v_mfma_f32_16x16x32_bf16 a[148:151], a[40:43], a[112:115], a[148:151]
    s_add_u32 m0, s48, 98304
    ds_read_b64_tr_b16 a[16:17], v30 offset:0
    v_mfma_f32_16x16x32_bf16 a[148:151], a[44:47], a[116:119], a[148:151]
    buffer_load_dwordx4 v18, s[20:23], s50 offen offset:0 lds
    v_mfma_f32_16x16x32_bf16 a[180:183], a[40:43], a[120:123], a[180:183]
    ds_read_b128 a[228:231], v27 offset:8192
    v_mfma_f32_16x16x32_bf16 a[180:183], a[44:47], a[124:127], a[180:183]
    ds_read_b64_tr_b16 a[18:19], v30 offset:2048
    v_mfma_f32_16x16x32_bf16 v[76:79], a[48:51], a[64:67], v[76:79]
    buffer_load_dwordx4 v19, s[20:23], s50 offen offset:1024 lds
    v_mfma_f32_16x16x32_bf16 v[76:79], a[52:55], a[68:71], v[76:79]
    ds_read_b128 a[232:235], v26 offset:10240
    v_mfma_f32_16x16x32_bf16 v[92:95], a[48:51], a[72:75], v[92:95]
    v_mfma_f32_16x16x32_bf16 v[92:95], a[52:55], a[76:79], v[92:95]
    buffer_load_dwordx4 v20, s[20:23], s50 offen offset:2048 lds
    ds_read_b64_tr_b16 a[20:21], v30 offset:16384
    v_mfma_f32_16x16x32_bf16 v[108:111], a[48:51], a[80:83], v[108:111]
    ds_read_b128 a[236:239], v27 offset:10240
    v_mfma_f32_16x16x32_bf16 v[108:111], a[52:55], a[84:87], v[108:111]
    v_mfma_f32_16x16x32_bf16 v[124:127], a[48:51], a[88:91], v[124:127]
    ds_read_b64_tr_b16 a[22:23], v30 offset:18432
    v_mfma_f32_16x16x32_bf16 v[124:127], a[52:55], a[92:95], v[124:127]
    buffer_load_dwordx4 v21, s[20:23], s50 offen offset:3072 lds
    v_mfma_f32_16x16x32_bf16 v[140:143], a[48:51], a[96:99], v[140:143]
    s_add_u32 m0, s48, 102400
    ds_read_b128 a[240:243], v26 offset:12288
    v_mfma_f32_16x16x32_bf16 v[140:143], a[52:55], a[100:103], v[140:143]
    ds_read_b64_tr_b16 a[24:25], v31 offset:0
    v_mfma_f32_16x16x32_bf16 v[156:159], a[48:51], a[104:107], v[156:159]
    buffer_load_dwordx4 v22, s[20:23], s50 offen offset:0 lds
    v_mfma_f32_16x16x32_bf16 v[156:159], a[52:55], a[108:111], v[156:159]
    ds_read_b128 a[244:247], v27 offset:12288
    v_mfma_f32_16x16x32_bf16 a[152:155], a[48:51], a[112:115], a[152:155]
    v_mfma_f32_16x16x32_bf16 a[152:155], a[52:55], a[116:119], a[152:155]
    ds_read_b64_tr_b16 a[26:27], v31 offset:2048
    v_mfma_f32_16x16x32_bf16 a[184:187], a[48:51], a[120:123], a[184:187]
    buffer_load_dwordx4 v23, s[20:23], s50 offen offset:1024 lds
    ds_read_b128 a[248:251], v26 offset:14336
    v_mfma_f32_16x16x32_bf16 a[184:187], a[52:55], a[124:127], a[184:187]
    v_mfma_f32_16x16x32_bf16 v[172:175], a[56:59], a[64:67], v[172:175]
    ds_read_b64_tr_b16 a[28:29], v31 offset:16384
    v_mfma_f32_16x16x32_bf16 v[172:175], a[60:63], a[68:71], v[172:175]
    buffer_load_dwordx4 v24, s[20:23], s50 offen offset:2048 lds
    v_mfma_f32_16x16x32_bf16 v[188:191], a[56:59], a[72:75], v[188:191]
    ds_read_b128 a[252:255], v27 offset:14336
    v_mfma_f32_16x16x32_bf16 v[188:191], a[60:63], a[76:79], v[188:191]
    ds_read_b64_tr_b16 a[30:31], v31 offset:18432
    v_mfma_f32_16x16x32_bf16 v[204:207], a[56:59], a[80:83], v[204:207]
    v_mfma_f32_16x16x32_bf16 v[204:207], a[60:63], a[84:87], v[204:207]
    buffer_load_dwordx4 v25, s[20:23], s50 offen offset:3072 lds
    v_mfma_f32_16x16x32_bf16 v[220:223], a[56:59], a[88:91], v[220:223]
    v_mfma_f32_16x16x32_bf16 v[220:223], a[60:63], a[92:95], v[220:223]
    s_add_u32 s50, s50, 0x80000
    v_mfma_f32_16x16x32_bf16 v[236:239], a[56:59], a[96:99], v[236:239]
    v_mfma_f32_16x16x32_bf16 v[236:239], a[60:63], a[100:103], v[236:239]
    s_cmp_eq_u32 s51, s53
    s_cbranch_scc1 k12_ool_22
k12_oolret_23:
    v_mfma_f32_16x16x32_bf16 v[252:255], a[56:59], a[104:107], v[252:255]
    s_cmp_eq_u32 s51, s63
    s_cbranch_scc1 k12_ool_24
k12_oolret_25:
    v_mfma_f32_16x16x32_bf16 v[252:255], a[60:63], a[108:111], v[252:255]
    s_cmp_eq_u32 s51, 5
    s_cbranch_scc1 k12_ool_26
k12_oolret_27:
    v_mfma_f32_16x16x32_bf16 a[156:159], a[56:59], a[112:115], a[156:159]
    v_mfma_f32_16x16x32_bf16 a[156:159], a[60:63], a[116:119], a[156:159]
    s_add_u32 s51, s51, 1
    v_mfma_f32_16x16x32_bf16 a[188:191], a[56:59], a[120:123], a[188:191]
    v_mfma_f32_16x16x32_bf16 a[188:191], a[60:63], a[124:127], a[188:191]
    s_waitcnt lgkmcnt(0)
    s_branch k12_loop_8
k12_last_9:
    v_mfma_f32_16x16x32_bf16 v[64:67], a[0:3], a[64:67], v[64:67]
    buffer_load_dwordx4 a[192:195], v36, s[8:11], s62 offen sc1
    v_mfma_f32_16x16x32_bf16 v[64:67], a[4:7], a[68:71], v[64:67]
    ds_read_b64_tr_b16 a[32:33], v32 offset:32768
    v_mfma_f32_16x16x32_bf16 v[160:163], a[8:11], a[64:67], v[160:163]
    buffer_load_dwordx4 a[196:199], v54, s[8:11], s62 offen sc1
    ds_read_b64_tr_b16 a[34:35], v32 offset:34816
    v_mfma_f32_16x16x32_bf16 v[160:163], a[12:15], a[68:71], v[160:163]
    v_mfma_f32_16x16x32_bf16 v[80:83], a[0:3], a[72:75], v[80:83]
    buffer_load_dwordx4 a[200:203], v37, s[8:11], s62 offen sc1
    v_mfma_f32_16x16x32_bf16 v[80:83], a[4:7], a[76:79], v[80:83]
    ds_read_b64_tr_b16 a[36:37], v32 offset:49152
    v_mfma_f32_16x16x32_bf16 v[176:179], a[8:11], a[72:75], v[176:179]
    buffer_load_dwordx4 a[204:207], v55, s[8:11], s62 offen sc1
    v_mfma_f32_16x16x32_bf16 v[176:179], a[12:15], a[76:79], v[176:179]
    s_add_u32 s62, s62, 0x20000
    buffer_load_dwordx4 a[208:211], v36, s[8:11], s62 offen sc1
    ds_read_b64_tr_b16 a[38:39], v32 offset:51200
    v_mfma_f32_16x16x32_bf16 v[96:99], a[0:3], a[80:83], v[96:99]
    v_mfma_f32_16x16x32_bf16 v[96:99], a[4:7], a[84:87], v[96:99]
    v_cvt_pk_bf16_f32 v64, v64, v65
    v_cvt_pk_bf16_f32 v65, v66, v67
    v_mfma_f32_16x16x32_bf16 v[192:195], a[8:11], a[80:83], v[192:195]
    v_cvt_pk_bf16_f32 v66, v160, v161
    v_cvt_pk_bf16_f32 v67, v162, v163
    v_mfma_f32_16x16x32_bf16 v[192:195], a[12:15], a[84:87], v[192:195]
    buffer_load_dwordx4 a[212:215], v54, s[8:11], s62 offen sc1
    ds_read_b64_tr_b16 a[40:41], v33 offset:32768
    v_mfma_f32_16x16x32_bf16 v[112:115], a[0:3], a[88:91], v[112:115]
    buffer_load_dwordx4 a[216:219], v37, s[8:11], s62 offen sc1
    ds_read_b64_tr_b16 a[42:43], v33 offset:34816
    v_mfma_f32_16x16x32_bf16 v[112:115], a[4:7], a[92:95], v[112:115]
    v_cvt_pk_bf16_f32 v80, v80, v81
    v_cvt_pk_bf16_f32 v81, v82, v83
    v_mfma_f32_16x16x32_bf16 v[208:211], a[8:11], a[88:91], v[208:211]
    v_cvt_pk_bf16_f32 v82, v176, v177
    v_cvt_pk_bf16_f32 v83, v178, v179
    v_mfma_f32_16x16x32_bf16 v[208:211], a[12:15], a[92:95], v[208:211]
    buffer_load_dwordx4 a[220:223], v55, s[8:11], s62 offen sc1
    ds_read_b64_tr_b16 a[44:45], v33 offset:49152
    v_mfma_f32_16x16x32_bf16 v[128:131], a[0:3], a[96:99], v[128:131]
    s_add_u32 s62, s62, 0x20000
    buffer_load_dwordx4 a[224:227], v36, s[8:11], s62 offen sc1
    v_mfma_f32_16x16x32_bf16 v[128:131], a[4:7], a[100:103], v[128:131]
    v_cvt_pk_bf16_f32 v96, v96, v97
    v_cvt_pk_bf16_f32 v97, v98, v99
    v_mfma_f32_16x16x32_bf16 v[224:227], a[8:11], a[96:99], v[224:227]
    buffer_load_dwordx4 a[228:231], v54, s[8:11], s62 offen sc1
    ds_read_b64_tr_b16 a[46:47], v33 offset:51200
    v_mfma_f32_16x16x32_bf16 v[224:227], a[12:15], a[100:103], v[224:227]
    v_cvt_pk_bf16_f32 v98, v192, v193
    v_cvt_pk_bf16_f32 v99, v194, v195
    v_mfma_f32_16x16x32_bf16 v[144:147], a[0:3], a[104:107], v[144:147]
    buffer_load_dwordx4 a[232:235], v37, s[8:11], s62 offen sc1
    ds_read_b64_tr_b16 a[48:49], v34 offset:32768
    v_mfma_f32_16x16x32_bf16 v[144:147], a[4:7], a[108:111], v[144:147]
    v_cvt_pk_bf16_f32 v112, v112, v113
    v_cvt_pk_bf16_f32 v113, v114, v115
    v_mfma_f32_16x16x32_bf16 v[240:243], a[8:11], a[104:107], v[240:243]
    buffer_load_dwordx4 a[236:239], v55, s[8:11], s62 offen sc1
    ds_read_b64_tr_b16 a[50:51], v34 offset:34816
    v_mfma_f32_16x16x32_bf16 v[240:243], a[12:15], a[108:111], v[240:243]
    s_add_u32 s62, s62, 0x20000
    v_cvt_pk_bf16_f32 v114, v208, v209
    v_cvt_pk_bf16_f32 v115, v210, v211
    v_mfma_f32_16x16x32_bf16 a[128:131], a[0:3], a[112:115], a[128:131]
    buffer_load_dwordx4 a[240:243], v36, s[8:11], s62 offen sc1
    ds_read_b64_tr_b16 a[52:53], v34 offset:49152
    v_mfma_f32_16x16x32_bf16 a[128:131], a[4:7], a[116:119], a[128:131]
    v_cvt_pk_bf16_f32 v128, v128, v129
    v_cvt_pk_bf16_f32 v129, v130, v131
    v_mfma_f32_16x16x32_bf16 a[132:135], a[8:11], a[112:115], a[132:135]
    buffer_load_dwordx4 a[244:247], v54, s[8:11], s62 offen sc1
    buffer_load_dwordx4 a[248:251], v37, s[8:11], s62 offen sc1
    v_mfma_f32_16x16x32_bf16 a[132:135], a[12:15], a[116:119], a[132:135]
    v_cvt_pk_bf16_f32 v130, v224, v225
    v_cvt_pk_bf16_f32 v131, v226, v227
    v_mfma_f32_16x16x32_bf16 a[160:163], a[0:3], a[120:123], a[160:163]
    buffer_load_dwordx4 a[252:255], v55, s[8:11], s62 offen sc1
    ds_read_b64_tr_b16 a[54:55], v34 offset:51200
    v_mfma_f32_16x16x32_bf16 a[160:163], a[4:7], a[124:127], a[160:163]
    s_add_u32 s62, s62, 0x20000
    v_cvt_pk_bf16_f32 v144, v144, v145
    v_cvt_pk_bf16_f32 v145, v146, v147
    v_mfma_f32_16x16x32_bf16 a[164:167], a[8:11], a[120:123], a[164:167]
    ds_read_b64_tr_b16 a[56:57], v35 offset:32768
    v_cvt_pk_bf16_f32 v146, v240, v241
    v_mfma_f32_16x16x32_bf16 a[164:167], a[12:15], a[124:127], a[164:167]
    v_cvt_pk_bf16_f32 v147, v242, v243
    v_mfma_f32_16x16x32_bf16 v[68:71], a[16:19], a[64:67], v[68:71]
    s_add_u32 s52, s47, 0
    ds_read_b64_tr_b16 a[58:59], v35 offset:34816
    v_mfma_f32_16x16x32_bf16 v[68:71], a[20:23], a[68:71], v[68:71]
    v_accvgpr_read_b32 v56, a128
    v_accvgpr_read_b32 v57, a129
    v_mfma_f32_16x16x32_bf16 v[164:167], a[24:27], a[64:67], v[164:167]
    v_accvgpr_read_b32 v58, a130
    v_accvgpr_read_b32 v59, a131
    v_mfma_f32_16x16x32_bf16 v[164:167], a[28:31], a[68:71], v[164:167]
    buffer_store_dwordx4 v[64:67], v1, s[32:35], s52 offen offset:0 sc1
    ds_read_b64_tr_b16 a[60:61], v35 offset:49152
    v_mfma_f32_16x16x32_bf16 v[84:87], a[16:19], a[72:75], v[84:87]
    v_accvgpr_read_b32 v60, a132
    v_accvgpr_read_b32 v61, a133
    v_mfma_f32_16x16x32_bf16 v[84:87], a[20:23], a[76:79], v[84:87]
    v_accvgpr_read_b32 v62, a134
    v_accvgpr_read_b32 v63, a135
    v_mfma_f32_16x16x32_bf16 v[180:183], a[24:27], a[72:75], v[180:183]
    v_cvt_pk_bf16_f32 v160, v56, v57
    v_cvt_pk_bf16_f32 v161, v58, v59
    v_mfma_f32_16x16x32_bf16 v[180:183], a[28:31], a[76:79], v[180:183]
    ds_read_b64_tr_b16 a[62:63], v35 offset:51200
    v_cvt_pk_bf16_f32 v162, v60, v61
    v_mfma_f32_16x16x32_bf16 v[100:103], a[16:19], a[80:83], v[100:103]
    v_cvt_pk_bf16_f32 v163, v62, v63
    v_accvgpr_read_b32 v56, a160
    v_mfma_f32_16x16x32_bf16 v[100:103], a[20:23], a[84:87], v[100:103]
    v_accvgpr_read_b32 v57, a161
    v_accvgpr_read_b32 v58, a162
    v_mfma_f32_16x16x32_bf16 v[196:199], a[24:27], a[80:83], v[196:199]
    v_accvgpr_read_b32 v59, a163
    v_accvgpr_read_b32 v60, a164
    v_mfma_f32_16x16x32_bf16 v[196:199], a[28:31], a[84:87], v[196:199]
    s_add_u32 s52, s47, 8192
    v_accvgpr_read_b32 v61, a165
    v_accvgpr_read_b32 v62, a166
    v_mfma_f32_16x16x32_bf16 v[116:119], a[16:19], a[88:91], v[116:119]
    v_accvgpr_read_b32 v63, a167
    v_cvt_pk_bf16_f32 v176, v56, v57
    v_mfma_f32_16x16x32_bf16 v[116:119], a[20:23], a[92:95], v[116:119]
    v_cvt_pk_bf16_f32 v177, v58, v59
    v_cvt_pk_bf16_f32 v68, v68, v69
    v_mfma_f32_16x16x32_bf16 v[212:215], a[24:27], a[88:91], v[212:215]
    v_cvt_pk_bf16_f32 v178, v60, v61
    v_cvt_pk_bf16_f32 v69, v70, v71
    v_mfma_f32_16x16x32_bf16 v[212:215], a[28:31], a[92:95], v[212:215]
    v_cvt_pk_bf16_f32 v179, v62, v63
    v_cvt_pk_bf16_f32 v70, v164, v165
    v_mfma_f32_16x16x32_bf16 v[132:135], a[16:19], a[96:99], v[132:135]
    v_cvt_pk_bf16_f32 v71, v166, v167
    v_cvt_pk_bf16_f32 v84, v84, v85
    v_mfma_f32_16x16x32_bf16 v[132:135], a[20:23], a[100:103], v[132:135]
    buffer_store_dwordx4 v[96:99], v1, s[32:35], s52 offen offset:0 sc1
    v_cvt_pk_bf16_f32 v85, v86, v87
    v_mfma_f32_16x16x32_bf16 v[228:231], a[24:27], a[96:99], v[228:231]
    v_cvt_pk_bf16_f32 v86, v180, v181
    v_cvt_pk_bf16_f32 v87, v182, v183
    v_mfma_f32_16x16x32_bf16 v[228:231], a[28:31], a[100:103], v[228:231]
    v_cvt_pk_bf16_f32 v100, v100, v101
    v_cvt_pk_bf16_f32 v101, v102, v103
    v_mfma_f32_16x16x32_bf16 v[148:151], a[16:19], a[104:107], v[148:151]
    v_cvt_pk_bf16_f32 v102, v196, v197
    v_cvt_pk_bf16_f32 v103, v198, v199
    v_mfma_f32_16x16x32_bf16 v[148:151], a[20:23], a[108:111], v[148:151]
    v_cvt_pk_bf16_f32 v116, v116, v117
    v_cvt_pk_bf16_f32 v117, v118, v119
    v_mfma_f32_16x16x32_bf16 v[244:247], a[24:27], a[104:107], v[244:247]
    v_cvt_pk_bf16_f32 v118, v212, v213
    v_cvt_pk_bf16_f32 v119, v214, v215
    v_mfma_f32_16x16x32_bf16 v[244:247], a[28:31], a[108:111], v[244:247]
    s_add_u32 s52, s47, 524288
    v_mfma_f32_16x16x32_bf16 a[136:139], a[16:19], a[112:115], a[136:139]
    buffer_store_dwordx4 v[128:131], v1, s[32:35], s52 offen offset:0 sc1
    v_mfma_f32_16x16x32_bf16 a[136:139], a[20:23], a[116:119], a[136:139]
    v_cvt_pk_bf16_f32 v132, v132, v133
    v_cvt_pk_bf16_f32 v133, v134, v135
    v_mfma_f32_16x16x32_bf16 a[140:143], a[24:27], a[112:115], a[140:143]
    v_cvt_pk_bf16_f32 v134, v228, v229
    v_cvt_pk_bf16_f32 v135, v230, v231
    v_mfma_f32_16x16x32_bf16 a[140:143], a[28:31], a[116:119], a[140:143]
    v_mfma_f32_16x16x32_bf16 a[168:171], a[16:19], a[120:123], a[168:171]
    s_waitcnt lgkmcnt(0)
    v_mfma_f32_16x16x32_bf16 a[168:171], a[20:23], a[124:127], a[168:171]
    v_cvt_pk_bf16_f32 v148, v148, v149
    v_cvt_pk_bf16_f32 v149, v150, v151
    v_mfma_f32_16x16x32_bf16 a[172:175], a[24:27], a[120:123], a[172:175]
    v_cvt_pk_bf16_f32 v150, v244, v245
    v_cvt_pk_bf16_f32 v151, v246, v247
    v_mfma_f32_16x16x32_bf16 a[172:175], a[28:31], a[124:127], a[172:175]
    v_mfma_f32_16x16x32_bf16 v[72:75], a[32:35], a[64:67], v[72:75]
    v_mfma_f32_16x16x32_bf16 v[72:75], a[36:39], a[68:71], v[72:75]
    v_accvgpr_read_b32 v56, a136
    v_accvgpr_read_b32 v57, a137
    v_mfma_f32_16x16x32_bf16 v[168:171], a[40:43], a[64:67], v[168:171]
    s_add_u32 s52, s47, 532480
    v_accvgpr_read_b32 v58, a138
    v_accvgpr_read_b32 v59, a139
    v_mfma_f32_16x16x32_bf16 v[168:171], a[44:47], a[68:71], v[168:171]
    v_accvgpr_read_b32 v60, a140
    v_accvgpr_read_b32 v61, a141
    v_mfma_f32_16x16x32_bf16 v[88:91], a[32:35], a[72:75], v[88:91]
    v_accvgpr_read_b32 v62, a142
    v_accvgpr_read_b32 v63, a143
    v_mfma_f32_16x16x32_bf16 v[88:91], a[36:39], a[76:79], v[88:91]
    v_cvt_pk_bf16_f32 v164, v56, v57
    v_cvt_pk_bf16_f32 v165, v58, v59
    v_mfma_f32_16x16x32_bf16 v[184:187], a[40:43], a[72:75], v[184:187]
    buffer_store_dwordx4 v[160:163], v1, s[32:35], s52 offen offset:0 sc1
    v_mfma_f32_16x16x32_bf16 v[184:187], a[44:47], a[76:79], v[184:187]
    v_cvt_pk_bf16_f32 v166, v60, v61
    v_cvt_pk_bf16_f32 v167, v62, v63
    v_mfma_f32_16x16x32_bf16 v[104:107], a[32:35], a[80:83], v[104:107]
    v_accvgpr_read_b32 v56, a168
    v_accvgpr_read_b32 v57, a169
    v_mfma_f32_16x16x32_bf16 v[104:107], a[36:39], a[84:87], v[104:107]
    v_accvgpr_read_b32 v58, a170
    v_accvgpr_read_b32 v59, a171
    v_mfma_f32_16x16x32_bf16 v[200:203], a[40:43], a[80:83], v[200:203]
    v_accvgpr_read_b32 v60, a172
    v_accvgpr_read_b32 v61, a173
    v_mfma_f32_16x16x32_bf16 v[200:203], a[44:47], a[84:87], v[200:203]
    v_accvgpr_read_b32 v62, a174
    v_accvgpr_read_b32 v63, a175
    v_mfma_f32_16x16x32_bf16 v[120:123], a[32:35], a[88:91], v[120:123]
    v_cvt_pk_bf16_f32 v180, v56, v57
    v_cvt_pk_bf16_f32 v181, v58, v59
    v_mfma_f32_16x16x32_bf16 v[120:123], a[36:39], a[92:95], v[120:123]
    v_cvt_pk_bf16_f32 v72, v72, v73
    v_cvt_pk_bf16_f32 v182, v60, v61
    v_mfma_f32_16x16x32_bf16 v[216:219], a[40:43], a[88:91], v[216:219]
    s_add_u32 s52, s47, 0
    v_cvt_pk_bf16_f32 v73, v74, v75
    v_cvt_pk_bf16_f32 v183, v62, v63
    v_mfma_f32_16x16x32_bf16 v[216:219], a[44:47], a[92:95], v[216:219]
    v_cvt_pk_bf16_f32 v74, v168, v169
    v_cvt_pk_bf16_f32 v75, v170, v171
    v_mfma_f32_16x16x32_bf16 v[136:139], a[32:35], a[96:99], v[136:139]
    v_cvt_pk_bf16_f32 v88, v88, v89
    v_cvt_pk_bf16_f32 v89, v90, v91
    v_mfma_f32_16x16x32_bf16 v[136:139], a[36:39], a[100:103], v[136:139]
    v_cvt_pk_bf16_f32 v90, v184, v185
    v_cvt_pk_bf16_f32 v91, v186, v187
    v_mfma_f32_16x16x32_bf16 v[232:235], a[40:43], a[96:99], v[232:235]
    buffer_store_dwordx4 v[68:71], v1, s[32:35], s52 offen offset:1024 sc1
    v_mfma_f32_16x16x32_bf16 v[232:235], a[44:47], a[100:103], v[232:235]
    v_cvt_pk_bf16_f32 v104, v104, v105
    v_cvt_pk_bf16_f32 v105, v106, v107
    v_mfma_f32_16x16x32_bf16 v[152:155], a[32:35], a[104:107], v[152:155]
    v_cvt_pk_bf16_f32 v106, v200, v201
    v_cvt_pk_bf16_f32 v107, v202, v203
    v_mfma_f32_16x16x32_bf16 v[152:155], a[36:39], a[108:111], v[152:155]
    v_cvt_pk_bf16_f32 v120, v120, v121
    v_cvt_pk_bf16_f32 v121, v122, v123
    v_mfma_f32_16x16x32_bf16 v[248:251], a[40:43], a[104:107], v[248:251]
    v_cvt_pk_bf16_f32 v122, v216, v217
    v_cvt_pk_bf16_f32 v123, v218, v219
    v_mfma_f32_16x16x32_bf16 v[248:251], a[44:47], a[108:111], v[248:251]
    v_mfma_f32_16x16x32_bf16 a[144:147], a[32:35], a[112:115], a[144:147]
    v_mfma_f32_16x16x32_bf16 a[144:147], a[36:39], a[116:119], a[144:147]
    s_add_u32 s52, s47, 8192
    v_cvt_pk_bf16_f32 v136, v136, v137
    v_cvt_pk_bf16_f32 v137, v138, v139
    v_mfma_f32_16x16x32_bf16 a[148:151], a[40:43], a[112:115], a[148:151]
    v_cvt_pk_bf16_f32 v138, v232, v233
    v_cvt_pk_bf16_f32 v139, v234, v235
    v_mfma_f32_16x16x32_bf16 a[148:151], a[44:47], a[116:119], a[148:151]
    buffer_store_dwordx4 v[100:103], v1, s[32:35], s52 offen offset:1024 sc1
    v_mfma_f32_16x16x32_bf16 a[176:179], a[32:35], a[120:123], a[176:179]
    v_mfma_f32_16x16x32_bf16 a[176:179], a[36:39], a[124:127], a[176:179]
    v_cvt_pk_bf16_f32 v152, v152, v153
    v_cvt_pk_bf16_f32 v153, v154, v155
    v_mfma_f32_16x16x32_bf16 a[180:183], a[40:43], a[120:123], a[180:183]
    v_cvt_pk_bf16_f32 v154, v248, v249
    v_cvt_pk_bf16_f32 v155, v250, v251
    v_mfma_f32_16x16x32_bf16 a[180:183], a[44:47], a[124:127], a[180:183]
    v_mfma_f32_16x16x32_bf16 v[76:79], a[48:51], a[64:67], v[76:79]
    s_waitcnt vmcnt(16)
    s_barrier
    v_mfma_f32_16x16x32_bf16 v[76:79], a[52:55], a[68:71], v[76:79]
    ds_read_b64_tr_b16 a[0:1], v42 offset:32768
    v_accvgpr_read_b32 v56, a144
    v_mfma_f32_16x16x32_bf16 v[172:175], a[56:59], a[64:67], v[172:175]
    v_accvgpr_read_b32 v57, a145
    v_accvgpr_read_b32 v58, a146
    v_mfma_f32_16x16x32_bf16 v[172:175], a[60:63], a[68:71], v[172:175]
    ds_read_b64_tr_b16 a[2:3], v42 offset:33792
    v_accvgpr_read_b32 v59, a147
    v_mfma_f32_16x16x32_bf16 v[92:95], a[48:51], a[72:75], v[92:95]
    v_accvgpr_read_b32 v60, a148
    v_accvgpr_read_b32 v61, a149
    v_mfma_f32_16x16x32_bf16 v[92:95], a[52:55], a[76:79], v[92:95]
    s_add_u32 s52, s47, 524288
    ds_read_b64_tr_b16 a[4:5], v42 offset:40960
    v_accvgpr_read_b32 v62, a150
    v_mfma_f32_16x16x32_bf16 v[188:191], a[56:59], a[72:75], v[188:191]
    v_accvgpr_read_b32 v63, a151
    v_cvt_pk_bf16_f32 v168, v56, v57
    v_mfma_f32_16x16x32_bf16 v[188:191], a[60:63], a[76:79], v[188:191]
    v_cvt_pk_bf16_f32 v169, v58, v59
    v_cvt_pk_bf16_f32 v170, v60, v61
    v_mfma_f32_16x16x32_bf16 v[108:111], a[48:51], a[80:83], v[108:111]
    ds_read_b64_tr_b16 a[6:7], v42 offset:41984
    v_cvt_pk_bf16_f32 v171, v62, v63
    v_mfma_f32_16x16x32_bf16 v[108:111], a[52:55], a[84:87], v[108:111]
    v_accvgpr_read_b32 v56, a176
    v_accvgpr_read_b32 v57, a177
    v_mfma_f32_16x16x32_bf16 v[204:207], a[56:59], a[80:83], v[204:207]
    v_accvgpr_read_b32 v58, a178
    v_accvgpr_read_b32 v59, a179
    v_mfma_f32_16x16x32_bf16 v[204:207], a[60:63], a[84:87], v[204:207]
    ds_read_b64_tr_b16 a[8:9], v43 offset:32768
    v_accvgpr_read_b32 v60, a180
    v_mfma_f32_16x16x32_bf16 v[124:127], a[48:51], a[88:91], v[124:127]
    buffer_store_dwordx4 v[132:135], v1, s[32:35], s52 offen offset:1024 sc1
    v_accvgpr_read_b32 v61, a181
    v_mfma_f32_16x16x32_bf16 v[124:127], a[52:55], a[92:95], v[124:127]
    v_accvgpr_read_b32 v62, a182
    v_accvgpr_read_b32 v63, a183
    v_mfma_f32_16x16x32_bf16 v[220:223], a[56:59], a[88:91], v[220:223]
    ds_read_b64_tr_b16 a[10:11], v43 offset:33792
    v_cvt_pk_bf16_f32 v184, v56, v57
    v_mfma_f32_16x16x32_bf16 v[220:223], a[60:63], a[92:95], v[220:223]
    v_cvt_pk_bf16_f32 v185, v58, v59
    v_cvt_pk_bf16_f32 v76, v76, v77
    v_mfma_f32_16x16x32_bf16 v[140:143], a[48:51], a[96:99], v[140:143]
    s_add_u32 s52, s47, 532480
    v_cvt_pk_bf16_f32 v186, v60, v61
    v_cvt_pk_bf16_f32 v77, v78, v79
    v_mfma_f32_16x16x32_bf16 v[140:143], a[52:55], a[100:103], v[140:143]
    ds_read_b64_tr_b16 a[12:13], v43 offset:40960
    v_cvt_pk_bf16_f32 v187, v62, v63
    v_mfma_f32_16x16x32_bf16 v[236:239], a[56:59], a[96:99], v[236:239]
    v_cvt_pk_bf16_f32 v78, v172, v173
    v_cvt_pk_bf16_f32 v79, v174, v175
    v_mfma_f32_16x16x32_bf16 v[236:239], a[60:63], a[100:103], v[236:239]
    ds_read_b64_tr_b16 a[14:15], v43 offset:41984
    ds_read_b64_tr_b16 a[16:17], v44 offset:32768
    v_mfma_f32_16x16x32_bf16 v[156:159], a[48:51], a[104:107], v[156:159]
    v_cvt_pk_bf16_f32 v92, v92, v93
    v_cvt_pk_bf16_f32 v93, v94, v95
    v_mfma_f32_16x16x32_bf16 v[156:159], a[52:55], a[108:111], v[156:159]
    ds_read_b64_tr_b16 a[18:19], v44 offset:33792
    v_cvt_pk_bf16_f32 v94, v188, v189
    v_mfma_f32_16x16x32_bf16 v[252:255], a[56:59], a[104:107], v[252:255]
    ds_read_b64_tr_b16 a[20:21], v44 offset:40960
    v_cvt_pk_bf16_f32 v95, v190, v191
    v_mfma_f32_16x16x32_bf16 v[252:255], a[60:63], a[108:111], v[252:255]
    ds_read_b64_tr_b16 a[22:23], v44 offset:41984
    v_cvt_pk_bf16_f32 v108, v108, v109
    v_mfma_f32_16x16x32_bf16 a[152:155], a[48:51], a[112:115], a[152:155]
    v_cvt_pk_bf16_f32 v109, v110, v111
    v_cvt_pk_bf16_f32 v110, v204, v205
    v_mfma_f32_16x16x32_bf16 a[152:155], a[52:55], a[116:119], a[152:155]
    ds_read_b64_tr_b16 a[24:25], v45 offset:32768
    v_cvt_pk_bf16_f32 v111, v206, v207
    v_mfma_f32_16x16x32_bf16 a[156:159], a[56:59], a[112:115], a[156:159]
    buffer_store_dwordx4 v[164:167], v1, s[32:35], s52 offen offset:1024 sc1
    ds_read_b64_tr_b16 a[26:27], v45 offset:33792
    v_mfma_f32_16x16x32_bf16 a[156:159], a[60:63], a[116:119], a[156:159]
    ds_read_b64_tr_b16 a[28:29], v45 offset:40960
    v_cvt_pk_bf16_f32 v124, v124, v125
    v_mfma_f32_16x16x32_bf16 a[184:187], a[48:51], a[120:123], a[184:187]
    v_cvt_pk_bf16_f32 v125, v126, v127
    v_cvt_pk_bf16_f32 v126, v220, v221
    v_mfma_f32_16x16x32_bf16 a[184:187], a[52:55], a[124:127], a[184:187]
    ds_read_b64_tr_b16 a[30:31], v45 offset:41984
    v_cvt_pk_bf16_f32 v127, v222, v223
    v_mfma_f32_16x16x32_bf16 a[188:191], a[56:59], a[120:123], a[188:191]
    v_cvt_pk_bf16_f32 v140, v140, v141
    v_cvt_pk_bf16_f32 v141, v142, v143
    v_mfma_f32_16x16x32_bf16 a[188:191], a[60:63], a[124:127], a[188:191]
    v_cvt_pk_bf16_f32 v142, v236, v237
    v_cvt_pk_bf16_f32 v143, v238, v239
    v_cvt_pk_bf16_f32 v156, v156, v157
    v_cvt_pk_bf16_f32 v157, v158, v159
    v_cvt_pk_bf16_f32 v158, v252, v253
    v_cvt_pk_bf16_f32 v159, v254, v255
    v_accvgpr_read_b32 v56, a152
    v_accvgpr_read_b32 v57, a153
    v_accvgpr_read_b32 v58, a154
    v_accvgpr_read_b32 v59, a155
    v_accvgpr_read_b32 v60, a156
    v_accvgpr_read_b32 v61, a157
    v_accvgpr_read_b32 v62, a158
    v_accvgpr_read_b32 v63, a159
    v_cvt_pk_bf16_f32 v172, v56, v57
    v_cvt_pk_bf16_f32 v173, v58, v59
    v_cvt_pk_bf16_f32 v174, v60, v61
    v_cvt_pk_bf16_f32 v175, v62, v63
    v_accvgpr_read_b32 v56, a184
    v_accvgpr_read_b32 v57, a185
    v_accvgpr_read_b32 v58, a186
    v_accvgpr_read_b32 v59, a187
    v_accvgpr_read_b32 v60, a188
    v_accvgpr_read_b32 v61, a189
    v_accvgpr_read_b32 v62, a190
    v_accvgpr_read_b32 v63, a191
    v_cvt_pk_bf16_f32 v188, v56, v57
    v_cvt_pk_bf16_f32 v189, v58, v59
    v_cvt_pk_bf16_f32 v190, v60, v61
    v_cvt_pk_bf16_f32 v191, v62, v63
    s_branch k12_join_7
k12_v_6:
k12_loop_28:
    v_mfma_f32_16x16x32_bf16 v[64:67], a[192:195], a[0:3], v[64:67]
    v_mfma_f32_16x16x32_bf16 v[64:67], a[196:199], a[4:7], v[64:67]
    ds_read_b64_tr_b16 a[32:33], v32 offset:0
    v_mfma_f32_16x16x32_bf16 v[160:163], a[200:203], a[0:3], v[160:163]
    v_mfma_f32_16x16x32_bf16 v[160:163], a[204:207], a[4:7], v[160:163]
    ds_read_b64_tr_b16 a[34:35], v32 offset:2048
    v_mfma_f32_16x16x32_bf16 v[96:99], a[208:211], a[0:3], v[96:99]
    s_cmp_eq_u32 s51, s46
    s_cbranch_scc1 k12_ool_30
k12_oolret_31:
    v_mfma_f32_16x16x32_bf16 v[96:99], a[212:215], a[4:7], v[96:99]
    v_mfma_f32_16x16x32_bf16 v[192:195], a[216:219], a[0:3], v[192:195]
    ds_read_b64_tr_b16 a[36:37], v32 offset:16384
    v_mfma_f32_16x16x32_bf16 v[192:195], a[220:223], a[4:7], v[192:195]
    v_mfma_f32_16x16x32_bf16 v[128:131], a[224:227], a[0:3], v[128:131]
    v_mfma_f32_16x16x32_bf16 v[128:131], a[228:231], a[4:7], v[128:131]
    ds_read_b64_tr_b16 a[38:39], v32 offset:18432
    v_mfma_f32_16x16x32_bf16 v[224:227], a[232:235], a[0:3], v[224:227]
    v_mfma_f32_16x16x32_bf16 v[224:227], a[236:239], a[4:7], v[224:227]
    v_mfma_f32_16x16x32_bf16 a[128:131], a[240:243], a[0:3], a[128:131]
    ds_read_b64_tr_b16 a[40:41], v33 offset:0
    v_mfma_f32_16x16x32_bf16 a[128:131], a[244:247], a[4:7], a[128:131]
    v_mfma_f32_16x16x32_bf16 a[132:135], a[248:251], a[0:3], a[132:135]
    v_mfma_f32_16x16x32_bf16 a[132:135], a[252:255], a[4:7], a[132:135]
    ds_read_b64_tr_b16 a[42:43], v33 offset:2048
    v_mfma_f32_16x16x32_bf16 v[68:71], a[192:195], a[8:11], v[68:71]
    v_mfma_f32_16x16x32_bf16 v[68:71], a[196:199], a[12:15], v[68:71]
    v_mfma_f32_16x16x32_bf16 v[164:167], a[200:203], a[8:11], v[164:167]
    ds_read_b64_tr_b16 a[44:45], v33 offset:16384
    v_mfma_f32_16x16x32_bf16 v[164:167], a[204:207], a[12:15], v[164:167]
    v_mfma_f32_16x16x32_bf16 v[100:103], a[208:211], a[8:11], v[100:103]
    v_mfma_f32_16x16x32_bf16 v[100:103], a[212:215], a[12:15], v[100:103]
    ds_read_b64_tr_b16 a[46:47], v33 offset:18432
    v_mfma_f32_16x16x32_bf16 v[196:199], a[216:219], a[8:11], v[196:199]
    v_mfma_f32_16x16x32_bf16 v[196:199], a[220:223], a[12:15], v[196:199]
    ds_read_b64_tr_b16 a[48:49], v34 offset:0
    v_mfma_f32_16x16x32_bf16 v[132:135], a[224:227], a[8:11], v[132:135]
    v_mfma_f32_16x16x32_bf16 v[132:135], a[228:231], a[12:15], v[132:135]
    v_mfma_f32_16x16x32_bf16 v[228:231], a[232:235], a[8:11], v[228:231]
    ds_read_b64_tr_b16 a[50:51], v34 offset:2048
    v_mfma_f32_16x16x32_bf16 v[228:231], a[236:239], a[12:15], v[228:231]
    v_mfma_f32_16x16x32_bf16 a[136:139], a[240:243], a[8:11], a[136:139]
    v_mfma_f32_16x16x32_bf16 a[136:139], a[244:247], a[12:15], a[136:139]
    ds_read_b64_tr_b16 a[52:53], v34 offset:16384
    v_mfma_f32_16x16x32_bf16 a[140:143], a[248:251], a[8:11], a[140:143]
    v_mfma_f32_16x16x32_bf16 a[140:143], a[252:255], a[12:15], a[140:143]
    v_mfma_f32_16x16x32_bf16 v[72:75], a[192:195], a[16:19], v[72:75]
    ds_read_b64_tr_b16 a[54:55], v34 offset:18432
    v_mfma_f32_16x16x32_bf16 v[72:75], a[196:199], a[20:23], v[72:75]
    v_mfma_f32_16x16x32_bf16 v[168:171], a[200:203], a[16:19], v[168:171]
    v_mfma_f32_16x16x32_bf16 v[168:171], a[204:207], a[20:23], v[168:171]
    ds_read_b64_tr_b16 a[56:57], v35 offset:0
    v_mfma_f32_16x16x32_bf16 v[104:107], a[208:211], a[16:19], v[104:107]
    v_mfma_f32_16x16x32_bf16 v[104:107], a[212:215], a[20:23], v[104:107]
    v_mfma_f32_16x16x32_bf16 v[200:203], a[216:219], a[16:19], v[200:203]
    ds_read_b64_tr_b16 a[58:59], v35 offset:2048
    v_mfma_f32_16x16x32_bf16 v[200:203], a[220:223], a[20:23], v[200:203]
    v_mfma_f32_16x16x32_bf16 v[136:139], a[224:227], a[16:19], v[136:139]
    v_mfma_f32_16x16x32_bf16 v[136:139], a[228:231], a[20:23], v[136:139]
    ds_read_b64_tr_b16 a[60:61], v35 offset:16384
    v_mfma_f32_16x16x32_bf16 v[232:235], a[232:235], a[16:19], v[232:235]
    v_mfma_f32_16x16x32_bf16 v[232:235], a[236:239], a[20:23], v[232:235]
    v_mfma_f32_16x16x32_bf16 a[144:147], a[240:243], a[16:19], a[144:147]
    ds_read_b64_tr_b16 a[62:63], v35 offset:18432
    v_mfma_f32_16x16x32_bf16 a[144:147], a[244:247], a[20:23], a[144:147]
    v_mfma_f32_16x16x32_bf16 a[148:151], a[248:251], a[16:19], a[148:151]
    v_mfma_f32_16x16x32_bf16 a[148:151], a[252:255], a[20:23], a[148:151]
    v_mfma_f32_16x16x32_bf16 v[76:79], a[192:195], a[24:27], v[76:79]
    v_mfma_f32_16x16x32_bf16 v[76:79], a[196:199], a[28:31], v[76:79]
    v_mfma_f32_16x16x32_bf16 v[172:175], a[200:203], a[24:27], v[172:175]
    v_mfma_f32_16x16x32_bf16 v[172:175], a[204:207], a[28:31], v[172:175]
    v_mfma_f32_16x16x32_bf16 v[108:111], a[208:211], a[24:27], v[108:111]
    v_mfma_f32_16x16x32_bf16 v[108:111], a[212:215], a[28:31], v[108:111]
    v_mfma_f32_16x16x32_bf16 v[204:207], a[216:219], a[24:27], v[204:207]
    v_mfma_f32_16x16x32_bf16 v[204:207], a[220:223], a[28:31], v[204:207]
    v_mfma_f32_16x16x32_bf16 v[140:143], a[224:227], a[24:27], v[140:143]
    v_mfma_f32_16x16x32_bf16 v[140:143], a[228:231], a[28:31], v[140:143]
    v_mfma_f32_16x16x32_bf16 v[236:239], a[232:235], a[24:27], v[236:239]
    v_mfma_f32_16x16x32_bf16 v[236:239], a[236:239], a[28:31], v[236:239]
    v_mfma_f32_16x16x32_bf16 a[152:155], a[240:243], a[24:27], a[152:155]
    v_mfma_f32_16x16x32_bf16 a[152:155], a[244:247], a[28:31], a[152:155]
    v_mfma_f32_16x16x32_bf16 a[156:159], a[248:251], a[24:27], a[156:159]
    v_mfma_f32_16x16x32_bf16 a[156:159], a[252:255], a[28:31], a[156:159]
    s_waitcnt vmcnt(0) lgkmcnt(0)
    s_cmp_eq_u32 s51, s46
    s_cbranch_scc1 k12_ool_34
k12_oolret_35:
    s_barrier
    v_mfma_f32_16x16x32_bf16 v[80:83], a[192:195], a[32:35], v[80:83]
    s_cmp_ge_u32 s49, 1024
    s_cselect_b32 s18, 0, s18
    s_cselect_b32 s22, 0, s22
    v_mfma_f32_16x16x32_bf16 v[80:83], a[196:199], a[36:39], v[80:83]
    s_add_u32 m0, s48, 0
    ds_read_b128 a[64:67], v26 offset:32768
    v_mfma_f32_16x16x32_bf16 v[176:179], a[200:203], a[32:35], v[176:179]
    buffer_load_dwordx4 v10, s[16:19], s49 offen offset:0 lds
    ds_read_b64_tr_b16 a[0:1], v28 offset:32768
    v_mfma_f32_16x16x32_bf16 v[176:179], a[204:207], a[36:39], v[176:179]
    ds_read_b128 a[68:71], v27 offset:32768
    v_mfma_f32_16x16x32_bf16 v[112:115], a[208:211], a[32:35], v[112:115]
    buffer_load_dwordx4 v11, s[16:19], s49 offen offset:1024 lds
    v_mfma_f32_16x16x32_bf16 v[112:115], a[212:215], a[36:39], v[112:115]
    ds_read_b64_tr_b16 a[2:3], v28 offset:34816
    v_mfma_f32_16x16x32_bf16 v[208:211], a[216:219], a[32:35], v[208:211]
    v_mfma_f32_16x16x32_bf16 v[208:211], a[220:223], a[36:39], v[208:211]
    ds_read_b128 a[72:75], v26 offset:34816
    v_mfma_f32_16x16x32_bf16 v[144:147], a[224:227], a[32:35], v[144:147]
    buffer_load_dwordx4 v12, s[16:19], s49 offen offset:2048 lds
    ds_read_b64_tr_b16 a[4:5], v28 offset:49152
    v_mfma_f32_16x16x32_bf16 v[144:147], a[228:231], a[36:39], v[144:147]
    v_mfma_f32_16x16x32_bf16 v[240:243], a[232:235], a[32:35], v[240:243]
    ds_read_b128 a[76:79], v27 offset:34816
    v_mfma_f32_16x16x32_bf16 v[240:243], a[236:239], a[36:39], v[240:243]
    buffer_load_dwordx4 v13, s[16:19], s49 offen offset:3072 lds
    v_mfma_f32_16x16x32_bf16 a[160:163], a[240:243], a[32:35], a[160:163]
    ds_read_b64_tr_b16 a[6:7], v28 offset:51200
    v_mfma_f32_16x16x32_bf16 a[160:163], a[244:247], a[36:39], a[160:163]
    s_add_u32 m0, s48, 4096
    ds_read_b128 a[80:83], v26 offset:36864
    v_mfma_f32_16x16x32_bf16 a[164:167], a[248:251], a[32:35], a[164:167]
    v_mfma_f32_16x16x32_bf16 a[164:167], a[252:255], a[36:39], a[164:167]
    buffer_load_dwordx4 v14, s[16:19], s49 offen offset:0 lds
    ds_read_b64_tr_b16 a[8:9], v29 offset:32768
    v_mfma_f32_16x16x32_bf16 v[84:87], a[192:195], a[40:43], v[84:87]
    v_mfma_f32_16x16x32_bf16 v[84:87], a[196:199], a[44:47], v[84:87]
    ds_read_b128 a[84:87], v27 offset:36864
    v_mfma_f32_16x16x32_bf16 v[180:183], a[200:203], a[40:43], v[180:183]
    buffer_load_dwordx4 v15, s[16:19], s49 offen offset:1024 lds
    ds_read_b64_tr_b16 a[10:11], v29 offset:34816
    v_mfma_f32_16x16x32_bf16 v[180:183], a[204:207], a[44:47], v[180:183]
    v_mfma_f32_16x16x32_bf16 v[116:119], a[208:211], a[40:43], v[116:119]
    ds_read_b128 a[88:91], v26 offset:38912
    v_mfma_f32_16x16x32_bf16 v[116:119], a[212:215], a[44:47], v[116:119]
    v_mfma_f32_16x16x32_bf16 v[212:215], a[216:219], a[40:43], v[212:215]
    buffer_load_dwordx4 v16, s[16:19], s49 offen offset:2048 lds
    ds_read_b64_tr_b16 a[12:13], v29 offset:49152
    v_mfma_f32_16x16x32_bf16 v[212:215], a[220:223], a[44:47], v[212:215]
    ds_read_b128 a[92:95], v27 offset:38912
    v_mfma_f32_16x16x32_bf16 v[148:151], a[224:227], a[40:43], v[148:151]
    v_mfma_f32_16x16x32_bf16 v[148:151], a[228:231], a[44:47], v[148:151]
    buffer_load_dwordx4 v17, s[16:19], s49 offen offset:3072 lds
    ds_read_b64_tr_b16 a[14:15], v29 offset:51200
    v_mfma_f32_16x16x32_bf16 v[244:247], a[232:235], a[40:43], v[244:247]
    ds_read_b128 a[96:99], v26 offset:40960
    v_mfma_f32_16x16x32_bf16 v[244:247], a[236:239], a[44:47], v[244:247]
    s_add_u32 s49, s49, 128
    v_mfma_f32_16x16x32_bf16 a[168:171], a[240:243], a[40:43], a[168:171]
    s_add_u32 m0, s48, 65536
    ds_read_b64_tr_b16 a[16:17], v30 offset:32768
    v_mfma_f32_16x16x32_bf16 a[168:171], a[244:247], a[44:47], a[168:171]
    buffer_load_dwordx4 v18, s[20:23], s50 offen offset:0 lds
    v_mfma_f32_16x16x32_bf16 a[172:175], a[248:251], a[40:43], a[172:175]
    ds_read_b128 a[100:103], v27 offset:40960
    v_mfma_f32_16x16x32_bf16 a[172:175], a[252:255], a[44:47], a[172:175]
    ds_read_b64_tr_b16 a[18:19], v30 offset:34816
    v_mfma_f32_16x16x32_bf16 v[88:91], a[192:195], a[48:51], v[88:91]
    buffer_load_dwordx4 v19, s[20:23], s50 offen offset:1024 lds
    v_mfma_f32_16x16x32_bf16 v[88:91], a[196:199], a[52:55], v[88:91]
    ds_read_b128 a[104:107], v26 offset:43008
    v_mfma_f32_16x16x32_bf16 v[184:187], a[200:203], a[48:51], v[184:187]
    v_mfma_f32_16x16x32_bf16 v[184:187], a[204:207], a[52:55], v[184:187]
    buffer_load_dwordx4 v20, s[20:23], s50 offen offset:2048 lds
    ds_read_b64_tr_b16 a[20:21], v30 offset:49152
    v_mfma_f32_16x16x32_bf16 v[120:123], a[208:211], a[48:51], v[120:123]
    ds_read_b128 a[108:111], v27 offset:43008
    v_mfma_f32_16x16x32_bf16 v[120:123], a[212:215], a[52:55], v[120:123]
    v_mfma_f32_16x16x32_bf16 v[216:219], a[216:219], a[48:51], v[216:219]
    ds_read_b64_tr_b16 a[22:23], v30 offset:51200
    v_mfma_f32_16x16x32_bf16 v[216:219], a[220:223], a[52:55], v[216:219]
    buffer_load_dwordx4 v21, s[20:23], s50 offen offset:3072 lds
    v_mfma_f32_16x16x32_bf16 v[152:155], a[224:227], a[48:51], v[152:155]
    s_add_u32 m0, s48, 69632
    ds_read_b128 a[112:115], v26 offset:45056
    v_mfma_f32_16x16x32_bf16 v[152:155], a[228:231], a[52:55], v[152:155]
    ds_read_b64_tr_b16 a[24:25], v31 offset:32768
    v_mfma_f32_16x16x32_bf16 v[248:251], a[232:235], a[48:51], v[248:251]
    buffer_load_dwordx4 v22, s[20:23], s50 offen offset:0 lds
    v_mfma_f32_16x16x32_bf16 v[248:251], a[236:239], a[52:55], v[248:251]
    ds_read_b128 a[116:119], v27 offset:45056
    v_mfma_f32_16x16x32_bf16 a[176:179], a[240:243], a[48:51], a[176:179]
    v_mfma_f32_16x16x32_bf16 a[176:179], a[244:247], a[52:55], a[176:179]
    ds_read_b64_tr_b16 a[26:27], v31 offset:34816
    v_mfma_f32_16x16x32_bf16 a[180:183], a[248:251], a[48:51], a[180:183]
    buffer_load_dwordx4 v23, s[20:23], s50 offen offset:1024 lds
    ds_read_b128 a[120:123], v26 offset:47104
    v_mfma_f32_16x16x32_bf16 a[180:183], a[252:255], a[52:55], a[180:183]
    v_mfma_f32_16x16x32_bf16 v[92:95], a[192:195], a[56:59], v[92:95]
    ds_read_b64_tr_b16 a[28:29], v31 offset:49152
    v_mfma_f32_16x16x32_bf16 v[92:95], a[196:199], a[60:63], v[92:95]
    buffer_load_dwordx4 v24, s[20:23], s50 offen offset:2048 lds
    v_mfma_f32_16x16x32_bf16 v[188:191], a[200:203], a[56:59], v[188:191]
    ds_read_b128 a[124:127], v27 offset:47104
    v_mfma_f32_16x16x32_bf16 v[188:191], a[204:207], a[60:63], v[188:191]
    ds_read_b64_tr_b16 a[30:31], v31 offset:51200
    v_mfma_f32_16x16x32_bf16 v[124:127], a[208:211], a[56:59], v[124:127]
    v_mfma_f32_16x16x32_bf16 v[124:127], a[212:215], a[60:63], v[124:127]
    buffer_load_dwordx4 v25, s[20:23], s50 offen offset:3072 lds
    v_mfma_f32_16x16x32_bf16 v[220:223], a[216:219], a[56:59], v[220:223]
    v_mfma_f32_16x16x32_bf16 v[220:223], a[220:223], a[60:63], v[220:223]
    s_add_u32 s50, s50, 0x80000
    v_mfma_f32_16x16x32_bf16 v[156:159], a[224:227], a[56:59], v[156:159]
    v_mfma_f32_16x16x32_bf16 v[156:159], a[228:231], a[60:63], v[156:159]
    s_cmp_eq_u32 s51, s53
    s_cbranch_scc1 k12_ool_36
k12_oolret_37:
    v_mfma_f32_16x16x32_bf16 v[252:255], a[232:235], a[56:59], v[252:255]
    s_cmp_eq_u32 s51, s63
    s_cbranch_scc1 k12_ool_38
k12_oolret_39:
    v_mfma_f32_16x16x32_bf16 v[252:255], a[236:239], a[60:63], v[252:255]
    s_cmp_eq_u32 s51, 6
    s_cbranch_scc1 k12_ool_40
k12_oolret_41:
    v_mfma_f32_16x16x32_bf16 a[184:187], a[240:243], a[56:59], a[184:187]
    v_mfma_f32_16x16x32_bf16 a[184:187], a[244:247], a[60:63], a[184:187]
    s_add_u32 s51, s51, 1
    v_mfma_f32_16x16x32_bf16 a[188:191], a[248:251], a[56:59], a[188:191]
    v_mfma_f32_16x16x32_bf16 a[188:191], a[252:255], a[60:63], a[188:191]
    s_waitcnt lgkmcnt(0)
    s_cmp_eq_u32 s51, 7
    s_cbranch_scc1 k12_last_29
    v_mfma_f32_16x16x32_bf16 v[64:67], a[64:67], a[0:3], v[64:67]
    v_mfma_f32_16x16x32_bf16 v[64:67], a[68:71], a[4:7], v[64:67]
    ds_read_b64_tr_b16 a[32:33], v32 offset:32768
    v_mfma_f32_16x16x32_bf16 v[160:163], a[72:75], a[0:3], v[160:163]
    v_mfma_f32_16x16x32_bf16 v[160:163], a[76:79], a[4:7], v[160:163]
    ds_read_b64_tr_b16 a[34:35], v32 offset:34816
    v_mfma_f32_16x16x32_bf16 v[96:99], a[80:83], a[0:3], v[96:99]
    v_mfma_f32_16x16x32_bf16 v[96:99], a[84:87], a[4:7], v[96:99]
    v_mfma_f32_16x16x32_bf16 v[192:195], a[88:91], a[0:3], v[192:195]
    ds_read_b64_tr_b16 a[36:37], v32 offset:49152
    v_mfma_f32_16x16x32_bf16 v[192:195], a[92:95], a[4:7], v[192:195]
    v_mfma_f32_16x16x32_bf16 v[128:131], a[96:99], a[0:3], v[128:131]
    v_mfma_f32_16x16x32_bf16 v[128:131], a[100:103], a[4:7], v[128:131]
    ds_read_b64_tr_b16 a[38:39], v32 offset:51200
    v_mfma_f32_16x16x32_bf16 v[224:227], a[104:107], a[0:3], v[224:227]
    v_mfma_f32_16x16x32_bf16 v[224:227], a[108:111], a[4:7], v[224:227]
    v_mfma_f32_16x16x32_bf16 a[128:131], a[112:115], a[0:3], a[128:131]
    ds_read_b64_tr_b16 a[40:41], v33 offset:32768
    v_mfma_f32_16x16x32_bf16 a[128:131], a[116:119], a[4:7], a[128:131]
    v_mfma_f32_16x16x32_bf16 a[132:135], a[120:123], a[0:3], a[132:135]
    v_mfma_f32_16x16x32_bf16 a[132:135], a[124:127], a[4:7], a[132:135]
    ds_read_b64_tr_b16 a[42:43], v33 offset:34816
    v_mfma_f32_16x16x32_bf16 v[68:71], a[64:67], a[8:11], v[68:71]
    v_mfma_f32_16x16x32_bf16 v[68:71], a[68:71], a[12:15], v[68:71]
    v_mfma_f32_16x16x32_bf16 v[164:167], a[72:75], a[8:11], v[164:167]
    ds_read_b64_tr_b16 a[44:45], v33 offset:49152
    v_mfma_f32_16x16x32_bf16 v[164:167], a[76:79], a[12:15], v[164:167]
    v_mfma_f32_16x16x32_bf16 v[100:103], a[80:83], a[8:11], v[100:103]
    v_mfma_f32_16x16x32_bf16 v[100:103], a[84:87], a[12:15], v[100:103]
    ds_read_b64_tr_b16 a[46:47], v33 offset:51200
    v_mfma_f32_16x16x32_bf16 v[196:199], a[88:91], a[8:11], v[196:199]
    v_mfma_f32_16x16x32_bf16 v[196:199], a[92:95], a[12:15], v[196:199]
    ds_read_b64_tr_b16 a[48:49], v34 offset:32768
    v_mfma_f32_16x16x32_bf16 v[132:135], a[96:99], a[8:11], v[132:135]
    v_mfma_f32_16x16x32_bf16 v[132:135], a[100:103], a[12:15], v[132:135]
    v_mfma_f32_16x16x32_bf16 v[228:231], a[104:107], a[8:11], v[228:231]
    ds_read_b64_tr_b16 a[50:51], v34 offset:34816
    v_mfma_f32_16x16x32_bf16 v[228:231], a[108:111], a[12:15], v[228:231]
    v_mfma_f32_16x16x32_bf16 a[136:139], a[112:115], a[8:11], a[136:139]
    v_mfma_f32_16x16x32_bf16 a[136:139], a[116:119], a[12:15], a[136:139]
    ds_read_b64_tr_b16 a[52:53], v34 offset:49152
    v_mfma_f32_16x16x32_bf16 a[140:143], a[120:123], a[8:11], a[140:143]
    v_mfma_f32_16x16x32_bf16 a[140:143], a[124:127], a[12:15], a[140:143]
    v_mfma_f32_16x16x32_bf16 v[72:75], a[64:67], a[16:19], v[72:75]
    ds_read_b64_tr_b16 a[54:55], v34 offset:51200
    v_mfma_f32_16x16x32_bf16 v[72:75], a[68:71], a[20:23], v[72:75]
    v_mfma_f32_16x16x32_bf16 v[168:171], a[72:75], a[16:19], v[168:171]
    v_mfma_f32_16x16x32_bf16 v[168:171], a[76:79], a[20:23], v[168:171]
    ds_read_b64_tr_b16 a[56:57], v35 offset:32768
    v_mfma_f32_16x16x32_bf16 v[104:107], a[80:83], a[16:19], v[104:107]
    v_mfma_f32_16x16x32_bf16 v[104:107], a[84:87], a[20:23], v[104:107]
    v_mfma_f32_16x16x32_bf16 v[200:203], a[88:91], a[16:19], v[200:203]
    ds_read_b64_tr_b16 a[58:59], v35 offset:34816
    v_mfma_f32_16x16x32_bf16 v[200:203], a[92:95], a[20:23], v[200:203]
    v_mfma_f32_16x16x32_bf16 v[136:139], a[96:99], a[16:19], v[136:139]
    v_mfma_f32_16x16x32_bf16 v[136:139], a[100:103], a[20:23], v[136:139]
    ds_read_b64_tr_b16 a[60:61], v35 offset:49152
    v_mfma_f32_16x16x32_bf16 v[232:235], a[104:107], a[16:19], v[232:235]
    v_mfma_f32_16x16x32_bf16 v[232:235], a[108:111], a[20:23], v[232:235]
    v_mfma_f32_16x16x32_bf16 a[144:147], a[112:115], a[16:19], a[144:147]
    ds_read_b64_tr_b16 a[62:63], v35 offset:51200
    v_mfma_f32_16x16x32_bf16 a[144:147], a[116:119], a[20:23], a[144:147]
    v_mfma_f32_16x16x32_bf16 a[148:151], a[120:123], a[16:19], a[148:151]
    v_mfma_f32_16x16x32_bf16 a[148:151], a[124:127], a[20:23], a[148:151]
    v_mfma_f32_16x16x32_bf16 v[76:79], a[64:67], a[24:27], v[76:79]
    v_mfma_f32_16x16x32_bf16 v[76:79], a[68:71], a[28:31], v[76:79]
    v_mfma_f32_16x16x32_bf16 v[172:175], a[72:75], a[24:27], v[172:175]
    v_mfma_f32_16x16x32_bf16 v[172:175], a[76:79], a[28:31], v[172:175]
    v_mfma_f32_16x16x32_bf16 v[108:111], a[80:83], a[24:27], v[108:111]
    v_mfma_f32_16x16x32_bf16 v[108:111], a[84:87], a[28:31], v[108:111]
    v_mfma_f32_16x16x32_bf16 v[204:207], a[88:91], a[24:27], v[204:207]
    v_mfma_f32_16x16x32_bf16 v[204:207], a[92:95], a[28:31], v[204:207]
    v_mfma_f32_16x16x32_bf16 v[140:143], a[96:99], a[24:27], v[140:143]
    v_mfma_f32_16x16x32_bf16 v[140:143], a[100:103], a[28:31], v[140:143]
    v_mfma_f32_16x16x32_bf16 v[236:239], a[104:107], a[24:27], v[236:239]
    v_mfma_f32_16x16x32_bf16 v[236:239], a[108:111], a[28:31], v[236:239]
    v_mfma_f32_16x16x32_bf16 a[152:155], a[112:115], a[24:27], a[152:155]
    v_mfma_f32_16x16x32_bf16 a[152:155], a[116:119], a[28:31], a[152:155]
    v_mfma_f32_16x16x32_bf16 a[156:159], a[120:123], a[24:27], a[156:159]
    v_mfma_f32_16x16x32_bf16 a[156:159], a[124:127], a[28:31], a[156:159]
    s_waitcnt vmcnt(0) lgkmcnt(0)
    s_barrier
    v_mfma_f32_16x16x32_bf16 v[80:83], a[64:67], a[32:35], v[80:83]
    v_mfma_f32_16x16x32_bf16 v[80:83], a[68:71], a[36:39], v[80:83]
    s_add_u32 m0, s48, 32768
    ds_read_b128 a[192:195], v26 offset:0
    v_mfma_f32_16x16x32_bf16 v[176:179], a[72:75], a[32:35], v[176:179]
    buffer_load_dwordx4 v10, s[16:19], s49 offen offset:0 lds
    ds_read_b64_tr_b16 a[0:1], v28 offset:0
    v_mfma_f32_16x16x32_bf16 v[176:179], a[76:79], a[36:39], v[176:179]
    ds_read_b128 a[196:199], v27 offset:0
    v_mfma_f32_16x16x32_bf16 v[112:115], a[80:83], a[32:35], v[112:115]
    buffer_load_dwordx4 v11, s[16:19], s49 offen offset:1024 lds
    v_mfma_f32_16x16x32_bf16 v[112:115], a[84:87], a[36:39], v[112:115]
    ds_read_b64_tr_b16 a[2:3], v28 offset:2048
    v_mfma_f32_16x16x32_bf16 v[208:211], a[88:91], a[32:35], v[208:211]
    v_mfma_f32_16x16x32_bf16 v[208:211], a[92:95], a[36:39], v[208:211]
    ds_read_b128 a[200:203], v26 offset:2048
    v_mfma_f32_16x16x32_bf16 v[144:147], a[96:99], a[32:35], v[144:147]
    buffer_load_dwordx4 v12, s[16:19], s49 offen offset:2048 lds
    ds_read_b64_tr_b16 a[4:5], v28 offset:16384
    v_mfma_f32_16x16x32_bf16 v[144:147], a[100:103], a[36:39], v[144:147]
    v_mfma_f32_16x16x32_bf16 v[240:243], a[104:107], a[32:35], v[240:243]
    ds_read_b128 a[204:207], v27 offset:2048
    v_mfma_f32_16x16x32_bf16 v[240:243], a[108:111], a[36:39], v[240:243]
    buffer_load_dwordx4 v13, s[16:19], s49 offen offset:3072 lds
    v_mfma_f32_16x16x32_bf16 a[160:163], a[112:115], a[32:35], a[160:163]
    ds_read_b64_tr_b16 a[6:7], v28 offset:18432
    v_mfma_f32_16x16x32_bf16 a[160:163], a[116:119], a[36:39], a[160:163]
    s_add_u32 m0, s48, 36864
    ds_read_b128 a[208:211], v26 offset:4096
    v_mfma_f32_16x16x32_bf16 a[164:167], a[120:123], a[32:35], a[164:167]
    v_mfma_f32_16x16x32_bf16 a[164:167], a[124:127], a[36:39], a[164:167]
    buffer_load_dwordx4 v14, s[16:19], s49 offen offset:0 lds
    ds_read_b64_tr_b16 a[8:9], v29 offset:0
    v_mfma_f32_16x16x32_bf16 v[84:87], a[64:67], a[40:43], v[84:87]
    v_mfma_f32_16x16x32_bf16 v[84:87], a[68:71], a[44:47], v[84:87]
    ds_read_b128 a[212:215], v27 offset:4096
    v_mfma_f32_16x16x32_bf16 v[180:183], a[72:75], a[40:43], v[180:183]
    buffer_load_dwordx4 v15, s[16:19], s49 offen offset:1024 lds
    ds_read_b64_tr_b16 a[10:11], v29 offset:2048
    v_mfma_f32_16x16x32_bf16 v[180:183], a[76:79], a[44:47], v[180:183]
    v_mfma_f32_16x16x32_bf16 v[116:119], a[80:83], a[40:43], v[116:119]
    ds_read_b128 a[216:219], v26 offset:6144
    v_mfma_f32_16x16x32_bf16 v[116:119], a[84:87], a[44:47], v[116:119]
    v_mfma_f32_16x16x32_bf16 v[212:215], a[88:91], a[40:43], v[212:215]
    buffer_load_dwordx4 v16, s[16:19], s49 offen offset:2048 lds
    ds_read_b64_tr_b16 a[12:13], v29 offset:16384
    v_mfma_f32_16x16x32_bf16 v[212:215], a[92:95], a[44:47], v[212:215]
    ds_read_b128 a[220:223], v27 offset:6144
    v_mfma_f32_16x16x32_bf16 v[148:151], a[96:99], a[40:43], v[148:151]
    v_mfma_f32_16x16x32_bf16 v[148:151], a[100:103], a[44:47], v[148:151]
    buffer_load_dwordx4 v17, s[16:19], s49 offen offset:3072 lds
    ds_read_b64_tr_b16 a[14:15], v29 offset:18432
    v_mfma_f32_16x16x32_bf16 v[244:247], a[104:107], a[40:43], v[244:247]
    ds_read_b128 a[224:227], v26 offset:8192
    v_mfma_f32_16x16x32_bf16 v[244:247], a[108:111], a[44:47], v[244:247]
    s_add_u32 s49, s49, 128
    v_mfma_f32_16x16x32_bf16 a[168:171], a[112:115], a[40:43], a[168:171]
    s_add_u32 m0, s48, 98304
    ds_read_b64_tr_b16 a[16:17], v30 offset:0
    v_mfma_f32_16x16x32_bf16 a[168:171], a[116:119], a[44:47], a[168:171]
    buffer_load_dwordx4 v18, s[20:23], s50 offen offset:0 lds
    v_mfma_f32_16x16x32_bf16 a[172:175], a[120:123], a[40:43], a[172:175]
    ds_read_b128 a[228:231], v27 offset:8192
    v_mfma_f32_16x16x32_bf16 a[172:175], a[124:127], a[44:47], a[172:175]
    ds_read_b64_tr_b16 a[18:19], v30 offset:2048
    v_mfma_f32_16x16x32_bf16 v[88:91], a[64:67], a[48:51], v[88:91]
    buffer_load_dwordx4 v19, s[20:23], s50 offen offset:1024 lds
    v_mfma_f32_16x16x32_bf16 v[88:91], a[68:71], a[52:55], v[88:91]
    ds_read_b128 a[232:235], v26 offset:10240
    v_mfma_f32_16x16x32_bf16 v[184:187], a[72:75], a[48:51], v[184:187]
    v_mfma_f32_16x16x32_bf16 v[184:187], a[76:79], a[52:55], v[184:187]
    buffer_load_dwordx4 v20, s[20:23], s50 offen offset:2048 lds
    ds_read_b64_tr_b16 a[20:21], v30 offset:16384
    v_mfma_f32_16x16x32_bf16 v[120:123], a[80:83], a[48:51], v[120:123]
    ds_read_b128 a[236:239], v27 offset:10240
    v_mfma_f32_16x16x32_bf16 v[120:123], a[84:87], a[52:55], v[120:123]
    v_mfma_f32_16x16x32_bf16 v[216:219], a[88:91], a[48:51], v[216:219]
    ds_read_b64_tr_b16 a[22:23], v30 offset:18432
    v_mfma_f32_16x16x32_bf16 v[216:219], a[92:95], a[52:55], v[216:219]
    buffer_load_dwordx4 v21, s[20:23], s50 offen offset:3072 lds
    v_mfma_f32_16x16x32_bf16 v[152:155], a[96:99], a[48:51], v[152:155]
    s_add_u32 m0, s48, 102400
    ds_read_b128 a[240:243], v26 offset:12288
    v_mfma_f32_16x16x32_bf16 v[152:155], a[100:103], a[52:55], v[152:155]
    ds_read_b64_tr_b16 a[24:25], v31 offset:0
    v_mfma_f32_16x16x32_bf16 v[248:251], a[104:107], a[48:51], v[248:251]
    buffer_load_dwordx4 v22, s[20:23], s50 offen offset:0 lds
    v_mfma_f32_16x16x32_bf16 v[248:251], a[108:111], a[52:55], v[248:251]
    ds_read_b128 a[244:247], v27 offset:12288
    v_mfma_f32_16x16x32_bf16 a[176:179], a[112:115], a[48:51], a[176:179]
    v_mfma_f32_16x16x32_bf16 a[176:179], a[116:119], a[52:55], a[176:179]
    ds_read_b64_tr_b16 a[26:27], v31 offset:2048
    v_mfma_f32_16x16x32_bf16 a[180:183], a[120:123], a[48:51], a[180:183]
    buffer_load_dwordx4 v23, s[20:23], s50 offen offset:1024 lds
    ds_read_b128 a[248:251], v26 offset:14336
    v_mfma_f32_16x16x32_bf16 a[180:183], a[124:127], a[52:55], a[180:183]
    v_mfma_f32_16x16x32_bf16 v[92:95], a[64:67], a[56:59], v[92:95]
    ds_read_b64_tr_b16 a[28:29], v31 offset:16384
    v_mfma_f32_16x16x32_bf16 v[92:95], a[68:71], a[60:63], v[92:95]
    buffer_load_dwordx4 v24, s[20:23], s50 offen offset:2048 lds
    v_mfma_f32_16x16x32_bf16 v[188:191], a[72:75], a[56:59], v[188:191]
    ds_read_b128 a[252:255], v27 offset:14336
    v_mfma_f32_16x16x32_bf16 v[188:191], a[76:79], a[60:63], v[188:191]
    ds_read_b64_tr_b16 a[30:31], v31 offset:18432
    v_mfma_f32_16x16x32_bf16 v[124:127], a[80:83], a[56:59], v[124:127]
    v_mfma_f32_16x16x32_bf16 v[124:127], a[84:87], a[60:63], v[124:127]
    buffer_load_dwordx4 v25, s[20:23], s50 offen offset:3072 lds
    v_mfma_f32_16x16x32_bf16 v[220:223], a[88:91], a[56:59], v[220:223]
    v_mfma_f32_16x16x32_bf16 v[220:223], a[92:95], a[60:63], v[220:223]
    s_add_u32 s50, s50, 0x80000
    v_mfma_f32_16x16x32_bf16 v[156:159], a[96:99], a[56:59], v[156:159]
    v_mfma_f32_16x16x32_bf16 v[156:159], a[100:103], a[60:63], v[156:159]
    s_cmp_eq_u32 s51, s53
    s_cbranch_scc1 k12_ool_42
k12_oolret_43:
    v_mfma_f32_16x16x32_bf16 v[252:255], a[104:107], a[56:59], v[252:255]
    s_cmp_eq_u32 s51, s63
    s_cbranch_scc1 k12_ool_44
k12_oolret_45:
    v_mfma_f32_16x16x32_bf16 v[252:255], a[108:111], a[60:63], v[252:255]
    s_cmp_eq_u32 s51, 5
    s_cbranch_scc1 k12_ool_46
k12_oolret_47:
    v_mfma_f32_16x16x32_bf16 a[184:187], a[112:115], a[56:59], a[184:187]
    v_mfma_f32_16x16x32_bf16 a[184:187], a[116:119], a[60:63], a[184:187]
    s_add_u32 s51, s51, 1
    v_mfma_f32_16x16x32_bf16 a[188:191], a[120:123], a[56:59], a[188:191]
    v_mfma_f32_16x16x32_bf16 a[188:191], a[124:127], a[60:63], a[188:191]
    s_waitcnt lgkmcnt(0)
    s_branch k12_loop_28
k12_last_29:
    v_mfma_f32_16x16x32_bf16 v[64:67], a[64:67], a[0:3], v[64:67]
    buffer_load_dwordx4 a[192:195], v36, s[8:11], s62 offen sc1
    v_mfma_f32_16x16x32_bf16 v[64:67], a[68:71], a[4:7], v[64:67]
    ds_read_b64_tr_b16 a[32:33], v32 offset:32768
    v_mfma_f32_16x16x32_bf16 v[160:163], a[72:75], a[0:3], v[160:163]
    buffer_load_dwordx4 a[196:199], v54, s[8:11], s62 offen sc1
    ds_read_b64_tr_b16 a[34:35], v32 offset:34816
    v_mfma_f32_16x16x32_bf16 v[160:163], a[76:79], a[4:7], v[160:163]
    v_mfma_f32_16x16x32_bf16 v[96:99], a[80:83], a[0:3], v[96:99]
    buffer_load_dwordx4 a[200:203], v37, s[8:11], s62 offen sc1
    v_mfma_f32_16x16x32_bf16 v[96:99], a[84:87], a[4:7], v[96:99]
    ds_read_b64_tr_b16 a[36:37], v32 offset:49152
    v_mfma_f32_16x16x32_bf16 v[192:195], a[88:91], a[0:3], v[192:195]
    buffer_load_dwordx4 a[204:207], v55, s[8:11], s62 offen sc1
    v_mfma_f32_16x16x32_bf16 v[192:195], a[92:95], a[4:7], v[192:195]
    s_add_u32 s62, s62, 0x20000
    buffer_load_dwordx4 a[208:211], v36, s[8:11], s62 offen sc1
    ds_read_b64_tr_b16 a[38:39], v32 offset:51200
    v_mfma_f32_16x16x32_bf16 v[128:131], a[96:99], a[0:3], v[128:131]
    v_mfma_f32_16x16x32_bf16 v[128:131], a[100:103], a[4:7], v[128:131]
    v_cvt_pk_bf16_f32 v64, v64, v65
    v_cvt_pk_bf16_f32 v65, v66, v67
    v_mfma_f32_16x16x32_bf16 v[224:227], a[104:107], a[0:3], v[224:227]
    v_cvt_pk_bf16_f32 v66, v160, v161
    v_cvt_pk_bf16_f32 v67, v162, v163
    v_mfma_f32_16x16x32_bf16 v[224:227], a[108:111], a[4:7], v[224:227]
    buffer_load_dwordx4 a[212:215], v54, s[8:11], s62 offen sc1
    ds_read_b64_tr_b16 a[40:41], v33 offset:32768
    v_mfma_f32_16x16x32_bf16 a[128:131], a[112:115], a[0:3], a[128:131]
    buffer_load_dwordx4 a[216:219], v37, s[8:11], s62 offen sc1
    ds_read_b64_tr_b16 a[42:43], v33 offset:34816
    v_mfma_f32_16x16x32_bf16 a[128:131], a[116:119], a[4:7], a[128:131]
    v_cvt_pk_bf16_f32 v96, v96, v97
    v_cvt_pk_bf16_f32 v97, v98, v99
    v_mfma_f32_16x16x32_bf16 a[132:135], a[120:123], a[0:3], a[132:135]
    v_cvt_pk_bf16_f32 v98, v192, v193
    v_cvt_pk_bf16_f32 v99, v194, v195
    v_mfma_f32_16x16x32_bf16 a[132:135], a[124:127], a[4:7], a[132:135]
    buffer_load_dwordx4 a[220:223], v55, s[8:11], s62 offen sc1
    ds_read_b64_tr_b16 a[44:45], v33 offset:49152
    v_mfma_f32_16x16x32_bf16 v[68:71], a[64:67], a[8:11], v[68:71]
    s_add_u32 s62, s62, 0x20000
    buffer_load_dwordx4 a[224:227], v36, s[8:11], s62 offen sc1
    v_mfma_f32_16x16x32_bf16 v[68:71], a[68:71], a[12:15], v[68:71]
    v_cvt_pk_bf16_f32 v128, v128, v129
    v_cvt_pk_bf16_f32 v129, v130, v131
    v_mfma_f32_16x16x32_bf16 v[164:167], a[72:75], a[8:11], v[164:167]
    buffer_load_dwordx4 a[228:231], v54, s[8:11], s62 offen sc1
    ds_read_b64_tr_b16 a[46:47], v33 offset:51200
    v_mfma_f32_16x16x32_bf16 v[164:167], a[76:79], a[12:15], v[164:167]
    v_cvt_pk_bf16_f32 v130, v224, v225
    v_cvt_pk_bf16_f32 v131, v226, v227
    v_mfma_f32_16x16x32_bf16 v[100:103], a[80:83], a[8:11], v[100:103]
    buffer_load_dwordx4 a[232:235], v37, s[8:11], s62 offen sc1
    ds_read_b64_tr_b16 a[48:49], v34 offset:32768
    v_mfma_f32_16x16x32_bf16 v[100:103], a[84:87], a[12:15], v[100:103]
    v_accvgpr_read_b32 v56, a128
    v_accvgpr_read_b32 v57, a129
    v_mfma_f32_16x16x32_bf16 v[196:199], a[88:91], a[8:11], v[196:199]
    buffer_load_dwordx4 a[236:239], v55, s[8:11], s62 offen sc1
    ds_read_b64_tr_b16 a[50:51], v34 offset:34816
    v_mfma_f32_16x16x32_bf16 v[196:199], a[92:95], a[12:15], v[196:199]
    s_add_u32 s62, s62, 0x20000
    v_accvgpr_read_b32 v58, a130
    v_accvgpr_read_b32 v59, a131
    v_mfma_f32_16x16x32_bf16 v[132:135], a[96:99], a[8:11], v[132:135]
    v_accvgpr_read_b32 v60, a132
    v_accvgpr_read_b32 v61, a133
    v_mfma_f32_16x16x32_bf16 v[132:135], a[100:103], a[12:15], v[132:135]
    v_accvgpr_read_b32 v62, a134
    v_accvgpr_read_b32 v63, a135
    v_mfma_f32_16x16x32_bf16 v[228:231], a[104:107], a[8:11], v[228:231]
    buffer_load_dwordx4 a[240:243], v36, s[8:11], s62 offen sc1
    ds_read_b64_tr_b16 a[52:53], v34 offset:49152
    v_mfma_f32_16x16x32_bf16 v[228:231], a[108:111], a[12:15], v[228:231]
    v_cvt_pk_bf16_f32 v160, v56, v57
    v_cvt_pk_bf16_f32 v161, v58, v59
    v_mfma_f32_16x16x32_bf16 a[136:139], a[112:115], a[8:11], a[136:139]
    v_cvt_pk_bf16_f32 v68, v68, v69
    v_cvt_pk_bf16_f32 v162, v60, v61
    v_mfma_f32_16x16x32_bf16 a[136:139], a[116:119], a[12:15], a[136:139]
    buffer_load_dwordx4 a[244:247], v54, s[8:11], s62 offen sc1
    v_cvt_pk_bf16_f32 v69, v70, v71
    v_mfma_f32_16x16x32_bf16 a[140:143], a[120:123], a[8:11], a[140:143]
    v_cvt_pk_bf16_f32 v163, v62, v63
    v_cvt_pk_bf16_f32 v70, v164, v165
    v_mfma_f32_16x16x32_bf16 a[140:143], a[124:127], a[12:15], a[140:143]
    buffer_load_dwordx4 a[248:251], v37, s[8:11], s62 offen sc1
    v_cvt_pk_bf16_f32 v71, v166, v167
    v_mfma_f32_16x16x32_bf16 v[72:75], a[64:67], a[16:19], v[72:75]
    ds_read_b64_tr_b16 a[54:55], v34 offset:51200
    v_cvt_pk_bf16_f32 v100, v100, v101
    v_mfma_f32_16x16x32_bf16 v[72:75], a[68:71], a[20:23], v[72:75]
    buffer_load_dwordx4 a[252:255], v55, s[8:11], s62 offen sc1
    v_cvt_pk_bf16_f32 v101, v102, v103
    v_mfma_f32_16x16x32_bf16 v[168:171], a[72:75], a[16:19], v[168:171]
    s_add_u32 s62, s62, 0x20000
    ds_read_b64_tr_b16 a[56:57], v35 offset:32768
    v_cvt_pk_bf16_f32 v102, v196, v197
    v_mfma_f32_16x16x32_bf16 v[168:171], a[76:79], a[20:23], v[168:171]
    s_add_u32 s52, s47, 0
    ds_read_b64_tr_b16 a[58:59], v35 offset:34816
    v_cvt_pk_bf16_f32 v103, v198, v199
    v_mfma_f32_16x16x32_bf16 v[104:107], a[80:83], a[16:19], v[104:107]
    v_cvt_pk_bf16_f32 v132, v132, v133
    v_cvt_pk_bf16_f32 v133, v134, v135
    v_mfma_f32_16x16x32_bf16 v[104:107], a[84:87], a[20:23], v[104:107]
    v_cvt_pk_bf16_f32 v134, v228, v229
    v_cvt_pk_bf16_f32 v135, v230, v231
    v_mfma_f32_16x16x32_bf16 v[200:203], a[88:91], a[16:19], v[200:203]
    buffer_store_dwordx4 v[64:67], v1, s[32:35], s52 offen offset:0 sc1
    ds_read_b64_tr_b16 a[60:61], v35 offset:49152
    v_mfma_f32_16x16x32_bf16 v[200:203], a[92:95], a[20:23], v[200:203]
    v_accvgpr_read_b32 v56, a136
    v_accvgpr_read_b32 v57, a137
    v_mfma_f32_16x16x32_bf16 v[136:139], a[96:99], a[16:19], v[136:139]
    ds_read_b64_tr_b16 a[62:63], v35 offset:51200
    v_accvgpr_read_b32 v58, a138
    v_mfma_f32_16x16x32_bf16 v[136:139], a[100:103], a[20:23], v[136:139]
    v_accvgpr_read_b32 v59, a139
    v_accvgpr_read_b32 v60, a140
    v_mfma_f32_16x16x32_bf16 v[232:235], a[104:107], a[16:19], v[232:235]
    v_accvgpr_read_b32 v61, a141
    v_accvgpr_read_b32 v62, a142
    v_mfma_f32_16x16x32_bf16 v[232:235], a[108:111], a[20:23], v[232:235]
    s_add_u32 s52, s47, 8192
    v_accvgpr_read_b32 v63, a143
    v_cvt_pk_bf16_f32 v164, v56, v57
    v_mfma_f32_16x16x32_bf16 a[144:147], a[112:115], a[16:19], a[144:147]
    v_cvt_pk_bf16_f32 v165, v58, v59
    v_cvt_pk_bf16_f32 v72, v72, v73
    v_mfma_f32_16x16x32_bf16 a[144:147], a[116:119], a[20:23], a[144:147]
    v_cvt_pk_bf16_f32 v166, v60, v61
    v_cvt_pk_bf16_f32 v73, v74, v75
    v_mfma_f32_16x16x32_bf16 a[148:151], a[120:123], a[16:19], a[148:151]
    v_cvt_pk_bf16_f32 v167, v62, v63
    v_cvt_pk_bf16_f32 v74, v168, v169
    v_mfma_f32_16x16x32_bf16 a[148:151], a[124:127], a[20:23], a[148:151]
    v_cvt_pk_bf16_f32 v75, v170, v171
    v_cvt_pk_bf16_f32 v104, v104, v105
    v_mfma_f32_16x16x32_bf16 v[76:79], a[64:67], a[24:27], v[76:79]
    v_cvt_pk_bf16_f32 v105, v106, v107
    v_cvt_pk_bf16_f32 v106, v200, v201
    v_mfma_f32_16x16x32_bf16 v[76:79], a[68:71], a[28:31], v[76:79]
    buffer_store_dwordx4 v[96:99], v1, s[32:35], s52 offen offset:0 sc1
    v_mfma_f32_16x16x32_bf16 v[172:175], a[72:75], a[24:27], v[172:175]
    v_cvt_pk_bf16_f32 v107, v202, v203
    v_cvt_pk_bf16_f32 v136, v136, v137
    v_mfma_f32_16x16x32_bf16 v[172:175], a[76:79], a[28:31], v[172:175]
    v_cvt_pk_bf16_f32 v137, v138, v139
    v_cvt_pk_bf16_f32 v138, v232, v233
    v_mfma_f32_16x16x32_bf16 v[108:111], a[80:83], a[24:27], v[108:111]
    v_cvt_pk_bf16_f32 v139, v234, v235
    v_mfma_f32_16x16x32_bf16 v[108:111], a[84:87], a[28:31], v[108:111]
    v_accvgpr_read_b32 v56, a144
    v_accvgpr_read_b32 v57, a145
    v_mfma_f32_16x16x32_bf16 v[204:207], a[88:91], a[24:27], v[204:207]
    v_accvgpr_read_b32 v58, a146
    v_accvgpr_read_b32 v59, a147
    v_mfma_f32_16x16x32_bf16 v[204:207], a[92:95], a[28:31], v[204:207]
    s_add_u32 s52, s47, 524288
    v_accvgpr_read_b32 v60, a148
    v_accvgpr_read_b32 v61, a149
    v_mfma_f32_16x16x32_bf16 v[140:143], a[96:99], a[24:27], v[140:143]
    v_accvgpr_read_b32 v62, a150
    v_accvgpr_read_b32 v63, a151
    v_mfma_f32_16x16x32_bf16 v[140:143], a[100:103], a[28:31], v[140:143]
    v_cvt_pk_bf16_f32 v168, v56, v57
    v_cvt_pk_bf16_f32 v169, v58, v59
    v_mfma_f32_16x16x32_bf16 v[236:239], a[104:107], a[24:27], v[236:239]
    v_cvt_pk_bf16_f32 v76, v76, v77
    v_cvt_pk_bf16_f32 v170, v60, v61
    v_mfma_f32_16x16x32_bf16 v[236:239], a[108:111], a[28:31], v[236:239]
    buffer_store_dwordx4 v[128:131], v1, s[32:35], s52 offen offset:0 sc1
    v_mfma_f32_16x16x32_bf16 a[152:155], a[112:115], a[24:27], a[152:155]
    s_waitcnt lgkmcnt(0)
    v_cvt_pk_bf16_f32 v77, v78, v79
    v_cvt_pk_bf16_f32 v171, v62, v63
    v_mfma_f32_16x16x32_bf16 a[152:155], a[116:119], a[28:31], a[152:155]
    v_cvt_pk_bf16_f32 v78, v172, v173
    v_cvt_pk_bf16_f32 v79, v174, v175
    v_mfma_f32_16x16x32_bf16 a[156:159], a[120:123], a[24:27], a[156:159]
    v_cvt_pk_bf16_f32 v108, v108, v109
    v_cvt_pk_bf16_f32 v109, v110, v111
    v_mfma_f32_16x16x32_bf16 a[156:159], a[124:127], a[28:31], a[156:159]
    v_cvt_pk_bf16_f32 v110, v204, v205
    v_cvt_pk_bf16_f32 v111, v206, v207
    v_mfma_f32_16x16x32_bf16 v[80:83], a[64:67], a[32:35], v[80:83]
    v_mfma_f32_16x16x32_bf16 v[80:83], a[68:71], a[36:39], v[80:83]
    v_cvt_pk_bf16_f32 v140, v140, v141
    v_cvt_pk_bf16_f32 v141, v142, v143
    v_mfma_f32_16x16x32_bf16 v[176:179], a[72:75], a[32:35], v[176:179]
    s_add_u32 s52, s47, 532480
    v_cvt_pk_bf16_f32 v142, v236, v237
    v_cvt_pk_bf16_f32 v143, v238, v239
    v_mfma_f32_16x16x32_bf16 v[176:179], a[76:79], a[36:39], v[176:179]
    buffer_store_dwordx4 v[160:163], v1, s[32:35], s52 offen offset:0 sc1
    v_mfma_f32_16x16x32_bf16 v[112:115], a[80:83], a[32:35], v[112:115]
    v_mfma_f32_16x16x32_bf16 v[112:115], a[84:87], a[36:39], v[112:115]
    v_accvgpr_read_b32 v56, a152
    v_accvgpr_read_b32 v57, a153
    v_mfma_f32_16x16x32_bf16 v[208:211], a[88:91], a[32:35], v[208:211]
    v_accvgpr_read_b32 v58, a154
    v_accvgpr_read_b32 v59, a155
    v_mfma_f32_16x16x32_bf16 v[208:211], a[92:95], a[36:39], v[208:211]
    v_accvgpr_read_b32 v60, a156
    v_accvgpr_read_b32 v61, a157
    v_mfma_f32_16x16x32_bf16 v[144:147], a[96:99], a[32:35], v[144:147]
    v_accvgpr_read_b32 v62, a158
    v_accvgpr_read_b32 v63, a159
    v_mfma_f32_16x16x32_bf16 v[144:147], a[100:103], a[36:39], v[144:147]
    v_cvt_pk_bf16_f32 v172, v56, v57
    v_cvt_pk_bf16_f32 v173, v58, v59
    v_mfma_f32_16x16x32_bf16 v[240:243], a[104:107], a[32:35], v[240:243]
    v_cvt_pk_bf16_f32 v80, v80, v81
    v_cvt_pk_bf16_f32 v174, v60, v61
    v_mfma_f32_16x16x32_bf16 v[240:243], a[108:111], a[36:39], v[240:243]
    v_cvt_pk_bf16_f32 v81, v82, v83
    v_cvt_pk_bf16_f32 v175, v62, v63
    v_mfma_f32_16x16x32_bf16 a[160:163], a[112:115], a[32:35], a[160:163]
    v_cvt_pk_bf16_f32 v82, v176, v177
    v_cvt_pk_bf16_f32 v83, v178, v179
    v_mfma_f32_16x16x32_bf16 a[160:163], a[116:119], a[36:39], a[160:163]
    v_cvt_pk_bf16_f32 v112, v112, v113
    v_cvt_pk_bf16_f32 v113, v114, v115
    v_mfma_f32_16x16x32_bf16 a[164:167], a[120:123], a[32:35], a[164:167]
    s_add_u32 s52, s47, 0
    v_cvt_pk_bf16_f32 v114, v208, v209
    v_cvt_pk_bf16_f32 v115, v210, v211
    v_mfma_f32_16x16x32_bf16 a[164:167], a[124:127], a[36:39], a[164:167]
    buffer_store_dwordx4 v[68:71], v1, s[32:35], s52 offen offset:1024 sc1
    v_mfma_f32_16x16x32_bf16 v[84:87], a[64:67], a[40:43], v[84:87]
    v_mfma_f32_16x16x32_bf16 v[84:87], a[68:71], a[44:47], v[84:87]
    v_cvt_pk_bf16_f32 v144, v144, v145
    v_cvt_pk_bf16_f32 v145, v146, v147
    v_mfma_f32_16x16x32_bf16 v[180:183], a[72:75], a[40:43], v[180:183]
    v_cvt_pk_bf16_f32 v146, v240, v241
    v_cvt_pk_bf16_f32 v147, v242, v243
    v_mfma_f32_16x16x32_bf16 v[180:183], a[76:79], a[44:47], v[180:183]
    v_mfma_f32_16x16x32_bf16 v[116:119], a[80:83], a[40:43], v[116:119]
    v_mfma_f32_16x16x32_bf16 v[116:119], a[84:87], a[44:47], v[116:119]
    v_accvgpr_read_b32 v56, a160
    v_accvgpr_read_b32 v57, a161
    v_mfma_f32_16x16x32_bf16 v[212:215], a[88:91], a[40:43], v[212:215]
    v_accvgpr_read_b32 v58, a162
    v_accvgpr_read_b32 v59, a163
    v_mfma_f32_16x16x32_bf16 v[212:215], a[92:95], a[44:47], v[212:215]
    v_accvgpr_read_b32 v60, a164
    v_accvgpr_read_b32 v61, a165
    v_mfma_f32_16x16x32_bf16 v[148:151], a[96:99], a[40:43], v[148:151]
    v_accvgpr_read_b32 v62, a166
    v_accvgpr_read_b32 v63, a167
    v_mfma_f32_16x16x32_bf16 v[148:151], a[100:103], a[44:47], v[148:151]
    s_add_u32 s52, s47, 8192
    v_cvt_pk_bf16_f32 v176, v56, v57
    v_cvt_pk_bf16_f32 v177, v58, v59
    v_mfma_f32_16x16x32_bf16 v[244:247], a[104:107], a[40:43], v[244:247]
    v_cvt_pk_bf16_f32 v84, v84, v85
    v_cvt_pk_bf16_f32 v178, v60, v61
    v_mfma_f32_16x16x32_bf16 v[244:247], a[108:111], a[44:47], v[244:247]
    v_cvt_pk_bf16_f32 v85, v86, v87
    v_cvt_pk_bf16_f32 v179, v62, v63
    v_mfma_f32_16x16x32_bf16 a[168:171], a[112:115], a[40:43], a[168:171]
    v_cvt_pk_bf16_f32 v86, v180, v181
    v_cvt_pk_bf16_f32 v87, v182, v183
    v_mfma_f32_16x16x32_bf16 a[168:171], a[116:119], a[44:47], a[168:171]
    buffer_store_dwordx4 v[100:103], v1, s[32:35], s52 offen offset:1024 sc1
    v_mfma_f32_16x16x32_bf16 a[172:175], a[120:123], a[40:43], a[172:175]
    v_cvt_pk_bf16_f32 v116, v116, v117
    v_cvt_pk_bf16_f32 v117, v118, v119
    v_mfma_f32_16x16x32_bf16 a[172:175], a[124:127], a[44:47], a[172:175]
    v_cvt_pk_bf16_f32 v118, v212, v213
    v_cvt_pk_bf16_f32 v119, v214, v215
    v_mfma_f32_16x16x32_bf16 v[88:91], a[64:67], a[48:51], v[88:91]
    s_waitcnt vmcnt(16)
    s_barrier
    v_mfma_f32_16x16x32_bf16 v[88:91], a[68:71], a[52:55], v[88:91]
    ds_read_b64_tr_b16 a[0:1], v42 offset:32768
    v_cvt_pk_bf16_f32 v148, v148, v149
    v_mfma_f32_16x16x32_bf16 v[184:187], a[72:75], a[48:51], v[184:187]
    v_cvt_pk_bf16_f32 v149, v150, v151
    v_cvt_pk_bf16_f32 v150, v244, v245
    v_mfma_f32_16x16x32_bf16 v[184:187], a[76:79], a[52:55], v[184:187]
    ds_read_b64_tr_b16 a[2:3], v42 offset:33792
    v_cvt_pk_bf16_f32 v151, v246, v247
    v_mfma_f32_16x16x32_bf16 v[120:123], a[80:83], a[48:51], v[120:123]
    ds_read_b64_tr_b16 a[4:5], v42 offset:40960
    ds_read_b64_tr_b16 a[6:7], v42 offset:41984
    v_mfma_f32_16x16x32_bf16 v[120:123], a[84:87], a[52:55], v[120:123]
    s_add_u32 s52, s47, 524288
    v_accvgpr_read_b32 v56, a168
    v_accvgpr_read_b32 v57, a169
    v_mfma_f32_16x16x32_bf16 v[216:219], a[88:91], a[48:51], v[216:219]
    v_accvgpr_read_b32 v58, a170
    v_accvgpr_read_b32 v59, a171
    v_mfma_f32_16x16x32_bf16 v[216:219], a[92:95], a[52:55], v[216:219]
    ds_read_b64_tr_b16 a[8:9], v43 offset:32768
    v_accvgpr_read_b32 v60, a172
    v_mfma_f32_16x16x32_bf16 v[152:155], a[96:99], a[48:51], v[152:155]
    buffer_store_dwordx4 v[132:135], v1, s[32:35], s52 offen offset:1024 sc1
    ds_read_b64_tr_b16 a[10:11], v43 offset:33792
    v_mfma_f32_16x16x32_bf16 v[152:155], a[100:103], a[52:55], v[152:155]
    v_accvgpr_read_b32 v61, a173
    v_accvgpr_read_b32 v62, a174
    v_mfma_f32_16x16x32_bf16 v[248:251], a[104:107], a[48:51], v[248:251]
    v_accvgpr_read_b32 v63, a175
    v_cvt_pk_bf16_f32 v180, v56, v57
    v_mfma_f32_16x16x32_bf16 v[248:251], a[108:111], a[52:55], v[248:251]
    v_cvt_pk_bf16_f32 v181, v58, v59
    v_cvt_pk_bf16_f32 v88, v88, v89
    v_mfma_f32_16x16x32_bf16 a[176:179], a[112:115], a[48:51], a[176:179]
    v_cvt_pk_bf16_f32 v182, v60, v61
    v_cvt_pk_bf16_f32 v89, v90, v91
    v_mfma_f32_16x16x32_bf16 a[176:179], a[116:119], a[52:55], a[176:179]
    ds_read_b64_tr_b16 a[12:13], v43 offset:40960
    v_cvt_pk_bf16_f32 v183, v62, v63
    v_mfma_f32_16x16x32_bf16 a[180:183], a[120:123], a[48:51], a[180:183]
    v_cvt_pk_bf16_f32 v90, v184, v185
    v_cvt_pk_bf16_f32 v91, v186, v187
    v_mfma_f32_16x16x32_bf16 a[180:183], a[124:127], a[52:55], a[180:183]
    ds_read_b64_tr_b16 a[14:15], v43 offset:41984
    ds_read_b64_tr_b16 a[16:17], v44 offset:32768
    v_mfma_f32_16x16x32_bf16 v[92:95], a[64:67], a[56:59], v[92:95]
    s_add_u32 s52, s47, 532480
    v_cvt_pk_bf16_f32 v120, v120, v121
    v_cvt_pk_bf16_f32 v121, v122, v123
    v_mfma_f32_16x16x32_bf16 v[92:95], a[68:71], a[60:63], v[92:95]
    ds_read_b64_tr_b16 a[18:19], v44 offset:33792
    v_cvt_pk_bf16_f32 v122, v216, v217
    v_mfma_f32_16x16x32_bf16 v[188:191], a[72:75], a[56:59], v[188:191]
    ds_read_b64_tr_b16 a[20:21], v44 offset:40960
    v_cvt_pk_bf16_f32 v123, v218, v219
    v_mfma_f32_16x16x32_bf16 v[188:191], a[76:79], a[60:63], v[188:191]
    ds_read_b64_tr_b16 a[22:23], v44 offset:41984
    v_cvt_pk_bf16_f32 v152, v152, v153
    v_mfma_f32_16x16x32_bf16 v[124:127], a[80:83], a[56:59], v[124:127]
    v_cvt_pk_bf16_f32 v153, v154, v155
    v_cvt_pk_bf16_f32 v154, v248, v249
    v_mfma_f32_16x16x32_bf16 v[124:127], a[84:87], a[60:63], v[124:127]
    ds_read_b64_tr_b16 a[24:25], v45 offset:32768
    v_cvt_pk_bf16_f32 v155, v250, v251
    v_mfma_f32_16x16x32_bf16 v[220:223], a[88:91], a[56:59], v[220:223]
    buffer_store_dwordx4 v[164:167], v1, s[32:35], s52 offen offset:1024 sc1
    ds_read_b64_tr_b16 a[26:27], v45 offset:33792
    v_mfma_f32_16x16x32_bf16 v[220:223], a[92:95], a[60:63], v[220:223]
    ds_read_b64_tr_b16 a[28:29], v45 offset:40960
    v_accvgpr_read_b32 v56, a176
    v_mfma_f32_16x16x32_bf16 v[156:159], a[96:99], a[56:59], v[156:159]
    v_accvgpr_read_b32 v57, a177
    v_accvgpr_read_b32 v58, a178
    v_mfma_f32_16x16x32_bf16 v[156:159], a[100:103], a[60:63], v[156:159]
    ds_read_b64_tr_b16 a[30:31], v45 offset:41984
    v_accvgpr_read_b32 v59, a179
    v_mfma_f32_16x16x32_bf16 v[252:255], a[104:107], a[56:59], v[252:255]
    v_accvgpr_read_b32 v60, a180
    v_accvgpr_read_b32 v61, a181
    v_mfma_f32_16x16x32_bf16 v[252:255], a[108:111], a[60:63], v[252:255]
    v_accvgpr_read_b32 v62, a182
    v_accvgpr_read_b32 v63, a183
    v_mfma_f32_16x16x32_bf16 a[184:187], a[112:115], a[56:59], a[184:187]
    v_cvt_pk_bf16_f32 v184, v56, v57
    v_cvt_pk_bf16_f32 v185, v58, v59
    v_mfma_f32_16x16x32_bf16 a[184:187], a[116:119], a[60:63], a[184:187]
    v_cvt_pk_bf16_f32 v92, v92, v93
    v_cvt_pk_bf16_f32 v186, v60, v61
    v_mfma_f32_16x16x32_bf16 a[188:191], a[120:123], a[56:59], a[188:191]
    v_cvt_pk_bf16_f32 v93, v94, v95
    v_cvt_pk_bf16_f32 v187, v62, v63
    v_mfma_f32_16x16x32_bf16 a[188:191], a[124:127], a[60:63], a[188:191]
    v_cvt_pk_bf16_f32 v94, v188, v189
    v_cvt_pk_bf16_f32 v95, v190, v191
    v_cvt_pk_bf16_f32 v124, v124, v125
    v_cvt_pk_bf16_f32 v125, v126, v127
    v_cvt_pk_bf16_f32 v126, v220, v221
    v_cvt_pk_bf16_f32 v127, v222, v223
    v_cvt_pk_bf16_f32 v156, v156, v157
    v_cvt_pk_bf16_f32 v157, v158, v159
    v_cvt_pk_bf16_f32 v158, v252, v253
    v_cvt_pk_bf16_f32 v159, v254, v255
    v_accvgpr_read_b32 v56, a184
    v_accvgpr_read_b32 v57, a185
    v_accvgpr_read_b32 v58, a186
    v_accvgpr_read_b32 v59, a187
    v_accvgpr_read_b32 v60, a188
    v_accvgpr_read_b32 v61, a189
    v_accvgpr_read_b32 v62, a190
    v_accvgpr_read_b32 v63, a191
    v_cvt_pk_bf16_f32 v188, v56, v57
    v_cvt_pk_bf16_f32 v189, v58, v59
    v_cvt_pk_bf16_f32 v190, v60, v61
    v_cvt_pk_bf16_f32 v191, v62, v63
k12_join_7:
k12_qcode:
    s_mov_b64 s[48:49], s[32:33]
    s_mov_b32 s51, 0x00020000
    s_cmp_eq_u32 s45, 0
    s_mov_b32 s50, s34
    s_cselect_b32 s56, s30, -1
    s_cselect_b32 s57, -1, s30
    s_waitcnt vmcnt(16) lgkmcnt(0)
    v_mfma_f32_16x16x32_bf16 v[192:195], a[0:3], a[192:195], 0
    v_mfma_f32_16x16x32_bf16 v[192:195], a[4:7], a[208:211], v[192:195]
    buffer_load_dwordx4 a[128:131], v36, s[8:11], s62 offen sc1
    ds_read_b64_tr_b16 a[32:33], v46 offset:32768
    v_mfma_f32_16x16x32_bf16 v[196:199], a[0:3], a[196:199], 0
    ds_read_b64_tr_b16 a[34:35], v46 offset:33792
    v_mfma_f32_16x16x32_bf16 v[196:199], a[4:7], a[212:215], v[196:199]
    ds_read_b64_tr_b16 a[36:37], v46 offset:40960
    v_mfma_f32_16x16x32_bf16 a[64:67], a[0:3], a[200:203], 0
    ds_read_b64_tr_b16 a[38:39], v46 offset:41984
    v_mfma_f32_16x16x32_bf16 a[64:67], a[4:7], a[216:219], a[64:67]
    ds_read_b64_tr_b16 a[40:41], v47 offset:32768
    v_mfma_f32_16x16x32_bf16 a[68:71], a[0:3], a[204:207], 0
    s_lshl_b32 s31, s28, 14
    v_mfma_f32_16x16x32_bf16 a[68:71], a[4:7], a[220:223], a[68:71]
    s_add_u32 s16, s6, s31
    s_addc_u32 s17, s7, 0
    buffer_load_dwordx4 a[132:135], v54, s[8:11], s62 offen sc1
    ds_read_b64_tr_b16 a[42:43], v47 offset:33792
    v_mfma_f32_16x16x32_bf16 v[200:203], a[8:11], a[192:195], 0
    ds_read_b64_tr_b16 a[44:45], v47 offset:40960
    v_mfma_f32_16x16x32_bf16 v[200:203], a[12:15], a[208:211], v[200:203]
    s_add_u32 s20, s16, 0x2000000
    s_addc_u32 s21, s17, 0
    ds_read_b64_tr_b16 a[46:47], v47 offset:41984
    v_mfma_f32_16x16x32_bf16 v[204:207], a[8:11], a[196:199], 0
    ds_read_b64_tr_b16 a[48:49], v48 offset:32768
    v_mfma_f32_16x16x32_bf16 v[204:207], a[12:15], a[212:215], v[204:207]
    s_add_u32 s16, s16, 0x1000000
    s_addc_u32 s17, s17, 0
    v_mfma_f32_16x16x32_bf16 a[72:75], a[8:11], a[200:203], 0
    ds_read_b64_tr_b16 a[50:51], v48 offset:33792
    v_mfma_f32_16x16x32_bf16 a[72:75], a[12:15], a[216:219], a[72:75]
    s_and_b32 s17, s17, 0xffff
    ds_read_b64_tr_b16 a[52:53], v48 offset:40960
    v_mfma_f32_16x16x32_bf16 a[76:79], a[8:11], a[204:207], 0
    buffer_load_dwordx4 a[136:139], v37, s[8:11], s62 offen sc1
    ds_read_b64_tr_b16 a[54:55], v48 offset:41984
    v_mfma_f32_16x16x32_bf16 a[76:79], a[12:15], a[220:223], a[76:79]
    s_and_b32 s21, s21, 0xffff
    v_mfma_f32_16x16x32_bf16 v[208:211], a[16:19], a[192:195], 0
    ds_read_b64_tr_b16 a[56:57], v49 offset:32768
    v_mfma_f32_16x16x32_bf16 v[208:211], a[20:23], a[208:211], v[208:211]
    s_lshl_b32 s31, s29, 20
    ds_read_b64_tr_b16 a[58:59], v49 offset:33792
    v_mfma_f32_16x16x32_bf16 v[212:215], a[16:19], a[196:199], 0
    ds_read_b64_tr_b16 a[60:61], v49 offset:40960
    v_mfma_f32_16x16x32_bf16 v[212:215], a[20:23], a[212:215], v[212:215]
    s_sub_u32 s18, 0xf84000, s31
    v_mfma_f32_16x16x32_bf16 a[80:83], a[16:19], a[200:203], 0
    buffer_load_dwordx4 a[140:143], v55, s[8:11], s62 offen sc1
    ds_read_b64_tr_b16 a[62:63], v49 offset:41984
    v_mfma_f32_16x16x32_bf16 a[80:83], a[20:23], a[216:219], a[80:83]
    s_mov_b32 s22, s18
    v_mfma_f32_16x16x32_bf16 a[84:87], a[16:19], a[204:207], 0
    v_mfma_f32_16x16x32_bf16 a[84:87], a[20:23], a[220:223], a[84:87]
    s_add_u32 s24, s6, 0x4806000
    s_addc_u32 s25, s7, 0
    v_mfma_f32_16x16x32_bf16 v[216:219], a[24:27], a[192:195], 0
    v_mfma_f32_16x16x32_bf16 v[216:219], a[28:31], a[208:211], v[216:219]
    s_and_b32 s25, s25, 0xffff
    v_mfma_f32_16x16x32_bf16 v[220:223], a[24:27], a[196:199], 0
    s_add_u32 s62, s62, 0x20000
    v_mfma_f32_16x16x32_bf16 v[220:223], a[28:31], a[212:215], v[220:223]
    s_mov_b32 s26, 4096
    v_mfma_f32_16x16x32_bf16 a[88:91], a[24:27], a[200:203], 0
    s_cmp_eq_u32 s45, 0
    s_cbranch_scc1 k12_ool_48
k12_oolret_49:
    v_mfma_f32_16x16x32_bf16 a[88:91], a[28:31], a[216:219], a[88:91]
    v_mfma_f32_16x16x32_bf16 a[92:95], a[24:27], a[204:207], 0
    v_mfma_f32_16x16x32_bf16 a[92:95], a[28:31], a[220:223], a[92:95]
    s_waitcnt vmcnt(28) lgkmcnt(0)
    s_barrier
    v_mfma_f32_16x16x32_bf16 v[224:227], a[32:35], a[192:195], 0
    v_mfma_f32_16x16x32_bf16 v[224:227], a[36:39], a[208:211], v[224:227]
    s_add_u32 m0, s60, 98304
    ds_read_b64_tr_b16 a[0:1], v42 offset:49152
    ds_read_b64_tr_b16 a[2:3], v42 offset:50176
    v_mfma_f32_16x16x32_bf16 v[228:231], a[32:35], a[196:199], 0
    buffer_load_dwordx4 v38, s[12:15], s61 offen offset:0 lds
    v_mfma_f32_16x16x32_bf16 v[228:231], a[36:39], a[212:215], v[228:231]
    ds_read_b64_tr_b16 a[4:5], v42 offset:57344
    v_mfma_f32_16x16x32_bf16 a[96:99], a[32:35], a[200:203], 0
    buffer_load_dwordx4 v39, s[12:15], s61 offen offset:1024 lds
    ds_read_b64_tr_b16 a[6:7], v42 offset:58368
    v_mfma_f32_16x16x32_bf16 a[96:99], a[36:39], a[216:219], a[96:99]
    ds_read_b64_tr_b16 a[8:9], v43 offset:49152
    v_mfma_f32_16x16x32_bf16 a[100:103], a[32:35], a[204:207], 0
    v_mfma_f32_16x16x32_bf16 a[100:103], a[36:39], a[220:223], a[100:103]
    buffer_load_dwordx4 v40, s[12:15], s61 offen offset:2048 lds
    ds_read_b64_tr_b16 a[10:11], v43 offset:50176
    v_mfma_f32_16x16x32_bf16 v[232:235], a[40:43], a[192:195], 0
    ds_read_b64_tr_b16 a[12:13], v43 offset:57344
    v_mfma_f32_16x16x32_bf16 v[232:235], a[44:47], a[208:211], v[232:235]
    ds_read_b64_tr_b16 a[14:15], v43 offset:58368
    v_mfma_f32_16x16x32_bf16 v[236:239], a[40:43], a[196:199], 0
    buffer_load_dwordx4 v41, s[12:15], s61 offen offset:3072 lds
    ds_read_b64_tr_b16 a[16:17], v44 offset:49152
    v_mfma_f32_16x16x32_bf16 v[236:239], a[44:47], a[212:215], v[236:239]
    v_mfma_f32_16x16x32_bf16 a[104:107], a[40:43], a[200:203], 0
    s_add_u32 s61, s61, 0x80000
    ds_read_b64_tr_b16 a[18:19], v44 offset:50176
    v_mfma_f32_16x16x32_bf16 a[104:107], a[44:47], a[216:219], a[104:107]
    buffer_load_dwordx4 a[144:147], v36, s[8:11], s62 offen sc1
    ds_read_b64_tr_b16 a[20:21], v44 offset:57344
    v_mfma_f32_16x16x32_bf16 a[108:111], a[40:43], a[204:207], 0
    ds_read_b64_tr_b16 a[22:23], v44 offset:58368
    v_mfma_f32_16x16x32_bf16 a[108:111], a[44:47], a[220:223], a[108:111]
    buffer_load_dwordx4 a[148:151], v54, s[8:11], s62 offen sc1
    v_mfma_f32_16x16x32_bf16 v[240:243], a[48:51], a[192:195], 0
    ds_read_b64_tr_b16 a[24:25], v45 offset:49152
    v_mfma_f32_16x16x32_bf16 v[240:243], a[52:55], a[208:211], v[240:243]
    ds_read_b64_tr_b16 a[26:27], v45 offset:50176
    v_mfma_f32_16x16x32_bf16 v[244:247], a[48:51], a[196:199], 0
    buffer_load_dwordx4 a[152:155], v37, s[8:11], s62 offen sc1
    ds_read_b64_tr_b16 a[28:29], v45 offset:57344
    v_mfma_f32_16x16x32_bf16 v[244:247], a[52:55], a[212:215], v[244:247]
    v_mfma_f32_16x16x32_bf16 a[112:115], a[48:51], a[200:203], 0
    ds_read_b64_tr_b16 a[30:31], v45 offset:58368
    v_mfma_f32_16x16x32_bf16 a[112:115], a[52:55], a[216:219], a[112:115]
    buffer_load_dwordx4 a[156:159], v55, s[8:11], s62 offen sc1
    v_mfma_f32_16x16x32_bf16 a[116:119], a[48:51], a[204:207], 0
    v_mfma_f32_16x16x32_bf16 a[116:119], a[52:55], a[220:223], a[116:119]
    s_add_u32 s62, s62, 0x20000
    v_mfma_f32_16x16x32_bf16 v[248:251], a[56:59], a[192:195], 0
    s_add_u32 s52, s47, 0
    v_mfma_f32_16x16x32_bf16 v[248:251], a[60:63], a[208:211], v[248:251]
    buffer_store_dwordx4 v[72:75], v1, s[48:51], s52 offen offset:2048 sc1
    v_mfma_f32_16x16x32_bf16 v[252:255], a[56:59], a[196:199], 0
    v_mfma_f32_16x16x32_bf16 v[252:255], a[60:63], a[212:215], v[252:255]
    v_mfma_f32_16x16x32_bf16 a[120:123], a[56:59], a[200:203], 0
    v_mfma_f32_16x16x32_bf16 a[120:123], a[60:63], a[216:219], a[120:123]
    v_mfma_f32_16x16x32_bf16 a[124:127], a[56:59], a[204:207], 0
    v_mfma_f32_16x16x32_bf16 a[124:127], a[60:63], a[220:223], a[124:127]
    s_waitcnt vmcnt(21) lgkmcnt(0)
    v_mfma_f32_16x16x32_bf16 v[192:195], a[0:3], a[224:227], v[192:195]
    v_mfma_f32_16x16x32_bf16 v[192:195], a[4:7], a[240:243], v[192:195]
    buffer_load_dwordx4 a[160:163], v36, s[8:11], s62 offen sc1
    ds_read_b64_tr_b16 a[32:33], v46 offset:49152
    v_mfma_f32_16x16x32_bf16 v[196:199], a[0:3], a[228:231], v[196:199]
    ds_read_b64_tr_b16 a[34:35], v46 offset:50176
    v_mfma_f32_16x16x32_bf16 v[196:199], a[4:7], a[244:247], v[196:199]
    ds_read_b64_tr_b16 a[36:37], v46 offset:57344
    v_mfma_f32_16x16x32_bf16 a[64:67], a[0:3], a[232:235], a[64:67]
    ds_read_b64_tr_b16 a[38:39], v46 offset:58368
    v_mfma_f32_16x16x32_bf16 a[64:67], a[4:7], a[248:251], a[64:67]
    ds_read_b64_tr_b16 a[40:41], v47 offset:49152
    v_mfma_f32_16x16x32_bf16 a[68:71], a[0:3], a[236:239], a[68:71]
    buffer_load_dwordx4 a[164:167], v54, s[8:11], s62 offen sc1
    v_mfma_f32_16x16x32_bf16 a[68:71], a[4:7], a[252:255], a[68:71]
    ds_read_b64_tr_b16 a[42:43], v47 offset:50176
    v_mfma_f32_16x16x32_bf16 v[200:203], a[8:11], a[224:227], v[200:203]
    ds_read_b64_tr_b16 a[44:45], v47 offset:57344
    v_mfma_f32_16x16x32_bf16 v[200:203], a[12:15], a[240:243], v[200:203]
    ds_read_b64_tr_b16 a[46:47], v47 offset:58368
    v_mfma_f32_16x16x32_bf16 v[204:207], a[8:11], a[228:231], v[204:207]
    ds_read_b64_tr_b16 a[48:49], v48 offset:49152
    v_mfma_f32_16x16x32_bf16 v[204:207], a[12:15], a[244:247], v[204:207]
    buffer_load_dwordx4 a[168:171], v37, s[8:11], s62 offen sc1
    v_mfma_f32_16x16x32_bf16 a[72:75], a[8:11], a[232:235], a[72:75]
    ds_read_b64_tr_b16 a[50:51], v48 offset:50176
    v_mfma_f32_16x16x32_bf16 a[72:75], a[12:15], a[248:251], a[72:75]
    ds_read_b64_tr_b16 a[52:53], v48 offset:57344
    v_mfma_f32_16x16x32_bf16 a[76:79], a[8:11], a[236:239], a[76:79]
    ds_read_b64_tr_b16 a[54:55], v48 offset:58368
    v_mfma_f32_16x16x32_bf16 a[76:79], a[12:15], a[252:255], a[76:79]
    v_mfma_f32_16x16x32_bf16 v[208:211], a[16:19], a[224:227], v[208:211]
    ds_read_b64_tr_b16 a[56:57], v49 offset:49152
    v_mfma_f32_16x16x32_bf16 v[208:211], a[20:23], a[240:243], v[208:211]
    buffer_load_dwordx4 a[172:175], v55, s[8:11], s62 offen sc1
    ds_read_b64_tr_b16 a[58:59], v49 offset:50176
    v_mfma_f32_16x16x32_bf16 v[212:215], a[16:19], a[228:231], v[212:215]
    ds_read_b64_tr_b16 a[60:61], v49 offset:57344
    v_mfma_f32_16x16x32_bf16 v[212:215], a[20:23], a[244:247], v[212:215]
    v_mfma_f32_16x16x32_bf16 a[80:83], a[16:19], a[232:235], a[80:83]
    ds_read_b64_tr_b16 a[62:63], v49 offset:58368
    v_mfma_f32_16x16x32_bf16 a[80:83], a[20:23], a[248:251], a[80:83]
    s_add_u32 s62, s62, 0x20000
    v_mfma_f32_16x16x32_bf16 a[84:87], a[16:19], a[236:239], a[84:87]
    s_add_u32 s52, s47, 0
    v_mfma_f32_16x16x32_bf16 a[84:87], a[20:23], a[252:255], a[84:87]
    buffer_store_dwordx4 v[76:79], v1, s[48:51], s52 offen offset:3072 sc1
    v_mfma_f32_16x16x32_bf16 v[216:219], a[24:27], a[224:227], v[216:219]
    v_mfma_f32_16x16x32_bf16 v[216:219], a[28:31], a[240:243], v[216:219]
    v_mfma_f32_16x16x32_bf16 v[220:223], a[24:27], a[228:231], v[220:223]
    v_mfma_f32_16x16x32_bf16 v[220:223], a[28:31], a[244:247], v[220:223]
    v_mfma_f32_16x16x32_bf16 a[88:91], a[24:27], a[232:235], a[88:91]
    s_cmp_eq_u32 s45, 0
    s_cbranch_scc1 k12_ool_50
k12_oolret_51:
    v_mfma_f32_16x16x32_bf16 a[88:91], a[28:31], a[248:251], a[88:91]
    v_mfma_f32_16x16x32_bf16 a[92:95], a[24:27], a[236:239], a[92:95]
    v_mfma_f32_16x16x32_bf16 a[92:95], a[28:31], a[252:255], a[92:95]
    s_waitcnt vmcnt(10) lgkmcnt(0)
    s_barrier
    v_mfma_f32_16x16x32_bf16 v[224:227], a[32:35], a[224:227], v[224:227]
    v_mfma_f32_16x16x32_bf16 v[224:227], a[36:39], a[240:243], v[224:227]
    s_add_u32 m0, s60, 114688
    ds_read_b64_tr_b16 a[0:1], v42 offset:0
    ds_read_b64_tr_b16 a[2:3], v42 offset:1024
    v_mfma_f32_16x16x32_bf16 v[228:231], a[32:35], a[228:231], v[228:231]
    buffer_load_dwordx4 v38, s[12:15], s61 offen offset:0 lds
    v_mfma_f32_16x16x32_bf16 v[228:231], a[36:39], a[244:247], v[228:231]
    ds_read_b64_tr_b16 a[4:5], v42 offset:8192
    v_mfma_f32_16x16x32_bf16 a[96:99], a[32:35], a[232:235], a[96:99]
    buffer_load_dwordx4 v39, s[12:15], s61 offen offset:1024 lds
    ds_read_b64_tr_b16 a[6:7], v42 offset:9216
    v_mfma_f32_16x16x32_bf16 a[96:99], a[36:39], a[248:251], a[96:99]
    ds_read_b64_tr_b16 a[8:9], v43 offset:0
    v_mfma_f32_16x16x32_bf16 a[100:103], a[32:35], a[236:239], a[100:103]
    v_mfma_f32_16x16x32_bf16 a[100:103], a[36:39], a[252:255], a[100:103]
    buffer_load_dwordx4 v40, s[12:15], s61 offen offset:2048 lds
    ds_read_b64_tr_b16 a[10:11], v43 offset:1024
    v_mfma_f32_16x16x32_bf16 v[232:235], a[40:43], a[224:227], v[232:235]
    ds_read_b64_tr_b16 a[12:13], v43 offset:8192
    v_mfma_f32_16x16x32_bf16 v[232:235], a[44:47], a[240:243], v[232:235]
    ds_read_b64_tr_b16 a[14:15], v43 offset:9216
    v_mfma_f32_16x16x32_bf16 v[236:239], a[40:43], a[228:231], v[236:239]
    buffer_load_dwordx4 v41, s[12:15], s61 offen offset:3072 lds
    ds_read_b64_tr_b16 a[16:17], v44 offset:0
    v_mfma_f32_16x16x32_bf16 v[236:239], a[44:47], a[244:247], v[236:239]
    v_mfma_f32_16x16x32_bf16 a[104:107], a[40:43], a[232:235], a[104:107]
    s_add_u32 s61, s61, 0x80000
    ds_read_b64_tr_b16 a[18:19], v44 offset:1024
    v_mfma_f32_16x16x32_bf16 a[104:107], a[44:47], a[248:251], a[104:107]
    buffer_load_dwordx4 a[176:179], v36, s[8:11], s62 offen sc1
    ds_read_b64_tr_b16 a[20:21], v44 offset:8192
    v_mfma_f32_16x16x32_bf16 a[108:111], a[40:43], a[236:239], a[108:111]
    ds_read_b64_tr_b16 a[22:23], v44 offset:9216
    v_mfma_f32_16x16x32_bf16 a[108:111], a[44:47], a[252:255], a[108:111]
    buffer_load_dwordx4 a[180:183], v54, s[8:11], s62 offen sc1
    v_mfma_f32_16x16x32_bf16 v[240:243], a[48:51], a[224:227], v[240:243]
    ds_read_b64_tr_b16 a[24:25], v45 offset:0
    v_mfma_f32_16x16x32_bf16 v[240:243], a[52:55], a[240:243], v[240:243]
    ds_read_b64_tr_b16 a[26:27], v45 offset:1024
    v_mfma_f32_16x16x32_bf16 v[244:247], a[48:51], a[228:231], v[244:247]
    buffer_load_dwordx4 a[184:187], v37, s[8:11], s62 offen sc1
    ds_read_b64_tr_b16 a[28:29], v45 offset:8192
    v_mfma_f32_16x16x32_bf16 v[244:247], a[52:55], a[244:247], v[244:247]
    v_mfma_f32_16x16x32_bf16 a[112:115], a[48:51], a[232:235], a[112:115]
    ds_read_b64_tr_b16 a[30:31], v45 offset:9216
    v_mfma_f32_16x16x32_bf16 a[112:115], a[52:55], a[248:251], a[112:115]
    buffer_load_dwordx4 a[188:191], v55, s[8:11], s62 offen sc1
    v_mfma_f32_16x16x32_bf16 a[116:119], a[48:51], a[236:239], a[116:119]
    v_mfma_f32_16x16x32_bf16 a[116:119], a[52:55], a[252:255], a[116:119]
    s_add_u32 s62, s62, 0x20000
    v_mfma_f32_16x16x32_bf16 v[248:251], a[56:59], a[224:227], v[248:251]
    s_add_u32 s52, s47, 4096
    v_mfma_f32_16x16x32_bf16 v[248:251], a[60:63], a[240:243], v[248:251]
    buffer_store_dwordx4 v[80:83], v1, s[48:51], s52 offen offset:0 sc1
    v_mfma_f32_16x16x32_bf16 v[252:255], a[56:59], a[228:231], v[252:255]
    v_mfma_f32_16x16x32_bf16 v[252:255], a[60:63], a[244:247], v[252:255]
    v_mfma_f32_16x16x32_bf16 a[120:123], a[56:59], a[232:235], a[120:123]
    v_mfma_f32_16x16x32_bf16 a[120:123], a[60:63], a[248:251], a[120:123]
    v_mfma_f32_16x16x32_bf16 a[124:127], a[56:59], a[236:239], a[124:127]
    v_mfma_f32_16x16x32_bf16 a[124:127], a[60:63], a[252:255], a[124:127]
    s_waitcnt vmcnt(15) lgkmcnt(0)
    v_mfma_f32_16x16x32_bf16 v[192:195], a[0:3], a[128:131], v[192:195]
    v_mfma_f32_16x16x32_bf16 v[192:195], a[4:7], a[144:147], v[192:195]
    buffer_load_dwordx4 a[192:195], v36, s[8:11], s62 offen sc1
    ds_read_b64_tr_b16 a[32:33], v46 offset:0
    v_mfma_f32_16x16x32_bf16 v[196:199], a[0:3], a[132:135], v[196:199]
    ds_read_b64_tr_b16 a[34:35], v46 offset:1024
    v_mfma_f32_16x16x32_bf16 v[196:199], a[4:7], a[148:151], v[196:199]
    ds_read_b64_tr_b16 a[36:37], v46 offset:8192
    v_mfma_f32_16x16x32_bf16 a[64:67], a[0:3], a[136:139], a[64:67]
    ds_read_b64_tr_b16 a[38:39], v46 offset:9216
    v_mfma_f32_16x16x32_bf16 a[64:67], a[4:7], a[152:155], a[64:67]
    ds_read_b64_tr_b16 a[40:41], v47 offset:0
    v_mfma_f32_16x16x32_bf16 a[68:71], a[0:3], a[140:143], a[68:71]
    buffer_load_dwordx4 a[196:199], v54, s[8:11], s62 offen sc1
    v_mfma_f32_16x16x32_bf16 a[68:71], a[4:7], a[156:159], a[68:71]
    ds_read_b64_tr_b16 a[42:43], v47 offset:1024
    v_mfma_f32_16x16x32_bf16 v[200:203], a[8:11], a[128:131], v[200:203]
    ds_read_b64_tr_b16 a[44:45], v47 offset:8192
    v_mfma_f32_16x16x32_bf16 v[200:203], a[12:15], a[144:147], v[200:203]
    ds_read_b64_tr_b16 a[46:47], v47 offset:9216
    v_mfma_f32_16x16x32_bf16 v[204:207], a[8:11], a[132:135], v[204:207]
    ds_read_b64_tr_b16 a[48:49], v48 offset:0
    v_mfma_f32_16x16x32_bf16 v[204:207], a[12:15], a[148:151], v[204:207]
    buffer_load_dwordx4 a[200:203], v37, s[8:11], s62 offen sc1
    v_mfma_f32_16x16x32_bf16 a[72:75], a[8:11], a[136:139], a[72:75]
    ds_read_b64_tr_b16 a[50:51], v48 offset:1024
    v_mfma_f32_16x16x32_bf16 a[72:75], a[12:15], a[152:155], a[72:75]
    ds_read_b64_tr_b16 a[52:53], v48 offset:8192
    v_mfma_f32_16x16x32_bf16 a[76:79], a[8:11], a[140:143], a[76:79]
    ds_read_b64_tr_b16 a[54:55], v48 offset:9216
    v_mfma_f32_16x16x32_bf16 a[76:79], a[12:15], a[156:159], a[76:79]
    v_mfma_f32_16x16x32_bf16 v[208:211], a[16:19], a[128:131], v[208:211]
    ds_read_b64_tr_b16 a[56:57], v49 offset:0
    v_mfma_f32_16x16x32_bf16 v[208:211], a[20:23], a[144:147], v[208:211]
    buffer_load_dwordx4 a[204:207], v55, s[8:11], s62 offen sc1
    ds_read_b64_tr_b16 a[58:59], v49 offset:1024
    v_mfma_f32_16x16x32_bf16 v[212:215], a[16:19], a[132:135], v[212:215]
    ds_read_b64_tr_b16 a[60:61], v49 offset:8192
    v_mfma_f32_16x16x32_bf16 v[212:215], a[20:23], a[148:151], v[212:215]
    v_mfma_f32_16x16x32_bf16 a[80:83], a[16:19], a[136:139], a[80:83]
    ds_read_b64_tr_b16 a[62:63], v49 offset:9216
    v_mfma_f32_16x16x32_bf16 a[80:83], a[20:23], a[152:155], a[80:83]
    s_add_u32 s62, s62, 0x20000
    v_mfma_f32_16x16x32_bf16 a[84:87], a[16:19], a[140:143], a[84:87]
    s_add_u32 s52, s47, 4096
    v_mfma_f32_16x16x32_bf16 a[84:87], a[20:23], a[156:159], a[84:87]
    buffer_store_dwordx4 v[84:87], v1, s[48:51], s52 offen offset:1024 sc1
    v_mfma_f32_16x16x32_bf16 v[216:219], a[24:27], a[128:131], v[216:219]
    v_mfma_f32_16x16x32_bf16 v[216:219], a[28:31], a[144:147], v[216:219]
    v_mfma_f32_16x16x32_bf16 v[220:223], a[24:27], a[132:135], v[220:223]
    v_mfma_f32_16x16x32_bf16 v[220:223], a[28:31], a[148:151], v[220:223]
    v_mfma_f32_16x16x32_bf16 a[88:91], a[24:27], a[136:139], a[88:91]
    v_mfma_f32_16x16x32_bf16 a[88:91], a[28:31], a[152:155], a[88:91]
    v_mfma_f32_16x16x32_bf16 a[92:95], a[24:27], a[140:143], a[92:95]
    v_mfma_f32_16x16x32_bf16 a[92:95], a[28:31], a[156:159], a[92:95]
    s_waitcnt vmcnt(10) lgkmcnt(0)
    s_barrier
    v_mfma_f32_16x16x32_bf16 v[224:227], a[32:35], a[128:131], v[224:227]
    v_mfma_f32_16x16x32_bf16 v[224:227], a[36:39], a[144:147], v[224:227]
    s_add_u32 m0, s60, 131072
    ds_read_b64_tr_b16 a[0:1], v42 offset:16384
    ds_read_b64_tr_b16 a[2:3], v42 offset:17408
    v_mfma_f32_16x16x32_bf16 v[228:231], a[32:35], a[132:135], v[228:231]
    buffer_load_dwordx4 v38, s[12:15], s61 offen offset:0 lds
    v_mfma_f32_16x16x32_bf16 v[228:231], a[36:39], a[148:151], v[228:231]
    ds_read_b64_tr_b16 a[4:5], v42 offset:24576
    v_mfma_f32_16x16x32_bf16 a[96:99], a[32:35], a[136:139], a[96:99]
    buffer_load_dwordx4 v39, s[12:15], s61 offen offset:1024 lds
    ds_read_b64_tr_b16 a[6:7], v42 offset:25600
    v_mfma_f32_16x16x32_bf16 a[96:99], a[36:39], a[152:155], a[96:99]
    ds_read_b64_tr_b16 a[8:9], v43 offset:16384
    v_mfma_f32_16x16x32_bf16 a[100:103], a[32:35], a[140:143], a[100:103]
    v_mfma_f32_16x16x32_bf16 a[100:103], a[36:39], a[156:159], a[100:103]
    buffer_load_dwordx4 v40, s[12:15], s61 offen offset:2048 lds
    ds_read_b64_tr_b16 a[10:11], v43 offset:17408
    v_mfma_f32_16x16x32_bf16 v[232:235], a[40:43], a[128:131], v[232:235]
    ds_read_b64_tr_b16 a[12:13], v43 offset:24576
    v_mfma_f32_16x16x32_bf16 v[232:235], a[44:47], a[144:147], v[232:235]
    ds_read_b64_tr_b16 a[14:15], v43 offset:25600
    v_mfma_f32_16x16x32_bf16 v[236:239], a[40:43], a[132:135], v[236:239]
    ds_read_b64_tr_b16 a[16:17], v44 offset:16384
    v_mfma_f32_16x16x32_bf16 v[236:239], a[44:47], a[148:151], v[236:239]
    buffer_load_dwordx4 v41, s[12:15], s61 offen offset:3072 lds
    v_mfma_f32_16x16x32_bf16 a[104:107], a[40:43], a[136:139], a[104:107]
    ds_read_b64_tr_b16 a[18:19], v44 offset:17408
    v_mfma_f32_16x16x32_bf16 a[104:107], a[44:47], a[152:155], a[104:107]
    s_add_u32 s61, s61, 0x80000
    ds_read_b64_tr_b16 a[20:21], v44 offset:24576
    v_mfma_f32_16x16x32_bf16 a[108:111], a[40:43], a[140:143], a[108:111]
    buffer_load_dwordx4 a[208:211], v36, s[8:11], s62 offen sc1
    ds_read_b64_tr_b16 a[22:23], v44 offset:25600
    v_mfma_f32_16x16x32_bf16 a[108:111], a[44:47], a[156:159], a[108:111]
    v_mfma_f32_16x16x32_bf16 v[240:243], a[48:51], a[128:131], v[240:243]
    ds_read_b64_tr_b16 a[24:25], v45 offset:16384
    v_mfma_f32_16x16x32_bf16 v[240:243], a[52:55], a[144:147], v[240:243]
    buffer_load_dwordx4 a[212:215], v54, s[8:11], s62 offen sc1
    ds_read_b64_tr_b16 a[26:27], v45 offset:17408
    v_mfma_f32_16x16x32_bf16 v[244:247], a[48:51], a[132:135], v[244:247]
    ds_read_b64_tr_b16 a[28:29], v45 offset:24576
    v_mfma_f32_16x16x32_bf16 v[244:247], a[52:55], a[148:151], v[244:247]
    v_mfma_f32_16x16x32_bf16 a[112:115], a[48:51], a[136:139], a[112:115]
    buffer_load_dwordx4 a[216:219], v37, s[8:11], s62 offen sc1
    ds_read_b64_tr_b16 a[30:31], v45 offset:25600
    v_mfma_f32_16x16x32_bf16 a[112:115], a[52:55], a[152:155], a[112:115]
    v_mfma_f32_16x16x32_bf16 a[116:119], a[48:51], a[140:143], a[116:119]
    v_mfma_f32_16x16x32_bf16 a[116:119], a[52:55], a[156:159], a[116:119]
    v_mfma_f32_16x16x32_bf16 v[248:251], a[56:59], a[128:131], v[248:251]
    buffer_load_dwordx4 a[220:223], v55, s[8:11], s62 offen sc1
    v_mfma_f32_16x16x32_bf16 v[248:251], a[60:63], a[144:147], v[248:251]
    v_mfma_f32_16x16x32_bf16 v[252:255], a[56:59], a[132:135], v[252:255]
    s_add_u32 s62, s62, 0x20000
    v_mfma_f32_16x16x32_bf16 v[252:255], a[60:63], a[148:151], v[252:255]
    v_mfma_f32_16x16x32_bf16 a[120:123], a[56:59], a[136:139], a[120:123]
    s_cmp_eq_u32 s45, 0
    s_cbranch_scc1 k12_ool_52
k12_oolret_53:
    v_mfma_f32_16x16x32_bf16 a[120:123], a[60:63], a[152:155], a[120:123]
    v_mfma_f32_16x16x32_bf16 a[124:127], a[56:59], a[140:143], a[124:127]
    v_mfma_f32_16x16x32_bf16 a[124:127], a[60:63], a[156:159], a[124:127]
    s_waitcnt vmcnt(14) lgkmcnt(0)
    v_mfma_f32_16x16x32_bf16 v[192:195], a[0:3], a[160:163], v[192:195]
    v_mfma_f32_16x16x32_bf16 v[192:195], a[4:7], a[176:179], v[192:195]
    buffer_load_dwordx4 a[224:227], v36, s[8:11], s62 offen sc1
    ds_read_b64_tr_b16 a[32:33], v46 offset:16384
    v_mfma_f32_16x16x32_bf16 v[196:199], a[0:3], a[164:167], v[196:199]
    ds_read_b64_tr_b16 a[34:35], v46 offset:17408
    v_mfma_f32_16x16x32_bf16 v[196:199], a[4:7], a[180:183], v[196:199]
    ds_read_b64_tr_b16 a[36:37], v46 offset:24576
    v_mfma_f32_16x16x32_bf16 a[64:67], a[0:3], a[168:171], a[64:67]
    ds_read_b64_tr_b16 a[38:39], v46 offset:25600
    v_mfma_f32_16x16x32_bf16 a[64:67], a[4:7], a[184:187], a[64:67]
    ds_read_b64_tr_b16 a[40:41], v47 offset:16384
    v_mfma_f32_16x16x32_bf16 a[68:71], a[0:3], a[172:175], a[68:71]
    buffer_load_dwordx4 a[228:231], v54, s[8:11], s62 offen sc1
    v_mfma_f32_16x16x32_bf16 a[68:71], a[4:7], a[188:191], a[68:71]
    ds_read_b64_tr_b16 a[42:43], v47 offset:17408
    v_mfma_f32_16x16x32_bf16 v[200:203], a[8:11], a[160:163], v[200:203]
    ds_read_b64_tr_b16 a[44:45], v47 offset:24576
    v_mfma_f32_16x16x32_bf16 v[200:203], a[12:15], a[176:179], v[200:203]
    ds_read_b64_tr_b16 a[46:47], v47 offset:25600
    v_mfma_f32_16x16x32_bf16 v[204:207], a[8:11], a[164:167], v[204:207]
    ds_read_b64_tr_b16 a[48:49], v48 offset:16384
    v_mfma_f32_16x16x32_bf16 v[204:207], a[12:15], a[180:183], v[204:207]
    buffer_load_dwordx4 a[232:235], v37, s[8:11], s62 offen sc1
    v_mfma_f32_16x16x32_bf16 a[72:75], a[8:11], a[168:171], a[72:75]
    ds_read_b64_tr_b16 a[50:51], v48 offset:17408
    v_mfma_f32_16x16x32_bf16 a[72:75], a[12:15], a[184:187], a[72:75]
    ds_read_b64_tr_b16 a[52:53], v48 offset:24576
    v_mfma_f32_16x16x32_bf16 a[76:79], a[8:11], a[172:175], a[76:79]
    ds_read_b64_tr_b16 a[54:55], v48 offset:25600
    v_mfma_f32_16x16x32_bf16 a[76:79], a[12:15], a[188:191], a[76:79]
    v_mfma_f32_16x16x32_bf16 v[208:211], a[16:19], a[160:163], v[208:211]
    ds_read_b64_tr_b16 a[56:57], v49 offset:16384
    v_mfma_f32_16x16x32_bf16 v[208:211], a[20:23], a[176:179], v[208:211]
    buffer_load_dwordx4 a[236:239], v55, s[8:11], s62 offen sc1
    ds_read_b64_tr_b16 a[58:59], v49 offset:17408
    v_mfma_f32_16x16x32_bf16 v[212:215], a[16:19], a[164:167], v[212:215]
    ds_read_b64_tr_b16 a[60:61], v49 offset:24576
    v_mfma_f32_16x16x32_bf16 v[212:215], a[20:23], a[180:183], v[212:215]
    v_mfma_f32_16x16x32_bf16 a[80:83], a[16:19], a[168:171], a[80:83]
    ds_read_b64_tr_b16 a[62:63], v49 offset:25600
    v_mfma_f32_16x16x32_bf16 a[80:83], a[20:23], a[184:187], a[80:83]
    s_add_u32 s62, s62, 0x20000
    v_mfma_f32_16x16x32_bf16 a[84:87], a[16:19], a[172:175], a[84:87]
    s_add_u32 s52, s47, 4096
    v_mfma_f32_16x16x32_bf16 a[84:87], a[20:23], a[188:191], a[84:87]
    buffer_store_dwordx4 v[88:91], v1, s[48:51], s52 offen offset:2048 sc1
    v_mfma_f32_16x16x32_bf16 v[216:219], a[24:27], a[160:163], v[216:219]
    v_mfma_f32_16x16x32_bf16 v[216:219], a[28:31], a[176:179], v[216:219]
    v_mfma_f32_16x16x32_bf16 v[220:223], a[24:27], a[164:167], v[220:223]
    v_mfma_f32_16x16x32_bf16 v[220:223], a[28:31], a[180:183], v[220:223]
    v_mfma_f32_16x16x32_bf16 a[88:91], a[24:27], a[168:171], a[88:91]
    v_mfma_f32_16x16x32_bf16 a[88:91], a[28:31], a[184:187], a[88:91]
    v_mfma_f32_16x16x32_bf16 a[92:95], a[24:27], a[172:175], a[92:95]
    v_mfma_f32_16x16x32_bf16 a[92:95], a[28:31], a[188:191], a[92:95]
    s_waitcnt vmcnt(9) lgkmcnt(0)
    s_barrier
    v_mfma_f32_16x16x32_bf16 v[224:227], a[32:35], a[160:163], v[224:227]
    v_mfma_f32_16x16x32_bf16 v[224:227], a[36:39], a[176:179], v[224:227]
    s_add_u32 m0, s60, 147456
    ds_read_b64_tr_b16 a[0:1], v42 offset:32768
    ds_read_b64_tr_b16 a[2:3], v42 offset:33792
    v_mfma_f32_16x16x32_bf16 v[228:231], a[32:35], a[164:167], v[228:231]
    buffer_load_dwordx4 v38, s[12:15], s61 offen offset:0 lds
    v_mfma_f32_16x16x32_bf16 v[228:231], a[36:39], a[180:183], v[228:231]
    ds_read_b64_tr_b16 a[4:5], v42 offset:40960
    v_mfma_f32_16x16x32_bf16 a[96:99], a[32:35], a[168:171], a[96:99]
    buffer_load_dwordx4 v39, s[12:15], s61 offen offset:1024 lds
    ds_read_b64_tr_b16 a[6:7], v42 offset:41984
    v_mfma_f32_16x16x32_bf16 a[96:99], a[36:39], a[184:187], a[96:99]
    ds_read_b64_tr_b16 a[8:9], v43 offset:32768
    v_mfma_f32_16x16x32_bf16 a[100:103], a[32:35], a[172:175], a[100:103]
    v_mfma_f32_16x16x32_bf16 a[100:103], a[36:39], a[188:191], a[100:103]
    buffer_load_dwordx4 v40, s[12:15], s61 offen offset:2048 lds
    ds_read_b64_tr_b16 a[10:11], v43 offset:33792
    v_mfma_f32_16x16x32_bf16 v[232:235], a[40:43], a[160:163], v[232:235]
    ds_read_b64_tr_b16 a[12:13], v43 offset:40960
    v_mfma_f32_16x16x32_bf16 v[232:235], a[44:47], a[176:179], v[232:235]
    ds_read_b64_tr_b16 a[14:15], v43 offset:41984
    v_mfma_f32_16x16x32_bf16 v[236:239], a[40:43], a[164:167], v[236:239]
    buffer_load_dwordx4 v41, s[12:15], s61 offen offset:3072 lds
    ds_read_b64_tr_b16 a[16:17], v44 offset:32768
    v_mfma_f32_16x16x32_bf16 v[236:239], a[44:47], a[180:183], v[236:239]
    v_mfma_f32_16x16x32_bf16 a[104:107], a[40:43], a[168:171], a[104:107]
    s_add_u32 s61, s61, 0x80000
    ds_read_b64_tr_b16 a[18:19], v44 offset:33792
    v_mfma_f32_16x16x32_bf16 a[104:107], a[44:47], a[184:187], a[104:107]
    buffer_load_dwordx4 a[240:243], v36, s[8:11], s62 offen sc1
    ds_read_b64_tr_b16 a[20:21], v44 offset:40960
    v_mfma_f32_16x16x32_bf16 a[108:111], a[40:43], a[172:175], a[108:111]
    ds_read_b64_tr_b16 a[22:23], v44 offset:41984
    v_mfma_f32_16x16x32_bf16 a[108:111], a[44:47], a[188:191], a[108:111]
    buffer_load_dwordx4 a[244:247], v54, s[8:11], s62 offen sc1
    v_mfma_f32_16x16x32_bf16 v[240:243], a[48:51], a[160:163], v[240:243]
    ds_read_b64_tr_b16 a[24:25], v45 offset:32768
    v_mfma_f32_16x16x32_bf16 v[240:243], a[52:55], a[176:179], v[240:243]
    ds_read_b64_tr_b16 a[26:27], v45 offset:33792
    v_mfma_f32_16x16x32_bf16 v[244:247], a[48:51], a[164:167], v[244:247]
    buffer_load_dwordx4 a[248:251], v37, s[8:11], s62 offen sc1
    ds_read_b64_tr_b16 a[28:29], v45 offset:40960
    v_mfma_f32_16x16x32_bf16 v[244:247], a[52:55], a[180:183], v[244:247]
    v_mfma_f32_16x16x32_bf16 a[112:115], a[48:51], a[168:171], a[112:115]
    ds_read_b64_tr_b16 a[30:31], v45 offset:41984
    v_mfma_f32_16x16x32_bf16 a[112:115], a[52:55], a[184:187], a[112:115]
    buffer_load_dwordx4 a[252:255], v55, s[8:11], s62 offen sc1
    v_mfma_f32_16x16x32_bf16 a[116:119], a[48:51], a[172:175], a[116:119]
    v_mfma_f32_16x16x32_bf16 a[116:119], a[52:55], a[188:191], a[116:119]
    s_add_u32 s62, s62, 0x20000
    v_mfma_f32_16x16x32_bf16 v[248:251], a[56:59], a[160:163], v[248:251]
    s_add_u32 s52, s47, 4096
    v_mfma_f32_16x16x32_bf16 v[248:251], a[60:63], a[176:179], v[248:251]
    buffer_store_dwordx4 v[92:95], v1, s[48:51], s52 offen offset:3072 sc1
    v_mfma_f32_16x16x32_bf16 v[252:255], a[56:59], a[164:167], v[252:255]
    v_mfma_f32_16x16x32_bf16 v[252:255], a[60:63], a[180:183], v[252:255]
    v_mfma_f32_16x16x32_bf16 a[120:123], a[56:59], a[168:171], a[120:123]
    s_cmp_eq_u32 s45, 0
    s_cbranch_scc1 k12_ool_54
k12_oolret_55:
    v_mfma_f32_16x16x32_bf16 a[120:123], a[60:63], a[184:187], a[120:123]
    v_mfma_f32_16x16x32_bf16 a[124:127], a[56:59], a[172:175], a[124:127]
    v_mfma_f32_16x16x32_bf16 a[124:127], a[60:63], a[188:191], a[124:127]
    s_waitcnt vmcnt(14) lgkmcnt(0)
    v_mfma_f32_16x16x32_bf16 v[192:195], a[0:3], a[192:195], v[192:195]
    v_mfma_f32_16x16x32_bf16 v[192:195], a[4:7], a[208:211], v[192:195]
    buffer_load_dwordx4 a[128:131], v36, s[8:11], s62 offen sc1
    ds_read_b64_tr_b16 a[32:33], v46 offset:32768
    v_mfma_f32_16x16x32_bf16 v[196:199], a[0:3], a[196:199], v[196:199]
    ds_read_b64_tr_b16 a[34:35], v46 offset:33792
    v_mfma_f32_16x16x32_bf16 v[196:199], a[4:7], a[212:215], v[196:199]
    ds_read_b64_tr_b16 a[36:37], v46 offset:40960
    v_mfma_f32_16x16x32_bf16 a[64:67], a[0:3], a[200:203], a[64:67]
    ds_read_b64_tr_b16 a[38:39], v46 offset:41984
    v_mfma_f32_16x16x32_bf16 a[64:67], a[4:7], a[216:219], a[64:67]
    ds_read_b64_tr_b16 a[40:41], v47 offset:32768
    v_mfma_f32_16x16x32_bf16 a[68:71], a[0:3], a[204:207], a[68:71]
    buffer_load_dwordx4 a[132:135], v54, s[8:11], s62 offen sc1
    v_mfma_f32_16x16x32_bf16 a[68:71], a[4:7], a[220:223], a[68:71]
    ds_read_b64_tr_b16 a[42:43], v47 offset:33792
    v_mfma_f32_16x16x32_bf16 v[200:203], a[8:11], a[192:195], v[200:203]
    ds_read_b64_tr_b16 a[44:45], v47 offset:40960
    v_mfma_f32_16x16x32_bf16 v[200:203], a[12:15], a[208:211], v[200:203]
    ds_read_b64_tr_b16 a[46:47], v47 offset:41984
    v_mfma_f32_16x16x32_bf16 v[204:207], a[8:11], a[196:199], v[204:207]
    ds_read_b64_tr_b16 a[48:49], v48 offset:32768
    v_mfma_f32_16x16x32_bf16 v[204:207], a[12:15], a[212:215], v[204:207]
    buffer_load_dwordx4 a[136:139], v37, s[8:11], s62 offen sc1
    v_mfma_f32_16x16x32_bf16 a[72:75], a[8:11], a[200:203], a[72:75]
    ds_read_b64_tr_b16 a[50:51], v48 offset:33792
    v_mfma_f32_16x16x32_bf16 a[72:75], a[12:15], a[216:219], a[72:75]
    ds_read_b64_tr_b16 a[52:53], v48 offset:40960
    v_mfma_f32_16x16x32_bf16 a[76:79], a[8:11], a[204:207], a[76:79]
    ds_read_b64_tr_b16 a[54:55], v48 offset:41984
    v_mfma_f32_16x16x32_bf16 a[76:79], a[12:15], a[220:223], a[76:79]
    v_mfma_f32_16x16x32_bf16 v[208:211], a[16:19], a[192:195], v[208:211]
    ds_read_b64_tr_b16 a[56:57], v49 offset:32768
    v_mfma_f32_16x16x32_bf16 v[208:211], a[20:23], a[208:211], v[208:211]
    buffer_load_dwordx4 a[140:143], v55, s[8:11], s62 offen sc1
    ds_read_b64_tr_b16 a[58:59], v49 offset:33792
    v_mfma_f32_16x16x32_bf16 v[212:215], a[16:19], a[196:199], v[212:215]
    ds_read_b64_tr_b16 a[60:61], v49 offset:40960
    v_mfma_f32_16x16x32_bf16 v[212:215], a[20:23], a[212:215], v[212:215]
    v_mfma_f32_16x16x32_bf16 a[80:83], a[16:19], a[200:203], a[80:83]
    ds_read_b64_tr_b16 a[62:63], v49 offset:41984
    v_mfma_f32_16x16x32_bf16 a[80:83], a[20:23], a[216:219], a[80:83]
    s_add_u32 s62, s62, 0x20000
    v_mfma_f32_16x16x32_bf16 a[84:87], a[16:19], a[204:207], a[84:87]
    s_add_u32 s52, s47, 8192
    v_mfma_f32_16x16x32_bf16 a[84:87], a[20:23], a[220:223], a[84:87]
    buffer_store_dwordx4 v[104:107], v1, s[48:51], s52 offen offset:2048 sc1
    v_mfma_f32_16x16x32_bf16 v[216:219], a[24:27], a[192:195], v[216:219]
    v_mfma_f32_16x16x32_bf16 v[216:219], a[28:31], a[208:211], v[216:219]
    v_mfma_f32_16x16x32_bf16 v[220:223], a[24:27], a[196:199], v[220:223]
    v_mfma_f32_16x16x32_bf16 v[220:223], a[28:31], a[212:215], v[220:223]
    v_mfma_f32_16x16x32_bf16 a[88:91], a[24:27], a[200:203], a[88:91]
    v_mfma_f32_16x16x32_bf16 a[88:91], a[28:31], a[216:219], a[88:91]
    v_mfma_f32_16x16x32_bf16 a[92:95], a[24:27], a[204:207], a[92:95]
    v_mfma_f32_16x16x32_bf16 a[92:95], a[28:31], a[220:223], a[92:95]
    s_waitcnt vmcnt(10) lgkmcnt(0)
    s_barrier
    v_mfma_f32_16x16x32_bf16 v[224:227], a[32:35], a[192:195], v[224:227]
    v_mfma_f32_16x16x32_bf16 v[224:227], a[36:39], a[208:211], v[224:227]
    s_add_u32 m0, s60, 98304
    ds_read_b64_tr_b16 a[0:1], v42 offset:49152
    ds_read_b64_tr_b16 a[2:3], v42 offset:50176
    v_mfma_f32_16x16x32_bf16 v[228:231], a[32:35], a[196:199], v[228:231]
    buffer_load_dwordx4 v38, s[12:15], s61 offen offset:0 lds
    v_mfma_f32_16x16x32_bf16 v[228:231], a[36:39], a[212:215], v[228:231]
    ds_read_b64_tr_b16 a[4:5], v42 offset:57344
    v_mfma_f32_16x16x32_bf16 a[96:99], a[32:35], a[200:203], a[96:99]
    buffer_load_dwordx4 v39, s[12:15], s61 offen offset:1024 lds
    ds_read_b64_tr_b16 a[6:7], v42 offset:58368
    v_mfma_f32_16x16x32_bf16 a[96:99], a[36:39], a[216:219], a[96:99]
    ds_read_b64_tr_b16 a[8:9], v43 offset:49152
    v_mfma_f32_16x16x32_bf16 a[100:103], a[32:35], a[204:207], a[100:103]
    v_mfma_f32_16x16x32_bf16 a[100:103], a[36:39], a[220:223], a[100:103]
    buffer_load_dwordx4 v40, s[12:15], s61 offen offset:2048 lds
    ds_read_b64_tr_b16 a[10:11], v43 offset:50176
    v_mfma_f32_16x16x32_bf16 v[232:235], a[40:43], a[192:195], v[232:235]
    ds_read_b64_tr_b16 a[12:13], v43 offset:57344
    v_mfma_f32_16x16x32_bf16 v[232:235], a[44:47], a[208:211], v[232:235]
    ds_read_b64_tr_b16 a[14:15], v43 offset:58368
    v_mfma_f32_16x16x32_bf16 v[236:239], a[40:43], a[196:199], v[236:239]
    buffer_load_dwordx4 v41, s[12:15], s61 offen offset:3072 lds
    ds_read_b64_tr_b16 a[16:17], v44 offset:49152
    v_mfma_f32_16x16x32_bf16 v[236:239], a[44:47], a[212:215], v[236:239]
    v_mfma_f32_16x16x32_bf16 a[104:107], a[40:43], a[200:203], a[104:107]
    s_add_u32 s61, s61, 0x80000
    ds_read_b64_tr_b16 a[18:19], v44 offset:50176
    v_mfma_f32_16x16x32_bf16 a[104:107], a[44:47], a[216:219], a[104:107]
    buffer_load_dwordx4 a[144:147], v36, s[8:11], s62 offen sc1
    ds_read_b64_tr_b16 a[20:21], v44 offset:57344
    v_mfma_f32_16x16x32_bf16 a[108:111], a[40:43], a[204:207], a[108:111]
    ds_read_b64_tr_b16 a[22:23], v44 offset:58368
    v_mfma_f32_16x16x32_bf16 a[108:111], a[44:47], a[220:223], a[108:111]
    buffer_load_dwordx4 a[148:151], v54, s[8:11], s62 offen sc1
    v_mfma_f32_16x16x32_bf16 v[240:243], a[48:51], a[192:195], v[240:243]
    ds_read_b64_tr_b16 a[24:25], v45 offset:49152
    v_mfma_f32_16x16x32_bf16 v[240:243], a[52:55], a[208:211], v[240:243]
    ds_read_b64_tr_b16 a[26:27], v45 offset:50176
    v_mfma_f32_16x16x32_bf16 v[244:247], a[48:51], a[196:199], v[244:247]
    buffer_load_dwordx4 a[152:155], v37, s[8:11], s62 offen sc1
    ds_read_b64_tr_b16 a[28:29], v45 offset:57344
    v_mfma_f32_16x16x32_bf16 v[244:247], a[52:55], a[212:215], v[244:247]
    v_mfma_f32_16x16x32_bf16 a[112:115], a[48:51], a[200:203], a[112:115]
    ds_read_b64_tr_b16 a[30:31], v45 offset:58368
    v_mfma_f32_16x16x32_bf16 a[112:115], a[52:55], a[216:219], a[112:115]
    buffer_load_dwordx4 a[156:159], v55, s[8:11], s62 offen sc1
    v_mfma_f32_16x16x32_bf16 a[116:119], a[48:51], a[204:207], a[116:119]
    v_mfma_f32_16x16x32_bf16 a[116:119], a[52:55], a[220:223], a[116:119]
    s_add_u32 s62, s62, 0x20000
    v_mfma_f32_16x16x32_bf16 v[248:251], a[56:59], a[192:195], v[248:251]
    s_add_u32 s52, s47, 8192
    v_mfma_f32_16x16x32_bf16 v[248:251], a[60:63], a[208:211], v[248:251]
    buffer_store_dwordx4 v[108:111], v1, s[48:51], s52 offen offset:3072 sc1
    v_mfma_f32_16x16x32_bf16 v[252:255], a[56:59], a[196:199], v[252:255]
    v_mfma_f32_16x16x32_bf16 v[252:255], a[60:63], a[212:215], v[252:255]
    v_mfma_f32_16x16x32_bf16 a[120:123], a[56:59], a[200:203], a[120:123]
    v_mfma_f32_16x16x32_bf16 a[120:123], a[60:63], a[216:219], a[120:123]
    v_mfma_f32_16x16x32_bf16 a[124:127], a[56:59], a[204:207], a[124:127]
    v_mfma_f32_16x16x32_bf16 a[124:127], a[60:63], a[220:223], a[124:127]
    s_waitcnt vmcnt(15) lgkmcnt(0)
    v_mfma_f32_16x16x32_bf16 v[192:195], a[0:3], a[224:227], v[192:195]
    v_mfma_f32_16x16x32_bf16 v[192:195], a[4:7], a[240:243], v[192:195]
    buffer_load_dwordx4 a[160:163], v36, s[8:11], s62 offen sc1
    ds_read_b64_tr_b16 a[32:33], v46 offset:49152
    v_mfma_f32_16x16x32_bf16 v[196:199], a[0:3], a[228:231], v[196:199]
    ds_read_b64_tr_b16 a[34:35], v46 offset:50176
    v_mfma_f32_16x16x32_bf16 v[196:199], a[4:7], a[244:247], v[196:199]
    ds_read_b64_tr_b16 a[36:37], v46 offset:57344
    v_mfma_f32_16x16x32_bf16 a[64:67], a[0:3], a[232:235], a[64:67]
    ds_read_b64_tr_b16 a[38:39], v46 offset:58368
    v_mfma_f32_16x16x32_bf16 a[64:67], a[4:7], a[248:251], a[64:67]
    ds_read_b64_tr_b16 a[40:41], v47 offset:49152
    v_mfma_f32_16x16x32_bf16 a[68:71], a[0:3], a[236:239], a[68:71]
    buffer_load_dwordx4 a[164:167], v54, s[8:11], s62 offen sc1
    v_mfma_f32_16x16x32_bf16 a[68:71], a[4:7], a[252:255], a[68:71]
    ds_read_b64_tr_b16 a[42:43], v47 offset:50176
    v_mfma_f32_16x16x32_bf16 v[200:203], a[8:11], a[224:227], v[200:203]
    ds_read_b64_tr_b16 a[44:45], v47 offset:57344
    v_mfma_f32_16x16x32_bf16 v[200:203], a[12:15], a[240:243], v[200:203]
    ds_read_b64_tr_b16 a[46:47], v47 offset:58368
    v_mfma_f32_16x16x32_bf16 v[204:207], a[8:11], a[228:231], v[204:207]
    ds_read_b64_tr_b16 a[48:49], v48 offset:49152
    v_mfma_f32_16x16x32_bf16 v[204:207], a[12:15], a[244:247], v[204:207]
    buffer_load_dwordx4 a[168:171], v37, s[8:11], s62 offen sc1
    v_mfma_f32_16x16x32_bf16 a[72:75], a[8:11], a[232:235], a[72:75]
    ds_read_b64_tr_b16 a[50:51], v48 offset:50176
    v_mfma_f32_16x16x32_bf16 a[72:75], a[12:15], a[248:251], a[72:75]
    ds_read_b64_tr_b16 a[52:53], v48 offset:57344
    v_mfma_f32_16x16x32_bf16 a[76:79], a[8:11], a[236:239], a[76:79]
    ds_read_b64_tr_b16 a[54:55], v48 offset:58368
    v_mfma_f32_16x16x32_bf16 a[76:79], a[12:15], a[252:255], a[76:79]
    v_mfma_f32_16x16x32_bf16 v[208:211], a[16:19], a[224:227], v[208:211]
    ds_read_b64_tr_b16 a[56:57], v49 offset:49152
    v_mfma_f32_16x16x32_bf16 v[208:211], a[20:23], a[240:243], v[208:211]
    buffer_load_dwordx4 a[172:175], v55, s[8:11], s62 offen sc1
    ds_read_b64_tr_b16 a[58:59], v49 offset:50176
    v_mfma_f32_16x16x32_bf16 v[212:215], a[16:19], a[228:231], v[212:215]
    ds_read_b64_tr_b16 a[60:61], v49 offset:57344
    v_mfma_f32_16x16x32_bf16 v[212:215], a[20:23], a[244:247], v[212:215]
    v_mfma_f32_16x16x32_bf16 a[80:83], a[16:19], a[232:235], a[80:83]
    ds_read_b64_tr_b16 a[62:63], v49 offset:58368
    v_mfma_f32_16x16x32_bf16 a[80:83], a[20:23], a[248:251], a[80:83]
    s_add_u32 s62, s62, 0x20000
    v_mfma_f32_16x16x32_bf16 a[84:87], a[16:19], a[236:239], a[84:87]
    s_add_u32 s52, s47, 12288
    v_mfma_f32_16x16x32_bf16 a[84:87], a[20:23], a[252:255], a[84:87]
    buffer_store_dwordx4 v[112:115], v1, s[48:51], s52 offen offset:0 sc1
    v_mfma_f32_16x16x32_bf16 v[216:219], a[24:27], a[224:227], v[216:219]
    v_mfma_f32_16x16x32_bf16 v[216:219], a[28:31], a[240:243], v[216:219]
    v_mfma_f32_16x16x32_bf16 v[220:223], a[24:27], a[228:231], v[220:223]
    v_mfma_f32_16x16x32_bf16 v[220:223], a[28:31], a[244:247], v[220:223]
    v_mfma_f32_16x16x32_bf16 a[88:91], a[24:27], a[232:235], a[88:91]
    s_cmp_eq_u32 s45, 0
    s_cbranch_scc1 k12_ool_56
k12_oolret_57:
    v_mfma_f32_16x16x32_bf16 a[88:91], a[28:31], a[248:251], a[88:91]
    v_mfma_f32_16x16x32_bf16 a[92:95], a[24:27], a[236:239], a[92:95]
    v_mfma_f32_16x16x32_bf16 a[92:95], a[28:31], a[252:255], a[92:95]
    s_waitcnt vmcnt(10) lgkmcnt(0)
    s_barrier
    v_mfma_f32_16x16x32_bf16 v[224:227], a[32:35], a[224:227], v[224:227]
    v_mfma_f32_16x16x32_bf16 v[224:227], a[36:39], a[240:243], v[224:227]
    s_add_u32 m0, s60, 114688
    ds_read_b64_tr_b16 a[0:1], v42 offset:0
    ds_read_b64_tr_b16 a[2:3], v42 offset:1024
    v_mfma_f32_16x16x32_bf16 v[228:231], a[32:35], a[228:231], v[228:231]
    buffer_load_dwordx4 v38, s[12:15], s61 offen offset:0 lds
    v_mfma_f32_16x16x32_bf16 v[228:231], a[36:39], a[244:247], v[228:231]
    ds_read_b64_tr_b16 a[4:5], v42 offset:8192
    v_mfma_f32_16x16x32_bf16 a[96:99], a[32:35], a[232:235], a[96:99]
    buffer_load_dwordx4 v39, s[12:15], s61 offen offset:1024 lds
    ds_read_b64_tr_b16 a[6:7], v42 offset:9216
    v_mfma_f32_16x16x32_bf16 a[96:99], a[36:39], a[248:251], a[96:99]
    ds_read_b64_tr_b16 a[8:9], v43 offset:0
    v_mfma_f32_16x16x32_bf16 a[100:103], a[32:35], a[236:239], a[100:103]
    v_mfma_f32_16x16x32_bf16 a[100:103], a[36:39], a[252:255], a[100:103]
    buffer_load_dwordx4 v40, s[12:15], s61 offen offset:2048 lds
    ds_read_b64_tr_b16 a[10:11], v43 offset:1024
    v_mfma_f32_16x16x32_bf16 v[232:235], a[40:43], a[224:227], v[232:235]
    ds_read_b64_tr_b16 a[12:13], v43 offset:8192
    v_mfma_f32_16x16x32_bf16 v[232:235], a[44:47], a[240:243], v[232:235]
    ds_read_b64_tr_b16 a[14:15], v43 offset:9216
    v_mfma_f32_16x16x32_bf16 v[236:239], a[40:43], a[228:231], v[236:239]
    ds_read_b64_tr_b16 a[16:17], v44 offset:0
    v_mfma_f32_16x16x32_bf16 v[236:239], a[44:47], a[244:247], v[236:239]
    buffer_load_dwordx4 v41, s[12:15], s61 offen offset:3072 lds
    v_mfma_f32_16x16x32_bf16 a[104:107], a[40:43], a[232:235], a[104:107]
    ds_read_b64_tr_b16 a[18:19], v44 offset:1024
    v_mfma_f32_16x16x32_bf16 a[104:107], a[44:47], a[248:251], a[104:107]
    s_add_u32 s61, s61, 0x80000
    ds_read_b64_tr_b16 a[20:21], v44 offset:8192
    v_mfma_f32_16x16x32_bf16 a[108:111], a[40:43], a[236:239], a[108:111]
    buffer_load_dwordx4 a[176:179], v36, s[8:11], s62 offen sc1
    ds_read_b64_tr_b16 a[22:23], v44 offset:9216
    v_mfma_f32_16x16x32_bf16 a[108:111], a[44:47], a[252:255], a[108:111]
    v_mfma_f32_16x16x32_bf16 v[240:243], a[48:51], a[224:227], v[240:243]
    ds_read_b64_tr_b16 a[24:25], v45 offset:0
    v_mfma_f32_16x16x32_bf16 v[240:243], a[52:55], a[240:243], v[240:243]
    buffer_load_dwordx4 a[180:183], v54, s[8:11], s62 offen sc1
    ds_read_b64_tr_b16 a[26:27], v45 offset:1024
    v_mfma_f32_16x16x32_bf16 v[244:247], a[48:51], a[228:231], v[244:247]
    ds_read_b64_tr_b16 a[28:29], v45 offset:8192
    v_mfma_f32_16x16x32_bf16 v[244:247], a[52:55], a[244:247], v[244:247]
    v_mfma_f32_16x16x32_bf16 a[112:115], a[48:51], a[232:235], a[112:115]
    buffer_load_dwordx4 a[184:187], v37, s[8:11], s62 offen sc1
    ds_read_b64_tr_b16 a[30:31], v45 offset:9216
    v_mfma_f32_16x16x32_bf16 a[112:115], a[52:55], a[248:251], a[112:115]
    v_mfma_f32_16x16x32_bf16 a[116:119], a[48:51], a[236:239], a[116:119]
    v_mfma_f32_16x16x32_bf16 a[116:119], a[52:55], a[252:255], a[116:119]
    v_mfma_f32_16x16x32_bf16 v[248:251], a[56:59], a[224:227], v[248:251]
    buffer_load_dwordx4 a[188:191], v55, s[8:11], s62 offen sc1
    v_mfma_f32_16x16x32_bf16 v[248:251], a[60:63], a[240:243], v[248:251]
    v_mfma_f32_16x16x32_bf16 v[252:255], a[56:59], a[228:231], v[252:255]
    s_add_u32 s62, s62, 0x20000
    v_mfma_f32_16x16x32_bf16 v[252:255], a[60:63], a[244:247], v[252:255]
    v_mfma_f32_16x16x32_bf16 a[120:123], a[56:59], a[232:235], a[120:123]
    v_mfma_f32_16x16x32_bf16 a[120:123], a[60:63], a[248:251], a[120:123]
    v_mfma_f32_16x16x32_bf16 a[124:127], a[56:59], a[236:239], a[124:127]
    v_mfma_f32_16x16x32_bf16 a[124:127], a[60:63], a[252:255], a[124:127]
    s_waitcnt vmcnt(14) lgkmcnt(0)
    v_mfma_f32_16x16x32_bf16 v[192:195], a[0:3], a[128:131], v[192:195]
    v_mfma_f32_16x16x32_bf16 v[192:195], a[4:7], a[144:147], v[192:195]
    buffer_load_dwordx4 a[192:195], v36, s[8:11], s62 offen sc1
    ds_read_b64_tr_b16 a[32:33], v46 offset:0
    v_mfma_f32_16x16x32_bf16 v[196:199], a[0:3], a[132:135], v[196:199]
    ds_read_b64_tr_b16 a[34:35], v46 offset:1024
    v_mfma_f32_16x16x32_bf16 v[196:199], a[4:7], a[148:151], v[196:199]
    ds_read_b64_tr_b16 a[36:37], v46 offset:8192
    v_mfma_f32_16x16x32_bf16 a[64:67], a[0:3], a[136:139], a[64:67]
    ds_read_b64_tr_b16 a[38:39], v46 offset:9216
    v_mfma_f32_16x16x32_bf16 a[64:67], a[4:7], a[152:155], a[64:67]
    ds_read_b64_tr_b16 a[40:41], v47 offset:0
    v_mfma_f32_16x16x32_bf16 a[68:71], a[0:3], a[140:143], a[68:71]
    buffer_load_dwordx4 a[196:199], v54, s[8:11], s62 offen sc1
    v_mfma_f32_16x16x32_bf16 a[68:71], a[4:7], a[156:159], a[68:71]
    ds_read_b64_tr_b16 a[42:43], v47 offset:1024
    v_mfma_f32_16x16x32_bf16 v[200:203], a[8:11], a[128:131], v[200:203]
    ds_read_b64_tr_b16 a[44:45], v47 offset:8192
    v_mfma_f32_16x16x32_bf16 v[200:203], a[12:15], a[144:147], v[200:203]
    ds_read_b64_tr_b16 a[46:47], v47 offset:9216
    v_mfma_f32_16x16x32_bf16 v[204:207], a[8:11], a[132:135], v[204:207]
    ds_read_b64_tr_b16 a[48:49], v48 offset:0
    v_mfma_f32_16x16x32_bf16 v[204:207], a[12:15], a[148:151], v[204:207]
    buffer_load_dwordx4 a[200:203], v37, s[8:11], s62 offen sc1
    v_mfma_f32_16x16x32_bf16 a[72:75], a[8:11], a[136:139], a[72:75]
    ds_read_b64_tr_b16 a[50:51], v48 offset:1024
    v_mfma_f32_16x16x32_bf16 a[72:75], a[12:15], a[152:155], a[72:75]
    ds_read_b64_tr_b16 a[52:53], v48 offset:8192
    v_mfma_f32_16x16x32_bf16 a[76:79], a[8:11], a[140:143], a[76:79]
    ds_read_b64_tr_b16 a[54:55], v48 offset:9216
    v_mfma_f32_16x16x32_bf16 a[76:79], a[12:15], a[156:159], a[76:79]
    v_mfma_f32_16x16x32_bf16 v[208:211], a[16:19], a[128:131], v[208:211]
    ds_read_b64_tr_b16 a[56:57], v49 offset:0
    v_mfma_f32_16x16x32_bf16 v[208:211], a[20:23], a[144:147], v[208:211]
    buffer_load_dwordx4 a[204:207], v55, s[8:11], s62 offen sc1
    ds_read_b64_tr_b16 a[58:59], v49 offset:1024
    v_mfma_f32_16x16x32_bf16 v[212:215], a[16:19], a[132:135], v[212:215]
    ds_read_b64_tr_b16 a[60:61], v49 offset:8192
    v_mfma_f32_16x16x32_bf16 v[212:215], a[20:23], a[148:151], v[212:215]
    v_mfma_f32_16x16x32_bf16 a[80:83], a[16:19], a[136:139], a[80:83]
    ds_read_b64_tr_b16 a[62:63], v49 offset:9216
    v_mfma_f32_16x16x32_bf16 a[80:83], a[20:23], a[152:155], a[80:83]
    s_add_u32 s62, s62, 0x20000
    v_mfma_f32_16x16x32_bf16 a[84:87], a[16:19], a[140:143], a[84:87]
    s_add_u32 s52, s47, 12288
    v_mfma_f32_16x16x32_bf16 a[84:87], a[20:23], a[156:159], a[84:87]
    buffer_store_dwordx4 v[116:119], v1, s[48:51], s52 offen offset:1024 sc1
    v_mfma_f32_16x16x32_bf16 v[216:219], a[24:27], a[128:131], v[216:219]
    v_mfma_f32_16x16x32_bf16 v[216:219], a[28:31], a[144:147], v[216:219]
    v_mfma_f32_16x16x32_bf16 v[220:223], a[24:27], a[132:135], v[220:223]
    v_mfma_f32_16x16x32_bf16 v[220:223], a[28:31], a[148:151], v[220:223]
    v_mfma_f32_16x16x32_bf16 a[88:91], a[24:27], a[136:139], a[88:91]
    s_cmp_eq_u32 s45, 0
    s_cbranch_scc1 k12_ool_58
k12_oolret_59:
    v_mfma_f32_16x16x32_bf16 a[88:91], a[28:31], a[152:155], a[88:91]
    v_mfma_f32_16x16x32_bf16 a[92:95], a[24:27], a[140:143], a[92:95]
    v_mfma_f32_16x16x32_bf16 a[92:95], a[28:31], a[156:159], a[92:95]
    s_waitcnt vmcnt(9) lgkmcnt(0)
    s_barrier
    v_mfma_f32_16x16x32_bf16 v[224:227], a[32:35], a[128:131], v[224:227]
    v_mfma_f32_16x16x32_bf16 v[224:227], a[36:39], a[144:147], v[224:227]
    s_add_u32 m0, s60, 131072
    ds_read_b64_tr_b16 a[0:1], v42 offset:16384
    ds_read_b64_tr_b16 a[2:3], v42 offset:17408
    v_mfma_f32_16x16x32_bf16 v[228:231], a[32:35], a[132:135], v[228:231]
    buffer_load_dwordx4 v38, s[12:15], s61 offen offset:0 lds
    v_mfma_f32_16x16x32_bf16 v[228:231], a[36:39], a[148:151], v[228:231]
    ds_read_b64_tr_b16 a[4:5], v42 offset:24576
    v_mfma_f32_16x16x32_bf16 a[96:99], a[32:35], a[136:139], a[96:99]
    buffer_load_dwordx4 v39, s[12:15], s61 offen offset:1024 lds
    ds_read_b64_tr_b16 a[6:7], v42 offset:25600
    v_mfma_f32_16x16x32_bf16 a[96:99], a[36:39], a[152:155], a[96:99]
    ds_read_b64_tr_b16 a[8:9], v43 offset:16384
    v_mfma_f32_16x16x32_bf16 a[100:103], a[32:35], a[140:143], a[100:103]
    v_mfma_f32_16x16x32_bf16 a[100:103], a[36:39], a[156:159], a[100:103]
    buffer_load_dwordx4 v40, s[12:15], s61 offen offset:2048 lds
    ds_read_b64_tr_b16 a[10:11], v43 offset:17408
    v_mfma_f32_16x16x32_bf16 v[232:235], a[40:43], a[128:131], v[232:235]
    ds_read_b64_tr_b16 a[12:13], v43 offset:24576
    v_mfma_f32_16x16x32_bf16 v[232:235], a[44:47], a[144:147], v[232:235]
    ds_read_b64_tr_b16 a[14:15], v43 offset:25600
    v_mfma_f32_16x16x32_bf16 v[236:239], a[40:43], a[132:135], v[236:239]
    buffer_load_dwordx4 v41, s[12:15], s61 offen offset:3072 lds
    ds_read_b64_tr_b16 a[16:17], v44 offset:16384
    v_mfma_f32_16x16x32_bf16 v[236:239], a[44:47], a[148:151], v[236:239]
    v_mfma_f32_16x16x32_bf16 a[104:107], a[40:43], a[136:139], a[104:107]
    s_add_u32 s61, s61, 0x80000
    ds_read_b64_tr_b16 a[18:19], v44 offset:17408
    v_mfma_f32_16x16x32_bf16 a[104:107], a[44:47], a[152:155], a[104:107]
    buffer_load_dwordx4 a[208:211], v36, s[8:11], s62 offen sc1
    ds_read_b64_tr_b16 a[20:21], v44 offset:24576
    v_mfma_f32_16x16x32_bf16 a[108:111], a[40:43], a[140:143], a[108:111]
    ds_read_b64_tr_b16 a[22:23], v44 offset:25600
    v_mfma_f32_16x16x32_bf16 a[108:111], a[44:47], a[156:159], a[108:111]
    buffer_load_dwordx4 a[212:215], v54, s[8:11], s62 offen sc1
    v_mfma_f32_16x16x32_bf16 v[240:243], a[48:51], a[128:131], v[240:243]
    ds_read_b64_tr_b16 a[24:25], v45 offset:16384
    v_mfma_f32_16x16x32_bf16 v[240:243], a[52:55], a[144:147], v[240:243]
    ds_read_b64_tr_b16 a[26:27], v45 offset:17408
    v_mfma_f32_16x16x32_bf16 v[244:247], a[48:51], a[132:135], v[244:247]
    buffer_load_dwordx4 a[216:219], v37, s[8:11], s62 offen sc1
    ds_read_b64_tr_b16 a[28:29], v45 offset:24576
    v_mfma_f32_16x16x32_bf16 v[244:247], a[52:55], a[148:151], v[244:247]
    v_mfma_f32_16x16x32_bf16 a[112:115], a[48:51], a[136:139], a[112:115]
    ds_read_b64_tr_b16 a[30:31], v45 offset:25600
    v_mfma_f32_16x16x32_bf16 a[112:115], a[52:55], a[152:155], a[112:115]
    buffer_load_dwordx4 a[220:223], v55, s[8:11], s62 offen sc1
    v_mfma_f32_16x16x32_bf16 a[116:119], a[48:51], a[140:143], a[116:119]
    v_mfma_f32_16x16x32_bf16 a[116:119], a[52:55], a[156:159], a[116:119]
    s_add_u32 s62, s62, 0x20000
    v_mfma_f32_16x16x32_bf16 v[248:251], a[56:59], a[128:131], v[248:251]
    s_add_u32 s52, s47, 12288
    v_mfma_f32_16x16x32_bf16 v[248:251], a[60:63], a[144:147], v[248:251]
    buffer_store_dwordx4 v[120:123], v1, s[48:51], s52 offen offset:2048 sc1
    v_mfma_f32_16x16x32_bf16 v[252:255], a[56:59], a[132:135], v[252:255]
    v_mfma_f32_16x16x32_bf16 v[252:255], a[60:63], a[148:151], v[252:255]
    v_mfma_f32_16x16x32_bf16 a[120:123], a[56:59], a[136:139], a[120:123]
    v_mfma_f32_16x16x32_bf16 a[120:123], a[60:63], a[152:155], a[120:123]
    v_mfma_f32_16x16x32_bf16 a[124:127], a[56:59], a[140:143], a[124:127]
    v_mfma_f32_16x16x32_bf16 a[124:127], a[60:63], a[156:159], a[124:127]
    s_waitcnt vmcnt(14) lgkmcnt(0)
    v_mfma_f32_16x16x32_bf16 v[192:195], a[0:3], a[160:163], v[192:195]
    v_mfma_f32_16x16x32_bf16 v[192:195], a[4:7], a[176:179], v[192:195]
    buffer_load_dwordx4 a[224:227], v36, s[8:11], s62 offen sc1
    ds_read_b64_tr_b16 a[32:33], v46 offset:16384
    v_mfma_f32_16x16x32_bf16 v[196:199], a[0:3], a[164:167], v[196:199]
    ds_read_b64_tr_b16 a[34:35], v46 offset:17408
    v_mfma_f32_16x16x32_bf16 v[196:199], a[4:7], a[180:183], v[196:199]
    ds_read_b64_tr_b16 a[36:37], v46 offset:24576
    v_mfma_f32_16x16x32_bf16 a[64:67], a[0:3], a[168:171], a[64:67]
    ds_read_b64_tr_b16 a[38:39], v46 offset:25600
    v_mfma_f32_16x16x32_bf16 a[64:67], a[4:7], a[184:187], a[64:67]
    ds_read_b64_tr_b16 a[40:41], v47 offset:16384
    v_mfma_f32_16x16x32_bf16 a[68:71], a[0:3], a[172:175], a[68:71]
    buffer_load_dwordx4 a[228:231], v54, s[8:11], s62 offen sc1
    v_mfma_f32_16x16x32_bf16 a[68:71], a[4:7], a[188:191], a[68:71]
    ds_read_b64_tr_b16 a[42:43], v47 offset:17408
    v_mfma_f32_16x16x32_bf16 v[200:203], a[8:11], a[160:163], v[200:203]
    ds_read_b64_tr_b16 a[44:45], v47 offset:24576
    v_mfma_f32_16x16x32_bf16 v[200:203], a[12:15], a[176:179], v[200:203]
    ds_read_b64_tr_b16 a[46:47], v47 offset:25600
    v_mfma_f32_16x16x32_bf16 v[204:207], a[8:11], a[164:167], v[204:207]
    ds_read_b64_tr_b16 a[48:49], v48 offset:16384
    v_mfma_f32_16x16x32_bf16 v[204:207], a[12:15], a[180:183], v[204:207]
    buffer_load_dwordx4 a[232:235], v37, s[8:11], s62 offen sc1
    v_mfma_f32_16x16x32_bf16 a[72:75], a[8:11], a[168:171], a[72:75]
    ds_read_b64_tr_b16 a[50:51], v48 offset:17408
    v_mfma_f32_16x16x32_bf16 a[72:75], a[12:15], a[184:187], a[72:75]
    ds_read_b64_tr_b16 a[52:53], v48 offset:24576
    v_mfma_f32_16x16x32_bf16 a[76:79], a[8:11], a[172:175], a[76:79]
    ds_read_b64_tr_b16 a[54:55], v48 offset:25600
    v_mfma_f32_16x16x32_bf16 a[76:79], a[12:15], a[188:191], a[76:79]
    v_mfma_f32_16x16x32_bf16 v[208:211], a[16:19], a[160:163], v[208:211]
    ds_read_b64_tr_b16 a[56:57], v49 offset:16384
    v_mfma_f32_16x16x32_bf16 v[208:211], a[20:23], a[176:179], v[208:211]
    buffer_load_dwordx4 a[236:239], v55, s[8:11], s62 offen sc1
    ds_read_b64_tr_b16 a[58:59], v49 offset:17408
    v_mfma_f32_16x16x32_bf16 v[212:215], a[16:19], a[164:167], v[212:215]
    ds_read_b64_tr_b16 a[60:61], v49 offset:24576
    v_mfma_f32_16x16x32_bf16 v[212:215], a[20:23], a[180:183], v[212:215]
    v_mfma_f32_16x16x32_bf16 a[80:83], a[16:19], a[168:171], a[80:83]
    ds_read_b64_tr_b16 a[62:63], v49 offset:25600
    v_mfma_f32_16x16x32_bf16 a[80:83], a[20:23], a[184:187], a[80:83]
    s_add_u32 s62, s62, 0x20000
    v_mfma_f32_16x16x32_bf16 a[84:87], a[16:19], a[172:175], a[84:87]
    s_add_u32 s52, s47, 12288
    v_mfma_f32_16x16x32_bf16 a[84:87], a[20:23], a[188:191], a[84:87]
    buffer_store_dwordx4 v[124:127], v1, s[48:51], s52 offen offset:3072 sc1
    v_mfma_f32_16x16x32_bf16 v[216:219], a[24:27], a[160:163], v[216:219]
    v_mfma_f32_16x16x32_bf16 v[216:219], a[28:31], a[176:179], v[216:219]
    v_mfma_f32_16x16x32_bf16 v[220:223], a[24:27], a[164:167], v[220:223]
    v_mfma_f32_16x16x32_bf16 v[220:223], a[28:31], a[180:183], v[220:223]
    v_mfma_f32_16x16x32_bf16 a[88:91], a[24:27], a[168:171], a[88:91]
    v_mfma_f32_16x16x32_bf16 a[88:91], a[28:31], a[184:187], a[88:91]
    v_mfma_f32_16x16x32_bf16 a[92:95], a[24:27], a[172:175], a[92:95]
    v_mfma_f32_16x16x32_bf16 a[92:95], a[28:31], a[188:191], a[92:95]
    s_waitcnt vmcnt(10) lgkmcnt(0)
    s_barrier
    v_mfma_f32_16x16x32_bf16 v[224:227], a[32:35], a[160:163], v[224:227]
    v_mfma_f32_16x16x32_bf16 v[224:227], a[36:39], a[176:179], v[224:227]
    s_add_u32 m0, s60, 147456
    ds_read_b64_tr_b16 a[0:1], v42 offset:32768
    ds_read_b64_tr_b16 a[2:3], v42 offset:33792
    v_mfma_f32_16x16x32_bf16 v[228:231], a[32:35], a[164:167], v[228:231]
    buffer_load_dwordx4 v38, s[12:15], s61 offen offset:0 lds
    v_mfma_f32_16x16x32_bf16 v[228:231], a[36:39], a[180:183], v[228:231]
    ds_read_b64_tr_b16 a[4:5], v42 offset:40960
    v_mfma_f32_16x16x32_bf16 a[96:99], a[32:35], a[168:171], a[96:99]
    buffer_load_dwordx4 v39, s[12:15], s61 offen offset:1024 lds
    ds_read_b64_tr_b16 a[6:7], v42 offset:41984
    v_mfma_f32_16x16x32_bf16 a[96:99], a[36:39], a[184:187], a[96:99]
    ds_read_b64_tr_b16 a[8:9], v43 offset:32768
    v_mfma_f32_16x16x32_bf16 a[100:103], a[32:35], a[172:175], a[100:103]
    v_mfma_f32_16x16x32_bf16 a[100:103], a[36:39], a[188:191], a[100:103]
    buffer_load_dwordx4 v40, s[12:15], s61 offen offset:2048 lds
    ds_read_b64_tr_b16 a[10:11], v43 offset:33792
    v_mfma_f32_16x16x32_bf16 v[232:235], a[40:43], a[160:163], v[232:235]
    ds_read_b64_tr_b16 a[12:13], v43 offset:40960
    v_mfma_f32_16x16x32_bf16 v[232:235], a[44:47], a[176:179], v[232:235]
    ds_read_b64_tr_b16 a[14:15], v43 offset:41984
    v_mfma_f32_16x16x32_bf16 v[236:239], a[40:43], a[164:167], v[236:239]
    buffer_load_dwordx4 v41, s[12:15], s61 offen offset:3072 lds
    ds_read_b64_tr_b16 a[16:17], v44 offset:32768
    v_mfma_f32_16x16x32_bf16 v[236:239], a[44:47], a[180:183], v[236:239]
    v_mfma_f32_16x16x32_bf16 a[104:107], a[40:43], a[168:171], a[104:107]
    s_add_u32 s61, s61, 0x80000
    ds_read_b64_tr_b16 a[18:19], v44 offset:33792
    v_mfma_f32_16x16x32_bf16 a[104:107], a[44:47], a[184:187], a[104:107]
    buffer_load_dwordx4 a[240:243], v36, s[8:11], s62 offen sc1
    ds_read_b64_tr_b16 a[20:21], v44 offset:40960
    v_mfma_f32_16x16x32_bf16 a[108:111], a[40:43], a[172:175], a[108:111]
    ds_read_b64_tr_b16 a[22:23], v44 offset:41984
    v_mfma_f32_16x16x32_bf16 a[108:111], a[44:47], a[188:191], a[108:111]
    buffer_load_dwordx4 a[244:247], v54, s[8:11], s62 offen sc1
    v_mfma_f32_16x16x32_bf16 v[240:243], a[48:51], a[160:163], v[240:243]
    ds_read_b64_tr_b16 a[24:25], v45 offset:32768
    v_mfma_f32_16x16x32_bf16 v[240:243], a[52:55], a[176:179], v[240:243]
    ds_read_b64_tr_b16 a[26:27], v45 offset:33792
    v_mfma_f32_16x16x32_bf16 v[244:247], a[48:51], a[164:167], v[244:247]
    buffer_load_dwordx4 a[248:251], v37, s[8:11], s62 offen sc1
    ds_read_b64_tr_b16 a[28:29], v45 offset:40960
    v_mfma_f32_16x16x32_bf16 v[244:247], a[52:55], a[180:183], v[244:247]
    v_mfma_f32_16x16x32_bf16 a[112:115], a[48:51], a[168:171], a[112:115]
    ds_read_b64_tr_b16 a[30:31], v45 offset:41984
    v_mfma_f32_16x16x32_bf16 a[112:115], a[52:55], a[184:187], a[112:115]
    buffer_load_dwordx4 a[252:255], v55, s[8:11], s62 offen sc1
    v_mfma_f32_16x16x32_bf16 a[116:119], a[48:51], a[172:175], a[116:119]
    v_mfma_f32_16x16x32_bf16 a[116:119], a[52:55], a[188:191], a[116:119]
    s_add_u32 s62, s62, 0x20000
    v_mfma_f32_16x16x32_bf16 v[248:251], a[56:59], a[160:163], v[248:251]
    s_add_u32 s52, s47, 524288
    v_mfma_f32_16x16x32_bf16 v[248:251], a[60:63], a[176:179], v[248:251]
    buffer_store_dwordx4 v[136:139], v1, s[48:51], s52 offen offset:2048 sc1
    v_mfma_f32_16x16x32_bf16 v[252:255], a[56:59], a[164:167], v[252:255]
    v_mfma_f32_16x16x32_bf16 v[252:255], a[60:63], a[180:183], v[252:255]
    v_mfma_f32_16x16x32_bf16 a[120:123], a[56:59], a[168:171], a[120:123]
    s_cmp_eq_u32 s45, 0
    s_cbranch_scc1 k12_ool_60
k12_oolret_61:
    v_mfma_f32_16x16x32_bf16 a[120:123], a[60:63], a[184:187], a[120:123]
    v_mfma_f32_16x16x32_bf16 a[124:127], a[56:59], a[172:175], a[124:127]
    v_mfma_f32_16x16x32_bf16 a[124:127], a[60:63], a[188:191], a[124:127]
    s_waitcnt vmcnt(15) lgkmcnt(0)
    v_mfma_f32_16x16x32_bf16 v[192:195], a[0:3], a[192:195], v[192:195]
    v_mfma_f32_16x16x32_bf16 v[192:195], a[4:7], a[208:211], v[192:195]
    buffer_load_dwordx4 a[128:131], v36, s[8:11], s62 offen sc1
    ds_read_b64_tr_b16 a[32:33], v46 offset:32768
    v_mfma_f32_16x16x32_bf16 v[196:199], a[0:3], a[196:199], v[196:199]
    ds_read_b64_tr_b16 a[34:35], v46 offset:33792
    v_mfma_f32_16x16x32_bf16 v[196:199], a[4:7], a[212:215], v[196:199]
    ds_read_b64_tr_b16 a[36:37], v46 offset:40960
    v_mfma_f32_16x16x32_bf16 a[64:67], a[0:3], a[200:203], a[64:67]
    ds_read_b64_tr_b16 a[38:39], v46 offset:41984
    v_mfma_f32_16x16x32_bf16 a[64:67], a[4:7], a[216:219], a[64:67]
    ds_read_b64_tr_b16 a[40:41], v47 offset:32768
    v_mfma_f32_16x16x32_bf16 a[68:71], a[0:3], a[204:207], a[68:71]
    buffer_load_dwordx4 a[132:135], v54, s[8:11], s62 offen sc1
    v_mfma_f32_16x16x32_bf16 a[68:71], a[4:7], a[220:223], a[68:71]
    ds_read_b64_tr_b16 a[42:43], v47 offset:33792
    v_mfma_f32_16x16x32_bf16 v[200:203], a[8:11], a[192:195], v[200:203]
    ds_read_b64_tr_b16 a[44:45], v47 offset:40960
    v_mfma_f32_16x16x32_bf16 v[200:203], a[12:15], a[208:211], v[200:203]
    ds_read_b64_tr_b16 a[46:47], v47 offset:41984
    v_mfma_f32_16x16x32_bf16 v[204:207], a[8:11], a[196:199], v[204:207]
    ds_read_b64_tr_b16 a[48:49], v48 offset:32768
    v_mfma_f32_16x16x32_bf16 v[204:207], a[12:15], a[212:215], v[204:207]
    buffer_load_dwordx4 a[136:139], v37, s[8:11], s62 offen sc1
    v_mfma_f32_16x16x32_bf16 a[72:75], a[8:11], a[200:203], a[72:75]
    ds_read_b64_tr_b16 a[50:51], v48 offset:33792
    v_mfma_f32_16x16x32_bf16 a[72:75], a[12:15], a[216:219], a[72:75]
    ds_read_b64_tr_b16 a[52:53], v48 offset:40960
    v_mfma_f32_16x16x32_bf16 a[76:79], a[8:11], a[204:207], a[76:79]
    ds_read_b64_tr_b16 a[54:55], v48 offset:41984
    v_mfma_f32_16x16x32_bf16 a[76:79], a[12:15], a[220:223], a[76:79]
    v_mfma_f32_16x16x32_bf16 v[208:211], a[16:19], a[192:195], v[208:211]
    ds_read_b64_tr_b16 a[56:57], v49 offset:32768
    v_mfma_f32_16x16x32_bf16 v[208:211], a[20:23], a[208:211], v[208:211]
    buffer_load_dwordx4 a[140:143], v55, s[8:11], s62 offen sc1
    ds_read_b64_tr_b16 a[58:59], v49 offset:33792
    v_mfma_f32_16x16x32_bf16 v[212:215], a[16:19], a[196:199], v[212:215]
    ds_read_b64_tr_b16 a[60:61], v49 offset:40960
    v_mfma_f32_16x16x32_bf16 v[212:215], a[20:23], a[212:215], v[212:215]
    v_mfma_f32_16x16x32_bf16 a[80:83], a[16:19], a[200:203], a[80:83]
    ds_read_b64_tr_b16 a[62:63], v49 offset:41984
    v_mfma_f32_16x16x32_bf16 a[80:83], a[20:23], a[216:219], a[80:83]
    s_add_u32 s62, s62, 0x20000
    v_mfma_f32_16x16x32_bf16 a[84:87], a[16:19], a[204:207], a[84:87]
    s_add_u32 s52, s47, 524288
    v_mfma_f32_16x16x32_bf16 a[84:87], a[20:23], a[220:223], a[84:87]
    buffer_store_dwordx4 v[140:143], v1, s[48:51], s52 offen offset:3072 sc1
    v_mfma_f32_16x16x32_bf16 v[216:219], a[24:27], a[192:195], v[216:219]
    v_mfma_f32_16x16x32_bf16 v[216:219], a[28:31], a[208:211], v[216:219]
    v_mfma_f32_16x16x32_bf16 v[220:223], a[24:27], a[196:199], v[220:223]
    v_mfma_f32_16x16x32_bf16 v[220:223], a[28:31], a[212:215], v[220:223]
    v_mfma_f32_16x16x32_bf16 a[88:91], a[24:27], a[200:203], a[88:91]
    v_mfma_f32_16x16x32_bf16 a[88:91], a[28:31], a[216:219], a[88:91]
    v_mfma_f32_16x16x32_bf16 a[92:95], a[24:27], a[204:207], a[92:95]
    v_mfma_f32_16x16x32_bf16 a[92:95], a[28:31], a[220:223], a[92:95]
    s_waitcnt vmcnt(10) lgkmcnt(0)
    s_barrier
    v_mfma_f32_16x16x32_bf16 v[224:227], a[32:35], a[192:195], v[224:227]
    v_mfma_f32_16x16x32_bf16 v[224:227], a[36:39], a[208:211], v[224:227]
    s_add_u32 m0, s60, 98304
    ds_read_b64_tr_b16 a[0:1], v42 offset:49152
    ds_read_b64_tr_b16 a[2:3], v42 offset:50176
    v_mfma_f32_16x16x32_bf16 v[228:231], a[32:35], a[196:199], v[228:231]
    buffer_load_dwordx4 v38, s[12:15], s61 offen offset:0 lds
    v_mfma_f32_16x16x32_bf16 v[228:231], a[36:39], a[212:215], v[228:231]
    ds_read_b64_tr_b16 a[4:5], v42 offset:57344
    v_mfma_f32_16x16x32_bf16 a[96:99], a[32:35], a[200:203], a[96:99]
    buffer_load_dwordx4 v39, s[12:15], s61 offen offset:1024 lds
    ds_read_b64_tr_b16 a[6:7], v42 offset:58368
    v_mfma_f32_16x16x32_bf16 a[96:99], a[36:39], a[216:219], a[96:99]
    ds_read_b64_tr_b16 a[8:9], v43 offset:49152
    v_mfma_f32_16x16x32_bf16 a[100:103], a[32:35], a[204:207], a[100:103]
    v_mfma_f32_16x16x32_bf16 a[100:103], a[36:39], a[220:223], a[100:103]
    buffer_load_dwordx4 v40, s[12:15], s61 offen offset:2048 lds
    ds_read_b64_tr_b16 a[10:11], v43 offset:50176
    v_mfma_f32_16x16x32_bf16 v[232:235], a[40:43], a[192:195], v[232:235]
    ds_read_b64_tr_b16 a[12:13], v43 offset:57344
    v_mfma_f32_16x16x32_bf16 v[232:235], a[44:47], a[208:211], v[232:235]
    ds_read_b64_tr_b16 a[14:15], v43 offset:58368
    v_mfma_f32_16x16x32_bf16 v[236:239], a[40:43], a[196:199], v[236:239]
    ds_read_b64_tr_b16 a[16:17], v44 offset:49152
    v_mfma_f32_16x16x32_bf16 v[236:239], a[44:47], a[212:215], v[236:239]
    buffer_load_dwordx4 v41, s[12:15], s61 offen offset:3072 lds
    v_mfma_f32_16x16x32_bf16 a[104:107], a[40:43], a[200:203], a[104:107]
    ds_read_b64_tr_b16 a[18:19], v44 offset:50176
    v_mfma_f32_16x16x32_bf16 a[104:107], a[44:47], a[216:219], a[104:107]
    s_add_u32 s61, s61, 0x80000
    ds_read_b64_tr_b16 a[20:21], v44 offset:57344
    v_mfma_f32_16x16x32_bf16 a[108:111], a[40:43], a[204:207], a[108:111]
    buffer_load_dwordx4 a[144:147], v36, s[8:11], s62 offen sc1
    ds_read_b64_tr_b16 a[22:23], v44 offset:58368
    v_mfma_f32_16x16x32_bf16 a[108:111], a[44:47], a[220:223], a[108:111]
    v_mfma_f32_16x16x32_bf16 v[240:243], a[48:51], a[192:195], v[240:243]
    ds_read_b64_tr_b16 a[24:25], v45 offset:49152
    v_mfma_f32_16x16x32_bf16 v[240:243], a[52:55], a[208:211], v[240:243]
    buffer_load_dwordx4 a[148:151], v54, s[8:11], s62 offen sc1
    ds_read_b64_tr_b16 a[26:27], v45 offset:50176
    v_mfma_f32_16x16x32_bf16 v[244:247], a[48:51], a[196:199], v[244:247]
    ds_read_b64_tr_b16 a[28:29], v45 offset:57344
    v_mfma_f32_16x16x32_bf16 v[244:247], a[52:55], a[212:215], v[244:247]
    v_mfma_f32_16x16x32_bf16 a[112:115], a[48:51], a[200:203], a[112:115]
    buffer_load_dwordx4 a[152:155], v37, s[8:11], s62 offen sc1
    ds_read_b64_tr_b16 a[30:31], v45 offset:58368
    v_mfma_f32_16x16x32_bf16 a[112:115], a[52:55], a[216:219], a[112:115]
    v_mfma_f32_16x16x32_bf16 a[116:119], a[48:51], a[204:207], a[116:119]
    v_mfma_f32_16x16x32_bf16 a[116:119], a[52:55], a[220:223], a[116:119]
    v_mfma_f32_16x16x32_bf16 v[248:251], a[56:59], a[192:195], v[248:251]
    buffer_load_dwordx4 a[156:159], v55, s[8:11], s62 offen sc1
    v_mfma_f32_16x16x32_bf16 v[248:251], a[60:63], a[208:211], v[248:251]
    v_mfma_f32_16x16x32_bf16 v[252:255], a[56:59], a[196:199], v[252:255]
    s_add_u32 s62, s62, 0x20000
    v_mfma_f32_16x16x32_bf16 v[252:255], a[60:63], a[212:215], v[252:255]
    v_mfma_f32_16x16x32_bf16 a[120:123], a[56:59], a[200:203], a[120:123]
    s_cmp_eq_u32 s45, 0
    s_cbranch_scc1 k12_ool_62
k12_oolret_63:
    v_mfma_f32_16x16x32_bf16 a[120:123], a[60:63], a[216:219], a[120:123]
    v_mfma_f32_16x16x32_bf16 a[124:127], a[56:59], a[204:207], a[124:127]
    v_mfma_f32_16x16x32_bf16 a[124:127], a[60:63], a[220:223], a[124:127]
    s_waitcnt vmcnt(14) lgkmcnt(0)
    v_mfma_f32_16x16x32_bf16 v[192:195], a[0:3], a[224:227], v[192:195]
    v_mfma_f32_16x16x32_bf16 v[192:195], a[4:7], a[240:243], v[192:195]
    buffer_load_dwordx4 a[160:163], v36, s[8:11], s62 offen sc1
    ds_read_b64_tr_b16 a[32:33], v46 offset:49152
    v_mfma_f32_16x16x32_bf16 v[196:199], a[0:3], a[228:231], v[196:199]
    ds_read_b64_tr_b16 a[34:35], v46 offset:50176
    v_mfma_f32_16x16x32_bf16 v[196:199], a[4:7], a[244:247], v[196:199]
    ds_read_b64_tr_b16 a[36:37], v46 offset:57344
    v_mfma_f32_16x16x32_bf16 a[64:67], a[0:3], a[232:235], a[64:67]
    ds_read_b64_tr_b16 a[38:39], v46 offset:58368
    v_mfma_f32_16x16x32_bf16 a[64:67], a[4:7], a[248:251], a[64:67]
    ds_read_b64_tr_b16 a[40:41], v47 offset:49152
    v_mfma_f32_16x16x32_bf16 a[68:71], a[0:3], a[236:239], a[68:71]
    buffer_load_dwordx4 a[164:167], v54, s[8:11], s62 offen sc1
    v_mfma_f32_16x16x32_bf16 a[68:71], a[4:7], a[252:255], a[68:71]
    ds_read_b64_tr_b16 a[42:43], v47 offset:50176
    v_mfma_f32_16x16x32_bf16 v[200:203], a[8:11], a[224:227], v[200:203]
    ds_read_b64_tr_b16 a[44:45], v47 offset:57344
    v_mfma_f32_16x16x32_bf16 v[200:203], a[12:15], a[240:243], v[200:203]
    ds_read_b64_tr_b16 a[46:47], v47 offset:58368
    v_mfma_f32_16x16x32_bf16 v[204:207], a[8:11], a[228:231], v[204:207]
    ds_read_b64_tr_b16 a[48:49], v48 offset:49152
    v_mfma_f32_16x16x32_bf16 v[204:207], a[12:15], a[244:247], v[204:207]
    buffer_load_dwordx4 a[168:171], v37, s[8:11], s62 offen sc1
    v_mfma_f32_16x16x32_bf16 a[72:75], a[8:11], a[232:235], a[72:75]
    ds_read_b64_tr_b16 a[50:51], v48 offset:50176
    v_mfma_f32_16x16x32_bf16 a[72:75], a[12:15], a[248:251], a[72:75]
    ds_read_b64_tr_b16 a[52:53], v48 offset:57344
    v_mfma_f32_16x16x32_bf16 a[76:79], a[8:11], a[236:239], a[76:79]
    ds_read_b64_tr_b16 a[54:55], v48 offset:58368
    v_mfma_f32_16x16x32_bf16 a[76:79], a[12:15], a[252:255], a[76:79]
    v_mfma_f32_16x16x32_bf16 v[208:211], a[16:19], a[224:227], v[208:211]
    ds_read_b64_tr_b16 a[56:57], v49 offset:49152
    v_mfma_f32_16x16x32_bf16 v[208:211], a[20:23], a[240:243], v[208:211]
    buffer_load_dwordx4 a[172:175], v55, s[8:11], s62 offen sc1
    ds_read_b64_tr_b16 a[58:59], v49 offset:50176
    v_mfma_f32_16x16x32_bf16 v[212:215], a[16:19], a[228:231], v[212:215]
    ds_read_b64_tr_b16 a[60:61], v49 offset:57344
    v_mfma_f32_16x16x32_bf16 v[212:215], a[20:23], a[244:247], v[212:215]
    v_mfma_f32_16x16x32_bf16 a[80:83], a[16:19], a[232:235], a[80:83]
    ds_read_b64_tr_b16 a[62:63], v49 offset:58368
    v_mfma_f32_16x16x32_bf16 a[80:83], a[20:23], a[248:251], a[80:83]
    s_add_u32 s62, s62, 0x20000
    v_mfma_f32_16x16x32_bf16 a[84:87], a[16:19], a[236:239], a[84:87]
    s_add_u32 s52, s47, 528384
    v_mfma_f32_16x16x32_bf16 a[84:87], a[20:23], a[252:255], a[84:87]
    buffer_store_dwordx4 v[144:147], v1, s[48:51], s52 offen offset:0 sc1
    v_mfma_f32_16x16x32_bf16 v[216:219], a[24:27], a[224:227], v[216:219]
    v_mfma_f32_16x16x32_bf16 v[216:219], a[28:31], a[240:243], v[216:219]
    v_mfma_f32_16x16x32_bf16 v[220:223], a[24:27], a[228:231], v[220:223]
    v_mfma_f32_16x16x32_bf16 v[220:223], a[28:31], a[244:247], v[220:223]
    v_mfma_f32_16x16x32_bf16 a[88:91], a[24:27], a[232:235], a[88:91]
    v_mfma_f32_16x16x32_bf16 a[88:91], a[28:31], a[248:251], a[88:91]
    v_mfma_f32_16x16x32_bf16 a[92:95], a[24:27], a[236:239], a[92:95]
    v_mfma_f32_16x16x32_bf16 a[92:95], a[28:31], a[252:255], a[92:95]
    s_waitcnt vmcnt(9) lgkmcnt(0)
    s_barrier
    v_mfma_f32_16x16x32_bf16 v[224:227], a[32:35], a[224:227], v[224:227]
    v_mfma_f32_16x16x32_bf16 v[224:227], a[36:39], a[240:243], v[224:227]
    s_add_u32 m0, s60, 114688
    ds_read_b64_tr_b16 a[0:1], v42 offset:0
    ds_read_b64_tr_b16 a[2:3], v42 offset:1024
    v_mfma_f32_16x16x32_bf16 v[228:231], a[32:35], a[228:231], v[228:231]
    buffer_load_dwordx4 v38, s[12:15], s61 offen offset:0 lds
    v_mfma_f32_16x16x32_bf16 v[228:231], a[36:39], a[244:247], v[228:231]
    ds_read_b64_tr_b16 a[4:5], v42 offset:8192
    v_mfma_f32_16x16x32_bf16 a[96:99], a[32:35], a[232:235], a[96:99]
    buffer_load_dwordx4 v39, s[12:15], s61 offen offset:1024 lds
    ds_read_b64_tr_b16 a[6:7], v42 offset:9216
    v_mfma_f32_16x16x32_bf16 a[96:99], a[36:39], a[248:251], a[96:99]
    ds_read_b64_tr_b16 a[8:9], v43 offset:0
    v_mfma_f32_16x16x32_bf16 a[100:103], a[32:35], a[236:239], a[100:103]
    v_mfma_f32_16x16x32_bf16 a[100:103], a[36:39], a[252:255], a[100:103]
    buffer_load_dwordx4 v40, s[12:15], s61 offen offset:2048 lds
    ds_read_b64_tr_b16 a[10:11], v43 offset:1024
    v_mfma_f32_16x16x32_bf16 v[232:235], a[40:43], a[224:227], v[232:235]
    ds_read_b64_tr_b16 a[12:13], v43 offset:8192
    v_mfma_f32_16x16x32_bf16 v[232:235], a[44:47], a[240:243], v[232:235]
    ds_read_b64_tr_b16 a[14:15], v43 offset:9216
    v_mfma_f32_16x16x32_bf16 v[236:239], a[40:43], a[228:231], v[236:239]
    buffer_load_dwordx4 v41, s[12:15], s61 offen offset:3072 lds
    ds_read_b64_tr_b16 a[16:17], v44 offset:0
    v_mfma_f32_16x16x32_bf16 v[236:239], a[44:47], a[244:247], v[236:239]
    v_mfma_f32_16x16x32_bf16 a[104:107], a[40:43], a[232:235], a[104:107]
    s_add_u32 s61, s61, 0x80000
    ds_read_b64_tr_b16 a[18:19], v44 offset:1024
    v_mfma_f32_16x16x32_bf16 a[104:107], a[44:47], a[248:251], a[104:107]
    buffer_load_dwordx4 a[176:179], v36, s[8:11], s62 offen sc1
    ds_read_b64_tr_b16 a[20:21], v44 offset:8192
    v_mfma_f32_16x16x32_bf16 a[108:111], a[40:43], a[236:239], a[108:111]
    ds_read_b64_tr_b16 a[22:23], v44 offset:9216
    v_mfma_f32_16x16x32_bf16 a[108:111], a[44:47], a[252:255], a[108:111]
    buffer_load_dwordx4 a[180:183], v54, s[8:11], s62 offen sc1
    v_mfma_f32_16x16x32_bf16 v[240:243], a[48:51], a[224:227], v[240:243]
    ds_read_b64_tr_b16 a[24:25], v45 offset:0
    v_mfma_f32_16x16x32_bf16 v[240:243], a[52:55], a[240:243], v[240:243]
    ds_read_b64_tr_b16 a[26:27], v45 offset:1024
    v_mfma_f32_16x16x32_bf16 v[244:247], a[48:51], a[228:231], v[244:247]
    buffer_load_dwordx4 a[184:187], v37, s[8:11], s62 offen sc1
    ds_read_b64_tr_b16 a[28:29], v45 offset:8192
    v_mfma_f32_16x16x32_bf16 v[244:247], a[52:55], a[244:247], v[244:247]
    v_mfma_f32_16x16x32_bf16 a[112:115], a[48:51], a[232:235], a[112:115]
    ds_read_b64_tr_b16 a[30:31], v45 offset:9216
    v_mfma_f32_16x16x32_bf16 a[112:115], a[52:55], a[248:251], a[112:115]
    buffer_load_dwordx4 a[188:191], v55, s[8:11], s62 offen sc1
    v_mfma_f32_16x16x32_bf16 a[116:119], a[48:51], a[236:239], a[116:119]
    v_mfma_f32_16x16x32_bf16 a[116:119], a[52:55], a[252:255], a[116:119]
    s_add_u32 s62, s62, 0x20000
    v_mfma_f32_16x16x32_bf16 v[248:251], a[56:59], a[224:227], v[248:251]
    s_add_u32 s52, s47, 528384
    v_mfma_f32_16x16x32_bf16 v[248:251], a[60:63], a[240:243], v[248:251]
    buffer_store_dwordx4 v[148:151], v1, s[48:51], s52 offen offset:1024 sc1
    v_mfma_f32_16x16x32_bf16 v[252:255], a[56:59], a[228:231], v[252:255]
    v_mfma_f32_16x16x32_bf16 v[252:255], a[60:63], a[244:247], v[252:255]
    v_mfma_f32_16x16x32_bf16 a[120:123], a[56:59], a[232:235], a[120:123]
    s_cmp_eq_u32 s45, 0
    s_cbranch_scc1 k12_ool_64
k12_oolret_65:
    v_mfma_f32_16x16x32_bf16 a[120:123], a[60:63], a[248:251], a[120:123]
    v_mfma_f32_16x16x32_bf16 a[124:127], a[56:59], a[236:239], a[124:127]
    v_mfma_f32_16x16x32_bf16 a[124:127], a[60:63], a[252:255], a[124:127]
    s_waitcnt vmcnt(14) lgkmcnt(0)
    v_mfma_f32_16x16x32_bf16 v[192:195], a[0:3], a[128:131], v[192:195]
    v_mfma_f32_16x16x32_bf16 v[192:195], a[4:7], a[144:147], v[192:195]
    buffer_load_dwordx4 a[192:195], v36, s[8:11], s62 offen sc1
    ds_read_b64_tr_b16 a[32:33], v46 offset:0
    v_mfma_f32_16x16x32_bf16 v[196:199], a[0:3], a[132:135], v[196:199]
    ds_read_b64_tr_b16 a[34:35], v46 offset:1024
    v_mfma_f32_16x16x32_bf16 v[196:199], a[4:7], a[148:151], v[196:199]
    ds_read_b64_tr_b16 a[36:37], v46 offset:8192
    v_mfma_f32_16x16x32_bf16 a[64:67], a[0:3], a[136:139], a[64:67]
    ds_read_b64_tr_b16 a[38:39], v46 offset:9216
    v_mfma_f32_16x16x32_bf16 a[64:67], a[4:7], a[152:155], a[64:67]
    ds_read_b64_tr_b16 a[40:41], v47 offset:0
    v_mfma_f32_16x16x32_bf16 a[68:71], a[0:3], a[140:143], a[68:71]
    buffer_load_dwordx4 a[196:199], v54, s[8:11], s62 offen sc1
    v_mfma_f32_16x16x32_bf16 a[68:71], a[4:7], a[156:159], a[68:71]
    ds_read_b64_tr_b16 a[42:43], v47 offset:1024
    v_mfma_f32_16x16x32_bf16 v[200:203], a[8:11], a[128:131], v[200:203]
    ds_read_b64_tr_b16 a[44:45], v47 offset:8192
    v_mfma_f32_16x16x32_bf16 v[200:203], a[12:15], a[144:147], v[200:203]
    ds_read_b64_tr_b16 a[46:47], v47 offset:9216
    v_mfma_f32_16x16x32_bf16 v[204:207], a[8:11], a[132:135], v[204:207]
    ds_read_b64_tr_b16 a[48:49], v48 offset:0
    v_mfma_f32_16x16x32_bf16 v[204:207], a[12:15], a[148:151], v[204:207]
    buffer_load_dwordx4 a[200:203], v37, s[8:11], s62 offen sc1
    v_mfma_f32_16x16x32_bf16 a[72:75], a[8:11], a[136:139], a[72:75]
    ds_read_b64_tr_b16 a[50:51], v48 offset:1024
    v_mfma_f32_16x16x32_bf16 a[72:75], a[12:15], a[152:155], a[72:75]
    ds_read_b64_tr_b16 a[52:53], v48 offset:8192
    v_mfma_f32_16x16x32_bf16 a[76:79], a[8:11], a[140:143], a[76:79]
    ds_read_b64_tr_b16 a[54:55], v48 offset:9216
    v_mfma_f32_16x16x32_bf16 a[76:79], a[12:15], a[156:159], a[76:79]
    v_mfma_f32_16x16x32_bf16 v[208:211], a[16:19], a[128:131], v[208:211]
    ds_read_b64_tr_b16 a[56:57], v49 offset:0
    v_mfma_f32_16x16x32_bf16 v[208:211], a[20:23], a[144:147], v[208:211]
    buffer_load_dwordx4 a[204:207], v55, s[8:11], s62 offen sc1
    ds_read_b64_tr_b16 a[58:59], v49 offset:1024
    v_mfma_f32_16x16x32_bf16 v[212:215], a[16:19], a[132:135], v[212:215]
    ds_read_b64_tr_b16 a[60:61], v49 offset:8192
    v_mfma_f32_16x16x32_bf16 v[212:215], a[20:23], a[148:151], v[212:215]
    v_mfma_f32_16x16x32_bf16 a[80:83], a[16:19], a[136:139], a[80:83]
    ds_read_b64_tr_b16 a[62:63], v49 offset:9216
    v_mfma_f32_16x16x32_bf16 a[80:83], a[20:23], a[152:155], a[80:83]
    s_add_u32 s62, s62, 0x20000
    v_mfma_f32_16x16x32_bf16 a[84:87], a[16:19], a[140:143], a[84:87]
    s_add_u32 s52, s47, 528384
    v_mfma_f32_16x16x32_bf16 a[84:87], a[20:23], a[156:159], a[84:87]
    buffer_store_dwordx4 v[152:155], v1, s[48:51], s52 offen offset:2048 sc1
    v_mfma_f32_16x16x32_bf16 v[216:219], a[24:27], a[128:131], v[216:219]
    v_mfma_f32_16x16x32_bf16 v[216:219], a[28:31], a[144:147], v[216:219]
    v_mfma_f32_16x16x32_bf16 v[220:223], a[24:27], a[132:135], v[220:223]
    v_mfma_f32_16x16x32_bf16 v[220:223], a[28:31], a[148:151], v[220:223]
    v_mfma_f32_16x16x32_bf16 a[88:91], a[24:27], a[136:139], a[88:91]
    v_mfma_f32_16x16x32_bf16 a[88:91], a[28:31], a[152:155], a[88:91]
    v_mfma_f32_16x16x32_bf16 a[92:95], a[24:27], a[140:143], a[92:95]
    v_mfma_f32_16x16x32_bf16 a[92:95], a[28:31], a[156:159], a[92:95]
    s_waitcnt vmcnt(10) lgkmcnt(0)
    s_barrier
    v_mfma_f32_16x16x32_bf16 v[224:227], a[32:35], a[128:131], v[224:227]
    v_mfma_f32_16x16x32_bf16 v[224:227], a[36:39], a[144:147], v[224:227]
    s_add_u32 m0, s60, 131072
    ds_read_b64_tr_b16 a[0:1], v42 offset:16384
    ds_read_b64_tr_b16 a[2:3], v42 offset:17408
    v_mfma_f32_16x16x32_bf16 v[228:231], a[32:35], a[132:135], v[228:231]
    buffer_load_dwordx4 v38, s[12:15], s61 offen offset:0 lds
    v_mfma_f32_16x16x32_bf16 v[228:231], a[36:39], a[148:151], v[228:231]
    ds_read_b64_tr_b16 a[4:5], v42 offset:24576
    v_mfma_f32_16x16x32_bf16 a[96:99], a[32:35], a[136:139], a[96:99]
    buffer_load_dwordx4 v39, s[12:15], s61 offen offset:1024 lds
    ds_read_b64_tr_b16 a[6:7], v42 offset:25600
    v_mfma_f32_16x16x32_bf16 a[96:99], a[36:39], a[152:155], a[96:99]
    ds_read_b64_tr_b16 a[8:9], v43 offset:16384
    v_mfma_f32_16x16x32_bf16 a[100:103], a[32:35], a[140:143], a[100:103]
    v_mfma_f32_16x16x32_bf16 a[100:103], a[36:39], a[156:159], a[100:103]
    buffer_load_dwordx4 v40, s[12:15], s61 offen offset:2048 lds
    ds_read_b64_tr_b16 a[10:11], v43 offset:17408
    v_mfma_f32_16x16x32_bf16 v[232:235], a[40:43], a[128:131], v[232:235]
    ds_read_b64_tr_b16 a[12:13], v43 offset:24576
    v_mfma_f32_16x16x32_bf16 v[232:235], a[44:47], a[144:147], v[232:235]
    ds_read_b64_tr_b16 a[14:15], v43 offset:25600
    v_mfma_f32_16x16x32_bf16 v[236:239], a[40:43], a[132:135], v[236:239]
    buffer_load_dwordx4 v41, s[12:15], s61 offen offset:3072 lds
    ds_read_b64_tr_b16 a[16:17], v44 offset:16384
    v_mfma_f32_16x16x32_bf16 v[236:239], a[44:47], a[148:151], v[236:239]
    v_mfma_f32_16x16x32_bf16 a[104:107], a[40:43], a[136:139], a[104:107]
    s_add_u32 s61, s61, 0x80000
    ds_read_b64_tr_b16 a[18:19], v44 offset:17408
    v_mfma_f32_16x16x32_bf16 a[104:107], a[44:47], a[152:155], a[104:107]
    buffer_load_dwordx4 a[208:211], v36, s[8:11], s62 offen sc1
    ds_read_b64_tr_b16 a[20:21], v44 offset:24576
    v_mfma_f32_16x16x32_bf16 a[108:111], a[40:43], a[140:143], a[108:111]
    ds_read_b64_tr_b16 a[22:23], v44 offset:25600
    v_mfma_f32_16x16x32_bf16 a[108:111], a[44:47], a[156:159], a[108:111]
    buffer_load_dwordx4 a[212:215], v54, s[8:11], s62 offen sc1
    v_mfma_f32_16x16x32_bf16 v[240:243], a[48:51], a[128:131], v[240:243]
    ds_read_b64_tr_b16 a[24:25], v45 offset:16384
    v_mfma_f32_16x16x32_bf16 v[240:243], a[52:55], a[144:147], v[240:243]
    ds_read_b64_tr_b16 a[26:27], v45 offset:17408
    v_mfma_f32_16x16x32_bf16 v[244:247], a[48:51], a[132:135], v[244:247]
    buffer_load_dwordx4 a[216:219], v37, s[8:11], s62 offen sc1
    ds_read_b64_tr_b16 a[28:29], v45 offset:24576
    v_mfma_f32_16x16x32_bf16 v[244:247], a[52:55], a[148:151], v[244:247]
    v_mfma_f32_16x16x32_bf16 a[112:115], a[48:51], a[136:139], a[112:115]
    ds_read_b64_tr_b16 a[30:31], v45 offset:25600
    v_mfma_f32_16x16x32_bf16 a[112:115], a[52:55], a[152:155], a[112:115]
    buffer_load_dwordx4 a[220:223], v55, s[8:11], s62 offen sc1
    v_mfma_f32_16x16x32_bf16 a[116:119], a[48:51], a[140:143], a[116:119]
    v_mfma_f32_16x16x32_bf16 a[116:119], a[52:55], a[156:159], a[116:119]
    s_add_u32 s62, s62, 0x20000
    v_mfma_f32_16x16x32_bf16 v[248:251], a[56:59], a[128:131], v[248:251]
    s_add_u32 s52, s47, 528384
    v_mfma_f32_16x16x32_bf16 v[248:251], a[60:63], a[144:147], v[248:251]
    buffer_store_dwordx4 v[156:159], v1, s[48:51], s52 offen offset:3072 sc1
    v_mfma_f32_16x16x32_bf16 v[252:255], a[56:59], a[132:135], v[252:255]
    v_mfma_f32_16x16x32_bf16 v[252:255], a[60:63], a[148:151], v[252:255]
    v_mfma_f32_16x16x32_bf16 a[120:123], a[56:59], a[136:139], a[120:123]
    v_mfma_f32_16x16x32_bf16 a[120:123], a[60:63], a[152:155], a[120:123]
    v_mfma_f32_16x16x32_bf16 a[124:127], a[56:59], a[140:143], a[124:127]
    v_mfma_f32_16x16x32_bf16 a[124:127], a[60:63], a[156:159], a[124:127]
    s_waitcnt vmcnt(15) lgkmcnt(0)
    v_mfma_f32_16x16x32_bf16 v[192:195], a[0:3], a[160:163], v[192:195]
    v_mfma_f32_16x16x32_bf16 v[192:195], a[4:7], a[176:179], v[192:195]
    buffer_load_dwordx4 a[224:227], v36, s[8:11], s62 offen sc1
    ds_read_b64_tr_b16 a[32:33], v46 offset:16384
    v_mfma_f32_16x16x32_bf16 v[196:199], a[0:3], a[164:167], v[196:199]
    ds_read_b64_tr_b16 a[34:35], v46 offset:17408
    v_mfma_f32_16x16x32_bf16 v[196:199], a[4:7], a[180:183], v[196:199]
    ds_read_b64_tr_b16 a[36:37], v46 offset:24576
    v_mfma_f32_16x16x32_bf16 a[64:67], a[0:3], a[168:171], a[64:67]
    ds_read_b64_tr_b16 a[38:39], v46 offset:25600
    v_mfma_f32_16x16x32_bf16 a[64:67], a[4:7], a[184:187], a[64:67]
    ds_read_b64_tr_b16 a[40:41], v47 offset:16384
    v_mfma_f32_16x16x32_bf16 a[68:71], a[0:3], a[172:175], a[68:71]
    buffer_load_dwordx4 a[228:231], v54, s[8:11], s62 offen sc1
    v_mfma_f32_16x16x32_bf16 a[68:71], a[4:7], a[188:191], a[68:71]
    ds_read_b64_tr_b16 a[42:43], v47 offset:17408
    v_mfma_f32_16x16x32_bf16 v[200:203], a[8:11], a[160:163], v[200:203]
    ds_read_b64_tr_b16 a[44:45], v47 offset:24576
    v_mfma_f32_16x16x32_bf16 v[200:203], a[12:15], a[176:179], v[200:203]
    ds_read_b64_tr_b16 a[46:47], v47 offset:25600
    v_mfma_f32_16x16x32_bf16 v[204:207], a[8:11], a[164:167], v[204:207]
    ds_read_b64_tr_b16 a[48:49], v48 offset:16384
    v_mfma_f32_16x16x32_bf16 v[204:207], a[12:15], a[180:183], v[204:207]
    buffer_load_dwordx4 a[232:235], v37, s[8:11], s62 offen sc1
    v_mfma_f32_16x16x32_bf16 a[72:75], a[8:11], a[168:171], a[72:75]
    ds_read_b64_tr_b16 a[50:51], v48 offset:17408
    v_mfma_f32_16x16x32_bf16 a[72:75], a[12:15], a[184:187], a[72:75]
    ds_read_b64_tr_b16 a[52:53], v48 offset:24576
    v_mfma_f32_16x16x32_bf16 a[76:79], a[8:11], a[172:175], a[76:79]
    ds_read_b64_tr_b16 a[54:55], v48 offset:25600
    v_mfma_f32_16x16x32_bf16 a[76:79], a[12:15], a[188:191], a[76:79]
    v_mfma_f32_16x16x32_bf16 v[208:211], a[16:19], a[160:163], v[208:211]
    ds_read_b64_tr_b16 a[56:57], v49 offset:16384
    v_mfma_f32_16x16x32_bf16 v[208:211], a[20:23], a[176:179], v[208:211]
    buffer_load_dwordx4 a[236:239], v55, s[8:11], s62 offen sc1
    ds_read_b64_tr_b16 a[58:59], v49 offset:17408
    v_mfma_f32_16x16x32_bf16 v[212:215], a[16:19], a[164:167], v[212:215]
    ds_read_b64_tr_b16 a[60:61], v49 offset:24576
    v_mfma_f32_16x16x32_bf16 v[212:215], a[20:23], a[180:183], v[212:215]
    v_mfma_f32_16x16x32_bf16 a[80:83], a[16:19], a[168:171], a[80:83]
    ds_read_b64_tr_b16 a[62:63], v49 offset:25600
    v_mfma_f32_16x16x32_bf16 a[80:83], a[20:23], a[184:187], a[80:83]
    s_add_u32 s62, s62, 0x20000
    v_mfma_f32_16x16x32_bf16 a[84:87], a[16:19], a[172:175], a[84:87]
    s_add_u32 s52, s47, 532480
    v_mfma_f32_16x16x32_bf16 a[84:87], a[20:23], a[188:191], a[84:87]
    buffer_store_dwordx4 v[168:171], v1, s[48:51], s52 offen offset:2048 sc1
    v_mfma_f32_16x16x32_bf16 v[216:219], a[24:27], a[160:163], v[216:219]
    v_mfma_f32_16x16x32_bf16 v[216:219], a[28:31], a[176:179], v[216:219]
    v_mfma_f32_16x16x32_bf16 v[220:223], a[24:27], a[164:167], v[220:223]
    v_mfma_f32_16x16x32_bf16 v[220:223], a[28:31], a[180:183], v[220:223]
    v_mfma_f32_16x16x32_bf16 a[88:91], a[24:27], a[168:171], a[88:91]
    v_mfma_f32_16x16x32_bf16 a[88:91], a[28:31], a[184:187], a[88:91]
    v_mfma_f32_16x16x32_bf16 a[92:95], a[24:27], a[172:175], a[92:95]
    v_mfma_f32_16x16x32_bf16 a[92:95], a[28:31], a[188:191], a[92:95]
    s_waitcnt vmcnt(10) lgkmcnt(0)
    s_barrier
    v_mfma_f32_16x16x32_bf16 v[224:227], a[32:35], a[160:163], v[224:227]
    s_cmp_eq_u32 s56, 0
    s_cbranch_scc1 k12_ool_66
k12_oolret_67:
    v_mfma_f32_16x16x32_bf16 v[224:227], a[36:39], a[176:179], v[224:227]
    s_add_u32 m0, s60, 147456
    ds_read_b64_tr_b16 a[0:1], v42 offset:32768
    ds_read_b64_tr_b16 a[2:3], v42 offset:33792
    v_mfma_f32_16x16x32_bf16 v[228:231], a[32:35], a[164:167], v[228:231]
    buffer_load_dwordx4 v38, s[12:15], s61 offen offset:0 lds
    v_mfma_f32_16x16x32_bf16 v[228:231], a[36:39], a[180:183], v[228:231]
    ds_read_b64_tr_b16 a[4:5], v42 offset:40960
    v_mfma_f32_16x16x32_bf16 a[96:99], a[32:35], a[168:171], a[96:99]
    buffer_load_dwordx4 v39, s[12:15], s61 offen offset:1024 lds
    ds_read_b64_tr_b16 a[6:7], v42 offset:41984
    v_mfma_f32_16x16x32_bf16 a[96:99], a[36:39], a[184:187], a[96:99]
    ds_read_b64_tr_b16 a[8:9], v43 offset:32768
    v_mfma_f32_16x16x32_bf16 a[100:103], a[32:35], a[172:175], a[100:103]
    v_mfma_f32_16x16x32_bf16 a[100:103], a[36:39], a[188:191], a[100:103]
    buffer_load_dwordx4 v40, s[12:15], s61 offen offset:2048 lds
    ds_read_b64_tr_b16 a[10:11], v43 offset:33792
    v_mfma_f32_16x16x32_bf16 v[232:235], a[40:43], a[160:163], v[232:235]
    s_mov_b32 s32, s60
    ds_read_b64_tr_b16 a[12:13], v43 offset:40960
    v_mfma_f32_16x16x32_bf16 v[232:235], a[44:47], a[176:179], v[232:235]
    ds_read_b64_tr_b16 a[14:15], v43 offset:41984
    v_mfma_f32_16x16x32_bf16 v[236:239], a[40:43], a[164:167], v[236:239]
    s_mov_b32 s34, s60
    ds_read_b64_tr_b16 a[16:17], v44 offset:32768
    v_mfma_f32_16x16x32_bf16 v[236:239], a[44:47], a[180:183], v[236:239]
    buffer_load_dwordx4 v41, s[12:15], s61 offen offset:3072 lds
    v_mfma_f32_16x16x32_bf16 a[104:107], a[40:43], a[168:171], a[104:107]
    ds_read_b64_tr_b16 a[18:19], v44 offset:33792
    v_mfma_f32_16x16x32_bf16 a[104:107], a[44:47], a[184:187], a[104:107]
    s_mov_b32 s33, s60
    ds_read_b64_tr_b16 a[20:21], v44 offset:40960
    v_mfma_f32_16x16x32_bf16 a[108:111], a[40:43], a[172:175], a[108:111]
    s_add_u32 s61, s61, 0x80000
    buffer_load_dwordx4 a[240:243], v36, s[8:11], s62 offen sc1
    ds_read_b64_tr_b16 a[22:23], v44 offset:41984
    v_mfma_f32_16x16x32_bf16 a[108:111], a[44:47], a[188:191], a[108:111]
    v_mfma_f32_16x16x32_bf16 v[240:243], a[48:51], a[160:163], v[240:243]
    s_add_u32 s35, s60, 0x10000
    ds_read_b64_tr_b16 a[24:25], v45 offset:32768
    v_mfma_f32_16x16x32_bf16 v[240:243], a[52:55], a[176:179], v[240:243]
    buffer_load_dwordx4 a[244:247], v54, s[8:11], s62 offen sc1
    ds_read_b64_tr_b16 a[26:27], v45 offset:33792
    v_mfma_f32_16x16x32_bf16 v[244:247], a[48:51], a[164:167], v[244:247]
    ds_read_b64_tr_b16 a[28:29], v45 offset:40960
    v_mfma_f32_16x16x32_bf16 v[244:247], a[52:55], a[180:183], v[244:247]
    v_mfma_f32_16x16x32_bf16 a[112:115], a[48:51], a[168:171], a[112:115]
    buffer_load_dwordx4 a[248:251], v37, s[8:11], s62 offen sc1
    ds_read_b64_tr_b16 a[30:31], v45 offset:41984
    v_mfma_f32_16x16x32_bf16 a[112:115], a[52:55], a[184:187], a[112:115]
    v_mfma_f32_16x16x32_bf16 a[116:119], a[48:51], a[172:175], a[116:119]
    v_mfma_f32_16x16x32_bf16 a[116:119], a[52:55], a[188:191], a[116:119]
    v_mfma_f32_16x16x32_bf16 v[248:251], a[56:59], a[160:163], v[248:251]
    buffer_load_dwordx4 a[252:255], v55, s[8:11], s62 offen sc1
    v_mfma_f32_16x16x32_bf16 v[248:251], a[60:63], a[176:179], v[248:251]
    v_mfma_f32_16x16x32_bf16 v[252:255], a[56:59], a[164:167], v[252:255]
    s_add_u32 s62, s62, 0x20000
    v_mfma_f32_16x16x32_bf16 v[252:255], a[60:63], a[180:183], v[252:255]
    v_mfma_f32_16x16x32_bf16 a[120:123], a[56:59], a[168:171], a[120:123]
    v_mfma_f32_16x16x32_bf16 a[120:123], a[60:63], a[184:187], a[120:123]
    v_mfma_f32_16x16x32_bf16 a[124:127], a[56:59], a[172:175], a[124:127]
    v_mfma_f32_16x16x32_bf16 a[124:127], a[60:63], a[188:191], a[124:127]
    s_waitcnt vmcnt(14) lgkmcnt(0)
    v_mfma_f32_16x16x32_bf16 v[192:195], a[0:3], a[192:195], v[192:195]
    v_mfma_f32_16x16x32_bf16 v[192:195], a[4:7], a[208:211], v[192:195]
    buffer_load_dwordx4 a[128:131], v36, s[8:11], s62 offen sc1
    ds_read_b64_tr_b16 a[32:33], v46 offset:32768
    v_mfma_f32_16x16x32_bf16 v[196:199], a[0:3], a[196:199], v[196:199]
    ds_read_b64_tr_b16 a[34:35], v46 offset:33792
    v_mfma_f32_16x16x32_bf16 v[196:199], a[4:7], a[212:215], v[196:199]
    ds_read_b64_tr_b16 a[36:37], v46 offset:40960
    v_mfma_f32_16x16x32_bf16 a[64:67], a[0:3], a[200:203], a[64:67]
    ds_read_b64_tr_b16 a[38:39], v46 offset:41984
    v_mfma_f32_16x16x32_bf16 a[64:67], a[4:7], a[216:219], a[64:67]
    ds_read_b64_tr_b16 a[40:41], v47 offset:32768
    v_mfma_f32_16x16x32_bf16 a[68:71], a[0:3], a[204:207], a[68:71]
    buffer_load_dwordx4 a[132:135], v54, s[8:11], s62 offen sc1
    v_mfma_f32_16x16x32_bf16 a[68:71], a[4:7], a[220:223], a[68:71]
    ds_read_b64_tr_b16 a[42:43], v47 offset:33792
    v_mfma_f32_16x16x32_bf16 v[200:203], a[8:11], a[192:195], v[200:203]
    ds_read_b64_tr_b16 a[44:45], v47 offset:40960
    v_mfma_f32_16x16x32_bf16 v[200:203], a[12:15], a[208:211], v[200:203]
    ds_read_b64_tr_b16 a[46:47], v47 offset:41984
    v_mfma_f32_16x16x32_bf16 v[204:207], a[8:11], a[196:199], v[204:207]
    ds_read_b64_tr_b16 a[48:49], v48 offset:32768
    v_mfma_f32_16x16x32_bf16 v[204:207], a[12:15], a[212:215], v[204:207]
    buffer_load_dwordx4 a[136:139], v37, s[8:11], s62 offen sc1
    v_mfma_f32_16x16x32_bf16 a[72:75], a[8:11], a[200:203], a[72:75]
    ds_read_b64_tr_b16 a[50:51], v48 offset:33792
    v_mfma_f32_16x16x32_bf16 a[72:75], a[12:15], a[216:219], a[72:75]
    ds_read_b64_tr_b16 a[52:53], v48 offset:40960
    v_mfma_f32_16x16x32_bf16 a[76:79], a[8:11], a[204:207], a[76:79]
    ds_read_b64_tr_b16 a[54:55], v48 offset:41984
    v_mfma_f32_16x16x32_bf16 a[76:79], a[12:15], a[220:223], a[76:79]
    v_mfma_f32_16x16x32_bf16 v[208:211], a[16:19], a[192:195], v[208:211]
    ds_read_b64_tr_b16 a[56:57], v49 offset:32768
    v_mfma_f32_16x16x32_bf16 v[208:211], a[20:23], a[208:211], v[208:211]
    buffer_load_dwordx4 a[140:143], v55, s[8:11], s62 offen sc1
    ds_read_b64_tr_b16 a[58:59], v49 offset:33792
    v_mfma_f32_16x16x32_bf16 v[212:215], a[16:19], a[196:199], v[212:215]
    ds_read_b64_tr_b16 a[60:61], v49 offset:40960
    v_mfma_f32_16x16x32_bf16 v[212:215], a[20:23], a[212:215], v[212:215]
    v_mfma_f32_16x16x32_bf16 a[80:83], a[16:19], a[200:203], a[80:83]
    ds_read_b64_tr_b16 a[62:63], v49 offset:41984
    v_mfma_f32_16x16x32_bf16 a[80:83], a[20:23], a[216:219], a[80:83]
    s_add_u32 s62, s62, 0x20000
    v_mfma_f32_16x16x32_bf16 a[84:87], a[16:19], a[204:207], a[84:87]
    s_add_u32 s52, s47, 532480
    v_mfma_f32_16x16x32_bf16 a[84:87], a[20:23], a[220:223], a[84:87]
    buffer_store_dwordx4 v[172:175], v1, s[48:51], s52 offen offset:3072 sc1
    v_mfma_f32_16x16x32_bf16 v[216:219], a[24:27], a[192:195], v[216:219]
    v_mfma_f32_16x16x32_bf16 v[216:219], a[28:31], a[208:211], v[216:219]
    v_mfma_f32_16x16x32_bf16 v[220:223], a[24:27], a[196:199], v[220:223]
    v_mfma_f32_16x16x32_bf16 v[220:223], a[28:31], a[212:215], v[220:223]
    v_mfma_f32_16x16x32_bf16 a[88:91], a[24:27], a[200:203], a[88:91]
    v_add_co_u32 v2, vcc, 0x4000, v2
    s_nop 1
    v_addc_co_u32 v3, vcc, 0, v3, vcc
    global_load_dword v51, v[2:3], off
    v_mfma_f32_16x16x32_bf16 a[88:91], a[28:31], a[216:219], a[88:91]
    v_mfma_f32_16x16x32_bf16 a[92:95], a[24:27], a[204:207], a[92:95]
    v_mfma_f32_16x16x32_bf16 a[92:95], a[28:31], a[220:223], a[92:95]
    s_waitcnt vmcnt(9) lgkmcnt(0)
    s_barrier
    v_mfma_f32_16x16x32_bf16 v[224:227], a[32:35], a[192:195], v[224:227]
    v_mfma_f32_16x16x32_bf16 v[224:227], a[36:39], a[208:211], v[224:227]
    s_add_u32 m0, s60, 98304
    ds_read_b64_tr_b16 a[0:1], v42 offset:49152
    ds_read_b64_tr_b16 a[2:3], v42 offset:50176
    v_mfma_f32_16x16x32_bf16 v[228:231], a[32:35], a[196:199], v[228:231]
    buffer_load_dwordx4 v38, s[12:15], s61 offen offset:0 lds
    v_mfma_f32_16x16x32_bf16 v[228:231], a[36:39], a[212:215], v[228:231]
    ds_read_b64_tr_b16 a[4:5], v42 offset:57344
    v_mfma_f32_16x16x32_bf16 a[96:99], a[32:35], a[200:203], a[96:99]
    buffer_load_dwordx4 v39, s[12:15], s61 offen offset:1024 lds
    ds_read_b64_tr_b16 a[6:7], v42 offset:58368
    v_mfma_f32_16x16x32_bf16 a[96:99], a[36:39], a[216:219], a[96:99]
    ds_read_b64_tr_b16 a[8:9], v43 offset:49152
    v_mfma_f32_16x16x32_bf16 a[100:103], a[32:35], a[204:207], a[100:103]
    v_mfma_f32_16x16x32_bf16 a[100:103], a[36:39], a[220:223], a[100:103]
    buffer_load_dwordx4 v40, s[12:15], s61 offen offset:2048 lds
    ds_read_b64_tr_b16 a[10:11], v43 offset:50176
    v_mfma_f32_16x16x32_bf16 v[232:235], a[40:43], a[192:195], v[232:235]
    ds_read_b64_tr_b16 a[12:13], v43 offset:57344
    v_mfma_f32_16x16x32_bf16 v[232:235], a[44:47], a[208:211], v[232:235]
    ds_read_b64_tr_b16 a[14:15], v43 offset:58368
    v_mfma_f32_16x16x32_bf16 v[236:239], a[40:43], a[196:199], v[236:239]
    buffer_load_dwordx4 v41, s[12:15], s61 offen offset:3072 lds
    ds_read_b64_tr_b16 a[16:17], v44 offset:49152
    v_mfma_f32_16x16x32_bf16 v[236:239], a[44:47], a[212:215], v[236:239]
    v_mfma_f32_16x16x32_bf16 a[104:107], a[40:43], a[200:203], a[104:107]
    s_add_u32 s61, s61, 0x80000
    ds_read_b64_tr_b16 a[18:19], v44 offset:50176
    v_mfma_f32_16x16x32_bf16 a[104:107], a[44:47], a[216:219], a[104:107]
    buffer_load_dwordx4 a[144:147], v36, s[8:11], s62 offen sc1
    ds_read_b64_tr_b16 a[20:21], v44 offset:57344
    v_mfma_f32_16x16x32_bf16 a[108:111], a[40:43], a[204:207], a[108:111]
    ds_read_b64_tr_b16 a[22:23], v44 offset:58368
    v_mfma_f32_16x16x32_bf16 a[108:111], a[44:47], a[220:223], a[108:111]
    buffer_load_dwordx4 a[148:151], v54, s[8:11], s62 offen sc1
    v_mfma_f32_16x16x32_bf16 v[240:243], a[48:51], a[192:195], v[240:243]
    ds_read_b64_tr_b16 a[24:25], v45 offset:49152
    v_mfma_f32_16x16x32_bf16 v[240:243], a[52:55], a[208:211], v[240:243]
    ds_read_b64_tr_b16 a[26:27], v45 offset:50176
    v_mfma_f32_16x16x32_bf16 v[244:247], a[48:51], a[196:199], v[244:247]
    buffer_load_dwordx4 a[152:155], v37, s[8:11], s62 offen sc1
    ds_read_b64_tr_b16 a[28:29], v45 offset:57344
    v_mfma_f32_16x16x32_bf16 v[244:247], a[52:55], a[212:215], v[244:247]
    v_mfma_f32_16x16x32_bf16 a[112:115], a[48:51], a[200:203], a[112:115]
    ds_read_b64_tr_b16 a[30:31], v45 offset:58368
    v_mfma_f32_16x16x32_bf16 a[112:115], a[52:55], a[216:219], a[112:115]
    buffer_load_dwordx4 a[156:159], v55, s[8:11], s62 offen sc1
    v_mfma_f32_16x16x32_bf16 a[116:119], a[48:51], a[204:207], a[116:119]
    v_mfma_f32_16x16x32_bf16 a[116:119], a[52:55], a[220:223], a[116:119]
    s_add_u32 s62, s62, 0x20000
    v_mfma_f32_16x16x32_bf16 v[248:251], a[56:59], a[192:195], v[248:251]
    s_add_u32 s52, s47, 536576
    v_mfma_f32_16x16x32_bf16 v[248:251], a[60:63], a[208:211], v[248:251]
    buffer_store_dwordx4 v[176:179], v1, s[48:51], s52 offen offset:0 sc1
    v_mfma_f32_16x16x32_bf16 v[252:255], a[56:59], a[196:199], v[252:255]
    v_mfma_f32_16x16x32_bf16 v[252:255], a[60:63], a[212:215], v[252:255]
    v_mfma_f32_16x16x32_bf16 a[120:123], a[56:59], a[200:203], a[120:123]
    v_mfma_f32_16x16x32_bf16 a[120:123], a[60:63], a[216:219], a[120:123]
    v_mfma_f32_16x16x32_bf16 a[124:127], a[56:59], a[204:207], a[124:127]
    v_mfma_f32_16x16x32_bf16 a[124:127], a[60:63], a[220:223], a[124:127]
    s_waitcnt vmcnt(14) lgkmcnt(0)
    v_mfma_f32_16x16x32_bf16 v[192:195], a[0:3], a[224:227], v[192:195]
    v_mfma_f32_16x16x32_bf16 v[192:195], a[4:7], a[240:243], v[192:195]
    buffer_load_dwordx4 a[160:163], v36, s[8:11], s62 offen sc1
    ds_read_b64_tr_b16 a[32:33], v46 offset:49152
    v_mfma_f32_16x16x32_bf16 v[196:199], a[0:3], a[228:231], v[196:199]
    ds_read_b64_tr_b16 a[34:35], v46 offset:50176
    v_mfma_f32_16x16x32_bf16 v[196:199], a[4:7], a[244:247], v[196:199]
    ds_read_b64_tr_b16 a[36:37], v46 offset:57344
    v_mfma_f32_16x16x32_bf16 a[64:67], a[0:3], a[232:235], a[64:67]
    ds_read_b64_tr_b16 a[38:39], v46 offset:58368
    v_mfma_f32_16x16x32_bf16 a[64:67], a[4:7], a[248:251], a[64:67]
    ds_read_b64_tr_b16 a[40:41], v47 offset:49152
    v_mfma_f32_16x16x32_bf16 a[68:71], a[0:3], a[236:239], a[68:71]
    buffer_load_dwordx4 a[164:167], v54, s[8:11], s62 offen sc1
    v_mfma_f32_16x16x32_bf16 a[68:71], a[4:7], a[252:255], a[68:71]
    ds_read_b64_tr_b16 a[42:43], v47 offset:50176
    v_mfma_f32_16x16x32_bf16 v[200:203], a[8:11], a[224:227], v[200:203]
    ds_read_b64_tr_b16 a[44:45], v47 offset:57344
    v_mfma_f32_16x16x32_bf16 v[200:203], a[12:15], a[240:243], v[200:203]
    ds_read_b64_tr_b16 a[46:47], v47 offset:58368
    v_mfma_f32_16x16x32_bf16 v[204:207], a[8:11], a[228:231], v[204:207]
    ds_read_b64_tr_b16 a[48:49], v48 offset:49152
    v_mfma_f32_16x16x32_bf16 v[204:207], a[12:15], a[244:247], v[204:207]
    buffer_load_dwordx4 a[168:171], v37, s[8:11], s62 offen sc1
    v_mfma_f32_16x16x32_bf16 a[72:75], a[8:11], a[232:235], a[72:75]
    ds_read_b64_tr_b16 a[50:51], v48 offset:50176
    v_mfma_f32_16x16x32_bf16 a[72:75], a[12:15], a[248:251], a[72:75]
    ds_read_b64_tr_b16 a[52:53], v48 offset:57344
    v_mfma_f32_16x16x32_bf16 a[76:79], a[8:11], a[236:239], a[76:79]
    ds_read_b64_tr_b16 a[54:55], v48 offset:58368
    v_mfma_f32_16x16x32_bf16 a[76:79], a[12:15], a[252:255], a[76:79]
    v_mfma_f32_16x16x32_bf16 v[208:211], a[16:19], a[224:227], v[208:211]
    ds_read_b64_tr_b16 a[56:57], v49 offset:49152
    v_mfma_f32_16x16x32_bf16 v[208:211], a[20:23], a[240:243], v[208:211]
    buffer_load_dwordx4 a[172:175], v55, s[8:11], s62 offen sc1
    ds_read_b64_tr_b16 a[58:59], v49 offset:50176
    v_mfma_f32_16x16x32_bf16 v[212:215], a[16:19], a[228:231], v[212:215]
    ds_read_b64_tr_b16 a[60:61], v49 offset:57344
    v_mfma_f32_16x16x32_bf16 v[212:215], a[20:23], a[244:247], v[212:215]
    v_mfma_f32_16x16x32_bf16 a[80:83], a[16:19], a[232:235], a[80:83]
    ds_read_b64_tr_b16 a[62:63], v49 offset:58368
    v_mfma_f32_16x16x32_bf16 a[80:83], a[20:23], a[248:251], a[80:83]
    s_add_u32 s62, s62, 0x20000
    v_mfma_f32_16x16x32_bf16 a[84:87], a[16:19], a[236:239], a[84:87]
    s_add_u32 s52, s47, 536576
    v_mfma_f32_16x16x32_bf16 a[84:87], a[20:23], a[252:255], a[84:87]
    buffer_store_dwordx4 v[180:183], v1, s[48:51], s52 offen offset:1024 sc1
    v_mfma_f32_16x16x32_bf16 v[216:219], a[24:27], a[224:227], v[216:219]
    v_mfma_f32_16x16x32_bf16 v[216:219], a[28:31], a[240:243], v[216:219]
    v_mfma_f32_16x16x32_bf16 v[220:223], a[24:27], a[228:231], v[220:223]
    v_mfma_f32_16x16x32_bf16 v[220:223], a[28:31], a[244:247], v[220:223]
    v_mfma_f32_16x16x32_bf16 a[88:91], a[24:27], a[232:235], a[88:91]
    v_mfma_f32_16x16x32_bf16 a[88:91], a[28:31], a[248:251], a[88:91]
    v_mfma_f32_16x16x32_bf16 a[92:95], a[24:27], a[236:239], a[92:95]
    v_mfma_f32_16x16x32_bf16 a[92:95], a[28:31], a[252:255], a[92:95]
    s_waitcnt vmcnt(10) lgkmcnt(0)
    s_barrier
    v_mfma_f32_16x16x32_bf16 v[224:227], a[32:35], a[224:227], v[224:227]
    s_cmp_eq_u32 s30, 0
    s_cbranch_scc1 k12_ool_68
k12_oolret_69:
    v_mfma_f32_16x16x32_bf16 v[224:227], a[36:39], a[240:243], v[224:227]
    s_add_u32 m0, s60, 114688
    ds_read_b64_tr_b16 a[0:1], v42 offset:0
    ds_read_b64_tr_b16 a[2:3], v42 offset:1024
    v_mfma_f32_16x16x32_bf16 v[228:231], a[32:35], a[228:231], v[228:231]
    buffer_load_dwordx4 v38, s[12:15], s61 offen offset:0 lds
    v_mfma_f32_16x16x32_bf16 v[228:231], a[36:39], a[244:247], v[228:231]
    ds_read_b64_tr_b16 a[4:5], v42 offset:8192
    v_mfma_f32_16x16x32_bf16 a[96:99], a[32:35], a[232:235], a[96:99]
    buffer_load_dwordx4 v39, s[12:15], s61 offen offset:1024 lds
    ds_read_b64_tr_b16 a[6:7], v42 offset:9216
    v_mfma_f32_16x16x32_bf16 a[96:99], a[36:39], a[248:251], a[96:99]
    ds_read_b64_tr_b16 a[8:9], v43 offset:0
    v_mfma_f32_16x16x32_bf16 a[100:103], a[32:35], a[236:239], a[100:103]
    v_mfma_f32_16x16x32_bf16 a[100:103], a[36:39], a[252:255], a[100:103]
    buffer_load_dwordx4 v40, s[12:15], s61 offen offset:2048 lds
    ds_read_b64_tr_b16 a[10:11], v43 offset:1024
    v_mfma_f32_16x16x32_bf16 v[232:235], a[40:43], a[224:227], v[232:235]
    ds_read_b64_tr_b16 a[12:13], v43 offset:8192
    v_mfma_f32_16x16x32_bf16 v[232:235], a[44:47], a[240:243], v[232:235]
    ds_read_b64_tr_b16 a[14:15], v43 offset:9216
    v_mfma_f32_16x16x32_bf16 v[236:239], a[40:43], a[228:231], v[236:239]
    buffer_load_dwordx4 v41, s[12:15], s61 offen offset:3072 lds
    ds_read_b64_tr_b16 a[16:17], v44 offset:0
    v_mfma_f32_16x16x32_bf16 v[236:239], a[44:47], a[244:247], v[236:239]
    v_mfma_f32_16x16x32_bf16 a[104:107], a[40:43], a[232:235], a[104:107]
    s_add_u32 s61, s61, 0x80000
    ds_read_b64_tr_b16 a[18:19], v44 offset:1024
    v_mfma_f32_16x16x32_bf16 a[104:107], a[44:47], a[248:251], a[104:107]
    buffer_load_dwordx4 a[176:179], v36, s[8:11], s62 offen sc1
    ds_read_b64_tr_b16 a[20:21], v44 offset:8192
    v_mfma_f32_16x16x32_bf16 a[108:111], a[40:43], a[236:239], a[108:111]
    ds_read_b64_tr_b16 a[22:23], v44 offset:9216
    v_mfma_f32_16x16x32_bf16 a[108:111], a[44:47], a[252:255], a[108:111]
    buffer_load_dwordx4 a[180:183], v54, s[8:11], s62 offen sc1
    v_mfma_f32_16x16x32_bf16 v[240:243], a[48:51], a[224:227], v[240:243]
    ds_read_b64_tr_b16 a[24:25], v45 offset:0
    v_mfma_f32_16x16x32_bf16 v[240:243], a[52:55], a[240:243], v[240:243]
    ds_read_b64_tr_b16 a[26:27], v45 offset:1024
    v_mfma_f32_16x16x32_bf16 v[244:247], a[48:51], a[228:231], v[244:247]
    buffer_load_dwordx4 a[184:187], v37, s[8:11], s62 offen sc1
    ds_read_b64_tr_b16 a[28:29], v45 offset:8192
    v_mfma_f32_16x16x32_bf16 v[244:247], a[52:55], a[244:247], v[244:247]
    v_mfma_f32_16x16x32_bf16 a[112:115], a[48:51], a[232:235], a[112:115]
    ds_read_b64_tr_b16 a[30:31], v45 offset:9216
    v_mfma_f32_16x16x32_bf16 a[112:115], a[52:55], a[248:251], a[112:115]
    buffer_load_dwordx4 a[188:191], v55, s[8:11], s62 offen sc1
    v_mfma_f32_16x16x32_bf16 a[116:119], a[48:51], a[236:239], a[116:119]
    v_mfma_f32_16x16x32_bf16 a[116:119], a[52:55], a[252:255], a[116:119]
    s_add_u32 s62, s62, 0x20000
    v_mfma_f32_16x16x32_bf16 v[248:251], a[56:59], a[224:227], v[248:251]
    s_add_u32 s52, s47, 536576
    v_mfma_f32_16x16x32_bf16 v[248:251], a[60:63], a[240:243], v[248:251]
    buffer_store_dwordx4 v[184:187], v1, s[48:51], s52 offen offset:2048 sc1
    v_mfma_f32_16x16x32_bf16 v[252:255], a[56:59], a[228:231], v[252:255]
    v_mfma_f32_16x16x32_bf16 v[252:255], a[60:63], a[244:247], v[252:255]
    v_mfma_f32_16x16x32_bf16 a[120:123], a[56:59], a[232:235], a[120:123]
    v_mfma_f32_16x16x32_bf16 a[120:123], a[60:63], a[248:251], a[120:123]
    v_mfma_f32_16x16x32_bf16 a[124:127], a[56:59], a[236:239], a[124:127]
    v_mfma_f32_16x16x32_bf16 a[124:127], a[60:63], a[252:255], a[124:127]
    s_waitcnt vmcnt(15) lgkmcnt(0)
    v_mfma_f32_16x16x32_bf16 v[192:195], a[0:3], a[128:131], v[192:195]
    v_mfma_f32_16x16x32_bf16 v[192:195], a[4:7], a[144:147], v[192:195]
    s_add_u32 s52, s47, 536576
    ds_read_b64_tr_b16 a[32:33], v46 offset:0
    ds_read_b64_tr_b16 a[34:35], v46 offset:1024
    v_mfma_f32_16x16x32_bf16 v[196:199], a[0:3], a[132:135], v[196:199]
    buffer_store_dwordx4 v[188:191], v1, s[48:51], s52 offen offset:3072 sc1
    v_mfma_f32_16x16x32_bf16 v[196:199], a[4:7], a[148:151], v[196:199]
    ds_read_b64_tr_b16 a[36:37], v46 offset:8192
    v_mfma_f32_16x16x32_bf16 a[64:67], a[0:3], a[136:139], a[64:67]
    ds_read_b64_tr_b16 a[38:39], v46 offset:9216
    v_mfma_f32_16x16x32_bf16 a[64:67], a[4:7], a[152:155], a[64:67]
    ds_read_b64_tr_b16 a[40:41], v47 offset:0
    v_mfma_f32_16x16x32_bf16 a[68:71], a[0:3], a[140:143], a[68:71]
    v_mfma_f32_16x16x32_bf16 a[68:71], a[4:7], a[156:159], a[68:71]
    ds_read_b64_tr_b16 a[42:43], v47 offset:1024
    v_mfma_f32_16x16x32_bf16 v[200:203], a[8:11], a[128:131], v[200:203]
    ds_read_b64_tr_b16 a[44:45], v47 offset:8192
    v_mfma_f32_16x16x32_bf16 v[200:203], a[12:15], a[144:147], v[200:203]
    ds_read_b64_tr_b16 a[46:47], v47 offset:9216
    v_mfma_f32_16x16x32_bf16 v[204:207], a[8:11], a[132:135], v[204:207]
    ds_read_b64_tr_b16 a[48:49], v48 offset:0
    v_mfma_f32_16x16x32_bf16 v[204:207], a[12:15], a[148:151], v[204:207]
    v_mfma_f32_16x16x32_bf16 a[72:75], a[8:11], a[136:139], a[72:75]
    ds_read_b64_tr_b16 a[50:51], v48 offset:1024
    v_mfma_f32_16x16x32_bf16 a[72:75], a[12:15], a[152:155], a[72:75]
    ds_read_b64_tr_b16 a[52:53], v48 offset:8192
    v_mfma_f32_16x16x32_bf16 a[76:79], a[8:11], a[140:143], a[76:79]
    ds_read_b64_tr_b16 a[54:55], v48 offset:9216
    v_mfma_f32_16x16x32_bf16 a[76:79], a[12:15], a[156:159], a[76:79]
    v_mfma_f32_16x16x32_bf16 v[208:211], a[16:19], a[128:131], v[208:211]
    ds_read_b64_tr_b16 a[56:57], v49 offset:0
    v_mfma_f32_16x16x32_bf16 v[208:211], a[20:23], a[144:147], v[208:211]
    ds_read_b64_tr_b16 a[58:59], v49 offset:1024
    v_mfma_f32_16x16x32_bf16 v[212:215], a[16:19], a[132:135], v[212:215]
    ds_read_b64_tr_b16 a[60:61], v49 offset:8192
    v_mfma_f32_16x16x32_bf16 v[212:215], a[20:23], a[148:151], v[212:215]
    v_mfma_f32_16x16x32_bf16 a[80:83], a[16:19], a[136:139], a[80:83]
    ds_read_b64_tr_b16 a[62:63], v49 offset:9216
    v_mfma_f32_16x16x32_bf16 a[80:83], a[20:23], a[152:155], a[80:83]
    v_mfma_f32_16x16x32_bf16 a[84:87], a[16:19], a[140:143], a[84:87]
    v_mfma_f32_16x16x32_bf16 a[84:87], a[20:23], a[156:159], a[84:87]
    v_mfma_f32_16x16x32_bf16 v[216:219], a[24:27], a[128:131], v[216:219]
    v_mfma_f32_16x16x32_bf16 v[216:219], a[28:31], a[144:147], v[216:219]
    v_mfma_f32_16x16x32_bf16 v[220:223], a[24:27], a[132:135], v[220:223]
    v_mfma_f32_16x16x32_bf16 v[220:223], a[28:31], a[148:151], v[220:223]
    v_mfma_f32_16x16x32_bf16 a[88:91], a[24:27], a[136:139], a[88:91]
    s_cmp_eq_u32 s30, 0
    s_cbranch_scc1 k12_ool_72
k12_oolret_73:
    v_mfma_f32_16x16x32_bf16 a[88:91], a[28:31], a[152:155], a[88:91]
    v_mfma_f32_16x16x32_bf16 a[92:95], a[24:27], a[140:143], a[92:95]
    v_mfma_f32_16x16x32_bf16 a[92:95], a[28:31], a[156:159], a[92:95]
    s_waitcnt vmcnt(6) lgkmcnt(0)
    s_barrier
    v_mfma_f32_16x16x32_bf16 v[224:227], a[32:35], a[128:131], v[224:227]
    v_mfma_f32_16x16x32_bf16 v[224:227], a[36:39], a[144:147], v[224:227]
    s_mov_b32 m0, s34
    ds_read_b64_tr_b16 a[0:1], v42 offset:16384
    ds_read_b64_tr_b16 a[2:3], v42 offset:17408
    v_mfma_f32_16x16x32_bf16 v[228:231], a[32:35], a[132:135], v[228:231]
    buffer_load_dwordx4 v1, s[16:19], s32 offen offset:0 sc1 lds
    v_mfma_f32_16x16x32_bf16 v[228:231], a[36:39], a[148:151], v[228:231]
    ds_read_b64_tr_b16 a[4:5], v42 offset:24576
    v_mfma_f32_16x16x32_bf16 a[96:99], a[32:35], a[136:139], a[96:99]
    buffer_load_dwordx4 v1, s[16:19], s32 offen offset:1024 sc1 lds
    ds_read_b64_tr_b16 a[6:7], v42 offset:25600
    v_mfma_f32_16x16x32_bf16 a[96:99], a[36:39], a[152:155], a[96:99]
    ds_read_b64_tr_b16 a[8:9], v43 offset:16384
    v_mfma_f32_16x16x32_bf16 a[100:103], a[32:35], a[140:143], a[100:103]
    v_mfma_f32_16x16x32_bf16 a[100:103], a[36:39], a[156:159], a[100:103]
    buffer_load_dwordx4 v1, s[16:19], s32 offen offset:2048 sc1 lds
    ds_read_b64_tr_b16 a[10:11], v43 offset:17408
    v_mfma_f32_16x16x32_bf16 v[232:235], a[40:43], a[128:131], v[232:235]
    ds_read_b64_tr_b16 a[12:13], v43 offset:24576
    v_mfma_f32_16x16x32_bf16 v[232:235], a[44:47], a[144:147], v[232:235]
    ds_read_b64_tr_b16 a[14:15], v43 offset:25600
    v_mfma_f32_16x16x32_bf16 v[236:239], a[40:43], a[132:135], v[236:239]
    ds_read_b64_tr_b16 a[16:17], v44 offset:16384
    v_mfma_f32_16x16x32_bf16 v[236:239], a[44:47], a[148:151], v[236:239]
    buffer_load_dwordx4 v1, s[16:19], s32 offen offset:3072 sc1 lds
    v_mfma_f32_16x16x32_bf16 a[104:107], a[40:43], a[136:139], a[104:107]
    ds_read_b64_tr_b16 a[18:19], v44 offset:17408
    v_mfma_f32_16x16x32_bf16 a[104:107], a[44:47], a[152:155], a[104:107]
    s_add_u32 s32, s32, 0x80000
    ds_read_b64_tr_b16 a[20:21], v44 offset:24576
    v_mfma_f32_16x16x32_bf16 a[108:111], a[40:43], a[140:143], a[108:111]
    s_add_u32 s34, s34, 0x4000
    ds_read_b64_tr_b16 a[22:23], v44 offset:25600
    s_mov_b32 m0, s34
    v_mfma_f32_16x16x32_bf16 a[108:111], a[44:47], a[156:159], a[108:111]
    buffer_load_dwordx4 v1, s[16:19], s32 offen offset:0 sc1 lds
    v_mfma_f32_16x16x32_bf16 v[240:243], a[48:51], a[128:131], v[240:243]
    ds_read_b64_tr_b16 a[24:25], v45 offset:16384
    v_mfma_f32_16x16x32_bf16 v[240:243], a[52:55], a[144:147], v[240:243]
    buffer_load_dwordx4 v1, s[16:19], s32 offen offset:1024 sc1 lds
    ds_read_b64_tr_b16 a[26:27], v45 offset:17408
    v_mfma_f32_16x16x32_bf16 v[244:247], a[48:51], a[132:135], v[244:247]
    ds_read_b64_tr_b16 a[28:29], v45 offset:24576
    v_mfma_f32_16x16x32_bf16 v[244:247], a[52:55], a[148:151], v[244:247]
    v_mfma_f32_16x16x32_bf16 a[112:115], a[48:51], a[136:139], a[112:115]
    buffer_load_dwordx4 v1, s[16:19], s32 offen offset:2048 sc1 lds
    ds_read_b64_tr_b16 a[30:31], v45 offset:25600
    v_mfma_f32_16x16x32_bf16 a[112:115], a[52:55], a[152:155], a[112:115]
    v_mfma_f32_16x16x32_bf16 a[116:119], a[48:51], a[140:143], a[116:119]
    v_mfma_f32_16x16x32_bf16 a[116:119], a[52:55], a[156:159], a[116:119]
    v_mfma_f32_16x16x32_bf16 v[248:251], a[56:59], a[128:131], v[248:251]
    buffer_load_dwordx4 v1, s[16:19], s32 offen offset:3072 sc1 lds
    v_mfma_f32_16x16x32_bf16 v[248:251], a[60:63], a[144:147], v[248:251]
    v_mfma_f32_16x16x32_bf16 v[252:255], a[56:59], a[132:135], v[252:255]
    s_add_u32 s32, s32, 0x80000
    v_mfma_f32_16x16x32_bf16 v[252:255], a[60:63], a[148:151], v[252:255]
    s_add_u32 s34, s34, 0x4000
    v_mfma_f32_16x16x32_bf16 a[120:123], a[56:59], a[136:139], a[120:123]
    v_mfma_f32_16x16x32_bf16 a[120:123], a[60:63], a[152:155], a[120:123]
    v_mfma_f32_16x16x32_bf16 a[124:127], a[56:59], a[140:143], a[124:127]
    v_mfma_f32_16x16x32_bf16 a[124:127], a[60:63], a[156:159], a[124:127]
    s_waitcnt vmcnt(10) lgkmcnt(0)
    v_mfma_f32_16x16x32_bf16 v[192:195], a[0:3], a[160:163], v[192:195]
    v_mfma_f32_16x16x32_bf16 v[192:195], a[4:7], a[176:179], v[192:195]
    s_mov_b32 m0, s35
    ds_read_b64_tr_b16 a[32:33], v46 offset:16384
    ds_read_b64_tr_b16 a[34:35], v46 offset:17408
    v_mfma_f32_16x16x32_bf16 v[196:199], a[0:3], a[164:167], v[196:199]
    buffer_load_dwordx4 v1, s[20:23], s33 offen offset:0 sc1 lds
    v_mfma_f32_16x16x32_bf16 v[196:199], a[4:7], a[180:183], v[196:199]
    ds_read_b64_tr_b16 a[36:37], v46 offset:24576
    v_mfma_f32_16x16x32_bf16 a[64:67], a[0:3], a[168:171], a[64:67]
    buffer_load_dwordx4 v1, s[20:23], s33 offen offset:1024 sc1 lds
    ds_read_b64_tr_b16 a[38:39], v46 offset:25600
    v_mfma_f32_16x16x32_bf16 a[64:67], a[4:7], a[184:187], a[64:67]
    ds_read_b64_tr_b16 a[40:41], v47 offset:16384
    v_mfma_f32_16x16x32_bf16 a[68:71], a[0:3], a[172:175], a[68:71]
    v_mfma_f32_16x16x32_bf16 a[68:71], a[4:7], a[188:191], a[68:71]
    buffer_load_dwordx4 v1, s[20:23], s33 offen offset:2048 sc1 lds
    ds_read_b64_tr_b16 a[42:43], v47 offset:17408
    v_mfma_f32_16x16x32_bf16 v[200:203], a[8:11], a[160:163], v[200:203]
    ds_read_b64_tr_b16 a[44:45], v47 offset:24576
    v_mfma_f32_16x16x32_bf16 v[200:203], a[12:15], a[176:179], v[200:203]
    ds_read_b64_tr_b16 a[46:47], v47 offset:25600
    v_mfma_f32_16x16x32_bf16 v[204:207], a[8:11], a[164:167], v[204:207]
    ds_read_b64_tr_b16 a[48:49], v48 offset:16384
    v_mfma_f32_16x16x32_bf16 v[204:207], a[12:15], a[180:183], v[204:207]
    buffer_load_dwordx4 v1, s[20:23], s33 offen offset:3072 sc1 lds
    v_mfma_f32_16x16x32_bf16 a[72:75], a[8:11], a[168:171], a[72:75]
    ds_read_b64_tr_b16 a[50:51], v48 offset:17408
    v_mfma_f32_16x16x32_bf16 a[72:75], a[12:15], a[184:187], a[72:75]
    s_add_u32 s33, s33, 0x80000
    ds_read_b64_tr_b16 a[52:53], v48 offset:24576
    v_mfma_f32_16x16x32_bf16 a[76:79], a[8:11], a[172:175], a[76:79]
    s_add_u32 s35, s35, 0x4000
    ds_read_b64_tr_b16 a[54:55], v48 offset:25600
    s_mov_b32 m0, s34
    v_mfma_f32_16x16x32_bf16 a[76:79], a[12:15], a[188:191], a[76:79]
    buffer_load_dwordx4 v1, s[16:19], s32 offen offset:0 sc1 lds
    v_mfma_f32_16x16x32_bf16 v[208:211], a[16:19], a[160:163], v[208:211]
    ds_read_b64_tr_b16 a[56:57], v49 offset:16384
    v_mfma_f32_16x16x32_bf16 v[208:211], a[20:23], a[176:179], v[208:211]
    buffer_load_dwordx4 v1, s[16:19], s32 offen offset:1024 sc1 lds
    ds_read_b64_tr_b16 a[58:59], v49 offset:17408
    v_mfma_f32_16x16x32_bf16 v[212:215], a[16:19], a[164:167], v[212:215]
    ds_read_b64_tr_b16 a[60:61], v49 offset:24576
    v_mfma_f32_16x16x32_bf16 v[212:215], a[20:23], a[180:183], v[212:215]
    v_mfma_f32_16x16x32_bf16 a[80:83], a[16:19], a[168:171], a[80:83]
    buffer_load_dwordx4 v1, s[16:19], s32 offen offset:2048 sc1 lds
    ds_read_b64_tr_b16 a[62:63], v49 offset:25600
    v_mfma_f32_16x16x32_bf16 a[80:83], a[20:23], a[184:187], a[80:83]
    v_mfma_f32_16x16x32_bf16 a[84:87], a[16:19], a[172:175], a[84:87]
    v_mfma_f32_16x16x32_bf16 a[84:87], a[20:23], a[188:191], a[84:87]
    v_mfma_f32_16x16x32_bf16 v[216:219], a[24:27], a[160:163], v[216:219]
    buffer_load_dwordx4 v1, s[16:19], s32 offen offset:3072 sc1 lds
    v_mfma_f32_16x16x32_bf16 v[216:219], a[28:31], a[176:179], v[216:219]
    v_mfma_f32_16x16x32_bf16 v[220:223], a[24:27], a[164:167], v[220:223]
    s_add_u32 s32, s32, 0x80000
    v_mfma_f32_16x16x32_bf16 v[220:223], a[28:31], a[180:183], v[220:223]
    s_add_u32 s34, s34, 0x4000
    v_mfma_f32_16x16x32_bf16 a[88:91], a[24:27], a[168:171], a[88:91]
    v_mfma_f32_16x16x32_bf16 a[88:91], a[28:31], a[184:187], a[88:91]
    v_mfma_f32_16x16x32_bf16 a[92:95], a[24:27], a[172:175], a[92:95]
    v_mfma_f32_16x16x32_bf16 a[92:95], a[28:31], a[188:191], a[92:95]
    s_waitcnt vmcnt(63) lgkmcnt(0)
    s_barrier
    v_mfma_f32_16x16x32_bf16 v[224:227], a[32:35], a[160:163], v[224:227]
    v_mfma_f32_16x16x32_bf16 v[224:227], a[36:39], a[176:179], v[224:227]
    s_mov_b32 m0, s35
    v_mfma_f32_16x16x32_bf16 v[228:231], a[32:35], a[164:167], v[228:231]
    buffer_load_dwordx4 v1, s[20:23], s33 offen offset:0 sc1 lds
    v_mfma_f32_16x16x32_bf16 v[228:231], a[36:39], a[180:183], v[228:231]
    v_mfma_f32_16x16x32_bf16 a[96:99], a[32:35], a[168:171], a[96:99]
    v_mfma_f32_16x16x32_bf16 a[96:99], a[36:39], a[184:187], a[96:99]
    v_mfma_f32_16x16x32_bf16 a[100:103], a[32:35], a[172:175], a[100:103]
    v_mfma_f32_16x16x32_bf16 a[100:103], a[36:39], a[188:191], a[100:103]
    buffer_load_dwordx4 v1, s[20:23], s33 offen offset:1024 sc1 lds
    v_mfma_f32_16x16x32_bf16 v[232:235], a[40:43], a[160:163], v[232:235]
    v_mfma_f32_16x16x32_bf16 v[232:235], a[44:47], a[176:179], v[232:235]
    v_mfma_f32_16x16x32_bf16 v[236:239], a[40:43], a[164:167], v[236:239]
    v_mfma_f32_16x16x32_bf16 v[236:239], a[44:47], a[180:183], v[236:239]
    v_mfma_f32_16x16x32_bf16 a[104:107], a[40:43], a[168:171], a[104:107]
    v_mfma_f32_16x16x32_bf16 a[104:107], a[44:47], a[184:187], a[104:107]
    v_mfma_f32_16x16x32_bf16 a[108:111], a[40:43], a[172:175], a[108:111]
    buffer_load_dwordx4 v1, s[20:23], s33 offen offset:2048 sc1 lds
    v_mfma_f32_16x16x32_bf16 a[108:111], a[44:47], a[188:191], a[108:111]
    v_mfma_f32_16x16x32_bf16 v[240:243], a[48:51], a[160:163], v[240:243]
    v_mfma_f32_16x16x32_bf16 v[240:243], a[52:55], a[176:179], v[240:243]
    v_mfma_f32_16x16x32_bf16 v[244:247], a[48:51], a[164:167], v[244:247]
    v_mfma_f32_16x16x32_bf16 v[244:247], a[52:55], a[180:183], v[244:247]
    v_mfma_f32_16x16x32_bf16 a[112:115], a[48:51], a[168:171], a[112:115]
    buffer_load_dwordx4 v1, s[20:23], s33 offen offset:3072 sc1 lds
    v_mfma_f32_16x16x32_bf16 a[112:115], a[52:55], a[184:187], a[112:115]
    v_mfma_f32_16x16x32_bf16 a[116:119], a[48:51], a[172:175], a[116:119]
    v_mfma_f32_16x16x32_bf16 a[116:119], a[52:55], a[188:191], a[116:119]
    v_mfma_f32_16x16x32_bf16 v[248:251], a[56:59], a[160:163], v[248:251]
    v_mfma_f32_16x16x32_bf16 v[248:251], a[60:63], a[176:179], v[248:251]
    v_mfma_f32_16x16x32_bf16 v[252:255], a[56:59], a[164:167], v[252:255]
    s_add_u32 s33, s33, 0x80000
    v_mfma_f32_16x16x32_bf16 v[252:255], a[60:63], a[180:183], v[252:255]
    s_add_u32 s35, s35, 0x4000
    v_mfma_f32_16x16x32_bf16 a[120:123], a[56:59], a[168:171], a[120:123]
    v_mfma_f32_16x16x32_bf16 a[120:123], a[60:63], a[184:187], a[120:123]
    v_mfma_f32_16x16x32_bf16 a[124:127], a[56:59], a[172:175], a[124:127]
    v_mfma_f32_16x16x32_bf16 a[124:127], a[60:63], a[188:191], a[124:127]
    s_add_u32 s3, s54, 64
    s_add_u32 s5, s55, 64
    s_mov_b32 s63, s57
    s_load_dwordx2 s[44:45], s[0:1], 40
    s_load_dwordx2 s[46:47], s[0:1], 64
    s_load_dwordx4 s[48:51], s[0:1], 72
    s_mov_b32 s40, 0x3e0293ee
    s_mov_b32 s41, 0x3e0293ee
    s_mov_b32 m0, s34
    s_nop 0
    buffer_load_dwordx4 v1, s[16:19], s32 offen offset:0 sc1 lds
    buffer_load_dwordx4 v1, s[16:19], s32 offen offset:1024 sc1 lds
    buffer_load_dwordx4 v1, s[16:19], s32 offen offset:2048 sc1 lds
    buffer_load_dwordx4 v1, s[16:19], s32 offen offset:3072 sc1 lds
    s_mov_b32 m0, s35
    s_nop 0
    buffer_load_dwordx4 v1, s[20:23], s33 offen offset:0 sc1 lds
    buffer_load_dwordx4 v1, s[20:23], s33 offen offset:1024 sc1 lds
    buffer_load_dwordx4 v1, s[20:23], s33 offen offset:2048 sc1 lds
    buffer_load_dwordx4 v1, s[20:23], s33 offen offset:3072 sc1 lds
    s_add_u32 s32, s32, 0x80000
    s_add_u32 s33, s33, 0x80000
    s_add_u32 s34, s34, 0x4000
    s_and_b32 s34, s34, 0xffff
    s_add_u32 s35, s35, 0x4000
    s_and_b32 s35, s35, 0xffff
    s_or_b32 s35, s35, 0x10000
    v_mov_b32 v2, v1
    v_or_b32 v3, 0x10000, v1
    v_mov_b32 v56, v3
    s_mov_b32 s52, 0x4000
    s_mov_b32 s53, 0
    s_lshl_b32 s62, s28, 6
    s_mul_i32 s31, s29, s29
    s_add_u32 s62, s62, s31
    s_lshr_b32 s31, s30, 1
    s_lshl_b32 s4, s31, 23
    s_add_u32 s4, s4, 0x6000000
    s_add_u32 s8, s6, s4
    s_addc_u32 s9, s7, 0
    s_and_b32 s9, s9, 0xffff
    s_mov_b32 s10, 0
    s_mov_b32 s58, 0
    s_mov_b32 s14, 0x700000
    s_mov_b32 s59, 0x700000
    s_lshl_b32 s54, s62, 12
    s_waitcnt vmcnt(16) lgkmcnt(0)
    s_barrier
    s_cmp_eq_u32 s63, 0
    s_cbranch_scc1 k12_ool_74
k12_oolret_75:
    v_mov_b32 v59, 0
    ds_read_b128 a[128:131], v2 offset:0
    ds_read_b128 a[132:135], v2 offset:1024
    ds_read_b128 a[136:139], v2 offset:2048
    ds_read_b128 a[140:143], v2 offset:3072
    ds_read_b128 a[144:147], v2 offset:4096
    ds_read_b128 a[148:151], v2 offset:5120
    ds_read_b128 a[152:155], v2 offset:6144
    ds_read_b128 a[156:159], v2 offset:7168
    ds_read_b128 a[160:163], v2 offset:8192
    ds_read_b128 a[164:167], v2 offset:9216
    ds_read_b128 a[168:171], v2 offset:10240
    ds_read_b128 a[172:175], v2 offset:11264
    ds_read_b128 a[176:179], v2 offset:12288
    ds_read_b128 a[180:183], v2 offset:13312
    ds_read_b128 a[184:187], v2 offset:14336
    ds_read_b128 a[188:191], v2 offset:15360
    s_cmp_lt_u32 s30, 2
    s_cselect_b64 s[12:13], s[46:47], s[48:49]
    s_cselect_b64 s[60:61], s[44:45], s[50:51]
    s_cselect_b32 s55, 0x800000, s14
    s_and_b32 s13, s13, 0xffff
    v_accvgpr_read_b32 v128, a64
    v_accvgpr_read_b32 v129, a65
    v_accvgpr_read_b32 v130, a66
    v_accvgpr_read_b32 v131, a67
    v_pk_mul_f32 v[128:129], v[128:129], s[40:41]
    v_pk_mul_f32 v[130:131], v[130:131], s[40:41]
    v_cvt_pk_bf16_f32 v96, v128, v129
    v_cvt_pk_bf16_f32 v97, v130, v131
    v_accvgpr_read_b32 v132, a72
    v_accvgpr_read_b32 v133, a73
    v_accvgpr_read_b32 v134, a74
    v_accvgpr_read_b32 v135, a75
    v_pk_mul_f32 v[132:133], v[132:133], s[40:41]
    v_pk_mul_f32 v[134:135], v[134:135], s[40:41]
    v_cvt_pk_bf16_f32 v98, v132, v133
    v_cvt_pk_bf16_f32 v99, v134, v135
    v_accvgpr_read_b32 v136, a80
    v_accvgpr_read_b32 v137, a81
    v_accvgpr_read_b32 v138, a82
    v_accvgpr_read_b32 v139, a83
    v_pk_mul_f32 v[136:137], v[136:137], s[40:41]
    v_pk_mul_f32 v[138:139], v[138:139], s[40:41]
    v_cvt_pk_bf16_f32 v100, v136, v137
    v_cvt_pk_bf16_f32 v101, v138, v139
    v_accvgpr_read_b32 v140, a88
    v_accvgpr_read_b32 v141, a89
    v_accvgpr_read_b32 v142, a90
    v_accvgpr_read_b32 v143, a91
    v_pk_mul_f32 v[140:141], v[140:141], s[40:41]
    v_pk_mul_f32 v[142:143], v[142:143], s[40:41]
    v_cvt_pk_bf16_f32 v102, v140, v141
    v_cvt_pk_bf16_f32 v103, v142, v143
    v_accvgpr_read_b32 v128, a96
    v_accvgpr_read_b32 v129, a97
    v_accvgpr_read_b32 v130, a98
    v_accvgpr_read_b32 v131, a99
    v_pk_mul_f32 v[128:129], v[128:129], s[40:41]
    v_pk_mul_f32 v[130:131], v[130:131], s[40:41]
    v_cvt_pk_bf16_f32 v104, v128, v129
    v_cvt_pk_bf16_f32 v105, v130, v131
    v_accvgpr_read_b32 v132, a104
    v_accvgpr_read_b32 v133, a105
    v_accvgpr_read_b32 v134, a106
    v_accvgpr_read_b32 v135, a107
    v_pk_mul_f32 v[132:133], v[132:133], s[40:41]
    v_pk_mul_f32 v[134:135], v[134:135], s[40:41]
    v_cvt_pk_bf16_f32 v106, v132, v133
    v_cvt_pk_bf16_f32 v107, v134, v135
    v_accvgpr_read_b32 v136, a112
    v_accvgpr_read_b32 v137, a113
    v_accvgpr_read_b32 v138, a114
    v_accvgpr_read_b32 v139, a115
    v_pk_mul_f32 v[136:137], v[136:137], s[40:41]
    v_pk_mul_f32 v[138:139], v[138:139], s[40:41]
    v_cvt_pk_bf16_f32 v108, v136, v137
    v_cvt_pk_bf16_f32 v109, v138, v139
    v_accvgpr_read_b32 v140, a120
    v_accvgpr_read_b32 v141, a121
    v_accvgpr_read_b32 v142, a122
    v_accvgpr_read_b32 v143, a123
    v_pk_mul_f32 v[140:141], v[140:141], s[40:41]
    v_pk_mul_f32 v[142:143], v[142:143], s[40:41]
    v_cvt_pk_bf16_f32 v110, v140, v141
    v_cvt_pk_bf16_f32 v111, v142, v143
    v_accvgpr_read_b32 v128, a68
    v_accvgpr_read_b32 v129, a69
    v_accvgpr_read_b32 v130, a70
    v_accvgpr_read_b32 v131, a71
    v_pk_mul_f32 v[128:129], v[128:129], s[40:41]
    v_pk_mul_f32 v[130:131], v[130:131], s[40:41]
    v_cvt_pk_bf16_f32 v112, v128, v129
    v_cvt_pk_bf16_f32 v113, v130, v131
    v_accvgpr_read_b32 v132, a76
    v_accvgpr_read_b32 v133, a77
    v_accvgpr_read_b32 v134, a78
    v_accvgpr_read_b32 v135, a79
    v_pk_mul_f32 v[132:133], v[132:133], s[40:41]
    v_pk_mul_f32 v[134:135], v[134:135], s[40:41]
    v_cvt_pk_bf16_f32 v114, v132, v133
    v_cvt_pk_bf16_f32 v115, v134, v135
    v_accvgpr_read_b32 v136, a84
    v_accvgpr_read_b32 v137, a85
    v_accvgpr_read_b32 v138, a86
    v_accvgpr_read_b32 v139, a87
    v_pk_mul_f32 v[136:137], v[136:137], s[40:41]
    v_pk_mul_f32 v[138:139], v[138:139], s[40:41]
    v_cvt_pk_bf16_f32 v116, v136, v137
    v_cvt_pk_bf16_f32 v117, v138, v139
    v_accvgpr_read_b32 v140, a92
    v_accvgpr_read_b32 v141, a93
    v_accvgpr_read_b32 v142, a94
    v_accvgpr_read_b32 v143, a95
    v_pk_mul_f32 v[140:141], v[140:141], s[40:41]
    v_pk_mul_f32 v[142:143], v[142:143], s[40:41]
    v_cvt_pk_bf16_f32 v118, v140, v141
    v_cvt_pk_bf16_f32 v119, v142, v143
    v_accvgpr_read_b32 v128, a100
    v_accvgpr_read_b32 v129, a101
    v_accvgpr_read_b32 v130, a102
    v_accvgpr_read_b32 v131, a103
    v_pk_mul_f32 v[128:129], v[128:129], s[40:41]
    v_pk_mul_f32 v[130:131], v[130:131], s[40:41]
    v_cvt_pk_bf16_f32 v120, v128, v129
    v_cvt_pk_bf16_f32 v121, v130, v131
    v_accvgpr_read_b32 v132, a108
    v_accvgpr_read_b32 v133, a109
    v_accvgpr_read_b32 v134, a110
    v_accvgpr_read_b32 v135, a111
    v_pk_mul_f32 v[132:133], v[132:133], s[40:41]
    v_pk_mul_f32 v[134:135], v[134:135], s[40:41]
    v_cvt_pk_bf16_f32 v122, v132, v133
    v_cvt_pk_bf16_f32 v123, v134, v135
    v_accvgpr_read_b32 v136, a116
    v_accvgpr_read_b32 v137, a117
    v_accvgpr_read_b32 v138, a118
    v_accvgpr_read_b32 v139, a119
    v_pk_mul_f32 v[136:137], v[136:137], s[40:41]
    v_pk_mul_f32 v[138:139], v[138:139], s[40:41]
    v_cvt_pk_bf16_f32 v124, v136, v137
    v_cvt_pk_bf16_f32 v125, v138, v139
    v_accvgpr_read_b32 v140, a124
    v_accvgpr_read_b32 v141, a125
    v_accvgpr_read_b32 v142, a126
    v_accvgpr_read_b32 v143, a127
    v_pk_mul_f32 v[140:141], v[140:141], s[40:41]
    v_pk_mul_f32 v[142:143], v[142:143], s[40:41]
    v_cvt_pk_bf16_f32 v126, v140, v141
    v_cvt_pk_bf16_f32 v127, v142, v143
    v_pk_mul_f32 v[192:193], v[192:193], s[40:41]
    v_pk_mul_f32 v[194:195], v[194:195], s[40:41]
    v_cvt_pk_bf16_f32 v64, v192, v193
    v_cvt_pk_bf16_f32 v65, v194, v195
    v_pk_mul_f32 v[200:201], v[200:201], s[40:41]
    v_pk_mul_f32 v[202:203], v[202:203], s[40:41]
    v_cvt_pk_bf16_f32 v66, v200, v201
    v_cvt_pk_bf16_f32 v67, v202, v203
    v_pk_mul_f32 v[208:209], v[208:209], s[40:41]
    v_pk_mul_f32 v[210:211], v[210:211], s[40:41]
    v_cvt_pk_bf16_f32 v68, v208, v209
    v_cvt_pk_bf16_f32 v69, v210, v211
    v_pk_mul_f32 v[216:217], v[216:217], s[40:41]
    v_pk_mul_f32 v[218:219], v[218:219], s[40:41]
    v_cvt_pk_bf16_f32 v70, v216, v217
    v_cvt_pk_bf16_f32 v71, v218, v219
    v_pk_mul_f32 v[224:225], v[224:225], s[40:41]
    v_pk_mul_f32 v[226:227], v[226:227], s[40:41]
    v_cvt_pk_bf16_f32 v72, v224, v225
    v_cvt_pk_bf16_f32 v73, v226, v227
    v_pk_mul_f32 v[232:233], v[232:233], s[40:41]
    v_pk_mul_f32 v[234:235], v[234:235], s[40:41]
    v_cvt_pk_bf16_f32 v74, v232, v233
    v_cvt_pk_bf16_f32 v75, v234, v235
    v_pk_mul_f32 v[240:241], v[240:241], s[40:41]
    v_pk_mul_f32 v[242:243], v[242:243], s[40:41]
    v_cvt_pk_bf16_f32 v76, v240, v241
    v_cvt_pk_bf16_f32 v77, v242, v243
    v_pk_mul_f32 v[248:249], v[248:249], s[40:41]
    v_pk_mul_f32 v[250:251], v[250:251], s[40:41]
    v_cvt_pk_bf16_f32 v78, v248, v249
    v_cvt_pk_bf16_f32 v79, v250, v251
    v_pk_mul_f32 v[196:197], v[196:197], s[40:41]
    v_pk_mul_f32 v[198:199], v[198:199], s[40:41]
    v_cvt_pk_bf16_f32 v80, v196, v197
    v_cvt_pk_bf16_f32 v81, v198, v199
    v_pk_mul_f32 v[204:205], v[204:205], s[40:41]
    v_pk_mul_f32 v[206:207], v[206:207], s[40:41]
    v_cvt_pk_bf16_f32 v82, v204, v205
    v_cvt_pk_bf16_f32 v83, v206, v207
    v_pk_mul_f32 v[212:213], v[212:213], s[40:41]
    v_pk_mul_f32 v[214:215], v[214:215], s[40:41]
    v_cvt_pk_bf16_f32 v84, v212, v213
    v_cvt_pk_bf16_f32 v85, v214, v215
    v_pk_mul_f32 v[220:221], v[220:221], s[40:41]
    v_pk_mul_f32 v[222:223], v[222:223], s[40:41]
    v_cvt_pk_bf16_f32 v86, v220, v221
    v_cvt_pk_bf16_f32 v87, v222, v223
    v_pk_mul_f32 v[228:229], v[228:229], s[40:41]
    v_pk_mul_f32 v[230:231], v[230:231], s[40:41]
    v_cvt_pk_bf16_f32 v88, v228, v229
    v_cvt_pk_bf16_f32 v89, v230, v231
    v_pk_mul_f32 v[236:237], v[236:237], s[40:41]
    v_pk_mul_f32 v[238:239], v[238:239], s[40:41]
    v_cvt_pk_bf16_f32 v90, v236, v237
    v_cvt_pk_bf16_f32 v91, v238, v239
    v_pk_mul_f32 v[244:245], v[244:245], s[40:41]
    v_pk_mul_f32 v[246:247], v[246:247], s[40:41]
    v_cvt_pk_bf16_f32 v92, v244, v245
    v_cvt_pk_bf16_f32 v93, v246, v247
    v_pk_mul_f32 v[252:253], v[252:253], s[40:41]
    v_pk_mul_f32 v[254:255], v[254:255], s[40:41]
    v_cvt_pk_bf16_f32 v94, v252, v253
    v_cvt_pk_bf16_f32 v95, v254, v255
    v_add_u32 v2, 0x4000, v1
    v_mov_b32 v8, 0
    v_mov_b32 v232, 0
    v_mov_b32 v9, 0
    v_mov_b32 v233, 0
    v_mov_b32 v10, 0
    v_mov_b32 v234, 0
    v_mov_b32 v11, 0
    v_mov_b32 v235, 0
    s_mov_b32 s36, 0
    s_mov_b32 s37, 0x40004000
    v_mfma_f32_32x32x16_bf16 v[16:31], v[232:235], v[232:235], 0
    v_mfma_f32_32x32x16_bf16 v[32:47], v[232:235], v[232:235], 0
    v_and_b32 v6, 0xf0, v1
    v_cmp_eq_u32 vcc, 0, v6
    v_mov_b32 v6, 0x3f803f80
    v_lshrrev_b32 v229, 7, v1
    s_and_b32 s4, s30, 1
    s_lshl_b32 s31, s4, 11
    v_lshl_add_u32 v230, v1, 1, s31
    v_lshl_add_u32 v229, s4, 4, v229
    v_mul_u32_u24 v228, 7168, v229
    v_and_b32 v7, 0x70, v1
    v_add_u32 v228, v228, v7
    v_lshlrev_b32 v229, 5, v229
    v_and_b32 v57, 0x10, v1
    v_add_u32 v229, v229, v57
    v_lshrrev_b32 v7, 5, v7
    v_lshl_add_u32 v229, v7, 15, v229
    v_cndmask_b32 v60, 0, v6, vcc
    v_cndmask_b32 v61, 0, v6, vcc
    v_cndmask_b32 v62, 0, v6, vcc
    v_cndmask_b32 v63, 0, v6, vcc
    v_mov_b32 v12, 0
    v_mov_b32 v13, 0
    v_mov_b32 v14, 0
    v_mov_b32 v15, 0
    v_mov_b32 v48, 0
    v_mov_b32 v49, 0
    v_mov_b32 v50, 0
    v_mov_b32 v51, 0
    v_mov_b32 v248, 0
    v_mov_b32 v249, 0
    v_mov_b32 v250, 0
    v_mov_b32 v251, 0
    v_mov_b32 v252, 0
    v_mov_b32 v253, 0
    v_mov_b32 v254, 0
    v_mov_b32 v255, 0
    s_waitcnt lgkmcnt(0)
    s_cmp_ge_u32 s36, s42
    s_cbranch_scc1 k2_prep_76
k2_prepret_77:
    v_mfma_f32_16x16x32_bf16 v[128:131], a[128:131], v[64:67], v[16:19]
    v_mfma_f32_16x16x32_bf16 v[128:131], a[132:135], v[68:71], v[128:131]
    v_mfma_f32_16x16x32_bf16 v[128:131], a[136:139], v[72:75], v[128:131]
    v_mfma_f32_16x16x32_bf16 v[128:131], a[140:143], v[76:79], v[128:131]
    s_add_u32 s36, s36, 32
    v_mfma_f32_16x16x32_bf16 v[132:135], a[128:131], v[80:83], v[20:23]
    v_mfma_f32_16x16x32_bf16 v[132:135], a[132:135], v[84:87], v[132:135]
    v_mfma_f32_16x16x32_bf16 v[132:135], a[136:139], v[88:91], v[132:135]
    v_mfma_f32_16x16x32_bf16 v[132:135], a[140:143], v[92:95], v[132:135]
    v_mfma_f32_16x16x32_bf16 v[136:139], a[128:131], v[96:99], v[24:27]
    v_mfma_f32_16x16x32_bf16 v[136:139], a[132:135], v[100:103], v[136:139]
    v_mfma_f32_16x16x32_bf16 v[136:139], a[136:139], v[104:107], v[136:139]
    v_mfma_f32_16x16x32_bf16 v[136:139], a[140:143], v[108:111], v[136:139]
    v_mfma_f32_16x16x32_bf16 v[140:143], a[128:131], v[112:115], v[28:31]
    v_mfma_f32_16x16x32_bf16 v[140:143], a[132:135], v[116:119], v[140:143]
    v_mfma_f32_16x16x32_bf16 v[140:143], a[136:139], v[120:123], v[140:143]
    v_mfma_f32_16x16x32_bf16 v[140:143], a[140:143], v[124:127], v[140:143]
    v_mfma_f32_16x16x32_bf16 v[144:147], a[144:147], v[64:67], v[32:35]
    v_mfma_f32_16x16x32_bf16 v[144:147], a[148:151], v[68:71], v[144:147]
    v_mfma_f32_16x16x32_bf16 v[144:147], a[152:155], v[72:75], v[144:147]
    v_mfma_f32_16x16x32_bf16 v[144:147], a[156:159], v[76:79], v[144:147]
    v_mfma_f32_16x16x32_bf16 v[148:151], a[144:147], v[80:83], v[36:39]
    v_mfma_f32_16x16x32_bf16 v[148:151], a[148:151], v[84:87], v[148:151]
    v_mfma_f32_16x16x32_bf16 v[148:151], a[152:155], v[88:91], v[148:151]
    v_mfma_f32_16x16x32_bf16 v[148:151], a[156:159], v[92:95], v[148:151]
    v_mfma_f32_16x16x32_bf16 v[152:155], a[144:147], v[96:99], v[40:43]
    v_mfma_f32_16x16x32_bf16 v[152:155], a[148:151], v[100:103], v[152:155]
    v_mfma_f32_16x16x32_bf16 v[152:155], a[152:155], v[104:107], v[152:155]
    v_mfma_f32_16x16x32_bf16 v[152:155], a[156:159], v[108:111], v[152:155]
    v_mfma_f32_16x16x32_bf16 v[156:159], a[144:147], v[112:115], v[44:47]
    v_mfma_f32_16x16x32_bf16 v[156:159], a[148:151], v[116:119], v[156:159]
    v_mfma_f32_16x16x32_bf16 v[156:159], a[152:155], v[120:123], v[156:159]
    v_mfma_f32_16x16x32_bf16 v[156:159], a[156:159], v[124:127], v[156:159]
    v_mfma_f32_32x32x16_bf16 a[0:15], v[232:235], v[232:235], 0
    v_mfma_f32_32x32x16_bf16 a[16:31], v[232:235], v[232:235], 0
    v_mfma_f32_32x32x16_bf16 a[32:47], v[232:235], v[232:235], 0
    v_mfma_f32_32x32x16_bf16 a[48:63], v[232:235], v[232:235], 0
    v_mfma_f32_32x32x16_bf16 a[64:79], v[232:235], v[232:235], 0
    v_mfma_f32_32x32x16_bf16 a[80:95], v[232:235], v[232:235], 0
    v_mfma_f32_32x32x16_bf16 a[96:111], v[232:235], v[232:235], 0
    v_mfma_f32_32x32x16_bf16 a[112:127], v[232:235], v[232:235], 0
    v_max_f32 v52, v128, v129
    v_max3_f32 v52, v52, v130, v131
    v_max3_f32 v52, v52, v144, v145
    v_max3_f32 v52, v52, v146, v147
    v_max_f32 v53, v132, v133
    v_max3_f32 v53, v53, v134, v135
    v_max3_f32 v53, v53, v148, v149
    v_max3_f32 v53, v53, v150, v151
    v_max_f32 v54, v136, v137
    v_max3_f32 v54, v54, v138, v139
    v_max3_f32 v54, v54, v152, v153
    v_max3_f32 v54, v54, v154, v155
    v_max_f32 v55, v140, v141
    v_max3_f32 v55, v55, v142, v143
    v_max3_f32 v55, v55, v156, v157
    v_max3_f32 v55, v55, v158, v159
    v_mov_b32 v224, v52
    v_mov_b32 v225, v53
    v_mov_b32 v226, v54
    v_mov_b32 v227, v55
    s_nop 1
    v_permlane16_swap_b32 v52, v224
    v_permlane16_swap_b32 v53, v225
    v_permlane16_swap_b32 v54, v226
    v_permlane16_swap_b32 v55, v227
    s_nop 1
    v_max_f32 v52, v52, v224
    v_max_f32 v53, v53, v225
    v_max_f32 v54, v54, v226
    v_max_f32 v55, v55, v227
    v_mov_b32 v224, v52
    v_mov_b32 v225, v53
    v_mov_b32 v226, v54
    v_mov_b32 v227, v55
    s_nop 1
    v_permlane32_swap_b32 v52, v224
    v_permlane32_swap_b32 v53, v225
    v_permlane32_swap_b32 v54, v226
    v_permlane32_swap_b32 v55, v227
    s_nop 1
    v_max_f32 v52, v52, v224
    v_max_f32 v53, v53, v225
    v_max_f32 v54, v54, v226
    v_max_f32 v55, v55, v227
    v_add_f32 v52, 0x41400000, v52
    v_add_f32 v53, 0x41400000, v53
    v_add_f32 v54, 0x41400000, v54
    v_add_f32 v55, 0x41400000, v55
    v_sub_f32 v16, 0, v52
    v_sub_f32 v17, 0, v52
    v_sub_f32 v18, 0, v52
    v_sub_f32 v19, 0, v52
    v_sub_f32 v20, 0, v53
    v_sub_f32 v21, 0, v53
    v_sub_f32 v22, 0, v53
    v_sub_f32 v23, 0, v53
    v_sub_f32 v24, 0, v54
    v_sub_f32 v25, 0, v54
    v_sub_f32 v26, 0, v54
    v_sub_f32 v27, 0, v54
    v_sub_f32 v28, 0, v55
    v_sub_f32 v29, 0, v55
    v_sub_f32 v30, 0, v55
    v_sub_f32 v31, 0, v55
    v_sub_f32 v32, 0, v52
    v_sub_f32 v33, 0, v52
    v_sub_f32 v34, 0, v52
    v_sub_f32 v35, 0, v52
    v_sub_f32 v36, 0, v53
    v_sub_f32 v37, 0, v53
    v_sub_f32 v38, 0, v53
    v_sub_f32 v39, 0, v53
    v_sub_f32 v40, 0, v54
    v_sub_f32 v41, 0, v54
    v_sub_f32 v42, 0, v54
    v_sub_f32 v43, 0, v54
    v_sub_f32 v44, 0, v55
    v_sub_f32 v45, 0, v55
    v_sub_f32 v46, 0, v55
    v_sub_f32 v47, 0, v55
    v_sub_f32 v8, 0, v52
    v_sub_f32 v9, 0, v53
    v_sub_f32 v10, 0, v54
    v_sub_f32 v11, 0, v55
    s_cmp_ge_u32 s36, s42
    s_cbranch_scc1 k2_prep_84
k2_prepret_85:
    v_mfma_f32_16x16x32_bf16 v[160:163], a[160:163], v[64:67], v[16:19]
    v_sub_f32 v128, v128, v52
    v_sub_f32 v129, v129, v52
    v_sub_f32 v130, v130, v52
    v_mfma_f32_16x16x32_bf16 v[160:163], a[164:167], v[68:71], v[160:163]
    v_exp_f32 v232, v128
    v_sub_f32 v131, v131, v52
    v_mfma_f32_16x16x32_bf16 v[160:163], a[168:171], v[72:75], v[160:163]
    v_exp_f32 v233, v129
    v_sub_f32 v144, v144, v52
    v_mfma_f32_16x16x32_bf16 v[160:163], a[172:175], v[76:79], v[160:163]
    s_add_u32 s36, s36, 32
    s_cmp_eq_u32 s30, 0
    s_cbranch_scc1 k12_ool_78
k12_oolret_79:
    v_sub_f32 v145, v145, v52
    v_mfma_f32_16x16x32_bf16 v[164:167], a[160:163], v[80:83], v[20:23]
    v_exp_f32 v234, v130
    v_cvt_pk_bf16_f32 v192, v232, v233
    v_mfma_f32_16x16x32_bf16 v[164:167], a[164:167], v[84:87], v[164:167]
    v_exp_f32 v235, v131
    v_sub_f32 v146, v146, v52
    v_mfma_f32_16x16x32_bf16 v[164:167], a[168:171], v[88:91], v[164:167]
    v_exp_f32 v236, v144
    v_sub_f32 v147, v147, v52
    v_mfma_f32_16x16x32_bf16 v[164:167], a[172:175], v[92:95], v[164:167]
    v_cvt_pk_bf16_f32 v193, v234, v235
    v_exp_f32 v237, v145
    v_mfma_f32_16x16x32_bf16 v[168:171], a[160:163], v[96:99], v[24:27]
    v_exp_f32 v238, v146
    v_sub_f32 v132, v132, v53
    v_mfma_f32_16x16x32_bf16 v[168:171], a[164:167], v[100:103], v[168:171]
    v_sub_f32 v133, v133, v53
    v_cvt_pk_bf16_f32 v194, v236, v237
    v_or3_b32 v57, v192, v193, v194
    v_mfma_f32_16x16x32_bf16 v[168:171], a[168:171], v[104:107], v[168:171]
    v_exp_f32 v239, v147
    v_sub_f32 v134, v134, v53
    v_mfma_f32_16x16x32_bf16 v[168:171], a[172:175], v[108:111], v[168:171]
    v_exp_f32 v240, v132
    v_sub_f32 v135, v135, v53
    v_mfma_f32_16x16x32_bf16 v[172:175], a[160:163], v[112:115], v[28:31]
    v_cvt_pk_bf16_f32 v195, v238, v239
    v_exp_f32 v241, v133
    v_mfma_f32_16x16x32_bf16 v[172:175], a[164:167], v[116:119], v[172:175]
    v_exp_f32 v242, v134
    v_sub_f32 v148, v148, v53
    v_mfma_f32_16x16x32_bf16 v[172:175], a[168:171], v[120:123], v[172:175]
    v_sub_f32 v149, v149, v53
    v_cvt_pk_bf16_f32 v196, v240, v241
    v_exp_f32 v243, v135
    v_mfma_f32_16x16x32_bf16 v[172:175], a[172:175], v[124:127], v[172:175]
    v_or3_b32 v57, v57, v195, v196
    v_exp_f32 v244, v148
    v_mfma_f32_16x16x32_bf16 v[176:179], a[176:179], v[64:67], v[32:35]
    v_sub_f32 v150, v150, v53
    v_sub_f32 v151, v151, v53
    v_cvt_pk_bf16_f32 v197, v242, v243
    v_mfma_f32_16x16x32_bf16 v[176:179], a[180:183], v[68:71], v[176:179]
    v_exp_f32 v245, v149
    v_exp_f32 v246, v150
    v_mfma_f32_16x16x32_bf16 v[176:179], a[184:187], v[72:75], v[176:179]
    v_sub_f32 v136, v136, v54
    v_sub_f32 v137, v137, v54
    v_cvt_pk_bf16_f32 v198, v244, v245
    v_mfma_f32_16x16x32_bf16 v[176:179], a[188:191], v[76:79], v[176:179]
    v_exp_f32 v247, v151
    v_or3_b32 v57, v57, v197, v198
    v_mfma_f32_16x16x32_bf16 v[180:183], a[176:179], v[80:83], v[36:39]
    v_exp_f32 v232, v136
    v_sub_f32 v138, v138, v54
    v_mfma_f32_16x16x32_bf16 v[180:183], a[180:183], v[84:87], v[180:183]
    ds_read_b128 a[192:195], v3 offset:0
    v_sub_f32 v139, v139, v54
    v_cvt_pk_bf16_f32 v199, v246, v247
    v_mfma_f32_16x16x32_bf16 v[180:183], a[184:187], v[88:91], v[180:183]
    v_exp_f32 v233, v137
    v_exp_f32 v234, v138
    v_mfma_f32_16x16x32_bf16 v[180:183], a[188:191], v[92:95], v[180:183]
    v_sub_f32 v152, v152, v54
    v_sub_f32 v153, v153, v54
    v_cvt_pk_bf16_f32 v200, v232, v233
    v_mfma_f32_16x16x32_bf16 v[184:187], a[176:179], v[96:99], v[40:43]
    v_exp_f32 v235, v139
    v_or3_b32 v57, v57, v199, v200
    v_mfma_f32_16x16x32_bf16 v[184:187], a[180:183], v[100:103], v[184:187]
    v_exp_f32 v236, v152
    v_sub_f32 v154, v154, v54
    v_mfma_f32_16x16x32_bf16 v[184:187], a[184:187], v[104:107], v[184:187]
    v_sub_f32 v155, v155, v54
    v_cvt_pk_bf16_f32 v201, v234, v235
    v_exp_f32 v237, v153
    v_mfma_f32_16x16x32_bf16 v[184:187], a[188:191], v[108:111], v[184:187]
    ds_read_b128 a[196:199], v3 offset:1024
    v_exp_f32 v238, v154
    v_mfma_f32_16x16x32_bf16 v[188:191], a[176:179], v[112:115], v[44:47]
    v_sub_f32 v140, v140, v55
    v_sub_f32 v141, v141, v55
    v_cvt_pk_bf16_f32 v202, v236, v237
    v_mfma_f32_16x16x32_bf16 v[188:191], a[180:183], v[116:119], v[188:191]
    v_exp_f32 v239, v155
    v_or3_b32 v57, v57, v201, v202
    v_mfma_f32_16x16x32_bf16 v[188:191], a[184:187], v[120:123], v[188:191]
    s_cmp_eq_u32 s30, 0
    s_cbranch_scc1 k12_ool_82
k12_oolret_83:
    v_exp_f32 v240, v140
    v_mfma_f32_16x16x32_bf16 v[188:191], a[188:191], v[124:127], v[188:191]
    s_waitcnt vmcnt(8)
    s_barrier
    v_sub_f32 v142, v142, v55
    v_sub_f32 v143, v143, v55
    v_cvt_pk_bf16_f32 v203, v238, v239
    v_exp_f32 v241, v141
    v_exp_f32 v242, v142
    v_sub_f32 v156, v156, v55
    v_sub_f32 v157, v157, v55
    ds_read_b128 a[200:203], v3 offset:2048
    v_cvt_pk_bf16_f32 v204, v240, v241
    v_exp_f32 v243, v143
    v_or3_b32 v57, v57, v203, v204
    v_exp_f32 v244, v156
    v_sub_f32 v158, v158, v55
    v_sub_f32 v159, v159, v55
    v_cvt_pk_bf16_f32 v205, v242, v243
    v_exp_f32 v245, v157
    v_exp_f32 v246, v158
    v_cvt_pk_bf16_f32 v206, v244, v245
    ds_read_b128 a[204:207], v3 offset:3072
    v_exp_f32 v247, v159
    v_or3_b32 v57, v57, v205, v206
    v_cvt_pk_bf16_f32 v207, v246, v247
    v_bitop3_b32 v57, v57, v207, s37 bitop3:0xa8
    v_cmp_ne_u32 vcc, 0, v57
    s_cbranch_vccnz k2_tramp_86
k2_ret_87:
    s_mov_b32 s24, s60
    s_and_b32 s25, s61, 0xffff
    s_mov_b32 s26, s55
    s_lshl_b32 s63, s29, 1
    s_sub_u32 s63, s63, 1
    s_cbranch_scc1 k2_dm3_89
k2_dloop_88:
    v_mfma_f32_16x16x32_bf16 v[12:15], v[60:63], v[192:195], v[12:15]
    v_exp_f32 v232, v160
    v_mfma_f32_16x16x32_bf16 v[48:51], v[60:63], v[196:199], v[48:51]
    s_mov_b32 m0, s34
    ds_read_b128 a[208:211], v3 offset:4096
    v_mfma_f32_16x16x32_bf16 v[248:251], v[60:63], v[200:203], v[248:251]
    s_add_u32 s53, s53, 8192
    buffer_load_dwordx4 v1, s[16:19], s32 offen offset:0 sc1 lds
    v_mfma_f32_16x16x32_bf16 v[252:255], v[60:63], v[204:207], v[252:255]
    s_waitcnt lgkmcnt(3)
    v_exp_f32 v233, v161
    v_mfma_f32_16x16x32_bf16 a[0:3], a[192:195], v[192:195], a[0:3]
    s_and_b32 s53, s53, 0xffff
    v_exp_f32 v234, v162
    v_mfma_f32_16x16x32_bf16 a[4:7], a[192:195], v[196:199], a[4:7]
    s_add_u32 s34, s34, 0x4000
    ds_read_b128 a[212:215], v3 offset:5120
    v_cvt_pk_bf16_f32 v208, v232, v233
    v_mfma_f32_16x16x32_bf16 a[8:11], a[192:195], v[200:203], a[8:11]
    v_exp_f32 v235, v163
    v_mfma_f32_16x16x32_bf16 a[12:15], a[192:195], v[204:207], a[12:15]
    buffer_load_dwordx4 v1, s[16:19], s32 offen offset:1024 sc1 lds
    v_mfma_f32_16x16x32_bf16 a[16:19], a[196:199], v[192:195], a[16:19]
    v_exp_f32 v236, v176
    v_mfma_f32_16x16x32_bf16 a[20:23], a[196:199], v[196:199], a[20:23]
    ds_read_b128 a[216:219], v3 offset:6144
    v_cvt_pk_bf16_f32 v209, v234, v235
    v_mfma_f32_16x16x32_bf16 a[24:27], a[196:199], v[200:203], a[24:27]
    v_exp_f32 v237, v177
    v_mfma_f32_16x16x32_bf16 a[28:31], a[196:199], v[204:207], a[28:31]
    s_waitcnt lgkmcnt(3)
    v_exp_f32 v238, v178
    v_mfma_f32_16x16x32_bf16 a[32:35], a[200:203], v[192:195], a[32:35]
    s_and_b32 s34, s34, 0xffff
    ds_read_b128 a[220:223], v3 offset:7168
    v_cvt_pk_bf16_f32 v210, v236, v237
    v_mfma_f32_16x16x32_bf16 a[36:39], a[200:203], v[196:199], a[36:39]
    s_and_b32 s60, s62, 31
    buffer_load_dwordx4 v1, s[16:19], s32 offen offset:2048 sc1 lds
    v_mfma_f32_16x16x32_bf16 a[40:43], a[200:203], v[200:203], a[40:43]
    v_exp_f32 v239, v179
    v_mfma_f32_16x16x32_bf16 a[44:47], a[200:203], v[204:207], a[44:47]
    s_lshr_b32 s61, s62, 5
    v_or3_b32 v57, v208, v209, v210
    v_add_u32 v3, s53, v56
    v_mfma_f32_16x16x32_bf16 a[48:51], a[204:207], v[192:195], a[48:51]
    v_exp_f32 v240, v164
    v_mfma_f32_16x16x32_bf16 a[52:55], a[204:207], v[196:199], a[52:55]
    ds_read_b128 a[128:131], v2 offset:0
    v_cvt_pk_bf16_f32 v211, v238, v239
    v_mfma_f32_16x16x32_bf16 a[56:59], a[204:207], v[200:203], a[56:59]
    s_mul_i32 s57, s60, 229376
    v_exp_f32 v241, v165
    v_mfma_f32_16x16x32_bf16 a[60:63], a[204:207], v[204:207], a[60:63]
    s_waitcnt lgkmcnt(3)
    buffer_load_dwordx4 v1, s[16:19], s32 offen offset:3072 sc1 lds
    v_mfma_f32_16x16x32_bf16 a[64:67], a[208:211], v[192:195], a[64:67]
    s_add_u32 s32, s32, 0x80000
    v_exp_f32 v242, v166
    v_mfma_f32_16x16x32_bf16 a[68:71], a[208:211], v[196:199], a[68:71]
    s_lshl_b32 s4, s61, 7
    ds_read_b128 a[132:135], v2 offset:1024
    v_cvt_pk_bf16_f32 v212, v240, v241
    v_mfma_f32_16x16x32_bf16 a[72:75], a[208:211], v[200:203], a[72:75]
    v_exp_f32 v243, v167
    v_mfma_f32_16x16x32_bf16 a[76:79], a[208:211], v[204:207], a[76:79]
    s_add_u32 s57, s57, s4
    v_or3_b32 v57, v57, v211, v212
    v_cvt_pk_bf16_f32 v213, v242, v243
    v_mfma_f32_16x16x32_bf16 a[80:83], a[212:215], v[192:195], a[80:83]
    s_waitcnt vmcnt(8)
    v_exp_f32 v244, v180
    v_mfma_f32_16x16x32_bf16 a[84:87], a[212:215], v[196:199], a[84:87]
    buffer_store_dwordx4 a[224:227], v229, s[8:11], s58 offen offset:0 sc1
    ds_read_b128 a[136:139], v2 offset:2048
    v_mfma_f32_16x16x32_bf16 a[88:91], a[212:215], v[200:203], a[88:91]
    s_add_u32 s56, s57, 57344
    v_exp_f32 v245, v181
    v_mfma_f32_16x16x32_bf16 a[92:95], a[212:215], v[204:207], a[92:95]
    s_waitcnt lgkmcnt(3)
    v_exp_f32 v246, v182
    v_mfma_f32_16x16x32_bf16 a[96:99], a[216:219], v[192:195], a[96:99]
    ds_read_b128 a[140:143], v2 offset:3072
    v_cvt_pk_bf16_f32 v214, v244, v245
    v_mfma_f32_16x16x32_bf16 a[100:103], a[216:219], v[196:199], a[100:103]
    s_add_u32 s62, s62, 1
    v_exp_f32 v247, v183
    v_mfma_f32_16x16x32_bf16 a[104:107], a[216:219], v[200:203], a[104:107]
    v_or3_b32 v57, v57, v213, v214
    v_mfma_f32_16x16x32_bf16 a[108:111], a[216:219], v[204:207], a[108:111]
    v_exp_f32 v232, v168
    v_mfma_f32_16x16x32_bf16 a[112:115], a[220:223], v[192:195], a[112:115]
    ds_read_b128 a[144:147], v2 offset:4096
    v_cvt_pk_bf16_f32 v215, v246, v247
    v_mfma_f32_16x16x32_bf16 a[116:119], a[220:223], v[196:199], a[116:119]
    buffer_store_dwordx4 a[228:231], v229, s[8:11], s58 offen offset:256 sc1
    v_mfma_f32_16x16x32_bf16 a[120:123], a[220:223], v[200:203], a[120:123]
    v_exp_f32 v233, v169
    v_mfma_f32_16x16x32_bf16 a[124:127], a[220:223], v[204:207], a[124:127]
    s_waitcnt lgkmcnt(3)
    v_exp_f32 v234, v170
    v_mfma_f32_16x16x32_bf16 v[128:131], a[128:131], v[64:67], v[16:19]
    ds_read_b128 a[148:151], v2 offset:5120
    v_cvt_pk_bf16_f32 v216, v232, v233
    v_mfma_f32_16x16x32_bf16 v[128:131], a[132:135], v[68:71], v[128:131]
    s_waitcnt lgkmcnt(2)
    v_exp_f32 v235, v171
    v_mfma_f32_16x16x32_bf16 v[128:131], a[136:139], v[72:75], v[128:131]
    v_or3_b32 v57, v57, v215, v216
    v_mfma_f32_16x16x32_bf16 v[128:131], a[140:143], v[76:79], v[128:131]
    s_add_u32 s36, s36, 32
    v_exp_f32 v236, v184
    v_mfma_f32_16x16x32_bf16 v[132:135], a[128:131], v[80:83], v[20:23]
    ds_read_b128 a[152:155], v2 offset:6144
    v_cvt_pk_bf16_f32 v217, v234, v235
    v_mfma_f32_16x16x32_bf16 v[132:135], a[132:135], v[84:87], v[132:135]
    s_lshl_b32 s58, s61, 17
    buffer_load_dwordx4 a[224:227], v228, s[12:15], s57 offen
    v_mfma_f32_16x16x32_bf16 v[132:135], a[136:139], v[88:91], v[132:135]
    s_add_u32 s52, s52, 8192
    v_exp_f32 v237, v185
    v_mfma_f32_16x16x32_bf16 v[132:135], a[140:143], v[92:95], v[132:135]
    v_exp_f32 v238, v186
    v_mfma_f32_16x16x32_bf16 v[136:139], a[128:131], v[96:99], v[24:27]
    s_lshl_b32 s60, s60, 10
    ds_read_b128 a[156:159], v2 offset:7168
    v_cvt_pk_bf16_f32 v218, v236, v237
    v_mfma_f32_16x16x32_bf16 v[136:139], a[132:135], v[100:103], v[136:139]
    s_and_b32 s52, s52, 0xffff
    v_exp_f32 v239, v187
    v_mfma_f32_16x16x32_bf16 v[136:139], a[136:139], v[104:107], v[136:139]
    v_or3_b32 v57, v57, v217, v218
    v_mfma_f32_16x16x32_bf16 v[136:139], a[140:143], v[108:111], v[136:139]
    v_add_u32 v2, s52, v1
    v_cvt_pk_bf16_f32 v219, v238, v239
    v_mfma_f32_16x16x32_bf16 v[140:143], a[128:131], v[112:115], v[28:31]
    s_add_u32 s58, s58, s60
    v_exp_f32 v240, v172
    v_mfma_f32_16x16x32_bf16 v[140:143], a[132:135], v[116:119], v[140:143]
    buffer_load_dwordx4 a[228:231], v228, s[12:15], s56 offen
    v_mfma_f32_16x16x32_bf16 v[140:143], a[136:139], v[120:123], v[140:143]
    v_exp_f32 v241, v173
    v_mfma_f32_16x16x32_bf16 v[140:143], a[140:143], v[124:127], v[140:143]
    s_waitcnt lgkmcnt(2)
    ds_read_b128 a[192:195], v3 offset:0
    v_cvt_pk_bf16_f32 v220, v240, v241
    v_mfma_f32_16x16x32_bf16 v[144:147], a[144:147], v[64:67], v[32:35]
    s_mov_b32 s10, s59
    v_exp_f32 v242, v174
    v_mfma_f32_16x16x32_bf16 v[144:147], a[148:151], v[68:71], v[144:147]
    s_waitcnt lgkmcnt(1)
    v_exp_f32 v243, v175
    v_mfma_f32_16x16x32_bf16 v[144:147], a[152:155], v[72:75], v[144:147]
    ds_read_b128 a[196:199], v3 offset:1024
    v_or3_b32 v57, v57, v219, v220
    v_mfma_f32_16x16x32_bf16 v[144:147], a[156:159], v[76:79], v[144:147]
    v_exp_f32 v244, v188
    v_mfma_f32_16x16x32_bf16 v[148:151], a[144:147], v[80:83], v[36:39]
    v_cvt_pk_bf16_f32 v221, v242, v243
    v_mfma_f32_16x16x32_bf16 v[148:151], a[148:151], v[84:87], v[148:151]
    buffer_load_dword v7, v230, s[24:27], s54 offen
    v_mfma_f32_16x16x32_bf16 v[148:151], a[152:155], v[88:91], v[148:151]
    v_exp_f32 v245, v189
    v_mfma_f32_16x16x32_bf16 v[148:151], a[156:159], v[92:95], v[148:151]
    ds_read_b128 a[200:203], v3 offset:2048
    v_cvt_pk_bf16_f32 v222, v244, v245
    v_mfma_f32_16x16x32_bf16 v[152:155], a[144:147], v[96:99], v[40:43]
    v_exp_f32 v246, v190
    v_mfma_f32_16x16x32_bf16 v[152:155], a[148:151], v[100:103], v[152:155]
    v_exp_f32 v247, v191
    v_mfma_f32_16x16x32_bf16 v[152:155], a[152:155], v[104:107], v[152:155]
    ds_read_b128 a[204:207], v3 offset:3072
    v_or3_b32 v57, v57, v221, v222
    v_mfma_f32_16x16x32_bf16 v[152:155], a[156:159], v[108:111], v[152:155]
    v_cvt_pk_bf16_f32 v223, v246, v247
    v_mfma_f32_16x16x32_bf16 v[156:159], a[144:147], v[112:115], v[44:47]
    s_add_u32 s54, s54, 4096
    v_mfma_f32_16x16x32_bf16 v[156:159], a[148:151], v[116:119], v[156:159]
    v_bitop3_b32 v57, v57, v223, s37 bitop3:0xa8
    v_cmp_ne_u32 vcc, 0, v57
    v_mfma_f32_16x16x32_bf16 v[156:159], a[152:155], v[120:123], v[156:159]
    v_mfma_f32_16x16x32_bf16 v[156:159], a[156:159], v[124:127], v[156:159]
    s_cbranch_vccnz k2_tramp_90
k2_ret_91:
    v_mfma_f32_16x16x32_bf16 v[12:15], v[60:63], v[208:211], v[12:15]
    v_exp_f32 v232, v128
    v_mfma_f32_16x16x32_bf16 v[48:51], v[60:63], v[212:215], v[48:51]
    s_mov_b32 m0, s35
    ds_read_b128 a[208:211], v3 offset:4096
    v_mfma_f32_16x16x32_bf16 v[248:251], v[60:63], v[216:219], v[248:251]
    s_add_u32 s53, s53, 8192
    buffer_load_dwordx4 v1, s[20:23], s33 offen offset:0 sc1 lds
    v_mfma_f32_16x16x32_bf16 v[252:255], v[60:63], v[220:223], v[252:255]
    s_waitcnt lgkmcnt(3)
    v_exp_f32 v233, v129
    v_mfma_f32_16x16x32_bf16 a[0:3], a[192:195], v[208:211], a[0:3]
    s_and_b32 s53, s53, 0xffff
    v_exp_f32 v234, v130
    v_mfma_f32_16x16x32_bf16 a[4:7], a[192:195], v[212:215], a[4:7]
    ds_read_b128 a[212:215], v3 offset:5120
    v_cvt_pk_bf16_f32 v192, v232, v233
    v_mfma_f32_16x16x32_bf16 a[8:11], a[192:195], v[216:219], a[8:11]
    v_exp_f32 v235, v131
    v_mfma_f32_16x16x32_bf16 a[12:15], a[192:195], v[220:223], a[12:15]
    v_exp_f32 v236, v144
    v_mfma_f32_16x16x32_bf16 a[16:19], a[196:199], v[208:211], a[16:19]
    ds_read_b128 a[216:219], v3 offset:6144
    v_cvt_pk_bf16_f32 v193, v234, v235
    v_mfma_f32_16x16x32_bf16 a[20:23], a[196:199], v[212:215], a[20:23]
    v_exp_f32 v237, v145
    v_mfma_f32_16x16x32_bf16 a[24:27], a[196:199], v[216:219], a[24:27]
    v_mfma_f32_16x16x32_bf16 a[28:31], a[196:199], v[220:223], a[28:31]
    s_waitcnt lgkmcnt(3)
    v_exp_f32 v238, v146
    v_mfma_f32_16x16x32_bf16 a[32:35], a[200:203], v[208:211], a[32:35]
    ds_read_b128 a[220:223], v3 offset:7168
    v_cvt_pk_bf16_f32 v194, v236, v237
    v_mfma_f32_16x16x32_bf16 a[36:39], a[200:203], v[212:215], a[36:39]
    v_exp_f32 v239, v147
    v_mfma_f32_16x16x32_bf16 a[40:43], a[200:203], v[216:219], a[40:43]
    v_or3_b32 v57, v192, v193, v194
    v_mfma_f32_16x16x32_bf16 a[44:47], a[200:203], v[220:223], a[44:47]
    s_add_u32 s35, s35, 0x4000
    v_add_u32 v3, s53, v56
    v_cvt_pk_bf16_f32 v195, v238, v239
    v_mfma_f32_16x16x32_bf16 a[48:51], a[204:207], v[208:211], a[48:51]
    v_exp_f32 v240, v132
    v_mfma_f32_16x16x32_bf16 a[52:55], a[204:207], v[212:215], a[52:55]
    buffer_load_dwordx4 v1, s[20:23], s33 offen offset:1024 sc1 lds
    ds_read_b128 a[128:131], v2 offset:0
    v_mfma_f32_16x16x32_bf16 a[56:59], a[204:207], v[216:219], a[56:59]
    v_exp_f32 v241, v133
    v_mfma_f32_16x16x32_bf16 a[60:63], a[204:207], v[220:223], a[60:63]
    s_waitcnt lgkmcnt(3)
    v_exp_f32 v242, v134
    v_mfma_f32_16x16x32_bf16 a[64:67], a[208:211], v[208:211], a[64:67]
    ds_read_b128 a[132:135], v2 offset:1024
    v_cvt_pk_bf16_f32 v196, v240, v241
    v_mfma_f32_16x16x32_bf16 a[68:71], a[208:211], v[212:215], a[68:71]
    v_exp_f32 v243, v135
    v_mfma_f32_16x16x32_bf16 a[72:75], a[208:211], v[216:219], a[72:75]
    v_or3_b32 v57, v57, v195, v196
    v_mfma_f32_16x16x32_bf16 a[76:79], a[208:211], v[220:223], a[76:79]
    v_exp_f32 v244, v148
    v_mfma_f32_16x16x32_bf16 a[80:83], a[212:215], v[208:211], a[80:83]
    ds_read_b128 a[136:139], v2 offset:2048
    v_cvt_pk_bf16_f32 v197, v242, v243
    v_mfma_f32_16x16x32_bf16 a[84:87], a[212:215], v[212:215], a[84:87]
    v_exp_f32 v245, v149
    v_mfma_f32_16x16x32_bf16 a[88:91], a[212:215], v[216:219], a[88:91]
    v_mfma_f32_16x16x32_bf16 a[92:95], a[212:215], v[220:223], a[92:95]
    s_waitcnt lgkmcnt(3)
    v_exp_f32 v246, v150
    v_mfma_f32_16x16x32_bf16 a[96:99], a[216:219], v[208:211], a[96:99]
    ds_read_b128 a[140:143], v2 offset:3072
    v_cvt_pk_bf16_f32 v198, v244, v245
    v_mfma_f32_16x16x32_bf16 a[100:103], a[216:219], v[212:215], a[100:103]
    v_exp_f32 v247, v151
    v_mfma_f32_16x16x32_bf16 a[104:107], a[216:219], v[216:219], a[104:107]
    v_or3_b32 v57, v57, v197, v198
    v_mfma_f32_16x16x32_bf16 a[108:111], a[216:219], v[220:223], a[108:111]
    s_and_b32 s35, s35, 0xffff
    v_exp_f32 v232, v136
    v_mfma_f32_16x16x32_bf16 a[112:115], a[220:223], v[208:211], a[112:115]
    ds_read_b128 a[144:147], v2 offset:4096
    v_cvt_pk_bf16_f32 v199, v246, v247
    v_mfma_f32_16x16x32_bf16 a[116:119], a[220:223], v[212:215], a[116:119]
    buffer_load_dwordx4 v1, s[20:23], s33 offen offset:2048 sc1 lds
    v_mfma_f32_16x16x32_bf16 a[120:123], a[220:223], v[216:219], a[120:123]
    v_exp_f32 v233, v137
    v_mfma_f32_16x16x32_bf16 a[124:127], a[220:223], v[220:223], a[124:127]
    s_waitcnt lgkmcnt(3)
    v_exp_f32 v234, v138
    v_mfma_f32_16x16x32_bf16 v[160:163], a[128:131], v[64:67], v[16:19]
    ds_read_b128 a[148:151], v2 offset:5120
    v_cvt_pk_bf16_f32 v200, v232, v233
    v_mfma_f32_16x16x32_bf16 v[160:163], a[132:135], v[68:71], v[160:163]
    s_waitcnt lgkmcnt(2)
    v_exp_f32 v235, v139
    v_mfma_f32_16x16x32_bf16 v[160:163], a[136:139], v[72:75], v[160:163]
    v_or3_b32 v57, v57, v199, v200
    v_mfma_f32_16x16x32_bf16 v[160:163], a[140:143], v[76:79], v[160:163]
    s_or_b32 s35, s35, 0x10000
    v_exp_f32 v236, v152
    v_mfma_f32_16x16x32_bf16 v[164:167], a[128:131], v[80:83], v[20:23]
    s_add_u32 s36, s36, 32
    ds_read_b128 a[152:155], v2 offset:6144
    v_cvt_pk_bf16_f32 v201, v234, v235
    v_mfma_f32_16x16x32_bf16 v[164:167], a[132:135], v[84:87], v[164:167]
    v_exp_f32 v237, v153
    v_mfma_f32_16x16x32_bf16 v[164:167], a[136:139], v[88:91], v[164:167]
    s_add_u32 s52, s52, 8192
    v_mfma_f32_16x16x32_bf16 v[164:167], a[140:143], v[92:95], v[164:167]
    v_exp_f32 v238, v154
    v_mfma_f32_16x16x32_bf16 v[168:171], a[128:131], v[96:99], v[24:27]
    s_and_b32 s52, s52, 0xffff
    ds_read_b128 a[156:159], v2 offset:7168
    v_cvt_pk_bf16_f32 v202, v236, v237
    v_mfma_f32_16x16x32_bf16 v[168:171], a[132:135], v[100:103], v[168:171]
    v_exp_f32 v239, v155
    v_mfma_f32_16x16x32_bf16 v[168:171], a[136:139], v[104:107], v[168:171]
    v_or3_b32 v57, v57, v201, v202
    v_mfma_f32_16x16x32_bf16 v[168:171], a[140:143], v[108:111], v[168:171]
    v_add_u32 v2, s52, v1
    v_cvt_pk_bf16_f32 v203, v238, v239
    v_mfma_f32_16x16x32_bf16 v[172:175], a[128:131], v[112:115], v[28:31]
    v_exp_f32 v240, v140
    v_mfma_f32_16x16x32_bf16 v[172:175], a[132:135], v[116:119], v[172:175]
    buffer_load_dwordx4 v1, s[20:23], s33 offen offset:3072 sc1 lds
    v_mfma_f32_16x16x32_bf16 v[172:175], a[136:139], v[120:123], v[172:175]
    s_add_u32 s33, s33, 0x80000
    v_exp_f32 v241, v141
    v_mfma_f32_16x16x32_bf16 v[172:175], a[140:143], v[124:127], v[172:175]
    s_waitcnt lgkmcnt(2)
    ds_read_b128 a[192:195], v3 offset:0
    v_cvt_pk_bf16_f32 v204, v240, v241
    v_mfma_f32_16x16x32_bf16 v[176:179], a[144:147], v[64:67], v[32:35]
    v_exp_f32 v242, v142
    v_mfma_f32_16x16x32_bf16 v[176:179], a[148:151], v[68:71], v[176:179]
    s_waitcnt lgkmcnt(1)
    v_exp_f32 v243, v143
    v_mfma_f32_16x16x32_bf16 v[176:179], a[152:155], v[72:75], v[176:179]
    ds_read_b128 a[196:199], v3 offset:1024
    v_or3_b32 v57, v57, v203, v204
    v_mfma_f32_16x16x32_bf16 v[176:179], a[156:159], v[76:79], v[176:179]
    v_exp_f32 v244, v156
    v_mfma_f32_16x16x32_bf16 v[180:183], a[144:147], v[80:83], v[36:39]
    v_cvt_pk_bf16_f32 v205, v242, v243
    v_mfma_f32_16x16x32_bf16 v[180:183], a[148:151], v[84:87], v[180:183]
    v_exp_f32 v245, v157
    v_mfma_f32_16x16x32_bf16 v[180:183], a[152:155], v[88:91], v[180:183]
    ds_read_b128 a[200:203], v3 offset:2048
    v_mfma_f32_16x16x32_bf16 v[180:183], a[156:159], v[92:95], v[180:183]
    s_sub_u32 s63, s63, 1
    v_exp_f32 v246, v158
    v_mfma_f32_16x16x32_bf16 v[184:187], a[144:147], v[96:99], v[40:43]
    v_cvt_pk_bf16_f32 v206, v244, v245
    v_mfma_f32_16x16x32_bf16 v[184:187], a[148:151], v[100:103], v[184:187]
    v_exp_f32 v247, v159
    v_mfma_f32_16x16x32_bf16 v[184:187], a[152:155], v[104:107], v[184:187]
    ds_read_b128 a[204:207], v3 offset:3072
    v_or3_b32 v57, v57, v205, v206
    v_mfma_f32_16x16x32_bf16 v[184:187], a[156:159], v[108:111], v[184:187]
    v_cvt_pk_bf16_f32 v207, v246, v247
    v_mfma_f32_16x16x32_bf16 v[188:191], a[144:147], v[112:115], v[44:47]
    v_mfma_f32_16x16x32_bf16 v[188:191], a[148:151], v[116:119], v[188:191]
    v_bitop3_b32 v57, v57, v207, s37 bitop3:0xa8
    v_cmp_ne_u32 vcc, 0, v57
    v_mfma_f32_16x16x32_bf16 v[188:191], a[152:155], v[120:123], v[188:191]
    v_mfma_f32_16x16x32_bf16 v[188:191], a[156:159], v[124:127], v[188:191]
    s_waitcnt vmcnt(13)
    s_barrier
    s_cbranch_vccnz k2_tramp_92
k2_ret_93:
    s_cmp_lg_u32 s63, 0
    s_cbranch_scc1 k2_dloop_88
    v_mfma_f32_16x16x32_bf16 v[12:15], v[60:63], v[192:195], v[12:15]
    v_exp_f32 v232, v160
    v_mfma_f32_16x16x32_bf16 v[48:51], v[60:63], v[196:199], v[48:51]
    s_mov_b32 m0, s34
    ds_read_b128 a[208:211], v3 offset:4096
    v_mfma_f32_16x16x32_bf16 v[248:251], v[60:63], v[200:203], v[248:251]
    s_add_u32 s53, s53, 8192
    buffer_load_dwordx4 v1, s[16:19], s32 offen offset:0 sc1 lds
    v_mfma_f32_16x16x32_bf16 v[252:255], v[60:63], v[204:207], v[252:255]
    s_waitcnt lgkmcnt(3)
    v_exp_f32 v233, v161
    v_mfma_f32_16x16x32_bf16 a[0:3], a[192:195], v[192:195], a[0:3]
    s_sub_u32 s40, s36, s38
    v_exp_f32 v234, v162
    v_mfma_f32_16x16x32_bf16 a[4:7], a[192:195], v[196:199], a[4:7]
    s_and_b32 s53, s53, 0xffff
    ds_read_b128 a[212:215], v3 offset:5120
    v_cvt_pk_bf16_f32 v208, v232, v233
    v_mfma_f32_16x16x32_bf16 a[8:11], a[192:195], v[200:203], a[8:11]
    s_add_u32 s34, s34, 0x4000
    v_subrev_u32 v6, s40, v4
    v_cmp_gt_i32 s[44:45], 0, v6
    v_mfma_f32_16x16x32_bf16 a[12:15], a[192:195], v[204:207], a[12:15]
    v_exp_f32 v235, v163
    v_mfma_f32_16x16x32_bf16 a[16:19], a[196:199], v[192:195], a[16:19]
    buffer_load_dwordx4 v1, s[16:19], s32 offen offset:1024 sc1 lds
    ds_read_b128 a[216:219], v3 offset:6144
    v_mfma_f32_16x16x32_bf16 a[20:23], a[196:199], v[196:199], a[20:23]
    v_exp_f32 v236, v176
    v_mfma_f32_16x16x32_bf16 a[24:27], a[196:199], v[200:203], a[24:27]
    v_cmp_gt_i32 s[46:47], 1, v6
    v_cvt_pk_bf16_f32 v209, v234, v235
    v_mfma_f32_16x16x32_bf16 a[28:31], a[196:199], v[204:207], a[28:31]
    s_waitcnt lgkmcnt(3)
    v_cmp_gt_i32 s[48:49], 2, v6
    v_cmp_gt_i32 s[50:51], 3, v6
    v_mfma_f32_16x16x32_bf16 a[32:35], a[200:203], v[192:195], a[32:35]
    s_and_b32 s34, s34, 0xffff
    v_exp_f32 v237, v177
    v_mfma_f32_16x16x32_bf16 a[36:39], a[200:203], v[196:199], a[36:39]
    s_and_b32 s60, s62, 31
    v_exp_f32 v238, v178
    v_mfma_f32_16x16x32_bf16 a[40:43], a[200:203], v[200:203], a[40:43]
    ds_read_b128 a[220:223], v3 offset:7168
    v_cvt_pk_bf16_f32 v210, v236, v237
    v_mfma_f32_16x16x32_bf16 a[44:47], a[200:203], v[204:207], a[44:47]
    s_lshr_b32 s61, s62, 5
    buffer_load_dwordx4 v1, s[16:19], s32 offen offset:2048 sc1 lds
    v_mfma_f32_16x16x32_bf16 a[48:51], a[204:207], v[192:195], a[48:51]
    v_cndmask_b32 v16, v8, v5, s[44:45]
    v_or3_b32 v57, v208, v209, v210
    v_mfma_f32_16x16x32_bf16 a[52:55], a[204:207], v[196:199], a[52:55]
    v_exp_f32 v239, v179
    v_mfma_f32_16x16x32_bf16 a[56:59], a[204:207], v[200:203], a[56:59]
    s_mul_i32 s57, s60, 229376
    v_cndmask_b32 v17, v8, v5, s[46:47]
    v_add_u32 v3, s53, v56
    v_mfma_f32_16x16x32_bf16 a[60:63], a[204:207], v[204:207], a[60:63]
    s_waitcnt lgkmcnt(2)
    v_exp_f32 v240, v164
    v_mfma_f32_16x16x32_bf16 a[64:67], a[208:211], v[192:195], a[64:67]
    v_cvt_pk_bf16_f32 v211, v238, v239
    v_cndmask_b32 v18, v8, v5, s[48:49]
    v_mfma_f32_16x16x32_bf16 a[68:71], a[208:211], v[196:199], a[68:71]
    s_lshl_b32 s4, s61, 7
    ds_read_b128 a[128:131], v2 offset:0
    v_cndmask_b32 v19, v8, v5, s[50:51]
    v_mfma_f32_16x16x32_bf16 a[72:75], a[208:211], v[200:203], a[72:75]
    v_exp_f32 v241, v165
    v_mfma_f32_16x16x32_bf16 a[76:79], a[208:211], v[204:207], a[76:79]
    s_add_u32 s57, s57, s4
    buffer_load_dwordx4 v1, s[16:19], s32 offen offset:3072 sc1 lds
    s_add_u32 s32, s32, 0x80000
    v_mfma_f32_16x16x32_bf16 a[80:83], a[212:215], v[192:195], a[80:83]
    s_waitcnt vmcnt(8)
    v_cmp_gt_i32 s[44:45], 16, v6
    v_exp_f32 v242, v166
    v_mfma_f32_16x16x32_bf16 a[84:87], a[212:215], v[196:199], a[84:87]
    ds_read_b128 a[132:135], v2 offset:1024
    v_cvt_pk_bf16_f32 v212, v240, v241
    v_mfma_f32_16x16x32_bf16 a[88:91], a[212:215], v[200:203], a[88:91]
    s_add_u32 s56, s57, 57344
    v_cmp_gt_i32 s[46:47], 17, v6
    v_exp_f32 v243, v167
    v_mfma_f32_16x16x32_bf16 a[92:95], a[212:215], v[204:207], a[92:95]
    s_waitcnt lgkmcnt(2)
    v_or3_b32 v57, v57, v211, v212
    v_cmp_gt_i32 s[48:49], 18, v6
    v_mfma_f32_16x16x32_bf16 a[96:99], a[216:219], v[192:195], a[96:99]
    v_exp_f32 v244, v180
    v_mfma_f32_16x16x32_bf16 a[100:103], a[216:219], v[196:199], a[100:103]
    s_add_u32 s62, s62, 1
    v_cvt_pk_bf16_f32 v213, v242, v243
    v_cmp_gt_i32 s[50:51], 19, v6
    v_mfma_f32_16x16x32_bf16 a[104:107], a[216:219], v[200:203], a[104:107]
    buffer_store_dwordx4 a[224:227], v229, s[8:11], s58 offen offset:0 sc1
    ds_read_b128 a[136:139], v2 offset:2048
    v_mfma_f32_16x16x32_bf16 a[108:111], a[216:219], v[204:207], a[108:111]
    v_exp_f32 v245, v181
    v_mfma_f32_16x16x32_bf16 a[112:115], a[220:223], v[192:195], a[112:115]
    v_cndmask_b32 v32, v8, v5, s[44:45]
    v_exp_f32 v246, v182
    v_mfma_f32_16x16x32_bf16 a[116:119], a[220:223], v[196:199], a[116:119]
    ds_read_b128 a[140:143], v2 offset:3072
    v_cndmask_b32 v33, v8, v5, s[46:47]
    v_cvt_pk_bf16_f32 v214, v244, v245
    v_cndmask_b32 v34, v8, v5, s[48:49]
    v_cndmask_b32 v35, v8, v5, s[50:51]
    v_mfma_f32_16x16x32_bf16 a[120:123], a[220:223], v[200:203], a[120:123]
    v_exp_f32 v247, v183
    v_mfma_f32_16x16x32_bf16 a[124:127], a[220:223], v[204:207], a[124:127]
    s_waitcnt lgkmcnt(2)
    v_or3_b32 v57, v57, v213, v214
    v_cvt_pk_bf16_f32 v215, v246, v247
    v_mfma_f32_16x16x32_bf16 v[128:131], a[128:131], v[64:67], v[16:19]
    v_exp_f32 v232, v168
    v_mfma_f32_16x16x32_bf16 v[128:131], a[132:135], v[68:71], v[128:131]
    s_waitcnt lgkmcnt(0)
    buffer_store_dwordx4 a[228:231], v229, s[8:11], s58 offen offset:256 sc1
    ds_read_b128 a[144:147], v2 offset:4096
    v_mfma_f32_16x16x32_bf16 v[128:131], a[136:139], v[72:75], v[128:131]
    v_exp_f32 v233, v169
    v_mfma_f32_16x16x32_bf16 v[128:131], a[140:143], v[76:79], v[128:131]
    s_add_u32 s36, s36, 32
    v_exp_f32 v234, v170
    v_mfma_f32_16x16x32_bf16 v[132:135], a[128:131], v[80:83], v[20:23]
    ds_read_b128 a[148:151], v2 offset:5120
    v_cvt_pk_bf16_f32 v216, v232, v233
    v_mfma_f32_16x16x32_bf16 v[132:135], a[132:135], v[84:87], v[132:135]
    s_lshl_b32 s58, s61, 17
    v_exp_f32 v235, v171
    v_mfma_f32_16x16x32_bf16 v[132:135], a[136:139], v[88:91], v[132:135]
    s_add_u32 s52, s52, 8192
    v_or3_b32 v57, v57, v215, v216
    v_cvt_pk_bf16_f32 v217, v234, v235
    v_mfma_f32_16x16x32_bf16 v[132:135], a[140:143], v[92:95], v[132:135]
    v_exp_f32 v236, v184
    v_mfma_f32_16x16x32_bf16 v[136:139], a[128:131], v[96:99], v[24:27]
    s_lshl_b32 s60, s60, 10
    buffer_load_dwordx4 a[224:227], v228, s[12:15], s57 offen
    ds_read_b128 a[152:155], v2 offset:6144
    v_mfma_f32_16x16x32_bf16 v[136:139], a[132:135], v[100:103], v[136:139]
    s_and_b32 s52, s52, 0xffff
    v_exp_f32 v237, v185
    v_mfma_f32_16x16x32_bf16 v[136:139], a[136:139], v[104:107], v[136:139]
    v_exp_f32 v238, v186
    v_mfma_f32_16x16x32_bf16 v[136:139], a[140:143], v[108:111], v[136:139]
    ds_read_b128 a[156:159], v2 offset:7168
    v_cvt_pk_bf16_f32 v218, v236, v237
    v_mfma_f32_16x16x32_bf16 v[140:143], a[128:131], v[112:115], v[28:31]
    s_add_u32 s58, s58, s60
    v_exp_f32 v239, v187
    v_mfma_f32_16x16x32_bf16 v[140:143], a[132:135], v[116:119], v[140:143]
    v_or3_b32 v57, v57, v217, v218
    v_add_u32 v2, s52, v1
    v_mfma_f32_16x16x32_bf16 v[140:143], a[136:139], v[120:123], v[140:143]
    v_exp_f32 v240, v172
    v_mfma_f32_16x16x32_bf16 v[140:143], a[140:143], v[124:127], v[140:143]
    s_waitcnt lgkmcnt(2)
    ds_read_b128 a[192:195], v3 offset:0
    v_cvt_pk_bf16_f32 v219, v238, v239
    v_mfma_f32_16x16x32_bf16 v[144:147], a[144:147], v[64:67], v[32:35]
    s_mov_b32 s10, s59
    buffer_load_dwordx4 a[228:231], v228, s[12:15], s56 offen
    v_mfma_f32_16x16x32_bf16 v[144:147], a[148:151], v[68:71], v[144:147]
    s_waitcnt lgkmcnt(1)
    v_exp_f32 v241, v173
    v_mfma_f32_16x16x32_bf16 v[144:147], a[152:155], v[72:75], v[144:147]
    v_exp_f32 v242, v174
    v_mfma_f32_16x16x32_bf16 v[144:147], a[156:159], v[76:79], v[144:147]
    v_cvt_pk_bf16_f32 v220, v240, v241
    v_or3_b32 v57, v57, v219, v220
    v_mfma_f32_16x16x32_bf16 v[148:151], a[144:147], v[80:83], v[36:39]
    v_exp_f32 v243, v175
    v_mfma_f32_16x16x32_bf16 v[148:151], a[148:151], v[84:87], v[148:151]
    ds_read_b128 a[196:199], v3 offset:1024
    v_cvt_pk_bf16_f32 v221, v242, v243
    v_mfma_f32_16x16x32_bf16 v[148:151], a[152:155], v[88:91], v[148:151]
    v_exp_f32 v244, v188
    v_mfma_f32_16x16x32_bf16 v[148:151], a[156:159], v[92:95], v[148:151]
    buffer_load_dword v7, v230, s[24:27], s54 offen
    ds_read_b128 a[200:203], v3 offset:2048
    v_mfma_f32_16x16x32_bf16 v[152:155], a[144:147], v[96:99], v[40:43]
    v_exp_f32 v245, v189
    v_mfma_f32_16x16x32_bf16 v[152:155], a[148:151], v[100:103], v[152:155]
    v_exp_f32 v246, v190
    v_mfma_f32_16x16x32_bf16 v[152:155], a[152:155], v[104:107], v[152:155]
    v_cvt_pk_bf16_f32 v222, v244, v245
    v_or3_b32 v57, v57, v221, v222
    v_mfma_f32_16x16x32_bf16 v[152:155], a[156:159], v[108:111], v[152:155]
    v_exp_f32 v247, v191
    v_mfma_f32_16x16x32_bf16 v[156:159], a[144:147], v[112:115], v[44:47]
    s_add_u32 s54, s54, 4096
    ds_read_b128 a[204:207], v3 offset:3072
    v_cvt_pk_bf16_f32 v223, v246, v247
    v_mfma_f32_16x16x32_bf16 v[156:159], a[148:151], v[116:119], v[156:159]
    v_bitop3_b32 v57, v57, v223, s37 bitop3:0xa8
    v_cmp_ne_u32 vcc, 0, v57
    v_mfma_f32_16x16x32_bf16 v[156:159], a[152:155], v[120:123], v[156:159]
    v_mfma_f32_16x16x32_bf16 v[156:159], a[156:159], v[124:127], v[156:159]
    s_cbranch_vccnz k2_tramp_94
k2_ret_95:
    v_mfma_f32_16x16x32_bf16 v[12:15], v[60:63], v[208:211], v[12:15]
    v_exp_f32 v232, v128
    v_mfma_f32_16x16x32_bf16 v[48:51], v[60:63], v[212:215], v[48:51]
    s_mov_b32 m0, s35
    ds_read_b128 a[208:211], v3 offset:4096
    v_mfma_f32_16x16x32_bf16 v[248:251], v[60:63], v[216:219], v[248:251]
    s_add_u32 s53, s53, 8192
    buffer_load_dwordx4 v1, s[20:23], s33 offen offset:0 sc1 lds
    v_mfma_f32_16x16x32_bf16 v[252:255], v[60:63], v[220:223], v[252:255]
    s_waitcnt lgkmcnt(3)
    v_exp_f32 v233, v129
    v_mfma_f32_16x16x32_bf16 a[0:3], a[192:195], v[208:211], a[0:3]
    s_sub_u32 s40, s36, s38
    v_exp_f32 v234, v130
    v_mfma_f32_16x16x32_bf16 a[4:7], a[192:195], v[212:215], a[4:7]
    s_and_b32 s53, s53, 0xffff
    ds_read_b128 a[212:215], v3 offset:5120
    v_cvt_pk_bf16_f32 v192, v232, v233
    v_mfma_f32_16x16x32_bf16 a[8:11], a[192:195], v[216:219], a[8:11]
    v_subrev_u32 v6, s40, v4
    v_cmp_gt_i32 s[44:45], 0, v6
    v_mfma_f32_16x16x32_bf16 a[12:15], a[192:195], v[220:223], a[12:15]
    v_exp_f32 v235, v131
    v_mfma_f32_16x16x32_bf16 a[16:19], a[196:199], v[208:211], a[16:19]
    v_exp_f32 v236, v144
    v_mfma_f32_16x16x32_bf16 a[20:23], a[196:199], v[212:215], a[20:23]
    v_cmp_gt_i32 s[46:47], 1, v6
    v_cvt_pk_bf16_f32 v193, v234, v235
    v_mfma_f32_16x16x32_bf16 a[24:27], a[196:199], v[216:219], a[24:27]
    ds_read_b128 a[216:219], v3 offset:6144
    v_cmp_gt_i32 s[48:49], 2, v6
    v_mfma_f32_16x16x32_bf16 a[28:31], a[196:199], v[220:223], a[28:31]
    s_waitcnt lgkmcnt(3)
    v_exp_f32 v237, v145
    v_mfma_f32_16x16x32_bf16 a[32:35], a[200:203], v[208:211], a[32:35]
    v_cmp_gt_i32 s[50:51], 3, v6
    v_cvt_pk_bf16_f32 v194, v236, v237
    v_mfma_f32_16x16x32_bf16 a[36:39], a[200:203], v[212:215], a[36:39]
    v_exp_f32 v238, v146
    v_mfma_f32_16x16x32_bf16 a[40:43], a[200:203], v[216:219], a[40:43]
    ds_read_b128 a[220:223], v3 offset:7168
    v_cndmask_b32 v16, v8, v5, s[44:45]
    v_mfma_f32_16x16x32_bf16 a[44:47], a[200:203], v[220:223], a[44:47]
    s_add_u32 s35, s35, 0x4000
    v_exp_f32 v239, v147
    v_mfma_f32_16x16x32_bf16 a[48:51], a[204:207], v[208:211], a[48:51]
    v_or3_b32 v57, v192, v193, v194
    v_cndmask_b32 v17, v8, v5, s[46:47]
    v_mfma_f32_16x16x32_bf16 a[52:55], a[204:207], v[212:215], a[52:55]
    v_add_u32 v3, s53, v56
    v_cvt_pk_bf16_f32 v195, v238, v239
    v_mfma_f32_16x16x32_bf16 a[56:59], a[204:207], v[216:219], a[56:59]
    v_exp_f32 v240, v132
    v_mfma_f32_16x16x32_bf16 a[60:63], a[204:207], v[220:223], a[60:63]
    s_waitcnt lgkmcnt(2)
    ds_read_b128 a[128:131], v2 offset:0
    v_cndmask_b32 v18, v8, v5, s[48:49]
    v_mfma_f32_16x16x32_bf16 a[64:67], a[208:211], v[208:211], a[64:67]
    buffer_load_dwordx4 v1, s[20:23], s33 offen offset:1024 sc1 lds
    ds_read_b128 a[132:135], v2 offset:1024
    v_mfma_f32_16x16x32_bf16 a[68:71], a[208:211], v[212:215], a[68:71]
    v_exp_f32 v241, v133
    v_mfma_f32_16x16x32_bf16 a[72:75], a[208:211], v[216:219], a[72:75]
    v_cndmask_b32 v19, v8, v5, s[50:51]
    v_cmp_gt_i32 s[44:45], 16, v6
    v_mfma_f32_16x16x32_bf16 a[76:79], a[208:211], v[220:223], a[76:79]
    v_exp_f32 v242, v134
    v_mfma_f32_16x16x32_bf16 a[80:83], a[212:215], v[208:211], a[80:83]
    v_cvt_pk_bf16_f32 v196, v240, v241
    v_cmp_gt_i32 s[46:47], 17, v6
    v_mfma_f32_16x16x32_bf16 a[84:87], a[212:215], v[212:215], a[84:87]
    v_exp_f32 v243, v135
    v_mfma_f32_16x16x32_bf16 a[88:91], a[212:215], v[216:219], a[88:91]
    v_or3_b32 v57, v57, v195, v196
    v_cmp_gt_i32 s[48:49], 18, v6
    v_mfma_f32_16x16x32_bf16 a[92:95], a[212:215], v[220:223], a[92:95]
    s_waitcnt lgkmcnt(2)
    v_exp_f32 v244, v148
    v_mfma_f32_16x16x32_bf16 a[96:99], a[216:219], v[208:211], a[96:99]
    v_cvt_pk_bf16_f32 v197, v242, v243
    v_cmp_gt_i32 s[50:51], 19, v6
    v_mfma_f32_16x16x32_bf16 a[100:103], a[216:219], v[212:215], a[100:103]
    ds_read_b128 a[136:139], v2 offset:2048
    v_cndmask_b32 v32, v8, v5, s[44:45]
    v_mfma_f32_16x16x32_bf16 a[104:107], a[216:219], v[216:219], a[104:107]
    v_exp_f32 v245, v149
    v_mfma_f32_16x16x32_bf16 a[108:111], a[216:219], v[220:223], a[108:111]
    s_and_b32 s35, s35, 0xffff
    v_exp_f32 v246, v150
    v_mfma_f32_16x16x32_bf16 a[112:115], a[220:223], v[208:211], a[112:115]
    v_cndmask_b32 v33, v8, v5, s[46:47]
    v_cvt_pk_bf16_f32 v198, v244, v245
    v_mfma_f32_16x16x32_bf16 a[116:119], a[220:223], v[212:215], a[116:119]
    ds_read_b128 a[140:143], v2 offset:3072
    v_cndmask_b32 v34, v8, v5, s[48:49]
    v_cndmask_b32 v35, v8, v5, s[50:51]
    v_mfma_f32_16x16x32_bf16 a[120:123], a[220:223], v[216:219], a[120:123]
    v_exp_f32 v247, v151
    v_mfma_f32_16x16x32_bf16 a[124:127], a[220:223], v[220:223], a[124:127]
    s_waitcnt lgkmcnt(2)
    v_or3_b32 v57, v57, v197, v198
    v_cvt_pk_bf16_f32 v199, v246, v247
    v_mfma_f32_16x16x32_bf16 v[160:163], a[128:131], v[64:67], v[16:19]
    v_exp_f32 v232, v136
    v_mfma_f32_16x16x32_bf16 v[160:163], a[132:135], v[68:71], v[160:163]
    s_waitcnt lgkmcnt(0)
    buffer_load_dwordx4 v1, s[20:23], s33 offen offset:2048 sc1 lds
    ds_read_b128 a[144:147], v2 offset:4096
    v_mfma_f32_16x16x32_bf16 v[160:163], a[136:139], v[72:75], v[160:163]
    v_exp_f32 v233, v137
    v_mfma_f32_16x16x32_bf16 v[160:163], a[140:143], v[76:79], v[160:163]
    s_or_b32 s35, s35, 0x10000
    v_exp_f32 v234, v138
    v_mfma_f32_16x16x32_bf16 v[164:167], a[128:131], v[80:83], v[20:23]
    s_add_u32 s36, s36, 32
    ds_read_b128 a[148:151], v2 offset:5120
    v_cvt_pk_bf16_f32 v200, v232, v233
    v_mfma_f32_16x16x32_bf16 v[164:167], a[132:135], v[84:87], v[164:167]
    v_exp_f32 v235, v139
    v_mfma_f32_16x16x32_bf16 v[164:167], a[136:139], v[88:91], v[164:167]
    s_add_u32 s52, s52, 8192
    v_or3_b32 v57, v57, v199, v200
    v_cvt_pk_bf16_f32 v201, v234, v235
    v_mfma_f32_16x16x32_bf16 v[164:167], a[140:143], v[92:95], v[164:167]
    v_exp_f32 v236, v152
    v_mfma_f32_16x16x32_bf16 v[168:171], a[128:131], v[96:99], v[24:27]
    s_and_b32 s52, s52, 0xffff
    ds_read_b128 a[152:155], v2 offset:6144
    ds_read_b128 a[156:159], v2 offset:7168
    v_mfma_f32_16x16x32_bf16 v[168:171], a[132:135], v[100:103], v[168:171]
    v_exp_f32 v237, v153
    v_mfma_f32_16x16x32_bf16 v[168:171], a[136:139], v[104:107], v[168:171]
    v_exp_f32 v238, v154
    v_mfma_f32_16x16x32_bf16 v[168:171], a[140:143], v[108:111], v[168:171]
    v_cvt_pk_bf16_f32 v202, v236, v237
    v_or3_b32 v57, v57, v201, v202
    v_mfma_f32_16x16x32_bf16 v[172:175], a[128:131], v[112:115], v[28:31]
    v_exp_f32 v239, v155
    v_mfma_f32_16x16x32_bf16 v[172:175], a[132:135], v[116:119], v[172:175]
    v_add_u32 v2, s52, v1
    v_cvt_pk_bf16_f32 v203, v238, v239
    v_mfma_f32_16x16x32_bf16 v[172:175], a[136:139], v[120:123], v[172:175]
    v_exp_f32 v240, v140
    v_mfma_f32_16x16x32_bf16 v[172:175], a[140:143], v[124:127], v[172:175]
    s_waitcnt lgkmcnt(2)
    buffer_load_dwordx4 v1, s[20:23], s33 offen offset:3072 sc1 lds
    s_add_u32 s33, s33, 0x80000
    v_mfma_f32_16x16x32_bf16 v[176:179], a[144:147], v[64:67], v[32:35]
    v_exp_f32 v241, v141
    v_mfma_f32_16x16x32_bf16 v[176:179], a[148:151], v[68:71], v[176:179]
    s_waitcnt lgkmcnt(0)
    ds_read_b128 a[192:195], v3 offset:0
    v_cvt_pk_bf16_f32 v204, v240, v241
    v_mfma_f32_16x16x32_bf16 v[176:179], a[152:155], v[72:75], v[176:179]
    v_exp_f32 v242, v142
    v_mfma_f32_16x16x32_bf16 v[176:179], a[156:159], v[76:79], v[176:179]
    v_exp_f32 v243, v143
    v_mfma_f32_16x16x32_bf16 v[180:183], a[144:147], v[80:83], v[36:39]
    ds_read_b128 a[196:199], v3 offset:1024
    v_or3_b32 v57, v57, v203, v204
    v_mfma_f32_16x16x32_bf16 v[180:183], a[148:151], v[84:87], v[180:183]
    v_exp_f32 v244, v156
    v_mfma_f32_16x16x32_bf16 v[180:183], a[152:155], v[88:91], v[180:183]
    ds_read_b128 a[200:203], v3 offset:2048
    v_cvt_pk_bf16_f32 v205, v242, v243
    v_mfma_f32_16x16x32_bf16 v[180:183], a[156:159], v[92:95], v[180:183]
    v_exp_f32 v245, v157
    v_mfma_f32_16x16x32_bf16 v[184:187], a[144:147], v[96:99], v[40:43]
    v_exp_f32 v246, v158
    v_mfma_f32_16x16x32_bf16 v[184:187], a[148:151], v[100:103], v[184:187]
    v_cvt_pk_bf16_f32 v206, v244, v245
    v_or3_b32 v57, v57, v205, v206
    v_mfma_f32_16x16x32_bf16 v[184:187], a[152:155], v[104:107], v[184:187]
    v_exp_f32 v247, v159
    v_mfma_f32_16x16x32_bf16 v[184:187], a[156:159], v[108:111], v[184:187]
    ds_read_b128 a[204:207], v3 offset:3072
    v_cvt_pk_bf16_f32 v207, v246, v247
    v_mfma_f32_16x16x32_bf16 v[188:191], a[144:147], v[112:115], v[44:47]
    v_mfma_f32_16x16x32_bf16 v[188:191], a[148:151], v[116:119], v[188:191]
    v_bitop3_b32 v57, v57, v207, s37 bitop3:0xa8
    v_cmp_ne_u32 vcc, 0, v57
    v_mfma_f32_16x16x32_bf16 v[188:191], a[152:155], v[120:123], v[188:191]
    v_mfma_f32_16x16x32_bf16 v[188:191], a[156:159], v[124:127], v[188:191]
    s_waitcnt vmcnt(13)
    s_barrier
    s_cbranch_vccnz k2_tramp_96
k2_ret_97:
k2_dm3_89:
    v_mfma_f32_16x16x32_bf16 v[12:15], v[60:63], v[192:195], v[12:15]
    v_exp_f32 v232, v160
    v_mfma_f32_16x16x32_bf16 v[48:51], v[60:63], v[196:199], v[48:51]
    s_mov_b32 m0, s34
    ds_read_b128 a[208:211], v3 offset:4096
    v_mfma_f32_16x16x32_bf16 v[248:251], v[60:63], v[200:203], v[248:251]
    s_add_u32 s53, s53, 8192
    v_exp_f32 v233, v161
    v_mfma_f32_16x16x32_bf16 v[252:255], v[60:63], v[204:207], v[252:255]
    s_waitcnt lgkmcnt(3)
    buffer_load_dwordx4 v1, s[16:19], s32 offen offset:0 sc1 lds
    v_mfma_f32_16x16x32_bf16 a[0:3], a[192:195], v[192:195], a[0:3]
    s_sub_u32 s40, s36, s38
    s_sub_u32 s40, s40, 64
    v_exp_f32 v234, v162
    v_cvt_pk_bf16_f32 v208, v232, v233
    v_mfma_f32_16x16x32_bf16 a[4:7], a[192:195], v[196:199], a[4:7]
    s_and_b32 s53, s53, 0xffff
    ds_read_b128 a[212:215], v3 offset:5120
    v_subrev_u32 v6, s40, v4
    v_mfma_f32_16x16x32_bf16 a[8:11], a[192:195], v[200:203], a[8:11]
    s_add_u32 s34, s34, 0x4000
    v_exp_f32 v235, v163
    v_cmp_gt_i32 s[44:45], 0, v6
    v_mfma_f32_16x16x32_bf16 a[12:15], a[192:195], v[204:207], a[12:15]
    v_exp_f32 v236, v176
    v_cvt_pk_bf16_f32 v209, v234, v235
    v_mfma_f32_16x16x32_bf16 a[16:19], a[196:199], v[192:195], a[16:19]
    buffer_load_dwordx4 v1, s[16:19], s32 offen offset:1024 sc1 lds
    ds_read_b128 a[216:219], v3 offset:6144
    v_mfma_f32_16x16x32_bf16 a[20:23], a[196:199], v[196:199], a[20:23]
    v_cmp_gt_i32 s[46:47], 1, v6
    v_exp_f32 v237, v177
    v_mfma_f32_16x16x32_bf16 a[24:27], a[196:199], v[200:203], a[24:27]
    v_cmp_gt_i32 s[48:49], 2, v6
    v_exp_f32 v238, v178
    v_mfma_f32_16x16x32_bf16 a[28:31], a[196:199], v[204:207], a[28:31]
    s_waitcnt lgkmcnt(3)
    v_cvt_pk_bf16_f32 v210, v236, v237
    v_cmp_gt_i32 s[50:51], 3, v6
    v_mfma_f32_16x16x32_bf16 a[32:35], a[200:203], v[192:195], a[32:35]
    s_and_b32 s34, s34, 0xffff
    v_exp_f32 v239, v179
    v_mfma_f32_16x16x32_bf16 a[36:39], a[200:203], v[196:199], a[36:39]
    s_and_b32 s60, s62, 31
    ds_read_b128 a[220:223], v3 offset:7168
    v_or3_b32 v57, v208, v209, v210
    v_cndmask_b32 v20, v9, v5, s[44:45]
    v_mfma_f32_16x16x32_bf16 a[40:43], a[200:203], v[200:203], a[40:43]
    buffer_load_dwordx4 v1, s[16:19], s32 offen offset:2048 sc1 lds
    v_mfma_f32_16x16x32_bf16 a[44:47], a[200:203], v[204:207], a[44:47]
    s_lshr_b32 s61, s62, 5
    v_exp_f32 v240, v164
    v_cvt_pk_bf16_f32 v211, v238, v239
    v_mfma_f32_16x16x32_bf16 a[48:51], a[204:207], v[192:195], a[48:51]
    v_cndmask_b32 v21, v9, v5, s[46:47]
    v_add_u32 v3, s53, v56
    v_mfma_f32_16x16x32_bf16 a[52:55], a[204:207], v[196:199], a[52:55]
    s_mul_i32 s57, s60, 229376
    v_exp_f32 v241, v165
    v_mfma_f32_16x16x32_bf16 a[56:59], a[204:207], v[200:203], a[56:59]
    ds_read_b128 a[128:131], v2 offset:0
    v_cndmask_b32 v22, v9, v5, s[48:49]
    v_cvt_pk_bf16_f32 v212, v240, v241
    v_mfma_f32_16x16x32_bf16 a[60:63], a[204:207], v[204:207], a[60:63]
    s_waitcnt lgkmcnt(3)
    v_exp_f32 v242, v166
    v_mfma_f32_16x16x32_bf16 a[64:67], a[208:211], v[192:195], a[64:67]
    s_lshl_b32 s4, s61, 7
    v_cndmask_b32 v23, v9, v5, s[50:51]
    v_or3_b32 v57, v57, v211, v212
    v_mfma_f32_16x16x32_bf16 a[68:71], a[208:211], v[196:199], a[68:71]
    buffer_load_dwordx4 v1, s[16:19], s32 offen offset:3072 sc1 lds
    ds_read_b128 a[132:135], v2 offset:1024
    s_add_u32 s32, s32, 0x80000
    v_mfma_f32_16x16x32_bf16 a[72:75], a[208:211], v[200:203], a[72:75]
    v_exp_f32 v243, v167
    v_mfma_f32_16x16x32_bf16 a[76:79], a[208:211], v[204:207], a[76:79]
    s_add_u32 s57, s57, s4
    v_cmp_gt_i32 s[44:45], 16, v6
    v_cvt_pk_bf16_f32 v213, v242, v243
    v_mfma_f32_16x16x32_bf16 a[80:83], a[212:215], v[192:195], a[80:83]
    s_waitcnt vmcnt(8)
    v_exp_f32 v244, v180
    v_mfma_f32_16x16x32_bf16 a[84:87], a[212:215], v[196:199], a[84:87]
    s_add_u32 s56, s57, 57344
    ds_read_b128 a[136:139], v2 offset:2048
    v_cmp_gt_i32 s[46:47], 17, v6
    v_mfma_f32_16x16x32_bf16 a[88:91], a[212:215], v[200:203], a[88:91]
    v_exp_f32 v245, v181
    v_cmp_gt_i32 s[48:49], 18, v6
    v_mfma_f32_16x16x32_bf16 a[92:95], a[212:215], v[204:207], a[92:95]
    s_waitcnt lgkmcnt(3)
    v_exp_f32 v246, v182
    v_mfma_f32_16x16x32_bf16 a[96:99], a[216:219], v[192:195], a[96:99]
    s_add_u32 s62, s62, 1
    v_cmp_gt_i32 s[50:51], 19, v6
    v_cvt_pk_bf16_f32 v214, v244, v245
    v_mfma_f32_16x16x32_bf16 a[100:103], a[216:219], v[196:199], a[100:103]
    buffer_store_dwordx4 a[224:227], v229, s[8:11], s58 offen offset:0 sc1
    ds_read_b128 a[140:143], v2 offset:3072
    ds_read_b128 a[144:147], v2 offset:4096
    v_mfma_f32_16x16x32_bf16 a[104:107], a[216:219], v[200:203], a[104:107]
    v_exp_f32 v247, v183
    v_mfma_f32_16x16x32_bf16 a[108:111], a[216:219], v[204:207], a[108:111]
    v_cndmask_b32 v36, v9, v5, s[44:45]
    v_or3_b32 v57, v57, v213, v214
    v_mfma_f32_16x16x32_bf16 a[112:115], a[220:223], v[192:195], a[112:115]
    v_exp_f32 v232, v168
    v_mfma_f32_16x16x32_bf16 a[116:119], a[220:223], v[196:199], a[116:119]
    v_cndmask_b32 v37, v9, v5, s[46:47]
    v_cvt_pk_bf16_f32 v215, v246, v247
    v_cndmask_b32 v38, v9, v5, s[48:49]
    v_cndmask_b32 v39, v9, v5, s[50:51]
    v_mfma_f32_16x16x32_bf16 a[120:123], a[220:223], v[200:203], a[120:123]
    v_exp_f32 v233, v169
    v_mfma_f32_16x16x32_bf16 a[124:127], a[220:223], v[204:207], a[124:127]
    s_waitcnt lgkmcnt(3)
    buffer_store_dwordx4 a[228:231], v229, s[8:11], s58 offen offset:256 sc1
    v_exp_f32 v234, v170
    v_mfma_f32_16x16x32_bf16 v[132:135], a[128:131], v[80:83], v[20:23]
    ds_read_b128 a[148:151], v2 offset:5120
    v_cvt_pk_bf16_f32 v216, v232, v233
    v_mfma_f32_16x16x32_bf16 v[132:135], a[132:135], v[84:87], v[132:135]
    s_waitcnt lgkmcnt(2)
    v_exp_f32 v235, v171
    v_mfma_f32_16x16x32_bf16 v[132:135], a[136:139], v[88:91], v[132:135]
    s_lshl_b32 s58, s61, 17
    ds_read_b128 a[152:155], v2 offset:6144
    v_or3_b32 v57, v57, v215, v216
    v_mfma_f32_16x16x32_bf16 v[132:135], a[140:143], v[92:95], v[132:135]
    s_add_u32 s36, s36, 32
    v_exp_f32 v236, v184
    v_mfma_f32_16x16x32_bf16 v[136:139], a[128:131], v[96:99], v[24:27]
    s_lshl_b32 s60, s60, 10
    v_cvt_pk_bf16_f32 v217, v234, v235
    v_exp_f32 v237, v185
    v_mfma_f32_16x16x32_bf16 v[136:139], a[132:135], v[100:103], v[136:139]
    buffer_load_dwordx4 a[224:227], v228, s[12:15], s57 offen
    ds_read_b128 a[156:159], v2 offset:7168
    v_mfma_f32_16x16x32_bf16 v[136:139], a[136:139], v[104:107], v[136:139]
    s_add_u32 s52, s52, 8192
    v_exp_f32 v238, v186
    v_mfma_f32_16x16x32_bf16 v[136:139], a[140:143], v[108:111], v[136:139]
    s_add_u32 s58, s58, s60
    v_cvt_pk_bf16_f32 v218, v236, v237
    v_or3_b32 v57, v57, v217, v218
    v_mfma_f32_16x16x32_bf16 v[140:143], a[128:131], v[112:115], v[28:31]
    s_and_b32 s52, s52, 0xffff
    v_exp_f32 v239, v187
    v_mfma_f32_16x16x32_bf16 v[140:143], a[132:135], v[116:119], v[140:143]
    v_add_u32 v2, s52, v1
    v_cvt_pk_bf16_f32 v219, v238, v239
    v_mfma_f32_16x16x32_bf16 v[140:143], a[136:139], v[120:123], v[140:143]
    s_mov_b32 s10, s59
    v_exp_f32 v240, v172
    v_mfma_f32_16x16x32_bf16 v[140:143], a[140:143], v[124:127], v[140:143]
    s_waitcnt lgkmcnt(2)
    ds_read_b128 a[192:195], v3 offset:0
    v_exp_f32 v241, v173
    v_mfma_f32_16x16x32_bf16 v[148:151], a[144:147], v[80:83], v[36:39]
    buffer_load_dwordx4 a[228:231], v228, s[12:15], s56 offen
    ds_read_b128 a[196:199], v3 offset:1024
    v_mfma_f32_16x16x32_bf16 v[148:151], a[148:151], v[84:87], v[148:151]
    s_waitcnt lgkmcnt(2)
    v_exp_f32 v242, v174
    v_mfma_f32_16x16x32_bf16 v[148:151], a[152:155], v[88:91], v[148:151]
    v_cvt_pk_bf16_f32 v220, v240, v241
    v_or3_b32 v57, v57, v219, v220
    v_mfma_f32_16x16x32_bf16 v[148:151], a[156:159], v[92:95], v[148:151]
    v_exp_f32 v243, v175
    v_mfma_f32_16x16x32_bf16 v[152:155], a[144:147], v[96:99], v[40:43]
    v_exp_f32 v244, v188
    v_mfma_f32_16x16x32_bf16 v[152:155], a[148:151], v[100:103], v[152:155]
    v_cvt_pk_bf16_f32 v221, v242, v243
    v_exp_f32 v245, v189
    v_mfma_f32_16x16x32_bf16 v[152:155], a[152:155], v[104:107], v[152:155]
    buffer_load_dword v7, v230, s[24:27], s54 offen
    ds_read_b128 a[200:203], v3 offset:2048
    v_mfma_f32_16x16x32_bf16 v[152:155], a[156:159], v[108:111], v[152:155]
    v_exp_f32 v246, v190
    v_mfma_f32_16x16x32_bf16 v[156:159], a[144:147], v[112:115], v[44:47]
    s_add_u32 s54, s54, 4096
    v_cvt_pk_bf16_f32 v222, v244, v245
    v_or3_b32 v57, v57, v221, v222
    v_mfma_f32_16x16x32_bf16 v[156:159], a[148:151], v[116:119], v[156:159]
    v_exp_f32 v247, v191
    v_mfma_f32_16x16x32_bf16 v[156:159], a[152:155], v[120:123], v[156:159]
    ds_read_b128 a[204:207], v3 offset:3072
    v_cvt_pk_bf16_f32 v223, v246, v247
    v_bitop3_b32 v57, v57, v223, s37 bitop3:0xa8
    v_mfma_f32_16x16x32_bf16 v[156:159], a[156:159], v[124:127], v[156:159]
    v_cmp_ne_u32 vcc, 0, v57
    s_cbranch_vccnz k2_tramp_98
k2_ret_99:
    v_mfma_f32_16x16x32_bf16 v[12:15], v[60:63], v[208:211], v[12:15]
    v_exp_f32 v232, v132
    v_mfma_f32_16x16x32_bf16 v[48:51], v[60:63], v[212:215], v[48:51]
    s_mov_b32 m0, s35
    ds_read_b128 a[208:211], v3 offset:4096
    v_mfma_f32_16x16x32_bf16 v[248:251], v[60:63], v[216:219], v[248:251]
    s_add_u32 s53, s53, 8192
    buffer_load_dwordx4 v1, s[20:23], s33 offen offset:0 sc1 lds
    v_mfma_f32_16x16x32_bf16 v[252:255], v[60:63], v[220:223], v[252:255]
    s_waitcnt lgkmcnt(3)
    v_exp_f32 v233, v133
    v_mfma_f32_16x16x32_bf16 a[0:3], a[192:195], v[208:211], a[0:3]
    s_sub_u32 s40, s36, s38
    s_sub_u32 s40, s40, 64
    v_exp_f32 v234, v134
    v_mfma_f32_16x16x32_bf16 a[4:7], a[192:195], v[212:215], a[4:7]
    s_and_b32 s53, s53, 0xffff
    ds_read_b128 a[212:215], v3 offset:5120
    v_subrev_u32 v6, s40, v4
    v_mfma_f32_16x16x32_bf16 a[8:11], a[192:195], v[216:219], a[8:11]
    v_cvt_pk_bf16_f32 v196, v232, v233
    v_cmp_gt_i32 s[44:45], 0, v6
    v_mfma_f32_16x16x32_bf16 a[12:15], a[192:195], v[220:223], a[12:15]
    v_exp_f32 v235, v135
    v_mfma_f32_16x16x32_bf16 a[16:19], a[196:199], v[208:211], a[16:19]
    ds_read_b128 a[216:219], v3 offset:6144
    v_cmp_gt_i32 s[46:47], 1, v6
    v_mfma_f32_16x16x32_bf16 a[20:23], a[196:199], v[212:215], a[20:23]
    v_exp_f32 v236, v148
    v_mfma_f32_16x16x32_bf16 a[24:27], a[196:199], v[216:219], a[24:27]
    v_cvt_pk_bf16_f32 v197, v234, v235
    v_cmp_gt_i32 s[48:49], 2, v6
    v_mfma_f32_16x16x32_bf16 a[28:31], a[196:199], v[220:223], a[28:31]
    s_waitcnt lgkmcnt(3)
    v_cmp_gt_i32 s[50:51], 3, v6
    v_mfma_f32_16x16x32_bf16 a[32:35], a[200:203], v[208:211], a[32:35]
    v_exp_f32 v237, v149
    v_mfma_f32_16x16x32_bf16 a[36:39], a[200:203], v[212:215], a[36:39]
    s_add_u32 s35, s35, 0x4000
    ds_read_b128 a[220:223], v3 offset:7168
    v_cndmask_b32 v20, v9, v5, s[44:45]
    v_mfma_f32_16x16x32_bf16 a[40:43], a[200:203], v[216:219], a[40:43]
    v_exp_f32 v238, v150
    v_mfma_f32_16x16x32_bf16 a[44:47], a[200:203], v[220:223], a[44:47]
    v_cvt_pk_bf16_f32 v198, v236, v237
    v_cndmask_b32 v21, v9, v5, s[46:47]
    v_mfma_f32_16x16x32_bf16 a[48:51], a[204:207], v[208:211], a[48:51]
    buffer_load_dwordx4 v1, s[20:23], s33 offen offset:1024 sc1 lds
    ds_read_b128 a[128:131], v2 offset:0
    v_mfma_f32_16x16x32_bf16 a[52:55], a[204:207], v[212:215], a[52:55]
    v_add_u32 v3, s53, v56
    v_cndmask_b32 v22, v9, v5, s[48:49]
    v_mfma_f32_16x16x32_bf16 a[56:59], a[204:207], v[216:219], a[56:59]
    v_exp_f32 v239, v151
    v_mfma_f32_16x16x32_bf16 a[60:63], a[204:207], v[220:223], a[60:63]
    s_waitcnt lgkmcnt(3)
    v_or3_b32 v57, v196, v197, v198
    v_cndmask_b32 v23, v9, v5, s[50:51]
    v_mfma_f32_16x16x32_bf16 a[64:67], a[208:211], v[208:211], a[64:67]
    v_exp_f32 v240, v136
    v_mfma_f32_16x16x32_bf16 a[68:71], a[208:211], v[212:215], a[68:71]
    v_cvt_pk_bf16_f32 v199, v238, v239
    v_cmp_gt_i32 s[44:45], 16, v6
    v_mfma_f32_16x16x32_bf16 a[72:75], a[208:211], v[216:219], a[72:75]
    ds_read_b128 a[132:135], v2 offset:1024
    v_cmp_gt_i32 s[46:47], 17, v6
    v_mfma_f32_16x16x32_bf16 a[76:79], a[208:211], v[220:223], a[76:79]
    v_exp_f32 v241, v137
    v_mfma_f32_16x16x32_bf16 a[80:83], a[212:215], v[208:211], a[80:83]
    ds_read_b128 a[136:139], v2 offset:2048
    v_cmp_gt_i32 s[48:49], 18, v6
    v_mfma_f32_16x16x32_bf16 a[84:87], a[212:215], v[212:215], a[84:87]
    v_exp_f32 v242, v138
    v_mfma_f32_16x16x32_bf16 a[88:91], a[212:215], v[216:219], a[88:91]
    v_cvt_pk_bf16_f32 v200, v240, v241
    v_cmp_gt_i32 s[50:51], 19, v6
    v_mfma_f32_16x16x32_bf16 a[92:95], a[212:215], v[220:223], a[92:95]
    s_waitcnt lgkmcnt(3)
    v_exp_f32 v243, v139
    v_mfma_f32_16x16x32_bf16 a[96:99], a[216:219], v[208:211], a[96:99]
    s_and_b32 s35, s35, 0xffff
    ds_read_b128 a[140:143], v2 offset:3072
    v_or3_b32 v57, v57, v199, v200
    v_mfma_f32_16x16x32_bf16 a[100:103], a[216:219], v[212:215], a[100:103]
    v_cndmask_b32 v36, v9, v5, s[44:45]
    v_cndmask_b32 v37, v9, v5, s[46:47]
    v_mfma_f32_16x16x32_bf16 a[104:107], a[216:219], v[216:219], a[104:107]
    v_exp_f32 v244, v152
    v_mfma_f32_16x16x32_bf16 a[108:111], a[216:219], v[220:223], a[108:111]
    ds_read_b128 a[144:147], v2 offset:4096
    v_cvt_pk_bf16_f32 v201, v242, v243
    v_mfma_f32_16x16x32_bf16 a[112:115], a[220:223], v[208:211], a[112:115]
    buffer_load_dwordx4 v1, s[20:23], s33 offen offset:2048 sc1 lds
    ds_read_b128 a[148:151], v2 offset:5120
    v_mfma_f32_16x16x32_bf16 a[116:119], a[220:223], v[212:215], a[116:119]
    v_cndmask_b32 v38, v9, v5, s[48:49]
    v_cndmask_b32 v39, v9, v5, s[50:51]
    v_mfma_f32_16x16x32_bf16 a[120:123], a[220:223], v[216:219], a[120:123]
    s_or_b32 s35, s35, 0x10000
    v_exp_f32 v245, v153
    v_mfma_f32_16x16x32_bf16 a[124:127], a[220:223], v[220:223], a[124:127]
    s_waitcnt lgkmcnt(4)
    v_exp_f32 v246, v154
    v_mfma_f32_16x16x32_bf16 v[164:167], a[128:131], v[80:83], v[20:23]
    ds_read_b128 a[152:155], v2 offset:6144
    v_cvt_pk_bf16_f32 v202, v244, v245
    v_mfma_f32_16x16x32_bf16 v[164:167], a[132:135], v[84:87], v[164:167]
    s_waitcnt lgkmcnt(3)
    v_exp_f32 v247, v155
    v_mfma_f32_16x16x32_bf16 v[164:167], a[136:139], v[88:91], v[164:167]
    v_or3_b32 v57, v57, v201, v202
    v_cvt_pk_bf16_f32 v203, v246, v247
    v_mfma_f32_16x16x32_bf16 v[164:167], a[140:143], v[92:95], v[164:167]
    s_add_u32 s36, s36, 32
    v_exp_f32 v232, v140
    v_mfma_f32_16x16x32_bf16 v[168:171], a[128:131], v[96:99], v[24:27]
    ds_read_b128 a[156:159], v2 offset:7168
    v_mfma_f32_16x16x32_bf16 v[168:171], a[132:135], v[100:103], v[168:171]
    v_exp_f32 v233, v141
    v_mfma_f32_16x16x32_bf16 v[168:171], a[136:139], v[104:107], v[168:171]
    s_add_u32 s52, s52, 8192
    v_exp_f32 v234, v142
    v_mfma_f32_16x16x32_bf16 v[168:171], a[140:143], v[108:111], v[168:171]
    ds_read_b128 a[192:195], v3 offset:0
    v_cvt_pk_bf16_f32 v204, v232, v233
    v_mfma_f32_16x16x32_bf16 v[172:175], a[128:131], v[112:115], v[28:31]
    s_and_b32 s52, s52, 0xffff
    v_add_u32 v2, s52, v1
    v_or3_b32 v57, v57, v203, v204
    v_mfma_f32_16x16x32_bf16 v[172:175], a[132:135], v[116:119], v[172:175]
    buffer_load_dwordx4 v1, s[20:23], s33 offen offset:3072 sc1 lds
    s_add_u32 s33, s33, 0x80000
    v_mfma_f32_16x16x32_bf16 v[172:175], a[136:139], v[120:123], v[172:175]
    v_exp_f32 v235, v143
    v_mfma_f32_16x16x32_bf16 v[172:175], a[140:143], v[124:127], v[172:175]
    s_waitcnt lgkmcnt(3)
    v_exp_f32 v236, v156
    v_mfma_f32_16x16x32_bf16 v[180:183], a[144:147], v[80:83], v[36:39]
    ds_read_b128 a[196:199], v3 offset:1024
    v_cvt_pk_bf16_f32 v205, v234, v235
    v_mfma_f32_16x16x32_bf16 v[180:183], a[148:151], v[84:87], v[180:183]
    s_waitcnt lgkmcnt(2)
    v_exp_f32 v237, v157
    v_mfma_f32_16x16x32_bf16 v[180:183], a[152:155], v[88:91], v[180:183]
    ds_read_b128 a[200:203], v3 offset:2048
    v_mfma_f32_16x16x32_bf16 v[180:183], a[156:159], v[92:95], v[180:183]
    v_exp_f32 v238, v158
    v_mfma_f32_16x16x32_bf16 v[184:187], a[144:147], v[96:99], v[40:43]
    v_cvt_pk_bf16_f32 v206, v236, v237
    v_mfma_f32_16x16x32_bf16 v[184:187], a[148:151], v[100:103], v[184:187]
    v_exp_f32 v239, v159
    v_mfma_f32_16x16x32_bf16 v[184:187], a[152:155], v[104:107], v[184:187]
    ds_read_b128 a[204:207], v3 offset:3072
    v_or3_b32 v57, v57, v205, v206
    v_mfma_f32_16x16x32_bf16 v[184:187], a[156:159], v[108:111], v[184:187]
    v_cvt_pk_bf16_f32 v207, v238, v239
    v_mfma_f32_16x16x32_bf16 v[188:191], a[144:147], v[112:115], v[44:47]
    v_mfma_f32_16x16x32_bf16 v[188:191], a[148:151], v[116:119], v[188:191]
    v_bitop3_b32 v57, v57, v207, s37 bitop3:0xa8
    v_cmp_ne_u32 vcc, 0, v57
    v_mfma_f32_16x16x32_bf16 v[188:191], a[152:155], v[120:123], v[188:191]
    v_mfma_f32_16x16x32_bf16 v[188:191], a[156:159], v[124:127], v[188:191]
    s_waitcnt vmcnt(13)
    s_barrier
    s_cbranch_vccnz k2_tramp_100
k2_ret_101:
    v_mfma_f32_16x16x32_bf16 v[48:51], v[60:63], v[196:199], v[48:51]
    ds_read_b128 a[208:211], v3 offset:4096
    ds_read_b128 a[212:215], v3 offset:5120
    v_mfma_f32_16x16x32_bf16 v[248:251], v[60:63], v[200:203], v[248:251]
    s_mov_b32 m0, s34
    v_exp_f32 v232, v164
    v_mfma_f32_16x16x32_bf16 v[252:255], v[60:63], v[204:207], v[252:255]
    s_waitcnt lgkmcnt(4)
    buffer_load_dwordx4 v1, s[16:19], s32 offen offset:0 sc1 lds
    ds_read_b128 a[216:219], v3 offset:6144
    v_mfma_f32_16x16x32_bf16 a[4:7], a[192:195], v[196:199], a[4:7]
    s_add_u32 s53, s53, 8192
    v_exp_f32 v233, v165
    v_mfma_f32_16x16x32_bf16 a[8:11], a[192:195], v[200:203], a[8:11]
    s_and_b32 s53, s53, 0xffff
    v_mov_b32 v16, v10
    v_mov_b32 v17, v10
    v_mfma_f32_16x16x32_bf16 a[12:15], a[192:195], v[204:207], a[12:15]
    s_add_u32 s34, s34, 0x4000
    v_exp_f32 v234, v166
    v_mfma_f32_16x16x32_bf16 a[20:23], a[196:199], v[196:199], a[20:23]
    ds_read_b128 a[220:223], v3 offset:7168
    v_cvt_pk_bf16_f32 v212, v232, v233
    v_mfma_f32_16x16x32_bf16 a[24:27], a[196:199], v[200:203], a[24:27]
    v_mov_b32 v18, v10
    v_mov_b32 v19, v10
    v_mfma_f32_16x16x32_bf16 a[28:31], a[196:199], v[204:207], a[28:31]
    s_waitcnt lgkmcnt(4)
    v_exp_f32 v235, v167
    v_mfma_f32_16x16x32_bf16 a[36:39], a[200:203], v[196:199], a[36:39]
    buffer_load_dwordx4 v1, s[16:19], s32 offen offset:1024 sc1 lds
    ds_read_b128 a[128:131], v2 offset:0
    v_mfma_f32_16x16x32_bf16 a[40:43], a[200:203], v[200:203], a[40:43]
    v_mov_b32 v20, v11
    v_add_u32 v3, s53, v56
    v_mfma_f32_16x16x32_bf16 a[44:47], a[200:203], v[204:207], a[44:47]
    s_and_b32 s34, s34, 0xffff
    v_mov_b32 v21, v11
    v_mov_b32 v22, v11
    v_mfma_f32_16x16x32_bf16 a[52:55], a[204:207], v[196:199], a[52:55]
    v_exp_f32 v236, v180
    v_mfma_f32_16x16x32_bf16 a[56:59], a[204:207], v[200:203], a[56:59]
    ds_read_b128 a[132:135], v2 offset:1024
    v_cvt_pk_bf16_f32 v213, v234, v235
    v_mfma_f32_16x16x32_bf16 a[60:63], a[204:207], v[204:207], a[60:63]
    s_waitcnt lgkmcnt(4)
    v_mov_b32 v23, v11
    v_mov_b32 v32, v10
    v_mfma_f32_16x16x32_bf16 a[68:71], a[208:211], v[196:199], a[68:71]
    v_exp_f32 v237, v181
    v_mfma_f32_16x16x32_bf16 a[72:75], a[208:211], v[200:203], a[72:75]
    ds_read_b128 a[136:139], v2 offset:2048
    v_mov_b32 v33, v10
    v_mfma_f32_16x16x32_bf16 a[76:79], a[208:211], v[204:207], a[76:79]
    buffer_load_dwordx4 v1, s[16:19], s32 offen offset:2048 sc1 lds
    v_mov_b32 v34, v10
    v_mfma_f32_16x16x32_bf16 a[84:87], a[212:215], v[196:199], a[84:87]
    v_exp_f32 v238, v182
    v_mfma_f32_16x16x32_bf16 a[88:91], a[212:215], v[200:203], a[88:91]
    ds_read_b128 a[140:143], v2 offset:3072
    v_cvt_pk_bf16_f32 v214, v236, v237
    v_mfma_f32_16x16x32_bf16 a[92:95], a[212:215], v[204:207], a[92:95]
    s_waitcnt lgkmcnt(4)
    v_mov_b32 v35, v10
    v_mov_b32 v36, v11
    v_mfma_f32_16x16x32_bf16 a[100:103], a[216:219], v[196:199], a[100:103]
    ds_read_b128 a[144:147], v2 offset:4096
    v_exp_f32 v239, v183
    v_mfma_f32_16x16x32_bf16 a[104:107], a[216:219], v[200:203], a[104:107]
    v_mov_b32 v37, v11
    v_or3_b32 v57, v212, v213, v214
    v_mov_b32 v38, v11
    v_mov_b32 v39, v11
    v_mfma_f32_16x16x32_bf16 a[108:111], a[216:219], v[204:207], a[108:111]
    buffer_load_dwordx4 v1, s[16:19], s32 offen offset:3072 sc1 lds
    ds_read_b128 a[148:151], v2 offset:5120
    v_mfma_f32_16x16x32_bf16 a[116:119], a[220:223], v[196:199], a[116:119]
    s_add_u32 s32, s32, 0x80000
    s_cmp_ge_u32 s36, s43
    s_cbranch_scc1 k2_prep_102
k2_prepret_103:
    v_mfma_f32_16x16x32_bf16 a[120:123], a[220:223], v[200:203], a[120:123]
    s_waitcnt vmcnt(8)
    v_exp_f32 v240, v168
    v_mfma_f32_16x16x32_bf16 a[124:127], a[220:223], v[204:207], a[124:127]
    s_waitcnt lgkmcnt(4)
    ds_read_b128 a[152:155], v2 offset:6144
    v_cvt_pk_bf16_f32 v215, v238, v239
    v_mfma_f32_16x16x32_bf16 v[128:131], a[128:131], v[96:99], v[16:19]
    v_exp_f32 v241, v169
    v_mfma_f32_16x16x32_bf16 v[128:131], a[132:135], v[100:103], v[128:131]
    s_waitcnt lgkmcnt(3)
    ds_read_b128 a[156:159], v2 offset:7168
    v_exp_f32 v242, v170
    v_mfma_f32_16x16x32_bf16 v[128:131], a[136:139], v[104:107], v[128:131]
    ds_read_b128 a[160:163], v2 offset:8192
    v_cvt_pk_bf16_f32 v216, v240, v241
    v_mfma_f32_16x16x32_bf16 v[128:131], a[140:143], v[108:111], v[128:131]
    s_add_u32 s36, s36, 64
    buffer_store_dwordx4 a[224:227], v229, s[8:11], s58 offen offset:0 sc1
    v_exp_f32 v243, v171
    v_mfma_f32_16x16x32_bf16 v[132:135], a[128:131], v[112:115], v[20:23]
    ds_read_b128 a[164:167], v2 offset:9216
    v_or3_b32 v57, v57, v215, v216
    v_mfma_f32_16x16x32_bf16 v[132:135], a[132:135], v[116:119], v[132:135]
    v_exp_f32 v244, v184
    v_mfma_f32_16x16x32_bf16 v[132:135], a[136:139], v[120:123], v[132:135]
    s_add_u32 s52, s52, 16384
    ds_read_b128 a[168:171], v2 offset:10240
    v_cvt_pk_bf16_f32 v217, v242, v243
    v_mfma_f32_16x16x32_bf16 v[132:135], a[140:143], v[124:127], v[132:135]
    s_waitcnt lgkmcnt(5)
    v_exp_f32 v245, v185
    v_mfma_f32_16x16x32_bf16 v[144:147], a[144:147], v[96:99], v[32:35]
    s_and_b32 s52, s52, 0xffff
    ds_read_b128 a[172:175], v2 offset:11264
    ds_read_b128 a[176:179], v2 offset:12288
    v_mfma_f32_16x16x32_bf16 v[144:147], a[148:151], v[100:103], v[144:147]
    s_waitcnt lgkmcnt(5)
    v_exp_f32 v246, v186
    v_mfma_f32_16x16x32_bf16 v[144:147], a[152:155], v[104:107], v[144:147]
    ds_read_b128 a[180:183], v2 offset:13312
    v_cvt_pk_bf16_f32 v218, v244, v245
    v_mfma_f32_16x16x32_bf16 v[144:147], a[156:159], v[108:111], v[144:147]
    v_exp_f32 v247, v187
    v_mfma_f32_16x16x32_bf16 v[148:151], a[144:147], v[112:115], v[36:39]
    ds_read_b128 a[184:187], v2 offset:14336
    v_or3_b32 v57, v57, v217, v218
    v_mfma_f32_16x16x32_bf16 v[148:151], a[148:151], v[116:119], v[148:151]
    v_exp_f32 v232, v172
    v_mfma_f32_16x16x32_bf16 v[148:151], a[152:155], v[120:123], v[148:151]
    ds_read_b128 a[188:191], v2 offset:15360
    v_cvt_pk_bf16_f32 v219, v246, v247
    v_mfma_f32_16x16x32_bf16 v[148:151], a[156:159], v[124:127], v[148:151]
    s_waitcnt lgkmcnt(6)
    v_exp_f32 v233, v173
    v_mfma_f32_16x16x32_bf16 v[136:139], a[160:163], v[96:99], v[24:27]
    buffer_store_dwordx4 a[228:231], v229, s[8:11], s58 offen offset:256 sc1
    ds_read_b128 a[192:195], v3 offset:0
    v_mfma_f32_16x16x32_bf16 v[136:139], a[164:167], v[100:103], v[136:139]
    s_waitcnt lgkmcnt(5)
    v_add_u32 v2, s52, v1
    v_cvt_pk_bf16_f32 v220, v232, v233
    v_mfma_f32_16x16x32_bf16 v[136:139], a[168:171], v[104:107], v[136:139]
    v_exp_f32 v234, v174
    v_mfma_f32_16x16x32_bf16 v[136:139], a[172:175], v[108:111], v[136:139]
    v_exp_f32 v235, v175
    v_mfma_f32_16x16x32_bf16 v[140:143], a[160:163], v[112:115], v[28:31]
    ds_read_b128 a[196:199], v3 offset:1024
    v_or3_b32 v57, v57, v219, v220
    v_mfma_f32_16x16x32_bf16 v[140:143], a[164:167], v[116:119], v[140:143]
    v_exp_f32 v236, v188
    v_mfma_f32_16x16x32_bf16 v[140:143], a[168:171], v[120:123], v[140:143]
    ds_read_b128 a[200:203], v3 offset:2048
    v_cvt_pk_bf16_f32 v221, v234, v235
    v_mfma_f32_16x16x32_bf16 v[140:143], a[172:175], v[124:127], v[140:143]
    s_waitcnt lgkmcnt(5)
    v_exp_f32 v237, v189
    v_mfma_f32_16x16x32_bf16 v[152:155], a[176:179], v[96:99], v[40:43]
    v_exp_f32 v238, v190
    v_mfma_f32_16x16x32_bf16 v[152:155], a[180:183], v[100:103], v[152:155]
    s_waitcnt lgkmcnt(3)
    v_cvt_pk_bf16_f32 v222, v236, v237
    v_or3_b32 v57, v57, v221, v222
    v_mfma_f32_16x16x32_bf16 v[152:155], a[184:187], v[104:107], v[152:155]
    v_exp_f32 v239, v191
    v_mfma_f32_16x16x32_bf16 v[152:155], a[188:191], v[108:111], v[152:155]
    ds_read_b128 a[204:207], v3 offset:3072
    v_cvt_pk_bf16_f32 v223, v238, v239
    v_mfma_f32_16x16x32_bf16 v[156:159], a[176:179], v[112:115], v[44:47]
    v_mfma_f32_16x16x32_bf16 v[156:159], a[180:183], v[116:119], v[156:159]
    v_bitop3_b32 v57, v57, v223, s37 bitop3:0xa8
    v_cmp_ne_u32 vcc, 0, v57
    v_mfma_f32_16x16x32_bf16 v[156:159], a[184:187], v[120:123], v[156:159]
    v_mfma_f32_16x16x32_bf16 v[156:159], a[188:191], v[124:127], v[156:159]
    s_cbranch_vccnz k2_tramp_104
k2_ret_105:
    v_mfma_f32_16x16x32_bf16 v[48:51], v[60:63], v[212:215], v[48:51]
    ds_read_b128 a[208:211], v3 offset:4096
    ds_read_b128 a[212:215], v3 offset:5120
    v_mfma_f32_16x16x32_bf16 v[248:251], v[60:63], v[216:219], v[248:251]
    s_mov_b32 m0, s35
    v_exp_f32 v232, v128
    v_mfma_f32_16x16x32_bf16 v[252:255], v[60:63], v[220:223], v[252:255]
    s_waitcnt lgkmcnt(4)
    ds_read_b128 a[216:219], v3 offset:6144
    v_exp_f32 v233, v129
    v_mfma_f32_16x16x32_bf16 a[4:7], a[192:195], v[212:215], a[4:7]
    s_add_u32 s53, s53, 8192
    buffer_load_dwordx4 v1, s[20:23], s33 offen offset:0 sc1 lds
    v_mfma_f32_16x16x32_bf16 a[8:11], a[192:195], v[216:219], a[8:11]
    s_and_b32 s53, s53, 0xffff
    v_exp_f32 v234, v130
    v_cvt_pk_bf16_f32 v192, v232, v233
    v_mfma_f32_16x16x32_bf16 a[12:15], a[192:195], v[220:223], a[12:15]
    ds_read_b128 a[220:223], v3 offset:7168
    v_mfma_f32_16x16x32_bf16 a[20:23], a[196:199], v[212:215], a[20:23]
    s_add_u32 s35, s35, 0x4000
    v_exp_f32 v235, v131
    v_mfma_f32_16x16x32_bf16 a[24:27], a[196:199], v[216:219], a[24:27]
    v_exp_f32 v236, v144
    v_cvt_pk_bf16_f32 v193, v234, v235
    v_mfma_f32_16x16x32_bf16 a[28:31], a[196:199], v[220:223], a[28:31]
    s_waitcnt lgkmcnt(4)
    buffer_load_dwordx4 v1, s[20:23], s33 offen offset:1024 sc1 lds
    ds_read_b128 a[128:131], v2 offset:0
    v_mfma_f32_16x16x32_bf16 a[36:39], a[200:203], v[212:215], a[36:39]
    v_add_u32 v3, s53, v56
    v_exp_f32 v237, v145
    v_mfma_f32_16x16x32_bf16 a[40:43], a[200:203], v[216:219], a[40:43]
    ds_read_b128 a[132:135], v2 offset:1024
    v_cvt_pk_bf16_f32 v194, v236, v237
    v_mfma_f32_16x16x32_bf16 a[44:47], a[200:203], v[220:223], a[44:47]
    ds_read_b128 a[136:139], v2 offset:2048
    v_exp_f32 v238, v146
    v_mfma_f32_16x16x32_bf16 a[52:55], a[204:207], v[212:215], a[52:55]
    s_and_b32 s35, s35, 0xffff
    v_exp_f32 v239, v147
    v_mfma_f32_16x16x32_bf16 a[56:59], a[204:207], v[216:219], a[56:59]
    ds_read_b128 a[140:143], v2 offset:3072
    v_or3_b32 v57, v192, v193, v194
    v_mfma_f32_16x16x32_bf16 a[60:63], a[204:207], v[220:223], a[60:63]
    s_waitcnt lgkmcnt(6)
    v_exp_f32 v240, v132
    v_mfma_f32_16x16x32_bf16 a[68:71], a[208:211], v[212:215], a[68:71]
    s_or_b32 s35, s35, 0x10000
    buffer_load_dwordx4 v1, s[20:23], s33 offen offset:2048 sc1 lds
    ds_read_b128 a[144:147], v2 offset:4096
    v_mfma_f32_16x16x32_bf16 a[72:75], a[208:211], v[216:219], a[72:75]
    v_cvt_pk_bf16_f32 v195, v238, v239
    v_exp_f32 v241, v133
    v_mfma_f32_16x16x32_bf16 a[76:79], a[208:211], v[220:223], a[76:79]
    v_exp_f32 v242, v134
    v_mfma_f32_16x16x32_bf16 a[84:87], a[212:215], v[212:215], a[84:87]
    ds_read_b128 a[148:151], v2 offset:5120
    v_cvt_pk_bf16_f32 v196, v240, v241
    v_mfma_f32_16x16x32_bf16 a[88:91], a[212:215], v[216:219], a[88:91]
    v_exp_f32 v243, v135
    v_mfma_f32_16x16x32_bf16 a[92:95], a[212:215], v[220:223], a[92:95]
    s_waitcnt lgkmcnt(6)
    ds_read_b128 a[152:155], v2 offset:6144
    v_or3_b32 v57, v57, v195, v196
    v_cvt_pk_bf16_f32 v197, v242, v243
    v_mfma_f32_16x16x32_bf16 a[100:103], a[216:219], v[212:215], a[100:103]
    buffer_load_dwordx4 v1, s[20:23], s33 offen offset:3072 sc1 lds
    ds_read_b128 a[156:159], v2 offset:7168
    v_mfma_f32_16x16x32_bf16 a[104:107], a[216:219], v[216:219], a[104:107]
    s_add_u32 s33, s33, 0x80000
    v_exp_f32 v244, v148
    v_mfma_f32_16x16x32_bf16 a[108:111], a[216:219], v[220:223], a[108:111]
    v_exp_f32 v245, v149
    v_mfma_f32_16x16x32_bf16 a[116:119], a[220:223], v[212:215], a[116:119]
    ds_read_b128 a[160:163], v2 offset:8192
    s_cmp_ge_u32 s36, s43
    s_cbranch_scc1 k2_prep_106
k2_prepret_107:
    v_mfma_f32_16x16x32_bf16 a[120:123], a[220:223], v[216:219], a[120:123]
    v_exp_f32 v246, v150
    v_mfma_f32_16x16x32_bf16 a[124:127], a[220:223], v[220:223], a[124:127]
    s_waitcnt lgkmcnt(7)
    ds_read_b128 a[164:167], v2 offset:9216
    v_cvt_pk_bf16_f32 v198, v244, v245
    v_mfma_f32_16x16x32_bf16 v[160:163], a[128:131], v[96:99], v[16:19]
    s_waitcnt vmcnt(12)
    s_barrier
    v_exp_f32 v247, v151
    v_mfma_f32_16x16x32_bf16 v[160:163], a[132:135], v[100:103], v[160:163]
    s_waitcnt lgkmcnt(6)
    v_or3_b32 v57, v57, v197, v198
    v_cvt_pk_bf16_f32 v199, v246, v247
    v_mfma_f32_16x16x32_bf16 v[160:163], a[136:139], v[104:107], v[160:163]
    s_mov_b32 m0, s34
    ds_read_b128 a[168:171], v2 offset:10240
    v_exp_f32 v232, v136
    v_mfma_f32_16x16x32_bf16 v[160:163], a[140:143], v[108:111], v[160:163]
    s_add_u32 s36, s36, 64
    buffer_load_dwordx4 v1, s[16:19], s32 offen offset:0 sc1 lds
    ds_read_b128 a[172:175], v2 offset:11264
    v_mfma_f32_16x16x32_bf16 v[164:167], a[128:131], v[112:115], v[20:23]
    v_exp_f32 v233, v137
    v_mfma_f32_16x16x32_bf16 v[164:167], a[132:135], v[116:119], v[164:167]
    v_exp_f32 v234, v138
    v_mfma_f32_16x16x32_bf16 v[164:167], a[136:139], v[120:123], v[164:167]
    s_add_u32 s52, s52, 16384
    ds_read_b128 a[176:179], v2 offset:12288
    v_cvt_pk_bf16_f32 v200, v232, v233
    v_mfma_f32_16x16x32_bf16 v[164:167], a[140:143], v[124:127], v[164:167]
    s_waitcnt lgkmcnt(7)
    v_exp_f32 v235, v139
    v_or3_b32 v57, v57, v199, v200
    v_mfma_f32_16x16x32_bf16 v[176:179], a[144:147], v[96:99], v[32:35]
    s_add_u32 s34, s34, 0x4000
    ds_read_b128 a[180:183], v2 offset:13312
    v_cvt_pk_bf16_f32 v201, v234, v235
    v_mfma_f32_16x16x32_bf16 v[176:179], a[148:151], v[100:103], v[176:179]
    s_waitcnt lgkmcnt(6)
    v_exp_f32 v236, v152
    v_mfma_f32_16x16x32_bf16 v[176:179], a[152:155], v[104:107], v[176:179]
    s_and_b32 s52, s52, 0xffff
    buffer_load_dwordx4 v1, s[16:19], s32 offen offset:1024 sc1 lds
    ds_read_b128 a[184:187], v2 offset:14336
    v_mfma_f32_16x16x32_bf16 v[176:179], a[156:159], v[108:111], v[176:179]
    ds_read_b128 a[188:191], v2 offset:15360
    v_exp_f32 v237, v153
    v_mfma_f32_16x16x32_bf16 v[180:183], a[144:147], v[112:115], v[36:39]
    v_exp_f32 v238, v154
    v_mfma_f32_16x16x32_bf16 v[180:183], a[148:151], v[116:119], v[180:183]
    v_cvt_pk_bf16_f32 v202, v236, v237
    v_or3_b32 v57, v57, v201, v202
    v_mfma_f32_16x16x32_bf16 v[180:183], a[152:155], v[120:123], v[180:183]
    s_and_b32 s34, s34, 0xffff
    v_exp_f32 v239, v155
    v_mfma_f32_16x16x32_bf16 v[180:183], a[156:159], v[124:127], v[180:183]
    s_waitcnt lgkmcnt(6)
    v_add_u32 v2, s52, v1
    v_cvt_pk_bf16_f32 v203, v238, v239
    v_mfma_f32_16x16x32_bf16 v[168:171], a[160:163], v[96:99], v[24:27]
    ds_read_b128 a[192:195], v3 offset:0
    v_exp_f32 v240, v140
    v_mfma_f32_16x16x32_bf16 v[168:171], a[164:167], v[100:103], v[168:171]
    s_waitcnt lgkmcnt(5)
    v_exp_f32 v241, v141
    v_mfma_f32_16x16x32_bf16 v[168:171], a[168:171], v[104:107], v[168:171]
    buffer_load_dwordx4 v1, s[16:19], s32 offen offset:2048 sc1 lds
    ds_read_b128 a[196:199], v3 offset:8192
    v_mfma_f32_16x16x32_bf16 v[168:171], a[172:175], v[108:111], v[168:171]
    v_exp_f32 v242, v142
    v_mfma_f32_16x16x32_bf16 v[172:175], a[160:163], v[112:115], v[28:31]
    ds_read_b128 a[200:203], v3 offset:1024
    v_cvt_pk_bf16_f32 v204, v240, v241
    v_or3_b32 v57, v57, v203, v204
    v_mfma_f32_16x16x32_bf16 v[172:175], a[164:167], v[116:119], v[172:175]
    v_exp_f32 v243, v143
    v_mfma_f32_16x16x32_bf16 v[172:175], a[168:171], v[120:123], v[172:175]
    ds_read_b128 a[204:207], v3 offset:9216
    v_cvt_pk_bf16_f32 v205, v242, v243
    v_mfma_f32_16x16x32_bf16 v[172:175], a[172:175], v[124:127], v[172:175]
    s_waitcnt lgkmcnt(6)
    v_exp_f32 v244, v156
    v_mfma_f32_16x16x32_bf16 v[184:187], a[176:179], v[96:99], v[40:43]
    v_exp_f32 v245, v157
    v_mfma_f32_16x16x32_bf16 v[184:187], a[180:183], v[100:103], v[184:187]
    s_waitcnt lgkmcnt(4)
    buffer_load_dwordx4 v1, s[16:19], s32 offen offset:3072 sc1 lds
    ds_read_b128 a[208:211], v3 offset:2048
    ds_read_b128 a[212:215], v3 offset:10240
    v_mfma_f32_16x16x32_bf16 v[184:187], a[184:187], v[104:107], v[184:187]
    s_add_u32 s32, s32, 0x80000
    v_exp_f32 v246, v158
    v_mfma_f32_16x16x32_bf16 v[184:187], a[188:191], v[108:111], v[184:187]
    v_cvt_pk_bf16_f32 v206, v244, v245
    v_or3_b32 v57, v57, v205, v206
    v_mfma_f32_16x16x32_bf16 v[188:191], a[176:179], v[112:115], v[44:47]
    v_exp_f32 v247, v159
    v_mfma_f32_16x16x32_bf16 v[188:191], a[180:183], v[116:119], v[188:191]
    ds_read_b128 a[216:219], v3 offset:3072
    ds_read_b128 a[220:223], v3 offset:11264
    v_cvt_pk_bf16_f32 v207, v246, v247
    v_mfma_f32_16x16x32_bf16 v[188:191], a[184:187], v[120:123], v[188:191]
    v_bitop3_b32 v57, v57, v207, s37 bitop3:0xa8
    v_cmp_ne_u32 vcc, 0, v57
    v_mfma_f32_16x16x32_bf16 v[188:191], a[188:191], v[124:127], v[188:191]
    s_cbranch_vccnz k2_tramp_108
k2_ret_109:
    s_load_dwordx2 s[4:5], s[0:1], 40
    s_add_u32 s24, s6, 0x3000000
    s_addc_u32 s25, s7, 0
    s_and_b32 s25, s25, 0xffff
    s_mov_b32 s26, 0x1000000
    s_mov_b32 s27, 0x00020000
    s_lshl_b32 s31, s28, 19
    s_lshl_b32 s44, s38, 6
    s_add_u32 s44, s44, s31
    s_add_u32 s45, s44, 131072
    s_add_u32 s46, s44, 262144
    s_add_u32 s47, s44, 393216
    s_add_u32 s48, s44, 4096
    s_add_u32 s49, s44, 135168
    s_add_u32 s50, s44, 266240
    s_add_u32 s51, s44, 397312
    v_mov_b32 v13, v12
    v_mov_b32 v49, v48
    s_nop 1
    v_permlane16_swap_b32 v12, v13
    v_permlane16_swap_b32 v48, v49
    s_nop 1
    v_add_f32 v12, v12, v13
    v_add_f32 v48, v48, v49
    v_mov_b32 v13, v12
    v_mov_b32 v49, v48
    s_nop 1
    v_permlane32_swap_b32 v12, v13
    v_permlane32_swap_b32 v48, v49
    s_nop 1
    v_add_f32 v12, v12, v13
    v_add_f32 v48, v48, v49
    v_rcp_f32 v13, v12
    v_rcp_f32 v49, v48
    v_rcp_f32 v12, v12
    v_rcp_f32 v48, v48
    s_nop 0
    v_accvgpr_read_b32 v68, a0
    v_accvgpr_read_b32 v69, a1
    v_accvgpr_read_b32 v70, a2
    v_accvgpr_read_b32 v71, a3
    v_accvgpr_read_b32 v72, a16
    v_accvgpr_read_b32 v73, a17
    v_accvgpr_read_b32 v74, a18
    v_accvgpr_read_b32 v75, a19
    v_pk_mul_f32 v[68:69], v[68:69], v[12:13]
    v_pk_mul_f32 v[70:71], v[70:71], v[12:13]
    v_pk_mul_f32 v[72:73], v[72:73], v[12:13]
    v_pk_mul_f32 v[74:75], v[74:75], v[12:13]
    v_cvt_pk_bf16_f32 v64, v68, v69
    v_cvt_pk_bf16_f32 v65, v70, v71
    v_cvt_pk_bf16_f32 v66, v72, v73
    v_cvt_pk_bf16_f32 v67, v74, v75
    buffer_store_dwordx4 v[64:67], v1, s[24:27], s44 offen sc1
    v_accvgpr_read_b32 v80, a32
    v_accvgpr_read_b32 v81, a33
    v_accvgpr_read_b32 v82, a34
    v_accvgpr_read_b32 v83, a35
    v_accvgpr_read_b32 v84, a48
    v_accvgpr_read_b32 v85, a49
    v_accvgpr_read_b32 v86, a50
    v_accvgpr_read_b32 v87, a51
    v_pk_mul_f32 v[80:81], v[80:81], v[12:13]
    v_pk_mul_f32 v[82:83], v[82:83], v[12:13]
    v_pk_mul_f32 v[84:85], v[84:85], v[12:13]
    v_pk_mul_f32 v[86:87], v[86:87], v[12:13]
    v_cvt_pk_bf16_f32 v76, v80, v81
    v_cvt_pk_bf16_f32 v77, v82, v83
    v_cvt_pk_bf16_f32 v78, v84, v85
    v_cvt_pk_bf16_f32 v79, v86, v87
    buffer_store_dwordx4 v[76:79], v1, s[24:27], s45 offen sc1
    v_accvgpr_read_b32 v68, a64
    v_accvgpr_read_b32 v69, a65
    v_accvgpr_read_b32 v70, a66
    v_accvgpr_read_b32 v71, a67
    v_accvgpr_read_b32 v72, a80
    v_accvgpr_read_b32 v73, a81
    v_accvgpr_read_b32 v74, a82
    v_accvgpr_read_b32 v75, a83
    v_pk_mul_f32 v[68:69], v[68:69], v[12:13]
    v_pk_mul_f32 v[70:71], v[70:71], v[12:13]
    v_pk_mul_f32 v[72:73], v[72:73], v[12:13]
    v_pk_mul_f32 v[74:75], v[74:75], v[12:13]
    v_cvt_pk_bf16_f32 v64, v68, v69
    v_cvt_pk_bf16_f32 v65, v70, v71
    v_cvt_pk_bf16_f32 v66, v72, v73
    v_cvt_pk_bf16_f32 v67, v74, v75
    buffer_store_dwordx4 v[64:67], v1, s[24:27], s46 offen sc1
    v_accvgpr_read_b32 v80, a96
    v_accvgpr_read_b32 v81, a97
    v_accvgpr_read_b32 v82, a98
    v_accvgpr_read_b32 v83, a99
    v_accvgpr_read_b32 v84, a112
    v_accvgpr_read_b32 v85, a113
    v_accvgpr_read_b32 v86, a114
    v_accvgpr_read_b32 v87, a115
    v_pk_mul_f32 v[80:81], v[80:81], v[12:13]
    v_pk_mul_f32 v[82:83], v[82:83], v[12:13]
    v_pk_mul_f32 v[84:85], v[84:85], v[12:13]
    v_pk_mul_f32 v[86:87], v[86:87], v[12:13]
    v_cvt_pk_bf16_f32 v76, v80, v81
    v_cvt_pk_bf16_f32 v77, v82, v83
    v_cvt_pk_bf16_f32 v78, v84, v85
    v_cvt_pk_bf16_f32 v79, v86, v87
    buffer_store_dwordx4 v[76:79], v1, s[24:27], s47 offen sc1
    v_accvgpr_read_b32 v68, a4
    v_accvgpr_read_b32 v69, a5
    v_accvgpr_read_b32 v70, a6
    v_accvgpr_read_b32 v71, a7
    v_accvgpr_read_b32 v72, a20
    v_accvgpr_read_b32 v73, a21
    v_accvgpr_read_b32 v74, a22
    v_accvgpr_read_b32 v75, a23
    v_pk_mul_f32 v[68:69], v[68:69], v[48:49]
    v_pk_mul_f32 v[70:71], v[70:71], v[48:49]
    v_pk_mul_f32 v[72:73], v[72:73], v[48:49]
    v_pk_mul_f32 v[74:75], v[74:75], v[48:49]
    v_cvt_pk_bf16_f32 v64, v68, v69
    v_cvt_pk_bf16_f32 v65, v70, v71
    v_cvt_pk_bf16_f32 v66, v72, v73
    v_cvt_pk_bf16_f32 v67, v74, v75
    buffer_store_dwordx4 v[64:67], v1, s[24:27], s48 offen sc1
    v_accvgpr_read_b32 v80, a36
    v_accvgpr_read_b32 v81, a37
    v_accvgpr_read_b32 v82, a38
    v_accvgpr_read_b32 v83, a39
    v_accvgpr_read_b32 v84, a52
    v_accvgpr_read_b32 v85, a53
    v_accvgpr_read_b32 v86, a54
    v_accvgpr_read_b32 v87, a55
    v_pk_mul_f32 v[80:81], v[80:81], v[48:49]
    v_pk_mul_f32 v[82:83], v[82:83], v[48:49]
    v_pk_mul_f32 v[84:85], v[84:85], v[48:49]
    v_pk_mul_f32 v[86:87], v[86:87], v[48:49]
    v_cvt_pk_bf16_f32 v76, v80, v81
    v_cvt_pk_bf16_f32 v77, v82, v83
    v_cvt_pk_bf16_f32 v78, v84, v85
    v_cvt_pk_bf16_f32 v79, v86, v87
    buffer_store_dwordx4 v[76:79], v1, s[24:27], s49 offen sc1
    v_accvgpr_read_b32 v68, a68
    v_accvgpr_read_b32 v69, a69
    v_accvgpr_read_b32 v70, a70
    v_accvgpr_read_b32 v71, a71
    v_accvgpr_read_b32 v72, a84
    v_accvgpr_read_b32 v73, a85
    v_accvgpr_read_b32 v74, a86
    v_accvgpr_read_b32 v75, a87
    v_pk_mul_f32 v[68:69], v[68:69], v[48:49]
    v_pk_mul_f32 v[70:71], v[70:71], v[48:49]
    v_pk_mul_f32 v[72:73], v[72:73], v[48:49]
    v_pk_mul_f32 v[74:75], v[74:75], v[48:49]
    v_cvt_pk_bf16_f32 v64, v68, v69
    v_cvt_pk_bf16_f32 v65, v70, v71
    v_cvt_pk_bf16_f32 v66, v72, v73
    v_cvt_pk_bf16_f32 v67, v74, v75
    buffer_store_dwordx4 v[64:67], v1, s[24:27], s50 offen sc1
    v_accvgpr_read_b32 v80, a100
    v_accvgpr_read_b32 v81, a101
    v_accvgpr_read_b32 v82, a102
    v_accvgpr_read_b32 v83, a103
    v_accvgpr_read_b32 v84, a116
    v_accvgpr_read_b32 v85, a117
    v_accvgpr_read_b32 v86, a118
    v_accvgpr_read_b32 v87, a119
    v_pk_mul_f32 v[80:81], v[80:81], v[48:49]
    v_pk_mul_f32 v[82:83], v[82:83], v[48:49]
    v_pk_mul_f32 v[84:85], v[84:85], v[48:49]
    v_pk_mul_f32 v[86:87], v[86:87], v[48:49]
    v_cvt_pk_bf16_f32 v76, v80, v81
    v_cvt_pk_bf16_f32 v77, v82, v83
    v_cvt_pk_bf16_f32 v78, v84, v85
    v_cvt_pk_bf16_f32 v79, v86, v87
    buffer_store_dwordx4 v[76:79], v1, s[24:27], s51 offen sc1
    s_nop 1
    s_lshr_b32 s31, s2, 3
    s_bfe_u32 s56, s2, 0x10002
    s_and_b32 s54, s2, 1
    s_and_b32 s55, s31, 7
    s_lshl_b32 s54, s54, 3
    s_add_u32 s54, s54, s55
    s_and_b32 s55, s2, 2
    s_lshl_b32 s55, s55, 1
    s_lshr_b32 s31, s31, 3
    s_add_u32 s55, s55, s31
    v_lshrrev_b32 v87, 4, v1
    v_lshrrev_b32 v72, 4, v87
    s_lshl_b32 s57, s54, 7
    s_lshl_b32 s31, s30, 5
    s_add_u32 s57, s57, s31
    s_lshl_b32 s31, s57, 6
    v_add_u32 v88, s31, v1
    v_add_u32 v89, 0x20000, v88
    v_bfe_u32 v84, v87, 1, 3
    v_xor_b32 v84, v84, v72
    v_and_b32 v85, 16, v1
    v_lshl_add_u32 v85, v72, 11, v85
    s_lshl_b32 s31, s30, 15
    s_lshl_b32 s58, s55, 8
    s_add_u32 s31, s31, s58
    v_add_u32 v85, s31, v85
    v_xor_b32 v86, 0, v84
    v_lshl_add_u32 v86, v86, 5, v85
    v_add_u32 v90, 0, v86
    v_xor_b32 v86, 4, v84
    v_lshl_add_u32 v86, v86, 5, v85
    v_add_u32 v91, 7168, v86
    v_xor_b32 v86, 0, v84
    v_lshl_add_u32 v86, v86, 5, v85
    v_add_u32 v92, 14336, v86
    v_xor_b32 v86, 4, v84
    v_lshl_add_u32 v86, v86, 5, v85
    v_add_u32 v93, 21504, v86
    v_and_b32 v84, 15, v87
    v_add_u32 v85, s57, v84
    v_lshlrev_b32 v77, 2, v85
    v_lshl_add_u32 v77, v72, 13, v77
    s_lshl_b32 s31, s56, 7
    s_add_u32 s58, s58, s31
    v_lshl_add_u32 v80, v72, 3, s58
    v_lshl_add_u32 v78, v85, 11, v80
    v_add_u32 v79, 0x8000, v78
    v_lshrrev_b32 v85, 2, v84
    v_lshl_add_u32 v85, v72, 2, v85
    v_and_b32 v84, 7, v85
    s_lshl_b32 s31, s56, 2
    v_xor_b32 v84, s31, v84
    v_lshlrev_b32 v85, 8, v85
    v_and_b32 v86, 3, v87
    v_lshl_add_u32 v85, v86, 3, v85
    s_add_u32 s31, s2, 1
    s_and_b32 s31, s31, 3
    v_add_u32 v73, s31, v86
    v_and_b32 v73, 3, v73
    v_lshlrev_b32 v73, 7, v73
    v_xor_b32 v86, 0, v84
    v_lshl_add_u32 v64, v86, 5, v85
    v_xor_b32 v86, 1, v84
    v_lshl_add_u32 v65, v86, 5, v85
    v_xor_b32 v86, 2, v84
    v_lshl_add_u32 v66, v86, 5, v85
    v_xor_b32 v86, 3, v84
    v_lshl_add_u32 v67, v86, 5, v85
    v_xor_b32 v86, 4, v84
    v_lshl_add_u32 v68, v86, 5, v85
    v_xor_b32 v86, 5, v84
    v_lshl_add_u32 v69, v86, 5, v85
    v_xor_b32 v86, 6, v84
    v_lshl_add_u32 v70, v86, 5, v85
    v_xor_b32 v86, 7, v84
    v_lshl_add_u32 v71, v86, 5, v85
    s_lshl_b32 s61, s31, 20
    s_lshl_b32 s62, s31, 21
    s_lshl_b32 s60, s30, 12
    s_lshl_b32 s59, s54, 10
    s_lshl_b32 s31, s56, 9
    s_add_u32 s59, s59, s31
    s_lshr_b32 s31, s28, 2
    s_lshl_b32 s31, s31, 7
    s_lshl_b32 s57, s29, 10
    s_sub_u32 s58, 0x3c00, s57
    s_add_u32 s57, s57, s31
    s_add_u32 s58, s58, s31
    v_mov_b32 v75, 0
    v_mov_b32 v76, 1
    s_lshl_b32 s31, s56, 23
    s_add_u32 s31, s31, 0x3000000
    s_add_u32 s8, s6, s31
    s_addc_u32 s9, s7, 0
    s_and_b32 s9, s9, 0xffff
    s_mov_b32 s10, 0x800000
    s_lshl_b32 s31, s56, 22
    s_waitcnt lgkmcnt(0)
    s_add_u32 s12, s4, s31
    s_addc_u32 s13, s5, 0
    s_and_b32 s13, s13, 0xffff
    s_mov_b32 s14, 0x400000
    s_load_dwordx2 s[4:5], s[0:1], 80
    v_mov_b32 v12, -1
    v_mov_b32 v13, -1
    v_mov_b32 v14, -1
    v_mov_b32 v15, -1
    s_waitcnt lgkmcnt(0)
    s_mov_b32 s26, -1
    s_lshl_b32 s31, s2, 14
    s_add_u32 s31, s31, s60
    s_add_u32 s40, s31, 0x2000000
    buffer_store_dwordx4 v[12:15], v1, s[24:27], s40 offen offset:0 sc1
    buffer_store_dwordx4 v[12:15], v1, s[24:27], s40 offen offset:1024 sc1
    buffer_store_dwordx4 v[12:15], v1, s[24:27], s40 offen offset:2048 sc1
    buffer_store_dwordx4 v[12:15], v1, s[24:27], s40 offen offset:3072 sc1
    s_lshr_b32 s31, s31, 1
    s_add_u32 s40, s31, 0x1900000
    buffer_store_dwordx4 v[12:15], v1, s[24:27], s40 offen offset:0 sc1
    buffer_store_dwordx4 v[12:15], v1, s[24:27], s40 offen offset:1024 sc1
    s_mov_b32 s26, 0x1000000
    s_and_b32 s31, s2, 7
    s_mul_i32 s31, s31, 28
    s_lshr_b32 s40, s2, 3
    s_add_u32 s31, s31, s40
    s_lshl_b32 s31, s31, 15
    s_lshl_b32 s40, s30, 13
    s_add_u32 s31, s31, s40
    s_mov_b32 s44, s4
    s_mov_b32 s47, 0x00020000
    s_and_b32 s45, s5, 0xffff
    s_cmp_ge_u32 s2, 224
    s_cselect_b32 s46, 0, 7340032
    s_add_u32 m0, s40, 131072
    s_nop 0
    buffer_load_dwordx4 v1, s[44:47], s31 offen offset:0 lds
    buffer_load_dwordx4 v1, s[44:47], s31 offen offset:1024 lds
    buffer_load_dwordx4 v1, s[44:47], s31 offen offset:2048 lds
    buffer_load_dwordx4 v1, s[44:47], s31 offen offset:3072 lds
    s_add_u32 s31, s31, 4096
    s_add_u32 m0, s40, 135168
    s_nop 0
    buffer_load_dwordx4 v1, s[44:47], s31 offen offset:0 lds
    buffer_load_dwordx4 v1, s[44:47], s31 offen offset:1024 lds
    buffer_load_dwordx4 v1, s[44:47], s31 offen offset:2048 lds
    buffer_load_dwordx4 v1, s[44:47], s31 offen offset:3072 lds
    s_add_u32 s31, s31, 4096
    s_lshl_b32 s63, s29, 1
    s_sub_u32 s63, 13, s63
    s_cbranch_scc1 k2_sdone_111
k2_sloop_110:
    v_mfma_f32_16x16x32_bf16 v[248:251], v[60:63], v[192:195], v[248:251]
    v_exp_f32 v232, v160
    v_mfma_f32_16x16x32_bf16 v[248:251], v[60:63], v[200:203], v[248:251]
    s_mov_b32 m0, s35
    ds_read_b128 a[224:227], v3 offset:4096
    v_mfma_f32_16x16x32_bf16 v[252:255], v[60:63], v[196:199], v[252:255]
    s_add_u32 s53, s53, 16384
    buffer_load_dwordx4 v1, s[20:23], s33 offen offset:0 sc1 lds
    ds_read_b128 a[228:231], v3 offset:12288
    v_mfma_f32_16x16x32_bf16 v[252:255], v[60:63], v[204:207], v[252:255]
    s_waitcnt lgkmcnt(8)
    v_exp_f32 v233, v161
    v_mfma_f32_16x16x32_bf16 a[8:11], a[192:195], v[192:195], a[8:11]
    s_and_b32 s53, s53, 0xffff
    v_exp_f32 v234, v162
    v_mfma_f32_16x16x32_bf16 a[8:11], a[196:199], v[200:203], a[8:11]
    ds_read_b128 a[232:235], v3 offset:5120
    v_cvt_pk_bf16_f32 v208, v232, v233
    v_mfma_f32_16x16x32_bf16 a[12:15], a[192:195], v[196:199], a[12:15]
    v_exp_f32 v235, v163
    v_mfma_f32_16x16x32_bf16 a[12:15], a[196:199], v[204:207], a[12:15]
    s_waitcnt lgkmcnt(7)
    ds_read_b128 a[236:239], v3 offset:13312
    v_cvt_pk_bf16_f32 v209, v234, v235
    v_mfma_f32_16x16x32_bf16 a[24:27], a[200:203], v[192:195], a[24:27]
    s_add_u32 s35, s35, 0x4000
    v_exp_f32 v236, v176
    v_mfma_f32_16x16x32_bf16 a[24:27], a[204:207], v[200:203], a[24:27]
    buffer_load_dwordx4 v1, s[20:23], s33 offen offset:1024 sc1 lds
    ds_read_b128 a[240:243], v3 offset:6144
    v_mfma_f32_16x16x32_bf16 a[28:31], a[200:203], v[196:199], a[28:31]
    v_exp_f32 v237, v177
    v_mfma_f32_16x16x32_bf16 a[28:31], a[204:207], v[204:207], a[28:31]
    s_waitcnt lgkmcnt(7)
    ds_read_b128 a[244:247], v3 offset:14336
    v_cvt_pk_bf16_f32 v210, v236, v237
    v_mfma_f32_16x16x32_bf16 a[40:43], a[208:211], v[192:195], a[40:43]
    v_exp_f32 v238, v178
    v_mfma_f32_16x16x32_bf16 a[40:43], a[212:215], v[200:203], a[40:43]
    ds_read_b128 a[248:251], v3 offset:7168
    v_or3_b32 v57, v208, v209, v210
    v_mfma_f32_16x16x32_bf16 a[44:47], a[208:211], v[196:199], a[44:47]
    v_exp_f32 v239, v179
    v_mfma_f32_16x16x32_bf16 a[44:47], a[212:215], v[204:207], a[44:47]
    s_waitcnt lgkmcnt(7)
    ds_read_b128 a[252:255], v3 offset:15360
    v_cvt_pk_bf16_f32 v211, v238, v239
    v_mfma_f32_16x16x32_bf16 a[56:59], a[216:219], v[192:195], a[56:59]
    s_and_b32 s35, s35, 0xffff
    v_exp_f32 v240, v164
    v_mfma_f32_16x16x32_bf16 a[56:59], a[220:223], v[200:203], a[56:59]
    ds_read_b128 a[128:131], v2 offset:0
    v_add_u32 v3, s53, v56
    v_mfma_f32_16x16x32_bf16 a[60:63], a[216:219], v[196:199], a[60:63]
    v_exp_f32 v241, v165
    v_mfma_f32_16x16x32_bf16 a[60:63], a[220:223], v[204:207], a[60:63]
    s_waitcnt lgkmcnt(7)
    buffer_load_dwordx4 v1, s[20:23], s33 offen offset:2048 sc1 lds
    ds_read_b128 a[132:135], v2 offset:1024
    v_mfma_f32_16x16x32_bf16 a[72:75], a[224:227], v[192:195], a[72:75]
    v_exp_f32 v242, v166
    v_mfma_f32_16x16x32_bf16 a[72:75], a[228:231], v[200:203], a[72:75]
    s_or_b32 s35, s35, 0x10000
    ds_read_b128 a[136:139], v2 offset:2048
    v_cvt_pk_bf16_f32 v212, v240, v241
    v_mfma_f32_16x16x32_bf16 a[76:79], a[224:227], v[196:199], a[76:79]
    v_exp_f32 v243, v167
    v_mfma_f32_16x16x32_bf16 a[76:79], a[228:231], v[204:207], a[76:79]
    s_waitcnt lgkmcnt(7)
    ds_read_b128 a[140:143], v2 offset:3072
    v_or3_b32 v57, v57, v211, v212
    v_mfma_f32_16x16x32_bf16 a[88:91], a[232:235], v[192:195], a[88:91]
    v_exp_f32 v244, v180
    v_mfma_f32_16x16x32_bf16 a[88:91], a[236:239], v[200:203], a[88:91]
    ds_read_b128 a[144:147], v2 offset:4096
    v_cvt_pk_bf16_f32 v213, v242, v243
    v_mfma_f32_16x16x32_bf16 a[92:95], a[232:235], v[196:199], a[92:95]
    v_exp_f32 v245, v181
    v_mfma_f32_16x16x32_bf16 a[92:95], a[236:239], v[204:207], a[92:95]
    s_waitcnt lgkmcnt(7)
    buffer_load_dwordx4 v1, s[20:23], s33 offen offset:3072 sc1 lds
    ds_read_b128 a[148:151], v2 offset:5120
    v_mfma_f32_16x16x32_bf16 a[104:107], a[240:243], v[192:195], a[104:107]
    s_add_u32 s33, s33, 0x80000
    v_exp_f32 v246, v182
    v_mfma_f32_16x16x32_bf16 a[104:107], a[244:247], v[200:203], a[104:107]
    ds_read_b128 a[152:155], v2 offset:6144
    v_cvt_pk_bf16_f32 v214, v244, v245
    v_mfma_f32_16x16x32_bf16 a[108:111], a[240:243], v[196:199], a[108:111]
    v_exp_f32 v247, v183
    v_mfma_f32_16x16x32_bf16 a[108:111], a[244:247], v[204:207], a[108:111]
    s_waitcnt lgkmcnt(7)
    ds_read_b128 a[156:159], v2 offset:7168
    v_or3_b32 v57, v57, v213, v214
    v_mfma_f32_16x16x32_bf16 a[120:123], a[248:251], v[192:195], a[120:123]
    v_exp_f32 v232, v168
    v_mfma_f32_16x16x32_bf16 a[120:123], a[252:255], v[200:203], a[120:123]
    ds_read_b128 a[160:163], v2 offset:8192
    v_cvt_pk_bf16_f32 v215, v246, v247
    v_mfma_f32_16x16x32_bf16 a[124:127], a[248:251], v[196:199], a[124:127]
    v_exp_f32 v233, v169
    v_mfma_f32_16x16x32_bf16 a[124:127], a[252:255], v[204:207], a[124:127]
    s_waitcnt lgkmcnt(7)
    ds_read_b128 a[164:167], v2 offset:9216
    v_cvt_pk_bf16_f32 v216, v232, v233
    v_mfma_f32_16x16x32_bf16 v[128:131], a[128:131], v[96:99], v[16:19]
    s_waitcnt vmcnt(12)
    s_barrier
    v_exp_f32 v234, v170
    v_mfma_f32_16x16x32_bf16 v[128:131], a[132:135], v[100:103], v[128:131]
    s_waitcnt lgkmcnt(6)
    ds_read_b128 a[168:171], v2 offset:10240
    v_or3_b32 v57, v57, v215, v216
    v_mfma_f32_16x16x32_bf16 v[128:131], a[136:139], v[104:107], v[128:131]
    s_mov_b32 m0, s34
    v_exp_f32 v235, v171
    v_mfma_f32_16x16x32_bf16 v[128:131], a[140:143], v[108:111], v[128:131]
    s_add_u32 s36, s36, 64
    buffer_load_dwordx4 v1, s[16:19], s32 offen offset:0 sc1 lds
    ds_read_b128 a[172:175], v2 offset:11264
    v_mfma_f32_16x16x32_bf16 v[132:135], a[128:131], v[112:115], v[20:23]
    v_exp_f32 v236, v184
    v_mfma_f32_16x16x32_bf16 v[132:135], a[132:135], v[116:119], v[132:135]
    ds_read_b128 a[176:179], v2 offset:12288
    v_cvt_pk_bf16_f32 v217, v234, v235
    v_mfma_f32_16x16x32_bf16 v[132:135], a[136:139], v[120:123], v[132:135]
    s_add_u32 s52, s52, 16384
    v_exp_f32 v237, v185
    v_mfma_f32_16x16x32_bf16 v[132:135], a[140:143], v[124:127], v[132:135]
    s_waitcnt lgkmcnt(7)
    ds_read_b128 a[180:183], v2 offset:13312
    v_cvt_pk_bf16_f32 v218, v236, v237
    v_mfma_f32_16x16x32_bf16 v[144:147], a[144:147], v[96:99], v[32:35]
    s_add_u32 s34, s34, 0x4000
    v_exp_f32 v238, v186
    v_mfma_f32_16x16x32_bf16 v[144:147], a[148:151], v[100:103], v[144:147]
    s_waitcnt lgkmcnt(6)
    buffer_load_dwordx4 v1, s[16:19], s32 offen offset:1024 sc1 lds
    ds_read_b128 a[184:187], v2 offset:14336
    v_mfma_f32_16x16x32_bf16 v[144:147], a[152:155], v[104:107], v[144:147]
    s_and_b32 s52, s52, 0xffff
    v_exp_f32 v239, v187
    v_mfma_f32_16x16x32_bf16 v[144:147], a[156:159], v[108:111], v[144:147]
    ds_read_b128 a[188:191], v2 offset:15360
    v_or3_b32 v57, v57, v217, v218
    v_mfma_f32_16x16x32_bf16 v[148:151], a[144:147], v[112:115], v[36:39]
    v_exp_f32 v240, v172
    v_mfma_f32_16x16x32_bf16 v[148:151], a[148:151], v[116:119], v[148:151]
    v_cvt_pk_bf16_f32 v219, v238, v239
    v_add_u32 v2, s52, v1
    v_mfma_f32_16x16x32_bf16 v[148:151], a[152:155], v[120:123], v[148:151]
    s_and_b32 s34, s34, 0xffff
    v_exp_f32 v241, v173
    v_mfma_f32_16x16x32_bf16 v[148:151], a[156:159], v[124:127], v[148:151]
    s_waitcnt lgkmcnt(6)
    ds_read_b128 a[192:195], v3 offset:0
    v_cvt_pk_bf16_f32 v220, v240, v241
    v_mfma_f32_16x16x32_bf16 v[136:139], a[160:163], v[96:99], v[24:27]
    v_exp_f32 v242, v174
    v_mfma_f32_16x16x32_bf16 v[136:139], a[164:167], v[100:103], v[136:139]
    s_waitcnt lgkmcnt(5)
    buffer_load_dwordx4 v1, s[16:19], s32 offen offset:2048 sc1 lds
    ds_read_b128 a[196:199], v3 offset:8192
    v_mfma_f32_16x16x32_bf16 v[136:139], a[168:171], v[104:107], v[136:139]
    v_exp_f32 v243, v175
    v_mfma_f32_16x16x32_bf16 v[136:139], a[172:175], v[108:111], v[136:139]
    ds_read_b128 a[200:203], v3 offset:1024
    v_or3_b32 v57, v57, v219, v220
    v_mfma_f32_16x16x32_bf16 v[140:143], a[160:163], v[112:115], v[28:31]
    v_exp_f32 v244, v188
    v_mfma_f32_16x16x32_bf16 v[140:143], a[164:167], v[116:119], v[140:143]
    ds_read_b128 a[204:207], v3 offset:9216
    v_cvt_pk_bf16_f32 v221, v242, v243
    v_mfma_f32_16x16x32_bf16 v[140:143], a[168:171], v[120:123], v[140:143]
    v_exp_f32 v245, v189
    v_mfma_f32_16x16x32_bf16 v[140:143], a[172:175], v[124:127], v[140:143]
    s_waitcnt lgkmcnt(6)
    buffer_load_dwordx4 v1, s[16:19], s32 offen offset:3072 sc1 lds
    ds_read_b128 a[208:211], v3 offset:2048
    v_mfma_f32_16x16x32_bf16 v[152:155], a[176:179], v[96:99], v[40:43]
    s_add_u32 s32, s32, 0x80000
    v_exp_f32 v246, v190
    v_mfma_f32_16x16x32_bf16 v[152:155], a[180:183], v[100:103], v[152:155]
    s_waitcnt lgkmcnt(5)
    ds_read_b128 a[212:215], v3 offset:10240
    v_cvt_pk_bf16_f32 v222, v244, v245
    v_mfma_f32_16x16x32_bf16 v[152:155], a[184:187], v[104:107], v[152:155]
    v_exp_f32 v247, v191
    v_mfma_f32_16x16x32_bf16 v[152:155], a[188:191], v[108:111], v[152:155]
    ds_read_b128 a[216:219], v3 offset:3072
    v_or3_b32 v57, v57, v221, v222
    v_mfma_f32_16x16x32_bf16 v[156:159], a[176:179], v[112:115], v[44:47]
    ds_read_b128 a[220:223], v3 offset:11264
    v_cvt_pk_bf16_f32 v223, v246, v247
    v_mfma_f32_16x16x32_bf16 v[156:159], a[180:183], v[116:119], v[156:159]
    v_bitop3_b32 v57, v57, v223, s37 bitop3:0xa8
    v_cmp_ne_u32 vcc, 0, v57
    v_mfma_f32_16x16x32_bf16 v[156:159], a[184:187], v[120:123], v[156:159]
    v_mfma_f32_16x16x32_bf16 v[156:159], a[188:191], v[124:127], v[156:159]
    s_cbranch_vccnz k2_tramp_112
k2_ret_113:
    v_mfma_f32_16x16x32_bf16 v[248:251], v[60:63], v[208:211], v[248:251]
    v_exp_f32 v232, v128
    v_mfma_f32_16x16x32_bf16 v[248:251], v[60:63], v[216:219], v[248:251]
    s_mov_b32 m0, s35
    ds_read_b128 a[224:227], v3 offset:4096
    v_mfma_f32_16x16x32_bf16 v[252:255], v[60:63], v[212:215], v[252:255]
    s_add_u32 s53, s53, 16384
    buffer_load_dwordx4 v1, s[20:23], s33 offen offset:0 sc1 lds
    ds_read_b128 a[228:231], v3 offset:12288
    v_mfma_f32_16x16x32_bf16 v[252:255], v[60:63], v[220:223], v[252:255]
    s_waitcnt lgkmcnt(8)
    v_exp_f32 v233, v129
    v_mfma_f32_16x16x32_bf16 a[8:11], a[192:195], v[208:211], a[8:11]
    s_and_b32 s53, s53, 0xffff
    v_exp_f32 v234, v130
    v_mfma_f32_16x16x32_bf16 a[8:11], a[196:199], v[216:219], a[8:11]
    ds_read_b128 a[232:235], v3 offset:5120
    v_cvt_pk_bf16_f32 v192, v232, v233
    v_mfma_f32_16x16x32_bf16 a[12:15], a[192:195], v[212:215], a[12:15]
    v_exp_f32 v235, v131
    v_mfma_f32_16x16x32_bf16 a[12:15], a[196:199], v[220:223], a[12:15]
    s_waitcnt lgkmcnt(7)
    ds_read_b128 a[236:239], v3 offset:13312
    v_cvt_pk_bf16_f32 v193, v234, v235
    v_mfma_f32_16x16x32_bf16 a[24:27], a[200:203], v[208:211], a[24:27]
    s_add_u32 s35, s35, 0x4000
    v_exp_f32 v236, v144
    v_mfma_f32_16x16x32_bf16 a[24:27], a[204:207], v[216:219], a[24:27]
    buffer_load_dwordx4 v1, s[20:23], s33 offen offset:1024 sc1 lds
    ds_read_b128 a[240:243], v3 offset:6144
    v_mfma_f32_16x16x32_bf16 a[28:31], a[200:203], v[212:215], a[28:31]
    v_exp_f32 v237, v145
    v_mfma_f32_16x16x32_bf16 a[28:31], a[204:207], v[220:223], a[28:31]
    s_waitcnt lgkmcnt(7)
    ds_read_b128 a[244:247], v3 offset:14336
    v_cvt_pk_bf16_f32 v194, v236, v237
    v_mfma_f32_16x16x32_bf16 a[40:43], a[208:211], v[208:211], a[40:43]
    v_exp_f32 v238, v146
    v_mfma_f32_16x16x32_bf16 a[40:43], a[212:215], v[216:219], a[40:43]
    ds_read_b128 a[248:251], v3 offset:7168
    v_or3_b32 v57, v192, v193, v194
    v_mfma_f32_16x16x32_bf16 a[44:47], a[208:211], v[212:215], a[44:47]
    v_exp_f32 v239, v147
    v_mfma_f32_16x16x32_bf16 a[44:47], a[212:215], v[220:223], a[44:47]
    s_waitcnt lgkmcnt(7)
    ds_read_b128 a[252:255], v3 offset:15360
    v_cvt_pk_bf16_f32 v195, v238, v239
    v_mfma_f32_16x16x32_bf16 a[56:59], a[216:219], v[208:211], a[56:59]
    s_and_b32 s35, s35, 0xffff
    v_exp_f32 v240, v132
    v_mfma_f32_16x16x32_bf16 a[56:59], a[220:223], v[216:219], a[56:59]
    ds_read_b128 a[128:131], v2 offset:0
    v_add_u32 v3, s53, v56
    v_mfma_f32_16x16x32_bf16 a[60:63], a[216:219], v[212:215], a[60:63]
    v_exp_f32 v241, v133
    v_mfma_f32_16x16x32_bf16 a[60:63], a[220:223], v[220:223], a[60:63]
    s_waitcnt lgkmcnt(7)
    buffer_load_dwordx4 v1, s[20:23], s33 offen offset:2048 sc1 lds
    ds_read_b128 a[132:135], v2 offset:1024
    v_mfma_f32_16x16x32_bf16 a[72:75], a[224:227], v[208:211], a[72:75]
    v_exp_f32 v242, v134
    v_mfma_f32_16x16x32_bf16 a[72:75], a[228:231], v[216:219], a[72:75]
    s_or_b32 s35, s35, 0x10000
    ds_read_b128 a[136:139], v2 offset:2048
    v_cvt_pk_bf16_f32 v196, v240, v241
    v_mfma_f32_16x16x32_bf16 a[76:79], a[224:227], v[212:215], a[76:79]
    v_exp_f32 v243, v135
    v_mfma_f32_16x16x32_bf16 a[76:79], a[228:231], v[220:223], a[76:79]
    s_waitcnt lgkmcnt(7)
    ds_read_b128 a[140:143], v2 offset:3072
    v_or3_b32 v57, v57, v195, v196
    v_mfma_f32_16x16x32_bf16 a[88:91], a[232:235], v[208:211], a[88:91]
    v_exp_f32 v244, v148
    v_mfma_f32_16x16x32_bf16 a[88:91], a[236:239], v[216:219], a[88:91]
    ds_read_b128 a[144:147], v2 offset:4096
    v_cvt_pk_bf16_f32 v197, v242, v243
    v_mfma_f32_16x16x32_bf16 a[92:95], a[232:235], v[212:215], a[92:95]
    v_exp_f32 v245, v149
    v_mfma_f32_16x16x32_bf16 a[92:95], a[236:239], v[220:223], a[92:95]
    s_waitcnt lgkmcnt(7)
    buffer_load_dwordx4 v1, s[20:23], s33 offen offset:3072 sc1 lds
    ds_read_b128 a[148:151], v2 offset:5120
    v_mfma_f32_16x16x32_bf16 a[104:107], a[240:243], v[208:211], a[104:107]
    s_add_u32 s33, s33, 0x80000
    v_exp_f32 v246, v150
    v_mfma_f32_16x16x32_bf16 a[104:107], a[244:247], v[216:219], a[104:107]
    ds_read_b128 a[152:155], v2 offset:6144
    v_cvt_pk_bf16_f32 v198, v244, v245
    v_mfma_f32_16x16x32_bf16 a[108:111], a[240:243], v[212:215], a[108:111]
    v_exp_f32 v247, v151
    v_mfma_f32_16x16x32_bf16 a[108:111], a[244:247], v[220:223], a[108:111]
    s_waitcnt lgkmcnt(7)
    ds_read_b128 a[156:159], v2 offset:7168
    v_or3_b32 v57, v57, v197, v198
    v_mfma_f32_16x16x32_bf16 a[120:123], a[248:251], v[208:211], a[120:123]
    v_exp_f32 v232, v136
    v_mfma_f32_16x16x32_bf16 a[120:123], a[252:255], v[216:219], a[120:123]
    ds_read_b128 a[160:163], v2 offset:8192
    v_cvt_pk_bf16_f32 v199, v246, v247
    v_mfma_f32_16x16x32_bf16 a[124:127], a[248:251], v[212:215], a[124:127]
    v_exp_f32 v233, v137
    v_mfma_f32_16x16x32_bf16 a[124:127], a[252:255], v[220:223], a[124:127]
    s_waitcnt lgkmcnt(7)
    ds_read_b128 a[164:167], v2 offset:9216
    v_cvt_pk_bf16_f32 v200, v232, v233
    v_mfma_f32_16x16x32_bf16 v[160:163], a[128:131], v[96:99], v[16:19]
    s_waitcnt vmcnt(12)
    s_barrier
    v_exp_f32 v234, v138
    v_mfma_f32_16x16x32_bf16 v[160:163], a[132:135], v[100:103], v[160:163]
    s_waitcnt lgkmcnt(6)
    ds_read_b128 a[168:171], v2 offset:10240
    v_or3_b32 v57, v57, v199, v200
    v_mfma_f32_16x16x32_bf16 v[160:163], a[136:139], v[104:107], v[160:163]
    s_mov_b32 m0, s34
    v_exp_f32 v235, v139
    v_mfma_f32_16x16x32_bf16 v[160:163], a[140:143], v[108:111], v[160:163]
    s_add_u32 s36, s36, 64
    buffer_load_dwordx4 v1, s[16:19], s32 offen offset:0 sc1 lds
    ds_read_b128 a[172:175], v2 offset:11264
    v_mfma_f32_16x16x32_bf16 v[164:167], a[128:131], v[112:115], v[20:23]
    v_exp_f32 v236, v152
    v_mfma_f32_16x16x32_bf16 v[164:167], a[132:135], v[116:119], v[164:167]
    ds_read_b128 a[176:179], v2 offset:12288
    v_cvt_pk_bf16_f32 v201, v234, v235
    v_mfma_f32_16x16x32_bf16 v[164:167], a[136:139], v[120:123], v[164:167]
    s_add_u32 s52, s52, 16384
    v_exp_f32 v237, v153
    v_mfma_f32_16x16x32_bf16 v[164:167], a[140:143], v[124:127], v[164:167]
    s_waitcnt lgkmcnt(7)
    ds_read_b128 a[180:183], v2 offset:13312
    v_cvt_pk_bf16_f32 v202, v236, v237
    v_mfma_f32_16x16x32_bf16 v[176:179], a[144:147], v[96:99], v[32:35]
    s_add_u32 s34, s34, 0x4000
    v_exp_f32 v238, v154
    v_mfma_f32_16x16x32_bf16 v[176:179], a[148:151], v[100:103], v[176:179]
    s_waitcnt lgkmcnt(6)
    buffer_load_dwordx4 v1, s[16:19], s32 offen offset:1024 sc1 lds
    ds_read_b128 a[184:187], v2 offset:14336
    v_mfma_f32_16x16x32_bf16 v[176:179], a[152:155], v[104:107], v[176:179]
    s_and_b32 s52, s52, 0xffff
    v_exp_f32 v239, v155
    v_mfma_f32_16x16x32_bf16 v[176:179], a[156:159], v[108:111], v[176:179]
    ds_read_b128 a[188:191], v2 offset:15360
    v_or3_b32 v57, v57, v201, v202
    v_mfma_f32_16x16x32_bf16 v[180:183], a[144:147], v[112:115], v[36:39]
    v_exp_f32 v240, v140
    v_mfma_f32_16x16x32_bf16 v[180:183], a[148:151], v[116:119], v[180:183]
    v_cvt_pk_bf16_f32 v203, v238, v239
    v_add_u32 v2, s52, v1
    v_mfma_f32_16x16x32_bf16 v[180:183], a[152:155], v[120:123], v[180:183]
    s_and_b32 s34, s34, 0xffff
    v_exp_f32 v241, v141
    v_mfma_f32_16x16x32_bf16 v[180:183], a[156:159], v[124:127], v[180:183]
    s_waitcnt lgkmcnt(6)
    ds_read_b128 a[192:195], v3 offset:0
    v_cvt_pk_bf16_f32 v204, v240, v241
    v_mfma_f32_16x16x32_bf16 v[168:171], a[160:163], v[96:99], v[24:27]
    v_exp_f32 v242, v142
    v_mfma_f32_16x16x32_bf16 v[168:171], a[164:167], v[100:103], v[168:171]
    s_waitcnt lgkmcnt(5)
    buffer_load_dwordx4 v1, s[16:19], s32 offen offset:2048 sc1 lds
    ds_read_b128 a[196:199], v3 offset:8192
    v_mfma_f32_16x16x32_bf16 v[168:171], a[168:171], v[104:107], v[168:171]
    v_exp_f32 v243, v143
    v_mfma_f32_16x16x32_bf16 v[168:171], a[172:175], v[108:111], v[168:171]
    ds_read_b128 a[200:203], v3 offset:1024
    v_or3_b32 v57, v57, v203, v204
    v_mfma_f32_16x16x32_bf16 v[172:175], a[160:163], v[112:115], v[28:31]
    v_exp_f32 v244, v156
    v_mfma_f32_16x16x32_bf16 v[172:175], a[164:167], v[116:119], v[172:175]
    ds_read_b128 a[204:207], v3 offset:9216
    v_cvt_pk_bf16_f32 v205, v242, v243
    v_mfma_f32_16x16x32_bf16 v[172:175], a[168:171], v[120:123], v[172:175]
    v_exp_f32 v245, v157
    v_mfma_f32_16x16x32_bf16 v[172:175], a[172:175], v[124:127], v[172:175]
    s_waitcnt lgkmcnt(6)
    buffer_load_dwordx4 v1, s[16:19], s32 offen offset:3072 sc1 lds
    ds_read_b128 a[208:211], v3 offset:2048
    v_mfma_f32_16x16x32_bf16 v[184:187], a[176:179], v[96:99], v[40:43]
    s_sub_u32 s63, s63, 1
    v_exp_f32 v246, v158
    v_mfma_f32_16x16x32_bf16 v[184:187], a[180:183], v[100:103], v[184:187]
    s_waitcnt lgkmcnt(5)
    ds_read_b128 a[212:215], v3 offset:10240
    v_cvt_pk_bf16_f32 v206, v244, v245
    v_mfma_f32_16x16x32_bf16 v[184:187], a[184:187], v[104:107], v[184:187]
    s_add_u32 s32, s32, 0x80000
    v_exp_f32 v247, v159
    v_mfma_f32_16x16x32_bf16 v[184:187], a[188:191], v[108:111], v[184:187]
    ds_read_b128 a[216:219], v3 offset:3072
    v_or3_b32 v57, v57, v205, v206
    v_mfma_f32_16x16x32_bf16 v[188:191], a[176:179], v[112:115], v[44:47]
    ds_read_b128 a[220:223], v3 offset:11264
    v_cvt_pk_bf16_f32 v207, v246, v247
    v_mfma_f32_16x16x32_bf16 v[188:191], a[180:183], v[116:119], v[188:191]
    v_bitop3_b32 v57, v57, v207, s37 bitop3:0xa8
    v_cmp_ne_u32 vcc, 0, v57
    v_mfma_f32_16x16x32_bf16 v[188:191], a[184:187], v[120:123], v[188:191]
    v_mfma_f32_16x16x32_bf16 v[188:191], a[188:191], v[124:127], v[188:191]
    s_cbranch_vccnz k2_tramp_114
k2_ret_115:
    s_cmp_lg_u32 s63, 0
    s_cbranch_scc1 k2_sloop_110
    v_mfma_f32_16x16x32_bf16 v[248:251], v[60:63], v[192:195], v[248:251]
    v_exp_f32 v232, v160
    v_mfma_f32_16x16x32_bf16 v[248:251], v[60:63], v[200:203], v[248:251]
    s_mov_b32 m0, s35
    ds_read_b128 a[224:227], v3 offset:4096
    v_exp_f32 v233, v161
    v_mfma_f32_16x16x32_bf16 v[252:255], v[60:63], v[196:199], v[252:255]
    s_add_u32 s53, s53, 16384
    buffer_load_dwordx4 v1, s[20:23], s33 offen offset:0 sc1 lds
    ds_read_b128 a[228:231], v3 offset:12288
    v_mfma_f32_16x16x32_bf16 v[252:255], v[60:63], v[204:207], v[252:255]
    s_waitcnt lgkmcnt(8)
    v_exp_f32 v234, v162
    v_cvt_pk_bf16_f32 v208, v232, v233
    v_mfma_f32_16x16x32_bf16 a[8:11], a[192:195], v[192:195], a[8:11]
    s_sub_u32 s40, s36, s39
    ds_read_b128 a[232:235], v3 offset:5120
    v_mfma_f32_16x16x32_bf16 a[8:11], a[196:199], v[200:203], a[8:11]
    s_and_b32 s53, s53, 0xffff
    v_subrev_u32 v6, s40, v4
    v_cmp_gt_i32 s[44:45], 0, v6
    v_mfma_f32_16x16x32_bf16 a[12:15], a[192:195], v[196:199], a[12:15]
    v_exp_f32 v235, v163
    v_cmp_gt_i32 s[46:47], 1, v6
    v_mfma_f32_16x16x32_bf16 a[12:15], a[196:199], v[204:207], a[12:15]
    s_waitcnt lgkmcnt(7)
    ds_read_b128 a[236:239], v3 offset:13312
    v_cmp_gt_i32 s[48:49], 2, v6
    v_cmp_gt_i32 s[50:51], 3, v6
    v_mfma_f32_16x16x32_bf16 a[24:27], a[200:203], v[192:195], a[24:27]
    s_add_u32 s35, s35, 0x4000
    v_exp_f32 v236, v176
    v_mfma_f32_16x16x32_bf16 a[24:27], a[204:207], v[200:203], a[24:27]
    ds_read_b128 a[240:243], v3 offset:6144
    v_cvt_pk_bf16_f32 v209, v234, v235
    v_cndmask_b32 v16, v10, v5, s[44:45]
    v_mfma_f32_16x16x32_bf16 a[28:31], a[200:203], v[196:199], a[28:31]
    v_exp_f32 v237, v177
    v_mfma_f32_16x16x32_bf16 a[28:31], a[204:207], v[204:207], a[28:31]
    s_waitcnt lgkmcnt(7)
    ds_read_b128 a[244:247], v3 offset:14336
    v_cndmask_b32 v17, v10, v5, s[46:47]
    v_cndmask_b32 v18, v10, v5, s[48:49]
    v_mfma_f32_16x16x32_bf16 a[40:43], a[208:211], v[192:195], a[40:43]
    buffer_load_dwordx4 v1, s[20:23], s33 offen offset:1024 sc1 lds
    ds_read_b128 a[248:251], v3 offset:7168
    v_mfma_f32_16x16x32_bf16 a[40:43], a[212:215], v[200:203], a[40:43]
    v_cndmask_b32 v19, v10, v5, s[50:51]
    v_cvt_pk_bf16_f32 v210, v236, v237
    v_mfma_f32_16x16x32_bf16 a[44:47], a[208:211], v[196:199], a[44:47]
    v_exp_f32 v238, v178
    v_cmp_gt_i32 s[44:45], 16, v6
    v_mfma_f32_16x16x32_bf16 a[44:47], a[212:215], v[204:207], a[44:47]
    s_waitcnt lgkmcnt(7)
    v_cmp_gt_i32 s[46:47], 17, v6
    v_cmp_gt_i32 s[48:49], 18, v6
    v_mfma_f32_16x16x32_bf16 a[56:59], a[216:219], v[192:195], a[56:59]
    s_and_b32 s35, s35, 0xffff
    v_exp_f32 v239, v179
    v_mfma_f32_16x16x32_bf16 a[56:59], a[220:223], v[200:203], a[56:59]
    ds_read_b128 a[252:255], v3 offset:15360
    v_or3_b32 v57, v208, v209, v210
    v_cmp_gt_i32 s[50:51], 19, v6
    v_mfma_f32_16x16x32_bf16 a[60:63], a[216:219], v[196:199], a[60:63]
    v_exp_f32 v240, v164
    v_mfma_f32_16x16x32_bf16 a[60:63], a[220:223], v[204:207], a[60:63]
    s_waitcnt lgkmcnt(6)
    v_cndmask_b32 v32, v10, v5, s[44:45]
    v_cvt_pk_bf16_f32 v211, v238, v239
    v_cndmask_b32 v33, v10, v5, s[46:47]
    v_mfma_f32_16x16x32_bf16 a[72:75], a[224:227], v[192:195], a[72:75]
    ds_read_b128 a[128:131], v2 offset:0
    v_cndmask_b32 v34, v10, v5, s[48:49]
    v_mfma_f32_16x16x32_bf16 a[72:75], a[228:231], v[200:203], a[72:75]
    s_or_b32 s35, s35, 0x10000
    v_add_u32 v3, s53, v56
    v_cndmask_b32 v35, v10, v5, s[50:51]
    v_mfma_f32_16x16x32_bf16 a[76:79], a[224:227], v[196:199], a[76:79]
    buffer_load_dwordx4 v1, s[20:23], s33 offen offset:2048 sc1 lds
    v_exp_f32 v241, v165
    v_mfma_f32_16x16x32_bf16 a[76:79], a[228:231], v[204:207], a[76:79]
    s_waitcnt lgkmcnt(5)
    ds_read_b128 a[132:135], v2 offset:1024
    v_cmp_gt_i32 s[44:45], 32, v6
    v_mfma_f32_16x16x32_bf16 a[88:91], a[232:235], v[192:195], a[88:91]
    v_exp_f32 v242, v166
    v_cmp_gt_i32 s[46:47], 33, v6
    v_mfma_f32_16x16x32_bf16 a[88:91], a[236:239], v[200:203], a[88:91]
    ds_read_b128 a[136:139], v2 offset:2048
    v_cvt_pk_bf16_f32 v212, v240, v241
    v_mfma_f32_16x16x32_bf16 a[92:95], a[232:235], v[196:199], a[92:95]
    v_cmp_gt_i32 s[48:49], 34, v6
    v_cmp_gt_i32 s[50:51], 35, v6
    v_mfma_f32_16x16x32_bf16 a[92:95], a[236:239], v[204:207], a[92:95]
    s_waitcnt lgkmcnt(5)
    v_exp_f32 v243, v167
    v_or3_b32 v57, v57, v211, v212
    v_mfma_f32_16x16x32_bf16 a[104:107], a[240:243], v[192:195], a[104:107]
    ds_read_b128 a[140:143], v2 offset:3072
    v_cndmask_b32 v24, v10, v5, s[44:45]
    v_mfma_f32_16x16x32_bf16 a[104:107], a[244:247], v[200:203], a[104:107]
    v_cndmask_b32 v25, v10, v5, s[46:47]
    v_exp_f32 v244, v180
    v_mfma_f32_16x16x32_bf16 a[108:111], a[240:243], v[196:199], a[108:111]
    v_cvt_pk_bf16_f32 v213, v242, v243
    v_cndmask_b32 v26, v10, v5, s[48:49]
    v_mfma_f32_16x16x32_bf16 a[108:111], a[244:247], v[204:207], a[108:111]
    s_waitcnt lgkmcnt(4)
    ds_read_b128 a[144:147], v2 offset:4096
    v_cndmask_b32 v27, v10, v5, s[50:51]
    v_mfma_f32_16x16x32_bf16 a[120:123], a[248:251], v[192:195], a[120:123]
    v_exp_f32 v245, v181
    v_cmp_gt_i32 s[44:45], 48, v6
    v_mfma_f32_16x16x32_bf16 a[120:123], a[252:255], v[200:203], a[120:123]
    buffer_load_dwordx4 v1, s[20:23], s33 offen offset:3072 sc1 lds
    ds_read_b128 a[148:151], v2 offset:5120
    ds_read_b128 a[152:155], v2 offset:6144
    v_cmp_gt_i32 s[46:47], 49, v6
    s_add_u32 s33, s33, 0x80000
    v_cmp_gt_i32 s[48:49], 50, v6
    v_exp_f32 v246, v182
    v_cvt_pk_bf16_f32 v214, v244, v245
    v_cmp_gt_i32 s[50:51], 51, v6
    v_cndmask_b32 v40, v10, v5, s[44:45]
    v_mfma_f32_16x16x32_bf16 a[124:127], a[248:251], v[196:199], a[124:127]
    v_exp_f32 v247, v183
    v_or3_b32 v57, v57, v213, v214
    v_cndmask_b32 v41, v10, v5, s[46:47]
    v_mfma_f32_16x16x32_bf16 a[124:127], a[252:255], v[204:207], a[124:127]
    s_waitcnt lgkmcnt(5)
    ds_read_b128 a[156:159], v2 offset:7168
    v_cndmask_b32 v42, v10, v5, s[48:49]
    v_cndmask_b32 v43, v10, v5, s[50:51]
    v_mfma_f32_16x16x32_bf16 v[128:131], a[128:131], v[96:99], v[16:19]
    s_waitcnt vmcnt(4)
    s_barrier
    v_exp_f32 v232, v168
    v_mfma_f32_16x16x32_bf16 v[128:131], a[132:135], v[100:103], v[128:131]
    s_waitcnt lgkmcnt(4)
    ds_read_b128 a[160:163], v2 offset:8192
    v_cvt_pk_bf16_f32 v215, v246, v247
    v_mfma_f32_16x16x32_bf16 v[128:131], a[136:139], v[104:107], v[128:131]
    v_exp_f32 v233, v169
    v_mfma_f32_16x16x32_bf16 v[128:131], a[140:143], v[108:111], v[128:131]
    s_add_u32 s36, s36, 64
    ds_read_b128 a[164:167], v2 offset:9216
    v_cvt_pk_bf16_f32 v216, v232, v233
    v_mfma_f32_16x16x32_bf16 v[132:135], a[128:131], v[112:115], v[20:23]
    v_exp_f32 v234, v170
    v_mfma_f32_16x16x32_bf16 v[132:135], a[132:135], v[116:119], v[132:135]
    ds_read_b128 a[168:171], v2 offset:10240
    v_or3_b32 v57, v57, v215, v216
    v_mfma_f32_16x16x32_bf16 v[132:135], a[136:139], v[120:123], v[132:135]
    s_add_u32 s52, s52, 16384
    v_exp_f32 v235, v171
    v_mfma_f32_16x16x32_bf16 v[132:135], a[140:143], v[124:127], v[132:135]
    s_waitcnt lgkmcnt(5)
    ds_read_b128 a[172:175], v2 offset:11264
    v_cvt_pk_bf16_f32 v217, v234, v235
    v_mfma_f32_16x16x32_bf16 v[144:147], a[144:147], v[96:99], v[32:35]
    s_and_b32 s52, s52, 0xffff
    v_exp_f32 v236, v184
    v_mfma_f32_16x16x32_bf16 v[144:147], a[148:151], v[100:103], v[144:147]
    s_waitcnt lgkmcnt(4)
    ds_read_b128 a[176:179], v2 offset:12288
    ds_read_b128 a[180:183], v2 offset:13312
    v_mfma_f32_16x16x32_bf16 v[144:147], a[152:155], v[104:107], v[144:147]
    v_exp_f32 v237, v185
    v_mfma_f32_16x16x32_bf16 v[144:147], a[156:159], v[108:111], v[144:147]
    v_exp_f32 v238, v186
    v_mfma_f32_16x16x32_bf16 v[148:151], a[144:147], v[112:115], v[36:39]
    ds_read_b128 a[184:187], v2 offset:14336
    v_cvt_pk_bf16_f32 v218, v236, v237
    v_mfma_f32_16x16x32_bf16 v[148:151], a[148:151], v[116:119], v[148:151]
    v_exp_f32 v239, v187
    v_mfma_f32_16x16x32_bf16 v[148:151], a[152:155], v[120:123], v[148:151]
    ds_read_b128 a[188:191], v2 offset:15360
    v_or3_b32 v57, v57, v217, v218
    v_mfma_f32_16x16x32_bf16 v[148:151], a[156:159], v[124:127], v[148:151]
    s_waitcnt lgkmcnt(6)
    v_exp_f32 v240, v172
    v_mfma_f32_16x16x32_bf16 v[136:139], a[160:163], v[96:99], v[24:27]
    v_cvt_pk_bf16_f32 v219, v238, v239
    v_add_u32 v2, s52, v1
    v_mfma_f32_16x16x32_bf16 v[136:139], a[164:167], v[100:103], v[136:139]
    s_waitcnt lgkmcnt(4)
    v_exp_f32 v241, v173
    v_mfma_f32_16x16x32_bf16 v[136:139], a[168:171], v[104:107], v[136:139]
    ds_read_b128 a[192:195], v3 offset:0
    v_cvt_pk_bf16_f32 v220, v240, v241
    v_mfma_f32_16x16x32_bf16 v[136:139], a[172:175], v[108:111], v[136:139]
    v_exp_f32 v242, v174
    v_mfma_f32_16x16x32_bf16 v[140:143], a[160:163], v[112:115], v[28:31]
    ds_read_b128 a[196:199], v3 offset:8192
    v_or3_b32 v57, v57, v219, v220
    v_mfma_f32_16x16x32_bf16 v[140:143], a[164:167], v[116:119], v[140:143]
    v_exp_f32 v243, v175
    v_mfma_f32_16x16x32_bf16 v[140:143], a[168:171], v[120:123], v[140:143]
    ds_read_b128 a[200:203], v3 offset:1024
    v_cvt_pk_bf16_f32 v221, v242, v243
    v_mfma_f32_16x16x32_bf16 v[140:143], a[172:175], v[124:127], v[140:143]
    s_waitcnt lgkmcnt(5)
    v_exp_f32 v244, v188
    v_mfma_f32_16x16x32_bf16 v[152:155], a[176:179], v[96:99], v[40:43]
    ds_read_b128 a[204:207], v3 offset:9216
    ds_read_b128 a[208:211], v3 offset:2048
    v_mfma_f32_16x16x32_bf16 v[152:155], a[180:183], v[100:103], v[152:155]
    s_waitcnt lgkmcnt(5)
    v_exp_f32 v245, v189
    v_mfma_f32_16x16x32_bf16 v[152:155], a[184:187], v[104:107], v[152:155]
    v_exp_f32 v246, v190
    v_mfma_f32_16x16x32_bf16 v[152:155], a[188:191], v[108:111], v[152:155]
    ds_read_b128 a[212:215], v3 offset:10240
    v_cvt_pk_bf16_f32 v222, v244, v245
    v_mfma_f32_16x16x32_bf16 v[156:159], a[176:179], v[112:115], v[44:47]
    v_exp_f32 v247, v191
    v_mfma_f32_16x16x32_bf16 v[156:159], a[180:183], v[116:119], v[156:159]
    ds_read_b128 a[216:219], v3 offset:3072
    v_or3_b32 v57, v57, v221, v222
    v_mfma_f32_16x16x32_bf16 v[156:159], a[184:187], v[120:123], v[156:159]
    ds_read_b128 a[220:223], v3 offset:11264
    v_cvt_pk_bf16_f32 v223, v246, v247
    v_bitop3_b32 v57, v57, v223, s37 bitop3:0xa8
    v_mfma_f32_16x16x32_bf16 v[156:159], a[188:191], v[124:127], v[156:159]
    v_cmp_ne_u32 vcc, 0, v57
    s_cbranch_vccnz k2_tramp_116
k2_ret_117:
    v_mfma_f32_16x16x32_bf16 v[248:251], v[60:63], v[208:211], v[248:251]
    ds_read_b128 a[224:227], v3 offset:4096
    v_exp_f32 v232, v128
    v_mfma_f32_16x16x32_bf16 v[248:251], v[60:63], v[216:219], v[248:251]
    v_exp_f32 v233, v129
    v_mfma_f32_16x16x32_bf16 v[252:255], v[60:63], v[212:215], v[252:255]
    s_add_u32 s53, s53, 16384
    ds_read_b128 a[228:231], v3 offset:12288
    v_exp_f32 v234, v130
    v_mfma_f32_16x16x32_bf16 v[252:255], v[60:63], v[220:223], v[252:255]
    s_waitcnt lgkmcnt(8)
    v_cvt_pk_bf16_f32 v192, v232, v233
    v_exp_f32 v235, v131
    v_mfma_f32_16x16x32_bf16 a[8:11], a[192:195], v[208:211], a[8:11]
    s_sub_u32 s40, s36, s39
    s_sub_u32 s40, s40, 64
    ds_read_b128 a[232:235], v3 offset:5120
    v_mfma_f32_16x16x32_bf16 a[8:11], a[196:199], v[216:219], a[8:11]
    s_and_b32 s53, s53, 0xffff
    v_subrev_u32 v6, s40, v4
    v_cmp_gt_i32 s[44:45], 0, v6
    v_cvt_pk_bf16_f32 v193, v234, v235
    v_mfma_f32_16x16x32_bf16 a[12:15], a[192:195], v[212:215], a[12:15]
    v_exp_f32 v236, v144
    v_cmp_gt_i32 s[46:47], 1, v6
    v_mfma_f32_16x16x32_bf16 a[12:15], a[196:199], v[220:223], a[12:15]
    s_waitcnt lgkmcnt(7)
    ds_read_b128 a[236:239], v3 offset:13312
    v_exp_f32 v237, v145
    v_mfma_f32_16x16x32_bf16 a[24:27], a[200:203], v[208:211], a[24:27]
    ds_read_b128 a[240:243], v3 offset:6144
    v_cmp_gt_i32 s[48:49], 2, v6
    v_cmp_gt_i32 s[50:51], 3, v6
    v_mfma_f32_16x16x32_bf16 a[24:27], a[204:207], v[216:219], a[24:27]
    v_exp_f32 v238, v146
    v_cndmask_b32 v20, v11, v5, s[44:45]
    v_mfma_f32_16x16x32_bf16 a[28:31], a[200:203], v[212:215], a[28:31]
    v_cvt_pk_bf16_f32 v194, v236, v237
    v_cndmask_b32 v21, v11, v5, s[46:47]
    v_or3_b32 v57, v192, v193, v194
    v_mfma_f32_16x16x32_bf16 a[28:31], a[204:207], v[220:223], a[28:31]
    s_waitcnt lgkmcnt(7)
    v_exp_f32 v239, v147
    v_cndmask_b32 v22, v11, v5, s[48:49]
    v_mfma_f32_16x16x32_bf16 a[40:43], a[208:211], v[208:211], a[40:43]
    ds_read_b128 a[244:247], v3 offset:14336
    v_cndmask_b32 v23, v11, v5, s[50:51]
    v_cvt_pk_bf16_f32 v195, v238, v239
    v_mfma_f32_16x16x32_bf16 a[40:43], a[212:215], v[216:219], a[40:43]
    v_exp_f32 v240, v132
    v_cmp_gt_i32 s[44:45], 16, v6
    v_mfma_f32_16x16x32_bf16 a[44:47], a[208:211], v[212:215], a[44:47]
    ds_read_b128 a[248:251], v3 offset:7168
    v_cmp_gt_i32 s[46:47], 17, v6
    v_cmp_gt_i32 s[48:49], 18, v6
    v_mfma_f32_16x16x32_bf16 a[44:47], a[212:215], v[220:223], a[44:47]
    s_waitcnt lgkmcnt(7)
    ds_read_b128 a[252:255], v3 offset:15360
    v_exp_f32 v241, v133
    v_mfma_f32_16x16x32_bf16 a[56:59], a[216:219], v[208:211], a[56:59]
    v_exp_f32 v242, v134
    v_cmp_gt_i32 s[50:51], 19, v6
    v_mfma_f32_16x16x32_bf16 a[56:59], a[220:223], v[216:219], a[56:59]
    v_cvt_pk_bf16_f32 v196, v240, v241
    v_cndmask_b32 v36, v11, v5, s[44:45]
    v_or3_b32 v57, v57, v195, v196
    v_mfma_f32_16x16x32_bf16 a[60:63], a[216:219], v[212:215], a[60:63]
    v_exp_f32 v243, v135
    v_cndmask_b32 v37, v11, v5, s[46:47]
    v_mfma_f32_16x16x32_bf16 a[60:63], a[220:223], v[220:223], a[60:63]
    s_waitcnt lgkmcnt(6)
    ds_read_b128 a[128:131], v2 offset:0
    v_cndmask_b32 v38, v11, v5, s[48:49]
    v_add_u32 v3, s53, v56
    v_mfma_f32_16x16x32_bf16 a[72:75], a[224:227], v[208:211], a[72:75]
    ds_read_b128 a[132:135], v2 offset:1024
    v_exp_f32 v244, v148
    v_mfma_f32_16x16x32_bf16 a[72:75], a[228:231], v[216:219], a[72:75]
    ds_read_b128 a[136:139], v2 offset:2048
    v_cvt_pk_bf16_f32 v197, v242, v243
    v_cndmask_b32 v39, v11, v5, s[50:51]
    v_mfma_f32_16x16x32_bf16 a[76:79], a[224:227], v[212:215], a[76:79]
    v_cmp_gt_i32 s[44:45], 32, v6
    v_exp_f32 v245, v149
    v_mfma_f32_16x16x32_bf16 a[76:79], a[228:231], v[220:223], a[76:79]
    s_waitcnt lgkmcnt(7)
    ds_read_b128 a[140:143], v2 offset:3072
    ds_read_b128 a[144:147], v2 offset:4096
    v_cmp_gt_i32 s[46:47], 33, v6
    v_mfma_f32_16x16x32_bf16 a[88:91], a[232:235], v[208:211], a[88:91]
    v_exp_f32 v246, v150
    v_cmp_gt_i32 s[48:49], 34, v6
    v_mfma_f32_16x16x32_bf16 a[88:91], a[236:239], v[216:219], a[88:91]
    ds_read_b128 a[148:151], v2 offset:5120
    v_cvt_pk_bf16_f32 v198, v244, v245
    v_cmp_gt_i32 s[50:51], 35, v6
    v_mfma_f32_16x16x32_bf16 a[92:95], a[232:235], v[212:215], a[92:95]
    v_exp_f32 v247, v151
    v_or3_b32 v57, v57, v197, v198
    v_mfma_f32_16x16x32_bf16 a[92:95], a[236:239], v[220:223], a[92:95]
    s_waitcnt lgkmcnt(8)
    ds_read_b128 a[152:155], v2 offset:6144
    v_cndmask_b32 v28, v11, v5, s[44:45]
    v_cndmask_b32 v29, v11, v5, s[46:47]
    v_mfma_f32_16x16x32_bf16 a[104:107], a[240:243], v[208:211], a[104:107]
    ds_read_b128 a[156:159], v2 offset:7168
    v_exp_f32 v232, v136
    v_mfma_f32_16x16x32_bf16 a[104:107], a[244:247], v[216:219], a[104:107]
    ds_read_b128 a[160:163], v2 offset:8192
    v_cvt_pk_bf16_f32 v199, v246, v247
    v_cndmask_b32 v30, v11, v5, s[48:49]
    v_mfma_f32_16x16x32_bf16 a[108:111], a[240:243], v[212:215], a[108:111]
    v_cndmask_b32 v31, v11, v5, s[50:51]
    v_exp_f32 v233, v137
    v_mfma_f32_16x16x32_bf16 a[108:111], a[244:247], v[220:223], a[108:111]
    s_waitcnt lgkmcnt(9)
    ds_read_b128 a[164:167], v2 offset:9216
    ds_read_b128 a[168:171], v2 offset:10240
    v_cmp_gt_i32 s[44:45], 48, v6
    v_mfma_f32_16x16x32_bf16 a[120:123], a[248:251], v[208:211], a[120:123]
    v_exp_f32 v234, v138
    v_cmp_gt_i32 s[46:47], 49, v6
    v_mfma_f32_16x16x32_bf16 a[120:123], a[252:255], v[216:219], a[120:123]
    ds_read_b128 a[172:175], v2 offset:11264
    ds_read_b128 a[176:179], v2 offset:12288
    v_cvt_pk_bf16_f32 v200, v232, v233
    v_cmp_gt_i32 s[48:49], 50, v6
    v_exp_f32 v235, v139
    v_cmp_gt_i32 s[50:51], 51, v6
    v_or3_b32 v57, v57, v199, v200
    v_cndmask_b32 v44, v11, v5, s[44:45]
    v_mfma_f32_16x16x32_bf16 a[124:127], a[248:251], v[212:215], a[124:127]
    ds_read_b128 a[180:183], v2 offset:13312
    v_exp_f32 v236, v152
    v_cvt_pk_bf16_f32 v201, v234, v235
    v_cndmask_b32 v45, v11, v5, s[46:47]
    v_mfma_f32_16x16x32_bf16 a[124:127], a[252:255], v[220:223], a[124:127]
    s_waitcnt lgkmcnt(12)
    ds_read_b128 a[184:187], v2 offset:14336
    v_cndmask_b32 v46, v11, v5, s[48:49]
    v_cndmask_b32 v47, v11, v5, s[50:51]
    v_mfma_f32_16x16x32_bf16 v[164:167], a[128:131], v[112:115], v[20:23]
    v_exp_f32 v237, v153
    v_mfma_f32_16x16x32_bf16 v[164:167], a[132:135], v[116:119], v[164:167]
    s_waitcnt lgkmcnt(11)
    ds_read_b128 a[188:191], v2 offset:15360
    v_exp_f32 v238, v154
    v_mfma_f32_16x16x32_bf16 v[164:167], a[136:139], v[120:123], v[164:167]
    v_cvt_pk_bf16_f32 v202, v236, v237
    v_exp_f32 v239, v155
    v_mfma_f32_16x16x32_bf16 v[164:167], a[140:143], v[124:127], v[164:167]
    s_waitcnt lgkmcnt(10)
    ds_read_b128 a[192:195], v3 offset:0
    v_or3_b32 v57, v57, v201, v202
    v_mfma_f32_16x16x32_bf16 v[180:183], a[144:147], v[112:115], v[36:39]
    s_add_u32 s36, s36, 64
    v_exp_f32 v240, v140
    v_mfma_f32_16x16x32_bf16 v[180:183], a[148:151], v[116:119], v[180:183]
    s_waitcnt lgkmcnt(9)
    ds_read_b128 a[196:199], v3 offset:8192
    v_cvt_pk_bf16_f32 v203, v238, v239
    v_exp_f32 v241, v141
    v_mfma_f32_16x16x32_bf16 v[180:183], a[152:155], v[120:123], v[180:183]
    s_add_u32 s52, s52, 16384
    ds_read_b128 a[200:203], v3 offset:1024
    v_cvt_pk_bf16_f32 v204, v240, v241
    v_mfma_f32_16x16x32_bf16 v[180:183], a[156:159], v[124:127], v[180:183]
    s_waitcnt lgkmcnt(9)
    v_exp_f32 v242, v142
    v_or3_b32 v57, v57, v203, v204
    v_mfma_f32_16x16x32_bf16 v[172:175], a[160:163], v[112:115], v[28:31]
    s_and_b32 s52, s52, 0xffff
    v_add_u32 v2, s52, v1
    v_exp_f32 v243, v143
    v_mfma_f32_16x16x32_bf16 v[172:175], a[164:167], v[116:119], v[172:175]
    s_waitcnt lgkmcnt(7)
    ds_read_b128 a[204:207], v3 offset:9216
    v_exp_f32 v244, v156
    v_mfma_f32_16x16x32_bf16 v[172:175], a[168:171], v[120:123], v[172:175]
    ds_read_b128 a[208:211], v3 offset:2048
    ds_read_b128 a[212:215], v3 offset:10240
    v_cvt_pk_bf16_f32 v205, v242, v243
    v_mfma_f32_16x16x32_bf16 v[172:175], a[172:175], v[124:127], v[172:175]
    s_waitcnt lgkmcnt(8)
    ds_read_b128 a[216:219], v3 offset:3072
    v_exp_f32 v245, v157
    v_mfma_f32_16x16x32_bf16 v[188:191], a[176:179], v[112:115], v[44:47]
    v_exp_f32 v246, v158
    v_cvt_pk_bf16_f32 v206, v244, v245
    v_mfma_f32_16x16x32_bf16 v[188:191], a[180:183], v[116:119], v[188:191]
    s_waitcnt lgkmcnt(7)
    v_exp_f32 v247, v159
    v_or3_b32 v57, v57, v205, v206
    v_mfma_f32_16x16x32_bf16 v[188:191], a[184:187], v[120:123], v[188:191]
    ds_read_b128 a[220:223], v3 offset:11264
    v_cvt_pk_bf16_f32 v207, v246, v247
    v_bitop3_b32 v57, v57, v207, s37 bitop3:0xa8
    v_mfma_f32_16x16x32_bf16 v[188:191], a[188:191], v[124:127], v[188:191]
    v_cmp_ne_u32 vcc, 0, v57
    s_cbranch_vccnz k2_tramp_118
k2_ret_119:
k2_sdone_111:
    s_add_u32 s16, s6, 0x4811000
    s_addc_u32 s17, s7, 0
    s_and_b32 s17, s17, 0xffff
    s_mov_b32 s18, 0x4000
    s_mov_b32 s19, 0x00020000
    v_mfma_f32_16x16x32_bf16 v[248:251], v[60:63], v[192:195], v[248:251]
    s_waitcnt vmcnt(0)
    s_barrier
    v_exp_f32 v232, v164
    v_mfma_f32_16x16x32_bf16 v[248:251], v[60:63], v[200:203], v[248:251]
    ds_read_b128 a[224:227], v3 offset:4096
    s_cmp_eq_u32 s30, 0
    s_cbranch_scc1 k12_ool_122
k12_oolret_123:
    v_mfma_f32_16x16x32_bf16 v[252:255], v[60:63], v[196:199], v[252:255]
    s_add_u32 m0, s60, 0
    v_exp_f32 v233, v165
    v_mfma_f32_16x16x32_bf16 v[252:255], v[60:63], v[204:207], v[252:255]
    s_waitcnt lgkmcnt(7)
    buffer_load_dwordx4 v90, s[12:15], s61 offen offset:0 lds
    ds_read_b128 a[228:231], v3 offset:12288
    v_mfma_f32_16x16x32_bf16 a[8:11], a[192:195], v[192:195], a[8:11]
    s_add_u32 s53, s53, 16384
    v_exp_f32 v234, v166
    v_cvt_pk_bf16_f32 v212, v232, v233
    v_mfma_f32_16x16x32_bf16 a[8:11], a[196:199], v[200:203], a[8:11]
    s_and_b32 s53, s53, 0xffff
    buffer_load_dwordx4 v91, s[12:15], s61 offen offset:1024 lds
    ds_read_b128 a[232:235], v3 offset:5120
    v_mfma_f32_16x16x32_bf16 a[12:15], a[192:195], v[196:199], a[12:15]
    ds_read_b128 a[236:239], v3 offset:13312
    v_exp_f32 v235, v167
    v_mfma_f32_16x16x32_bf16 a[12:15], a[196:199], v[204:207], a[12:15]
    s_waitcnt lgkmcnt(8)
    v_exp_f32 v236, v180
    v_mfma_f32_16x16x32_bf16 a[24:27], a[200:203], v[192:195], a[24:27]
    buffer_load_dwordx4 v92, s[12:15], s61 offen offset:2048 lds
    ds_read_b128 a[240:243], v3 offset:6144
    v_mfma_f32_16x16x32_bf16 a[24:27], a[204:207], v[200:203], a[24:27]
    v_cvt_pk_bf16_f32 v213, v234, v235
    v_exp_f32 v237, v181
    v_mfma_f32_16x16x32_bf16 a[28:31], a[200:203], v[196:199], a[28:31]
    buffer_load_dwordx4 v93, s[12:15], s61 offen offset:3072 lds
    ds_read_b128 a[244:247], v3 offset:14336
    v_mfma_f32_16x16x32_bf16 a[28:31], a[204:207], v[204:207], a[28:31]
    s_waitcnt lgkmcnt(8)
    v_exp_f32 v238, v182
    v_cvt_pk_bf16_f32 v214, v236, v237
    v_mfma_f32_16x16x32_bf16 a[40:43], a[208:211], v[192:195], a[40:43]
    s_add_u32 s61, s61, 0x20000
    s_and_b32 s61, s61, 0x3fffff
    ds_read_b128 a[248:251], v3 offset:7168
    v_mfma_f32_16x16x32_bf16 a[40:43], a[212:215], v[200:203], a[40:43]
    s_add_u32 m0, s60, 16384
    v_exp_f32 v239, v183
    v_or3_b32 v57, v212, v213, v214
    v_mfma_f32_16x16x32_bf16 a[44:47], a[208:211], v[196:199], a[44:47]
    buffer_load_dwordx4 v90, s[12:15], s61 offen offset:0 lds
    buffer_load_dwordx4 v91, s[12:15], s61 offen offset:1024 lds
    ds_read_b128 a[252:255], v3 offset:15360
    v_mfma_f32_16x16x32_bf16 a[44:47], a[212:215], v[204:207], a[44:47]
    s_waitcnt lgkmcnt(8)
    v_exp_f32 v240, v172
    v_cvt_pk_bf16_f32 v215, v238, v239
    v_mfma_f32_16x16x32_bf16 a[56:59], a[216:219], v[192:195], a[56:59]
    v_mfma_f32_16x16x32_bf16 a[56:59], a[220:223], v[200:203], a[56:59]
    v_add_u32 v3, s53, v56
    ds_read_b128 a[192:195], v3 offset:0
    v_mfma_f32_16x16x32_bf16 a[60:63], a[216:219], v[196:199], a[60:63]
    ds_read_b128 a[196:199], v3 offset:8192
    v_exp_f32 v241, v173
    v_mfma_f32_16x16x32_bf16 a[60:63], a[220:223], v[204:207], a[60:63]
    s_waitcnt lgkmcnt(8)
    buffer_load_dwordx4 v92, s[12:15], s61 offen offset:2048 lds
    buffer_load_dwordx4 v93, s[12:15], s61 offen offset:3072 lds
    ds_read_b128 a[200:203], v3 offset:1024
    v_mfma_f32_16x16x32_bf16 a[72:75], a[224:227], v[192:195], a[72:75]
    v_exp_f32 v242, v174
    v_cvt_pk_bf16_f32 v220, v240, v241
    v_mfma_f32_16x16x32_bf16 a[72:75], a[228:231], v[200:203], a[72:75]
    ds_read_b128 a[204:207], v3 offset:9216
    ds_read_b128 a[208:211], v3 offset:2048
    v_or3_b32 v57, v57, v215, v220
    v_mfma_f32_16x16x32_bf16 a[76:79], a[224:227], v[196:199], a[76:79]
    s_add_u32 s61, s61, 0x20000
    s_and_b32 s61, s61, 0x3fffff
    ds_read_b128 a[212:215], v3 offset:10240
    v_exp_f32 v243, v175
    v_mfma_f32_16x16x32_bf16 a[76:79], a[228:231], v[204:207], a[76:79]
    s_waitcnt lgkmcnt(10)
    ds_read_b128 a[216:219], v3 offset:3072
    s_add_u32 m0, s60, 32768
    v_mfma_f32_16x16x32_bf16 a[88:91], a[232:235], v[192:195], a[88:91]
    buffer_load_dwordx4 v90, s[12:15], s61 offen offset:0 lds
    ds_read_b128 a[220:223], v3 offset:11264
    v_mfma_f32_16x16x32_bf16 a[88:91], a[236:239], v[200:203], a[88:91]
    v_exp_f32 v244, v188
    v_cvt_pk_bf16_f32 v221, v242, v243
    v_mfma_f32_16x16x32_bf16 a[92:95], a[232:235], v[196:199], a[92:95]
    buffer_load_dwordx4 v91, s[12:15], s61 offen offset:1024 lds
    ds_read_b128 a[224:227], v3 offset:4096
    v_mfma_f32_16x16x32_bf16 a[92:95], a[236:239], v[204:207], a[92:95]
    s_waitcnt lgkmcnt(11)
    ds_read_b128 a[228:231], v3 offset:12288
    v_exp_f32 v245, v189
    v_mfma_f32_16x16x32_bf16 a[104:107], a[240:243], v[192:195], a[104:107]
    buffer_load_dwordx4 v92, s[12:15], s61 offen offset:2048 lds
    ds_read_b128 a[232:235], v3 offset:5120
    v_mfma_f32_16x16x32_bf16 a[104:107], a[244:247], v[200:203], a[104:107]
    v_exp_f32 v246, v190
    v_mfma_f32_16x16x32_bf16 a[108:111], a[240:243], v[196:199], a[108:111]
    ds_read_b128 a[236:239], v3 offset:13312
    v_cvt_pk_bf16_f32 v222, v244, v245
    v_or3_b32 v57, v57, v221, v222
    v_mfma_f32_16x16x32_bf16 a[108:111], a[244:247], v[204:207], a[108:111]
    s_waitcnt lgkmcnt(12)
    v_exp_f32 v247, v191
    v_mfma_f32_16x16x32_bf16 a[120:123], a[248:251], v[192:195], a[120:123]
    buffer_load_dwordx4 v93, s[12:15], s61 offen offset:3072 lds
    ds_read_b128 a[240:243], v3 offset:6144
    ds_read_b128 a[244:247], v3 offset:14336
    v_mfma_f32_16x16x32_bf16 a[120:123], a[252:255], v[200:203], a[120:123]
    s_add_u32 s61, s61, 0x20000
    s_and_b32 s61, s61, 0x3fffff
    v_cvt_pk_bf16_f32 v223, v246, v247
    v_bitop3_b32 v57, v57, v223, s37 bitop3:0xa8
    v_mfma_f32_16x16x32_bf16 a[124:127], a[248:251], v[196:199], a[124:127]
    v_cmp_ne_u32 vcc, 0, v57
    v_mfma_f32_16x16x32_bf16 a[124:127], a[252:255], v[204:207], a[124:127]
    buffer_load_dword v74, v73, s[16:19], s59 offen sc1
    ds_read_b128 a[248:251], v3 offset:7168
    ds_read_b128 a[252:255], v3 offset:15360
    s_cbranch_vccnz k2_tramp_120
k2_ret_121:
    v_lshrrev_b32 v6, 4, v1
    v_and_b32 v6, 31, v6
    s_getpc_b64 s[40:41]
pc_124:
    s_add_u32 s40, s40, op_head-pc_124
    s_addc_u32 s41, s41, 0
    v_lshlrev_b32 v224, 7, v6
    v_mov_b32 v225, s41
    v_add_co_u32 v224, vcc, s40, v224
    s_nop 1
    v_addc_co_u32 v225, vcc, 0, v225, vcc
    global_load_dword v7, v[224:225], off
    v_mfma_f32_16x16x32_bf16 v[252:255], v[60:63], v[212:215], v[252:255]
    s_lshl_b32 s31, s28, 19
    v_mov_b32 v249, v248
    s_nop 1
    v_permlane16_swap_b32 v248, v249
    v_mfma_f32_16x16x32_bf16 v[252:255], v[60:63], v[220:223], v[252:255]
    s_waitcnt lgkmcnt(0)
    s_nop 1
    v_add_f32 v248, v248, v249
    v_mov_b32 v249, v248
    v_mfma_f32_16x16x32_bf16 a[12:15], a[192:195], v[212:215], a[12:15]
    s_lshl_b32 s44, s39, 6
    s_nop 1
    v_permlane32_swap_b32 v248, v249
    s_nop 1
    v_mfma_f32_16x16x32_bf16 a[12:15], a[196:199], v[220:223], a[12:15]
    s_add_u32 s44, s44, s31
    s_add_u32 s45, s44, 131072
    v_add_f32 v248, v248, v249
    v_rcp_f32 v249, v248
    v_mfma_f32_16x16x32_bf16 a[28:31], a[200:203], v[212:215], a[28:31]
    s_add_u32 s46, s44, 262144
    v_rcp_f32 v248, v248
    s_nop 0
    s_add_u32 s47, s44, 393216
    v_mfma_f32_16x16x32_bf16 a[28:31], a[204:207], v[220:223], a[28:31]
    s_add_u32 s48, s44, 4096
    v_accvgpr_read_b32 v132, a8
    v_accvgpr_read_b32 v133, a9
    v_accvgpr_read_b32 v134, a10
    v_mfma_f32_16x16x32_bf16 a[44:47], a[208:211], v[212:215], a[44:47]
    s_add_u32 s49, s44, 135168
    v_accvgpr_read_b32 v135, a11
    v_accvgpr_read_b32 v136, a24
    v_accvgpr_read_b32 v137, a25
    v_mfma_f32_16x16x32_bf16 a[44:47], a[212:215], v[220:223], a[44:47]
    s_add_u32 s50, s44, 266240
    v_accvgpr_read_b32 v138, a26
    v_accvgpr_read_b32 v139, a27
    v_mul_f32 v132, v132, v248
    v_mfma_f32_16x16x32_bf16 a[60:63], a[216:219], v[212:215], a[60:63]
    s_add_u32 s51, s44, 397312
    v_mul_f32 v133, v133, v248
    v_mul_f32 v134, v134, v248
    v_mul_f32 v135, v135, v248
    v_mfma_f32_16x16x32_bf16 a[60:63], a[220:223], v[220:223], a[60:63]
    v_mul_f32 v136, v136, v248
    v_mul_f32 v137, v137, v248
    v_mul_f32 v138, v138, v248
    v_mfma_f32_16x16x32_bf16 a[76:79], a[224:227], v[212:215], a[76:79]
    v_mul_f32 v139, v139, v248
    v_cvt_pk_bf16_f32 v128, v132, v133
    v_cvt_pk_bf16_f32 v129, v134, v135
    v_mfma_f32_16x16x32_bf16 a[76:79], a[228:231], v[220:223], a[76:79]
    v_cvt_pk_bf16_f32 v130, v136, v137
    v_cvt_pk_bf16_f32 v131, v138, v139
    buffer_store_dwordx4 v[128:131], v1, s[24:27], s44 offen sc1
    v_mfma_f32_16x16x32_bf16 a[92:95], a[232:235], v[212:215], a[92:95]
    v_accvgpr_read_b32 v144, a40
    v_accvgpr_read_b32 v145, a41
    v_accvgpr_read_b32 v146, a42
    v_mfma_f32_16x16x32_bf16 a[92:95], a[236:239], v[220:223], a[92:95]
    v_accvgpr_read_b32 v147, a43
    v_accvgpr_read_b32 v148, a56
    v_mov_b32 v253, v252
    v_mfma_f32_16x16x32_bf16 a[108:111], a[240:243], v[212:215], a[108:111]
    v_accvgpr_read_b32 v149, a57
    v_accvgpr_read_b32 v150, a58
    s_nop 1
    v_mfma_f32_16x16x32_bf16 a[108:111], a[244:247], v[220:223], a[108:111]
    v_accvgpr_read_b32 v151, a59
    v_permlane16_swap_b32 v252, v253
    v_mul_f32 v144, v144, v248
    v_mfma_f32_16x16x32_bf16 a[124:127], a[248:251], v[212:215], a[124:127]
    s_nop 1
    v_mul_f32 v145, v145, v248
    v_add_f32 v252, v252, v253
    v_mfma_f32_16x16x32_bf16 a[124:127], a[252:255], v[220:223], a[124:127]
    v_mul_f32 v146, v146, v248
    v_mov_b32 v253, v252
    v_mul_f32 v147, v147, v248
    s_nop 1
    v_mul_f32 v148, v148, v248
    v_mul_f32 v149, v149, v248
    v_permlane32_swap_b32 v252, v253
    v_mul_f32 v150, v150, v248
    s_nop 1
    v_mul_f32 v151, v151, v248
    v_add_f32 v252, v252, v253
    v_cvt_pk_bf16_f32 v140, v144, v145
    v_rcp_f32 v253, v252
    v_cvt_pk_bf16_f32 v141, v146, v147
    v_rcp_f32 v252, v252
    v_cvt_pk_bf16_f32 v142, v148, v149
    s_nop 0
    v_cvt_pk_bf16_f32 v143, v150, v151
    buffer_store_dwordx4 v[140:143], v1, s[24:27], s45 offen sc1
    v_accvgpr_read_b32 v156, a72
    v_accvgpr_read_b32 v157, a73
    v_accvgpr_read_b32 v158, a74
    v_accvgpr_read_b32 v159, a75
    v_accvgpr_read_b32 v160, a88
    v_accvgpr_read_b32 v161, a89
    v_accvgpr_read_b32 v162, a90
    v_accvgpr_read_b32 v163, a91
    v_mul_f32 v156, v156, v248
    v_mul_f32 v157, v157, v248
    v_mul_f32 v158, v158, v248
    v_mul_f32 v159, v159, v248
    v_mul_f32 v160, v160, v248
    v_mul_f32 v161, v161, v248
    v_mul_f32 v162, v162, v248
    v_mul_f32 v163, v163, v248
    v_cvt_pk_bf16_f32 v152, v156, v157
    v_cvt_pk_bf16_f32 v153, v158, v159
    v_cvt_pk_bf16_f32 v154, v160, v161
    v_cvt_pk_bf16_f32 v155, v162, v163
    buffer_store_dwordx4 v[152:155], v1, s[24:27], s46 offen sc1
    v_accvgpr_read_b32 v168, a104
    v_accvgpr_read_b32 v169, a105
    v_accvgpr_read_b32 v170, a106
    v_accvgpr_read_b32 v171, a107
    v_accvgpr_read_b32 v172, a120
    v_accvgpr_read_b32 v173, a121
    v_accvgpr_read_b32 v174, a122
    v_accvgpr_read_b32 v175, a123
    v_mul_f32 v168, v168, v248
    v_mul_f32 v169, v169, v248
    v_mul_f32 v170, v170, v248
    v_mul_f32 v171, v171, v248
    v_mul_f32 v172, v172, v248
    v_mul_f32 v173, v173, v248
    v_mul_f32 v174, v174, v248
    v_mul_f32 v175, v175, v248
    v_cvt_pk_bf16_f32 v164, v168, v169
    v_cvt_pk_bf16_f32 v165, v170, v171
    v_cvt_pk_bf16_f32 v166, v172, v173
    v_cvt_pk_bf16_f32 v167, v174, v175
    buffer_store_dwordx4 v[164:167], v1, s[24:27], s47 offen sc1
    v_accvgpr_read_b32 v132, a12
    v_accvgpr_read_b32 v133, a13
    v_accvgpr_read_b32 v134, a14
    v_accvgpr_read_b32 v135, a15
    v_accvgpr_read_b32 v136, a28
    v_accvgpr_read_b32 v137, a29
    v_accvgpr_read_b32 v138, a30
    v_accvgpr_read_b32 v139, a31
    v_pk_mul_f32 v[132:133], v[132:133], v[252:253]
    v_pk_mul_f32 v[134:135], v[134:135], v[252:253]
    v_pk_mul_f32 v[136:137], v[136:137], v[252:253]
    v_pk_mul_f32 v[138:139], v[138:139], v[252:253]
    v_cvt_pk_bf16_f32 v128, v132, v133
    v_cvt_pk_bf16_f32 v129, v134, v135
    v_cvt_pk_bf16_f32 v130, v136, v137
    v_cvt_pk_bf16_f32 v131, v138, v139
    v_accvgpr_read_b32 v144, a44
    v_accvgpr_read_b32 v145, a45
    v_accvgpr_read_b32 v146, a46
    v_accvgpr_read_b32 v147, a47
    v_accvgpr_read_b32 v148, a60
    v_accvgpr_read_b32 v149, a61
    v_accvgpr_read_b32 v150, a62
    v_accvgpr_read_b32 v151, a63
    v_pk_mul_f32 v[144:145], v[144:145], v[252:253]
    v_pk_mul_f32 v[146:147], v[146:147], v[252:253]
    v_pk_mul_f32 v[148:149], v[148:149], v[252:253]
    v_pk_mul_f32 v[150:151], v[150:151], v[252:253]
    v_cvt_pk_bf16_f32 v140, v144, v145
    v_cvt_pk_bf16_f32 v141, v146, v147
    v_cvt_pk_bf16_f32 v142, v148, v149
    v_cvt_pk_bf16_f32 v143, v150, v151
    v_accvgpr_read_b32 v156, a76
    v_accvgpr_read_b32 v157, a77
    v_accvgpr_read_b32 v158, a78
    v_accvgpr_read_b32 v159, a79
    v_accvgpr_read_b32 v160, a92
    v_accvgpr_read_b32 v161, a93
    v_accvgpr_read_b32 v162, a94
    v_accvgpr_read_b32 v163, a95
    v_pk_mul_f32 v[156:157], v[156:157], v[252:253]
    v_pk_mul_f32 v[158:159], v[158:159], v[252:253]
    v_pk_mul_f32 v[160:161], v[160:161], v[252:253]
    v_pk_mul_f32 v[162:163], v[162:163], v[252:253]
    v_cvt_pk_bf16_f32 v152, v156, v157
    v_cvt_pk_bf16_f32 v153, v158, v159
    v_cvt_pk_bf16_f32 v154, v160, v161
    v_cvt_pk_bf16_f32 v155, v162, v163
    v_accvgpr_read_b32 v168, a108
    v_accvgpr_read_b32 v169, a109
    v_accvgpr_read_b32 v170, a110
    v_accvgpr_read_b32 v171, a111
    v_accvgpr_read_b32 v172, a124
    v_accvgpr_read_b32 v173, a125
    v_accvgpr_read_b32 v174, a126
    v_accvgpr_read_b32 v175, a127
    v_pk_mul_f32 v[168:169], v[168:169], v[252:253]
    v_pk_mul_f32 v[170:171], v[170:171], v[252:253]
    v_pk_mul_f32 v[172:173], v[172:173], v[252:253]
    v_pk_mul_f32 v[174:175], v[174:175], v[252:253]
    v_cvt_pk_bf16_f32 v164, v168, v169
    v_cvt_pk_bf16_f32 v165, v170, v171
    v_cvt_pk_bf16_f32 v166, v172, v173
    v_cvt_pk_bf16_f32 v167, v174, v175
    buffer_store_dwordx4 v[128:131], v1, s[24:27], s48 offen sc1
    buffer_store_dwordx4 v[140:143], v1, s[24:27], s49 offen sc1
    buffer_store_dwordx4 v[152:155], v1, s[24:27], s50 offen sc1
    buffer_store_dwordx4 v[164:167], v1, s[24:27], s51 offen sc1
op_head:
    s_load_dwordx2 s[28:29], s[0:1], 0
    s_load_dwordx2 s[42:43], s[0:1], 56
    s_waitcnt vmcnt(8)
    v_cmp_le_u32 vcc, 4, v74
    v_mov_b32 v56, 0
    v_mov_b32 v57, 0
    v_mov_b32 v58, 0
    v_mov_b32 v59, 0
    s_nop 1
    v_mfma_f32_32x32x16_bf16 v[128:143], v[56:59], v[56:59], 0
    v_mfma_f32_32x32x16_bf16 v[144:159], v[56:59], v[56:59], 0
    v_mfma_f32_32x32x16_bf16 v[160:175], v[56:59], v[56:59], 0
    v_mfma_f32_32x32x16_bf16 v[176:191], v[56:59], v[56:59], 0
    s_mov_b32 s33, vcc_lo
    s_bitcmp1_b32 s33, 0
    s_cbranch_scc0 op_late_125
    buffer_load_dwordx4 a[128:131], v88, s[8:11], s62 offen offset:0 sc1
    buffer_load_dwordx4 a[132:135], v88, s[8:11], s62 offen offset:1024 sc1
    buffer_load_dwordx4 a[136:139], v89, s[8:11], s62 offen offset:0 sc1
    buffer_load_dwordx4 a[140:143], v89, s[8:11], s62 offen offset:1024 sc1
    s_add_u32 s62, s62, 0x40000
    s_and_b32 s62, s62, 0x7fffff
    buffer_load_dwordx4 a[144:147], v88, s[8:11], s62 offen offset:0 sc1
    buffer_load_dwordx4 a[148:151], v88, s[8:11], s62 offen offset:1024 sc1
    buffer_load_dwordx4 a[152:155], v89, s[8:11], s62 offen offset:0 sc1
    buffer_load_dwordx4 a[156:159], v89, s[8:11], s62 offen offset:1024 sc1
    s_add_u32 s62, s62, 0x40000
    s_and_b32 s62, s62, 0x7fffff
    buffer_load_dwordx4 a[160:163], v88, s[8:11], s62 offen offset:0 sc1
    buffer_load_dwordx4 a[164:167], v88, s[8:11], s62 offen offset:1024 sc1
    buffer_load_dwordx4 a[168:171], v89, s[8:11], s62 offen offset:0 sc1
    buffer_load_dwordx4 a[172:175], v89, s[8:11], s62 offen offset:1024 sc1
    s_add_u32 s62, s62, 0x40000
    s_and_b32 s62, s62, 0x7fffff
    s_waitcnt vmcnt(12)
    s_branch op_join_126
op_late_125:
    s_waitcnt vmcnt(0)
op_join_126:
    s_barrier
    s_cmp_eq_u32 s30, 0
    s_cbranch_scc1 k12_ool_127
k12_oolret_128:
    s_bitcmp0_b32 s33, 0
    s_cbranch_scc1 k12_ool_131
k12_oolret_132:
    ds_read_b64_tr_b16 a[0:1], v64 offset:0
    ds_read_b64_tr_b16 a[2:3], v64 offset:4096
    ds_read_b64_tr_b16 a[4:5], v65 offset:0
    ds_read_b64_tr_b16 a[6:7], v65 offset:4096
    ds_read_b64_tr_b16 a[8:9], v66 offset:0
    ds_read_b64_tr_b16 a[10:11], v66 offset:4096
    ds_read_b64_tr_b16 a[12:13], v67 offset:0
    ds_read_b64_tr_b16 a[14:15], v67 offset:4096
    ds_read_b64_tr_b16 a[16:17], v68 offset:0
    ds_read_b64_tr_b16 a[18:19], v68 offset:4096
    ds_read_b64_tr_b16 a[20:21], v69 offset:0
    ds_read_b64_tr_b16 a[22:23], v69 offset:4096
    ds_read_b64_tr_b16 a[24:25], v70 offset:0
    ds_read_b64_tr_b16 a[26:27], v70 offset:4096
    ds_read_b64_tr_b16 a[28:29], v71 offset:0
    ds_read_b64_tr_b16 a[30:31], v71 offset:4096
    ds_read_b64_tr_b16 a[32:33], v64 offset:8192
    ds_read_b64_tr_b16 a[34:35], v64 offset:12288
    ds_read_b64_tr_b16 a[36:37], v65 offset:8192
    ds_read_b64_tr_b16 a[38:39], v65 offset:12288
    ds_read_b64_tr_b16 a[40:41], v66 offset:8192
    ds_read_b64_tr_b16 a[42:43], v66 offset:12288
    ds_read_b64_tr_b16 a[44:45], v67 offset:8192
    ds_read_b64_tr_b16 a[46:47], v67 offset:12288
    ds_read_b64_tr_b16 a[48:49], v68 offset:8192
    ds_read_b64_tr_b16 a[50:51], v68 offset:12288
    ds_read_b64_tr_b16 a[52:53], v69 offset:8192
    ds_read_b64_tr_b16 a[54:55], v69 offset:12288
    ds_read_b64_tr_b16 a[56:57], v70 offset:8192
    ds_read_b64_tr_b16 a[58:59], v70 offset:12288
    ds_read_b64_tr_b16 a[60:61], v71 offset:8192
    ds_read_b64_tr_b16 a[62:63], v71 offset:12288
    s_add_u32 s24, s6, 0x4000000
    s_addc_u32 s25, s7, 0
    s_and_b32 s25, s25, 0xffff
    s_mov_b32 s26, 0x400000
    s_mov_b32 s27, 0x00020000
    s_add_u32 s36, s6, 0x5000000
    s_addc_u32 s37, s7, 0
    s_and_b32 s37, s37, 0xffff
    s_mov_b32 s38, 0x800000
    s_mov_b32 s39, 0x00020000
    s_add_u32 s48, s6, 0x4807000
    s_addc_u32 s49, s7, 0
    s_and_b32 s49, s49, 0xffff
    s_mov_b32 s50, 0x8000
    s_mov_b32 s51, 0x00020000
    s_lshl_b32 s52, s2, 14
    s_add_u32 s52, s52, s60
    s_xor_b32 s53, s52, 0x10000
    s_lshl_b32 s57, s2, 7
    s_xor_b32 s58, s57, 0x200
    v_lshrrev_b32 v56, 4, v1
    s_lshl_b32 s31, s30, 6
    s_and_b32 s31, s31, 64
    v_add_u32 v56, s31, v56
    s_mov_b32 s31, (code_end-op_tail)/128
    v_min_u32 v56, s31, v56
    s_getpc_b64 s[40:41]
pc_133:
    s_add_u32 s40, s40, op_tail-pc_133
    s_addc_u32 s41, s41, 0
    v_lshlrev_b32 v82, 7, v56
    v_mov_b32 v83, s41
    v_add_co_u32 v82, vcc, s40, v82
    s_nop 1
    v_addc_co_u32 v83, vcc, 0, v83, vcc
    v_lshlrev_b32 v94, 3, v1
    s_and_b32 s35, s2, 7
    s_mul_i32 s35, s35, 28
    s_lshr_b32 s31, s2, 3
    s_add_u32 s55, s35, s31
    s_lshl_b32 s3, s55, 15
    s_lshl_b32 s31, s30, 13
    s_add_u32 s3, s3, s31
    s_add_u32 s35, s31, 65536
    s_mov_b32 s63, 0
    s_waitcnt vmcnt(8) lgkmcnt(0)
    s_mov_b32 s20, s28
    s_and_b32 s21, s29, 0xffff
    s_mov_b32 s22, 0x400000
    s_mov_b32 s23, 0x00020000
    s_mov_b32 s44, s42
    s_and_b32 s45, s43, 0xffff
    s_mov_b32 s46, 0x800
    s_mov_b32 s47, 0x00020000
op_loop_134:
    v_mfma_f32_16x16x32_bf16 v[160:163], a[16:19], a[128:131], v[160:163]
    s_add_u32 m0, s60, 49152
    ds_read_b64_tr_b16 a[64:65], v64 offset:16384
    ds_read_b64_tr_b16 a[66:67], v64 offset:20480
    v_mfma_f32_16x16x32_bf16 v[160:163], a[48:51], a[136:139], v[160:163]
    buffer_load_dwordx4 v90, s[12:15], s61 offen offset:0 lds
    ds_read_b64_tr_b16 a[68:69], v65 offset:16384
    v_mfma_f32_16x16x32_bf16 v[164:167], a[16:19], a[132:135], v[164:167]
    ds_read_b64_tr_b16 a[70:71], v65 offset:20480
    ds_read_b64_tr_b16 a[72:73], v66 offset:16384
    v_mfma_f32_16x16x32_bf16 v[164:167], a[48:51], a[140:143], v[164:167]
    buffer_load_dwordx4 v91, s[12:15], s61 offen offset:1024 lds
    ds_read_b64_tr_b16 a[74:75], v66 offset:20480
    v_mfma_f32_16x16x32_bf16 v[168:171], a[20:23], a[128:131], v[168:171]
    ds_read_b64_tr_b16 a[76:77], v67 offset:16384
    ds_read_b64_tr_b16 a[78:79], v67 offset:20480
    v_mfma_f32_16x16x32_bf16 v[168:171], a[52:55], a[136:139], v[168:171]
    ds_read_b64_tr_b16 a[80:81], v68 offset:16384
    v_mfma_f32_16x16x32_bf16 v[172:175], a[20:23], a[132:135], v[172:175]
    ds_read_b64_tr_b16 a[82:83], v68 offset:20480
    v_mfma_f32_16x16x32_bf16 v[172:175], a[52:55], a[140:143], v[172:175]
    buffer_load_dwordx4 v92, s[12:15], s61 offen offset:2048 lds
    ds_read_b64_tr_b16 a[84:85], v69 offset:16384
    v_mfma_f32_16x16x32_bf16 v[176:179], a[24:27], a[128:131], v[176:179]
    ds_read_b64_tr_b16 a[86:87], v69 offset:20480
    ds_read_b64_tr_b16 a[88:89], v70 offset:16384
    v_mfma_f32_16x16x32_bf16 v[176:179], a[56:59], a[136:139], v[176:179]
    ds_read_b64_tr_b16 a[90:91], v70 offset:20480
    v_mfma_f32_16x16x32_bf16 v[180:183], a[24:27], a[132:135], v[180:183]
    buffer_load_dwordx4 v93, s[12:15], s61 offen offset:3072 lds
    ds_read_b64_tr_b16 a[92:93], v71 offset:16384
    v_mfma_f32_16x16x32_bf16 v[180:183], a[56:59], a[140:143], v[180:183]
    ds_read_b64_tr_b16 a[94:95], v71 offset:20480
    ds_read_b64_tr_b16 a[96:97], v64 offset:24576
    v_mfma_f32_16x16x32_bf16 v[184:187], a[28:31], a[128:131], v[184:187]
    ds_read_b64_tr_b16 a[98:99], v64 offset:28672
    v_mfma_f32_16x16x32_bf16 v[184:187], a[60:63], a[136:139], v[184:187]
    ds_read_b64_tr_b16 a[100:101], v65 offset:24576
    v_mfma_f32_16x16x32_bf16 v[188:191], a[28:31], a[132:135], v[188:191]
    buffer_load_dwordx4 a[176:179], v88, s[8:11], s62 offen offset:0 sc1
    ds_read_b64_tr_b16 a[102:103], v65 offset:28672
    v_mfma_f32_16x16x32_bf16 v[188:191], a[60:63], a[140:143], v[188:191]
    s_add_u32 s61, s61, 0x20000
    s_and_b32 s61, s61, 0x3fffff
    ds_read_b64_tr_b16 a[104:105], v66 offset:24576
    ds_read_b64_tr_b16 a[106:107], v66 offset:28672
    v_mfma_f32_16x16x32_bf16 v[128:131], a[0:3], a[128:131], v[128:131]
    ds_read_b64_tr_b16 a[108:109], v67 offset:24576
    v_mfma_f32_16x16x32_bf16 v[128:131], a[32:35], a[136:139], v[128:131]
    buffer_load_dwordx4 a[180:183], v88, s[8:11], s62 offen offset:1024 sc1
    ds_read_b64_tr_b16 a[110:111], v67 offset:28672
    v_mfma_f32_16x16x32_bf16 v[132:135], a[0:3], a[132:135], v[132:135]
    ds_read_b64_tr_b16 a[112:113], v68 offset:24576
    v_mfma_f32_16x16x32_bf16 v[132:135], a[32:35], a[140:143], v[132:135]
    ds_read_b64_tr_b16 a[114:115], v68 offset:28672
    ds_read_b64_tr_b16 a[116:117], v69 offset:24576
    v_mfma_f32_16x16x32_bf16 v[136:139], a[4:7], a[128:131], v[136:139]
    ds_read_b64_tr_b16 a[118:119], v69 offset:28672
    v_mfma_f32_16x16x32_bf16 v[136:139], a[36:39], a[136:139], v[136:139]
    buffer_load_dwordx4 a[184:187], v89, s[8:11], s62 offen offset:0 sc1
    ds_read_b64_tr_b16 a[120:121], v70 offset:24576
    v_mfma_f32_16x16x32_bf16 v[140:143], a[4:7], a[132:135], v[140:143]
    ds_read_b64_tr_b16 a[122:123], v70 offset:28672
    ds_read_b64_tr_b16 a[124:125], v71 offset:24576
    v_mfma_f32_16x16x32_bf16 v[140:143], a[36:39], a[140:143], v[140:143]
    ds_read_b64_tr_b16 a[126:127], v71 offset:28672
    v_mfma_f32_16x16x32_bf16 v[144:147], a[8:11], a[128:131], v[144:147]
    buffer_load_dwordx4 a[188:191], v89, s[8:11], s62 offen offset:1024 sc1
    v_mfma_f32_16x16x32_bf16 v[144:147], a[40:43], a[136:139], v[144:147]
    v_mfma_f32_16x16x32_bf16 v[148:151], a[8:11], a[132:135], v[148:151]
    v_mfma_f32_16x16x32_bf16 v[148:151], a[40:43], a[140:143], v[148:151]
    v_mfma_f32_16x16x32_bf16 v[152:155], a[12:15], a[128:131], v[152:155]
    s_cmp_eq_u32 s63, 7
    s_cbranch_scc1 k12_ool_137
k12_oolret_138:
    v_mfma_f32_16x16x32_bf16 v[152:155], a[44:47], a[136:139], v[152:155]
    s_add_u32 s62, s62, 0x40000
    s_and_b32 s62, s62, 0x7fffff
    v_mfma_f32_16x16x32_bf16 v[156:159], a[12:15], a[132:135], v[156:159]
    v_mfma_f32_16x16x32_bf16 v[156:159], a[44:47], a[140:143], v[156:159]
    s_waitcnt vmcnt(12) lgkmcnt(0)
    s_barrier
    v_mfma_f32_16x16x32_bf16 v[160:163], a[80:83], a[144:147], v[160:163]
    s_add_u32 s32, s63, 1
    s_lshr_b32 s32, s32, 1
    ds_read_b64_tr_b16 a[0:1], v64 offset:32768
    v_cmp_le_u32 vcc, 4, v74
    v_mfma_f32_16x16x32_bf16 v[160:163], a[112:115], a[152:155], v[160:163]
    s_add_u32 m0, s60, 0
    ds_read_b64_tr_b16 a[2:3], v64 offset:36864
    ds_read_b64_tr_b16 a[4:5], v65 offset:32768
    v_mfma_f32_16x16x32_bf16 v[164:167], a[80:83], a[148:151], v[164:167]
    s_or_b32 s33, vcc_lo, 16
    buffer_load_dwordx4 v90, s[12:15], s61 offen offset:0 lds
    ds_read_b64_tr_b16 a[6:7], v65 offset:36864
    v_mfma_f32_16x16x32_bf16 v[164:167], a[112:115], a[156:159], v[164:167]
    ds_read_b64_tr_b16 a[8:9], v66 offset:32768
    ds_read_b64_tr_b16 a[10:11], v66 offset:36864
    v_mfma_f32_16x16x32_bf16 v[168:171], a[84:87], a[144:147], v[168:171]
    buffer_load_dwordx4 v91, s[12:15], s61 offen offset:1024 lds
    ds_read_b64_tr_b16 a[12:13], v67 offset:32768
    v_mfma_f32_16x16x32_bf16 v[168:171], a[116:119], a[152:155], v[168:171]
    ds_read_b64_tr_b16 a[14:15], v67 offset:36864
    ds_read_b64_tr_b16 a[16:17], v68 offset:32768
    v_mfma_f32_16x16x32_bf16 v[172:175], a[84:87], a[148:151], v[172:175]
    s_bitcmp0_b32 s33, s32
    s_cbranch_scc1 k12_ool_141
k12_oolret_142:
    v_mfma_f32_16x16x32_bf16 v[172:175], a[116:119], a[156:159], v[172:175]
    ds_read_b64_tr_b16 a[18:19], v68 offset:36864
    ds_read_b64_tr_b16 a[20:21], v69 offset:32768
    v_mfma_f32_16x16x32_bf16 v[176:179], a[88:91], a[144:147], v[176:179]
    buffer_load_dwordx4 v92, s[12:15], s61 offen offset:2048 lds
    ds_read_b64_tr_b16 a[22:23], v69 offset:36864
    v_mfma_f32_16x16x32_bf16 v[176:179], a[120:123], a[152:155], v[176:179]
    ds_read_b64_tr_b16 a[24:25], v70 offset:32768
    ds_read_b64_tr_b16 a[26:27], v70 offset:36864
    v_mfma_f32_16x16x32_bf16 v[180:183], a[88:91], a[148:151], v[180:183]
    buffer_load_dwordx4 v93, s[12:15], s61 offen offset:3072 lds
    ds_read_b64_tr_b16 a[28:29], v71 offset:32768
    v_mfma_f32_16x16x32_bf16 v[180:183], a[120:123], a[156:159], v[180:183]
    ds_read_b64_tr_b16 a[30:31], v71 offset:36864
    ds_read_b64_tr_b16 a[32:33], v64 offset:40960
    v_mfma_f32_16x16x32_bf16 v[184:187], a[92:95], a[144:147], v[184:187]
    ds_read_b64_tr_b16 a[34:35], v64 offset:45056
    v_mfma_f32_16x16x32_bf16 v[184:187], a[124:127], a[152:155], v[184:187]
    ds_read_b64_tr_b16 a[36:37], v65 offset:40960
    v_mfma_f32_16x16x32_bf16 v[188:191], a[92:95], a[148:151], v[188:191]
    buffer_load_dwordx4 a[128:131], v88, s[8:11], s62 offen offset:0 sc1
    ds_read_b64_tr_b16 a[38:39], v65 offset:45056
    v_mfma_f32_16x16x32_bf16 v[188:191], a[124:127], a[156:159], v[188:191]
    s_add_u32 s61, s61, 0x20000
    s_and_b32 s61, s61, 0x3fffff
    ds_read_b64_tr_b16 a[40:41], v66 offset:40960
    ds_read_b64_tr_b16 a[42:43], v66 offset:45056
    v_mfma_f32_16x16x32_bf16 v[128:131], a[64:67], a[144:147], v[128:131]
    ds_read_b64_tr_b16 a[44:45], v67 offset:40960
    v_mfma_f32_16x16x32_bf16 v[128:131], a[96:99], a[152:155], v[128:131]
    buffer_load_dwordx4 a[132:135], v88, s[8:11], s62 offen offset:1024 sc1
    ds_read_b64_tr_b16 a[46:47], v67 offset:45056
    v_mfma_f32_16x16x32_bf16 v[132:135], a[64:67], a[148:151], v[132:135]
    ds_read_b64_tr_b16 a[48:49], v68 offset:40960
    v_mfma_f32_16x16x32_bf16 v[132:135], a[96:99], a[156:159], v[132:135]
    ds_read_b64_tr_b16 a[50:51], v68 offset:45056
    ds_read_b64_tr_b16 a[52:53], v69 offset:40960
    v_mfma_f32_16x16x32_bf16 v[136:139], a[68:71], a[144:147], v[136:139]
    ds_read_b64_tr_b16 a[54:55], v69 offset:45056
    v_mfma_f32_16x16x32_bf16 v[136:139], a[100:103], a[152:155], v[136:139]
    buffer_load_dwordx4 a[136:139], v89, s[8:11], s62 offen offset:0 sc1
    ds_read_b64_tr_b16 a[56:57], v70 offset:40960
    v_mfma_f32_16x16x32_bf16 v[140:143], a[68:71], a[148:151], v[140:143]
    ds_read_b64_tr_b16 a[58:59], v70 offset:45056
    ds_read_b64_tr_b16 a[60:61], v71 offset:40960
    v_mfma_f32_16x16x32_bf16 v[140:143], a[100:103], a[156:159], v[140:143]
    ds_read_b64_tr_b16 a[62:63], v71 offset:45056
    v_mfma_f32_16x16x32_bf16 v[144:147], a[72:75], a[144:147], v[144:147]
    buffer_load_dwordx4 a[140:143], v89, s[8:11], s62 offen offset:1024 sc1
    v_mfma_f32_16x16x32_bf16 v[144:147], a[104:107], a[152:155], v[144:147]
    v_mfma_f32_16x16x32_bf16 v[148:151], a[72:75], a[148:151], v[148:151]
    s_cmp_eq_u32 s63, 6
    s_cbranch_scc1 k12_ool_143
k12_oolret_144:
    v_mfma_f32_16x16x32_bf16 v[148:151], a[104:107], a[156:159], v[148:151]
    v_mfma_f32_16x16x32_bf16 v[152:155], a[76:79], a[144:147], v[152:155]
    v_mfma_f32_16x16x32_bf16 v[152:155], a[108:111], a[152:155], v[152:155]
    s_add_u32 s62, s62, 0x40000
    s_and_b32 s62, s62, 0x7fffff
    v_mfma_f32_16x16x32_bf16 v[156:159], a[76:79], a[148:151], v[156:159]
    v_mfma_f32_16x16x32_bf16 v[156:159], a[108:111], a[156:159], v[156:159]
    s_waitcnt vmcnt(12) lgkmcnt(0)
    s_barrier
    v_mfma_f32_16x16x32_bf16 v[160:163], a[16:19], a[160:163], v[160:163]
    s_add_u32 m0, s60, 16384
    buffer_load_dword v74, v73, s[16:19], s59 offen sc1
    ds_read_b64_tr_b16 a[64:65], v64 offset:49152
    v_mfma_f32_16x16x32_bf16 v[160:163], a[48:51], a[168:171], v[160:163]
    buffer_load_dwordx4 v90, s[12:15], s61 offen offset:0 lds
    ds_read_b64_tr_b16 a[66:67], v64 offset:53248
    v_mfma_f32_16x16x32_bf16 v[164:167], a[16:19], a[164:167], v[164:167]
    ds_read_b64_tr_b16 a[68:69], v65 offset:49152
    ds_read_b64_tr_b16 a[70:71], v65 offset:53248
    v_mfma_f32_16x16x32_bf16 v[164:167], a[48:51], a[172:175], v[164:167]
    ds_read_b64_tr_b16 a[72:73], v66 offset:49152
    ds_read_b64_tr_b16 a[74:75], v66 offset:53248
    v_mfma_f32_16x16x32_bf16 v[168:171], a[20:23], a[160:163], v[168:171]
    buffer_load_dwordx4 v91, s[12:15], s61 offen offset:1024 lds
    ds_read_b64_tr_b16 a[76:77], v67 offset:49152
    v_mfma_f32_16x16x32_bf16 v[168:171], a[52:55], a[168:171], v[168:171]
    ds_read_b64_tr_b16 a[78:79], v67 offset:53248
    ds_read_b64_tr_b16 a[80:81], v68 offset:49152
    v_mfma_f32_16x16x32_bf16 v[172:175], a[20:23], a[164:167], v[172:175]
    ds_read_b64_tr_b16 a[82:83], v68 offset:53248
    v_mfma_f32_16x16x32_bf16 v[172:175], a[52:55], a[172:175], v[172:175]
    buffer_load_dwordx4 v92, s[12:15], s61 offen offset:2048 lds
    ds_read_b64_tr_b16 a[84:85], v69 offset:49152
    v_mfma_f32_16x16x32_bf16 v[176:179], a[24:27], a[160:163], v[176:179]
    ds_read_b64_tr_b16 a[86:87], v69 offset:53248
    ds_read_b64_tr_b16 a[88:89], v70 offset:49152
    v_mfma_f32_16x16x32_bf16 v[176:179], a[56:59], a[168:171], v[176:179]
    ds_read_b64_tr_b16 a[90:91], v70 offset:53248
    v_mfma_f32_16x16x32_bf16 v[180:183], a[24:27], a[164:167], v[180:183]
    buffer_load_dwordx4 v93, s[12:15], s61 offen offset:3072 lds
    ds_read_b64_tr_b16 a[92:93], v71 offset:49152
    v_mfma_f32_16x16x32_bf16 v[180:183], a[56:59], a[172:175], v[180:183]
    ds_read_b64_tr_b16 a[94:95], v71 offset:53248
    ds_read_b64_tr_b16 a[96:97], v64 offset:57344
    v_mfma_f32_16x16x32_bf16 v[184:187], a[28:31], a[160:163], v[184:187]
    ds_read_b64_tr_b16 a[98:99], v64 offset:61440
    v_mfma_f32_16x16x32_bf16 v[184:187], a[60:63], a[168:171], v[184:187]
    ds_read_b64_tr_b16 a[100:101], v65 offset:57344
    v_mfma_f32_16x16x32_bf16 v[188:191], a[28:31], a[164:167], v[188:191]
    buffer_load_dwordx4 a[144:147], v88, s[8:11], s62 offen offset:0 sc1
    ds_read_b64_tr_b16 a[102:103], v65 offset:61440
    v_mfma_f32_16x16x32_bf16 v[188:191], a[60:63], a[172:175], v[188:191]
    s_add_u32 s61, s61, 0x20000
    s_and_b32 s61, s61, 0x3fffff
    ds_read_b64_tr_b16 a[104:105], v66 offset:57344
    ds_read_b64_tr_b16 a[106:107], v66 offset:61440
    v_mfma_f32_16x16x32_bf16 v[128:131], a[0:3], a[160:163], v[128:131]
    ds_read_b64_tr_b16 a[108:109], v67 offset:57344
    v_mfma_f32_16x16x32_bf16 v[128:131], a[32:35], a[168:171], v[128:131]
    buffer_load_dwordx4 a[148:151], v88, s[8:11], s62 offen offset:1024 sc1
    ds_read_b64_tr_b16 a[110:111], v67 offset:61440
    v_mfma_f32_16x16x32_bf16 v[132:135], a[0:3], a[164:167], v[132:135]
    ds_read_b64_tr_b16 a[112:113], v68 offset:57344
    v_mfma_f32_16x16x32_bf16 v[132:135], a[32:35], a[172:175], v[132:135]
    ds_read_b64_tr_b16 a[114:115], v68 offset:61440
    ds_read_b64_tr_b16 a[116:117], v69 offset:57344
    v_mfma_f32_16x16x32_bf16 v[136:139], a[4:7], a[160:163], v[136:139]
    ds_read_b64_tr_b16 a[118:119], v69 offset:61440
    v_mfma_f32_16x16x32_bf16 v[136:139], a[36:39], a[168:171], v[136:139]
    buffer_load_dwordx4 a[152:155], v89, s[8:11], s62 offen offset:0 sc1
    ds_read_b64_tr_b16 a[120:121], v70 offset:57344
    v_mfma_f32_16x16x32_bf16 v[140:143], a[4:7], a[164:167], v[140:143]
    ds_read_b64_tr_b16 a[122:123], v70 offset:61440
    ds_read_b64_tr_b16 a[124:125], v71 offset:57344
    v_mfma_f32_16x16x32_bf16 v[140:143], a[36:39], a[172:175], v[140:143]
    ds_read_b64_tr_b16 a[126:127], v71 offset:61440
    v_mfma_f32_16x16x32_bf16 v[144:147], a[8:11], a[160:163], v[144:147]
    buffer_load_dwordx4 a[156:159], v89, s[8:11], s62 offen offset:1024 sc1
    v_mfma_f32_16x16x32_bf16 v[144:147], a[40:43], a[168:171], v[144:147]
    v_mfma_f32_16x16x32_bf16 v[148:151], a[8:11], a[164:167], v[148:151]
    v_mfma_f32_16x16x32_bf16 v[148:151], a[40:43], a[172:175], v[148:151]
    v_mfma_f32_16x16x32_bf16 v[152:155], a[12:15], a[160:163], v[152:155]
    v_mfma_f32_16x16x32_bf16 v[152:155], a[44:47], a[168:171], v[152:155]
    s_add_u32 s62, s62, 0x40000
    s_and_b32 s62, s62, 0x7fffff
    v_mfma_f32_16x16x32_bf16 v[156:159], a[12:15], a[164:167], v[156:159]
    v_mfma_f32_16x16x32_bf16 v[156:159], a[44:47], a[172:175], v[156:159]
    s_waitcnt vmcnt(12) lgkmcnt(0)
    s_barrier
    v_mfma_f32_16x16x32_bf16 v[160:163], a[80:83], a[176:179], v[160:163]
    s_add_u32 m0, s60, 32768
    ds_read_b64_tr_b16 a[0:1], v64 offset:0
    ds_read_b64_tr_b16 a[2:3], v64 offset:4096
    v_mfma_f32_16x16x32_bf16 v[160:163], a[112:115], a[184:187], v[160:163]
    buffer_load_dwordx4 v90, s[12:15], s61 offen offset:0 lds
    ds_read_b64_tr_b16 a[4:5], v65 offset:0
    v_mfma_f32_16x16x32_bf16 v[164:167], a[80:83], a[180:183], v[164:167]
    ds_read_b64_tr_b16 a[6:7], v65 offset:4096
    ds_read_b64_tr_b16 a[8:9], v66 offset:0
    v_mfma_f32_16x16x32_bf16 v[164:167], a[112:115], a[188:191], v[164:167]
    buffer_load_dwordx4 v91, s[12:15], s61 offen offset:1024 lds
    ds_read_b64_tr_b16 a[10:11], v66 offset:4096
    v_mfma_f32_16x16x32_bf16 v[168:171], a[84:87], a[176:179], v[168:171]
    ds_read_b64_tr_b16 a[12:13], v67 offset:0
    ds_read_b64_tr_b16 a[14:15], v67 offset:4096
    v_mfma_f32_16x16x32_bf16 v[168:171], a[116:119], a[184:187], v[168:171]
    ds_read_b64_tr_b16 a[16:17], v68 offset:0
    v_mfma_f32_16x16x32_bf16 v[172:175], a[84:87], a[180:183], v[172:175]
    ds_read_b64_tr_b16 a[18:19], v68 offset:4096
    v_mfma_f32_16x16x32_bf16 v[172:175], a[116:119], a[188:191], v[172:175]
    buffer_load_dwordx4 v92, s[12:15], s61 offen offset:2048 lds
    ds_read_b64_tr_b16 a[20:21], v69 offset:0
    v_mfma_f32_16x16x32_bf16 v[176:179], a[88:91], a[176:179], v[176:179]
    ds_read_b64_tr_b16 a[22:23], v69 offset:4096
    ds_read_b64_tr_b16 a[24:25], v70 offset:0
    v_mfma_f32_16x16x32_bf16 v[176:179], a[120:123], a[184:187], v[176:179]
    ds_read_b64_tr_b16 a[26:27], v70 offset:4096
    v_mfma_f32_16x16x32_bf16 v[180:183], a[88:91], a[180:183], v[180:183]
    buffer_load_dwordx4 v93, s[12:15], s61 offen offset:3072 lds
    ds_read_b64_tr_b16 a[28:29], v71 offset:0
    v_mfma_f32_16x16x32_bf16 v[180:183], a[120:123], a[188:191], v[180:183]
    ds_read_b64_tr_b16 a[30:31], v71 offset:4096
    ds_read_b64_tr_b16 a[32:33], v64 offset:8192
    v_mfma_f32_16x16x32_bf16 v[184:187], a[92:95], a[176:179], v[184:187]
    ds_read_b64_tr_b16 a[34:35], v64 offset:12288
    v_mfma_f32_16x16x32_bf16 v[184:187], a[124:127], a[184:187], v[184:187]
    ds_read_b64_tr_b16 a[36:37], v65 offset:8192
    v_mfma_f32_16x16x32_bf16 v[188:191], a[92:95], a[180:183], v[188:191]
    buffer_load_dwordx4 a[160:163], v88, s[8:11], s62 offen offset:0 sc1
    ds_read_b64_tr_b16 a[38:39], v65 offset:12288
    v_mfma_f32_16x16x32_bf16 v[188:191], a[124:127], a[188:191], v[188:191]
    s_add_u32 s61, s61, 0x20000
    s_and_b32 s61, s61, 0x3fffff
    ds_read_b64_tr_b16 a[40:41], v66 offset:8192
    ds_read_b64_tr_b16 a[42:43], v66 offset:12288
    v_mfma_f32_16x16x32_bf16 v[128:131], a[64:67], a[176:179], v[128:131]
    ds_read_b64_tr_b16 a[44:45], v67 offset:8192
    v_mfma_f32_16x16x32_bf16 v[128:131], a[96:99], a[184:187], v[128:131]
    buffer_load_dwordx4 a[164:167], v88, s[8:11], s62 offen offset:1024 sc1
    ds_read_b64_tr_b16 a[46:47], v67 offset:12288
    v_mfma_f32_16x16x32_bf16 v[132:135], a[64:67], a[180:183], v[132:135]
    ds_read_b64_tr_b16 a[48:49], v68 offset:8192
    v_mfma_f32_16x16x32_bf16 v[132:135], a[96:99], a[188:191], v[132:135]
    ds_read_b64_tr_b16 a[50:51], v68 offset:12288
    ds_read_b64_tr_b16 a[52:53], v69 offset:8192
    v_mfma_f32_16x16x32_bf16 v[136:139], a[68:71], a[176:179], v[136:139]
    ds_read_b64_tr_b16 a[54:55], v69 offset:12288
    v_mfma_f32_16x16x32_bf16 v[136:139], a[100:103], a[184:187], v[136:139]
    buffer_load_dwordx4 a[168:171], v89, s[8:11], s62 offen offset:0 sc1
    ds_read_b64_tr_b16 a[56:57], v70 offset:8192
    v_mfma_f32_16x16x32_bf16 v[140:143], a[68:71], a[180:183], v[140:143]
    ds_read_b64_tr_b16 a[58:59], v70 offset:12288
    ds_read_b64_tr_b16 a[60:61], v71 offset:8192
    v_mfma_f32_16x16x32_bf16 v[140:143], a[100:103], a[188:191], v[140:143]
    ds_read_b64_tr_b16 a[62:63], v71 offset:12288
    v_mfma_f32_16x16x32_bf16 v[144:147], a[72:75], a[176:179], v[144:147]
    buffer_load_dwordx4 a[172:175], v89, s[8:11], s62 offen offset:1024 sc1
    v_mfma_f32_16x16x32_bf16 v[144:147], a[104:107], a[184:187], v[144:147]
    v_mfma_f32_16x16x32_bf16 v[148:151], a[72:75], a[180:183], v[148:151]
    v_mfma_f32_16x16x32_bf16 v[148:151], a[104:107], a[188:191], v[148:151]
    v_mfma_f32_16x16x32_bf16 v[152:155], a[76:79], a[176:179], v[152:155]
    v_mfma_f32_16x16x32_bf16 v[152:155], a[108:111], a[184:187], v[152:155]
    s_add_u32 s62, s62, 0x40000
    s_and_b32 s62, s62, 0x7fffff
    v_mfma_f32_16x16x32_bf16 v[156:159], a[76:79], a[180:183], v[156:159]
    s_add_u32 s63, s63, 1
    v_mfma_f32_16x16x32_bf16 v[156:159], a[108:111], a[188:191], v[156:159]
    s_waitcnt vmcnt(12) lgkmcnt(0)
    s_barrier
    s_cmp_lt_u32 s63, 8
    s_cbranch_scc1 op_loop_134
op_tail:
    s_nop 1
    v_cvt_pk_bf16_f32 v160, v160, v161
    v_cvt_pk_bf16_f32 v161, v162, v163
    v_cvt_pk_bf16_f32 v162, v164, v165
    v_cvt_pk_bf16_f32 v163, v166, v167
    v_min_u32 v160, -2, v160
    v_min_u32 v161, -2, v161
    v_min_u32 v162, -2, v162
    v_min_u32 v163, -2, v163
    buffer_store_dwordx4 v[160:163], v1, s[36:39], s52 offen offset:0 sc1
    v_cvt_pk_bf16_f32 v168, v168, v169
    v_cvt_pk_bf16_f32 v169, v170, v171
    v_cvt_pk_bf16_f32 v170, v172, v173
    v_cvt_pk_bf16_f32 v171, v174, v175
    v_min_u32 v168, -2, v168
    v_min_u32 v169, -2, v169
    v_min_u32 v170, -2, v170
    v_min_u32 v171, -2, v171
    buffer_store_dwordx4 v[168:171], v1, s[36:39], s52 offen offset:1024 sc1
    v_cvt_pk_bf16_f32 v176, v176, v177
    v_cvt_pk_bf16_f32 v177, v178, v179
    v_cvt_pk_bf16_f32 v178, v180, v181
    v_cvt_pk_bf16_f32 v179, v182, v183
    v_min_u32 v176, -2, v176
    v_min_u32 v177, -2, v177
    v_min_u32 v178, -2, v178
    v_min_u32 v179, -2, v179
    buffer_store_dwordx4 v[176:179], v1, s[36:39], s52 offen offset:2048 sc1
    v_cvt_pk_bf16_f32 v184, v184, v185
    v_cvt_pk_bf16_f32 v185, v186, v187
    v_cvt_pk_bf16_f32 v186, v188, v189
    v_cvt_pk_bf16_f32 v187, v190, v191
    v_min_u32 v184, -2, v184
    v_min_u32 v185, -2, v185
    v_min_u32 v186, -2, v186
    v_min_u32 v187, -2, v187
    buffer_store_dwordx4 v[184:187], v1, s[36:39], s52 offen offset:3072 sc1
    s_add_u32 s32, s6, 0x4800000
    s_addc_u32 s33, s7, 0
    s_and_b32 s33, s33, 0xffff
    s_mov_b32 s34, 0x6000
    s_mov_b32 s35, 0x00020000
    s_waitcnt vmcnt(4) lgkmcnt(0)
    v_lshlrev_b32 v58, 16, v192
    v_and_b32 v59, 0xffff0000, v192
    v_pk_add_f32 v[128:129], v[128:129], v[58:59]
    v_lshlrev_b32 v58, 16, v193
    v_and_b32 v59, 0xffff0000, v193
    v_pk_add_f32 v[130:131], v[130:131], v[58:59]
    v_lshlrev_b32 v58, 16, v200
    v_and_b32 v59, 0xffff0000, v200
    v_pk_add_f32 v[132:133], v[132:133], v[58:59]
    v_lshlrev_b32 v58, 16, v201
    v_and_b32 v59, 0xffff0000, v201
    v_pk_add_f32 v[134:135], v[134:135], v[58:59]
    v_lshlrev_b32 v58, 16, v194
    v_and_b32 v59, 0xffff0000, v194
    v_pk_add_f32 v[136:137], v[136:137], v[58:59]
    v_lshlrev_b32 v58, 16, v195
    v_and_b32 v59, 0xffff0000, v195
    v_pk_add_f32 v[138:139], v[138:139], v[58:59]
    v_lshlrev_b32 v58, 16, v202
    v_and_b32 v59, 0xffff0000, v202
    v_pk_add_f32 v[140:141], v[140:141], v[58:59]
    v_lshlrev_b32 v58, 16, v203
    v_and_b32 v59, 0xffff0000, v203
    v_pk_add_f32 v[142:143], v[142:143], v[58:59]
    v_lshlrev_b32 v58, 16, v196
    v_and_b32 v59, 0xffff0000, v196
    v_pk_add_f32 v[144:145], v[144:145], v[58:59]
    v_lshlrev_b32 v58, 16, v197
    v_and_b32 v59, 0xffff0000, v197
    v_pk_add_f32 v[146:147], v[146:147], v[58:59]
    v_lshlrev_b32 v58, 16, v204
    v_and_b32 v59, 0xffff0000, v204
    v_pk_add_f32 v[148:149], v[148:149], v[58:59]
    v_lshlrev_b32 v58, 16, v205
    v_and_b32 v59, 0xffff0000, v205
    v_pk_add_f32 v[150:151], v[150:151], v[58:59]
    v_lshlrev_b32 v58, 16, v198
    v_and_b32 v59, 0xffff0000, v198
    v_pk_add_f32 v[152:153], v[152:153], v[58:59]
    v_lshlrev_b32 v58, 16, v199
    v_and_b32 v59, 0xffff0000, v199
    v_pk_add_f32 v[154:155], v[154:155], v[58:59]
    v_lshlrev_b32 v58, 16, v206
    v_and_b32 v59, 0xffff0000, v206
    v_pk_add_f32 v[156:157], v[156:157], v[58:59]
    v_lshlrev_b32 v58, 16, v207
    v_and_b32 v59, 0xffff0000, v207
    v_pk_add_f32 v[158:159], v[158:159], v[58:59]
    v_and_b32 v58, 1, v72
    v_lshrrev_b32 v59, 1, v72
    v_lshlrev_b32 v58, 5, v58
    v_lshl_add_u32 v58, v59, 4, v58
    v_lshlrev_b32 v59, 3, v72
    v_sub_u32 v58, v58, v59
    v_add_u32 v78, v78, v58
    v_add_u32 v79, v79, v58
    v_lshlrev_b32 v32, 16, v208
    v_and_b32 v33, 0xffff0000, v208
    v_lshlrev_b32 v34, 16, v209
    v_and_b32 v35, 0xffff0000, v209
    v_lshlrev_b32 v36, 16, v210
    v_and_b32 v37, 0xffff0000, v210
    v_lshlrev_b32 v38, 16, v211
    v_and_b32 v39, 0xffff0000, v211
    v_lshlrev_b32 v40, 16, v212
    v_and_b32 v41, 0xffff0000, v212
    v_lshlrev_b32 v42, 16, v213
    v_and_b32 v43, 0xffff0000, v213
    v_lshlrev_b32 v44, 16, v214
    v_and_b32 v45, 0xffff0000, v214
    v_lshlrev_b32 v46, 16, v215
    v_and_b32 v47, 0xffff0000, v215
    s_or_b32 s31, s54, s30
    s_cbranch_scc1 op_nowr_145
    v_pk_add_f32 v[56:57], v[32:33], v[34:35]
    v_pk_add_f32 v[56:57], v[56:57], v[36:37]
    v_pk_add_f32 v[56:57], v[56:57], v[38:39]
    v_pk_add_f32 v[56:57], v[56:57], v[40:41]
    v_pk_add_f32 v[56:57], v[56:57], v[42:43]
    v_pk_add_f32 v[56:57], v[56:57], v[44:45]
    v_pk_add_f32 v[56:57], v[56:57], v[46:47]
    v_add_f32 v56, v56, v57
    v_mov_b32 v57, v56
    s_nop 1
    v_permlane16_swap_b32 v56, v57
    s_nop 1
    v_add_f32 v56, v56, v57
    v_mov_b32 v57, v56
    s_nop 1
    v_permlane32_swap_b32 v56, v57
    s_nop 1
    v_add_f32 v56, v56, v57
    s_mov_b32 s31, 24704
    s_mov_b32 s34, 24708
    s_mov_b64 exec, 1
    buffer_atomic_add_f32 v56, v75, s[32:35], s31 offen
    s_mov_b64 exec, -1
    s_mov_b32 s34, 24576
op_nowr_145:
    v_mov_b32 v208, 0
    v_mov_b32 v209, 0
    v_mov_b32 v210, 0
    v_mov_b32 v211, 0
    v_mov_b32 v212, 0
    v_mov_b32 v213, 0
    v_mov_b32 v214, 0
    v_mov_b32 v215, 0
    v_mov_b32 v216, 0
    v_mov_b32 v217, 0
    v_mov_b32 v218, 0
    v_mov_b32 v219, 0
    s_mov_b32 s40, 1048576
op_xspin_146:
    buffer_load_dwordx4 v[224:227], v1, s[36:39], s53 offen offset:0 sc1
    buffer_load_dwordx4 v[228:231], v1, s[36:39], s53 offen offset:1024 sc1
    buffer_load_dwordx4 v[232:235], v1, s[36:39], s53 offen offset:2048 sc1
    buffer_load_dwordx4 v[236:239], v1, s[36:39], s53 offen offset:3072 sc1
    s_sub_u32 s40, s40, 1
    s_waitcnt vmcnt(0)
    s_cbranch_scc1 op_xok_147
    v_max3_u32 v56, v224, v225, v226
    v_max3_u32 v56, v56, v227, v228
    v_max3_u32 v56, v56, v229, v230
    v_max3_u32 v56, v56, v231, v232
    v_max3_u32 v56, v56, v233, v234
    v_max3_u32 v56, v56, v235, v236
    v_max3_u32 v56, v56, v237, v238
    v_max_u32 v56, v56, v239
    v_cmp_eq_u32 vcc, -1, v56
    s_cbranch_vccz op_xok_147
    s_sleep 2
    s_branch op_xspin_146
op_xok_147:
    v_lshlrev_b32 v56, 16, v224
    v_and_b32 v57, 0xffff0000, v224
    v_lshlrev_b32 v58, 16, v225
    v_and_b32 v59, 0xffff0000, v225
    v_pk_add_f32 v[128:129], v[128:129], v[56:57]
    v_pk_add_f32 v[130:131], v[130:131], v[58:59]
    v_cvt_pk_bf16_f32 v192, v128, v129
    v_cvt_pk_bf16_f32 v193, v130, v131
    v_lshlrev_b32 v128, 16, v192
    v_and_b32 v129, 0xffff0000, v192
    v_lshlrev_b32 v130, 16, v193
    v_and_b32 v131, 0xffff0000, v193
    v_pk_add_f32 v[208:209], v[208:209], v[128:129]
    v_pk_fma_f32 v[210:211], v[128:129], v[128:129], v[210:211]
    v_pk_fma_f32 v[212:213], v[128:129], v[32:33], v[212:213]
    v_pk_add_f32 v[208:209], v[208:209], v[130:131]
    v_pk_fma_f32 v[210:211], v[130:131], v[130:131], v[210:211]
    v_pk_fma_f32 v[212:213], v[130:131], v[34:35], v[212:213]
    v_lshlrev_b32 v56, 16, v226
    v_and_b32 v57, 0xffff0000, v226
    v_lshlrev_b32 v58, 16, v227
    v_and_b32 v59, 0xffff0000, v227
    v_pk_add_f32 v[132:133], v[132:133], v[56:57]
    v_pk_add_f32 v[134:135], v[134:135], v[58:59]
    v_cvt_pk_bf16_f32 v200, v132, v133
    v_cvt_pk_bf16_f32 v201, v134, v135
    v_lshlrev_b32 v132, 16, v200
    v_and_b32 v133, 0xffff0000, v200
    v_lshlrev_b32 v134, 16, v201
    v_and_b32 v135, 0xffff0000, v201
    v_pk_add_f32 v[214:215], v[214:215], v[132:133]
    v_pk_fma_f32 v[216:217], v[132:133], v[132:133], v[216:217]
    v_pk_fma_f32 v[218:219], v[132:133], v[32:33], v[218:219]
    v_pk_add_f32 v[214:215], v[214:215], v[134:135]
    v_pk_fma_f32 v[216:217], v[134:135], v[134:135], v[216:217]
    v_pk_fma_f32 v[218:219], v[134:135], v[34:35], v[218:219]
    v_lshlrev_b32 v56, 16, v228
    v_and_b32 v57, 0xffff0000, v228
    v_lshlrev_b32 v58, 16, v229
    v_and_b32 v59, 0xffff0000, v229
    v_pk_add_f32 v[136:137], v[136:137], v[56:57]
    v_pk_add_f32 v[138:139], v[138:139], v[58:59]
    v_cvt_pk_bf16_f32 v194, v136, v137
    v_cvt_pk_bf16_f32 v195, v138, v139
    v_lshlrev_b32 v136, 16, v194
    v_and_b32 v137, 0xffff0000, v194
    v_lshlrev_b32 v138, 16, v195
    v_and_b32 v139, 0xffff0000, v195
    v_permlane16_swap_b32 v192, v194
    v_permlane16_swap_b32 v193, v195
    buffer_store_dwordx4 v[192:195], v78, s[24:27], 0 offen offset:0 sc1
    v_pk_add_f32 v[208:209], v[208:209], v[136:137]
    v_pk_fma_f32 v[210:211], v[136:137], v[136:137], v[210:211]
    v_pk_fma_f32 v[212:213], v[136:137], v[36:37], v[212:213]
    v_pk_add_f32 v[208:209], v[208:209], v[138:139]
    v_pk_fma_f32 v[210:211], v[138:139], v[138:139], v[210:211]
    v_pk_fma_f32 v[212:213], v[138:139], v[38:39], v[212:213]
    v_lshlrev_b32 v56, 16, v230
    v_and_b32 v57, 0xffff0000, v230
    v_lshlrev_b32 v58, 16, v231
    v_and_b32 v59, 0xffff0000, v231
    v_pk_add_f32 v[140:141], v[140:141], v[56:57]
    v_pk_add_f32 v[142:143], v[142:143], v[58:59]
    v_cvt_pk_bf16_f32 v202, v140, v141
    v_cvt_pk_bf16_f32 v203, v142, v143
    v_lshlrev_b32 v140, 16, v202
    v_and_b32 v141, 0xffff0000, v202
    v_lshlrev_b32 v142, 16, v203
    v_and_b32 v143, 0xffff0000, v203
    v_permlane16_swap_b32 v200, v202
    v_permlane16_swap_b32 v201, v203
    buffer_store_dwordx4 v[200:203], v79, s[24:27], 0 offen offset:0 sc1
    v_pk_add_f32 v[214:215], v[214:215], v[140:141]
    v_pk_fma_f32 v[216:217], v[140:141], v[140:141], v[216:217]
    v_pk_fma_f32 v[218:219], v[140:141], v[36:37], v[218:219]
    v_pk_add_f32 v[214:215], v[214:215], v[142:143]
    v_pk_fma_f32 v[216:217], v[142:143], v[142:143], v[216:217]
    v_pk_fma_f32 v[218:219], v[142:143], v[38:39], v[218:219]
    v_lshlrev_b32 v56, 16, v232
    v_and_b32 v57, 0xffff0000, v232
    v_lshlrev_b32 v58, 16, v233
    v_and_b32 v59, 0xffff0000, v233
    v_pk_add_f32 v[144:145], v[144:145], v[56:57]
    v_pk_add_f32 v[146:147], v[146:147], v[58:59]
    v_cvt_pk_bf16_f32 v196, v144, v145
    v_cvt_pk_bf16_f32 v197, v146, v147
    v_lshlrev_b32 v144, 16, v196
    v_and_b32 v145, 0xffff0000, v196
    v_lshlrev_b32 v146, 16, v197
    v_and_b32 v147, 0xffff0000, v197
    v_pk_add_f32 v[208:209], v[208:209], v[144:145]
    v_pk_fma_f32 v[210:211], v[144:145], v[144:145], v[210:211]
    v_pk_fma_f32 v[212:213], v[144:145], v[40:41], v[212:213]
    v_pk_add_f32 v[208:209], v[208:209], v[146:147]
    v_pk_fma_f32 v[210:211], v[146:147], v[146:147], v[210:211]
    v_pk_fma_f32 v[212:213], v[146:147], v[42:43], v[212:213]
    v_lshlrev_b32 v56, 16, v234
    v_and_b32 v57, 0xffff0000, v234
    v_lshlrev_b32 v58, 16, v235
    v_and_b32 v59, 0xffff0000, v235
    v_pk_add_f32 v[148:149], v[148:149], v[56:57]
    v_pk_add_f32 v[150:151], v[150:151], v[58:59]
    v_cvt_pk_bf16_f32 v204, v148, v149
    v_cvt_pk_bf16_f32 v205, v150, v151
    v_lshlrev_b32 v148, 16, v204
    v_and_b32 v149, 0xffff0000, v204
    v_lshlrev_b32 v150, 16, v205
    v_and_b32 v151, 0xffff0000, v205
    v_pk_add_f32 v[214:215], v[214:215], v[148:149]
    v_pk_fma_f32 v[216:217], v[148:149], v[148:149], v[216:217]
    v_pk_fma_f32 v[218:219], v[148:149], v[40:41], v[218:219]
    v_pk_add_f32 v[214:215], v[214:215], v[150:151]
    v_pk_fma_f32 v[216:217], v[150:151], v[150:151], v[216:217]
    v_pk_fma_f32 v[218:219], v[150:151], v[42:43], v[218:219]
    v_lshlrev_b32 v56, 16, v236
    v_and_b32 v57, 0xffff0000, v236
    v_lshlrev_b32 v58, 16, v237
    v_and_b32 v59, 0xffff0000, v237
    v_pk_add_f32 v[152:153], v[152:153], v[56:57]
    v_pk_add_f32 v[154:155], v[154:155], v[58:59]
    v_cvt_pk_bf16_f32 v198, v152, v153
    v_cvt_pk_bf16_f32 v199, v154, v155
    v_lshlrev_b32 v152, 16, v198
    v_and_b32 v153, 0xffff0000, v198
    v_lshlrev_b32 v154, 16, v199
    v_and_b32 v155, 0xffff0000, v199
    v_permlane16_swap_b32 v196, v198
    v_permlane16_swap_b32 v197, v199
    buffer_store_dwordx4 v[196:199], v78, s[24:27], 0 offen offset:64 sc1
    v_pk_add_f32 v[208:209], v[208:209], v[152:153]
    v_pk_fma_f32 v[210:211], v[152:153], v[152:153], v[210:211]
    v_pk_fma_f32 v[212:213], v[152:153], v[44:45], v[212:213]
    v_pk_add_f32 v[208:209], v[208:209], v[154:155]
    v_pk_fma_f32 v[210:211], v[154:155], v[154:155], v[210:211]
    v_pk_fma_f32 v[212:213], v[154:155], v[46:47], v[212:213]
    v_lshlrev_b32 v56, 16, v238
    v_and_b32 v57, 0xffff0000, v238
    v_lshlrev_b32 v58, 16, v239
    v_and_b32 v59, 0xffff0000, v239
    v_pk_add_f32 v[156:157], v[156:157], v[56:57]
    v_pk_add_f32 v[158:159], v[158:159], v[58:59]
    v_cvt_pk_bf16_f32 v206, v156, v157
    v_cvt_pk_bf16_f32 v207, v158, v159
    v_lshlrev_b32 v156, 16, v206
    v_and_b32 v157, 0xffff0000, v206
    v_lshlrev_b32 v158, 16, v207
    v_and_b32 v159, 0xffff0000, v207
    v_permlane16_swap_b32 v204, v206
    v_permlane16_swap_b32 v205, v207
    buffer_store_dwordx4 v[204:207], v79, s[24:27], 0 offen offset:64 sc1
    v_pk_add_f32 v[214:215], v[214:215], v[156:157]
    v_pk_fma_f32 v[216:217], v[156:157], v[156:157], v[216:217]
    v_pk_fma_f32 v[218:219], v[156:157], v[44:45], v[218:219]
    v_pk_add_f32 v[214:215], v[214:215], v[158:159]
    v_pk_fma_f32 v[216:217], v[158:159], v[158:159], v[216:217]
    v_pk_fma_f32 v[218:219], v[158:159], v[46:47], v[218:219]
    v_add_f32 v48, v208, v209
    v_add_f32 v49, v210, v211
    v_add_f32 v50, v212, v213
    v_add_f32 v52, v214, v215
    v_add_f32 v53, v216, v217
    v_add_f32 v54, v218, v219
    v_mov_b32 v56, v48
    v_mov_b32 v57, v49
    v_mov_b32 v58, v50
    v_mov_b32 v59, v52
    v_mov_b32 v60, v53
    v_mov_b32 v61, v54
    s_nop 1
    v_permlane16_swap_b32 v48, v56
    v_permlane16_swap_b32 v49, v57
    v_permlane16_swap_b32 v50, v58
    v_permlane16_swap_b32 v52, v59
    v_permlane16_swap_b32 v53, v60
    v_permlane16_swap_b32 v54, v61
    s_nop 1
    v_add_f32 v48, v48, v56
    v_add_f32 v49, v49, v57
    v_add_f32 v50, v50, v58
    v_add_f32 v52, v52, v59
    v_add_f32 v53, v53, v60
    v_add_f32 v54, v54, v61
    v_mov_b32 v56, v48
    v_mov_b32 v57, v49
    v_mov_b32 v58, v50
    v_mov_b32 v59, v52
    v_mov_b32 v60, v53
    v_mov_b32 v61, v54
    s_nop 1
    v_permlane32_swap_b32 v48, v56
    v_permlane32_swap_b32 v49, v57
    v_permlane32_swap_b32 v50, v58
    v_permlane32_swap_b32 v52, v59
    v_permlane32_swap_b32 v53, v60
    v_permlane32_swap_b32 v54, v61
    s_nop 1
    v_add_f32 v48, v48, v56
    v_add_f32 v49, v49, v57
    v_add_f32 v50, v50, v58
    v_add_f32 v52, v52, v59
    v_add_f32 v53, v53, v60
    v_add_f32 v54, v54, v61
    v_cmp_eq_u32 s[40:41], 1, v72
    v_cmp_eq_u32 s[42:43], 2, v72
    s_nop 1
    v_cndmask_b32 v48, v48, v49, s[40:41]
    v_cndmask_b32 v48, v48, v50, s[42:43]
    buffer_atomic_add_f32 v48, v77, s[32:35], 0 offen offset:0
    v_cndmask_b32 v52, v52, v53, s[40:41]
    v_cndmask_b32 v52, v52, v54, s[42:43]
    buffer_atomic_add_f32 v52, v77, s[32:35], 0 offen offset:64
    s_load_dwordx2 s[42:43], s[0:1], 88
    s_load_dwordx2 s[56:57], s[0:1], 56
    s_add_u32 s16, s6, 0x4815000
    s_addc_u32 s17, s7, 0
    s_and_b32 s17, s17, 0xffff
    s_mov_b32 s18, 0x1000
    s_mov_b32 s19, 0x00020000
    v_lshrrev_b32 v3, 4, v1
    v_lshl_add_u32 v2, s30, 6, v3
    v_and_b32 v4, 31, v3
    v_lshrrev_b32 v5, 5, v3
    v_lshlrev_b32 v7, 4, v4
    v_and_b32 v8, 15, v3
    v_lshlrev_b32 v6, 7, v8
    s_bfe_u32 s31, s2, 0x20003
    s_lshl_b32 s31, s31, 7
    v_lshlrev_b32 v12, 9, v3
    v_and_b32 v14, 3, v3
    v_lshlrev_b32 v14, 7, v14
    s_and_b32 s59, s2, 7
    s_lshl_b32 s59, s59, 9
    s_setreg_imm32_b32 hwreg(HW_REG_MODE, 4, 2), 3
    s_waitcnt vmcnt(0) lgkmcnt(0)
    s_barrier
    s_cmp_lg_u32 s30, 0
    s_cbranch_scc1 ff_nosig_148
    s_mov_b64 exec, 0xff
    buffer_atomic_add v76, v12, s[16:19], s31 offen sc1
    s_mov_b64 exec, -1
ff_nosig_148:
    s_lshl_b32 s40, s30, 13
    s_add_u32 m0, s40, 65536
    s_add_u32 s41, s3, 0
    buffer_load_dwordx4 v1, s[44:47], s41 offen offset:0 sc1 lds
    buffer_load_dwordx4 v1, s[44:47], s41 offen offset:1024 sc1 lds
    buffer_load_dwordx4 v1, s[44:47], s41 offen offset:2048 sc1 lds
    buffer_load_dwordx4 v1, s[44:47], s41 offen offset:3072 sc1 lds
    s_waitcnt vmcnt(0)
    s_lshl_b32 s40, s30, 13
    s_add_u32 m0, s40, 69632
    s_add_u32 s41, s3, 4096
    buffer_load_dwordx4 v1, s[44:47], s41 offen offset:0 sc1 lds
    buffer_load_dwordx4 v1, s[44:47], s41 offen offset:1024 sc1 lds
    buffer_load_dwordx4 v1, s[44:47], s41 offen offset:2048 sc1 lds
    buffer_load_dwordx4 v1, s[44:47], s41 offen offset:3072 sc1 lds
    s_waitcnt vmcnt(0)
    s_lshl_b32 s40, s30, 13
    s_add_u32 m0, s40, 98304
    s_add_u32 s41, s3, 8388608
    buffer_load_dwordx4 v1, s[44:47], s41 offen offset:0 sc1 lds
    buffer_load_dwordx4 v1, s[44:47], s41 offen offset:1024 sc1 lds
    buffer_load_dwordx4 v1, s[44:47], s41 offen offset:2048 sc1 lds
    buffer_load_dwordx4 v1, s[44:47], s41 offen offset:3072 sc1 lds
    s_waitcnt vmcnt(0)
    s_lshl_b32 s40, s30, 13
    s_add_u32 m0, s40, 102400
    s_add_u32 s41, s3, 8392704
    buffer_load_dwordx4 v1, s[44:47], s41 offen offset:0 sc1 lds
    buffer_load_dwordx4 v1, s[44:47], s41 offen offset:1024 sc1 lds
    buffer_load_dwordx4 v1, s[44:47], s41 offen offset:2048 sc1 lds
    buffer_load_dwordx4 v1, s[44:47], s41 offen offset:3072 sc1 lds
    s_lshl_b32 s41, s30, 9
    s_add_u32 s41, s41, 131072
    v_lshrrev_b32 v9, 1, v1
    v_add_u32 v9, s41, v9
    ds_read_b64 v[96:97], v9 offset:0
    ds_read_b64 v[98:99], v9 offset:2048
    ds_read_b64 v[100:101], v9 offset:4096
    ds_read_b64 v[102:103], v9 offset:6144
    ds_read_b64 v[104:105], v9 offset:8192
    ds_read_b64 v[106:107], v9 offset:10240
    ds_read_b64 v[108:109], v9 offset:12288
    ds_read_b64 v[110:111], v9 offset:14336
    ds_read_b64 v[112:113], v9 offset:16384
    ds_read_b64 v[114:115], v9 offset:18432
    ds_read_b64 v[116:117], v9 offset:20480
    ds_read_b64 v[118:119], v9 offset:22528
    ds_read_b64 v[120:121], v9 offset:24576
    ds_read_b64 v[122:123], v9 offset:26624
    ds_read_b64 v[124:125], v9 offset:28672
    ds_read_b64 v[126:127], v9 offset:30720
    s_mov_b32 s54, 0x05040100
    s_mov_b32 s53, 0x07060302
    s_waitcnt lgkmcnt(0)
    v_perm_b32 v144, v98, v96, s54
    v_perm_b32 v145, v98, v96, s53
    v_perm_b32 v146, v99, v97, s54
    v_perm_b32 v147, v99, v97, s53
    v_perm_b32 v148, v102, v100, s54
    v_perm_b32 v149, v102, v100, s53
    v_perm_b32 v150, v103, v101, s54
    v_perm_b32 v151, v103, v101, s53
    v_perm_b32 v152, v106, v104, s54
    v_perm_b32 v153, v106, v104, s53
    v_perm_b32 v154, v107, v105, s54
    v_perm_b32 v155, v107, v105, s53
    v_perm_b32 v156, v110, v108, s54
    v_perm_b32 v157, v110, v108, s53
    v_perm_b32 v158, v111, v109, s54
    v_perm_b32 v159, v111, v109, s53
    v_perm_b32 v160, v114, v112, s54
    v_perm_b32 v161, v114, v112, s53
    v_perm_b32 v162, v115, v113, s54
    v_perm_b32 v163, v115, v113, s53
    v_perm_b32 v164, v118, v116, s54
    v_perm_b32 v165, v118, v116, s53
    v_perm_b32 v166, v119, v117, s54
    v_perm_b32 v167, v119, v117, s53
    v_perm_b32 v168, v122, v120, s54
    v_perm_b32 v169, v122, v120, s53
    v_perm_b32 v170, v123, v121, s54
    v_perm_b32 v171, v123, v121, s53
    v_perm_b32 v172, v126, v124, s54
    v_perm_b32 v173, v126, v124, s53
    v_perm_b32 v174, v127, v125, s54
    v_perm_b32 v175, v127, v125, s53
    s_mov_b32 s34, 24708
    s_mov_b32 s36, s42
    s_and_b32 s37, s43, 0xffff
    s_mov_b32 s38, 0x400000
    s_mov_b32 s39, 0x00020000
    s_add_u32 s48, s6, 0x4900000
    s_addc_u32 s49, s7, 0
    s_and_b32 s49, s49, 0xffff
    s_mov_b32 s50, 0x1c0000
    s_mov_b32 s51, 0x00020000
    v_lshlrev_b32 v10, 5, v2
    v_lshl_add_u32 v11, s30, 1, v5
    s_lshl_b32 s31, s2, 3
    v_add_u32 v11, s31, v11
    v_lshl_add_u32 v0, v11, 11, v7
    s_cmp_lg_u32 s30, 0
    s_cbranch_scc1 ff_go_149
    s_mov_b32 s52, 1048576
ff_poll_150:
    buffer_load_dword v13, v14, s[16:19], s59 offen sc1
    s_sub_u32 s52, s52, 1
    s_cbranch_scc1 ff_go_149
    s_waitcnt vmcnt(0)
    v_cmp_gt_u32 vcc, 64, v13
    s_cbranch_vccz ff_go_149
    s_sleep 4
    s_branch ff_poll_150
ff_go_149:
    s_barrier
    s_mov_b32 s31, 0
    buffer_load_dwordx4 v[16:19], v10, s[32:35], s31 offen sc1
    buffer_load_dwordx4 v[20:23], v10, s[32:35], s31 offen offset:16 sc1
    s_mov_b32 s31, 8192
    buffer_load_dwordx4 v[24:27], v10, s[32:35], s31 offen sc1
    buffer_load_dwordx4 v[28:31], v10, s[32:35], s31 offen offset:16 sc1
    s_mov_b32 s31, 16384
    buffer_load_dwordx4 v[32:35], v10, s[32:35], s31 offen sc1
    buffer_load_dwordx4 v[36:39], v10, s[32:35], s31 offen offset:16 sc1
    s_mov_b32 s31, 24704
    buffer_load_dword v10, v75, s[32:35], s31 offen sc1
    s_mov_b32 s52, 0x3a800000
    s_mov_b32 s53, 0x3a800000
    s_mov_b32 s54, 0x7ff
    v_mov_b32 v14, 0x3727c5ac
    v_mov_b32 v15, v14
    v_mov_b32 v12, 0xff800000
    v_mov_b32 v13, v12
    s_waitcnt vmcnt(0)
    v_sub_f32 v56, 0, v10
    v_sub_f32 v57, 0, v10
    v_pk_mul_f32 v[16:17], v[16:17], s[52:53]
    v_pk_fma_f32 v[24:25], v[24:25], s[52:53], v[14:15]
    v_pk_fma_f32 v[32:33], v[16:17], v[56:57], v[32:33]
    v_pk_fma_f32 v[24:25], v[16:17], v[16:17], v[24:25] neg_lo:[1,0,0] neg_hi:[1,0,0]
    v_pk_mul_f32 v[18:19], v[18:19], s[52:53]
    v_pk_fma_f32 v[26:27], v[26:27], s[52:53], v[14:15]
    v_pk_fma_f32 v[34:35], v[18:19], v[56:57], v[34:35]
    v_pk_fma_f32 v[26:27], v[18:19], v[18:19], v[26:27] neg_lo:[1,0,0] neg_hi:[1,0,0]
    v_pk_mul_f32 v[20:21], v[20:21], s[52:53]
    v_pk_fma_f32 v[28:29], v[28:29], s[52:53], v[14:15]
    v_pk_fma_f32 v[36:37], v[20:21], v[56:57], v[36:37]
    v_pk_fma_f32 v[28:29], v[20:21], v[20:21], v[28:29] neg_lo:[1,0,0] neg_hi:[1,0,0]
    v_pk_mul_f32 v[22:23], v[22:23], s[52:53]
    v_pk_fma_f32 v[30:31], v[30:31], s[52:53], v[14:15]
    v_pk_fma_f32 v[38:39], v[22:23], v[56:57], v[38:39]
    v_pk_fma_f32 v[30:31], v[22:23], v[22:23], v[30:31] neg_lo:[1,0,0] neg_hi:[1,0,0]
    v_max_f32 v24, v14, v24
    v_max_f32 v25, v14, v25
    v_max_f32 v26, v14, v26
    v_max_f32 v27, v14, v27
    v_max_f32 v28, v14, v28
    v_max_f32 v29, v14, v29
    v_max_f32 v30, v14, v30
    v_max_f32 v31, v14, v31
    v_rsq_f32 v24, v24
    v_rsq_f32 v25, v25
    v_rsq_f32 v26, v26
    v_rsq_f32 v27, v27
    v_rsq_f32 v28, v28
    v_rsq_f32 v29, v29
    v_rsq_f32 v30, v30
    v_rsq_f32 v31, v31
    v_pk_mul_f32 v[32:33], v[32:33], v[24:25]
    v_pk_mul_f32 v[34:35], v[34:35], v[26:27]
    v_pk_mul_f32 v[36:37], v[36:37], v[28:29]
    v_pk_mul_f32 v[38:39], v[38:39], v[30:31]
    v_bfi_b32 v32, s54, 0, v32
    v_med3_f32 v13, v12, v13, v32
    v_max_f32 v12, v12, v32
    v_bfi_b32 v33, s54, 1, v33
    v_med3_f32 v13, v12, v13, v33
    v_max_f32 v12, v12, v33
    v_bfi_b32 v34, s54, 2, v34
    v_med3_f32 v13, v12, v13, v34
    v_max_f32 v12, v12, v34
    v_bfi_b32 v35, s54, 3, v35
    v_med3_f32 v13, v12, v13, v35
    v_max_f32 v12, v12, v35
    v_bfi_b32 v36, s54, 4, v36
    v_med3_f32 v13, v12, v13, v36
    v_max_f32 v12, v12, v36
    v_bfi_b32 v37, s54, 5, v37
    v_med3_f32 v13, v12, v13, v37
    v_max_f32 v12, v12, v37
    v_bfi_b32 v38, s54, 6, v38
    v_med3_f32 v13, v12, v13, v38
    v_max_f32 v12, v12, v38
    v_bfi_b32 v39, s54, 7, v39
    v_med3_f32 v13, v12, v13, v39
    v_max_f32 v12, v12, v39
    v_lshl_or_b32 v12, v2, 3, v12
    v_lshl_or_b32 v13, v2, 3, v13
    s_nop 1
    v_mov_b32_dpp v14, v12 quad_perm:[1,0,3,2] row_mask:0xf bank_mask:0xf
    v_mov_b32_dpp v15, v13 quad_perm:[1,0,3,2] row_mask:0xf bank_mask:0xf
    v_max_f32 v15, v15, v13
    v_med3_f32 v13, v12, v14, v15
    v_max_f32 v12, v12, v14
    s_nop 1
    v_mov_b32_dpp v14, v12 quad_perm:[2,3,0,1] row_mask:0xf bank_mask:0xf
    v_mov_b32_dpp v15, v13 quad_perm:[2,3,0,1] row_mask:0xf bank_mask:0xf
    v_max_f32 v15, v15, v13
    v_med3_f32 v13, v12, v14, v15
    v_max_f32 v12, v12, v14
    s_nop 1
    v_mov_b32_dpp v14, v12 row_half_mirror row_mask:0xf bank_mask:0xf
    v_mov_b32_dpp v15, v13 row_half_mirror row_mask:0xf bank_mask:0xf
    v_max_f32 v15, v15, v13
    v_med3_f32 v13, v12, v14, v15
    v_max_f32 v12, v12, v14
    s_nop 1
    v_mov_b32_dpp v14, v12 row_mirror row_mask:0xf bank_mask:0xf
    v_mov_b32_dpp v15, v13 row_mirror row_mask:0xf bank_mask:0xf
    v_max_f32 v15, v15, v13
    v_med3_f32 v13, v12, v14, v15
    v_max_f32 v12, v12, v14
    v_mov_b32 v14, v12
    v_mov_b32 v15, v13
    s_nop 1
    v_permlane16_swap_b32 v12, v14
    v_permlane16_swap_b32 v13, v15
    s_nop 1
    v_max_f32 v15, v15, v13
    v_med3_f32 v13, v12, v14, v15
    v_max_f32 v12, v12, v14
    v_mov_b32 v14, v12
    v_mov_b32 v15, v13
    s_nop 1
    v_permlane32_swap_b32 v12, v14
    v_permlane32_swap_b32 v13, v15
    s_nop 1
    v_max_f32 v15, v15, v13
    v_med3_f32 v13, v12, v14, v15
    v_max_f32 v12, v12, v14
    s_lshl_b32 s31, s30, 3
    s_add_u32 s31, s31, 8192
    v_mov_b32 v14, s31
    ds_write_b64 v14, v[12:13]
    v_mov_b32 v14, 8192
    s_waitcnt lgkmcnt(0)
    s_barrier
    ds_read_b128 v[16:19], v14
    ds_read_b128 v[20:23], v14 offset:16
    v_cmp_eq_u32 vcc, 0, v5
    s_waitcnt lgkmcnt(0)
    v_max_f32 v19, v19, v17
    v_med3_f32 v17, v16, v18, v19
    v_max_f32 v16, v16, v18
    v_max_f32 v23, v23, v21
    v_med3_f32 v21, v20, v22, v23
    v_max_f32 v20, v20, v22
    v_max_f32 v21, v21, v17
    v_med3_f32 v17, v16, v20, v21
    v_max_f32 v16, v16, v20
    v_and_b32 v16, 0x7ff, v16
    v_and_b32 v17, 0x7ff, v17
    v_cndmask_b32 v15, v17, v16, vcc
    v_lshl_add_u32 v12, v15, 11, v7
    buffer_load_dwordx4 v[40:43], v12, s[24:27], 0 offen offset:0 sc1
    buffer_load_dwordx4 v[44:47], v12, s[24:27], 0 offen offset:512 sc1
    buffer_load_dwordx4 v[48:51], v12, s[24:27], 0 offen offset:1024 sc1
    buffer_load_dwordx4 v[52:55], v12, s[24:27], 0 offen offset:1536 sc1
    buffer_load_dwordx4 v[128:131], v0, s[24:27], 0 offen offset:0 sc1
    buffer_load_dwordx4 v[132:135], v0, s[24:27], 0 offen offset:512 sc1
    buffer_load_dwordx4 v[136:139], v0, s[24:27], 0 offen offset:1024 sc1
    buffer_load_dwordx4 v[140:143], v0, s[24:27], 0 offen offset:1536 sc1
    v_cmp_eq_u32 vcc, v16, v11
    v_cmp_eq_u32 s[52:53], v17, v11
    v_mov_b32 v13, 0x7fffffff
    s_or_b64 vcc, vcc, s[52:53]
    v_cndmask_b32 v0, v0, v13, vcc
    v_lshl_add_u32 v12, v5, 11, v7
    v_add_u32 v12, 4096, v12
    s_mov_b32 s58, 0
    s_waitcnt vmcnt(4)
ff_ln_151:
    v_lshlrev_b32 v216, 16, v40
    v_and_b32 v217, 0xffff0000, v40
    v_lshlrev_b32 v218, 16, v41
    v_and_b32 v219, 0xffff0000, v41
    v_lshlrev_b32 v220, 16, v42
    v_and_b32 v221, 0xffff0000, v42
    v_lshlrev_b32 v222, 16, v43
    v_and_b32 v223, 0xffff0000, v43
    v_lshlrev_b32 v224, 16, v44
    v_and_b32 v225, 0xffff0000, v44
    v_lshlrev_b32 v226, 16, v45
    v_and_b32 v227, 0xffff0000, v45
    v_lshlrev_b32 v228, 16, v46
    v_and_b32 v229, 0xffff0000, v46
    v_lshlrev_b32 v230, 16, v47
    v_and_b32 v231, 0xffff0000, v47
    v_lshlrev_b32 v232, 16, v48
    v_and_b32 v233, 0xffff0000, v48
    v_lshlrev_b32 v234, 16, v49
    v_and_b32 v235, 0xffff0000, v49
    v_lshlrev_b32 v236, 16, v50
    v_and_b32 v237, 0xffff0000, v50
    v_lshlrev_b32 v238, 16, v51
    v_and_b32 v239, 0xffff0000, v51
    v_lshlrev_b32 v240, 16, v52
    v_and_b32 v241, 0xffff0000, v52
    v_lshlrev_b32 v242, 16, v53
    v_and_b32 v243, 0xffff0000, v53
    v_lshlrev_b32 v244, 16, v54
    v_and_b32 v245, 0xffff0000, v54
    v_lshlrev_b32 v246, 16, v55
    v_and_b32 v247, 0xffff0000, v55
    v_pk_add_f32 v[208:209], v[216:217], v[218:219]
    v_pk_add_f32 v[210:211], v[220:221], v[222:223]
    v_pk_add_f32 v[208:209], v[208:209], v[224:225]
    v_pk_add_f32 v[210:211], v[210:211], v[226:227]
    v_pk_add_f32 v[208:209], v[208:209], v[228:229]
    v_pk_add_f32 v[210:211], v[210:211], v[230:231]
    v_pk_add_f32 v[208:209], v[208:209], v[232:233]
    v_pk_add_f32 v[210:211], v[210:211], v[234:235]
    v_pk_add_f32 v[208:209], v[208:209], v[236:237]
    v_pk_add_f32 v[210:211], v[210:211], v[238:239]
    v_pk_add_f32 v[208:209], v[208:209], v[240:241]
    v_pk_add_f32 v[210:211], v[210:211], v[242:243]
    v_pk_add_f32 v[208:209], v[208:209], v[244:245]
    v_pk_add_f32 v[210:211], v[210:211], v[246:247]
    v_pk_add_f32 v[208:209], v[208:209], v[210:211]
    v_add_f32 v208, v208, v209
    s_nop 1
    v_add_f32_dpp v208, v208, v208 quad_perm:[1,0,3,2] row_mask:0xf bank_mask:0xf
    s_nop 1
    v_add_f32_dpp v208, v208, v208 quad_perm:[2,3,0,1] row_mask:0xf bank_mask:0xf
    s_nop 1
    v_add_f32_dpp v208, v208, v208 row_half_mirror row_mask:0xf bank_mask:0xf
    s_nop 1
    v_add_f32_dpp v208, v208, v208 row_mirror row_mask:0xf bank_mask:0xf
    v_mov_b32 v210, v208
    s_nop 1
    v_permlane16_swap_b32 v208, v210
    s_nop 1
    v_add_f32 v208, v208, v210
    v_mul_f32 v208, 0xba800000, v208
    v_mov_b32 v209, v208
    v_pk_add_f32 v[210:211], v[216:217], v[208:209]
    v_pk_add_f32 v[214:215], v[218:219], v[208:209]
    v_pk_mul_f32 v[212:213], v[210:211], v[210:211]
    v_pk_fma_f32 v[212:213], v[214:215], v[214:215], v[212:213]
    v_pk_add_f32 v[210:211], v[220:221], v[208:209]
    v_pk_add_f32 v[214:215], v[222:223], v[208:209]
    v_pk_fma_f32 v[212:213], v[210:211], v[210:211], v[212:213]
    v_pk_fma_f32 v[212:213], v[214:215], v[214:215], v[212:213]
    v_pk_add_f32 v[210:211], v[224:225], v[208:209]
    v_pk_add_f32 v[214:215], v[226:227], v[208:209]
    v_pk_fma_f32 v[212:213], v[210:211], v[210:211], v[212:213]
    v_pk_fma_f32 v[212:213], v[214:215], v[214:215], v[212:213]
    v_pk_add_f32 v[210:211], v[228:229], v[208:209]
    v_pk_add_f32 v[214:215], v[230:231], v[208:209]
    v_pk_fma_f32 v[212:213], v[210:211], v[210:211], v[212:213]
    v_pk_fma_f32 v[212:213], v[214:215], v[214:215], v[212:213]
    v_pk_add_f32 v[210:211], v[232:233], v[208:209]
    v_pk_add_f32 v[214:215], v[234:235], v[208:209]
    v_pk_fma_f32 v[212:213], v[210:211], v[210:211], v[212:213]
    v_pk_fma_f32 v[212:213], v[214:215], v[214:215], v[212:213]
    v_pk_add_f32 v[210:211], v[236:237], v[208:209]
    v_pk_add_f32 v[214:215], v[238:239], v[208:209]
    v_pk_fma_f32 v[212:213], v[210:211], v[210:211], v[212:213]
    v_pk_fma_f32 v[212:213], v[214:215], v[214:215], v[212:213]
    v_pk_add_f32 v[210:211], v[240:241], v[208:209]
    v_pk_add_f32 v[214:215], v[242:243], v[208:209]
    v_pk_fma_f32 v[212:213], v[210:211], v[210:211], v[212:213]
    v_pk_fma_f32 v[212:213], v[214:215], v[214:215], v[212:213]
    v_pk_add_f32 v[210:211], v[244:245], v[208:209]
    v_pk_add_f32 v[214:215], v[246:247], v[208:209]
    v_pk_fma_f32 v[212:213], v[210:211], v[210:211], v[212:213]
    v_pk_fma_f32 v[212:213], v[214:215], v[214:215], v[212:213]
    v_add_f32 v212, v212, v213
    s_nop 1
    v_add_f32_dpp v212, v212, v212 quad_perm:[1,0,3,2] row_mask:0xf bank_mask:0xf
    s_nop 1
    v_add_f32_dpp v212, v212, v212 quad_perm:[2,3,0,1] row_mask:0xf bank_mask:0xf
    s_nop 1
    v_add_f32_dpp v212, v212, v212 row_half_mirror row_mask:0xf bank_mask:0xf
    s_nop 1
    v_add_f32_dpp v212, v212, v212 row_mirror row_mask:0xf bank_mask:0xf
    v_mov_b32 v210, v212
    s_nop 1
    v_permlane16_swap_b32 v212, v210
    s_nop 1
    v_add_f32 v212, v212, v210
    v_mul_f32 v212, 0x3a800000, v212
    v_cvt_pk_bf16_f32 v214, v208, v212
    v_and_b32 v212, 0xffff0000, v214
    v_lshlrev_b32 v214, 16, v214
    v_add_f32 v212, 0x3727c5ac, v212
    v_mov_b32 v215, v214
    v_cvt_pk_bf16_f32 v212, v212, v212
    v_and_b32 v212, 0xffff0000, v212
    v_sqrt_f32 v212, v212
    v_pk_add_f32 v[176:177], v[216:217], v[214:215]
    v_pk_add_f32 v[178:179], v[218:219], v[214:215]
    v_pk_add_f32 v[180:181], v[220:221], v[214:215]
    v_pk_add_f32 v[182:183], v[222:223], v[214:215]
    v_pk_add_f32 v[184:185], v[224:225], v[214:215]
    v_pk_add_f32 v[186:187], v[226:227], v[214:215]
    v_pk_add_f32 v[188:189], v[228:229], v[214:215]
    v_pk_add_f32 v[190:191], v[230:231], v[214:215]
    v_pk_add_f32 v[192:193], v[232:233], v[214:215]
    v_pk_add_f32 v[194:195], v[234:235], v[214:215]
    v_pk_add_f32 v[196:197], v[236:237], v[214:215]
    v_pk_add_f32 v[198:199], v[238:239], v[214:215]
    v_pk_add_f32 v[200:201], v[240:241], v[214:215]
    v_pk_add_f32 v[202:203], v[242:243], v[214:215]
    v_pk_add_f32 v[204:205], v[244:245], v[214:215]
    v_pk_add_f32 v[206:207], v[246:247], v[214:215]
    v_cvt_pk_bf16_f32 v212, v212, v212
    v_and_b32 v212, 0xffff0000, v212
    v_rcp_f32 v212, v212
    v_cvt_pk_bf16_f32 v40, v176, v177
    v_cvt_pk_bf16_f32 v41, v178, v179
    v_cvt_pk_bf16_f32 v42, v180, v181
    v_cvt_pk_bf16_f32 v43, v182, v183
    v_cvt_pk_bf16_f32 v44, v184, v185
    v_cvt_pk_bf16_f32 v45, v186, v187
    v_cvt_pk_bf16_f32 v46, v188, v189
    v_cvt_pk_bf16_f32 v47, v190, v191
    v_cvt_pk_bf16_f32 v48, v192, v193
    v_cvt_pk_bf16_f32 v49, v194, v195
    v_cvt_pk_bf16_f32 v50, v196, v197
    v_cvt_pk_bf16_f32 v51, v198, v199
    v_cvt_pk_bf16_f32 v52, v200, v201
    v_cvt_pk_bf16_f32 v53, v202, v203
    v_cvt_pk_bf16_f32 v54, v204, v205
    v_cvt_pk_bf16_f32 v55, v206, v207
    v_mov_b32 v213, v212
    v_lshlrev_b32 v176, 16, v40
    v_and_b32 v177, 0xffff0000, v40
    v_lshlrev_b32 v178, 16, v41
    v_and_b32 v179, 0xffff0000, v41
    v_lshlrev_b32 v180, 16, v42
    v_and_b32 v181, 0xffff0000, v42
    v_lshlrev_b32 v182, 16, v43
    v_and_b32 v183, 0xffff0000, v43
    v_lshlrev_b32 v184, 16, v44
    v_and_b32 v185, 0xffff0000, v44
    v_lshlrev_b32 v186, 16, v45
    v_and_b32 v187, 0xffff0000, v45
    v_lshlrev_b32 v188, 16, v46
    v_and_b32 v189, 0xffff0000, v46
    v_lshlrev_b32 v190, 16, v47
    v_and_b32 v191, 0xffff0000, v47
    v_lshlrev_b32 v192, 16, v48
    v_and_b32 v193, 0xffff0000, v48
    v_lshlrev_b32 v194, 16, v49
    v_and_b32 v195, 0xffff0000, v49
    v_lshlrev_b32 v196, 16, v50
    v_and_b32 v197, 0xffff0000, v50
    v_lshlrev_b32 v198, 16, v51
    v_and_b32 v199, 0xffff0000, v51
    v_lshlrev_b32 v200, 16, v52
    v_and_b32 v201, 0xffff0000, v52
    v_lshlrev_b32 v202, 16, v53
    v_and_b32 v203, 0xffff0000, v53
    v_lshlrev_b32 v204, 16, v54
    v_and_b32 v205, 0xffff0000, v54
    v_lshlrev_b32 v206, 16, v55
    v_and_b32 v207, 0xffff0000, v55
    v_pk_mul_f32 v[176:177], v[176:177], v[212:213]
    v_pk_mul_f32 v[178:179], v[178:179], v[212:213]
    v_pk_mul_f32 v[180:181], v[180:181], v[212:213]
    v_pk_mul_f32 v[182:183], v[182:183], v[212:213]
    v_pk_mul_f32 v[184:185], v[184:185], v[212:213]
    v_pk_mul_f32 v[186:187], v[186:187], v[212:213]
    v_pk_mul_f32 v[188:189], v[188:189], v[212:213]
    v_pk_mul_f32 v[190:191], v[190:191], v[212:213]
    v_pk_mul_f32 v[192:193], v[192:193], v[212:213]
    v_pk_mul_f32 v[194:195], v[194:195], v[212:213]
    v_pk_mul_f32 v[196:197], v[196:197], v[212:213]
    v_pk_mul_f32 v[198:199], v[198:199], v[212:213]
    v_pk_mul_f32 v[200:201], v[200:201], v[212:213]
    v_pk_mul_f32 v[202:203], v[202:203], v[212:213]
    v_pk_mul_f32 v[204:205], v[204:205], v[212:213]
    v_pk_mul_f32 v[206:207], v[206:207], v[212:213]
    v_cvt_pk_bf16_f32 v40, v176, v177
    v_cvt_pk_bf16_f32 v41, v178, v179
    v_cvt_pk_bf16_f32 v42, v180, v181
    v_cvt_pk_bf16_f32 v43, v182, v183
    v_cvt_pk_bf16_f32 v44, v184, v185
    v_cvt_pk_bf16_f32 v45, v186, v187
    v_cvt_pk_bf16_f32 v46, v188, v189
    v_cvt_pk_bf16_f32 v47, v190, v191
    v_cvt_pk_bf16_f32 v48, v192, v193
    v_cvt_pk_bf16_f32 v49, v194, v195
    v_cvt_pk_bf16_f32 v50, v196, v197
    v_cvt_pk_bf16_f32 v51, v198, v199
    v_cvt_pk_bf16_f32 v52, v200, v201
    v_cvt_pk_bf16_f32 v53, v202, v203
    v_cvt_pk_bf16_f32 v54, v204, v205
    v_cvt_pk_bf16_f32 v55, v206, v207
    s_cmp_lg_u32 s58, 0
    s_cbranch_scc1 ff_own_152
    ds_write_b128 v12, v[40:43] offset:0
    ds_write_b128 v12, v[44:47] offset:512
    ds_write_b128 v12, v[48:51] offset:1024
    ds_write_b128 v12, v[52:55] offset:1536
    s_cmp_ge_u32 s2, 224
    s_cbranch_scc1 ff_red_153
    v_lshrrev_b32 v12, 4, v3
    v_and_b32 v13, 1, v3
    v_lshlrev_b32 v13, 11, v13
    v_lshl_add_u32 v13, v12, 3, v13
    s_lshl_b32 s54, s30, 9
    s_add_u32 s54, s54, 4096
    v_add_u32 v13, s54, v13
    v_lshlrev_b32 v14, 3, v3
    s_lshl_b32 s54, s30, 13
    s_add_u32 s54, s54, 65536
    v_add_u32 v14, s54, v14
    ds_read_b64_tr_b16 a[0:1], v14 offset:0
    ds_read_b64_tr_b16 a[2:3], v14 offset:512
    ds_read_b64_tr_b16 a[4:5], v14 offset:1024
    ds_read_b64_tr_b16 a[6:7], v14 offset:1536
    ds_read_b64_tr_b16 a[8:9], v14 offset:2048
    ds_read_b64_tr_b16 a[10:11], v14 offset:2560
    ds_read_b64_tr_b16 a[12:13], v14 offset:3072
    ds_read_b64_tr_b16 a[14:15], v14 offset:3584
    ds_read_b64_tr_b16 a[16:17], v14 offset:4096
    ds_read_b64_tr_b16 a[18:19], v14 offset:4608
    ds_read_b64_tr_b16 a[20:21], v14 offset:5120
    ds_read_b64_tr_b16 a[22:23], v14 offset:5632
    ds_read_b64_tr_b16 a[24:25], v14 offset:6144
    ds_read_b64_tr_b16 a[26:27], v14 offset:6656
    ds_read_b64_tr_b16 a[28:29], v14 offset:7168
    ds_read_b64_tr_b16 a[30:31], v14 offset:7680
    ds_read_b64_tr_b16 a[32:33], v14 offset:32768
    ds_read_b64_tr_b16 a[34:35], v14 offset:33280
    ds_read_b64_tr_b16 a[36:37], v14 offset:33792
    ds_read_b64_tr_b16 a[38:39], v14 offset:34304
    ds_read_b64_tr_b16 a[40:41], v14 offset:34816
    ds_read_b64_tr_b16 a[42:43], v14 offset:35328
    ds_read_b64_tr_b16 a[44:45], v14 offset:35840
    ds_read_b64_tr_b16 a[46:47], v14 offset:36352
    ds_read_b64_tr_b16 a[48:49], v14 offset:36864
    ds_read_b64_tr_b16 a[50:51], v14 offset:37376
    ds_read_b64_tr_b16 a[52:53], v14 offset:37888
    ds_read_b64_tr_b16 a[54:55], v14 offset:38400
    ds_read_b64_tr_b16 a[56:57], v14 offset:38912
    ds_read_b64_tr_b16 a[58:59], v14 offset:39424
    ds_read_b64_tr_b16 a[60:61], v14 offset:39936
    ds_read_b64_tr_b16 a[62:63], v14 offset:40448
    ds_read_b64 a[64:65], v13 offset:0
    ds_read_b64 a[66:67], v13 offset:32
    ds_read_b64 a[68:69], v13 offset:64
    ds_read_b64 a[70:71], v13 offset:96
    ds_read_b64 a[72:73], v13 offset:128
    ds_read_b64 a[74:75], v13 offset:160
    ds_read_b64 a[76:77], v13 offset:192
    ds_read_b64 a[78:79], v13 offset:224
    ds_read_b64 a[80:81], v13 offset:256
    ds_read_b64 a[82:83], v13 offset:288
    ds_read_b64 a[84:85], v13 offset:320
    ds_read_b64 a[86:87], v13 offset:352
    ds_read_b64 a[88:89], v13 offset:384
    ds_read_b64 a[90:91], v13 offset:416
    ds_read_b64 a[92:93], v13 offset:448
    ds_read_b64 a[94:95], v13 offset:480
    v_lshlrev_b32 v13, 6, v8
    v_lshl_add_u32 v13, v12, 4, v13
    s_lshl_b32 s54, s30, 11
    s_add_u32 s54, s54, 8448
    v_add_u32 v13, s54, v13
    s_waitcnt lgkmcnt(0)
    v_mfma_f32_16x16x32_bf16 v[16:19], a[0:3], a[64:67], 0
    v_mfma_f32_16x16x32_bf16 v[20:23], a[32:35], a[64:67], 0
    v_mfma_f32_16x16x32_bf16 v[16:19], a[4:7], a[68:71], v[16:19]
    v_mfma_f32_16x16x32_bf16 v[20:23], a[36:39], a[68:71], v[20:23]
    v_mfma_f32_16x16x32_bf16 v[16:19], a[8:11], a[72:75], v[16:19]
    v_mfma_f32_16x16x32_bf16 v[20:23], a[40:43], a[72:75], v[20:23]
    v_mfma_f32_16x16x32_bf16 v[16:19], a[12:15], a[76:79], v[16:19]
    v_mfma_f32_16x16x32_bf16 v[20:23], a[44:47], a[76:79], v[20:23]
    v_mfma_f32_16x16x32_bf16 v[16:19], a[16:19], a[80:83], v[16:19]
    v_mfma_f32_16x16x32_bf16 v[20:23], a[48:51], a[80:83], v[20:23]
    v_mfma_f32_16x16x32_bf16 v[16:19], a[20:23], a[84:87], v[16:19]
    v_mfma_f32_16x16x32_bf16 v[20:23], a[52:55], a[84:87], v[20:23]
    v_mfma_f32_16x16x32_bf16 v[16:19], a[24:27], a[88:91], v[16:19]
    v_mfma_f32_16x16x32_bf16 v[20:23], a[56:59], a[88:91], v[20:23]
    v_mfma_f32_16x16x32_bf16 v[16:19], a[28:31], a[92:95], v[16:19]
    v_mfma_f32_16x16x32_bf16 v[20:23], a[60:63], a[92:95], v[20:23]
    s_nop 7
    ds_write_b128 v13, v[16:19]
    ds_write_b128 v13, v[20:23] offset:1024
    v_lshlrev_b32 v13, 2, v4
    v_add_u32 v13, 8448, v13
    s_waitcnt lgkmcnt(0)
    s_barrier
    ds_read2st64_b32 v[16:17], v13 offset0:0 offset1:4
    ds_read2st64_b32 v[18:19], v13 offset0:8 offset1:12
    ds_read2st64_b32 v[20:21], v13 offset0:16 offset1:20
    ds_read2st64_b32 v[22:23], v13 offset0:24 offset1:28
    s_waitcnt lgkmcnt(0)
    v_pk_add_f32 v[16:17], v[16:17], v[20:21]
    v_pk_add_f32 v[18:19], v[18:19], v[22:23]
    v_pk_add_f32 v[16:17], v[16:17], v[18:19]
    v_cvt_pk_bf16_f32 v16, v16, v17
    v_and_b32 v20, 0xffff0000, v16
    v_lshlrev_b32 v16, 16, v16
    v_mul_f32 v17, 0xbfb8aa3b, v16
    v_exp_f32 v17, v17
    s_lshl_b32 s54, s55, 13
    v_add_f32 v17, 1.0, v17
    v_rcp_f32 v17, v17
    s_add_u32 s53, s54, 4096
    v_mul_f32 v16, v16, v17
    v_cvt_pk_bf16_f32 v16, v16, v16
    v_and_b32 v16, 0xffff0000, v16
    v_mul_f32 v16, v16, v20
    s_nop 1
    v_mov_b32_dpp v17, v16 quad_perm:[1,0,3,2] row_mask:0xf bank_mask:0xf
    v_cvt_pk_bf16_f32 v16, v16, v17
    v_lshlrev_b32 v13, 4, v2
    v_readlane_b32 s8, v16, 0
    v_readlane_b32 s9, v16, 2
    v_readlane_b32 s10, v16, 4
    v_readlane_b32 s11, v16, 6
    v_readlane_b32 s12, v16, 8
    v_readlane_b32 s13, v16, 10
    v_readlane_b32 s14, v16, 12
    v_readlane_b32 s15, v16, 14
    v_readlane_b32 s16, v16, 16
    v_readlane_b32 s17, v16, 18
    v_readlane_b32 s18, v16, 20
    v_readlane_b32 s19, v16, 22
    v_readlane_b32 s20, v16, 24
    v_readlane_b32 s21, v16, 26
    v_readlane_b32 s22, v16, 28
    v_readlane_b32 s23, v16, 30
    v_dot2_f32_bf16 v24, v144, s8, 0
    v_dot2_f32_bf16 v25, v145, s8, 0
    v_dot2_f32_bf16 v26, v146, s8, 0
    v_dot2_f32_bf16 v27, v147, s8, 0
    v_dot2_f32_bf16 v24, v148, s9, v24
    v_dot2_f32_bf16 v25, v149, s9, v25
    v_dot2_f32_bf16 v26, v150, s9, v26
    v_dot2_f32_bf16 v27, v151, s9, v27
    v_dot2_f32_bf16 v24, v152, s10, v24
    v_dot2_f32_bf16 v25, v153, s10, v25
    v_dot2_f32_bf16 v26, v154, s10, v26
    v_dot2_f32_bf16 v27, v155, s10, v27
    v_dot2_f32_bf16 v24, v156, s11, v24
    v_dot2_f32_bf16 v25, v157, s11, v25
    v_dot2_f32_bf16 v26, v158, s11, v26
    v_dot2_f32_bf16 v27, v159, s11, v27
    v_dot2_f32_bf16 v24, v160, s12, v24
    v_dot2_f32_bf16 v25, v161, s12, v25
    v_dot2_f32_bf16 v26, v162, s12, v26
    v_dot2_f32_bf16 v27, v163, s12, v27
    v_dot2_f32_bf16 v24, v164, s13, v24
    v_dot2_f32_bf16 v25, v165, s13, v25
    v_dot2_f32_bf16 v26, v166, s13, v26
    v_dot2_f32_bf16 v27, v167, s13, v27
    v_dot2_f32_bf16 v24, v168, s14, v24
    v_dot2_f32_bf16 v25, v169, s14, v25
    v_dot2_f32_bf16 v26, v170, s14, v26
    v_dot2_f32_bf16 v27, v171, s14, v27
    v_dot2_f32_bf16 v24, v172, s15, v24
    v_dot2_f32_bf16 v25, v173, s15, v25
    v_dot2_f32_bf16 v26, v174, s15, v26
    v_dot2_f32_bf16 v27, v175, s15, v27
    v_dot2_f32_bf16 v28, v144, s16, 0
    v_dot2_f32_bf16 v29, v145, s16, 0
    v_dot2_f32_bf16 v30, v146, s16, 0
    v_dot2_f32_bf16 v31, v147, s16, 0
    v_dot2_f32_bf16 v28, v148, s17, v28
    v_dot2_f32_bf16 v29, v149, s17, v29
    v_dot2_f32_bf16 v30, v150, s17, v30
    v_dot2_f32_bf16 v31, v151, s17, v31
    v_dot2_f32_bf16 v28, v152, s18, v28
    v_dot2_f32_bf16 v29, v153, s18, v29
    v_dot2_f32_bf16 v30, v154, s18, v30
    v_dot2_f32_bf16 v31, v155, s18, v31
    v_dot2_f32_bf16 v28, v156, s19, v28
    v_dot2_f32_bf16 v29, v157, s19, v29
    v_dot2_f32_bf16 v30, v158, s19, v30
    v_dot2_f32_bf16 v31, v159, s19, v31
    v_dot2_f32_bf16 v28, v160, s20, v28
    v_dot2_f32_bf16 v29, v161, s20, v29
    v_dot2_f32_bf16 v30, v162, s20, v30
    v_dot2_f32_bf16 v31, v163, s20, v31
    v_dot2_f32_bf16 v28, v164, s21, v28
    v_dot2_f32_bf16 v29, v165, s21, v29
    v_dot2_f32_bf16 v30, v166, s21, v30
    v_dot2_f32_bf16 v31, v167, s21, v31
    v_dot2_f32_bf16 v28, v168, s22, v28
    v_dot2_f32_bf16 v29, v169, s22, v29
    v_dot2_f32_bf16 v30, v170, s22, v30
    v_dot2_f32_bf16 v31, v171, s22, v31
    v_dot2_f32_bf16 v28, v172, s23, v28
    v_dot2_f32_bf16 v29, v173, s23, v29
    v_dot2_f32_bf16 v30, v174, s23, v30
    v_dot2_f32_bf16 v31, v175, s23, v31
    s_nop 2
    v_min_u32 v24, -2, v24
    v_min_u32 v25, -2, v25
    v_min_u32 v26, -2, v26
    v_min_u32 v27, -2, v27
    v_min_u32 v28, -2, v28
    v_min_u32 v29, -2, v29
    v_min_u32 v30, -2, v30
    v_min_u32 v31, -2, v31
    buffer_store_dwordx4 v[24:27], v13, s[48:51], s54 offen sc1
    buffer_store_dwordx4 v[28:31], v13, s[48:51], s53 offen sc1
    s_waitcnt vmcnt(2)
    v_mov_b32 v40, v128
    v_mov_b32 v41, v129
    v_mov_b32 v42, v130
    v_mov_b32 v43, v131
    v_mov_b32 v44, v132
    v_mov_b32 v45, v133
    v_mov_b32 v46, v134
    v_mov_b32 v47, v135
    v_mov_b32 v48, v136
    v_mov_b32 v49, v137
    v_mov_b32 v50, v138
    v_mov_b32 v51, v139
    v_mov_b32 v52, v140
    v_mov_b32 v53, v141
    v_mov_b32 v54, v142
    v_mov_b32 v55, v143
    s_mov_b32 s58, 1
    s_branch ff_ln_151
ff_own_152:
    v_lshlrev_b32 v176, 16, v40
    v_and_b32 v177, 0xffff0000, v40
    v_lshlrev_b32 v178, 16, v41
    v_and_b32 v179, 0xffff0000, v41
    v_lshlrev_b32 v180, 16, v42
    v_and_b32 v181, 0xffff0000, v42
    v_lshlrev_b32 v182, 16, v43
    v_and_b32 v183, 0xffff0000, v43
    v_lshlrev_b32 v184, 16, v44
    v_and_b32 v185, 0xffff0000, v44
    v_lshlrev_b32 v186, 16, v45
    v_and_b32 v187, 0xffff0000, v45
    v_lshlrev_b32 v188, 16, v46
    v_and_b32 v189, 0xffff0000, v46
    v_lshlrev_b32 v190, 16, v47
    v_and_b32 v191, 0xffff0000, v47
    v_lshlrev_b32 v192, 16, v48
    v_and_b32 v193, 0xffff0000, v48
    v_lshlrev_b32 v194, 16, v49
    v_and_b32 v195, 0xffff0000, v49
    v_lshlrev_b32 v196, 16, v50
    v_and_b32 v197, 0xffff0000, v50
    v_lshlrev_b32 v198, 16, v51
    v_and_b32 v199, 0xffff0000, v51
    v_lshlrev_b32 v200, 16, v52
    v_and_b32 v201, 0xffff0000, v52
    v_lshlrev_b32 v202, 16, v53
    v_and_b32 v203, 0xffff0000, v53
    v_lshlrev_b32 v204, 16, v54
    v_and_b32 v205, 0xffff0000, v54
    v_lshlrev_b32 v206, 16, v55
    v_and_b32 v207, 0xffff0000, v55
    v_pk_add_f32 v[176:177], v[176:177], v[216:217]
    v_pk_add_f32 v[178:179], v[178:179], v[218:219]
    v_pk_add_f32 v[180:181], v[180:181], v[220:221]
    v_pk_add_f32 v[182:183], v[182:183], v[222:223]
    v_pk_add_f32 v[184:185], v[184:185], v[224:225]
    v_pk_add_f32 v[186:187], v[186:187], v[226:227]
    v_pk_add_f32 v[188:189], v[188:189], v[228:229]
    v_pk_add_f32 v[190:191], v[190:191], v[230:231]
    v_pk_add_f32 v[192:193], v[192:193], v[232:233]
    v_pk_add_f32 v[194:195], v[194:195], v[234:235]
    v_pk_add_f32 v[196:197], v[196:197], v[236:237]
    v_pk_add_f32 v[198:199], v[198:199], v[238:239]
    v_pk_add_f32 v[200:201], v[200:201], v[240:241]
    v_pk_add_f32 v[202:203], v[202:203], v[242:243]
    v_pk_add_f32 v[204:205], v[204:205], v[244:245]
    v_pk_add_f32 v[206:207], v[206:207], v[246:247]
    v_cvt_pk_bf16_f32 v40, v176, v177
    v_cvt_pk_bf16_f32 v41, v178, v179
    v_cvt_pk_bf16_f32 v42, v180, v181
    v_cvt_pk_bf16_f32 v43, v182, v183
    v_cvt_pk_bf16_f32 v44, v184, v185
    v_cvt_pk_bf16_f32 v45, v186, v187
    v_cvt_pk_bf16_f32 v46, v188, v189
    v_cvt_pk_bf16_f32 v47, v190, v191
    v_cvt_pk_bf16_f32 v48, v192, v193
    v_cvt_pk_bf16_f32 v49, v194, v195
    v_cvt_pk_bf16_f32 v50, v196, v197
    v_cvt_pk_bf16_f32 v51, v198, v199
    v_cvt_pk_bf16_f32 v52, v200, v201
    v_cvt_pk_bf16_f32 v53, v202, v203
    v_cvt_pk_bf16_f32 v54, v204, v205
    v_cvt_pk_bf16_f32 v55, v206, v207
    buffer_store_dwordx4 v[40:43], v0, s[36:39], 0 offen offset:0 sc1
    buffer_store_dwordx4 v[44:47], v0, s[36:39], 0 offen offset:512 sc1
    buffer_store_dwordx4 v[48:51], v0, s[36:39], 0 offen offset:1024 sc1
    buffer_store_dwordx4 v[52:55], v0, s[36:39], 0 offen offset:1536 sc1
    s_cmp_ge_u32 s2, 224
    s_cbranch_scc1 ff_red2_154
    s_branch ff_fin_155
ff_red_153:
    s_sub_u32 s40, s2, 224
    s_lshr_b32 s41, s40, 4
    s_and_b32 s42, s40, 15
    s_mov_b32 s8, s56
    s_and_b32 s9, s57, 0xffff
    s_mov_b32 s10, 0x800
    s_mov_b32 s11, 0x00020000
    buffer_load_dwordx4 v[96:99], v7, s[8:11], 0 offen offset:0
    buffer_load_dwordx4 v[100:103], v7, s[8:11], 0 offen offset:512
    buffer_load_dwordx4 v[104:107], v7, s[8:11], 0 offen offset:1024
    buffer_load_dwordx4 v[108:111], v7, s[8:11], 0 offen offset:1536
    s_lshl_b32 s43, s41, 5
    v_readlane_b32 s46, v15, s43
    s_lshl_b32 s47, s42, 7
    v_lshl_add_u32 v9, v8, 3, s47
    s_lshl_b32 s46, s46, 11
    s_lshl_b32 s31, s41, 11
    s_add_u32 s31, s31, 4096
    v_add_u32 v12, s31, v9
    s_waitcnt lgkmcnt(0)
    ds_read_b64 v[32:33], v12
    buffer_load_dwordx2 v[34:35], v9, s[24:27], s46 offen sc1
    v_lshrrev_b32 v10, 4, v2
    v_lshlrev_b32 v10, 13, v10
    v_lshl_add_u32 v10, v8, 4, v10
    s_lshl_b32 s47, s40, 8
    s_waitcnt vmcnt(1)
    v_dot2_f32_bf16 v12, v40, v96, 0
    v_dot2_f32_bf16 v12, v41, v97, v12
    v_dot2_f32_bf16 v12, v42, v98, v12
    v_dot2_f32_bf16 v12, v43, v99, v12
    v_dot2_f32_bf16 v12, v44, v100, v12
    v_dot2_f32_bf16 v12, v45, v101, v12
    v_dot2_f32_bf16 v12, v46, v102, v12
    v_dot2_f32_bf16 v12, v47, v103, v12
    v_dot2_f32_bf16 v12, v48, v104, v12
    v_dot2_f32_bf16 v12, v49, v105, v12
    v_dot2_f32_bf16 v12, v50, v106, v12
    v_dot2_f32_bf16 v12, v51, v107, v12
    v_dot2_f32_bf16 v12, v52, v108, v12
    v_dot2_f32_bf16 v12, v53, v109, v12
    v_dot2_f32_bf16 v12, v54, v110, v12
    v_dot2_f32_bf16 v12, v55, v111, v12
    s_nop 2
    s_nop 1
    v_add_f32_dpp v12, v12, v12 quad_perm:[1,0,3,2] row_mask:0xf bank_mask:0xf
    s_nop 1
    v_add_f32_dpp v12, v12, v12 quad_perm:[2,3,0,1] row_mask:0xf bank_mask:0xf
    s_nop 1
    v_add_f32_dpp v12, v12, v12 row_half_mirror row_mask:0xf bank_mask:0xf
    s_nop 1
    v_add_f32_dpp v12, v12, v12 row_mirror row_mask:0xf bank_mask:0xf
    v_mov_b32 v13, v12
    s_nop 1
    v_permlane16_swap_b32 v12, v13
    s_nop 1
    v_add_f32 v12, v12, v13
    v_cvt_pk_bf16_f32 v12, v12, v12
    v_and_b32 v12, 0xffff0000, v12
    v_mul_f32 v12, 0xbfb8aa3b, v12
    v_exp_f32 v12, v12
    s_lshl_b32 s44, s42, 1
    v_add_f32 v12, 1.0, v12
    v_rcp_f32 v12, v12
    s_add_u32 s44, s44, s41
    s_lshl_b32 s44, s44, 11
    v_cvt_pk_bf16_f32 v12, v12, v12
    v_and_b32 v12, 0xffff0000, v12
    v_mov_b32 v40, v128
    v_mov_b32 v41, v129
    v_mov_b32 v42, v130
    v_mov_b32 v43, v131
    v_mov_b32 v44, v132
    v_mov_b32 v45, v133
    v_mov_b32 v46, v134
    v_mov_b32 v47, v135
    v_mov_b32 v48, v136
    v_mov_b32 v49, v137
    v_mov_b32 v50, v138
    v_mov_b32 v51, v139
    v_mov_b32 v52, v140
    v_mov_b32 v53, v141
    v_mov_b32 v54, v142
    v_mov_b32 v55, v143
    v_readlane_b32 s45, v12, s43
    s_mov_b32 s58, 1
    s_branch ff_ln_151
ff_red2_154:
    s_mov_b32 s52, 1048576
ff_rpoll_157:
    s_mov_b32 s53, s47
    buffer_load_dwordx4 v[96:99], v10, s[48:51], s53 offen sc1
    s_add_u32 s53, s53, 0x20000
    buffer_load_dwordx4 v[100:103], v10, s[48:51], s53 offen sc1
    s_add_u32 s53, s53, 0x20000
    buffer_load_dwordx4 v[104:107], v10, s[48:51], s53 offen sc1
    s_add_u32 s53, s53, 0x20000
    buffer_load_dwordx4 v[108:111], v10, s[48:51], s53 offen sc1
    s_add_u32 s53, s53, 0x20000
    buffer_load_dwordx4 v[112:115], v10, s[48:51], s53 offen sc1
    s_add_u32 s53, s53, 0x20000
    buffer_load_dwordx4 v[116:119], v10, s[48:51], s53 offen sc1
    s_add_u32 s53, s53, 0x20000
    buffer_load_dwordx4 v[120:123], v10, s[48:51], s53 offen sc1
    s_add_u32 s53, s53, 0x20000
    buffer_load_dwordx4 v[124:127], v10, s[48:51], s53 offen sc1
    s_add_u32 s53, s53, 0x20000
    buffer_load_dwordx4 v[128:131], v10, s[48:51], s53 offen sc1
    s_add_u32 s53, s53, 0x20000
    buffer_load_dwordx4 v[132:135], v10, s[48:51], s53 offen sc1
    s_add_u32 s53, s53, 0x20000
    buffer_load_dwordx4 v[136:139], v10, s[48:51], s53 offen sc1
    s_add_u32 s53, s53, 0x20000
    buffer_load_dwordx4 v[140:143], v10, s[48:51], s53 offen sc1
    s_add_u32 s53, s53, 0x20000
    buffer_load_dwordx4 v[144:147], v10, s[48:51], s53 offen sc1
    s_add_u32 s53, s53, 0x20000
    buffer_load_dwordx4 v[148:151], v10, s[48:51], s53 offen sc1
    s_add_u32 s53, s53, 0x20000
    v_mov_b32 v13, 0
    s_waitcnt vmcnt(13)
    v_max3_u32 v13, v13, v96, v97
    v_max3_u32 v13, v13, v98, v99
    s_waitcnt vmcnt(12)
    v_max3_u32 v13, v13, v100, v101
    v_max3_u32 v13, v13, v102, v103
    s_waitcnt vmcnt(11)
    v_max3_u32 v13, v13, v104, v105
    v_max3_u32 v13, v13, v106, v107
    s_waitcnt vmcnt(10)
    v_max3_u32 v13, v13, v108, v109
    v_max3_u32 v13, v13, v110, v111
    s_waitcnt vmcnt(9)
    v_max3_u32 v13, v13, v112, v113
    v_max3_u32 v13, v13, v114, v115
    s_waitcnt vmcnt(8)
    v_max3_u32 v13, v13, v116, v117
    v_max3_u32 v13, v13, v118, v119
    s_waitcnt vmcnt(7)
    v_max3_u32 v13, v13, v120, v121
    v_max3_u32 v13, v13, v122, v123
    s_waitcnt vmcnt(6)
    v_max3_u32 v13, v13, v124, v125
    v_max3_u32 v13, v13, v126, v127
    s_waitcnt vmcnt(5)
    v_max3_u32 v13, v13, v128, v129
    v_max3_u32 v13, v13, v130, v131
    s_waitcnt vmcnt(4)
    v_max3_u32 v13, v13, v132, v133
    v_max3_u32 v13, v13, v134, v135
    s_waitcnt vmcnt(3)
    v_max3_u32 v13, v13, v136, v137
    v_max3_u32 v13, v13, v138, v139
    s_waitcnt vmcnt(2)
    v_max3_u32 v13, v13, v140, v141
    v_max3_u32 v13, v13, v142, v143
    s_waitcnt vmcnt(1)
    v_max3_u32 v13, v13, v144, v145
    v_max3_u32 v13, v13, v146, v147
    s_waitcnt vmcnt(0)
    v_max3_u32 v13, v13, v148, v149
    v_max3_u32 v13, v13, v150, v151
    s_sub_u32 s52, s52, 1
    s_cbranch_scc1 ff_rgo_156
    v_cmp_eq_u32 vcc, -1, v13
    s_cbranch_vccnz ff_rpoll_157
ff_rgo_156:
    v_pk_add_f32 v[96:97], v[96:97], v[100:101]
    v_pk_add_f32 v[98:99], v[98:99], v[102:103]
    v_pk_add_f32 v[96:97], v[96:97], v[104:105]
    v_pk_add_f32 v[98:99], v[98:99], v[106:107]
    v_pk_add_f32 v[96:97], v[96:97], v[108:109]
    v_pk_add_f32 v[98:99], v[98:99], v[110:111]
    v_pk_add_f32 v[96:97], v[96:97], v[112:113]
    v_pk_add_f32 v[98:99], v[98:99], v[114:115]
    v_pk_add_f32 v[96:97], v[96:97], v[116:117]
    v_pk_add_f32 v[98:99], v[98:99], v[118:119]
    v_pk_add_f32 v[96:97], v[96:97], v[120:121]
    v_pk_add_f32 v[98:99], v[98:99], v[122:123]
    v_pk_add_f32 v[96:97], v[96:97], v[124:125]
    v_pk_add_f32 v[98:99], v[98:99], v[126:127]
    v_pk_add_f32 v[96:97], v[96:97], v[128:129]
    v_pk_add_f32 v[98:99], v[98:99], v[130:131]
    v_pk_add_f32 v[96:97], v[96:97], v[132:133]
    v_pk_add_f32 v[98:99], v[98:99], v[134:135]
    v_pk_add_f32 v[96:97], v[96:97], v[136:137]
    v_pk_add_f32 v[98:99], v[98:99], v[138:139]
    v_pk_add_f32 v[96:97], v[96:97], v[140:141]
    v_pk_add_f32 v[98:99], v[98:99], v[142:143]
    v_pk_add_f32 v[96:97], v[96:97], v[144:145]
    v_pk_add_f32 v[98:99], v[98:99], v[146:147]
    v_pk_add_f32 v[96:97], v[96:97], v[148:149]
    v_pk_add_f32 v[98:99], v[98:99], v[150:151]
    v_mov_b32 v100, v96
    v_mov_b32 v101, v97
    v_mov_b32 v102, v98
    v_mov_b32 v103, v99
    s_nop 1
    v_permlane16_swap_b32 v96, v100
    v_permlane16_swap_b32 v97, v101
    v_permlane16_swap_b32 v98, v102
    v_permlane16_swap_b32 v99, v103
    s_nop 1
    v_add_f32 v96, v96, v100
    v_add_f32 v97, v97, v101
    v_add_f32 v98, v98, v102
    v_add_f32 v99, v99, v103
    v_mov_b32 v100, v96
    v_mov_b32 v101, v97
    v_mov_b32 v102, v98
    v_mov_b32 v103, v99
    s_nop 1
    v_permlane32_swap_b32 v96, v100
    v_permlane32_swap_b32 v97, v101
    v_permlane32_swap_b32 v98, v102
    v_permlane32_swap_b32 v99, v103
    s_nop 1
    v_add_f32 v96, v96, v100
    v_add_f32 v97, v97, v101
    v_add_f32 v98, v98, v102
    v_add_f32 v99, v99, v103
    v_lshlrev_b32 v14, 4, v8
    s_lshl_b32 s31, s30, 8
    v_add_u32 v13, s31, v14
    ds_write_b128 v13, v[96:99]
    s_waitcnt lgkmcnt(0)
    s_barrier
    ds_read_b128 v[96:99], v14 offset:0
    ds_read_b128 v[100:103], v14 offset:256
    ds_read_b128 v[104:107], v14 offset:512
    ds_read_b128 v[108:111], v14 offset:768
    s_waitcnt lgkmcnt(0)
    v_pk_add_f32 v[96:97], v[96:97], v[100:101]
    v_pk_add_f32 v[98:99], v[98:99], v[102:103]
    v_pk_add_f32 v[96:97], v[96:97], v[104:105]
    v_pk_add_f32 v[98:99], v[98:99], v[106:107]
    v_pk_add_f32 v[96:97], v[96:97], v[108:109]
    v_pk_add_f32 v[98:99], v[98:99], v[110:111]
    v_cvt_pk_bf16_f32 v20, v96, v97
    v_lshlrev_b32 v21, 16, v20
    v_and_b32 v22, 0xffff0000, v20
    v_mul_f32 v21, s45, v21
    v_mul_f32 v22, s45, v22
    v_cvt_pk_bf16_f32 v20, v21, v22
    v_lshlrev_b32 v21, 16, v20
    v_and_b32 v22, 0xffff0000, v20
    v_lshlrev_b32 v23, 16, v32
    v_and_b32 v24, 0xffff0000, v32
    v_add_f32 v21, v21, v23
    v_add_f32 v22, v22, v24
    v_cvt_pk_bf16_f32 v20, v21, v22
    v_lshlrev_b32 v21, 16, v20
    v_and_b32 v22, 0xffff0000, v20
    v_lshlrev_b32 v23, 16, v34
    v_and_b32 v24, 0xffff0000, v34
    v_add_f32 v21, v21, v23
    v_add_f32 v22, v22, v24
    v_cvt_pk_bf16_f32 v26, v21, v22
    v_cvt_pk_bf16_f32 v20, v98, v99
    v_lshlrev_b32 v21, 16, v20
    v_and_b32 v22, 0xffff0000, v20
    v_mul_f32 v21, s45, v21
    v_mul_f32 v22, s45, v22
    v_cvt_pk_bf16_f32 v20, v21, v22
    v_lshlrev_b32 v21, 16, v20
    v_and_b32 v22, 0xffff0000, v20
    v_lshlrev_b32 v23, 16, v33
    v_and_b32 v24, 0xffff0000, v33
    v_add_f32 v21, v21, v23
    v_add_f32 v22, v22, v24
    v_cvt_pk_bf16_f32 v20, v21, v22
    v_lshlrev_b32 v21, 16, v20
    v_and_b32 v22, 0xffff0000, v20
    v_lshlrev_b32 v23, 16, v35
    v_and_b32 v24, 0xffff0000, v35
    v_add_f32 v21, v21, v23
    v_add_f32 v22, v22, v24
    v_cvt_pk_bf16_f32 v27, v21, v22
    v_cmp_gt_u32 vcc, 16, v2
    s_and_saveexec_b64 s[52:53], vcc
    s_cbranch_execz ff_fin_155
    buffer_store_dwordx2 v[26:27], v9, s[36:39], s46 offen sc1
ff_fin_155:
    s_mov_b64 exec, -1
k12_end_1:
    s_endpgm
k2_prep_76:
    s_sub_u32 s40, s36, s38
    v_subrev_u32 v6, s40, v4
    v_cmp_gt_i32 s[44:45], 0, v6
    v_cmp_gt_i32 s[46:47], 1, v6
    v_cmp_gt_i32 s[48:49], 2, v6
    v_cmp_gt_i32 s[50:51], 3, v6
    v_cndmask_b32 v16, v8, v5, s[44:45]
    v_cndmask_b32 v17, v8, v5, s[46:47]
    v_cndmask_b32 v18, v8, v5, s[48:49]
    v_cndmask_b32 v19, v8, v5, s[50:51]
    v_cmp_gt_i32 s[44:45], 16, v6
    v_cmp_gt_i32 s[46:47], 17, v6
    v_cmp_gt_i32 s[48:49], 18, v6
    v_cmp_gt_i32 s[50:51], 19, v6
    v_cndmask_b32 v32, v8, v5, s[44:45]
    v_cndmask_b32 v33, v8, v5, s[46:47]
    v_cndmask_b32 v34, v8, v5, s[48:49]
    v_cndmask_b32 v35, v8, v5, s[50:51]
    s_nop 1
    s_branch k2_prepret_77
k2_prep_84:
    s_sub_u32 s40, s36, s38
    v_subrev_u32 v6, s40, v4
    v_cmp_gt_i32 s[44:45], 0, v6
    v_cmp_gt_i32 s[46:47], 1, v6
    v_cmp_gt_i32 s[48:49], 2, v6
    v_cmp_gt_i32 s[50:51], 3, v6
    v_cndmask_b32 v16, v8, v5, s[44:45]
    v_cndmask_b32 v17, v8, v5, s[46:47]
    v_cndmask_b32 v18, v8, v5, s[48:49]
    v_cndmask_b32 v19, v8, v5, s[50:51]
    v_cmp_gt_i32 s[44:45], 16, v6
    v_cmp_gt_i32 s[46:47], 17, v6
    v_cmp_gt_i32 s[48:49], 18, v6
    v_cmp_gt_i32 s[50:51], 19, v6
    v_cndmask_b32 v32, v8, v5, s[44:45]
    v_cndmask_b32 v33, v8, v5, s[46:47]
    v_cndmask_b32 v34, v8, v5, s[48:49]
    v_cndmask_b32 v35, v8, v5, s[50:51]
    s_nop 1
    s_branch k2_prepret_85
k2_prep_102:
    s_sub_u32 s40, s36, s39
    v_subrev_u32 v6, s40, v4
    v_cmp_gt_i32 s[44:45], 0, v6
    v_cmp_gt_i32 s[46:47], 1, v6
    v_cmp_gt_i32 s[48:49], 2, v6
    v_cmp_gt_i32 s[50:51], 3, v6
    v_cndmask_b32 v16, v10, v5, s[44:45]
    v_cndmask_b32 v17, v10, v5, s[46:47]
    v_cndmask_b32 v18, v10, v5, s[48:49]
    v_cndmask_b32 v19, v10, v5, s[50:51]
    v_cmp_gt_i32 s[44:45], 16, v6
    v_cmp_gt_i32 s[46:47], 17, v6
    v_cmp_gt_i32 s[48:49], 18, v6
    v_cmp_gt_i32 s[50:51], 19, v6
    v_cndmask_b32 v32, v10, v5, s[44:45]
    v_cndmask_b32 v33, v10, v5, s[46:47]
    v_cndmask_b32 v34, v10, v5, s[48:49]
    v_cndmask_b32 v35, v10, v5, s[50:51]
    v_cmp_gt_i32 s[44:45], 32, v6
    v_cmp_gt_i32 s[46:47], 33, v6
    v_cmp_gt_i32 s[48:49], 34, v6
    v_cmp_gt_i32 s[50:51], 35, v6
    v_cndmask_b32 v24, v10, v5, s[44:45]
    v_cndmask_b32 v25, v10, v5, s[46:47]
    v_cndmask_b32 v26, v10, v5, s[48:49]
    v_cndmask_b32 v27, v10, v5, s[50:51]
    v_cmp_gt_i32 s[44:45], 48, v6
    v_cmp_gt_i32 s[46:47], 49, v6
    v_cmp_gt_i32 s[48:49], 50, v6
    v_cmp_gt_i32 s[50:51], 51, v6
    v_cndmask_b32 v40, v10, v5, s[44:45]
    v_cndmask_b32 v41, v10, v5, s[46:47]
    v_cndmask_b32 v42, v10, v5, s[48:49]
    v_cndmask_b32 v43, v10, v5, s[50:51]
    s_nop 1
    s_branch k2_prepret_103
k2_prep_106:
    s_sub_u32 s40, s36, s39
    s_sub_u32 s40, s40, 64
    v_subrev_u32 v6, s40, v4
    v_cmp_gt_i32 s[44:45], 0, v6
    v_cmp_gt_i32 s[46:47], 1, v6
    v_cmp_gt_i32 s[48:49], 2, v6
    v_cmp_gt_i32 s[50:51], 3, v6
    v_cndmask_b32 v20, v11, v5, s[44:45]
    v_cndmask_b32 v21, v11, v5, s[46:47]
    v_cndmask_b32 v22, v11, v5, s[48:49]
    v_cndmask_b32 v23, v11, v5, s[50:51]
    v_cmp_gt_i32 s[44:45], 16, v6
    v_cmp_gt_i32 s[46:47], 17, v6
    v_cmp_gt_i32 s[48:49], 18, v6
    v_cmp_gt_i32 s[50:51], 19, v6
    v_cndmask_b32 v36, v11, v5, s[44:45]
    v_cndmask_b32 v37, v11, v5, s[46:47]
    v_cndmask_b32 v38, v11, v5, s[48:49]
    v_cndmask_b32 v39, v11, v5, s[50:51]
    v_cmp_gt_i32 s[44:45], 32, v6
    v_cmp_gt_i32 s[46:47], 33, v6
    v_cmp_gt_i32 s[48:49], 34, v6
    v_cmp_gt_i32 s[50:51], 35, v6
    v_cndmask_b32 v28, v11, v5, s[44:45]
    v_cndmask_b32 v29, v11, v5, s[46:47]
    v_cndmask_b32 v30, v11, v5, s[48:49]
    v_cndmask_b32 v31, v11, v5, s[50:51]
    v_cmp_gt_i32 s[44:45], 48, v6
    v_cmp_gt_i32 s[46:47], 49, v6
    v_cmp_gt_i32 s[48:49], 50, v6
    v_cmp_gt_i32 s[50:51], 51, v6
    v_cndmask_b32 v44, v11, v5, s[44:45]
    v_cndmask_b32 v45, v11, v5, s[46:47]
    v_cndmask_b32 v46, v11, v5, s[48:49]
    v_cndmask_b32 v47, v11, v5, s[50:51]
    s_nop 1
    s_branch k2_prepret_107
k12_ool_10:
    buffer_load_dword v52, v8, s[24:27], 0 offen sc1
    s_branch k12_oolret_11
k12_ool_14:
    v_readfirstlane_b32 s31, v52
    s_cmp_ge_u32 s31, 256
    s_cbranch_scc1 spin_ok_12
    s_mov_b32 s40, 1048576
spin_13:
    s_sleep 8
    buffer_load_dword v52, v8, s[24:27], 0 offen sc1
    s_waitcnt vmcnt(0)
    v_readfirstlane_b32 s31, v52
    s_sub_u32 s40, s40, 1
    s_cselect_b32 s31, -1, s31
    s_cmp_lt_u32 s31, 256
    s_cbranch_scc1 spin_13
spin_ok_12:
    s_branch k12_oolret_15
k12_ool_16:
    s_mov_b64 exec, 1
    buffer_atomic_add v9, v8, s[24:27], 0 offen sc1
    s_mov_b64 exec, -1
    s_branch k12_oolret_17
k12_ool_18:
    buffer_load_dword v51, v50, s[12:15], s56 offen
    s_branch k12_oolret_19
k12_ool_20:
    s_add_u32 m0, s60, 131072
    s_nop 0
    buffer_load_dwordx4 v38, s[12:15], s61 offen offset:0 lds
    buffer_load_dwordx4 v39, s[12:15], s61 offen offset:1024 lds
    buffer_load_dwordx4 v40, s[12:15], s61 offen offset:2048 lds
    buffer_load_dwordx4 v41, s[12:15], s61 offen offset:3072 lds
    s_add_u32 s61, s61, 0x80000
    s_add_u32 m0, s60, 147456
    s_nop 0
    buffer_load_dwordx4 v38, s[12:15], s61 offen offset:0 lds
    buffer_load_dwordx4 v39, s[12:15], s61 offen offset:1024 lds
    buffer_load_dwordx4 v40, s[12:15], s61 offen offset:2048 lds
    buffer_load_dwordx4 v41, s[12:15], s61 offen offset:3072 lds
    s_add_u32 s61, s61, 0x80000
    s_branch k12_oolret_21
k12_ool_22:
    s_mov_b64 exec, 1
    buffer_atomic_add v9, v8, s[24:27], 0 offen sc1
    s_mov_b64 exec, -1
    s_branch k12_oolret_23
k12_ool_24:
    buffer_load_dword v51, v50, s[12:15], s56 offen
    s_branch k12_oolret_25
k12_ool_26:
    global_load_dword v51, v[2:3], off
    s_branch k12_oolret_27
k12_ool_30:
    buffer_load_dword v52, v8, s[24:27], 0 offen sc1
    s_branch k12_oolret_31
k12_ool_34:
    v_readfirstlane_b32 s31, v52
    s_cmp_ge_u32 s31, 256
    s_cbranch_scc1 spin_ok_32
    s_mov_b32 s40, 1048576
spin_33:
    s_sleep 8
    buffer_load_dword v52, v8, s[24:27], 0 offen sc1
    s_waitcnt vmcnt(0)
    v_readfirstlane_b32 s31, v52
    s_sub_u32 s40, s40, 1
    s_cselect_b32 s31, -1, s31
    s_cmp_lt_u32 s31, 256
    s_cbranch_scc1 spin_33
spin_ok_32:
    s_branch k12_oolret_35
k12_ool_36:
    s_mov_b64 exec, 1
    buffer_atomic_add v9, v8, s[24:27], 0 offen sc1
    s_mov_b64 exec, -1
    s_branch k12_oolret_37
k12_ool_38:
    buffer_load_dword v51, v50, s[12:15], s56 offen
    s_branch k12_oolret_39
k12_ool_40:
    s_add_u32 m0, s60, 131072
    s_nop 0
    buffer_load_dwordx4 v38, s[12:15], s61 offen offset:0 lds
    buffer_load_dwordx4 v39, s[12:15], s61 offen offset:1024 lds
    buffer_load_dwordx4 v40, s[12:15], s61 offen offset:2048 lds
    buffer_load_dwordx4 v41, s[12:15], s61 offen offset:3072 lds
    s_add_u32 s61, s61, 0x80000
    s_add_u32 m0, s60, 147456
    s_nop 0
    buffer_load_dwordx4 v38, s[12:15], s61 offen offset:0 lds
    buffer_load_dwordx4 v39, s[12:15], s61 offen offset:1024 lds
    buffer_load_dwordx4 v40, s[12:15], s61 offen offset:2048 lds
    buffer_load_dwordx4 v41, s[12:15], s61 offen offset:3072 lds
    s_add_u32 s61, s61, 0x80000
    s_branch k12_oolret_41
k12_ool_42:
    s_mov_b64 exec, 1
    buffer_atomic_add v9, v8, s[24:27], 0 offen sc1
    s_mov_b64 exec, -1
    s_branch k12_oolret_43
k12_ool_44:
    buffer_load_dword v51, v50, s[12:15], s56 offen
    s_branch k12_oolret_45
k12_ool_46:
    global_load_dword v51, v[2:3], off
    s_branch k12_oolret_47
k12_ool_48:
    s_add_u32 s52, s47, 528384
    buffer_store_dwordx4 v[152:155], v1, s[48:51], s52 offen offset:2048 sc1
    s_branch k12_oolret_49
k12_ool_50:
    s_add_u32 s52, s47, 528384
    buffer_store_dwordx4 v[156:159], v1, s[48:51], s52 offen offset:3072 sc1
    s_branch k12_oolret_51
k12_ool_52:
    s_add_u32 s52, s47, 532480
    buffer_store_dwordx4 v[168:171], v1, s[48:51], s52 offen offset:2048 sc1
    s_branch k12_oolret_53
k12_ool_54:
    s_add_u32 s52, s47, 532480
    buffer_store_dwordx4 v[172:175], v1, s[48:51], s52 offen offset:3072 sc1
    s_branch k12_oolret_55
k12_ool_56:
    s_add_u32 s52, s47, 536576
    buffer_store_dwordx4 v[176:179], v1, s[48:51], s52 offen offset:0 sc1
    s_branch k12_oolret_57
k12_ool_58:
    s_add_u32 s52, s47, 536576
    buffer_store_dwordx4 v[180:183], v1, s[48:51], s52 offen offset:1024 sc1
    s_branch k12_oolret_59
k12_ool_60:
    s_add_u32 s52, s47, 536576
    buffer_store_dwordx4 v[184:187], v1, s[48:51], s52 offen offset:2048 sc1
    s_branch k12_oolret_61
k12_ool_62:
    s_add_u32 s52, s47, 536576
    buffer_store_dwordx4 v[188:191], v1, s[48:51], s52 offen offset:3072 sc1
    s_branch k12_oolret_63
k12_ool_64:
    s_mov_b32 s50, 0
    s_branch k12_oolret_65
k12_ool_66:
    s_mov_b64 exec, 1
    buffer_atomic_add v9, v8, s[24:27], s54 offen sc1
    s_mov_b64 exec, -1
    s_branch k12_oolret_67
k12_ool_68:
    buffer_load_dword v52, v8, s[24:27], s55 offen sc1
    s_branch k12_oolret_69
k12_ool_72:
    s_waitcnt vmcnt(10)
    v_readfirstlane_b32 s31, v52
    s_cmp_ge_u32 s31, 2
    s_cbranch_scc1 spin_ok_70
    s_mov_b32 s40, 1048576
spin_71:
    s_sleep 8
    buffer_load_dword v52, v8, s[24:27], s55 offen sc1
    s_waitcnt vmcnt(0)
    v_readfirstlane_b32 s31, v52
    s_sub_u32 s40, s40, 1
    s_cselect_b32 s31, -1, s31
    s_cmp_lt_u32 s31, 2
    s_cbranch_scc1 spin_71
spin_ok_70:
    s_branch k12_oolret_73
k12_ool_74:
    s_mov_b64 exec, 1
    buffer_atomic_add v9, v8, s[24:27], s3 offen sc1
    s_mov_b64 exec, -1
    s_branch k12_oolret_75
k12_ool_78:
    buffer_load_dword v58, v59, s[24:27], s5 offen sc1
    s_branch k12_oolret_79
k12_ool_82:
    s_waitcnt vmcnt(0)
    v_readfirstlane_b32 s31, v58
    s_cmp_ge_u32 s31, 14
    s_cbranch_scc1 spin_ok_80
    s_mov_b32 s40, 1048576
spin_81:
    s_sleep 8
    buffer_load_dword v58, v59, s[24:27], s5 offen sc1
    s_waitcnt vmcnt(0)
    v_readfirstlane_b32 s31, v58
    s_sub_u32 s40, s40, 1
    s_cselect_b32 s31, -1, s31
    s_cmp_lt_u32 s31, 14
    s_cbranch_scc1 spin_81
spin_ok_80:
    s_branch k12_oolret_83
k12_ool_122:
    s_mov_b64 exec, 1
    buffer_atomic_add v76, v75, s[16:19], s57 offen sc1
    s_mov_b64 exec, -1
    s_branch k12_oolret_123
k12_ool_127:
    s_mov_b64 exec, 1
    buffer_atomic_add v76, v75, s[16:19], s58 offen sc1
    s_mov_b64 exec, -1
    s_branch k12_oolret_128
k12_ool_131:
    s_mov_b32 s34, 1048576
op_spin_129:
    buffer_load_dword v74, v73, s[16:19], s59 offen sc1
    s_waitcnt vmcnt(0)
    v_cmp_le_u32 vcc, 4, v74
    s_sub_u32 s34, s34, 1
    s_cbranch_scc1 op_ok_130
    s_mov_b32 s33, vcc_lo
    s_bitcmp1_b32 s33, 0
    s_cbranch_scc1 op_ok_130
    s_sleep 4
    s_branch op_spin_129
op_ok_130:
    buffer_load_dwordx4 a[128:131], v88, s[8:11], s62 offen offset:0 sc1
    buffer_load_dwordx4 a[132:135], v88, s[8:11], s62 offen offset:1024 sc1
    buffer_load_dwordx4 a[136:139], v89, s[8:11], s62 offen offset:0 sc1
    buffer_load_dwordx4 a[140:143], v89, s[8:11], s62 offen offset:1024 sc1
    s_add_u32 s62, s62, 0x40000
    s_and_b32 s62, s62, 0x7fffff
    buffer_load_dwordx4 a[144:147], v88, s[8:11], s62 offen offset:0 sc1
    buffer_load_dwordx4 a[148:151], v88, s[8:11], s62 offen offset:1024 sc1
    buffer_load_dwordx4 a[152:155], v89, s[8:11], s62 offen offset:0 sc1
    buffer_load_dwordx4 a[156:159], v89, s[8:11], s62 offen offset:1024 sc1
    s_add_u32 s62, s62, 0x40000
    s_and_b32 s62, s62, 0x7fffff
    buffer_load_dwordx4 a[160:163], v88, s[8:11], s62 offen offset:0 sc1
    buffer_load_dwordx4 a[164:167], v88, s[8:11], s62 offen offset:1024 sc1
    buffer_load_dwordx4 a[168:171], v89, s[8:11], s62 offen offset:0 sc1
    buffer_load_dwordx4 a[172:175], v89, s[8:11], s62 offen offset:1024 sc1
    s_add_u32 s62, s62, 0x40000
    s_and_b32 s62, s62, 0x7fffff
    s_branch k12_oolret_132
k12_ool_137:
    buffer_load_dwordx2 v[192:193], v78, s[20:23], 0 offen offset:0
    buffer_load_dwordx2 v[194:195], v78, s[20:23], 0 offen offset:32
    buffer_load_dwordx2 v[196:197], v78, s[20:23], 0 offen offset:64
    buffer_load_dwordx2 v[198:199], v78, s[20:23], 0 offen offset:96
    buffer_load_dwordx2 v[200:201], v79, s[20:23], 0 offen offset:0
    buffer_load_dwordx2 v[202:203], v79, s[20:23], 0 offen offset:32
    buffer_load_dwordx2 v[204:205], v79, s[20:23], 0 offen offset:64
    buffer_load_dwordx2 v[206:207], v79, s[20:23], 0 offen offset:96
    buffer_load_dwordx2 v[208:209], v80, s[44:47], 0 offen offset:0
    buffer_load_dwordx2 v[210:211], v80, s[44:47], 0 offen offset:32
    buffer_load_dwordx2 v[212:213], v80, s[44:47], 0 offen offset:64
    buffer_load_dwordx2 v[214:215], v80, s[44:47], 0 offen offset:96
    global_load_dword v84, v[82:83], off
    s_mov_b32 s10, 0
    s_mov_b32 s14, 0
    s_mov_b32 s34, 1048576
ff_spin_135:
    v_cmp_gt_u32 vcc, 4, v95
    s_cbranch_vccz ff_ok_136
    s_sub_u32 s34, s34, 1
    s_cbranch_scc1 ff_ok_136
    s_sleep 4
    buffer_load_dword v95, v94, s[16:19], 0 offen sc1
    s_waitcnt vmcnt(0)
    s_branch ff_spin_135
ff_ok_136:
    s_add_u32 s44, s6, 0x6000000
    s_addc_u32 s45, s7, 0
    s_and_b32 s45, s45, 0xffff
    s_cmp_ge_u32 s2, 224
    s_cselect_b32 s46, 0, 0x1000000
    s_branch k12_oolret_138
k12_ool_141:
    s_mov_b32 s34, 1048576
op_spin_139:
    buffer_load_dword v74, v73, s[16:19], s59 offen sc1
    s_waitcnt vmcnt(0)
    v_cmp_le_u32 vcc, 4, v74
    s_sub_u32 s34, s34, 1
    s_cbranch_scc1 op_ok_140
    s_mov_b32 s33, vcc_lo
    s_bitcmp1_b32 s33, s32
    s_cbranch_scc1 op_ok_140
    s_sleep 4
    s_branch op_spin_139
op_ok_140:
    s_branch k12_oolret_142
k12_ool_143:
    buffer_load_dword v95, v94, s[16:19], 0 offen sc1
    s_branch k12_oolret_144
k2_tramp_86:
    s_call_b64 s[40:41], k2_rare_158
    s_branch k2_ret_87
k2_tramp_90:
    s_call_b64 s[40:41], k2_rare_159
    s_branch k2_ret_91
k2_tramp_92:
    s_call_b64 s[40:41], k2_rare_158
    s_branch k2_ret_93
k2_tramp_94:
    s_call_b64 s[40:41], k2_rare_159
    s_branch k2_ret_95
k2_tramp_96:
    s_call_b64 s[40:41], k2_rare_158
    s_branch k2_ret_97
k2_tramp_98:
    s_call_b64 s[40:41], k2_rare_159
    s_branch k2_ret_99
k2_tramp_100:
    s_call_b64 s[40:41], k2_rare_164
    s_branch k2_ret_101
k2_tramp_104:
    s_call_b64 s[40:41], k2_rare_165
    s_branch k2_ret_105
k2_tramp_108:
    s_call_b64 s[40:41], k2_rare_166
    s_branch k2_ret_109
k2_tramp_112:
    s_call_b64 s[40:41], k2_rare_167
    s_branch k2_ret_113
k2_tramp_114:
    s_call_b64 s[40:41], k2_rare_166
    s_branch k2_ret_115
k2_tramp_116:
    s_call_b64 s[40:41], k2_rare_167
    s_branch k2_ret_117
k2_tramp_118:
    s_call_b64 s[40:41], k2_rare_166
    s_branch k2_ret_119
k2_tramp_120:
    s_call_b64 s[40:41], k2_rare_171
    s_branch k2_ret_121
k2_rare_158:
    s_nop 7
    v_max_f32 v52, v128, v129
    v_max3_f32 v52, v52, v130, v131
    v_max3_f32 v52, v52, v144, v145
    v_max3_f32 v52, v52, v146, v147
    v_max_f32 v53, v132, v133
    v_max3_f32 v53, v53, v134, v135
    v_max3_f32 v53, v53, v148, v149
    v_max3_f32 v53, v53, v150, v151
    v_max_f32 v54, v136, v137
    v_max3_f32 v54, v54, v138, v139
    v_max3_f32 v54, v54, v152, v153
    v_max3_f32 v54, v54, v154, v155
    v_max_f32 v55, v140, v141
    v_max3_f32 v55, v55, v142, v143
    v_max3_f32 v55, v55, v156, v157
    v_max3_f32 v55, v55, v158, v159
    v_mov_b32 v224, v52
    v_mov_b32 v225, v53
    v_mov_b32 v226, v54
    v_mov_b32 v227, v55
    s_nop 1
    v_permlane16_swap_b32 v52, v224
    v_permlane16_swap_b32 v53, v225
    v_permlane16_swap_b32 v54, v226
    v_permlane16_swap_b32 v55, v227
    s_nop 1
    v_max_f32 v52, v52, v224
    v_max_f32 v53, v53, v225
    v_max_f32 v54, v54, v226
    v_max_f32 v55, v55, v227
    v_mov_b32 v224, v52
    v_mov_b32 v225, v53
    v_mov_b32 v226, v54
    v_mov_b32 v227, v55
    s_nop 1
    v_permlane32_swap_b32 v52, v224
    v_permlane32_swap_b32 v53, v225
    v_permlane32_swap_b32 v54, v226
    v_permlane32_swap_b32 v55, v227
    s_nop 1
    v_max_f32 v52, v52, v224
    v_max_f32 v53, v53, v225
    v_max_f32 v54, v54, v226
    v_max_f32 v55, v55, v227
    v_add_f32 v52, 0x41400000, v52
    v_max_f32 v52, 0, v52
    v_add_f32 v53, 0x41400000, v53
    v_max_f32 v53, 0, v53
    v_add_f32 v54, 0x41400000, v54
    v_max_f32 v54, 0, v54
    v_add_f32 v55, 0x41400000, v55
    v_max_f32 v55, 0, v55
    v_sub_f32 v128, v128, v52
    v_sub_f32 v129, v129, v52
    v_sub_f32 v130, v130, v52
    v_sub_f32 v131, v131, v52
    v_sub_f32 v132, v132, v53
    v_sub_f32 v133, v133, v53
    v_sub_f32 v134, v134, v53
    v_sub_f32 v135, v135, v53
    v_sub_f32 v136, v136, v54
    v_sub_f32 v137, v137, v54
    v_sub_f32 v138, v138, v54
    v_sub_f32 v139, v139, v54
    v_sub_f32 v140, v140, v55
    v_sub_f32 v141, v141, v55
    v_sub_f32 v142, v142, v55
    v_sub_f32 v143, v143, v55
    v_sub_f32 v144, v144, v52
    v_sub_f32 v145, v145, v52
    v_sub_f32 v146, v146, v52
    v_sub_f32 v147, v147, v52
    v_sub_f32 v148, v148, v53
    v_sub_f32 v149, v149, v53
    v_sub_f32 v150, v150, v53
    v_sub_f32 v151, v151, v53
    v_sub_f32 v152, v152, v54
    v_sub_f32 v153, v153, v54
    v_sub_f32 v154, v154, v54
    v_sub_f32 v155, v155, v54
    v_sub_f32 v156, v156, v55
    v_sub_f32 v157, v157, v55
    v_sub_f32 v158, v158, v55
    v_sub_f32 v159, v159, v55
    v_sub_f32 v160, v160, v52
    v_sub_f32 v16, v16, v52
    v_sub_f32 v161, v161, v52
    v_sub_f32 v17, v17, v52
    v_sub_f32 v162, v162, v52
    v_sub_f32 v18, v18, v52
    v_sub_f32 v163, v163, v52
    v_sub_f32 v19, v19, v52
    v_sub_f32 v164, v164, v53
    v_sub_f32 v20, v20, v53
    v_sub_f32 v165, v165, v53
    v_sub_f32 v21, v21, v53
    v_sub_f32 v166, v166, v53
    v_sub_f32 v22, v22, v53
    v_sub_f32 v167, v167, v53
    v_sub_f32 v23, v23, v53
    v_sub_f32 v168, v168, v54
    v_sub_f32 v24, v24, v54
    v_sub_f32 v169, v169, v54
    v_sub_f32 v25, v25, v54
    v_sub_f32 v170, v170, v54
    v_sub_f32 v26, v26, v54
    v_sub_f32 v171, v171, v54
    v_sub_f32 v27, v27, v54
    v_sub_f32 v172, v172, v55
    v_sub_f32 v28, v28, v55
    v_sub_f32 v173, v173, v55
    v_sub_f32 v29, v29, v55
    v_sub_f32 v174, v174, v55
    v_sub_f32 v30, v30, v55
    v_sub_f32 v175, v175, v55
    v_sub_f32 v31, v31, v55
    v_sub_f32 v176, v176, v52
    v_sub_f32 v32, v32, v52
    v_sub_f32 v177, v177, v52
    v_sub_f32 v33, v33, v52
    v_sub_f32 v178, v178, v52
    v_sub_f32 v34, v34, v52
    v_sub_f32 v179, v179, v52
    v_sub_f32 v35, v35, v52
    v_sub_f32 v180, v180, v53
    v_sub_f32 v36, v36, v53
    v_sub_f32 v181, v181, v53
    v_sub_f32 v37, v37, v53
    v_sub_f32 v182, v182, v53
    v_sub_f32 v38, v38, v53
    v_sub_f32 v183, v183, v53
    v_sub_f32 v39, v39, v53
    v_sub_f32 v184, v184, v54
    v_sub_f32 v40, v40, v54
    v_sub_f32 v185, v185, v54
    v_sub_f32 v41, v41, v54
    v_sub_f32 v186, v186, v54
    v_sub_f32 v42, v42, v54
    v_sub_f32 v187, v187, v54
    v_sub_f32 v43, v43, v54
    v_sub_f32 v188, v188, v55
    v_sub_f32 v44, v44, v55
    v_sub_f32 v189, v189, v55
    v_sub_f32 v45, v45, v55
    v_sub_f32 v190, v190, v55
    v_sub_f32 v46, v46, v55
    v_sub_f32 v191, v191, v55
    v_sub_f32 v47, v47, v55
    v_sub_f32 v8, v8, v52
    v_exp_f32 v52, -v52
    v_sub_f32 v9, v9, v53
    v_exp_f32 v53, -v53
    v_sub_f32 v10, v10, v54
    v_exp_f32 v54, -v54
    v_sub_f32 v11, v11, v55
    v_exp_f32 v55, -v55
    s_nop 0
    v_mul_f32 v12, v12, v52
    v_mul_f32 v48, v48, v53
    v_mul_f32 v248, v248, v54
    v_mul_f32 v252, v252, v55
    v_accvgpr_read_b32 v224, a0
    v_accvgpr_read_b32 v225, a1
    v_accvgpr_read_b32 v226, a2
    v_accvgpr_read_b32 v227, a3
    v_mul_f32 v224, v224, v52
    v_mul_f32 v225, v225, v52
    v_mul_f32 v226, v226, v52
    v_mul_f32 v227, v227, v52
    v_accvgpr_write_b32 a0, v224
    v_accvgpr_write_b32 a1, v225
    v_accvgpr_write_b32 a2, v226
    v_accvgpr_write_b32 a3, v227
    v_accvgpr_read_b32 v224, a4
    v_accvgpr_read_b32 v225, a5
    v_accvgpr_read_b32 v226, a6
    v_accvgpr_read_b32 v227, a7
    v_mul_f32 v224, v224, v53
    v_mul_f32 v225, v225, v53
    v_mul_f32 v226, v226, v53
    v_mul_f32 v227, v227, v53
    v_accvgpr_write_b32 a4, v224
    v_accvgpr_write_b32 a5, v225
    v_accvgpr_write_b32 a6, v226
    v_accvgpr_write_b32 a7, v227
    v_accvgpr_read_b32 v224, a8
    v_accvgpr_read_b32 v225, a9
    v_accvgpr_read_b32 v226, a10
    v_accvgpr_read_b32 v227, a11
    v_mul_f32 v224, v224, v54
    v_mul_f32 v225, v225, v54
    v_mul_f32 v226, v226, v54
    v_mul_f32 v227, v227, v54
    v_accvgpr_write_b32 a8, v224
    v_accvgpr_write_b32 a9, v225
    v_accvgpr_write_b32 a10, v226
    v_accvgpr_write_b32 a11, v227
    v_accvgpr_read_b32 v224, a12
    v_accvgpr_read_b32 v225, a13
    v_accvgpr_read_b32 v226, a14
    v_accvgpr_read_b32 v227, a15
    v_mul_f32 v224, v224, v55
    v_mul_f32 v225, v225, v55
    v_mul_f32 v226, v226, v55
    v_mul_f32 v227, v227, v55
    v_accvgpr_write_b32 a12, v224
    v_accvgpr_write_b32 a13, v225
    v_accvgpr_write_b32 a14, v226
    v_accvgpr_write_b32 a15, v227
    v_accvgpr_read_b32 v224, a16
    v_accvgpr_read_b32 v225, a17
    v_accvgpr_read_b32 v226, a18
    v_accvgpr_read_b32 v227, a19
    v_mul_f32 v224, v224, v52
    v_mul_f32 v225, v225, v52
    v_mul_f32 v226, v226, v52
    v_mul_f32 v227, v227, v52
    v_accvgpr_write_b32 a16, v224
    v_accvgpr_write_b32 a17, v225
    v_accvgpr_write_b32 a18, v226
    v_accvgpr_write_b32 a19, v227
    v_accvgpr_read_b32 v224, a20
    v_accvgpr_read_b32 v225, a21
    v_accvgpr_read_b32 v226, a22
    v_accvgpr_read_b32 v227, a23
    v_mul_f32 v224, v224, v53
    v_mul_f32 v225, v225, v53
    v_mul_f32 v226, v226, v53
    v_mul_f32 v227, v227, v53
    v_accvgpr_write_b32 a20, v224
    v_accvgpr_write_b32 a21, v225
    v_accvgpr_write_b32 a22, v226
    v_accvgpr_write_b32 a23, v227
    v_accvgpr_read_b32 v224, a24
    v_accvgpr_read_b32 v225, a25
    v_accvgpr_read_b32 v226, a26
    v_accvgpr_read_b32 v227, a27
    v_mul_f32 v224, v224, v54
    v_mul_f32 v225, v225, v54
    v_mul_f32 v226, v226, v54
    v_mul_f32 v227, v227, v54
    v_accvgpr_write_b32 a24, v224
    v_accvgpr_write_b32 a25, v225
    v_accvgpr_write_b32 a26, v226
    v_accvgpr_write_b32 a27, v227
    v_accvgpr_read_b32 v224, a28
    v_accvgpr_read_b32 v225, a29
    v_accvgpr_read_b32 v226, a30
    v_accvgpr_read_b32 v227, a31
    v_mul_f32 v224, v224, v55
    v_mul_f32 v225, v225, v55
    v_mul_f32 v226, v226, v55
    v_mul_f32 v227, v227, v55
    v_accvgpr_write_b32 a28, v224
    v_accvgpr_write_b32 a29, v225
    v_accvgpr_write_b32 a30, v226
    v_accvgpr_write_b32 a31, v227
    v_accvgpr_read_b32 v224, a32
    v_accvgpr_read_b32 v225, a33
    v_accvgpr_read_b32 v226, a34
    v_accvgpr_read_b32 v227, a35
    v_mul_f32 v224, v224, v52
    v_mul_f32 v225, v225, v52
    v_mul_f32 v226, v226, v52
    v_mul_f32 v227, v227, v52
    v_accvgpr_write_b32 a32, v224
    v_accvgpr_write_b32 a33, v225
    v_accvgpr_write_b32 a34, v226
    v_accvgpr_write_b32 a35, v227
    v_accvgpr_read_b32 v224, a36
    v_accvgpr_read_b32 v225, a37
    v_accvgpr_read_b32 v226, a38
    v_accvgpr_read_b32 v227, a39
    v_mul_f32 v224, v224, v53
    v_mul_f32 v225, v225, v53
    v_mul_f32 v226, v226, v53
    v_mul_f32 v227, v227, v53
    v_accvgpr_write_b32 a36, v224
    v_accvgpr_write_b32 a37, v225
    v_accvgpr_write_b32 a38, v226
    v_accvgpr_write_b32 a39, v227
    v_accvgpr_read_b32 v224, a40
    v_accvgpr_read_b32 v225, a41
    v_accvgpr_read_b32 v226, a42
    v_accvgpr_read_b32 v227, a43
    v_mul_f32 v224, v224, v54
    v_mul_f32 v225, v225, v54
    v_mul_f32 v226, v226, v54
    v_mul_f32 v227, v227, v54
    v_accvgpr_write_b32 a40, v224
    v_accvgpr_write_b32 a41, v225
    v_accvgpr_write_b32 a42, v226
    v_accvgpr_write_b32 a43, v227
    v_accvgpr_read_b32 v224, a44
    v_accvgpr_read_b32 v225, a45
    v_accvgpr_read_b32 v226, a46
    v_accvgpr_read_b32 v227, a47
    v_mul_f32 v224, v224, v55
    v_mul_f32 v225, v225, v55
    v_mul_f32 v226, v226, v55
    v_mul_f32 v227, v227, v55
    v_accvgpr_write_b32 a44, v224
    v_accvgpr_write_b32 a45, v225
    v_accvgpr_write_b32 a46, v226
    v_accvgpr_write_b32 a47, v227
    v_accvgpr_read_b32 v224, a48
    v_accvgpr_read_b32 v225, a49
    v_accvgpr_read_b32 v226, a50
    v_accvgpr_read_b32 v227, a51
    v_mul_f32 v224, v224, v52
    v_mul_f32 v225, v225, v52
    v_mul_f32 v226, v226, v52
    v_mul_f32 v227, v227, v52
    v_accvgpr_write_b32 a48, v224
    v_accvgpr_write_b32 a49, v225
    v_accvgpr_write_b32 a50, v226
    v_accvgpr_write_b32 a51, v227
    v_accvgpr_read_b32 v224, a52
    v_accvgpr_read_b32 v225, a53
    v_accvgpr_read_b32 v226, a54
    v_accvgpr_read_b32 v227, a55
    v_mul_f32 v224, v224, v53
    v_mul_f32 v225, v225, v53
    v_mul_f32 v226, v226, v53
    v_mul_f32 v227, v227, v53
    v_accvgpr_write_b32 a52, v224
    v_accvgpr_write_b32 a53, v225
    v_accvgpr_write_b32 a54, v226
    v_accvgpr_write_b32 a55, v227
    v_accvgpr_read_b32 v224, a56
    v_accvgpr_read_b32 v225, a57
    v_accvgpr_read_b32 v226, a58
    v_accvgpr_read_b32 v227, a59
    v_mul_f32 v224, v224, v54
    v_mul_f32 v225, v225, v54
    v_mul_f32 v226, v226, v54
    v_mul_f32 v227, v227, v54
    v_accvgpr_write_b32 a56, v224
    v_accvgpr_write_b32 a57, v225
    v_accvgpr_write_b32 a58, v226
    v_accvgpr_write_b32 a59, v227
    v_accvgpr_read_b32 v224, a60
    v_accvgpr_read_b32 v225, a61
    v_accvgpr_read_b32 v226, a62
    v_accvgpr_read_b32 v227, a63
    v_mul_f32 v224, v224, v55
    v_mul_f32 v225, v225, v55
    v_mul_f32 v226, v226, v55
    v_mul_f32 v227, v227, v55
    v_accvgpr_write_b32 a60, v224
    v_accvgpr_write_b32 a61, v225
    v_accvgpr_write_b32 a62, v226
    v_accvgpr_write_b32 a63, v227
    v_accvgpr_read_b32 v224, a64
    v_accvgpr_read_b32 v225, a65
    v_accvgpr_read_b32 v226, a66
    v_accvgpr_read_b32 v227, a67
    v_mul_f32 v224, v224, v52
    v_mul_f32 v225, v225, v52
    v_mul_f32 v226, v226, v52
    v_mul_f32 v227, v227, v52
    v_accvgpr_write_b32 a64, v224
    v_accvgpr_write_b32 a65, v225
    v_accvgpr_write_b32 a66, v226
    v_accvgpr_write_b32 a67, v227
    v_accvgpr_read_b32 v224, a68
    v_accvgpr_read_b32 v225, a69
    v_accvgpr_read_b32 v226, a70
    v_accvgpr_read_b32 v227, a71
    v_mul_f32 v224, v224, v53
    v_mul_f32 v225, v225, v53
    v_mul_f32 v226, v226, v53
    v_mul_f32 v227, v227, v53
    v_accvgpr_write_b32 a68, v224
    v_accvgpr_write_b32 a69, v225
    v_accvgpr_write_b32 a70, v226
    v_accvgpr_write_b32 a71, v227
    v_accvgpr_read_b32 v224, a72
    v_accvgpr_read_b32 v225, a73
    v_accvgpr_read_b32 v226, a74
    v_accvgpr_read_b32 v227, a75
    v_mul_f32 v224, v224, v54
    v_mul_f32 v225, v225, v54
    v_mul_f32 v226, v226, v54
    v_mul_f32 v227, v227, v54
    v_accvgpr_write_b32 a72, v224
    v_accvgpr_write_b32 a73, v225
    v_accvgpr_write_b32 a74, v226
    v_accvgpr_write_b32 a75, v227
    v_accvgpr_read_b32 v224, a76
    v_accvgpr_read_b32 v225, a77
    v_accvgpr_read_b32 v226, a78
    v_accvgpr_read_b32 v227, a79
    v_mul_f32 v224, v224, v55
    v_mul_f32 v225, v225, v55
    v_mul_f32 v226, v226, v55
    v_mul_f32 v227, v227, v55
    v_accvgpr_write_b32 a76, v224
    v_accvgpr_write_b32 a77, v225
    v_accvgpr_write_b32 a78, v226
    v_accvgpr_write_b32 a79, v227
    v_accvgpr_read_b32 v224, a80
    v_accvgpr_read_b32 v225, a81
    v_accvgpr_read_b32 v226, a82
    v_accvgpr_read_b32 v227, a83
    v_mul_f32 v224, v224, v52
    v_mul_f32 v225, v225, v52
    v_mul_f32 v226, v226, v52
    v_mul_f32 v227, v227, v52
    v_accvgpr_write_b32 a80, v224
    v_accvgpr_write_b32 a81, v225
    v_accvgpr_write_b32 a82, v226
    v_accvgpr_write_b32 a83, v227
    v_accvgpr_read_b32 v224, a84
    v_accvgpr_read_b32 v225, a85
    v_accvgpr_read_b32 v226, a86
    v_accvgpr_read_b32 v227, a87
    v_mul_f32 v224, v224, v53
    v_mul_f32 v225, v225, v53
    v_mul_f32 v226, v226, v53
    v_mul_f32 v227, v227, v53
    v_accvgpr_write_b32 a84, v224
    v_accvgpr_write_b32 a85, v225
    v_accvgpr_write_b32 a86, v226
    v_accvgpr_write_b32 a87, v227
    v_accvgpr_read_b32 v224, a88
    v_accvgpr_read_b32 v225, a89
    v_accvgpr_read_b32 v226, a90
    v_accvgpr_read_b32 v227, a91
    v_mul_f32 v224, v224, v54
    v_mul_f32 v225, v225, v54
    v_mul_f32 v226, v226, v54
    v_mul_f32 v227, v227, v54
    v_accvgpr_write_b32 a88, v224
    v_accvgpr_write_b32 a89, v225
    v_accvgpr_write_b32 a90, v226
    v_accvgpr_write_b32 a91, v227
    v_accvgpr_read_b32 v224, a92
    v_accvgpr_read_b32 v225, a93
    v_accvgpr_read_b32 v226, a94
    v_accvgpr_read_b32 v227, a95
    v_mul_f32 v224, v224, v55
    v_mul_f32 v225, v225, v55
    v_mul_f32 v226, v226, v55
    v_mul_f32 v227, v227, v55
    v_accvgpr_write_b32 a92, v224
    v_accvgpr_write_b32 a93, v225
    v_accvgpr_write_b32 a94, v226
    v_accvgpr_write_b32 a95, v227
    v_accvgpr_read_b32 v224, a96
    v_accvgpr_read_b32 v225, a97
    v_accvgpr_read_b32 v226, a98
    v_accvgpr_read_b32 v227, a99
    v_mul_f32 v224, v224, v52
    v_mul_f32 v225, v225, v52
    v_mul_f32 v226, v226, v52
    v_mul_f32 v227, v227, v52
    v_accvgpr_write_b32 a96, v224
    v_accvgpr_write_b32 a97, v225
    v_accvgpr_write_b32 a98, v226
    v_accvgpr_write_b32 a99, v227
    v_accvgpr_read_b32 v224, a100
    v_accvgpr_read_b32 v225, a101
    v_accvgpr_read_b32 v226, a102
    v_accvgpr_read_b32 v227, a103
    v_mul_f32 v224, v224, v53
    v_mul_f32 v225, v225, v53
    v_mul_f32 v226, v226, v53
    v_mul_f32 v227, v227, v53
    v_accvgpr_write_b32 a100, v224
    v_accvgpr_write_b32 a101, v225
    v_accvgpr_write_b32 a102, v226
    v_accvgpr_write_b32 a103, v227
    v_accvgpr_read_b32 v224, a104
    v_accvgpr_read_b32 v225, a105
    v_accvgpr_read_b32 v226, a106
    v_accvgpr_read_b32 v227, a107
    v_mul_f32 v224, v224, v54
    v_mul_f32 v225, v225, v54
    v_mul_f32 v226, v226, v54
    v_mul_f32 v227, v227, v54
    v_accvgpr_write_b32 a104, v224
    v_accvgpr_write_b32 a105, v225
    v_accvgpr_write_b32 a106, v226
    v_accvgpr_write_b32 a107, v227
    v_accvgpr_read_b32 v224, a108
    v_accvgpr_read_b32 v225, a109
    v_accvgpr_read_b32 v226, a110
    v_accvgpr_read_b32 v227, a111
    v_mul_f32 v224, v224, v55
    v_mul_f32 v225, v225, v55
    v_mul_f32 v226, v226, v55
    v_mul_f32 v227, v227, v55
    v_accvgpr_write_b32 a108, v224
    v_accvgpr_write_b32 a109, v225
    v_accvgpr_write_b32 a110, v226
    v_accvgpr_write_b32 a111, v227
    v_accvgpr_read_b32 v224, a112
    v_accvgpr_read_b32 v225, a113
    v_accvgpr_read_b32 v226, a114
    v_accvgpr_read_b32 v227, a115
    v_mul_f32 v224, v224, v52
    v_mul_f32 v225, v225, v52
    v_mul_f32 v226, v226, v52
    v_mul_f32 v227, v227, v52
    v_accvgpr_write_b32 a112, v224
    v_accvgpr_write_b32 a113, v225
    v_accvgpr_write_b32 a114, v226
    v_accvgpr_write_b32 a115, v227
    v_accvgpr_read_b32 v224, a116
    v_accvgpr_read_b32 v225, a117
    v_accvgpr_read_b32 v226, a118
    v_accvgpr_read_b32 v227, a119
    v_mul_f32 v224, v224, v53
    v_mul_f32 v225, v225, v53
    v_mul_f32 v226, v226, v53
    v_mul_f32 v227, v227, v53
    v_accvgpr_write_b32 a116, v224
    v_accvgpr_write_b32 a117, v225
    v_accvgpr_write_b32 a118, v226
    v_accvgpr_write_b32 a119, v227
    v_accvgpr_read_b32 v224, a120
    v_accvgpr_read_b32 v225, a121
    v_accvgpr_read_b32 v226, a122
    v_accvgpr_read_b32 v227, a123
    v_mul_f32 v224, v224, v54
    v_mul_f32 v225, v225, v54
    v_mul_f32 v226, v226, v54
    v_mul_f32 v227, v227, v54
    v_accvgpr_write_b32 a120, v224
    v_accvgpr_write_b32 a121, v225
    v_accvgpr_write_b32 a122, v226
    v_accvgpr_write_b32 a123, v227
    v_accvgpr_read_b32 v224, a124
    v_accvgpr_read_b32 v225, a125
    v_accvgpr_read_b32 v226, a126
    v_accvgpr_read_b32 v227, a127
    v_mul_f32 v224, v224, v55
    v_mul_f32 v225, v225, v55
    v_mul_f32 v226, v226, v55
    v_mul_f32 v227, v227, v55
    v_accvgpr_write_b32 a124, v224
    v_accvgpr_write_b32 a125, v225
    v_accvgpr_write_b32 a126, v226
    v_accvgpr_write_b32 a127, v227
    v_exp_f32 v232, v128
    v_exp_f32 v233, v129
    v_exp_f32 v234, v130
    v_exp_f32 v235, v131
    s_nop 0
    v_cvt_pk_bf16_f32 v192, v232, v233
    v_cvt_pk_bf16_f32 v193, v234, v235
    v_exp_f32 v232, v144
    v_exp_f32 v233, v145
    v_exp_f32 v234, v146
    v_exp_f32 v235, v147
    s_nop 0
    v_cvt_pk_bf16_f32 v194, v232, v233
    v_cvt_pk_bf16_f32 v195, v234, v235
    v_exp_f32 v232, v132
    v_exp_f32 v233, v133
    v_exp_f32 v234, v134
    v_exp_f32 v235, v135
    s_nop 0
    v_cvt_pk_bf16_f32 v196, v232, v233
    v_cvt_pk_bf16_f32 v197, v234, v235
    v_exp_f32 v232, v148
    v_exp_f32 v233, v149
    v_exp_f32 v234, v150
    v_exp_f32 v235, v151
    s_nop 0
    v_cvt_pk_bf16_f32 v198, v232, v233
    v_cvt_pk_bf16_f32 v199, v234, v235
    v_exp_f32 v232, v136
    v_exp_f32 v233, v137
    v_exp_f32 v234, v138
    v_exp_f32 v235, v139
    s_nop 0
    v_cvt_pk_bf16_f32 v200, v232, v233
    v_cvt_pk_bf16_f32 v201, v234, v235
    v_exp_f32 v232, v152
    v_exp_f32 v233, v153
    v_exp_f32 v234, v154
    v_exp_f32 v235, v155
    s_nop 0
    v_cvt_pk_bf16_f32 v202, v232, v233
    v_cvt_pk_bf16_f32 v203, v234, v235
    v_exp_f32 v232, v140
    v_exp_f32 v233, v141
    v_exp_f32 v234, v142
    v_exp_f32 v235, v143
    s_nop 0
    v_cvt_pk_bf16_f32 v204, v232, v233
    v_cvt_pk_bf16_f32 v205, v234, v235
    v_exp_f32 v232, v156
    v_exp_f32 v233, v157
    v_exp_f32 v234, v158
    v_exp_f32 v235, v159
    s_nop 0
    v_cvt_pk_bf16_f32 v206, v232, v233
    v_cvt_pk_bf16_f32 v207, v234, v235
    s_nop 3
    s_setpc_b64 s[40:41]
k2_rare_159:
    s_nop 7
    v_max_f32 v52, v160, v161
    v_max3_f32 v52, v52, v162, v163
    v_max3_f32 v52, v52, v176, v177
    v_max3_f32 v52, v52, v178, v179
    v_max_f32 v53, v164, v165
    v_max3_f32 v53, v53, v166, v167
    v_max3_f32 v53, v53, v180, v181
    v_max3_f32 v53, v53, v182, v183
    v_max_f32 v54, v168, v169
    v_max3_f32 v54, v54, v170, v171
    v_max3_f32 v54, v54, v184, v185
    v_max3_f32 v54, v54, v186, v187
    v_max_f32 v55, v172, v173
    v_max3_f32 v55, v55, v174, v175
    v_max3_f32 v55, v55, v188, v189
    v_max3_f32 v55, v55, v190, v191
    v_mov_b32 v224, v52
    v_mov_b32 v225, v53
    v_mov_b32 v226, v54
    v_mov_b32 v227, v55
    s_nop 1
    v_permlane16_swap_b32 v52, v224
    v_permlane16_swap_b32 v53, v225
    v_permlane16_swap_b32 v54, v226
    v_permlane16_swap_b32 v55, v227
    s_nop 1
    v_max_f32 v52, v52, v224
    v_max_f32 v53, v53, v225
    v_max_f32 v54, v54, v226
    v_max_f32 v55, v55, v227
    v_mov_b32 v224, v52
    v_mov_b32 v225, v53
    v_mov_b32 v226, v54
    v_mov_b32 v227, v55
    s_nop 1
    v_permlane32_swap_b32 v52, v224
    v_permlane32_swap_b32 v53, v225
    v_permlane32_swap_b32 v54, v226
    v_permlane32_swap_b32 v55, v227
    s_nop 1
    v_max_f32 v52, v52, v224
    v_max_f32 v53, v53, v225
    v_max_f32 v54, v54, v226
    v_max_f32 v55, v55, v227
    v_add_f32 v52, 0x41400000, v52
    v_max_f32 v52, 0, v52
    v_add_f32 v53, 0x41400000, v53
    v_max_f32 v53, 0, v53
    v_add_f32 v54, 0x41400000, v54
    v_max_f32 v54, 0, v54
    v_add_f32 v55, 0x41400000, v55
    v_max_f32 v55, 0, v55
    v_sub_f32 v160, v160, v52
    v_sub_f32 v161, v161, v52
    v_sub_f32 v162, v162, v52
    v_sub_f32 v163, v163, v52
    v_sub_f32 v164, v164, v53
    v_sub_f32 v165, v165, v53
    v_sub_f32 v166, v166, v53
    v_sub_f32 v167, v167, v53
    v_sub_f32 v168, v168, v54
    v_sub_f32 v169, v169, v54
    v_sub_f32 v170, v170, v54
    v_sub_f32 v171, v171, v54
    v_sub_f32 v172, v172, v55
    v_sub_f32 v173, v173, v55
    v_sub_f32 v174, v174, v55
    v_sub_f32 v175, v175, v55
    v_sub_f32 v176, v176, v52
    v_sub_f32 v177, v177, v52
    v_sub_f32 v178, v178, v52
    v_sub_f32 v179, v179, v52
    v_sub_f32 v180, v180, v53
    v_sub_f32 v181, v181, v53
    v_sub_f32 v182, v182, v53
    v_sub_f32 v183, v183, v53
    v_sub_f32 v184, v184, v54
    v_sub_f32 v185, v185, v54
    v_sub_f32 v186, v186, v54
    v_sub_f32 v187, v187, v54
    v_sub_f32 v188, v188, v55
    v_sub_f32 v189, v189, v55
    v_sub_f32 v190, v190, v55
    v_sub_f32 v191, v191, v55
    v_sub_f32 v128, v128, v52
    v_sub_f32 v16, v16, v52
    v_sub_f32 v129, v129, v52
    v_sub_f32 v17, v17, v52
    v_sub_f32 v130, v130, v52
    v_sub_f32 v18, v18, v52
    v_sub_f32 v131, v131, v52
    v_sub_f32 v19, v19, v52
    v_sub_f32 v132, v132, v53
    v_sub_f32 v20, v20, v53
    v_sub_f32 v133, v133, v53
    v_sub_f32 v21, v21, v53
    v_sub_f32 v134, v134, v53
    v_sub_f32 v22, v22, v53
    v_sub_f32 v135, v135, v53
    v_sub_f32 v23, v23, v53
    v_sub_f32 v136, v136, v54
    v_sub_f32 v24, v24, v54
    v_sub_f32 v137, v137, v54
    v_sub_f32 v25, v25, v54
    v_sub_f32 v138, v138, v54
    v_sub_f32 v26, v26, v54
    v_sub_f32 v139, v139, v54
    v_sub_f32 v27, v27, v54
    v_sub_f32 v140, v140, v55
    v_sub_f32 v28, v28, v55
    v_sub_f32 v141, v141, v55
    v_sub_f32 v29, v29, v55
    v_sub_f32 v142, v142, v55
    v_sub_f32 v30, v30, v55
    v_sub_f32 v143, v143, v55
    v_sub_f32 v31, v31, v55
    v_sub_f32 v144, v144, v52
    v_sub_f32 v32, v32, v52
    v_sub_f32 v145, v145, v52
    v_sub_f32 v33, v33, v52
    v_sub_f32 v146, v146, v52
    v_sub_f32 v34, v34, v52
    v_sub_f32 v147, v147, v52
    v_sub_f32 v35, v35, v52
    v_sub_f32 v148, v148, v53
    v_sub_f32 v36, v36, v53
    v_sub_f32 v149, v149, v53
    v_sub_f32 v37, v37, v53
    v_sub_f32 v150, v150, v53
    v_sub_f32 v38, v38, v53
    v_sub_f32 v151, v151, v53
    v_sub_f32 v39, v39, v53
    v_sub_f32 v152, v152, v54
    v_sub_f32 v40, v40, v54
    v_sub_f32 v153, v153, v54
    v_sub_f32 v41, v41, v54
    v_sub_f32 v154, v154, v54
    v_sub_f32 v42, v42, v54
    v_sub_f32 v155, v155, v54
    v_sub_f32 v43, v43, v54
    v_sub_f32 v156, v156, v55
    v_sub_f32 v44, v44, v55
    v_sub_f32 v157, v157, v55
    v_sub_f32 v45, v45, v55
    v_sub_f32 v158, v158, v55
    v_sub_f32 v46, v46, v55
    v_sub_f32 v159, v159, v55
    v_sub_f32 v47, v47, v55
    v_sub_f32 v8, v8, v52
    v_exp_f32 v52, -v52
    v_sub_f32 v9, v9, v53
    v_exp_f32 v53, -v53
    v_sub_f32 v10, v10, v54
    v_exp_f32 v54, -v54
    v_sub_f32 v11, v11, v55
    v_exp_f32 v55, -v55
    s_nop 0
    v_mul_f32 v12, v12, v52
    v_mul_f32 v48, v48, v53
    v_mul_f32 v248, v248, v54
    v_mul_f32 v252, v252, v55
    v_accvgpr_read_b32 v224, a0
    v_accvgpr_read_b32 v225, a1
    v_accvgpr_read_b32 v226, a2
    v_accvgpr_read_b32 v227, a3
    v_mul_f32 v224, v224, v52
    v_mul_f32 v225, v225, v52
    v_mul_f32 v226, v226, v52
    v_mul_f32 v227, v227, v52
    v_accvgpr_write_b32 a0, v224
    v_accvgpr_write_b32 a1, v225
    v_accvgpr_write_b32 a2, v226
    v_accvgpr_write_b32 a3, v227
    v_accvgpr_read_b32 v224, a4
    v_accvgpr_read_b32 v225, a5
    v_accvgpr_read_b32 v226, a6
    v_accvgpr_read_b32 v227, a7
    v_mul_f32 v224, v224, v53
    v_mul_f32 v225, v225, v53
    v_mul_f32 v226, v226, v53
    v_mul_f32 v227, v227, v53
    v_accvgpr_write_b32 a4, v224
    v_accvgpr_write_b32 a5, v225
    v_accvgpr_write_b32 a6, v226
    v_accvgpr_write_b32 a7, v227
    v_accvgpr_read_b32 v224, a8
    v_accvgpr_read_b32 v225, a9
    v_accvgpr_read_b32 v226, a10
    v_accvgpr_read_b32 v227, a11
    v_mul_f32 v224, v224, v54
    v_mul_f32 v225, v225, v54
    v_mul_f32 v226, v226, v54
    v_mul_f32 v227, v227, v54
    v_accvgpr_write_b32 a8, v224
    v_accvgpr_write_b32 a9, v225
    v_accvgpr_write_b32 a10, v226
    v_accvgpr_write_b32 a11, v227
    v_accvgpr_read_b32 v224, a12
    v_accvgpr_read_b32 v225, a13
    v_accvgpr_read_b32 v226, a14
    v_accvgpr_read_b32 v227, a15
    v_mul_f32 v224, v224, v55
    v_mul_f32 v225, v225, v55
    v_mul_f32 v226, v226, v55
    v_mul_f32 v227, v227, v55
    v_accvgpr_write_b32 a12, v224
    v_accvgpr_write_b32 a13, v225
    v_accvgpr_write_b32 a14, v226
    v_accvgpr_write_b32 a15, v227
    v_accvgpr_read_b32 v224, a16
    v_accvgpr_read_b32 v225, a17
    v_accvgpr_read_b32 v226, a18
    v_accvgpr_read_b32 v227, a19
    v_mul_f32 v224, v224, v52
    v_mul_f32 v225, v225, v52
    v_mul_f32 v226, v226, v52
    v_mul_f32 v227, v227, v52
    v_accvgpr_write_b32 a16, v224
    v_accvgpr_write_b32 a17, v225
    v_accvgpr_write_b32 a18, v226
    v_accvgpr_write_b32 a19, v227
    v_accvgpr_read_b32 v224, a20
    v_accvgpr_read_b32 v225, a21
    v_accvgpr_read_b32 v226, a22
    v_accvgpr_read_b32 v227, a23
    v_mul_f32 v224, v224, v53
    v_mul_f32 v225, v225, v53
    v_mul_f32 v226, v226, v53
    v_mul_f32 v227, v227, v53
    v_accvgpr_write_b32 a20, v224
    v_accvgpr_write_b32 a21, v225
    v_accvgpr_write_b32 a22, v226
    v_accvgpr_write_b32 a23, v227
    v_accvgpr_read_b32 v224, a24
    v_accvgpr_read_b32 v225, a25
    v_accvgpr_read_b32 v226, a26
    v_accvgpr_read_b32 v227, a27
    v_mul_f32 v224, v224, v54
    v_mul_f32 v225, v225, v54
    v_mul_f32 v226, v226, v54
    v_mul_f32 v227, v227, v54
    v_accvgpr_write_b32 a24, v224
    v_accvgpr_write_b32 a25, v225
    v_accvgpr_write_b32 a26, v226
    v_accvgpr_write_b32 a27, v227
    v_accvgpr_read_b32 v224, a28
    v_accvgpr_read_b32 v225, a29
    v_accvgpr_read_b32 v226, a30
    v_accvgpr_read_b32 v227, a31
    v_mul_f32 v224, v224, v55
    v_mul_f32 v225, v225, v55
    v_mul_f32 v226, v226, v55
    v_mul_f32 v227, v227, v55
    v_accvgpr_write_b32 a28, v224
    v_accvgpr_write_b32 a29, v225
    v_accvgpr_write_b32 a30, v226
    v_accvgpr_write_b32 a31, v227
    v_accvgpr_read_b32 v224, a32
    v_accvgpr_read_b32 v225, a33
    v_accvgpr_read_b32 v226, a34
    v_accvgpr_read_b32 v227, a35
    v_mul_f32 v224, v224, v52
    v_mul_f32 v225, v225, v52
    v_mul_f32 v226, v226, v52
    v_mul_f32 v227, v227, v52
    v_accvgpr_write_b32 a32, v224
    v_accvgpr_write_b32 a33, v225
    v_accvgpr_write_b32 a34, v226
    v_accvgpr_write_b32 a35, v227
    v_accvgpr_read_b32 v224, a36
    v_accvgpr_read_b32 v225, a37
    v_accvgpr_read_b32 v226, a38
    v_accvgpr_read_b32 v227, a39
    v_mul_f32 v224, v224, v53
    v_mul_f32 v225, v225, v53
    v_mul_f32 v226, v226, v53
    v_mul_f32 v227, v227, v53
    v_accvgpr_write_b32 a36, v224
    v_accvgpr_write_b32 a37, v225
    v_accvgpr_write_b32 a38, v226
    v_accvgpr_write_b32 a39, v227
    v_accvgpr_read_b32 v224, a40
    v_accvgpr_read_b32 v225, a41
    v_accvgpr_read_b32 v226, a42
    v_accvgpr_read_b32 v227, a43
    v_mul_f32 v224, v224, v54
    v_mul_f32 v225, v225, v54
    v_mul_f32 v226, v226, v54
    v_mul_f32 v227, v227, v54
    v_accvgpr_write_b32 a40, v224
    v_accvgpr_write_b32 a41, v225
    v_accvgpr_write_b32 a42, v226
    v_accvgpr_write_b32 a43, v227
    v_accvgpr_read_b32 v224, a44
    v_accvgpr_read_b32 v225, a45
    v_accvgpr_read_b32 v226, a46
    v_accvgpr_read_b32 v227, a47
    v_mul_f32 v224, v224, v55
    v_mul_f32 v225, v225, v55
    v_mul_f32 v226, v226, v55
    v_mul_f32 v227, v227, v55
    v_accvgpr_write_b32 a44, v224
    v_accvgpr_write_b32 a45, v225
    v_accvgpr_write_b32 a46, v226
    v_accvgpr_write_b32 a47, v227
    v_accvgpr_read_b32 v224, a48
    v_accvgpr_read_b32 v225, a49
    v_accvgpr_read_b32 v226, a50
    v_accvgpr_read_b32 v227, a51
    v_mul_f32 v224, v224, v52
    v_mul_f32 v225, v225, v52
    v_mul_f32 v226, v226, v52
    v_mul_f32 v227, v227, v52
    v_accvgpr_write_b32 a48, v224
    v_accvgpr_write_b32 a49, v225
    v_accvgpr_write_b32 a50, v226
    v_accvgpr_write_b32 a51, v227
    v_accvgpr_read_b32 v224, a52
    v_accvgpr_read_b32 v225, a53
    v_accvgpr_read_b32 v226, a54
    v_accvgpr_read_b32 v227, a55
    v_mul_f32 v224, v224, v53
    v_mul_f32 v225, v225, v53
    v_mul_f32 v226, v226, v53
    v_mul_f32 v227, v227, v53
    v_accvgpr_write_b32 a52, v224
    v_accvgpr_write_b32 a53, v225
    v_accvgpr_write_b32 a54, v226
    v_accvgpr_write_b32 a55, v227
    v_accvgpr_read_b32 v224, a56
    v_accvgpr_read_b32 v225, a57
    v_accvgpr_read_b32 v226, a58
    v_accvgpr_read_b32 v227, a59
    v_mul_f32 v224, v224, v54
    v_mul_f32 v225, v225, v54
    v_mul_f32 v226, v226, v54
    v_mul_f32 v227, v227, v54
    v_accvgpr_write_b32 a56, v224
    v_accvgpr_write_b32 a57, v225
    v_accvgpr_write_b32 a58, v226
    v_accvgpr_write_b32 a59, v227
    v_accvgpr_read_b32 v224, a60
    v_accvgpr_read_b32 v225, a61
    v_accvgpr_read_b32 v226, a62
    v_accvgpr_read_b32 v227, a63
    v_mul_f32 v224, v224, v55
    v_mul_f32 v225, v225, v55
    v_mul_f32 v226, v226, v55
    v_mul_f32 v227, v227, v55
    v_accvgpr_write_b32 a60, v224
    v_accvgpr_write_b32 a61, v225
    v_accvgpr_write_b32 a62, v226
    v_accvgpr_write_b32 a63, v227
    v_accvgpr_read_b32 v224, a64
    v_accvgpr_read_b32 v225, a65
    v_accvgpr_read_b32 v226, a66
    v_accvgpr_read_b32 v227, a67
    v_mul_f32 v224, v224, v52
    v_mul_f32 v225, v225, v52
    v_mul_f32 v226, v226, v52
    v_mul_f32 v227, v227, v52
    v_accvgpr_write_b32 a64, v224
    v_accvgpr_write_b32 a65, v225
    v_accvgpr_write_b32 a66, v226
    v_accvgpr_write_b32 a67, v227
    v_accvgpr_read_b32 v224, a68
    v_accvgpr_read_b32 v225, a69
    v_accvgpr_read_b32 v226, a70
    v_accvgpr_read_b32 v227, a71
    v_mul_f32 v224, v224, v53
    v_mul_f32 v225, v225, v53
    v_mul_f32 v226, v226, v53
    v_mul_f32 v227, v227, v53
    v_accvgpr_write_b32 a68, v224
    v_accvgpr_write_b32 a69, v225
    v_accvgpr_write_b32 a70, v226
    v_accvgpr_write_b32 a71, v227
    v_accvgpr_read_b32 v224, a72
    v_accvgpr_read_b32 v225, a73
    v_accvgpr_read_b32 v226, a74
    v_accvgpr_read_b32 v227, a75
    v_mul_f32 v224, v224, v54
    v_mul_f32 v225, v225, v54
    v_mul_f32 v226, v226, v54
    v_mul_f32 v227, v227, v54
    v_accvgpr_write_b32 a72, v224
    v_accvgpr_write_b32 a73, v225
    v_accvgpr_write_b32 a74, v226
    v_accvgpr_write_b32 a75, v227
    v_accvgpr_read_b32 v224, a76
    v_accvgpr_read_b32 v225, a77
    v_accvgpr_read_b32 v226, a78
    v_accvgpr_read_b32 v227, a79
    v_mul_f32 v224, v224, v55
    v_mul_f32 v225, v225, v55
    v_mul_f32 v226, v226, v55
    v_mul_f32 v227, v227, v55
    v_accvgpr_write_b32 a76, v224
    v_accvgpr_write_b32 a77, v225
    v_accvgpr_write_b32 a78, v226
    v_accvgpr_write_b32 a79, v227
    v_accvgpr_read_b32 v224, a80
    v_accvgpr_read_b32 v225, a81
    v_accvgpr_read_b32 v226, a82
    v_accvgpr_read_b32 v227, a83
    v_mul_f32 v224, v224, v52
    v_mul_f32 v225, v225, v52
    v_mul_f32 v226, v226, v52
    v_mul_f32 v227, v227, v52
    v_accvgpr_write_b32 a80, v224
    v_accvgpr_write_b32 a81, v225
    v_accvgpr_write_b32 a82, v226
    v_accvgpr_write_b32 a83, v227
    v_accvgpr_read_b32 v224, a84
    v_accvgpr_read_b32 v225, a85
    v_accvgpr_read_b32 v226, a86
    v_accvgpr_read_b32 v227, a87
    v_mul_f32 v224, v224, v53
    v_mul_f32 v225, v225, v53
    v_mul_f32 v226, v226, v53
    v_mul_f32 v227, v227, v53
    v_accvgpr_write_b32 a84, v224
    v_accvgpr_write_b32 a85, v225
    v_accvgpr_write_b32 a86, v226
    v_accvgpr_write_b32 a87, v227
    v_accvgpr_read_b32 v224, a88
    v_accvgpr_read_b32 v225, a89
    v_accvgpr_read_b32 v226, a90
    v_accvgpr_read_b32 v227, a91
    v_mul_f32 v224, v224, v54
    v_mul_f32 v225, v225, v54
    v_mul_f32 v226, v226, v54
    v_mul_f32 v227, v227, v54
    v_accvgpr_write_b32 a88, v224
    v_accvgpr_write_b32 a89, v225
    v_accvgpr_write_b32 a90, v226
    v_accvgpr_write_b32 a91, v227
    v_accvgpr_read_b32 v224, a92
    v_accvgpr_read_b32 v225, a93
    v_accvgpr_read_b32 v226, a94
    v_accvgpr_read_b32 v227, a95
    v_mul_f32 v224, v224, v55
    v_mul_f32 v225, v225, v55
    v_mul_f32 v226, v226, v55
    v_mul_f32 v227, v227, v55
    v_accvgpr_write_b32 a92, v224
    v_accvgpr_write_b32 a93, v225
    v_accvgpr_write_b32 a94, v226
    v_accvgpr_write_b32 a95, v227
    v_accvgpr_read_b32 v224, a96
    v_accvgpr_read_b32 v225, a97
    v_accvgpr_read_b32 v226, a98
    v_accvgpr_read_b32 v227, a99
    v_mul_f32 v224, v224, v52
    v_mul_f32 v225, v225, v52
    v_mul_f32 v226, v226, v52
    v_mul_f32 v227, v227, v52
    v_accvgpr_write_b32 a96, v224
    v_accvgpr_write_b32 a97, v225
    v_accvgpr_write_b32 a98, v226
    v_accvgpr_write_b32 a99, v227
    v_accvgpr_read_b32 v224, a100
    v_accvgpr_read_b32 v225, a101
    v_accvgpr_read_b32 v226, a102
    v_accvgpr_read_b32 v227, a103
    v_mul_f32 v224, v224, v53
    v_mul_f32 v225, v225, v53
    v_mul_f32 v226, v226, v53
    v_mul_f32 v227, v227, v53
    v_accvgpr_write_b32 a100, v224
    v_accvgpr_write_b32 a101, v225
    v_accvgpr_write_b32 a102, v226
    v_accvgpr_write_b32 a103, v227
    v_accvgpr_read_b32 v224, a104
    v_accvgpr_read_b32 v225, a105
    v_accvgpr_read_b32 v226, a106
    v_accvgpr_read_b32 v227, a107
    v_mul_f32 v224, v224, v54
    v_mul_f32 v225, v225, v54
    v_mul_f32 v226, v226, v54
    v_mul_f32 v227, v227, v54
    v_accvgpr_write_b32 a104, v224
    v_accvgpr_write_b32 a105, v225
    v_accvgpr_write_b32 a106, v226
    v_accvgpr_write_b32 a107, v227
    v_accvgpr_read_b32 v224, a108
    v_accvgpr_read_b32 v225, a109
    v_accvgpr_read_b32 v226, a110
    v_accvgpr_read_b32 v227, a111
    v_mul_f32 v224, v224, v55
    v_mul_f32 v225, v225, v55
    v_mul_f32 v226, v226, v55
    v_mul_f32 v227, v227, v55
    v_accvgpr_write_b32 a108, v224
    v_accvgpr_write_b32 a109, v225
    v_accvgpr_write_b32 a110, v226
    v_accvgpr_write_b32 a111, v227
    v_accvgpr_read_b32 v224, a112
    v_accvgpr_read_b32 v225, a113
    v_accvgpr_read_b32 v226, a114
    v_accvgpr_read_b32 v227, a115
    v_mul_f32 v224, v224, v52
    v_mul_f32 v225, v225, v52
    v_mul_f32 v226, v226, v52
    v_mul_f32 v227, v227, v52
    v_accvgpr_write_b32 a112, v224
    v_accvgpr_write_b32 a113, v225
    v_accvgpr_write_b32 a114, v226
    v_accvgpr_write_b32 a115, v227
    v_accvgpr_read_b32 v224, a116
    v_accvgpr_read_b32 v225, a117
    v_accvgpr_read_b32 v226, a118
    v_accvgpr_read_b32 v227, a119
    v_mul_f32 v224, v224, v53
    v_mul_f32 v225, v225, v53
    v_mul_f32 v226, v226, v53
    v_mul_f32 v227, v227, v53
    v_accvgpr_write_b32 a116, v224
    v_accvgpr_write_b32 a117, v225
    v_accvgpr_write_b32 a118, v226
    v_accvgpr_write_b32 a119, v227
    v_accvgpr_read_b32 v224, a120
    v_accvgpr_read_b32 v225, a121
    v_accvgpr_read_b32 v226, a122
    v_accvgpr_read_b32 v227, a123
    v_mul_f32 v224, v224, v54
    v_mul_f32 v225, v225, v54
    v_mul_f32 v226, v226, v54
    v_mul_f32 v227, v227, v54
    v_accvgpr_write_b32 a120, v224
    v_accvgpr_write_b32 a121, v225
    v_accvgpr_write_b32 a122, v226
    v_accvgpr_write_b32 a123, v227
    v_accvgpr_read_b32 v224, a124
    v_accvgpr_read_b32 v225, a125
    v_accvgpr_read_b32 v226, a126
    v_accvgpr_read_b32 v227, a127
    v_mul_f32 v224, v224, v55
    v_mul_f32 v225, v225, v55
    v_mul_f32 v226, v226, v55
    v_mul_f32 v227, v227, v55
    v_accvgpr_write_b32 a124, v224
    v_accvgpr_write_b32 a125, v225
    v_accvgpr_write_b32 a126, v226
    v_accvgpr_write_b32 a127, v227
    v_exp_f32 v232, v160
    v_exp_f32 v233, v161
    v_exp_f32 v234, v162
    v_exp_f32 v235, v163
    s_nop 0
    v_cvt_pk_bf16_f32 v208, v232, v233
    v_cvt_pk_bf16_f32 v209, v234, v235
    v_exp_f32 v232, v176
    v_exp_f32 v233, v177
    v_exp_f32 v234, v178
    v_exp_f32 v235, v179
    s_nop 0
    v_cvt_pk_bf16_f32 v210, v232, v233
    v_cvt_pk_bf16_f32 v211, v234, v235
    v_exp_f32 v232, v164
    v_exp_f32 v233, v165
    v_exp_f32 v234, v166
    v_exp_f32 v235, v167
    s_nop 0
    v_cvt_pk_bf16_f32 v212, v232, v233
    v_cvt_pk_bf16_f32 v213, v234, v235
    v_exp_f32 v232, v180
    v_exp_f32 v233, v181
    v_exp_f32 v234, v182
    v_exp_f32 v235, v183
    s_nop 0
    v_cvt_pk_bf16_f32 v214, v232, v233
    v_cvt_pk_bf16_f32 v215, v234, v235
    v_exp_f32 v232, v168
    v_exp_f32 v233, v169
    v_exp_f32 v234, v170
    v_exp_f32 v235, v171
    s_nop 0
    v_cvt_pk_bf16_f32 v216, v232, v233
    v_cvt_pk_bf16_f32 v217, v234, v235
    v_exp_f32 v232, v184
    v_exp_f32 v233, v185
    v_exp_f32 v234, v186
    v_exp_f32 v235, v187
    s_nop 0
    v_cvt_pk_bf16_f32 v218, v232, v233
    v_cvt_pk_bf16_f32 v219, v234, v235
    v_exp_f32 v232, v172
    v_exp_f32 v233, v173
    v_exp_f32 v234, v174
    v_exp_f32 v235, v175
    s_nop 0
    v_cvt_pk_bf16_f32 v220, v232, v233
    v_cvt_pk_bf16_f32 v221, v234, v235
    v_exp_f32 v232, v188
    v_exp_f32 v233, v189
    v_exp_f32 v234, v190
    v_exp_f32 v235, v191
    s_nop 0
    v_cvt_pk_bf16_f32 v222, v232, v233
    v_cvt_pk_bf16_f32 v223, v234, v235
    s_nop 3
    s_setpc_b64 s[40:41]
k2_rare_164:
    s_nop 7
    v_max_f32 v53, v132, v133
    v_max3_f32 v53, v53, v134, v135
    v_max3_f32 v53, v53, v148, v149
    v_max3_f32 v53, v53, v150, v151
    v_max_f32 v54, v136, v137
    v_max3_f32 v54, v54, v138, v139
    v_max3_f32 v54, v54, v152, v153
    v_max3_f32 v54, v54, v154, v155
    v_max_f32 v55, v140, v141
    v_max3_f32 v55, v55, v142, v143
    v_max3_f32 v55, v55, v156, v157
    v_max3_f32 v55, v55, v158, v159
    v_mov_b32 v225, v53
    v_mov_b32 v226, v54
    v_mov_b32 v227, v55
    s_nop 1
    v_permlane16_swap_b32 v53, v225
    v_permlane16_swap_b32 v54, v226
    v_permlane16_swap_b32 v55, v227
    s_nop 1
    v_max_f32 v53, v53, v225
    v_max_f32 v54, v54, v226
    v_max_f32 v55, v55, v227
    v_mov_b32 v225, v53
    v_mov_b32 v226, v54
    v_mov_b32 v227, v55
    s_nop 1
    v_permlane32_swap_b32 v53, v225
    v_permlane32_swap_b32 v54, v226
    v_permlane32_swap_b32 v55, v227
    s_nop 1
    v_max_f32 v53, v53, v225
    v_max_f32 v54, v54, v226
    v_max_f32 v55, v55, v227
    v_add_f32 v53, 0x41400000, v53
    v_max_f32 v53, 0, v53
    v_add_f32 v54, 0x41400000, v54
    v_max_f32 v54, 0, v54
    v_add_f32 v55, 0x41400000, v55
    v_max_f32 v55, 0, v55
    v_sub_f32 v132, v132, v53
    v_sub_f32 v133, v133, v53
    v_sub_f32 v134, v134, v53
    v_sub_f32 v135, v135, v53
    v_sub_f32 v136, v136, v54
    v_sub_f32 v137, v137, v54
    v_sub_f32 v138, v138, v54
    v_sub_f32 v139, v139, v54
    v_sub_f32 v140, v140, v55
    v_sub_f32 v141, v141, v55
    v_sub_f32 v142, v142, v55
    v_sub_f32 v143, v143, v55
    v_sub_f32 v148, v148, v53
    v_sub_f32 v149, v149, v53
    v_sub_f32 v150, v150, v53
    v_sub_f32 v151, v151, v53
    v_sub_f32 v152, v152, v54
    v_sub_f32 v153, v153, v54
    v_sub_f32 v154, v154, v54
    v_sub_f32 v155, v155, v54
    v_sub_f32 v156, v156, v55
    v_sub_f32 v157, v157, v55
    v_sub_f32 v158, v158, v55
    v_sub_f32 v159, v159, v55
    v_sub_f32 v164, v164, v53
    v_sub_f32 v20, v20, v53
    v_sub_f32 v165, v165, v53
    v_sub_f32 v21, v21, v53
    v_sub_f32 v166, v166, v53
    v_sub_f32 v22, v22, v53
    v_sub_f32 v167, v167, v53
    v_sub_f32 v23, v23, v53
    v_sub_f32 v168, v168, v54
    v_sub_f32 v24, v24, v54
    v_sub_f32 v169, v169, v54
    v_sub_f32 v25, v25, v54
    v_sub_f32 v170, v170, v54
    v_sub_f32 v26, v26, v54
    v_sub_f32 v171, v171, v54
    v_sub_f32 v27, v27, v54
    v_sub_f32 v172, v172, v55
    v_sub_f32 v28, v28, v55
    v_sub_f32 v173, v173, v55
    v_sub_f32 v29, v29, v55
    v_sub_f32 v174, v174, v55
    v_sub_f32 v30, v30, v55
    v_sub_f32 v175, v175, v55
    v_sub_f32 v31, v31, v55
    v_sub_f32 v180, v180, v53
    v_sub_f32 v36, v36, v53
    v_sub_f32 v181, v181, v53
    v_sub_f32 v37, v37, v53
    v_sub_f32 v182, v182, v53
    v_sub_f32 v38, v38, v53
    v_sub_f32 v183, v183, v53
    v_sub_f32 v39, v39, v53
    v_sub_f32 v184, v184, v54
    v_sub_f32 v40, v40, v54
    v_sub_f32 v185, v185, v54
    v_sub_f32 v41, v41, v54
    v_sub_f32 v186, v186, v54
    v_sub_f32 v42, v42, v54
    v_sub_f32 v187, v187, v54
    v_sub_f32 v43, v43, v54
    v_sub_f32 v188, v188, v55
    v_sub_f32 v44, v44, v55
    v_sub_f32 v189, v189, v55
    v_sub_f32 v45, v45, v55
    v_sub_f32 v190, v190, v55
    v_sub_f32 v46, v46, v55
    v_sub_f32 v191, v191, v55
    v_sub_f32 v47, v47, v55
    v_sub_f32 v9, v9, v53
    v_exp_f32 v53, -v53
    v_sub_f32 v10, v10, v54
    v_exp_f32 v54, -v54
    v_sub_f32 v11, v11, v55
    v_exp_f32 v55, -v55
    s_nop 0
    v_mul_f32 v48, v48, v53
    v_mul_f32 v248, v248, v54
    v_mul_f32 v252, v252, v55
    v_accvgpr_read_b32 v224, a4
    v_accvgpr_read_b32 v225, a5
    v_accvgpr_read_b32 v226, a6
    v_accvgpr_read_b32 v227, a7
    v_mul_f32 v224, v224, v53
    v_mul_f32 v225, v225, v53
    v_mul_f32 v226, v226, v53
    v_mul_f32 v227, v227, v53
    v_accvgpr_write_b32 a4, v224
    v_accvgpr_write_b32 a5, v225
    v_accvgpr_write_b32 a6, v226
    v_accvgpr_write_b32 a7, v227
    v_accvgpr_read_b32 v224, a8
    v_accvgpr_read_b32 v225, a9
    v_accvgpr_read_b32 v226, a10
    v_accvgpr_read_b32 v227, a11
    v_mul_f32 v224, v224, v54
    v_mul_f32 v225, v225, v54
    v_mul_f32 v226, v226, v54
    v_mul_f32 v227, v227, v54
    v_accvgpr_write_b32 a8, v224
    v_accvgpr_write_b32 a9, v225
    v_accvgpr_write_b32 a10, v226
    v_accvgpr_write_b32 a11, v227
    v_accvgpr_read_b32 v224, a12
    v_accvgpr_read_b32 v225, a13
    v_accvgpr_read_b32 v226, a14
    v_accvgpr_read_b32 v227, a15
    v_mul_f32 v224, v224, v55
    v_mul_f32 v225, v225, v55
    v_mul_f32 v226, v226, v55
    v_mul_f32 v227, v227, v55
    v_accvgpr_write_b32 a12, v224
    v_accvgpr_write_b32 a13, v225
    v_accvgpr_write_b32 a14, v226
    v_accvgpr_write_b32 a15, v227
    v_accvgpr_read_b32 v224, a20
    v_accvgpr_read_b32 v225, a21
    v_accvgpr_read_b32 v226, a22
    v_accvgpr_read_b32 v227, a23
    v_mul_f32 v224, v224, v53
    v_mul_f32 v225, v225, v53
    v_mul_f32 v226, v226, v53
    v_mul_f32 v227, v227, v53
    v_accvgpr_write_b32 a20, v224
    v_accvgpr_write_b32 a21, v225
    v_accvgpr_write_b32 a22, v226
    v_accvgpr_write_b32 a23, v227
    v_accvgpr_read_b32 v224, a24
    v_accvgpr_read_b32 v225, a25
    v_accvgpr_read_b32 v226, a26
    v_accvgpr_read_b32 v227, a27
    v_mul_f32 v224, v224, v54
    v_mul_f32 v225, v225, v54
    v_mul_f32 v226, v226, v54
    v_mul_f32 v227, v227, v54
    v_accvgpr_write_b32 a24, v224
    v_accvgpr_write_b32 a25, v225
    v_accvgpr_write_b32 a26, v226
    v_accvgpr_write_b32 a27, v227
    v_accvgpr_read_b32 v224, a28
    v_accvgpr_read_b32 v225, a29
    v_accvgpr_read_b32 v226, a30
    v_accvgpr_read_b32 v227, a31
    v_mul_f32 v224, v224, v55
    v_mul_f32 v225, v225, v55
    v_mul_f32 v226, v226, v55
    v_mul_f32 v227, v227, v55
    v_accvgpr_write_b32 a28, v224
    v_accvgpr_write_b32 a29, v225
    v_accvgpr_write_b32 a30, v226
    v_accvgpr_write_b32 a31, v227
    v_accvgpr_read_b32 v224, a36
    v_accvgpr_read_b32 v225, a37
    v_accvgpr_read_b32 v226, a38
    v_accvgpr_read_b32 v227, a39
    v_mul_f32 v224, v224, v53
    v_mul_f32 v225, v225, v53
    v_mul_f32 v226, v226, v53
    v_mul_f32 v227, v227, v53
    v_accvgpr_write_b32 a36, v224
    v_accvgpr_write_b32 a37, v225
    v_accvgpr_write_b32 a38, v226
    v_accvgpr_write_b32 a39, v227
    v_accvgpr_read_b32 v224, a40
    v_accvgpr_read_b32 v225, a41
    v_accvgpr_read_b32 v226, a42
    v_accvgpr_read_b32 v227, a43
    v_mul_f32 v224, v224, v54
    v_mul_f32 v225, v225, v54
    v_mul_f32 v226, v226, v54
    v_mul_f32 v227, v227, v54
    v_accvgpr_write_b32 a40, v224
    v_accvgpr_write_b32 a41, v225
    v_accvgpr_write_b32 a42, v226
    v_accvgpr_write_b32 a43, v227
    v_accvgpr_read_b32 v224, a44
    v_accvgpr_read_b32 v225, a45
    v_accvgpr_read_b32 v226, a46
    v_accvgpr_read_b32 v227, a47
    v_mul_f32 v224, v224, v55
    v_mul_f32 v225, v225, v55
    v_mul_f32 v226, v226, v55
    v_mul_f32 v227, v227, v55
    v_accvgpr_write_b32 a44, v224
    v_accvgpr_write_b32 a45, v225
    v_accvgpr_write_b32 a46, v226
    v_accvgpr_write_b32 a47, v227
    v_accvgpr_read_b32 v224, a52
    v_accvgpr_read_b32 v225, a53
    v_accvgpr_read_b32 v226, a54
    v_accvgpr_read_b32 v227, a55
    v_mul_f32 v224, v224, v53
    v_mul_f32 v225, v225, v53
    v_mul_f32 v226, v226, v53
    v_mul_f32 v227, v227, v53
    v_accvgpr_write_b32 a52, v224
    v_accvgpr_write_b32 a53, v225
    v_accvgpr_write_b32 a54, v226
    v_accvgpr_write_b32 a55, v227
    v_accvgpr_read_b32 v224, a56
    v_accvgpr_read_b32 v225, a57
    v_accvgpr_read_b32 v226, a58
    v_accvgpr_read_b32 v227, a59
    v_mul_f32 v224, v224, v54
    v_mul_f32 v225, v225, v54
    v_mul_f32 v226, v226, v54
    v_mul_f32 v227, v227, v54
    v_accvgpr_write_b32 a56, v224
    v_accvgpr_write_b32 a57, v225
    v_accvgpr_write_b32 a58, v226
    v_accvgpr_write_b32 a59, v227
    v_accvgpr_read_b32 v224, a60
    v_accvgpr_read_b32 v225, a61
    v_accvgpr_read_b32 v226, a62
    v_accvgpr_read_b32 v227, a63
    v_mul_f32 v224, v224, v55
    v_mul_f32 v225, v225, v55
    v_mul_f32 v226, v226, v55
    v_mul_f32 v227, v227, v55
    v_accvgpr_write_b32 a60, v224
    v_accvgpr_write_b32 a61, v225
    v_accvgpr_write_b32 a62, v226
    v_accvgpr_write_b32 a63, v227
    v_accvgpr_read_b32 v224, a68
    v_accvgpr_read_b32 v225, a69
    v_accvgpr_read_b32 v226, a70
    v_accvgpr_read_b32 v227, a71
    v_mul_f32 v224, v224, v53
    v_mul_f32 v225, v225, v53
    v_mul_f32 v226, v226, v53
    v_mul_f32 v227, v227, v53
    v_accvgpr_write_b32 a68, v224
    v_accvgpr_write_b32 a69, v225
    v_accvgpr_write_b32 a70, v226
    v_accvgpr_write_b32 a71, v227
    v_accvgpr_read_b32 v224, a72
    v_accvgpr_read_b32 v225, a73
    v_accvgpr_read_b32 v226, a74
    v_accvgpr_read_b32 v227, a75
    v_mul_f32 v224, v224, v54
    v_mul_f32 v225, v225, v54
    v_mul_f32 v226, v226, v54
    v_mul_f32 v227, v227, v54
    v_accvgpr_write_b32 a72, v224
    v_accvgpr_write_b32 a73, v225
    v_accvgpr_write_b32 a74, v226
    v_accvgpr_write_b32 a75, v227
    v_accvgpr_read_b32 v224, a76
    v_accvgpr_read_b32 v225, a77
    v_accvgpr_read_b32 v226, a78
    v_accvgpr_read_b32 v227, a79
    v_mul_f32 v224, v224, v55
    v_mul_f32 v225, v225, v55
    v_mul_f32 v226, v226, v55
    v_mul_f32 v227, v227, v55
    v_accvgpr_write_b32 a76, v224
    v_accvgpr_write_b32 a77, v225
    v_accvgpr_write_b32 a78, v226
    v_accvgpr_write_b32 a79, v227
    v_accvgpr_read_b32 v224, a84
    v_accvgpr_read_b32 v225, a85
    v_accvgpr_read_b32 v226, a86
    v_accvgpr_read_b32 v227, a87
    v_mul_f32 v224, v224, v53
    v_mul_f32 v225, v225, v53
    v_mul_f32 v226, v226, v53
    v_mul_f32 v227, v227, v53
    v_accvgpr_write_b32 a84, v224
    v_accvgpr_write_b32 a85, v225
    v_accvgpr_write_b32 a86, v226
    v_accvgpr_write_b32 a87, v227
    v_accvgpr_read_b32 v224, a88
    v_accvgpr_read_b32 v225, a89
    v_accvgpr_read_b32 v226, a90
    v_accvgpr_read_b32 v227, a91
    v_mul_f32 v224, v224, v54
    v_mul_f32 v225, v225, v54
    v_mul_f32 v226, v226, v54
    v_mul_f32 v227, v227, v54
    v_accvgpr_write_b32 a88, v224
    v_accvgpr_write_b32 a89, v225
    v_accvgpr_write_b32 a90, v226
    v_accvgpr_write_b32 a91, v227
    v_accvgpr_read_b32 v224, a92
    v_accvgpr_read_b32 v225, a93
    v_accvgpr_read_b32 v226, a94
    v_accvgpr_read_b32 v227, a95
    v_mul_f32 v224, v224, v55
    v_mul_f32 v225, v225, v55
    v_mul_f32 v226, v226, v55
    v_mul_f32 v227, v227, v55
    v_accvgpr_write_b32 a92, v224
    v_accvgpr_write_b32 a93, v225
    v_accvgpr_write_b32 a94, v226
    v_accvgpr_write_b32 a95, v227
    v_accvgpr_read_b32 v224, a100
    v_accvgpr_read_b32 v225, a101
    v_accvgpr_read_b32 v226, a102
    v_accvgpr_read_b32 v227, a103
    v_mul_f32 v224, v224, v53
    v_mul_f32 v225, v225, v53
    v_mul_f32 v226, v226, v53
    v_mul_f32 v227, v227, v53
    v_accvgpr_write_b32 a100, v224
    v_accvgpr_write_b32 a101, v225
    v_accvgpr_write_b32 a102, v226
    v_accvgpr_write_b32 a103, v227
    v_accvgpr_read_b32 v224, a104
    v_accvgpr_read_b32 v225, a105
    v_accvgpr_read_b32 v226, a106
    v_accvgpr_read_b32 v227, a107
    v_mul_f32 v224, v224, v54
    v_mul_f32 v225, v225, v54
    v_mul_f32 v226, v226, v54
    v_mul_f32 v227, v227, v54
    v_accvgpr_write_b32 a104, v224
    v_accvgpr_write_b32 a105, v225
    v_accvgpr_write_b32 a106, v226
    v_accvgpr_write_b32 a107, v227
    v_accvgpr_read_b32 v224, a108
    v_accvgpr_read_b32 v225, a109
    v_accvgpr_read_b32 v226, a110
    v_accvgpr_read_b32 v227, a111
    v_mul_f32 v224, v224, v55
    v_mul_f32 v225, v225, v55
    v_mul_f32 v226, v226, v55
    v_mul_f32 v227, v227, v55
    v_accvgpr_write_b32 a108, v224
    v_accvgpr_write_b32 a109, v225
    v_accvgpr_write_b32 a110, v226
    v_accvgpr_write_b32 a111, v227
    v_accvgpr_read_b32 v224, a116
    v_accvgpr_read_b32 v225, a117
    v_accvgpr_read_b32 v226, a118
    v_accvgpr_read_b32 v227, a119
    v_mul_f32 v224, v224, v53
    v_mul_f32 v225, v225, v53
    v_mul_f32 v226, v226, v53
    v_mul_f32 v227, v227, v53
    v_accvgpr_write_b32 a116, v224
    v_accvgpr_write_b32 a117, v225
    v_accvgpr_write_b32 a118, v226
    v_accvgpr_write_b32 a119, v227
    v_accvgpr_read_b32 v224, a120
    v_accvgpr_read_b32 v225, a121
    v_accvgpr_read_b32 v226, a122
    v_accvgpr_read_b32 v227, a123
    v_mul_f32 v224, v224, v54
    v_mul_f32 v225, v225, v54
    v_mul_f32 v226, v226, v54
    v_mul_f32 v227, v227, v54
    v_accvgpr_write_b32 a120, v224
    v_accvgpr_write_b32 a121, v225
    v_accvgpr_write_b32 a122, v226
    v_accvgpr_write_b32 a123, v227
    v_accvgpr_read_b32 v224, a124
    v_accvgpr_read_b32 v225, a125
    v_accvgpr_read_b32 v226, a126
    v_accvgpr_read_b32 v227, a127
    v_mul_f32 v224, v224, v55
    v_mul_f32 v225, v225, v55
    v_mul_f32 v226, v226, v55
    v_mul_f32 v227, v227, v55
    v_accvgpr_write_b32 a124, v224
    v_accvgpr_write_b32 a125, v225
    v_accvgpr_write_b32 a126, v226
    v_accvgpr_write_b32 a127, v227
    v_exp_f32 v232, v132
    v_exp_f32 v233, v133
    v_exp_f32 v234, v134
    v_exp_f32 v235, v135
    s_nop 0
    v_cvt_pk_bf16_f32 v196, v232, v233
    v_cvt_pk_bf16_f32 v197, v234, v235
    v_exp_f32 v232, v148
    v_exp_f32 v233, v149
    v_exp_f32 v234, v150
    v_exp_f32 v235, v151
    s_nop 0
    v_cvt_pk_bf16_f32 v198, v232, v233
    v_cvt_pk_bf16_f32 v199, v234, v235
    v_exp_f32 v232, v136
    v_exp_f32 v233, v137
    v_exp_f32 v234, v138
    v_exp_f32 v235, v139
    s_nop 0
    v_cvt_pk_bf16_f32 v200, v232, v233
    v_cvt_pk_bf16_f32 v201, v234, v235
    v_exp_f32 v232, v152
    v_exp_f32 v233, v153
    v_exp_f32 v234, v154
    v_exp_f32 v235, v155
    s_nop 0
    v_cvt_pk_bf16_f32 v202, v232, v233
    v_cvt_pk_bf16_f32 v203, v234, v235
    v_exp_f32 v232, v140
    v_exp_f32 v233, v141
    v_exp_f32 v234, v142
    v_exp_f32 v235, v143
    s_nop 0
    v_cvt_pk_bf16_f32 v204, v232, v233
    v_cvt_pk_bf16_f32 v205, v234, v235
    v_exp_f32 v232, v156
    v_exp_f32 v233, v157
    v_exp_f32 v234, v158
    v_exp_f32 v235, v159
    s_nop 0
    v_cvt_pk_bf16_f32 v206, v232, v233
    v_cvt_pk_bf16_f32 v207, v234, v235
    s_nop 3
    s_setpc_b64 s[40:41]
k2_rare_165:
    s_nop 7
    v_max_f32 v53, v164, v165
    v_max3_f32 v53, v53, v166, v167
    v_max3_f32 v53, v53, v180, v181
    v_max3_f32 v53, v53, v182, v183
    v_max_f32 v54, v168, v169
    v_max3_f32 v54, v54, v170, v171
    v_max3_f32 v54, v54, v184, v185
    v_max3_f32 v54, v54, v186, v187
    v_max_f32 v55, v172, v173
    v_max3_f32 v55, v55, v174, v175
    v_max3_f32 v55, v55, v188, v189
    v_max3_f32 v55, v55, v190, v191
    v_mov_b32 v225, v53
    v_mov_b32 v226, v54
    v_mov_b32 v227, v55
    s_nop 1
    v_permlane16_swap_b32 v53, v225
    v_permlane16_swap_b32 v54, v226
    v_permlane16_swap_b32 v55, v227
    s_nop 1
    v_max_f32 v53, v53, v225
    v_max_f32 v54, v54, v226
    v_max_f32 v55, v55, v227
    v_mov_b32 v225, v53
    v_mov_b32 v226, v54
    v_mov_b32 v227, v55
    s_nop 1
    v_permlane32_swap_b32 v53, v225
    v_permlane32_swap_b32 v54, v226
    v_permlane32_swap_b32 v55, v227
    s_nop 1
    v_max_f32 v53, v53, v225
    v_max_f32 v54, v54, v226
    v_max_f32 v55, v55, v227
    v_add_f32 v53, 0x41400000, v53
    v_max_f32 v53, 0, v53
    v_add_f32 v54, 0x41400000, v54
    v_max_f32 v54, 0, v54
    v_add_f32 v55, 0x41400000, v55
    v_max_f32 v55, 0, v55
    v_sub_f32 v164, v164, v53
    v_sub_f32 v165, v165, v53
    v_sub_f32 v166, v166, v53
    v_sub_f32 v167, v167, v53
    v_sub_f32 v168, v168, v54
    v_sub_f32 v169, v169, v54
    v_sub_f32 v170, v170, v54
    v_sub_f32 v171, v171, v54
    v_sub_f32 v172, v172, v55
    v_sub_f32 v173, v173, v55
    v_sub_f32 v174, v174, v55
    v_sub_f32 v175, v175, v55
    v_sub_f32 v180, v180, v53
    v_sub_f32 v181, v181, v53
    v_sub_f32 v182, v182, v53
    v_sub_f32 v183, v183, v53
    v_sub_f32 v184, v184, v54
    v_sub_f32 v185, v185, v54
    v_sub_f32 v186, v186, v54
    v_sub_f32 v187, v187, v54
    v_sub_f32 v188, v188, v55
    v_sub_f32 v189, v189, v55
    v_sub_f32 v190, v190, v55
    v_sub_f32 v191, v191, v55
    v_sub_f32 v128, v128, v54
    v_sub_f32 v16, v16, v54
    v_sub_f32 v129, v129, v54
    v_sub_f32 v17, v17, v54
    v_sub_f32 v130, v130, v54
    v_sub_f32 v18, v18, v54
    v_sub_f32 v131, v131, v54
    v_sub_f32 v19, v19, v54
    v_sub_f32 v132, v132, v55
    v_sub_f32 v20, v20, v55
    v_sub_f32 v133, v133, v55
    v_sub_f32 v21, v21, v55
    v_sub_f32 v134, v134, v55
    v_sub_f32 v22, v22, v55
    v_sub_f32 v135, v135, v55
    v_sub_f32 v23, v23, v55
    v_sub_f32 v136, v136, v54
    v_sub_f32 v24, v24, v54
    v_sub_f32 v137, v137, v54
    v_sub_f32 v25, v25, v54
    v_sub_f32 v138, v138, v54
    v_sub_f32 v26, v26, v54
    v_sub_f32 v139, v139, v54
    v_sub_f32 v27, v27, v54
    v_sub_f32 v140, v140, v55
    v_sub_f32 v28, v28, v55
    v_sub_f32 v141, v141, v55
    v_sub_f32 v29, v29, v55
    v_sub_f32 v142, v142, v55
    v_sub_f32 v30, v30, v55
    v_sub_f32 v143, v143, v55
    v_sub_f32 v31, v31, v55
    v_sub_f32 v144, v144, v54
    v_sub_f32 v32, v32, v54
    v_sub_f32 v145, v145, v54
    v_sub_f32 v33, v33, v54
    v_sub_f32 v146, v146, v54
    v_sub_f32 v34, v34, v54
    v_sub_f32 v147, v147, v54
    v_sub_f32 v35, v35, v54
    v_sub_f32 v148, v148, v55
    v_sub_f32 v36, v36, v55
    v_sub_f32 v149, v149, v55
    v_sub_f32 v37, v37, v55
    v_sub_f32 v150, v150, v55
    v_sub_f32 v38, v38, v55
    v_sub_f32 v151, v151, v55
    v_sub_f32 v39, v39, v55
    v_sub_f32 v152, v152, v54
    v_sub_f32 v40, v40, v54
    v_sub_f32 v153, v153, v54
    v_sub_f32 v41, v41, v54
    v_sub_f32 v154, v154, v54
    v_sub_f32 v42, v42, v54
    v_sub_f32 v155, v155, v54
    v_sub_f32 v43, v43, v54
    v_sub_f32 v156, v156, v55
    v_sub_f32 v44, v44, v55
    v_sub_f32 v157, v157, v55
    v_sub_f32 v45, v45, v55
    v_sub_f32 v158, v158, v55
    v_sub_f32 v46, v46, v55
    v_sub_f32 v159, v159, v55
    v_sub_f32 v47, v47, v55
    v_sub_f32 v9, v9, v53
    v_exp_f32 v53, -v53
    v_sub_f32 v10, v10, v54
    v_exp_f32 v54, -v54
    v_sub_f32 v11, v11, v55
    v_exp_f32 v55, -v55
    s_nop 0
    v_mul_f32 v48, v48, v53
    v_mul_f32 v248, v248, v54
    v_mul_f32 v252, v252, v55
    v_accvgpr_read_b32 v224, a4
    v_accvgpr_read_b32 v225, a5
    v_accvgpr_read_b32 v226, a6
    v_accvgpr_read_b32 v227, a7
    v_mul_f32 v224, v224, v53
    v_mul_f32 v225, v225, v53
    v_mul_f32 v226, v226, v53
    v_mul_f32 v227, v227, v53
    v_accvgpr_write_b32 a4, v224
    v_accvgpr_write_b32 a5, v225
    v_accvgpr_write_b32 a6, v226
    v_accvgpr_write_b32 a7, v227
    v_accvgpr_read_b32 v224, a8
    v_accvgpr_read_b32 v225, a9
    v_accvgpr_read_b32 v226, a10
    v_accvgpr_read_b32 v227, a11
    v_mul_f32 v224, v224, v54
    v_mul_f32 v225, v225, v54
    v_mul_f32 v226, v226, v54
    v_mul_f32 v227, v227, v54
    v_accvgpr_write_b32 a8, v224
    v_accvgpr_write_b32 a9, v225
    v_accvgpr_write_b32 a10, v226
    v_accvgpr_write_b32 a11, v227
    v_accvgpr_read_b32 v224, a12
    v_accvgpr_read_b32 v225, a13
    v_accvgpr_read_b32 v226, a14
    v_accvgpr_read_b32 v227, a15
    v_mul_f32 v224, v224, v55
    v_mul_f32 v225, v225, v55
    v_mul_f32 v226, v226, v55
    v_mul_f32 v227, v227, v55
    v_accvgpr_write_b32 a12, v224
    v_accvgpr_write_b32 a13, v225
    v_accvgpr_write_b32 a14, v226
    v_accvgpr_write_b32 a15, v227
    v_accvgpr_read_b32 v224, a20
    v_accvgpr_read_b32 v225, a21
    v_accvgpr_read_b32 v226, a22
    v_accvgpr_read_b32 v227, a23
    v_mul_f32 v224, v224, v53
    v_mul_f32 v225, v225, v53
    v_mul_f32 v226, v226, v53
    v_mul_f32 v227, v227, v53
    v_accvgpr_write_b32 a20, v224
    v_accvgpr_write_b32 a21, v225
    v_accvgpr_write_b32 a22, v226
    v_accvgpr_write_b32 a23, v227
    v_accvgpr_read_b32 v224, a24
    v_accvgpr_read_b32 v225, a25
    v_accvgpr_read_b32 v226, a26
    v_accvgpr_read_b32 v227, a27
    v_mul_f32 v224, v224, v54
    v_mul_f32 v225, v225, v54
    v_mul_f32 v226, v226, v54
    v_mul_f32 v227, v227, v54
    v_accvgpr_write_b32 a24, v224
    v_accvgpr_write_b32 a25, v225
    v_accvgpr_write_b32 a26, v226
    v_accvgpr_write_b32 a27, v227
    v_accvgpr_read_b32 v224, a28
    v_accvgpr_read_b32 v225, a29
    v_accvgpr_read_b32 v226, a30
    v_accvgpr_read_b32 v227, a31
    v_mul_f32 v224, v224, v55
    v_mul_f32 v225, v225, v55
    v_mul_f32 v226, v226, v55
    v_mul_f32 v227, v227, v55
    v_accvgpr_write_b32 a28, v224
    v_accvgpr_write_b32 a29, v225
    v_accvgpr_write_b32 a30, v226
    v_accvgpr_write_b32 a31, v227
    v_accvgpr_read_b32 v224, a36
    v_accvgpr_read_b32 v225, a37
    v_accvgpr_read_b32 v226, a38
    v_accvgpr_read_b32 v227, a39
    v_mul_f32 v224, v224, v53
    v_mul_f32 v225, v225, v53
    v_mul_f32 v226, v226, v53
    v_mul_f32 v227, v227, v53
    v_accvgpr_write_b32 a36, v224
    v_accvgpr_write_b32 a37, v225
    v_accvgpr_write_b32 a38, v226
    v_accvgpr_write_b32 a39, v227
    v_accvgpr_read_b32 v224, a40
    v_accvgpr_read_b32 v225, a41
    v_accvgpr_read_b32 v226, a42
    v_accvgpr_read_b32 v227, a43
    v_mul_f32 v224, v224, v54
    v_mul_f32 v225, v225, v54
    v_mul_f32 v226, v226, v54
    v_mul_f32 v227, v227, v54
    v_accvgpr_write_b32 a40, v224
    v_accvgpr_write_b32 a41, v225
    v_accvgpr_write_b32 a42, v226
    v_accvgpr_write_b32 a43, v227
    v_accvgpr_read_b32 v224, a44
    v_accvgpr_read_b32 v225, a45
    v_accvgpr_read_b32 v226, a46
    v_accvgpr_read_b32 v227, a47
    v_mul_f32 v224, v224, v55
    v_mul_f32 v225, v225, v55
    v_mul_f32 v226, v226, v55
    v_mul_f32 v227, v227, v55
    v_accvgpr_write_b32 a44, v224
    v_accvgpr_write_b32 a45, v225
    v_accvgpr_write_b32 a46, v226
    v_accvgpr_write_b32 a47, v227
    v_accvgpr_read_b32 v224, a52
    v_accvgpr_read_b32 v225, a53
    v_accvgpr_read_b32 v226, a54
    v_accvgpr_read_b32 v227, a55
    v_mul_f32 v224, v224, v53
    v_mul_f32 v225, v225, v53
    v_mul_f32 v226, v226, v53
    v_mul_f32 v227, v227, v53
    v_accvgpr_write_b32 a52, v224
    v_accvgpr_write_b32 a53, v225
    v_accvgpr_write_b32 a54, v226
    v_accvgpr_write_b32 a55, v227
    v_accvgpr_read_b32 v224, a56
    v_accvgpr_read_b32 v225, a57
    v_accvgpr_read_b32 v226, a58
    v_accvgpr_read_b32 v227, a59
    v_mul_f32 v224, v224, v54
    v_mul_f32 v225, v225, v54
    v_mul_f32 v226, v226, v54
    v_mul_f32 v227, v227, v54
    v_accvgpr_write_b32 a56, v224
    v_accvgpr_write_b32 a57, v225
    v_accvgpr_write_b32 a58, v226
    v_accvgpr_write_b32 a59, v227
    v_accvgpr_read_b32 v224, a60
    v_accvgpr_read_b32 v225, a61
    v_accvgpr_read_b32 v226, a62
    v_accvgpr_read_b32 v227, a63
    v_mul_f32 v224, v224, v55
    v_mul_f32 v225, v225, v55
    v_mul_f32 v226, v226, v55
    v_mul_f32 v227, v227, v55
    v_accvgpr_write_b32 a60, v224
    v_accvgpr_write_b32 a61, v225
    v_accvgpr_write_b32 a62, v226
    v_accvgpr_write_b32 a63, v227
    v_accvgpr_read_b32 v224, a68
    v_accvgpr_read_b32 v225, a69
    v_accvgpr_read_b32 v226, a70
    v_accvgpr_read_b32 v227, a71
    v_mul_f32 v224, v224, v53
    v_mul_f32 v225, v225, v53
    v_mul_f32 v226, v226, v53
    v_mul_f32 v227, v227, v53
    v_accvgpr_write_b32 a68, v224
    v_accvgpr_write_b32 a69, v225
    v_accvgpr_write_b32 a70, v226
    v_accvgpr_write_b32 a71, v227
    v_accvgpr_read_b32 v224, a72
    v_accvgpr_read_b32 v225, a73
    v_accvgpr_read_b32 v226, a74
    v_accvgpr_read_b32 v227, a75
    v_mul_f32 v224, v224, v54
    v_mul_f32 v225, v225, v54
    v_mul_f32 v226, v226, v54
    v_mul_f32 v227, v227, v54
    v_accvgpr_write_b32 a72, v224
    v_accvgpr_write_b32 a73, v225
    v_accvgpr_write_b32 a74, v226
    v_accvgpr_write_b32 a75, v227
    v_accvgpr_read_b32 v224, a76
    v_accvgpr_read_b32 v225, a77
    v_accvgpr_read_b32 v226, a78
    v_accvgpr_read_b32 v227, a79
    v_mul_f32 v224, v224, v55
    v_mul_f32 v225, v225, v55
    v_mul_f32 v226, v226, v55
    v_mul_f32 v227, v227, v55
    v_accvgpr_write_b32 a76, v224
    v_accvgpr_write_b32 a77, v225
    v_accvgpr_write_b32 a78, v226
    v_accvgpr_write_b32 a79, v227
    v_accvgpr_read_b32 v224, a84
    v_accvgpr_read_b32 v225, a85
    v_accvgpr_read_b32 v226, a86
    v_accvgpr_read_b32 v227, a87
    v_mul_f32 v224, v224, v53
    v_mul_f32 v225, v225, v53
    v_mul_f32 v226, v226, v53
    v_mul_f32 v227, v227, v53
    v_accvgpr_write_b32 a84, v224
    v_accvgpr_write_b32 a85, v225
    v_accvgpr_write_b32 a86, v226
    v_accvgpr_write_b32 a87, v227
    v_accvgpr_read_b32 v224, a88
    v_accvgpr_read_b32 v225, a89
    v_accvgpr_read_b32 v226, a90
    v_accvgpr_read_b32 v227, a91
    v_mul_f32 v224, v224, v54
    v_mul_f32 v225, v225, v54
    v_mul_f32 v226, v226, v54
    v_mul_f32 v227, v227, v54
    v_accvgpr_write_b32 a88, v224
    v_accvgpr_write_b32 a89, v225
    v_accvgpr_write_b32 a90, v226
    v_accvgpr_write_b32 a91, v227
    v_accvgpr_read_b32 v224, a92
    v_accvgpr_read_b32 v225, a93
    v_accvgpr_read_b32 v226, a94
    v_accvgpr_read_b32 v227, a95
    v_mul_f32 v224, v224, v55
    v_mul_f32 v225, v225, v55
    v_mul_f32 v226, v226, v55
    v_mul_f32 v227, v227, v55
    v_accvgpr_write_b32 a92, v224
    v_accvgpr_write_b32 a93, v225
    v_accvgpr_write_b32 a94, v226
    v_accvgpr_write_b32 a95, v227
    v_accvgpr_read_b32 v224, a100
    v_accvgpr_read_b32 v225, a101
    v_accvgpr_read_b32 v226, a102
    v_accvgpr_read_b32 v227, a103
    v_mul_f32 v224, v224, v53
    v_mul_f32 v225, v225, v53
    v_mul_f32 v226, v226, v53
    v_mul_f32 v227, v227, v53
    v_accvgpr_write_b32 a100, v224
    v_accvgpr_write_b32 a101, v225
    v_accvgpr_write_b32 a102, v226
    v_accvgpr_write_b32 a103, v227
    v_accvgpr_read_b32 v224, a104
    v_accvgpr_read_b32 v225, a105
    v_accvgpr_read_b32 v226, a106
    v_accvgpr_read_b32 v227, a107
    v_mul_f32 v224, v224, v54
    v_mul_f32 v225, v225, v54
    v_mul_f32 v226, v226, v54
    v_mul_f32 v227, v227, v54
    v_accvgpr_write_b32 a104, v224
    v_accvgpr_write_b32 a105, v225
    v_accvgpr_write_b32 a106, v226
    v_accvgpr_write_b32 a107, v227
    v_accvgpr_read_b32 v224, a108
    v_accvgpr_read_b32 v225, a109
    v_accvgpr_read_b32 v226, a110
    v_accvgpr_read_b32 v227, a111
    v_mul_f32 v224, v224, v55
    v_mul_f32 v225, v225, v55
    v_mul_f32 v226, v226, v55
    v_mul_f32 v227, v227, v55
    v_accvgpr_write_b32 a108, v224
    v_accvgpr_write_b32 a109, v225
    v_accvgpr_write_b32 a110, v226
    v_accvgpr_write_b32 a111, v227
    v_accvgpr_read_b32 v224, a116
    v_accvgpr_read_b32 v225, a117
    v_accvgpr_read_b32 v226, a118
    v_accvgpr_read_b32 v227, a119
    v_mul_f32 v224, v224, v53
    v_mul_f32 v225, v225, v53
    v_mul_f32 v226, v226, v53
    v_mul_f32 v227, v227, v53
    v_accvgpr_write_b32 a116, v224
    v_accvgpr_write_b32 a117, v225
    v_accvgpr_write_b32 a118, v226
    v_accvgpr_write_b32 a119, v227
    v_accvgpr_read_b32 v224, a120
    v_accvgpr_read_b32 v225, a121
    v_accvgpr_read_b32 v226, a122
    v_accvgpr_read_b32 v227, a123
    v_mul_f32 v224, v224, v54
    v_mul_f32 v225, v225, v54
    v_mul_f32 v226, v226, v54
    v_mul_f32 v227, v227, v54
    v_accvgpr_write_b32 a120, v224
    v_accvgpr_write_b32 a121, v225
    v_accvgpr_write_b32 a122, v226
    v_accvgpr_write_b32 a123, v227
    v_accvgpr_read_b32 v224, a124
    v_accvgpr_read_b32 v225, a125
    v_accvgpr_read_b32 v226, a126
    v_accvgpr_read_b32 v227, a127
    v_mul_f32 v224, v224, v55
    v_mul_f32 v225, v225, v55
    v_mul_f32 v226, v226, v55
    v_mul_f32 v227, v227, v55
    v_accvgpr_write_b32 a124, v224
    v_accvgpr_write_b32 a125, v225
    v_accvgpr_write_b32 a126, v226
    v_accvgpr_write_b32 a127, v227
    v_exp_f32 v232, v164
    v_exp_f32 v233, v165
    v_exp_f32 v234, v166
    v_exp_f32 v235, v167
    s_nop 0
    v_cvt_pk_bf16_f32 v212, v232, v233
    v_cvt_pk_bf16_f32 v213, v234, v235
    v_exp_f32 v232, v180
    v_exp_f32 v233, v181
    v_exp_f32 v234, v182
    v_exp_f32 v235, v183
    s_nop 0
    v_cvt_pk_bf16_f32 v214, v232, v233
    v_cvt_pk_bf16_f32 v215, v234, v235
    v_exp_f32 v232, v168
    v_exp_f32 v233, v169
    v_exp_f32 v234, v170
    v_exp_f32 v235, v171
    s_nop 0
    v_cvt_pk_bf16_f32 v216, v232, v233
    v_cvt_pk_bf16_f32 v217, v234, v235
    v_exp_f32 v232, v184
    v_exp_f32 v233, v185
    v_exp_f32 v234, v186
    v_exp_f32 v235, v187
    s_nop 0
    v_cvt_pk_bf16_f32 v218, v232, v233
    v_cvt_pk_bf16_f32 v219, v234, v235
    v_exp_f32 v232, v172
    v_exp_f32 v233, v173
    v_exp_f32 v234, v174
    v_exp_f32 v235, v175
    s_nop 0
    v_cvt_pk_bf16_f32 v220, v232, v233
    v_cvt_pk_bf16_f32 v221, v234, v235
    v_exp_f32 v232, v188
    v_exp_f32 v233, v189
    v_exp_f32 v234, v190
    v_exp_f32 v235, v191
    s_nop 0
    v_cvt_pk_bf16_f32 v222, v232, v233
    v_cvt_pk_bf16_f32 v223, v234, v235
    s_nop 3
    s_setpc_b64 s[40:41]
k2_rare_166:
    s_nop 7
    v_max_f32 v54, v128, v129
    v_max3_f32 v54, v54, v130, v131
    v_max3_f32 v54, v54, v144, v145
    v_max3_f32 v54, v54, v146, v147
    v_max3_f32 v54, v54, v136, v137
    v_max3_f32 v54, v54, v138, v139
    v_max3_f32 v54, v54, v152, v153
    v_max3_f32 v54, v54, v154, v155
    v_max_f32 v55, v132, v133
    v_max3_f32 v55, v55, v134, v135
    v_max3_f32 v55, v55, v148, v149
    v_max3_f32 v55, v55, v150, v151
    v_max3_f32 v55, v55, v140, v141
    v_max3_f32 v55, v55, v142, v143
    v_max3_f32 v55, v55, v156, v157
    v_max3_f32 v55, v55, v158, v159
    v_mov_b32 v226, v54
    v_mov_b32 v227, v55
    s_nop 1
    v_permlane16_swap_b32 v54, v226
    v_permlane16_swap_b32 v55, v227
    s_nop 1
    v_max_f32 v54, v54, v226
    v_max_f32 v55, v55, v227
    v_mov_b32 v226, v54
    v_mov_b32 v227, v55
    s_nop 1
    v_permlane32_swap_b32 v54, v226
    v_permlane32_swap_b32 v55, v227
    s_nop 1
    v_max_f32 v54, v54, v226
    v_max_f32 v55, v55, v227
    v_add_f32 v54, 0x41400000, v54
    v_max_f32 v54, 0, v54
    v_add_f32 v55, 0x41400000, v55
    v_max_f32 v55, 0, v55
    v_sub_f32 v128, v128, v54
    v_sub_f32 v129, v129, v54
    v_sub_f32 v130, v130, v54
    v_sub_f32 v131, v131, v54
    v_sub_f32 v132, v132, v55
    v_sub_f32 v133, v133, v55
    v_sub_f32 v134, v134, v55
    v_sub_f32 v135, v135, v55
    v_sub_f32 v136, v136, v54
    v_sub_f32 v137, v137, v54
    v_sub_f32 v138, v138, v54
    v_sub_f32 v139, v139, v54
    v_sub_f32 v140, v140, v55
    v_sub_f32 v141, v141, v55
    v_sub_f32 v142, v142, v55
    v_sub_f32 v143, v143, v55
    v_sub_f32 v144, v144, v54
    v_sub_f32 v145, v145, v54
    v_sub_f32 v146, v146, v54
    v_sub_f32 v147, v147, v54
    v_sub_f32 v148, v148, v55
    v_sub_f32 v149, v149, v55
    v_sub_f32 v150, v150, v55
    v_sub_f32 v151, v151, v55
    v_sub_f32 v152, v152, v54
    v_sub_f32 v153, v153, v54
    v_sub_f32 v154, v154, v54
    v_sub_f32 v155, v155, v54
    v_sub_f32 v156, v156, v55
    v_sub_f32 v157, v157, v55
    v_sub_f32 v158, v158, v55
    v_sub_f32 v159, v159, v55
    v_sub_f32 v160, v160, v54
    v_sub_f32 v16, v16, v54
    v_sub_f32 v161, v161, v54
    v_sub_f32 v17, v17, v54
    v_sub_f32 v162, v162, v54
    v_sub_f32 v18, v18, v54
    v_sub_f32 v163, v163, v54
    v_sub_f32 v19, v19, v54
    v_sub_f32 v164, v164, v55
    v_sub_f32 v20, v20, v55
    v_sub_f32 v165, v165, v55
    v_sub_f32 v21, v21, v55
    v_sub_f32 v166, v166, v55
    v_sub_f32 v22, v22, v55
    v_sub_f32 v167, v167, v55
    v_sub_f32 v23, v23, v55
    v_sub_f32 v168, v168, v54
    v_sub_f32 v24, v24, v54
    v_sub_f32 v169, v169, v54
    v_sub_f32 v25, v25, v54
    v_sub_f32 v170, v170, v54
    v_sub_f32 v26, v26, v54
    v_sub_f32 v171, v171, v54
    v_sub_f32 v27, v27, v54
    v_sub_f32 v172, v172, v55
    v_sub_f32 v28, v28, v55
    v_sub_f32 v173, v173, v55
    v_sub_f32 v29, v29, v55
    v_sub_f32 v174, v174, v55
    v_sub_f32 v30, v30, v55
    v_sub_f32 v175, v175, v55
    v_sub_f32 v31, v31, v55
    v_sub_f32 v176, v176, v54
    v_sub_f32 v32, v32, v54
    v_sub_f32 v177, v177, v54
    v_sub_f32 v33, v33, v54
    v_sub_f32 v178, v178, v54
    v_sub_f32 v34, v34, v54
    v_sub_f32 v179, v179, v54
    v_sub_f32 v35, v35, v54
    v_sub_f32 v180, v180, v55
    v_sub_f32 v36, v36, v55
    v_sub_f32 v181, v181, v55
    v_sub_f32 v37, v37, v55
    v_sub_f32 v182, v182, v55
    v_sub_f32 v38, v38, v55
    v_sub_f32 v183, v183, v55
    v_sub_f32 v39, v39, v55
    v_sub_f32 v184, v184, v54
    v_sub_f32 v40, v40, v54
    v_sub_f32 v185, v185, v54
    v_sub_f32 v41, v41, v54
    v_sub_f32 v186, v186, v54
    v_sub_f32 v42, v42, v54
    v_sub_f32 v187, v187, v54
    v_sub_f32 v43, v43, v54
    v_sub_f32 v188, v188, v55
    v_sub_f32 v44, v44, v55
    v_sub_f32 v189, v189, v55
    v_sub_f32 v45, v45, v55
    v_sub_f32 v190, v190, v55
    v_sub_f32 v46, v46, v55
    v_sub_f32 v191, v191, v55
    v_sub_f32 v47, v47, v55
    v_sub_f32 v10, v10, v54
    v_exp_f32 v54, -v54
    v_sub_f32 v11, v11, v55
    v_exp_f32 v55, -v55
    s_nop 0
    v_mul_f32 v248, v248, v54
    v_mul_f32 v252, v252, v55
    v_accvgpr_read_b32 v224, a8
    v_accvgpr_read_b32 v225, a9
    v_accvgpr_read_b32 v226, a10
    v_accvgpr_read_b32 v227, a11
    v_mul_f32 v224, v224, v54
    v_mul_f32 v225, v225, v54
    v_mul_f32 v226, v226, v54
    v_mul_f32 v227, v227, v54
    v_accvgpr_write_b32 a8, v224
    v_accvgpr_write_b32 a9, v225
    v_accvgpr_write_b32 a10, v226
    v_accvgpr_write_b32 a11, v227
    v_accvgpr_read_b32 v224, a12
    v_accvgpr_read_b32 v225, a13
    v_accvgpr_read_b32 v226, a14
    v_accvgpr_read_b32 v227, a15
    v_mul_f32 v224, v224, v55
    v_mul_f32 v225, v225, v55
    v_mul_f32 v226, v226, v55
    v_mul_f32 v227, v227, v55
    v_accvgpr_write_b32 a12, v224
    v_accvgpr_write_b32 a13, v225
    v_accvgpr_write_b32 a14, v226
    v_accvgpr_write_b32 a15, v227
    v_accvgpr_read_b32 v224, a24
    v_accvgpr_read_b32 v225, a25
    v_accvgpr_read_b32 v226, a26
    v_accvgpr_read_b32 v227, a27
    v_mul_f32 v224, v224, v54
    v_mul_f32 v225, v225, v54
    v_mul_f32 v226, v226, v54
    v_mul_f32 v227, v227, v54
    v_accvgpr_write_b32 a24, v224
    v_accvgpr_write_b32 a25, v225
    v_accvgpr_write_b32 a26, v226
    v_accvgpr_write_b32 a27, v227
    v_accvgpr_read_b32 v224, a28
    v_accvgpr_read_b32 v225, a29
    v_accvgpr_read_b32 v226, a30
    v_accvgpr_read_b32 v227, a31
    v_mul_f32 v224, v224, v55
    v_mul_f32 v225, v225, v55
    v_mul_f32 v226, v226, v55
    v_mul_f32 v227, v227, v55
    v_accvgpr_write_b32 a28, v224
    v_accvgpr_write_b32 a29, v225
    v_accvgpr_write_b32 a30, v226
    v_accvgpr_write_b32 a31, v227
    v_accvgpr_read_b32 v224, a40
    v_accvgpr_read_b32 v225, a41
    v_accvgpr_read_b32 v226, a42
    v_accvgpr_read_b32 v227, a43
    v_mul_f32 v224, v224, v54
    v_mul_f32 v225, v225, v54
    v_mul_f32 v226, v226, v54
    v_mul_f32 v227, v227, v54
    v_accvgpr_write_b32 a40, v224
    v_accvgpr_write_b32 a41, v225
    v_accvgpr_write_b32 a42, v226
    v_accvgpr_write_b32 a43, v227
    v_accvgpr_read_b32 v224, a44
    v_accvgpr_read_b32 v225, a45
    v_accvgpr_read_b32 v226, a46
    v_accvgpr_read_b32 v227, a47
    v_mul_f32 v224, v224, v55
    v_mul_f32 v225, v225, v55
    v_mul_f32 v226, v226, v55
    v_mul_f32 v227, v227, v55
    v_accvgpr_write_b32 a44, v224
    v_accvgpr_write_b32 a45, v225
    v_accvgpr_write_b32 a46, v226
    v_accvgpr_write_b32 a47, v227
    v_accvgpr_read_b32 v224, a56
    v_accvgpr_read_b32 v225, a57
    v_accvgpr_read_b32 v226, a58
    v_accvgpr_read_b32 v227, a59
    v_mul_f32 v224, v224, v54
    v_mul_f32 v225, v225, v54
    v_mul_f32 v226, v226, v54
    v_mul_f32 v227, v227, v54
    v_accvgpr_write_b32 a56, v224
    v_accvgpr_write_b32 a57, v225
    v_accvgpr_write_b32 a58, v226
    v_accvgpr_write_b32 a59, v227
    v_accvgpr_read_b32 v224, a60
    v_accvgpr_read_b32 v225, a61
    v_accvgpr_read_b32 v226, a62
    v_accvgpr_read_b32 v227, a63
    v_mul_f32 v224, v224, v55
    v_mul_f32 v225, v225, v55
    v_mul_f32 v226, v226, v55
    v_mul_f32 v227, v227, v55
    v_accvgpr_write_b32 a60, v224
    v_accvgpr_write_b32 a61, v225
    v_accvgpr_write_b32 a62, v226
    v_accvgpr_write_b32 a63, v227
    v_accvgpr_read_b32 v224, a72
    v_accvgpr_read_b32 v225, a73
    v_accvgpr_read_b32 v226, a74
    v_accvgpr_read_b32 v227, a75
    v_mul_f32 v224, v224, v54
    v_mul_f32 v225, v225, v54
    v_mul_f32 v226, v226, v54
    v_mul_f32 v227, v227, v54
    v_accvgpr_write_b32 a72, v224
    v_accvgpr_write_b32 a73, v225
    v_accvgpr_write_b32 a74, v226
    v_accvgpr_write_b32 a75, v227
    v_accvgpr_read_b32 v224, a76
    v_accvgpr_read_b32 v225, a77
    v_accvgpr_read_b32 v226, a78
    v_accvgpr_read_b32 v227, a79
    v_mul_f32 v224, v224, v55
    v_mul_f32 v225, v225, v55
    v_mul_f32 v226, v226, v55
    v_mul_f32 v227, v227, v55
    v_accvgpr_write_b32 a76, v224
    v_accvgpr_write_b32 a77, v225
    v_accvgpr_write_b32 a78, v226
    v_accvgpr_write_b32 a79, v227
    v_accvgpr_read_b32 v224, a88
    v_accvgpr_read_b32 v225, a89
    v_accvgpr_read_b32 v226, a90
    v_accvgpr_read_b32 v227, a91
    v_mul_f32 v224, v224, v54
    v_mul_f32 v225, v225, v54
    v_mul_f32 v226, v226, v54
    v_mul_f32 v227, v227, v54
    v_accvgpr_write_b32 a88, v224
    v_accvgpr_write_b32 a89, v225
    v_accvgpr_write_b32 a90, v226
    v_accvgpr_write_b32 a91, v227
    v_accvgpr_read_b32 v224, a92
    v_accvgpr_read_b32 v225, a93
    v_accvgpr_read_b32 v226, a94
    v_accvgpr_read_b32 v227, a95
    v_mul_f32 v224, v224, v55
    v_mul_f32 v225, v225, v55
    v_mul_f32 v226, v226, v55
    v_mul_f32 v227, v227, v55
    v_accvgpr_write_b32 a92, v224
    v_accvgpr_write_b32 a93, v225
    v_accvgpr_write_b32 a94, v226
    v_accvgpr_write_b32 a95, v227
    v_accvgpr_read_b32 v224, a104
    v_accvgpr_read_b32 v225, a105
    v_accvgpr_read_b32 v226, a106
    v_accvgpr_read_b32 v227, a107
    v_mul_f32 v224, v224, v54
    v_mul_f32 v225, v225, v54
    v_mul_f32 v226, v226, v54
    v_mul_f32 v227, v227, v54
    v_accvgpr_write_b32 a104, v224
    v_accvgpr_write_b32 a105, v225
    v_accvgpr_write_b32 a106, v226
    v_accvgpr_write_b32 a107, v227
    v_accvgpr_read_b32 v224, a108
    v_accvgpr_read_b32 v225, a109
    v_accvgpr_read_b32 v226, a110
    v_accvgpr_read_b32 v227, a111
    v_mul_f32 v224, v224, v55
    v_mul_f32 v225, v225, v55
    v_mul_f32 v226, v226, v55
    v_mul_f32 v227, v227, v55
    v_accvgpr_write_b32 a108, v224
    v_accvgpr_write_b32 a109, v225
    v_accvgpr_write_b32 a110, v226
    v_accvgpr_write_b32 a111, v227
    v_accvgpr_read_b32 v224, a120
    v_accvgpr_read_b32 v225, a121
    v_accvgpr_read_b32 v226, a122
    v_accvgpr_read_b32 v227, a123
    v_mul_f32 v224, v224, v54
    v_mul_f32 v225, v225, v54
    v_mul_f32 v226, v226, v54
    v_mul_f32 v227, v227, v54
    v_accvgpr_write_b32 a120, v224
    v_accvgpr_write_b32 a121, v225
    v_accvgpr_write_b32 a122, v226
    v_accvgpr_write_b32 a123, v227
    v_accvgpr_read_b32 v224, a124
    v_accvgpr_read_b32 v225, a125
    v_accvgpr_read_b32 v226, a126
    v_accvgpr_read_b32 v227, a127
    v_mul_f32 v224, v224, v55
    v_mul_f32 v225, v225, v55
    v_mul_f32 v226, v226, v55
    v_mul_f32 v227, v227, v55
    v_accvgpr_write_b32 a124, v224
    v_accvgpr_write_b32 a125, v225
    v_accvgpr_write_b32 a126, v226
    v_accvgpr_write_b32 a127, v227
    v_exp_f32 v232, v128
    v_exp_f32 v233, v129
    v_exp_f32 v234, v130
    v_exp_f32 v235, v131
    s_nop 0
    v_cvt_pk_bf16_f32 v192, v232, v233
    v_cvt_pk_bf16_f32 v193, v234, v235
    v_exp_f32 v232, v144
    v_exp_f32 v233, v145
    v_exp_f32 v234, v146
    v_exp_f32 v235, v147
    s_nop 0
    v_cvt_pk_bf16_f32 v194, v232, v233
    v_cvt_pk_bf16_f32 v195, v234, v235
    v_exp_f32 v232, v132
    v_exp_f32 v233, v133
    v_exp_f32 v234, v134
    v_exp_f32 v235, v135
    s_nop 0
    v_cvt_pk_bf16_f32 v196, v232, v233
    v_cvt_pk_bf16_f32 v197, v234, v235
    v_exp_f32 v232, v148
    v_exp_f32 v233, v149
    v_exp_f32 v234, v150
    v_exp_f32 v235, v151
    s_nop 0
    v_cvt_pk_bf16_f32 v198, v232, v233
    v_cvt_pk_bf16_f32 v199, v234, v235
    v_exp_f32 v232, v136
    v_exp_f32 v233, v137
    v_exp_f32 v234, v138
    v_exp_f32 v235, v139
    s_nop 0
    v_cvt_pk_bf16_f32 v200, v232, v233
    v_cvt_pk_bf16_f32 v201, v234, v235
    v_exp_f32 v232, v152
    v_exp_f32 v233, v153
    v_exp_f32 v234, v154
    v_exp_f32 v235, v155
    s_nop 0
    v_cvt_pk_bf16_f32 v202, v232, v233
    v_cvt_pk_bf16_f32 v203, v234, v235
    v_exp_f32 v232, v140
    v_exp_f32 v233, v141
    v_exp_f32 v234, v142
    v_exp_f32 v235, v143
    s_nop 0
    v_cvt_pk_bf16_f32 v204, v232, v233
    v_cvt_pk_bf16_f32 v205, v234, v235
    v_exp_f32 v232, v156
    v_exp_f32 v233, v157
    v_exp_f32 v234, v158
    v_exp_f32 v235, v159
    s_nop 0
    v_cvt_pk_bf16_f32 v206, v232, v233
    v_cvt_pk_bf16_f32 v207, v234, v235
    s_nop 3
    s_setpc_b64 s[40:41]
k2_rare_167:
    s_nop 7
    v_max_f32 v54, v160, v161
    v_max3_f32 v54, v54, v162, v163
    v_max3_f32 v54, v54, v176, v177
    v_max3_f32 v54, v54, v178, v179
    v_max3_f32 v54, v54, v168, v169
    v_max3_f32 v54, v54, v170, v171
    v_max3_f32 v54, v54, v184, v185
    v_max3_f32 v54, v54, v186, v187
    v_max_f32 v55, v164, v165
    v_max3_f32 v55, v55, v166, v167
    v_max3_f32 v55, v55, v180, v181
    v_max3_f32 v55, v55, v182, v183
    v_max3_f32 v55, v55, v172, v173
    v_max3_f32 v55, v55, v174, v175
    v_max3_f32 v55, v55, v188, v189
    v_max3_f32 v55, v55, v190, v191
    v_mov_b32 v226, v54
    v_mov_b32 v227, v55
    s_nop 1
    v_permlane16_swap_b32 v54, v226
    v_permlane16_swap_b32 v55, v227
    s_nop 1
    v_max_f32 v54, v54, v226
    v_max_f32 v55, v55, v227
    v_mov_b32 v226, v54
    v_mov_b32 v227, v55
    s_nop 1
    v_permlane32_swap_b32 v54, v226
    v_permlane32_swap_b32 v55, v227
    s_nop 1
    v_max_f32 v54, v54, v226
    v_max_f32 v55, v55, v227
    v_add_f32 v54, 0x41400000, v54
    v_max_f32 v54, 0, v54
    v_add_f32 v55, 0x41400000, v55
    v_max_f32 v55, 0, v55
    v_sub_f32 v160, v160, v54
    v_sub_f32 v161, v161, v54
    v_sub_f32 v162, v162, v54
    v_sub_f32 v163, v163, v54
    v_sub_f32 v164, v164, v55
    v_sub_f32 v165, v165, v55
    v_sub_f32 v166, v166, v55
    v_sub_f32 v167, v167, v55
    v_sub_f32 v168, v168, v54
    v_sub_f32 v169, v169, v54
    v_sub_f32 v170, v170, v54
    v_sub_f32 v171, v171, v54
    v_sub_f32 v172, v172, v55
    v_sub_f32 v173, v173, v55
    v_sub_f32 v174, v174, v55
    v_sub_f32 v175, v175, v55
    v_sub_f32 v176, v176, v54
    v_sub_f32 v177, v177, v54
    v_sub_f32 v178, v178, v54
    v_sub_f32 v179, v179, v54
    v_sub_f32 v180, v180, v55
    v_sub_f32 v181, v181, v55
    v_sub_f32 v182, v182, v55
    v_sub_f32 v183, v183, v55
    v_sub_f32 v184, v184, v54
    v_sub_f32 v185, v185, v54
    v_sub_f32 v186, v186, v54
    v_sub_f32 v187, v187, v54
    v_sub_f32 v188, v188, v55
    v_sub_f32 v189, v189, v55
    v_sub_f32 v190, v190, v55
    v_sub_f32 v191, v191, v55
    v_sub_f32 v128, v128, v54
    v_sub_f32 v16, v16, v54
    v_sub_f32 v129, v129, v54
    v_sub_f32 v17, v17, v54
    v_sub_f32 v130, v130, v54
    v_sub_f32 v18, v18, v54
    v_sub_f32 v131, v131, v54
    v_sub_f32 v19, v19, v54
    v_sub_f32 v132, v132, v55
    v_sub_f32 v20, v20, v55
    v_sub_f32 v133, v133, v55
    v_sub_f32 v21, v21, v55
    v_sub_f32 v134, v134, v55
    v_sub_f32 v22, v22, v55
    v_sub_f32 v135, v135, v55
    v_sub_f32 v23, v23, v55
    v_sub_f32 v136, v136, v54
    v_sub_f32 v24, v24, v54
    v_sub_f32 v137, v137, v54
    v_sub_f32 v25, v25, v54
    v_sub_f32 v138, v138, v54
    v_sub_f32 v26, v26, v54
    v_sub_f32 v139, v139, v54
    v_sub_f32 v27, v27, v54
    v_sub_f32 v140, v140, v55
    v_sub_f32 v28, v28, v55
    v_sub_f32 v141, v141, v55
    v_sub_f32 v29, v29, v55
    v_sub_f32 v142, v142, v55
    v_sub_f32 v30, v30, v55
    v_sub_f32 v143, v143, v55
    v_sub_f32 v31, v31, v55
    v_sub_f32 v144, v144, v54
    v_sub_f32 v32, v32, v54
    v_sub_f32 v145, v145, v54
    v_sub_f32 v33, v33, v54
    v_sub_f32 v146, v146, v54
    v_sub_f32 v34, v34, v54
    v_sub_f32 v147, v147, v54
    v_sub_f32 v35, v35, v54
    v_sub_f32 v148, v148, v55
    v_sub_f32 v36, v36, v55
    v_sub_f32 v149, v149, v55
    v_sub_f32 v37, v37, v55
    v_sub_f32 v150, v150, v55
    v_sub_f32 v38, v38, v55
    v_sub_f32 v151, v151, v55
    v_sub_f32 v39, v39, v55
    v_sub_f32 v152, v152, v54
    v_sub_f32 v40, v40, v54
    v_sub_f32 v153, v153, v54
    v_sub_f32 v41, v41, v54
    v_sub_f32 v154, v154, v54
    v_sub_f32 v42, v42, v54
    v_sub_f32 v155, v155, v54
    v_sub_f32 v43, v43, v54
    v_sub_f32 v156, v156, v55
    v_sub_f32 v44, v44, v55
    v_sub_f32 v157, v157, v55
    v_sub_f32 v45, v45, v55
    v_sub_f32 v158, v158, v55
    v_sub_f32 v46, v46, v55
    v_sub_f32 v159, v159, v55
    v_sub_f32 v47, v47, v55
    v_sub_f32 v10, v10, v54
    v_exp_f32 v54, -v54
    v_sub_f32 v11, v11, v55
    v_exp_f32 v55, -v55
    s_nop 0
    v_mul_f32 v248, v248, v54
    v_mul_f32 v252, v252, v55
    v_accvgpr_read_b32 v224, a8
    v_accvgpr_read_b32 v225, a9
    v_accvgpr_read_b32 v226, a10
    v_accvgpr_read_b32 v227, a11
    v_mul_f32 v224, v224, v54
    v_mul_f32 v225, v225, v54
    v_mul_f32 v226, v226, v54
    v_mul_f32 v227, v227, v54
    v_accvgpr_write_b32 a8, v224
    v_accvgpr_write_b32 a9, v225
    v_accvgpr_write_b32 a10, v226
    v_accvgpr_write_b32 a11, v227
    v_accvgpr_read_b32 v224, a12
    v_accvgpr_read_b32 v225, a13
    v_accvgpr_read_b32 v226, a14
    v_accvgpr_read_b32 v227, a15
    v_mul_f32 v224, v224, v55
    v_mul_f32 v225, v225, v55
    v_mul_f32 v226, v226, v55
    v_mul_f32 v227, v227, v55
    v_accvgpr_write_b32 a12, v224
    v_accvgpr_write_b32 a13, v225
    v_accvgpr_write_b32 a14, v226
    v_accvgpr_write_b32 a15, v227
    v_accvgpr_read_b32 v224, a24
    v_accvgpr_read_b32 v225, a25
    v_accvgpr_read_b32 v226, a26
    v_accvgpr_read_b32 v227, a27
    v_mul_f32 v224, v224, v54
    v_mul_f32 v225, v225, v54
    v_mul_f32 v226, v226, v54
    v_mul_f32 v227, v227, v54
    v_accvgpr_write_b32 a24, v224
    v_accvgpr_write_b32 a25, v225
    v_accvgpr_write_b32 a26, v226
    v_accvgpr_write_b32 a27, v227
    v_accvgpr_read_b32 v224, a28
    v_accvgpr_read_b32 v225, a29
    v_accvgpr_read_b32 v226, a30
    v_accvgpr_read_b32 v227, a31
    v_mul_f32 v224, v224, v55
    v_mul_f32 v225, v225, v55
    v_mul_f32 v226, v226, v55
    v_mul_f32 v227, v227, v55
    v_accvgpr_write_b32 a28, v224
    v_accvgpr_write_b32 a29, v225
    v_accvgpr_write_b32 a30, v226
    v_accvgpr_write_b32 a31, v227
    v_accvgpr_read_b32 v224, a40
    v_accvgpr_read_b32 v225, a41
    v_accvgpr_read_b32 v226, a42
    v_accvgpr_read_b32 v227, a43
    v_mul_f32 v224, v224, v54
    v_mul_f32 v225, v225, v54
    v_mul_f32 v226, v226, v54
    v_mul_f32 v227, v227, v54
    v_accvgpr_write_b32 a40, v224
    v_accvgpr_write_b32 a41, v225
    v_accvgpr_write_b32 a42, v226
    v_accvgpr_write_b32 a43, v227
    v_accvgpr_read_b32 v224, a44
    v_accvgpr_read_b32 v225, a45
    v_accvgpr_read_b32 v226, a46
    v_accvgpr_read_b32 v227, a47
    v_mul_f32 v224, v224, v55
    v_mul_f32 v225, v225, v55
    v_mul_f32 v226, v226, v55
    v_mul_f32 v227, v227, v55
    v_accvgpr_write_b32 a44, v224
    v_accvgpr_write_b32 a45, v225
    v_accvgpr_write_b32 a46, v226
    v_accvgpr_write_b32 a47, v227
    v_accvgpr_read_b32 v224, a56
    v_accvgpr_read_b32 v225, a57
    v_accvgpr_read_b32 v226, a58
    v_accvgpr_read_b32 v227, a59
    v_mul_f32 v224, v224, v54
    v_mul_f32 v225, v225, v54
    v_mul_f32 v226, v226, v54
    v_mul_f32 v227, v227, v54
    v_accvgpr_write_b32 a56, v224
    v_accvgpr_write_b32 a57, v225
    v_accvgpr_write_b32 a58, v226
    v_accvgpr_write_b32 a59, v227
    v_accvgpr_read_b32 v224, a60
    v_accvgpr_read_b32 v225, a61
    v_accvgpr_read_b32 v226, a62
    v_accvgpr_read_b32 v227, a63
    v_mul_f32 v224, v224, v55
    v_mul_f32 v225, v225, v55
    v_mul_f32 v226, v226, v55
    v_mul_f32 v227, v227, v55
    v_accvgpr_write_b32 a60, v224
    v_accvgpr_write_b32 a61, v225
    v_accvgpr_write_b32 a62, v226
    v_accvgpr_write_b32 a63, v227
    v_accvgpr_read_b32 v224, a72
    v_accvgpr_read_b32 v225, a73
    v_accvgpr_read_b32 v226, a74
    v_accvgpr_read_b32 v227, a75
    v_mul_f32 v224, v224, v54
    v_mul_f32 v225, v225, v54
    v_mul_f32 v226, v226, v54
    v_mul_f32 v227, v227, v54
    v_accvgpr_write_b32 a72, v224
    v_accvgpr_write_b32 a73, v225
    v_accvgpr_write_b32 a74, v226
    v_accvgpr_write_b32 a75, v227
    v_accvgpr_read_b32 v224, a76
    v_accvgpr_read_b32 v225, a77
    v_accvgpr_read_b32 v226, a78
    v_accvgpr_read_b32 v227, a79
    v_mul_f32 v224, v224, v55
    v_mul_f32 v225, v225, v55
    v_mul_f32 v226, v226, v55
    v_mul_f32 v227, v227, v55
    v_accvgpr_write_b32 a76, v224
    v_accvgpr_write_b32 a77, v225
    v_accvgpr_write_b32 a78, v226
    v_accvgpr_write_b32 a79, v227
    v_accvgpr_read_b32 v224, a88
    v_accvgpr_read_b32 v225, a89
    v_accvgpr_read_b32 v226, a90
    v_accvgpr_read_b32 v227, a91
    v_mul_f32 v224, v224, v54
    v_mul_f32 v225, v225, v54
    v_mul_f32 v226, v226, v54
    v_mul_f32 v227, v227, v54
    v_accvgpr_write_b32 a88, v224
    v_accvgpr_write_b32 a89, v225
    v_accvgpr_write_b32 a90, v226
    v_accvgpr_write_b32 a91, v227
    v_accvgpr_read_b32 v224, a92
    v_accvgpr_read_b32 v225, a93
    v_accvgpr_read_b32 v226, a94
    v_accvgpr_read_b32 v227, a95
    v_mul_f32 v224, v224, v55
    v_mul_f32 v225, v225, v55
    v_mul_f32 v226, v226, v55
    v_mul_f32 v227, v227, v55
    v_accvgpr_write_b32 a92, v224
    v_accvgpr_write_b32 a93, v225
    v_accvgpr_write_b32 a94, v226
    v_accvgpr_write_b32 a95, v227
    v_accvgpr_read_b32 v224, a104
    v_accvgpr_read_b32 v225, a105
    v_accvgpr_read_b32 v226, a106
    v_accvgpr_read_b32 v227, a107
    v_mul_f32 v224, v224, v54
    v_mul_f32 v225, v225, v54
    v_mul_f32 v226, v226, v54
    v_mul_f32 v227, v227, v54
    v_accvgpr_write_b32 a104, v224
    v_accvgpr_write_b32 a105, v225
    v_accvgpr_write_b32 a106, v226
    v_accvgpr_write_b32 a107, v227
    v_accvgpr_read_b32 v224, a108
    v_accvgpr_read_b32 v225, a109
    v_accvgpr_read_b32 v226, a110
    v_accvgpr_read_b32 v227, a111
    v_mul_f32 v224, v224, v55
    v_mul_f32 v225, v225, v55
    v_mul_f32 v226, v226, v55
    v_mul_f32 v227, v227, v55
    v_accvgpr_write_b32 a108, v224
    v_accvgpr_write_b32 a109, v225
    v_accvgpr_write_b32 a110, v226
    v_accvgpr_write_b32 a111, v227
    v_accvgpr_read_b32 v224, a120
    v_accvgpr_read_b32 v225, a121
    v_accvgpr_read_b32 v226, a122
    v_accvgpr_read_b32 v227, a123
    v_mul_f32 v224, v224, v54
    v_mul_f32 v225, v225, v54
    v_mul_f32 v226, v226, v54
    v_mul_f32 v227, v227, v54
    v_accvgpr_write_b32 a120, v224
    v_accvgpr_write_b32 a121, v225
    v_accvgpr_write_b32 a122, v226
    v_accvgpr_write_b32 a123, v227
    v_accvgpr_read_b32 v224, a124
    v_accvgpr_read_b32 v225, a125
    v_accvgpr_read_b32 v226, a126
    v_accvgpr_read_b32 v227, a127
    v_mul_f32 v224, v224, v55
    v_mul_f32 v225, v225, v55
    v_mul_f32 v226, v226, v55
    v_mul_f32 v227, v227, v55
    v_accvgpr_write_b32 a124, v224
    v_accvgpr_write_b32 a125, v225
    v_accvgpr_write_b32 a126, v226
    v_accvgpr_write_b32 a127, v227
    v_exp_f32 v232, v160
    v_exp_f32 v233, v161
    v_exp_f32 v234, v162
    v_exp_f32 v235, v163
    s_nop 0
    v_cvt_pk_bf16_f32 v208, v232, v233
    v_cvt_pk_bf16_f32 v209, v234, v235
    v_exp_f32 v232, v176
    v_exp_f32 v233, v177
    v_exp_f32 v234, v178
    v_exp_f32 v235, v179
    s_nop 0
    v_cvt_pk_bf16_f32 v210, v232, v233
    v_cvt_pk_bf16_f32 v211, v234, v235
    v_exp_f32 v232, v164
    v_exp_f32 v233, v165
    v_exp_f32 v234, v166
    v_exp_f32 v235, v167
    s_nop 0
    v_cvt_pk_bf16_f32 v212, v232, v233
    v_cvt_pk_bf16_f32 v213, v234, v235
    v_exp_f32 v232, v180
    v_exp_f32 v233, v181
    v_exp_f32 v234, v182
    v_exp_f32 v235, v183
    s_nop 0
    v_cvt_pk_bf16_f32 v214, v232, v233
    v_cvt_pk_bf16_f32 v215, v234, v235
    v_exp_f32 v232, v168
    v_exp_f32 v233, v169
    v_exp_f32 v234, v170
    v_exp_f32 v235, v171
    s_nop 0
    v_cvt_pk_bf16_f32 v216, v232, v233
    v_cvt_pk_bf16_f32 v217, v234, v235
    v_exp_f32 v232, v184
    v_exp_f32 v233, v185
    v_exp_f32 v234, v186
    v_exp_f32 v235, v187
    s_nop 0
    v_cvt_pk_bf16_f32 v218, v232, v233
    v_cvt_pk_bf16_f32 v219, v234, v235
    v_exp_f32 v232, v172
    v_exp_f32 v233, v173
    v_exp_f32 v234, v174
    v_exp_f32 v235, v175
    s_nop 0
    v_cvt_pk_bf16_f32 v220, v232, v233
    v_cvt_pk_bf16_f32 v221, v234, v235
    v_exp_f32 v232, v188
    v_exp_f32 v233, v189
    v_exp_f32 v234, v190
    v_exp_f32 v235, v191
    s_nop 0
    v_cvt_pk_bf16_f32 v222, v232, v233
    v_cvt_pk_bf16_f32 v223, v234, v235
    s_nop 3
    s_setpc_b64 s[40:41]
k2_rare_171:
    s_nop 7
    v_max_f32 v55, v164, v165
    v_max3_f32 v55, v55, v166, v167
    v_max3_f32 v55, v55, v180, v181
    v_max3_f32 v55, v55, v182, v183
    v_max3_f32 v55, v55, v172, v173
    v_max3_f32 v55, v55, v174, v175
    v_max3_f32 v55, v55, v188, v189
    v_max3_f32 v55, v55, v190, v191
    v_mov_b32 v227, v55
    s_nop 1
    v_permlane16_swap_b32 v55, v227
    s_nop 1
    v_max_f32 v55, v55, v227
    v_mov_b32 v227, v55
    s_nop 1
    v_permlane32_swap_b32 v55, v227
    s_nop 1
    v_max_f32 v55, v55, v227
    v_add_f32 v55, 0x41400000, v55
    v_max_f32 v55, 0, v55
    v_sub_f32 v164, v164, v55
    v_sub_f32 v165, v165, v55
    v_sub_f32 v166, v166, v55
    v_sub_f32 v167, v167, v55
    v_sub_f32 v172, v172, v55
    v_sub_f32 v173, v173, v55
    v_sub_f32 v174, v174, v55
    v_sub_f32 v175, v175, v55
    v_sub_f32 v180, v180, v55
    v_sub_f32 v181, v181, v55
    v_sub_f32 v182, v182, v55
    v_sub_f32 v183, v183, v55
    v_sub_f32 v188, v188, v55
    v_sub_f32 v189, v189, v55
    v_sub_f32 v190, v190, v55
    v_sub_f32 v191, v191, v55
    v_sub_f32 v11, v11, v55
    v_exp_f32 v55, -v55
    s_nop 0
    v_mul_f32 v252, v252, v55
    v_accvgpr_read_b32 v224, a12
    v_accvgpr_read_b32 v225, a13
    v_accvgpr_read_b32 v226, a14
    v_accvgpr_read_b32 v227, a15
    v_mul_f32 v224, v224, v55
    v_mul_f32 v225, v225, v55
    v_mul_f32 v226, v226, v55
    v_mul_f32 v227, v227, v55
    v_accvgpr_write_b32 a12, v224
    v_accvgpr_write_b32 a13, v225
    v_accvgpr_write_b32 a14, v226
    v_accvgpr_write_b32 a15, v227
    v_accvgpr_read_b32 v224, a28
    v_accvgpr_read_b32 v225, a29
    v_accvgpr_read_b32 v226, a30
    v_accvgpr_read_b32 v227, a31
    v_mul_f32 v224, v224, v55
    v_mul_f32 v225, v225, v55
    v_mul_f32 v226, v226, v55
    v_mul_f32 v227, v227, v55
    v_accvgpr_write_b32 a28, v224
    v_accvgpr_write_b32 a29, v225
    v_accvgpr_write_b32 a30, v226
    v_accvgpr_write_b32 a31, v227
    v_accvgpr_read_b32 v224, a44
    v_accvgpr_read_b32 v225, a45
    v_accvgpr_read_b32 v226, a46
    v_accvgpr_read_b32 v227, a47
    v_mul_f32 v224, v224, v55
    v_mul_f32 v225, v225, v55
    v_mul_f32 v226, v226, v55
    v_mul_f32 v227, v227, v55
    v_accvgpr_write_b32 a44, v224
    v_accvgpr_write_b32 a45, v225
    v_accvgpr_write_b32 a46, v226
    v_accvgpr_write_b32 a47, v227
    v_accvgpr_read_b32 v224, a60
    v_accvgpr_read_b32 v225, a61
    v_accvgpr_read_b32 v226, a62
    v_accvgpr_read_b32 v227, a63
    v_mul_f32 v224, v224, v55
    v_mul_f32 v225, v225, v55
    v_mul_f32 v226, v226, v55
    v_mul_f32 v227, v227, v55
    v_accvgpr_write_b32 a60, v224
    v_accvgpr_write_b32 a61, v225
    v_accvgpr_write_b32 a62, v226
    v_accvgpr_write_b32 a63, v227
    v_accvgpr_read_b32 v224, a76
    v_accvgpr_read_b32 v225, a77
    v_accvgpr_read_b32 v226, a78
    v_accvgpr_read_b32 v227, a79
    v_mul_f32 v224, v224, v55
    v_mul_f32 v225, v225, v55
    v_mul_f32 v226, v226, v55
    v_mul_f32 v227, v227, v55
    v_accvgpr_write_b32 a76, v224
    v_accvgpr_write_b32 a77, v225
    v_accvgpr_write_b32 a78, v226
    v_accvgpr_write_b32 a79, v227
    v_accvgpr_read_b32 v224, a92
    v_accvgpr_read_b32 v225, a93
    v_accvgpr_read_b32 v226, a94
    v_accvgpr_read_b32 v227, a95
    v_mul_f32 v224, v224, v55
    v_mul_f32 v225, v225, v55
    v_mul_f32 v226, v226, v55
    v_mul_f32 v227, v227, v55
    v_accvgpr_write_b32 a92, v224
    v_accvgpr_write_b32 a93, v225
    v_accvgpr_write_b32 a94, v226
    v_accvgpr_write_b32 a95, v227
    v_accvgpr_read_b32 v224, a108
    v_accvgpr_read_b32 v225, a109
    v_accvgpr_read_b32 v226, a110
    v_accvgpr_read_b32 v227, a111
    v_mul_f32 v224, v224, v55
    v_mul_f32 v225, v225, v55
    v_mul_f32 v226, v226, v55
    v_mul_f32 v227, v227, v55
    v_accvgpr_write_b32 a108, v224
    v_accvgpr_write_b32 a109, v225
    v_accvgpr_write_b32 a110, v226
    v_accvgpr_write_b32 a111, v227
    v_accvgpr_read_b32 v224, a124
    v_accvgpr_read_b32 v225, a125
    v_accvgpr_read_b32 v226, a126
    v_accvgpr_read_b32 v227, a127
    v_mul_f32 v224, v224, v55
    v_mul_f32 v225, v225, v55
    v_mul_f32 v226, v226, v55
    v_mul_f32 v227, v227, v55
    v_accvgpr_write_b32 a124, v224
    v_accvgpr_write_b32 a125, v225
    v_accvgpr_write_b32 a126, v226
    v_accvgpr_write_b32 a127, v227
    v_exp_f32 v232, v164
    v_exp_f32 v233, v165
    v_exp_f32 v234, v166
    v_exp_f32 v235, v167
    s_nop 0
    v_cvt_pk_bf16_f32 v212, v232, v233
    v_cvt_pk_bf16_f32 v213, v234, v235
    v_exp_f32 v232, v180
    v_exp_f32 v233, v181
    v_exp_f32 v234, v182
    v_exp_f32 v235, v183
    s_nop 0
    v_cvt_pk_bf16_f32 v214, v232, v233
    v_cvt_pk_bf16_f32 v215, v234, v235
    v_exp_f32 v232, v172
    v_exp_f32 v233, v173
    v_exp_f32 v234, v174
    v_exp_f32 v235, v175
    s_nop 0
    v_cvt_pk_bf16_f32 v220, v232, v233
    v_cvt_pk_bf16_f32 v221, v234, v235
    v_exp_f32 v232, v188
    v_exp_f32 v233, v189
    v_exp_f32 v234, v190
    v_exp_f32 v235, v191
    s_nop 0
    v_cvt_pk_bf16_f32 v222, v232, v233
    v_cvt_pk_bf16_f32 v223, v234, v235
    s_nop 3
    s_setpc_b64 s[40:41]
code_end:
    s_endpgm
.section .rodata,"a"
.p2align 6
.amdhsa_kernel sequential_preLN__compressed_kv_cla__moe_arch_mod__prompt_kernel
  .amdhsa_next_free_vgpr 512
  .amdhsa_next_free_sgpr 102
  .amdhsa_accum_offset 256
  .amdhsa_group_segment_fixed_size 0
  .amdhsa_kernarg_size 112
  .amdhsa_user_sgpr_count 2
  .amdhsa_user_sgpr_kernarg_segment_ptr 1
  .amdhsa_system_sgpr_workgroup_id_x 1
.end_amdhsa_kernel
```

```asm
; @launch grid=(256,1,1) block=(256,1,1) lds=163840
.amdgcn_target "amdgcn-amd-amdhsa--gfx950"
.text
.globl sequential_preLN__compressed_kv_cla__moe_arch_mod__prompt_kernel
.p2align 8
.type sequential_preLN__compressed_kv_cla__moe_arch_mod__prompt_kernel,@function
sequential_preLN__compressed_kv_cla__moe_arch_mod__prompt_kernel:
    s_cmp_ge_u32 s2, 256
    s_cbranch_scc1 k12_end_1
    s_load_dwordx4 s[36:39], s[0:1], 0
    s_load_dwordx4 s[40:43], s[0:1], 24
    s_load_dwordx2 s[4:5], s[0:1], 16
    s_load_dwordx4 s[60:63], s[0:1], 96
    s_lshr_b32 s59, s2, 3
    s_lshl_b32 s58, s59, 4
    v_add_u32 v6, s58, v0
    v_cmp_gt_u32 vcc, 48, v0
    v_cmp_gt_u32 s[56:57], 64, v0
    s_nop 0
    v_cndmask_b32 v6, v6, v0, vcc
    s_getpc_b64 s[52:53]
pc_2:
    s_add_u32 s52, s52, k12_code0-pc_2
    s_addc_u32 s53, s53, 0
    v_lshlrev_b32 v58, 7, v6
    v_mov_b32 v59, s53
    v_add_co_u32 v58, vcc, s52, v58
    s_nop 1
    v_addc_co_u32 v59, vcc, 0, v59, vcc
k12_code0:
    s_mov_b64 exec, s[56:57]
    s_cbranch_execz k12_nocode_3
    global_load_dword v51, v[58:59], off
k12_nocode_3:
    s_mov_b64 exec, -1
    s_and_b32 s58, s2, 7
    s_lshr_b32 s59, s2, 3
    s_and_b32 s45, s59, 7
    s_lshr_b32 s57, s59, 3
    s_and_b32 s44, s57, 1
    s_lshl_b32 s52, s58, 1
    s_add_u32 s44, s44, s52
    s_lshr_b32 s57, s57, 1
    v_lshrrev_b32 v2, 6, v0
    v_and_b32 v3, 63, v0
    v_readfirstlane_b32 s30, v2
    v_lshlrev_b32 v1, 4, v3
    v_lshrrev_b32 v60, 5, v3
    v_lshl_add_u32 v60, v2, 1, v60
    v_and_b32 v61, 31, v3
    v_lshlrev_b32 v6, 11, v60
    v_lshl_add_u32 v62, v61, 4, v6
    s_lshl_b32 s52, s2, 14
    v_lshrrev_b32 v56, 3, v3
    v_and_b32 v57, 7, v3
    v_lshrrev_b32 v58, 1, v56
    v_xor_b32 v6, v57, v58
    v_xor_b32 v7, 4, v6
    v_lshl_add_u32 v58, v2, 6, v56
    v_lshlrev_b32 v58, 10, v58
    s_lshl_b32 s47, s45, 18
    v_add_u32 v58, s47, v58
    v_lshl_add_u32 v10, v6, 4, v58
    v_lshl_add_u32 v11, v7, 4, v58
    v_add_u32 v17, 54272, v11
    v_add_u32 v16, 47104, v10
    v_add_u32 v15, 39936, v11
    v_add_u32 v14, 32768, v10
    v_add_u32 v13, 21504, v11
    v_add_u32 v12, 14336, v10
    v_add_u32 v11, 7168, v11
    v_add_u32 v10, 0, v10
    v_lshrrev_b32 v6, 5, v3
    v_bfe_u32 v7, v3, 1, 4
    v_and_b32 v59, 1, v3
    v_lshl_add_u32 v58, v2, 4, v6
    v_lshlrev_b32 v58, 13, v58
    v_lshl_add_u32 v58, v59, 4, v58
    s_lshl_b32 s47, s44, 9
    v_add_u32 v58, s47, v58
    v_xor_b32 v7, v7, v6
    v_xor_b32 v6, 0, v7
    v_lshl_add_u32 v6, v6, 5, v58
    v_add_u32 v18, 0, v6
    v_xor_b32 v6, 2, v7
    v_lshl_add_u32 v6, v6, 5, v58
    v_add_u32 v19, 15360, v6
    v_xor_b32 v6, 0, v7
    v_lshl_add_u32 v6, v6, 5, v58
    v_add_u32 v20, 30720, v6
    v_xor_b32 v6, 2, v7
    v_lshl_add_u32 v6, v6, 5, v58
    v_add_u32 v21, 46080, v6
    v_xor_b32 v6, 4, v7
    v_lshl_add_u32 v6, v6, 5, v58
    v_add_u32 v22, 65536, v6
    v_xor_b32 v6, 6, v7
    v_lshl_add_u32 v6, v6, 5, v58
    v_add_u32 v23, 80896, v6
    v_xor_b32 v6, 4, v7
    v_lshl_add_u32 v6, v6, 5, v58
    v_add_u32 v24, 96256, v6
    v_xor_b32 v6, 6, v7
    v_lshl_add_u32 v6, v6, 5, v58
    v_add_u32 v25, 111616, v6
    s_lshl_b32 s48, s30, 13
    s_mov_b32 s49, 0
    s_mov_b32 s50, 0
    s_waitcnt lgkmcnt(0)
    s_mov_b32 s24, s36
    s_and_b32 s25, s37, 0xffff
    s_mov_b32 s26, 0x400000
    s_mov_b32 s27, 0x00020000
    buffer_load_dwordx4 v[64:67], v62, s[24:27], s52 offen offset:0
    buffer_load_dwordx4 v[68:71], v62, s[24:27], s52 offen offset:512
    buffer_load_dwordx4 v[72:75], v62, s[24:27], s52 offen offset:1024
    buffer_load_dwordx4 v[76:79], v62, s[24:27], s52 offen offset:1536
    s_mov_b32 s16, s38
    s_and_b32 s17, s39, 0xffff
    s_mov_b32 s18, 0x200000
    s_mov_b32 s19, 0x00020000
    s_cmp_eq_u32 s57, 0
    s_cselect_b32 s20, s40, s42
    s_cselect_b32 s21, s41, s43
    s_and_b32 s21, s21, 0xffff
    s_mov_b32 s22, 0x400000
    s_mov_b32 s23, 0x00020000
    s_add_u32 m0, s48, 0
    s_nop 0
    buffer_load_dwordx4 v10, s[16:19], s49 offen offset:0 lds
    buffer_load_dwordx4 v11, s[16:19], s49 offen offset:1024 lds
    buffer_load_dwordx4 v12, s[16:19], s49 offen offset:2048 lds
    buffer_load_dwordx4 v13, s[16:19], s49 offen offset:3072 lds
    s_add_u32 m0, s48, 65536
    s_nop 0
    buffer_load_dwordx4 v18, s[20:23], s50 offen offset:0 lds
    buffer_load_dwordx4 v19, s[20:23], s50 offen offset:1024 lds
    buffer_load_dwordx4 v20, s[20:23], s50 offen offset:2048 lds
    buffer_load_dwordx4 v21, s[20:23], s50 offen offset:3072 lds
    s_mov_b64 s[6:7], s[62:63]
    s_add_u32 s8, s6, 0x0
    s_addc_u32 s9, s7, 0
    s_and_b32 s9, s9, 0xffff
    s_mov_b32 s10, 0x400000
    s_mov_b32 s11, 0x00020000
    s_mov_b32 s12, s4
    s_and_b32 s13, s5, 0xffff
    s_mov_b32 s14, 0x800000
    s_mov_b32 s15, 0x00020000
    s_add_u32 s32, s6, 0x1000000
    s_addc_u32 s33, s7, 0
    s_and_b32 s33, s33, 0xffff
    s_mov_b32 s34, 0x2000000
    s_mov_b32 s35, 0x00020000
    s_mov_b32 s24, s60
    s_and_b32 s25, s61, 0xffff
    s_mov_b32 s26, 0x100
    s_mov_b32 s27, 0x00020000
    s_lshl_b32 s28, s58, 2
    s_and_b32 s31, s59, 3
    s_add_u32 s28, s28, s31
    s_lshr_b32 s29, s59, 2
    s_lshl_b32 s42, s29, 7
    s_sub_u32 s43, 1920, s42
    s_lshl_b32 s31, s30, 4
    s_add_u32 s38, s42, s31
    s_add_u32 s39, s43, s31
    s_lshl_b32 s60, s30, 12
    s_mov_b32 s61, 0
    s_mov_b32 s62, 0
    s_lshl_b32 s47, s44, 1
    s_lshr_b32 s52, s30, 1
    s_add_u32 s47, s47, s52
    s_lshl_b32 s47, s47, 14
    s_lshl_b32 s52, s45, 1
    s_and_b32 s53, s30, 1
    s_add_u32 s52, s52, s53
    s_lshl_b32 s52, s52, 20
    s_add_u32 s47, s47, s52
    s_lshl_b32 s52, s57, 24
    s_add_u32 s47, s47, s52
    s_lshl_b32 s54, s44, 8
    s_lshr_b32 s55, s28, 1
    s_lshl_b32 s55, s55, 8
    s_and_b32 s53, s59, 3
    s_add_u32 s53, s53, 1
    s_cmp_eq_u32 s30, 0
    s_cselect_b32 s53, s53, -1
    s_cselect_b32 s46, 6, -1
    v_lshlrev_b32 v6, 13, v56
    v_lshl_add_u32 v50, v57, 7, v6
    s_lshl_b32 s56, s30, 5
    s_add_u32 s56, s56, s59
    s_lshl_b32 s56, s56, 16
    s_lshl_b32 s52, s58, 10
    s_add_u32 s56, s56, s52
    s_add_u32 s63, s30, 1
    v_mul_u32_u24 v6, 2064, v60
    v_lshl_add_u32 v6, v61, 4, v6
    v_add_u32 v54, 131072, v6
    v_mul_u32_u24 v7, 2064, v57
    v_lshl_add_u32 v7, v56, 4, v7
    v_lshl_add_u32 v7, v2, 9, v7
    v_add_u32 v55, 131072, v7
    v_lshrrev_b32 v7, 2, v56
    v_lshl_add_u32 v7, v2, 3, v7
    v_lshlrev_b32 v7, 17, v7
    v_and_b32 v6, 3, v56
    v_lshl_add_u32 v7, v6, 8, v7
    v_lshl_add_u32 v7, v57, 4, v7
    s_lshr_b32 s52, s2, 1
    s_lshl_b32 s52, s52, 10
    s_and_b32 s31, s2, 1
    s_lshl_b32 s31, s31, 7
    s_add_u32 s52, s52, s31
    v_add_u32 v53, s52, v7
    v_and_b32 v56, 15, v3
    v_lshrrev_b32 v57, 4, v3
    v_lshrrev_b32 v6, 1, v56
    v_xor_b32 v6, v6, v57
    v_and_b32 v7, 1, v2
    v_lshl_add_u32 v7, v7, 7, v56
    v_lshlrev_b32 v7, 7, v7
    v_lshl_add_u32 v26, v6, 4, v7
    v_xor_b32 v27, 64, v26
    v_lshrrev_b32 v6, 2, v56
    v_and_b32 v58, 1, v57
    v_lshl_add_u32 v58, v58, 2, v6
    v_lshl_add_u32 v59, v57, 3, v6
    v_and_b32 v63, 3, v3
    v_lshlrev_b32 v7, 9, v59
    v_lshrrev_b32 v6, 1, v2
    v_lshl_add_u32 v7, v6, 8, v7
    v_lshl_add_u32 v7, v63, 3, v7
    v_add_u32 v7, 65536, v7
    v_lshlrev_b32 v59, 8, v59
    v_lshl_add_u32 v59, v63, 3, v59
    v_add_u32 v59, 98304, v59
    v_xor_b32 v6, 0, v58
    v_lshl_add_u32 v28, v6, 5, v7
    v_lshl_add_u32 v42, v6, 5, v59
    v_xor_b32 v6, 1, v58
    v_lshl_add_u32 v29, v6, 5, v7
    v_lshl_add_u32 v43, v6, 5, v59
    v_xor_b32 v6, 2, v58
    v_lshl_add_u32 v30, v6, 5, v7
    v_lshl_add_u32 v44, v6, 5, v59
    v_xor_b32 v6, 3, v58
    v_lshl_add_u32 v31, v6, 5, v7
    v_lshl_add_u32 v45, v6, 5, v59
    v_xor_b32 v6, 4, v58
    v_lshl_add_u32 v32, v6, 5, v7
    v_lshl_add_u32 v46, v6, 5, v59
    v_xor_b32 v6, 5, v58
    v_lshl_add_u32 v33, v6, 5, v7
    v_lshl_add_u32 v47, v6, 5, v59
    v_xor_b32 v6, 6, v58
    v_lshl_add_u32 v34, v6, 5, v7
    v_lshl_add_u32 v48, v6, 5, v59
    v_xor_b32 v6, 7, v58
    v_lshl_add_u32 v35, v6, 5, v7
    v_lshl_add_u32 v49, v6, 5, v59
    s_lshl_b32 s31, s38, 6
    v_add_u32 v36, s31, v1
    s_lshl_b32 s31, s39, 6
    v_add_u32 v37, s31, v1
    v_bfe_u32 v6, v3, 1, 3
    v_and_b32 v7, 1, v3
    v_lshl_add_u32 v58, v2, 4, v57
    v_lshlrev_b32 v58, 13, v58
    v_lshl_add_u32 v58, v7, 4, v58
    s_lshl_b32 s31, s28, 8
    v_add_u32 v58, s31, v58
    v_xor_b32 v6, v6, v57
    v_xor_b32 v7, 0, v6
    v_lshl_add_u32 v7, v7, 5, v58
    v_add_u32 v38, 0, v7
    v_xor_b32 v7, 0, v6
    v_lshl_add_u32 v7, v7, 5, v58
    v_add_u32 v39, 31744, v7
    v_xor_b32 v7, 4, v6
    v_lshl_add_u32 v7, v7, 5, v58
    v_add_u32 v40, 63488, v7
    v_xor_b32 v7, 4, v6
    v_lshl_add_u32 v7, v7, 5, v58
    v_add_u32 v41, 95232, v7
    v_lshlrev_b32 v6, 2, v57
    v_sub_u32 v4, v56, v6
    v_mov_b32 v5, 0xff800000
    v_mov_b32 v8, 0
    v_mov_b32 v9, 1
    s_lshl_b32 s52, s59, 2
    s_add_u32 s52, s52, s30
    v_and_b32 v6, 1, v3
    v_lshl_add_u32 v6, s52, 1, v6
    s_getpc_b64 s[40:41]
pc_4:
    s_add_u32 s40, s40, k12_qcode-pc_4
    s_addc_u32 s41, s41, 0
    v_lshlrev_b32 v2, 7, v6
    v_mov_b32 v3, s41
    v_add_co_u32 v2, vcc, s40, v2
    s_nop 1
    v_addc_co_u32 v3, vcc, 0, v3, vcc
    v_mov_b32 v56, 0
    v_mov_b32 v57, 0
    v_mov_b32 v58, 0
    v_mov_b32 v59, 0
    s_nop 1
    v_mfma_f32_32x32x16_bf16 a[128:143], v[56:59], v[56:59], 0
    v_mfma_f32_32x32x16_bf16 a[144:159], v[56:59], v[56:59], 0
    v_mfma_f32_32x32x16_bf16 a[160:175], v[56:59], v[56:59], 0
    v_mfma_f32_32x32x16_bf16 a[176:191], v[56:59], v[56:59], 0
    v_mfma_f32_32x32x16_bf16 v[128:143], v[56:59], v[56:59], 0
    v_mfma_f32_32x32x16_bf16 v[144:159], v[56:59], v[56:59], 0
    v_mfma_f32_32x32x16_bf16 v[160:175], v[56:59], v[56:59], 0
    v_mfma_f32_32x32x16_bf16 v[176:191], v[56:59], v[56:59], 0
    v_mfma_f32_32x32x16_bf16 v[192:207], v[56:59], v[56:59], 0
    v_mfma_f32_32x32x16_bf16 v[208:223], v[56:59], v[56:59], 0
    v_mfma_f32_32x32x16_bf16 v[224:239], v[56:59], v[56:59], 0
    v_mfma_f32_32x32x16_bf16 v[240:255], v[56:59], v[56:59], 0
    s_add_u32 m0, s48, 4096
    s_nop 0
    buffer_load_dwordx4 v14, s[16:19], s49 offen offset:0 lds
    buffer_load_dwordx4 v15, s[16:19], s49 offen offset:1024 lds
    buffer_load_dwordx4 v16, s[16:19], s49 offen offset:2048 lds
    buffer_load_dwordx4 v17, s[16:19], s49 offen offset:3072 lds
    s_add_u32 s49, s49, 128
    s_add_u32 m0, s48, 69632
    s_nop 0
    buffer_load_dwordx4 v22, s[20:23], s50 offen offset:0 lds
    buffer_load_dwordx4 v23, s[20:23], s50 offen offset:1024 lds
    buffer_load_dwordx4 v24, s[20:23], s50 offen offset:2048 lds
    buffer_load_dwordx4 v25, s[20:23], s50 offen offset:3072 lds
    s_add_u32 s50, s50, 0x80000
    s_waitcnt vmcnt(16)
    v_lshlrev_b32 v80, 16, v64
    v_and_b32 v81, 0xffff0000, v64
    v_lshlrev_b32 v82, 16, v65
    v_and_b32 v83, 0xffff0000, v65
    v_lshlrev_b32 v84, 16, v66
    v_and_b32 v85, 0xffff0000, v66
    v_lshlrev_b32 v86, 16, v67
    v_and_b32 v87, 0xffff0000, v67
    v_lshlrev_b32 v88, 16, v68
    v_and_b32 v89, 0xffff0000, v68
    v_lshlrev_b32 v90, 16, v69
    v_and_b32 v91, 0xffff0000, v69
    v_lshlrev_b32 v92, 16, v70
    v_and_b32 v93, 0xffff0000, v70
    v_lshlrev_b32 v94, 16, v71
    v_and_b32 v95, 0xffff0000, v71
    v_lshlrev_b32 v96, 16, v72
    v_and_b32 v97, 0xffff0000, v72
    v_lshlrev_b32 v98, 16, v73
    v_and_b32 v99, 0xffff0000, v73
    v_lshlrev_b32 v100, 16, v74
    v_and_b32 v101, 0xffff0000, v74
    v_lshlrev_b32 v102, 16, v75
    v_and_b32 v103, 0xffff0000, v75
    v_lshlrev_b32 v104, 16, v76
    v_and_b32 v105, 0xffff0000, v76
    v_lshlrev_b32 v106, 16, v77
    v_and_b32 v107, 0xffff0000, v77
    v_lshlrev_b32 v108, 16, v78
    v_and_b32 v109, 0xffff0000, v78
    v_lshlrev_b32 v110, 16, v79
    v_and_b32 v111, 0xffff0000, v79
    v_pk_add_f32 v[112:113], v[80:81], v[82:83]
    v_pk_add_f32 v[114:115], v[84:85], v[86:87]
    v_pk_add_f32 v[112:113], v[112:113], v[88:89]
    v_pk_add_f32 v[114:115], v[114:115], v[90:91]
    v_pk_add_f32 v[112:113], v[112:113], v[92:93]
    v_pk_add_f32 v[114:115], v[114:115], v[94:95]
    v_pk_add_f32 v[112:113], v[112:113], v[96:97]
    v_pk_add_f32 v[114:115], v[114:115], v[98:99]
    v_pk_add_f32 v[112:113], v[112:113], v[100:101]
    v_pk_add_f32 v[114:115], v[114:115], v[102:103]
    v_pk_add_f32 v[112:113], v[112:113], v[104:105]
    v_pk_add_f32 v[114:115], v[114:115], v[106:107]
    s_add_u32 m0, s48, 32768
    s_nop 0
    buffer_load_dwordx4 v10, s[16:19], s49 offen offset:0 lds
    buffer_load_dwordx4 v11, s[16:19], s49 offen offset:1024 lds
    buffer_load_dwordx4 v12, s[16:19], s49 offen offset:2048 lds
    buffer_load_dwordx4 v13, s[16:19], s49 offen offset:3072 lds
    v_pk_add_f32 v[112:113], v[112:113], v[108:109]
    v_pk_add_f32 v[114:115], v[114:115], v[110:111]
    v_pk_add_f32 v[112:113], v[112:113], v[114:115]
    v_add_f32 v112, v112, v113
    s_nop 1
    v_add_f32_dpp v112, v112, v112 quad_perm:[1,0,3,2] row_mask:0xf bank_mask:0xf
    s_nop 1
    v_add_f32_dpp v112, v112, v112 quad_perm:[2,3,0,1] row_mask:0xf bank_mask:0xf
    s_nop 1
    v_add_f32_dpp v112, v112, v112 row_half_mirror row_mask:0xf bank_mask:0xf
    s_nop 1
    v_add_f32_dpp v112, v112, v112 row_mirror row_mask:0xf bank_mask:0xf
    v_mov_b32 v114, v112
    s_nop 1
    v_permlane16_swap_b32 v112, v114
    s_nop 1
    v_add_f32 v112, v112, v114
    v_mul_f32 v112, 0xba800000, v112
    v_mov_b32 v113, v112
    v_pk_add_f32 v[114:115], v[80:81], v[112:113]
    v_pk_add_f32 v[118:119], v[82:83], v[112:113]
    v_pk_mul_f32 v[116:117], v[114:115], v[114:115]
    v_pk_fma_f32 v[116:117], v[118:119], v[118:119], v[116:117]
    v_pk_add_f32 v[114:115], v[84:85], v[112:113]
    v_pk_add_f32 v[118:119], v[86:87], v[112:113]
    v_pk_fma_f32 v[116:117], v[114:115], v[114:115], v[116:117]
    v_pk_fma_f32 v[116:117], v[118:119], v[118:119], v[116:117]
    v_pk_add_f32 v[114:115], v[88:89], v[112:113]
    v_pk_add_f32 v[118:119], v[90:91], v[112:113]
    v_pk_fma_f32 v[116:117], v[114:115], v[114:115], v[116:117]
    v_pk_fma_f32 v[116:117], v[118:119], v[118:119], v[116:117]
    v_pk_add_f32 v[114:115], v[92:93], v[112:113]
    v_pk_add_f32 v[118:119], v[94:95], v[112:113]
    v_pk_fma_f32 v[116:117], v[114:115], v[114:115], v[116:117]
    v_pk_fma_f32 v[116:117], v[118:119], v[118:119], v[116:117]
    v_pk_add_f32 v[114:115], v[96:97], v[112:113]
    v_pk_add_f32 v[118:119], v[98:99], v[112:113]
    v_pk_fma_f32 v[116:117], v[114:115], v[114:115], v[116:117]
    v_pk_fma_f32 v[116:117], v[118:119], v[118:119], v[116:117]
    v_pk_add_f32 v[114:115], v[100:101], v[112:113]
    v_pk_add_f32 v[118:119], v[102:103], v[112:113]
    v_pk_fma_f32 v[116:117], v[114:115], v[114:115], v[116:117]
    v_pk_fma_f32 v[116:117], v[118:119], v[118:119], v[116:117]
    v_pk_add_f32 v[114:115], v[104:105], v[112:113]
    s_add_u32 m0, s48, 98304
    s_nop 0
    buffer_load_dwordx4 v18, s[20:23], s50 offen offset:0 lds
    buffer_load_dwordx4 v19, s[20:23], s50 offen offset:1024 lds
    buffer_load_dwordx4 v20, s[20:23], s50 offen offset:2048 lds
    buffer_load_dwordx4 v21, s[20:23], s50 offen offset:3072 lds
    v_pk_add_f32 v[118:119], v[106:107], v[112:113]
    v_pk_fma_f32 v[116:117], v[114:115], v[114:115], v[116:117]
    v_pk_fma_f32 v[116:117], v[118:119], v[118:119], v[116:117]
    v_pk_add_f32 v[114:115], v[108:109], v[112:113]
    v_pk_add_f32 v[118:119], v[110:111], v[112:113]
    v_pk_fma_f32 v[116:117], v[114:115], v[114:115], v[116:117]
    v_pk_fma_f32 v[116:117], v[118:119], v[118:119], v[116:117]
    v_add_f32 v116, v116, v117
    s_nop 1
    v_add_f32_dpp v116, v116, v116 quad_perm:[1,0,3,2] row_mask:0xf bank_mask:0xf
    s_nop 1
    v_add_f32_dpp v116, v116, v116 quad_perm:[2,3,0,1] row_mask:0xf bank_mask:0xf
    s_nop 1
    v_add_f32_dpp v116, v116, v116 row_half_mirror row_mask:0xf bank_mask:0xf
    s_nop 1
    v_add_f32_dpp v116, v116, v116 row_mirror row_mask:0xf bank_mask:0xf
    v_mov_b32 v114, v116
    s_nop 1
    v_permlane16_swap_b32 v116, v114
    s_nop 1
    v_add_f32 v116, v116, v114
    v_mul_f32 v116, 0x3a800000, v116
    v_cvt_pk_bf16_f32 v118, v112, v116
    v_and_b32 v116, 0xffff0000, v118
    v_lshlrev_b32 v118, 16, v118
    v_add_f32 v116, 0x3727c5ac, v116
    v_mov_b32 v119, v118
    v_cvt_pk_bf16_f32 v116, v116, v116
    v_and_b32 v116, 0xffff0000, v116
    v_sqrt_f32 v116, v116
    v_pk_add_f32 v[80:81], v[80:81], v[118:119]
    v_pk_add_f32 v[82:83], v[82:83], v[118:119]
    v_pk_add_f32 v[84:85], v[84:85], v[118:119]
    v_pk_add_f32 v[86:87], v[86:87], v[118:119]
    v_pk_add_f32 v[88:89], v[88:89], v[118:119]
    v_pk_add_f32 v[90:91], v[90:91], v[118:119]
    v_pk_add_f32 v[92:93], v[92:93], v[118:119]
    v_pk_add_f32 v[94:95], v[94:95], v[118:119]
    v_pk_add_f32 v[96:97], v[96:97], v[118:119]
    v_pk_add_f32 v[98:99], v[98:99], v[118:119]
    v_pk_add_f32 v[100:101], v[100:101], v[118:119]
    v_pk_add_f32 v[102:103], v[102:103], v[118:119]
    v_pk_add_f32 v[104:105], v[104:105], v[118:119]
    s_add_u32 m0, s48, 36864
    s_nop 0
    buffer_load_dwordx4 v14, s[16:19], s49 offen offset:0 lds
    buffer_load_dwordx4 v15, s[16:19], s49 offen offset:1024 lds
    buffer_load_dwordx4 v16, s[16:19], s49 offen offset:2048 lds
    buffer_load_dwordx4 v17, s[16:19], s49 offen offset:3072 lds
    s_add_u32 s49, s49, 128
    v_pk_add_f32 v[106:107], v[106:107], v[118:119]
    v_pk_add_f32 v[108:109], v[108:109], v[118:119]
    v_pk_add_f32 v[110:111], v[110:111], v[118:119]
    v_cvt_pk_bf16_f32 v116, v116, v116
    v_and_b32 v116, 0xffff0000, v116
    v_rcp_f32 v116, v116
    v_cvt_pk_bf16_f32 v64, v80, v81
    v_cvt_pk_bf16_f32 v65, v82, v83
    v_cvt_pk_bf16_f32 v66, v84, v85
    v_cvt_pk_bf16_f32 v67, v86, v87
    v_cvt_pk_bf16_f32 v68, v88, v89
    v_cvt_pk_bf16_f32 v69, v90, v91
    v_cvt_pk_bf16_f32 v70, v92, v93
    v_cvt_pk_bf16_f32 v71, v94, v95
    v_cvt_pk_bf16_f32 v72, v96, v97
    v_cvt_pk_bf16_f32 v73, v98, v99
    v_cvt_pk_bf16_f32 v74, v100, v101
    v_cvt_pk_bf16_f32 v75, v102, v103
    v_cvt_pk_bf16_f32 v76, v104, v105
    v_cvt_pk_bf16_f32 v77, v106, v107
    v_cvt_pk_bf16_f32 v78, v108, v109
    v_cvt_pk_bf16_f32 v79, v110, v111
    v_mov_b32 v117, v116
    v_lshlrev_b32 v80, 16, v64
    v_and_b32 v81, 0xffff0000, v64
    v_lshlrev_b32 v82, 16, v65
    v_and_b32 v83, 0xffff0000, v65
    v_lshlrev_b32 v84, 16, v66
    v_and_b32 v85, 0xffff0000, v66
    v_lshlrev_b32 v86, 16, v67
    v_and_b32 v87, 0xffff0000, v67
    v_lshlrev_b32 v88, 16, v68
    v_and_b32 v89, 0xffff0000, v68
    v_lshlrev_b32 v90, 16, v69
    v_and_b32 v91, 0xffff0000, v69
    v_lshlrev_b32 v92, 16, v70
    v_and_b32 v93, 0xffff0000, v70
    v_lshlrev_b32 v94, 16, v71
    v_and_b32 v95, 0xffff0000, v71
    v_lshlrev_b32 v96, 16, v72
    v_and_b32 v97, 0xffff0000, v72
    v_lshlrev_b32 v98, 16, v73
    v_and_b32 v99, 0xffff0000, v73
    v_lshlrev_b32 v100, 16, v74
    s_add_u32 m0, s48, 102400
    s_nop 0
    buffer_load_dwordx4 v22, s[20:23], s50 offen offset:0 lds
    buffer_load_dwordx4 v23, s[20:23], s50 offen offset:1024 lds
    buffer_load_dwordx4 v24, s[20:23], s50 offen offset:2048 lds
    buffer_load_dwordx4 v25, s[20:23], s50 offen offset:3072 lds
    s_add_u32 s50, s50, 0x80000
    v_and_b32 v101, 0xffff0000, v74
    v_lshlrev_b32 v102, 16, v75
    v_and_b32 v103, 0xffff0000, v75
    v_lshlrev_b32 v104, 16, v76
    v_and_b32 v105, 0xffff0000, v76
    v_lshlrev_b32 v106, 16, v77
    v_and_b32 v107, 0xffff0000, v77
    v_lshlrev_b32 v108, 16, v78
    v_and_b32 v109, 0xffff0000, v78
    v_lshlrev_b32 v110, 16, v79
    v_and_b32 v111, 0xffff0000, v79
    v_pk_mul_f32 v[80:81], v[80:81], v[116:117]
    v_pk_mul_f32 v[82:83], v[82:83], v[116:117]
    v_pk_mul_f32 v[84:85], v[84:85], v[116:117]
    v_pk_mul_f32 v[86:87], v[86:87], v[116:117]
    v_pk_mul_f32 v[88:89], v[88:89], v[116:117]
    v_pk_mul_f32 v[90:91], v[90:91], v[116:117]
    v_pk_mul_f32 v[92:93], v[92:93], v[116:117]
    v_pk_mul_f32 v[94:95], v[94:95], v[116:117]
    v_pk_mul_f32 v[96:97], v[96:97], v[116:117]
    v_pk_mul_f32 v[98:99], v[98:99], v[116:117]
    v_pk_mul_f32 v[100:101], v[100:101], v[116:117]
    v_pk_mul_f32 v[102:103], v[102:103], v[116:117]
    v_pk_mul_f32 v[104:105], v[104:105], v[116:117]
    v_pk_mul_f32 v[106:107], v[106:107], v[116:117]
    v_pk_mul_f32 v[108:109], v[108:109], v[116:117]
    v_pk_mul_f32 v[110:111], v[110:111], v[116:117]
    v_cvt_pk_bf16_f32 v64, v80, v81
    v_cvt_pk_bf16_f32 v65, v82, v83
    v_cvt_pk_bf16_f32 v66, v84, v85
    v_cvt_pk_bf16_f32 v67, v86, v87
    v_cvt_pk_bf16_f32 v68, v88, v89
    v_cvt_pk_bf16_f32 v69, v90, v91
    v_cvt_pk_bf16_f32 v70, v92, v93
    v_cvt_pk_bf16_f32 v71, v94, v95
    v_cvt_pk_bf16_f32 v72, v96, v97
    v_cvt_pk_bf16_f32 v73, v98, v99
    v_cvt_pk_bf16_f32 v74, v100, v101
    v_cvt_pk_bf16_f32 v75, v102, v103
    v_cvt_pk_bf16_f32 v76, v104, v105
    v_cvt_pk_bf16_f32 v77, v106, v107
    v_cvt_pk_bf16_f32 v78, v108, v109
    v_cvt_pk_bf16_f32 v79, v110, v111
    ds_write_b128 v54, v[64:67] offset:0
    ds_write_b128 v54, v[68:71] offset:512
    ds_write_b128 v54, v[72:75] offset:1024
    ds_write_b128 v54, v[76:79] offset:1536
    s_waitcnt vmcnt(16) lgkmcnt(0)
    s_barrier
    ds_read_b128 a[64:67], v55 offset:0
    ds_read_b128 a[68:71], v55 offset:128
    ds_read_b128 a[72:75], v55 offset:256
    ds_read_b128 a[76:79], v55 offset:384
    v_add_u32 v54, 4096, v36
    v_add_u32 v55, 4096, v37
    v_mfma_f32_32x32x16_bf16 v[64:79], v[56:59], v[56:59], 0
    v_mfma_f32_32x32x16_bf16 v[80:95], v[56:59], v[56:59], 0
    v_mfma_f32_32x32x16_bf16 v[96:111], v[56:59], v[56:59], 0
    v_mfma_f32_32x32x16_bf16 v[112:127], v[56:59], v[56:59], 0
    s_cmp_ge_u32 s2, 22
    s_cbranch_scc1 k12_nostat_5
    s_lshl_b32 s52, s2, 12
    s_add_u32 s52, s52, 0x3800000
    s_mov_b32 s34, -1
    v_lshlrev_b32 v6, 4, v0
    buffer_store_dwordx4 v[56:59], v6, s[32:35], s52 offen sc1
    s_mov_b32 s34, 0x2000000
k12_nostat_5:
    ds_read_b128 a[192:195], v26 offset:0
    ds_read_b64_tr_b16 a[0:1], v28 offset:0
    ds_read_b128 a[196:199], v27 offset:0
    ds_read_b64_tr_b16 a[2:3], v28 offset:2048
    ds_read_b128 a[200:203], v26 offset:2048
    ds_read_b64_tr_b16 a[4:5], v28 offset:16384
    ds_read_b128 a[204:207], v27 offset:2048
    ds_read_b64_tr_b16 a[6:7], v28 offset:18432
    ds_read_b128 a[208:211], v26 offset:4096
    ds_read_b64_tr_b16 a[8:9], v29 offset:0
    ds_read_b128 a[212:215], v27 offset:4096
    ds_read_b64_tr_b16 a[10:11], v29 offset:2048
    ds_read_b128 a[216:219], v26 offset:6144
    ds_read_b64_tr_b16 a[12:13], v29 offset:16384
    ds_read_b128 a[220:223], v27 offset:6144
    ds_read_b64_tr_b16 a[14:15], v29 offset:18432
    ds_read_b128 a[224:227], v26 offset:8192
    ds_read_b64_tr_b16 a[16:17], v30 offset:0
    ds_read_b128 a[228:231], v27 offset:8192
    ds_read_b64_tr_b16 a[18:19], v30 offset:2048
    ds_read_b128 a[232:235], v26 offset:10240
    ds_read_b64_tr_b16 a[20:21], v30 offset:16384
    ds_read_b128 a[236:239], v27 offset:10240
    ds_read_b64_tr_b16 a[22:23], v30 offset:18432
    ds_read_b128 a[240:243], v26 offset:12288
    ds_read_b64_tr_b16 a[24:25], v31 offset:0
    ds_read_b128 a[244:247], v27 offset:12288
    ds_read_b64_tr_b16 a[26:27], v31 offset:2048
    ds_read_b128 a[248:251], v26 offset:14336
    ds_read_b64_tr_b16 a[28:29], v31 offset:16384
    ds_read_b128 a[252:255], v27 offset:14336
    ds_read_b64_tr_b16 a[30:31], v31 offset:18432
    s_mov_b32 s51, 0
    s_waitcnt lgkmcnt(15)
    s_mov_b32 s52, 0
    buffer_store_dwordx4 a[64:67], v53, s[8:11], s52 offen sc1
    s_mov_b32 s52, 262144
    buffer_store_dwordx4 a[68:71], v53, s[8:11], s52 offen sc1
    s_mov_b32 s52, 524288
    buffer_store_dwordx4 a[72:75], v53, s[8:11], s52 offen sc1
    s_mov_b32 s52, 786432
    buffer_store_dwordx4 a[76:79], v53, s[8:11], s52 offen sc1
    s_waitcnt lgkmcnt(0)
    s_cmp_lg_u32 s57, 0
    s_cbranch_scc1 k12_v_6
k12_loop_8:
    v_mfma_f32_16x16x32_bf16 v[64:67], a[0:3], a[192:195], v[64:67]
    v_mfma_f32_16x16x32_bf16 v[64:67], a[4:7], a[196:199], v[64:67]
    ds_read_b64_tr_b16 a[32:33], v32 offset:0
    v_mfma_f32_16x16x32_bf16 v[80:83], a[4:7], a[204:207], v[80:83]
    v_mfma_f32_16x16x32_bf16 v[80:83], a[0:3], a[200:203], v[80:83]
    ds_read_b64_tr_b16 a[34:35], v32 offset:2048
    v_mfma_f32_16x16x32_bf16 v[96:99], a[0:3], a[208:211], v[96:99]
    s_cmp_eq_u32 s51, s46
    s_cbranch_scc1 k12_ool_10
k12_oolret_11:
    v_mfma_f32_16x16x32_bf16 v[96:99], a[4:7], a[212:215], v[96:99]
    v_mfma_f32_16x16x32_bf16 v[112:115], a[4:7], a[220:223], v[112:115]
    ds_read_b64_tr_b16 a[36:37], v32 offset:16384
    v_mfma_f32_16x16x32_bf16 v[112:115], a[0:3], a[216:219], v[112:115]
    v_mfma_f32_16x16x32_bf16 v[128:131], a[0:3], a[224:227], v[128:131]
    v_mfma_f32_16x16x32_bf16 v[128:131], a[4:7], a[228:231], v[128:131]
    ds_read_b64_tr_b16 a[38:39], v32 offset:18432
    v_mfma_f32_16x16x32_bf16 v[144:147], a[4:7], a[236:239], v[144:147]
    v_mfma_f32_16x16x32_bf16 v[144:147], a[0:3], a[232:235], v[144:147]
    v_mfma_f32_16x16x32_bf16 a[128:131], a[0:3], a[240:243], a[128:131]
    ds_read_b64_tr_b16 a[40:41], v33 offset:0
    v_mfma_f32_16x16x32_bf16 a[128:131], a[4:7], a[244:247], a[128:131]
    v_mfma_f32_16x16x32_bf16 a[160:163], a[4:7], a[252:255], a[160:163]
    v_mfma_f32_16x16x32_bf16 a[160:163], a[0:3], a[248:251], a[160:163]
    ds_read_b64_tr_b16 a[42:43], v33 offset:2048
    v_mfma_f32_16x16x32_bf16 a[164:167], a[8:11], a[248:251], a[164:167]
    v_mfma_f32_16x16x32_bf16 a[164:167], a[12:15], a[252:255], a[164:167]
    v_mfma_f32_16x16x32_bf16 a[132:135], a[12:15], a[244:247], a[132:135]
    ds_read_b64_tr_b16 a[44:45], v33 offset:16384
    v_mfma_f32_16x16x32_bf16 a[132:135], a[8:11], a[240:243], a[132:135]
    v_mfma_f32_16x16x32_bf16 v[240:243], a[8:11], a[232:235], v[240:243]
    v_mfma_f32_16x16x32_bf16 v[240:243], a[12:15], a[236:239], v[240:243]
    ds_read_b64_tr_b16 a[46:47], v33 offset:18432
    v_mfma_f32_16x16x32_bf16 v[224:227], a[12:15], a[228:231], v[224:227]
    v_mfma_f32_16x16x32_bf16 v[224:227], a[8:11], a[224:227], v[224:227]
    ds_read_b64_tr_b16 a[48:49], v34 offset:0
    v_mfma_f32_16x16x32_bf16 v[208:211], a[8:11], a[216:219], v[208:211]
    v_mfma_f32_16x16x32_bf16 v[208:211], a[12:15], a[220:223], v[208:211]
    v_mfma_f32_16x16x32_bf16 v[192:195], a[12:15], a[212:215], v[192:195]
    ds_read_b64_tr_b16 a[50:51], v34 offset:2048
    v_mfma_f32_16x16x32_bf16 v[192:195], a[8:11], a[208:211], v[192:195]
    v_mfma_f32_16x16x32_bf16 v[176:179], a[8:11], a[200:203], v[176:179]
    v_mfma_f32_16x16x32_bf16 v[176:179], a[12:15], a[204:207], v[176:179]
    ds_read_b64_tr_b16 a[52:53], v34 offset:16384
    v_mfma_f32_16x16x32_bf16 v[160:163], a[12:15], a[196:199], v[160:163]
    v_mfma_f32_16x16x32_bf16 v[160:163], a[8:11], a[192:195], v[160:163]
    v_mfma_f32_16x16x32_bf16 v[68:71], a[16:19], a[192:195], v[68:71]
    ds_read_b64_tr_b16 a[54:55], v34 offset:18432
    v_mfma_f32_16x16x32_bf16 v[68:71], a[20:23], a[196:199], v[68:71]
    v_mfma_f32_16x16x32_bf16 v[84:87], a[20:23], a[204:207], v[84:87]
    v_mfma_f32_16x16x32_bf16 v[84:87], a[16:19], a[200:203], v[84:87]
    ds_read_b64_tr_b16 a[56:57], v35 offset:0
    v_mfma_f32_16x16x32_bf16 v[100:103], a[16:19], a[208:211], v[100:103]
    v_mfma_f32_16x16x32_bf16 v[100:103], a[20:23], a[212:215], v[100:103]
    v_mfma_f32_16x16x32_bf16 v[116:119], a[20:23], a[220:223], v[116:119]
    ds_read_b64_tr_b16 a[58:59], v35 offset:2048
    v_mfma_f32_16x16x32_bf16 v[116:119], a[16:19], a[216:219], v[116:119]
    v_mfma_f32_16x16x32_bf16 v[132:135], a[16:19], a[224:227], v[132:135]
    v_mfma_f32_16x16x32_bf16 v[132:135], a[20:23], a[228:231], v[132:135]
    ds_read_b64_tr_b16 a[60:61], v35 offset:16384
    v_mfma_f32_16x16x32_bf16 v[148:151], a[20:23], a[236:239], v[148:151]
    v_mfma_f32_16x16x32_bf16 v[148:151], a[16:19], a[232:235], v[148:151]
    v_mfma_f32_16x16x32_bf16 a[136:139], a[16:19], a[240:243], a[136:139]
    ds_read_b64_tr_b16 a[62:63], v35 offset:18432
    v_mfma_f32_16x16x32_bf16 a[136:139], a[20:23], a[244:247], a[136:139]
    v_mfma_f32_16x16x32_bf16 a[168:171], a[20:23], a[252:255], a[168:171]
    v_mfma_f32_16x16x32_bf16 a[168:171], a[16:19], a[248:251], a[168:171]
    v_mfma_f32_16x16x32_bf16 a[172:175], a[24:27], a[248:251], a[172:175]
    v_mfma_f32_16x16x32_bf16 a[172:175], a[28:31], a[252:255], a[172:175]
    v_mfma_f32_16x16x32_bf16 a[140:143], a[28:31], a[244:247], a[140:143]
    v_mfma_f32_16x16x32_bf16 a[140:143], a[24:27], a[240:243], a[140:143]
    v_mfma_f32_16x16x32_bf16 v[244:247], a[24:27], a[232:235], v[244:247]
    v_mfma_f32_16x16x32_bf16 v[244:247], a[28:31], a[236:239], v[244:247]
    v_mfma_f32_16x16x32_bf16 v[228:231], a[28:31], a[228:231], v[228:231]
    v_mfma_f32_16x16x32_bf16 v[228:231], a[24:27], a[224:227], v[228:231]
    v_mfma_f32_16x16x32_bf16 v[212:215], a[24:27], a[216:219], v[212:215]
    v_mfma_f32_16x16x32_bf16 v[212:215], a[28:31], a[220:223], v[212:215]
    v_mfma_f32_16x16x32_bf16 v[196:199], a[28:31], a[212:215], v[196:199]
    v_mfma_f32_16x16x32_bf16 v[196:199], a[24:27], a[208:211], v[196:199]
    v_mfma_f32_16x16x32_bf16 v[180:183], a[24:27], a[200:203], v[180:183]
    v_mfma_f32_16x16x32_bf16 v[180:183], a[28:31], a[204:207], v[180:183]
    v_mfma_f32_16x16x32_bf16 v[164:167], a[28:31], a[196:199], v[164:167]
    v_mfma_f32_16x16x32_bf16 v[164:167], a[24:27], a[192:195], v[164:167]
    s_waitcnt vmcnt(0) lgkmcnt(0)
    s_cmp_eq_u32 s51, s46
    s_cbranch_scc1 k12_ool_14
k12_oolret_15:
    s_barrier
    v_mfma_f32_16x16x32_bf16 v[72:75], a[32:35], a[192:195], v[72:75]
    s_cmp_ge_u32 s49, 1024
    s_cselect_b32 s18, 0, s18
    s_cselect_b32 s22, 0, s22
    v_mfma_f32_16x16x32_bf16 v[72:75], a[36:39], a[196:199], v[72:75]
    s_add_u32 m0, s48, 0
    ds_read_b128 a[64:67], v26 offset:32768
    v_mfma_f32_16x16x32_bf16 v[88:91], a[36:39], a[204:207], v[88:91]
    buffer_load_dwordx4 v10, s[16:19], s49 offen offset:0 lds
    ds_read_b64_tr_b16 a[0:1], v28 offset:32768
    v_mfma_f32_16x16x32_bf16 v[88:91], a[32:35], a[200:203], v[88:91]
    ds_read_b128 a[68:71], v27 offset:32768
    v_mfma_f32_16x16x32_bf16 v[104:107], a[32:35], a[208:211], v[104:107]
    buffer_load_dwordx4 v11, s[16:19], s49 offen offset:1024 lds
    v_mfma_f32_16x16x32_bf16 v[104:107], a[36:39], a[212:215], v[104:107]
    ds_read_b64_tr_b16 a[2:3], v28 offset:34816
    v_mfma_f32_16x16x32_bf16 v[120:123], a[36:39], a[220:223], v[120:123]
    v_mfma_f32_16x16x32_bf16 v[120:123], a[32:35], a[216:219], v[120:123]
    ds_read_b128 a[72:75], v26 offset:34816
    v_mfma_f32_16x16x32_bf16 v[136:139], a[32:35], a[224:227], v[136:139]
    buffer_load_dwordx4 v12, s[16:19], s49 offen offset:2048 lds
    ds_read_b64_tr_b16 a[4:5], v28 offset:49152
    v_mfma_f32_16x16x32_bf16 v[136:139], a[36:39], a[228:231], v[136:139]
    v_mfma_f32_16x16x32_bf16 v[152:155], a[36:39], a[236:239], v[152:155]
    ds_read_b128 a[76:79], v27 offset:34816
    v_mfma_f32_16x16x32_bf16 v[152:155], a[32:35], a[232:235], v[152:155]
    buffer_load_dwordx4 v13, s[16:19], s49 offen offset:3072 lds
    v_mfma_f32_16x16x32_bf16 a[144:147], a[32:35], a[240:243], a[144:147]
    ds_read_b64_tr_b16 a[6:7], v28 offset:51200
    v_mfma_f32_16x16x32_bf16 a[144:147], a[36:39], a[244:247], a[144:147]
    s_add_u32 m0, s48, 4096
    ds_read_b128 a[80:83], v26 offset:36864
    v_mfma_f32_16x16x32_bf16 a[176:179], a[36:39], a[252:255], a[176:179]
    v_mfma_f32_16x16x32_bf16 a[176:179], a[32:35], a[248:251], a[176:179]
    buffer_load_dwordx4 v14, s[16:19], s49 offen offset:0 lds
    ds_read_b64_tr_b16 a[8:9], v29 offset:32768
    v_mfma_f32_16x16x32_bf16 a[180:183], a[40:43], a[248:251], a[180:183]
    v_mfma_f32_16x16x32_bf16 a[180:183], a[44:47], a[252:255], a[180:183]
    ds_read_b128 a[84:87], v27 offset:36864
    v_mfma_f32_16x16x32_bf16 a[148:151], a[44:47], a[244:247], a[148:151]
    buffer_load_dwordx4 v15, s[16:19], s49 offen offset:1024 lds
    ds_read_b64_tr_b16 a[10:11], v29 offset:34816
    v_mfma_f32_16x16x32_bf16 a[148:151], a[40:43], a[240:243], a[148:151]
    v_mfma_f32_16x16x32_bf16 v[248:251], a[40:43], a[232:235], v[248:251]
    ds_read_b128 a[88:91], v26 offset:38912
    v_mfma_f32_16x16x32_bf16 v[248:251], a[44:47], a[236:239], v[248:251]
    v_mfma_f32_16x16x32_bf16 v[232:235], a[44:47], a[228:231], v[232:235]
    buffer_load_dwordx4 v16, s[16:19], s49 offen offset:2048 lds
    ds_read_b64_tr_b16 a[12:13], v29 offset:49152
    v_mfma_f32_16x16x32_bf16 v[232:235], a[40:43], a[224:227], v[232:235]
    ds_read_b128 a[92:95], v27 offset:38912
    v_mfma_f32_16x16x32_bf16 v[216:219], a[40:43], a[216:219], v[216:219]
    v_mfma_f32_16x16x32_bf16 v[216:219], a[44:47], a[220:223], v[216:219]
    buffer_load_dwordx4 v17, s[16:19], s49 offen offset:3072 lds
    ds_read_b64_tr_b16 a[14:15], v29 offset:51200
    v_mfma_f32_16x16x32_bf16 v[200:203], a[44:47], a[212:215], v[200:203]
    ds_read_b128 a[96:99], v26 offset:40960
    v_mfma_f32_16x16x32_bf16 v[200:203], a[40:43], a[208:211], v[200:203]
    s_add_u32 s49, s49, 128
    v_mfma_f32_16x16x32_bf16 v[184:187], a[40:43], a[200:203], v[184:187]
    s_add_u32 m0, s48, 65536
    ds_read_b64_tr_b16 a[16:17], v30 offset:32768
    v_mfma_f32_16x16x32_bf16 v[184:187], a[44:47], a[204:207], v[184:187]
    buffer_load_dwordx4 v18, s[20:23], s50 offen offset:0 lds
    v_mfma_f32_16x16x32_bf16 v[168:171], a[44:47], a[196:199], v[168:171]
    ds_read_b128 a[100:103], v27 offset:40960
    v_mfma_f32_16x16x32_bf16 v[168:171], a[40:43], a[192:195], v[168:171]
    ds_read_b64_tr_b16 a[18:19], v30 offset:34816
    v_mfma_f32_16x16x32_bf16 v[76:79], a[48:51], a[192:195], v[76:79]
    buffer_load_dwordx4 v19, s[20:23], s50 offen offset:1024 lds
    v_mfma_f32_16x16x32_bf16 v[76:79], a[52:55], a[196:199], v[76:79]
    ds_read_b128 a[104:107], v26 offset:43008
    v_mfma_f32_16x16x32_bf16 v[92:95], a[52:55], a[204:207], v[92:95]
    v_mfma_f32_16x16x32_bf16 v[92:95], a[48:51], a[200:203], v[92:95]
    buffer_load_dwordx4 v20, s[20:23], s50 offen offset:2048 lds
    ds_read_b64_tr_b16 a[20:21], v30 offset:49152
    v_mfma_f32_16x16x32_bf16 v[108:111], a[48:51], a[208:211], v[108:111]
    ds_read_b128 a[108:111], v27 offset:43008
    v_mfma_f32_16x16x32_bf16 v[108:111], a[52:55], a[212:215], v[108:111]
    v_mfma_f32_16x16x32_bf16 v[124:127], a[52:55], a[220:223], v[124:127]
    ds_read_b64_tr_b16 a[22:23], v30 offset:51200
    v_mfma_f32_16x16x32_bf16 v[124:127], a[48:51], a[216:219], v[124:127]
    buffer_load_dwordx4 v21, s[20:23], s50 offen offset:3072 lds
    v_mfma_f32_16x16x32_bf16 v[140:143], a[48:51], a[224:227], v[140:143]
    s_add_u32 m0, s48, 69632
    ds_read_b128 a[112:115], v26 offset:45056
    v_mfma_f32_16x16x32_bf16 v[140:143], a[52:55], a[228:231], v[140:143]
    ds_read_b64_tr_b16 a[24:25], v31 offset:32768
    v_mfma_f32_16x16x32_bf16 v[156:159], a[52:55], a[236:239], v[156:159]
    buffer_load_dwordx4 v22, s[20:23], s50 offen offset:0 lds
    v_mfma_f32_16x16x32_bf16 v[156:159], a[48:51], a[232:235], v[156:159]
    ds_read_b128 a[116:119], v27 offset:45056
    v_mfma_f32_16x16x32_bf16 a[152:155], a[48:51], a[240:243], a[152:155]
    v_mfma_f32_16x16x32_bf16 a[152:155], a[52:55], a[244:247], a[152:155]
    ds_read_b64_tr_b16 a[26:27], v31 offset:34816
    v_mfma_f32_16x16x32_bf16 a[184:187], a[52:55], a[252:255], a[184:187]
    buffer_load_dwordx4 v23, s[20:23], s50 offen offset:1024 lds
    ds_read_b128 a[120:123], v26 offset:47104
    v_mfma_f32_16x16x32_bf16 a[184:187], a[48:51], a[248:251], a[184:187]
    v_mfma_f32_16x16x32_bf16 a[188:191], a[56:59], a[248:251], a[188:191]
    ds_read_b64_tr_b16 a[28:29], v31 offset:49152
    v_mfma_f32_16x16x32_bf16 a[188:191], a[60:63], a[252:255], a[188:191]
    buffer_load_dwordx4 v24, s[20:23], s50 offen offset:2048 lds
    v_mfma_f32_16x16x32_bf16 a[156:159], a[60:63], a[244:247], a[156:159]
    ds_read_b128 a[124:127], v27 offset:47104
    v_mfma_f32_16x16x32_bf16 a[156:159], a[56:59], a[240:243], a[156:159]
    ds_read_b64_tr_b16 a[30:31], v31 offset:51200
    v_mfma_f32_16x16x32_bf16 v[252:255], a[56:59], a[232:235], v[252:255]
    v_mfma_f32_16x16x32_bf16 v[252:255], a[60:63], a[236:239], v[252:255]
    buffer_load_dwordx4 v25, s[20:23], s50 offen offset:3072 lds
    v_mfma_f32_16x16x32_bf16 v[236:239], a[60:63], a[228:231], v[236:239]
    v_mfma_f32_16x16x32_bf16 v[236:239], a[56:59], a[224:227], v[236:239]
    s_add_u32 s50, s50, 0x80000
    v_mfma_f32_16x16x32_bf16 v[220:223], a[56:59], a[216:219], v[220:223]
    v_mfma_f32_16x16x32_bf16 v[220:223], a[60:63], a[220:223], v[220:223]
    s_cmp_eq_u32 s51, s53
    s_cbranch_scc1 k12_ool_16
k12_oolret_17:
    v_mfma_f32_16x16x32_bf16 v[204:207], a[60:63], a[212:215], v[204:207]
    s_cmp_eq_u32 s51, s63
    s_cbranch_scc1 k12_ool_18
k12_oolret_19:
    v_mfma_f32_16x16x32_bf16 v[204:207], a[56:59], a[208:211], v[204:207]
    s_cmp_eq_u32 s51, 6
    s_cbranch_scc1 k12_ool_20
k12_oolret_21:
    v_mfma_f32_16x16x32_bf16 v[188:191], a[56:59], a[200:203], v[188:191]
    v_mfma_f32_16x16x32_bf16 v[188:191], a[60:63], a[204:207], v[188:191]
    s_add_u32 s51, s51, 1
    v_mfma_f32_16x16x32_bf16 v[172:175], a[60:63], a[196:199], v[172:175]
    v_mfma_f32_16x16x32_bf16 v[172:175], a[56:59], a[192:195], v[172:175]
    s_waitcnt lgkmcnt(0)
    s_cmp_eq_u32 s51, 7
    s_cbranch_scc1 k12_last_9
    v_mfma_f32_16x16x32_bf16 v[64:67], a[0:3], a[64:67], v[64:67]
    v_mfma_f32_16x16x32_bf16 v[64:67], a[4:7], a[68:71], v[64:67]
    ds_read_b64_tr_b16 a[32:33], v32 offset:32768
    v_mfma_f32_16x16x32_bf16 v[80:83], a[4:7], a[76:79], v[80:83]
    v_mfma_f32_16x16x32_bf16 v[80:83], a[0:3], a[72:75], v[80:83]
    ds_read_b64_tr_b16 a[34:35], v32 offset:34816
    v_mfma_f32_16x16x32_bf16 v[96:99], a[0:3], a[80:83], v[96:99]
    v_mfma_f32_16x16x32_bf16 v[96:99], a[4:7], a[84:87], v[96:99]
    v_mfma_f32_16x16x32_bf16 v[112:115], a[4:7], a[92:95], v[112:115]
    ds_read_b64_tr_b16 a[36:37], v32 offset:49152
    v_mfma_f32_16x16x32_bf16 v[112:115], a[0:3], a[88:91], v[112:115]
    v_mfma_f32_16x16x32_bf16 v[128:131], a[0:3], a[96:99], v[128:131]
    v_mfma_f32_16x16x32_bf16 v[128:131], a[4:7], a[100:103], v[128:131]
    ds_read_b64_tr_b16 a[38:39], v32 offset:51200
    v_mfma_f32_16x16x32_bf16 v[144:147], a[4:7], a[108:111], v[144:147]
    v_mfma_f32_16x16x32_bf16 v[144:147], a[0:3], a[104:107], v[144:147]
    v_mfma_f32_16x16x32_bf16 a[128:131], a[0:3], a[112:115], a[128:131]
    ds_read_b64_tr_b16 a[40:41], v33 offset:32768
    v_mfma_f32_16x16x32_bf16 a[128:131], a[4:7], a[116:119], a[128:131]
    v_mfma_f32_16x16x32_bf16 a[160:163], a[4:7], a[124:127], a[160:163]
    v_mfma_f32_16x16x32_bf16 a[160:163], a[0:3], a[120:123], a[160:163]
    ds_read_b64_tr_b16 a[42:43], v33 offset:34816
    v_mfma_f32_16x16x32_bf16 a[164:167], a[8:11], a[120:123], a[164:167]
    v_mfma_f32_16x16x32_bf16 a[164:167], a[12:15], a[124:127], a[164:167]
    v_mfma_f32_16x16x32_bf16 a[132:135], a[12:15], a[116:119], a[132:135]
    ds_read_b64_tr_b16 a[44:45], v33 offset:49152
    v_mfma_f32_16x16x32_bf16 a[132:135], a[8:11], a[112:115], a[132:135]
    v_mfma_f32_16x16x32_bf16 v[240:243], a[8:11], a[104:107], v[240:243]
    v_mfma_f32_16x16x32_bf16 v[240:243], a[12:15], a[108:111], v[240:243]
    ds_read_b64_tr_b16 a[46:47], v33 offset:51200
    v_mfma_f32_16x16x32_bf16 v[224:227], a[12:15], a[100:103], v[224:227]
    v_mfma_f32_16x16x32_bf16 v[224:227], a[8:11], a[96:99], v[224:227]
    ds_read_b64_tr_b16 a[48:49], v34 offset:32768
    v_mfma_f32_16x16x32_bf16 v[208:211], a[8:11], a[88:91], v[208:211]
    v_mfma_f32_16x16x32_bf16 v[208:211], a[12:15], a[92:95], v[208:211]
    v_mfma_f32_16x16x32_bf16 v[192:195], a[12:15], a[84:87], v[192:195]
    ds_read_b64_tr_b16 a[50:51], v34 offset:34816
    v_mfma_f32_16x16x32_bf16 v[192:195], a[8:11], a[80:83], v[192:195]
    v_mfma_f32_16x16x32_bf16 v[176:179], a[8:11], a[72:75], v[176:179]
    v_mfma_f32_16x16x32_bf16 v[176:179], a[12:15], a[76:79], v[176:179]
    ds_read_b64_tr_b16 a[52:53], v34 offset:49152
    v_mfma_f32_16x16x32_bf16 v[160:163], a[12:15], a[68:71], v[160:163]
    v_mfma_f32_16x16x32_bf16 v[160:163], a[8:11], a[64:67], v[160:163]
    v_mfma_f32_16x16x32_bf16 v[68:71], a[16:19], a[64:67], v[68:71]
    ds_read_b64_tr_b16 a[54:55], v34 offset:51200
    v_mfma_f32_16x16x32_bf16 v[68:71], a[20:23], a[68:71], v[68:71]
    v_mfma_f32_16x16x32_bf16 v[84:87], a[20:23], a[76:79], v[84:87]
    v_mfma_f32_16x16x32_bf16 v[84:87], a[16:19], a[72:75], v[84:87]
    ds_read_b64_tr_b16 a[56:57], v35 offset:32768
    v_mfma_f32_16x16x32_bf16 v[100:103], a[16:19], a[80:83], v[100:103]
    v_mfma_f32_16x16x32_bf16 v[100:103], a[20:23], a[84:87], v[100:103]
    v_mfma_f32_16x16x32_bf16 v[116:119], a[20:23], a[92:95], v[116:119]
    ds_read_b64_tr_b16 a[58:59], v35 offset:34816
    v_mfma_f32_16x16x32_bf16 v[116:119], a[16:19], a[88:91], v[116:119]
    v_mfma_f32_16x16x32_bf16 v[132:135], a[16:19], a[96:99], v[132:135]
    v_mfma_f32_16x16x32_bf16 v[132:135], a[20:23], a[100:103], v[132:135]
    ds_read_b64_tr_b16 a[60:61], v35 offset:49152
    v_mfma_f32_16x16x32_bf16 v[148:151], a[20:23], a[108:111], v[148:151]
    v_mfma_f32_16x16x32_bf16 v[148:151], a[16:19], a[104:107], v[148:151]
    v_mfma_f32_16x16x32_bf16 a[136:139], a[16:19], a[112:115], a[136:139]
    ds_read_b64_tr_b16 a[62:63], v35 offset:51200
    v_mfma_f32_16x16x32_bf16 a[136:139], a[20:23], a[116:119], a[136:139]
    v_mfma_f32_16x16x32_bf16 a[168:171], a[20:23], a[124:127], a[168:171]
    v_mfma_f32_16x16x32_bf16 a[168:171], a[16:19], a[120:123], a[168:171]
    v_mfma_f32_16x16x32_bf16 a[172:175], a[24:27], a[120:123], a[172:175]
    v_mfma_f32_16x16x32_bf16 a[172:175], a[28:31], a[124:127], a[172:175]
    v_mfma_f32_16x16x32_bf16 a[140:143], a[28:31], a[116:119], a[140:143]
    v_mfma_f32_16x16x32_bf16 a[140:143], a[24:27], a[112:115], a[140:143]
    v_mfma_f32_16x16x32_bf16 v[244:247], a[24:27], a[104:107], v[244:247]
    v_mfma_f32_16x16x32_bf16 v[244:247], a[28:31], a[108:111], v[244:247]
    v_mfma_f32_16x16x32_bf16 v[228:231], a[28:31], a[100:103], v[228:231]
    v_mfma_f32_16x16x32_bf16 v[228:231], a[24:27], a[96:99], v[228:231]
    v_mfma_f32_16x16x32_bf16 v[212:215], a[24:27], a[88:91], v[212:215]
    v_mfma_f32_16x16x32_bf16 v[212:215], a[28:31], a[92:95], v[212:215]
    v_mfma_f32_16x16x32_bf16 v[196:199], a[28:31], a[84:87], v[196:199]
    v_mfma_f32_16x16x32_bf16 v[196:199], a[24:27], a[80:83], v[196:199]
    v_mfma_f32_16x16x32_bf16 v[180:183], a[24:27], a[72:75], v[180:183]
    v_mfma_f32_16x16x32_bf16 v[180:183], a[28:31], a[76:79], v[180:183]
    v_mfma_f32_16x16x32_bf16 v[164:167], a[28:31], a[68:71], v[164:167]
    v_mfma_f32_16x16x32_bf16 v[164:167], a[24:27], a[64:67], v[164:167]
    s_waitcnt vmcnt(0) lgkmcnt(0)
    s_barrier
    v_mfma_f32_16x16x32_bf16 v[72:75], a[32:35], a[64:67], v[72:75]
    v_mfma_f32_16x16x32_bf16 v[72:75], a[36:39], a[68:71], v[72:75]
    s_add_u32 m0, s48, 32768
    ds_read_b128 a[192:195], v26 offset:0
    v_mfma_f32_16x16x32_bf16 v[88:91], a[36:39], a[76:79], v[88:91]
    buffer_load_dwordx4 v10, s[16:19], s49 offen offset:0 lds
    ds_read_b64_tr_b16 a[0:1], v28 offset:0
    v_mfma_f32_16x16x32_bf16 v[88:91], a[32:35], a[72:75], v[88:91]
    ds_read_b128 a[196:199], v27 offset:0
    v_mfma_f32_16x16x32_bf16 v[104:107], a[32:35], a[80:83], v[104:107]
    buffer_load_dwordx4 v11, s[16:19], s49 offen offset:1024 lds
    v_mfma_f32_16x16x32_bf16 v[104:107], a[36:39], a[84:87], v[104:107]
    ds_read_b64_tr_b16 a[2:3], v28 offset:2048
    v_mfma_f32_16x16x32_bf16 v[120:123], a[36:39], a[92:95], v[120:123]
    v_mfma_f32_16x16x32_bf16 v[120:123], a[32:35], a[88:91], v[120:123]
    ds_read_b128 a[200:203], v26 offset:2048
    v_mfma_f32_16x16x32_bf16 v[136:139], a[32:35], a[96:99], v[136:139]
    buffer_load_dwordx4 v12, s[16:19], s49 offen offset:2048 lds
    ds_read_b64_tr_b16 a[4:5], v28 offset:16384
    v_mfma_f32_16x16x32_bf16 v[136:139], a[36:39], a[100:103], v[136:139]
    v_mfma_f32_16x16x32_bf16 v[152:155], a[36:39], a[108:111], v[152:155]
    ds_read_b128 a[204:207], v27 offset:2048
    v_mfma_f32_16x16x32_bf16 v[152:155], a[32:35], a[104:107], v[152:155]
    buffer_load_dwordx4 v13, s[16:19], s49 offen offset:3072 lds
    v_mfma_f32_16x16x32_bf16 a[144:147], a[32:35], a[112:115], a[144:147]
    ds_read_b64_tr_b16 a[6:7], v28 offset:18432
    v_mfma_f32_16x16x32_bf16 a[144:147], a[36:39], a[116:119], a[144:147]
    s_add_u32 m0, s48, 36864
    ds_read_b128 a[208:211], v26 offset:4096
    v_mfma_f32_16x16x32_bf16 a[176:179], a[36:39], a[124:127], a[176:179]
    v_mfma_f32_16x16x32_bf16 a[176:179], a[32:35], a[120:123], a[176:179]
    buffer_load_dwordx4 v14, s[16:19], s49 offen offset:0 lds
    ds_read_b64_tr_b16 a[8:9], v29 offset:0
    v_mfma_f32_16x16x32_bf16 a[180:183], a[40:43], a[120:123], a[180:183]
    v_mfma_f32_16x16x32_bf16 a[180:183], a[44:47], a[124:127], a[180:183]
    ds_read_b128 a[212:215], v27 offset:4096
    v_mfma_f32_16x16x32_bf16 a[148:151], a[44:47], a[116:119], a[148:151]
    buffer_load_dwordx4 v15, s[16:19], s49 offen offset:1024 lds
    ds_read_b64_tr_b16 a[10:11], v29 offset:2048
    v_mfma_f32_16x16x32_bf16 a[148:151], a[40:43], a[112:115], a[148:151]
    v_mfma_f32_16x16x32_bf16 v[248:251], a[40:43], a[104:107], v[248:251]
    ds_read_b128 a[216:219], v26 offset:6144
    v_mfma_f32_16x16x32_bf16 v[248:251], a[44:47], a[108:111], v[248:251]
    v_mfma_f32_16x16x32_bf16 v[232:235], a[44:47], a[100:103], v[232:235]
    buffer_load_dwordx4 v16, s[16:19], s49 offen offset:2048 lds
    ds_read_b64_tr_b16 a[12:13], v29 offset:16384
    v_mfma_f32_16x16x32_bf16 v[232:235], a[40:43], a[96:99], v[232:235]
    ds_read_b128 a[220:223], v27 offset:6144
    v_mfma_f32_16x16x32_bf16 v[216:219], a[40:43], a[88:91], v[216:219]
    v_mfma_f32_16x16x32_bf16 v[216:219], a[44:47], a[92:95], v[216:219]
    buffer_load_dwordx4 v17, s[16:19], s49 offen offset:3072 lds
    ds_read_b64_tr_b16 a[14:15], v29 offset:18432
    v_mfma_f32_16x16x32_bf16 v[200:203], a[44:47], a[84:87], v[200:203]
    ds_read_b128 a[224:227], v26 offset:8192
    v_mfma_f32_16x16x32_bf16 v[200:203], a[40:43], a[80:83], v[200:203]
    s_add_u32 s49, s49, 128
    v_mfma_f32_16x16x32_bf16 v[184:187], a[40:43], a[72:75], v[184:187]
    s_add_u32 m0, s48, 98304
    ds_read_b64_tr_b16 a[16:17], v30 offset:0
    v_mfma_f32_16x16x32_bf16 v[184:187], a[44:47], a[76:79], v[184:187]
    buffer_load_dwordx4 v18, s[20:23], s50 offen offset:0 lds
    v_mfma_f32_16x16x32_bf16 v[168:171], a[44:47], a[68:71], v[168:171]
    ds_read_b128 a[228:231], v27 offset:8192
    v_mfma_f32_16x16x32_bf16 v[168:171], a[40:43], a[64:67], v[168:171]
    ds_read_b64_tr_b16 a[18:19], v30 offset:2048
    v_mfma_f32_16x16x32_bf16 v[76:79], a[48:51], a[64:67], v[76:79]
    buffer_load_dwordx4 v19, s[20:23], s50 offen offset:1024 lds
    v_mfma_f32_16x16x32_bf16 v[76:79], a[52:55], a[68:71], v[76:79]
    ds_read_b128 a[232:235], v26 offset:10240
    v_mfma_f32_16x16x32_bf16 v[92:95], a[52:55], a[76:79], v[92:95]
    v_mfma_f32_16x16x32_bf16 v[92:95], a[48:51], a[72:75], v[92:95]
    buffer_load_dwordx4 v20, s[20:23], s50 offen offset:2048 lds
    ds_read_b64_tr_b16 a[20:21], v30 offset:16384
    v_mfma_f32_16x16x32_bf16 v[108:111], a[48:51], a[80:83], v[108:111]
    ds_read_b128 a[236:239], v27 offset:10240
    v_mfma_f32_16x16x32_bf16 v[108:111], a[52:55], a[84:87], v[108:111]
    v_mfma_f32_16x16x32_bf16 v[124:127], a[52:55], a[92:95], v[124:127]
    ds_read_b64_tr_b16 a[22:23], v30 offset:18432
    v_mfma_f32_16x16x32_bf16 v[124:127], a[48:51], a[88:91], v[124:127]
    buffer_load_dwordx4 v21, s[20:23], s50 offen offset:3072 lds
    v_mfma_f32_16x16x32_bf16 v[140:143], a[48:51], a[96:99], v[140:143]
    s_add_u32 m0, s48, 102400
    ds_read_b128 a[240:243], v26 offset:12288
    v_mfma_f32_16x16x32_bf16 v[140:143], a[52:55], a[100:103], v[140:143]
    ds_read_b64_tr_b16 a[24:25], v31 offset:0
    v_mfma_f32_16x16x32_bf16 v[156:159], a[52:55], a[108:111], v[156:159]
    buffer_load_dwordx4 v22, s[20:23], s50 offen offset:0 lds
    v_mfma_f32_16x16x32_bf16 v[156:159], a[48:51], a[104:107], v[156:159]
    ds_read_b128 a[244:247], v27 offset:12288
    v_mfma_f32_16x16x32_bf16 a[152:155], a[48:51], a[112:115], a[152:155]
    v_mfma_f32_16x16x32_bf16 a[152:155], a[52:55], a[116:119], a[152:155]
    ds_read_b64_tr_b16 a[26:27], v31 offset:2048
    v_mfma_f32_16x16x32_bf16 a[184:187], a[52:55], a[124:127], a[184:187]
    buffer_load_dwordx4 v23, s[20:23], s50 offen offset:1024 lds
    ds_read_b128 a[248:251], v26 offset:14336
    v_mfma_f32_16x16x32_bf16 a[184:187], a[48:51], a[120:123], a[184:187]
    v_mfma_f32_16x16x32_bf16 a[188:191], a[56:59], a[120:123], a[188:191]
    ds_read_b64_tr_b16 a[28:29], v31 offset:16384
    v_mfma_f32_16x16x32_bf16 a[188:191], a[60:63], a[124:127], a[188:191]
    buffer_load_dwordx4 v24, s[20:23], s50 offen offset:2048 lds
    v_mfma_f32_16x16x32_bf16 a[156:159], a[60:63], a[116:119], a[156:159]
    ds_read_b128 a[252:255], v27 offset:14336
    v_mfma_f32_16x16x32_bf16 a[156:159], a[56:59], a[112:115], a[156:159]
    ds_read_b64_tr_b16 a[30:31], v31 offset:18432
    v_mfma_f32_16x16x32_bf16 v[252:255], a[56:59], a[104:107], v[252:255]
    v_mfma_f32_16x16x32_bf16 v[252:255], a[60:63], a[108:111], v[252:255]
    buffer_load_dwordx4 v25, s[20:23], s50 offen offset:3072 lds
    v_mfma_f32_16x16x32_bf16 v[236:239], a[60:63], a[100:103], v[236:239]
    v_mfma_f32_16x16x32_bf16 v[236:239], a[56:59], a[96:99], v[236:239]
    s_add_u32 s50, s50, 0x80000
    v_mfma_f32_16x16x32_bf16 v[220:223], a[56:59], a[88:91], v[220:223]
    v_mfma_f32_16x16x32_bf16 v[220:223], a[60:63], a[92:95], v[220:223]
    s_cmp_eq_u32 s51, s53
    s_cbranch_scc1 k12_ool_22
k12_oolret_23:
    v_mfma_f32_16x16x32_bf16 v[204:207], a[60:63], a[84:87], v[204:207]
    s_cmp_eq_u32 s51, s63
    s_cbranch_scc1 k12_ool_24
k12_oolret_25:
    v_mfma_f32_16x16x32_bf16 v[204:207], a[56:59], a[80:83], v[204:207]
    s_cmp_eq_u32 s51, 5
    s_cbranch_scc1 k12_ool_26
k12_oolret_27:
    v_mfma_f32_16x16x32_bf16 v[188:191], a[56:59], a[72:75], v[188:191]
    v_mfma_f32_16x16x32_bf16 v[188:191], a[60:63], a[76:79], v[188:191]
    s_add_u32 s51, s51, 1
    v_mfma_f32_16x16x32_bf16 v[172:175], a[60:63], a[68:71], v[172:175]
    v_mfma_f32_16x16x32_bf16 v[172:175], a[56:59], a[64:67], v[172:175]
    s_waitcnt lgkmcnt(0)
    s_branch k12_loop_8
k12_last_9:
    v_mfma_f32_16x16x32_bf16 v[64:67], a[0:3], a[64:67], v[64:67]
    buffer_load_dwordx4 a[192:195], v36, s[8:11], s62 offen sc1
    v_mfma_f32_16x16x32_bf16 v[64:67], a[4:7], a[68:71], v[64:67]
    ds_read_b64_tr_b16 a[32:33], v32 offset:32768
    v_mfma_f32_16x16x32_bf16 v[160:163], a[12:15], a[68:71], v[160:163]
    buffer_load_dwordx4 a[196:199], v54, s[8:11], s62 offen sc1
    ds_read_b64_tr_b16 a[34:35], v32 offset:34816
    v_mfma_f32_16x16x32_bf16 v[160:163], a[8:11], a[64:67], v[160:163]
    v_mfma_f32_16x16x32_bf16 v[80:83], a[0:3], a[72:75], v[80:83]
    buffer_load_dwordx4 a[200:203], v37, s[8:11], s62 offen sc1
    v_mfma_f32_16x16x32_bf16 v[80:83], a[4:7], a[76:79], v[80:83]
    ds_read_b64_tr_b16 a[36:37], v32 offset:49152
    v_mfma_f32_16x16x32_bf16 v[176:179], a[12:15], a[76:79], v[176:179]
    buffer_load_dwordx4 a[204:207], v55, s[8:11], s62 offen sc1
    v_mfma_f32_16x16x32_bf16 v[176:179], a[8:11], a[72:75], v[176:179]
    s_add_u32 s62, s62, 0x20000
    buffer_load_dwordx4 a[208:211], v36, s[8:11], s62 offen sc1
    ds_read_b64_tr_b16 a[38:39], v32 offset:51200
    v_mfma_f32_16x16x32_bf16 v[96:99], a[0:3], a[80:83], v[96:99]
    v_mfma_f32_16x16x32_bf16 v[96:99], a[4:7], a[84:87], v[96:99]
    v_cvt_pk_bf16_f32 v64, v64, v65
    v_cvt_pk_bf16_f32 v65, v66, v67
    v_mfma_f32_16x16x32_bf16 v[192:195], a[12:15], a[84:87], v[192:195]
    v_cvt_pk_bf16_f32 v66, v160, v161
    v_cvt_pk_bf16_f32 v67, v162, v163
    v_mfma_f32_16x16x32_bf16 v[192:195], a[8:11], a[80:83], v[192:195]
    buffer_load_dwordx4 a[212:215], v54, s[8:11], s62 offen sc1
    ds_read_b64_tr_b16 a[40:41], v33 offset:32768
    v_mfma_f32_16x16x32_bf16 v[112:115], a[0:3], a[88:91], v[112:115]
    buffer_load_dwordx4 a[216:219], v37, s[8:11], s62 offen sc1
    ds_read_b64_tr_b16 a[42:43], v33 offset:34816
    v_mfma_f32_16x16x32_bf16 v[112:115], a[4:7], a[92:95], v[112:115]
    v_cvt_pk_bf16_f32 v80, v80, v81
    v_cvt_pk_bf16_f32 v81, v82, v83
    v_mfma_f32_16x16x32_bf16 v[208:211], a[12:15], a[92:95], v[208:211]
    v_cvt_pk_bf16_f32 v82, v176, v177
    v_cvt_pk_bf16_f32 v83, v178, v179
    v_mfma_f32_16x16x32_bf16 v[208:211], a[8:11], a[88:91], v[208:211]
    buffer_load_dwordx4 a[220:223], v55, s[8:11], s62 offen sc1
    ds_read_b64_tr_b16 a[44:45], v33 offset:49152
    v_mfma_f32_16x16x32_bf16 v[128:131], a[0:3], a[96:99], v[128:131]
    s_add_u32 s62, s62, 0x20000
    buffer_load_dwordx4 a[224:227], v36, s[8:11], s62 offen sc1
    v_mfma_f32_16x16x32_bf16 v[128:131], a[4:7], a[100:103], v[128:131]
    v_cvt_pk_bf16_f32 v96, v96, v97
    v_cvt_pk_bf16_f32 v97, v98, v99
    v_mfma_f32_16x16x32_bf16 v[224:227], a[12:15], a[100:103], v[224:227]
    buffer_load_dwordx4 a[228:231], v54, s[8:11], s62 offen sc1
    ds_read_b64_tr_b16 a[46:47], v33 offset:51200
    v_mfma_f32_16x16x32_bf16 v[224:227], a[8:11], a[96:99], v[224:227]
    v_cvt_pk_bf16_f32 v98, v192, v193
    v_cvt_pk_bf16_f32 v99, v194, v195
    v_mfma_f32_16x16x32_bf16 v[144:147], a[0:3], a[104:107], v[144:147]
    buffer_load_dwordx4 a[232:235], v37, s[8:11], s62 offen sc1
    ds_read_b64_tr_b16 a[48:49], v34 offset:32768
    v_mfma_f32_16x16x32_bf16 v[144:147], a[4:7], a[108:111], v[144:147]
    v_cvt_pk_bf16_f32 v112, v112, v113
    v_cvt_pk_bf16_f32 v113, v114, v115
    v_mfma_f32_16x16x32_bf16 v[240:243], a[12:15], a[108:111], v[240:243]
    buffer_load_dwordx4 a[236:239], v55, s[8:11], s62 offen sc1
    ds_read_b64_tr_b16 a[50:51], v34 offset:34816
    v_mfma_f32_16x16x32_bf16 v[240:243], a[8:11], a[104:107], v[240:243]
    s_add_u32 s62, s62, 0x20000
    v_cvt_pk_bf16_f32 v114, v208, v209
    v_cvt_pk_bf16_f32 v115, v210, v211
    v_mfma_f32_16x16x32_bf16 a[128:131], a[0:3], a[112:115], a[128:131]
    buffer_load_dwordx4 a[240:243], v36, s[8:11], s62 offen sc1
    ds_read_b64_tr_b16 a[52:53], v34 offset:49152
    v_mfma_f32_16x16x32_bf16 a[128:131], a[4:7], a[116:119], a[128:131]
    v_cvt_pk_bf16_f32 v128, v128, v129
    v_cvt_pk_bf16_f32 v129, v130, v131
    v_mfma_f32_16x16x32_bf16 a[132:135], a[12:15], a[116:119], a[132:135]
    buffer_load_dwordx4 a[244:247], v54, s[8:11], s62 offen sc1
    buffer_load_dwordx4 a[248:251], v37, s[8:11], s62 offen sc1
    v_mfma_f32_16x16x32_bf16 a[132:135], a[8:11], a[112:115], a[132:135]
    v_cvt_pk_bf16_f32 v130, v224, v225
    v_cvt_pk_bf16_f32 v131, v226, v227
    v_mfma_f32_16x16x32_bf16 a[160:163], a[0:3], a[120:123], a[160:163]
    buffer_load_dwordx4 a[252:255], v55, s[8:11], s62 offen sc1
    ds_read_b64_tr_b16 a[54:55], v34 offset:51200
    v_mfma_f32_16x16x32_bf16 a[160:163], a[4:7], a[124:127], a[160:163]
    s_add_u32 s62, s62, 0x20000
    v_cvt_pk_bf16_f32 v144, v144, v145
    v_cvt_pk_bf16_f32 v145, v146, v147
    v_mfma_f32_16x16x32_bf16 a[164:167], a[12:15], a[124:127], a[164:167]
    ds_read_b64_tr_b16 a[56:57], v35 offset:32768
    v_cvt_pk_bf16_f32 v146, v240, v241
    v_mfma_f32_16x16x32_bf16 a[164:167], a[8:11], a[120:123], a[164:167]
    v_cvt_pk_bf16_f32 v147, v242, v243
    v_mfma_f32_16x16x32_bf16 v[68:71], a[16:19], a[64:67], v[68:71]
    s_add_u32 s52, s47, 0
    ds_read_b64_tr_b16 a[58:59], v35 offset:34816
    v_mfma_f32_16x16x32_bf16 v[68:71], a[20:23], a[68:71], v[68:71]
    v_accvgpr_read_b32 v56, a128
    v_accvgpr_read_b32 v57, a129
    v_mfma_f32_16x16x32_bf16 v[164:167], a[28:31], a[68:71], v[164:167]
    v_accvgpr_read_b32 v58, a130
    v_accvgpr_read_b32 v59, a131
    v_mfma_f32_16x16x32_bf16 v[164:167], a[24:27], a[64:67], v[164:167]
    buffer_store_dwordx4 v[64:67], v1, s[32:35], s52 offen offset:0 sc1
    ds_read_b64_tr_b16 a[60:61], v35 offset:49152
    v_mfma_f32_16x16x32_bf16 v[84:87], a[16:19], a[72:75], v[84:87]
    v_accvgpr_read_b32 v60, a132
    v_accvgpr_read_b32 v61, a133
    v_mfma_f32_16x16x32_bf16 v[84:87], a[20:23], a[76:79], v[84:87]
    v_accvgpr_read_b32 v62, a134
    v_accvgpr_read_b32 v63, a135
    v_mfma_f32_16x16x32_bf16 v[180:183], a[28:31], a[76:79], v[180:183]
    v_cvt_pk_bf16_f32 v160, v56, v57
    v_cvt_pk_bf16_f32 v161, v58, v59
    v_mfma_f32_16x16x32_bf16 v[180:183], a[24:27], a[72:75], v[180:183]
    ds_read_b64_tr_b16 a[62:63], v35 offset:51200
    v_cvt_pk_bf16_f32 v162, v60, v61
    v_mfma_f32_16x16x32_bf16 v[100:103], a[16:19], a[80:83], v[100:103]
    v_cvt_pk_bf16_f32 v163, v62, v63
    v_accvgpr_read_b32 v56, a160
    v_mfma_f32_16x16x32_bf16 v[100:103], a[20:23], a[84:87], v[100:103]
    v_accvgpr_read_b32 v57, a161
    v_accvgpr_read_b32 v58, a162
    v_mfma_f32_16x16x32_bf16 v[196:199], a[28:31], a[84:87], v[196:199]
    v_accvgpr_read_b32 v59, a163
    v_accvgpr_read_b32 v60, a164
    v_mfma_f32_16x16x32_bf16 v[196:199], a[24:27], a[80:83], v[196:199]
    s_add_u32 s52, s47, 8192
    v_accvgpr_read_b32 v61, a165
    v_accvgpr_read_b32 v62, a166
    v_mfma_f32_16x16x32_bf16 v[116:119], a[16:19], a[88:91], v[116:119]
    v_accvgpr_read_b32 v63, a167
    v_cvt_pk_bf16_f32 v176, v56, v57
    v_mfma_f32_16x16x32_bf16 v[116:119], a[20:23], a[92:95], v[116:119]
    v_cvt_pk_bf16_f32 v177, v58, v59
    v_cvt_pk_bf16_f32 v68, v68, v69
    v_mfma_f32_16x16x32_bf16 v[212:215], a[28:31], a[92:95], v[212:215]
    v_cvt_pk_bf16_f32 v178, v60, v61
    v_cvt_pk_bf16_f32 v69, v70, v71
    v_mfma_f32_16x16x32_bf16 v[212:215], a[24:27], a[88:91], v[212:215]
    v_cvt_pk_bf16_f32 v179, v62, v63
    v_cvt_pk_bf16_f32 v70, v164, v165
    v_mfma_f32_16x16x32_bf16 v[132:135], a[16:19], a[96:99], v[132:135]
    v_cvt_pk_bf16_f32 v71, v166, v167
    v_cvt_pk_bf16_f32 v84, v84, v85
    v_mfma_f32_16x16x32_bf16 v[132:135], a[20:23], a[100:103], v[132:135]
    buffer_store_dwordx4 v[96:99], v1, s[32:35], s52 offen offset:0 sc1
    v_cvt_pk_bf16_f32 v85, v86, v87
    v_mfma_f32_16x16x32_bf16 v[228:231], a[28:31], a[100:103], v[228:231]
    v_cvt_pk_bf16_f32 v86, v180, v181
    v_cvt_pk_bf16_f32 v87, v182, v183
    v_mfma_f32_16x16x32_bf16 v[228:231], a[24:27], a[96:99], v[228:231]
    v_cvt_pk_bf16_f32 v100, v100, v101
    v_cvt_pk_bf16_f32 v101, v102, v103
    v_mfma_f32_16x16x32_bf16 v[148:151], a[16:19], a[104:107], v[148:151]
    v_cvt_pk_bf16_f32 v102, v196, v197
    v_cvt_pk_bf16_f32 v103, v198, v199
    v_mfma_f32_16x16x32_bf16 v[148:151], a[20:23], a[108:111], v[148:151]
    v_cvt_pk_bf16_f32 v116, v116, v117
    v_cvt_pk_bf16_f32 v117, v118, v119
    v_mfma_f32_16x16x32_bf16 v[244:247], a[28:31], a[108:111], v[244:247]
    v_cvt_pk_bf16_f32 v118, v212, v213
    v_cvt_pk_bf16_f32 v119, v214, v215
    v_mfma_f32_16x16x32_bf16 v[244:247], a[24:27], a[104:107], v[244:247]
    s_add_u32 s52, s47, 524288
    v_mfma_f32_16x16x32_bf16 a[136:139], a[16:19], a[112:115], a[136:139]
    buffer_store_dwordx4 v[128:131], v1, s[32:35], s52 offen offset:0 sc1
    v_mfma_f32_16x16x32_bf16 a[136:139], a[20:23], a[116:119], a[136:139]
    v_cvt_pk_bf16_f32 v132, v132, v133
    v_cvt_pk_bf16_f32 v133, v134, v135
    v_mfma_f32_16x16x32_bf16 a[140:143], a[28:31], a[116:119], a[140:143]
    v_cvt_pk_bf16_f32 v134, v228, v229
    v_cvt_pk_bf16_f32 v135, v230, v231
    v_mfma_f32_16x16x32_bf16 a[140:143], a[24:27], a[112:115], a[140:143]
    v_mfma_f32_16x16x32_bf16 a[168:171], a[16:19], a[120:123], a[168:171]
    s_waitcnt lgkmcnt(0)
    v_mfma_f32_16x16x32_bf16 a[168:171], a[20:23], a[124:127], a[168:171]
    v_cvt_pk_bf16_f32 v148, v148, v149
    v_cvt_pk_bf16_f32 v149, v150, v151
    v_mfma_f32_16x16x32_bf16 a[172:175], a[28:31], a[124:127], a[172:175]
    v_cvt_pk_bf16_f32 v150, v244, v245
    v_cvt_pk_bf16_f32 v151, v246, v247
    v_mfma_f32_16x16x32_bf16 a[172:175], a[24:27], a[120:123], a[172:175]
    v_mfma_f32_16x16x32_bf16 v[72:75], a[32:35], a[64:67], v[72:75]
    v_mfma_f32_16x16x32_bf16 v[72:75], a[36:39], a[68:71], v[72:75]
    v_accvgpr_read_b32 v56, a136
    v_accvgpr_read_b32 v57, a137
    v_mfma_f32_16x16x32_bf16 v[168:171], a[44:47], a[68:71], v[168:171]
    s_add_u32 s52, s47, 532480
    v_accvgpr_read_b32 v58, a138
    v_accvgpr_read_b32 v59, a139
    v_mfma_f32_16x16x32_bf16 v[168:171], a[40:43], a[64:67], v[168:171]
    v_accvgpr_read_b32 v60, a140
    v_accvgpr_read_b32 v61, a141
    v_mfma_f32_16x16x32_bf16 v[88:91], a[32:35], a[72:75], v[88:91]
    v_accvgpr_read_b32 v62, a142
    v_accvgpr_read_b32 v63, a143
    v_mfma_f32_16x16x32_bf16 v[88:91], a[36:39], a[76:79], v[88:91]
    v_cvt_pk_bf16_f32 v164, v56, v57
    v_cvt_pk_bf16_f32 v165, v58, v59
    v_mfma_f32_16x16x32_bf16 v[184:187], a[44:47], a[76:79], v[184:187]
    buffer_store_dwordx4 v[160:163], v1, s[32:35], s52 offen offset:0 sc1
    v_mfma_f32_16x16x32_bf16 v[184:187], a[40:43], a[72:75], v[184:187]
    v_cvt_pk_bf16_f32 v166, v60, v61
    v_cvt_pk_bf16_f32 v167, v62, v63
    v_mfma_f32_16x16x32_bf16 v[104:107], a[32:35], a[80:83], v[104:107]
    v_accvgpr_read_b32 v56, a168
    v_accvgpr_read_b32 v57, a169
    v_mfma_f32_16x16x32_bf16 v[104:107], a[36:39], a[84:87], v[104:107]
    v_accvgpr_read_b32 v58, a170
    v_accvgpr_read_b32 v59, a171
    v_mfma_f32_16x16x32_bf16 v[200:203], a[44:47], a[84:87], v[200:203]
    v_accvgpr_read_b32 v60, a172
    v_accvgpr_read_b32 v61, a173
    v_mfma_f32_16x16x32_bf16 v[200:203], a[40:43], a[80:83], v[200:203]
    v_accvgpr_read_b32 v62, a174
    v_accvgpr_read_b32 v63, a175
    v_mfma_f32_16x16x32_bf16 v[120:123], a[32:35], a[88:91], v[120:123]
    v_cvt_pk_bf16_f32 v180, v56, v57
    v_cvt_pk_bf16_f32 v181, v58, v59
    v_mfma_f32_16x16x32_bf16 v[120:123], a[36:39], a[92:95], v[120:123]
    v_cvt_pk_bf16_f32 v72, v72, v73
    v_cvt_pk_bf16_f32 v182, v60, v61
    v_mfma_f32_16x16x32_bf16 v[216:219], a[44:47], a[92:95], v[216:219]
    s_add_u32 s52, s47, 0
    v_cvt_pk_bf16_f32 v73, v74, v75
    v_cvt_pk_bf16_f32 v183, v62, v63
    v_mfma_f32_16x16x32_bf16 v[216:219], a[40:43], a[88:91], v[216:219]
    v_cvt_pk_bf16_f32 v74, v168, v169
    v_cvt_pk_bf16_f32 v75, v170, v171
    v_mfma_f32_16x16x32_bf16 v[136:139], a[32:35], a[96:99], v[136:139]
    v_cvt_pk_bf16_f32 v88, v88, v89
    v_cvt_pk_bf16_f32 v89, v90, v91
    v_mfma_f32_16x16x32_bf16 v[136:139], a[36:39], a[100:103], v[136:139]
    v_cvt_pk_bf16_f32 v90, v184, v185
    v_cvt_pk_bf16_f32 v91, v186, v187
    v_mfma_f32_16x16x32_bf16 v[232:235], a[44:47], a[100:103], v[232:235]
    buffer_store_dwordx4 v[68:71], v1, s[32:35], s52 offen offset:1024 sc1
    v_mfma_f32_16x16x32_bf16 v[232:235], a[40:43], a[96:99], v[232:235]
    v_cvt_pk_bf16_f32 v104, v104, v105
    v_cvt_pk_bf16_f32 v105, v106, v107
    v_mfma_f32_16x16x32_bf16 v[152:155], a[32:35], a[104:107], v[152:155]
    v_cvt_pk_bf16_f32 v106, v200, v201
    v_cvt_pk_bf16_f32 v107, v202, v203
    v_mfma_f32_16x16x32_bf16 v[152:155], a[36:39], a[108:111], v[152:155]
    v_cvt_pk_bf16_f32 v120, v120, v121
    v_cvt_pk_bf16_f32 v121, v122, v123
    v_mfma_f32_16x16x32_bf16 v[248:251], a[44:47], a[108:111], v[248:251]
    v_cvt_pk_bf16_f32 v122, v216, v217
    v_cvt_pk_bf16_f32 v123, v218, v219
    v_mfma_f32_16x16x32_bf16 v[248:251], a[40:43], a[104:107], v[248:251]
    v_mfma_f32_16x16x32_bf16 a[144:147], a[32:35], a[112:115], a[144:147]
    v_mfma_f32_16x16x32_bf16 a[144:147], a[36:39], a[116:119], a[144:147]
    s_add_u32 s52, s47, 8192
    v_cvt_pk_bf16_f32 v136, v136, v137
    v_cvt_pk_bf16_f32 v137, v138, v139
    v_mfma_f32_16x16x32_bf16 a[148:151], a[44:47], a[116:119], a[148:151]
    v_cvt_pk_bf16_f32 v138, v232, v233
    v_cvt_pk_bf16_f32 v139, v234, v235
    v_mfma_f32_16x16x32_bf16 a[148:151], a[40:43], a[112:115], a[148:151]
    buffer_store_dwordx4 v[100:103], v1, s[32:35], s52 offen offset:1024 sc1
    v_mfma_f32_16x16x32_bf16 a[176:179], a[32:35], a[120:123], a[176:179]
    v_mfma_f32_16x16x32_bf16 a[176:179], a[36:39], a[124:127], a[176:179]
    v_cvt_pk_bf16_f32 v152, v152, v153
    v_cvt_pk_bf16_f32 v153, v154, v155
    v_mfma_f32_16x16x32_bf16 a[180:183], a[44:47], a[124:127], a[180:183]
    v_cvt_pk_bf16_f32 v154, v248, v249
    v_cvt_pk_bf16_f32 v155, v250, v251
    v_mfma_f32_16x16x32_bf16 a[180:183], a[40:43], a[120:123], a[180:183]
    v_mfma_f32_16x16x32_bf16 v[76:79], a[48:51], a[64:67], v[76:79]
    s_waitcnt vmcnt(16)
    s_barrier
    v_mfma_f32_16x16x32_bf16 v[76:79], a[52:55], a[68:71], v[76:79]
    ds_read_b64_tr_b16 a[0:1], v42 offset:32768
    v_accvgpr_read_b32 v56, a144
    v_mfma_f32_16x16x32_bf16 v[172:175], a[60:63], a[68:71], v[172:175]
    v_accvgpr_read_b32 v57, a145
    v_accvgpr_read_b32 v58, a146
    v_mfma_f32_16x16x32_bf16 v[172:175], a[56:59], a[64:67], v[172:175]
    ds_read_b64_tr_b16 a[2:3], v42 offset:33792
    v_accvgpr_read_b32 v59, a147
    v_mfma_f32_16x16x32_bf16 v[92:95], a[48:51], a[72:75], v[92:95]
    v_accvgpr_read_b32 v60, a148
    v_accvgpr_read_b32 v61, a149
    v_mfma_f32_16x16x32_bf16 v[92:95], a[52:55], a[76:79], v[92:95]
    s_add_u32 s52, s47, 524288
    ds_read_b64_tr_b16 a[4:5], v42 offset:40960
    v_accvgpr_read_b32 v62, a150
    v_mfma_f32_16x16x32_bf16 v[188:191], a[60:63], a[76:79], v[188:191]
    v_accvgpr_read_b32 v63, a151
    v_cvt_pk_bf16_f32 v168, v56, v57
    v_mfma_f32_16x16x32_bf16 v[188:191], a[56:59], a[72:75], v[188:191]
    v_cvt_pk_bf16_f32 v169, v58, v59
    v_cvt_pk_bf16_f32 v170, v60, v61
    v_mfma_f32_16x16x32_bf16 v[108:111], a[48:51], a[80:83], v[108:111]
    ds_read_b64_tr_b16 a[6:7], v42 offset:41984
    v_cvt_pk_bf16_f32 v171, v62, v63
    v_mfma_f32_16x16x32_bf16 v[108:111], a[52:55], a[84:87], v[108:111]
    v_accvgpr_read_b32 v56, a176
    v_accvgpr_read_b32 v57, a177
    v_mfma_f32_16x16x32_bf16 v[204:207], a[60:63], a[84:87], v[204:207]
    v_accvgpr_read_b32 v58, a178
    v_accvgpr_read_b32 v59, a179
    v_mfma_f32_16x16x32_bf16 v[204:207], a[56:59], a[80:83], v[204:207]
    ds_read_b64_tr_b16 a[8:9], v43 offset:32768
    v_accvgpr_read_b32 v60, a180
    v_mfma_f32_16x16x32_bf16 v[124:127], a[48:51], a[88:91], v[124:127]
    buffer_store_dwordx4 v[132:135], v1, s[32:35], s52 offen offset:1024 sc1
    v_accvgpr_read_b32 v61, a181
    v_mfma_f32_16x16x32_bf16 v[124:127], a[52:55], a[92:95], v[124:127]
    v_accvgpr_read_b32 v62, a182
    v_accvgpr_read_b32 v63, a183
    v_mfma_f32_16x16x32_bf16 v[220:223], a[60:63], a[92:95], v[220:223]
    ds_read_b64_tr_b16 a[10:11], v43 offset:33792
    v_cvt_pk_bf16_f32 v184, v56, v57
    v_mfma_f32_16x16x32_bf16 v[220:223], a[56:59], a[88:91], v[220:223]
    v_cvt_pk_bf16_f32 v185, v58, v59
    v_cvt_pk_bf16_f32 v76, v76, v77
    v_mfma_f32_16x16x32_bf16 v[140:143], a[48:51], a[96:99], v[140:143]
    s_add_u32 s52, s47, 532480
    v_cvt_pk_bf16_f32 v186, v60, v61
    v_cvt_pk_bf16_f32 v77, v78, v79
    v_mfma_f32_16x16x32_bf16 v[140:143], a[52:55], a[100:103], v[140:143]
    ds_read_b64_tr_b16 a[12:13], v43 offset:40960
    v_cvt_pk_bf16_f32 v187, v62, v63
    v_mfma_f32_16x16x32_bf16 v[236:239], a[60:63], a[100:103], v[236:239]
    v_cvt_pk_bf16_f32 v78, v172, v173
    v_cvt_pk_bf16_f32 v79, v174, v175
    v_mfma_f32_16x16x32_bf16 v[236:239], a[56:59], a[96:99], v[236:239]
    ds_read_b64_tr_b16 a[14:15], v43 offset:41984
    ds_read_b64_tr_b16 a[16:17], v44 offset:32768
    v_mfma_f32_16x16x32_bf16 v[156:159], a[48:51], a[104:107], v[156:159]
    v_cvt_pk_bf16_f32 v92, v92, v93
    v_cvt_pk_bf16_f32 v93, v94, v95
    v_mfma_f32_16x16x32_bf16 v[156:159], a[52:55], a[108:111], v[156:159]
    ds_read_b64_tr_b16 a[18:19], v44 offset:33792
    v_cvt_pk_bf16_f32 v94, v188, v189
    v_mfma_f32_16x16x32_bf16 v[252:255], a[60:63], a[108:111], v[252:255]
    ds_read_b64_tr_b16 a[20:21], v44 offset:40960
    v_cvt_pk_bf16_f32 v95, v190, v191
    v_mfma_f32_16x16x32_bf16 v[252:255], a[56:59], a[104:107], v[252:255]
    ds_read_b64_tr_b16 a[22:23], v44 offset:41984
    v_cvt_pk_bf16_f32 v108, v108, v109
    v_mfma_f32_16x16x32_bf16 a[152:155], a[48:51], a[112:115], a[152:155]
    v_cvt_pk_bf16_f32 v109, v110, v111
    v_cvt_pk_bf16_f32 v110, v204, v205
    v_mfma_f32_16x16x32_bf16 a[152:155], a[52:55], a[116:119], a[152:155]
    ds_read_b64_tr_b16 a[24:25], v45 offset:32768
    v_cvt_pk_bf16_f32 v111, v206, v207
    v_mfma_f32_16x16x32_bf16 a[156:159], a[60:63], a[116:119], a[156:159]
    buffer_store_dwordx4 v[164:167], v1, s[32:35], s52 offen offset:1024 sc1
    ds_read_b64_tr_b16 a[26:27], v45 offset:33792
    v_mfma_f32_16x16x32_bf16 a[156:159], a[56:59], a[112:115], a[156:159]
    ds_read_b64_tr_b16 a[28:29], v45 offset:40960
    v_cvt_pk_bf16_f32 v124, v124, v125
    v_mfma_f32_16x16x32_bf16 a[184:187], a[48:51], a[120:123], a[184:187]
    v_cvt_pk_bf16_f32 v125, v126, v127
    v_cvt_pk_bf16_f32 v126, v220, v221
    v_mfma_f32_16x16x32_bf16 a[184:187], a[52:55], a[124:127], a[184:187]
    ds_read_b64_tr_b16 a[30:31], v45 offset:41984
    v_cvt_pk_bf16_f32 v127, v222, v223
    v_mfma_f32_16x16x32_bf16 a[188:191], a[60:63], a[124:127], a[188:191]
    v_cvt_pk_bf16_f32 v140, v140, v141
    v_cvt_pk_bf16_f32 v141, v142, v143
    v_mfma_f32_16x16x32_bf16 a[188:191], a[56:59], a[120:123], a[188:191]
    v_cvt_pk_bf16_f32 v142, v236, v237
    v_cvt_pk_bf16_f32 v143, v238, v239
    v_cvt_pk_bf16_f32 v156, v156, v157
    v_cvt_pk_bf16_f32 v157, v158, v159
    v_cvt_pk_bf16_f32 v158, v252, v253
    v_cvt_pk_bf16_f32 v159, v254, v255
    v_accvgpr_read_b32 v56, a152
    v_accvgpr_read_b32 v57, a153
    v_accvgpr_read_b32 v58, a154
    v_accvgpr_read_b32 v59, a155
    v_accvgpr_read_b32 v60, a156
    v_accvgpr_read_b32 v61, a157
    v_accvgpr_read_b32 v62, a158
    v_accvgpr_read_b32 v63, a159
    v_cvt_pk_bf16_f32 v172, v56, v57
    v_cvt_pk_bf16_f32 v173, v58, v59
    v_cvt_pk_bf16_f32 v174, v60, v61
    v_cvt_pk_bf16_f32 v175, v62, v63
    v_accvgpr_read_b32 v56, a184
    v_accvgpr_read_b32 v57, a185
    v_accvgpr_read_b32 v58, a186
    v_accvgpr_read_b32 v59, a187
    v_accvgpr_read_b32 v60, a188
    v_accvgpr_read_b32 v61, a189
    v_accvgpr_read_b32 v62, a190
    v_accvgpr_read_b32 v63, a191
    v_cvt_pk_bf16_f32 v188, v56, v57
    v_cvt_pk_bf16_f32 v189, v58, v59
    v_cvt_pk_bf16_f32 v190, v60, v61
    v_cvt_pk_bf16_f32 v191, v62, v63
    s_branch k12_join_7
k12_v_6:
k12_loop_28:
    v_mfma_f32_16x16x32_bf16 v[64:67], a[192:195], a[0:3], v[64:67]
    v_mfma_f32_16x16x32_bf16 v[64:67], a[196:199], a[4:7], v[64:67]
    ds_read_b64_tr_b16 a[32:33], v32 offset:0
    v_mfma_f32_16x16x32_bf16 v[160:163], a[204:207], a[4:7], v[160:163]
    v_mfma_f32_16x16x32_bf16 v[160:163], a[200:203], a[0:3], v[160:163]
    ds_read_b64_tr_b16 a[34:35], v32 offset:2048
    v_mfma_f32_16x16x32_bf16 v[96:99], a[208:211], a[0:3], v[96:99]
    s_cmp_eq_u32 s51, s46
    s_cbranch_scc1 k12_ool_30
k12_oolret_31:
    v_mfma_f32_16x16x32_bf16 v[96:99], a[212:215], a[4:7], v[96:99]
    v_mfma_f32_16x16x32_bf16 v[192:195], a[220:223], a[4:7], v[192:195]
    ds_read_b64_tr_b16 a[36:37], v32 offset:16384
    v_mfma_f32_16x16x32_bf16 v[192:195], a[216:219], a[0:3], v[192:195]
    v_mfma_f32_16x16x32_bf16 v[128:131], a[224:227], a[0:3], v[128:131]
    v_mfma_f32_16x16x32_bf16 v[128:131], a[228:231], a[4:7], v[128:131]
    ds_read_b64_tr_b16 a[38:39], v32 offset:18432
    v_mfma_f32_16x16x32_bf16 v[224:227], a[236:239], a[4:7], v[224:227]
    v_mfma_f32_16x16x32_bf16 v[224:227], a[232:235], a[0:3], v[224:227]
    v_mfma_f32_16x16x32_bf16 a[128:131], a[240:243], a[0:3], a[128:131]
    ds_read_b64_tr_b16 a[40:41], v33 offset:0
    v_mfma_f32_16x16x32_bf16 a[128:131], a[244:247], a[4:7], a[128:131]
    v_mfma_f32_16x16x32_bf16 a[132:135], a[252:255], a[4:7], a[132:135]
    v_mfma_f32_16x16x32_bf16 a[132:135], a[248:251], a[0:3], a[132:135]
    ds_read_b64_tr_b16 a[42:43], v33 offset:2048
    v_mfma_f32_16x16x32_bf16 a[140:143], a[248:251], a[8:11], a[140:143]
    v_mfma_f32_16x16x32_bf16 a[140:143], a[252:255], a[12:15], a[140:143]
    v_mfma_f32_16x16x32_bf16 a[136:139], a[244:247], a[12:15], a[136:139]
    ds_read_b64_tr_b16 a[44:45], v33 offset:16384
    v_mfma_f32_16x16x32_bf16 a[136:139], a[240:243], a[8:11], a[136:139]
    v_mfma_f32_16x16x32_bf16 v[228:231], a[232:235], a[8:11], v[228:231]
    v_mfma_f32_16x16x32_bf16 v[228:231], a[236:239], a[12:15], v[228:231]
    ds_read_b64_tr_b16 a[46:47], v33 offset:18432
    v_mfma_f32_16x16x32_bf16 v[132:135], a[228:231], a[12:15], v[132:135]
    v_mfma_f32_16x16x32_bf16 v[132:135], a[224:227], a[8:11], v[132:135]
    ds_read_b64_tr_b16 a[48:49], v34 offset:0
    v_mfma_f32_16x16x32_bf16 v[196:199], a[216:219], a[8:11], v[196:199]
    v_mfma_f32_16x16x32_bf16 v[196:199], a[220:223], a[12:15], v[196:199]
    v_mfma_f32_16x16x32_bf16 v[100:103], a[212:215], a[12:15], v[100:103]
    ds_read_b64_tr_b16 a[50:51], v34 offset:2048
    v_mfma_f32_16x16x32_bf16 v[100:103], a[208:211], a[8:11], v[100:103]
    v_mfma_f32_16x16x32_bf16 v[164:167], a[200:203], a[8:11], v[164:167]
    v_mfma_f32_16x16x32_bf16 v[164:167], a[204:207], a[12:15], v[164:167]
    ds_read_b64_tr_b16 a[52:53], v34 offset:16384
    v_mfma_f32_16x16x32_bf16 v[68:71], a[196:199], a[12:15], v[68:71]
    v_mfma_f32_16x16x32_bf16 v[68:71], a[192:195], a[8:11], v[68:71]
    v_mfma_f32_16x16x32_bf16 v[72:75], a[192:195], a[16:19], v[72:75]
    ds_read_b64_tr_b16 a[54:55], v34 offset:18432
    v_mfma_f32_16x16x32_bf16 v[72:75], a[196:199], a[20:23], v[72:75]
    v_mfma_f32_16x16x32_bf16 v[168:171], a[204:207], a[20:23], v[168:171]
    v_mfma_f32_16x16x32_bf16 v[168:171], a[200:203], a[16:19], v[168:171]
    ds_read_b64_tr_b16 a[56:57], v35 offset:0
    v_mfma_f32_16x16x32_bf16 v[104:107], a[208:211], a[16:19], v[104:107]
    v_mfma_f32_16x16x32_bf16 v[104:107], a[212:215], a[20:23], v[104:107]
    v_mfma_f32_16x16x32_bf16 v[200:203], a[220:223], a[20:23], v[200:203]
    ds_read_b64_tr_b16 a[58:59], v35 offset:2048
    v_mfma_f32_16x16x32_bf16 v[200:203], a[216:219], a[16:19], v[200:203]
    v_mfma_f32_16x16x32_bf16 v[136:139], a[224:227], a[16:19], v[136:139]
    v_mfma_f32_16x16x32_bf16 v[136:139], a[228:231], a[20:23], v[136:139]
    ds_read_b64_tr_b16 a[60:61], v35 offset:16384
    v_mfma_f32_16x16x32_bf16 v[232:235], a[236:239], a[20:23], v[232:235]
    v_mfma_f32_16x16x32_bf16 v[232:235], a[232:235], a[16:19], v[232:235]
    v_mfma_f32_16x16x32_bf16 a[144:147], a[240:243], a[16:19], a[144:147]
    ds_read_b64_tr_b16 a[62:63], v35 offset:18432
    v_mfma_f32_16x16x32_bf16 a[144:147], a[244:247], a[20:23], a[144:147]
    v_mfma_f32_16x16x32_bf16 a[148:151], a[252:255], a[20:23], a[148:151]
    v_mfma_f32_16x16x32_bf16 a[148:151], a[248:251], a[16:19], a[148:151]
    v_mfma_f32_16x16x32_bf16 a[156:159], a[248:251], a[24:27], a[156:159]
    v_mfma_f32_16x16x32_bf16 a[156:159], a[252:255], a[28:31], a[156:159]
    v_mfma_f32_16x16x32_bf16 a[152:155], a[244:247], a[28:31], a[152:155]
    v_mfma_f32_16x16x32_bf16 a[152:155], a[240:243], a[24:27], a[152:155]
    v_mfma_f32_16x16x32_bf16 v[236:239], a[232:235], a[24:27], v[236:239]
    v_mfma_f32_16x16x32_bf16 v[236:239], a[236:239], a[28:31], v[236:239]
    v_mfma_f32_16x16x32_bf16 v[140:143], a[228:231], a[28:31], v[140:143]
    v_mfma_f32_16x16x32_bf16 v[140:143], a[224:227], a[24:27], v[140:143]
    v_mfma_f32_16x16x32_bf16 v[204:207], a[216:219], a[24:27], v[204:207]
    v_mfma_f32_16x16x32_bf16 v[204:207], a[220:223], a[28:31], v[204:207]
    v_mfma_f32_16x16x32_bf16 v[108:111], a[212:215], a[28:31], v[108:111]
    v_mfma_f32_16x16x32_bf16 v[108:111], a[208:211], a[24:27], v[108:111]
    v_mfma_f32_16x16x32_bf16 v[172:175], a[200:203], a[24:27], v[172:175]
    v_mfma_f32_16x16x32_bf16 v[172:175], a[204:207], a[28:31], v[172:175]
    v_mfma_f32_16x16x32_bf16 v[76:79], a[196:199], a[28:31], v[76:79]
    v_mfma_f32_16x16x32_bf16 v[76:79], a[192:195], a[24:27], v[76:79]
    s_waitcnt vmcnt(0) lgkmcnt(0)
    s_cmp_eq_u32 s51, s46
    s_cbranch_scc1 k12_ool_34
k12_oolret_35:
    s_barrier
    v_mfma_f32_16x16x32_bf16 v[80:83], a[192:195], a[32:35], v[80:83]
    s_cmp_ge_u32 s49, 1024
    s_cselect_b32 s18, 0, s18
    s_cselect_b32 s22, 0, s22
    v_mfma_f32_16x16x32_bf16 v[80:83], a[196:199], a[36:39], v[80:83]
    s_add_u32 m0, s48, 0
    ds_read_b128 a[64:67], v26 offset:32768
    v_mfma_f32_16x16x32_bf16 v[176:179], a[204:207], a[36:39], v[176:179]
    buffer_load_dwordx4 v10, s[16:19], s49 offen offset:0 lds
    ds_read_b64_tr_b16 a[0:1], v28 offset:32768
    v_mfma_f32_16x16x32_bf16 v[176:179], a[200:203], a[32:35], v[176:179]
    ds_read_b128 a[68:71], v27 offset:32768
    v_mfma_f32_16x16x32_bf16 v[112:115], a[208:211], a[32:35], v[112:115]
    buffer_load_dwordx4 v11, s[16:19], s49 offen offset:1024 lds
    v_mfma_f32_16x16x32_bf16 v[112:115], a[212:215], a[36:39], v[112:115]
    ds_read_b64_tr_b16 a[2:3], v28 offset:34816
    v_mfma_f32_16x16x32_bf16 v[208:211], a[220:223], a[36:39], v[208:211]
    v_mfma_f32_16x16x32_bf16 v[208:211], a[216:219], a[32:35], v[208:211]
    ds_read_b128 a[72:75], v26 offset:34816
    v_mfma_f32_16x16x32_bf16 v[144:147], a[224:227], a[32:35], v[144:147]
    buffer_load_dwordx4 v12, s[16:19], s49 offen offset:2048 lds
    ds_read_b64_tr_b16 a[4:5], v28 offset:49152
    v_mfma_f32_16x16x32_bf16 v[144:147], a[228:231], a[36:39], v[144:147]
    v_mfma_f32_16x16x32_bf16 v[240:243], a[236:239], a[36:39], v[240:243]
    ds_read_b128 a[76:79], v27 offset:34816
    v_mfma_f32_16x16x32_bf16 v[240:243], a[232:235], a[32:35], v[240:243]
    buffer_load_dwordx4 v13, s[16:19], s49 offen offset:3072 lds
    v_mfma_f32_16x16x32_bf16 a[160:163], a[240:243], a[32:35], a[160:163]
    ds_read_b64_tr_b16 a[6:7], v28 offset:51200
    v_mfma_f32_16x16x32_bf16 a[160:163], a[244:247], a[36:39], a[160:163]
    s_add_u32 m0, s48, 4096
    ds_read_b128 a[80:83], v26 offset:36864
    v_mfma_f32_16x16x32_bf16 a[164:167], a[252:255], a[36:39], a[164:167]
    v_mfma_f32_16x16x32_bf16 a[164:167], a[248:251], a[32:35], a[164:167]
    buffer_load_dwordx4 v14, s[16:19], s49 offen offset:0 lds
    ds_read_b64_tr_b16 a[8:9], v29 offset:32768
    v_mfma_f32_16x16x32_bf16 a[172:175], a[248:251], a[40:43], a[172:175]
    v_mfma_f32_16x16x32_bf16 a[172:175], a[252:255], a[44:47], a[172:175]
    ds_read_b128 a[84:87], v27 offset:36864
    v_mfma_f32_16x16x32_bf16 a[168:171], a[244:247], a[44:47], a[168:171]
    buffer_load_dwordx4 v15, s[16:19], s49 offen offset:1024 lds
    ds_read_b64_tr_b16 a[10:11], v29 offset:34816
    v_mfma_f32_16x16x32_bf16 a[168:171], a[240:243], a[40:43], a[168:171]
    v_mfma_f32_16x16x32_bf16 v[244:247], a[232:235], a[40:43], v[244:247]
    ds_read_b128 a[88:91], v26 offset:38912
    v_mfma_f32_16x16x32_bf16 v[244:247], a[236:239], a[44:47], v[244:247]
    v_mfma_f32_16x16x32_bf16 v[148:151], a[228:231], a[44:47], v[148:151]
    buffer_load_dwordx4 v16, s[16:19], s49 offen offset:2048 lds
    ds_read_b64_tr_b16 a[12:13], v29 offset:49152
    v_mfma_f32_16x16x32_bf16 v[148:151], a[224:227], a[40:43], v[148:151]
    ds_read_b128 a[92:95], v27 offset:38912
    v_mfma_f32_16x16x32_bf16 v[212:215], a[216:219], a[40:43], v[212:215]
    v_mfma_f32_16x16x32_bf16 v[212:215], a[220:223], a[44:47], v[212:215]
    buffer_load_dwordx4 v17, s[16:19], s49 offen offset:3072 lds
    ds_read_b64_tr_b16 a[14:15], v29 offset:51200
    v_mfma_f32_16x16x32_bf16 v[116:119], a[212:215], a[44:47], v[116:119]
    ds_read_b128 a[96:99], v26 offset:40960
    v_mfma_f32_16x16x32_bf16 v[116:119], a[208:211], a[40:43], v[116:119]
    s_add_u32 s49, s49, 128
    v_mfma_f32_16x16x32_bf16 v[180:183], a[200:203], a[40:43], v[180:183]
    s_add_u32 m0, s48, 65536
    ds_read_b64_tr_b16 a[16:17], v30 offset:32768
    v_mfma_f32_16x16x32_bf16 v[180:183], a[204:207], a[44:47], v[180:183]
    buffer_load_dwordx4 v18, s[20:23], s50 offen offset:0 lds
    v_mfma_f32_16x16x32_bf16 v[84:87], a[196:199], a[44:47], v[84:87]
    ds_read_b128 a[100:103], v27 offset:40960
    v_mfma_f32_16x16x32_bf16 v[84:87], a[192:195], a[40:43], v[84:87]
    ds_read_b64_tr_b16 a[18:19], v30 offset:34816
    v_mfma_f32_16x16x32_bf16 v[88:91], a[192:195], a[48:51], v[88:91]
    buffer_load_dwordx4 v19, s[20:23], s50 offen offset:1024 lds
    v_mfma_f32_16x16x32_bf16 v[88:91], a[196:199], a[52:55], v[88:91]
    ds_read_b128 a[104:107], v26 offset:43008
    v_mfma_f32_16x16x32_bf16 v[184:187], a[204:207], a[52:55], v[184:187]
    v_mfma_f32_16x16x32_bf16 v[184:187], a[200:203], a[48:51], v[184:187]
    buffer_load_dwordx4 v20, s[20:23], s50 offen offset:2048 lds
    ds_read_b64_tr_b16 a[20:21], v30 offset:49152
    v_mfma_f32_16x16x32_bf16 v[120:123], a[208:211], a[48:51], v[120:123]
    ds_read_b128 a[108:111], v27 offset:43008
    v_mfma_f32_16x16x32_bf16 v[120:123], a[212:215], a[52:55], v[120:123]
    v_mfma_f32_16x16x32_bf16 v[216:219], a[220:223], a[52:55], v[216:219]
    ds_read_b64_tr_b16 a[22:23], v30 offset:51200
    v_mfma_f32_16x16x32_bf16 v[216:219], a[216:219], a[48:51], v[216:219]
    buffer_load_dwordx4 v21, s[20:23], s50 offen offset:3072 lds
    v_mfma_f32_16x16x32_bf16 v[152:155], a[224:227], a[48:51], v[152:155]
    s_add_u32 m0, s48, 69632
    ds_read_b128 a[112:115], v26 offset:45056
    v_mfma_f32_16x16x32_bf16 v[152:155], a[228:231], a[52:55], v[152:155]
    ds_read_b64_tr_b16 a[24:25], v31 offset:32768
    v_mfma_f32_16x16x32_bf16 v[248:251], a[236:239], a[52:55], v[248:251]
    buffer_load_dwordx4 v22, s[20:23], s50 offen offset:0 lds
    v_mfma_f32_16x16x32_bf16 v[248:251], a[232:235], a[48:51], v[248:251]
    ds_read_b128 a[116:119], v27 offset:45056
    v_mfma_f32_16x16x32_bf16 a[176:179], a[240:243], a[48:51], a[176:179]
    v_mfma_f32_16x16x32_bf16 a[176:179], a[244:247], a[52:55], a[176:179]
    ds_read_b64_tr_b16 a[26:27], v31 offset:34816
    v_mfma_f32_16x16x32_bf16 a[180:183], a[252:255], a[52:55], a[180:183]
    buffer_load_dwordx4 v23, s[20:23], s50 offen offset:1024 lds
    ds_read_b128 a[120:123], v26 offset:47104
    v_mfma_f32_16x16x32_bf16 a[180:183], a[248:251], a[48:51], a[180:183]
    v_mfma_f32_16x16x32_bf16 a[188:191], a[248:251], a[56:59], a[188:191]
    ds_read_b64_tr_b16 a[28:29], v31 offset:49152
    v_mfma_f32_16x16x32_bf16 a[188:191], a[252:255], a[60:63], a[188:191]
    buffer_load_dwordx4 v24, s[20:23], s50 offen offset:2048 lds
    v_mfma_f32_16x16x32_bf16 a[184:187], a[244:247], a[60:63], a[184:187]
    ds_read_b128 a[124:127], v27 offset:47104
    v_mfma_f32_16x16x32_bf16 a[184:187], a[240:243], a[56:59], a[184:187]
    ds_read_b64_tr_b16 a[30:31], v31 offset:51200
    v_mfma_f32_16x16x32_bf16 v[252:255], a[232:235], a[56:59], v[252:255]
    v_mfma_f32_16x16x32_bf16 v[252:255], a[236:239], a[60:63], v[252:255]
    buffer_load_dwordx4 v25, s[20:23], s50 offen offset:3072 lds
    v_mfma_f32_16x16x32_bf16 v[156:159], a[228:231], a[60:63], v[156:159]
    v_mfma_f32_16x16x32_bf16 v[156:159], a[224:227], a[56:59], v[156:159]
    s_add_u32 s50, s50, 0x80000
    v_mfma_f32_16x16x32_bf16 v[220:223], a[216:219], a[56:59], v[220:223]
    v_mfma_f32_16x16x32_bf16 v[220:223], a[220:223], a[60:63], v[220:223]
    s_cmp_eq_u32 s51, s53
    s_cbranch_scc1 k12_ool_36
k12_oolret_37:
    v_mfma_f32_16x16x32_bf16 v[124:127], a[212:215], a[60:63], v[124:127]
    s_cmp_eq_u32 s51, s63
    s_cbranch_scc1 k12_ool_38
k12_oolret_39:
    v_mfma_f32_16x16x32_bf16 v[124:127], a[208:211], a[56:59], v[124:127]
    s_cmp_eq_u32 s51, 6
    s_cbranch_scc1 k12_ool_40
k12_oolret_41:
    v_mfma_f32_16x16x32_bf16 v[188:191], a[200:203], a[56:59], v[188:191]
    v_mfma_f32_16x16x32_bf16 v[188:191], a[204:207], a[60:63], v[188:191]
    s_add_u32 s51, s51, 1
    v_mfma_f32_16x16x32_bf16 v[92:95], a[196:199], a[60:63], v[92:95]
    v_mfma_f32_16x16x32_bf16 v[92:95], a[192:195], a[56:59], v[92:95]
    s_waitcnt lgkmcnt(0)
    s_cmp_eq_u32 s51, 7
    s_cbranch_scc1 k12_last_29
    v_mfma_f32_16x16x32_bf16 v[64:67], a[64:67], a[0:3], v[64:67]
    v_mfma_f32_16x16x32_bf16 v[64:67], a[68:71], a[4:7], v[64:67]
    ds_read_b64_tr_b16 a[32:33], v32 offset:32768
    v_mfma_f32_16x16x32_bf16 v[160:163], a[76:79], a[4:7], v[160:163]
    v_mfma_f32_16x16x32_bf16 v[160:163], a[72:75], a[0:3], v[160:163]
    ds_read_b64_tr_b16 a[34:35], v32 offset:34816
    v_mfma_f32_16x16x32_bf16 v[96:99], a[80:83], a[0:3], v[96:99]
    v_mfma_f32_16x16x32_bf16 v[96:99], a[84:87], a[4:7], v[96:99]
    v_mfma_f32_16x16x32_bf16 v[192:195], a[92:95], a[4:7], v[192:195]
    ds_read_b64_tr_b16 a[36:37], v32 offset:49152
    v_mfma_f32_16x16x32_bf16 v[192:195], a[88:91], a[0:3], v[192:195]
    v_mfma_f32_16x16x32_bf16 v[128:131], a[96:99], a[0:3], v[128:131]
    v_mfma_f32_16x16x32_bf16 v[128:131], a[100:103], a[4:7], v[128:131]
    ds_read_b64_tr_b16 a[38:39], v32 offset:51200
    v_mfma_f32_16x16x32_bf16 v[224:227], a[108:111], a[4:7], v[224:227]
    v_mfma_f32_16x16x32_bf16 v[224:227], a[104:107], a[0:3], v[224:227]
    v_mfma_f32_16x16x32_bf16 a[128:131], a[112:115], a[0:3], a[128:131]
    ds_read_b64_tr_b16 a[40:41], v33 offset:32768
    v_mfma_f32_16x16x32_bf16 a[128:131], a[116:119], a[4:7], a[128:131]
    v_mfma_f32_16x16x32_bf16 a[132:135], a[124:127], a[4:7], a[132:135]
    v_mfma_f32_16x16x32_bf16 a[132:135], a[120:123], a[0:3], a[132:135]
    ds_read_b64_tr_b16 a[42:43], v33 offset:34816
    v_mfma_f32_16x16x32_bf16 a[140:143], a[120:123], a[8:11], a[140:143]
    v_mfma_f32_16x16x32_bf16 a[140:143], a[124:127], a[12:15], a[140:143]
    v_mfma_f32_16x16x32_bf16 a[136:139], a[116:119], a[12:15], a[136:139]
    ds_read_b64_tr_b16 a[44:45], v33 offset:49152
    v_mfma_f32_16x16x32_bf16 a[136:139], a[112:115], a[8:11], a[136:139]
    v_mfma_f32_16x16x32_bf16 v[228:231], a[104:107], a[8:11], v[228:231]
    v_mfma_f32_16x16x32_bf16 v[228:231], a[108:111], a[12:15], v[228:231]
    ds_read_b64_tr_b16 a[46:47], v33 offset:51200
    v_mfma_f32_16x16x32_bf16 v[132:135], a[100:103], a[12:15], v[132:135]
    v_mfma_f32_16x16x32_bf16 v[132:135], a[96:99], a[8:11], v[132:135]
    ds_read_b64_tr_b16 a[48:49], v34 offset:32768
    v_mfma_f32_16x16x32_bf16 v[196:199], a[88:91], a[8:11], v[196:199]
    v_mfma_f32_16x16x32_bf16 v[196:199], a[92:95], a[12:15], v[196:199]
    v_mfma_f32_16x16x32_bf16 v[100:103], a[84:87], a[12:15], v[100:103]
    ds_read_b64_tr_b16 a[50:51], v34 offset:34816
    v_mfma_f32_16x16x32_bf16 v[100:103], a[80:83], a[8:11], v[100:103]
    v_mfma_f32_16x16x32_bf16 v[164:167], a[72:75], a[8:11], v[164:167]
    v_mfma_f32_16x16x32_bf16 v[164:167], a[76:79], a[12:15], v[164:167]
    ds_read_b64_tr_b16 a[52:53], v34 offset:49152
    v_mfma_f32_16x16x32_bf16 v[68:71], a[68:71], a[12:15], v[68:71]
    v_mfma_f32_16x16x32_bf16 v[68:71], a[64:67], a[8:11], v[68:71]
    v_mfma_f32_16x16x32_bf16 v[72:75], a[64:67], a[16:19], v[72:75]
    ds_read_b64_tr_b16 a[54:55], v34 offset:51200
    v_mfma_f32_16x16x32_bf16 v[72:75], a[68:71], a[20:23], v[72:75]
    v_mfma_f32_16x16x32_bf16 v[168:171], a[76:79], a[20:23], v[168:171]
    v_mfma_f32_16x16x32_bf16 v[168:171], a[72:75], a[16:19], v[168:171]
    ds_read_b64_tr_b16 a[56:57], v35 offset:32768
    v_mfma_f32_16x16x32_bf16 v[104:107], a[80:83], a[16:19], v[104:107]
    v_mfma_f32_16x16x32_bf16 v[104:107], a[84:87], a[20:23], v[104:107]
    v_mfma_f32_16x16x32_bf16 v[200:203], a[92:95], a[20:23], v[200:203]
    ds_read_b64_tr_b16 a[58:59], v35 offset:34816
    v_mfma_f32_16x16x32_bf16 v[200:203], a[88:91], a[16:19], v[200:203]
    v_mfma_f32_16x16x32_bf16 v[136:139], a[96:99], a[16:19], v[136:139]
    v_mfma_f32_16x16x32_bf16 v[136:139], a[100:103], a[20:23], v[136:139]
    ds_read_b64_tr_b16 a[60:61], v35 offset:49152
    v_mfma_f32_16x16x32_bf16 v[232:235], a[108:111], a[20:23], v[232:235]
    v_mfma_f32_16x16x32_bf16 v[232:235], a[104:107], a[16:19], v[232:235]
    v_mfma_f32_16x16x32_bf16 a[144:147], a[112:115], a[16:19], a[144:147]
    ds_read_b64_tr_b16 a[62:63], v35 offset:51200
    v_mfma_f32_16x16x32_bf16 a[144:147], a[116:119], a[20:23], a[144:147]
    v_mfma_f32_16x16x32_bf16 a[148:151], a[124:127], a[20:23], a[148:151]
    v_mfma_f32_16x16x32_bf16 a[148:151], a[120:123], a[16:19], a[148:151]
    v_mfma_f32_16x16x32_bf16 a[156:159], a[120:123], a[24:27], a[156:159]
    v_mfma_f32_16x16x32_bf16 a[156:159], a[124:127], a[28:31], a[156:159]
    v_mfma_f32_16x16x32_bf16 a[152:155], a[116:119], a[28:31], a[152:155]
    v_mfma_f32_16x16x32_bf16 a[152:155], a[112:115], a[24:27], a[152:155]
    v_mfma_f32_16x16x32_bf16 v[236:239], a[104:107], a[24:27], v[236:239]
    v_mfma_f32_16x16x32_bf16 v[236:239], a[108:111], a[28:31], v[236:239]
    v_mfma_f32_16x16x32_bf16 v[140:143], a[100:103], a[28:31], v[140:143]
    v_mfma_f32_16x16x32_bf16 v[140:143], a[96:99], a[24:27], v[140:143]
    v_mfma_f32_16x16x32_bf16 v[204:207], a[88:91], a[24:27], v[204:207]
    v_mfma_f32_16x16x32_bf16 v[204:207], a[92:95], a[28:31], v[204:207]
    v_mfma_f32_16x16x32_bf16 v[108:111], a[84:87], a[28:31], v[108:111]
    v_mfma_f32_16x16x32_bf16 v[108:111], a[80:83], a[24:27], v[108:111]
    v_mfma_f32_16x16x32_bf16 v[172:175], a[72:75], a[24:27], v[172:175]
    v_mfma_f32_16x16x32_bf16 v[172:175], a[76:79], a[28:31], v[172:175]
    v_mfma_f32_16x16x32_bf16 v[76:79], a[68:71], a[28:31], v[76:79]
    v_mfma_f32_16x16x32_bf16 v[76:79], a[64:67], a[24:27], v[76:79]
    s_waitcnt vmcnt(0) lgkmcnt(0)
    s_barrier
    v_mfma_f32_16x16x32_bf16 v[80:83], a[64:67], a[32:35], v[80:83]
    v_mfma_f32_16x16x32_bf16 v[80:83], a[68:71], a[36:39], v[80:83]
    s_add_u32 m0, s48, 32768
    ds_read_b128 a[192:195], v26 offset:0
    v_mfma_f32_16x16x32_bf16 v[176:179], a[76:79], a[36:39], v[176:179]
    buffer_load_dwordx4 v10, s[16:19], s49 offen offset:0 lds
    ds_read_b64_tr_b16 a[0:1], v28 offset:0
    v_mfma_f32_16x16x32_bf16 v[176:179], a[72:75], a[32:35], v[176:179]
    ds_read_b128 a[196:199], v27 offset:0
    v_mfma_f32_16x16x32_bf16 v[112:115], a[80:83], a[32:35], v[112:115]
    buffer_load_dwordx4 v11, s[16:19], s49 offen offset:1024 lds
    v_mfma_f32_16x16x32_bf16 v[112:115], a[84:87], a[36:39], v[112:115]
    ds_read_b64_tr_b16 a[2:3], v28 offset:2048
    v_mfma_f32_16x16x32_bf16 v[208:211], a[92:95], a[36:39], v[208:211]
    v_mfma_f32_16x16x32_bf16 v[208:211], a[88:91], a[32:35], v[208:211]
    ds_read_b128 a[200:203], v26 offset:2048
    v_mfma_f32_16x16x32_bf16 v[144:147], a[96:99], a[32:35], v[144:147]
    buffer_load_dwordx4 v12, s[16:19], s49 offen offset:2048 lds
    ds_read_b64_tr_b16 a[4:5], v28 offset:16384
    v_mfma_f32_16x16x32_bf16 v[144:147], a[100:103], a[36:39], v[144:147]
    v_mfma_f32_16x16x32_bf16 v[240:243], a[108:111], a[36:39], v[240:243]
    ds_read_b128 a[204:207], v27 offset:2048
    v_mfma_f32_16x16x32_bf16 v[240:243], a[104:107], a[32:35], v[240:243]
    buffer_load_dwordx4 v13, s[16:19], s49 offen offset:3072 lds
    v_mfma_f32_16x16x32_bf16 a[160:163], a[112:115], a[32:35], a[160:163]
    ds_read_b64_tr_b16 a[6:7], v28 offset:18432
    v_mfma_f32_16x16x32_bf16 a[160:163], a[116:119], a[36:39], a[160:163]
    s_add_u32 m0, s48, 36864
    ds_read_b128 a[208:211], v26 offset:4096
    v_mfma_f32_16x16x32_bf16 a[164:167], a[124:127], a[36:39], a[164:167]
    v_mfma_f32_16x16x32_bf16 a[164:167], a[120:123], a[32:35], a[164:167]
    buffer_load_dwordx4 v14, s[16:19], s49 offen offset:0 lds
    ds_read_b64_tr_b16 a[8:9], v29 offset:0
    v_mfma_f32_16x16x32_bf16 a[172:175], a[120:123], a[40:43], a[172:175]
    v_mfma_f32_16x16x32_bf16 a[172:175], a[124:127], a[44:47], a[172:175]
    ds_read_b128 a[212:215], v27 offset:4096
    v_mfma_f32_16x16x32_bf16 a[168:171], a[116:119], a[44:47], a[168:171]
    buffer_load_dwordx4 v15, s[16:19], s49 offen offset:1024 lds
    ds_read_b64_tr_b16 a[10:11], v29 offset:2048
    v_mfma_f32_16x16x32_bf16 a[168:171], a[112:115], a[40:43], a[168:171]
    v_mfma_f32_16x16x32_bf16 v[244:247], a[104:107], a[40:43], v[244:247]
    ds_read_b128 a[216:219], v26 offset:6144
    v_mfma_f32_16x16x32_bf16 v[244:247], a[108:111], a[44:47], v[244:247]
    v_mfma_f32_16x16x32_bf16 v[148:151], a[100:103], a[44:47], v[148:151]
    buffer_load_dwordx4 v16, s[16:19], s49 offen offset:2048 lds
    ds_read_b64_tr_b16 a[12:13], v29 offset:16384
    v_mfma_f32_16x16x32_bf16 v[148:151], a[96:99], a[40:43], v[148:151]
    ds_read_b128 a[220:223], v27 offset:6144
    v_mfma_f32_16x16x32_bf16 v[212:215], a[88:91], a[40:43], v[212:215]
    v_mfma_f32_16x16x32_bf16 v[212:215], a[92:95], a[44:47], v[212:215]
    buffer_load_dwordx4 v17, s[16:19], s49 offen offset:3072 lds
    ds_read_b64_tr_b16 a[14:15], v29 offset:18432
    v_mfma_f32_16x16x32_bf16 v[116:119], a[84:87], a[44:47], v[116:119]
    ds_read_b128 a[224:227], v26 offset:8192
    v_mfma_f32_16x16x32_bf16 v[116:119], a[80:83], a[40:43], v[116:119]
    s_add_u32 s49, s49, 128
    v_mfma_f32_16x16x32_bf16 v[180:183], a[72:75], a[40:43], v[180:183]
    s_add_u32 m0, s48, 98304
    ds_read_b64_tr_b16 a[16:17], v30 offset:0
    v_mfma_f32_16x16x32_bf16 v[180:183], a[76:79], a[44:47], v[180:183]
    buffer_load_dwordx4 v18, s[20:23], s50 offen offset:0 lds
    v_mfma_f32_16x16x32_bf16 v[84:87], a[68:71], a[44:47], v[84:87]
    ds_read_b128 a[228:231], v27 offset:8192
    v_mfma_f32_16x16x32_bf16 v[84:87], a[64:67], a[40:43], v[84:87]
    ds_read_b64_tr_b16 a[18:19], v30 offset:2048
    v_mfma_f32_16x16x32_bf16 v[88:91], a[64:67], a[48:51], v[88:91]
    buffer_load_dwordx4 v19, s[20:23], s50 offen offset:1024 lds
    v_mfma_f32_16x16x32_bf16 v[88:91], a[68:71], a[52:55], v[88:91]
    ds_read_b128 a[232:235], v26 offset:10240
    v_mfma_f32_16x16x32_bf16 v[184:187], a[76:79], a[52:55], v[184:187]
    v_mfma_f32_16x16x32_bf16 v[184:187], a[72:75], a[48:51], v[184:187]
    buffer_load_dwordx4 v20, s[20:23], s50 offen offset:2048 lds
    ds_read_b64_tr_b16 a[20:21], v30 offset:16384
    v_mfma_f32_16x16x32_bf16 v[120:123], a[80:83], a[48:51], v[120:123]
    ds_read_b128 a[236:239], v27 offset:10240
    v_mfma_f32_16x16x32_bf16 v[120:123], a[84:87], a[52:55], v[120:123]
    v_mfma_f32_16x16x32_bf16 v[216:219], a[92:95], a[52:55], v[216:219]
    ds_read_b64_tr_b16 a[22:23], v30 offset:18432
    v_mfma_f32_16x16x32_bf16 v[216:219], a[88:91], a[48:51], v[216:219]
    buffer_load_dwordx4 v21, s[20:23], s50 offen offset:3072 lds
    v_mfma_f32_16x16x32_bf16 v[152:155], a[96:99], a[48:51], v[152:155]
    s_add_u32 m0, s48, 102400
    ds_read_b128 a[240:243], v26 offset:12288
    v_mfma_f32_16x16x32_bf16 v[152:155], a[100:103], a[52:55], v[152:155]
    ds_read_b64_tr_b16 a[24:25], v31 offset:0
    v_mfma_f32_16x16x32_bf16 v[248:251], a[108:111], a[52:55], v[248:251]
    buffer_load_dwordx4 v22, s[20:23], s50 offen offset:0 lds
    v_mfma_f32_16x16x32_bf16 v[248:251], a[104:107], a[48:51], v[248:251]
    ds_read_b128 a[244:247], v27 offset:12288
    v_mfma_f32_16x16x32_bf16 a[176:179], a[112:115], a[48:51], a[176:179]
    v_mfma_f32_16x16x32_bf16 a[176:179], a[116:119], a[52:55], a[176:179]
    ds_read_b64_tr_b16 a[26:27], v31 offset:2048
    v_mfma_f32_16x16x32_bf16 a[180:183], a[124:127], a[52:55], a[180:183]
    buffer_load_dwordx4 v23, s[20:23], s50 offen offset:1024 lds
    ds_read_b128 a[248:251], v26 offset:14336
    v_mfma_f32_16x16x32_bf16 a[180:183], a[120:123], a[48:51], a[180:183]
    v_mfma_f32_16x16x32_bf16 a[188:191], a[120:123], a[56:59], a[188:191]
    ds_read_b64_tr_b16 a[28:29], v31 offset:16384
    v_mfma_f32_16x16x32_bf16 a[188:191], a[124:127], a[60:63], a[188:191]
    buffer_load_dwordx4 v24, s[20:23], s50 offen offset:2048 lds
    v_mfma_f32_16x16x32_bf16 a[184:187], a[116:119], a[60:63], a[184:187]
    ds_read_b128 a[252:255], v27 offset:14336
    v_mfma_f32_16x16x32_bf16 a[184:187], a[112:115], a[56:59], a[184:187]
    ds_read_b64_tr_b16 a[30:31], v31 offset:18432
    v_mfma_f32_16x16x32_bf16 v[252:255], a[104:107], a[56:59], v[252:255]
    v_mfma_f32_16x16x32_bf16 v[252:255], a[108:111], a[60:63], v[252:255]
    buffer_load_dwordx4 v25, s[20:23], s50 offen offset:3072 lds
    v_mfma_f32_16x16x32_bf16 v[156:159], a[100:103], a[60:63], v[156:159]
    v_mfma_f32_16x16x32_bf16 v[156:159], a[96:99], a[56:59], v[156:159]
    s_add_u32 s50, s50, 0x80000
    v_mfma_f32_16x16x32_bf16 v[220:223], a[88:91], a[56:59], v[220:223]
    v_mfma_f32_16x16x32_bf16 v[220:223], a[92:95], a[60:63], v[220:223]
    s_cmp_eq_u32 s51, s53
    s_cbranch_scc1 k12_ool_42
k12_oolret_43:
    v_mfma_f32_16x16x32_bf16 v[124:127], a[84:87], a[60:63], v[124:127]
    s_cmp_eq_u32 s51, s63
    s_cbranch_scc1 k12_ool_44
k12_oolret_45:
    v_mfma_f32_16x16x32_bf16 v[124:127], a[80:83], a[56:59], v[124:127]
    s_cmp_eq_u32 s51, 5
    s_cbranch_scc1 k12_ool_46
k12_oolret_47:
    v_mfma_f32_16x16x32_bf16 v[188:191], a[72:75], a[56:59], v[188:191]
    v_mfma_f32_16x16x32_bf16 v[188:191], a[76:79], a[60:63], v[188:191]
    s_add_u32 s51, s51, 1
    v_mfma_f32_16x16x32_bf16 v[92:95], a[68:71], a[60:63], v[92:95]
    v_mfma_f32_16x16x32_bf16 v[92:95], a[64:67], a[56:59], v[92:95]
    s_waitcnt lgkmcnt(0)
    s_branch k12_loop_28
k12_last_29:
    v_mfma_f32_16x16x32_bf16 v[64:67], a[64:67], a[0:3], v[64:67]
    buffer_load_dwordx4 a[192:195], v36, s[8:11], s62 offen sc1
    v_mfma_f32_16x16x32_bf16 v[64:67], a[68:71], a[4:7], v[64:67]
    ds_read_b64_tr_b16 a[32:33], v32 offset:32768
    v_mfma_f32_16x16x32_bf16 v[160:163], a[76:79], a[4:7], v[160:163]
    buffer_load_dwordx4 a[196:199], v54, s[8:11], s62 offen sc1
    ds_read_b64_tr_b16 a[34:35], v32 offset:34816
    v_mfma_f32_16x16x32_bf16 v[160:163], a[72:75], a[0:3], v[160:163]
    v_mfma_f32_16x16x32_bf16 v[96:99], a[80:83], a[0:3], v[96:99]
    buffer_load_dwordx4 a[200:203], v37, s[8:11], s62 offen sc1
    v_mfma_f32_16x16x32_bf16 v[96:99], a[84:87], a[4:7], v[96:99]
    ds_read_b64_tr_b16 a[36:37], v32 offset:49152
    v_mfma_f32_16x16x32_bf16 v[192:195], a[92:95], a[4:7], v[192:195]
    buffer_load_dwordx4 a[204:207], v55, s[8:11], s62 offen sc1
    v_mfma_f32_16x16x32_bf16 v[192:195], a[88:91], a[0:3], v[192:195]
    s_add_u32 s62, s62, 0x20000
    buffer_load_dwordx4 a[208:211], v36, s[8:11], s62 offen sc1
    ds_read_b64_tr_b16 a[38:39], v32 offset:51200
    v_mfma_f32_16x16x32_bf16 v[128:131], a[96:99], a[0:3], v[128:131]
    v_mfma_f32_16x16x32_bf16 v[128:131], a[100:103], a[4:7], v[128:131]
    v_cvt_pk_bf16_f32 v64, v64, v65
    v_cvt_pk_bf16_f32 v65, v66, v67
    v_mfma_f32_16x16x32_bf16 v[224:227], a[108:111], a[4:7], v[224:227]
    v_cvt_pk_bf16_f32 v66, v160, v161
    v_cvt_pk_bf16_f32 v67, v162, v163
    v_mfma_f32_16x16x32_bf16 v[224:227], a[104:107], a[0:3], v[224:227]
    buffer_load_dwordx4 a[212:215], v54, s[8:11], s62 offen sc1
    ds_read_b64_tr_b16 a[40:41], v33 offset:32768
    v_mfma_f32_16x16x32_bf16 a[128:131], a[112:115], a[0:3], a[128:131]
    buffer_load_dwordx4 a[216:219], v37, s[8:11], s62 offen sc1
    ds_read_b64_tr_b16 a[42:43], v33 offset:34816
    v_mfma_f32_16x16x32_bf16 a[128:131], a[116:119], a[4:7], a[128:131]
    v_cvt_pk_bf16_f32 v96, v96, v97
    v_cvt_pk_bf16_f32 v97, v98, v99
    v_mfma_f32_16x16x32_bf16 a[132:135], a[124:127], a[4:7], a[132:135]
    v_cvt_pk_bf16_f32 v98, v192, v193
    v_cvt_pk_bf16_f32 v99, v194, v195
    v_mfma_f32_16x16x32_bf16 a[132:135], a[120:123], a[0:3], a[132:135]
    buffer_load_dwordx4 a[220:223], v55, s[8:11], s62 offen sc1
    ds_read_b64_tr_b16 a[44:45], v33 offset:49152
    v_mfma_f32_16x16x32_bf16 v[68:71], a[64:67], a[8:11], v[68:71]
    s_add_u32 s62, s62, 0x20000
    buffer_load_dwordx4 a[224:227], v36, s[8:11], s62 offen sc1
    v_mfma_f32_16x16x32_bf16 v[68:71], a[68:71], a[12:15], v[68:71]
    v_cvt_pk_bf16_f32 v128, v128, v129
    v_cvt_pk_bf16_f32 v129, v130, v131
    v_mfma_f32_16x16x32_bf16 v[164:167], a[76:79], a[12:15], v[164:167]
    buffer_load_dwordx4 a[228:231], v54, s[8:11], s62 offen sc1
    ds_read_b64_tr_b16 a[46:47], v33 offset:51200
    v_mfma_f32_16x16x32_bf16 v[164:167], a[72:75], a[8:11], v[164:167]
    v_cvt_pk_bf16_f32 v130, v224, v225
    v_cvt_pk_bf16_f32 v131, v226, v227
    v_mfma_f32_16x16x32_bf16 v[100:103], a[80:83], a[8:11], v[100:103]
    buffer_load_dwordx4 a[232:235], v37, s[8:11], s62 offen sc1
    ds_read_b64_tr_b16 a[48:49], v34 offset:32768
    v_mfma_f32_16x16x32_bf16 v[100:103], a[84:87], a[12:15], v[100:103]
    v_accvgpr_read_b32 v56, a128
    v_accvgpr_read_b32 v57, a129
    v_mfma_f32_16x16x32_bf16 v[196:199], a[92:95], a[12:15], v[196:199]
    buffer_load_dwordx4 a[236:239], v55, s[8:11], s62 offen sc1
    ds_read_b64_tr_b16 a[50:51], v34 offset:34816
    v_mfma_f32_16x16x32_bf16 v[196:199], a[88:91], a[8:11], v[196:199]
    s_add_u32 s62, s62, 0x20000
    v_accvgpr_read_b32 v58, a130
    v_accvgpr_read_b32 v59, a131
    v_mfma_f32_16x16x32_bf16 v[132:135], a[96:99], a[8:11], v[132:135]
    v_accvgpr_read_b32 v60, a132
    v_accvgpr_read_b32 v61, a133
    v_mfma_f32_16x16x32_bf16 v[132:135], a[100:103], a[12:15], v[132:135]
    v_accvgpr_read_b32 v62, a134
    v_accvgpr_read_b32 v63, a135
    v_mfma_f32_16x16x32_bf16 v[228:231], a[108:111], a[12:15], v[228:231]
    buffer_load_dwordx4 a[240:243], v36, s[8:11], s62 offen sc1
    ds_read_b64_tr_b16 a[52:53], v34 offset:49152
    v_mfma_f32_16x16x32_bf16 v[228:231], a[104:107], a[8:11], v[228:231]
    v_cvt_pk_bf16_f32 v160, v56, v57
    v_cvt_pk_bf16_f32 v161, v58, v59
    v_mfma_f32_16x16x32_bf16 a[136:139], a[112:115], a[8:11], a[136:139]
    v_cvt_pk_bf16_f32 v68, v68, v69
    v_cvt_pk_bf16_f32 v162, v60, v61
    v_mfma_f32_16x16x32_bf16 a[136:139], a[116:119], a[12:15], a[136:139]
    buffer_load_dwordx4 a[244:247], v54, s[8:11], s62 offen sc1
    v_cvt_pk_bf16_f32 v69, v70, v71
    v_mfma_f32_16x16x32_bf16 a[140:143], a[124:127], a[12:15], a[140:143]
    v_cvt_pk_bf16_f32 v163, v62, v63
    v_cvt_pk_bf16_f32 v70, v164, v165
    v_mfma_f32_16x16x32_bf16 a[140:143], a[120:123], a[8:11], a[140:143]
    buffer_load_dwordx4 a[248:251], v37, s[8:11], s62 offen sc1
    v_cvt_pk_bf16_f32 v71, v166, v167
    v_mfma_f32_16x16x32_bf16 v[72:75], a[64:67], a[16:19], v[72:75]
    ds_read_b64_tr_b16 a[54:55], v34 offset:51200
    v_cvt_pk_bf16_f32 v100, v100, v101
    v_mfma_f32_16x16x32_bf16 v[72:75], a[68:71], a[20:23], v[72:75]
    buffer_load_dwordx4 a[252:255], v55, s[8:11], s62 offen sc1
    v_cvt_pk_bf16_f32 v101, v102, v103
    v_mfma_f32_16x16x32_bf16 v[168:171], a[76:79], a[20:23], v[168:171]
    s_add_u32 s62, s62, 0x20000
    ds_read_b64_tr_b16 a[56:57], v35 offset:32768
    v_cvt_pk_bf16_f32 v102, v196, v197
    v_mfma_f32_16x16x32_bf16 v[168:171], a[72:75], a[16:19], v[168:171]
    s_add_u32 s52, s47, 0
    ds_read_b64_tr_b16 a[58:59], v35 offset:34816
    v_cvt_pk_bf16_f32 v103, v198, v199
    v_mfma_f32_16x16x32_bf16 v[104:107], a[80:83], a[16:19], v[104:107]
    v_cvt_pk_bf16_f32 v132, v132, v133
    v_cvt_pk_bf16_f32 v133, v134, v135
    v_mfma_f32_16x16x32_bf16 v[104:107], a[84:87], a[20:23], v[104:107]
    v_cvt_pk_bf16_f32 v134, v228, v229
    v_cvt_pk_bf16_f32 v135, v230, v231
    v_mfma_f32_16x16x32_bf16 v[200:203], a[92:95], a[20:23], v[200:203]
    buffer_store_dwordx4 v[64:67], v1, s[32:35], s52 offen offset:0 sc1
    ds_read_b64_tr_b16 a[60:61], v35 offset:49152
    v_mfma_f32_16x16x32_bf16 v[200:203], a[88:91], a[16:19], v[200:203]
    v_accvgpr_read_b32 v56, a136
    v_accvgpr_read_b32 v57, a137
    v_mfma_f32_16x16x32_bf16 v[136:139], a[96:99], a[16:19], v[136:139]
    ds_read_b64_tr_b16 a[62:63], v35 offset:51200
    v_accvgpr_read_b32 v58, a138
    v_mfma_f32_16x16x32_bf16 v[136:139], a[100:103], a[20:23], v[136:139]
    v_accvgpr_read_b32 v59, a139
    v_accvgpr_read_b32 v60, a140
    v_mfma_f32_16x16x32_bf16 v[232:235], a[108:111], a[20:23], v[232:235]
    v_accvgpr_read_b32 v61, a141
    v_accvgpr_read_b32 v62, a142
    v_mfma_f32_16x16x32_bf16 v[232:235], a[104:107], a[16:19], v[232:235]
    s_add_u32 s52, s47, 8192
    v_accvgpr_read_b32 v63, a143
    v_cvt_pk_bf16_f32 v164, v56, v57
    v_mfma_f32_16x16x32_bf16 a[144:147], a[112:115], a[16:19], a[144:147]
    v_cvt_pk_bf16_f32 v165, v58, v59
    v_cvt_pk_bf16_f32 v72, v72, v73
    v_mfma_f32_16x16x32_bf16 a[144:147], a[116:119], a[20:23], a[144:147]
    v_cvt_pk_bf16_f32 v166, v60, v61
    v_cvt_pk_bf16_f32 v73, v74, v75
    v_mfma_f32_16x16x32_bf16 a[148:151], a[124:127], a[20:23], a[148:151]
    v_cvt_pk_bf16_f32 v167, v62, v63
    v_cvt_pk_bf16_f32 v74, v168, v169
    v_mfma_f32_16x16x32_bf16 a[148:151], a[120:123], a[16:19], a[148:151]
    v_cvt_pk_bf16_f32 v75, v170, v171
    v_cvt_pk_bf16_f32 v104, v104, v105
    v_mfma_f32_16x16x32_bf16 v[76:79], a[64:67], a[24:27], v[76:79]
    v_cvt_pk_bf16_f32 v105, v106, v107
    v_cvt_pk_bf16_f32 v106, v200, v201
    v_mfma_f32_16x16x32_bf16 v[76:79], a[68:71], a[28:31], v[76:79]
    buffer_store_dwordx4 v[96:99], v1, s[32:35], s52 offen offset:0 sc1
    v_mfma_f32_16x16x32_bf16 v[172:175], a[76:79], a[28:31], v[172:175]
    v_cvt_pk_bf16_f32 v107, v202, v203
    v_cvt_pk_bf16_f32 v136, v136, v137
    v_mfma_f32_16x16x32_bf16 v[172:175], a[72:75], a[24:27], v[172:175]
    v_cvt_pk_bf16_f32 v137, v138, v139
    v_cvt_pk_bf16_f32 v138, v232, v233
    v_mfma_f32_16x16x32_bf16 v[108:111], a[80:83], a[24:27], v[108:111]
    v_cvt_pk_bf16_f32 v139, v234, v235
    v_mfma_f32_16x16x32_bf16 v[108:111], a[84:87], a[28:31], v[108:111]
    v_accvgpr_read_b32 v56, a144
    v_accvgpr_read_b32 v57, a145
    v_mfma_f32_16x16x32_bf16 v[204:207], a[92:95], a[28:31], v[204:207]
    v_accvgpr_read_b32 v58, a146
    v_accvgpr_read_b32 v59, a147
    v_mfma_f32_16x16x32_bf16 v[204:207], a[88:91], a[24:27], v[204:207]
    s_add_u32 s52, s47, 524288
    v_accvgpr_read_b32 v60, a148
    v_accvgpr_read_b32 v61, a149
    v_mfma_f32_16x16x32_bf16 v[140:143], a[96:99], a[24:27], v[140:143]
    v_accvgpr_read_b32 v62, a150
    v_accvgpr_read_b32 v63, a151
    v_mfma_f32_16x16x32_bf16 v[140:143], a[100:103], a[28:31], v[140:143]
    v_cvt_pk_bf16_f32 v168, v56, v57
    v_cvt_pk_bf16_f32 v169, v58, v59
    v_mfma_f32_16x16x32_bf16 v[236:239], a[108:111], a[28:31], v[236:239]
    v_cvt_pk_bf16_f32 v76, v76, v77
    v_cvt_pk_bf16_f32 v170, v60, v61
    v_mfma_f32_16x16x32_bf16 v[236:239], a[104:107], a[24:27], v[236:239]
    buffer_store_dwordx4 v[128:131], v1, s[32:35], s52 offen offset:0 sc1
    v_mfma_f32_16x16x32_bf16 a[152:155], a[112:115], a[24:27], a[152:155]
    s_waitcnt lgkmcnt(0)
    v_cvt_pk_bf16_f32 v77, v78, v79
    v_cvt_pk_bf16_f32 v171, v62, v63
    v_mfma_f32_16x16x32_bf16 a[152:155], a[116:119], a[28:31], a[152:155]
    v_cvt_pk_bf16_f32 v78, v172, v173
    v_cvt_pk_bf16_f32 v79, v174, v175
    v_mfma_f32_16x16x32_bf16 a[156:159], a[124:127], a[28:31], a[156:159]
    v_cvt_pk_bf16_f32 v108, v108, v109
    v_cvt_pk_bf16_f32 v109, v110, v111
    v_mfma_f32_16x16x32_bf16 a[156:159], a[120:123], a[24:27], a[156:159]
    v_cvt_pk_bf16_f32 v110, v204, v205
    v_cvt_pk_bf16_f32 v111, v206, v207
    v_mfma_f32_16x16x32_bf16 v[80:83], a[64:67], a[32:35], v[80:83]
    v_mfma_f32_16x16x32_bf16 v[80:83], a[68:71], a[36:39], v[80:83]
    v_cvt_pk_bf16_f32 v140, v140, v141
    v_cvt_pk_bf16_f32 v141, v142, v143
    v_mfma_f32_16x16x32_bf16 v[176:179], a[76:79], a[36:39], v[176:179]
    s_add_u32 s52, s47, 532480
    v_cvt_pk_bf16_f32 v142, v236, v237
    v_cvt_pk_bf16_f32 v143, v238, v239
    v_mfma_f32_16x16x32_bf16 v[176:179], a[72:75], a[32:35], v[176:179]
    buffer_store_dwordx4 v[160:163], v1, s[32:35], s52 offen offset:0 sc1
    v_mfma_f32_16x16x32_bf16 v[112:115], a[80:83], a[32:35], v[112:115]
    v_mfma_f32_16x16x32_bf16 v[112:115], a[84:87], a[36:39], v[112:115]
    v_accvgpr_read_b32 v56, a152
    v_accvgpr_read_b32 v57, a153
    v_mfma_f32_16x16x32_bf16 v[208:211], a[92:95], a[36:39], v[208:211]
    v_accvgpr_read_b32 v58, a154
    v_accvgpr_read_b32 v59, a155
    v_mfma_f32_16x16x32_bf16 v[208:211], a[88:91], a[32:35], v[208:211]
    v_accvgpr_read_b32 v60, a156
    v_accvgpr_read_b32 v61, a157
    v_mfma_f32_16x16x32_bf16 v[144:147], a[96:99], a[32:35], v[144:147]
    v_accvgpr_read_b32 v62, a158
    v_accvgpr_read_b32 v63, a159
    v_mfma_f32_16x16x32_bf16 v[144:147], a[100:103], a[36:39], v[144:147]
    v_cvt_pk_bf16_f32 v172, v56, v57
    v_cvt_pk_bf16_f32 v173, v58, v59
    v_mfma_f32_16x16x32_bf16 v[240:243], a[108:111], a[36:39], v[240:243]
    v_cvt_pk_bf16_f32 v80, v80, v81
    v_cvt_pk_bf16_f32 v174, v60, v61
    v_mfma_f32_16x16x32_bf16 v[240:243], a[104:107], a[32:35], v[240:243]
    v_cvt_pk_bf16_f32 v81, v82, v83
    v_cvt_pk_bf16_f32 v175, v62, v63
    v_mfma_f32_16x16x32_bf16 a[160:163], a[112:115], a[32:35], a[160:163]
    v_cvt_pk_bf16_f32 v82, v176, v177
    v_cvt_pk_bf16_f32 v83, v178, v179
    v_mfma_f32_16x16x32_bf16 a[160:163], a[116:119], a[36:39], a[160:163]
    v_cvt_pk_bf16_f32 v112, v112, v113
    v_cvt_pk_bf16_f32 v113, v114, v115
    v_mfma_f32_16x16x32_bf16 a[164:167], a[124:127], a[36:39], a[164:167]
    s_add_u32 s52, s47, 0
    v_cvt_pk_bf16_f32 v114, v208, v209
    v_cvt_pk_bf16_f32 v115, v210, v211
    v_mfma_f32_16x16x32_bf16 a[164:167], a[120:123], a[32:35], a[164:167]
    buffer_store_dwordx4 v[68:71], v1, s[32:35], s52 offen offset:1024 sc1
    v_mfma_f32_16x16x32_bf16 v[84:87], a[64:67], a[40:43], v[84:87]
    v_mfma_f32_16x16x32_bf16 v[84:87], a[68:71], a[44:47], v[84:87]
    v_cvt_pk_bf16_f32 v144, v144, v145
    v_cvt_pk_bf16_f32 v145, v146, v147
    v_mfma_f32_16x16x32_bf16 v[180:183], a[76:79], a[44:47], v[180:183]
    v_cvt_pk_bf16_f32 v146, v240, v241
    v_cvt_pk_bf16_f32 v147, v242, v243
    v_mfma_f32_16x16x32_bf16 v[180:183], a[72:75], a[40:43], v[180:183]
    v_mfma_f32_16x16x32_bf16 v[116:119], a[80:83], a[40:43], v[116:119]
    v_mfma_f32_16x16x32_bf16 v[116:119], a[84:87], a[44:47], v[116:119]
    v_accvgpr_read_b32 v56, a160
    v_accvgpr_read_b32 v57, a161
    v_mfma_f32_16x16x32_bf16 v[212:215], a[92:95], a[44:47], v[212:215]
    v_accvgpr_read_b32 v58, a162
    v_accvgpr_read_b32 v59, a163
    v_mfma_f32_16x16x32_bf16 v[212:215], a[88:91], a[40:43], v[212:215]
    v_accvgpr_read_b32 v60, a164
    v_accvgpr_read_b32 v61, a165
    v_mfma_f32_16x16x32_bf16 v[148:151], a[96:99], a[40:43], v[148:151]
    v_accvgpr_read_b32 v62, a166
    v_accvgpr_read_b32 v63, a167
    v_mfma_f32_16x16x32_bf16 v[148:151], a[100:103], a[44:47], v[148:151]
    s_add_u32 s52, s47, 8192
    v_cvt_pk_bf16_f32 v176, v56, v57
    v_cvt_pk_bf16_f32 v177, v58, v59
    v_mfma_f32_16x16x32_bf16 v[244:247], a[108:111], a[44:47], v[244:247]
    v_cvt_pk_bf16_f32 v84, v84, v85
    v_cvt_pk_bf16_f32 v178, v60, v61
    v_mfma_f32_16x16x32_bf16 v[244:247], a[104:107], a[40:43], v[244:247]
    v_cvt_pk_bf16_f32 v85, v86, v87
    v_cvt_pk_bf16_f32 v179, v62, v63
    v_mfma_f32_16x16x32_bf16 a[168:171], a[112:115], a[40:43], a[168:171]
    v_cvt_pk_bf16_f32 v86, v180, v181
    v_cvt_pk_bf16_f32 v87, v182, v183
    v_mfma_f32_16x16x32_bf16 a[168:171], a[116:119], a[44:47], a[168:171]
    buffer_store_dwordx4 v[100:103], v1, s[32:35], s52 offen offset:1024 sc1
    v_mfma_f32_16x16x32_bf16 a[172:175], a[124:127], a[44:47], a[172:175]
    v_cvt_pk_bf16_f32 v116, v116, v117
    v_cvt_pk_bf16_f32 v117, v118, v119
    v_mfma_f32_16x16x32_bf16 a[172:175], a[120:123], a[40:43], a[172:175]
    v_cvt_pk_bf16_f32 v118, v212, v213
    v_cvt_pk_bf16_f32 v119, v214, v215
    v_mfma_f32_16x16x32_bf16 v[88:91], a[64:67], a[48:51], v[88:91]
    s_waitcnt vmcnt(16)
    s_barrier
    v_mfma_f32_16x16x32_bf16 v[88:91], a[68:71], a[52:55], v[88:91]
    ds_read_b64_tr_b16 a[0:1], v42 offset:32768
    v_cvt_pk_bf16_f32 v148, v148, v149
    v_mfma_f32_16x16x32_bf16 v[184:187], a[76:79], a[52:55], v[184:187]
    v_cvt_pk_bf16_f32 v149, v150, v151
    v_cvt_pk_bf16_f32 v150, v244, v245
    v_mfma_f32_16x16x32_bf16 v[184:187], a[72:75], a[48:51], v[184:187]
    ds_read_b64_tr_b16 a[2:3], v42 offset:33792
    v_cvt_pk_bf16_f32 v151, v246, v247
    v_mfma_f32_16x16x32_bf16 v[120:123], a[80:83], a[48:51], v[120:123]
    ds_read_b64_tr_b16 a[4:5], v42 offset:40960
    ds_read_b64_tr_b16 a[6:7], v42 offset:41984
    v_mfma_f32_16x16x32_bf16 v[120:123], a[84:87], a[52:55], v[120:123]
    s_add_u32 s52, s47, 524288
    v_accvgpr_read_b32 v56, a168
    v_accvgpr_read_b32 v57, a169
    v_mfma_f32_16x16x32_bf16 v[216:219], a[92:95], a[52:55], v[216:219]
    v_accvgpr_read_b32 v58, a170
    v_accvgpr_read_b32 v59, a171
    v_mfma_f32_16x16x32_bf16 v[216:219], a[88:91], a[48:51], v[216:219]
    ds_read_b64_tr_b16 a[8:9], v43 offset:32768
    v_accvgpr_read_b32 v60, a172
    v_mfma_f32_16x16x32_bf16 v[152:155], a[96:99], a[48:51], v[152:155]
    buffer_store_dwordx4 v[132:135], v1, s[32:35], s52 offen offset:1024 sc1
    ds_read_b64_tr_b16 a[10:11], v43 offset:33792
    v_mfma_f32_16x16x32_bf16 v[152:155], a[100:103], a[52:55], v[152:155]
    v_accvgpr_read_b32 v61, a173
    v_accvgpr_read_b32 v62, a174
    v_mfma_f32_16x16x32_bf16 v[248:251], a[108:111], a[52:55], v[248:251]
    v_accvgpr_read_b32 v63, a175
    v_cvt_pk_bf16_f32 v180, v56, v57
    v_mfma_f32_16x16x32_bf16 v[248:251], a[104:107], a[48:51], v[248:251]
    v_cvt_pk_bf16_f32 v181, v58, v59
    v_cvt_pk_bf16_f32 v88, v88, v89
    v_mfma_f32_16x16x32_bf16 a[176:179], a[112:115], a[48:51], a[176:179]
    v_cvt_pk_bf16_f32 v182, v60, v61
    v_cvt_pk_bf16_f32 v89, v90, v91
    v_mfma_f32_16x16x32_bf16 a[176:179], a[116:119], a[52:55], a[176:179]
    ds_read_b64_tr_b16 a[12:13], v43 offset:40960
    v_cvt_pk_bf16_f32 v183, v62, v63
    v_mfma_f32_16x16x32_bf16 a[180:183], a[124:127], a[52:55], a[180:183]
    v_cvt_pk_bf16_f32 v90, v184, v185
    v_cvt_pk_bf16_f32 v91, v186, v187
    v_mfma_f32_16x16x32_bf16 a[180:183], a[120:123], a[48:51], a[180:183]
    ds_read_b64_tr_b16 a[14:15], v43 offset:41984
    ds_read_b64_tr_b16 a[16:17], v44 offset:32768
    v_mfma_f32_16x16x32_bf16 v[92:95], a[64:67], a[56:59], v[92:95]
    s_add_u32 s52, s47, 532480
    v_cvt_pk_bf16_f32 v120, v120, v121
    v_cvt_pk_bf16_f32 v121, v122, v123
    v_mfma_f32_16x16x32_bf16 v[92:95], a[68:71], a[60:63], v[92:95]
    ds_read_b64_tr_b16 a[18:19], v44 offset:33792
    v_cvt_pk_bf16_f32 v122, v216, v217
    v_mfma_f32_16x16x32_bf16 v[188:191], a[76:79], a[60:63], v[188:191]
    ds_read_b64_tr_b16 a[20:21], v44 offset:40960
    v_cvt_pk_bf16_f32 v123, v218, v219
    v_mfma_f32_16x16x32_bf16 v[188:191], a[72:75], a[56:59], v[188:191]
    ds_read_b64_tr_b16 a[22:23], v44 offset:41984
    v_cvt_pk_bf16_f32 v152, v152, v153
    v_mfma_f32_16x16x32_bf16 v[124:127], a[80:83], a[56:59], v[124:127]
    v_cvt_pk_bf16_f32 v153, v154, v155
    v_cvt_pk_bf16_f32 v154, v248, v249
    v_mfma_f32_16x16x32_bf16 v[124:127], a[84:87], a[60:63], v[124:127]
    ds_read_b64_tr_b16 a[24:25], v45 offset:32768
    v_cvt_pk_bf16_f32 v155, v250, v251
    v_mfma_f32_16x16x32_bf16 v[220:223], a[92:95], a[60:63], v[220:223]
    buffer_store_dwordx4 v[164:167], v1, s[32:35], s52 offen offset:1024 sc1
    ds_read_b64_tr_b16 a[26:27], v45 offset:33792
    v_mfma_f32_16x16x32_bf16 v[220:223], a[88:91], a[56:59], v[220:223]
    ds_read_b64_tr_b16 a[28:29], v45 offset:40960
    v_accvgpr_read_b32 v56, a176
    v_mfma_f32_16x16x32_bf16 v[156:159], a[96:99], a[56:59], v[156:159]
    v_accvgpr_read_b32 v57, a177
    v_accvgpr_read_b32 v58, a178
    v_mfma_f32_16x16x32_bf16 v[156:159], a[100:103], a[60:63], v[156:159]
    ds_read_b64_tr_b16 a[30:31], v45 offset:41984
    v_accvgpr_read_b32 v59, a179
    v_mfma_f32_16x16x32_bf16 v[252:255], a[108:111], a[60:63], v[252:255]
    v_accvgpr_read_b32 v60, a180
    v_accvgpr_read_b32 v61, a181
    v_mfma_f32_16x16x32_bf16 v[252:255], a[104:107], a[56:59], v[252:255]
    v_accvgpr_read_b32 v62, a182
    v_accvgpr_read_b32 v63, a183
    v_mfma_f32_16x16x32_bf16 a[184:187], a[112:115], a[56:59], a[184:187]
    v_cvt_pk_bf16_f32 v184, v56, v57
    v_cvt_pk_bf16_f32 v185, v58, v59
    v_mfma_f32_16x16x32_bf16 a[184:187], a[116:119], a[60:63], a[184:187]
    v_cvt_pk_bf16_f32 v92, v92, v93
    v_cvt_pk_bf16_f32 v186, v60, v61
    v_mfma_f32_16x16x32_bf16 a[188:191], a[124:127], a[60:63], a[188:191]
    v_cvt_pk_bf16_f32 v93, v94, v95
    v_cvt_pk_bf16_f32 v187, v62, v63
    v_mfma_f32_16x16x32_bf16 a[188:191], a[120:123], a[56:59], a[188:191]
    v_cvt_pk_bf16_f32 v94, v188, v189
    v_cvt_pk_bf16_f32 v95, v190, v191
    v_cvt_pk_bf16_f32 v124, v124, v125
    v_cvt_pk_bf16_f32 v125, v126, v127
    v_cvt_pk_bf16_f32 v126, v220, v221
    v_cvt_pk_bf16_f32 v127, v222, v223
    v_cvt_pk_bf16_f32 v156, v156, v157
    v_cvt_pk_bf16_f32 v157, v158, v159
    v_cvt_pk_bf16_f32 v158, v252, v253
    v_cvt_pk_bf16_f32 v159, v254, v255
    v_accvgpr_read_b32 v56, a184
    v_accvgpr_read_b32 v57, a185
    v_accvgpr_read_b32 v58, a186
    v_accvgpr_read_b32 v59, a187
    v_accvgpr_read_b32 v60, a188
    v_accvgpr_read_b32 v61, a189
    v_accvgpr_read_b32 v62, a190
    v_accvgpr_read_b32 v63, a191
    v_cvt_pk_bf16_f32 v188, v56, v57
    v_cvt_pk_bf16_f32 v189, v58, v59
    v_cvt_pk_bf16_f32 v190, v60, v61
    v_cvt_pk_bf16_f32 v191, v62, v63
k12_join_7:
k12_qcode:
    s_mov_b64 s[48:49], s[32:33]
    s_mov_b32 s51, 0x00020000
    s_cmp_eq_u32 s45, 0
    s_mov_b32 s50, s34
    s_cselect_b32 s56, s30, -1
    s_cselect_b32 s57, -1, s30
    s_waitcnt vmcnt(16) lgkmcnt(0)
    v_mfma_f32_16x16x32_bf16 v[192:195], a[0:3], a[192:195], 0
    v_mfma_f32_16x16x32_bf16 v[192:195], a[4:7], a[208:211], v[192:195]
    buffer_load_dwordx4 a[128:131], v36, s[8:11], s62 offen sc1
    ds_read_b64_tr_b16 a[32:33], v46 offset:32768
    v_mfma_f32_16x16x32_bf16 v[196:199], a[4:7], a[212:215], 0
    ds_read_b64_tr_b16 a[34:35], v46 offset:33792
    v_mfma_f32_16x16x32_bf16 v[196:199], a[0:3], a[196:199], v[196:199]
    ds_read_b64_tr_b16 a[36:37], v46 offset:40960
    v_mfma_f32_16x16x32_bf16 a[64:67], a[0:3], a[200:203], 0
    ds_read_b64_tr_b16 a[38:39], v46 offset:41984
    v_mfma_f32_16x16x32_bf16 a[64:67], a[4:7], a[216:219], a[64:67]
    ds_read_b64_tr_b16 a[40:41], v47 offset:32768
    v_mfma_f32_16x16x32_bf16 a[68:71], a[4:7], a[220:223], 0
    s_lshl_b32 s31, s28, 14
    v_mfma_f32_16x16x32_bf16 a[68:71], a[0:3], a[204:207], a[68:71]
    s_add_u32 s16, s6, s31
    s_addc_u32 s17, s7, 0
    buffer_load_dwordx4 a[132:135], v54, s[8:11], s62 offen sc1
    ds_read_b64_tr_b16 a[42:43], v47 offset:33792
    v_mfma_f32_16x16x32_bf16 a[76:79], a[8:11], a[204:207], 0
    ds_read_b64_tr_b16 a[44:45], v47 offset:40960
    v_mfma_f32_16x16x32_bf16 a[76:79], a[12:15], a[220:223], a[76:79]
    s_add_u32 s20, s16, 0x2000000
    s_addc_u32 s21, s17, 0
    ds_read_b64_tr_b16 a[46:47], v47 offset:41984
    v_mfma_f32_16x16x32_bf16 a[72:75], a[12:15], a[216:219], 0
    ds_read_b64_tr_b16 a[48:49], v48 offset:32768
    v_mfma_f32_16x16x32_bf16 a[72:75], a[8:11], a[200:203], a[72:75]
    s_add_u32 s16, s16, 0x1000000
    s_addc_u32 s17, s17, 0
    v_mfma_f32_16x16x32_bf16 v[204:207], a[8:11], a[196:199], 0
    ds_read_b64_tr_b16 a[50:51], v48 offset:33792
    v_mfma_f32_16x16x32_bf16 v[204:207], a[12:15], a[212:215], v[204:207]
    s_and_b32 s17, s17, 0xffff
    ds_read_b64_tr_b16 a[52:53], v48 offset:40960
    v_mfma_f32_16x16x32_bf16 v[200:203], a[12:15], a[208:211], 0
    buffer_load_dwordx4 a[136:139], v37, s[8:11], s62 offen sc1
    ds_read_b64_tr_b16 a[54:55], v48 offset:41984
    v_mfma_f32_16x16x32_bf16 v[200:203], a[8:11], a[192:195], v[200:203]
    s_and_b32 s21, s21, 0xffff
    v_mfma_f32_16x16x32_bf16 v[208:211], a[16:19], a[192:195], 0
    ds_read_b64_tr_b16 a[56:57], v49 offset:32768
    v_mfma_f32_16x16x32_bf16 v[208:211], a[20:23], a[208:211], v[208:211]
    s_lshl_b32 s31, s29, 20
    ds_read_b64_tr_b16 a[58:59], v49 offset:33792
    v_mfma_f32_16x16x32_bf16 v[212:215], a[20:23], a[212:215], 0
    ds_read_b64_tr_b16 a[60:61], v49 offset:40960
    v_mfma_f32_16x16x32_bf16 v[212:215], a[16:19], a[196:199], v[212:215]
    s_sub_u32 s18, 0xf84000, s31
    v_mfma_f32_16x16x32_bf16 a[80:83], a[16:19], a[200:203], 0
    buffer_load_dwordx4 a[140:143], v55, s[8:11], s62 offen sc1
    ds_read_b64_tr_b16 a[62:63], v49 offset:41984
    v_mfma_f32_16x16x32_bf16 a[80:83], a[20:23], a[216:219], a[80:83]
    s_mov_b32 s22, s18
    v_mfma_f32_16x16x32_bf16 a[84:87], a[20:23], a[220:223], 0
    v_mfma_f32_16x16x32_bf16 a[84:87], a[16:19], a[204:207], a[84:87]
    s_add_u32 s24, s6, 0x4806000
    s_addc_u32 s25, s7, 0
    v_mfma_f32_16x16x32_bf16 a[92:95], a[24:27], a[204:207], 0
    v_mfma_f32_16x16x32_bf16 a[92:95], a[28:31], a[220:223], a[92:95]
    s_and_b32 s25, s25, 0xffff
    v_mfma_f32_16x16x32_bf16 a[88:91], a[28:31], a[216:219], 0
    s_add_u32 s62, s62, 0x20000
    v_mfma_f32_16x16x32_bf16 a[88:91], a[24:27], a[200:203], a[88:91]
    s_mov_b32 s26, 4096
    v_mfma_f32_16x16x32_bf16 v[220:223], a[24:27], a[196:199], 0
    s_cmp_eq_u32 s45, 0
    s_cbranch_scc1 k12_ool_48
k12_oolret_49:
    v_mfma_f32_16x16x32_bf16 v[220:223], a[28:31], a[212:215], v[220:223]
    v_mfma_f32_16x16x32_bf16 v[216:219], a[28:31], a[208:211], 0
    v_mfma_f32_16x16x32_bf16 v[216:219], a[24:27], a[192:195], v[216:219]
    s_waitcnt vmcnt(28) lgkmcnt(0)
    s_barrier
    v_mfma_f32_16x16x32_bf16 v[224:227], a[32:35], a[192:195], 0
    v_mfma_f32_16x16x32_bf16 v[224:227], a[36:39], a[208:211], v[224:227]
    s_add_u32 m0, s60, 98304
    ds_read_b64_tr_b16 a[0:1], v42 offset:49152
    ds_read_b64_tr_b16 a[2:3], v42 offset:50176
    v_mfma_f32_16x16x32_bf16 v[228:231], a[36:39], a[212:215], 0
    buffer_load_dwordx4 v38, s[12:15], s61 offen offset:0 lds
    v_mfma_f32_16x16x32_bf16 v[228:231], a[32:35], a[196:199], v[228:231]
    ds_read_b64_tr_b16 a[4:5], v42 offset:57344
    v_mfma_f32_16x16x32_bf16 a[96:99], a[32:35], a[200:203], 0
    buffer_load_dwordx4 v39, s[12:15], s61 offen offset:1024 lds
    ds_read_b64_tr_b16 a[6:7], v42 offset:58368
    v_mfma_f32_16x16x32_bf16 a[96:99], a[36:39], a[216:219], a[96:99]
    ds_read_b64_tr_b16 a[8:9], v43 offset:49152
    v_mfma_f32_16x16x32_bf16 a[100:103], a[36:39], a[220:223], 0
    v_mfma_f32_16x16x32_bf16 a[100:103], a[32:35], a[204:207], a[100:103]
    buffer_load_dwordx4 v40, s[12:15], s61 offen offset:2048 lds
    ds_read_b64_tr_b16 a[10:11], v43 offset:50176
    v_mfma_f32_16x16x32_bf16 a[108:111], a[40:43], a[204:207], 0
    ds_read_b64_tr_b16 a[12:13], v43 offset:57344
    v_mfma_f32_16x16x32_bf16 a[108:111], a[44:47], a[220:223], a[108:111]
    ds_read_b64_tr_b16 a[14:15], v43 offset:58368
    v_mfma_f32_16x16x32_bf16 a[104:107], a[44:47], a[216:219], 0
    buffer_load_dwordx4 v41, s[12:15], s61 offen offset:3072 lds
    ds_read_b64_tr_b16 a[16:17], v44 offset:49152
    v_mfma_f32_16x16x32_bf16 a[104:107], a[40:43], a[200:203], a[104:107]
    v_mfma_f32_16x16x32_bf16 v[236:239], a[40:43], a[196:199], 0
    s_add_u32 s61, s61, 0x80000
    ds_read_b64_tr_b16 a[18:19], v44 offset:50176
    v_mfma_f32_16x16x32_bf16 v[236:239], a[44:47], a[212:215], v[236:239]
    buffer_load_dwordx4 a[144:147], v36, s[8:11], s62 offen sc1
    ds_read_b64_tr_b16 a[20:21], v44 offset:57344
    v_mfma_f32_16x16x32_bf16 v[232:235], a[44:47], a[208:211], 0
    ds_read_b64_tr_b16 a[22:23], v44 offset:58368
    v_mfma_f32_16x16x32_bf16 v[232:235], a[40:43], a[192:195], v[232:235]
    buffer_load_dwordx4 a[148:151], v54, s[8:11], s62 offen sc1
    v_mfma_f32_16x16x32_bf16 v[240:243], a[48:51], a[192:195], 0
    ds_read_b64_tr_b16 a[24:25], v45 offset:49152
    v_mfma_f32_16x16x32_bf16 v[240:243], a[52:55], a[208:211], v[240:243]
    ds_read_b64_tr_b16 a[26:27], v45 offset:50176
    v_mfma_f32_16x16x32_bf16 v[244:247], a[52:55], a[212:215], 0
    buffer_load_dwordx4 a[152:155], v37, s[8:11], s62 offen sc1
    ds_read_b64_tr_b16 a[28:29], v45 offset:57344
    v_mfma_f32_16x16x32_bf16 v[244:247], a[48:51], a[196:199], v[244:247]
    v_mfma_f32_16x16x32_bf16 a[112:115], a[48:51], a[200:203], 0
    ds_read_b64_tr_b16 a[30:31], v45 offset:58368
    v_mfma_f32_16x16x32_bf16 a[112:115], a[52:55], a[216:219], a[112:115]
    buffer_load_dwordx4 a[156:159], v55, s[8:11], s62 offen sc1
    v_mfma_f32_16x16x32_bf16 a[116:119], a[52:55], a[220:223], 0
    v_mfma_f32_16x16x32_bf16 a[116:119], a[48:51], a[204:207], a[116:119]
    s_add_u32 s62, s62, 0x20000
    v_mfma_f32_16x16x32_bf16 a[124:127], a[56:59], a[204:207], 0
    s_add_u32 s52, s47, 0
    v_mfma_f32_16x16x32_bf16 a[124:127], a[60:63], a[220:223], a[124:127]
    buffer_store_dwordx4 v[72:75], v1, s[48:51], s52 offen offset:2048 sc1
    v_mfma_f32_16x16x32_bf16 a[120:123], a[60:63], a[216:219], 0
    v_mfma_f32_16x16x32_bf16 a[120:123], a[56:59], a[200:203], a[120:123]
    v_mfma_f32_16x16x32_bf16 v[252:255], a[56:59], a[196:199], 0
    v_mfma_f32_16x16x32_bf16 v[252:255], a[60:63], a[212:215], v[252:255]
    v_mfma_f32_16x16x32_bf16 v[248:251], a[60:63], a[208:211], 0
    v_mfma_f32_16x16x32_bf16 v[248:251], a[56:59], a[192:195], v[248:251]
    s_waitcnt vmcnt(21) lgkmcnt(0)
    v_mfma_f32_16x16x32_bf16 v[192:195], a[0:3], a[224:227], v[192:195]
    v_mfma_f32_16x16x32_bf16 v[192:195], a[4:7], a[240:243], v[192:195]
    buffer_load_dwordx4 a[160:163], v36, s[8:11], s62 offen sc1
    ds_read_b64_tr_b16 a[32:33], v46 offset:49152
    v_mfma_f32_16x16x32_bf16 v[196:199], a[4:7], a[244:247], v[196:199]
    ds_read_b64_tr_b16 a[34:35], v46 offset:50176
    v_mfma_f32_16x16x32_bf16 v[196:199], a[0:3], a[228:231], v[196:199]
    ds_read_b64_tr_b16 a[36:37], v46 offset:57344
    v_mfma_f32_16x16x32_bf16 a[64:67], a[0:3], a[232:235], a[64:67]
    ds_read_b64_tr_b16 a[38:39], v46 offset:58368
    v_mfma_f32_16x16x32_bf16 a[64:67], a[4:7], a[248:251], a[64:67]
    ds_read_b64_tr_b16 a[40:41], v47 offset:49152
    v_mfma_f32_16x16x32_bf16 a[68:71], a[4:7], a[252:255], a[68:71]
    buffer_load_dwordx4 a[164:167], v54, s[8:11], s62 offen sc1
    v_mfma_f32_16x16x32_bf16 a[68:71], a[0:3], a[236:239], a[68:71]
    ds_read_b64_tr_b16 a[42:43], v47 offset:50176
    v_mfma_f32_16x16x32_bf16 a[76:79], a[8:11], a[236:239], a[76:79]
    ds_read_b64_tr_b16 a[44:45], v47 offset:57344
    v_mfma_f32_16x16x32_bf16 a[76:79], a[12:15], a[252:255], a[76:79]
    ds_read_b64_tr_b16 a[46:47], v47 offset:58368
    v_mfma_f32_16x16x32_bf16 a[72:75], a[12:15], a[248:251], a[72:75]
    ds_read_b64_tr_b16 a[48:49], v48 offset:49152
    v_mfma_f32_16x16x32_bf16 a[72:75], a[8:11], a[232:235], a[72:75]
    buffer_load_dwordx4 a[168:171], v37, s[8:11], s62 offen sc1
    v_mfma_f32_16x16x32_bf16 v[204:207], a[8:11], a[228:231], v[204:207]
    ds_read_b64_tr_b16 a[50:51], v48 offset:50176
    v_mfma_f32_16x16x32_bf16 v[204:207], a[12:15], a[244:247], v[204:207]
    ds_read_b64_tr_b16 a[52:53], v48 offset:57344
    v_mfma_f32_16x16x32_bf16 v[200:203], a[12:15], a[240:243], v[200:203]
    ds_read_b64_tr_b16 a[54:55], v48 offset:58368
    v_mfma_f32_16x16x32_bf16 v[200:203], a[8:11], a[224:227], v[200:203]
    v_mfma_f32_16x16x32_bf16 v[208:211], a[16:19], a[224:227], v[208:211]
    ds_read_b64_tr_b16 a[56:57], v49 offset:49152
    v_mfma_f32_16x16x32_bf16 v[208:211], a[20:23], a[240:243], v[208:211]
    buffer_load_dwordx4 a[172:175], v55, s[8:11], s62 offen sc1
    ds_read_b64_tr_b16 a[58:59], v49 offset:50176
    v_mfma_f32_16x16x32_bf16 v[212:215], a[20:23], a[244:247], v[212:215]
    ds_read_b64_tr_b16 a[60:61], v49 offset:57344
    v_mfma_f32_16x16x32_bf16 v[212:215], a[16:19], a[228:231], v[212:215]
    v_mfma_f32_16x16x32_bf16 a[80:83], a[16:19], a[232:235], a[80:83]
    ds_read_b64_tr_b16 a[62:63], v49 offset:58368
    v_mfma_f32_16x16x32_bf16 a[80:83], a[20:23], a[248:251], a[80:83]
    s_add_u32 s62, s62, 0x20000
    v_mfma_f32_16x16x32_bf16 a[84:87], a[20:23], a[252:255], a[84:87]
    s_add_u32 s52, s47, 0
    v_mfma_f32_16x16x32_bf16 a[84:87], a[16:19], a[236:239], a[84:87]
    buffer_store_dwordx4 v[76:79], v1, s[48:51], s52 offen offset:3072 sc1
    v_mfma_f32_16x16x32_bf16 a[92:95], a[24:27], a[236:239], a[92:95]
    v_mfma_f32_16x16x32_bf16 a[92:95], a[28:31], a[252:255], a[92:95]
    v_mfma_f32_16x16x32_bf16 a[88:91], a[28:31], a[248:251], a[88:91]
    v_mfma_f32_16x16x32_bf16 a[88:91], a[24:27], a[232:235], a[88:91]
    v_mfma_f32_16x16x32_bf16 v[220:223], a[24:27], a[228:231], v[220:223]
    s_cmp_eq_u32 s45, 0
    s_cbranch_scc1 k12_ool_50
k12_oolret_51:
    v_mfma_f32_16x16x32_bf16 v[220:223], a[28:31], a[244:247], v[220:223]
    v_mfma_f32_16x16x32_bf16 v[216:219], a[28:31], a[240:243], v[216:219]
    v_mfma_f32_16x16x32_bf16 v[216:219], a[24:27], a[224:227], v[216:219]
    s_waitcnt vmcnt(10) lgkmcnt(0)
    s_barrier
    v_mfma_f32_16x16x32_bf16 v[224:227], a[32:35], a[224:227], v[224:227]
    v_mfma_f32_16x16x32_bf16 v[224:227], a[36:39], a[240:243], v[224:227]
    s_add_u32 m0, s60, 114688
    ds_read_b64_tr_b16 a[0:1], v42 offset:0
    ds_read_b64_tr_b16 a[2:3], v42 offset:1024
    v_mfma_f32_16x16x32_bf16 v[228:231], a[36:39], a[244:247], v[228:231]
    buffer_load_dwordx4 v38, s[12:15], s61 offen offset:0 lds
    v_mfma_f32_16x16x32_bf16 v[228:231], a[32:35], a[228:231], v[228:231]
    ds_read_b64_tr_b16 a[4:5], v42 offset:8192
    v_mfma_f32_16x16x32_bf16 a[96:99], a[32:35], a[232:235], a[96:99]
    buffer_load_dwordx4 v39, s[12:15], s61 offen offset:1024 lds
    ds_read_b64_tr_b16 a[6:7], v42 offset:9216
    v_mfma_f32_16x16x32_bf16 a[96:99], a[36:39], a[248:251], a[96:99]
    ds_read_b64_tr_b16 a[8:9], v43 offset:0
    v_mfma_f32_16x16x32_bf16 a[100:103], a[36:39], a[252:255], a[100:103]
    v_mfma_f32_16x16x32_bf16 a[100:103], a[32:35], a[236:239], a[100:103]
    buffer_load_dwordx4 v40, s[12:15], s61 offen offset:2048 lds
    ds_read_b64_tr_b16 a[10:11], v43 offset:1024
    v_mfma_f32_16x16x32_bf16 a[108:111], a[40:43], a[236:239], a[108:111]
    ds_read_b64_tr_b16 a[12:13], v43 offset:8192
    v_mfma_f32_16x16x32_bf16 a[108:111], a[44:47], a[252:255], a[108:111]
    ds_read_b64_tr_b16 a[14:15], v43 offset:9216
    v_mfma_f32_16x16x32_bf16 a[104:107], a[44:47], a[248:251], a[104:107]
    buffer_load_dwordx4 v41, s[12:15], s61 offen offset:3072 lds
    ds_read_b64_tr_b16 a[16:17], v44 offset:0
    v_mfma_f32_16x16x32_bf16 a[104:107], a[40:43], a[232:235], a[104:107]
    v_mfma_f32_16x16x32_bf16 v[236:239], a[40:43], a[228:231], v[236:239]
    s_add_u32 s61, s61, 0x80000
    ds_read_b64_tr_b16 a[18:19], v44 offset:1024
    v_mfma_f32_16x16x32_bf16 v[236:239], a[44:47], a[244:247], v[236:239]
    buffer_load_dwordx4 a[176:179], v36, s[8:11], s62 offen sc1
    ds_read_b64_tr_b16 a[20:21], v44 offset:8192
    v_mfma_f32_16x16x32_bf16 v[232:235], a[44:47], a[240:243], v[232:235]
    ds_read_b64_tr_b16 a[22:23], v44 offset:9216
    v_mfma_f32_16x16x32_bf16 v[232:235], a[40:43], a[224:227], v[232:235]
    buffer_load_dwordx4 a[180:183], v54, s[8:11], s62 offen sc1
    v_mfma_f32_16x16x32_bf16 v[240:243], a[48:51], a[224:227], v[240:243]
    ds_read_b64_tr_b16 a[24:25], v45 offset:0
    v_mfma_f32_16x16x32_bf16 v[240:243], a[52:55], a[240:243], v[240:243]
    ds_read_b64_tr_b16 a[26:27], v45 offset:1024
    v_mfma_f32_16x16x32_bf16 v[244:247], a[52:55], a[244:247], v[244:247]
    buffer_load_dwordx4 a[184:187], v37, s[8:11], s62 offen sc1
    ds_read_b64_tr_b16 a[28:29], v45 offset:8192
    v_mfma_f32_16x16x32_bf16 v[244:247], a[48:51], a[228:231], v[244:247]
    v_mfma_f32_16x16x32_bf16 a[112:115], a[48:51], a[232:235], a[112:115]
    ds_read_b64_tr_b16 a[30:31], v45 offset:9216
    v_mfma_f32_16x16x32_bf16 a[112:115], a[52:55], a[248:251], a[112:115]
    buffer_load_dwordx4 a[188:191], v55, s[8:11], s62 offen sc1
    v_mfma_f32_16x16x32_bf16 a[116:119], a[52:55], a[252:255], a[116:119]
    v_mfma_f32_16x16x32_bf16 a[116:119], a[48:51], a[236:239], a[116:119]
    s_add_u32 s62, s62, 0x20000
    v_mfma_f32_16x16x32_bf16 a[124:127], a[56:59], a[236:239], a[124:127]
    s_add_u32 s52, s47, 4096
    v_mfma_f32_16x16x32_bf16 a[124:127], a[60:63], a[252:255], a[124:127]
    buffer_store_dwordx4 v[80:83], v1, s[48:51], s52 offen offset:0 sc1
    v_mfma_f32_16x16x32_bf16 a[120:123], a[60:63], a[248:251], a[120:123]
    v_mfma_f32_16x16x32_bf16 a[120:123], a[56:59], a[232:235], a[120:123]
    v_mfma_f32_16x16x32_bf16 v[252:255], a[56:59], a[228:231], v[252:255]
    v_mfma_f32_16x16x32_bf16 v[252:255], a[60:63], a[244:247], v[252:255]
    v_mfma_f32_16x16x32_bf16 v[248:251], a[60:63], a[240:243], v[248:251]
    v_mfma_f32_16x16x32_bf16 v[248:251], a[56:59], a[224:227], v[248:251]
    s_waitcnt vmcnt(15) lgkmcnt(0)
    v_mfma_f32_16x16x32_bf16 v[192:195], a[0:3], a[128:131], v[192:195]
    v_mfma_f32_16x16x32_bf16 v[192:195], a[4:7], a[144:147], v[192:195]
    buffer_load_dwordx4 a[192:195], v36, s[8:11], s62 offen sc1
    ds_read_b64_tr_b16 a[32:33], v46 offset:0
    v_mfma_f32_16x16x32_bf16 v[196:199], a[4:7], a[148:151], v[196:199]
    ds_read_b64_tr_b16 a[34:35], v46 offset:1024
    v_mfma_f32_16x16x32_bf16 v[196:199], a[0:3], a[132:135], v[196:199]
    ds_read_b64_tr_b16 a[36:37], v46 offset:8192
    v_mfma_f32_16x16x32_bf16 a[64:67], a[0:3], a[136:139], a[64:67]
    ds_read_b64_tr_b16 a[38:39], v46 offset:9216
    v_mfma_f32_16x16x32_bf16 a[64:67], a[4:7], a[152:155], a[64:67]
    ds_read_b64_tr_b16 a[40:41], v47 offset:0
    v_mfma_f32_16x16x32_bf16 a[68:71], a[4:7], a[156:159], a[68:71]
    buffer_load_dwordx4 a[196:199], v54, s[8:11], s62 offen sc1
    v_mfma_f32_16x16x32_bf16 a[68:71], a[0:3], a[140:143], a[68:71]
    ds_read_b64_tr_b16 a[42:43], v47 offset:1024
    v_mfma_f32_16x16x32_bf16 a[76:79], a[8:11], a[140:143], a[76:79]
    ds_read_b64_tr_b16 a[44:45], v47 offset:8192
    v_mfma_f32_16x16x32_bf16 a[76:79], a[12:15], a[156:159], a[76:79]
    ds_read_b64_tr_b16 a[46:47], v47 offset:9216
    v_mfma_f32_16x16x32_bf16 a[72:75], a[12:15], a[152:155], a[72:75]
    ds_read_b64_tr_b16 a[48:49], v48 offset:0
    v_mfma_f32_16x16x32_bf16 a[72:75], a[8:11], a[136:139], a[72:75]
    buffer_load_dwordx4 a[200:203], v37, s[8:11], s62 offen sc1
    v_mfma_f32_16x16x32_bf16 v[204:207], a[8:11], a[132:135], v[204:207]
    ds_read_b64_tr_b16 a[50:51], v48 offset:1024
    v_mfma_f32_16x16x32_bf16 v[204:207], a[12:15], a[148:151], v[204:207]
    ds_read_b64_tr_b16 a[52:53], v48 offset:8192
    v_mfma_f32_16x16x32_bf16 v[200:203], a[12:15], a[144:147], v[200:203]
    ds_read_b64_tr_b16 a[54:55], v48 offset:9216
    v_mfma_f32_16x16x32_bf16 v[200:203], a[8:11], a[128:131], v[200:203]
    v_mfma_f32_16x16x32_bf16 v[208:211], a[16:19], a[128:131], v[208:211]
    ds_read_b64_tr_b16 a[56:57], v49 offset:0
    v_mfma_f32_16x16x32_bf16 v[208:211], a[20:23], a[144:147], v[208:211]
    buffer_load_dwordx4 a[204:207], v55, s[8:11], s62 offen sc1
    ds_read_b64_tr_b16 a[58:59], v49 offset:1024
    v_mfma_f32_16x16x32_bf16 v[212:215], a[20:23], a[148:151], v[212:215]
    ds_read_b64_tr_b16 a[60:61], v49 offset:8192
    v_mfma_f32_16x16x32_bf16 v[212:215], a[16:19], a[132:135], v[212:215]
    v_mfma_f32_16x16x32_bf16 a[80:83], a[16:19], a[136:139], a[80:83]
    ds_read_b64_tr_b16 a[62:63], v49 offset:9216
    v_mfma_f32_16x16x32_bf16 a[80:83], a[20:23], a[152:155], a[80:83]
    s_add_u32 s62, s62, 0x20000
    v_mfma_f32_16x16x32_bf16 a[84:87], a[20:23], a[156:159], a[84:87]
    s_add_u32 s52, s47, 4096
    v_mfma_f32_16x16x32_bf16 a[84:87], a[16:19], a[140:143], a[84:87]
    buffer_store_dwordx4 v[84:87], v1, s[48:51], s52 offen offset:1024 sc1
    v_mfma_f32_16x16x32_bf16 a[92:95], a[24:27], a[140:143], a[92:95]
    v_mfma_f32_16x16x32_bf16 a[92:95], a[28:31], a[156:159], a[92:95]
    v_mfma_f32_16x16x32_bf16 a[88:91], a[28:31], a[152:155], a[88:91]
    v_mfma_f32_16x16x32_bf16 a[88:91], a[24:27], a[136:139], a[88:91]
    v_mfma_f32_16x16x32_bf16 v[220:223], a[24:27], a[132:135], v[220:223]
    v_mfma_f32_16x16x32_bf16 v[220:223], a[28:31], a[148:151], v[220:223]
    v_mfma_f32_16x16x32_bf16 v[216:219], a[28:31], a[144:147], v[216:219]
    v_mfma_f32_16x16x32_bf16 v[216:219], a[24:27], a[128:131], v[216:219]
    s_waitcnt vmcnt(10) lgkmcnt(0)
    s_barrier
    v_mfma_f32_16x16x32_bf16 v[224:227], a[32:35], a[128:131], v[224:227]
    v_mfma_f32_16x16x32_bf16 v[224:227], a[36:39], a[144:147], v[224:227]
    s_add_u32 m0, s60, 131072
    ds_read_b64_tr_b16 a[0:1], v42 offset:16384
    ds_read_b64_tr_b16 a[2:3], v42 offset:17408
    v_mfma_f32_16x16x32_bf16 v[228:231], a[36:39], a[148:151], v[228:231]
    buffer_load_dwordx4 v38, s[12:15], s61 offen offset:0 lds
    v_mfma_f32_16x16x32_bf16 v[228:231], a[32:35], a[132:135], v[228:231]
    ds_read_b64_tr_b16 a[4:5], v42 offset:24576
    v_mfma_f32_16x16x32_bf16 a[96:99], a[32:35], a[136:139], a[96:99]
    buffer_load_dwordx4 v39, s[12:15], s61 offen offset:1024 lds
    ds_read_b64_tr_b16 a[6:7], v42 offset:25600
    v_mfma_f32_16x16x32_bf16 a[96:99], a[36:39], a[152:155], a[96:99]
    ds_read_b64_tr_b16 a[8:9], v43 offset:16384
    v_mfma_f32_16x16x32_bf16 a[100:103], a[36:39], a[156:159], a[100:103]
    v_mfma_f32_16x16x32_bf16 a[100:103], a[32:35], a[140:143], a[100:103]
    buffer_load_dwordx4 v40, s[12:15], s61 offen offset:2048 lds
    ds_read_b64_tr_b16 a[10:11], v43 offset:17408
    v_mfma_f32_16x16x32_bf16 a[108:111], a[40:43], a[140:143], a[108:111]
    ds_read_b64_tr_b16 a[12:13], v43 offset:24576
    v_mfma_f32_16x16x32_bf16 a[108:111], a[44:47], a[156:159], a[108:111]
    ds_read_b64_tr_b16 a[14:15], v43 offset:25600
    v_mfma_f32_16x16x32_bf16 a[104:107], a[44:47], a[152:155], a[104:107]
    ds_read_b64_tr_b16 a[16:17], v44 offset:16384
    v_mfma_f32_16x16x32_bf16 a[104:107], a[40:43], a[136:139], a[104:107]
    buffer_load_dwordx4 v41, s[12:15], s61 offen offset:3072 lds
    v_mfma_f32_16x16x32_bf16 v[236:239], a[40:43], a[132:135], v[236:239]
    ds_read_b64_tr_b16 a[18:19], v44 offset:17408
    v_mfma_f32_16x16x32_bf16 v[236:239], a[44:47], a[148:151], v[236:239]
    s_add_u32 s61, s61, 0x80000
    ds_read_b64_tr_b16 a[20:21], v44 offset:24576
    v_mfma_f32_16x16x32_bf16 v[232:235], a[44:47], a[144:147], v[232:235]
    buffer_load_dwordx4 a[208:211], v36, s[8:11], s62 offen sc1
    ds_read_b64_tr_b16 a[22:23], v44 offset:25600
    v_mfma_f32_16x16x32_bf16 v[232:235], a[40:43], a[128:131], v[232:235]
    v_mfma_f32_16x16x32_bf16 v[240:243], a[48:51], a[128:131], v[240:243]
    ds_read_b64_tr_b16 a[24:25], v45 offset:16384
    v_mfma_f32_16x16x32_bf16 v[240:243], a[52:55], a[144:147], v[240:243]
    buffer_load_dwordx4 a[212:215], v54, s[8:11], s62 offen sc1
    ds_read_b64_tr_b16 a[26:27], v45 offset:17408
    v_mfma_f32_16x16x32_bf16 v[244:247], a[52:55], a[148:151], v[244:247]
    ds_read_b64_tr_b16 a[28:29], v45 offset:24576
    v_mfma_f32_16x16x32_bf16 v[244:247], a[48:51], a[132:135], v[244:247]
    v_mfma_f32_16x16x32_bf16 a[112:115], a[48:51], a[136:139], a[112:115]
    buffer_load_dwordx4 a[216:219], v37, s[8:11], s62 offen sc1
    ds_read_b64_tr_b16 a[30:31], v45 offset:25600
    v_mfma_f32_16x16x32_bf16 a[112:115], a[52:55], a[152:155], a[112:115]
    v_mfma_f32_16x16x32_bf16 a[116:119], a[52:55], a[156:159], a[116:119]
    v_mfma_f32_16x16x32_bf16 a[116:119], a[48:51], a[140:143], a[116:119]
    v_mfma_f32_16x16x32_bf16 a[124:127], a[56:59], a[140:143], a[124:127]
    buffer_load_dwordx4 a[220:223], v55, s[8:11], s62 offen sc1
    v_mfma_f32_16x16x32_bf16 a[124:127], a[60:63], a[156:159], a[124:127]
    v_mfma_f32_16x16x32_bf16 a[120:123], a[60:63], a[152:155], a[120:123]
    s_add_u32 s62, s62, 0x20000
    v_mfma_f32_16x16x32_bf16 a[120:123], a[56:59], a[136:139], a[120:123]
    v_mfma_f32_16x16x32_bf16 v[252:255], a[56:59], a[132:135], v[252:255]
    s_cmp_eq_u32 s45, 0
    s_cbranch_scc1 k12_ool_52
k12_oolret_53:
    v_mfma_f32_16x16x32_bf16 v[252:255], a[60:63], a[148:151], v[252:255]
    v_mfma_f32_16x16x32_bf16 v[248:251], a[60:63], a[144:147], v[248:251]
    v_mfma_f32_16x16x32_bf16 v[248:251], a[56:59], a[128:131], v[248:251]
    s_waitcnt vmcnt(14) lgkmcnt(0)
    v_mfma_f32_16x16x32_bf16 v[192:195], a[0:3], a[160:163], v[192:195]
    v_mfma_f32_16x16x32_bf16 v[192:195], a[4:7], a[176:179], v[192:195]
    buffer_load_dwordx4 a[224:227], v36, s[8:11], s62 offen sc1
    ds_read_b64_tr_b16 a[32:33], v46 offset:16384
    v_mfma_f32_16x16x32_bf16 v[196:199], a[4:7], a[180:183], v[196:199]
    ds_read_b64_tr_b16 a[34:35], v46 offset:17408
    v_mfma_f32_16x16x32_bf16 v[196:199], a[0:3], a[164:167], v[196:199]
    ds_read_b64_tr_b16 a[36:37], v46 offset:24576
    v_mfma_f32_16x16x32_bf16 a[64:67], a[0:3], a[168:171], a[64:67]
    ds_read_b64_tr_b16 a[38:39], v46 offset:25600
    v_mfma_f32_16x16x32_bf16 a[64:67], a[4:7], a[184:187], a[64:67]
    ds_read_b64_tr_b16 a[40:41], v47 offset:16384
    v_mfma_f32_16x16x32_bf16 a[68:71], a[4:7], a[188:191], a[68:71]
    buffer_load_dwordx4 a[228:231], v54, s[8:11], s62 offen sc1
    v_mfma_f32_16x16x32_bf16 a[68:71], a[0:3], a[172:175], a[68:71]
    ds_read_b64_tr_b16 a[42:43], v47 offset:17408
    v_mfma_f32_16x16x32_bf16 a[76:79], a[8:11], a[172:175], a[76:79]
    ds_read_b64_tr_b16 a[44:45], v47 offset:24576
    v_mfma_f32_16x16x32_bf16 a[76:79], a[12:15], a[188:191], a[76:79]
    ds_read_b64_tr_b16 a[46:47], v47 offset:25600
    v_mfma_f32_16x16x32_bf16 a[72:75], a[12:15], a[184:187], a[72:75]
    ds_read_b64_tr_b16 a[48:49], v48 offset:16384
    v_mfma_f32_16x16x32_bf16 a[72:75], a[8:11], a[168:171], a[72:75]
    buffer_load_dwordx4 a[232:235], v37, s[8:11], s62 offen sc1
    v_mfma_f32_16x16x32_bf16 v[204:207], a[8:11], a[164:167], v[204:207]
    ds_read_b64_tr_b16 a[50:51], v48 offset:17408
    v_mfma_f32_16x16x32_bf16 v[204:207], a[12:15], a[180:183], v[204:207]
    ds_read_b64_tr_b16 a[52:53], v48 offset:24576
    v_mfma_f32_16x16x32_bf16 v[200:203], a[12:15], a[176:179], v[200:203]
    ds_read_b64_tr_b16 a[54:55], v48 offset:25600
    v_mfma_f32_16x16x32_bf16 v[200:203], a[8:11], a[160:163], v[200:203]
    v_mfma_f32_16x16x32_bf16 v[208:211], a[16:19], a[160:163], v[208:211]
    ds_read_b64_tr_b16 a[56:57], v49 offset:16384
    v_mfma_f32_16x16x32_bf16 v[208:211], a[20:23], a[176:179], v[208:211]
    buffer_load_dwordx4 a[236:239], v55, s[8:11], s62 offen sc1
    ds_read_b64_tr_b16 a[58:59], v49 offset:17408
    v_mfma_f32_16x16x32_bf16 v[212:215], a[20:23], a[180:183], v[212:215]
    ds_read_b64_tr_b16 a[60:61], v49 offset:24576
    v_mfma_f32_16x16x32_bf16 v[212:215], a[16:19], a[164:167], v[212:215]
    v_mfma_f32_16x16x32_bf16 a[80:83], a[16:19], a[168:171], a[80:83]
    ds_read_b64_tr_b16 a[62:63], v49 offset:25600
    v_mfma_f32_16x16x32_bf16 a[80:83], a[20:23], a[184:187], a[80:83]
    s_add_u32 s62, s62, 0x20000
    v_mfma_f32_16x16x32_bf16 a[84:87], a[20:23], a[188:191], a[84:87]
    s_add_u32 s52, s47, 4096
    v_mfma_f32_16x16x32_bf16 a[84:87], a[16:19], a[172:175], a[84:87]
    buffer_store_dwordx4 v[88:91], v1, s[48:51], s52 offen offset:2048 sc1
    v_mfma_f32_16x16x32_bf16 a[92:95], a[24:27], a[172:175], a[92:95]
    v_mfma_f32_16x16x32_bf16 a[92:95], a[28:31], a[188:191], a[92:95]
    v_mfma_f32_16x16x32_bf16 a[88:91], a[28:31], a[184:187], a[88:91]
    v_mfma_f32_16x16x32_bf16 a[88:91], a[24:27], a[168:171], a[88:91]
    v_mfma_f32_16x16x32_bf16 v[220:223], a[24:27], a[164:167], v[220:223]
    v_mfma_f32_16x16x32_bf16 v[220:223], a[28:31], a[180:183], v[220:223]
    v_mfma_f32_16x16x32_bf16 v[216:219], a[28:31], a[176:179], v[216:219]
    v_mfma_f32_16x16x32_bf16 v[216:219], a[24:27], a[160:163], v[216:219]
    s_waitcnt vmcnt(9) lgkmcnt(0)
    s_barrier
    v_mfma_f32_16x16x32_bf16 v[224:227], a[32:35], a[160:163], v[224:227]
    v_mfma_f32_16x16x32_bf16 v[224:227], a[36:39], a[176:179], v[224:227]
    s_add_u32 m0, s60, 147456
    ds_read_b64_tr_b16 a[0:1], v42 offset:32768
    ds_read_b64_tr_b16 a[2:3], v42 offset:33792
    v_mfma_f32_16x16x32_bf16 v[228:231], a[36:39], a[180:183], v[228:231]
    buffer_load_dwordx4 v38, s[12:15], s61 offen offset:0 lds
    v_mfma_f32_16x16x32_bf16 v[228:231], a[32:35], a[164:167], v[228:231]
    ds_read_b64_tr_b16 a[4:5], v42 offset:40960
    v_mfma_f32_16x16x32_bf16 a[96:99], a[32:35], a[168:171], a[96:99]
    buffer_load_dwordx4 v39, s[12:15], s61 offen offset:1024 lds
    ds_read_b64_tr_b16 a[6:7], v42 offset:41984
    v_mfma_f32_16x16x32_bf16 a[96:99], a[36:39], a[184:187], a[96:99]
    ds_read_b64_tr_b16 a[8:9], v43 offset:32768
    v_mfma_f32_16x16x32_bf16 a[100:103], a[36:39], a[188:191], a[100:103]
    v_mfma_f32_16x16x32_bf16 a[100:103], a[32:35], a[172:175], a[100:103]
    buffer_load_dwordx4 v40, s[12:15], s61 offen offset:2048 lds
    ds_read_b64_tr_b16 a[10:11], v43 offset:33792
    v_mfma_f32_16x16x32_bf16 a[108:111], a[40:43], a[172:175], a[108:111]
    ds_read_b64_tr_b16 a[12:13], v43 offset:40960
    v_mfma_f32_16x16x32_bf16 a[108:111], a[44:47], a[188:191], a[108:111]
    ds_read_b64_tr_b16 a[14:15], v43 offset:41984
    v_mfma_f32_16x16x32_bf16 a[104:107], a[44:47], a[184:187], a[104:107]
    buffer_load_dwordx4 v41, s[12:15], s61 offen offset:3072 lds
    ds_read_b64_tr_b16 a[16:17], v44 offset:32768
    v_mfma_f32_16x16x32_bf16 a[104:107], a[40:43], a[168:171], a[104:107]
    v_mfma_f32_16x16x32_bf16 v[236:239], a[40:43], a[164:167], v[236:239]
    s_add_u32 s61, s61, 0x80000
    ds_read_b64_tr_b16 a[18:19], v44 offset:33792
    v_mfma_f32_16x16x32_bf16 v[236:239], a[44:47], a[180:183], v[236:239]
    buffer_load_dwordx4 a[240:243], v36, s[8:11], s62 offen sc1
    ds_read_b64_tr_b16 a[20:21], v44 offset:40960
    v_mfma_f32_16x16x32_bf16 v[232:235], a[44:47], a[176:179], v[232:235]
    ds_read_b64_tr_b16 a[22:23], v44 offset:41984
    v_mfma_f32_16x16x32_bf16 v[232:235], a[40:43], a[160:163], v[232:235]
    buffer_load_dwordx4 a[244:247], v54, s[8:11], s62 offen sc1
    v_mfma_f32_16x16x32_bf16 v[240:243], a[48:51], a[160:163], v[240:243]
    ds_read_b64_tr_b16 a[24:25], v45 offset:32768
    v_mfma_f32_16x16x32_bf16 v[240:243], a[52:55], a[176:179], v[240:243]
    ds_read_b64_tr_b16 a[26:27], v45 offset:33792
    v_mfma_f32_16x16x32_bf16 v[244:247], a[52:55], a[180:183], v[244:247]
    buffer_load_dwordx4 a[248:251], v37, s[8:11], s62 offen sc1
    ds_read_b64_tr_b16 a[28:29], v45 offset:40960
    v_mfma_f32_16x16x32_bf16 v[244:247], a[48:51], a[164:167], v[244:247]
    v_mfma_f32_16x16x32_bf16 a[112:115], a[48:51], a[168:171], a[112:115]
    ds_read_b64_tr_b16 a[30:31], v45 offset:41984
    v_mfma_f32_16x16x32_bf16 a[112:115], a[52:55], a[184:187], a[112:115]
    buffer_load_dwordx4 a[252:255], v55, s[8:11], s62 offen sc1
    v_mfma_f32_16x16x32_bf16 a[116:119], a[52:55], a[188:191], a[116:119]
    v_mfma_f32_16x16x32_bf16 a[116:119], a[48:51], a[172:175], a[116:119]
    s_add_u32 s62, s62, 0x20000
    v_mfma_f32_16x16x32_bf16 a[124:127], a[56:59], a[172:175], a[124:127]
    s_add_u32 s52, s47, 4096
    v_mfma_f32_16x16x32_bf16 a[124:127], a[60:63], a[188:191], a[124:127]
    buffer_store_dwordx4 v[92:95], v1, s[48:51], s52 offen offset:3072 sc1
    v_mfma_f32_16x16x32_bf16 a[120:123], a[60:63], a[184:187], a[120:123]
    v_mfma_f32_16x16x32_bf16 a[120:123], a[56:59], a[168:171], a[120:123]
    v_mfma_f32_16x16x32_bf16 v[252:255], a[56:59], a[164:167], v[252:255]
    s_cmp_eq_u32 s45, 0
    s_cbranch_scc1 k12_ool_54
k12_oolret_55:
    v_mfma_f32_16x16x32_bf16 v[252:255], a[60:63], a[180:183], v[252:255]
    v_mfma_f32_16x16x32_bf16 v[248:251], a[60:63], a[176:179], v[248:251]
    v_mfma_f32_16x16x32_bf16 v[248:251], a[56:59], a[160:163], v[248:251]
    s_waitcnt vmcnt(14) lgkmcnt(0)
    v_mfma_f32_16x16x32_bf16 v[192:195], a[0:3], a[192:195], v[192:195]
    v_mfma_f32_16x16x32_bf16 v[192:195], a[4:7], a[208:211], v[192:195]
    buffer_load_dwordx4 a[128:131], v36, s[8:11], s62 offen sc1
    ds_read_b64_tr_b16 a[32:33], v46 offset:32768
    v_mfma_f32_16x16x32_bf16 v[196:199], a[4:7], a[212:215], v[196:199]
    ds_read_b64_tr_b16 a[34:35], v46 offset:33792
    v_mfma_f32_16x16x32_bf16 v[196:199], a[0:3], a[196:199], v[196:199]
    ds_read_b64_tr_b16 a[36:37], v46 offset:40960
    v_mfma_f32_16x16x32_bf16 a[64:67], a[0:3], a[200:203], a[64:67]
    ds_read_b64_tr_b16 a[38:39], v46 offset:41984
    v_mfma_f32_16x16x32_bf16 a[64:67], a[4:7], a[216:219], a[64:67]
    ds_read_b64_tr_b16 a[40:41], v47 offset:32768
    v_mfma_f32_16x16x32_bf16 a[68:71], a[4:7], a[220:223], a[68:71]
    buffer_load_dwordx4 a[132:135], v54, s[8:11], s62 offen sc1
    v_mfma_f32_16x16x32_bf16 a[68:71], a[0:3], a[204:207], a[68:71]
    ds_read_b64_tr_b16 a[42:43], v47 offset:33792
    v_mfma_f32_16x16x32_bf16 a[76:79], a[8:11], a[204:207], a[76:79]
    ds_read_b64_tr_b16 a[44:45], v47 offset:40960
    v_mfma_f32_16x16x32_bf16 a[76:79], a[12:15], a[220:223], a[76:79]
    ds_read_b64_tr_b16 a[46:47], v47 offset:41984
    v_mfma_f32_16x16x32_bf16 a[72:75], a[12:15], a[216:219], a[72:75]
    ds_read_b64_tr_b16 a[48:49], v48 offset:32768
    v_mfma_f32_16x16x32_bf16 a[72:75], a[8:11], a[200:203], a[72:75]
    buffer_load_dwordx4 a[136:139], v37, s[8:11], s62 offen sc1
    v_mfma_f32_16x16x32_bf16 v[204:207], a[8:11], a[196:199], v[204:207]
    ds_read_b64_tr_b16 a[50:51], v48 offset:33792
    v_mfma_f32_16x16x32_bf16 v[204:207], a[12:15], a[212:215], v[204:207]
    ds_read_b64_tr_b16 a[52:53], v48 offset:40960
    v_mfma_f32_16x16x32_bf16 v[200:203], a[12:15], a[208:211], v[200:203]
    ds_read_b64_tr_b16 a[54:55], v48 offset:41984
    v_mfma_f32_16x16x32_bf16 v[200:203], a[8:11], a[192:195], v[200:203]
    v_mfma_f32_16x16x32_bf16 v[208:211], a[16:19], a[192:195], v[208:211]
    ds_read_b64_tr_b16 a[56:57], v49 offset:32768
    v_mfma_f32_16x16x32_bf16 v[208:211], a[20:23], a[208:211], v[208:211]
    buffer_load_dwordx4 a[140:143], v55, s[8:11], s62 offen sc1
    ds_read_b64_tr_b16 a[58:59], v49 offset:33792
    v_mfma_f32_16x16x32_bf16 v[212:215], a[20:23], a[212:215], v[212:215]
    ds_read_b64_tr_b16 a[60:61], v49 offset:40960
    v_mfma_f32_16x16x32_bf16 v[212:215], a[16:19], a[196:199], v[212:215]
    v_mfma_f32_16x16x32_bf16 a[80:83], a[16:19], a[200:203], a[80:83]
    ds_read_b64_tr_b16 a[62:63], v49 offset:41984
    v_mfma_f32_16x16x32_bf16 a[80:83], a[20:23], a[216:219], a[80:83]
    s_add_u32 s62, s62, 0x20000
    v_mfma_f32_16x16x32_bf16 a[84:87], a[20:23], a[220:223], a[84:87]
    s_add_u32 s52, s47, 8192
    v_mfma_f32_16x16x32_bf16 a[84:87], a[16:19], a[204:207], a[84:87]
    buffer_store_dwordx4 v[104:107], v1, s[48:51], s52 offen offset:2048 sc1
    v_mfma_f32_16x16x32_bf16 a[92:95], a[24:27], a[204:207], a[92:95]
    v_mfma_f32_16x16x32_bf16 a[92:95], a[28:31], a[220:223], a[92:95]
    v_mfma_f32_16x16x32_bf16 a[88:91], a[28:31], a[216:219], a[88:91]
    v_mfma_f32_16x16x32_bf16 a[88:91], a[24:27], a[200:203], a[88:91]
    v_mfma_f32_16x16x32_bf16 v[220:223], a[24:27], a[196:199], v[220:223]
    v_mfma_f32_16x16x32_bf16 v[220:223], a[28:31], a[212:215], v[220:223]
    v_mfma_f32_16x16x32_bf16 v[216:219], a[28:31], a[208:211], v[216:219]
    v_mfma_f32_16x16x32_bf16 v[216:219], a[24:27], a[192:195], v[216:219]
    s_waitcnt vmcnt(10) lgkmcnt(0)
    s_barrier
    v_mfma_f32_16x16x32_bf16 v[224:227], a[32:35], a[192:195], v[224:227]
    v_mfma_f32_16x16x32_bf16 v[224:227], a[36:39], a[208:211], v[224:227]
    s_add_u32 m0, s60, 98304
    ds_read_b64_tr_b16 a[0:1], v42 offset:49152
    ds_read_b64_tr_b16 a[2:3], v42 offset:50176
    v_mfma_f32_16x16x32_bf16 v[228:231], a[36:39], a[212:215], v[228:231]
    buffer_load_dwordx4 v38, s[12:15], s61 offen offset:0 lds
    v_mfma_f32_16x16x32_bf16 v[228:231], a[32:35], a[196:199], v[228:231]
    ds_read_b64_tr_b16 a[4:5], v42 offset:57344
    v_mfma_f32_16x16x32_bf16 a[96:99], a[32:35], a[200:203], a[96:99]
    buffer_load_dwordx4 v39, s[12:15], s61 offen offset:1024 lds
    ds_read_b64_tr_b16 a[6:7], v42 offset:58368
    v_mfma_f32_16x16x32_bf16 a[96:99], a[36:39], a[216:219], a[96:99]
    ds_read_b64_tr_b16 a[8:9], v43 offset:49152
    v_mfma_f32_16x16x32_bf16 a[100:103], a[36:39], a[220:223], a[100:103]
    v_mfma_f32_16x16x32_bf16 a[100:103], a[32:35], a[204:207], a[100:103]
    buffer_load_dwordx4 v40, s[12:15], s61 offen offset:2048 lds
    ds_read_b64_tr_b16 a[10:11], v43 offset:50176
    v_mfma_f32_16x16x32_bf16 a[108:111], a[40:43], a[204:207], a[108:111]
    ds_read_b64_tr_b16 a[12:13], v43 offset:57344
    v_mfma_f32_16x16x32_bf16 a[108:111], a[44:47], a[220:223], a[108:111]
    ds_read_b64_tr_b16 a[14:15], v43 offset:58368
    v_mfma_f32_16x16x32_bf16 a[104:107], a[44:47], a[216:219], a[104:107]
    buffer_load_dwordx4 v41, s[12:15], s61 offen offset:3072 lds
    ds_read_b64_tr_b16 a[16:17], v44 offset:49152
    v_mfma_f32_16x16x32_bf16 a[104:107], a[40:43], a[200:203], a[104:107]
    v_mfma_f32_16x16x32_bf16 v[236:239], a[40:43], a[196:199], v[236:239]
    s_add_u32 s61, s61, 0x80000
    ds_read_b64_tr_b16 a[18:19], v44 offset:50176
    v_mfma_f32_16x16x32_bf16 v[236:239], a[44:47], a[212:215], v[236:239]
    buffer_load_dwordx4 a[144:147], v36, s[8:11], s62 offen sc1
    ds_read_b64_tr_b16 a[20:21], v44 offset:57344
    v_mfma_f32_16x16x32_bf16 v[232:235], a[44:47], a[208:211], v[232:235]
    ds_read_b64_tr_b16 a[22:23], v44 offset:58368
    v_mfma_f32_16x16x32_bf16 v[232:235], a[40:43], a[192:195], v[232:235]
    buffer_load_dwordx4 a[148:151], v54, s[8:11], s62 offen sc1
    v_mfma_f32_16x16x32_bf16 v[240:243], a[48:51], a[192:195], v[240:243]
    ds_read_b64_tr_b16 a[24:25], v45 offset:49152
    v_mfma_f32_16x16x32_bf16 v[240:243], a[52:55], a[208:211], v[240:243]
    ds_read_b64_tr_b16 a[26:27], v45 offset:50176
    v_mfma_f32_16x16x32_bf16 v[244:247], a[52:55], a[212:215], v[244:247]
    buffer_load_dwordx4 a[152:155], v37, s[8:11], s62 offen sc1
    ds_read_b64_tr_b16 a[28:29], v45 offset:57344
    v_mfma_f32_16x16x32_bf16 v[244:247], a[48:51], a[196:199], v[244:247]
    v_mfma_f32_16x16x32_bf16 a[112:115], a[48:51], a[200:203], a[112:115]
    ds_read_b64_tr_b16 a[30:31], v45 offset:58368
    v_mfma_f32_16x16x32_bf16 a[112:115], a[52:55], a[216:219], a[112:115]
    buffer_load_dwordx4 a[156:159], v55, s[8:11], s62 offen sc1
    v_mfma_f32_16x16x32_bf16 a[116:119], a[52:55], a[220:223], a[116:119]
    v_mfma_f32_16x16x32_bf16 a[116:119], a[48:51], a[204:207], a[116:119]
    s_add_u32 s62, s62, 0x20000
    v_mfma_f32_16x16x32_bf16 a[124:127], a[56:59], a[204:207], a[124:127]
    s_add_u32 s52, s47, 8192
    v_mfma_f32_16x16x32_bf16 a[124:127], a[60:63], a[220:223], a[124:127]
    buffer_store_dwordx4 v[108:111], v1, s[48:51], s52 offen offset:3072 sc1
    v_mfma_f32_16x16x32_bf16 a[120:123], a[60:63], a[216:219], a[120:123]
    v_mfma_f32_16x16x32_bf16 a[120:123], a[56:59], a[200:203], a[120:123]
    v_mfma_f32_16x16x32_bf16 v[252:255], a[56:59], a[196:199], v[252:255]
    v_mfma_f32_16x16x32_bf16 v[252:255], a[60:63], a[212:215], v[252:255]
    v_mfma_f32_16x16x32_bf16 v[248:251], a[60:63], a[208:211], v[248:251]
    v_mfma_f32_16x16x32_bf16 v[248:251], a[56:59], a[192:195], v[248:251]
    s_waitcnt vmcnt(15) lgkmcnt(0)
    v_mfma_f32_16x16x32_bf16 v[192:195], a[0:3], a[224:227], v[192:195]
    v_mfma_f32_16x16x32_bf16 v[192:195], a[4:7], a[240:243], v[192:195]
    buffer_load_dwordx4 a[160:163], v36, s[8:11], s62 offen sc1
    ds_read_b64_tr_b16 a[32:33], v46 offset:49152
    v_mfma_f32_16x16x32_bf16 v[196:199], a[4:7], a[244:247], v[196:199]
    ds_read_b64_tr_b16 a[34:35], v46 offset:50176
    v_mfma_f32_16x16x32_bf16 v[196:199], a[0:3], a[228:231], v[196:199]
    ds_read_b64_tr_b16 a[36:37], v46 offset:57344
    v_mfma_f32_16x16x32_bf16 a[64:67], a[0:3], a[232:235], a[64:67]
    ds_read_b64_tr_b16 a[38:39], v46 offset:58368
    v_mfma_f32_16x16x32_bf16 a[64:67], a[4:7], a[248:251], a[64:67]
    ds_read_b64_tr_b16 a[40:41], v47 offset:49152
    v_mfma_f32_16x16x32_bf16 a[68:71], a[4:7], a[252:255], a[68:71]
    buffer_load_dwordx4 a[164:167], v54, s[8:11], s62 offen sc1
    v_mfma_f32_16x16x32_bf16 a[68:71], a[0:3], a[236:239], a[68:71]
    ds_read_b64_tr_b16 a[42:43], v47 offset:50176
    v_mfma_f32_16x16x32_bf16 a[76:79], a[8:11], a[236:239], a[76:79]
    ds_read_b64_tr_b16 a[44:45], v47 offset:57344
    v_mfma_f32_16x16x32_bf16 a[76:79], a[12:15], a[252:255], a[76:79]
    ds_read_b64_tr_b16 a[46:47], v47 offset:58368
    v_mfma_f32_16x16x32_bf16 a[72:75], a[12:15], a[248:251], a[72:75]
    ds_read_b64_tr_b16 a[48:49], v48 offset:49152
    v_mfma_f32_16x16x32_bf16 a[72:75], a[8:11], a[232:235], a[72:75]
    buffer_load_dwordx4 a[168:171], v37, s[8:11], s62 offen sc1
    v_mfma_f32_16x16x32_bf16 v[204:207], a[8:11], a[228:231], v[204:207]
    ds_read_b64_tr_b16 a[50:51], v48 offset:50176
    v_mfma_f32_16x16x32_bf16 v[204:207], a[12:15], a[244:247], v[204:207]
    ds_read_b64_tr_b16 a[52:53], v48 offset:57344
    v_mfma_f32_16x16x32_bf16 v[200:203], a[12:15], a[240:243], v[200:203]
    ds_read_b64_tr_b16 a[54:55], v48 offset:58368
    v_mfma_f32_16x16x32_bf16 v[200:203], a[8:11], a[224:227], v[200:203]
    v_mfma_f32_16x16x32_bf16 v[208:211], a[16:19], a[224:227], v[208:211]
    ds_read_b64_tr_b16 a[56:57], v49 offset:49152
    v_mfma_f32_16x16x32_bf16 v[208:211], a[20:23], a[240:243], v[208:211]
    buffer_load_dwordx4 a[172:175], v55, s[8:11], s62 offen sc1
    ds_read_b64_tr_b16 a[58:59], v49 offset:50176
    v_mfma_f32_16x16x32_bf16 v[212:215], a[20:23], a[244:247], v[212:215]
    ds_read_b64_tr_b16 a[60:61], v49 offset:57344
    v_mfma_f32_16x16x32_bf16 v[212:215], a[16:19], a[228:231], v[212:215]
    v_mfma_f32_16x16x32_bf16 a[80:83], a[16:19], a[232:235], a[80:83]
    ds_read_b64_tr_b16 a[62:63], v49 offset:58368
    v_mfma_f32_16x16x32_bf16 a[80:83], a[20:23], a[248:251], a[80:83]
    s_add_u32 s62, s62, 0x20000
    v_mfma_f32_16x16x32_bf16 a[84:87], a[20:23], a[252:255], a[84:87]
    s_add_u32 s52, s47, 12288
    v_mfma_f32_16x16x32_bf16 a[84:87], a[16:19], a[236:239], a[84:87]
    buffer_store_dwordx4 v[112:115], v1, s[48:51], s52 offen offset:0 sc1
    v_mfma_f32_16x16x32_bf16 a[92:95], a[24:27], a[236:239], a[92:95]
    v_mfma_f32_16x16x32_bf16 a[92:95], a[28:31], a[252:255], a[92:95]
    v_mfma_f32_16x16x32_bf16 a[88:91], a[28:31], a[248:251], a[88:91]
    v_mfma_f32_16x16x32_bf16 a[88:91], a[24:27], a[232:235], a[88:91]
    v_mfma_f32_16x16x32_bf16 v[220:223], a[24:27], a[228:231], v[220:223]
    s_cmp_eq_u32 s45, 0
    s_cbranch_scc1 k12_ool_56
k12_oolret_57:
    v_mfma_f32_16x16x32_bf16 v[220:223], a[28:31], a[244:247], v[220:223]
    v_mfma_f32_16x16x32_bf16 v[216:219], a[28:31], a[240:243], v[216:219]
    v_mfma_f32_16x16x32_bf16 v[216:219], a[24:27], a[224:227], v[216:219]
    s_waitcnt vmcnt(10) lgkmcnt(0)
    s_barrier
    v_mfma_f32_16x16x32_bf16 v[224:227], a[32:35], a[224:227], v[224:227]
    v_mfma_f32_16x16x32_bf16 v[224:227], a[36:39], a[240:243], v[224:227]
    s_add_u32 m0, s60, 114688
    ds_read_b64_tr_b16 a[0:1], v42 offset:0
    ds_read_b64_tr_b16 a[2:3], v42 offset:1024
    v_mfma_f32_16x16x32_bf16 v[228:231], a[36:39], a[244:247], v[228:231]
    buffer_load_dwordx4 v38, s[12:15], s61 offen offset:0 lds
    v_mfma_f32_16x16x32_bf16 v[228:231], a[32:35], a[228:231], v[228:231]
    ds_read_b64_tr_b16 a[4:5], v42 offset:8192
    v_mfma_f32_16x16x32_bf16 a[96:99], a[32:35], a[232:235], a[96:99]
    buffer_load_dwordx4 v39, s[12:15], s61 offen offset:1024 lds
    ds_read_b64_tr_b16 a[6:7], v42 offset:9216
    v_mfma_f32_16x16x32_bf16 a[96:99], a[36:39], a[248:251], a[96:99]
    ds_read_b64_tr_b16 a[8:9], v43 offset:0
    v_mfma_f32_16x16x32_bf16 a[100:103], a[36:39], a[252:255], a[100:103]
    v_mfma_f32_16x16x32_bf16 a[100:103], a[32:35], a[236:239], a[100:103]
    buffer_load_dwordx4 v40, s[12:15], s61 offen offset:2048 lds
    ds_read_b64_tr_b16 a[10:11], v43 offset:1024
    v_mfma_f32_16x16x32_bf16 a[108:111], a[40:43], a[236:239], a[108:111]
    ds_read_b64_tr_b16 a[12:13], v43 offset:8192
    v_mfma_f32_16x16x32_bf16 a[108:111], a[44:47], a[252:255], a[108:111]
    ds_read_b64_tr_b16 a[14:15], v43 offset:9216
    v_mfma_f32_16x16x32_bf16 a[104:107], a[44:47], a[248:251], a[104:107]
    ds_read_b64_tr_b16 a[16:17], v44 offset:0
    v_mfma_f32_16x16x32_bf16 a[104:107], a[40:43], a[232:235], a[104:107]
    buffer_load_dwordx4 v41, s[12:15], s61 offen offset:3072 lds
    v_mfma_f32_16x16x32_bf16 v[236:239], a[40:43], a[228:231], v[236:239]
    ds_read_b64_tr_b16 a[18:19], v44 offset:1024
    v_mfma_f32_16x16x32_bf16 v[236:239], a[44:47], a[244:247], v[236:239]
    s_add_u32 s61, s61, 0x80000
    ds_read_b64_tr_b16 a[20:21], v44 offset:8192
    v_mfma_f32_16x16x32_bf16 v[232:235], a[44:47], a[240:243], v[232:235]
    buffer_load_dwordx4 a[176:179], v36, s[8:11], s62 offen sc1
    ds_read_b64_tr_b16 a[22:23], v44 offset:9216
    v_mfma_f32_16x16x32_bf16 v[232:235], a[40:43], a[224:227], v[232:235]
    v_mfma_f32_16x16x32_bf16 v[240:243], a[48:51], a[224:227], v[240:243]
    ds_read_b64_tr_b16 a[24:25], v45 offset:0
    v_mfma_f32_16x16x32_bf16 v[240:243], a[52:55], a[240:243], v[240:243]
    buffer_load_dwordx4 a[180:183], v54, s[8:11], s62 offen sc1
    ds_read_b64_tr_b16 a[26:27], v45 offset:1024
    v_mfma_f32_16x16x32_bf16 v[244:247], a[52:55], a[244:247], v[244:247]
    ds_read_b64_tr_b16 a[28:29], v45 offset:8192
    v_mfma_f32_16x16x32_bf16 v[244:247], a[48:51], a[228:231], v[244:247]
    v_mfma_f32_16x16x32_bf16 a[112:115], a[48:51], a[232:235], a[112:115]
    buffer_load_dwordx4 a[184:187], v37, s[8:11], s62 offen sc1
    ds_read_b64_tr_b16 a[30:31], v45 offset:9216
    v_mfma_f32_16x16x32_bf16 a[112:115], a[52:55], a[248:251], a[112:115]
    v_mfma_f32_16x16x32_bf16 a[116:119], a[52:55], a[252:255], a[116:119]
    v_mfma_f32_16x16x32_bf16 a[116:119], a[48:51], a[236:239], a[116:119]
    v_mfma_f32_16x16x32_bf16 a[124:127], a[56:59], a[236:239], a[124:127]
    buffer_load_dwordx4 a[188:191], v55, s[8:11], s62 offen sc1
    v_mfma_f32_16x16x32_bf16 a[124:127], a[60:63], a[252:255], a[124:127]
    v_mfma_f32_16x16x32_bf16 a[120:123], a[60:63], a[248:251], a[120:123]
    s_add_u32 s62, s62, 0x20000
    v_mfma_f32_16x16x32_bf16 a[120:123], a[56:59], a[232:235], a[120:123]
    v_mfma_f32_16x16x32_bf16 v[252:255], a[56:59], a[228:231], v[252:255]
    v_mfma_f32_16x16x32_bf16 v[252:255], a[60:63], a[244:247], v[252:255]
    v_mfma_f32_16x16x32_bf16 v[248:251], a[60:63], a[240:243], v[248:251]
    v_mfma_f32_16x16x32_bf16 v[248:251], a[56:59], a[224:227], v[248:251]
    s_waitcnt vmcnt(14) lgkmcnt(0)
    v_mfma_f32_16x16x32_bf16 v[192:195], a[0:3], a[128:131], v[192:195]
    v_mfma_f32_16x16x32_bf16 v[192:195], a[4:7], a[144:147], v[192:195]
    buffer_load_dwordx4 a[192:195], v36, s[8:11], s62 offen sc1
    ds_read_b64_tr_b16 a[32:33], v46 offset:0
    v_mfma_f32_16x16x32_bf16 v[196:199], a[4:7], a[148:151], v[196:199]
    ds_read_b64_tr_b16 a[34:35], v46 offset:1024
    v_mfma_f32_16x16x32_bf16 v[196:199], a[0:3], a[132:135], v[196:199]
    ds_read_b64_tr_b16 a[36:37], v46 offset:8192
    v_mfma_f32_16x16x32_bf16 a[64:67], a[0:3], a[136:139], a[64:67]
    ds_read_b64_tr_b16 a[38:39], v46 offset:9216
    v_mfma_f32_16x16x32_bf16 a[64:67], a[4:7], a[152:155], a[64:67]
    ds_read_b64_tr_b16 a[40:41], v47 offset:0
    v_mfma_f32_16x16x32_bf16 a[68:71], a[4:7], a[156:159], a[68:71]
    buffer_load_dwordx4 a[196:199], v54, s[8:11], s62 offen sc1
    v_mfma_f32_16x16x32_bf16 a[68:71], a[0:3], a[140:143], a[68:71]
    ds_read_b64_tr_b16 a[42:43], v47 offset:1024
    v_mfma_f32_16x16x32_bf16 a[76:79], a[8:11], a[140:143], a[76:79]
    ds_read_b64_tr_b16 a[44:45], v47 offset:8192
    v_mfma_f32_16x16x32_bf16 a[76:79], a[12:15], a[156:159], a[76:79]
    ds_read_b64_tr_b16 a[46:47], v47 offset:9216
    v_mfma_f32_16x16x32_bf16 a[72:75], a[12:15], a[152:155], a[72:75]
    ds_read_b64_tr_b16 a[48:49], v48 offset:0
    v_mfma_f32_16x16x32_bf16 a[72:75], a[8:11], a[136:139], a[72:75]
    buffer_load_dwordx4 a[200:203], v37, s[8:11], s62 offen sc1
    v_mfma_f32_16x16x32_bf16 v[204:207], a[8:11], a[132:135], v[204:207]
    ds_read_b64_tr_b16 a[50:51], v48 offset:1024
    v_mfma_f32_16x16x32_bf16 v[204:207], a[12:15], a[148:151], v[204:207]
    ds_read_b64_tr_b16 a[52:53], v48 offset:8192
    v_mfma_f32_16x16x32_bf16 v[200:203], a[12:15], a[144:147], v[200:203]
    ds_read_b64_tr_b16 a[54:55], v48 offset:9216
    v_mfma_f32_16x16x32_bf16 v[200:203], a[8:11], a[128:131], v[200:203]
    v_mfma_f32_16x16x32_bf16 v[208:211], a[16:19], a[128:131], v[208:211]
    ds_read_b64_tr_b16 a[56:57], v49 offset:0
    v_mfma_f32_16x16x32_bf16 v[208:211], a[20:23], a[144:147], v[208:211]
    buffer_load_dwordx4 a[204:207], v55, s[8:11], s62 offen sc1
    ds_read_b64_tr_b16 a[58:59], v49 offset:1024
    v_mfma_f32_16x16x32_bf16 v[212:215], a[20:23], a[148:151], v[212:215]
    ds_read_b64_tr_b16 a[60:61], v49 offset:8192
    v_mfma_f32_16x16x32_bf16 v[212:215], a[16:19], a[132:135], v[212:215]
    v_mfma_f32_16x16x32_bf16 a[80:83], a[16:19], a[136:139], a[80:83]
    ds_read_b64_tr_b16 a[62:63], v49 offset:9216
    v_mfma_f32_16x16x32_bf16 a[80:83], a[20:23], a[152:155], a[80:83]
    s_add_u32 s62, s62, 0x20000
    v_mfma_f32_16x16x32_bf16 a[84:87], a[20:23], a[156:159], a[84:87]
    s_add_u32 s52, s47, 12288
    v_mfma_f32_16x16x32_bf16 a[84:87], a[16:19], a[140:143], a[84:87]
    buffer_store_dwordx4 v[116:119], v1, s[48:51], s52 offen offset:1024 sc1
    v_mfma_f32_16x16x32_bf16 a[92:95], a[24:27], a[140:143], a[92:95]
    v_mfma_f32_16x16x32_bf16 a[92:95], a[28:31], a[156:159], a[92:95]
    v_mfma_f32_16x16x32_bf16 a[88:91], a[28:31], a[152:155], a[88:91]
    v_mfma_f32_16x16x32_bf16 a[88:91], a[24:27], a[136:139], a[88:91]
    v_mfma_f32_16x16x32_bf16 v[220:223], a[24:27], a[132:135], v[220:223]
    s_cmp_eq_u32 s45, 0
    s_cbranch_scc1 k12_ool_58
k12_oolret_59:
    v_mfma_f32_16x16x32_bf16 v[220:223], a[28:31], a[148:151], v[220:223]
    v_mfma_f32_16x16x32_bf16 v[216:219], a[28:31], a[144:147], v[216:219]
    v_mfma_f32_16x16x32_bf16 v[216:219], a[24:27], a[128:131], v[216:219]
    s_waitcnt vmcnt(9) lgkmcnt(0)
    s_barrier
    v_mfma_f32_16x16x32_bf16 v[224:227], a[32:35], a[128:131], v[224:227]
    v_mfma_f32_16x16x32_bf16 v[224:227], a[36:39], a[144:147], v[224:227]
    s_add_u32 m0, s60, 131072
    ds_read_b64_tr_b16 a[0:1], v42 offset:16384
    ds_read_b64_tr_b16 a[2:3], v42 offset:17408
    v_mfma_f32_16x16x32_bf16 v[228:231], a[36:39], a[148:151], v[228:231]
    buffer_load_dwordx4 v38, s[12:15], s61 offen offset:0 lds
    v_mfma_f32_16x16x32_bf16 v[228:231], a[32:35], a[132:135], v[228:231]
    ds_read_b64_tr_b16 a[4:5], v42 offset:24576
    v_mfma_f32_16x16x32_bf16 a[96:99], a[32:35], a[136:139], a[96:99]
    buffer_load_dwordx4 v39, s[12:15], s61 offen offset:1024 lds
    ds_read_b64_tr_b16 a[6:7], v42 offset:25600
    v_mfma_f32_16x16x32_bf16 a[96:99], a[36:39], a[152:155], a[96:99]
    ds_read_b64_tr_b16 a[8:9], v43 offset:16384
    v_mfma_f32_16x16x32_bf16 a[100:103], a[36:39], a[156:159], a[100:103]
    v_mfma_f32_16x16x32_bf16 a[100:103], a[32:35], a[140:143], a[100:103]
    buffer_load_dwordx4 v40, s[12:15], s61 offen offset:2048 lds
    ds_read_b64_tr_b16 a[10:11], v43 offset:17408
    v_mfma_f32_16x16x32_bf16 a[108:111], a[40:43], a[140:143], a[108:111]
    ds_read_b64_tr_b16 a[12:13], v43 offset:24576
    v_mfma_f32_16x16x32_bf16 a[108:111], a[44:47], a[156:159], a[108:111]
    ds_read_b64_tr_b16 a[14:15], v43 offset:25600
    v_mfma_f32_16x16x32_bf16 a[104:107], a[44:47], a[152:155], a[104:107]
    buffer_load_dwordx4 v41, s[12:15], s61 offen offset:3072 lds
    ds_read_b64_tr_b16 a[16:17], v44 offset:16384
    v_mfma_f32_16x16x32_bf16 a[104:107], a[40:43], a[136:139], a[104:107]
    v_mfma_f32_16x16x32_bf16 v[236:239], a[40:43], a[132:135], v[236:239]
    s_add_u32 s61, s61, 0x80000
    ds_read_b64_tr_b16 a[18:19], v44 offset:17408
    v_mfma_f32_16x16x32_bf16 v[236:239], a[44:47], a[148:151], v[236:239]
    buffer_load_dwordx4 a[208:211], v36, s[8:11], s62 offen sc1
    ds_read_b64_tr_b16 a[20:21], v44 offset:24576
    v_mfma_f32_16x16x32_bf16 v[232:235], a[44:47], a[144:147], v[232:235]
    ds_read_b64_tr_b16 a[22:23], v44 offset:25600
    v_mfma_f32_16x16x32_bf16 v[232:235], a[40:43], a[128:131], v[232:235]
    buffer_load_dwordx4 a[212:215], v54, s[8:11], s62 offen sc1
    v_mfma_f32_16x16x32_bf16 v[240:243], a[48:51], a[128:131], v[240:243]
    ds_read_b64_tr_b16 a[24:25], v45 offset:16384
    v_mfma_f32_16x16x32_bf16 v[240:243], a[52:55], a[144:147], v[240:243]
    ds_read_b64_tr_b16 a[26:27], v45 offset:17408
    v_mfma_f32_16x16x32_bf16 v[244:247], a[52:55], a[148:151], v[244:247]
    buffer_load_dwordx4 a[216:219], v37, s[8:11], s62 offen sc1
    ds_read_b64_tr_b16 a[28:29], v45 offset:24576
    v_mfma_f32_16x16x32_bf16 v[244:247], a[48:51], a[132:135], v[244:247]
    v_mfma_f32_16x16x32_bf16 a[112:115], a[48:51], a[136:139], a[112:115]
    ds_read_b64_tr_b16 a[30:31], v45 offset:25600
    v_mfma_f32_16x16x32_bf16 a[112:115], a[52:55], a[152:155], a[112:115]
    buffer_load_dwordx4 a[220:223], v55, s[8:11], s62 offen sc1
    v_mfma_f32_16x16x32_bf16 a[116:119], a[52:55], a[156:159], a[116:119]
    v_mfma_f32_16x16x32_bf16 a[116:119], a[48:51], a[140:143], a[116:119]
    s_add_u32 s62, s62, 0x20000
    v_mfma_f32_16x16x32_bf16 a[124:127], a[56:59], a[140:143], a[124:127]
    s_add_u32 s52, s47, 12288
    v_mfma_f32_16x16x32_bf16 a[124:127], a[60:63], a[156:159], a[124:127]
    buffer_store_dwordx4 v[120:123], v1, s[48:51], s52 offen offset:2048 sc1
    v_mfma_f32_16x16x32_bf16 a[120:123], a[60:63], a[152:155], a[120:123]
    v_mfma_f32_16x16x32_bf16 a[120:123], a[56:59], a[136:139], a[120:123]
    v_mfma_f32_16x16x32_bf16 v[252:255], a[56:59], a[132:135], v[252:255]
    v_mfma_f32_16x16x32_bf16 v[252:255], a[60:63], a[148:151], v[252:255]
    v_mfma_f32_16x16x32_bf16 v[248:251], a[60:63], a[144:147], v[248:251]
    v_mfma_f32_16x16x32_bf16 v[248:251], a[56:59], a[128:131], v[248:251]
    s_waitcnt vmcnt(14) lgkmcnt(0)
    v_mfma_f32_16x16x32_bf16 v[192:195], a[0:3], a[160:163], v[192:195]
    v_mfma_f32_16x16x32_bf16 v[192:195], a[4:7], a[176:179], v[192:195]
    buffer_load_dwordx4 a[224:227], v36, s[8:11], s62 offen sc1
    ds_read_b64_tr_b16 a[32:33], v46 offset:16384
    v_mfma_f32_16x16x32_bf16 v[196:199], a[4:7], a[180:183], v[196:199]
    ds_read_b64_tr_b16 a[34:35], v46 offset:17408
    v_mfma_f32_16x16x32_bf16 v[196:199], a[0:3], a[164:167], v[196:199]
    ds_read_b64_tr_b16 a[36:37], v46 offset:24576
    v_mfma_f32_16x16x32_bf16 a[64:67], a[0:3], a[168:171], a[64:67]
    ds_read_b64_tr_b16 a[38:39], v46 offset:25600
    v_mfma_f32_16x16x32_bf16 a[64:67], a[4:7], a[184:187], a[64:67]
    ds_read_b64_tr_b16 a[40:41], v47 offset:16384
    v_mfma_f32_16x16x32_bf16 a[68:71], a[4:7], a[188:191], a[68:71]
    buffer_load_dwordx4 a[228:231], v54, s[8:11], s62 offen sc1
    v_mfma_f32_16x16x32_bf16 a[68:71], a[0:3], a[172:175], a[68:71]
    ds_read_b64_tr_b16 a[42:43], v47 offset:17408
    v_mfma_f32_16x16x32_bf16 a[76:79], a[8:11], a[172:175], a[76:79]
    ds_read_b64_tr_b16 a[44:45], v47 offset:24576
    v_mfma_f32_16x16x32_bf16 a[76:79], a[12:15], a[188:191], a[76:79]
    ds_read_b64_tr_b16 a[46:47], v47 offset:25600
    v_mfma_f32_16x16x32_bf16 a[72:75], a[12:15], a[184:187], a[72:75]
    ds_read_b64_tr_b16 a[48:49], v48 offset:16384
    v_mfma_f32_16x16x32_bf16 a[72:75], a[8:11], a[168:171], a[72:75]
    buffer_load_dwordx4 a[232:235], v37, s[8:11], s62 offen sc1
    v_mfma_f32_16x16x32_bf16 v[204:207], a[8:11], a[164:167], v[204:207]
    ds_read_b64_tr_b16 a[50:51], v48 offset:17408
    v_mfma_f32_16x16x32_bf16 v[204:207], a[12:15], a[180:183], v[204:207]
    ds_read_b64_tr_b16 a[52:53], v48 offset:24576
    v_mfma_f32_16x16x32_bf16 v[200:203], a[12:15], a[176:179], v[200:203]
    ds_read_b64_tr_b16 a[54:55], v48 offset:25600
    v_mfma_f32_16x16x32_bf16 v[200:203], a[8:11], a[160:163], v[200:203]
    v_mfma_f32_16x16x32_bf16 v[208:211], a[16:19], a[160:163], v[208:211]
    ds_read_b64_tr_b16 a[56:57], v49 offset:16384
    v_mfma_f32_16x16x32_bf16 v[208:211], a[20:23], a[176:179], v[208:211]
    buffer_load_dwordx4 a[236:239], v55, s[8:11], s62 offen sc1
    ds_read_b64_tr_b16 a[58:59], v49 offset:17408
    v_mfma_f32_16x16x32_bf16 v[212:215], a[20:23], a[180:183], v[212:215]
    ds_read_b64_tr_b16 a[60:61], v49 offset:24576
    v_mfma_f32_16x16x32_bf16 v[212:215], a[16:19], a[164:167], v[212:215]
    v_mfma_f32_16x16x32_bf16 a[80:83], a[16:19], a[168:171], a[80:83]
    ds_read_b64_tr_b16 a[62:63], v49 offset:25600
    v_mfma_f32_16x16x32_bf16 a[80:83], a[20:23], a[184:187], a[80:83]
    s_add_u32 s62, s62, 0x20000
    v_mfma_f32_16x16x32_bf16 a[84:87], a[20:23], a[188:191], a[84:87]
    s_add_u32 s52, s47, 12288
    v_mfma_f32_16x16x32_bf16 a[84:87], a[16:19], a[172:175], a[84:87]
    buffer_store_dwordx4 v[124:127], v1, s[48:51], s52 offen offset:3072 sc1
    v_mfma_f32_16x16x32_bf16 a[92:95], a[24:27], a[172:175], a[92:95]
    v_mfma_f32_16x16x32_bf16 a[92:95], a[28:31], a[188:191], a[92:95]
    v_mfma_f32_16x16x32_bf16 a[88:91], a[28:31], a[184:187], a[88:91]
    v_mfma_f32_16x16x32_bf16 a[88:91], a[24:27], a[168:171], a[88:91]
    v_mfma_f32_16x16x32_bf16 v[220:223], a[24:27], a[164:167], v[220:223]
    v_mfma_f32_16x16x32_bf16 v[220:223], a[28:31], a[180:183], v[220:223]
    v_mfma_f32_16x16x32_bf16 v[216:219], a[28:31], a[176:179], v[216:219]
    v_mfma_f32_16x16x32_bf16 v[216:219], a[24:27], a[160:163], v[216:219]
    s_waitcnt vmcnt(10) lgkmcnt(0)
    s_barrier
    v_mfma_f32_16x16x32_bf16 v[224:227], a[32:35], a[160:163], v[224:227]
    v_mfma_f32_16x16x32_bf16 v[224:227], a[36:39], a[176:179], v[224:227]
    s_add_u32 m0, s60, 147456
    ds_read_b64_tr_b16 a[0:1], v42 offset:32768
    ds_read_b64_tr_b16 a[2:3], v42 offset:33792
    v_mfma_f32_16x16x32_bf16 v[228:231], a[36:39], a[180:183], v[228:231]
    buffer_load_dwordx4 v38, s[12:15], s61 offen offset:0 lds
    v_mfma_f32_16x16x32_bf16 v[228:231], a[32:35], a[164:167], v[228:231]
    ds_read_b64_tr_b16 a[4:5], v42 offset:40960
    v_mfma_f32_16x16x32_bf16 a[96:99], a[32:35], a[168:171], a[96:99]
    buffer_load_dwordx4 v39, s[12:15], s61 offen offset:1024 lds
    ds_read_b64_tr_b16 a[6:7], v42 offset:41984
    v_mfma_f32_16x16x32_bf16 a[96:99], a[36:39], a[184:187], a[96:99]
    ds_read_b64_tr_b16 a[8:9], v43 offset:32768
    v_mfma_f32_16x16x32_bf16 a[100:103], a[36:39], a[188:191], a[100:103]
    v_mfma_f32_16x16x32_bf16 a[100:103], a[32:35], a[172:175], a[100:103]
    buffer_load_dwordx4 v40, s[12:15], s61 offen offset:2048 lds
    ds_read_b64_tr_b16 a[10:11], v43 offset:33792
    v_mfma_f32_16x16x32_bf16 a[108:111], a[40:43], a[172:175], a[108:111]
    ds_read_b64_tr_b16 a[12:13], v43 offset:40960
    v_mfma_f32_16x16x32_bf16 a[108:111], a[44:47], a[188:191], a[108:111]
    ds_read_b64_tr_b16 a[14:15], v43 offset:41984
    v_mfma_f32_16x16x32_bf16 a[104:107], a[44:47], a[184:187], a[104:107]
    buffer_load_dwordx4 v41, s[12:15], s61 offen offset:3072 lds
    ds_read_b64_tr_b16 a[16:17], v44 offset:32768
    v_mfma_f32_16x16x32_bf16 a[104:107], a[40:43], a[168:171], a[104:107]
    v_mfma_f32_16x16x32_bf16 v[236:239], a[40:43], a[164:167], v[236:239]
    s_add_u32 s61, s61, 0x80000
    ds_read_b64_tr_b16 a[18:19], v44 offset:33792
    v_mfma_f32_16x16x32_bf16 v[236:239], a[44:47], a[180:183], v[236:239]
    buffer_load_dwordx4 a[240:243], v36, s[8:11], s62 offen sc1
    ds_read_b64_tr_b16 a[20:21], v44 offset:40960
    v_mfma_f32_16x16x32_bf16 v[232:235], a[44:47], a[176:179], v[232:235]
    ds_read_b64_tr_b16 a[22:23], v44 offset:41984
    v_mfma_f32_16x16x32_bf16 v[232:235], a[40:43], a[160:163], v[232:235]
    buffer_load_dwordx4 a[244:247], v54, s[8:11], s62 offen sc1
    v_mfma_f32_16x16x32_bf16 v[240:243], a[48:51], a[160:163], v[240:243]
    ds_read_b64_tr_b16 a[24:25], v45 offset:32768
    v_mfma_f32_16x16x32_bf16 v[240:243], a[52:55], a[176:179], v[240:243]
    ds_read_b64_tr_b16 a[26:27], v45 offset:33792
    v_mfma_f32_16x16x32_bf16 v[244:247], a[52:55], a[180:183], v[244:247]
    buffer_load_dwordx4 a[248:251], v37, s[8:11], s62 offen sc1
    ds_read_b64_tr_b16 a[28:29], v45 offset:40960
    v_mfma_f32_16x16x32_bf16 v[244:247], a[48:51], a[164:167], v[244:247]
    v_mfma_f32_16x16x32_bf16 a[112:115], a[48:51], a[168:171], a[112:115]
    ds_read_b64_tr_b16 a[30:31], v45 offset:41984
    v_mfma_f32_16x16x32_bf16 a[112:115], a[52:55], a[184:187], a[112:115]
    buffer_load_dwordx4 a[252:255], v55, s[8:11], s62 offen sc1
    v_mfma_f32_16x16x32_bf16 a[116:119], a[52:55], a[188:191], a[116:119]
    v_mfma_f32_16x16x32_bf16 a[116:119], a[48:51], a[172:175], a[116:119]
    s_add_u32 s62, s62, 0x20000
    v_mfma_f32_16x16x32_bf16 a[124:127], a[56:59], a[172:175], a[124:127]
    s_add_u32 s52, s47, 524288
    v_mfma_f32_16x16x32_bf16 a[124:127], a[60:63], a[188:191], a[124:127]
    buffer_store_dwordx4 v[136:139], v1, s[48:51], s52 offen offset:2048 sc1
    v_mfma_f32_16x16x32_bf16 a[120:123], a[60:63], a[184:187], a[120:123]
    v_mfma_f32_16x16x32_bf16 a[120:123], a[56:59], a[168:171], a[120:123]
    v_mfma_f32_16x16x32_bf16 v[252:255], a[56:59], a[164:167], v[252:255]
    s_cmp_eq_u32 s45, 0
    s_cbranch_scc1 k12_ool_60
k12_oolret_61:
    v_mfma_f32_16x16x32_bf16 v[252:255], a[60:63], a[180:183], v[252:255]
    v_mfma_f32_16x16x32_bf16 v[248:251], a[60:63], a[176:179], v[248:251]
    v_mfma_f32_16x16x32_bf16 v[248:251], a[56:59], a[160:163], v[248:251]
    s_waitcnt vmcnt(15) lgkmcnt(0)
    v_mfma_f32_16x16x32_bf16 v[192:195], a[0:3], a[192:195], v[192:195]
    v_mfma_f32_16x16x32_bf16 v[192:195], a[4:7], a[208:211], v[192:195]
    buffer_load_dwordx4 a[128:131], v36, s[8:11], s62 offen sc1
    ds_read_b64_tr_b16 a[32:33], v46 offset:32768
    v_mfma_f32_16x16x32_bf16 v[196:199], a[4:7], a[212:215], v[196:199]
    ds_read_b64_tr_b16 a[34:35], v46 offset:33792
    v_mfma_f32_16x16x32_bf16 v[196:199], a[0:3], a[196:199], v[196:199]
    ds_read_b64_tr_b16 a[36:37], v46 offset:40960
    v_mfma_f32_16x16x32_bf16 a[64:67], a[0:3], a[200:203], a[64:67]
    ds_read_b64_tr_b16 a[38:39], v46 offset:41984
    v_mfma_f32_16x16x32_bf16 a[64:67], a[4:7], a[216:219], a[64:67]
    ds_read_b64_tr_b16 a[40:41], v47 offset:32768
    v_mfma_f32_16x16x32_bf16 a[68:71], a[4:7], a[220:223], a[68:71]
    buffer_load_dwordx4 a[132:135], v54, s[8:11], s62 offen sc1
    v_mfma_f32_16x16x32_bf16 a[68:71], a[0:3], a[204:207], a[68:71]
    ds_read_b64_tr_b16 a[42:43], v47 offset:33792
    v_mfma_f32_16x16x32_bf16 a[76:79], a[8:11], a[204:207], a[76:79]
    ds_read_b64_tr_b16 a[44:45], v47 offset:40960
    v_mfma_f32_16x16x32_bf16 a[76:79], a[12:15], a[220:223], a[76:79]
    ds_read_b64_tr_b16 a[46:47], v47 offset:41984
    v_mfma_f32_16x16x32_bf16 a[72:75], a[12:15], a[216:219], a[72:75]
    ds_read_b64_tr_b16 a[48:49], v48 offset:32768
    v_mfma_f32_16x16x32_bf16 a[72:75], a[8:11], a[200:203], a[72:75]
    buffer_load_dwordx4 a[136:139], v37, s[8:11], s62 offen sc1
    v_mfma_f32_16x16x32_bf16 v[204:207], a[8:11], a[196:199], v[204:207]
    ds_read_b64_tr_b16 a[50:51], v48 offset:33792
    v_mfma_f32_16x16x32_bf16 v[204:207], a[12:15], a[212:215], v[204:207]
    ds_read_b64_tr_b16 a[52:53], v48 offset:40960
    v_mfma_f32_16x16x32_bf16 v[200:203], a[12:15], a[208:211], v[200:203]
    ds_read_b64_tr_b16 a[54:55], v48 offset:41984
    v_mfma_f32_16x16x32_bf16 v[200:203], a[8:11], a[192:195], v[200:203]
    v_mfma_f32_16x16x32_bf16 v[208:211], a[16:19], a[192:195], v[208:211]
    ds_read_b64_tr_b16 a[56:57], v49 offset:32768
    v_mfma_f32_16x16x32_bf16 v[208:211], a[20:23], a[208:211], v[208:211]
    buffer_load_dwordx4 a[140:143], v55, s[8:11], s62 offen sc1
    ds_read_b64_tr_b16 a[58:59], v49 offset:33792
    v_mfma_f32_16x16x32_bf16 v[212:215], a[20:23], a[212:215], v[212:215]
    ds_read_b64_tr_b16 a[60:61], v49 offset:40960
    v_mfma_f32_16x16x32_bf16 v[212:215], a[16:19], a[196:199], v[212:215]
    v_mfma_f32_16x16x32_bf16 a[80:83], a[16:19], a[200:203], a[80:83]
    ds_read_b64_tr_b16 a[62:63], v49 offset:41984
    v_mfma_f32_16x16x32_bf16 a[80:83], a[20:23], a[216:219], a[80:83]
    s_add_u32 s62, s62, 0x20000
    v_mfma_f32_16x16x32_bf16 a[84:87], a[20:23], a[220:223], a[84:87]
    s_add_u32 s52, s47, 524288
    v_mfma_f32_16x16x32_bf16 a[84:87], a[16:19], a[204:207], a[84:87]
    buffer_store_dwordx4 v[140:143], v1, s[48:51], s52 offen offset:3072 sc1
    v_mfma_f32_16x16x32_bf16 a[92:95], a[24:27], a[204:207], a[92:95]
    v_mfma_f32_16x16x32_bf16 a[92:95], a[28:31], a[220:223], a[92:95]
    v_mfma_f32_16x16x32_bf16 a[88:91], a[28:31], a[216:219], a[88:91]
    v_mfma_f32_16x16x32_bf16 a[88:91], a[24:27], a[200:203], a[88:91]
    v_mfma_f32_16x16x32_bf16 v[220:223], a[24:27], a[196:199], v[220:223]
    v_mfma_f32_16x16x32_bf16 v[220:223], a[28:31], a[212:215], v[220:223]
    v_mfma_f32_16x16x32_bf16 v[216:219], a[28:31], a[208:211], v[216:219]
    v_mfma_f32_16x16x32_bf16 v[216:219], a[24:27], a[192:195], v[216:219]
    s_waitcnt vmcnt(10) lgkmcnt(0)
    s_barrier
    v_mfma_f32_16x16x32_bf16 v[224:227], a[32:35], a[192:195], v[224:227]
    v_mfma_f32_16x16x32_bf16 v[224:227], a[36:39], a[208:211], v[224:227]
    s_add_u32 m0, s60, 98304
    ds_read_b64_tr_b16 a[0:1], v42 offset:49152
    ds_read_b64_tr_b16 a[2:3], v42 offset:50176
    v_mfma_f32_16x16x32_bf16 v[228:231], a[36:39], a[212:215], v[228:231]
    buffer_load_dwordx4 v38, s[12:15], s61 offen offset:0 lds
    v_mfma_f32_16x16x32_bf16 v[228:231], a[32:35], a[196:199], v[228:231]
    ds_read_b64_tr_b16 a[4:5], v42 offset:57344
    v_mfma_f32_16x16x32_bf16 a[96:99], a[32:35], a[200:203], a[96:99]
    buffer_load_dwordx4 v39, s[12:15], s61 offen offset:1024 lds
    ds_read_b64_tr_b16 a[6:7], v42 offset:58368
    v_mfma_f32_16x16x32_bf16 a[96:99], a[36:39], a[216:219], a[96:99]
    ds_read_b64_tr_b16 a[8:9], v43 offset:49152
    v_mfma_f32_16x16x32_bf16 a[100:103], a[36:39], a[220:223], a[100:103]
    v_mfma_f32_16x16x32_bf16 a[100:103], a[32:35], a[204:207], a[100:103]
    buffer_load_dwordx4 v40, s[12:15], s61 offen offset:2048 lds
    ds_read_b64_tr_b16 a[10:11], v43 offset:50176
    v_mfma_f32_16x16x32_bf16 a[108:111], a[40:43], a[204:207], a[108:111]
    ds_read_b64_tr_b16 a[12:13], v43 offset:57344
    v_mfma_f32_16x16x32_bf16 a[108:111], a[44:47], a[220:223], a[108:111]
    ds_read_b64_tr_b16 a[14:15], v43 offset:58368
    v_mfma_f32_16x16x32_bf16 a[104:107], a[44:47], a[216:219], a[104:107]
    ds_read_b64_tr_b16 a[16:17], v44 offset:49152
    v_mfma_f32_16x16x32_bf16 a[104:107], a[40:43], a[200:203], a[104:107]
    buffer_load_dwordx4 v41, s[12:15], s61 offen offset:3072 lds
    v_mfma_f32_16x16x32_bf16 v[236:239], a[40:43], a[196:199], v[236:239]
    ds_read_b64_tr_b16 a[18:19], v44 offset:50176
    v_mfma_f32_16x16x32_bf16 v[236:239], a[44:47], a[212:215], v[236:239]
    s_add_u32 s61, s61, 0x80000
    ds_read_b64_tr_b16 a[20:21], v44 offset:57344
    v_mfma_f32_16x16x32_bf16 v[232:235], a[44:47], a[208:211], v[232:235]
    buffer_load_dwordx4 a[144:147], v36, s[8:11], s62 offen sc1
    ds_read_b64_tr_b16 a[22:23], v44 offset:58368
    v_mfma_f32_16x16x32_bf16 v[232:235], a[40:43], a[192:195], v[232:235]
    v_mfma_f32_16x16x32_bf16 v[240:243], a[48:51], a[192:195], v[240:243]
    ds_read_b64_tr_b16 a[24:25], v45 offset:49152
    v_mfma_f32_16x16x32_bf16 v[240:243], a[52:55], a[208:211], v[240:243]
    buffer_load_dwordx4 a[148:151], v54, s[8:11], s62 offen sc1
    ds_read_b64_tr_b16 a[26:27], v45 offset:50176
    v_mfma_f32_16x16x32_bf16 v[244:247], a[52:55], a[212:215], v[244:247]
    ds_read_b64_tr_b16 a[28:29], v45 offset:57344
    v_mfma_f32_16x16x32_bf16 v[244:247], a[48:51], a[196:199], v[244:247]
    v_mfma_f32_16x16x32_bf16 a[112:115], a[48:51], a[200:203], a[112:115]
    buffer_load_dwordx4 a[152:155], v37, s[8:11], s62 offen sc1
    ds_read_b64_tr_b16 a[30:31], v45 offset:58368
    v_mfma_f32_16x16x32_bf16 a[112:115], a[52:55], a[216:219], a[112:115]
    v_mfma_f32_16x16x32_bf16 a[116:119], a[52:55], a[220:223], a[116:119]
    v_mfma_f32_16x16x32_bf16 a[116:119], a[48:51], a[204:207], a[116:119]
    v_mfma_f32_16x16x32_bf16 a[124:127], a[56:59], a[204:207], a[124:127]
    buffer_load_dwordx4 a[156:159], v55, s[8:11], s62 offen sc1
    v_mfma_f32_16x16x32_bf16 a[124:127], a[60:63], a[220:223], a[124:127]
    v_mfma_f32_16x16x32_bf16 a[120:123], a[60:63], a[216:219], a[120:123]
    s_add_u32 s62, s62, 0x20000
    v_mfma_f32_16x16x32_bf16 a[120:123], a[56:59], a[200:203], a[120:123]
    v_mfma_f32_16x16x32_bf16 v[252:255], a[56:59], a[196:199], v[252:255]
    s_cmp_eq_u32 s45, 0
    s_cbranch_scc1 k12_ool_62
k12_oolret_63:
    v_mfma_f32_16x16x32_bf16 v[252:255], a[60:63], a[212:215], v[252:255]
    v_mfma_f32_16x16x32_bf16 v[248:251], a[60:63], a[208:211], v[248:251]
    v_mfma_f32_16x16x32_bf16 v[248:251], a[56:59], a[192:195], v[248:251]
    s_waitcnt vmcnt(14) lgkmcnt(0)
    v_mfma_f32_16x16x32_bf16 v[192:195], a[0:3], a[224:227], v[192:195]
    v_mfma_f32_16x16x32_bf16 v[192:195], a[4:7], a[240:243], v[192:195]
    buffer_load_dwordx4 a[160:163], v36, s[8:11], s62 offen sc1
    ds_read_b64_tr_b16 a[32:33], v46 offset:49152
    v_mfma_f32_16x16x32_bf16 v[196:199], a[4:7], a[244:247], v[196:199]
    ds_read_b64_tr_b16 a[34:35], v46 offset:50176
    v_mfma_f32_16x16x32_bf16 v[196:199], a[0:3], a[228:231], v[196:199]
    ds_read_b64_tr_b16 a[36:37], v46 offset:57344
    v_mfma_f32_16x16x32_bf16 a[64:67], a[0:3], a[232:235], a[64:67]
    ds_read_b64_tr_b16 a[38:39], v46 offset:58368
    v_mfma_f32_16x16x32_bf16 a[64:67], a[4:7], a[248:251], a[64:67]
    ds_read_b64_tr_b16 a[40:41], v47 offset:49152
    v_mfma_f32_16x16x32_bf16 a[68:71], a[4:7], a[252:255], a[68:71]
    buffer_load_dwordx4 a[164:167], v54, s[8:11], s62 offen sc1
    v_mfma_f32_16x16x32_bf16 a[68:71], a[0:3], a[236:239], a[68:71]
    ds_read_b64_tr_b16 a[42:43], v47 offset:50176
    v_mfma_f32_16x16x32_bf16 a[76:79], a[8:11], a[236:239], a[76:79]
    ds_read_b64_tr_b16 a[44:45], v47 offset:57344
    v_mfma_f32_16x16x32_bf16 a[76:79], a[12:15], a[252:255], a[76:79]
    ds_read_b64_tr_b16 a[46:47], v47 offset:58368
    v_mfma_f32_16x16x32_bf16 a[72:75], a[12:15], a[248:251], a[72:75]
    ds_read_b64_tr_b16 a[48:49], v48 offset:49152
    v_mfma_f32_16x16x32_bf16 a[72:75], a[8:11], a[232:235], a[72:75]
    buffer_load_dwordx4 a[168:171], v37, s[8:11], s62 offen sc1
    v_mfma_f32_16x16x32_bf16 v[204:207], a[8:11], a[228:231], v[204:207]
    ds_read_b64_tr_b16 a[50:51], v48 offset:50176
    v_mfma_f32_16x16x32_bf16 v[204:207], a[12:15], a[244:247], v[204:207]
    ds_read_b64_tr_b16 a[52:53], v48 offset:57344
    v_mfma_f32_16x16x32_bf16 v[200:203], a[12:15], a[240:243], v[200:203]
    ds_read_b64_tr_b16 a[54:55], v48 offset:58368
    v_mfma_f32_16x16x32_bf16 v[200:203], a[8:11], a[224:227], v[200:203]
    v_mfma_f32_16x16x32_bf16 v[208:211], a[16:19], a[224:227], v[208:211]
    ds_read_b64_tr_b16 a[56:57], v49 offset:49152
    v_mfma_f32_16x16x32_bf16 v[208:211], a[20:23], a[240:243], v[208:211]
    buffer_load_dwordx4 a[172:175], v55, s[8:11], s62 offen sc1
    ds_read_b64_tr_b16 a[58:59], v49 offset:50176
    v_mfma_f32_16x16x32_bf16 v[212:215], a[20:23], a[244:247], v[212:215]
    ds_read_b64_tr_b16 a[60:61], v49 offset:57344
    v_mfma_f32_16x16x32_bf16 v[212:215], a[16:19], a[228:231], v[212:215]
    v_mfma_f32_16x16x32_bf16 a[80:83], a[16:19], a[232:235], a[80:83]
    ds_read_b64_tr_b16 a[62:63], v49 offset:58368
    v_mfma_f32_16x16x32_bf16 a[80:83], a[20:23], a[248:251], a[80:83]
    s_add_u32 s62, s62, 0x20000
    v_mfma_f32_16x16x32_bf16 a[84:87], a[20:23], a[252:255], a[84:87]
    s_add_u32 s52, s47, 528384
    v_mfma_f32_16x16x32_bf16 a[84:87], a[16:19], a[236:239], a[84:87]
    buffer_store_dwordx4 v[144:147], v1, s[48:51], s52 offen offset:0 sc1
    v_mfma_f32_16x16x32_bf16 a[92:95], a[24:27], a[236:239], a[92:95]
    v_mfma_f32_16x16x32_bf16 a[92:95], a[28:31], a[252:255], a[92:95]
    v_mfma_f32_16x16x32_bf16 a[88:91], a[28:31], a[248:251], a[88:91]
    v_mfma_f32_16x16x32_bf16 a[88:91], a[24:27], a[232:235], a[88:91]
    v_mfma_f32_16x16x32_bf16 v[220:223], a[24:27], a[228:231], v[220:223]
    v_mfma_f32_16x16x32_bf16 v[220:223], a[28:31], a[244:247], v[220:223]
    v_mfma_f32_16x16x32_bf16 v[216:219], a[28:31], a[240:243], v[216:219]
    v_mfma_f32_16x16x32_bf16 v[216:219], a[24:27], a[224:227], v[216:219]
    s_waitcnt vmcnt(9) lgkmcnt(0)
    s_barrier
    v_mfma_f32_16x16x32_bf16 v[224:227], a[32:35], a[224:227], v[224:227]
    v_mfma_f32_16x16x32_bf16 v[224:227], a[36:39], a[240:243], v[224:227]
    s_add_u32 m0, s60, 114688
    ds_read_b64_tr_b16 a[0:1], v42 offset:0
    ds_read_b64_tr_b16 a[2:3], v42 offset:1024
    v_mfma_f32_16x16x32_bf16 v[228:231], a[36:39], a[244:247], v[228:231]
    buffer_load_dwordx4 v38, s[12:15], s61 offen offset:0 lds
    v_mfma_f32_16x16x32_bf16 v[228:231], a[32:35], a[228:231], v[228:231]
    ds_read_b64_tr_b16 a[4:5], v42 offset:8192
    v_mfma_f32_16x16x32_bf16 a[96:99], a[32:35], a[232:235], a[96:99]
    buffer_load_dwordx4 v39, s[12:15], s61 offen offset:1024 lds
    ds_read_b64_tr_b16 a[6:7], v42 offset:9216
    v_mfma_f32_16x16x32_bf16 a[96:99], a[36:39], a[248:251], a[96:99]
    ds_read_b64_tr_b16 a[8:9], v43 offset:0
    v_mfma_f32_16x16x32_bf16 a[100:103], a[36:39], a[252:255], a[100:103]
    v_mfma_f32_16x16x32_bf16 a[100:103], a[32:35], a[236:239], a[100:103]
    buffer_load_dwordx4 v40, s[12:15], s61 offen offset:2048 lds
    ds_read_b64_tr_b16 a[10:11], v43 offset:1024
    v_mfma_f32_16x16x32_bf16 a[108:111], a[40:43], a[236:239], a[108:111]
    ds_read_b64_tr_b16 a[12:13], v43 offset:8192
    v_mfma_f32_16x16x32_bf16 a[108:111], a[44:47], a[252:255], a[108:111]
    ds_read_b64_tr_b16 a[14:15], v43 offset:9216
    v_mfma_f32_16x16x32_bf16 a[104:107], a[44:47], a[248:251], a[104:107]
    buffer_load_dwordx4 v41, s[12:15], s61 offen offset:3072 lds
    ds_read_b64_tr_b16 a[16:17], v44 offset:0
    v_mfma_f32_16x16x32_bf16 a[104:107], a[40:43], a[232:235], a[104:107]
    v_mfma_f32_16x16x32_bf16 v[236:239], a[40:43], a[228:231], v[236:239]
    s_add_u32 s61, s61, 0x80000
    ds_read_b64_tr_b16 a[18:19], v44 offset:1024
    v_mfma_f32_16x16x32_bf16 v[236:239], a[44:47], a[244:247], v[236:239]
    buffer_load_dwordx4 a[176:179], v36, s[8:11], s62 offen sc1
    ds_read_b64_tr_b16 a[20:21], v44 offset:8192
    v_mfma_f32_16x16x32_bf16 v[232:235], a[44:47], a[240:243], v[232:235]
    ds_read_b64_tr_b16 a[22:23], v44 offset:9216
    v_mfma_f32_16x16x32_bf16 v[232:235], a[40:43], a[224:227], v[232:235]
    buffer_load_dwordx4 a[180:183], v54, s[8:11], s62 offen sc1
    v_mfma_f32_16x16x32_bf16 v[240:243], a[48:51], a[224:227], v[240:243]
    ds_read_b64_tr_b16 a[24:25], v45 offset:0
    v_mfma_f32_16x16x32_bf16 v[240:243], a[52:55], a[240:243], v[240:243]
    ds_read_b64_tr_b16 a[26:27], v45 offset:1024
    v_mfma_f32_16x16x32_bf16 v[244:247], a[52:55], a[244:247], v[244:247]
    buffer_load_dwordx4 a[184:187], v37, s[8:11], s62 offen sc1
    ds_read_b64_tr_b16 a[28:29], v45 offset:8192
    v_mfma_f32_16x16x32_bf16 v[244:247], a[48:51], a[228:231], v[244:247]
    v_mfma_f32_16x16x32_bf16 a[112:115], a[48:51], a[232:235], a[112:115]
    ds_read_b64_tr_b16 a[30:31], v45 offset:9216
    v_mfma_f32_16x16x32_bf16 a[112:115], a[52:55], a[248:251], a[112:115]
    buffer_load_dwordx4 a[188:191], v55, s[8:11], s62 offen sc1
    v_mfma_f32_16x16x32_bf16 a[116:119], a[52:55], a[252:255], a[116:119]
    v_mfma_f32_16x16x32_bf16 a[116:119], a[48:51], a[236:239], a[116:119]
    s_add_u32 s62, s62, 0x20000
    v_mfma_f32_16x16x32_bf16 a[124:127], a[56:59], a[236:239], a[124:127]
    s_add_u32 s52, s47, 528384
    v_mfma_f32_16x16x32_bf16 a[124:127], a[60:63], a[252:255], a[124:127]
    buffer_store_dwordx4 v[148:151], v1, s[48:51], s52 offen offset:1024 sc1
    v_mfma_f32_16x16x32_bf16 a[120:123], a[60:63], a[248:251], a[120:123]
    v_mfma_f32_16x16x32_bf16 a[120:123], a[56:59], a[232:235], a[120:123]
    v_mfma_f32_16x16x32_bf16 v[252:255], a[56:59], a[228:231], v[252:255]
    s_cmp_eq_u32 s45, 0
    s_cbranch_scc1 k12_ool_64
k12_oolret_65:
    v_mfma_f32_16x16x32_bf16 v[252:255], a[60:63], a[244:247], v[252:255]
    v_mfma_f32_16x16x32_bf16 v[248:251], a[60:63], a[240:243], v[248:251]
    v_mfma_f32_16x16x32_bf16 v[248:251], a[56:59], a[224:227], v[248:251]
    s_waitcnt vmcnt(14) lgkmcnt(0)
    v_mfma_f32_16x16x32_bf16 v[192:195], a[0:3], a[128:131], v[192:195]
    v_mfma_f32_16x16x32_bf16 v[192:195], a[4:7], a[144:147], v[192:195]
    buffer_load_dwordx4 a[192:195], v36, s[8:11], s62 offen sc1
    ds_read_b64_tr_b16 a[32:33], v46 offset:0
    v_mfma_f32_16x16x32_bf16 v[196:199], a[4:7], a[148:151], v[196:199]
    ds_read_b64_tr_b16 a[34:35], v46 offset:1024
    v_mfma_f32_16x16x32_bf16 v[196:199], a[0:3], a[132:135], v[196:199]
    ds_read_b64_tr_b16 a[36:37], v46 offset:8192
    v_mfma_f32_16x16x32_bf16 a[64:67], a[0:3], a[136:139], a[64:67]
    ds_read_b64_tr_b16 a[38:39], v46 offset:9216
    v_mfma_f32_16x16x32_bf16 a[64:67], a[4:7], a[152:155], a[64:67]
    ds_read_b64_tr_b16 a[40:41], v47 offset:0
    v_mfma_f32_16x16x32_bf16 a[68:71], a[4:7], a[156:159], a[68:71]
    buffer_load_dwordx4 a[196:199], v54, s[8:11], s62 offen sc1
    v_mfma_f32_16x16x32_bf16 a[68:71], a[0:3], a[140:143], a[68:71]
    ds_read_b64_tr_b16 a[42:43], v47 offset:1024
    v_mfma_f32_16x16x32_bf16 a[76:79], a[8:11], a[140:143], a[76:79]
    ds_read_b64_tr_b16 a[44:45], v47 offset:8192
    v_mfma_f32_16x16x32_bf16 a[76:79], a[12:15], a[156:159], a[76:79]
    ds_read_b64_tr_b16 a[46:47], v47 offset:9216
    v_mfma_f32_16x16x32_bf16 a[72:75], a[12:15], a[152:155], a[72:75]
    ds_read_b64_tr_b16 a[48:49], v48 offset:0
    v_mfma_f32_16x16x32_bf16 a[72:75], a[8:11], a[136:139], a[72:75]
    buffer_load_dwordx4 a[200:203], v37, s[8:11], s62 offen sc1
    v_mfma_f32_16x16x32_bf16 v[204:207], a[8:11], a[132:135], v[204:207]
    ds_read_b64_tr_b16 a[50:51], v48 offset:1024
    v_mfma_f32_16x16x32_bf16 v[204:207], a[12:15], a[148:151], v[204:207]
    ds_read_b64_tr_b16 a[52:53], v48 offset:8192
    v_mfma_f32_16x16x32_bf16 v[200:203], a[12:15], a[144:147], v[200:203]
    ds_read_b64_tr_b16 a[54:55], v48 offset:9216
    v_mfma_f32_16x16x32_bf16 v[200:203], a[8:11], a[128:131], v[200:203]
    v_mfma_f32_16x16x32_bf16 v[208:211], a[16:19], a[128:131], v[208:211]
    ds_read_b64_tr_b16 a[56:57], v49 offset:0
    v_mfma_f32_16x16x32_bf16 v[208:211], a[20:23], a[144:147], v[208:211]
    buffer_load_dwordx4 a[204:207], v55, s[8:11], s62 offen sc1
    ds_read_b64_tr_b16 a[58:59], v49 offset:1024
    v_mfma_f32_16x16x32_bf16 v[212:215], a[20:23], a[148:151], v[212:215]
    ds_read_b64_tr_b16 a[60:61], v49 offset:8192
    v_mfma_f32_16x16x32_bf16 v[212:215], a[16:19], a[132:135], v[212:215]
    v_mfma_f32_16x16x32_bf16 a[80:83], a[16:19], a[136:139], a[80:83]
    ds_read_b64_tr_b16 a[62:63], v49 offset:9216
    v_mfma_f32_16x16x32_bf16 a[80:83], a[20:23], a[152:155], a[80:83]
    s_add_u32 s62, s62, 0x20000
    v_mfma_f32_16x16x32_bf16 a[84:87], a[20:23], a[156:159], a[84:87]
    s_add_u32 s52, s47, 528384
    v_mfma_f32_16x16x32_bf16 a[84:87], a[16:19], a[140:143], a[84:87]
    buffer_store_dwordx4 v[152:155], v1, s[48:51], s52 offen offset:2048 sc1
    v_mfma_f32_16x16x32_bf16 a[92:95], a[24:27], a[140:143], a[92:95]
    v_mfma_f32_16x16x32_bf16 a[92:95], a[28:31], a[156:159], a[92:95]
    v_mfma_f32_16x16x32_bf16 a[88:91], a[28:31], a[152:155], a[88:91]
    v_mfma_f32_16x16x32_bf16 a[88:91], a[24:27], a[136:139], a[88:91]
    v_mfma_f32_16x16x32_bf16 v[220:223], a[24:27], a[132:135], v[220:223]
    v_mfma_f32_16x16x32_bf16 v[220:223], a[28:31], a[148:151], v[220:223]
    v_mfma_f32_16x16x32_bf16 v[216:219], a[28:31], a[144:147], v[216:219]
    v_mfma_f32_16x16x32_bf16 v[216:219], a[24:27], a[128:131], v[216:219]
    s_waitcnt vmcnt(10) lgkmcnt(0)
    s_barrier
    v_mfma_f32_16x16x32_bf16 v[224:227], a[32:35], a[128:131], v[224:227]
    v_mfma_f32_16x16x32_bf16 v[224:227], a[36:39], a[144:147], v[224:227]
    s_add_u32 m0, s60, 131072
    ds_read_b64_tr_b16 a[0:1], v42 offset:16384
    ds_read_b64_tr_b16 a[2:3], v42 offset:17408
    v_mfma_f32_16x16x32_bf16 v[228:231], a[36:39], a[148:151], v[228:231]
    buffer_load_dwordx4 v38, s[12:15], s61 offen offset:0 lds
    v_mfma_f32_16x16x32_bf16 v[228:231], a[32:35], a[132:135], v[228:231]
    ds_read_b64_tr_b16 a[4:5], v42 offset:24576
    v_mfma_f32_16x16x32_bf16 a[96:99], a[32:35], a[136:139], a[96:99]
    buffer_load_dwordx4 v39, s[12:15], s61 offen offset:1024 lds
    ds_read_b64_tr_b16 a[6:7], v42 offset:25600
    v_mfma_f32_16x16x32_bf16 a[96:99], a[36:39], a[152:155], a[96:99]
    ds_read_b64_tr_b16 a[8:9], v43 offset:16384
    v_mfma_f32_16x16x32_bf16 a[100:103], a[36:39], a[156:159], a[100:103]
    v_mfma_f32_16x16x32_bf16 a[100:103], a[32:35], a[140:143], a[100:103]
    buffer_load_dwordx4 v40, s[12:15], s61 offen offset:2048 lds
    ds_read_b64_tr_b16 a[10:11], v43 offset:17408
    v_mfma_f32_16x16x32_bf16 a[108:111], a[40:43], a[140:143], a[108:111]
    ds_read_b64_tr_b16 a[12:13], v43 offset:24576
    v_mfma_f32_16x16x32_bf16 a[108:111], a[44:47], a[156:159], a[108:111]
    ds_read_b64_tr_b16 a[14:15], v43 offset:25600
    v_mfma_f32_16x16x32_bf16 a[104:107], a[44:47], a[152:155], a[104:107]
    buffer_load_dwordx4 v41, s[12:15], s61 offen offset:3072 lds
    ds_read_b64_tr_b16 a[16:17], v44 offset:16384
    v_mfma_f32_16x16x32_bf16 a[104:107], a[40:43], a[136:139], a[104:107]
    v_mfma_f32_16x16x32_bf16 v[236:239], a[40:43], a[132:135], v[236:239]
    s_add_u32 s61, s61, 0x80000
    ds_read_b64_tr_b16 a[18:19], v44 offset:17408
    v_mfma_f32_16x16x32_bf16 v[236:239], a[44:47], a[148:151], v[236:239]
    buffer_load_dwordx4 a[208:211], v36, s[8:11], s62 offen sc1
    ds_read_b64_tr_b16 a[20:21], v44 offset:24576
    v_mfma_f32_16x16x32_bf16 v[232:235], a[44:47], a[144:147], v[232:235]
    ds_read_b64_tr_b16 a[22:23], v44 offset:25600
    v_mfma_f32_16x16x32_bf16 v[232:235], a[40:43], a[128:131], v[232:235]
    buffer_load_dwordx4 a[212:215], v54, s[8:11], s62 offen sc1
    v_mfma_f32_16x16x32_bf16 v[240:243], a[48:51], a[128:131], v[240:243]
    ds_read_b64_tr_b16 a[24:25], v45 offset:16384
    v_mfma_f32_16x16x32_bf16 v[240:243], a[52:55], a[144:147], v[240:243]
    ds_read_b64_tr_b16 a[26:27], v45 offset:17408
    v_mfma_f32_16x16x32_bf16 v[244:247], a[52:55], a[148:151], v[244:247]
    buffer_load_dwordx4 a[216:219], v37, s[8:11], s62 offen sc1
    ds_read_b64_tr_b16 a[28:29], v45 offset:24576
    v_mfma_f32_16x16x32_bf16 v[244:247], a[48:51], a[132:135], v[244:247]
    v_mfma_f32_16x16x32_bf16 a[112:115], a[48:51], a[136:139], a[112:115]
    ds_read_b64_tr_b16 a[30:31], v45 offset:25600
    v_mfma_f32_16x16x32_bf16 a[112:115], a[52:55], a[152:155], a[112:115]
    buffer_load_dwordx4 a[220:223], v55, s[8:11], s62 offen sc1
    v_mfma_f32_16x16x32_bf16 a[116:119], a[52:55], a[156:159], a[116:119]
    v_mfma_f32_16x16x32_bf16 a[116:119], a[48:51], a[140:143], a[116:119]
    s_add_u32 s62, s62, 0x20000
    v_mfma_f32_16x16x32_bf16 a[124:127], a[56:59], a[140:143], a[124:127]
    s_add_u32 s52, s47, 528384
    v_mfma_f32_16x16x32_bf16 a[124:127], a[60:63], a[156:159], a[124:127]
    buffer_store_dwordx4 v[156:159], v1, s[48:51], s52 offen offset:3072 sc1
    v_mfma_f32_16x16x32_bf16 a[120:123], a[60:63], a[152:155], a[120:123]
    v_mfma_f32_16x16x32_bf16 a[120:123], a[56:59], a[136:139], a[120:123]
    v_mfma_f32_16x16x32_bf16 v[252:255], a[56:59], a[132:135], v[252:255]
    v_mfma_f32_16x16x32_bf16 v[252:255], a[60:63], a[148:151], v[252:255]
    v_mfma_f32_16x16x32_bf16 v[248:251], a[60:63], a[144:147], v[248:251]
    v_mfma_f32_16x16x32_bf16 v[248:251], a[56:59], a[128:131], v[248:251]
    s_waitcnt vmcnt(15) lgkmcnt(0)
    v_mfma_f32_16x16x32_bf16 v[192:195], a[0:3], a[160:163], v[192:195]
    v_mfma_f32_16x16x32_bf16 v[192:195], a[4:7], a[176:179], v[192:195]
    buffer_load_dwordx4 a[224:227], v36, s[8:11], s62 offen sc1
    ds_read_b64_tr_b16 a[32:33], v46 offset:16384
    v_mfma_f32_16x16x32_bf16 v[196:199], a[4:7], a[180:183], v[196:199]
    ds_read_b64_tr_b16 a[34:35], v46 offset:17408
    v_mfma_f32_16x16x32_bf16 v[196:199], a[0:3], a[164:167], v[196:199]
    ds_read_b64_tr_b16 a[36:37], v46 offset:24576
    v_mfma_f32_16x16x32_bf16 a[64:67], a[0:3], a[168:171], a[64:67]
    ds_read_b64_tr_b16 a[38:39], v46 offset:25600
    v_mfma_f32_16x16x32_bf16 a[64:67], a[4:7], a[184:187], a[64:67]
    ds_read_b64_tr_b16 a[40:41], v47 offset:16384
    v_mfma_f32_16x16x32_bf16 a[68:71], a[4:7], a[188:191], a[68:71]
    buffer_load_dwordx4 a[228:231], v54, s[8:11], s62 offen sc1
    v_mfma_f32_16x16x32_bf16 a[68:71], a[0:3], a[172:175], a[68:71]
    ds_read_b64_tr_b16 a[42:43], v47 offset:17408
    v_mfma_f32_16x16x32_bf16 a[76:79], a[8:11], a[172:175], a[76:79]
    ds_read_b64_tr_b16 a[44:45], v47 offset:24576
    v_mfma_f32_16x16x32_bf16 a[76:79], a[12:15], a[188:191], a[76:79]
    ds_read_b64_tr_b16 a[46:47], v47 offset:25600
    v_mfma_f32_16x16x32_bf16 a[72:75], a[12:15], a[184:187], a[72:75]
    ds_read_b64_tr_b16 a[48:49], v48 offset:16384
    v_mfma_f32_16x16x32_bf16 a[72:75], a[8:11], a[168:171], a[72:75]
    buffer_load_dwordx4 a[232:235], v37, s[8:11], s62 offen sc1
    v_mfma_f32_16x16x32_bf16 v[204:207], a[8:11], a[164:167], v[204:207]
    ds_read_b64_tr_b16 a[50:51], v48 offset:17408
    v_mfma_f32_16x16x32_bf16 v[204:207], a[12:15], a[180:183], v[204:207]
    ds_read_b64_tr_b16 a[52:53], v48 offset:24576
    v_mfma_f32_16x16x32_bf16 v[200:203], a[12:15], a[176:179], v[200:203]
    ds_read_b64_tr_b16 a[54:55], v48 offset:25600
    v_mfma_f32_16x16x32_bf16 v[200:203], a[8:11], a[160:163], v[200:203]
    v_mfma_f32_16x16x32_bf16 v[208:211], a[16:19], a[160:163], v[208:211]
    ds_read_b64_tr_b16 a[56:57], v49 offset:16384
    v_mfma_f32_16x16x32_bf16 v[208:211], a[20:23], a[176:179], v[208:211]
    buffer_load_dwordx4 a[236:239], v55, s[8:11], s62 offen sc1
    ds_read_b64_tr_b16 a[58:59], v49 offset:17408
    v_mfma_f32_16x16x32_bf16 v[212:215], a[20:23], a[180:183], v[212:215]
    ds_read_b64_tr_b16 a[60:61], v49 offset:24576
    v_mfma_f32_16x16x32_bf16 v[212:215], a[16:19], a[164:167], v[212:215]
    v_mfma_f32_16x16x32_bf16 a[80:83], a[16:19], a[168:171], a[80:83]
    ds_read_b64_tr_b16 a[62:63], v49 offset:25600
    v_mfma_f32_16x16x32_bf16 a[80:83], a[20:23], a[184:187], a[80:83]
    s_add_u32 s62, s62, 0x20000
    v_mfma_f32_16x16x32_bf16 a[84:87], a[20:23], a[188:191], a[84:87]
    s_add_u32 s52, s47, 532480
    v_mfma_f32_16x16x32_bf16 a[84:87], a[16:19], a[172:175], a[84:87]
    buffer_store_dwordx4 v[168:171], v1, s[48:51], s52 offen offset:2048 sc1
    v_mfma_f32_16x16x32_bf16 a[92:95], a[24:27], a[172:175], a[92:95]
    v_mfma_f32_16x16x32_bf16 a[92:95], a[28:31], a[188:191], a[92:95]
    v_mfma_f32_16x16x32_bf16 a[88:91], a[28:31], a[184:187], a[88:91]
    v_mfma_f32_16x16x32_bf16 a[88:91], a[24:27], a[168:171], a[88:91]
    v_mfma_f32_16x16x32_bf16 v[220:223], a[24:27], a[164:167], v[220:223]
    v_mfma_f32_16x16x32_bf16 v[220:223], a[28:31], a[180:183], v[220:223]
    v_mfma_f32_16x16x32_bf16 v[216:219], a[28:31], a[176:179], v[216:219]
    v_mfma_f32_16x16x32_bf16 v[216:219], a[24:27], a[160:163], v[216:219]
    s_waitcnt vmcnt(10) lgkmcnt(0)
    s_barrier
    v_mfma_f32_16x16x32_bf16 v[224:227], a[32:35], a[160:163], v[224:227]
    s_cmp_eq_u32 s56, 0
    s_cbranch_scc1 k12_ool_66
k12_oolret_67:
    v_mfma_f32_16x16x32_bf16 v[224:227], a[36:39], a[176:179], v[224:227]
    s_add_u32 m0, s60, 147456
    ds_read_b64_tr_b16 a[0:1], v42 offset:32768
    ds_read_b64_tr_b16 a[2:3], v42 offset:33792
    v_mfma_f32_16x16x32_bf16 v[228:231], a[36:39], a[180:183], v[228:231]
    buffer_load_dwordx4 v38, s[12:15], s61 offen offset:0 lds
    v_mfma_f32_16x16x32_bf16 v[228:231], a[32:35], a[164:167], v[228:231]
    ds_read_b64_tr_b16 a[4:5], v42 offset:40960
    v_mfma_f32_16x16x32_bf16 a[96:99], a[32:35], a[168:171], a[96:99]
    buffer_load_dwordx4 v39, s[12:15], s61 offen offset:1024 lds
    ds_read_b64_tr_b16 a[6:7], v42 offset:41984
    v_mfma_f32_16x16x32_bf16 a[96:99], a[36:39], a[184:187], a[96:99]
    ds_read_b64_tr_b16 a[8:9], v43 offset:32768
    v_mfma_f32_16x16x32_bf16 a[100:103], a[36:39], a[188:191], a[100:103]
    v_mfma_f32_16x16x32_bf16 a[100:103], a[32:35], a[172:175], a[100:103]
    buffer_load_dwordx4 v40, s[12:15], s61 offen offset:2048 lds
    ds_read_b64_tr_b16 a[10:11], v43 offset:33792
    v_mfma_f32_16x16x32_bf16 a[108:111], a[40:43], a[172:175], a[108:111]
    s_mov_b32 s32, s60
    ds_read_b64_tr_b16 a[12:13], v43 offset:40960
    v_mfma_f32_16x16x32_bf16 a[108:111], a[44:47], a[188:191], a[108:111]
    ds_read_b64_tr_b16 a[14:15], v43 offset:41984
    v_mfma_f32_16x16x32_bf16 a[104:107], a[44:47], a[184:187], a[104:107]
    s_mov_b32 s34, s60
    ds_read_b64_tr_b16 a[16:17], v44 offset:32768
    v_mfma_f32_16x16x32_bf16 a[104:107], a[40:43], a[168:171], a[104:107]
    buffer_load_dwordx4 v41, s[12:15], s61 offen offset:3072 lds
    v_mfma_f32_16x16x32_bf16 v[236:239], a[40:43], a[164:167], v[236:239]
    ds_read_b64_tr_b16 a[18:19], v44 offset:33792
    v_mfma_f32_16x16x32_bf16 v[236:239], a[44:47], a[180:183], v[236:239]
    s_mov_b32 s33, s60
    ds_read_b64_tr_b16 a[20:21], v44 offset:40960
    v_mfma_f32_16x16x32_bf16 v[232:235], a[44:47], a[176:179], v[232:235]
    s_add_u32 s61, s61, 0x80000
    buffer_load_dwordx4 a[240:243], v36, s[8:11], s62 offen sc1
    ds_read_b64_tr_b16 a[22:23], v44 offset:41984
    v_mfma_f32_16x16x32_bf16 v[232:235], a[40:43], a[160:163], v[232:235]
    v_mfma_f32_16x16x32_bf16 v[240:243], a[48:51], a[160:163], v[240:243]
    s_add_u32 s35, s60, 0x10000
    ds_read_b64_tr_b16 a[24:25], v45 offset:32768
    v_mfma_f32_16x16x32_bf16 v[240:243], a[52:55], a[176:179], v[240:243]
    buffer_load_dwordx4 a[244:247], v54, s[8:11], s62 offen sc1
    ds_read_b64_tr_b16 a[26:27], v45 offset:33792
    v_mfma_f32_16x16x32_bf16 v[244:247], a[52:55], a[180:183], v[244:247]
    ds_read_b64_tr_b16 a[28:29], v45 offset:40960
    v_mfma_f32_16x16x32_bf16 v[244:247], a[48:51], a[164:167], v[244:247]
    v_mfma_f32_16x16x32_bf16 a[112:115], a[48:51], a[168:171], a[112:115]
    buffer_load_dwordx4 a[248:251], v37, s[8:11], s62 offen sc1
    ds_read_b64_tr_b16 a[30:31], v45 offset:41984
    v_mfma_f32_16x16x32_bf16 a[112:115], a[52:55], a[184:187], a[112:115]
    v_mfma_f32_16x16x32_bf16 a[116:119], a[52:55], a[188:191], a[116:119]
    v_mfma_f32_16x16x32_bf16 a[116:119], a[48:51], a[172:175], a[116:119]
    v_mfma_f32_16x16x32_bf16 a[124:127], a[56:59], a[172:175], a[124:127]
    buffer_load_dwordx4 a[252:255], v55, s[8:11], s62 offen sc1
    v_mfma_f32_16x16x32_bf16 a[124:127], a[60:63], a[188:191], a[124:127]
    v_mfma_f32_16x16x32_bf16 a[120:123], a[60:63], a[184:187], a[120:123]
    s_add_u32 s62, s62, 0x20000
    v_mfma_f32_16x16x32_bf16 a[120:123], a[56:59], a[168:171], a[120:123]
    v_mfma_f32_16x16x32_bf16 v[252:255], a[56:59], a[164:167], v[252:255]
    v_mfma_f32_16x16x32_bf16 v[252:255], a[60:63], a[180:183], v[252:255]
    v_mfma_f32_16x16x32_bf16 v[248:251], a[60:63], a[176:179], v[248:251]
    v_mfma_f32_16x16x32_bf16 v[248:251], a[56:59], a[160:163], v[248:251]
    s_waitcnt vmcnt(14) lgkmcnt(0)
    v_mfma_f32_16x16x32_bf16 v[192:195], a[0:3], a[192:195], v[192:195]
    v_mfma_f32_16x16x32_bf16 v[192:195], a[4:7], a[208:211], v[192:195]
    buffer_load_dwordx4 a[128:131], v36, s[8:11], s62 offen sc1
    ds_read_b64_tr_b16 a[32:33], v46 offset:32768
    v_mfma_f32_16x16x32_bf16 v[196:199], a[4:7], a[212:215], v[196:199]
    ds_read_b64_tr_b16 a[34:35], v46 offset:33792
    v_mfma_f32_16x16x32_bf16 v[196:199], a[0:3], a[196:199], v[196:199]
    ds_read_b64_tr_b16 a[36:37], v46 offset:40960
    v_mfma_f32_16x16x32_bf16 a[64:67], a[0:3], a[200:203], a[64:67]
    ds_read_b64_tr_b16 a[38:39], v46 offset:41984
    v_mfma_f32_16x16x32_bf16 a[64:67], a[4:7], a[216:219], a[64:67]
    ds_read_b64_tr_b16 a[40:41], v47 offset:32768
    v_mfma_f32_16x16x32_bf16 a[68:71], a[4:7], a[220:223], a[68:71]
    buffer_load_dwordx4 a[132:135], v54, s[8:11], s62 offen sc1
    v_mfma_f32_16x16x32_bf16 a[68:71], a[0:3], a[204:207], a[68:71]
    ds_read_b64_tr_b16 a[42:43], v47 offset:33792
    v_mfma_f32_16x16x32_bf16 a[76:79], a[8:11], a[204:207], a[76:79]
    ds_read_b64_tr_b16 a[44:45], v47 offset:40960
    v_mfma_f32_16x16x32_bf16 a[76:79], a[12:15], a[220:223], a[76:79]
    ds_read_b64_tr_b16 a[46:47], v47 offset:41984
    v_mfma_f32_16x16x32_bf16 a[72:75], a[12:15], a[216:219], a[72:75]
    ds_read_b64_tr_b16 a[48:49], v48 offset:32768
    v_mfma_f32_16x16x32_bf16 a[72:75], a[8:11], a[200:203], a[72:75]
    buffer_load_dwordx4 a[136:139], v37, s[8:11], s62 offen sc1
    v_mfma_f32_16x16x32_bf16 v[204:207], a[8:11], a[196:199], v[204:207]
    ds_read_b64_tr_b16 a[50:51], v48 offset:33792
    v_mfma_f32_16x16x32_bf16 v[204:207], a[12:15], a[212:215], v[204:207]
    ds_read_b64_tr_b16 a[52:53], v48 offset:40960
    v_mfma_f32_16x16x32_bf16 v[200:203], a[12:15], a[208:211], v[200:203]
    ds_read_b64_tr_b16 a[54:55], v48 offset:41984
    v_mfma_f32_16x16x32_bf16 v[200:203], a[8:11], a[192:195], v[200:203]
    v_mfma_f32_16x16x32_bf16 v[208:211], a[16:19], a[192:195], v[208:211]
    ds_read_b64_tr_b16 a[56:57], v49 offset:32768
    v_mfma_f32_16x16x32_bf16 v[208:211], a[20:23], a[208:211], v[208:211]
    buffer_load_dwordx4 a[140:143], v55, s[8:11], s62 offen sc1
    ds_read_b64_tr_b16 a[58:59], v49 offset:33792
    v_mfma_f32_16x16x32_bf16 v[212:215], a[20:23], a[212:215], v[212:215]
    ds_read_b64_tr_b16 a[60:61], v49 offset:40960
    v_mfma_f32_16x16x32_bf16 v[212:215], a[16:19], a[196:199], v[212:215]
    v_mfma_f32_16x16x32_bf16 a[80:83], a[16:19], a[200:203], a[80:83]
    ds_read_b64_tr_b16 a[62:63], v49 offset:41984
    v_mfma_f32_16x16x32_bf16 a[80:83], a[20:23], a[216:219], a[80:83]
    s_add_u32 s62, s62, 0x20000
    v_mfma_f32_16x16x32_bf16 a[84:87], a[20:23], a[220:223], a[84:87]
    s_add_u32 s52, s47, 532480
    v_mfma_f32_16x16x32_bf16 a[84:87], a[16:19], a[204:207], a[84:87]
    buffer_store_dwordx4 v[172:175], v1, s[48:51], s52 offen offset:3072 sc1
    v_mfma_f32_16x16x32_bf16 a[92:95], a[24:27], a[204:207], a[92:95]
    v_mfma_f32_16x16x32_bf16 a[92:95], a[28:31], a[220:223], a[92:95]
    v_mfma_f32_16x16x32_bf16 a[88:91], a[28:31], a[216:219], a[88:91]
    v_mfma_f32_16x16x32_bf16 a[88:91], a[24:27], a[200:203], a[88:91]
    v_mfma_f32_16x16x32_bf16 v[220:223], a[24:27], a[196:199], v[220:223]
    v_add_co_u32 v2, vcc, 0x4000, v2
    s_nop 1
    v_addc_co_u32 v3, vcc, 0, v3, vcc
    global_load_dword v51, v[2:3], off
    v_mfma_f32_16x16x32_bf16 v[220:223], a[28:31], a[212:215], v[220:223]
    v_mfma_f32_16x16x32_bf16 v[216:219], a[28:31], a[208:211], v[216:219]
    v_mfma_f32_16x16x32_bf16 v[216:219], a[24:27], a[192:195], v[216:219]
    s_waitcnt vmcnt(9) lgkmcnt(0)
    s_barrier
    v_mfma_f32_16x16x32_bf16 v[224:227], a[32:35], a[192:195], v[224:227]
    v_mfma_f32_16x16x32_bf16 v[224:227], a[36:39], a[208:211], v[224:227]
    s_add_u32 m0, s60, 98304
    ds_read_b64_tr_b16 a[0:1], v42 offset:49152
    ds_read_b64_tr_b16 a[2:3], v42 offset:50176
    v_mfma_f32_16x16x32_bf16 v[228:231], a[36:39], a[212:215], v[228:231]
    buffer_load_dwordx4 v38, s[12:15], s61 offen offset:0 lds
    v_mfma_f32_16x16x32_bf16 v[228:231], a[32:35], a[196:199], v[228:231]
    ds_read_b64_tr_b16 a[4:5], v42 offset:57344
    v_mfma_f32_16x16x32_bf16 a[96:99], a[32:35], a[200:203], a[96:99]
    buffer_load_dwordx4 v39, s[12:15], s61 offen offset:1024 lds
    ds_read_b64_tr_b16 a[6:7], v42 offset:58368
    v_mfma_f32_16x16x32_bf16 a[96:99], a[36:39], a[216:219], a[96:99]
    ds_read_b64_tr_b16 a[8:9], v43 offset:49152
    v_mfma_f32_16x16x32_bf16 a[100:103], a[36:39], a[220:223], a[100:103]
    v_mfma_f32_16x16x32_bf16 a[100:103], a[32:35], a[204:207], a[100:103]
    buffer_load_dwordx4 v40, s[12:15], s61 offen offset:2048 lds
    ds_read_b64_tr_b16 a[10:11], v43 offset:50176
    v_mfma_f32_16x16x32_bf16 a[108:111], a[40:43], a[204:207], a[108:111]
    ds_read_b64_tr_b16 a[12:13], v43 offset:57344
    v_mfma_f32_16x16x32_bf16 a[108:111], a[44:47], a[220:223], a[108:111]
    ds_read_b64_tr_b16 a[14:15], v43 offset:58368
    v_mfma_f32_16x16x32_bf16 a[104:107], a[44:47], a[216:219], a[104:107]
    buffer_load_dwordx4 v41, s[12:15], s61 offen offset:3072 lds
    ds_read_b64_tr_b16 a[16:17], v44 offset:49152
    v_mfma_f32_16x16x32_bf16 a[104:107], a[40:43], a[200:203], a[104:107]
    v_mfma_f32_16x16x32_bf16 v[236:239], a[40:43], a[196:199], v[236:239]
    s_add_u32 s61, s61, 0x80000
    ds_read_b64_tr_b16 a[18:19], v44 offset:50176
    v_mfma_f32_16x16x32_bf16 v[236:239], a[44:47], a[212:215], v[236:239]
    buffer_load_dwordx4 a[144:147], v36, s[8:11], s62 offen sc1
    ds_read_b64_tr_b16 a[20:21], v44 offset:57344
    v_mfma_f32_16x16x32_bf16 v[232:235], a[44:47], a[208:211], v[232:235]
    ds_read_b64_tr_b16 a[22:23], v44 offset:58368
    v_mfma_f32_16x16x32_bf16 v[232:235], a[40:43], a[192:195], v[232:235]
    buffer_load_dwordx4 a[148:151], v54, s[8:11], s62 offen sc1
    v_mfma_f32_16x16x32_bf16 v[240:243], a[48:51], a[192:195], v[240:243]
    ds_read_b64_tr_b16 a[24:25], v45 offset:49152
    v_mfma_f32_16x16x32_bf16 v[240:243], a[52:55], a[208:211], v[240:243]
    ds_read_b64_tr_b16 a[26:27], v45 offset:50176
    v_mfma_f32_16x16x32_bf16 v[244:247], a[52:55], a[212:215], v[244:247]
    buffer_load_dwordx4 a[152:155], v37, s[8:11], s62 offen sc1
    ds_read_b64_tr_b16 a[28:29], v45 offset:57344
    v_mfma_f32_16x16x32_bf16 v[244:247], a[48:51], a[196:199], v[244:247]
    v_mfma_f32_16x16x32_bf16 a[112:115], a[48:51], a[200:203], a[112:115]
    ds_read_b64_tr_b16 a[30:31], v45 offset:58368
    v_mfma_f32_16x16x32_bf16 a[112:115], a[52:55], a[216:219], a[112:115]
    buffer_load_dwordx4 a[156:159], v55, s[8:11], s62 offen sc1
    v_mfma_f32_16x16x32_bf16 a[116:119], a[52:55], a[220:223], a[116:119]
    v_mfma_f32_16x16x32_bf16 a[116:119], a[48:51], a[204:207], a[116:119]
    s_add_u32 s62, s62, 0x20000
    v_mfma_f32_16x16x32_bf16 a[124:127], a[56:59], a[204:207], a[124:127]
    s_add_u32 s52, s47, 536576
    v_mfma_f32_16x16x32_bf16 a[124:127], a[60:63], a[220:223], a[124:127]
    buffer_store_dwordx4 v[176:179], v1, s[48:51], s52 offen offset:0 sc1
    v_mfma_f32_16x16x32_bf16 a[120:123], a[60:63], a[216:219], a[120:123]
    v_mfma_f32_16x16x32_bf16 a[120:123], a[56:59], a[200:203], a[120:123]
    v_mfma_f32_16x16x32_bf16 v[252:255], a[56:59], a[196:199], v[252:255]
    v_mfma_f32_16x16x32_bf16 v[252:255], a[60:63], a[212:215], v[252:255]
    v_mfma_f32_16x16x32_bf16 v[248:251], a[60:63], a[208:211], v[248:251]
    v_mfma_f32_16x16x32_bf16 v[248:251], a[56:59], a[192:195], v[248:251]
    s_waitcnt vmcnt(14) lgkmcnt(0)
    v_mfma_f32_16x16x32_bf16 v[192:195], a[0:3], a[224:227], v[192:195]
    v_mfma_f32_16x16x32_bf16 v[192:195], a[4:7], a[240:243], v[192:195]
    buffer_load_dwordx4 a[160:163], v36, s[8:11], s62 offen sc1
    ds_read_b64_tr_b16 a[32:33], v46 offset:49152
    v_mfma_f32_16x16x32_bf16 v[196:199], a[4:7], a[244:247], v[196:199]
    ds_read_b64_tr_b16 a[34:35], v46 offset:50176
    v_mfma_f32_16x16x32_bf16 v[196:199], a[0:3], a[228:231], v[196:199]
    ds_read_b64_tr_b16 a[36:37], v46 offset:57344
    v_mfma_f32_16x16x32_bf16 a[64:67], a[0:3], a[232:235], a[64:67]
    ds_read_b64_tr_b16 a[38:39], v46 offset:58368
    v_mfma_f32_16x16x32_bf16 a[64:67], a[4:7], a[248:251], a[64:67]
    ds_read_b64_tr_b16 a[40:41], v47 offset:49152
    v_mfma_f32_16x16x32_bf16 a[68:71], a[4:7], a[252:255], a[68:71]
    buffer_load_dwordx4 a[164:167], v54, s[8:11], s62 offen sc1
    v_mfma_f32_16x16x32_bf16 a[68:71], a[0:3], a[236:239], a[68:71]
    ds_read_b64_tr_b16 a[42:43], v47 offset:50176
    v_mfma_f32_16x16x32_bf16 a[76:79], a[8:11], a[236:239], a[76:79]
    ds_read_b64_tr_b16 a[44:45], v47 offset:57344
    v_mfma_f32_16x16x32_bf16 a[76:79], a[12:15], a[252:255], a[76:79]
    ds_read_b64_tr_b16 a[46:47], v47 offset:58368
    v_mfma_f32_16x16x32_bf16 a[72:75], a[12:15], a[248:251], a[72:75]
    ds_read_b64_tr_b16 a[48:49], v48 offset:49152
    v_mfma_f32_16x16x32_bf16 a[72:75], a[8:11], a[232:235], a[72:75]
    buffer_load_dwordx4 a[168:171], v37, s[8:11], s62 offen sc1
    v_mfma_f32_16x16x32_bf16 v[204:207], a[8:11], a[228:231], v[204:207]
    ds_read_b64_tr_b16 a[50:51], v48 offset:50176
    v_mfma_f32_16x16x32_bf16 v[204:207], a[12:15], a[244:247], v[204:207]
    ds_read_b64_tr_b16 a[52:53], v48 offset:57344
    v_mfma_f32_16x16x32_bf16 v[200:203], a[12:15], a[240:243], v[200:203]
    ds_read_b64_tr_b16 a[54:55], v48 offset:58368
    v_mfma_f32_16x16x32_bf16 v[200:203], a[8:11], a[224:227], v[200:203]
    v_mfma_f32_16x16x32_bf16 v[208:211], a[16:19], a[224:227], v[208:211]
    ds_read_b64_tr_b16 a[56:57], v49 offset:49152
    v_mfma_f32_16x16x32_bf16 v[208:211], a[20:23], a[240:243], v[208:211]
    buffer_load_dwordx4 a[172:175], v55, s[8:11], s62 offen sc1
    ds_read_b64_tr_b16 a[58:59], v49 offset:50176
    v_mfma_f32_16x16x32_bf16 v[212:215], a[20:23], a[244:247], v[212:215]
    ds_read_b64_tr_b16 a[60:61], v49 offset:57344
    v_mfma_f32_16x16x32_bf16 v[212:215], a[16:19], a[228:231], v[212:215]
    v_mfma_f32_16x16x32_bf16 a[80:83], a[16:19], a[232:235], a[80:83]
    ds_read_b64_tr_b16 a[62:63], v49 offset:58368
    v_mfma_f32_16x16x32_bf16 a[80:83], a[20:23], a[248:251], a[80:83]
    s_add_u32 s62, s62, 0x20000
    v_mfma_f32_16x16x32_bf16 a[84:87], a[20:23], a[252:255], a[84:87]
    s_add_u32 s52, s47, 536576
    v_mfma_f32_16x16x32_bf16 a[84:87], a[16:19], a[236:239], a[84:87]
    buffer_store_dwordx4 v[180:183], v1, s[48:51], s52 offen offset:1024 sc1
    v_mfma_f32_16x16x32_bf16 a[92:95], a[24:27], a[236:239], a[92:95]
    v_mfma_f32_16x16x32_bf16 a[92:95], a[28:31], a[252:255], a[92:95]
    v_mfma_f32_16x16x32_bf16 a[88:91], a[28:31], a[248:251], a[88:91]
    v_mfma_f32_16x16x32_bf16 a[88:91], a[24:27], a[232:235], a[88:91]
    v_mfma_f32_16x16x32_bf16 v[220:223], a[24:27], a[228:231], v[220:223]
    v_mfma_f32_16x16x32_bf16 v[220:223], a[28:31], a[244:247], v[220:223]
    v_mfma_f32_16x16x32_bf16 v[216:219], a[28:31], a[240:243], v[216:219]
    v_mfma_f32_16x16x32_bf16 v[216:219], a[24:27], a[224:227], v[216:219]
    s_waitcnt vmcnt(10) lgkmcnt(0)
    s_barrier
    v_mfma_f32_16x16x32_bf16 v[224:227], a[32:35], a[224:227], v[224:227]
    s_cmp_eq_u32 s30, 0
    s_cbranch_scc1 k12_ool_68
k12_oolret_69:
    v_mfma_f32_16x16x32_bf16 v[224:227], a[36:39], a[240:243], v[224:227]
    s_add_u32 m0, s60, 114688
    ds_read_b64_tr_b16 a[0:1], v42 offset:0
    ds_read_b64_tr_b16 a[2:3], v42 offset:1024
    v_mfma_f32_16x16x32_bf16 v[228:231], a[36:39], a[244:247], v[228:231]
    buffer_load_dwordx4 v38, s[12:15], s61 offen offset:0 lds
    v_mfma_f32_16x16x32_bf16 v[228:231], a[32:35], a[228:231], v[228:231]
    ds_read_b64_tr_b16 a[4:5], v42 offset:8192
    v_mfma_f32_16x16x32_bf16 a[96:99], a[32:35], a[232:235], a[96:99]
    buffer_load_dwordx4 v39, s[12:15], s61 offen offset:1024 lds
    ds_read_b64_tr_b16 a[6:7], v42 offset:9216
    v_mfma_f32_16x16x32_bf16 a[96:99], a[36:39], a[248:251], a[96:99]
    ds_read_b64_tr_b16 a[8:9], v43 offset:0
    v_mfma_f32_16x16x32_bf16 a[100:103], a[36:39], a[252:255], a[100:103]
    v_mfma_f32_16x16x32_bf16 a[100:103], a[32:35], a[236:239], a[100:103]
    buffer_load_dwordx4 v40, s[12:15], s61 offen offset:2048 lds
    ds_read_b64_tr_b16 a[10:11], v43 offset:1024
    v_mfma_f32_16x16x32_bf16 a[108:111], a[40:43], a[236:239], a[108:111]
    ds_read_b64_tr_b16 a[12:13], v43 offset:8192
    v_mfma_f32_16x16x32_bf16 a[108:111], a[44:47], a[252:255], a[108:111]
    ds_read_b64_tr_b16 a[14:15], v43 offset:9216
    v_mfma_f32_16x16x32_bf16 a[104:107], a[44:47], a[248:251], a[104:107]
    buffer_load_dwordx4 v41, s[12:15], s61 offen offset:3072 lds
    ds_read_b64_tr_b16 a[16:17], v44 offset:0
    v_mfma_f32_16x16x32_bf16 a[104:107], a[40:43], a[232:235], a[104:107]
    v_mfma_f32_16x16x32_bf16 v[236:239], a[40:43], a[228:231], v[236:239]
    s_add_u32 s61, s61, 0x80000
    ds_read_b64_tr_b16 a[18:19], v44 offset:1024
    v_mfma_f32_16x16x32_bf16 v[236:239], a[44:47], a[244:247], v[236:239]
    buffer_load_dwordx4 a[176:179], v36, s[8:11], s62 offen sc1
    ds_read_b64_tr_b16 a[20:21], v44 offset:8192
    v_mfma_f32_16x16x32_bf16 v[232:235], a[44:47], a[240:243], v[232:235]
    ds_read_b64_tr_b16 a[22:23], v44 offset:9216
    v_mfma_f32_16x16x32_bf16 v[232:235], a[40:43], a[224:227], v[232:235]
    buffer_load_dwordx4 a[180:183], v54, s[8:11], s62 offen sc1
    v_mfma_f32_16x16x32_bf16 v[240:243], a[48:51], a[224:227], v[240:243]
    ds_read_b64_tr_b16 a[24:25], v45 offset:0
    v_mfma_f32_16x16x32_bf16 v[240:243], a[52:55], a[240:243], v[240:243]
    ds_read_b64_tr_b16 a[26:27], v45 offset:1024
    v_mfma_f32_16x16x32_bf16 v[244:247], a[52:55], a[244:247], v[244:247]
    buffer_load_dwordx4 a[184:187], v37, s[8:11], s62 offen sc1
    ds_read_b64_tr_b16 a[28:29], v45 offset:8192
    v_mfma_f32_16x16x32_bf16 v[244:247], a[48:51], a[228:231], v[244:247]
    v_mfma_f32_16x16x32_bf16 a[112:115], a[48:51], a[232:235], a[112:115]
    ds_read_b64_tr_b16 a[30:31], v45 offset:9216
    v_mfma_f32_16x16x32_bf16 a[112:115], a[52:55], a[248:251], a[112:115]
    buffer_load_dwordx4 a[188:191], v55, s[8:11], s62 offen sc1
    v_mfma_f32_16x16x32_bf16 a[116:119], a[52:55], a[252:255], a[116:119]
    v_mfma_f32_16x16x32_bf16 a[116:119], a[48:51], a[236:239], a[116:119]
    s_add_u32 s62, s62, 0x20000
    v_mfma_f32_16x16x32_bf16 a[124:127], a[56:59], a[236:239], a[124:127]
    s_add_u32 s52, s47, 536576
    v_mfma_f32_16x16x32_bf16 a[124:127], a[60:63], a[252:255], a[124:127]
    buffer_store_dwordx4 v[184:187], v1, s[48:51], s52 offen offset:2048 sc1
    v_mfma_f32_16x16x32_bf16 a[120:123], a[60:63], a[248:251], a[120:123]
    v_mfma_f32_16x16x32_bf16 a[120:123], a[56:59], a[232:235], a[120:123]
    v_mfma_f32_16x16x32_bf16 v[252:255], a[56:59], a[228:231], v[252:255]
    v_mfma_f32_16x16x32_bf16 v[252:255], a[60:63], a[244:247], v[252:255]
    v_mfma_f32_16x16x32_bf16 v[248:251], a[60:63], a[240:243], v[248:251]
    v_mfma_f32_16x16x32_bf16 v[248:251], a[56:59], a[224:227], v[248:251]
    s_waitcnt vmcnt(15) lgkmcnt(0)
    v_mfma_f32_16x16x32_bf16 v[192:195], a[0:3], a[128:131], v[192:195]
    v_mfma_f32_16x16x32_bf16 v[192:195], a[4:7], a[144:147], v[192:195]
    s_add_u32 s52, s47, 536576
    ds_read_b64_tr_b16 a[32:33], v46 offset:0
    ds_read_b64_tr_b16 a[34:35], v46 offset:1024
    v_mfma_f32_16x16x32_bf16 v[196:199], a[4:7], a[148:151], v[196:199]
    buffer_store_dwordx4 v[188:191], v1, s[48:51], s52 offen offset:3072 sc1
    v_mfma_f32_16x16x32_bf16 v[196:199], a[0:3], a[132:135], v[196:199]
    ds_read_b64_tr_b16 a[36:37], v46 offset:8192
    v_mfma_f32_16x16x32_bf16 a[64:67], a[0:3], a[136:139], a[64:67]
    ds_read_b64_tr_b16 a[38:39], v46 offset:9216
    v_mfma_f32_16x16x32_bf16 a[64:67], a[4:7], a[152:155], a[64:67]
    ds_read_b64_tr_b16 a[40:41], v47 offset:0
    v_mfma_f32_16x16x32_bf16 a[68:71], a[4:7], a[156:159], a[68:71]
    v_mfma_f32_16x16x32_bf16 a[68:71], a[0:3], a[140:143], a[68:71]
    ds_read_b64_tr_b16 a[42:43], v47 offset:1024
    v_mfma_f32_16x16x32_bf16 a[76:79], a[8:11], a[140:143], a[76:79]
    ds_read_b64_tr_b16 a[44:45], v47 offset:8192
    v_mfma_f32_16x16x32_bf16 a[76:79], a[12:15], a[156:159], a[76:79]
    ds_read_b64_tr_b16 a[46:47], v47 offset:9216
    v_mfma_f32_16x16x32_bf16 a[72:75], a[12:15], a[152:155], a[72:75]
    ds_read_b64_tr_b16 a[48:49], v48 offset:0
    v_mfma_f32_16x16x32_bf16 a[72:75], a[8:11], a[136:139], a[72:75]
    v_mfma_f32_16x16x32_bf16 v[204:207], a[8:11], a[132:135], v[204:207]
    ds_read_b64_tr_b16 a[50:51], v48 offset:1024
    v_mfma_f32_16x16x32_bf16 v[204:207], a[12:15], a[148:151], v[204:207]
    ds_read_b64_tr_b16 a[52:53], v48 offset:8192
    v_mfma_f32_16x16x32_bf16 v[200:203], a[12:15], a[144:147], v[200:203]
    ds_read_b64_tr_b16 a[54:55], v48 offset:9216
    v_mfma_f32_16x16x32_bf16 v[200:203], a[8:11], a[128:131], v[200:203]
    v_mfma_f32_16x16x32_bf16 v[208:211], a[16:19], a[128:131], v[208:211]
    ds_read_b64_tr_b16 a[56:57], v49 offset:0
    v_mfma_f32_16x16x32_bf16 v[208:211], a[20:23], a[144:147], v[208:211]
    ds_read_b64_tr_b16 a[58:59], v49 offset:1024
    v_mfma_f32_16x16x32_bf16 v[212:215], a[20:23], a[148:151], v[212:215]
    ds_read_b64_tr_b16 a[60:61], v49 offset:8192
    v_mfma_f32_16x16x32_bf16 v[212:215], a[16:19], a[132:135], v[212:215]
    v_mfma_f32_16x16x32_bf16 a[80:83], a[16:19], a[136:139], a[80:83]
    ds_read_b64_tr_b16 a[62:63], v49 offset:9216
    v_mfma_f32_16x16x32_bf16 a[80:83], a[20:23], a[152:155], a[80:83]
    v_mfma_f32_16x16x32_bf16 a[84:87], a[20:23], a[156:159], a[84:87]
    v_mfma_f32_16x16x32_bf16 a[84:87], a[16:19], a[140:143], a[84:87]
    v_mfma_f32_16x16x32_bf16 a[92:95], a[24:27], a[140:143], a[92:95]
    v_mfma_f32_16x16x32_bf16 a[92:95], a[28:31], a[156:159], a[92:95]
    v_mfma_f32_16x16x32_bf16 a[88:91], a[28:31], a[152:155], a[88:91]
    v_mfma_f32_16x16x32_bf16 a[88:91], a[24:27], a[136:139], a[88:91]
    v_mfma_f32_16x16x32_bf16 v[220:223], a[24:27], a[132:135], v[220:223]
    s_cmp_eq_u32 s30, 0
    s_cbranch_scc1 k12_ool_72
k12_oolret_73:
    v_mfma_f32_16x16x32_bf16 v[220:223], a[28:31], a[148:151], v[220:223]
    v_mfma_f32_16x16x32_bf16 v[216:219], a[28:31], a[144:147], v[216:219]
    v_mfma_f32_16x16x32_bf16 v[216:219], a[24:27], a[128:131], v[216:219]
    s_waitcnt vmcnt(6) lgkmcnt(0)
    s_barrier
    v_mfma_f32_16x16x32_bf16 v[224:227], a[32:35], a[128:131], v[224:227]
    v_mfma_f32_16x16x32_bf16 v[224:227], a[36:39], a[144:147], v[224:227]
    s_mov_b32 m0, s34
    ds_read_b64_tr_b16 a[0:1], v42 offset:16384
    ds_read_b64_tr_b16 a[2:3], v42 offset:17408
    v_mfma_f32_16x16x32_bf16 v[228:231], a[36:39], a[148:151], v[228:231]
    buffer_load_dwordx4 v1, s[16:19], s32 offen offset:0 sc1 lds
    v_mfma_f32_16x16x32_bf16 v[228:231], a[32:35], a[132:135], v[228:231]
    ds_read_b64_tr_b16 a[4:5], v42 offset:24576
    v_mfma_f32_16x16x32_bf16 a[96:99], a[32:35], a[136:139], a[96:99]
    buffer_load_dwordx4 v1, s[16:19], s32 offen offset:1024 sc1 lds
    ds_read_b64_tr_b16 a[6:7], v42 offset:25600
    v_mfma_f32_16x16x32_bf16 a[96:99], a[36:39], a[152:155], a[96:99]
    ds_read_b64_tr_b16 a[8:9], v43 offset:16384
    v_mfma_f32_16x16x32_bf16 a[100:103], a[36:39], a[156:159], a[100:103]
    v_mfma_f32_16x16x32_bf16 a[100:103], a[32:35], a[140:143], a[100:103]
    buffer_load_dwordx4 v1, s[16:19], s32 offen offset:2048 sc1 lds
    ds_read_b64_tr_b16 a[10:11], v43 offset:17408
    v_mfma_f32_16x16x32_bf16 a[108:111], a[40:43], a[140:143], a[108:111]
    ds_read_b64_tr_b16 a[12:13], v43 offset:24576
    v_mfma_f32_16x16x32_bf16 a[108:111], a[44:47], a[156:159], a[108:111]
    ds_read_b64_tr_b16 a[14:15], v43 offset:25600
    v_mfma_f32_16x16x32_bf16 a[104:107], a[44:47], a[152:155], a[104:107]
    ds_read_b64_tr_b16 a[16:17], v44 offset:16384
    v_mfma_f32_16x16x32_bf16 a[104:107], a[40:43], a[136:139], a[104:107]
    buffer_load_dwordx4 v1, s[16:19], s32 offen offset:3072 sc1 lds
    v_mfma_f32_16x16x32_bf16 v[236:239], a[40:43], a[132:135], v[236:239]
    ds_read_b64_tr_b16 a[18:19], v44 offset:17408
    v_mfma_f32_16x16x32_bf16 v[236:239], a[44:47], a[148:151], v[236:239]
    s_add_u32 s32, s32, 0x80000
    ds_read_b64_tr_b16 a[20:21], v44 offset:24576
    v_mfma_f32_16x16x32_bf16 v[232:235], a[44:47], a[144:147], v[232:235]
    s_add_u32 s34, s34, 0x4000
    ds_read_b64_tr_b16 a[22:23], v44 offset:25600
    s_mov_b32 m0, s34
    v_mfma_f32_16x16x32_bf16 v[232:235], a[40:43], a[128:131], v[232:235]
    buffer_load_dwordx4 v1, s[16:19], s32 offen offset:0 sc1 lds
    v_mfma_f32_16x16x32_bf16 v[240:243], a[48:51], a[128:131], v[240:243]
    ds_read_b64_tr_b16 a[24:25], v45 offset:16384
    v_mfma_f32_16x16x32_bf16 v[240:243], a[52:55], a[144:147], v[240:243]
    buffer_load_dwordx4 v1, s[16:19], s32 offen offset:1024 sc1 lds
    ds_read_b64_tr_b16 a[26:27], v45 offset:17408
    v_mfma_f32_16x16x32_bf16 v[244:247], a[52:55], a[148:151], v[244:247]
    ds_read_b64_tr_b16 a[28:29], v45 offset:24576
    v_mfma_f32_16x16x32_bf16 v[244:247], a[48:51], a[132:135], v[244:247]
    v_mfma_f32_16x16x32_bf16 a[112:115], a[48:51], a[136:139], a[112:115]
    buffer_load_dwordx4 v1, s[16:19], s32 offen offset:2048 sc1 lds
    ds_read_b64_tr_b16 a[30:31], v45 offset:25600
    v_mfma_f32_16x16x32_bf16 a[112:115], a[52:55], a[152:155], a[112:115]
    v_mfma_f32_16x16x32_bf16 a[116:119], a[52:55], a[156:159], a[116:119]
    v_mfma_f32_16x16x32_bf16 a[116:119], a[48:51], a[140:143], a[116:119]
    v_mfma_f32_16x16x32_bf16 a[124:127], a[56:59], a[140:143], a[124:127]
    buffer_load_dwordx4 v1, s[16:19], s32 offen offset:3072 sc1 lds
    v_mfma_f32_16x16x32_bf16 a[124:127], a[60:63], a[156:159], a[124:127]
    v_mfma_f32_16x16x32_bf16 a[120:123], a[60:63], a[152:155], a[120:123]
    s_add_u32 s32, s32, 0x80000
    v_mfma_f32_16x16x32_bf16 a[120:123], a[56:59], a[136:139], a[120:123]
    s_add_u32 s34, s34, 0x4000
    v_mfma_f32_16x16x32_bf16 v[252:255], a[56:59], a[132:135], v[252:255]
    v_mfma_f32_16x16x32_bf16 v[252:255], a[60:63], a[148:151], v[252:255]
    v_mfma_f32_16x16x32_bf16 v[248:251], a[60:63], a[144:147], v[248:251]
    v_mfma_f32_16x16x32_bf16 v[248:251], a[56:59], a[128:131], v[248:251]
    s_waitcnt vmcnt(10) lgkmcnt(0)
    v_mfma_f32_16x16x32_bf16 v[192:195], a[0:3], a[160:163], v[192:195]
    v_mfma_f32_16x16x32_bf16 v[192:195], a[4:7], a[176:179], v[192:195]
    s_mov_b32 m0, s35
    ds_read_b64_tr_b16 a[32:33], v46 offset:16384
    ds_read_b64_tr_b16 a[34:35], v46 offset:17408
    v_mfma_f32_16x16x32_bf16 v[196:199], a[4:7], a[180:183], v[196:199]
    buffer_load_dwordx4 v1, s[20:23], s33 offen offset:0 sc1 lds
    v_mfma_f32_16x16x32_bf16 v[196:199], a[0:3], a[164:167], v[196:199]
    ds_read_b64_tr_b16 a[36:37], v46 offset:24576
    v_mfma_f32_16x16x32_bf16 a[64:67], a[0:3], a[168:171], a[64:67]
    buffer_load_dwordx4 v1, s[20:23], s33 offen offset:1024 sc1 lds
    ds_read_b64_tr_b16 a[38:39], v46 offset:25600
    v_mfma_f32_16x16x32_bf16 a[64:67], a[4:7], a[184:187], a[64:67]
    ds_read_b64_tr_b16 a[40:41], v47 offset:16384
    v_mfma_f32_16x16x32_bf16 a[68:71], a[4:7], a[188:191], a[68:71]
    v_mfma_f32_16x16x32_bf16 a[68:71], a[0:3], a[172:175], a[68:71]
    buffer_load_dwordx4 v1, s[20:23], s33 offen offset:2048 sc1 lds
    ds_read_b64_tr_b16 a[42:43], v47 offset:17408
    v_mfma_f32_16x16x32_bf16 a[76:79], a[8:11], a[172:175], a[76:79]
    ds_read_b64_tr_b16 a[44:45], v47 offset:24576
    v_mfma_f32_16x16x32_bf16 a[76:79], a[12:15], a[188:191], a[76:79]
    ds_read_b64_tr_b16 a[46:47], v47 offset:25600
    v_mfma_f32_16x16x32_bf16 a[72:75], a[12:15], a[184:187], a[72:75]
    ds_read_b64_tr_b16 a[48:49], v48 offset:16384
    v_mfma_f32_16x16x32_bf16 a[72:75], a[8:11], a[168:171], a[72:75]
    buffer_load_dwordx4 v1, s[20:23], s33 offen offset:3072 sc1 lds
    v_mfma_f32_16x16x32_bf16 v[204:207], a[8:11], a[164:167], v[204:207]
    ds_read_b64_tr_b16 a[50:51], v48 offset:17408
    v_mfma_f32_16x16x32_bf16 v[204:207], a[12:15], a[180:183], v[204:207]
    s_add_u32 s33, s33, 0x80000
    ds_read_b64_tr_b16 a[52:53], v48 offset:24576
    v_mfma_f32_16x16x32_bf16 v[200:203], a[12:15], a[176:179], v[200:203]
    s_add_u32 s35, s35, 0x4000
    ds_read_b64_tr_b16 a[54:55], v48 offset:25600
    s_mov_b32 m0, s34
    v_mfma_f32_16x16x32_bf16 v[200:203], a[8:11], a[160:163], v[200:203]
    buffer_load_dwordx4 v1, s[16:19], s32 offen offset:0 sc1 lds
    v_mfma_f32_16x16x32_bf16 v[208:211], a[16:19], a[160:163], v[208:211]
    ds_read_b64_tr_b16 a[56:57], v49 offset:16384
    v_mfma_f32_16x16x32_bf16 v[208:211], a[20:23], a[176:179], v[208:211]
    buffer_load_dwordx4 v1, s[16:19], s32 offen offset:1024 sc1 lds
    ds_read_b64_tr_b16 a[58:59], v49 offset:17408
    v_mfma_f32_16x16x32_bf16 v[212:215], a[20:23], a[180:183], v[212:215]
    ds_read_b64_tr_b16 a[60:61], v49 offset:24576
    v_mfma_f32_16x16x32_bf16 v[212:215], a[16:19], a[164:167], v[212:215]
    v_mfma_f32_16x16x32_bf16 a[80:83], a[16:19], a[168:171], a[80:83]
    buffer_load_dwordx4 v1, s[16:19], s32 offen offset:2048 sc1 lds
    ds_read_b64_tr_b16 a[62:63], v49 offset:25600
    v_mfma_f32_16x16x32_bf16 a[80:83], a[20:23], a[184:187], a[80:83]
    v_mfma_f32_16x16x32_bf16 a[84:87], a[20:23], a[188:191], a[84:87]
    v_mfma_f32_16x16x32_bf16 a[84:87], a[16:19], a[172:175], a[84:87]
    v_mfma_f32_16x16x32_bf16 a[92:95], a[24:27], a[172:175], a[92:95]
    buffer_load_dwordx4 v1, s[16:19], s32 offen offset:3072 sc1 lds
    v_mfma_f32_16x16x32_bf16 a[92:95], a[28:31], a[188:191], a[92:95]
    v_mfma_f32_16x16x32_bf16 a[88:91], a[28:31], a[184:187], a[88:91]
    s_add_u32 s32, s32, 0x80000
    v_mfma_f32_16x16x32_bf16 a[88:91], a[24:27], a[168:171], a[88:91]
    s_add_u32 s34, s34, 0x4000
    v_mfma_f32_16x16x32_bf16 v[220:223], a[24:27], a[164:167], v[220:223]
    v_mfma_f32_16x16x32_bf16 v[220:223], a[28:31], a[180:183], v[220:223]
    v_mfma_f32_16x16x32_bf16 v[216:219], a[28:31], a[176:179], v[216:219]
    v_mfma_f32_16x16x32_bf16 v[216:219], a[24:27], a[160:163], v[216:219]
    s_waitcnt vmcnt(63) lgkmcnt(0)
    s_barrier
    v_mfma_f32_16x16x32_bf16 v[224:227], a[32:35], a[160:163], v[224:227]
    v_mfma_f32_16x16x32_bf16 v[224:227], a[36:39], a[176:179], v[224:227]
    s_mov_b32 m0, s35
    v_mfma_f32_16x16x32_bf16 v[228:231], a[36:39], a[180:183], v[228:231]
    buffer_load_dwordx4 v1, s[20:23], s33 offen offset:0 sc1 lds
    v_mfma_f32_16x16x32_bf16 v[228:231], a[32:35], a[164:167], v[228:231]
    v_mfma_f32_16x16x32_bf16 a[96:99], a[32:35], a[168:171], a[96:99]
    v_mfma_f32_16x16x32_bf16 a[96:99], a[36:39], a[184:187], a[96:99]
    v_mfma_f32_16x16x32_bf16 a[100:103], a[36:39], a[188:191], a[100:103]
    v_mfma_f32_16x16x32_bf16 a[100:103], a[32:35], a[172:175], a[100:103]
    buffer_load_dwordx4 v1, s[20:23], s33 offen offset:1024 sc1 lds
    v_mfma_f32_16x16x32_bf16 a[108:111], a[40:43], a[172:175], a[108:111]
    v_mfma_f32_16x16x32_bf16 a[108:111], a[44:47], a[188:191], a[108:111]
    v_mfma_f32_16x16x32_bf16 a[104:107], a[44:47], a[184:187], a[104:107]
    v_mfma_f32_16x16x32_bf16 a[104:107], a[40:43], a[168:171], a[104:107]
    v_mfma_f32_16x16x32_bf16 v[236:239], a[40:43], a[164:167], v[236:239]
    v_mfma_f32_16x16x32_bf16 v[236:239], a[44:47], a[180:183], v[236:239]
    v_mfma_f32_16x16x32_bf16 v[232:235], a[44:47], a[176:179], v[232:235]
    buffer_load_dwordx4 v1, s[20:23], s33 offen offset:2048 sc1 lds
    v_mfma_f32_16x16x32_bf16 v[232:235], a[40:43], a[160:163], v[232:235]
    v_mfma_f32_16x16x32_bf16 v[240:243], a[48:51], a[160:163], v[240:243]
    v_mfma_f32_16x16x32_bf16 v[240:243], a[52:55], a[176:179], v[240:243]
    v_mfma_f32_16x16x32_bf16 v[244:247], a[52:55], a[180:183], v[244:247]
    v_mfma_f32_16x16x32_bf16 v[244:247], a[48:51], a[164:167], v[244:247]
    v_mfma_f32_16x16x32_bf16 a[112:115], a[48:51], a[168:171], a[112:115]
    buffer_load_dwordx4 v1, s[20:23], s33 offen offset:3072 sc1 lds
    v_mfma_f32_16x16x32_bf16 a[112:115], a[52:55], a[184:187], a[112:115]
    v_mfma_f32_16x16x32_bf16 a[116:119], a[52:55], a[188:191], a[116:119]
    v_mfma_f32_16x16x32_bf16 a[116:119], a[48:51], a[172:175], a[116:119]
    v_mfma_f32_16x16x32_bf16 a[124:127], a[56:59], a[172:175], a[124:127]
    v_mfma_f32_16x16x32_bf16 a[124:127], a[60:63], a[188:191], a[124:127]
    v_mfma_f32_16x16x32_bf16 a[120:123], a[60:63], a[184:187], a[120:123]
    s_add_u32 s33, s33, 0x80000
    v_mfma_f32_16x16x32_bf16 a[120:123], a[56:59], a[168:171], a[120:123]
    s_add_u32 s35, s35, 0x4000
    v_mfma_f32_16x16x32_bf16 v[252:255], a[56:59], a[164:167], v[252:255]
    v_mfma_f32_16x16x32_bf16 v[252:255], a[60:63], a[180:183], v[252:255]
    v_mfma_f32_16x16x32_bf16 v[248:251], a[60:63], a[176:179], v[248:251]
    v_mfma_f32_16x16x32_bf16 v[248:251], a[56:59], a[160:163], v[248:251]
    s_add_u32 s3, s54, 64
    s_add_u32 s5, s55, 64
    s_mov_b32 s63, s57
    s_load_dwordx2 s[44:45], s[0:1], 40
    s_load_dwordx2 s[46:47], s[0:1], 64
    s_load_dwordx4 s[48:51], s[0:1], 72
    s_mov_b32 s40, 0x3e0293ee
    s_mov_b32 s41, 0x3e0293ee
    s_mov_b32 m0, s34
    s_nop 0
    buffer_load_dwordx4 v1, s[16:19], s32 offen offset:0 sc1 lds
    buffer_load_dwordx4 v1, s[16:19], s32 offen offset:1024 sc1 lds
    buffer_load_dwordx4 v1, s[16:19], s32 offen offset:2048 sc1 lds
    buffer_load_dwordx4 v1, s[16:19], s32 offen offset:3072 sc1 lds
    s_mov_b32 m0, s35
    s_nop 0
    buffer_load_dwordx4 v1, s[20:23], s33 offen offset:0 sc1 lds
    buffer_load_dwordx4 v1, s[20:23], s33 offen offset:1024 sc1 lds
    buffer_load_dwordx4 v1, s[20:23], s33 offen offset:2048 sc1 lds
    buffer_load_dwordx4 v1, s[20:23], s33 offen offset:3072 sc1 lds
    s_add_u32 s32, s32, 0x80000
    s_add_u32 s33, s33, 0x80000
    s_add_u32 s34, s34, 0x4000
    s_and_b32 s34, s34, 0xffff
    s_add_u32 s35, s35, 0x4000
    s_and_b32 s35, s35, 0xffff
    s_or_b32 s35, s35, 0x10000
    v_mov_b32 v2, v1
    v_or_b32 v3, 0x10000, v1
    v_mov_b32 v56, v3
    s_mov_b32 s52, 0x4000
    s_mov_b32 s53, 0
    s_lshl_b32 s62, s28, 6
    s_mul_i32 s31, s29, s29
    s_add_u32 s62, s62, s31
    s_lshr_b32 s31, s30, 1
    s_lshl_b32 s4, s31, 23
    s_add_u32 s4, s4, 0x6000000
    s_add_u32 s8, s6, s4
    s_addc_u32 s9, s7, 0
    s_and_b32 s9, s9, 0xffff
    s_mov_b32 s10, 0
    s_mov_b32 s58, 0
    s_mov_b32 s14, 0x700000
    s_mov_b32 s59, 0x700000
    s_lshl_b32 s54, s62, 12
    s_waitcnt vmcnt(16) lgkmcnt(0)
    s_barrier
    s_cmp_eq_u32 s63, 0
    s_cbranch_scc1 k12_ool_74
k12_oolret_75:
    v_mov_b32 v59, 0
    ds_read_b128 a[128:131], v2 offset:0
    ds_read_b128 a[132:135], v2 offset:1024
    ds_read_b128 a[136:139], v2 offset:2048
    ds_read_b128 a[140:143], v2 offset:3072
    ds_read_b128 a[144:147], v2 offset:4096
    ds_read_b128 a[148:151], v2 offset:5120
    ds_read_b128 a[152:155], v2 offset:6144
    ds_read_b128 a[156:159], v2 offset:7168
    ds_read_b128 a[160:163], v2 offset:8192
    ds_read_b128 a[164:167], v2 offset:9216
    ds_read_b128 a[168:171], v2 offset:10240
    ds_read_b128 a[172:175], v2 offset:11264
    ds_read_b128 a[176:179], v2 offset:12288
    ds_read_b128 a[180:183], v2 offset:13312
    ds_read_b128 a[184:187], v2 offset:14336
    ds_read_b128 a[188:191], v2 offset:15360
    s_cmp_lt_u32 s30, 2
    s_cselect_b64 s[12:13], s[46:47], s[48:49]
    s_cselect_b64 s[60:61], s[44:45], s[50:51]
    s_cselect_b32 s55, 0x800000, s14
    s_and_b32 s13, s13, 0xffff
    v_accvgpr_read_b32 v128, a64
    v_accvgpr_read_b32 v129, a65
    v_accvgpr_read_b32 v130, a66
    v_accvgpr_read_b32 v131, a67
    v_pk_mul_f32 v[128:129], v[128:129], s[40:41]
    v_pk_mul_f32 v[130:131], v[130:131], s[40:41]
    v_cvt_pk_bf16_f32 v96, v128, v129
    v_cvt_pk_bf16_f32 v97, v130, v131
    v_accvgpr_read_b32 v132, a72
    v_accvgpr_read_b32 v133, a73
    v_accvgpr_read_b32 v134, a74
    v_accvgpr_read_b32 v135, a75
    v_pk_mul_f32 v[132:133], v[132:133], s[40:41]
    v_pk_mul_f32 v[134:135], v[134:135], s[40:41]
    v_cvt_pk_bf16_f32 v98, v132, v133
    v_cvt_pk_bf16_f32 v99, v134, v135
    v_accvgpr_read_b32 v136, a80
    v_accvgpr_read_b32 v137, a81
    v_accvgpr_read_b32 v138, a82
    v_accvgpr_read_b32 v139, a83
    v_pk_mul_f32 v[136:137], v[136:137], s[40:41]
    v_pk_mul_f32 v[138:139], v[138:139], s[40:41]
    v_cvt_pk_bf16_f32 v100, v136, v137
    v_cvt_pk_bf16_f32 v101, v138, v139
    v_accvgpr_read_b32 v140, a88
    v_accvgpr_read_b32 v141, a89
    v_accvgpr_read_b32 v142, a90
    v_accvgpr_read_b32 v143, a91
    v_pk_mul_f32 v[140:141], v[140:141], s[40:41]
    v_pk_mul_f32 v[142:143], v[142:143], s[40:41]
    v_cvt_pk_bf16_f32 v102, v140, v141
    v_cvt_pk_bf16_f32 v103, v142, v143
    v_accvgpr_read_b32 v128, a96
    v_accvgpr_read_b32 v129, a97
    v_accvgpr_read_b32 v130, a98
    v_accvgpr_read_b32 v131, a99
    v_pk_mul_f32 v[128:129], v[128:129], s[40:41]
    v_pk_mul_f32 v[130:131], v[130:131], s[40:41]
    v_cvt_pk_bf16_f32 v104, v128, v129
    v_cvt_pk_bf16_f32 v105, v130, v131
    v_accvgpr_read_b32 v132, a104
    v_accvgpr_read_b32 v133, a105
    v_accvgpr_read_b32 v134, a106
    v_accvgpr_read_b32 v135, a107
    v_pk_mul_f32 v[132:133], v[132:133], s[40:41]
    v_pk_mul_f32 v[134:135], v[134:135], s[40:41]
    v_cvt_pk_bf16_f32 v106, v132, v133
    v_cvt_pk_bf16_f32 v107, v134, v135
    v_accvgpr_read_b32 v136, a112
    v_accvgpr_read_b32 v137, a113
    v_accvgpr_read_b32 v138, a114
    v_accvgpr_read_b32 v139, a115
    v_pk_mul_f32 v[136:137], v[136:137], s[40:41]
    v_pk_mul_f32 v[138:139], v[138:139], s[40:41]
    v_cvt_pk_bf16_f32 v108, v136, v137
    v_cvt_pk_bf16_f32 v109, v138, v139
    v_accvgpr_read_b32 v140, a120
    v_accvgpr_read_b32 v141, a121
    v_accvgpr_read_b32 v142, a122
    v_accvgpr_read_b32 v143, a123
    v_pk_mul_f32 v[140:141], v[140:141], s[40:41]
    v_pk_mul_f32 v[142:143], v[142:143], s[40:41]
    v_cvt_pk_bf16_f32 v110, v140, v141
    v_cvt_pk_bf16_f32 v111, v142, v143
    v_accvgpr_read_b32 v128, a68
    v_accvgpr_read_b32 v129, a69
    v_accvgpr_read_b32 v130, a70
    v_accvgpr_read_b32 v131, a71
    v_pk_mul_f32 v[128:129], v[128:129], s[40:41]
    v_pk_mul_f32 v[130:131], v[130:131], s[40:41]
    v_cvt_pk_bf16_f32 v112, v128, v129
    v_cvt_pk_bf16_f32 v113, v130, v131
    v_accvgpr_read_b32 v132, a76
    v_accvgpr_read_b32 v133, a77
    v_accvgpr_read_b32 v134, a78
    v_accvgpr_read_b32 v135, a79
    v_pk_mul_f32 v[132:133], v[132:133], s[40:41]
    v_pk_mul_f32 v[134:135], v[134:135], s[40:41]
    v_cvt_pk_bf16_f32 v114, v132, v133
    v_cvt_pk_bf16_f32 v115, v134, v135
    v_accvgpr_read_b32 v136, a84
    v_accvgpr_read_b32 v137, a85
    v_accvgpr_read_b32 v138, a86
    v_accvgpr_read_b32 v139, a87
    v_pk_mul_f32 v[136:137], v[136:137], s[40:41]
    v_pk_mul_f32 v[138:139], v[138:139], s[40:41]
    v_cvt_pk_bf16_f32 v116, v136, v137
    v_cvt_pk_bf16_f32 v117, v138, v139
    v_accvgpr_read_b32 v140, a92
    v_accvgpr_read_b32 v141, a93
    v_accvgpr_read_b32 v142, a94
    v_accvgpr_read_b32 v143, a95
    v_pk_mul_f32 v[140:141], v[140:141], s[40:41]
    v_pk_mul_f32 v[142:143], v[142:143], s[40:41]
    v_cvt_pk_bf16_f32 v118, v140, v141
    v_cvt_pk_bf16_f32 v119, v142, v143
    v_accvgpr_read_b32 v128, a100
    v_accvgpr_read_b32 v129, a101
    v_accvgpr_read_b32 v130, a102
    v_accvgpr_read_b32 v131, a103
    v_pk_mul_f32 v[128:129], v[128:129], s[40:41]
    v_pk_mul_f32 v[130:131], v[130:131], s[40:41]
    v_cvt_pk_bf16_f32 v120, v128, v129
    v_cvt_pk_bf16_f32 v121, v130, v131
    v_accvgpr_read_b32 v132, a108
    v_accvgpr_read_b32 v133, a109
    v_accvgpr_read_b32 v134, a110
    v_accvgpr_read_b32 v135, a111
    v_pk_mul_f32 v[132:133], v[132:133], s[40:41]
    v_pk_mul_f32 v[134:135], v[134:135], s[40:41]
    v_cvt_pk_bf16_f32 v122, v132, v133
    v_cvt_pk_bf16_f32 v123, v134, v135
    v_accvgpr_read_b32 v136, a116
    v_accvgpr_read_b32 v137, a117
    v_accvgpr_read_b32 v138, a118
    v_accvgpr_read_b32 v139, a119
    v_pk_mul_f32 v[136:137], v[136:137], s[40:41]
    v_pk_mul_f32 v[138:139], v[138:139], s[40:41]
    v_cvt_pk_bf16_f32 v124, v136, v137
    v_cvt_pk_bf16_f32 v125, v138, v139
    v_accvgpr_read_b32 v140, a124
    v_accvgpr_read_b32 v141, a125
    v_accvgpr_read_b32 v142, a126
    v_accvgpr_read_b32 v143, a127
    v_pk_mul_f32 v[140:141], v[140:141], s[40:41]
    v_pk_mul_f32 v[142:143], v[142:143], s[40:41]
    v_cvt_pk_bf16_f32 v126, v140, v141
    v_cvt_pk_bf16_f32 v127, v142, v143
    v_pk_mul_f32 v[192:193], v[192:193], s[40:41]
    v_pk_mul_f32 v[194:195], v[194:195], s[40:41]
    v_cvt_pk_bf16_f32 v64, v192, v193
    v_cvt_pk_bf16_f32 v65, v194, v195
    v_pk_mul_f32 v[200:201], v[200:201], s[40:41]
    v_pk_mul_f32 v[202:203], v[202:203], s[40:41]
    v_cvt_pk_bf16_f32 v66, v200, v201
    v_cvt_pk_bf16_f32 v67, v202, v203
    v_pk_mul_f32 v[208:209], v[208:209], s[40:41]
    v_pk_mul_f32 v[210:211], v[210:211], s[40:41]
    v_cvt_pk_bf16_f32 v68, v208, v209
    v_cvt_pk_bf16_f32 v69, v210, v211
    v_pk_mul_f32 v[216:217], v[216:217], s[40:41]
    v_pk_mul_f32 v[218:219], v[218:219], s[40:41]
    v_cvt_pk_bf16_f32 v70, v216, v217
    v_cvt_pk_bf16_f32 v71, v218, v219
    v_pk_mul_f32 v[224:225], v[224:225], s[40:41]
    v_pk_mul_f32 v[226:227], v[226:227], s[40:41]
    v_cvt_pk_bf16_f32 v72, v224, v225
    v_cvt_pk_bf16_f32 v73, v226, v227
    v_pk_mul_f32 v[232:233], v[232:233], s[40:41]
    v_pk_mul_f32 v[234:235], v[234:235], s[40:41]
    v_cvt_pk_bf16_f32 v74, v232, v233
    v_cvt_pk_bf16_f32 v75, v234, v235
    v_pk_mul_f32 v[240:241], v[240:241], s[40:41]
    v_pk_mul_f32 v[242:243], v[242:243], s[40:41]
    v_cvt_pk_bf16_f32 v76, v240, v241
    v_cvt_pk_bf16_f32 v77, v242, v243
    v_pk_mul_f32 v[248:249], v[248:249], s[40:41]
    v_pk_mul_f32 v[250:251], v[250:251], s[40:41]
    v_cvt_pk_bf16_f32 v78, v248, v249
    v_cvt_pk_bf16_f32 v79, v250, v251
    v_pk_mul_f32 v[196:197], v[196:197], s[40:41]
    v_pk_mul_f32 v[198:199], v[198:199], s[40:41]
    v_cvt_pk_bf16_f32 v80, v196, v197
    v_cvt_pk_bf16_f32 v81, v198, v199
    v_pk_mul_f32 v[204:205], v[204:205], s[40:41]
    v_pk_mul_f32 v[206:207], v[206:207], s[40:41]
    v_cvt_pk_bf16_f32 v82, v204, v205
    v_cvt_pk_bf16_f32 v83, v206, v207
    v_pk_mul_f32 v[212:213], v[212:213], s[40:41]
    v_pk_mul_f32 v[214:215], v[214:215], s[40:41]
    v_cvt_pk_bf16_f32 v84, v212, v213
    v_cvt_pk_bf16_f32 v85, v214, v215
    v_pk_mul_f32 v[220:221], v[220:221], s[40:41]
    v_pk_mul_f32 v[222:223], v[222:223], s[40:41]
    v_cvt_pk_bf16_f32 v86, v220, v221
    v_cvt_pk_bf16_f32 v87, v222, v223
    v_pk_mul_f32 v[228:229], v[228:229], s[40:41]
    v_pk_mul_f32 v[230:231], v[230:231], s[40:41]
    v_cvt_pk_bf16_f32 v88, v228, v229
    v_cvt_pk_bf16_f32 v89, v230, v231
    v_pk_mul_f32 v[236:237], v[236:237], s[40:41]
    v_pk_mul_f32 v[238:239], v[238:239], s[40:41]
    v_cvt_pk_bf16_f32 v90, v236, v237
    v_cvt_pk_bf16_f32 v91, v238, v239
    v_pk_mul_f32 v[244:245], v[244:245], s[40:41]
    v_pk_mul_f32 v[246:247], v[246:247], s[40:41]
    v_cvt_pk_bf16_f32 v92, v244, v245
    v_cvt_pk_bf16_f32 v93, v246, v247
    v_pk_mul_f32 v[252:253], v[252:253], s[40:41]
    v_pk_mul_f32 v[254:255], v[254:255], s[40:41]
    v_cvt_pk_bf16_f32 v94, v252, v253
    v_cvt_pk_bf16_f32 v95, v254, v255
    v_add_u32 v2, 0x4000, v1
    v_mov_b32 v8, 0
    v_mov_b32 v232, 0
    v_mov_b32 v9, 0
    v_mov_b32 v233, 0
    v_mov_b32 v10, 0
    v_mov_b32 v234, 0
    v_mov_b32 v11, 0
    v_mov_b32 v235, 0
    s_mov_b32 s36, 0
    s_mov_b32 s37, 0x40004000
    v_mfma_f32_32x32x16_bf16 v[16:31], v[232:235], v[232:235], 0
    v_mfma_f32_32x32x16_bf16 v[32:47], v[232:235], v[232:235], 0
    v_and_b32 v6, 0xf0, v1
    v_cmp_eq_u32 vcc, 0, v6
    v_mov_b32 v6, 0x3f803f80
    v_lshrrev_b32 v229, 7, v1
    s_and_b32 s4, s30, 1
    s_lshl_b32 s31, s4, 11
    v_lshl_add_u32 v230, v1, 1, s31
    v_lshl_add_u32 v229, s4, 4, v229
    v_mul_u32_u24 v228, 7168, v229
    v_and_b32 v7, 0x70, v1
    v_add_u32 v228, v228, v7
    v_lshlrev_b32 v229, 5, v229
    v_and_b32 v57, 0x10, v1
    v_add_u32 v229, v229, v57
    v_lshrrev_b32 v7, 5, v7
    v_lshl_add_u32 v229, v7, 15, v229
    v_cndmask_b32 v60, 0, v6, vcc
    v_cndmask_b32 v61, 0, v6, vcc
    v_cndmask_b32 v62, 0, v6, vcc
    v_cndmask_b32 v63, 0, v6, vcc
    v_mov_b32 v12, 0
    v_mov_b32 v13, 0
    v_mov_b32 v14, 0
    v_mov_b32 v15, 0
    v_mov_b32 v48, 0
    v_mov_b32 v49, 0
    v_mov_b32 v50, 0
    v_mov_b32 v51, 0
    v_mov_b32 v248, 0
    v_mov_b32 v249, 0
    v_mov_b32 v250, 0
    v_mov_b32 v251, 0
    v_mov_b32 v252, 0
    v_mov_b32 v253, 0
    v_mov_b32 v254, 0
    v_mov_b32 v255, 0
    s_waitcnt lgkmcnt(0)
    s_cmp_ge_u32 s36, s42
    s_cbranch_scc1 k2_prep_76
k2_prepret_77:
    v_mfma_f32_16x16x32_bf16 v[128:131], a[128:131], v[64:67], v[16:19]
    v_mfma_f32_16x16x32_bf16 v[128:131], a[132:135], v[68:71], v[128:131]
    v_mfma_f32_16x16x32_bf16 v[128:131], a[136:139], v[72:75], v[128:131]
    v_mfma_f32_16x16x32_bf16 v[128:131], a[140:143], v[76:79], v[128:131]
    s_add_u32 s36, s36, 32
    v_mfma_f32_16x16x32_bf16 v[132:135], a[140:143], v[92:95], v[20:23]
    v_mfma_f32_16x16x32_bf16 v[132:135], a[136:139], v[88:91], v[132:135]
    v_mfma_f32_16x16x32_bf16 v[132:135], a[132:135], v[84:87], v[132:135]
    v_mfma_f32_16x16x32_bf16 v[132:135], a[128:131], v[80:83], v[132:135]
    v_mfma_f32_16x16x32_bf16 v[136:139], a[128:131], v[96:99], v[24:27]
    v_mfma_f32_16x16x32_bf16 v[136:139], a[132:135], v[100:103], v[136:139]
    v_mfma_f32_16x16x32_bf16 v[136:139], a[136:139], v[104:107], v[136:139]
    v_mfma_f32_16x16x32_bf16 v[136:139], a[140:143], v[108:111], v[136:139]
    v_mfma_f32_16x16x32_bf16 v[140:143], a[140:143], v[124:127], v[28:31]
    v_mfma_f32_16x16x32_bf16 v[140:143], a[136:139], v[120:123], v[140:143]
    v_mfma_f32_16x16x32_bf16 v[140:143], a[132:135], v[116:119], v[140:143]
    v_mfma_f32_16x16x32_bf16 v[140:143], a[128:131], v[112:115], v[140:143]
    v_mfma_f32_16x16x32_bf16 v[156:159], a[144:147], v[112:115], v[44:47]
    v_mfma_f32_16x16x32_bf16 v[156:159], a[148:151], v[116:119], v[156:159]
    v_mfma_f32_16x16x32_bf16 v[156:159], a[152:155], v[120:123], v[156:159]
    v_mfma_f32_16x16x32_bf16 v[156:159], a[156:159], v[124:127], v[156:159]
    v_mfma_f32_16x16x32_bf16 v[152:155], a[156:159], v[108:111], v[40:43]
    v_mfma_f32_16x16x32_bf16 v[152:155], a[152:155], v[104:107], v[152:155]
    v_mfma_f32_16x16x32_bf16 v[152:155], a[148:151], v[100:103], v[152:155]
    v_mfma_f32_16x16x32_bf16 v[152:155], a[144:147], v[96:99], v[152:155]
    v_mfma_f32_16x16x32_bf16 v[148:151], a[144:147], v[80:83], v[36:39]
    v_mfma_f32_16x16x32_bf16 v[148:151], a[148:151], v[84:87], v[148:151]
    v_mfma_f32_16x16x32_bf16 v[148:151], a[152:155], v[88:91], v[148:151]
    v_mfma_f32_16x16x32_bf16 v[148:151], a[156:159], v[92:95], v[148:151]
    v_mfma_f32_16x16x32_bf16 v[144:147], a[156:159], v[76:79], v[32:35]
    v_mfma_f32_16x16x32_bf16 v[144:147], a[152:155], v[72:75], v[144:147]
    v_mfma_f32_16x16x32_bf16 v[144:147], a[148:151], v[68:71], v[144:147]
    v_mfma_f32_16x16x32_bf16 v[144:147], a[144:147], v[64:67], v[144:147]
    v_mfma_f32_32x32x16_bf16 a[0:15], v[232:235], v[232:235], 0
    v_mfma_f32_32x32x16_bf16 a[16:31], v[232:235], v[232:235], 0
    v_mfma_f32_32x32x16_bf16 a[32:47], v[232:235], v[232:235], 0
    v_mfma_f32_32x32x16_bf16 a[48:63], v[232:235], v[232:235], 0
    v_mfma_f32_32x32x16_bf16 a[64:79], v[232:235], v[232:235], 0
    v_mfma_f32_32x32x16_bf16 a[80:95], v[232:235], v[232:235], 0
    v_mfma_f32_32x32x16_bf16 a[96:111], v[232:235], v[232:235], 0
    v_mfma_f32_32x32x16_bf16 a[112:127], v[232:235], v[232:235], 0
    v_max_f32 v52, v128, v129
    v_max3_f32 v52, v52, v130, v131
    v_max3_f32 v52, v52, v144, v145
    v_max3_f32 v52, v52, v146, v147
    v_max_f32 v53, v132, v133
    v_max3_f32 v53, v53, v134, v135
    v_max3_f32 v53, v53, v148, v149
    v_max3_f32 v53, v53, v150, v151
    v_max_f32 v54, v136, v137
    v_max3_f32 v54, v54, v138, v139
    v_max3_f32 v54, v54, v152, v153
    v_max3_f32 v54, v54, v154, v155
    v_max_f32 v55, v140, v141
    v_max3_f32 v55, v55, v142, v143
    v_max3_f32 v55, v55, v156, v157
    v_max3_f32 v55, v55, v158, v159
    v_mov_b32 v224, v52
    v_mov_b32 v225, v53
    v_mov_b32 v226, v54
    v_mov_b32 v227, v55
    s_nop 1
    v_permlane16_swap_b32 v52, v224
    v_permlane16_swap_b32 v53, v225
    v_permlane16_swap_b32 v54, v226
    v_permlane16_swap_b32 v55, v227
    s_nop 1
    v_max_f32 v52, v52, v224
    v_max_f32 v53, v53, v225
    v_max_f32 v54, v54, v226
    v_max_f32 v55, v55, v227
    v_mov_b32 v224, v52
    v_mov_b32 v225, v53
    v_mov_b32 v226, v54
    v_mov_b32 v227, v55
    s_nop 1
    v_permlane32_swap_b32 v52, v224
    v_permlane32_swap_b32 v53, v225
    v_permlane32_swap_b32 v54, v226
    v_permlane32_swap_b32 v55, v227
    s_nop 1
    v_max_f32 v52, v52, v224
    v_max_f32 v53, v53, v225
    v_max_f32 v54, v54, v226
    v_max_f32 v55, v55, v227
    v_add_f32 v52, 0x41400000, v52
    v_add_f32 v53, 0x41400000, v53
    v_add_f32 v54, 0x41400000, v54
    v_add_f32 v55, 0x41400000, v55
    v_sub_f32 v16, 0, v52
    v_sub_f32 v17, 0, v52
    v_sub_f32 v18, 0, v52
    v_sub_f32 v19, 0, v52
    v_sub_f32 v20, 0, v53
    v_sub_f32 v21, 0, v53
    v_sub_f32 v22, 0, v53
    v_sub_f32 v23, 0, v53
    v_sub_f32 v24, 0, v54
    v_sub_f32 v25, 0, v54
    v_sub_f32 v26, 0, v54
    v_sub_f32 v27, 0, v54
    v_sub_f32 v28, 0, v55
    v_sub_f32 v29, 0, v55
    v_sub_f32 v30, 0, v55
    v_sub_f32 v31, 0, v55
    v_sub_f32 v32, 0, v52
    v_sub_f32 v33, 0, v52
    v_sub_f32 v34, 0, v52
    v_sub_f32 v35, 0, v52
    v_sub_f32 v36, 0, v53
    v_sub_f32 v37, 0, v53
    v_sub_f32 v38, 0, v53
    v_sub_f32 v39, 0, v53
    v_sub_f32 v40, 0, v54
    v_sub_f32 v41, 0, v54
    v_sub_f32 v42, 0, v54
    v_sub_f32 v43, 0, v54
    v_sub_f32 v44, 0, v55
    v_sub_f32 v45, 0, v55
    v_sub_f32 v46, 0, v55
    v_sub_f32 v47, 0, v55
    v_sub_f32 v8, 0, v52
    v_sub_f32 v9, 0, v53
    v_sub_f32 v10, 0, v54
    v_sub_f32 v11, 0, v55
    s_cmp_ge_u32 s36, s42
    s_cbranch_scc1 k2_prep_84
k2_prepret_85:
    v_mfma_f32_16x16x32_bf16 v[160:163], a[160:163], v[64:67], v[16:19]
    v_sub_f32 v128, v128, v52
    v_sub_f32 v129, v129, v52
    v_sub_f32 v130, v130, v52
    v_mfma_f32_16x16x32_bf16 v[160:163], a[164:167], v[68:71], v[160:163]
    v_exp_f32 v232, v128
    v_sub_f32 v131, v131, v52
    v_mfma_f32_16x16x32_bf16 v[160:163], a[168:171], v[72:75], v[160:163]
    v_exp_f32 v233, v129
    v_sub_f32 v144, v144, v52
    v_mfma_f32_16x16x32_bf16 v[160:163], a[172:175], v[76:79], v[160:163]
    s_add_u32 s36, s36, 32
    s_cmp_eq_u32 s30, 0
    s_cbranch_scc1 k12_ool_78
k12_oolret_79:
    v_sub_f32 v145, v145, v52
    v_mfma_f32_16x16x32_bf16 v[164:167], a[172:175], v[92:95], v[20:23]
    v_exp_f32 v234, v130
    v_cvt_pk_bf16_f32 v192, v232, v233
    v_mfma_f32_16x16x32_bf16 v[164:167], a[168:171], v[88:91], v[164:167]
    v_exp_f32 v235, v131
    v_sub_f32 v146, v146, v52
    v_mfma_f32_16x16x32_bf16 v[164:167], a[164:167], v[84:87], v[164:167]
    v_exp_f32 v236, v144
    v_sub_f32 v147, v147, v52
    v_mfma_f32_16x16x32_bf16 v[164:167], a[160:163], v[80:83], v[164:167]
    v_cvt_pk_bf16_f32 v193, v234, v235
    v_exp_f32 v237, v145
    v_mfma_f32_16x16x32_bf16 v[168:171], a[160:163], v[96:99], v[24:27]
    v_exp_f32 v238, v146
    v_sub_f32 v132, v132, v53
    v_mfma_f32_16x16x32_bf16 v[168:171], a[164:167], v[100:103], v[168:171]
    v_sub_f32 v133, v133, v53
    v_cvt_pk_bf16_f32 v194, v236, v237
    v_or3_b32 v57, v192, v193, v194
    v_mfma_f32_16x16x32_bf16 v[168:171], a[168:171], v[104:107], v[168:171]
    v_exp_f32 v239, v147
    v_sub_f32 v134, v134, v53
    v_mfma_f32_16x16x32_bf16 v[168:171], a[172:175], v[108:111], v[168:171]
    v_exp_f32 v240, v132
    v_sub_f32 v135, v135, v53
    v_mfma_f32_16x16x32_bf16 v[172:175], a[172:175], v[124:127], v[28:31]
    v_cvt_pk_bf16_f32 v195, v238, v239
    v_exp_f32 v241, v133
    v_mfma_f32_16x16x32_bf16 v[172:175], a[168:171], v[120:123], v[172:175]
    v_exp_f32 v242, v134
    v_sub_f32 v148, v148, v53
    v_mfma_f32_16x16x32_bf16 v[172:175], a[164:167], v[116:119], v[172:175]
    v_sub_f32 v149, v149, v53
    v_cvt_pk_bf16_f32 v196, v240, v241
    v_exp_f32 v243, v135
    v_mfma_f32_16x16x32_bf16 v[172:175], a[160:163], v[112:115], v[172:175]
    v_or3_b32 v57, v57, v195, v196
    v_exp_f32 v244, v148
    v_mfma_f32_16x16x32_bf16 v[188:191], a[176:179], v[112:115], v[44:47]
    v_sub_f32 v150, v150, v53
    v_sub_f32 v151, v151, v53
    v_cvt_pk_bf16_f32 v197, v242, v243
    v_mfma_f32_16x16x32_bf16 v[188:191], a[180:183], v[116:119], v[188:191]
    v_exp_f32 v245, v149
    v_exp_f32 v246, v150
    v_mfma_f32_16x16x32_bf16 v[188:191], a[184:187], v[120:123], v[188:191]
    v_sub_f32 v136, v136, v54
    v_sub_f32 v137, v137, v54
    v_cvt_pk_bf16_f32 v198, v244, v245
    v_mfma_f32_16x16x32_bf16 v[188:191], a[188:191], v[124:127], v[188:191]
    v_exp_f32 v247, v151
    v_or3_b32 v57, v57, v197, v198
    v_mfma_f32_16x16x32_bf16 v[184:187], a[188:191], v[108:111], v[40:43]
    v_exp_f32 v232, v136
    v_sub_f32 v138, v138, v54
    v_mfma_f32_16x16x32_bf16 v[184:187], a[184:187], v[104:107], v[184:187]
    ds_read_b128 a[192:195], v3 offset:0
    v_sub_f32 v139, v139, v54
    v_cvt_pk_bf16_f32 v199, v246, v247
    v_mfma_f32_16x16x32_bf16 v[184:187], a[180:183], v[100:103], v[184:187]
    v_exp_f32 v233, v137
    v_exp_f32 v234, v138
    v_mfma_f32_16x16x32_bf16 v[184:187], a[176:179], v[96:99], v[184:187]
    v_sub_f32 v152, v152, v54
    v_sub_f32 v153, v153, v54
    v_cvt_pk_bf16_f32 v200, v232, v233
    v_mfma_f32_16x16x32_bf16 v[180:183], a[176:179], v[80:83], v[36:39]
    v_exp_f32 v235, v139
    v_or3_b32 v57, v57, v199, v200
    v_mfma_f32_16x16x32_bf16 v[180:183], a[180:183], v[84:87], v[180:183]
    v_exp_f32 v236, v152
    v_sub_f32 v154, v154, v54
    v_mfma_f32_16x16x32_bf16 v[180:183], a[184:187], v[88:91], v[180:183]
    v_sub_f32 v155, v155, v54
    v_cvt_pk_bf16_f32 v201, v234, v235
    v_exp_f32 v237, v153
    v_mfma_f32_16x16x32_bf16 v[180:183], a[188:191], v[92:95], v[180:183]
    ds_read_b128 a[196:199], v3 offset:1024
    v_exp_f32 v238, v154
    v_mfma_f32_16x16x32_bf16 v[176:179], a[188:191], v[76:79], v[32:35]
    v_sub_f32 v140, v140, v55
    v_sub_f32 v141, v141, v55
    v_cvt_pk_bf16_f32 v202, v236, v237
    v_mfma_f32_16x16x32_bf16 v[176:179], a[184:187], v[72:75], v[176:179]
    v_exp_f32 v239, v155
    v_or3_b32 v57, v57, v201, v202
    v_mfma_f32_16x16x32_bf16 v[176:179], a[180:183], v[68:71], v[176:179]
    s_cmp_eq_u32 s30, 0
    s_cbranch_scc1 k12_ool_82
k12_oolret_83:
    v_exp_f32 v240, v140
    v_mfma_f32_16x16x32_bf16 v[176:179], a[176:179], v[64:67], v[176:179]
    s_waitcnt vmcnt(8)
    s_barrier
    v_sub_f32 v142, v142, v55
    v_sub_f32 v143, v143, v55
    v_cvt_pk_bf16_f32 v203, v238, v239
    v_exp_f32 v241, v141
    v_exp_f32 v242, v142
    v_sub_f32 v156, v156, v55
    v_sub_f32 v157, v157, v55
    ds_read_b128 a[200:203], v3 offset:2048
    v_cvt_pk_bf16_f32 v204, v240, v241
    v_exp_f32 v243, v143
    v_or3_b32 v57, v57, v203, v204
    v_exp_f32 v244, v156
    v_sub_f32 v158, v158, v55
    v_sub_f32 v159, v159, v55
    v_cvt_pk_bf16_f32 v205, v242, v243
    v_exp_f32 v245, v157
    v_exp_f32 v246, v158
    v_cvt_pk_bf16_f32 v206, v244, v245
    ds_read_b128 a[204:207], v3 offset:3072
    v_exp_f32 v247, v159
    v_or3_b32 v57, v57, v205, v206
    v_cvt_pk_bf16_f32 v207, v246, v247
    v_bitop3_b32 v57, v57, v207, s37 bitop3:0xa8
    v_cmp_ne_u32 vcc, 0, v57
    s_cbranch_vccnz k2_tramp_86
k2_ret_87:
    s_mov_b32 s24, s60
    s_and_b32 s25, s61, 0xffff
    s_mov_b32 s26, s55
    s_lshl_b32 s63, s29, 1
    s_sub_u32 s63, s63, 1
    s_cbranch_scc1 k2_dm3_89
k2_dloop_88:
    v_mfma_f32_16x16x32_bf16 v[12:15], v[60:63], v[192:195], v[12:15]
    v_exp_f32 v232, v160
    v_mfma_f32_16x16x32_bf16 v[48:51], v[60:63], v[196:199], v[48:51]
    s_mov_b32 m0, s34
    ds_read_b128 a[208:211], v3 offset:4096
    v_mfma_f32_16x16x32_bf16 v[248:251], v[60:63], v[200:203], v[248:251]
    s_add_u32 s53, s53, 8192
    buffer_load_dwordx4 v1, s[16:19], s32 offen offset:0 sc1 lds
    v_mfma_f32_16x16x32_bf16 v[252:255], v[60:63], v[204:207], v[252:255]
    s_waitcnt lgkmcnt(3)
    v_exp_f32 v233, v161
    v_mfma_f32_16x16x32_bf16 a[12:15], a[192:195], v[204:207], a[12:15]
    s_and_b32 s53, s53, 0xffff
    v_exp_f32 v234, v162
    v_mfma_f32_16x16x32_bf16 a[8:11], a[192:195], v[200:203], a[8:11]
    s_add_u32 s34, s34, 0x4000
    ds_read_b128 a[212:215], v3 offset:5120
    v_cvt_pk_bf16_f32 v208, v232, v233
    v_mfma_f32_16x16x32_bf16 a[4:7], a[192:195], v[196:199], a[4:7]
    v_exp_f32 v235, v163
    v_mfma_f32_16x16x32_bf16 a[0:3], a[192:195], v[192:195], a[0:3]
    buffer_load_dwordx4 v1, s[16:19], s32 offen offset:1024 sc1 lds
    v_mfma_f32_16x16x32_bf16 a[16:19], a[196:199], v[192:195], a[16:19]
    v_exp_f32 v236, v176
    v_mfma_f32_16x16x32_bf16 a[20:23], a[196:199], v[196:199], a[20:23]
    ds_read_b128 a[216:219], v3 offset:6144
    v_cvt_pk_bf16_f32 v209, v234, v235
    v_mfma_f32_16x16x32_bf16 a[24:27], a[196:199], v[200:203], a[24:27]
    v_exp_f32 v237, v177
    v_mfma_f32_16x16x32_bf16 a[28:31], a[196:199], v[204:207], a[28:31]
    s_waitcnt lgkmcnt(3)
    v_exp_f32 v238, v178
    v_mfma_f32_16x16x32_bf16 a[44:47], a[200:203], v[204:207], a[44:47]
    s_and_b32 s34, s34, 0xffff
    ds_read_b128 a[220:223], v3 offset:7168
    v_cvt_pk_bf16_f32 v210, v236, v237
    v_mfma_f32_16x16x32_bf16 a[40:43], a[200:203], v[200:203], a[40:43]
    s_and_b32 s60, s62, 31
    buffer_load_dwordx4 v1, s[16:19], s32 offen offset:2048 sc1 lds
    v_mfma_f32_16x16x32_bf16 a[36:39], a[200:203], v[196:199], a[36:39]
    v_exp_f32 v239, v179
    v_mfma_f32_16x16x32_bf16 a[32:35], a[200:203], v[192:195], a[32:35]
    s_lshr_b32 s61, s62, 5
    v_or3_b32 v57, v208, v209, v210
    v_add_u32 v3, s53, v56
    v_mfma_f32_16x16x32_bf16 a[48:51], a[204:207], v[192:195], a[48:51]
    v_exp_f32 v240, v164
    v_mfma_f32_16x16x32_bf16 a[52:55], a[204:207], v[196:199], a[52:55]
    ds_read_b128 a[128:131], v2 offset:0
    v_cvt_pk_bf16_f32 v211, v238, v239
    v_mfma_f32_16x16x32_bf16 a[56:59], a[204:207], v[200:203], a[56:59]
    s_mul_i32 s57, s60, 229376
    v_exp_f32 v241, v165
    v_mfma_f32_16x16x32_bf16 a[60:63], a[204:207], v[204:207], a[60:63]
    s_waitcnt lgkmcnt(3)
    buffer_load_dwordx4 v1, s[16:19], s32 offen offset:3072 sc1 lds
    v_mfma_f32_16x16x32_bf16 a[76:79], a[208:211], v[204:207], a[76:79]
    s_add_u32 s32, s32, 0x80000
    v_exp_f32 v242, v166
    v_mfma_f32_16x16x32_bf16 a[72:75], a[208:211], v[200:203], a[72:75]
    s_lshl_b32 s4, s61, 7
    ds_read_b128 a[132:135], v2 offset:1024
    v_cvt_pk_bf16_f32 v212, v240, v241
    v_mfma_f32_16x16x32_bf16 a[68:71], a[208:211], v[196:199], a[68:71]
    v_exp_f32 v243, v167
    v_mfma_f32_16x16x32_bf16 a[64:67], a[208:211], v[192:195], a[64:67]
    s_add_u32 s57, s57, s4
    v_or3_b32 v57, v57, v211, v212
    v_cvt_pk_bf16_f32 v213, v242, v243
    v_mfma_f32_16x16x32_bf16 a[80:83], a[212:215], v[192:195], a[80:83]
    s_waitcnt vmcnt(8)
    v_exp_f32 v244, v180
    v_mfma_f32_16x16x32_bf16 a[84:87], a[212:215], v[196:199], a[84:87]
    buffer_store_dwordx4 a[224:227], v229, s[8:11], s58 offen offset:0 sc1
    ds_read_b128 a[136:139], v2 offset:2048
    v_mfma_f32_16x16x32_bf16 a[88:91], a[212:215], v[200:203], a[88:91]
    s_add_u32 s56, s57, 57344
    v_exp_f32 v245, v181
    v_mfma_f32_16x16x32_bf16 a[92:95], a[212:215], v[204:207], a[92:95]
    s_waitcnt lgkmcnt(3)
    v_exp_f32 v246, v182
    v_mfma_f32_16x16x32_bf16 a[108:111], a[216:219], v[204:207], a[108:111]
    ds_read_b128 a[140:143], v2 offset:3072
    v_cvt_pk_bf16_f32 v214, v244, v245
    v_mfma_f32_16x16x32_bf16 a[104:107], a[216:219], v[200:203], a[104:107]
    s_add_u32 s62, s62, 1
    v_exp_f32 v247, v183
    v_mfma_f32_16x16x32_bf16 a[100:103], a[216:219], v[196:199], a[100:103]
    v_or3_b32 v57, v57, v213, v214
    v_mfma_f32_16x16x32_bf16 a[96:99], a[216:219], v[192:195], a[96:99]
    v_exp_f32 v232, v168
    v_mfma_f32_16x16x32_bf16 a[112:115], a[220:223], v[192:195], a[112:115]
    ds_read_b128 a[144:147], v2 offset:4096
    v_cvt_pk_bf16_f32 v215, v246, v247
    v_mfma_f32_16x16x32_bf16 a[116:119], a[220:223], v[196:199], a[116:119]
    buffer_store_dwordx4 a[228:231], v229, s[8:11], s58 offen offset:256 sc1
    v_mfma_f32_16x16x32_bf16 a[120:123], a[220:223], v[200:203], a[120:123]
    v_exp_f32 v233, v169
    v_mfma_f32_16x16x32_bf16 a[124:127], a[220:223], v[204:207], a[124:127]
    s_waitcnt lgkmcnt(3)
    v_exp_f32 v234, v170
    v_mfma_f32_16x16x32_bf16 v[128:131], a[128:131], v[64:67], v[16:19]
    ds_read_b128 a[148:151], v2 offset:5120
    v_cvt_pk_bf16_f32 v216, v232, v233
    v_mfma_f32_16x16x32_bf16 v[128:131], a[132:135], v[68:71], v[128:131]
    s_waitcnt lgkmcnt(2)
    v_exp_f32 v235, v171
    v_mfma_f32_16x16x32_bf16 v[128:131], a[136:139], v[72:75], v[128:131]
    v_or3_b32 v57, v57, v215, v216
    v_mfma_f32_16x16x32_bf16 v[128:131], a[140:143], v[76:79], v[128:131]
    s_add_u32 s36, s36, 32
    v_exp_f32 v236, v184
    v_mfma_f32_16x16x32_bf16 v[132:135], a[140:143], v[92:95], v[20:23]
    ds_read_b128 a[152:155], v2 offset:6144
    v_cvt_pk_bf16_f32 v217, v234, v235
    v_mfma_f32_16x16x32_bf16 v[132:135], a[136:139], v[88:91], v[132:135]
    s_lshl_b32 s58, s61, 17
    buffer_load_dwordx4 a[224:227], v228, s[12:15], s57 offen
    v_mfma_f32_16x16x32_bf16 v[132:135], a[132:135], v[84:87], v[132:135]
    s_add_u32 s52, s52, 8192
    v_exp_f32 v237, v185
    v_mfma_f32_16x16x32_bf16 v[132:135], a[128:131], v[80:83], v[132:135]
    v_exp_f32 v238, v186
    v_mfma_f32_16x16x32_bf16 v[136:139], a[128:131], v[96:99], v[24:27]
    s_lshl_b32 s60, s60, 10
    ds_read_b128 a[156:159], v2 offset:7168
    v_cvt_pk_bf16_f32 v218, v236, v237
    v_mfma_f32_16x16x32_bf16 v[136:139], a[132:135], v[100:103], v[136:139]
    s_and_b32 s52, s52, 0xffff
    v_exp_f32 v239, v187
    v_mfma_f32_16x16x32_bf16 v[136:139], a[136:139], v[104:107], v[136:139]
    v_or3_b32 v57, v57, v217, v218
    v_mfma_f32_16x16x32_bf16 v[136:139], a[140:143], v[108:111], v[136:139]
    v_add_u32 v2, s52, v1
    v_cvt_pk_bf16_f32 v219, v238, v239
    v_mfma_f32_16x16x32_bf16 v[140:143], a[140:143], v[124:127], v[28:31]
    s_add_u32 s58, s58, s60
    v_exp_f32 v240, v172
    v_mfma_f32_16x16x32_bf16 v[140:143], a[136:139], v[120:123], v[140:143]
    buffer_load_dwordx4 a[228:231], v228, s[12:15], s56 offen
    v_mfma_f32_16x16x32_bf16 v[140:143], a[132:135], v[116:119], v[140:143]
    v_exp_f32 v241, v173
    v_mfma_f32_16x16x32_bf16 v[140:143], a[128:131], v[112:115], v[140:143]
    s_waitcnt lgkmcnt(2)
    ds_read_b128 a[192:195], v3 offset:0
    v_cvt_pk_bf16_f32 v220, v240, v241
    v_mfma_f32_16x16x32_bf16 v[156:159], a[144:147], v[112:115], v[44:47]
    s_mov_b32 s10, s59
    v_exp_f32 v242, v174
    v_mfma_f32_16x16x32_bf16 v[156:159], a[148:151], v[116:119], v[156:159]
    s_waitcnt lgkmcnt(1)
    v_exp_f32 v243, v175
    v_mfma_f32_16x16x32_bf16 v[156:159], a[152:155], v[120:123], v[156:159]
    ds_read_b128 a[196:199], v3 offset:1024
    v_or3_b32 v57, v57, v219, v220
    v_mfma_f32_16x16x32_bf16 v[156:159], a[156:159], v[124:127], v[156:159]
    v_exp_f32 v244, v188
    v_mfma_f32_16x16x32_bf16 v[152:155], a[156:159], v[108:111], v[40:43]
    v_cvt_pk_bf16_f32 v221, v242, v243
    v_mfma_f32_16x16x32_bf16 v[152:155], a[152:155], v[104:107], v[152:155]
    buffer_load_dword v7, v230, s[24:27], s54 offen
    v_mfma_f32_16x16x32_bf16 v[152:155], a[148:151], v[100:103], v[152:155]
    v_exp_f32 v245, v189
    v_mfma_f32_16x16x32_bf16 v[152:155], a[144:147], v[96:99], v[152:155]
    ds_read_b128 a[200:203], v3 offset:2048
    v_cvt_pk_bf16_f32 v222, v244, v245
    v_mfma_f32_16x16x32_bf16 v[148:151], a[144:147], v[80:83], v[36:39]
    v_exp_f32 v246, v190
    v_mfma_f32_16x16x32_bf16 v[148:151], a[148:151], v[84:87], v[148:151]
    v_exp_f32 v247, v191
    v_mfma_f32_16x16x32_bf16 v[148:151], a[152:155], v[88:91], v[148:151]
    ds_read_b128 a[204:207], v3 offset:3072
    v_or3_b32 v57, v57, v221, v222
    v_mfma_f32_16x16x32_bf16 v[148:151], a[156:159], v[92:95], v[148:151]
    v_cvt_pk_bf16_f32 v223, v246, v247
    v_mfma_f32_16x16x32_bf16 v[144:147], a[156:159], v[76:79], v[32:35]
    s_add_u32 s54, s54, 4096
    v_mfma_f32_16x16x32_bf16 v[144:147], a[152:155], v[72:75], v[144:147]
    v_bitop3_b32 v57, v57, v223, s37 bitop3:0xa8
    v_cmp_ne_u32 vcc, 0, v57
    v_mfma_f32_16x16x32_bf16 v[144:147], a[148:151], v[68:71], v[144:147]
    v_mfma_f32_16x16x32_bf16 v[144:147], a[144:147], v[64:67], v[144:147]
    s_cbranch_vccnz k2_tramp_90
k2_ret_91:
    v_mfma_f32_16x16x32_bf16 v[12:15], v[60:63], v[208:211], v[12:15]
    v_exp_f32 v232, v128
    v_mfma_f32_16x16x32_bf16 v[48:51], v[60:63], v[212:215], v[48:51]
    s_mov_b32 m0, s35
    ds_read_b128 a[208:211], v3 offset:4096
    v_mfma_f32_16x16x32_bf16 v[248:251], v[60:63], v[216:219], v[248:251]
    s_add_u32 s53, s53, 8192
    buffer_load_dwordx4 v1, s[20:23], s33 offen offset:0 sc1 lds
    v_mfma_f32_16x16x32_bf16 v[252:255], v[60:63], v[220:223], v[252:255]
    s_waitcnt lgkmcnt(3)
    v_exp_f32 v233, v129
    v_mfma_f32_16x16x32_bf16 a[12:15], a[192:195], v[220:223], a[12:15]
    s_and_b32 s53, s53, 0xffff
    v_exp_f32 v234, v130
    v_mfma_f32_16x16x32_bf16 a[8:11], a[192:195], v[216:219], a[8:11]
    ds_read_b128 a[212:215], v3 offset:5120
    v_cvt_pk_bf16_f32 v192, v232, v233
    v_mfma_f32_16x16x32_bf16 a[4:7], a[192:195], v[212:215], a[4:7]
    v_exp_f32 v235, v131
    v_mfma_f32_16x16x32_bf16 a[0:3], a[192:195], v[208:211], a[0:3]
    v_exp_f32 v236, v144
    v_mfma_f32_16x16x32_bf16 a[16:19], a[196:199], v[208:211], a[16:19]
    ds_read_b128 a[216:219], v3 offset:6144
    v_cvt_pk_bf16_f32 v193, v234, v235
    v_mfma_f32_16x16x32_bf16 a[20:23], a[196:199], v[212:215], a[20:23]
    v_exp_f32 v237, v145
    v_mfma_f32_16x16x32_bf16 a[24:27], a[196:199], v[216:219], a[24:27]
    v_mfma_f32_16x16x32_bf16 a[28:31], a[196:199], v[220:223], a[28:31]
    s_waitcnt lgkmcnt(3)
    v_exp_f32 v238, v146
    v_mfma_f32_16x16x32_bf16 a[44:47], a[200:203], v[220:223], a[44:47]
    ds_read_b128 a[220:223], v3 offset:7168
    v_cvt_pk_bf16_f32 v194, v236, v237
    v_mfma_f32_16x16x32_bf16 a[40:43], a[200:203], v[216:219], a[40:43]
    v_exp_f32 v239, v147
    v_mfma_f32_16x16x32_bf16 a[36:39], a[200:203], v[212:215], a[36:39]
    v_or3_b32 v57, v192, v193, v194
    v_mfma_f32_16x16x32_bf16 a[32:35], a[200:203], v[208:211], a[32:35]
    s_add_u32 s35, s35, 0x4000
    v_add_u32 v3, s53, v56
    v_cvt_pk_bf16_f32 v195, v238, v239
    v_mfma_f32_16x16x32_bf16 a[48:51], a[204:207], v[208:211], a[48:51]
    v_exp_f32 v240, v132
    v_mfma_f32_16x16x32_bf16 a[52:55], a[204:207], v[212:215], a[52:55]
    buffer_load_dwordx4 v1, s[20:23], s33 offen offset:1024 sc1 lds
    ds_read_b128 a[128:131], v2 offset:0
    v_mfma_f32_16x16x32_bf16 a[56:59], a[204:207], v[216:219], a[56:59]
    v_exp_f32 v241, v133
    v_mfma_f32_16x16x32_bf16 a[60:63], a[204:207], v[220:223], a[60:63]
    s_waitcnt lgkmcnt(3)
    v_exp_f32 v242, v134
    v_mfma_f32_16x16x32_bf16 a[76:79], a[208:211], v[220:223], a[76:79]
    ds_read_b128 a[132:135], v2 offset:1024
    v_cvt_pk_bf16_f32 v196, v240, v241
    v_mfma_f32_16x16x32_bf16 a[72:75], a[208:211], v[216:219], a[72:75]
    v_exp_f32 v243, v135
    v_mfma_f32_16x16x32_bf16 a[68:71], a[208:211], v[212:215], a[68:71]
    v_or3_b32 v57, v57, v195, v196
    v_mfma_f32_16x16x32_bf16 a[64:67], a[208:211], v[208:211], a[64:67]
    v_exp_f32 v244, v148
    v_mfma_f32_16x16x32_bf16 a[80:83], a[212:215], v[208:211], a[80:83]
    ds_read_b128 a[136:139], v2 offset:2048
    v_cvt_pk_bf16_f32 v197, v242, v243
    v_mfma_f32_16x16x32_bf16 a[84:87], a[212:215], v[212:215], a[84:87]
    v_exp_f32 v245, v149
    v_mfma_f32_16x16x32_bf16 a[88:91], a[212:215], v[216:219], a[88:91]
    v_mfma_f32_16x16x32_bf16 a[92:95], a[212:215], v[220:223], a[92:95]
    s_waitcnt lgkmcnt(3)
    v_exp_f32 v246, v150
    v_mfma_f32_16x16x32_bf16 a[108:111], a[216:219], v[220:223], a[108:111]
    ds_read_b128 a[140:143], v2 offset:3072
    v_cvt_pk_bf16_f32 v198, v244, v245
    v_mfma_f32_16x16x32_bf16 a[104:107], a[216:219], v[216:219], a[104:107]
    v_exp_f32 v247, v151
    v_mfma_f32_16x16x32_bf16 a[100:103], a[216:219], v[212:215], a[100:103]
    v_or3_b32 v57, v57, v197, v198
    v_mfma_f32_16x16x32_bf16 a[96:99], a[216:219], v[208:211], a[96:99]
    s_and_b32 s35, s35, 0xffff
    v_exp_f32 v232, v136
    v_mfma_f32_16x16x32_bf16 a[112:115], a[220:223], v[208:211], a[112:115]
    ds_read_b128 a[144:147], v2 offset:4096
    v_cvt_pk_bf16_f32 v199, v246, v247
    v_mfma_f32_16x16x32_bf16 a[116:119], a[220:223], v[212:215], a[116:119]
    buffer_load_dwordx4 v1, s[20:23], s33 offen offset:2048 sc1 lds
    v_mfma_f32_16x16x32_bf16 a[120:123], a[220:223], v[216:219], a[120:123]
    v_exp_f32 v233, v137
    v_mfma_f32_16x16x32_bf16 a[124:127], a[220:223], v[220:223], a[124:127]
    s_waitcnt lgkmcnt(3)
    v_exp_f32 v234, v138
    v_mfma_f32_16x16x32_bf16 v[160:163], a[128:131], v[64:67], v[16:19]
    ds_read_b128 a[148:151], v2 offset:5120
    v_cvt_pk_bf16_f32 v200, v232, v233
    v_mfma_f32_16x16x32_bf16 v[160:163], a[132:135], v[68:71], v[160:163]
    s_waitcnt lgkmcnt(2)
    v_exp_f32 v235, v139
    v_mfma_f32_16x16x32_bf16 v[160:163], a[136:139], v[72:75], v[160:163]
    v_or3_b32 v57, v57, v199, v200
    v_mfma_f32_16x16x32_bf16 v[160:163], a[140:143], v[76:79], v[160:163]
    s_or_b32 s35, s35, 0x10000
    v_exp_f32 v236, v152
    v_mfma_f32_16x16x32_bf16 v[164:167], a[140:143], v[92:95], v[20:23]
    s_add_u32 s36, s36, 32
    ds_read_b128 a[152:155], v2 offset:6144
    v_cvt_pk_bf16_f32 v201, v234, v235
    v_mfma_f32_16x16x32_bf16 v[164:167], a[136:139], v[88:91], v[164:167]
    v_exp_f32 v237, v153
    v_mfma_f32_16x16x32_bf16 v[164:167], a[132:135], v[84:87], v[164:167]
    s_add_u32 s52, s52, 8192
    v_mfma_f32_16x16x32_bf16 v[164:167], a[128:131], v[80:83], v[164:167]
    v_exp_f32 v238, v154
    v_mfma_f32_16x16x32_bf16 v[168:171], a[128:131], v[96:99], v[24:27]
    s_and_b32 s52, s52, 0xffff
    ds_read_b128 a[156:159], v2 offset:7168
    v_cvt_pk_bf16_f32 v202, v236, v237
    v_mfma_f32_16x16x32_bf16 v[168:171], a[132:135], v[100:103], v[168:171]
    v_exp_f32 v239, v155
    v_mfma_f32_16x16x32_bf16 v[168:171], a[136:139], v[104:107], v[168:171]
    v_or3_b32 v57, v57, v201, v202
    v_mfma_f32_16x16x32_bf16 v[168:171], a[140:143], v[108:111], v[168:171]
    v_add_u32 v2, s52, v1
    v_cvt_pk_bf16_f32 v203, v238, v239
    v_mfma_f32_16x16x32_bf16 v[172:175], a[140:143], v[124:127], v[28:31]
    v_exp_f32 v240, v140
    v_mfma_f32_16x16x32_bf16 v[172:175], a[136:139], v[120:123], v[172:175]
    buffer_load_dwordx4 v1, s[20:23], s33 offen offset:3072 sc1 lds
    v_mfma_f32_16x16x32_bf16 v[172:175], a[132:135], v[116:119], v[172:175]
    s_add_u32 s33, s33, 0x80000
    v_exp_f32 v241, v141
    v_mfma_f32_16x16x32_bf16 v[172:175], a[128:131], v[112:115], v[172:175]
    s_waitcnt lgkmcnt(2)
    ds_read_b128 a[192:195], v3 offset:0
    v_cvt_pk_bf16_f32 v204, v240, v241
    v_mfma_f32_16x16x32_bf16 v[188:191], a[144:147], v[112:115], v[44:47]
    v_exp_f32 v242, v142
    v_mfma_f32_16x16x32_bf16 v[188:191], a[148:151], v[116:119], v[188:191]
    s_waitcnt lgkmcnt(1)
    v_exp_f32 v243, v143
    v_mfma_f32_16x16x32_bf16 v[188:191], a[152:155], v[120:123], v[188:191]
    ds_read_b128 a[196:199], v3 offset:1024
    v_or3_b32 v57, v57, v203, v204
    v_mfma_f32_16x16x32_bf16 v[188:191], a[156:159], v[124:127], v[188:191]
    v_exp_f32 v244, v156
    v_mfma_f32_16x16x32_bf16 v[184:187], a[156:159], v[108:111], v[40:43]
    v_cvt_pk_bf16_f32 v205, v242, v243
    v_mfma_f32_16x16x32_bf16 v[184:187], a[152:155], v[104:107], v[184:187]
    v_exp_f32 v245, v157
    v_mfma_f32_16x16x32_bf16 v[184:187], a[148:151], v[100:103], v[184:187]
    ds_read_b128 a[200:203], v3 offset:2048
    v_mfma_f32_16x16x32_bf16 v[184:187], a[144:147], v[96:99], v[184:187]
    s_sub_u32 s63, s63, 1
    v_exp_f32 v246, v158
    v_mfma_f32_16x16x32_bf16 v[180:183], a[144:147], v[80:83], v[36:39]
    v_cvt_pk_bf16_f32 v206, v244, v245
    v_mfma_f32_16x16x32_bf16 v[180:183], a[148:151], v[84:87], v[180:183]
    v_exp_f32 v247, v159
    v_mfma_f32_16x16x32_bf16 v[180:183], a[152:155], v[88:91], v[180:183]
    ds_read_b128 a[204:207], v3 offset:3072
    v_or3_b32 v57, v57, v205, v206
    v_mfma_f32_16x16x32_bf16 v[180:183], a[156:159], v[92:95], v[180:183]
    v_cvt_pk_bf16_f32 v207, v246, v247
    v_mfma_f32_16x16x32_bf16 v[176:179], a[156:159], v[76:79], v[32:35]
    v_mfma_f32_16x16x32_bf16 v[176:179], a[152:155], v[72:75], v[176:179]
    v_bitop3_b32 v57, v57, v207, s37 bitop3:0xa8
    v_cmp_ne_u32 vcc, 0, v57
    v_mfma_f32_16x16x32_bf16 v[176:179], a[148:151], v[68:71], v[176:179]
    v_mfma_f32_16x16x32_bf16 v[176:179], a[144:147], v[64:67], v[176:179]
    s_waitcnt vmcnt(13)
    s_barrier
    s_cbranch_vccnz k2_tramp_92
k2_ret_93:
    s_cmp_lg_u32 s63, 0
    s_cbranch_scc1 k2_dloop_88
    v_mfma_f32_16x16x32_bf16 v[12:15], v[60:63], v[192:195], v[12:15]
    v_exp_f32 v232, v160
    v_mfma_f32_16x16x32_bf16 v[48:51], v[60:63], v[196:199], v[48:51]
    s_mov_b32 m0, s34
    ds_read_b128 a[208:211], v3 offset:4096
    v_mfma_f32_16x16x32_bf16 v[248:251], v[60:63], v[200:203], v[248:251]
    s_add_u32 s53, s53, 8192
    buffer_load_dwordx4 v1, s[16:19], s32 offen offset:0 sc1 lds
    v_mfma_f32_16x16x32_bf16 v[252:255], v[60:63], v[204:207], v[252:255]
    s_waitcnt lgkmcnt(3)
    v_exp_f32 v233, v161
    v_mfma_f32_16x16x32_bf16 a[12:15], a[192:195], v[204:207], a[12:15]
    s_sub_u32 s40, s36, s38
    v_exp_f32 v234, v162
    v_mfma_f32_16x16x32_bf16 a[8:11], a[192:195], v[200:203], a[8:11]
    s_and_b32 s53, s53, 0xffff
    ds_read_b128 a[212:215], v3 offset:5120
    v_cvt_pk_bf16_f32 v208, v232, v233
    v_mfma_f32_16x16x32_bf16 a[4:7], a[192:195], v[196:199], a[4:7]
    s_add_u32 s34, s34, 0x4000
    v_subrev_u32 v6, s40, v4
    v_cmp_gt_i32 s[44:45], 0, v6
    v_mfma_f32_16x16x32_bf16 a[0:3], a[192:195], v[192:195], a[0:3]
    v_exp_f32 v235, v163
    v_mfma_f32_16x16x32_bf16 a[16:19], a[196:199], v[192:195], a[16:19]
    buffer_load_dwordx4 v1, s[16:19], s32 offen offset:1024 sc1 lds
    ds_read_b128 a[216:219], v3 offset:6144
    v_mfma_f32_16x16x32_bf16 a[20:23], a[196:199], v[196:199], a[20:23]
    v_exp_f32 v236, v176
    v_mfma_f32_16x16x32_bf16 a[24:27], a[196:199], v[200:203], a[24:27]
    v_cmp_gt_i32 s[46:47], 1, v6
    v_cvt_pk_bf16_f32 v209, v234, v235
    v_mfma_f32_16x16x32_bf16 a[28:31], a[196:199], v[204:207], a[28:31]
    s_waitcnt lgkmcnt(3)
    v_cmp_gt_i32 s[48:49], 2, v6
    v_cmp_gt_i32 s[50:51], 3, v6
    v_mfma_f32_16x16x32_bf16 a[44:47], a[200:203], v[204:207], a[44:47]
    s_and_b32 s34, s34, 0xffff
    v_exp_f32 v237, v177
    v_mfma_f32_16x16x32_bf16 a[40:43], a[200:203], v[200:203], a[40:43]
    s_and_b32 s60, s62, 31
    v_exp_f32 v238, v178
    v_mfma_f32_16x16x32_bf16 a[36:39], a[200:203], v[196:199], a[36:39]
    ds_read_b128 a[220:223], v3 offset:7168
    v_cvt_pk_bf16_f32 v210, v236, v237
    v_mfma_f32_16x16x32_bf16 a[32:35], a[200:203], v[192:195], a[32:35]
    s_lshr_b32 s61, s62, 5
    buffer_load_dwordx4 v1, s[16:19], s32 offen offset:2048 sc1 lds
    v_mfma_f32_16x16x32_bf16 a[48:51], a[204:207], v[192:195], a[48:51]
    v_cndmask_b32 v16, v8, v5, s[44:45]
    v_or3_b32 v57, v208, v209, v210
    v_mfma_f32_16x16x32_bf16 a[52:55], a[204:207], v[196:199], a[52:55]
    v_exp_f32 v239, v179
    v_mfma_f32_16x16x32_bf16 a[56:59], a[204:207], v[200:203], a[56:59]
    s_mul_i32 s57, s60, 229376
    v_cndmask_b32 v17, v8, v5, s[46:47]
    v_add_u32 v3, s53, v56
    v_mfma_f32_16x16x32_bf16 a[60:63], a[204:207], v[204:207], a[60:63]
    s_waitcnt lgkmcnt(2)
    v_exp_f32 v240, v164
    v_mfma_f32_16x16x32_bf16 a[76:79], a[208:211], v[204:207], a[76:79]
    v_cvt_pk_bf16_f32 v211, v238, v239
    v_cndmask_b32 v18, v8, v5, s[48:49]
    v_mfma_f32_16x16x32_bf16 a[72:75], a[208:211], v[200:203], a[72:75]
    s_lshl_b32 s4, s61, 7
    ds_read_b128 a[128:131], v2 offset:0
    v_cndmask_b32 v19, v8, v5, s[50:51]
    v_mfma_f32_16x16x32_bf16 a[68:71], a[208:211], v[196:199], a[68:71]
    v_exp_f32 v241, v165
    v_mfma_f32_16x16x32_bf16 a[64:67], a[208:211], v[192:195], a[64:67]
    s_add_u32 s57, s57, s4
    buffer_load_dwordx4 v1, s[16:19], s32 offen offset:3072 sc1 lds
    s_add_u32 s32, s32, 0x80000
    v_mfma_f32_16x16x32_bf16 a[80:83], a[212:215], v[192:195], a[80:83]
    s_waitcnt vmcnt(8)
    v_cmp_gt_i32 s[44:45], 16, v6
    v_exp_f32 v242, v166
    v_mfma_f32_16x16x32_bf16 a[84:87], a[212:215], v[196:199], a[84:87]
    ds_read_b128 a[132:135], v2 offset:1024
    v_cvt_pk_bf16_f32 v212, v240, v241
    v_mfma_f32_16x16x32_bf16 a[88:91], a[212:215], v[200:203], a[88:91]
    s_add_u32 s56, s57, 57344
    v_cmp_gt_i32 s[46:47], 17, v6
    v_exp_f32 v243, v167
    v_mfma_f32_16x16x32_bf16 a[92:95], a[212:215], v[204:207], a[92:95]
    s_waitcnt lgkmcnt(2)
    v_or3_b32 v57, v57, v211, v212
    v_cmp_gt_i32 s[48:49], 18, v6
    v_mfma_f32_16x16x32_bf16 a[108:111], a[216:219], v[204:207], a[108:111]
    v_exp_f32 v244, v180
    v_mfma_f32_16x16x32_bf16 a[104:107], a[216:219], v[200:203], a[104:107]
    s_add_u32 s62, s62, 1
    v_cvt_pk_bf16_f32 v213, v242, v243
    v_cmp_gt_i32 s[50:51], 19, v6
    v_mfma_f32_16x16x32_bf16 a[100:103], a[216:219], v[196:199], a[100:103]
    buffer_store_dwordx4 a[224:227], v229, s[8:11], s58 offen offset:0 sc1
    ds_read_b128 a[136:139], v2 offset:2048
    v_mfma_f32_16x16x32_bf16 a[96:99], a[216:219], v[192:195], a[96:99]
    v_exp_f32 v245, v181
    v_mfma_f32_16x16x32_bf16 a[112:115], a[220:223], v[192:195], a[112:115]
    v_cndmask_b32 v32, v8, v5, s[44:45]
    v_exp_f32 v246, v182
    v_mfma_f32_16x16x32_bf16 a[116:119], a[220:223], v[196:199], a[116:119]
    ds_read_b128 a[140:143], v2 offset:3072
    v_cndmask_b32 v33, v8, v5, s[46:47]
    v_cvt_pk_bf16_f32 v214, v244, v245
    v_cndmask_b32 v34, v8, v5, s[48:49]
    v_cndmask_b32 v35, v8, v5, s[50:51]
    v_mfma_f32_16x16x32_bf16 a[120:123], a[220:223], v[200:203], a[120:123]
    v_exp_f32 v247, v183
    v_mfma_f32_16x16x32_bf16 a[124:127], a[220:223], v[204:207], a[124:127]
    s_waitcnt lgkmcnt(2)
    v_or3_b32 v57, v57, v213, v214
    v_cvt_pk_bf16_f32 v215, v246, v247
    v_mfma_f32_16x16x32_bf16 v[128:131], a[128:131], v[64:67], v[16:19]
    v_exp_f32 v232, v168
    v_mfma_f32_16x16x32_bf16 v[128:131], a[132:135], v[68:71], v[128:131]
    s_waitcnt lgkmcnt(0)
    buffer_store_dwordx4 a[228:231], v229, s[8:11], s58 offen offset:256 sc1
    ds_read_b128 a[144:147], v2 offset:4096
    v_mfma_f32_16x16x32_bf16 v[128:131], a[136:139], v[72:75], v[128:131]
    v_exp_f32 v233, v169
    v_mfma_f32_16x16x32_bf16 v[128:131], a[140:143], v[76:79], v[128:131]
    s_add_u32 s36, s36, 32
    v_exp_f32 v234, v170
    v_mfma_f32_16x16x32_bf16 v[132:135], a[140:143], v[92:95], v[20:23]
    ds_read_b128 a[148:151], v2 offset:5120
    v_cvt_pk_bf16_f32 v216, v232, v233
    v_mfma_f32_16x16x32_bf16 v[132:135], a[136:139], v[88:91], v[132:135]
    s_lshl_b32 s58, s61, 17
    v_exp_f32 v235, v171
    v_mfma_f32_16x16x32_bf16 v[132:135], a[132:135], v[84:87], v[132:135]
    s_add_u32 s52, s52, 8192
    v_or3_b32 v57, v57, v215, v216
    v_cvt_pk_bf16_f32 v217, v234, v235
    v_mfma_f32_16x16x32_bf16 v[132:135], a[128:131], v[80:83], v[132:135]
    v_exp_f32 v236, v184
    v_mfma_f32_16x16x32_bf16 v[136:139], a[128:131], v[96:99], v[24:27]
    s_lshl_b32 s60, s60, 10
    buffer_load_dwordx4 a[224:227], v228, s[12:15], s57 offen
    ds_read_b128 a[152:155], v2 offset:6144
    v_mfma_f32_16x16x32_bf16 v[136:139], a[132:135], v[100:103], v[136:139]
    s_and_b32 s52, s52, 0xffff
    v_exp_f32 v237, v185
    v_mfma_f32_16x16x32_bf16 v[136:139], a[136:139], v[104:107], v[136:139]
    v_exp_f32 v238, v186
    v_mfma_f32_16x16x32_bf16 v[136:139], a[140:143], v[108:111], v[136:139]
    ds_read_b128 a[156:159], v2 offset:7168
    v_cvt_pk_bf16_f32 v218, v236, v237
    v_mfma_f32_16x16x32_bf16 v[140:143], a[140:143], v[124:127], v[28:31]
    s_add_u32 s58, s58, s60
    v_exp_f32 v239, v187
    v_mfma_f32_16x16x32_bf16 v[140:143], a[136:139], v[120:123], v[140:143]
    v_or3_b32 v57, v57, v217, v218
    v_add_u32 v2, s52, v1
    v_mfma_f32_16x16x32_bf16 v[140:143], a[132:135], v[116:119], v[140:143]
    v_exp_f32 v240, v172
    v_mfma_f32_16x16x32_bf16 v[140:143], a[128:131], v[112:115], v[140:143]
    s_waitcnt lgkmcnt(2)
    ds_read_b128 a[192:195], v3 offset:0
    v_cvt_pk_bf16_f32 v219, v238, v239
    v_mfma_f32_16x16x32_bf16 v[156:159], a[144:147], v[112:115], v[44:47]
    s_mov_b32 s10, s59
    buffer_load_dwordx4 a[228:231], v228, s[12:15], s56 offen
    v_mfma_f32_16x16x32_bf16 v[156:159], a[148:151], v[116:119], v[156:159]
    s_waitcnt lgkmcnt(1)
    v_exp_f32 v241, v173
    v_mfma_f32_16x16x32_bf16 v[156:159], a[152:155], v[120:123], v[156:159]
    v_exp_f32 v242, v174
    v_mfma_f32_16x16x32_bf16 v[156:159], a[156:159], v[124:127], v[156:159]
    v_cvt_pk_bf16_f32 v220, v240, v241
    v_or3_b32 v57, v57, v219, v220
    v_mfma_f32_16x16x32_bf16 v[152:155], a[156:159], v[108:111], v[40:43]
    v_exp_f32 v243, v175
    v_mfma_f32_16x16x32_bf16 v[152:155], a[152:155], v[104:107], v[152:155]
    ds_read_b128 a[196:199], v3 offset:1024
    v_cvt_pk_bf16_f32 v221, v242, v243
    v_mfma_f32_16x16x32_bf16 v[152:155], a[148:151], v[100:103], v[152:155]
    v_exp_f32 v244, v188
    v_mfma_f32_16x16x32_bf16 v[152:155], a[144:147], v[96:99], v[152:155]
    buffer_load_dword v7, v230, s[24:27], s54 offen
    ds_read_b128 a[200:203], v3 offset:2048
    v_mfma_f32_16x16x32_bf16 v[148:151], a[144:147], v[80:83], v[36:39]
    v_exp_f32 v245, v189
    v_mfma_f32_16x16x32_bf16 v[148:151], a[148:151], v[84:87], v[148:151]
    v_exp_f32 v246, v190
    v_mfma_f32_16x16x32_bf16 v[148:151], a[152:155], v[88:91], v[148:151]
    v_cvt_pk_bf16_f32 v222, v244, v245
    v_or3_b32 v57, v57, v221, v222
    v_mfma_f32_16x16x32_bf16 v[148:151], a[156:159], v[92:95], v[148:151]
    v_exp_f32 v247, v191
    v_mfma_f32_16x16x32_bf16 v[144:147], a[156:159], v[76:79], v[32:35]
    s_add_u32 s54, s54, 4096
    ds_read_b128 a[204:207], v3 offset:3072
    v_cvt_pk_bf16_f32 v223, v246, v247
    v_mfma_f32_16x16x32_bf16 v[144:147], a[152:155], v[72:75], v[144:147]
    v_bitop3_b32 v57, v57, v223, s37 bitop3:0xa8
    v_cmp_ne_u32 vcc, 0, v57
    v_mfma_f32_16x16x32_bf16 v[144:147], a[148:151], v[68:71], v[144:147]
    v_mfma_f32_16x16x32_bf16 v[144:147], a[144:147], v[64:67], v[144:147]
    s_cbranch_vccnz k2_tramp_94
k2_ret_95:
    v_mfma_f32_16x16x32_bf16 v[12:15], v[60:63], v[208:211], v[12:15]
    v_exp_f32 v232, v128
    v_mfma_f32_16x16x32_bf16 v[48:51], v[60:63], v[212:215], v[48:51]
    s_mov_b32 m0, s35
    ds_read_b128 a[208:211], v3 offset:4096
    v_mfma_f32_16x16x32_bf16 v[248:251], v[60:63], v[216:219], v[248:251]
    s_add_u32 s53, s53, 8192
    buffer_load_dwordx4 v1, s[20:23], s33 offen offset:0 sc1 lds
    v_mfma_f32_16x16x32_bf16 v[252:255], v[60:63], v[220:223], v[252:255]
    s_waitcnt lgkmcnt(3)
    v_exp_f32 v233, v129
    v_mfma_f32_16x16x32_bf16 a[12:15], a[192:195], v[220:223], a[12:15]
    s_sub_u32 s40, s36, s38
    v_exp_f32 v234, v130
    v_mfma_f32_16x16x32_bf16 a[8:11], a[192:195], v[216:219], a[8:11]
    s_and_b32 s53, s53, 0xffff
    ds_read_b128 a[212:215], v3 offset:5120
    v_cvt_pk_bf16_f32 v192, v232, v233
    v_mfma_f32_16x16x32_bf16 a[4:7], a[192:195], v[212:215], a[4:7]
    v_subrev_u32 v6, s40, v4
    v_cmp_gt_i32 s[44:45], 0, v6
    v_mfma_f32_16x16x32_bf16 a[0:3], a[192:195], v[208:211], a[0:3]
    v_exp_f32 v235, v131
    v_mfma_f32_16x16x32_bf16 a[16:19], a[196:199], v[208:211], a[16:19]
    v_exp_f32 v236, v144
    v_mfma_f32_16x16x32_bf16 a[20:23], a[196:199], v[212:215], a[20:23]
    v_cmp_gt_i32 s[46:47], 1, v6
    v_cvt_pk_bf16_f32 v193, v234, v235
    v_mfma_f32_16x16x32_bf16 a[24:27], a[196:199], v[216:219], a[24:27]
    ds_read_b128 a[216:219], v3 offset:6144
    v_cmp_gt_i32 s[48:49], 2, v6
    v_mfma_f32_16x16x32_bf16 a[28:31], a[196:199], v[220:223], a[28:31]
    s_waitcnt lgkmcnt(3)
    v_exp_f32 v237, v145
    v_mfma_f32_16x16x32_bf16 a[44:47], a[200:203], v[220:223], a[44:47]
    v_cmp_gt_i32 s[50:51], 3, v6
    v_cvt_pk_bf16_f32 v194, v236, v237
    v_mfma_f32_16x16x32_bf16 a[40:43], a[200:203], v[216:219], a[40:43]
    v_exp_f32 v238, v146
    v_mfma_f32_16x16x32_bf16 a[36:39], a[200:203], v[212:215], a[36:39]
    ds_read_b128 a[220:223], v3 offset:7168
    v_cndmask_b32 v16, v8, v5, s[44:45]
    v_mfma_f32_16x16x32_bf16 a[32:35], a[200:203], v[208:211], a[32:35]
    s_add_u32 s35, s35, 0x4000
    v_exp_f32 v239, v147
    v_mfma_f32_16x16x32_bf16 a[48:51], a[204:207], v[208:211], a[48:51]
    v_or3_b32 v57, v192, v193, v194
    v_cndmask_b32 v17, v8, v5, s[46:47]
    v_mfma_f32_16x16x32_bf16 a[52:55], a[204:207], v[212:215], a[52:55]
    v_add_u32 v3, s53, v56
    v_cvt_pk_bf16_f32 v195, v238, v239
    v_mfma_f32_16x16x32_bf16 a[56:59], a[204:207], v[216:219], a[56:59]
    v_exp_f32 v240, v132
    v_mfma_f32_16x16x32_bf16 a[60:63], a[204:207], v[220:223], a[60:63]
    s_waitcnt lgkmcnt(2)
    ds_read_b128 a[128:131], v2 offset:0
    v_cndmask_b32 v18, v8, v5, s[48:49]
    v_mfma_f32_16x16x32_bf16 a[76:79], a[208:211], v[220:223], a[76:79]
    buffer_load_dwordx4 v1, s[20:23], s33 offen offset:1024 sc1 lds
    ds_read_b128 a[132:135], v2 offset:1024
    v_mfma_f32_16x16x32_bf16 a[72:75], a[208:211], v[216:219], a[72:75]
    v_exp_f32 v241, v133
    v_mfma_f32_16x16x32_bf16 a[68:71], a[208:211], v[212:215], a[68:71]
    v_cndmask_b32 v19, v8, v5, s[50:51]
    v_cmp_gt_i32 s[44:45], 16, v6
    v_mfma_f32_16x16x32_bf16 a[64:67], a[208:211], v[208:211], a[64:67]
    v_exp_f32 v242, v134
    v_mfma_f32_16x16x32_bf16 a[80:83], a[212:215], v[208:211], a[80:83]
    v_cvt_pk_bf16_f32 v196, v240, v241
    v_cmp_gt_i32 s[46:47], 17, v6
    v_mfma_f32_16x16x32_bf16 a[84:87], a[212:215], v[212:215], a[84:87]
    v_exp_f32 v243, v135
    v_mfma_f32_16x16x32_bf16 a[88:91], a[212:215], v[216:219], a[88:91]
    v_or3_b32 v57, v57, v195, v196
    v_cmp_gt_i32 s[48:49], 18, v6
    v_mfma_f32_16x16x32_bf16 a[92:95], a[212:215], v[220:223], a[92:95]
    s_waitcnt lgkmcnt(2)
    v_exp_f32 v244, v148
    v_mfma_f32_16x16x32_bf16 a[108:111], a[216:219], v[220:223], a[108:111]
    v_cvt_pk_bf16_f32 v197, v242, v243
    v_cmp_gt_i32 s[50:51], 19, v6
    v_mfma_f32_16x16x32_bf16 a[104:107], a[216:219], v[216:219], a[104:107]
    ds_read_b128 a[136:139], v2 offset:2048
    v_cndmask_b32 v32, v8, v5, s[44:45]
    v_mfma_f32_16x16x32_bf16 a[100:103], a[216:219], v[212:215], a[100:103]
    v_exp_f32 v245, v149
    v_mfma_f32_16x16x32_bf16 a[96:99], a[216:219], v[208:211], a[96:99]
    s_and_b32 s35, s35, 0xffff
    v_exp_f32 v246, v150
    v_mfma_f32_16x16x32_bf16 a[112:115], a[220:223], v[208:211], a[112:115]
    v_cndmask_b32 v33, v8, v5, s[46:47]
    v_cvt_pk_bf16_f32 v198, v244, v245
    v_mfma_f32_16x16x32_bf16 a[116:119], a[220:223], v[212:215], a[116:119]
    ds_read_b128 a[140:143], v2 offset:3072
    v_cndmask_b32 v34, v8, v5, s[48:49]
    v_cndmask_b32 v35, v8, v5, s[50:51]
    v_mfma_f32_16x16x32_bf16 a[120:123], a[220:223], v[216:219], a[120:123]
    v_exp_f32 v247, v151
    v_mfma_f32_16x16x32_bf16 a[124:127], a[220:223], v[220:223], a[124:127]
    s_waitcnt lgkmcnt(2)
    v_or3_b32 v57, v57, v197, v198
    v_cvt_pk_bf16_f32 v199, v246, v247
    v_mfma_f32_16x16x32_bf16 v[160:163], a[128:131], v[64:67], v[16:19]
    v_exp_f32 v232, v136
    v_mfma_f32_16x16x32_bf16 v[160:163], a[132:135], v[68:71], v[160:163]
    s_waitcnt lgkmcnt(0)
    buffer_load_dwordx4 v1, s[20:23], s33 offen offset:2048 sc1 lds
    ds_read_b128 a[144:147], v2 offset:4096
    v_mfma_f32_16x16x32_bf16 v[160:163], a[136:139], v[72:75], v[160:163]
    v_exp_f32 v233, v137
    v_mfma_f32_16x16x32_bf16 v[160:163], a[140:143], v[76:79], v[160:163]
    s_or_b32 s35, s35, 0x10000
    v_exp_f32 v234, v138
    v_mfma_f32_16x16x32_bf16 v[164:167], a[140:143], v[92:95], v[20:23]
    s_add_u32 s36, s36, 32
    ds_read_b128 a[148:151], v2 offset:5120
    v_cvt_pk_bf16_f32 v200, v232, v233
    v_mfma_f32_16x16x32_bf16 v[164:167], a[136:139], v[88:91], v[164:167]
    v_exp_f32 v235, v139
    v_mfma_f32_16x16x32_bf16 v[164:167], a[132:135], v[84:87], v[164:167]
    s_add_u32 s52, s52, 8192
    v_or3_b32 v57, v57, v199, v200
    v_cvt_pk_bf16_f32 v201, v234, v235
    v_mfma_f32_16x16x32_bf16 v[164:167], a[128:131], v[80:83], v[164:167]
    v_exp_f32 v236, v152
    v_mfma_f32_16x16x32_bf16 v[168:171], a[128:131], v[96:99], v[24:27]
    s_and_b32 s52, s52, 0xffff
    ds_read_b128 a[152:155], v2 offset:6144
    ds_read_b128 a[156:159], v2 offset:7168
    v_mfma_f32_16x16x32_bf16 v[168:171], a[132:135], v[100:103], v[168:171]
    v_exp_f32 v237, v153
    v_mfma_f32_16x16x32_bf16 v[168:171], a[136:139], v[104:107], v[168:171]
    v_exp_f32 v238, v154
    v_mfma_f32_16x16x32_bf16 v[168:171], a[140:143], v[108:111], v[168:171]
    v_cvt_pk_bf16_f32 v202, v236, v237
    v_or3_b32 v57, v57, v201, v202
    v_mfma_f32_16x16x32_bf16 v[172:175], a[140:143], v[124:127], v[28:31]
    v_exp_f32 v239, v155
    v_mfma_f32_16x16x32_bf16 v[172:175], a[136:139], v[120:123], v[172:175]
    v_add_u32 v2, s52, v1
    v_cvt_pk_bf16_f32 v203, v238, v239
    v_mfma_f32_16x16x32_bf16 v[172:175], a[132:135], v[116:119], v[172:175]
    v_exp_f32 v240, v140
    v_mfma_f32_16x16x32_bf16 v[172:175], a[128:131], v[112:115], v[172:175]
    s_waitcnt lgkmcnt(2)
    buffer_load_dwordx4 v1, s[20:23], s33 offen offset:3072 sc1 lds
    s_add_u32 s33, s33, 0x80000
    v_mfma_f32_16x16x32_bf16 v[188:191], a[144:147], v[112:115], v[44:47]
    v_exp_f32 v241, v141
    v_mfma_f32_16x16x32_bf16 v[188:191], a[148:151], v[116:119], v[188:191]
    s_waitcnt lgkmcnt(0)
    ds_read_b128 a[192:195], v3 offset:0
    v_cvt_pk_bf16_f32 v204, v240, v241
    v_mfma_f32_16x16x32_bf16 v[188:191], a[152:155], v[120:123], v[188:191]
    v_exp_f32 v242, v142
    v_mfma_f32_16x16x32_bf16 v[188:191], a[156:159], v[124:127], v[188:191]
    v_exp_f32 v243, v143
    v_mfma_f32_16x16x32_bf16 v[184:187], a[156:159], v[108:111], v[40:43]
    ds_read_b128 a[196:199], v3 offset:1024
    v_or3_b32 v57, v57, v203, v204
    v_mfma_f32_16x16x32_bf16 v[184:187], a[152:155], v[104:107], v[184:187]
    v_exp_f32 v244, v156
    v_mfma_f32_16x16x32_bf16 v[184:187], a[148:151], v[100:103], v[184:187]
    ds_read_b128 a[200:203], v3 offset:2048
    v_cvt_pk_bf16_f32 v205, v242, v243
    v_mfma_f32_16x16x32_bf16 v[184:187], a[144:147], v[96:99], v[184:187]
    v_exp_f32 v245, v157
    v_mfma_f32_16x16x32_bf16 v[180:183], a[144:147], v[80:83], v[36:39]
    v_exp_f32 v246, v158
    v_mfma_f32_16x16x32_bf16 v[180:183], a[148:151], v[84:87], v[180:183]
    v_cvt_pk_bf16_f32 v206, v244, v245
    v_or3_b32 v57, v57, v205, v206
    v_mfma_f32_16x16x32_bf16 v[180:183], a[152:155], v[88:91], v[180:183]
    v_exp_f32 v247, v159
    v_mfma_f32_16x16x32_bf16 v[180:183], a[156:159], v[92:95], v[180:183]
    ds_read_b128 a[204:207], v3 offset:3072
    v_cvt_pk_bf16_f32 v207, v246, v247
    v_mfma_f32_16x16x32_bf16 v[176:179], a[156:159], v[76:79], v[32:35]
    v_mfma_f32_16x16x32_bf16 v[176:179], a[152:155], v[72:75], v[176:179]
    v_bitop3_b32 v57, v57, v207, s37 bitop3:0xa8
    v_cmp_ne_u32 vcc, 0, v57
    v_mfma_f32_16x16x32_bf16 v[176:179], a[148:151], v[68:71], v[176:179]
    v_mfma_f32_16x16x32_bf16 v[176:179], a[144:147], v[64:67], v[176:179]
    s_waitcnt vmcnt(13)
    s_barrier
    s_cbranch_vccnz k2_tramp_96
k2_ret_97:
k2_dm3_89:
    v_mfma_f32_16x16x32_bf16 v[12:15], v[60:63], v[192:195], v[12:15]
    v_exp_f32 v232, v160
    v_mfma_f32_16x16x32_bf16 v[48:51], v[60:63], v[196:199], v[48:51]
    s_mov_b32 m0, s34
    ds_read_b128 a[208:211], v3 offset:4096
    v_mfma_f32_16x16x32_bf16 v[248:251], v[60:63], v[200:203], v[248:251]
    s_add_u32 s53, s53, 8192
    v_exp_f32 v233, v161
    v_mfma_f32_16x16x32_bf16 v[252:255], v[60:63], v[204:207], v[252:255]
    s_waitcnt lgkmcnt(3)
    buffer_load_dwordx4 v1, s[16:19], s32 offen offset:0 sc1 lds
    v_mfma_f32_16x16x32_bf16 a[12:15], a[192:195], v[204:207], a[12:15]
    s_sub_u32 s40, s36, s38
    s_sub_u32 s40, s40, 64
    v_exp_f32 v234, v162
    v_cvt_pk_bf16_f32 v208, v232, v233
    v_mfma_f32_16x16x32_bf16 a[8:11], a[192:195], v[200:203], a[8:11]
    s_and_b32 s53, s53, 0xffff
    ds_read_b128 a[212:215], v3 offset:5120
    v_subrev_u32 v6, s40, v4
    v_mfma_f32_16x16x32_bf16 a[4:7], a[192:195], v[196:199], a[4:7]
    s_add_u32 s34, s34, 0x4000
    v_exp_f32 v235, v163
    v_cmp_gt_i32 s[44:45], 0, v6
    v_mfma_f32_16x16x32_bf16 a[0:3], a[192:195], v[192:195], a[0:3]
    v_exp_f32 v236, v176
    v_cvt_pk_bf16_f32 v209, v234, v235
    v_mfma_f32_16x16x32_bf16 a[16:19], a[196:199], v[192:195], a[16:19]
    buffer_load_dwordx4 v1, s[16:19], s32 offen offset:1024 sc1 lds
    ds_read_b128 a[216:219], v3 offset:6144
    v_mfma_f32_16x16x32_bf16 a[20:23], a[196:199], v[196:199], a[20:23]
    v_cmp_gt_i32 s[46:47], 1, v6
    v_exp_f32 v237, v177
    v_mfma_f32_16x16x32_bf16 a[24:27], a[196:199], v[200:203], a[24:27]
    v_cmp_gt_i32 s[48:49], 2, v6
    v_exp_f32 v238, v178
    v_mfma_f32_16x16x32_bf16 a[28:31], a[196:199], v[204:207], a[28:31]
    s_waitcnt lgkmcnt(3)
    v_cvt_pk_bf16_f32 v210, v236, v237
    v_cmp_gt_i32 s[50:51], 3, v6
    v_mfma_f32_16x16x32_bf16 a[44:47], a[200:203], v[204:207], a[44:47]
    s_and_b32 s34, s34, 0xffff
    v_exp_f32 v239, v179
    v_mfma_f32_16x16x32_bf16 a[40:43], a[200:203], v[200:203], a[40:43]
    s_and_b32 s60, s62, 31
    ds_read_b128 a[220:223], v3 offset:7168
    v_or3_b32 v57, v208, v209, v210
    v_cndmask_b32 v20, v9, v5, s[44:45]
    v_mfma_f32_16x16x32_bf16 a[36:39], a[200:203], v[196:199], a[36:39]
    buffer_load_dwordx4 v1, s[16:19], s32 offen offset:2048 sc1 lds
    v_mfma_f32_16x16x32_bf16 a[32:35], a[200:203], v[192:195], a[32:35]
    s_lshr_b32 s61, s62, 5
    v_exp_f32 v240, v164
    v_cvt_pk_bf16_f32 v211, v238, v239
    v_mfma_f32_16x16x32_bf16 a[48:51], a[204:207], v[192:195], a[48:51]
    v_cndmask_b32 v21, v9, v5, s[46:47]
    v_add_u32 v3, s53, v56
    v_mfma_f32_16x16x32_bf16 a[52:55], a[204:207], v[196:199], a[52:55]
    s_mul_i32 s57, s60, 229376
    v_exp_f32 v241, v165
    v_mfma_f32_16x16x32_bf16 a[56:59], a[204:207], v[200:203], a[56:59]
    ds_read_b128 a[128:131], v2 offset:0
    v_cndmask_b32 v22, v9, v5, s[48:49]
    v_cvt_pk_bf16_f32 v212, v240, v241
    v_mfma_f32_16x16x32_bf16 a[60:63], a[204:207], v[204:207], a[60:63]
    s_waitcnt lgkmcnt(3)
    v_exp_f32 v242, v166
    v_mfma_f32_16x16x32_bf16 a[76:79], a[208:211], v[204:207], a[76:79]
    s_lshl_b32 s4, s61, 7
    v_cndmask_b32 v23, v9, v5, s[50:51]
    v_or3_b32 v57, v57, v211, v212
    v_mfma_f32_16x16x32_bf16 a[72:75], a[208:211], v[200:203], a[72:75]
    buffer_load_dwordx4 v1, s[16:19], s32 offen offset:3072 sc1 lds
    ds_read_b128 a[132:135], v2 offset:1024
    s_add_u32 s32, s32, 0x80000
    v_mfma_f32_16x16x32_bf16 a[68:71], a[208:211], v[196:199], a[68:71]
    v_exp_f32 v243, v167
    v_mfma_f32_16x16x32_bf16 a[64:67], a[208:211], v[192:195], a[64:67]
    s_add_u32 s57, s57, s4
    v_cmp_gt_i32 s[44:45], 16, v6
    v_cvt_pk_bf16_f32 v213, v242, v243
    v_mfma_f32_16x16x32_bf16 a[80:83], a[212:215], v[192:195], a[80:83]
    s_waitcnt vmcnt(8)
    v_exp_f32 v244, v180
    v_mfma_f32_16x16x32_bf16 a[84:87], a[212:215], v[196:199], a[84:87]
    s_add_u32 s56, s57, 57344
    ds_read_b128 a[136:139], v2 offset:2048
    v_cmp_gt_i32 s[46:47], 17, v6
    v_mfma_f32_16x16x32_bf16 a[88:91], a[212:215], v[200:203], a[88:91]
    v_exp_f32 v245, v181
    v_cmp_gt_i32 s[48:49], 18, v6
    v_mfma_f32_16x16x32_bf16 a[92:95], a[212:215], v[204:207], a[92:95]
    s_waitcnt lgkmcnt(3)
    v_exp_f32 v246, v182
    v_mfma_f32_16x16x32_bf16 a[108:111], a[216:219], v[204:207], a[108:111]
    s_add_u32 s62, s62, 1
    v_cmp_gt_i32 s[50:51], 19, v6
    v_cvt_pk_bf16_f32 v214, v244, v245
    v_mfma_f32_16x16x32_bf16 a[104:107], a[216:219], v[200:203], a[104:107]
    buffer_store_dwordx4 a[224:227], v229, s[8:11], s58 offen offset:0 sc1
    ds_read_b128 a[140:143], v2 offset:3072
    ds_read_b128 a[144:147], v2 offset:4096
    v_mfma_f32_16x16x32_bf16 a[100:103], a[216:219], v[196:199], a[100:103]
    v_exp_f32 v247, v183
    v_mfma_f32_16x16x32_bf16 a[96:99], a[216:219], v[192:195], a[96:99]
    v_cndmask_b32 v36, v9, v5, s[44:45]
    v_or3_b32 v57, v57, v213, v214
    v_mfma_f32_16x16x32_bf16 a[112:115], a[220:223], v[192:195], a[112:115]
    v_exp_f32 v232, v168
    v_mfma_f32_16x16x32_bf16 a[116:119], a[220:223], v[196:199], a[116:119]
    v_cndmask_b32 v37, v9, v5, s[46:47]
    v_cvt_pk_bf16_f32 v215, v246, v247
    v_cndmask_b32 v38, v9, v5, s[48:49]
    v_cndmask_b32 v39, v9, v5, s[50:51]
    v_mfma_f32_16x16x32_bf16 a[120:123], a[220:223], v[200:203], a[120:123]
    v_exp_f32 v233, v169
    v_mfma_f32_16x16x32_bf16 a[124:127], a[220:223], v[204:207], a[124:127]
    s_waitcnt lgkmcnt(3)
    buffer_store_dwordx4 a[228:231], v229, s[8:11], s58 offen offset:256 sc1
    v_exp_f32 v234, v170
    v_mfma_f32_16x16x32_bf16 v[132:135], a[128:131], v[80:83], v[20:23]
    ds_read_b128 a[148:151], v2 offset:5120
    v_cvt_pk_bf16_f32 v216, v232, v233
    v_mfma_f32_16x16x32_bf16 v[132:135], a[132:135], v[84:87], v[132:135]
    s_waitcnt lgkmcnt(2)
    v_exp_f32 v235, v171
    v_mfma_f32_16x16x32_bf16 v[132:135], a[136:139], v[88:91], v[132:135]
    s_lshl_b32 s58, s61, 17
    ds_read_b128 a[152:155], v2 offset:6144
    v_or3_b32 v57, v57, v215, v216
    v_mfma_f32_16x16x32_bf16 v[132:135], a[140:143], v[92:95], v[132:135]
    s_add_u32 s36, s36, 32
    v_exp_f32 v236, v184
    v_mfma_f32_16x16x32_bf16 v[136:139], a[140:143], v[108:111], v[24:27]
    s_lshl_b32 s60, s60, 10
    v_cvt_pk_bf16_f32 v217, v234, v235
    v_exp_f32 v237, v185
    v_mfma_f32_16x16x32_bf16 v[136:139], a[136:139], v[104:107], v[136:139]
    buffer_load_dwordx4 a[224:227], v228, s[12:15], s57 offen
    ds_read_b128 a[156:159], v2 offset:7168
    v_mfma_f32_16x16x32_bf16 v[136:139], a[132:135], v[100:103], v[136:139]
    s_add_u32 s52, s52, 8192
    v_exp_f32 v238, v186
    v_mfma_f32_16x16x32_bf16 v[136:139], a[128:131], v[96:99], v[136:139]
    s_add_u32 s58, s58, s60
    v_cvt_pk_bf16_f32 v218, v236, v237
    v_or3_b32 v57, v57, v217, v218
    v_mfma_f32_16x16x32_bf16 v[140:143], a[128:131], v[112:115], v[28:31]
    s_and_b32 s52, s52, 0xffff
    v_exp_f32 v239, v187
    v_mfma_f32_16x16x32_bf16 v[140:143], a[132:135], v[116:119], v[140:143]
    v_add_u32 v2, s52, v1
    v_cvt_pk_bf16_f32 v219, v238, v239
    v_mfma_f32_16x16x32_bf16 v[140:143], a[136:139], v[120:123], v[140:143]
    s_mov_b32 s10, s59
    v_exp_f32 v240, v172
    v_mfma_f32_16x16x32_bf16 v[140:143], a[140:143], v[124:127], v[140:143]
    s_waitcnt lgkmcnt(2)
    ds_read_b128 a[192:195], v3 offset:0
    s_waitcnt lgkmcnt(1)
    v_mfma_f32_16x16x32_bf16 v[156:159], a[156:159], v[124:127], v[44:47]
    v_exp_f32 v241, v173
    v_mfma_f32_16x16x32_bf16 v[156:159], a[152:155], v[120:123], v[156:159]
    buffer_load_dwordx4 a[228:231], v228, s[12:15], s56 offen
    v_exp_f32 v242, v174
    v_mfma_f32_16x16x32_bf16 v[156:159], a[148:151], v[116:119], v[156:159]
    ds_read_b128 a[196:199], v3 offset:1024
    v_cvt_pk_bf16_f32 v220, v240, v241
    v_mfma_f32_16x16x32_bf16 v[156:159], a[144:147], v[112:115], v[156:159]
    v_exp_f32 v243, v175
    v_mfma_f32_16x16x32_bf16 v[152:155], a[144:147], v[96:99], v[40:43]
    v_or3_b32 v57, v57, v219, v220
    v_cvt_pk_bf16_f32 v221, v242, v243
    v_mfma_f32_16x16x32_bf16 v[152:155], a[148:151], v[100:103], v[152:155]
    ds_read_b128 a[200:203], v3 offset:2048
    v_exp_f32 v244, v188
    v_mfma_f32_16x16x32_bf16 v[152:155], a[152:155], v[104:107], v[152:155]
    buffer_load_dword v7, v230, s[24:27], s54 offen
    v_exp_f32 v245, v189
    v_mfma_f32_16x16x32_bf16 v[152:155], a[156:159], v[108:111], v[152:155]
    v_exp_f32 v246, v190
    v_mfma_f32_16x16x32_bf16 v[148:151], a[156:159], v[92:95], v[36:39]
    s_add_u32 s54, s54, 4096
    v_cvt_pk_bf16_f32 v222, v244, v245
    v_or3_b32 v57, v57, v221, v222
    v_mfma_f32_16x16x32_bf16 v[148:151], a[152:155], v[88:91], v[148:151]
    v_exp_f32 v247, v191
    v_mfma_f32_16x16x32_bf16 v[148:151], a[148:151], v[84:87], v[148:151]
    ds_read_b128 a[204:207], v3 offset:3072
    v_cvt_pk_bf16_f32 v223, v246, v247
    v_mfma_f32_16x16x32_bf16 v[148:151], a[144:147], v[80:83], v[148:151]
    v_bitop3_b32 v57, v57, v223, s37 bitop3:0xa8
    v_cmp_ne_u32 vcc, 0, v57
    s_cbranch_vccnz k2_tramp_98
k2_ret_99:
    v_mfma_f32_16x16x32_bf16 v[12:15], v[60:63], v[208:211], v[12:15]
    v_exp_f32 v232, v132
    v_mfma_f32_16x16x32_bf16 v[48:51], v[60:63], v[212:215], v[48:51]
    s_mov_b32 m0, s35
    ds_read_b128 a[208:211], v3 offset:4096
    v_mfma_f32_16x16x32_bf16 v[248:251], v[60:63], v[216:219], v[248:251]
    s_add_u32 s53, s53, 8192
    buffer_load_dwordx4 v1, s[20:23], s33 offen offset:0 sc1 lds
    v_mfma_f32_16x16x32_bf16 v[252:255], v[60:63], v[220:223], v[252:255]
    s_waitcnt lgkmcnt(3)
    v_exp_f32 v233, v133
    v_mfma_f32_16x16x32_bf16 a[12:15], a[192:195], v[220:223], a[12:15]
    s_sub_u32 s40, s36, s38
    s_sub_u32 s40, s40, 64
    v_exp_f32 v234, v134
    v_mfma_f32_16x16x32_bf16 a[8:11], a[192:195], v[216:219], a[8:11]
    s_and_b32 s53, s53, 0xffff
    ds_read_b128 a[212:215], v3 offset:5120
    v_subrev_u32 v6, s40, v4
    v_mfma_f32_16x16x32_bf16 a[4:7], a[192:195], v[212:215], a[4:7]
    v_cvt_pk_bf16_f32 v196, v232, v233
    v_cmp_gt_i32 s[44:45], 0, v6
    v_mfma_f32_16x16x32_bf16 a[0:3], a[192:195], v[208:211], a[0:3]
    v_exp_f32 v235, v135
    v_mfma_f32_16x16x32_bf16 a[16:19], a[196:199], v[208:211], a[16:19]
    ds_read_b128 a[216:219], v3 offset:6144
    v_cmp_gt_i32 s[46:47], 1, v6
    v_mfma_f32_16x16x32_bf16 a[20:23], a[196:199], v[212:215], a[20:23]
    v_exp_f32 v236, v148
    v_mfma_f32_16x16x32_bf16 a[24:27], a[196:199], v[216:219], a[24:27]
    v_cvt_pk_bf16_f32 v197, v234, v235
    v_cmp_gt_i32 s[48:49], 2, v6
    v_mfma_f32_16x16x32_bf16 a[28:31], a[196:199], v[220:223], a[28:31]
    s_waitcnt lgkmcnt(3)
    v_cmp_gt_i32 s[50:51], 3, v6
    v_mfma_f32_16x16x32_bf16 a[44:47], a[200:203], v[220:223], a[44:47]
    v_exp_f32 v237, v149
    v_mfma_f32_16x16x32_bf16 a[40:43], a[200:203], v[216:219], a[40:43]
    s_add_u32 s35, s35, 0x4000
    ds_read_b128 a[220:223], v3 offset:7168
    v_cndmask_b32 v20, v9, v5, s[44:45]
    v_mfma_f32_16x16x32_bf16 a[36:39], a[200:203], v[212:215], a[36:39]
    v_exp_f32 v238, v150
    v_mfma_f32_16x16x32_bf16 a[32:35], a[200:203], v[208:211], a[32:35]
    v_cvt_pk_bf16_f32 v198, v236, v237
    v_cndmask_b32 v21, v9, v5, s[46:47]
    v_mfma_f32_16x16x32_bf16 a[48:51], a[204:207], v[208:211], a[48:51]
    buffer_load_dwordx4 v1, s[20:23], s33 offen offset:1024 sc1 lds
    ds_read_b128 a[128:131], v2 offset:0
    v_mfma_f32_16x16x32_bf16 a[52:55], a[204:207], v[212:215], a[52:55]
    v_add_u32 v3, s53, v56
    v_cndmask_b32 v22, v9, v5, s[48:49]
    v_mfma_f32_16x16x32_bf16 a[56:59], a[204:207], v[216:219], a[56:59]
    v_exp_f32 v239, v151
    v_mfma_f32_16x16x32_bf16 a[60:63], a[204:207], v[220:223], a[60:63]
    s_waitcnt lgkmcnt(3)
    v_or3_b32 v57, v196, v197, v198
    v_cndmask_b32 v23, v9, v5, s[50:51]
    v_mfma_f32_16x16x32_bf16 a[76:79], a[208:211], v[220:223], a[76:79]
    v_exp_f32 v240, v136
    v_mfma_f32_16x16x32_bf16 a[72:75], a[208:211], v[216:219], a[72:75]
    v_cvt_pk_bf16_f32 v199, v238, v239
    v_cmp_gt_i32 s[44:45], 16, v6
    v_mfma_f32_16x16x32_bf16 a[68:71], a[208:211], v[212:215], a[68:71]
    ds_read_b128 a[132:135], v2 offset:1024
    v_cmp_gt_i32 s[46:47], 17, v6
    v_mfma_f32_16x16x32_bf16 a[64:67], a[208:211], v[208:211], a[64:67]
    v_exp_f32 v241, v137
    v_mfma_f32_16x16x32_bf16 a[80:83], a[212:215], v[208:211], a[80:83]
    ds_read_b128 a[136:139], v2 offset:2048
    v_cmp_gt_i32 s[48:49], 18, v6
    v_mfma_f32_16x16x32_bf16 a[84:87], a[212:215], v[212:215], a[84:87]
    v_exp_f32 v242, v138
    v_mfma_f32_16x16x32_bf16 a[88:91], a[212:215], v[216:219], a[88:91]
    v_cvt_pk_bf16_f32 v200, v240, v241
    v_cmp_gt_i32 s[50:51], 19, v6
    v_mfma_f32_16x16x32_bf16 a[92:95], a[212:215], v[220:223], a[92:95]
    s_waitcnt lgkmcnt(3)
    v_exp_f32 v243, v139
    v_mfma_f32_16x16x32_bf16 a[108:111], a[216:219], v[220:223], a[108:111]
    s_and_b32 s35, s35, 0xffff
    ds_read_b128 a[140:143], v2 offset:3072
    v_or3_b32 v57, v57, v199, v200
    v_mfma_f32_16x16x32_bf16 a[104:107], a[216:219], v[216:219], a[104:107]
    v_cndmask_b32 v36, v9, v5, s[44:45]
    v_cndmask_b32 v37, v9, v5, s[46:47]
    v_mfma_f32_16x16x32_bf16 a[100:103], a[216:219], v[212:215], a[100:103]
    v_exp_f32 v244, v152
    v_mfma_f32_16x16x32_bf16 a[96:99], a[216:219], v[208:211], a[96:99]
    ds_read_b128 a[144:147], v2 offset:4096
    v_cvt_pk_bf16_f32 v201, v242, v243
    v_mfma_f32_16x16x32_bf16 a[112:115], a[220:223], v[208:211], a[112:115]
    buffer_load_dwordx4 v1, s[20:23], s33 offen offset:2048 sc1 lds
    ds_read_b128 a[148:151], v2 offset:5120
    v_mfma_f32_16x16x32_bf16 a[116:119], a[220:223], v[212:215], a[116:119]
    v_cndmask_b32 v38, v9, v5, s[48:49]
    v_cndmask_b32 v39, v9, v5, s[50:51]
    v_mfma_f32_16x16x32_bf16 a[120:123], a[220:223], v[216:219], a[120:123]
    s_or_b32 s35, s35, 0x10000
    v_exp_f32 v245, v153
    v_mfma_f32_16x16x32_bf16 a[124:127], a[220:223], v[220:223], a[124:127]
    s_waitcnt lgkmcnt(4)
    v_exp_f32 v246, v154
    v_mfma_f32_16x16x32_bf16 v[164:167], a[128:131], v[80:83], v[20:23]
    ds_read_b128 a[152:155], v2 offset:6144
    v_cvt_pk_bf16_f32 v202, v244, v245
    v_mfma_f32_16x16x32_bf16 v[164:167], a[132:135], v[84:87], v[164:167]
    s_waitcnt lgkmcnt(3)
    v_exp_f32 v247, v155
    v_mfma_f32_16x16x32_bf16 v[164:167], a[136:139], v[88:91], v[164:167]
    v_or3_b32 v57, v57, v201, v202
    v_cvt_pk_bf16_f32 v203, v246, v247
    v_mfma_f32_16x16x32_bf16 v[164:167], a[140:143], v[92:95], v[164:167]
    s_add_u32 s36, s36, 32
    v_exp_f32 v232, v140
    v_mfma_f32_16x16x32_bf16 v[168:171], a[140:143], v[108:111], v[24:27]
    ds_read_b128 a[156:159], v2 offset:7168
    v_mfma_f32_16x16x32_bf16 v[168:171], a[136:139], v[104:107], v[168:171]
    v_exp_f32 v233, v141
    v_mfma_f32_16x16x32_bf16 v[168:171], a[132:135], v[100:103], v[168:171]
    s_add_u32 s52, s52, 8192
    v_exp_f32 v234, v142
    v_mfma_f32_16x16x32_bf16 v[168:171], a[128:131], v[96:99], v[168:171]
    ds_read_b128 a[192:195], v3 offset:0
    v_cvt_pk_bf16_f32 v204, v232, v233
    v_mfma_f32_16x16x32_bf16 v[172:175], a[128:131], v[112:115], v[28:31]
    s_and_b32 s52, s52, 0xffff
    v_add_u32 v2, s52, v1
    v_or3_b32 v57, v57, v203, v204
    v_mfma_f32_16x16x32_bf16 v[172:175], a[132:135], v[116:119], v[172:175]
    buffer_load_dwordx4 v1, s[20:23], s33 offen offset:3072 sc1 lds
    s_add_u32 s33, s33, 0x80000
    v_mfma_f32_16x16x32_bf16 v[172:175], a[136:139], v[120:123], v[172:175]
    v_exp_f32 v235, v143
    v_mfma_f32_16x16x32_bf16 v[172:175], a[140:143], v[124:127], v[172:175]
    s_waitcnt lgkmcnt(3)
    ds_read_b128 a[196:199], v3 offset:1024
    s_waitcnt lgkmcnt(2)
    v_mfma_f32_16x16x32_bf16 v[188:191], a[156:159], v[124:127], v[44:47]
    v_exp_f32 v236, v156
    v_mfma_f32_16x16x32_bf16 v[188:191], a[152:155], v[120:123], v[188:191]
    v_cvt_pk_bf16_f32 v205, v234, v235
    v_mfma_f32_16x16x32_bf16 v[188:191], a[148:151], v[116:119], v[188:191]
    v_exp_f32 v237, v157
    v_mfma_f32_16x16x32_bf16 v[188:191], a[144:147], v[112:115], v[188:191]
    ds_read_b128 a[200:203], v3 offset:2048
    v_cvt_pk_bf16_f32 v206, v236, v237
    v_mfma_f32_16x16x32_bf16 v[184:187], a[144:147], v[96:99], v[40:43]
    v_exp_f32 v238, v158
    v_mfma_f32_16x16x32_bf16 v[184:187], a[148:151], v[100:103], v[184:187]
    v_exp_f32 v239, v159
    v_mfma_f32_16x16x32_bf16 v[184:187], a[152:155], v[104:107], v[184:187]
    ds_read_b128 a[204:207], v3 offset:3072
    v_or3_b32 v57, v57, v205, v206
    v_mfma_f32_16x16x32_bf16 v[184:187], a[156:159], v[108:111], v[184:187]
    v_cvt_pk_bf16_f32 v207, v238, v239
    v_mfma_f32_16x16x32_bf16 v[180:183], a[156:159], v[92:95], v[36:39]
    v_mfma_f32_16x16x32_bf16 v[180:183], a[152:155], v[88:91], v[180:183]
    v_bitop3_b32 v57, v57, v207, s37 bitop3:0xa8
    v_cmp_ne_u32 vcc, 0, v57
    v_mfma_f32_16x16x32_bf16 v[180:183], a[148:151], v[84:87], v[180:183]
    v_mfma_f32_16x16x32_bf16 v[180:183], a[144:147], v[80:83], v[180:183]
    s_waitcnt vmcnt(13)
    s_barrier
    s_cbranch_vccnz k2_tramp_100
k2_ret_101:
    v_mfma_f32_16x16x32_bf16 v[48:51], v[60:63], v[196:199], v[48:51]
    ds_read_b128 a[208:211], v3 offset:4096
    ds_read_b128 a[212:215], v3 offset:5120
    v_mfma_f32_16x16x32_bf16 v[248:251], v[60:63], v[200:203], v[248:251]
    s_mov_b32 m0, s34
    v_exp_f32 v232, v164
    v_mfma_f32_16x16x32_bf16 v[252:255], v[60:63], v[204:207], v[252:255]
    s_waitcnt lgkmcnt(4)
    buffer_load_dwordx4 v1, s[16:19], s32 offen offset:0 sc1 lds
    ds_read_b128 a[216:219], v3 offset:6144
    v_mfma_f32_16x16x32_bf16 a[12:15], a[192:195], v[204:207], a[12:15]
    s_add_u32 s53, s53, 8192
    v_exp_f32 v233, v165
    v_mfma_f32_16x16x32_bf16 a[8:11], a[192:195], v[200:203], a[8:11]
    s_and_b32 s53, s53, 0xffff
    v_mov_b32 v16, v10
    v_mov_b32 v17, v10
    v_mfma_f32_16x16x32_bf16 a[4:7], a[192:195], v[196:199], a[4:7]
    s_add_u32 s34, s34, 0x4000
    v_exp_f32 v234, v166
    v_mfma_f32_16x16x32_bf16 a[20:23], a[196:199], v[196:199], a[20:23]
    ds_read_b128 a[220:223], v3 offset:7168
    v_cvt_pk_bf16_f32 v212, v232, v233
    v_mfma_f32_16x16x32_bf16 a[24:27], a[196:199], v[200:203], a[24:27]
    v_mov_b32 v18, v10
    v_mov_b32 v19, v10
    v_mfma_f32_16x16x32_bf16 a[28:31], a[196:199], v[204:207], a[28:31]
    s_waitcnt lgkmcnt(4)
    v_exp_f32 v235, v167
    v_mfma_f32_16x16x32_bf16 a[44:47], a[200:203], v[204:207], a[44:47]
    buffer_load_dwordx4 v1, s[16:19], s32 offen offset:1024 sc1 lds
    ds_read_b128 a[128:131], v2 offset:0
    v_mfma_f32_16x16x32_bf16 a[40:43], a[200:203], v[200:203], a[40:43]
    v_mov_b32 v20, v11
    v_add_u32 v3, s53, v56
    v_mfma_f32_16x16x32_bf16 a[36:39], a[200:203], v[196:199], a[36:39]
    s_and_b32 s34, s34, 0xffff
    v_mov_b32 v21, v11
    v_mov_b32 v22, v11
    v_mfma_f32_16x16x32_bf16 a[52:55], a[204:207], v[196:199], a[52:55]
    v_exp_f32 v236, v180
    v_mfma_f32_16x16x32_bf16 a[56:59], a[204:207], v[200:203], a[56:59]
    ds_read_b128 a[132:135], v2 offset:1024
    v_cvt_pk_bf16_f32 v213, v234, v235
    v_mfma_f32_16x16x32_bf16 a[60:63], a[204:207], v[204:207], a[60:63]
    s_waitcnt lgkmcnt(4)
    v_mov_b32 v23, v11
    v_mov_b32 v32, v10
    v_mfma_f32_16x16x32_bf16 a[76:79], a[208:211], v[204:207], a[76:79]
    v_exp_f32 v237, v181
    v_mfma_f32_16x16x32_bf16 a[72:75], a[208:211], v[200:203], a[72:75]
    ds_read_b128 a[136:139], v2 offset:2048
    v_mov_b32 v33, v10
    v_mfma_f32_16x16x32_bf16 a[68:71], a[208:211], v[196:199], a[68:71]
    buffer_load_dwordx4 v1, s[16:19], s32 offen offset:2048 sc1 lds
    v_mov_b32 v34, v10
    v_mfma_f32_16x16x32_bf16 a[84:87], a[212:215], v[196:199], a[84:87]
    v_exp_f32 v238, v182
    v_mfma_f32_16x16x32_bf16 a[88:91], a[212:215], v[200:203], a[88:91]
    ds_read_b128 a[140:143], v2 offset:3072
    v_cvt_pk_bf16_f32 v214, v236, v237
    v_mfma_f32_16x16x32_bf16 a[92:95], a[212:215], v[204:207], a[92:95]
    s_waitcnt lgkmcnt(4)
    v_mov_b32 v35, v10
    v_mov_b32 v36, v11
    v_mfma_f32_16x16x32_bf16 a[108:111], a[216:219], v[204:207], a[108:111]
    ds_read_b128 a[144:147], v2 offset:4096
    v_exp_f32 v239, v183
    v_mfma_f32_16x16x32_bf16 a[104:107], a[216:219], v[200:203], a[104:107]
    v_mov_b32 v37, v11
    v_or3_b32 v57, v212, v213, v214
    v_mov_b32 v38, v11
    v_mov_b32 v39, v11
    v_mfma_f32_16x16x32_bf16 a[100:103], a[216:219], v[196:199], a[100:103]
    buffer_load_dwordx4 v1, s[16:19], s32 offen offset:3072 sc1 lds
    ds_read_b128 a[148:151], v2 offset:5120
    v_mfma_f32_16x16x32_bf16 a[116:119], a[220:223], v[196:199], a[116:119]
    s_add_u32 s32, s32, 0x80000
    s_cmp_ge_u32 s36, s43
    s_cbranch_scc1 k2_prep_102
k2_prepret_103:
    v_mfma_f32_16x16x32_bf16 a[120:123], a[220:223], v[200:203], a[120:123]
    s_waitcnt vmcnt(8)
    v_exp_f32 v240, v168
    v_mfma_f32_16x16x32_bf16 a[124:127], a[220:223], v[204:207], a[124:127]
    s_waitcnt lgkmcnt(4)
    ds_read_b128 a[152:155], v2 offset:6144
    v_cvt_pk_bf16_f32 v215, v238, v239
    v_mfma_f32_16x16x32_bf16 v[128:131], a[128:131], v[96:99], v[16:19]
    v_exp_f32 v241, v169
    v_mfma_f32_16x16x32_bf16 v[128:131], a[132:135], v[100:103], v[128:131]
    s_waitcnt lgkmcnt(3)
    ds_read_b128 a[156:159], v2 offset:7168
    v_exp_f32 v242, v170
    v_mfma_f32_16x16x32_bf16 v[128:131], a[136:139], v[104:107], v[128:131]
    ds_read_b128 a[160:163], v2 offset:8192
    v_cvt_pk_bf16_f32 v216, v240, v241
    v_mfma_f32_16x16x32_bf16 v[128:131], a[140:143], v[108:111], v[128:131]
    s_add_u32 s36, s36, 64
    buffer_store_dwordx4 a[224:227], v229, s[8:11], s58 offen offset:0 sc1
    v_exp_f32 v243, v171
    v_mfma_f32_16x16x32_bf16 v[132:135], a[140:143], v[124:127], v[20:23]
    ds_read_b128 a[164:167], v2 offset:9216
    v_or3_b32 v57, v57, v215, v216
    v_mfma_f32_16x16x32_bf16 v[132:135], a[136:139], v[120:123], v[132:135]
    v_exp_f32 v244, v184
    v_mfma_f32_16x16x32_bf16 v[132:135], a[132:135], v[116:119], v[132:135]
    s_add_u32 s52, s52, 16384
    ds_read_b128 a[168:171], v2 offset:10240
    v_cvt_pk_bf16_f32 v217, v242, v243
    v_mfma_f32_16x16x32_bf16 v[132:135], a[128:131], v[112:115], v[132:135]
    s_waitcnt lgkmcnt(5)
    v_exp_f32 v245, v185
    v_mfma_f32_16x16x32_bf16 v[148:151], a[144:147], v[112:115], v[36:39]
    s_and_b32 s52, s52, 0xffff
    ds_read_b128 a[172:175], v2 offset:11264
    ds_read_b128 a[176:179], v2 offset:12288
    v_mfma_f32_16x16x32_bf16 v[148:151], a[148:151], v[116:119], v[148:151]
    s_waitcnt lgkmcnt(5)
    v_exp_f32 v246, v186
    v_mfma_f32_16x16x32_bf16 v[148:151], a[152:155], v[120:123], v[148:151]
    ds_read_b128 a[180:183], v2 offset:13312
    v_cvt_pk_bf16_f32 v218, v244, v245
    v_mfma_f32_16x16x32_bf16 v[148:151], a[156:159], v[124:127], v[148:151]
    v_exp_f32 v247, v187
    v_mfma_f32_16x16x32_bf16 v[144:147], a[156:159], v[108:111], v[32:35]
    ds_read_b128 a[184:187], v2 offset:14336
    v_or3_b32 v57, v57, v217, v218
    v_mfma_f32_16x16x32_bf16 v[144:147], a[152:155], v[104:107], v[144:147]
    v_exp_f32 v232, v172
    v_mfma_f32_16x16x32_bf16 v[144:147], a[148:151], v[100:103], v[144:147]
    ds_read_b128 a[188:191], v2 offset:15360
    v_cvt_pk_bf16_f32 v219, v246, v247
    v_mfma_f32_16x16x32_bf16 v[144:147], a[144:147], v[96:99], v[144:147]
    s_waitcnt lgkmcnt(6)
    v_exp_f32 v233, v173
    v_mfma_f32_16x16x32_bf16 v[136:139], a[160:163], v[96:99], v[24:27]
    buffer_store_dwordx4 a[228:231], v229, s[8:11], s58 offen offset:256 sc1
    ds_read_b128 a[192:195], v3 offset:0
    v_mfma_f32_16x16x32_bf16 v[136:139], a[164:167], v[100:103], v[136:139]
    s_waitcnt lgkmcnt(5)
    v_add_u32 v2, s52, v1
    v_cvt_pk_bf16_f32 v220, v232, v233
    v_mfma_f32_16x16x32_bf16 v[136:139], a[168:171], v[104:107], v[136:139]
    v_exp_f32 v234, v174
    v_mfma_f32_16x16x32_bf16 v[136:139], a[172:175], v[108:111], v[136:139]
    v_exp_f32 v235, v175
    v_mfma_f32_16x16x32_bf16 v[140:143], a[172:175], v[124:127], v[28:31]
    ds_read_b128 a[196:199], v3 offset:1024
    v_or3_b32 v57, v57, v219, v220
    v_mfma_f32_16x16x32_bf16 v[140:143], a[168:171], v[120:123], v[140:143]
    v_exp_f32 v236, v188
    v_mfma_f32_16x16x32_bf16 v[140:143], a[164:167], v[116:119], v[140:143]
    ds_read_b128 a[200:203], v3 offset:2048
    v_cvt_pk_bf16_f32 v221, v234, v235
    v_mfma_f32_16x16x32_bf16 v[140:143], a[160:163], v[112:115], v[140:143]
    s_waitcnt lgkmcnt(5)
    v_exp_f32 v237, v189
    v_mfma_f32_16x16x32_bf16 v[156:159], a[176:179], v[112:115], v[44:47]
    v_exp_f32 v238, v190
    v_mfma_f32_16x16x32_bf16 v[156:159], a[180:183], v[116:119], v[156:159]
    s_waitcnt lgkmcnt(3)
    v_cvt_pk_bf16_f32 v222, v236, v237
    v_or3_b32 v57, v57, v221, v222
    v_mfma_f32_16x16x32_bf16 v[156:159], a[184:187], v[120:123], v[156:159]
    v_exp_f32 v239, v191
    v_mfma_f32_16x16x32_bf16 v[156:159], a[188:191], v[124:127], v[156:159]
    ds_read_b128 a[204:207], v3 offset:3072
    v_cvt_pk_bf16_f32 v223, v238, v239
    v_mfma_f32_16x16x32_bf16 v[152:155], a[188:191], v[108:111], v[40:43]
    v_mfma_f32_16x16x32_bf16 v[152:155], a[184:187], v[104:107], v[152:155]
    v_bitop3_b32 v57, v57, v223, s37 bitop3:0xa8
    v_cmp_ne_u32 vcc, 0, v57
    v_mfma_f32_16x16x32_bf16 v[152:155], a[180:183], v[100:103], v[152:155]
    v_mfma_f32_16x16x32_bf16 v[152:155], a[176:179], v[96:99], v[152:155]
    s_cbranch_vccnz k2_tramp_104
k2_ret_105:
    v_mfma_f32_16x16x32_bf16 v[48:51], v[60:63], v[212:215], v[48:51]
    ds_read_b128 a[208:211], v3 offset:4096
    ds_read_b128 a[212:215], v3 offset:5120
    v_mfma_f32_16x16x32_bf16 v[248:251], v[60:63], v[216:219], v[248:251]
    s_mov_b32 m0, s35
    v_exp_f32 v232, v128
    v_mfma_f32_16x16x32_bf16 v[252:255], v[60:63], v[220:223], v[252:255]
    s_waitcnt lgkmcnt(4)
    ds_read_b128 a[216:219], v3 offset:6144
    v_exp_f32 v233, v129
    v_mfma_f32_16x16x32_bf16 a[12:15], a[192:195], v[220:223], a[12:15]
    s_add_u32 s53, s53, 8192
    buffer_load_dwordx4 v1, s[20:23], s33 offen offset:0 sc1 lds
    v_mfma_f32_16x16x32_bf16 a[8:11], a[192:195], v[216:219], a[8:11]
    s_and_b32 s53, s53, 0xffff
    v_exp_f32 v234, v130
    v_cvt_pk_bf16_f32 v192, v232, v233
    v_mfma_f32_16x16x32_bf16 a[4:7], a[192:195], v[212:215], a[4:7]
    ds_read_b128 a[220:223], v3 offset:7168
    v_mfma_f32_16x16x32_bf16 a[20:23], a[196:199], v[212:215], a[20:23]
    s_add_u32 s35, s35, 0x4000
    v_exp_f32 v235, v131
    v_mfma_f32_16x16x32_bf16 a[24:27], a[196:199], v[216:219], a[24:27]
    v_exp_f32 v236, v144
    v_cvt_pk_bf16_f32 v193, v234, v235
    v_mfma_f32_16x16x32_bf16 a[28:31], a[196:199], v[220:223], a[28:31]
    s_waitcnt lgkmcnt(4)
    buffer_load_dwordx4 v1, s[20:23], s33 offen offset:1024 sc1 lds
    ds_read_b128 a[128:131], v2 offset:0
    v_mfma_f32_16x16x32_bf16 a[44:47], a[200:203], v[220:223], a[44:47]
    v_add_u32 v3, s53, v56
    v_exp_f32 v237, v145
    v_mfma_f32_16x16x32_bf16 a[40:43], a[200:203], v[216:219], a[40:43]
    ds_read_b128 a[132:135], v2 offset:1024
    v_cvt_pk_bf16_f32 v194, v236, v237
    v_mfma_f32_16x16x32_bf16 a[36:39], a[200:203], v[212:215], a[36:39]
    ds_read_b128 a[136:139], v2 offset:2048
    v_exp_f32 v238, v146
    v_mfma_f32_16x16x32_bf16 a[52:55], a[204:207], v[212:215], a[52:55]
    s_and_b32 s35, s35, 0xffff
    v_exp_f32 v239, v147
    v_mfma_f32_16x16x32_bf16 a[56:59], a[204:207], v[216:219], a[56:59]
    ds_read_b128 a[140:143], v2 offset:3072
    v_or3_b32 v57, v192, v193, v194
    v_mfma_f32_16x16x32_bf16 a[60:63], a[204:207], v[220:223], a[60:63]
    s_waitcnt lgkmcnt(6)
    v_exp_f32 v240, v132
    v_mfma_f32_16x16x32_bf16 a[76:79], a[208:211], v[220:223], a[76:79]
    s_or_b32 s35, s35, 0x10000
    buffer_load_dwordx4 v1, s[20:23], s33 offen offset:2048 sc1 lds
    ds_read_b128 a[144:147], v2 offset:4096
    v_mfma_f32_16x16x32_bf16 a[72:75], a[208:211], v[216:219], a[72:75]
    v_cvt_pk_bf16_f32 v195, v238, v239
    v_exp_f32 v241, v133
    v_mfma_f32_16x16x32_bf16 a[68:71], a[208:211], v[212:215], a[68:71]
    v_exp_f32 v242, v134
    v_mfma_f32_16x16x32_bf16 a[84:87], a[212:215], v[212:215], a[84:87]
    ds_read_b128 a[148:151], v2 offset:5120
    v_cvt_pk_bf16_f32 v196, v240, v241
    v_mfma_f32_16x16x32_bf16 a[88:91], a[212:215], v[216:219], a[88:91]
    v_exp_f32 v243, v135
    v_mfma_f32_16x16x32_bf16 a[92:95], a[212:215], v[220:223], a[92:95]
    s_waitcnt lgkmcnt(6)
    ds_read_b128 a[152:155], v2 offset:6144
    v_or3_b32 v57, v57, v195, v196
    v_cvt_pk_bf16_f32 v197, v242, v243
    v_mfma_f32_16x16x32_bf16 a[108:111], a[216:219], v[220:223], a[108:111]
    buffer_load_dwordx4 v1, s[20:23], s33 offen offset:3072 sc1 lds
    ds_read_b128 a[156:159], v2 offset:7168
    v_mfma_f32_16x16x32_bf16 a[104:107], a[216:219], v[216:219], a[104:107]
    s_add_u32 s33, s33, 0x80000
    v_exp_f32 v244, v148
    v_mfma_f32_16x16x32_bf16 a[100:103], a[216:219], v[212:215], a[100:103]
    v_exp_f32 v245, v149
    v_mfma_f32_16x16x32_bf16 a[116:119], a[220:223], v[212:215], a[116:119]
    ds_read_b128 a[160:163], v2 offset:8192
    s_cmp_ge_u32 s36, s43
    s_cbranch_scc1 k2_prep_106
k2_prepret_107:
    v_mfma_f32_16x16x32_bf16 a[120:123], a[220:223], v[216:219], a[120:123]
    v_exp_f32 v246, v150
    v_mfma_f32_16x16x32_bf16 a[124:127], a[220:223], v[220:223], a[124:127]
    s_waitcnt lgkmcnt(7)
    ds_read_b128 a[164:167], v2 offset:9216
    v_cvt_pk_bf16_f32 v198, v244, v245
    v_mfma_f32_16x16x32_bf16 v[160:163], a[128:131], v[96:99], v[16:19]
    s_waitcnt vmcnt(12)
    s_barrier
    v_exp_f32 v247, v151
    v_mfma_f32_16x16x32_bf16 v[160:163], a[132:135], v[100:103], v[160:163]
    s_waitcnt lgkmcnt(6)
    v_or3_b32 v57, v57, v197, v198
    v_cvt_pk_bf16_f32 v199, v246, v247
    v_mfma_f32_16x16x32_bf16 v[160:163], a[136:139], v[104:107], v[160:163]
    s_mov_b32 m0, s34
    ds_read_b128 a[168:171], v2 offset:10240
    v_exp_f32 v232, v136
    v_mfma_f32_16x16x32_bf16 v[160:163], a[140:143], v[108:111], v[160:163]
    s_add_u32 s36, s36, 64
    buffer_load_dwordx4 v1, s[16:19], s32 offen offset:0 sc1 lds
    ds_read_b128 a[172:175], v2 offset:11264
    v_mfma_f32_16x16x32_bf16 v[164:167], a[140:143], v[124:127], v[20:23]
    v_exp_f32 v233, v137
    v_mfma_f32_16x16x32_bf16 v[164:167], a[136:139], v[120:123], v[164:167]
    v_exp_f32 v234, v138
    v_mfma_f32_16x16x32_bf16 v[164:167], a[132:135], v[116:119], v[164:167]
    s_add_u32 s52, s52, 16384
    ds_read_b128 a[176:179], v2 offset:12288
    v_cvt_pk_bf16_f32 v200, v232, v233
    v_mfma_f32_16x16x32_bf16 v[164:167], a[128:131], v[112:115], v[164:167]
    s_waitcnt lgkmcnt(7)
    v_exp_f32 v235, v139
    v_or3_b32 v57, v57, v199, v200
    v_mfma_f32_16x16x32_bf16 v[180:183], a[144:147], v[112:115], v[36:39]
    s_add_u32 s34, s34, 0x4000
    ds_read_b128 a[180:183], v2 offset:13312
    v_cvt_pk_bf16_f32 v201, v234, v235
    v_mfma_f32_16x16x32_bf16 v[180:183], a[148:151], v[116:119], v[180:183]
    s_waitcnt lgkmcnt(6)
    v_exp_f32 v236, v152
    v_mfma_f32_16x16x32_bf16 v[180:183], a[152:155], v[120:123], v[180:183]
    s_and_b32 s52, s52, 0xffff
    buffer_load_dwordx4 v1, s[16:19], s32 offen offset:1024 sc1 lds
    ds_read_b128 a[184:187], v2 offset:14336
    v_mfma_f32_16x16x32_bf16 v[180:183], a[156:159], v[124:127], v[180:183]
    ds_read_b128 a[188:191], v2 offset:15360
    v_exp_f32 v237, v153
    v_mfma_f32_16x16x32_bf16 v[176:179], a[156:159], v[108:111], v[32:35]
    v_exp_f32 v238, v154
    v_mfma_f32_16x16x32_bf16 v[176:179], a[152:155], v[104:107], v[176:179]
    v_cvt_pk_bf16_f32 v202, v236, v237
    v_or3_b32 v57, v57, v201, v202
    v_mfma_f32_16x16x32_bf16 v[176:179], a[148:151], v[100:103], v[176:179]
    s_and_b32 s34, s34, 0xffff
    v_exp_f32 v239, v155
    v_mfma_f32_16x16x32_bf16 v[176:179], a[144:147], v[96:99], v[176:179]
    s_waitcnt lgkmcnt(6)
    v_add_u32 v2, s52, v1
    v_cvt_pk_bf16_f32 v203, v238, v239
    v_mfma_f32_16x16x32_bf16 v[168:171], a[160:163], v[96:99], v[24:27]
    ds_read_b128 a[192:195], v3 offset:0
    v_exp_f32 v240, v140
    v_mfma_f32_16x16x32_bf16 v[168:171], a[164:167], v[100:103], v[168:171]
    s_waitcnt lgkmcnt(5)
    v_exp_f32 v241, v141
    v_mfma_f32_16x16x32_bf16 v[168:171], a[168:171], v[104:107], v[168:171]
    buffer_load_dwordx4 v1, s[16:19], s32 offen offset:2048 sc1 lds
    ds_read_b128 a[196:199], v3 offset:8192
    v_mfma_f32_16x16x32_bf16 v[168:171], a[172:175], v[108:111], v[168:171]
    v_exp_f32 v242, v142
    v_mfma_f32_16x16x32_bf16 v[172:175], a[172:175], v[124:127], v[28:31]
    ds_read_b128 a[200:203], v3 offset:1024
    v_cvt_pk_bf16_f32 v204, v240, v241
    v_or3_b32 v57, v57, v203, v204
    v_mfma_f32_16x16x32_bf16 v[172:175], a[168:171], v[120:123], v[172:175]
    v_exp_f32 v243, v143
    v_mfma_f32_16x16x32_bf16 v[172:175], a[164:167], v[116:119], v[172:175]
    ds_read_b128 a[204:207], v3 offset:9216
    v_cvt_pk_bf16_f32 v205, v242, v243
    v_mfma_f32_16x16x32_bf16 v[172:175], a[160:163], v[112:115], v[172:175]
    s_waitcnt lgkmcnt(6)
    v_exp_f32 v244, v156
    v_mfma_f32_16x16x32_bf16 v[188:191], a[176:179], v[112:115], v[44:47]
    v_exp_f32 v245, v157
    v_mfma_f32_16x16x32_bf16 v[188:191], a[180:183], v[116:119], v[188:191]
    s_waitcnt lgkmcnt(4)
    buffer_load_dwordx4 v1, s[16:19], s32 offen offset:3072 sc1 lds
    ds_read_b128 a[208:211], v3 offset:2048
    ds_read_b128 a[212:215], v3 offset:10240
    v_mfma_f32_16x16x32_bf16 v[188:191], a[184:187], v[120:123], v[188:191]
    s_add_u32 s32, s32, 0x80000
    v_exp_f32 v246, v158
    v_mfma_f32_16x16x32_bf16 v[188:191], a[188:191], v[124:127], v[188:191]
    v_cvt_pk_bf16_f32 v206, v244, v245
    v_or3_b32 v57, v57, v205, v206
    v_mfma_f32_16x16x32_bf16 v[184:187], a[188:191], v[108:111], v[40:43]
    v_exp_f32 v247, v159
    v_mfma_f32_16x16x32_bf16 v[184:187], a[184:187], v[104:107], v[184:187]
    ds_read_b128 a[216:219], v3 offset:3072
    ds_read_b128 a[220:223], v3 offset:11264
    v_cvt_pk_bf16_f32 v207, v246, v247
    v_mfma_f32_16x16x32_bf16 v[184:187], a[180:183], v[100:103], v[184:187]
    v_bitop3_b32 v57, v57, v207, s37 bitop3:0xa8
    v_cmp_ne_u32 vcc, 0, v57
    v_mfma_f32_16x16x32_bf16 v[184:187], a[176:179], v[96:99], v[184:187]
    s_cbranch_vccnz k2_tramp_108
k2_ret_109:
    s_load_dwordx2 s[4:5], s[0:1], 40
    s_add_u32 s24, s6, 0x3000000
    s_addc_u32 s25, s7, 0
    s_and_b32 s25, s25, 0xffff
    s_mov_b32 s26, 0x1000000
    s_mov_b32 s27, 0x00020000
    s_lshl_b32 s31, s28, 19
    s_lshl_b32 s44, s38, 6
    s_add_u32 s44, s44, s31
    s_add_u32 s45, s44, 131072
    s_add_u32 s46, s44, 262144
    s_add_u32 s47, s44, 393216
    s_add_u32 s48, s44, 4096
    s_add_u32 s49, s44, 135168
    s_add_u32 s50, s44, 266240
    s_add_u32 s51, s44, 397312
    v_mov_b32 v13, v12
    v_mov_b32 v49, v48
    s_nop 1
    v_permlane16_swap_b32 v12, v13
    v_permlane16_swap_b32 v48, v49
    s_nop 1
    v_add_f32 v12, v12, v13
    v_add_f32 v48, v48, v49
    v_mov_b32 v13, v12
    v_mov_b32 v49, v48
    s_nop 1
    v_permlane32_swap_b32 v12, v13
    v_permlane32_swap_b32 v48, v49
    s_nop 1
    v_add_f32 v12, v12, v13
    v_add_f32 v48, v48, v49
    v_rcp_f32 v13, v12
    v_rcp_f32 v49, v48
    v_rcp_f32 v12, v12
    v_rcp_f32 v48, v48
    s_nop 0
    v_accvgpr_read_b32 v68, a0
    v_accvgpr_read_b32 v69, a1
    v_accvgpr_read_b32 v70, a2
    v_accvgpr_read_b32 v71, a3
    v_accvgpr_read_b32 v72, a16
    v_accvgpr_read_b32 v73, a17
    v_accvgpr_read_b32 v74, a18
    v_accvgpr_read_b32 v75, a19
    v_pk_mul_f32 v[68:69], v[68:69], v[12:13]
    v_pk_mul_f32 v[70:71], v[70:71], v[12:13]
    v_pk_mul_f32 v[72:73], v[72:73], v[12:13]
    v_pk_mul_f32 v[74:75], v[74:75], v[12:13]
    v_cvt_pk_bf16_f32 v64, v68, v69
    v_cvt_pk_bf16_f32 v65, v70, v71
    v_cvt_pk_bf16_f32 v66, v72, v73
    v_cvt_pk_bf16_f32 v67, v74, v75
    buffer_store_dwordx4 v[64:67], v1, s[24:27], s44 offen sc1
    v_accvgpr_read_b32 v80, a32
    v_accvgpr_read_b32 v81, a33
    v_accvgpr_read_b32 v82, a34
    v_accvgpr_read_b32 v83, a35
    v_accvgpr_read_b32 v84, a48
    v_accvgpr_read_b32 v85, a49
    v_accvgpr_read_b32 v86, a50
    v_accvgpr_read_b32 v87, a51
    v_pk_mul_f32 v[80:81], v[80:81], v[12:13]
    v_pk_mul_f32 v[82:83], v[82:83], v[12:13]
    v_pk_mul_f32 v[84:85], v[84:85], v[12:13]
    v_pk_mul_f32 v[86:87], v[86:87], v[12:13]
    v_cvt_pk_bf16_f32 v76, v80, v81
    v_cvt_pk_bf16_f32 v77, v82, v83
    v_cvt_pk_bf16_f32 v78, v84, v85
    v_cvt_pk_bf16_f32 v79, v86, v87
    buffer_store_dwordx4 v[76:79], v1, s[24:27], s45 offen sc1
    v_accvgpr_read_b32 v68, a64
    v_accvgpr_read_b32 v69, a65
    v_accvgpr_read_b32 v70, a66
    v_accvgpr_read_b32 v71, a67
    v_accvgpr_read_b32 v72, a80
    v_accvgpr_read_b32 v73, a81
    v_accvgpr_read_b32 v74, a82
    v_accvgpr_read_b32 v75, a83
    v_pk_mul_f32 v[68:69], v[68:69], v[12:13]
    v_pk_mul_f32 v[70:71], v[70:71], v[12:13]
    v_pk_mul_f32 v[72:73], v[72:73], v[12:13]
    v_pk_mul_f32 v[74:75], v[74:75], v[12:13]
    v_cvt_pk_bf16_f32 v64, v68, v69
    v_cvt_pk_bf16_f32 v65, v70, v71
    v_cvt_pk_bf16_f32 v66, v72, v73
    v_cvt_pk_bf16_f32 v67, v74, v75
    buffer_store_dwordx4 v[64:67], v1, s[24:27], s46 offen sc1
    v_accvgpr_read_b32 v80, a96
    v_accvgpr_read_b32 v81, a97
    v_accvgpr_read_b32 v82, a98
    v_accvgpr_read_b32 v83, a99
    v_accvgpr_read_b32 v84, a112
    v_accvgpr_read_b32 v85, a113
    v_accvgpr_read_b32 v86, a114
    v_accvgpr_read_b32 v87, a115
    v_pk_mul_f32 v[80:81], v[80:81], v[12:13]
    v_pk_mul_f32 v[82:83], v[82:83], v[12:13]
    v_pk_mul_f32 v[84:85], v[84:85], v[12:13]
    v_pk_mul_f32 v[86:87], v[86:87], v[12:13]
    v_cvt_pk_bf16_f32 v76, v80, v81
    v_cvt_pk_bf16_f32 v77, v82, v83
    v_cvt_pk_bf16_f32 v78, v84, v85
    v_cvt_pk_bf16_f32 v79, v86, v87
    buffer_store_dwordx4 v[76:79], v1, s[24:27], s47 offen sc1
    v_accvgpr_read_b32 v68, a4
    v_accvgpr_read_b32 v69, a5
    v_accvgpr_read_b32 v70, a6
    v_accvgpr_read_b32 v71, a7
    v_accvgpr_read_b32 v72, a20
    v_accvgpr_read_b32 v73, a21
    v_accvgpr_read_b32 v74, a22
    v_accvgpr_read_b32 v75, a23
    v_pk_mul_f32 v[68:69], v[68:69], v[48:49]
    v_pk_mul_f32 v[70:71], v[70:71], v[48:49]
    v_pk_mul_f32 v[72:73], v[72:73], v[48:49]
    v_pk_mul_f32 v[74:75], v[74:75], v[48:49]
    v_cvt_pk_bf16_f32 v64, v68, v69
    v_cvt_pk_bf16_f32 v65, v70, v71
    v_cvt_pk_bf16_f32 v66, v72, v73
    v_cvt_pk_bf16_f32 v67, v74, v75
    buffer_store_dwordx4 v[64:67], v1, s[24:27], s48 offen sc1
    v_accvgpr_read_b32 v80, a36
    v_accvgpr_read_b32 v81, a37
    v_accvgpr_read_b32 v82, a38
    v_accvgpr_read_b32 v83, a39
    v_accvgpr_read_b32 v84, a52
    v_accvgpr_read_b32 v85, a53
    v_accvgpr_read_b32 v86, a54
    v_accvgpr_read_b32 v87, a55
    v_pk_mul_f32 v[80:81], v[80:81], v[48:49]
    v_pk_mul_f32 v[82:83], v[82:83], v[48:49]
    v_pk_mul_f32 v[84:85], v[84:85], v[48:49]
    v_pk_mul_f32 v[86:87], v[86:87], v[48:49]
    v_cvt_pk_bf16_f32 v76, v80, v81
    v_cvt_pk_bf16_f32 v77, v82, v83
    v_cvt_pk_bf16_f32 v78, v84, v85
    v_cvt_pk_bf16_f32 v79, v86, v87
    buffer_store_dwordx4 v[76:79], v1, s[24:27], s49 offen sc1
    v_accvgpr_read_b32 v68, a68
    v_accvgpr_read_b32 v69, a69
    v_accvgpr_read_b32 v70, a70
    v_accvgpr_read_b32 v71, a71
    v_accvgpr_read_b32 v72, a84
    v_accvgpr_read_b32 v73, a85
    v_accvgpr_read_b32 v74, a86
    v_accvgpr_read_b32 v75, a87
    v_pk_mul_f32 v[68:69], v[68:69], v[48:49]
    v_pk_mul_f32 v[70:71], v[70:71], v[48:49]
    v_pk_mul_f32 v[72:73], v[72:73], v[48:49]
    v_pk_mul_f32 v[74:75], v[74:75], v[48:49]
    v_cvt_pk_bf16_f32 v64, v68, v69
    v_cvt_pk_bf16_f32 v65, v70, v71
    v_cvt_pk_bf16_f32 v66, v72, v73
    v_cvt_pk_bf16_f32 v67, v74, v75
    buffer_store_dwordx4 v[64:67], v1, s[24:27], s50 offen sc1
    v_accvgpr_read_b32 v80, a100
    v_accvgpr_read_b32 v81, a101
    v_accvgpr_read_b32 v82, a102
    v_accvgpr_read_b32 v83, a103
    v_accvgpr_read_b32 v84, a116
    v_accvgpr_read_b32 v85, a117
    v_accvgpr_read_b32 v86, a118
    v_accvgpr_read_b32 v87, a119
    v_pk_mul_f32 v[80:81], v[80:81], v[48:49]
    v_pk_mul_f32 v[82:83], v[82:83], v[48:49]
    v_pk_mul_f32 v[84:85], v[84:85], v[48:49]
    v_pk_mul_f32 v[86:87], v[86:87], v[48:49]
    v_cvt_pk_bf16_f32 v76, v80, v81
    v_cvt_pk_bf16_f32 v77, v82, v83
    v_cvt_pk_bf16_f32 v78, v84, v85
    v_cvt_pk_bf16_f32 v79, v86, v87
    buffer_store_dwordx4 v[76:79], v1, s[24:27], s51 offen sc1
    s_nop 1
    s_lshr_b32 s31, s2, 3
    s_bfe_u32 s56, s2, 0x10002
    s_and_b32 s54, s2, 1
    s_and_b32 s55, s31, 7
    s_lshl_b32 s54, s54, 3
    s_add_u32 s54, s54, s55
    s_and_b32 s55, s2, 2
    s_lshl_b32 s55, s55, 1
    s_lshr_b32 s31, s31, 3
    s_add_u32 s55, s55, s31
    v_lshrrev_b32 v87, 4, v1
    v_lshrrev_b32 v72, 4, v87
    s_lshl_b32 s57, s54, 7
    s_lshl_b32 s31, s30, 5
    s_add_u32 s57, s57, s31
    s_lshl_b32 s31, s57, 6
    v_add_u32 v88, s31, v1
    v_add_u32 v89, 0x20000, v88
    v_bfe_u32 v84, v87, 1, 3
    v_xor_b32 v84, v84, v72
    v_and_b32 v85, 16, v1
    v_lshl_add_u32 v85, v72, 11, v85
    s_lshl_b32 s31, s30, 15
    s_lshl_b32 s58, s55, 8
    s_add_u32 s31, s31, s58
    v_add_u32 v85, s31, v85
    v_xor_b32 v86, 0, v84
    v_lshl_add_u32 v86, v86, 5, v85
    v_add_u32 v90, 0, v86
    v_xor_b32 v86, 4, v84
    v_lshl_add_u32 v86, v86, 5, v85
    v_add_u32 v91, 7168, v86
    v_xor_b32 v86, 0, v84
    v_lshl_add_u32 v86, v86, 5, v85
    v_add_u32 v92, 14336, v86
    v_xor_b32 v86, 4, v84
    v_lshl_add_u32 v86, v86, 5, v85
    v_add_u32 v93, 21504, v86
    v_and_b32 v84, 15, v87
    v_add_u32 v85, s57, v84
    v_lshlrev_b32 v77, 2, v85
    v_lshl_add_u32 v77, v72, 13, v77
    s_lshl_b32 s31, s56, 7
    s_add_u32 s58, s58, s31
    v_lshl_add_u32 v80, v72, 3, s58
    v_lshl_add_u32 v78, v85, 11, v80
    v_add_u32 v79, 0x8000, v78
    v_lshrrev_b32 v85, 2, v84
    v_lshl_add_u32 v85, v72, 2, v85
    v_and_b32 v84, 7, v85
    s_lshl_b32 s31, s56, 2
    v_xor_b32 v84, s31, v84
    v_lshlrev_b32 v85, 8, v85
    v_and_b32 v86, 3, v87
    v_lshl_add_u32 v85, v86, 3, v85
    s_add_u32 s31, s2, 1
    s_and_b32 s31, s31, 3
    v_add_u32 v73, s31, v86
    v_and_b32 v73, 3, v73
    v_lshlrev_b32 v73, 7, v73
    v_xor_b32 v86, 0, v84
    v_lshl_add_u32 v64, v86, 5, v85
    v_xor_b32 v86, 1, v84
    v_lshl_add_u32 v65, v86, 5, v85
    v_xor_b32 v86, 2, v84
    v_lshl_add_u32 v66, v86, 5, v85
    v_xor_b32 v86, 3, v84
    v_lshl_add_u32 v67, v86, 5, v85
    v_xor_b32 v86, 4, v84
    v_lshl_add_u32 v68, v86, 5, v85
    v_xor_b32 v86, 5, v84
    v_lshl_add_u32 v69, v86, 5, v85
    v_xor_b32 v86, 6, v84
    v_lshl_add_u32 v70, v86, 5, v85
    v_xor_b32 v86, 7, v84
    v_lshl_add_u32 v71, v86, 5, v85
    s_lshl_b32 s61, s31, 20
    s_lshl_b32 s62, s31, 21
    s_lshl_b32 s60, s30, 12
    s_lshl_b32 s59, s54, 10
    s_lshl_b32 s31, s56, 9
    s_add_u32 s59, s59, s31
    s_lshr_b32 s31, s28, 2
    s_lshl_b32 s31, s31, 7
    s_lshl_b32 s57, s29, 10
    s_sub_u32 s58, 0x3c00, s57
    s_add_u32 s57, s57, s31
    s_add_u32 s58, s58, s31
    v_mov_b32 v75, 0
    v_mov_b32 v76, 1
    s_lshl_b32 s31, s56, 23
    s_add_u32 s31, s31, 0x3000000
    s_add_u32 s8, s6, s31
    s_addc_u32 s9, s7, 0
    s_and_b32 s9, s9, 0xffff
    s_mov_b32 s10, 0x800000
    s_lshl_b32 s31, s56, 22
    s_waitcnt lgkmcnt(0)
    s_add_u32 s12, s4, s31
    s_addc_u32 s13, s5, 0
    s_and_b32 s13, s13, 0xffff
    s_mov_b32 s14, 0x400000
    s_load_dwordx2 s[4:5], s[0:1], 80
    v_mov_b32 v12, -1
    v_mov_b32 v13, -1
    v_mov_b32 v14, -1
    v_mov_b32 v15, -1
    s_waitcnt lgkmcnt(0)
    s_mov_b32 s26, -1
    s_lshl_b32 s31, s2, 14
    s_add_u32 s31, s31, s60
    s_add_u32 s40, s31, 0x2000000
    buffer_store_dwordx4 v[12:15], v1, s[24:27], s40 offen offset:0 sc1
    buffer_store_dwordx4 v[12:15], v1, s[24:27], s40 offen offset:1024 sc1
    buffer_store_dwordx4 v[12:15], v1, s[24:27], s40 offen offset:2048 sc1
    buffer_store_dwordx4 v[12:15], v1, s[24:27], s40 offen offset:3072 sc1
    s_lshr_b32 s31, s31, 1
    s_add_u32 s40, s31, 0x1900000
    buffer_store_dwordx4 v[12:15], v1, s[24:27], s40 offen offset:0 sc1
    buffer_store_dwordx4 v[12:15], v1, s[24:27], s40 offen offset:1024 sc1
    s_mov_b32 s26, 0x1000000
    s_and_b32 s31, s2, 7
    s_mul_i32 s31, s31, 28
    s_lshr_b32 s40, s2, 3
    s_add_u32 s31, s31, s40
    s_lshl_b32 s31, s31, 15
    s_lshl_b32 s40, s30, 13
    s_add_u32 s31, s31, s40
    s_mov_b32 s44, s4
    s_mov_b32 s47, 0x00020000
    s_and_b32 s45, s5, 0xffff
    s_cmp_ge_u32 s2, 224
    s_cselect_b32 s46, 0, 7340032
    s_add_u32 m0, s40, 131072
    s_nop 0
    buffer_load_dwordx4 v1, s[44:47], s31 offen offset:0 lds
    buffer_load_dwordx4 v1, s[44:47], s31 offen offset:1024 lds
    buffer_load_dwordx4 v1, s[44:47], s31 offen offset:2048 lds
    buffer_load_dwordx4 v1, s[44:47], s31 offen offset:3072 lds
    s_add_u32 s31, s31, 4096
    s_add_u32 m0, s40, 135168
    s_nop 0
    buffer_load_dwordx4 v1, s[44:47], s31 offen offset:0 lds
    buffer_load_dwordx4 v1, s[44:47], s31 offen offset:1024 lds
    buffer_load_dwordx4 v1, s[44:47], s31 offen offset:2048 lds
    buffer_load_dwordx4 v1, s[44:47], s31 offen offset:3072 lds
    s_add_u32 s31, s31, 4096
    s_lshl_b32 s63, s29, 1
    s_sub_u32 s63, 13, s63
    s_cbranch_scc1 k2_sdone_111
k2_sloop_110:
    v_mfma_f32_16x16x32_bf16 v[248:251], v[60:63], v[192:195], v[248:251]
    v_exp_f32 v232, v160
    v_mfma_f32_16x16x32_bf16 v[248:251], v[60:63], v[200:203], v[248:251]
    s_mov_b32 m0, s35
    ds_read_b128 a[224:227], v3 offset:4096
    v_mfma_f32_16x16x32_bf16 v[252:255], v[60:63], v[204:207], v[252:255]
    s_add_u32 s53, s53, 16384
    buffer_load_dwordx4 v1, s[20:23], s33 offen offset:0 sc1 lds
    ds_read_b128 a[228:231], v3 offset:12288
    v_mfma_f32_16x16x32_bf16 v[252:255], v[60:63], v[196:199], v[252:255]
    s_waitcnt lgkmcnt(8)
    v_exp_f32 v233, v161
    v_mfma_f32_16x16x32_bf16 a[12:15], a[192:195], v[196:199], a[12:15]
    s_and_b32 s53, s53, 0xffff
    v_exp_f32 v234, v162
    v_mfma_f32_16x16x32_bf16 a[12:15], a[196:199], v[204:207], a[12:15]
    ds_read_b128 a[232:235], v3 offset:5120
    v_cvt_pk_bf16_f32 v208, v232, v233
    v_mfma_f32_16x16x32_bf16 a[8:11], a[196:199], v[200:203], a[8:11]
    v_exp_f32 v235, v163
    v_mfma_f32_16x16x32_bf16 a[8:11], a[192:195], v[192:195], a[8:11]
    s_waitcnt lgkmcnt(7)
    ds_read_b128 a[236:239], v3 offset:13312
    v_cvt_pk_bf16_f32 v209, v234, v235
    v_mfma_f32_16x16x32_bf16 a[24:27], a[200:203], v[192:195], a[24:27]
    s_add_u32 s35, s35, 0x4000
    v_exp_f32 v236, v176
    v_mfma_f32_16x16x32_bf16 a[24:27], a[204:207], v[200:203], a[24:27]
    buffer_load_dwordx4 v1, s[20:23], s33 offen offset:1024 sc1 lds
    ds_read_b128 a[240:243], v3 offset:6144
    v_mfma_f32_16x16x32_bf16 a[28:31], a[204:207], v[204:207], a[28:31]
    v_exp_f32 v237, v177
    v_mfma_f32_16x16x32_bf16 a[28:31], a[200:203], v[196:199], a[28:31]
    s_waitcnt lgkmcnt(7)
    ds_read_b128 a[244:247], v3 offset:14336
    v_cvt_pk_bf16_f32 v210, v236, v237
    v_mfma_f32_16x16x32_bf16 a[44:47], a[208:211], v[196:199], a[44:47]
    v_exp_f32 v238, v178
    v_mfma_f32_16x16x32_bf16 a[44:47], a[212:215], v[204:207], a[44:47]
    ds_read_b128 a[248:251], v3 offset:7168
    v_or3_b32 v57, v208, v209, v210
    v_mfma_f32_16x16x32_bf16 a[40:43], a[212:215], v[200:203], a[40:43]
    v_exp_f32 v239, v179
    v_mfma_f32_16x16x32_bf16 a[40:43], a[208:211], v[192:195], a[40:43]
    s_waitcnt lgkmcnt(7)
    ds_read_b128 a[252:255], v3 offset:15360
    v_cvt_pk_bf16_f32 v211, v238, v239
    v_mfma_f32_16x16x32_bf16 a[56:59], a[216:219], v[192:195], a[56:59]
    s_and_b32 s35, s35, 0xffff
    v_exp_f32 v240, v164
    v_mfma_f32_16x16x32_bf16 a[56:59], a[220:223], v[200:203], a[56:59]
    ds_read_b128 a[128:131], v2 offset:0
    v_add_u32 v3, s53, v56
    v_mfma_f32_16x16x32_bf16 a[60:63], a[220:223], v[204:207], a[60:63]
    v_exp_f32 v241, v165
    v_mfma_f32_16x16x32_bf16 a[60:63], a[216:219], v[196:199], a[60:63]
    s_waitcnt lgkmcnt(7)
    buffer_load_dwordx4 v1, s[20:23], s33 offen offset:2048 sc1 lds
    ds_read_b128 a[132:135], v2 offset:1024
    v_mfma_f32_16x16x32_bf16 a[76:79], a[224:227], v[196:199], a[76:79]
    v_exp_f32 v242, v166
    v_mfma_f32_16x16x32_bf16 a[76:79], a[228:231], v[204:207], a[76:79]
    s_or_b32 s35, s35, 0x10000
    ds_read_b128 a[136:139], v2 offset:2048
    v_cvt_pk_bf16_f32 v212, v240, v241
    v_mfma_f32_16x16x32_bf16 a[72:75], a[228:231], v[200:203], a[72:75]
    v_exp_f32 v243, v167
    v_mfma_f32_16x16x32_bf16 a[72:75], a[224:227], v[192:195], a[72:75]
    s_waitcnt lgkmcnt(7)
    ds_read_b128 a[140:143], v2 offset:3072
    v_or3_b32 v57, v57, v211, v212
    v_mfma_f32_16x16x32_bf16 a[88:91], a[232:235], v[192:195], a[88:91]
    v_exp_f32 v244, v180
    v_mfma_f32_16x16x32_bf16 a[88:91], a[236:239], v[200:203], a[88:91]
    ds_read_b128 a[144:147], v2 offset:4096
    v_cvt_pk_bf16_f32 v213, v242, v243
    v_mfma_f32_16x16x32_bf16 a[92:95], a[236:239], v[204:207], a[92:95]
    v_exp_f32 v245, v181
    v_mfma_f32_16x16x32_bf16 a[92:95], a[232:235], v[196:199], a[92:95]
    s_waitcnt lgkmcnt(7)
    buffer_load_dwordx4 v1, s[20:23], s33 offen offset:3072 sc1 lds
    ds_read_b128 a[148:151], v2 offset:5120
    v_mfma_f32_16x16x32_bf16 a[108:111], a[240:243], v[196:199], a[108:111]
    s_add_u32 s33, s33, 0x80000
    v_exp_f32 v246, v182
    v_mfma_f32_16x16x32_bf16 a[108:111], a[244:247], v[204:207], a[108:111]
    ds_read_b128 a[152:155], v2 offset:6144
    v_cvt_pk_bf16_f32 v214, v244, v245
    v_mfma_f32_16x16x32_bf16 a[104:107], a[244:247], v[200:203], a[104:107]
    v_exp_f32 v247, v183
    v_mfma_f32_16x16x32_bf16 a[104:107], a[240:243], v[192:195], a[104:107]
    s_waitcnt lgkmcnt(7)
    ds_read_b128 a[156:159], v2 offset:7168
    v_or3_b32 v57, v57, v213, v214
    v_mfma_f32_16x16x32_bf16 a[120:123], a[248:251], v[192:195], a[120:123]
    v_exp_f32 v232, v168
    v_mfma_f32_16x16x32_bf16 a[120:123], a[252:255], v[200:203], a[120:123]
    ds_read_b128 a[160:163], v2 offset:8192
    v_cvt_pk_bf16_f32 v215, v246, v247
    v_mfma_f32_16x16x32_bf16 a[124:127], a[252:255], v[204:207], a[124:127]
    v_exp_f32 v233, v169
    v_mfma_f32_16x16x32_bf16 a[124:127], a[248:251], v[196:199], a[124:127]
    s_waitcnt lgkmcnt(7)
    ds_read_b128 a[164:167], v2 offset:9216
    v_cvt_pk_bf16_f32 v216, v232, v233
    v_mfma_f32_16x16x32_bf16 v[128:131], a[128:131], v[96:99], v[16:19]
    s_waitcnt vmcnt(12)
    s_barrier
    v_exp_f32 v234, v170
    v_mfma_f32_16x16x32_bf16 v[128:131], a[132:135], v[100:103], v[128:131]
    s_waitcnt lgkmcnt(6)
    ds_read_b128 a[168:171], v2 offset:10240
    v_or3_b32 v57, v57, v215, v216
    v_mfma_f32_16x16x32_bf16 v[128:131], a[136:139], v[104:107], v[128:131]
    s_mov_b32 m0, s34
    v_exp_f32 v235, v171
    v_mfma_f32_16x16x32_bf16 v[128:131], a[140:143], v[108:111], v[128:131]
    s_add_u32 s36, s36, 64
    buffer_load_dwordx4 v1, s[16:19], s32 offen offset:0 sc1 lds
    ds_read_b128 a[172:175], v2 offset:11264
    v_mfma_f32_16x16x32_bf16 v[132:135], a[140:143], v[124:127], v[20:23]
    v_exp_f32 v236, v184
    v_mfma_f32_16x16x32_bf16 v[132:135], a[136:139], v[120:123], v[132:135]
    ds_read_b128 a[176:179], v2 offset:12288
    v_cvt_pk_bf16_f32 v217, v234, v235
    v_mfma_f32_16x16x32_bf16 v[132:135], a[132:135], v[116:119], v[132:135]
    s_add_u32 s52, s52, 16384
    v_exp_f32 v237, v185
    v_mfma_f32_16x16x32_bf16 v[132:135], a[128:131], v[112:115], v[132:135]
    s_waitcnt lgkmcnt(7)
    ds_read_b128 a[180:183], v2 offset:13312
    v_cvt_pk_bf16_f32 v218, v236, v237
    v_mfma_f32_16x16x32_bf16 v[148:151], a[144:147], v[112:115], v[36:39]
    s_add_u32 s34, s34, 0x4000
    v_exp_f32 v238, v186
    v_mfma_f32_16x16x32_bf16 v[148:151], a[148:151], v[116:119], v[148:151]
    s_waitcnt lgkmcnt(6)
    buffer_load_dwordx4 v1, s[16:19], s32 offen offset:1024 sc1 lds
    ds_read_b128 a[184:187], v2 offset:14336
    v_mfma_f32_16x16x32_bf16 v[148:151], a[152:155], v[120:123], v[148:151]
    s_and_b32 s52, s52, 0xffff
    v_exp_f32 v239, v187
    v_mfma_f32_16x16x32_bf16 v[148:151], a[156:159], v[124:127], v[148:151]
    ds_read_b128 a[188:191], v2 offset:15360
    v_or3_b32 v57, v57, v217, v218
    v_mfma_f32_16x16x32_bf16 v[144:147], a[156:159], v[108:111], v[32:35]
    v_exp_f32 v240, v172
    v_mfma_f32_16x16x32_bf16 v[144:147], a[152:155], v[104:107], v[144:147]
    v_cvt_pk_bf16_f32 v219, v238, v239
    v_add_u32 v2, s52, v1
    v_mfma_f32_16x16x32_bf16 v[144:147], a[148:151], v[100:103], v[144:147]
    s_and_b32 s34, s34, 0xffff
    v_exp_f32 v241, v173
    v_mfma_f32_16x16x32_bf16 v[144:147], a[144:147], v[96:99], v[144:147]
    s_waitcnt lgkmcnt(6)
    ds_read_b128 a[192:195], v3 offset:0
    v_cvt_pk_bf16_f32 v220, v240, v241
    v_mfma_f32_16x16x32_bf16 v[136:139], a[160:163], v[96:99], v[24:27]
    v_exp_f32 v242, v174
    v_mfma_f32_16x16x32_bf16 v[136:139], a[164:167], v[100:103], v[136:139]
    s_waitcnt lgkmcnt(5)
    buffer_load_dwordx4 v1, s[16:19], s32 offen offset:2048 sc1 lds
    ds_read_b128 a[196:199], v3 offset:8192
    v_mfma_f32_16x16x32_bf16 v[136:139], a[168:171], v[104:107], v[136:139]
    v_exp_f32 v243, v175
    v_mfma_f32_16x16x32_bf16 v[136:139], a[172:175], v[108:111], v[136:139]
    ds_read_b128 a[200:203], v3 offset:1024
    v_or3_b32 v57, v57, v219, v220
    v_mfma_f32_16x16x32_bf16 v[140:143], a[172:175], v[124:127], v[28:31]
    v_exp_f32 v244, v188
    v_mfma_f32_16x16x32_bf16 v[140:143], a[168:171], v[120:123], v[140:143]
    ds_read_b128 a[204:207], v3 offset:9216
    v_cvt_pk_bf16_f32 v221, v242, v243
    v_mfma_f32_16x16x32_bf16 v[140:143], a[164:167], v[116:119], v[140:143]
    v_exp_f32 v245, v189
    v_mfma_f32_16x16x32_bf16 v[140:143], a[160:163], v[112:115], v[140:143]
    s_waitcnt lgkmcnt(6)
    buffer_load_dwordx4 v1, s[16:19], s32 offen offset:3072 sc1 lds
    ds_read_b128 a[208:211], v3 offset:2048
    v_mfma_f32_16x16x32_bf16 v[156:159], a[176:179], v[112:115], v[44:47]
    s_add_u32 s32, s32, 0x80000
    v_exp_f32 v246, v190
    v_mfma_f32_16x16x32_bf16 v[156:159], a[180:183], v[116:119], v[156:159]
    s_waitcnt lgkmcnt(5)
    ds_read_b128 a[212:215], v3 offset:10240
    v_cvt_pk_bf16_f32 v222, v244, v245
    v_mfma_f32_16x16x32_bf16 v[156:159], a[184:187], v[120:123], v[156:159]
    v_exp_f32 v247, v191
    v_mfma_f32_16x16x32_bf16 v[156:159], a[188:191], v[124:127], v[156:159]
    ds_read_b128 a[216:219], v3 offset:3072
    v_or3_b32 v57, v57, v221, v222
    v_mfma_f32_16x16x32_bf16 v[152:155], a[188:191], v[108:111], v[40:43]
    ds_read_b128 a[220:223], v3 offset:11264
    v_cvt_pk_bf16_f32 v223, v246, v247
    v_mfma_f32_16x16x32_bf16 v[152:155], a[184:187], v[104:107], v[152:155]
    v_bitop3_b32 v57, v57, v223, s37 bitop3:0xa8
    v_cmp_ne_u32 vcc, 0, v57
    v_mfma_f32_16x16x32_bf16 v[152:155], a[180:183], v[100:103], v[152:155]
    v_mfma_f32_16x16x32_bf16 v[152:155], a[176:179], v[96:99], v[152:155]
    s_cbranch_vccnz k2_tramp_112
k2_ret_113:
    v_mfma_f32_16x16x32_bf16 v[248:251], v[60:63], v[208:211], v[248:251]
    v_exp_f32 v232, v128
    v_mfma_f32_16x16x32_bf16 v[248:251], v[60:63], v[216:219], v[248:251]
    s_mov_b32 m0, s35
    ds_read_b128 a[224:227], v3 offset:4096
    v_mfma_f32_16x16x32_bf16 v[252:255], v[60:63], v[220:223], v[252:255]
    s_add_u32 s53, s53, 16384
    buffer_load_dwordx4 v1, s[20:23], s33 offen offset:0 sc1 lds
    ds_read_b128 a[228:231], v3 offset:12288
    v_mfma_f32_16x16x32_bf16 v[252:255], v[60:63], v[212:215], v[252:255]
    s_waitcnt lgkmcnt(8)
    v_exp_f32 v233, v129
    v_mfma_f32_16x16x32_bf16 a[12:15], a[192:195], v[212:215], a[12:15]
    s_and_b32 s53, s53, 0xffff
    v_exp_f32 v234, v130
    v_mfma_f32_16x16x32_bf16 a[12:15], a[196:199], v[220:223], a[12:15]
    ds_read_b128 a[232:235], v3 offset:5120
    v_cvt_pk_bf16_f32 v192, v232, v233
    v_mfma_f32_16x16x32_bf16 a[8:11], a[196:199], v[216:219], a[8:11]
    v_exp_f32 v235, v131
    v_mfma_f32_16x16x32_bf16 a[8:11], a[192:195], v[208:211], a[8:11]
    s_waitcnt lgkmcnt(7)
    ds_read_b128 a[236:239], v3 offset:13312
    v_cvt_pk_bf16_f32 v193, v234, v235
    v_mfma_f32_16x16x32_bf16 a[24:27], a[200:203], v[208:211], a[24:27]
    s_add_u32 s35, s35, 0x4000
    v_exp_f32 v236, v144
    v_mfma_f32_16x16x32_bf16 a[24:27], a[204:207], v[216:219], a[24:27]
    buffer_load_dwordx4 v1, s[20:23], s33 offen offset:1024 sc1 lds
    ds_read_b128 a[240:243], v3 offset:6144
    v_mfma_f32_16x16x32_bf16 a[28:31], a[204:207], v[220:223], a[28:31]
    v_exp_f32 v237, v145
    v_mfma_f32_16x16x32_bf16 a[28:31], a[200:203], v[212:215], a[28:31]
    s_waitcnt lgkmcnt(7)
    ds_read_b128 a[244:247], v3 offset:14336
    v_cvt_pk_bf16_f32 v194, v236, v237
    v_mfma_f32_16x16x32_bf16 a[44:47], a[208:211], v[212:215], a[44:47]
    v_exp_f32 v238, v146
    v_mfma_f32_16x16x32_bf16 a[44:47], a[212:215], v[220:223], a[44:47]
    ds_read_b128 a[248:251], v3 offset:7168
    v_or3_b32 v57, v192, v193, v194
    v_mfma_f32_16x16x32_bf16 a[40:43], a[212:215], v[216:219], a[40:43]
    v_exp_f32 v239, v147
    v_mfma_f32_16x16x32_bf16 a[40:43], a[208:211], v[208:211], a[40:43]
    s_waitcnt lgkmcnt(7)
    ds_read_b128 a[252:255], v3 offset:15360
    v_cvt_pk_bf16_f32 v195, v238, v239
    v_mfma_f32_16x16x32_bf16 a[56:59], a[216:219], v[208:211], a[56:59]
    s_and_b32 s35, s35, 0xffff
    v_exp_f32 v240, v132
    v_mfma_f32_16x16x32_bf16 a[56:59], a[220:223], v[216:219], a[56:59]
    ds_read_b128 a[128:131], v2 offset:0
    v_add_u32 v3, s53, v56
    v_mfma_f32_16x16x32_bf16 a[60:63], a[220:223], v[220:223], a[60:63]
    v_exp_f32 v241, v133
    v_mfma_f32_16x16x32_bf16 a[60:63], a[216:219], v[212:215], a[60:63]
    s_waitcnt lgkmcnt(7)
    buffer_load_dwordx4 v1, s[20:23], s33 offen offset:2048 sc1 lds
    ds_read_b128 a[132:135], v2 offset:1024
    v_mfma_f32_16x16x32_bf16 a[76:79], a[224:227], v[212:215], a[76:79]
    v_exp_f32 v242, v134
    v_mfma_f32_16x16x32_bf16 a[76:79], a[228:231], v[220:223], a[76:79]
    s_or_b32 s35, s35, 0x10000
    ds_read_b128 a[136:139], v2 offset:2048
    v_cvt_pk_bf16_f32 v196, v240, v241
    v_mfma_f32_16x16x32_bf16 a[72:75], a[228:231], v[216:219], a[72:75]
    v_exp_f32 v243, v135
    v_mfma_f32_16x16x32_bf16 a[72:75], a[224:227], v[208:211], a[72:75]
    s_waitcnt lgkmcnt(7)
    ds_read_b128 a[140:143], v2 offset:3072
    v_or3_b32 v57, v57, v195, v196
    v_mfma_f32_16x16x32_bf16 a[88:91], a[232:235], v[208:211], a[88:91]
    v_exp_f32 v244, v148
    v_mfma_f32_16x16x32_bf16 a[88:91], a[236:239], v[216:219], a[88:91]
    ds_read_b128 a[144:147], v2 offset:4096
    v_cvt_pk_bf16_f32 v197, v242, v243
    v_mfma_f32_16x16x32_bf16 a[92:95], a[236:239], v[220:223], a[92:95]
    v_exp_f32 v245, v149
    v_mfma_f32_16x16x32_bf16 a[92:95], a[232:235], v[212:215], a[92:95]
    s_waitcnt lgkmcnt(7)
    buffer_load_dwordx4 v1, s[20:23], s33 offen offset:3072 sc1 lds
    ds_read_b128 a[148:151], v2 offset:5120
    v_mfma_f32_16x16x32_bf16 a[108:111], a[240:243], v[212:215], a[108:111]
    s_add_u32 s33, s33, 0x80000
    v_exp_f32 v246, v150
    v_mfma_f32_16x16x32_bf16 a[108:111], a[244:247], v[220:223], a[108:111]
    ds_read_b128 a[152:155], v2 offset:6144
    v_cvt_pk_bf16_f32 v198, v244, v245
    v_mfma_f32_16x16x32_bf16 a[104:107], a[244:247], v[216:219], a[104:107]
    v_exp_f32 v247, v151
    v_mfma_f32_16x16x32_bf16 a[104:107], a[240:243], v[208:211], a[104:107]
    s_waitcnt lgkmcnt(7)
    ds_read_b128 a[156:159], v2 offset:7168
    v_or3_b32 v57, v57, v197, v198
    v_mfma_f32_16x16x32_bf16 a[120:123], a[248:251], v[208:211], a[120:123]
    v_exp_f32 v232, v136
    v_mfma_f32_16x16x32_bf16 a[120:123], a[252:255], v[216:219], a[120:123]
    ds_read_b128 a[160:163], v2 offset:8192
    v_cvt_pk_bf16_f32 v199, v246, v247
    v_mfma_f32_16x16x32_bf16 a[124:127], a[252:255], v[220:223], a[124:127]
    v_exp_f32 v233, v137
    v_mfma_f32_16x16x32_bf16 a[124:127], a[248:251], v[212:215], a[124:127]
    s_waitcnt lgkmcnt(7)
    ds_read_b128 a[164:167], v2 offset:9216
    v_cvt_pk_bf16_f32 v200, v232, v233
    v_mfma_f32_16x16x32_bf16 v[160:163], a[128:131], v[96:99], v[16:19]
    s_waitcnt vmcnt(12)
    s_barrier
    v_exp_f32 v234, v138
    v_mfma_f32_16x16x32_bf16 v[160:163], a[132:135], v[100:103], v[160:163]
    s_waitcnt lgkmcnt(6)
    ds_read_b128 a[168:171], v2 offset:10240
    v_or3_b32 v57, v57, v199, v200
    v_mfma_f32_16x16x32_bf16 v[160:163], a[136:139], v[104:107], v[160:163]
    s_mov_b32 m0, s34
    v_exp_f32 v235, v139
    v_mfma_f32_16x16x32_bf16 v[160:163], a[140:143], v[108:111], v[160:163]
    s_add_u32 s36, s36, 64
    buffer_load_dwordx4 v1, s[16:19], s32 offen offset:0 sc1 lds
    ds_read_b128 a[172:175], v2 offset:11264
    v_mfma_f32_16x16x32_bf16 v[164:167], a[140:143], v[124:127], v[20:23]
    v_exp_f32 v236, v152
    v_mfma_f32_16x16x32_bf16 v[164:167], a[136:139], v[120:123], v[164:167]
    ds_read_b128 a[176:179], v2 offset:12288
    v_cvt_pk_bf16_f32 v201, v234, v235
    v_mfma_f32_16x16x32_bf16 v[164:167], a[132:135], v[116:119], v[164:167]
    s_add_u32 s52, s52, 16384
    v_exp_f32 v237, v153
    v_mfma_f32_16x16x32_bf16 v[164:167], a[128:131], v[112:115], v[164:167]
    s_waitcnt lgkmcnt(7)
    ds_read_b128 a[180:183], v2 offset:13312
    v_cvt_pk_bf16_f32 v202, v236, v237
    v_mfma_f32_16x16x32_bf16 v[180:183], a[144:147], v[112:115], v[36:39]
    s_add_u32 s34, s34, 0x4000
    v_exp_f32 v238, v154
    v_mfma_f32_16x16x32_bf16 v[180:183], a[148:151], v[116:119], v[180:183]
    s_waitcnt lgkmcnt(6)
    buffer_load_dwordx4 v1, s[16:19], s32 offen offset:1024 sc1 lds
    ds_read_b128 a[184:187], v2 offset:14336
    v_mfma_f32_16x16x32_bf16 v[180:183], a[152:155], v[120:123], v[180:183]
    s_and_b32 s52, s52, 0xffff
    v_exp_f32 v239, v155
    v_mfma_f32_16x16x32_bf16 v[180:183], a[156:159], v[124:127], v[180:183]
    ds_read_b128 a[188:191], v2 offset:15360
    v_or3_b32 v57, v57, v201, v202
    v_mfma_f32_16x16x32_bf16 v[176:179], a[156:159], v[108:111], v[32:35]
    v_exp_f32 v240, v140
    v_mfma_f32_16x16x32_bf16 v[176:179], a[152:155], v[104:107], v[176:179]
    v_cvt_pk_bf16_f32 v203, v238, v239
    v_add_u32 v2, s52, v1
    v_mfma_f32_16x16x32_bf16 v[176:179], a[148:151], v[100:103], v[176:179]
    s_and_b32 s34, s34, 0xffff
    v_exp_f32 v241, v141
    v_mfma_f32_16x16x32_bf16 v[176:179], a[144:147], v[96:99], v[176:179]
    s_waitcnt lgkmcnt(6)
    ds_read_b128 a[192:195], v3 offset:0
    v_cvt_pk_bf16_f32 v204, v240, v241
    v_mfma_f32_16x16x32_bf16 v[168:171], a[160:163], v[96:99], v[24:27]
    v_exp_f32 v242, v142
    v_mfma_f32_16x16x32_bf16 v[168:171], a[164:167], v[100:103], v[168:171]
    s_waitcnt lgkmcnt(5)
    buffer_load_dwordx4 v1, s[16:19], s32 offen offset:2048 sc1 lds
    ds_read_b128 a[196:199], v3 offset:8192
    v_mfma_f32_16x16x32_bf16 v[168:171], a[168:171], v[104:107], v[168:171]
    v_exp_f32 v243, v143
    v_mfma_f32_16x16x32_bf16 v[168:171], a[172:175], v[108:111], v[168:171]
    ds_read_b128 a[200:203], v3 offset:1024
    v_or3_b32 v57, v57, v203, v204
    v_mfma_f32_16x16x32_bf16 v[172:175], a[172:175], v[124:127], v[28:31]
    v_exp_f32 v244, v156
    v_mfma_f32_16x16x32_bf16 v[172:175], a[168:171], v[120:123], v[172:175]
    ds_read_b128 a[204:207], v3 offset:9216
    v_cvt_pk_bf16_f32 v205, v242, v243
    v_mfma_f32_16x16x32_bf16 v[172:175], a[164:167], v[116:119], v[172:175]
    v_exp_f32 v245, v157
    v_mfma_f32_16x16x32_bf16 v[172:175], a[160:163], v[112:115], v[172:175]
    s_waitcnt lgkmcnt(6)
    buffer_load_dwordx4 v1, s[16:19], s32 offen offset:3072 sc1 lds
    ds_read_b128 a[208:211], v3 offset:2048
    v_mfma_f32_16x16x32_bf16 v[188:191], a[176:179], v[112:115], v[44:47]
    s_sub_u32 s63, s63, 1
    v_exp_f32 v246, v158
    v_mfma_f32_16x16x32_bf16 v[188:191], a[180:183], v[116:119], v[188:191]
    s_waitcnt lgkmcnt(5)
    ds_read_b128 a[212:215], v3 offset:10240
    v_cvt_pk_bf16_f32 v206, v244, v245
    v_mfma_f32_16x16x32_bf16 v[188:191], a[184:187], v[120:123], v[188:191]
    s_add_u32 s32, s32, 0x80000
    v_exp_f32 v247, v159
    v_mfma_f32_16x16x32_bf16 v[188:191], a[188:191], v[124:127], v[188:191]
    ds_read_b128 a[216:219], v3 offset:3072
    v_or3_b32 v57, v57, v205, v206
    v_mfma_f32_16x16x32_bf16 v[184:187], a[188:191], v[108:111], v[40:43]
    ds_read_b128 a[220:223], v3 offset:11264
    v_cvt_pk_bf16_f32 v207, v246, v247
    v_mfma_f32_16x16x32_bf16 v[184:187], a[184:187], v[104:107], v[184:187]
    v_bitop3_b32 v57, v57, v207, s37 bitop3:0xa8
    v_cmp_ne_u32 vcc, 0, v57
    v_mfma_f32_16x16x32_bf16 v[184:187], a[180:183], v[100:103], v[184:187]
    v_mfma_f32_16x16x32_bf16 v[184:187], a[176:179], v[96:99], v[184:187]
    s_cbranch_vccnz k2_tramp_114
k2_ret_115:
    s_cmp_lg_u32 s63, 0
    s_cbranch_scc1 k2_sloop_110
    v_mfma_f32_16x16x32_bf16 v[248:251], v[60:63], v[192:195], v[248:251]
    v_exp_f32 v232, v160
    v_mfma_f32_16x16x32_bf16 v[248:251], v[60:63], v[200:203], v[248:251]
    s_mov_b32 m0, s35
    ds_read_b128 a[224:227], v3 offset:4096
    v_exp_f32 v233, v161
    v_mfma_f32_16x16x32_bf16 v[252:255], v[60:63], v[204:207], v[252:255]
    s_add_u32 s53, s53, 16384
    buffer_load_dwordx4 v1, s[20:23], s33 offen offset:0 sc1 lds
    ds_read_b128 a[228:231], v3 offset:12288
    v_mfma_f32_16x16x32_bf16 v[252:255], v[60:63], v[196:199], v[252:255]
    s_waitcnt lgkmcnt(8)
    v_exp_f32 v234, v162
    v_cvt_pk_bf16_f32 v208, v232, v233
    v_mfma_f32_16x16x32_bf16 a[12:15], a[192:195], v[196:199], a[12:15]
    s_sub_u32 s40, s36, s39
    ds_read_b128 a[232:235], v3 offset:5120
    v_mfma_f32_16x16x32_bf16 a[12:15], a[196:199], v[204:207], a[12:15]
    s_and_b32 s53, s53, 0xffff
    v_subrev_u32 v6, s40, v4
    v_cmp_gt_i32 s[44:45], 0, v6
    v_mfma_f32_16x16x32_bf16 a[8:11], a[196:199], v[200:203], a[8:11]
    v_exp_f32 v235, v163
    v_cmp_gt_i32 s[46:47], 1, v6
    v_mfma_f32_16x16x32_bf16 a[8:11], a[192:195], v[192:195], a[8:11]
    s_waitcnt lgkmcnt(7)
    ds_read_b128 a[236:239], v3 offset:13312
    v_cmp_gt_i32 s[48:49], 2, v6
    v_cmp_gt_i32 s[50:51], 3, v6
    v_mfma_f32_16x16x32_bf16 a[24:27], a[200:203], v[192:195], a[24:27]
    s_add_u32 s35, s35, 0x4000
    v_exp_f32 v236, v176
    v_mfma_f32_16x16x32_bf16 a[24:27], a[204:207], v[200:203], a[24:27]
    ds_read_b128 a[240:243], v3 offset:6144
    v_cvt_pk_bf16_f32 v209, v234, v235
    v_cndmask_b32 v16, v10, v5, s[44:45]
    v_mfma_f32_16x16x32_bf16 a[28:31], a[204:207], v[204:207], a[28:31]
    v_exp_f32 v237, v177
    v_mfma_f32_16x16x32_bf16 a[28:31], a[200:203], v[196:199], a[28:31]
    s_waitcnt lgkmcnt(7)
    ds_read_b128 a[244:247], v3 offset:14336
    v_cndmask_b32 v17, v10, v5, s[46:47]
    v_cndmask_b32 v18, v10, v5, s[48:49]
    v_mfma_f32_16x16x32_bf16 a[44:47], a[208:211], v[196:199], a[44:47]
    buffer_load_dwordx4 v1, s[20:23], s33 offen offset:1024 sc1 lds
    ds_read_b128 a[248:251], v3 offset:7168
    v_mfma_f32_16x16x32_bf16 a[44:47], a[212:215], v[204:207], a[44:47]
    v_cndmask_b32 v19, v10, v5, s[50:51]
    v_cvt_pk_bf16_f32 v210, v236, v237
    v_mfma_f32_16x16x32_bf16 a[40:43], a[212:215], v[200:203], a[40:43]
    v_exp_f32 v238, v178
    v_cmp_gt_i32 s[44:45], 16, v6
    v_mfma_f32_16x16x32_bf16 a[40:43], a[208:211], v[192:195], a[40:43]
    s_waitcnt lgkmcnt(7)
    v_cmp_gt_i32 s[46:47], 17, v6
    v_cmp_gt_i32 s[48:49], 18, v6
    v_mfma_f32_16x16x32_bf16 a[56:59], a[216:219], v[192:195], a[56:59]
    s_and_b32 s35, s35, 0xffff
    v_exp_f32 v239, v179
    v_mfma_f32_16x16x32_bf16 a[56:59], a[220:223], v[200:203], a[56:59]
    ds_read_b128 a[252:255], v3 offset:15360
    v_or3_b32 v57, v208, v209, v210
    v_cmp_gt_i32 s[50:51], 19, v6
    v_mfma_f32_16x16x32_bf16 a[60:63], a[220:223], v[204:207], a[60:63]
    v_exp_f32 v240, v164
    v_mfma_f32_16x16x32_bf16 a[60:63], a[216:219], v[196:199], a[60:63]
    s_waitcnt lgkmcnt(6)
    v_cndmask_b32 v32, v10, v5, s[44:45]
    v_cvt_pk_bf16_f32 v211, v238, v239
    v_cndmask_b32 v33, v10, v5, s[46:47]
    v_mfma_f32_16x16x32_bf16 a[76:79], a[224:227], v[196:199], a[76:79]
    ds_read_b128 a[128:131], v2 offset:0
    v_cndmask_b32 v34, v10, v5, s[48:49]
    v_mfma_f32_16x16x32_bf16 a[76:79], a[228:231], v[204:207], a[76:79]
    s_or_b32 s35, s35, 0x10000
    v_add_u32 v3, s53, v56
    v_cndmask_b32 v35, v10, v5, s[50:51]
    v_mfma_f32_16x16x32_bf16 a[72:75], a[228:231], v[200:203], a[72:75]
    buffer_load_dwordx4 v1, s[20:23], s33 offen offset:2048 sc1 lds
    v_exp_f32 v241, v165
    v_mfma_f32_16x16x32_bf16 a[72:75], a[224:227], v[192:195], a[72:75]
    s_waitcnt lgkmcnt(5)
    ds_read_b128 a[132:135], v2 offset:1024
    v_cmp_gt_i32 s[44:45], 32, v6
    v_mfma_f32_16x16x32_bf16 a[88:91], a[232:235], v[192:195], a[88:91]
    v_exp_f32 v242, v166
    v_cmp_gt_i32 s[46:47], 33, v6
    v_mfma_f32_16x16x32_bf16 a[88:91], a[236:239], v[200:203], a[88:91]
    ds_read_b128 a[136:139], v2 offset:2048
    v_cvt_pk_bf16_f32 v212, v240, v241
    v_mfma_f32_16x16x32_bf16 a[92:95], a[236:239], v[204:207], a[92:95]
    v_cmp_gt_i32 s[48:49], 34, v6
    v_cmp_gt_i32 s[50:51], 35, v6
    v_mfma_f32_16x16x32_bf16 a[92:95], a[232:235], v[196:199], a[92:95]
    s_waitcnt lgkmcnt(5)
    v_exp_f32 v243, v167
    v_or3_b32 v57, v57, v211, v212
    v_mfma_f32_16x16x32_bf16 a[108:111], a[240:243], v[196:199], a[108:111]
    ds_read_b128 a[140:143], v2 offset:3072
    v_cndmask_b32 v24, v10, v5, s[44:45]
    v_mfma_f32_16x16x32_bf16 a[108:111], a[244:247], v[204:207], a[108:111]
    v_cndmask_b32 v25, v10, v5, s[46:47]
    v_exp_f32 v244, v180
    v_mfma_f32_16x16x32_bf16 a[104:107], a[244:247], v[200:203], a[104:107]
    v_cvt_pk_bf16_f32 v213, v242, v243
    v_cndmask_b32 v26, v10, v5, s[48:49]
    v_mfma_f32_16x16x32_bf16 a[104:107], a[240:243], v[192:195], a[104:107]
    s_waitcnt lgkmcnt(4)
    ds_read_b128 a[144:147], v2 offset:4096
    v_cndmask_b32 v27, v10, v5, s[50:51]
    v_mfma_f32_16x16x32_bf16 a[120:123], a[248:251], v[192:195], a[120:123]
    v_exp_f32 v245, v181
    v_cmp_gt_i32 s[44:45], 48, v6
    v_mfma_f32_16x16x32_bf16 a[120:123], a[252:255], v[200:203], a[120:123]
    buffer_load_dwordx4 v1, s[20:23], s33 offen offset:3072 sc1 lds
    ds_read_b128 a[148:151], v2 offset:5120
    ds_read_b128 a[152:155], v2 offset:6144
    v_cmp_gt_i32 s[46:47], 49, v6
    s_add_u32 s33, s33, 0x80000
    v_cmp_gt_i32 s[48:49], 50, v6
    v_exp_f32 v246, v182
    v_cvt_pk_bf16_f32 v214, v244, v245
    v_cmp_gt_i32 s[50:51], 51, v6
    v_cndmask_b32 v40, v10, v5, s[44:45]
    v_mfma_f32_16x16x32_bf16 a[124:127], a[252:255], v[204:207], a[124:127]
    v_exp_f32 v247, v183
    v_or3_b32 v57, v57, v213, v214
    v_cndmask_b32 v41, v10, v5, s[46:47]
    v_mfma_f32_16x16x32_bf16 a[124:127], a[248:251], v[196:199], a[124:127]
    s_waitcnt lgkmcnt(5)
    ds_read_b128 a[156:159], v2 offset:7168
    v_cndmask_b32 v42, v10, v5, s[48:49]
    v_cndmask_b32 v43, v10, v5, s[50:51]
    v_mfma_f32_16x16x32_bf16 v[128:131], a[128:131], v[96:99], v[16:19]
    s_waitcnt vmcnt(4)
    s_barrier
    v_exp_f32 v232, v168
    v_mfma_f32_16x16x32_bf16 v[128:131], a[132:135], v[100:103], v[128:131]
    s_waitcnt lgkmcnt(4)
    ds_read_b128 a[160:163], v2 offset:8192
    v_cvt_pk_bf16_f32 v215, v246, v247
    v_mfma_f32_16x16x32_bf16 v[128:131], a[136:139], v[104:107], v[128:131]
    v_exp_f32 v233, v169
    v_mfma_f32_16x16x32_bf16 v[128:131], a[140:143], v[108:111], v[128:131]
    s_add_u32 s36, s36, 64
    ds_read_b128 a[164:167], v2 offset:9216
    v_cvt_pk_bf16_f32 v216, v232, v233
    v_mfma_f32_16x16x32_bf16 v[132:135], a[140:143], v[124:127], v[20:23]
    v_exp_f32 v234, v170
    v_mfma_f32_16x16x32_bf16 v[132:135], a[136:139], v[120:123], v[132:135]
    ds_read_b128 a[168:171], v2 offset:10240
    v_or3_b32 v57, v57, v215, v216
    v_mfma_f32_16x16x32_bf16 v[132:135], a[132:135], v[116:119], v[132:135]
    s_add_u32 s52, s52, 16384
    v_exp_f32 v235, v171
    v_mfma_f32_16x16x32_bf16 v[132:135], a[128:131], v[112:115], v[132:135]
    s_waitcnt lgkmcnt(5)
    ds_read_b128 a[172:175], v2 offset:11264
    v_cvt_pk_bf16_f32 v217, v234, v235
    v_mfma_f32_16x16x32_bf16 v[148:151], a[144:147], v[112:115], v[36:39]
    s_and_b32 s52, s52, 0xffff
    v_exp_f32 v236, v184
    v_mfma_f32_16x16x32_bf16 v[148:151], a[148:151], v[116:119], v[148:151]
    s_waitcnt lgkmcnt(4)
    ds_read_b128 a[176:179], v2 offset:12288
    ds_read_b128 a[180:183], v2 offset:13312
    v_mfma_f32_16x16x32_bf16 v[148:151], a[152:155], v[120:123], v[148:151]
    v_exp_f32 v237, v185
    v_mfma_f32_16x16x32_bf16 v[148:151], a[156:159], v[124:127], v[148:151]
    v_exp_f32 v238, v186
    v_mfma_f32_16x16x32_bf16 v[144:147], a[156:159], v[108:111], v[32:35]
    ds_read_b128 a[184:187], v2 offset:14336
    v_cvt_pk_bf16_f32 v218, v236, v237
    v_mfma_f32_16x16x32_bf16 v[144:147], a[152:155], v[104:107], v[144:147]
    v_exp_f32 v239, v187
    v_mfma_f32_16x16x32_bf16 v[144:147], a[148:151], v[100:103], v[144:147]
    ds_read_b128 a[188:191], v2 offset:15360
    v_or3_b32 v57, v57, v217, v218
    v_mfma_f32_16x16x32_bf16 v[144:147], a[144:147], v[96:99], v[144:147]
    s_waitcnt lgkmcnt(6)
    v_exp_f32 v240, v172
    v_mfma_f32_16x16x32_bf16 v[136:139], a[160:163], v[96:99], v[24:27]
    v_cvt_pk_bf16_f32 v219, v238, v239
    v_add_u32 v2, s52, v1
    v_mfma_f32_16x16x32_bf16 v[136:139], a[164:167], v[100:103], v[136:139]
    s_waitcnt lgkmcnt(4)
    v_exp_f32 v241, v173
    v_mfma_f32_16x16x32_bf16 v[136:139], a[168:171], v[104:107], v[136:139]
    ds_read_b128 a[192:195], v3 offset:0
    v_cvt_pk_bf16_f32 v220, v240, v241
    v_mfma_f32_16x16x32_bf16 v[136:139], a[172:175], v[108:111], v[136:139]
    v_exp_f32 v242, v174
    v_mfma_f32_16x16x32_bf16 v[140:143], a[172:175], v[124:127], v[28:31]
    ds_read_b128 a[196:199], v3 offset:8192
    v_or3_b32 v57, v57, v219, v220
    v_mfma_f32_16x16x32_bf16 v[140:143], a[168:171], v[120:123], v[140:143]
    v_exp_f32 v243, v175
    v_mfma_f32_16x16x32_bf16 v[140:143], a[164:167], v[116:119], v[140:143]
    ds_read_b128 a[200:203], v3 offset:1024
    v_cvt_pk_bf16_f32 v221, v242, v243
    v_mfma_f32_16x16x32_bf16 v[140:143], a[160:163], v[112:115], v[140:143]
    s_waitcnt lgkmcnt(5)
    v_exp_f32 v244, v188
    v_mfma_f32_16x16x32_bf16 v[156:159], a[176:179], v[112:115], v[44:47]
    ds_read_b128 a[204:207], v3 offset:9216
    ds_read_b128 a[208:211], v3 offset:2048
    v_mfma_f32_16x16x32_bf16 v[156:159], a[180:183], v[116:119], v[156:159]
    s_waitcnt lgkmcnt(5)
    v_exp_f32 v245, v189
    v_mfma_f32_16x16x32_bf16 v[156:159], a[184:187], v[120:123], v[156:159]
    v_exp_f32 v246, v190
    v_mfma_f32_16x16x32_bf16 v[156:159], a[188:191], v[124:127], v[156:159]
    ds_read_b128 a[212:215], v3 offset:10240
    v_cvt_pk_bf16_f32 v222, v244, v245
    v_mfma_f32_16x16x32_bf16 v[152:155], a[188:191], v[108:111], v[40:43]
    v_exp_f32 v247, v191
    v_mfma_f32_16x16x32_bf16 v[152:155], a[184:187], v[104:107], v[152:155]
    ds_read_b128 a[216:219], v3 offset:3072
    v_or3_b32 v57, v57, v221, v222
    v_mfma_f32_16x16x32_bf16 v[152:155], a[180:183], v[100:103], v[152:155]
    ds_read_b128 a[220:223], v3 offset:11264
    v_cvt_pk_bf16_f32 v223, v246, v247
    v_bitop3_b32 v57, v57, v223, s37 bitop3:0xa8
    v_mfma_f32_16x16x32_bf16 v[152:155], a[176:179], v[96:99], v[152:155]
    v_cmp_ne_u32 vcc, 0, v57
    s_cbranch_vccnz k2_tramp_116
k2_ret_117:
    v_mfma_f32_16x16x32_bf16 v[248:251], v[60:63], v[208:211], v[248:251]
    ds_read_b128 a[224:227], v3 offset:4096
    v_exp_f32 v232, v128
    v_mfma_f32_16x16x32_bf16 v[248:251], v[60:63], v[216:219], v[248:251]
    v_exp_f32 v233, v129
    v_mfma_f32_16x16x32_bf16 v[252:255], v[60:63], v[220:223], v[252:255]
    s_add_u32 s53, s53, 16384
    ds_read_b128 a[228:231], v3 offset:12288
    v_exp_f32 v234, v130
    v_mfma_f32_16x16x32_bf16 v[252:255], v[60:63], v[212:215], v[252:255]
    s_waitcnt lgkmcnt(8)
    v_cvt_pk_bf16_f32 v192, v232, v233
    v_exp_f32 v235, v131
    v_mfma_f32_16x16x32_bf16 a[12:15], a[192:195], v[212:215], a[12:15]
    s_sub_u32 s40, s36, s39
    s_sub_u32 s40, s40, 64
    ds_read_b128 a[232:235], v3 offset:5120
    v_mfma_f32_16x16x32_bf16 a[12:15], a[196:199], v[220:223], a[12:15]
    s_and_b32 s53, s53, 0xffff
    v_subrev_u32 v6, s40, v4
    v_cmp_gt_i32 s[44:45], 0, v6
    v_cvt_pk_bf16_f32 v193, v234, v235
    v_mfma_f32_16x16x32_bf16 a[8:11], a[196:199], v[216:219], a[8:11]
    v_exp_f32 v236, v144
    v_cmp_gt_i32 s[46:47], 1, v6
    v_mfma_f32_16x16x32_bf16 a[8:11], a[192:195], v[208:211], a[8:11]
    s_waitcnt lgkmcnt(7)
    ds_read_b128 a[236:239], v3 offset:13312
    v_exp_f32 v237, v145
    v_mfma_f32_16x16x32_bf16 a[24:27], a[200:203], v[208:211], a[24:27]
    ds_read_b128 a[240:243], v3 offset:6144
    v_cmp_gt_i32 s[48:49], 2, v6
    v_cmp_gt_i32 s[50:51], 3, v6
    v_mfma_f32_16x16x32_bf16 a[24:27], a[204:207], v[216:219], a[24:27]
    v_exp_f32 v238, v146
    v_cndmask_b32 v20, v11, v5, s[44:45]
    v_mfma_f32_16x16x32_bf16 a[28:31], a[204:207], v[220:223], a[28:31]
    v_cvt_pk_bf16_f32 v194, v236, v237
    v_cndmask_b32 v21, v11, v5, s[46:47]
    v_or3_b32 v57, v192, v193, v194
    v_mfma_f32_16x16x32_bf16 a[28:31], a[200:203], v[212:215], a[28:31]
    s_waitcnt lgkmcnt(7)
    v_exp_f32 v239, v147
    v_cndmask_b32 v22, v11, v5, s[48:49]
    v_mfma_f32_16x16x32_bf16 a[44:47], a[208:211], v[212:215], a[44:47]
    ds_read_b128 a[244:247], v3 offset:14336
    v_cndmask_b32 v23, v11, v5, s[50:51]
    v_cvt_pk_bf16_f32 v195, v238, v239
    v_mfma_f32_16x16x32_bf16 a[44:47], a[212:215], v[220:223], a[44:47]
    v_exp_f32 v240, v132
    v_cmp_gt_i32 s[44:45], 16, v6
    v_mfma_f32_16x16x32_bf16 a[40:43], a[212:215], v[216:219], a[40:43]
    ds_read_b128 a[248:251], v3 offset:7168
    v_cmp_gt_i32 s[46:47], 17, v6
    v_cmp_gt_i32 s[48:49], 18, v6
    v_mfma_f32_16x16x32_bf16 a[40:43], a[208:211], v[208:211], a[40:43]
    s_waitcnt lgkmcnt(7)
    ds_read_b128 a[252:255], v3 offset:15360
    v_exp_f32 v241, v133
    v_mfma_f32_16x16x32_bf16 a[56:59], a[216:219], v[208:211], a[56:59]
    v_exp_f32 v242, v134
    v_cmp_gt_i32 s[50:51], 19, v6
    v_mfma_f32_16x16x32_bf16 a[56:59], a[220:223], v[216:219], a[56:59]
    v_cvt_pk_bf16_f32 v196, v240, v241
    v_cndmask_b32 v36, v11, v5, s[44:45]
    v_or3_b32 v57, v57, v195, v196
    v_mfma_f32_16x16x32_bf16 a[60:63], a[220:223], v[220:223], a[60:63]
    v_exp_f32 v243, v135
    v_cndmask_b32 v37, v11, v5, s[46:47]
    v_mfma_f32_16x16x32_bf16 a[60:63], a[216:219], v[212:215], a[60:63]
    s_waitcnt lgkmcnt(6)
    ds_read_b128 a[128:131], v2 offset:0
    v_cndmask_b32 v38, v11, v5, s[48:49]
    v_add_u32 v3, s53, v56
    v_mfma_f32_16x16x32_bf16 a[76:79], a[224:227], v[212:215], a[76:79]
    ds_read_b128 a[132:135], v2 offset:1024
    v_exp_f32 v244, v148
    v_mfma_f32_16x16x32_bf16 a[76:79], a[228:231], v[220:223], a[76:79]
    ds_read_b128 a[136:139], v2 offset:2048
    v_cvt_pk_bf16_f32 v197, v242, v243
    v_cndmask_b32 v39, v11, v5, s[50:51]
    v_mfma_f32_16x16x32_bf16 a[72:75], a[228:231], v[216:219], a[72:75]
    v_cmp_gt_i32 s[44:45], 32, v6
    v_exp_f32 v245, v149
    v_mfma_f32_16x16x32_bf16 a[72:75], a[224:227], v[208:211], a[72:75]
    s_waitcnt lgkmcnt(7)
    ds_read_b128 a[140:143], v2 offset:3072
    ds_read_b128 a[144:147], v2 offset:4096
    v_cmp_gt_i32 s[46:47], 33, v6
    v_mfma_f32_16x16x32_bf16 a[88:91], a[232:235], v[208:211], a[88:91]
    v_exp_f32 v246, v150
    v_cmp_gt_i32 s[48:49], 34, v6
    v_mfma_f32_16x16x32_bf16 a[88:91], a[236:239], v[216:219], a[88:91]
    ds_read_b128 a[148:151], v2 offset:5120
    v_cvt_pk_bf16_f32 v198, v244, v245
    v_cmp_gt_i32 s[50:51], 35, v6
    v_mfma_f32_16x16x32_bf16 a[92:95], a[236:239], v[220:223], a[92:95]
    v_exp_f32 v247, v151
    v_or3_b32 v57, v57, v197, v198
    v_mfma_f32_16x16x32_bf16 a[92:95], a[232:235], v[212:215], a[92:95]
    s_waitcnt lgkmcnt(8)
    ds_read_b128 a[152:155], v2 offset:6144
    v_cndmask_b32 v28, v11, v5, s[44:45]
    v_cndmask_b32 v29, v11, v5, s[46:47]
    v_mfma_f32_16x16x32_bf16 a[108:111], a[240:243], v[212:215], a[108:111]
    ds_read_b128 a[156:159], v2 offset:7168
    v_exp_f32 v232, v136
    v_mfma_f32_16x16x32_bf16 a[108:111], a[244:247], v[220:223], a[108:111]
    ds_read_b128 a[160:163], v2 offset:8192
    v_cvt_pk_bf16_f32 v199, v246, v247
    v_cndmask_b32 v30, v11, v5, s[48:49]
    v_mfma_f32_16x16x32_bf16 a[104:107], a[244:247], v[216:219], a[104:107]
    v_cndmask_b32 v31, v11, v5, s[50:51]
    v_exp_f32 v233, v137
    v_mfma_f32_16x16x32_bf16 a[104:107], a[240:243], v[208:211], a[104:107]
    s_waitcnt lgkmcnt(9)
    ds_read_b128 a[164:167], v2 offset:9216
    ds_read_b128 a[168:171], v2 offset:10240
    v_cmp_gt_i32 s[44:45], 48, v6
    v_mfma_f32_16x16x32_bf16 a[120:123], a[248:251], v[208:211], a[120:123]
    v_exp_f32 v234, v138
    v_cmp_gt_i32 s[46:47], 49, v6
    v_mfma_f32_16x16x32_bf16 a[120:123], a[252:255], v[216:219], a[120:123]
    ds_read_b128 a[172:175], v2 offset:11264
    ds_read_b128 a[176:179], v2 offset:12288
    v_cvt_pk_bf16_f32 v200, v232, v233
    v_cmp_gt_i32 s[48:49], 50, v6
    v_exp_f32 v235, v139
    v_cmp_gt_i32 s[50:51], 51, v6
    v_or3_b32 v57, v57, v199, v200
    v_cndmask_b32 v44, v11, v5, s[44:45]
    v_mfma_f32_16x16x32_bf16 a[124:127], a[252:255], v[220:223], a[124:127]
    ds_read_b128 a[180:183], v2 offset:13312
    v_exp_f32 v236, v152
    v_cvt_pk_bf16_f32 v201, v234, v235
    v_cndmask_b32 v45, v11, v5, s[46:47]
    v_mfma_f32_16x16x32_bf16 a[124:127], a[248:251], v[212:215], a[124:127]
    s_waitcnt lgkmcnt(12)
    ds_read_b128 a[184:187], v2 offset:14336
    v_cndmask_b32 v46, v11, v5, s[48:49]
    v_cndmask_b32 v47, v11, v5, s[50:51]
    v_mfma_f32_16x16x32_bf16 v[164:167], a[128:131], v[112:115], v[20:23]
    v_exp_f32 v237, v153
    v_mfma_f32_16x16x32_bf16 v[164:167], a[132:135], v[116:119], v[164:167]
    s_waitcnt lgkmcnt(11)
    ds_read_b128 a[188:191], v2 offset:15360
    v_exp_f32 v238, v154
    v_mfma_f32_16x16x32_bf16 v[164:167], a[136:139], v[120:123], v[164:167]
    v_cvt_pk_bf16_f32 v202, v236, v237
    v_exp_f32 v239, v155
    v_mfma_f32_16x16x32_bf16 v[164:167], a[140:143], v[124:127], v[164:167]
    s_waitcnt lgkmcnt(10)
    s_waitcnt lgkmcnt(8)
    v_or3_b32 v57, v57, v201, v202
    v_mfma_f32_16x16x32_bf16 v[180:183], a[156:159], v[124:127], v[36:39]
    s_add_u32 s36, s36, 64
    ds_read_b128 a[192:195], v3 offset:0
    v_exp_f32 v240, v140
    v_mfma_f32_16x16x32_bf16 v[180:183], a[152:155], v[120:123], v[180:183]
    ds_read_b128 a[196:199], v3 offset:8192
    v_cvt_pk_bf16_f32 v203, v238, v239
    v_mfma_f32_16x16x32_bf16 v[180:183], a[148:151], v[116:119], v[180:183]
    s_add_u32 s52, s52, 16384
    ds_read_b128 a[200:203], v3 offset:1024
    v_exp_f32 v241, v141
    v_mfma_f32_16x16x32_bf16 v[180:183], a[144:147], v[112:115], v[180:183]
    s_waitcnt lgkmcnt(9)
    v_exp_f32 v242, v142
    v_cvt_pk_bf16_f32 v204, v240, v241
    v_mfma_f32_16x16x32_bf16 v[172:175], a[160:163], v[112:115], v[28:31]
    s_and_b32 s52, s52, 0xffff
    v_add_u32 v2, s52, v1
    v_exp_f32 v243, v143
    v_mfma_f32_16x16x32_bf16 v[172:175], a[164:167], v[116:119], v[172:175]
    s_waitcnt lgkmcnt(7)
    ds_read_b128 a[204:207], v3 offset:9216
    v_or3_b32 v57, v57, v203, v204
    v_cvt_pk_bf16_f32 v205, v242, v243
    v_mfma_f32_16x16x32_bf16 v[172:175], a[168:171], v[120:123], v[172:175]
    ds_read_b128 a[208:211], v3 offset:2048
    v_exp_f32 v244, v156
    v_mfma_f32_16x16x32_bf16 v[172:175], a[172:175], v[124:127], v[172:175]
    s_waitcnt lgkmcnt(7)
    s_waitcnt lgkmcnt(5)
    v_exp_f32 v245, v157
    v_mfma_f32_16x16x32_bf16 v[188:191], a[188:191], v[124:127], v[44:47]
    ds_read_b128 a[212:215], v3 offset:10240
    v_exp_f32 v246, v158
    v_mfma_f32_16x16x32_bf16 v[188:191], a[184:187], v[120:123], v[188:191]
    v_cvt_pk_bf16_f32 v206, v244, v245
    v_exp_f32 v247, v159
    v_mfma_f32_16x16x32_bf16 v[188:191], a[180:183], v[116:119], v[188:191]
    ds_read_b128 a[216:219], v3 offset:3072
    v_or3_b32 v57, v57, v205, v206
    v_cvt_pk_bf16_f32 v207, v246, v247
    v_mfma_f32_16x16x32_bf16 v[188:191], a[176:179], v[112:115], v[188:191]
    ds_read_b128 a[220:223], v3 offset:11264
    v_bitop3_b32 v57, v57, v207, s37 bitop3:0xa8
    v_cmp_ne_u32 vcc, 0, v57
    s_cbranch_vccnz k2_tramp_118
k2_ret_119:
k2_sdone_111:
    s_add_u32 s16, s6, 0x4811000
    s_addc_u32 s17, s7, 0
    s_and_b32 s17, s17, 0xffff
    s_mov_b32 s18, 0x4000
    s_mov_b32 s19, 0x00020000
    v_mfma_f32_16x16x32_bf16 v[248:251], v[60:63], v[192:195], v[248:251]
    s_waitcnt vmcnt(0)
    s_barrier
    v_exp_f32 v232, v164
    v_mfma_f32_16x16x32_bf16 v[248:251], v[60:63], v[200:203], v[248:251]
    ds_read_b128 a[224:227], v3 offset:4096
    s_cmp_eq_u32 s30, 0
    s_cbranch_scc1 k12_ool_122
k12_oolret_123:
    v_mfma_f32_16x16x32_bf16 v[252:255], v[60:63], v[204:207], v[252:255]
    s_add_u32 m0, s60, 0
    v_exp_f32 v233, v165
    v_mfma_f32_16x16x32_bf16 v[252:255], v[60:63], v[196:199], v[252:255]
    s_waitcnt lgkmcnt(7)
    buffer_load_dwordx4 v90, s[12:15], s61 offen offset:0 lds
    ds_read_b128 a[228:231], v3 offset:12288
    v_mfma_f32_16x16x32_bf16 a[12:15], a[192:195], v[196:199], a[12:15]
    s_add_u32 s53, s53, 16384
    v_exp_f32 v234, v166
    v_cvt_pk_bf16_f32 v212, v232, v233
    v_mfma_f32_16x16x32_bf16 a[12:15], a[196:199], v[204:207], a[12:15]
    s_and_b32 s53, s53, 0xffff
    buffer_load_dwordx4 v91, s[12:15], s61 offen offset:1024 lds
    ds_read_b128 a[232:235], v3 offset:5120
    v_mfma_f32_16x16x32_bf16 a[8:11], a[196:199], v[200:203], a[8:11]
    ds_read_b128 a[236:239], v3 offset:13312
    v_exp_f32 v235, v167
    v_mfma_f32_16x16x32_bf16 a[8:11], a[192:195], v[192:195], a[8:11]
    s_waitcnt lgkmcnt(8)
    v_exp_f32 v236, v180
    v_mfma_f32_16x16x32_bf16 a[24:27], a[200:203], v[192:195], a[24:27]
    buffer_load_dwordx4 v92, s[12:15], s61 offen offset:2048 lds
    ds_read_b128 a[240:243], v3 offset:6144
    v_mfma_f32_16x16x32_bf16 a[24:27], a[204:207], v[200:203], a[24:27]
    v_cvt_pk_bf16_f32 v213, v234, v235
    v_exp_f32 v237, v181
    v_mfma_f32_16x16x32_bf16 a[28:31], a[204:207], v[204:207], a[28:31]
    buffer_load_dwordx4 v93, s[12:15], s61 offen offset:3072 lds
    ds_read_b128 a[244:247], v3 offset:14336
    v_mfma_f32_16x16x32_bf16 a[28:31], a[200:203], v[196:199], a[28:31]
    s_waitcnt lgkmcnt(8)
    v_exp_f32 v238, v182
    v_cvt_pk_bf16_f32 v214, v236, v237
    v_mfma_f32_16x16x32_bf16 a[44:47], a[208:211], v[196:199], a[44:47]
    s_add_u32 s61, s61, 0x20000
    s_and_b32 s61, s61, 0x3fffff
    ds_read_b128 a[248:251], v3 offset:7168
    v_mfma_f32_16x16x32_bf16 a[44:47], a[212:215], v[204:207], a[44:47]
    s_add_u32 m0, s60, 16384
    v_exp_f32 v239, v183
    v_or3_b32 v57, v212, v213, v214
    v_mfma_f32_16x16x32_bf16 a[40:43], a[212:215], v[200:203], a[40:43]
    buffer_load_dwordx4 v90, s[12:15], s61 offen offset:0 lds
    buffer_load_dwordx4 v91, s[12:15], s61 offen offset:1024 lds
    ds_read_b128 a[252:255], v3 offset:15360
    v_mfma_f32_16x16x32_bf16 a[40:43], a[208:211], v[192:195], a[40:43]
    s_waitcnt lgkmcnt(8)
    v_exp_f32 v240, v172
    v_cvt_pk_bf16_f32 v215, v238, v239
    v_mfma_f32_16x16x32_bf16 a[56:59], a[216:219], v[192:195], a[56:59]
    v_mfma_f32_16x16x32_bf16 a[56:59], a[220:223], v[200:203], a[56:59]
    v_add_u32 v3, s53, v56
    ds_read_b128 a[192:195], v3 offset:0
    v_mfma_f32_16x16x32_bf16 a[60:63], a[220:223], v[204:207], a[60:63]
    ds_read_b128 a[196:199], v3 offset:8192
    v_exp_f32 v241, v173
    v_mfma_f32_16x16x32_bf16 a[60:63], a[216:219], v[196:199], a[60:63]
    s_waitcnt lgkmcnt(8)
    buffer_load_dwordx4 v92, s[12:15], s61 offen offset:2048 lds
    buffer_load_dwordx4 v93, s[12:15], s61 offen offset:3072 lds
    ds_read_b128 a[200:203], v3 offset:1024
    v_mfma_f32_16x16x32_bf16 a[76:79], a[224:227], v[196:199], a[76:79]
    v_exp_f32 v242, v174
    v_cvt_pk_bf16_f32 v220, v240, v241
    v_mfma_f32_16x16x32_bf16 a[76:79], a[228:231], v[204:207], a[76:79]
    ds_read_b128 a[204:207], v3 offset:9216
    ds_read_b128 a[208:211], v3 offset:2048
    v_or3_b32 v57, v57, v215, v220
    v_mfma_f32_16x16x32_bf16 a[72:75], a[228:231], v[200:203], a[72:75]
    s_add_u32 s61, s61, 0x20000
    s_and_b32 s61, s61, 0x3fffff
    ds_read_b128 a[212:215], v3 offset:10240
    v_exp_f32 v243, v175
    v_mfma_f32_16x16x32_bf16 a[72:75], a[224:227], v[192:195], a[72:75]
    s_waitcnt lgkmcnt(10)
    ds_read_b128 a[216:219], v3 offset:3072
    s_add_u32 m0, s60, 32768
    v_mfma_f32_16x16x32_bf16 a[88:91], a[232:235], v[192:195], a[88:91]
    buffer_load_dwordx4 v90, s[12:15], s61 offen offset:0 lds
    ds_read_b128 a[220:223], v3 offset:11264
    v_mfma_f32_16x16x32_bf16 a[88:91], a[236:239], v[200:203], a[88:91]
    v_exp_f32 v244, v188
    v_cvt_pk_bf16_f32 v221, v242, v243
    v_mfma_f32_16x16x32_bf16 a[92:95], a[236:239], v[204:207], a[92:95]
    buffer_load_dwordx4 v91, s[12:15], s61 offen offset:1024 lds
    ds_read_b128 a[224:227], v3 offset:4096
    v_mfma_f32_16x16x32_bf16 a[92:95], a[232:235], v[196:199], a[92:95]
    s_waitcnt lgkmcnt(11)
    ds_read_b128 a[228:231], v3 offset:12288
    v_exp_f32 v245, v189
    v_mfma_f32_16x16x32_bf16 a[108:111], a[240:243], v[196:199], a[108:111]
    buffer_load_dwordx4 v92, s[12:15], s61 offen offset:2048 lds
    ds_read_b128 a[232:235], v3 offset:5120
    v_mfma_f32_16x16x32_bf16 a[108:111], a[244:247], v[204:207], a[108:111]
    v_exp_f32 v246, v190
    v_mfma_f32_16x16x32_bf16 a[104:107], a[244:247], v[200:203], a[104:107]
    ds_read_b128 a[236:239], v3 offset:13312
    v_cvt_pk_bf16_f32 v222, v244, v245
    v_or3_b32 v57, v57, v221, v222
    v_mfma_f32_16x16x32_bf16 a[104:107], a[240:243], v[192:195], a[104:107]
    s_waitcnt lgkmcnt(12)
    v_exp_f32 v247, v191
    v_mfma_f32_16x16x32_bf16 a[120:123], a[248:251], v[192:195], a[120:123]
    buffer_load_dwordx4 v93, s[12:15], s61 offen offset:3072 lds
    ds_read_b128 a[240:243], v3 offset:6144
    ds_read_b128 a[244:247], v3 offset:14336
    v_mfma_f32_16x16x32_bf16 a[120:123], a[252:255], v[200:203], a[120:123]
    s_add_u32 s61, s61, 0x20000
    s_and_b32 s61, s61, 0x3fffff
    v_cvt_pk_bf16_f32 v223, v246, v247
    v_bitop3_b32 v57, v57, v223, s37 bitop3:0xa8
    v_mfma_f32_16x16x32_bf16 a[124:127], a[252:255], v[204:207], a[124:127]
    v_cmp_ne_u32 vcc, 0, v57
    v_mfma_f32_16x16x32_bf16 a[124:127], a[248:251], v[196:199], a[124:127]
    buffer_load_dword v74, v73, s[16:19], s59 offen sc1
    ds_read_b128 a[248:251], v3 offset:7168
    ds_read_b128 a[252:255], v3 offset:15360
    s_cbranch_vccnz k2_tramp_120
k2_ret_121:
    v_lshrrev_b32 v6, 4, v1
    v_and_b32 v6, 31, v6
    s_getpc_b64 s[40:41]
pc_124:
    s_add_u32 s40, s40, op_head-pc_124
    s_addc_u32 s41, s41, 0
    v_lshlrev_b32 v224, 7, v6
    v_mov_b32 v225, s41
    v_add_co_u32 v224, vcc, s40, v224
    s_nop 1
    v_addc_co_u32 v225, vcc, 0, v225, vcc
    global_load_dword v7, v[224:225], off
    v_mfma_f32_16x16x32_bf16 v[252:255], v[60:63], v[212:215], v[252:255]
    s_lshl_b32 s31, s28, 19
    v_mov_b32 v249, v248
    s_nop 1
    v_permlane16_swap_b32 v248, v249
    v_mfma_f32_16x16x32_bf16 v[252:255], v[60:63], v[220:223], v[252:255]
    s_waitcnt lgkmcnt(0)
    s_nop 1
    v_add_f32 v248, v248, v249
    v_mov_b32 v249, v248
    v_mfma_f32_16x16x32_bf16 a[12:15], a[196:199], v[220:223], a[12:15]
    s_lshl_b32 s44, s39, 6
    s_nop 1
    v_permlane32_swap_b32 v248, v249
    s_nop 1
    v_mfma_f32_16x16x32_bf16 a[12:15], a[192:195], v[212:215], a[12:15]
    s_add_u32 s44, s44, s31
    s_add_u32 s45, s44, 131072
    v_add_f32 v248, v248, v249
    v_rcp_f32 v249, v248
    v_mfma_f32_16x16x32_bf16 a[28:31], a[200:203], v[212:215], a[28:31]
    s_add_u32 s46, s44, 262144
    v_rcp_f32 v248, v248
    s_nop 0
    s_add_u32 s47, s44, 393216
    v_mfma_f32_16x16x32_bf16 a[28:31], a[204:207], v[220:223], a[28:31]
    s_add_u32 s48, s44, 4096
    v_accvgpr_read_b32 v132, a8
    v_accvgpr_read_b32 v133, a9
    v_accvgpr_read_b32 v134, a10
    v_mfma_f32_16x16x32_bf16 a[44:47], a[212:215], v[220:223], a[44:47]
    s_add_u32 s49, s44, 135168
    v_accvgpr_read_b32 v135, a11
    v_accvgpr_read_b32 v136, a24
    v_accvgpr_read_b32 v137, a25
    v_mfma_f32_16x16x32_bf16 a[44:47], a[208:211], v[212:215], a[44:47]
    s_add_u32 s50, s44, 266240
    v_accvgpr_read_b32 v138, a26
    v_accvgpr_read_b32 v139, a27
    v_mul_f32 v132, v132, v248
    v_mfma_f32_16x16x32_bf16 a[60:63], a[216:219], v[212:215], a[60:63]
    s_add_u32 s51, s44, 397312
    v_mul_f32 v133, v133, v248
    v_mul_f32 v134, v134, v248
    v_mul_f32 v135, v135, v248
    v_mfma_f32_16x16x32_bf16 a[60:63], a[220:223], v[220:223], a[60:63]
    v_mul_f32 v136, v136, v248
    v_mul_f32 v137, v137, v248
    v_mul_f32 v138, v138, v248
    v_mfma_f32_16x16x32_bf16 a[76:79], a[228:231], v[220:223], a[76:79]
    v_mul_f32 v139, v139, v248
    v_cvt_pk_bf16_f32 v128, v132, v133
    v_cvt_pk_bf16_f32 v129, v134, v135
    v_mfma_f32_16x16x32_bf16 a[76:79], a[224:227], v[212:215], a[76:79]
    v_cvt_pk_bf16_f32 v130, v136, v137
    v_cvt_pk_bf16_f32 v131, v138, v139
    buffer_store_dwordx4 v[128:131], v1, s[24:27], s44 offen sc1
    v_mfma_f32_16x16x32_bf16 a[92:95], a[232:235], v[212:215], a[92:95]
    v_accvgpr_read_b32 v144, a40
    v_accvgpr_read_b32 v145, a41
    v_accvgpr_read_b32 v146, a42
    v_mfma_f32_16x16x32_bf16 a[92:95], a[236:239], v[220:223], a[92:95]
    v_accvgpr_read_b32 v147, a43
    v_accvgpr_read_b32 v148, a56
    v_mov_b32 v253, v252
    v_mfma_f32_16x16x32_bf16 a[108:111], a[244:247], v[220:223], a[108:111]
    v_accvgpr_read_b32 v149, a57
    v_accvgpr_read_b32 v150, a58
    s_nop 1
    v_mfma_f32_16x16x32_bf16 a[108:111], a[240:243], v[212:215], a[108:111]
    v_accvgpr_read_b32 v151, a59
    v_permlane16_swap_b32 v252, v253
    v_mul_f32 v144, v144, v248
    v_mfma_f32_16x16x32_bf16 a[124:127], a[248:251], v[212:215], a[124:127]
    s_nop 1
    v_mul_f32 v145, v145, v248
    v_add_f32 v252, v252, v253
    v_mfma_f32_16x16x32_bf16 a[124:127], a[252:255], v[220:223], a[124:127]
    v_mul_f32 v146, v146, v248
    v_mov_b32 v253, v252
    v_mul_f32 v147, v147, v248
    s_nop 1
    v_mul_f32 v148, v148, v248
    v_mul_f32 v149, v149, v248
    v_permlane32_swap_b32 v252, v253
    v_mul_f32 v150, v150, v248
    s_nop 1
    v_mul_f32 v151, v151, v248
    v_add_f32 v252, v252, v253
    v_cvt_pk_bf16_f32 v140, v144, v145
    v_rcp_f32 v253, v252
    v_cvt_pk_bf16_f32 v141, v146, v147
    v_rcp_f32 v252, v252
    v_cvt_pk_bf16_f32 v142, v148, v149
    s_nop 0
    v_cvt_pk_bf16_f32 v143, v150, v151
    buffer_store_dwordx4 v[140:143], v1, s[24:27], s45 offen sc1
    v_accvgpr_read_b32 v156, a72
    v_accvgpr_read_b32 v157, a73
    v_accvgpr_read_b32 v158, a74
    v_accvgpr_read_b32 v159, a75
    v_accvgpr_read_b32 v160, a88
    v_accvgpr_read_b32 v161, a89
    v_accvgpr_read_b32 v162, a90
    v_accvgpr_read_b32 v163, a91
    v_mul_f32 v156, v156, v248
    v_mul_f32 v157, v157, v248
    v_mul_f32 v158, v158, v248
    v_mul_f32 v159, v159, v248
    v_mul_f32 v160, v160, v248
    v_mul_f32 v161, v161, v248
    v_mul_f32 v162, v162, v248
    v_mul_f32 v163, v163, v248
    v_cvt_pk_bf16_f32 v152, v156, v157
    v_cvt_pk_bf16_f32 v153, v158, v159
    v_cvt_pk_bf16_f32 v154, v160, v161
    v_cvt_pk_bf16_f32 v155, v162, v163
    buffer_store_dwordx4 v[152:155], v1, s[24:27], s46 offen sc1
    v_accvgpr_read_b32 v168, a104
    v_accvgpr_read_b32 v169, a105
    v_accvgpr_read_b32 v170, a106
    v_accvgpr_read_b32 v171, a107
    v_accvgpr_read_b32 v172, a120
    v_accvgpr_read_b32 v173, a121
    v_accvgpr_read_b32 v174, a122
    v_accvgpr_read_b32 v175, a123
    v_mul_f32 v168, v168, v248
    v_mul_f32 v169, v169, v248
    v_mul_f32 v170, v170, v248
    v_mul_f32 v171, v171, v248
    v_mul_f32 v172, v172, v248
    v_mul_f32 v173, v173, v248
    v_mul_f32 v174, v174, v248
    v_mul_f32 v175, v175, v248
    v_cvt_pk_bf16_f32 v164, v168, v169
    v_cvt_pk_bf16_f32 v165, v170, v171
    v_cvt_pk_bf16_f32 v166, v172, v173
    v_cvt_pk_bf16_f32 v167, v174, v175
    buffer_store_dwordx4 v[164:167], v1, s[24:27], s47 offen sc1
    v_accvgpr_read_b32 v132, a12
    v_accvgpr_read_b32 v133, a13
    v_accvgpr_read_b32 v134, a14
    v_accvgpr_read_b32 v135, a15
    v_accvgpr_read_b32 v136, a28
    v_accvgpr_read_b32 v137, a29
    v_accvgpr_read_b32 v138, a30
    v_accvgpr_read_b32 v139, a31
    v_pk_mul_f32 v[132:133], v[132:133], v[252:253]
    v_pk_mul_f32 v[134:135], v[134:135], v[252:253]
    v_pk_mul_f32 v[136:137], v[136:137], v[252:253]
    v_pk_mul_f32 v[138:139], v[138:139], v[252:253]
    v_cvt_pk_bf16_f32 v128, v132, v133
    v_cvt_pk_bf16_f32 v129, v134, v135
    v_cvt_pk_bf16_f32 v130, v136, v137
    v_cvt_pk_bf16_f32 v131, v138, v139
    v_accvgpr_read_b32 v144, a44
    v_accvgpr_read_b32 v145, a45
    v_accvgpr_read_b32 v146, a46
    v_accvgpr_read_b32 v147, a47
    v_accvgpr_read_b32 v148, a60
    v_accvgpr_read_b32 v149, a61
    v_accvgpr_read_b32 v150, a62
    v_accvgpr_read_b32 v151, a63
    v_pk_mul_f32 v[144:145], v[144:145], v[252:253]
    v_pk_mul_f32 v[146:147], v[146:147], v[252:253]
    v_pk_mul_f32 v[148:149], v[148:149], v[252:253]
    v_pk_mul_f32 v[150:151], v[150:151], v[252:253]
    v_cvt_pk_bf16_f32 v140, v144, v145
    v_cvt_pk_bf16_f32 v141, v146, v147
    v_cvt_pk_bf16_f32 v142, v148, v149
    v_cvt_pk_bf16_f32 v143, v150, v151
    v_accvgpr_read_b32 v156, a76
    v_accvgpr_read_b32 v157, a77
    v_accvgpr_read_b32 v158, a78
    v_accvgpr_read_b32 v159, a79
    v_accvgpr_read_b32 v160, a92
    v_accvgpr_read_b32 v161, a93
    v_accvgpr_read_b32 v162, a94
    v_accvgpr_read_b32 v163, a95
    v_pk_mul_f32 v[156:157], v[156:157], v[252:253]
    v_pk_mul_f32 v[158:159], v[158:159], v[252:253]
    v_pk_mul_f32 v[160:161], v[160:161], v[252:253]
    v_pk_mul_f32 v[162:163], v[162:163], v[252:253]
    v_cvt_pk_bf16_f32 v152, v156, v157
    v_cvt_pk_bf16_f32 v153, v158, v159
    v_cvt_pk_bf16_f32 v154, v160, v161
    v_cvt_pk_bf16_f32 v155, v162, v163
    v_accvgpr_read_b32 v168, a108
    v_accvgpr_read_b32 v169, a109
    v_accvgpr_read_b32 v170, a110
    v_accvgpr_read_b32 v171, a111
    v_accvgpr_read_b32 v172, a124
    v_accvgpr_read_b32 v173, a125
    v_accvgpr_read_b32 v174, a126
    v_accvgpr_read_b32 v175, a127
    v_pk_mul_f32 v[168:169], v[168:169], v[252:253]
    v_pk_mul_f32 v[170:171], v[170:171], v[252:253]
    v_pk_mul_f32 v[172:173], v[172:173], v[252:253]
    v_pk_mul_f32 v[174:175], v[174:175], v[252:253]
    v_cvt_pk_bf16_f32 v164, v168, v169
    v_cvt_pk_bf16_f32 v165, v170, v171
    v_cvt_pk_bf16_f32 v166, v172, v173
    v_cvt_pk_bf16_f32 v167, v174, v175
    buffer_store_dwordx4 v[128:131], v1, s[24:27], s48 offen sc1
    buffer_store_dwordx4 v[140:143], v1, s[24:27], s49 offen sc1
    buffer_store_dwordx4 v[152:155], v1, s[24:27], s50 offen sc1
    buffer_store_dwordx4 v[164:167], v1, s[24:27], s51 offen sc1
op_head:
    s_load_dwordx2 s[28:29], s[0:1], 0
    s_load_dwordx2 s[42:43], s[0:1], 56
    s_waitcnt vmcnt(8)
    v_cmp_le_u32 vcc, 4, v74
    v_mov_b32 v56, 0
    v_mov_b32 v57, 0
    v_mov_b32 v58, 0
    v_mov_b32 v59, 0
    s_nop 1
    v_mfma_f32_32x32x16_bf16 v[128:143], v[56:59], v[56:59], 0
    v_mfma_f32_32x32x16_bf16 v[144:159], v[56:59], v[56:59], 0
    v_mfma_f32_32x32x16_bf16 v[160:175], v[56:59], v[56:59], 0
    v_mfma_f32_32x32x16_bf16 v[176:191], v[56:59], v[56:59], 0
    s_mov_b32 s33, vcc_lo
    s_bitcmp1_b32 s33, 0
    s_cbranch_scc0 op_late_125
    buffer_load_dwordx4 a[128:131], v88, s[8:11], s62 offen offset:0 sc1
    buffer_load_dwordx4 a[132:135], v88, s[8:11], s62 offen offset:1024 sc1
    buffer_load_dwordx4 a[136:139], v89, s[8:11], s62 offen offset:0 sc1
    buffer_load_dwordx4 a[140:143], v89, s[8:11], s62 offen offset:1024 sc1
    s_add_u32 s62, s62, 0x40000
    s_and_b32 s62, s62, 0x7fffff
    buffer_load_dwordx4 a[144:147], v88, s[8:11], s62 offen offset:0 sc1
    buffer_load_dwordx4 a[148:151], v88, s[8:11], s62 offen offset:1024 sc1
    buffer_load_dwordx4 a[152:155], v89, s[8:11], s62 offen offset:0 sc1
    buffer_load_dwordx4 a[156:159], v89, s[8:11], s62 offen offset:1024 sc1
    s_add_u32 s62, s62, 0x40000
    s_and_b32 s62, s62, 0x7fffff
    buffer_load_dwordx4 a[160:163], v88, s[8:11], s62 offen offset:0 sc1
    buffer_load_dwordx4 a[164:167], v88, s[8:11], s62 offen offset:1024 sc1
    buffer_load_dwordx4 a[168:171], v89, s[8:11], s62 offen offset:0 sc1
    buffer_load_dwordx4 a[172:175], v89, s[8:11], s62 offen offset:1024 sc1
    s_add_u32 s62, s62, 0x40000
    s_and_b32 s62, s62, 0x7fffff
    s_waitcnt vmcnt(12)
    s_branch op_join_126
op_late_125:
    s_waitcnt vmcnt(0)
op_join_126:
    s_barrier
    s_cmp_eq_u32 s30, 0
    s_cbranch_scc1 k12_ool_127
k12_oolret_128:
    s_bitcmp0_b32 s33, 0
    s_cbranch_scc1 k12_ool_131
k12_oolret_132:
    ds_read_b64_tr_b16 a[0:1], v64 offset:0
    ds_read_b64_tr_b16 a[2:3], v64 offset:4096
    ds_read_b64_tr_b16 a[4:5], v65 offset:0
    ds_read_b64_tr_b16 a[6:7], v65 offset:4096
    ds_read_b64_tr_b16 a[8:9], v66 offset:0
    ds_read_b64_tr_b16 a[10:11], v66 offset:4096
    ds_read_b64_tr_b16 a[12:13], v67 offset:0
    ds_read_b64_tr_b16 a[14:15], v67 offset:4096
    ds_read_b64_tr_b16 a[16:17], v68 offset:0
    ds_read_b64_tr_b16 a[18:19], v68 offset:4096
    ds_read_b64_tr_b16 a[20:21], v69 offset:0
    ds_read_b64_tr_b16 a[22:23], v69 offset:4096
    ds_read_b64_tr_b16 a[24:25], v70 offset:0
    ds_read_b64_tr_b16 a[26:27], v70 offset:4096
    ds_read_b64_tr_b16 a[28:29], v71 offset:0
    ds_read_b64_tr_b16 a[30:31], v71 offset:4096
    ds_read_b64_tr_b16 a[32:33], v64 offset:8192
    ds_read_b64_tr_b16 a[34:35], v64 offset:12288
    ds_read_b64_tr_b16 a[36:37], v65 offset:8192
    ds_read_b64_tr_b16 a[38:39], v65 offset:12288
    ds_read_b64_tr_b16 a[40:41], v66 offset:8192
    ds_read_b64_tr_b16 a[42:43], v66 offset:12288
    ds_read_b64_tr_b16 a[44:45], v67 offset:8192
    ds_read_b64_tr_b16 a[46:47], v67 offset:12288
    ds_read_b64_tr_b16 a[48:49], v68 offset:8192
    ds_read_b64_tr_b16 a[50:51], v68 offset:12288
    ds_read_b64_tr_b16 a[52:53], v69 offset:8192
    ds_read_b64_tr_b16 a[54:55], v69 offset:12288
    ds_read_b64_tr_b16 a[56:57], v70 offset:8192
    ds_read_b64_tr_b16 a[58:59], v70 offset:12288
    ds_read_b64_tr_b16 a[60:61], v71 offset:8192
    ds_read_b64_tr_b16 a[62:63], v71 offset:12288
    s_add_u32 s24, s6, 0x4000000
    s_addc_u32 s25, s7, 0
    s_and_b32 s25, s25, 0xffff
    s_mov_b32 s26, 0x400000
    s_mov_b32 s27, 0x00020000
    s_add_u32 s36, s6, 0x5000000
    s_addc_u32 s37, s7, 0
    s_and_b32 s37, s37, 0xffff
    s_mov_b32 s38, 0x800000
    s_mov_b32 s39, 0x00020000
    s_add_u32 s48, s6, 0x4807000
    s_addc_u32 s49, s7, 0
    s_and_b32 s49, s49, 0xffff
    s_mov_b32 s50, 0x8000
    s_mov_b32 s51, 0x00020000
    s_lshl_b32 s52, s2, 14
    s_add_u32 s52, s52, s60
    s_xor_b32 s53, s52, 0x10000
    s_lshl_b32 s57, s2, 7
    s_xor_b32 s58, s57, 0x200
    v_lshrrev_b32 v56, 4, v1
    s_lshl_b32 s31, s30, 6
    s_and_b32 s31, s31, 64
    v_add_u32 v56, s31, v56
    s_mov_b32 s31, (code_end-op_tail)/128
    v_min_u32 v56, s31, v56
    s_getpc_b64 s[40:41]
pc_133:
    s_add_u32 s40, s40, op_tail-pc_133
    s_addc_u32 s41, s41, 0
    v_lshlrev_b32 v82, 7, v56
    v_mov_b32 v83, s41
    v_add_co_u32 v82, vcc, s40, v82
    s_nop 1
    v_addc_co_u32 v83, vcc, 0, v83, vcc
    v_lshlrev_b32 v94, 3, v1
    s_and_b32 s35, s2, 7
    s_mul_i32 s35, s35, 28
    s_lshr_b32 s31, s2, 3
    s_add_u32 s55, s35, s31
    s_lshl_b32 s3, s55, 15
    s_lshl_b32 s31, s30, 13
    s_add_u32 s3, s3, s31
    s_add_u32 s35, s31, 65536
    s_mov_b32 s63, 0
    s_waitcnt vmcnt(8) lgkmcnt(0)
    s_mov_b32 s20, s28
    s_and_b32 s21, s29, 0xffff
    s_mov_b32 s22, 0x400000
    s_mov_b32 s23, 0x00020000
    s_mov_b32 s44, s42
    s_and_b32 s45, s43, 0xffff
    s_mov_b32 s46, 0x800
    s_mov_b32 s47, 0x00020000
op_loop_134:
    v_mfma_f32_16x16x32_bf16 v[160:163], a[16:19], a[128:131], v[160:163]
    s_add_u32 m0, s60, 49152
    ds_read_b64_tr_b16 a[64:65], v64 offset:16384
    ds_read_b64_tr_b16 a[66:67], v64 offset:20480
    v_mfma_f32_16x16x32_bf16 v[160:163], a[48:51], a[136:139], v[160:163]
    buffer_load_dwordx4 v90, s[12:15], s61 offen offset:0 lds
    ds_read_b64_tr_b16 a[68:69], v65 offset:16384
    v_mfma_f32_16x16x32_bf16 v[164:167], a[48:51], a[140:143], v[164:167]
    ds_read_b64_tr_b16 a[70:71], v65 offset:20480
    ds_read_b64_tr_b16 a[72:73], v66 offset:16384
    v_mfma_f32_16x16x32_bf16 v[164:167], a[16:19], a[132:135], v[164:167]
    buffer_load_dwordx4 v91, s[12:15], s61 offen offset:1024 lds
    ds_read_b64_tr_b16 a[74:75], v66 offset:20480
    v_mfma_f32_16x16x32_bf16 v[172:175], a[20:23], a[132:135], v[172:175]
    ds_read_b64_tr_b16 a[76:77], v67 offset:16384
    ds_read_b64_tr_b16 a[78:79], v67 offset:20480
    v_mfma_f32_16x16x32_bf16 v[172:175], a[52:55], a[140:143], v[172:175]
    ds_read_b64_tr_b16 a[80:81], v68 offset:16384
    v_mfma_f32_16x16x32_bf16 v[168:171], a[52:55], a[136:139], v[168:171]
    ds_read_b64_tr_b16 a[82:83], v68 offset:20480
    v_mfma_f32_16x16x32_bf16 v[168:171], a[20:23], a[128:131], v[168:171]
    buffer_load_dwordx4 v92, s[12:15], s61 offen offset:2048 lds
    ds_read_b64_tr_b16 a[84:85], v69 offset:16384
    v_mfma_f32_16x16x32_bf16 v[176:179], a[24:27], a[128:131], v[176:179]
    ds_read_b64_tr_b16 a[86:87], v69 offset:20480
    ds_read_b64_tr_b16 a[88:89], v70 offset:16384
    v_mfma_f32_16x16x32_bf16 v[176:179], a[56:59], a[136:139], v[176:179]
    ds_read_b64_tr_b16 a[90:91], v70 offset:20480
    v_mfma_f32_16x16x32_bf16 v[180:183], a[56:59], a[140:143], v[180:183]
    buffer_load_dwordx4 v93, s[12:15], s61 offen offset:3072 lds
    ds_read_b64_tr_b16 a[92:93], v71 offset:16384
    v_mfma_f32_16x16x32_bf16 v[180:183], a[24:27], a[132:135], v[180:183]
    ds_read_b64_tr_b16 a[94:95], v71 offset:20480
    ds_read_b64_tr_b16 a[96:97], v64 offset:24576
    v_mfma_f32_16x16x32_bf16 v[188:191], a[28:31], a[132:135], v[188:191]
    ds_read_b64_tr_b16 a[98:99], v64 offset:28672
    v_mfma_f32_16x16x32_bf16 v[188:191], a[60:63], a[140:143], v[188:191]
    ds_read_b64_tr_b16 a[100:101], v65 offset:24576
    v_mfma_f32_16x16x32_bf16 v[184:187], a[60:63], a[136:139], v[184:187]
    buffer_load_dwordx4 a[176:179], v88, s[8:11], s62 offen offset:0 sc1
    ds_read_b64_tr_b16 a[102:103], v65 offset:28672
    v_mfma_f32_16x16x32_bf16 v[184:187], a[28:31], a[128:131], v[184:187]
    s_add_u32 s61, s61, 0x20000
    s_and_b32 s61, s61, 0x3fffff
    ds_read_b64_tr_b16 a[104:105], v66 offset:24576
    ds_read_b64_tr_b16 a[106:107], v66 offset:28672
    v_mfma_f32_16x16x32_bf16 v[128:131], a[0:3], a[128:131], v[128:131]
    ds_read_b64_tr_b16 a[108:109], v67 offset:24576
    v_mfma_f32_16x16x32_bf16 v[128:131], a[32:35], a[136:139], v[128:131]
    buffer_load_dwordx4 a[180:183], v88, s[8:11], s62 offen offset:1024 sc1
    ds_read_b64_tr_b16 a[110:111], v67 offset:28672
    v_mfma_f32_16x16x32_bf16 v[132:135], a[32:35], a[140:143], v[132:135]
    ds_read_b64_tr_b16 a[112:113], v68 offset:24576
    v_mfma_f32_16x16x32_bf16 v[132:135], a[0:3], a[132:135], v[132:135]
    ds_read_b64_tr_b16 a[114:115], v68 offset:28672
    ds_read_b64_tr_b16 a[116:117], v69 offset:24576
    v_mfma_f32_16x16x32_bf16 v[140:143], a[4:7], a[132:135], v[140:143]
    ds_read_b64_tr_b16 a[118:119], v69 offset:28672
    v_mfma_f32_16x16x32_bf16 v[140:143], a[36:39], a[140:143], v[140:143]
    buffer_load_dwordx4 a[184:187], v89, s[8:11], s62 offen offset:0 sc1
    ds_read_b64_tr_b16 a[120:121], v70 offset:24576
    v_mfma_f32_16x16x32_bf16 v[136:139], a[36:39], a[136:139], v[136:139]
    ds_read_b64_tr_b16 a[122:123], v70 offset:28672
    ds_read_b64_tr_b16 a[124:125], v71 offset:24576
    v_mfma_f32_16x16x32_bf16 v[136:139], a[4:7], a[128:131], v[136:139]
    ds_read_b64_tr_b16 a[126:127], v71 offset:28672
    v_mfma_f32_16x16x32_bf16 v[144:147], a[8:11], a[128:131], v[144:147]
    buffer_load_dwordx4 a[188:191], v89, s[8:11], s62 offen offset:1024 sc1
    v_mfma_f32_16x16x32_bf16 v[144:147], a[40:43], a[136:139], v[144:147]
    v_mfma_f32_16x16x32_bf16 v[148:151], a[40:43], a[140:143], v[148:151]
    v_mfma_f32_16x16x32_bf16 v[148:151], a[8:11], a[132:135], v[148:151]
    v_mfma_f32_16x16x32_bf16 v[156:159], a[12:15], a[132:135], v[156:159]
    s_cmp_eq_u32 s63, 7
    s_cbranch_scc1 k12_ool_137
k12_oolret_138:
    v_mfma_f32_16x16x32_bf16 v[156:159], a[44:47], a[140:143], v[156:159]
    s_add_u32 s62, s62, 0x40000
    s_and_b32 s62, s62, 0x7fffff
    v_mfma_f32_16x16x32_bf16 v[152:155], a[44:47], a[136:139], v[152:155]
    v_mfma_f32_16x16x32_bf16 v[152:155], a[12:15], a[128:131], v[152:155]
    s_waitcnt vmcnt(12) lgkmcnt(0)
    s_barrier
    v_mfma_f32_16x16x32_bf16 v[160:163], a[80:83], a[144:147], v[160:163]
    s_add_u32 s32, s63, 1
    s_lshr_b32 s32, s32, 1
    ds_read_b64_tr_b16 a[0:1], v64 offset:32768
    v_cmp_le_u32 vcc, 4, v74
    v_mfma_f32_16x16x32_bf16 v[160:163], a[112:115], a[152:155], v[160:163]
    s_add_u32 m0, s60, 0
    ds_read_b64_tr_b16 a[2:3], v64 offset:36864
    ds_read_b64_tr_b16 a[4:5], v65 offset:32768
    v_mfma_f32_16x16x32_bf16 v[164:167], a[112:115], a[156:159], v[164:167]
    s_or_b32 s33, vcc_lo, 16
    buffer_load_dwordx4 v90, s[12:15], s61 offen offset:0 lds
    ds_read_b64_tr_b16 a[6:7], v65 offset:36864
    v_mfma_f32_16x16x32_bf16 v[164:167], a[80:83], a[148:151], v[164:167]
    ds_read_b64_tr_b16 a[8:9], v66 offset:32768
    ds_read_b64_tr_b16 a[10:11], v66 offset:36864
    v_mfma_f32_16x16x32_bf16 v[172:175], a[84:87], a[148:151], v[172:175]
    buffer_load_dwordx4 v91, s[12:15], s61 offen offset:1024 lds
    ds_read_b64_tr_b16 a[12:13], v67 offset:32768
    v_mfma_f32_16x16x32_bf16 v[172:175], a[116:119], a[156:159], v[172:175]
    ds_read_b64_tr_b16 a[14:15], v67 offset:36864
    ds_read_b64_tr_b16 a[16:17], v68 offset:32768
    v_mfma_f32_16x16x32_bf16 v[168:171], a[116:119], a[152:155], v[168:171]
    s_bitcmp0_b32 s33, s32
    s_cbranch_scc1 k12_ool_141
k12_oolret_142:
    v_mfma_f32_16x16x32_bf16 v[168:171], a[84:87], a[144:147], v[168:171]
    ds_read_b64_tr_b16 a[18:19], v68 offset:36864
    ds_read_b64_tr_b16 a[20:21], v69 offset:32768
    v_mfma_f32_16x16x32_bf16 v[176:179], a[88:91], a[144:147], v[176:179]
    buffer_load_dwordx4 v92, s[12:15], s61 offen offset:2048 lds
    ds_read_b64_tr_b16 a[22:23], v69 offset:36864
    v_mfma_f32_16x16x32_bf16 v[176:179], a[120:123], a[152:155], v[176:179]
    ds_read_b64_tr_b16 a[24:25], v70 offset:32768
    ds_read_b64_tr_b16 a[26:27], v70 offset:36864
    v_mfma_f32_16x16x32_bf16 v[180:183], a[120:123], a[156:159], v[180:183]
    buffer_load_dwordx4 v93, s[12:15], s61 offen offset:3072 lds
    ds_read_b64_tr_b16 a[28:29], v71 offset:32768
    v_mfma_f32_16x16x32_bf16 v[180:183], a[88:91], a[148:151], v[180:183]
    ds_read_b64_tr_b16 a[30:31], v71 offset:36864
    ds_read_b64_tr_b16 a[32:33], v64 offset:40960
    v_mfma_f32_16x16x32_bf16 v[188:191], a[92:95], a[148:151], v[188:191]
    ds_read_b64_tr_b16 a[34:35], v64 offset:45056
    v_mfma_f32_16x16x32_bf16 v[188:191], a[124:127], a[156:159], v[188:191]
    ds_read_b64_tr_b16 a[36:37], v65 offset:40960
    v_mfma_f32_16x16x32_bf16 v[184:187], a[124:127], a[152:155], v[184:187]
    buffer_load_dwordx4 a[128:131], v88, s[8:11], s62 offen offset:0 sc1
    ds_read_b64_tr_b16 a[38:39], v65 offset:45056
    v_mfma_f32_16x16x32_bf16 v[184:187], a[92:95], a[144:147], v[184:187]
    s_add_u32 s61, s61, 0x20000
    s_and_b32 s61, s61, 0x3fffff
    ds_read_b64_tr_b16 a[40:41], v66 offset:40960
    ds_read_b64_tr_b16 a[42:43], v66 offset:45056
    v_mfma_f32_16x16x32_bf16 v[128:131], a[64:67], a[144:147], v[128:131]
    ds_read_b64_tr_b16 a[44:45], v67 offset:40960
    v_mfma_f32_16x16x32_bf16 v[128:131], a[96:99], a[152:155], v[128:131]
    buffer_load_dwordx4 a[132:135], v88, s[8:11], s62 offen offset:1024 sc1
    ds_read_b64_tr_b16 a[46:47], v67 offset:45056
    v_mfma_f32_16x16x32_bf16 v[132:135], a[96:99], a[156:159], v[132:135]
    ds_read_b64_tr_b16 a[48:49], v68 offset:40960
    v_mfma_f32_16x16x32_bf16 v[132:135], a[64:67], a[148:151], v[132:135]
    ds_read_b64_tr_b16 a[50:51], v68 offset:45056
    ds_read_b64_tr_b16 a[52:53], v69 offset:40960
    v_mfma_f32_16x16x32_bf16 v[140:143], a[68:71], a[148:151], v[140:143]
    ds_read_b64_tr_b16 a[54:55], v69 offset:45056
    v_mfma_f32_16x16x32_bf16 v[140:143], a[100:103], a[156:159], v[140:143]
    buffer_load_dwordx4 a[136:139], v89, s[8:11], s62 offen offset:0 sc1
    ds_read_b64_tr_b16 a[56:57], v70 offset:40960
    v_mfma_f32_16x16x32_bf16 v[136:139], a[100:103], a[152:155], v[136:139]
    ds_read_b64_tr_b16 a[58:59], v70 offset:45056
    ds_read_b64_tr_b16 a[60:61], v71 offset:40960
    v_mfma_f32_16x16x32_bf16 v[136:139], a[68:71], a[144:147], v[136:139]
    ds_read_b64_tr_b16 a[62:63], v71 offset:45056
    v_mfma_f32_16x16x32_bf16 v[144:147], a[72:75], a[144:147], v[144:147]
    buffer_load_dwordx4 a[140:143], v89, s[8:11], s62 offen offset:1024 sc1
    v_mfma_f32_16x16x32_bf16 v[144:147], a[104:107], a[152:155], v[144:147]
    v_mfma_f32_16x16x32_bf16 v[148:151], a[104:107], a[156:159], v[148:151]
    s_cmp_eq_u32 s63, 6
    s_cbranch_scc1 k12_ool_143
k12_oolret_144:
    v_mfma_f32_16x16x32_bf16 v[148:151], a[72:75], a[148:151], v[148:151]
    v_mfma_f32_16x16x32_bf16 v[156:159], a[76:79], a[148:151], v[156:159]
    v_mfma_f32_16x16x32_bf16 v[156:159], a[108:111], a[156:159], v[156:159]
    s_add_u32 s62, s62, 0x40000
    s_and_b32 s62, s62, 0x7fffff
    v_mfma_f32_16x16x32_bf16 v[152:155], a[108:111], a[152:155], v[152:155]
    v_mfma_f32_16x16x32_bf16 v[152:155], a[76:79], a[144:147], v[152:155]
    s_waitcnt vmcnt(12) lgkmcnt(0)
    s_barrier
    v_mfma_f32_16x16x32_bf16 v[160:163], a[16:19], a[160:163], v[160:163]
    s_add_u32 m0, s60, 16384
    buffer_load_dword v74, v73, s[16:19], s59 offen sc1
    ds_read_b64_tr_b16 a[64:65], v64 offset:49152
    v_mfma_f32_16x16x32_bf16 v[160:163], a[48:51], a[168:171], v[160:163]
    buffer_load_dwordx4 v90, s[12:15], s61 offen offset:0 lds
    ds_read_b64_tr_b16 a[66:67], v64 offset:53248
    v_mfma_f32_16x16x32_bf16 v[164:167], a[48:51], a[172:175], v[164:167]
    ds_read_b64_tr_b16 a[68:69], v65 offset:49152
    ds_read_b64_tr_b16 a[70:71], v65 offset:53248
    v_mfma_f32_16x16x32_bf16 v[164:167], a[16:19], a[164:167], v[164:167]
    ds_read_b64_tr_b16 a[72:73], v66 offset:49152
    ds_read_b64_tr_b16 a[74:75], v66 offset:53248
    v_mfma_f32_16x16x32_bf16 v[172:175], a[20:23], a[164:167], v[172:175]
    buffer_load_dwordx4 v91, s[12:15], s61 offen offset:1024 lds
    ds_read_b64_tr_b16 a[76:77], v67 offset:49152
    v_mfma_f32_16x16x32_bf16 v[172:175], a[52:55], a[172:175], v[172:175]
    ds_read_b64_tr_b16 a[78:79], v67 offset:53248
    ds_read_b64_tr_b16 a[80:81], v68 offset:49152
    v_mfma_f32_16x16x32_bf16 v[168:171], a[52:55], a[168:171], v[168:171]
    ds_read_b64_tr_b16 a[82:83], v68 offset:53248
    v_mfma_f32_16x16x32_bf16 v[168:171], a[20:23], a[160:163], v[168:171]
    buffer_load_dwordx4 v92, s[12:15], s61 offen offset:2048 lds
    ds_read_b64_tr_b16 a[84:85], v69 offset:49152
    v_mfma_f32_16x16x32_bf16 v[176:179], a[24:27], a[160:163], v[176:179]
    ds_read_b64_tr_b16 a[86:87], v69 offset:53248
    ds_read_b64_tr_b16 a[88:89], v70 offset:49152
    v_mfma_f32_16x16x32_bf16 v[176:179], a[56:59], a[168:171], v[176:179]
    ds_read_b64_tr_b16 a[90:91], v70 offset:53248
    v_mfma_f32_16x16x32_bf16 v[180:183], a[56:59], a[172:175], v[180:183]
    buffer_load_dwordx4 v93, s[12:15], s61 offen offset:3072 lds
    ds_read_b64_tr_b16 a[92:93], v71 offset:49152
    v_mfma_f32_16x16x32_bf16 v[180:183], a[24:27], a[164:167], v[180:183]
    ds_read_b64_tr_b16 a[94:95], v71 offset:53248
    ds_read_b64_tr_b16 a[96:97], v64 offset:57344
    v_mfma_f32_16x16x32_bf16 v[188:191], a[28:31], a[164:167], v[188:191]
    ds_read_b64_tr_b16 a[98:99], v64 offset:61440
    v_mfma_f32_16x16x32_bf16 v[188:191], a[60:63], a[172:175], v[188:191]
    ds_read_b64_tr_b16 a[100:101], v65 offset:57344
    v_mfma_f32_16x16x32_bf16 v[184:187], a[60:63], a[168:171], v[184:187]
    buffer_load_dwordx4 a[144:147], v88, s[8:11], s62 offen offset:0 sc1
    ds_read_b64_tr_b16 a[102:103], v65 offset:61440
    v_mfma_f32_16x16x32_bf16 v[184:187], a[28:31], a[160:163], v[184:187]
    s_add_u32 s61, s61, 0x20000
    s_and_b32 s61, s61, 0x3fffff
    ds_read_b64_tr_b16 a[104:105], v66 offset:57344
    ds_read_b64_tr_b16 a[106:107], v66 offset:61440
    v_mfma_f32_16x16x32_bf16 v[128:131], a[0:3], a[160:163], v[128:131]
    ds_read_b64_tr_b16 a[108:109], v67 offset:57344
    v_mfma_f32_16x16x32_bf16 v[128:131], a[32:35], a[168:171], v[128:131]
    buffer_load_dwordx4 a[148:151], v88, s[8:11], s62 offen offset:1024 sc1
    ds_read_b64_tr_b16 a[110:111], v67 offset:61440
    v_mfma_f32_16x16x32_bf16 v[132:135], a[32:35], a[172:175], v[132:135]
    ds_read_b64_tr_b16 a[112:113], v68 offset:57344
    v_mfma_f32_16x16x32_bf16 v[132:135], a[0:3], a[164:167], v[132:135]
    ds_read_b64_tr_b16 a[114:115], v68 offset:61440
    ds_read_b64_tr_b16 a[116:117], v69 offset:57344
    v_mfma_f32_16x16x32_bf16 v[140:143], a[4:7], a[164:167], v[140:143]
    ds_read_b64_tr_b16 a[118:119], v69 offset:61440
    v_mfma_f32_16x16x32_bf16 v[140:143], a[36:39], a[172:175], v[140:143]
    buffer_load_dwordx4 a[152:155], v89, s[8:11], s62 offen offset:0 sc1
    ds_read_b64_tr_b16 a[120:121], v70 offset:57344
    v_mfma_f32_16x16x32_bf16 v[136:139], a[36:39], a[168:171], v[136:139]
    ds_read_b64_tr_b16 a[122:123], v70 offset:61440
    ds_read_b64_tr_b16 a[124:125], v71 offset:57344
    v_mfma_f32_16x16x32_bf16 v[136:139], a[4:7], a[160:163], v[136:139]
    ds_read_b64_tr_b16 a[126:127], v71 offset:61440
    v_mfma_f32_16x16x32_bf16 v[144:147], a[8:11], a[160:163], v[144:147]
    buffer_load_dwordx4 a[156:159], v89, s[8:11], s62 offen offset:1024 sc1
    v_mfma_f32_16x16x32_bf16 v[144:147], a[40:43], a[168:171], v[144:147]
    v_mfma_f32_16x16x32_bf16 v[148:151], a[40:43], a[172:175], v[148:151]
    v_mfma_f32_16x16x32_bf16 v[148:151], a[8:11], a[164:167], v[148:151]
    v_mfma_f32_16x16x32_bf16 v[156:159], a[12:15], a[164:167], v[156:159]
    v_mfma_f32_16x16x32_bf16 v[156:159], a[44:47], a[172:175], v[156:159]
    s_add_u32 s62, s62, 0x40000
    s_and_b32 s62, s62, 0x7fffff
    v_mfma_f32_16x16x32_bf16 v[152:155], a[44:47], a[168:171], v[152:155]
    v_mfma_f32_16x16x32_bf16 v[152:155], a[12:15], a[160:163], v[152:155]
    s_waitcnt vmcnt(12) lgkmcnt(0)
    s_barrier
    v_mfma_f32_16x16x32_bf16 v[160:163], a[80:83], a[176:179], v[160:163]
    s_add_u32 m0, s60, 32768
    ds_read_b64_tr_b16 a[0:1], v64 offset:0
    ds_read_b64_tr_b16 a[2:3], v64 offset:4096
    v_mfma_f32_16x16x32_bf16 v[160:163], a[112:115], a[184:187], v[160:163]
    buffer_load_dwordx4 v90, s[12:15], s61 offen offset:0 lds
    ds_read_b64_tr_b16 a[4:5], v65 offset:0
    v_mfma_f32_16x16x32_bf16 v[164:167], a[112:115], a[188:191], v[164:167]
    ds_read_b64_tr_b16 a[6:7], v65 offset:4096
    ds_read_b64_tr_b16 a[8:9], v66 offset:0
    v_mfma_f32_16x16x32_bf16 v[164:167], a[80:83], a[180:183], v[164:167]
    buffer_load_dwordx4 v91, s[12:15], s61 offen offset:1024 lds
    ds_read_b64_tr_b16 a[10:11], v66 offset:4096
    v_mfma_f32_16x16x32_bf16 v[172:175], a[84:87], a[180:183], v[172:175]
    ds_read_b64_tr_b16 a[12:13], v67 offset:0
    ds_read_b64_tr_b16 a[14:15], v67 offset:4096
    v_mfma_f32_16x16x32_bf16 v[172:175], a[116:119], a[188:191], v[172:175]
    ds_read_b64_tr_b16 a[16:17], v68 offset:0
    v_mfma_f32_16x16x32_bf16 v[168:171], a[116:119], a[184:187], v[168:171]
    ds_read_b64_tr_b16 a[18:19], v68 offset:4096
    v_mfma_f32_16x16x32_bf16 v[168:171], a[84:87], a[176:179], v[168:171]
    buffer_load_dwordx4 v92, s[12:15], s61 offen offset:2048 lds
    ds_read_b64_tr_b16 a[20:21], v69 offset:0
    v_mfma_f32_16x16x32_bf16 v[176:179], a[88:91], a[176:179], v[176:179]
    ds_read_b64_tr_b16 a[22:23], v69 offset:4096
    ds_read_b64_tr_b16 a[24:25], v70 offset:0
    v_mfma_f32_16x16x32_bf16 v[176:179], a[120:123], a[184:187], v[176:179]
    ds_read_b64_tr_b16 a[26:27], v70 offset:4096
    v_mfma_f32_16x16x32_bf16 v[180:183], a[120:123], a[188:191], v[180:183]
    buffer_load_dwordx4 v93, s[12:15], s61 offen offset:3072 lds
    ds_read_b64_tr_b16 a[28:29], v71 offset:0
    v_mfma_f32_16x16x32_bf16 v[180:183], a[88:91], a[180:183], v[180:183]
    ds_read_b64_tr_b16 a[30:31], v71 offset:4096
    ds_read_b64_tr_b16 a[32:33], v64 offset:8192
    v_mfma_f32_16x16x32_bf16 v[188:191], a[92:95], a[180:183], v[188:191]
    ds_read_b64_tr_b16 a[34:35], v64 offset:12288
    v_mfma_f32_16x16x32_bf16 v[188:191], a[124:127], a[188:191], v[188:191]
    ds_read_b64_tr_b16 a[36:37], v65 offset:8192
    v_mfma_f32_16x16x32_bf16 v[184:187], a[124:127], a[184:187], v[184:187]
    buffer_load_dwordx4 a[160:163], v88, s[8:11], s62 offen offset:0 sc1
    ds_read_b64_tr_b16 a[38:39], v65 offset:12288
    v_mfma_f32_16x16x32_bf16 v[184:187], a[92:95], a[176:179], v[184:187]
    s_add_u32 s61, s61, 0x20000
    s_and_b32 s61, s61, 0x3fffff
    ds_read_b64_tr_b16 a[40:41], v66 offset:8192
    ds_read_b64_tr_b16 a[42:43], v66 offset:12288
    v_mfma_f32_16x16x32_bf16 v[128:131], a[64:67], a[176:179], v[128:131]
    ds_read_b64_tr_b16 a[44:45], v67 offset:8192
    v_mfma_f32_16x16x32_bf16 v[128:131], a[96:99], a[184:187], v[128:131]
    buffer_load_dwordx4 a[164:167], v88, s[8:11], s62 offen offset:1024 sc1
    ds_read_b64_tr_b16 a[46:47], v67 offset:12288
    v_mfma_f32_16x16x32_bf16 v[132:135], a[96:99], a[188:191], v[132:135]
    ds_read_b64_tr_b16 a[48:49], v68 offset:8192
    v_mfma_f32_16x16x32_bf16 v[132:135], a[64:67], a[180:183], v[132:135]
    ds_read_b64_tr_b16 a[50:51], v68 offset:12288
    ds_read_b64_tr_b16 a[52:53], v69 offset:8192
    v_mfma_f32_16x16x32_bf16 v[140:143], a[68:71], a[180:183], v[140:143]
    ds_read_b64_tr_b16 a[54:55], v69 offset:12288
    v_mfma_f32_16x16x32_bf16 v[140:143], a[100:103], a[188:191], v[140:143]
    buffer_load_dwordx4 a[168:171], v89, s[8:11], s62 offen offset:0 sc1
    ds_read_b64_tr_b16 a[56:57], v70 offset:8192
    v_mfma_f32_16x16x32_bf16 v[136:139], a[100:103], a[184:187], v[136:139]
    ds_read_b64_tr_b16 a[58:59], v70 offset:12288
    ds_read_b64_tr_b16 a[60:61], v71 offset:8192
    v_mfma_f32_16x16x32_bf16 v[136:139], a[68:71], a[176:179], v[136:139]
    ds_read_b64_tr_b16 a[62:63], v71 offset:12288
    v_mfma_f32_16x16x32_bf16 v[144:147], a[72:75], a[176:179], v[144:147]
    buffer_load_dwordx4 a[172:175], v89, s[8:11], s62 offen offset:1024 sc1
    v_mfma_f32_16x16x32_bf16 v[144:147], a[104:107], a[184:187], v[144:147]
    v_mfma_f32_16x16x32_bf16 v[148:151], a[104:107], a[188:191], v[148:151]
    v_mfma_f32_16x16x32_bf16 v[148:151], a[72:75], a[180:183], v[148:151]
    v_mfma_f32_16x16x32_bf16 v[156:159], a[76:79], a[180:183], v[156:159]
    v_mfma_f32_16x16x32_bf16 v[156:159], a[108:111], a[188:191], v[156:159]
    s_add_u32 s62, s62, 0x40000
    s_and_b32 s62, s62, 0x7fffff
    v_mfma_f32_16x16x32_bf16 v[152:155], a[108:111], a[184:187], v[152:155]
    s_add_u32 s63, s63, 1
    v_mfma_f32_16x16x32_bf16 v[152:155], a[76:79], a[176:179], v[152:155]
    s_waitcnt vmcnt(12) lgkmcnt(0)
    s_barrier
    s_cmp_lt_u32 s63, 8
    s_cbranch_scc1 op_loop_134
op_tail:
    s_nop 1
    v_cvt_pk_bf16_f32 v160, v160, v161
    v_cvt_pk_bf16_f32 v161, v162, v163
    v_cvt_pk_bf16_f32 v162, v164, v165
    v_cvt_pk_bf16_f32 v163, v166, v167
    v_min_u32 v160, -2, v160
    v_min_u32 v161, -2, v161
    v_min_u32 v162, -2, v162
    v_min_u32 v163, -2, v163
    buffer_store_dwordx4 v[160:163], v1, s[36:39], s52 offen offset:0 sc1
    v_cvt_pk_bf16_f32 v168, v168, v169
    v_cvt_pk_bf16_f32 v169, v170, v171
    v_cvt_pk_bf16_f32 v170, v172, v173
    v_cvt_pk_bf16_f32 v171, v174, v175
    v_min_u32 v168, -2, v168
    v_min_u32 v169, -2, v169
    v_min_u32 v170, -2, v170
    v_min_u32 v171, -2, v171
    buffer_store_dwordx4 v[168:171], v1, s[36:39], s52 offen offset:1024 sc1
    v_cvt_pk_bf16_f32 v176, v176, v177
    v_cvt_pk_bf16_f32 v177, v178, v179
    v_cvt_pk_bf16_f32 v178, v180, v181
    v_cvt_pk_bf16_f32 v179, v182, v183
    v_min_u32 v176, -2, v176
    v_min_u32 v177, -2, v177
    v_min_u32 v178, -2, v178
    v_min_u32 v179, -2, v179
    buffer_store_dwordx4 v[176:179], v1, s[36:39], s52 offen offset:2048 sc1
    v_cvt_pk_bf16_f32 v184, v184, v185
    v_cvt_pk_bf16_f32 v185, v186, v187
    v_cvt_pk_bf16_f32 v186, v188, v189
    v_cvt_pk_bf16_f32 v187, v190, v191
    v_min_u32 v184, -2, v184
    v_min_u32 v185, -2, v185
    v_min_u32 v186, -2, v186
    v_min_u32 v187, -2, v187
    buffer_store_dwordx4 v[184:187], v1, s[36:39], s52 offen offset:3072 sc1
    s_add_u32 s32, s6, 0x4800000
    s_addc_u32 s33, s7, 0
    s_and_b32 s33, s33, 0xffff
    s_mov_b32 s34, 0x6000
    s_mov_b32 s35, 0x00020000
    s_waitcnt vmcnt(4) lgkmcnt(0)
    v_lshlrev_b32 v58, 16, v192
    v_and_b32 v59, 0xffff0000, v192
    v_pk_add_f32 v[128:129], v[128:129], v[58:59]
    v_lshlrev_b32 v58, 16, v193
    v_and_b32 v59, 0xffff0000, v193
    v_pk_add_f32 v[130:131], v[130:131], v[58:59]
    v_lshlrev_b32 v58, 16, v200
    v_and_b32 v59, 0xffff0000, v200
    v_pk_add_f32 v[132:133], v[132:133], v[58:59]
    v_lshlrev_b32 v58, 16, v201
    v_and_b32 v59, 0xffff0000, v201
    v_pk_add_f32 v[134:135], v[134:135], v[58:59]
    v_lshlrev_b32 v58, 16, v194
    v_and_b32 v59, 0xffff0000, v194
    v_pk_add_f32 v[136:137], v[136:137], v[58:59]
    v_lshlrev_b32 v58, 16, v195
    v_and_b32 v59, 0xffff0000, v195
    v_pk_add_f32 v[138:139], v[138:139], v[58:59]
    v_lshlrev_b32 v58, 16, v202
    v_and_b32 v59, 0xffff0000, v202
    v_pk_add_f32 v[140:141], v[140:141], v[58:59]
    v_lshlrev_b32 v58, 16, v203
    v_and_b32 v59, 0xffff0000, v203
    v_pk_add_f32 v[142:143], v[142:143], v[58:59]
    v_lshlrev_b32 v58, 16, v196
    v_and_b32 v59, 0xffff0000, v196
    v_pk_add_f32 v[144:145], v[144:145], v[58:59]
    v_lshlrev_b32 v58, 16, v197
    v_and_b32 v59, 0xffff0000, v197
    v_pk_add_f32 v[146:147], v[146:147], v[58:59]
    v_lshlrev_b32 v58, 16, v204
    v_and_b32 v59, 0xffff0000, v204
    v_pk_add_f32 v[148:149], v[148:149], v[58:59]
    v_lshlrev_b32 v58, 16, v205
    v_and_b32 v59, 0xffff0000, v205
    v_pk_add_f32 v[150:151], v[150:151], v[58:59]
    v_lshlrev_b32 v58, 16, v198
    v_and_b32 v59, 0xffff0000, v198
    v_pk_add_f32 v[152:153], v[152:153], v[58:59]
    v_lshlrev_b32 v58, 16, v199
    v_and_b32 v59, 0xffff0000, v199
    v_pk_add_f32 v[154:155], v[154:155], v[58:59]
    v_lshlrev_b32 v58, 16, v206
    v_and_b32 v59, 0xffff0000, v206
    v_pk_add_f32 v[156:157], v[156:157], v[58:59]
    v_lshlrev_b32 v58, 16, v207
    v_and_b32 v59, 0xffff0000, v207
    v_pk_add_f32 v[158:159], v[158:159], v[58:59]
    v_and_b32 v58, 1, v72
    v_lshrrev_b32 v59, 1, v72
    v_lshlrev_b32 v58, 5, v58
    v_lshl_add_u32 v58, v59, 4, v58
    v_lshlrev_b32 v59, 3, v72
    v_sub_u32 v58, v58, v59
    v_add_u32 v78, v78, v58
    v_add_u32 v79, v79, v58
    v_lshlrev_b32 v32, 16, v208
    v_and_b32 v33, 0xffff0000, v208
    v_lshlrev_b32 v34, 16, v209
    v_and_b32 v35, 0xffff0000, v209
    v_lshlrev_b32 v36, 16, v210
    v_and_b32 v37, 0xffff0000, v210
    v_lshlrev_b32 v38, 16, v211
    v_and_b32 v39, 0xffff0000, v211
    v_lshlrev_b32 v40, 16, v212
    v_and_b32 v41, 0xffff0000, v212
    v_lshlrev_b32 v42, 16, v213
    v_and_b32 v43, 0xffff0000, v213
    v_lshlrev_b32 v44, 16, v214
    v_and_b32 v45, 0xffff0000, v214
    v_lshlrev_b32 v46, 16, v215
    v_and_b32 v47, 0xffff0000, v215
    s_or_b32 s31, s54, s30
    s_cbranch_scc1 op_nowr_145
    v_pk_add_f32 v[56:57], v[32:33], v[34:35]
    v_pk_add_f32 v[56:57], v[56:57], v[36:37]
    v_pk_add_f32 v[56:57], v[56:57], v[38:39]
    v_pk_add_f32 v[56:57], v[56:57], v[40:41]
    v_pk_add_f32 v[56:57], v[56:57], v[42:43]
    v_pk_add_f32 v[56:57], v[56:57], v[44:45]
    v_pk_add_f32 v[56:57], v[56:57], v[46:47]
    v_add_f32 v56, v56, v57
    v_mov_b32 v57, v56
    s_nop 1
    v_permlane16_swap_b32 v56, v57
    s_nop 1
    v_add_f32 v56, v56, v57
    v_mov_b32 v57, v56
    s_nop 1
    v_permlane32_swap_b32 v56, v57
    s_nop 1
    v_add_f32 v56, v56, v57
    s_mov_b32 s31, 24704
    s_mov_b32 s34, 24708
    s_mov_b64 exec, 1
    buffer_atomic_add_f32 v56, v75, s[32:35], s31 offen
    s_mov_b64 exec, -1
    s_mov_b32 s34, 24576
op_nowr_145:
    v_mov_b32 v208, 0
    v_mov_b32 v209, 0
    v_mov_b32 v210, 0
    v_mov_b32 v211, 0
    v_mov_b32 v212, 0
    v_mov_b32 v213, 0
    v_mov_b32 v214, 0
    v_mov_b32 v215, 0
    v_mov_b32 v216, 0
    v_mov_b32 v217, 0
    v_mov_b32 v218, 0
    v_mov_b32 v219, 0
    s_mov_b32 s40, 1048576
op_xspin_146:
    buffer_load_dwordx4 v[224:227], v1, s[36:39], s53 offen offset:0 sc1
    buffer_load_dwordx4 v[228:231], v1, s[36:39], s53 offen offset:1024 sc1
    buffer_load_dwordx4 v[232:235], v1, s[36:39], s53 offen offset:2048 sc1
    buffer_load_dwordx4 v[236:239], v1, s[36:39], s53 offen offset:3072 sc1
    s_sub_u32 s40, s40, 1
    s_waitcnt vmcnt(0)
    s_cbranch_scc1 op_xok_147
    v_max3_u32 v56, v224, v225, v226
    v_max3_u32 v56, v56, v227, v228
    v_max3_u32 v56, v56, v229, v230
    v_max3_u32 v56, v56, v231, v232
    v_max3_u32 v56, v56, v233, v234
    v_max3_u32 v56, v56, v235, v236
    v_max3_u32 v56, v56, v237, v238
    v_max_u32 v56, v56, v239
    v_cmp_eq_u32 vcc, -1, v56
    s_cbranch_vccz op_xok_147
    s_sleep 2
    s_branch op_xspin_146
op_xok_147:
    v_lshlrev_b32 v56, 16, v224
    v_and_b32 v57, 0xffff0000, v224
    v_lshlrev_b32 v58, 16, v225
    v_and_b32 v59, 0xffff0000, v225
    v_pk_add_f32 v[128:129], v[128:129], v[56:57]
    v_pk_add_f32 v[130:131], v[130:131], v[58:59]
    v_cvt_pk_bf16_f32 v192, v128, v129
    v_cvt_pk_bf16_f32 v193, v130, v131
    v_lshlrev_b32 v128, 16, v192
    v_and_b32 v129, 0xffff0000, v192
    v_lshlrev_b32 v130, 16, v193
    v_and_b32 v131, 0xffff0000, v193
    v_pk_add_f32 v[208:209], v[208:209], v[128:129]
    v_pk_fma_f32 v[210:211], v[128:129], v[128:129], v[210:211]
    v_pk_fma_f32 v[212:213], v[128:129], v[32:33], v[212:213]
    v_pk_add_f32 v[208:209], v[208:209], v[130:131]
    v_pk_fma_f32 v[210:211], v[130:131], v[130:131], v[210:211]
    v_pk_fma_f32 v[212:213], v[130:131], v[34:35], v[212:213]
    v_lshlrev_b32 v56, 16, v226
    v_and_b32 v57, 0xffff0000, v226
    v_lshlrev_b32 v58, 16, v227
    v_and_b32 v59, 0xffff0000, v227
    v_pk_add_f32 v[132:133], v[132:133], v[56:57]
    v_pk_add_f32 v[134:135], v[134:135], v[58:59]
    v_cvt_pk_bf16_f32 v200, v132, v133
    v_cvt_pk_bf16_f32 v201, v134, v135
    v_lshlrev_b32 v132, 16, v200
    v_and_b32 v133, 0xffff0000, v200
    v_lshlrev_b32 v134, 16, v201
    v_and_b32 v135, 0xffff0000, v201
    v_pk_add_f32 v[214:215], v[214:215], v[132:133]
    v_pk_fma_f32 v[216:217], v[132:133], v[132:133], v[216:217]
    v_pk_fma_f32 v[218:219], v[132:133], v[32:33], v[218:219]
    v_pk_add_f32 v[214:215], v[214:215], v[134:135]
    v_pk_fma_f32 v[216:217], v[134:135], v[134:135], v[216:217]
    v_pk_fma_f32 v[218:219], v[134:135], v[34:35], v[218:219]
    v_lshlrev_b32 v56, 16, v228
    v_and_b32 v57, 0xffff0000, v228
    v_lshlrev_b32 v58, 16, v229
    v_and_b32 v59, 0xffff0000, v229
    v_pk_add_f32 v[136:137], v[136:137], v[56:57]
    v_pk_add_f32 v[138:139], v[138:139], v[58:59]
    v_cvt_pk_bf16_f32 v194, v136, v137
    v_cvt_pk_bf16_f32 v195, v138, v139
    v_lshlrev_b32 v136, 16, v194
    v_and_b32 v137, 0xffff0000, v194
    v_lshlrev_b32 v138, 16, v195
    v_and_b32 v139, 0xffff0000, v195
    v_permlane16_swap_b32 v192, v194
    v_permlane16_swap_b32 v193, v195
    buffer_store_dwordx4 v[192:195], v78, s[24:27], 0 offen offset:0 sc1
    v_pk_add_f32 v[208:209], v[208:209], v[136:137]
    v_pk_fma_f32 v[210:211], v[136:137], v[136:137], v[210:211]
    v_pk_fma_f32 v[212:213], v[136:137], v[36:37], v[212:213]
    v_pk_add_f32 v[208:209], v[208:209], v[138:139]
    v_pk_fma_f32 v[210:211], v[138:139], v[138:139], v[210:211]
    v_pk_fma_f32 v[212:213], v[138:139], v[38:39], v[212:213]
    v_lshlrev_b32 v56, 16, v230
    v_and_b32 v57, 0xffff0000, v230
    v_lshlrev_b32 v58, 16, v231
    v_and_b32 v59, 0xffff0000, v231
    v_pk_add_f32 v[140:141], v[140:141], v[56:57]
    v_pk_add_f32 v[142:143], v[142:143], v[58:59]
    v_cvt_pk_bf16_f32 v202, v140, v141
    v_cvt_pk_bf16_f32 v203, v142, v143
    v_lshlrev_b32 v140, 16, v202
    v_and_b32 v141, 0xffff0000, v202
    v_lshlrev_b32 v142, 16, v203
    v_and_b32 v143, 0xffff0000, v203
    v_permlane16_swap_b32 v200, v202
    v_permlane16_swap_b32 v201, v203
    buffer_store_dwordx4 v[200:203], v79, s[24:27], 0 offen offset:0 sc1
    v_pk_add_f32 v[214:215], v[214:215], v[140:141]
    v_pk_fma_f32 v[216:217], v[140:141], v[140:141], v[216:217]
    v_pk_fma_f32 v[218:219], v[140:141], v[36:37], v[218:219]
    v_pk_add_f32 v[214:215], v[214:215], v[142:143]
    v_pk_fma_f32 v[216:217], v[142:143], v[142:143], v[216:217]
    v_pk_fma_f32 v[218:219], v[142:143], v[38:39], v[218:219]
    v_lshlrev_b32 v56, 16, v232
    v_and_b32 v57, 0xffff0000, v232
    v_lshlrev_b32 v58, 16, v233
    v_and_b32 v59, 0xffff0000, v233
    v_pk_add_f32 v[144:145], v[144:145], v[56:57]
    v_pk_add_f32 v[146:147], v[146:147], v[58:59]
    v_cvt_pk_bf16_f32 v196, v144, v145
    v_cvt_pk_bf16_f32 v197, v146, v147
    v_lshlrev_b32 v144, 16, v196
    v_and_b32 v145, 0xffff0000, v196
    v_lshlrev_b32 v146, 16, v197
    v_and_b32 v147, 0xffff0000, v197
    v_pk_add_f32 v[208:209], v[208:209], v[144:145]
    v_pk_fma_f32 v[210:211], v[144:145], v[144:145], v[210:211]
    v_pk_fma_f32 v[212:213], v[144:145], v[40:41], v[212:213]
    v_pk_add_f32 v[208:209], v[208:209], v[146:147]
    v_pk_fma_f32 v[210:211], v[146:147], v[146:147], v[210:211]
    v_pk_fma_f32 v[212:213], v[146:147], v[42:43], v[212:213]
    v_lshlrev_b32 v56, 16, v234
    v_and_b32 v57, 0xffff0000, v234
    v_lshlrev_b32 v58, 16, v235
    v_and_b32 v59, 0xffff0000, v235
    v_pk_add_f32 v[148:149], v[148:149], v[56:57]
    v_pk_add_f32 v[150:151], v[150:151], v[58:59]
    v_cvt_pk_bf16_f32 v204, v148, v149
    v_cvt_pk_bf16_f32 v205, v150, v151
    v_lshlrev_b32 v148, 16, v204
    v_and_b32 v149, 0xffff0000, v204
    v_lshlrev_b32 v150, 16, v205
    v_and_b32 v151, 0xffff0000, v205
    v_pk_add_f32 v[214:215], v[214:215], v[148:149]
    v_pk_fma_f32 v[216:217], v[148:149], v[148:149], v[216:217]
    v_pk_fma_f32 v[218:219], v[148:149], v[40:41], v[218:219]
    v_pk_add_f32 v[214:215], v[214:215], v[150:151]
    v_pk_fma_f32 v[216:217], v[150:151], v[150:151], v[216:217]
    v_pk_fma_f32 v[218:219], v[150:151], v[42:43], v[218:219]
    v_lshlrev_b32 v56, 16, v236
    v_and_b32 v57, 0xffff0000, v236
    v_lshlrev_b32 v58, 16, v237
    v_and_b32 v59, 0xffff0000, v237
    v_pk_add_f32 v[152:153], v[152:153], v[56:57]
    v_pk_add_f32 v[154:155], v[154:155], v[58:59]
    v_cvt_pk_bf16_f32 v198, v152, v153
    v_cvt_pk_bf16_f32 v199, v154, v155
    v_lshlrev_b32 v152, 16, v198
    v_and_b32 v153, 0xffff0000, v198
    v_lshlrev_b32 v154, 16, v199
    v_and_b32 v155, 0xffff0000, v199
    v_permlane16_swap_b32 v196, v198
    v_permlane16_swap_b32 v197, v199
    buffer_store_dwordx4 v[196:199], v78, s[24:27], 0 offen offset:64 sc1
    v_pk_add_f32 v[208:209], v[208:209], v[152:153]
    v_pk_fma_f32 v[210:211], v[152:153], v[152:153], v[210:211]
    v_pk_fma_f32 v[212:213], v[152:153], v[44:45], v[212:213]
    v_pk_add_f32 v[208:209], v[208:209], v[154:155]
    v_pk_fma_f32 v[210:211], v[154:155], v[154:155], v[210:211]
    v_pk_fma_f32 v[212:213], v[154:155], v[46:47], v[212:213]
    v_lshlrev_b32 v56, 16, v238
    v_and_b32 v57, 0xffff0000, v238
    v_lshlrev_b32 v58, 16, v239
    v_and_b32 v59, 0xffff0000, v239
    v_pk_add_f32 v[156:157], v[156:157], v[56:57]
    v_pk_add_f32 v[158:159], v[158:159], v[58:59]
    v_cvt_pk_bf16_f32 v206, v156, v157
    v_cvt_pk_bf16_f32 v207, v158, v159
    v_lshlrev_b32 v156, 16, v206
    v_and_b32 v157, 0xffff0000, v206
    v_lshlrev_b32 v158, 16, v207
    v_and_b32 v159, 0xffff0000, v207
    v_permlane16_swap_b32 v204, v206
    v_permlane16_swap_b32 v205, v207
    buffer_store_dwordx4 v[204:207], v79, s[24:27], 0 offen offset:64 sc1
    v_pk_add_f32 v[214:215], v[214:215], v[156:157]
    v_pk_fma_f32 v[216:217], v[156:157], v[156:157], v[216:217]
    v_pk_fma_f32 v[218:219], v[156:157], v[44:45], v[218:219]
    v_pk_add_f32 v[214:215], v[214:215], v[158:159]
    v_pk_fma_f32 v[216:217], v[158:159], v[158:159], v[216:217]
    v_pk_fma_f32 v[218:219], v[158:159], v[46:47], v[218:219]
    v_add_f32 v48, v208, v209
    v_add_f32 v49, v210, v211
    v_add_f32 v50, v212, v213
    v_add_f32 v52, v214, v215
    v_add_f32 v53, v216, v217
    v_add_f32 v54, v218, v219
    v_mov_b32 v56, v48
    v_mov_b32 v57, v49
    v_mov_b32 v58, v50
    v_mov_b32 v59, v52
    v_mov_b32 v60, v53
    v_mov_b32 v61, v54
    s_nop 1
    v_permlane16_swap_b32 v48, v56
    v_permlane16_swap_b32 v49, v57
    v_permlane16_swap_b32 v50, v58
    v_permlane16_swap_b32 v52, v59
    v_permlane16_swap_b32 v53, v60
    v_permlane16_swap_b32 v54, v61
    s_nop 1
    v_add_f32 v48, v48, v56
    v_add_f32 v49, v49, v57
    v_add_f32 v50, v50, v58
    v_add_f32 v52, v52, v59
    v_add_f32 v53, v53, v60
    v_add_f32 v54, v54, v61
    v_mov_b32 v56, v48
    v_mov_b32 v57, v49
    v_mov_b32 v58, v50
    v_mov_b32 v59, v52
    v_mov_b32 v60, v53
    v_mov_b32 v61, v54
    s_nop 1
    v_permlane32_swap_b32 v48, v56
    v_permlane32_swap_b32 v49, v57
    v_permlane32_swap_b32 v50, v58
    v_permlane32_swap_b32 v52, v59
    v_permlane32_swap_b32 v53, v60
    v_permlane32_swap_b32 v54, v61
    s_nop 1
    v_add_f32 v48, v48, v56
    v_add_f32 v49, v49, v57
    v_add_f32 v50, v50, v58
    v_add_f32 v52, v52, v59
    v_add_f32 v53, v53, v60
    v_add_f32 v54, v54, v61
    v_cmp_eq_u32 s[40:41], 1, v72
    v_cmp_eq_u32 s[42:43], 2, v72
    s_nop 1
    v_cndmask_b32 v48, v48, v49, s[40:41]
    v_cndmask_b32 v48, v48, v50, s[42:43]
    buffer_atomic_add_f32 v48, v77, s[32:35], 0 offen offset:0
    v_cndmask_b32 v52, v52, v53, s[40:41]
    v_cndmask_b32 v52, v52, v54, s[42:43]
    buffer_atomic_add_f32 v52, v77, s[32:35], 0 offen offset:64
    s_load_dwordx2 s[42:43], s[0:1], 88
    s_load_dwordx2 s[56:57], s[0:1], 56
    s_add_u32 s16, s6, 0x4815000
    s_addc_u32 s17, s7, 0
    s_and_b32 s17, s17, 0xffff
    s_mov_b32 s18, 0x1000
    s_mov_b32 s19, 0x00020000
    v_lshrrev_b32 v3, 4, v1
    v_lshl_add_u32 v2, s30, 6, v3
    v_and_b32 v4, 31, v3
    v_lshrrev_b32 v5, 5, v3
    v_lshlrev_b32 v7, 4, v4
    v_and_b32 v8, 15, v3
    v_lshlrev_b32 v6, 7, v8
    s_bfe_u32 s31, s2, 0x20003
    s_lshl_b32 s31, s31, 7
    v_lshlrev_b32 v12, 9, v3
    v_and_b32 v14, 3, v3
    v_lshlrev_b32 v14, 7, v14
    s_and_b32 s59, s2, 7
    s_lshl_b32 s59, s59, 9
    s_setreg_imm32_b32 hwreg(HW_REG_MODE, 4, 2), 3
    s_waitcnt vmcnt(0) lgkmcnt(0)
    s_barrier
    s_cmp_lg_u32 s30, 0
    s_cbranch_scc1 ff_nosig_148
    s_mov_b64 exec, 0xff
    buffer_atomic_add v76, v12, s[16:19], s31 offen sc1
    s_mov_b64 exec, -1
ff_nosig_148:
    s_lshl_b32 s40, s30, 13
    s_add_u32 m0, s40, 65536
    s_add_u32 s41, s3, 0
    buffer_load_dwordx4 v1, s[44:47], s41 offen offset:0 sc1 lds
    buffer_load_dwordx4 v1, s[44:47], s41 offen offset:1024 sc1 lds
    buffer_load_dwordx4 v1, s[44:47], s41 offen offset:2048 sc1 lds
    buffer_load_dwordx4 v1, s[44:47], s41 offen offset:3072 sc1 lds
    s_waitcnt vmcnt(0)
    s_lshl_b32 s40, s30, 13
    s_add_u32 m0, s40, 69632
    s_add_u32 s41, s3, 4096
    buffer_load_dwordx4 v1, s[44:47], s41 offen offset:0 sc1 lds
    buffer_load_dwordx4 v1, s[44:47], s41 offen offset:1024 sc1 lds
    buffer_load_dwordx4 v1, s[44:47], s41 offen offset:2048 sc1 lds
    buffer_load_dwordx4 v1, s[44:47], s41 offen offset:3072 sc1 lds
    s_waitcnt vmcnt(0)
    s_lshl_b32 s40, s30, 13
    s_add_u32 m0, s40, 98304
    s_add_u32 s41, s3, 8388608
    buffer_load_dwordx4 v1, s[44:47], s41 offen offset:0 sc1 lds
    buffer_load_dwordx4 v1, s[44:47], s41 offen offset:1024 sc1 lds
    buffer_load_dwordx4 v1, s[44:47], s41 offen offset:2048 sc1 lds
    buffer_load_dwordx4 v1, s[44:47], s41 offen offset:3072 sc1 lds
    s_waitcnt vmcnt(0)
    s_lshl_b32 s40, s30, 13
    s_add_u32 m0, s40, 102400
    s_add_u32 s41, s3, 8392704
    buffer_load_dwordx4 v1, s[44:47], s41 offen offset:0 sc1 lds
    buffer_load_dwordx4 v1, s[44:47], s41 offen offset:1024 sc1 lds
    buffer_load_dwordx4 v1, s[44:47], s41 offen offset:2048 sc1 lds
    buffer_load_dwordx4 v1, s[44:47], s41 offen offset:3072 sc1 lds
    s_lshl_b32 s41, s30, 9
    s_add_u32 s41, s41, 131072
    v_lshrrev_b32 v9, 1, v1
    v_add_u32 v9, s41, v9
    ds_read_b64 v[96:97], v9 offset:0
    ds_read_b64 v[98:99], v9 offset:2048
    ds_read_b64 v[100:101], v9 offset:4096
    ds_read_b64 v[102:103], v9 offset:6144
    ds_read_b64 v[104:105], v9 offset:8192
    ds_read_b64 v[106:107], v9 offset:10240
    ds_read_b64 v[108:109], v9 offset:12288
    ds_read_b64 v[110:111], v9 offset:14336
    ds_read_b64 v[112:113], v9 offset:16384
    ds_read_b64 v[114:115], v9 offset:18432
    ds_read_b64 v[116:117], v9 offset:20480
    ds_read_b64 v[118:119], v9 offset:22528
    ds_read_b64 v[120:121], v9 offset:24576
    ds_read_b64 v[122:123], v9 offset:26624
    ds_read_b64 v[124:125], v9 offset:28672
    ds_read_b64 v[126:127], v9 offset:30720
    s_mov_b32 s54, 0x05040100
    s_mov_b32 s53, 0x07060302
    s_waitcnt lgkmcnt(0)
    v_perm_b32 v144, v98, v96, s54
    v_perm_b32 v145, v98, v96, s53
    v_perm_b32 v146, v99, v97, s54
    v_perm_b32 v147, v99, v97, s53
    v_perm_b32 v148, v102, v100, s54
    v_perm_b32 v149, v102, v100, s53
    v_perm_b32 v150, v103, v101, s54
    v_perm_b32 v151, v103, v101, s53
    v_perm_b32 v152, v106, v104, s54
    v_perm_b32 v153, v106, v104, s53
    v_perm_b32 v154, v107, v105, s54
    v_perm_b32 v155, v107, v105, s53
    v_perm_b32 v156, v110, v108, s54
    v_perm_b32 v157, v110, v108, s53
    v_perm_b32 v158, v111, v109, s54
    v_perm_b32 v159, v111, v109, s53
    v_perm_b32 v160, v114, v112, s54
    v_perm_b32 v161, v114, v112, s53
    v_perm_b32 v162, v115, v113, s54
    v_perm_b32 v163, v115, v113, s53
    v_perm_b32 v164, v118, v116, s54
    v_perm_b32 v165, v118, v116, s53
    v_perm_b32 v166, v119, v117, s54
    v_perm_b32 v167, v119, v117, s53
    v_perm_b32 v168, v122, v120, s54
    v_perm_b32 v169, v122, v120, s53
    v_perm_b32 v170, v123, v121, s54
    v_perm_b32 v171, v123, v121, s53
    v_perm_b32 v172, v126, v124, s54
    v_perm_b32 v173, v126, v124, s53
    v_perm_b32 v174, v127, v125, s54
    v_perm_b32 v175, v127, v125, s53
    s_mov_b32 s34, 24708
    s_mov_b32 s36, s42
    s_and_b32 s37, s43, 0xffff
    s_mov_b32 s38, 0x400000
    s_mov_b32 s39, 0x00020000
    s_add_u32 s48, s6, 0x4900000
    s_addc_u32 s49, s7, 0
    s_and_b32 s49, s49, 0xffff
    s_mov_b32 s50, 0x1c0000
    s_mov_b32 s51, 0x00020000
    v_lshlrev_b32 v10, 5, v2
    v_lshl_add_u32 v11, s30, 1, v5
    s_lshl_b32 s31, s2, 3
    v_add_u32 v11, s31, v11
    v_lshl_add_u32 v0, v11, 11, v7
    s_cmp_lg_u32 s30, 0
    s_cbranch_scc1 ff_go_149
    s_mov_b32 s52, 1048576
ff_poll_150:
    buffer_load_dword v13, v14, s[16:19], s59 offen sc1
    s_sub_u32 s52, s52, 1
    s_cbranch_scc1 ff_go_149
    s_waitcnt vmcnt(0)
    v_cmp_gt_u32 vcc, 64, v13
    s_cbranch_vccz ff_go_149
    s_sleep 4
    s_branch ff_poll_150
ff_go_149:
    s_barrier
    s_mov_b32 s31, 0
    buffer_load_dwordx4 v[16:19], v10, s[32:35], s31 offen sc1
    buffer_load_dwordx4 v[20:23], v10, s[32:35], s31 offen offset:16 sc1
    s_mov_b32 s31, 8192
    buffer_load_dwordx4 v[24:27], v10, s[32:35], s31 offen sc1
    buffer_load_dwordx4 v[28:31], v10, s[32:35], s31 offen offset:16 sc1
    s_mov_b32 s31, 16384
    buffer_load_dwordx4 v[32:35], v10, s[32:35], s31 offen sc1
    buffer_load_dwordx4 v[36:39], v10, s[32:35], s31 offen offset:16 sc1
    s_mov_b32 s31, 24704
    buffer_load_dword v10, v75, s[32:35], s31 offen sc1
    s_mov_b32 s52, 0x3a800000
    s_mov_b32 s53, 0x3a800000
    s_mov_b32 s54, 0x7ff
    v_mov_b32 v14, 0x3727c5ac
    v_mov_b32 v15, v14
    v_mov_b32 v12, 0xff800000
    v_mov_b32 v13, v12
    s_waitcnt vmcnt(0)
    v_sub_f32 v56, 0, v10
    v_sub_f32 v57, 0, v10
    v_pk_mul_f32 v[16:17], v[16:17], s[52:53]
    v_pk_fma_f32 v[24:25], v[24:25], s[52:53], v[14:15]
    v_pk_fma_f32 v[32:33], v[16:17], v[56:57], v[32:33]
    v_pk_fma_f32 v[24:25], v[16:17], v[16:17], v[24:25] neg_lo:[1,0,0] neg_hi:[1,0,0]
    v_pk_mul_f32 v[18:19], v[18:19], s[52:53]
    v_pk_fma_f32 v[26:27], v[26:27], s[52:53], v[14:15]
    v_pk_fma_f32 v[34:35], v[18:19], v[56:57], v[34:35]
    v_pk_fma_f32 v[26:27], v[18:19], v[18:19], v[26:27] neg_lo:[1,0,0] neg_hi:[1,0,0]
    v_pk_mul_f32 v[20:21], v[20:21], s[52:53]
    v_pk_fma_f32 v[28:29], v[28:29], s[52:53], v[14:15]
    v_pk_fma_f32 v[36:37], v[20:21], v[56:57], v[36:37]
    v_pk_fma_f32 v[28:29], v[20:21], v[20:21], v[28:29] neg_lo:[1,0,0] neg_hi:[1,0,0]
    v_pk_mul_f32 v[22:23], v[22:23], s[52:53]
    v_pk_fma_f32 v[30:31], v[30:31], s[52:53], v[14:15]
    v_pk_fma_f32 v[38:39], v[22:23], v[56:57], v[38:39]
    v_pk_fma_f32 v[30:31], v[22:23], v[22:23], v[30:31] neg_lo:[1,0,0] neg_hi:[1,0,0]
    v_max_f32 v24, v14, v24
    v_max_f32 v25, v14, v25
    v_max_f32 v26, v14, v26
    v_max_f32 v27, v14, v27
    v_max_f32 v28, v14, v28
    v_max_f32 v29, v14, v29
    v_max_f32 v30, v14, v30
    v_max_f32 v31, v14, v31
    v_rsq_f32 v24, v24
    v_rsq_f32 v25, v25
    v_rsq_f32 v26, v26
    v_rsq_f32 v27, v27
    v_rsq_f32 v28, v28
    v_rsq_f32 v29, v29
    v_rsq_f32 v30, v30
    v_rsq_f32 v31, v31
    v_pk_mul_f32 v[32:33], v[32:33], v[24:25]
    v_pk_mul_f32 v[34:35], v[34:35], v[26:27]
    v_pk_mul_f32 v[36:37], v[36:37], v[28:29]
    v_pk_mul_f32 v[38:39], v[38:39], v[30:31]
    v_bfi_b32 v32, s54, 0, v32
    v_med3_f32 v13, v12, v13, v32
    v_max_f32 v12, v12, v32
    v_bfi_b32 v33, s54, 1, v33
    v_med3_f32 v13, v12, v13, v33
    v_max_f32 v12, v12, v33
    v_bfi_b32 v34, s54, 2, v34
    v_med3_f32 v13, v12, v13, v34
    v_max_f32 v12, v12, v34
    v_bfi_b32 v35, s54, 3, v35
    v_med3_f32 v13, v12, v13, v35
    v_max_f32 v12, v12, v35
    v_bfi_b32 v36, s54, 4, v36
    v_med3_f32 v13, v12, v13, v36
    v_max_f32 v12, v12, v36
    v_bfi_b32 v37, s54, 5, v37
    v_med3_f32 v13, v12, v13, v37
    v_max_f32 v12, v12, v37
    v_bfi_b32 v38, s54, 6, v38
    v_med3_f32 v13, v12, v13, v38
    v_max_f32 v12, v12, v38
    v_bfi_b32 v39, s54, 7, v39
    v_med3_f32 v13, v12, v13, v39
    v_max_f32 v12, v12, v39
    v_lshl_or_b32 v12, v2, 3, v12
    v_lshl_or_b32 v13, v2, 3, v13
    s_nop 1
    v_mov_b32_dpp v14, v12 quad_perm:[1,0,3,2] row_mask:0xf bank_mask:0xf
    v_mov_b32_dpp v15, v13 quad_perm:[1,0,3,2] row_mask:0xf bank_mask:0xf
    v_max_f32 v15, v15, v13
    v_med3_f32 v13, v12, v14, v15
    v_max_f32 v12, v12, v14
    s_nop 1
    v_mov_b32_dpp v14, v12 quad_perm:[2,3,0,1] row_mask:0xf bank_mask:0xf
    v_mov_b32_dpp v15, v13 quad_perm:[2,3,0,1] row_mask:0xf bank_mask:0xf
    v_max_f32 v15, v15, v13
    v_med3_f32 v13, v12, v14, v15
    v_max_f32 v12, v12, v14
    s_nop 1
    v_mov_b32_dpp v14, v12 row_half_mirror row_mask:0xf bank_mask:0xf
    v_mov_b32_dpp v15, v13 row_half_mirror row_mask:0xf bank_mask:0xf
    v_max_f32 v15, v15, v13
    v_med3_f32 v13, v12, v14, v15
    v_max_f32 v12, v12, v14
    s_nop 1
    v_mov_b32_dpp v14, v12 row_mirror row_mask:0xf bank_mask:0xf
    v_mov_b32_dpp v15, v13 row_mirror row_mask:0xf bank_mask:0xf
    v_max_f32 v15, v15, v13
    v_med3_f32 v13, v12, v14, v15
    v_max_f32 v12, v12, v14
    v_mov_b32 v14, v12
    v_mov_b32 v15, v13
    s_nop 1
    v_permlane16_swap_b32 v12, v14
    v_permlane16_swap_b32 v13, v15
    s_nop 1
    v_max_f32 v15, v15, v13
    v_med3_f32 v13, v12, v14, v15
    v_max_f32 v12, v12, v14
    v_mov_b32 v14, v12
    v_mov_b32 v15, v13
    s_nop 1
    v_permlane32_swap_b32 v12, v14
    v_permlane32_swap_b32 v13, v15
    s_nop 1
    v_max_f32 v15, v15, v13
    v_med3_f32 v13, v12, v14, v15
    v_max_f32 v12, v12, v14
    s_lshl_b32 s31, s30, 3
    s_add_u32 s31, s31, 8192
    v_mov_b32 v14, s31
    ds_write_b64 v14, v[12:13]
    v_mov_b32 v14, 8192
    s_waitcnt lgkmcnt(0)
    s_barrier
    ds_read_b128 v[16:19], v14
    ds_read_b128 v[20:23], v14 offset:16
    v_cmp_eq_u32 vcc, 0, v5
    s_waitcnt lgkmcnt(0)
    v_max_f32 v19, v19, v17
    v_med3_f32 v17, v16, v18, v19
    v_max_f32 v16, v16, v18
    v_max_f32 v23, v23, v21
    v_med3_f32 v21, v20, v22, v23
    v_max_f32 v20, v20, v22
    v_max_f32 v21, v21, v17
    v_med3_f32 v17, v16, v20, v21
    v_max_f32 v16, v16, v20
    v_and_b32 v16, 0x7ff, v16
    v_and_b32 v17, 0x7ff, v17
    v_cndmask_b32 v15, v17, v16, vcc
    v_lshl_add_u32 v12, v15, 11, v7
    buffer_load_dwordx4 v[40:43], v12, s[24:27], 0 offen offset:0 sc1
    buffer_load_dwordx4 v[44:47], v12, s[24:27], 0 offen offset:512 sc1
    buffer_load_dwordx4 v[48:51], v12, s[24:27], 0 offen offset:1024 sc1
    buffer_load_dwordx4 v[52:55], v12, s[24:27], 0 offen offset:1536 sc1
    buffer_load_dwordx4 v[128:131], v0, s[24:27], 0 offen offset:0 sc1
    buffer_load_dwordx4 v[132:135], v0, s[24:27], 0 offen offset:512 sc1
    buffer_load_dwordx4 v[136:139], v0, s[24:27], 0 offen offset:1024 sc1
    buffer_load_dwordx4 v[140:143], v0, s[24:27], 0 offen offset:1536 sc1
    v_cmp_eq_u32 vcc, v16, v11
    v_cmp_eq_u32 s[52:53], v17, v11
    v_mov_b32 v13, 0x7fffffff
    s_or_b64 vcc, vcc, s[52:53]
    v_cndmask_b32 v0, v0, v13, vcc
    v_lshl_add_u32 v12, v5, 11, v7
    v_add_u32 v12, 4096, v12
    s_mov_b32 s58, 0
    s_waitcnt vmcnt(4)
ff_ln_151:
    v_lshlrev_b32 v216, 16, v40
    v_and_b32 v217, 0xffff0000, v40
    v_lshlrev_b32 v218, 16, v41
    v_and_b32 v219, 0xffff0000, v41
    v_lshlrev_b32 v220, 16, v42
    v_and_b32 v221, 0xffff0000, v42
    v_lshlrev_b32 v222, 16, v43
    v_and_b32 v223, 0xffff0000, v43
    v_lshlrev_b32 v224, 16, v44
    v_and_b32 v225, 0xffff0000, v44
    v_lshlrev_b32 v226, 16, v45
    v_and_b32 v227, 0xffff0000, v45
    v_lshlrev_b32 v228, 16, v46
    v_and_b32 v229, 0xffff0000, v46
    v_lshlrev_b32 v230, 16, v47
    v_and_b32 v231, 0xffff0000, v47
    v_lshlrev_b32 v232, 16, v48
    v_and_b32 v233, 0xffff0000, v48
    v_lshlrev_b32 v234, 16, v49
    v_and_b32 v235, 0xffff0000, v49
    v_lshlrev_b32 v236, 16, v50
    v_and_b32 v237, 0xffff0000, v50
    v_lshlrev_b32 v238, 16, v51
    v_and_b32 v239, 0xffff0000, v51
    v_lshlrev_b32 v240, 16, v52
    v_and_b32 v241, 0xffff0000, v52
    v_lshlrev_b32 v242, 16, v53
    v_and_b32 v243, 0xffff0000, v53
    v_lshlrev_b32 v244, 16, v54
    v_and_b32 v245, 0xffff0000, v54
    v_lshlrev_b32 v246, 16, v55
    v_and_b32 v247, 0xffff0000, v55
    v_pk_add_f32 v[208:209], v[216:217], v[218:219]
    v_pk_add_f32 v[210:211], v[220:221], v[222:223]
    v_pk_add_f32 v[208:209], v[208:209], v[224:225]
    v_pk_add_f32 v[210:211], v[210:211], v[226:227]
    v_pk_add_f32 v[208:209], v[208:209], v[228:229]
    v_pk_add_f32 v[210:211], v[210:211], v[230:231]
    v_pk_add_f32 v[208:209], v[208:209], v[232:233]
    v_pk_add_f32 v[210:211], v[210:211], v[234:235]
    v_pk_add_f32 v[208:209], v[208:209], v[236:237]
    v_pk_add_f32 v[210:211], v[210:211], v[238:239]
    v_pk_add_f32 v[208:209], v[208:209], v[240:241]
    v_pk_add_f32 v[210:211], v[210:211], v[242:243]
    v_pk_add_f32 v[208:209], v[208:209], v[244:245]
    v_pk_add_f32 v[210:211], v[210:211], v[246:247]
    v_pk_add_f32 v[208:209], v[208:209], v[210:211]
    v_add_f32 v208, v208, v209
    s_nop 1
    v_add_f32_dpp v208, v208, v208 quad_perm:[1,0,3,2] row_mask:0xf bank_mask:0xf
    s_nop 1
    v_add_f32_dpp v208, v208, v208 quad_perm:[2,3,0,1] row_mask:0xf bank_mask:0xf
    s_nop 1
    v_add_f32_dpp v208, v208, v208 row_half_mirror row_mask:0xf bank_mask:0xf
    s_nop 1
    v_add_f32_dpp v208, v208, v208 row_mirror row_mask:0xf bank_mask:0xf
    v_mov_b32 v210, v208
    s_nop 1
    v_permlane16_swap_b32 v208, v210
    s_nop 1
    v_add_f32 v208, v208, v210
    v_mul_f32 v208, 0xba800000, v208
    v_mov_b32 v209, v208
    v_pk_add_f32 v[210:211], v[216:217], v[208:209]
    v_pk_add_f32 v[214:215], v[218:219], v[208:209]
    v_pk_mul_f32 v[212:213], v[210:211], v[210:211]
    v_pk_fma_f32 v[212:213], v[214:215], v[214:215], v[212:213]
    v_pk_add_f32 v[210:211], v[220:221], v[208:209]
    v_pk_add_f32 v[214:215], v[222:223], v[208:209]
    v_pk_fma_f32 v[212:213], v[210:211], v[210:211], v[212:213]
    v_pk_fma_f32 v[212:213], v[214:215], v[214:215], v[212:213]
    v_pk_add_f32 v[210:211], v[224:225], v[208:209]
    v_pk_add_f32 v[214:215], v[226:227], v[208:209]
    v_pk_fma_f32 v[212:213], v[210:211], v[210:211], v[212:213]
    v_pk_fma_f32 v[212:213], v[214:215], v[214:215], v[212:213]
    v_pk_add_f32 v[210:211], v[228:229], v[208:209]
    v_pk_add_f32 v[214:215], v[230:231], v[208:209]
    v_pk_fma_f32 v[212:213], v[210:211], v[210:211], v[212:213]
    v_pk_fma_f32 v[212:213], v[214:215], v[214:215], v[212:213]
    v_pk_add_f32 v[210:211], v[232:233], v[208:209]
    v_pk_add_f32 v[214:215], v[234:235], v[208:209]
    v_pk_fma_f32 v[212:213], v[210:211], v[210:211], v[212:213]
    v_pk_fma_f32 v[212:213], v[214:215], v[214:215], v[212:213]
    v_pk_add_f32 v[210:211], v[236:237], v[208:209]
    v_pk_add_f32 v[214:215], v[238:239], v[208:209]
    v_pk_fma_f32 v[212:213], v[210:211], v[210:211], v[212:213]
    v_pk_fma_f32 v[212:213], v[214:215], v[214:215], v[212:213]
    v_pk_add_f32 v[210:211], v[240:241], v[208:209]
    v_pk_add_f32 v[214:215], v[242:243], v[208:209]
    v_pk_fma_f32 v[212:213], v[210:211], v[210:211], v[212:213]
    v_pk_fma_f32 v[212:213], v[214:215], v[214:215], v[212:213]
    v_pk_add_f32 v[210:211], v[244:245], v[208:209]
    v_pk_add_f32 v[214:215], v[246:247], v[208:209]
    v_pk_fma_f32 v[212:213], v[210:211], v[210:211], v[212:213]
    v_pk_fma_f32 v[212:213], v[214:215], v[214:215], v[212:213]
    v_add_f32 v212, v212, v213
    s_nop 1
    v_add_f32_dpp v212, v212, v212 quad_perm:[1,0,3,2] row_mask:0xf bank_mask:0xf
    s_nop 1
    v_add_f32_dpp v212, v212, v212 quad_perm:[2,3,0,1] row_mask:0xf bank_mask:0xf
    s_nop 1
    v_add_f32_dpp v212, v212, v212 row_half_mirror row_mask:0xf bank_mask:0xf
    s_nop 1
    v_add_f32_dpp v212, v212, v212 row_mirror row_mask:0xf bank_mask:0xf
    v_mov_b32 v210, v212
    s_nop 1
    v_permlane16_swap_b32 v212, v210
    s_nop 1
    v_add_f32 v212, v212, v210
    v_mul_f32 v212, 0x3a800000, v212
    v_cvt_pk_bf16_f32 v214, v208, v212
    v_and_b32 v212, 0xffff0000, v214
    v_lshlrev_b32 v214, 16, v214
    v_add_f32 v212, 0x3727c5ac, v212
    v_mov_b32 v215, v214
    v_cvt_pk_bf16_f32 v212, v212, v212
    v_and_b32 v212, 0xffff0000, v212
    v_sqrt_f32 v212, v212
    v_pk_add_f32 v[176:177], v[216:217], v[214:215]
    v_pk_add_f32 v[178:179], v[218:219], v[214:215]
    v_pk_add_f32 v[180:181], v[220:221], v[214:215]
    v_pk_add_f32 v[182:183], v[222:223], v[214:215]
    v_pk_add_f32 v[184:185], v[224:225], v[214:215]
    v_pk_add_f32 v[186:187], v[226:227], v[214:215]
    v_pk_add_f32 v[188:189], v[228:229], v[214:215]
    v_pk_add_f32 v[190:191], v[230:231], v[214:215]
    v_pk_add_f32 v[192:193], v[232:233], v[214:215]
    v_pk_add_f32 v[194:195], v[234:235], v[214:215]
    v_pk_add_f32 v[196:197], v[236:237], v[214:215]
    v_pk_add_f32 v[198:199], v[238:239], v[214:215]
    v_pk_add_f32 v[200:201], v[240:241], v[214:215]
    v_pk_add_f32 v[202:203], v[242:243], v[214:215]
    v_pk_add_f32 v[204:205], v[244:245], v[214:215]
    v_pk_add_f32 v[206:207], v[246:247], v[214:215]
    v_cvt_pk_bf16_f32 v212, v212, v212
    v_and_b32 v212, 0xffff0000, v212
    v_rcp_f32 v212, v212
    v_cvt_pk_bf16_f32 v40, v176, v177
    v_cvt_pk_bf16_f32 v41, v178, v179
    v_cvt_pk_bf16_f32 v42, v180, v181
    v_cvt_pk_bf16_f32 v43, v182, v183
    v_cvt_pk_bf16_f32 v44, v184, v185
    v_cvt_pk_bf16_f32 v45, v186, v187
    v_cvt_pk_bf16_f32 v46, v188, v189
    v_cvt_pk_bf16_f32 v47, v190, v191
    v_cvt_pk_bf16_f32 v48, v192, v193
    v_cvt_pk_bf16_f32 v49, v194, v195
    v_cvt_pk_bf16_f32 v50, v196, v197
    v_cvt_pk_bf16_f32 v51, v198, v199
    v_cvt_pk_bf16_f32 v52, v200, v201
    v_cvt_pk_bf16_f32 v53, v202, v203
    v_cvt_pk_bf16_f32 v54, v204, v205
    v_cvt_pk_bf16_f32 v55, v206, v207
    v_mov_b32 v213, v212
    v_lshlrev_b32 v176, 16, v40
    v_and_b32 v177, 0xffff0000, v40
    v_lshlrev_b32 v178, 16, v41
    v_and_b32 v179, 0xffff0000, v41
    v_lshlrev_b32 v180, 16, v42
    v_and_b32 v181, 0xffff0000, v42
    v_lshlrev_b32 v182, 16, v43
    v_and_b32 v183, 0xffff0000, v43
    v_lshlrev_b32 v184, 16, v44
    v_and_b32 v185, 0xffff0000, v44
    v_lshlrev_b32 v186, 16, v45
    v_and_b32 v187, 0xffff0000, v45
    v_lshlrev_b32 v188, 16, v46
    v_and_b32 v189, 0xffff0000, v46
    v_lshlrev_b32 v190, 16, v47
    v_and_b32 v191, 0xffff0000, v47
    v_lshlrev_b32 v192, 16, v48
    v_and_b32 v193, 0xffff0000, v48
    v_lshlrev_b32 v194, 16, v49
    v_and_b32 v195, 0xffff0000, v49
    v_lshlrev_b32 v196, 16, v50
    v_and_b32 v197, 0xffff0000, v50
    v_lshlrev_b32 v198, 16, v51
    v_and_b32 v199, 0xffff0000, v51
    v_lshlrev_b32 v200, 16, v52
    v_and_b32 v201, 0xffff0000, v52
    v_lshlrev_b32 v202, 16, v53
    v_and_b32 v203, 0xffff0000, v53
    v_lshlrev_b32 v204, 16, v54
    v_and_b32 v205, 0xffff0000, v54
    v_lshlrev_b32 v206, 16, v55
    v_and_b32 v207, 0xffff0000, v55
    v_pk_mul_f32 v[176:177], v[176:177], v[212:213]
    v_pk_mul_f32 v[178:179], v[178:179], v[212:213]
    v_pk_mul_f32 v[180:181], v[180:181], v[212:213]
    v_pk_mul_f32 v[182:183], v[182:183], v[212:213]
    v_pk_mul_f32 v[184:185], v[184:185], v[212:213]
    v_pk_mul_f32 v[186:187], v[186:187], v[212:213]
    v_pk_mul_f32 v[188:189], v[188:189], v[212:213]
    v_pk_mul_f32 v[190:191], v[190:191], v[212:213]
    v_pk_mul_f32 v[192:193], v[192:193], v[212:213]
    v_pk_mul_f32 v[194:195], v[194:195], v[212:213]
    v_pk_mul_f32 v[196:197], v[196:197], v[212:213]
    v_pk_mul_f32 v[198:199], v[198:199], v[212:213]
    v_pk_mul_f32 v[200:201], v[200:201], v[212:213]
    v_pk_mul_f32 v[202:203], v[202:203], v[212:213]
    v_pk_mul_f32 v[204:205], v[204:205], v[212:213]
    v_pk_mul_f32 v[206:207], v[206:207], v[212:213]
    v_cvt_pk_bf16_f32 v40, v176, v177
    v_cvt_pk_bf16_f32 v41, v178, v179
    v_cvt_pk_bf16_f32 v42, v180, v181
    v_cvt_pk_bf16_f32 v43, v182, v183
    v_cvt_pk_bf16_f32 v44, v184, v185
    v_cvt_pk_bf16_f32 v45, v186, v187
    v_cvt_pk_bf16_f32 v46, v188, v189
    v_cvt_pk_bf16_f32 v47, v190, v191
    v_cvt_pk_bf16_f32 v48, v192, v193
    v_cvt_pk_bf16_f32 v49, v194, v195
    v_cvt_pk_bf16_f32 v50, v196, v197
    v_cvt_pk_bf16_f32 v51, v198, v199
    v_cvt_pk_bf16_f32 v52, v200, v201
    v_cvt_pk_bf16_f32 v53, v202, v203
    v_cvt_pk_bf16_f32 v54, v204, v205
    v_cvt_pk_bf16_f32 v55, v206, v207
    s_cmp_lg_u32 s58, 0
    s_cbranch_scc1 ff_own_152
    ds_write_b128 v12, v[40:43] offset:0
    ds_write_b128 v12, v[44:47] offset:512
    ds_write_b128 v12, v[48:51] offset:1024
    ds_write_b128 v12, v[52:55] offset:1536
    s_cmp_ge_u32 s2, 224
    s_cbranch_scc1 ff_red_153
    v_lshrrev_b32 v12, 4, v3
    v_and_b32 v13, 1, v3
    v_lshlrev_b32 v13, 11, v13
    v_lshl_add_u32 v13, v12, 3, v13
    s_lshl_b32 s54, s30, 9
    s_add_u32 s54, s54, 4096
    v_add_u32 v13, s54, v13
    v_lshlrev_b32 v14, 3, v3
    s_lshl_b32 s54, s30, 13
    s_add_u32 s54, s54, 65536
    v_add_u32 v14, s54, v14
    ds_read_b64_tr_b16 a[0:1], v14 offset:0
    ds_read_b64_tr_b16 a[2:3], v14 offset:512
    ds_read_b64_tr_b16 a[4:5], v14 offset:1024
    ds_read_b64_tr_b16 a[6:7], v14 offset:1536
    ds_read_b64_tr_b16 a[8:9], v14 offset:2048
    ds_read_b64_tr_b16 a[10:11], v14 offset:2560
    ds_read_b64_tr_b16 a[12:13], v14 offset:3072
    ds_read_b64_tr_b16 a[14:15], v14 offset:3584
    ds_read_b64_tr_b16 a[16:17], v14 offset:4096
    ds_read_b64_tr_b16 a[18:19], v14 offset:4608
    ds_read_b64_tr_b16 a[20:21], v14 offset:5120
    ds_read_b64_tr_b16 a[22:23], v14 offset:5632
    ds_read_b64_tr_b16 a[24:25], v14 offset:6144
    ds_read_b64_tr_b16 a[26:27], v14 offset:6656
    ds_read_b64_tr_b16 a[28:29], v14 offset:7168
    ds_read_b64_tr_b16 a[30:31], v14 offset:7680
    ds_read_b64_tr_b16 a[32:33], v14 offset:32768
    ds_read_b64_tr_b16 a[34:35], v14 offset:33280
    ds_read_b64_tr_b16 a[36:37], v14 offset:33792
    ds_read_b64_tr_b16 a[38:39], v14 offset:34304
    ds_read_b64_tr_b16 a[40:41], v14 offset:34816
    ds_read_b64_tr_b16 a[42:43], v14 offset:35328
    ds_read_b64_tr_b16 a[44:45], v14 offset:35840
    ds_read_b64_tr_b16 a[46:47], v14 offset:36352
    ds_read_b64_tr_b16 a[48:49], v14 offset:36864
    ds_read_b64_tr_b16 a[50:51], v14 offset:37376
    ds_read_b64_tr_b16 a[52:53], v14 offset:37888
    ds_read_b64_tr_b16 a[54:55], v14 offset:38400
    ds_read_b64_tr_b16 a[56:57], v14 offset:38912
    ds_read_b64_tr_b16 a[58:59], v14 offset:39424
    ds_read_b64_tr_b16 a[60:61], v14 offset:39936
    ds_read_b64_tr_b16 a[62:63], v14 offset:40448
    ds_read_b64 a[64:65], v13 offset:0
    ds_read_b64 a[66:67], v13 offset:32
    ds_read_b64 a[68:69], v13 offset:64
    ds_read_b64 a[70:71], v13 offset:96
    ds_read_b64 a[72:73], v13 offset:128
    ds_read_b64 a[74:75], v13 offset:160
    ds_read_b64 a[76:77], v13 offset:192
    ds_read_b64 a[78:79], v13 offset:224
    ds_read_b64 a[80:81], v13 offset:256
    ds_read_b64 a[82:83], v13 offset:288
    ds_read_b64 a[84:85], v13 offset:320
    ds_read_b64 a[86:87], v13 offset:352
    ds_read_b64 a[88:89], v13 offset:384
    ds_read_b64 a[90:91], v13 offset:416
    ds_read_b64 a[92:93], v13 offset:448
    ds_read_b64 a[94:95], v13 offset:480
    v_lshlrev_b32 v13, 6, v8
    v_lshl_add_u32 v13, v12, 4, v13
    s_lshl_b32 s54, s30, 11
    s_add_u32 s54, s54, 8448
    v_add_u32 v13, s54, v13
    s_waitcnt lgkmcnt(0)
    v_mfma_f32_16x16x32_bf16 v[16:19], a[0:3], a[64:67], 0
    v_mfma_f32_16x16x32_bf16 v[20:23], a[32:35], a[64:67], 0
    v_mfma_f32_16x16x32_bf16 v[16:19], a[4:7], a[68:71], v[16:19]
    v_mfma_f32_16x16x32_bf16 v[20:23], a[36:39], a[68:71], v[20:23]
    v_mfma_f32_16x16x32_bf16 v[16:19], a[8:11], a[72:75], v[16:19]
    v_mfma_f32_16x16x32_bf16 v[20:23], a[40:43], a[72:75], v[20:23]
    v_mfma_f32_16x16x32_bf16 v[16:19], a[12:15], a[76:79], v[16:19]
    v_mfma_f32_16x16x32_bf16 v[20:23], a[44:47], a[76:79], v[20:23]
    v_mfma_f32_16x16x32_bf16 v[16:19], a[16:19], a[80:83], v[16:19]
    v_mfma_f32_16x16x32_bf16 v[20:23], a[48:51], a[80:83], v[20:23]
    v_mfma_f32_16x16x32_bf16 v[16:19], a[20:23], a[84:87], v[16:19]
    v_mfma_f32_16x16x32_bf16 v[20:23], a[52:55], a[84:87], v[20:23]
    v_mfma_f32_16x16x32_bf16 v[16:19], a[24:27], a[88:91], v[16:19]
    v_mfma_f32_16x16x32_bf16 v[20:23], a[56:59], a[88:91], v[20:23]
    v_mfma_f32_16x16x32_bf16 v[16:19], a[28:31], a[92:95], v[16:19]
    v_mfma_f32_16x16x32_bf16 v[20:23], a[60:63], a[92:95], v[20:23]
    s_nop 7
    ds_write_b128 v13, v[16:19]
    ds_write_b128 v13, v[20:23] offset:1024
    v_lshlrev_b32 v13, 2, v4
    v_add_u32 v13, 8448, v13
    s_waitcnt lgkmcnt(0)
    s_barrier
    ds_read2st64_b32 v[16:17], v13 offset0:0 offset1:4
    ds_read2st64_b32 v[18:19], v13 offset0:8 offset1:12
    ds_read2st64_b32 v[20:21], v13 offset0:16 offset1:20
    ds_read2st64_b32 v[22:23], v13 offset0:24 offset1:28
    s_waitcnt lgkmcnt(0)
    v_pk_add_f32 v[16:17], v[16:17], v[20:21]
    v_pk_add_f32 v[18:19], v[18:19], v[22:23]
    v_pk_add_f32 v[16:17], v[16:17], v[18:19]
    v_cvt_pk_bf16_f32 v16, v16, v17
    v_and_b32 v20, 0xffff0000, v16
    v_lshlrev_b32 v16, 16, v16
    v_mul_f32 v17, 0xbfb8aa3b, v16
    v_exp_f32 v17, v17
    s_lshl_b32 s54, s55, 13
    v_add_f32 v17, 1.0, v17
    v_rcp_f32 v17, v17
    s_add_u32 s53, s54, 4096
    v_mul_f32 v16, v16, v17
    v_cvt_pk_bf16_f32 v16, v16, v16
    v_and_b32 v16, 0xffff0000, v16
    v_mul_f32 v16, v16, v20
    s_nop 1
    v_mov_b32_dpp v17, v16 quad_perm:[1,0,3,2] row_mask:0xf bank_mask:0xf
    v_cvt_pk_bf16_f32 v16, v16, v17
    v_lshlrev_b32 v13, 4, v2
    v_readlane_b32 s8, v16, 0
    v_readlane_b32 s9, v16, 2
    v_readlane_b32 s10, v16, 4
    v_readlane_b32 s11, v16, 6
    v_readlane_b32 s12, v16, 8
    v_readlane_b32 s13, v16, 10
    v_readlane_b32 s14, v16, 12
    v_readlane_b32 s15, v16, 14
    v_readlane_b32 s16, v16, 16
    v_readlane_b32 s17, v16, 18
    v_readlane_b32 s18, v16, 20
    v_readlane_b32 s19, v16, 22
    v_readlane_b32 s20, v16, 24
    v_readlane_b32 s21, v16, 26
    v_readlane_b32 s22, v16, 28
    v_readlane_b32 s23, v16, 30
    v_dot2_f32_bf16 v24, v144, s8, 0
    v_dot2_f32_bf16 v25, v145, s8, 0
    v_dot2_f32_bf16 v26, v146, s8, 0
    v_dot2_f32_bf16 v27, v147, s8, 0
    v_dot2_f32_bf16 v24, v148, s9, v24
    v_dot2_f32_bf16 v25, v149, s9, v25
    v_dot2_f32_bf16 v26, v150, s9, v26
    v_dot2_f32_bf16 v27, v151, s9, v27
    v_dot2_f32_bf16 v24, v152, s10, v24
    v_dot2_f32_bf16 v25, v153, s10, v25
    v_dot2_f32_bf16 v26, v154, s10, v26
    v_dot2_f32_bf16 v27, v155, s10, v27
    v_dot2_f32_bf16 v24, v156, s11, v24
    v_dot2_f32_bf16 v25, v157, s11, v25
    v_dot2_f32_bf16 v26, v158, s11, v26
    v_dot2_f32_bf16 v27, v159, s11, v27
    v_dot2_f32_bf16 v24, v160, s12, v24
    v_dot2_f32_bf16 v25, v161, s12, v25
    v_dot2_f32_bf16 v26, v162, s12, v26
    v_dot2_f32_bf16 v27, v163, s12, v27
    v_dot2_f32_bf16 v24, v164, s13, v24
    v_dot2_f32_bf16 v25, v165, s13, v25
    v_dot2_f32_bf16 v26, v166, s13, v26
    v_dot2_f32_bf16 v27, v167, s13, v27
    v_dot2_f32_bf16 v24, v168, s14, v24
    v_dot2_f32_bf16 v25, v169, s14, v25
    v_dot2_f32_bf16 v26, v170, s14, v26
    v_dot2_f32_bf16 v27, v171, s14, v27
    v_dot2_f32_bf16 v24, v172, s15, v24
    v_dot2_f32_bf16 v25, v173, s15, v25
    v_dot2_f32_bf16 v26, v174, s15, v26
    v_dot2_f32_bf16 v27, v175, s15, v27
    v_dot2_f32_bf16 v28, v144, s16, 0
    v_dot2_f32_bf16 v29, v145, s16, 0
    v_dot2_f32_bf16 v30, v146, s16, 0
    v_dot2_f32_bf16 v31, v147, s16, 0
    v_dot2_f32_bf16 v28, v148, s17, v28
    v_dot2_f32_bf16 v29, v149, s17, v29
    v_dot2_f32_bf16 v30, v150, s17, v30
    v_dot2_f32_bf16 v31, v151, s17, v31
    v_dot2_f32_bf16 v28, v152, s18, v28
    v_dot2_f32_bf16 v29, v153, s18, v29
    v_dot2_f32_bf16 v30, v154, s18, v30
    v_dot2_f32_bf16 v31, v155, s18, v31
    v_dot2_f32_bf16 v28, v156, s19, v28
    v_dot2_f32_bf16 v29, v157, s19, v29
    v_dot2_f32_bf16 v30, v158, s19, v30
    v_dot2_f32_bf16 v31, v159, s19, v31
    v_dot2_f32_bf16 v28, v160, s20, v28
    v_dot2_f32_bf16 v29, v161, s20, v29
    v_dot2_f32_bf16 v30, v162, s20, v30
    v_dot2_f32_bf16 v31, v163, s20, v31
    v_dot2_f32_bf16 v28, v164, s21, v28
    v_dot2_f32_bf16 v29, v165, s21, v29
    v_dot2_f32_bf16 v30, v166, s21, v30
    v_dot2_f32_bf16 v31, v167, s21, v31
    v_dot2_f32_bf16 v28, v168, s22, v28
    v_dot2_f32_bf16 v29, v169, s22, v29
    v_dot2_f32_bf16 v30, v170, s22, v30
    v_dot2_f32_bf16 v31, v171, s22, v31
    v_dot2_f32_bf16 v28, v172, s23, v28
    v_dot2_f32_bf16 v29, v173, s23, v29
    v_dot2_f32_bf16 v30, v174, s23, v30
    v_dot2_f32_bf16 v31, v175, s23, v31
    s_nop 2
    v_min_u32 v24, -2, v24
    v_min_u32 v25, -2, v25
    v_min_u32 v26, -2, v26
    v_min_u32 v27, -2, v27
    v_min_u32 v28, -2, v28
    v_min_u32 v29, -2, v29
    v_min_u32 v30, -2, v30
    v_min_u32 v31, -2, v31
    buffer_store_dwordx4 v[24:27], v13, s[48:51], s54 offen sc1
    buffer_store_dwordx4 v[28:31], v13, s[48:51], s53 offen sc1
    s_waitcnt vmcnt(2)
    v_mov_b32 v40, v128
    v_mov_b32 v41, v129
    v_mov_b32 v42, v130
    v_mov_b32 v43, v131
    v_mov_b32 v44, v132
    v_mov_b32 v45, v133
    v_mov_b32 v46, v134
    v_mov_b32 v47, v135
    v_mov_b32 v48, v136
    v_mov_b32 v49, v137
    v_mov_b32 v50, v138
    v_mov_b32 v51, v139
    v_mov_b32 v52, v140
    v_mov_b32 v53, v141
    v_mov_b32 v54, v142
    v_mov_b32 v55, v143
    s_mov_b32 s58, 1
    s_branch ff_ln_151
ff_own_152:
    v_lshlrev_b32 v176, 16, v40
    v_and_b32 v177, 0xffff0000, v40
    v_lshlrev_b32 v178, 16, v41
    v_and_b32 v179, 0xffff0000, v41
    v_lshlrev_b32 v180, 16, v42
    v_and_b32 v181, 0xffff0000, v42
    v_lshlrev_b32 v182, 16, v43
    v_and_b32 v183, 0xffff0000, v43
    v_lshlrev_b32 v184, 16, v44
    v_and_b32 v185, 0xffff0000, v44
    v_lshlrev_b32 v186, 16, v45
    v_and_b32 v187, 0xffff0000, v45
    v_lshlrev_b32 v188, 16, v46
    v_and_b32 v189, 0xffff0000, v46
    v_lshlrev_b32 v190, 16, v47
    v_and_b32 v191, 0xffff0000, v47
    v_lshlrev_b32 v192, 16, v48
    v_and_b32 v193, 0xffff0000, v48
    v_lshlrev_b32 v194, 16, v49
    v_and_b32 v195, 0xffff0000, v49
    v_lshlrev_b32 v196, 16, v50
    v_and_b32 v197, 0xffff0000, v50
    v_lshlrev_b32 v198, 16, v51
    v_and_b32 v199, 0xffff0000, v51
    v_lshlrev_b32 v200, 16, v52
    v_and_b32 v201, 0xffff0000, v52
    v_lshlrev_b32 v202, 16, v53
    v_and_b32 v203, 0xffff0000, v53
    v_lshlrev_b32 v204, 16, v54
    v_and_b32 v205, 0xffff0000, v54
    v_lshlrev_b32 v206, 16, v55
    v_and_b32 v207, 0xffff0000, v55
    v_pk_add_f32 v[176:177], v[176:177], v[216:217]
    v_pk_add_f32 v[178:179], v[178:179], v[218:219]
    v_pk_add_f32 v[180:181], v[180:181], v[220:221]
    v_pk_add_f32 v[182:183], v[182:183], v[222:223]
    v_pk_add_f32 v[184:185], v[184:185], v[224:225]
    v_pk_add_f32 v[186:187], v[186:187], v[226:227]
    v_pk_add_f32 v[188:189], v[188:189], v[228:229]
    v_pk_add_f32 v[190:191], v[190:191], v[230:231]
    v_pk_add_f32 v[192:193], v[192:193], v[232:233]
    v_pk_add_f32 v[194:195], v[194:195], v[234:235]
    v_pk_add_f32 v[196:197], v[196:197], v[236:237]
    v_pk_add_f32 v[198:199], v[198:199], v[238:239]
    v_pk_add_f32 v[200:201], v[200:201], v[240:241]
    v_pk_add_f32 v[202:203], v[202:203], v[242:243]
    v_pk_add_f32 v[204:205], v[204:205], v[244:245]
    v_pk_add_f32 v[206:207], v[206:207], v[246:247]
    v_cvt_pk_bf16_f32 v40, v176, v177
    v_cvt_pk_bf16_f32 v41, v178, v179
    v_cvt_pk_bf16_f32 v42, v180, v181
    v_cvt_pk_bf16_f32 v43, v182, v183
    v_cvt_pk_bf16_f32 v44, v184, v185
    v_cvt_pk_bf16_f32 v45, v186, v187
    v_cvt_pk_bf16_f32 v46, v188, v189
    v_cvt_pk_bf16_f32 v47, v190, v191
    v_cvt_pk_bf16_f32 v48, v192, v193
    v_cvt_pk_bf16_f32 v49, v194, v195
    v_cvt_pk_bf16_f32 v50, v196, v197
    v_cvt_pk_bf16_f32 v51, v198, v199
    v_cvt_pk_bf16_f32 v52, v200, v201
    v_cvt_pk_bf16_f32 v53, v202, v203
    v_cvt_pk_bf16_f32 v54, v204, v205
    v_cvt_pk_bf16_f32 v55, v206, v207
    buffer_store_dwordx4 v[40:43], v0, s[36:39], 0 offen offset:0 sc1
    buffer_store_dwordx4 v[44:47], v0, s[36:39], 0 offen offset:512 sc1
    buffer_store_dwordx4 v[48:51], v0, s[36:39], 0 offen offset:1024 sc1
    buffer_store_dwordx4 v[52:55], v0, s[36:39], 0 offen offset:1536 sc1
    s_cmp_ge_u32 s2, 224
    s_cbranch_scc1 ff_red2_154
    s_branch ff_fin_155
ff_red_153:
    s_sub_u32 s40, s2, 224
    s_lshr_b32 s41, s40, 4
    s_and_b32 s42, s40, 15
    s_mov_b32 s8, s56
    s_and_b32 s9, s57, 0xffff
    s_mov_b32 s10, 0x800
    s_mov_b32 s11, 0x00020000
    buffer_load_dwordx4 v[96:99], v7, s[8:11], 0 offen offset:0
    buffer_load_dwordx4 v[100:103], v7, s[8:11], 0 offen offset:512
    buffer_load_dwordx4 v[104:107], v7, s[8:11], 0 offen offset:1024
    buffer_load_dwordx4 v[108:111], v7, s[8:11], 0 offen offset:1536
    s_lshl_b32 s43, s41, 5
    v_readlane_b32 s46, v15, s43
    s_lshl_b32 s47, s42, 7
    v_lshl_add_u32 v9, v8, 3, s47
    s_lshl_b32 s46, s46, 11
    s_lshl_b32 s31, s41, 11
    s_add_u32 s31, s31, 4096
    v_add_u32 v12, s31, v9
    s_waitcnt lgkmcnt(0)
    ds_read_b64 v[32:33], v12
    buffer_load_dwordx2 v[34:35], v9, s[24:27], s46 offen sc1
    v_lshrrev_b32 v10, 4, v2
    v_lshlrev_b32 v10, 13, v10
    v_lshl_add_u32 v10, v8, 4, v10
    s_lshl_b32 s47, s40, 8
    s_waitcnt vmcnt(1)
    v_dot2_f32_bf16 v12, v40, v96, 0
    v_dot2_f32_bf16 v12, v41, v97, v12
    v_dot2_f32_bf16 v12, v42, v98, v12
    v_dot2_f32_bf16 v12, v43, v99, v12
    v_dot2_f32_bf16 v12, v44, v100, v12
    v_dot2_f32_bf16 v12, v45, v101, v12
    v_dot2_f32_bf16 v12, v46, v102, v12
    v_dot2_f32_bf16 v12, v47, v103, v12
    v_dot2_f32_bf16 v12, v48, v104, v12
    v_dot2_f32_bf16 v12, v49, v105, v12
    v_dot2_f32_bf16 v12, v50, v106, v12
    v_dot2_f32_bf16 v12, v51, v107, v12
    v_dot2_f32_bf16 v12, v52, v108, v12
    v_dot2_f32_bf16 v12, v53, v109, v12
    v_dot2_f32_bf16 v12, v54, v110, v12
    v_dot2_f32_bf16 v12, v55, v111, v12
    s_nop 2
    s_nop 1
    v_add_f32_dpp v12, v12, v12 quad_perm:[1,0,3,2] row_mask:0xf bank_mask:0xf
    s_nop 1
    v_add_f32_dpp v12, v12, v12 quad_perm:[2,3,0,1] row_mask:0xf bank_mask:0xf
    s_nop 1
    v_add_f32_dpp v12, v12, v12 row_half_mirror row_mask:0xf bank_mask:0xf
    s_nop 1
    v_add_f32_dpp v12, v12, v12 row_mirror row_mask:0xf bank_mask:0xf
    v_mov_b32 v13, v12
    s_nop 1
    v_permlane16_swap_b32 v12, v13
    s_nop 1
    v_add_f32 v12, v12, v13
    v_cvt_pk_bf16_f32 v12, v12, v12
    v_and_b32 v12, 0xffff0000, v12
    v_mul_f32 v12, 0xbfb8aa3b, v12
    v_exp_f32 v12, v12
    s_lshl_b32 s44, s42, 1
    v_add_f32 v12, 1.0, v12
    v_rcp_f32 v12, v12
    s_add_u32 s44, s44, s41
    s_lshl_b32 s44, s44, 11
    v_cvt_pk_bf16_f32 v12, v12, v12
    v_and_b32 v12, 0xffff0000, v12
    v_mov_b32 v40, v128
    v_mov_b32 v41, v129
    v_mov_b32 v42, v130
    v_mov_b32 v43, v131
    v_mov_b32 v44, v132
    v_mov_b32 v45, v133
    v_mov_b32 v46, v134
    v_mov_b32 v47, v135
    v_mov_b32 v48, v136
    v_mov_b32 v49, v137
    v_mov_b32 v50, v138
    v_mov_b32 v51, v139
    v_mov_b32 v52, v140
    v_mov_b32 v53, v141
    v_mov_b32 v54, v142
    v_mov_b32 v55, v143
    v_readlane_b32 s45, v12, s43
    s_mov_b32 s58, 1
    s_branch ff_ln_151
ff_red2_154:
    s_mov_b32 s52, 1048576
ff_rpoll_157:
    s_mov_b32 s53, s47
    buffer_load_dwordx4 v[96:99], v10, s[48:51], s53 offen sc1
    s_add_u32 s53, s53, 0x20000
    buffer_load_dwordx4 v[100:103], v10, s[48:51], s53 offen sc1
    s_add_u32 s53, s53, 0x20000
    buffer_load_dwordx4 v[104:107], v10, s[48:51], s53 offen sc1
    s_add_u32 s53, s53, 0x20000
    buffer_load_dwordx4 v[108:111], v10, s[48:51], s53 offen sc1
    s_add_u32 s53, s53, 0x20000
    buffer_load_dwordx4 v[112:115], v10, s[48:51], s53 offen sc1
    s_add_u32 s53, s53, 0x20000
    buffer_load_dwordx4 v[116:119], v10, s[48:51], s53 offen sc1
    s_add_u32 s53, s53, 0x20000
    buffer_load_dwordx4 v[120:123], v10, s[48:51], s53 offen sc1
    s_add_u32 s53, s53, 0x20000
    buffer_load_dwordx4 v[124:127], v10, s[48:51], s53 offen sc1
    s_add_u32 s53, s53, 0x20000
    buffer_load_dwordx4 v[128:131], v10, s[48:51], s53 offen sc1
    s_add_u32 s53, s53, 0x20000
    buffer_load_dwordx4 v[132:135], v10, s[48:51], s53 offen sc1
    s_add_u32 s53, s53, 0x20000
    buffer_load_dwordx4 v[136:139], v10, s[48:51], s53 offen sc1
    s_add_u32 s53, s53, 0x20000
    buffer_load_dwordx4 v[140:143], v10, s[48:51], s53 offen sc1
    s_add_u32 s53, s53, 0x20000
    buffer_load_dwordx4 v[144:147], v10, s[48:51], s53 offen sc1
    s_add_u32 s53, s53, 0x20000
    buffer_load_dwordx4 v[148:151], v10, s[48:51], s53 offen sc1
    s_add_u32 s53, s53, 0x20000
    v_mov_b32 v13, 0
    s_waitcnt vmcnt(13)
    v_max3_u32 v13, v13, v96, v97
    v_max3_u32 v13, v13, v98, v99
    s_waitcnt vmcnt(12)
    v_max3_u32 v13, v13, v100, v101
    v_max3_u32 v13, v13, v102, v103
    s_waitcnt vmcnt(11)
    v_max3_u32 v13, v13, v104, v105
    v_max3_u32 v13, v13, v106, v107
    s_waitcnt vmcnt(10)
    v_max3_u32 v13, v13, v108, v109
    v_max3_u32 v13, v13, v110, v111
    s_waitcnt vmcnt(9)
    v_max3_u32 v13, v13, v112, v113
    v_max3_u32 v13, v13, v114, v115
    s_waitcnt vmcnt(8)
    v_max3_u32 v13, v13, v116, v117
    v_max3_u32 v13, v13, v118, v119
    s_waitcnt vmcnt(7)
    v_max3_u32 v13, v13, v120, v121
    v_max3_u32 v13, v13, v122, v123
    s_waitcnt vmcnt(6)
    v_max3_u32 v13, v13, v124, v125
    v_max3_u32 v13, v13, v126, v127
    s_waitcnt vmcnt(5)
    v_max3_u32 v13, v13, v128, v129
    v_max3_u32 v13, v13, v130, v131
    s_waitcnt vmcnt(4)
    v_max3_u32 v13, v13, v132, v133
    v_max3_u32 v13, v13, v134, v135
    s_waitcnt vmcnt(3)
    v_max3_u32 v13, v13, v136, v137
    v_max3_u32 v13, v13, v138, v139
    s_waitcnt vmcnt(2)
    v_max3_u32 v13, v13, v140, v141
    v_max3_u32 v13, v13, v142, v143
    s_waitcnt vmcnt(1)
    v_max3_u32 v13, v13, v144, v145
    v_max3_u32 v13, v13, v146, v147
    s_waitcnt vmcnt(0)
    v_max3_u32 v13, v13, v148, v149
    v_max3_u32 v13, v13, v150, v151
    s_sub_u32 s52, s52, 1
    s_cbranch_scc1 ff_rgo_156
    v_cmp_eq_u32 vcc, -1, v13
    s_cbranch_vccnz ff_rpoll_157
ff_rgo_156:
    v_pk_add_f32 v[96:97], v[96:97], v[100:101]
    v_pk_add_f32 v[98:99], v[98:99], v[102:103]
    v_pk_add_f32 v[96:97], v[96:97], v[104:105]
    v_pk_add_f32 v[98:99], v[98:99], v[106:107]
    v_pk_add_f32 v[96:97], v[96:97], v[108:109]
    v_pk_add_f32 v[98:99], v[98:99], v[110:111]
    v_pk_add_f32 v[96:97], v[96:97], v[112:113]
    v_pk_add_f32 v[98:99], v[98:99], v[114:115]
    v_pk_add_f32 v[96:97], v[96:97], v[116:117]
    v_pk_add_f32 v[98:99], v[98:99], v[118:119]
    v_pk_add_f32 v[96:97], v[96:97], v[120:121]
    v_pk_add_f32 v[98:99], v[98:99], v[122:123]
    v_pk_add_f32 v[96:97], v[96:97], v[124:125]
    v_pk_add_f32 v[98:99], v[98:99], v[126:127]
    v_pk_add_f32 v[96:97], v[96:97], v[128:129]
    v_pk_add_f32 v[98:99], v[98:99], v[130:131]
    v_pk_add_f32 v[96:97], v[96:97], v[132:133]
    v_pk_add_f32 v[98:99], v[98:99], v[134:135]
    v_pk_add_f32 v[96:97], v[96:97], v[136:137]
    v_pk_add_f32 v[98:99], v[98:99], v[138:139]
    v_pk_add_f32 v[96:97], v[96:97], v[140:141]
    v_pk_add_f32 v[98:99], v[98:99], v[142:143]
    v_pk_add_f32 v[96:97], v[96:97], v[144:145]
    v_pk_add_f32 v[98:99], v[98:99], v[146:147]
    v_pk_add_f32 v[96:97], v[96:97], v[148:149]
    v_pk_add_f32 v[98:99], v[98:99], v[150:151]
    v_mov_b32 v100, v96
    v_mov_b32 v101, v97
    v_mov_b32 v102, v98
    v_mov_b32 v103, v99
    s_nop 1
    v_permlane16_swap_b32 v96, v100
    v_permlane16_swap_b32 v97, v101
    v_permlane16_swap_b32 v98, v102
    v_permlane16_swap_b32 v99, v103
    s_nop 1
    v_add_f32 v96, v96, v100
    v_add_f32 v97, v97, v101
    v_add_f32 v98, v98, v102
    v_add_f32 v99, v99, v103
    v_mov_b32 v100, v96
    v_mov_b32 v101, v97
    v_mov_b32 v102, v98
    v_mov_b32 v103, v99
    s_nop 1
    v_permlane32_swap_b32 v96, v100
    v_permlane32_swap_b32 v97, v101
    v_permlane32_swap_b32 v98, v102
    v_permlane32_swap_b32 v99, v103
    s_nop 1
    v_add_f32 v96, v96, v100
    v_add_f32 v97, v97, v101
    v_add_f32 v98, v98, v102
    v_add_f32 v99, v99, v103
    v_lshlrev_b32 v14, 4, v8
    s_lshl_b32 s31, s30, 8
    v_add_u32 v13, s31, v14
    ds_write_b128 v13, v[96:99]
    s_waitcnt lgkmcnt(0)
    s_barrier
    ds_read_b128 v[96:99], v14 offset:0
    ds_read_b128 v[100:103], v14 offset:256
    ds_read_b128 v[104:107], v14 offset:512
    ds_read_b128 v[108:111], v14 offset:768
    s_waitcnt lgkmcnt(0)
    v_pk_add_f32 v[96:97], v[96:97], v[100:101]
    v_pk_add_f32 v[98:99], v[98:99], v[102:103]
    v_pk_add_f32 v[96:97], v[96:97], v[104:105]
    v_pk_add_f32 v[98:99], v[98:99], v[106:107]
    v_pk_add_f32 v[96:97], v[96:97], v[108:109]
    v_pk_add_f32 v[98:99], v[98:99], v[110:111]
    v_cvt_pk_bf16_f32 v20, v96, v97
    v_lshlrev_b32 v21, 16, v20
    v_and_b32 v22, 0xffff0000, v20
    v_mul_f32 v21, s45, v21
    v_mul_f32 v22, s45, v22
    v_cvt_pk_bf16_f32 v20, v21, v22
    v_lshlrev_b32 v21, 16, v20
    v_and_b32 v22, 0xffff0000, v20
    v_lshlrev_b32 v23, 16, v32
    v_and_b32 v24, 0xffff0000, v32
    v_add_f32 v21, v21, v23
    v_add_f32 v22, v22, v24
    v_cvt_pk_bf16_f32 v20, v21, v22
    v_lshlrev_b32 v21, 16, v20
    v_and_b32 v22, 0xffff0000, v20
    v_lshlrev_b32 v23, 16, v34
    v_and_b32 v24, 0xffff0000, v34
    v_add_f32 v21, v21, v23
    v_add_f32 v22, v22, v24
    v_cvt_pk_bf16_f32 v26, v21, v22
    v_cvt_pk_bf16_f32 v20, v98, v99
    v_lshlrev_b32 v21, 16, v20
    v_and_b32 v22, 0xffff0000, v20
    v_mul_f32 v21, s45, v21
    v_mul_f32 v22, s45, v22
    v_cvt_pk_bf16_f32 v20, v21, v22
    v_lshlrev_b32 v21, 16, v20
    v_and_b32 v22, 0xffff0000, v20
    v_lshlrev_b32 v23, 16, v33
    v_and_b32 v24, 0xffff0000, v33
    v_add_f32 v21, v21, v23
    v_add_f32 v22, v22, v24
    v_cvt_pk_bf16_f32 v20, v21, v22
    v_lshlrev_b32 v21, 16, v20
    v_and_b32 v22, 0xffff0000, v20
    v_lshlrev_b32 v23, 16, v35
    v_and_b32 v24, 0xffff0000, v35
    v_add_f32 v21, v21, v23
    v_add_f32 v22, v22, v24
    v_cvt_pk_bf16_f32 v27, v21, v22
    v_cmp_gt_u32 vcc, 16, v2
    s_and_saveexec_b64 s[52:53], vcc
    s_cbranch_execz ff_fin_155
    buffer_store_dwordx2 v[26:27], v9, s[36:39], s46 offen sc1
ff_fin_155:
    s_mov_b64 exec, -1
k12_end_1:
    s_endpgm
k2_prep_76:
    s_sub_u32 s40, s36, s38
    v_subrev_u32 v6, s40, v4
    v_cmp_gt_i32 s[44:45], 0, v6
    v_cmp_gt_i32 s[46:47], 1, v6
    v_cmp_gt_i32 s[48:49], 2, v6
    v_cmp_gt_i32 s[50:51], 3, v6
    v_cndmask_b32 v16, v8, v5, s[44:45]
    v_cndmask_b32 v17, v8, v5, s[46:47]
    v_cndmask_b32 v18, v8, v5, s[48:49]
    v_cndmask_b32 v19, v8, v5, s[50:51]
    v_cmp_gt_i32 s[44:45], 16, v6
    v_cmp_gt_i32 s[46:47], 17, v6
    v_cmp_gt_i32 s[48:49], 18, v6
    v_cmp_gt_i32 s[50:51], 19, v6
    v_cndmask_b32 v32, v8, v5, s[44:45]
    v_cndmask_b32 v33, v8, v5, s[46:47]
    v_cndmask_b32 v34, v8, v5, s[48:49]
    v_cndmask_b32 v35, v8, v5, s[50:51]
    s_nop 1
    s_branch k2_prepret_77
k2_prep_84:
    s_sub_u32 s40, s36, s38
    v_subrev_u32 v6, s40, v4
    v_cmp_gt_i32 s[44:45], 0, v6
    v_cmp_gt_i32 s[46:47], 1, v6
    v_cmp_gt_i32 s[48:49], 2, v6
    v_cmp_gt_i32 s[50:51], 3, v6
    v_cndmask_b32 v16, v8, v5, s[44:45]
    v_cndmask_b32 v17, v8, v5, s[46:47]
    v_cndmask_b32 v18, v8, v5, s[48:49]
    v_cndmask_b32 v19, v8, v5, s[50:51]
    v_cmp_gt_i32 s[44:45], 16, v6
    v_cmp_gt_i32 s[46:47], 17, v6
    v_cmp_gt_i32 s[48:49], 18, v6
    v_cmp_gt_i32 s[50:51], 19, v6
    v_cndmask_b32 v32, v8, v5, s[44:45]
    v_cndmask_b32 v33, v8, v5, s[46:47]
    v_cndmask_b32 v34, v8, v5, s[48:49]
    v_cndmask_b32 v35, v8, v5, s[50:51]
    s_nop 1
    s_branch k2_prepret_85
k2_prep_102:
    s_sub_u32 s40, s36, s39
    v_subrev_u32 v6, s40, v4
    v_cmp_gt_i32 s[44:45], 0, v6
    v_cmp_gt_i32 s[46:47], 1, v6
    v_cmp_gt_i32 s[48:49], 2, v6
    v_cmp_gt_i32 s[50:51], 3, v6
    v_cndmask_b32 v16, v10, v5, s[44:45]
    v_cndmask_b32 v17, v10, v5, s[46:47]
    v_cndmask_b32 v18, v10, v5, s[48:49]
    v_cndmask_b32 v19, v10, v5, s[50:51]
    v_cmp_gt_i32 s[44:45], 16, v6
    v_cmp_gt_i32 s[46:47], 17, v6
    v_cmp_gt_i32 s[48:49], 18, v6
    v_cmp_gt_i32 s[50:51], 19, v6
    v_cndmask_b32 v32, v10, v5, s[44:45]
    v_cndmask_b32 v33, v10, v5, s[46:47]
    v_cndmask_b32 v34, v10, v5, s[48:49]
    v_cndmask_b32 v35, v10, v5, s[50:51]
    v_cmp_gt_i32 s[44:45], 32, v6
    v_cmp_gt_i32 s[46:47], 33, v6
    v_cmp_gt_i32 s[48:49], 34, v6
    v_cmp_gt_i32 s[50:51], 35, v6
    v_cndmask_b32 v24, v10, v5, s[44:45]
    v_cndmask_b32 v25, v10, v5, s[46:47]
    v_cndmask_b32 v26, v10, v5, s[48:49]
    v_cndmask_b32 v27, v10, v5, s[50:51]
    v_cmp_gt_i32 s[44:45], 48, v6
    v_cmp_gt_i32 s[46:47], 49, v6
    v_cmp_gt_i32 s[48:49], 50, v6
    v_cmp_gt_i32 s[50:51], 51, v6
    v_cndmask_b32 v40, v10, v5, s[44:45]
    v_cndmask_b32 v41, v10, v5, s[46:47]
    v_cndmask_b32 v42, v10, v5, s[48:49]
    v_cndmask_b32 v43, v10, v5, s[50:51]
    s_nop 1
    s_branch k2_prepret_103
k2_prep_106:
    s_sub_u32 s40, s36, s39
    s_sub_u32 s40, s40, 64
    v_subrev_u32 v6, s40, v4
    v_cmp_gt_i32 s[44:45], 0, v6
    v_cmp_gt_i32 s[46:47], 1, v6
    v_cmp_gt_i32 s[48:49], 2, v6
    v_cmp_gt_i32 s[50:51], 3, v6
    v_cndmask_b32 v20, v11, v5, s[44:45]
    v_cndmask_b32 v21, v11, v5, s[46:47]
    v_cndmask_b32 v22, v11, v5, s[48:49]
    v_cndmask_b32 v23, v11, v5, s[50:51]
    v_cmp_gt_i32 s[44:45], 16, v6
    v_cmp_gt_i32 s[46:47], 17, v6
    v_cmp_gt_i32 s[48:49], 18, v6
    v_cmp_gt_i32 s[50:51], 19, v6
    v_cndmask_b32 v36, v11, v5, s[44:45]
    v_cndmask_b32 v37, v11, v5, s[46:47]
    v_cndmask_b32 v38, v11, v5, s[48:49]
    v_cndmask_b32 v39, v11, v5, s[50:51]
    v_cmp_gt_i32 s[44:45], 32, v6
    v_cmp_gt_i32 s[46:47], 33, v6
    v_cmp_gt_i32 s[48:49], 34, v6
    v_cmp_gt_i32 s[50:51], 35, v6
    v_cndmask_b32 v28, v11, v5, s[44:45]
    v_cndmask_b32 v29, v11, v5, s[46:47]
    v_cndmask_b32 v30, v11, v5, s[48:49]
    v_cndmask_b32 v31, v11, v5, s[50:51]
    v_cmp_gt_i32 s[44:45], 48, v6
    v_cmp_gt_i32 s[46:47], 49, v6
    v_cmp_gt_i32 s[48:49], 50, v6
    v_cmp_gt_i32 s[50:51], 51, v6
    v_cndmask_b32 v44, v11, v5, s[44:45]
    v_cndmask_b32 v45, v11, v5, s[46:47]
    v_cndmask_b32 v46, v11, v5, s[48:49]
    v_cndmask_b32 v47, v11, v5, s[50:51]
    s_nop 1
    s_branch k2_prepret_107
k12_ool_10:
    buffer_load_dword v52, v8, s[24:27], 0 offen sc1
    s_branch k12_oolret_11
k12_ool_14:
    v_readfirstlane_b32 s31, v52
    s_cmp_ge_u32 s31, 256
    s_cbranch_scc1 spin_ok_12
    s_mov_b32 s40, 1048576
spin_13:
    s_sleep 8
    buffer_load_dword v52, v8, s[24:27], 0 offen sc1
    s_waitcnt vmcnt(0)
    v_readfirstlane_b32 s31, v52
    s_sub_u32 s40, s40, 1
    s_cselect_b32 s31, -1, s31
    s_cmp_lt_u32 s31, 256
    s_cbranch_scc1 spin_13
spin_ok_12:
    s_branch k12_oolret_15
k12_ool_16:
    s_mov_b64 exec, 1
    buffer_atomic_add v9, v8, s[24:27], 0 offen sc1
    s_mov_b64 exec, -1
    s_branch k12_oolret_17
k12_ool_18:
    buffer_load_dword v51, v50, s[12:15], s56 offen
    s_branch k12_oolret_19
k12_ool_20:
    s_add_u32 m0, s60, 131072
    s_nop 0
    buffer_load_dwordx4 v38, s[12:15], s61 offen offset:0 lds
    buffer_load_dwordx4 v39, s[12:15], s61 offen offset:1024 lds
    buffer_load_dwordx4 v40, s[12:15], s61 offen offset:2048 lds
    buffer_load_dwordx4 v41, s[12:15], s61 offen offset:3072 lds
    s_add_u32 s61, s61, 0x80000
    s_add_u32 m0, s60, 147456
    s_nop 0
    buffer_load_dwordx4 v38, s[12:15], s61 offen offset:0 lds
    buffer_load_dwordx4 v39, s[12:15], s61 offen offset:1024 lds
    buffer_load_dwordx4 v40, s[12:15], s61 offen offset:2048 lds
    buffer_load_dwordx4 v41, s[12:15], s61 offen offset:3072 lds
    s_add_u32 s61, s61, 0x80000
    s_branch k12_oolret_21
k12_ool_22:
    s_mov_b64 exec, 1
    buffer_atomic_add v9, v8, s[24:27], 0 offen sc1
    s_mov_b64 exec, -1
    s_branch k12_oolret_23
k12_ool_24:
    buffer_load_dword v51, v50, s[12:15], s56 offen
    s_branch k12_oolret_25
k12_ool_26:
    global_load_dword v51, v[2:3], off
    s_branch k12_oolret_27
k12_ool_30:
    buffer_load_dword v52, v8, s[24:27], 0 offen sc1
    s_branch k12_oolret_31
k12_ool_34:
    v_readfirstlane_b32 s31, v52
    s_cmp_ge_u32 s31, 256
    s_cbranch_scc1 spin_ok_32
    s_mov_b32 s40, 1048576
spin_33:
    s_sleep 8
    buffer_load_dword v52, v8, s[24:27], 0 offen sc1
    s_waitcnt vmcnt(0)
    v_readfirstlane_b32 s31, v52
    s_sub_u32 s40, s40, 1
    s_cselect_b32 s31, -1, s31
    s_cmp_lt_u32 s31, 256
    s_cbranch_scc1 spin_33
spin_ok_32:
    s_branch k12_oolret_35
k12_ool_36:
    s_mov_b64 exec, 1
    buffer_atomic_add v9, v8, s[24:27], 0 offen sc1
    s_mov_b64 exec, -1
    s_branch k12_oolret_37
k12_ool_38:
    buffer_load_dword v51, v50, s[12:15], s56 offen
    s_branch k12_oolret_39
k12_ool_40:
    s_add_u32 m0, s60, 131072
    s_nop 0
    buffer_load_dwordx4 v38, s[12:15], s61 offen offset:0 lds
    buffer_load_dwordx4 v39, s[12:15], s61 offen offset:1024 lds
    buffer_load_dwordx4 v40, s[12:15], s61 offen offset:2048 lds
    buffer_load_dwordx4 v41, s[12:15], s61 offen offset:3072 lds
    s_add_u32 s61, s61, 0x80000
    s_add_u32 m0, s60, 147456
    s_nop 0
    buffer_load_dwordx4 v38, s[12:15], s61 offen offset:0 lds
    buffer_load_dwordx4 v39, s[12:15], s61 offen offset:1024 lds
    buffer_load_dwordx4 v40, s[12:15], s61 offen offset:2048 lds
    buffer_load_dwordx4 v41, s[12:15], s61 offen offset:3072 lds
    s_add_u32 s61, s61, 0x80000
    s_branch k12_oolret_41
k12_ool_42:
    s_mov_b64 exec, 1
    buffer_atomic_add v9, v8, s[24:27], 0 offen sc1
    s_mov_b64 exec, -1
    s_branch k12_oolret_43
k12_ool_44:
    buffer_load_dword v51, v50, s[12:15], s56 offen
    s_branch k12_oolret_45
k12_ool_46:
    global_load_dword v51, v[2:3], off
    s_branch k12_oolret_47
k12_ool_48:
    s_add_u32 s52, s47, 528384
    buffer_store_dwordx4 v[152:155], v1, s[48:51], s52 offen offset:2048 sc1
    s_branch k12_oolret_49
k12_ool_50:
    s_add_u32 s52, s47, 528384
    buffer_store_dwordx4 v[156:159], v1, s[48:51], s52 offen offset:3072 sc1
    s_branch k12_oolret_51
k12_ool_52:
    s_add_u32 s52, s47, 532480
    buffer_store_dwordx4 v[168:171], v1, s[48:51], s52 offen offset:2048 sc1
    s_branch k12_oolret_53
k12_ool_54:
    s_add_u32 s52, s47, 532480
    buffer_store_dwordx4 v[172:175], v1, s[48:51], s52 offen offset:3072 sc1
    s_branch k12_oolret_55
k12_ool_56:
    s_add_u32 s52, s47, 536576
    buffer_store_dwordx4 v[176:179], v1, s[48:51], s52 offen offset:0 sc1
    s_branch k12_oolret_57
k12_ool_58:
    s_add_u32 s52, s47, 536576
    buffer_store_dwordx4 v[180:183], v1, s[48:51], s52 offen offset:1024 sc1
    s_branch k12_oolret_59
k12_ool_60:
    s_add_u32 s52, s47, 536576
    buffer_store_dwordx4 v[184:187], v1, s[48:51], s52 offen offset:2048 sc1
    s_branch k12_oolret_61
k12_ool_62:
    s_add_u32 s52, s47, 536576
    buffer_store_dwordx4 v[188:191], v1, s[48:51], s52 offen offset:3072 sc1
    s_branch k12_oolret_63
k12_ool_64:
    s_mov_b32 s50, 0
    s_branch k12_oolret_65
k12_ool_66:
    s_mov_b64 exec, 1
    buffer_atomic_add v9, v8, s[24:27], s54 offen sc1
    s_mov_b64 exec, -1
    s_branch k12_oolret_67
k12_ool_68:
    buffer_load_dword v52, v8, s[24:27], s55 offen sc1
    s_branch k12_oolret_69
k12_ool_72:
    s_waitcnt vmcnt(10)
    v_readfirstlane_b32 s31, v52
    s_cmp_ge_u32 s31, 2
    s_cbranch_scc1 spin_ok_70
    s_mov_b32 s40, 1048576
spin_71:
    s_sleep 8
    buffer_load_dword v52, v8, s[24:27], s55 offen sc1
    s_waitcnt vmcnt(0)
    v_readfirstlane_b32 s31, v52
    s_sub_u32 s40, s40, 1
    s_cselect_b32 s31, -1, s31
    s_cmp_lt_u32 s31, 2
    s_cbranch_scc1 spin_71
spin_ok_70:
    s_branch k12_oolret_73
k12_ool_74:
    s_mov_b64 exec, 1
    buffer_atomic_add v9, v8, s[24:27], s3 offen sc1
    s_mov_b64 exec, -1
    s_branch k12_oolret_75
k12_ool_78:
    buffer_load_dword v58, v59, s[24:27], s5 offen sc1
    s_branch k12_oolret_79
k12_ool_82:
    s_waitcnt vmcnt(0)
    v_readfirstlane_b32 s31, v58
    s_cmp_ge_u32 s31, 14
    s_cbranch_scc1 spin_ok_80
    s_mov_b32 s40, 1048576
spin_81:
    s_sleep 8
    buffer_load_dword v58, v59, s[24:27], s5 offen sc1
    s_waitcnt vmcnt(0)
    v_readfirstlane_b32 s31, v58
    s_sub_u32 s40, s40, 1
    s_cselect_b32 s31, -1, s31
    s_cmp_lt_u32 s31, 14
    s_cbranch_scc1 spin_81
spin_ok_80:
    s_branch k12_oolret_83
k12_ool_122:
    s_mov_b64 exec, 1
    buffer_atomic_add v76, v75, s[16:19], s57 offen sc1
    s_mov_b64 exec, -1
    s_branch k12_oolret_123
k12_ool_127:
    s_mov_b64 exec, 1
    buffer_atomic_add v76, v75, s[16:19], s58 offen sc1
    s_mov_b64 exec, -1
    s_branch k12_oolret_128
k12_ool_131:
    s_mov_b32 s34, 1048576
op_spin_129:
    buffer_load_dword v74, v73, s[16:19], s59 offen sc1
    s_waitcnt vmcnt(0)
    v_cmp_le_u32 vcc, 4, v74
    s_sub_u32 s34, s34, 1
    s_cbranch_scc1 op_ok_130
    s_mov_b32 s33, vcc_lo
    s_bitcmp1_b32 s33, 0
    s_cbranch_scc1 op_ok_130
    s_sleep 4
    s_branch op_spin_129
op_ok_130:
    buffer_load_dwordx4 a[128:131], v88, s[8:11], s62 offen offset:0 sc1
    buffer_load_dwordx4 a[132:135], v88, s[8:11], s62 offen offset:1024 sc1
    buffer_load_dwordx4 a[136:139], v89, s[8:11], s62 offen offset:0 sc1
    buffer_load_dwordx4 a[140:143], v89, s[8:11], s62 offen offset:1024 sc1
    s_add_u32 s62, s62, 0x40000
    s_and_b32 s62, s62, 0x7fffff
    buffer_load_dwordx4 a[144:147], v88, s[8:11], s62 offen offset:0 sc1
    buffer_load_dwordx4 a[148:151], v88, s[8:11], s62 offen offset:1024 sc1
    buffer_load_dwordx4 a[152:155], v89, s[8:11], s62 offen offset:0 sc1
    buffer_load_dwordx4 a[156:159], v89, s[8:11], s62 offen offset:1024 sc1
    s_add_u32 s62, s62, 0x40000
    s_and_b32 s62, s62, 0x7fffff
    buffer_load_dwordx4 a[160:163], v88, s[8:11], s62 offen offset:0 sc1
    buffer_load_dwordx4 a[164:167], v88, s[8:11], s62 offen offset:1024 sc1
    buffer_load_dwordx4 a[168:171], v89, s[8:11], s62 offen offset:0 sc1
    buffer_load_dwordx4 a[172:175], v89, s[8:11], s62 offen offset:1024 sc1
    s_add_u32 s62, s62, 0x40000
    s_and_b32 s62, s62, 0x7fffff
    s_branch k12_oolret_132
k12_ool_137:
    buffer_load_dwordx2 v[192:193], v78, s[20:23], 0 offen offset:0
    buffer_load_dwordx2 v[194:195], v78, s[20:23], 0 offen offset:32
    buffer_load_dwordx2 v[196:197], v78, s[20:23], 0 offen offset:64
    buffer_load_dwordx2 v[198:199], v78, s[20:23], 0 offen offset:96
    buffer_load_dwordx2 v[200:201], v79, s[20:23], 0 offen offset:0
    buffer_load_dwordx2 v[202:203], v79, s[20:23], 0 offen offset:32
    buffer_load_dwordx2 v[204:205], v79, s[20:23], 0 offen offset:64
    buffer_load_dwordx2 v[206:207], v79, s[20:23], 0 offen offset:96
    buffer_load_dwordx2 v[208:209], v80, s[44:47], 0 offen offset:0
    buffer_load_dwordx2 v[210:211], v80, s[44:47], 0 offen offset:32
    buffer_load_dwordx2 v[212:213], v80, s[44:47], 0 offen offset:64
    buffer_load_dwordx2 v[214:215], v80, s[44:47], 0 offen offset:96
    global_load_dword v84, v[82:83], off
    s_mov_b32 s10, 0
    s_mov_b32 s14, 0
    s_mov_b32 s34, 1048576
ff_spin_135:
    v_cmp_gt_u32 vcc, 4, v95
    s_cbranch_vccz ff_ok_136
    s_sub_u32 s34, s34, 1
    s_cbranch_scc1 ff_ok_136
    s_sleep 4
    buffer_load_dword v95, v94, s[16:19], 0 offen sc1
    s_waitcnt vmcnt(0)
    s_branch ff_spin_135
ff_ok_136:
    s_add_u32 s44, s6, 0x6000000
    s_addc_u32 s45, s7, 0
    s_and_b32 s45, s45, 0xffff
    s_cmp_ge_u32 s2, 224
    s_cselect_b32 s46, 0, 0x1000000
    s_branch k12_oolret_138
k12_ool_141:
    s_mov_b32 s34, 1048576
op_spin_139:
    buffer_load_dword v74, v73, s[16:19], s59 offen sc1
    s_waitcnt vmcnt(0)
    v_cmp_le_u32 vcc, 4, v74
    s_sub_u32 s34, s34, 1
    s_cbranch_scc1 op_ok_140
    s_mov_b32 s33, vcc_lo
    s_bitcmp1_b32 s33, s32
    s_cbranch_scc1 op_ok_140
    s_sleep 4
    s_branch op_spin_139
op_ok_140:
    s_branch k12_oolret_142
k12_ool_143:
    buffer_load_dword v95, v94, s[16:19], 0 offen sc1
    s_branch k12_oolret_144
k2_tramp_86:
    s_call_b64 s[40:41], k2_rare_158
    s_branch k2_ret_87
k2_tramp_90:
    s_call_b64 s[40:41], k2_rare_159
    s_branch k2_ret_91
k2_tramp_92:
    s_call_b64 s[40:41], k2_rare_158
    s_branch k2_ret_93
k2_tramp_94:
    s_call_b64 s[40:41], k2_rare_159
    s_branch k2_ret_95
k2_tramp_96:
    s_call_b64 s[40:41], k2_rare_158
    s_branch k2_ret_97
k2_tramp_98:
    s_call_b64 s[40:41], k2_rare_159
    s_branch k2_ret_99
k2_tramp_100:
    s_call_b64 s[40:41], k2_rare_164
    s_branch k2_ret_101
k2_tramp_104:
    s_call_b64 s[40:41], k2_rare_165
    s_branch k2_ret_105
k2_tramp_108:
    s_call_b64 s[40:41], k2_rare_166
    s_branch k2_ret_109
k2_tramp_112:
    s_call_b64 s[40:41], k2_rare_167
    s_branch k2_ret_113
k2_tramp_114:
    s_call_b64 s[40:41], k2_rare_166
    s_branch k2_ret_115
k2_tramp_116:
    s_call_b64 s[40:41], k2_rare_167
    s_branch k2_ret_117
k2_tramp_118:
    s_call_b64 s[40:41], k2_rare_166
    s_branch k2_ret_119
k2_tramp_120:
    s_call_b64 s[40:41], k2_rare_171
    s_branch k2_ret_121
k2_rare_158:
    s_nop 7
    v_max_f32 v52, v128, v129
    v_max3_f32 v52, v52, v130, v131
    v_max3_f32 v52, v52, v144, v145
    v_max3_f32 v52, v52, v146, v147
    v_max_f32 v53, v132, v133
    v_max3_f32 v53, v53, v134, v135
    v_max3_f32 v53, v53, v148, v149
    v_max3_f32 v53, v53, v150, v151
    v_max_f32 v54, v136, v137
    v_max3_f32 v54, v54, v138, v139
    v_max3_f32 v54, v54, v152, v153
    v_max3_f32 v54, v54, v154, v155
    v_max_f32 v55, v140, v141
    v_max3_f32 v55, v55, v142, v143
    v_max3_f32 v55, v55, v156, v157
    v_max3_f32 v55, v55, v158, v159
    v_mov_b32 v224, v52
    v_mov_b32 v225, v53
    v_mov_b32 v226, v54
    v_mov_b32 v227, v55
    s_nop 1
    v_permlane16_swap_b32 v52, v224
    v_permlane16_swap_b32 v53, v225
    v_permlane16_swap_b32 v54, v226
    v_permlane16_swap_b32 v55, v227
    s_nop 1
    v_max_f32 v52, v52, v224
    v_max_f32 v53, v53, v225
    v_max_f32 v54, v54, v226
    v_max_f32 v55, v55, v227
    v_mov_b32 v224, v52
    v_mov_b32 v225, v53
    v_mov_b32 v226, v54
    v_mov_b32 v227, v55
    s_nop 1
    v_permlane32_swap_b32 v52, v224
    v_permlane32_swap_b32 v53, v225
    v_permlane32_swap_b32 v54, v226
    v_permlane32_swap_b32 v55, v227
    s_nop 1
    v_max_f32 v52, v52, v224
    v_max_f32 v53, v53, v225
    v_max_f32 v54, v54, v226
    v_max_f32 v55, v55, v227
    v_add_f32 v52, 0x41400000, v52
    v_max_f32 v52, 0, v52
    v_add_f32 v53, 0x41400000, v53
    v_max_f32 v53, 0, v53
    v_add_f32 v54, 0x41400000, v54
    v_max_f32 v54, 0, v54
    v_add_f32 v55, 0x41400000, v55
    v_max_f32 v55, 0, v55
    v_sub_f32 v128, v128, v52
    v_sub_f32 v129, v129, v52
    v_sub_f32 v130, v130, v52
    v_sub_f32 v131, v131, v52
    v_sub_f32 v132, v132, v53
    v_sub_f32 v133, v133, v53
    v_sub_f32 v134, v134, v53
    v_sub_f32 v135, v135, v53
    v_sub_f32 v136, v136, v54
    v_sub_f32 v137, v137, v54
    v_sub_f32 v138, v138, v54
    v_sub_f32 v139, v139, v54
    v_sub_f32 v140, v140, v55
    v_sub_f32 v141, v141, v55
    v_sub_f32 v142, v142, v55
    v_sub_f32 v143, v143, v55
    v_sub_f32 v144, v144, v52
    v_sub_f32 v145, v145, v52
    v_sub_f32 v146, v146, v52
    v_sub_f32 v147, v147, v52
    v_sub_f32 v148, v148, v53
    v_sub_f32 v149, v149, v53
    v_sub_f32 v150, v150, v53
    v_sub_f32 v151, v151, v53
    v_sub_f32 v152, v152, v54
    v_sub_f32 v153, v153, v54
    v_sub_f32 v154, v154, v54
    v_sub_f32 v155, v155, v54
    v_sub_f32 v156, v156, v55
    v_sub_f32 v157, v157, v55
    v_sub_f32 v158, v158, v55
    v_sub_f32 v159, v159, v55
    v_sub_f32 v160, v160, v52
    v_sub_f32 v16, v16, v52
    v_sub_f32 v161, v161, v52
    v_sub_f32 v17, v17, v52
    v_sub_f32 v162, v162, v52
    v_sub_f32 v18, v18, v52
    v_sub_f32 v163, v163, v52
    v_sub_f32 v19, v19, v52
    v_sub_f32 v164, v164, v53
    v_sub_f32 v20, v20, v53
    v_sub_f32 v165, v165, v53
    v_sub_f32 v21, v21, v53
    v_sub_f32 v166, v166, v53
    v_sub_f32 v22, v22, v53
    v_sub_f32 v167, v167, v53
    v_sub_f32 v23, v23, v53
    v_sub_f32 v168, v168, v54
    v_sub_f32 v24, v24, v54
    v_sub_f32 v169, v169, v54
    v_sub_f32 v25, v25, v54
    v_sub_f32 v170, v170, v54
    v_sub_f32 v26, v26, v54
    v_sub_f32 v171, v171, v54
    v_sub_f32 v27, v27, v54
    v_sub_f32 v172, v172, v55
    v_sub_f32 v28, v28, v55
    v_sub_f32 v173, v173, v55
    v_sub_f32 v29, v29, v55
    v_sub_f32 v174, v174, v55
    v_sub_f32 v30, v30, v55
    v_sub_f32 v175, v175, v55
    v_sub_f32 v31, v31, v55
    v_sub_f32 v176, v176, v52
    v_sub_f32 v32, v32, v52
    v_sub_f32 v177, v177, v52
    v_sub_f32 v33, v33, v52
    v_sub_f32 v178, v178, v52
    v_sub_f32 v34, v34, v52
    v_sub_f32 v179, v179, v52
    v_sub_f32 v35, v35, v52
    v_sub_f32 v180, v180, v53
    v_sub_f32 v36, v36, v53
    v_sub_f32 v181, v181, v53
    v_sub_f32 v37, v37, v53
    v_sub_f32 v182, v182, v53
    v_sub_f32 v38, v38, v53
    v_sub_f32 v183, v183, v53
    v_sub_f32 v39, v39, v53
    v_sub_f32 v184, v184, v54
    v_sub_f32 v40, v40, v54
    v_sub_f32 v185, v185, v54
    v_sub_f32 v41, v41, v54
    v_sub_f32 v186, v186, v54
    v_sub_f32 v42, v42, v54
    v_sub_f32 v187, v187, v54
    v_sub_f32 v43, v43, v54
    v_sub_f32 v188, v188, v55
    v_sub_f32 v44, v44, v55
    v_sub_f32 v189, v189, v55
    v_sub_f32 v45, v45, v55
    v_sub_f32 v190, v190, v55
    v_sub_f32 v46, v46, v55
    v_sub_f32 v191, v191, v55
    v_sub_f32 v47, v47, v55
    v_sub_f32 v8, v8, v52
    v_exp_f32 v52, -v52
    v_sub_f32 v9, v9, v53
    v_exp_f32 v53, -v53
    v_sub_f32 v10, v10, v54
    v_exp_f32 v54, -v54
    v_sub_f32 v11, v11, v55
    v_exp_f32 v55, -v55
    s_nop 0
    v_mul_f32 v12, v12, v52
    v_mul_f32 v48, v48, v53
    v_mul_f32 v248, v248, v54
    v_mul_f32 v252, v252, v55
    v_accvgpr_read_b32 v224, a0
    v_accvgpr_read_b32 v225, a1
    v_accvgpr_read_b32 v226, a2
    v_accvgpr_read_b32 v227, a3
    v_mul_f32 v224, v224, v52
    v_mul_f32 v225, v225, v52
    v_mul_f32 v226, v226, v52
    v_mul_f32 v227, v227, v52
    v_accvgpr_write_b32 a0, v224
    v_accvgpr_write_b32 a1, v225
    v_accvgpr_write_b32 a2, v226
    v_accvgpr_write_b32 a3, v227
    v_accvgpr_read_b32 v224, a4
    v_accvgpr_read_b32 v225, a5
    v_accvgpr_read_b32 v226, a6
    v_accvgpr_read_b32 v227, a7
    v_mul_f32 v224, v224, v53
    v_mul_f32 v225, v225, v53
    v_mul_f32 v226, v226, v53
    v_mul_f32 v227, v227, v53
    v_accvgpr_write_b32 a4, v224
    v_accvgpr_write_b32 a5, v225
    v_accvgpr_write_b32 a6, v226
    v_accvgpr_write_b32 a7, v227
    v_accvgpr_read_b32 v224, a8
    v_accvgpr_read_b32 v225, a9
    v_accvgpr_read_b32 v226, a10
    v_accvgpr_read_b32 v227, a11
    v_mul_f32 v224, v224, v54
    v_mul_f32 v225, v225, v54
    v_mul_f32 v226, v226, v54
    v_mul_f32 v227, v227, v54
    v_accvgpr_write_b32 a8, v224
    v_accvgpr_write_b32 a9, v225
    v_accvgpr_write_b32 a10, v226
    v_accvgpr_write_b32 a11, v227
    v_accvgpr_read_b32 v224, a12
    v_accvgpr_read_b32 v225, a13
    v_accvgpr_read_b32 v226, a14
    v_accvgpr_read_b32 v227, a15
    v_mul_f32 v224, v224, v55
    v_mul_f32 v225, v225, v55
    v_mul_f32 v226, v226, v55
    v_mul_f32 v227, v227, v55
    v_accvgpr_write_b32 a12, v224
    v_accvgpr_write_b32 a13, v225
    v_accvgpr_write_b32 a14, v226
    v_accvgpr_write_b32 a15, v227
    v_accvgpr_read_b32 v224, a16
    v_accvgpr_read_b32 v225, a17
    v_accvgpr_read_b32 v226, a18
    v_accvgpr_read_b32 v227, a19
    v_mul_f32 v224, v224, v52
    v_mul_f32 v225, v225, v52
    v_mul_f32 v226, v226, v52
    v_mul_f32 v227, v227, v52
    v_accvgpr_write_b32 a16, v224
    v_accvgpr_write_b32 a17, v225
    v_accvgpr_write_b32 a18, v226
    v_accvgpr_write_b32 a19, v227
    v_accvgpr_read_b32 v224, a20
    v_accvgpr_read_b32 v225, a21
    v_accvgpr_read_b32 v226, a22
    v_accvgpr_read_b32 v227, a23
    v_mul_f32 v224, v224, v53
    v_mul_f32 v225, v225, v53
    v_mul_f32 v226, v226, v53
    v_mul_f32 v227, v227, v53
    v_accvgpr_write_b32 a20, v224
    v_accvgpr_write_b32 a21, v225
    v_accvgpr_write_b32 a22, v226
    v_accvgpr_write_b32 a23, v227
    v_accvgpr_read_b32 v224, a24
    v_accvgpr_read_b32 v225, a25
    v_accvgpr_read_b32 v226, a26
    v_accvgpr_read_b32 v227, a27
    v_mul_f32 v224, v224, v54
    v_mul_f32 v225, v225, v54
    v_mul_f32 v226, v226, v54
    v_mul_f32 v227, v227, v54
    v_accvgpr_write_b32 a24, v224
    v_accvgpr_write_b32 a25, v225
    v_accvgpr_write_b32 a26, v226
    v_accvgpr_write_b32 a27, v227
    v_accvgpr_read_b32 v224, a28
    v_accvgpr_read_b32 v225, a29
    v_accvgpr_read_b32 v226, a30
    v_accvgpr_read_b32 v227, a31
    v_mul_f32 v224, v224, v55
    v_mul_f32 v225, v225, v55
    v_mul_f32 v226, v226, v55
    v_mul_f32 v227, v227, v55
    v_accvgpr_write_b32 a28, v224
    v_accvgpr_write_b32 a29, v225
    v_accvgpr_write_b32 a30, v226
    v_accvgpr_write_b32 a31, v227
    v_accvgpr_read_b32 v224, a32
    v_accvgpr_read_b32 v225, a33
    v_accvgpr_read_b32 v226, a34
    v_accvgpr_read_b32 v227, a35
    v_mul_f32 v224, v224, v52
    v_mul_f32 v225, v225, v52
    v_mul_f32 v226, v226, v52
    v_mul_f32 v227, v227, v52
    v_accvgpr_write_b32 a32, v224
    v_accvgpr_write_b32 a33, v225
    v_accvgpr_write_b32 a34, v226
    v_accvgpr_write_b32 a35, v227
    v_accvgpr_read_b32 v224, a36
    v_accvgpr_read_b32 v225, a37
    v_accvgpr_read_b32 v226, a38
    v_accvgpr_read_b32 v227, a39
    v_mul_f32 v224, v224, v53
    v_mul_f32 v225, v225, v53
    v_mul_f32 v226, v226, v53
    v_mul_f32 v227, v227, v53
    v_accvgpr_write_b32 a36, v224
    v_accvgpr_write_b32 a37, v225
    v_accvgpr_write_b32 a38, v226
    v_accvgpr_write_b32 a39, v227
    v_accvgpr_read_b32 v224, a40
    v_accvgpr_read_b32 v225, a41
    v_accvgpr_read_b32 v226, a42
    v_accvgpr_read_b32 v227, a43
    v_mul_f32 v224, v224, v54
    v_mul_f32 v225, v225, v54
    v_mul_f32 v226, v226, v54
    v_mul_f32 v227, v227, v54
    v_accvgpr_write_b32 a40, v224
    v_accvgpr_write_b32 a41, v225
    v_accvgpr_write_b32 a42, v226
    v_accvgpr_write_b32 a43, v227
    v_accvgpr_read_b32 v224, a44
    v_accvgpr_read_b32 v225, a45
    v_accvgpr_read_b32 v226, a46
    v_accvgpr_read_b32 v227, a47
    v_mul_f32 v224, v224, v55
    v_mul_f32 v225, v225, v55
    v_mul_f32 v226, v226, v55
    v_mul_f32 v227, v227, v55
    v_accvgpr_write_b32 a44, v224
    v_accvgpr_write_b32 a45, v225
    v_accvgpr_write_b32 a46, v226
    v_accvgpr_write_b32 a47, v227
    v_accvgpr_read_b32 v224, a48
    v_accvgpr_read_b32 v225, a49
    v_accvgpr_read_b32 v226, a50
    v_accvgpr_read_b32 v227, a51
    v_mul_f32 v224, v224, v52
    v_mul_f32 v225, v225, v52
    v_mul_f32 v226, v226, v52
    v_mul_f32 v227, v227, v52
    v_accvgpr_write_b32 a48, v224
    v_accvgpr_write_b32 a49, v225
    v_accvgpr_write_b32 a50, v226
    v_accvgpr_write_b32 a51, v227
    v_accvgpr_read_b32 v224, a52
    v_accvgpr_read_b32 v225, a53
    v_accvgpr_read_b32 v226, a54
    v_accvgpr_read_b32 v227, a55
    v_mul_f32 v224, v224, v53
    v_mul_f32 v225, v225, v53
    v_mul_f32 v226, v226, v53
    v_mul_f32 v227, v227, v53
    v_accvgpr_write_b32 a52, v224
    v_accvgpr_write_b32 a53, v225
    v_accvgpr_write_b32 a54, v226
    v_accvgpr_write_b32 a55, v227
    v_accvgpr_read_b32 v224, a56
    v_accvgpr_read_b32 v225, a57
    v_accvgpr_read_b32 v226, a58
    v_accvgpr_read_b32 v227, a59
    v_mul_f32 v224, v224, v54
    v_mul_f32 v225, v225, v54
    v_mul_f32 v226, v226, v54
    v_mul_f32 v227, v227, v54
    v_accvgpr_write_b32 a56, v224
    v_accvgpr_write_b32 a57, v225
    v_accvgpr_write_b32 a58, v226
    v_accvgpr_write_b32 a59, v227
    v_accvgpr_read_b32 v224, a60
    v_accvgpr_read_b32 v225, a61
    v_accvgpr_read_b32 v226, a62
    v_accvgpr_read_b32 v227, a63
    v_mul_f32 v224, v224, v55
    v_mul_f32 v225, v225, v55
    v_mul_f32 v226, v226, v55
    v_mul_f32 v227, v227, v55
    v_accvgpr_write_b32 a60, v224
    v_accvgpr_write_b32 a61, v225
    v_accvgpr_write_b32 a62, v226
    v_accvgpr_write_b32 a63, v227
    v_accvgpr_read_b32 v224, a64
    v_accvgpr_read_b32 v225, a65
    v_accvgpr_read_b32 v226, a66
    v_accvgpr_read_b32 v227, a67
    v_mul_f32 v224, v224, v52
    v_mul_f32 v225, v225, v52
    v_mul_f32 v226, v226, v52
    v_mul_f32 v227, v227, v52
    v_accvgpr_write_b32 a64, v224
    v_accvgpr_write_b32 a65, v225
    v_accvgpr_write_b32 a66, v226
    v_accvgpr_write_b32 a67, v227
    v_accvgpr_read_b32 v224, a68
    v_accvgpr_read_b32 v225, a69
    v_accvgpr_read_b32 v226, a70
    v_accvgpr_read_b32 v227, a71
    v_mul_f32 v224, v224, v53
    v_mul_f32 v225, v225, v53
    v_mul_f32 v226, v226, v53
    v_mul_f32 v227, v227, v53
    v_accvgpr_write_b32 a68, v224
    v_accvgpr_write_b32 a69, v225
    v_accvgpr_write_b32 a70, v226
    v_accvgpr_write_b32 a71, v227
    v_accvgpr_read_b32 v224, a72
    v_accvgpr_read_b32 v225, a73
    v_accvgpr_read_b32 v226, a74
    v_accvgpr_read_b32 v227, a75
    v_mul_f32 v224, v224, v54
    v_mul_f32 v225, v225, v54
    v_mul_f32 v226, v226, v54
    v_mul_f32 v227, v227, v54
    v_accvgpr_write_b32 a72, v224
    v_accvgpr_write_b32 a73, v225
    v_accvgpr_write_b32 a74, v226
    v_accvgpr_write_b32 a75, v227
    v_accvgpr_read_b32 v224, a76
    v_accvgpr_read_b32 v225, a77
    v_accvgpr_read_b32 v226, a78
    v_accvgpr_read_b32 v227, a79
    v_mul_f32 v224, v224, v55
    v_mul_f32 v225, v225, v55
    v_mul_f32 v226, v226, v55
    v_mul_f32 v227, v227, v55
    v_accvgpr_write_b32 a76, v224
    v_accvgpr_write_b32 a77, v225
    v_accvgpr_write_b32 a78, v226
    v_accvgpr_write_b32 a79, v227
    v_accvgpr_read_b32 v224, a80
    v_accvgpr_read_b32 v225, a81
    v_accvgpr_read_b32 v226, a82
    v_accvgpr_read_b32 v227, a83
    v_mul_f32 v224, v224, v52
    v_mul_f32 v225, v225, v52
    v_mul_f32 v226, v226, v52
    v_mul_f32 v227, v227, v52
    v_accvgpr_write_b32 a80, v224
    v_accvgpr_write_b32 a81, v225
    v_accvgpr_write_b32 a82, v226
    v_accvgpr_write_b32 a83, v227
    v_accvgpr_read_b32 v224, a84
    v_accvgpr_read_b32 v225, a85
    v_accvgpr_read_b32 v226, a86
    v_accvgpr_read_b32 v227, a87
    v_mul_f32 v224, v224, v53
    v_mul_f32 v225, v225, v53
    v_mul_f32 v226, v226, v53
    v_mul_f32 v227, v227, v53
    v_accvgpr_write_b32 a84, v224
    v_accvgpr_write_b32 a85, v225
    v_accvgpr_write_b32 a86, v226
    v_accvgpr_write_b32 a87, v227
    v_accvgpr_read_b32 v224, a88
    v_accvgpr_read_b32 v225, a89
    v_accvgpr_read_b32 v226, a90
    v_accvgpr_read_b32 v227, a91
    v_mul_f32 v224, v224, v54
    v_mul_f32 v225, v225, v54
    v_mul_f32 v226, v226, v54
    v_mul_f32 v227, v227, v54
    v_accvgpr_write_b32 a88, v224
    v_accvgpr_write_b32 a89, v225
    v_accvgpr_write_b32 a90, v226
    v_accvgpr_write_b32 a91, v227
    v_accvgpr_read_b32 v224, a92
    v_accvgpr_read_b32 v225, a93
    v_accvgpr_read_b32 v226, a94
    v_accvgpr_read_b32 v227, a95
    v_mul_f32 v224, v224, v55
    v_mul_f32 v225, v225, v55
    v_mul_f32 v226, v226, v55
    v_mul_f32 v227, v227, v55
    v_accvgpr_write_b32 a92, v224
    v_accvgpr_write_b32 a93, v225
    v_accvgpr_write_b32 a94, v226
    v_accvgpr_write_b32 a95, v227
    v_accvgpr_read_b32 v224, a96
    v_accvgpr_read_b32 v225, a97
    v_accvgpr_read_b32 v226, a98
    v_accvgpr_read_b32 v227, a99
    v_mul_f32 v224, v224, v52
    v_mul_f32 v225, v225, v52
    v_mul_f32 v226, v226, v52
    v_mul_f32 v227, v227, v52
    v_accvgpr_write_b32 a96, v224
    v_accvgpr_write_b32 a97, v225
    v_accvgpr_write_b32 a98, v226
    v_accvgpr_write_b32 a99, v227
    v_accvgpr_read_b32 v224, a100
    v_accvgpr_read_b32 v225, a101
    v_accvgpr_read_b32 v226, a102
    v_accvgpr_read_b32 v227, a103
    v_mul_f32 v224, v224, v53
    v_mul_f32 v225, v225, v53
    v_mul_f32 v226, v226, v53
    v_mul_f32 v227, v227, v53
    v_accvgpr_write_b32 a100, v224
    v_accvgpr_write_b32 a101, v225
    v_accvgpr_write_b32 a102, v226
    v_accvgpr_write_b32 a103, v227
    v_accvgpr_read_b32 v224, a104
    v_accvgpr_read_b32 v225, a105
    v_accvgpr_read_b32 v226, a106
    v_accvgpr_read_b32 v227, a107
    v_mul_f32 v224, v224, v54
    v_mul_f32 v225, v225, v54
    v_mul_f32 v226, v226, v54
    v_mul_f32 v227, v227, v54
    v_accvgpr_write_b32 a104, v224
    v_accvgpr_write_b32 a105, v225
    v_accvgpr_write_b32 a106, v226
    v_accvgpr_write_b32 a107, v227
    v_accvgpr_read_b32 v224, a108
    v_accvgpr_read_b32 v225, a109
    v_accvgpr_read_b32 v226, a110
    v_accvgpr_read_b32 v227, a111
    v_mul_f32 v224, v224, v55
    v_mul_f32 v225, v225, v55
    v_mul_f32 v226, v226, v55
    v_mul_f32 v227, v227, v55
    v_accvgpr_write_b32 a108, v224
    v_accvgpr_write_b32 a109, v225
    v_accvgpr_write_b32 a110, v226
    v_accvgpr_write_b32 a111, v227
    v_accvgpr_read_b32 v224, a112
    v_accvgpr_read_b32 v225, a113
    v_accvgpr_read_b32 v226, a114
    v_accvgpr_read_b32 v227, a115
    v_mul_f32 v224, v224, v52
    v_mul_f32 v225, v225, v52
    v_mul_f32 v226, v226, v52
    v_mul_f32 v227, v227, v52
    v_accvgpr_write_b32 a112, v224
    v_accvgpr_write_b32 a113, v225
    v_accvgpr_write_b32 a114, v226
    v_accvgpr_write_b32 a115, v227
    v_accvgpr_read_b32 v224, a116
    v_accvgpr_read_b32 v225, a117
    v_accvgpr_read_b32 v226, a118
    v_accvgpr_read_b32 v227, a119
    v_mul_f32 v224, v224, v53
    v_mul_f32 v225, v225, v53
    v_mul_f32 v226, v226, v53
    v_mul_f32 v227, v227, v53
    v_accvgpr_write_b32 a116, v224
    v_accvgpr_write_b32 a117, v225
    v_accvgpr_write_b32 a118, v226
    v_accvgpr_write_b32 a119, v227
    v_accvgpr_read_b32 v224, a120
    v_accvgpr_read_b32 v225, a121
    v_accvgpr_read_b32 v226, a122
    v_accvgpr_read_b32 v227, a123
    v_mul_f32 v224, v224, v54
    v_mul_f32 v225, v225, v54
    v_mul_f32 v226, v226, v54
    v_mul_f32 v227, v227, v54
    v_accvgpr_write_b32 a120, v224
    v_accvgpr_write_b32 a121, v225
    v_accvgpr_write_b32 a122, v226
    v_accvgpr_write_b32 a123, v227
    v_accvgpr_read_b32 v224, a124
    v_accvgpr_read_b32 v225, a125
    v_accvgpr_read_b32 v226, a126
    v_accvgpr_read_b32 v227, a127
    v_mul_f32 v224, v224, v55
    v_mul_f32 v225, v225, v55
    v_mul_f32 v226, v226, v55
    v_mul_f32 v227, v227, v55
    v_accvgpr_write_b32 a124, v224
    v_accvgpr_write_b32 a125, v225
    v_accvgpr_write_b32 a126, v226
    v_accvgpr_write_b32 a127, v227
    v_exp_f32 v232, v128
    v_exp_f32 v233, v129
    v_exp_f32 v234, v130
    v_exp_f32 v235, v131
    s_nop 0
    v_cvt_pk_bf16_f32 v192, v232, v233
    v_cvt_pk_bf16_f32 v193, v234, v235
    v_exp_f32 v232, v144
    v_exp_f32 v233, v145
    v_exp_f32 v234, v146
    v_exp_f32 v235, v147
    s_nop 0
    v_cvt_pk_bf16_f32 v194, v232, v233
    v_cvt_pk_bf16_f32 v195, v234, v235
    v_exp_f32 v232, v132
    v_exp_f32 v233, v133
    v_exp_f32 v234, v134
    v_exp_f32 v235, v135
    s_nop 0
    v_cvt_pk_bf16_f32 v196, v232, v233
    v_cvt_pk_bf16_f32 v197, v234, v235
    v_exp_f32 v232, v148
    v_exp_f32 v233, v149
    v_exp_f32 v234, v150
    v_exp_f32 v235, v151
    s_nop 0
    v_cvt_pk_bf16_f32 v198, v232, v233
    v_cvt_pk_bf16_f32 v199, v234, v235
    v_exp_f32 v232, v136
    v_exp_f32 v233, v137
    v_exp_f32 v234, v138
    v_exp_f32 v235, v139
    s_nop 0
    v_cvt_pk_bf16_f32 v200, v232, v233
    v_cvt_pk_bf16_f32 v201, v234, v235
    v_exp_f32 v232, v152
    v_exp_f32 v233, v153
    v_exp_f32 v234, v154
    v_exp_f32 v235, v155
    s_nop 0
    v_cvt_pk_bf16_f32 v202, v232, v233
    v_cvt_pk_bf16_f32 v203, v234, v235
    v_exp_f32 v232, v140
    v_exp_f32 v233, v141
    v_exp_f32 v234, v142
    v_exp_f32 v235, v143
    s_nop 0
    v_cvt_pk_bf16_f32 v204, v232, v233
    v_cvt_pk_bf16_f32 v205, v234, v235
    v_exp_f32 v232, v156
    v_exp_f32 v233, v157
    v_exp_f32 v234, v158
    v_exp_f32 v235, v159
    s_nop 0
    v_cvt_pk_bf16_f32 v206, v232, v233
    v_cvt_pk_bf16_f32 v207, v234, v235
    s_nop 3
    s_setpc_b64 s[40:41]
k2_rare_159:
    s_nop 7
    v_max_f32 v52, v160, v161
    v_max3_f32 v52, v52, v162, v163
    v_max3_f32 v52, v52, v176, v177
    v_max3_f32 v52, v52, v178, v179
    v_max_f32 v53, v164, v165
    v_max3_f32 v53, v53, v166, v167
    v_max3_f32 v53, v53, v180, v181
    v_max3_f32 v53, v53, v182, v183
    v_max_f32 v54, v168, v169
    v_max3_f32 v54, v54, v170, v171
    v_max3_f32 v54, v54, v184, v185
    v_max3_f32 v54, v54, v186, v187
    v_max_f32 v55, v172, v173
    v_max3_f32 v55, v55, v174, v175
    v_max3_f32 v55, v55, v188, v189
    v_max3_f32 v55, v55, v190, v191
    v_mov_b32 v224, v52
    v_mov_b32 v225, v53
    v_mov_b32 v226, v54
    v_mov_b32 v227, v55
    s_nop 1
    v_permlane16_swap_b32 v52, v224
    v_permlane16_swap_b32 v53, v225
    v_permlane16_swap_b32 v54, v226
    v_permlane16_swap_b32 v55, v227
    s_nop 1
    v_max_f32 v52, v52, v224
    v_max_f32 v53, v53, v225
    v_max_f32 v54, v54, v226
    v_max_f32 v55, v55, v227
    v_mov_b32 v224, v52
    v_mov_b32 v225, v53
    v_mov_b32 v226, v54
    v_mov_b32 v227, v55
    s_nop 1
    v_permlane32_swap_b32 v52, v224
    v_permlane32_swap_b32 v53, v225
    v_permlane32_swap_b32 v54, v226
    v_permlane32_swap_b32 v55, v227
    s_nop 1
    v_max_f32 v52, v52, v224
    v_max_f32 v53, v53, v225
    v_max_f32 v54, v54, v226
    v_max_f32 v55, v55, v227
    v_add_f32 v52, 0x41400000, v52
    v_max_f32 v52, 0, v52
    v_add_f32 v53, 0x41400000, v53
    v_max_f32 v53, 0, v53
    v_add_f32 v54, 0x41400000, v54
    v_max_f32 v54, 0, v54
    v_add_f32 v55, 0x41400000, v55
    v_max_f32 v55, 0, v55
    v_sub_f32 v160, v160, v52
    v_sub_f32 v161, v161, v52
    v_sub_f32 v162, v162, v52
    v_sub_f32 v163, v163, v52
    v_sub_f32 v164, v164, v53
    v_sub_f32 v165, v165, v53
    v_sub_f32 v166, v166, v53
    v_sub_f32 v167, v167, v53
    v_sub_f32 v168, v168, v54
    v_sub_f32 v169, v169, v54
    v_sub_f32 v170, v170, v54
    v_sub_f32 v171, v171, v54
    v_sub_f32 v172, v172, v55
    v_sub_f32 v173, v173, v55
    v_sub_f32 v174, v174, v55
    v_sub_f32 v175, v175, v55
    v_sub_f32 v176, v176, v52
    v_sub_f32 v177, v177, v52
    v_sub_f32 v178, v178, v52
    v_sub_f32 v179, v179, v52
    v_sub_f32 v180, v180, v53
    v_sub_f32 v181, v181, v53
    v_sub_f32 v182, v182, v53
    v_sub_f32 v183, v183, v53
    v_sub_f32 v184, v184, v54
    v_sub_f32 v185, v185, v54
    v_sub_f32 v186, v186, v54
    v_sub_f32 v187, v187, v54
    v_sub_f32 v188, v188, v55
    v_sub_f32 v189, v189, v55
    v_sub_f32 v190, v190, v55
    v_sub_f32 v191, v191, v55
    v_sub_f32 v128, v128, v52
    v_sub_f32 v16, v16, v52
    v_sub_f32 v129, v129, v52
    v_sub_f32 v17, v17, v52
    v_sub_f32 v130, v130, v52
    v_sub_f32 v18, v18, v52
    v_sub_f32 v131, v131, v52
    v_sub_f32 v19, v19, v52
    v_sub_f32 v132, v132, v53
    v_sub_f32 v20, v20, v53
    v_sub_f32 v133, v133, v53
    v_sub_f32 v21, v21, v53
    v_sub_f32 v134, v134, v53
    v_sub_f32 v22, v22, v53
    v_sub_f32 v135, v135, v53
    v_sub_f32 v23, v23, v53
    v_sub_f32 v136, v136, v54
    v_sub_f32 v24, v24, v54
    v_sub_f32 v137, v137, v54
    v_sub_f32 v25, v25, v54
    v_sub_f32 v138, v138, v54
    v_sub_f32 v26, v26, v54
    v_sub_f32 v139, v139, v54
    v_sub_f32 v27, v27, v54
    v_sub_f32 v140, v140, v55
    v_sub_f32 v28, v28, v55
    v_sub_f32 v141, v141, v55
    v_sub_f32 v29, v29, v55
    v_sub_f32 v142, v142, v55
    v_sub_f32 v30, v30, v55
    v_sub_f32 v143, v143, v55
    v_sub_f32 v31, v31, v55
    v_sub_f32 v144, v144, v52
    v_sub_f32 v32, v32, v52
    v_sub_f32 v145, v145, v52
    v_sub_f32 v33, v33, v52
    v_sub_f32 v146, v146, v52
    v_sub_f32 v34, v34, v52
    v_sub_f32 v147, v147, v52
    v_sub_f32 v35, v35, v52
    v_sub_f32 v148, v148, v53
    v_sub_f32 v36, v36, v53
    v_sub_f32 v149, v149, v53
    v_sub_f32 v37, v37, v53
    v_sub_f32 v150, v150, v53
    v_sub_f32 v38, v38, v53
    v_sub_f32 v151, v151, v53
    v_sub_f32 v39, v39, v53
    v_sub_f32 v152, v152, v54
    v_sub_f32 v40, v40, v54
    v_sub_f32 v153, v153, v54
    v_sub_f32 v41, v41, v54
    v_sub_f32 v154, v154, v54
    v_sub_f32 v42, v42, v54
    v_sub_f32 v155, v155, v54
    v_sub_f32 v43, v43, v54
    v_sub_f32 v156, v156, v55
    v_sub_f32 v44, v44, v55
    v_sub_f32 v157, v157, v55
    v_sub_f32 v45, v45, v55
    v_sub_f32 v158, v158, v55
    v_sub_f32 v46, v46, v55
    v_sub_f32 v159, v159, v55
    v_sub_f32 v47, v47, v55
    v_sub_f32 v8, v8, v52
    v_exp_f32 v52, -v52
    v_sub_f32 v9, v9, v53
    v_exp_f32 v53, -v53
    v_sub_f32 v10, v10, v54
    v_exp_f32 v54, -v54
    v_sub_f32 v11, v11, v55
    v_exp_f32 v55, -v55
    s_nop 0
    v_mul_f32 v12, v12, v52
    v_mul_f32 v48, v48, v53
    v_mul_f32 v248, v248, v54
    v_mul_f32 v252, v252, v55
    v_accvgpr_read_b32 v224, a0
    v_accvgpr_read_b32 v225, a1
    v_accvgpr_read_b32 v226, a2
    v_accvgpr_read_b32 v227, a3
    v_mul_f32 v224, v224, v52
    v_mul_f32 v225, v225, v52
    v_mul_f32 v226, v226, v52
    v_mul_f32 v227, v227, v52
    v_accvgpr_write_b32 a0, v224
    v_accvgpr_write_b32 a1, v225
    v_accvgpr_write_b32 a2, v226
    v_accvgpr_write_b32 a3, v227
    v_accvgpr_read_b32 v224, a4
    v_accvgpr_read_b32 v225, a5
    v_accvgpr_read_b32 v226, a6
    v_accvgpr_read_b32 v227, a7
    v_mul_f32 v224, v224, v53
    v_mul_f32 v225, v225, v53
    v_mul_f32 v226, v226, v53
    v_mul_f32 v227, v227, v53
    v_accvgpr_write_b32 a4, v224
    v_accvgpr_write_b32 a5, v225
    v_accvgpr_write_b32 a6, v226
    v_accvgpr_write_b32 a7, v227
    v_accvgpr_read_b32 v224, a8
    v_accvgpr_read_b32 v225, a9
    v_accvgpr_read_b32 v226, a10
    v_accvgpr_read_b32 v227, a11
    v_mul_f32 v224, v224, v54
    v_mul_f32 v225, v225, v54
    v_mul_f32 v226, v226, v54
    v_mul_f32 v227, v227, v54
    v_accvgpr_write_b32 a8, v224
    v_accvgpr_write_b32 a9, v225
    v_accvgpr_write_b32 a10, v226
    v_accvgpr_write_b32 a11, v227
    v_accvgpr_read_b32 v224, a12
    v_accvgpr_read_b32 v225, a13
    v_accvgpr_read_b32 v226, a14
    v_accvgpr_read_b32 v227, a15
    v_mul_f32 v224, v224, v55
    v_mul_f32 v225, v225, v55
    v_mul_f32 v226, v226, v55
    v_mul_f32 v227, v227, v55
    v_accvgpr_write_b32 a12, v224
    v_accvgpr_write_b32 a13, v225
    v_accvgpr_write_b32 a14, v226
    v_accvgpr_write_b32 a15, v227
    v_accvgpr_read_b32 v224, a16
    v_accvgpr_read_b32 v225, a17
    v_accvgpr_read_b32 v226, a18
    v_accvgpr_read_b32 v227, a19
    v_mul_f32 v224, v224, v52
    v_mul_f32 v225, v225, v52
    v_mul_f32 v226, v226, v52
    v_mul_f32 v227, v227, v52
    v_accvgpr_write_b32 a16, v224
    v_accvgpr_write_b32 a17, v225
    v_accvgpr_write_b32 a18, v226
    v_accvgpr_write_b32 a19, v227
    v_accvgpr_read_b32 v224, a20
    v_accvgpr_read_b32 v225, a21
    v_accvgpr_read_b32 v226, a22
    v_accvgpr_read_b32 v227, a23
    v_mul_f32 v224, v224, v53
    v_mul_f32 v225, v225, v53
    v_mul_f32 v226, v226, v53
    v_mul_f32 v227, v227, v53
    v_accvgpr_write_b32 a20, v224
    v_accvgpr_write_b32 a21, v225
    v_accvgpr_write_b32 a22, v226
    v_accvgpr_write_b32 a23, v227
    v_accvgpr_read_b32 v224, a24
    v_accvgpr_read_b32 v225, a25
    v_accvgpr_read_b32 v226, a26
    v_accvgpr_read_b32 v227, a27
    v_mul_f32 v224, v224, v54
    v_mul_f32 v225, v225, v54
    v_mul_f32 v226, v226, v54
    v_mul_f32 v227, v227, v54
    v_accvgpr_write_b32 a24, v224
    v_accvgpr_write_b32 a25, v225
    v_accvgpr_write_b32 a26, v226
    v_accvgpr_write_b32 a27, v227
    v_accvgpr_read_b32 v224, a28
    v_accvgpr_read_b32 v225, a29
    v_accvgpr_read_b32 v226, a30
    v_accvgpr_read_b32 v227, a31
    v_mul_f32 v224, v224, v55
    v_mul_f32 v225, v225, v55
    v_mul_f32 v226, v226, v55
    v_mul_f32 v227, v227, v55
    v_accvgpr_write_b32 a28, v224
    v_accvgpr_write_b32 a29, v225
    v_accvgpr_write_b32 a30, v226
    v_accvgpr_write_b32 a31, v227
    v_accvgpr_read_b32 v224, a32
    v_accvgpr_read_b32 v225, a33
    v_accvgpr_read_b32 v226, a34
    v_accvgpr_read_b32 v227, a35
    v_mul_f32 v224, v224, v52
    v_mul_f32 v225, v225, v52
    v_mul_f32 v226, v226, v52
    v_mul_f32 v227, v227, v52
    v_accvgpr_write_b32 a32, v224
    v_accvgpr_write_b32 a33, v225
    v_accvgpr_write_b32 a34, v226
    v_accvgpr_write_b32 a35, v227
    v_accvgpr_read_b32 v224, a36
    v_accvgpr_read_b32 v225, a37
    v_accvgpr_read_b32 v226, a38
    v_accvgpr_read_b32 v227, a39
    v_mul_f32 v224, v224, v53
    v_mul_f32 v225, v225, v53
    v_mul_f32 v226, v226, v53
    v_mul_f32 v227, v227, v53
    v_accvgpr_write_b32 a36, v224
    v_accvgpr_write_b32 a37, v225
    v_accvgpr_write_b32 a38, v226
    v_accvgpr_write_b32 a39, v227
    v_accvgpr_read_b32 v224, a40
    v_accvgpr_read_b32 v225, a41
    v_accvgpr_read_b32 v226, a42
    v_accvgpr_read_b32 v227, a43
    v_mul_f32 v224, v224, v54
    v_mul_f32 v225, v225, v54
    v_mul_f32 v226, v226, v54
    v_mul_f32 v227, v227, v54
    v_accvgpr_write_b32 a40, v224
    v_accvgpr_write_b32 a41, v225
    v_accvgpr_write_b32 a42, v226
    v_accvgpr_write_b32 a43, v227
    v_accvgpr_read_b32 v224, a44
    v_accvgpr_read_b32 v225, a45
    v_accvgpr_read_b32 v226, a46
    v_accvgpr_read_b32 v227, a47
    v_mul_f32 v224, v224, v55
    v_mul_f32 v225, v225, v55
    v_mul_f32 v226, v226, v55
    v_mul_f32 v227, v227, v55
    v_accvgpr_write_b32 a44, v224
    v_accvgpr_write_b32 a45, v225
    v_accvgpr_write_b32 a46, v226
    v_accvgpr_write_b32 a47, v227
    v_accvgpr_read_b32 v224, a48
    v_accvgpr_read_b32 v225, a49
    v_accvgpr_read_b32 v226, a50
    v_accvgpr_read_b32 v227, a51
    v_mul_f32 v224, v224, v52
    v_mul_f32 v225, v225, v52
    v_mul_f32 v226, v226, v52
    v_mul_f32 v227, v227, v52
    v_accvgpr_write_b32 a48, v224
    v_accvgpr_write_b32 a49, v225
    v_accvgpr_write_b32 a50, v226
    v_accvgpr_write_b32 a51, v227
    v_accvgpr_read_b32 v224, a52
    v_accvgpr_read_b32 v225, a53
    v_accvgpr_read_b32 v226, a54
    v_accvgpr_read_b32 v227, a55
    v_mul_f32 v224, v224, v53
    v_mul_f32 v225, v225, v53
    v_mul_f32 v226, v226, v53
    v_mul_f32 v227, v227, v53
    v_accvgpr_write_b32 a52, v224
    v_accvgpr_write_b32 a53, v225
    v_accvgpr_write_b32 a54, v226
    v_accvgpr_write_b32 a55, v227
    v_accvgpr_read_b32 v224, a56
    v_accvgpr_read_b32 v225, a57
    v_accvgpr_read_b32 v226, a58
    v_accvgpr_read_b32 v227, a59
    v_mul_f32 v224, v224, v54
    v_mul_f32 v225, v225, v54
    v_mul_f32 v226, v226, v54
    v_mul_f32 v227, v227, v54
    v_accvgpr_write_b32 a56, v224
    v_accvgpr_write_b32 a57, v225
    v_accvgpr_write_b32 a58, v226
    v_accvgpr_write_b32 a59, v227
    v_accvgpr_read_b32 v224, a60
    v_accvgpr_read_b32 v225, a61
    v_accvgpr_read_b32 v226, a62
    v_accvgpr_read_b32 v227, a63
    v_mul_f32 v224, v224, v55
    v_mul_f32 v225, v225, v55
    v_mul_f32 v226, v226, v55
    v_mul_f32 v227, v227, v55
    v_accvgpr_write_b32 a60, v224
    v_accvgpr_write_b32 a61, v225
    v_accvgpr_write_b32 a62, v226
    v_accvgpr_write_b32 a63, v227
    v_accvgpr_read_b32 v224, a64
    v_accvgpr_read_b32 v225, a65
    v_accvgpr_read_b32 v226, a66
    v_accvgpr_read_b32 v227, a67
    v_mul_f32 v224, v224, v52
    v_mul_f32 v225, v225, v52
    v_mul_f32 v226, v226, v52
    v_mul_f32 v227, v227, v52
    v_accvgpr_write_b32 a64, v224
    v_accvgpr_write_b32 a65, v225
    v_accvgpr_write_b32 a66, v226
    v_accvgpr_write_b32 a67, v227
    v_accvgpr_read_b32 v224, a68
    v_accvgpr_read_b32 v225, a69
    v_accvgpr_read_b32 v226, a70
    v_accvgpr_read_b32 v227, a71
    v_mul_f32 v224, v224, v53
    v_mul_f32 v225, v225, v53
    v_mul_f32 v226, v226, v53
    v_mul_f32 v227, v227, v53
    v_accvgpr_write_b32 a68, v224
    v_accvgpr_write_b32 a69, v225
    v_accvgpr_write_b32 a70, v226
    v_accvgpr_write_b32 a71, v227
    v_accvgpr_read_b32 v224, a72
    v_accvgpr_read_b32 v225, a73
    v_accvgpr_read_b32 v226, a74
    v_accvgpr_read_b32 v227, a75
    v_mul_f32 v224, v224, v54
    v_mul_f32 v225, v225, v54
    v_mul_f32 v226, v226, v54
    v_mul_f32 v227, v227, v54
    v_accvgpr_write_b32 a72, v224
    v_accvgpr_write_b32 a73, v225
    v_accvgpr_write_b32 a74, v226
    v_accvgpr_write_b32 a75, v227
    v_accvgpr_read_b32 v224, a76
    v_accvgpr_read_b32 v225, a77
    v_accvgpr_read_b32 v226, a78
    v_accvgpr_read_b32 v227, a79
    v_mul_f32 v224, v224, v55
    v_mul_f32 v225, v225, v55
    v_mul_f32 v226, v226, v55
    v_mul_f32 v227, v227, v55
    v_accvgpr_write_b32 a76, v224
    v_accvgpr_write_b32 a77, v225
    v_accvgpr_write_b32 a78, v226
    v_accvgpr_write_b32 a79, v227
    v_accvgpr_read_b32 v224, a80
    v_accvgpr_read_b32 v225, a81
    v_accvgpr_read_b32 v226, a82
    v_accvgpr_read_b32 v227, a83
    v_mul_f32 v224, v224, v52
    v_mul_f32 v225, v225, v52
    v_mul_f32 v226, v226, v52
    v_mul_f32 v227, v227, v52
    v_accvgpr_write_b32 a80, v224
    v_accvgpr_write_b32 a81, v225
    v_accvgpr_write_b32 a82, v226
    v_accvgpr_write_b32 a83, v227
    v_accvgpr_read_b32 v224, a84
    v_accvgpr_read_b32 v225, a85
    v_accvgpr_read_b32 v226, a86
    v_accvgpr_read_b32 v227, a87
    v_mul_f32 v224, v224, v53
    v_mul_f32 v225, v225, v53
    v_mul_f32 v226, v226, v53
    v_mul_f32 v227, v227, v53
    v_accvgpr_write_b32 a84, v224
    v_accvgpr_write_b32 a85, v225
    v_accvgpr_write_b32 a86, v226
    v_accvgpr_write_b32 a87, v227
    v_accvgpr_read_b32 v224, a88
    v_accvgpr_read_b32 v225, a89
    v_accvgpr_read_b32 v226, a90
    v_accvgpr_read_b32 v227, a91
    v_mul_f32 v224, v224, v54
    v_mul_f32 v225, v225, v54
    v_mul_f32 v226, v226, v54
    v_mul_f32 v227, v227, v54
    v_accvgpr_write_b32 a88, v224
    v_accvgpr_write_b32 a89, v225
    v_accvgpr_write_b32 a90, v226
    v_accvgpr_write_b32 a91, v227
    v_accvgpr_read_b32 v224, a92
    v_accvgpr_read_b32 v225, a93
    v_accvgpr_read_b32 v226, a94
    v_accvgpr_read_b32 v227, a95
    v_mul_f32 v224, v224, v55
    v_mul_f32 v225, v225, v55
    v_mul_f32 v226, v226, v55
    v_mul_f32 v227, v227, v55
    v_accvgpr_write_b32 a92, v224
    v_accvgpr_write_b32 a93, v225
    v_accvgpr_write_b32 a94, v226
    v_accvgpr_write_b32 a95, v227
    v_accvgpr_read_b32 v224, a96
    v_accvgpr_read_b32 v225, a97
    v_accvgpr_read_b32 v226, a98
    v_accvgpr_read_b32 v227, a99
    v_mul_f32 v224, v224, v52
    v_mul_f32 v225, v225, v52
    v_mul_f32 v226, v226, v52
    v_mul_f32 v227, v227, v52
    v_accvgpr_write_b32 a96, v224
    v_accvgpr_write_b32 a97, v225
    v_accvgpr_write_b32 a98, v226
    v_accvgpr_write_b32 a99, v227
    v_accvgpr_read_b32 v224, a100
    v_accvgpr_read_b32 v225, a101
    v_accvgpr_read_b32 v226, a102
    v_accvgpr_read_b32 v227, a103
    v_mul_f32 v224, v224, v53
    v_mul_f32 v225, v225, v53
    v_mul_f32 v226, v226, v53
    v_mul_f32 v227, v227, v53
    v_accvgpr_write_b32 a100, v224
    v_accvgpr_write_b32 a101, v225
    v_accvgpr_write_b32 a102, v226
    v_accvgpr_write_b32 a103, v227
    v_accvgpr_read_b32 v224, a104
    v_accvgpr_read_b32 v225, a105
    v_accvgpr_read_b32 v226, a106
    v_accvgpr_read_b32 v227, a107
    v_mul_f32 v224, v224, v54
    v_mul_f32 v225, v225, v54
    v_mul_f32 v226, v226, v54
    v_mul_f32 v227, v227, v54
    v_accvgpr_write_b32 a104, v224
    v_accvgpr_write_b32 a105, v225
    v_accvgpr_write_b32 a106, v226
    v_accvgpr_write_b32 a107, v227
    v_accvgpr_read_b32 v224, a108
    v_accvgpr_read_b32 v225, a109
    v_accvgpr_read_b32 v226, a110
    v_accvgpr_read_b32 v227, a111
    v_mul_f32 v224, v224, v55
    v_mul_f32 v225, v225, v55
    v_mul_f32 v226, v226, v55
    v_mul_f32 v227, v227, v55
    v_accvgpr_write_b32 a108, v224
    v_accvgpr_write_b32 a109, v225
    v_accvgpr_write_b32 a110, v226
    v_accvgpr_write_b32 a111, v227
    v_accvgpr_read_b32 v224, a112
    v_accvgpr_read_b32 v225, a113
    v_accvgpr_read_b32 v226, a114
    v_accvgpr_read_b32 v227, a115
    v_mul_f32 v224, v224, v52
    v_mul_f32 v225, v225, v52
    v_mul_f32 v226, v226, v52
    v_mul_f32 v227, v227, v52
    v_accvgpr_write_b32 a112, v224
    v_accvgpr_write_b32 a113, v225
    v_accvgpr_write_b32 a114, v226
    v_accvgpr_write_b32 a115, v227
    v_accvgpr_read_b32 v224, a116
    v_accvgpr_read_b32 v225, a117
    v_accvgpr_read_b32 v226, a118
    v_accvgpr_read_b32 v227, a119
    v_mul_f32 v224, v224, v53
    v_mul_f32 v225, v225, v53
    v_mul_f32 v226, v226, v53
    v_mul_f32 v227, v227, v53
    v_accvgpr_write_b32 a116, v224
    v_accvgpr_write_b32 a117, v225
    v_accvgpr_write_b32 a118, v226
    v_accvgpr_write_b32 a119, v227
    v_accvgpr_read_b32 v224, a120
    v_accvgpr_read_b32 v225, a121
    v_accvgpr_read_b32 v226, a122
    v_accvgpr_read_b32 v227, a123
    v_mul_f32 v224, v224, v54
    v_mul_f32 v225, v225, v54
    v_mul_f32 v226, v226, v54
    v_mul_f32 v227, v227, v54
    v_accvgpr_write_b32 a120, v224
    v_accvgpr_write_b32 a121, v225
    v_accvgpr_write_b32 a122, v226
    v_accvgpr_write_b32 a123, v227
    v_accvgpr_read_b32 v224, a124
    v_accvgpr_read_b32 v225, a125
    v_accvgpr_read_b32 v226, a126
    v_accvgpr_read_b32 v227, a127
    v_mul_f32 v224, v224, v55
    v_mul_f32 v225, v225, v55
    v_mul_f32 v226, v226, v55
    v_mul_f32 v227, v227, v55
    v_accvgpr_write_b32 a124, v224
    v_accvgpr_write_b32 a125, v225
    v_accvgpr_write_b32 a126, v226
    v_accvgpr_write_b32 a127, v227
    v_exp_f32 v232, v160
    v_exp_f32 v233, v161
    v_exp_f32 v234, v162
    v_exp_f32 v235, v163
    s_nop 0
    v_cvt_pk_bf16_f32 v208, v232, v233
    v_cvt_pk_bf16_f32 v209, v234, v235
    v_exp_f32 v232, v176
    v_exp_f32 v233, v177
    v_exp_f32 v234, v178
    v_exp_f32 v235, v179
    s_nop 0
    v_cvt_pk_bf16_f32 v210, v232, v233
    v_cvt_pk_bf16_f32 v211, v234, v235
    v_exp_f32 v232, v164
    v_exp_f32 v233, v165
    v_exp_f32 v234, v166
    v_exp_f32 v235, v167
    s_nop 0
    v_cvt_pk_bf16_f32 v212, v232, v233
    v_cvt_pk_bf16_f32 v213, v234, v235
    v_exp_f32 v232, v180
    v_exp_f32 v233, v181
    v_exp_f32 v234, v182
    v_exp_f32 v235, v183
    s_nop 0
    v_cvt_pk_bf16_f32 v214, v232, v233
    v_cvt_pk_bf16_f32 v215, v234, v235
    v_exp_f32 v232, v168
    v_exp_f32 v233, v169
    v_exp_f32 v234, v170
    v_exp_f32 v235, v171
    s_nop 0
    v_cvt_pk_bf16_f32 v216, v232, v233
    v_cvt_pk_bf16_f32 v217, v234, v235
    v_exp_f32 v232, v184
    v_exp_f32 v233, v185
    v_exp_f32 v234, v186
    v_exp_f32 v235, v187
    s_nop 0
    v_cvt_pk_bf16_f32 v218, v232, v233
    v_cvt_pk_bf16_f32 v219, v234, v235
    v_exp_f32 v232, v172
    v_exp_f32 v233, v173
    v_exp_f32 v234, v174
    v_exp_f32 v235, v175
    s_nop 0
    v_cvt_pk_bf16_f32 v220, v232, v233
    v_cvt_pk_bf16_f32 v221, v234, v235
    v_exp_f32 v232, v188
    v_exp_f32 v233, v189
    v_exp_f32 v234, v190
    v_exp_f32 v235, v191
    s_nop 0
    v_cvt_pk_bf16_f32 v222, v232, v233
    v_cvt_pk_bf16_f32 v223, v234, v235
    s_nop 3
    s_setpc_b64 s[40:41]
k2_rare_164:
    s_nop 7
    v_max_f32 v53, v132, v133
    v_max3_f32 v53, v53, v134, v135
    v_max3_f32 v53, v53, v148, v149
    v_max3_f32 v53, v53, v150, v151
    v_max_f32 v54, v136, v137
    v_max3_f32 v54, v54, v138, v139
    v_max3_f32 v54, v54, v152, v153
    v_max3_f32 v54, v54, v154, v155
    v_max_f32 v55, v140, v141
    v_max3_f32 v55, v55, v142, v143
    v_max3_f32 v55, v55, v156, v157
    v_max3_f32 v55, v55, v158, v159
    v_mov_b32 v225, v53
    v_mov_b32 v226, v54
    v_mov_b32 v227, v55
    s_nop 1
    v_permlane16_swap_b32 v53, v225
    v_permlane16_swap_b32 v54, v226
    v_permlane16_swap_b32 v55, v227
    s_nop 1
    v_max_f32 v53, v53, v225
    v_max_f32 v54, v54, v226
    v_max_f32 v55, v55, v227
    v_mov_b32 v225, v53
    v_mov_b32 v226, v54
    v_mov_b32 v227, v55
    s_nop 1
    v_permlane32_swap_b32 v53, v225
    v_permlane32_swap_b32 v54, v226
    v_permlane32_swap_b32 v55, v227
    s_nop 1
    v_max_f32 v53, v53, v225
    v_max_f32 v54, v54, v226
    v_max_f32 v55, v55, v227
    v_add_f32 v53, 0x41400000, v53
    v_max_f32 v53, 0, v53
    v_add_f32 v54, 0x41400000, v54
    v_max_f32 v54, 0, v54
    v_add_f32 v55, 0x41400000, v55
    v_max_f32 v55, 0, v55
    v_sub_f32 v132, v132, v53
    v_sub_f32 v133, v133, v53
    v_sub_f32 v134, v134, v53
    v_sub_f32 v135, v135, v53
    v_sub_f32 v136, v136, v54
    v_sub_f32 v137, v137, v54
    v_sub_f32 v138, v138, v54
    v_sub_f32 v139, v139, v54
    v_sub_f32 v140, v140, v55
    v_sub_f32 v141, v141, v55
    v_sub_f32 v142, v142, v55
    v_sub_f32 v143, v143, v55
    v_sub_f32 v148, v148, v53
    v_sub_f32 v149, v149, v53
    v_sub_f32 v150, v150, v53
    v_sub_f32 v151, v151, v53
    v_sub_f32 v152, v152, v54
    v_sub_f32 v153, v153, v54
    v_sub_f32 v154, v154, v54
    v_sub_f32 v155, v155, v54
    v_sub_f32 v156, v156, v55
    v_sub_f32 v157, v157, v55
    v_sub_f32 v158, v158, v55
    v_sub_f32 v159, v159, v55
    v_sub_f32 v164, v164, v53
    v_sub_f32 v20, v20, v53
    v_sub_f32 v165, v165, v53
    v_sub_f32 v21, v21, v53
    v_sub_f32 v166, v166, v53
    v_sub_f32 v22, v22, v53
    v_sub_f32 v167, v167, v53
    v_sub_f32 v23, v23, v53
    v_sub_f32 v168, v168, v54
    v_sub_f32 v24, v24, v54
    v_sub_f32 v169, v169, v54
    v_sub_f32 v25, v25, v54
    v_sub_f32 v170, v170, v54
    v_sub_f32 v26, v26, v54
    v_sub_f32 v171, v171, v54
    v_sub_f32 v27, v27, v54
    v_sub_f32 v172, v172, v55
    v_sub_f32 v28, v28, v55
    v_sub_f32 v173, v173, v55
    v_sub_f32 v29, v29, v55
    v_sub_f32 v174, v174, v55
    v_sub_f32 v30, v30, v55
    v_sub_f32 v175, v175, v55
    v_sub_f32 v31, v31, v55
    v_sub_f32 v180, v180, v53
    v_sub_f32 v36, v36, v53
    v_sub_f32 v181, v181, v53
    v_sub_f32 v37, v37, v53
    v_sub_f32 v182, v182, v53
    v_sub_f32 v38, v38, v53
    v_sub_f32 v183, v183, v53
    v_sub_f32 v39, v39, v53
    v_sub_f32 v184, v184, v54
    v_sub_f32 v40, v40, v54
    v_sub_f32 v185, v185, v54
    v_sub_f32 v41, v41, v54
    v_sub_f32 v186, v186, v54
    v_sub_f32 v42, v42, v54
    v_sub_f32 v187, v187, v54
    v_sub_f32 v43, v43, v54
    v_sub_f32 v188, v188, v55
    v_sub_f32 v44, v44, v55
    v_sub_f32 v189, v189, v55
    v_sub_f32 v45, v45, v55
    v_sub_f32 v190, v190, v55
    v_sub_f32 v46, v46, v55
    v_sub_f32 v191, v191, v55
    v_sub_f32 v47, v47, v55
    v_sub_f32 v9, v9, v53
    v_exp_f32 v53, -v53
    v_sub_f32 v10, v10, v54
    v_exp_f32 v54, -v54
    v_sub_f32 v11, v11, v55
    v_exp_f32 v55, -v55
    s_nop 0
    v_mul_f32 v48, v48, v53
    v_mul_f32 v248, v248, v54
    v_mul_f32 v252, v252, v55
    v_accvgpr_read_b32 v224, a4
    v_accvgpr_read_b32 v225, a5
    v_accvgpr_read_b32 v226, a6
    v_accvgpr_read_b32 v227, a7
    v_mul_f32 v224, v224, v53
    v_mul_f32 v225, v225, v53
    v_mul_f32 v226, v226, v53
    v_mul_f32 v227, v227, v53
    v_accvgpr_write_b32 a4, v224
    v_accvgpr_write_b32 a5, v225
    v_accvgpr_write_b32 a6, v226
    v_accvgpr_write_b32 a7, v227
    v_accvgpr_read_b32 v224, a8
    v_accvgpr_read_b32 v225, a9
    v_accvgpr_read_b32 v226, a10
    v_accvgpr_read_b32 v227, a11
    v_mul_f32 v224, v224, v54
    v_mul_f32 v225, v225, v54
    v_mul_f32 v226, v226, v54
    v_mul_f32 v227, v227, v54
    v_accvgpr_write_b32 a8, v224
    v_accvgpr_write_b32 a9, v225
    v_accvgpr_write_b32 a10, v226
    v_accvgpr_write_b32 a11, v227
    v_accvgpr_read_b32 v224, a12
    v_accvgpr_read_b32 v225, a13
    v_accvgpr_read_b32 v226, a14
    v_accvgpr_read_b32 v227, a15
    v_mul_f32 v224, v224, v55
    v_mul_f32 v225, v225, v55
    v_mul_f32 v226, v226, v55
    v_mul_f32 v227, v227, v55
    v_accvgpr_write_b32 a12, v224
    v_accvgpr_write_b32 a13, v225
    v_accvgpr_write_b32 a14, v226
    v_accvgpr_write_b32 a15, v227
    v_accvgpr_read_b32 v224, a20
    v_accvgpr_read_b32 v225, a21
    v_accvgpr_read_b32 v226, a22
    v_accvgpr_read_b32 v227, a23
    v_mul_f32 v224, v224, v53
    v_mul_f32 v225, v225, v53
    v_mul_f32 v226, v226, v53
    v_mul_f32 v227, v227, v53
    v_accvgpr_write_b32 a20, v224
    v_accvgpr_write_b32 a21, v225
    v_accvgpr_write_b32 a22, v226
    v_accvgpr_write_b32 a23, v227
    v_accvgpr_read_b32 v224, a24
    v_accvgpr_read_b32 v225, a25
    v_accvgpr_read_b32 v226, a26
    v_accvgpr_read_b32 v227, a27
    v_mul_f32 v224, v224, v54
    v_mul_f32 v225, v225, v54
    v_mul_f32 v226, v226, v54
    v_mul_f32 v227, v227, v54
    v_accvgpr_write_b32 a24, v224
    v_accvgpr_write_b32 a25, v225
    v_accvgpr_write_b32 a26, v226
    v_accvgpr_write_b32 a27, v227
    v_accvgpr_read_b32 v224, a28
    v_accvgpr_read_b32 v225, a29
    v_accvgpr_read_b32 v226, a30
    v_accvgpr_read_b32 v227, a31
    v_mul_f32 v224, v224, v55
    v_mul_f32 v225, v225, v55
    v_mul_f32 v226, v226, v55
    v_mul_f32 v227, v227, v55
    v_accvgpr_write_b32 a28, v224
    v_accvgpr_write_b32 a29, v225
    v_accvgpr_write_b32 a30, v226
    v_accvgpr_write_b32 a31, v227
    v_accvgpr_read_b32 v224, a36
    v_accvgpr_read_b32 v225, a37
    v_accvgpr_read_b32 v226, a38
    v_accvgpr_read_b32 v227, a39
    v_mul_f32 v224, v224, v53
    v_mul_f32 v225, v225, v53
    v_mul_f32 v226, v226, v53
    v_mul_f32 v227, v227, v53
    v_accvgpr_write_b32 a36, v224
    v_accvgpr_write_b32 a37, v225
    v_accvgpr_write_b32 a38, v226
    v_accvgpr_write_b32 a39, v227
    v_accvgpr_read_b32 v224, a40
    v_accvgpr_read_b32 v225, a41
    v_accvgpr_read_b32 v226, a42
    v_accvgpr_read_b32 v227, a43
    v_mul_f32 v224, v224, v54
    v_mul_f32 v225, v225, v54
    v_mul_f32 v226, v226, v54
    v_mul_f32 v227, v227, v54
    v_accvgpr_write_b32 a40, v224
    v_accvgpr_write_b32 a41, v225
    v_accvgpr_write_b32 a42, v226
    v_accvgpr_write_b32 a43, v227
    v_accvgpr_read_b32 v224, a44
    v_accvgpr_read_b32 v225, a45
    v_accvgpr_read_b32 v226, a46
    v_accvgpr_read_b32 v227, a47
    v_mul_f32 v224, v224, v55
    v_mul_f32 v225, v225, v55
    v_mul_f32 v226, v226, v55
    v_mul_f32 v227, v227, v55
    v_accvgpr_write_b32 a44, v224
    v_accvgpr_write_b32 a45, v225
    v_accvgpr_write_b32 a46, v226
    v_accvgpr_write_b32 a47, v227
    v_accvgpr_read_b32 v224, a52
    v_accvgpr_read_b32 v225, a53
    v_accvgpr_read_b32 v226, a54
    v_accvgpr_read_b32 v227, a55
    v_mul_f32 v224, v224, v53
    v_mul_f32 v225, v225, v53
    v_mul_f32 v226, v226, v53
    v_mul_f32 v227, v227, v53
    v_accvgpr_write_b32 a52, v224
    v_accvgpr_write_b32 a53, v225
    v_accvgpr_write_b32 a54, v226
    v_accvgpr_write_b32 a55, v227
    v_accvgpr_read_b32 v224, a56
    v_accvgpr_read_b32 v225, a57
    v_accvgpr_read_b32 v226, a58
    v_accvgpr_read_b32 v227, a59
    v_mul_f32 v224, v224, v54
    v_mul_f32 v225, v225, v54
    v_mul_f32 v226, v226, v54
    v_mul_f32 v227, v227, v54
    v_accvgpr_write_b32 a56, v224
    v_accvgpr_write_b32 a57, v225
    v_accvgpr_write_b32 a58, v226
    v_accvgpr_write_b32 a59, v227
    v_accvgpr_read_b32 v224, a60
    v_accvgpr_read_b32 v225, a61
    v_accvgpr_read_b32 v226, a62
    v_accvgpr_read_b32 v227, a63
    v_mul_f32 v224, v224, v55
    v_mul_f32 v225, v225, v55
    v_mul_f32 v226, v226, v55
    v_mul_f32 v227, v227, v55
    v_accvgpr_write_b32 a60, v224
    v_accvgpr_write_b32 a61, v225
    v_accvgpr_write_b32 a62, v226
    v_accvgpr_write_b32 a63, v227
    v_accvgpr_read_b32 v224, a68
    v_accvgpr_read_b32 v225, a69
    v_accvgpr_read_b32 v226, a70
    v_accvgpr_read_b32 v227, a71
    v_mul_f32 v224, v224, v53
    v_mul_f32 v225, v225, v53
    v_mul_f32 v226, v226, v53
    v_mul_f32 v227, v227, v53
    v_accvgpr_write_b32 a68, v224
    v_accvgpr_write_b32 a69, v225
    v_accvgpr_write_b32 a70, v226
    v_accvgpr_write_b32 a71, v227
    v_accvgpr_read_b32 v224, a72
    v_accvgpr_read_b32 v225, a73
    v_accvgpr_read_b32 v226, a74
    v_accvgpr_read_b32 v227, a75
    v_mul_f32 v224, v224, v54
    v_mul_f32 v225, v225, v54
    v_mul_f32 v226, v226, v54
    v_mul_f32 v227, v227, v54
    v_accvgpr_write_b32 a72, v224
    v_accvgpr_write_b32 a73, v225
    v_accvgpr_write_b32 a74, v226
    v_accvgpr_write_b32 a75, v227
    v_accvgpr_read_b32 v224, a76
    v_accvgpr_read_b32 v225, a77
    v_accvgpr_read_b32 v226, a78
    v_accvgpr_read_b32 v227, a79
    v_mul_f32 v224, v224, v55
    v_mul_f32 v225, v225, v55
    v_mul_f32 v226, v226, v55
    v_mul_f32 v227, v227, v55
    v_accvgpr_write_b32 a76, v224
    v_accvgpr_write_b32 a77, v225
    v_accvgpr_write_b32 a78, v226
    v_accvgpr_write_b32 a79, v227
    v_accvgpr_read_b32 v224, a84
    v_accvgpr_read_b32 v225, a85
    v_accvgpr_read_b32 v226, a86
    v_accvgpr_read_b32 v227, a87
    v_mul_f32 v224, v224, v53
    v_mul_f32 v225, v225, v53
    v_mul_f32 v226, v226, v53
    v_mul_f32 v227, v227, v53
    v_accvgpr_write_b32 a84, v224
    v_accvgpr_write_b32 a85, v225
    v_accvgpr_write_b32 a86, v226
    v_accvgpr_write_b32 a87, v227
    v_accvgpr_read_b32 v224, a88
    v_accvgpr_read_b32 v225, a89
    v_accvgpr_read_b32 v226, a90
    v_accvgpr_read_b32 v227, a91
    v_mul_f32 v224, v224, v54
    v_mul_f32 v225, v225, v54
    v_mul_f32 v226, v226, v54
    v_mul_f32 v227, v227, v54
    v_accvgpr_write_b32 a88, v224
    v_accvgpr_write_b32 a89, v225
    v_accvgpr_write_b32 a90, v226
    v_accvgpr_write_b32 a91, v227
    v_accvgpr_read_b32 v224, a92
    v_accvgpr_read_b32 v225, a93
    v_accvgpr_read_b32 v226, a94
    v_accvgpr_read_b32 v227, a95
    v_mul_f32 v224, v224, v55
    v_mul_f32 v225, v225, v55
    v_mul_f32 v226, v226, v55
    v_mul_f32 v227, v227, v55
    v_accvgpr_write_b32 a92, v224
    v_accvgpr_write_b32 a93, v225
    v_accvgpr_write_b32 a94, v226
    v_accvgpr_write_b32 a95, v227
    v_accvgpr_read_b32 v224, a100
    v_accvgpr_read_b32 v225, a101
    v_accvgpr_read_b32 v226, a102
    v_accvgpr_read_b32 v227, a103
    v_mul_f32 v224, v224, v53
    v_mul_f32 v225, v225, v53
    v_mul_f32 v226, v226, v53
    v_mul_f32 v227, v227, v53
    v_accvgpr_write_b32 a100, v224
    v_accvgpr_write_b32 a101, v225
    v_accvgpr_write_b32 a102, v226
    v_accvgpr_write_b32 a103, v227
    v_accvgpr_read_b32 v224, a104
    v_accvgpr_read_b32 v225, a105
    v_accvgpr_read_b32 v226, a106
    v_accvgpr_read_b32 v227, a107
    v_mul_f32 v224, v224, v54
    v_mul_f32 v225, v225, v54
    v_mul_f32 v226, v226, v54
    v_mul_f32 v227, v227, v54
    v_accvgpr_write_b32 a104, v224
    v_accvgpr_write_b32 a105, v225
    v_accvgpr_write_b32 a106, v226
    v_accvgpr_write_b32 a107, v227
    v_accvgpr_read_b32 v224, a108
    v_accvgpr_read_b32 v225, a109
    v_accvgpr_read_b32 v226, a110
    v_accvgpr_read_b32 v227, a111
    v_mul_f32 v224, v224, v55
    v_mul_f32 v225, v225, v55
    v_mul_f32 v226, v226, v55
    v_mul_f32 v227, v227, v55
    v_accvgpr_write_b32 a108, v224
    v_accvgpr_write_b32 a109, v225
    v_accvgpr_write_b32 a110, v226
    v_accvgpr_write_b32 a111, v227
    v_accvgpr_read_b32 v224, a116
    v_accvgpr_read_b32 v225, a117
    v_accvgpr_read_b32 v226, a118
    v_accvgpr_read_b32 v227, a119
    v_mul_f32 v224, v224, v53
    v_mul_f32 v225, v225, v53
    v_mul_f32 v226, v226, v53
    v_mul_f32 v227, v227, v53
    v_accvgpr_write_b32 a116, v224
    v_accvgpr_write_b32 a117, v225
    v_accvgpr_write_b32 a118, v226
    v_accvgpr_write_b32 a119, v227
    v_accvgpr_read_b32 v224, a120
    v_accvgpr_read_b32 v225, a121
    v_accvgpr_read_b32 v226, a122
    v_accvgpr_read_b32 v227, a123
    v_mul_f32 v224, v224, v54
    v_mul_f32 v225, v225, v54
    v_mul_f32 v226, v226, v54
    v_mul_f32 v227, v227, v54
    v_accvgpr_write_b32 a120, v224
    v_accvgpr_write_b32 a121, v225
    v_accvgpr_write_b32 a122, v226
    v_accvgpr_write_b32 a123, v227
    v_accvgpr_read_b32 v224, a124
    v_accvgpr_read_b32 v225, a125
    v_accvgpr_read_b32 v226, a126
    v_accvgpr_read_b32 v227, a127
    v_mul_f32 v224, v224, v55
    v_mul_f32 v225, v225, v55
    v_mul_f32 v226, v226, v55
    v_mul_f32 v227, v227, v55
    v_accvgpr_write_b32 a124, v224
    v_accvgpr_write_b32 a125, v225
    v_accvgpr_write_b32 a126, v226
    v_accvgpr_write_b32 a127, v227
    v_exp_f32 v232, v132
    v_exp_f32 v233, v133
    v_exp_f32 v234, v134
    v_exp_f32 v235, v135
    s_nop 0
    v_cvt_pk_bf16_f32 v196, v232, v233
    v_cvt_pk_bf16_f32 v197, v234, v235
    v_exp_f32 v232, v148
    v_exp_f32 v233, v149
    v_exp_f32 v234, v150
    v_exp_f32 v235, v151
    s_nop 0
    v_cvt_pk_bf16_f32 v198, v232, v233
    v_cvt_pk_bf16_f32 v199, v234, v235
    v_exp_f32 v232, v136
    v_exp_f32 v233, v137
    v_exp_f32 v234, v138
    v_exp_f32 v235, v139
    s_nop 0
    v_cvt_pk_bf16_f32 v200, v232, v233
    v_cvt_pk_bf16_f32 v201, v234, v235
    v_exp_f32 v232, v152
    v_exp_f32 v233, v153
    v_exp_f32 v234, v154
    v_exp_f32 v235, v155
    s_nop 0
    v_cvt_pk_bf16_f32 v202, v232, v233
    v_cvt_pk_bf16_f32 v203, v234, v235
    v_exp_f32 v232, v140
    v_exp_f32 v233, v141
    v_exp_f32 v234, v142
    v_exp_f32 v235, v143
    s_nop 0
    v_cvt_pk_bf16_f32 v204, v232, v233
    v_cvt_pk_bf16_f32 v205, v234, v235
    v_exp_f32 v232, v156
    v_exp_f32 v233, v157
    v_exp_f32 v234, v158
    v_exp_f32 v235, v159
    s_nop 0
    v_cvt_pk_bf16_f32 v206, v232, v233
    v_cvt_pk_bf16_f32 v207, v234, v235
    s_nop 3
    s_setpc_b64 s[40:41]
k2_rare_165:
    s_nop 7
    v_max_f32 v53, v164, v165
    v_max3_f32 v53, v53, v166, v167
    v_max3_f32 v53, v53, v180, v181
    v_max3_f32 v53, v53, v182, v183
    v_max_f32 v54, v168, v169
    v_max3_f32 v54, v54, v170, v171
    v_max3_f32 v54, v54, v184, v185
    v_max3_f32 v54, v54, v186, v187
    v_max_f32 v55, v172, v173
    v_max3_f32 v55, v55, v174, v175
    v_max3_f32 v55, v55, v188, v189
    v_max3_f32 v55, v55, v190, v191
    v_mov_b32 v225, v53
    v_mov_b32 v226, v54
    v_mov_b32 v227, v55
    s_nop 1
    v_permlane16_swap_b32 v53, v225
    v_permlane16_swap_b32 v54, v226
    v_permlane16_swap_b32 v55, v227
    s_nop 1
    v_max_f32 v53, v53, v225
    v_max_f32 v54, v54, v226
    v_max_f32 v55, v55, v227
    v_mov_b32 v225, v53
    v_mov_b32 v226, v54
    v_mov_b32 v227, v55
    s_nop 1
    v_permlane32_swap_b32 v53, v225
    v_permlane32_swap_b32 v54, v226
    v_permlane32_swap_b32 v55, v227
    s_nop 1
    v_max_f32 v53, v53, v225
    v_max_f32 v54, v54, v226
    v_max_f32 v55, v55, v227
    v_add_f32 v53, 0x41400000, v53
    v_max_f32 v53, 0, v53
    v_add_f32 v54, 0x41400000, v54
    v_max_f32 v54, 0, v54
    v_add_f32 v55, 0x41400000, v55
    v_max_f32 v55, 0, v55
    v_sub_f32 v164, v164, v53
    v_sub_f32 v165, v165, v53
    v_sub_f32 v166, v166, v53
    v_sub_f32 v167, v167, v53
    v_sub_f32 v168, v168, v54
    v_sub_f32 v169, v169, v54
    v_sub_f32 v170, v170, v54
    v_sub_f32 v171, v171, v54
    v_sub_f32 v172, v172, v55
    v_sub_f32 v173, v173, v55
    v_sub_f32 v174, v174, v55
    v_sub_f32 v175, v175, v55
    v_sub_f32 v180, v180, v53
    v_sub_f32 v181, v181, v53
    v_sub_f32 v182, v182, v53
    v_sub_f32 v183, v183, v53
    v_sub_f32 v184, v184, v54
    v_sub_f32 v185, v185, v54
    v_sub_f32 v186, v186, v54
    v_sub_f32 v187, v187, v54
    v_sub_f32 v188, v188, v55
    v_sub_f32 v189, v189, v55
    v_sub_f32 v190, v190, v55
    v_sub_f32 v191, v191, v55
    v_sub_f32 v128, v128, v54
    v_sub_f32 v16, v16, v54
    v_sub_f32 v129, v129, v54
    v_sub_f32 v17, v17, v54
    v_sub_f32 v130, v130, v54
    v_sub_f32 v18, v18, v54
    v_sub_f32 v131, v131, v54
    v_sub_f32 v19, v19, v54
    v_sub_f32 v132, v132, v55
    v_sub_f32 v20, v20, v55
    v_sub_f32 v133, v133, v55
    v_sub_f32 v21, v21, v55
    v_sub_f32 v134, v134, v55
    v_sub_f32 v22, v22, v55
    v_sub_f32 v135, v135, v55
    v_sub_f32 v23, v23, v55
    v_sub_f32 v136, v136, v54
    v_sub_f32 v24, v24, v54
    v_sub_f32 v137, v137, v54
    v_sub_f32 v25, v25, v54
    v_sub_f32 v138, v138, v54
    v_sub_f32 v26, v26, v54
    v_sub_f32 v139, v139, v54
    v_sub_f32 v27, v27, v54
    v_sub_f32 v140, v140, v55
    v_sub_f32 v28, v28, v55
    v_sub_f32 v141, v141, v55
    v_sub_f32 v29, v29, v55
    v_sub_f32 v142, v142, v55
    v_sub_f32 v30, v30, v55
    v_sub_f32 v143, v143, v55
    v_sub_f32 v31, v31, v55
    v_sub_f32 v144, v144, v54
    v_sub_f32 v32, v32, v54
    v_sub_f32 v145, v145, v54
    v_sub_f32 v33, v33, v54
    v_sub_f32 v146, v146, v54
    v_sub_f32 v34, v34, v54
    v_sub_f32 v147, v147, v54
    v_sub_f32 v35, v35, v54
    v_sub_f32 v148, v148, v55
    v_sub_f32 v36, v36, v55
    v_sub_f32 v149, v149, v55
    v_sub_f32 v37, v37, v55
    v_sub_f32 v150, v150, v55
    v_sub_f32 v38, v38, v55
    v_sub_f32 v151, v151, v55
    v_sub_f32 v39, v39, v55
    v_sub_f32 v152, v152, v54
    v_sub_f32 v40, v40, v54
    v_sub_f32 v153, v153, v54
    v_sub_f32 v41, v41, v54
    v_sub_f32 v154, v154, v54
    v_sub_f32 v42, v42, v54
    v_sub_f32 v155, v155, v54
    v_sub_f32 v43, v43, v54
    v_sub_f32 v156, v156, v55
    v_sub_f32 v44, v44, v55
    v_sub_f32 v157, v157, v55
    v_sub_f32 v45, v45, v55
    v_sub_f32 v158, v158, v55
    v_sub_f32 v46, v46, v55
    v_sub_f32 v159, v159, v55
    v_sub_f32 v47, v47, v55
    v_sub_f32 v9, v9, v53
    v_exp_f32 v53, -v53
    v_sub_f32 v10, v10, v54
    v_exp_f32 v54, -v54
    v_sub_f32 v11, v11, v55
    v_exp_f32 v55, -v55
    s_nop 0
    v_mul_f32 v48, v48, v53
    v_mul_f32 v248, v248, v54
    v_mul_f32 v252, v252, v55
    v_accvgpr_read_b32 v224, a4
    v_accvgpr_read_b32 v225, a5
    v_accvgpr_read_b32 v226, a6
    v_accvgpr_read_b32 v227, a7
    v_mul_f32 v224, v224, v53
    v_mul_f32 v225, v225, v53
    v_mul_f32 v226, v226, v53
    v_mul_f32 v227, v227, v53
    v_accvgpr_write_b32 a4, v224
    v_accvgpr_write_b32 a5, v225
    v_accvgpr_write_b32 a6, v226
    v_accvgpr_write_b32 a7, v227
    v_accvgpr_read_b32 v224, a8
    v_accvgpr_read_b32 v225, a9
    v_accvgpr_read_b32 v226, a10
    v_accvgpr_read_b32 v227, a11
    v_mul_f32 v224, v224, v54
    v_mul_f32 v225, v225, v54
    v_mul_f32 v226, v226, v54
    v_mul_f32 v227, v227, v54
    v_accvgpr_write_b32 a8, v224
    v_accvgpr_write_b32 a9, v225
    v_accvgpr_write_b32 a10, v226
    v_accvgpr_write_b32 a11, v227
    v_accvgpr_read_b32 v224, a12
    v_accvgpr_read_b32 v225, a13
    v_accvgpr_read_b32 v226, a14
    v_accvgpr_read_b32 v227, a15
    v_mul_f32 v224, v224, v55
    v_mul_f32 v225, v225, v55
    v_mul_f32 v226, v226, v55
    v_mul_f32 v227, v227, v55
    v_accvgpr_write_b32 a12, v224
    v_accvgpr_write_b32 a13, v225
    v_accvgpr_write_b32 a14, v226
    v_accvgpr_write_b32 a15, v227
    v_accvgpr_read_b32 v224, a20
    v_accvgpr_read_b32 v225, a21
    v_accvgpr_read_b32 v226, a22
    v_accvgpr_read_b32 v227, a23
    v_mul_f32 v224, v224, v53
    v_mul_f32 v225, v225, v53
    v_mul_f32 v226, v226, v53
    v_mul_f32 v227, v227, v53
    v_accvgpr_write_b32 a20, v224
    v_accvgpr_write_b32 a21, v225
    v_accvgpr_write_b32 a22, v226
    v_accvgpr_write_b32 a23, v227
    v_accvgpr_read_b32 v224, a24
    v_accvgpr_read_b32 v225, a25
    v_accvgpr_read_b32 v226, a26
    v_accvgpr_read_b32 v227, a27
    v_mul_f32 v224, v224, v54
    v_mul_f32 v225, v225, v54
    v_mul_f32 v226, v226, v54
    v_mul_f32 v227, v227, v54
    v_accvgpr_write_b32 a24, v224
    v_accvgpr_write_b32 a25, v225
    v_accvgpr_write_b32 a26, v226
    v_accvgpr_write_b32 a27, v227
    v_accvgpr_read_b32 v224, a28
    v_accvgpr_read_b32 v225, a29
    v_accvgpr_read_b32 v226, a30
    v_accvgpr_read_b32 v227, a31
    v_mul_f32 v224, v224, v55
    v_mul_f32 v225, v225, v55
    v_mul_f32 v226, v226, v55
    v_mul_f32 v227, v227, v55
    v_accvgpr_write_b32 a28, v224
    v_accvgpr_write_b32 a29, v225
    v_accvgpr_write_b32 a30, v226
    v_accvgpr_write_b32 a31, v227
    v_accvgpr_read_b32 v224, a36
    v_accvgpr_read_b32 v225, a37
    v_accvgpr_read_b32 v226, a38
    v_accvgpr_read_b32 v227, a39
    v_mul_f32 v224, v224, v53
    v_mul_f32 v225, v225, v53
    v_mul_f32 v226, v226, v53
    v_mul_f32 v227, v227, v53
    v_accvgpr_write_b32 a36, v224
    v_accvgpr_write_b32 a37, v225
    v_accvgpr_write_b32 a38, v226
    v_accvgpr_write_b32 a39, v227
    v_accvgpr_read_b32 v224, a40
    v_accvgpr_read_b32 v225, a41
    v_accvgpr_read_b32 v226, a42
    v_accvgpr_read_b32 v227, a43
    v_mul_f32 v224, v224, v54
    v_mul_f32 v225, v225, v54
    v_mul_f32 v226, v226, v54
    v_mul_f32 v227, v227, v54
    v_accvgpr_write_b32 a40, v224
    v_accvgpr_write_b32 a41, v225
    v_accvgpr_write_b32 a42, v226
    v_accvgpr_write_b32 a43, v227
    v_accvgpr_read_b32 v224, a44
    v_accvgpr_read_b32 v225, a45
    v_accvgpr_read_b32 v226, a46
    v_accvgpr_read_b32 v227, a47
    v_mul_f32 v224, v224, v55
    v_mul_f32 v225, v225, v55
    v_mul_f32 v226, v226, v55
    v_mul_f32 v227, v227, v55
    v_accvgpr_write_b32 a44, v224
    v_accvgpr_write_b32 a45, v225
    v_accvgpr_write_b32 a46, v226
    v_accvgpr_write_b32 a47, v227
    v_accvgpr_read_b32 v224, a52
    v_accvgpr_read_b32 v225, a53
    v_accvgpr_read_b32 v226, a54
    v_accvgpr_read_b32 v227, a55
    v_mul_f32 v224, v224, v53
    v_mul_f32 v225, v225, v53
    v_mul_f32 v226, v226, v53
    v_mul_f32 v227, v227, v53
    v_accvgpr_write_b32 a52, v224
    v_accvgpr_write_b32 a53, v225
    v_accvgpr_write_b32 a54, v226
    v_accvgpr_write_b32 a55, v227
    v_accvgpr_read_b32 v224, a56
    v_accvgpr_read_b32 v225, a57
    v_accvgpr_read_b32 v226, a58
    v_accvgpr_read_b32 v227, a59
    v_mul_f32 v224, v224, v54
    v_mul_f32 v225, v225, v54
    v_mul_f32 v226, v226, v54
    v_mul_f32 v227, v227, v54
    v_accvgpr_write_b32 a56, v224
    v_accvgpr_write_b32 a57, v225
    v_accvgpr_write_b32 a58, v226
    v_accvgpr_write_b32 a59, v227
    v_accvgpr_read_b32 v224, a60
    v_accvgpr_read_b32 v225, a61
    v_accvgpr_read_b32 v226, a62
    v_accvgpr_read_b32 v227, a63
    v_mul_f32 v224, v224, v55
    v_mul_f32 v225, v225, v55
    v_mul_f32 v226, v226, v55
    v_mul_f32 v227, v227, v55
    v_accvgpr_write_b32 a60, v224
    v_accvgpr_write_b32 a61, v225
    v_accvgpr_write_b32 a62, v226
    v_accvgpr_write_b32 a63, v227
    v_accvgpr_read_b32 v224, a68
    v_accvgpr_read_b32 v225, a69
    v_accvgpr_read_b32 v226, a70
    v_accvgpr_read_b32 v227, a71
    v_mul_f32 v224, v224, v53
    v_mul_f32 v225, v225, v53
    v_mul_f32 v226, v226, v53
    v_mul_f32 v227, v227, v53
    v_accvgpr_write_b32 a68, v224
    v_accvgpr_write_b32 a69, v225
    v_accvgpr_write_b32 a70, v226
    v_accvgpr_write_b32 a71, v227
    v_accvgpr_read_b32 v224, a72
    v_accvgpr_read_b32 v225, a73
    v_accvgpr_read_b32 v226, a74
    v_accvgpr_read_b32 v227, a75
    v_mul_f32 v224, v224, v54
    v_mul_f32 v225, v225, v54
    v_mul_f32 v226, v226, v54
    v_mul_f32 v227, v227, v54
    v_accvgpr_write_b32 a72, v224
    v_accvgpr_write_b32 a73, v225
    v_accvgpr_write_b32 a74, v226
    v_accvgpr_write_b32 a75, v227
    v_accvgpr_read_b32 v224, a76
    v_accvgpr_read_b32 v225, a77
    v_accvgpr_read_b32 v226, a78
    v_accvgpr_read_b32 v227, a79
    v_mul_f32 v224, v224, v55
    v_mul_f32 v225, v225, v55
    v_mul_f32 v226, v226, v55
    v_mul_f32 v227, v227, v55
    v_accvgpr_write_b32 a76, v224
    v_accvgpr_write_b32 a77, v225
    v_accvgpr_write_b32 a78, v226
    v_accvgpr_write_b32 a79, v227
    v_accvgpr_read_b32 v224, a84
    v_accvgpr_read_b32 v225, a85
    v_accvgpr_read_b32 v226, a86
    v_accvgpr_read_b32 v227, a87
    v_mul_f32 v224, v224, v53
    v_mul_f32 v225, v225, v53
    v_mul_f32 v226, v226, v53
    v_mul_f32 v227, v227, v53
    v_accvgpr_write_b32 a84, v224
    v_accvgpr_write_b32 a85, v225
    v_accvgpr_write_b32 a86, v226
    v_accvgpr_write_b32 a87, v227
    v_accvgpr_read_b32 v224, a88
    v_accvgpr_read_b32 v225, a89
    v_accvgpr_read_b32 v226, a90
    v_accvgpr_read_b32 v227, a91
    v_mul_f32 v224, v224, v54
    v_mul_f32 v225, v225, v54
    v_mul_f32 v226, v226, v54
    v_mul_f32 v227, v227, v54
    v_accvgpr_write_b32 a88, v224
    v_accvgpr_write_b32 a89, v225
    v_accvgpr_write_b32 a90, v226
    v_accvgpr_write_b32 a91, v227
    v_accvgpr_read_b32 v224, a92
    v_accvgpr_read_b32 v225, a93
    v_accvgpr_read_b32 v226, a94
    v_accvgpr_read_b32 v227, a95
    v_mul_f32 v224, v224, v55
    v_mul_f32 v225, v225, v55
    v_mul_f32 v226, v226, v55
    v_mul_f32 v227, v227, v55
    v_accvgpr_write_b32 a92, v224
    v_accvgpr_write_b32 a93, v225
    v_accvgpr_write_b32 a94, v226
    v_accvgpr_write_b32 a95, v227
    v_accvgpr_read_b32 v224, a100
    v_accvgpr_read_b32 v225, a101
    v_accvgpr_read_b32 v226, a102
    v_accvgpr_read_b32 v227, a103
    v_mul_f32 v224, v224, v53
    v_mul_f32 v225, v225, v53
    v_mul_f32 v226, v226, v53
    v_mul_f32 v227, v227, v53
    v_accvgpr_write_b32 a100, v224
    v_accvgpr_write_b32 a101, v225
    v_accvgpr_write_b32 a102, v226
    v_accvgpr_write_b32 a103, v227
    v_accvgpr_read_b32 v224, a104
    v_accvgpr_read_b32 v225, a105
    v_accvgpr_read_b32 v226, a106
    v_accvgpr_read_b32 v227, a107
    v_mul_f32 v224, v224, v54
    v_mul_f32 v225, v225, v54
    v_mul_f32 v226, v226, v54
    v_mul_f32 v227, v227, v54
    v_accvgpr_write_b32 a104, v224
    v_accvgpr_write_b32 a105, v225
    v_accvgpr_write_b32 a106, v226
    v_accvgpr_write_b32 a107, v227
    v_accvgpr_read_b32 v224, a108
    v_accvgpr_read_b32 v225, a109
    v_accvgpr_read_b32 v226, a110
    v_accvgpr_read_b32 v227, a111
    v_mul_f32 v224, v224, v55
    v_mul_f32 v225, v225, v55
    v_mul_f32 v226, v226, v55
    v_mul_f32 v227, v227, v55
    v_accvgpr_write_b32 a108, v224
    v_accvgpr_write_b32 a109, v225
    v_accvgpr_write_b32 a110, v226
    v_accvgpr_write_b32 a111, v227
    v_accvgpr_read_b32 v224, a116
    v_accvgpr_read_b32 v225, a117
    v_accvgpr_read_b32 v226, a118
    v_accvgpr_read_b32 v227, a119
    v_mul_f32 v224, v224, v53
    v_mul_f32 v225, v225, v53
    v_mul_f32 v226, v226, v53
    v_mul_f32 v227, v227, v53
    v_accvgpr_write_b32 a116, v224
    v_accvgpr_write_b32 a117, v225
    v_accvgpr_write_b32 a118, v226
    v_accvgpr_write_b32 a119, v227
    v_accvgpr_read_b32 v224, a120
    v_accvgpr_read_b32 v225, a121
    v_accvgpr_read_b32 v226, a122
    v_accvgpr_read_b32 v227, a123
    v_mul_f32 v224, v224, v54
    v_mul_f32 v225, v225, v54
    v_mul_f32 v226, v226, v54
    v_mul_f32 v227, v227, v54
    v_accvgpr_write_b32 a120, v224
    v_accvgpr_write_b32 a121, v225
    v_accvgpr_write_b32 a122, v226
    v_accvgpr_write_b32 a123, v227
    v_accvgpr_read_b32 v224, a124
    v_accvgpr_read_b32 v225, a125
    v_accvgpr_read_b32 v226, a126
    v_accvgpr_read_b32 v227, a127
    v_mul_f32 v224, v224, v55
    v_mul_f32 v225, v225, v55
    v_mul_f32 v226, v226, v55
    v_mul_f32 v227, v227, v55
    v_accvgpr_write_b32 a124, v224
    v_accvgpr_write_b32 a125, v225
    v_accvgpr_write_b32 a126, v226
    v_accvgpr_write_b32 a127, v227
    v_exp_f32 v232, v164
    v_exp_f32 v233, v165
    v_exp_f32 v234, v166
    v_exp_f32 v235, v167
    s_nop 0
    v_cvt_pk_bf16_f32 v212, v232, v233
    v_cvt_pk_bf16_f32 v213, v234, v235
    v_exp_f32 v232, v180
    v_exp_f32 v233, v181
    v_exp_f32 v234, v182
    v_exp_f32 v235, v183
    s_nop 0
    v_cvt_pk_bf16_f32 v214, v232, v233
    v_cvt_pk_bf16_f32 v215, v234, v235
    v_exp_f32 v232, v168
    v_exp_f32 v233, v169
    v_exp_f32 v234, v170
    v_exp_f32 v235, v171
    s_nop 0
    v_cvt_pk_bf16_f32 v216, v232, v233
    v_cvt_pk_bf16_f32 v217, v234, v235
    v_exp_f32 v232, v184
    v_exp_f32 v233, v185
    v_exp_f32 v234, v186
    v_exp_f32 v235, v187
    s_nop 0
    v_cvt_pk_bf16_f32 v218, v232, v233
    v_cvt_pk_bf16_f32 v219, v234, v235
    v_exp_f32 v232, v172
    v_exp_f32 v233, v173
    v_exp_f32 v234, v174
    v_exp_f32 v235, v175
    s_nop 0
    v_cvt_pk_bf16_f32 v220, v232, v233
    v_cvt_pk_bf16_f32 v221, v234, v235
    v_exp_f32 v232, v188
    v_exp_f32 v233, v189
    v_exp_f32 v234, v190
    v_exp_f32 v235, v191
    s_nop 0
    v_cvt_pk_bf16_f32 v222, v232, v233
    v_cvt_pk_bf16_f32 v223, v234, v235
    s_nop 3
    s_setpc_b64 s[40:41]
k2_rare_166:
    s_nop 7
    v_max_f32 v54, v128, v129
    v_max3_f32 v54, v54, v130, v131
    v_max3_f32 v54, v54, v144, v145
    v_max3_f32 v54, v54, v146, v147
    v_max3_f32 v54, v54, v136, v137
    v_max3_f32 v54, v54, v138, v139
    v_max3_f32 v54, v54, v152, v153
    v_max3_f32 v54, v54, v154, v155
    v_max_f32 v55, v132, v133
    v_max3_f32 v55, v55, v134, v135
    v_max3_f32 v55, v55, v148, v149
    v_max3_f32 v55, v55, v150, v151
    v_max3_f32 v55, v55, v140, v141
    v_max3_f32 v55, v55, v142, v143
    v_max3_f32 v55, v55, v156, v157
    v_max3_f32 v55, v55, v158, v159
    v_mov_b32 v226, v54
    v_mov_b32 v227, v55
    s_nop 1
    v_permlane16_swap_b32 v54, v226
    v_permlane16_swap_b32 v55, v227
    s_nop 1
    v_max_f32 v54, v54, v226
    v_max_f32 v55, v55, v227
    v_mov_b32 v226, v54
    v_mov_b32 v227, v55
    s_nop 1
    v_permlane32_swap_b32 v54, v226
    v_permlane32_swap_b32 v55, v227
    s_nop 1
    v_max_f32 v54, v54, v226
    v_max_f32 v55, v55, v227
    v_add_f32 v54, 0x41400000, v54
    v_max_f32 v54, 0, v54
    v_add_f32 v55, 0x41400000, v55
    v_max_f32 v55, 0, v55
    v_sub_f32 v128, v128, v54
    v_sub_f32 v129, v129, v54
    v_sub_f32 v130, v130, v54
    v_sub_f32 v131, v131, v54
    v_sub_f32 v132, v132, v55
    v_sub_f32 v133, v133, v55
    v_sub_f32 v134, v134, v55
    v_sub_f32 v135, v135, v55
    v_sub_f32 v136, v136, v54
    v_sub_f32 v137, v137, v54
    v_sub_f32 v138, v138, v54
    v_sub_f32 v139, v139, v54
    v_sub_f32 v140, v140, v55
    v_sub_f32 v141, v141, v55
    v_sub_f32 v142, v142, v55
    v_sub_f32 v143, v143, v55
    v_sub_f32 v144, v144, v54
    v_sub_f32 v145, v145, v54
    v_sub_f32 v146, v146, v54
    v_sub_f32 v147, v147, v54
    v_sub_f32 v148, v148, v55
    v_sub_f32 v149, v149, v55
    v_sub_f32 v150, v150, v55
    v_sub_f32 v151, v151, v55
    v_sub_f32 v152, v152, v54
    v_sub_f32 v153, v153, v54
    v_sub_f32 v154, v154, v54
    v_sub_f32 v155, v155, v54
    v_sub_f32 v156, v156, v55
    v_sub_f32 v157, v157, v55
    v_sub_f32 v158, v158, v55
    v_sub_f32 v159, v159, v55
    v_sub_f32 v160, v160, v54
    v_sub_f32 v16, v16, v54
    v_sub_f32 v161, v161, v54
    v_sub_f32 v17, v17, v54
    v_sub_f32 v162, v162, v54
    v_sub_f32 v18, v18, v54
    v_sub_f32 v163, v163, v54
    v_sub_f32 v19, v19, v54
    v_sub_f32 v164, v164, v55
    v_sub_f32 v20, v20, v55
    v_sub_f32 v165, v165, v55
    v_sub_f32 v21, v21, v55
    v_sub_f32 v166, v166, v55
    v_sub_f32 v22, v22, v55
    v_sub_f32 v167, v167, v55
    v_sub_f32 v23, v23, v55
    v_sub_f32 v168, v168, v54
    v_sub_f32 v24, v24, v54
    v_sub_f32 v169, v169, v54
    v_sub_f32 v25, v25, v54
    v_sub_f32 v170, v170, v54
    v_sub_f32 v26, v26, v54
    v_sub_f32 v171, v171, v54
    v_sub_f32 v27, v27, v54
    v_sub_f32 v172, v172, v55
    v_sub_f32 v28, v28, v55
    v_sub_f32 v173, v173, v55
    v_sub_f32 v29, v29, v55
    v_sub_f32 v174, v174, v55
    v_sub_f32 v30, v30, v55
    v_sub_f32 v175, v175, v55
    v_sub_f32 v31, v31, v55
    v_sub_f32 v176, v176, v54
    v_sub_f32 v32, v32, v54
    v_sub_f32 v177, v177, v54
    v_sub_f32 v33, v33, v54
    v_sub_f32 v178, v178, v54
    v_sub_f32 v34, v34, v54
    v_sub_f32 v179, v179, v54
    v_sub_f32 v35, v35, v54
    v_sub_f32 v180, v180, v55
    v_sub_f32 v36, v36, v55
    v_sub_f32 v181, v181, v55
    v_sub_f32 v37, v37, v55
    v_sub_f32 v182, v182, v55
    v_sub_f32 v38, v38, v55
    v_sub_f32 v183, v183, v55
    v_sub_f32 v39, v39, v55
    v_sub_f32 v184, v184, v54
    v_sub_f32 v40, v40, v54
    v_sub_f32 v185, v185, v54
    v_sub_f32 v41, v41, v54
    v_sub_f32 v186, v186, v54
    v_sub_f32 v42, v42, v54
    v_sub_f32 v187, v187, v54
    v_sub_f32 v43, v43, v54
    v_sub_f32 v188, v188, v55
    v_sub_f32 v44, v44, v55
    v_sub_f32 v189, v189, v55
    v_sub_f32 v45, v45, v55
    v_sub_f32 v190, v190, v55
    v_sub_f32 v46, v46, v55
    v_sub_f32 v191, v191, v55
    v_sub_f32 v47, v47, v55
    v_sub_f32 v10, v10, v54
    v_exp_f32 v54, -v54
    v_sub_f32 v11, v11, v55
    v_exp_f32 v55, -v55
    s_nop 0
    v_mul_f32 v248, v248, v54
    v_mul_f32 v252, v252, v55
    v_accvgpr_read_b32 v224, a8
    v_accvgpr_read_b32 v225, a9
    v_accvgpr_read_b32 v226, a10
    v_accvgpr_read_b32 v227, a11
    v_mul_f32 v224, v224, v54
    v_mul_f32 v225, v225, v54
    v_mul_f32 v226, v226, v54
    v_mul_f32 v227, v227, v54
    v_accvgpr_write_b32 a8, v224
    v_accvgpr_write_b32 a9, v225
    v_accvgpr_write_b32 a10, v226
    v_accvgpr_write_b32 a11, v227
    v_accvgpr_read_b32 v224, a12
    v_accvgpr_read_b32 v225, a13
    v_accvgpr_read_b32 v226, a14
    v_accvgpr_read_b32 v227, a15
    v_mul_f32 v224, v224, v55
    v_mul_f32 v225, v225, v55
    v_mul_f32 v226, v226, v55
    v_mul_f32 v227, v227, v55
    v_accvgpr_write_b32 a12, v224
    v_accvgpr_write_b32 a13, v225
    v_accvgpr_write_b32 a14, v226
    v_accvgpr_write_b32 a15, v227
    v_accvgpr_read_b32 v224, a24
    v_accvgpr_read_b32 v225, a25
    v_accvgpr_read_b32 v226, a26
    v_accvgpr_read_b32 v227, a27
    v_mul_f32 v224, v224, v54
    v_mul_f32 v225, v225, v54
    v_mul_f32 v226, v226, v54
    v_mul_f32 v227, v227, v54
    v_accvgpr_write_b32 a24, v224
    v_accvgpr_write_b32 a25, v225
    v_accvgpr_write_b32 a26, v226
    v_accvgpr_write_b32 a27, v227
    v_accvgpr_read_b32 v224, a28
    v_accvgpr_read_b32 v225, a29
    v_accvgpr_read_b32 v226, a30
    v_accvgpr_read_b32 v227, a31
    v_mul_f32 v224, v224, v55
    v_mul_f32 v225, v225, v55
    v_mul_f32 v226, v226, v55
    v_mul_f32 v227, v227, v55
    v_accvgpr_write_b32 a28, v224
    v_accvgpr_write_b32 a29, v225
    v_accvgpr_write_b32 a30, v226
    v_accvgpr_write_b32 a31, v227
    v_accvgpr_read_b32 v224, a40
    v_accvgpr_read_b32 v225, a41
    v_accvgpr_read_b32 v226, a42
    v_accvgpr_read_b32 v227, a43
    v_mul_f32 v224, v224, v54
    v_mul_f32 v225, v225, v54
    v_mul_f32 v226, v226, v54
    v_mul_f32 v227, v227, v54
    v_accvgpr_write_b32 a40, v224
    v_accvgpr_write_b32 a41, v225
    v_accvgpr_write_b32 a42, v226
    v_accvgpr_write_b32 a43, v227
    v_accvgpr_read_b32 v224, a44
    v_accvgpr_read_b32 v225, a45
    v_accvgpr_read_b32 v226, a46
    v_accvgpr_read_b32 v227, a47
    v_mul_f32 v224, v224, v55
    v_mul_f32 v225, v225, v55
    v_mul_f32 v226, v226, v55
    v_mul_f32 v227, v227, v55
    v_accvgpr_write_b32 a44, v224
    v_accvgpr_write_b32 a45, v225
    v_accvgpr_write_b32 a46, v226
    v_accvgpr_write_b32 a47, v227
    v_accvgpr_read_b32 v224, a56
    v_accvgpr_read_b32 v225, a57
    v_accvgpr_read_b32 v226, a58
    v_accvgpr_read_b32 v227, a59
    v_mul_f32 v224, v224, v54
    v_mul_f32 v225, v225, v54
    v_mul_f32 v226, v226, v54
    v_mul_f32 v227, v227, v54
    v_accvgpr_write_b32 a56, v224
    v_accvgpr_write_b32 a57, v225
    v_accvgpr_write_b32 a58, v226
    v_accvgpr_write_b32 a59, v227
    v_accvgpr_read_b32 v224, a60
    v_accvgpr_read_b32 v225, a61
    v_accvgpr_read_b32 v226, a62
    v_accvgpr_read_b32 v227, a63
    v_mul_f32 v224, v224, v55
    v_mul_f32 v225, v225, v55
    v_mul_f32 v226, v226, v55
    v_mul_f32 v227, v227, v55
    v_accvgpr_write_b32 a60, v224
    v_accvgpr_write_b32 a61, v225
    v_accvgpr_write_b32 a62, v226
    v_accvgpr_write_b32 a63, v227
    v_accvgpr_read_b32 v224, a72
    v_accvgpr_read_b32 v225, a73
    v_accvgpr_read_b32 v226, a74
    v_accvgpr_read_b32 v227, a75
    v_mul_f32 v224, v224, v54
    v_mul_f32 v225, v225, v54
    v_mul_f32 v226, v226, v54
    v_mul_f32 v227, v227, v54
    v_accvgpr_write_b32 a72, v224
    v_accvgpr_write_b32 a73, v225
    v_accvgpr_write_b32 a74, v226
    v_accvgpr_write_b32 a75, v227
    v_accvgpr_read_b32 v224, a76
    v_accvgpr_read_b32 v225, a77
    v_accvgpr_read_b32 v226, a78
    v_accvgpr_read_b32 v227, a79
    v_mul_f32 v224, v224, v55
    v_mul_f32 v225, v225, v55
    v_mul_f32 v226, v226, v55
    v_mul_f32 v227, v227, v55
    v_accvgpr_write_b32 a76, v224
    v_accvgpr_write_b32 a77, v225
    v_accvgpr_write_b32 a78, v226
    v_accvgpr_write_b32 a79, v227
    v_accvgpr_read_b32 v224, a88
    v_accvgpr_read_b32 v225, a89
    v_accvgpr_read_b32 v226, a90
    v_accvgpr_read_b32 v227, a91
    v_mul_f32 v224, v224, v54
    v_mul_f32 v225, v225, v54
    v_mul_f32 v226, v226, v54
    v_mul_f32 v227, v227, v54
    v_accvgpr_write_b32 a88, v224
    v_accvgpr_write_b32 a89, v225
    v_accvgpr_write_b32 a90, v226
    v_accvgpr_write_b32 a91, v227
    v_accvgpr_read_b32 v224, a92
    v_accvgpr_read_b32 v225, a93
    v_accvgpr_read_b32 v226, a94
    v_accvgpr_read_b32 v227, a95
    v_mul_f32 v224, v224, v55
    v_mul_f32 v225, v225, v55
    v_mul_f32 v226, v226, v55
    v_mul_f32 v227, v227, v55
    v_accvgpr_write_b32 a92, v224
    v_accvgpr_write_b32 a93, v225
    v_accvgpr_write_b32 a94, v226
    v_accvgpr_write_b32 a95, v227
    v_accvgpr_read_b32 v224, a104
    v_accvgpr_read_b32 v225, a105
    v_accvgpr_read_b32 v226, a106
    v_accvgpr_read_b32 v227, a107
    v_mul_f32 v224, v224, v54
    v_mul_f32 v225, v225, v54
    v_mul_f32 v226, v226, v54
    v_mul_f32 v227, v227, v54
    v_accvgpr_write_b32 a104, v224
    v_accvgpr_write_b32 a105, v225
    v_accvgpr_write_b32 a106, v226
    v_accvgpr_write_b32 a107, v227
    v_accvgpr_read_b32 v224, a108
    v_accvgpr_read_b32 v225, a109
    v_accvgpr_read_b32 v226, a110
    v_accvgpr_read_b32 v227, a111
    v_mul_f32 v224, v224, v55
    v_mul_f32 v225, v225, v55
    v_mul_f32 v226, v226, v55
    v_mul_f32 v227, v227, v55
    v_accvgpr_write_b32 a108, v224
    v_accvgpr_write_b32 a109, v225
    v_accvgpr_write_b32 a110, v226
    v_accvgpr_write_b32 a111, v227
    v_accvgpr_read_b32 v224, a120
    v_accvgpr_read_b32 v225, a121
    v_accvgpr_read_b32 v226, a122
    v_accvgpr_read_b32 v227, a123
    v_mul_f32 v224, v224, v54
    v_mul_f32 v225, v225, v54
    v_mul_f32 v226, v226, v54
    v_mul_f32 v227, v227, v54
    v_accvgpr_write_b32 a120, v224
    v_accvgpr_write_b32 a121, v225
    v_accvgpr_write_b32 a122, v226
    v_accvgpr_write_b32 a123, v227
    v_accvgpr_read_b32 v224, a124
    v_accvgpr_read_b32 v225, a125
    v_accvgpr_read_b32 v226, a126
    v_accvgpr_read_b32 v227, a127
    v_mul_f32 v224, v224, v55
    v_mul_f32 v225, v225, v55
    v_mul_f32 v226, v226, v55
    v_mul_f32 v227, v227, v55
    v_accvgpr_write_b32 a124, v224
    v_accvgpr_write_b32 a125, v225
    v_accvgpr_write_b32 a126, v226
    v_accvgpr_write_b32 a127, v227
    v_exp_f32 v232, v128
    v_exp_f32 v233, v129
    v_exp_f32 v234, v130
    v_exp_f32 v235, v131
    s_nop 0
    v_cvt_pk_bf16_f32 v192, v232, v233
    v_cvt_pk_bf16_f32 v193, v234, v235
    v_exp_f32 v232, v144
    v_exp_f32 v233, v145
    v_exp_f32 v234, v146
    v_exp_f32 v235, v147
    s_nop 0
    v_cvt_pk_bf16_f32 v194, v232, v233
    v_cvt_pk_bf16_f32 v195, v234, v235
    v_exp_f32 v232, v132
    v_exp_f32 v233, v133
    v_exp_f32 v234, v134
    v_exp_f32 v235, v135
    s_nop 0
    v_cvt_pk_bf16_f32 v196, v232, v233
    v_cvt_pk_bf16_f32 v197, v234, v235
    v_exp_f32 v232, v148
    v_exp_f32 v233, v149
    v_exp_f32 v234, v150
    v_exp_f32 v235, v151
    s_nop 0
    v_cvt_pk_bf16_f32 v198, v232, v233
    v_cvt_pk_bf16_f32 v199, v234, v235
    v_exp_f32 v232, v136
    v_exp_f32 v233, v137
    v_exp_f32 v234, v138
    v_exp_f32 v235, v139
    s_nop 0
    v_cvt_pk_bf16_f32 v200, v232, v233
    v_cvt_pk_bf16_f32 v201, v234, v235
    v_exp_f32 v232, v152
    v_exp_f32 v233, v153
    v_exp_f32 v234, v154
    v_exp_f32 v235, v155
    s_nop 0
    v_cvt_pk_bf16_f32 v202, v232, v233
    v_cvt_pk_bf16_f32 v203, v234, v235
    v_exp_f32 v232, v140
    v_exp_f32 v233, v141
    v_exp_f32 v234, v142
    v_exp_f32 v235, v143
    s_nop 0
    v_cvt_pk_bf16_f32 v204, v232, v233
    v_cvt_pk_bf16_f32 v205, v234, v235
    v_exp_f32 v232, v156
    v_exp_f32 v233, v157
    v_exp_f32 v234, v158
    v_exp_f32 v235, v159
    s_nop 0
    v_cvt_pk_bf16_f32 v206, v232, v233
    v_cvt_pk_bf16_f32 v207, v234, v235
    s_nop 3
    s_setpc_b64 s[40:41]
k2_rare_167:
    s_nop 7
    v_max_f32 v54, v160, v161
    v_max3_f32 v54, v54, v162, v163
    v_max3_f32 v54, v54, v176, v177
    v_max3_f32 v54, v54, v178, v179
    v_max3_f32 v54, v54, v168, v169
    v_max3_f32 v54, v54, v170, v171
    v_max3_f32 v54, v54, v184, v185
    v_max3_f32 v54, v54, v186, v187
    v_max_f32 v55, v164, v165
    v_max3_f32 v55, v55, v166, v167
    v_max3_f32 v55, v55, v180, v181
    v_max3_f32 v55, v55, v182, v183
    v_max3_f32 v55, v55, v172, v173
    v_max3_f32 v55, v55, v174, v175
    v_max3_f32 v55, v55, v188, v189
    v_max3_f32 v55, v55, v190, v191
    v_mov_b32 v226, v54
    v_mov_b32 v227, v55
    s_nop 1
    v_permlane16_swap_b32 v54, v226
    v_permlane16_swap_b32 v55, v227
    s_nop 1
    v_max_f32 v54, v54, v226
    v_max_f32 v55, v55, v227
    v_mov_b32 v226, v54
    v_mov_b32 v227, v55
    s_nop 1
    v_permlane32_swap_b32 v54, v226
    v_permlane32_swap_b32 v55, v227
    s_nop 1
    v_max_f32 v54, v54, v226
    v_max_f32 v55, v55, v227
    v_add_f32 v54, 0x41400000, v54
    v_max_f32 v54, 0, v54
    v_add_f32 v55, 0x41400000, v55
    v_max_f32 v55, 0, v55
    v_sub_f32 v160, v160, v54
    v_sub_f32 v161, v161, v54
    v_sub_f32 v162, v162, v54
    v_sub_f32 v163, v163, v54
    v_sub_f32 v164, v164, v55
    v_sub_f32 v165, v165, v55
    v_sub_f32 v166, v166, v55
    v_sub_f32 v167, v167, v55
    v_sub_f32 v168, v168, v54
    v_sub_f32 v169, v169, v54
    v_sub_f32 v170, v170, v54
    v_sub_f32 v171, v171, v54
    v_sub_f32 v172, v172, v55
    v_sub_f32 v173, v173, v55
    v_sub_f32 v174, v174, v55
    v_sub_f32 v175, v175, v55
    v_sub_f32 v176, v176, v54
    v_sub_f32 v177, v177, v54
    v_sub_f32 v178, v178, v54
    v_sub_f32 v179, v179, v54
    v_sub_f32 v180, v180, v55
    v_sub_f32 v181, v181, v55
    v_sub_f32 v182, v182, v55
    v_sub_f32 v183, v183, v55
    v_sub_f32 v184, v184, v54
    v_sub_f32 v185, v185, v54
    v_sub_f32 v186, v186, v54
    v_sub_f32 v187, v187, v54
    v_sub_f32 v188, v188, v55
    v_sub_f32 v189, v189, v55
    v_sub_f32 v190, v190, v55
    v_sub_f32 v191, v191, v55
    v_sub_f32 v128, v128, v54
    v_sub_f32 v16, v16, v54
    v_sub_f32 v129, v129, v54
    v_sub_f32 v17, v17, v54
    v_sub_f32 v130, v130, v54
    v_sub_f32 v18, v18, v54
    v_sub_f32 v131, v131, v54
    v_sub_f32 v19, v19, v54
    v_sub_f32 v132, v132, v55
    v_sub_f32 v20, v20, v55
    v_sub_f32 v133, v133, v55
    v_sub_f32 v21, v21, v55
    v_sub_f32 v134, v134, v55
    v_sub_f32 v22, v22, v55
    v_sub_f32 v135, v135, v55
    v_sub_f32 v23, v23, v55
    v_sub_f32 v136, v136, v54
    v_sub_f32 v24, v24, v54
    v_sub_f32 v137, v137, v54
    v_sub_f32 v25, v25, v54
    v_sub_f32 v138, v138, v54
    v_sub_f32 v26, v26, v54
    v_sub_f32 v139, v139, v54
    v_sub_f32 v27, v27, v54
    v_sub_f32 v140, v140, v55
    v_sub_f32 v28, v28, v55
    v_sub_f32 v141, v141, v55
    v_sub_f32 v29, v29, v55
    v_sub_f32 v142, v142, v55
    v_sub_f32 v30, v30, v55
    v_sub_f32 v143, v143, v55
    v_sub_f32 v31, v31, v55
    v_sub_f32 v144, v144, v54
    v_sub_f32 v32, v32, v54
    v_sub_f32 v145, v145, v54
    v_sub_f32 v33, v33, v54
    v_sub_f32 v146, v146, v54
    v_sub_f32 v34, v34, v54
    v_sub_f32 v147, v147, v54
    v_sub_f32 v35, v35, v54
    v_sub_f32 v148, v148, v55
    v_sub_f32 v36, v36, v55
    v_sub_f32 v149, v149, v55
    v_sub_f32 v37, v37, v55
    v_sub_f32 v150, v150, v55
    v_sub_f32 v38, v38, v55
    v_sub_f32 v151, v151, v55
    v_sub_f32 v39, v39, v55
    v_sub_f32 v152, v152, v54
    v_sub_f32 v40, v40, v54
    v_sub_f32 v153, v153, v54
    v_sub_f32 v41, v41, v54
    v_sub_f32 v154, v154, v54
    v_sub_f32 v42, v42, v54
    v_sub_f32 v155, v155, v54
    v_sub_f32 v43, v43, v54
    v_sub_f32 v156, v156, v55
    v_sub_f32 v44, v44, v55
    v_sub_f32 v157, v157, v55
    v_sub_f32 v45, v45, v55
    v_sub_f32 v158, v158, v55
    v_sub_f32 v46, v46, v55
    v_sub_f32 v159, v159, v55
    v_sub_f32 v47, v47, v55
    v_sub_f32 v10, v10, v54
    v_exp_f32 v54, -v54
    v_sub_f32 v11, v11, v55
    v_exp_f32 v55, -v55
    s_nop 0
    v_mul_f32 v248, v248, v54
    v_mul_f32 v252, v252, v55
    v_accvgpr_read_b32 v224, a8
    v_accvgpr_read_b32 v225, a9
    v_accvgpr_read_b32 v226, a10
    v_accvgpr_read_b32 v227, a11
    v_mul_f32 v224, v224, v54
    v_mul_f32 v225, v225, v54
    v_mul_f32 v226, v226, v54
    v_mul_f32 v227, v227, v54
    v_accvgpr_write_b32 a8, v224
    v_accvgpr_write_b32 a9, v225
    v_accvgpr_write_b32 a10, v226
    v_accvgpr_write_b32 a11, v227
    v_accvgpr_read_b32 v224, a12
    v_accvgpr_read_b32 v225, a13
    v_accvgpr_read_b32 v226, a14
    v_accvgpr_read_b32 v227, a15
    v_mul_f32 v224, v224, v55
    v_mul_f32 v225, v225, v55
    v_mul_f32 v226, v226, v55
    v_mul_f32 v227, v227, v55
    v_accvgpr_write_b32 a12, v224
    v_accvgpr_write_b32 a13, v225
    v_accvgpr_write_b32 a14, v226
    v_accvgpr_write_b32 a15, v227
    v_accvgpr_read_b32 v224, a24
    v_accvgpr_read_b32 v225, a25
    v_accvgpr_read_b32 v226, a26
    v_accvgpr_read_b32 v227, a27
    v_mul_f32 v224, v224, v54
    v_mul_f32 v225, v225, v54
    v_mul_f32 v226, v226, v54
    v_mul_f32 v227, v227, v54
    v_accvgpr_write_b32 a24, v224
    v_accvgpr_write_b32 a25, v225
    v_accvgpr_write_b32 a26, v226
    v_accvgpr_write_b32 a27, v227
    v_accvgpr_read_b32 v224, a28
    v_accvgpr_read_b32 v225, a29
    v_accvgpr_read_b32 v226, a30
    v_accvgpr_read_b32 v227, a31
    v_mul_f32 v224, v224, v55
    v_mul_f32 v225, v225, v55
    v_mul_f32 v226, v226, v55
    v_mul_f32 v227, v227, v55
    v_accvgpr_write_b32 a28, v224
    v_accvgpr_write_b32 a29, v225
    v_accvgpr_write_b32 a30, v226
    v_accvgpr_write_b32 a31, v227
    v_accvgpr_read_b32 v224, a40
    v_accvgpr_read_b32 v225, a41
    v_accvgpr_read_b32 v226, a42
    v_accvgpr_read_b32 v227, a43
    v_mul_f32 v224, v224, v54
    v_mul_f32 v225, v225, v54
    v_mul_f32 v226, v226, v54
    v_mul_f32 v227, v227, v54
    v_accvgpr_write_b32 a40, v224
    v_accvgpr_write_b32 a41, v225
    v_accvgpr_write_b32 a42, v226
    v_accvgpr_write_b32 a43, v227
    v_accvgpr_read_b32 v224, a44
    v_accvgpr_read_b32 v225, a45
    v_accvgpr_read_b32 v226, a46
    v_accvgpr_read_b32 v227, a47
    v_mul_f32 v224, v224, v55
    v_mul_f32 v225, v225, v55
    v_mul_f32 v226, v226, v55
    v_mul_f32 v227, v227, v55
    v_accvgpr_write_b32 a44, v224
    v_accvgpr_write_b32 a45, v225
    v_accvgpr_write_b32 a46, v226
    v_accvgpr_write_b32 a47, v227
    v_accvgpr_read_b32 v224, a56
    v_accvgpr_read_b32 v225, a57
    v_accvgpr_read_b32 v226, a58
    v_accvgpr_read_b32 v227, a59
    v_mul_f32 v224, v224, v54
    v_mul_f32 v225, v225, v54
    v_mul_f32 v226, v226, v54
    v_mul_f32 v227, v227, v54
    v_accvgpr_write_b32 a56, v224
    v_accvgpr_write_b32 a57, v225
    v_accvgpr_write_b32 a58, v226
    v_accvgpr_write_b32 a59, v227
    v_accvgpr_read_b32 v224, a60
    v_accvgpr_read_b32 v225, a61
    v_accvgpr_read_b32 v226, a62
    v_accvgpr_read_b32 v227, a63
    v_mul_f32 v224, v224, v55
    v_mul_f32 v225, v225, v55
    v_mul_f32 v226, v226, v55
    v_mul_f32 v227, v227, v55
    v_accvgpr_write_b32 a60, v224
    v_accvgpr_write_b32 a61, v225
    v_accvgpr_write_b32 a62, v226
    v_accvgpr_write_b32 a63, v227
    v_accvgpr_read_b32 v224, a72
    v_accvgpr_read_b32 v225, a73
    v_accvgpr_read_b32 v226, a74
    v_accvgpr_read_b32 v227, a75
    v_mul_f32 v224, v224, v54
    v_mul_f32 v225, v225, v54
    v_mul_f32 v226, v226, v54
    v_mul_f32 v227, v227, v54
    v_accvgpr_write_b32 a72, v224
    v_accvgpr_write_b32 a73, v225
    v_accvgpr_write_b32 a74, v226
    v_accvgpr_write_b32 a75, v227
    v_accvgpr_read_b32 v224, a76
    v_accvgpr_read_b32 v225, a77
    v_accvgpr_read_b32 v226, a78
    v_accvgpr_read_b32 v227, a79
    v_mul_f32 v224, v224, v55
    v_mul_f32 v225, v225, v55
    v_mul_f32 v226, v226, v55
    v_mul_f32 v227, v227, v55
    v_accvgpr_write_b32 a76, v224
    v_accvgpr_write_b32 a77, v225
    v_accvgpr_write_b32 a78, v226
    v_accvgpr_write_b32 a79, v227
    v_accvgpr_read_b32 v224, a88
    v_accvgpr_read_b32 v225, a89
    v_accvgpr_read_b32 v226, a90
    v_accvgpr_read_b32 v227, a91
    v_mul_f32 v224, v224, v54
    v_mul_f32 v225, v225, v54
    v_mul_f32 v226, v226, v54
    v_mul_f32 v227, v227, v54
    v_accvgpr_write_b32 a88, v224
    v_accvgpr_write_b32 a89, v225
    v_accvgpr_write_b32 a90, v226
    v_accvgpr_write_b32 a91, v227
    v_accvgpr_read_b32 v224, a92
    v_accvgpr_read_b32 v225, a93
    v_accvgpr_read_b32 v226, a94
    v_accvgpr_read_b32 v227, a95
    v_mul_f32 v224, v224, v55
    v_mul_f32 v225, v225, v55
    v_mul_f32 v226, v226, v55
    v_mul_f32 v227, v227, v55
    v_accvgpr_write_b32 a92, v224
    v_accvgpr_write_b32 a93, v225
    v_accvgpr_write_b32 a94, v226
    v_accvgpr_write_b32 a95, v227
    v_accvgpr_read_b32 v224, a104
    v_accvgpr_read_b32 v225, a105
    v_accvgpr_read_b32 v226, a106
    v_accvgpr_read_b32 v227, a107
    v_mul_f32 v224, v224, v54
    v_mul_f32 v225, v225, v54
    v_mul_f32 v226, v226, v54
    v_mul_f32 v227, v227, v54
    v_accvgpr_write_b32 a104, v224
    v_accvgpr_write_b32 a105, v225
    v_accvgpr_write_b32 a106, v226
    v_accvgpr_write_b32 a107, v227
    v_accvgpr_read_b32 v224, a108
    v_accvgpr_read_b32 v225, a109
    v_accvgpr_read_b32 v226, a110
    v_accvgpr_read_b32 v227, a111
    v_mul_f32 v224, v224, v55
    v_mul_f32 v225, v225, v55
    v_mul_f32 v226, v226, v55
    v_mul_f32 v227, v227, v55
    v_accvgpr_write_b32 a108, v224
    v_accvgpr_write_b32 a109, v225
    v_accvgpr_write_b32 a110, v226
    v_accvgpr_write_b32 a111, v227
    v_accvgpr_read_b32 v224, a120
    v_accvgpr_read_b32 v225, a121
    v_accvgpr_read_b32 v226, a122
    v_accvgpr_read_b32 v227, a123
    v_mul_f32 v224, v224, v54
    v_mul_f32 v225, v225, v54
    v_mul_f32 v226, v226, v54
    v_mul_f32 v227, v227, v54
    v_accvgpr_write_b32 a120, v224
    v_accvgpr_write_b32 a121, v225
    v_accvgpr_write_b32 a122, v226
    v_accvgpr_write_b32 a123, v227
    v_accvgpr_read_b32 v224, a124
    v_accvgpr_read_b32 v225, a125
    v_accvgpr_read_b32 v226, a126
    v_accvgpr_read_b32 v227, a127
    v_mul_f32 v224, v224, v55
    v_mul_f32 v225, v225, v55
    v_mul_f32 v226, v226, v55
    v_mul_f32 v227, v227, v55
    v_accvgpr_write_b32 a124, v224
    v_accvgpr_write_b32 a125, v225
    v_accvgpr_write_b32 a126, v226
    v_accvgpr_write_b32 a127, v227
    v_exp_f32 v232, v160
    v_exp_f32 v233, v161
    v_exp_f32 v234, v162
    v_exp_f32 v235, v163
    s_nop 0
    v_cvt_pk_bf16_f32 v208, v232, v233
    v_cvt_pk_bf16_f32 v209, v234, v235
    v_exp_f32 v232, v176
    v_exp_f32 v233, v177
    v_exp_f32 v234, v178
    v_exp_f32 v235, v179
    s_nop 0
    v_cvt_pk_bf16_f32 v210, v232, v233
    v_cvt_pk_bf16_f32 v211, v234, v235
    v_exp_f32 v232, v164
    v_exp_f32 v233, v165
    v_exp_f32 v234, v166
    v_exp_f32 v235, v167
    s_nop 0
    v_cvt_pk_bf16_f32 v212, v232, v233
    v_cvt_pk_bf16_f32 v213, v234, v235
    v_exp_f32 v232, v180
    v_exp_f32 v233, v181
    v_exp_f32 v234, v182
    v_exp_f32 v235, v183
    s_nop 0
    v_cvt_pk_bf16_f32 v214, v232, v233
    v_cvt_pk_bf16_f32 v215, v234, v235
    v_exp_f32 v232, v168
    v_exp_f32 v233, v169
    v_exp_f32 v234, v170
    v_exp_f32 v235, v171
    s_nop 0
    v_cvt_pk_bf16_f32 v216, v232, v233
    v_cvt_pk_bf16_f32 v217, v234, v235
    v_exp_f32 v232, v184
    v_exp_f32 v233, v185
    v_exp_f32 v234, v186
    v_exp_f32 v235, v187
    s_nop 0
    v_cvt_pk_bf16_f32 v218, v232, v233
    v_cvt_pk_bf16_f32 v219, v234, v235
    v_exp_f32 v232, v172
    v_exp_f32 v233, v173
    v_exp_f32 v234, v174
    v_exp_f32 v235, v175
    s_nop 0
    v_cvt_pk_bf16_f32 v220, v232, v233
    v_cvt_pk_bf16_f32 v221, v234, v235
    v_exp_f32 v232, v188
    v_exp_f32 v233, v189
    v_exp_f32 v234, v190
    v_exp_f32 v235, v191
    s_nop 0
    v_cvt_pk_bf16_f32 v222, v232, v233
    v_cvt_pk_bf16_f32 v223, v234, v235
    s_nop 3
    s_setpc_b64 s[40:41]
k2_rare_171:
    s_nop 7
    v_max_f32 v55, v164, v165
    v_max3_f32 v55, v55, v166, v167
    v_max3_f32 v55, v55, v180, v181
    v_max3_f32 v55, v55, v182, v183
    v_max3_f32 v55, v55, v172, v173
    v_max3_f32 v55, v55, v174, v175
    v_max3_f32 v55, v55, v188, v189
    v_max3_f32 v55, v55, v190, v191
    v_mov_b32 v227, v55
    s_nop 1
    v_permlane16_swap_b32 v55, v227
    s_nop 1
    v_max_f32 v55, v55, v227
    v_mov_b32 v227, v55
    s_nop 1
    v_permlane32_swap_b32 v55, v227
    s_nop 1
    v_max_f32 v55, v55, v227
    v_add_f32 v55, 0x41400000, v55
    v_max_f32 v55, 0, v55
    v_sub_f32 v164, v164, v55
    v_sub_f32 v165, v165, v55
    v_sub_f32 v166, v166, v55
    v_sub_f32 v167, v167, v55
    v_sub_f32 v172, v172, v55
    v_sub_f32 v173, v173, v55
    v_sub_f32 v174, v174, v55
    v_sub_f32 v175, v175, v55
    v_sub_f32 v180, v180, v55
    v_sub_f32 v181, v181, v55
    v_sub_f32 v182, v182, v55
    v_sub_f32 v183, v183, v55
    v_sub_f32 v188, v188, v55
    v_sub_f32 v189, v189, v55
    v_sub_f32 v190, v190, v55
    v_sub_f32 v191, v191, v55
    v_sub_f32 v11, v11, v55
    v_exp_f32 v55, -v55
    s_nop 0
    v_mul_f32 v252, v252, v55
    v_accvgpr_read_b32 v224, a12
    v_accvgpr_read_b32 v225, a13
    v_accvgpr_read_b32 v226, a14
    v_accvgpr_read_b32 v227, a15
    v_mul_f32 v224, v224, v55
    v_mul_f32 v225, v225, v55
    v_mul_f32 v226, v226, v55
    v_mul_f32 v227, v227, v55
    v_accvgpr_write_b32 a12, v224
    v_accvgpr_write_b32 a13, v225
    v_accvgpr_write_b32 a14, v226
    v_accvgpr_write_b32 a15, v227
    v_accvgpr_read_b32 v224, a28
    v_accvgpr_read_b32 v225, a29
    v_accvgpr_read_b32 v226, a30
    v_accvgpr_read_b32 v227, a31
    v_mul_f32 v224, v224, v55
    v_mul_f32 v225, v225, v55
    v_mul_f32 v226, v226, v55
    v_mul_f32 v227, v227, v55
    v_accvgpr_write_b32 a28, v224
    v_accvgpr_write_b32 a29, v225
    v_accvgpr_write_b32 a30, v226
    v_accvgpr_write_b32 a31, v227
    v_accvgpr_read_b32 v224, a44
    v_accvgpr_read_b32 v225, a45
    v_accvgpr_read_b32 v226, a46
    v_accvgpr_read_b32 v227, a47
    v_mul_f32 v224, v224, v55
    v_mul_f32 v225, v225, v55
    v_mul_f32 v226, v226, v55
    v_mul_f32 v227, v227, v55
    v_accvgpr_write_b32 a44, v224
    v_accvgpr_write_b32 a45, v225
    v_accvgpr_write_b32 a46, v226
    v_accvgpr_write_b32 a47, v227
    v_accvgpr_read_b32 v224, a60
    v_accvgpr_read_b32 v225, a61
    v_accvgpr_read_b32 v226, a62
    v_accvgpr_read_b32 v227, a63
    v_mul_f32 v224, v224, v55
    v_mul_f32 v225, v225, v55
    v_mul_f32 v226, v226, v55
    v_mul_f32 v227, v227, v55
    v_accvgpr_write_b32 a60, v224
    v_accvgpr_write_b32 a61, v225
    v_accvgpr_write_b32 a62, v226
    v_accvgpr_write_b32 a63, v227
    v_accvgpr_read_b32 v224, a76
    v_accvgpr_read_b32 v225, a77
    v_accvgpr_read_b32 v226, a78
    v_accvgpr_read_b32 v227, a79
    v_mul_f32 v224, v224, v55
    v_mul_f32 v225, v225, v55
    v_mul_f32 v226, v226, v55
    v_mul_f32 v227, v227, v55
    v_accvgpr_write_b32 a76, v224
    v_accvgpr_write_b32 a77, v225
    v_accvgpr_write_b32 a78, v226
    v_accvgpr_write_b32 a79, v227
    v_accvgpr_read_b32 v224, a92
    v_accvgpr_read_b32 v225, a93
    v_accvgpr_read_b32 v226, a94
    v_accvgpr_read_b32 v227, a95
    v_mul_f32 v224, v224, v55
    v_mul_f32 v225, v225, v55
    v_mul_f32 v226, v226, v55
    v_mul_f32 v227, v227, v55
    v_accvgpr_write_b32 a92, v224
    v_accvgpr_write_b32 a93, v225
    v_accvgpr_write_b32 a94, v226
    v_accvgpr_write_b32 a95, v227
    v_accvgpr_read_b32 v224, a108
    v_accvgpr_read_b32 v225, a109
    v_accvgpr_read_b32 v226, a110
    v_accvgpr_read_b32 v227, a111
    v_mul_f32 v224, v224, v55
    v_mul_f32 v225, v225, v55
    v_mul_f32 v226, v226, v55
    v_mul_f32 v227, v227, v55
    v_accvgpr_write_b32 a108, v224
    v_accvgpr_write_b32 a109, v225
    v_accvgpr_write_b32 a110, v226
    v_accvgpr_write_b32 a111, v227
    v_accvgpr_read_b32 v224, a124
    v_accvgpr_read_b32 v225, a125
    v_accvgpr_read_b32 v226, a126
    v_accvgpr_read_b32 v227, a127
    v_mul_f32 v224, v224, v55
    v_mul_f32 v225, v225, v55
    v_mul_f32 v226, v226, v55
    v_mul_f32 v227, v227, v55
    v_accvgpr_write_b32 a124, v224
    v_accvgpr_write_b32 a125, v225
    v_accvgpr_write_b32 a126, v226
    v_accvgpr_write_b32 a127, v227
    v_exp_f32 v232, v164
    v_exp_f32 v233, v165
    v_exp_f32 v234, v166
    v_exp_f32 v235, v167
    s_nop 0
    v_cvt_pk_bf16_f32 v212, v232, v233
    v_cvt_pk_bf16_f32 v213, v234, v235
    v_exp_f32 v232, v180
    v_exp_f32 v233, v181
    v_exp_f32 v234, v182
    v_exp_f32 v235, v183
    s_nop 0
    v_cvt_pk_bf16_f32 v214, v232, v233
    v_cvt_pk_bf16_f32 v215, v234, v235
    v_exp_f32 v232, v172
    v_exp_f32 v233, v173
    v_exp_f32 v234, v174
    v_exp_f32 v235, v175
    s_nop 0
    v_cvt_pk_bf16_f32 v220, v232, v233
    v_cvt_pk_bf16_f32 v221, v234, v235
    v_exp_f32 v232, v188
    v_exp_f32 v233, v189
    v_exp_f32 v234, v190
    v_exp_f32 v235, v191
    s_nop 0
    v_cvt_pk_bf16_f32 v222, v232, v233
    v_cvt_pk_bf16_f32 v223, v234, v235
    s_nop 3
    s_setpc_b64 s[40:41]
code_end:
    s_endpgm
.section .rodata,"a"
.p2align 6
.amdhsa_kernel sequential_preLN__compressed_kv_cla__moe_arch_mod__prompt_kernel
  .amdhsa_next_free_vgpr 512
  .amdhsa_next_free_sgpr 102
  .amdhsa_accum_offset 256
  .amdhsa_group_segment_fixed_size 0
  .amdhsa_kernarg_size 112
  .amdhsa_user_sgpr_count 2
  .amdhsa_user_sgpr_kernarg_segment_ptr 1
  .amdhsa_system_sgpr_workgroup_id_x 1
.end_amdhsa_kernel
```

```asm
; @launch grid=(256,1,1) block=(256,1,1) lds=163840
.amdgcn_target "amdgcn-amd-amdhsa--gfx950"
.text
.globl sequential_preLN__compressed_kv_cla__moe_arch_mod__prompt_kernel
.p2align 8
.type sequential_preLN__compressed_kv_cla__moe_arch_mod__prompt_kernel,@function
sequential_preLN__compressed_kv_cla__moe_arch_mod__prompt_kernel:
    s_cmp_ge_u32 s2, 256
    s_cbranch_scc1 k12_end_1
    s_load_dwordx4 s[36:39], s[0:1], 0
    s_load_dwordx4 s[40:43], s[0:1], 24
    s_load_dwordx2 s[4:5], s[0:1], 16
    s_load_dwordx4 s[60:63], s[0:1], 96
    s_lshr_b32 s59, s2, 3
    s_lshl_b32 s58, s59, 4
    v_add_u32 v6, s58, v0
    v_cmp_gt_u32 vcc, 48, v0
    v_cmp_gt_u32 s[56:57], 64, v0
    s_nop 0
    v_cndmask_b32 v6, v6, v0, vcc
    s_getpc_b64 s[52:53]
pc_2:
    s_add_u32 s52, s52, k12_code0-pc_2
    s_addc_u32 s53, s53, 0
    v_lshlrev_b32 v58, 7, v6
    v_mov_b32 v59, s53
    v_add_co_u32 v58, vcc, s52, v58
    s_nop 1
    v_addc_co_u32 v59, vcc, 0, v59, vcc
k12_code0:
    s_mov_b64 exec, s[56:57]
    s_cbranch_execz k12_nocode_3
    global_load_dword v51, v[58:59], off
k12_nocode_3:
    s_mov_b64 exec, -1
    s_and_b32 s58, s2, 7
    s_lshr_b32 s59, s2, 3
    s_and_b32 s45, s59, 7
    s_lshr_b32 s57, s59, 3
    s_and_b32 s44, s57, 1
    s_lshl_b32 s52, s58, 1
    s_add_u32 s44, s44, s52
    s_lshr_b32 s57, s57, 1
    v_lshrrev_b32 v2, 6, v0
    v_and_b32 v3, 63, v0
    v_readfirstlane_b32 s30, v2
    v_lshlrev_b32 v1, 4, v3
    v_lshrrev_b32 v60, 5, v3
    v_lshl_add_u32 v60, v2, 1, v60
    v_and_b32 v61, 31, v3
    v_lshlrev_b32 v6, 11, v60
    v_lshl_add_u32 v62, v61, 4, v6
    s_lshl_b32 s52, s2, 14
    v_lshrrev_b32 v56, 3, v3
    v_and_b32 v57, 7, v3
    v_lshrrev_b32 v58, 1, v56
    v_xor_b32 v6, v57, v58
    v_xor_b32 v7, 4, v6
    v_lshl_add_u32 v58, v2, 6, v56
    v_lshlrev_b32 v58, 10, v58
    s_lshl_b32 s47, s45, 18
    v_add_u32 v58, s47, v58
    v_lshl_add_u32 v10, v6, 4, v58
    v_lshl_add_u32 v11, v7, 4, v58
    v_add_u32 v17, 54272, v11
    v_add_u32 v16, 47104, v10
    v_add_u32 v15, 39936, v11
    v_add_u32 v14, 32768, v10
    v_add_u32 v13, 21504, v11
    v_add_u32 v12, 14336, v10
    v_add_u32 v11, 7168, v11
    v_add_u32 v10, 0, v10
    v_lshrrev_b32 v6, 5, v3
    v_bfe_u32 v7, v3, 1, 4
    v_and_b32 v59, 1, v3
    v_lshl_add_u32 v58, v2, 4, v6
    v_lshlrev_b32 v58, 13, v58
    v_lshl_add_u32 v58, v59, 4, v58
    s_lshl_b32 s47, s44, 9
    v_add_u32 v58, s47, v58
    v_xor_b32 v7, v7, v6
    v_xor_b32 v6, 0, v7
    v_lshl_add_u32 v6, v6, 5, v58
    v_add_u32 v18, 0, v6
    v_xor_b32 v6, 2, v7
    v_lshl_add_u32 v6, v6, 5, v58
    v_add_u32 v19, 15360, v6
    v_xor_b32 v6, 0, v7
    v_lshl_add_u32 v6, v6, 5, v58
    v_add_u32 v20, 30720, v6
    v_xor_b32 v6, 2, v7
    v_lshl_add_u32 v6, v6, 5, v58
    v_add_u32 v21, 46080, v6
    v_xor_b32 v6, 4, v7
    v_lshl_add_u32 v6, v6, 5, v58
    v_add_u32 v22, 65536, v6
    v_xor_b32 v6, 6, v7
    v_lshl_add_u32 v6, v6, 5, v58
    v_add_u32 v23, 80896, v6
    v_xor_b32 v6, 4, v7
    v_lshl_add_u32 v6, v6, 5, v58
    v_add_u32 v24, 96256, v6
    v_xor_b32 v6, 6, v7
    v_lshl_add_u32 v6, v6, 5, v58
    v_add_u32 v25, 111616, v6
    s_lshl_b32 s48, s30, 13
    s_mov_b32 s49, 0
    s_mov_b32 s50, 0
    s_waitcnt lgkmcnt(0)
    s_mov_b32 s24, s36
    s_and_b32 s25, s37, 0xffff
    s_mov_b32 s26, 0x400000
    s_mov_b32 s27, 0x00020000
    buffer_load_dwordx4 v[64:67], v62, s[24:27], s52 offen offset:0
    buffer_load_dwordx4 v[68:71], v62, s[24:27], s52 offen offset:512
    buffer_load_dwordx4 v[72:75], v62, s[24:27], s52 offen offset:1024
    buffer_load_dwordx4 v[76:79], v62, s[24:27], s52 offen offset:1536
    s_mov_b32 s16, s38
    s_and_b32 s17, s39, 0xffff
    s_mov_b32 s18, 0x200000
    s_mov_b32 s19, 0x00020000
    s_cmp_eq_u32 s57, 0
    s_cselect_b32 s20, s40, s42
    s_cselect_b32 s21, s41, s43
    s_and_b32 s21, s21, 0xffff
    s_mov_b32 s22, 0x400000
    s_mov_b32 s23, 0x00020000
    s_add_u32 m0, s48, 0
    s_nop 0
    buffer_load_dwordx4 v10, s[16:19], s49 offen offset:0 lds
    buffer_load_dwordx4 v11, s[16:19], s49 offen offset:1024 lds
    buffer_load_dwordx4 v12, s[16:19], s49 offen offset:2048 lds
    buffer_load_dwordx4 v13, s[16:19], s49 offen offset:3072 lds
    s_add_u32 m0, s48, 65536
    s_nop 0
    buffer_load_dwordx4 v18, s[20:23], s50 offen offset:0 lds
    buffer_load_dwordx4 v19, s[20:23], s50 offen offset:1024 lds
    buffer_load_dwordx4 v20, s[20:23], s50 offen offset:2048 lds
    buffer_load_dwordx4 v21, s[20:23], s50 offen offset:3072 lds
    s_mov_b64 s[6:7], s[62:63]
    s_add_u32 s8, s6, 0x0
    s_addc_u32 s9, s7, 0
    s_and_b32 s9, s9, 0xffff
    s_mov_b32 s10, 0x400000
    s_mov_b32 s11, 0x00020000
    s_mov_b32 s12, s4
    s_and_b32 s13, s5, 0xffff
    s_mov_b32 s14, 0x800000
    s_mov_b32 s15, 0x00020000
    s_add_u32 s32, s6, 0x1000000
    s_addc_u32 s33, s7, 0
    s_and_b32 s33, s33, 0xffff
    s_mov_b32 s34, 0x2000000
    s_mov_b32 s35, 0x00020000
    s_mov_b32 s24, s60
    s_and_b32 s25, s61, 0xffff
    s_mov_b32 s26, 0x100
    s_mov_b32 s27, 0x00020000
    s_lshl_b32 s28, s58, 2
    s_and_b32 s31, s59, 3
    s_add_u32 s28, s28, s31
    s_lshr_b32 s29, s59, 2
    s_lshl_b32 s42, s29, 7
    s_sub_u32 s43, 1920, s42
    s_lshl_b32 s31, s30, 4
    s_add_u32 s38, s42, s31
    s_add_u32 s39, s43, s31
    s_lshl_b32 s60, s30, 12
    s_mov_b32 s61, 0
    s_mov_b32 s62, 0
    s_lshl_b32 s47, s44, 1
    s_lshr_b32 s52, s30, 1
    s_add_u32 s47, s47, s52
    s_lshl_b32 s47, s47, 14
    s_lshl_b32 s52, s45, 1
    s_and_b32 s53, s30, 1
    s_add_u32 s52, s52, s53
    s_lshl_b32 s52, s52, 20
    s_add_u32 s47, s47, s52
    s_lshl_b32 s52, s57, 24
    s_add_u32 s47, s47, s52
    s_lshl_b32 s54, s44, 8
    s_lshr_b32 s55, s28, 1
    s_lshl_b32 s55, s55, 8
    s_and_b32 s53, s59, 3
    s_add_u32 s53, s53, 1
    s_cmp_eq_u32 s30, 0
    s_cselect_b32 s53, s53, -1
    s_cselect_b32 s46, 6, -1
    v_lshlrev_b32 v6, 13, v56
    v_lshl_add_u32 v50, v57, 7, v6
    s_lshl_b32 s56, s30, 5
    s_add_u32 s56, s56, s59
    s_lshl_b32 s56, s56, 16
    s_lshl_b32 s52, s58, 10
    s_add_u32 s56, s56, s52
    s_add_u32 s63, s30, 1
    v_mul_u32_u24 v6, 2064, v60
    v_lshl_add_u32 v6, v61, 4, v6
    v_add_u32 v54, 131072, v6
    v_mul_u32_u24 v7, 2064, v57
    v_lshl_add_u32 v7, v56, 4, v7
    v_lshl_add_u32 v7, v2, 9, v7
    v_add_u32 v55, 131072, v7
    v_lshrrev_b32 v7, 2, v56
    v_lshl_add_u32 v7, v2, 3, v7
    v_lshlrev_b32 v7, 17, v7
    v_and_b32 v6, 3, v56
    v_lshl_add_u32 v7, v6, 8, v7
    v_lshl_add_u32 v7, v57, 4, v7
    s_lshr_b32 s52, s2, 1
    s_lshl_b32 s52, s52, 10
    s_and_b32 s31, s2, 1
    s_lshl_b32 s31, s31, 7
    s_add_u32 s52, s52, s31
    v_add_u32 v53, s52, v7
    v_and_b32 v56, 15, v3
    v_lshrrev_b32 v57, 4, v3
    v_lshrrev_b32 v6, 1, v56
    v_xor_b32 v6, v6, v57
    v_and_b32 v7, 1, v2
    v_lshl_add_u32 v7, v7, 7, v56
    v_lshlrev_b32 v7, 7, v7
    v_lshl_add_u32 v26, v6, 4, v7
    v_xor_b32 v27, 64, v26
    v_lshrrev_b32 v6, 2, v56
    v_and_b32 v58, 1, v57
    v_lshl_add_u32 v58, v58, 2, v6
    v_lshl_add_u32 v59, v57, 3, v6
    v_and_b32 v63, 3, v3
    v_lshlrev_b32 v7, 9, v59
    v_lshrrev_b32 v6, 1, v2
    v_lshl_add_u32 v7, v6, 8, v7
    v_lshl_add_u32 v7, v63, 3, v7
    v_add_u32 v7, 65536, v7
    v_lshlrev_b32 v59, 8, v59
    v_lshl_add_u32 v59, v63, 3, v59
    v_add_u32 v59, 98304, v59
    v_xor_b32 v6, 0, v58
    v_lshl_add_u32 v28, v6, 5, v7
    v_lshl_add_u32 v42, v6, 5, v59
    v_xor_b32 v6, 1, v58
    v_lshl_add_u32 v29, v6, 5, v7
    v_lshl_add_u32 v43, v6, 5, v59
    v_xor_b32 v6, 2, v58
    v_lshl_add_u32 v30, v6, 5, v7
    v_lshl_add_u32 v44, v6, 5, v59
    v_xor_b32 v6, 3, v58
    v_lshl_add_u32 v31, v6, 5, v7
    v_lshl_add_u32 v45, v6, 5, v59
    v_xor_b32 v6, 4, v58
    v_lshl_add_u32 v32, v6, 5, v7
    v_lshl_add_u32 v46, v6, 5, v59
    v_xor_b32 v6, 5, v58
    v_lshl_add_u32 v33, v6, 5, v7
    v_lshl_add_u32 v47, v6, 5, v59
    v_xor_b32 v6, 6, v58
    v_lshl_add_u32 v34, v6, 5, v7
    v_lshl_add_u32 v48, v6, 5, v59
    v_xor_b32 v6, 7, v58
    v_lshl_add_u32 v35, v6, 5, v7
    v_lshl_add_u32 v49, v6, 5, v59
    s_lshl_b32 s31, s38, 6
    v_add_u32 v36, s31, v1
    s_lshl_b32 s31, s39, 6
    v_add_u32 v37, s31, v1
    v_bfe_u32 v6, v3, 1, 3
    v_and_b32 v7, 1, v3
    v_lshl_add_u32 v58, v2, 4, v57
    v_lshlrev_b32 v58, 13, v58
    v_lshl_add_u32 v58, v7, 4, v58
    s_lshl_b32 s31, s28, 8
    v_add_u32 v58, s31, v58
    v_xor_b32 v6, v6, v57
    v_xor_b32 v7, 0, v6
    v_lshl_add_u32 v7, v7, 5, v58
    v_add_u32 v38, 0, v7
    v_xor_b32 v7, 0, v6
    v_lshl_add_u32 v7, v7, 5, v58
    v_add_u32 v39, 31744, v7
    v_xor_b32 v7, 4, v6
    v_lshl_add_u32 v7, v7, 5, v58
    v_add_u32 v40, 63488, v7
    v_xor_b32 v7, 4, v6
    v_lshl_add_u32 v7, v7, 5, v58
    v_add_u32 v41, 95232, v7
    v_lshlrev_b32 v6, 2, v57
    v_sub_u32 v4, v56, v6
    v_mov_b32 v5, 0xff800000
    v_mov_b32 v8, 0
    v_mov_b32 v9, 1
    s_lshl_b32 s52, s59, 2
    s_add_u32 s52, s52, s30
    v_and_b32 v6, 1, v3
    v_lshl_add_u32 v6, s52, 1, v6
    s_getpc_b64 s[40:41]
pc_4:
    s_add_u32 s40, s40, k12_qcode-pc_4
    s_addc_u32 s41, s41, 0
    v_lshlrev_b32 v2, 7, v6
    v_mov_b32 v3, s41
    v_add_co_u32 v2, vcc, s40, v2
    s_nop 1
    v_addc_co_u32 v3, vcc, 0, v3, vcc
    v_mov_b32 v56, 0
    v_mov_b32 v57, 0
    v_mov_b32 v58, 0
    v_mov_b32 v59, 0
    s_nop 1
    v_mfma_f32_32x32x16_bf16 a[128:143], v[56:59], v[56:59], 0
    v_mfma_f32_32x32x16_bf16 a[144:159], v[56:59], v[56:59], 0
    v_mfma_f32_32x32x16_bf16 a[160:175], v[56:59], v[56:59], 0
    v_mfma_f32_32x32x16_bf16 a[176:191], v[56:59], v[56:59], 0
    v_mfma_f32_32x32x16_bf16 v[128:143], v[56:59], v[56:59], 0
    v_mfma_f32_32x32x16_bf16 v[144:159], v[56:59], v[56:59], 0
    v_mfma_f32_32x32x16_bf16 v[160:175], v[56:59], v[56:59], 0
    v_mfma_f32_32x32x16_bf16 v[176:191], v[56:59], v[56:59], 0
    v_mfma_f32_32x32x16_bf16 v[192:207], v[56:59], v[56:59], 0
    v_mfma_f32_32x32x16_bf16 v[208:223], v[56:59], v[56:59], 0
    v_mfma_f32_32x32x16_bf16 v[224:239], v[56:59], v[56:59], 0
    v_mfma_f32_32x32x16_bf16 v[240:255], v[56:59], v[56:59], 0
    s_add_u32 m0, s48, 4096
    s_nop 0
    buffer_load_dwordx4 v14, s[16:19], s49 offen offset:0 lds
    buffer_load_dwordx4 v15, s[16:19], s49 offen offset:1024 lds
    buffer_load_dwordx4 v16, s[16:19], s49 offen offset:2048 lds
    buffer_load_dwordx4 v17, s[16:19], s49 offen offset:3072 lds
    s_add_u32 s49, s49, 128
    s_add_u32 m0, s48, 69632
    s_nop 0
    buffer_load_dwordx4 v22, s[20:23], s50 offen offset:0 lds
    buffer_load_dwordx4 v23, s[20:23], s50 offen offset:1024 lds
    buffer_load_dwordx4 v24, s[20:23], s50 offen offset:2048 lds
    buffer_load_dwordx4 v25, s[20:23], s50 offen offset:3072 lds
    s_add_u32 s50, s50, 0x80000
    s_waitcnt vmcnt(16)
    v_lshlrev_b32 v80, 16, v64
    v_and_b32 v81, 0xffff0000, v64
    v_lshlrev_b32 v82, 16, v65
    v_and_b32 v83, 0xffff0000, v65
    v_lshlrev_b32 v84, 16, v66
    v_and_b32 v85, 0xffff0000, v66
    v_lshlrev_b32 v86, 16, v67
    v_and_b32 v87, 0xffff0000, v67
    v_lshlrev_b32 v88, 16, v68
    v_and_b32 v89, 0xffff0000, v68
    v_lshlrev_b32 v90, 16, v69
    v_and_b32 v91, 0xffff0000, v69
    v_lshlrev_b32 v92, 16, v70
    v_and_b32 v93, 0xffff0000, v70
    v_lshlrev_b32 v94, 16, v71
    v_and_b32 v95, 0xffff0000, v71
    v_lshlrev_b32 v96, 16, v72
    v_and_b32 v97, 0xffff0000, v72
    v_lshlrev_b32 v98, 16, v73
    v_and_b32 v99, 0xffff0000, v73
    v_lshlrev_b32 v100, 16, v74
    v_and_b32 v101, 0xffff0000, v74
    v_lshlrev_b32 v102, 16, v75
    v_and_b32 v103, 0xffff0000, v75
    v_lshlrev_b32 v104, 16, v76
    v_and_b32 v105, 0xffff0000, v76
    v_lshlrev_b32 v106, 16, v77
    v_and_b32 v107, 0xffff0000, v77
    v_lshlrev_b32 v108, 16, v78
    v_and_b32 v109, 0xffff0000, v78
    v_lshlrev_b32 v110, 16, v79
    v_and_b32 v111, 0xffff0000, v79
    v_pk_add_f32 v[112:113], v[80:81], v[82:83]
    v_pk_add_f32 v[114:115], v[84:85], v[86:87]
    v_pk_add_f32 v[112:113], v[112:113], v[88:89]
    v_pk_add_f32 v[114:115], v[114:115], v[90:91]
    v_pk_add_f32 v[112:113], v[112:113], v[92:93]
    v_pk_add_f32 v[114:115], v[114:115], v[94:95]
    v_pk_add_f32 v[112:113], v[112:113], v[96:97]
    v_pk_add_f32 v[114:115], v[114:115], v[98:99]
    v_pk_add_f32 v[112:113], v[112:113], v[100:101]
    v_pk_add_f32 v[114:115], v[114:115], v[102:103]
    v_pk_add_f32 v[112:113], v[112:113], v[104:105]
    v_pk_add_f32 v[114:115], v[114:115], v[106:107]
    s_add_u32 m0, s48, 32768
    s_nop 0
    buffer_load_dwordx4 v10, s[16:19], s49 offen offset:0 lds
    buffer_load_dwordx4 v11, s[16:19], s49 offen offset:1024 lds
    buffer_load_dwordx4 v12, s[16:19], s49 offen offset:2048 lds
    buffer_load_dwordx4 v13, s[16:19], s49 offen offset:3072 lds
    v_pk_add_f32 v[112:113], v[112:113], v[108:109]
    v_pk_add_f32 v[114:115], v[114:115], v[110:111]
    v_pk_add_f32 v[112:113], v[112:113], v[114:115]
    v_add_f32 v112, v112, v113
    s_nop 1
    v_add_f32_dpp v112, v112, v112 quad_perm:[1,0,3,2] row_mask:0xf bank_mask:0xf
    s_nop 1
    v_add_f32_dpp v112, v112, v112 quad_perm:[2,3,0,1] row_mask:0xf bank_mask:0xf
    s_nop 1
    v_add_f32_dpp v112, v112, v112 row_half_mirror row_mask:0xf bank_mask:0xf
    s_nop 1
    v_add_f32_dpp v112, v112, v112 row_mirror row_mask:0xf bank_mask:0xf
    v_mov_b32 v114, v112
    s_nop 1
    v_permlane16_swap_b32 v112, v114
    s_nop 1
    v_add_f32 v112, v112, v114
    v_mul_f32 v112, 0xba800000, v112
    v_mov_b32 v113, v112
    v_pk_add_f32 v[114:115], v[80:81], v[112:113]
    v_pk_add_f32 v[118:119], v[82:83], v[112:113]
    v_pk_mul_f32 v[116:117], v[114:115], v[114:115]
    v_pk_fma_f32 v[116:117], v[118:119], v[118:119], v[116:117]
    v_pk_add_f32 v[114:115], v[84:85], v[112:113]
    v_pk_add_f32 v[118:119], v[86:87], v[112:113]
    v_pk_fma_f32 v[116:117], v[114:115], v[114:115], v[116:117]
    v_pk_fma_f32 v[116:117], v[118:119], v[118:119], v[116:117]
    v_pk_add_f32 v[114:115], v[88:89], v[112:113]
    v_pk_add_f32 v[118:119], v[90:91], v[112:113]
    v_pk_fma_f32 v[116:117], v[114:115], v[114:115], v[116:117]
    v_pk_fma_f32 v[116:117], v[118:119], v[118:119], v[116:117]
    v_pk_add_f32 v[114:115], v[92:93], v[112:113]
    v_pk_add_f32 v[118:119], v[94:95], v[112:113]
    v_pk_fma_f32 v[116:117], v[114:115], v[114:115], v[116:117]
    v_pk_fma_f32 v[116:117], v[118:119], v[118:119], v[116:117]
    v_pk_add_f32 v[114:115], v[96:97], v[112:113]
    v_pk_add_f32 v[118:119], v[98:99], v[112:113]
    v_pk_fma_f32 v[116:117], v[114:115], v[114:115], v[116:117]
    v_pk_fma_f32 v[116:117], v[118:119], v[118:119], v[116:117]
    v_pk_add_f32 v[114:115], v[100:101], v[112:113]
    v_pk_add_f32 v[118:119], v[102:103], v[112:113]
    v_pk_fma_f32 v[116:117], v[114:115], v[114:115], v[116:117]
    v_pk_fma_f32 v[116:117], v[118:119], v[118:119], v[116:117]
    v_pk_add_f32 v[114:115], v[104:105], v[112:113]
    s_add_u32 m0, s48, 98304
    s_nop 0
    buffer_load_dwordx4 v18, s[20:23], s50 offen offset:0 lds
    buffer_load_dwordx4 v19, s[20:23], s50 offen offset:1024 lds
    buffer_load_dwordx4 v20, s[20:23], s50 offen offset:2048 lds
    buffer_load_dwordx4 v21, s[20:23], s50 offen offset:3072 lds
    v_pk_add_f32 v[118:119], v[106:107], v[112:113]
    v_pk_fma_f32 v[116:117], v[114:115], v[114:115], v[116:117]
    v_pk_fma_f32 v[116:117], v[118:119], v[118:119], v[116:117]
    v_pk_add_f32 v[114:115], v[108:109], v[112:113]
    v_pk_add_f32 v[118:119], v[110:111], v[112:113]
    v_pk_fma_f32 v[116:117], v[114:115], v[114:115], v[116:117]
    v_pk_fma_f32 v[116:117], v[118:119], v[118:119], v[116:117]
    v_add_f32 v116, v116, v117
    s_nop 1
    v_add_f32_dpp v116, v116, v116 quad_perm:[1,0,3,2] row_mask:0xf bank_mask:0xf
    s_nop 1
    v_add_f32_dpp v116, v116, v116 quad_perm:[2,3,0,1] row_mask:0xf bank_mask:0xf
    s_nop 1
    v_add_f32_dpp v116, v116, v116 row_half_mirror row_mask:0xf bank_mask:0xf
    s_nop 1
    v_add_f32_dpp v116, v116, v116 row_mirror row_mask:0xf bank_mask:0xf
    v_mov_b32 v114, v116
    s_nop 1
    v_permlane16_swap_b32 v116, v114
    s_nop 1
    v_add_f32 v116, v116, v114
    v_mul_f32 v116, 0x3a800000, v116
    v_cvt_pk_bf16_f32 v118, v112, v116
    v_and_b32 v116, 0xffff0000, v118
    v_lshlrev_b32 v118, 16, v118
    v_add_f32 v116, 0x3727c5ac, v116
    v_mov_b32 v119, v118
    v_cvt_pk_bf16_f32 v116, v116, v116
    v_and_b32 v116, 0xffff0000, v116
    v_sqrt_f32 v116, v116
    v_pk_add_f32 v[80:81], v[80:81], v[118:119]
    v_pk_add_f32 v[82:83], v[82:83], v[118:119]
    v_pk_add_f32 v[84:85], v[84:85], v[118:119]
    v_pk_add_f32 v[86:87], v[86:87], v[118:119]
    v_pk_add_f32 v[88:89], v[88:89], v[118:119]
    v_pk_add_f32 v[90:91], v[90:91], v[118:119]
    v_pk_add_f32 v[92:93], v[92:93], v[118:119]
    v_pk_add_f32 v[94:95], v[94:95], v[118:119]
    v_pk_add_f32 v[96:97], v[96:97], v[118:119]
    v_pk_add_f32 v[98:99], v[98:99], v[118:119]
    v_pk_add_f32 v[100:101], v[100:101], v[118:119]
    v_pk_add_f32 v[102:103], v[102:103], v[118:119]
    v_pk_add_f32 v[104:105], v[104:105], v[118:119]
    s_add_u32 m0, s48, 36864
    s_nop 0
    buffer_load_dwordx4 v14, s[16:19], s49 offen offset:0 lds
    buffer_load_dwordx4 v15, s[16:19], s49 offen offset:1024 lds
    buffer_load_dwordx4 v16, s[16:19], s49 offen offset:2048 lds
    buffer_load_dwordx4 v17, s[16:19], s49 offen offset:3072 lds
    s_add_u32 s49, s49, 128
    v_pk_add_f32 v[106:107], v[106:107], v[118:119]
    v_pk_add_f32 v[108:109], v[108:109], v[118:119]
    v_pk_add_f32 v[110:111], v[110:111], v[118:119]
    v_cvt_pk_bf16_f32 v116, v116, v116
    v_and_b32 v116, 0xffff0000, v116
    v_rcp_f32 v116, v116
    v_cvt_pk_bf16_f32 v64, v80, v81
    v_cvt_pk_bf16_f32 v65, v82, v83
    v_cvt_pk_bf16_f32 v66, v84, v85
    v_cvt_pk_bf16_f32 v67, v86, v87
    v_cvt_pk_bf16_f32 v68, v88, v89
    v_cvt_pk_bf16_f32 v69, v90, v91
    v_cvt_pk_bf16_f32 v70, v92, v93
    v_cvt_pk_bf16_f32 v71, v94, v95
    v_cvt_pk_bf16_f32 v72, v96, v97
    v_cvt_pk_bf16_f32 v73, v98, v99
    v_cvt_pk_bf16_f32 v74, v100, v101
    v_cvt_pk_bf16_f32 v75, v102, v103
    v_cvt_pk_bf16_f32 v76, v104, v105
    v_cvt_pk_bf16_f32 v77, v106, v107
    v_cvt_pk_bf16_f32 v78, v108, v109
    v_cvt_pk_bf16_f32 v79, v110, v111
    v_mov_b32 v117, v116
    v_lshlrev_b32 v80, 16, v64
    v_and_b32 v81, 0xffff0000, v64
    v_lshlrev_b32 v82, 16, v65
    v_and_b32 v83, 0xffff0000, v65
    v_lshlrev_b32 v84, 16, v66
    v_and_b32 v85, 0xffff0000, v66
    v_lshlrev_b32 v86, 16, v67
    v_and_b32 v87, 0xffff0000, v67
    v_lshlrev_b32 v88, 16, v68
    v_and_b32 v89, 0xffff0000, v68
    v_lshlrev_b32 v90, 16, v69
    v_and_b32 v91, 0xffff0000, v69
    v_lshlrev_b32 v92, 16, v70
    v_and_b32 v93, 0xffff0000, v70
    v_lshlrev_b32 v94, 16, v71
    v_and_b32 v95, 0xffff0000, v71
    v_lshlrev_b32 v96, 16, v72
    v_and_b32 v97, 0xffff0000, v72
    v_lshlrev_b32 v98, 16, v73
    v_and_b32 v99, 0xffff0000, v73
    v_lshlrev_b32 v100, 16, v74
    s_add_u32 m0, s48, 102400
    s_nop 0
    buffer_load_dwordx4 v22, s[20:23], s50 offen offset:0 lds
    buffer_load_dwordx4 v23, s[20:23], s50 offen offset:1024 lds
    buffer_load_dwordx4 v24, s[20:23], s50 offen offset:2048 lds
    buffer_load_dwordx4 v25, s[20:23], s50 offen offset:3072 lds
    s_add_u32 s50, s50, 0x80000
    v_and_b32 v101, 0xffff0000, v74
    v_lshlrev_b32 v102, 16, v75
    v_and_b32 v103, 0xffff0000, v75
    v_lshlrev_b32 v104, 16, v76
    v_and_b32 v105, 0xffff0000, v76
    v_lshlrev_b32 v106, 16, v77
    v_and_b32 v107, 0xffff0000, v77
    v_lshlrev_b32 v108, 16, v78
    v_and_b32 v109, 0xffff0000, v78
    v_lshlrev_b32 v110, 16, v79
    v_and_b32 v111, 0xffff0000, v79
    v_pk_mul_f32 v[80:81], v[80:81], v[116:117]
    v_pk_mul_f32 v[82:83], v[82:83], v[116:117]
    v_pk_mul_f32 v[84:85], v[84:85], v[116:117]
    v_pk_mul_f32 v[86:87], v[86:87], v[116:117]
    v_pk_mul_f32 v[88:89], v[88:89], v[116:117]
    v_pk_mul_f32 v[90:91], v[90:91], v[116:117]
    v_pk_mul_f32 v[92:93], v[92:93], v[116:117]
    v_pk_mul_f32 v[94:95], v[94:95], v[116:117]
    v_pk_mul_f32 v[96:97], v[96:97], v[116:117]
    v_pk_mul_f32 v[98:99], v[98:99], v[116:117]
    v_pk_mul_f32 v[100:101], v[100:101], v[116:117]
    v_pk_mul_f32 v[102:103], v[102:103], v[116:117]
    v_pk_mul_f32 v[104:105], v[104:105], v[116:117]
    v_pk_mul_f32 v[106:107], v[106:107], v[116:117]
    v_pk_mul_f32 v[108:109], v[108:109], v[116:117]
    v_pk_mul_f32 v[110:111], v[110:111], v[116:117]
    v_cvt_pk_bf16_f32 v64, v80, v81
    v_cvt_pk_bf16_f32 v65, v82, v83
    v_cvt_pk_bf16_f32 v66, v84, v85
    v_cvt_pk_bf16_f32 v67, v86, v87
    v_cvt_pk_bf16_f32 v68, v88, v89
    v_cvt_pk_bf16_f32 v69, v90, v91
    v_cvt_pk_bf16_f32 v70, v92, v93
    v_cvt_pk_bf16_f32 v71, v94, v95
    v_cvt_pk_bf16_f32 v72, v96, v97
    v_cvt_pk_bf16_f32 v73, v98, v99
    v_cvt_pk_bf16_f32 v74, v100, v101
    v_cvt_pk_bf16_f32 v75, v102, v103
    v_cvt_pk_bf16_f32 v76, v104, v105
    v_cvt_pk_bf16_f32 v77, v106, v107
    v_cvt_pk_bf16_f32 v78, v108, v109
    v_cvt_pk_bf16_f32 v79, v110, v111
    ds_write_b128 v54, v[64:67] offset:0
    ds_write_b128 v54, v[68:71] offset:512
    ds_write_b128 v54, v[72:75] offset:1024
    ds_write_b128 v54, v[76:79] offset:1536
    s_waitcnt vmcnt(16) lgkmcnt(0)
    s_barrier
    ds_read_b128 a[64:67], v55 offset:0
    ds_read_b128 a[68:71], v55 offset:128
    ds_read_b128 a[72:75], v55 offset:256
    ds_read_b128 a[76:79], v55 offset:384
    v_add_u32 v54, 4096, v36
    v_add_u32 v55, 4096, v37
    v_mfma_f32_32x32x16_bf16 v[64:79], v[56:59], v[56:59], 0
    v_mfma_f32_32x32x16_bf16 v[80:95], v[56:59], v[56:59], 0
    v_mfma_f32_32x32x16_bf16 v[96:111], v[56:59], v[56:59], 0
    v_mfma_f32_32x32x16_bf16 v[112:127], v[56:59], v[56:59], 0
    s_cmp_ge_u32 s2, 22
    s_cbranch_scc1 k12_nostat_5
    s_lshl_b32 s52, s2, 12
    s_add_u32 s52, s52, 0x3800000
    s_mov_b32 s34, -1
    v_lshlrev_b32 v6, 4, v0
    buffer_store_dwordx4 v[56:59], v6, s[32:35], s52 offen sc1
    s_mov_b32 s34, 0x2000000
k12_nostat_5:
    ds_read_b128 a[192:195], v26 offset:0
    ds_read_b64_tr_b16 a[0:1], v28 offset:0
    ds_read_b128 a[196:199], v27 offset:0
    ds_read_b64_tr_b16 a[2:3], v28 offset:2048
    ds_read_b128 a[200:203], v26 offset:2048
    ds_read_b64_tr_b16 a[4:5], v28 offset:16384
    ds_read_b128 a[204:207], v27 offset:2048
    ds_read_b64_tr_b16 a[6:7], v28 offset:18432
    ds_read_b128 a[208:211], v26 offset:4096
    ds_read_b64_tr_b16 a[8:9], v29 offset:0
    ds_read_b128 a[212:215], v27 offset:4096
    ds_read_b64_tr_b16 a[10:11], v29 offset:2048
    ds_read_b128 a[216:219], v26 offset:6144
    ds_read_b64_tr_b16 a[12:13], v29 offset:16384
    ds_read_b128 a[220:223], v27 offset:6144
    ds_read_b64_tr_b16 a[14:15], v29 offset:18432
    ds_read_b128 a[224:227], v26 offset:8192
    ds_read_b64_tr_b16 a[16:17], v30 offset:0
    ds_read_b128 a[228:231], v27 offset:8192
    ds_read_b64_tr_b16 a[18:19], v30 offset:2048
    ds_read_b128 a[232:235], v26 offset:10240
    ds_read_b64_tr_b16 a[20:21], v30 offset:16384
    ds_read_b128 a[236:239], v27 offset:10240
    ds_read_b64_tr_b16 a[22:23], v30 offset:18432
    ds_read_b128 a[240:243], v26 offset:12288
    ds_read_b64_tr_b16 a[24:25], v31 offset:0
    ds_read_b128 a[244:247], v27 offset:12288
    ds_read_b64_tr_b16 a[26:27], v31 offset:2048
    ds_read_b128 a[248:251], v26 offset:14336
    ds_read_b64_tr_b16 a[28:29], v31 offset:16384
    ds_read_b128 a[252:255], v27 offset:14336
    ds_read_b64_tr_b16 a[30:31], v31 offset:18432
    s_mov_b32 s51, 0
    s_waitcnt lgkmcnt(15)
    s_mov_b32 s52, 0
    buffer_store_dwordx4 a[64:67], v53, s[8:11], s52 offen sc1
    s_mov_b32 s52, 262144
    buffer_store_dwordx4 a[68:71], v53, s[8:11], s52 offen sc1
    s_mov_b32 s52, 524288
    buffer_store_dwordx4 a[72:75], v53, s[8:11], s52 offen sc1
    s_mov_b32 s52, 786432
    buffer_store_dwordx4 a[76:79], v53, s[8:11], s52 offen sc1
    s_waitcnt lgkmcnt(0)
    s_cmp_lg_u32 s57, 0
    s_cbranch_scc1 k12_v_6
k12_loop_8:
    v_mfma_f32_16x16x32_bf16 v[64:67], a[0:3], a[192:195], v[64:67]
    v_mfma_f32_16x16x32_bf16 v[64:67], a[4:7], a[196:199], v[64:67]
    ds_read_b64_tr_b16 a[32:33], v32 offset:0
    v_mfma_f32_16x16x32_bf16 v[80:83], a[4:7], a[204:207], v[80:83]
    v_mfma_f32_16x16x32_bf16 v[80:83], a[0:3], a[200:203], v[80:83]
    ds_read_b64_tr_b16 a[34:35], v32 offset:2048
    v_mfma_f32_16x16x32_bf16 v[96:99], a[0:3], a[208:211], v[96:99]
    s_cmp_eq_u32 s51, s46
    s_cbranch_scc1 k12_ool_10
k12_oolret_11:
    v_mfma_f32_16x16x32_bf16 v[96:99], a[4:7], a[212:215], v[96:99]
    v_mfma_f32_16x16x32_bf16 v[112:115], a[4:7], a[220:223], v[112:115]
    ds_read_b64_tr_b16 a[36:37], v32 offset:16384
    v_mfma_f32_16x16x32_bf16 v[112:115], a[0:3], a[216:219], v[112:115]
    v_mfma_f32_16x16x32_bf16 v[128:131], a[0:3], a[224:227], v[128:131]
    v_mfma_f32_16x16x32_bf16 v[128:131], a[4:7], a[228:231], v[128:131]
    ds_read_b64_tr_b16 a[38:39], v32 offset:18432
    v_mfma_f32_16x16x32_bf16 v[144:147], a[4:7], a[236:239], v[144:147]
    v_mfma_f32_16x16x32_bf16 v[144:147], a[0:3], a[232:235], v[144:147]
    v_mfma_f32_16x16x32_bf16 a[128:131], a[0:3], a[240:243], a[128:131]
    ds_read_b64_tr_b16 a[40:41], v33 offset:0
    v_mfma_f32_16x16x32_bf16 a[128:131], a[4:7], a[244:247], a[128:131]
    v_mfma_f32_16x16x32_bf16 a[160:163], a[4:7], a[252:255], a[160:163]
    v_mfma_f32_16x16x32_bf16 a[160:163], a[0:3], a[248:251], a[160:163]
    ds_read_b64_tr_b16 a[42:43], v33 offset:2048
    v_mfma_f32_16x16x32_bf16 a[164:167], a[8:11], a[248:251], a[164:167]
    v_mfma_f32_16x16x32_bf16 a[164:167], a[12:15], a[252:255], a[164:167]
    v_mfma_f32_16x16x32_bf16 a[132:135], a[12:15], a[244:247], a[132:135]
    ds_read_b64_tr_b16 a[44:45], v33 offset:16384
    v_mfma_f32_16x16x32_bf16 a[132:135], a[8:11], a[240:243], a[132:135]
    v_mfma_f32_16x16x32_bf16 v[240:243], a[8:11], a[232:235], v[240:243]
    v_mfma_f32_16x16x32_bf16 v[240:243], a[12:15], a[236:239], v[240:243]
    ds_read_b64_tr_b16 a[46:47], v33 offset:18432
    v_mfma_f32_16x16x32_bf16 v[224:227], a[12:15], a[228:231], v[224:227]
    v_mfma_f32_16x16x32_bf16 v[224:227], a[8:11], a[224:227], v[224:227]
    ds_read_b64_tr_b16 a[48:49], v34 offset:0
    v_mfma_f32_16x16x32_bf16 v[208:211], a[8:11], a[216:219], v[208:211]
    v_mfma_f32_16x16x32_bf16 v[208:211], a[12:15], a[220:223], v[208:211]
    v_mfma_f32_16x16x32_bf16 v[192:195], a[12:15], a[212:215], v[192:195]
    ds_read_b64_tr_b16 a[50:51], v34 offset:2048
    v_mfma_f32_16x16x32_bf16 v[192:195], a[8:11], a[208:211], v[192:195]
    v_mfma_f32_16x16x32_bf16 v[176:179], a[8:11], a[200:203], v[176:179]
    v_mfma_f32_16x16x32_bf16 v[176:179], a[12:15], a[204:207], v[176:179]
    ds_read_b64_tr_b16 a[52:53], v34 offset:16384
    v_mfma_f32_16x16x32_bf16 v[160:163], a[12:15], a[196:199], v[160:163]
    v_mfma_f32_16x16x32_bf16 v[160:163], a[8:11], a[192:195], v[160:163]
    v_mfma_f32_16x16x32_bf16 v[68:71], a[16:19], a[192:195], v[68:71]
    ds_read_b64_tr_b16 a[54:55], v34 offset:18432
    v_mfma_f32_16x16x32_bf16 v[68:71], a[20:23], a[196:199], v[68:71]
    v_mfma_f32_16x16x32_bf16 v[84:87], a[20:23], a[204:207], v[84:87]
    v_mfma_f32_16x16x32_bf16 v[84:87], a[16:19], a[200:203], v[84:87]
    ds_read_b64_tr_b16 a[56:57], v35 offset:0
    v_mfma_f32_16x16x32_bf16 v[100:103], a[16:19], a[208:211], v[100:103]
    v_mfma_f32_16x16x32_bf16 v[100:103], a[20:23], a[212:215], v[100:103]
    v_mfma_f32_16x16x32_bf16 v[116:119], a[20:23], a[220:223], v[116:119]
    ds_read_b64_tr_b16 a[58:59], v35 offset:2048
    v_mfma_f32_16x16x32_bf16 v[116:119], a[16:19], a[216:219], v[116:119]
    v_mfma_f32_16x16x32_bf16 v[132:135], a[16:19], a[224:227], v[132:135]
    v_mfma_f32_16x16x32_bf16 v[132:135], a[20:23], a[228:231], v[132:135]
    ds_read_b64_tr_b16 a[60:61], v35 offset:16384
    v_mfma_f32_16x16x32_bf16 v[148:151], a[20:23], a[236:239], v[148:151]
    v_mfma_f32_16x16x32_bf16 v[148:151], a[16:19], a[232:235], v[148:151]
    v_mfma_f32_16x16x32_bf16 a[136:139], a[16:19], a[240:243], a[136:139]
    ds_read_b64_tr_b16 a[62:63], v35 offset:18432
    v_mfma_f32_16x16x32_bf16 a[136:139], a[20:23], a[244:247], a[136:139]
    v_mfma_f32_16x16x32_bf16 a[168:171], a[20:23], a[252:255], a[168:171]
    v_mfma_f32_16x16x32_bf16 a[168:171], a[16:19], a[248:251], a[168:171]
    v_mfma_f32_16x16x32_bf16 a[172:175], a[24:27], a[248:251], a[172:175]
    v_mfma_f32_16x16x32_bf16 a[172:175], a[28:31], a[252:255], a[172:175]
    v_mfma_f32_16x16x32_bf16 a[140:143], a[28:31], a[244:247], a[140:143]
    v_mfma_f32_16x16x32_bf16 a[140:143], a[24:27], a[240:243], a[140:143]
    v_mfma_f32_16x16x32_bf16 v[244:247], a[24:27], a[232:235], v[244:247]
    v_mfma_f32_16x16x32_bf16 v[244:247], a[28:31], a[236:239], v[244:247]
    v_mfma_f32_16x16x32_bf16 v[228:231], a[28:31], a[228:231], v[228:231]
    v_mfma_f32_16x16x32_bf16 v[228:231], a[24:27], a[224:227], v[228:231]
    v_mfma_f32_16x16x32_bf16 v[212:215], a[24:27], a[216:219], v[212:215]
    v_mfma_f32_16x16x32_bf16 v[212:215], a[28:31], a[220:223], v[212:215]
    v_mfma_f32_16x16x32_bf16 v[196:199], a[28:31], a[212:215], v[196:199]
    v_mfma_f32_16x16x32_bf16 v[196:199], a[24:27], a[208:211], v[196:199]
    v_mfma_f32_16x16x32_bf16 v[180:183], a[24:27], a[200:203], v[180:183]
    v_mfma_f32_16x16x32_bf16 v[180:183], a[28:31], a[204:207], v[180:183]
    v_mfma_f32_16x16x32_bf16 v[164:167], a[28:31], a[196:199], v[164:167]
    v_mfma_f32_16x16x32_bf16 v[164:167], a[24:27], a[192:195], v[164:167]
    s_waitcnt vmcnt(0) lgkmcnt(0)
    s_cmp_eq_u32 s51, s46
    s_cbranch_scc1 k12_ool_14
k12_oolret_15:
    s_barrier
    v_mfma_f32_16x16x32_bf16 v[72:75], a[32:35], a[192:195], v[72:75]
    s_cmp_ge_u32 s49, 1024
    s_cselect_b32 s18, 0, s18
    s_cselect_b32 s22, 0, s22
    v_mfma_f32_16x16x32_bf16 v[72:75], a[36:39], a[196:199], v[72:75]
    s_add_u32 m0, s48, 0
    ds_read_b128 a[64:67], v26 offset:32768
    v_mfma_f32_16x16x32_bf16 v[88:91], a[36:39], a[204:207], v[88:91]
    buffer_load_dwordx4 v10, s[16:19], s49 offen offset:0 lds
    ds_read_b64_tr_b16 a[0:1], v28 offset:32768
    v_mfma_f32_16x16x32_bf16 v[88:91], a[32:35], a[200:203], v[88:91]
    ds_read_b128 a[68:71], v27 offset:32768
    v_mfma_f32_16x16x32_bf16 v[104:107], a[32:35], a[208:211], v[104:107]
    buffer_load_dwordx4 v11, s[16:19], s49 offen offset:1024 lds
    v_mfma_f32_16x16x32_bf16 v[104:107], a[36:39], a[212:215], v[104:107]
    ds_read_b64_tr_b16 a[2:3], v28 offset:34816
    v_mfma_f32_16x16x32_bf16 v[120:123], a[36:39], a[220:223], v[120:123]
    v_mfma_f32_16x16x32_bf16 v[120:123], a[32:35], a[216:219], v[120:123]
    ds_read_b128 a[72:75], v26 offset:34816
    v_mfma_f32_16x16x32_bf16 v[136:139], a[32:35], a[224:227], v[136:139]
    buffer_load_dwordx4 v12, s[16:19], s49 offen offset:2048 lds
    ds_read_b64_tr_b16 a[4:5], v28 offset:49152
    v_mfma_f32_16x16x32_bf16 v[136:139], a[36:39], a[228:231], v[136:139]
    v_mfma_f32_16x16x32_bf16 v[152:155], a[36:39], a[236:239], v[152:155]
    ds_read_b128 a[76:79], v27 offset:34816
    v_mfma_f32_16x16x32_bf16 v[152:155], a[32:35], a[232:235], v[152:155]
    buffer_load_dwordx4 v13, s[16:19], s49 offen offset:3072 lds
    v_mfma_f32_16x16x32_bf16 a[144:147], a[32:35], a[240:243], a[144:147]
    ds_read_b64_tr_b16 a[6:7], v28 offset:51200
    v_mfma_f32_16x16x32_bf16 a[144:147], a[36:39], a[244:247], a[144:147]
    s_add_u32 m0, s48, 4096
    ds_read_b128 a[80:83], v26 offset:36864
    v_mfma_f32_16x16x32_bf16 a[176:179], a[36:39], a[252:255], a[176:179]
    v_mfma_f32_16x16x32_bf16 a[176:179], a[32:35], a[248:251], a[176:179]
    buffer_load_dwordx4 v14, s[16:19], s49 offen offset:0 lds
    ds_read_b64_tr_b16 a[8:9], v29 offset:32768
    v_mfma_f32_16x16x32_bf16 a[180:183], a[40:43], a[248:251], a[180:183]
    v_mfma_f32_16x16x32_bf16 a[180:183], a[44:47], a[252:255], a[180:183]
    ds_read_b128 a[84:87], v27 offset:36864
    v_mfma_f32_16x16x32_bf16 a[148:151], a[44:47], a[244:247], a[148:151]
    buffer_load_dwordx4 v15, s[16:19], s49 offen offset:1024 lds
    ds_read_b64_tr_b16 a[10:11], v29 offset:34816
    v_mfma_f32_16x16x32_bf16 a[148:151], a[40:43], a[240:243], a[148:151]
    v_mfma_f32_16x16x32_bf16 v[248:251], a[40:43], a[232:235], v[248:251]
    ds_read_b128 a[88:91], v26 offset:38912
    v_mfma_f32_16x16x32_bf16 v[248:251], a[44:47], a[236:239], v[248:251]
    v_mfma_f32_16x16x32_bf16 v[232:235], a[44:47], a[228:231], v[232:235]
    buffer_load_dwordx4 v16, s[16:19], s49 offen offset:2048 lds
    ds_read_b64_tr_b16 a[12:13], v29 offset:49152
    v_mfma_f32_16x16x32_bf16 v[232:235], a[40:43], a[224:227], v[232:235]
    ds_read_b128 a[92:95], v27 offset:38912
    v_mfma_f32_16x16x32_bf16 v[216:219], a[40:43], a[216:219], v[216:219]
    v_mfma_f32_16x16x32_bf16 v[216:219], a[44:47], a[220:223], v[216:219]
    buffer_load_dwordx4 v17, s[16:19], s49 offen offset:3072 lds
    ds_read_b64_tr_b16 a[14:15], v29 offset:51200
    v_mfma_f32_16x16x32_bf16 v[200:203], a[44:47], a[212:215], v[200:203]
    ds_read_b128 a[96:99], v26 offset:40960
    v_mfma_f32_16x16x32_bf16 v[200:203], a[40:43], a[208:211], v[200:203]
    s_add_u32 s49, s49, 128
    v_mfma_f32_16x16x32_bf16 v[184:187], a[40:43], a[200:203], v[184:187]
    s_add_u32 m0, s48, 65536
    ds_read_b64_tr_b16 a[16:17], v30 offset:32768
    v_mfma_f32_16x16x32_bf16 v[184:187], a[44:47], a[204:207], v[184:187]
    buffer_load_dwordx4 v18, s[20:23], s50 offen offset:0 lds
    v_mfma_f32_16x16x32_bf16 v[168:171], a[44:47], a[196:199], v[168:171]
    ds_read_b128 a[100:103], v27 offset:40960
    v_mfma_f32_16x16x32_bf16 v[168:171], a[40:43], a[192:195], v[168:171]
    ds_read_b64_tr_b16 a[18:19], v30 offset:34816
    v_mfma_f32_16x16x32_bf16 v[76:79], a[48:51], a[192:195], v[76:79]
    buffer_load_dwordx4 v19, s[20:23], s50 offen offset:1024 lds
    v_mfma_f32_16x16x32_bf16 v[76:79], a[52:55], a[196:199], v[76:79]
    ds_read_b128 a[104:107], v26 offset:43008
    v_mfma_f32_16x16x32_bf16 v[92:95], a[52:55], a[204:207], v[92:95]
    v_mfma_f32_16x16x32_bf16 v[92:95], a[48:51], a[200:203], v[92:95]
    buffer_load_dwordx4 v20, s[20:23], s50 offen offset:2048 lds
    ds_read_b64_tr_b16 a[20:21], v30 offset:49152
    v_mfma_f32_16x16x32_bf16 v[108:111], a[48:51], a[208:211], v[108:111]
    ds_read_b128 a[108:111], v27 offset:43008
    v_mfma_f32_16x16x32_bf16 v[108:111], a[52:55], a[212:215], v[108:111]
    v_mfma_f32_16x16x32_bf16 v[124:127], a[52:55], a[220:223], v[124:127]
    ds_read_b64_tr_b16 a[22:23], v30 offset:51200
    v_mfma_f32_16x16x32_bf16 v[124:127], a[48:51], a[216:219], v[124:127]
    buffer_load_dwordx4 v21, s[20:23], s50 offen offset:3072 lds
    v_mfma_f32_16x16x32_bf16 v[140:143], a[48:51], a[224:227], v[140:143]
    s_add_u32 m0, s48, 69632
    ds_read_b128 a[112:115], v26 offset:45056
    v_mfma_f32_16x16x32_bf16 v[140:143], a[52:55], a[228:231], v[140:143]
    ds_read_b64_tr_b16 a[24:25], v31 offset:32768
    v_mfma_f32_16x16x32_bf16 v[156:159], a[52:55], a[236:239], v[156:159]
    buffer_load_dwordx4 v22, s[20:23], s50 offen offset:0 lds
    v_mfma_f32_16x16x32_bf16 v[156:159], a[48:51], a[232:235], v[156:159]
    ds_read_b128 a[116:119], v27 offset:45056
    v_mfma_f32_16x16x32_bf16 a[152:155], a[48:51], a[240:243], a[152:155]
    v_mfma_f32_16x16x32_bf16 a[152:155], a[52:55], a[244:247], a[152:155]
    ds_read_b64_tr_b16 a[26:27], v31 offset:34816
    v_mfma_f32_16x16x32_bf16 a[184:187], a[52:55], a[252:255], a[184:187]
    buffer_load_dwordx4 v23, s[20:23], s50 offen offset:1024 lds
    ds_read_b128 a[120:123], v26 offset:47104
    v_mfma_f32_16x16x32_bf16 a[184:187], a[48:51], a[248:251], a[184:187]
    v_mfma_f32_16x16x32_bf16 a[188:191], a[56:59], a[248:251], a[188:191]
    ds_read_b64_tr_b16 a[28:29], v31 offset:49152
    v_mfma_f32_16x16x32_bf16 a[188:191], a[60:63], a[252:255], a[188:191]
    buffer_load_dwordx4 v24, s[20:23], s50 offen offset:2048 lds
    v_mfma_f32_16x16x32_bf16 a[156:159], a[60:63], a[244:247], a[156:159]
    ds_read_b128 a[124:127], v27 offset:47104
    v_mfma_f32_16x16x32_bf16 a[156:159], a[56:59], a[240:243], a[156:159]
    ds_read_b64_tr_b16 a[30:31], v31 offset:51200
    v_mfma_f32_16x16x32_bf16 v[252:255], a[56:59], a[232:235], v[252:255]
    v_mfma_f32_16x16x32_bf16 v[252:255], a[60:63], a[236:239], v[252:255]
    buffer_load_dwordx4 v25, s[20:23], s50 offen offset:3072 lds
    v_mfma_f32_16x16x32_bf16 v[236:239], a[60:63], a[228:231], v[236:239]
    v_mfma_f32_16x16x32_bf16 v[236:239], a[56:59], a[224:227], v[236:239]
    s_add_u32 s50, s50, 0x80000
    v_mfma_f32_16x16x32_bf16 v[220:223], a[56:59], a[216:219], v[220:223]
    v_mfma_f32_16x16x32_bf16 v[220:223], a[60:63], a[220:223], v[220:223]
    s_cmp_eq_u32 s51, s53
    s_cbranch_scc1 k12_ool_16
k12_oolret_17:
    v_mfma_f32_16x16x32_bf16 v[204:207], a[60:63], a[212:215], v[204:207]
    s_cmp_eq_u32 s51, s63
    s_cbranch_scc1 k12_ool_18
k12_oolret_19:
    v_mfma_f32_16x16x32_bf16 v[204:207], a[56:59], a[208:211], v[204:207]
    s_cmp_eq_u32 s51, 6
    s_cbranch_scc1 k12_ool_20
k12_oolret_21:
    v_mfma_f32_16x16x32_bf16 v[188:191], a[56:59], a[200:203], v[188:191]
    v_mfma_f32_16x16x32_bf16 v[188:191], a[60:63], a[204:207], v[188:191]
    s_add_u32 s51, s51, 1
    v_mfma_f32_16x16x32_bf16 v[172:175], a[60:63], a[196:199], v[172:175]
    v_mfma_f32_16x16x32_bf16 v[172:175], a[56:59], a[192:195], v[172:175]
    s_waitcnt lgkmcnt(0)
    s_cmp_eq_u32 s51, 7
    s_cbranch_scc1 k12_last_9
    v_mfma_f32_16x16x32_bf16 v[64:67], a[0:3], a[64:67], v[64:67]
    v_mfma_f32_16x16x32_bf16 v[64:67], a[4:7], a[68:71], v[64:67]
    ds_read_b64_tr_b16 a[32:33], v32 offset:32768
    v_mfma_f32_16x16x32_bf16 v[80:83], a[4:7], a[76:79], v[80:83]
    v_mfma_f32_16x16x32_bf16 v[80:83], a[0:3], a[72:75], v[80:83]
    ds_read_b64_tr_b16 a[34:35], v32 offset:34816
    v_mfma_f32_16x16x32_bf16 v[96:99], a[0:3], a[80:83], v[96:99]
    v_mfma_f32_16x16x32_bf16 v[96:99], a[4:7], a[84:87], v[96:99]
    v_mfma_f32_16x16x32_bf16 v[112:115], a[4:7], a[92:95], v[112:115]
    ds_read_b64_tr_b16 a[36:37], v32 offset:49152
    v_mfma_f32_16x16x32_bf16 v[112:115], a[0:3], a[88:91], v[112:115]
    v_mfma_f32_16x16x32_bf16 v[128:131], a[0:3], a[96:99], v[128:131]
    v_mfma_f32_16x16x32_bf16 v[128:131], a[4:7], a[100:103], v[128:131]
    ds_read_b64_tr_b16 a[38:39], v32 offset:51200
    v_mfma_f32_16x16x32_bf16 v[144:147], a[4:7], a[108:111], v[144:147]
    v_mfma_f32_16x16x32_bf16 v[144:147], a[0:3], a[104:107], v[144:147]
    v_mfma_f32_16x16x32_bf16 a[128:131], a[0:3], a[112:115], a[128:131]
    ds_read_b64_tr_b16 a[40:41], v33 offset:32768
    v_mfma_f32_16x16x32_bf16 a[128:131], a[4:7], a[116:119], a[128:131]
    v_mfma_f32_16x16x32_bf16 a[160:163], a[4:7], a[124:127], a[160:163]
    v_mfma_f32_16x16x32_bf16 a[160:163], a[0:3], a[120:123], a[160:163]
    ds_read_b64_tr_b16 a[42:43], v33 offset:34816
    v_mfma_f32_16x16x32_bf16 a[164:167], a[8:11], a[120:123], a[164:167]
    v_mfma_f32_16x16x32_bf16 a[164:167], a[12:15], a[124:127], a[164:167]
    v_mfma_f32_16x16x32_bf16 a[132:135], a[12:15], a[116:119], a[132:135]
    ds_read_b64_tr_b16 a[44:45], v33 offset:49152
    v_mfma_f32_16x16x32_bf16 a[132:135], a[8:11], a[112:115], a[132:135]
    v_mfma_f32_16x16x32_bf16 v[240:243], a[8:11], a[104:107], v[240:243]
    v_mfma_f32_16x16x32_bf16 v[240:243], a[12:15], a[108:111], v[240:243]
    ds_read_b64_tr_b16 a[46:47], v33 offset:51200
    v_mfma_f32_16x16x32_bf16 v[224:227], a[12:15], a[100:103], v[224:227]
    v_mfma_f32_16x16x32_bf16 v[224:227], a[8:11], a[96:99], v[224:227]
    ds_read_b64_tr_b16 a[48:49], v34 offset:32768
    v_mfma_f32_16x16x32_bf16 v[208:211], a[8:11], a[88:91], v[208:211]
    v_mfma_f32_16x16x32_bf16 v[208:211], a[12:15], a[92:95], v[208:211]
    v_mfma_f32_16x16x32_bf16 v[192:195], a[12:15], a[84:87], v[192:195]
    ds_read_b64_tr_b16 a[50:51], v34 offset:34816
    v_mfma_f32_16x16x32_bf16 v[192:195], a[8:11], a[80:83], v[192:195]
    v_mfma_f32_16x16x32_bf16 v[176:179], a[8:11], a[72:75], v[176:179]
    v_mfma_f32_16x16x32_bf16 v[176:179], a[12:15], a[76:79], v[176:179]
    ds_read_b64_tr_b16 a[52:53], v34 offset:49152
    v_mfma_f32_16x16x32_bf16 v[160:163], a[12:15], a[68:71], v[160:163]
    v_mfma_f32_16x16x32_bf16 v[160:163], a[8:11], a[64:67], v[160:163]
    v_mfma_f32_16x16x32_bf16 v[68:71], a[16:19], a[64:67], v[68:71]
    ds_read_b64_tr_b16 a[54:55], v34 offset:51200
    v_mfma_f32_16x16x32_bf16 v[68:71], a[20:23], a[68:71], v[68:71]
    v_mfma_f32_16x16x32_bf16 v[84:87], a[20:23], a[76:79], v[84:87]
    v_mfma_f32_16x16x32_bf16 v[84:87], a[16:19], a[72:75], v[84:87]
    ds_read_b64_tr_b16 a[56:57], v35 offset:32768
    v_mfma_f32_16x16x32_bf16 v[100:103], a[16:19], a[80:83], v[100:103]
    v_mfma_f32_16x16x32_bf16 v[100:103], a[20:23], a[84:87], v[100:103]
    v_mfma_f32_16x16x32_bf16 v[116:119], a[20:23], a[92:95], v[116:119]
    ds_read_b64_tr_b16 a[58:59], v35 offset:34816
    v_mfma_f32_16x16x32_bf16 v[116:119], a[16:19], a[88:91], v[116:119]
    v_mfma_f32_16x16x32_bf16 v[132:135], a[16:19], a[96:99], v[132:135]
    v_mfma_f32_16x16x32_bf16 v[132:135], a[20:23], a[100:103], v[132:135]
    ds_read_b64_tr_b16 a[60:61], v35 offset:49152
    v_mfma_f32_16x16x32_bf16 v[148:151], a[20:23], a[108:111], v[148:151]
    v_mfma_f32_16x16x32_bf16 v[148:151], a[16:19], a[104:107], v[148:151]
    v_mfma_f32_16x16x32_bf16 a[136:139], a[16:19], a[112:115], a[136:139]
    ds_read_b64_tr_b16 a[62:63], v35 offset:51200
    v_mfma_f32_16x16x32_bf16 a[136:139], a[20:23], a[116:119], a[136:139]
    v_mfma_f32_16x16x32_bf16 a[168:171], a[20:23], a[124:127], a[168:171]
    v_mfma_f32_16x16x32_bf16 a[168:171], a[16:19], a[120:123], a[168:171]
    v_mfma_f32_16x16x32_bf16 a[172:175], a[24:27], a[120:123], a[172:175]
    v_mfma_f32_16x16x32_bf16 a[172:175], a[28:31], a[124:127], a[172:175]
    v_mfma_f32_16x16x32_bf16 a[140:143], a[28:31], a[116:119], a[140:143]
    v_mfma_f32_16x16x32_bf16 a[140:143], a[24:27], a[112:115], a[140:143]
    v_mfma_f32_16x16x32_bf16 v[244:247], a[24:27], a[104:107], v[244:247]
    v_mfma_f32_16x16x32_bf16 v[244:247], a[28:31], a[108:111], v[244:247]
    v_mfma_f32_16x16x32_bf16 v[228:231], a[28:31], a[100:103], v[228:231]
    v_mfma_f32_16x16x32_bf16 v[228:231], a[24:27], a[96:99], v[228:231]
    v_mfma_f32_16x16x32_bf16 v[212:215], a[24:27], a[88:91], v[212:215]
    v_mfma_f32_16x16x32_bf16 v[212:215], a[28:31], a[92:95], v[212:215]
    v_mfma_f32_16x16x32_bf16 v[196:199], a[28:31], a[84:87], v[196:199]
    v_mfma_f32_16x16x32_bf16 v[196:199], a[24:27], a[80:83], v[196:199]
    v_mfma_f32_16x16x32_bf16 v[180:183], a[24:27], a[72:75], v[180:183]
    v_mfma_f32_16x16x32_bf16 v[180:183], a[28:31], a[76:79], v[180:183]
    v_mfma_f32_16x16x32_bf16 v[164:167], a[28:31], a[68:71], v[164:167]
    v_mfma_f32_16x16x32_bf16 v[164:167], a[24:27], a[64:67], v[164:167]
    s_waitcnt vmcnt(0) lgkmcnt(0)
    s_barrier
    v_mfma_f32_16x16x32_bf16 v[72:75], a[32:35], a[64:67], v[72:75]
    v_mfma_f32_16x16x32_bf16 v[72:75], a[36:39], a[68:71], v[72:75]
    s_add_u32 m0, s48, 32768
    ds_read_b128 a[192:195], v26 offset:0
    v_mfma_f32_16x16x32_bf16 v[88:91], a[36:39], a[76:79], v[88:91]
    buffer_load_dwordx4 v10, s[16:19], s49 offen offset:0 lds
    ds_read_b64_tr_b16 a[0:1], v28 offset:0
    v_mfma_f32_16x16x32_bf16 v[88:91], a[32:35], a[72:75], v[88:91]
    ds_read_b128 a[196:199], v27 offset:0
    v_mfma_f32_16x16x32_bf16 v[104:107], a[32:35], a[80:83], v[104:107]
    buffer_load_dwordx4 v11, s[16:19], s49 offen offset:1024 lds
    v_mfma_f32_16x16x32_bf16 v[104:107], a[36:39], a[84:87], v[104:107]
    ds_read_b64_tr_b16 a[2:3], v28 offset:2048
    v_mfma_f32_16x16x32_bf16 v[120:123], a[36:39], a[92:95], v[120:123]
    v_mfma_f32_16x16x32_bf16 v[120:123], a[32:35], a[88:91], v[120:123]
    ds_read_b128 a[200:203], v26 offset:2048
    v_mfma_f32_16x16x32_bf16 v[136:139], a[32:35], a[96:99], v[136:139]
    buffer_load_dwordx4 v12, s[16:19], s49 offen offset:2048 lds
    ds_read_b64_tr_b16 a[4:5], v28 offset:16384
    v_mfma_f32_16x16x32_bf16 v[136:139], a[36:39], a[100:103], v[136:139]
    v_mfma_f32_16x16x32_bf16 v[152:155], a[36:39], a[108:111], v[152:155]
    ds_read_b128 a[204:207], v27 offset:2048
    v_mfma_f32_16x16x32_bf16 v[152:155], a[32:35], a[104:107], v[152:155]
    buffer_load_dwordx4 v13, s[16:19], s49 offen offset:3072 lds
    v_mfma_f32_16x16x32_bf16 a[144:147], a[32:35], a[112:115], a[144:147]
    ds_read_b64_tr_b16 a[6:7], v28 offset:18432
    v_mfma_f32_16x16x32_bf16 a[144:147], a[36:39], a[116:119], a[144:147]
    s_add_u32 m0, s48, 36864
    ds_read_b128 a[208:211], v26 offset:4096
    v_mfma_f32_16x16x32_bf16 a[176:179], a[36:39], a[124:127], a[176:179]
    v_mfma_f32_16x16x32_bf16 a[176:179], a[32:35], a[120:123], a[176:179]
    buffer_load_dwordx4 v14, s[16:19], s49 offen offset:0 lds
    ds_read_b64_tr_b16 a[8:9], v29 offset:0
    v_mfma_f32_16x16x32_bf16 a[180:183], a[40:43], a[120:123], a[180:183]
    v_mfma_f32_16x16x32_bf16 a[180:183], a[44:47], a[124:127], a[180:183]
    ds_read_b128 a[212:215], v27 offset:4096
    v_mfma_f32_16x16x32_bf16 a[148:151], a[44:47], a[116:119], a[148:151]
    buffer_load_dwordx4 v15, s[16:19], s49 offen offset:1024 lds
    ds_read_b64_tr_b16 a[10:11], v29 offset:2048
    v_mfma_f32_16x16x32_bf16 a[148:151], a[40:43], a[112:115], a[148:151]
    v_mfma_f32_16x16x32_bf16 v[248:251], a[40:43], a[104:107], v[248:251]
    ds_read_b128 a[216:219], v26 offset:6144
    v_mfma_f32_16x16x32_bf16 v[248:251], a[44:47], a[108:111], v[248:251]
    v_mfma_f32_16x16x32_bf16 v[232:235], a[44:47], a[100:103], v[232:235]
    buffer_load_dwordx4 v16, s[16:19], s49 offen offset:2048 lds
    ds_read_b64_tr_b16 a[12:13], v29 offset:16384
    v_mfma_f32_16x16x32_bf16 v[232:235], a[40:43], a[96:99], v[232:235]
    ds_read_b128 a[220:223], v27 offset:6144
    v_mfma_f32_16x16x32_bf16 v[216:219], a[40:43], a[88:91], v[216:219]
    v_mfma_f32_16x16x32_bf16 v[216:219], a[44:47], a[92:95], v[216:219]
    buffer_load_dwordx4 v17, s[16:19], s49 offen offset:3072 lds
    ds_read_b64_tr_b16 a[14:15], v29 offset:18432
    v_mfma_f32_16x16x32_bf16 v[200:203], a[44:47], a[84:87], v[200:203]
    ds_read_b128 a[224:227], v26 offset:8192
    v_mfma_f32_16x16x32_bf16 v[200:203], a[40:43], a[80:83], v[200:203]
    s_add_u32 s49, s49, 128
    v_mfma_f32_16x16x32_bf16 v[184:187], a[40:43], a[72:75], v[184:187]
    s_add_u32 m0, s48, 98304
    ds_read_b64_tr_b16 a[16:17], v30 offset:0
    v_mfma_f32_16x16x32_bf16 v[184:187], a[44:47], a[76:79], v[184:187]
    buffer_load_dwordx4 v18, s[20:23], s50 offen offset:0 lds
    v_mfma_f32_16x16x32_bf16 v[168:171], a[44:47], a[68:71], v[168:171]
    ds_read_b128 a[228:231], v27 offset:8192
    v_mfma_f32_16x16x32_bf16 v[168:171], a[40:43], a[64:67], v[168:171]
    ds_read_b64_tr_b16 a[18:19], v30 offset:2048
    v_mfma_f32_16x16x32_bf16 v[76:79], a[48:51], a[64:67], v[76:79]
    buffer_load_dwordx4 v19, s[20:23], s50 offen offset:1024 lds
    v_mfma_f32_16x16x32_bf16 v[76:79], a[52:55], a[68:71], v[76:79]
    ds_read_b128 a[232:235], v26 offset:10240
    v_mfma_f32_16x16x32_bf16 v[92:95], a[52:55], a[76:79], v[92:95]
    v_mfma_f32_16x16x32_bf16 v[92:95], a[48:51], a[72:75], v[92:95]
    buffer_load_dwordx4 v20, s[20:23], s50 offen offset:2048 lds
    ds_read_b64_tr_b16 a[20:21], v30 offset:16384
    v_mfma_f32_16x16x32_bf16 v[108:111], a[48:51], a[80:83], v[108:111]
    ds_read_b128 a[236:239], v27 offset:10240
    v_mfma_f32_16x16x32_bf16 v[108:111], a[52:55], a[84:87], v[108:111]
    v_mfma_f32_16x16x32_bf16 v[124:127], a[52:55], a[92:95], v[124:127]
    ds_read_b64_tr_b16 a[22:23], v30 offset:18432
    v_mfma_f32_16x16x32_bf16 v[124:127], a[48:51], a[88:91], v[124:127]
    buffer_load_dwordx4 v21, s[20:23], s50 offen offset:3072 lds
    v_mfma_f32_16x16x32_bf16 v[140:143], a[48:51], a[96:99], v[140:143]
    s_add_u32 m0, s48, 102400
    ds_read_b128 a[240:243], v26 offset:12288
    v_mfma_f32_16x16x32_bf16 v[140:143], a[52:55], a[100:103], v[140:143]
    ds_read_b64_tr_b16 a[24:25], v31 offset:0
    v_mfma_f32_16x16x32_bf16 v[156:159], a[52:55], a[108:111], v[156:159]
    buffer_load_dwordx4 v22, s[20:23], s50 offen offset:0 lds
    v_mfma_f32_16x16x32_bf16 v[156:159], a[48:51], a[104:107], v[156:159]
    ds_read_b128 a[244:247], v27 offset:12288
    v_mfma_f32_16x16x32_bf16 a[152:155], a[48:51], a[112:115], a[152:155]
    v_mfma_f32_16x16x32_bf16 a[152:155], a[52:55], a[116:119], a[152:155]
    ds_read_b64_tr_b16 a[26:27], v31 offset:2048
    v_mfma_f32_16x16x32_bf16 a[184:187], a[52:55], a[124:127], a[184:187]
    buffer_load_dwordx4 v23, s[20:23], s50 offen offset:1024 lds
    ds_read_b128 a[248:251], v26 offset:14336
    v_mfma_f32_16x16x32_bf16 a[184:187], a[48:51], a[120:123], a[184:187]
    v_mfma_f32_16x16x32_bf16 a[188:191], a[56:59], a[120:123], a[188:191]
    ds_read_b64_tr_b16 a[28:29], v31 offset:16384
    v_mfma_f32_16x16x32_bf16 a[188:191], a[60:63], a[124:127], a[188:191]
    buffer_load_dwordx4 v24, s[20:23], s50 offen offset:2048 lds
    v_mfma_f32_16x16x32_bf16 a[156:159], a[60:63], a[116:119], a[156:159]
    ds_read_b128 a[252:255], v27 offset:14336
    v_mfma_f32_16x16x32_bf16 a[156:159], a[56:59], a[112:115], a[156:159]
    ds_read_b64_tr_b16 a[30:31], v31 offset:18432
    v_mfma_f32_16x16x32_bf16 v[252:255], a[56:59], a[104:107], v[252:255]
    v_mfma_f32_16x16x32_bf16 v[252:255], a[60:63], a[108:111], v[252:255]
    buffer_load_dwordx4 v25, s[20:23], s50 offen offset:3072 lds
    v_mfma_f32_16x16x32_bf16 v[236:239], a[60:63], a[100:103], v[236:239]
    v_mfma_f32_16x16x32_bf16 v[236:239], a[56:59], a[96:99], v[236:239]
    s_add_u32 s50, s50, 0x80000
    v_mfma_f32_16x16x32_bf16 v[220:223], a[56:59], a[88:91], v[220:223]
    v_mfma_f32_16x16x32_bf16 v[220:223], a[60:63], a[92:95], v[220:223]
    s_cmp_eq_u32 s51, s53
    s_cbranch_scc1 k12_ool_22
k12_oolret_23:
    v_mfma_f32_16x16x32_bf16 v[204:207], a[60:63], a[84:87], v[204:207]
    s_cmp_eq_u32 s51, s63
    s_cbranch_scc1 k12_ool_24
k12_oolret_25:
    v_mfma_f32_16x16x32_bf16 v[204:207], a[56:59], a[80:83], v[204:207]
    s_cmp_eq_u32 s51, 5
    s_cbranch_scc1 k12_ool_26
k12_oolret_27:
    v_mfma_f32_16x16x32_bf16 v[188:191], a[56:59], a[72:75], v[188:191]
    v_mfma_f32_16x16x32_bf16 v[188:191], a[60:63], a[76:79], v[188:191]
    s_add_u32 s51, s51, 1
    v_mfma_f32_16x16x32_bf16 v[172:175], a[60:63], a[68:71], v[172:175]
    v_mfma_f32_16x16x32_bf16 v[172:175], a[56:59], a[64:67], v[172:175]
    s_waitcnt lgkmcnt(0)
    s_branch k12_loop_8
k12_last_9:
    v_mfma_f32_16x16x32_bf16 v[64:67], a[0:3], a[64:67], v[64:67]
    buffer_load_dwordx4 a[192:195], v36, s[8:11], s62 offen sc1
    v_mfma_f32_16x16x32_bf16 v[64:67], a[4:7], a[68:71], v[64:67]
    ds_read_b64_tr_b16 a[32:33], v32 offset:32768
    v_mfma_f32_16x16x32_bf16 v[160:163], a[12:15], a[68:71], v[160:163]
    buffer_load_dwordx4 a[196:199], v54, s[8:11], s62 offen sc1
    ds_read_b64_tr_b16 a[34:35], v32 offset:34816
    v_mfma_f32_16x16x32_bf16 v[160:163], a[8:11], a[64:67], v[160:163]
    v_mfma_f32_16x16x32_bf16 v[80:83], a[0:3], a[72:75], v[80:83]
    buffer_load_dwordx4 a[200:203], v37, s[8:11], s62 offen sc1
    v_mfma_f32_16x16x32_bf16 v[80:83], a[4:7], a[76:79], v[80:83]
    ds_read_b64_tr_b16 a[36:37], v32 offset:49152
    v_mfma_f32_16x16x32_bf16 v[176:179], a[12:15], a[76:79], v[176:179]
    buffer_load_dwordx4 a[204:207], v55, s[8:11], s62 offen sc1
    v_mfma_f32_16x16x32_bf16 v[176:179], a[8:11], a[72:75], v[176:179]
    s_add_u32 s62, s62, 0x20000
    buffer_load_dwordx4 a[208:211], v36, s[8:11], s62 offen sc1
    ds_read_b64_tr_b16 a[38:39], v32 offset:51200
    v_mfma_f32_16x16x32_bf16 v[96:99], a[0:3], a[80:83], v[96:99]
    v_mfma_f32_16x16x32_bf16 v[96:99], a[4:7], a[84:87], v[96:99]
    v_cvt_pk_bf16_f32 v64, v64, v65
    v_cvt_pk_bf16_f32 v65, v66, v67
    v_mfma_f32_16x16x32_bf16 v[192:195], a[12:15], a[84:87], v[192:195]
    v_cvt_pk_bf16_f32 v66, v160, v161
    v_cvt_pk_bf16_f32 v67, v162, v163
    v_mfma_f32_16x16x32_bf16 v[192:195], a[8:11], a[80:83], v[192:195]
    buffer_load_dwordx4 a[212:215], v54, s[8:11], s62 offen sc1
    ds_read_b64_tr_b16 a[40:41], v33 offset:32768
    v_mfma_f32_16x16x32_bf16 v[112:115], a[0:3], a[88:91], v[112:115]
    buffer_load_dwordx4 a[216:219], v37, s[8:11], s62 offen sc1
    ds_read_b64_tr_b16 a[42:43], v33 offset:34816
    v_mfma_f32_16x16x32_bf16 v[112:115], a[4:7], a[92:95], v[112:115]
    v_cvt_pk_bf16_f32 v80, v80, v81
    v_cvt_pk_bf16_f32 v81, v82, v83
    v_mfma_f32_16x16x32_bf16 v[208:211], a[12:15], a[92:95], v[208:211]
    v_cvt_pk_bf16_f32 v82, v176, v177
    v_cvt_pk_bf16_f32 v83, v178, v179
    v_mfma_f32_16x16x32_bf16 v[208:211], a[8:11], a[88:91], v[208:211]
    buffer_load_dwordx4 a[220:223], v55, s[8:11], s62 offen sc1
    ds_read_b64_tr_b16 a[44:45], v33 offset:49152
    v_mfma_f32_16x16x32_bf16 v[128:131], a[0:3], a[96:99], v[128:131]
    s_add_u32 s62, s62, 0x20000
    buffer_load_dwordx4 a[224:227], v36, s[8:11], s62 offen sc1
    v_mfma_f32_16x16x32_bf16 v[128:131], a[4:7], a[100:103], v[128:131]
    v_cvt_pk_bf16_f32 v96, v96, v97
    v_cvt_pk_bf16_f32 v97, v98, v99
    v_mfma_f32_16x16x32_bf16 v[224:227], a[12:15], a[100:103], v[224:227]
    buffer_load_dwordx4 a[228:231], v54, s[8:11], s62 offen sc1
    ds_read_b64_tr_b16 a[46:47], v33 offset:51200
    v_mfma_f32_16x16x32_bf16 v[224:227], a[8:11], a[96:99], v[224:227]
    v_cvt_pk_bf16_f32 v98, v192, v193
    v_cvt_pk_bf16_f32 v99, v194, v195
    v_mfma_f32_16x16x32_bf16 v[144:147], a[0:3], a[104:107], v[144:147]
    buffer_load_dwordx4 a[232:235], v37, s[8:11], s62 offen sc1
    ds_read_b64_tr_b16 a[48:49], v34 offset:32768
    v_mfma_f32_16x16x32_bf16 v[144:147], a[4:7], a[108:111], v[144:147]
    v_cvt_pk_bf16_f32 v112, v112, v113
    v_cvt_pk_bf16_f32 v113, v114, v115
    v_mfma_f32_16x16x32_bf16 v[240:243], a[12:15], a[108:111], v[240:243]
    buffer_load_dwordx4 a[236:239], v55, s[8:11], s62 offen sc1
    ds_read_b64_tr_b16 a[50:51], v34 offset:34816
    v_mfma_f32_16x16x32_bf16 v[240:243], a[8:11], a[104:107], v[240:243]
    s_add_u32 s62, s62, 0x20000
    v_cvt_pk_bf16_f32 v114, v208, v209
    v_cvt_pk_bf16_f32 v115, v210, v211
    v_mfma_f32_16x16x32_bf16 a[128:131], a[0:3], a[112:115], a[128:131]
    buffer_load_dwordx4 a[240:243], v36, s[8:11], s62 offen sc1
    ds_read_b64_tr_b16 a[52:53], v34 offset:49152
    v_mfma_f32_16x16x32_bf16 a[128:131], a[4:7], a[116:119], a[128:131]
    v_cvt_pk_bf16_f32 v128, v128, v129
    v_cvt_pk_bf16_f32 v129, v130, v131
    v_mfma_f32_16x16x32_bf16 a[132:135], a[12:15], a[116:119], a[132:135]
    buffer_load_dwordx4 a[244:247], v54, s[8:11], s62 offen sc1
    buffer_load_dwordx4 a[248:251], v37, s[8:11], s62 offen sc1
    v_mfma_f32_16x16x32_bf16 a[132:135], a[8:11], a[112:115], a[132:135]
    v_cvt_pk_bf16_f32 v130, v224, v225
    v_cvt_pk_bf16_f32 v131, v226, v227
    v_mfma_f32_16x16x32_bf16 a[160:163], a[0:3], a[120:123], a[160:163]
    buffer_load_dwordx4 a[252:255], v55, s[8:11], s62 offen sc1
    ds_read_b64_tr_b16 a[54:55], v34 offset:51200
    v_mfma_f32_16x16x32_bf16 a[160:163], a[4:7], a[124:127], a[160:163]
    s_add_u32 s62, s62, 0x20000
    v_cvt_pk_bf16_f32 v144, v144, v145
    v_cvt_pk_bf16_f32 v145, v146, v147
    v_mfma_f32_16x16x32_bf16 a[164:167], a[12:15], a[124:127], a[164:167]
    ds_read_b64_tr_b16 a[56:57], v35 offset:32768
    v_cvt_pk_bf16_f32 v146, v240, v241
    v_mfma_f32_16x16x32_bf16 a[164:167], a[8:11], a[120:123], a[164:167]
    v_cvt_pk_bf16_f32 v147, v242, v243
    v_mfma_f32_16x16x32_bf16 v[68:71], a[16:19], a[64:67], v[68:71]
    s_add_u32 s52, s47, 0
    ds_read_b64_tr_b16 a[58:59], v35 offset:34816
    v_mfma_f32_16x16x32_bf16 v[68:71], a[20:23], a[68:71], v[68:71]
    v_accvgpr_read_b32 v56, a128
    v_accvgpr_read_b32 v57, a129
    v_mfma_f32_16x16x32_bf16 v[164:167], a[28:31], a[68:71], v[164:167]
    v_accvgpr_read_b32 v58, a130
    v_accvgpr_read_b32 v59, a131
    v_mfma_f32_16x16x32_bf16 v[164:167], a[24:27], a[64:67], v[164:167]
    buffer_store_dwordx4 v[64:67], v1, s[32:35], s52 offen offset:0 sc1
    ds_read_b64_tr_b16 a[60:61], v35 offset:49152
    v_mfma_f32_16x16x32_bf16 v[84:87], a[16:19], a[72:75], v[84:87]
    v_accvgpr_read_b32 v60, a132
    v_accvgpr_read_b32 v61, a133
    v_mfma_f32_16x16x32_bf16 v[84:87], a[20:23], a[76:79], v[84:87]
    v_accvgpr_read_b32 v62, a134
    v_accvgpr_read_b32 v63, a135
    v_mfma_f32_16x16x32_bf16 v[180:183], a[28:31], a[76:79], v[180:183]
    v_cvt_pk_bf16_f32 v160, v56, v57
    v_cvt_pk_bf16_f32 v161, v58, v59
    v_mfma_f32_16x16x32_bf16 v[180:183], a[24:27], a[72:75], v[180:183]
    ds_read_b64_tr_b16 a[62:63], v35 offset:51200
    v_cvt_pk_bf16_f32 v162, v60, v61
    v_mfma_f32_16x16x32_bf16 v[100:103], a[16:19], a[80:83], v[100:103]
    v_cvt_pk_bf16_f32 v163, v62, v63
    v_accvgpr_read_b32 v56, a160
    v_mfma_f32_16x16x32_bf16 v[100:103], a[20:23], a[84:87], v[100:103]
    v_accvgpr_read_b32 v57, a161
    v_accvgpr_read_b32 v58, a162
    v_mfma_f32_16x16x32_bf16 v[196:199], a[28:31], a[84:87], v[196:199]
    v_accvgpr_read_b32 v59, a163
    v_accvgpr_read_b32 v60, a164
    v_mfma_f32_16x16x32_bf16 v[196:199], a[24:27], a[80:83], v[196:199]
    s_add_u32 s52, s47, 8192
    v_accvgpr_read_b32 v61, a165
    v_accvgpr_read_b32 v62, a166
    v_mfma_f32_16x16x32_bf16 v[116:119], a[16:19], a[88:91], v[116:119]
    v_accvgpr_read_b32 v63, a167
    v_cvt_pk_bf16_f32 v176, v56, v57
    v_mfma_f32_16x16x32_bf16 v[116:119], a[20:23], a[92:95], v[116:119]
    v_cvt_pk_bf16_f32 v177, v58, v59
    v_cvt_pk_bf16_f32 v68, v68, v69
    v_mfma_f32_16x16x32_bf16 v[212:215], a[28:31], a[92:95], v[212:215]
    v_cvt_pk_bf16_f32 v178, v60, v61
    v_cvt_pk_bf16_f32 v69, v70, v71
    v_mfma_f32_16x16x32_bf16 v[212:215], a[24:27], a[88:91], v[212:215]
    v_cvt_pk_bf16_f32 v179, v62, v63
    v_cvt_pk_bf16_f32 v70, v164, v165
    v_mfma_f32_16x16x32_bf16 v[132:135], a[16:19], a[96:99], v[132:135]
    v_cvt_pk_bf16_f32 v71, v166, v167
    v_cvt_pk_bf16_f32 v84, v84, v85
    v_mfma_f32_16x16x32_bf16 v[132:135], a[20:23], a[100:103], v[132:135]
    buffer_store_dwordx4 v[96:99], v1, s[32:35], s52 offen offset:0 sc1
    v_cvt_pk_bf16_f32 v85, v86, v87
    v_mfma_f32_16x16x32_bf16 v[228:231], a[28:31], a[100:103], v[228:231]
    v_cvt_pk_bf16_f32 v86, v180, v181
    v_cvt_pk_bf16_f32 v87, v182, v183
    v_mfma_f32_16x16x32_bf16 v[228:231], a[24:27], a[96:99], v[228:231]
    v_cvt_pk_bf16_f32 v100, v100, v101
    v_cvt_pk_bf16_f32 v101, v102, v103
    v_mfma_f32_16x16x32_bf16 v[148:151], a[16:19], a[104:107], v[148:151]
    v_cvt_pk_bf16_f32 v102, v196, v197
    v_cvt_pk_bf16_f32 v103, v198, v199
    v_mfma_f32_16x16x32_bf16 v[148:151], a[20:23], a[108:111], v[148:151]
    v_cvt_pk_bf16_f32 v116, v116, v117
    v_cvt_pk_bf16_f32 v117, v118, v119
    v_mfma_f32_16x16x32_bf16 v[244:247], a[28:31], a[108:111], v[244:247]
    v_cvt_pk_bf16_f32 v118, v212, v213
    v_cvt_pk_bf16_f32 v119, v214, v215
    v_mfma_f32_16x16x32_bf16 v[244:247], a[24:27], a[104:107], v[244:247]
    s_add_u32 s52, s47, 524288
    v_mfma_f32_16x16x32_bf16 a[136:139], a[16:19], a[112:115], a[136:139]
    buffer_store_dwordx4 v[128:131], v1, s[32:35], s52 offen offset:0 sc1
    v_mfma_f32_16x16x32_bf16 a[136:139], a[20:23], a[116:119], a[136:139]
    v_cvt_pk_bf16_f32 v132, v132, v133
    v_cvt_pk_bf16_f32 v133, v134, v135
    v_mfma_f32_16x16x32_bf16 a[140:143], a[28:31], a[116:119], a[140:143]
    v_cvt_pk_bf16_f32 v134, v228, v229
    v_cvt_pk_bf16_f32 v135, v230, v231
    v_mfma_f32_16x16x32_bf16 a[140:143], a[24:27], a[112:115], a[140:143]
    v_mfma_f32_16x16x32_bf16 a[168:171], a[16:19], a[120:123], a[168:171]
    s_waitcnt lgkmcnt(0)
    v_mfma_f32_16x16x32_bf16 a[168:171], a[20:23], a[124:127], a[168:171]
    v_cvt_pk_bf16_f32 v148, v148, v149
    v_cvt_pk_bf16_f32 v149, v150, v151
    v_mfma_f32_16x16x32_bf16 a[172:175], a[28:31], a[124:127], a[172:175]
    v_cvt_pk_bf16_f32 v150, v244, v245
    v_cvt_pk_bf16_f32 v151, v246, v247
    v_mfma_f32_16x16x32_bf16 a[172:175], a[24:27], a[120:123], a[172:175]
    v_mfma_f32_16x16x32_bf16 v[72:75], a[32:35], a[64:67], v[72:75]
    v_mfma_f32_16x16x32_bf16 v[72:75], a[36:39], a[68:71], v[72:75]
    v_accvgpr_read_b32 v56, a136
    v_accvgpr_read_b32 v57, a137
    v_mfma_f32_16x16x32_bf16 v[168:171], a[44:47], a[68:71], v[168:171]
    s_add_u32 s52, s47, 532480
    v_accvgpr_read_b32 v58, a138
    v_accvgpr_read_b32 v59, a139
    v_mfma_f32_16x16x32_bf16 v[168:171], a[40:43], a[64:67], v[168:171]
    v_accvgpr_read_b32 v60, a140
    v_accvgpr_read_b32 v61, a141
    v_mfma_f32_16x16x32_bf16 v[88:91], a[32:35], a[72:75], v[88:91]
    v_accvgpr_read_b32 v62, a142
    v_accvgpr_read_b32 v63, a143
    v_mfma_f32_16x16x32_bf16 v[88:91], a[36:39], a[76:79], v[88:91]
    v_cvt_pk_bf16_f32 v164, v56, v57
    v_cvt_pk_bf16_f32 v165, v58, v59
    v_mfma_f32_16x16x32_bf16 v[184:187], a[44:47], a[76:79], v[184:187]
    buffer_store_dwordx4 v[160:163], v1, s[32:35], s52 offen offset:0 sc1
    v_mfma_f32_16x16x32_bf16 v[184:187], a[40:43], a[72:75], v[184:187]
    v_cvt_pk_bf16_f32 v166, v60, v61
    v_cvt_pk_bf16_f32 v167, v62, v63
    v_mfma_f32_16x16x32_bf16 v[104:107], a[32:35], a[80:83], v[104:107]
    v_accvgpr_read_b32 v56, a168
    v_accvgpr_read_b32 v57, a169
    v_mfma_f32_16x16x32_bf16 v[104:107], a[36:39], a[84:87], v[104:107]
    v_accvgpr_read_b32 v58, a170
    v_accvgpr_read_b32 v59, a171
    v_mfma_f32_16x16x32_bf16 v[200:203], a[44:47], a[84:87], v[200:203]
    v_accvgpr_read_b32 v60, a172
    v_accvgpr_read_b32 v61, a173
    v_mfma_f32_16x16x32_bf16 v[200:203], a[40:43], a[80:83], v[200:203]
    v_accvgpr_read_b32 v62, a174
    v_accvgpr_read_b32 v63, a175
    v_mfma_f32_16x16x32_bf16 v[120:123], a[32:35], a[88:91], v[120:123]
    v_cvt_pk_bf16_f32 v180, v56, v57
    v_cvt_pk_bf16_f32 v181, v58, v59
    v_mfma_f32_16x16x32_bf16 v[120:123], a[36:39], a[92:95], v[120:123]
    v_cvt_pk_bf16_f32 v72, v72, v73
    v_cvt_pk_bf16_f32 v182, v60, v61
    v_mfma_f32_16x16x32_bf16 v[216:219], a[44:47], a[92:95], v[216:219]
    s_add_u32 s52, s47, 0
    v_cvt_pk_bf16_f32 v73, v74, v75
    v_cvt_pk_bf16_f32 v183, v62, v63
    v_mfma_f32_16x16x32_bf16 v[216:219], a[40:43], a[88:91], v[216:219]
    v_cvt_pk_bf16_f32 v74, v168, v169
    v_cvt_pk_bf16_f32 v75, v170, v171
    v_mfma_f32_16x16x32_bf16 v[136:139], a[32:35], a[96:99], v[136:139]
    v_cvt_pk_bf16_f32 v88, v88, v89
    v_cvt_pk_bf16_f32 v89, v90, v91
    v_mfma_f32_16x16x32_bf16 v[136:139], a[36:39], a[100:103], v[136:139]
    v_cvt_pk_bf16_f32 v90, v184, v185
    v_cvt_pk_bf16_f32 v91, v186, v187
    v_mfma_f32_16x16x32_bf16 v[232:235], a[44:47], a[100:103], v[232:235]
    buffer_store_dwordx4 v[68:71], v1, s[32:35], s52 offen offset:1024 sc1
    v_mfma_f32_16x16x32_bf16 v[232:235], a[40:43], a[96:99], v[232:235]
    v_cvt_pk_bf16_f32 v104, v104, v105
    v_cvt_pk_bf16_f32 v105, v106, v107
    v_mfma_f32_16x16x32_bf16 v[152:155], a[32:35], a[104:107], v[152:155]
    v_cvt_pk_bf16_f32 v106, v200, v201
    v_cvt_pk_bf16_f32 v107, v202, v203
    v_mfma_f32_16x16x32_bf16 v[152:155], a[36:39], a[108:111], v[152:155]
    v_cvt_pk_bf16_f32 v120, v120, v121
    v_cvt_pk_bf16_f32 v121, v122, v123
    v_mfma_f32_16x16x32_bf16 v[248:251], a[44:47], a[108:111], v[248:251]
    v_cvt_pk_bf16_f32 v122, v216, v217
    v_cvt_pk_bf16_f32 v123, v218, v219
    v_mfma_f32_16x16x32_bf16 v[248:251], a[40:43], a[104:107], v[248:251]
    v_mfma_f32_16x16x32_bf16 a[144:147], a[32:35], a[112:115], a[144:147]
    v_mfma_f32_16x16x32_bf16 a[144:147], a[36:39], a[116:119], a[144:147]
    s_add_u32 s52, s47, 8192
    v_cvt_pk_bf16_f32 v136, v136, v137
    v_cvt_pk_bf16_f32 v137, v138, v139
    v_mfma_f32_16x16x32_bf16 a[148:151], a[44:47], a[116:119], a[148:151]
    v_cvt_pk_bf16_f32 v138, v232, v233
    v_cvt_pk_bf16_f32 v139, v234, v235
    v_mfma_f32_16x16x32_bf16 a[148:151], a[40:43], a[112:115], a[148:151]
    buffer_store_dwordx4 v[100:103], v1, s[32:35], s52 offen offset:1024 sc1
    v_mfma_f32_16x16x32_bf16 a[176:179], a[32:35], a[120:123], a[176:179]
    v_mfma_f32_16x16x32_bf16 a[176:179], a[36:39], a[124:127], a[176:179]
    v_cvt_pk_bf16_f32 v152, v152, v153
    v_cvt_pk_bf16_f32 v153, v154, v155
    v_mfma_f32_16x16x32_bf16 a[180:183], a[44:47], a[124:127], a[180:183]
    v_cvt_pk_bf16_f32 v154, v248, v249
    v_cvt_pk_bf16_f32 v155, v250, v251
    v_mfma_f32_16x16x32_bf16 a[180:183], a[40:43], a[120:123], a[180:183]
    v_mfma_f32_16x16x32_bf16 v[76:79], a[48:51], a[64:67], v[76:79]
    s_waitcnt vmcnt(16)
    s_barrier
    v_mfma_f32_16x16x32_bf16 v[76:79], a[52:55], a[68:71], v[76:79]
    ds_read_b64_tr_b16 a[0:1], v42 offset:32768
    v_accvgpr_read_b32 v56, a144
    v_mfma_f32_16x16x32_bf16 v[172:175], a[60:63], a[68:71], v[172:175]
    v_accvgpr_read_b32 v57, a145
    v_accvgpr_read_b32 v58, a146
    v_mfma_f32_16x16x32_bf16 v[172:175], a[56:59], a[64:67], v[172:175]
    ds_read_b64_tr_b16 a[2:3], v42 offset:33792
    v_accvgpr_read_b32 v59, a147
    v_mfma_f32_16x16x32_bf16 v[92:95], a[48:51], a[72:75], v[92:95]
    v_accvgpr_read_b32 v60, a148
    v_accvgpr_read_b32 v61, a149
    v_mfma_f32_16x16x32_bf16 v[92:95], a[52:55], a[76:79], v[92:95]
    s_add_u32 s52, s47, 524288
    ds_read_b64_tr_b16 a[4:5], v42 offset:40960
    v_accvgpr_read_b32 v62, a150
    v_mfma_f32_16x16x32_bf16 v[188:191], a[60:63], a[76:79], v[188:191]
    v_accvgpr_read_b32 v63, a151
    v_cvt_pk_bf16_f32 v168, v56, v57
    v_mfma_f32_16x16x32_bf16 v[188:191], a[56:59], a[72:75], v[188:191]
    v_cvt_pk_bf16_f32 v169, v58, v59
    v_cvt_pk_bf16_f32 v170, v60, v61
    v_mfma_f32_16x16x32_bf16 v[108:111], a[48:51], a[80:83], v[108:111]
    ds_read_b64_tr_b16 a[6:7], v42 offset:41984
    v_cvt_pk_bf16_f32 v171, v62, v63
    v_mfma_f32_16x16x32_bf16 v[108:111], a[52:55], a[84:87], v[108:111]
    v_accvgpr_read_b32 v56, a176
    v_accvgpr_read_b32 v57, a177
    v_mfma_f32_16x16x32_bf16 v[204:207], a[60:63], a[84:87], v[204:207]
    v_accvgpr_read_b32 v58, a178
    v_accvgpr_read_b32 v59, a179
    v_mfma_f32_16x16x32_bf16 v[204:207], a[56:59], a[80:83], v[204:207]
    ds_read_b64_tr_b16 a[8:9], v43 offset:32768
    v_accvgpr_read_b32 v60, a180
    v_mfma_f32_16x16x32_bf16 v[124:127], a[48:51], a[88:91], v[124:127]
    buffer_store_dwordx4 v[132:135], v1, s[32:35], s52 offen offset:1024 sc1
    v_accvgpr_read_b32 v61, a181
    v_mfma_f32_16x16x32_bf16 v[124:127], a[52:55], a[92:95], v[124:127]
    v_accvgpr_read_b32 v62, a182
    v_accvgpr_read_b32 v63, a183
    v_mfma_f32_16x16x32_bf16 v[220:223], a[60:63], a[92:95], v[220:223]
    ds_read_b64_tr_b16 a[10:11], v43 offset:33792
    v_cvt_pk_bf16_f32 v184, v56, v57
    v_mfma_f32_16x16x32_bf16 v[220:223], a[56:59], a[88:91], v[220:223]
    v_cvt_pk_bf16_f32 v185, v58, v59
    v_cvt_pk_bf16_f32 v76, v76, v77
    v_mfma_f32_16x16x32_bf16 v[140:143], a[48:51], a[96:99], v[140:143]
    s_add_u32 s52, s47, 532480
    v_cvt_pk_bf16_f32 v186, v60, v61
    v_cvt_pk_bf16_f32 v77, v78, v79
    v_mfma_f32_16x16x32_bf16 v[140:143], a[52:55], a[100:103], v[140:143]
    ds_read_b64_tr_b16 a[12:13], v43 offset:40960
    v_cvt_pk_bf16_f32 v187, v62, v63
    v_mfma_f32_16x16x32_bf16 v[236:239], a[60:63], a[100:103], v[236:239]
    v_cvt_pk_bf16_f32 v78, v172, v173
    v_cvt_pk_bf16_f32 v79, v174, v175
    v_mfma_f32_16x16x32_bf16 v[236:239], a[56:59], a[96:99], v[236:239]
    ds_read_b64_tr_b16 a[14:15], v43 offset:41984
    ds_read_b64_tr_b16 a[16:17], v44 offset:32768
    v_mfma_f32_16x16x32_bf16 v[156:159], a[48:51], a[104:107], v[156:159]
    v_cvt_pk_bf16_f32 v92, v92, v93
    v_cvt_pk_bf16_f32 v93, v94, v95
    v_mfma_f32_16x16x32_bf16 v[156:159], a[52:55], a[108:111], v[156:159]
    ds_read_b64_tr_b16 a[18:19], v44 offset:33792
    v_cvt_pk_bf16_f32 v94, v188, v189
    v_mfma_f32_16x16x32_bf16 v[252:255], a[60:63], a[108:111], v[252:255]
    ds_read_b64_tr_b16 a[20:21], v44 offset:40960
    v_cvt_pk_bf16_f32 v95, v190, v191
    v_mfma_f32_16x16x32_bf16 v[252:255], a[56:59], a[104:107], v[252:255]
    ds_read_b64_tr_b16 a[22:23], v44 offset:41984
    v_cvt_pk_bf16_f32 v108, v108, v109
    v_mfma_f32_16x16x32_bf16 a[152:155], a[48:51], a[112:115], a[152:155]
    v_cvt_pk_bf16_f32 v109, v110, v111
    v_cvt_pk_bf16_f32 v110, v204, v205
    v_mfma_f32_16x16x32_bf16 a[152:155], a[52:55], a[116:119], a[152:155]
    ds_read_b64_tr_b16 a[24:25], v45 offset:32768
    v_cvt_pk_bf16_f32 v111, v206, v207
    v_mfma_f32_16x16x32_bf16 a[156:159], a[60:63], a[116:119], a[156:159]
    buffer_store_dwordx4 v[164:167], v1, s[32:35], s52 offen offset:1024 sc1
    ds_read_b64_tr_b16 a[26:27], v45 offset:33792
    v_mfma_f32_16x16x32_bf16 a[156:159], a[56:59], a[112:115], a[156:159]
    ds_read_b64_tr_b16 a[28:29], v45 offset:40960
    v_cvt_pk_bf16_f32 v124, v124, v125
    v_mfma_f32_16x16x32_bf16 a[184:187], a[48:51], a[120:123], a[184:187]
    v_cvt_pk_bf16_f32 v125, v126, v127
    v_cvt_pk_bf16_f32 v126, v220, v221
    v_mfma_f32_16x16x32_bf16 a[184:187], a[52:55], a[124:127], a[184:187]
    ds_read_b64_tr_b16 a[30:31], v45 offset:41984
    v_cvt_pk_bf16_f32 v127, v222, v223
    v_mfma_f32_16x16x32_bf16 a[188:191], a[60:63], a[124:127], a[188:191]
    v_cvt_pk_bf16_f32 v140, v140, v141
    v_cvt_pk_bf16_f32 v141, v142, v143
    v_mfma_f32_16x16x32_bf16 a[188:191], a[56:59], a[120:123], a[188:191]
    v_cvt_pk_bf16_f32 v142, v236, v237
    v_cvt_pk_bf16_f32 v143, v238, v239
    v_cvt_pk_bf16_f32 v156, v156, v157
    v_cvt_pk_bf16_f32 v157, v158, v159
    v_cvt_pk_bf16_f32 v158, v252, v253
    v_cvt_pk_bf16_f32 v159, v254, v255
    v_accvgpr_read_b32 v56, a152
    v_accvgpr_read_b32 v57, a153
    v_accvgpr_read_b32 v58, a154
    v_accvgpr_read_b32 v59, a155
    v_accvgpr_read_b32 v60, a156
    v_accvgpr_read_b32 v61, a157
    v_accvgpr_read_b32 v62, a158
    v_accvgpr_read_b32 v63, a159
    v_cvt_pk_bf16_f32 v172, v56, v57
    v_cvt_pk_bf16_f32 v173, v58, v59
    v_cvt_pk_bf16_f32 v174, v60, v61
    v_cvt_pk_bf16_f32 v175, v62, v63
    v_accvgpr_read_b32 v56, a184
    v_accvgpr_read_b32 v57, a185
    v_accvgpr_read_b32 v58, a186
    v_accvgpr_read_b32 v59, a187
    v_accvgpr_read_b32 v60, a188
    v_accvgpr_read_b32 v61, a189
    v_accvgpr_read_b32 v62, a190
    v_accvgpr_read_b32 v63, a191
    v_cvt_pk_bf16_f32 v188, v56, v57
    v_cvt_pk_bf16_f32 v189, v58, v59
    v_cvt_pk_bf16_f32 v190, v60, v61
    v_cvt_pk_bf16_f32 v191, v62, v63
    s_branch k12_join_7
k12_v_6:
k12_loop_28:
    v_mfma_f32_16x16x32_bf16 v[64:67], a[192:195], a[0:3], v[64:67]
    v_mfma_f32_16x16x32_bf16 v[64:67], a[196:199], a[4:7], v[64:67]
    ds_read_b64_tr_b16 a[32:33], v32 offset:0
    v_mfma_f32_16x16x32_bf16 v[160:163], a[204:207], a[4:7], v[160:163]
    v_mfma_f32_16x16x32_bf16 v[160:163], a[200:203], a[0:3], v[160:163]
    ds_read_b64_tr_b16 a[34:35], v32 offset:2048
    v_mfma_f32_16x16x32_bf16 v[96:99], a[208:211], a[0:3], v[96:99]
    s_cmp_eq_u32 s51, s46
    s_cbranch_scc1 k12_ool_30
k12_oolret_31:
    v_mfma_f32_16x16x32_bf16 v[96:99], a[212:215], a[4:7], v[96:99]
    v_mfma_f32_16x16x32_bf16 v[192:195], a[220:223], a[4:7], v[192:195]
    ds_read_b64_tr_b16 a[36:37], v32 offset:16384
    v_mfma_f32_16x16x32_bf16 v[192:195], a[216:219], a[0:3], v[192:195]
    v_mfma_f32_16x16x32_bf16 v[128:131], a[224:227], a[0:3], v[128:131]
    v_mfma_f32_16x16x32_bf16 v[128:131], a[228:231], a[4:7], v[128:131]
    ds_read_b64_tr_b16 a[38:39], v32 offset:18432
    v_mfma_f32_16x16x32_bf16 v[224:227], a[236:239], a[4:7], v[224:227]
    v_mfma_f32_16x16x32_bf16 v[224:227], a[232:235], a[0:3], v[224:227]
    v_mfma_f32_16x16x32_bf16 a[128:131], a[240:243], a[0:3], a[128:131]
    ds_read_b64_tr_b16 a[40:41], v33 offset:0
    v_mfma_f32_16x16x32_bf16 a[128:131], a[244:247], a[4:7], a[128:131]
    v_mfma_f32_16x16x32_bf16 a[132:135], a[252:255], a[4:7], a[132:135]
    v_mfma_f32_16x16x32_bf16 a[132:135], a[248:251], a[0:3], a[132:135]
    ds_read_b64_tr_b16 a[42:43], v33 offset:2048
    v_mfma_f32_16x16x32_bf16 a[140:143], a[248:251], a[8:11], a[140:143]
    v_mfma_f32_16x16x32_bf16 a[140:143], a[252:255], a[12:15], a[140:143]
    v_mfma_f32_16x16x32_bf16 a[136:139], a[244:247], a[12:15], a[136:139]
    ds_read_b64_tr_b16 a[44:45], v33 offset:16384
    v_mfma_f32_16x16x32_bf16 a[136:139], a[240:243], a[8:11], a[136:139]
    v_mfma_f32_16x16x32_bf16 v[228:231], a[232:235], a[8:11], v[228:231]
    v_mfma_f32_16x16x32_bf16 v[228:231], a[236:239], a[12:15], v[228:231]
    ds_read_b64_tr_b16 a[46:47], v33 offset:18432
    v_mfma_f32_16x16x32_bf16 v[132:135], a[228:231], a[12:15], v[132:135]
    v_mfma_f32_16x16x32_bf16 v[132:135], a[224:227], a[8:11], v[132:135]
    ds_read_b64_tr_b16 a[48:49], v34 offset:0
    v_mfma_f32_16x16x32_bf16 v[196:199], a[216:219], a[8:11], v[196:199]
    v_mfma_f32_16x16x32_bf16 v[196:199], a[220:223], a[12:15], v[196:199]
    v_mfma_f32_16x16x32_bf16 v[100:103], a[212:215], a[12:15], v[100:103]
    ds_read_b64_tr_b16 a[50:51], v34 offset:2048
    v_mfma_f32_16x16x32_bf16 v[100:103], a[208:211], a[8:11], v[100:103]
    v_mfma_f32_16x16x32_bf16 v[164:167], a[200:203], a[8:11], v[164:167]
    v_mfma_f32_16x16x32_bf16 v[164:167], a[204:207], a[12:15], v[164:167]
    ds_read_b64_tr_b16 a[52:53], v34 offset:16384
    v_mfma_f32_16x16x32_bf16 v[68:71], a[196:199], a[12:15], v[68:71]
    v_mfma_f32_16x16x32_bf16 v[68:71], a[192:195], a[8:11], v[68:71]
    v_mfma_f32_16x16x32_bf16 v[72:75], a[192:195], a[16:19], v[72:75]
    ds_read_b64_tr_b16 a[54:55], v34 offset:18432
    v_mfma_f32_16x16x32_bf16 v[72:75], a[196:199], a[20:23], v[72:75]
    v_mfma_f32_16x16x32_bf16 v[168:171], a[204:207], a[20:23], v[168:171]
    v_mfma_f32_16x16x32_bf16 v[168:171], a[200:203], a[16:19], v[168:171]
    ds_read_b64_tr_b16 a[56:57], v35 offset:0
    v_mfma_f32_16x16x32_bf16 v[104:107], a[208:211], a[16:19], v[104:107]
    v_mfma_f32_16x16x32_bf16 v[104:107], a[212:215], a[20:23], v[104:107]
    v_mfma_f32_16x16x32_bf16 v[200:203], a[220:223], a[20:23], v[200:203]
    ds_read_b64_tr_b16 a[58:59], v35 offset:2048
    v_mfma_f32_16x16x32_bf16 v[200:203], a[216:219], a[16:19], v[200:203]
    v_mfma_f32_16x16x32_bf16 v[136:139], a[224:227], a[16:19], v[136:139]
    v_mfma_f32_16x16x32_bf16 v[136:139], a[228:231], a[20:23], v[136:139]
    ds_read_b64_tr_b16 a[60:61], v35 offset:16384
    v_mfma_f32_16x16x32_bf16 v[232:235], a[236:239], a[20:23], v[232:235]
    v_mfma_f32_16x16x32_bf16 v[232:235], a[232:235], a[16:19], v[232:235]
    v_mfma_f32_16x16x32_bf16 a[144:147], a[240:243], a[16:19], a[144:147]
    ds_read_b64_tr_b16 a[62:63], v35 offset:18432
    v_mfma_f32_16x16x32_bf16 a[144:147], a[244:247], a[20:23], a[144:147]
    v_mfma_f32_16x16x32_bf16 a[148:151], a[252:255], a[20:23], a[148:151]
    v_mfma_f32_16x16x32_bf16 a[148:151], a[248:251], a[16:19], a[148:151]
    v_mfma_f32_16x16x32_bf16 a[156:159], a[248:251], a[24:27], a[156:159]
    v_mfma_f32_16x16x32_bf16 a[156:159], a[252:255], a[28:31], a[156:159]
    v_mfma_f32_16x16x32_bf16 a[152:155], a[244:247], a[28:31], a[152:155]
    v_mfma_f32_16x16x32_bf16 a[152:155], a[240:243], a[24:27], a[152:155]
    v_mfma_f32_16x16x32_bf16 v[236:239], a[232:235], a[24:27], v[236:239]
    v_mfma_f32_16x16x32_bf16 v[236:239], a[236:239], a[28:31], v[236:239]
    v_mfma_f32_16x16x32_bf16 v[140:143], a[228:231], a[28:31], v[140:143]
    v_mfma_f32_16x16x32_bf16 v[140:143], a[224:227], a[24:27], v[140:143]
    v_mfma_f32_16x16x32_bf16 v[204:207], a[216:219], a[24:27], v[204:207]
    v_mfma_f32_16x16x32_bf16 v[204:207], a[220:223], a[28:31], v[204:207]
    v_mfma_f32_16x16x32_bf16 v[108:111], a[212:215], a[28:31], v[108:111]
    v_mfma_f32_16x16x32_bf16 v[108:111], a[208:211], a[24:27], v[108:111]
    v_mfma_f32_16x16x32_bf16 v[172:175], a[200:203], a[24:27], v[172:175]
    v_mfma_f32_16x16x32_bf16 v[172:175], a[204:207], a[28:31], v[172:175]
    v_mfma_f32_16x16x32_bf16 v[76:79], a[196:199], a[28:31], v[76:79]
    v_mfma_f32_16x16x32_bf16 v[76:79], a[192:195], a[24:27], v[76:79]
    s_waitcnt vmcnt(0) lgkmcnt(0)
    s_cmp_eq_u32 s51, s46
    s_cbranch_scc1 k12_ool_34
k12_oolret_35:
    s_barrier
    v_mfma_f32_16x16x32_bf16 v[80:83], a[192:195], a[32:35], v[80:83]
    s_cmp_ge_u32 s49, 1024
    s_cselect_b32 s18, 0, s18
    s_cselect_b32 s22, 0, s22
    v_mfma_f32_16x16x32_bf16 v[80:83], a[196:199], a[36:39], v[80:83]
    s_add_u32 m0, s48, 0
    ds_read_b128 a[64:67], v26 offset:32768
    v_mfma_f32_16x16x32_bf16 v[176:179], a[204:207], a[36:39], v[176:179]
    buffer_load_dwordx4 v10, s[16:19], s49 offen offset:0 lds
    ds_read_b64_tr_b16 a[0:1], v28 offset:32768
    v_mfma_f32_16x16x32_bf16 v[176:179], a[200:203], a[32:35], v[176:179]
    ds_read_b128 a[68:71], v27 offset:32768
    v_mfma_f32_16x16x32_bf16 v[112:115], a[208:211], a[32:35], v[112:115]
    buffer_load_dwordx4 v11, s[16:19], s49 offen offset:1024 lds
    v_mfma_f32_16x16x32_bf16 v[112:115], a[212:215], a[36:39], v[112:115]
    ds_read_b64_tr_b16 a[2:3], v28 offset:34816
    v_mfma_f32_16x16x32_bf16 v[208:211], a[220:223], a[36:39], v[208:211]
    v_mfma_f32_16x16x32_bf16 v[208:211], a[216:219], a[32:35], v[208:211]
    ds_read_b128 a[72:75], v26 offset:34816
    v_mfma_f32_16x16x32_bf16 v[144:147], a[224:227], a[32:35], v[144:147]
    buffer_load_dwordx4 v12, s[16:19], s49 offen offset:2048 lds
    ds_read_b64_tr_b16 a[4:5], v28 offset:49152
    v_mfma_f32_16x16x32_bf16 v[144:147], a[228:231], a[36:39], v[144:147]
    v_mfma_f32_16x16x32_bf16 v[240:243], a[236:239], a[36:39], v[240:243]
    ds_read_b128 a[76:79], v27 offset:34816
    v_mfma_f32_16x16x32_bf16 v[240:243], a[232:235], a[32:35], v[240:243]
    buffer_load_dwordx4 v13, s[16:19], s49 offen offset:3072 lds
    v_mfma_f32_16x16x32_bf16 a[160:163], a[240:243], a[32:35], a[160:163]
    ds_read_b64_tr_b16 a[6:7], v28 offset:51200
    v_mfma_f32_16x16x32_bf16 a[160:163], a[244:247], a[36:39], a[160:163]
    s_add_u32 m0, s48, 4096
    ds_read_b128 a[80:83], v26 offset:36864
    v_mfma_f32_16x16x32_bf16 a[164:167], a[252:255], a[36:39], a[164:167]
    v_mfma_f32_16x16x32_bf16 a[164:167], a[248:251], a[32:35], a[164:167]
    buffer_load_dwordx4 v14, s[16:19], s49 offen offset:0 lds
    ds_read_b64_tr_b16 a[8:9], v29 offset:32768
    v_mfma_f32_16x16x32_bf16 a[172:175], a[248:251], a[40:43], a[172:175]
    v_mfma_f32_16x16x32_bf16 a[172:175], a[252:255], a[44:47], a[172:175]
    ds_read_b128 a[84:87], v27 offset:36864
    v_mfma_f32_16x16x32_bf16 a[168:171], a[244:247], a[44:47], a[168:171]
    buffer_load_dwordx4 v15, s[16:19], s49 offen offset:1024 lds
    ds_read_b64_tr_b16 a[10:11], v29 offset:34816
    v_mfma_f32_16x16x32_bf16 a[168:171], a[240:243], a[40:43], a[168:171]
    v_mfma_f32_16x16x32_bf16 v[244:247], a[232:235], a[40:43], v[244:247]
    ds_read_b128 a[88:91], v26 offset:38912
    v_mfma_f32_16x16x32_bf16 v[244:247], a[236:239], a[44:47], v[244:247]
    v_mfma_f32_16x16x32_bf16 v[148:151], a[228:231], a[44:47], v[148:151]
    buffer_load_dwordx4 v16, s[16:19], s49 offen offset:2048 lds
    ds_read_b64_tr_b16 a[12:13], v29 offset:49152
    v_mfma_f32_16x16x32_bf16 v[148:151], a[224:227], a[40:43], v[148:151]
    ds_read_b128 a[92:95], v27 offset:38912
    v_mfma_f32_16x16x32_bf16 v[212:215], a[216:219], a[40:43], v[212:215]
    v_mfma_f32_16x16x32_bf16 v[212:215], a[220:223], a[44:47], v[212:215]
    buffer_load_dwordx4 v17, s[16:19], s49 offen offset:3072 lds
    ds_read_b64_tr_b16 a[14:15], v29 offset:51200
    v_mfma_f32_16x16x32_bf16 v[116:119], a[212:215], a[44:47], v[116:119]
    ds_read_b128 a[96:99], v26 offset:40960
    v_mfma_f32_16x16x32_bf16 v[116:119], a[208:211], a[40:43], v[116:119]
    s_add_u32 s49, s49, 128
    v_mfma_f32_16x16x32_bf16 v[180:183], a[200:203], a[40:43], v[180:183]
    s_add_u32 m0, s48, 65536
    ds_read_b64_tr_b16 a[16:17], v30 offset:32768
    v_mfma_f32_16x16x32_bf16 v[180:183], a[204:207], a[44:47], v[180:183]
    buffer_load_dwordx4 v18, s[20:23], s50 offen offset:0 lds
    v_mfma_f32_16x16x32_bf16 v[84:87], a[196:199], a[44:47], v[84:87]
    ds_read_b128 a[100:103], v27 offset:40960
    v_mfma_f32_16x16x32_bf16 v[84:87], a[192:195], a[40:43], v[84:87]
    ds_read_b64_tr_b16 a[18:19], v30 offset:34816
    v_mfma_f32_16x16x32_bf16 v[88:91], a[192:195], a[48:51], v[88:91]
    buffer_load_dwordx4 v19, s[20:23], s50 offen offset:1024 lds
    v_mfma_f32_16x16x32_bf16 v[88:91], a[196:199], a[52:55], v[88:91]
    ds_read_b128 a[104:107], v26 offset:43008
    v_mfma_f32_16x16x32_bf16 v[184:187], a[204:207], a[52:55], v[184:187]
    v_mfma_f32_16x16x32_bf16 v[184:187], a[200:203], a[48:51], v[184:187]
    buffer_load_dwordx4 v20, s[20:23], s50 offen offset:2048 lds
    ds_read_b64_tr_b16 a[20:21], v30 offset:49152
    v_mfma_f32_16x16x32_bf16 v[120:123], a[208:211], a[48:51], v[120:123]
    ds_read_b128 a[108:111], v27 offset:43008
    v_mfma_f32_16x16x32_bf16 v[120:123], a[212:215], a[52:55], v[120:123]
    v_mfma_f32_16x16x32_bf16 v[216:219], a[220:223], a[52:55], v[216:219]
    ds_read_b64_tr_b16 a[22:23], v30 offset:51200
    v_mfma_f32_16x16x32_bf16 v[216:219], a[216:219], a[48:51], v[216:219]
    buffer_load_dwordx4 v21, s[20:23], s50 offen offset:3072 lds
    v_mfma_f32_16x16x32_bf16 v[152:155], a[224:227], a[48:51], v[152:155]
    s_add_u32 m0, s48, 69632
    ds_read_b128 a[112:115], v26 offset:45056
    v_mfma_f32_16x16x32_bf16 v[152:155], a[228:231], a[52:55], v[152:155]
    ds_read_b64_tr_b16 a[24:25], v31 offset:32768
    v_mfma_f32_16x16x32_bf16 v[248:251], a[236:239], a[52:55], v[248:251]
    buffer_load_dwordx4 v22, s[20:23], s50 offen offset:0 lds
    v_mfma_f32_16x16x32_bf16 v[248:251], a[232:235], a[48:51], v[248:251]
    ds_read_b128 a[116:119], v27 offset:45056
    v_mfma_f32_16x16x32_bf16 a[176:179], a[240:243], a[48:51], a[176:179]
    v_mfma_f32_16x16x32_bf16 a[176:179], a[244:247], a[52:55], a[176:179]
    ds_read_b64_tr_b16 a[26:27], v31 offset:34816
    v_mfma_f32_16x16x32_bf16 a[180:183], a[252:255], a[52:55], a[180:183]
    buffer_load_dwordx4 v23, s[20:23], s50 offen offset:1024 lds
    ds_read_b128 a[120:123], v26 offset:47104
    v_mfma_f32_16x16x32_bf16 a[180:183], a[248:251], a[48:51], a[180:183]
    v_mfma_f32_16x16x32_bf16 a[188:191], a[248:251], a[56:59], a[188:191]
    ds_read_b64_tr_b16 a[28:29], v31 offset:49152
    v_mfma_f32_16x16x32_bf16 a[188:191], a[252:255], a[60:63], a[188:191]
    buffer_load_dwordx4 v24, s[20:23], s50 offen offset:2048 lds
    v_mfma_f32_16x16x32_bf16 a[184:187], a[244:247], a[60:63], a[184:187]
    ds_read_b128 a[124:127], v27 offset:47104
    v_mfma_f32_16x16x32_bf16 a[184:187], a[240:243], a[56:59], a[184:187]
    ds_read_b64_tr_b16 a[30:31], v31 offset:51200
    v_mfma_f32_16x16x32_bf16 v[252:255], a[232:235], a[56:59], v[252:255]
    v_mfma_f32_16x16x32_bf16 v[252:255], a[236:239], a[60:63], v[252:255]
    buffer_load_dwordx4 v25, s[20:23], s50 offen offset:3072 lds
    v_mfma_f32_16x16x32_bf16 v[156:159], a[228:231], a[60:63], v[156:159]
    v_mfma_f32_16x16x32_bf16 v[156:159], a[224:227], a[56:59], v[156:159]
    s_add_u32 s50, s50, 0x80000
    v_mfma_f32_16x16x32_bf16 v[220:223], a[216:219], a[56:59], v[220:223]
    v_mfma_f32_16x16x32_bf16 v[220:223], a[220:223], a[60:63], v[220:223]
    s_cmp_eq_u32 s51, s53
    s_cbranch_scc1 k12_ool_36
k12_oolret_37:
    v_mfma_f32_16x16x32_bf16 v[124:127], a[212:215], a[60:63], v[124:127]
    s_cmp_eq_u32 s51, s63
    s_cbranch_scc1 k12_ool_38
k12_oolret_39:
    v_mfma_f32_16x16x32_bf16 v[124:127], a[208:211], a[56:59], v[124:127]
    s_cmp_eq_u32 s51, 6
    s_cbranch_scc1 k12_ool_40
k12_oolret_41:
    v_mfma_f32_16x16x32_bf16 v[188:191], a[200:203], a[56:59], v[188:191]
    v_mfma_f32_16x16x32_bf16 v[188:191], a[204:207], a[60:63], v[188:191]
    s_add_u32 s51, s51, 1
    v_mfma_f32_16x16x32_bf16 v[92:95], a[196:199], a[60:63], v[92:95]
    v_mfma_f32_16x16x32_bf16 v[92:95], a[192:195], a[56:59], v[92:95]
    s_waitcnt lgkmcnt(0)
    s_cmp_eq_u32 s51, 7
    s_cbranch_scc1 k12_last_29
    v_mfma_f32_16x16x32_bf16 v[64:67], a[64:67], a[0:3], v[64:67]
    v_mfma_f32_16x16x32_bf16 v[64:67], a[68:71], a[4:7], v[64:67]
    ds_read_b64_tr_b16 a[32:33], v32 offset:32768
    v_mfma_f32_16x16x32_bf16 v[160:163], a[76:79], a[4:7], v[160:163]
    v_mfma_f32_16x16x32_bf16 v[160:163], a[72:75], a[0:3], v[160:163]
    ds_read_b64_tr_b16 a[34:35], v32 offset:34816
    v_mfma_f32_16x16x32_bf16 v[96:99], a[80:83], a[0:3], v[96:99]
    v_mfma_f32_16x16x32_bf16 v[96:99], a[84:87], a[4:7], v[96:99]
    v_mfma_f32_16x16x32_bf16 v[192:195], a[92:95], a[4:7], v[192:195]
    ds_read_b64_tr_b16 a[36:37], v32 offset:49152
    v_mfma_f32_16x16x32_bf16 v[192:195], a[88:91], a[0:3], v[192:195]
    v_mfma_f32_16x16x32_bf16 v[128:131], a[96:99], a[0:3], v[128:131]
    v_mfma_f32_16x16x32_bf16 v[128:131], a[100:103], a[4:7], v[128:131]
    ds_read_b64_tr_b16 a[38:39], v32 offset:51200
    v_mfma_f32_16x16x32_bf16 v[224:227], a[108:111], a[4:7], v[224:227]
    v_mfma_f32_16x16x32_bf16 v[224:227], a[104:107], a[0:3], v[224:227]
    v_mfma_f32_16x16x32_bf16 a[128:131], a[112:115], a[0:3], a[128:131]
    ds_read_b64_tr_b16 a[40:41], v33 offset:32768
    v_mfma_f32_16x16x32_bf16 a[128:131], a[116:119], a[4:7], a[128:131]
    v_mfma_f32_16x16x32_bf16 a[132:135], a[124:127], a[4:7], a[132:135]
    v_mfma_f32_16x16x32_bf16 a[132:135], a[120:123], a[0:3], a[132:135]
    ds_read_b64_tr_b16 a[42:43], v33 offset:34816
    v_mfma_f32_16x16x32_bf16 a[140:143], a[120:123], a[8:11], a[140:143]
    v_mfma_f32_16x16x32_bf16 a[140:143], a[124:127], a[12:15], a[140:143]
    v_mfma_f32_16x16x32_bf16 a[136:139], a[116:119], a[12:15], a[136:139]
    ds_read_b64_tr_b16 a[44:45], v33 offset:49152
    v_mfma_f32_16x16x32_bf16 a[136:139], a[112:115], a[8:11], a[136:139]
    v_mfma_f32_16x16x32_bf16 v[228:231], a[104:107], a[8:11], v[228:231]
    v_mfma_f32_16x16x32_bf16 v[228:231], a[108:111], a[12:15], v[228:231]
    ds_read_b64_tr_b16 a[46:47], v33 offset:51200
    v_mfma_f32_16x16x32_bf16 v[132:135], a[100:103], a[12:15], v[132:135]
    v_mfma_f32_16x16x32_bf16 v[132:135], a[96:99], a[8:11], v[132:135]
    ds_read_b64_tr_b16 a[48:49], v34 offset:32768
    v_mfma_f32_16x16x32_bf16 v[196:199], a[88:91], a[8:11], v[196:199]
    v_mfma_f32_16x16x32_bf16 v[196:199], a[92:95], a[12:15], v[196:199]
    v_mfma_f32_16x16x32_bf16 v[100:103], a[84:87], a[12:15], v[100:103]
    ds_read_b64_tr_b16 a[50:51], v34 offset:34816
    v_mfma_f32_16x16x32_bf16 v[100:103], a[80:83], a[8:11], v[100:103]
    v_mfma_f32_16x16x32_bf16 v[164:167], a[72:75], a[8:11], v[164:167]
    v_mfma_f32_16x16x32_bf16 v[164:167], a[76:79], a[12:15], v[164:167]
    ds_read_b64_tr_b16 a[52:53], v34 offset:49152
    v_mfma_f32_16x16x32_bf16 v[68:71], a[68:71], a[12:15], v[68:71]
    v_mfma_f32_16x16x32_bf16 v[68:71], a[64:67], a[8:11], v[68:71]
    v_mfma_f32_16x16x32_bf16 v[72:75], a[64:67], a[16:19], v[72:75]
    ds_read_b64_tr_b16 a[54:55], v34 offset:51200
    v_mfma_f32_16x16x32_bf16 v[72:75], a[68:71], a[20:23], v[72:75]
    v_mfma_f32_16x16x32_bf16 v[168:171], a[76:79], a[20:23], v[168:171]
    v_mfma_f32_16x16x32_bf16 v[168:171], a[72:75], a[16:19], v[168:171]
    ds_read_b64_tr_b16 a[56:57], v35 offset:32768
    v_mfma_f32_16x16x32_bf16 v[104:107], a[80:83], a[16:19], v[104:107]
    v_mfma_f32_16x16x32_bf16 v[104:107], a[84:87], a[20:23], v[104:107]
    v_mfma_f32_16x16x32_bf16 v[200:203], a[92:95], a[20:23], v[200:203]
    ds_read_b64_tr_b16 a[58:59], v35 offset:34816
    v_mfma_f32_16x16x32_bf16 v[200:203], a[88:91], a[16:19], v[200:203]
    v_mfma_f32_16x16x32_bf16 v[136:139], a[96:99], a[16:19], v[136:139]
    v_mfma_f32_16x16x32_bf16 v[136:139], a[100:103], a[20:23], v[136:139]
    ds_read_b64_tr_b16 a[60:61], v35 offset:49152
    v_mfma_f32_16x16x32_bf16 v[232:235], a[108:111], a[20:23], v[232:235]
    v_mfma_f32_16x16x32_bf16 v[232:235], a[104:107], a[16:19], v[232:235]
    v_mfma_f32_16x16x32_bf16 a[144:147], a[112:115], a[16:19], a[144:147]
    ds_read_b64_tr_b16 a[62:63], v35 offset:51200
    v_mfma_f32_16x16x32_bf16 a[144:147], a[116:119], a[20:23], a[144:147]
    v_mfma_f32_16x16x32_bf16 a[148:151], a[124:127], a[20:23], a[148:151]
    v_mfma_f32_16x16x32_bf16 a[148:151], a[120:123], a[16:19], a[148:151]
    v_mfma_f32_16x16x32_bf16 a[156:159], a[120:123], a[24:27], a[156:159]
    v_mfma_f32_16x16x32_bf16 a[156:159], a[124:127], a[28:31], a[156:159]
    v_mfma_f32_16x16x32_bf16 a[152:155], a[116:119], a[28:31], a[152:155]
    v_mfma_f32_16x16x32_bf16 a[152:155], a[112:115], a[24:27], a[152:155]
    v_mfma_f32_16x16x32_bf16 v[236:239], a[104:107], a[24:27], v[236:239]
    v_mfma_f32_16x16x32_bf16 v[236:239], a[108:111], a[28:31], v[236:239]
    v_mfma_f32_16x16x32_bf16 v[140:143], a[100:103], a[28:31], v[140:143]
    v_mfma_f32_16x16x32_bf16 v[140:143], a[96:99], a[24:27], v[140:143]
    v_mfma_f32_16x16x32_bf16 v[204:207], a[88:91], a[24:27], v[204:207]
    v_mfma_f32_16x16x32_bf16 v[204:207], a[92:95], a[28:31], v[204:207]
    v_mfma_f32_16x16x32_bf16 v[108:111], a[84:87], a[28:31], v[108:111]
    v_mfma_f32_16x16x32_bf16 v[108:111], a[80:83], a[24:27], v[108:111]
    v_mfma_f32_16x16x32_bf16 v[172:175], a[72:75], a[24:27], v[172:175]
    v_mfma_f32_16x16x32_bf16 v[172:175], a[76:79], a[28:31], v[172:175]
    v_mfma_f32_16x16x32_bf16 v[76:79], a[68:71], a[28:31], v[76:79]
    v_mfma_f32_16x16x32_bf16 v[76:79], a[64:67], a[24:27], v[76:79]
    s_waitcnt vmcnt(0) lgkmcnt(0)
    s_barrier
    v_mfma_f32_16x16x32_bf16 v[80:83], a[64:67], a[32:35], v[80:83]
    v_mfma_f32_16x16x32_bf16 v[80:83], a[68:71], a[36:39], v[80:83]
    s_add_u32 m0, s48, 32768
    ds_read_b128 a[192:195], v26 offset:0
    v_mfma_f32_16x16x32_bf16 v[176:179], a[76:79], a[36:39], v[176:179]
    buffer_load_dwordx4 v10, s[16:19], s49 offen offset:0 lds
    ds_read_b64_tr_b16 a[0:1], v28 offset:0
    v_mfma_f32_16x16x32_bf16 v[176:179], a[72:75], a[32:35], v[176:179]
    ds_read_b128 a[196:199], v27 offset:0
    v_mfma_f32_16x16x32_bf16 v[112:115], a[80:83], a[32:35], v[112:115]
    buffer_load_dwordx4 v11, s[16:19], s49 offen offset:1024 lds
    v_mfma_f32_16x16x32_bf16 v[112:115], a[84:87], a[36:39], v[112:115]
    ds_read_b64_tr_b16 a[2:3], v28 offset:2048
    v_mfma_f32_16x16x32_bf16 v[208:211], a[92:95], a[36:39], v[208:211]
    v_mfma_f32_16x16x32_bf16 v[208:211], a[88:91], a[32:35], v[208:211]
    ds_read_b128 a[200:203], v26 offset:2048
    v_mfma_f32_16x16x32_bf16 v[144:147], a[96:99], a[32:35], v[144:147]
    buffer_load_dwordx4 v12, s[16:19], s49 offen offset:2048 lds
    ds_read_b64_tr_b16 a[4:5], v28 offset:16384
    v_mfma_f32_16x16x32_bf16 v[144:147], a[100:103], a[36:39], v[144:147]
    v_mfma_f32_16x16x32_bf16 v[240:243], a[108:111], a[36:39], v[240:243]
    ds_read_b128 a[204:207], v27 offset:2048
    v_mfma_f32_16x16x32_bf16 v[240:243], a[104:107], a[32:35], v[240:243]
    buffer_load_dwordx4 v13, s[16:19], s49 offen offset:3072 lds
    v_mfma_f32_16x16x32_bf16 a[160:163], a[112:115], a[32:35], a[160:163]
    ds_read_b64_tr_b16 a[6:7], v28 offset:18432
    v_mfma_f32_16x16x32_bf16 a[160:163], a[116:119], a[36:39], a[160:163]
    s_add_u32 m0, s48, 36864
    ds_read_b128 a[208:211], v26 offset:4096
    v_mfma_f32_16x16x32_bf16 a[164:167], a[124:127], a[36:39], a[164:167]
    v_mfma_f32_16x16x32_bf16 a[164:167], a[120:123], a[32:35], a[164:167]
    buffer_load_dwordx4 v14, s[16:19], s49 offen offset:0 lds
    ds_read_b64_tr_b16 a[8:9], v29 offset:0
    v_mfma_f32_16x16x32_bf16 a[172:175], a[120:123], a[40:43], a[172:175]
    v_mfma_f32_16x16x32_bf16 a[172:175], a[124:127], a[44:47], a[172:175]
    ds_read_b128 a[212:215], v27 offset:4096
    v_mfma_f32_16x16x32_bf16 a[168:171], a[116:119], a[44:47], a[168:171]
    buffer_load_dwordx4 v15, s[16:19], s49 offen offset:1024 lds
    ds_read_b64_tr_b16 a[10:11], v29 offset:2048
    v_mfma_f32_16x16x32_bf16 a[168:171], a[112:115], a[40:43], a[168:171]
    v_mfma_f32_16x16x32_bf16 v[244:247], a[104:107], a[40:43], v[244:247]
    ds_read_b128 a[216:219], v26 offset:6144
    v_mfma_f32_16x16x32_bf16 v[244:247], a[108:111], a[44:47], v[244:247]
    v_mfma_f32_16x16x32_bf16 v[148:151], a[100:103], a[44:47], v[148:151]
    buffer_load_dwordx4 v16, s[16:19], s49 offen offset:2048 lds
    ds_read_b64_tr_b16 a[12:13], v29 offset:16384
    v_mfma_f32_16x16x32_bf16 v[148:151], a[96:99], a[40:43], v[148:151]
    ds_read_b128 a[220:223], v27 offset:6144
    v_mfma_f32_16x16x32_bf16 v[212:215], a[88:91], a[40:43], v[212:215]
    v_mfma_f32_16x16x32_bf16 v[212:215], a[92:95], a[44:47], v[212:215]
    buffer_load_dwordx4 v17, s[16:19], s49 offen offset:3072 lds
    ds_read_b64_tr_b16 a[14:15], v29 offset:18432
    v_mfma_f32_16x16x32_bf16 v[116:119], a[84:87], a[44:47], v[116:119]
    ds_read_b128 a[224:227], v26 offset:8192
    v_mfma_f32_16x16x32_bf16 v[116:119], a[80:83], a[40:43], v[116:119]
    s_add_u32 s49, s49, 128
    v_mfma_f32_16x16x32_bf16 v[180:183], a[72:75], a[40:43], v[180:183]
    s_add_u32 m0, s48, 98304
    ds_read_b64_tr_b16 a[16:17], v30 offset:0
    v_mfma_f32_16x16x32_bf16 v[180:183], a[76:79], a[44:47], v[180:183]
    buffer_load_dwordx4 v18, s[20:23], s50 offen offset:0 lds
    v_mfma_f32_16x16x32_bf16 v[84:87], a[68:71], a[44:47], v[84:87]
    ds_read_b128 a[228:231], v27 offset:8192
    v_mfma_f32_16x16x32_bf16 v[84:87], a[64:67], a[40:43], v[84:87]
    ds_read_b64_tr_b16 a[18:19], v30 offset:2048
    v_mfma_f32_16x16x32_bf16 v[88:91], a[64:67], a[48:51], v[88:91]
    buffer_load_dwordx4 v19, s[20:23], s50 offen offset:1024 lds
    v_mfma_f32_16x16x32_bf16 v[88:91], a[68:71], a[52:55], v[88:91]
    ds_read_b128 a[232:235], v26 offset:10240
    v_mfma_f32_16x16x32_bf16 v[184:187], a[76:79], a[52:55], v[184:187]
    v_mfma_f32_16x16x32_bf16 v[184:187], a[72:75], a[48:51], v[184:187]
    buffer_load_dwordx4 v20, s[20:23], s50 offen offset:2048 lds
    ds_read_b64_tr_b16 a[20:21], v30 offset:16384
    v_mfma_f32_16x16x32_bf16 v[120:123], a[80:83], a[48:51], v[120:123]
    ds_read_b128 a[236:239], v27 offset:10240
    v_mfma_f32_16x16x32_bf16 v[120:123], a[84:87], a[52:55], v[120:123]
    v_mfma_f32_16x16x32_bf16 v[216:219], a[92:95], a[52:55], v[216:219]
    ds_read_b64_tr_b16 a[22:23], v30 offset:18432
    v_mfma_f32_16x16x32_bf16 v[216:219], a[88:91], a[48:51], v[216:219]
    buffer_load_dwordx4 v21, s[20:23], s50 offen offset:3072 lds
    v_mfma_f32_16x16x32_bf16 v[152:155], a[96:99], a[48:51], v[152:155]
    s_add_u32 m0, s48, 102400
    ds_read_b128 a[240:243], v26 offset:12288
    v_mfma_f32_16x16x32_bf16 v[152:155], a[100:103], a[52:55], v[152:155]
    ds_read_b64_tr_b16 a[24:25], v31 offset:0
    v_mfma_f32_16x16x32_bf16 v[248:251], a[108:111], a[52:55], v[248:251]
    buffer_load_dwordx4 v22, s[20:23], s50 offen offset:0 lds
    v_mfma_f32_16x16x32_bf16 v[248:251], a[104:107], a[48:51], v[248:251]
    ds_read_b128 a[244:247], v27 offset:12288
    v_mfma_f32_16x16x32_bf16 a[176:179], a[112:115], a[48:51], a[176:179]
    v_mfma_f32_16x16x32_bf16 a[176:179], a[116:119], a[52:55], a[176:179]
    ds_read_b64_tr_b16 a[26:27], v31 offset:2048
    v_mfma_f32_16x16x32_bf16 a[180:183], a[124:127], a[52:55], a[180:183]
    buffer_load_dwordx4 v23, s[20:23], s50 offen offset:1024 lds
    ds_read_b128 a[248:251], v26 offset:14336
    v_mfma_f32_16x16x32_bf16 a[180:183], a[120:123], a[48:51], a[180:183]
    v_mfma_f32_16x16x32_bf16 a[188:191], a[120:123], a[56:59], a[188:191]
    ds_read_b64_tr_b16 a[28:29], v31 offset:16384
    v_mfma_f32_16x16x32_bf16 a[188:191], a[124:127], a[60:63], a[188:191]
    buffer_load_dwordx4 v24, s[20:23], s50 offen offset:2048 lds
    v_mfma_f32_16x16x32_bf16 a[184:187], a[116:119], a[60:63], a[184:187]
    ds_read_b128 a[252:255], v27 offset:14336
    v_mfma_f32_16x16x32_bf16 a[184:187], a[112:115], a[56:59], a[184:187]
    ds_read_b64_tr_b16 a[30:31], v31 offset:18432
    v_mfma_f32_16x16x32_bf16 v[252:255], a[104:107], a[56:59], v[252:255]
    v_mfma_f32_16x16x32_bf16 v[252:255], a[108:111], a[60:63], v[252:255]
    buffer_load_dwordx4 v25, s[20:23], s50 offen offset:3072 lds
    v_mfma_f32_16x16x32_bf16 v[156:159], a[100:103], a[60:63], v[156:159]
    v_mfma_f32_16x16x32_bf16 v[156:159], a[96:99], a[56:59], v[156:159]
    s_add_u32 s50, s50, 0x80000
    v_mfma_f32_16x16x32_bf16 v[220:223], a[88:91], a[56:59], v[220:223]
    v_mfma_f32_16x16x32_bf16 v[220:223], a[92:95], a[60:63], v[220:223]
    s_cmp_eq_u32 s51, s53
    s_cbranch_scc1 k12_ool_42
k12_oolret_43:
    v_mfma_f32_16x16x32_bf16 v[124:127], a[84:87], a[60:63], v[124:127]
    s_cmp_eq_u32 s51, s63
    s_cbranch_scc1 k12_ool_44
k12_oolret_45:
    v_mfma_f32_16x16x32_bf16 v[124:127], a[80:83], a[56:59], v[124:127]
    s_cmp_eq_u32 s51, 5
    s_cbranch_scc1 k12_ool_46
k12_oolret_47:
    v_mfma_f32_16x16x32_bf16 v[188:191], a[72:75], a[56:59], v[188:191]
    v_mfma_f32_16x16x32_bf16 v[188:191], a[76:79], a[60:63], v[188:191]
    s_add_u32 s51, s51, 1
    v_mfma_f32_16x16x32_bf16 v[92:95], a[68:71], a[60:63], v[92:95]
    v_mfma_f32_16x16x32_bf16 v[92:95], a[64:67], a[56:59], v[92:95]
    s_waitcnt lgkmcnt(0)
    s_branch k12_loop_28
k12_last_29:
    v_mfma_f32_16x16x32_bf16 v[64:67], a[64:67], a[0:3], v[64:67]
    buffer_load_dwordx4 a[192:195], v36, s[8:11], s62 offen sc1
    v_mfma_f32_16x16x32_bf16 v[64:67], a[68:71], a[4:7], v[64:67]
    ds_read_b64_tr_b16 a[32:33], v32 offset:32768
    v_mfma_f32_16x16x32_bf16 v[160:163], a[76:79], a[4:7], v[160:163]
    buffer_load_dwordx4 a[196:199], v54, s[8:11], s62 offen sc1
    ds_read_b64_tr_b16 a[34:35], v32 offset:34816
    v_mfma_f32_16x16x32_bf16 v[160:163], a[72:75], a[0:3], v[160:163]
    v_mfma_f32_16x16x32_bf16 v[96:99], a[80:83], a[0:3], v[96:99]
    buffer_load_dwordx4 a[200:203], v37, s[8:11], s62 offen sc1
    v_mfma_f32_16x16x32_bf16 v[96:99], a[84:87], a[4:7], v[96:99]
    ds_read_b64_tr_b16 a[36:37], v32 offset:49152
    v_mfma_f32_16x16x32_bf16 v[192:195], a[92:95], a[4:7], v[192:195]
    buffer_load_dwordx4 a[204:207], v55, s[8:11], s62 offen sc1
    v_mfma_f32_16x16x32_bf16 v[192:195], a[88:91], a[0:3], v[192:195]
    s_add_u32 s62, s62, 0x20000
    buffer_load_dwordx4 a[208:211], v36, s[8:11], s62 offen sc1
    ds_read_b64_tr_b16 a[38:39], v32 offset:51200
    v_mfma_f32_16x16x32_bf16 v[128:131], a[96:99], a[0:3], v[128:131]
    v_mfma_f32_16x16x32_bf16 v[128:131], a[100:103], a[4:7], v[128:131]
    v_cvt_pk_bf16_f32 v64, v64, v65
    v_cvt_pk_bf16_f32 v65, v66, v67
    v_mfma_f32_16x16x32_bf16 v[224:227], a[108:111], a[4:7], v[224:227]
    v_cvt_pk_bf16_f32 v66, v160, v161
    v_cvt_pk_bf16_f32 v67, v162, v163
    v_mfma_f32_16x16x32_bf16 v[224:227], a[104:107], a[0:3], v[224:227]
    buffer_load_dwordx4 a[212:215], v54, s[8:11], s62 offen sc1
    ds_read_b64_tr_b16 a[40:41], v33 offset:32768
    v_mfma_f32_16x16x32_bf16 a[128:131], a[112:115], a[0:3], a[128:131]
    buffer_load_dwordx4 a[216:219], v37, s[8:11], s62 offen sc1
    ds_read_b64_tr_b16 a[42:43], v33 offset:34816
    v_mfma_f32_16x16x32_bf16 a[128:131], a[116:119], a[4:7], a[128:131]
    v_cvt_pk_bf16_f32 v96, v96, v97
    v_cvt_pk_bf16_f32 v97, v98, v99
    v_mfma_f32_16x16x32_bf16 a[132:135], a[124:127], a[4:7], a[132:135]
    v_cvt_pk_bf16_f32 v98, v192, v193
    v_cvt_pk_bf16_f32 v99, v194, v195
    v_mfma_f32_16x16x32_bf16 a[132:135], a[120:123], a[0:3], a[132:135]
    buffer_load_dwordx4 a[220:223], v55, s[8:11], s62 offen sc1
    ds_read_b64_tr_b16 a[44:45], v33 offset:49152
    v_mfma_f32_16x16x32_bf16 v[68:71], a[64:67], a[8:11], v[68:71]
    s_add_u32 s62, s62, 0x20000
    buffer_load_dwordx4 a[224:227], v36, s[8:11], s62 offen sc1
    v_mfma_f32_16x16x32_bf16 v[68:71], a[68:71], a[12:15], v[68:71]
    v_cvt_pk_bf16_f32 v128, v128, v129
    v_cvt_pk_bf16_f32 v129, v130, v131
    v_mfma_f32_16x16x32_bf16 v[164:167], a[76:79], a[12:15], v[164:167]
    buffer_load_dwordx4 a[228:231], v54, s[8:11], s62 offen sc1
    ds_read_b64_tr_b16 a[46:47], v33 offset:51200
    v_mfma_f32_16x16x32_bf16 v[164:167], a[72:75], a[8:11], v[164:167]
    v_cvt_pk_bf16_f32 v130, v224, v225
    v_cvt_pk_bf16_f32 v131, v226, v227
    v_mfma_f32_16x16x32_bf16 v[100:103], a[80:83], a[8:11], v[100:103]
    buffer_load_dwordx4 a[232:235], v37, s[8:11], s62 offen sc1
    ds_read_b64_tr_b16 a[48:49], v34 offset:32768
    v_mfma_f32_16x16x32_bf16 v[100:103], a[84:87], a[12:15], v[100:103]
    v_accvgpr_read_b32 v56, a128
    v_accvgpr_read_b32 v57, a129
    v_mfma_f32_16x16x32_bf16 v[196:199], a[92:95], a[12:15], v[196:199]
    buffer_load_dwordx4 a[236:239], v55, s[8:11], s62 offen sc1
    ds_read_b64_tr_b16 a[50:51], v34 offset:34816
    v_mfma_f32_16x16x32_bf16 v[196:199], a[88:91], a[8:11], v[196:199]
    s_add_u32 s62, s62, 0x20000
    v_accvgpr_read_b32 v58, a130
    v_accvgpr_read_b32 v59, a131
    v_mfma_f32_16x16x32_bf16 v[132:135], a[96:99], a[8:11], v[132:135]
    v_accvgpr_read_b32 v60, a132
    v_accvgpr_read_b32 v61, a133
    v_mfma_f32_16x16x32_bf16 v[132:135], a[100:103], a[12:15], v[132:135]
    v_accvgpr_read_b32 v62, a134
    v_accvgpr_read_b32 v63, a135
    v_mfma_f32_16x16x32_bf16 v[228:231], a[108:111], a[12:15], v[228:231]
    buffer_load_dwordx4 a[240:243], v36, s[8:11], s62 offen sc1
    ds_read_b64_tr_b16 a[52:53], v34 offset:49152
    v_mfma_f32_16x16x32_bf16 v[228:231], a[104:107], a[8:11], v[228:231]
    v_cvt_pk_bf16_f32 v160, v56, v57
    v_cvt_pk_bf16_f32 v161, v58, v59
    v_mfma_f32_16x16x32_bf16 a[136:139], a[112:115], a[8:11], a[136:139]
    v_cvt_pk_bf16_f32 v68, v68, v69
    v_cvt_pk_bf16_f32 v162, v60, v61
    v_mfma_f32_16x16x32_bf16 a[136:139], a[116:119], a[12:15], a[136:139]
    buffer_load_dwordx4 a[244:247], v54, s[8:11], s62 offen sc1
    v_cvt_pk_bf16_f32 v69, v70, v71
    v_mfma_f32_16x16x32_bf16 a[140:143], a[124:127], a[12:15], a[140:143]
    v_cvt_pk_bf16_f32 v163, v62, v63
    v_cvt_pk_bf16_f32 v70, v164, v165
    v_mfma_f32_16x16x32_bf16 a[140:143], a[120:123], a[8:11], a[140:143]
    buffer_load_dwordx4 a[248:251], v37, s[8:11], s62 offen sc1
    v_cvt_pk_bf16_f32 v71, v166, v167
    v_mfma_f32_16x16x32_bf16 v[72:75], a[64:67], a[16:19], v[72:75]
    ds_read_b64_tr_b16 a[54:55], v34 offset:51200
    v_cvt_pk_bf16_f32 v100, v100, v101
    v_mfma_f32_16x16x32_bf16 v[72:75], a[68:71], a[20:23], v[72:75]
    buffer_load_dwordx4 a[252:255], v55, s[8:11], s62 offen sc1
    v_cvt_pk_bf16_f32 v101, v102, v103
    v_mfma_f32_16x16x32_bf16 v[168:171], a[76:79], a[20:23], v[168:171]
    s_add_u32 s62, s62, 0x20000
    ds_read_b64_tr_b16 a[56:57], v35 offset:32768
    v_cvt_pk_bf16_f32 v102, v196, v197
    v_mfma_f32_16x16x32_bf16 v[168:171], a[72:75], a[16:19], v[168:171]
    s_add_u32 s52, s47, 0
    ds_read_b64_tr_b16 a[58:59], v35 offset:34816
    v_cvt_pk_bf16_f32 v103, v198, v199
    v_mfma_f32_16x16x32_bf16 v[104:107], a[80:83], a[16:19], v[104:107]
    v_cvt_pk_bf16_f32 v132, v132, v133
    v_cvt_pk_bf16_f32 v133, v134, v135
    v_mfma_f32_16x16x32_bf16 v[104:107], a[84:87], a[20:23], v[104:107]
    v_cvt_pk_bf16_f32 v134, v228, v229
    v_cvt_pk_bf16_f32 v135, v230, v231
    v_mfma_f32_16x16x32_bf16 v[200:203], a[92:95], a[20:23], v[200:203]
    buffer_store_dwordx4 v[64:67], v1, s[32:35], s52 offen offset:0 sc1
    ds_read_b64_tr_b16 a[60:61], v35 offset:49152
    v_mfma_f32_16x16x32_bf16 v[200:203], a[88:91], a[16:19], v[200:203]
    v_accvgpr_read_b32 v56, a136
    v_accvgpr_read_b32 v57, a137
    v_mfma_f32_16x16x32_bf16 v[136:139], a[96:99], a[16:19], v[136:139]
    ds_read_b64_tr_b16 a[62:63], v35 offset:51200
    v_accvgpr_read_b32 v58, a138
    v_mfma_f32_16x16x32_bf16 v[136:139], a[100:103], a[20:23], v[136:139]
    v_accvgpr_read_b32 v59, a139
    v_accvgpr_read_b32 v60, a140
    v_mfma_f32_16x16x32_bf16 v[232:235], a[108:111], a[20:23], v[232:235]
    v_accvgpr_read_b32 v61, a141
    v_accvgpr_read_b32 v62, a142
    v_mfma_f32_16x16x32_bf16 v[232:235], a[104:107], a[16:19], v[232:235]
    s_add_u32 s52, s47, 8192
    v_accvgpr_read_b32 v63, a143
    v_cvt_pk_bf16_f32 v164, v56, v57
    v_mfma_f32_16x16x32_bf16 a[144:147], a[112:115], a[16:19], a[144:147]
    v_cvt_pk_bf16_f32 v165, v58, v59
    v_cvt_pk_bf16_f32 v72, v72, v73
    v_mfma_f32_16x16x32_bf16 a[144:147], a[116:119], a[20:23], a[144:147]
    v_cvt_pk_bf16_f32 v166, v60, v61
    v_cvt_pk_bf16_f32 v73, v74, v75
    v_mfma_f32_16x16x32_bf16 a[148:151], a[124:127], a[20:23], a[148:151]
    v_cvt_pk_bf16_f32 v167, v62, v63
    v_cvt_pk_bf16_f32 v74, v168, v169
    v_mfma_f32_16x16x32_bf16 a[148:151], a[120:123], a[16:19], a[148:151]
    v_cvt_pk_bf16_f32 v75, v170, v171
    v_cvt_pk_bf16_f32 v104, v104, v105
    v_mfma_f32_16x16x32_bf16 v[76:79], a[64:67], a[24:27], v[76:79]
    v_cvt_pk_bf16_f32 v105, v106, v107
    v_cvt_pk_bf16_f32 v106, v200, v201
    v_mfma_f32_16x16x32_bf16 v[76:79], a[68:71], a[28:31], v[76:79]
    buffer_store_dwordx4 v[96:99], v1, s[32:35], s52 offen offset:0 sc1
    v_mfma_f32_16x16x32_bf16 v[172:175], a[76:79], a[28:31], v[172:175]
    v_cvt_pk_bf16_f32 v107, v202, v203
    v_cvt_pk_bf16_f32 v136, v136, v137
    v_mfma_f32_16x16x32_bf16 v[172:175], a[72:75], a[24:27], v[172:175]
    v_cvt_pk_bf16_f32 v137, v138, v139
    v_cvt_pk_bf16_f32 v138, v232, v233
    v_mfma_f32_16x16x32_bf16 v[108:111], a[80:83], a[24:27], v[108:111]
    v_cvt_pk_bf16_f32 v139, v234, v235
    v_mfma_f32_16x16x32_bf16 v[108:111], a[84:87], a[28:31], v[108:111]
    v_accvgpr_read_b32 v56, a144
    v_accvgpr_read_b32 v57, a145
    v_mfma_f32_16x16x32_bf16 v[204:207], a[92:95], a[28:31], v[204:207]
    v_accvgpr_read_b32 v58, a146
    v_accvgpr_read_b32 v59, a147
    v_mfma_f32_16x16x32_bf16 v[204:207], a[88:91], a[24:27], v[204:207]
    s_add_u32 s52, s47, 524288
    v_accvgpr_read_b32 v60, a148
    v_accvgpr_read_b32 v61, a149
    v_mfma_f32_16x16x32_bf16 v[140:143], a[96:99], a[24:27], v[140:143]
    v_accvgpr_read_b32 v62, a150
    v_accvgpr_read_b32 v63, a151
    v_mfma_f32_16x16x32_bf16 v[140:143], a[100:103], a[28:31], v[140:143]
    v_cvt_pk_bf16_f32 v168, v56, v57
    v_cvt_pk_bf16_f32 v169, v58, v59
    v_mfma_f32_16x16x32_bf16 v[236:239], a[108:111], a[28:31], v[236:239]
    v_cvt_pk_bf16_f32 v76, v76, v77
    v_cvt_pk_bf16_f32 v170, v60, v61
    v_mfma_f32_16x16x32_bf16 v[236:239], a[104:107], a[24:27], v[236:239]
    buffer_store_dwordx4 v[128:131], v1, s[32:35], s52 offen offset:0 sc1
    v_mfma_f32_16x16x32_bf16 a[152:155], a[112:115], a[24:27], a[152:155]
    s_waitcnt lgkmcnt(0)
    v_cvt_pk_bf16_f32 v77, v78, v79
    v_cvt_pk_bf16_f32 v171, v62, v63
    v_mfma_f32_16x16x32_bf16 a[152:155], a[116:119], a[28:31], a[152:155]
    v_cvt_pk_bf16_f32 v78, v172, v173
    v_cvt_pk_bf16_f32 v79, v174, v175
    v_mfma_f32_16x16x32_bf16 a[156:159], a[124:127], a[28:31], a[156:159]
    v_cvt_pk_bf16_f32 v108, v108, v109
    v_cvt_pk_bf16_f32 v109, v110, v111
    v_mfma_f32_16x16x32_bf16 a[156:159], a[120:123], a[24:27], a[156:159]
    v_cvt_pk_bf16_f32 v110, v204, v205
    v_cvt_pk_bf16_f32 v111, v206, v207
    v_mfma_f32_16x16x32_bf16 v[80:83], a[64:67], a[32:35], v[80:83]
    v_mfma_f32_16x16x32_bf16 v[80:83], a[68:71], a[36:39], v[80:83]
    v_cvt_pk_bf16_f32 v140, v140, v141
    v_cvt_pk_bf16_f32 v141, v142, v143
    v_mfma_f32_16x16x32_bf16 v[176:179], a[76:79], a[36:39], v[176:179]
    s_add_u32 s52, s47, 532480
    v_cvt_pk_bf16_f32 v142, v236, v237
    v_cvt_pk_bf16_f32 v143, v238, v239
    v_mfma_f32_16x16x32_bf16 v[176:179], a[72:75], a[32:35], v[176:179]
    buffer_store_dwordx4 v[160:163], v1, s[32:35], s52 offen offset:0 sc1
    v_mfma_f32_16x16x32_bf16 v[112:115], a[80:83], a[32:35], v[112:115]
    v_mfma_f32_16x16x32_bf16 v[112:115], a[84:87], a[36:39], v[112:115]
    v_accvgpr_read_b32 v56, a152
    v_accvgpr_read_b32 v57, a153
    v_mfma_f32_16x16x32_bf16 v[208:211], a[92:95], a[36:39], v[208:211]
    v_accvgpr_read_b32 v58, a154
    v_accvgpr_read_b32 v59, a155
    v_mfma_f32_16x16x32_bf16 v[208:211], a[88:91], a[32:35], v[208:211]
    v_accvgpr_read_b32 v60, a156
    v_accvgpr_read_b32 v61, a157
    v_mfma_f32_16x16x32_bf16 v[144:147], a[96:99], a[32:35], v[144:147]
    v_accvgpr_read_b32 v62, a158
    v_accvgpr_read_b32 v63, a159
    v_mfma_f32_16x16x32_bf16 v[144:147], a[100:103], a[36:39], v[144:147]
    v_cvt_pk_bf16_f32 v172, v56, v57
    v_cvt_pk_bf16_f32 v173, v58, v59
    v_mfma_f32_16x16x32_bf16 v[240:243], a[108:111], a[36:39], v[240:243]
    v_cvt_pk_bf16_f32 v80, v80, v81
    v_cvt_pk_bf16_f32 v174, v60, v61
    v_mfma_f32_16x16x32_bf16 v[240:243], a[104:107], a[32:35], v[240:243]
    v_cvt_pk_bf16_f32 v81, v82, v83
    v_cvt_pk_bf16_f32 v175, v62, v63
    v_mfma_f32_16x16x32_bf16 a[160:163], a[112:115], a[32:35], a[160:163]
    v_cvt_pk_bf16_f32 v82, v176, v177
    v_cvt_pk_bf16_f32 v83, v178, v179
    v_mfma_f32_16x16x32_bf16 a[160:163], a[116:119], a[36:39], a[160:163]
    v_cvt_pk_bf16_f32 v112, v112, v113
    v_cvt_pk_bf16_f32 v113, v114, v115
    v_mfma_f32_16x16x32_bf16 a[164:167], a[124:127], a[36:39], a[164:167]
    s_add_u32 s52, s47, 0
    v_cvt_pk_bf16_f32 v114, v208, v209
    v_cvt_pk_bf16_f32 v115, v210, v211
    v_mfma_f32_16x16x32_bf16 a[164:167], a[120:123], a[32:35], a[164:167]
    buffer_store_dwordx4 v[68:71], v1, s[32:35], s52 offen offset:1024 sc1
    v_mfma_f32_16x16x32_bf16 v[84:87], a[64:67], a[40:43], v[84:87]
    v_mfma_f32_16x16x32_bf16 v[84:87], a[68:71], a[44:47], v[84:87]
    v_cvt_pk_bf16_f32 v144, v144, v145
    v_cvt_pk_bf16_f32 v145, v146, v147
    v_mfma_f32_16x16x32_bf16 v[180:183], a[76:79], a[44:47], v[180:183]
    v_cvt_pk_bf16_f32 v146, v240, v241
    v_cvt_pk_bf16_f32 v147, v242, v243
    v_mfma_f32_16x16x32_bf16 v[180:183], a[72:75], a[40:43], v[180:183]
    v_mfma_f32_16x16x32_bf16 v[116:119], a[80:83], a[40:43], v[116:119]
    v_mfma_f32_16x16x32_bf16 v[116:119], a[84:87], a[44:47], v[116:119]
    v_accvgpr_read_b32 v56, a160
    v_accvgpr_read_b32 v57, a161
    v_mfma_f32_16x16x32_bf16 v[212:215], a[92:95], a[44:47], v[212:215]
    v_accvgpr_read_b32 v58, a162
    v_accvgpr_read_b32 v59, a163
    v_mfma_f32_16x16x32_bf16 v[212:215], a[88:91], a[40:43], v[212:215]
    v_accvgpr_read_b32 v60, a164
    v_accvgpr_read_b32 v61, a165
    v_mfma_f32_16x16x32_bf16 v[148:151], a[96:99], a[40:43], v[148:151]
    v_accvgpr_read_b32 v62, a166
    v_accvgpr_read_b32 v63, a167
    v_mfma_f32_16x16x32_bf16 v[148:151], a[100:103], a[44:47], v[148:151]
    s_add_u32 s52, s47, 8192
    v_cvt_pk_bf16_f32 v176, v56, v57
    v_cvt_pk_bf16_f32 v177, v58, v59
    v_mfma_f32_16x16x32_bf16 v[244:247], a[108:111], a[44:47], v[244:247]
    v_cvt_pk_bf16_f32 v84, v84, v85
    v_cvt_pk_bf16_f32 v178, v60, v61
    v_mfma_f32_16x16x32_bf16 v[244:247], a[104:107], a[40:43], v[244:247]
    v_cvt_pk_bf16_f32 v85, v86, v87
    v_cvt_pk_bf16_f32 v179, v62, v63
    v_mfma_f32_16x16x32_bf16 a[168:171], a[112:115], a[40:43], a[168:171]
    v_cvt_pk_bf16_f32 v86, v180, v181
    v_cvt_pk_bf16_f32 v87, v182, v183
    v_mfma_f32_16x16x32_bf16 a[168:171], a[116:119], a[44:47], a[168:171]
    buffer_store_dwordx4 v[100:103], v1, s[32:35], s52 offen offset:1024 sc1
    v_mfma_f32_16x16x32_bf16 a[172:175], a[124:127], a[44:47], a[172:175]
    v_cvt_pk_bf16_f32 v116, v116, v117
    v_cvt_pk_bf16_f32 v117, v118, v119
    v_mfma_f32_16x16x32_bf16 a[172:175], a[120:123], a[40:43], a[172:175]
    v_cvt_pk_bf16_f32 v118, v212, v213
    v_cvt_pk_bf16_f32 v119, v214, v215
    v_mfma_f32_16x16x32_bf16 v[88:91], a[64:67], a[48:51], v[88:91]
    s_waitcnt vmcnt(16)
    s_barrier
    v_mfma_f32_16x16x32_bf16 v[88:91], a[68:71], a[52:55], v[88:91]
    ds_read_b64_tr_b16 a[0:1], v42 offset:32768
    v_cvt_pk_bf16_f32 v148, v148, v149
    v_mfma_f32_16x16x32_bf16 v[184:187], a[76:79], a[52:55], v[184:187]
    v_cvt_pk_bf16_f32 v149, v150, v151
    v_cvt_pk_bf16_f32 v150, v244, v245
    v_mfma_f32_16x16x32_bf16 v[184:187], a[72:75], a[48:51], v[184:187]
    ds_read_b64_tr_b16 a[2:3], v42 offset:33792
    v_cvt_pk_bf16_f32 v151, v246, v247
    v_mfma_f32_16x16x32_bf16 v[120:123], a[80:83], a[48:51], v[120:123]
    ds_read_b64_tr_b16 a[4:5], v42 offset:40960
    ds_read_b64_tr_b16 a[6:7], v42 offset:41984
    v_mfma_f32_16x16x32_bf16 v[120:123], a[84:87], a[52:55], v[120:123]
    s_add_u32 s52, s47, 524288
    v_accvgpr_read_b32 v56, a168
    v_accvgpr_read_b32 v57, a169
    v_mfma_f32_16x16x32_bf16 v[216:219], a[92:95], a[52:55], v[216:219]
    v_accvgpr_read_b32 v58, a170
    v_accvgpr_read_b32 v59, a171
    v_mfma_f32_16x16x32_bf16 v[216:219], a[88:91], a[48:51], v[216:219]
    ds_read_b64_tr_b16 a[8:9], v43 offset:32768
    v_accvgpr_read_b32 v60, a172
    v_mfma_f32_16x16x32_bf16 v[152:155], a[96:99], a[48:51], v[152:155]
    buffer_store_dwordx4 v[132:135], v1, s[32:35], s52 offen offset:1024 sc1
    ds_read_b64_tr_b16 a[10:11], v43 offset:33792
    v_mfma_f32_16x16x32_bf16 v[152:155], a[100:103], a[52:55], v[152:155]
    v_accvgpr_read_b32 v61, a173
    v_accvgpr_read_b32 v62, a174
    v_mfma_f32_16x16x32_bf16 v[248:251], a[108:111], a[52:55], v[248:251]
    v_accvgpr_read_b32 v63, a175
    v_cvt_pk_bf16_f32 v180, v56, v57
    v_mfma_f32_16x16x32_bf16 v[248:251], a[104:107], a[48:51], v[248:251]
    v_cvt_pk_bf16_f32 v181, v58, v59
    v_cvt_pk_bf16_f32 v88, v88, v89
    v_mfma_f32_16x16x32_bf16 a[176:179], a[112:115], a[48:51], a[176:179]
    v_cvt_pk_bf16_f32 v182, v60, v61
    v_cvt_pk_bf16_f32 v89, v90, v91
    v_mfma_f32_16x16x32_bf16 a[176:179], a[116:119], a[52:55], a[176:179]
    ds_read_b64_tr_b16 a[12:13], v43 offset:40960
    v_cvt_pk_bf16_f32 v183, v62, v63
    v_mfma_f32_16x16x32_bf16 a[180:183], a[124:127], a[52:55], a[180:183]
    v_cvt_pk_bf16_f32 v90, v184, v185
    v_cvt_pk_bf16_f32 v91, v186, v187
    v_mfma_f32_16x16x32_bf16 a[180:183], a[120:123], a[48:51], a[180:183]
    ds_read_b64_tr_b16 a[14:15], v43 offset:41984
    ds_read_b64_tr_b16 a[16:17], v44 offset:32768
    v_mfma_f32_16x16x32_bf16 v[92:95], a[64:67], a[56:59], v[92:95]
    s_add_u32 s52, s47, 532480
    v_cvt_pk_bf16_f32 v120, v120, v121
    v_cvt_pk_bf16_f32 v121, v122, v123
    v_mfma_f32_16x16x32_bf16 v[92:95], a[68:71], a[60:63], v[92:95]
    ds_read_b64_tr_b16 a[18:19], v44 offset:33792
    v_cvt_pk_bf16_f32 v122, v216, v217
    v_mfma_f32_16x16x32_bf16 v[188:191], a[76:79], a[60:63], v[188:191]
    ds_read_b64_tr_b16 a[20:21], v44 offset:40960
    v_cvt_pk_bf16_f32 v123, v218, v219
    v_mfma_f32_16x16x32_bf16 v[188:191], a[72:75], a[56:59], v[188:191]
    ds_read_b64_tr_b16 a[22:23], v44 offset:41984
    v_cvt_pk_bf16_f32 v152, v152, v153
    v_mfma_f32_16x16x32_bf16 v[124:127], a[80:83], a[56:59], v[124:127]
    v_cvt_pk_bf16_f32 v153, v154, v155
    v_cvt_pk_bf16_f32 v154, v248, v249
    v_mfma_f32_16x16x32_bf16 v[124:127], a[84:87], a[60:63], v[124:127]
    ds_read_b64_tr_b16 a[24:25], v45 offset:32768
    v_cvt_pk_bf16_f32 v155, v250, v251
    v_mfma_f32_16x16x32_bf16 v[220:223], a[92:95], a[60:63], v[220:223]
    buffer_store_dwordx4 v[164:167], v1, s[32:35], s52 offen offset:1024 sc1
    ds_read_b64_tr_b16 a[26:27], v45 offset:33792
    v_mfma_f32_16x16x32_bf16 v[220:223], a[88:91], a[56:59], v[220:223]
    ds_read_b64_tr_b16 a[28:29], v45 offset:40960
    v_accvgpr_read_b32 v56, a176
    v_mfma_f32_16x16x32_bf16 v[156:159], a[96:99], a[56:59], v[156:159]
    v_accvgpr_read_b32 v57, a177
    v_accvgpr_read_b32 v58, a178
    v_mfma_f32_16x16x32_bf16 v[156:159], a[100:103], a[60:63], v[156:159]
    ds_read_b64_tr_b16 a[30:31], v45 offset:41984
    v_accvgpr_read_b32 v59, a179
    v_mfma_f32_16x16x32_bf16 v[252:255], a[108:111], a[60:63], v[252:255]
    v_accvgpr_read_b32 v60, a180
    v_accvgpr_read_b32 v61, a181
    v_mfma_f32_16x16x32_bf16 v[252:255], a[104:107], a[56:59], v[252:255]
    v_accvgpr_read_b32 v62, a182
    v_accvgpr_read_b32 v63, a183
    v_mfma_f32_16x16x32_bf16 a[184:187], a[112:115], a[56:59], a[184:187]
    v_cvt_pk_bf16_f32 v184, v56, v57
    v_cvt_pk_bf16_f32 v185, v58, v59
    v_mfma_f32_16x16x32_bf16 a[184:187], a[116:119], a[60:63], a[184:187]
    v_cvt_pk_bf16_f32 v92, v92, v93
    v_cvt_pk_bf16_f32 v186, v60, v61
    v_mfma_f32_16x16x32_bf16 a[188:191], a[124:127], a[60:63], a[188:191]
    v_cvt_pk_bf16_f32 v93, v94, v95
    v_cvt_pk_bf16_f32 v187, v62, v63
    v_mfma_f32_16x16x32_bf16 a[188:191], a[120:123], a[56:59], a[188:191]
    v_cvt_pk_bf16_f32 v94, v188, v189
    v_cvt_pk_bf16_f32 v95, v190, v191
    v_cvt_pk_bf16_f32 v124, v124, v125
    v_cvt_pk_bf16_f32 v125, v126, v127
    v_cvt_pk_bf16_f32 v126, v220, v221
    v_cvt_pk_bf16_f32 v127, v222, v223
    v_cvt_pk_bf16_f32 v156, v156, v157
    v_cvt_pk_bf16_f32 v157, v158, v159
    v_cvt_pk_bf16_f32 v158, v252, v253
    v_cvt_pk_bf16_f32 v159, v254, v255
    v_accvgpr_read_b32 v56, a184
    v_accvgpr_read_b32 v57, a185
    v_accvgpr_read_b32 v58, a186
    v_accvgpr_read_b32 v59, a187
    v_accvgpr_read_b32 v60, a188
    v_accvgpr_read_b32 v61, a189
    v_accvgpr_read_b32 v62, a190
    v_accvgpr_read_b32 v63, a191
    v_cvt_pk_bf16_f32 v188, v56, v57
    v_cvt_pk_bf16_f32 v189, v58, v59
    v_cvt_pk_bf16_f32 v190, v60, v61
    v_cvt_pk_bf16_f32 v191, v62, v63
k12_join_7:
k12_qcode:
    s_mov_b64 s[48:49], s[32:33]
    s_mov_b32 s51, 0x00020000
    s_cmp_eq_u32 s45, 0
    s_mov_b32 s50, s34
    s_cselect_b32 s56, s30, -1
    s_cselect_b32 s57, -1, s30
    s_waitcnt vmcnt(16) lgkmcnt(0)
    v_mfma_f32_16x16x32_bf16 v[192:195], a[0:3], a[192:195], 0
    v_mfma_f32_16x16x32_bf16 v[192:195], a[4:7], a[208:211], v[192:195]
    buffer_load_dwordx4 a[128:131], v36, s[8:11], s62 offen sc1
    ds_read_b64_tr_b16 a[32:33], v46 offset:32768
    v_mfma_f32_16x16x32_bf16 v[196:199], a[4:7], a[212:215], 0
    ds_read_b64_tr_b16 a[34:35], v46 offset:33792
    v_mfma_f32_16x16x32_bf16 v[196:199], a[0:3], a[196:199], v[196:199]
    ds_read_b64_tr_b16 a[36:37], v46 offset:40960
    v_mfma_f32_16x16x32_bf16 a[64:67], a[0:3], a[200:203], 0
    ds_read_b64_tr_b16 a[38:39], v46 offset:41984
    v_mfma_f32_16x16x32_bf16 a[64:67], a[4:7], a[216:219], a[64:67]
    ds_read_b64_tr_b16 a[40:41], v47 offset:32768
    v_mfma_f32_16x16x32_bf16 a[68:71], a[4:7], a[220:223], 0
    s_lshl_b32 s31, s28, 14
    v_mfma_f32_16x16x32_bf16 a[68:71], a[0:3], a[204:207], a[68:71]
    s_add_u32 s16, s6, s31
    s_addc_u32 s17, s7, 0
    buffer_load_dwordx4 a[132:135], v54, s[8:11], s62 offen sc1
    ds_read_b64_tr_b16 a[42:43], v47 offset:33792
    v_mfma_f32_16x16x32_bf16 a[76:79], a[8:11], a[204:207], 0
    ds_read_b64_tr_b16 a[44:45], v47 offset:40960
    v_mfma_f32_16x16x32_bf16 a[76:79], a[12:15], a[220:223], a[76:79]
    s_add_u32 s20, s16, 0x2000000
    s_addc_u32 s21, s17, 0
    ds_read_b64_tr_b16 a[46:47], v47 offset:41984
    v_mfma_f32_16x16x32_bf16 a[72:75], a[12:15], a[216:219], 0
    ds_read_b64_tr_b16 a[48:49], v48 offset:32768
    v_mfma_f32_16x16x32_bf16 a[72:75], a[8:11], a[200:203], a[72:75]
    s_add_u32 s16, s16, 0x1000000
    s_addc_u32 s17, s17, 0
    v_mfma_f32_16x16x32_bf16 v[204:207], a[8:11], a[196:199], 0
    ds_read_b64_tr_b16 a[50:51], v48 offset:33792
    v_mfma_f32_16x16x32_bf16 v[204:207], a[12:15], a[212:215], v[204:207]
    s_and_b32 s17, s17, 0xffff
    ds_read_b64_tr_b16 a[52:53], v48 offset:40960
    v_mfma_f32_16x16x32_bf16 v[200:203], a[12:15], a[208:211], 0
    buffer_load_dwordx4 a[136:139], v37, s[8:11], s62 offen sc1
    ds_read_b64_tr_b16 a[54:55], v48 offset:41984
    v_mfma_f32_16x16x32_bf16 v[200:203], a[8:11], a[192:195], v[200:203]
    s_and_b32 s21, s21, 0xffff
    v_mfma_f32_16x16x32_bf16 v[208:211], a[16:19], a[192:195], 0
    ds_read_b64_tr_b16 a[56:57], v49 offset:32768
    v_mfma_f32_16x16x32_bf16 v[208:211], a[20:23], a[208:211], v[208:211]
    s_lshl_b32 s31, s29, 20
    ds_read_b64_tr_b16 a[58:59], v49 offset:33792
    v_mfma_f32_16x16x32_bf16 v[212:215], a[20:23], a[212:215], 0
    ds_read_b64_tr_b16 a[60:61], v49 offset:40960
    v_mfma_f32_16x16x32_bf16 v[212:215], a[16:19], a[196:199], v[212:215]
    s_sub_u32 s18, 0xf84000, s31
    v_mfma_f32_16x16x32_bf16 a[80:83], a[16:19], a[200:203], 0
    buffer_load_dwordx4 a[140:143], v55, s[8:11], s62 offen sc1
    ds_read_b64_tr_b16 a[62:63], v49 offset:41984
    v_mfma_f32_16x16x32_bf16 a[80:83], a[20:23], a[216:219], a[80:83]
    s_mov_b32 s22, s18
    v_mfma_f32_16x16x32_bf16 a[84:87], a[20:23], a[220:223], 0
    v_mfma_f32_16x16x32_bf16 a[84:87], a[16:19], a[204:207], a[84:87]
    s_add_u32 s24, s6, 0x4806000
    s_addc_u32 s25, s7, 0
    v_mfma_f32_16x16x32_bf16 a[92:95], a[24:27], a[204:207], 0
    v_mfma_f32_16x16x32_bf16 a[92:95], a[28:31], a[220:223], a[92:95]
    s_and_b32 s25, s25, 0xffff
    v_mfma_f32_16x16x32_bf16 a[88:91], a[28:31], a[216:219], 0
    s_add_u32 s62, s62, 0x20000
    v_mfma_f32_16x16x32_bf16 a[88:91], a[24:27], a[200:203], a[88:91]
    s_mov_b32 s26, 4096
    v_mfma_f32_16x16x32_bf16 v[220:223], a[24:27], a[196:199], 0
    s_cmp_eq_u32 s45, 0
    s_cbranch_scc1 k12_ool_48
k12_oolret_49:
    v_mfma_f32_16x16x32_bf16 v[220:223], a[28:31], a[212:215], v[220:223]
    v_mfma_f32_16x16x32_bf16 v[216:219], a[28:31], a[208:211], 0
    v_mfma_f32_16x16x32_bf16 v[216:219], a[24:27], a[192:195], v[216:219]
    s_waitcnt vmcnt(28) lgkmcnt(0)
    s_barrier
    v_mfma_f32_16x16x32_bf16 v[224:227], a[32:35], a[192:195], 0
    v_mfma_f32_16x16x32_bf16 v[224:227], a[36:39], a[208:211], v[224:227]
    s_add_u32 m0, s60, 98304
    ds_read_b64_tr_b16 a[0:1], v42 offset:49152
    ds_read_b64_tr_b16 a[2:3], v42 offset:50176
    v_mfma_f32_16x16x32_bf16 v[228:231], a[36:39], a[212:215], 0
    buffer_load_dwordx4 v38, s[12:15], s61 offen offset:0 lds
    v_mfma_f32_16x16x32_bf16 v[228:231], a[32:35], a[196:199], v[228:231]
    ds_read_b64_tr_b16 a[4:5], v42 offset:57344
    v_mfma_f32_16x16x32_bf16 a[96:99], a[32:35], a[200:203], 0
    buffer_load_dwordx4 v39, s[12:15], s61 offen offset:1024 lds
    ds_read_b64_tr_b16 a[6:7], v42 offset:58368
    v_mfma_f32_16x16x32_bf16 a[96:99], a[36:39], a[216:219], a[96:99]
    ds_read_b64_tr_b16 a[8:9], v43 offset:49152
    v_mfma_f32_16x16x32_bf16 a[100:103], a[36:39], a[220:223], 0
    v_mfma_f32_16x16x32_bf16 a[100:103], a[32:35], a[204:207], a[100:103]
    buffer_load_dwordx4 v40, s[12:15], s61 offen offset:2048 lds
    ds_read_b64_tr_b16 a[10:11], v43 offset:50176
    v_mfma_f32_16x16x32_bf16 a[108:111], a[40:43], a[204:207], 0
    ds_read_b64_tr_b16 a[12:13], v43 offset:57344
    v_mfma_f32_16x16x32_bf16 a[108:111], a[44:47], a[220:223], a[108:111]
    ds_read_b64_tr_b16 a[14:15], v43 offset:58368
    v_mfma_f32_16x16x32_bf16 a[104:107], a[44:47], a[216:219], 0
    buffer_load_dwordx4 v41, s[12:15], s61 offen offset:3072 lds
    ds_read_b64_tr_b16 a[16:17], v44 offset:49152
    v_mfma_f32_16x16x32_bf16 a[104:107], a[40:43], a[200:203], a[104:107]
    v_mfma_f32_16x16x32_bf16 v[236:239], a[40:43], a[196:199], 0
    s_add_u32 s61, s61, 0x80000
    ds_read_b64_tr_b16 a[18:19], v44 offset:50176
    v_mfma_f32_16x16x32_bf16 v[236:239], a[44:47], a[212:215], v[236:239]
    buffer_load_dwordx4 a[144:147], v36, s[8:11], s62 offen sc1
    ds_read_b64_tr_b16 a[20:21], v44 offset:57344
    v_mfma_f32_16x16x32_bf16 v[232:235], a[44:47], a[208:211], 0
    ds_read_b64_tr_b16 a[22:23], v44 offset:58368
    v_mfma_f32_16x16x32_bf16 v[232:235], a[40:43], a[192:195], v[232:235]
    buffer_load_dwordx4 a[148:151], v54, s[8:11], s62 offen sc1
    v_mfma_f32_16x16x32_bf16 v[240:243], a[48:51], a[192:195], 0
    ds_read_b64_tr_b16 a[24:25], v45 offset:49152
    v_mfma_f32_16x16x32_bf16 v[240:243], a[52:55], a[208:211], v[240:243]
    ds_read_b64_tr_b16 a[26:27], v45 offset:50176
    v_mfma_f32_16x16x32_bf16 v[244:247], a[52:55], a[212:215], 0
    buffer_load_dwordx4 a[152:155], v37, s[8:11], s62 offen sc1
    ds_read_b64_tr_b16 a[28:29], v45 offset:57344
    v_mfma_f32_16x16x32_bf16 v[244:247], a[48:51], a[196:199], v[244:247]
    v_mfma_f32_16x16x32_bf16 a[112:115], a[48:51], a[200:203], 0
    ds_read_b64_tr_b16 a[30:31], v45 offset:58368
    v_mfma_f32_16x16x32_bf16 a[112:115], a[52:55], a[216:219], a[112:115]
    buffer_load_dwordx4 a[156:159], v55, s[8:11], s62 offen sc1
    v_mfma_f32_16x16x32_bf16 a[116:119], a[52:55], a[220:223], 0
    v_mfma_f32_16x16x32_bf16 a[116:119], a[48:51], a[204:207], a[116:119]
    s_add_u32 s62, s62, 0x20000
    v_mfma_f32_16x16x32_bf16 a[124:127], a[56:59], a[204:207], 0
    s_add_u32 s52, s47, 0
    v_mfma_f32_16x16x32_bf16 a[124:127], a[60:63], a[220:223], a[124:127]
    buffer_store_dwordx4 v[72:75], v1, s[48:51], s52 offen offset:2048 sc1
    v_mfma_f32_16x16x32_bf16 a[120:123], a[60:63], a[216:219], 0
    v_mfma_f32_16x16x32_bf16 a[120:123], a[56:59], a[200:203], a[120:123]
    v_mfma_f32_16x16x32_bf16 v[252:255], a[56:59], a[196:199], 0
    v_mfma_f32_16x16x32_bf16 v[252:255], a[60:63], a[212:215], v[252:255]
    v_mfma_f32_16x16x32_bf16 v[248:251], a[60:63], a[208:211], 0
    v_mfma_f32_16x16x32_bf16 v[248:251], a[56:59], a[192:195], v[248:251]
    s_waitcnt vmcnt(21) lgkmcnt(0)
    v_mfma_f32_16x16x32_bf16 v[192:195], a[0:3], a[224:227], v[192:195]
    v_mfma_f32_16x16x32_bf16 v[192:195], a[4:7], a[240:243], v[192:195]
    buffer_load_dwordx4 a[160:163], v36, s[8:11], s62 offen sc1
    ds_read_b64_tr_b16 a[32:33], v46 offset:49152
    v_mfma_f32_16x16x32_bf16 v[196:199], a[4:7], a[244:247], v[196:199]
    ds_read_b64_tr_b16 a[34:35], v46 offset:50176
    v_mfma_f32_16x16x32_bf16 v[196:199], a[0:3], a[228:231], v[196:199]
    ds_read_b64_tr_b16 a[36:37], v46 offset:57344
    v_mfma_f32_16x16x32_bf16 a[64:67], a[0:3], a[232:235], a[64:67]
    ds_read_b64_tr_b16 a[38:39], v46 offset:58368
    v_mfma_f32_16x16x32_bf16 a[64:67], a[4:7], a[248:251], a[64:67]
    ds_read_b64_tr_b16 a[40:41], v47 offset:49152
    v_mfma_f32_16x16x32_bf16 a[68:71], a[4:7], a[252:255], a[68:71]
    buffer_load_dwordx4 a[164:167], v54, s[8:11], s62 offen sc1
    v_mfma_f32_16x16x32_bf16 a[68:71], a[0:3], a[236:239], a[68:71]
    ds_read_b64_tr_b16 a[42:43], v47 offset:50176
    v_mfma_f32_16x16x32_bf16 a[76:79], a[8:11], a[236:239], a[76:79]
    ds_read_b64_tr_b16 a[44:45], v47 offset:57344
    v_mfma_f32_16x16x32_bf16 a[76:79], a[12:15], a[252:255], a[76:79]
    ds_read_b64_tr_b16 a[46:47], v47 offset:58368
    v_mfma_f32_16x16x32_bf16 a[72:75], a[12:15], a[248:251], a[72:75]
    ds_read_b64_tr_b16 a[48:49], v48 offset:49152
    v_mfma_f32_16x16x32_bf16 a[72:75], a[8:11], a[232:235], a[72:75]
    buffer_load_dwordx4 a[168:171], v37, s[8:11], s62 offen sc1
    v_mfma_f32_16x16x32_bf16 v[204:207], a[8:11], a[228:231], v[204:207]
    ds_read_b64_tr_b16 a[50:51], v48 offset:50176
    v_mfma_f32_16x16x32_bf16 v[204:207], a[12:15], a[244:247], v[204:207]
    ds_read_b64_tr_b16 a[52:53], v48 offset:57344
    v_mfma_f32_16x16x32_bf16 v[200:203], a[12:15], a[240:243], v[200:203]
    ds_read_b64_tr_b16 a[54:55], v48 offset:58368
    v_mfma_f32_16x16x32_bf16 v[200:203], a[8:11], a[224:227], v[200:203]
    v_mfma_f32_16x16x32_bf16 v[208:211], a[16:19], a[224:227], v[208:211]
    ds_read_b64_tr_b16 a[56:57], v49 offset:49152
    v_mfma_f32_16x16x32_bf16 v[208:211], a[20:23], a[240:243], v[208:211]
    buffer_load_dwordx4 a[172:175], v55, s[8:11], s62 offen sc1
    ds_read_b64_tr_b16 a[58:59], v49 offset:50176
    v_mfma_f32_16x16x32_bf16 v[212:215], a[20:23], a[244:247], v[212:215]
    ds_read_b64_tr_b16 a[60:61], v49 offset:57344
    v_mfma_f32_16x16x32_bf16 v[212:215], a[16:19], a[228:231], v[212:215]
    v_mfma_f32_16x16x32_bf16 a[80:83], a[16:19], a[232:235], a[80:83]
    ds_read_b64_tr_b16 a[62:63], v49 offset:58368
    v_mfma_f32_16x16x32_bf16 a[80:83], a[20:23], a[248:251], a[80:83]
    s_add_u32 s62, s62, 0x20000
    v_mfma_f32_16x16x32_bf16 a[84:87], a[20:23], a[252:255], a[84:87]
    s_add_u32 s52, s47, 0
    v_mfma_f32_16x16x32_bf16 a[84:87], a[16:19], a[236:239], a[84:87]
    buffer_store_dwordx4 v[76:79], v1, s[48:51], s52 offen offset:3072 sc1
    v_mfma_f32_16x16x32_bf16 a[92:95], a[24:27], a[236:239], a[92:95]
    v_mfma_f32_16x16x32_bf16 a[92:95], a[28:31], a[252:255], a[92:95]
    v_mfma_f32_16x16x32_bf16 a[88:91], a[28:31], a[248:251], a[88:91]
    v_mfma_f32_16x16x32_bf16 a[88:91], a[24:27], a[232:235], a[88:91]
    v_mfma_f32_16x16x32_bf16 v[220:223], a[24:27], a[228:231], v[220:223]
    s_cmp_eq_u32 s45, 0
    s_cbranch_scc1 k12_ool_50
k12_oolret_51:
    v_mfma_f32_16x16x32_bf16 v[220:223], a[28:31], a[244:247], v[220:223]
    v_mfma_f32_16x16x32_bf16 v[216:219], a[28:31], a[240:243], v[216:219]
    v_mfma_f32_16x16x32_bf16 v[216:219], a[24:27], a[224:227], v[216:219]
    s_waitcnt vmcnt(10) lgkmcnt(0)
    s_barrier
    v_mfma_f32_16x16x32_bf16 v[224:227], a[32:35], a[224:227], v[224:227]
    v_mfma_f32_16x16x32_bf16 v[224:227], a[36:39], a[240:243], v[224:227]
    s_add_u32 m0, s60, 114688
    ds_read_b64_tr_b16 a[0:1], v42 offset:0
    ds_read_b64_tr_b16 a[2:3], v42 offset:1024
    v_mfma_f32_16x16x32_bf16 v[228:231], a[36:39], a[244:247], v[228:231]
    buffer_load_dwordx4 v38, s[12:15], s61 offen offset:0 lds
    v_mfma_f32_16x16x32_bf16 v[228:231], a[32:35], a[228:231], v[228:231]
    ds_read_b64_tr_b16 a[4:5], v42 offset:8192
    v_mfma_f32_16x16x32_bf16 a[96:99], a[32:35], a[232:235], a[96:99]
    buffer_load_dwordx4 v39, s[12:15], s61 offen offset:1024 lds
    ds_read_b64_tr_b16 a[6:7], v42 offset:9216
    v_mfma_f32_16x16x32_bf16 a[96:99], a[36:39], a[248:251], a[96:99]
    ds_read_b64_tr_b16 a[8:9], v43 offset:0
    v_mfma_f32_16x16x32_bf16 a[100:103], a[36:39], a[252:255], a[100:103]
    v_mfma_f32_16x16x32_bf16 a[100:103], a[32:35], a[236:239], a[100:103]
    buffer_load_dwordx4 v40, s[12:15], s61 offen offset:2048 lds
    ds_read_b64_tr_b16 a[10:11], v43 offset:1024
    v_mfma_f32_16x16x32_bf16 a[108:111], a[40:43], a[236:239], a[108:111]
    ds_read_b64_tr_b16 a[12:13], v43 offset:8192
    v_mfma_f32_16x16x32_bf16 a[108:111], a[44:47], a[252:255], a[108:111]
    ds_read_b64_tr_b16 a[14:15], v43 offset:9216
    v_mfma_f32_16x16x32_bf16 a[104:107], a[44:47], a[248:251], a[104:107]
    buffer_load_dwordx4 v41, s[12:15], s61 offen offset:3072 lds
    ds_read_b64_tr_b16 a[16:17], v44 offset:0
    v_mfma_f32_16x16x32_bf16 a[104:107], a[40:43], a[232:235], a[104:107]
    v_mfma_f32_16x16x32_bf16 v[236:239], a[40:43], a[228:231], v[236:239]
    s_add_u32 s61, s61, 0x80000
    ds_read_b64_tr_b16 a[18:19], v44 offset:1024
    v_mfma_f32_16x16x32_bf16 v[236:239], a[44:47], a[244:247], v[236:239]
    buffer_load_dwordx4 a[176:179], v36, s[8:11], s62 offen sc1
    ds_read_b64_tr_b16 a[20:21], v44 offset:8192
    v_mfma_f32_16x16x32_bf16 v[232:235], a[44:47], a[240:243], v[232:235]
    ds_read_b64_tr_b16 a[22:23], v44 offset:9216
    v_mfma_f32_16x16x32_bf16 v[232:235], a[40:43], a[224:227], v[232:235]
    buffer_load_dwordx4 a[180:183], v54, s[8:11], s62 offen sc1
    v_mfma_f32_16x16x32_bf16 v[240:243], a[48:51], a[224:227], v[240:243]
    ds_read_b64_tr_b16 a[24:25], v45 offset:0
    v_mfma_f32_16x16x32_bf16 v[240:243], a[52:55], a[240:243], v[240:243]
    ds_read_b64_tr_b16 a[26:27], v45 offset:1024
    v_mfma_f32_16x16x32_bf16 v[244:247], a[52:55], a[244:247], v[244:247]
    buffer_load_dwordx4 a[184:187], v37, s[8:11], s62 offen sc1
    ds_read_b64_tr_b16 a[28:29], v45 offset:8192
    v_mfma_f32_16x16x32_bf16 v[244:247], a[48:51], a[228:231], v[244:247]
    v_mfma_f32_16x16x32_bf16 a[112:115], a[48:51], a[232:235], a[112:115]
    ds_read_b64_tr_b16 a[30:31], v45 offset:9216
    v_mfma_f32_16x16x32_bf16 a[112:115], a[52:55], a[248:251], a[112:115]
    buffer_load_dwordx4 a[188:191], v55, s[8:11], s62 offen sc1
    v_mfma_f32_16x16x32_bf16 a[116:119], a[52:55], a[252:255], a[116:119]
    v_mfma_f32_16x16x32_bf16 a[116:119], a[48:51], a[236:239], a[116:119]
    s_add_u32 s62, s62, 0x20000
    v_mfma_f32_16x16x32_bf16 a[124:127], a[56:59], a[236:239], a[124:127]
    s_add_u32 s52, s47, 4096
    v_mfma_f32_16x16x32_bf16 a[124:127], a[60:63], a[252:255], a[124:127]
    buffer_store_dwordx4 v[80:83], v1, s[48:51], s52 offen offset:0 sc1
    v_mfma_f32_16x16x32_bf16 a[120:123], a[60:63], a[248:251], a[120:123]
    v_mfma_f32_16x16x32_bf16 a[120:123], a[56:59], a[232:235], a[120:123]
    v_mfma_f32_16x16x32_bf16 v[252:255], a[56:59], a[228:231], v[252:255]
    v_mfma_f32_16x16x32_bf16 v[252:255], a[60:63], a[244:247], v[252:255]
    v_mfma_f32_16x16x32_bf16 v[248:251], a[60:63], a[240:243], v[248:251]
    v_mfma_f32_16x16x32_bf16 v[248:251], a[56:59], a[224:227], v[248:251]
    s_waitcnt vmcnt(15) lgkmcnt(0)
    v_mfma_f32_16x16x32_bf16 v[192:195], a[0:3], a[128:131], v[192:195]
    v_mfma_f32_16x16x32_bf16 v[192:195], a[4:7], a[144:147], v[192:195]
    buffer_load_dwordx4 a[192:195], v36, s[8:11], s62 offen sc1
    ds_read_b64_tr_b16 a[32:33], v46 offset:0
    v_mfma_f32_16x16x32_bf16 v[196:199], a[4:7], a[148:151], v[196:199]
    ds_read_b64_tr_b16 a[34:35], v46 offset:1024
    v_mfma_f32_16x16x32_bf16 v[196:199], a[0:3], a[132:135], v[196:199]
    ds_read_b64_tr_b16 a[36:37], v46 offset:8192
    v_mfma_f32_16x16x32_bf16 a[64:67], a[0:3], a[136:139], a[64:67]
    ds_read_b64_tr_b16 a[38:39], v46 offset:9216
    v_mfma_f32_16x16x32_bf16 a[64:67], a[4:7], a[152:155], a[64:67]
    ds_read_b64_tr_b16 a[40:41], v47 offset:0
    v_mfma_f32_16x16x32_bf16 a[68:71], a[4:7], a[156:159], a[68:71]
    buffer_load_dwordx4 a[196:199], v54, s[8:11], s62 offen sc1
    v_mfma_f32_16x16x32_bf16 a[68:71], a[0:3], a[140:143], a[68:71]
    ds_read_b64_tr_b16 a[42:43], v47 offset:1024
    v_mfma_f32_16x16x32_bf16 a[76:79], a[8:11], a[140:143], a[76:79]
    ds_read_b64_tr_b16 a[44:45], v47 offset:8192
    v_mfma_f32_16x16x32_bf16 a[76:79], a[12:15], a[156:159], a[76:79]
    ds_read_b64_tr_b16 a[46:47], v47 offset:9216
    v_mfma_f32_16x16x32_bf16 a[72:75], a[12:15], a[152:155], a[72:75]
    ds_read_b64_tr_b16 a[48:49], v48 offset:0
    v_mfma_f32_16x16x32_bf16 a[72:75], a[8:11], a[136:139], a[72:75]
    buffer_load_dwordx4 a[200:203], v37, s[8:11], s62 offen sc1
    v_mfma_f32_16x16x32_bf16 v[204:207], a[8:11], a[132:135], v[204:207]
    ds_read_b64_tr_b16 a[50:51], v48 offset:1024
    v_mfma_f32_16x16x32_bf16 v[204:207], a[12:15], a[148:151], v[204:207]
    ds_read_b64_tr_b16 a[52:53], v48 offset:8192
    v_mfma_f32_16x16x32_bf16 v[200:203], a[12:15], a[144:147], v[200:203]
    ds_read_b64_tr_b16 a[54:55], v48 offset:9216
    v_mfma_f32_16x16x32_bf16 v[200:203], a[8:11], a[128:131], v[200:203]
    v_mfma_f32_16x16x32_bf16 v[208:211], a[16:19], a[128:131], v[208:211]
    ds_read_b64_tr_b16 a[56:57], v49 offset:0
    v_mfma_f32_16x16x32_bf16 v[208:211], a[20:23], a[144:147], v[208:211]
    buffer_load_dwordx4 a[204:207], v55, s[8:11], s62 offen sc1
    ds_read_b64_tr_b16 a[58:59], v49 offset:1024
    v_mfma_f32_16x16x32_bf16 v[212:215], a[20:23], a[148:151], v[212:215]
    ds_read_b64_tr_b16 a[60:61], v49 offset:8192
    v_mfma_f32_16x16x32_bf16 v[212:215], a[16:19], a[132:135], v[212:215]
    v_mfma_f32_16x16x32_bf16 a[80:83], a[16:19], a[136:139], a[80:83]
    ds_read_b64_tr_b16 a[62:63], v49 offset:9216
    v_mfma_f32_16x16x32_bf16 a[80:83], a[20:23], a[152:155], a[80:83]
    s_add_u32 s62, s62, 0x20000
    v_mfma_f32_16x16x32_bf16 a[84:87], a[20:23], a[156:159], a[84:87]
    s_add_u32 s52, s47, 4096
    v_mfma_f32_16x16x32_bf16 a[84:87], a[16:19], a[140:143], a[84:87]
    buffer_store_dwordx4 v[84:87], v1, s[48:51], s52 offen offset:1024 sc1
    v_mfma_f32_16x16x32_bf16 a[92:95], a[24:27], a[140:143], a[92:95]
    v_mfma_f32_16x16x32_bf16 a[92:95], a[28:31], a[156:159], a[92:95]
    v_mfma_f32_16x16x32_bf16 a[88:91], a[28:31], a[152:155], a[88:91]
    v_mfma_f32_16x16x32_bf16 a[88:91], a[24:27], a[136:139], a[88:91]
    v_mfma_f32_16x16x32_bf16 v[220:223], a[24:27], a[132:135], v[220:223]
    v_mfma_f32_16x16x32_bf16 v[220:223], a[28:31], a[148:151], v[220:223]
    v_mfma_f32_16x16x32_bf16 v[216:219], a[28:31], a[144:147], v[216:219]
    v_mfma_f32_16x16x32_bf16 v[216:219], a[24:27], a[128:131], v[216:219]
    s_waitcnt vmcnt(10) lgkmcnt(0)
    s_barrier
    v_mfma_f32_16x16x32_bf16 v[224:227], a[32:35], a[128:131], v[224:227]
    v_mfma_f32_16x16x32_bf16 v[224:227], a[36:39], a[144:147], v[224:227]
    s_add_u32 m0, s60, 131072
    ds_read_b64_tr_b16 a[0:1], v42 offset:16384
    ds_read_b64_tr_b16 a[2:3], v42 offset:17408
    v_mfma_f32_16x16x32_bf16 v[228:231], a[36:39], a[148:151], v[228:231]
    buffer_load_dwordx4 v38, s[12:15], s61 offen offset:0 lds
    v_mfma_f32_16x16x32_bf16 v[228:231], a[32:35], a[132:135], v[228:231]
    ds_read_b64_tr_b16 a[4:5], v42 offset:24576
    v_mfma_f32_16x16x32_bf16 a[96:99], a[32:35], a[136:139], a[96:99]
    buffer_load_dwordx4 v39, s[12:15], s61 offen offset:1024 lds
    ds_read_b64_tr_b16 a[6:7], v42 offset:25600
    v_mfma_f32_16x16x32_bf16 a[96:99], a[36:39], a[152:155], a[96:99]
    ds_read_b64_tr_b16 a[8:9], v43 offset:16384
    v_mfma_f32_16x16x32_bf16 a[100:103], a[36:39], a[156:159], a[100:103]
    v_mfma_f32_16x16x32_bf16 a[100:103], a[32:35], a[140:143], a[100:103]
    buffer_load_dwordx4 v40, s[12:15], s61 offen offset:2048 lds
    ds_read_b64_tr_b16 a[10:11], v43 offset:17408
    v_mfma_f32_16x16x32_bf16 a[108:111], a[40:43], a[140:143], a[108:111]
    ds_read_b64_tr_b16 a[12:13], v43 offset:24576
    v_mfma_f32_16x16x32_bf16 a[108:111], a[44:47], a[156:159], a[108:111]
    ds_read_b64_tr_b16 a[14:15], v43 offset:25600
    v_mfma_f32_16x16x32_bf16 a[104:107], a[44:47], a[152:155], a[104:107]
    ds_read_b64_tr_b16 a[16:17], v44 offset:16384
    v_mfma_f32_16x16x32_bf16 a[104:107], a[40:43], a[136:139], a[104:107]
    buffer_load_dwordx4 v41, s[12:15], s61 offen offset:3072 lds
    v_mfma_f32_16x16x32_bf16 v[236:239], a[40:43], a[132:135], v[236:239]
    ds_read_b64_tr_b16 a[18:19], v44 offset:17408
    v_mfma_f32_16x16x32_bf16 v[236:239], a[44:47], a[148:151], v[236:239]
    s_add_u32 s61, s61, 0x80000
    ds_read_b64_tr_b16 a[20:21], v44 offset:24576
    v_mfma_f32_16x16x32_bf16 v[232:235], a[44:47], a[144:147], v[232:235]
    buffer_load_dwordx4 a[208:211], v36, s[8:11], s62 offen sc1
    ds_read_b64_tr_b16 a[22:23], v44 offset:25600
    v_mfma_f32_16x16x32_bf16 v[232:235], a[40:43], a[128:131], v[232:235]
    v_mfma_f32_16x16x32_bf16 v[240:243], a[48:51], a[128:131], v[240:243]
    ds_read_b64_tr_b16 a[24:25], v45 offset:16384
    v_mfma_f32_16x16x32_bf16 v[240:243], a[52:55], a[144:147], v[240:243]
    buffer_load_dwordx4 a[212:215], v54, s[8:11], s62 offen sc1
    ds_read_b64_tr_b16 a[26:27], v45 offset:17408
    v_mfma_f32_16x16x32_bf16 v[244:247], a[52:55], a[148:151], v[244:247]
    ds_read_b64_tr_b16 a[28:29], v45 offset:24576
    v_mfma_f32_16x16x32_bf16 v[244:247], a[48:51], a[132:135], v[244:247]
    v_mfma_f32_16x16x32_bf16 a[112:115], a[48:51], a[136:139], a[112:115]
    buffer_load_dwordx4 a[216:219], v37, s[8:11], s62 offen sc1
    ds_read_b64_tr_b16 a[30:31], v45 offset:25600
    v_mfma_f32_16x16x32_bf16 a[112:115], a[52:55], a[152:155], a[112:115]
    v_mfma_f32_16x16x32_bf16 a[116:119], a[52:55], a[156:159], a[116:119]
    v_mfma_f32_16x16x32_bf16 a[116:119], a[48:51], a[140:143], a[116:119]
    v_mfma_f32_16x16x32_bf16 a[124:127], a[56:59], a[140:143], a[124:127]
    buffer_load_dwordx4 a[220:223], v55, s[8:11], s62 offen sc1
    v_mfma_f32_16x16x32_bf16 a[124:127], a[60:63], a[156:159], a[124:127]
    v_mfma_f32_16x16x32_bf16 a[120:123], a[60:63], a[152:155], a[120:123]
    s_add_u32 s62, s62, 0x20000
    v_mfma_f32_16x16x32_bf16 a[120:123], a[56:59], a[136:139], a[120:123]
    v_mfma_f32_16x16x32_bf16 v[252:255], a[56:59], a[132:135], v[252:255]
    s_cmp_eq_u32 s45, 0
    s_cbranch_scc1 k12_ool_52
k12_oolret_53:
    v_mfma_f32_16x16x32_bf16 v[252:255], a[60:63], a[148:151], v[252:255]
    v_mfma_f32_16x16x32_bf16 v[248:251], a[60:63], a[144:147], v[248:251]
    v_mfma_f32_16x16x32_bf16 v[248:251], a[56:59], a[128:131], v[248:251]
    s_waitcnt vmcnt(14) lgkmcnt(0)
    v_mfma_f32_16x16x32_bf16 v[192:195], a[0:3], a[160:163], v[192:195]
    v_mfma_f32_16x16x32_bf16 v[192:195], a[4:7], a[176:179], v[192:195]
    buffer_load_dwordx4 a[224:227], v36, s[8:11], s62 offen sc1
    ds_read_b64_tr_b16 a[32:33], v46 offset:16384
    v_mfma_f32_16x16x32_bf16 v[196:199], a[4:7], a[180:183], v[196:199]
    ds_read_b64_tr_b16 a[34:35], v46 offset:17408
    v_mfma_f32_16x16x32_bf16 v[196:199], a[0:3], a[164:167], v[196:199]
    ds_read_b64_tr_b16 a[36:37], v46 offset:24576
    v_mfma_f32_16x16x32_bf16 a[64:67], a[0:3], a[168:171], a[64:67]
    ds_read_b64_tr_b16 a[38:39], v46 offset:25600
    v_mfma_f32_16x16x32_bf16 a[64:67], a[4:7], a[184:187], a[64:67]
    ds_read_b64_tr_b16 a[40:41], v47 offset:16384
    v_mfma_f32_16x16x32_bf16 a[68:71], a[4:7], a[188:191], a[68:71]
    buffer_load_dwordx4 a[228:231], v54, s[8:11], s62 offen sc1
    v_mfma_f32_16x16x32_bf16 a[68:71], a[0:3], a[172:175], a[68:71]
    ds_read_b64_tr_b16 a[42:43], v47 offset:17408
    v_mfma_f32_16x16x32_bf16 a[76:79], a[8:11], a[172:175], a[76:79]
    ds_read_b64_tr_b16 a[44:45], v47 offset:24576
    v_mfma_f32_16x16x32_bf16 a[76:79], a[12:15], a[188:191], a[76:79]
    ds_read_b64_tr_b16 a[46:47], v47 offset:25600
    v_mfma_f32_16x16x32_bf16 a[72:75], a[12:15], a[184:187], a[72:75]
    ds_read_b64_tr_b16 a[48:49], v48 offset:16384
    v_mfma_f32_16x16x32_bf16 a[72:75], a[8:11], a[168:171], a[72:75]
    buffer_load_dwordx4 a[232:235], v37, s[8:11], s62 offen sc1
    v_mfma_f32_16x16x32_bf16 v[204:207], a[8:11], a[164:167], v[204:207]
    ds_read_b64_tr_b16 a[50:51], v48 offset:17408
    v_mfma_f32_16x16x32_bf16 v[204:207], a[12:15], a[180:183], v[204:207]
    ds_read_b64_tr_b16 a[52:53], v48 offset:24576
    v_mfma_f32_16x16x32_bf16 v[200:203], a[12:15], a[176:179], v[200:203]
    ds_read_b64_tr_b16 a[54:55], v48 offset:25600
    v_mfma_f32_16x16x32_bf16 v[200:203], a[8:11], a[160:163], v[200:203]
    v_mfma_f32_16x16x32_bf16 v[208:211], a[16:19], a[160:163], v[208:211]
    ds_read_b64_tr_b16 a[56:57], v49 offset:16384
    v_mfma_f32_16x16x32_bf16 v[208:211], a[20:23], a[176:179], v[208:211]
    buffer_load_dwordx4 a[236:239], v55, s[8:11], s62 offen sc1
    ds_read_b64_tr_b16 a[58:59], v49 offset:17408
    v_mfma_f32_16x16x32_bf16 v[212:215], a[20:23], a[180:183], v[212:215]
    ds_read_b64_tr_b16 a[60:61], v49 offset:24576
    v_mfma_f32_16x16x32_bf16 v[212:215], a[16:19], a[164:167], v[212:215]
    v_mfma_f32_16x16x32_bf16 a[80:83], a[16:19], a[168:171], a[80:83]
    ds_read_b64_tr_b16 a[62:63], v49 offset:25600
    v_mfma_f32_16x16x32_bf16 a[80:83], a[20:23], a[184:187], a[80:83]
    s_add_u32 s62, s62, 0x20000
    v_mfma_f32_16x16x32_bf16 a[84:87], a[20:23], a[188:191], a[84:87]
    s_add_u32 s52, s47, 4096
    v_mfma_f32_16x16x32_bf16 a[84:87], a[16:19], a[172:175], a[84:87]
    buffer_store_dwordx4 v[88:91], v1, s[48:51], s52 offen offset:2048 sc1
    v_mfma_f32_16x16x32_bf16 a[92:95], a[24:27], a[172:175], a[92:95]
    v_mfma_f32_16x16x32_bf16 a[92:95], a[28:31], a[188:191], a[92:95]
    v_mfma_f32_16x16x32_bf16 a[88:91], a[28:31], a[184:187], a[88:91]
    v_mfma_f32_16x16x32_bf16 a[88:91], a[24:27], a[168:171], a[88:91]
    v_mfma_f32_16x16x32_bf16 v[220:223], a[24:27], a[164:167], v[220:223]
    v_mfma_f32_16x16x32_bf16 v[220:223], a[28:31], a[180:183], v[220:223]
    v_mfma_f32_16x16x32_bf16 v[216:219], a[28:31], a[176:179], v[216:219]
    v_mfma_f32_16x16x32_bf16 v[216:219], a[24:27], a[160:163], v[216:219]
    s_waitcnt vmcnt(9) lgkmcnt(0)
    s_barrier
    v_mfma_f32_16x16x32_bf16 v[224:227], a[32:35], a[160:163], v[224:227]
    v_mfma_f32_16x16x32_bf16 v[224:227], a[36:39], a[176:179], v[224:227]
    s_add_u32 m0, s60, 147456
    ds_read_b64_tr_b16 a[0:1], v42 offset:32768
    ds_read_b64_tr_b16 a[2:3], v42 offset:33792
    v_mfma_f32_16x16x32_bf16 v[228:231], a[36:39], a[180:183], v[228:231]
    buffer_load_dwordx4 v38, s[12:15], s61 offen offset:0 lds
    v_mfma_f32_16x16x32_bf16 v[228:231], a[32:35], a[164:167], v[228:231]
    ds_read_b64_tr_b16 a[4:5], v42 offset:40960
    v_mfma_f32_16x16x32_bf16 a[96:99], a[32:35], a[168:171], a[96:99]
    buffer_load_dwordx4 v39, s[12:15], s61 offen offset:1024 lds
    ds_read_b64_tr_b16 a[6:7], v42 offset:41984
    v_mfma_f32_16x16x32_bf16 a[96:99], a[36:39], a[184:187], a[96:99]
    ds_read_b64_tr_b16 a[8:9], v43 offset:32768
    v_mfma_f32_16x16x32_bf16 a[100:103], a[36:39], a[188:191], a[100:103]
    v_mfma_f32_16x16x32_bf16 a[100:103], a[32:35], a[172:175], a[100:103]
    buffer_load_dwordx4 v40, s[12:15], s61 offen offset:2048 lds
    ds_read_b64_tr_b16 a[10:11], v43 offset:33792
    v_mfma_f32_16x16x32_bf16 a[108:111], a[40:43], a[172:175], a[108:111]
    ds_read_b64_tr_b16 a[12:13], v43 offset:40960
    v_mfma_f32_16x16x32_bf16 a[108:111], a[44:47], a[188:191], a[108:111]
    ds_read_b64_tr_b16 a[14:15], v43 offset:41984
    v_mfma_f32_16x16x32_bf16 a[104:107], a[44:47], a[184:187], a[104:107]
    buffer_load_dwordx4 v41, s[12:15], s61 offen offset:3072 lds
    ds_read_b64_tr_b16 a[16:17], v44 offset:32768
    v_mfma_f32_16x16x32_bf16 a[104:107], a[40:43], a[168:171], a[104:107]
    v_mfma_f32_16x16x32_bf16 v[236:239], a[40:43], a[164:167], v[236:239]
    s_add_u32 s61, s61, 0x80000
    ds_read_b64_tr_b16 a[18:19], v44 offset:33792
    v_mfma_f32_16x16x32_bf16 v[236:239], a[44:47], a[180:183], v[236:239]
    buffer_load_dwordx4 a[240:243], v36, s[8:11], s62 offen sc1
    ds_read_b64_tr_b16 a[20:21], v44 offset:40960
    v_mfma_f32_16x16x32_bf16 v[232:235], a[44:47], a[176:179], v[232:235]
    ds_read_b64_tr_b16 a[22:23], v44 offset:41984
    v_mfma_f32_16x16x32_bf16 v[232:235], a[40:43], a[160:163], v[232:235]
    buffer_load_dwordx4 a[244:247], v54, s[8:11], s62 offen sc1
    v_mfma_f32_16x16x32_bf16 v[240:243], a[48:51], a[160:163], v[240:243]
    ds_read_b64_tr_b16 a[24:25], v45 offset:32768
    v_mfma_f32_16x16x32_bf16 v[240:243], a[52:55], a[176:179], v[240:243]
    ds_read_b64_tr_b16 a[26:27], v45 offset:33792
    v_mfma_f32_16x16x32_bf16 v[244:247], a[52:55], a[180:183], v[244:247]
    buffer_load_dwordx4 a[248:251], v37, s[8:11], s62 offen sc1
    ds_read_b64_tr_b16 a[28:29], v45 offset:40960
    v_mfma_f32_16x16x32_bf16 v[244:247], a[48:51], a[164:167], v[244:247]
    v_mfma_f32_16x16x32_bf16 a[112:115], a[48:51], a[168:171], a[112:115]
    ds_read_b64_tr_b16 a[30:31], v45 offset:41984
    v_mfma_f32_16x16x32_bf16 a[112:115], a[52:55], a[184:187], a[112:115]
    buffer_load_dwordx4 a[252:255], v55, s[8:11], s62 offen sc1
    v_mfma_f32_16x16x32_bf16 a[116:119], a[52:55], a[188:191], a[116:119]
    v_mfma_f32_16x16x32_bf16 a[116:119], a[48:51], a[172:175], a[116:119]
    s_add_u32 s62, s62, 0x20000
    v_mfma_f32_16x16x32_bf16 a[124:127], a[56:59], a[172:175], a[124:127]
    s_add_u32 s52, s47, 4096
    v_mfma_f32_16x16x32_bf16 a[124:127], a[60:63], a[188:191], a[124:127]
    buffer_store_dwordx4 v[92:95], v1, s[48:51], s52 offen offset:3072 sc1
    v_mfma_f32_16x16x32_bf16 a[120:123], a[60:63], a[184:187], a[120:123]
    v_mfma_f32_16x16x32_bf16 a[120:123], a[56:59], a[168:171], a[120:123]
    v_mfma_f32_16x16x32_bf16 v[252:255], a[56:59], a[164:167], v[252:255]
    s_cmp_eq_u32 s45, 0
    s_cbranch_scc1 k12_ool_54
k12_oolret_55:
    v_mfma_f32_16x16x32_bf16 v[252:255], a[60:63], a[180:183], v[252:255]
    v_mfma_f32_16x16x32_bf16 v[248:251], a[60:63], a[176:179], v[248:251]
    v_mfma_f32_16x16x32_bf16 v[248:251], a[56:59], a[160:163], v[248:251]
    s_waitcnt vmcnt(14) lgkmcnt(0)
    v_mfma_f32_16x16x32_bf16 v[192:195], a[0:3], a[192:195], v[192:195]
    v_mfma_f32_16x16x32_bf16 v[192:195], a[4:7], a[208:211], v[192:195]
    buffer_load_dwordx4 a[128:131], v36, s[8:11], s62 offen sc1
    ds_read_b64_tr_b16 a[32:33], v46 offset:32768
    v_mfma_f32_16x16x32_bf16 v[196:199], a[4:7], a[212:215], v[196:199]
    ds_read_b64_tr_b16 a[34:35], v46 offset:33792
    v_mfma_f32_16x16x32_bf16 v[196:199], a[0:3], a[196:199], v[196:199]
    ds_read_b64_tr_b16 a[36:37], v46 offset:40960
    v_mfma_f32_16x16x32_bf16 a[64:67], a[0:3], a[200:203], a[64:67]
    ds_read_b64_tr_b16 a[38:39], v46 offset:41984
    v_mfma_f32_16x16x32_bf16 a[64:67], a[4:7], a[216:219], a[64:67]
    ds_read_b64_tr_b16 a[40:41], v47 offset:32768
    v_mfma_f32_16x16x32_bf16 a[68:71], a[4:7], a[220:223], a[68:71]
    buffer_load_dwordx4 a[132:135], v54, s[8:11], s62 offen sc1
    v_mfma_f32_16x16x32_bf16 a[68:71], a[0:3], a[204:207], a[68:71]
    ds_read_b64_tr_b16 a[42:43], v47 offset:33792
    v_mfma_f32_16x16x32_bf16 a[76:79], a[8:11], a[204:207], a[76:79]
    ds_read_b64_tr_b16 a[44:45], v47 offset:40960
    v_mfma_f32_16x16x32_bf16 a[76:79], a[12:15], a[220:223], a[76:79]
    ds_read_b64_tr_b16 a[46:47], v47 offset:41984
    v_mfma_f32_16x16x32_bf16 a[72:75], a[12:15], a[216:219], a[72:75]
    ds_read_b64_tr_b16 a[48:49], v48 offset:32768
    v_mfma_f32_16x16x32_bf16 a[72:75], a[8:11], a[200:203], a[72:75]
    buffer_load_dwordx4 a[136:139], v37, s[8:11], s62 offen sc1
    v_mfma_f32_16x16x32_bf16 v[204:207], a[8:11], a[196:199], v[204:207]
    ds_read_b64_tr_b16 a[50:51], v48 offset:33792
    v_mfma_f32_16x16x32_bf16 v[204:207], a[12:15], a[212:215], v[204:207]
    ds_read_b64_tr_b16 a[52:53], v48 offset:40960
    v_mfma_f32_16x16x32_bf16 v[200:203], a[12:15], a[208:211], v[200:203]
    ds_read_b64_tr_b16 a[54:55], v48 offset:41984
    v_mfma_f32_16x16x32_bf16 v[200:203], a[8:11], a[192:195], v[200:203]
    v_mfma_f32_16x16x32_bf16 v[208:211], a[16:19], a[192:195], v[208:211]
    ds_read_b64_tr_b16 a[56:57], v49 offset:32768
    v_mfma_f32_16x16x32_bf16 v[208:211], a[20:23], a[208:211], v[208:211]
    buffer_load_dwordx4 a[140:143], v55, s[8:11], s62 offen sc1
    ds_read_b64_tr_b16 a[58:59], v49 offset:33792
    v_mfma_f32_16x16x32_bf16 v[212:215], a[20:23], a[212:215], v[212:215]
    ds_read_b64_tr_b16 a[60:61], v49 offset:40960
    v_mfma_f32_16x16x32_bf16 v[212:215], a[16:19], a[196:199], v[212:215]
    v_mfma_f32_16x16x32_bf16 a[80:83], a[16:19], a[200:203], a[80:83]
    ds_read_b64_tr_b16 a[62:63], v49 offset:41984
    v_mfma_f32_16x16x32_bf16 a[80:83], a[20:23], a[216:219], a[80:83]
    s_add_u32 s62, s62, 0x20000
    v_mfma_f32_16x16x32_bf16 a[84:87], a[20:23], a[220:223], a[84:87]
    s_add_u32 s52, s47, 8192
    v_mfma_f32_16x16x32_bf16 a[84:87], a[16:19], a[204:207], a[84:87]
    buffer_store_dwordx4 v[104:107], v1, s[48:51], s52 offen offset:2048 sc1
    v_mfma_f32_16x16x32_bf16 a[92:95], a[24:27], a[204:207], a[92:95]
    v_mfma_f32_16x16x32_bf16 a[92:95], a[28:31], a[220:223], a[92:95]
    v_mfma_f32_16x16x32_bf16 a[88:91], a[28:31], a[216:219], a[88:91]
    v_mfma_f32_16x16x32_bf16 a[88:91], a[24:27], a[200:203], a[88:91]
    v_mfma_f32_16x16x32_bf16 v[220:223], a[24:27], a[196:199], v[220:223]
    v_mfma_f32_16x16x32_bf16 v[220:223], a[28:31], a[212:215], v[220:223]
    v_mfma_f32_16x16x32_bf16 v[216:219], a[28:31], a[208:211], v[216:219]
    v_mfma_f32_16x16x32_bf16 v[216:219], a[24:27], a[192:195], v[216:219]
    s_waitcnt vmcnt(10) lgkmcnt(0)
    s_barrier
    v_mfma_f32_16x16x32_bf16 v[224:227], a[32:35], a[192:195], v[224:227]
    v_mfma_f32_16x16x32_bf16 v[224:227], a[36:39], a[208:211], v[224:227]
    s_add_u32 m0, s60, 98304
    ds_read_b64_tr_b16 a[0:1], v42 offset:49152
    ds_read_b64_tr_b16 a[2:3], v42 offset:50176
    v_mfma_f32_16x16x32_bf16 v[228:231], a[36:39], a[212:215], v[228:231]
    buffer_load_dwordx4 v38, s[12:15], s61 offen offset:0 lds
    v_mfma_f32_16x16x32_bf16 v[228:231], a[32:35], a[196:199], v[228:231]
    ds_read_b64_tr_b16 a[4:5], v42 offset:57344
    v_mfma_f32_16x16x32_bf16 a[96:99], a[32:35], a[200:203], a[96:99]
    buffer_load_dwordx4 v39, s[12:15], s61 offen offset:1024 lds
    ds_read_b64_tr_b16 a[6:7], v42 offset:58368
    v_mfma_f32_16x16x32_bf16 a[96:99], a[36:39], a[216:219], a[96:99]
    ds_read_b64_tr_b16 a[8:9], v43 offset:49152
    v_mfma_f32_16x16x32_bf16 a[100:103], a[36:39], a[220:223], a[100:103]
    v_mfma_f32_16x16x32_bf16 a[100:103], a[32:35], a[204:207], a[100:103]
    buffer_load_dwordx4 v40, s[12:15], s61 offen offset:2048 lds
    ds_read_b64_tr_b16 a[10:11], v43 offset:50176
    v_mfma_f32_16x16x32_bf16 a[108:111], a[40:43], a[204:207], a[108:111]
    ds_read_b64_tr_b16 a[12:13], v43 offset:57344
    v_mfma_f32_16x16x32_bf16 a[108:111], a[44:47], a[220:223], a[108:111]
    ds_read_b64_tr_b16 a[14:15], v43 offset:58368
    v_mfma_f32_16x16x32_bf16 a[104:107], a[44:47], a[216:219], a[104:107]
    buffer_load_dwordx4 v41, s[12:15], s61 offen offset:3072 lds
    ds_read_b64_tr_b16 a[16:17], v44 offset:49152
    v_mfma_f32_16x16x32_bf16 a[104:107], a[40:43], a[200:203], a[104:107]
    v_mfma_f32_16x16x32_bf16 v[236:239], a[40:43], a[196:199], v[236:239]
    s_add_u32 s61, s61, 0x80000
    ds_read_b64_tr_b16 a[18:19], v44 offset:50176
    v_mfma_f32_16x16x32_bf16 v[236:239], a[44:47], a[212:215], v[236:239]
    buffer_load_dwordx4 a[144:147], v36, s[8:11], s62 offen sc1
    ds_read_b64_tr_b16 a[20:21], v44 offset:57344
    v_mfma_f32_16x16x32_bf16 v[232:235], a[44:47], a[208:211], v[232:235]
    ds_read_b64_tr_b16 a[22:23], v44 offset:58368
    v_mfma_f32_16x16x32_bf16 v[232:235], a[40:43], a[192:195], v[232:235]
    buffer_load_dwordx4 a[148:151], v54, s[8:11], s62 offen sc1
    v_mfma_f32_16x16x32_bf16 v[240:243], a[48:51], a[192:195], v[240:243]
    ds_read_b64_tr_b16 a[24:25], v45 offset:49152
    v_mfma_f32_16x16x32_bf16 v[240:243], a[52:55], a[208:211], v[240:243]
    ds_read_b64_tr_b16 a[26:27], v45 offset:50176
    v_mfma_f32_16x16x32_bf16 v[244:247], a[52:55], a[212:215], v[244:247]
    buffer_load_dwordx4 a[152:155], v37, s[8:11], s62 offen sc1
    ds_read_b64_tr_b16 a[28:29], v45 offset:57344
    v_mfma_f32_16x16x32_bf16 v[244:247], a[48:51], a[196:199], v[244:247]
    v_mfma_f32_16x16x32_bf16 a[112:115], a[48:51], a[200:203], a[112:115]
    ds_read_b64_tr_b16 a[30:31], v45 offset:58368
    v_mfma_f32_16x16x32_bf16 a[112:115], a[52:55], a[216:219], a[112:115]
    buffer_load_dwordx4 a[156:159], v55, s[8:11], s62 offen sc1
    v_mfma_f32_16x16x32_bf16 a[116:119], a[52:55], a[220:223], a[116:119]
    v_mfma_f32_16x16x32_bf16 a[116:119], a[48:51], a[204:207], a[116:119]
    s_add_u32 s62, s62, 0x20000
    v_mfma_f32_16x16x32_bf16 a[124:127], a[56:59], a[204:207], a[124:127]
    s_add_u32 s52, s47, 8192
    v_mfma_f32_16x16x32_bf16 a[124:127], a[60:63], a[220:223], a[124:127]
    buffer_store_dwordx4 v[108:111], v1, s[48:51], s52 offen offset:3072 sc1
    v_mfma_f32_16x16x32_bf16 a[120:123], a[60:63], a[216:219], a[120:123]
    v_mfma_f32_16x16x32_bf16 a[120:123], a[56:59], a[200:203], a[120:123]
    v_mfma_f32_16x16x32_bf16 v[252:255], a[56:59], a[196:199], v[252:255]
    v_mfma_f32_16x16x32_bf16 v[252:255], a[60:63], a[212:215], v[252:255]
    v_mfma_f32_16x16x32_bf16 v[248:251], a[60:63], a[208:211], v[248:251]
    v_mfma_f32_16x16x32_bf16 v[248:251], a[56:59], a[192:195], v[248:251]
    s_waitcnt vmcnt(15) lgkmcnt(0)
    v_mfma_f32_16x16x32_bf16 v[192:195], a[0:3], a[224:227], v[192:195]
    v_mfma_f32_16x16x32_bf16 v[192:195], a[4:7], a[240:243], v[192:195]
    buffer_load_dwordx4 a[160:163], v36, s[8:11], s62 offen sc1
    ds_read_b64_tr_b16 a[32:33], v46 offset:49152
    v_mfma_f32_16x16x32_bf16 v[196:199], a[4:7], a[244:247], v[196:199]
    ds_read_b64_tr_b16 a[34:35], v46 offset:50176
    v_mfma_f32_16x16x32_bf16 v[196:199], a[0:3], a[228:231], v[196:199]
    ds_read_b64_tr_b16 a[36:37], v46 offset:57344
    v_mfma_f32_16x16x32_bf16 a[64:67], a[0:3], a[232:235], a[64:67]
    ds_read_b64_tr_b16 a[38:39], v46 offset:58368
    v_mfma_f32_16x16x32_bf16 a[64:67], a[4:7], a[248:251], a[64:67]
    ds_read_b64_tr_b16 a[40:41], v47 offset:49152
    v_mfma_f32_16x16x32_bf16 a[68:71], a[4:7], a[252:255], a[68:71]
    buffer_load_dwordx4 a[164:167], v54, s[8:11], s62 offen sc1
    v_mfma_f32_16x16x32_bf16 a[68:71], a[0:3], a[236:239], a[68:71]
    ds_read_b64_tr_b16 a[42:43], v47 offset:50176
    v_mfma_f32_16x16x32_bf16 a[76:79], a[8:11], a[236:239], a[76:79]
    ds_read_b64_tr_b16 a[44:45], v47 offset:57344
    v_mfma_f32_16x16x32_bf16 a[76:79], a[12:15], a[252:255], a[76:79]
    ds_read_b64_tr_b16 a[46:47], v47 offset:58368
    v_mfma_f32_16x16x32_bf16 a[72:75], a[12:15], a[248:251], a[72:75]
    ds_read_b64_tr_b16 a[48:49], v48 offset:49152
    v_mfma_f32_16x16x32_bf16 a[72:75], a[8:11], a[232:235], a[72:75]
    buffer_load_dwordx4 a[168:171], v37, s[8:11], s62 offen sc1
    v_mfma_f32_16x16x32_bf16 v[204:207], a[8:11], a[228:231], v[204:207]
    ds_read_b64_tr_b16 a[50:51], v48 offset:50176
    v_mfma_f32_16x16x32_bf16 v[204:207], a[12:15], a[244:247], v[204:207]
    ds_read_b64_tr_b16 a[52:53], v48 offset:57344
    v_mfma_f32_16x16x32_bf16 v[200:203], a[12:15], a[240:243], v[200:203]
    ds_read_b64_tr_b16 a[54:55], v48 offset:58368
    v_mfma_f32_16x16x32_bf16 v[200:203], a[8:11], a[224:227], v[200:203]
    v_mfma_f32_16x16x32_bf16 v[208:211], a[16:19], a[224:227], v[208:211]
    ds_read_b64_tr_b16 a[56:57], v49 offset:49152
    v_mfma_f32_16x16x32_bf16 v[208:211], a[20:23], a[240:243], v[208:211]
    buffer_load_dwordx4 a[172:175], v55, s[8:11], s62 offen sc1
    ds_read_b64_tr_b16 a[58:59], v49 offset:50176
    v_mfma_f32_16x16x32_bf16 v[212:215], a[20:23], a[244:247], v[212:215]
    ds_read_b64_tr_b16 a[60:61], v49 offset:57344
    v_mfma_f32_16x16x32_bf16 v[212:215], a[16:19], a[228:231], v[212:215]
    v_mfma_f32_16x16x32_bf16 a[80:83], a[16:19], a[232:235], a[80:83]
    ds_read_b64_tr_b16 a[62:63], v49 offset:58368
    v_mfma_f32_16x16x32_bf16 a[80:83], a[20:23], a[248:251], a[80:83]
    s_add_u32 s62, s62, 0x20000
    v_mfma_f32_16x16x32_bf16 a[84:87], a[20:23], a[252:255], a[84:87]
    s_add_u32 s52, s47, 12288
    v_mfma_f32_16x16x32_bf16 a[84:87], a[16:19], a[236:239], a[84:87]
    buffer_store_dwordx4 v[112:115], v1, s[48:51], s52 offen offset:0 sc1
    v_mfma_f32_16x16x32_bf16 a[92:95], a[24:27], a[236:239], a[92:95]
    v_mfma_f32_16x16x32_bf16 a[92:95], a[28:31], a[252:255], a[92:95]
    v_mfma_f32_16x16x32_bf16 a[88:91], a[28:31], a[248:251], a[88:91]
    v_mfma_f32_16x16x32_bf16 a[88:91], a[24:27], a[232:235], a[88:91]
    v_mfma_f32_16x16x32_bf16 v[220:223], a[24:27], a[228:231], v[220:223]
    s_cmp_eq_u32 s45, 0
    s_cbranch_scc1 k12_ool_56
k12_oolret_57:
    v_mfma_f32_16x16x32_bf16 v[220:223], a[28:31], a[244:247], v[220:223]
    v_mfma_f32_16x16x32_bf16 v[216:219], a[28:31], a[240:243], v[216:219]
    v_mfma_f32_16x16x32_bf16 v[216:219], a[24:27], a[224:227], v[216:219]
    s_waitcnt vmcnt(10) lgkmcnt(0)
    s_barrier
    v_mfma_f32_16x16x32_bf16 v[224:227], a[32:35], a[224:227], v[224:227]
    v_mfma_f32_16x16x32_bf16 v[224:227], a[36:39], a[240:243], v[224:227]
    s_add_u32 m0, s60, 114688
    ds_read_b64_tr_b16 a[0:1], v42 offset:0
    ds_read_b64_tr_b16 a[2:3], v42 offset:1024
    v_mfma_f32_16x16x32_bf16 v[228:231], a[36:39], a[244:247], v[228:231]
    buffer_load_dwordx4 v38, s[12:15], s61 offen offset:0 lds
    v_mfma_f32_16x16x32_bf16 v[228:231], a[32:35], a[228:231], v[228:231]
    ds_read_b64_tr_b16 a[4:5], v42 offset:8192
    v_mfma_f32_16x16x32_bf16 a[96:99], a[32:35], a[232:235], a[96:99]
    buffer_load_dwordx4 v39, s[12:15], s61 offen offset:1024 lds
    ds_read_b64_tr_b16 a[6:7], v42 offset:9216
    v_mfma_f32_16x16x32_bf16 a[96:99], a[36:39], a[248:251], a[96:99]
    ds_read_b64_tr_b16 a[8:9], v43 offset:0
    v_mfma_f32_16x16x32_bf16 a[100:103], a[36:39], a[252:255], a[100:103]
    v_mfma_f32_16x16x32_bf16 a[100:103], a[32:35], a[236:239], a[100:103]
    buffer_load_dwordx4 v40, s[12:15], s61 offen offset:2048 lds
    ds_read_b64_tr_b16 a[10:11], v43 offset:1024
    v_mfma_f32_16x16x32_bf16 a[108:111], a[40:43], a[236:239], a[108:111]
    ds_read_b64_tr_b16 a[12:13], v43 offset:8192
    v_mfma_f32_16x16x32_bf16 a[108:111], a[44:47], a[252:255], a[108:111]
    ds_read_b64_tr_b16 a[14:15], v43 offset:9216
    v_mfma_f32_16x16x32_bf16 a[104:107], a[44:47], a[248:251], a[104:107]
    ds_read_b64_tr_b16 a[16:17], v44 offset:0
    v_mfma_f32_16x16x32_bf16 a[104:107], a[40:43], a[232:235], a[104:107]
    buffer_load_dwordx4 v41, s[12:15], s61 offen offset:3072 lds
    v_mfma_f32_16x16x32_bf16 v[236:239], a[40:43], a[228:231], v[236:239]
    ds_read_b64_tr_b16 a[18:19], v44 offset:1024
    v_mfma_f32_16x16x32_bf16 v[236:239], a[44:47], a[244:247], v[236:239]
    s_add_u32 s61, s61, 0x80000
    ds_read_b64_tr_b16 a[20:21], v44 offset:8192
    v_mfma_f32_16x16x32_bf16 v[232:235], a[44:47], a[240:243], v[232:235]
    buffer_load_dwordx4 a[176:179], v36, s[8:11], s62 offen sc1
    ds_read_b64_tr_b16 a[22:23], v44 offset:9216
    v_mfma_f32_16x16x32_bf16 v[232:235], a[40:43], a[224:227], v[232:235]
    v_mfma_f32_16x16x32_bf16 v[240:243], a[48:51], a[224:227], v[240:243]
    ds_read_b64_tr_b16 a[24:25], v45 offset:0
    v_mfma_f32_16x16x32_bf16 v[240:243], a[52:55], a[240:243], v[240:243]
    buffer_load_dwordx4 a[180:183], v54, s[8:11], s62 offen sc1
    ds_read_b64_tr_b16 a[26:27], v45 offset:1024
    v_mfma_f32_16x16x32_bf16 v[244:247], a[52:55], a[244:247], v[244:247]
    ds_read_b64_tr_b16 a[28:29], v45 offset:8192
    v_mfma_f32_16x16x32_bf16 v[244:247], a[48:51], a[228:231], v[244:247]
    v_mfma_f32_16x16x32_bf16 a[112:115], a[48:51], a[232:235], a[112:115]
    buffer_load_dwordx4 a[184:187], v37, s[8:11], s62 offen sc1
    ds_read_b64_tr_b16 a[30:31], v45 offset:9216
    v_mfma_f32_16x16x32_bf16 a[112:115], a[52:55], a[248:251], a[112:115]
    v_mfma_f32_16x16x32_bf16 a[116:119], a[52:55], a[252:255], a[116:119]
    v_mfma_f32_16x16x32_bf16 a[116:119], a[48:51], a[236:239], a[116:119]
    v_mfma_f32_16x16x32_bf16 a[124:127], a[56:59], a[236:239], a[124:127]
    buffer_load_dwordx4 a[188:191], v55, s[8:11], s62 offen sc1
    v_mfma_f32_16x16x32_bf16 a[124:127], a[60:63], a[252:255], a[124:127]
    v_mfma_f32_16x16x32_bf16 a[120:123], a[60:63], a[248:251], a[120:123]
    s_add_u32 s62, s62, 0x20000
    v_mfma_f32_16x16x32_bf16 a[120:123], a[56:59], a[232:235], a[120:123]
    v_mfma_f32_16x16x32_bf16 v[252:255], a[56:59], a[228:231], v[252:255]
    v_mfma_f32_16x16x32_bf16 v[252:255], a[60:63], a[244:247], v[252:255]
    v_mfma_f32_16x16x32_bf16 v[248:251], a[60:63], a[240:243], v[248:251]
    v_mfma_f32_16x16x32_bf16 v[248:251], a[56:59], a[224:227], v[248:251]
    s_waitcnt vmcnt(14) lgkmcnt(0)
    v_mfma_f32_16x16x32_bf16 v[192:195], a[0:3], a[128:131], v[192:195]
    v_mfma_f32_16x16x32_bf16 v[192:195], a[4:7], a[144:147], v[192:195]
    buffer_load_dwordx4 a[192:195], v36, s[8:11], s62 offen sc1
    ds_read_b64_tr_b16 a[32:33], v46 offset:0
    v_mfma_f32_16x16x32_bf16 v[196:199], a[4:7], a[148:151], v[196:199]
    ds_read_b64_tr_b16 a[34:35], v46 offset:1024
    v_mfma_f32_16x16x32_bf16 v[196:199], a[0:3], a[132:135], v[196:199]
    ds_read_b64_tr_b16 a[36:37], v46 offset:8192
    v_mfma_f32_16x16x32_bf16 a[64:67], a[0:3], a[136:139], a[64:67]
    ds_read_b64_tr_b16 a[38:39], v46 offset:9216
    v_mfma_f32_16x16x32_bf16 a[64:67], a[4:7], a[152:155], a[64:67]
    ds_read_b64_tr_b16 a[40:41], v47 offset:0
    v_mfma_f32_16x16x32_bf16 a[68:71], a[4:7], a[156:159], a[68:71]
    buffer_load_dwordx4 a[196:199], v54, s[8:11], s62 offen sc1
    v_mfma_f32_16x16x32_bf16 a[68:71], a[0:3], a[140:143], a[68:71]
    ds_read_b64_tr_b16 a[42:43], v47 offset:1024
    v_mfma_f32_16x16x32_bf16 a[76:79], a[8:11], a[140:143], a[76:79]
    ds_read_b64_tr_b16 a[44:45], v47 offset:8192
    v_mfma_f32_16x16x32_bf16 a[76:79], a[12:15], a[156:159], a[76:79]
    ds_read_b64_tr_b16 a[46:47], v47 offset:9216
    v_mfma_f32_16x16x32_bf16 a[72:75], a[12:15], a[152:155], a[72:75]
    ds_read_b64_tr_b16 a[48:49], v48 offset:0
    v_mfma_f32_16x16x32_bf16 a[72:75], a[8:11], a[136:139], a[72:75]
    buffer_load_dwordx4 a[200:203], v37, s[8:11], s62 offen sc1
    v_mfma_f32_16x16x32_bf16 v[204:207], a[8:11], a[132:135], v[204:207]
    ds_read_b64_tr_b16 a[50:51], v48 offset:1024
    v_mfma_f32_16x16x32_bf16 v[204:207], a[12:15], a[148:151], v[204:207]
    ds_read_b64_tr_b16 a[52:53], v48 offset:8192
    v_mfma_f32_16x16x32_bf16 v[200:203], a[12:15], a[144:147], v[200:203]
    ds_read_b64_tr_b16 a[54:55], v48 offset:9216
    v_mfma_f32_16x16x32_bf16 v[200:203], a[8:11], a[128:131], v[200:203]
    v_mfma_f32_16x16x32_bf16 v[208:211], a[16:19], a[128:131], v[208:211]
    ds_read_b64_tr_b16 a[56:57], v49 offset:0
    v_mfma_f32_16x16x32_bf16 v[208:211], a[20:23], a[144:147], v[208:211]
    buffer_load_dwordx4 a[204:207], v55, s[8:11], s62 offen sc1
    ds_read_b64_tr_b16 a[58:59], v49 offset:1024
    v_mfma_f32_16x16x32_bf16 v[212:215], a[20:23], a[148:151], v[212:215]
    ds_read_b64_tr_b16 a[60:61], v49 offset:8192
    v_mfma_f32_16x16x32_bf16 v[212:215], a[16:19], a[132:135], v[212:215]
    v_mfma_f32_16x16x32_bf16 a[80:83], a[16:19], a[136:139], a[80:83]
    ds_read_b64_tr_b16 a[62:63], v49 offset:9216
    v_mfma_f32_16x16x32_bf16 a[80:83], a[20:23], a[152:155], a[80:83]
    s_add_u32 s62, s62, 0x20000
    v_mfma_f32_16x16x32_bf16 a[84:87], a[20:23], a[156:159], a[84:87]
    s_add_u32 s52, s47, 12288
    v_mfma_f32_16x16x32_bf16 a[84:87], a[16:19], a[140:143], a[84:87]
    buffer_store_dwordx4 v[116:119], v1, s[48:51], s52 offen offset:1024 sc1
    v_mfma_f32_16x16x32_bf16 a[92:95], a[24:27], a[140:143], a[92:95]
    v_mfma_f32_16x16x32_bf16 a[92:95], a[28:31], a[156:159], a[92:95]
    v_mfma_f32_16x16x32_bf16 a[88:91], a[28:31], a[152:155], a[88:91]
    v_mfma_f32_16x16x32_bf16 a[88:91], a[24:27], a[136:139], a[88:91]
    v_mfma_f32_16x16x32_bf16 v[220:223], a[24:27], a[132:135], v[220:223]
    s_cmp_eq_u32 s45, 0
    s_cbranch_scc1 k12_ool_58
k12_oolret_59:
    v_mfma_f32_16x16x32_bf16 v[220:223], a[28:31], a[148:151], v[220:223]
    v_mfma_f32_16x16x32_bf16 v[216:219], a[28:31], a[144:147], v[216:219]
    v_mfma_f32_16x16x32_bf16 v[216:219], a[24:27], a[128:131], v[216:219]
    s_waitcnt vmcnt(9) lgkmcnt(0)
    s_barrier
    v_mfma_f32_16x16x32_bf16 v[224:227], a[32:35], a[128:131], v[224:227]
    v_mfma_f32_16x16x32_bf16 v[224:227], a[36:39], a[144:147], v[224:227]
    s_add_u32 m0, s60, 131072
    ds_read_b64_tr_b16 a[0:1], v42 offset:16384
    ds_read_b64_tr_b16 a[2:3], v42 offset:17408
    v_mfma_f32_16x16x32_bf16 v[228:231], a[36:39], a[148:151], v[228:231]
    buffer_load_dwordx4 v38, s[12:15], s61 offen offset:0 lds
    v_mfma_f32_16x16x32_bf16 v[228:231], a[32:35], a[132:135], v[228:231]
    ds_read_b64_tr_b16 a[4:5], v42 offset:24576
    v_mfma_f32_16x16x32_bf16 a[96:99], a[32:35], a[136:139], a[96:99]
    buffer_load_dwordx4 v39, s[12:15], s61 offen offset:1024 lds
    ds_read_b64_tr_b16 a[6:7], v42 offset:25600
    v_mfma_f32_16x16x32_bf16 a[96:99], a[36:39], a[152:155], a[96:99]
    ds_read_b64_tr_b16 a[8:9], v43 offset:16384
    v_mfma_f32_16x16x32_bf16 a[100:103], a[36:39], a[156:159], a[100:103]
    v_mfma_f32_16x16x32_bf16 a[100:103], a[32:35], a[140:143], a[100:103]
    buffer_load_dwordx4 v40, s[12:15], s61 offen offset:2048 lds
    ds_read_b64_tr_b16 a[10:11], v43 offset:17408
    v_mfma_f32_16x16x32_bf16 a[108:111], a[40:43], a[140:143], a[108:111]
    ds_read_b64_tr_b16 a[12:13], v43 offset:24576
    v_mfma_f32_16x16x32_bf16 a[108:111], a[44:47], a[156:159], a[108:111]
    ds_read_b64_tr_b16 a[14:15], v43 offset:25600
    v_mfma_f32_16x16x32_bf16 a[104:107], a[44:47], a[152:155], a[104:107]
    buffer_load_dwordx4 v41, s[12:15], s61 offen offset:3072 lds
    ds_read_b64_tr_b16 a[16:17], v44 offset:16384
    v_mfma_f32_16x16x32_bf16 a[104:107], a[40:43], a[136:139], a[104:107]
    v_mfma_f32_16x16x32_bf16 v[236:239], a[40:43], a[132:135], v[236:239]
    s_add_u32 s61, s61, 0x80000
    ds_read_b64_tr_b16 a[18:19], v44 offset:17408
    v_mfma_f32_16x16x32_bf16 v[236:239], a[44:47], a[148:151], v[236:239]
    buffer_load_dwordx4 a[208:211], v36, s[8:11], s62 offen sc1
    ds_read_b64_tr_b16 a[20:21], v44 offset:24576
    v_mfma_f32_16x16x32_bf16 v[232:235], a[44:47], a[144:147], v[232:235]
    ds_read_b64_tr_b16 a[22:23], v44 offset:25600
    v_mfma_f32_16x16x32_bf16 v[232:235], a[40:43], a[128:131], v[232:235]
    buffer_load_dwordx4 a[212:215], v54, s[8:11], s62 offen sc1
    v_mfma_f32_16x16x32_bf16 v[240:243], a[48:51], a[128:131], v[240:243]
    ds_read_b64_tr_b16 a[24:25], v45 offset:16384
    v_mfma_f32_16x16x32_bf16 v[240:243], a[52:55], a[144:147], v[240:243]
    ds_read_b64_tr_b16 a[26:27], v45 offset:17408
    v_mfma_f32_16x16x32_bf16 v[244:247], a[52:55], a[148:151], v[244:247]
    buffer_load_dwordx4 a[216:219], v37, s[8:11], s62 offen sc1
    ds_read_b64_tr_b16 a[28:29], v45 offset:24576
    v_mfma_f32_16x16x32_bf16 v[244:247], a[48:51], a[132:135], v[244:247]
    v_mfma_f32_16x16x32_bf16 a[112:115], a[48:51], a[136:139], a[112:115]
    ds_read_b64_tr_b16 a[30:31], v45 offset:25600
    v_mfma_f32_16x16x32_bf16 a[112:115], a[52:55], a[152:155], a[112:115]
    buffer_load_dwordx4 a[220:223], v55, s[8:11], s62 offen sc1
    v_mfma_f32_16x16x32_bf16 a[116:119], a[52:55], a[156:159], a[116:119]
    v_mfma_f32_16x16x32_bf16 a[116:119], a[48:51], a[140:143], a[116:119]
    s_add_u32 s62, s62, 0x20000
    v_mfma_f32_16x16x32_bf16 a[124:127], a[56:59], a[140:143], a[124:127]
    s_add_u32 s52, s47, 12288
    v_mfma_f32_16x16x32_bf16 a[124:127], a[60:63], a[156:159], a[124:127]
    buffer_store_dwordx4 v[120:123], v1, s[48:51], s52 offen offset:2048 sc1
    v_mfma_f32_16x16x32_bf16 a[120:123], a[60:63], a[152:155], a[120:123]
    v_mfma_f32_16x16x32_bf16 a[120:123], a[56:59], a[136:139], a[120:123]
    v_mfma_f32_16x16x32_bf16 v[252:255], a[56:59], a[132:135], v[252:255]
    v_mfma_f32_16x16x32_bf16 v[252:255], a[60:63], a[148:151], v[252:255]
    v_mfma_f32_16x16x32_bf16 v[248:251], a[60:63], a[144:147], v[248:251]
    v_mfma_f32_16x16x32_bf16 v[248:251], a[56:59], a[128:131], v[248:251]
    s_waitcnt vmcnt(14) lgkmcnt(0)
    v_mfma_f32_16x16x32_bf16 v[192:195], a[0:3], a[160:163], v[192:195]
    v_mfma_f32_16x16x32_bf16 v[192:195], a[4:7], a[176:179], v[192:195]
    buffer_load_dwordx4 a[224:227], v36, s[8:11], s62 offen sc1
    ds_read_b64_tr_b16 a[32:33], v46 offset:16384
    v_mfma_f32_16x16x32_bf16 v[196:199], a[4:7], a[180:183], v[196:199]
    ds_read_b64_tr_b16 a[34:35], v46 offset:17408
    v_mfma_f32_16x16x32_bf16 v[196:199], a[0:3], a[164:167], v[196:199]
    ds_read_b64_tr_b16 a[36:37], v46 offset:24576
    v_mfma_f32_16x16x32_bf16 a[64:67], a[0:3], a[168:171], a[64:67]
    ds_read_b64_tr_b16 a[38:39], v46 offset:25600
    v_mfma_f32_16x16x32_bf16 a[64:67], a[4:7], a[184:187], a[64:67]
    ds_read_b64_tr_b16 a[40:41], v47 offset:16384
    v_mfma_f32_16x16x32_bf16 a[68:71], a[4:7], a[188:191], a[68:71]
    buffer_load_dwordx4 a[228:231], v54, s[8:11], s62 offen sc1
    v_mfma_f32_16x16x32_bf16 a[68:71], a[0:3], a[172:175], a[68:71]
    ds_read_b64_tr_b16 a[42:43], v47 offset:17408
    v_mfma_f32_16x16x32_bf16 a[76:79], a[8:11], a[172:175], a[76:79]
    ds_read_b64_tr_b16 a[44:45], v47 offset:24576
    v_mfma_f32_16x16x32_bf16 a[76:79], a[12:15], a[188:191], a[76:79]
    ds_read_b64_tr_b16 a[46:47], v47 offset:25600
    v_mfma_f32_16x16x32_bf16 a[72:75], a[12:15], a[184:187], a[72:75]
    ds_read_b64_tr_b16 a[48:49], v48 offset:16384
    v_mfma_f32_16x16x32_bf16 a[72:75], a[8:11], a[168:171], a[72:75]
    buffer_load_dwordx4 a[232:235], v37, s[8:11], s62 offen sc1
    v_mfma_f32_16x16x32_bf16 v[204:207], a[8:11], a[164:167], v[204:207]
    ds_read_b64_tr_b16 a[50:51], v48 offset:17408
    v_mfma_f32_16x16x32_bf16 v[204:207], a[12:15], a[180:183], v[204:207]
    ds_read_b64_tr_b16 a[52:53], v48 offset:24576
    v_mfma_f32_16x16x32_bf16 v[200:203], a[12:15], a[176:179], v[200:203]
    ds_read_b64_tr_b16 a[54:55], v48 offset:25600
    v_mfma_f32_16x16x32_bf16 v[200:203], a[8:11], a[160:163], v[200:203]
    v_mfma_f32_16x16x32_bf16 v[208:211], a[16:19], a[160:163], v[208:211]
    ds_read_b64_tr_b16 a[56:57], v49 offset:16384
    v_mfma_f32_16x16x32_bf16 v[208:211], a[20:23], a[176:179], v[208:211]
    buffer_load_dwordx4 a[236:239], v55, s[8:11], s62 offen sc1
    ds_read_b64_tr_b16 a[58:59], v49 offset:17408
    v_mfma_f32_16x16x32_bf16 v[212:215], a[20:23], a[180:183], v[212:215]
    ds_read_b64_tr_b16 a[60:61], v49 offset:24576
    v_mfma_f32_16x16x32_bf16 v[212:215], a[16:19], a[164:167], v[212:215]
    v_mfma_f32_16x16x32_bf16 a[80:83], a[16:19], a[168:171], a[80:83]
    ds_read_b64_tr_b16 a[62:63], v49 offset:25600
    v_mfma_f32_16x16x32_bf16 a[80:83], a[20:23], a[184:187], a[80:83]
    s_add_u32 s62, s62, 0x20000
    v_mfma_f32_16x16x32_bf16 a[84:87], a[20:23], a[188:191], a[84:87]
    s_add_u32 s52, s47, 12288
    v_mfma_f32_16x16x32_bf16 a[84:87], a[16:19], a[172:175], a[84:87]
    buffer_store_dwordx4 v[124:127], v1, s[48:51], s52 offen offset:3072 sc1
    v_mfma_f32_16x16x32_bf16 a[92:95], a[24:27], a[172:175], a[92:95]
    v_mfma_f32_16x16x32_bf16 a[92:95], a[28:31], a[188:191], a[92:95]
    v_mfma_f32_16x16x32_bf16 a[88:91], a[28:31], a[184:187], a[88:91]
    v_mfma_f32_16x16x32_bf16 a[88:91], a[24:27], a[168:171], a[88:91]
    v_mfma_f32_16x16x32_bf16 v[220:223], a[24:27], a[164:167], v[220:223]
    v_mfma_f32_16x16x32_bf16 v[220:223], a[28:31], a[180:183], v[220:223]
    v_mfma_f32_16x16x32_bf16 v[216:219], a[28:31], a[176:179], v[216:219]
    v_mfma_f32_16x16x32_bf16 v[216:219], a[24:27], a[160:163], v[216:219]
    s_waitcnt vmcnt(10) lgkmcnt(0)
    s_barrier
    v_mfma_f32_16x16x32_bf16 v[224:227], a[32:35], a[160:163], v[224:227]
    v_mfma_f32_16x16x32_bf16 v[224:227], a[36:39], a[176:179], v[224:227]
    s_add_u32 m0, s60, 147456
    ds_read_b64_tr_b16 a[0:1], v42 offset:32768
    ds_read_b64_tr_b16 a[2:3], v42 offset:33792
    v_mfma_f32_16x16x32_bf16 v[228:231], a[36:39], a[180:183], v[228:231]
    buffer_load_dwordx4 v38, s[12:15], s61 offen offset:0 lds
    v_mfma_f32_16x16x32_bf16 v[228:231], a[32:35], a[164:167], v[228:231]
    ds_read_b64_tr_b16 a[4:5], v42 offset:40960
    v_mfma_f32_16x16x32_bf16 a[96:99], a[32:35], a[168:171], a[96:99]
    buffer_load_dwordx4 v39, s[12:15], s61 offen offset:1024 lds
    ds_read_b64_tr_b16 a[6:7], v42 offset:41984
    v_mfma_f32_16x16x32_bf16 a[96:99], a[36:39], a[184:187], a[96:99]
    ds_read_b64_tr_b16 a[8:9], v43 offset:32768
    v_mfma_f32_16x16x32_bf16 a[100:103], a[36:39], a[188:191], a[100:103]
    v_mfma_f32_16x16x32_bf16 a[100:103], a[32:35], a[172:175], a[100:103]
    buffer_load_dwordx4 v40, s[12:15], s61 offen offset:2048 lds
    ds_read_b64_tr_b16 a[10:11], v43 offset:33792
    v_mfma_f32_16x16x32_bf16 a[108:111], a[40:43], a[172:175], a[108:111]
    ds_read_b64_tr_b16 a[12:13], v43 offset:40960
    v_mfma_f32_16x16x32_bf16 a[108:111], a[44:47], a[188:191], a[108:111]
    ds_read_b64_tr_b16 a[14:15], v43 offset:41984
    v_mfma_f32_16x16x32_bf16 a[104:107], a[44:47], a[184:187], a[104:107]
    buffer_load_dwordx4 v41, s[12:15], s61 offen offset:3072 lds
    ds_read_b64_tr_b16 a[16:17], v44 offset:32768
    v_mfma_f32_16x16x32_bf16 a[104:107], a[40:43], a[168:171], a[104:107]
    v_mfma_f32_16x16x32_bf16 v[236:239], a[40:43], a[164:167], v[236:239]
    s_add_u32 s61, s61, 0x80000
    ds_read_b64_tr_b16 a[18:19], v44 offset:33792
    v_mfma_f32_16x16x32_bf16 v[236:239], a[44:47], a[180:183], v[236:239]
    buffer_load_dwordx4 a[240:243], v36, s[8:11], s62 offen sc1
    ds_read_b64_tr_b16 a[20:21], v44 offset:40960
    v_mfma_f32_16x16x32_bf16 v[232:235], a[44:47], a[176:179], v[232:235]
    ds_read_b64_tr_b16 a[22:23], v44 offset:41984
    v_mfma_f32_16x16x32_bf16 v[232:235], a[40:43], a[160:163], v[232:235]
    buffer_load_dwordx4 a[244:247], v54, s[8:11], s62 offen sc1
    v_mfma_f32_16x16x32_bf16 v[240:243], a[48:51], a[160:163], v[240:243]
    ds_read_b64_tr_b16 a[24:25], v45 offset:32768
    v_mfma_f32_16x16x32_bf16 v[240:243], a[52:55], a[176:179], v[240:243]
    ds_read_b64_tr_b16 a[26:27], v45 offset:33792
    v_mfma_f32_16x16x32_bf16 v[244:247], a[52:55], a[180:183], v[244:247]
    buffer_load_dwordx4 a[248:251], v37, s[8:11], s62 offen sc1
    ds_read_b64_tr_b16 a[28:29], v45 offset:40960
    v_mfma_f32_16x16x32_bf16 v[244:247], a[48:51], a[164:167], v[244:247]
    v_mfma_f32_16x16x32_bf16 a[112:115], a[48:51], a[168:171], a[112:115]
    ds_read_b64_tr_b16 a[30:31], v45 offset:41984
    v_mfma_f32_16x16x32_bf16 a[112:115], a[52:55], a[184:187], a[112:115]
    buffer_load_dwordx4 a[252:255], v55, s[8:11], s62 offen sc1
    v_mfma_f32_16x16x32_bf16 a[116:119], a[52:55], a[188:191], a[116:119]
    v_mfma_f32_16x16x32_bf16 a[116:119], a[48:51], a[172:175], a[116:119]
    s_add_u32 s62, s62, 0x20000
    v_mfma_f32_16x16x32_bf16 a[124:127], a[56:59], a[172:175], a[124:127]
    s_add_u32 s52, s47, 524288
    v_mfma_f32_16x16x32_bf16 a[124:127], a[60:63], a[188:191], a[124:127]
    buffer_store_dwordx4 v[136:139], v1, s[48:51], s52 offen offset:2048 sc1
    v_mfma_f32_16x16x32_bf16 a[120:123], a[60:63], a[184:187], a[120:123]
    v_mfma_f32_16x16x32_bf16 a[120:123], a[56:59], a[168:171], a[120:123]
    v_mfma_f32_16x16x32_bf16 v[252:255], a[56:59], a[164:167], v[252:255]
    s_cmp_eq_u32 s45, 0
    s_cbranch_scc1 k12_ool_60
k12_oolret_61:
    v_mfma_f32_16x16x32_bf16 v[252:255], a[60:63], a[180:183], v[252:255]
    v_mfma_f32_16x16x32_bf16 v[248:251], a[60:63], a[176:179], v[248:251]
    v_mfma_f32_16x16x32_bf16 v[248:251], a[56:59], a[160:163], v[248:251]
    s_waitcnt vmcnt(15) lgkmcnt(0)
    v_mfma_f32_16x16x32_bf16 v[192:195], a[0:3], a[192:195], v[192:195]
    v_mfma_f32_16x16x32_bf16 v[192:195], a[4:7], a[208:211], v[192:195]
    buffer_load_dwordx4 a[128:131], v36, s[8:11], s62 offen sc1
    ds_read_b64_tr_b16 a[32:33], v46 offset:32768
    v_mfma_f32_16x16x32_bf16 v[196:199], a[4:7], a[212:215], v[196:199]
    ds_read_b64_tr_b16 a[34:35], v46 offset:33792
    v_mfma_f32_16x16x32_bf16 v[196:199], a[0:3], a[196:199], v[196:199]
    ds_read_b64_tr_b16 a[36:37], v46 offset:40960
    v_mfma_f32_16x16x32_bf16 a[64:67], a[0:3], a[200:203], a[64:67]
    ds_read_b64_tr_b16 a[38:39], v46 offset:41984
    v_mfma_f32_16x16x32_bf16 a[64:67], a[4:7], a[216:219], a[64:67]
    ds_read_b64_tr_b16 a[40:41], v47 offset:32768
    v_mfma_f32_16x16x32_bf16 a[68:71], a[4:7], a[220:223], a[68:71]
    buffer_load_dwordx4 a[132:135], v54, s[8:11], s62 offen sc1
    v_mfma_f32_16x16x32_bf16 a[68:71], a[0:3], a[204:207], a[68:71]
    ds_read_b64_tr_b16 a[42:43], v47 offset:33792
    v_mfma_f32_16x16x32_bf16 a[76:79], a[8:11], a[204:207], a[76:79]
    ds_read_b64_tr_b16 a[44:45], v47 offset:40960
    v_mfma_f32_16x16x32_bf16 a[76:79], a[12:15], a[220:223], a[76:79]
    ds_read_b64_tr_b16 a[46:47], v47 offset:41984
    v_mfma_f32_16x16x32_bf16 a[72:75], a[12:15], a[216:219], a[72:75]
    ds_read_b64_tr_b16 a[48:49], v48 offset:32768
    v_mfma_f32_16x16x32_bf16 a[72:75], a[8:11], a[200:203], a[72:75]
    buffer_load_dwordx4 a[136:139], v37, s[8:11], s62 offen sc1
    v_mfma_f32_16x16x32_bf16 v[204:207], a[8:11], a[196:199], v[204:207]
    ds_read_b64_tr_b16 a[50:51], v48 offset:33792
    v_mfma_f32_16x16x32_bf16 v[204:207], a[12:15], a[212:215], v[204:207]
    ds_read_b64_tr_b16 a[52:53], v48 offset:40960
    v_mfma_f32_16x16x32_bf16 v[200:203], a[12:15], a[208:211], v[200:203]
    ds_read_b64_tr_b16 a[54:55], v48 offset:41984
    v_mfma_f32_16x16x32_bf16 v[200:203], a[8:11], a[192:195], v[200:203]
    v_mfma_f32_16x16x32_bf16 v[208:211], a[16:19], a[192:195], v[208:211]
    ds_read_b64_tr_b16 a[56:57], v49 offset:32768
    v_mfma_f32_16x16x32_bf16 v[208:211], a[20:23], a[208:211], v[208:211]
    buffer_load_dwordx4 a[140:143], v55, s[8:11], s62 offen sc1
    ds_read_b64_tr_b16 a[58:59], v49 offset:33792
    v_mfma_f32_16x16x32_bf16 v[212:215], a[20:23], a[212:215], v[212:215]
    ds_read_b64_tr_b16 a[60:61], v49 offset:40960
    v_mfma_f32_16x16x32_bf16 v[212:215], a[16:19], a[196:199], v[212:215]
    v_mfma_f32_16x16x32_bf16 a[80:83], a[16:19], a[200:203], a[80:83]
    ds_read_b64_tr_b16 a[62:63], v49 offset:41984
    v_mfma_f32_16x16x32_bf16 a[80:83], a[20:23], a[216:219], a[80:83]
    s_add_u32 s62, s62, 0x20000
    v_mfma_f32_16x16x32_bf16 a[84:87], a[20:23], a[220:223], a[84:87]
    s_add_u32 s52, s47, 524288
    v_mfma_f32_16x16x32_bf16 a[84:87], a[16:19], a[204:207], a[84:87]
    buffer_store_dwordx4 v[140:143], v1, s[48:51], s52 offen offset:3072 sc1
    v_mfma_f32_16x16x32_bf16 a[92:95], a[24:27], a[204:207], a[92:95]
    v_mfma_f32_16x16x32_bf16 a[92:95], a[28:31], a[220:223], a[92:95]
    v_mfma_f32_16x16x32_bf16 a[88:91], a[28:31], a[216:219], a[88:91]
    v_mfma_f32_16x16x32_bf16 a[88:91], a[24:27], a[200:203], a[88:91]
    v_mfma_f32_16x16x32_bf16 v[220:223], a[24:27], a[196:199], v[220:223]
    v_mfma_f32_16x16x32_bf16 v[220:223], a[28:31], a[212:215], v[220:223]
    v_mfma_f32_16x16x32_bf16 v[216:219], a[28:31], a[208:211], v[216:219]
    v_mfma_f32_16x16x32_bf16 v[216:219], a[24:27], a[192:195], v[216:219]
    s_waitcnt vmcnt(10) lgkmcnt(0)
    s_barrier
    v_mfma_f32_16x16x32_bf16 v[224:227], a[32:35], a[192:195], v[224:227]
    v_mfma_f32_16x16x32_bf16 v[224:227], a[36:39], a[208:211], v[224:227]
    s_add_u32 m0, s60, 98304
    ds_read_b64_tr_b16 a[0:1], v42 offset:49152
    ds_read_b64_tr_b16 a[2:3], v42 offset:50176
    v_mfma_f32_16x16x32_bf16 v[228:231], a[36:39], a[212:215], v[228:231]
    buffer_load_dwordx4 v38, s[12:15], s61 offen offset:0 lds
    v_mfma_f32_16x16x32_bf16 v[228:231], a[32:35], a[196:199], v[228:231]
    ds_read_b64_tr_b16 a[4:5], v42 offset:57344
    v_mfma_f32_16x16x32_bf16 a[96:99], a[32:35], a[200:203], a[96:99]
    buffer_load_dwordx4 v39, s[12:15], s61 offen offset:1024 lds
    ds_read_b64_tr_b16 a[6:7], v42 offset:58368
    v_mfma_f32_16x16x32_bf16 a[96:99], a[36:39], a[216:219], a[96:99]
    ds_read_b64_tr_b16 a[8:9], v43 offset:49152
    v_mfma_f32_16x16x32_bf16 a[100:103], a[36:39], a[220:223], a[100:103]
    v_mfma_f32_16x16x32_bf16 a[100:103], a[32:35], a[204:207], a[100:103]
    buffer_load_dwordx4 v40, s[12:15], s61 offen offset:2048 lds
    ds_read_b64_tr_b16 a[10:11], v43 offset:50176
    v_mfma_f32_16x16x32_bf16 a[108:111], a[40:43], a[204:207], a[108:111]
    ds_read_b64_tr_b16 a[12:13], v43 offset:57344
    v_mfma_f32_16x16x32_bf16 a[108:111], a[44:47], a[220:223], a[108:111]
    ds_read_b64_tr_b16 a[14:15], v43 offset:58368
    v_mfma_f32_16x16x32_bf16 a[104:107], a[44:47], a[216:219], a[104:107]
    ds_read_b64_tr_b16 a[16:17], v44 offset:49152
    v_mfma_f32_16x16x32_bf16 a[104:107], a[40:43], a[200:203], a[104:107]
    buffer_load_dwordx4 v41, s[12:15], s61 offen offset:3072 lds
    v_mfma_f32_16x16x32_bf16 v[236:239], a[40:43], a[196:199], v[236:239]
    ds_read_b64_tr_b16 a[18:19], v44 offset:50176
    v_mfma_f32_16x16x32_bf16 v[236:239], a[44:47], a[212:215], v[236:239]
    s_add_u32 s61, s61, 0x80000
    ds_read_b64_tr_b16 a[20:21], v44 offset:57344
    v_mfma_f32_16x16x32_bf16 v[232:235], a[44:47], a[208:211], v[232:235]
    buffer_load_dwordx4 a[144:147], v36, s[8:11], s62 offen sc1
    ds_read_b64_tr_b16 a[22:23], v44 offset:58368
    v_mfma_f32_16x16x32_bf16 v[232:235], a[40:43], a[192:195], v[232:235]
    v_mfma_f32_16x16x32_bf16 v[240:243], a[48:51], a[192:195], v[240:243]
    ds_read_b64_tr_b16 a[24:25], v45 offset:49152
    v_mfma_f32_16x16x32_bf16 v[240:243], a[52:55], a[208:211], v[240:243]
    buffer_load_dwordx4 a[148:151], v54, s[8:11], s62 offen sc1
    ds_read_b64_tr_b16 a[26:27], v45 offset:50176
    v_mfma_f32_16x16x32_bf16 v[244:247], a[52:55], a[212:215], v[244:247]
    ds_read_b64_tr_b16 a[28:29], v45 offset:57344
    v_mfma_f32_16x16x32_bf16 v[244:247], a[48:51], a[196:199], v[244:247]
    v_mfma_f32_16x16x32_bf16 a[112:115], a[48:51], a[200:203], a[112:115]
    buffer_load_dwordx4 a[152:155], v37, s[8:11], s62 offen sc1
    ds_read_b64_tr_b16 a[30:31], v45 offset:58368
    v_mfma_f32_16x16x32_bf16 a[112:115], a[52:55], a[216:219], a[112:115]
    v_mfma_f32_16x16x32_bf16 a[116:119], a[52:55], a[220:223], a[116:119]
    v_mfma_f32_16x16x32_bf16 a[116:119], a[48:51], a[204:207], a[116:119]
    v_mfma_f32_16x16x32_bf16 a[124:127], a[56:59], a[204:207], a[124:127]
    buffer_load_dwordx4 a[156:159], v55, s[8:11], s62 offen sc1
    v_mfma_f32_16x16x32_bf16 a[124:127], a[60:63], a[220:223], a[124:127]
    v_mfma_f32_16x16x32_bf16 a[120:123], a[60:63], a[216:219], a[120:123]
    s_add_u32 s62, s62, 0x20000
    v_mfma_f32_16x16x32_bf16 a[120:123], a[56:59], a[200:203], a[120:123]
    v_mfma_f32_16x16x32_bf16 v[252:255], a[56:59], a[196:199], v[252:255]
    s_cmp_eq_u32 s45, 0
    s_cbranch_scc1 k12_ool_62
k12_oolret_63:
    v_mfma_f32_16x16x32_bf16 v[252:255], a[60:63], a[212:215], v[252:255]
    v_mfma_f32_16x16x32_bf16 v[248:251], a[60:63], a[208:211], v[248:251]
    v_mfma_f32_16x16x32_bf16 v[248:251], a[56:59], a[192:195], v[248:251]
    s_waitcnt vmcnt(14) lgkmcnt(0)
    v_mfma_f32_16x16x32_bf16 v[192:195], a[0:3], a[224:227], v[192:195]
    v_mfma_f32_16x16x32_bf16 v[192:195], a[4:7], a[240:243], v[192:195]
    buffer_load_dwordx4 a[160:163], v36, s[8:11], s62 offen sc1
    ds_read_b64_tr_b16 a[32:33], v46 offset:49152
    v_mfma_f32_16x16x32_bf16 v[196:199], a[4:7], a[244:247], v[196:199]
    ds_read_b64_tr_b16 a[34:35], v46 offset:50176
    v_mfma_f32_16x16x32_bf16 v[196:199], a[0:3], a[228:231], v[196:199]
    ds_read_b64_tr_b16 a[36:37], v46 offset:57344
    v_mfma_f32_16x16x32_bf16 a[64:67], a[0:3], a[232:235], a[64:67]
    ds_read_b64_tr_b16 a[38:39], v46 offset:58368
    v_mfma_f32_16x16x32_bf16 a[64:67], a[4:7], a[248:251], a[64:67]
    ds_read_b64_tr_b16 a[40:41], v47 offset:49152
    v_mfma_f32_16x16x32_bf16 a[68:71], a[4:7], a[252:255], a[68:71]
    buffer_load_dwordx4 a[164:167], v54, s[8:11], s62 offen sc1
    v_mfma_f32_16x16x32_bf16 a[68:71], a[0:3], a[236:239], a[68:71]
    ds_read_b64_tr_b16 a[42:43], v47 offset:50176
    v_mfma_f32_16x16x32_bf16 a[76:79], a[8:11], a[236:239], a[76:79]
    ds_read_b64_tr_b16 a[44:45], v47 offset:57344
    v_mfma_f32_16x16x32_bf16 a[76:79], a[12:15], a[252:255], a[76:79]
    ds_read_b64_tr_b16 a[46:47], v47 offset:58368
    v_mfma_f32_16x16x32_bf16 a[72:75], a[12:15], a[248:251], a[72:75]
    ds_read_b64_tr_b16 a[48:49], v48 offset:49152
    v_mfma_f32_16x16x32_bf16 a[72:75], a[8:11], a[232:235], a[72:75]
    buffer_load_dwordx4 a[168:171], v37, s[8:11], s62 offen sc1
    v_mfma_f32_16x16x32_bf16 v[204:207], a[8:11], a[228:231], v[204:207]
    ds_read_b64_tr_b16 a[50:51], v48 offset:50176
    v_mfma_f32_16x16x32_bf16 v[204:207], a[12:15], a[244:247], v[204:207]
    ds_read_b64_tr_b16 a[52:53], v48 offset:57344
    v_mfma_f32_16x16x32_bf16 v[200:203], a[12:15], a[240:243], v[200:203]
    ds_read_b64_tr_b16 a[54:55], v48 offset:58368
    v_mfma_f32_16x16x32_bf16 v[200:203], a[8:11], a[224:227], v[200:203]
    v_mfma_f32_16x16x32_bf16 v[208:211], a[16:19], a[224:227], v[208:211]
    ds_read_b64_tr_b16 a[56:57], v49 offset:49152
    v_mfma_f32_16x16x32_bf16 v[208:211], a[20:23], a[240:243], v[208:211]
    buffer_load_dwordx4 a[172:175], v55, s[8:11], s62 offen sc1
    ds_read_b64_tr_b16 a[58:59], v49 offset:50176
    v_mfma_f32_16x16x32_bf16 v[212:215], a[20:23], a[244:247], v[212:215]
    ds_read_b64_tr_b16 a[60:61], v49 offset:57344
    v_mfma_f32_16x16x32_bf16 v[212:215], a[16:19], a[228:231], v[212:215]
    v_mfma_f32_16x16x32_bf16 a[80:83], a[16:19], a[232:235], a[80:83]
    ds_read_b64_tr_b16 a[62:63], v49 offset:58368
    v_mfma_f32_16x16x32_bf16 a[80:83], a[20:23], a[248:251], a[80:83]
    s_add_u32 s62, s62, 0x20000
    v_mfma_f32_16x16x32_bf16 a[84:87], a[20:23], a[252:255], a[84:87]
    s_add_u32 s52, s47, 528384
    v_mfma_f32_16x16x32_bf16 a[84:87], a[16:19], a[236:239], a[84:87]
    buffer_store_dwordx4 v[144:147], v1, s[48:51], s52 offen offset:0 sc1
    v_mfma_f32_16x16x32_bf16 a[92:95], a[24:27], a[236:239], a[92:95]
    v_mfma_f32_16x16x32_bf16 a[92:95], a[28:31], a[252:255], a[92:95]
    v_mfma_f32_16x16x32_bf16 a[88:91], a[28:31], a[248:251], a[88:91]
    v_mfma_f32_16x16x32_bf16 a[88:91], a[24:27], a[232:235], a[88:91]
    v_mfma_f32_16x16x32_bf16 v[220:223], a[24:27], a[228:231], v[220:223]
    v_mfma_f32_16x16x32_bf16 v[220:223], a[28:31], a[244:247], v[220:223]
    v_mfma_f32_16x16x32_bf16 v[216:219], a[28:31], a[240:243], v[216:219]
    v_mfma_f32_16x16x32_bf16 v[216:219], a[24:27], a[224:227], v[216:219]
    s_waitcnt vmcnt(9) lgkmcnt(0)
    s_barrier
    v_mfma_f32_16x16x32_bf16 v[224:227], a[32:35], a[224:227], v[224:227]
    v_mfma_f32_16x16x32_bf16 v[224:227], a[36:39], a[240:243], v[224:227]
    s_add_u32 m0, s60, 114688
    ds_read_b64_tr_b16 a[0:1], v42 offset:0
    ds_read_b64_tr_b16 a[2:3], v42 offset:1024
    v_mfma_f32_16x16x32_bf16 v[228:231], a[36:39], a[244:247], v[228:231]
    buffer_load_dwordx4 v38, s[12:15], s61 offen offset:0 lds
    v_mfma_f32_16x16x32_bf16 v[228:231], a[32:35], a[228:231], v[228:231]
    ds_read_b64_tr_b16 a[4:5], v42 offset:8192
    v_mfma_f32_16x16x32_bf16 a[96:99], a[32:35], a[232:235], a[96:99]
    buffer_load_dwordx4 v39, s[12:15], s61 offen offset:1024 lds
    ds_read_b64_tr_b16 a[6:7], v42 offset:9216
    v_mfma_f32_16x16x32_bf16 a[96:99], a[36:39], a[248:251], a[96:99]
    ds_read_b64_tr_b16 a[8:9], v43 offset:0
    v_mfma_f32_16x16x32_bf16 a[100:103], a[36:39], a[252:255], a[100:103]
    v_mfma_f32_16x16x32_bf16 a[100:103], a[32:35], a[236:239], a[100:103]
    buffer_load_dwordx4 v40, s[12:15], s61 offen offset:2048 lds
    ds_read_b64_tr_b16 a[10:11], v43 offset:1024
    v_mfma_f32_16x16x32_bf16 a[108:111], a[40:43], a[236:239], a[108:111]
    ds_read_b64_tr_b16 a[12:13], v43 offset:8192
    v_mfma_f32_16x16x32_bf16 a[108:111], a[44:47], a[252:255], a[108:111]
    ds_read_b64_tr_b16 a[14:15], v43 offset:9216
    v_mfma_f32_16x16x32_bf16 a[104:107], a[44:47], a[248:251], a[104:107]
    buffer_load_dwordx4 v41, s[12:15], s61 offen offset:3072 lds
    ds_read_b64_tr_b16 a[16:17], v44 offset:0
    v_mfma_f32_16x16x32_bf16 a[104:107], a[40:43], a[232:235], a[104:107]
    v_mfma_f32_16x16x32_bf16 v[236:239], a[40:43], a[228:231], v[236:239]
    s_add_u32 s61, s61, 0x80000
    ds_read_b64_tr_b16 a[18:19], v44 offset:1024
    v_mfma_f32_16x16x32_bf16 v[236:239], a[44:47], a[244:247], v[236:239]
    buffer_load_dwordx4 a[176:179], v36, s[8:11], s62 offen sc1
    ds_read_b64_tr_b16 a[20:21], v44 offset:8192
    v_mfma_f32_16x16x32_bf16 v[232:235], a[44:47], a[240:243], v[232:235]
    ds_read_b64_tr_b16 a[22:23], v44 offset:9216
    v_mfma_f32_16x16x32_bf16 v[232:235], a[40:43], a[224:227], v[232:235]
    buffer_load_dwordx4 a[180:183], v54, s[8:11], s62 offen sc1
    v_mfma_f32_16x16x32_bf16 v[240:243], a[48:51], a[224:227], v[240:243]
    ds_read_b64_tr_b16 a[24:25], v45 offset:0
    v_mfma_f32_16x16x32_bf16 v[240:243], a[52:55], a[240:243], v[240:243]
    ds_read_b64_tr_b16 a[26:27], v45 offset:1024
    v_mfma_f32_16x16x32_bf16 v[244:247], a[52:55], a[244:247], v[244:247]
    buffer_load_dwordx4 a[184:187], v37, s[8:11], s62 offen sc1
    ds_read_b64_tr_b16 a[28:29], v45 offset:8192
    v_mfma_f32_16x16x32_bf16 v[244:247], a[48:51], a[228:231], v[244:247]
    v_mfma_f32_16x16x32_bf16 a[112:115], a[48:51], a[232:235], a[112:115]
    ds_read_b64_tr_b16 a[30:31], v45 offset:9216
    v_mfma_f32_16x16x32_bf16 a[112:115], a[52:55], a[248:251], a[112:115]
    buffer_load_dwordx4 a[188:191], v55, s[8:11], s62 offen sc1
    v_mfma_f32_16x16x32_bf16 a[116:119], a[52:55], a[252:255], a[116:119]
    v_mfma_f32_16x16x32_bf16 a[116:119], a[48:51], a[236:239], a[116:119]
    s_add_u32 s62, s62, 0x20000
    v_mfma_f32_16x16x32_bf16 a[124:127], a[56:59], a[236:239], a[124:127]
    s_add_u32 s52, s47, 528384
    v_mfma_f32_16x16x32_bf16 a[124:127], a[60:63], a[252:255], a[124:127]
    buffer_store_dwordx4 v[148:151], v1, s[48:51], s52 offen offset:1024 sc1
    v_mfma_f32_16x16x32_bf16 a[120:123], a[60:63], a[248:251], a[120:123]
    v_mfma_f32_16x16x32_bf16 a[120:123], a[56:59], a[232:235], a[120:123]
    v_mfma_f32_16x16x32_bf16 v[252:255], a[56:59], a[228:231], v[252:255]
    s_cmp_eq_u32 s45, 0
    s_cbranch_scc1 k12_ool_64
k12_oolret_65:
    v_mfma_f32_16x16x32_bf16 v[252:255], a[60:63], a[244:247], v[252:255]
    v_mfma_f32_16x16x32_bf16 v[248:251], a[60:63], a[240:243], v[248:251]
    v_mfma_f32_16x16x32_bf16 v[248:251], a[56:59], a[224:227], v[248:251]
    s_waitcnt vmcnt(14) lgkmcnt(0)
    v_mfma_f32_16x16x32_bf16 v[192:195], a[0:3], a[128:131], v[192:195]
    v_mfma_f32_16x16x32_bf16 v[192:195], a[4:7], a[144:147], v[192:195]
    buffer_load_dwordx4 a[192:195], v36, s[8:11], s62 offen sc1
    ds_read_b64_tr_b16 a[32:33], v46 offset:0
    v_mfma_f32_16x16x32_bf16 v[196:199], a[4:7], a[148:151], v[196:199]
    ds_read_b64_tr_b16 a[34:35], v46 offset:1024
    v_mfma_f32_16x16x32_bf16 v[196:199], a[0:3], a[132:135], v[196:199]
    ds_read_b64_tr_b16 a[36:37], v46 offset:8192
    v_mfma_f32_16x16x32_bf16 a[64:67], a[0:3], a[136:139], a[64:67]
    ds_read_b64_tr_b16 a[38:39], v46 offset:9216
    v_mfma_f32_16x16x32_bf16 a[64:67], a[4:7], a[152:155], a[64:67]
    ds_read_b64_tr_b16 a[40:41], v47 offset:0
    v_mfma_f32_16x16x32_bf16 a[68:71], a[4:7], a[156:159], a[68:71]
    buffer_load_dwordx4 a[196:199], v54, s[8:11], s62 offen sc1
    v_mfma_f32_16x16x32_bf16 a[68:71], a[0:3], a[140:143], a[68:71]
    ds_read_b64_tr_b16 a[42:43], v47 offset:1024
    v_mfma_f32_16x16x32_bf16 a[76:79], a[8:11], a[140:143], a[76:79]
    ds_read_b64_tr_b16 a[44:45], v47 offset:8192
    v_mfma_f32_16x16x32_bf16 a[76:79], a[12:15], a[156:159], a[76:79]
    ds_read_b64_tr_b16 a[46:47], v47 offset:9216
    v_mfma_f32_16x16x32_bf16 a[72:75], a[12:15], a[152:155], a[72:75]
    ds_read_b64_tr_b16 a[48:49], v48 offset:0
    v_mfma_f32_16x16x32_bf16 a[72:75], a[8:11], a[136:139], a[72:75]
    buffer_load_dwordx4 a[200:203], v37, s[8:11], s62 offen sc1
    v_mfma_f32_16x16x32_bf16 v[204:207], a[8:11], a[132:135], v[204:207]
    ds_read_b64_tr_b16 a[50:51], v48 offset:1024
    v_mfma_f32_16x16x32_bf16 v[204:207], a[12:15], a[148:151], v[204:207]
    ds_read_b64_tr_b16 a[52:53], v48 offset:8192
    v_mfma_f32_16x16x32_bf16 v[200:203], a[12:15], a[144:147], v[200:203]
    ds_read_b64_tr_b16 a[54:55], v48 offset:9216
    v_mfma_f32_16x16x32_bf16 v[200:203], a[8:11], a[128:131], v[200:203]
    v_mfma_f32_16x16x32_bf16 v[208:211], a[16:19], a[128:131], v[208:211]
    ds_read_b64_tr_b16 a[56:57], v49 offset:0
    v_mfma_f32_16x16x32_bf16 v[208:211], a[20:23], a[144:147], v[208:211]
    buffer_load_dwordx4 a[204:207], v55, s[8:11], s62 offen sc1
    ds_read_b64_tr_b16 a[58:59], v49 offset:1024
    v_mfma_f32_16x16x32_bf16 v[212:215], a[20:23], a[148:151], v[212:215]
    ds_read_b64_tr_b16 a[60:61], v49 offset:8192
    v_mfma_f32_16x16x32_bf16 v[212:215], a[16:19], a[132:135], v[212:215]
    v_mfma_f32_16x16x32_bf16 a[80:83], a[16:19], a[136:139], a[80:83]
    ds_read_b64_tr_b16 a[62:63], v49 offset:9216
    v_mfma_f32_16x16x32_bf16 a[80:83], a[20:23], a[152:155], a[80:83]
    s_add_u32 s62, s62, 0x20000
    v_mfma_f32_16x16x32_bf16 a[84:87], a[20:23], a[156:159], a[84:87]
    s_add_u32 s52, s47, 528384
    v_mfma_f32_16x16x32_bf16 a[84:87], a[16:19], a[140:143], a[84:87]
    buffer_store_dwordx4 v[152:155], v1, s[48:51], s52 offen offset:2048 sc1
    v_mfma_f32_16x16x32_bf16 a[92:95], a[24:27], a[140:143], a[92:95]
    v_mfma_f32_16x16x32_bf16 a[92:95], a[28:31], a[156:159], a[92:95]
    v_mfma_f32_16x16x32_bf16 a[88:91], a[28:31], a[152:155], a[88:91]
    v_mfma_f32_16x16x32_bf16 a[88:91], a[24:27], a[136:139], a[88:91]
    v_mfma_f32_16x16x32_bf16 v[220:223], a[24:27], a[132:135], v[220:223]
    v_mfma_f32_16x16x32_bf16 v[220:223], a[28:31], a[148:151], v[220:223]
    v_mfma_f32_16x16x32_bf16 v[216:219], a[28:31], a[144:147], v[216:219]
    v_mfma_f32_16x16x32_bf16 v[216:219], a[24:27], a[128:131], v[216:219]
    s_waitcnt vmcnt(10) lgkmcnt(0)
    s_barrier
    v_mfma_f32_16x16x32_bf16 v[224:227], a[32:35], a[128:131], v[224:227]
    v_mfma_f32_16x16x32_bf16 v[224:227], a[36:39], a[144:147], v[224:227]
    s_add_u32 m0, s60, 131072
    ds_read_b64_tr_b16 a[0:1], v42 offset:16384
    ds_read_b64_tr_b16 a[2:3], v42 offset:17408
    v_mfma_f32_16x16x32_bf16 v[228:231], a[36:39], a[148:151], v[228:231]
    buffer_load_dwordx4 v38, s[12:15], s61 offen offset:0 lds
    v_mfma_f32_16x16x32_bf16 v[228:231], a[32:35], a[132:135], v[228:231]
    ds_read_b64_tr_b16 a[4:5], v42 offset:24576
    v_mfma_f32_16x16x32_bf16 a[96:99], a[32:35], a[136:139], a[96:99]
    buffer_load_dwordx4 v39, s[12:15], s61 offen offset:1024 lds
    ds_read_b64_tr_b16 a[6:7], v42 offset:25600
    v_mfma_f32_16x16x32_bf16 a[96:99], a[36:39], a[152:155], a[96:99]
    ds_read_b64_tr_b16 a[8:9], v43 offset:16384
    v_mfma_f32_16x16x32_bf16 a[100:103], a[36:39], a[156:159], a[100:103]
    v_mfma_f32_16x16x32_bf16 a[100:103], a[32:35], a[140:143], a[100:103]
    buffer_load_dwordx4 v40, s[12:15], s61 offen offset:2048 lds
    ds_read_b64_tr_b16 a[10:11], v43 offset:17408
    v_mfma_f32_16x16x32_bf16 a[108:111], a[40:43], a[140:143], a[108:111]
    ds_read_b64_tr_b16 a[12:13], v43 offset:24576
    v_mfma_f32_16x16x32_bf16 a[108:111], a[44:47], a[156:159], a[108:111]
    ds_read_b64_tr_b16 a[14:15], v43 offset:25600
    v_mfma_f32_16x16x32_bf16 a[104:107], a[44:47], a[152:155], a[104:107]
    buffer_load_dwordx4 v41, s[12:15], s61 offen offset:3072 lds
    ds_read_b64_tr_b16 a[16:17], v44 offset:16384
    v_mfma_f32_16x16x32_bf16 a[104:107], a[40:43], a[136:139], a[104:107]
    v_mfma_f32_16x16x32_bf16 v[236:239], a[40:43], a[132:135], v[236:239]
    s_add_u32 s61, s61, 0x80000
    ds_read_b64_tr_b16 a[18:19], v44 offset:17408
    v_mfma_f32_16x16x32_bf16 v[236:239], a[44:47], a[148:151], v[236:239]
    buffer_load_dwordx4 a[208:211], v36, s[8:11], s62 offen sc1
    ds_read_b64_tr_b16 a[20:21], v44 offset:24576
    v_mfma_f32_16x16x32_bf16 v[232:235], a[44:47], a[144:147], v[232:235]
    ds_read_b64_tr_b16 a[22:23], v44 offset:25600
    v_mfma_f32_16x16x32_bf16 v[232:235], a[40:43], a[128:131], v[232:235]
    buffer_load_dwordx4 a[212:215], v54, s[8:11], s62 offen sc1
    v_mfma_f32_16x16x32_bf16 v[240:243], a[48:51], a[128:131], v[240:243]
    ds_read_b64_tr_b16 a[24:25], v45 offset:16384
    v_mfma_f32_16x16x32_bf16 v[240:243], a[52:55], a[144:147], v[240:243]
    ds_read_b64_tr_b16 a[26:27], v45 offset:17408
    v_mfma_f32_16x16x32_bf16 v[244:247], a[52:55], a[148:151], v[244:247]
    buffer_load_dwordx4 a[216:219], v37, s[8:11], s62 offen sc1
    ds_read_b64_tr_b16 a[28:29], v45 offset:24576
    v_mfma_f32_16x16x32_bf16 v[244:247], a[48:51], a[132:135], v[244:247]
    v_mfma_f32_16x16x32_bf16 a[112:115], a[48:51], a[136:139], a[112:115]
    ds_read_b64_tr_b16 a[30:31], v45 offset:25600
    v_mfma_f32_16x16x32_bf16 a[112:115], a[52:55], a[152:155], a[112:115]
    buffer_load_dwordx4 a[220:223], v55, s[8:11], s62 offen sc1
    v_mfma_f32_16x16x32_bf16 a[116:119], a[52:55], a[156:159], a[116:119]
    v_mfma_f32_16x16x32_bf16 a[116:119], a[48:51], a[140:143], a[116:119]
    s_add_u32 s62, s62, 0x20000
    v_mfma_f32_16x16x32_bf16 a[124:127], a[56:59], a[140:143], a[124:127]
    s_add_u32 s52, s47, 528384
    v_mfma_f32_16x16x32_bf16 a[124:127], a[60:63], a[156:159], a[124:127]
    buffer_store_dwordx4 v[156:159], v1, s[48:51], s52 offen offset:3072 sc1
    v_mfma_f32_16x16x32_bf16 a[120:123], a[60:63], a[152:155], a[120:123]
    v_mfma_f32_16x16x32_bf16 a[120:123], a[56:59], a[136:139], a[120:123]
    v_mfma_f32_16x16x32_bf16 v[252:255], a[56:59], a[132:135], v[252:255]
    v_mfma_f32_16x16x32_bf16 v[252:255], a[60:63], a[148:151], v[252:255]
    v_mfma_f32_16x16x32_bf16 v[248:251], a[60:63], a[144:147], v[248:251]
    v_mfma_f32_16x16x32_bf16 v[248:251], a[56:59], a[128:131], v[248:251]
    s_waitcnt vmcnt(15) lgkmcnt(0)
    v_mfma_f32_16x16x32_bf16 v[192:195], a[0:3], a[160:163], v[192:195]
    v_mfma_f32_16x16x32_bf16 v[192:195], a[4:7], a[176:179], v[192:195]
    buffer_load_dwordx4 a[224:227], v36, s[8:11], s62 offen sc1
    ds_read_b64_tr_b16 a[32:33], v46 offset:16384
    v_mfma_f32_16x16x32_bf16 v[196:199], a[4:7], a[180:183], v[196:199]
    ds_read_b64_tr_b16 a[34:35], v46 offset:17408
    v_mfma_f32_16x16x32_bf16 v[196:199], a[0:3], a[164:167], v[196:199]
    ds_read_b64_tr_b16 a[36:37], v46 offset:24576
    v_mfma_f32_16x16x32_bf16 a[64:67], a[0:3], a[168:171], a[64:67]
    ds_read_b64_tr_b16 a[38:39], v46 offset:25600
    v_mfma_f32_16x16x32_bf16 a[64:67], a[4:7], a[184:187], a[64:67]
    ds_read_b64_tr_b16 a[40:41], v47 offset:16384
    v_mfma_f32_16x16x32_bf16 a[68:71], a[4:7], a[188:191], a[68:71]
    buffer_load_dwordx4 a[228:231], v54, s[8:11], s62 offen sc1
    v_mfma_f32_16x16x32_bf16 a[68:71], a[0:3], a[172:175], a[68:71]
    ds_read_b64_tr_b16 a[42:43], v47 offset:17408
    v_mfma_f32_16x16x32_bf16 a[76:79], a[8:11], a[172:175], a[76:79]
    ds_read_b64_tr_b16 a[44:45], v47 offset:24576
    v_mfma_f32_16x16x32_bf16 a[76:79], a[12:15], a[188:191], a[76:79]
    ds_read_b64_tr_b16 a[46:47], v47 offset:25600
    v_mfma_f32_16x16x32_bf16 a[72:75], a[12:15], a[184:187], a[72:75]
    ds_read_b64_tr_b16 a[48:49], v48 offset:16384
    v_mfma_f32_16x16x32_bf16 a[72:75], a[8:11], a[168:171], a[72:75]
    buffer_load_dwordx4 a[232:235], v37, s[8:11], s62 offen sc1
    v_mfma_f32_16x16x32_bf16 v[204:207], a[8:11], a[164:167], v[204:207]
    ds_read_b64_tr_b16 a[50:51], v48 offset:17408
    v_mfma_f32_16x16x32_bf16 v[204:207], a[12:15], a[180:183], v[204:207]
    ds_read_b64_tr_b16 a[52:53], v48 offset:24576
    v_mfma_f32_16x16x32_bf16 v[200:203], a[12:15], a[176:179], v[200:203]
    ds_read_b64_tr_b16 a[54:55], v48 offset:25600
    v_mfma_f32_16x16x32_bf16 v[200:203], a[8:11], a[160:163], v[200:203]
    v_mfma_f32_16x16x32_bf16 v[208:211], a[16:19], a[160:163], v[208:211]
    ds_read_b64_tr_b16 a[56:57], v49 offset:16384
    v_mfma_f32_16x16x32_bf16 v[208:211], a[20:23], a[176:179], v[208:211]
    buffer_load_dwordx4 a[236:239], v55, s[8:11], s62 offen sc1
    ds_read_b64_tr_b16 a[58:59], v49 offset:17408
    v_mfma_f32_16x16x32_bf16 v[212:215], a[20:23], a[180:183], v[212:215]
    ds_read_b64_tr_b16 a[60:61], v49 offset:24576
    v_mfma_f32_16x16x32_bf16 v[212:215], a[16:19], a[164:167], v[212:215]
    v_mfma_f32_16x16x32_bf16 a[80:83], a[16:19], a[168:171], a[80:83]
    ds_read_b64_tr_b16 a[62:63], v49 offset:25600
    v_mfma_f32_16x16x32_bf16 a[80:83], a[20:23], a[184:187], a[80:83]
    s_add_u32 s62, s62, 0x20000
    v_mfma_f32_16x16x32_bf16 a[84:87], a[20:23], a[188:191], a[84:87]
    s_add_u32 s52, s47, 532480
    v_mfma_f32_16x16x32_bf16 a[84:87], a[16:19], a[172:175], a[84:87]
    buffer_store_dwordx4 v[168:171], v1, s[48:51], s52 offen offset:2048 sc1
    v_mfma_f32_16x16x32_bf16 a[92:95], a[24:27], a[172:175], a[92:95]
    v_mfma_f32_16x16x32_bf16 a[92:95], a[28:31], a[188:191], a[92:95]
    v_mfma_f32_16x16x32_bf16 a[88:91], a[28:31], a[184:187], a[88:91]
    v_mfma_f32_16x16x32_bf16 a[88:91], a[24:27], a[168:171], a[88:91]
    v_mfma_f32_16x16x32_bf16 v[220:223], a[24:27], a[164:167], v[220:223]
    v_mfma_f32_16x16x32_bf16 v[220:223], a[28:31], a[180:183], v[220:223]
    v_mfma_f32_16x16x32_bf16 v[216:219], a[28:31], a[176:179], v[216:219]
    v_mfma_f32_16x16x32_bf16 v[216:219], a[24:27], a[160:163], v[216:219]
    s_waitcnt vmcnt(10) lgkmcnt(0)
    s_barrier
    v_mfma_f32_16x16x32_bf16 v[224:227], a[32:35], a[160:163], v[224:227]
    s_cmp_eq_u32 s56, 0
    s_cbranch_scc1 k12_ool_66
k12_oolret_67:
    v_mfma_f32_16x16x32_bf16 v[224:227], a[36:39], a[176:179], v[224:227]
    s_add_u32 m0, s60, 147456
    ds_read_b64_tr_b16 a[0:1], v42 offset:32768
    ds_read_b64_tr_b16 a[2:3], v42 offset:33792
    v_mfma_f32_16x16x32_bf16 v[228:231], a[36:39], a[180:183], v[228:231]
    buffer_load_dwordx4 v38, s[12:15], s61 offen offset:0 lds
    v_mfma_f32_16x16x32_bf16 v[228:231], a[32:35], a[164:167], v[228:231]
    ds_read_b64_tr_b16 a[4:5], v42 offset:40960
    v_mfma_f32_16x16x32_bf16 a[96:99], a[32:35], a[168:171], a[96:99]
    buffer_load_dwordx4 v39, s[12:15], s61 offen offset:1024 lds
    ds_read_b64_tr_b16 a[6:7], v42 offset:41984
    v_mfma_f32_16x16x32_bf16 a[96:99], a[36:39], a[184:187], a[96:99]
    ds_read_b64_tr_b16 a[8:9], v43 offset:32768
    v_mfma_f32_16x16x32_bf16 a[100:103], a[36:39], a[188:191], a[100:103]
    v_mfma_f32_16x16x32_bf16 a[100:103], a[32:35], a[172:175], a[100:103]
    buffer_load_dwordx4 v40, s[12:15], s61 offen offset:2048 lds
    ds_read_b64_tr_b16 a[10:11], v43 offset:33792
    v_mfma_f32_16x16x32_bf16 a[108:111], a[40:43], a[172:175], a[108:111]
    s_mov_b32 s32, s60
    ds_read_b64_tr_b16 a[12:13], v43 offset:40960
    v_mfma_f32_16x16x32_bf16 a[108:111], a[44:47], a[188:191], a[108:111]
    ds_read_b64_tr_b16 a[14:15], v43 offset:41984
    v_mfma_f32_16x16x32_bf16 a[104:107], a[44:47], a[184:187], a[104:107]
    s_mov_b32 s34, s60
    ds_read_b64_tr_b16 a[16:17], v44 offset:32768
    v_mfma_f32_16x16x32_bf16 a[104:107], a[40:43], a[168:171], a[104:107]
    buffer_load_dwordx4 v41, s[12:15], s61 offen offset:3072 lds
    v_mfma_f32_16x16x32_bf16 v[236:239], a[40:43], a[164:167], v[236:239]
    ds_read_b64_tr_b16 a[18:19], v44 offset:33792
    v_mfma_f32_16x16x32_bf16 v[236:239], a[44:47], a[180:183], v[236:239]
    s_mov_b32 s33, s60
    ds_read_b64_tr_b16 a[20:21], v44 offset:40960
    v_mfma_f32_16x16x32_bf16 v[232:235], a[44:47], a[176:179], v[232:235]
    s_add_u32 s61, s61, 0x80000
    buffer_load_dwordx4 a[240:243], v36, s[8:11], s62 offen sc1
    ds_read_b64_tr_b16 a[22:23], v44 offset:41984
    v_mfma_f32_16x16x32_bf16 v[232:235], a[40:43], a[160:163], v[232:235]
    v_mfma_f32_16x16x32_bf16 v[240:243], a[48:51], a[160:163], v[240:243]
    s_add_u32 s35, s60, 0x10000
    ds_read_b64_tr_b16 a[24:25], v45 offset:32768
    v_mfma_f32_16x16x32_bf16 v[240:243], a[52:55], a[176:179], v[240:243]
    buffer_load_dwordx4 a[244:247], v54, s[8:11], s62 offen sc1
    ds_read_b64_tr_b16 a[26:27], v45 offset:33792
    v_mfma_f32_16x16x32_bf16 v[244:247], a[52:55], a[180:183], v[244:247]
    ds_read_b64_tr_b16 a[28:29], v45 offset:40960
    v_mfma_f32_16x16x32_bf16 v[244:247], a[48:51], a[164:167], v[244:247]
    v_mfma_f32_16x16x32_bf16 a[112:115], a[48:51], a[168:171], a[112:115]
    buffer_load_dwordx4 a[248:251], v37, s[8:11], s62 offen sc1
    ds_read_b64_tr_b16 a[30:31], v45 offset:41984
    v_mfma_f32_16x16x32_bf16 a[112:115], a[52:55], a[184:187], a[112:115]
    v_mfma_f32_16x16x32_bf16 a[116:119], a[52:55], a[188:191], a[116:119]
    v_mfma_f32_16x16x32_bf16 a[116:119], a[48:51], a[172:175], a[116:119]
    v_mfma_f32_16x16x32_bf16 a[124:127], a[56:59], a[172:175], a[124:127]
    buffer_load_dwordx4 a[252:255], v55, s[8:11], s62 offen sc1
    v_mfma_f32_16x16x32_bf16 a[124:127], a[60:63], a[188:191], a[124:127]
    v_mfma_f32_16x16x32_bf16 a[120:123], a[60:63], a[184:187], a[120:123]
    s_add_u32 s62, s62, 0x20000
    v_mfma_f32_16x16x32_bf16 a[120:123], a[56:59], a[168:171], a[120:123]
    v_mfma_f32_16x16x32_bf16 v[252:255], a[56:59], a[164:167], v[252:255]
    v_mfma_f32_16x16x32_bf16 v[252:255], a[60:63], a[180:183], v[252:255]
    v_mfma_f32_16x16x32_bf16 v[248:251], a[60:63], a[176:179], v[248:251]
    v_mfma_f32_16x16x32_bf16 v[248:251], a[56:59], a[160:163], v[248:251]
    s_waitcnt vmcnt(14) lgkmcnt(0)
    v_mfma_f32_16x16x32_bf16 v[192:195], a[0:3], a[192:195], v[192:195]
    v_mfma_f32_16x16x32_bf16 v[192:195], a[4:7], a[208:211], v[192:195]
    buffer_load_dwordx4 a[128:131], v36, s[8:11], s62 offen sc1
    ds_read_b64_tr_b16 a[32:33], v46 offset:32768
    v_mfma_f32_16x16x32_bf16 v[196:199], a[4:7], a[212:215], v[196:199]
    ds_read_b64_tr_b16 a[34:35], v46 offset:33792
    v_mfma_f32_16x16x32_bf16 v[196:199], a[0:3], a[196:199], v[196:199]
    ds_read_b64_tr_b16 a[36:37], v46 offset:40960
    v_mfma_f32_16x16x32_bf16 a[64:67], a[0:3], a[200:203], a[64:67]
    ds_read_b64_tr_b16 a[38:39], v46 offset:41984
    v_mfma_f32_16x16x32_bf16 a[64:67], a[4:7], a[216:219], a[64:67]
    ds_read_b64_tr_b16 a[40:41], v47 offset:32768
    v_mfma_f32_16x16x32_bf16 a[68:71], a[4:7], a[220:223], a[68:71]
    buffer_load_dwordx4 a[132:135], v54, s[8:11], s62 offen sc1
    v_mfma_f32_16x16x32_bf16 a[68:71], a[0:3], a[204:207], a[68:71]
    ds_read_b64_tr_b16 a[42:43], v47 offset:33792
    v_mfma_f32_16x16x32_bf16 a[76:79], a[8:11], a[204:207], a[76:79]
    ds_read_b64_tr_b16 a[44:45], v47 offset:40960
    v_mfma_f32_16x16x32_bf16 a[76:79], a[12:15], a[220:223], a[76:79]
    ds_read_b64_tr_b16 a[46:47], v47 offset:41984
    v_mfma_f32_16x16x32_bf16 a[72:75], a[12:15], a[216:219], a[72:75]
    ds_read_b64_tr_b16 a[48:49], v48 offset:32768
    v_mfma_f32_16x16x32_bf16 a[72:75], a[8:11], a[200:203], a[72:75]
    buffer_load_dwordx4 a[136:139], v37, s[8:11], s62 offen sc1
    v_mfma_f32_16x16x32_bf16 v[204:207], a[8:11], a[196:199], v[204:207]
    ds_read_b64_tr_b16 a[50:51], v48 offset:33792
    v_mfma_f32_16x16x32_bf16 v[204:207], a[12:15], a[212:215], v[204:207]
    ds_read_b64_tr_b16 a[52:53], v48 offset:40960
    v_mfma_f32_16x16x32_bf16 v[200:203], a[12:15], a[208:211], v[200:203]
    ds_read_b64_tr_b16 a[54:55], v48 offset:41984
    v_mfma_f32_16x16x32_bf16 v[200:203], a[8:11], a[192:195], v[200:203]
    v_mfma_f32_16x16x32_bf16 v[208:211], a[16:19], a[192:195], v[208:211]
    ds_read_b64_tr_b16 a[56:57], v49 offset:32768
    v_mfma_f32_16x16x32_bf16 v[208:211], a[20:23], a[208:211], v[208:211]
    buffer_load_dwordx4 a[140:143], v55, s[8:11], s62 offen sc1
    ds_read_b64_tr_b16 a[58:59], v49 offset:33792
    v_mfma_f32_16x16x32_bf16 v[212:215], a[20:23], a[212:215], v[212:215]
    ds_read_b64_tr_b16 a[60:61], v49 offset:40960
    v_mfma_f32_16x16x32_bf16 v[212:215], a[16:19], a[196:199], v[212:215]
    v_mfma_f32_16x16x32_bf16 a[80:83], a[16:19], a[200:203], a[80:83]
    ds_read_b64_tr_b16 a[62:63], v49 offset:41984
    v_mfma_f32_16x16x32_bf16 a[80:83], a[20:23], a[216:219], a[80:83]
    s_add_u32 s62, s62, 0x20000
    v_mfma_f32_16x16x32_bf16 a[84:87], a[20:23], a[220:223], a[84:87]
    s_add_u32 s52, s47, 532480
    v_mfma_f32_16x16x32_bf16 a[84:87], a[16:19], a[204:207], a[84:87]
    buffer_store_dwordx4 v[172:175], v1, s[48:51], s52 offen offset:3072 sc1
    v_mfma_f32_16x16x32_bf16 a[92:95], a[24:27], a[204:207], a[92:95]
    v_mfma_f32_16x16x32_bf16 a[92:95], a[28:31], a[220:223], a[92:95]
    v_mfma_f32_16x16x32_bf16 a[88:91], a[28:31], a[216:219], a[88:91]
    v_mfma_f32_16x16x32_bf16 a[88:91], a[24:27], a[200:203], a[88:91]
    v_mfma_f32_16x16x32_bf16 v[220:223], a[24:27], a[196:199], v[220:223]
    v_add_co_u32 v2, vcc, 0x4000, v2
    s_nop 1
    v_addc_co_u32 v3, vcc, 0, v3, vcc
    global_load_dword v51, v[2:3], off
    v_mfma_f32_16x16x32_bf16 v[220:223], a[28:31], a[212:215], v[220:223]
    v_mfma_f32_16x16x32_bf16 v[216:219], a[28:31], a[208:211], v[216:219]
    v_mfma_f32_16x16x32_bf16 v[216:219], a[24:27], a[192:195], v[216:219]
    s_waitcnt vmcnt(9) lgkmcnt(0)
    s_barrier
    v_mfma_f32_16x16x32_bf16 v[224:227], a[32:35], a[192:195], v[224:227]
    v_mfma_f32_16x16x32_bf16 v[224:227], a[36:39], a[208:211], v[224:227]
    s_add_u32 m0, s60, 98304
    ds_read_b64_tr_b16 a[0:1], v42 offset:49152
    ds_read_b64_tr_b16 a[2:3], v42 offset:50176
    v_mfma_f32_16x16x32_bf16 v[228:231], a[36:39], a[212:215], v[228:231]
    buffer_load_dwordx4 v38, s[12:15], s61 offen offset:0 lds
    v_mfma_f32_16x16x32_bf16 v[228:231], a[32:35], a[196:199], v[228:231]
    ds_read_b64_tr_b16 a[4:5], v42 offset:57344
    v_mfma_f32_16x16x32_bf16 a[96:99], a[32:35], a[200:203], a[96:99]
    buffer_load_dwordx4 v39, s[12:15], s61 offen offset:1024 lds
    ds_read_b64_tr_b16 a[6:7], v42 offset:58368
    v_mfma_f32_16x16x32_bf16 a[96:99], a[36:39], a[216:219], a[96:99]
    ds_read_b64_tr_b16 a[8:9], v43 offset:49152
    v_mfma_f32_16x16x32_bf16 a[100:103], a[36:39], a[220:223], a[100:103]
    v_mfma_f32_16x16x32_bf16 a[100:103], a[32:35], a[204:207], a[100:103]
    buffer_load_dwordx4 v40, s[12:15], s61 offen offset:2048 lds
    ds_read_b64_tr_b16 a[10:11], v43 offset:50176
    v_mfma_f32_16x16x32_bf16 a[108:111], a[40:43], a[204:207], a[108:111]
    ds_read_b64_tr_b16 a[12:13], v43 offset:57344
    v_mfma_f32_16x16x32_bf16 a[108:111], a[44:47], a[220:223], a[108:111]
    ds_read_b64_tr_b16 a[14:15], v43 offset:58368
    v_mfma_f32_16x16x32_bf16 a[104:107], a[44:47], a[216:219], a[104:107]
    buffer_load_dwordx4 v41, s[12:15], s61 offen offset:3072 lds
    ds_read_b64_tr_b16 a[16:17], v44 offset:49152
    v_mfma_f32_16x16x32_bf16 a[104:107], a[40:43], a[200:203], a[104:107]
    v_mfma_f32_16x16x32_bf16 v[236:239], a[40:43], a[196:199], v[236:239]
    s_add_u32 s61, s61, 0x80000
    ds_read_b64_tr_b16 a[18:19], v44 offset:50176
    v_mfma_f32_16x16x32_bf16 v[236:239], a[44:47], a[212:215], v[236:239]
    buffer_load_dwordx4 a[144:147], v36, s[8:11], s62 offen sc1
    ds_read_b64_tr_b16 a[20:21], v44 offset:57344
    v_mfma_f32_16x16x32_bf16 v[232:235], a[44:47], a[208:211], v[232:235]
    ds_read_b64_tr_b16 a[22:23], v44 offset:58368
    v_mfma_f32_16x16x32_bf16 v[232:235], a[40:43], a[192:195], v[232:235]
    buffer_load_dwordx4 a[148:151], v54, s[8:11], s62 offen sc1
    v_mfma_f32_16x16x32_bf16 v[240:243], a[48:51], a[192:195], v[240:243]
    ds_read_b64_tr_b16 a[24:25], v45 offset:49152
    v_mfma_f32_16x16x32_bf16 v[240:243], a[52:55], a[208:211], v[240:243]
    ds_read_b64_tr_b16 a[26:27], v45 offset:50176
    v_mfma_f32_16x16x32_bf16 v[244:247], a[52:55], a[212:215], v[244:247]
    buffer_load_dwordx4 a[152:155], v37, s[8:11], s62 offen sc1
    ds_read_b64_tr_b16 a[28:29], v45 offset:57344
    v_mfma_f32_16x16x32_bf16 v[244:247], a[48:51], a[196:199], v[244:247]
    v_mfma_f32_16x16x32_bf16 a[112:115], a[48:51], a[200:203], a[112:115]
    ds_read_b64_tr_b16 a[30:31], v45 offset:58368
    v_mfma_f32_16x16x32_bf16 a[112:115], a[52:55], a[216:219], a[112:115]
    buffer_load_dwordx4 a[156:159], v55, s[8:11], s62 offen sc1
    v_mfma_f32_16x16x32_bf16 a[116:119], a[52:55], a[220:223], a[116:119]
    v_mfma_f32_16x16x32_bf16 a[116:119], a[48:51], a[204:207], a[116:119]
    s_add_u32 s62, s62, 0x20000
    v_mfma_f32_16x16x32_bf16 a[124:127], a[56:59], a[204:207], a[124:127]
    s_add_u32 s52, s47, 536576
    v_mfma_f32_16x16x32_bf16 a[124:127], a[60:63], a[220:223], a[124:127]
    buffer_store_dwordx4 v[176:179], v1, s[48:51], s52 offen offset:0 sc1
    v_mfma_f32_16x16x32_bf16 a[120:123], a[60:63], a[216:219], a[120:123]
    v_mfma_f32_16x16x32_bf16 a[120:123], a[56:59], a[200:203], a[120:123]
    v_mfma_f32_16x16x32_bf16 v[252:255], a[56:59], a[196:199], v[252:255]
    v_mfma_f32_16x16x32_bf16 v[252:255], a[60:63], a[212:215], v[252:255]
    v_mfma_f32_16x16x32_bf16 v[248:251], a[60:63], a[208:211], v[248:251]
    v_mfma_f32_16x16x32_bf16 v[248:251], a[56:59], a[192:195], v[248:251]
    s_waitcnt vmcnt(14) lgkmcnt(0)
    v_mfma_f32_16x16x32_bf16 v[192:195], a[0:3], a[224:227], v[192:195]
    v_mfma_f32_16x16x32_bf16 v[192:195], a[4:7], a[240:243], v[192:195]
    buffer_load_dwordx4 a[160:163], v36, s[8:11], s62 offen sc1
    ds_read_b64_tr_b16 a[32:33], v46 offset:49152
    v_mfma_f32_16x16x32_bf16 v[196:199], a[4:7], a[244:247], v[196:199]
    ds_read_b64_tr_b16 a[34:35], v46 offset:50176
    v_mfma_f32_16x16x32_bf16 v[196:199], a[0:3], a[228:231], v[196:199]
    ds_read_b64_tr_b16 a[36:37], v46 offset:57344
    v_mfma_f32_16x16x32_bf16 a[64:67], a[0:3], a[232:235], a[64:67]
    ds_read_b64_tr_b16 a[38:39], v46 offset:58368
    v_mfma_f32_16x16x32_bf16 a[64:67], a[4:7], a[248:251], a[64:67]
    ds_read_b64_tr_b16 a[40:41], v47 offset:49152
    v_mfma_f32_16x16x32_bf16 a[68:71], a[4:7], a[252:255], a[68:71]
    buffer_load_dwordx4 a[164:167], v54, s[8:11], s62 offen sc1
    v_mfma_f32_16x16x32_bf16 a[68:71], a[0:3], a[236:239], a[68:71]
    ds_read_b64_tr_b16 a[42:43], v47 offset:50176
    v_mfma_f32_16x16x32_bf16 a[76:79], a[8:11], a[236:239], a[76:79]
    ds_read_b64_tr_b16 a[44:45], v47 offset:57344
    v_mfma_f32_16x16x32_bf16 a[76:79], a[12:15], a[252:255], a[76:79]
    ds_read_b64_tr_b16 a[46:47], v47 offset:58368
    v_mfma_f32_16x16x32_bf16 a[72:75], a[12:15], a[248:251], a[72:75]
    ds_read_b64_tr_b16 a[48:49], v48 offset:49152
    v_mfma_f32_16x16x32_bf16 a[72:75], a[8:11], a[232:235], a[72:75]
    buffer_load_dwordx4 a[168:171], v37, s[8:11], s62 offen sc1
    v_mfma_f32_16x16x32_bf16 v[204:207], a[8:11], a[228:231], v[204:207]
    ds_read_b64_tr_b16 a[50:51], v48 offset:50176
    v_mfma_f32_16x16x32_bf16 v[204:207], a[12:15], a[244:247], v[204:207]
    ds_read_b64_tr_b16 a[52:53], v48 offset:57344
    v_mfma_f32_16x16x32_bf16 v[200:203], a[12:15], a[240:243], v[200:203]
    ds_read_b64_tr_b16 a[54:55], v48 offset:58368
    v_mfma_f32_16x16x32_bf16 v[200:203], a[8:11], a[224:227], v[200:203]
    v_mfma_f32_16x16x32_bf16 v[208:211], a[16:19], a[224:227], v[208:211]
    ds_read_b64_tr_b16 a[56:57], v49 offset:49152
    v_mfma_f32_16x16x32_bf16 v[208:211], a[20:23], a[240:243], v[208:211]
    buffer_load_dwordx4 a[172:175], v55, s[8:11], s62 offen sc1
    ds_read_b64_tr_b16 a[58:59], v49 offset:50176
    v_mfma_f32_16x16x32_bf16 v[212:215], a[20:23], a[244:247], v[212:215]
    ds_read_b64_tr_b16 a[60:61], v49 offset:57344
    v_mfma_f32_16x16x32_bf16 v[212:215], a[16:19], a[228:231], v[212:215]
    v_mfma_f32_16x16x32_bf16 a[80:83], a[16:19], a[232:235], a[80:83]
    ds_read_b64_tr_b16 a[62:63], v49 offset:58368
    v_mfma_f32_16x16x32_bf16 a[80:83], a[20:23], a[248:251], a[80:83]
    s_add_u32 s62, s62, 0x20000
    v_mfma_f32_16x16x32_bf16 a[84:87], a[20:23], a[252:255], a[84:87]
    s_add_u32 s52, s47, 536576
    v_mfma_f32_16x16x32_bf16 a[84:87], a[16:19], a[236:239], a[84:87]
    buffer_store_dwordx4 v[180:183], v1, s[48:51], s52 offen offset:1024 sc1
    v_mfma_f32_16x16x32_bf16 a[92:95], a[24:27], a[236:239], a[92:95]
    v_mfma_f32_16x16x32_bf16 a[92:95], a[28:31], a[252:255], a[92:95]
    v_mfma_f32_16x16x32_bf16 a[88:91], a[28:31], a[248:251], a[88:91]
    v_mfma_f32_16x16x32_bf16 a[88:91], a[24:27], a[232:235], a[88:91]
    v_mfma_f32_16x16x32_bf16 v[220:223], a[24:27], a[228:231], v[220:223]
    v_mfma_f32_16x16x32_bf16 v[220:223], a[28:31], a[244:247], v[220:223]
    v_mfma_f32_16x16x32_bf16 v[216:219], a[28:31], a[240:243], v[216:219]
    v_mfma_f32_16x16x32_bf16 v[216:219], a[24:27], a[224:227], v[216:219]
    s_waitcnt vmcnt(10) lgkmcnt(0)
    s_barrier
    v_mfma_f32_16x16x32_bf16 v[224:227], a[32:35], a[224:227], v[224:227]
    s_cmp_eq_u32 s30, 0
    s_cbranch_scc1 k12_ool_68
k12_oolret_69:
    v_mfma_f32_16x16x32_bf16 v[224:227], a[36:39], a[240:243], v[224:227]
    s_add_u32 m0, s60, 114688
    ds_read_b64_tr_b16 a[0:1], v42 offset:0
    ds_read_b64_tr_b16 a[2:3], v42 offset:1024
    v_mfma_f32_16x16x32_bf16 v[228:231], a[36:39], a[244:247], v[228:231]
    buffer_load_dwordx4 v38, s[12:15], s61 offen offset:0 lds
    v_mfma_f32_16x16x32_bf16 v[228:231], a[32:35], a[228:231], v[228:231]
    ds_read_b64_tr_b16 a[4:5], v42 offset:8192
    v_mfma_f32_16x16x32_bf16 a[96:99], a[32:35], a[232:235], a[96:99]
    buffer_load_dwordx4 v39, s[12:15], s61 offen offset:1024 lds
    ds_read_b64_tr_b16 a[6:7], v42 offset:9216
    v_mfma_f32_16x16x32_bf16 a[96:99], a[36:39], a[248:251], a[96:99]
    ds_read_b64_tr_b16 a[8:9], v43 offset:0
    v_mfma_f32_16x16x32_bf16 a[100:103], a[36:39], a[252:255], a[100:103]
    v_mfma_f32_16x16x32_bf16 a[100:103], a[32:35], a[236:239], a[100:103]
    buffer_load_dwordx4 v40, s[12:15], s61 offen offset:2048 lds
    ds_read_b64_tr_b16 a[10:11], v43 offset:1024
    v_mfma_f32_16x16x32_bf16 a[108:111], a[40:43], a[236:239], a[108:111]
    ds_read_b64_tr_b16 a[12:13], v43 offset:8192
    v_mfma_f32_16x16x32_bf16 a[108:111], a[44:47], a[252:255], a[108:111]
    ds_read_b64_tr_b16 a[14:15], v43 offset:9216
    v_mfma_f32_16x16x32_bf16 a[104:107], a[44:47], a[248:251], a[104:107]
    buffer_load_dwordx4 v41, s[12:15], s61 offen offset:3072 lds
    ds_read_b64_tr_b16 a[16:17], v44 offset:0
    v_mfma_f32_16x16x32_bf16 a[104:107], a[40:43], a[232:235], a[104:107]
    v_mfma_f32_16x16x32_bf16 v[236:239], a[40:43], a[228:231], v[236:239]
    s_add_u32 s61, s61, 0x80000
    ds_read_b64_tr_b16 a[18:19], v44 offset:1024
    v_mfma_f32_16x16x32_bf16 v[236:239], a[44:47], a[244:247], v[236:239]
    buffer_load_dwordx4 a[176:179], v36, s[8:11], s62 offen sc1
    ds_read_b64_tr_b16 a[20:21], v44 offset:8192
    v_mfma_f32_16x16x32_bf16 v[232:235], a[44:47], a[240:243], v[232:235]
    ds_read_b64_tr_b16 a[22:23], v44 offset:9216
    v_mfma_f32_16x16x32_bf16 v[232:235], a[40:43], a[224:227], v[232:235]
    buffer_load_dwordx4 a[180:183], v54, s[8:11], s62 offen sc1
    v_mfma_f32_16x16x32_bf16 v[240:243], a[48:51], a[224:227], v[240:243]
    ds_read_b64_tr_b16 a[24:25], v45 offset:0
    v_mfma_f32_16x16x32_bf16 v[240:243], a[52:55], a[240:243], v[240:243]
    ds_read_b64_tr_b16 a[26:27], v45 offset:1024
    v_mfma_f32_16x16x32_bf16 v[244:247], a[52:55], a[244:247], v[244:247]
    buffer_load_dwordx4 a[184:187], v37, s[8:11], s62 offen sc1
    ds_read_b64_tr_b16 a[28:29], v45 offset:8192
    v_mfma_f32_16x16x32_bf16 v[244:247], a[48:51], a[228:231], v[244:247]
    v_mfma_f32_16x16x32_bf16 a[112:115], a[48:51], a[232:235], a[112:115]
    ds_read_b64_tr_b16 a[30:31], v45 offset:9216
    v_mfma_f32_16x16x32_bf16 a[112:115], a[52:55], a[248:251], a[112:115]
    buffer_load_dwordx4 a[188:191], v55, s[8:11], s62 offen sc1
    v_mfma_f32_16x16x32_bf16 a[116:119], a[52:55], a[252:255], a[116:119]
    v_mfma_f32_16x16x32_bf16 a[116:119], a[48:51], a[236:239], a[116:119]
    s_add_u32 s62, s62, 0x20000
    v_mfma_f32_16x16x32_bf16 a[124:127], a[56:59], a[236:239], a[124:127]
    s_add_u32 s52, s47, 536576
    v_mfma_f32_16x16x32_bf16 a[124:127], a[60:63], a[252:255], a[124:127]
    buffer_store_dwordx4 v[184:187], v1, s[48:51], s52 offen offset:2048 sc1
    v_mfma_f32_16x16x32_bf16 a[120:123], a[60:63], a[248:251], a[120:123]
    v_mfma_f32_16x16x32_bf16 a[120:123], a[56:59], a[232:235], a[120:123]
    v_mfma_f32_16x16x32_bf16 v[252:255], a[56:59], a[228:231], v[252:255]
    v_mfma_f32_16x16x32_bf16 v[252:255], a[60:63], a[244:247], v[252:255]
    v_mfma_f32_16x16x32_bf16 v[248:251], a[60:63], a[240:243], v[248:251]
    v_mfma_f32_16x16x32_bf16 v[248:251], a[56:59], a[224:227], v[248:251]
    s_waitcnt vmcnt(15) lgkmcnt(0)
    v_mfma_f32_16x16x32_bf16 v[192:195], a[0:3], a[128:131], v[192:195]
    v_mfma_f32_16x16x32_bf16 v[192:195], a[4:7], a[144:147], v[192:195]
    s_add_u32 s52, s47, 536576
    ds_read_b64_tr_b16 a[32:33], v46 offset:0
    ds_read_b64_tr_b16 a[34:35], v46 offset:1024
    v_mfma_f32_16x16x32_bf16 v[196:199], a[4:7], a[148:151], v[196:199]
    buffer_store_dwordx4 v[188:191], v1, s[48:51], s52 offen offset:3072 sc1
    v_mfma_f32_16x16x32_bf16 v[196:199], a[0:3], a[132:135], v[196:199]
    ds_read_b64_tr_b16 a[36:37], v46 offset:8192
    v_mfma_f32_16x16x32_bf16 a[64:67], a[0:3], a[136:139], a[64:67]
    ds_read_b64_tr_b16 a[38:39], v46 offset:9216
    v_mfma_f32_16x16x32_bf16 a[64:67], a[4:7], a[152:155], a[64:67]
    ds_read_b64_tr_b16 a[40:41], v47 offset:0
    v_mfma_f32_16x16x32_bf16 a[68:71], a[4:7], a[156:159], a[68:71]
    v_mfma_f32_16x16x32_bf16 a[68:71], a[0:3], a[140:143], a[68:71]
    ds_read_b64_tr_b16 a[42:43], v47 offset:1024
    v_mfma_f32_16x16x32_bf16 a[76:79], a[8:11], a[140:143], a[76:79]
    ds_read_b64_tr_b16 a[44:45], v47 offset:8192
    v_mfma_f32_16x16x32_bf16 a[76:79], a[12:15], a[156:159], a[76:79]
    ds_read_b64_tr_b16 a[46:47], v47 offset:9216
    v_mfma_f32_16x16x32_bf16 a[72:75], a[12:15], a[152:155], a[72:75]
    ds_read_b64_tr_b16 a[48:49], v48 offset:0
    v_mfma_f32_16x16x32_bf16 a[72:75], a[8:11], a[136:139], a[72:75]
    v_mfma_f32_16x16x32_bf16 v[204:207], a[8:11], a[132:135], v[204:207]
    ds_read_b64_tr_b16 a[50:51], v48 offset:1024
    v_mfma_f32_16x16x32_bf16 v[204:207], a[12:15], a[148:151], v[204:207]
    ds_read_b64_tr_b16 a[52:53], v48 offset:8192
    v_mfma_f32_16x16x32_bf16 v[200:203], a[12:15], a[144:147], v[200:203]
    ds_read_b64_tr_b16 a[54:55], v48 offset:9216
    v_mfma_f32_16x16x32_bf16 v[200:203], a[8:11], a[128:131], v[200:203]
    v_mfma_f32_16x16x32_bf16 v[208:211], a[16:19], a[128:131], v[208:211]
    ds_read_b64_tr_b16 a[56:57], v49 offset:0
    v_mfma_f32_16x16x32_bf16 v[208:211], a[20:23], a[144:147], v[208:211]
    ds_read_b64_tr_b16 a[58:59], v49 offset:1024
    v_mfma_f32_16x16x32_bf16 v[212:215], a[20:23], a[148:151], v[212:215]
    ds_read_b64_tr_b16 a[60:61], v49 offset:8192
    v_mfma_f32_16x16x32_bf16 v[212:215], a[16:19], a[132:135], v[212:215]
    v_mfma_f32_16x16x32_bf16 a[80:83], a[16:19], a[136:139], a[80:83]
    ds_read_b64_tr_b16 a[62:63], v49 offset:9216
    v_mfma_f32_16x16x32_bf16 a[80:83], a[20:23], a[152:155], a[80:83]
    v_mfma_f32_16x16x32_bf16 a[84:87], a[20:23], a[156:159], a[84:87]
    v_mfma_f32_16x16x32_bf16 a[84:87], a[16:19], a[140:143], a[84:87]
    v_mfma_f32_16x16x32_bf16 a[92:95], a[24:27], a[140:143], a[92:95]
    v_mfma_f32_16x16x32_bf16 a[92:95], a[28:31], a[156:159], a[92:95]
    v_mfma_f32_16x16x32_bf16 a[88:91], a[28:31], a[152:155], a[88:91]
    v_mfma_f32_16x16x32_bf16 a[88:91], a[24:27], a[136:139], a[88:91]
    v_mfma_f32_16x16x32_bf16 v[220:223], a[24:27], a[132:135], v[220:223]
    s_cmp_eq_u32 s30, 0
    s_cbranch_scc1 k12_ool_72
k12_oolret_73:
    v_mfma_f32_16x16x32_bf16 v[220:223], a[28:31], a[148:151], v[220:223]
    v_mfma_f32_16x16x32_bf16 v[216:219], a[28:31], a[144:147], v[216:219]
    v_mfma_f32_16x16x32_bf16 v[216:219], a[24:27], a[128:131], v[216:219]
    s_waitcnt vmcnt(6) lgkmcnt(0)
    s_barrier
    v_mfma_f32_16x16x32_bf16 v[224:227], a[32:35], a[128:131], v[224:227]
    v_mfma_f32_16x16x32_bf16 v[224:227], a[36:39], a[144:147], v[224:227]
    s_mov_b32 m0, s34
    ds_read_b64_tr_b16 a[0:1], v42 offset:16384
    ds_read_b64_tr_b16 a[2:3], v42 offset:17408
    v_mfma_f32_16x16x32_bf16 v[228:231], a[36:39], a[148:151], v[228:231]
    buffer_load_dwordx4 v1, s[16:19], s32 offen offset:0 sc1 lds
    v_mfma_f32_16x16x32_bf16 v[228:231], a[32:35], a[132:135], v[228:231]
    ds_read_b64_tr_b16 a[4:5], v42 offset:24576
    v_mfma_f32_16x16x32_bf16 a[96:99], a[32:35], a[136:139], a[96:99]
    buffer_load_dwordx4 v1, s[16:19], s32 offen offset:1024 sc1 lds
    ds_read_b64_tr_b16 a[6:7], v42 offset:25600
    v_mfma_f32_16x16x32_bf16 a[96:99], a[36:39], a[152:155], a[96:99]
    ds_read_b64_tr_b16 a[8:9], v43 offset:16384
    v_mfma_f32_16x16x32_bf16 a[100:103], a[36:39], a[156:159], a[100:103]
    v_mfma_f32_16x16x32_bf16 a[100:103], a[32:35], a[140:143], a[100:103]
    buffer_load_dwordx4 v1, s[16:19], s32 offen offset:2048 sc1 lds
    ds_read_b64_tr_b16 a[10:11], v43 offset:17408
    v_mfma_f32_16x16x32_bf16 a[108:111], a[40:43], a[140:143], a[108:111]
    ds_read_b64_tr_b16 a[12:13], v43 offset:24576
    v_mfma_f32_16x16x32_bf16 a[108:111], a[44:47], a[156:159], a[108:111]
    ds_read_b64_tr_b16 a[14:15], v43 offset:25600
    v_mfma_f32_16x16x32_bf16 a[104:107], a[44:47], a[152:155], a[104:107]
    ds_read_b64_tr_b16 a[16:17], v44 offset:16384
    v_mfma_f32_16x16x32_bf16 a[104:107], a[40:43], a[136:139], a[104:107]
    buffer_load_dwordx4 v1, s[16:19], s32 offen offset:3072 sc1 lds
    v_mfma_f32_16x16x32_bf16 v[236:239], a[40:43], a[132:135], v[236:239]
    ds_read_b64_tr_b16 a[18:19], v44 offset:17408
    v_mfma_f32_16x16x32_bf16 v[236:239], a[44:47], a[148:151], v[236:239]
    s_add_u32 s32, s32, 0x80000
    ds_read_b64_tr_b16 a[20:21], v44 offset:24576
    v_mfma_f32_16x16x32_bf16 v[232:235], a[44:47], a[144:147], v[232:235]
    s_add_u32 s34, s34, 0x4000
    ds_read_b64_tr_b16 a[22:23], v44 offset:25600
    s_mov_b32 m0, s34
    v_mfma_f32_16x16x32_bf16 v[232:235], a[40:43], a[128:131], v[232:235]
    buffer_load_dwordx4 v1, s[16:19], s32 offen offset:0 sc1 lds
    v_mfma_f32_16x16x32_bf16 v[240:243], a[48:51], a[128:131], v[240:243]
    ds_read_b64_tr_b16 a[24:25], v45 offset:16384
    v_mfma_f32_16x16x32_bf16 v[240:243], a[52:55], a[144:147], v[240:243]
    buffer_load_dwordx4 v1, s[16:19], s32 offen offset:1024 sc1 lds
    ds_read_b64_tr_b16 a[26:27], v45 offset:17408
    v_mfma_f32_16x16x32_bf16 v[244:247], a[52:55], a[148:151], v[244:247]
    ds_read_b64_tr_b16 a[28:29], v45 offset:24576
    v_mfma_f32_16x16x32_bf16 v[244:247], a[48:51], a[132:135], v[244:247]
    v_mfma_f32_16x16x32_bf16 a[112:115], a[48:51], a[136:139], a[112:115]
    buffer_load_dwordx4 v1, s[16:19], s32 offen offset:2048 sc1 lds
    ds_read_b64_tr_b16 a[30:31], v45 offset:25600
    v_mfma_f32_16x16x32_bf16 a[112:115], a[52:55], a[152:155], a[112:115]
    v_mfma_f32_16x16x32_bf16 a[116:119], a[52:55], a[156:159], a[116:119]
    v_mfma_f32_16x16x32_bf16 a[116:119], a[48:51], a[140:143], a[116:119]
    v_mfma_f32_16x16x32_bf16 a[124:127], a[56:59], a[140:143], a[124:127]
    buffer_load_dwordx4 v1, s[16:19], s32 offen offset:3072 sc1 lds
    v_mfma_f32_16x16x32_bf16 a[124:127], a[60:63], a[156:159], a[124:127]
    v_mfma_f32_16x16x32_bf16 a[120:123], a[60:63], a[152:155], a[120:123]
    s_add_u32 s32, s32, 0x80000
    v_mfma_f32_16x16x32_bf16 a[120:123], a[56:59], a[136:139], a[120:123]
    s_add_u32 s34, s34, 0x4000
    v_mfma_f32_16x16x32_bf16 v[252:255], a[56:59], a[132:135], v[252:255]
    v_mfma_f32_16x16x32_bf16 v[252:255], a[60:63], a[148:151], v[252:255]
    v_mfma_f32_16x16x32_bf16 v[248:251], a[60:63], a[144:147], v[248:251]
    v_mfma_f32_16x16x32_bf16 v[248:251], a[56:59], a[128:131], v[248:251]
    s_waitcnt vmcnt(10) lgkmcnt(0)
    v_mfma_f32_16x16x32_bf16 v[192:195], a[0:3], a[160:163], v[192:195]
    v_mfma_f32_16x16x32_bf16 v[192:195], a[4:7], a[176:179], v[192:195]
    s_mov_b32 m0, s35
    ds_read_b64_tr_b16 a[32:33], v46 offset:16384
    ds_read_b64_tr_b16 a[34:35], v46 offset:17408
    v_mfma_f32_16x16x32_bf16 v[196:199], a[4:7], a[180:183], v[196:199]
    buffer_load_dwordx4 v1, s[20:23], s33 offen offset:0 sc1 lds
    v_mfma_f32_16x16x32_bf16 v[196:199], a[0:3], a[164:167], v[196:199]
    ds_read_b64_tr_b16 a[36:37], v46 offset:24576
    v_mfma_f32_16x16x32_bf16 a[64:67], a[0:3], a[168:171], a[64:67]
    buffer_load_dwordx4 v1, s[20:23], s33 offen offset:1024 sc1 lds
    ds_read_b64_tr_b16 a[38:39], v46 offset:25600
    v_mfma_f32_16x16x32_bf16 a[64:67], a[4:7], a[184:187], a[64:67]
    ds_read_b64_tr_b16 a[40:41], v47 offset:16384
    v_mfma_f32_16x16x32_bf16 a[68:71], a[4:7], a[188:191], a[68:71]
    v_mfma_f32_16x16x32_bf16 a[68:71], a[0:3], a[172:175], a[68:71]
    buffer_load_dwordx4 v1, s[20:23], s33 offen offset:2048 sc1 lds
    ds_read_b64_tr_b16 a[42:43], v47 offset:17408
    v_mfma_f32_16x16x32_bf16 a[76:79], a[8:11], a[172:175], a[76:79]
    ds_read_b64_tr_b16 a[44:45], v47 offset:24576
    v_mfma_f32_16x16x32_bf16 a[76:79], a[12:15], a[188:191], a[76:79]
    ds_read_b64_tr_b16 a[46:47], v47 offset:25600
    v_mfma_f32_16x16x32_bf16 a[72:75], a[12:15], a[184:187], a[72:75]
    ds_read_b64_tr_b16 a[48:49], v48 offset:16384
    v_mfma_f32_16x16x32_bf16 a[72:75], a[8:11], a[168:171], a[72:75]
    buffer_load_dwordx4 v1, s[20:23], s33 offen offset:3072 sc1 lds
    v_mfma_f32_16x16x32_bf16 v[204:207], a[8:11], a[164:167], v[204:207]
    ds_read_b64_tr_b16 a[50:51], v48 offset:17408
    v_mfma_f32_16x16x32_bf16 v[204:207], a[12:15], a[180:183], v[204:207]
    s_add_u32 s33, s33, 0x80000
    ds_read_b64_tr_b16 a[52:53], v48 offset:24576
    v_mfma_f32_16x16x32_bf16 v[200:203], a[12:15], a[176:179], v[200:203]
    s_add_u32 s35, s35, 0x4000
    ds_read_b64_tr_b16 a[54:55], v48 offset:25600
    s_mov_b32 m0, s34
    v_mfma_f32_16x16x32_bf16 v[200:203], a[8:11], a[160:163], v[200:203]
    buffer_load_dwordx4 v1, s[16:19], s32 offen offset:0 sc1 lds
    v_mfma_f32_16x16x32_bf16 v[208:211], a[16:19], a[160:163], v[208:211]
    ds_read_b64_tr_b16 a[56:57], v49 offset:16384
    v_mfma_f32_16x16x32_bf16 v[208:211], a[20:23], a[176:179], v[208:211]
    buffer_load_dwordx4 v1, s[16:19], s32 offen offset:1024 sc1 lds
    ds_read_b64_tr_b16 a[58:59], v49 offset:17408
    v_mfma_f32_16x16x32_bf16 v[212:215], a[20:23], a[180:183], v[212:215]
    ds_read_b64_tr_b16 a[60:61], v49 offset:24576
    v_mfma_f32_16x16x32_bf16 v[212:215], a[16:19], a[164:167], v[212:215]
    v_mfma_f32_16x16x32_bf16 a[80:83], a[16:19], a[168:171], a[80:83]
    buffer_load_dwordx4 v1, s[16:19], s32 offen offset:2048 sc1 lds
    ds_read_b64_tr_b16 a[62:63], v49 offset:25600
    v_mfma_f32_16x16x32_bf16 a[80:83], a[20:23], a[184:187], a[80:83]
    v_mfma_f32_16x16x32_bf16 a[84:87], a[20:23], a[188:191], a[84:87]
    v_mfma_f32_16x16x32_bf16 a[84:87], a[16:19], a[172:175], a[84:87]
    v_mfma_f32_16x16x32_bf16 a[92:95], a[24:27], a[172:175], a[92:95]
    buffer_load_dwordx4 v1, s[16:19], s32 offen offset:3072 sc1 lds
    v_mfma_f32_16x16x32_bf16 a[92:95], a[28:31], a[188:191], a[92:95]
    v_mfma_f32_16x16x32_bf16 a[88:91], a[28:31], a[184:187], a[88:91]
    s_add_u32 s32, s32, 0x80000
    v_mfma_f32_16x16x32_bf16 a[88:91], a[24:27], a[168:171], a[88:91]
    s_add_u32 s34, s34, 0x4000
    v_mfma_f32_16x16x32_bf16 v[220:223], a[24:27], a[164:167], v[220:223]
    v_mfma_f32_16x16x32_bf16 v[220:223], a[28:31], a[180:183], v[220:223]
    v_mfma_f32_16x16x32_bf16 v[216:219], a[28:31], a[176:179], v[216:219]
    v_mfma_f32_16x16x32_bf16 v[216:219], a[24:27], a[160:163], v[216:219]
    s_waitcnt vmcnt(63) lgkmcnt(0)
    s_barrier
    v_mfma_f32_16x16x32_bf16 v[224:227], a[32:35], a[160:163], v[224:227]
    v_mfma_f32_16x16x32_bf16 v[224:227], a[36:39], a[176:179], v[224:227]
    s_mov_b32 m0, s35
    v_mfma_f32_16x16x32_bf16 v[228:231], a[36:39], a[180:183], v[228:231]
    buffer_load_dwordx4 v1, s[20:23], s33 offen offset:0 sc1 lds
    v_mfma_f32_16x16x32_bf16 v[228:231], a[32:35], a[164:167], v[228:231]
    v_mfma_f32_16x16x32_bf16 a[96:99], a[32:35], a[168:171], a[96:99]
    v_mfma_f32_16x16x32_bf16 a[96:99], a[36:39], a[184:187], a[96:99]
    v_mfma_f32_16x16x32_bf16 a[100:103], a[36:39], a[188:191], a[100:103]
    v_mfma_f32_16x16x32_bf16 a[100:103], a[32:35], a[172:175], a[100:103]
    buffer_load_dwordx4 v1, s[20:23], s33 offen offset:1024 sc1 lds
    v_mfma_f32_16x16x32_bf16 a[108:111], a[40:43], a[172:175], a[108:111]
    v_mfma_f32_16x16x32_bf16 a[108:111], a[44:47], a[188:191], a[108:111]
    v_mfma_f32_16x16x32_bf16 a[104:107], a[44:47], a[184:187], a[104:107]
    v_mfma_f32_16x16x32_bf16 a[104:107], a[40:43], a[168:171], a[104:107]
    v_mfma_f32_16x16x32_bf16 v[236:239], a[40:43], a[164:167], v[236:239]
    v_mfma_f32_16x16x32_bf16 v[236:239], a[44:47], a[180:183], v[236:239]
    v_mfma_f32_16x16x32_bf16 v[232:235], a[44:47], a[176:179], v[232:235]
    buffer_load_dwordx4 v1, s[20:23], s33 offen offset:2048 sc1 lds
    v_mfma_f32_16x16x32_bf16 v[232:235], a[40:43], a[160:163], v[232:235]
    v_mfma_f32_16x16x32_bf16 v[240:243], a[48:51], a[160:163], v[240:243]
    v_mfma_f32_16x16x32_bf16 v[240:243], a[52:55], a[176:179], v[240:243]
    v_mfma_f32_16x16x32_bf16 v[244:247], a[52:55], a[180:183], v[244:247]
    v_mfma_f32_16x16x32_bf16 v[244:247], a[48:51], a[164:167], v[244:247]
    v_mfma_f32_16x16x32_bf16 a[112:115], a[48:51], a[168:171], a[112:115]
    buffer_load_dwordx4 v1, s[20:23], s33 offen offset:3072 sc1 lds
    v_mfma_f32_16x16x32_bf16 a[112:115], a[52:55], a[184:187], a[112:115]
    v_mfma_f32_16x16x32_bf16 a[116:119], a[52:55], a[188:191], a[116:119]
    v_mfma_f32_16x16x32_bf16 a[116:119], a[48:51], a[172:175], a[116:119]
    v_mfma_f32_16x16x32_bf16 a[124:127], a[56:59], a[172:175], a[124:127]
    v_mfma_f32_16x16x32_bf16 a[124:127], a[60:63], a[188:191], a[124:127]
    v_mfma_f32_16x16x32_bf16 a[120:123], a[60:63], a[184:187], a[120:123]
    s_add_u32 s33, s33, 0x80000
    v_mfma_f32_16x16x32_bf16 a[120:123], a[56:59], a[168:171], a[120:123]
    s_add_u32 s35, s35, 0x4000
    v_mfma_f32_16x16x32_bf16 v[252:255], a[56:59], a[164:167], v[252:255]
    v_mfma_f32_16x16x32_bf16 v[252:255], a[60:63], a[180:183], v[252:255]
    v_mfma_f32_16x16x32_bf16 v[248:251], a[60:63], a[176:179], v[248:251]
    v_mfma_f32_16x16x32_bf16 v[248:251], a[56:59], a[160:163], v[248:251]
    s_add_u32 s3, s54, 64
    s_add_u32 s5, s55, 64
    s_mov_b32 s63, s57
    s_load_dwordx2 s[44:45], s[0:1], 40
    s_load_dwordx2 s[46:47], s[0:1], 64
    s_load_dwordx4 s[48:51], s[0:1], 72
    s_mov_b32 s40, 0x3e0293ee
    s_mov_b32 s41, 0x3e0293ee
    s_mov_b32 m0, s34
    s_nop 0
    buffer_load_dwordx4 v1, s[16:19], s32 offen offset:0 sc1 lds
    buffer_load_dwordx4 v1, s[16:19], s32 offen offset:1024 sc1 lds
    buffer_load_dwordx4 v1, s[16:19], s32 offen offset:2048 sc1 lds
    buffer_load_dwordx4 v1, s[16:19], s32 offen offset:3072 sc1 lds
    s_mov_b32 m0, s35
    s_nop 0
    buffer_load_dwordx4 v1, s[20:23], s33 offen offset:0 sc1 lds
    buffer_load_dwordx4 v1, s[20:23], s33 offen offset:1024 sc1 lds
    buffer_load_dwordx4 v1, s[20:23], s33 offen offset:2048 sc1 lds
    buffer_load_dwordx4 v1, s[20:23], s33 offen offset:3072 sc1 lds
    s_add_u32 s32, s32, 0x80000
    s_add_u32 s33, s33, 0x80000
    s_add_u32 s34, s34, 0x4000
    s_and_b32 s34, s34, 0xffff
    s_add_u32 s35, s35, 0x4000
    s_and_b32 s35, s35, 0xffff
    s_or_b32 s35, s35, 0x10000
    v_mov_b32 v2, v1
    v_or_b32 v3, 0x10000, v1
    v_mov_b32 v56, v3
    s_mov_b32 s52, 0x4000
    s_mov_b32 s53, 0
    s_lshl_b32 s62, s28, 6
    s_mul_i32 s31, s29, s29
    s_add_u32 s62, s62, s31
    s_lshr_b32 s31, s30, 1
    s_lshl_b32 s4, s31, 23
    s_add_u32 s4, s4, 0x6000000
    s_add_u32 s8, s6, s4
    s_addc_u32 s9, s7, 0
    s_and_b32 s9, s9, 0xffff
    s_mov_b32 s10, 0
    s_mov_b32 s58, 0
    s_mov_b32 s14, 0x700000
    s_mov_b32 s59, 0x700000
    s_lshl_b32 s54, s62, 12
    s_waitcnt vmcnt(16) lgkmcnt(0)
    s_barrier
    s_cmp_eq_u32 s63, 0
    s_cbranch_scc1 k12_ool_74
k12_oolret_75:
    v_mov_b32 v59, 0
    ds_read_b128 a[128:131], v2 offset:0
    ds_read_b128 a[132:135], v2 offset:1024
    ds_read_b128 a[136:139], v2 offset:2048
    ds_read_b128 a[140:143], v2 offset:3072
    ds_read_b128 a[144:147], v2 offset:4096
    ds_read_b128 a[148:151], v2 offset:5120
    ds_read_b128 a[152:155], v2 offset:6144
    ds_read_b128 a[156:159], v2 offset:7168
    ds_read_b128 a[160:163], v2 offset:8192
    ds_read_b128 a[164:167], v2 offset:9216
    ds_read_b128 a[168:171], v2 offset:10240
    ds_read_b128 a[172:175], v2 offset:11264
    ds_read_b128 a[176:179], v2 offset:12288
    ds_read_b128 a[180:183], v2 offset:13312
    ds_read_b128 a[184:187], v2 offset:14336
    ds_read_b128 a[188:191], v2 offset:15360
    s_cmp_lt_u32 s30, 2
    s_cselect_b64 s[12:13], s[46:47], s[48:49]
    s_cselect_b64 s[60:61], s[44:45], s[50:51]
    s_cselect_b32 s55, 0x800000, s14
    s_and_b32 s13, s13, 0xffff
    v_accvgpr_read_b32 v128, a64
    v_accvgpr_read_b32 v129, a65
    v_accvgpr_read_b32 v130, a66
    v_accvgpr_read_b32 v131, a67
    v_pk_mul_f32 v[128:129], v[128:129], s[40:41]
    v_pk_mul_f32 v[130:131], v[130:131], s[40:41]
    v_cvt_pk_bf16_f32 v96, v128, v129
    v_cvt_pk_bf16_f32 v97, v130, v131
    v_accvgpr_read_b32 v132, a72
    v_accvgpr_read_b32 v133, a73
    v_accvgpr_read_b32 v134, a74
    v_accvgpr_read_b32 v135, a75
    v_pk_mul_f32 v[132:133], v[132:133], s[40:41]
    v_pk_mul_f32 v[134:135], v[134:135], s[40:41]
    v_cvt_pk_bf16_f32 v98, v132, v133
    v_cvt_pk_bf16_f32 v99, v134, v135
    v_accvgpr_read_b32 v136, a80
    v_accvgpr_read_b32 v137, a81
    v_accvgpr_read_b32 v138, a82
    v_accvgpr_read_b32 v139, a83
    v_pk_mul_f32 v[136:137], v[136:137], s[40:41]
    v_pk_mul_f32 v[138:139], v[138:139], s[40:41]
    v_cvt_pk_bf16_f32 v100, v136, v137
    v_cvt_pk_bf16_f32 v101, v138, v139
    v_accvgpr_read_b32 v140, a88
    v_accvgpr_read_b32 v141, a89
    v_accvgpr_read_b32 v142, a90
    v_accvgpr_read_b32 v143, a91
    v_pk_mul_f32 v[140:141], v[140:141], s[40:41]
    v_pk_mul_f32 v[142:143], v[142:143], s[40:41]
    v_cvt_pk_bf16_f32 v102, v140, v141
    v_cvt_pk_bf16_f32 v103, v142, v143
    v_accvgpr_read_b32 v128, a96
    v_accvgpr_read_b32 v129, a97
    v_accvgpr_read_b32 v130, a98
    v_accvgpr_read_b32 v131, a99
    v_pk_mul_f32 v[128:129], v[128:129], s[40:41]
    v_pk_mul_f32 v[130:131], v[130:131], s[40:41]
    v_cvt_pk_bf16_f32 v104, v128, v129
    v_cvt_pk_bf16_f32 v105, v130, v131
    v_accvgpr_read_b32 v132, a104
    v_accvgpr_read_b32 v133, a105
    v_accvgpr_read_b32 v134, a106
    v_accvgpr_read_b32 v135, a107
    v_pk_mul_f32 v[132:133], v[132:133], s[40:41]
    v_pk_mul_f32 v[134:135], v[134:135], s[40:41]
    v_cvt_pk_bf16_f32 v106, v132, v133
    v_cvt_pk_bf16_f32 v107, v134, v135
    v_accvgpr_read_b32 v136, a112
    v_accvgpr_read_b32 v137, a113
    v_accvgpr_read_b32 v138, a114
    v_accvgpr_read_b32 v139, a115
    v_pk_mul_f32 v[136:137], v[136:137], s[40:41]
    v_pk_mul_f32 v[138:139], v[138:139], s[40:41]
    v_cvt_pk_bf16_f32 v108, v136, v137
    v_cvt_pk_bf16_f32 v109, v138, v139
    v_accvgpr_read_b32 v140, a120
    v_accvgpr_read_b32 v141, a121
    v_accvgpr_read_b32 v142, a122
    v_accvgpr_read_b32 v143, a123
    v_pk_mul_f32 v[140:141], v[140:141], s[40:41]
    v_pk_mul_f32 v[142:143], v[142:143], s[40:41]
    v_cvt_pk_bf16_f32 v110, v140, v141
    v_cvt_pk_bf16_f32 v111, v142, v143
    v_accvgpr_read_b32 v128, a68
    v_accvgpr_read_b32 v129, a69
    v_accvgpr_read_b32 v130, a70
    v_accvgpr_read_b32 v131, a71
    v_pk_mul_f32 v[128:129], v[128:129], s[40:41]
    v_pk_mul_f32 v[130:131], v[130:131], s[40:41]
    v_cvt_pk_bf16_f32 v112, v128, v129
    v_cvt_pk_bf16_f32 v113, v130, v131
    v_accvgpr_read_b32 v132, a76
    v_accvgpr_read_b32 v133, a77
    v_accvgpr_read_b32 v134, a78
    v_accvgpr_read_b32 v135, a79
    v_pk_mul_f32 v[132:133], v[132:133], s[40:41]
    v_pk_mul_f32 v[134:135], v[134:135], s[40:41]
    v_cvt_pk_bf16_f32 v114, v132, v133
    v_cvt_pk_bf16_f32 v115, v134, v135
    v_accvgpr_read_b32 v136, a84
    v_accvgpr_read_b32 v137, a85
    v_accvgpr_read_b32 v138, a86
    v_accvgpr_read_b32 v139, a87
    v_pk_mul_f32 v[136:137], v[136:137], s[40:41]
    v_pk_mul_f32 v[138:139], v[138:139], s[40:41]
    v_cvt_pk_bf16_f32 v116, v136, v137
    v_cvt_pk_bf16_f32 v117, v138, v139
    v_accvgpr_read_b32 v140, a92
    v_accvgpr_read_b32 v141, a93
    v_accvgpr_read_b32 v142, a94
    v_accvgpr_read_b32 v143, a95
    v_pk_mul_f32 v[140:141], v[140:141], s[40:41]
    v_pk_mul_f32 v[142:143], v[142:143], s[40:41]
    v_cvt_pk_bf16_f32 v118, v140, v141
    v_cvt_pk_bf16_f32 v119, v142, v143
    v_accvgpr_read_b32 v128, a100
    v_accvgpr_read_b32 v129, a101
    v_accvgpr_read_b32 v130, a102
    v_accvgpr_read_b32 v131, a103
    v_pk_mul_f32 v[128:129], v[128:129], s[40:41]
    v_pk_mul_f32 v[130:131], v[130:131], s[40:41]
    v_cvt_pk_bf16_f32 v120, v128, v129
    v_cvt_pk_bf16_f32 v121, v130, v131
    v_accvgpr_read_b32 v132, a108
    v_accvgpr_read_b32 v133, a109
    v_accvgpr_read_b32 v134, a110
    v_accvgpr_read_b32 v135, a111
    v_pk_mul_f32 v[132:133], v[132:133], s[40:41]
    v_pk_mul_f32 v[134:135], v[134:135], s[40:41]
    v_cvt_pk_bf16_f32 v122, v132, v133
    v_cvt_pk_bf16_f32 v123, v134, v135
    v_accvgpr_read_b32 v136, a116
    v_accvgpr_read_b32 v137, a117
    v_accvgpr_read_b32 v138, a118
    v_accvgpr_read_b32 v139, a119
    v_pk_mul_f32 v[136:137], v[136:137], s[40:41]
    v_pk_mul_f32 v[138:139], v[138:139], s[40:41]
    v_cvt_pk_bf16_f32 v124, v136, v137
    v_cvt_pk_bf16_f32 v125, v138, v139
    v_accvgpr_read_b32 v140, a124
    v_accvgpr_read_b32 v141, a125
    v_accvgpr_read_b32 v142, a126
    v_accvgpr_read_b32 v143, a127
    v_pk_mul_f32 v[140:141], v[140:141], s[40:41]
    v_pk_mul_f32 v[142:143], v[142:143], s[40:41]
    v_cvt_pk_bf16_f32 v126, v140, v141
    v_cvt_pk_bf16_f32 v127, v142, v143
    v_pk_mul_f32 v[192:193], v[192:193], s[40:41]
    v_pk_mul_f32 v[194:195], v[194:195], s[40:41]
    v_cvt_pk_bf16_f32 v64, v192, v193
    v_cvt_pk_bf16_f32 v65, v194, v195
    v_pk_mul_f32 v[200:201], v[200:201], s[40:41]
    v_pk_mul_f32 v[202:203], v[202:203], s[40:41]
    v_cvt_pk_bf16_f32 v66, v200, v201
    v_cvt_pk_bf16_f32 v67, v202, v203
    v_pk_mul_f32 v[208:209], v[208:209], s[40:41]
    v_pk_mul_f32 v[210:211], v[210:211], s[40:41]
    v_cvt_pk_bf16_f32 v68, v208, v209
    v_cvt_pk_bf16_f32 v69, v210, v211
    v_pk_mul_f32 v[216:217], v[216:217], s[40:41]
    v_pk_mul_f32 v[218:219], v[218:219], s[40:41]
    v_cvt_pk_bf16_f32 v70, v216, v217
    v_cvt_pk_bf16_f32 v71, v218, v219
    v_pk_mul_f32 v[224:225], v[224:225], s[40:41]
    v_pk_mul_f32 v[226:227], v[226:227], s[40:41]
    v_cvt_pk_bf16_f32 v72, v224, v225
    v_cvt_pk_bf16_f32 v73, v226, v227
    v_pk_mul_f32 v[232:233], v[232:233], s[40:41]
    v_pk_mul_f32 v[234:235], v[234:235], s[40:41]
    v_cvt_pk_bf16_f32 v74, v232, v233
    v_cvt_pk_bf16_f32 v75, v234, v235
    v_pk_mul_f32 v[240:241], v[240:241], s[40:41]
    v_pk_mul_f32 v[242:243], v[242:243], s[40:41]
    v_cvt_pk_bf16_f32 v76, v240, v241
    v_cvt_pk_bf16_f32 v77, v242, v243
    v_pk_mul_f32 v[248:249], v[248:249], s[40:41]
    v_pk_mul_f32 v[250:251], v[250:251], s[40:41]
    v_cvt_pk_bf16_f32 v78, v248, v249
    v_cvt_pk_bf16_f32 v79, v250, v251
    v_pk_mul_f32 v[196:197], v[196:197], s[40:41]
    v_pk_mul_f32 v[198:199], v[198:199], s[40:41]
    v_cvt_pk_bf16_f32 v80, v196, v197
    v_cvt_pk_bf16_f32 v81, v198, v199
    v_pk_mul_f32 v[204:205], v[204:205], s[40:41]
    v_pk_mul_f32 v[206:207], v[206:207], s[40:41]
    v_cvt_pk_bf16_f32 v82, v204, v205
    v_cvt_pk_bf16_f32 v83, v206, v207
    v_pk_mul_f32 v[212:213], v[212:213], s[40:41]
    v_pk_mul_f32 v[214:215], v[214:215], s[40:41]
    v_cvt_pk_bf16_f32 v84, v212, v213
    v_cvt_pk_bf16_f32 v85, v214, v215
    v_pk_mul_f32 v[220:221], v[220:221], s[40:41]
    v_pk_mul_f32 v[222:223], v[222:223], s[40:41]
    v_cvt_pk_bf16_f32 v86, v220, v221
    v_cvt_pk_bf16_f32 v87, v222, v223
    v_pk_mul_f32 v[228:229], v[228:229], s[40:41]
    v_pk_mul_f32 v[230:231], v[230:231], s[40:41]
    v_cvt_pk_bf16_f32 v88, v228, v229
    v_cvt_pk_bf16_f32 v89, v230, v231
    v_pk_mul_f32 v[236:237], v[236:237], s[40:41]
    v_pk_mul_f32 v[238:239], v[238:239], s[40:41]
    v_cvt_pk_bf16_f32 v90, v236, v237
    v_cvt_pk_bf16_f32 v91, v238, v239
    v_pk_mul_f32 v[244:245], v[244:245], s[40:41]
    v_pk_mul_f32 v[246:247], v[246:247], s[40:41]
    v_cvt_pk_bf16_f32 v92, v244, v245
    v_cvt_pk_bf16_f32 v93, v246, v247
    v_pk_mul_f32 v[252:253], v[252:253], s[40:41]
    v_pk_mul_f32 v[254:255], v[254:255], s[40:41]
    v_cvt_pk_bf16_f32 v94, v252, v253
    v_cvt_pk_bf16_f32 v95, v254, v255
    v_add_u32 v2, 0x4000, v1
    v_mov_b32 v8, 0
    v_mov_b32 v232, 0
    v_mov_b32 v9, 0
    v_mov_b32 v233, 0
    v_mov_b32 v10, 0
    v_mov_b32 v234, 0
    v_mov_b32 v11, 0
    v_mov_b32 v235, 0
    s_mov_b32 s36, 0
    s_mov_b32 s37, 0x40004000
    v_mfma_f32_32x32x16_bf16 v[16:31], v[232:235], v[232:235], 0
    v_mfma_f32_32x32x16_bf16 v[32:47], v[232:235], v[232:235], 0
    v_and_b32 v6, 0xf0, v1
    v_cmp_eq_u32 vcc, 0, v6
    v_mov_b32 v6, 0x3f803f80
    v_lshrrev_b32 v229, 7, v1
    s_and_b32 s4, s30, 1
    s_lshl_b32 s31, s4, 11
    v_lshl_add_u32 v230, v1, 1, s31
    v_lshl_add_u32 v229, s4, 4, v229
    v_mul_u32_u24 v228, 7168, v229
    v_and_b32 v7, 0x70, v1
    v_add_u32 v228, v228, v7
    v_lshlrev_b32 v229, 5, v229
    v_and_b32 v57, 0x10, v1
    v_add_u32 v229, v229, v57
    v_lshrrev_b32 v7, 5, v7
    v_lshl_add_u32 v229, v7, 15, v229
    v_cndmask_b32 v60, 0, v6, vcc
    v_cndmask_b32 v61, 0, v6, vcc
    v_cndmask_b32 v62, 0, v6, vcc
    v_cndmask_b32 v63, 0, v6, vcc
    v_mov_b32 v12, 0
    v_mov_b32 v13, 0
    v_mov_b32 v14, 0
    v_mov_b32 v15, 0
    v_mov_b32 v48, 0
    v_mov_b32 v49, 0
    v_mov_b32 v50, 0
    v_mov_b32 v51, 0
    v_mov_b32 v248, 0
    v_mov_b32 v249, 0
    v_mov_b32 v250, 0
    v_mov_b32 v251, 0
    v_mov_b32 v252, 0
    v_mov_b32 v253, 0
    v_mov_b32 v254, 0
    v_mov_b32 v255, 0
    s_waitcnt lgkmcnt(0)
    s_cmp_ge_u32 s36, s42
    s_cbranch_scc1 k2_prep_76
k2_prepret_77:
    v_mfma_f32_16x16x32_bf16 v[128:131], a[128:131], v[64:67], v[16:19]
    v_mfma_f32_16x16x32_bf16 v[128:131], a[132:135], v[68:71], v[128:131]
    v_mfma_f32_16x16x32_bf16 v[128:131], a[136:139], v[72:75], v[128:131]
    v_mfma_f32_16x16x32_bf16 v[128:131], a[140:143], v[76:79], v[128:131]
    s_add_u32 s36, s36, 32
    v_mfma_f32_16x16x32_bf16 v[132:135], a[140:143], v[92:95], v[20:23]
    v_mfma_f32_16x16x32_bf16 v[132:135], a[136:139], v[88:91], v[132:135]
    v_mfma_f32_16x16x32_bf16 v[132:135], a[132:135], v[84:87], v[132:135]
    v_mfma_f32_16x16x32_bf16 v[132:135], a[128:131], v[80:83], v[132:135]
    v_mfma_f32_16x16x32_bf16 v[136:139], a[128:131], v[96:99], v[24:27]
    v_mfma_f32_16x16x32_bf16 v[136:139], a[132:135], v[100:103], v[136:139]
    v_mfma_f32_16x16x32_bf16 v[136:139], a[136:139], v[104:107], v[136:139]
    v_mfma_f32_16x16x32_bf16 v[136:139], a[140:143], v[108:111], v[136:139]
    v_mfma_f32_16x16x32_bf16 v[140:143], a[140:143], v[124:127], v[28:31]
    v_mfma_f32_16x16x32_bf16 v[140:143], a[136:139], v[120:123], v[140:143]
    v_mfma_f32_16x16x32_bf16 v[140:143], a[132:135], v[116:119], v[140:143]
    v_mfma_f32_16x16x32_bf16 v[140:143], a[128:131], v[112:115], v[140:143]
    v_mfma_f32_16x16x32_bf16 v[156:159], a[144:147], v[112:115], v[44:47]
    v_mfma_f32_16x16x32_bf16 v[156:159], a[148:151], v[116:119], v[156:159]
    v_mfma_f32_16x16x32_bf16 v[156:159], a[152:155], v[120:123], v[156:159]
    v_mfma_f32_16x16x32_bf16 v[156:159], a[156:159], v[124:127], v[156:159]
    v_mfma_f32_16x16x32_bf16 v[152:155], a[156:159], v[108:111], v[40:43]
    v_mfma_f32_16x16x32_bf16 v[152:155], a[152:155], v[104:107], v[152:155]
    v_mfma_f32_16x16x32_bf16 v[152:155], a[148:151], v[100:103], v[152:155]
    v_mfma_f32_16x16x32_bf16 v[152:155], a[144:147], v[96:99], v[152:155]
    v_mfma_f32_16x16x32_bf16 v[148:151], a[144:147], v[80:83], v[36:39]
    v_mfma_f32_16x16x32_bf16 v[148:151], a[148:151], v[84:87], v[148:151]
    v_mfma_f32_16x16x32_bf16 v[148:151], a[152:155], v[88:91], v[148:151]
    v_mfma_f32_16x16x32_bf16 v[148:151], a[156:159], v[92:95], v[148:151]
    v_mfma_f32_16x16x32_bf16 v[144:147], a[156:159], v[76:79], v[32:35]
    v_mfma_f32_16x16x32_bf16 v[144:147], a[152:155], v[72:75], v[144:147]
    v_mfma_f32_16x16x32_bf16 v[144:147], a[148:151], v[68:71], v[144:147]
    v_mfma_f32_16x16x32_bf16 v[144:147], a[144:147], v[64:67], v[144:147]
    v_mfma_f32_32x32x16_bf16 a[0:15], v[232:235], v[232:235], 0
    v_mfma_f32_32x32x16_bf16 a[16:31], v[232:235], v[232:235], 0
    v_mfma_f32_32x32x16_bf16 a[32:47], v[232:235], v[232:235], 0
    v_mfma_f32_32x32x16_bf16 a[48:63], v[232:235], v[232:235], 0
    v_mfma_f32_32x32x16_bf16 a[64:79], v[232:235], v[232:235], 0
    v_mfma_f32_32x32x16_bf16 a[80:95], v[232:235], v[232:235], 0
    v_mfma_f32_32x32x16_bf16 a[96:111], v[232:235], v[232:235], 0
    v_mfma_f32_32x32x16_bf16 a[112:127], v[232:235], v[232:235], 0
    v_max_f32 v52, v128, v129
    v_max3_f32 v52, v52, v130, v131
    v_max3_f32 v52, v52, v144, v145
    v_max3_f32 v52, v52, v146, v147
    v_max_f32 v53, v132, v133
    v_max3_f32 v53, v53, v134, v135
    v_max3_f32 v53, v53, v148, v149
    v_max3_f32 v53, v53, v150, v151
    v_max_f32 v54, v136, v137
    v_max3_f32 v54, v54, v138, v139
    v_max3_f32 v54, v54, v152, v153
    v_max3_f32 v54, v54, v154, v155
    v_max_f32 v55, v140, v141
    v_max3_f32 v55, v55, v142, v143
    v_max3_f32 v55, v55, v156, v157
    v_max3_f32 v55, v55, v158, v159
    v_mov_b32 v224, v52
    v_mov_b32 v225, v53
    v_mov_b32 v226, v54
    v_mov_b32 v227, v55
    s_nop 1
    v_permlane16_swap_b32 v52, v224
    v_permlane16_swap_b32 v53, v225
    v_permlane16_swap_b32 v54, v226
    v_permlane16_swap_b32 v55, v227
    s_nop 1
    v_max_f32 v52, v52, v224
    v_max_f32 v53, v53, v225
    v_max_f32 v54, v54, v226
    v_max_f32 v55, v55, v227
    v_mov_b32 v224, v52
    v_mov_b32 v225, v53
    v_mov_b32 v226, v54
    v_mov_b32 v227, v55
    s_nop 1
    v_permlane32_swap_b32 v52, v224
    v_permlane32_swap_b32 v53, v225
    v_permlane32_swap_b32 v54, v226
    v_permlane32_swap_b32 v55, v227
    s_nop 1
    v_max_f32 v52, v52, v224
    v_max_f32 v53, v53, v225
    v_max_f32 v54, v54, v226
    v_max_f32 v55, v55, v227
    v_add_f32 v52, 0x41400000, v52
    v_add_f32 v53, 0x41400000, v53
    v_add_f32 v54, 0x41400000, v54
    v_add_f32 v55, 0x41400000, v55
    v_sub_f32 v16, 0, v52
    v_sub_f32 v17, 0, v52
    v_sub_f32 v18, 0, v52
    v_sub_f32 v19, 0, v52
    v_sub_f32 v20, 0, v53
    v_sub_f32 v21, 0, v53
    v_sub_f32 v22, 0, v53
    v_sub_f32 v23, 0, v53
    v_sub_f32 v24, 0, v54
    v_sub_f32 v25, 0, v54
    v_sub_f32 v26, 0, v54
    v_sub_f32 v27, 0, v54
    v_sub_f32 v28, 0, v55
    v_sub_f32 v29, 0, v55
    v_sub_f32 v30, 0, v55
    v_sub_f32 v31, 0, v55
    v_sub_f32 v32, 0, v52
    v_sub_f32 v33, 0, v52
    v_sub_f32 v34, 0, v52
    v_sub_f32 v35, 0, v52
    v_sub_f32 v36, 0, v53
    v_sub_f32 v37, 0, v53
    v_sub_f32 v38, 0, v53
    v_sub_f32 v39, 0, v53
    v_sub_f32 v40, 0, v54
    v_sub_f32 v41, 0, v54
    v_sub_f32 v42, 0, v54
    v_sub_f32 v43, 0, v54
    v_sub_f32 v44, 0, v55
    v_sub_f32 v45, 0, v55
    v_sub_f32 v46, 0, v55
    v_sub_f32 v47, 0, v55
    v_sub_f32 v8, 0, v52
    v_sub_f32 v9, 0, v53
    v_sub_f32 v10, 0, v54
    v_sub_f32 v11, 0, v55
    s_cmp_ge_u32 s36, s42
    s_cbranch_scc1 k2_prep_84
k2_prepret_85:
    v_mfma_f32_16x16x32_bf16 v[160:163], a[160:163], v[64:67], v[16:19]
    v_sub_f32 v128, v128, v52
    v_sub_f32 v129, v129, v52
    v_sub_f32 v130, v130, v52
    v_mfma_f32_16x16x32_bf16 v[160:163], a[164:167], v[68:71], v[160:163]
    v_exp_f32 v232, v128
    v_sub_f32 v131, v131, v52
    v_mfma_f32_16x16x32_bf16 v[160:163], a[168:171], v[72:75], v[160:163]
    v_exp_f32 v233, v129
    v_sub_f32 v144, v144, v52
    v_mfma_f32_16x16x32_bf16 v[160:163], a[172:175], v[76:79], v[160:163]
    s_add_u32 s36, s36, 32
    s_cmp_eq_u32 s30, 0
    s_cbranch_scc1 k12_ool_78
k12_oolret_79:
    v_sub_f32 v145, v145, v52
    v_mfma_f32_16x16x32_bf16 v[164:167], a[172:175], v[92:95], v[20:23]
    v_exp_f32 v234, v130
    v_cvt_pk_bf16_f32 v192, v232, v233
    v_mfma_f32_16x16x32_bf16 v[164:167], a[168:171], v[88:91], v[164:167]
    v_exp_f32 v235, v131
    v_sub_f32 v146, v146, v52
    v_mfma_f32_16x16x32_bf16 v[164:167], a[164:167], v[84:87], v[164:167]
    v_exp_f32 v236, v144
    v_sub_f32 v147, v147, v52
    v_mfma_f32_16x16x32_bf16 v[164:167], a[160:163], v[80:83], v[164:167]
    v_cvt_pk_bf16_f32 v193, v234, v235
    v_exp_f32 v237, v145
    v_mfma_f32_16x16x32_bf16 v[168:171], a[160:163], v[96:99], v[24:27]
    v_exp_f32 v238, v146
    v_sub_f32 v132, v132, v53
    v_mfma_f32_16x16x32_bf16 v[168:171], a[164:167], v[100:103], v[168:171]
    v_sub_f32 v133, v133, v53
    v_cvt_pk_bf16_f32 v194, v236, v237
    v_or3_b32 v57, v192, v193, v194
    v_mfma_f32_16x16x32_bf16 v[168:171], a[168:171], v[104:107], v[168:171]
    v_exp_f32 v239, v147
    v_sub_f32 v134, v134, v53
    v_mfma_f32_16x16x32_bf16 v[168:171], a[172:175], v[108:111], v[168:171]
    v_exp_f32 v240, v132
    v_sub_f32 v135, v135, v53
    v_mfma_f32_16x16x32_bf16 v[172:175], a[172:175], v[124:127], v[28:31]
    v_cvt_pk_bf16_f32 v195, v238, v239
    v_exp_f32 v241, v133
    v_mfma_f32_16x16x32_bf16 v[172:175], a[168:171], v[120:123], v[172:175]
    v_exp_f32 v242, v134
    v_sub_f32 v148, v148, v53
    v_mfma_f32_16x16x32_bf16 v[172:175], a[164:167], v[116:119], v[172:175]
    v_sub_f32 v149, v149, v53
    v_cvt_pk_bf16_f32 v196, v240, v241
    v_exp_f32 v243, v135
    v_mfma_f32_16x16x32_bf16 v[172:175], a[160:163], v[112:115], v[172:175]
    v_or3_b32 v57, v57, v195, v196
    v_exp_f32 v244, v148
    v_mfma_f32_16x16x32_bf16 v[188:191], a[176:179], v[112:115], v[44:47]
    v_sub_f32 v150, v150, v53
    v_sub_f32 v151, v151, v53
    v_cvt_pk_bf16_f32 v197, v242, v243
    v_mfma_f32_16x16x32_bf16 v[188:191], a[180:183], v[116:119], v[188:191]
    v_exp_f32 v245, v149
    v_exp_f32 v246, v150
    v_mfma_f32_16x16x32_bf16 v[188:191], a[184:187], v[120:123], v[188:191]
    v_sub_f32 v136, v136, v54
    v_sub_f32 v137, v137, v54
    v_cvt_pk_bf16_f32 v198, v244, v245
    v_mfma_f32_16x16x32_bf16 v[188:191], a[188:191], v[124:127], v[188:191]
    v_exp_f32 v247, v151
    v_or3_b32 v57, v57, v197, v198
    v_mfma_f32_16x16x32_bf16 v[184:187], a[188:191], v[108:111], v[40:43]
    v_exp_f32 v232, v136
    v_sub_f32 v138, v138, v54
    v_mfma_f32_16x16x32_bf16 v[184:187], a[184:187], v[104:107], v[184:187]
    ds_read_b128 a[192:195], v3 offset:0
    v_sub_f32 v139, v139, v54
    v_cvt_pk_bf16_f32 v199, v246, v247
    v_mfma_f32_16x16x32_bf16 v[184:187], a[180:183], v[100:103], v[184:187]
    v_exp_f32 v233, v137
    v_exp_f32 v234, v138
    v_mfma_f32_16x16x32_bf16 v[184:187], a[176:179], v[96:99], v[184:187]
    v_sub_f32 v152, v152, v54
    v_sub_f32 v153, v153, v54
    v_cvt_pk_bf16_f32 v200, v232, v233
    v_mfma_f32_16x16x32_bf16 v[180:183], a[176:179], v[80:83], v[36:39]
    v_exp_f32 v235, v139
    v_or3_b32 v57, v57, v199, v200
    v_mfma_f32_16x16x32_bf16 v[180:183], a[180:183], v[84:87], v[180:183]
    v_exp_f32 v236, v152
    v_sub_f32 v154, v154, v54
    v_mfma_f32_16x16x32_bf16 v[180:183], a[184:187], v[88:91], v[180:183]
    v_sub_f32 v155, v155, v54
    v_cvt_pk_bf16_f32 v201, v234, v235
    v_exp_f32 v237, v153
    v_mfma_f32_16x16x32_bf16 v[180:183], a[188:191], v[92:95], v[180:183]
    ds_read_b128 a[196:199], v3 offset:1024
    v_exp_f32 v238, v154
    v_mfma_f32_16x16x32_bf16 v[176:179], a[188:191], v[76:79], v[32:35]
    v_sub_f32 v140, v140, v55
    v_sub_f32 v141, v141, v55
    v_cvt_pk_bf16_f32 v202, v236, v237
    v_mfma_f32_16x16x32_bf16 v[176:179], a[184:187], v[72:75], v[176:179]
    v_exp_f32 v239, v155
    v_or3_b32 v57, v57, v201, v202
    v_mfma_f32_16x16x32_bf16 v[176:179], a[180:183], v[68:71], v[176:179]
    s_cmp_eq_u32 s30, 0
    s_cbranch_scc1 k12_ool_82
k12_oolret_83:
    v_exp_f32 v240, v140
    v_mfma_f32_16x16x32_bf16 v[176:179], a[176:179], v[64:67], v[176:179]
    s_waitcnt vmcnt(8)
    s_barrier
    v_sub_f32 v142, v142, v55
    v_sub_f32 v143, v143, v55
    v_cvt_pk_bf16_f32 v203, v238, v239
    v_exp_f32 v241, v141
    v_exp_f32 v242, v142
    v_sub_f32 v156, v156, v55
    v_sub_f32 v157, v157, v55
    ds_read_b128 a[200:203], v3 offset:2048
    v_cvt_pk_bf16_f32 v204, v240, v241
    v_exp_f32 v243, v143
    v_or3_b32 v57, v57, v203, v204
    v_exp_f32 v244, v156
    v_sub_f32 v158, v158, v55
    v_sub_f32 v159, v159, v55
    v_cvt_pk_bf16_f32 v205, v242, v243
    v_exp_f32 v245, v157
    v_exp_f32 v246, v158
    v_cvt_pk_bf16_f32 v206, v244, v245
    ds_read_b128 a[204:207], v3 offset:3072
    v_exp_f32 v247, v159
    v_or3_b32 v57, v57, v205, v206
    v_cvt_pk_bf16_f32 v207, v246, v247
    v_bitop3_b32 v57, v57, v207, s37 bitop3:0xa8
    v_cmp_ne_u32 vcc, 0, v57
    s_cbranch_vccnz k2_tramp_86
k2_ret_87:
    s_mov_b32 s24, s60
    s_and_b32 s25, s61, 0xffff
    s_mov_b32 s26, s55
    s_lshl_b32 s63, s29, 1
    s_sub_u32 s63, s63, 1
    s_cbranch_scc1 k2_dm3_89
k2_dloop_88:
    v_mfma_f32_16x16x32_bf16 v[12:15], v[60:63], v[192:195], v[12:15]
    v_exp_f32 v232, v160
    v_mfma_f32_16x16x32_bf16 v[48:51], v[60:63], v[196:199], v[48:51]
    s_mov_b32 m0, s34
    ds_read_b128 a[208:211], v3 offset:4096
    v_mfma_f32_16x16x32_bf16 v[248:251], v[60:63], v[200:203], v[248:251]
    s_add_u32 s53, s53, 8192
    buffer_load_dwordx4 v1, s[16:19], s32 offen offset:0 sc1 lds
    v_mfma_f32_16x16x32_bf16 v[252:255], v[60:63], v[204:207], v[252:255]
    s_waitcnt lgkmcnt(3)
    v_exp_f32 v233, v161
    v_mfma_f32_16x16x32_bf16 a[12:15], a[192:195], v[204:207], a[12:15]
    s_and_b32 s53, s53, 0xffff
    v_exp_f32 v234, v162
    v_mfma_f32_16x16x32_bf16 a[8:11], a[192:195], v[200:203], a[8:11]
    s_add_u32 s34, s34, 0x4000
    ds_read_b128 a[212:215], v3 offset:5120
    v_cvt_pk_bf16_f32 v208, v232, v233
    v_mfma_f32_16x16x32_bf16 a[4:7], a[192:195], v[196:199], a[4:7]
    v_exp_f32 v235, v163
    v_mfma_f32_16x16x32_bf16 a[0:3], a[192:195], v[192:195], a[0:3]
    buffer_load_dwordx4 v1, s[16:19], s32 offen offset:1024 sc1 lds
    v_mfma_f32_16x16x32_bf16 a[16:19], a[196:199], v[192:195], a[16:19]
    v_exp_f32 v236, v176
    v_mfma_f32_16x16x32_bf16 a[20:23], a[196:199], v[196:199], a[20:23]
    ds_read_b128 a[216:219], v3 offset:6144
    v_cvt_pk_bf16_f32 v209, v234, v235
    v_mfma_f32_16x16x32_bf16 a[24:27], a[196:199], v[200:203], a[24:27]
    v_exp_f32 v237, v177
    v_mfma_f32_16x16x32_bf16 a[28:31], a[196:199], v[204:207], a[28:31]
    s_waitcnt lgkmcnt(3)
    v_exp_f32 v238, v178
    v_mfma_f32_16x16x32_bf16 a[44:47], a[200:203], v[204:207], a[44:47]
    s_and_b32 s34, s34, 0xffff
    ds_read_b128 a[220:223], v3 offset:7168
    v_cvt_pk_bf16_f32 v210, v236, v237
    v_mfma_f32_16x16x32_bf16 a[40:43], a[200:203], v[200:203], a[40:43]
    s_and_b32 s60, s62, 31
    buffer_load_dwordx4 v1, s[16:19], s32 offen offset:2048 sc1 lds
    v_mfma_f32_16x16x32_bf16 a[36:39], a[200:203], v[196:199], a[36:39]
    v_exp_f32 v239, v179
    v_mfma_f32_16x16x32_bf16 a[32:35], a[200:203], v[192:195], a[32:35]
    s_lshr_b32 s61, s62, 5
    v_or3_b32 v57, v208, v209, v210
    v_add_u32 v3, s53, v56
    v_mfma_f32_16x16x32_bf16 a[48:51], a[204:207], v[192:195], a[48:51]
    v_exp_f32 v240, v164
    v_mfma_f32_16x16x32_bf16 a[52:55], a[204:207], v[196:199], a[52:55]
    ds_read_b128 a[128:131], v2 offset:0
    v_cvt_pk_bf16_f32 v211, v238, v239
    v_mfma_f32_16x16x32_bf16 a[56:59], a[204:207], v[200:203], a[56:59]
    s_mul_i32 s57, s60, 229376
    v_exp_f32 v241, v165
    v_mfma_f32_16x16x32_bf16 a[60:63], a[204:207], v[204:207], a[60:63]
    s_waitcnt lgkmcnt(3)
    buffer_load_dwordx4 v1, s[16:19], s32 offen offset:3072 sc1 lds
    v_mfma_f32_16x16x32_bf16 a[76:79], a[208:211], v[204:207], a[76:79]
    s_add_u32 s32, s32, 0x80000
    v_exp_f32 v242, v166
    v_mfma_f32_16x16x32_bf16 a[72:75], a[208:211], v[200:203], a[72:75]
    s_lshl_b32 s4, s61, 7
    ds_read_b128 a[132:135], v2 offset:1024
    v_cvt_pk_bf16_f32 v212, v240, v241
    v_mfma_f32_16x16x32_bf16 a[68:71], a[208:211], v[196:199], a[68:71]
    v_exp_f32 v243, v167
    v_mfma_f32_16x16x32_bf16 a[64:67], a[208:211], v[192:195], a[64:67]
    s_add_u32 s57, s57, s4
    v_or3_b32 v57, v57, v211, v212
    v_cvt_pk_bf16_f32 v213, v242, v243
    v_mfma_f32_16x16x32_bf16 a[80:83], a[212:215], v[192:195], a[80:83]
    s_waitcnt vmcnt(9)
    v_exp_f32 v244, v180
    v_mfma_f32_16x16x32_bf16 a[84:87], a[212:215], v[196:199], a[84:87]
    buffer_store_dwordx4 a[224:227], v229, s[8:11], s58 offen offset:0 sc1
    ds_read_b128 a[136:139], v2 offset:2048
    v_mfma_f32_16x16x32_bf16 a[88:91], a[212:215], v[200:203], a[88:91]
    s_add_u32 s56, s57, 57344
    v_exp_f32 v245, v181
    v_mfma_f32_16x16x32_bf16 a[92:95], a[212:215], v[204:207], a[92:95]
    s_waitcnt lgkmcnt(3)
    v_exp_f32 v246, v182
    v_mfma_f32_16x16x32_bf16 a[108:111], a[216:219], v[204:207], a[108:111]
    ds_read_b128 a[140:143], v2 offset:3072
    v_cvt_pk_bf16_f32 v214, v244, v245
    v_mfma_f32_16x16x32_bf16 a[104:107], a[216:219], v[200:203], a[104:107]
    s_add_u32 s62, s62, 1
    v_exp_f32 v247, v183
    v_mfma_f32_16x16x32_bf16 a[100:103], a[216:219], v[196:199], a[100:103]
    v_or3_b32 v57, v57, v213, v214
    v_mfma_f32_16x16x32_bf16 a[96:99], a[216:219], v[192:195], a[96:99]
    v_exp_f32 v232, v168
    v_mfma_f32_16x16x32_bf16 a[112:115], a[220:223], v[192:195], a[112:115]
    ds_read_b128 a[144:147], v2 offset:4096
    v_cvt_pk_bf16_f32 v215, v246, v247
    v_mfma_f32_16x16x32_bf16 a[116:119], a[220:223], v[196:199], a[116:119]
    buffer_store_dwordx4 a[228:231], v229, s[8:11], s58 offen offset:256 sc1
    v_mfma_f32_16x16x32_bf16 a[120:123], a[220:223], v[200:203], a[120:123]
    v_exp_f32 v233, v169
    v_mfma_f32_16x16x32_bf16 a[124:127], a[220:223], v[204:207], a[124:127]
    s_waitcnt lgkmcnt(3)
    v_exp_f32 v234, v170
    v_mfma_f32_16x16x32_bf16 v[128:131], a[128:131], v[64:67], v[16:19]
    ds_read_b128 a[148:151], v2 offset:5120
    v_cvt_pk_bf16_f32 v216, v232, v233
    v_mfma_f32_16x16x32_bf16 v[128:131], a[132:135], v[68:71], v[128:131]
    s_waitcnt lgkmcnt(2)
    v_exp_f32 v235, v171
    v_mfma_f32_16x16x32_bf16 v[128:131], a[136:139], v[72:75], v[128:131]
    v_or3_b32 v57, v57, v215, v216
    v_mfma_f32_16x16x32_bf16 v[128:131], a[140:143], v[76:79], v[128:131]
    s_add_u32 s36, s36, 32
    v_exp_f32 v236, v184
    v_mfma_f32_16x16x32_bf16 v[132:135], a[140:143], v[92:95], v[20:23]
    ds_read_b128 a[152:155], v2 offset:6144
    v_cvt_pk_bf16_f32 v217, v234, v235
    v_mfma_f32_16x16x32_bf16 v[132:135], a[136:139], v[88:91], v[132:135]
    s_lshl_b32 s58, s61, 17
    buffer_load_dwordx4 a[224:227], v228, s[12:15], s57 offen nt
    v_mfma_f32_16x16x32_bf16 v[132:135], a[132:135], v[84:87], v[132:135]
    s_add_u32 s52, s52, 8192
    v_exp_f32 v237, v185
    v_mfma_f32_16x16x32_bf16 v[132:135], a[128:131], v[80:83], v[132:135]
    v_exp_f32 v238, v186
    v_mfma_f32_16x16x32_bf16 v[136:139], a[128:131], v[96:99], v[24:27]
    s_lshl_b32 s60, s60, 10
    ds_read_b128 a[156:159], v2 offset:7168
    v_cvt_pk_bf16_f32 v218, v236, v237
    v_mfma_f32_16x16x32_bf16 v[136:139], a[132:135], v[100:103], v[136:139]
    s_and_b32 s52, s52, 0xffff
    v_exp_f32 v239, v187
    v_mfma_f32_16x16x32_bf16 v[136:139], a[136:139], v[104:107], v[136:139]
    v_or3_b32 v57, v57, v217, v218
    v_mfma_f32_16x16x32_bf16 v[136:139], a[140:143], v[108:111], v[136:139]
    v_add_u32 v2, s52, v1
    v_cvt_pk_bf16_f32 v219, v238, v239
    v_mfma_f32_16x16x32_bf16 v[140:143], a[140:143], v[124:127], v[28:31]
    s_add_u32 s58, s58, s60
    v_exp_f32 v240, v172
    v_mfma_f32_16x16x32_bf16 v[140:143], a[136:139], v[120:123], v[140:143]
    buffer_load_dwordx4 a[228:231], v228, s[12:15], s56 offen nt
    v_mfma_f32_16x16x32_bf16 v[140:143], a[132:135], v[116:119], v[140:143]
    v_exp_f32 v241, v173
    v_mfma_f32_16x16x32_bf16 v[140:143], a[128:131], v[112:115], v[140:143]
    s_waitcnt lgkmcnt(2)
    ds_read_b128 a[192:195], v3 offset:0
    v_cvt_pk_bf16_f32 v220, v240, v241
    v_mfma_f32_16x16x32_bf16 v[156:159], a[144:147], v[112:115], v[44:47]
    s_mov_b32 s10, s59
    v_exp_f32 v242, v174
    v_mfma_f32_16x16x32_bf16 v[156:159], a[148:151], v[116:119], v[156:159]
    s_waitcnt lgkmcnt(1)
    v_exp_f32 v243, v175
    v_mfma_f32_16x16x32_bf16 v[156:159], a[152:155], v[120:123], v[156:159]
    ds_read_b128 a[196:199], v3 offset:1024
    v_or3_b32 v57, v57, v219, v220
    v_mfma_f32_16x16x32_bf16 v[156:159], a[156:159], v[124:127], v[156:159]
    v_exp_f32 v244, v188
    v_mfma_f32_16x16x32_bf16 v[152:155], a[156:159], v[108:111], v[40:43]
    v_cvt_pk_bf16_f32 v221, v242, v243
    v_mfma_f32_16x16x32_bf16 v[152:155], a[152:155], v[104:107], v[152:155]
    buffer_load_dword v7, v230, s[24:27], s54 offen
    v_mfma_f32_16x16x32_bf16 v[152:155], a[148:151], v[100:103], v[152:155]
    v_exp_f32 v245, v189
    v_mfma_f32_16x16x32_bf16 v[152:155], a[144:147], v[96:99], v[152:155]
    ds_read_b128 a[200:203], v3 offset:2048
    v_cvt_pk_bf16_f32 v222, v244, v245
    v_mfma_f32_16x16x32_bf16 v[148:151], a[144:147], v[80:83], v[36:39]
    v_exp_f32 v246, v190
    v_mfma_f32_16x16x32_bf16 v[148:151], a[148:151], v[84:87], v[148:151]
    v_exp_f32 v247, v191
    v_mfma_f32_16x16x32_bf16 v[148:151], a[152:155], v[88:91], v[148:151]
    ds_read_b128 a[204:207], v3 offset:3072
    v_or3_b32 v57, v57, v221, v222
    v_mfma_f32_16x16x32_bf16 v[148:151], a[156:159], v[92:95], v[148:151]
    v_cvt_pk_bf16_f32 v223, v246, v247
    v_mfma_f32_16x16x32_bf16 v[144:147], a[156:159], v[76:79], v[32:35]
    s_add_u32 s54, s54, 4096
    v_mfma_f32_16x16x32_bf16 v[144:147], a[152:155], v[72:75], v[144:147]
    v_bitop3_b32 v57, v57, v223, s37 bitop3:0xa8
    v_cmp_ne_u32 vcc, 0, v57
    v_mfma_f32_16x16x32_bf16 v[144:147], a[148:151], v[68:71], v[144:147]
    v_mfma_f32_16x16x32_bf16 v[144:147], a[144:147], v[64:67], v[144:147]
    s_cbranch_vccnz k2_tramp_90
k2_ret_91:
    v_mfma_f32_16x16x32_bf16 v[12:15], v[60:63], v[208:211], v[12:15]
    v_exp_f32 v232, v128
    v_mfma_f32_16x16x32_bf16 v[48:51], v[60:63], v[212:215], v[48:51]
    s_mov_b32 m0, s35
    ds_read_b128 a[208:211], v3 offset:4096
    v_mfma_f32_16x16x32_bf16 v[248:251], v[60:63], v[216:219], v[248:251]
    s_add_u32 s53, s53, 8192
    buffer_load_dwordx4 v1, s[20:23], s33 offen offset:0 sc1 lds
    v_mfma_f32_16x16x32_bf16 v[252:255], v[60:63], v[220:223], v[252:255]
    s_waitcnt lgkmcnt(3)
    v_exp_f32 v233, v129
    v_mfma_f32_16x16x32_bf16 a[12:15], a[192:195], v[220:223], a[12:15]
    s_and_b32 s53, s53, 0xffff
    v_exp_f32 v234, v130
    v_mfma_f32_16x16x32_bf16 a[8:11], a[192:195], v[216:219], a[8:11]
    ds_read_b128 a[212:215], v3 offset:5120
    v_cvt_pk_bf16_f32 v192, v232, v233
    v_mfma_f32_16x16x32_bf16 a[4:7], a[192:195], v[212:215], a[4:7]
    v_exp_f32 v235, v131
    v_mfma_f32_16x16x32_bf16 a[0:3], a[192:195], v[208:211], a[0:3]
    v_exp_f32 v236, v144
    v_mfma_f32_16x16x32_bf16 a[16:19], a[196:199], v[208:211], a[16:19]
    ds_read_b128 a[216:219], v3 offset:6144
    v_cvt_pk_bf16_f32 v193, v234, v235
    v_mfma_f32_16x16x32_bf16 a[20:23], a[196:199], v[212:215], a[20:23]
    v_exp_f32 v237, v145
    v_mfma_f32_16x16x32_bf16 a[24:27], a[196:199], v[216:219], a[24:27]
    v_mfma_f32_16x16x32_bf16 a[28:31], a[196:199], v[220:223], a[28:31]
    s_waitcnt lgkmcnt(3)
    v_exp_f32 v238, v146
    v_mfma_f32_16x16x32_bf16 a[44:47], a[200:203], v[220:223], a[44:47]
    ds_read_b128 a[220:223], v3 offset:7168
    v_cvt_pk_bf16_f32 v194, v236, v237
    v_mfma_f32_16x16x32_bf16 a[40:43], a[200:203], v[216:219], a[40:43]
    v_exp_f32 v239, v147
    v_mfma_f32_16x16x32_bf16 a[36:39], a[200:203], v[212:215], a[36:39]
    v_or3_b32 v57, v192, v193, v194
    v_mfma_f32_16x16x32_bf16 a[32:35], a[200:203], v[208:211], a[32:35]
    s_add_u32 s35, s35, 0x4000
    v_add_u32 v3, s53, v56
    v_cvt_pk_bf16_f32 v195, v238, v239
    v_mfma_f32_16x16x32_bf16 a[48:51], a[204:207], v[208:211], a[48:51]
    v_exp_f32 v240, v132
    v_mfma_f32_16x16x32_bf16 a[52:55], a[204:207], v[212:215], a[52:55]
    buffer_load_dwordx4 v1, s[20:23], s33 offen offset:1024 sc1 lds
    ds_read_b128 a[128:131], v2 offset:0
    v_mfma_f32_16x16x32_bf16 a[56:59], a[204:207], v[216:219], a[56:59]
    v_exp_f32 v241, v133
    v_mfma_f32_16x16x32_bf16 a[60:63], a[204:207], v[220:223], a[60:63]
    s_waitcnt lgkmcnt(3)
    v_exp_f32 v242, v134
    v_mfma_f32_16x16x32_bf16 a[76:79], a[208:211], v[220:223], a[76:79]
    ds_read_b128 a[132:135], v2 offset:1024
    v_cvt_pk_bf16_f32 v196, v240, v241
    v_mfma_f32_16x16x32_bf16 a[72:75], a[208:211], v[216:219], a[72:75]
    v_exp_f32 v243, v135
    v_mfma_f32_16x16x32_bf16 a[68:71], a[208:211], v[212:215], a[68:71]
    v_or3_b32 v57, v57, v195, v196
    v_mfma_f32_16x16x32_bf16 a[64:67], a[208:211], v[208:211], a[64:67]
    v_exp_f32 v244, v148
    v_mfma_f32_16x16x32_bf16 a[80:83], a[212:215], v[208:211], a[80:83]
    ds_read_b128 a[136:139], v2 offset:2048
    v_cvt_pk_bf16_f32 v197, v242, v243
    v_mfma_f32_16x16x32_bf16 a[84:87], a[212:215], v[212:215], a[84:87]
    v_exp_f32 v245, v149
    v_mfma_f32_16x16x32_bf16 a[88:91], a[212:215], v[216:219], a[88:91]
    v_mfma_f32_16x16x32_bf16 a[92:95], a[212:215], v[220:223], a[92:95]
    s_waitcnt lgkmcnt(3)
    v_exp_f32 v246, v150
    v_mfma_f32_16x16x32_bf16 a[108:111], a[216:219], v[220:223], a[108:111]
    ds_read_b128 a[140:143], v2 offset:3072
    v_cvt_pk_bf16_f32 v198, v244, v245
    v_mfma_f32_16x16x32_bf16 a[104:107], a[216:219], v[216:219], a[104:107]
    v_exp_f32 v247, v151
    v_mfma_f32_16x16x32_bf16 a[100:103], a[216:219], v[212:215], a[100:103]
    v_or3_b32 v57, v57, v197, v198
    v_mfma_f32_16x16x32_bf16 a[96:99], a[216:219], v[208:211], a[96:99]
    s_and_b32 s35, s35, 0xffff
    v_exp_f32 v232, v136
    v_mfma_f32_16x16x32_bf16 a[112:115], a[220:223], v[208:211], a[112:115]
    ds_read_b128 a[144:147], v2 offset:4096
    v_cvt_pk_bf16_f32 v199, v246, v247
    v_mfma_f32_16x16x32_bf16 a[116:119], a[220:223], v[212:215], a[116:119]
    buffer_load_dwordx4 v1, s[20:23], s33 offen offset:2048 sc1 lds
    v_mfma_f32_16x16x32_bf16 a[120:123], a[220:223], v[216:219], a[120:123]
    v_exp_f32 v233, v137
    v_mfma_f32_16x16x32_bf16 a[124:127], a[220:223], v[220:223], a[124:127]
    s_waitcnt lgkmcnt(3)
    v_exp_f32 v234, v138
    v_mfma_f32_16x16x32_bf16 v[160:163], a[128:131], v[64:67], v[16:19]
    ds_read_b128 a[148:151], v2 offset:5120
    v_cvt_pk_bf16_f32 v200, v232, v233
    v_mfma_f32_16x16x32_bf16 v[160:163], a[132:135], v[68:71], v[160:163]
    s_waitcnt lgkmcnt(2)
    v_exp_f32 v235, v139
    v_mfma_f32_16x16x32_bf16 v[160:163], a[136:139], v[72:75], v[160:163]
    v_or3_b32 v57, v57, v199, v200
    v_mfma_f32_16x16x32_bf16 v[160:163], a[140:143], v[76:79], v[160:163]
    s_or_b32 s35, s35, 0x10000
    v_exp_f32 v236, v152
    v_mfma_f32_16x16x32_bf16 v[164:167], a[140:143], v[92:95], v[20:23]
    s_add_u32 s36, s36, 32
    ds_read_b128 a[152:155], v2 offset:6144
    v_cvt_pk_bf16_f32 v201, v234, v235
    v_mfma_f32_16x16x32_bf16 v[164:167], a[136:139], v[88:91], v[164:167]
    v_exp_f32 v237, v153
    v_mfma_f32_16x16x32_bf16 v[164:167], a[132:135], v[84:87], v[164:167]
    s_add_u32 s52, s52, 8192
    v_mfma_f32_16x16x32_bf16 v[164:167], a[128:131], v[80:83], v[164:167]
    v_exp_f32 v238, v154
    v_mfma_f32_16x16x32_bf16 v[168:171], a[128:131], v[96:99], v[24:27]
    s_and_b32 s52, s52, 0xffff
    ds_read_b128 a[156:159], v2 offset:7168
    v_cvt_pk_bf16_f32 v202, v236, v237
    v_mfma_f32_16x16x32_bf16 v[168:171], a[132:135], v[100:103], v[168:171]
    v_exp_f32 v239, v155
    v_mfma_f32_16x16x32_bf16 v[168:171], a[136:139], v[104:107], v[168:171]
    v_or3_b32 v57, v57, v201, v202
    v_mfma_f32_16x16x32_bf16 v[168:171], a[140:143], v[108:111], v[168:171]
    v_add_u32 v2, s52, v1
    v_cvt_pk_bf16_f32 v203, v238, v239
    v_mfma_f32_16x16x32_bf16 v[172:175], a[140:143], v[124:127], v[28:31]
    v_exp_f32 v240, v140
    v_mfma_f32_16x16x32_bf16 v[172:175], a[136:139], v[120:123], v[172:175]
    buffer_load_dwordx4 v1, s[20:23], s33 offen offset:3072 sc1 lds
    v_mfma_f32_16x16x32_bf16 v[172:175], a[132:135], v[116:119], v[172:175]
    s_add_u32 s33, s33, 0x80000
    v_exp_f32 v241, v141
    v_mfma_f32_16x16x32_bf16 v[172:175], a[128:131], v[112:115], v[172:175]
    s_waitcnt lgkmcnt(2)
    ds_read_b128 a[192:195], v3 offset:0
    v_cvt_pk_bf16_f32 v204, v240, v241
    v_mfma_f32_16x16x32_bf16 v[188:191], a[144:147], v[112:115], v[44:47]
    v_exp_f32 v242, v142
    v_mfma_f32_16x16x32_bf16 v[188:191], a[148:151], v[116:119], v[188:191]
    s_waitcnt lgkmcnt(1)
    v_exp_f32 v243, v143
    v_mfma_f32_16x16x32_bf16 v[188:191], a[152:155], v[120:123], v[188:191]
    ds_read_b128 a[196:199], v3 offset:1024
    v_or3_b32 v57, v57, v203, v204
    v_mfma_f32_16x16x32_bf16 v[188:191], a[156:159], v[124:127], v[188:191]
    v_exp_f32 v244, v156
    v_mfma_f32_16x16x32_bf16 v[184:187], a[156:159], v[108:111], v[40:43]
    v_cvt_pk_bf16_f32 v205, v242, v243
    v_mfma_f32_16x16x32_bf16 v[184:187], a[152:155], v[104:107], v[184:187]
    v_exp_f32 v245, v157
    v_mfma_f32_16x16x32_bf16 v[184:187], a[148:151], v[100:103], v[184:187]
    ds_read_b128 a[200:203], v3 offset:2048
    v_mfma_f32_16x16x32_bf16 v[184:187], a[144:147], v[96:99], v[184:187]
    s_sub_u32 s63, s63, 1
    v_exp_f32 v246, v158
    v_mfma_f32_16x16x32_bf16 v[180:183], a[144:147], v[80:83], v[36:39]
    v_cvt_pk_bf16_f32 v206, v244, v245
    v_mfma_f32_16x16x32_bf16 v[180:183], a[148:151], v[84:87], v[180:183]
    v_exp_f32 v247, v159
    v_mfma_f32_16x16x32_bf16 v[180:183], a[152:155], v[88:91], v[180:183]
    ds_read_b128 a[204:207], v3 offset:3072
    v_or3_b32 v57, v57, v205, v206
    v_mfma_f32_16x16x32_bf16 v[180:183], a[156:159], v[92:95], v[180:183]
    v_cvt_pk_bf16_f32 v207, v246, v247
    v_mfma_f32_16x16x32_bf16 v[176:179], a[156:159], v[76:79], v[32:35]
    v_mfma_f32_16x16x32_bf16 v[176:179], a[152:155], v[72:75], v[176:179]
    v_bitop3_b32 v57, v57, v207, s37 bitop3:0xa8
    v_cmp_ne_u32 vcc, 0, v57
    v_mfma_f32_16x16x32_bf16 v[176:179], a[148:151], v[68:71], v[176:179]
    v_mfma_f32_16x16x32_bf16 v[176:179], a[144:147], v[64:67], v[176:179]
    s_waitcnt vmcnt(13)
    s_barrier
    s_cbranch_vccnz k2_tramp_92
k2_ret_93:
    s_cmp_lg_u32 s63, 0
    s_cbranch_scc1 k2_dloop_88
    v_mfma_f32_16x16x32_bf16 v[12:15], v[60:63], v[192:195], v[12:15]
    v_exp_f32 v232, v160
    v_mfma_f32_16x16x32_bf16 v[48:51], v[60:63], v[196:199], v[48:51]
    s_mov_b32 m0, s34
    ds_read_b128 a[208:211], v3 offset:4096
    v_mfma_f32_16x16x32_bf16 v[248:251], v[60:63], v[200:203], v[248:251]
    s_add_u32 s53, s53, 8192
    buffer_load_dwordx4 v1, s[16:19], s32 offen offset:0 sc1 lds
    v_mfma_f32_16x16x32_bf16 v[252:255], v[60:63], v[204:207], v[252:255]
    s_waitcnt lgkmcnt(3)
    v_exp_f32 v233, v161
    v_mfma_f32_16x16x32_bf16 a[12:15], a[192:195], v[204:207], a[12:15]
    s_sub_u32 s40, s36, s38
    v_exp_f32 v234, v162
    v_mfma_f32_16x16x32_bf16 a[8:11], a[192:195], v[200:203], a[8:11]
    s_and_b32 s53, s53, 0xffff
    ds_read_b128 a[212:215], v3 offset:5120
    v_cvt_pk_bf16_f32 v208, v232, v233
    v_mfma_f32_16x16x32_bf16 a[4:7], a[192:195], v[196:199], a[4:7]
    s_add_u32 s34, s34, 0x4000
    v_subrev_u32 v6, s40, v4
    v_cmp_gt_i32 s[44:45], 0, v6
    v_mfma_f32_16x16x32_bf16 a[0:3], a[192:195], v[192:195], a[0:3]
    v_exp_f32 v235, v163
    v_mfma_f32_16x16x32_bf16 a[16:19], a[196:199], v[192:195], a[16:19]
    buffer_load_dwordx4 v1, s[16:19], s32 offen offset:1024 sc1 lds
    ds_read_b128 a[216:219], v3 offset:6144
    v_mfma_f32_16x16x32_bf16 a[20:23], a[196:199], v[196:199], a[20:23]
    v_exp_f32 v236, v176
    v_mfma_f32_16x16x32_bf16 a[24:27], a[196:199], v[200:203], a[24:27]
    v_cmp_gt_i32 s[46:47], 1, v6
    v_cvt_pk_bf16_f32 v209, v234, v235
    v_mfma_f32_16x16x32_bf16 a[28:31], a[196:199], v[204:207], a[28:31]
    s_waitcnt lgkmcnt(3)
    v_cmp_gt_i32 s[48:49], 2, v6
    v_cmp_gt_i32 s[50:51], 3, v6
    v_mfma_f32_16x16x32_bf16 a[44:47], a[200:203], v[204:207], a[44:47]
    s_and_b32 s34, s34, 0xffff
    v_exp_f32 v237, v177
    v_mfma_f32_16x16x32_bf16 a[40:43], a[200:203], v[200:203], a[40:43]
    s_and_b32 s60, s62, 31
    v_exp_f32 v238, v178
    v_mfma_f32_16x16x32_bf16 a[36:39], a[200:203], v[196:199], a[36:39]
    ds_read_b128 a[220:223], v3 offset:7168
    v_cvt_pk_bf16_f32 v210, v236, v237
    v_mfma_f32_16x16x32_bf16 a[32:35], a[200:203], v[192:195], a[32:35]
    s_lshr_b32 s61, s62, 5
    buffer_load_dwordx4 v1, s[16:19], s32 offen offset:2048 sc1 lds
    v_mfma_f32_16x16x32_bf16 a[48:51], a[204:207], v[192:195], a[48:51]
    v_cndmask_b32 v16, v8, v5, s[44:45]
    v_or3_b32 v57, v208, v209, v210
    v_mfma_f32_16x16x32_bf16 a[52:55], a[204:207], v[196:199], a[52:55]
    v_exp_f32 v239, v179
    v_mfma_f32_16x16x32_bf16 a[56:59], a[204:207], v[200:203], a[56:59]
    s_mul_i32 s57, s60, 229376
    v_cndmask_b32 v17, v8, v5, s[46:47]
    v_add_u32 v3, s53, v56
    v_mfma_f32_16x16x32_bf16 a[60:63], a[204:207], v[204:207], a[60:63]
    s_waitcnt lgkmcnt(2)
    v_exp_f32 v240, v164
    v_mfma_f32_16x16x32_bf16 a[76:79], a[208:211], v[204:207], a[76:79]
    v_cvt_pk_bf16_f32 v211, v238, v239
    v_cndmask_b32 v18, v8, v5, s[48:49]
    v_mfma_f32_16x16x32_bf16 a[72:75], a[208:211], v[200:203], a[72:75]
    s_lshl_b32 s4, s61, 7
    ds_read_b128 a[128:131], v2 offset:0
    v_cndmask_b32 v19, v8, v5, s[50:51]
    v_mfma_f32_16x16x32_bf16 a[68:71], a[208:211], v[196:199], a[68:71]
    v_exp_f32 v241, v165
    v_mfma_f32_16x16x32_bf16 a[64:67], a[208:211], v[192:195], a[64:67]
    s_add_u32 s57, s57, s4
    buffer_load_dwordx4 v1, s[16:19], s32 offen offset:3072 sc1 lds
    s_add_u32 s32, s32, 0x80000
    v_mfma_f32_16x16x32_bf16 a[80:83], a[212:215], v[192:195], a[80:83]
    s_waitcnt vmcnt(9)
    v_cmp_gt_i32 s[44:45], 16, v6
    v_exp_f32 v242, v166
    v_mfma_f32_16x16x32_bf16 a[84:87], a[212:215], v[196:199], a[84:87]
    ds_read_b128 a[132:135], v2 offset:1024
    v_cvt_pk_bf16_f32 v212, v240, v241
    v_mfma_f32_16x16x32_bf16 a[88:91], a[212:215], v[200:203], a[88:91]
    s_add_u32 s56, s57, 57344
    v_cmp_gt_i32 s[46:47], 17, v6
    v_exp_f32 v243, v167
    v_mfma_f32_16x16x32_bf16 a[92:95], a[212:215], v[204:207], a[92:95]
    s_waitcnt lgkmcnt(2)
    v_or3_b32 v57, v57, v211, v212
    v_cmp_gt_i32 s[48:49], 18, v6
    v_mfma_f32_16x16x32_bf16 a[108:111], a[216:219], v[204:207], a[108:111]
    v_exp_f32 v244, v180
    v_mfma_f32_16x16x32_bf16 a[104:107], a[216:219], v[200:203], a[104:107]
    s_add_u32 s62, s62, 1
    v_cvt_pk_bf16_f32 v213, v242, v243
    v_cmp_gt_i32 s[50:51], 19, v6
    v_mfma_f32_16x16x32_bf16 a[100:103], a[216:219], v[196:199], a[100:103]
    buffer_store_dwordx4 a[224:227], v229, s[8:11], s58 offen offset:0 sc1
    ds_read_b128 a[136:139], v2 offset:2048
    v_mfma_f32_16x16x32_bf16 a[96:99], a[216:219], v[192:195], a[96:99]
    v_exp_f32 v245, v181
    v_mfma_f32_16x16x32_bf16 a[112:115], a[220:223], v[192:195], a[112:115]
    v_cndmask_b32 v32, v8, v5, s[44:45]
    v_exp_f32 v246, v182
    v_mfma_f32_16x16x32_bf16 a[116:119], a[220:223], v[196:199], a[116:119]
    ds_read_b128 a[140:143], v2 offset:3072
    v_cndmask_b32 v33, v8, v5, s[46:47]
    v_cvt_pk_bf16_f32 v214, v244, v245
    v_cndmask_b32 v34, v8, v5, s[48:49]
    v_cndmask_b32 v35, v8, v5, s[50:51]
    v_mfma_f32_16x16x32_bf16 a[120:123], a[220:223], v[200:203], a[120:123]
    v_exp_f32 v247, v183
    v_mfma_f32_16x16x32_bf16 a[124:127], a[220:223], v[204:207], a[124:127]
    s_waitcnt lgkmcnt(2)
    v_or3_b32 v57, v57, v213, v214
    v_cvt_pk_bf16_f32 v215, v246, v247
    v_mfma_f32_16x16x32_bf16 v[128:131], a[128:131], v[64:67], v[16:19]
    v_exp_f32 v232, v168
    v_mfma_f32_16x16x32_bf16 v[128:131], a[132:135], v[68:71], v[128:131]
    s_waitcnt lgkmcnt(0)
    buffer_store_dwordx4 a[228:231], v229, s[8:11], s58 offen offset:256 sc1
    ds_read_b128 a[144:147], v2 offset:4096
    v_mfma_f32_16x16x32_bf16 v[128:131], a[136:139], v[72:75], v[128:131]
    v_exp_f32 v233, v169
    v_mfma_f32_16x16x32_bf16 v[128:131], a[140:143], v[76:79], v[128:131]
    s_add_u32 s36, s36, 32
    v_exp_f32 v234, v170
    v_mfma_f32_16x16x32_bf16 v[132:135], a[140:143], v[92:95], v[20:23]
    ds_read_b128 a[148:151], v2 offset:5120
    v_cvt_pk_bf16_f32 v216, v232, v233
    v_mfma_f32_16x16x32_bf16 v[132:135], a[136:139], v[88:91], v[132:135]
    s_lshl_b32 s58, s61, 17
    v_exp_f32 v235, v171
    v_mfma_f32_16x16x32_bf16 v[132:135], a[132:135], v[84:87], v[132:135]
    s_add_u32 s52, s52, 8192
    v_or3_b32 v57, v57, v215, v216
    v_cvt_pk_bf16_f32 v217, v234, v235
    v_mfma_f32_16x16x32_bf16 v[132:135], a[128:131], v[80:83], v[132:135]
    v_exp_f32 v236, v184
    v_mfma_f32_16x16x32_bf16 v[136:139], a[128:131], v[96:99], v[24:27]
    s_lshl_b32 s60, s60, 10
    buffer_load_dwordx4 a[224:227], v228, s[12:15], s57 offen nt
    ds_read_b128 a[152:155], v2 offset:6144
    v_mfma_f32_16x16x32_bf16 v[136:139], a[132:135], v[100:103], v[136:139]
    s_and_b32 s52, s52, 0xffff
    v_exp_f32 v237, v185
    v_mfma_f32_16x16x32_bf16 v[136:139], a[136:139], v[104:107], v[136:139]
    v_exp_f32 v238, v186
    v_mfma_f32_16x16x32_bf16 v[136:139], a[140:143], v[108:111], v[136:139]
    ds_read_b128 a[156:159], v2 offset:7168
    v_cvt_pk_bf16_f32 v218, v236, v237
    v_mfma_f32_16x16x32_bf16 v[140:143], a[140:143], v[124:127], v[28:31]
    s_add_u32 s58, s58, s60
    v_exp_f32 v239, v187
    v_mfma_f32_16x16x32_bf16 v[140:143], a[136:139], v[120:123], v[140:143]
    v_or3_b32 v57, v57, v217, v218
    v_add_u32 v2, s52, v1
    v_mfma_f32_16x16x32_bf16 v[140:143], a[132:135], v[116:119], v[140:143]
    v_exp_f32 v240, v172
    v_mfma_f32_16x16x32_bf16 v[140:143], a[128:131], v[112:115], v[140:143]
    s_waitcnt lgkmcnt(2)
    ds_read_b128 a[192:195], v3 offset:0
    v_cvt_pk_bf16_f32 v219, v238, v239
    v_mfma_f32_16x16x32_bf16 v[156:159], a[144:147], v[112:115], v[44:47]
    s_mov_b32 s10, s59
    buffer_load_dwordx4 a[228:231], v228, s[12:15], s56 offen nt
    v_mfma_f32_16x16x32_bf16 v[156:159], a[148:151], v[116:119], v[156:159]
    s_waitcnt lgkmcnt(1)
    v_exp_f32 v241, v173
    v_mfma_f32_16x16x32_bf16 v[156:159], a[152:155], v[120:123], v[156:159]
    v_exp_f32 v242, v174
    v_mfma_f32_16x16x32_bf16 v[156:159], a[156:159], v[124:127], v[156:159]
    v_cvt_pk_bf16_f32 v220, v240, v241
    v_or3_b32 v57, v57, v219, v220
    v_mfma_f32_16x16x32_bf16 v[152:155], a[156:159], v[108:111], v[40:43]
    v_exp_f32 v243, v175
    v_mfma_f32_16x16x32_bf16 v[152:155], a[152:155], v[104:107], v[152:155]
    ds_read_b128 a[196:199], v3 offset:1024
    v_cvt_pk_bf16_f32 v221, v242, v243
    v_mfma_f32_16x16x32_bf16 v[152:155], a[148:151], v[100:103], v[152:155]
    v_exp_f32 v244, v188
    v_mfma_f32_16x16x32_bf16 v[152:155], a[144:147], v[96:99], v[152:155]
    buffer_load_dword v7, v230, s[24:27], s54 offen
    ds_read_b128 a[200:203], v3 offset:2048
    v_mfma_f32_16x16x32_bf16 v[148:151], a[144:147], v[80:83], v[36:39]
    v_exp_f32 v245, v189
    v_mfma_f32_16x16x32_bf16 v[148:151], a[148:151], v[84:87], v[148:151]
    v_exp_f32 v246, v190
    v_mfma_f32_16x16x32_bf16 v[148:151], a[152:155], v[88:91], v[148:151]
    v_cvt_pk_bf16_f32 v222, v244, v245
    v_or3_b32 v57, v57, v221, v222
    v_mfma_f32_16x16x32_bf16 v[148:151], a[156:159], v[92:95], v[148:151]
    v_exp_f32 v247, v191
    v_mfma_f32_16x16x32_bf16 v[144:147], a[156:159], v[76:79], v[32:35]
    s_add_u32 s54, s54, 4096
    ds_read_b128 a[204:207], v3 offset:3072
    v_cvt_pk_bf16_f32 v223, v246, v247
    v_mfma_f32_16x16x32_bf16 v[144:147], a[152:155], v[72:75], v[144:147]
    v_bitop3_b32 v57, v57, v223, s37 bitop3:0xa8
    v_cmp_ne_u32 vcc, 0, v57
    v_mfma_f32_16x16x32_bf16 v[144:147], a[148:151], v[68:71], v[144:147]
    v_mfma_f32_16x16x32_bf16 v[144:147], a[144:147], v[64:67], v[144:147]
    s_cbranch_vccnz k2_tramp_94
k2_ret_95:
    v_mfma_f32_16x16x32_bf16 v[12:15], v[60:63], v[208:211], v[12:15]
    v_exp_f32 v232, v128
    v_mfma_f32_16x16x32_bf16 v[48:51], v[60:63], v[212:215], v[48:51]
    s_mov_b32 m0, s35
    ds_read_b128 a[208:211], v3 offset:4096
    v_mfma_f32_16x16x32_bf16 v[248:251], v[60:63], v[216:219], v[248:251]
    s_add_u32 s53, s53, 8192
    buffer_load_dwordx4 v1, s[20:23], s33 offen offset:0 sc1 lds
    v_mfma_f32_16x16x32_bf16 v[252:255], v[60:63], v[220:223], v[252:255]
    s_waitcnt lgkmcnt(3)
    v_exp_f32 v233, v129
    v_mfma_f32_16x16x32_bf16 a[12:15], a[192:195], v[220:223], a[12:15]
    s_sub_u32 s40, s36, s38
    v_exp_f32 v234, v130
    v_mfma_f32_16x16x32_bf16 a[8:11], a[192:195], v[216:219], a[8:11]
    s_and_b32 s53, s53, 0xffff
    ds_read_b128 a[212:215], v3 offset:5120
    v_cvt_pk_bf16_f32 v192, v232, v233
    v_mfma_f32_16x16x32_bf16 a[4:7], a[192:195], v[212:215], a[4:7]
    v_subrev_u32 v6, s40, v4
    v_cmp_gt_i32 s[44:45], 0, v6
    v_mfma_f32_16x16x32_bf16 a[0:3], a[192:195], v[208:211], a[0:3]
    v_exp_f32 v235, v131
    v_mfma_f32_16x16x32_bf16 a[16:19], a[196:199], v[208:211], a[16:19]
    v_exp_f32 v236, v144
    v_mfma_f32_16x16x32_bf16 a[20:23], a[196:199], v[212:215], a[20:23]
    v_cmp_gt_i32 s[46:47], 1, v6
    v_cvt_pk_bf16_f32 v193, v234, v235
    v_mfma_f32_16x16x32_bf16 a[24:27], a[196:199], v[216:219], a[24:27]
    ds_read_b128 a[216:219], v3 offset:6144
    v_cmp_gt_i32 s[48:49], 2, v6
    v_mfma_f32_16x16x32_bf16 a[28:31], a[196:199], v[220:223], a[28:31]
    s_waitcnt lgkmcnt(3)
    v_exp_f32 v237, v145
    v_mfma_f32_16x16x32_bf16 a[44:47], a[200:203], v[220:223], a[44:47]
    v_cmp_gt_i32 s[50:51], 3, v6
    v_cvt_pk_bf16_f32 v194, v236, v237
    v_mfma_f32_16x16x32_bf16 a[40:43], a[200:203], v[216:219], a[40:43]
    v_exp_f32 v238, v146
    v_mfma_f32_16x16x32_bf16 a[36:39], a[200:203], v[212:215], a[36:39]
    ds_read_b128 a[220:223], v3 offset:7168
    v_cndmask_b32 v16, v8, v5, s[44:45]
    v_mfma_f32_16x16x32_bf16 a[32:35], a[200:203], v[208:211], a[32:35]
    s_add_u32 s35, s35, 0x4000
    v_exp_f32 v239, v147
    v_mfma_f32_16x16x32_bf16 a[48:51], a[204:207], v[208:211], a[48:51]
    v_or3_b32 v57, v192, v193, v194
    v_cndmask_b32 v17, v8, v5, s[46:47]
    v_mfma_f32_16x16x32_bf16 a[52:55], a[204:207], v[212:215], a[52:55]
    v_add_u32 v3, s53, v56
    v_cvt_pk_bf16_f32 v195, v238, v239
    v_mfma_f32_16x16x32_bf16 a[56:59], a[204:207], v[216:219], a[56:59]
    v_exp_f32 v240, v132
    v_mfma_f32_16x16x32_bf16 a[60:63], a[204:207], v[220:223], a[60:63]
    s_waitcnt lgkmcnt(2)
    ds_read_b128 a[128:131], v2 offset:0
    v_cndmask_b32 v18, v8, v5, s[48:49]
    v_mfma_f32_16x16x32_bf16 a[76:79], a[208:211], v[220:223], a[76:79]
    buffer_load_dwordx4 v1, s[20:23], s33 offen offset:1024 sc1 lds
    ds_read_b128 a[132:135], v2 offset:1024
    v_mfma_f32_16x16x32_bf16 a[72:75], a[208:211], v[216:219], a[72:75]
    v_exp_f32 v241, v133
    v_mfma_f32_16x16x32_bf16 a[68:71], a[208:211], v[212:215], a[68:71]
    v_cndmask_b32 v19, v8, v5, s[50:51]
    v_cmp_gt_i32 s[44:45], 16, v6
    v_mfma_f32_16x16x32_bf16 a[64:67], a[208:211], v[208:211], a[64:67]
    v_exp_f32 v242, v134
    v_mfma_f32_16x16x32_bf16 a[80:83], a[212:215], v[208:211], a[80:83]
    v_cvt_pk_bf16_f32 v196, v240, v241
    v_cmp_gt_i32 s[46:47], 17, v6
    v_mfma_f32_16x16x32_bf16 a[84:87], a[212:215], v[212:215], a[84:87]
    v_exp_f32 v243, v135
    v_mfma_f32_16x16x32_bf16 a[88:91], a[212:215], v[216:219], a[88:91]
    v_or3_b32 v57, v57, v195, v196
    v_cmp_gt_i32 s[48:49], 18, v6
    v_mfma_f32_16x16x32_bf16 a[92:95], a[212:215], v[220:223], a[92:95]
    s_waitcnt lgkmcnt(2)
    v_exp_f32 v244, v148
    v_mfma_f32_16x16x32_bf16 a[108:111], a[216:219], v[220:223], a[108:111]
    v_cvt_pk_bf16_f32 v197, v242, v243
    v_cmp_gt_i32 s[50:51], 19, v6
    v_mfma_f32_16x16x32_bf16 a[104:107], a[216:219], v[216:219], a[104:107]
    ds_read_b128 a[136:139], v2 offset:2048
    v_cndmask_b32 v32, v8, v5, s[44:45]
    v_mfma_f32_16x16x32_bf16 a[100:103], a[216:219], v[212:215], a[100:103]
    v_exp_f32 v245, v149
    v_mfma_f32_16x16x32_bf16 a[96:99], a[216:219], v[208:211], a[96:99]
    s_and_b32 s35, s35, 0xffff
    v_exp_f32 v246, v150
    v_mfma_f32_16x16x32_bf16 a[112:115], a[220:223], v[208:211], a[112:115]
    v_cndmask_b32 v33, v8, v5, s[46:47]
    v_cvt_pk_bf16_f32 v198, v244, v245
    v_mfma_f32_16x16x32_bf16 a[116:119], a[220:223], v[212:215], a[116:119]
    ds_read_b128 a[140:143], v2 offset:3072
    v_cndmask_b32 v34, v8, v5, s[48:49]
    v_cndmask_b32 v35, v8, v5, s[50:51]
    v_mfma_f32_16x16x32_bf16 a[120:123], a[220:223], v[216:219], a[120:123]
    v_exp_f32 v247, v151
    v_mfma_f32_16x16x32_bf16 a[124:127], a[220:223], v[220:223], a[124:127]
    s_waitcnt lgkmcnt(2)
    v_or3_b32 v57, v57, v197, v198
    v_cvt_pk_bf16_f32 v199, v246, v247
    v_mfma_f32_16x16x32_bf16 v[160:163], a[128:131], v[64:67], v[16:19]
    v_exp_f32 v232, v136
    v_mfma_f32_16x16x32_bf16 v[160:163], a[132:135], v[68:71], v[160:163]
    s_waitcnt lgkmcnt(0)
    buffer_load_dwordx4 v1, s[20:23], s33 offen offset:2048 sc1 lds
    ds_read_b128 a[144:147], v2 offset:4096
    v_mfma_f32_16x16x32_bf16 v[160:163], a[136:139], v[72:75], v[160:163]
    v_exp_f32 v233, v137
    v_mfma_f32_16x16x32_bf16 v[160:163], a[140:143], v[76:79], v[160:163]
    s_or_b32 s35, s35, 0x10000
    v_exp_f32 v234, v138
    v_mfma_f32_16x16x32_bf16 v[164:167], a[140:143], v[92:95], v[20:23]
    s_add_u32 s36, s36, 32
    ds_read_b128 a[148:151], v2 offset:5120
    v_cvt_pk_bf16_f32 v200, v232, v233
    v_mfma_f32_16x16x32_bf16 v[164:167], a[136:139], v[88:91], v[164:167]
    v_exp_f32 v235, v139
    v_mfma_f32_16x16x32_bf16 v[164:167], a[132:135], v[84:87], v[164:167]
    s_add_u32 s52, s52, 8192
    v_or3_b32 v57, v57, v199, v200
    v_cvt_pk_bf16_f32 v201, v234, v235
    v_mfma_f32_16x16x32_bf16 v[164:167], a[128:131], v[80:83], v[164:167]
    v_exp_f32 v236, v152
    v_mfma_f32_16x16x32_bf16 v[168:171], a[128:131], v[96:99], v[24:27]
    s_and_b32 s52, s52, 0xffff
    ds_read_b128 a[152:155], v2 offset:6144
    ds_read_b128 a[156:159], v2 offset:7168
    v_mfma_f32_16x16x32_bf16 v[168:171], a[132:135], v[100:103], v[168:171]
    v_exp_f32 v237, v153
    v_mfma_f32_16x16x32_bf16 v[168:171], a[136:139], v[104:107], v[168:171]
    v_exp_f32 v238, v154
    v_mfma_f32_16x16x32_bf16 v[168:171], a[140:143], v[108:111], v[168:171]
    v_cvt_pk_bf16_f32 v202, v236, v237
    v_or3_b32 v57, v57, v201, v202
    v_mfma_f32_16x16x32_bf16 v[172:175], a[140:143], v[124:127], v[28:31]
    v_exp_f32 v239, v155
    v_mfma_f32_16x16x32_bf16 v[172:175], a[136:139], v[120:123], v[172:175]
    v_add_u32 v2, s52, v1
    v_cvt_pk_bf16_f32 v203, v238, v239
    v_mfma_f32_16x16x32_bf16 v[172:175], a[132:135], v[116:119], v[172:175]
    v_exp_f32 v240, v140
    v_mfma_f32_16x16x32_bf16 v[172:175], a[128:131], v[112:115], v[172:175]
    s_waitcnt lgkmcnt(2)
    buffer_load_dwordx4 v1, s[20:23], s33 offen offset:3072 sc1 lds
    s_add_u32 s33, s33, 0x80000
    v_mfma_f32_16x16x32_bf16 v[188:191], a[144:147], v[112:115], v[44:47]
    v_exp_f32 v241, v141
    v_mfma_f32_16x16x32_bf16 v[188:191], a[148:151], v[116:119], v[188:191]
    s_waitcnt lgkmcnt(0)
    ds_read_b128 a[192:195], v3 offset:0
    v_cvt_pk_bf16_f32 v204, v240, v241
    v_mfma_f32_16x16x32_bf16 v[188:191], a[152:155], v[120:123], v[188:191]
    v_exp_f32 v242, v142
    v_mfma_f32_16x16x32_bf16 v[188:191], a[156:159], v[124:127], v[188:191]
    v_exp_f32 v243, v143
    v_mfma_f32_16x16x32_bf16 v[184:187], a[156:159], v[108:111], v[40:43]
    ds_read_b128 a[196:199], v3 offset:1024
    v_or3_b32 v57, v57, v203, v204
    v_mfma_f32_16x16x32_bf16 v[184:187], a[152:155], v[104:107], v[184:187]
    v_exp_f32 v244, v156
    v_mfma_f32_16x16x32_bf16 v[184:187], a[148:151], v[100:103], v[184:187]
    ds_read_b128 a[200:203], v3 offset:2048
    v_cvt_pk_bf16_f32 v205, v242, v243
    v_mfma_f32_16x16x32_bf16 v[184:187], a[144:147], v[96:99], v[184:187]
    v_exp_f32 v245, v157
    v_mfma_f32_16x16x32_bf16 v[180:183], a[144:147], v[80:83], v[36:39]
    v_exp_f32 v246, v158
    v_mfma_f32_16x16x32_bf16 v[180:183], a[148:151], v[84:87], v[180:183]
    v_cvt_pk_bf16_f32 v206, v244, v245
    v_or3_b32 v57, v57, v205, v206
    v_mfma_f32_16x16x32_bf16 v[180:183], a[152:155], v[88:91], v[180:183]
    v_exp_f32 v247, v159
    v_mfma_f32_16x16x32_bf16 v[180:183], a[156:159], v[92:95], v[180:183]
    ds_read_b128 a[204:207], v3 offset:3072
    v_cvt_pk_bf16_f32 v207, v246, v247
    v_mfma_f32_16x16x32_bf16 v[176:179], a[156:159], v[76:79], v[32:35]
    v_mfma_f32_16x16x32_bf16 v[176:179], a[152:155], v[72:75], v[176:179]
    v_bitop3_b32 v57, v57, v207, s37 bitop3:0xa8
    v_cmp_ne_u32 vcc, 0, v57
    v_mfma_f32_16x16x32_bf16 v[176:179], a[148:151], v[68:71], v[176:179]
    v_mfma_f32_16x16x32_bf16 v[176:179], a[144:147], v[64:67], v[176:179]
    s_waitcnt vmcnt(13)
    s_barrier
    s_cbranch_vccnz k2_tramp_96
k2_ret_97:
k2_dm3_89:
    v_mfma_f32_16x16x32_bf16 v[12:15], v[60:63], v[192:195], v[12:15]
    v_exp_f32 v232, v160
    v_mfma_f32_16x16x32_bf16 v[48:51], v[60:63], v[196:199], v[48:51]
    s_mov_b32 m0, s34
    ds_read_b128 a[208:211], v3 offset:4096
    v_mfma_f32_16x16x32_bf16 v[248:251], v[60:63], v[200:203], v[248:251]
    s_add_u32 s53, s53, 8192
    v_exp_f32 v233, v161
    v_mfma_f32_16x16x32_bf16 v[252:255], v[60:63], v[204:207], v[252:255]
    s_waitcnt lgkmcnt(3)
    buffer_load_dwordx4 v1, s[16:19], s32 offen offset:0 sc1 lds
    v_mfma_f32_16x16x32_bf16 a[12:15], a[192:195], v[204:207], a[12:15]
    s_sub_u32 s40, s36, s38
    s_sub_u32 s40, s40, 64
    v_exp_f32 v234, v162
    v_cvt_pk_bf16_f32 v208, v232, v233
    v_mfma_f32_16x16x32_bf16 a[8:11], a[192:195], v[200:203], a[8:11]
    s_and_b32 s53, s53, 0xffff
    ds_read_b128 a[212:215], v3 offset:5120
    v_subrev_u32 v6, s40, v4
    v_mfma_f32_16x16x32_bf16 a[4:7], a[192:195], v[196:199], a[4:7]
    s_add_u32 s34, s34, 0x4000
    v_exp_f32 v235, v163
    v_cmp_gt_i32 s[44:45], 0, v6
    v_mfma_f32_16x16x32_bf16 a[0:3], a[192:195], v[192:195], a[0:3]
    v_exp_f32 v236, v176
    v_cvt_pk_bf16_f32 v209, v234, v235
    v_mfma_f32_16x16x32_bf16 a[16:19], a[196:199], v[192:195], a[16:19]
    buffer_load_dwordx4 v1, s[16:19], s32 offen offset:1024 sc1 lds
    ds_read_b128 a[216:219], v3 offset:6144
    v_mfma_f32_16x16x32_bf16 a[20:23], a[196:199], v[196:199], a[20:23]
    v_cmp_gt_i32 s[46:47], 1, v6
    v_exp_f32 v237, v177
    v_mfma_f32_16x16x32_bf16 a[24:27], a[196:199], v[200:203], a[24:27]
    v_cmp_gt_i32 s[48:49], 2, v6
    v_exp_f32 v238, v178
    v_mfma_f32_16x16x32_bf16 a[28:31], a[196:199], v[204:207], a[28:31]
    s_waitcnt lgkmcnt(3)
    v_cvt_pk_bf16_f32 v210, v236, v237
    v_cmp_gt_i32 s[50:51], 3, v6
    v_mfma_f32_16x16x32_bf16 a[44:47], a[200:203], v[204:207], a[44:47]
    s_and_b32 s34, s34, 0xffff
    v_exp_f32 v239, v179
    v_mfma_f32_16x16x32_bf16 a[40:43], a[200:203], v[200:203], a[40:43]
    s_and_b32 s60, s62, 31
    ds_read_b128 a[220:223], v3 offset:7168
    v_or3_b32 v57, v208, v209, v210
    v_cndmask_b32 v20, v9, v5, s[44:45]
    v_mfma_f32_16x16x32_bf16 a[36:39], a[200:203], v[196:199], a[36:39]
    buffer_load_dwordx4 v1, s[16:19], s32 offen offset:2048 sc1 lds
    v_mfma_f32_16x16x32_bf16 a[32:35], a[200:203], v[192:195], a[32:35]
    s_lshr_b32 s61, s62, 5
    v_exp_f32 v240, v164
    v_cvt_pk_bf16_f32 v211, v238, v239
    v_mfma_f32_16x16x32_bf16 a[48:51], a[204:207], v[192:195], a[48:51]
    v_cndmask_b32 v21, v9, v5, s[46:47]
    v_add_u32 v3, s53, v56
    v_mfma_f32_16x16x32_bf16 a[52:55], a[204:207], v[196:199], a[52:55]
    s_mul_i32 s57, s60, 229376
    v_exp_f32 v241, v165
    v_mfma_f32_16x16x32_bf16 a[56:59], a[204:207], v[200:203], a[56:59]
    ds_read_b128 a[128:131], v2 offset:0
    v_cndmask_b32 v22, v9, v5, s[48:49]
    v_cvt_pk_bf16_f32 v212, v240, v241
    v_mfma_f32_16x16x32_bf16 a[60:63], a[204:207], v[204:207], a[60:63]
    s_waitcnt lgkmcnt(3)
    v_exp_f32 v242, v166
    v_mfma_f32_16x16x32_bf16 a[76:79], a[208:211], v[204:207], a[76:79]
    s_lshl_b32 s4, s61, 7
    v_cndmask_b32 v23, v9, v5, s[50:51]
    v_or3_b32 v57, v57, v211, v212
    v_mfma_f32_16x16x32_bf16 a[72:75], a[208:211], v[200:203], a[72:75]
    buffer_load_dwordx4 v1, s[16:19], s32 offen offset:3072 sc1 lds
    ds_read_b128 a[132:135], v2 offset:1024
    s_add_u32 s32, s32, 0x80000
    v_mfma_f32_16x16x32_bf16 a[68:71], a[208:211], v[196:199], a[68:71]
    v_exp_f32 v243, v167
    v_mfma_f32_16x16x32_bf16 a[64:67], a[208:211], v[192:195], a[64:67]
    s_add_u32 s57, s57, s4
    v_cmp_gt_i32 s[44:45], 16, v6
    v_cvt_pk_bf16_f32 v213, v242, v243
    v_mfma_f32_16x16x32_bf16 a[80:83], a[212:215], v[192:195], a[80:83]
    s_waitcnt vmcnt(9)
    v_exp_f32 v244, v180
    v_mfma_f32_16x16x32_bf16 a[84:87], a[212:215], v[196:199], a[84:87]
    s_add_u32 s56, s57, 57344
    ds_read_b128 a[136:139], v2 offset:2048
    v_cmp_gt_i32 s[46:47], 17, v6
    v_mfma_f32_16x16x32_bf16 a[88:91], a[212:215], v[200:203], a[88:91]
    v_exp_f32 v245, v181
    v_cmp_gt_i32 s[48:49], 18, v6
    v_mfma_f32_16x16x32_bf16 a[92:95], a[212:215], v[204:207], a[92:95]
    s_waitcnt lgkmcnt(3)
    v_exp_f32 v246, v182
    v_mfma_f32_16x16x32_bf16 a[108:111], a[216:219], v[204:207], a[108:111]
    s_add_u32 s62, s62, 1
    v_cmp_gt_i32 s[50:51], 19, v6
    v_cvt_pk_bf16_f32 v214, v244, v245
    v_mfma_f32_16x16x32_bf16 a[104:107], a[216:219], v[200:203], a[104:107]
    buffer_store_dwordx4 a[224:227], v229, s[8:11], s58 offen offset:0 sc1
    ds_read_b128 a[140:143], v2 offset:3072
    ds_read_b128 a[144:147], v2 offset:4096
    v_mfma_f32_16x16x32_bf16 a[100:103], a[216:219], v[196:199], a[100:103]
    v_exp_f32 v247, v183
    v_mfma_f32_16x16x32_bf16 a[96:99], a[216:219], v[192:195], a[96:99]
    v_cndmask_b32 v36, v9, v5, s[44:45]
    v_or3_b32 v57, v57, v213, v214
    v_mfma_f32_16x16x32_bf16 a[112:115], a[220:223], v[192:195], a[112:115]
    v_exp_f32 v232, v168
    v_mfma_f32_16x16x32_bf16 a[116:119], a[220:223], v[196:199], a[116:119]
    v_cndmask_b32 v37, v9, v5, s[46:47]
    v_cvt_pk_bf16_f32 v215, v246, v247
    v_cndmask_b32 v38, v9, v5, s[48:49]
    v_cndmask_b32 v39, v9, v5, s[50:51]
    v_mfma_f32_16x16x32_bf16 a[120:123], a[220:223], v[200:203], a[120:123]
    v_exp_f32 v233, v169
    v_mfma_f32_16x16x32_bf16 a[124:127], a[220:223], v[204:207], a[124:127]
    s_waitcnt lgkmcnt(3)
    buffer_store_dwordx4 a[228:231], v229, s[8:11], s58 offen offset:256 sc1
    v_exp_f32 v234, v170
    v_mfma_f32_16x16x32_bf16 v[132:135], a[128:131], v[80:83], v[20:23]
    ds_read_b128 a[148:151], v2 offset:5120
    v_cvt_pk_bf16_f32 v216, v232, v233
    v_mfma_f32_16x16x32_bf16 v[132:135], a[132:135], v[84:87], v[132:135]
    s_waitcnt lgkmcnt(2)
    v_exp_f32 v235, v171
    v_mfma_f32_16x16x32_bf16 v[132:135], a[136:139], v[88:91], v[132:135]
    s_lshl_b32 s58, s61, 17
    ds_read_b128 a[152:155], v2 offset:6144
    v_or3_b32 v57, v57, v215, v216
    v_mfma_f32_16x16x32_bf16 v[132:135], a[140:143], v[92:95], v[132:135]
    s_add_u32 s36, s36, 32
    v_exp_f32 v236, v184
    v_mfma_f32_16x16x32_bf16 v[136:139], a[140:143], v[108:111], v[24:27]
    s_lshl_b32 s60, s60, 10
    v_cvt_pk_bf16_f32 v217, v234, v235
    v_exp_f32 v237, v185
    v_mfma_f32_16x16x32_bf16 v[136:139], a[136:139], v[104:107], v[136:139]
    buffer_load_dwordx4 a[224:227], v228, s[12:15], s57 offen nt
    ds_read_b128 a[156:159], v2 offset:7168
    v_mfma_f32_16x16x32_bf16 v[136:139], a[132:135], v[100:103], v[136:139]
    s_add_u32 s52, s52, 8192
    v_exp_f32 v238, v186
    v_mfma_f32_16x16x32_bf16 v[136:139], a[128:131], v[96:99], v[136:139]
    s_add_u32 s58, s58, s60
    v_cvt_pk_bf16_f32 v218, v236, v237
    v_or3_b32 v57, v57, v217, v218
    v_mfma_f32_16x16x32_bf16 v[140:143], a[128:131], v[112:115], v[28:31]
    s_and_b32 s52, s52, 0xffff
    v_exp_f32 v239, v187
    v_mfma_f32_16x16x32_bf16 v[140:143], a[132:135], v[116:119], v[140:143]
    v_add_u32 v2, s52, v1
    v_cvt_pk_bf16_f32 v219, v238, v239
    v_mfma_f32_16x16x32_bf16 v[140:143], a[136:139], v[120:123], v[140:143]
    s_mov_b32 s10, s59
    v_exp_f32 v240, v172
    v_mfma_f32_16x16x32_bf16 v[140:143], a[140:143], v[124:127], v[140:143]
    s_waitcnt lgkmcnt(2)
    ds_read_b128 a[192:195], v3 offset:0
    s_waitcnt lgkmcnt(1)
    v_mfma_f32_16x16x32_bf16 v[156:159], a[156:159], v[124:127], v[44:47]
    v_exp_f32 v241, v173
    v_mfma_f32_16x16x32_bf16 v[156:159], a[152:155], v[120:123], v[156:159]
    buffer_load_dwordx4 a[228:231], v228, s[12:15], s56 offen nt
    v_exp_f32 v242, v174
    v_mfma_f32_16x16x32_bf16 v[156:159], a[148:151], v[116:119], v[156:159]
    ds_read_b128 a[196:199], v3 offset:1024
    v_cvt_pk_bf16_f32 v220, v240, v241
    v_mfma_f32_16x16x32_bf16 v[156:159], a[144:147], v[112:115], v[156:159]
    v_exp_f32 v243, v175
    v_mfma_f32_16x16x32_bf16 v[152:155], a[144:147], v[96:99], v[40:43]
    v_or3_b32 v57, v57, v219, v220
    v_cvt_pk_bf16_f32 v221, v242, v243
    v_mfma_f32_16x16x32_bf16 v[152:155], a[148:151], v[100:103], v[152:155]
    ds_read_b128 a[200:203], v3 offset:2048
    v_exp_f32 v244, v188
    v_mfma_f32_16x16x32_bf16 v[152:155], a[152:155], v[104:107], v[152:155]
    buffer_load_dword v7, v230, s[24:27], s54 offen
    v_exp_f32 v245, v189
    v_mfma_f32_16x16x32_bf16 v[152:155], a[156:159], v[108:111], v[152:155]
    v_exp_f32 v246, v190
    v_mfma_f32_16x16x32_bf16 v[148:151], a[156:159], v[92:95], v[36:39]
    s_add_u32 s54, s54, 4096
    v_cvt_pk_bf16_f32 v222, v244, v245
    v_or3_b32 v57, v57, v221, v222
    v_mfma_f32_16x16x32_bf16 v[148:151], a[152:155], v[88:91], v[148:151]
    v_exp_f32 v247, v191
    v_mfma_f32_16x16x32_bf16 v[148:151], a[148:151], v[84:87], v[148:151]
    ds_read_b128 a[204:207], v3 offset:3072
    v_cvt_pk_bf16_f32 v223, v246, v247
    v_mfma_f32_16x16x32_bf16 v[148:151], a[144:147], v[80:83], v[148:151]
    v_bitop3_b32 v57, v57, v223, s37 bitop3:0xa8
    v_cmp_ne_u32 vcc, 0, v57
    s_cbranch_vccnz k2_tramp_98
k2_ret_99:
    v_mfma_f32_16x16x32_bf16 v[12:15], v[60:63], v[208:211], v[12:15]
    v_exp_f32 v232, v132
    v_mfma_f32_16x16x32_bf16 v[48:51], v[60:63], v[212:215], v[48:51]
    s_mov_b32 m0, s35
    ds_read_b128 a[208:211], v3 offset:4096
    v_mfma_f32_16x16x32_bf16 v[248:251], v[60:63], v[216:219], v[248:251]
    s_add_u32 s53, s53, 8192
    buffer_load_dwordx4 v1, s[20:23], s33 offen offset:0 sc1 lds
    v_mfma_f32_16x16x32_bf16 v[252:255], v[60:63], v[220:223], v[252:255]
    s_waitcnt lgkmcnt(3)
    v_exp_f32 v233, v133
    v_mfma_f32_16x16x32_bf16 a[12:15], a[192:195], v[220:223], a[12:15]
    s_sub_u32 s40, s36, s38
    s_sub_u32 s40, s40, 64
    v_exp_f32 v234, v134
    v_mfma_f32_16x16x32_bf16 a[8:11], a[192:195], v[216:219], a[8:11]
    s_and_b32 s53, s53, 0xffff
    ds_read_b128 a[212:215], v3 offset:5120
    v_subrev_u32 v6, s40, v4
    v_mfma_f32_16x16x32_bf16 a[4:7], a[192:195], v[212:215], a[4:7]
    v_cvt_pk_bf16_f32 v196, v232, v233
    v_cmp_gt_i32 s[44:45], 0, v6
    v_mfma_f32_16x16x32_bf16 a[0:3], a[192:195], v[208:211], a[0:3]
    v_exp_f32 v235, v135
    v_mfma_f32_16x16x32_bf16 a[16:19], a[196:199], v[208:211], a[16:19]
    ds_read_b128 a[216:219], v3 offset:6144
    v_cmp_gt_i32 s[46:47], 1, v6
    v_mfma_f32_16x16x32_bf16 a[20:23], a[196:199], v[212:215], a[20:23]
    v_exp_f32 v236, v148
    v_mfma_f32_16x16x32_bf16 a[24:27], a[196:199], v[216:219], a[24:27]
    v_cvt_pk_bf16_f32 v197, v234, v235
    v_cmp_gt_i32 s[48:49], 2, v6
    v_mfma_f32_16x16x32_bf16 a[28:31], a[196:199], v[220:223], a[28:31]
    s_waitcnt lgkmcnt(3)
    v_cmp_gt_i32 s[50:51], 3, v6
    v_mfma_f32_16x16x32_bf16 a[44:47], a[200:203], v[220:223], a[44:47]
    v_exp_f32 v237, v149
    v_mfma_f32_16x16x32_bf16 a[40:43], a[200:203], v[216:219], a[40:43]
    s_add_u32 s35, s35, 0x4000
    ds_read_b128 a[220:223], v3 offset:7168
    v_cndmask_b32 v20, v9, v5, s[44:45]
    v_mfma_f32_16x16x32_bf16 a[36:39], a[200:203], v[212:215], a[36:39]
    v_exp_f32 v238, v150
    v_mfma_f32_16x16x32_bf16 a[32:35], a[200:203], v[208:211], a[32:35]
    v_cvt_pk_bf16_f32 v198, v236, v237
    v_cndmask_b32 v21, v9, v5, s[46:47]
    v_mfma_f32_16x16x32_bf16 a[48:51], a[204:207], v[208:211], a[48:51]
    buffer_load_dwordx4 v1, s[20:23], s33 offen offset:1024 sc1 lds
    ds_read_b128 a[128:131], v2 offset:0
    v_mfma_f32_16x16x32_bf16 a[52:55], a[204:207], v[212:215], a[52:55]
    v_add_u32 v3, s53, v56
    v_cndmask_b32 v22, v9, v5, s[48:49]
    v_mfma_f32_16x16x32_bf16 a[56:59], a[204:207], v[216:219], a[56:59]
    v_exp_f32 v239, v151
    v_mfma_f32_16x16x32_bf16 a[60:63], a[204:207], v[220:223], a[60:63]
    s_waitcnt lgkmcnt(3)
    v_or3_b32 v57, v196, v197, v198
    v_cndmask_b32 v23, v9, v5, s[50:51]
    v_mfma_f32_16x16x32_bf16 a[76:79], a[208:211], v[220:223], a[76:79]
    v_exp_f32 v240, v136
    v_mfma_f32_16x16x32_bf16 a[72:75], a[208:211], v[216:219], a[72:75]
    v_cvt_pk_bf16_f32 v199, v238, v239
    v_cmp_gt_i32 s[44:45], 16, v6
    v_mfma_f32_16x16x32_bf16 a[68:71], a[208:211], v[212:215], a[68:71]
    ds_read_b128 a[132:135], v2 offset:1024
    v_cmp_gt_i32 s[46:47], 17, v6
    v_mfma_f32_16x16x32_bf16 a[64:67], a[208:211], v[208:211], a[64:67]
    v_exp_f32 v241, v137
    v_mfma_f32_16x16x32_bf16 a[80:83], a[212:215], v[208:211], a[80:83]
    ds_read_b128 a[136:139], v2 offset:2048
    v_cmp_gt_i32 s[48:49], 18, v6
    v_mfma_f32_16x16x32_bf16 a[84:87], a[212:215], v[212:215], a[84:87]
    v_exp_f32 v242, v138
    v_mfma_f32_16x16x32_bf16 a[88:91], a[212:215], v[216:219], a[88:91]
    v_cvt_pk_bf16_f32 v200, v240, v241
    v_cmp_gt_i32 s[50:51], 19, v6
    v_mfma_f32_16x16x32_bf16 a[92:95], a[212:215], v[220:223], a[92:95]
    s_waitcnt lgkmcnt(3)
    v_exp_f32 v243, v139
    v_mfma_f32_16x16x32_bf16 a[108:111], a[216:219], v[220:223], a[108:111]
    s_and_b32 s35, s35, 0xffff
    ds_read_b128 a[140:143], v2 offset:3072
    v_or3_b32 v57, v57, v199, v200
    v_mfma_f32_16x16x32_bf16 a[104:107], a[216:219], v[216:219], a[104:107]
    v_cndmask_b32 v36, v9, v5, s[44:45]
    v_cndmask_b32 v37, v9, v5, s[46:47]
    v_mfma_f32_16x16x32_bf16 a[100:103], a[216:219], v[212:215], a[100:103]
    v_exp_f32 v244, v152
    v_mfma_f32_16x16x32_bf16 a[96:99], a[216:219], v[208:211], a[96:99]
    ds_read_b128 a[144:147], v2 offset:4096
    v_cvt_pk_bf16_f32 v201, v242, v243
    v_mfma_f32_16x16x32_bf16 a[112:115], a[220:223], v[208:211], a[112:115]
    buffer_load_dwordx4 v1, s[20:23], s33 offen offset:2048 sc1 lds
    ds_read_b128 a[148:151], v2 offset:5120
    v_mfma_f32_16x16x32_bf16 a[116:119], a[220:223], v[212:215], a[116:119]
    v_cndmask_b32 v38, v9, v5, s[48:49]
    v_cndmask_b32 v39, v9, v5, s[50:51]
    v_mfma_f32_16x16x32_bf16 a[120:123], a[220:223], v[216:219], a[120:123]
    s_or_b32 s35, s35, 0x10000
    v_exp_f32 v245, v153
    v_mfma_f32_16x16x32_bf16 a[124:127], a[220:223], v[220:223], a[124:127]
    s_waitcnt lgkmcnt(4)
    v_exp_f32 v246, v154
    v_mfma_f32_16x16x32_bf16 v[164:167], a[128:131], v[80:83], v[20:23]
    ds_read_b128 a[152:155], v2 offset:6144
    v_cvt_pk_bf16_f32 v202, v244, v245
    v_mfma_f32_16x16x32_bf16 v[164:167], a[132:135], v[84:87], v[164:167]
    s_waitcnt lgkmcnt(3)
    v_exp_f32 v247, v155
    v_mfma_f32_16x16x32_bf16 v[164:167], a[136:139], v[88:91], v[164:167]
    v_or3_b32 v57, v57, v201, v202
    v_cvt_pk_bf16_f32 v203, v246, v247
    v_mfma_f32_16x16x32_bf16 v[164:167], a[140:143], v[92:95], v[164:167]
    s_add_u32 s36, s36, 32
    v_exp_f32 v232, v140
    v_mfma_f32_16x16x32_bf16 v[168:171], a[140:143], v[108:111], v[24:27]
    ds_read_b128 a[156:159], v2 offset:7168
    v_mfma_f32_16x16x32_bf16 v[168:171], a[136:139], v[104:107], v[168:171]
    v_exp_f32 v233, v141
    v_mfma_f32_16x16x32_bf16 v[168:171], a[132:135], v[100:103], v[168:171]
    s_add_u32 s52, s52, 8192
    v_exp_f32 v234, v142
    v_mfma_f32_16x16x32_bf16 v[168:171], a[128:131], v[96:99], v[168:171]
    ds_read_b128 a[192:195], v3 offset:0
    v_cvt_pk_bf16_f32 v204, v232, v233
    v_mfma_f32_16x16x32_bf16 v[172:175], a[128:131], v[112:115], v[28:31]
    s_and_b32 s52, s52, 0xffff
    v_add_u32 v2, s52, v1
    v_or3_b32 v57, v57, v203, v204
    v_mfma_f32_16x16x32_bf16 v[172:175], a[132:135], v[116:119], v[172:175]
    buffer_load_dwordx4 v1, s[20:23], s33 offen offset:3072 sc1 lds
    s_add_u32 s33, s33, 0x80000
    v_mfma_f32_16x16x32_bf16 v[172:175], a[136:139], v[120:123], v[172:175]
    v_exp_f32 v235, v143
    v_mfma_f32_16x16x32_bf16 v[172:175], a[140:143], v[124:127], v[172:175]
    s_waitcnt lgkmcnt(3)
    ds_read_b128 a[196:199], v3 offset:1024
    s_waitcnt lgkmcnt(2)
    v_mfma_f32_16x16x32_bf16 v[188:191], a[156:159], v[124:127], v[44:47]
    v_exp_f32 v236, v156
    v_mfma_f32_16x16x32_bf16 v[188:191], a[152:155], v[120:123], v[188:191]
    v_cvt_pk_bf16_f32 v205, v234, v235
    v_mfma_f32_16x16x32_bf16 v[188:191], a[148:151], v[116:119], v[188:191]
    v_exp_f32 v237, v157
    v_mfma_f32_16x16x32_bf16 v[188:191], a[144:147], v[112:115], v[188:191]
    ds_read_b128 a[200:203], v3 offset:2048
    v_cvt_pk_bf16_f32 v206, v236, v237
    v_mfma_f32_16x16x32_bf16 v[184:187], a[144:147], v[96:99], v[40:43]
    v_exp_f32 v238, v158
    v_mfma_f32_16x16x32_bf16 v[184:187], a[148:151], v[100:103], v[184:187]
    v_exp_f32 v239, v159
    v_mfma_f32_16x16x32_bf16 v[184:187], a[152:155], v[104:107], v[184:187]
    ds_read_b128 a[204:207], v3 offset:3072
    v_or3_b32 v57, v57, v205, v206
    v_mfma_f32_16x16x32_bf16 v[184:187], a[156:159], v[108:111], v[184:187]
    v_cvt_pk_bf16_f32 v207, v238, v239
    v_mfma_f32_16x16x32_bf16 v[180:183], a[156:159], v[92:95], v[36:39]
    v_mfma_f32_16x16x32_bf16 v[180:183], a[152:155], v[88:91], v[180:183]
    v_bitop3_b32 v57, v57, v207, s37 bitop3:0xa8
    v_cmp_ne_u32 vcc, 0, v57
    v_mfma_f32_16x16x32_bf16 v[180:183], a[148:151], v[84:87], v[180:183]
    v_mfma_f32_16x16x32_bf16 v[180:183], a[144:147], v[80:83], v[180:183]
    s_waitcnt vmcnt(13)
    s_barrier
    s_cbranch_vccnz k2_tramp_100
k2_ret_101:
    v_mfma_f32_16x16x32_bf16 v[48:51], v[60:63], v[196:199], v[48:51]
    ds_read_b128 a[208:211], v3 offset:4096
    ds_read_b128 a[212:215], v3 offset:5120
    v_mfma_f32_16x16x32_bf16 v[248:251], v[60:63], v[200:203], v[248:251]
    s_mov_b32 m0, s34
    v_exp_f32 v232, v164
    v_mfma_f32_16x16x32_bf16 v[252:255], v[60:63], v[204:207], v[252:255]
    s_waitcnt lgkmcnt(4)
    buffer_load_dwordx4 v1, s[16:19], s32 offen offset:0 sc1 lds
    ds_read_b128 a[216:219], v3 offset:6144
    v_mfma_f32_16x16x32_bf16 a[12:15], a[192:195], v[204:207], a[12:15]
    s_add_u32 s53, s53, 8192
    v_exp_f32 v233, v165
    v_mfma_f32_16x16x32_bf16 a[8:11], a[192:195], v[200:203], a[8:11]
    s_and_b32 s53, s53, 0xffff
    v_mov_b32 v16, v10
    v_mov_b32 v17, v10
    v_mfma_f32_16x16x32_bf16 a[4:7], a[192:195], v[196:199], a[4:7]
    s_add_u32 s34, s34, 0x4000
    v_exp_f32 v234, v166
    v_mfma_f32_16x16x32_bf16 a[20:23], a[196:199], v[196:199], a[20:23]
    ds_read_b128 a[220:223], v3 offset:7168
    v_cvt_pk_bf16_f32 v212, v232, v233
    v_mfma_f32_16x16x32_bf16 a[24:27], a[196:199], v[200:203], a[24:27]
    v_mov_b32 v18, v10
    v_mov_b32 v19, v10
    v_mfma_f32_16x16x32_bf16 a[28:31], a[196:199], v[204:207], a[28:31]
    s_waitcnt lgkmcnt(4)
    v_exp_f32 v235, v167
    v_mfma_f32_16x16x32_bf16 a[44:47], a[200:203], v[204:207], a[44:47]
    buffer_load_dwordx4 v1, s[16:19], s32 offen offset:1024 sc1 lds
    ds_read_b128 a[128:131], v2 offset:0
    v_mfma_f32_16x16x32_bf16 a[40:43], a[200:203], v[200:203], a[40:43]
    v_mov_b32 v20, v11
    v_add_u32 v3, s53, v56
    v_mfma_f32_16x16x32_bf16 a[36:39], a[200:203], v[196:199], a[36:39]
    s_and_b32 s34, s34, 0xffff
    v_mov_b32 v21, v11
    v_mov_b32 v22, v11
    v_mfma_f32_16x16x32_bf16 a[52:55], a[204:207], v[196:199], a[52:55]
    v_exp_f32 v236, v180
    v_mfma_f32_16x16x32_bf16 a[56:59], a[204:207], v[200:203], a[56:59]
    ds_read_b128 a[132:135], v2 offset:1024
    v_cvt_pk_bf16_f32 v213, v234, v235
    v_mfma_f32_16x16x32_bf16 a[60:63], a[204:207], v[204:207], a[60:63]
    s_waitcnt lgkmcnt(4)
    v_mov_b32 v23, v11
    v_mov_b32 v32, v10
    v_mfma_f32_16x16x32_bf16 a[76:79], a[208:211], v[204:207], a[76:79]
    v_exp_f32 v237, v181
    v_mfma_f32_16x16x32_bf16 a[72:75], a[208:211], v[200:203], a[72:75]
    ds_read_b128 a[136:139], v2 offset:2048
    v_mov_b32 v33, v10
    v_mfma_f32_16x16x32_bf16 a[68:71], a[208:211], v[196:199], a[68:71]
    buffer_load_dwordx4 v1, s[16:19], s32 offen offset:2048 sc1 lds
    v_mov_b32 v34, v10
    v_mfma_f32_16x16x32_bf16 a[84:87], a[212:215], v[196:199], a[84:87]
    v_exp_f32 v238, v182
    v_mfma_f32_16x16x32_bf16 a[88:91], a[212:215], v[200:203], a[88:91]
    ds_read_b128 a[140:143], v2 offset:3072
    v_cvt_pk_bf16_f32 v214, v236, v237
    v_mfma_f32_16x16x32_bf16 a[92:95], a[212:215], v[204:207], a[92:95]
    s_waitcnt lgkmcnt(4)
    v_mov_b32 v35, v10
    v_mov_b32 v36, v11
    v_mfma_f32_16x16x32_bf16 a[108:111], a[216:219], v[204:207], a[108:111]
    ds_read_b128 a[144:147], v2 offset:4096
    v_exp_f32 v239, v183
    v_mfma_f32_16x16x32_bf16 a[104:107], a[216:219], v[200:203], a[104:107]
    v_mov_b32 v37, v11
    v_or3_b32 v57, v212, v213, v214
    v_mov_b32 v38, v11
    v_mov_b32 v39, v11
    v_mfma_f32_16x16x32_bf16 a[100:103], a[216:219], v[196:199], a[100:103]
    buffer_load_dwordx4 v1, s[16:19], s32 offen offset:3072 sc1 lds
    ds_read_b128 a[148:151], v2 offset:5120
    v_mfma_f32_16x16x32_bf16 a[116:119], a[220:223], v[196:199], a[116:119]
    s_add_u32 s32, s32, 0x80000
    s_cmp_ge_u32 s36, s43
    s_cbranch_scc1 k2_prep_102
k2_prepret_103:
    v_mfma_f32_16x16x32_bf16 a[120:123], a[220:223], v[200:203], a[120:123]
    s_waitcnt vmcnt(9)
    v_exp_f32 v240, v168
    v_mfma_f32_16x16x32_bf16 a[124:127], a[220:223], v[204:207], a[124:127]
    s_waitcnt lgkmcnt(4)
    ds_read_b128 a[152:155], v2 offset:6144
    v_cvt_pk_bf16_f32 v215, v238, v239
    v_mfma_f32_16x16x32_bf16 v[128:131], a[128:131], v[96:99], v[16:19]
    v_exp_f32 v241, v169
    v_mfma_f32_16x16x32_bf16 v[128:131], a[132:135], v[100:103], v[128:131]
    s_waitcnt lgkmcnt(3)
    ds_read_b128 a[156:159], v2 offset:7168
    v_exp_f32 v242, v170
    v_mfma_f32_16x16x32_bf16 v[128:131], a[136:139], v[104:107], v[128:131]
    ds_read_b128 a[160:163], v2 offset:8192
    v_cvt_pk_bf16_f32 v216, v240, v241
    v_mfma_f32_16x16x32_bf16 v[128:131], a[140:143], v[108:111], v[128:131]
    s_add_u32 s36, s36, 64
    buffer_store_dwordx4 a[224:227], v229, s[8:11], s58 offen offset:0 sc1
    v_exp_f32 v243, v171
    v_mfma_f32_16x16x32_bf16 v[132:135], a[140:143], v[124:127], v[20:23]
    ds_read_b128 a[164:167], v2 offset:9216
    v_or3_b32 v57, v57, v215, v216
    v_mfma_f32_16x16x32_bf16 v[132:135], a[136:139], v[120:123], v[132:135]
    v_exp_f32 v244, v184
    v_mfma_f32_16x16x32_bf16 v[132:135], a[132:135], v[116:119], v[132:135]
    s_add_u32 s52, s52, 16384
    ds_read_b128 a[168:171], v2 offset:10240
    v_cvt_pk_bf16_f32 v217, v242, v243
    v_mfma_f32_16x16x32_bf16 v[132:135], a[128:131], v[112:115], v[132:135]
    s_waitcnt lgkmcnt(5)
    v_exp_f32 v245, v185
    v_mfma_f32_16x16x32_bf16 v[148:151], a[144:147], v[112:115], v[36:39]
    s_and_b32 s52, s52, 0xffff
    ds_read_b128 a[172:175], v2 offset:11264
    ds_read_b128 a[176:179], v2 offset:12288
    v_mfma_f32_16x16x32_bf16 v[148:151], a[148:151], v[116:119], v[148:151]
    s_waitcnt lgkmcnt(5)
    v_exp_f32 v246, v186
    v_mfma_f32_16x16x32_bf16 v[148:151], a[152:155], v[120:123], v[148:151]
    ds_read_b128 a[180:183], v2 offset:13312
    v_cvt_pk_bf16_f32 v218, v244, v245
    v_mfma_f32_16x16x32_bf16 v[148:151], a[156:159], v[124:127], v[148:151]
    v_exp_f32 v247, v187
    v_mfma_f32_16x16x32_bf16 v[144:147], a[156:159], v[108:111], v[32:35]
    ds_read_b128 a[184:187], v2 offset:14336
    v_or3_b32 v57, v57, v217, v218
    v_mfma_f32_16x16x32_bf16 v[144:147], a[152:155], v[104:107], v[144:147]
    v_exp_f32 v232, v172
    v_mfma_f32_16x16x32_bf16 v[144:147], a[148:151], v[100:103], v[144:147]
    ds_read_b128 a[188:191], v2 offset:15360
    v_cvt_pk_bf16_f32 v219, v246, v247
    v_mfma_f32_16x16x32_bf16 v[144:147], a[144:147], v[96:99], v[144:147]
    s_waitcnt lgkmcnt(6)
    v_exp_f32 v233, v173
    v_mfma_f32_16x16x32_bf16 v[136:139], a[160:163], v[96:99], v[24:27]
    buffer_store_dwordx4 a[228:231], v229, s[8:11], s58 offen offset:256 sc1
    ds_read_b128 a[192:195], v3 offset:0
    v_mfma_f32_16x16x32_bf16 v[136:139], a[164:167], v[100:103], v[136:139]
    s_waitcnt lgkmcnt(5)
    v_add_u32 v2, s52, v1
    v_cvt_pk_bf16_f32 v220, v232, v233
    v_mfma_f32_16x16x32_bf16 v[136:139], a[168:171], v[104:107], v[136:139]
    v_exp_f32 v234, v174
    v_mfma_f32_16x16x32_bf16 v[136:139], a[172:175], v[108:111], v[136:139]
    v_exp_f32 v235, v175
    v_mfma_f32_16x16x32_bf16 v[140:143], a[172:175], v[124:127], v[28:31]
    ds_read_b128 a[196:199], v3 offset:1024
    v_or3_b32 v57, v57, v219, v220
    v_mfma_f32_16x16x32_bf16 v[140:143], a[168:171], v[120:123], v[140:143]
    v_exp_f32 v236, v188
    v_mfma_f32_16x16x32_bf16 v[140:143], a[164:167], v[116:119], v[140:143]
    ds_read_b128 a[200:203], v3 offset:2048
    v_cvt_pk_bf16_f32 v221, v234, v235
    v_mfma_f32_16x16x32_bf16 v[140:143], a[160:163], v[112:115], v[140:143]
    s_waitcnt lgkmcnt(5)
    v_exp_f32 v237, v189
    v_mfma_f32_16x16x32_bf16 v[156:159], a[176:179], v[112:115], v[44:47]
    v_exp_f32 v238, v190
    v_mfma_f32_16x16x32_bf16 v[156:159], a[180:183], v[116:119], v[156:159]
    s_waitcnt lgkmcnt(3)
    v_cvt_pk_bf16_f32 v222, v236, v237
    v_or3_b32 v57, v57, v221, v222
    v_mfma_f32_16x16x32_bf16 v[156:159], a[184:187], v[120:123], v[156:159]
    v_exp_f32 v239, v191
    v_mfma_f32_16x16x32_bf16 v[156:159], a[188:191], v[124:127], v[156:159]
    ds_read_b128 a[204:207], v3 offset:3072
    v_cvt_pk_bf16_f32 v223, v238, v239
    v_mfma_f32_16x16x32_bf16 v[152:155], a[188:191], v[108:111], v[40:43]
    v_mfma_f32_16x16x32_bf16 v[152:155], a[184:187], v[104:107], v[152:155]
    v_bitop3_b32 v57, v57, v223, s37 bitop3:0xa8
    v_cmp_ne_u32 vcc, 0, v57
    v_mfma_f32_16x16x32_bf16 v[152:155], a[180:183], v[100:103], v[152:155]
    v_mfma_f32_16x16x32_bf16 v[152:155], a[176:179], v[96:99], v[152:155]
    s_cbranch_vccnz k2_tramp_104
k2_ret_105:
    v_mfma_f32_16x16x32_bf16 v[48:51], v[60:63], v[212:215], v[48:51]
    ds_read_b128 a[208:211], v3 offset:4096
    ds_read_b128 a[212:215], v3 offset:5120
    v_mfma_f32_16x16x32_bf16 v[248:251], v[60:63], v[216:219], v[248:251]
    s_mov_b32 m0, s35
    v_exp_f32 v232, v128
    v_mfma_f32_16x16x32_bf16 v[252:255], v[60:63], v[220:223], v[252:255]
    s_waitcnt lgkmcnt(4)
    ds_read_b128 a[216:219], v3 offset:6144
    v_exp_f32 v233, v129
    v_mfma_f32_16x16x32_bf16 a[12:15], a[192:195], v[220:223], a[12:15]
    s_add_u32 s53, s53, 8192
    buffer_load_dwordx4 v1, s[20:23], s33 offen offset:0 sc1 lds
    v_mfma_f32_16x16x32_bf16 a[8:11], a[192:195], v[216:219], a[8:11]
    s_and_b32 s53, s53, 0xffff
    v_exp_f32 v234, v130
    v_cvt_pk_bf16_f32 v192, v232, v233
    v_mfma_f32_16x16x32_bf16 a[4:7], a[192:195], v[212:215], a[4:7]
    ds_read_b128 a[220:223], v3 offset:7168
    v_mfma_f32_16x16x32_bf16 a[20:23], a[196:199], v[212:215], a[20:23]
    s_add_u32 s35, s35, 0x4000
    v_exp_f32 v235, v131
    v_mfma_f32_16x16x32_bf16 a[24:27], a[196:199], v[216:219], a[24:27]
    v_exp_f32 v236, v144
    v_cvt_pk_bf16_f32 v193, v234, v235
    v_mfma_f32_16x16x32_bf16 a[28:31], a[196:199], v[220:223], a[28:31]
    s_waitcnt lgkmcnt(4)
    buffer_load_dwordx4 v1, s[20:23], s33 offen offset:1024 sc1 lds
    ds_read_b128 a[128:131], v2 offset:0
    v_mfma_f32_16x16x32_bf16 a[44:47], a[200:203], v[220:223], a[44:47]
    v_add_u32 v3, s53, v56
    v_exp_f32 v237, v145
    v_mfma_f32_16x16x32_bf16 a[40:43], a[200:203], v[216:219], a[40:43]
    ds_read_b128 a[132:135], v2 offset:1024
    v_cvt_pk_bf16_f32 v194, v236, v237
    v_mfma_f32_16x16x32_bf16 a[36:39], a[200:203], v[212:215], a[36:39]
    ds_read_b128 a[136:139], v2 offset:2048
    v_exp_f32 v238, v146
    v_mfma_f32_16x16x32_bf16 a[52:55], a[204:207], v[212:215], a[52:55]
    s_and_b32 s35, s35, 0xffff
    v_exp_f32 v239, v147
    v_mfma_f32_16x16x32_bf16 a[56:59], a[204:207], v[216:219], a[56:59]
    ds_read_b128 a[140:143], v2 offset:3072
    v_or3_b32 v57, v192, v193, v194
    v_mfma_f32_16x16x32_bf16 a[60:63], a[204:207], v[220:223], a[60:63]
    s_waitcnt lgkmcnt(6)
    v_exp_f32 v240, v132
    v_mfma_f32_16x16x32_bf16 a[76:79], a[208:211], v[220:223], a[76:79]
    s_or_b32 s35, s35, 0x10000
    buffer_load_dwordx4 v1, s[20:23], s33 offen offset:2048 sc1 lds
    ds_read_b128 a[144:147], v2 offset:4096
    v_mfma_f32_16x16x32_bf16 a[72:75], a[208:211], v[216:219], a[72:75]
    v_cvt_pk_bf16_f32 v195, v238, v239
    v_exp_f32 v241, v133
    v_mfma_f32_16x16x32_bf16 a[68:71], a[208:211], v[212:215], a[68:71]
    v_exp_f32 v242, v134
    v_mfma_f32_16x16x32_bf16 a[84:87], a[212:215], v[212:215], a[84:87]
    ds_read_b128 a[148:151], v2 offset:5120
    v_cvt_pk_bf16_f32 v196, v240, v241
    v_mfma_f32_16x16x32_bf16 a[88:91], a[212:215], v[216:219], a[88:91]
    v_exp_f32 v243, v135
    v_mfma_f32_16x16x32_bf16 a[92:95], a[212:215], v[220:223], a[92:95]
    s_waitcnt lgkmcnt(6)
    ds_read_b128 a[152:155], v2 offset:6144
    v_or3_b32 v57, v57, v195, v196
    v_cvt_pk_bf16_f32 v197, v242, v243
    v_mfma_f32_16x16x32_bf16 a[108:111], a[216:219], v[220:223], a[108:111]
    buffer_load_dwordx4 v1, s[20:23], s33 offen offset:3072 sc1 lds
    ds_read_b128 a[156:159], v2 offset:7168
    v_mfma_f32_16x16x32_bf16 a[104:107], a[216:219], v[216:219], a[104:107]
    s_add_u32 s33, s33, 0x80000
    v_exp_f32 v244, v148
    v_mfma_f32_16x16x32_bf16 a[100:103], a[216:219], v[212:215], a[100:103]
    v_exp_f32 v245, v149
    v_mfma_f32_16x16x32_bf16 a[116:119], a[220:223], v[212:215], a[116:119]
    ds_read_b128 a[160:163], v2 offset:8192
    s_cmp_ge_u32 s36, s43
    s_cbranch_scc1 k2_prep_106
k2_prepret_107:
    v_mfma_f32_16x16x32_bf16 a[120:123], a[220:223], v[216:219], a[120:123]
    v_exp_f32 v246, v150
    v_mfma_f32_16x16x32_bf16 a[124:127], a[220:223], v[220:223], a[124:127]
    s_waitcnt lgkmcnt(7)
    ds_read_b128 a[164:167], v2 offset:9216
    v_cvt_pk_bf16_f32 v198, v244, v245
    v_mfma_f32_16x16x32_bf16 v[160:163], a[128:131], v[96:99], v[16:19]
    s_waitcnt vmcnt(12)
    s_barrier
    v_exp_f32 v247, v151
    v_mfma_f32_16x16x32_bf16 v[160:163], a[132:135], v[100:103], v[160:163]
    s_waitcnt lgkmcnt(6)
    v_or3_b32 v57, v57, v197, v198
    v_cvt_pk_bf16_f32 v199, v246, v247
    v_mfma_f32_16x16x32_bf16 v[160:163], a[136:139], v[104:107], v[160:163]
    s_mov_b32 m0, s34
    ds_read_b128 a[168:171], v2 offset:10240
    v_exp_f32 v232, v136
    v_mfma_f32_16x16x32_bf16 v[160:163], a[140:143], v[108:111], v[160:163]
    s_add_u32 s36, s36, 64
    buffer_load_dwordx4 v1, s[16:19], s32 offen offset:0 sc1 lds
    ds_read_b128 a[172:175], v2 offset:11264
    v_mfma_f32_16x16x32_bf16 v[164:167], a[140:143], v[124:127], v[20:23]
    v_exp_f32 v233, v137
    v_mfma_f32_16x16x32_bf16 v[164:167], a[136:139], v[120:123], v[164:167]
    v_exp_f32 v234, v138
    v_mfma_f32_16x16x32_bf16 v[164:167], a[132:135], v[116:119], v[164:167]
    s_add_u32 s52, s52, 16384
    ds_read_b128 a[176:179], v2 offset:12288
    v_cvt_pk_bf16_f32 v200, v232, v233
    v_mfma_f32_16x16x32_bf16 v[164:167], a[128:131], v[112:115], v[164:167]
    s_waitcnt lgkmcnt(7)
    v_exp_f32 v235, v139
    v_or3_b32 v57, v57, v199, v200
    v_mfma_f32_16x16x32_bf16 v[180:183], a[144:147], v[112:115], v[36:39]
    s_add_u32 s34, s34, 0x4000
    ds_read_b128 a[180:183], v2 offset:13312
    v_cvt_pk_bf16_f32 v201, v234, v235
    v_mfma_f32_16x16x32_bf16 v[180:183], a[148:151], v[116:119], v[180:183]
    s_waitcnt lgkmcnt(6)
    v_exp_f32 v236, v152
    v_mfma_f32_16x16x32_bf16 v[180:183], a[152:155], v[120:123], v[180:183]
    s_and_b32 s52, s52, 0xffff
    buffer_load_dwordx4 v1, s[16:19], s32 offen offset:1024 sc1 lds
    ds_read_b128 a[184:187], v2 offset:14336
    v_mfma_f32_16x16x32_bf16 v[180:183], a[156:159], v[124:127], v[180:183]
    ds_read_b128 a[188:191], v2 offset:15360
    v_exp_f32 v237, v153
    v_mfma_f32_16x16x32_bf16 v[176:179], a[156:159], v[108:111], v[32:35]
    v_exp_f32 v238, v154
    v_mfma_f32_16x16x32_bf16 v[176:179], a[152:155], v[104:107], v[176:179]
    v_cvt_pk_bf16_f32 v202, v236, v237
    v_or3_b32 v57, v57, v201, v202
    v_mfma_f32_16x16x32_bf16 v[176:179], a[148:151], v[100:103], v[176:179]
    s_and_b32 s34, s34, 0xffff
    v_exp_f32 v239, v155
    v_mfma_f32_16x16x32_bf16 v[176:179], a[144:147], v[96:99], v[176:179]
    s_waitcnt lgkmcnt(6)
    v_add_u32 v2, s52, v1
    v_cvt_pk_bf16_f32 v203, v238, v239
    v_mfma_f32_16x16x32_bf16 v[168:171], a[160:163], v[96:99], v[24:27]
    ds_read_b128 a[192:195], v3 offset:0
    v_exp_f32 v240, v140
    v_mfma_f32_16x16x32_bf16 v[168:171], a[164:167], v[100:103], v[168:171]
    s_waitcnt lgkmcnt(5)
    v_exp_f32 v241, v141
    v_mfma_f32_16x16x32_bf16 v[168:171], a[168:171], v[104:107], v[168:171]
    buffer_load_dwordx4 v1, s[16:19], s32 offen offset:2048 sc1 lds
    ds_read_b128 a[196:199], v3 offset:8192
    v_mfma_f32_16x16x32_bf16 v[168:171], a[172:175], v[108:111], v[168:171]
    v_exp_f32 v242, v142
    v_mfma_f32_16x16x32_bf16 v[172:175], a[172:175], v[124:127], v[28:31]
    ds_read_b128 a[200:203], v3 offset:1024
    v_cvt_pk_bf16_f32 v204, v240, v241
    v_or3_b32 v57, v57, v203, v204
    v_mfma_f32_16x16x32_bf16 v[172:175], a[168:171], v[120:123], v[172:175]
    v_exp_f32 v243, v143
    v_mfma_f32_16x16x32_bf16 v[172:175], a[164:167], v[116:119], v[172:175]
    ds_read_b128 a[204:207], v3 offset:9216
    v_cvt_pk_bf16_f32 v205, v242, v243
    v_mfma_f32_16x16x32_bf16 v[172:175], a[160:163], v[112:115], v[172:175]
    s_waitcnt lgkmcnt(6)
    v_exp_f32 v244, v156
    v_mfma_f32_16x16x32_bf16 v[188:191], a[176:179], v[112:115], v[44:47]
    v_exp_f32 v245, v157
    v_mfma_f32_16x16x32_bf16 v[188:191], a[180:183], v[116:119], v[188:191]
    s_waitcnt lgkmcnt(4)
    buffer_load_dwordx4 v1, s[16:19], s32 offen offset:3072 sc1 lds
    ds_read_b128 a[208:211], v3 offset:2048
    ds_read_b128 a[212:215], v3 offset:10240
    v_mfma_f32_16x16x32_bf16 v[188:191], a[184:187], v[120:123], v[188:191]
    s_add_u32 s32, s32, 0x80000
    v_exp_f32 v246, v158
    v_mfma_f32_16x16x32_bf16 v[188:191], a[188:191], v[124:127], v[188:191]
    v_cvt_pk_bf16_f32 v206, v244, v245
    v_or3_b32 v57, v57, v205, v206
    v_mfma_f32_16x16x32_bf16 v[184:187], a[188:191], v[108:111], v[40:43]
    v_exp_f32 v247, v159
    v_mfma_f32_16x16x32_bf16 v[184:187], a[184:187], v[104:107], v[184:187]
    ds_read_b128 a[216:219], v3 offset:3072
    ds_read_b128 a[220:223], v3 offset:11264
    v_cvt_pk_bf16_f32 v207, v246, v247
    v_mfma_f32_16x16x32_bf16 v[184:187], a[180:183], v[100:103], v[184:187]
    v_bitop3_b32 v57, v57, v207, s37 bitop3:0xa8
    v_cmp_ne_u32 vcc, 0, v57
    v_mfma_f32_16x16x32_bf16 v[184:187], a[176:179], v[96:99], v[184:187]
    s_cbranch_vccnz k2_tramp_108
k2_ret_109:
    s_load_dwordx2 s[4:5], s[0:1], 40
    s_add_u32 s24, s6, 0x3000000
    s_addc_u32 s25, s7, 0
    s_and_b32 s25, s25, 0xffff
    s_mov_b32 s26, 0x1000000
    s_mov_b32 s27, 0x00020000
    s_lshl_b32 s31, s28, 19
    s_lshl_b32 s44, s38, 6
    s_add_u32 s44, s44, s31
    s_add_u32 s45, s44, 131072
    s_add_u32 s46, s44, 262144
    s_add_u32 s47, s44, 393216
    s_add_u32 s48, s44, 4096
    s_add_u32 s49, s44, 135168
    s_add_u32 s50, s44, 266240
    s_add_u32 s51, s44, 397312
    v_mov_b32 v13, v12
    v_mov_b32 v49, v48
    s_nop 1
    v_permlane16_swap_b32 v12, v13
    v_permlane16_swap_b32 v48, v49
    s_nop 1
    v_add_f32 v12, v12, v13
    v_add_f32 v48, v48, v49
    v_mov_b32 v13, v12
    v_mov_b32 v49, v48
    s_nop 1
    v_permlane32_swap_b32 v12, v13
    v_permlane32_swap_b32 v48, v49
    s_nop 1
    v_add_f32 v12, v12, v13
    v_add_f32 v48, v48, v49
    v_rcp_f32 v13, v12
    v_rcp_f32 v49, v48
    v_rcp_f32 v12, v12
    v_rcp_f32 v48, v48
    s_nop 0
    v_accvgpr_read_b32 v68, a0
    v_accvgpr_read_b32 v69, a1
    v_accvgpr_read_b32 v70, a2
    v_accvgpr_read_b32 v71, a3
    v_accvgpr_read_b32 v72, a16
    v_accvgpr_read_b32 v73, a17
    v_accvgpr_read_b32 v74, a18
    v_accvgpr_read_b32 v75, a19
    v_pk_mul_f32 v[68:69], v[68:69], v[12:13]
    v_pk_mul_f32 v[70:71], v[70:71], v[12:13]
    v_pk_mul_f32 v[72:73], v[72:73], v[12:13]
    v_pk_mul_f32 v[74:75], v[74:75], v[12:13]
    v_cvt_pk_bf16_f32 v64, v68, v69
    v_cvt_pk_bf16_f32 v65, v70, v71
    v_cvt_pk_bf16_f32 v66, v72, v73
    v_cvt_pk_bf16_f32 v67, v74, v75
    buffer_store_dwordx4 v[64:67], v1, s[24:27], s44 offen sc1
    v_accvgpr_read_b32 v80, a32
    v_accvgpr_read_b32 v81, a33
    v_accvgpr_read_b32 v82, a34
    v_accvgpr_read_b32 v83, a35
    v_accvgpr_read_b32 v84, a48
    v_accvgpr_read_b32 v85, a49
    v_accvgpr_read_b32 v86, a50
    v_accvgpr_read_b32 v87, a51
    v_pk_mul_f32 v[80:81], v[80:81], v[12:13]
    v_pk_mul_f32 v[82:83], v[82:83], v[12:13]
    v_pk_mul_f32 v[84:85], v[84:85], v[12:13]
    v_pk_mul_f32 v[86:87], v[86:87], v[12:13]
    v_cvt_pk_bf16_f32 v76, v80, v81
    v_cvt_pk_bf16_f32 v77, v82, v83
    v_cvt_pk_bf16_f32 v78, v84, v85
    v_cvt_pk_bf16_f32 v79, v86, v87
    buffer_store_dwordx4 v[76:79], v1, s[24:27], s45 offen sc1
    v_accvgpr_read_b32 v68, a64
    v_accvgpr_read_b32 v69, a65
    v_accvgpr_read_b32 v70, a66
    v_accvgpr_read_b32 v71, a67
    v_accvgpr_read_b32 v72, a80
    v_accvgpr_read_b32 v73, a81
    v_accvgpr_read_b32 v74, a82
    v_accvgpr_read_b32 v75, a83
    v_pk_mul_f32 v[68:69], v[68:69], v[12:13]
    v_pk_mul_f32 v[70:71], v[70:71], v[12:13]
    v_pk_mul_f32 v[72:73], v[72:73], v[12:13]
    v_pk_mul_f32 v[74:75], v[74:75], v[12:13]
    v_cvt_pk_bf16_f32 v64, v68, v69
    v_cvt_pk_bf16_f32 v65, v70, v71
    v_cvt_pk_bf16_f32 v66, v72, v73
    v_cvt_pk_bf16_f32 v67, v74, v75
    buffer_store_dwordx4 v[64:67], v1, s[24:27], s46 offen sc1
    v_accvgpr_read_b32 v80, a96
    v_accvgpr_read_b32 v81, a97
    v_accvgpr_read_b32 v82, a98
    v_accvgpr_read_b32 v83, a99
    v_accvgpr_read_b32 v84, a112
    v_accvgpr_read_b32 v85, a113
    v_accvgpr_read_b32 v86, a114
    v_accvgpr_read_b32 v87, a115
    v_pk_mul_f32 v[80:81], v[80:81], v[12:13]
    v_pk_mul_f32 v[82:83], v[82:83], v[12:13]
    v_pk_mul_f32 v[84:85], v[84:85], v[12:13]
    v_pk_mul_f32 v[86:87], v[86:87], v[12:13]
    v_cvt_pk_bf16_f32 v76, v80, v81
    v_cvt_pk_bf16_f32 v77, v82, v83
    v_cvt_pk_bf16_f32 v78, v84, v85
    v_cvt_pk_bf16_f32 v79, v86, v87
    buffer_store_dwordx4 v[76:79], v1, s[24:27], s47 offen sc1
    v_accvgpr_read_b32 v68, a4
    v_accvgpr_read_b32 v69, a5
    v_accvgpr_read_b32 v70, a6
    v_accvgpr_read_b32 v71, a7
    v_accvgpr_read_b32 v72, a20
    v_accvgpr_read_b32 v73, a21
    v_accvgpr_read_b32 v74, a22
    v_accvgpr_read_b32 v75, a23
    v_pk_mul_f32 v[68:69], v[68:69], v[48:49]
    v_pk_mul_f32 v[70:71], v[70:71], v[48:49]
    v_pk_mul_f32 v[72:73], v[72:73], v[48:49]
    v_pk_mul_f32 v[74:75], v[74:75], v[48:49]
    v_cvt_pk_bf16_f32 v64, v68, v69
    v_cvt_pk_bf16_f32 v65, v70, v71
    v_cvt_pk_bf16_f32 v66, v72, v73
    v_cvt_pk_bf16_f32 v67, v74, v75
    buffer_store_dwordx4 v[64:67], v1, s[24:27], s48 offen sc1
    v_accvgpr_read_b32 v80, a36
    v_accvgpr_read_b32 v81, a37
    v_accvgpr_read_b32 v82, a38
    v_accvgpr_read_b32 v83, a39
    v_accvgpr_read_b32 v84, a52
    v_accvgpr_read_b32 v85, a53
    v_accvgpr_read_b32 v86, a54
    v_accvgpr_read_b32 v87, a55
    v_pk_mul_f32 v[80:81], v[80:81], v[48:49]
    v_pk_mul_f32 v[82:83], v[82:83], v[48:49]
    v_pk_mul_f32 v[84:85], v[84:85], v[48:49]
    v_pk_mul_f32 v[86:87], v[86:87], v[48:49]
    v_cvt_pk_bf16_f32 v76, v80, v81
    v_cvt_pk_bf16_f32 v77, v82, v83
    v_cvt_pk_bf16_f32 v78, v84, v85
    v_cvt_pk_bf16_f32 v79, v86, v87
    buffer_store_dwordx4 v[76:79], v1, s[24:27], s49 offen sc1
    v_accvgpr_read_b32 v68, a68
    v_accvgpr_read_b32 v69, a69
    v_accvgpr_read_b32 v70, a70
    v_accvgpr_read_b32 v71, a71
    v_accvgpr_read_b32 v72, a84
    v_accvgpr_read_b32 v73, a85
    v_accvgpr_read_b32 v74, a86
    v_accvgpr_read_b32 v75, a87
    v_pk_mul_f32 v[68:69], v[68:69], v[48:49]
    v_pk_mul_f32 v[70:71], v[70:71], v[48:49]
    v_pk_mul_f32 v[72:73], v[72:73], v[48:49]
    v_pk_mul_f32 v[74:75], v[74:75], v[48:49]
    v_cvt_pk_bf16_f32 v64, v68, v69
    v_cvt_pk_bf16_f32 v65, v70, v71
    v_cvt_pk_bf16_f32 v66, v72, v73
    v_cvt_pk_bf16_f32 v67, v74, v75
    buffer_store_dwordx4 v[64:67], v1, s[24:27], s50 offen sc1
    v_accvgpr_read_b32 v80, a100
    v_accvgpr_read_b32 v81, a101
    v_accvgpr_read_b32 v82, a102
    v_accvgpr_read_b32 v83, a103
    v_accvgpr_read_b32 v84, a116
    v_accvgpr_read_b32 v85, a117
    v_accvgpr_read_b32 v86, a118
    v_accvgpr_read_b32 v87, a119
    v_pk_mul_f32 v[80:81], v[80:81], v[48:49]
    v_pk_mul_f32 v[82:83], v[82:83], v[48:49]
    v_pk_mul_f32 v[84:85], v[84:85], v[48:49]
    v_pk_mul_f32 v[86:87], v[86:87], v[48:49]
    v_cvt_pk_bf16_f32 v76, v80, v81
    v_cvt_pk_bf16_f32 v77, v82, v83
    v_cvt_pk_bf16_f32 v78, v84, v85
    v_cvt_pk_bf16_f32 v79, v86, v87
    buffer_store_dwordx4 v[76:79], v1, s[24:27], s51 offen sc1
    s_nop 1
    s_lshr_b32 s31, s2, 3
    s_bfe_u32 s56, s2, 0x10002
    s_and_b32 s54, s2, 1
    s_and_b32 s55, s31, 7
    s_lshl_b32 s54, s54, 3
    s_add_u32 s54, s54, s55
    s_and_b32 s55, s2, 2
    s_lshl_b32 s55, s55, 1
    s_lshr_b32 s31, s31, 3
    s_add_u32 s55, s55, s31
    v_lshrrev_b32 v87, 4, v1
    v_lshrrev_b32 v72, 4, v87
    s_lshl_b32 s57, s54, 7
    s_lshl_b32 s31, s30, 5
    s_add_u32 s57, s57, s31
    s_lshl_b32 s31, s57, 6
    v_add_u32 v88, s31, v1
    v_add_u32 v89, 0x20000, v88
    v_bfe_u32 v84, v87, 1, 3
    v_xor_b32 v84, v84, v72
    v_and_b32 v85, 16, v1
    v_lshl_add_u32 v85, v72, 11, v85
    s_lshl_b32 s31, s30, 15
    s_lshl_b32 s58, s55, 8
    s_add_u32 s31, s31, s58
    v_add_u32 v85, s31, v85
    v_xor_b32 v86, 0, v84
    v_lshl_add_u32 v86, v86, 5, v85
    v_add_u32 v90, 0, v86
    v_xor_b32 v86, 4, v84
    v_lshl_add_u32 v86, v86, 5, v85
    v_add_u32 v91, 7168, v86
    v_xor_b32 v86, 0, v84
    v_lshl_add_u32 v86, v86, 5, v85
    v_add_u32 v92, 14336, v86
    v_xor_b32 v86, 4, v84
    v_lshl_add_u32 v86, v86, 5, v85
    v_add_u32 v93, 21504, v86
    v_and_b32 v84, 15, v87
    v_add_u32 v85, s57, v84
    v_lshlrev_b32 v77, 2, v85
    v_lshl_add_u32 v77, v72, 13, v77
    s_lshl_b32 s31, s56, 7
    s_add_u32 s58, s58, s31
    v_lshl_add_u32 v80, v72, 3, s58
    v_lshl_add_u32 v78, v85, 11, v80
    v_add_u32 v79, 0x8000, v78
    v_lshrrev_b32 v85, 2, v84
    v_lshl_add_u32 v85, v72, 2, v85
    v_and_b32 v84, 7, v85
    s_lshl_b32 s31, s56, 2
    v_xor_b32 v84, s31, v84
    v_lshlrev_b32 v85, 8, v85
    v_and_b32 v86, 3, v87
    v_lshl_add_u32 v85, v86, 3, v85
    s_add_u32 s31, s2, 1
    s_and_b32 s31, s31, 3
    v_add_u32 v73, s31, v86
    v_and_b32 v73, 3, v73
    v_lshlrev_b32 v73, 7, v73
    v_xor_b32 v86, 0, v84
    v_lshl_add_u32 v64, v86, 5, v85
    v_xor_b32 v86, 1, v84
    v_lshl_add_u32 v65, v86, 5, v85
    v_xor_b32 v86, 2, v84
    v_lshl_add_u32 v66, v86, 5, v85
    v_xor_b32 v86, 3, v84
    v_lshl_add_u32 v67, v86, 5, v85
    v_xor_b32 v86, 4, v84
    v_lshl_add_u32 v68, v86, 5, v85
    v_xor_b32 v86, 5, v84
    v_lshl_add_u32 v69, v86, 5, v85
    v_xor_b32 v86, 6, v84
    v_lshl_add_u32 v70, v86, 5, v85
    v_xor_b32 v86, 7, v84
    v_lshl_add_u32 v71, v86, 5, v85
    s_lshl_b32 s61, s31, 20
    s_lshl_b32 s62, s31, 21
    s_lshl_b32 s60, s30, 12
    s_lshl_b32 s59, s54, 10
    s_lshl_b32 s31, s56, 9
    s_add_u32 s59, s59, s31
    s_lshr_b32 s31, s28, 2
    s_lshl_b32 s31, s31, 7
    s_lshl_b32 s57, s29, 10
    s_sub_u32 s58, 0x3c00, s57
    s_add_u32 s57, s57, s31
    s_add_u32 s58, s58, s31
    v_mov_b32 v75, 0
    v_mov_b32 v76, 1
    s_lshl_b32 s31, s56, 23
    s_add_u32 s31, s31, 0x3000000
    s_add_u32 s8, s6, s31
    s_addc_u32 s9, s7, 0
    s_and_b32 s9, s9, 0xffff
    s_mov_b32 s10, 0x800000
    s_lshl_b32 s31, s56, 22
    s_waitcnt lgkmcnt(0)
    s_add_u32 s12, s4, s31
    s_addc_u32 s13, s5, 0
    s_and_b32 s13, s13, 0xffff
    s_mov_b32 s14, 0x400000
    s_load_dwordx2 s[4:5], s[0:1], 80
    v_mov_b32 v12, -1
    v_mov_b32 v13, -1
    v_mov_b32 v14, -1
    v_mov_b32 v15, -1
    s_waitcnt lgkmcnt(0)
    s_mov_b32 s26, -1
    s_lshl_b32 s31, s2, 14
    s_add_u32 s31, s31, s60
    s_add_u32 s40, s31, 0x2000000
    buffer_store_dwordx4 v[12:15], v1, s[24:27], s40 offen offset:0 sc1
    buffer_store_dwordx4 v[12:15], v1, s[24:27], s40 offen offset:1024 sc1
    buffer_store_dwordx4 v[12:15], v1, s[24:27], s40 offen offset:2048 sc1
    buffer_store_dwordx4 v[12:15], v1, s[24:27], s40 offen offset:3072 sc1
    s_lshr_b32 s31, s31, 1
    s_add_u32 s40, s31, 0x1900000
    buffer_store_dwordx4 v[12:15], v1, s[24:27], s40 offen offset:0 sc1
    buffer_store_dwordx4 v[12:15], v1, s[24:27], s40 offen offset:1024 sc1
    s_mov_b32 s26, 0x1000000
    s_and_b32 s31, s2, 7
    s_mul_i32 s31, s31, 28
    s_lshr_b32 s40, s2, 3
    s_add_u32 s31, s31, s40
    s_lshl_b32 s31, s31, 15
    s_lshl_b32 s40, s30, 13
    s_add_u32 s31, s31, s40
    s_mov_b32 s44, s4
    s_mov_b32 s47, 0x00020000
    s_and_b32 s45, s5, 0xffff
    s_cmp_ge_u32 s2, 224
    s_cselect_b32 s46, 0, 7340032
    s_add_u32 m0, s40, 131072
    s_nop 0
    buffer_load_dwordx4 v1, s[44:47], s31 offen offset:0 lds
    buffer_load_dwordx4 v1, s[44:47], s31 offen offset:1024 lds
    buffer_load_dwordx4 v1, s[44:47], s31 offen offset:2048 lds
    buffer_load_dwordx4 v1, s[44:47], s31 offen offset:3072 lds
    s_add_u32 s31, s31, 4096
    s_add_u32 m0, s40, 135168
    s_nop 0
    buffer_load_dwordx4 v1, s[44:47], s31 offen offset:0 lds
    buffer_load_dwordx4 v1, s[44:47], s31 offen offset:1024 lds
    buffer_load_dwordx4 v1, s[44:47], s31 offen offset:2048 lds
    buffer_load_dwordx4 v1, s[44:47], s31 offen offset:3072 lds
    s_add_u32 s31, s31, 4096
    s_lshl_b32 s63, s29, 1
    s_sub_u32 s63, 13, s63
    s_cbranch_scc1 k2_sdone_111
k2_sloop_110:
    v_mfma_f32_16x16x32_bf16 v[248:251], v[60:63], v[192:195], v[248:251]
    v_exp_f32 v232, v160
    v_mfma_f32_16x16x32_bf16 v[248:251], v[60:63], v[200:203], v[248:251]
    s_mov_b32 m0, s35
    ds_read_b128 a[224:227], v3 offset:4096
    v_mfma_f32_16x16x32_bf16 v[252:255], v[60:63], v[204:207], v[252:255]
    s_add_u32 s53, s53, 16384
    buffer_load_dwordx4 v1, s[20:23], s33 offen offset:0 sc1 lds
    ds_read_b128 a[228:231], v3 offset:12288
    v_mfma_f32_16x16x32_bf16 v[252:255], v[60:63], v[196:199], v[252:255]
    s_waitcnt lgkmcnt(8)
    v_exp_f32 v233, v161
    v_mfma_f32_16x16x32_bf16 a[12:15], a[192:195], v[196:199], a[12:15]
    s_and_b32 s53, s53, 0xffff
    v_exp_f32 v234, v162
    v_mfma_f32_16x16x32_bf16 a[12:15], a[196:199], v[204:207], a[12:15]
    ds_read_b128 a[232:235], v3 offset:5120
    v_cvt_pk_bf16_f32 v208, v232, v233
    v_mfma_f32_16x16x32_bf16 a[8:11], a[196:199], v[200:203], a[8:11]
    v_exp_f32 v235, v163
    v_mfma_f32_16x16x32_bf16 a[8:11], a[192:195], v[192:195], a[8:11]
    s_waitcnt lgkmcnt(7)
    ds_read_b128 a[236:239], v3 offset:13312
    v_cvt_pk_bf16_f32 v209, v234, v235
    v_mfma_f32_16x16x32_bf16 a[24:27], a[200:203], v[192:195], a[24:27]
    s_add_u32 s35, s35, 0x4000
    v_exp_f32 v236, v176
    v_mfma_f32_16x16x32_bf16 a[24:27], a[204:207], v[200:203], a[24:27]
    buffer_load_dwordx4 v1, s[20:23], s33 offen offset:1024 sc1 lds
    ds_read_b128 a[240:243], v3 offset:6144
    v_mfma_f32_16x16x32_bf16 a[28:31], a[204:207], v[204:207], a[28:31]
    v_exp_f32 v237, v177
    v_mfma_f32_16x16x32_bf16 a[28:31], a[200:203], v[196:199], a[28:31]
    s_waitcnt lgkmcnt(7)
    ds_read_b128 a[244:247], v3 offset:14336
    v_cvt_pk_bf16_f32 v210, v236, v237
    v_mfma_f32_16x16x32_bf16 a[44:47], a[208:211], v[196:199], a[44:47]
    v_exp_f32 v238, v178
    v_mfma_f32_16x16x32_bf16 a[44:47], a[212:215], v[204:207], a[44:47]
    ds_read_b128 a[248:251], v3 offset:7168
    v_or3_b32 v57, v208, v209, v210
    v_mfma_f32_16x16x32_bf16 a[40:43], a[212:215], v[200:203], a[40:43]
    v_exp_f32 v239, v179
    v_mfma_f32_16x16x32_bf16 a[40:43], a[208:211], v[192:195], a[40:43]
    s_waitcnt lgkmcnt(7)
    ds_read_b128 a[252:255], v3 offset:15360
    v_cvt_pk_bf16_f32 v211, v238, v239
    v_mfma_f32_16x16x32_bf16 a[56:59], a[216:219], v[192:195], a[56:59]
    s_and_b32 s35, s35, 0xffff
    v_exp_f32 v240, v164
    v_mfma_f32_16x16x32_bf16 a[56:59], a[220:223], v[200:203], a[56:59]
    ds_read_b128 a[128:131], v2 offset:0
    v_add_u32 v3, s53, v56
    v_mfma_f32_16x16x32_bf16 a[60:63], a[220:223], v[204:207], a[60:63]
    v_exp_f32 v241, v165
    v_mfma_f32_16x16x32_bf16 a[60:63], a[216:219], v[196:199], a[60:63]
    s_waitcnt lgkmcnt(7)
    buffer_load_dwordx4 v1, s[20:23], s33 offen offset:2048 sc1 lds
    ds_read_b128 a[132:135], v2 offset:1024
    v_mfma_f32_16x16x32_bf16 a[76:79], a[224:227], v[196:199], a[76:79]
    v_exp_f32 v242, v166
    v_mfma_f32_16x16x32_bf16 a[76:79], a[228:231], v[204:207], a[76:79]
    s_or_b32 s35, s35, 0x10000
    ds_read_b128 a[136:139], v2 offset:2048
    v_cvt_pk_bf16_f32 v212, v240, v241
    v_mfma_f32_16x16x32_bf16 a[72:75], a[228:231], v[200:203], a[72:75]
    v_exp_f32 v243, v167
    v_mfma_f32_16x16x32_bf16 a[72:75], a[224:227], v[192:195], a[72:75]
    s_waitcnt lgkmcnt(7)
    ds_read_b128 a[140:143], v2 offset:3072
    v_or3_b32 v57, v57, v211, v212
    v_mfma_f32_16x16x32_bf16 a[88:91], a[232:235], v[192:195], a[88:91]
    v_exp_f32 v244, v180
    v_mfma_f32_16x16x32_bf16 a[88:91], a[236:239], v[200:203], a[88:91]
    ds_read_b128 a[144:147], v2 offset:4096
    v_cvt_pk_bf16_f32 v213, v242, v243
    v_mfma_f32_16x16x32_bf16 a[92:95], a[236:239], v[204:207], a[92:95]
    v_exp_f32 v245, v181
    v_mfma_f32_16x16x32_bf16 a[92:95], a[232:235], v[196:199], a[92:95]
    s_waitcnt lgkmcnt(7)
    buffer_load_dwordx4 v1, s[20:23], s33 offen offset:3072 sc1 lds
    ds_read_b128 a[148:151], v2 offset:5120
    v_mfma_f32_16x16x32_bf16 a[108:111], a[240:243], v[196:199], a[108:111]
    s_add_u32 s33, s33, 0x80000
    v_exp_f32 v246, v182
    v_mfma_f32_16x16x32_bf16 a[108:111], a[244:247], v[204:207], a[108:111]
    ds_read_b128 a[152:155], v2 offset:6144
    v_cvt_pk_bf16_f32 v214, v244, v245
    v_mfma_f32_16x16x32_bf16 a[104:107], a[244:247], v[200:203], a[104:107]
    v_exp_f32 v247, v183
    v_mfma_f32_16x16x32_bf16 a[104:107], a[240:243], v[192:195], a[104:107]
    s_waitcnt lgkmcnt(7)
    ds_read_b128 a[156:159], v2 offset:7168
    v_or3_b32 v57, v57, v213, v214
    v_mfma_f32_16x16x32_bf16 a[120:123], a[248:251], v[192:195], a[120:123]
    v_exp_f32 v232, v168
    v_mfma_f32_16x16x32_bf16 a[120:123], a[252:255], v[200:203], a[120:123]
    ds_read_b128 a[160:163], v2 offset:8192
    v_cvt_pk_bf16_f32 v215, v246, v247
    v_mfma_f32_16x16x32_bf16 a[124:127], a[252:255], v[204:207], a[124:127]
    v_exp_f32 v233, v169
    v_mfma_f32_16x16x32_bf16 a[124:127], a[248:251], v[196:199], a[124:127]
    s_waitcnt lgkmcnt(7)
    ds_read_b128 a[164:167], v2 offset:9216
    v_cvt_pk_bf16_f32 v216, v232, v233
    v_mfma_f32_16x16x32_bf16 v[128:131], a[128:131], v[96:99], v[16:19]
    s_waitcnt vmcnt(12)
    s_barrier
    v_exp_f32 v234, v170
    v_mfma_f32_16x16x32_bf16 v[128:131], a[132:135], v[100:103], v[128:131]
    s_waitcnt lgkmcnt(6)
    ds_read_b128 a[168:171], v2 offset:10240
    v_or3_b32 v57, v57, v215, v216
    v_mfma_f32_16x16x32_bf16 v[128:131], a[136:139], v[104:107], v[128:131]
    s_mov_b32 m0, s34
    v_exp_f32 v235, v171
    v_mfma_f32_16x16x32_bf16 v[128:131], a[140:143], v[108:111], v[128:131]
    s_add_u32 s36, s36, 64
    buffer_load_dwordx4 v1, s[16:19], s32 offen offset:0 sc1 lds
    ds_read_b128 a[172:175], v2 offset:11264
    v_mfma_f32_16x16x32_bf16 v[132:135], a[140:143], v[124:127], v[20:23]
    v_exp_f32 v236, v184
    v_mfma_f32_16x16x32_bf16 v[132:135], a[136:139], v[120:123], v[132:135]
    ds_read_b128 a[176:179], v2 offset:12288
    v_cvt_pk_bf16_f32 v217, v234, v235
    v_mfma_f32_16x16x32_bf16 v[132:135], a[132:135], v[116:119], v[132:135]
    s_add_u32 s52, s52, 16384
    v_exp_f32 v237, v185
    v_mfma_f32_16x16x32_bf16 v[132:135], a[128:131], v[112:115], v[132:135]
    s_waitcnt lgkmcnt(7)
    ds_read_b128 a[180:183], v2 offset:13312
    v_cvt_pk_bf16_f32 v218, v236, v237
    v_mfma_f32_16x16x32_bf16 v[148:151], a[144:147], v[112:115], v[36:39]
    s_add_u32 s34, s34, 0x4000
    v_exp_f32 v238, v186
    v_mfma_f32_16x16x32_bf16 v[148:151], a[148:151], v[116:119], v[148:151]
    s_waitcnt lgkmcnt(6)
    buffer_load_dwordx4 v1, s[16:19], s32 offen offset:1024 sc1 lds
    ds_read_b128 a[184:187], v2 offset:14336
    v_mfma_f32_16x16x32_bf16 v[148:151], a[152:155], v[120:123], v[148:151]
    s_and_b32 s52, s52, 0xffff
    v_exp_f32 v239, v187
    v_mfma_f32_16x16x32_bf16 v[148:151], a[156:159], v[124:127], v[148:151]
    ds_read_b128 a[188:191], v2 offset:15360
    v_or3_b32 v57, v57, v217, v218
    v_mfma_f32_16x16x32_bf16 v[144:147], a[156:159], v[108:111], v[32:35]
    v_exp_f32 v240, v172
    v_mfma_f32_16x16x32_bf16 v[144:147], a[152:155], v[104:107], v[144:147]
    v_cvt_pk_bf16_f32 v219, v238, v239
    v_add_u32 v2, s52, v1
    v_mfma_f32_16x16x32_bf16 v[144:147], a[148:151], v[100:103], v[144:147]
    s_and_b32 s34, s34, 0xffff
    v_exp_f32 v241, v173
    v_mfma_f32_16x16x32_bf16 v[144:147], a[144:147], v[96:99], v[144:147]
    s_waitcnt lgkmcnt(6)
    ds_read_b128 a[192:195], v3 offset:0
    v_cvt_pk_bf16_f32 v220, v240, v241
    v_mfma_f32_16x16x32_bf16 v[136:139], a[160:163], v[96:99], v[24:27]
    v_exp_f32 v242, v174
    v_mfma_f32_16x16x32_bf16 v[136:139], a[164:167], v[100:103], v[136:139]
    s_waitcnt lgkmcnt(5)
    buffer_load_dwordx4 v1, s[16:19], s32 offen offset:2048 sc1 lds
    ds_read_b128 a[196:199], v3 offset:8192
    v_mfma_f32_16x16x32_bf16 v[136:139], a[168:171], v[104:107], v[136:139]
    v_exp_f32 v243, v175
    v_mfma_f32_16x16x32_bf16 v[136:139], a[172:175], v[108:111], v[136:139]
    ds_read_b128 a[200:203], v3 offset:1024
    v_or3_b32 v57, v57, v219, v220
    v_mfma_f32_16x16x32_bf16 v[140:143], a[172:175], v[124:127], v[28:31]
    v_exp_f32 v244, v188
    v_mfma_f32_16x16x32_bf16 v[140:143], a[168:171], v[120:123], v[140:143]
    ds_read_b128 a[204:207], v3 offset:9216
    v_cvt_pk_bf16_f32 v221, v242, v243
    v_mfma_f32_16x16x32_bf16 v[140:143], a[164:167], v[116:119], v[140:143]
    v_exp_f32 v245, v189
    v_mfma_f32_16x16x32_bf16 v[140:143], a[160:163], v[112:115], v[140:143]
    s_waitcnt lgkmcnt(6)
    buffer_load_dwordx4 v1, s[16:19], s32 offen offset:3072 sc1 lds
    ds_read_b128 a[208:211], v3 offset:2048
    v_mfma_f32_16x16x32_bf16 v[156:159], a[176:179], v[112:115], v[44:47]
    s_add_u32 s32, s32, 0x80000
    v_exp_f32 v246, v190
    v_mfma_f32_16x16x32_bf16 v[156:159], a[180:183], v[116:119], v[156:159]
    s_waitcnt lgkmcnt(5)
    ds_read_b128 a[212:215], v3 offset:10240
    v_cvt_pk_bf16_f32 v222, v244, v245
    v_mfma_f32_16x16x32_bf16 v[156:159], a[184:187], v[120:123], v[156:159]
    v_exp_f32 v247, v191
    v_mfma_f32_16x16x32_bf16 v[156:159], a[188:191], v[124:127], v[156:159]
    ds_read_b128 a[216:219], v3 offset:3072
    v_or3_b32 v57, v57, v221, v222
    v_mfma_f32_16x16x32_bf16 v[152:155], a[188:191], v[108:111], v[40:43]
    ds_read_b128 a[220:223], v3 offset:11264
    v_cvt_pk_bf16_f32 v223, v246, v247
    v_mfma_f32_16x16x32_bf16 v[152:155], a[184:187], v[104:107], v[152:155]
    v_bitop3_b32 v57, v57, v223, s37 bitop3:0xa8
    v_cmp_ne_u32 vcc, 0, v57
    v_mfma_f32_16x16x32_bf16 v[152:155], a[180:183], v[100:103], v[152:155]
    v_mfma_f32_16x16x32_bf16 v[152:155], a[176:179], v[96:99], v[152:155]
    s_cbranch_vccnz k2_tramp_112
k2_ret_113:
    v_mfma_f32_16x16x32_bf16 v[248:251], v[60:63], v[208:211], v[248:251]
    v_exp_f32 v232, v128
    v_mfma_f32_16x16x32_bf16 v[248:251], v[60:63], v[216:219], v[248:251]
    s_mov_b32 m0, s35
    ds_read_b128 a[224:227], v3 offset:4096
    v_mfma_f32_16x16x32_bf16 v[252:255], v[60:63], v[220:223], v[252:255]
    s_add_u32 s53, s53, 16384
    buffer_load_dwordx4 v1, s[20:23], s33 offen offset:0 sc1 lds
    ds_read_b128 a[228:231], v3 offset:12288
    v_mfma_f32_16x16x32_bf16 v[252:255], v[60:63], v[212:215], v[252:255]
    s_waitcnt lgkmcnt(8)
    v_exp_f32 v233, v129
    v_mfma_f32_16x16x32_bf16 a[12:15], a[192:195], v[212:215], a[12:15]
    s_and_b32 s53, s53, 0xffff
    v_exp_f32 v234, v130
    v_mfma_f32_16x16x32_bf16 a[12:15], a[196:199], v[220:223], a[12:15]
    ds_read_b128 a[232:235], v3 offset:5120
    v_cvt_pk_bf16_f32 v192, v232, v233
    v_mfma_f32_16x16x32_bf16 a[8:11], a[196:199], v[216:219], a[8:11]
    v_exp_f32 v235, v131
    v_mfma_f32_16x16x32_bf16 a[8:11], a[192:195], v[208:211], a[8:11]
    s_waitcnt lgkmcnt(7)
    ds_read_b128 a[236:239], v3 offset:13312
    v_cvt_pk_bf16_f32 v193, v234, v235
    v_mfma_f32_16x16x32_bf16 a[24:27], a[200:203], v[208:211], a[24:27]
    s_add_u32 s35, s35, 0x4000
    v_exp_f32 v236, v144
    v_mfma_f32_16x16x32_bf16 a[24:27], a[204:207], v[216:219], a[24:27]
    buffer_load_dwordx4 v1, s[20:23], s33 offen offset:1024 sc1 lds
    ds_read_b128 a[240:243], v3 offset:6144
    v_mfma_f32_16x16x32_bf16 a[28:31], a[204:207], v[220:223], a[28:31]
    v_exp_f32 v237, v145
    v_mfma_f32_16x16x32_bf16 a[28:31], a[200:203], v[212:215], a[28:31]
    s_waitcnt lgkmcnt(7)
    ds_read_b128 a[244:247], v3 offset:14336
    v_cvt_pk_bf16_f32 v194, v236, v237
    v_mfma_f32_16x16x32_bf16 a[44:47], a[208:211], v[212:215], a[44:47]
    v_exp_f32 v238, v146
    v_mfma_f32_16x16x32_bf16 a[44:47], a[212:215], v[220:223], a[44:47]
    ds_read_b128 a[248:251], v3 offset:7168
    v_or3_b32 v57, v192, v193, v194
    v_mfma_f32_16x16x32_bf16 a[40:43], a[212:215], v[216:219], a[40:43]
    v_exp_f32 v239, v147
    v_mfma_f32_16x16x32_bf16 a[40:43], a[208:211], v[208:211], a[40:43]
    s_waitcnt lgkmcnt(7)
    ds_read_b128 a[252:255], v3 offset:15360
    v_cvt_pk_bf16_f32 v195, v238, v239
    v_mfma_f32_16x16x32_bf16 a[56:59], a[216:219], v[208:211], a[56:59]
    s_and_b32 s35, s35, 0xffff
    v_exp_f32 v240, v132
    v_mfma_f32_16x16x32_bf16 a[56:59], a[220:223], v[216:219], a[56:59]
    ds_read_b128 a[128:131], v2 offset:0
    v_add_u32 v3, s53, v56
    v_mfma_f32_16x16x32_bf16 a[60:63], a[220:223], v[220:223], a[60:63]
    v_exp_f32 v241, v133
    v_mfma_f32_16x16x32_bf16 a[60:63], a[216:219], v[212:215], a[60:63]
    s_waitcnt lgkmcnt(7)
    buffer_load_dwordx4 v1, s[20:23], s33 offen offset:2048 sc1 lds
    ds_read_b128 a[132:135], v2 offset:1024
    v_mfma_f32_16x16x32_bf16 a[76:79], a[224:227], v[212:215], a[76:79]
    v_exp_f32 v242, v134
    v_mfma_f32_16x16x32_bf16 a[76:79], a[228:231], v[220:223], a[76:79]
    s_or_b32 s35, s35, 0x10000
    ds_read_b128 a[136:139], v2 offset:2048
    v_cvt_pk_bf16_f32 v196, v240, v241
    v_mfma_f32_16x16x32_bf16 a[72:75], a[228:231], v[216:219], a[72:75]
    v_exp_f32 v243, v135
    v_mfma_f32_16x16x32_bf16 a[72:75], a[224:227], v[208:211], a[72:75]
    s_waitcnt lgkmcnt(7)
    ds_read_b128 a[140:143], v2 offset:3072
    v_or3_b32 v57, v57, v195, v196
    v_mfma_f32_16x16x32_bf16 a[88:91], a[232:235], v[208:211], a[88:91]
    v_exp_f32 v244, v148
    v_mfma_f32_16x16x32_bf16 a[88:91], a[236:239], v[216:219], a[88:91]
    ds_read_b128 a[144:147], v2 offset:4096
    v_cvt_pk_bf16_f32 v197, v242, v243
    v_mfma_f32_16x16x32_bf16 a[92:95], a[236:239], v[220:223], a[92:95]
    v_exp_f32 v245, v149
    v_mfma_f32_16x16x32_bf16 a[92:95], a[232:235], v[212:215], a[92:95]
    s_waitcnt lgkmcnt(7)
    buffer_load_dwordx4 v1, s[20:23], s33 offen offset:3072 sc1 lds
    ds_read_b128 a[148:151], v2 offset:5120
    v_mfma_f32_16x16x32_bf16 a[108:111], a[240:243], v[212:215], a[108:111]
    s_add_u32 s33, s33, 0x80000
    v_exp_f32 v246, v150
    v_mfma_f32_16x16x32_bf16 a[108:111], a[244:247], v[220:223], a[108:111]
    ds_read_b128 a[152:155], v2 offset:6144
    v_cvt_pk_bf16_f32 v198, v244, v245
    v_mfma_f32_16x16x32_bf16 a[104:107], a[244:247], v[216:219], a[104:107]
    v_exp_f32 v247, v151
    v_mfma_f32_16x16x32_bf16 a[104:107], a[240:243], v[208:211], a[104:107]
    s_waitcnt lgkmcnt(7)
    ds_read_b128 a[156:159], v2 offset:7168
    v_or3_b32 v57, v57, v197, v198
    v_mfma_f32_16x16x32_bf16 a[120:123], a[248:251], v[208:211], a[120:123]
    v_exp_f32 v232, v136
    v_mfma_f32_16x16x32_bf16 a[120:123], a[252:255], v[216:219], a[120:123]
    ds_read_b128 a[160:163], v2 offset:8192
    v_cvt_pk_bf16_f32 v199, v246, v247
    v_mfma_f32_16x16x32_bf16 a[124:127], a[252:255], v[220:223], a[124:127]
    v_exp_f32 v233, v137
    v_mfma_f32_16x16x32_bf16 a[124:127], a[248:251], v[212:215], a[124:127]
    s_waitcnt lgkmcnt(7)
    ds_read_b128 a[164:167], v2 offset:9216
    v_cvt_pk_bf16_f32 v200, v232, v233
    v_mfma_f32_16x16x32_bf16 v[160:163], a[128:131], v[96:99], v[16:19]
    s_waitcnt vmcnt(12)
    s_barrier
    v_exp_f32 v234, v138
    v_mfma_f32_16x16x32_bf16 v[160:163], a[132:135], v[100:103], v[160:163]
    s_waitcnt lgkmcnt(6)
    ds_read_b128 a[168:171], v2 offset:10240
    v_or3_b32 v57, v57, v199, v200
    v_mfma_f32_16x16x32_bf16 v[160:163], a[136:139], v[104:107], v[160:163]
    s_mov_b32 m0, s34
    v_exp_f32 v235, v139
    v_mfma_f32_16x16x32_bf16 v[160:163], a[140:143], v[108:111], v[160:163]
    s_add_u32 s36, s36, 64
    buffer_load_dwordx4 v1, s[16:19], s32 offen offset:0 sc1 lds
    ds_read_b128 a[172:175], v2 offset:11264
    v_mfma_f32_16x16x32_bf16 v[164:167], a[140:143], v[124:127], v[20:23]
    v_exp_f32 v236, v152
    v_mfma_f32_16x16x32_bf16 v[164:167], a[136:139], v[120:123], v[164:167]
    ds_read_b128 a[176:179], v2 offset:12288
    v_cvt_pk_bf16_f32 v201, v234, v235
    v_mfma_f32_16x16x32_bf16 v[164:167], a[132:135], v[116:119], v[164:167]
    s_add_u32 s52, s52, 16384
    v_exp_f32 v237, v153
    v_mfma_f32_16x16x32_bf16 v[164:167], a[128:131], v[112:115], v[164:167]
    s_waitcnt lgkmcnt(7)
    ds_read_b128 a[180:183], v2 offset:13312
    v_cvt_pk_bf16_f32 v202, v236, v237
    v_mfma_f32_16x16x32_bf16 v[180:183], a[144:147], v[112:115], v[36:39]
    s_add_u32 s34, s34, 0x4000
    v_exp_f32 v238, v154
    v_mfma_f32_16x16x32_bf16 v[180:183], a[148:151], v[116:119], v[180:183]
    s_waitcnt lgkmcnt(6)
    buffer_load_dwordx4 v1, s[16:19], s32 offen offset:1024 sc1 lds
    ds_read_b128 a[184:187], v2 offset:14336
    v_mfma_f32_16x16x32_bf16 v[180:183], a[152:155], v[120:123], v[180:183]
    s_and_b32 s52, s52, 0xffff
    v_exp_f32 v239, v155
    v_mfma_f32_16x16x32_bf16 v[180:183], a[156:159], v[124:127], v[180:183]
    ds_read_b128 a[188:191], v2 offset:15360
    v_or3_b32 v57, v57, v201, v202
    v_mfma_f32_16x16x32_bf16 v[176:179], a[156:159], v[108:111], v[32:35]
    v_exp_f32 v240, v140
    v_mfma_f32_16x16x32_bf16 v[176:179], a[152:155], v[104:107], v[176:179]
    v_cvt_pk_bf16_f32 v203, v238, v239
    v_add_u32 v2, s52, v1
    v_mfma_f32_16x16x32_bf16 v[176:179], a[148:151], v[100:103], v[176:179]
    s_and_b32 s34, s34, 0xffff
    v_exp_f32 v241, v141
    v_mfma_f32_16x16x32_bf16 v[176:179], a[144:147], v[96:99], v[176:179]
    s_waitcnt lgkmcnt(6)
    ds_read_b128 a[192:195], v3 offset:0
    v_cvt_pk_bf16_f32 v204, v240, v241
    v_mfma_f32_16x16x32_bf16 v[168:171], a[160:163], v[96:99], v[24:27]
    v_exp_f32 v242, v142
    v_mfma_f32_16x16x32_bf16 v[168:171], a[164:167], v[100:103], v[168:171]
    s_waitcnt lgkmcnt(5)
    buffer_load_dwordx4 v1, s[16:19], s32 offen offset:2048 sc1 lds
    ds_read_b128 a[196:199], v3 offset:8192
    v_mfma_f32_16x16x32_bf16 v[168:171], a[168:171], v[104:107], v[168:171]
    v_exp_f32 v243, v143
    v_mfma_f32_16x16x32_bf16 v[168:171], a[172:175], v[108:111], v[168:171]
    ds_read_b128 a[200:203], v3 offset:1024
    v_or3_b32 v57, v57, v203, v204
    v_mfma_f32_16x16x32_bf16 v[172:175], a[172:175], v[124:127], v[28:31]
    v_exp_f32 v244, v156
    v_mfma_f32_16x16x32_bf16 v[172:175], a[168:171], v[120:123], v[172:175]
    ds_read_b128 a[204:207], v3 offset:9216
    v_cvt_pk_bf16_f32 v205, v242, v243
    v_mfma_f32_16x16x32_bf16 v[172:175], a[164:167], v[116:119], v[172:175]
    v_exp_f32 v245, v157
    v_mfma_f32_16x16x32_bf16 v[172:175], a[160:163], v[112:115], v[172:175]
    s_waitcnt lgkmcnt(6)
    buffer_load_dwordx4 v1, s[16:19], s32 offen offset:3072 sc1 lds
    ds_read_b128 a[208:211], v3 offset:2048
    v_mfma_f32_16x16x32_bf16 v[188:191], a[176:179], v[112:115], v[44:47]
    s_sub_u32 s63, s63, 1
    v_exp_f32 v246, v158
    v_mfma_f32_16x16x32_bf16 v[188:191], a[180:183], v[116:119], v[188:191]
    s_waitcnt lgkmcnt(5)
    ds_read_b128 a[212:215], v3 offset:10240
    v_cvt_pk_bf16_f32 v206, v244, v245
    v_mfma_f32_16x16x32_bf16 v[188:191], a[184:187], v[120:123], v[188:191]
    s_add_u32 s32, s32, 0x80000
    v_exp_f32 v247, v159
    v_mfma_f32_16x16x32_bf16 v[188:191], a[188:191], v[124:127], v[188:191]
    ds_read_b128 a[216:219], v3 offset:3072
    v_or3_b32 v57, v57, v205, v206
    v_mfma_f32_16x16x32_bf16 v[184:187], a[188:191], v[108:111], v[40:43]
    ds_read_b128 a[220:223], v3 offset:11264
    v_cvt_pk_bf16_f32 v207, v246, v247
    v_mfma_f32_16x16x32_bf16 v[184:187], a[184:187], v[104:107], v[184:187]
    v_bitop3_b32 v57, v57, v207, s37 bitop3:0xa8
    v_cmp_ne_u32 vcc, 0, v57
    v_mfma_f32_16x16x32_bf16 v[184:187], a[180:183], v[100:103], v[184:187]
    v_mfma_f32_16x16x32_bf16 v[184:187], a[176:179], v[96:99], v[184:187]
    s_cbranch_vccnz k2_tramp_114
k2_ret_115:
    s_cmp_lg_u32 s63, 0
    s_cbranch_scc1 k2_sloop_110
    v_mfma_f32_16x16x32_bf16 v[248:251], v[60:63], v[192:195], v[248:251]
    v_exp_f32 v232, v160
    v_mfma_f32_16x16x32_bf16 v[248:251], v[60:63], v[200:203], v[248:251]
    s_mov_b32 m0, s35
    ds_read_b128 a[224:227], v3 offset:4096
    v_exp_f32 v233, v161
    v_mfma_f32_16x16x32_bf16 v[252:255], v[60:63], v[204:207], v[252:255]
    s_add_u32 s53, s53, 16384
    buffer_load_dwordx4 v1, s[20:23], s33 offen offset:0 sc1 lds
    ds_read_b128 a[228:231], v3 offset:12288
    v_mfma_f32_16x16x32_bf16 v[252:255], v[60:63], v[196:199], v[252:255]
    s_waitcnt lgkmcnt(8)
    v_exp_f32 v234, v162
    v_cvt_pk_bf16_f32 v208, v232, v233
    v_mfma_f32_16x16x32_bf16 a[12:15], a[192:195], v[196:199], a[12:15]
    s_sub_u32 s40, s36, s39
    ds_read_b128 a[232:235], v3 offset:5120
    v_mfma_f32_16x16x32_bf16 a[12:15], a[196:199], v[204:207], a[12:15]
    s_and_b32 s53, s53, 0xffff
    v_subrev_u32 v6, s40, v4
    v_cmp_gt_i32 s[44:45], 0, v6
    v_mfma_f32_16x16x32_bf16 a[8:11], a[196:199], v[200:203], a[8:11]
    v_exp_f32 v235, v163
    v_cmp_gt_i32 s[46:47], 1, v6
    v_mfma_f32_16x16x32_bf16 a[8:11], a[192:195], v[192:195], a[8:11]
    s_waitcnt lgkmcnt(7)
    ds_read_b128 a[236:239], v3 offset:13312
    v_cmp_gt_i32 s[48:49], 2, v6
    v_cmp_gt_i32 s[50:51], 3, v6
    v_mfma_f32_16x16x32_bf16 a[24:27], a[200:203], v[192:195], a[24:27]
    s_add_u32 s35, s35, 0x4000
    v_exp_f32 v236, v176
    v_mfma_f32_16x16x32_bf16 a[24:27], a[204:207], v[200:203], a[24:27]
    ds_read_b128 a[240:243], v3 offset:6144
    v_cvt_pk_bf16_f32 v209, v234, v235
    v_cndmask_b32 v16, v10, v5, s[44:45]
    v_mfma_f32_16x16x32_bf16 a[28:31], a[204:207], v[204:207], a[28:31]
    v_exp_f32 v237, v177
    v_mfma_f32_16x16x32_bf16 a[28:31], a[200:203], v[196:199], a[28:31]
    s_waitcnt lgkmcnt(7)
    ds_read_b128 a[244:247], v3 offset:14336
    v_cndmask_b32 v17, v10, v5, s[46:47]
    v_cndmask_b32 v18, v10, v5, s[48:49]
    v_mfma_f32_16x16x32_bf16 a[44:47], a[208:211], v[196:199], a[44:47]
    buffer_load_dwordx4 v1, s[20:23], s33 offen offset:1024 sc1 lds
    ds_read_b128 a[248:251], v3 offset:7168
    v_mfma_f32_16x16x32_bf16 a[44:47], a[212:215], v[204:207], a[44:47]
    v_cndmask_b32 v19, v10, v5, s[50:51]
    v_cvt_pk_bf16_f32 v210, v236, v237
    v_mfma_f32_16x16x32_bf16 a[40:43], a[212:215], v[200:203], a[40:43]
    v_exp_f32 v238, v178
    v_cmp_gt_i32 s[44:45], 16, v6
    v_mfma_f32_16x16x32_bf16 a[40:43], a[208:211], v[192:195], a[40:43]
    s_waitcnt lgkmcnt(7)
    v_cmp_gt_i32 s[46:47], 17, v6
    v_cmp_gt_i32 s[48:49], 18, v6
    v_mfma_f32_16x16x32_bf16 a[56:59], a[216:219], v[192:195], a[56:59]
    s_and_b32 s35, s35, 0xffff
    v_exp_f32 v239, v179
    v_mfma_f32_16x16x32_bf16 a[56:59], a[220:223], v[200:203], a[56:59]
    ds_read_b128 a[252:255], v3 offset:15360
    v_or3_b32 v57, v208, v209, v210
    v_cmp_gt_i32 s[50:51], 19, v6
    v_mfma_f32_16x16x32_bf16 a[60:63], a[220:223], v[204:207], a[60:63]
    v_exp_f32 v240, v164
    v_mfma_f32_16x16x32_bf16 a[60:63], a[216:219], v[196:199], a[60:63]
    s_waitcnt lgkmcnt(6)
    v_cndmask_b32 v32, v10, v5, s[44:45]
    v_cvt_pk_bf16_f32 v211, v238, v239
    v_cndmask_b32 v33, v10, v5, s[46:47]
    v_mfma_f32_16x16x32_bf16 a[76:79], a[224:227], v[196:199], a[76:79]
    ds_read_b128 a[128:131], v2 offset:0
    v_cndmask_b32 v34, v10, v5, s[48:49]
    v_mfma_f32_16x16x32_bf16 a[76:79], a[228:231], v[204:207], a[76:79]
    s_or_b32 s35, s35, 0x10000
    v_add_u32 v3, s53, v56
    v_cndmask_b32 v35, v10, v5, s[50:51]
    v_mfma_f32_16x16x32_bf16 a[72:75], a[228:231], v[200:203], a[72:75]
    buffer_load_dwordx4 v1, s[20:23], s33 offen offset:2048 sc1 lds
    v_exp_f32 v241, v165
    v_mfma_f32_16x16x32_bf16 a[72:75], a[224:227], v[192:195], a[72:75]
    s_waitcnt lgkmcnt(5)
    ds_read_b128 a[132:135], v2 offset:1024
    v_cmp_gt_i32 s[44:45], 32, v6
    v_mfma_f32_16x16x32_bf16 a[88:91], a[232:235], v[192:195], a[88:91]
    v_exp_f32 v242, v166
    v_cmp_gt_i32 s[46:47], 33, v6
    v_mfma_f32_16x16x32_bf16 a[88:91], a[236:239], v[200:203], a[88:91]
    ds_read_b128 a[136:139], v2 offset:2048
    v_cvt_pk_bf16_f32 v212, v240, v241
    v_mfma_f32_16x16x32_bf16 a[92:95], a[236:239], v[204:207], a[92:95]
    v_cmp_gt_i32 s[48:49], 34, v6
    v_cmp_gt_i32 s[50:51], 35, v6
    v_mfma_f32_16x16x32_bf16 a[92:95], a[232:235], v[196:199], a[92:95]
    s_waitcnt lgkmcnt(5)
    v_exp_f32 v243, v167
    v_or3_b32 v57, v57, v211, v212
    v_mfma_f32_16x16x32_bf16 a[108:111], a[240:243], v[196:199], a[108:111]
    ds_read_b128 a[140:143], v2 offset:3072
    v_cndmask_b32 v24, v10, v5, s[44:45]
    v_mfma_f32_16x16x32_bf16 a[108:111], a[244:247], v[204:207], a[108:111]
    v_cndmask_b32 v25, v10, v5, s[46:47]
    v_exp_f32 v244, v180
    v_mfma_f32_16x16x32_bf16 a[104:107], a[244:247], v[200:203], a[104:107]
    v_cvt_pk_bf16_f32 v213, v242, v243
    v_cndmask_b32 v26, v10, v5, s[48:49]
    v_mfma_f32_16x16x32_bf16 a[104:107], a[240:243], v[192:195], a[104:107]
    s_waitcnt lgkmcnt(4)
    ds_read_b128 a[144:147], v2 offset:4096
    v_cndmask_b32 v27, v10, v5, s[50:51]
    v_mfma_f32_16x16x32_bf16 a[120:123], a[248:251], v[192:195], a[120:123]
    v_exp_f32 v245, v181
    v_cmp_gt_i32 s[44:45], 48, v6
    v_mfma_f32_16x16x32_bf16 a[120:123], a[252:255], v[200:203], a[120:123]
    buffer_load_dwordx4 v1, s[20:23], s33 offen offset:3072 sc1 lds
    ds_read_b128 a[148:151], v2 offset:5120
    ds_read_b128 a[152:155], v2 offset:6144
    v_cmp_gt_i32 s[46:47], 49, v6
    s_add_u32 s33, s33, 0x80000
    v_cmp_gt_i32 s[48:49], 50, v6
    v_exp_f32 v246, v182
    v_cvt_pk_bf16_f32 v214, v244, v245
    v_cmp_gt_i32 s[50:51], 51, v6
    v_cndmask_b32 v40, v10, v5, s[44:45]
    v_mfma_f32_16x16x32_bf16 a[124:127], a[252:255], v[204:207], a[124:127]
    v_exp_f32 v247, v183
    v_or3_b32 v57, v57, v213, v214
    v_cndmask_b32 v41, v10, v5, s[46:47]
    v_mfma_f32_16x16x32_bf16 a[124:127], a[248:251], v[196:199], a[124:127]
    s_waitcnt lgkmcnt(5)
    ds_read_b128 a[156:159], v2 offset:7168
    v_cndmask_b32 v42, v10, v5, s[48:49]
    v_cndmask_b32 v43, v10, v5, s[50:51]
    v_mfma_f32_16x16x32_bf16 v[128:131], a[128:131], v[96:99], v[16:19]
    s_waitcnt vmcnt(4)
    s_barrier
    v_exp_f32 v232, v168
    v_mfma_f32_16x16x32_bf16 v[128:131], a[132:135], v[100:103], v[128:131]
    s_waitcnt lgkmcnt(4)
    ds_read_b128 a[160:163], v2 offset:8192
    v_cvt_pk_bf16_f32 v215, v246, v247
    v_mfma_f32_16x16x32_bf16 v[128:131], a[136:139], v[104:107], v[128:131]
    v_exp_f32 v233, v169
    v_mfma_f32_16x16x32_bf16 v[128:131], a[140:143], v[108:111], v[128:131]
    s_add_u32 s36, s36, 64
    ds_read_b128 a[164:167], v2 offset:9216
    v_cvt_pk_bf16_f32 v216, v232, v233
    v_mfma_f32_16x16x32_bf16 v[132:135], a[140:143], v[124:127], v[20:23]
    v_exp_f32 v234, v170
    v_mfma_f32_16x16x32_bf16 v[132:135], a[136:139], v[120:123], v[132:135]
    ds_read_b128 a[168:171], v2 offset:10240
    v_or3_b32 v57, v57, v215, v216
    v_mfma_f32_16x16x32_bf16 v[132:135], a[132:135], v[116:119], v[132:135]
    s_add_u32 s52, s52, 16384
    v_exp_f32 v235, v171
    v_mfma_f32_16x16x32_bf16 v[132:135], a[128:131], v[112:115], v[132:135]
    s_waitcnt lgkmcnt(5)
    ds_read_b128 a[172:175], v2 offset:11264
    v_cvt_pk_bf16_f32 v217, v234, v235
    v_mfma_f32_16x16x32_bf16 v[148:151], a[144:147], v[112:115], v[36:39]
    s_and_b32 s52, s52, 0xffff
    v_exp_f32 v236, v184
    v_mfma_f32_16x16x32_bf16 v[148:151], a[148:151], v[116:119], v[148:151]
    s_waitcnt lgkmcnt(4)
    ds_read_b128 a[176:179], v2 offset:12288
    ds_read_b128 a[180:183], v2 offset:13312
    v_mfma_f32_16x16x32_bf16 v[148:151], a[152:155], v[120:123], v[148:151]
    v_exp_f32 v237, v185
    v_mfma_f32_16x16x32_bf16 v[148:151], a[156:159], v[124:127], v[148:151]
    v_exp_f32 v238, v186
    v_mfma_f32_16x16x32_bf16 v[144:147], a[156:159], v[108:111], v[32:35]
    ds_read_b128 a[184:187], v2 offset:14336
    v_cvt_pk_bf16_f32 v218, v236, v237
    v_mfma_f32_16x16x32_bf16 v[144:147], a[152:155], v[104:107], v[144:147]
    v_exp_f32 v239, v187
    v_mfma_f32_16x16x32_bf16 v[144:147], a[148:151], v[100:103], v[144:147]
    ds_read_b128 a[188:191], v2 offset:15360
    v_or3_b32 v57, v57, v217, v218
    v_mfma_f32_16x16x32_bf16 v[144:147], a[144:147], v[96:99], v[144:147]
    s_waitcnt lgkmcnt(6)
    v_exp_f32 v240, v172
    v_mfma_f32_16x16x32_bf16 v[136:139], a[160:163], v[96:99], v[24:27]
    v_cvt_pk_bf16_f32 v219, v238, v239
    v_add_u32 v2, s52, v1
    v_mfma_f32_16x16x32_bf16 v[136:139], a[164:167], v[100:103], v[136:139]
    s_waitcnt lgkmcnt(4)
    v_exp_f32 v241, v173
    v_mfma_f32_16x16x32_bf16 v[136:139], a[168:171], v[104:107], v[136:139]
    ds_read_b128 a[192:195], v3 offset:0
    v_cvt_pk_bf16_f32 v220, v240, v241
    v_mfma_f32_16x16x32_bf16 v[136:139], a[172:175], v[108:111], v[136:139]
    v_exp_f32 v242, v174
    v_mfma_f32_16x16x32_bf16 v[140:143], a[172:175], v[124:127], v[28:31]
    ds_read_b128 a[196:199], v3 offset:8192
    v_or3_b32 v57, v57, v219, v220
    v_mfma_f32_16x16x32_bf16 v[140:143], a[168:171], v[120:123], v[140:143]
    v_exp_f32 v243, v175
    v_mfma_f32_16x16x32_bf16 v[140:143], a[164:167], v[116:119], v[140:143]
    ds_read_b128 a[200:203], v3 offset:1024
    v_cvt_pk_bf16_f32 v221, v242, v243
    v_mfma_f32_16x16x32_bf16 v[140:143], a[160:163], v[112:115], v[140:143]
    s_waitcnt lgkmcnt(5)
    v_exp_f32 v244, v188
    v_mfma_f32_16x16x32_bf16 v[156:159], a[176:179], v[112:115], v[44:47]
    ds_read_b128 a[204:207], v3 offset:9216
    ds_read_b128 a[208:211], v3 offset:2048
    v_mfma_f32_16x16x32_bf16 v[156:159], a[180:183], v[116:119], v[156:159]
    s_waitcnt lgkmcnt(5)
    v_exp_f32 v245, v189
    v_mfma_f32_16x16x32_bf16 v[156:159], a[184:187], v[120:123], v[156:159]
    v_exp_f32 v246, v190
    v_mfma_f32_16x16x32_bf16 v[156:159], a[188:191], v[124:127], v[156:159]
    ds_read_b128 a[212:215], v3 offset:10240
    v_cvt_pk_bf16_f32 v222, v244, v245
    v_mfma_f32_16x16x32_bf16 v[152:155], a[188:191], v[108:111], v[40:43]
    v_exp_f32 v247, v191
    v_mfma_f32_16x16x32_bf16 v[152:155], a[184:187], v[104:107], v[152:155]
    ds_read_b128 a[216:219], v3 offset:3072
    v_or3_b32 v57, v57, v221, v222
    v_mfma_f32_16x16x32_bf16 v[152:155], a[180:183], v[100:103], v[152:155]
    ds_read_b128 a[220:223], v3 offset:11264
    v_cvt_pk_bf16_f32 v223, v246, v247
    v_bitop3_b32 v57, v57, v223, s37 bitop3:0xa8
    v_mfma_f32_16x16x32_bf16 v[152:155], a[176:179], v[96:99], v[152:155]
    v_cmp_ne_u32 vcc, 0, v57
    s_cbranch_vccnz k2_tramp_116
k2_ret_117:
    v_mfma_f32_16x16x32_bf16 v[248:251], v[60:63], v[208:211], v[248:251]
    ds_read_b128 a[224:227], v3 offset:4096
    v_exp_f32 v232, v128
    v_mfma_f32_16x16x32_bf16 v[248:251], v[60:63], v[216:219], v[248:251]
    v_exp_f32 v233, v129
    v_mfma_f32_16x16x32_bf16 v[252:255], v[60:63], v[220:223], v[252:255]
    s_add_u32 s53, s53, 16384
    ds_read_b128 a[228:231], v3 offset:12288
    v_exp_f32 v234, v130
    v_mfma_f32_16x16x32_bf16 v[252:255], v[60:63], v[212:215], v[252:255]
    s_waitcnt lgkmcnt(8)
    v_cvt_pk_bf16_f32 v192, v232, v233
    v_exp_f32 v235, v131
    v_mfma_f32_16x16x32_bf16 a[12:15], a[192:195], v[212:215], a[12:15]
    s_sub_u32 s40, s36, s39
    s_sub_u32 s40, s40, 64
    ds_read_b128 a[232:235], v3 offset:5120
    v_mfma_f32_16x16x32_bf16 a[12:15], a[196:199], v[220:223], a[12:15]
    s_and_b32 s53, s53, 0xffff
    v_subrev_u32 v6, s40, v4
    v_cmp_gt_i32 s[44:45], 0, v6
    v_cvt_pk_bf16_f32 v193, v234, v235
    v_mfma_f32_16x16x32_bf16 a[8:11], a[196:199], v[216:219], a[8:11]
    v_exp_f32 v236, v144
    v_cmp_gt_i32 s[46:47], 1, v6
    v_mfma_f32_16x16x32_bf16 a[8:11], a[192:195], v[208:211], a[8:11]
    s_waitcnt lgkmcnt(7)
    ds_read_b128 a[236:239], v3 offset:13312
    v_exp_f32 v237, v145
    v_mfma_f32_16x16x32_bf16 a[24:27], a[200:203], v[208:211], a[24:27]
    ds_read_b128 a[240:243], v3 offset:6144
    v_cmp_gt_i32 s[48:49], 2, v6
    v_cmp_gt_i32 s[50:51], 3, v6
    v_mfma_f32_16x16x32_bf16 a[24:27], a[204:207], v[216:219], a[24:27]
    v_exp_f32 v238, v146
    v_cndmask_b32 v20, v11, v5, s[44:45]
    v_mfma_f32_16x16x32_bf16 a[28:31], a[204:207], v[220:223], a[28:31]
    v_cvt_pk_bf16_f32 v194, v236, v237
    v_cndmask_b32 v21, v11, v5, s[46:47]
    v_or3_b32 v57, v192, v193, v194
    v_mfma_f32_16x16x32_bf16 a[28:31], a[200:203], v[212:215], a[28:31]
    s_waitcnt lgkmcnt(7)
    v_exp_f32 v239, v147
    v_cndmask_b32 v22, v11, v5, s[48:49]
    v_mfma_f32_16x16x32_bf16 a[44:47], a[208:211], v[212:215], a[44:47]
    ds_read_b128 a[244:247], v3 offset:14336
    v_cndmask_b32 v23, v11, v5, s[50:51]
    v_cvt_pk_bf16_f32 v195, v238, v239
    v_mfma_f32_16x16x32_bf16 a[44:47], a[212:215], v[220:223], a[44:47]
    v_exp_f32 v240, v132
    v_cmp_gt_i32 s[44:45], 16, v6
    v_mfma_f32_16x16x32_bf16 a[40:43], a[212:215], v[216:219], a[40:43]
    ds_read_b128 a[248:251], v3 offset:7168
    v_cmp_gt_i32 s[46:47], 17, v6
    v_cmp_gt_i32 s[48:49], 18, v6
    v_mfma_f32_16x16x32_bf16 a[40:43], a[208:211], v[208:211], a[40:43]
    s_waitcnt lgkmcnt(7)
    ds_read_b128 a[252:255], v3 offset:15360
    v_exp_f32 v241, v133
    v_mfma_f32_16x16x32_bf16 a[56:59], a[216:219], v[208:211], a[56:59]
    v_exp_f32 v242, v134
    v_cmp_gt_i32 s[50:51], 19, v6
    v_mfma_f32_16x16x32_bf16 a[56:59], a[220:223], v[216:219], a[56:59]
    v_cvt_pk_bf16_f32 v196, v240, v241
    v_cndmask_b32 v36, v11, v5, s[44:45]
    v_or3_b32 v57, v57, v195, v196
    v_mfma_f32_16x16x32_bf16 a[60:63], a[220:223], v[220:223], a[60:63]
    v_exp_f32 v243, v135
    v_cndmask_b32 v37, v11, v5, s[46:47]
    v_mfma_f32_16x16x32_bf16 a[60:63], a[216:219], v[212:215], a[60:63]
    s_waitcnt lgkmcnt(6)
    ds_read_b128 a[128:131], v2 offset:0
    v_cndmask_b32 v38, v11, v5, s[48:49]
    v_add_u32 v3, s53, v56
    v_mfma_f32_16x16x32_bf16 a[76:79], a[224:227], v[212:215], a[76:79]
    ds_read_b128 a[132:135], v2 offset:1024
    v_exp_f32 v244, v148
    v_mfma_f32_16x16x32_bf16 a[76:79], a[228:231], v[220:223], a[76:79]
    ds_read_b128 a[136:139], v2 offset:2048
    v_cvt_pk_bf16_f32 v197, v242, v243
    v_cndmask_b32 v39, v11, v5, s[50:51]
    v_mfma_f32_16x16x32_bf16 a[72:75], a[228:231], v[216:219], a[72:75]
    v_cmp_gt_i32 s[44:45], 32, v6
    v_exp_f32 v245, v149
    v_mfma_f32_16x16x32_bf16 a[72:75], a[224:227], v[208:211], a[72:75]
    s_waitcnt lgkmcnt(7)
    ds_read_b128 a[140:143], v2 offset:3072
    ds_read_b128 a[144:147], v2 offset:4096
    v_cmp_gt_i32 s[46:47], 33, v6
    v_mfma_f32_16x16x32_bf16 a[88:91], a[232:235], v[208:211], a[88:91]
    v_exp_f32 v246, v150
    v_cmp_gt_i32 s[48:49], 34, v6
    v_mfma_f32_16x16x32_bf16 a[88:91], a[236:239], v[216:219], a[88:91]
    ds_read_b128 a[148:151], v2 offset:5120
    v_cvt_pk_bf16_f32 v198, v244, v245
    v_cmp_gt_i32 s[50:51], 35, v6
    v_mfma_f32_16x16x32_bf16 a[92:95], a[236:239], v[220:223], a[92:95]
    v_exp_f32 v247, v151
    v_or3_b32 v57, v57, v197, v198
    v_mfma_f32_16x16x32_bf16 a[92:95], a[232:235], v[212:215], a[92:95]
    s_waitcnt lgkmcnt(8)
    ds_read_b128 a[152:155], v2 offset:6144
    v_cndmask_b32 v28, v11, v5, s[44:45]
    v_cndmask_b32 v29, v11, v5, s[46:47]
    v_mfma_f32_16x16x32_bf16 a[108:111], a[240:243], v[212:215], a[108:111]
    ds_read_b128 a[156:159], v2 offset:7168
    v_exp_f32 v232, v136
    v_mfma_f32_16x16x32_bf16 a[108:111], a[244:247], v[220:223], a[108:111]
    ds_read_b128 a[160:163], v2 offset:8192
    v_cvt_pk_bf16_f32 v199, v246, v247
    v_cndmask_b32 v30, v11, v5, s[48:49]
    v_mfma_f32_16x16x32_bf16 a[104:107], a[244:247], v[216:219], a[104:107]
    v_cndmask_b32 v31, v11, v5, s[50:51]
    v_exp_f32 v233, v137
    v_mfma_f32_16x16x32_bf16 a[104:107], a[240:243], v[208:211], a[104:107]
    s_waitcnt lgkmcnt(9)
    ds_read_b128 a[164:167], v2 offset:9216
    ds_read_b128 a[168:171], v2 offset:10240
    v_cmp_gt_i32 s[44:45], 48, v6
    v_mfma_f32_16x16x32_bf16 a[120:123], a[248:251], v[208:211], a[120:123]
    v_exp_f32 v234, v138
    v_cmp_gt_i32 s[46:47], 49, v6
    v_mfma_f32_16x16x32_bf16 a[120:123], a[252:255], v[216:219], a[120:123]
    ds_read_b128 a[172:175], v2 offset:11264
    ds_read_b128 a[176:179], v2 offset:12288
    v_cvt_pk_bf16_f32 v200, v232, v233
    v_cmp_gt_i32 s[48:49], 50, v6
    v_exp_f32 v235, v139
    v_cmp_gt_i32 s[50:51], 51, v6
    v_or3_b32 v57, v57, v199, v200
    v_cndmask_b32 v44, v11, v5, s[44:45]
    v_mfma_f32_16x16x32_bf16 a[124:127], a[252:255], v[220:223], a[124:127]
    ds_read_b128 a[180:183], v2 offset:13312
    v_exp_f32 v236, v152
    v_cvt_pk_bf16_f32 v201, v234, v235
    v_cndmask_b32 v45, v11, v5, s[46:47]
    v_mfma_f32_16x16x32_bf16 a[124:127], a[248:251], v[212:215], a[124:127]
    s_waitcnt lgkmcnt(12)
    ds_read_b128 a[184:187], v2 offset:14336
    v_cndmask_b32 v46, v11, v5, s[48:49]
    v_cndmask_b32 v47, v11, v5, s[50:51]
    v_mfma_f32_16x16x32_bf16 v[164:167], a[128:131], v[112:115], v[20:23]
    v_exp_f32 v237, v153
    v_mfma_f32_16x16x32_bf16 v[164:167], a[132:135], v[116:119], v[164:167]
    s_waitcnt lgkmcnt(11)
    ds_read_b128 a[188:191], v2 offset:15360
    v_exp_f32 v238, v154
    v_mfma_f32_16x16x32_bf16 v[164:167], a[136:139], v[120:123], v[164:167]
    v_cvt_pk_bf16_f32 v202, v236, v237
    v_exp_f32 v239, v155
    v_mfma_f32_16x16x32_bf16 v[164:167], a[140:143], v[124:127], v[164:167]
    s_waitcnt lgkmcnt(10)
    s_waitcnt lgkmcnt(8)
    v_or3_b32 v57, v57, v201, v202
    v_mfma_f32_16x16x32_bf16 v[180:183], a[156:159], v[124:127], v[36:39]
    s_add_u32 s36, s36, 64
    ds_read_b128 a[192:195], v3 offset:0
    v_exp_f32 v240, v140
    v_mfma_f32_16x16x32_bf16 v[180:183], a[152:155], v[120:123], v[180:183]
    ds_read_b128 a[196:199], v3 offset:8192
    v_cvt_pk_bf16_f32 v203, v238, v239
    v_mfma_f32_16x16x32_bf16 v[180:183], a[148:151], v[116:119], v[180:183]
    s_add_u32 s52, s52, 16384
    ds_read_b128 a[200:203], v3 offset:1024
    v_exp_f32 v241, v141
    v_mfma_f32_16x16x32_bf16 v[180:183], a[144:147], v[112:115], v[180:183]
    s_waitcnt lgkmcnt(9)
    v_exp_f32 v242, v142
    v_cvt_pk_bf16_f32 v204, v240, v241
    v_mfma_f32_16x16x32_bf16 v[172:175], a[160:163], v[112:115], v[28:31]
    s_and_b32 s52, s52, 0xffff
    v_add_u32 v2, s52, v1
    v_exp_f32 v243, v143
    v_mfma_f32_16x16x32_bf16 v[172:175], a[164:167], v[116:119], v[172:175]
    s_waitcnt lgkmcnt(7)
    ds_read_b128 a[204:207], v3 offset:9216
    v_or3_b32 v57, v57, v203, v204
    v_cvt_pk_bf16_f32 v205, v242, v243
    v_mfma_f32_16x16x32_bf16 v[172:175], a[168:171], v[120:123], v[172:175]
    ds_read_b128 a[208:211], v3 offset:2048
    v_exp_f32 v244, v156
    v_mfma_f32_16x16x32_bf16 v[172:175], a[172:175], v[124:127], v[172:175]
    s_waitcnt lgkmcnt(7)
    s_waitcnt lgkmcnt(5)
    v_exp_f32 v245, v157
    v_mfma_f32_16x16x32_bf16 v[188:191], a[188:191], v[124:127], v[44:47]
    ds_read_b128 a[212:215], v3 offset:10240
    v_exp_f32 v246, v158
    v_mfma_f32_16x16x32_bf16 v[188:191], a[184:187], v[120:123], v[188:191]
    v_cvt_pk_bf16_f32 v206, v244, v245
    v_exp_f32 v247, v159
    v_mfma_f32_16x16x32_bf16 v[188:191], a[180:183], v[116:119], v[188:191]
    ds_read_b128 a[216:219], v3 offset:3072
    v_or3_b32 v57, v57, v205, v206
    v_cvt_pk_bf16_f32 v207, v246, v247
    v_mfma_f32_16x16x32_bf16 v[188:191], a[176:179], v[112:115], v[188:191]
    ds_read_b128 a[220:223], v3 offset:11264
    v_bitop3_b32 v57, v57, v207, s37 bitop3:0xa8
    v_cmp_ne_u32 vcc, 0, v57
    s_cbranch_vccnz k2_tramp_118
k2_ret_119:
k2_sdone_111:
    s_add_u32 s16, s6, 0x4811000
    s_addc_u32 s17, s7, 0
    s_and_b32 s17, s17, 0xffff
    s_mov_b32 s18, 0x4000
    s_mov_b32 s19, 0x00020000
    v_mfma_f32_16x16x32_bf16 v[248:251], v[60:63], v[192:195], v[248:251]
    s_waitcnt vmcnt(0)
    s_barrier
    v_exp_f32 v232, v164
    v_mfma_f32_16x16x32_bf16 v[248:251], v[60:63], v[200:203], v[248:251]
    ds_read_b128 a[224:227], v3 offset:4096
    s_cmp_eq_u32 s30, 0
    s_cbranch_scc1 k12_ool_122
k12_oolret_123:
    v_mfma_f32_16x16x32_bf16 v[252:255], v[60:63], v[204:207], v[252:255]
    s_add_u32 m0, s60, 0
    v_exp_f32 v233, v165
    v_mfma_f32_16x16x32_bf16 v[252:255], v[60:63], v[196:199], v[252:255]
    s_waitcnt lgkmcnt(7)
    buffer_load_dwordx4 v90, s[12:15], s61 offen offset:0 lds
    ds_read_b128 a[228:231], v3 offset:12288
    v_mfma_f32_16x16x32_bf16 a[12:15], a[192:195], v[196:199], a[12:15]
    s_add_u32 s53, s53, 16384
    v_exp_f32 v234, v166
    v_cvt_pk_bf16_f32 v212, v232, v233
    v_mfma_f32_16x16x32_bf16 a[12:15], a[196:199], v[204:207], a[12:15]
    s_and_b32 s53, s53, 0xffff
    buffer_load_dwordx4 v91, s[12:15], s61 offen offset:1024 lds
    ds_read_b128 a[232:235], v3 offset:5120
    v_mfma_f32_16x16x32_bf16 a[8:11], a[196:199], v[200:203], a[8:11]
    ds_read_b128 a[236:239], v3 offset:13312
    v_exp_f32 v235, v167
    v_mfma_f32_16x16x32_bf16 a[8:11], a[192:195], v[192:195], a[8:11]
    s_waitcnt lgkmcnt(8)
    v_exp_f32 v236, v180
    v_mfma_f32_16x16x32_bf16 a[24:27], a[200:203], v[192:195], a[24:27]
    buffer_load_dwordx4 v92, s[12:15], s61 offen offset:2048 lds
    ds_read_b128 a[240:243], v3 offset:6144
    v_mfma_f32_16x16x32_bf16 a[24:27], a[204:207], v[200:203], a[24:27]
    v_cvt_pk_bf16_f32 v213, v234, v235
    v_exp_f32 v237, v181
    v_mfma_f32_16x16x32_bf16 a[28:31], a[204:207], v[204:207], a[28:31]
    buffer_load_dwordx4 v93, s[12:15], s61 offen offset:3072 lds
    ds_read_b128 a[244:247], v3 offset:14336
    v_mfma_f32_16x16x32_bf16 a[28:31], a[200:203], v[196:199], a[28:31]
    s_waitcnt lgkmcnt(8)
    v_exp_f32 v238, v182
    v_cvt_pk_bf16_f32 v214, v236, v237
    v_mfma_f32_16x16x32_bf16 a[44:47], a[208:211], v[196:199], a[44:47]
    s_add_u32 s61, s61, 0x20000
    s_and_b32 s61, s61, 0x3fffff
    ds_read_b128 a[248:251], v3 offset:7168
    v_mfma_f32_16x16x32_bf16 a[44:47], a[212:215], v[204:207], a[44:47]
    s_add_u32 m0, s60, 16384
    v_exp_f32 v239, v183
    v_or3_b32 v57, v212, v213, v214
    v_mfma_f32_16x16x32_bf16 a[40:43], a[212:215], v[200:203], a[40:43]
    buffer_load_dwordx4 v90, s[12:15], s61 offen offset:0 lds
    buffer_load_dwordx4 v91, s[12:15], s61 offen offset:1024 lds
    ds_read_b128 a[252:255], v3 offset:15360
    v_mfma_f32_16x16x32_bf16 a[40:43], a[208:211], v[192:195], a[40:43]
    s_waitcnt lgkmcnt(8)
    v_exp_f32 v240, v172
    v_cvt_pk_bf16_f32 v215, v238, v239
    v_mfma_f32_16x16x32_bf16 a[56:59], a[216:219], v[192:195], a[56:59]
    v_mfma_f32_16x16x32_bf16 a[56:59], a[220:223], v[200:203], a[56:59]
    v_add_u32 v3, s53, v56
    ds_read_b128 a[192:195], v3 offset:0
    v_mfma_f32_16x16x32_bf16 a[60:63], a[220:223], v[204:207], a[60:63]
    ds_read_b128 a[196:199], v3 offset:8192
    v_exp_f32 v241, v173
    v_mfma_f32_16x16x32_bf16 a[60:63], a[216:219], v[196:199], a[60:63]
    s_waitcnt lgkmcnt(8)
    buffer_load_dwordx4 v92, s[12:15], s61 offen offset:2048 lds
    buffer_load_dwordx4 v93, s[12:15], s61 offen offset:3072 lds
    ds_read_b128 a[200:203], v3 offset:1024
    v_mfma_f32_16x16x32_bf16 a[76:79], a[224:227], v[196:199], a[76:79]
    v_exp_f32 v242, v174
    v_cvt_pk_bf16_f32 v220, v240, v241
    v_mfma_f32_16x16x32_bf16 a[76:79], a[228:231], v[204:207], a[76:79]
    ds_read_b128 a[204:207], v3 offset:9216
    ds_read_b128 a[208:211], v3 offset:2048
    v_or3_b32 v57, v57, v215, v220
    v_mfma_f32_16x16x32_bf16 a[72:75], a[228:231], v[200:203], a[72:75]
    s_add_u32 s61, s61, 0x20000
    s_and_b32 s61, s61, 0x3fffff
    ds_read_b128 a[212:215], v3 offset:10240
    v_exp_f32 v243, v175
    v_mfma_f32_16x16x32_bf16 a[72:75], a[224:227], v[192:195], a[72:75]
    s_waitcnt lgkmcnt(10)
    ds_read_b128 a[216:219], v3 offset:3072
    s_add_u32 m0, s60, 32768
    v_mfma_f32_16x16x32_bf16 a[88:91], a[232:235], v[192:195], a[88:91]
    buffer_load_dwordx4 v90, s[12:15], s61 offen offset:0 lds
    ds_read_b128 a[220:223], v3 offset:11264
    v_mfma_f32_16x16x32_bf16 a[88:91], a[236:239], v[200:203], a[88:91]
    v_exp_f32 v244, v188
    v_cvt_pk_bf16_f32 v221, v242, v243
    v_mfma_f32_16x16x32_bf16 a[92:95], a[236:239], v[204:207], a[92:95]
    buffer_load_dwordx4 v91, s[12:15], s61 offen offset:1024 lds
    ds_read_b128 a[224:227], v3 offset:4096
    v_mfma_f32_16x16x32_bf16 a[92:95], a[232:235], v[196:199], a[92:95]
    s_waitcnt lgkmcnt(11)
    ds_read_b128 a[228:231], v3 offset:12288
    v_exp_f32 v245, v189
    v_mfma_f32_16x16x32_bf16 a[108:111], a[240:243], v[196:199], a[108:111]
    buffer_load_dwordx4 v92, s[12:15], s61 offen offset:2048 lds
    ds_read_b128 a[232:235], v3 offset:5120
    v_mfma_f32_16x16x32_bf16 a[108:111], a[244:247], v[204:207], a[108:111]
    v_exp_f32 v246, v190
    v_mfma_f32_16x16x32_bf16 a[104:107], a[244:247], v[200:203], a[104:107]
    ds_read_b128 a[236:239], v3 offset:13312
    v_cvt_pk_bf16_f32 v222, v244, v245
    v_or3_b32 v57, v57, v221, v222
    v_mfma_f32_16x16x32_bf16 a[104:107], a[240:243], v[192:195], a[104:107]
    s_waitcnt lgkmcnt(12)
    v_exp_f32 v247, v191
    v_mfma_f32_16x16x32_bf16 a[120:123], a[248:251], v[192:195], a[120:123]
    buffer_load_dwordx4 v93, s[12:15], s61 offen offset:3072 lds
    ds_read_b128 a[240:243], v3 offset:6144
    ds_read_b128 a[244:247], v3 offset:14336
    v_mfma_f32_16x16x32_bf16 a[120:123], a[252:255], v[200:203], a[120:123]
    s_add_u32 s61, s61, 0x20000
    s_and_b32 s61, s61, 0x3fffff
    v_cvt_pk_bf16_f32 v223, v246, v247
    v_bitop3_b32 v57, v57, v223, s37 bitop3:0xa8
    v_mfma_f32_16x16x32_bf16 a[124:127], a[252:255], v[204:207], a[124:127]
    v_cmp_ne_u32 vcc, 0, v57
    v_mfma_f32_16x16x32_bf16 a[124:127], a[248:251], v[196:199], a[124:127]
    buffer_load_dword v74, v73, s[16:19], s59 offen sc1
    ds_read_b128 a[248:251], v3 offset:7168
    ds_read_b128 a[252:255], v3 offset:15360
    s_cbranch_vccnz k2_tramp_120
k2_ret_121:
    v_lshrrev_b32 v6, 4, v1
    v_and_b32 v6, 31, v6
    s_getpc_b64 s[40:41]
pc_124:
    s_add_u32 s40, s40, op_head-pc_124
    s_addc_u32 s41, s41, 0
    v_lshlrev_b32 v224, 7, v6
    v_mov_b32 v225, s41
    v_add_co_u32 v224, vcc, s40, v224
    s_nop 1
    v_addc_co_u32 v225, vcc, 0, v225, vcc
    global_load_dword v7, v[224:225], off
    v_mfma_f32_16x16x32_bf16 v[252:255], v[60:63], v[212:215], v[252:255]
    s_lshl_b32 s31, s28, 19
    v_mov_b32 v249, v248
    s_nop 1
    v_permlane16_swap_b32 v248, v249
    v_mfma_f32_16x16x32_bf16 v[252:255], v[60:63], v[220:223], v[252:255]
    s_waitcnt lgkmcnt(0)
    s_nop 1
    v_add_f32 v248, v248, v249
    v_mov_b32 v249, v248
    v_mfma_f32_16x16x32_bf16 a[12:15], a[196:199], v[220:223], a[12:15]
    s_lshl_b32 s44, s39, 6
    s_nop 1
    v_permlane32_swap_b32 v248, v249
    s_nop 1
    v_mfma_f32_16x16x32_bf16 a[12:15], a[192:195], v[212:215], a[12:15]
    s_add_u32 s44, s44, s31
    s_add_u32 s45, s44, 131072
    v_add_f32 v248, v248, v249
    v_rcp_f32 v249, v248
    v_mfma_f32_16x16x32_bf16 a[28:31], a[200:203], v[212:215], a[28:31]
    s_add_u32 s46, s44, 262144
    v_rcp_f32 v248, v248
    s_nop 0
    s_add_u32 s47, s44, 393216
    v_mfma_f32_16x16x32_bf16 a[28:31], a[204:207], v[220:223], a[28:31]
    s_add_u32 s48, s44, 4096
    v_accvgpr_read_b32 v132, a8
    v_accvgpr_read_b32 v133, a9
    v_accvgpr_read_b32 v134, a10
    v_mfma_f32_16x16x32_bf16 a[44:47], a[212:215], v[220:223], a[44:47]
    s_add_u32 s49, s44, 135168
    v_accvgpr_read_b32 v135, a11
    v_accvgpr_read_b32 v136, a24
    v_accvgpr_read_b32 v137, a25
    v_mfma_f32_16x16x32_bf16 a[44:47], a[208:211], v[212:215], a[44:47]
    s_add_u32 s50, s44, 266240
    v_accvgpr_read_b32 v138, a26
    v_accvgpr_read_b32 v139, a27
    v_mul_f32 v132, v132, v248
    v_mfma_f32_16x16x32_bf16 a[60:63], a[216:219], v[212:215], a[60:63]
    s_add_u32 s51, s44, 397312
    v_mul_f32 v133, v133, v248
    v_mul_f32 v134, v134, v248
    v_mul_f32 v135, v135, v248
    v_mfma_f32_16x16x32_bf16 a[60:63], a[220:223], v[220:223], a[60:63]
    v_mul_f32 v136, v136, v248
    v_mul_f32 v137, v137, v248
    v_mul_f32 v138, v138, v248
    v_mfma_f32_16x16x32_bf16 a[76:79], a[228:231], v[220:223], a[76:79]
    v_mul_f32 v139, v139, v248
    v_cvt_pk_bf16_f32 v128, v132, v133
    v_cvt_pk_bf16_f32 v129, v134, v135
    v_mfma_f32_16x16x32_bf16 a[76:79], a[224:227], v[212:215], a[76:79]
    v_cvt_pk_bf16_f32 v130, v136, v137
    v_cvt_pk_bf16_f32 v131, v138, v139
    buffer_store_dwordx4 v[128:131], v1, s[24:27], s44 offen sc1
    v_mfma_f32_16x16x32_bf16 a[92:95], a[232:235], v[212:215], a[92:95]
    v_accvgpr_read_b32 v144, a40
    v_accvgpr_read_b32 v145, a41
    v_accvgpr_read_b32 v146, a42
    v_mfma_f32_16x16x32_bf16 a[92:95], a[236:239], v[220:223], a[92:95]
    v_accvgpr_read_b32 v147, a43
    v_accvgpr_read_b32 v148, a56
    v_mov_b32 v253, v252
    v_mfma_f32_16x16x32_bf16 a[108:111], a[244:247], v[220:223], a[108:111]
    v_accvgpr_read_b32 v149, a57
    v_accvgpr_read_b32 v150, a58
    s_nop 1
    v_mfma_f32_16x16x32_bf16 a[108:111], a[240:243], v[212:215], a[108:111]
    v_accvgpr_read_b32 v151, a59
    v_permlane16_swap_b32 v252, v253
    v_mul_f32 v144, v144, v248
    v_mfma_f32_16x16x32_bf16 a[124:127], a[248:251], v[212:215], a[124:127]
    s_nop 1
    v_mul_f32 v145, v145, v248
    v_add_f32 v252, v252, v253
    v_mfma_f32_16x16x32_bf16 a[124:127], a[252:255], v[220:223], a[124:127]
    v_mul_f32 v146, v146, v248
    v_mov_b32 v253, v252
    v_mul_f32 v147, v147, v248
    s_nop 1
    v_mul_f32 v148, v148, v248
    v_mul_f32 v149, v149, v248
    v_permlane32_swap_b32 v252, v253
    v_mul_f32 v150, v150, v248
    s_nop 1
    v_mul_f32 v151, v151, v248
    v_add_f32 v252, v252, v253
    v_cvt_pk_bf16_f32 v140, v144, v145
    v_rcp_f32 v253, v252
    v_cvt_pk_bf16_f32 v141, v146, v147
    v_rcp_f32 v252, v252
    v_cvt_pk_bf16_f32 v142, v148, v149
    s_nop 0
    v_cvt_pk_bf16_f32 v143, v150, v151
    buffer_store_dwordx4 v[140:143], v1, s[24:27], s45 offen sc1
    v_accvgpr_read_b32 v156, a72
    v_accvgpr_read_b32 v157, a73
    v_accvgpr_read_b32 v158, a74
    v_accvgpr_read_b32 v159, a75
    v_accvgpr_read_b32 v160, a88
    v_accvgpr_read_b32 v161, a89
    v_accvgpr_read_b32 v162, a90
    v_accvgpr_read_b32 v163, a91
    v_mul_f32 v156, v156, v248
    v_mul_f32 v157, v157, v248
    v_mul_f32 v158, v158, v248
    v_mul_f32 v159, v159, v248
    v_mul_f32 v160, v160, v248
    v_mul_f32 v161, v161, v248
    v_mul_f32 v162, v162, v248
    v_mul_f32 v163, v163, v248
    v_cvt_pk_bf16_f32 v152, v156, v157
    v_cvt_pk_bf16_f32 v153, v158, v159
    v_cvt_pk_bf16_f32 v154, v160, v161
    v_cvt_pk_bf16_f32 v155, v162, v163
    buffer_store_dwordx4 v[152:155], v1, s[24:27], s46 offen sc1
    v_accvgpr_read_b32 v168, a104
    v_accvgpr_read_b32 v169, a105
    v_accvgpr_read_b32 v170, a106
    v_accvgpr_read_b32 v171, a107
    v_accvgpr_read_b32 v172, a120
    v_accvgpr_read_b32 v173, a121
    v_accvgpr_read_b32 v174, a122
    v_accvgpr_read_b32 v175, a123
    v_mul_f32 v168, v168, v248
    v_mul_f32 v169, v169, v248
    v_mul_f32 v170, v170, v248
    v_mul_f32 v171, v171, v248
    v_mul_f32 v172, v172, v248
    v_mul_f32 v173, v173, v248
    v_mul_f32 v174, v174, v248
    v_mul_f32 v175, v175, v248
    v_cvt_pk_bf16_f32 v164, v168, v169
    v_cvt_pk_bf16_f32 v165, v170, v171
    v_cvt_pk_bf16_f32 v166, v172, v173
    v_cvt_pk_bf16_f32 v167, v174, v175
    buffer_store_dwordx4 v[164:167], v1, s[24:27], s47 offen sc1
    v_accvgpr_read_b32 v132, a12
    v_accvgpr_read_b32 v133, a13
    v_accvgpr_read_b32 v134, a14
    v_accvgpr_read_b32 v135, a15
    v_accvgpr_read_b32 v136, a28
    v_accvgpr_read_b32 v137, a29
    v_accvgpr_read_b32 v138, a30
    v_accvgpr_read_b32 v139, a31
    v_pk_mul_f32 v[132:133], v[132:133], v[252:253]
    v_pk_mul_f32 v[134:135], v[134:135], v[252:253]
    v_pk_mul_f32 v[136:137], v[136:137], v[252:253]
    v_pk_mul_f32 v[138:139], v[138:139], v[252:253]
    v_cvt_pk_bf16_f32 v128, v132, v133
    v_cvt_pk_bf16_f32 v129, v134, v135
    v_cvt_pk_bf16_f32 v130, v136, v137
    v_cvt_pk_bf16_f32 v131, v138, v139
    v_accvgpr_read_b32 v144, a44
    v_accvgpr_read_b32 v145, a45
    v_accvgpr_read_b32 v146, a46
    v_accvgpr_read_b32 v147, a47
    v_accvgpr_read_b32 v148, a60
    v_accvgpr_read_b32 v149, a61
    v_accvgpr_read_b32 v150, a62
    v_accvgpr_read_b32 v151, a63
    v_pk_mul_f32 v[144:145], v[144:145], v[252:253]
    v_pk_mul_f32 v[146:147], v[146:147], v[252:253]
    v_pk_mul_f32 v[148:149], v[148:149], v[252:253]
    v_pk_mul_f32 v[150:151], v[150:151], v[252:253]
    v_cvt_pk_bf16_f32 v140, v144, v145
    v_cvt_pk_bf16_f32 v141, v146, v147
    v_cvt_pk_bf16_f32 v142, v148, v149
    v_cvt_pk_bf16_f32 v143, v150, v151
    v_accvgpr_read_b32 v156, a76
    v_accvgpr_read_b32 v157, a77
    v_accvgpr_read_b32 v158, a78
    v_accvgpr_read_b32 v159, a79
    v_accvgpr_read_b32 v160, a92
    v_accvgpr_read_b32 v161, a93
    v_accvgpr_read_b32 v162, a94
    v_accvgpr_read_b32 v163, a95
    v_pk_mul_f32 v[156:157], v[156:157], v[252:253]
    v_pk_mul_f32 v[158:159], v[158:159], v[252:253]
    v_pk_mul_f32 v[160:161], v[160:161], v[252:253]
    v_pk_mul_f32 v[162:163], v[162:163], v[252:253]
    v_cvt_pk_bf16_f32 v152, v156, v157
    v_cvt_pk_bf16_f32 v153, v158, v159
    v_cvt_pk_bf16_f32 v154, v160, v161
    v_cvt_pk_bf16_f32 v155, v162, v163
    v_accvgpr_read_b32 v168, a108
    v_accvgpr_read_b32 v169, a109
    v_accvgpr_read_b32 v170, a110
    v_accvgpr_read_b32 v171, a111
    v_accvgpr_read_b32 v172, a124
    v_accvgpr_read_b32 v173, a125
    v_accvgpr_read_b32 v174, a126
    v_accvgpr_read_b32 v175, a127
    v_pk_mul_f32 v[168:169], v[168:169], v[252:253]
    v_pk_mul_f32 v[170:171], v[170:171], v[252:253]
    v_pk_mul_f32 v[172:173], v[172:173], v[252:253]
    v_pk_mul_f32 v[174:175], v[174:175], v[252:253]
    v_cvt_pk_bf16_f32 v164, v168, v169
    v_cvt_pk_bf16_f32 v165, v170, v171
    v_cvt_pk_bf16_f32 v166, v172, v173
    v_cvt_pk_bf16_f32 v167, v174, v175
    buffer_store_dwordx4 v[128:131], v1, s[24:27], s48 offen sc1
    buffer_store_dwordx4 v[140:143], v1, s[24:27], s49 offen sc1
    buffer_store_dwordx4 v[152:155], v1, s[24:27], s50 offen sc1
    buffer_store_dwordx4 v[164:167], v1, s[24:27], s51 offen sc1
op_head:
    s_load_dwordx2 s[28:29], s[0:1], 0
    s_load_dwordx2 s[42:43], s[0:1], 56
    s_waitcnt vmcnt(8)
    v_cmp_le_u32 vcc, 4, v74
    v_mov_b32 v56, 0
    v_mov_b32 v57, 0
    v_mov_b32 v58, 0
    v_mov_b32 v59, 0
    s_nop 1
    v_mfma_f32_32x32x16_bf16 v[128:143], v[56:59], v[56:59], 0
    v_mfma_f32_32x32x16_bf16 v[144:159], v[56:59], v[56:59], 0
    v_mfma_f32_32x32x16_bf16 v[160:175], v[56:59], v[56:59], 0
    v_mfma_f32_32x32x16_bf16 v[176:191], v[56:59], v[56:59], 0
    s_mov_b32 s33, vcc_lo
    s_bitcmp1_b32 s33, 0
    s_cbranch_scc0 op_late_125
    buffer_load_dwordx4 a[128:131], v88, s[8:11], s62 offen offset:0 sc1
    buffer_load_dwordx4 a[132:135], v88, s[8:11], s62 offen offset:1024 sc1
    buffer_load_dwordx4 a[136:139], v89, s[8:11], s62 offen offset:0 sc1
    buffer_load_dwordx4 a[140:143], v89, s[8:11], s62 offen offset:1024 sc1
    s_add_u32 s62, s62, 0x40000
    s_and_b32 s62, s62, 0x7fffff
    buffer_load_dwordx4 a[144:147], v88, s[8:11], s62 offen offset:0 sc1
    buffer_load_dwordx4 a[148:151], v88, s[8:11], s62 offen offset:1024 sc1
    buffer_load_dwordx4 a[152:155], v89, s[8:11], s62 offen offset:0 sc1
    buffer_load_dwordx4 a[156:159], v89, s[8:11], s62 offen offset:1024 sc1
    s_add_u32 s62, s62, 0x40000
    s_and_b32 s62, s62, 0x7fffff
    buffer_load_dwordx4 a[160:163], v88, s[8:11], s62 offen offset:0 sc1
    buffer_load_dwordx4 a[164:167], v88, s[8:11], s62 offen offset:1024 sc1
    buffer_load_dwordx4 a[168:171], v89, s[8:11], s62 offen offset:0 sc1
    buffer_load_dwordx4 a[172:175], v89, s[8:11], s62 offen offset:1024 sc1
    s_add_u32 s62, s62, 0x40000
    s_and_b32 s62, s62, 0x7fffff
    s_waitcnt vmcnt(12)
    s_branch op_join_126
op_late_125:
    s_waitcnt vmcnt(0)
op_join_126:
    s_barrier
    s_cmp_eq_u32 s30, 0
    s_cbranch_scc1 k12_ool_127
k12_oolret_128:
    s_bitcmp0_b32 s33, 0
    s_cbranch_scc1 k12_ool_131
k12_oolret_132:
    ds_read_b64_tr_b16 a[0:1], v64 offset:0
    ds_read_b64_tr_b16 a[2:3], v64 offset:4096
    ds_read_b64_tr_b16 a[4:5], v65 offset:0
    ds_read_b64_tr_b16 a[6:7], v65 offset:4096
    ds_read_b64_tr_b16 a[8:9], v66 offset:0
    ds_read_b64_tr_b16 a[10:11], v66 offset:4096
    ds_read_b64_tr_b16 a[12:13], v67 offset:0
    ds_read_b64_tr_b16 a[14:15], v67 offset:4096
    ds_read_b64_tr_b16 a[16:17], v68 offset:0
    ds_read_b64_tr_b16 a[18:19], v68 offset:4096
    ds_read_b64_tr_b16 a[20:21], v69 offset:0
    ds_read_b64_tr_b16 a[22:23], v69 offset:4096
    ds_read_b64_tr_b16 a[24:25], v70 offset:0
    ds_read_b64_tr_b16 a[26:27], v70 offset:4096
    ds_read_b64_tr_b16 a[28:29], v71 offset:0
    ds_read_b64_tr_b16 a[30:31], v71 offset:4096
    ds_read_b64_tr_b16 a[32:33], v64 offset:8192
    ds_read_b64_tr_b16 a[34:35], v64 offset:12288
    ds_read_b64_tr_b16 a[36:37], v65 offset:8192
    ds_read_b64_tr_b16 a[38:39], v65 offset:12288
    ds_read_b64_tr_b16 a[40:41], v66 offset:8192
    ds_read_b64_tr_b16 a[42:43], v66 offset:12288
    ds_read_b64_tr_b16 a[44:45], v67 offset:8192
    ds_read_b64_tr_b16 a[46:47], v67 offset:12288
    ds_read_b64_tr_b16 a[48:49], v68 offset:8192
    ds_read_b64_tr_b16 a[50:51], v68 offset:12288
    ds_read_b64_tr_b16 a[52:53], v69 offset:8192
    ds_read_b64_tr_b16 a[54:55], v69 offset:12288
    ds_read_b64_tr_b16 a[56:57], v70 offset:8192
    ds_read_b64_tr_b16 a[58:59], v70 offset:12288
    ds_read_b64_tr_b16 a[60:61], v71 offset:8192
    ds_read_b64_tr_b16 a[62:63], v71 offset:12288
    s_add_u32 s24, s6, 0x4000000
    s_addc_u32 s25, s7, 0
    s_and_b32 s25, s25, 0xffff
    s_mov_b32 s26, 0x400000
    s_mov_b32 s27, 0x00020000
    s_add_u32 s36, s6, 0x5000000
    s_addc_u32 s37, s7, 0
    s_and_b32 s37, s37, 0xffff
    s_mov_b32 s38, 0x800000
    s_mov_b32 s39, 0x00020000
    s_add_u32 s48, s6, 0x4807000
    s_addc_u32 s49, s7, 0
    s_and_b32 s49, s49, 0xffff
    s_mov_b32 s50, 0x8000
    s_mov_b32 s51, 0x00020000
    s_lshl_b32 s52, s2, 14
    s_add_u32 s52, s52, s60
    s_xor_b32 s53, s52, 0x10000
    s_lshl_b32 s57, s2, 7
    s_xor_b32 s58, s57, 0x200
    v_lshrrev_b32 v56, 4, v1
    s_lshl_b32 s31, s30, 6
    s_and_b32 s31, s31, 64
    v_add_u32 v56, s31, v56
    s_mov_b32 s31, (code_end-op_tail)/128
    v_min_u32 v56, s31, v56
    s_getpc_b64 s[40:41]
pc_133:
    s_add_u32 s40, s40, op_tail-pc_133
    s_addc_u32 s41, s41, 0
    v_lshlrev_b32 v82, 7, v56
    v_mov_b32 v83, s41
    v_add_co_u32 v82, vcc, s40, v82
    s_nop 1
    v_addc_co_u32 v83, vcc, 0, v83, vcc
    v_lshlrev_b32 v94, 3, v1
    s_and_b32 s35, s2, 7
    s_mul_i32 s35, s35, 28
    s_lshr_b32 s31, s2, 3
    s_add_u32 s55, s35, s31
    s_lshl_b32 s3, s55, 15
    s_lshl_b32 s31, s30, 13
    s_add_u32 s3, s3, s31
    s_add_u32 s35, s31, 65536
    s_mov_b32 s63, 0
    s_waitcnt vmcnt(8) lgkmcnt(0)
    s_mov_b32 s20, s28
    s_and_b32 s21, s29, 0xffff
    s_mov_b32 s22, 0x400000
    s_mov_b32 s23, 0x00020000
    s_mov_b32 s44, s42
    s_and_b32 s45, s43, 0xffff
    s_mov_b32 s46, 0x800
    s_mov_b32 s47, 0x00020000
op_loop_134:
    v_mfma_f32_16x16x32_bf16 v[160:163], a[16:19], a[128:131], v[160:163]
    s_add_u32 m0, s60, 49152
    ds_read_b64_tr_b16 a[64:65], v64 offset:16384
    ds_read_b64_tr_b16 a[66:67], v64 offset:20480
    v_mfma_f32_16x16x32_bf16 v[160:163], a[48:51], a[136:139], v[160:163]
    buffer_load_dwordx4 v90, s[12:15], s61 offen offset:0 lds
    ds_read_b64_tr_b16 a[68:69], v65 offset:16384
    v_mfma_f32_16x16x32_bf16 v[164:167], a[48:51], a[140:143], v[164:167]
    ds_read_b64_tr_b16 a[70:71], v65 offset:20480
    ds_read_b64_tr_b16 a[72:73], v66 offset:16384
    v_mfma_f32_16x16x32_bf16 v[164:167], a[16:19], a[132:135], v[164:167]
    buffer_load_dwordx4 v91, s[12:15], s61 offen offset:1024 lds
    ds_read_b64_tr_b16 a[74:75], v66 offset:20480
    v_mfma_f32_16x16x32_bf16 v[172:175], a[20:23], a[132:135], v[172:175]
    ds_read_b64_tr_b16 a[76:77], v67 offset:16384
    ds_read_b64_tr_b16 a[78:79], v67 offset:20480
    v_mfma_f32_16x16x32_bf16 v[172:175], a[52:55], a[140:143], v[172:175]
    ds_read_b64_tr_b16 a[80:81], v68 offset:16384
    v_mfma_f32_16x16x32_bf16 v[168:171], a[52:55], a[136:139], v[168:171]
    ds_read_b64_tr_b16 a[82:83], v68 offset:20480
    v_mfma_f32_16x16x32_bf16 v[168:171], a[20:23], a[128:131], v[168:171]
    buffer_load_dwordx4 v92, s[12:15], s61 offen offset:2048 lds
    ds_read_b64_tr_b16 a[84:85], v69 offset:16384
    v_mfma_f32_16x16x32_bf16 v[176:179], a[24:27], a[128:131], v[176:179]
    ds_read_b64_tr_b16 a[86:87], v69 offset:20480
    ds_read_b64_tr_b16 a[88:89], v70 offset:16384
    v_mfma_f32_16x16x32_bf16 v[176:179], a[56:59], a[136:139], v[176:179]
    ds_read_b64_tr_b16 a[90:91], v70 offset:20480
    v_mfma_f32_16x16x32_bf16 v[180:183], a[56:59], a[140:143], v[180:183]
    buffer_load_dwordx4 v93, s[12:15], s61 offen offset:3072 lds
    ds_read_b64_tr_b16 a[92:93], v71 offset:16384
    v_mfma_f32_16x16x32_bf16 v[180:183], a[24:27], a[132:135], v[180:183]
    ds_read_b64_tr_b16 a[94:95], v71 offset:20480
    ds_read_b64_tr_b16 a[96:97], v64 offset:24576
    v_mfma_f32_16x16x32_bf16 v[188:191], a[28:31], a[132:135], v[188:191]
    ds_read_b64_tr_b16 a[98:99], v64 offset:28672
    v_mfma_f32_16x16x32_bf16 v[188:191], a[60:63], a[140:143], v[188:191]
    ds_read_b64_tr_b16 a[100:101], v65 offset:24576
    v_mfma_f32_16x16x32_bf16 v[184:187], a[60:63], a[136:139], v[184:187]
    buffer_load_dwordx4 a[176:179], v88, s[8:11], s62 offen offset:0 sc1
    ds_read_b64_tr_b16 a[102:103], v65 offset:28672
    v_mfma_f32_16x16x32_bf16 v[184:187], a[28:31], a[128:131], v[184:187]
    s_add_u32 s61, s61, 0x20000
    s_and_b32 s61, s61, 0x3fffff
    ds_read_b64_tr_b16 a[104:105], v66 offset:24576
    ds_read_b64_tr_b16 a[106:107], v66 offset:28672
    v_mfma_f32_16x16x32_bf16 v[128:131], a[0:3], a[128:131], v[128:131]
    ds_read_b64_tr_b16 a[108:109], v67 offset:24576
    v_mfma_f32_16x16x32_bf16 v[128:131], a[32:35], a[136:139], v[128:131]
    buffer_load_dwordx4 a[180:183], v88, s[8:11], s62 offen offset:1024 sc1
    ds_read_b64_tr_b16 a[110:111], v67 offset:28672
    v_mfma_f32_16x16x32_bf16 v[132:135], a[32:35], a[140:143], v[132:135]
    ds_read_b64_tr_b16 a[112:113], v68 offset:24576
    v_mfma_f32_16x16x32_bf16 v[132:135], a[0:3], a[132:135], v[132:135]
    ds_read_b64_tr_b16 a[114:115], v68 offset:28672
    ds_read_b64_tr_b16 a[116:117], v69 offset:24576
    v_mfma_f32_16x16x32_bf16 v[140:143], a[4:7], a[132:135], v[140:143]
    ds_read_b64_tr_b16 a[118:119], v69 offset:28672
    v_mfma_f32_16x16x32_bf16 v[140:143], a[36:39], a[140:143], v[140:143]
    buffer_load_dwordx4 a[184:187], v89, s[8:11], s62 offen offset:0 sc1
    ds_read_b64_tr_b16 a[120:121], v70 offset:24576
    v_mfma_f32_16x16x32_bf16 v[136:139], a[36:39], a[136:139], v[136:139]
    ds_read_b64_tr_b16 a[122:123], v70 offset:28672
    ds_read_b64_tr_b16 a[124:125], v71 offset:24576
    v_mfma_f32_16x16x32_bf16 v[136:139], a[4:7], a[128:131], v[136:139]
    ds_read_b64_tr_b16 a[126:127], v71 offset:28672
    v_mfma_f32_16x16x32_bf16 v[144:147], a[8:11], a[128:131], v[144:147]
    buffer_load_dwordx4 a[188:191], v89, s[8:11], s62 offen offset:1024 sc1
    v_mfma_f32_16x16x32_bf16 v[144:147], a[40:43], a[136:139], v[144:147]
    v_mfma_f32_16x16x32_bf16 v[148:151], a[40:43], a[140:143], v[148:151]
    v_mfma_f32_16x16x32_bf16 v[148:151], a[8:11], a[132:135], v[148:151]
    v_mfma_f32_16x16x32_bf16 v[156:159], a[12:15], a[132:135], v[156:159]
    s_cmp_eq_u32 s63, 7
    s_cbranch_scc1 k12_ool_137
k12_oolret_138:
    v_mfma_f32_16x16x32_bf16 v[156:159], a[44:47], a[140:143], v[156:159]
    s_add_u32 s62, s62, 0x40000
    s_and_b32 s62, s62, 0x7fffff
    v_mfma_f32_16x16x32_bf16 v[152:155], a[44:47], a[136:139], v[152:155]
    v_mfma_f32_16x16x32_bf16 v[152:155], a[12:15], a[128:131], v[152:155]
    s_waitcnt vmcnt(12) lgkmcnt(0)
    s_barrier
    v_mfma_f32_16x16x32_bf16 v[160:163], a[80:83], a[144:147], v[160:163]
    s_add_u32 s32, s63, 1
    s_lshr_b32 s32, s32, 1
    ds_read_b64_tr_b16 a[0:1], v64 offset:32768
    v_cmp_le_u32 vcc, 4, v74
    v_mfma_f32_16x16x32_bf16 v[160:163], a[112:115], a[152:155], v[160:163]
    s_add_u32 m0, s60, 0
    ds_read_b64_tr_b16 a[2:3], v64 offset:36864
    ds_read_b64_tr_b16 a[4:5], v65 offset:32768
    v_mfma_f32_16x16x32_bf16 v[164:167], a[112:115], a[156:159], v[164:167]
    s_or_b32 s33, vcc_lo, 16
    buffer_load_dwordx4 v90, s[12:15], s61 offen offset:0 lds
    ds_read_b64_tr_b16 a[6:7], v65 offset:36864
    v_mfma_f32_16x16x32_bf16 v[164:167], a[80:83], a[148:151], v[164:167]
    ds_read_b64_tr_b16 a[8:9], v66 offset:32768
    ds_read_b64_tr_b16 a[10:11], v66 offset:36864
    v_mfma_f32_16x16x32_bf16 v[172:175], a[84:87], a[148:151], v[172:175]
    buffer_load_dwordx4 v91, s[12:15], s61 offen offset:1024 lds
    ds_read_b64_tr_b16 a[12:13], v67 offset:32768
    v_mfma_f32_16x16x32_bf16 v[172:175], a[116:119], a[156:159], v[172:175]
    ds_read_b64_tr_b16 a[14:15], v67 offset:36864
    ds_read_b64_tr_b16 a[16:17], v68 offset:32768
    v_mfma_f32_16x16x32_bf16 v[168:171], a[116:119], a[152:155], v[168:171]
    s_bitcmp0_b32 s33, s32
    s_cbranch_scc1 k12_ool_141
k12_oolret_142:
    v_mfma_f32_16x16x32_bf16 v[168:171], a[84:87], a[144:147], v[168:171]
    ds_read_b64_tr_b16 a[18:19], v68 offset:36864
    ds_read_b64_tr_b16 a[20:21], v69 offset:32768
    v_mfma_f32_16x16x32_bf16 v[176:179], a[88:91], a[144:147], v[176:179]
    buffer_load_dwordx4 v92, s[12:15], s61 offen offset:2048 lds
    ds_read_b64_tr_b16 a[22:23], v69 offset:36864
    v_mfma_f32_16x16x32_bf16 v[176:179], a[120:123], a[152:155], v[176:179]
    ds_read_b64_tr_b16 a[24:25], v70 offset:32768
    ds_read_b64_tr_b16 a[26:27], v70 offset:36864
    v_mfma_f32_16x16x32_bf16 v[180:183], a[120:123], a[156:159], v[180:183]
    buffer_load_dwordx4 v93, s[12:15], s61 offen offset:3072 lds
    ds_read_b64_tr_b16 a[28:29], v71 offset:32768
    v_mfma_f32_16x16x32_bf16 v[180:183], a[88:91], a[148:151], v[180:183]
    ds_read_b64_tr_b16 a[30:31], v71 offset:36864
    ds_read_b64_tr_b16 a[32:33], v64 offset:40960
    v_mfma_f32_16x16x32_bf16 v[188:191], a[92:95], a[148:151], v[188:191]
    ds_read_b64_tr_b16 a[34:35], v64 offset:45056
    v_mfma_f32_16x16x32_bf16 v[188:191], a[124:127], a[156:159], v[188:191]
    ds_read_b64_tr_b16 a[36:37], v65 offset:40960
    v_mfma_f32_16x16x32_bf16 v[184:187], a[124:127], a[152:155], v[184:187]
    buffer_load_dwordx4 a[128:131], v88, s[8:11], s62 offen offset:0 sc1
    ds_read_b64_tr_b16 a[38:39], v65 offset:45056
    v_mfma_f32_16x16x32_bf16 v[184:187], a[92:95], a[144:147], v[184:187]
    s_add_u32 s61, s61, 0x20000
    s_and_b32 s61, s61, 0x3fffff
    ds_read_b64_tr_b16 a[40:41], v66 offset:40960
    ds_read_b64_tr_b16 a[42:43], v66 offset:45056
    v_mfma_f32_16x16x32_bf16 v[128:131], a[64:67], a[144:147], v[128:131]
    ds_read_b64_tr_b16 a[44:45], v67 offset:40960
    v_mfma_f32_16x16x32_bf16 v[128:131], a[96:99], a[152:155], v[128:131]
    buffer_load_dwordx4 a[132:135], v88, s[8:11], s62 offen offset:1024 sc1
    ds_read_b64_tr_b16 a[46:47], v67 offset:45056
    v_mfma_f32_16x16x32_bf16 v[132:135], a[96:99], a[156:159], v[132:135]
    ds_read_b64_tr_b16 a[48:49], v68 offset:40960
    v_mfma_f32_16x16x32_bf16 v[132:135], a[64:67], a[148:151], v[132:135]
    ds_read_b64_tr_b16 a[50:51], v68 offset:45056
    ds_read_b64_tr_b16 a[52:53], v69 offset:40960
    v_mfma_f32_16x16x32_bf16 v[140:143], a[68:71], a[148:151], v[140:143]
    ds_read_b64_tr_b16 a[54:55], v69 offset:45056
    v_mfma_f32_16x16x32_bf16 v[140:143], a[100:103], a[156:159], v[140:143]
    buffer_load_dwordx4 a[136:139], v89, s[8:11], s62 offen offset:0 sc1
    ds_read_b64_tr_b16 a[56:57], v70 offset:40960
    v_mfma_f32_16x16x32_bf16 v[136:139], a[100:103], a[152:155], v[136:139]
    ds_read_b64_tr_b16 a[58:59], v70 offset:45056
    ds_read_b64_tr_b16 a[60:61], v71 offset:40960
    v_mfma_f32_16x16x32_bf16 v[136:139], a[68:71], a[144:147], v[136:139]
    ds_read_b64_tr_b16 a[62:63], v71 offset:45056
    v_mfma_f32_16x16x32_bf16 v[144:147], a[72:75], a[144:147], v[144:147]
    buffer_load_dwordx4 a[140:143], v89, s[8:11], s62 offen offset:1024 sc1
    v_mfma_f32_16x16x32_bf16 v[144:147], a[104:107], a[152:155], v[144:147]
    v_mfma_f32_16x16x32_bf16 v[148:151], a[104:107], a[156:159], v[148:151]
    s_cmp_eq_u32 s63, 6
    s_cbranch_scc1 k12_ool_143
k12_oolret_144:
    v_mfma_f32_16x16x32_bf16 v[148:151], a[72:75], a[148:151], v[148:151]
    v_mfma_f32_16x16x32_bf16 v[156:159], a[76:79], a[148:151], v[156:159]
    v_mfma_f32_16x16x32_bf16 v[156:159], a[108:111], a[156:159], v[156:159]
    s_add_u32 s62, s62, 0x40000
    s_and_b32 s62, s62, 0x7fffff
    v_mfma_f32_16x16x32_bf16 v[152:155], a[108:111], a[152:155], v[152:155]
    v_mfma_f32_16x16x32_bf16 v[152:155], a[76:79], a[144:147], v[152:155]
    s_waitcnt vmcnt(12) lgkmcnt(0)
    s_barrier
    v_mfma_f32_16x16x32_bf16 v[160:163], a[16:19], a[160:163], v[160:163]
    s_add_u32 m0, s60, 16384
    buffer_load_dword v74, v73, s[16:19], s59 offen sc1
    ds_read_b64_tr_b16 a[64:65], v64 offset:49152
    v_mfma_f32_16x16x32_bf16 v[160:163], a[48:51], a[168:171], v[160:163]
    buffer_load_dwordx4 v90, s[12:15], s61 offen offset:0 lds
    ds_read_b64_tr_b16 a[66:67], v64 offset:53248
    v_mfma_f32_16x16x32_bf16 v[164:167], a[48:51], a[172:175], v[164:167]
    ds_read_b64_tr_b16 a[68:69], v65 offset:49152
    ds_read_b64_tr_b16 a[70:71], v65 offset:53248
    v_mfma_f32_16x16x32_bf16 v[164:167], a[16:19], a[164:167], v[164:167]
    ds_read_b64_tr_b16 a[72:73], v66 offset:49152
    ds_read_b64_tr_b16 a[74:75], v66 offset:53248
    v_mfma_f32_16x16x32_bf16 v[172:175], a[20:23], a[164:167], v[172:175]
    buffer_load_dwordx4 v91, s[12:15], s61 offen offset:1024 lds
    ds_read_b64_tr_b16 a[76:77], v67 offset:49152
    v_mfma_f32_16x16x32_bf16 v[172:175], a[52:55], a[172:175], v[172:175]
    ds_read_b64_tr_b16 a[78:79], v67 offset:53248
    ds_read_b64_tr_b16 a[80:81], v68 offset:49152
    v_mfma_f32_16x16x32_bf16 v[168:171], a[52:55], a[168:171], v[168:171]
    ds_read_b64_tr_b16 a[82:83], v68 offset:53248
    v_mfma_f32_16x16x32_bf16 v[168:171], a[20:23], a[160:163], v[168:171]
    buffer_load_dwordx4 v92, s[12:15], s61 offen offset:2048 lds
    ds_read_b64_tr_b16 a[84:85], v69 offset:49152
    v_mfma_f32_16x16x32_bf16 v[176:179], a[24:27], a[160:163], v[176:179]
    ds_read_b64_tr_b16 a[86:87], v69 offset:53248
    ds_read_b64_tr_b16 a[88:89], v70 offset:49152
    v_mfma_f32_16x16x32_bf16 v[176:179], a[56:59], a[168:171], v[176:179]
    ds_read_b64_tr_b16 a[90:91], v70 offset:53248
    v_mfma_f32_16x16x32_bf16 v[180:183], a[56:59], a[172:175], v[180:183]
    buffer_load_dwordx4 v93, s[12:15], s61 offen offset:3072 lds
    ds_read_b64_tr_b16 a[92:93], v71 offset:49152
    v_mfma_f32_16x16x32_bf16 v[180:183], a[24:27], a[164:167], v[180:183]
    ds_read_b64_tr_b16 a[94:95], v71 offset:53248
    ds_read_b64_tr_b16 a[96:97], v64 offset:57344
    v_mfma_f32_16x16x32_bf16 v[188:191], a[28:31], a[164:167], v[188:191]
    ds_read_b64_tr_b16 a[98:99], v64 offset:61440
    v_mfma_f32_16x16x32_bf16 v[188:191], a[60:63], a[172:175], v[188:191]
    ds_read_b64_tr_b16 a[100:101], v65 offset:57344
    v_mfma_f32_16x16x32_bf16 v[184:187], a[60:63], a[168:171], v[184:187]
    buffer_load_dwordx4 a[144:147], v88, s[8:11], s62 offen offset:0 sc1
    ds_read_b64_tr_b16 a[102:103], v65 offset:61440
    v_mfma_f32_16x16x32_bf16 v[184:187], a[28:31], a[160:163], v[184:187]
    s_add_u32 s61, s61, 0x20000
    s_and_b32 s61, s61, 0x3fffff
    ds_read_b64_tr_b16 a[104:105], v66 offset:57344
    ds_read_b64_tr_b16 a[106:107], v66 offset:61440
    v_mfma_f32_16x16x32_bf16 v[128:131], a[0:3], a[160:163], v[128:131]
    ds_read_b64_tr_b16 a[108:109], v67 offset:57344
    v_mfma_f32_16x16x32_bf16 v[128:131], a[32:35], a[168:171], v[128:131]
    buffer_load_dwordx4 a[148:151], v88, s[8:11], s62 offen offset:1024 sc1
    ds_read_b64_tr_b16 a[110:111], v67 offset:61440
    v_mfma_f32_16x16x32_bf16 v[132:135], a[32:35], a[172:175], v[132:135]
    ds_read_b64_tr_b16 a[112:113], v68 offset:57344
    v_mfma_f32_16x16x32_bf16 v[132:135], a[0:3], a[164:167], v[132:135]
    ds_read_b64_tr_b16 a[114:115], v68 offset:61440
    ds_read_b64_tr_b16 a[116:117], v69 offset:57344
    v_mfma_f32_16x16x32_bf16 v[140:143], a[4:7], a[164:167], v[140:143]
    ds_read_b64_tr_b16 a[118:119], v69 offset:61440
    v_mfma_f32_16x16x32_bf16 v[140:143], a[36:39], a[172:175], v[140:143]
    buffer_load_dwordx4 a[152:155], v89, s[8:11], s62 offen offset:0 sc1
    ds_read_b64_tr_b16 a[120:121], v70 offset:57344
    v_mfma_f32_16x16x32_bf16 v[136:139], a[36:39], a[168:171], v[136:139]
    ds_read_b64_tr_b16 a[122:123], v70 offset:61440
    ds_read_b64_tr_b16 a[124:125], v71 offset:57344
    v_mfma_f32_16x16x32_bf16 v[136:139], a[4:7], a[160:163], v[136:139]
    ds_read_b64_tr_b16 a[126:127], v71 offset:61440
    v_mfma_f32_16x16x32_bf16 v[144:147], a[8:11], a[160:163], v[144:147]
    buffer_load_dwordx4 a[156:159], v89, s[8:11], s62 offen offset:1024 sc1
    v_mfma_f32_16x16x32_bf16 v[144:147], a[40:43], a[168:171], v[144:147]
    v_mfma_f32_16x16x32_bf16 v[148:151], a[40:43], a[172:175], v[148:151]
    v_mfma_f32_16x16x32_bf16 v[148:151], a[8:11], a[164:167], v[148:151]
    v_mfma_f32_16x16x32_bf16 v[156:159], a[12:15], a[164:167], v[156:159]
    v_mfma_f32_16x16x32_bf16 v[156:159], a[44:47], a[172:175], v[156:159]
    s_add_u32 s62, s62, 0x40000
    s_and_b32 s62, s62, 0x7fffff
    v_mfma_f32_16x16x32_bf16 v[152:155], a[44:47], a[168:171], v[152:155]
    v_mfma_f32_16x16x32_bf16 v[152:155], a[12:15], a[160:163], v[152:155]
    s_waitcnt vmcnt(12) lgkmcnt(0)
    s_barrier
    v_mfma_f32_16x16x32_bf16 v[160:163], a[80:83], a[176:179], v[160:163]
    s_add_u32 m0, s60, 32768
    ds_read_b64_tr_b16 a[0:1], v64 offset:0
    ds_read_b64_tr_b16 a[2:3], v64 offset:4096
    v_mfma_f32_16x16x32_bf16 v[160:163], a[112:115], a[184:187], v[160:163]
    buffer_load_dwordx4 v90, s[12:15], s61 offen offset:0 lds
    ds_read_b64_tr_b16 a[4:5], v65 offset:0
    v_mfma_f32_16x16x32_bf16 v[164:167], a[112:115], a[188:191], v[164:167]
    ds_read_b64_tr_b16 a[6:7], v65 offset:4096
    ds_read_b64_tr_b16 a[8:9], v66 offset:0
    v_mfma_f32_16x16x32_bf16 v[164:167], a[80:83], a[180:183], v[164:167]
    buffer_load_dwordx4 v91, s[12:15], s61 offen offset:1024 lds
    ds_read_b64_tr_b16 a[10:11], v66 offset:4096
    v_mfma_f32_16x16x32_bf16 v[172:175], a[84:87], a[180:183], v[172:175]
    ds_read_b64_tr_b16 a[12:13], v67 offset:0
    ds_read_b64_tr_b16 a[14:15], v67 offset:4096
    v_mfma_f32_16x16x32_bf16 v[172:175], a[116:119], a[188:191], v[172:175]
    ds_read_b64_tr_b16 a[16:17], v68 offset:0
    v_mfma_f32_16x16x32_bf16 v[168:171], a[116:119], a[184:187], v[168:171]
    ds_read_b64_tr_b16 a[18:19], v68 offset:4096
    v_mfma_f32_16x16x32_bf16 v[168:171], a[84:87], a[176:179], v[168:171]
    buffer_load_dwordx4 v92, s[12:15], s61 offen offset:2048 lds
    ds_read_b64_tr_b16 a[20:21], v69 offset:0
    v_mfma_f32_16x16x32_bf16 v[176:179], a[88:91], a[176:179], v[176:179]
    ds_read_b64_tr_b16 a[22:23], v69 offset:4096
    ds_read_b64_tr_b16 a[24:25], v70 offset:0
    v_mfma_f32_16x16x32_bf16 v[176:179], a[120:123], a[184:187], v[176:179]
    ds_read_b64_tr_b16 a[26:27], v70 offset:4096
    v_mfma_f32_16x16x32_bf16 v[180:183], a[120:123], a[188:191], v[180:183]
    buffer_load_dwordx4 v93, s[12:15], s61 offen offset:3072 lds
    ds_read_b64_tr_b16 a[28:29], v71 offset:0
    v_mfma_f32_16x16x32_bf16 v[180:183], a[88:91], a[180:183], v[180:183]
    ds_read_b64_tr_b16 a[30:31], v71 offset:4096
    ds_read_b64_tr_b16 a[32:33], v64 offset:8192
    v_mfma_f32_16x16x32_bf16 v[188:191], a[92:95], a[180:183], v[188:191]
    ds_read_b64_tr_b16 a[34:35], v64 offset:12288
    v_mfma_f32_16x16x32_bf16 v[188:191], a[124:127], a[188:191], v[188:191]
    ds_read_b64_tr_b16 a[36:37], v65 offset:8192
    v_mfma_f32_16x16x32_bf16 v[184:187], a[124:127], a[184:187], v[184:187]
    buffer_load_dwordx4 a[160:163], v88, s[8:11], s62 offen offset:0 sc1
    ds_read_b64_tr_b16 a[38:39], v65 offset:12288
    v_mfma_f32_16x16x32_bf16 v[184:187], a[92:95], a[176:179], v[184:187]
    s_add_u32 s61, s61, 0x20000
    s_and_b32 s61, s61, 0x3fffff
    ds_read_b64_tr_b16 a[40:41], v66 offset:8192
    ds_read_b64_tr_b16 a[42:43], v66 offset:12288
    v_mfma_f32_16x16x32_bf16 v[128:131], a[64:67], a[176:179], v[128:131]
    ds_read_b64_tr_b16 a[44:45], v67 offset:8192
    v_mfma_f32_16x16x32_bf16 v[128:131], a[96:99], a[184:187], v[128:131]
    buffer_load_dwordx4 a[164:167], v88, s[8:11], s62 offen offset:1024 sc1
    ds_read_b64_tr_b16 a[46:47], v67 offset:12288
    v_mfma_f32_16x16x32_bf16 v[132:135], a[96:99], a[188:191], v[132:135]
    ds_read_b64_tr_b16 a[48:49], v68 offset:8192
    v_mfma_f32_16x16x32_bf16 v[132:135], a[64:67], a[180:183], v[132:135]
    ds_read_b64_tr_b16 a[50:51], v68 offset:12288
    ds_read_b64_tr_b16 a[52:53], v69 offset:8192
    v_mfma_f32_16x16x32_bf16 v[140:143], a[68:71], a[180:183], v[140:143]
    ds_read_b64_tr_b16 a[54:55], v69 offset:12288
    v_mfma_f32_16x16x32_bf16 v[140:143], a[100:103], a[188:191], v[140:143]
    buffer_load_dwordx4 a[168:171], v89, s[8:11], s62 offen offset:0 sc1
    ds_read_b64_tr_b16 a[56:57], v70 offset:8192
    v_mfma_f32_16x16x32_bf16 v[136:139], a[100:103], a[184:187], v[136:139]
    ds_read_b64_tr_b16 a[58:59], v70 offset:12288
    ds_read_b64_tr_b16 a[60:61], v71 offset:8192
    v_mfma_f32_16x16x32_bf16 v[136:139], a[68:71], a[176:179], v[136:139]
    ds_read_b64_tr_b16 a[62:63], v71 offset:12288
    v_mfma_f32_16x16x32_bf16 v[144:147], a[72:75], a[176:179], v[144:147]
    buffer_load_dwordx4 a[172:175], v89, s[8:11], s62 offen offset:1024 sc1
    v_mfma_f32_16x16x32_bf16 v[144:147], a[104:107], a[184:187], v[144:147]
    v_mfma_f32_16x16x32_bf16 v[148:151], a[104:107], a[188:191], v[148:151]
    v_mfma_f32_16x16x32_bf16 v[148:151], a[72:75], a[180:183], v[148:151]
    v_mfma_f32_16x16x32_bf16 v[156:159], a[76:79], a[180:183], v[156:159]
    v_mfma_f32_16x16x32_bf16 v[156:159], a[108:111], a[188:191], v[156:159]
    s_add_u32 s62, s62, 0x40000
    s_and_b32 s62, s62, 0x7fffff
    v_mfma_f32_16x16x32_bf16 v[152:155], a[108:111], a[184:187], v[152:155]
    s_add_u32 s63, s63, 1
    v_mfma_f32_16x16x32_bf16 v[152:155], a[76:79], a[176:179], v[152:155]
    s_waitcnt vmcnt(12) lgkmcnt(0)
    s_barrier
    s_cmp_lt_u32 s63, 8
    s_cbranch_scc1 op_loop_134
op_tail:
    s_nop 1
    v_cvt_pk_bf16_f32 v160, v160, v161
    v_cvt_pk_bf16_f32 v161, v162, v163
    v_cvt_pk_bf16_f32 v162, v164, v165
    v_cvt_pk_bf16_f32 v163, v166, v167
    v_min_u32 v160, -2, v160
    v_min_u32 v161, -2, v161
    v_min_u32 v162, -2, v162
    v_min_u32 v163, -2, v163
    buffer_store_dwordx4 v[160:163], v1, s[36:39], s52 offen offset:0 sc1
    v_cvt_pk_bf16_f32 v168, v168, v169
    v_cvt_pk_bf16_f32 v169, v170, v171
    v_cvt_pk_bf16_f32 v170, v172, v173
    v_cvt_pk_bf16_f32 v171, v174, v175
    v_min_u32 v168, -2, v168
    v_min_u32 v169, -2, v169
    v_min_u32 v170, -2, v170
    v_min_u32 v171, -2, v171
    buffer_store_dwordx4 v[168:171], v1, s[36:39], s52 offen offset:1024 sc1
    v_cvt_pk_bf16_f32 v176, v176, v177
    v_cvt_pk_bf16_f32 v177, v178, v179
    v_cvt_pk_bf16_f32 v178, v180, v181
    v_cvt_pk_bf16_f32 v179, v182, v183
    v_min_u32 v176, -2, v176
    v_min_u32 v177, -2, v177
    v_min_u32 v178, -2, v178
    v_min_u32 v179, -2, v179
    buffer_store_dwordx4 v[176:179], v1, s[36:39], s52 offen offset:2048 sc1
    v_cvt_pk_bf16_f32 v184, v184, v185
    v_cvt_pk_bf16_f32 v185, v186, v187
    v_cvt_pk_bf16_f32 v186, v188, v189
    v_cvt_pk_bf16_f32 v187, v190, v191
    v_min_u32 v184, -2, v184
    v_min_u32 v185, -2, v185
    v_min_u32 v186, -2, v186
    v_min_u32 v187, -2, v187
    buffer_store_dwordx4 v[184:187], v1, s[36:39], s52 offen offset:3072 sc1
    s_add_u32 s32, s6, 0x4800000
    s_addc_u32 s33, s7, 0
    s_and_b32 s33, s33, 0xffff
    s_mov_b32 s34, 0x6000
    s_mov_b32 s35, 0x00020000
    s_waitcnt vmcnt(4) lgkmcnt(0)
    v_lshlrev_b32 v58, 16, v192
    v_and_b32 v59, 0xffff0000, v192
    v_pk_add_f32 v[128:129], v[128:129], v[58:59]
    v_lshlrev_b32 v58, 16, v193
    v_and_b32 v59, 0xffff0000, v193
    v_pk_add_f32 v[130:131], v[130:131], v[58:59]
    v_lshlrev_b32 v58, 16, v200
    v_and_b32 v59, 0xffff0000, v200
    v_pk_add_f32 v[132:133], v[132:133], v[58:59]
    v_lshlrev_b32 v58, 16, v201
    v_and_b32 v59, 0xffff0000, v201
    v_pk_add_f32 v[134:135], v[134:135], v[58:59]
    v_lshlrev_b32 v58, 16, v194
    v_and_b32 v59, 0xffff0000, v194
    v_pk_add_f32 v[136:137], v[136:137], v[58:59]
    v_lshlrev_b32 v58, 16, v195
    v_and_b32 v59, 0xffff0000, v195
    v_pk_add_f32 v[138:139], v[138:139], v[58:59]
    v_lshlrev_b32 v58, 16, v202
    v_and_b32 v59, 0xffff0000, v202
    v_pk_add_f32 v[140:141], v[140:141], v[58:59]
    v_lshlrev_b32 v58, 16, v203
    v_and_b32 v59, 0xffff0000, v203
    v_pk_add_f32 v[142:143], v[142:143], v[58:59]
    v_lshlrev_b32 v58, 16, v196
    v_and_b32 v59, 0xffff0000, v196
    v_pk_add_f32 v[144:145], v[144:145], v[58:59]
    v_lshlrev_b32 v58, 16, v197
    v_and_b32 v59, 0xffff0000, v197
    v_pk_add_f32 v[146:147], v[146:147], v[58:59]
    v_lshlrev_b32 v58, 16, v204
    v_and_b32 v59, 0xffff0000, v204
    v_pk_add_f32 v[148:149], v[148:149], v[58:59]
    v_lshlrev_b32 v58, 16, v205
    v_and_b32 v59, 0xffff0000, v205
    v_pk_add_f32 v[150:151], v[150:151], v[58:59]
    v_lshlrev_b32 v58, 16, v198
    v_and_b32 v59, 0xffff0000, v198
    v_pk_add_f32 v[152:153], v[152:153], v[58:59]
    v_lshlrev_b32 v58, 16, v199
    v_and_b32 v59, 0xffff0000, v199
    v_pk_add_f32 v[154:155], v[154:155], v[58:59]
    v_lshlrev_b32 v58, 16, v206
    v_and_b32 v59, 0xffff0000, v206
    v_pk_add_f32 v[156:157], v[156:157], v[58:59]
    v_lshlrev_b32 v58, 16, v207
    v_and_b32 v59, 0xffff0000, v207
    v_pk_add_f32 v[158:159], v[158:159], v[58:59]
    v_and_b32 v58, 1, v72
    v_lshrrev_b32 v59, 1, v72
    v_lshlrev_b32 v58, 5, v58
    v_lshl_add_u32 v58, v59, 4, v58
    v_lshlrev_b32 v59, 3, v72
    v_sub_u32 v58, v58, v59
    v_add_u32 v78, v78, v58
    v_add_u32 v79, v79, v58
    v_lshlrev_b32 v32, 16, v208
    v_and_b32 v33, 0xffff0000, v208
    v_lshlrev_b32 v34, 16, v209
    v_and_b32 v35, 0xffff0000, v209
    v_lshlrev_b32 v36, 16, v210
    v_and_b32 v37, 0xffff0000, v210
    v_lshlrev_b32 v38, 16, v211
    v_and_b32 v39, 0xffff0000, v211
    v_lshlrev_b32 v40, 16, v212
    v_and_b32 v41, 0xffff0000, v212
    v_lshlrev_b32 v42, 16, v213
    v_and_b32 v43, 0xffff0000, v213
    v_lshlrev_b32 v44, 16, v214
    v_and_b32 v45, 0xffff0000, v214
    v_lshlrev_b32 v46, 16, v215
    v_and_b32 v47, 0xffff0000, v215
    s_or_b32 s31, s54, s30
    s_cbranch_scc1 op_nowr_145
    v_pk_add_f32 v[56:57], v[32:33], v[34:35]
    v_pk_add_f32 v[56:57], v[56:57], v[36:37]
    v_pk_add_f32 v[56:57], v[56:57], v[38:39]
    v_pk_add_f32 v[56:57], v[56:57], v[40:41]
    v_pk_add_f32 v[56:57], v[56:57], v[42:43]
    v_pk_add_f32 v[56:57], v[56:57], v[44:45]
    v_pk_add_f32 v[56:57], v[56:57], v[46:47]
    v_add_f32 v56, v56, v57
    v_mov_b32 v57, v56
    s_nop 1
    v_permlane16_swap_b32 v56, v57
    s_nop 1
    v_add_f32 v56, v56, v57
    v_mov_b32 v57, v56
    s_nop 1
    v_permlane32_swap_b32 v56, v57
    s_nop 1
    v_add_f32 v56, v56, v57
    s_mov_b32 s31, 24704
    s_mov_b32 s34, 24708
    s_mov_b64 exec, 1
    buffer_atomic_add_f32 v56, v75, s[32:35], s31 offen
    s_mov_b64 exec, -1
    s_mov_b32 s34, 24576
op_nowr_145:
    v_mov_b32 v208, 0
    v_mov_b32 v209, 0
    v_mov_b32 v210, 0
    v_mov_b32 v211, 0
    v_mov_b32 v212, 0
    v_mov_b32 v213, 0
    v_mov_b32 v214, 0
    v_mov_b32 v215, 0
    v_mov_b32 v216, 0
    v_mov_b32 v217, 0
    v_mov_b32 v218, 0
    v_mov_b32 v219, 0
    s_mov_b32 s40, 1048576
op_xspin_146:
    buffer_load_dwordx4 v[224:227], v1, s[36:39], s53 offen offset:0 sc1
    buffer_load_dwordx4 v[228:231], v1, s[36:39], s53 offen offset:1024 sc1
    buffer_load_dwordx4 v[232:235], v1, s[36:39], s53 offen offset:2048 sc1
    buffer_load_dwordx4 v[236:239], v1, s[36:39], s53 offen offset:3072 sc1
    s_sub_u32 s40, s40, 1
    s_waitcnt vmcnt(0)
    s_cbranch_scc1 op_xok_147
    v_max3_u32 v56, v224, v225, v226
    v_max3_u32 v56, v56, v227, v228
    v_max3_u32 v56, v56, v229, v230
    v_max3_u32 v56, v56, v231, v232
    v_max3_u32 v56, v56, v233, v234
    v_max3_u32 v56, v56, v235, v236
    v_max3_u32 v56, v56, v237, v238
    v_max_u32 v56, v56, v239
    v_cmp_eq_u32 vcc, -1, v56
    s_cbranch_vccz op_xok_147
    s_sleep 2
    s_branch op_xspin_146
op_xok_147:
    v_lshlrev_b32 v56, 16, v224
    v_and_b32 v57, 0xffff0000, v224
    v_lshlrev_b32 v58, 16, v225
    v_and_b32 v59, 0xffff0000, v225
    v_pk_add_f32 v[128:129], v[128:129], v[56:57]
    v_pk_add_f32 v[130:131], v[130:131], v[58:59]
    v_cvt_pk_bf16_f32 v192, v128, v129
    v_cvt_pk_bf16_f32 v193, v130, v131
    v_lshlrev_b32 v128, 16, v192
    v_and_b32 v129, 0xffff0000, v192
    v_lshlrev_b32 v130, 16, v193
    v_and_b32 v131, 0xffff0000, v193
    v_pk_add_f32 v[208:209], v[208:209], v[128:129]
    v_pk_fma_f32 v[210:211], v[128:129], v[128:129], v[210:211]
    v_pk_fma_f32 v[212:213], v[128:129], v[32:33], v[212:213]
    v_pk_add_f32 v[208:209], v[208:209], v[130:131]
    v_pk_fma_f32 v[210:211], v[130:131], v[130:131], v[210:211]
    v_pk_fma_f32 v[212:213], v[130:131], v[34:35], v[212:213]
    v_lshlrev_b32 v56, 16, v226
    v_and_b32 v57, 0xffff0000, v226
    v_lshlrev_b32 v58, 16, v227
    v_and_b32 v59, 0xffff0000, v227
    v_pk_add_f32 v[132:133], v[132:133], v[56:57]
    v_pk_add_f32 v[134:135], v[134:135], v[58:59]
    v_cvt_pk_bf16_f32 v200, v132, v133
    v_cvt_pk_bf16_f32 v201, v134, v135
    v_lshlrev_b32 v132, 16, v200
    v_and_b32 v133, 0xffff0000, v200
    v_lshlrev_b32 v134, 16, v201
    v_and_b32 v135, 0xffff0000, v201
    v_pk_add_f32 v[214:215], v[214:215], v[132:133]
    v_pk_fma_f32 v[216:217], v[132:133], v[132:133], v[216:217]
    v_pk_fma_f32 v[218:219], v[132:133], v[32:33], v[218:219]
    v_pk_add_f32 v[214:215], v[214:215], v[134:135]
    v_pk_fma_f32 v[216:217], v[134:135], v[134:135], v[216:217]
    v_pk_fma_f32 v[218:219], v[134:135], v[34:35], v[218:219]
    v_lshlrev_b32 v56, 16, v228
    v_and_b32 v57, 0xffff0000, v228
    v_lshlrev_b32 v58, 16, v229
    v_and_b32 v59, 0xffff0000, v229
    v_pk_add_f32 v[136:137], v[136:137], v[56:57]
    v_pk_add_f32 v[138:139], v[138:139], v[58:59]
    v_cvt_pk_bf16_f32 v194, v136, v137
    v_cvt_pk_bf16_f32 v195, v138, v139
    v_lshlrev_b32 v136, 16, v194
    v_and_b32 v137, 0xffff0000, v194
    v_lshlrev_b32 v138, 16, v195
    v_and_b32 v139, 0xffff0000, v195
    v_permlane16_swap_b32 v192, v194
    v_permlane16_swap_b32 v193, v195
    buffer_store_dwordx4 v[192:195], v78, s[24:27], 0 offen offset:0 sc1
    v_pk_add_f32 v[208:209], v[208:209], v[136:137]
    v_pk_fma_f32 v[210:211], v[136:137], v[136:137], v[210:211]
    v_pk_fma_f32 v[212:213], v[136:137], v[36:37], v[212:213]
    v_pk_add_f32 v[208:209], v[208:209], v[138:139]
    v_pk_fma_f32 v[210:211], v[138:139], v[138:139], v[210:211]
    v_pk_fma_f32 v[212:213], v[138:139], v[38:39], v[212:213]
    v_lshlrev_b32 v56, 16, v230
    v_and_b32 v57, 0xffff0000, v230
    v_lshlrev_b32 v58, 16, v231
    v_and_b32 v59, 0xffff0000, v231
    v_pk_add_f32 v[140:141], v[140:141], v[56:57]
    v_pk_add_f32 v[142:143], v[142:143], v[58:59]
    v_cvt_pk_bf16_f32 v202, v140, v141
    v_cvt_pk_bf16_f32 v203, v142, v143
    v_lshlrev_b32 v140, 16, v202
    v_and_b32 v141, 0xffff0000, v202
    v_lshlrev_b32 v142, 16, v203
    v_and_b32 v143, 0xffff0000, v203
    v_permlane16_swap_b32 v200, v202
    v_permlane16_swap_b32 v201, v203
    buffer_store_dwordx4 v[200:203], v79, s[24:27], 0 offen offset:0 sc1
    v_pk_add_f32 v[214:215], v[214:215], v[140:141]
    v_pk_fma_f32 v[216:217], v[140:141], v[140:141], v[216:217]
    v_pk_fma_f32 v[218:219], v[140:141], v[36:37], v[218:219]
    v_pk_add_f32 v[214:215], v[214:215], v[142:143]
    v_pk_fma_f32 v[216:217], v[142:143], v[142:143], v[216:217]
    v_pk_fma_f32 v[218:219], v[142:143], v[38:39], v[218:219]
    v_lshlrev_b32 v56, 16, v232
    v_and_b32 v57, 0xffff0000, v232
    v_lshlrev_b32 v58, 16, v233
    v_and_b32 v59, 0xffff0000, v233
    v_pk_add_f32 v[144:145], v[144:145], v[56:57]
    v_pk_add_f32 v[146:147], v[146:147], v[58:59]
    v_cvt_pk_bf16_f32 v196, v144, v145
    v_cvt_pk_bf16_f32 v197, v146, v147
    v_lshlrev_b32 v144, 16, v196
    v_and_b32 v145, 0xffff0000, v196
    v_lshlrev_b32 v146, 16, v197
    v_and_b32 v147, 0xffff0000, v197
    v_pk_add_f32 v[208:209], v[208:209], v[144:145]
    v_pk_fma_f32 v[210:211], v[144:145], v[144:145], v[210:211]
    v_pk_fma_f32 v[212:213], v[144:145], v[40:41], v[212:213]
    v_pk_add_f32 v[208:209], v[208:209], v[146:147]
    v_pk_fma_f32 v[210:211], v[146:147], v[146:147], v[210:211]
    v_pk_fma_f32 v[212:213], v[146:147], v[42:43], v[212:213]
    v_lshlrev_b32 v56, 16, v234
    v_and_b32 v57, 0xffff0000, v234
    v_lshlrev_b32 v58, 16, v235
    v_and_b32 v59, 0xffff0000, v235
    v_pk_add_f32 v[148:149], v[148:149], v[56:57]
    v_pk_add_f32 v[150:151], v[150:151], v[58:59]
    v_cvt_pk_bf16_f32 v204, v148, v149
    v_cvt_pk_bf16_f32 v205, v150, v151
    v_lshlrev_b32 v148, 16, v204
    v_and_b32 v149, 0xffff0000, v204
    v_lshlrev_b32 v150, 16, v205
    v_and_b32 v151, 0xffff0000, v205
    v_pk_add_f32 v[214:215], v[214:215], v[148:149]
    v_pk_fma_f32 v[216:217], v[148:149], v[148:149], v[216:217]
    v_pk_fma_f32 v[218:219], v[148:149], v[40:41], v[218:219]
    v_pk_add_f32 v[214:215], v[214:215], v[150:151]
    v_pk_fma_f32 v[216:217], v[150:151], v[150:151], v[216:217]
    v_pk_fma_f32 v[218:219], v[150:151], v[42:43], v[218:219]
    v_lshlrev_b32 v56, 16, v236
    v_and_b32 v57, 0xffff0000, v236
    v_lshlrev_b32 v58, 16, v237
    v_and_b32 v59, 0xffff0000, v237
    v_pk_add_f32 v[152:153], v[152:153], v[56:57]
    v_pk_add_f32 v[154:155], v[154:155], v[58:59]
    v_cvt_pk_bf16_f32 v198, v152, v153
    v_cvt_pk_bf16_f32 v199, v154, v155
    v_lshlrev_b32 v152, 16, v198
    v_and_b32 v153, 0xffff0000, v198
    v_lshlrev_b32 v154, 16, v199
    v_and_b32 v155, 0xffff0000, v199
    v_permlane16_swap_b32 v196, v198
    v_permlane16_swap_b32 v197, v199
    buffer_store_dwordx4 v[196:199], v78, s[24:27], 0 offen offset:64 sc1
    v_pk_add_f32 v[208:209], v[208:209], v[152:153]
    v_pk_fma_f32 v[210:211], v[152:153], v[152:153], v[210:211]
    v_pk_fma_f32 v[212:213], v[152:153], v[44:45], v[212:213]
    v_pk_add_f32 v[208:209], v[208:209], v[154:155]
    v_pk_fma_f32 v[210:211], v[154:155], v[154:155], v[210:211]
    v_pk_fma_f32 v[212:213], v[154:155], v[46:47], v[212:213]
    v_lshlrev_b32 v56, 16, v238
    v_and_b32 v57, 0xffff0000, v238
    v_lshlrev_b32 v58, 16, v239
    v_and_b32 v59, 0xffff0000, v239
    v_pk_add_f32 v[156:157], v[156:157], v[56:57]
    v_pk_add_f32 v[158:159], v[158:159], v[58:59]
    v_cvt_pk_bf16_f32 v206, v156, v157
    v_cvt_pk_bf16_f32 v207, v158, v159
    v_lshlrev_b32 v156, 16, v206
    v_and_b32 v157, 0xffff0000, v206
    v_lshlrev_b32 v158, 16, v207
    v_and_b32 v159, 0xffff0000, v207
    v_permlane16_swap_b32 v204, v206
    v_permlane16_swap_b32 v205, v207
    buffer_store_dwordx4 v[204:207], v79, s[24:27], 0 offen offset:64 sc1
    v_pk_add_f32 v[214:215], v[214:215], v[156:157]
    v_pk_fma_f32 v[216:217], v[156:157], v[156:157], v[216:217]
    v_pk_fma_f32 v[218:219], v[156:157], v[44:45], v[218:219]
    v_pk_add_f32 v[214:215], v[214:215], v[158:159]
    v_pk_fma_f32 v[216:217], v[158:159], v[158:159], v[216:217]
    v_pk_fma_f32 v[218:219], v[158:159], v[46:47], v[218:219]
    v_add_f32 v48, v208, v209
    v_add_f32 v49, v210, v211
    v_add_f32 v50, v212, v213
    v_add_f32 v52, v214, v215
    v_add_f32 v53, v216, v217
    v_add_f32 v54, v218, v219
    v_mov_b32 v56, v48
    v_mov_b32 v57, v49
    v_mov_b32 v58, v50
    v_mov_b32 v59, v52
    v_mov_b32 v60, v53
    v_mov_b32 v61, v54
    s_nop 1
    v_permlane16_swap_b32 v48, v56
    v_permlane16_swap_b32 v49, v57
    v_permlane16_swap_b32 v50, v58
    v_permlane16_swap_b32 v52, v59
    v_permlane16_swap_b32 v53, v60
    v_permlane16_swap_b32 v54, v61
    s_nop 1
    v_add_f32 v48, v48, v56
    v_add_f32 v49, v49, v57
    v_add_f32 v50, v50, v58
    v_add_f32 v52, v52, v59
    v_add_f32 v53, v53, v60
    v_add_f32 v54, v54, v61
    v_mov_b32 v56, v48
    v_mov_b32 v57, v49
    v_mov_b32 v58, v50
    v_mov_b32 v59, v52
    v_mov_b32 v60, v53
    v_mov_b32 v61, v54
    s_nop 1
    v_permlane32_swap_b32 v48, v56
    v_permlane32_swap_b32 v49, v57
    v_permlane32_swap_b32 v50, v58
    v_permlane32_swap_b32 v52, v59
    v_permlane32_swap_b32 v53, v60
    v_permlane32_swap_b32 v54, v61
    s_nop 1
    v_add_f32 v48, v48, v56
    v_add_f32 v49, v49, v57
    v_add_f32 v50, v50, v58
    v_add_f32 v52, v52, v59
    v_add_f32 v53, v53, v60
    v_add_f32 v54, v54, v61
    v_cmp_eq_u32 s[40:41], 1, v72
    v_cmp_eq_u32 s[42:43], 2, v72
    s_nop 1
    v_cndmask_b32 v48, v48, v49, s[40:41]
    v_cndmask_b32 v48, v48, v50, s[42:43]
    buffer_atomic_add_f32 v48, v77, s[32:35], 0 offen offset:0
    v_cndmask_b32 v52, v52, v53, s[40:41]
    v_cndmask_b32 v52, v52, v54, s[42:43]
    buffer_atomic_add_f32 v52, v77, s[32:35], 0 offen offset:64
    s_load_dwordx2 s[42:43], s[0:1], 88
    s_load_dwordx2 s[56:57], s[0:1], 56
    s_add_u32 s16, s6, 0x4815000
    s_addc_u32 s17, s7, 0
    s_and_b32 s17, s17, 0xffff
    s_mov_b32 s18, 0x1000
    s_mov_b32 s19, 0x00020000
    v_lshrrev_b32 v3, 4, v1
    v_lshl_add_u32 v2, s30, 6, v3
    v_and_b32 v4, 31, v3
    v_lshrrev_b32 v5, 5, v3
    v_lshlrev_b32 v7, 4, v4
    v_and_b32 v8, 15, v3
    v_lshlrev_b32 v6, 7, v8
    s_bfe_u32 s31, s2, 0x20003
    s_lshl_b32 s31, s31, 7
    v_lshlrev_b32 v12, 9, v3
    v_and_b32 v14, 3, v3
    v_lshlrev_b32 v14, 7, v14
    s_and_b32 s59, s2, 7
    s_lshl_b32 s59, s59, 9
    s_setreg_imm32_b32 hwreg(HW_REG_MODE, 4, 2), 3
    s_waitcnt vmcnt(0) lgkmcnt(0)
    s_barrier
    s_cmp_lg_u32 s30, 0
    s_cbranch_scc1 ff_nosig_148
    s_mov_b64 exec, 0xff
    buffer_atomic_add v76, v12, s[16:19], s31 offen sc1
    s_mov_b64 exec, -1
ff_nosig_148:
    s_lshl_b32 s40, s30, 13
    s_add_u32 m0, s40, 65536
    s_add_u32 s41, s3, 0
    buffer_load_dwordx4 v1, s[44:47], s41 offen offset:0 sc1 lds
    buffer_load_dwordx4 v1, s[44:47], s41 offen offset:1024 sc1 lds
    buffer_load_dwordx4 v1, s[44:47], s41 offen offset:2048 sc1 lds
    buffer_load_dwordx4 v1, s[44:47], s41 offen offset:3072 sc1 lds
    s_waitcnt vmcnt(0)
    s_lshl_b32 s40, s30, 13
    s_add_u32 m0, s40, 69632
    s_add_u32 s41, s3, 4096
    buffer_load_dwordx4 v1, s[44:47], s41 offen offset:0 sc1 lds
    buffer_load_dwordx4 v1, s[44:47], s41 offen offset:1024 sc1 lds
    buffer_load_dwordx4 v1, s[44:47], s41 offen offset:2048 sc1 lds
    buffer_load_dwordx4 v1, s[44:47], s41 offen offset:3072 sc1 lds
    s_waitcnt vmcnt(0)
    s_lshl_b32 s40, s30, 13
    s_add_u32 m0, s40, 98304
    s_add_u32 s41, s3, 8388608
    buffer_load_dwordx4 v1, s[44:47], s41 offen offset:0 sc1 lds
    buffer_load_dwordx4 v1, s[44:47], s41 offen offset:1024 sc1 lds
    buffer_load_dwordx4 v1, s[44:47], s41 offen offset:2048 sc1 lds
    buffer_load_dwordx4 v1, s[44:47], s41 offen offset:3072 sc1 lds
    s_waitcnt vmcnt(0)
    s_lshl_b32 s40, s30, 13
    s_add_u32 m0, s40, 102400
    s_add_u32 s41, s3, 8392704
    buffer_load_dwordx4 v1, s[44:47], s41 offen offset:0 sc1 lds
    buffer_load_dwordx4 v1, s[44:47], s41 offen offset:1024 sc1 lds
    buffer_load_dwordx4 v1, s[44:47], s41 offen offset:2048 sc1 lds
    buffer_load_dwordx4 v1, s[44:47], s41 offen offset:3072 sc1 lds
    s_lshl_b32 s41, s30, 9
    s_add_u32 s41, s41, 131072
    v_lshrrev_b32 v9, 1, v1
    v_add_u32 v9, s41, v9
    ds_read_b64 v[96:97], v9 offset:0
    ds_read_b64 v[98:99], v9 offset:2048
    ds_read_b64 v[100:101], v9 offset:4096
    ds_read_b64 v[102:103], v9 offset:6144
    ds_read_b64 v[104:105], v9 offset:8192
    ds_read_b64 v[106:107], v9 offset:10240
    ds_read_b64 v[108:109], v9 offset:12288
    ds_read_b64 v[110:111], v9 offset:14336
    ds_read_b64 v[112:113], v9 offset:16384
    ds_read_b64 v[114:115], v9 offset:18432
    ds_read_b64 v[116:117], v9 offset:20480
    ds_read_b64 v[118:119], v9 offset:22528
    ds_read_b64 v[120:121], v9 offset:24576
    ds_read_b64 v[122:123], v9 offset:26624
    ds_read_b64 v[124:125], v9 offset:28672
    ds_read_b64 v[126:127], v9 offset:30720
    s_mov_b32 s54, 0x05040100
    s_mov_b32 s53, 0x07060302
    s_waitcnt lgkmcnt(0)
    v_perm_b32 v144, v98, v96, s54
    v_perm_b32 v145, v98, v96, s53
    v_perm_b32 v146, v99, v97, s54
    v_perm_b32 v147, v99, v97, s53
    v_perm_b32 v148, v102, v100, s54
    v_perm_b32 v149, v102, v100, s53
    v_perm_b32 v150, v103, v101, s54
    v_perm_b32 v151, v103, v101, s53
    v_perm_b32 v152, v106, v104, s54
    v_perm_b32 v153, v106, v104, s53
    v_perm_b32 v154, v107, v105, s54
    v_perm_b32 v155, v107, v105, s53
    v_perm_b32 v156, v110, v108, s54
    v_perm_b32 v157, v110, v108, s53
    v_perm_b32 v158, v111, v109, s54
    v_perm_b32 v159, v111, v109, s53
    v_perm_b32 v160, v114, v112, s54
    v_perm_b32 v161, v114, v112, s53
    v_perm_b32 v162, v115, v113, s54
    v_perm_b32 v163, v115, v113, s53
    v_perm_b32 v164, v118, v116, s54
    v_perm_b32 v165, v118, v116, s53
    v_perm_b32 v166, v119, v117, s54
    v_perm_b32 v167, v119, v117, s53
    v_perm_b32 v168, v122, v120, s54
    v_perm_b32 v169, v122, v120, s53
    v_perm_b32 v170, v123, v121, s54
    v_perm_b32 v171, v123, v121, s53
    v_perm_b32 v172, v126, v124, s54
    v_perm_b32 v173, v126, v124, s53
    v_perm_b32 v174, v127, v125, s54
    v_perm_b32 v175, v127, v125, s53
    s_mov_b32 s34, 24708
    s_mov_b32 s36, s42
    s_and_b32 s37, s43, 0xffff
    s_mov_b32 s38, 0x400000
    s_mov_b32 s39, 0x00020000
    s_add_u32 s48, s6, 0x4900000
    s_addc_u32 s49, s7, 0
    s_and_b32 s49, s49, 0xffff
    s_mov_b32 s50, 0x1c0000
    s_mov_b32 s51, 0x00020000
    v_lshlrev_b32 v10, 5, v2
    v_lshl_add_u32 v11, s30, 1, v5
    s_lshl_b32 s31, s2, 3
    v_add_u32 v11, s31, v11
    v_lshl_add_u32 v0, v11, 11, v7
    s_cmp_lg_u32 s30, 0
    s_cbranch_scc1 ff_go_149
    s_mov_b32 s52, 1048576
ff_poll_150:
    buffer_load_dword v13, v14, s[16:19], s59 offen sc1
    s_sub_u32 s52, s52, 1
    s_cbranch_scc1 ff_go_149
    s_waitcnt vmcnt(0)
    v_cmp_gt_u32 vcc, 64, v13
    s_cbranch_vccz ff_go_149
    s_sleep 4
    s_branch ff_poll_150
ff_go_149:
    s_barrier
    s_mov_b32 s31, 0
    buffer_load_dwordx4 v[16:19], v10, s[32:35], s31 offen sc1
    buffer_load_dwordx4 v[20:23], v10, s[32:35], s31 offen offset:16 sc1
    s_mov_b32 s31, 8192
    buffer_load_dwordx4 v[24:27], v10, s[32:35], s31 offen sc1
    buffer_load_dwordx4 v[28:31], v10, s[32:35], s31 offen offset:16 sc1
    s_mov_b32 s31, 16384
    buffer_load_dwordx4 v[32:35], v10, s[32:35], s31 offen sc1
    buffer_load_dwordx4 v[36:39], v10, s[32:35], s31 offen offset:16 sc1
    s_mov_b32 s31, 24704
    buffer_load_dword v10, v75, s[32:35], s31 offen sc1
    s_mov_b32 s52, 0x3a800000
    s_mov_b32 s53, 0x3a800000
    s_mov_b32 s54, 0x7ff
    v_mov_b32 v14, 0x3727c5ac
    v_mov_b32 v15, v14
    v_mov_b32 v12, 0xff800000
    v_mov_b32 v13, v12
    s_waitcnt vmcnt(0)
    v_sub_f32 v56, 0, v10
    v_sub_f32 v57, 0, v10
    v_pk_mul_f32 v[16:17], v[16:17], s[52:53]
    v_pk_fma_f32 v[24:25], v[24:25], s[52:53], v[14:15]
    v_pk_fma_f32 v[32:33], v[16:17], v[56:57], v[32:33]
    v_pk_fma_f32 v[24:25], v[16:17], v[16:17], v[24:25] neg_lo:[1,0,0] neg_hi:[1,0,0]
    v_pk_mul_f32 v[18:19], v[18:19], s[52:53]
    v_pk_fma_f32 v[26:27], v[26:27], s[52:53], v[14:15]
    v_pk_fma_f32 v[34:35], v[18:19], v[56:57], v[34:35]
    v_pk_fma_f32 v[26:27], v[18:19], v[18:19], v[26:27] neg_lo:[1,0,0] neg_hi:[1,0,0]
    v_pk_mul_f32 v[20:21], v[20:21], s[52:53]
    v_pk_fma_f32 v[28:29], v[28:29], s[52:53], v[14:15]
    v_pk_fma_f32 v[36:37], v[20:21], v[56:57], v[36:37]
    v_pk_fma_f32 v[28:29], v[20:21], v[20:21], v[28:29] neg_lo:[1,0,0] neg_hi:[1,0,0]
    v_pk_mul_f32 v[22:23], v[22:23], s[52:53]
    v_pk_fma_f32 v[30:31], v[30:31], s[52:53], v[14:15]
    v_pk_fma_f32 v[38:39], v[22:23], v[56:57], v[38:39]
    v_pk_fma_f32 v[30:31], v[22:23], v[22:23], v[30:31] neg_lo:[1,0,0] neg_hi:[1,0,0]
    v_max_f32 v24, v14, v24
    v_max_f32 v25, v14, v25
    v_max_f32 v26, v14, v26
    v_max_f32 v27, v14, v27
    v_max_f32 v28, v14, v28
    v_max_f32 v29, v14, v29
    v_max_f32 v30, v14, v30
    v_max_f32 v31, v14, v31
    v_rsq_f32 v24, v24
    v_rsq_f32 v25, v25
    v_rsq_f32 v26, v26
    v_rsq_f32 v27, v27
    v_rsq_f32 v28, v28
    v_rsq_f32 v29, v29
    v_rsq_f32 v30, v30
    v_rsq_f32 v31, v31
    v_pk_mul_f32 v[32:33], v[32:33], v[24:25]
    v_pk_mul_f32 v[34:35], v[34:35], v[26:27]
    v_pk_mul_f32 v[36:37], v[36:37], v[28:29]
    v_pk_mul_f32 v[38:39], v[38:39], v[30:31]
    v_bfi_b32 v32, s54, 0, v32
    v_med3_f32 v13, v12, v13, v32
    v_max_f32 v12, v12, v32
    v_bfi_b32 v33, s54, 1, v33
    v_med3_f32 v13, v12, v13, v33
    v_max_f32 v12, v12, v33
    v_bfi_b32 v34, s54, 2, v34
    v_med3_f32 v13, v12, v13, v34
    v_max_f32 v12, v12, v34
    v_bfi_b32 v35, s54, 3, v35
    v_med3_f32 v13, v12, v13, v35
    v_max_f32 v12, v12, v35
    v_bfi_b32 v36, s54, 4, v36
    v_med3_f32 v13, v12, v13, v36
    v_max_f32 v12, v12, v36
    v_bfi_b32 v37, s54, 5, v37
    v_med3_f32 v13, v12, v13, v37
    v_max_f32 v12, v12, v37
    v_bfi_b32 v38, s54, 6, v38
    v_med3_f32 v13, v12, v13, v38
    v_max_f32 v12, v12, v38
    v_bfi_b32 v39, s54, 7, v39
    v_med3_f32 v13, v12, v13, v39
    v_max_f32 v12, v12, v39
    v_lshl_or_b32 v12, v2, 3, v12
    v_lshl_or_b32 v13, v2, 3, v13
    s_nop 1
    v_mov_b32_dpp v14, v12 quad_perm:[1,0,3,2] row_mask:0xf bank_mask:0xf
    v_mov_b32_dpp v15, v13 quad_perm:[1,0,3,2] row_mask:0xf bank_mask:0xf
    v_max_f32 v15, v15, v13
    v_med3_f32 v13, v12, v14, v15
    v_max_f32 v12, v12, v14
    s_nop 1
    v_mov_b32_dpp v14, v12 quad_perm:[2,3,0,1] row_mask:0xf bank_mask:0xf
    v_mov_b32_dpp v15, v13 quad_perm:[2,3,0,1] row_mask:0xf bank_mask:0xf
    v_max_f32 v15, v15, v13
    v_med3_f32 v13, v12, v14, v15
    v_max_f32 v12, v12, v14
    s_nop 1
    v_mov_b32_dpp v14, v12 row_half_mirror row_mask:0xf bank_mask:0xf
    v_mov_b32_dpp v15, v13 row_half_mirror row_mask:0xf bank_mask:0xf
    v_max_f32 v15, v15, v13
    v_med3_f32 v13, v12, v14, v15
    v_max_f32 v12, v12, v14
    s_nop 1
    v_mov_b32_dpp v14, v12 row_mirror row_mask:0xf bank_mask:0xf
    v_mov_b32_dpp v15, v13 row_mirror row_mask:0xf bank_mask:0xf
    v_max_f32 v15, v15, v13
    v_med3_f32 v13, v12, v14, v15
    v_max_f32 v12, v12, v14
    v_mov_b32 v14, v12
    v_mov_b32 v15, v13
    s_nop 1
    v_permlane16_swap_b32 v12, v14
    v_permlane16_swap_b32 v13, v15
    s_nop 1
    v_max_f32 v15, v15, v13
    v_med3_f32 v13, v12, v14, v15
    v_max_f32 v12, v12, v14
    v_mov_b32 v14, v12
    v_mov_b32 v15, v13
    s_nop 1
    v_permlane32_swap_b32 v12, v14
    v_permlane32_swap_b32 v13, v15
    s_nop 1
    v_max_f32 v15, v15, v13
    v_med3_f32 v13, v12, v14, v15
    v_max_f32 v12, v12, v14
    s_lshl_b32 s31, s30, 3
    s_add_u32 s31, s31, 8192
    v_mov_b32 v14, s31
    ds_write_b64 v14, v[12:13]
    v_mov_b32 v14, 8192
    s_waitcnt lgkmcnt(0)
    s_barrier
    ds_read_b128 v[16:19], v14
    ds_read_b128 v[20:23], v14 offset:16
    v_cmp_eq_u32 vcc, 0, v5
    s_waitcnt lgkmcnt(0)
    v_max_f32 v19, v19, v17
    v_med3_f32 v17, v16, v18, v19
    v_max_f32 v16, v16, v18
    v_max_f32 v23, v23, v21
    v_med3_f32 v21, v20, v22, v23
    v_max_f32 v20, v20, v22
    v_max_f32 v21, v21, v17
    v_med3_f32 v17, v16, v20, v21
    v_max_f32 v16, v16, v20
    v_and_b32 v16, 0x7ff, v16
    v_and_b32 v17, 0x7ff, v17
    v_cndmask_b32 v15, v17, v16, vcc
    v_lshl_add_u32 v12, v15, 11, v7
    buffer_load_dwordx4 v[40:43], v12, s[24:27], 0 offen offset:0 sc1
    buffer_load_dwordx4 v[44:47], v12, s[24:27], 0 offen offset:512 sc1
    buffer_load_dwordx4 v[48:51], v12, s[24:27], 0 offen offset:1024 sc1
    buffer_load_dwordx4 v[52:55], v12, s[24:27], 0 offen offset:1536 sc1
    buffer_load_dwordx4 v[128:131], v0, s[24:27], 0 offen offset:0 sc1
    buffer_load_dwordx4 v[132:135], v0, s[24:27], 0 offen offset:512 sc1
    buffer_load_dwordx4 v[136:139], v0, s[24:27], 0 offen offset:1024 sc1
    buffer_load_dwordx4 v[140:143], v0, s[24:27], 0 offen offset:1536 sc1
    v_cmp_eq_u32 vcc, v16, v11
    v_cmp_eq_u32 s[52:53], v17, v11
    v_mov_b32 v13, 0x7fffffff
    s_or_b64 vcc, vcc, s[52:53]
    v_cndmask_b32 v0, v0, v13, vcc
    v_lshl_add_u32 v12, v5, 11, v7
    v_add_u32 v12, 4096, v12
    s_mov_b32 s58, 0
    s_waitcnt vmcnt(4)
ff_ln_151:
    v_lshlrev_b32 v216, 16, v40
    v_and_b32 v217, 0xffff0000, v40
    v_lshlrev_b32 v218, 16, v41
    v_and_b32 v219, 0xffff0000, v41
    v_lshlrev_b32 v220, 16, v42
    v_and_b32 v221, 0xffff0000, v42
    v_lshlrev_b32 v222, 16, v43
    v_and_b32 v223, 0xffff0000, v43
    v_lshlrev_b32 v224, 16, v44
    v_and_b32 v225, 0xffff0000, v44
    v_lshlrev_b32 v226, 16, v45
    v_and_b32 v227, 0xffff0000, v45
    v_lshlrev_b32 v228, 16, v46
    v_and_b32 v229, 0xffff0000, v46
    v_lshlrev_b32 v230, 16, v47
    v_and_b32 v231, 0xffff0000, v47
    v_lshlrev_b32 v232, 16, v48
    v_and_b32 v233, 0xffff0000, v48
    v_lshlrev_b32 v234, 16, v49
    v_and_b32 v235, 0xffff0000, v49
    v_lshlrev_b32 v236, 16, v50
    v_and_b32 v237, 0xffff0000, v50
    v_lshlrev_b32 v238, 16, v51
    v_and_b32 v239, 0xffff0000, v51
    v_lshlrev_b32 v240, 16, v52
    v_and_b32 v241, 0xffff0000, v52
    v_lshlrev_b32 v242, 16, v53
    v_and_b32 v243, 0xffff0000, v53
    v_lshlrev_b32 v244, 16, v54
    v_and_b32 v245, 0xffff0000, v54
    v_lshlrev_b32 v246, 16, v55
    v_and_b32 v247, 0xffff0000, v55
    v_pk_add_f32 v[208:209], v[216:217], v[218:219]
    v_pk_add_f32 v[210:211], v[220:221], v[222:223]
    v_pk_add_f32 v[208:209], v[208:209], v[224:225]
    v_pk_add_f32 v[210:211], v[210:211], v[226:227]
    v_pk_add_f32 v[208:209], v[208:209], v[228:229]
    v_pk_add_f32 v[210:211], v[210:211], v[230:231]
    v_pk_add_f32 v[208:209], v[208:209], v[232:233]
    v_pk_add_f32 v[210:211], v[210:211], v[234:235]
    v_pk_add_f32 v[208:209], v[208:209], v[236:237]
    v_pk_add_f32 v[210:211], v[210:211], v[238:239]
    v_pk_add_f32 v[208:209], v[208:209], v[240:241]
    v_pk_add_f32 v[210:211], v[210:211], v[242:243]
    v_pk_add_f32 v[208:209], v[208:209], v[244:245]
    v_pk_add_f32 v[210:211], v[210:211], v[246:247]
    v_pk_add_f32 v[208:209], v[208:209], v[210:211]
    v_add_f32 v208, v208, v209
    s_nop 1
    v_add_f32_dpp v208, v208, v208 quad_perm:[1,0,3,2] row_mask:0xf bank_mask:0xf
    s_nop 1
    v_add_f32_dpp v208, v208, v208 quad_perm:[2,3,0,1] row_mask:0xf bank_mask:0xf
    s_nop 1
    v_add_f32_dpp v208, v208, v208 row_half_mirror row_mask:0xf bank_mask:0xf
    s_nop 1
    v_add_f32_dpp v208, v208, v208 row_mirror row_mask:0xf bank_mask:0xf
    v_mov_b32 v210, v208
    s_nop 1
    v_permlane16_swap_b32 v208, v210
    s_nop 1
    v_add_f32 v208, v208, v210
    v_mul_f32 v208, 0xba800000, v208
    v_mov_b32 v209, v208
    v_pk_add_f32 v[210:211], v[216:217], v[208:209]
    v_pk_add_f32 v[214:215], v[218:219], v[208:209]
    v_pk_mul_f32 v[212:213], v[210:211], v[210:211]
    v_pk_fma_f32 v[212:213], v[214:215], v[214:215], v[212:213]
    v_pk_add_f32 v[210:211], v[220:221], v[208:209]
    v_pk_add_f32 v[214:215], v[222:223], v[208:209]
    v_pk_fma_f32 v[212:213], v[210:211], v[210:211], v[212:213]
    v_pk_fma_f32 v[212:213], v[214:215], v[214:215], v[212:213]
    v_pk_add_f32 v[210:211], v[224:225], v[208:209]
    v_pk_add_f32 v[214:215], v[226:227], v[208:209]
    v_pk_fma_f32 v[212:213], v[210:211], v[210:211], v[212:213]
    v_pk_fma_f32 v[212:213], v[214:215], v[214:215], v[212:213]
    v_pk_add_f32 v[210:211], v[228:229], v[208:209]
    v_pk_add_f32 v[214:215], v[230:231], v[208:209]
    v_pk_fma_f32 v[212:213], v[210:211], v[210:211], v[212:213]
    v_pk_fma_f32 v[212:213], v[214:215], v[214:215], v[212:213]
    v_pk_add_f32 v[210:211], v[232:233], v[208:209]
    v_pk_add_f32 v[214:215], v[234:235], v[208:209]
    v_pk_fma_f32 v[212:213], v[210:211], v[210:211], v[212:213]
    v_pk_fma_f32 v[212:213], v[214:215], v[214:215], v[212:213]
    v_pk_add_f32 v[210:211], v[236:237], v[208:209]
    v_pk_add_f32 v[214:215], v[238:239], v[208:209]
    v_pk_fma_f32 v[212:213], v[210:211], v[210:211], v[212:213]
    v_pk_fma_f32 v[212:213], v[214:215], v[214:215], v[212:213]
    v_pk_add_f32 v[210:211], v[240:241], v[208:209]
    v_pk_add_f32 v[214:215], v[242:243], v[208:209]
    v_pk_fma_f32 v[212:213], v[210:211], v[210:211], v[212:213]
    v_pk_fma_f32 v[212:213], v[214:215], v[214:215], v[212:213]
    v_pk_add_f32 v[210:211], v[244:245], v[208:209]
    v_pk_add_f32 v[214:215], v[246:247], v[208:209]
    v_pk_fma_f32 v[212:213], v[210:211], v[210:211], v[212:213]
    v_pk_fma_f32 v[212:213], v[214:215], v[214:215], v[212:213]
    v_add_f32 v212, v212, v213
    s_nop 1
    v_add_f32_dpp v212, v212, v212 quad_perm:[1,0,3,2] row_mask:0xf bank_mask:0xf
    s_nop 1
    v_add_f32_dpp v212, v212, v212 quad_perm:[2,3,0,1] row_mask:0xf bank_mask:0xf
    s_nop 1
    v_add_f32_dpp v212, v212, v212 row_half_mirror row_mask:0xf bank_mask:0xf
    s_nop 1
    v_add_f32_dpp v212, v212, v212 row_mirror row_mask:0xf bank_mask:0xf
    v_mov_b32 v210, v212
    s_nop 1
    v_permlane16_swap_b32 v212, v210
    s_nop 1
    v_add_f32 v212, v212, v210
    v_mul_f32 v212, 0x3a800000, v212
    v_cvt_pk_bf16_f32 v214, v208, v212
    v_and_b32 v212, 0xffff0000, v214
    v_lshlrev_b32 v214, 16, v214
    v_add_f32 v212, 0x3727c5ac, v212
    v_mov_b32 v215, v214
    v_cvt_pk_bf16_f32 v212, v212, v212
    v_and_b32 v212, 0xffff0000, v212
    v_sqrt_f32 v212, v212
    v_pk_add_f32 v[176:177], v[216:217], v[214:215]
    v_pk_add_f32 v[178:179], v[218:219], v[214:215]
    v_pk_add_f32 v[180:181], v[220:221], v[214:215]
    v_pk_add_f32 v[182:183], v[222:223], v[214:215]
    v_pk_add_f32 v[184:185], v[224:225], v[214:215]
    v_pk_add_f32 v[186:187], v[226:227], v[214:215]
    v_pk_add_f32 v[188:189], v[228:229], v[214:215]
    v_pk_add_f32 v[190:191], v[230:231], v[214:215]
    v_pk_add_f32 v[192:193], v[232:233], v[214:215]
    v_pk_add_f32 v[194:195], v[234:235], v[214:215]
    v_pk_add_f32 v[196:197], v[236:237], v[214:215]
    v_pk_add_f32 v[198:199], v[238:239], v[214:215]
    v_pk_add_f32 v[200:201], v[240:241], v[214:215]
    v_pk_add_f32 v[202:203], v[242:243], v[214:215]
    v_pk_add_f32 v[204:205], v[244:245], v[214:215]
    v_pk_add_f32 v[206:207], v[246:247], v[214:215]
    v_cvt_pk_bf16_f32 v212, v212, v212
    v_and_b32 v212, 0xffff0000, v212
    v_rcp_f32 v212, v212
    v_cvt_pk_bf16_f32 v40, v176, v177
    v_cvt_pk_bf16_f32 v41, v178, v179
    v_cvt_pk_bf16_f32 v42, v180, v181
    v_cvt_pk_bf16_f32 v43, v182, v183
    v_cvt_pk_bf16_f32 v44, v184, v185
    v_cvt_pk_bf16_f32 v45, v186, v187
    v_cvt_pk_bf16_f32 v46, v188, v189
    v_cvt_pk_bf16_f32 v47, v190, v191
    v_cvt_pk_bf16_f32 v48, v192, v193
    v_cvt_pk_bf16_f32 v49, v194, v195
    v_cvt_pk_bf16_f32 v50, v196, v197
    v_cvt_pk_bf16_f32 v51, v198, v199
    v_cvt_pk_bf16_f32 v52, v200, v201
    v_cvt_pk_bf16_f32 v53, v202, v203
    v_cvt_pk_bf16_f32 v54, v204, v205
    v_cvt_pk_bf16_f32 v55, v206, v207
    v_mov_b32 v213, v212
    v_lshlrev_b32 v176, 16, v40
    v_and_b32 v177, 0xffff0000, v40
    v_lshlrev_b32 v178, 16, v41
    v_and_b32 v179, 0xffff0000, v41
    v_lshlrev_b32 v180, 16, v42
    v_and_b32 v181, 0xffff0000, v42
    v_lshlrev_b32 v182, 16, v43
    v_and_b32 v183, 0xffff0000, v43
    v_lshlrev_b32 v184, 16, v44
    v_and_b32 v185, 0xffff0000, v44
    v_lshlrev_b32 v186, 16, v45
    v_and_b32 v187, 0xffff0000, v45
    v_lshlrev_b32 v188, 16, v46
    v_and_b32 v189, 0xffff0000, v46
    v_lshlrev_b32 v190, 16, v47
    v_and_b32 v191, 0xffff0000, v47
    v_lshlrev_b32 v192, 16, v48
    v_and_b32 v193, 0xffff0000, v48
    v_lshlrev_b32 v194, 16, v49
    v_and_b32 v195, 0xffff0000, v49
    v_lshlrev_b32 v196, 16, v50
    v_and_b32 v197, 0xffff0000, v50
    v_lshlrev_b32 v198, 16, v51
    v_and_b32 v199, 0xffff0000, v51
    v_lshlrev_b32 v200, 16, v52
    v_and_b32 v201, 0xffff0000, v52
    v_lshlrev_b32 v202, 16, v53
    v_and_b32 v203, 0xffff0000, v53
    v_lshlrev_b32 v204, 16, v54
    v_and_b32 v205, 0xffff0000, v54
    v_lshlrev_b32 v206, 16, v55
    v_and_b32 v207, 0xffff0000, v55
    v_pk_mul_f32 v[176:177], v[176:177], v[212:213]
    v_pk_mul_f32 v[178:179], v[178:179], v[212:213]
    v_pk_mul_f32 v[180:181], v[180:181], v[212:213]
    v_pk_mul_f32 v[182:183], v[182:183], v[212:213]
    v_pk_mul_f32 v[184:185], v[184:185], v[212:213]
    v_pk_mul_f32 v[186:187], v[186:187], v[212:213]
    v_pk_mul_f32 v[188:189], v[188:189], v[212:213]
    v_pk_mul_f32 v[190:191], v[190:191], v[212:213]
    v_pk_mul_f32 v[192:193], v[192:193], v[212:213]
    v_pk_mul_f32 v[194:195], v[194:195], v[212:213]
    v_pk_mul_f32 v[196:197], v[196:197], v[212:213]
    v_pk_mul_f32 v[198:199], v[198:199], v[212:213]
    v_pk_mul_f32 v[200:201], v[200:201], v[212:213]
    v_pk_mul_f32 v[202:203], v[202:203], v[212:213]
    v_pk_mul_f32 v[204:205], v[204:205], v[212:213]
    v_pk_mul_f32 v[206:207], v[206:207], v[212:213]
    v_cvt_pk_bf16_f32 v40, v176, v177
    v_cvt_pk_bf16_f32 v41, v178, v179
    v_cvt_pk_bf16_f32 v42, v180, v181
    v_cvt_pk_bf16_f32 v43, v182, v183
    v_cvt_pk_bf16_f32 v44, v184, v185
    v_cvt_pk_bf16_f32 v45, v186, v187
    v_cvt_pk_bf16_f32 v46, v188, v189
    v_cvt_pk_bf16_f32 v47, v190, v191
    v_cvt_pk_bf16_f32 v48, v192, v193
    v_cvt_pk_bf16_f32 v49, v194, v195
    v_cvt_pk_bf16_f32 v50, v196, v197
    v_cvt_pk_bf16_f32 v51, v198, v199
    v_cvt_pk_bf16_f32 v52, v200, v201
    v_cvt_pk_bf16_f32 v53, v202, v203
    v_cvt_pk_bf16_f32 v54, v204, v205
    v_cvt_pk_bf16_f32 v55, v206, v207
    s_cmp_lg_u32 s58, 0
    s_cbranch_scc1 ff_own_152
    ds_write_b128 v12, v[40:43] offset:0
    ds_write_b128 v12, v[44:47] offset:512
    ds_write_b128 v12, v[48:51] offset:1024
    ds_write_b128 v12, v[52:55] offset:1536
    s_cmp_ge_u32 s2, 224
    s_cbranch_scc1 ff_red_153
    v_lshrrev_b32 v12, 4, v3
    v_and_b32 v13, 1, v3
    v_lshlrev_b32 v13, 11, v13
    v_lshl_add_u32 v13, v12, 3, v13
    s_lshl_b32 s54, s30, 9
    s_add_u32 s54, s54, 4096
    v_add_u32 v13, s54, v13
    v_lshlrev_b32 v14, 3, v3
    s_lshl_b32 s54, s30, 13
    s_add_u32 s54, s54, 65536
    v_add_u32 v14, s54, v14
    ds_read_b64_tr_b16 a[0:1], v14 offset:0
    ds_read_b64_tr_b16 a[2:3], v14 offset:512
    ds_read_b64_tr_b16 a[4:5], v14 offset:1024
    ds_read_b64_tr_b16 a[6:7], v14 offset:1536
    ds_read_b64_tr_b16 a[8:9], v14 offset:2048
    ds_read_b64_tr_b16 a[10:11], v14 offset:2560
    ds_read_b64_tr_b16 a[12:13], v14 offset:3072
    ds_read_b64_tr_b16 a[14:15], v14 offset:3584
    ds_read_b64_tr_b16 a[16:17], v14 offset:4096
    ds_read_b64_tr_b16 a[18:19], v14 offset:4608
    ds_read_b64_tr_b16 a[20:21], v14 offset:5120
    ds_read_b64_tr_b16 a[22:23], v14 offset:5632
    ds_read_b64_tr_b16 a[24:25], v14 offset:6144
    ds_read_b64_tr_b16 a[26:27], v14 offset:6656
    ds_read_b64_tr_b16 a[28:29], v14 offset:7168
    ds_read_b64_tr_b16 a[30:31], v14 offset:7680
    ds_read_b64_tr_b16 a[32:33], v14 offset:32768
    ds_read_b64_tr_b16 a[34:35], v14 offset:33280
    ds_read_b64_tr_b16 a[36:37], v14 offset:33792
    ds_read_b64_tr_b16 a[38:39], v14 offset:34304
    ds_read_b64_tr_b16 a[40:41], v14 offset:34816
    ds_read_b64_tr_b16 a[42:43], v14 offset:35328
    ds_read_b64_tr_b16 a[44:45], v14 offset:35840
    ds_read_b64_tr_b16 a[46:47], v14 offset:36352
    ds_read_b64_tr_b16 a[48:49], v14 offset:36864
    ds_read_b64_tr_b16 a[50:51], v14 offset:37376
    ds_read_b64_tr_b16 a[52:53], v14 offset:37888
    ds_read_b64_tr_b16 a[54:55], v14 offset:38400
    ds_read_b64_tr_b16 a[56:57], v14 offset:38912
    ds_read_b64_tr_b16 a[58:59], v14 offset:39424
    ds_read_b64_tr_b16 a[60:61], v14 offset:39936
    ds_read_b64_tr_b16 a[62:63], v14 offset:40448
    ds_read_b64 a[64:65], v13 offset:0
    ds_read_b64 a[66:67], v13 offset:32
    ds_read_b64 a[68:69], v13 offset:64
    ds_read_b64 a[70:71], v13 offset:96
    ds_read_b64 a[72:73], v13 offset:128
    ds_read_b64 a[74:75], v13 offset:160
    ds_read_b64 a[76:77], v13 offset:192
    ds_read_b64 a[78:79], v13 offset:224
    ds_read_b64 a[80:81], v13 offset:256
    ds_read_b64 a[82:83], v13 offset:288
    ds_read_b64 a[84:85], v13 offset:320
    ds_read_b64 a[86:87], v13 offset:352
    ds_read_b64 a[88:89], v13 offset:384
    ds_read_b64 a[90:91], v13 offset:416
    ds_read_b64 a[92:93], v13 offset:448
    ds_read_b64 a[94:95], v13 offset:480
    v_lshlrev_b32 v13, 6, v8
    v_lshl_add_u32 v13, v12, 4, v13
    s_lshl_b32 s54, s30, 11
    s_add_u32 s54, s54, 8448
    v_add_u32 v13, s54, v13
    s_waitcnt lgkmcnt(0)
    v_mfma_f32_16x16x32_bf16 v[16:19], a[0:3], a[64:67], 0
    v_mfma_f32_16x16x32_bf16 v[20:23], a[32:35], a[64:67], 0
    v_mfma_f32_16x16x32_bf16 v[16:19], a[4:7], a[68:71], v[16:19]
    v_mfma_f32_16x16x32_bf16 v[20:23], a[36:39], a[68:71], v[20:23]
    v_mfma_f32_16x16x32_bf16 v[16:19], a[8:11], a[72:75], v[16:19]
    v_mfma_f32_16x16x32_bf16 v[20:23], a[40:43], a[72:75], v[20:23]
    v_mfma_f32_16x16x32_bf16 v[16:19], a[12:15], a[76:79], v[16:19]
    v_mfma_f32_16x16x32_bf16 v[20:23], a[44:47], a[76:79], v[20:23]
    v_mfma_f32_16x16x32_bf16 v[16:19], a[16:19], a[80:83], v[16:19]
    v_mfma_f32_16x16x32_bf16 v[20:23], a[48:51], a[80:83], v[20:23]
    v_mfma_f32_16x16x32_bf16 v[16:19], a[20:23], a[84:87], v[16:19]
    v_mfma_f32_16x16x32_bf16 v[20:23], a[52:55], a[84:87], v[20:23]
    v_mfma_f32_16x16x32_bf16 v[16:19], a[24:27], a[88:91], v[16:19]
    v_mfma_f32_16x16x32_bf16 v[20:23], a[56:59], a[88:91], v[20:23]
    v_mfma_f32_16x16x32_bf16 v[16:19], a[28:31], a[92:95], v[16:19]
    v_mfma_f32_16x16x32_bf16 v[20:23], a[60:63], a[92:95], v[20:23]
    s_nop 7
    ds_write_b128 v13, v[16:19]
    ds_write_b128 v13, v[20:23] offset:1024
    v_lshlrev_b32 v13, 2, v4
    v_add_u32 v13, 8448, v13
    s_waitcnt lgkmcnt(0)
    s_barrier
    ds_read2st64_b32 v[16:17], v13 offset0:0 offset1:4
    ds_read2st64_b32 v[18:19], v13 offset0:8 offset1:12
    ds_read2st64_b32 v[20:21], v13 offset0:16 offset1:20
    ds_read2st64_b32 v[22:23], v13 offset0:24 offset1:28
    s_waitcnt lgkmcnt(0)
    v_pk_add_f32 v[16:17], v[16:17], v[20:21]
    v_pk_add_f32 v[18:19], v[18:19], v[22:23]
    v_pk_add_f32 v[16:17], v[16:17], v[18:19]
    v_cvt_pk_bf16_f32 v16, v16, v17
    v_and_b32 v20, 0xffff0000, v16
    v_lshlrev_b32 v16, 16, v16
    v_mul_f32 v17, 0xbfb8aa3b, v16
    v_exp_f32 v17, v17
    s_lshl_b32 s54, s55, 13
    v_add_f32 v17, 1.0, v17
    v_rcp_f32 v17, v17
    s_add_u32 s53, s54, 4096
    v_mul_f32 v16, v16, v17
    v_cvt_pk_bf16_f32 v16, v16, v16
    v_and_b32 v16, 0xffff0000, v16
    v_mul_f32 v16, v16, v20
    s_nop 1
    v_mov_b32_dpp v17, v16 quad_perm:[1,0,3,2] row_mask:0xf bank_mask:0xf
    v_cvt_pk_bf16_f32 v16, v16, v17
    v_lshlrev_b32 v13, 4, v2
    v_readlane_b32 s8, v16, 0
    v_readlane_b32 s9, v16, 2
    v_readlane_b32 s10, v16, 4
    v_readlane_b32 s11, v16, 6
    v_readlane_b32 s12, v16, 8
    v_readlane_b32 s13, v16, 10
    v_readlane_b32 s14, v16, 12
    v_readlane_b32 s15, v16, 14
    v_readlane_b32 s16, v16, 16
    v_readlane_b32 s17, v16, 18
    v_readlane_b32 s18, v16, 20
    v_readlane_b32 s19, v16, 22
    v_readlane_b32 s20, v16, 24
    v_readlane_b32 s21, v16, 26
    v_readlane_b32 s22, v16, 28
    v_readlane_b32 s23, v16, 30
    v_dot2_f32_bf16 v24, v144, s8, 0
    v_dot2_f32_bf16 v25, v145, s8, 0
    v_dot2_f32_bf16 v26, v146, s8, 0
    v_dot2_f32_bf16 v27, v147, s8, 0
    v_dot2_f32_bf16 v24, v148, s9, v24
    v_dot2_f32_bf16 v25, v149, s9, v25
    v_dot2_f32_bf16 v26, v150, s9, v26
    v_dot2_f32_bf16 v27, v151, s9, v27
    v_dot2_f32_bf16 v24, v152, s10, v24
    v_dot2_f32_bf16 v25, v153, s10, v25
    v_dot2_f32_bf16 v26, v154, s10, v26
    v_dot2_f32_bf16 v27, v155, s10, v27
    v_dot2_f32_bf16 v24, v156, s11, v24
    v_dot2_f32_bf16 v25, v157, s11, v25
    v_dot2_f32_bf16 v26, v158, s11, v26
    v_dot2_f32_bf16 v27, v159, s11, v27
    v_dot2_f32_bf16 v24, v160, s12, v24
    v_dot2_f32_bf16 v25, v161, s12, v25
    v_dot2_f32_bf16 v26, v162, s12, v26
    v_dot2_f32_bf16 v27, v163, s12, v27
    v_dot2_f32_bf16 v24, v164, s13, v24
    v_dot2_f32_bf16 v25, v165, s13, v25
    v_dot2_f32_bf16 v26, v166, s13, v26
    v_dot2_f32_bf16 v27, v167, s13, v27
    v_dot2_f32_bf16 v24, v168, s14, v24
    v_dot2_f32_bf16 v25, v169, s14, v25
    v_dot2_f32_bf16 v26, v170, s14, v26
    v_dot2_f32_bf16 v27, v171, s14, v27
    v_dot2_f32_bf16 v24, v172, s15, v24
    v_dot2_f32_bf16 v25, v173, s15, v25
    v_dot2_f32_bf16 v26, v174, s15, v26
    v_dot2_f32_bf16 v27, v175, s15, v27
    v_dot2_f32_bf16 v28, v144, s16, 0
    v_dot2_f32_bf16 v29, v145, s16, 0
    v_dot2_f32_bf16 v30, v146, s16, 0
    v_dot2_f32_bf16 v31, v147, s16, 0
    v_dot2_f32_bf16 v28, v148, s17, v28
    v_dot2_f32_bf16 v29, v149, s17, v29
    v_dot2_f32_bf16 v30, v150, s17, v30
    v_dot2_f32_bf16 v31, v151, s17, v31
    v_dot2_f32_bf16 v28, v152, s18, v28
    v_dot2_f32_bf16 v29, v153, s18, v29
    v_dot2_f32_bf16 v30, v154, s18, v30
    v_dot2_f32_bf16 v31, v155, s18, v31
    v_dot2_f32_bf16 v28, v156, s19, v28
    v_dot2_f32_bf16 v29, v157, s19, v29
    v_dot2_f32_bf16 v30, v158, s19, v30
    v_dot2_f32_bf16 v31, v159, s19, v31
    v_dot2_f32_bf16 v28, v160, s20, v28
    v_dot2_f32_bf16 v29, v161, s20, v29
    v_dot2_f32_bf16 v30, v162, s20, v30
    v_dot2_f32_bf16 v31, v163, s20, v31
    v_dot2_f32_bf16 v28, v164, s21, v28
    v_dot2_f32_bf16 v29, v165, s21, v29
    v_dot2_f32_bf16 v30, v166, s21, v30
    v_dot2_f32_bf16 v31, v167, s21, v31
    v_dot2_f32_bf16 v28, v168, s22, v28
    v_dot2_f32_bf16 v29, v169, s22, v29
    v_dot2_f32_bf16 v30, v170, s22, v30
    v_dot2_f32_bf16 v31, v171, s22, v31
    v_dot2_f32_bf16 v28, v172, s23, v28
    v_dot2_f32_bf16 v29, v173, s23, v29
    v_dot2_f32_bf16 v30, v174, s23, v30
    v_dot2_f32_bf16 v31, v175, s23, v31
    s_nop 2
    v_min_u32 v24, -2, v24
    v_min_u32 v25, -2, v25
    v_min_u32 v26, -2, v26
    v_min_u32 v27, -2, v27
    v_min_u32 v28, -2, v28
    v_min_u32 v29, -2, v29
    v_min_u32 v30, -2, v30
    v_min_u32 v31, -2, v31
    buffer_store_dwordx4 v[24:27], v13, s[48:51], s54 offen sc1
    buffer_store_dwordx4 v[28:31], v13, s[48:51], s53 offen sc1
    s_waitcnt vmcnt(2)
    v_mov_b32 v40, v128
    v_mov_b32 v41, v129
    v_mov_b32 v42, v130
    v_mov_b32 v43, v131
    v_mov_b32 v44, v132
    v_mov_b32 v45, v133
    v_mov_b32 v46, v134
    v_mov_b32 v47, v135
    v_mov_b32 v48, v136
    v_mov_b32 v49, v137
    v_mov_b32 v50, v138
    v_mov_b32 v51, v139
    v_mov_b32 v52, v140
    v_mov_b32 v53, v141
    v_mov_b32 v54, v142
    v_mov_b32 v55, v143
    s_mov_b32 s58, 1
    s_branch ff_ln_151
ff_own_152:
    v_lshlrev_b32 v176, 16, v40
    v_and_b32 v177, 0xffff0000, v40
    v_lshlrev_b32 v178, 16, v41
    v_and_b32 v179, 0xffff0000, v41
    v_lshlrev_b32 v180, 16, v42
    v_and_b32 v181, 0xffff0000, v42
    v_lshlrev_b32 v182, 16, v43
    v_and_b32 v183, 0xffff0000, v43
    v_lshlrev_b32 v184, 16, v44
    v_and_b32 v185, 0xffff0000, v44
    v_lshlrev_b32 v186, 16, v45
    v_and_b32 v187, 0xffff0000, v45
    v_lshlrev_b32 v188, 16, v46
    v_and_b32 v189, 0xffff0000, v46
    v_lshlrev_b32 v190, 16, v47
    v_and_b32 v191, 0xffff0000, v47
    v_lshlrev_b32 v192, 16, v48
    v_and_b32 v193, 0xffff0000, v48
    v_lshlrev_b32 v194, 16, v49
    v_and_b32 v195, 0xffff0000, v49
    v_lshlrev_b32 v196, 16, v50
    v_and_b32 v197, 0xffff0000, v50
    v_lshlrev_b32 v198, 16, v51
    v_and_b32 v199, 0xffff0000, v51
    v_lshlrev_b32 v200, 16, v52
    v_and_b32 v201, 0xffff0000, v52
    v_lshlrev_b32 v202, 16, v53
    v_and_b32 v203, 0xffff0000, v53
    v_lshlrev_b32 v204, 16, v54
    v_and_b32 v205, 0xffff0000, v54
    v_lshlrev_b32 v206, 16, v55
    v_and_b32 v207, 0xffff0000, v55
    v_pk_add_f32 v[176:177], v[176:177], v[216:217]
    v_pk_add_f32 v[178:179], v[178:179], v[218:219]
    v_pk_add_f32 v[180:181], v[180:181], v[220:221]
    v_pk_add_f32 v[182:183], v[182:183], v[222:223]
    v_pk_add_f32 v[184:185], v[184:185], v[224:225]
    v_pk_add_f32 v[186:187], v[186:187], v[226:227]
    v_pk_add_f32 v[188:189], v[188:189], v[228:229]
    v_pk_add_f32 v[190:191], v[190:191], v[230:231]
    v_pk_add_f32 v[192:193], v[192:193], v[232:233]
    v_pk_add_f32 v[194:195], v[194:195], v[234:235]
    v_pk_add_f32 v[196:197], v[196:197], v[236:237]
    v_pk_add_f32 v[198:199], v[198:199], v[238:239]
    v_pk_add_f32 v[200:201], v[200:201], v[240:241]
    v_pk_add_f32 v[202:203], v[202:203], v[242:243]
    v_pk_add_f32 v[204:205], v[204:205], v[244:245]
    v_pk_add_f32 v[206:207], v[206:207], v[246:247]
    v_cvt_pk_bf16_f32 v40, v176, v177
    v_cvt_pk_bf16_f32 v41, v178, v179
    v_cvt_pk_bf16_f32 v42, v180, v181
    v_cvt_pk_bf16_f32 v43, v182, v183
    v_cvt_pk_bf16_f32 v44, v184, v185
    v_cvt_pk_bf16_f32 v45, v186, v187
    v_cvt_pk_bf16_f32 v46, v188, v189
    v_cvt_pk_bf16_f32 v47, v190, v191
    v_cvt_pk_bf16_f32 v48, v192, v193
    v_cvt_pk_bf16_f32 v49, v194, v195
    v_cvt_pk_bf16_f32 v50, v196, v197
    v_cvt_pk_bf16_f32 v51, v198, v199
    v_cvt_pk_bf16_f32 v52, v200, v201
    v_cvt_pk_bf16_f32 v53, v202, v203
    v_cvt_pk_bf16_f32 v54, v204, v205
    v_cvt_pk_bf16_f32 v55, v206, v207
    buffer_store_dwordx4 v[40:43], v0, s[36:39], 0 offen offset:0 sc1
    buffer_store_dwordx4 v[44:47], v0, s[36:39], 0 offen offset:512 sc1
    buffer_store_dwordx4 v[48:51], v0, s[36:39], 0 offen offset:1024 sc1
    buffer_store_dwordx4 v[52:55], v0, s[36:39], 0 offen offset:1536 sc1
    s_cmp_ge_u32 s2, 224
    s_cbranch_scc1 ff_red2_154
    s_branch ff_fin_155
ff_red_153:
    s_sub_u32 s40, s2, 224
    s_lshr_b32 s41, s40, 4
    s_and_b32 s42, s40, 15
    s_mov_b32 s8, s56
    s_and_b32 s9, s57, 0xffff
    s_mov_b32 s10, 0x800
    s_mov_b32 s11, 0x00020000
    buffer_load_dwordx4 v[96:99], v7, s[8:11], 0 offen offset:0
    buffer_load_dwordx4 v[100:103], v7, s[8:11], 0 offen offset:512
    buffer_load_dwordx4 v[104:107], v7, s[8:11], 0 offen offset:1024
    buffer_load_dwordx4 v[108:111], v7, s[8:11], 0 offen offset:1536
    s_lshl_b32 s43, s41, 5
    v_readlane_b32 s46, v15, s43
    s_lshl_b32 s47, s42, 7
    v_lshl_add_u32 v9, v8, 3, s47
    s_lshl_b32 s46, s46, 11
    s_lshl_b32 s31, s41, 11
    s_add_u32 s31, s31, 4096
    v_add_u32 v12, s31, v9
    s_waitcnt lgkmcnt(0)
    ds_read_b64 v[32:33], v12
    buffer_load_dwordx2 v[34:35], v9, s[24:27], s46 offen sc1
    v_lshrrev_b32 v10, 4, v2
    v_lshlrev_b32 v10, 13, v10
    v_lshl_add_u32 v10, v8, 4, v10
    s_lshl_b32 s47, s40, 8
    s_waitcnt vmcnt(1)
    v_dot2_f32_bf16 v12, v40, v96, 0
    v_dot2_f32_bf16 v12, v41, v97, v12
    v_dot2_f32_bf16 v12, v42, v98, v12
    v_dot2_f32_bf16 v12, v43, v99, v12
    v_dot2_f32_bf16 v12, v44, v100, v12
    v_dot2_f32_bf16 v12, v45, v101, v12
    v_dot2_f32_bf16 v12, v46, v102, v12
    v_dot2_f32_bf16 v12, v47, v103, v12
    v_dot2_f32_bf16 v12, v48, v104, v12
    v_dot2_f32_bf16 v12, v49, v105, v12
    v_dot2_f32_bf16 v12, v50, v106, v12
    v_dot2_f32_bf16 v12, v51, v107, v12
    v_dot2_f32_bf16 v12, v52, v108, v12
    v_dot2_f32_bf16 v12, v53, v109, v12
    v_dot2_f32_bf16 v12, v54, v110, v12
    v_dot2_f32_bf16 v12, v55, v111, v12
    s_nop 2
    s_nop 1
    v_add_f32_dpp v12, v12, v12 quad_perm:[1,0,3,2] row_mask:0xf bank_mask:0xf
    s_nop 1
    v_add_f32_dpp v12, v12, v12 quad_perm:[2,3,0,1] row_mask:0xf bank_mask:0xf
    s_nop 1
    v_add_f32_dpp v12, v12, v12 row_half_mirror row_mask:0xf bank_mask:0xf
    s_nop 1
    v_add_f32_dpp v12, v12, v12 row_mirror row_mask:0xf bank_mask:0xf
    v_mov_b32 v13, v12
    s_nop 1
    v_permlane16_swap_b32 v12, v13
    s_nop 1
    v_add_f32 v12, v12, v13
    v_cvt_pk_bf16_f32 v12, v12, v12
    v_and_b32 v12, 0xffff0000, v12
    v_mul_f32 v12, 0xbfb8aa3b, v12
    v_exp_f32 v12, v12
    s_lshl_b32 s44, s42, 1
    v_add_f32 v12, 1.0, v12
    v_rcp_f32 v12, v12
    s_add_u32 s44, s44, s41
    s_lshl_b32 s44, s44, 11
    v_cvt_pk_bf16_f32 v12, v12, v12
    v_and_b32 v12, 0xffff0000, v12
    v_mov_b32 v40, v128
    v_mov_b32 v41, v129
    v_mov_b32 v42, v130
    v_mov_b32 v43, v131
    v_mov_b32 v44, v132
    v_mov_b32 v45, v133
    v_mov_b32 v46, v134
    v_mov_b32 v47, v135
    v_mov_b32 v48, v136
    v_mov_b32 v49, v137
    v_mov_b32 v50, v138
    v_mov_b32 v51, v139
    v_mov_b32 v52, v140
    v_mov_b32 v53, v141
    v_mov_b32 v54, v142
    v_mov_b32 v55, v143
    v_readlane_b32 s45, v12, s43
    s_mov_b32 s58, 1
    s_branch ff_ln_151
ff_red2_154:
    s_mov_b32 s52, 1048576
ff_rpoll_157:
    s_mov_b32 s53, s47
    buffer_load_dwordx4 v[96:99], v10, s[48:51], s53 offen sc1
    s_add_u32 s53, s53, 0x20000
    buffer_load_dwordx4 v[100:103], v10, s[48:51], s53 offen sc1
    s_add_u32 s53, s53, 0x20000
    buffer_load_dwordx4 v[104:107], v10, s[48:51], s53 offen sc1
    s_add_u32 s53, s53, 0x20000
    buffer_load_dwordx4 v[108:111], v10, s[48:51], s53 offen sc1
    s_add_u32 s53, s53, 0x20000
    buffer_load_dwordx4 v[112:115], v10, s[48:51], s53 offen sc1
    s_add_u32 s53, s53, 0x20000
    buffer_load_dwordx4 v[116:119], v10, s[48:51], s53 offen sc1
    s_add_u32 s53, s53, 0x20000
    buffer_load_dwordx4 v[120:123], v10, s[48:51], s53 offen sc1
    s_add_u32 s53, s53, 0x20000
    buffer_load_dwordx4 v[124:127], v10, s[48:51], s53 offen sc1
    s_add_u32 s53, s53, 0x20000
    buffer_load_dwordx4 v[128:131], v10, s[48:51], s53 offen sc1
    s_add_u32 s53, s53, 0x20000
    buffer_load_dwordx4 v[132:135], v10, s[48:51], s53 offen sc1
    s_add_u32 s53, s53, 0x20000
    buffer_load_dwordx4 v[136:139], v10, s[48:51], s53 offen sc1
    s_add_u32 s53, s53, 0x20000
    buffer_load_dwordx4 v[140:143], v10, s[48:51], s53 offen sc1
    s_add_u32 s53, s53, 0x20000
    buffer_load_dwordx4 v[144:147], v10, s[48:51], s53 offen sc1
    s_add_u32 s53, s53, 0x20000
    buffer_load_dwordx4 v[148:151], v10, s[48:51], s53 offen sc1
    s_add_u32 s53, s53, 0x20000
    v_mov_b32 v13, 0
    s_waitcnt vmcnt(13)
    v_max3_u32 v13, v13, v96, v97
    v_max3_u32 v13, v13, v98, v99
    s_waitcnt vmcnt(12)
    v_max3_u32 v13, v13, v100, v101
    v_max3_u32 v13, v13, v102, v103
    s_waitcnt vmcnt(11)
    v_max3_u32 v13, v13, v104, v105
    v_max3_u32 v13, v13, v106, v107
    s_waitcnt vmcnt(10)
    v_max3_u32 v13, v13, v108, v109
    v_max3_u32 v13, v13, v110, v111
    s_waitcnt vmcnt(9)
    v_max3_u32 v13, v13, v112, v113
    v_max3_u32 v13, v13, v114, v115
    s_waitcnt vmcnt(8)
    v_max3_u32 v13, v13, v116, v117
    v_max3_u32 v13, v13, v118, v119
    s_waitcnt vmcnt(7)
    v_max3_u32 v13, v13, v120, v121
    v_max3_u32 v13, v13, v122, v123
    s_waitcnt vmcnt(6)
    v_max3_u32 v13, v13, v124, v125
    v_max3_u32 v13, v13, v126, v127
    s_waitcnt vmcnt(5)
    v_max3_u32 v13, v13, v128, v129
    v_max3_u32 v13, v13, v130, v131
    s_waitcnt vmcnt(4)
    v_max3_u32 v13, v13, v132, v133
    v_max3_u32 v13, v13, v134, v135
    s_waitcnt vmcnt(3)
    v_max3_u32 v13, v13, v136, v137
    v_max3_u32 v13, v13, v138, v139
    s_waitcnt vmcnt(2)
    v_max3_u32 v13, v13, v140, v141
    v_max3_u32 v13, v13, v142, v143
    s_waitcnt vmcnt(1)
    v_max3_u32 v13, v13, v144, v145
    v_max3_u32 v13, v13, v146, v147
    s_waitcnt vmcnt(0)
    v_max3_u32 v13, v13, v148, v149
    v_max3_u32 v13, v13, v150, v151
    s_sub_u32 s52, s52, 1
    s_cbranch_scc1 ff_rgo_156
    v_cmp_eq_u32 vcc, -1, v13
    s_cbranch_vccnz ff_rpoll_157
ff_rgo_156:
    v_pk_add_f32 v[96:97], v[96:97], v[100:101]
    v_pk_add_f32 v[98:99], v[98:99], v[102:103]
    v_pk_add_f32 v[96:97], v[96:97], v[104:105]
    v_pk_add_f32 v[98:99], v[98:99], v[106:107]
    v_pk_add_f32 v[96:97], v[96:97], v[108:109]
    v_pk_add_f32 v[98:99], v[98:99], v[110:111]
    v_pk_add_f32 v[96:97], v[96:97], v[112:113]
    v_pk_add_f32 v[98:99], v[98:99], v[114:115]
    v_pk_add_f32 v[96:97], v[96:97], v[116:117]
    v_pk_add_f32 v[98:99], v[98:99], v[118:119]
    v_pk_add_f32 v[96:97], v[96:97], v[120:121]
    v_pk_add_f32 v[98:99], v[98:99], v[122:123]
    v_pk_add_f32 v[96:97], v[96:97], v[124:125]
    v_pk_add_f32 v[98:99], v[98:99], v[126:127]
    v_pk_add_f32 v[96:97], v[96:97], v[128:129]
    v_pk_add_f32 v[98:99], v[98:99], v[130:131]
    v_pk_add_f32 v[96:97], v[96:97], v[132:133]
    v_pk_add_f32 v[98:99], v[98:99], v[134:135]
    v_pk_add_f32 v[96:97], v[96:97], v[136:137]
    v_pk_add_f32 v[98:99], v[98:99], v[138:139]
    v_pk_add_f32 v[96:97], v[96:97], v[140:141]
    v_pk_add_f32 v[98:99], v[98:99], v[142:143]
    v_pk_add_f32 v[96:97], v[96:97], v[144:145]
    v_pk_add_f32 v[98:99], v[98:99], v[146:147]
    v_pk_add_f32 v[96:97], v[96:97], v[148:149]
    v_pk_add_f32 v[98:99], v[98:99], v[150:151]
    v_mov_b32 v100, v96
    v_mov_b32 v101, v97
    v_mov_b32 v102, v98
    v_mov_b32 v103, v99
    s_nop 1
    v_permlane16_swap_b32 v96, v100
    v_permlane16_swap_b32 v97, v101
    v_permlane16_swap_b32 v98, v102
    v_permlane16_swap_b32 v99, v103
    s_nop 1
    v_add_f32 v96, v96, v100
    v_add_f32 v97, v97, v101
    v_add_f32 v98, v98, v102
    v_add_f32 v99, v99, v103
    v_mov_b32 v100, v96
    v_mov_b32 v101, v97
    v_mov_b32 v102, v98
    v_mov_b32 v103, v99
    s_nop 1
    v_permlane32_swap_b32 v96, v100
    v_permlane32_swap_b32 v97, v101
    v_permlane32_swap_b32 v98, v102
    v_permlane32_swap_b32 v99, v103
    s_nop 1
    v_add_f32 v96, v96, v100
    v_add_f32 v97, v97, v101
    v_add_f32 v98, v98, v102
    v_add_f32 v99, v99, v103
    v_lshlrev_b32 v14, 4, v8
    s_lshl_b32 s31, s30, 8
    v_add_u32 v13, s31, v14
    ds_write_b128 v13, v[96:99]
    s_waitcnt lgkmcnt(0)
    s_barrier
    ds_read_b128 v[96:99], v14 offset:0
    ds_read_b128 v[100:103], v14 offset:256
    ds_read_b128 v[104:107], v14 offset:512
    ds_read_b128 v[108:111], v14 offset:768
    s_waitcnt lgkmcnt(0)
    v_pk_add_f32 v[96:97], v[96:97], v[100:101]
    v_pk_add_f32 v[98:99], v[98:99], v[102:103]
    v_pk_add_f32 v[96:97], v[96:97], v[104:105]
    v_pk_add_f32 v[98:99], v[98:99], v[106:107]
    v_pk_add_f32 v[96:97], v[96:97], v[108:109]
    v_pk_add_f32 v[98:99], v[98:99], v[110:111]
    v_cvt_pk_bf16_f32 v20, v96, v97
    v_lshlrev_b32 v21, 16, v20
    v_and_b32 v22, 0xffff0000, v20
    v_mul_f32 v21, s45, v21
    v_mul_f32 v22, s45, v22
    v_cvt_pk_bf16_f32 v20, v21, v22
    v_lshlrev_b32 v21, 16, v20
    v_and_b32 v22, 0xffff0000, v20
    v_lshlrev_b32 v23, 16, v32
    v_and_b32 v24, 0xffff0000, v32
    v_add_f32 v21, v21, v23
    v_add_f32 v22, v22, v24
    v_cvt_pk_bf16_f32 v20, v21, v22
    v_lshlrev_b32 v21, 16, v20
    v_and_b32 v22, 0xffff0000, v20
    v_lshlrev_b32 v23, 16, v34
    v_and_b32 v24, 0xffff0000, v34
    v_add_f32 v21, v21, v23
    v_add_f32 v22, v22, v24
    v_cvt_pk_bf16_f32 v26, v21, v22
    v_cvt_pk_bf16_f32 v20, v98, v99
    v_lshlrev_b32 v21, 16, v20
    v_and_b32 v22, 0xffff0000, v20
    v_mul_f32 v21, s45, v21
    v_mul_f32 v22, s45, v22
    v_cvt_pk_bf16_f32 v20, v21, v22
    v_lshlrev_b32 v21, 16, v20
    v_and_b32 v22, 0xffff0000, v20
    v_lshlrev_b32 v23, 16, v33
    v_and_b32 v24, 0xffff0000, v33
    v_add_f32 v21, v21, v23
    v_add_f32 v22, v22, v24
    v_cvt_pk_bf16_f32 v20, v21, v22
    v_lshlrev_b32 v21, 16, v20
    v_and_b32 v22, 0xffff0000, v20
    v_lshlrev_b32 v23, 16, v35
    v_and_b32 v24, 0xffff0000, v35
    v_add_f32 v21, v21, v23
    v_add_f32 v22, v22, v24
    v_cvt_pk_bf16_f32 v27, v21, v22
    v_cmp_gt_u32 vcc, 16, v2
    s_and_saveexec_b64 s[52:53], vcc
    s_cbranch_execz ff_fin_155
    buffer_store_dwordx2 v[26:27], v9, s[36:39], s46 offen sc1
ff_fin_155:
    s_mov_b64 exec, -1
k12_end_1:
    s_endpgm
k2_prep_76:
    s_sub_u32 s40, s36, s38
    v_subrev_u32 v6, s40, v4
    v_cmp_gt_i32 s[44:45], 0, v6
    v_cmp_gt_i32 s[46:47], 1, v6
    v_cmp_gt_i32 s[48:49], 2, v6
    v_cmp_gt_i32 s[50:51], 3, v6
    v_cndmask_b32 v16, v8, v5, s[44:45]
    v_cndmask_b32 v17, v8, v5, s[46:47]
    v_cndmask_b32 v18, v8, v5, s[48:49]
    v_cndmask_b32 v19, v8, v5, s[50:51]
    v_cmp_gt_i32 s[44:45], 16, v6
    v_cmp_gt_i32 s[46:47], 17, v6
    v_cmp_gt_i32 s[48:49], 18, v6
    v_cmp_gt_i32 s[50:51], 19, v6
    v_cndmask_b32 v32, v8, v5, s[44:45]
    v_cndmask_b32 v33, v8, v5, s[46:47]
    v_cndmask_b32 v34, v8, v5, s[48:49]
    v_cndmask_b32 v35, v8, v5, s[50:51]
    s_nop 1
    s_branch k2_prepret_77
k2_prep_84:
    s_sub_u32 s40, s36, s38
    v_subrev_u32 v6, s40, v4
    v_cmp_gt_i32 s[44:45], 0, v6
    v_cmp_gt_i32 s[46:47], 1, v6
    v_cmp_gt_i32 s[48:49], 2, v6
    v_cmp_gt_i32 s[50:51], 3, v6
    v_cndmask_b32 v16, v8, v5, s[44:45]
    v_cndmask_b32 v17, v8, v5, s[46:47]
    v_cndmask_b32 v18, v8, v5, s[48:49]
    v_cndmask_b32 v19, v8, v5, s[50:51]
    v_cmp_gt_i32 s[44:45], 16, v6
    v_cmp_gt_i32 s[46:47], 17, v6
    v_cmp_gt_i32 s[48:49], 18, v6
    v_cmp_gt_i32 s[50:51], 19, v6
    v_cndmask_b32 v32, v8, v5, s[44:45]
    v_cndmask_b32 v33, v8, v5, s[46:47]
    v_cndmask_b32 v34, v8, v5, s[48:49]
    v_cndmask_b32 v35, v8, v5, s[50:51]
    s_nop 1
    s_branch k2_prepret_85
k2_prep_102:
    s_sub_u32 s40, s36, s39
    v_subrev_u32 v6, s40, v4
    v_cmp_gt_i32 s[44:45], 0, v6
    v_cmp_gt_i32 s[46:47], 1, v6
    v_cmp_gt_i32 s[48:49], 2, v6
    v_cmp_gt_i32 s[50:51], 3, v6
    v_cndmask_b32 v16, v10, v5, s[44:45]
    v_cndmask_b32 v17, v10, v5, s[46:47]
    v_cndmask_b32 v18, v10, v5, s[48:49]
    v_cndmask_b32 v19, v10, v5, s[50:51]
    v_cmp_gt_i32 s[44:45], 16, v6
    v_cmp_gt_i32 s[46:47], 17, v6
    v_cmp_gt_i32 s[48:49], 18, v6
    v_cmp_gt_i32 s[50:51], 19, v6
    v_cndmask_b32 v32, v10, v5, s[44:45]
    v_cndmask_b32 v33, v10, v5, s[46:47]
    v_cndmask_b32 v34, v10, v5, s[48:49]
    v_cndmask_b32 v35, v10, v5, s[50:51]
    v_cmp_gt_i32 s[44:45], 32, v6
    v_cmp_gt_i32 s[46:47], 33, v6
    v_cmp_gt_i32 s[48:49], 34, v6
    v_cmp_gt_i32 s[50:51], 35, v6
    v_cndmask_b32 v24, v10, v5, s[44:45]
    v_cndmask_b32 v25, v10, v5, s[46:47]
    v_cndmask_b32 v26, v10, v5, s[48:49]
    v_cndmask_b32 v27, v10, v5, s[50:51]
    v_cmp_gt_i32 s[44:45], 48, v6
    v_cmp_gt_i32 s[46:47], 49, v6
    v_cmp_gt_i32 s[48:49], 50, v6
    v_cmp_gt_i32 s[50:51], 51, v6
    v_cndmask_b32 v40, v10, v5, s[44:45]
    v_cndmask_b32 v41, v10, v5, s[46:47]
    v_cndmask_b32 v42, v10, v5, s[48:49]
    v_cndmask_b32 v43, v10, v5, s[50:51]
    s_nop 1
    s_branch k2_prepret_103
k2_prep_106:
    s_sub_u32 s40, s36, s39
    s_sub_u32 s40, s40, 64
    v_subrev_u32 v6, s40, v4
    v_cmp_gt_i32 s[44:45], 0, v6
    v_cmp_gt_i32 s[46:47], 1, v6
    v_cmp_gt_i32 s[48:49], 2, v6
    v_cmp_gt_i32 s[50:51], 3, v6
    v_cndmask_b32 v20, v11, v5, s[44:45]
    v_cndmask_b32 v21, v11, v5, s[46:47]
    v_cndmask_b32 v22, v11, v5, s[48:49]
    v_cndmask_b32 v23, v11, v5, s[50:51]
    v_cmp_gt_i32 s[44:45], 16, v6
    v_cmp_gt_i32 s[46:47], 17, v6
    v_cmp_gt_i32 s[48:49], 18, v6
    v_cmp_gt_i32 s[50:51], 19, v6
    v_cndmask_b32 v36, v11, v5, s[44:45]
    v_cndmask_b32 v37, v11, v5, s[46:47]
    v_cndmask_b32 v38, v11, v5, s[48:49]
    v_cndmask_b32 v39, v11, v5, s[50:51]
    v_cmp_gt_i32 s[44:45], 32, v6
    v_cmp_gt_i32 s[46:47], 33, v6
    v_cmp_gt_i32 s[48:49], 34, v6
    v_cmp_gt_i32 s[50:51], 35, v6
    v_cndmask_b32 v28, v11, v5, s[44:45]
    v_cndmask_b32 v29, v11, v5, s[46:47]
    v_cndmask_b32 v30, v11, v5, s[48:49]
    v_cndmask_b32 v31, v11, v5, s[50:51]
    v_cmp_gt_i32 s[44:45], 48, v6
    v_cmp_gt_i32 s[46:47], 49, v6
    v_cmp_gt_i32 s[48:49], 50, v6
    v_cmp_gt_i32 s[50:51], 51, v6
    v_cndmask_b32 v44, v11, v5, s[44:45]
    v_cndmask_b32 v45, v11, v5, s[46:47]
    v_cndmask_b32 v46, v11, v5, s[48:49]
    v_cndmask_b32 v47, v11, v5, s[50:51]
    s_nop 1
    s_branch k2_prepret_107
k12_ool_10:
    buffer_load_dword v52, v8, s[24:27], 0 offen sc1
    s_branch k12_oolret_11
k12_ool_14:
    v_readfirstlane_b32 s31, v52
    s_cmp_ge_u32 s31, 256
    s_cbranch_scc1 spin_ok_12
    s_mov_b32 s40, 1048576
spin_13:
    s_sleep 8
    buffer_load_dword v52, v8, s[24:27], 0 offen sc1
    s_waitcnt vmcnt(0)
    v_readfirstlane_b32 s31, v52
    s_sub_u32 s40, s40, 1
    s_cselect_b32 s31, -1, s31
    s_cmp_lt_u32 s31, 256
    s_cbranch_scc1 spin_13
spin_ok_12:
    s_branch k12_oolret_15
k12_ool_16:
    s_mov_b64 exec, 1
    buffer_atomic_add v9, v8, s[24:27], 0 offen sc1
    s_mov_b64 exec, -1
    s_branch k12_oolret_17
k12_ool_18:
    buffer_load_dword v51, v50, s[12:15], s56 offen
    s_branch k12_oolret_19
k12_ool_20:
    s_add_u32 m0, s60, 131072
    s_nop 0
    buffer_load_dwordx4 v38, s[12:15], s61 offen offset:0 lds
    buffer_load_dwordx4 v39, s[12:15], s61 offen offset:1024 lds
    buffer_load_dwordx4 v40, s[12:15], s61 offen offset:2048 lds
    buffer_load_dwordx4 v41, s[12:15], s61 offen offset:3072 lds
    s_add_u32 s61, s61, 0x80000
    s_add_u32 m0, s60, 147456
    s_nop 0
    buffer_load_dwordx4 v38, s[12:15], s61 offen offset:0 lds
    buffer_load_dwordx4 v39, s[12:15], s61 offen offset:1024 lds
    buffer_load_dwordx4 v40, s[12:15], s61 offen offset:2048 lds
    buffer_load_dwordx4 v41, s[12:15], s61 offen offset:3072 lds
    s_add_u32 s61, s61, 0x80000
    s_branch k12_oolret_21
k12_ool_22:
    s_mov_b64 exec, 1
    buffer_atomic_add v9, v8, s[24:27], 0 offen sc1
    s_mov_b64 exec, -1
    s_branch k12_oolret_23
k12_ool_24:
    buffer_load_dword v51, v50, s[12:15], s56 offen
    s_branch k12_oolret_25
k12_ool_26:
    global_load_dword v51, v[2:3], off
    s_branch k12_oolret_27
k12_ool_30:
    buffer_load_dword v52, v8, s[24:27], 0 offen sc1
    s_branch k12_oolret_31
k12_ool_34:
    v_readfirstlane_b32 s31, v52
    s_cmp_ge_u32 s31, 256
    s_cbranch_scc1 spin_ok_32
    s_mov_b32 s40, 1048576
spin_33:
    s_sleep 8
    buffer_load_dword v52, v8, s[24:27], 0 offen sc1
    s_waitcnt vmcnt(0)
    v_readfirstlane_b32 s31, v52
    s_sub_u32 s40, s40, 1
    s_cselect_b32 s31, -1, s31
    s_cmp_lt_u32 s31, 256
    s_cbranch_scc1 spin_33
spin_ok_32:
    s_branch k12_oolret_35
k12_ool_36:
    s_mov_b64 exec, 1
    buffer_atomic_add v9, v8, s[24:27], 0 offen sc1
    s_mov_b64 exec, -1
    s_branch k12_oolret_37
k12_ool_38:
    buffer_load_dword v51, v50, s[12:15], s56 offen
    s_branch k12_oolret_39
k12_ool_40:
    s_add_u32 m0, s60, 131072
    s_nop 0
    buffer_load_dwordx4 v38, s[12:15], s61 offen offset:0 lds
    buffer_load_dwordx4 v39, s[12:15], s61 offen offset:1024 lds
    buffer_load_dwordx4 v40, s[12:15], s61 offen offset:2048 lds
    buffer_load_dwordx4 v41, s[12:15], s61 offen offset:3072 lds
    s_add_u32 s61, s61, 0x80000
    s_add_u32 m0, s60, 147456
    s_nop 0
    buffer_load_dwordx4 v38, s[12:15], s61 offen offset:0 lds
    buffer_load_dwordx4 v39, s[12:15], s61 offen offset:1024 lds
    buffer_load_dwordx4 v40, s[12:15], s61 offen offset:2048 lds
    buffer_load_dwordx4 v41, s[12:15], s61 offen offset:3072 lds
    s_add_u32 s61, s61, 0x80000
    s_branch k12_oolret_41
k12_ool_42:
    s_mov_b64 exec, 1
    buffer_atomic_add v9, v8, s[24:27], 0 offen sc1
    s_mov_b64 exec, -1
    s_branch k12_oolret_43
k12_ool_44:
    buffer_load_dword v51, v50, s[12:15], s56 offen
    s_branch k12_oolret_45
k12_ool_46:
    global_load_dword v51, v[2:3], off
    s_branch k12_oolret_47
k12_ool_48:
    s_add_u32 s52, s47, 528384
    buffer_store_dwordx4 v[152:155], v1, s[48:51], s52 offen offset:2048 sc1
    s_branch k12_oolret_49
k12_ool_50:
    s_add_u32 s52, s47, 528384
    buffer_store_dwordx4 v[156:159], v1, s[48:51], s52 offen offset:3072 sc1
    s_branch k12_oolret_51
k12_ool_52:
    s_add_u32 s52, s47, 532480
    buffer_store_dwordx4 v[168:171], v1, s[48:51], s52 offen offset:2048 sc1
    s_branch k12_oolret_53
k12_ool_54:
    s_add_u32 s52, s47, 532480
    buffer_store_dwordx4 v[172:175], v1, s[48:51], s52 offen offset:3072 sc1
    s_branch k12_oolret_55
k12_ool_56:
    s_add_u32 s52, s47, 536576
    buffer_store_dwordx4 v[176:179], v1, s[48:51], s52 offen offset:0 sc1
    s_branch k12_oolret_57
k12_ool_58:
    s_add_u32 s52, s47, 536576
    buffer_store_dwordx4 v[180:183], v1, s[48:51], s52 offen offset:1024 sc1
    s_branch k12_oolret_59
k12_ool_60:
    s_add_u32 s52, s47, 536576
    buffer_store_dwordx4 v[184:187], v1, s[48:51], s52 offen offset:2048 sc1
    s_branch k12_oolret_61
k12_ool_62:
    s_add_u32 s52, s47, 536576
    buffer_store_dwordx4 v[188:191], v1, s[48:51], s52 offen offset:3072 sc1
    s_branch k12_oolret_63
k12_ool_64:
    s_mov_b32 s50, 0
    s_branch k12_oolret_65
k12_ool_66:
    s_mov_b64 exec, 1
    buffer_atomic_add v9, v8, s[24:27], s54 offen sc1
    s_mov_b64 exec, -1
    s_branch k12_oolret_67
k12_ool_68:
    buffer_load_dword v52, v8, s[24:27], s55 offen sc1
    s_branch k12_oolret_69
k12_ool_72:
    s_waitcnt vmcnt(10)
    v_readfirstlane_b32 s31, v52
    s_cmp_ge_u32 s31, 2
    s_cbranch_scc1 spin_ok_70
    s_mov_b32 s40, 1048576
spin_71:
    s_sleep 8
    buffer_load_dword v52, v8, s[24:27], s55 offen sc1
    s_waitcnt vmcnt(0)
    v_readfirstlane_b32 s31, v52
    s_sub_u32 s40, s40, 1
    s_cselect_b32 s31, -1, s31
    s_cmp_lt_u32 s31, 2
    s_cbranch_scc1 spin_71
spin_ok_70:
    s_branch k12_oolret_73
k12_ool_74:
    s_mov_b64 exec, 1
    buffer_atomic_add v9, v8, s[24:27], s3 offen sc1
    s_mov_b64 exec, -1
    s_branch k12_oolret_75
k12_ool_78:
    buffer_load_dword v58, v59, s[24:27], s5 offen sc1
    s_branch k12_oolret_79
k12_ool_82:
    s_waitcnt vmcnt(0)
    v_readfirstlane_b32 s31, v58
    s_cmp_ge_u32 s31, 14
    s_cbranch_scc1 spin_ok_80
    s_mov_b32 s40, 1048576
spin_81:
    s_sleep 8
    buffer_load_dword v58, v59, s[24:27], s5 offen sc1
    s_waitcnt vmcnt(0)
    v_readfirstlane_b32 s31, v58
    s_sub_u32 s40, s40, 1
    s_cselect_b32 s31, -1, s31
    s_cmp_lt_u32 s31, 14
    s_cbranch_scc1 spin_81
spin_ok_80:
    s_branch k12_oolret_83
k12_ool_122:
    s_mov_b64 exec, 1
    buffer_atomic_add v76, v75, s[16:19], s57 offen sc1
    s_mov_b64 exec, -1
    s_branch k12_oolret_123
k12_ool_127:
    s_mov_b64 exec, 1
    buffer_atomic_add v76, v75, s[16:19], s58 offen sc1
    s_mov_b64 exec, -1
    s_branch k12_oolret_128
k12_ool_131:
    s_mov_b32 s34, 1048576
op_spin_129:
    buffer_load_dword v74, v73, s[16:19], s59 offen sc1
    s_waitcnt vmcnt(0)
    v_cmp_le_u32 vcc, 4, v74
    s_sub_u32 s34, s34, 1
    s_cbranch_scc1 op_ok_130
    s_mov_b32 s33, vcc_lo
    s_bitcmp1_b32 s33, 0
    s_cbranch_scc1 op_ok_130
    s_sleep 4
    s_branch op_spin_129
op_ok_130:
    buffer_load_dwordx4 a[128:131], v88, s[8:11], s62 offen offset:0 sc1
    buffer_load_dwordx4 a[132:135], v88, s[8:11], s62 offen offset:1024 sc1
    buffer_load_dwordx4 a[136:139], v89, s[8:11], s62 offen offset:0 sc1
    buffer_load_dwordx4 a[140:143], v89, s[8:11], s62 offen offset:1024 sc1
    s_add_u32 s62, s62, 0x40000
    s_and_b32 s62, s62, 0x7fffff
    buffer_load_dwordx4 a[144:147], v88, s[8:11], s62 offen offset:0 sc1
    buffer_load_dwordx4 a[148:151], v88, s[8:11], s62 offen offset:1024 sc1
    buffer_load_dwordx4 a[152:155], v89, s[8:11], s62 offen offset:0 sc1
    buffer_load_dwordx4 a[156:159], v89, s[8:11], s62 offen offset:1024 sc1
    s_add_u32 s62, s62, 0x40000
    s_and_b32 s62, s62, 0x7fffff
    buffer_load_dwordx4 a[160:163], v88, s[8:11], s62 offen offset:0 sc1
    buffer_load_dwordx4 a[164:167], v88, s[8:11], s62 offen offset:1024 sc1
    buffer_load_dwordx4 a[168:171], v89, s[8:11], s62 offen offset:0 sc1
    buffer_load_dwordx4 a[172:175], v89, s[8:11], s62 offen offset:1024 sc1
    s_add_u32 s62, s62, 0x40000
    s_and_b32 s62, s62, 0x7fffff
    s_branch k12_oolret_132
k12_ool_137:
    buffer_load_dwordx2 v[192:193], v78, s[20:23], 0 offen offset:0
    buffer_load_dwordx2 v[194:195], v78, s[20:23], 0 offen offset:32
    buffer_load_dwordx2 v[196:197], v78, s[20:23], 0 offen offset:64
    buffer_load_dwordx2 v[198:199], v78, s[20:23], 0 offen offset:96
    buffer_load_dwordx2 v[200:201], v79, s[20:23], 0 offen offset:0
    buffer_load_dwordx2 v[202:203], v79, s[20:23], 0 offen offset:32
    buffer_load_dwordx2 v[204:205], v79, s[20:23], 0 offen offset:64
    buffer_load_dwordx2 v[206:207], v79, s[20:23], 0 offen offset:96
    buffer_load_dwordx2 v[208:209], v80, s[44:47], 0 offen offset:0
    buffer_load_dwordx2 v[210:211], v80, s[44:47], 0 offen offset:32
    buffer_load_dwordx2 v[212:213], v80, s[44:47], 0 offen offset:64
    buffer_load_dwordx2 v[214:215], v80, s[44:47], 0 offen offset:96
    global_load_dword v84, v[82:83], off
    s_mov_b32 s10, 0
    s_mov_b32 s14, 0
    s_mov_b32 s34, 1048576
ff_spin_135:
    v_cmp_gt_u32 vcc, 4, v95
    s_cbranch_vccz ff_ok_136
    s_sub_u32 s34, s34, 1
    s_cbranch_scc1 ff_ok_136
    s_sleep 4
    buffer_load_dword v95, v94, s[16:19], 0 offen sc1
    s_waitcnt vmcnt(0)
    s_branch ff_spin_135
ff_ok_136:
    s_add_u32 s44, s6, 0x6000000
    s_addc_u32 s45, s7, 0
    s_and_b32 s45, s45, 0xffff
    s_cmp_ge_u32 s2, 224
    s_cselect_b32 s46, 0, 0x1000000
    s_branch k12_oolret_138
k12_ool_141:
    s_mov_b32 s34, 1048576
op_spin_139:
    buffer_load_dword v74, v73, s[16:19], s59 offen sc1
    s_waitcnt vmcnt(0)
    v_cmp_le_u32 vcc, 4, v74
    s_sub_u32 s34, s34, 1
    s_cbranch_scc1 op_ok_140
    s_mov_b32 s33, vcc_lo
    s_bitcmp1_b32 s33, s32
    s_cbranch_scc1 op_ok_140
    s_sleep 4
    s_branch op_spin_139
op_ok_140:
    s_branch k12_oolret_142
k12_ool_143:
    buffer_load_dword v95, v94, s[16:19], 0 offen sc1
    s_branch k12_oolret_144
k2_tramp_86:
    s_call_b64 s[40:41], k2_rare_158
    s_branch k2_ret_87
k2_tramp_90:
    s_call_b64 s[40:41], k2_rare_159
    s_branch k2_ret_91
k2_tramp_92:
    s_call_b64 s[40:41], k2_rare_158
    s_branch k2_ret_93
k2_tramp_94:
    s_call_b64 s[40:41], k2_rare_159
    s_branch k2_ret_95
k2_tramp_96:
    s_call_b64 s[40:41], k2_rare_158
    s_branch k2_ret_97
k2_tramp_98:
    s_call_b64 s[40:41], k2_rare_159
    s_branch k2_ret_99
k2_tramp_100:
    s_call_b64 s[40:41], k2_rare_164
    s_branch k2_ret_101
k2_tramp_104:
    s_call_b64 s[40:41], k2_rare_165
    s_branch k2_ret_105
k2_tramp_108:
    s_call_b64 s[40:41], k2_rare_166
    s_branch k2_ret_109
k2_tramp_112:
    s_call_b64 s[40:41], k2_rare_167
    s_branch k2_ret_113
k2_tramp_114:
    s_call_b64 s[40:41], k2_rare_166
    s_branch k2_ret_115
k2_tramp_116:
    s_call_b64 s[40:41], k2_rare_167
    s_branch k2_ret_117
k2_tramp_118:
    s_call_b64 s[40:41], k2_rare_166
    s_branch k2_ret_119
k2_tramp_120:
    s_call_b64 s[40:41], k2_rare_171
    s_branch k2_ret_121
k2_rare_158:
    s_nop 7
    v_max_f32 v52, v128, v129
    v_max3_f32 v52, v52, v130, v131
    v_max3_f32 v52, v52, v144, v145
    v_max3_f32 v52, v52, v146, v147
    v_max_f32 v53, v132, v133
    v_max3_f32 v53, v53, v134, v135
    v_max3_f32 v53, v53, v148, v149
    v_max3_f32 v53, v53, v150, v151
    v_max_f32 v54, v136, v137
    v_max3_f32 v54, v54, v138, v139
    v_max3_f32 v54, v54, v152, v153
    v_max3_f32 v54, v54, v154, v155
    v_max_f32 v55, v140, v141
    v_max3_f32 v55, v55, v142, v143
    v_max3_f32 v55, v55, v156, v157
    v_max3_f32 v55, v55, v158, v159
    v_mov_b32 v224, v52
    v_mov_b32 v225, v53
    v_mov_b32 v226, v54
    v_mov_b32 v227, v55
    s_nop 1
    v_permlane16_swap_b32 v52, v224
    v_permlane16_swap_b32 v53, v225
    v_permlane16_swap_b32 v54, v226
    v_permlane16_swap_b32 v55, v227
    s_nop 1
    v_max_f32 v52, v52, v224
    v_max_f32 v53, v53, v225
    v_max_f32 v54, v54, v226
    v_max_f32 v55, v55, v227
    v_mov_b32 v224, v52
    v_mov_b32 v225, v53
    v_mov_b32 v226, v54
    v_mov_b32 v227, v55
    s_nop 1
    v_permlane32_swap_b32 v52, v224
    v_permlane32_swap_b32 v53, v225
    v_permlane32_swap_b32 v54, v226
    v_permlane32_swap_b32 v55, v227
    s_nop 1
    v_max_f32 v52, v52, v224
    v_max_f32 v53, v53, v225
    v_max_f32 v54, v54, v226
    v_max_f32 v55, v55, v227
    v_add_f32 v52, 0x41400000, v52
    v_max_f32 v52, 0, v52
    v_add_f32 v53, 0x41400000, v53
    v_max_f32 v53, 0, v53
    v_add_f32 v54, 0x41400000, v54
    v_max_f32 v54, 0, v54
    v_add_f32 v55, 0x41400000, v55
    v_max_f32 v55, 0, v55
    v_sub_f32 v128, v128, v52
    v_sub_f32 v129, v129, v52
    v_sub_f32 v130, v130, v52
    v_sub_f32 v131, v131, v52
    v_sub_f32 v132, v132, v53
    v_sub_f32 v133, v133, v53
    v_sub_f32 v134, v134, v53
    v_sub_f32 v135, v135, v53
    v_sub_f32 v136, v136, v54
    v_sub_f32 v137, v137, v54
    v_sub_f32 v138, v138, v54
    v_sub_f32 v139, v139, v54
    v_sub_f32 v140, v140, v55
    v_sub_f32 v141, v141, v55
    v_sub_f32 v142, v142, v55
    v_sub_f32 v143, v143, v55
    v_sub_f32 v144, v144, v52
    v_sub_f32 v145, v145, v52
    v_sub_f32 v146, v146, v52
    v_sub_f32 v147, v147, v52
    v_sub_f32 v148, v148, v53
    v_sub_f32 v149, v149, v53
    v_sub_f32 v150, v150, v53
    v_sub_f32 v151, v151, v53
    v_sub_f32 v152, v152, v54
    v_sub_f32 v153, v153, v54
    v_sub_f32 v154, v154, v54
    v_sub_f32 v155, v155, v54
    v_sub_f32 v156, v156, v55
    v_sub_f32 v157, v157, v55
    v_sub_f32 v158, v158, v55
    v_sub_f32 v159, v159, v55
    v_sub_f32 v160, v160, v52
    v_sub_f32 v16, v16, v52
    v_sub_f32 v161, v161, v52
    v_sub_f32 v17, v17, v52
    v_sub_f32 v162, v162, v52
    v_sub_f32 v18, v18, v52
    v_sub_f32 v163, v163, v52
    v_sub_f32 v19, v19, v52
    v_sub_f32 v164, v164, v53
    v_sub_f32 v20, v20, v53
    v_sub_f32 v165, v165, v53
    v_sub_f32 v21, v21, v53
    v_sub_f32 v166, v166, v53
    v_sub_f32 v22, v22, v53
    v_sub_f32 v167, v167, v53
    v_sub_f32 v23, v23, v53
    v_sub_f32 v168, v168, v54
    v_sub_f32 v24, v24, v54
    v_sub_f32 v169, v169, v54
    v_sub_f32 v25, v25, v54
    v_sub_f32 v170, v170, v54
    v_sub_f32 v26, v26, v54
    v_sub_f32 v171, v171, v54
    v_sub_f32 v27, v27, v54
    v_sub_f32 v172, v172, v55
    v_sub_f32 v28, v28, v55
    v_sub_f32 v173, v173, v55
    v_sub_f32 v29, v29, v55
    v_sub_f32 v174, v174, v55
    v_sub_f32 v30, v30, v55
    v_sub_f32 v175, v175, v55
    v_sub_f32 v31, v31, v55
    v_sub_f32 v176, v176, v52
    v_sub_f32 v32, v32, v52
    v_sub_f32 v177, v177, v52
    v_sub_f32 v33, v33, v52
    v_sub_f32 v178, v178, v52
    v_sub_f32 v34, v34, v52
    v_sub_f32 v179, v179, v52
    v_sub_f32 v35, v35, v52
    v_sub_f32 v180, v180, v53
    v_sub_f32 v36, v36, v53
    v_sub_f32 v181, v181, v53
    v_sub_f32 v37, v37, v53
    v_sub_f32 v182, v182, v53
    v_sub_f32 v38, v38, v53
    v_sub_f32 v183, v183, v53
    v_sub_f32 v39, v39, v53
    v_sub_f32 v184, v184, v54
    v_sub_f32 v40, v40, v54
    v_sub_f32 v185, v185, v54
    v_sub_f32 v41, v41, v54
    v_sub_f32 v186, v186, v54
    v_sub_f32 v42, v42, v54
    v_sub_f32 v187, v187, v54
    v_sub_f32 v43, v43, v54
    v_sub_f32 v188, v188, v55
    v_sub_f32 v44, v44, v55
    v_sub_f32 v189, v189, v55
    v_sub_f32 v45, v45, v55
    v_sub_f32 v190, v190, v55
    v_sub_f32 v46, v46, v55
    v_sub_f32 v191, v191, v55
    v_sub_f32 v47, v47, v55
    v_sub_f32 v8, v8, v52
    v_exp_f32 v52, -v52
    v_sub_f32 v9, v9, v53
    v_exp_f32 v53, -v53
    v_sub_f32 v10, v10, v54
    v_exp_f32 v54, -v54
    v_sub_f32 v11, v11, v55
    v_exp_f32 v55, -v55
    s_nop 0
    v_mul_f32 v12, v12, v52
    v_mul_f32 v48, v48, v53
    v_mul_f32 v248, v248, v54
    v_mul_f32 v252, v252, v55
    v_accvgpr_read_b32 v224, a0
    v_accvgpr_read_b32 v225, a1
    v_accvgpr_read_b32 v226, a2
    v_accvgpr_read_b32 v227, a3
    v_mul_f32 v224, v224, v52
    v_mul_f32 v225, v225, v52
    v_mul_f32 v226, v226, v52
    v_mul_f32 v227, v227, v52
    v_accvgpr_write_b32 a0, v224
    v_accvgpr_write_b32 a1, v225
    v_accvgpr_write_b32 a2, v226
    v_accvgpr_write_b32 a3, v227
    v_accvgpr_read_b32 v224, a4
    v_accvgpr_read_b32 v225, a5
    v_accvgpr_read_b32 v226, a6
    v_accvgpr_read_b32 v227, a7
    v_mul_f32 v224, v224, v53
    v_mul_f32 v225, v225, v53
    v_mul_f32 v226, v226, v53
    v_mul_f32 v227, v227, v53
    v_accvgpr_write_b32 a4, v224
    v_accvgpr_write_b32 a5, v225
    v_accvgpr_write_b32 a6, v226
    v_accvgpr_write_b32 a7, v227
    v_accvgpr_read_b32 v224, a8
    v_accvgpr_read_b32 v225, a9
    v_accvgpr_read_b32 v226, a10
    v_accvgpr_read_b32 v227, a11
    v_mul_f32 v224, v224, v54
    v_mul_f32 v225, v225, v54
    v_mul_f32 v226, v226, v54
    v_mul_f32 v227, v227, v54
    v_accvgpr_write_b32 a8, v224
    v_accvgpr_write_b32 a9, v225
    v_accvgpr_write_b32 a10, v226
    v_accvgpr_write_b32 a11, v227
    v_accvgpr_read_b32 v224, a12
    v_accvgpr_read_b32 v225, a13
    v_accvgpr_read_b32 v226, a14
    v_accvgpr_read_b32 v227, a15
    v_mul_f32 v224, v224, v55
    v_mul_f32 v225, v225, v55
    v_mul_f32 v226, v226, v55
    v_mul_f32 v227, v227, v55
    v_accvgpr_write_b32 a12, v224
    v_accvgpr_write_b32 a13, v225
    v_accvgpr_write_b32 a14, v226
    v_accvgpr_write_b32 a15, v227
    v_accvgpr_read_b32 v224, a16
    v_accvgpr_read_b32 v225, a17
    v_accvgpr_read_b32 v226, a18
    v_accvgpr_read_b32 v227, a19
    v_mul_f32 v224, v224, v52
    v_mul_f32 v225, v225, v52
    v_mul_f32 v226, v226, v52
    v_mul_f32 v227, v227, v52
    v_accvgpr_write_b32 a16, v224
    v_accvgpr_write_b32 a17, v225
    v_accvgpr_write_b32 a18, v226
    v_accvgpr_write_b32 a19, v227
    v_accvgpr_read_b32 v224, a20
    v_accvgpr_read_b32 v225, a21
    v_accvgpr_read_b32 v226, a22
    v_accvgpr_read_b32 v227, a23
    v_mul_f32 v224, v224, v53
    v_mul_f32 v225, v225, v53
    v_mul_f32 v226, v226, v53
    v_mul_f32 v227, v227, v53
    v_accvgpr_write_b32 a20, v224
    v_accvgpr_write_b32 a21, v225
    v_accvgpr_write_b32 a22, v226
    v_accvgpr_write_b32 a23, v227
    v_accvgpr_read_b32 v224, a24
    v_accvgpr_read_b32 v225, a25
    v_accvgpr_read_b32 v226, a26
    v_accvgpr_read_b32 v227, a27
    v_mul_f32 v224, v224, v54
    v_mul_f32 v225, v225, v54
    v_mul_f32 v226, v226, v54
    v_mul_f32 v227, v227, v54
    v_accvgpr_write_b32 a24, v224
    v_accvgpr_write_b32 a25, v225
    v_accvgpr_write_b32 a26, v226
    v_accvgpr_write_b32 a27, v227
    v_accvgpr_read_b32 v224, a28
    v_accvgpr_read_b32 v225, a29
    v_accvgpr_read_b32 v226, a30
    v_accvgpr_read_b32 v227, a31
    v_mul_f32 v224, v224, v55
    v_mul_f32 v225, v225, v55
    v_mul_f32 v226, v226, v55
    v_mul_f32 v227, v227, v55
    v_accvgpr_write_b32 a28, v224
    v_accvgpr_write_b32 a29, v225
    v_accvgpr_write_b32 a30, v226
    v_accvgpr_write_b32 a31, v227
    v_accvgpr_read_b32 v224, a32
    v_accvgpr_read_b32 v225, a33
    v_accvgpr_read_b32 v226, a34
    v_accvgpr_read_b32 v227, a35
    v_mul_f32 v224, v224, v52
    v_mul_f32 v225, v225, v52
    v_mul_f32 v226, v226, v52
    v_mul_f32 v227, v227, v52
    v_accvgpr_write_b32 a32, v224
    v_accvgpr_write_b32 a33, v225
    v_accvgpr_write_b32 a34, v226
    v_accvgpr_write_b32 a35, v227
    v_accvgpr_read_b32 v224, a36
    v_accvgpr_read_b32 v225, a37
    v_accvgpr_read_b32 v226, a38
    v_accvgpr_read_b32 v227, a39
    v_mul_f32 v224, v224, v53
    v_mul_f32 v225, v225, v53
    v_mul_f32 v226, v226, v53
    v_mul_f32 v227, v227, v53
    v_accvgpr_write_b32 a36, v224
    v_accvgpr_write_b32 a37, v225
    v_accvgpr_write_b32 a38, v226
    v_accvgpr_write_b32 a39, v227
    v_accvgpr_read_b32 v224, a40
    v_accvgpr_read_b32 v225, a41
    v_accvgpr_read_b32 v226, a42
    v_accvgpr_read_b32 v227, a43
    v_mul_f32 v224, v224, v54
    v_mul_f32 v225, v225, v54
    v_mul_f32 v226, v226, v54
    v_mul_f32 v227, v227, v54
    v_accvgpr_write_b32 a40, v224
    v_accvgpr_write_b32 a41, v225
    v_accvgpr_write_b32 a42, v226
    v_accvgpr_write_b32 a43, v227
    v_accvgpr_read_b32 v224, a44
    v_accvgpr_read_b32 v225, a45
    v_accvgpr_read_b32 v226, a46
    v_accvgpr_read_b32 v227, a47
    v_mul_f32 v224, v224, v55
    v_mul_f32 v225, v225, v55
    v_mul_f32 v226, v226, v55
    v_mul_f32 v227, v227, v55
    v_accvgpr_write_b32 a44, v224
    v_accvgpr_write_b32 a45, v225
    v_accvgpr_write_b32 a46, v226
    v_accvgpr_write_b32 a47, v227
    v_accvgpr_read_b32 v224, a48
    v_accvgpr_read_b32 v225, a49
    v_accvgpr_read_b32 v226, a50
    v_accvgpr_read_b32 v227, a51
    v_mul_f32 v224, v224, v52
    v_mul_f32 v225, v225, v52
    v_mul_f32 v226, v226, v52
    v_mul_f32 v227, v227, v52
    v_accvgpr_write_b32 a48, v224
    v_accvgpr_write_b32 a49, v225
    v_accvgpr_write_b32 a50, v226
    v_accvgpr_write_b32 a51, v227
    v_accvgpr_read_b32 v224, a52
    v_accvgpr_read_b32 v225, a53
    v_accvgpr_read_b32 v226, a54
    v_accvgpr_read_b32 v227, a55
    v_mul_f32 v224, v224, v53
    v_mul_f32 v225, v225, v53
    v_mul_f32 v226, v226, v53
    v_mul_f32 v227, v227, v53
    v_accvgpr_write_b32 a52, v224
    v_accvgpr_write_b32 a53, v225
    v_accvgpr_write_b32 a54, v226
    v_accvgpr_write_b32 a55, v227
    v_accvgpr_read_b32 v224, a56
    v_accvgpr_read_b32 v225, a57
    v_accvgpr_read_b32 v226, a58
    v_accvgpr_read_b32 v227, a59
    v_mul_f32 v224, v224, v54
    v_mul_f32 v225, v225, v54
    v_mul_f32 v226, v226, v54
    v_mul_f32 v227, v227, v54
    v_accvgpr_write_b32 a56, v224
    v_accvgpr_write_b32 a57, v225
    v_accvgpr_write_b32 a58, v226
    v_accvgpr_write_b32 a59, v227
    v_accvgpr_read_b32 v224, a60
    v_accvgpr_read_b32 v225, a61
    v_accvgpr_read_b32 v226, a62
    v_accvgpr_read_b32 v227, a63
    v_mul_f32 v224, v224, v55
    v_mul_f32 v225, v225, v55
    v_mul_f32 v226, v226, v55
    v_mul_f32 v227, v227, v55
    v_accvgpr_write_b32 a60, v224
    v_accvgpr_write_b32 a61, v225
    v_accvgpr_write_b32 a62, v226
    v_accvgpr_write_b32 a63, v227
    v_accvgpr_read_b32 v224, a64
    v_accvgpr_read_b32 v225, a65
    v_accvgpr_read_b32 v226, a66
    v_accvgpr_read_b32 v227, a67
    v_mul_f32 v224, v224, v52
    v_mul_f32 v225, v225, v52
    v_mul_f32 v226, v226, v52
    v_mul_f32 v227, v227, v52
    v_accvgpr_write_b32 a64, v224
    v_accvgpr_write_b32 a65, v225
    v_accvgpr_write_b32 a66, v226
    v_accvgpr_write_b32 a67, v227
    v_accvgpr_read_b32 v224, a68
    v_accvgpr_read_b32 v225, a69
    v_accvgpr_read_b32 v226, a70
    v_accvgpr_read_b32 v227, a71
    v_mul_f32 v224, v224, v53
    v_mul_f32 v225, v225, v53
    v_mul_f32 v226, v226, v53
    v_mul_f32 v227, v227, v53
    v_accvgpr_write_b32 a68, v224
    v_accvgpr_write_b32 a69, v225
    v_accvgpr_write_b32 a70, v226
    v_accvgpr_write_b32 a71, v227
    v_accvgpr_read_b32 v224, a72
    v_accvgpr_read_b32 v225, a73
    v_accvgpr_read_b32 v226, a74
    v_accvgpr_read_b32 v227, a75
    v_mul_f32 v224, v224, v54
    v_mul_f32 v225, v225, v54
    v_mul_f32 v226, v226, v54
    v_mul_f32 v227, v227, v54
    v_accvgpr_write_b32 a72, v224
    v_accvgpr_write_b32 a73, v225
    v_accvgpr_write_b32 a74, v226
    v_accvgpr_write_b32 a75, v227
    v_accvgpr_read_b32 v224, a76
    v_accvgpr_read_b32 v225, a77
    v_accvgpr_read_b32 v226, a78
    v_accvgpr_read_b32 v227, a79
    v_mul_f32 v224, v224, v55
    v_mul_f32 v225, v225, v55
    v_mul_f32 v226, v226, v55
    v_mul_f32 v227, v227, v55
    v_accvgpr_write_b32 a76, v224
    v_accvgpr_write_b32 a77, v225
    v_accvgpr_write_b32 a78, v226
    v_accvgpr_write_b32 a79, v227
    v_accvgpr_read_b32 v224, a80
    v_accvgpr_read_b32 v225, a81
    v_accvgpr_read_b32 v226, a82
    v_accvgpr_read_b32 v227, a83
    v_mul_f32 v224, v224, v52
    v_mul_f32 v225, v225, v52
    v_mul_f32 v226, v226, v52
    v_mul_f32 v227, v227, v52
    v_accvgpr_write_b32 a80, v224
    v_accvgpr_write_b32 a81, v225
    v_accvgpr_write_b32 a82, v226
    v_accvgpr_write_b32 a83, v227
    v_accvgpr_read_b32 v224, a84
    v_accvgpr_read_b32 v225, a85
    v_accvgpr_read_b32 v226, a86
    v_accvgpr_read_b32 v227, a87
    v_mul_f32 v224, v224, v53
    v_mul_f32 v225, v225, v53
    v_mul_f32 v226, v226, v53
    v_mul_f32 v227, v227, v53
    v_accvgpr_write_b32 a84, v224
    v_accvgpr_write_b32 a85, v225
    v_accvgpr_write_b32 a86, v226
    v_accvgpr_write_b32 a87, v227
    v_accvgpr_read_b32 v224, a88
    v_accvgpr_read_b32 v225, a89
    v_accvgpr_read_b32 v226, a90
    v_accvgpr_read_b32 v227, a91
    v_mul_f32 v224, v224, v54
    v_mul_f32 v225, v225, v54
    v_mul_f32 v226, v226, v54
    v_mul_f32 v227, v227, v54
    v_accvgpr_write_b32 a88, v224
    v_accvgpr_write_b32 a89, v225
    v_accvgpr_write_b32 a90, v226
    v_accvgpr_write_b32 a91, v227
    v_accvgpr_read_b32 v224, a92
    v_accvgpr_read_b32 v225, a93
    v_accvgpr_read_b32 v226, a94
    v_accvgpr_read_b32 v227, a95
    v_mul_f32 v224, v224, v55
    v_mul_f32 v225, v225, v55
    v_mul_f32 v226, v226, v55
    v_mul_f32 v227, v227, v55
    v_accvgpr_write_b32 a92, v224
    v_accvgpr_write_b32 a93, v225
    v_accvgpr_write_b32 a94, v226
    v_accvgpr_write_b32 a95, v227
    v_accvgpr_read_b32 v224, a96
    v_accvgpr_read_b32 v225, a97
    v_accvgpr_read_b32 v226, a98
    v_accvgpr_read_b32 v227, a99
    v_mul_f32 v224, v224, v52
    v_mul_f32 v225, v225, v52
    v_mul_f32 v226, v226, v52
    v_mul_f32 v227, v227, v52
    v_accvgpr_write_b32 a96, v224
    v_accvgpr_write_b32 a97, v225
    v_accvgpr_write_b32 a98, v226
    v_accvgpr_write_b32 a99, v227
    v_accvgpr_read_b32 v224, a100
    v_accvgpr_read_b32 v225, a101
    v_accvgpr_read_b32 v226, a102
    v_accvgpr_read_b32 v227, a103
    v_mul_f32 v224, v224, v53
    v_mul_f32 v225, v225, v53
    v_mul_f32 v226, v226, v53
    v_mul_f32 v227, v227, v53
    v_accvgpr_write_b32 a100, v224
    v_accvgpr_write_b32 a101, v225
    v_accvgpr_write_b32 a102, v226
    v_accvgpr_write_b32 a103, v227
    v_accvgpr_read_b32 v224, a104
    v_accvgpr_read_b32 v225, a105
    v_accvgpr_read_b32 v226, a106
    v_accvgpr_read_b32 v227, a107
    v_mul_f32 v224, v224, v54
    v_mul_f32 v225, v225, v54
    v_mul_f32 v226, v226, v54
    v_mul_f32 v227, v227, v54
    v_accvgpr_write_b32 a104, v224
    v_accvgpr_write_b32 a105, v225
    v_accvgpr_write_b32 a106, v226
    v_accvgpr_write_b32 a107, v227
    v_accvgpr_read_b32 v224, a108
    v_accvgpr_read_b32 v225, a109
    v_accvgpr_read_b32 v226, a110
    v_accvgpr_read_b32 v227, a111
    v_mul_f32 v224, v224, v55
    v_mul_f32 v225, v225, v55
    v_mul_f32 v226, v226, v55
    v_mul_f32 v227, v227, v55
    v_accvgpr_write_b32 a108, v224
    v_accvgpr_write_b32 a109, v225
    v_accvgpr_write_b32 a110, v226
    v_accvgpr_write_b32 a111, v227
    v_accvgpr_read_b32 v224, a112
    v_accvgpr_read_b32 v225, a113
    v_accvgpr_read_b32 v226, a114
    v_accvgpr_read_b32 v227, a115
    v_mul_f32 v224, v224, v52
    v_mul_f32 v225, v225, v52
    v_mul_f32 v226, v226, v52
    v_mul_f32 v227, v227, v52
    v_accvgpr_write_b32 a112, v224
    v_accvgpr_write_b32 a113, v225
    v_accvgpr_write_b32 a114, v226
    v_accvgpr_write_b32 a115, v227
    v_accvgpr_read_b32 v224, a116
    v_accvgpr_read_b32 v225, a117
    v_accvgpr_read_b32 v226, a118
    v_accvgpr_read_b32 v227, a119
    v_mul_f32 v224, v224, v53
    v_mul_f32 v225, v225, v53
    v_mul_f32 v226, v226, v53
    v_mul_f32 v227, v227, v53
    v_accvgpr_write_b32 a116, v224
    v_accvgpr_write_b32 a117, v225
    v_accvgpr_write_b32 a118, v226
    v_accvgpr_write_b32 a119, v227
    v_accvgpr_read_b32 v224, a120
    v_accvgpr_read_b32 v225, a121
    v_accvgpr_read_b32 v226, a122
    v_accvgpr_read_b32 v227, a123
    v_mul_f32 v224, v224, v54
    v_mul_f32 v225, v225, v54
    v_mul_f32 v226, v226, v54
    v_mul_f32 v227, v227, v54
    v_accvgpr_write_b32 a120, v224
    v_accvgpr_write_b32 a121, v225
    v_accvgpr_write_b32 a122, v226
    v_accvgpr_write_b32 a123, v227
    v_accvgpr_read_b32 v224, a124
    v_accvgpr_read_b32 v225, a125
    v_accvgpr_read_b32 v226, a126
    v_accvgpr_read_b32 v227, a127
    v_mul_f32 v224, v224, v55
    v_mul_f32 v225, v225, v55
    v_mul_f32 v226, v226, v55
    v_mul_f32 v227, v227, v55
    v_accvgpr_write_b32 a124, v224
    v_accvgpr_write_b32 a125, v225
    v_accvgpr_write_b32 a126, v226
    v_accvgpr_write_b32 a127, v227
    v_exp_f32 v232, v128
    v_exp_f32 v233, v129
    v_exp_f32 v234, v130
    v_exp_f32 v235, v131
    s_nop 0
    v_cvt_pk_bf16_f32 v192, v232, v233
    v_cvt_pk_bf16_f32 v193, v234, v235
    v_exp_f32 v232, v144
    v_exp_f32 v233, v145
    v_exp_f32 v234, v146
    v_exp_f32 v235, v147
    s_nop 0
    v_cvt_pk_bf16_f32 v194, v232, v233
    v_cvt_pk_bf16_f32 v195, v234, v235
    v_exp_f32 v232, v132
    v_exp_f32 v233, v133
    v_exp_f32 v234, v134
    v_exp_f32 v235, v135
    s_nop 0
    v_cvt_pk_bf16_f32 v196, v232, v233
    v_cvt_pk_bf16_f32 v197, v234, v235
    v_exp_f32 v232, v148
    v_exp_f32 v233, v149
    v_exp_f32 v234, v150
    v_exp_f32 v235, v151
    s_nop 0
    v_cvt_pk_bf16_f32 v198, v232, v233
    v_cvt_pk_bf16_f32 v199, v234, v235
    v_exp_f32 v232, v136
    v_exp_f32 v233, v137
    v_exp_f32 v234, v138
    v_exp_f32 v235, v139
    s_nop 0
    v_cvt_pk_bf16_f32 v200, v232, v233
    v_cvt_pk_bf16_f32 v201, v234, v235
    v_exp_f32 v232, v152
    v_exp_f32 v233, v153
    v_exp_f32 v234, v154
    v_exp_f32 v235, v155
    s_nop 0
    v_cvt_pk_bf16_f32 v202, v232, v233
    v_cvt_pk_bf16_f32 v203, v234, v235
    v_exp_f32 v232, v140
    v_exp_f32 v233, v141
    v_exp_f32 v234, v142
    v_exp_f32 v235, v143
    s_nop 0
    v_cvt_pk_bf16_f32 v204, v232, v233
    v_cvt_pk_bf16_f32 v205, v234, v235
    v_exp_f32 v232, v156
    v_exp_f32 v233, v157
    v_exp_f32 v234, v158
    v_exp_f32 v235, v159
    s_nop 0
    v_cvt_pk_bf16_f32 v206, v232, v233
    v_cvt_pk_bf16_f32 v207, v234, v235
    s_nop 3
    s_setpc_b64 s[40:41]
k2_rare_159:
    s_nop 7
    v_max_f32 v52, v160, v161
    v_max3_f32 v52, v52, v162, v163
    v_max3_f32 v52, v52, v176, v177
    v_max3_f32 v52, v52, v178, v179
    v_max_f32 v53, v164, v165
    v_max3_f32 v53, v53, v166, v167
    v_max3_f32 v53, v53, v180, v181
    v_max3_f32 v53, v53, v182, v183
    v_max_f32 v54, v168, v169
    v_max3_f32 v54, v54, v170, v171
    v_max3_f32 v54, v54, v184, v185
    v_max3_f32 v54, v54, v186, v187
    v_max_f32 v55, v172, v173
    v_max3_f32 v55, v55, v174, v175
    v_max3_f32 v55, v55, v188, v189
    v_max3_f32 v55, v55, v190, v191
    v_mov_b32 v224, v52
    v_mov_b32 v225, v53
    v_mov_b32 v226, v54
    v_mov_b32 v227, v55
    s_nop 1
    v_permlane16_swap_b32 v52, v224
    v_permlane16_swap_b32 v53, v225
    v_permlane16_swap_b32 v54, v226
    v_permlane16_swap_b32 v55, v227
    s_nop 1
    v_max_f32 v52, v52, v224
    v_max_f32 v53, v53, v225
    v_max_f32 v54, v54, v226
    v_max_f32 v55, v55, v227
    v_mov_b32 v224, v52
    v_mov_b32 v225, v53
    v_mov_b32 v226, v54
    v_mov_b32 v227, v55
    s_nop 1
    v_permlane32_swap_b32 v52, v224
    v_permlane32_swap_b32 v53, v225
    v_permlane32_swap_b32 v54, v226
    v_permlane32_swap_b32 v55, v227
    s_nop 1
    v_max_f32 v52, v52, v224
    v_max_f32 v53, v53, v225
    v_max_f32 v54, v54, v226
    v_max_f32 v55, v55, v227
    v_add_f32 v52, 0x41400000, v52
    v_max_f32 v52, 0, v52
    v_add_f32 v53, 0x41400000, v53
    v_max_f32 v53, 0, v53
    v_add_f32 v54, 0x41400000, v54
    v_max_f32 v54, 0, v54
    v_add_f32 v55, 0x41400000, v55
    v_max_f32 v55, 0, v55
    v_sub_f32 v160, v160, v52
    v_sub_f32 v161, v161, v52
    v_sub_f32 v162, v162, v52
    v_sub_f32 v163, v163, v52
    v_sub_f32 v164, v164, v53
    v_sub_f32 v165, v165, v53
    v_sub_f32 v166, v166, v53
    v_sub_f32 v167, v167, v53
    v_sub_f32 v168, v168, v54
    v_sub_f32 v169, v169, v54
    v_sub_f32 v170, v170, v54
    v_sub_f32 v171, v171, v54
    v_sub_f32 v172, v172, v55
    v_sub_f32 v173, v173, v55
    v_sub_f32 v174, v174, v55
    v_sub_f32 v175, v175, v55
    v_sub_f32 v176, v176, v52
    v_sub_f32 v177, v177, v52
    v_sub_f32 v178, v178, v52
    v_sub_f32 v179, v179, v52
    v_sub_f32 v180, v180, v53
    v_sub_f32 v181, v181, v53
    v_sub_f32 v182, v182, v53
    v_sub_f32 v183, v183, v53
    v_sub_f32 v184, v184, v54
    v_sub_f32 v185, v185, v54
    v_sub_f32 v186, v186, v54
    v_sub_f32 v187, v187, v54
    v_sub_f32 v188, v188, v55
    v_sub_f32 v189, v189, v55
    v_sub_f32 v190, v190, v55
    v_sub_f32 v191, v191, v55
    v_sub_f32 v128, v128, v52
    v_sub_f32 v16, v16, v52
    v_sub_f32 v129, v129, v52
    v_sub_f32 v17, v17, v52
    v_sub_f32 v130, v130, v52
    v_sub_f32 v18, v18, v52
    v_sub_f32 v131, v131, v52
    v_sub_f32 v19, v19, v52
    v_sub_f32 v132, v132, v53
    v_sub_f32 v20, v20, v53
    v_sub_f32 v133, v133, v53
    v_sub_f32 v21, v21, v53
    v_sub_f32 v134, v134, v53
    v_sub_f32 v22, v22, v53
    v_sub_f32 v135, v135, v53
    v_sub_f32 v23, v23, v53
    v_sub_f32 v136, v136, v54
    v_sub_f32 v24, v24, v54
    v_sub_f32 v137, v137, v54
    v_sub_f32 v25, v25, v54
    v_sub_f32 v138, v138, v54
    v_sub_f32 v26, v26, v54
    v_sub_f32 v139, v139, v54
    v_sub_f32 v27, v27, v54
    v_sub_f32 v140, v140, v55
    v_sub_f32 v28, v28, v55
    v_sub_f32 v141, v141, v55
    v_sub_f32 v29, v29, v55
    v_sub_f32 v142, v142, v55
    v_sub_f32 v30, v30, v55
    v_sub_f32 v143, v143, v55
    v_sub_f32 v31, v31, v55
    v_sub_f32 v144, v144, v52
    v_sub_f32 v32, v32, v52
    v_sub_f32 v145, v145, v52
    v_sub_f32 v33, v33, v52
    v_sub_f32 v146, v146, v52
    v_sub_f32 v34, v34, v52
    v_sub_f32 v147, v147, v52
    v_sub_f32 v35, v35, v52
    v_sub_f32 v148, v148, v53
    v_sub_f32 v36, v36, v53
    v_sub_f32 v149, v149, v53
    v_sub_f32 v37, v37, v53
    v_sub_f32 v150, v150, v53
    v_sub_f32 v38, v38, v53
    v_sub_f32 v151, v151, v53
    v_sub_f32 v39, v39, v53
    v_sub_f32 v152, v152, v54
    v_sub_f32 v40, v40, v54
    v_sub_f32 v153, v153, v54
    v_sub_f32 v41, v41, v54
    v_sub_f32 v154, v154, v54
    v_sub_f32 v42, v42, v54
    v_sub_f32 v155, v155, v54
    v_sub_f32 v43, v43, v54
    v_sub_f32 v156, v156, v55
    v_sub_f32 v44, v44, v55
    v_sub_f32 v157, v157, v55
    v_sub_f32 v45, v45, v55
    v_sub_f32 v158, v158, v55
    v_sub_f32 v46, v46, v55
    v_sub_f32 v159, v159, v55
    v_sub_f32 v47, v47, v55
    v_sub_f32 v8, v8, v52
    v_exp_f32 v52, -v52
    v_sub_f32 v9, v9, v53
    v_exp_f32 v53, -v53
    v_sub_f32 v10, v10, v54
    v_exp_f32 v54, -v54
    v_sub_f32 v11, v11, v55
    v_exp_f32 v55, -v55
    s_nop 0
    v_mul_f32 v12, v12, v52
    v_mul_f32 v48, v48, v53
    v_mul_f32 v248, v248, v54
    v_mul_f32 v252, v252, v55
    v_accvgpr_read_b32 v224, a0
    v_accvgpr_read_b32 v225, a1
    v_accvgpr_read_b32 v226, a2
    v_accvgpr_read_b32 v227, a3
    v_mul_f32 v224, v224, v52
    v_mul_f32 v225, v225, v52
    v_mul_f32 v226, v226, v52
    v_mul_f32 v227, v227, v52
    v_accvgpr_write_b32 a0, v224
    v_accvgpr_write_b32 a1, v225
    v_accvgpr_write_b32 a2, v226
    v_accvgpr_write_b32 a3, v227
    v_accvgpr_read_b32 v224, a4
    v_accvgpr_read_b32 v225, a5
    v_accvgpr_read_b32 v226, a6
    v_accvgpr_read_b32 v227, a7
    v_mul_f32 v224, v224, v53
    v_mul_f32 v225, v225, v53
    v_mul_f32 v226, v226, v53
    v_mul_f32 v227, v227, v53
    v_accvgpr_write_b32 a4, v224
    v_accvgpr_write_b32 a5, v225
    v_accvgpr_write_b32 a6, v226
    v_accvgpr_write_b32 a7, v227
    v_accvgpr_read_b32 v224, a8
    v_accvgpr_read_b32 v225, a9
    v_accvgpr_read_b32 v226, a10
    v_accvgpr_read_b32 v227, a11
    v_mul_f32 v224, v224, v54
    v_mul_f32 v225, v225, v54
    v_mul_f32 v226, v226, v54
    v_mul_f32 v227, v227, v54
    v_accvgpr_write_b32 a8, v224
    v_accvgpr_write_b32 a9, v225
    v_accvgpr_write_b32 a10, v226
    v_accvgpr_write_b32 a11, v227
    v_accvgpr_read_b32 v224, a12
    v_accvgpr_read_b32 v225, a13
    v_accvgpr_read_b32 v226, a14
    v_accvgpr_read_b32 v227, a15
    v_mul_f32 v224, v224, v55
    v_mul_f32 v225, v225, v55
    v_mul_f32 v226, v226, v55
    v_mul_f32 v227, v227, v55
    v_accvgpr_write_b32 a12, v224
    v_accvgpr_write_b32 a13, v225
    v_accvgpr_write_b32 a14, v226
    v_accvgpr_write_b32 a15, v227
    v_accvgpr_read_b32 v224, a16
    v_accvgpr_read_b32 v225, a17
    v_accvgpr_read_b32 v226, a18
    v_accvgpr_read_b32 v227, a19
    v_mul_f32 v224, v224, v52
    v_mul_f32 v225, v225, v52
    v_mul_f32 v226, v226, v52
    v_mul_f32 v227, v227, v52
    v_accvgpr_write_b32 a16, v224
    v_accvgpr_write_b32 a17, v225
    v_accvgpr_write_b32 a18, v226
    v_accvgpr_write_b32 a19, v227
    v_accvgpr_read_b32 v224, a20
    v_accvgpr_read_b32 v225, a21
    v_accvgpr_read_b32 v226, a22
    v_accvgpr_read_b32 v227, a23
    v_mul_f32 v224, v224, v53
    v_mul_f32 v225, v225, v53
    v_mul_f32 v226, v226, v53
    v_mul_f32 v227, v227, v53
    v_accvgpr_write_b32 a20, v224
    v_accvgpr_write_b32 a21, v225
    v_accvgpr_write_b32 a22, v226
    v_accvgpr_write_b32 a23, v227
    v_accvgpr_read_b32 v224, a24
    v_accvgpr_read_b32 v225, a25
    v_accvgpr_read_b32 v226, a26
    v_accvgpr_read_b32 v227, a27
    v_mul_f32 v224, v224, v54
    v_mul_f32 v225, v225, v54
    v_mul_f32 v226, v226, v54
    v_mul_f32 v227, v227, v54
    v_accvgpr_write_b32 a24, v224
    v_accvgpr_write_b32 a25, v225
    v_accvgpr_write_b32 a26, v226
    v_accvgpr_write_b32 a27, v227
    v_accvgpr_read_b32 v224, a28
    v_accvgpr_read_b32 v225, a29
    v_accvgpr_read_b32 v226, a30
    v_accvgpr_read_b32 v227, a31
    v_mul_f32 v224, v224, v55
    v_mul_f32 v225, v225, v55
    v_mul_f32 v226, v226, v55
    v_mul_f32 v227, v227, v55
    v_accvgpr_write_b32 a28, v224
    v_accvgpr_write_b32 a29, v225
    v_accvgpr_write_b32 a30, v226
    v_accvgpr_write_b32 a31, v227
    v_accvgpr_read_b32 v224, a32
    v_accvgpr_read_b32 v225, a33
    v_accvgpr_read_b32 v226, a34
    v_accvgpr_read_b32 v227, a35
    v_mul_f32 v224, v224, v52
    v_mul_f32 v225, v225, v52
    v_mul_f32 v226, v226, v52
    v_mul_f32 v227, v227, v52
    v_accvgpr_write_b32 a32, v224
    v_accvgpr_write_b32 a33, v225
    v_accvgpr_write_b32 a34, v226
    v_accvgpr_write_b32 a35, v227
    v_accvgpr_read_b32 v224, a36
    v_accvgpr_read_b32 v225, a37
    v_accvgpr_read_b32 v226, a38
    v_accvgpr_read_b32 v227, a39
    v_mul_f32 v224, v224, v53
    v_mul_f32 v225, v225, v53
    v_mul_f32 v226, v226, v53
    v_mul_f32 v227, v227, v53
    v_accvgpr_write_b32 a36, v224
    v_accvgpr_write_b32 a37, v225
    v_accvgpr_write_b32 a38, v226
    v_accvgpr_write_b32 a39, v227
    v_accvgpr_read_b32 v224, a40
    v_accvgpr_read_b32 v225, a41
    v_accvgpr_read_b32 v226, a42
    v_accvgpr_read_b32 v227, a43
    v_mul_f32 v224, v224, v54
    v_mul_f32 v225, v225, v54
    v_mul_f32 v226, v226, v54
    v_mul_f32 v227, v227, v54
    v_accvgpr_write_b32 a40, v224
    v_accvgpr_write_b32 a41, v225
    v_accvgpr_write_b32 a42, v226
    v_accvgpr_write_b32 a43, v227
    v_accvgpr_read_b32 v224, a44
    v_accvgpr_read_b32 v225, a45
    v_accvgpr_read_b32 v226, a46
    v_accvgpr_read_b32 v227, a47
    v_mul_f32 v224, v224, v55
    v_mul_f32 v225, v225, v55
    v_mul_f32 v226, v226, v55
    v_mul_f32 v227, v227, v55
    v_accvgpr_write_b32 a44, v224
    v_accvgpr_write_b32 a45, v225
    v_accvgpr_write_b32 a46, v226
    v_accvgpr_write_b32 a47, v227
    v_accvgpr_read_b32 v224, a48
    v_accvgpr_read_b32 v225, a49
    v_accvgpr_read_b32 v226, a50
    v_accvgpr_read_b32 v227, a51
    v_mul_f32 v224, v224, v52
    v_mul_f32 v225, v225, v52
    v_mul_f32 v226, v226, v52
    v_mul_f32 v227, v227, v52
    v_accvgpr_write_b32 a48, v224
    v_accvgpr_write_b32 a49, v225
    v_accvgpr_write_b32 a50, v226
    v_accvgpr_write_b32 a51, v227
    v_accvgpr_read_b32 v224, a52
    v_accvgpr_read_b32 v225, a53
    v_accvgpr_read_b32 v226, a54
    v_accvgpr_read_b32 v227, a55
    v_mul_f32 v224, v224, v53
    v_mul_f32 v225, v225, v53
    v_mul_f32 v226, v226, v53
    v_mul_f32 v227, v227, v53
    v_accvgpr_write_b32 a52, v224
    v_accvgpr_write_b32 a53, v225
    v_accvgpr_write_b32 a54, v226
    v_accvgpr_write_b32 a55, v227
    v_accvgpr_read_b32 v224, a56
    v_accvgpr_read_b32 v225, a57
    v_accvgpr_read_b32 v226, a58
    v_accvgpr_read_b32 v227, a59
    v_mul_f32 v224, v224, v54
    v_mul_f32 v225, v225, v54
    v_mul_f32 v226, v226, v54
    v_mul_f32 v227, v227, v54
    v_accvgpr_write_b32 a56, v224
    v_accvgpr_write_b32 a57, v225
    v_accvgpr_write_b32 a58, v226
    v_accvgpr_write_b32 a59, v227
    v_accvgpr_read_b32 v224, a60
    v_accvgpr_read_b32 v225, a61
    v_accvgpr_read_b32 v226, a62
    v_accvgpr_read_b32 v227, a63
    v_mul_f32 v224, v224, v55
    v_mul_f32 v225, v225, v55
    v_mul_f32 v226, v226, v55
    v_mul_f32 v227, v227, v55
    v_accvgpr_write_b32 a60, v224
    v_accvgpr_write_b32 a61, v225
    v_accvgpr_write_b32 a62, v226
    v_accvgpr_write_b32 a63, v227
    v_accvgpr_read_b32 v224, a64
    v_accvgpr_read_b32 v225, a65
    v_accvgpr_read_b32 v226, a66
    v_accvgpr_read_b32 v227, a67
    v_mul_f32 v224, v224, v52
    v_mul_f32 v225, v225, v52
    v_mul_f32 v226, v226, v52
    v_mul_f32 v227, v227, v52
    v_accvgpr_write_b32 a64, v224
    v_accvgpr_write_b32 a65, v225
    v_accvgpr_write_b32 a66, v226
    v_accvgpr_write_b32 a67, v227
    v_accvgpr_read_b32 v224, a68
    v_accvgpr_read_b32 v225, a69
    v_accvgpr_read_b32 v226, a70
    v_accvgpr_read_b32 v227, a71
    v_mul_f32 v224, v224, v53
    v_mul_f32 v225, v225, v53
    v_mul_f32 v226, v226, v53
    v_mul_f32 v227, v227, v53
    v_accvgpr_write_b32 a68, v224
    v_accvgpr_write_b32 a69, v225
    v_accvgpr_write_b32 a70, v226
    v_accvgpr_write_b32 a71, v227
    v_accvgpr_read_b32 v224, a72
    v_accvgpr_read_b32 v225, a73
    v_accvgpr_read_b32 v226, a74
    v_accvgpr_read_b32 v227, a75
    v_mul_f32 v224, v224, v54
    v_mul_f32 v225, v225, v54
    v_mul_f32 v226, v226, v54
    v_mul_f32 v227, v227, v54
    v_accvgpr_write_b32 a72, v224
    v_accvgpr_write_b32 a73, v225
    v_accvgpr_write_b32 a74, v226
    v_accvgpr_write_b32 a75, v227
    v_accvgpr_read_b32 v224, a76
    v_accvgpr_read_b32 v225, a77
    v_accvgpr_read_b32 v226, a78
    v_accvgpr_read_b32 v227, a79
    v_mul_f32 v224, v224, v55
    v_mul_f32 v225, v225, v55
    v_mul_f32 v226, v226, v55
    v_mul_f32 v227, v227, v55
    v_accvgpr_write_b32 a76, v224
    v_accvgpr_write_b32 a77, v225
    v_accvgpr_write_b32 a78, v226
    v_accvgpr_write_b32 a79, v227
    v_accvgpr_read_b32 v224, a80
    v_accvgpr_read_b32 v225, a81
    v_accvgpr_read_b32 v226, a82
    v_accvgpr_read_b32 v227, a83
    v_mul_f32 v224, v224, v52
    v_mul_f32 v225, v225, v52
    v_mul_f32 v226, v226, v52
    v_mul_f32 v227, v227, v52
    v_accvgpr_write_b32 a80, v224
    v_accvgpr_write_b32 a81, v225
    v_accvgpr_write_b32 a82, v226
    v_accvgpr_write_b32 a83, v227
    v_accvgpr_read_b32 v224, a84
    v_accvgpr_read_b32 v225, a85
    v_accvgpr_read_b32 v226, a86
    v_accvgpr_read_b32 v227, a87
    v_mul_f32 v224, v224, v53
    v_mul_f32 v225, v225, v53
    v_mul_f32 v226, v226, v53
    v_mul_f32 v227, v227, v53
    v_accvgpr_write_b32 a84, v224
    v_accvgpr_write_b32 a85, v225
    v_accvgpr_write_b32 a86, v226
    v_accvgpr_write_b32 a87, v227
    v_accvgpr_read_b32 v224, a88
    v_accvgpr_read_b32 v225, a89
    v_accvgpr_read_b32 v226, a90
    v_accvgpr_read_b32 v227, a91
    v_mul_f32 v224, v224, v54
    v_mul_f32 v225, v225, v54
    v_mul_f32 v226, v226, v54
    v_mul_f32 v227, v227, v54
    v_accvgpr_write_b32 a88, v224
    v_accvgpr_write_b32 a89, v225
    v_accvgpr_write_b32 a90, v226
    v_accvgpr_write_b32 a91, v227
    v_accvgpr_read_b32 v224, a92
    v_accvgpr_read_b32 v225, a93
    v_accvgpr_read_b32 v226, a94
    v_accvgpr_read_b32 v227, a95
    v_mul_f32 v224, v224, v55
    v_mul_f32 v225, v225, v55
    v_mul_f32 v226, v226, v55
    v_mul_f32 v227, v227, v55
    v_accvgpr_write_b32 a92, v224
    v_accvgpr_write_b32 a93, v225
    v_accvgpr_write_b32 a94, v226
    v_accvgpr_write_b32 a95, v227
    v_accvgpr_read_b32 v224, a96
    v_accvgpr_read_b32 v225, a97
    v_accvgpr_read_b32 v226, a98
    v_accvgpr_read_b32 v227, a99
    v_mul_f32 v224, v224, v52
    v_mul_f32 v225, v225, v52
    v_mul_f32 v226, v226, v52
    v_mul_f32 v227, v227, v52
    v_accvgpr_write_b32 a96, v224
    v_accvgpr_write_b32 a97, v225
    v_accvgpr_write_b32 a98, v226
    v_accvgpr_write_b32 a99, v227
    v_accvgpr_read_b32 v224, a100
    v_accvgpr_read_b32 v225, a101
    v_accvgpr_read_b32 v226, a102
    v_accvgpr_read_b32 v227, a103
    v_mul_f32 v224, v224, v53
    v_mul_f32 v225, v225, v53
    v_mul_f32 v226, v226, v53
    v_mul_f32 v227, v227, v53
    v_accvgpr_write_b32 a100, v224
    v_accvgpr_write_b32 a101, v225
    v_accvgpr_write_b32 a102, v226
    v_accvgpr_write_b32 a103, v227
    v_accvgpr_read_b32 v224, a104
    v_accvgpr_read_b32 v225, a105
    v_accvgpr_read_b32 v226, a106
    v_accvgpr_read_b32 v227, a107
    v_mul_f32 v224, v224, v54
    v_mul_f32 v225, v225, v54
    v_mul_f32 v226, v226, v54
    v_mul_f32 v227, v227, v54
    v_accvgpr_write_b32 a104, v224
    v_accvgpr_write_b32 a105, v225
    v_accvgpr_write_b32 a106, v226
    v_accvgpr_write_b32 a107, v227
    v_accvgpr_read_b32 v224, a108
    v_accvgpr_read_b32 v225, a109
    v_accvgpr_read_b32 v226, a110
    v_accvgpr_read_b32 v227, a111
    v_mul_f32 v224, v224, v55
    v_mul_f32 v225, v225, v55
    v_mul_f32 v226, v226, v55
    v_mul_f32 v227, v227, v55
    v_accvgpr_write_b32 a108, v224
    v_accvgpr_write_b32 a109, v225
    v_accvgpr_write_b32 a110, v226
    v_accvgpr_write_b32 a111, v227
    v_accvgpr_read_b32 v224, a112
    v_accvgpr_read_b32 v225, a113
    v_accvgpr_read_b32 v226, a114
    v_accvgpr_read_b32 v227, a115
    v_mul_f32 v224, v224, v52
    v_mul_f32 v225, v225, v52
    v_mul_f32 v226, v226, v52
    v_mul_f32 v227, v227, v52
    v_accvgpr_write_b32 a112, v224
    v_accvgpr_write_b32 a113, v225
    v_accvgpr_write_b32 a114, v226
    v_accvgpr_write_b32 a115, v227
    v_accvgpr_read_b32 v224, a116
    v_accvgpr_read_b32 v225, a117
    v_accvgpr_read_b32 v226, a118
    v_accvgpr_read_b32 v227, a119
    v_mul_f32 v224, v224, v53
    v_mul_f32 v225, v225, v53
    v_mul_f32 v226, v226, v53
    v_mul_f32 v227, v227, v53
    v_accvgpr_write_b32 a116, v224
    v_accvgpr_write_b32 a117, v225
    v_accvgpr_write_b32 a118, v226
    v_accvgpr_write_b32 a119, v227
    v_accvgpr_read_b32 v224, a120
    v_accvgpr_read_b32 v225, a121
    v_accvgpr_read_b32 v226, a122
    v_accvgpr_read_b32 v227, a123
    v_mul_f32 v224, v224, v54
    v_mul_f32 v225, v225, v54
    v_mul_f32 v226, v226, v54
    v_mul_f32 v227, v227, v54
    v_accvgpr_write_b32 a120, v224
    v_accvgpr_write_b32 a121, v225
    v_accvgpr_write_b32 a122, v226
    v_accvgpr_write_b32 a123, v227
    v_accvgpr_read_b32 v224, a124
    v_accvgpr_read_b32 v225, a125
    v_accvgpr_read_b32 v226, a126
    v_accvgpr_read_b32 v227, a127
    v_mul_f32 v224, v224, v55
    v_mul_f32 v225, v225, v55
    v_mul_f32 v226, v226, v55
    v_mul_f32 v227, v227, v55
    v_accvgpr_write_b32 a124, v224
    v_accvgpr_write_b32 a125, v225
    v_accvgpr_write_b32 a126, v226
    v_accvgpr_write_b32 a127, v227
    v_exp_f32 v232, v160
    v_exp_f32 v233, v161
    v_exp_f32 v234, v162
    v_exp_f32 v235, v163
    s_nop 0
    v_cvt_pk_bf16_f32 v208, v232, v233
    v_cvt_pk_bf16_f32 v209, v234, v235
    v_exp_f32 v232, v176
    v_exp_f32 v233, v177
    v_exp_f32 v234, v178
    v_exp_f32 v235, v179
    s_nop 0
    v_cvt_pk_bf16_f32 v210, v232, v233
    v_cvt_pk_bf16_f32 v211, v234, v235
    v_exp_f32 v232, v164
    v_exp_f32 v233, v165
    v_exp_f32 v234, v166
    v_exp_f32 v235, v167
    s_nop 0
    v_cvt_pk_bf16_f32 v212, v232, v233
    v_cvt_pk_bf16_f32 v213, v234, v235
    v_exp_f32 v232, v180
    v_exp_f32 v233, v181
    v_exp_f32 v234, v182
    v_exp_f32 v235, v183
    s_nop 0
    v_cvt_pk_bf16_f32 v214, v232, v233
    v_cvt_pk_bf16_f32 v215, v234, v235
    v_exp_f32 v232, v168
    v_exp_f32 v233, v169
    v_exp_f32 v234, v170
    v_exp_f32 v235, v171
    s_nop 0
    v_cvt_pk_bf16_f32 v216, v232, v233
    v_cvt_pk_bf16_f32 v217, v234, v235
    v_exp_f32 v232, v184
    v_exp_f32 v233, v185
    v_exp_f32 v234, v186
    v_exp_f32 v235, v187
    s_nop 0
    v_cvt_pk_bf16_f32 v218, v232, v233
    v_cvt_pk_bf16_f32 v219, v234, v235
    v_exp_f32 v232, v172
    v_exp_f32 v233, v173
    v_exp_f32 v234, v174
    v_exp_f32 v235, v175
    s_nop 0
    v_cvt_pk_bf16_f32 v220, v232, v233
    v_cvt_pk_bf16_f32 v221, v234, v235
    v_exp_f32 v232, v188
    v_exp_f32 v233, v189
    v_exp_f32 v234, v190
    v_exp_f32 v235, v191
    s_nop 0
    v_cvt_pk_bf16_f32 v222, v232, v233
    v_cvt_pk_bf16_f32 v223, v234, v235
    s_nop 3
    s_setpc_b64 s[40:41]
k2_rare_164:
    s_nop 7
    v_max_f32 v53, v132, v133
    v_max3_f32 v53, v53, v134, v135
    v_max3_f32 v53, v53, v148, v149
    v_max3_f32 v53, v53, v150, v151
    v_max_f32 v54, v136, v137
    v_max3_f32 v54, v54, v138, v139
    v_max3_f32 v54, v54, v152, v153
    v_max3_f32 v54, v54, v154, v155
    v_max_f32 v55, v140, v141
    v_max3_f32 v55, v55, v142, v143
    v_max3_f32 v55, v55, v156, v157
    v_max3_f32 v55, v55, v158, v159
    v_mov_b32 v225, v53
    v_mov_b32 v226, v54
    v_mov_b32 v227, v55
    s_nop 1
    v_permlane16_swap_b32 v53, v225
    v_permlane16_swap_b32 v54, v226
    v_permlane16_swap_b32 v55, v227
    s_nop 1
    v_max_f32 v53, v53, v225
    v_max_f32 v54, v54, v226
    v_max_f32 v55, v55, v227
    v_mov_b32 v225, v53
    v_mov_b32 v226, v54
    v_mov_b32 v227, v55
    s_nop 1
    v_permlane32_swap_b32 v53, v225
    v_permlane32_swap_b32 v54, v226
    v_permlane32_swap_b32 v55, v227
    s_nop 1
    v_max_f32 v53, v53, v225
    v_max_f32 v54, v54, v226
    v_max_f32 v55, v55, v227
    v_add_f32 v53, 0x41400000, v53
    v_max_f32 v53, 0, v53
    v_add_f32 v54, 0x41400000, v54
    v_max_f32 v54, 0, v54
    v_add_f32 v55, 0x41400000, v55
    v_max_f32 v55, 0, v55
    v_sub_f32 v132, v132, v53
    v_sub_f32 v133, v133, v53
    v_sub_f32 v134, v134, v53
    v_sub_f32 v135, v135, v53
    v_sub_f32 v136, v136, v54
    v_sub_f32 v137, v137, v54
    v_sub_f32 v138, v138, v54
    v_sub_f32 v139, v139, v54
    v_sub_f32 v140, v140, v55
    v_sub_f32 v141, v141, v55
    v_sub_f32 v142, v142, v55
    v_sub_f32 v143, v143, v55
    v_sub_f32 v148, v148, v53
    v_sub_f32 v149, v149, v53
    v_sub_f32 v150, v150, v53
    v_sub_f32 v151, v151, v53
    v_sub_f32 v152, v152, v54
    v_sub_f32 v153, v153, v54
    v_sub_f32 v154, v154, v54
    v_sub_f32 v155, v155, v54
    v_sub_f32 v156, v156, v55
    v_sub_f32 v157, v157, v55
    v_sub_f32 v158, v158, v55
    v_sub_f32 v159, v159, v55
    v_sub_f32 v164, v164, v53
    v_sub_f32 v20, v20, v53
    v_sub_f32 v165, v165, v53
    v_sub_f32 v21, v21, v53
    v_sub_f32 v166, v166, v53
    v_sub_f32 v22, v22, v53
    v_sub_f32 v167, v167, v53
    v_sub_f32 v23, v23, v53
    v_sub_f32 v168, v168, v54
    v_sub_f32 v24, v24, v54
    v_sub_f32 v169, v169, v54
    v_sub_f32 v25, v25, v54
    v_sub_f32 v170, v170, v54
    v_sub_f32 v26, v26, v54
    v_sub_f32 v171, v171, v54
    v_sub_f32 v27, v27, v54
    v_sub_f32 v172, v172, v55
    v_sub_f32 v28, v28, v55
    v_sub_f32 v173, v173, v55
    v_sub_f32 v29, v29, v55
    v_sub_f32 v174, v174, v55
    v_sub_f32 v30, v30, v55
    v_sub_f32 v175, v175, v55
    v_sub_f32 v31, v31, v55
    v_sub_f32 v180, v180, v53
    v_sub_f32 v36, v36, v53
    v_sub_f32 v181, v181, v53
    v_sub_f32 v37, v37, v53
    v_sub_f32 v182, v182, v53
    v_sub_f32 v38, v38, v53
    v_sub_f32 v183, v183, v53
    v_sub_f32 v39, v39, v53
    v_sub_f32 v184, v184, v54
    v_sub_f32 v40, v40, v54
    v_sub_f32 v185, v185, v54
    v_sub_f32 v41, v41, v54
    v_sub_f32 v186, v186, v54
    v_sub_f32 v42, v42, v54
    v_sub_f32 v187, v187, v54
    v_sub_f32 v43, v43, v54
    v_sub_f32 v188, v188, v55
    v_sub_f32 v44, v44, v55
    v_sub_f32 v189, v189, v55
    v_sub_f32 v45, v45, v55
    v_sub_f32 v190, v190, v55
    v_sub_f32 v46, v46, v55
    v_sub_f32 v191, v191, v55
    v_sub_f32 v47, v47, v55
    v_sub_f32 v9, v9, v53
    v_exp_f32 v53, -v53
    v_sub_f32 v10, v10, v54
    v_exp_f32 v54, -v54
    v_sub_f32 v11, v11, v55
    v_exp_f32 v55, -v55
    s_nop 0
    v_mul_f32 v48, v48, v53
    v_mul_f32 v248, v248, v54
    v_mul_f32 v252, v252, v55
    v_accvgpr_read_b32 v224, a4
    v_accvgpr_read_b32 v225, a5
    v_accvgpr_read_b32 v226, a6
    v_accvgpr_read_b32 v227, a7
    v_mul_f32 v224, v224, v53
    v_mul_f32 v225, v225, v53
    v_mul_f32 v226, v226, v53
    v_mul_f32 v227, v227, v53
    v_accvgpr_write_b32 a4, v224
    v_accvgpr_write_b32 a5, v225
    v_accvgpr_write_b32 a6, v226
    v_accvgpr_write_b32 a7, v227
    v_accvgpr_read_b32 v224, a8
    v_accvgpr_read_b32 v225, a9
    v_accvgpr_read_b32 v226, a10
    v_accvgpr_read_b32 v227, a11
    v_mul_f32 v224, v224, v54
    v_mul_f32 v225, v225, v54
    v_mul_f32 v226, v226, v54
    v_mul_f32 v227, v227, v54
    v_accvgpr_write_b32 a8, v224
    v_accvgpr_write_b32 a9, v225
    v_accvgpr_write_b32 a10, v226
    v_accvgpr_write_b32 a11, v227
    v_accvgpr_read_b32 v224, a12
    v_accvgpr_read_b32 v225, a13
    v_accvgpr_read_b32 v226, a14
    v_accvgpr_read_b32 v227, a15
    v_mul_f32 v224, v224, v55
    v_mul_f32 v225, v225, v55
    v_mul_f32 v226, v226, v55
    v_mul_f32 v227, v227, v55
    v_accvgpr_write_b32 a12, v224
    v_accvgpr_write_b32 a13, v225
    v_accvgpr_write_b32 a14, v226
    v_accvgpr_write_b32 a15, v227
    v_accvgpr_read_b32 v224, a20
    v_accvgpr_read_b32 v225, a21
    v_accvgpr_read_b32 v226, a22
    v_accvgpr_read_b32 v227, a23
    v_mul_f32 v224, v224, v53
    v_mul_f32 v225, v225, v53
    v_mul_f32 v226, v226, v53
    v_mul_f32 v227, v227, v53
    v_accvgpr_write_b32 a20, v224
    v_accvgpr_write_b32 a21, v225
    v_accvgpr_write_b32 a22, v226
    v_accvgpr_write_b32 a23, v227
    v_accvgpr_read_b32 v224, a24
    v_accvgpr_read_b32 v225, a25
    v_accvgpr_read_b32 v226, a26
    v_accvgpr_read_b32 v227, a27
    v_mul_f32 v224, v224, v54
    v_mul_f32 v225, v225, v54
    v_mul_f32 v226, v226, v54
    v_mul_f32 v227, v227, v54
    v_accvgpr_write_b32 a24, v224
    v_accvgpr_write_b32 a25, v225
    v_accvgpr_write_b32 a26, v226
    v_accvgpr_write_b32 a27, v227
    v_accvgpr_read_b32 v224, a28
    v_accvgpr_read_b32 v225, a29
    v_accvgpr_read_b32 v226, a30
    v_accvgpr_read_b32 v227, a31
    v_mul_f32 v224, v224, v55
    v_mul_f32 v225, v225, v55
    v_mul_f32 v226, v226, v55
    v_mul_f32 v227, v227, v55
    v_accvgpr_write_b32 a28, v224
    v_accvgpr_write_b32 a29, v225
    v_accvgpr_write_b32 a30, v226
    v_accvgpr_write_b32 a31, v227
    v_accvgpr_read_b32 v224, a36
    v_accvgpr_read_b32 v225, a37
    v_accvgpr_read_b32 v226, a38
    v_accvgpr_read_b32 v227, a39
    v_mul_f32 v224, v224, v53
    v_mul_f32 v225, v225, v53
    v_mul_f32 v226, v226, v53
    v_mul_f32 v227, v227, v53
    v_accvgpr_write_b32 a36, v224
    v_accvgpr_write_b32 a37, v225
    v_accvgpr_write_b32 a38, v226
    v_accvgpr_write_b32 a39, v227
    v_accvgpr_read_b32 v224, a40
    v_accvgpr_read_b32 v225, a41
    v_accvgpr_read_b32 v226, a42
    v_accvgpr_read_b32 v227, a43
    v_mul_f32 v224, v224, v54
    v_mul_f32 v225, v225, v54
    v_mul_f32 v226, v226, v54
    v_mul_f32 v227, v227, v54
    v_accvgpr_write_b32 a40, v224
    v_accvgpr_write_b32 a41, v225
    v_accvgpr_write_b32 a42, v226
    v_accvgpr_write_b32 a43, v227
    v_accvgpr_read_b32 v224, a44
    v_accvgpr_read_b32 v225, a45
    v_accvgpr_read_b32 v226, a46
    v_accvgpr_read_b32 v227, a47
    v_mul_f32 v224, v224, v55
    v_mul_f32 v225, v225, v55
    v_mul_f32 v226, v226, v55
    v_mul_f32 v227, v227, v55
    v_accvgpr_write_b32 a44, v224
    v_accvgpr_write_b32 a45, v225
    v_accvgpr_write_b32 a46, v226
    v_accvgpr_write_b32 a47, v227
    v_accvgpr_read_b32 v224, a52
    v_accvgpr_read_b32 v225, a53
    v_accvgpr_read_b32 v226, a54
    v_accvgpr_read_b32 v227, a55
    v_mul_f32 v224, v224, v53
    v_mul_f32 v225, v225, v53
    v_mul_f32 v226, v226, v53
    v_mul_f32 v227, v227, v53
    v_accvgpr_write_b32 a52, v224
    v_accvgpr_write_b32 a53, v225
    v_accvgpr_write_b32 a54, v226
    v_accvgpr_write_b32 a55, v227
    v_accvgpr_read_b32 v224, a56
    v_accvgpr_read_b32 v225, a57
    v_accvgpr_read_b32 v226, a58
    v_accvgpr_read_b32 v227, a59
    v_mul_f32 v224, v224, v54
    v_mul_f32 v225, v225, v54
    v_mul_f32 v226, v226, v54
    v_mul_f32 v227, v227, v54
    v_accvgpr_write_b32 a56, v224
    v_accvgpr_write_b32 a57, v225
    v_accvgpr_write_b32 a58, v226
    v_accvgpr_write_b32 a59, v227
    v_accvgpr_read_b32 v224, a60
    v_accvgpr_read_b32 v225, a61
    v_accvgpr_read_b32 v226, a62
    v_accvgpr_read_b32 v227, a63
    v_mul_f32 v224, v224, v55
    v_mul_f32 v225, v225, v55
    v_mul_f32 v226, v226, v55
    v_mul_f32 v227, v227, v55
    v_accvgpr_write_b32 a60, v224
    v_accvgpr_write_b32 a61, v225
    v_accvgpr_write_b32 a62, v226
    v_accvgpr_write_b32 a63, v227
    v_accvgpr_read_b32 v224, a68
    v_accvgpr_read_b32 v225, a69
    v_accvgpr_read_b32 v226, a70
    v_accvgpr_read_b32 v227, a71
    v_mul_f32 v224, v224, v53
    v_mul_f32 v225, v225, v53
    v_mul_f32 v226, v226, v53
    v_mul_f32 v227, v227, v53
    v_accvgpr_write_b32 a68, v224
    v_accvgpr_write_b32 a69, v225
    v_accvgpr_write_b32 a70, v226
    v_accvgpr_write_b32 a71, v227
    v_accvgpr_read_b32 v224, a72
    v_accvgpr_read_b32 v225, a73
    v_accvgpr_read_b32 v226, a74
    v_accvgpr_read_b32 v227, a75
    v_mul_f32 v224, v224, v54
    v_mul_f32 v225, v225, v54
    v_mul_f32 v226, v226, v54
    v_mul_f32 v227, v227, v54
    v_accvgpr_write_b32 a72, v224
    v_accvgpr_write_b32 a73, v225
    v_accvgpr_write_b32 a74, v226
    v_accvgpr_write_b32 a75, v227
    v_accvgpr_read_b32 v224, a76
    v_accvgpr_read_b32 v225, a77
    v_accvgpr_read_b32 v226, a78
    v_accvgpr_read_b32 v227, a79
    v_mul_f32 v224, v224, v55
    v_mul_f32 v225, v225, v55
    v_mul_f32 v226, v226, v55
    v_mul_f32 v227, v227, v55
    v_accvgpr_write_b32 a76, v224
    v_accvgpr_write_b32 a77, v225
    v_accvgpr_write_b32 a78, v226
    v_accvgpr_write_b32 a79, v227
    v_accvgpr_read_b32 v224, a84
    v_accvgpr_read_b32 v225, a85
    v_accvgpr_read_b32 v226, a86
    v_accvgpr_read_b32 v227, a87
    v_mul_f32 v224, v224, v53
    v_mul_f32 v225, v225, v53
    v_mul_f32 v226, v226, v53
    v_mul_f32 v227, v227, v53
    v_accvgpr_write_b32 a84, v224
    v_accvgpr_write_b32 a85, v225
    v_accvgpr_write_b32 a86, v226
    v_accvgpr_write_b32 a87, v227
    v_accvgpr_read_b32 v224, a88
    v_accvgpr_read_b32 v225, a89
    v_accvgpr_read_b32 v226, a90
    v_accvgpr_read_b32 v227, a91
    v_mul_f32 v224, v224, v54
    v_mul_f32 v225, v225, v54
    v_mul_f32 v226, v226, v54
    v_mul_f32 v227, v227, v54
    v_accvgpr_write_b32 a88, v224
    v_accvgpr_write_b32 a89, v225
    v_accvgpr_write_b32 a90, v226
    v_accvgpr_write_b32 a91, v227
    v_accvgpr_read_b32 v224, a92
    v_accvgpr_read_b32 v225, a93
    v_accvgpr_read_b32 v226, a94
    v_accvgpr_read_b32 v227, a95
    v_mul_f32 v224, v224, v55
    v_mul_f32 v225, v225, v55
    v_mul_f32 v226, v226, v55
    v_mul_f32 v227, v227, v55
    v_accvgpr_write_b32 a92, v224
    v_accvgpr_write_b32 a93, v225
    v_accvgpr_write_b32 a94, v226
    v_accvgpr_write_b32 a95, v227
    v_accvgpr_read_b32 v224, a100
    v_accvgpr_read_b32 v225, a101
    v_accvgpr_read_b32 v226, a102
    v_accvgpr_read_b32 v227, a103
    v_mul_f32 v224, v224, v53
    v_mul_f32 v225, v225, v53
    v_mul_f32 v226, v226, v53
    v_mul_f32 v227, v227, v53
    v_accvgpr_write_b32 a100, v224
    v_accvgpr_write_b32 a101, v225
    v_accvgpr_write_b32 a102, v226
    v_accvgpr_write_b32 a103, v227
    v_accvgpr_read_b32 v224, a104
    v_accvgpr_read_b32 v225, a105
    v_accvgpr_read_b32 v226, a106
    v_accvgpr_read_b32 v227, a107
    v_mul_f32 v224, v224, v54
    v_mul_f32 v225, v225, v54
    v_mul_f32 v226, v226, v54
    v_mul_f32 v227, v227, v54
    v_accvgpr_write_b32 a104, v224
    v_accvgpr_write_b32 a105, v225
    v_accvgpr_write_b32 a106, v226
    v_accvgpr_write_b32 a107, v227
    v_accvgpr_read_b32 v224, a108
    v_accvgpr_read_b32 v225, a109
    v_accvgpr_read_b32 v226, a110
    v_accvgpr_read_b32 v227, a111
    v_mul_f32 v224, v224, v55
    v_mul_f32 v225, v225, v55
    v_mul_f32 v226, v226, v55
    v_mul_f32 v227, v227, v55
    v_accvgpr_write_b32 a108, v224
    v_accvgpr_write_b32 a109, v225
    v_accvgpr_write_b32 a110, v226
    v_accvgpr_write_b32 a111, v227
    v_accvgpr_read_b32 v224, a116
    v_accvgpr_read_b32 v225, a117
    v_accvgpr_read_b32 v226, a118
    v_accvgpr_read_b32 v227, a119
    v_mul_f32 v224, v224, v53
    v_mul_f32 v225, v225, v53
    v_mul_f32 v226, v226, v53
    v_mul_f32 v227, v227, v53
    v_accvgpr_write_b32 a116, v224
    v_accvgpr_write_b32 a117, v225
    v_accvgpr_write_b32 a118, v226
    v_accvgpr_write_b32 a119, v227
    v_accvgpr_read_b32 v224, a120
    v_accvgpr_read_b32 v225, a121
    v_accvgpr_read_b32 v226, a122
    v_accvgpr_read_b32 v227, a123
    v_mul_f32 v224, v224, v54
    v_mul_f32 v225, v225, v54
    v_mul_f32 v226, v226, v54
    v_mul_f32 v227, v227, v54
    v_accvgpr_write_b32 a120, v224
    v_accvgpr_write_b32 a121, v225
    v_accvgpr_write_b32 a122, v226
    v_accvgpr_write_b32 a123, v227
    v_accvgpr_read_b32 v224, a124
    v_accvgpr_read_b32 v225, a125
    v_accvgpr_read_b32 v226, a126
    v_accvgpr_read_b32 v227, a127
    v_mul_f32 v224, v224, v55
    v_mul_f32 v225, v225, v55
    v_mul_f32 v226, v226, v55
    v_mul_f32 v227, v227, v55
    v_accvgpr_write_b32 a124, v224
    v_accvgpr_write_b32 a125, v225
    v_accvgpr_write_b32 a126, v226
    v_accvgpr_write_b32 a127, v227
    v_exp_f32 v232, v132
    v_exp_f32 v233, v133
    v_exp_f32 v234, v134
    v_exp_f32 v235, v135
    s_nop 0
    v_cvt_pk_bf16_f32 v196, v232, v233
    v_cvt_pk_bf16_f32 v197, v234, v235
    v_exp_f32 v232, v148
    v_exp_f32 v233, v149
    v_exp_f32 v234, v150
    v_exp_f32 v235, v151
    s_nop 0
    v_cvt_pk_bf16_f32 v198, v232, v233
    v_cvt_pk_bf16_f32 v199, v234, v235
    v_exp_f32 v232, v136
    v_exp_f32 v233, v137
    v_exp_f32 v234, v138
    v_exp_f32 v235, v139
    s_nop 0
    v_cvt_pk_bf16_f32 v200, v232, v233
    v_cvt_pk_bf16_f32 v201, v234, v235
    v_exp_f32 v232, v152
    v_exp_f32 v233, v153
    v_exp_f32 v234, v154
    v_exp_f32 v235, v155
    s_nop 0
    v_cvt_pk_bf16_f32 v202, v232, v233
    v_cvt_pk_bf16_f32 v203, v234, v235
    v_exp_f32 v232, v140
    v_exp_f32 v233, v141
    v_exp_f32 v234, v142
    v_exp_f32 v235, v143
    s_nop 0
    v_cvt_pk_bf16_f32 v204, v232, v233
    v_cvt_pk_bf16_f32 v205, v234, v235
    v_exp_f32 v232, v156
    v_exp_f32 v233, v157
    v_exp_f32 v234, v158
    v_exp_f32 v235, v159
    s_nop 0
    v_cvt_pk_bf16_f32 v206, v232, v233
    v_cvt_pk_bf16_f32 v207, v234, v235
    s_nop 3
    s_setpc_b64 s[40:41]
k2_rare_165:
    s_nop 7
    v_max_f32 v53, v164, v165
    v_max3_f32 v53, v53, v166, v167
    v_max3_f32 v53, v53, v180, v181
    v_max3_f32 v53, v53, v182, v183
    v_max_f32 v54, v168, v169
    v_max3_f32 v54, v54, v170, v171
    v_max3_f32 v54, v54, v184, v185
    v_max3_f32 v54, v54, v186, v187
    v_max_f32 v55, v172, v173
    v_max3_f32 v55, v55, v174, v175
    v_max3_f32 v55, v55, v188, v189
    v_max3_f32 v55, v55, v190, v191
    v_mov_b32 v225, v53
    v_mov_b32 v226, v54
    v_mov_b32 v227, v55
    s_nop 1
    v_permlane16_swap_b32 v53, v225
    v_permlane16_swap_b32 v54, v226
    v_permlane16_swap_b32 v55, v227
    s_nop 1
    v_max_f32 v53, v53, v225
    v_max_f32 v54, v54, v226
    v_max_f32 v55, v55, v227
    v_mov_b32 v225, v53
    v_mov_b32 v226, v54
    v_mov_b32 v227, v55
    s_nop 1
    v_permlane32_swap_b32 v53, v225
    v_permlane32_swap_b32 v54, v226
    v_permlane32_swap_b32 v55, v227
    s_nop 1
    v_max_f32 v53, v53, v225
    v_max_f32 v54, v54, v226
    v_max_f32 v55, v55, v227
    v_add_f32 v53, 0x41400000, v53
    v_max_f32 v53, 0, v53
    v_add_f32 v54, 0x41400000, v54
    v_max_f32 v54, 0, v54
    v_add_f32 v55, 0x41400000, v55
    v_max_f32 v55, 0, v55
    v_sub_f32 v164, v164, v53
    v_sub_f32 v165, v165, v53
    v_sub_f32 v166, v166, v53
    v_sub_f32 v167, v167, v53
    v_sub_f32 v168, v168, v54
    v_sub_f32 v169, v169, v54
    v_sub_f32 v170, v170, v54
    v_sub_f32 v171, v171, v54
    v_sub_f32 v172, v172, v55
    v_sub_f32 v173, v173, v55
    v_sub_f32 v174, v174, v55
    v_sub_f32 v175, v175, v55
    v_sub_f32 v180, v180, v53
    v_sub_f32 v181, v181, v53
    v_sub_f32 v182, v182, v53
    v_sub_f32 v183, v183, v53
    v_sub_f32 v184, v184, v54
    v_sub_f32 v185, v185, v54
    v_sub_f32 v186, v186, v54
    v_sub_f32 v187, v187, v54
    v_sub_f32 v188, v188, v55
    v_sub_f32 v189, v189, v55
    v_sub_f32 v190, v190, v55
    v_sub_f32 v191, v191, v55
    v_sub_f32 v128, v128, v54
    v_sub_f32 v16, v16, v54
    v_sub_f32 v129, v129, v54
    v_sub_f32 v17, v17, v54
    v_sub_f32 v130, v130, v54
    v_sub_f32 v18, v18, v54
    v_sub_f32 v131, v131, v54
    v_sub_f32 v19, v19, v54
    v_sub_f32 v132, v132, v55
    v_sub_f32 v20, v20, v55
    v_sub_f32 v133, v133, v55
    v_sub_f32 v21, v21, v55
    v_sub_f32 v134, v134, v55
    v_sub_f32 v22, v22, v55
    v_sub_f32 v135, v135, v55
    v_sub_f32 v23, v23, v55
    v_sub_f32 v136, v136, v54
    v_sub_f32 v24, v24, v54
    v_sub_f32 v137, v137, v54
    v_sub_f32 v25, v25, v54
    v_sub_f32 v138, v138, v54
    v_sub_f32 v26, v26, v54
    v_sub_f32 v139, v139, v54
    v_sub_f32 v27, v27, v54
    v_sub_f32 v140, v140, v55
    v_sub_f32 v28, v28, v55
    v_sub_f32 v141, v141, v55
    v_sub_f32 v29, v29, v55
    v_sub_f32 v142, v142, v55
    v_sub_f32 v30, v30, v55
    v_sub_f32 v143, v143, v55
    v_sub_f32 v31, v31, v55
    v_sub_f32 v144, v144, v54
    v_sub_f32 v32, v32, v54
    v_sub_f32 v145, v145, v54
    v_sub_f32 v33, v33, v54
    v_sub_f32 v146, v146, v54
    v_sub_f32 v34, v34, v54
    v_sub_f32 v147, v147, v54
    v_sub_f32 v35, v35, v54
    v_sub_f32 v148, v148, v55
    v_sub_f32 v36, v36, v55
    v_sub_f32 v149, v149, v55
    v_sub_f32 v37, v37, v55
    v_sub_f32 v150, v150, v55
    v_sub_f32 v38, v38, v55
    v_sub_f32 v151, v151, v55
    v_sub_f32 v39, v39, v55
    v_sub_f32 v152, v152, v54
    v_sub_f32 v40, v40, v54
    v_sub_f32 v153, v153, v54
    v_sub_f32 v41, v41, v54
    v_sub_f32 v154, v154, v54
    v_sub_f32 v42, v42, v54
    v_sub_f32 v155, v155, v54
    v_sub_f32 v43, v43, v54
    v_sub_f32 v156, v156, v55
    v_sub_f32 v44, v44, v55
    v_sub_f32 v157, v157, v55
    v_sub_f32 v45, v45, v55
    v_sub_f32 v158, v158, v55
    v_sub_f32 v46, v46, v55
    v_sub_f32 v159, v159, v55
    v_sub_f32 v47, v47, v55
    v_sub_f32 v9, v9, v53
    v_exp_f32 v53, -v53
    v_sub_f32 v10, v10, v54
    v_exp_f32 v54, -v54
    v_sub_f32 v11, v11, v55
    v_exp_f32 v55, -v55
    s_nop 0
    v_mul_f32 v48, v48, v53
    v_mul_f32 v248, v248, v54
    v_mul_f32 v252, v252, v55
    v_accvgpr_read_b32 v224, a4
    v_accvgpr_read_b32 v225, a5
    v_accvgpr_read_b32 v226, a6
    v_accvgpr_read_b32 v227, a7
    v_mul_f32 v224, v224, v53
    v_mul_f32 v225, v225, v53
    v_mul_f32 v226, v226, v53
    v_mul_f32 v227, v227, v53
    v_accvgpr_write_b32 a4, v224
    v_accvgpr_write_b32 a5, v225
    v_accvgpr_write_b32 a6, v226
    v_accvgpr_write_b32 a7, v227
    v_accvgpr_read_b32 v224, a8
    v_accvgpr_read_b32 v225, a9
    v_accvgpr_read_b32 v226, a10
    v_accvgpr_read_b32 v227, a11
    v_mul_f32 v224, v224, v54
    v_mul_f32 v225, v225, v54
    v_mul_f32 v226, v226, v54
    v_mul_f32 v227, v227, v54
    v_accvgpr_write_b32 a8, v224
    v_accvgpr_write_b32 a9, v225
    v_accvgpr_write_b32 a10, v226
    v_accvgpr_write_b32 a11, v227
    v_accvgpr_read_b32 v224, a12
    v_accvgpr_read_b32 v225, a13
    v_accvgpr_read_b32 v226, a14
    v_accvgpr_read_b32 v227, a15
    v_mul_f32 v224, v224, v55
    v_mul_f32 v225, v225, v55
    v_mul_f32 v226, v226, v55
    v_mul_f32 v227, v227, v55
    v_accvgpr_write_b32 a12, v224
    v_accvgpr_write_b32 a13, v225
    v_accvgpr_write_b32 a14, v226
    v_accvgpr_write_b32 a15, v227
    v_accvgpr_read_b32 v224, a20
    v_accvgpr_read_b32 v225, a21
    v_accvgpr_read_b32 v226, a22
    v_accvgpr_read_b32 v227, a23
    v_mul_f32 v224, v224, v53
    v_mul_f32 v225, v225, v53
    v_mul_f32 v226, v226, v53
    v_mul_f32 v227, v227, v53
    v_accvgpr_write_b32 a20, v224
    v_accvgpr_write_b32 a21, v225
    v_accvgpr_write_b32 a22, v226
    v_accvgpr_write_b32 a23, v227
    v_accvgpr_read_b32 v224, a24
    v_accvgpr_read_b32 v225, a25
    v_accvgpr_read_b32 v226, a26
    v_accvgpr_read_b32 v227, a27
    v_mul_f32 v224, v224, v54
    v_mul_f32 v225, v225, v54
    v_mul_f32 v226, v226, v54
    v_mul_f32 v227, v227, v54
    v_accvgpr_write_b32 a24, v224
    v_accvgpr_write_b32 a25, v225
    v_accvgpr_write_b32 a26, v226
    v_accvgpr_write_b32 a27, v227
    v_accvgpr_read_b32 v224, a28
    v_accvgpr_read_b32 v225, a29
    v_accvgpr_read_b32 v226, a30
    v_accvgpr_read_b32 v227, a31
    v_mul_f32 v224, v224, v55
    v_mul_f32 v225, v225, v55
    v_mul_f32 v226, v226, v55
    v_mul_f32 v227, v227, v55
    v_accvgpr_write_b32 a28, v224
    v_accvgpr_write_b32 a29, v225
    v_accvgpr_write_b32 a30, v226
    v_accvgpr_write_b32 a31, v227
    v_accvgpr_read_b32 v224, a36
    v_accvgpr_read_b32 v225, a37
    v_accvgpr_read_b32 v226, a38
    v_accvgpr_read_b32 v227, a39
    v_mul_f32 v224, v224, v53
    v_mul_f32 v225, v225, v53
    v_mul_f32 v226, v226, v53
    v_mul_f32 v227, v227, v53
    v_accvgpr_write_b32 a36, v224
    v_accvgpr_write_b32 a37, v225
    v_accvgpr_write_b32 a38, v226
    v_accvgpr_write_b32 a39, v227
    v_accvgpr_read_b32 v224, a40
    v_accvgpr_read_b32 v225, a41
    v_accvgpr_read_b32 v226, a42
    v_accvgpr_read_b32 v227, a43
    v_mul_f32 v224, v224, v54
    v_mul_f32 v225, v225, v54
    v_mul_f32 v226, v226, v54
    v_mul_f32 v227, v227, v54
    v_accvgpr_write_b32 a40, v224
    v_accvgpr_write_b32 a41, v225
    v_accvgpr_write_b32 a42, v226
    v_accvgpr_write_b32 a43, v227
    v_accvgpr_read_b32 v224, a44
    v_accvgpr_read_b32 v225, a45
    v_accvgpr_read_b32 v226, a46
    v_accvgpr_read_b32 v227, a47
    v_mul_f32 v224, v224, v55
    v_mul_f32 v225, v225, v55
    v_mul_f32 v226, v226, v55
    v_mul_f32 v227, v227, v55
    v_accvgpr_write_b32 a44, v224
    v_accvgpr_write_b32 a45, v225
    v_accvgpr_write_b32 a46, v226
    v_accvgpr_write_b32 a47, v227
    v_accvgpr_read_b32 v224, a52
    v_accvgpr_read_b32 v225, a53
    v_accvgpr_read_b32 v226, a54
    v_accvgpr_read_b32 v227, a55
    v_mul_f32 v224, v224, v53
    v_mul_f32 v225, v225, v53
    v_mul_f32 v226, v226, v53
    v_mul_f32 v227, v227, v53
    v_accvgpr_write_b32 a52, v224
    v_accvgpr_write_b32 a53, v225
    v_accvgpr_write_b32 a54, v226
    v_accvgpr_write_b32 a55, v227
    v_accvgpr_read_b32 v224, a56
    v_accvgpr_read_b32 v225, a57
    v_accvgpr_read_b32 v226, a58
    v_accvgpr_read_b32 v227, a59
    v_mul_f32 v224, v224, v54
    v_mul_f32 v225, v225, v54
    v_mul_f32 v226, v226, v54
    v_mul_f32 v227, v227, v54
    v_accvgpr_write_b32 a56, v224
    v_accvgpr_write_b32 a57, v225
    v_accvgpr_write_b32 a58, v226
    v_accvgpr_write_b32 a59, v227
    v_accvgpr_read_b32 v224, a60
    v_accvgpr_read_b32 v225, a61
    v_accvgpr_read_b32 v226, a62
    v_accvgpr_read_b32 v227, a63
    v_mul_f32 v224, v224, v55
    v_mul_f32 v225, v225, v55
    v_mul_f32 v226, v226, v55
    v_mul_f32 v227, v227, v55
    v_accvgpr_write_b32 a60, v224
    v_accvgpr_write_b32 a61, v225
    v_accvgpr_write_b32 a62, v226
    v_accvgpr_write_b32 a63, v227
    v_accvgpr_read_b32 v224, a68
    v_accvgpr_read_b32 v225, a69
    v_accvgpr_read_b32 v226, a70
    v_accvgpr_read_b32 v227, a71
    v_mul_f32 v224, v224, v53
    v_mul_f32 v225, v225, v53
    v_mul_f32 v226, v226, v53
    v_mul_f32 v227, v227, v53
    v_accvgpr_write_b32 a68, v224
    v_accvgpr_write_b32 a69, v225
    v_accvgpr_write_b32 a70, v226
    v_accvgpr_write_b32 a71, v227
    v_accvgpr_read_b32 v224, a72
    v_accvgpr_read_b32 v225, a73
    v_accvgpr_read_b32 v226, a74
    v_accvgpr_read_b32 v227, a75
    v_mul_f32 v224, v224, v54
    v_mul_f32 v225, v225, v54
    v_mul_f32 v226, v226, v54
    v_mul_f32 v227, v227, v54
    v_accvgpr_write_b32 a72, v224
    v_accvgpr_write_b32 a73, v225
    v_accvgpr_write_b32 a74, v226
    v_accvgpr_write_b32 a75, v227
    v_accvgpr_read_b32 v224, a76
    v_accvgpr_read_b32 v225, a77
    v_accvgpr_read_b32 v226, a78
    v_accvgpr_read_b32 v227, a79
    v_mul_f32 v224, v224, v55
    v_mul_f32 v225, v225, v55
    v_mul_f32 v226, v226, v55
    v_mul_f32 v227, v227, v55
    v_accvgpr_write_b32 a76, v224
    v_accvgpr_write_b32 a77, v225
    v_accvgpr_write_b32 a78, v226
    v_accvgpr_write_b32 a79, v227
    v_accvgpr_read_b32 v224, a84
    v_accvgpr_read_b32 v225, a85
    v_accvgpr_read_b32 v226, a86
    v_accvgpr_read_b32 v227, a87
    v_mul_f32 v224, v224, v53
    v_mul_f32 v225, v225, v53
    v_mul_f32 v226, v226, v53
    v_mul_f32 v227, v227, v53
    v_accvgpr_write_b32 a84, v224
    v_accvgpr_write_b32 a85, v225
    v_accvgpr_write_b32 a86, v226
    v_accvgpr_write_b32 a87, v227
    v_accvgpr_read_b32 v224, a88
    v_accvgpr_read_b32 v225, a89
    v_accvgpr_read_b32 v226, a90
    v_accvgpr_read_b32 v227, a91
    v_mul_f32 v224, v224, v54
    v_mul_f32 v225, v225, v54
    v_mul_f32 v226, v226, v54
    v_mul_f32 v227, v227, v54
    v_accvgpr_write_b32 a88, v224
    v_accvgpr_write_b32 a89, v225
    v_accvgpr_write_b32 a90, v226
    v_accvgpr_write_b32 a91, v227
    v_accvgpr_read_b32 v224, a92
    v_accvgpr_read_b32 v225, a93
    v_accvgpr_read_b32 v226, a94
    v_accvgpr_read_b32 v227, a95
    v_mul_f32 v224, v224, v55
    v_mul_f32 v225, v225, v55
    v_mul_f32 v226, v226, v55
    v_mul_f32 v227, v227, v55
    v_accvgpr_write_b32 a92, v224
    v_accvgpr_write_b32 a93, v225
    v_accvgpr_write_b32 a94, v226
    v_accvgpr_write_b32 a95, v227
    v_accvgpr_read_b32 v224, a100
    v_accvgpr_read_b32 v225, a101
    v_accvgpr_read_b32 v226, a102
    v_accvgpr_read_b32 v227, a103
    v_mul_f32 v224, v224, v53
    v_mul_f32 v225, v225, v53
    v_mul_f32 v226, v226, v53
    v_mul_f32 v227, v227, v53
    v_accvgpr_write_b32 a100, v224
    v_accvgpr_write_b32 a101, v225
    v_accvgpr_write_b32 a102, v226
    v_accvgpr_write_b32 a103, v227
    v_accvgpr_read_b32 v224, a104
    v_accvgpr_read_b32 v225, a105
    v_accvgpr_read_b32 v226, a106
    v_accvgpr_read_b32 v227, a107
    v_mul_f32 v224, v224, v54
    v_mul_f32 v225, v225, v54
    v_mul_f32 v226, v226, v54
    v_mul_f32 v227, v227, v54
    v_accvgpr_write_b32 a104, v224
    v_accvgpr_write_b32 a105, v225
    v_accvgpr_write_b32 a106, v226
    v_accvgpr_write_b32 a107, v227
    v_accvgpr_read_b32 v224, a108
    v_accvgpr_read_b32 v225, a109
    v_accvgpr_read_b32 v226, a110
    v_accvgpr_read_b32 v227, a111
    v_mul_f32 v224, v224, v55
    v_mul_f32 v225, v225, v55
    v_mul_f32 v226, v226, v55
    v_mul_f32 v227, v227, v55
    v_accvgpr_write_b32 a108, v224
    v_accvgpr_write_b32 a109, v225
    v_accvgpr_write_b32 a110, v226
    v_accvgpr_write_b32 a111, v227
    v_accvgpr_read_b32 v224, a116
    v_accvgpr_read_b32 v225, a117
    v_accvgpr_read_b32 v226, a118
    v_accvgpr_read_b32 v227, a119
    v_mul_f32 v224, v224, v53
    v_mul_f32 v225, v225, v53
    v_mul_f32 v226, v226, v53
    v_mul_f32 v227, v227, v53
    v_accvgpr_write_b32 a116, v224
    v_accvgpr_write_b32 a117, v225
    v_accvgpr_write_b32 a118, v226
    v_accvgpr_write_b32 a119, v227
    v_accvgpr_read_b32 v224, a120
    v_accvgpr_read_b32 v225, a121
    v_accvgpr_read_b32 v226, a122
    v_accvgpr_read_b32 v227, a123
    v_mul_f32 v224, v224, v54
    v_mul_f32 v225, v225, v54
    v_mul_f32 v226, v226, v54
    v_mul_f32 v227, v227, v54
    v_accvgpr_write_b32 a120, v224
    v_accvgpr_write_b32 a121, v225
    v_accvgpr_write_b32 a122, v226
    v_accvgpr_write_b32 a123, v227
    v_accvgpr_read_b32 v224, a124
    v_accvgpr_read_b32 v225, a125
    v_accvgpr_read_b32 v226, a126
    v_accvgpr_read_b32 v227, a127
    v_mul_f32 v224, v224, v55
    v_mul_f32 v225, v225, v55
    v_mul_f32 v226, v226, v55
    v_mul_f32 v227, v227, v55
    v_accvgpr_write_b32 a124, v224
    v_accvgpr_write_b32 a125, v225
    v_accvgpr_write_b32 a126, v226
    v_accvgpr_write_b32 a127, v227
    v_exp_f32 v232, v164
    v_exp_f32 v233, v165
    v_exp_f32 v234, v166
    v_exp_f32 v235, v167
    s_nop 0
    v_cvt_pk_bf16_f32 v212, v232, v233
    v_cvt_pk_bf16_f32 v213, v234, v235
    v_exp_f32 v232, v180
    v_exp_f32 v233, v181
    v_exp_f32 v234, v182
    v_exp_f32 v235, v183
    s_nop 0
    v_cvt_pk_bf16_f32 v214, v232, v233
    v_cvt_pk_bf16_f32 v215, v234, v235
    v_exp_f32 v232, v168
    v_exp_f32 v233, v169
    v_exp_f32 v234, v170
    v_exp_f32 v235, v171
    s_nop 0
    v_cvt_pk_bf16_f32 v216, v232, v233
    v_cvt_pk_bf16_f32 v217, v234, v235
    v_exp_f32 v232, v184
    v_exp_f32 v233, v185
    v_exp_f32 v234, v186
    v_exp_f32 v235, v187
    s_nop 0
    v_cvt_pk_bf16_f32 v218, v232, v233
    v_cvt_pk_bf16_f32 v219, v234, v235
    v_exp_f32 v232, v172
    v_exp_f32 v233, v173
    v_exp_f32 v234, v174
    v_exp_f32 v235, v175
    s_nop 0
    v_cvt_pk_bf16_f32 v220, v232, v233
    v_cvt_pk_bf16_f32 v221, v234, v235
    v_exp_f32 v232, v188
    v_exp_f32 v233, v189
    v_exp_f32 v234, v190
    v_exp_f32 v235, v191
    s_nop 0
    v_cvt_pk_bf16_f32 v222, v232, v233
    v_cvt_pk_bf16_f32 v223, v234, v235
    s_nop 3
    s_setpc_b64 s[40:41]
k2_rare_166:
    s_nop 7
    v_max_f32 v54, v128, v129
    v_max3_f32 v54, v54, v130, v131
    v_max3_f32 v54, v54, v144, v145
    v_max3_f32 v54, v54, v146, v147
    v_max3_f32 v54, v54, v136, v137
    v_max3_f32 v54, v54, v138, v139
    v_max3_f32 v54, v54, v152, v153
    v_max3_f32 v54, v54, v154, v155
    v_max_f32 v55, v132, v133
    v_max3_f32 v55, v55, v134, v135
    v_max3_f32 v55, v55, v148, v149
    v_max3_f32 v55, v55, v150, v151
    v_max3_f32 v55, v55, v140, v141
    v_max3_f32 v55, v55, v142, v143
    v_max3_f32 v55, v55, v156, v157
    v_max3_f32 v55, v55, v158, v159
    v_mov_b32 v226, v54
    v_mov_b32 v227, v55
    s_nop 1
    v_permlane16_swap_b32 v54, v226
    v_permlane16_swap_b32 v55, v227
    s_nop 1
    v_max_f32 v54, v54, v226
    v_max_f32 v55, v55, v227
    v_mov_b32 v226, v54
    v_mov_b32 v227, v55
    s_nop 1
    v_permlane32_swap_b32 v54, v226
    v_permlane32_swap_b32 v55, v227
    s_nop 1
    v_max_f32 v54, v54, v226
    v_max_f32 v55, v55, v227
    v_add_f32 v54, 0x41400000, v54
    v_max_f32 v54, 0, v54
    v_add_f32 v55, 0x41400000, v55
    v_max_f32 v55, 0, v55
    v_sub_f32 v128, v128, v54
    v_sub_f32 v129, v129, v54
    v_sub_f32 v130, v130, v54
    v_sub_f32 v131, v131, v54
    v_sub_f32 v132, v132, v55
    v_sub_f32 v133, v133, v55
    v_sub_f32 v134, v134, v55
    v_sub_f32 v135, v135, v55
    v_sub_f32 v136, v136, v54
    v_sub_f32 v137, v137, v54
    v_sub_f32 v138, v138, v54
    v_sub_f32 v139, v139, v54
    v_sub_f32 v140, v140, v55
    v_sub_f32 v141, v141, v55
    v_sub_f32 v142, v142, v55
    v_sub_f32 v143, v143, v55
    v_sub_f32 v144, v144, v54
    v_sub_f32 v145, v145, v54
    v_sub_f32 v146, v146, v54
    v_sub_f32 v147, v147, v54
    v_sub_f32 v148, v148, v55
    v_sub_f32 v149, v149, v55
    v_sub_f32 v150, v150, v55
    v_sub_f32 v151, v151, v55
    v_sub_f32 v152, v152, v54
    v_sub_f32 v153, v153, v54
    v_sub_f32 v154, v154, v54
    v_sub_f32 v155, v155, v54
    v_sub_f32 v156, v156, v55
    v_sub_f32 v157, v157, v55
    v_sub_f32 v158, v158, v55
    v_sub_f32 v159, v159, v55
    v_sub_f32 v160, v160, v54
    v_sub_f32 v16, v16, v54
    v_sub_f32 v161, v161, v54
    v_sub_f32 v17, v17, v54
    v_sub_f32 v162, v162, v54
    v_sub_f32 v18, v18, v54
    v_sub_f32 v163, v163, v54
    v_sub_f32 v19, v19, v54
    v_sub_f32 v164, v164, v55
    v_sub_f32 v20, v20, v55
    v_sub_f32 v165, v165, v55
    v_sub_f32 v21, v21, v55
    v_sub_f32 v166, v166, v55
    v_sub_f32 v22, v22, v55
    v_sub_f32 v167, v167, v55
    v_sub_f32 v23, v23, v55
    v_sub_f32 v168, v168, v54
    v_sub_f32 v24, v24, v54
    v_sub_f32 v169, v169, v54
    v_sub_f32 v25, v25, v54
    v_sub_f32 v170, v170, v54
    v_sub_f32 v26, v26, v54
    v_sub_f32 v171, v171, v54
    v_sub_f32 v27, v27, v54
    v_sub_f32 v172, v172, v55
    v_sub_f32 v28, v28, v55
    v_sub_f32 v173, v173, v55
    v_sub_f32 v29, v29, v55
    v_sub_f32 v174, v174, v55
    v_sub_f32 v30, v30, v55
    v_sub_f32 v175, v175, v55
    v_sub_f32 v31, v31, v55
    v_sub_f32 v176, v176, v54
    v_sub_f32 v32, v32, v54
    v_sub_f32 v177, v177, v54
    v_sub_f32 v33, v33, v54
    v_sub_f32 v178, v178, v54
    v_sub_f32 v34, v34, v54
    v_sub_f32 v179, v179, v54
    v_sub_f32 v35, v35, v54
    v_sub_f32 v180, v180, v55
    v_sub_f32 v36, v36, v55
    v_sub_f32 v181, v181, v55
    v_sub_f32 v37, v37, v55
    v_sub_f32 v182, v182, v55
    v_sub_f32 v38, v38, v55
    v_sub_f32 v183, v183, v55
    v_sub_f32 v39, v39, v55
    v_sub_f32 v184, v184, v54
    v_sub_f32 v40, v40, v54
    v_sub_f32 v185, v185, v54
    v_sub_f32 v41, v41, v54
    v_sub_f32 v186, v186, v54
    v_sub_f32 v42, v42, v54
    v_sub_f32 v187, v187, v54
    v_sub_f32 v43, v43, v54
    v_sub_f32 v188, v188, v55
    v_sub_f32 v44, v44, v55
    v_sub_f32 v189, v189, v55
    v_sub_f32 v45, v45, v55
    v_sub_f32 v190, v190, v55
    v_sub_f32 v46, v46, v55
    v_sub_f32 v191, v191, v55
    v_sub_f32 v47, v47, v55
    v_sub_f32 v10, v10, v54
    v_exp_f32 v54, -v54
    v_sub_f32 v11, v11, v55
    v_exp_f32 v55, -v55
    s_nop 0
    v_mul_f32 v248, v248, v54
    v_mul_f32 v252, v252, v55
    v_accvgpr_read_b32 v224, a8
    v_accvgpr_read_b32 v225, a9
    v_accvgpr_read_b32 v226, a10
    v_accvgpr_read_b32 v227, a11
    v_mul_f32 v224, v224, v54
    v_mul_f32 v225, v225, v54
    v_mul_f32 v226, v226, v54
    v_mul_f32 v227, v227, v54
    v_accvgpr_write_b32 a8, v224
    v_accvgpr_write_b32 a9, v225
    v_accvgpr_write_b32 a10, v226
    v_accvgpr_write_b32 a11, v227
    v_accvgpr_read_b32 v224, a12
    v_accvgpr_read_b32 v225, a13
    v_accvgpr_read_b32 v226, a14
    v_accvgpr_read_b32 v227, a15
    v_mul_f32 v224, v224, v55
    v_mul_f32 v225, v225, v55
    v_mul_f32 v226, v226, v55
    v_mul_f32 v227, v227, v55
    v_accvgpr_write_b32 a12, v224
    v_accvgpr_write_b32 a13, v225
    v_accvgpr_write_b32 a14, v226
    v_accvgpr_write_b32 a15, v227
    v_accvgpr_read_b32 v224, a24
    v_accvgpr_read_b32 v225, a25
    v_accvgpr_read_b32 v226, a26
    v_accvgpr_read_b32 v227, a27
    v_mul_f32 v224, v224, v54
    v_mul_f32 v225, v225, v54
    v_mul_f32 v226, v226, v54
    v_mul_f32 v227, v227, v54
    v_accvgpr_write_b32 a24, v224
    v_accvgpr_write_b32 a25, v225
    v_accvgpr_write_b32 a26, v226
    v_accvgpr_write_b32 a27, v227
    v_accvgpr_read_b32 v224, a28
    v_accvgpr_read_b32 v225, a29
    v_accvgpr_read_b32 v226, a30
    v_accvgpr_read_b32 v227, a31
    v_mul_f32 v224, v224, v55
    v_mul_f32 v225, v225, v55
    v_mul_f32 v226, v226, v55
    v_mul_f32 v227, v227, v55
    v_accvgpr_write_b32 a28, v224
    v_accvgpr_write_b32 a29, v225
    v_accvgpr_write_b32 a30, v226
    v_accvgpr_write_b32 a31, v227
    v_accvgpr_read_b32 v224, a40
    v_accvgpr_read_b32 v225, a41
    v_accvgpr_read_b32 v226, a42
    v_accvgpr_read_b32 v227, a43
    v_mul_f32 v224, v224, v54
    v_mul_f32 v225, v225, v54
    v_mul_f32 v226, v226, v54
    v_mul_f32 v227, v227, v54
    v_accvgpr_write_b32 a40, v224
    v_accvgpr_write_b32 a41, v225
    v_accvgpr_write_b32 a42, v226
    v_accvgpr_write_b32 a43, v227
    v_accvgpr_read_b32 v224, a44
    v_accvgpr_read_b32 v225, a45
    v_accvgpr_read_b32 v226, a46
    v_accvgpr_read_b32 v227, a47
    v_mul_f32 v224, v224, v55
    v_mul_f32 v225, v225, v55
    v_mul_f32 v226, v226, v55
    v_mul_f32 v227, v227, v55
    v_accvgpr_write_b32 a44, v224
    v_accvgpr_write_b32 a45, v225
    v_accvgpr_write_b32 a46, v226
    v_accvgpr_write_b32 a47, v227
    v_accvgpr_read_b32 v224, a56
    v_accvgpr_read_b32 v225, a57
    v_accvgpr_read_b32 v226, a58
    v_accvgpr_read_b32 v227, a59
    v_mul_f32 v224, v224, v54
    v_mul_f32 v225, v225, v54
    v_mul_f32 v226, v226, v54
    v_mul_f32 v227, v227, v54
    v_accvgpr_write_b32 a56, v224
    v_accvgpr_write_b32 a57, v225
    v_accvgpr_write_b32 a58, v226
    v_accvgpr_write_b32 a59, v227
    v_accvgpr_read_b32 v224, a60
    v_accvgpr_read_b32 v225, a61
    v_accvgpr_read_b32 v226, a62
    v_accvgpr_read_b32 v227, a63
    v_mul_f32 v224, v224, v55
    v_mul_f32 v225, v225, v55
    v_mul_f32 v226, v226, v55
    v_mul_f32 v227, v227, v55
    v_accvgpr_write_b32 a60, v224
    v_accvgpr_write_b32 a61, v225
    v_accvgpr_write_b32 a62, v226
    v_accvgpr_write_b32 a63, v227
    v_accvgpr_read_b32 v224, a72
    v_accvgpr_read_b32 v225, a73
    v_accvgpr_read_b32 v226, a74
    v_accvgpr_read_b32 v227, a75
    v_mul_f32 v224, v224, v54
    v_mul_f32 v225, v225, v54
    v_mul_f32 v226, v226, v54
    v_mul_f32 v227, v227, v54
    v_accvgpr_write_b32 a72, v224
    v_accvgpr_write_b32 a73, v225
    v_accvgpr_write_b32 a74, v226
    v_accvgpr_write_b32 a75, v227
    v_accvgpr_read_b32 v224, a76
    v_accvgpr_read_b32 v225, a77
    v_accvgpr_read_b32 v226, a78
    v_accvgpr_read_b32 v227, a79
    v_mul_f32 v224, v224, v55
    v_mul_f32 v225, v225, v55
    v_mul_f32 v226, v226, v55
    v_mul_f32 v227, v227, v55
    v_accvgpr_write_b32 a76, v224
    v_accvgpr_write_b32 a77, v225
    v_accvgpr_write_b32 a78, v226
    v_accvgpr_write_b32 a79, v227
    v_accvgpr_read_b32 v224, a88
    v_accvgpr_read_b32 v225, a89
    v_accvgpr_read_b32 v226, a90
    v_accvgpr_read_b32 v227, a91
    v_mul_f32 v224, v224, v54
    v_mul_f32 v225, v225, v54
    v_mul_f32 v226, v226, v54
    v_mul_f32 v227, v227, v54
    v_accvgpr_write_b32 a88, v224
    v_accvgpr_write_b32 a89, v225
    v_accvgpr_write_b32 a90, v226
    v_accvgpr_write_b32 a91, v227
    v_accvgpr_read_b32 v224, a92
    v_accvgpr_read_b32 v225, a93
    v_accvgpr_read_b32 v226, a94
    v_accvgpr_read_b32 v227, a95
    v_mul_f32 v224, v224, v55
    v_mul_f32 v225, v225, v55
    v_mul_f32 v226, v226, v55
    v_mul_f32 v227, v227, v55
    v_accvgpr_write_b32 a92, v224
    v_accvgpr_write_b32 a93, v225
    v_accvgpr_write_b32 a94, v226
    v_accvgpr_write_b32 a95, v227
    v_accvgpr_read_b32 v224, a104
    v_accvgpr_read_b32 v225, a105
    v_accvgpr_read_b32 v226, a106
    v_accvgpr_read_b32 v227, a107
    v_mul_f32 v224, v224, v54
    v_mul_f32 v225, v225, v54
    v_mul_f32 v226, v226, v54
    v_mul_f32 v227, v227, v54
    v_accvgpr_write_b32 a104, v224
    v_accvgpr_write_b32 a105, v225
    v_accvgpr_write_b32 a106, v226
    v_accvgpr_write_b32 a107, v227
    v_accvgpr_read_b32 v224, a108
    v_accvgpr_read_b32 v225, a109
    v_accvgpr_read_b32 v226, a110
    v_accvgpr_read_b32 v227, a111
    v_mul_f32 v224, v224, v55
    v_mul_f32 v225, v225, v55
    v_mul_f32 v226, v226, v55
    v_mul_f32 v227, v227, v55
    v_accvgpr_write_b32 a108, v224
    v_accvgpr_write_b32 a109, v225
    v_accvgpr_write_b32 a110, v226
    v_accvgpr_write_b32 a111, v227
    v_accvgpr_read_b32 v224, a120
    v_accvgpr_read_b32 v225, a121
    v_accvgpr_read_b32 v226, a122
    v_accvgpr_read_b32 v227, a123
    v_mul_f32 v224, v224, v54
    v_mul_f32 v225, v225, v54
    v_mul_f32 v226, v226, v54
    v_mul_f32 v227, v227, v54
    v_accvgpr_write_b32 a120, v224
    v_accvgpr_write_b32 a121, v225
    v_accvgpr_write_b32 a122, v226
    v_accvgpr_write_b32 a123, v227
    v_accvgpr_read_b32 v224, a124
    v_accvgpr_read_b32 v225, a125
    v_accvgpr_read_b32 v226, a126
    v_accvgpr_read_b32 v227, a127
    v_mul_f32 v224, v224, v55
    v_mul_f32 v225, v225, v55
    v_mul_f32 v226, v226, v55
    v_mul_f32 v227, v227, v55
    v_accvgpr_write_b32 a124, v224
    v_accvgpr_write_b32 a125, v225
    v_accvgpr_write_b32 a126, v226
    v_accvgpr_write_b32 a127, v227
    v_exp_f32 v232, v128
    v_exp_f32 v233, v129
    v_exp_f32 v234, v130
    v_exp_f32 v235, v131
    s_nop 0
    v_cvt_pk_bf16_f32 v192, v232, v233
    v_cvt_pk_bf16_f32 v193, v234, v235
    v_exp_f32 v232, v144
    v_exp_f32 v233, v145
    v_exp_f32 v234, v146
    v_exp_f32 v235, v147
    s_nop 0
    v_cvt_pk_bf16_f32 v194, v232, v233
    v_cvt_pk_bf16_f32 v195, v234, v235
    v_exp_f32 v232, v132
    v_exp_f32 v233, v133
    v_exp_f32 v234, v134
    v_exp_f32 v235, v135
    s_nop 0
    v_cvt_pk_bf16_f32 v196, v232, v233
    v_cvt_pk_bf16_f32 v197, v234, v235
    v_exp_f32 v232, v148
    v_exp_f32 v233, v149
    v_exp_f32 v234, v150
    v_exp_f32 v235, v151
    s_nop 0
    v_cvt_pk_bf16_f32 v198, v232, v233
    v_cvt_pk_bf16_f32 v199, v234, v235
    v_exp_f32 v232, v136
    v_exp_f32 v233, v137
    v_exp_f32 v234, v138
    v_exp_f32 v235, v139
    s_nop 0
    v_cvt_pk_bf16_f32 v200, v232, v233
    v_cvt_pk_bf16_f32 v201, v234, v235
    v_exp_f32 v232, v152
    v_exp_f32 v233, v153
    v_exp_f32 v234, v154
    v_exp_f32 v235, v155
    s_nop 0
    v_cvt_pk_bf16_f32 v202, v232, v233
    v_cvt_pk_bf16_f32 v203, v234, v235
    v_exp_f32 v232, v140
    v_exp_f32 v233, v141
    v_exp_f32 v234, v142
    v_exp_f32 v235, v143
    s_nop 0
    v_cvt_pk_bf16_f32 v204, v232, v233
    v_cvt_pk_bf16_f32 v205, v234, v235
    v_exp_f32 v232, v156
    v_exp_f32 v233, v157
    v_exp_f32 v234, v158
    v_exp_f32 v235, v159
    s_nop 0
    v_cvt_pk_bf16_f32 v206, v232, v233
    v_cvt_pk_bf16_f32 v207, v234, v235
    s_nop 3
    s_setpc_b64 s[40:41]
k2_rare_167:
    s_nop 7
    v_max_f32 v54, v160, v161
    v_max3_f32 v54, v54, v162, v163
    v_max3_f32 v54, v54, v176, v177
    v_max3_f32 v54, v54, v178, v179
    v_max3_f32 v54, v54, v168, v169
    v_max3_f32 v54, v54, v170, v171
    v_max3_f32 v54, v54, v184, v185
    v_max3_f32 v54, v54, v186, v187
    v_max_f32 v55, v164, v165
    v_max3_f32 v55, v55, v166, v167
    v_max3_f32 v55, v55, v180, v181
    v_max3_f32 v55, v55, v182, v183
    v_max3_f32 v55, v55, v172, v173
    v_max3_f32 v55, v55, v174, v175
    v_max3_f32 v55, v55, v188, v189
    v_max3_f32 v55, v55, v190, v191
    v_mov_b32 v226, v54
    v_mov_b32 v227, v55
    s_nop 1
    v_permlane16_swap_b32 v54, v226
    v_permlane16_swap_b32 v55, v227
    s_nop 1
    v_max_f32 v54, v54, v226
    v_max_f32 v55, v55, v227
    v_mov_b32 v226, v54
    v_mov_b32 v227, v55
    s_nop 1
    v_permlane32_swap_b32 v54, v226
    v_permlane32_swap_b32 v55, v227
    s_nop 1
    v_max_f32 v54, v54, v226
    v_max_f32 v55, v55, v227
    v_add_f32 v54, 0x41400000, v54
    v_max_f32 v54, 0, v54
    v_add_f32 v55, 0x41400000, v55
    v_max_f32 v55, 0, v55
    v_sub_f32 v160, v160, v54
    v_sub_f32 v161, v161, v54
    v_sub_f32 v162, v162, v54
    v_sub_f32 v163, v163, v54
    v_sub_f32 v164, v164, v55
    v_sub_f32 v165, v165, v55
    v_sub_f32 v166, v166, v55
    v_sub_f32 v167, v167, v55
    v_sub_f32 v168, v168, v54
    v_sub_f32 v169, v169, v54
    v_sub_f32 v170, v170, v54
    v_sub_f32 v171, v171, v54
    v_sub_f32 v172, v172, v55
    v_sub_f32 v173, v173, v55
    v_sub_f32 v174, v174, v55
    v_sub_f32 v175, v175, v55
    v_sub_f32 v176, v176, v54
    v_sub_f32 v177, v177, v54
    v_sub_f32 v178, v178, v54
    v_sub_f32 v179, v179, v54
    v_sub_f32 v180, v180, v55
    v_sub_f32 v181, v181, v55
    v_sub_f32 v182, v182, v55
    v_sub_f32 v183, v183, v55
    v_sub_f32 v184, v184, v54
    v_sub_f32 v185, v185, v54
    v_sub_f32 v186, v186, v54
    v_sub_f32 v187, v187, v54
    v_sub_f32 v188, v188, v55
    v_sub_f32 v189, v189, v55
    v_sub_f32 v190, v190, v55
    v_sub_f32 v191, v191, v55
    v_sub_f32 v128, v128, v54
    v_sub_f32 v16, v16, v54
    v_sub_f32 v129, v129, v54
    v_sub_f32 v17, v17, v54
    v_sub_f32 v130, v130, v54
    v_sub_f32 v18, v18, v54
    v_sub_f32 v131, v131, v54
    v_sub_f32 v19, v19, v54
    v_sub_f32 v132, v132, v55
    v_sub_f32 v20, v20, v55
    v_sub_f32 v133, v133, v55
    v_sub_f32 v21, v21, v55
    v_sub_f32 v134, v134, v55
    v_sub_f32 v22, v22, v55
    v_sub_f32 v135, v135, v55
    v_sub_f32 v23, v23, v55
    v_sub_f32 v136, v136, v54
    v_sub_f32 v24, v24, v54
    v_sub_f32 v137, v137, v54
    v_sub_f32 v25, v25, v54
    v_sub_f32 v138, v138, v54
    v_sub_f32 v26, v26, v54
    v_sub_f32 v139, v139, v54
    v_sub_f32 v27, v27, v54
    v_sub_f32 v140, v140, v55
    v_sub_f32 v28, v28, v55
    v_sub_f32 v141, v141, v55
    v_sub_f32 v29, v29, v55
    v_sub_f32 v142, v142, v55
    v_sub_f32 v30, v30, v55
    v_sub_f32 v143, v143, v55
    v_sub_f32 v31, v31, v55
    v_sub_f32 v144, v144, v54
    v_sub_f32 v32, v32, v54
    v_sub_f32 v145, v145, v54
    v_sub_f32 v33, v33, v54
    v_sub_f32 v146, v146, v54
    v_sub_f32 v34, v34, v54
    v_sub_f32 v147, v147, v54
    v_sub_f32 v35, v35, v54
    v_sub_f32 v148, v148, v55
    v_sub_f32 v36, v36, v55
    v_sub_f32 v149, v149, v55
    v_sub_f32 v37, v37, v55
    v_sub_f32 v150, v150, v55
    v_sub_f32 v38, v38, v55
    v_sub_f32 v151, v151, v55
    v_sub_f32 v39, v39, v55
    v_sub_f32 v152, v152, v54
    v_sub_f32 v40, v40, v54
    v_sub_f32 v153, v153, v54
    v_sub_f32 v41, v41, v54
    v_sub_f32 v154, v154, v54
    v_sub_f32 v42, v42, v54
    v_sub_f32 v155, v155, v54
    v_sub_f32 v43, v43, v54
    v_sub_f32 v156, v156, v55
    v_sub_f32 v44, v44, v55
    v_sub_f32 v157, v157, v55
    v_sub_f32 v45, v45, v55
    v_sub_f32 v158, v158, v55
    v_sub_f32 v46, v46, v55
    v_sub_f32 v159, v159, v55
    v_sub_f32 v47, v47, v55
    v_sub_f32 v10, v10, v54
    v_exp_f32 v54, -v54
    v_sub_f32 v11, v11, v55
    v_exp_f32 v55, -v55
    s_nop 0
    v_mul_f32 v248, v248, v54
    v_mul_f32 v252, v252, v55
    v_accvgpr_read_b32 v224, a8
    v_accvgpr_read_b32 v225, a9
    v_accvgpr_read_b32 v226, a10
    v_accvgpr_read_b32 v227, a11
    v_mul_f32 v224, v224, v54
    v_mul_f32 v225, v225, v54
    v_mul_f32 v226, v226, v54
    v_mul_f32 v227, v227, v54
    v_accvgpr_write_b32 a8, v224
    v_accvgpr_write_b32 a9, v225
    v_accvgpr_write_b32 a10, v226
    v_accvgpr_write_b32 a11, v227
    v_accvgpr_read_b32 v224, a12
    v_accvgpr_read_b32 v225, a13
    v_accvgpr_read_b32 v226, a14
    v_accvgpr_read_b32 v227, a15
    v_mul_f32 v224, v224, v55
    v_mul_f32 v225, v225, v55
    v_mul_f32 v226, v226, v55
    v_mul_f32 v227, v227, v55
    v_accvgpr_write_b32 a12, v224
    v_accvgpr_write_b32 a13, v225
    v_accvgpr_write_b32 a14, v226
    v_accvgpr_write_b32 a15, v227
    v_accvgpr_read_b32 v224, a24
    v_accvgpr_read_b32 v225, a25
    v_accvgpr_read_b32 v226, a26
    v_accvgpr_read_b32 v227, a27
    v_mul_f32 v224, v224, v54
    v_mul_f32 v225, v225, v54
    v_mul_f32 v226, v226, v54
    v_mul_f32 v227, v227, v54
    v_accvgpr_write_b32 a24, v224
    v_accvgpr_write_b32 a25, v225
    v_accvgpr_write_b32 a26, v226
    v_accvgpr_write_b32 a27, v227
    v_accvgpr_read_b32 v224, a28
    v_accvgpr_read_b32 v225, a29
    v_accvgpr_read_b32 v226, a30
    v_accvgpr_read_b32 v227, a31
    v_mul_f32 v224, v224, v55
    v_mul_f32 v225, v225, v55
    v_mul_f32 v226, v226, v55
    v_mul_f32 v227, v227, v55
    v_accvgpr_write_b32 a28, v224
    v_accvgpr_write_b32 a29, v225
    v_accvgpr_write_b32 a30, v226
    v_accvgpr_write_b32 a31, v227
    v_accvgpr_read_b32 v224, a40
    v_accvgpr_read_b32 v225, a41
    v_accvgpr_read_b32 v226, a42
    v_accvgpr_read_b32 v227, a43
    v_mul_f32 v224, v224, v54
    v_mul_f32 v225, v225, v54
    v_mul_f32 v226, v226, v54
    v_mul_f32 v227, v227, v54
    v_accvgpr_write_b32 a40, v224
    v_accvgpr_write_b32 a41, v225
    v_accvgpr_write_b32 a42, v226
    v_accvgpr_write_b32 a43, v227
    v_accvgpr_read_b32 v224, a44
    v_accvgpr_read_b32 v225, a45
    v_accvgpr_read_b32 v226, a46
    v_accvgpr_read_b32 v227, a47
    v_mul_f32 v224, v224, v55
    v_mul_f32 v225, v225, v55
    v_mul_f32 v226, v226, v55
    v_mul_f32 v227, v227, v55
    v_accvgpr_write_b32 a44, v224
    v_accvgpr_write_b32 a45, v225
    v_accvgpr_write_b32 a46, v226
    v_accvgpr_write_b32 a47, v227
    v_accvgpr_read_b32 v224, a56
    v_accvgpr_read_b32 v225, a57
    v_accvgpr_read_b32 v226, a58
    v_accvgpr_read_b32 v227, a59
    v_mul_f32 v224, v224, v54
    v_mul_f32 v225, v225, v54
    v_mul_f32 v226, v226, v54
    v_mul_f32 v227, v227, v54
    v_accvgpr_write_b32 a56, v224
    v_accvgpr_write_b32 a57, v225
    v_accvgpr_write_b32 a58, v226
    v_accvgpr_write_b32 a59, v227
    v_accvgpr_read_b32 v224, a60
    v_accvgpr_read_b32 v225, a61
    v_accvgpr_read_b32 v226, a62
    v_accvgpr_read_b32 v227, a63
    v_mul_f32 v224, v224, v55
    v_mul_f32 v225, v225, v55
    v_mul_f32 v226, v226, v55
    v_mul_f32 v227, v227, v55
    v_accvgpr_write_b32 a60, v224
    v_accvgpr_write_b32 a61, v225
    v_accvgpr_write_b32 a62, v226
    v_accvgpr_write_b32 a63, v227
    v_accvgpr_read_b32 v224, a72
    v_accvgpr_read_b32 v225, a73
    v_accvgpr_read_b32 v226, a74
    v_accvgpr_read_b32 v227, a75
    v_mul_f32 v224, v224, v54
    v_mul_f32 v225, v225, v54
    v_mul_f32 v226, v226, v54
    v_mul_f32 v227, v227, v54
    v_accvgpr_write_b32 a72, v224
    v_accvgpr_write_b32 a73, v225
    v_accvgpr_write_b32 a74, v226
    v_accvgpr_write_b32 a75, v227
    v_accvgpr_read_b32 v224, a76
    v_accvgpr_read_b32 v225, a77
    v_accvgpr_read_b32 v226, a78
    v_accvgpr_read_b32 v227, a79
    v_mul_f32 v224, v224, v55
    v_mul_f32 v225, v225, v55
    v_mul_f32 v226, v226, v55
    v_mul_f32 v227, v227, v55
    v_accvgpr_write_b32 a76, v224
    v_accvgpr_write_b32 a77, v225
    v_accvgpr_write_b32 a78, v226
    v_accvgpr_write_b32 a79, v227
    v_accvgpr_read_b32 v224, a88
    v_accvgpr_read_b32 v225, a89
    v_accvgpr_read_b32 v226, a90
    v_accvgpr_read_b32 v227, a91
    v_mul_f32 v224, v224, v54
    v_mul_f32 v225, v225, v54
    v_mul_f32 v226, v226, v54
    v_mul_f32 v227, v227, v54
    v_accvgpr_write_b32 a88, v224
    v_accvgpr_write_b32 a89, v225
    v_accvgpr_write_b32 a90, v226
    v_accvgpr_write_b32 a91, v227
    v_accvgpr_read_b32 v224, a92
    v_accvgpr_read_b32 v225, a93
    v_accvgpr_read_b32 v226, a94
    v_accvgpr_read_b32 v227, a95
    v_mul_f32 v224, v224, v55
    v_mul_f32 v225, v225, v55
    v_mul_f32 v226, v226, v55
    v_mul_f32 v227, v227, v55
    v_accvgpr_write_b32 a92, v224
    v_accvgpr_write_b32 a93, v225
    v_accvgpr_write_b32 a94, v226
    v_accvgpr_write_b32 a95, v227
    v_accvgpr_read_b32 v224, a104
    v_accvgpr_read_b32 v225, a105
    v_accvgpr_read_b32 v226, a106
    v_accvgpr_read_b32 v227, a107
    v_mul_f32 v224, v224, v54
    v_mul_f32 v225, v225, v54
    v_mul_f32 v226, v226, v54
    v_mul_f32 v227, v227, v54
    v_accvgpr_write_b32 a104, v224
    v_accvgpr_write_b32 a105, v225
    v_accvgpr_write_b32 a106, v226
    v_accvgpr_write_b32 a107, v227
    v_accvgpr_read_b32 v224, a108
    v_accvgpr_read_b32 v225, a109
    v_accvgpr_read_b32 v226, a110
    v_accvgpr_read_b32 v227, a111
    v_mul_f32 v224, v224, v55
    v_mul_f32 v225, v225, v55
    v_mul_f32 v226, v226, v55
    v_mul_f32 v227, v227, v55
    v_accvgpr_write_b32 a108, v224
    v_accvgpr_write_b32 a109, v225
    v_accvgpr_write_b32 a110, v226
    v_accvgpr_write_b32 a111, v227
    v_accvgpr_read_b32 v224, a120
    v_accvgpr_read_b32 v225, a121
    v_accvgpr_read_b32 v226, a122
    v_accvgpr_read_b32 v227, a123
    v_mul_f32 v224, v224, v54
    v_mul_f32 v225, v225, v54
    v_mul_f32 v226, v226, v54
    v_mul_f32 v227, v227, v54
    v_accvgpr_write_b32 a120, v224
    v_accvgpr_write_b32 a121, v225
    v_accvgpr_write_b32 a122, v226
    v_accvgpr_write_b32 a123, v227
    v_accvgpr_read_b32 v224, a124
    v_accvgpr_read_b32 v225, a125
    v_accvgpr_read_b32 v226, a126
    v_accvgpr_read_b32 v227, a127
    v_mul_f32 v224, v224, v55
    v_mul_f32 v225, v225, v55
    v_mul_f32 v226, v226, v55
    v_mul_f32 v227, v227, v55
    v_accvgpr_write_b32 a124, v224
    v_accvgpr_write_b32 a125, v225
    v_accvgpr_write_b32 a126, v226
    v_accvgpr_write_b32 a127, v227
    v_exp_f32 v232, v160
    v_exp_f32 v233, v161
    v_exp_f32 v234, v162
    v_exp_f32 v235, v163
    s_nop 0
    v_cvt_pk_bf16_f32 v208, v232, v233
    v_cvt_pk_bf16_f32 v209, v234, v235
    v_exp_f32 v232, v176
    v_exp_f32 v233, v177
    v_exp_f32 v234, v178
    v_exp_f32 v235, v179
    s_nop 0
    v_cvt_pk_bf16_f32 v210, v232, v233
    v_cvt_pk_bf16_f32 v211, v234, v235
    v_exp_f32 v232, v164
    v_exp_f32 v233, v165
    v_exp_f32 v234, v166
    v_exp_f32 v235, v167
    s_nop 0
    v_cvt_pk_bf16_f32 v212, v232, v233
    v_cvt_pk_bf16_f32 v213, v234, v235
    v_exp_f32 v232, v180
    v_exp_f32 v233, v181
    v_exp_f32 v234, v182
    v_exp_f32 v235, v183
    s_nop 0
    v_cvt_pk_bf16_f32 v214, v232, v233
    v_cvt_pk_bf16_f32 v215, v234, v235
    v_exp_f32 v232, v168
    v_exp_f32 v233, v169
    v_exp_f32 v234, v170
    v_exp_f32 v235, v171
    s_nop 0
    v_cvt_pk_bf16_f32 v216, v232, v233
    v_cvt_pk_bf16_f32 v217, v234, v235
    v_exp_f32 v232, v184
    v_exp_f32 v233, v185
    v_exp_f32 v234, v186
    v_exp_f32 v235, v187
    s_nop 0
    v_cvt_pk_bf16_f32 v218, v232, v233
    v_cvt_pk_bf16_f32 v219, v234, v235
    v_exp_f32 v232, v172
    v_exp_f32 v233, v173
    v_exp_f32 v234, v174
    v_exp_f32 v235, v175
    s_nop 0
    v_cvt_pk_bf16_f32 v220, v232, v233
    v_cvt_pk_bf16_f32 v221, v234, v235
    v_exp_f32 v232, v188
    v_exp_f32 v233, v189
    v_exp_f32 v234, v190
    v_exp_f32 v235, v191
    s_nop 0
    v_cvt_pk_bf16_f32 v222, v232, v233
    v_cvt_pk_bf16_f32 v223, v234, v235
    s_nop 3
    s_setpc_b64 s[40:41]
k2_rare_171:
    s_nop 7
    v_max_f32 v55, v164, v165
    v_max3_f32 v55, v55, v166, v167
    v_max3_f32 v55, v55, v180, v181
    v_max3_f32 v55, v55, v182, v183
    v_max3_f32 v55, v55, v172, v173
    v_max3_f32 v55, v55, v174, v175
    v_max3_f32 v55, v55, v188, v189
    v_max3_f32 v55, v55, v190, v191
    v_mov_b32 v227, v55
    s_nop 1
    v_permlane16_swap_b32 v55, v227
    s_nop 1
    v_max_f32 v55, v55, v227
    v_mov_b32 v227, v55
    s_nop 1
    v_permlane32_swap_b32 v55, v227
    s_nop 1
    v_max_f32 v55, v55, v227
    v_add_f32 v55, 0x41400000, v55
    v_max_f32 v55, 0, v55
    v_sub_f32 v164, v164, v55
    v_sub_f32 v165, v165, v55
    v_sub_f32 v166, v166, v55
    v_sub_f32 v167, v167, v55
    v_sub_f32 v172, v172, v55
    v_sub_f32 v173, v173, v55
    v_sub_f32 v174, v174, v55
    v_sub_f32 v175, v175, v55
    v_sub_f32 v180, v180, v55
    v_sub_f32 v181, v181, v55
    v_sub_f32 v182, v182, v55
    v_sub_f32 v183, v183, v55
    v_sub_f32 v188, v188, v55
    v_sub_f32 v189, v189, v55
    v_sub_f32 v190, v190, v55
    v_sub_f32 v191, v191, v55
    v_sub_f32 v11, v11, v55
    v_exp_f32 v55, -v55
    s_nop 0
    v_mul_f32 v252, v252, v55
    v_accvgpr_read_b32 v224, a12
    v_accvgpr_read_b32 v225, a13
    v_accvgpr_read_b32 v226, a14
    v_accvgpr_read_b32 v227, a15
    v_mul_f32 v224, v224, v55
    v_mul_f32 v225, v225, v55
    v_mul_f32 v226, v226, v55
    v_mul_f32 v227, v227, v55
    v_accvgpr_write_b32 a12, v224
    v_accvgpr_write_b32 a13, v225
    v_accvgpr_write_b32 a14, v226
    v_accvgpr_write_b32 a15, v227
    v_accvgpr_read_b32 v224, a28
    v_accvgpr_read_b32 v225, a29
    v_accvgpr_read_b32 v226, a30
    v_accvgpr_read_b32 v227, a31
    v_mul_f32 v224, v224, v55
    v_mul_f32 v225, v225, v55
    v_mul_f32 v226, v226, v55
    v_mul_f32 v227, v227, v55
    v_accvgpr_write_b32 a28, v224
    v_accvgpr_write_b32 a29, v225
    v_accvgpr_write_b32 a30, v226
    v_accvgpr_write_b32 a31, v227
    v_accvgpr_read_b32 v224, a44
    v_accvgpr_read_b32 v225, a45
    v_accvgpr_read_b32 v226, a46
    v_accvgpr_read_b32 v227, a47
    v_mul_f32 v224, v224, v55
    v_mul_f32 v225, v225, v55
    v_mul_f32 v226, v226, v55
    v_mul_f32 v227, v227, v55
    v_accvgpr_write_b32 a44, v224
    v_accvgpr_write_b32 a45, v225
    v_accvgpr_write_b32 a46, v226
    v_accvgpr_write_b32 a47, v227
    v_accvgpr_read_b32 v224, a60
    v_accvgpr_read_b32 v225, a61
    v_accvgpr_read_b32 v226, a62
    v_accvgpr_read_b32 v227, a63
    v_mul_f32 v224, v224, v55
    v_mul_f32 v225, v225, v55
    v_mul_f32 v226, v226, v55
    v_mul_f32 v227, v227, v55
    v_accvgpr_write_b32 a60, v224
    v_accvgpr_write_b32 a61, v225
    v_accvgpr_write_b32 a62, v226
    v_accvgpr_write_b32 a63, v227
    v_accvgpr_read_b32 v224, a76
    v_accvgpr_read_b32 v225, a77
    v_accvgpr_read_b32 v226, a78
    v_accvgpr_read_b32 v227, a79
    v_mul_f32 v224, v224, v55
    v_mul_f32 v225, v225, v55
    v_mul_f32 v226, v226, v55
    v_mul_f32 v227, v227, v55
    v_accvgpr_write_b32 a76, v224
    v_accvgpr_write_b32 a77, v225
    v_accvgpr_write_b32 a78, v226
    v_accvgpr_write_b32 a79, v227
    v_accvgpr_read_b32 v224, a92
    v_accvgpr_read_b32 v225, a93
    v_accvgpr_read_b32 v226, a94
    v_accvgpr_read_b32 v227, a95
    v_mul_f32 v224, v224, v55
    v_mul_f32 v225, v225, v55
    v_mul_f32 v226, v226, v55
    v_mul_f32 v227, v227, v55
    v_accvgpr_write_b32 a92, v224
    v_accvgpr_write_b32 a93, v225
    v_accvgpr_write_b32 a94, v226
    v_accvgpr_write_b32 a95, v227
    v_accvgpr_read_b32 v224, a108
    v_accvgpr_read_b32 v225, a109
    v_accvgpr_read_b32 v226, a110
    v_accvgpr_read_b32 v227, a111
    v_mul_f32 v224, v224, v55
    v_mul_f32 v225, v225, v55
    v_mul_f32 v226, v226, v55
    v_mul_f32 v227, v227, v55
    v_accvgpr_write_b32 a108, v224
    v_accvgpr_write_b32 a109, v225
    v_accvgpr_write_b32 a110, v226
    v_accvgpr_write_b32 a111, v227
    v_accvgpr_read_b32 v224, a124
    v_accvgpr_read_b32 v225, a125
    v_accvgpr_read_b32 v226, a126
    v_accvgpr_read_b32 v227, a127
    v_mul_f32 v224, v224, v55
    v_mul_f32 v225, v225, v55
    v_mul_f32 v226, v226, v55
    v_mul_f32 v227, v227, v55
    v_accvgpr_write_b32 a124, v224
    v_accvgpr_write_b32 a125, v225
    v_accvgpr_write_b32 a126, v226
    v_accvgpr_write_b32 a127, v227
    v_exp_f32 v232, v164
    v_exp_f32 v233, v165
    v_exp_f32 v234, v166
    v_exp_f32 v235, v167
    s_nop 0
    v_cvt_pk_bf16_f32 v212, v232, v233
    v_cvt_pk_bf16_f32 v213, v234, v235
    v_exp_f32 v232, v180
    v_exp_f32 v233, v181
    v_exp_f32 v234, v182
    v_exp_f32 v235, v183
    s_nop 0
    v_cvt_pk_bf16_f32 v214, v232, v233
    v_cvt_pk_bf16_f32 v215, v234, v235
    v_exp_f32 v232, v172
    v_exp_f32 v233, v173
    v_exp_f32 v234, v174
    v_exp_f32 v235, v175
    s_nop 0
    v_cvt_pk_bf16_f32 v220, v232, v233
    v_cvt_pk_bf16_f32 v221, v234, v235
    v_exp_f32 v232, v188
    v_exp_f32 v233, v189
    v_exp_f32 v234, v190
    v_exp_f32 v235, v191
    s_nop 0
    v_cvt_pk_bf16_f32 v222, v232, v233
    v_cvt_pk_bf16_f32 v223, v234, v235
    s_nop 3
    s_setpc_b64 s[40:41]
code_end:
    s_endpgm
.section .rodata,"a"
.p2align 6
.amdhsa_kernel sequential_preLN__compressed_kv_cla__moe_arch_mod__prompt_kernel
  .amdhsa_next_free_vgpr 512
  .amdhsa_next_free_sgpr 102
  .amdhsa_accum_offset 256
  .amdhsa_group_segment_fixed_size 0
  .amdhsa_kernarg_size 112
  .amdhsa_user_sgpr_count 2
  .amdhsa_user_sgpr_kernarg_segment_ptr 1
  .amdhsa_system_sgpr_workgroup_id_x 1
.end_amdhsa_kernel
```

```asm
; @launch grid=(256,1,1) block=(256,1,1) lds=163840
.amdgcn_target "amdgcn-amd-amdhsa--gfx950"
.text
.globl sequential_preLN__compressed_kv_cla__moe_arch_mod__prompt_kernel
.p2align 8
.type sequential_preLN__compressed_kv_cla__moe_arch_mod__prompt_kernel,@function
sequential_preLN__compressed_kv_cla__moe_arch_mod__prompt_kernel:
    s_cmp_ge_u32 s2, 256
    s_cbranch_scc1 k12_end_1
    s_load_dwordx4 s[36:39], s[0:1], 0
    s_load_dwordx4 s[40:43], s[0:1], 24
    s_load_dwordx2 s[4:5], s[0:1], 16
    s_load_dwordx4 s[60:63], s[0:1], 96
    s_lshr_b32 s59, s2, 3
    s_lshl_b32 s58, s59, 4
    v_add_u32 v6, s58, v0
    v_cmp_gt_u32 vcc, 48, v0
    v_cmp_gt_u32 s[56:57], 64, v0
    s_nop 0
    v_cndmask_b32 v6, v6, v0, vcc
    s_getpc_b64 s[52:53]
pc_2:
    s_add_u32 s52, s52, k12_code0-pc_2
    s_addc_u32 s53, s53, 0
    v_lshlrev_b32 v58, 7, v6
    v_mov_b32 v59, s53
    v_add_co_u32 v58, vcc, s52, v58
    s_nop 1
    v_addc_co_u32 v59, vcc, 0, v59, vcc
k12_code0:
    s_mov_b64 exec, s[56:57]
    s_cbranch_execz k12_nocode_3
    global_load_dword v51, v[58:59], off
k12_nocode_3:
    s_mov_b64 exec, -1
    s_and_b32 s58, s2, 7
    s_lshr_b32 s59, s2, 3
    s_and_b32 s45, s59, 7
    s_lshr_b32 s57, s59, 3
    s_and_b32 s44, s57, 1
    s_lshl_b32 s52, s58, 1
    s_add_u32 s44, s44, s52
    s_lshr_b32 s57, s57, 1
    v_lshrrev_b32 v2, 6, v0
    v_and_b32 v3, 63, v0
    v_readfirstlane_b32 s30, v2
    v_lshlrev_b32 v1, 4, v3
    v_lshrrev_b32 v60, 5, v3
    v_lshl_add_u32 v60, v2, 1, v60
    v_and_b32 v61, 31, v3
    v_lshlrev_b32 v6, 11, v60
    v_lshl_add_u32 v62, v61, 4, v6
    s_lshl_b32 s52, s2, 14
    v_lshrrev_b32 v56, 3, v3
    v_and_b32 v57, 7, v3
    v_lshrrev_b32 v58, 1, v56
    v_xor_b32 v6, v57, v58
    v_xor_b32 v7, 4, v6
    v_lshl_add_u32 v58, v2, 6, v56
    v_lshlrev_b32 v58, 10, v58
    s_lshl_b32 s47, s45, 18
    v_add_u32 v58, s47, v58
    v_lshl_add_u32 v10, v6, 4, v58
    v_lshl_add_u32 v11, v7, 4, v58
    v_add_u32 v17, 54272, v11
    v_add_u32 v16, 47104, v10
    v_add_u32 v15, 39936, v11
    v_add_u32 v14, 32768, v10
    v_add_u32 v13, 21504, v11
    v_add_u32 v12, 14336, v10
    v_add_u32 v11, 7168, v11
    v_add_u32 v10, 0, v10
    v_lshrrev_b32 v6, 5, v3
    v_bfe_u32 v7, v3, 1, 4
    v_and_b32 v59, 1, v3
    v_lshl_add_u32 v58, v2, 4, v6
    v_lshlrev_b32 v58, 13, v58
    v_lshl_add_u32 v58, v59, 4, v58
    s_lshl_b32 s47, s44, 9
    v_add_u32 v58, s47, v58
    v_xor_b32 v7, v7, v6
    v_xor_b32 v6, 0, v7
    v_lshl_add_u32 v6, v6, 5, v58
    v_add_u32 v18, 0, v6
    v_xor_b32 v6, 2, v7
    v_lshl_add_u32 v6, v6, 5, v58
    v_add_u32 v19, 15360, v6
    v_xor_b32 v6, 0, v7
    v_lshl_add_u32 v6, v6, 5, v58
    v_add_u32 v20, 30720, v6
    v_xor_b32 v6, 2, v7
    v_lshl_add_u32 v6, v6, 5, v58
    v_add_u32 v21, 46080, v6
    v_xor_b32 v6, 4, v7
    v_lshl_add_u32 v6, v6, 5, v58
    v_add_u32 v22, 65536, v6
    v_xor_b32 v6, 6, v7
    v_lshl_add_u32 v6, v6, 5, v58
    v_add_u32 v23, 80896, v6
    v_xor_b32 v6, 4, v7
    v_lshl_add_u32 v6, v6, 5, v58
    v_add_u32 v24, 96256, v6
    v_xor_b32 v6, 6, v7
    v_lshl_add_u32 v6, v6, 5, v58
    v_add_u32 v25, 111616, v6
    s_lshl_b32 s48, s30, 13
    s_mov_b32 s49, 0
    s_mov_b32 s50, 0
    s_waitcnt lgkmcnt(0)
    s_mov_b32 s24, s36
    s_and_b32 s25, s37, 0xffff
    s_mov_b32 s26, 0x400000
    s_mov_b32 s27, 0x00020000
    s_mov_b32 s16, s38
    s_and_b32 s17, s39, 0xffff
    s_mov_b32 s18, 0x200000
    s_mov_b32 s19, 0x00020000
    s_cmp_eq_u32 s57, 0
    s_cselect_b32 s20, s40, s42
    s_cselect_b32 s21, s41, s43
    s_and_b32 s21, s21, 0xffff
    s_mov_b32 s22, 0x400000
    s_mov_b32 s23, 0x00020000
    s_add_u32 m0, s48, 0
    s_nop 0
    buffer_load_dwordx4 v10, s[16:19], s49 offen offset:0 lds
    buffer_load_dwordx4 v11, s[16:19], s49 offen offset:1024 lds
    buffer_load_dwordx4 v12, s[16:19], s49 offen offset:2048 lds
    buffer_load_dwordx4 v13, s[16:19], s49 offen offset:3072 lds
    buffer_load_dwordx4 v[64:67], v62, s[24:27], s52 offen offset:0
    buffer_load_dwordx4 v[68:71], v62, s[24:27], s52 offen offset:512
    buffer_load_dwordx4 v[72:75], v62, s[24:27], s52 offen offset:1024
    buffer_load_dwordx4 v[76:79], v62, s[24:27], s52 offen offset:1536
    s_add_u32 m0, s48, 65536
    s_nop 0
    buffer_load_dwordx4 v18, s[20:23], s50 offen offset:0 lds
    buffer_load_dwordx4 v19, s[20:23], s50 offen offset:1024 lds
    buffer_load_dwordx4 v20, s[20:23], s50 offen offset:2048 lds
    buffer_load_dwordx4 v21, s[20:23], s50 offen offset:3072 lds
    s_mov_b64 s[6:7], s[62:63]
    s_add_u32 s8, s6, 0x0
    s_addc_u32 s9, s7, 0
    s_and_b32 s9, s9, 0xffff
    s_mov_b32 s10, 0x400000
    s_mov_b32 s11, 0x00020000
    s_mov_b32 s12, s4
    s_and_b32 s13, s5, 0xffff
    s_mov_b32 s14, 0x800000
    s_mov_b32 s15, 0x00020000
    s_add_u32 s32, s6, 0x1000000
    s_addc_u32 s33, s7, 0
    s_and_b32 s33, s33, 0xffff
    s_mov_b32 s34, 0x2000000
    s_mov_b32 s35, 0x00020000
    s_mov_b32 s24, s60
    s_and_b32 s25, s61, 0xffff
    s_mov_b32 s26, 0x100
    s_mov_b32 s27, 0x00020000
    s_lshl_b32 s28, s58, 2
    s_and_b32 s31, s59, 3
    s_add_u32 s28, s28, s31
    s_lshr_b32 s29, s59, 2
    s_lshl_b32 s42, s29, 7
    s_sub_u32 s43, 1920, s42
    s_lshl_b32 s31, s30, 4
    s_add_u32 s38, s42, s31
    s_add_u32 s39, s43, s31
    s_lshl_b32 s60, s30, 12
    s_mov_b32 s61, 0
    s_mov_b32 s62, 0
    s_lshl_b32 s47, s44, 1
    s_lshr_b32 s52, s30, 1
    s_add_u32 s47, s47, s52
    s_lshl_b32 s47, s47, 14
    s_lshl_b32 s52, s45, 1
    s_and_b32 s53, s30, 1
    s_add_u32 s52, s52, s53
    s_lshl_b32 s52, s52, 20
    s_add_u32 s47, s47, s52
    s_lshl_b32 s52, s57, 24
    s_add_u32 s47, s47, s52
    s_lshl_b32 s54, s44, 8
    s_lshr_b32 s55, s28, 1
    s_lshl_b32 s55, s55, 8
    s_and_b32 s53, s59, 3
    s_add_u32 s53, s53, 1
    s_cmp_eq_u32 s30, 0
    s_cselect_b32 s53, s53, -1
    s_cselect_b32 s46, 6, -1
    v_lshlrev_b32 v6, 13, v56
    v_lshl_add_u32 v50, v57, 7, v6
    s_lshl_b32 s56, s30, 5
    s_add_u32 s56, s56, s59
    s_lshl_b32 s56, s56, 16
    s_lshl_b32 s52, s58, 10
    s_add_u32 s56, s56, s52
    s_add_u32 s63, s30, 1
    v_mul_u32_u24 v6, 2064, v60
    v_lshl_add_u32 v6, v61, 4, v6
    v_add_u32 v54, 131072, v6
    v_mul_u32_u24 v7, 2064, v57
    v_lshl_add_u32 v7, v56, 4, v7
    v_lshl_add_u32 v7, v2, 9, v7
    v_add_u32 v55, 131072, v7
    v_lshrrev_b32 v7, 2, v56
    v_lshl_add_u32 v7, v2, 3, v7
    v_lshlrev_b32 v7, 17, v7
    v_and_b32 v6, 3, v56
    v_lshl_add_u32 v7, v6, 8, v7
    v_lshl_add_u32 v7, v57, 4, v7
    s_lshr_b32 s52, s2, 1
    s_lshl_b32 s52, s52, 10
    s_and_b32 s31, s2, 1
    s_lshl_b32 s31, s31, 7
    s_add_u32 s52, s52, s31
    v_add_u32 v53, s52, v7
    v_and_b32 v56, 15, v3
    v_lshrrev_b32 v57, 4, v3
    v_lshrrev_b32 v6, 1, v56
    v_xor_b32 v6, v6, v57
    v_and_b32 v7, 1, v2
    v_lshl_add_u32 v7, v7, 7, v56
    v_lshlrev_b32 v7, 7, v7
    v_lshl_add_u32 v26, v6, 4, v7
    v_xor_b32 v27, 64, v26
    v_lshrrev_b32 v6, 2, v56
    v_and_b32 v58, 1, v57
    v_lshl_add_u32 v58, v58, 2, v6
    v_lshl_add_u32 v59, v57, 3, v6
    v_and_b32 v63, 3, v3
    v_lshlrev_b32 v7, 9, v59
    v_lshrrev_b32 v6, 1, v2
    v_lshl_add_u32 v7, v6, 8, v7
    v_lshl_add_u32 v7, v63, 3, v7
    v_add_u32 v7, 65536, v7
    v_lshlrev_b32 v59, 8, v59
    v_lshl_add_u32 v59, v63, 3, v59
    v_add_u32 v59, 98304, v59
    v_xor_b32 v6, 0, v58
    v_lshl_add_u32 v28, v6, 5, v7
    v_lshl_add_u32 v42, v6, 5, v59
    v_xor_b32 v6, 1, v58
    v_lshl_add_u32 v29, v6, 5, v7
    v_lshl_add_u32 v43, v6, 5, v59
    v_xor_b32 v6, 2, v58
    v_lshl_add_u32 v30, v6, 5, v7
    v_lshl_add_u32 v44, v6, 5, v59
    v_xor_b32 v6, 3, v58
    v_lshl_add_u32 v31, v6, 5, v7
    v_lshl_add_u32 v45, v6, 5, v59
    v_xor_b32 v6, 4, v58
    v_lshl_add_u32 v32, v6, 5, v7
    v_lshl_add_u32 v46, v6, 5, v59
    v_xor_b32 v6, 5, v58
    v_lshl_add_u32 v33, v6, 5, v7
    v_lshl_add_u32 v47, v6, 5, v59
    v_xor_b32 v6, 6, v58
    v_lshl_add_u32 v34, v6, 5, v7
    v_lshl_add_u32 v48, v6, 5, v59
    v_xor_b32 v6, 7, v58
    v_lshl_add_u32 v35, v6, 5, v7
    v_lshl_add_u32 v49, v6, 5, v59
    s_lshl_b32 s31, s38, 6
    v_add_u32 v36, s31, v1
    s_lshl_b32 s31, s39, 6
    v_add_u32 v37, s31, v1
    v_bfe_u32 v6, v3, 1, 3
    v_and_b32 v7, 1, v3
    v_lshl_add_u32 v58, v2, 4, v57
    v_lshlrev_b32 v58, 13, v58
    v_lshl_add_u32 v58, v7, 4, v58
    s_lshl_b32 s31, s28, 8
    v_add_u32 v58, s31, v58
    v_xor_b32 v6, v6, v57
    v_xor_b32 v7, 0, v6
    v_lshl_add_u32 v7, v7, 5, v58
    v_add_u32 v38, 0, v7
    v_xor_b32 v7, 0, v6
    v_lshl_add_u32 v7, v7, 5, v58
    v_add_u32 v39, 31744, v7
    v_xor_b32 v7, 4, v6
    v_lshl_add_u32 v7, v7, 5, v58
    v_add_u32 v40, 63488, v7
    v_xor_b32 v7, 4, v6
    v_lshl_add_u32 v7, v7, 5, v58
    v_add_u32 v41, 95232, v7
    v_lshlrev_b32 v6, 2, v57
    v_sub_u32 v4, v56, v6
    v_mov_b32 v5, 0xff800000
    v_mov_b32 v8, 0
    v_mov_b32 v9, 1
    s_lshl_b32 s52, s59, 2
    s_add_u32 s52, s52, s30
    v_and_b32 v6, 1, v3
    v_lshl_add_u32 v6, s52, 1, v6
    s_getpc_b64 s[40:41]
pc_4:
    s_add_u32 s40, s40, k12_qcode-pc_4
    s_addc_u32 s41, s41, 0
    v_lshlrev_b32 v2, 7, v6
    v_mov_b32 v3, s41
    v_add_co_u32 v2, vcc, s40, v2
    s_nop 1
    v_addc_co_u32 v3, vcc, 0, v3, vcc
    v_mov_b32 v56, 0
    v_mov_b32 v57, 0
    v_mov_b32 v58, 0
    v_mov_b32 v59, 0
    s_nop 1
    v_mfma_f32_32x32x16_bf16 a[128:143], v[56:59], v[56:59], 0
    v_mfma_f32_32x32x16_bf16 a[144:159], v[56:59], v[56:59], 0
    v_mfma_f32_32x32x16_bf16 a[160:175], v[56:59], v[56:59], 0
    v_mfma_f32_32x32x16_bf16 a[176:191], v[56:59], v[56:59], 0
    v_mfma_f32_32x32x16_bf16 v[128:143], v[56:59], v[56:59], 0
    v_mfma_f32_32x32x16_bf16 v[144:159], v[56:59], v[56:59], 0
    v_mfma_f32_32x32x16_bf16 v[160:175], v[56:59], v[56:59], 0
    v_mfma_f32_32x32x16_bf16 v[176:191], v[56:59], v[56:59], 0
    v_mfma_f32_32x32x16_bf16 v[192:207], v[56:59], v[56:59], 0
    v_mfma_f32_32x32x16_bf16 v[208:223], v[56:59], v[56:59], 0
    v_mfma_f32_32x32x16_bf16 v[224:239], v[56:59], v[56:59], 0
    v_mfma_f32_32x32x16_bf16 v[240:255], v[56:59], v[56:59], 0
    s_add_u32 m0, s48, 4096
    s_nop 0
    buffer_load_dwordx4 v14, s[16:19], s49 offen offset:0 lds
    buffer_load_dwordx4 v15, s[16:19], s49 offen offset:1024 lds
    buffer_load_dwordx4 v16, s[16:19], s49 offen offset:2048 lds
    buffer_load_dwordx4 v17, s[16:19], s49 offen offset:3072 lds
    s_add_u32 s49, s49, 128
    s_add_u32 m0, s48, 69632
    s_nop 0
    buffer_load_dwordx4 v22, s[20:23], s50 offen offset:0 lds
    buffer_load_dwordx4 v23, s[20:23], s50 offen offset:1024 lds
    buffer_load_dwordx4 v24, s[20:23], s50 offen offset:2048 lds
    buffer_load_dwordx4 v25, s[20:23], s50 offen offset:3072 lds
    s_add_u32 s50, s50, 0x80000
    s_waitcnt vmcnt(12)
    v_lshlrev_b32 v80, 16, v64
    v_and_b32 v81, 0xffff0000, v64
    v_lshlrev_b32 v82, 16, v65
    v_and_b32 v83, 0xffff0000, v65
    v_lshlrev_b32 v84, 16, v66
    v_and_b32 v85, 0xffff0000, v66
    v_lshlrev_b32 v86, 16, v67
    v_and_b32 v87, 0xffff0000, v67
    v_lshlrev_b32 v88, 16, v68
    v_and_b32 v89, 0xffff0000, v68
    v_lshlrev_b32 v90, 16, v69
    v_and_b32 v91, 0xffff0000, v69
    v_lshlrev_b32 v92, 16, v70
    v_and_b32 v93, 0xffff0000, v70
    v_lshlrev_b32 v94, 16, v71
    v_and_b32 v95, 0xffff0000, v71
    v_lshlrev_b32 v96, 16, v72
    v_and_b32 v97, 0xffff0000, v72
    v_lshlrev_b32 v98, 16, v73
    v_and_b32 v99, 0xffff0000, v73
    v_lshlrev_b32 v100, 16, v74
    v_and_b32 v101, 0xffff0000, v74
    v_lshlrev_b32 v102, 16, v75
    v_and_b32 v103, 0xffff0000, v75
    v_lshlrev_b32 v104, 16, v76
    v_and_b32 v105, 0xffff0000, v76
    v_lshlrev_b32 v106, 16, v77
    v_and_b32 v107, 0xffff0000, v77
    v_lshlrev_b32 v108, 16, v78
    v_and_b32 v109, 0xffff0000, v78
    v_lshlrev_b32 v110, 16, v79
    v_and_b32 v111, 0xffff0000, v79
    v_pk_add_f32 v[112:113], v[80:81], v[82:83]
    v_pk_add_f32 v[114:115], v[84:85], v[86:87]
    v_pk_add_f32 v[112:113], v[112:113], v[88:89]
    v_pk_add_f32 v[114:115], v[114:115], v[90:91]
    v_pk_add_f32 v[112:113], v[112:113], v[92:93]
    v_pk_add_f32 v[114:115], v[114:115], v[94:95]
    v_pk_add_f32 v[112:113], v[112:113], v[96:97]
    v_pk_add_f32 v[114:115], v[114:115], v[98:99]
    v_pk_add_f32 v[112:113], v[112:113], v[100:101]
    v_pk_add_f32 v[114:115], v[114:115], v[102:103]
    v_pk_add_f32 v[112:113], v[112:113], v[104:105]
    v_pk_add_f32 v[114:115], v[114:115], v[106:107]
    s_add_u32 m0, s48, 32768
    s_nop 0
    buffer_load_dwordx4 v10, s[16:19], s49 offen offset:0 lds
    buffer_load_dwordx4 v11, s[16:19], s49 offen offset:1024 lds
    buffer_load_dwordx4 v12, s[16:19], s49 offen offset:2048 lds
    buffer_load_dwordx4 v13, s[16:19], s49 offen offset:3072 lds
    v_pk_add_f32 v[112:113], v[112:113], v[108:109]
    v_pk_add_f32 v[114:115], v[114:115], v[110:111]
    v_pk_add_f32 v[112:113], v[112:113], v[114:115]
    v_add_f32 v112, v112, v113
    s_nop 1
    v_add_f32_dpp v112, v112, v112 quad_perm:[1,0,3,2] row_mask:0xf bank_mask:0xf
    s_nop 1
    v_add_f32_dpp v112, v112, v112 quad_perm:[2,3,0,1] row_mask:0xf bank_mask:0xf
    s_nop 1
    v_add_f32_dpp v112, v112, v112 row_half_mirror row_mask:0xf bank_mask:0xf
    s_nop 1
    v_add_f32_dpp v112, v112, v112 row_mirror row_mask:0xf bank_mask:0xf
    v_mov_b32 v114, v112
    s_nop 1
    v_permlane16_swap_b32 v112, v114
    s_nop 1
    v_add_f32 v112, v112, v114
    v_mul_f32 v112, 0xba800000, v112
    v_mov_b32 v113, v112
    v_pk_add_f32 v[114:115], v[80:81], v[112:113]
    v_pk_add_f32 v[118:119], v[82:83], v[112:113]
    v_pk_mul_f32 v[116:117], v[114:115], v[114:115]
    v_pk_fma_f32 v[116:117], v[118:119], v[118:119], v[116:117]
    v_pk_add_f32 v[114:115], v[84:85], v[112:113]
    v_pk_add_f32 v[118:119], v[86:87], v[112:113]
    v_pk_fma_f32 v[116:117], v[114:115], v[114:115], v[116:117]
    v_pk_fma_f32 v[116:117], v[118:119], v[118:119], v[116:117]
    v_pk_add_f32 v[114:115], v[88:89], v[112:113]
    v_pk_add_f32 v[118:119], v[90:91], v[112:113]
    v_pk_fma_f32 v[116:117], v[114:115], v[114:115], v[116:117]
    v_pk_fma_f32 v[116:117], v[118:119], v[118:119], v[116:117]
    v_pk_add_f32 v[114:115], v[92:93], v[112:113]
    v_pk_add_f32 v[118:119], v[94:95], v[112:113]
    v_pk_fma_f32 v[116:117], v[114:115], v[114:115], v[116:117]
    v_pk_fma_f32 v[116:117], v[118:119], v[118:119], v[116:117]
    v_pk_add_f32 v[114:115], v[96:97], v[112:113]
    v_pk_add_f32 v[118:119], v[98:99], v[112:113]
    v_pk_fma_f32 v[116:117], v[114:115], v[114:115], v[116:117]
    v_pk_fma_f32 v[116:117], v[118:119], v[118:119], v[116:117]
    v_pk_add_f32 v[114:115], v[100:101], v[112:113]
    v_pk_add_f32 v[118:119], v[102:103], v[112:113]
    v_pk_fma_f32 v[116:117], v[114:115], v[114:115], v[116:117]
    v_pk_fma_f32 v[116:117], v[118:119], v[118:119], v[116:117]
    v_pk_add_f32 v[114:115], v[104:105], v[112:113]
    s_add_u32 m0, s48, 98304
    s_nop 0
    buffer_load_dwordx4 v18, s[20:23], s50 offen offset:0 lds
    buffer_load_dwordx4 v19, s[20:23], s50 offen offset:1024 lds
    buffer_load_dwordx4 v20, s[20:23], s50 offen offset:2048 lds
    buffer_load_dwordx4 v21, s[20:23], s50 offen offset:3072 lds
    v_pk_add_f32 v[118:119], v[106:107], v[112:113]
    v_pk_fma_f32 v[116:117], v[114:115], v[114:115], v[116:117]
    v_pk_fma_f32 v[116:117], v[118:119], v[118:119], v[116:117]
    v_pk_add_f32 v[114:115], v[108:109], v[112:113]
    v_pk_add_f32 v[118:119], v[110:111], v[112:113]
    v_pk_fma_f32 v[116:117], v[114:115], v[114:115], v[116:117]
    v_pk_fma_f32 v[116:117], v[118:119], v[118:119], v[116:117]
    v_add_f32 v116, v116, v117
    s_nop 1
    v_add_f32_dpp v116, v116, v116 quad_perm:[1,0,3,2] row_mask:0xf bank_mask:0xf
    s_nop 1
    v_add_f32_dpp v116, v116, v116 quad_perm:[2,3,0,1] row_mask:0xf bank_mask:0xf
    s_nop 1
    v_add_f32_dpp v116, v116, v116 row_half_mirror row_mask:0xf bank_mask:0xf
    s_nop 1
    v_add_f32_dpp v116, v116, v116 row_mirror row_mask:0xf bank_mask:0xf
    v_mov_b32 v114, v116
    s_nop 1
    v_permlane16_swap_b32 v116, v114
    s_nop 1
    v_add_f32 v116, v116, v114
    v_mul_f32 v116, 0x3a800000, v116
    v_cvt_pk_bf16_f32 v118, v112, v116
    v_and_b32 v116, 0xffff0000, v118
    v_lshlrev_b32 v118, 16, v118
    v_add_f32 v116, 0x3727c5ac, v116
    v_mov_b32 v119, v118
    v_cvt_pk_bf16_f32 v116, v116, v116
    v_and_b32 v116, 0xffff0000, v116
    v_sqrt_f32 v116, v116
    v_pk_add_f32 v[80:81], v[80:81], v[118:119]
    v_pk_add_f32 v[82:83], v[82:83], v[118:119]
    v_pk_add_f32 v[84:85], v[84:85], v[118:119]
    v_pk_add_f32 v[86:87], v[86:87], v[118:119]
    v_pk_add_f32 v[88:89], v[88:89], v[118:119]
    v_pk_add_f32 v[90:91], v[90:91], v[118:119]
    v_pk_add_f32 v[92:93], v[92:93], v[118:119]
    v_pk_add_f32 v[94:95], v[94:95], v[118:119]
    v_pk_add_f32 v[96:97], v[96:97], v[118:119]
    v_pk_add_f32 v[98:99], v[98:99], v[118:119]
    v_pk_add_f32 v[100:101], v[100:101], v[118:119]
    v_pk_add_f32 v[102:103], v[102:103], v[118:119]
    v_pk_add_f32 v[104:105], v[104:105], v[118:119]
    s_add_u32 m0, s48, 36864
    s_nop 0
    buffer_load_dwordx4 v14, s[16:19], s49 offen offset:0 lds
    buffer_load_dwordx4 v15, s[16:19], s49 offen offset:1024 lds
    buffer_load_dwordx4 v16, s[16:19], s49 offen offset:2048 lds
    buffer_load_dwordx4 v17, s[16:19], s49 offen offset:3072 lds
    s_add_u32 s49, s49, 128
    v_pk_add_f32 v[106:107], v[106:107], v[118:119]
    v_pk_add_f32 v[108:109], v[108:109], v[118:119]
    v_pk_add_f32 v[110:111], v[110:111], v[118:119]
    v_cvt_pk_bf16_f32 v116, v116, v116
    v_and_b32 v116, 0xffff0000, v116
    v_rcp_f32 v116, v116
    v_cvt_pk_bf16_f32 v64, v80, v81
    v_cvt_pk_bf16_f32 v65, v82, v83
    v_cvt_pk_bf16_f32 v66, v84, v85
    v_cvt_pk_bf16_f32 v67, v86, v87
    v_cvt_pk_bf16_f32 v68, v88, v89
    v_cvt_pk_bf16_f32 v69, v90, v91
    v_cvt_pk_bf16_f32 v70, v92, v93
    v_cvt_pk_bf16_f32 v71, v94, v95
    v_cvt_pk_bf16_f32 v72, v96, v97
    v_cvt_pk_bf16_f32 v73, v98, v99
    v_cvt_pk_bf16_f32 v74, v100, v101
    v_cvt_pk_bf16_f32 v75, v102, v103
    v_cvt_pk_bf16_f32 v76, v104, v105
    v_cvt_pk_bf16_f32 v77, v106, v107
    v_cvt_pk_bf16_f32 v78, v108, v109
    v_cvt_pk_bf16_f32 v79, v110, v111
    v_mov_b32 v117, v116
    v_lshlrev_b32 v80, 16, v64
    v_and_b32 v81, 0xffff0000, v64
    v_lshlrev_b32 v82, 16, v65
    v_and_b32 v83, 0xffff0000, v65
    v_lshlrev_b32 v84, 16, v66
    v_and_b32 v85, 0xffff0000, v66
    v_lshlrev_b32 v86, 16, v67
    v_and_b32 v87, 0xffff0000, v67
    v_lshlrev_b32 v88, 16, v68
    v_and_b32 v89, 0xffff0000, v68
    v_lshlrev_b32 v90, 16, v69
    v_and_b32 v91, 0xffff0000, v69
    v_lshlrev_b32 v92, 16, v70
    v_and_b32 v93, 0xffff0000, v70
    v_lshlrev_b32 v94, 16, v71
    v_and_b32 v95, 0xffff0000, v71
    v_lshlrev_b32 v96, 16, v72
    v_and_b32 v97, 0xffff0000, v72
    v_lshlrev_b32 v98, 16, v73
    v_and_b32 v99, 0xffff0000, v73
    v_lshlrev_b32 v100, 16, v74
    s_add_u32 m0, s48, 102400
    s_nop 0
    buffer_load_dwordx4 v22, s[20:23], s50 offen offset:0 lds
    buffer_load_dwordx4 v23, s[20:23], s50 offen offset:1024 lds
    buffer_load_dwordx4 v24, s[20:23], s50 offen offset:2048 lds
    buffer_load_dwordx4 v25, s[20:23], s50 offen offset:3072 lds
    s_add_u32 s50, s50, 0x80000
    v_and_b32 v101, 0xffff0000, v74
    v_lshlrev_b32 v102, 16, v75
    v_and_b32 v103, 0xffff0000, v75
    v_lshlrev_b32 v104, 16, v76
    v_and_b32 v105, 0xffff0000, v76
    v_lshlrev_b32 v106, 16, v77
    v_and_b32 v107, 0xffff0000, v77
    v_lshlrev_b32 v108, 16, v78
    v_and_b32 v109, 0xffff0000, v78
    v_lshlrev_b32 v110, 16, v79
    v_and_b32 v111, 0xffff0000, v79
    v_pk_mul_f32 v[80:81], v[80:81], v[116:117]
    v_pk_mul_f32 v[82:83], v[82:83], v[116:117]
    v_pk_mul_f32 v[84:85], v[84:85], v[116:117]
    v_pk_mul_f32 v[86:87], v[86:87], v[116:117]
    v_pk_mul_f32 v[88:89], v[88:89], v[116:117]
    v_pk_mul_f32 v[90:91], v[90:91], v[116:117]
    v_pk_mul_f32 v[92:93], v[92:93], v[116:117]
    v_pk_mul_f32 v[94:95], v[94:95], v[116:117]
    v_pk_mul_f32 v[96:97], v[96:97], v[116:117]
    v_pk_mul_f32 v[98:99], v[98:99], v[116:117]
    v_pk_mul_f32 v[100:101], v[100:101], v[116:117]
    v_pk_mul_f32 v[102:103], v[102:103], v[116:117]
    v_pk_mul_f32 v[104:105], v[104:105], v[116:117]
    v_pk_mul_f32 v[106:107], v[106:107], v[116:117]
    v_pk_mul_f32 v[108:109], v[108:109], v[116:117]
    v_pk_mul_f32 v[110:111], v[110:111], v[116:117]
    v_cvt_pk_bf16_f32 v64, v80, v81
    v_cvt_pk_bf16_f32 v65, v82, v83
    v_cvt_pk_bf16_f32 v66, v84, v85
    v_cvt_pk_bf16_f32 v67, v86, v87
    v_cvt_pk_bf16_f32 v68, v88, v89
    v_cvt_pk_bf16_f32 v69, v90, v91
    v_cvt_pk_bf16_f32 v70, v92, v93
    v_cvt_pk_bf16_f32 v71, v94, v95
    v_cvt_pk_bf16_f32 v72, v96, v97
    v_cvt_pk_bf16_f32 v73, v98, v99
    v_cvt_pk_bf16_f32 v74, v100, v101
    v_cvt_pk_bf16_f32 v75, v102, v103
    v_cvt_pk_bf16_f32 v76, v104, v105
    v_cvt_pk_bf16_f32 v77, v106, v107
    v_cvt_pk_bf16_f32 v78, v108, v109
    v_cvt_pk_bf16_f32 v79, v110, v111
    ds_write_b128 v54, v[64:67] offset:0
    ds_write_b128 v54, v[68:71] offset:512
    ds_write_b128 v54, v[72:75] offset:1024
    ds_write_b128 v54, v[76:79] offset:1536
    s_waitcnt vmcnt(16) lgkmcnt(0)
    s_barrier
    ds_read_b128 a[64:67], v55 offset:0
    ds_read_b128 a[68:71], v55 offset:128
    ds_read_b128 a[72:75], v55 offset:256
    ds_read_b128 a[76:79], v55 offset:384
    v_add_u32 v54, 4096, v36
    v_add_u32 v55, 4096, v37
    v_mfma_f32_32x32x16_bf16 v[64:79], v[56:59], v[56:59], 0
    v_mfma_f32_32x32x16_bf16 v[80:95], v[56:59], v[56:59], 0
    v_mfma_f32_32x32x16_bf16 v[96:111], v[56:59], v[56:59], 0
    v_mfma_f32_32x32x16_bf16 v[112:127], v[56:59], v[56:59], 0
    s_cmp_ge_u32 s2, 22
    s_cbranch_scc1 k12_nostat_5
    s_lshl_b32 s52, s2, 12
    s_add_u32 s52, s52, 0x3800000
    s_mov_b32 s34, -1
    v_lshlrev_b32 v6, 4, v0
    buffer_store_dwordx4 v[56:59], v6, s[32:35], s52 offen sc1
    s_mov_b32 s34, 0x2000000
k12_nostat_5:
    ds_read_b128 a[192:195], v26 offset:0
    ds_read_b64_tr_b16 a[0:1], v28 offset:0
    ds_read_b128 a[196:199], v27 offset:0
    ds_read_b64_tr_b16 a[2:3], v28 offset:2048
    ds_read_b128 a[200:203], v26 offset:2048
    ds_read_b64_tr_b16 a[4:5], v28 offset:16384
    ds_read_b128 a[204:207], v27 offset:2048
    ds_read_b64_tr_b16 a[6:7], v28 offset:18432
    ds_read_b128 a[208:211], v26 offset:4096
    ds_read_b64_tr_b16 a[8:9], v29 offset:0
    ds_read_b128 a[212:215], v27 offset:4096
    ds_read_b64_tr_b16 a[10:11], v29 offset:2048
    ds_read_b128 a[216:219], v26 offset:6144
    ds_read_b64_tr_b16 a[12:13], v29 offset:16384
    ds_read_b128 a[220:223], v27 offset:6144
    ds_read_b64_tr_b16 a[14:15], v29 offset:18432
    ds_read_b128 a[224:227], v26 offset:8192
    ds_read_b64_tr_b16 a[16:17], v30 offset:0
    ds_read_b128 a[228:231], v27 offset:8192
    ds_read_b64_tr_b16 a[18:19], v30 offset:2048
    ds_read_b128 a[232:235], v26 offset:10240
    ds_read_b64_tr_b16 a[20:21], v30 offset:16384
    ds_read_b128 a[236:239], v27 offset:10240
    ds_read_b64_tr_b16 a[22:23], v30 offset:18432
    ds_read_b128 a[240:243], v26 offset:12288
    ds_read_b64_tr_b16 a[24:25], v31 offset:0
    ds_read_b128 a[244:247], v27 offset:12288
    ds_read_b64_tr_b16 a[26:27], v31 offset:2048
    ds_read_b128 a[248:251], v26 offset:14336
    ds_read_b64_tr_b16 a[28:29], v31 offset:16384
    ds_read_b128 a[252:255], v27 offset:14336
    ds_read_b64_tr_b16 a[30:31], v31 offset:18432
    s_mov_b32 s51, 0
    s_waitcnt lgkmcnt(15)
    s_mov_b32 s52, 0
    buffer_store_dwordx4 a[64:67], v53, s[8:11], s52 offen sc1
    s_mov_b32 s52, 262144
    buffer_store_dwordx4 a[68:71], v53, s[8:11], s52 offen sc1
    s_mov_b32 s52, 524288
    buffer_store_dwordx4 a[72:75], v53, s[8:11], s52 offen sc1
    s_mov_b32 s52, 786432
    buffer_store_dwordx4 a[76:79], v53, s[8:11], s52 offen sc1
    s_waitcnt lgkmcnt(0)
    s_cmp_lg_u32 s57, 0
    s_cbranch_scc1 k12_v_6
k12_loop_8:
    v_mfma_f32_16x16x32_bf16 v[64:67], a[0:3], a[192:195], v[64:67]
    v_mfma_f32_16x16x32_bf16 v[64:67], a[4:7], a[196:199], v[64:67]
    ds_read_b64_tr_b16 a[32:33], v32 offset:0
    v_mfma_f32_16x16x32_bf16 v[80:83], a[4:7], a[204:207], v[80:83]
    v_mfma_f32_16x16x32_bf16 v[80:83], a[0:3], a[200:203], v[80:83]
    ds_read_b64_tr_b16 a[34:35], v32 offset:2048
    v_mfma_f32_16x16x32_bf16 v[96:99], a[0:3], a[208:211], v[96:99]
    s_cmp_eq_u32 s51, s46
    s_cbranch_scc1 k12_ool_10
k12_oolret_11:
    v_mfma_f32_16x16x32_bf16 v[96:99], a[4:7], a[212:215], v[96:99]
    v_mfma_f32_16x16x32_bf16 v[112:115], a[4:7], a[220:223], v[112:115]
    ds_read_b64_tr_b16 a[36:37], v32 offset:16384
    v_mfma_f32_16x16x32_bf16 v[112:115], a[0:3], a[216:219], v[112:115]
    v_mfma_f32_16x16x32_bf16 v[128:131], a[0:3], a[224:227], v[128:131]
    v_mfma_f32_16x16x32_bf16 v[128:131], a[4:7], a[228:231], v[128:131]
    ds_read_b64_tr_b16 a[38:39], v32 offset:18432
    v_mfma_f32_16x16x32_bf16 v[144:147], a[4:7], a[236:239], v[144:147]
    v_mfma_f32_16x16x32_bf16 v[144:147], a[0:3], a[232:235], v[144:147]
    v_mfma_f32_16x16x32_bf16 a[128:131], a[0:3], a[240:243], a[128:131]
    ds_read_b64_tr_b16 a[40:41], v33 offset:0
    v_mfma_f32_16x16x32_bf16 a[128:131], a[4:7], a[244:247], a[128:131]
    v_mfma_f32_16x16x32_bf16 a[160:163], a[4:7], a[252:255], a[160:163]
    v_mfma_f32_16x16x32_bf16 a[160:163], a[0:3], a[248:251], a[160:163]
    ds_read_b64_tr_b16 a[42:43], v33 offset:2048
    v_mfma_f32_16x16x32_bf16 a[164:167], a[8:11], a[248:251], a[164:167]
    v_mfma_f32_16x16x32_bf16 a[164:167], a[12:15], a[252:255], a[164:167]
    v_mfma_f32_16x16x32_bf16 a[132:135], a[12:15], a[244:247], a[132:135]
    ds_read_b64_tr_b16 a[44:45], v33 offset:16384
    v_mfma_f32_16x16x32_bf16 a[132:135], a[8:11], a[240:243], a[132:135]
    v_mfma_f32_16x16x32_bf16 v[240:243], a[8:11], a[232:235], v[240:243]
    v_mfma_f32_16x16x32_bf16 v[240:243], a[12:15], a[236:239], v[240:243]
    ds_read_b64_tr_b16 a[46:47], v33 offset:18432
    v_mfma_f32_16x16x32_bf16 v[224:227], a[12:15], a[228:231], v[224:227]
    v_mfma_f32_16x16x32_bf16 v[224:227], a[8:11], a[224:227], v[224:227]
    ds_read_b64_tr_b16 a[48:49], v34 offset:0
    v_mfma_f32_16x16x32_bf16 v[208:211], a[8:11], a[216:219], v[208:211]
    v_mfma_f32_16x16x32_bf16 v[208:211], a[12:15], a[220:223], v[208:211]
    v_mfma_f32_16x16x32_bf16 v[192:195], a[12:15], a[212:215], v[192:195]
    ds_read_b64_tr_b16 a[50:51], v34 offset:2048
    v_mfma_f32_16x16x32_bf16 v[192:195], a[8:11], a[208:211], v[192:195]
    v_mfma_f32_16x16x32_bf16 v[176:179], a[8:11], a[200:203], v[176:179]
    v_mfma_f32_16x16x32_bf16 v[176:179], a[12:15], a[204:207], v[176:179]
    ds_read_b64_tr_b16 a[52:53], v34 offset:16384
    v_mfma_f32_16x16x32_bf16 v[160:163], a[12:15], a[196:199], v[160:163]
    v_mfma_f32_16x16x32_bf16 v[160:163], a[8:11], a[192:195], v[160:163]
    v_mfma_f32_16x16x32_bf16 v[68:71], a[16:19], a[192:195], v[68:71]
    ds_read_b64_tr_b16 a[54:55], v34 offset:18432
    v_mfma_f32_16x16x32_bf16 v[68:71], a[20:23], a[196:199], v[68:71]
    v_mfma_f32_16x16x32_bf16 v[84:87], a[20:23], a[204:207], v[84:87]
    v_mfma_f32_16x16x32_bf16 v[84:87], a[16:19], a[200:203], v[84:87]
    ds_read_b64_tr_b16 a[56:57], v35 offset:0
    v_mfma_f32_16x16x32_bf16 v[100:103], a[16:19], a[208:211], v[100:103]
    v_mfma_f32_16x16x32_bf16 v[100:103], a[20:23], a[212:215], v[100:103]
    v_mfma_f32_16x16x32_bf16 v[116:119], a[20:23], a[220:223], v[116:119]
    ds_read_b64_tr_b16 a[58:59], v35 offset:2048
    v_mfma_f32_16x16x32_bf16 v[116:119], a[16:19], a[216:219], v[116:119]
    v_mfma_f32_16x16x32_bf16 v[132:135], a[16:19], a[224:227], v[132:135]
    v_mfma_f32_16x16x32_bf16 v[132:135], a[20:23], a[228:231], v[132:135]
    ds_read_b64_tr_b16 a[60:61], v35 offset:16384
    v_mfma_f32_16x16x32_bf16 v[148:151], a[20:23], a[236:239], v[148:151]
    v_mfma_f32_16x16x32_bf16 v[148:151], a[16:19], a[232:235], v[148:151]
    v_mfma_f32_16x16x32_bf16 a[136:139], a[16:19], a[240:243], a[136:139]
    ds_read_b64_tr_b16 a[62:63], v35 offset:18432
    v_mfma_f32_16x16x32_bf16 a[136:139], a[20:23], a[244:247], a[136:139]
    v_mfma_f32_16x16x32_bf16 a[168:171], a[20:23], a[252:255], a[168:171]
    v_mfma_f32_16x16x32_bf16 a[168:171], a[16:19], a[248:251], a[168:171]
    v_mfma_f32_16x16x32_bf16 a[172:175], a[24:27], a[248:251], a[172:175]
    v_mfma_f32_16x16x32_bf16 a[172:175], a[28:31], a[252:255], a[172:175]
    v_mfma_f32_16x16x32_bf16 a[140:143], a[28:31], a[244:247], a[140:143]
    v_mfma_f32_16x16x32_bf16 a[140:143], a[24:27], a[240:243], a[140:143]
    v_mfma_f32_16x16x32_bf16 v[244:247], a[24:27], a[232:235], v[244:247]
    v_mfma_f32_16x16x32_bf16 v[244:247], a[28:31], a[236:239], v[244:247]
    v_mfma_f32_16x16x32_bf16 v[228:231], a[28:31], a[228:231], v[228:231]
    v_mfma_f32_16x16x32_bf16 v[228:231], a[24:27], a[224:227], v[228:231]
    v_mfma_f32_16x16x32_bf16 v[212:215], a[24:27], a[216:219], v[212:215]
    v_mfma_f32_16x16x32_bf16 v[212:215], a[28:31], a[220:223], v[212:215]
    v_mfma_f32_16x16x32_bf16 v[196:199], a[28:31], a[212:215], v[196:199]
    v_mfma_f32_16x16x32_bf16 v[196:199], a[24:27], a[208:211], v[196:199]
    v_mfma_f32_16x16x32_bf16 v[180:183], a[24:27], a[200:203], v[180:183]
    v_mfma_f32_16x16x32_bf16 v[180:183], a[28:31], a[204:207], v[180:183]
    v_mfma_f32_16x16x32_bf16 v[164:167], a[28:31], a[196:199], v[164:167]
    v_mfma_f32_16x16x32_bf16 v[164:167], a[24:27], a[192:195], v[164:167]
    s_waitcnt vmcnt(0) lgkmcnt(0)
    s_cmp_eq_u32 s51, s46
    s_cbranch_scc1 k12_ool_14
k12_oolret_15:
    s_barrier
    v_mfma_f32_16x16x32_bf16 v[72:75], a[32:35], a[192:195], v[72:75]
    s_cmp_ge_u32 s49, 1024
    s_cselect_b32 s18, 0, s18
    s_cselect_b32 s22, 0, s22
    v_mfma_f32_16x16x32_bf16 v[72:75], a[36:39], a[196:199], v[72:75]
    s_add_u32 m0, s48, 0
    ds_read_b128 a[64:67], v26 offset:32768
    v_mfma_f32_16x16x32_bf16 v[88:91], a[36:39], a[204:207], v[88:91]
    buffer_load_dwordx4 v10, s[16:19], s49 offen offset:0 lds
    ds_read_b64_tr_b16 a[0:1], v28 offset:32768
    v_mfma_f32_16x16x32_bf16 v[88:91], a[32:35], a[200:203], v[88:91]
    ds_read_b128 a[68:71], v27 offset:32768
    v_mfma_f32_16x16x32_bf16 v[104:107], a[32:35], a[208:211], v[104:107]
    buffer_load_dwordx4 v11, s[16:19], s49 offen offset:1024 lds
    v_mfma_f32_16x16x32_bf16 v[104:107], a[36:39], a[212:215], v[104:107]
    ds_read_b64_tr_b16 a[2:3], v28 offset:34816
    v_mfma_f32_16x16x32_bf16 v[120:123], a[36:39], a[220:223], v[120:123]
    v_mfma_f32_16x16x32_bf16 v[120:123], a[32:35], a[216:219], v[120:123]
    ds_read_b128 a[72:75], v26 offset:34816
    v_mfma_f32_16x16x32_bf16 v[136:139], a[32:35], a[224:227], v[136:139]
    buffer_load_dwordx4 v12, s[16:19], s49 offen offset:2048 lds
    ds_read_b64_tr_b16 a[4:5], v28 offset:49152
    v_mfma_f32_16x16x32_bf16 v[136:139], a[36:39], a[228:231], v[136:139]
    v_mfma_f32_16x16x32_bf16 v[152:155], a[36:39], a[236:239], v[152:155]
    ds_read_b128 a[76:79], v27 offset:34816
    v_mfma_f32_16x16x32_bf16 v[152:155], a[32:35], a[232:235], v[152:155]
    buffer_load_dwordx4 v13, s[16:19], s49 offen offset:3072 lds
    v_mfma_f32_16x16x32_bf16 a[144:147], a[32:35], a[240:243], a[144:147]
    ds_read_b64_tr_b16 a[6:7], v28 offset:51200
    v_mfma_f32_16x16x32_bf16 a[144:147], a[36:39], a[244:247], a[144:147]
    s_add_u32 m0, s48, 4096
    ds_read_b128 a[80:83], v26 offset:36864
    v_mfma_f32_16x16x32_bf16 a[176:179], a[36:39], a[252:255], a[176:179]
    v_mfma_f32_16x16x32_bf16 a[176:179], a[32:35], a[248:251], a[176:179]
    buffer_load_dwordx4 v14, s[16:19], s49 offen offset:0 lds
    ds_read_b64_tr_b16 a[8:9], v29 offset:32768
    v_mfma_f32_16x16x32_bf16 a[180:183], a[40:43], a[248:251], a[180:183]
    v_mfma_f32_16x16x32_bf16 a[180:183], a[44:47], a[252:255], a[180:183]
    ds_read_b128 a[84:87], v27 offset:36864
    v_mfma_f32_16x16x32_bf16 a[148:151], a[44:47], a[244:247], a[148:151]
    buffer_load_dwordx4 v15, s[16:19], s49 offen offset:1024 lds
    ds_read_b64_tr_b16 a[10:11], v29 offset:34816
    v_mfma_f32_16x16x32_bf16 a[148:151], a[40:43], a[240:243], a[148:151]
    v_mfma_f32_16x16x32_bf16 v[248:251], a[40:43], a[232:235], v[248:251]
    ds_read_b128 a[88:91], v26 offset:38912
    v_mfma_f32_16x16x32_bf16 v[248:251], a[44:47], a[236:239], v[248:251]
    v_mfma_f32_16x16x32_bf16 v[232:235], a[44:47], a[228:231], v[232:235]
    buffer_load_dwordx4 v16, s[16:19], s49 offen offset:2048 lds
    ds_read_b64_tr_b16 a[12:13], v29 offset:49152
    v_mfma_f32_16x16x32_bf16 v[232:235], a[40:43], a[224:227], v[232:235]
    ds_read_b128 a[92:95], v27 offset:38912
    v_mfma_f32_16x16x32_bf16 v[216:219], a[40:43], a[216:219], v[216:219]
    v_mfma_f32_16x16x32_bf16 v[216:219], a[44:47], a[220:223], v[216:219]
    buffer_load_dwordx4 v17, s[16:19], s49 offen offset:3072 lds
    ds_read_b64_tr_b16 a[14:15], v29 offset:51200
    v_mfma_f32_16x16x32_bf16 v[200:203], a[44:47], a[212:215], v[200:203]
    ds_read_b128 a[96:99], v26 offset:40960
    v_mfma_f32_16x16x32_bf16 v[200:203], a[40:43], a[208:211], v[200:203]
    s_add_u32 s49, s49, 128
    v_mfma_f32_16x16x32_bf16 v[184:187], a[40:43], a[200:203], v[184:187]
    s_add_u32 m0, s48, 65536
    ds_read_b64_tr_b16 a[16:17], v30 offset:32768
    v_mfma_f32_16x16x32_bf16 v[184:187], a[44:47], a[204:207], v[184:187]
    buffer_load_dwordx4 v18, s[20:23], s50 offen offset:0 lds
    v_mfma_f32_16x16x32_bf16 v[168:171], a[44:47], a[196:199], v[168:171]
    ds_read_b128 a[100:103], v27 offset:40960
    v_mfma_f32_16x16x32_bf16 v[168:171], a[40:43], a[192:195], v[168:171]
    ds_read_b64_tr_b16 a[18:19], v30 offset:34816
    v_mfma_f32_16x16x32_bf16 v[76:79], a[48:51], a[192:195], v[76:79]
    buffer_load_dwordx4 v19, s[20:23], s50 offen offset:1024 lds
    v_mfma_f32_16x16x32_bf16 v[76:79], a[52:55], a[196:199], v[76:79]
    ds_read_b128 a[104:107], v26 offset:43008
    v_mfma_f32_16x16x32_bf16 v[92:95], a[52:55], a[204:207], v[92:95]
    v_mfma_f32_16x16x32_bf16 v[92:95], a[48:51], a[200:203], v[92:95]
    buffer_load_dwordx4 v20, s[20:23], s50 offen offset:2048 lds
    ds_read_b64_tr_b16 a[20:21], v30 offset:49152
    v_mfma_f32_16x16x32_bf16 v[108:111], a[48:51], a[208:211], v[108:111]
    ds_read_b128 a[108:111], v27 offset:43008
    v_mfma_f32_16x16x32_bf16 v[108:111], a[52:55], a[212:215], v[108:111]
    v_mfma_f32_16x16x32_bf16 v[124:127], a[52:55], a[220:223], v[124:127]
    ds_read_b64_tr_b16 a[22:23], v30 offset:51200
    v_mfma_f32_16x16x32_bf16 v[124:127], a[48:51], a[216:219], v[124:127]
    buffer_load_dwordx4 v21, s[20:23], s50 offen offset:3072 lds
    v_mfma_f32_16x16x32_bf16 v[140:143], a[48:51], a[224:227], v[140:143]
    s_add_u32 m0, s48, 69632
    ds_read_b128 a[112:115], v26 offset:45056
    v_mfma_f32_16x16x32_bf16 v[140:143], a[52:55], a[228:231], v[140:143]
    ds_read_b64_tr_b16 a[24:25], v31 offset:32768
    v_mfma_f32_16x16x32_bf16 v[156:159], a[52:55], a[236:239], v[156:159]
    buffer_load_dwordx4 v22, s[20:23], s50 offen offset:0 lds
    v_mfma_f32_16x16x32_bf16 v[156:159], a[48:51], a[232:235], v[156:159]
    ds_read_b128 a[116:119], v27 offset:45056
    v_mfma_f32_16x16x32_bf16 a[152:155], a[48:51], a[240:243], a[152:155]
    v_mfma_f32_16x16x32_bf16 a[152:155], a[52:55], a[244:247], a[152:155]
    ds_read_b64_tr_b16 a[26:27], v31 offset:34816
    v_mfma_f32_16x16x32_bf16 a[184:187], a[52:55], a[252:255], a[184:187]
    buffer_load_dwordx4 v23, s[20:23], s50 offen offset:1024 lds
    ds_read_b128 a[120:123], v26 offset:47104
    v_mfma_f32_16x16x32_bf16 a[184:187], a[48:51], a[248:251], a[184:187]
    v_mfma_f32_16x16x32_bf16 a[188:191], a[56:59], a[248:251], a[188:191]
    ds_read_b64_tr_b16 a[28:29], v31 offset:49152
    v_mfma_f32_16x16x32_bf16 a[188:191], a[60:63], a[252:255], a[188:191]
    buffer_load_dwordx4 v24, s[20:23], s50 offen offset:2048 lds
    v_mfma_f32_16x16x32_bf16 a[156:159], a[60:63], a[244:247], a[156:159]
    ds_read_b128 a[124:127], v27 offset:47104
    v_mfma_f32_16x16x32_bf16 a[156:159], a[56:59], a[240:243], a[156:159]
    ds_read_b64_tr_b16 a[30:31], v31 offset:51200
    v_mfma_f32_16x16x32_bf16 v[252:255], a[56:59], a[232:235], v[252:255]
    v_mfma_f32_16x16x32_bf16 v[252:255], a[60:63], a[236:239], v[252:255]
    buffer_load_dwordx4 v25, s[20:23], s50 offen offset:3072 lds
    v_mfma_f32_16x16x32_bf16 v[236:239], a[60:63], a[228:231], v[236:239]
    v_mfma_f32_16x16x32_bf16 v[236:239], a[56:59], a[224:227], v[236:239]
    s_add_u32 s50, s50, 0x80000
    v_mfma_f32_16x16x32_bf16 v[220:223], a[56:59], a[216:219], v[220:223]
    v_mfma_f32_16x16x32_bf16 v[220:223], a[60:63], a[220:223], v[220:223]
    s_cmp_eq_u32 s51, s53
    s_cbranch_scc1 k12_ool_16
k12_oolret_17:
    v_mfma_f32_16x16x32_bf16 v[204:207], a[60:63], a[212:215], v[204:207]
    s_cmp_eq_u32 s51, s63
    s_cbranch_scc1 k12_ool_18
k12_oolret_19:
    v_mfma_f32_16x16x32_bf16 v[204:207], a[56:59], a[208:211], v[204:207]
    s_cmp_eq_u32 s51, 6
    s_cbranch_scc1 k12_ool_20
k12_oolret_21:
    v_mfma_f32_16x16x32_bf16 v[188:191], a[56:59], a[200:203], v[188:191]
    v_mfma_f32_16x16x32_bf16 v[188:191], a[60:63], a[204:207], v[188:191]
    s_add_u32 s51, s51, 1
    v_mfma_f32_16x16x32_bf16 v[172:175], a[60:63], a[196:199], v[172:175]
    v_mfma_f32_16x16x32_bf16 v[172:175], a[56:59], a[192:195], v[172:175]
    s_waitcnt lgkmcnt(0)
    s_cmp_eq_u32 s51, 7
    s_cbranch_scc1 k12_last_9
    v_mfma_f32_16x16x32_bf16 v[64:67], a[0:3], a[64:67], v[64:67]
    v_mfma_f32_16x16x32_bf16 v[64:67], a[4:7], a[68:71], v[64:67]
    ds_read_b64_tr_b16 a[32:33], v32 offset:32768
    v_mfma_f32_16x16x32_bf16 v[80:83], a[4:7], a[76:79], v[80:83]
    v_mfma_f32_16x16x32_bf16 v[80:83], a[0:3], a[72:75], v[80:83]
    ds_read_b64_tr_b16 a[34:35], v32 offset:34816
    v_mfma_f32_16x16x32_bf16 v[96:99], a[0:3], a[80:83], v[96:99]
    v_mfma_f32_16x16x32_bf16 v[96:99], a[4:7], a[84:87], v[96:99]
    v_mfma_f32_16x16x32_bf16 v[112:115], a[4:7], a[92:95], v[112:115]
    ds_read_b64_tr_b16 a[36:37], v32 offset:49152
    v_mfma_f32_16x16x32_bf16 v[112:115], a[0:3], a[88:91], v[112:115]
    v_mfma_f32_16x16x32_bf16 v[128:131], a[0:3], a[96:99], v[128:131]
    v_mfma_f32_16x16x32_bf16 v[128:131], a[4:7], a[100:103], v[128:131]
    ds_read_b64_tr_b16 a[38:39], v32 offset:51200
    v_mfma_f32_16x16x32_bf16 v[144:147], a[4:7], a[108:111], v[144:147]
    v_mfma_f32_16x16x32_bf16 v[144:147], a[0:3], a[104:107], v[144:147]
    v_mfma_f32_16x16x32_bf16 a[128:131], a[0:3], a[112:115], a[128:131]
    ds_read_b64_tr_b16 a[40:41], v33 offset:32768
    v_mfma_f32_16x16x32_bf16 a[128:131], a[4:7], a[116:119], a[128:131]
    v_mfma_f32_16x16x32_bf16 a[160:163], a[4:7], a[124:127], a[160:163]
    v_mfma_f32_16x16x32_bf16 a[160:163], a[0:3], a[120:123], a[160:163]
    ds_read_b64_tr_b16 a[42:43], v33 offset:34816
    v_mfma_f32_16x16x32_bf16 a[164:167], a[8:11], a[120:123], a[164:167]
    v_mfma_f32_16x16x32_bf16 a[164:167], a[12:15], a[124:127], a[164:167]
    v_mfma_f32_16x16x32_bf16 a[132:135], a[12:15], a[116:119], a[132:135]
    ds_read_b64_tr_b16 a[44:45], v33 offset:49152
    v_mfma_f32_16x16x32_bf16 a[132:135], a[8:11], a[112:115], a[132:135]
    v_mfma_f32_16x16x32_bf16 v[240:243], a[8:11], a[104:107], v[240:243]
    v_mfma_f32_16x16x32_bf16 v[240:243], a[12:15], a[108:111], v[240:243]
    ds_read_b64_tr_b16 a[46:47], v33 offset:51200
    v_mfma_f32_16x16x32_bf16 v[224:227], a[12:15], a[100:103], v[224:227]
    v_mfma_f32_16x16x32_bf16 v[224:227], a[8:11], a[96:99], v[224:227]
    ds_read_b64_tr_b16 a[48:49], v34 offset:32768
    v_mfma_f32_16x16x32_bf16 v[208:211], a[8:11], a[88:91], v[208:211]
    v_mfma_f32_16x16x32_bf16 v[208:211], a[12:15], a[92:95], v[208:211]
    v_mfma_f32_16x16x32_bf16 v[192:195], a[12:15], a[84:87], v[192:195]
    ds_read_b64_tr_b16 a[50:51], v34 offset:34816
    v_mfma_f32_16x16x32_bf16 v[192:195], a[8:11], a[80:83], v[192:195]
    v_mfma_f32_16x16x32_bf16 v[176:179], a[8:11], a[72:75], v[176:179]
    v_mfma_f32_16x16x32_bf16 v[176:179], a[12:15], a[76:79], v[176:179]
    ds_read_b64_tr_b16 a[52:53], v34 offset:49152
    v_mfma_f32_16x16x32_bf16 v[160:163], a[12:15], a[68:71], v[160:163]
    v_mfma_f32_16x16x32_bf16 v[160:163], a[8:11], a[64:67], v[160:163]
    v_mfma_f32_16x16x32_bf16 v[68:71], a[16:19], a[64:67], v[68:71]
    ds_read_b64_tr_b16 a[54:55], v34 offset:51200
    v_mfma_f32_16x16x32_bf16 v[68:71], a[20:23], a[68:71], v[68:71]
    v_mfma_f32_16x16x32_bf16 v[84:87], a[20:23], a[76:79], v[84:87]
    v_mfma_f32_16x16x32_bf16 v[84:87], a[16:19], a[72:75], v[84:87]
    ds_read_b64_tr_b16 a[56:57], v35 offset:32768
    v_mfma_f32_16x16x32_bf16 v[100:103], a[16:19], a[80:83], v[100:103]
    v_mfma_f32_16x16x32_bf16 v[100:103], a[20:23], a[84:87], v[100:103]
    v_mfma_f32_16x16x32_bf16 v[116:119], a[20:23], a[92:95], v[116:119]
    ds_read_b64_tr_b16 a[58:59], v35 offset:34816
    v_mfma_f32_16x16x32_bf16 v[116:119], a[16:19], a[88:91], v[116:119]
    v_mfma_f32_16x16x32_bf16 v[132:135], a[16:19], a[96:99], v[132:135]
    v_mfma_f32_16x16x32_bf16 v[132:135], a[20:23], a[100:103], v[132:135]
    ds_read_b64_tr_b16 a[60:61], v35 offset:49152
    v_mfma_f32_16x16x32_bf16 v[148:151], a[20:23], a[108:111], v[148:151]
    v_mfma_f32_16x16x32_bf16 v[148:151], a[16:19], a[104:107], v[148:151]
    v_mfma_f32_16x16x32_bf16 a[136:139], a[16:19], a[112:115], a[136:139]
    ds_read_b64_tr_b16 a[62:63], v35 offset:51200
    v_mfma_f32_16x16x32_bf16 a[136:139], a[20:23], a[116:119], a[136:139]
    v_mfma_f32_16x16x32_bf16 a[168:171], a[20:23], a[124:127], a[168:171]
    v_mfma_f32_16x16x32_bf16 a[168:171], a[16:19], a[120:123], a[168:171]
    v_mfma_f32_16x16x32_bf16 a[172:175], a[24:27], a[120:123], a[172:175]
    v_mfma_f32_16x16x32_bf16 a[172:175], a[28:31], a[124:127], a[172:175]
    v_mfma_f32_16x16x32_bf16 a[140:143], a[28:31], a[116:119], a[140:143]
    v_mfma_f32_16x16x32_bf16 a[140:143], a[24:27], a[112:115], a[140:143]
    v_mfma_f32_16x16x32_bf16 v[244:247], a[24:27], a[104:107], v[244:247]
    v_mfma_f32_16x16x32_bf16 v[244:247], a[28:31], a[108:111], v[244:247]
    v_mfma_f32_16x16x32_bf16 v[228:231], a[28:31], a[100:103], v[228:231]
    v_mfma_f32_16x16x32_bf16 v[228:231], a[24:27], a[96:99], v[228:231]
    v_mfma_f32_16x16x32_bf16 v[212:215], a[24:27], a[88:91], v[212:215]
    v_mfma_f32_16x16x32_bf16 v[212:215], a[28:31], a[92:95], v[212:215]
    v_mfma_f32_16x16x32_bf16 v[196:199], a[28:31], a[84:87], v[196:199]
    v_mfma_f32_16x16x32_bf16 v[196:199], a[24:27], a[80:83], v[196:199]
    v_mfma_f32_16x16x32_bf16 v[180:183], a[24:27], a[72:75], v[180:183]
    v_mfma_f32_16x16x32_bf16 v[180:183], a[28:31], a[76:79], v[180:183]
    v_mfma_f32_16x16x32_bf16 v[164:167], a[28:31], a[68:71], v[164:167]
    v_mfma_f32_16x16x32_bf16 v[164:167], a[24:27], a[64:67], v[164:167]
    s_waitcnt vmcnt(0) lgkmcnt(0)
    s_barrier
    v_mfma_f32_16x16x32_bf16 v[72:75], a[32:35], a[64:67], v[72:75]
    v_mfma_f32_16x16x32_bf16 v[72:75], a[36:39], a[68:71], v[72:75]
    s_add_u32 m0, s48, 32768
    ds_read_b128 a[192:195], v26 offset:0
    v_mfma_f32_16x16x32_bf16 v[88:91], a[36:39], a[76:79], v[88:91]
    buffer_load_dwordx4 v10, s[16:19], s49 offen offset:0 lds
    ds_read_b64_tr_b16 a[0:1], v28 offset:0
    v_mfma_f32_16x16x32_bf16 v[88:91], a[32:35], a[72:75], v[88:91]
    ds_read_b128 a[196:199], v27 offset:0
    v_mfma_f32_16x16x32_bf16 v[104:107], a[32:35], a[80:83], v[104:107]
    buffer_load_dwordx4 v11, s[16:19], s49 offen offset:1024 lds
    v_mfma_f32_16x16x32_bf16 v[104:107], a[36:39], a[84:87], v[104:107]
    ds_read_b64_tr_b16 a[2:3], v28 offset:2048
    v_mfma_f32_16x16x32_bf16 v[120:123], a[36:39], a[92:95], v[120:123]
    v_mfma_f32_16x16x32_bf16 v[120:123], a[32:35], a[88:91], v[120:123]
    ds_read_b128 a[200:203], v26 offset:2048
    v_mfma_f32_16x16x32_bf16 v[136:139], a[32:35], a[96:99], v[136:139]
    buffer_load_dwordx4 v12, s[16:19], s49 offen offset:2048 lds
    ds_read_b64_tr_b16 a[4:5], v28 offset:16384
    v_mfma_f32_16x16x32_bf16 v[136:139], a[36:39], a[100:103], v[136:139]
    v_mfma_f32_16x16x32_bf16 v[152:155], a[36:39], a[108:111], v[152:155]
    ds_read_b128 a[204:207], v27 offset:2048
    v_mfma_f32_16x16x32_bf16 v[152:155], a[32:35], a[104:107], v[152:155]
    buffer_load_dwordx4 v13, s[16:19], s49 offen offset:3072 lds
    v_mfma_f32_16x16x32_bf16 a[144:147], a[32:35], a[112:115], a[144:147]
    ds_read_b64_tr_b16 a[6:7], v28 offset:18432
    v_mfma_f32_16x16x32_bf16 a[144:147], a[36:39], a[116:119], a[144:147]
    s_add_u32 m0, s48, 36864
    ds_read_b128 a[208:211], v26 offset:4096
    v_mfma_f32_16x16x32_bf16 a[176:179], a[36:39], a[124:127], a[176:179]
    v_mfma_f32_16x16x32_bf16 a[176:179], a[32:35], a[120:123], a[176:179]
    buffer_load_dwordx4 v14, s[16:19], s49 offen offset:0 lds
    ds_read_b64_tr_b16 a[8:9], v29 offset:0
    v_mfma_f32_16x16x32_bf16 a[180:183], a[40:43], a[120:123], a[180:183]
    v_mfma_f32_16x16x32_bf16 a[180:183], a[44:47], a[124:127], a[180:183]
    ds_read_b128 a[212:215], v27 offset:4096
    v_mfma_f32_16x16x32_bf16 a[148:151], a[44:47], a[116:119], a[148:151]
    buffer_load_dwordx4 v15, s[16:19], s49 offen offset:1024 lds
    ds_read_b64_tr_b16 a[10:11], v29 offset:2048
    v_mfma_f32_16x16x32_bf16 a[148:151], a[40:43], a[112:115], a[148:151]
    v_mfma_f32_16x16x32_bf16 v[248:251], a[40:43], a[104:107], v[248:251]
    ds_read_b128 a[216:219], v26 offset:6144
    v_mfma_f32_16x16x32_bf16 v[248:251], a[44:47], a[108:111], v[248:251]
    v_mfma_f32_16x16x32_bf16 v[232:235], a[44:47], a[100:103], v[232:235]
    buffer_load_dwordx4 v16, s[16:19], s49 offen offset:2048 lds
    ds_read_b64_tr_b16 a[12:13], v29 offset:16384
    v_mfma_f32_16x16x32_bf16 v[232:235], a[40:43], a[96:99], v[232:235]
    ds_read_b128 a[220:223], v27 offset:6144
    v_mfma_f32_16x16x32_bf16 v[216:219], a[40:43], a[88:91], v[216:219]
    v_mfma_f32_16x16x32_bf16 v[216:219], a[44:47], a[92:95], v[216:219]
    buffer_load_dwordx4 v17, s[16:19], s49 offen offset:3072 lds
    ds_read_b64_tr_b16 a[14:15], v29 offset:18432
    v_mfma_f32_16x16x32_bf16 v[200:203], a[44:47], a[84:87], v[200:203]
    ds_read_b128 a[224:227], v26 offset:8192
    v_mfma_f32_16x16x32_bf16 v[200:203], a[40:43], a[80:83], v[200:203]
    s_add_u32 s49, s49, 128
    v_mfma_f32_16x16x32_bf16 v[184:187], a[40:43], a[72:75], v[184:187]
    s_add_u32 m0, s48, 98304
    ds_read_b64_tr_b16 a[16:17], v30 offset:0
    v_mfma_f32_16x16x32_bf16 v[184:187], a[44:47], a[76:79], v[184:187]
    buffer_load_dwordx4 v18, s[20:23], s50 offen offset:0 lds
    v_mfma_f32_16x16x32_bf16 v[168:171], a[44:47], a[68:71], v[168:171]
    ds_read_b128 a[228:231], v27 offset:8192
    v_mfma_f32_16x16x32_bf16 v[168:171], a[40:43], a[64:67], v[168:171]
    ds_read_b64_tr_b16 a[18:19], v30 offset:2048
    v_mfma_f32_16x16x32_bf16 v[76:79], a[48:51], a[64:67], v[76:79]
    buffer_load_dwordx4 v19, s[20:23], s50 offen offset:1024 lds
    v_mfma_f32_16x16x32_bf16 v[76:79], a[52:55], a[68:71], v[76:79]
    ds_read_b128 a[232:235], v26 offset:10240
    v_mfma_f32_16x16x32_bf16 v[92:95], a[52:55], a[76:79], v[92:95]
    v_mfma_f32_16x16x32_bf16 v[92:95], a[48:51], a[72:75], v[92:95]
    buffer_load_dwordx4 v20, s[20:23], s50 offen offset:2048 lds
    ds_read_b64_tr_b16 a[20:21], v30 offset:16384
    v_mfma_f32_16x16x32_bf16 v[108:111], a[48:51], a[80:83], v[108:111]
    ds_read_b128 a[236:239], v27 offset:10240
    v_mfma_f32_16x16x32_bf16 v[108:111], a[52:55], a[84:87], v[108:111]
    v_mfma_f32_16x16x32_bf16 v[124:127], a[52:55], a[92:95], v[124:127]
    ds_read_b64_tr_b16 a[22:23], v30 offset:18432
    v_mfma_f32_16x16x32_bf16 v[124:127], a[48:51], a[88:91], v[124:127]
    buffer_load_dwordx4 v21, s[20:23], s50 offen offset:3072 lds
    v_mfma_f32_16x16x32_bf16 v[140:143], a[48:51], a[96:99], v[140:143]
    s_add_u32 m0, s48, 102400
    ds_read_b128 a[240:243], v26 offset:12288
    v_mfma_f32_16x16x32_bf16 v[140:143], a[52:55], a[100:103], v[140:143]
    ds_read_b64_tr_b16 a[24:25], v31 offset:0
    v_mfma_f32_16x16x32_bf16 v[156:159], a[52:55], a[108:111], v[156:159]
    buffer_load_dwordx4 v22, s[20:23], s50 offen offset:0 lds
    v_mfma_f32_16x16x32_bf16 v[156:159], a[48:51], a[104:107], v[156:159]
    ds_read_b128 a[244:247], v27 offset:12288
    v_mfma_f32_16x16x32_bf16 a[152:155], a[48:51], a[112:115], a[152:155]
    v_mfma_f32_16x16x32_bf16 a[152:155], a[52:55], a[116:119], a[152:155]
    ds_read_b64_tr_b16 a[26:27], v31 offset:2048
    v_mfma_f32_16x16x32_bf16 a[184:187], a[52:55], a[124:127], a[184:187]
    buffer_load_dwordx4 v23, s[20:23], s50 offen offset:1024 lds
    ds_read_b128 a[248:251], v26 offset:14336
    v_mfma_f32_16x16x32_bf16 a[184:187], a[48:51], a[120:123], a[184:187]
    v_mfma_f32_16x16x32_bf16 a[188:191], a[56:59], a[120:123], a[188:191]
    ds_read_b64_tr_b16 a[28:29], v31 offset:16384
    v_mfma_f32_16x16x32_bf16 a[188:191], a[60:63], a[124:127], a[188:191]
    buffer_load_dwordx4 v24, s[20:23], s50 offen offset:2048 lds
    v_mfma_f32_16x16x32_bf16 a[156:159], a[60:63], a[116:119], a[156:159]
    ds_read_b128 a[252:255], v27 offset:14336
    v_mfma_f32_16x16x32_bf16 a[156:159], a[56:59], a[112:115], a[156:159]
    ds_read_b64_tr_b16 a[30:31], v31 offset:18432
    v_mfma_f32_16x16x32_bf16 v[252:255], a[56:59], a[104:107], v[252:255]
    v_mfma_f32_16x16x32_bf16 v[252:255], a[60:63], a[108:111], v[252:255]
    buffer_load_dwordx4 v25, s[20:23], s50 offen offset:3072 lds
    v_mfma_f32_16x16x32_bf16 v[236:239], a[60:63], a[100:103], v[236:239]
    v_mfma_f32_16x16x32_bf16 v[236:239], a[56:59], a[96:99], v[236:239]
    s_add_u32 s50, s50, 0x80000
    v_mfma_f32_16x16x32_bf16 v[220:223], a[56:59], a[88:91], v[220:223]
    v_mfma_f32_16x16x32_bf16 v[220:223], a[60:63], a[92:95], v[220:223]
    s_cmp_eq_u32 s51, s53
    s_cbranch_scc1 k12_ool_22
k12_oolret_23:
    v_mfma_f32_16x16x32_bf16 v[204:207], a[60:63], a[84:87], v[204:207]
    s_cmp_eq_u32 s51, s63
    s_cbranch_scc1 k12_ool_24
k12_oolret_25:
    v_mfma_f32_16x16x32_bf16 v[204:207], a[56:59], a[80:83], v[204:207]
    s_cmp_eq_u32 s51, 5
    s_cbranch_scc1 k12_ool_26
k12_oolret_27:
    v_mfma_f32_16x16x32_bf16 v[188:191], a[56:59], a[72:75], v[188:191]
    v_mfma_f32_16x16x32_bf16 v[188:191], a[60:63], a[76:79], v[188:191]
    s_add_u32 s51, s51, 1
    v_mfma_f32_16x16x32_bf16 v[172:175], a[60:63], a[68:71], v[172:175]
    v_mfma_f32_16x16x32_bf16 v[172:175], a[56:59], a[64:67], v[172:175]
    s_waitcnt lgkmcnt(0)
    s_branch k12_loop_8
k12_last_9:
    v_mfma_f32_16x16x32_bf16 v[64:67], a[0:3], a[64:67], v[64:67]
    buffer_load_dwordx4 a[192:195], v36, s[8:11], s62 offen sc1
    v_mfma_f32_16x16x32_bf16 v[64:67], a[4:7], a[68:71], v[64:67]
    ds_read_b64_tr_b16 a[32:33], v32 offset:32768
    v_mfma_f32_16x16x32_bf16 v[160:163], a[12:15], a[68:71], v[160:163]
    buffer_load_dwordx4 a[196:199], v54, s[8:11], s62 offen sc1
    ds_read_b64_tr_b16 a[34:35], v32 offset:34816
    v_mfma_f32_16x16x32_bf16 v[160:163], a[8:11], a[64:67], v[160:163]
    v_mfma_f32_16x16x32_bf16 v[80:83], a[0:3], a[72:75], v[80:83]
    buffer_load_dwordx4 a[200:203], v37, s[8:11], s62 offen sc1
    v_mfma_f32_16x16x32_bf16 v[80:83], a[4:7], a[76:79], v[80:83]
    ds_read_b64_tr_b16 a[36:37], v32 offset:49152
    v_mfma_f32_16x16x32_bf16 v[176:179], a[12:15], a[76:79], v[176:179]
    buffer_load_dwordx4 a[204:207], v55, s[8:11], s62 offen sc1
    v_mfma_f32_16x16x32_bf16 v[176:179], a[8:11], a[72:75], v[176:179]
    s_add_u32 s62, s62, 0x20000
    buffer_load_dwordx4 a[208:211], v36, s[8:11], s62 offen sc1
    ds_read_b64_tr_b16 a[38:39], v32 offset:51200
    v_mfma_f32_16x16x32_bf16 v[96:99], a[0:3], a[80:83], v[96:99]
    v_mfma_f32_16x16x32_bf16 v[96:99], a[4:7], a[84:87], v[96:99]
    v_cvt_pk_bf16_f32 v64, v64, v65
    v_cvt_pk_bf16_f32 v65, v66, v67
    v_mfma_f32_16x16x32_bf16 v[192:195], a[12:15], a[84:87], v[192:195]
    v_cvt_pk_bf16_f32 v66, v160, v161
    v_cvt_pk_bf16_f32 v67, v162, v163
    v_mfma_f32_16x16x32_bf16 v[192:195], a[8:11], a[80:83], v[192:195]
    buffer_load_dwordx4 a[212:215], v54, s[8:11], s62 offen sc1
    ds_read_b64_tr_b16 a[40:41], v33 offset:32768
    v_mfma_f32_16x16x32_bf16 v[112:115], a[0:3], a[88:91], v[112:115]
    buffer_load_dwordx4 a[216:219], v37, s[8:11], s62 offen sc1
    ds_read_b64_tr_b16 a[42:43], v33 offset:34816
    v_mfma_f32_16x16x32_bf16 v[112:115], a[4:7], a[92:95], v[112:115]
    v_cvt_pk_bf16_f32 v80, v80, v81
    v_cvt_pk_bf16_f32 v81, v82, v83
    v_mfma_f32_16x16x32_bf16 v[208:211], a[12:15], a[92:95], v[208:211]
    v_cvt_pk_bf16_f32 v82, v176, v177
    v_cvt_pk_bf16_f32 v83, v178, v179
    v_mfma_f32_16x16x32_bf16 v[208:211], a[8:11], a[88:91], v[208:211]
    buffer_load_dwordx4 a[220:223], v55, s[8:11], s62 offen sc1
    ds_read_b64_tr_b16 a[44:45], v33 offset:49152
    v_mfma_f32_16x16x32_bf16 v[128:131], a[0:3], a[96:99], v[128:131]
    s_add_u32 s62, s62, 0x20000
    buffer_load_dwordx4 a[224:227], v36, s[8:11], s62 offen sc1
    v_mfma_f32_16x16x32_bf16 v[128:131], a[4:7], a[100:103], v[128:131]
    v_cvt_pk_bf16_f32 v96, v96, v97
    v_cvt_pk_bf16_f32 v97, v98, v99
    v_mfma_f32_16x16x32_bf16 v[224:227], a[12:15], a[100:103], v[224:227]
    buffer_load_dwordx4 a[228:231], v54, s[8:11], s62 offen sc1
    ds_read_b64_tr_b16 a[46:47], v33 offset:51200
    v_mfma_f32_16x16x32_bf16 v[224:227], a[8:11], a[96:99], v[224:227]
    v_cvt_pk_bf16_f32 v98, v192, v193
    v_cvt_pk_bf16_f32 v99, v194, v195
    v_mfma_f32_16x16x32_bf16 v[144:147], a[0:3], a[104:107], v[144:147]
    buffer_load_dwordx4 a[232:235], v37, s[8:11], s62 offen sc1
    ds_read_b64_tr_b16 a[48:49], v34 offset:32768
    v_mfma_f32_16x16x32_bf16 v[144:147], a[4:7], a[108:111], v[144:147]
    v_cvt_pk_bf16_f32 v112, v112, v113
    v_cvt_pk_bf16_f32 v113, v114, v115
    v_mfma_f32_16x16x32_bf16 v[240:243], a[12:15], a[108:111], v[240:243]
    buffer_load_dwordx4 a[236:239], v55, s[8:11], s62 offen sc1
    ds_read_b64_tr_b16 a[50:51], v34 offset:34816
    v_mfma_f32_16x16x32_bf16 v[240:243], a[8:11], a[104:107], v[240:243]
    s_add_u32 s62, s62, 0x20000
    v_cvt_pk_bf16_f32 v114, v208, v209
    v_cvt_pk_bf16_f32 v115, v210, v211
    v_mfma_f32_16x16x32_bf16 a[128:131], a[0:3], a[112:115], a[128:131]
    buffer_load_dwordx4 a[240:243], v36, s[8:11], s62 offen sc1
    ds_read_b64_tr_b16 a[52:53], v34 offset:49152
    v_mfma_f32_16x16x32_bf16 a[128:131], a[4:7], a[116:119], a[128:131]
    v_cvt_pk_bf16_f32 v128, v128, v129
    v_cvt_pk_bf16_f32 v129, v130, v131
    v_mfma_f32_16x16x32_bf16 a[132:135], a[12:15], a[116:119], a[132:135]
    buffer_load_dwordx4 a[244:247], v54, s[8:11], s62 offen sc1
    buffer_load_dwordx4 a[248:251], v37, s[8:11], s62 offen sc1
    v_mfma_f32_16x16x32_bf16 a[132:135], a[8:11], a[112:115], a[132:135]
    v_cvt_pk_bf16_f32 v130, v224, v225
    v_cvt_pk_bf16_f32 v131, v226, v227
    v_mfma_f32_16x16x32_bf16 a[160:163], a[0:3], a[120:123], a[160:163]
    buffer_load_dwordx4 a[252:255], v55, s[8:11], s62 offen sc1
    ds_read_b64_tr_b16 a[54:55], v34 offset:51200
    v_mfma_f32_16x16x32_bf16 a[160:163], a[4:7], a[124:127], a[160:163]
    s_add_u32 s62, s62, 0x20000
    v_cvt_pk_bf16_f32 v144, v144, v145
    v_cvt_pk_bf16_f32 v145, v146, v147
    v_mfma_f32_16x16x32_bf16 a[164:167], a[12:15], a[124:127], a[164:167]
    ds_read_b64_tr_b16 a[56:57], v35 offset:32768
    v_cvt_pk_bf16_f32 v146, v240, v241
    v_mfma_f32_16x16x32_bf16 a[164:167], a[8:11], a[120:123], a[164:167]
    v_cvt_pk_bf16_f32 v147, v242, v243
    v_mfma_f32_16x16x32_bf16 v[68:71], a[16:19], a[64:67], v[68:71]
    s_add_u32 s52, s47, 0
    ds_read_b64_tr_b16 a[58:59], v35 offset:34816
    v_mfma_f32_16x16x32_bf16 v[68:71], a[20:23], a[68:71], v[68:71]
    v_accvgpr_read_b32 v56, a128
    v_accvgpr_read_b32 v57, a129
    v_mfma_f32_16x16x32_bf16 v[164:167], a[28:31], a[68:71], v[164:167]
    v_accvgpr_read_b32 v58, a130
    v_accvgpr_read_b32 v59, a131
    v_mfma_f32_16x16x32_bf16 v[164:167], a[24:27], a[64:67], v[164:167]
    buffer_store_dwordx4 v[64:67], v1, s[32:35], s52 offen offset:0 sc1
    ds_read_b64_tr_b16 a[60:61], v35 offset:49152
    v_mfma_f32_16x16x32_bf16 v[84:87], a[16:19], a[72:75], v[84:87]
    v_accvgpr_read_b32 v60, a132
    v_accvgpr_read_b32 v61, a133
    v_mfma_f32_16x16x32_bf16 v[84:87], a[20:23], a[76:79], v[84:87]
    v_accvgpr_read_b32 v62, a134
    v_accvgpr_read_b32 v63, a135
    v_mfma_f32_16x16x32_bf16 v[180:183], a[28:31], a[76:79], v[180:183]
    v_cvt_pk_bf16_f32 v160, v56, v57
    v_cvt_pk_bf16_f32 v161, v58, v59
    v_mfma_f32_16x16x32_bf16 v[180:183], a[24:27], a[72:75], v[180:183]
    ds_read_b64_tr_b16 a[62:63], v35 offset:51200
    v_cvt_pk_bf16_f32 v162, v60, v61
    v_mfma_f32_16x16x32_bf16 v[100:103], a[16:19], a[80:83], v[100:103]
    v_cvt_pk_bf16_f32 v163, v62, v63
    v_accvgpr_read_b32 v56, a160
    v_mfma_f32_16x16x32_bf16 v[100:103], a[20:23], a[84:87], v[100:103]
    v_accvgpr_read_b32 v57, a161
    v_accvgpr_read_b32 v58, a162
    v_mfma_f32_16x16x32_bf16 v[196:199], a[28:31], a[84:87], v[196:199]
    v_accvgpr_read_b32 v59, a163
    v_accvgpr_read_b32 v60, a164
    v_mfma_f32_16x16x32_bf16 v[196:199], a[24:27], a[80:83], v[196:199]
    s_add_u32 s52, s47, 8192
    v_accvgpr_read_b32 v61, a165
    v_accvgpr_read_b32 v62, a166
    v_mfma_f32_16x16x32_bf16 v[116:119], a[16:19], a[88:91], v[116:119]
    v_accvgpr_read_b32 v63, a167
    v_cvt_pk_bf16_f32 v176, v56, v57
    v_mfma_f32_16x16x32_bf16 v[116:119], a[20:23], a[92:95], v[116:119]
    v_cvt_pk_bf16_f32 v177, v58, v59
    v_cvt_pk_bf16_f32 v68, v68, v69
    v_mfma_f32_16x16x32_bf16 v[212:215], a[28:31], a[92:95], v[212:215]
    v_cvt_pk_bf16_f32 v178, v60, v61
    v_cvt_pk_bf16_f32 v69, v70, v71
    v_mfma_f32_16x16x32_bf16 v[212:215], a[24:27], a[88:91], v[212:215]
    v_cvt_pk_bf16_f32 v179, v62, v63
    v_cvt_pk_bf16_f32 v70, v164, v165
    v_mfma_f32_16x16x32_bf16 v[132:135], a[16:19], a[96:99], v[132:135]
    v_cvt_pk_bf16_f32 v71, v166, v167
    v_cvt_pk_bf16_f32 v84, v84, v85
    v_mfma_f32_16x16x32_bf16 v[132:135], a[20:23], a[100:103], v[132:135]
    buffer_store_dwordx4 v[96:99], v1, s[32:35], s52 offen offset:0 sc1
    v_cvt_pk_bf16_f32 v85, v86, v87
    v_mfma_f32_16x16x32_bf16 v[228:231], a[28:31], a[100:103], v[228:231]
    v_cvt_pk_bf16_f32 v86, v180, v181
    v_cvt_pk_bf16_f32 v87, v182, v183
    v_mfma_f32_16x16x32_bf16 v[228:231], a[24:27], a[96:99], v[228:231]
    v_cvt_pk_bf16_f32 v100, v100, v101
    v_cvt_pk_bf16_f32 v101, v102, v103
    v_mfma_f32_16x16x32_bf16 v[148:151], a[16:19], a[104:107], v[148:151]
    v_cvt_pk_bf16_f32 v102, v196, v197
    v_cvt_pk_bf16_f32 v103, v198, v199
    v_mfma_f32_16x16x32_bf16 v[148:151], a[20:23], a[108:111], v[148:151]
    v_cvt_pk_bf16_f32 v116, v116, v117
    v_cvt_pk_bf16_f32 v117, v118, v119
    v_mfma_f32_16x16x32_bf16 v[244:247], a[28:31], a[108:111], v[244:247]
    v_cvt_pk_bf16_f32 v118, v212, v213
    v_cvt_pk_bf16_f32 v119, v214, v215
    v_mfma_f32_16x16x32_bf16 v[244:247], a[24:27], a[104:107], v[244:247]
    s_add_u32 s52, s47, 524288
    v_mfma_f32_16x16x32_bf16 a[136:139], a[16:19], a[112:115], a[136:139]
    buffer_store_dwordx4 v[128:131], v1, s[32:35], s52 offen offset:0 sc1
    v_mfma_f32_16x16x32_bf16 a[136:139], a[20:23], a[116:119], a[136:139]
    v_cvt_pk_bf16_f32 v132, v132, v133
    v_cvt_pk_bf16_f32 v133, v134, v135
    v_mfma_f32_16x16x32_bf16 a[140:143], a[28:31], a[116:119], a[140:143]
    v_cvt_pk_bf16_f32 v134, v228, v229
    v_cvt_pk_bf16_f32 v135, v230, v231
    v_mfma_f32_16x16x32_bf16 a[140:143], a[24:27], a[112:115], a[140:143]
    v_mfma_f32_16x16x32_bf16 a[168:171], a[16:19], a[120:123], a[168:171]
    s_waitcnt lgkmcnt(0)
    v_mfma_f32_16x16x32_bf16 a[168:171], a[20:23], a[124:127], a[168:171]
    v_cvt_pk_bf16_f32 v148, v148, v149
    v_cvt_pk_bf16_f32 v149, v150, v151
    v_mfma_f32_16x16x32_bf16 a[172:175], a[28:31], a[124:127], a[172:175]
    v_cvt_pk_bf16_f32 v150, v244, v245
    v_cvt_pk_bf16_f32 v151, v246, v247
    v_mfma_f32_16x16x32_bf16 a[172:175], a[24:27], a[120:123], a[172:175]
    v_mfma_f32_16x16x32_bf16 v[72:75], a[32:35], a[64:67], v[72:75]
    v_mfma_f32_16x16x32_bf16 v[72:75], a[36:39], a[68:71], v[72:75]
    v_accvgpr_read_b32 v56, a136
    v_accvgpr_read_b32 v57, a137
    v_mfma_f32_16x16x32_bf16 v[168:171], a[44:47], a[68:71], v[168:171]
    s_add_u32 s52, s47, 532480
    v_accvgpr_read_b32 v58, a138
    v_accvgpr_read_b32 v59, a139
    v_mfma_f32_16x16x32_bf16 v[168:171], a[40:43], a[64:67], v[168:171]
    v_accvgpr_read_b32 v60, a140
    v_accvgpr_read_b32 v61, a141
    v_mfma_f32_16x16x32_bf16 v[88:91], a[32:35], a[72:75], v[88:91]
    v_accvgpr_read_b32 v62, a142
    v_accvgpr_read_b32 v63, a143
    v_mfma_f32_16x16x32_bf16 v[88:91], a[36:39], a[76:79], v[88:91]
    v_cvt_pk_bf16_f32 v164, v56, v57
    v_cvt_pk_bf16_f32 v165, v58, v59
    v_mfma_f32_16x16x32_bf16 v[184:187], a[44:47], a[76:79], v[184:187]
    buffer_store_dwordx4 v[160:163], v1, s[32:35], s52 offen offset:0 sc1
    v_mfma_f32_16x16x32_bf16 v[184:187], a[40:43], a[72:75], v[184:187]
    v_cvt_pk_bf16_f32 v166, v60, v61
    v_cvt_pk_bf16_f32 v167, v62, v63
    v_mfma_f32_16x16x32_bf16 v[104:107], a[32:35], a[80:83], v[104:107]
    v_accvgpr_read_b32 v56, a168
    v_accvgpr_read_b32 v57, a169
    v_mfma_f32_16x16x32_bf16 v[104:107], a[36:39], a[84:87], v[104:107]
    v_accvgpr_read_b32 v58, a170
    v_accvgpr_read_b32 v59, a171
    v_mfma_f32_16x16x32_bf16 v[200:203], a[44:47], a[84:87], v[200:203]
    v_accvgpr_read_b32 v60, a172
    v_accvgpr_read_b32 v61, a173
    v_mfma_f32_16x16x32_bf16 v[200:203], a[40:43], a[80:83], v[200:203]
    v_accvgpr_read_b32 v62, a174
    v_accvgpr_read_b32 v63, a175
    v_mfma_f32_16x16x32_bf16 v[120:123], a[32:35], a[88:91], v[120:123]
    v_cvt_pk_bf16_f32 v180, v56, v57
    v_cvt_pk_bf16_f32 v181, v58, v59
    v_mfma_f32_16x16x32_bf16 v[120:123], a[36:39], a[92:95], v[120:123]
    v_cvt_pk_bf16_f32 v72, v72, v73
    v_cvt_pk_bf16_f32 v182, v60, v61
    v_mfma_f32_16x16x32_bf16 v[216:219], a[44:47], a[92:95], v[216:219]
    s_add_u32 s52, s47, 0
    v_cvt_pk_bf16_f32 v73, v74, v75
    v_cvt_pk_bf16_f32 v183, v62, v63
    v_mfma_f32_16x16x32_bf16 v[216:219], a[40:43], a[88:91], v[216:219]
    v_cvt_pk_bf16_f32 v74, v168, v169
    v_cvt_pk_bf16_f32 v75, v170, v171
    v_mfma_f32_16x16x32_bf16 v[136:139], a[32:35], a[96:99], v[136:139]
    v_cvt_pk_bf16_f32 v88, v88, v89
    v_cvt_pk_bf16_f32 v89, v90, v91
    v_mfma_f32_16x16x32_bf16 v[136:139], a[36:39], a[100:103], v[136:139]
    v_cvt_pk_bf16_f32 v90, v184, v185
    v_cvt_pk_bf16_f32 v91, v186, v187
    v_mfma_f32_16x16x32_bf16 v[232:235], a[44:47], a[100:103], v[232:235]
    buffer_store_dwordx4 v[68:71], v1, s[32:35], s52 offen offset:1024 sc1
    v_mfma_f32_16x16x32_bf16 v[232:235], a[40:43], a[96:99], v[232:235]
    v_cvt_pk_bf16_f32 v104, v104, v105
    v_cvt_pk_bf16_f32 v105, v106, v107
    v_mfma_f32_16x16x32_bf16 v[152:155], a[32:35], a[104:107], v[152:155]
    v_cvt_pk_bf16_f32 v106, v200, v201
    v_cvt_pk_bf16_f32 v107, v202, v203
    v_mfma_f32_16x16x32_bf16 v[152:155], a[36:39], a[108:111], v[152:155]
    v_cvt_pk_bf16_f32 v120, v120, v121
    v_cvt_pk_bf16_f32 v121, v122, v123
    v_mfma_f32_16x16x32_bf16 v[248:251], a[44:47], a[108:111], v[248:251]
    v_cvt_pk_bf16_f32 v122, v216, v217
    v_cvt_pk_bf16_f32 v123, v218, v219
    v_mfma_f32_16x16x32_bf16 v[248:251], a[40:43], a[104:107], v[248:251]
    v_mfma_f32_16x16x32_bf16 a[144:147], a[32:35], a[112:115], a[144:147]
    v_mfma_f32_16x16x32_bf16 a[144:147], a[36:39], a[116:119], a[144:147]
    s_add_u32 s52, s47, 8192
    v_cvt_pk_bf16_f32 v136, v136, v137
    v_cvt_pk_bf16_f32 v137, v138, v139
    v_mfma_f32_16x16x32_bf16 a[148:151], a[44:47], a[116:119], a[148:151]
    v_cvt_pk_bf16_f32 v138, v232, v233
    v_cvt_pk_bf16_f32 v139, v234, v235
    v_mfma_f32_16x16x32_bf16 a[148:151], a[40:43], a[112:115], a[148:151]
    buffer_store_dwordx4 v[100:103], v1, s[32:35], s52 offen offset:1024 sc1
    v_mfma_f32_16x16x32_bf16 a[176:179], a[32:35], a[120:123], a[176:179]
    v_mfma_f32_16x16x32_bf16 a[176:179], a[36:39], a[124:127], a[176:179]
    v_cvt_pk_bf16_f32 v152, v152, v153
    v_cvt_pk_bf16_f32 v153, v154, v155
    v_mfma_f32_16x16x32_bf16 a[180:183], a[44:47], a[124:127], a[180:183]
    v_cvt_pk_bf16_f32 v154, v248, v249
    v_cvt_pk_bf16_f32 v155, v250, v251
    v_mfma_f32_16x16x32_bf16 a[180:183], a[40:43], a[120:123], a[180:183]
    v_mfma_f32_16x16x32_bf16 v[76:79], a[48:51], a[64:67], v[76:79]
    s_waitcnt vmcnt(16)
    s_barrier
    v_mfma_f32_16x16x32_bf16 v[76:79], a[52:55], a[68:71], v[76:79]
    ds_read_b64_tr_b16 a[0:1], v42 offset:32768
    v_accvgpr_read_b32 v56, a144
    v_mfma_f32_16x16x32_bf16 v[172:175], a[60:63], a[68:71], v[172:175]
    v_accvgpr_read_b32 v57, a145
    v_accvgpr_read_b32 v58, a146
    v_mfma_f32_16x16x32_bf16 v[172:175], a[56:59], a[64:67], v[172:175]
    ds_read_b64_tr_b16 a[2:3], v42 offset:33792
    v_accvgpr_read_b32 v59, a147
    v_mfma_f32_16x16x32_bf16 v[92:95], a[48:51], a[72:75], v[92:95]
    v_accvgpr_read_b32 v60, a148
    v_accvgpr_read_b32 v61, a149
    v_mfma_f32_16x16x32_bf16 v[92:95], a[52:55], a[76:79], v[92:95]
    s_add_u32 s52, s47, 524288
    ds_read_b64_tr_b16 a[4:5], v42 offset:40960
    v_accvgpr_read_b32 v62, a150
    v_mfma_f32_16x16x32_bf16 v[188:191], a[60:63], a[76:79], v[188:191]
    v_accvgpr_read_b32 v63, a151
    v_cvt_pk_bf16_f32 v168, v56, v57
    v_mfma_f32_16x16x32_bf16 v[188:191], a[56:59], a[72:75], v[188:191]
    v_cvt_pk_bf16_f32 v169, v58, v59
    v_cvt_pk_bf16_f32 v170, v60, v61
    v_mfma_f32_16x16x32_bf16 v[108:111], a[48:51], a[80:83], v[108:111]
    ds_read_b64_tr_b16 a[6:7], v42 offset:41984
    v_cvt_pk_bf16_f32 v171, v62, v63
    v_mfma_f32_16x16x32_bf16 v[108:111], a[52:55], a[84:87], v[108:111]
    v_accvgpr_read_b32 v56, a176
    v_accvgpr_read_b32 v57, a177
    v_mfma_f32_16x16x32_bf16 v[204:207], a[60:63], a[84:87], v[204:207]
    v_accvgpr_read_b32 v58, a178
    v_accvgpr_read_b32 v59, a179
    v_mfma_f32_16x16x32_bf16 v[204:207], a[56:59], a[80:83], v[204:207]
    ds_read_b64_tr_b16 a[8:9], v43 offset:32768
    v_accvgpr_read_b32 v60, a180
    v_mfma_f32_16x16x32_bf16 v[124:127], a[48:51], a[88:91], v[124:127]
    buffer_store_dwordx4 v[132:135], v1, s[32:35], s52 offen offset:1024 sc1
    v_accvgpr_read_b32 v61, a181
    v_mfma_f32_16x16x32_bf16 v[124:127], a[52:55], a[92:95], v[124:127]
    v_accvgpr_read_b32 v62, a182
    v_accvgpr_read_b32 v63, a183
    v_mfma_f32_16x16x32_bf16 v[220:223], a[60:63], a[92:95], v[220:223]
    ds_read_b64_tr_b16 a[10:11], v43 offset:33792
    v_cvt_pk_bf16_f32 v184, v56, v57
    v_mfma_f32_16x16x32_bf16 v[220:223], a[56:59], a[88:91], v[220:223]
    v_cvt_pk_bf16_f32 v185, v58, v59
    v_cvt_pk_bf16_f32 v76, v76, v77
    v_mfma_f32_16x16x32_bf16 v[140:143], a[48:51], a[96:99], v[140:143]
    s_add_u32 s52, s47, 532480
    v_cvt_pk_bf16_f32 v186, v60, v61
    v_cvt_pk_bf16_f32 v77, v78, v79
    v_mfma_f32_16x16x32_bf16 v[140:143], a[52:55], a[100:103], v[140:143]
    ds_read_b64_tr_b16 a[12:13], v43 offset:40960
    v_cvt_pk_bf16_f32 v187, v62, v63
    v_mfma_f32_16x16x32_bf16 v[236:239], a[60:63], a[100:103], v[236:239]
    v_cvt_pk_bf16_f32 v78, v172, v173
    v_cvt_pk_bf16_f32 v79, v174, v175
    v_mfma_f32_16x16x32_bf16 v[236:239], a[56:59], a[96:99], v[236:239]
    ds_read_b64_tr_b16 a[14:15], v43 offset:41984
    ds_read_b64_tr_b16 a[16:17], v44 offset:32768
    v_mfma_f32_16x16x32_bf16 v[156:159], a[48:51], a[104:107], v[156:159]
    v_cvt_pk_bf16_f32 v92, v92, v93
    v_cvt_pk_bf16_f32 v93, v94, v95
    v_mfma_f32_16x16x32_bf16 v[156:159], a[52:55], a[108:111], v[156:159]
    ds_read_b64_tr_b16 a[18:19], v44 offset:33792
    v_cvt_pk_bf16_f32 v94, v188, v189
    v_mfma_f32_16x16x32_bf16 v[252:255], a[60:63], a[108:111], v[252:255]
    ds_read_b64_tr_b16 a[20:21], v44 offset:40960
    v_cvt_pk_bf16_f32 v95, v190, v191
    v_mfma_f32_16x16x32_bf16 v[252:255], a[56:59], a[104:107], v[252:255]
    ds_read_b64_tr_b16 a[22:23], v44 offset:41984
    v_cvt_pk_bf16_f32 v108, v108, v109
    v_mfma_f32_16x16x32_bf16 a[152:155], a[48:51], a[112:115], a[152:155]
    v_cvt_pk_bf16_f32 v109, v110, v111
    v_cvt_pk_bf16_f32 v110, v204, v205
    v_mfma_f32_16x16x32_bf16 a[152:155], a[52:55], a[116:119], a[152:155]
    ds_read_b64_tr_b16 a[24:25], v45 offset:32768
    v_cvt_pk_bf16_f32 v111, v206, v207
    v_mfma_f32_16x16x32_bf16 a[156:159], a[60:63], a[116:119], a[156:159]
    buffer_store_dwordx4 v[164:167], v1, s[32:35], s52 offen offset:1024 sc1
    ds_read_b64_tr_b16 a[26:27], v45 offset:33792
    v_mfma_f32_16x16x32_bf16 a[156:159], a[56:59], a[112:115], a[156:159]
    ds_read_b64_tr_b16 a[28:29], v45 offset:40960
    v_cvt_pk_bf16_f32 v124, v124, v125
    v_mfma_f32_16x16x32_bf16 a[184:187], a[48:51], a[120:123], a[184:187]
    v_cvt_pk_bf16_f32 v125, v126, v127
    v_cvt_pk_bf16_f32 v126, v220, v221
    v_mfma_f32_16x16x32_bf16 a[184:187], a[52:55], a[124:127], a[184:187]
    ds_read_b64_tr_b16 a[30:31], v45 offset:41984
    v_cvt_pk_bf16_f32 v127, v222, v223
    v_mfma_f32_16x16x32_bf16 a[188:191], a[60:63], a[124:127], a[188:191]
    v_cvt_pk_bf16_f32 v140, v140, v141
    v_cvt_pk_bf16_f32 v141, v142, v143
    v_mfma_f32_16x16x32_bf16 a[188:191], a[56:59], a[120:123], a[188:191]
    v_cvt_pk_bf16_f32 v142, v236, v237
    v_cvt_pk_bf16_f32 v143, v238, v239
    v_cvt_pk_bf16_f32 v156, v156, v157
    v_cvt_pk_bf16_f32 v157, v158, v159
    v_cvt_pk_bf16_f32 v158, v252, v253
    v_cvt_pk_bf16_f32 v159, v254, v255
    v_accvgpr_read_b32 v56, a152
    v_accvgpr_read_b32 v57, a153
    v_accvgpr_read_b32 v58, a154
    v_accvgpr_read_b32 v59, a155
    v_accvgpr_read_b32 v60, a156
    v_accvgpr_read_b32 v61, a157
    v_accvgpr_read_b32 v62, a158
    v_accvgpr_read_b32 v63, a159
    v_cvt_pk_bf16_f32 v172, v56, v57
    v_cvt_pk_bf16_f32 v173, v58, v59
    v_cvt_pk_bf16_f32 v174, v60, v61
    v_cvt_pk_bf16_f32 v175, v62, v63
    v_accvgpr_read_b32 v56, a184
    v_accvgpr_read_b32 v57, a185
    v_accvgpr_read_b32 v58, a186
    v_accvgpr_read_b32 v59, a187
    v_accvgpr_read_b32 v60, a188
    v_accvgpr_read_b32 v61, a189
    v_accvgpr_read_b32 v62, a190
    v_accvgpr_read_b32 v63, a191
    v_cvt_pk_bf16_f32 v188, v56, v57
    v_cvt_pk_bf16_f32 v189, v58, v59
    v_cvt_pk_bf16_f32 v190, v60, v61
    v_cvt_pk_bf16_f32 v191, v62, v63
    s_branch k12_join_7
k12_v_6:
k12_loop_28:
    v_mfma_f32_16x16x32_bf16 v[64:67], a[192:195], a[0:3], v[64:67]
    v_mfma_f32_16x16x32_bf16 v[64:67], a[196:199], a[4:7], v[64:67]
    ds_read_b64_tr_b16 a[32:33], v32 offset:0
    v_mfma_f32_16x16x32_bf16 v[160:163], a[204:207], a[4:7], v[160:163]
    v_mfma_f32_16x16x32_bf16 v[160:163], a[200:203], a[0:3], v[160:163]
    ds_read_b64_tr_b16 a[34:35], v32 offset:2048
    v_mfma_f32_16x16x32_bf16 v[96:99], a[208:211], a[0:3], v[96:99]
    s_cmp_eq_u32 s51, s46
    s_cbranch_scc1 k12_ool_30
k12_oolret_31:
    v_mfma_f32_16x16x32_bf16 v[96:99], a[212:215], a[4:7], v[96:99]
    v_mfma_f32_16x16x32_bf16 v[192:195], a[220:223], a[4:7], v[192:195]
    ds_read_b64_tr_b16 a[36:37], v32 offset:16384
    v_mfma_f32_16x16x32_bf16 v[192:195], a[216:219], a[0:3], v[192:195]
    v_mfma_f32_16x16x32_bf16 v[128:131], a[224:227], a[0:3], v[128:131]
    v_mfma_f32_16x16x32_bf16 v[128:131], a[228:231], a[4:7], v[128:131]
    ds_read_b64_tr_b16 a[38:39], v32 offset:18432
    v_mfma_f32_16x16x32_bf16 v[224:227], a[236:239], a[4:7], v[224:227]
    v_mfma_f32_16x16x32_bf16 v[224:227], a[232:235], a[0:3], v[224:227]
    v_mfma_f32_16x16x32_bf16 a[128:131], a[240:243], a[0:3], a[128:131]
    ds_read_b64_tr_b16 a[40:41], v33 offset:0
    v_mfma_f32_16x16x32_bf16 a[128:131], a[244:247], a[4:7], a[128:131]
    v_mfma_f32_16x16x32_bf16 a[132:135], a[252:255], a[4:7], a[132:135]
    v_mfma_f32_16x16x32_bf16 a[132:135], a[248:251], a[0:3], a[132:135]
    ds_read_b64_tr_b16 a[42:43], v33 offset:2048
    v_mfma_f32_16x16x32_bf16 a[140:143], a[248:251], a[8:11], a[140:143]
    v_mfma_f32_16x16x32_bf16 a[140:143], a[252:255], a[12:15], a[140:143]
    v_mfma_f32_16x16x32_bf16 a[136:139], a[244:247], a[12:15], a[136:139]
    ds_read_b64_tr_b16 a[44:45], v33 offset:16384
    v_mfma_f32_16x16x32_bf16 a[136:139], a[240:243], a[8:11], a[136:139]
    v_mfma_f32_16x16x32_bf16 v[228:231], a[232:235], a[8:11], v[228:231]
    v_mfma_f32_16x16x32_bf16 v[228:231], a[236:239], a[12:15], v[228:231]
    ds_read_b64_tr_b16 a[46:47], v33 offset:18432
    v_mfma_f32_16x16x32_bf16 v[132:135], a[228:231], a[12:15], v[132:135]
    v_mfma_f32_16x16x32_bf16 v[132:135], a[224:227], a[8:11], v[132:135]
    ds_read_b64_tr_b16 a[48:49], v34 offset:0
    v_mfma_f32_16x16x32_bf16 v[196:199], a[216:219], a[8:11], v[196:199]
    v_mfma_f32_16x16x32_bf16 v[196:199], a[220:223], a[12:15], v[196:199]
    v_mfma_f32_16x16x32_bf16 v[100:103], a[212:215], a[12:15], v[100:103]
    ds_read_b64_tr_b16 a[50:51], v34 offset:2048
    v_mfma_f32_16x16x32_bf16 v[100:103], a[208:211], a[8:11], v[100:103]
    v_mfma_f32_16x16x32_bf16 v[164:167], a[200:203], a[8:11], v[164:167]
    v_mfma_f32_16x16x32_bf16 v[164:167], a[204:207], a[12:15], v[164:167]
    ds_read_b64_tr_b16 a[52:53], v34 offset:16384
    v_mfma_f32_16x16x32_bf16 v[68:71], a[196:199], a[12:15], v[68:71]
    v_mfma_f32_16x16x32_bf16 v[68:71], a[192:195], a[8:11], v[68:71]
    v_mfma_f32_16x16x32_bf16 v[72:75], a[192:195], a[16:19], v[72:75]
    ds_read_b64_tr_b16 a[54:55], v34 offset:18432
    v_mfma_f32_16x16x32_bf16 v[72:75], a[196:199], a[20:23], v[72:75]
    v_mfma_f32_16x16x32_bf16 v[168:171], a[204:207], a[20:23], v[168:171]
    v_mfma_f32_16x16x32_bf16 v[168:171], a[200:203], a[16:19], v[168:171]
    ds_read_b64_tr_b16 a[56:57], v35 offset:0
    v_mfma_f32_16x16x32_bf16 v[104:107], a[208:211], a[16:19], v[104:107]
    v_mfma_f32_16x16x32_bf16 v[104:107], a[212:215], a[20:23], v[104:107]
    v_mfma_f32_16x16x32_bf16 v[200:203], a[220:223], a[20:23], v[200:203]
    ds_read_b64_tr_b16 a[58:59], v35 offset:2048
    v_mfma_f32_16x16x32_bf16 v[200:203], a[216:219], a[16:19], v[200:203]
    v_mfma_f32_16x16x32_bf16 v[136:139], a[224:227], a[16:19], v[136:139]
    v_mfma_f32_16x16x32_bf16 v[136:139], a[228:231], a[20:23], v[136:139]
    ds_read_b64_tr_b16 a[60:61], v35 offset:16384
    v_mfma_f32_16x16x32_bf16 v[232:235], a[236:239], a[20:23], v[232:235]
    v_mfma_f32_16x16x32_bf16 v[232:235], a[232:235], a[16:19], v[232:235]
    v_mfma_f32_16x16x32_bf16 a[144:147], a[240:243], a[16:19], a[144:147]
    ds_read_b64_tr_b16 a[62:63], v35 offset:18432
    v_mfma_f32_16x16x32_bf16 a[144:147], a[244:247], a[20:23], a[144:147]
    v_mfma_f32_16x16x32_bf16 a[148:151], a[252:255], a[20:23], a[148:151]
    v_mfma_f32_16x16x32_bf16 a[148:151], a[248:251], a[16:19], a[148:151]
    v_mfma_f32_16x16x32_bf16 a[156:159], a[248:251], a[24:27], a[156:159]
    v_mfma_f32_16x16x32_bf16 a[156:159], a[252:255], a[28:31], a[156:159]
    v_mfma_f32_16x16x32_bf16 a[152:155], a[244:247], a[28:31], a[152:155]
    v_mfma_f32_16x16x32_bf16 a[152:155], a[240:243], a[24:27], a[152:155]
    v_mfma_f32_16x16x32_bf16 v[236:239], a[232:235], a[24:27], v[236:239]
    v_mfma_f32_16x16x32_bf16 v[236:239], a[236:239], a[28:31], v[236:239]
    v_mfma_f32_16x16x32_bf16 v[140:143], a[228:231], a[28:31], v[140:143]
    v_mfma_f32_16x16x32_bf16 v[140:143], a[224:227], a[24:27], v[140:143]
    v_mfma_f32_16x16x32_bf16 v[204:207], a[216:219], a[24:27], v[204:207]
    v_mfma_f32_16x16x32_bf16 v[204:207], a[220:223], a[28:31], v[204:207]
    v_mfma_f32_16x16x32_bf16 v[108:111], a[212:215], a[28:31], v[108:111]
    v_mfma_f32_16x16x32_bf16 v[108:111], a[208:211], a[24:27], v[108:111]
    v_mfma_f32_16x16x32_bf16 v[172:175], a[200:203], a[24:27], v[172:175]
    v_mfma_f32_16x16x32_bf16 v[172:175], a[204:207], a[28:31], v[172:175]
    v_mfma_f32_16x16x32_bf16 v[76:79], a[196:199], a[28:31], v[76:79]
    v_mfma_f32_16x16x32_bf16 v[76:79], a[192:195], a[24:27], v[76:79]
    s_waitcnt vmcnt(0) lgkmcnt(0)
    s_cmp_eq_u32 s51, s46
    s_cbranch_scc1 k12_ool_34
k12_oolret_35:
    s_barrier
    v_mfma_f32_16x16x32_bf16 v[80:83], a[192:195], a[32:35], v[80:83]
    s_cmp_ge_u32 s49, 1024
    s_cselect_b32 s18, 0, s18
    s_cselect_b32 s22, 0, s22
    v_mfma_f32_16x16x32_bf16 v[80:83], a[196:199], a[36:39], v[80:83]
    s_add_u32 m0, s48, 0
    ds_read_b128 a[64:67], v26 offset:32768
    v_mfma_f32_16x16x32_bf16 v[176:179], a[204:207], a[36:39], v[176:179]
    buffer_load_dwordx4 v10, s[16:19], s49 offen offset:0 lds
    ds_read_b64_tr_b16 a[0:1], v28 offset:32768
    v_mfma_f32_16x16x32_bf16 v[176:179], a[200:203], a[32:35], v[176:179]
    ds_read_b128 a[68:71], v27 offset:32768
    v_mfma_f32_16x16x32_bf16 v[112:115], a[208:211], a[32:35], v[112:115]
    buffer_load_dwordx4 v11, s[16:19], s49 offen offset:1024 lds
    v_mfma_f32_16x16x32_bf16 v[112:115], a[212:215], a[36:39], v[112:115]
    ds_read_b64_tr_b16 a[2:3], v28 offset:34816
    v_mfma_f32_16x16x32_bf16 v[208:211], a[220:223], a[36:39], v[208:211]
    v_mfma_f32_16x16x32_bf16 v[208:211], a[216:219], a[32:35], v[208:211]
    ds_read_b128 a[72:75], v26 offset:34816
    v_mfma_f32_16x16x32_bf16 v[144:147], a[224:227], a[32:35], v[144:147]
    buffer_load_dwordx4 v12, s[16:19], s49 offen offset:2048 lds
    ds_read_b64_tr_b16 a[4:5], v28 offset:49152
    v_mfma_f32_16x16x32_bf16 v[144:147], a[228:231], a[36:39], v[144:147]
    v_mfma_f32_16x16x32_bf16 v[240:243], a[236:239], a[36:39], v[240:243]
    ds_read_b128 a[76:79], v27 offset:34816
    v_mfma_f32_16x16x32_bf16 v[240:243], a[232:235], a[32:35], v[240:243]
    buffer_load_dwordx4 v13, s[16:19], s49 offen offset:3072 lds
    v_mfma_f32_16x16x32_bf16 a[160:163], a[240:243], a[32:35], a[160:163]
    ds_read_b64_tr_b16 a[6:7], v28 offset:51200
    v_mfma_f32_16x16x32_bf16 a[160:163], a[244:247], a[36:39], a[160:163]
    s_add_u32 m0, s48, 4096
    ds_read_b128 a[80:83], v26 offset:36864
    v_mfma_f32_16x16x32_bf16 a[164:167], a[252:255], a[36:39], a[164:167]
    v_mfma_f32_16x16x32_bf16 a[164:167], a[248:251], a[32:35], a[164:167]
    buffer_load_dwordx4 v14, s[16:19], s49 offen offset:0 lds
    ds_read_b64_tr_b16 a[8:9], v29 offset:32768
    v_mfma_f32_16x16x32_bf16 a[172:175], a[248:251], a[40:43], a[172:175]
    v_mfma_f32_16x16x32_bf16 a[172:175], a[252:255], a[44:47], a[172:175]
    ds_read_b128 a[84:87], v27 offset:36864
    v_mfma_f32_16x16x32_bf16 a[168:171], a[244:247], a[44:47], a[168:171]
    buffer_load_dwordx4 v15, s[16:19], s49 offen offset:1024 lds
    ds_read_b64_tr_b16 a[10:11], v29 offset:34816
    v_mfma_f32_16x16x32_bf16 a[168:171], a[240:243], a[40:43], a[168:171]
    v_mfma_f32_16x16x32_bf16 v[244:247], a[232:235], a[40:43], v[244:247]
    ds_read_b128 a[88:91], v26 offset:38912
    v_mfma_f32_16x16x32_bf16 v[244:247], a[236:239], a[44:47], v[244:247]
    v_mfma_f32_16x16x32_bf16 v[148:151], a[228:231], a[44:47], v[148:151]
    buffer_load_dwordx4 v16, s[16:19], s49 offen offset:2048 lds
    ds_read_b64_tr_b16 a[12:13], v29 offset:49152
    v_mfma_f32_16x16x32_bf16 v[148:151], a[224:227], a[40:43], v[148:151]
    ds_read_b128 a[92:95], v27 offset:38912
    v_mfma_f32_16x16x32_bf16 v[212:215], a[216:219], a[40:43], v[212:215]
    v_mfma_f32_16x16x32_bf16 v[212:215], a[220:223], a[44:47], v[212:215]
    buffer_load_dwordx4 v17, s[16:19], s49 offen offset:3072 lds
    ds_read_b64_tr_b16 a[14:15], v29 offset:51200
    v_mfma_f32_16x16x32_bf16 v[116:119], a[212:215], a[44:47], v[116:119]
    ds_read_b128 a[96:99], v26 offset:40960
    v_mfma_f32_16x16x32_bf16 v[116:119], a[208:211], a[40:43], v[116:119]
    s_add_u32 s49, s49, 128
    v_mfma_f32_16x16x32_bf16 v[180:183], a[200:203], a[40:43], v[180:183]
    s_add_u32 m0, s48, 65536
    ds_read_b64_tr_b16 a[16:17], v30 offset:32768
    v_mfma_f32_16x16x32_bf16 v[180:183], a[204:207], a[44:47], v[180:183]
    buffer_load_dwordx4 v18, s[20:23], s50 offen offset:0 lds
    v_mfma_f32_16x16x32_bf16 v[84:87], a[196:199], a[44:47], v[84:87]
    ds_read_b128 a[100:103], v27 offset:40960
    v_mfma_f32_16x16x32_bf16 v[84:87], a[192:195], a[40:43], v[84:87]
    ds_read_b64_tr_b16 a[18:19], v30 offset:34816
    v_mfma_f32_16x16x32_bf16 v[88:91], a[192:195], a[48:51], v[88:91]
    buffer_load_dwordx4 v19, s[20:23], s50 offen offset:1024 lds
    v_mfma_f32_16x16x32_bf16 v[88:91], a[196:199], a[52:55], v[88:91]
    ds_read_b128 a[104:107], v26 offset:43008
    v_mfma_f32_16x16x32_bf16 v[184:187], a[204:207], a[52:55], v[184:187]
    v_mfma_f32_16x16x32_bf16 v[184:187], a[200:203], a[48:51], v[184:187]
    buffer_load_dwordx4 v20, s[20:23], s50 offen offset:2048 lds
    ds_read_b64_tr_b16 a[20:21], v30 offset:49152
    v_mfma_f32_16x16x32_bf16 v[120:123], a[208:211], a[48:51], v[120:123]
    ds_read_b128 a[108:111], v27 offset:43008
    v_mfma_f32_16x16x32_bf16 v[120:123], a[212:215], a[52:55], v[120:123]
    v_mfma_f32_16x16x32_bf16 v[216:219], a[220:223], a[52:55], v[216:219]
    ds_read_b64_tr_b16 a[22:23], v30 offset:51200
    v_mfma_f32_16x16x32_bf16 v[216:219], a[216:219], a[48:51], v[216:219]
    buffer_load_dwordx4 v21, s[20:23], s50 offen offset:3072 lds
    v_mfma_f32_16x16x32_bf16 v[152:155], a[224:227], a[48:51], v[152:155]
    s_add_u32 m0, s48, 69632
    ds_read_b128 a[112:115], v26 offset:45056
    v_mfma_f32_16x16x32_bf16 v[152:155], a[228:231], a[52:55], v[152:155]
    ds_read_b64_tr_b16 a[24:25], v31 offset:32768
    v_mfma_f32_16x16x32_bf16 v[248:251], a[236:239], a[52:55], v[248:251]
    buffer_load_dwordx4 v22, s[20:23], s50 offen offset:0 lds
    v_mfma_f32_16x16x32_bf16 v[248:251], a[232:235], a[48:51], v[248:251]
    ds_read_b128 a[116:119], v27 offset:45056
    v_mfma_f32_16x16x32_bf16 a[176:179], a[240:243], a[48:51], a[176:179]
    v_mfma_f32_16x16x32_bf16 a[176:179], a[244:247], a[52:55], a[176:179]
    ds_read_b64_tr_b16 a[26:27], v31 offset:34816
    v_mfma_f32_16x16x32_bf16 a[180:183], a[252:255], a[52:55], a[180:183]
    buffer_load_dwordx4 v23, s[20:23], s50 offen offset:1024 lds
    ds_read_b128 a[120:123], v26 offset:47104
    v_mfma_f32_16x16x32_bf16 a[180:183], a[248:251], a[48:51], a[180:183]
    v_mfma_f32_16x16x32_bf16 a[188:191], a[248:251], a[56:59], a[188:191]
    ds_read_b64_tr_b16 a[28:29], v31 offset:49152
    v_mfma_f32_16x16x32_bf16 a[188:191], a[252:255], a[60:63], a[188:191]
    buffer_load_dwordx4 v24, s[20:23], s50 offen offset:2048 lds
    v_mfma_f32_16x16x32_bf16 a[184:187], a[244:247], a[60:63], a[184:187]
    ds_read_b128 a[124:127], v27 offset:47104
    v_mfma_f32_16x16x32_bf16 a[184:187], a[240:243], a[56:59], a[184:187]
    ds_read_b64_tr_b16 a[30:31], v31 offset:51200
    v_mfma_f32_16x16x32_bf16 v[252:255], a[232:235], a[56:59], v[252:255]
    v_mfma_f32_16x16x32_bf16 v[252:255], a[236:239], a[60:63], v[252:255]
    buffer_load_dwordx4 v25, s[20:23], s50 offen offset:3072 lds
    v_mfma_f32_16x16x32_bf16 v[156:159], a[228:231], a[60:63], v[156:159]
    v_mfma_f32_16x16x32_bf16 v[156:159], a[224:227], a[56:59], v[156:159]
    s_add_u32 s50, s50, 0x80000
    v_mfma_f32_16x16x32_bf16 v[220:223], a[216:219], a[56:59], v[220:223]
    v_mfma_f32_16x16x32_bf16 v[220:223], a[220:223], a[60:63], v[220:223]
    s_cmp_eq_u32 s51, s53
    s_cbranch_scc1 k12_ool_36
k12_oolret_37:
    v_mfma_f32_16x16x32_bf16 v[124:127], a[212:215], a[60:63], v[124:127]
    s_cmp_eq_u32 s51, s63
    s_cbranch_scc1 k12_ool_38
k12_oolret_39:
    v_mfma_f32_16x16x32_bf16 v[124:127], a[208:211], a[56:59], v[124:127]
    s_cmp_eq_u32 s51, 6
    s_cbranch_scc1 k12_ool_40
k12_oolret_41:
    v_mfma_f32_16x16x32_bf16 v[188:191], a[200:203], a[56:59], v[188:191]
    v_mfma_f32_16x16x32_bf16 v[188:191], a[204:207], a[60:63], v[188:191]
    s_add_u32 s51, s51, 1
    v_mfma_f32_16x16x32_bf16 v[92:95], a[196:199], a[60:63], v[92:95]
    v_mfma_f32_16x16x32_bf16 v[92:95], a[192:195], a[56:59], v[92:95]
    s_waitcnt lgkmcnt(0)
    s_cmp_eq_u32 s51, 7
    s_cbranch_scc1 k12_last_29
    v_mfma_f32_16x16x32_bf16 v[64:67], a[64:67], a[0:3], v[64:67]
    v_mfma_f32_16x16x32_bf16 v[64:67], a[68:71], a[4:7], v[64:67]
    ds_read_b64_tr_b16 a[32:33], v32 offset:32768
    v_mfma_f32_16x16x32_bf16 v[160:163], a[76:79], a[4:7], v[160:163]
    v_mfma_f32_16x16x32_bf16 v[160:163], a[72:75], a[0:3], v[160:163]
    ds_read_b64_tr_b16 a[34:35], v32 offset:34816
    v_mfma_f32_16x16x32_bf16 v[96:99], a[80:83], a[0:3], v[96:99]
    v_mfma_f32_16x16x32_bf16 v[96:99], a[84:87], a[4:7], v[96:99]
    v_mfma_f32_16x16x32_bf16 v[192:195], a[92:95], a[4:7], v[192:195]
    ds_read_b64_tr_b16 a[36:37], v32 offset:49152
    v_mfma_f32_16x16x32_bf16 v[192:195], a[88:91], a[0:3], v[192:195]
    v_mfma_f32_16x16x32_bf16 v[128:131], a[96:99], a[0:3], v[128:131]
    v_mfma_f32_16x16x32_bf16 v[128:131], a[100:103], a[4:7], v[128:131]
    ds_read_b64_tr_b16 a[38:39], v32 offset:51200
    v_mfma_f32_16x16x32_bf16 v[224:227], a[108:111], a[4:7], v[224:227]
    v_mfma_f32_16x16x32_bf16 v[224:227], a[104:107], a[0:3], v[224:227]
    v_mfma_f32_16x16x32_bf16 a[128:131], a[112:115], a[0:3], a[128:131]
    ds_read_b64_tr_b16 a[40:41], v33 offset:32768
    v_mfma_f32_16x16x32_bf16 a[128:131], a[116:119], a[4:7], a[128:131]
    v_mfma_f32_16x16x32_bf16 a[132:135], a[124:127], a[4:7], a[132:135]
    v_mfma_f32_16x16x32_bf16 a[132:135], a[120:123], a[0:3], a[132:135]
    ds_read_b64_tr_b16 a[42:43], v33 offset:34816
    v_mfma_f32_16x16x32_bf16 a[140:143], a[120:123], a[8:11], a[140:143]
    v_mfma_f32_16x16x32_bf16 a[140:143], a[124:127], a[12:15], a[140:143]
    v_mfma_f32_16x16x32_bf16 a[136:139], a[116:119], a[12:15], a[136:139]
    ds_read_b64_tr_b16 a[44:45], v33 offset:49152
    v_mfma_f32_16x16x32_bf16 a[136:139], a[112:115], a[8:11], a[136:139]
    v_mfma_f32_16x16x32_bf16 v[228:231], a[104:107], a[8:11], v[228:231]
    v_mfma_f32_16x16x32_bf16 v[228:231], a[108:111], a[12:15], v[228:231]
    ds_read_b64_tr_b16 a[46:47], v33 offset:51200
    v_mfma_f32_16x16x32_bf16 v[132:135], a[100:103], a[12:15], v[132:135]
    v_mfma_f32_16x16x32_bf16 v[132:135], a[96:99], a[8:11], v[132:135]
    ds_read_b64_tr_b16 a[48:49], v34 offset:32768
    v_mfma_f32_16x16x32_bf16 v[196:199], a[88:91], a[8:11], v[196:199]
    v_mfma_f32_16x16x32_bf16 v[196:199], a[92:95], a[12:15], v[196:199]
    v_mfma_f32_16x16x32_bf16 v[100:103], a[84:87], a[12:15], v[100:103]
    ds_read_b64_tr_b16 a[50:51], v34 offset:34816
    v_mfma_f32_16x16x32_bf16 v[100:103], a[80:83], a[8:11], v[100:103]
    v_mfma_f32_16x16x32_bf16 v[164:167], a[72:75], a[8:11], v[164:167]
    v_mfma_f32_16x16x32_bf16 v[164:167], a[76:79], a[12:15], v[164:167]
    ds_read_b64_tr_b16 a[52:53], v34 offset:49152
    v_mfma_f32_16x16x32_bf16 v[68:71], a[68:71], a[12:15], v[68:71]
    v_mfma_f32_16x16x32_bf16 v[68:71], a[64:67], a[8:11], v[68:71]
    v_mfma_f32_16x16x32_bf16 v[72:75], a[64:67], a[16:19], v[72:75]
    ds_read_b64_tr_b16 a[54:55], v34 offset:51200
    v_mfma_f32_16x16x32_bf16 v[72:75], a[68:71], a[20:23], v[72:75]
    v_mfma_f32_16x16x32_bf16 v[168:171], a[76:79], a[20:23], v[168:171]
    v_mfma_f32_16x16x32_bf16 v[168:171], a[72:75], a[16:19], v[168:171]
    ds_read_b64_tr_b16 a[56:57], v35 offset:32768
    v_mfma_f32_16x16x32_bf16 v[104:107], a[80:83], a[16:19], v[104:107]
    v_mfma_f32_16x16x32_bf16 v[104:107], a[84:87], a[20:23], v[104:107]
    v_mfma_f32_16x16x32_bf16 v[200:203], a[92:95], a[20:23], v[200:203]
    ds_read_b64_tr_b16 a[58:59], v35 offset:34816
    v_mfma_f32_16x16x32_bf16 v[200:203], a[88:91], a[16:19], v[200:203]
    v_mfma_f32_16x16x32_bf16 v[136:139], a[96:99], a[16:19], v[136:139]
    v_mfma_f32_16x16x32_bf16 v[136:139], a[100:103], a[20:23], v[136:139]
    ds_read_b64_tr_b16 a[60:61], v35 offset:49152
    v_mfma_f32_16x16x32_bf16 v[232:235], a[108:111], a[20:23], v[232:235]
    v_mfma_f32_16x16x32_bf16 v[232:235], a[104:107], a[16:19], v[232:235]
    v_mfma_f32_16x16x32_bf16 a[144:147], a[112:115], a[16:19], a[144:147]
    ds_read_b64_tr_b16 a[62:63], v35 offset:51200
    v_mfma_f32_16x16x32_bf16 a[144:147], a[116:119], a[20:23], a[144:147]
    v_mfma_f32_16x16x32_bf16 a[148:151], a[124:127], a[20:23], a[148:151]
    v_mfma_f32_16x16x32_bf16 a[148:151], a[120:123], a[16:19], a[148:151]
    v_mfma_f32_16x16x32_bf16 a[156:159], a[120:123], a[24:27], a[156:159]
    v_mfma_f32_16x16x32_bf16 a[156:159], a[124:127], a[28:31], a[156:159]
    v_mfma_f32_16x16x32_bf16 a[152:155], a[116:119], a[28:31], a[152:155]
    v_mfma_f32_16x16x32_bf16 a[152:155], a[112:115], a[24:27], a[152:155]
    v_mfma_f32_16x16x32_bf16 v[236:239], a[104:107], a[24:27], v[236:239]
    v_mfma_f32_16x16x32_bf16 v[236:239], a[108:111], a[28:31], v[236:239]
    v_mfma_f32_16x16x32_bf16 v[140:143], a[100:103], a[28:31], v[140:143]
    v_mfma_f32_16x16x32_bf16 v[140:143], a[96:99], a[24:27], v[140:143]
    v_mfma_f32_16x16x32_bf16 v[204:207], a[88:91], a[24:27], v[204:207]
    v_mfma_f32_16x16x32_bf16 v[204:207], a[92:95], a[28:31], v[204:207]
    v_mfma_f32_16x16x32_bf16 v[108:111], a[84:87], a[28:31], v[108:111]
    v_mfma_f32_16x16x32_bf16 v[108:111], a[80:83], a[24:27], v[108:111]
    v_mfma_f32_16x16x32_bf16 v[172:175], a[72:75], a[24:27], v[172:175]
    v_mfma_f32_16x16x32_bf16 v[172:175], a[76:79], a[28:31], v[172:175]
    v_mfma_f32_16x16x32_bf16 v[76:79], a[68:71], a[28:31], v[76:79]
    v_mfma_f32_16x16x32_bf16 v[76:79], a[64:67], a[24:27], v[76:79]
    s_waitcnt vmcnt(0) lgkmcnt(0)
    s_barrier
    v_mfma_f32_16x16x32_bf16 v[80:83], a[64:67], a[32:35], v[80:83]
    v_mfma_f32_16x16x32_bf16 v[80:83], a[68:71], a[36:39], v[80:83]
    s_add_u32 m0, s48, 32768
    ds_read_b128 a[192:195], v26 offset:0
    v_mfma_f32_16x16x32_bf16 v[176:179], a[76:79], a[36:39], v[176:179]
    buffer_load_dwordx4 v10, s[16:19], s49 offen offset:0 lds
    ds_read_b64_tr_b16 a[0:1], v28 offset:0
    v_mfma_f32_16x16x32_bf16 v[176:179], a[72:75], a[32:35], v[176:179]
    ds_read_b128 a[196:199], v27 offset:0
    v_mfma_f32_16x16x32_bf16 v[112:115], a[80:83], a[32:35], v[112:115]
    buffer_load_dwordx4 v11, s[16:19], s49 offen offset:1024 lds
    v_mfma_f32_16x16x32_bf16 v[112:115], a[84:87], a[36:39], v[112:115]
    ds_read_b64_tr_b16 a[2:3], v28 offset:2048
    v_mfma_f32_16x16x32_bf16 v[208:211], a[92:95], a[36:39], v[208:211]
    v_mfma_f32_16x16x32_bf16 v[208:211], a[88:91], a[32:35], v[208:211]
    ds_read_b128 a[200:203], v26 offset:2048
    v_mfma_f32_16x16x32_bf16 v[144:147], a[96:99], a[32:35], v[144:147]
    buffer_load_dwordx4 v12, s[16:19], s49 offen offset:2048 lds
    ds_read_b64_tr_b16 a[4:5], v28 offset:16384
    v_mfma_f32_16x16x32_bf16 v[144:147], a[100:103], a[36:39], v[144:147]
    v_mfma_f32_16x16x32_bf16 v[240:243], a[108:111], a[36:39], v[240:243]
    ds_read_b128 a[204:207], v27 offset:2048
    v_mfma_f32_16x16x32_bf16 v[240:243], a[104:107], a[32:35], v[240:243]
    buffer_load_dwordx4 v13, s[16:19], s49 offen offset:3072 lds
    v_mfma_f32_16x16x32_bf16 a[160:163], a[112:115], a[32:35], a[160:163]
    ds_read_b64_tr_b16 a[6:7], v28 offset:18432
    v_mfma_f32_16x16x32_bf16 a[160:163], a[116:119], a[36:39], a[160:163]
    s_add_u32 m0, s48, 36864
    ds_read_b128 a[208:211], v26 offset:4096
    v_mfma_f32_16x16x32_bf16 a[164:167], a[124:127], a[36:39], a[164:167]
    v_mfma_f32_16x16x32_bf16 a[164:167], a[120:123], a[32:35], a[164:167]
    buffer_load_dwordx4 v14, s[16:19], s49 offen offset:0 lds
    ds_read_b64_tr_b16 a[8:9], v29 offset:0
    v_mfma_f32_16x16x32_bf16 a[172:175], a[120:123], a[40:43], a[172:175]
    v_mfma_f32_16x16x32_bf16 a[172:175], a[124:127], a[44:47], a[172:175]
    ds_read_b128 a[212:215], v27 offset:4096
    v_mfma_f32_16x16x32_bf16 a[168:171], a[116:119], a[44:47], a[168:171]
    buffer_load_dwordx4 v15, s[16:19], s49 offen offset:1024 lds
    ds_read_b64_tr_b16 a[10:11], v29 offset:2048
    v_mfma_f32_16x16x32_bf16 a[168:171], a[112:115], a[40:43], a[168:171]
    v_mfma_f32_16x16x32_bf16 v[244:247], a[104:107], a[40:43], v[244:247]
    ds_read_b128 a[216:219], v26 offset:6144
    v_mfma_f32_16x16x32_bf16 v[244:247], a[108:111], a[44:47], v[244:247]
    v_mfma_f32_16x16x32_bf16 v[148:151], a[100:103], a[44:47], v[148:151]
    buffer_load_dwordx4 v16, s[16:19], s49 offen offset:2048 lds
    ds_read_b64_tr_b16 a[12:13], v29 offset:16384
    v_mfma_f32_16x16x32_bf16 v[148:151], a[96:99], a[40:43], v[148:151]
    ds_read_b128 a[220:223], v27 offset:6144
    v_mfma_f32_16x16x32_bf16 v[212:215], a[88:91], a[40:43], v[212:215]
    v_mfma_f32_16x16x32_bf16 v[212:215], a[92:95], a[44:47], v[212:215]
    buffer_load_dwordx4 v17, s[16:19], s49 offen offset:3072 lds
    ds_read_b64_tr_b16 a[14:15], v29 offset:18432
    v_mfma_f32_16x16x32_bf16 v[116:119], a[84:87], a[44:47], v[116:119]
    ds_read_b128 a[224:227], v26 offset:8192
    v_mfma_f32_16x16x32_bf16 v[116:119], a[80:83], a[40:43], v[116:119]
    s_add_u32 s49, s49, 128
    v_mfma_f32_16x16x32_bf16 v[180:183], a[72:75], a[40:43], v[180:183]
    s_add_u32 m0, s48, 98304
    ds_read_b64_tr_b16 a[16:17], v30 offset:0
    v_mfma_f32_16x16x32_bf16 v[180:183], a[76:79], a[44:47], v[180:183]
    buffer_load_dwordx4 v18, s[20:23], s50 offen offset:0 lds
    v_mfma_f32_16x16x32_bf16 v[84:87], a[68:71], a[44:47], v[84:87]
    ds_read_b128 a[228:231], v27 offset:8192
    v_mfma_f32_16x16x32_bf16 v[84:87], a[64:67], a[40:43], v[84:87]
    ds_read_b64_tr_b16 a[18:19], v30 offset:2048
    v_mfma_f32_16x16x32_bf16 v[88:91], a[64:67], a[48:51], v[88:91]
    buffer_load_dwordx4 v19, s[20:23], s50 offen offset:1024 lds
    v_mfma_f32_16x16x32_bf16 v[88:91], a[68:71], a[52:55], v[88:91]
    ds_read_b128 a[232:235], v26 offset:10240
    v_mfma_f32_16x16x32_bf16 v[184:187], a[76:79], a[52:55], v[184:187]
    v_mfma_f32_16x16x32_bf16 v[184:187], a[72:75], a[48:51], v[184:187]
    buffer_load_dwordx4 v20, s[20:23], s50 offen offset:2048 lds
    ds_read_b64_tr_b16 a[20:21], v30 offset:16384
    v_mfma_f32_16x16x32_bf16 v[120:123], a[80:83], a[48:51], v[120:123]
    ds_read_b128 a[236:239], v27 offset:10240
    v_mfma_f32_16x16x32_bf16 v[120:123], a[84:87], a[52:55], v[120:123]
    v_mfma_f32_16x16x32_bf16 v[216:219], a[92:95], a[52:55], v[216:219]
    ds_read_b64_tr_b16 a[22:23], v30 offset:18432
    v_mfma_f32_16x16x32_bf16 v[216:219], a[88:91], a[48:51], v[216:219]
    buffer_load_dwordx4 v21, s[20:23], s50 offen offset:3072 lds
    v_mfma_f32_16x16x32_bf16 v[152:155], a[96:99], a[48:51], v[152:155]
    s_add_u32 m0, s48, 102400
    ds_read_b128 a[240:243], v26 offset:12288
    v_mfma_f32_16x16x32_bf16 v[152:155], a[100:103], a[52:55], v[152:155]
    ds_read_b64_tr_b16 a[24:25], v31 offset:0
    v_mfma_f32_16x16x32_bf16 v[248:251], a[108:111], a[52:55], v[248:251]
    buffer_load_dwordx4 v22, s[20:23], s50 offen offset:0 lds
    v_mfma_f32_16x16x32_bf16 v[248:251], a[104:107], a[48:51], v[248:251]
    ds_read_b128 a[244:247], v27 offset:12288
    v_mfma_f32_16x16x32_bf16 a[176:179], a[112:115], a[48:51], a[176:179]
    v_mfma_f32_16x16x32_bf16 a[176:179], a[116:119], a[52:55], a[176:179]
    ds_read_b64_tr_b16 a[26:27], v31 offset:2048
    v_mfma_f32_16x16x32_bf16 a[180:183], a[124:127], a[52:55], a[180:183]
    buffer_load_dwordx4 v23, s[20:23], s50 offen offset:1024 lds
    ds_read_b128 a[248:251], v26 offset:14336
    v_mfma_f32_16x16x32_bf16 a[180:183], a[120:123], a[48:51], a[180:183]
    v_mfma_f32_16x16x32_bf16 a[188:191], a[120:123], a[56:59], a[188:191]
    ds_read_b64_tr_b16 a[28:29], v31 offset:16384
    v_mfma_f32_16x16x32_bf16 a[188:191], a[124:127], a[60:63], a[188:191]
    buffer_load_dwordx4 v24, s[20:23], s50 offen offset:2048 lds
    v_mfma_f32_16x16x32_bf16 a[184:187], a[116:119], a[60:63], a[184:187]
    ds_read_b128 a[252:255], v27 offset:14336
    v_mfma_f32_16x16x32_bf16 a[184:187], a[112:115], a[56:59], a[184:187]
    ds_read_b64_tr_b16 a[30:31], v31 offset:18432
    v_mfma_f32_16x16x32_bf16 v[252:255], a[104:107], a[56:59], v[252:255]
    v_mfma_f32_16x16x32_bf16 v[252:255], a[108:111], a[60:63], v[252:255]
    buffer_load_dwordx4 v25, s[20:23], s50 offen offset:3072 lds
    v_mfma_f32_16x16x32_bf16 v[156:159], a[100:103], a[60:63], v[156:159]
    v_mfma_f32_16x16x32_bf16 v[156:159], a[96:99], a[56:59], v[156:159]
    s_add_u32 s50, s50, 0x80000
    v_mfma_f32_16x16x32_bf16 v[220:223], a[88:91], a[56:59], v[220:223]
    v_mfma_f32_16x16x32_bf16 v[220:223], a[92:95], a[60:63], v[220:223]
    s_cmp_eq_u32 s51, s53
    s_cbranch_scc1 k12_ool_42
k12_oolret_43:
    v_mfma_f32_16x16x32_bf16 v[124:127], a[84:87], a[60:63], v[124:127]
    s_cmp_eq_u32 s51, s63
    s_cbranch_scc1 k12_ool_44
k12_oolret_45:
    v_mfma_f32_16x16x32_bf16 v[124:127], a[80:83], a[56:59], v[124:127]
    s_cmp_eq_u32 s51, 5
    s_cbranch_scc1 k12_ool_46
k12_oolret_47:
    v_mfma_f32_16x16x32_bf16 v[188:191], a[72:75], a[56:59], v[188:191]
    v_mfma_f32_16x16x32_bf16 v[188:191], a[76:79], a[60:63], v[188:191]
    s_add_u32 s51, s51, 1
    v_mfma_f32_16x16x32_bf16 v[92:95], a[68:71], a[60:63], v[92:95]
    v_mfma_f32_16x16x32_bf16 v[92:95], a[64:67], a[56:59], v[92:95]
    s_waitcnt lgkmcnt(0)
    s_branch k12_loop_28
k12_last_29:
    v_mfma_f32_16x16x32_bf16 v[64:67], a[64:67], a[0:3], v[64:67]
    buffer_load_dwordx4 a[192:195], v36, s[8:11], s62 offen sc1
    v_mfma_f32_16x16x32_bf16 v[64:67], a[68:71], a[4:7], v[64:67]
    ds_read_b64_tr_b16 a[32:33], v32 offset:32768
    v_mfma_f32_16x16x32_bf16 v[160:163], a[76:79], a[4:7], v[160:163]
    buffer_load_dwordx4 a[196:199], v54, s[8:11], s62 offen sc1
    ds_read_b64_tr_b16 a[34:35], v32 offset:34816
    v_mfma_f32_16x16x32_bf16 v[160:163], a[72:75], a[0:3], v[160:163]
    v_mfma_f32_16x16x32_bf16 v[96:99], a[80:83], a[0:3], v[96:99]
    buffer_load_dwordx4 a[200:203], v37, s[8:11], s62 offen sc1
    v_mfma_f32_16x16x32_bf16 v[96:99], a[84:87], a[4:7], v[96:99]
    ds_read_b64_tr_b16 a[36:37], v32 offset:49152
    v_mfma_f32_16x16x32_bf16 v[192:195], a[92:95], a[4:7], v[192:195]
    buffer_load_dwordx4 a[204:207], v55, s[8:11], s62 offen sc1
    v_mfma_f32_16x16x32_bf16 v[192:195], a[88:91], a[0:3], v[192:195]
    s_add_u32 s62, s62, 0x20000
    buffer_load_dwordx4 a[208:211], v36, s[8:11], s62 offen sc1
    ds_read_b64_tr_b16 a[38:39], v32 offset:51200
    v_mfma_f32_16x16x32_bf16 v[128:131], a[96:99], a[0:3], v[128:131]
    v_mfma_f32_16x16x32_bf16 v[128:131], a[100:103], a[4:7], v[128:131]
    v_cvt_pk_bf16_f32 v64, v64, v65
    v_cvt_pk_bf16_f32 v65, v66, v67
    v_mfma_f32_16x16x32_bf16 v[224:227], a[108:111], a[4:7], v[224:227]
    v_cvt_pk_bf16_f32 v66, v160, v161
    v_cvt_pk_bf16_f32 v67, v162, v163
    v_mfma_f32_16x16x32_bf16 v[224:227], a[104:107], a[0:3], v[224:227]
    buffer_load_dwordx4 a[212:215], v54, s[8:11], s62 offen sc1
    ds_read_b64_tr_b16 a[40:41], v33 offset:32768
    v_mfma_f32_16x16x32_bf16 a[128:131], a[112:115], a[0:3], a[128:131]
    buffer_load_dwordx4 a[216:219], v37, s[8:11], s62 offen sc1
    ds_read_b64_tr_b16 a[42:43], v33 offset:34816
    v_mfma_f32_16x16x32_bf16 a[128:131], a[116:119], a[4:7], a[128:131]
    v_cvt_pk_bf16_f32 v96, v96, v97
    v_cvt_pk_bf16_f32 v97, v98, v99
    v_mfma_f32_16x16x32_bf16 a[132:135], a[124:127], a[4:7], a[132:135]
    v_cvt_pk_bf16_f32 v98, v192, v193
    v_cvt_pk_bf16_f32 v99, v194, v195
    v_mfma_f32_16x16x32_bf16 a[132:135], a[120:123], a[0:3], a[132:135]
    buffer_load_dwordx4 a[220:223], v55, s[8:11], s62 offen sc1
    ds_read_b64_tr_b16 a[44:45], v33 offset:49152
    v_mfma_f32_16x16x32_bf16 v[68:71], a[64:67], a[8:11], v[68:71]
    s_add_u32 s62, s62, 0x20000
    buffer_load_dwordx4 a[224:227], v36, s[8:11], s62 offen sc1
    v_mfma_f32_16x16x32_bf16 v[68:71], a[68:71], a[12:15], v[68:71]
    v_cvt_pk_bf16_f32 v128, v128, v129
    v_cvt_pk_bf16_f32 v129, v130, v131
    v_mfma_f32_16x16x32_bf16 v[164:167], a[76:79], a[12:15], v[164:167]
    buffer_load_dwordx4 a[228:231], v54, s[8:11], s62 offen sc1
    ds_read_b64_tr_b16 a[46:47], v33 offset:51200
    v_mfma_f32_16x16x32_bf16 v[164:167], a[72:75], a[8:11], v[164:167]
    v_cvt_pk_bf16_f32 v130, v224, v225
    v_cvt_pk_bf16_f32 v131, v226, v227
    v_mfma_f32_16x16x32_bf16 v[100:103], a[80:83], a[8:11], v[100:103]
    buffer_load_dwordx4 a[232:235], v37, s[8:11], s62 offen sc1
    ds_read_b64_tr_b16 a[48:49], v34 offset:32768
    v_mfma_f32_16x16x32_bf16 v[100:103], a[84:87], a[12:15], v[100:103]
    v_accvgpr_read_b32 v56, a128
    v_accvgpr_read_b32 v57, a129
    v_mfma_f32_16x16x32_bf16 v[196:199], a[92:95], a[12:15], v[196:199]
    buffer_load_dwordx4 a[236:239], v55, s[8:11], s62 offen sc1
    ds_read_b64_tr_b16 a[50:51], v34 offset:34816
    v_mfma_f32_16x16x32_bf16 v[196:199], a[88:91], a[8:11], v[196:199]
    s_add_u32 s62, s62, 0x20000
    v_accvgpr_read_b32 v58, a130
    v_accvgpr_read_b32 v59, a131
    v_mfma_f32_16x16x32_bf16 v[132:135], a[96:99], a[8:11], v[132:135]
    v_accvgpr_read_b32 v60, a132
    v_accvgpr_read_b32 v61, a133
    v_mfma_f32_16x16x32_bf16 v[132:135], a[100:103], a[12:15], v[132:135]
    v_accvgpr_read_b32 v62, a134
    v_accvgpr_read_b32 v63, a135
    v_mfma_f32_16x16x32_bf16 v[228:231], a[108:111], a[12:15], v[228:231]
    buffer_load_dwordx4 a[240:243], v36, s[8:11], s62 offen sc1
    ds_read_b64_tr_b16 a[52:53], v34 offset:49152
    v_mfma_f32_16x16x32_bf16 v[228:231], a[104:107], a[8:11], v[228:231]
    v_cvt_pk_bf16_f32 v160, v56, v57
    v_cvt_pk_bf16_f32 v161, v58, v59
    v_mfma_f32_16x16x32_bf16 a[136:139], a[112:115], a[8:11], a[136:139]
    v_cvt_pk_bf16_f32 v68, v68, v69
    v_cvt_pk_bf16_f32 v162, v60, v61
    v_mfma_f32_16x16x32_bf16 a[136:139], a[116:119], a[12:15], a[136:139]
    buffer_load_dwordx4 a[244:247], v54, s[8:11], s62 offen sc1
    v_cvt_pk_bf16_f32 v69, v70, v71
    v_mfma_f32_16x16x32_bf16 a[140:143], a[124:127], a[12:15], a[140:143]
    v_cvt_pk_bf16_f32 v163, v62, v63
    v_cvt_pk_bf16_f32 v70, v164, v165
    v_mfma_f32_16x16x32_bf16 a[140:143], a[120:123], a[8:11], a[140:143]
    buffer_load_dwordx4 a[248:251], v37, s[8:11], s62 offen sc1
    v_cvt_pk_bf16_f32 v71, v166, v167
    v_mfma_f32_16x16x32_bf16 v[72:75], a[64:67], a[16:19], v[72:75]
    ds_read_b64_tr_b16 a[54:55], v34 offset:51200
    v_cvt_pk_bf16_f32 v100, v100, v101
    v_mfma_f32_16x16x32_bf16 v[72:75], a[68:71], a[20:23], v[72:75]
    buffer_load_dwordx4 a[252:255], v55, s[8:11], s62 offen sc1
    v_cvt_pk_bf16_f32 v101, v102, v103
    v_mfma_f32_16x16x32_bf16 v[168:171], a[76:79], a[20:23], v[168:171]
    s_add_u32 s62, s62, 0x20000
    ds_read_b64_tr_b16 a[56:57], v35 offset:32768
    v_cvt_pk_bf16_f32 v102, v196, v197
    v_mfma_f32_16x16x32_bf16 v[168:171], a[72:75], a[16:19], v[168:171]
    s_add_u32 s52, s47, 0
    ds_read_b64_tr_b16 a[58:59], v35 offset:34816
    v_cvt_pk_bf16_f32 v103, v198, v199
    v_mfma_f32_16x16x32_bf16 v[104:107], a[80:83], a[16:19], v[104:107]
    v_cvt_pk_bf16_f32 v132, v132, v133
    v_cvt_pk_bf16_f32 v133, v134, v135
    v_mfma_f32_16x16x32_bf16 v[104:107], a[84:87], a[20:23], v[104:107]
    v_cvt_pk_bf16_f32 v134, v228, v229
    v_cvt_pk_bf16_f32 v135, v230, v231
    v_mfma_f32_16x16x32_bf16 v[200:203], a[92:95], a[20:23], v[200:203]
    buffer_store_dwordx4 v[64:67], v1, s[32:35], s52 offen offset:0 sc1
    ds_read_b64_tr_b16 a[60:61], v35 offset:49152
    v_mfma_f32_16x16x32_bf16 v[200:203], a[88:91], a[16:19], v[200:203]
    v_accvgpr_read_b32 v56, a136
    v_accvgpr_read_b32 v57, a137
    v_mfma_f32_16x16x32_bf16 v[136:139], a[96:99], a[16:19], v[136:139]
    ds_read_b64_tr_b16 a[62:63], v35 offset:51200
    v_accvgpr_read_b32 v58, a138
    v_mfma_f32_16x16x32_bf16 v[136:139], a[100:103], a[20:23], v[136:139]
    v_accvgpr_read_b32 v59, a139
    v_accvgpr_read_b32 v60, a140
    v_mfma_f32_16x16x32_bf16 v[232:235], a[108:111], a[20:23], v[232:235]
    v_accvgpr_read_b32 v61, a141
    v_accvgpr_read_b32 v62, a142
    v_mfma_f32_16x16x32_bf16 v[232:235], a[104:107], a[16:19], v[232:235]
    s_add_u32 s52, s47, 8192
    v_accvgpr_read_b32 v63, a143
    v_cvt_pk_bf16_f32 v164, v56, v57
    v_mfma_f32_16x16x32_bf16 a[144:147], a[112:115], a[16:19], a[144:147]
    v_cvt_pk_bf16_f32 v165, v58, v59
    v_cvt_pk_bf16_f32 v72, v72, v73
    v_mfma_f32_16x16x32_bf16 a[144:147], a[116:119], a[20:23], a[144:147]
    v_cvt_pk_bf16_f32 v166, v60, v61
    v_cvt_pk_bf16_f32 v73, v74, v75
    v_mfma_f32_16x16x32_bf16 a[148:151], a[124:127], a[20:23], a[148:151]
    v_cvt_pk_bf16_f32 v167, v62, v63
    v_cvt_pk_bf16_f32 v74, v168, v169
    v_mfma_f32_16x16x32_bf16 a[148:151], a[120:123], a[16:19], a[148:151]
    v_cvt_pk_bf16_f32 v75, v170, v171
    v_cvt_pk_bf16_f32 v104, v104, v105
    v_mfma_f32_16x16x32_bf16 v[76:79], a[64:67], a[24:27], v[76:79]
    v_cvt_pk_bf16_f32 v105, v106, v107
    v_cvt_pk_bf16_f32 v106, v200, v201
    v_mfma_f32_16x16x32_bf16 v[76:79], a[68:71], a[28:31], v[76:79]
    buffer_store_dwordx4 v[96:99], v1, s[32:35], s52 offen offset:0 sc1
    v_mfma_f32_16x16x32_bf16 v[172:175], a[76:79], a[28:31], v[172:175]
    v_cvt_pk_bf16_f32 v107, v202, v203
    v_cvt_pk_bf16_f32 v136, v136, v137
    v_mfma_f32_16x16x32_bf16 v[172:175], a[72:75], a[24:27], v[172:175]
    v_cvt_pk_bf16_f32 v137, v138, v139
    v_cvt_pk_bf16_f32 v138, v232, v233
    v_mfma_f32_16x16x32_bf16 v[108:111], a[80:83], a[24:27], v[108:111]
    v_cvt_pk_bf16_f32 v139, v234, v235
    v_mfma_f32_16x16x32_bf16 v[108:111], a[84:87], a[28:31], v[108:111]
    v_accvgpr_read_b32 v56, a144
    v_accvgpr_read_b32 v57, a145
    v_mfma_f32_16x16x32_bf16 v[204:207], a[92:95], a[28:31], v[204:207]
    v_accvgpr_read_b32 v58, a146
    v_accvgpr_read_b32 v59, a147
    v_mfma_f32_16x16x32_bf16 v[204:207], a[88:91], a[24:27], v[204:207]
    s_add_u32 s52, s47, 524288
    v_accvgpr_read_b32 v60, a148
    v_accvgpr_read_b32 v61, a149
    v_mfma_f32_16x16x32_bf16 v[140:143], a[96:99], a[24:27], v[140:143]
    v_accvgpr_read_b32 v62, a150
    v_accvgpr_read_b32 v63, a151
    v_mfma_f32_16x16x32_bf16 v[140:143], a[100:103], a[28:31], v[140:143]
    v_cvt_pk_bf16_f32 v168, v56, v57
    v_cvt_pk_bf16_f32 v169, v58, v59
    v_mfma_f32_16x16x32_bf16 v[236:239], a[108:111], a[28:31], v[236:239]
    v_cvt_pk_bf16_f32 v76, v76, v77
    v_cvt_pk_bf16_f32 v170, v60, v61
    v_mfma_f32_16x16x32_bf16 v[236:239], a[104:107], a[24:27], v[236:239]
    buffer_store_dwordx4 v[128:131], v1, s[32:35], s52 offen offset:0 sc1
    v_mfma_f32_16x16x32_bf16 a[152:155], a[112:115], a[24:27], a[152:155]
    s_waitcnt lgkmcnt(0)
    v_cvt_pk_bf16_f32 v77, v78, v79
    v_cvt_pk_bf16_f32 v171, v62, v63
    v_mfma_f32_16x16x32_bf16 a[152:155], a[116:119], a[28:31], a[152:155]
    v_cvt_pk_bf16_f32 v78, v172, v173
    v_cvt_pk_bf16_f32 v79, v174, v175
    v_mfma_f32_16x16x32_bf16 a[156:159], a[124:127], a[28:31], a[156:159]
    v_cvt_pk_bf16_f32 v108, v108, v109
    v_cvt_pk_bf16_f32 v109, v110, v111
    v_mfma_f32_16x16x32_bf16 a[156:159], a[120:123], a[24:27], a[156:159]
    v_cvt_pk_bf16_f32 v110, v204, v205
    v_cvt_pk_bf16_f32 v111, v206, v207
    v_mfma_f32_16x16x32_bf16 v[80:83], a[64:67], a[32:35], v[80:83]
    v_mfma_f32_16x16x32_bf16 v[80:83], a[68:71], a[36:39], v[80:83]
    v_cvt_pk_bf16_f32 v140, v140, v141
    v_cvt_pk_bf16_f32 v141, v142, v143
    v_mfma_f32_16x16x32_bf16 v[176:179], a[76:79], a[36:39], v[176:179]
    s_add_u32 s52, s47, 532480
    v_cvt_pk_bf16_f32 v142, v236, v237
    v_cvt_pk_bf16_f32 v143, v238, v239
    v_mfma_f32_16x16x32_bf16 v[176:179], a[72:75], a[32:35], v[176:179]
    buffer_store_dwordx4 v[160:163], v1, s[32:35], s52 offen offset:0 sc1
    v_mfma_f32_16x16x32_bf16 v[112:115], a[80:83], a[32:35], v[112:115]
    v_mfma_f32_16x16x32_bf16 v[112:115], a[84:87], a[36:39], v[112:115]
    v_accvgpr_read_b32 v56, a152
    v_accvgpr_read_b32 v57, a153
    v_mfma_f32_16x16x32_bf16 v[208:211], a[92:95], a[36:39], v[208:211]
    v_accvgpr_read_b32 v58, a154
    v_accvgpr_read_b32 v59, a155
    v_mfma_f32_16x16x32_bf16 v[208:211], a[88:91], a[32:35], v[208:211]
    v_accvgpr_read_b32 v60, a156
    v_accvgpr_read_b32 v61, a157
    v_mfma_f32_16x16x32_bf16 v[144:147], a[96:99], a[32:35], v[144:147]
    v_accvgpr_read_b32 v62, a158
    v_accvgpr_read_b32 v63, a159
    v_mfma_f32_16x16x32_bf16 v[144:147], a[100:103], a[36:39], v[144:147]
    v_cvt_pk_bf16_f32 v172, v56, v57
    v_cvt_pk_bf16_f32 v173, v58, v59
    v_mfma_f32_16x16x32_bf16 v[240:243], a[108:111], a[36:39], v[240:243]
    v_cvt_pk_bf16_f32 v80, v80, v81
    v_cvt_pk_bf16_f32 v174, v60, v61
    v_mfma_f32_16x16x32_bf16 v[240:243], a[104:107], a[32:35], v[240:243]
    v_cvt_pk_bf16_f32 v81, v82, v83
    v_cvt_pk_bf16_f32 v175, v62, v63
    v_mfma_f32_16x16x32_bf16 a[160:163], a[112:115], a[32:35], a[160:163]
    v_cvt_pk_bf16_f32 v82, v176, v177
    v_cvt_pk_bf16_f32 v83, v178, v179
    v_mfma_f32_16x16x32_bf16 a[160:163], a[116:119], a[36:39], a[160:163]
    v_cvt_pk_bf16_f32 v112, v112, v113
    v_cvt_pk_bf16_f32 v113, v114, v115
    v_mfma_f32_16x16x32_bf16 a[164:167], a[124:127], a[36:39], a[164:167]
    s_add_u32 s52, s47, 0
    v_cvt_pk_bf16_f32 v114, v208, v209
    v_cvt_pk_bf16_f32 v115, v210, v211
    v_mfma_f32_16x16x32_bf16 a[164:167], a[120:123], a[32:35], a[164:167]
    buffer_store_dwordx4 v[68:71], v1, s[32:35], s52 offen offset:1024 sc1
    v_mfma_f32_16x16x32_bf16 v[84:87], a[64:67], a[40:43], v[84:87]
    v_mfma_f32_16x16x32_bf16 v[84:87], a[68:71], a[44:47], v[84:87]
    v_cvt_pk_bf16_f32 v144, v144, v145
    v_cvt_pk_bf16_f32 v145, v146, v147
    v_mfma_f32_16x16x32_bf16 v[180:183], a[76:79], a[44:47], v[180:183]
    v_cvt_pk_bf16_f32 v146, v240, v241
    v_cvt_pk_bf16_f32 v147, v242, v243
    v_mfma_f32_16x16x32_bf16 v[180:183], a[72:75], a[40:43], v[180:183]
    v_mfma_f32_16x16x32_bf16 v[116:119], a[80:83], a[40:43], v[116:119]
    v_mfma_f32_16x16x32_bf16 v[116:119], a[84:87], a[44:47], v[116:119]
    v_accvgpr_read_b32 v56, a160
    v_accvgpr_read_b32 v57, a161
    v_mfma_f32_16x16x32_bf16 v[212:215], a[92:95], a[44:47], v[212:215]
    v_accvgpr_read_b32 v58, a162
    v_accvgpr_read_b32 v59, a163
    v_mfma_f32_16x16x32_bf16 v[212:215], a[88:91], a[40:43], v[212:215]
    v_accvgpr_read_b32 v60, a164
    v_accvgpr_read_b32 v61, a165
    v_mfma_f32_16x16x32_bf16 v[148:151], a[96:99], a[40:43], v[148:151]
    v_accvgpr_read_b32 v62, a166
    v_accvgpr_read_b32 v63, a167
    v_mfma_f32_16x16x32_bf16 v[148:151], a[100:103], a[44:47], v[148:151]
    s_add_u32 s52, s47, 8192
    v_cvt_pk_bf16_f32 v176, v56, v57
    v_cvt_pk_bf16_f32 v177, v58, v59
    v_mfma_f32_16x16x32_bf16 v[244:247], a[108:111], a[44:47], v[244:247]
    v_cvt_pk_bf16_f32 v84, v84, v85
    v_cvt_pk_bf16_f32 v178, v60, v61
    v_mfma_f32_16x16x32_bf16 v[244:247], a[104:107], a[40:43], v[244:247]
    v_cvt_pk_bf16_f32 v85, v86, v87
    v_cvt_pk_bf16_f32 v179, v62, v63
    v_mfma_f32_16x16x32_bf16 a[168:171], a[112:115], a[40:43], a[168:171]
    v_cvt_pk_bf16_f32 v86, v180, v181
    v_cvt_pk_bf16_f32 v87, v182, v183
    v_mfma_f32_16x16x32_bf16 a[168:171], a[116:119], a[44:47], a[168:171]
    buffer_store_dwordx4 v[100:103], v1, s[32:35], s52 offen offset:1024 sc1
    v_mfma_f32_16x16x32_bf16 a[172:175], a[124:127], a[44:47], a[172:175]
    v_cvt_pk_bf16_f32 v116, v116, v117
    v_cvt_pk_bf16_f32 v117, v118, v119
    v_mfma_f32_16x16x32_bf16 a[172:175], a[120:123], a[40:43], a[172:175]
    v_cvt_pk_bf16_f32 v118, v212, v213
    v_cvt_pk_bf16_f32 v119, v214, v215
    v_mfma_f32_16x16x32_bf16 v[88:91], a[64:67], a[48:51], v[88:91]
    s_waitcnt vmcnt(16)
    s_barrier
    v_mfma_f32_16x16x32_bf16 v[88:91], a[68:71], a[52:55], v[88:91]
    ds_read_b64_tr_b16 a[0:1], v42 offset:32768
    v_cvt_pk_bf16_f32 v148, v148, v149
    v_mfma_f32_16x16x32_bf16 v[184:187], a[76:79], a[52:55], v[184:187]
    v_cvt_pk_bf16_f32 v149, v150, v151
    v_cvt_pk_bf16_f32 v150, v244, v245
    v_mfma_f32_16x16x32_bf16 v[184:187], a[72:75], a[48:51], v[184:187]
    ds_read_b64_tr_b16 a[2:3], v42 offset:33792
    v_cvt_pk_bf16_f32 v151, v246, v247
    v_mfma_f32_16x16x32_bf16 v[120:123], a[80:83], a[48:51], v[120:123]
    ds_read_b64_tr_b16 a[4:5], v42 offset:40960
    ds_read_b64_tr_b16 a[6:7], v42 offset:41984
    v_mfma_f32_16x16x32_bf16 v[120:123], a[84:87], a[52:55], v[120:123]
    s_add_u32 s52, s47, 524288
    v_accvgpr_read_b32 v56, a168
    v_accvgpr_read_b32 v57, a169
    v_mfma_f32_16x16x32_bf16 v[216:219], a[92:95], a[52:55], v[216:219]
    v_accvgpr_read_b32 v58, a170
    v_accvgpr_read_b32 v59, a171
    v_mfma_f32_16x16x32_bf16 v[216:219], a[88:91], a[48:51], v[216:219]
    ds_read_b64_tr_b16 a[8:9], v43 offset:32768
    v_accvgpr_read_b32 v60, a172
    v_mfma_f32_16x16x32_bf16 v[152:155], a[96:99], a[48:51], v[152:155]
    buffer_store_dwordx4 v[132:135], v1, s[32:35], s52 offen offset:1024 sc1
    ds_read_b64_tr_b16 a[10:11], v43 offset:33792
    v_mfma_f32_16x16x32_bf16 v[152:155], a[100:103], a[52:55], v[152:155]
    v_accvgpr_read_b32 v61, a173
    v_accvgpr_read_b32 v62, a174
    v_mfma_f32_16x16x32_bf16 v[248:251], a[108:111], a[52:55], v[248:251]
    v_accvgpr_read_b32 v63, a175
    v_cvt_pk_bf16_f32 v180, v56, v57
    v_mfma_f32_16x16x32_bf16 v[248:251], a[104:107], a[48:51], v[248:251]
    v_cvt_pk_bf16_f32 v181, v58, v59
    v_cvt_pk_bf16_f32 v88, v88, v89
    v_mfma_f32_16x16x32_bf16 a[176:179], a[112:115], a[48:51], a[176:179]
    v_cvt_pk_bf16_f32 v182, v60, v61
    v_cvt_pk_bf16_f32 v89, v90, v91
    v_mfma_f32_16x16x32_bf16 a[176:179], a[116:119], a[52:55], a[176:179]
    ds_read_b64_tr_b16 a[12:13], v43 offset:40960
    v_cvt_pk_bf16_f32 v183, v62, v63
    v_mfma_f32_16x16x32_bf16 a[180:183], a[124:127], a[52:55], a[180:183]
    v_cvt_pk_bf16_f32 v90, v184, v185
    v_cvt_pk_bf16_f32 v91, v186, v187
    v_mfma_f32_16x16x32_bf16 a[180:183], a[120:123], a[48:51], a[180:183]
    ds_read_b64_tr_b16 a[14:15], v43 offset:41984
    ds_read_b64_tr_b16 a[16:17], v44 offset:32768
    v_mfma_f32_16x16x32_bf16 v[92:95], a[64:67], a[56:59], v[92:95]
    s_add_u32 s52, s47, 532480
    v_cvt_pk_bf16_f32 v120, v120, v121
    v_cvt_pk_bf16_f32 v121, v122, v123
    v_mfma_f32_16x16x32_bf16 v[92:95], a[68:71], a[60:63], v[92:95]
    ds_read_b64_tr_b16 a[18:19], v44 offset:33792
    v_cvt_pk_bf16_f32 v122, v216, v217
    v_mfma_f32_16x16x32_bf16 v[188:191], a[76:79], a[60:63], v[188:191]
    ds_read_b64_tr_b16 a[20:21], v44 offset:40960
    v_cvt_pk_bf16_f32 v123, v218, v219
    v_mfma_f32_16x16x32_bf16 v[188:191], a[72:75], a[56:59], v[188:191]
    ds_read_b64_tr_b16 a[22:23], v44 offset:41984
    v_cvt_pk_bf16_f32 v152, v152, v153
    v_mfma_f32_16x16x32_bf16 v[124:127], a[80:83], a[56:59], v[124:127]
    v_cvt_pk_bf16_f32 v153, v154, v155
    v_cvt_pk_bf16_f32 v154, v248, v249
    v_mfma_f32_16x16x32_bf16 v[124:127], a[84:87], a[60:63], v[124:127]
    ds_read_b64_tr_b16 a[24:25], v45 offset:32768
    v_cvt_pk_bf16_f32 v155, v250, v251
    v_mfma_f32_16x16x32_bf16 v[220:223], a[92:95], a[60:63], v[220:223]
    buffer_store_dwordx4 v[164:167], v1, s[32:35], s52 offen offset:1024 sc1
    ds_read_b64_tr_b16 a[26:27], v45 offset:33792
    v_mfma_f32_16x16x32_bf16 v[220:223], a[88:91], a[56:59], v[220:223]
    ds_read_b64_tr_b16 a[28:29], v45 offset:40960
    v_accvgpr_read_b32 v56, a176
    v_mfma_f32_16x16x32_bf16 v[156:159], a[96:99], a[56:59], v[156:159]
    v_accvgpr_read_b32 v57, a177
    v_accvgpr_read_b32 v58, a178
    v_mfma_f32_16x16x32_bf16 v[156:159], a[100:103], a[60:63], v[156:159]
    ds_read_b64_tr_b16 a[30:31], v45 offset:41984
    v_accvgpr_read_b32 v59, a179
    v_mfma_f32_16x16x32_bf16 v[252:255], a[108:111], a[60:63], v[252:255]
    v_accvgpr_read_b32 v60, a180
    v_accvgpr_read_b32 v61, a181
    v_mfma_f32_16x16x32_bf16 v[252:255], a[104:107], a[56:59], v[252:255]
    v_accvgpr_read_b32 v62, a182
    v_accvgpr_read_b32 v63, a183
    v_mfma_f32_16x16x32_bf16 a[184:187], a[112:115], a[56:59], a[184:187]
    v_cvt_pk_bf16_f32 v184, v56, v57
    v_cvt_pk_bf16_f32 v185, v58, v59
    v_mfma_f32_16x16x32_bf16 a[184:187], a[116:119], a[60:63], a[184:187]
    v_cvt_pk_bf16_f32 v92, v92, v93
    v_cvt_pk_bf16_f32 v186, v60, v61
    v_mfma_f32_16x16x32_bf16 a[188:191], a[124:127], a[60:63], a[188:191]
    v_cvt_pk_bf16_f32 v93, v94, v95
    v_cvt_pk_bf16_f32 v187, v62, v63
    v_mfma_f32_16x16x32_bf16 a[188:191], a[120:123], a[56:59], a[188:191]
    v_cvt_pk_bf16_f32 v94, v188, v189
    v_cvt_pk_bf16_f32 v95, v190, v191
    v_cvt_pk_bf16_f32 v124, v124, v125
    v_cvt_pk_bf16_f32 v125, v126, v127
    v_cvt_pk_bf16_f32 v126, v220, v221
    v_cvt_pk_bf16_f32 v127, v222, v223
    v_cvt_pk_bf16_f32 v156, v156, v157
    v_cvt_pk_bf16_f32 v157, v158, v159
    v_cvt_pk_bf16_f32 v158, v252, v253
    v_cvt_pk_bf16_f32 v159, v254, v255
    v_accvgpr_read_b32 v56, a184
    v_accvgpr_read_b32 v57, a185
    v_accvgpr_read_b32 v58, a186
    v_accvgpr_read_b32 v59, a187
    v_accvgpr_read_b32 v60, a188
    v_accvgpr_read_b32 v61, a189
    v_accvgpr_read_b32 v62, a190
    v_accvgpr_read_b32 v63, a191
    v_cvt_pk_bf16_f32 v188, v56, v57
    v_cvt_pk_bf16_f32 v189, v58, v59
    v_cvt_pk_bf16_f32 v190, v60, v61
    v_cvt_pk_bf16_f32 v191, v62, v63
k12_join_7:
k12_qcode:
    s_mov_b64 s[48:49], s[32:33]
    s_mov_b32 s51, 0x00020000
    s_cmp_eq_u32 s45, 0
    s_mov_b32 s50, s34
    s_cselect_b32 s56, s30, -1
    s_cselect_b32 s57, -1, s30
    s_waitcnt vmcnt(16) lgkmcnt(0)
    v_mfma_f32_16x16x32_bf16 v[192:195], a[0:3], a[192:195], 0
    v_mfma_f32_16x16x32_bf16 v[192:195], a[4:7], a[208:211], v[192:195]
    buffer_load_dwordx4 a[128:131], v36, s[8:11], s62 offen sc1
    ds_read_b64_tr_b16 a[32:33], v46 offset:32768
    v_mfma_f32_16x16x32_bf16 v[196:199], a[4:7], a[212:215], 0
    ds_read_b64_tr_b16 a[34:35], v46 offset:33792
    v_mfma_f32_16x16x32_bf16 v[196:199], a[0:3], a[196:199], v[196:199]
    ds_read_b64_tr_b16 a[36:37], v46 offset:40960
    v_mfma_f32_16x16x32_bf16 a[64:67], a[0:3], a[200:203], 0
    ds_read_b64_tr_b16 a[38:39], v46 offset:41984
    v_mfma_f32_16x16x32_bf16 a[64:67], a[4:7], a[216:219], a[64:67]
    ds_read_b64_tr_b16 a[40:41], v47 offset:32768
    v_mfma_f32_16x16x32_bf16 a[68:71], a[4:7], a[220:223], 0
    s_lshl_b32 s31, s28, 14
    v_mfma_f32_16x16x32_bf16 a[68:71], a[0:3], a[204:207], a[68:71]
    s_add_u32 s16, s6, s31
    s_addc_u32 s17, s7, 0
    buffer_load_dwordx4 a[132:135], v54, s[8:11], s62 offen sc1
    ds_read_b64_tr_b16 a[42:43], v47 offset:33792
    v_mfma_f32_16x16x32_bf16 a[76:79], a[8:11], a[204:207], 0
    ds_read_b64_tr_b16 a[44:45], v47 offset:40960
    v_mfma_f32_16x16x32_bf16 a[76:79], a[12:15], a[220:223], a[76:79]
    s_add_u32 s20, s16, 0x2000000
    s_addc_u32 s21, s17, 0
    ds_read_b64_tr_b16 a[46:47], v47 offset:41984
    v_mfma_f32_16x16x32_bf16 a[72:75], a[12:15], a[216:219], 0
    ds_read_b64_tr_b16 a[48:49], v48 offset:32768
    v_mfma_f32_16x16x32_bf16 a[72:75], a[8:11], a[200:203], a[72:75]
    s_add_u32 s16, s16, 0x1000000
    s_addc_u32 s17, s17, 0
    v_mfma_f32_16x16x32_bf16 v[204:207], a[8:11], a[196:199], 0
    ds_read_b64_tr_b16 a[50:51], v48 offset:33792
    v_mfma_f32_16x16x32_bf16 v[204:207], a[12:15], a[212:215], v[204:207]
    s_and_b32 s17, s17, 0xffff
    ds_read_b64_tr_b16 a[52:53], v48 offset:40960
    v_mfma_f32_16x16x32_bf16 v[200:203], a[12:15], a[208:211], 0
    buffer_load_dwordx4 a[136:139], v37, s[8:11], s62 offen sc1
    ds_read_b64_tr_b16 a[54:55], v48 offset:41984
    v_mfma_f32_16x16x32_bf16 v[200:203], a[8:11], a[192:195], v[200:203]
    s_and_b32 s21, s21, 0xffff
    v_mfma_f32_16x16x32_bf16 v[208:211], a[16:19], a[192:195], 0
    ds_read_b64_tr_b16 a[56:57], v49 offset:32768
    v_mfma_f32_16x16x32_bf16 v[208:211], a[20:23], a[208:211], v[208:211]
    s_lshl_b32 s31, s29, 20
    ds_read_b64_tr_b16 a[58:59], v49 offset:33792
    v_mfma_f32_16x16x32_bf16 v[212:215], a[20:23], a[212:215], 0
    ds_read_b64_tr_b16 a[60:61], v49 offset:40960
    v_mfma_f32_16x16x32_bf16 v[212:215], a[16:19], a[196:199], v[212:215]
    s_sub_u32 s18, 0xf84000, s31
    v_mfma_f32_16x16x32_bf16 a[80:83], a[16:19], a[200:203], 0
    buffer_load_dwordx4 a[140:143], v55, s[8:11], s62 offen sc1
    ds_read_b64_tr_b16 a[62:63], v49 offset:41984
    v_mfma_f32_16x16x32_bf16 a[80:83], a[20:23], a[216:219], a[80:83]
    s_mov_b32 s22, s18
    v_mfma_f32_16x16x32_bf16 a[84:87], a[20:23], a[220:223], 0
    v_mfma_f32_16x16x32_bf16 a[84:87], a[16:19], a[204:207], a[84:87]
    s_add_u32 s24, s6, 0x4806000
    s_addc_u32 s25, s7, 0
    v_mfma_f32_16x16x32_bf16 a[92:95], a[24:27], a[204:207], 0
    v_mfma_f32_16x16x32_bf16 a[92:95], a[28:31], a[220:223], a[92:95]
    s_and_b32 s25, s25, 0xffff
    v_mfma_f32_16x16x32_bf16 a[88:91], a[28:31], a[216:219], 0
    s_add_u32 s62, s62, 0x20000
    v_mfma_f32_16x16x32_bf16 a[88:91], a[24:27], a[200:203], a[88:91]
    s_mov_b32 s26, 4096
    v_mfma_f32_16x16x32_bf16 v[220:223], a[24:27], a[196:199], 0
    s_cmp_eq_u32 s45, 0
    s_cbranch_scc1 k12_ool_48
k12_oolret_49:
    v_mfma_f32_16x16x32_bf16 v[220:223], a[28:31], a[212:215], v[220:223]
    v_mfma_f32_16x16x32_bf16 v[216:219], a[28:31], a[208:211], 0
    v_mfma_f32_16x16x32_bf16 v[216:219], a[24:27], a[192:195], v[216:219]
    s_waitcnt vmcnt(28) lgkmcnt(0)
    s_barrier
    v_mfma_f32_16x16x32_bf16 v[224:227], a[32:35], a[192:195], 0
    v_mfma_f32_16x16x32_bf16 v[224:227], a[36:39], a[208:211], v[224:227]
    s_add_u32 m0, s60, 98304
    ds_read_b64_tr_b16 a[0:1], v42 offset:49152
    ds_read_b64_tr_b16 a[2:3], v42 offset:50176
    v_mfma_f32_16x16x32_bf16 v[228:231], a[36:39], a[212:215], 0
    buffer_load_dwordx4 v38, s[12:15], s61 offen offset:0 lds
    v_mfma_f32_16x16x32_bf16 v[228:231], a[32:35], a[196:199], v[228:231]
    ds_read_b64_tr_b16 a[4:5], v42 offset:57344
    v_mfma_f32_16x16x32_bf16 a[96:99], a[32:35], a[200:203], 0
    buffer_load_dwordx4 v39, s[12:15], s61 offen offset:1024 lds
    ds_read_b64_tr_b16 a[6:7], v42 offset:58368
    v_mfma_f32_16x16x32_bf16 a[96:99], a[36:39], a[216:219], a[96:99]
    ds_read_b64_tr_b16 a[8:9], v43 offset:49152
    v_mfma_f32_16x16x32_bf16 a[100:103], a[36:39], a[220:223], 0
    v_mfma_f32_16x16x32_bf16 a[100:103], a[32:35], a[204:207], a[100:103]
    buffer_load_dwordx4 v40, s[12:15], s61 offen offset:2048 lds
    ds_read_b64_tr_b16 a[10:11], v43 offset:50176
    v_mfma_f32_16x16x32_bf16 a[108:111], a[40:43], a[204:207], 0
    ds_read_b64_tr_b16 a[12:13], v43 offset:57344
    v_mfma_f32_16x16x32_bf16 a[108:111], a[44:47], a[220:223], a[108:111]
    ds_read_b64_tr_b16 a[14:15], v43 offset:58368
    v_mfma_f32_16x16x32_bf16 a[104:107], a[44:47], a[216:219], 0
    buffer_load_dwordx4 v41, s[12:15], s61 offen offset:3072 lds
    ds_read_b64_tr_b16 a[16:17], v44 offset:49152
    v_mfma_f32_16x16x32_bf16 a[104:107], a[40:43], a[200:203], a[104:107]
    v_mfma_f32_16x16x32_bf16 v[236:239], a[40:43], a[196:199], 0
    s_add_u32 s61, s61, 0x80000
    ds_read_b64_tr_b16 a[18:19], v44 offset:50176
    v_mfma_f32_16x16x32_bf16 v[236:239], a[44:47], a[212:215], v[236:239]
    buffer_load_dwordx4 a[144:147], v36, s[8:11], s62 offen sc1
    ds_read_b64_tr_b16 a[20:21], v44 offset:57344
    v_mfma_f32_16x16x32_bf16 v[232:235], a[44:47], a[208:211], 0
    ds_read_b64_tr_b16 a[22:23], v44 offset:58368
    v_mfma_f32_16x16x32_bf16 v[232:235], a[40:43], a[192:195], v[232:235]
    buffer_load_dwordx4 a[148:151], v54, s[8:11], s62 offen sc1
    v_mfma_f32_16x16x32_bf16 v[240:243], a[48:51], a[192:195], 0
    ds_read_b64_tr_b16 a[24:25], v45 offset:49152
    v_mfma_f32_16x16x32_bf16 v[240:243], a[52:55], a[208:211], v[240:243]
    ds_read_b64_tr_b16 a[26:27], v45 offset:50176
    v_mfma_f32_16x16x32_bf16 v[244:247], a[52:55], a[212:215], 0
    buffer_load_dwordx4 a[152:155], v37, s[8:11], s62 offen sc1
    ds_read_b64_tr_b16 a[28:29], v45 offset:57344
    v_mfma_f32_16x16x32_bf16 v[244:247], a[48:51], a[196:199], v[244:247]
    v_mfma_f32_16x16x32_bf16 a[112:115], a[48:51], a[200:203], 0
    ds_read_b64_tr_b16 a[30:31], v45 offset:58368
    v_mfma_f32_16x16x32_bf16 a[112:115], a[52:55], a[216:219], a[112:115]
    buffer_load_dwordx4 a[156:159], v55, s[8:11], s62 offen sc1
    v_mfma_f32_16x16x32_bf16 a[116:119], a[52:55], a[220:223], 0
    v_mfma_f32_16x16x32_bf16 a[116:119], a[48:51], a[204:207], a[116:119]
    s_add_u32 s62, s62, 0x20000
    v_mfma_f32_16x16x32_bf16 a[124:127], a[56:59], a[204:207], 0
    s_add_u32 s52, s47, 0
    v_mfma_f32_16x16x32_bf16 a[124:127], a[60:63], a[220:223], a[124:127]
    buffer_store_dwordx4 v[72:75], v1, s[48:51], s52 offen offset:2048 sc1
    v_mfma_f32_16x16x32_bf16 a[120:123], a[60:63], a[216:219], 0
    v_mfma_f32_16x16x32_bf16 a[120:123], a[56:59], a[200:203], a[120:123]
    v_mfma_f32_16x16x32_bf16 v[252:255], a[56:59], a[196:199], 0
    v_mfma_f32_16x16x32_bf16 v[252:255], a[60:63], a[212:215], v[252:255]
    v_mfma_f32_16x16x32_bf16 v[248:251], a[60:63], a[208:211], 0
    v_mfma_f32_16x16x32_bf16 v[248:251], a[56:59], a[192:195], v[248:251]
    s_waitcnt vmcnt(21) lgkmcnt(0)
    v_mfma_f32_16x16x32_bf16 v[192:195], a[0:3], a[224:227], v[192:195]
    v_mfma_f32_16x16x32_bf16 v[192:195], a[4:7], a[240:243], v[192:195]
    buffer_load_dwordx4 a[160:163], v36, s[8:11], s62 offen sc1
    ds_read_b64_tr_b16 a[32:33], v46 offset:49152
    v_mfma_f32_16x16x32_bf16 v[196:199], a[4:7], a[244:247], v[196:199]
    ds_read_b64_tr_b16 a[34:35], v46 offset:50176
    v_mfma_f32_16x16x32_bf16 v[196:199], a[0:3], a[228:231], v[196:199]
    ds_read_b64_tr_b16 a[36:37], v46 offset:57344
    v_mfma_f32_16x16x32_bf16 a[64:67], a[0:3], a[232:235], a[64:67]
    ds_read_b64_tr_b16 a[38:39], v46 offset:58368
    v_mfma_f32_16x16x32_bf16 a[64:67], a[4:7], a[248:251], a[64:67]
    ds_read_b64_tr_b16 a[40:41], v47 offset:49152
    v_mfma_f32_16x16x32_bf16 a[68:71], a[4:7], a[252:255], a[68:71]
    buffer_load_dwordx4 a[164:167], v54, s[8:11], s62 offen sc1
    v_mfma_f32_16x16x32_bf16 a[68:71], a[0:3], a[236:239], a[68:71]
    ds_read_b64_tr_b16 a[42:43], v47 offset:50176
    v_mfma_f32_16x16x32_bf16 a[76:79], a[8:11], a[236:239], a[76:79]
    ds_read_b64_tr_b16 a[44:45], v47 offset:57344
    v_mfma_f32_16x16x32_bf16 a[76:79], a[12:15], a[252:255], a[76:79]
    ds_read_b64_tr_b16 a[46:47], v47 offset:58368
    v_mfma_f32_16x16x32_bf16 a[72:75], a[12:15], a[248:251], a[72:75]
    ds_read_b64_tr_b16 a[48:49], v48 offset:49152
    v_mfma_f32_16x16x32_bf16 a[72:75], a[8:11], a[232:235], a[72:75]
    buffer_load_dwordx4 a[168:171], v37, s[8:11], s62 offen sc1
    v_mfma_f32_16x16x32_bf16 v[204:207], a[8:11], a[228:231], v[204:207]
    ds_read_b64_tr_b16 a[50:51], v48 offset:50176
    v_mfma_f32_16x16x32_bf16 v[204:207], a[12:15], a[244:247], v[204:207]
    ds_read_b64_tr_b16 a[52:53], v48 offset:57344
    v_mfma_f32_16x16x32_bf16 v[200:203], a[12:15], a[240:243], v[200:203]
    ds_read_b64_tr_b16 a[54:55], v48 offset:58368
    v_mfma_f32_16x16x32_bf16 v[200:203], a[8:11], a[224:227], v[200:203]
    v_mfma_f32_16x16x32_bf16 v[208:211], a[16:19], a[224:227], v[208:211]
    ds_read_b64_tr_b16 a[56:57], v49 offset:49152
    v_mfma_f32_16x16x32_bf16 v[208:211], a[20:23], a[240:243], v[208:211]
    buffer_load_dwordx4 a[172:175], v55, s[8:11], s62 offen sc1
    ds_read_b64_tr_b16 a[58:59], v49 offset:50176
    v_mfma_f32_16x16x32_bf16 v[212:215], a[20:23], a[244:247], v[212:215]
    ds_read_b64_tr_b16 a[60:61], v49 offset:57344
    v_mfma_f32_16x16x32_bf16 v[212:215], a[16:19], a[228:231], v[212:215]
    v_mfma_f32_16x16x32_bf16 a[80:83], a[16:19], a[232:235], a[80:83]
    ds_read_b64_tr_b16 a[62:63], v49 offset:58368
    v_mfma_f32_16x16x32_bf16 a[80:83], a[20:23], a[248:251], a[80:83]
    s_add_u32 s62, s62, 0x20000
    v_mfma_f32_16x16x32_bf16 a[84:87], a[20:23], a[252:255], a[84:87]
    s_add_u32 s52, s47, 0
    v_mfma_f32_16x16x32_bf16 a[84:87], a[16:19], a[236:239], a[84:87]
    buffer_store_dwordx4 v[76:79], v1, s[48:51], s52 offen offset:3072 sc1
    v_mfma_f32_16x16x32_bf16 a[92:95], a[24:27], a[236:239], a[92:95]
    v_mfma_f32_16x16x32_bf16 a[92:95], a[28:31], a[252:255], a[92:95]
    v_mfma_f32_16x16x32_bf16 a[88:91], a[28:31], a[248:251], a[88:91]
    v_mfma_f32_16x16x32_bf16 a[88:91], a[24:27], a[232:235], a[88:91]
    v_mfma_f32_16x16x32_bf16 v[220:223], a[24:27], a[228:231], v[220:223]
    s_cmp_eq_u32 s45, 0
    s_cbranch_scc1 k12_ool_50
k12_oolret_51:
    v_mfma_f32_16x16x32_bf16 v[220:223], a[28:31], a[244:247], v[220:223]
    v_mfma_f32_16x16x32_bf16 v[216:219], a[28:31], a[240:243], v[216:219]
    v_mfma_f32_16x16x32_bf16 v[216:219], a[24:27], a[224:227], v[216:219]
    s_waitcnt vmcnt(10) lgkmcnt(0)
    s_barrier
    v_mfma_f32_16x16x32_bf16 v[224:227], a[32:35], a[224:227], v[224:227]
    v_mfma_f32_16x16x32_bf16 v[224:227], a[36:39], a[240:243], v[224:227]
    s_add_u32 m0, s60, 114688
    ds_read_b64_tr_b16 a[0:1], v42 offset:0
    ds_read_b64_tr_b16 a[2:3], v42 offset:1024
    v_mfma_f32_16x16x32_bf16 v[228:231], a[36:39], a[244:247], v[228:231]
    buffer_load_dwordx4 v38, s[12:15], s61 offen offset:0 lds
    v_mfma_f32_16x16x32_bf16 v[228:231], a[32:35], a[228:231], v[228:231]
    ds_read_b64_tr_b16 a[4:5], v42 offset:8192
    v_mfma_f32_16x16x32_bf16 a[96:99], a[32:35], a[232:235], a[96:99]
    buffer_load_dwordx4 v39, s[12:15], s61 offen offset:1024 lds
    ds_read_b64_tr_b16 a[6:7], v42 offset:9216
    v_mfma_f32_16x16x32_bf16 a[96:99], a[36:39], a[248:251], a[96:99]
    ds_read_b64_tr_b16 a[8:9], v43 offset:0
    v_mfma_f32_16x16x32_bf16 a[100:103], a[36:39], a[252:255], a[100:103]
    v_mfma_f32_16x16x32_bf16 a[100:103], a[32:35], a[236:239], a[100:103]
    buffer_load_dwordx4 v40, s[12:15], s61 offen offset:2048 lds
    ds_read_b64_tr_b16 a[10:11], v43 offset:1024
    v_mfma_f32_16x16x32_bf16 a[108:111], a[40:43], a[236:239], a[108:111]
    ds_read_b64_tr_b16 a[12:13], v43 offset:8192
    v_mfma_f32_16x16x32_bf16 a[108:111], a[44:47], a[252:255], a[108:111]
    ds_read_b64_tr_b16 a[14:15], v43 offset:9216
    v_mfma_f32_16x16x32_bf16 a[104:107], a[44:47], a[248:251], a[104:107]
    buffer_load_dwordx4 v41, s[12:15], s61 offen offset:3072 lds
    ds_read_b64_tr_b16 a[16:17], v44 offset:0
    v_mfma_f32_16x16x32_bf16 a[104:107], a[40:43], a[232:235], a[104:107]
    v_mfma_f32_16x16x32_bf16 v[236:239], a[40:43], a[228:231], v[236:239]
    s_add_u32 s61, s61, 0x80000
    ds_read_b64_tr_b16 a[18:19], v44 offset:1024
    v_mfma_f32_16x16x32_bf16 v[236:239], a[44:47], a[244:247], v[236:239]
    buffer_load_dwordx4 a[176:179], v36, s[8:11], s62 offen sc1
    ds_read_b64_tr_b16 a[20:21], v44 offset:8192
    v_mfma_f32_16x16x32_bf16 v[232:235], a[44:47], a[240:243], v[232:235]
    ds_read_b64_tr_b16 a[22:23], v44 offset:9216
    v_mfma_f32_16x16x32_bf16 v[232:235], a[40:43], a[224:227], v[232:235]
    buffer_load_dwordx4 a[180:183], v54, s[8:11], s62 offen sc1
    v_mfma_f32_16x16x32_bf16 v[240:243], a[48:51], a[224:227], v[240:243]
    ds_read_b64_tr_b16 a[24:25], v45 offset:0
    v_mfma_f32_16x16x32_bf16 v[240:243], a[52:55], a[240:243], v[240:243]
    ds_read_b64_tr_b16 a[26:27], v45 offset:1024
    v_mfma_f32_16x16x32_bf16 v[244:247], a[52:55], a[244:247], v[244:247]
    buffer_load_dwordx4 a[184:187], v37, s[8:11], s62 offen sc1
    ds_read_b64_tr_b16 a[28:29], v45 offset:8192
    v_mfma_f32_16x16x32_bf16 v[244:247], a[48:51], a[228:231], v[244:247]
    v_mfma_f32_16x16x32_bf16 a[112:115], a[48:51], a[232:235], a[112:115]
    ds_read_b64_tr_b16 a[30:31], v45 offset:9216
    v_mfma_f32_16x16x32_bf16 a[112:115], a[52:55], a[248:251], a[112:115]
    buffer_load_dwordx4 a[188:191], v55, s[8:11], s62 offen sc1
    v_mfma_f32_16x16x32_bf16 a[116:119], a[52:55], a[252:255], a[116:119]
    v_mfma_f32_16x16x32_bf16 a[116:119], a[48:51], a[236:239], a[116:119]
    s_add_u32 s62, s62, 0x20000
    v_mfma_f32_16x16x32_bf16 a[124:127], a[56:59], a[236:239], a[124:127]
    s_add_u32 s52, s47, 4096
    v_mfma_f32_16x16x32_bf16 a[124:127], a[60:63], a[252:255], a[124:127]
    buffer_store_dwordx4 v[80:83], v1, s[48:51], s52 offen offset:0 sc1
    v_mfma_f32_16x16x32_bf16 a[120:123], a[60:63], a[248:251], a[120:123]
    v_mfma_f32_16x16x32_bf16 a[120:123], a[56:59], a[232:235], a[120:123]
    v_mfma_f32_16x16x32_bf16 v[252:255], a[56:59], a[228:231], v[252:255]
    v_mfma_f32_16x16x32_bf16 v[252:255], a[60:63], a[244:247], v[252:255]
    v_mfma_f32_16x16x32_bf16 v[248:251], a[60:63], a[240:243], v[248:251]
    v_mfma_f32_16x16x32_bf16 v[248:251], a[56:59], a[224:227], v[248:251]
    s_waitcnt vmcnt(15) lgkmcnt(0)
    v_mfma_f32_16x16x32_bf16 v[192:195], a[0:3], a[128:131], v[192:195]
    v_mfma_f32_16x16x32_bf16 v[192:195], a[4:7], a[144:147], v[192:195]
    buffer_load_dwordx4 a[192:195], v36, s[8:11], s62 offen sc1
    ds_read_b64_tr_b16 a[32:33], v46 offset:0
    v_mfma_f32_16x16x32_bf16 v[196:199], a[4:7], a[148:151], v[196:199]
    ds_read_b64_tr_b16 a[34:35], v46 offset:1024
    v_mfma_f32_16x16x32_bf16 v[196:199], a[0:3], a[132:135], v[196:199]
    ds_read_b64_tr_b16 a[36:37], v46 offset:8192
    v_mfma_f32_16x16x32_bf16 a[64:67], a[0:3], a[136:139], a[64:67]
    ds_read_b64_tr_b16 a[38:39], v46 offset:9216
    v_mfma_f32_16x16x32_bf16 a[64:67], a[4:7], a[152:155], a[64:67]
    ds_read_b64_tr_b16 a[40:41], v47 offset:0
    v_mfma_f32_16x16x32_bf16 a[68:71], a[4:7], a[156:159], a[68:71]
    buffer_load_dwordx4 a[196:199], v54, s[8:11], s62 offen sc1
    v_mfma_f32_16x16x32_bf16 a[68:71], a[0:3], a[140:143], a[68:71]
    ds_read_b64_tr_b16 a[42:43], v47 offset:1024
    v_mfma_f32_16x16x32_bf16 a[76:79], a[8:11], a[140:143], a[76:79]
    ds_read_b64_tr_b16 a[44:45], v47 offset:8192
    v_mfma_f32_16x16x32_bf16 a[76:79], a[12:15], a[156:159], a[76:79]
    ds_read_b64_tr_b16 a[46:47], v47 offset:9216
    v_mfma_f32_16x16x32_bf16 a[72:75], a[12:15], a[152:155], a[72:75]
    ds_read_b64_tr_b16 a[48:49], v48 offset:0
    v_mfma_f32_16x16x32_bf16 a[72:75], a[8:11], a[136:139], a[72:75]
    buffer_load_dwordx4 a[200:203], v37, s[8:11], s62 offen sc1
    v_mfma_f32_16x16x32_bf16 v[204:207], a[8:11], a[132:135], v[204:207]
    ds_read_b64_tr_b16 a[50:51], v48 offset:1024
    v_mfma_f32_16x16x32_bf16 v[204:207], a[12:15], a[148:151], v[204:207]
    ds_read_b64_tr_b16 a[52:53], v48 offset:8192
    v_mfma_f32_16x16x32_bf16 v[200:203], a[12:15], a[144:147], v[200:203]
    ds_read_b64_tr_b16 a[54:55], v48 offset:9216
    v_mfma_f32_16x16x32_bf16 v[200:203], a[8:11], a[128:131], v[200:203]
    v_mfma_f32_16x16x32_bf16 v[208:211], a[16:19], a[128:131], v[208:211]
    ds_read_b64_tr_b16 a[56:57], v49 offset:0
    v_mfma_f32_16x16x32_bf16 v[208:211], a[20:23], a[144:147], v[208:211]
    buffer_load_dwordx4 a[204:207], v55, s[8:11], s62 offen sc1
    ds_read_b64_tr_b16 a[58:59], v49 offset:1024
    v_mfma_f32_16x16x32_bf16 v[212:215], a[20:23], a[148:151], v[212:215]
    ds_read_b64_tr_b16 a[60:61], v49 offset:8192
    v_mfma_f32_16x16x32_bf16 v[212:215], a[16:19], a[132:135], v[212:215]
    v_mfma_f32_16x16x32_bf16 a[80:83], a[16:19], a[136:139], a[80:83]
    ds_read_b64_tr_b16 a[62:63], v49 offset:9216
    v_mfma_f32_16x16x32_bf16 a[80:83], a[20:23], a[152:155], a[80:83]
    s_add_u32 s62, s62, 0x20000
    v_mfma_f32_16x16x32_bf16 a[84:87], a[20:23], a[156:159], a[84:87]
    s_add_u32 s52, s47, 4096
    v_mfma_f32_16x16x32_bf16 a[84:87], a[16:19], a[140:143], a[84:87]
    buffer_store_dwordx4 v[84:87], v1, s[48:51], s52 offen offset:1024 sc1
    v_mfma_f32_16x16x32_bf16 a[92:95], a[24:27], a[140:143], a[92:95]
    v_mfma_f32_16x16x32_bf16 a[92:95], a[28:31], a[156:159], a[92:95]
    v_mfma_f32_16x16x32_bf16 a[88:91], a[28:31], a[152:155], a[88:91]
    v_mfma_f32_16x16x32_bf16 a[88:91], a[24:27], a[136:139], a[88:91]
    v_mfma_f32_16x16x32_bf16 v[220:223], a[24:27], a[132:135], v[220:223]
    v_mfma_f32_16x16x32_bf16 v[220:223], a[28:31], a[148:151], v[220:223]
    v_mfma_f32_16x16x32_bf16 v[216:219], a[28:31], a[144:147], v[216:219]
    v_mfma_f32_16x16x32_bf16 v[216:219], a[24:27], a[128:131], v[216:219]
    s_waitcnt vmcnt(10) lgkmcnt(0)
    s_barrier
    v_mfma_f32_16x16x32_bf16 v[224:227], a[32:35], a[128:131], v[224:227]
    v_mfma_f32_16x16x32_bf16 v[224:227], a[36:39], a[144:147], v[224:227]
    s_add_u32 m0, s60, 131072
    ds_read_b64_tr_b16 a[0:1], v42 offset:16384
    ds_read_b64_tr_b16 a[2:3], v42 offset:17408
    v_mfma_f32_16x16x32_bf16 v[228:231], a[36:39], a[148:151], v[228:231]
    buffer_load_dwordx4 v38, s[12:15], s61 offen offset:0 lds
    v_mfma_f32_16x16x32_bf16 v[228:231], a[32:35], a[132:135], v[228:231]
    ds_read_b64_tr_b16 a[4:5], v42 offset:24576
    v_mfma_f32_16x16x32_bf16 a[96:99], a[32:35], a[136:139], a[96:99]
    buffer_load_dwordx4 v39, s[12:15], s61 offen offset:1024 lds
    ds_read_b64_tr_b16 a[6:7], v42 offset:25600
    v_mfma_f32_16x16x32_bf16 a[96:99], a[36:39], a[152:155], a[96:99]
    ds_read_b64_tr_b16 a[8:9], v43 offset:16384
    v_mfma_f32_16x16x32_bf16 a[100:103], a[36:39], a[156:159], a[100:103]
    v_mfma_f32_16x16x32_bf16 a[100:103], a[32:35], a[140:143], a[100:103]
    buffer_load_dwordx4 v40, s[12:15], s61 offen offset:2048 lds
    ds_read_b64_tr_b16 a[10:11], v43 offset:17408
    v_mfma_f32_16x16x32_bf16 a[108:111], a[40:43], a[140:143], a[108:111]
    ds_read_b64_tr_b16 a[12:13], v43 offset:24576
    v_mfma_f32_16x16x32_bf16 a[108:111], a[44:47], a[156:159], a[108:111]
    ds_read_b64_tr_b16 a[14:15], v43 offset:25600
    v_mfma_f32_16x16x32_bf16 a[104:107], a[44:47], a[152:155], a[104:107]
    ds_read_b64_tr_b16 a[16:17], v44 offset:16384
    v_mfma_f32_16x16x32_bf16 a[104:107], a[40:43], a[136:139], a[104:107]
    buffer_load_dwordx4 v41, s[12:15], s61 offen offset:3072 lds
    v_mfma_f32_16x16x32_bf16 v[236:239], a[40:43], a[132:135], v[236:239]
    ds_read_b64_tr_b16 a[18:19], v44 offset:17408
    v_mfma_f32_16x16x32_bf16 v[236:239], a[44:47], a[148:151], v[236:239]
    s_add_u32 s61, s61, 0x80000
    ds_read_b64_tr_b16 a[20:21], v44 offset:24576
    v_mfma_f32_16x16x32_bf16 v[232:235], a[44:47], a[144:147], v[232:235]
    buffer_load_dwordx4 a[208:211], v36, s[8:11], s62 offen sc1
    ds_read_b64_tr_b16 a[22:23], v44 offset:25600
    v_mfma_f32_16x16x32_bf16 v[232:235], a[40:43], a[128:131], v[232:235]
    v_mfma_f32_16x16x32_bf16 v[240:243], a[48:51], a[128:131], v[240:243]
    ds_read_b64_tr_b16 a[24:25], v45 offset:16384
    v_mfma_f32_16x16x32_bf16 v[240:243], a[52:55], a[144:147], v[240:243]
    buffer_load_dwordx4 a[212:215], v54, s[8:11], s62 offen sc1
    ds_read_b64_tr_b16 a[26:27], v45 offset:17408
    v_mfma_f32_16x16x32_bf16 v[244:247], a[52:55], a[148:151], v[244:247]
    ds_read_b64_tr_b16 a[28:29], v45 offset:24576
    v_mfma_f32_16x16x32_bf16 v[244:247], a[48:51], a[132:135], v[244:247]
    v_mfma_f32_16x16x32_bf16 a[112:115], a[48:51], a[136:139], a[112:115]
    buffer_load_dwordx4 a[216:219], v37, s[8:11], s62 offen sc1
    ds_read_b64_tr_b16 a[30:31], v45 offset:25600
    v_mfma_f32_16x16x32_bf16 a[112:115], a[52:55], a[152:155], a[112:115]
    v_mfma_f32_16x16x32_bf16 a[116:119], a[52:55], a[156:159], a[116:119]
    v_mfma_f32_16x16x32_bf16 a[116:119], a[48:51], a[140:143], a[116:119]
    v_mfma_f32_16x16x32_bf16 a[124:127], a[56:59], a[140:143], a[124:127]
    buffer_load_dwordx4 a[220:223], v55, s[8:11], s62 offen sc1
    v_mfma_f32_16x16x32_bf16 a[124:127], a[60:63], a[156:159], a[124:127]
    v_mfma_f32_16x16x32_bf16 a[120:123], a[60:63], a[152:155], a[120:123]
    s_add_u32 s62, s62, 0x20000
    v_mfma_f32_16x16x32_bf16 a[120:123], a[56:59], a[136:139], a[120:123]
    v_mfma_f32_16x16x32_bf16 v[252:255], a[56:59], a[132:135], v[252:255]
    s_cmp_eq_u32 s45, 0
    s_cbranch_scc1 k12_ool_52
k12_oolret_53:
    v_mfma_f32_16x16x32_bf16 v[252:255], a[60:63], a[148:151], v[252:255]
    v_mfma_f32_16x16x32_bf16 v[248:251], a[60:63], a[144:147], v[248:251]
    v_mfma_f32_16x16x32_bf16 v[248:251], a[56:59], a[128:131], v[248:251]
    s_waitcnt vmcnt(14) lgkmcnt(0)
    v_mfma_f32_16x16x32_bf16 v[192:195], a[0:3], a[160:163], v[192:195]
    v_mfma_f32_16x16x32_bf16 v[192:195], a[4:7], a[176:179], v[192:195]
    buffer_load_dwordx4 a[224:227], v36, s[8:11], s62 offen sc1
    ds_read_b64_tr_b16 a[32:33], v46 offset:16384
    v_mfma_f32_16x16x32_bf16 v[196:199], a[4:7], a[180:183], v[196:199]
    ds_read_b64_tr_b16 a[34:35], v46 offset:17408
    v_mfma_f32_16x16x32_bf16 v[196:199], a[0:3], a[164:167], v[196:199]
    ds_read_b64_tr_b16 a[36:37], v46 offset:24576
    v_mfma_f32_16x16x32_bf16 a[64:67], a[0:3], a[168:171], a[64:67]
    ds_read_b64_tr_b16 a[38:39], v46 offset:25600
    v_mfma_f32_16x16x32_bf16 a[64:67], a[4:7], a[184:187], a[64:67]
    ds_read_b64_tr_b16 a[40:41], v47 offset:16384
    v_mfma_f32_16x16x32_bf16 a[68:71], a[4:7], a[188:191], a[68:71]
    buffer_load_dwordx4 a[228:231], v54, s[8:11], s62 offen sc1
    v_mfma_f32_16x16x32_bf16 a[68:71], a[0:3], a[172:175], a[68:71]
    ds_read_b64_tr_b16 a[42:43], v47 offset:17408
    v_mfma_f32_16x16x32_bf16 a[76:79], a[8:11], a[172:175], a[76:79]
    ds_read_b64_tr_b16 a[44:45], v47 offset:24576
    v_mfma_f32_16x16x32_bf16 a[76:79], a[12:15], a[188:191], a[76:79]
    ds_read_b64_tr_b16 a[46:47], v47 offset:25600
    v_mfma_f32_16x16x32_bf16 a[72:75], a[12:15], a[184:187], a[72:75]
    ds_read_b64_tr_b16 a[48:49], v48 offset:16384
    v_mfma_f32_16x16x32_bf16 a[72:75], a[8:11], a[168:171], a[72:75]
    buffer_load_dwordx4 a[232:235], v37, s[8:11], s62 offen sc1
    v_mfma_f32_16x16x32_bf16 v[204:207], a[8:11], a[164:167], v[204:207]
    ds_read_b64_tr_b16 a[50:51], v48 offset:17408
    v_mfma_f32_16x16x32_bf16 v[204:207], a[12:15], a[180:183], v[204:207]
    ds_read_b64_tr_b16 a[52:53], v48 offset:24576
    v_mfma_f32_16x16x32_bf16 v[200:203], a[12:15], a[176:179], v[200:203]
    ds_read_b64_tr_b16 a[54:55], v48 offset:25600
    v_mfma_f32_16x16x32_bf16 v[200:203], a[8:11], a[160:163], v[200:203]
    v_mfma_f32_16x16x32_bf16 v[208:211], a[16:19], a[160:163], v[208:211]
    ds_read_b64_tr_b16 a[56:57], v49 offset:16384
    v_mfma_f32_16x16x32_bf16 v[208:211], a[20:23], a[176:179], v[208:211]
    buffer_load_dwordx4 a[236:239], v55, s[8:11], s62 offen sc1
    ds_read_b64_tr_b16 a[58:59], v49 offset:17408
    v_mfma_f32_16x16x32_bf16 v[212:215], a[20:23], a[180:183], v[212:215]
    ds_read_b64_tr_b16 a[60:61], v49 offset:24576
    v_mfma_f32_16x16x32_bf16 v[212:215], a[16:19], a[164:167], v[212:215]
    v_mfma_f32_16x16x32_bf16 a[80:83], a[16:19], a[168:171], a[80:83]
    ds_read_b64_tr_b16 a[62:63], v49 offset:25600
    v_mfma_f32_16x16x32_bf16 a[80:83], a[20:23], a[184:187], a[80:83]
    s_add_u32 s62, s62, 0x20000
    v_mfma_f32_16x16x32_bf16 a[84:87], a[20:23], a[188:191], a[84:87]
    s_add_u32 s52, s47, 4096
    v_mfma_f32_16x16x32_bf16 a[84:87], a[16:19], a[172:175], a[84:87]
    buffer_store_dwordx4 v[88:91], v1, s[48:51], s52 offen offset:2048 sc1
    v_mfma_f32_16x16x32_bf16 a[92:95], a[24:27], a[172:175], a[92:95]
    v_mfma_f32_16x16x32_bf16 a[92:95], a[28:31], a[188:191], a[92:95]
    v_mfma_f32_16x16x32_bf16 a[88:91], a[28:31], a[184:187], a[88:91]
    v_mfma_f32_16x16x32_bf16 a[88:91], a[24:27], a[168:171], a[88:91]
    v_mfma_f32_16x16x32_bf16 v[220:223], a[24:27], a[164:167], v[220:223]
    v_mfma_f32_16x16x32_bf16 v[220:223], a[28:31], a[180:183], v[220:223]
    v_mfma_f32_16x16x32_bf16 v[216:219], a[28:31], a[176:179], v[216:219]
    v_mfma_f32_16x16x32_bf16 v[216:219], a[24:27], a[160:163], v[216:219]
    s_waitcnt vmcnt(9) lgkmcnt(0)
    s_barrier
    v_mfma_f32_16x16x32_bf16 v[224:227], a[32:35], a[160:163], v[224:227]
    v_mfma_f32_16x16x32_bf16 v[224:227], a[36:39], a[176:179], v[224:227]
    s_add_u32 m0, s60, 147456
    ds_read_b64_tr_b16 a[0:1], v42 offset:32768
    ds_read_b64_tr_b16 a[2:3], v42 offset:33792
    v_mfma_f32_16x16x32_bf16 v[228:231], a[36:39], a[180:183], v[228:231]
    buffer_load_dwordx4 v38, s[12:15], s61 offen offset:0 lds
    v_mfma_f32_16x16x32_bf16 v[228:231], a[32:35], a[164:167], v[228:231]
    ds_read_b64_tr_b16 a[4:5], v42 offset:40960
    v_mfma_f32_16x16x32_bf16 a[96:99], a[32:35], a[168:171], a[96:99]
    buffer_load_dwordx4 v39, s[12:15], s61 offen offset:1024 lds
    ds_read_b64_tr_b16 a[6:7], v42 offset:41984
    v_mfma_f32_16x16x32_bf16 a[96:99], a[36:39], a[184:187], a[96:99]
    ds_read_b64_tr_b16 a[8:9], v43 offset:32768
    v_mfma_f32_16x16x32_bf16 a[100:103], a[36:39], a[188:191], a[100:103]
    v_mfma_f32_16x16x32_bf16 a[100:103], a[32:35], a[172:175], a[100:103]
    buffer_load_dwordx4 v40, s[12:15], s61 offen offset:2048 lds
    ds_read_b64_tr_b16 a[10:11], v43 offset:33792
    v_mfma_f32_16x16x32_bf16 a[108:111], a[40:43], a[172:175], a[108:111]
    ds_read_b64_tr_b16 a[12:13], v43 offset:40960
    v_mfma_f32_16x16x32_bf16 a[108:111], a[44:47], a[188:191], a[108:111]
    ds_read_b64_tr_b16 a[14:15], v43 offset:41984
    v_mfma_f32_16x16x32_bf16 a[104:107], a[44:47], a[184:187], a[104:107]
    buffer_load_dwordx4 v41, s[12:15], s61 offen offset:3072 lds
    ds_read_b64_tr_b16 a[16:17], v44 offset:32768
    v_mfma_f32_16x16x32_bf16 a[104:107], a[40:43], a[168:171], a[104:107]
    v_mfma_f32_16x16x32_bf16 v[236:239], a[40:43], a[164:167], v[236:239]
    s_add_u32 s61, s61, 0x80000
    ds_read_b64_tr_b16 a[18:19], v44 offset:33792
    v_mfma_f32_16x16x32_bf16 v[236:239], a[44:47], a[180:183], v[236:239]
    buffer_load_dwordx4 a[240:243], v36, s[8:11], s62 offen sc1
    ds_read_b64_tr_b16 a[20:21], v44 offset:40960
    v_mfma_f32_16x16x32_bf16 v[232:235], a[44:47], a[176:179], v[232:235]
    ds_read_b64_tr_b16 a[22:23], v44 offset:41984
    v_mfma_f32_16x16x32_bf16 v[232:235], a[40:43], a[160:163], v[232:235]
    buffer_load_dwordx4 a[244:247], v54, s[8:11], s62 offen sc1
    v_mfma_f32_16x16x32_bf16 v[240:243], a[48:51], a[160:163], v[240:243]
    ds_read_b64_tr_b16 a[24:25], v45 offset:32768
    v_mfma_f32_16x16x32_bf16 v[240:243], a[52:55], a[176:179], v[240:243]
    ds_read_b64_tr_b16 a[26:27], v45 offset:33792
    v_mfma_f32_16x16x32_bf16 v[244:247], a[52:55], a[180:183], v[244:247]
    buffer_load_dwordx4 a[248:251], v37, s[8:11], s62 offen sc1
    ds_read_b64_tr_b16 a[28:29], v45 offset:40960
    v_mfma_f32_16x16x32_bf16 v[244:247], a[48:51], a[164:167], v[244:247]
    v_mfma_f32_16x16x32_bf16 a[112:115], a[48:51], a[168:171], a[112:115]
    ds_read_b64_tr_b16 a[30:31], v45 offset:41984
    v_mfma_f32_16x16x32_bf16 a[112:115], a[52:55], a[184:187], a[112:115]
    buffer_load_dwordx4 a[252:255], v55, s[8:11], s62 offen sc1
    v_mfma_f32_16x16x32_bf16 a[116:119], a[52:55], a[188:191], a[116:119]
    v_mfma_f32_16x16x32_bf16 a[116:119], a[48:51], a[172:175], a[116:119]
    s_add_u32 s62, s62, 0x20000
    v_mfma_f32_16x16x32_bf16 a[124:127], a[56:59], a[172:175], a[124:127]
    s_add_u32 s52, s47, 4096
    v_mfma_f32_16x16x32_bf16 a[124:127], a[60:63], a[188:191], a[124:127]
    buffer_store_dwordx4 v[92:95], v1, s[48:51], s52 offen offset:3072 sc1
    v_mfma_f32_16x16x32_bf16 a[120:123], a[60:63], a[184:187], a[120:123]
    v_mfma_f32_16x16x32_bf16 a[120:123], a[56:59], a[168:171], a[120:123]
    v_mfma_f32_16x16x32_bf16 v[252:255], a[56:59], a[164:167], v[252:255]
    s_cmp_eq_u32 s45, 0
    s_cbranch_scc1 k12_ool_54
k12_oolret_55:
    v_mfma_f32_16x16x32_bf16 v[252:255], a[60:63], a[180:183], v[252:255]
    v_mfma_f32_16x16x32_bf16 v[248:251], a[60:63], a[176:179], v[248:251]
    v_mfma_f32_16x16x32_bf16 v[248:251], a[56:59], a[160:163], v[248:251]
    s_waitcnt vmcnt(14) lgkmcnt(0)
    v_mfma_f32_16x16x32_bf16 v[192:195], a[0:3], a[192:195], v[192:195]
    v_mfma_f32_16x16x32_bf16 v[192:195], a[4:7], a[208:211], v[192:195]
    buffer_load_dwordx4 a[128:131], v36, s[8:11], s62 offen sc1
    ds_read_b64_tr_b16 a[32:33], v46 offset:32768
    v_mfma_f32_16x16x32_bf16 v[196:199], a[4:7], a[212:215], v[196:199]
    ds_read_b64_tr_b16 a[34:35], v46 offset:33792
    v_mfma_f32_16x16x32_bf16 v[196:199], a[0:3], a[196:199], v[196:199]
    ds_read_b64_tr_b16 a[36:37], v46 offset:40960
    v_mfma_f32_16x16x32_bf16 a[64:67], a[0:3], a[200:203], a[64:67]
    ds_read_b64_tr_b16 a[38:39], v46 offset:41984
    v_mfma_f32_16x16x32_bf16 a[64:67], a[4:7], a[216:219], a[64:67]
    ds_read_b64_tr_b16 a[40:41], v47 offset:32768
    v_mfma_f32_16x16x32_bf16 a[68:71], a[4:7], a[220:223], a[68:71]
    buffer_load_dwordx4 a[132:135], v54, s[8:11], s62 offen sc1
    v_mfma_f32_16x16x32_bf16 a[68:71], a[0:3], a[204:207], a[68:71]
    ds_read_b64_tr_b16 a[42:43], v47 offset:33792
    v_mfma_f32_16x16x32_bf16 a[76:79], a[8:11], a[204:207], a[76:79]
    ds_read_b64_tr_b16 a[44:45], v47 offset:40960
    v_mfma_f32_16x16x32_bf16 a[76:79], a[12:15], a[220:223], a[76:79]
    ds_read_b64_tr_b16 a[46:47], v47 offset:41984
    v_mfma_f32_16x16x32_bf16 a[72:75], a[12:15], a[216:219], a[72:75]
    ds_read_b64_tr_b16 a[48:49], v48 offset:32768
    v_mfma_f32_16x16x32_bf16 a[72:75], a[8:11], a[200:203], a[72:75]
    buffer_load_dwordx4 a[136:139], v37, s[8:11], s62 offen sc1
    v_mfma_f32_16x16x32_bf16 v[204:207], a[8:11], a[196:199], v[204:207]
    ds_read_b64_tr_b16 a[50:51], v48 offset:33792
    v_mfma_f32_16x16x32_bf16 v[204:207], a[12:15], a[212:215], v[204:207]
    ds_read_b64_tr_b16 a[52:53], v48 offset:40960
    v_mfma_f32_16x16x32_bf16 v[200:203], a[12:15], a[208:211], v[200:203]
    ds_read_b64_tr_b16 a[54:55], v48 offset:41984
    v_mfma_f32_16x16x32_bf16 v[200:203], a[8:11], a[192:195], v[200:203]
    v_mfma_f32_16x16x32_bf16 v[208:211], a[16:19], a[192:195], v[208:211]
    ds_read_b64_tr_b16 a[56:57], v49 offset:32768
    v_mfma_f32_16x16x32_bf16 v[208:211], a[20:23], a[208:211], v[208:211]
    buffer_load_dwordx4 a[140:143], v55, s[8:11], s62 offen sc1
    ds_read_b64_tr_b16 a[58:59], v49 offset:33792
    v_mfma_f32_16x16x32_bf16 v[212:215], a[20:23], a[212:215], v[212:215]
    ds_read_b64_tr_b16 a[60:61], v49 offset:40960
    v_mfma_f32_16x16x32_bf16 v[212:215], a[16:19], a[196:199], v[212:215]
    v_mfma_f32_16x16x32_bf16 a[80:83], a[16:19], a[200:203], a[80:83]
    ds_read_b64_tr_b16 a[62:63], v49 offset:41984
    v_mfma_f32_16x16x32_bf16 a[80:83], a[20:23], a[216:219], a[80:83]
    s_add_u32 s62, s62, 0x20000
    v_mfma_f32_16x16x32_bf16 a[84:87], a[20:23], a[220:223], a[84:87]
    s_add_u32 s52, s47, 8192
    v_mfma_f32_16x16x32_bf16 a[84:87], a[16:19], a[204:207], a[84:87]
    buffer_store_dwordx4 v[104:107], v1, s[48:51], s52 offen offset:2048 sc1
    v_mfma_f32_16x16x32_bf16 a[92:95], a[24:27], a[204:207], a[92:95]
    v_mfma_f32_16x16x32_bf16 a[92:95], a[28:31], a[220:223], a[92:95]
    v_mfma_f32_16x16x32_bf16 a[88:91], a[28:31], a[216:219], a[88:91]
    v_mfma_f32_16x16x32_bf16 a[88:91], a[24:27], a[200:203], a[88:91]
    v_mfma_f32_16x16x32_bf16 v[220:223], a[24:27], a[196:199], v[220:223]
    v_mfma_f32_16x16x32_bf16 v[220:223], a[28:31], a[212:215], v[220:223]
    v_mfma_f32_16x16x32_bf16 v[216:219], a[28:31], a[208:211], v[216:219]
    v_mfma_f32_16x16x32_bf16 v[216:219], a[24:27], a[192:195], v[216:219]
    s_waitcnt vmcnt(10) lgkmcnt(0)
    s_barrier
    v_mfma_f32_16x16x32_bf16 v[224:227], a[32:35], a[192:195], v[224:227]
    v_mfma_f32_16x16x32_bf16 v[224:227], a[36:39], a[208:211], v[224:227]
    s_add_u32 m0, s60, 98304
    ds_read_b64_tr_b16 a[0:1], v42 offset:49152
    ds_read_b64_tr_b16 a[2:3], v42 offset:50176
    v_mfma_f32_16x16x32_bf16 v[228:231], a[36:39], a[212:215], v[228:231]
    buffer_load_dwordx4 v38, s[12:15], s61 offen offset:0 lds
    v_mfma_f32_16x16x32_bf16 v[228:231], a[32:35], a[196:199], v[228:231]
    ds_read_b64_tr_b16 a[4:5], v42 offset:57344
    v_mfma_f32_16x16x32_bf16 a[96:99], a[32:35], a[200:203], a[96:99]
    buffer_load_dwordx4 v39, s[12:15], s61 offen offset:1024 lds
    ds_read_b64_tr_b16 a[6:7], v42 offset:58368
    v_mfma_f32_16x16x32_bf16 a[96:99], a[36:39], a[216:219], a[96:99]
    ds_read_b64_tr_b16 a[8:9], v43 offset:49152
    v_mfma_f32_16x16x32_bf16 a[100:103], a[36:39], a[220:223], a[100:103]
    v_mfma_f32_16x16x32_bf16 a[100:103], a[32:35], a[204:207], a[100:103]
    buffer_load_dwordx4 v40, s[12:15], s61 offen offset:2048 lds
    ds_read_b64_tr_b16 a[10:11], v43 offset:50176
    v_mfma_f32_16x16x32_bf16 a[108:111], a[40:43], a[204:207], a[108:111]
    ds_read_b64_tr_b16 a[12:13], v43 offset:57344
    v_mfma_f32_16x16x32_bf16 a[108:111], a[44:47], a[220:223], a[108:111]
    ds_read_b64_tr_b16 a[14:15], v43 offset:58368
    v_mfma_f32_16x16x32_bf16 a[104:107], a[44:47], a[216:219], a[104:107]
    buffer_load_dwordx4 v41, s[12:15], s61 offen offset:3072 lds
    ds_read_b64_tr_b16 a[16:17], v44 offset:49152
    v_mfma_f32_16x16x32_bf16 a[104:107], a[40:43], a[200:203], a[104:107]
    v_mfma_f32_16x16x32_bf16 v[236:239], a[40:43], a[196:199], v[236:239]
    s_add_u32 s61, s61, 0x80000
    ds_read_b64_tr_b16 a[18:19], v44 offset:50176
    v_mfma_f32_16x16x32_bf16 v[236:239], a[44:47], a[212:215], v[236:239]
    buffer_load_dwordx4 a[144:147], v36, s[8:11], s62 offen sc1
    ds_read_b64_tr_b16 a[20:21], v44 offset:57344
    v_mfma_f32_16x16x32_bf16 v[232:235], a[44:47], a[208:211], v[232:235]
    ds_read_b64_tr_b16 a[22:23], v44 offset:58368
    v_mfma_f32_16x16x32_bf16 v[232:235], a[40:43], a[192:195], v[232:235]
    buffer_load_dwordx4 a[148:151], v54, s[8:11], s62 offen sc1
    v_mfma_f32_16x16x32_bf16 v[240:243], a[48:51], a[192:195], v[240:243]
    ds_read_b64_tr_b16 a[24:25], v45 offset:49152
    v_mfma_f32_16x16x32_bf16 v[240:243], a[52:55], a[208:211], v[240:243]
    ds_read_b64_tr_b16 a[26:27], v45 offset:50176
    v_mfma_f32_16x16x32_bf16 v[244:247], a[52:55], a[212:215], v[244:247]
    buffer_load_dwordx4 a[152:155], v37, s[8:11], s62 offen sc1
    ds_read_b64_tr_b16 a[28:29], v45 offset:57344
    v_mfma_f32_16x16x32_bf16 v[244:247], a[48:51], a[196:199], v[244:247]
    v_mfma_f32_16x16x32_bf16 a[112:115], a[48:51], a[200:203], a[112:115]
    ds_read_b64_tr_b16 a[30:31], v45 offset:58368
    v_mfma_f32_16x16x32_bf16 a[112:115], a[52:55], a[216:219], a[112:115]
    buffer_load_dwordx4 a[156:159], v55, s[8:11], s62 offen sc1
    v_mfma_f32_16x16x32_bf16 a[116:119], a[52:55], a[220:223], a[116:119]
    v_mfma_f32_16x16x32_bf16 a[116:119], a[48:51], a[204:207], a[116:119]
    s_add_u32 s62, s62, 0x20000
    v_mfma_f32_16x16x32_bf16 a[124:127], a[56:59], a[204:207], a[124:127]
    s_add_u32 s52, s47, 8192
    v_mfma_f32_16x16x32_bf16 a[124:127], a[60:63], a[220:223], a[124:127]
    buffer_store_dwordx4 v[108:111], v1, s[48:51], s52 offen offset:3072 sc1
    v_mfma_f32_16x16x32_bf16 a[120:123], a[60:63], a[216:219], a[120:123]
    v_mfma_f32_16x16x32_bf16 a[120:123], a[56:59], a[200:203], a[120:123]
    v_mfma_f32_16x16x32_bf16 v[252:255], a[56:59], a[196:199], v[252:255]
    v_mfma_f32_16x16x32_bf16 v[252:255], a[60:63], a[212:215], v[252:255]
    v_mfma_f32_16x16x32_bf16 v[248:251], a[60:63], a[208:211], v[248:251]
    v_mfma_f32_16x16x32_bf16 v[248:251], a[56:59], a[192:195], v[248:251]
    s_waitcnt vmcnt(15) lgkmcnt(0)
    v_mfma_f32_16x16x32_bf16 v[192:195], a[0:3], a[224:227], v[192:195]
    v_mfma_f32_16x16x32_bf16 v[192:195], a[4:7], a[240:243], v[192:195]
    buffer_load_dwordx4 a[160:163], v36, s[8:11], s62 offen sc1
    ds_read_b64_tr_b16 a[32:33], v46 offset:49152
    v_mfma_f32_16x16x32_bf16 v[196:199], a[4:7], a[244:247], v[196:199]
    ds_read_b64_tr_b16 a[34:35], v46 offset:50176
    v_mfma_f32_16x16x32_bf16 v[196:199], a[0:3], a[228:231], v[196:199]
    ds_read_b64_tr_b16 a[36:37], v46 offset:57344
    v_mfma_f32_16x16x32_bf16 a[64:67], a[0:3], a[232:235], a[64:67]
    ds_read_b64_tr_b16 a[38:39], v46 offset:58368
    v_mfma_f32_16x16x32_bf16 a[64:67], a[4:7], a[248:251], a[64:67]
    ds_read_b64_tr_b16 a[40:41], v47 offset:49152
    v_mfma_f32_16x16x32_bf16 a[68:71], a[4:7], a[252:255], a[68:71]
    buffer_load_dwordx4 a[164:167], v54, s[8:11], s62 offen sc1
    v_mfma_f32_16x16x32_bf16 a[68:71], a[0:3], a[236:239], a[68:71]
    ds_read_b64_tr_b16 a[42:43], v47 offset:50176
    v_mfma_f32_16x16x32_bf16 a[76:79], a[8:11], a[236:239], a[76:79]
    ds_read_b64_tr_b16 a[44:45], v47 offset:57344
    v_mfma_f32_16x16x32_bf16 a[76:79], a[12:15], a[252:255], a[76:79]
    ds_read_b64_tr_b16 a[46:47], v47 offset:58368
    v_mfma_f32_16x16x32_bf16 a[72:75], a[12:15], a[248:251], a[72:75]
    ds_read_b64_tr_b16 a[48:49], v48 offset:49152
    v_mfma_f32_16x16x32_bf16 a[72:75], a[8:11], a[232:235], a[72:75]
    buffer_load_dwordx4 a[168:171], v37, s[8:11], s62 offen sc1
    v_mfma_f32_16x16x32_bf16 v[204:207], a[8:11], a[228:231], v[204:207]
    ds_read_b64_tr_b16 a[50:51], v48 offset:50176
    v_mfma_f32_16x16x32_bf16 v[204:207], a[12:15], a[244:247], v[204:207]
    ds_read_b64_tr_b16 a[52:53], v48 offset:57344
    v_mfma_f32_16x16x32_bf16 v[200:203], a[12:15], a[240:243], v[200:203]
    ds_read_b64_tr_b16 a[54:55], v48 offset:58368
    v_mfma_f32_16x16x32_bf16 v[200:203], a[8:11], a[224:227], v[200:203]
    v_mfma_f32_16x16x32_bf16 v[208:211], a[16:19], a[224:227], v[208:211]
    ds_read_b64_tr_b16 a[56:57], v49 offset:49152
    v_mfma_f32_16x16x32_bf16 v[208:211], a[20:23], a[240:243], v[208:211]
    buffer_load_dwordx4 a[172:175], v55, s[8:11], s62 offen sc1
    ds_read_b64_tr_b16 a[58:59], v49 offset:50176
    v_mfma_f32_16x16x32_bf16 v[212:215], a[20:23], a[244:247], v[212:215]
    ds_read_b64_tr_b16 a[60:61], v49 offset:57344
    v_mfma_f32_16x16x32_bf16 v[212:215], a[16:19], a[228:231], v[212:215]
    v_mfma_f32_16x16x32_bf16 a[80:83], a[16:19], a[232:235], a[80:83]
    ds_read_b64_tr_b16 a[62:63], v49 offset:58368
    v_mfma_f32_16x16x32_bf16 a[80:83], a[20:23], a[248:251], a[80:83]
    s_add_u32 s62, s62, 0x20000
    v_mfma_f32_16x16x32_bf16 a[84:87], a[20:23], a[252:255], a[84:87]
    s_add_u32 s52, s47, 12288
    v_mfma_f32_16x16x32_bf16 a[84:87], a[16:19], a[236:239], a[84:87]
    buffer_store_dwordx4 v[112:115], v1, s[48:51], s52 offen offset:0 sc1
    v_mfma_f32_16x16x32_bf16 a[92:95], a[24:27], a[236:239], a[92:95]
    v_mfma_f32_16x16x32_bf16 a[92:95], a[28:31], a[252:255], a[92:95]
    v_mfma_f32_16x16x32_bf16 a[88:91], a[28:31], a[248:251], a[88:91]
    v_mfma_f32_16x16x32_bf16 a[88:91], a[24:27], a[232:235], a[88:91]
    v_mfma_f32_16x16x32_bf16 v[220:223], a[24:27], a[228:231], v[220:223]
    s_cmp_eq_u32 s45, 0
    s_cbranch_scc1 k12_ool_56
k12_oolret_57:
    v_mfma_f32_16x16x32_bf16 v[220:223], a[28:31], a[244:247], v[220:223]
    v_mfma_f32_16x16x32_bf16 v[216:219], a[28:31], a[240:243], v[216:219]
    v_mfma_f32_16x16x32_bf16 v[216:219], a[24:27], a[224:227], v[216:219]
    s_waitcnt vmcnt(10) lgkmcnt(0)
    s_barrier
    v_mfma_f32_16x16x32_bf16 v[224:227], a[32:35], a[224:227], v[224:227]
    v_mfma_f32_16x16x32_bf16 v[224:227], a[36:39], a[240:243], v[224:227]
    s_add_u32 m0, s60, 114688
    ds_read_b64_tr_b16 a[0:1], v42 offset:0
    ds_read_b64_tr_b16 a[2:3], v42 offset:1024
    v_mfma_f32_16x16x32_bf16 v[228:231], a[36:39], a[244:247], v[228:231]
    buffer_load_dwordx4 v38, s[12:15], s61 offen offset:0 lds
    v_mfma_f32_16x16x32_bf16 v[228:231], a[32:35], a[228:231], v[228:231]
    ds_read_b64_tr_b16 a[4:5], v42 offset:8192
    v_mfma_f32_16x16x32_bf16 a[96:99], a[32:35], a[232:235], a[96:99]
    buffer_load_dwordx4 v39, s[12:15], s61 offen offset:1024 lds
    ds_read_b64_tr_b16 a[6:7], v42 offset:9216
    v_mfma_f32_16x16x32_bf16 a[96:99], a[36:39], a[248:251], a[96:99]
    ds_read_b64_tr_b16 a[8:9], v43 offset:0
    v_mfma_f32_16x16x32_bf16 a[100:103], a[36:39], a[252:255], a[100:103]
    v_mfma_f32_16x16x32_bf16 a[100:103], a[32:35], a[236:239], a[100:103]
    buffer_load_dwordx4 v40, s[12:15], s61 offen offset:2048 lds
    ds_read_b64_tr_b16 a[10:11], v43 offset:1024
    v_mfma_f32_16x16x32_bf16 a[108:111], a[40:43], a[236:239], a[108:111]
    ds_read_b64_tr_b16 a[12:13], v43 offset:8192
    v_mfma_f32_16x16x32_bf16 a[108:111], a[44:47], a[252:255], a[108:111]
    ds_read_b64_tr_b16 a[14:15], v43 offset:9216
    v_mfma_f32_16x16x32_bf16 a[104:107], a[44:47], a[248:251], a[104:107]
    ds_read_b64_tr_b16 a[16:17], v44 offset:0
    v_mfma_f32_16x16x32_bf16 a[104:107], a[40:43], a[232:235], a[104:107]
    buffer_load_dwordx4 v41, s[12:15], s61 offen offset:3072 lds
    v_mfma_f32_16x16x32_bf16 v[236:239], a[40:43], a[228:231], v[236:239]
    ds_read_b64_tr_b16 a[18:19], v44 offset:1024
    v_mfma_f32_16x16x32_bf16 v[236:239], a[44:47], a[244:247], v[236:239]
    s_add_u32 s61, s61, 0x80000
    ds_read_b64_tr_b16 a[20:21], v44 offset:8192
    v_mfma_f32_16x16x32_bf16 v[232:235], a[44:47], a[240:243], v[232:235]
    buffer_load_dwordx4 a[176:179], v36, s[8:11], s62 offen sc1
    ds_read_b64_tr_b16 a[22:23], v44 offset:9216
    v_mfma_f32_16x16x32_bf16 v[232:235], a[40:43], a[224:227], v[232:235]
    v_mfma_f32_16x16x32_bf16 v[240:243], a[48:51], a[224:227], v[240:243]
    ds_read_b64_tr_b16 a[24:25], v45 offset:0
    v_mfma_f32_16x16x32_bf16 v[240:243], a[52:55], a[240:243], v[240:243]
    buffer_load_dwordx4 a[180:183], v54, s[8:11], s62 offen sc1
    ds_read_b64_tr_b16 a[26:27], v45 offset:1024
    v_mfma_f32_16x16x32_bf16 v[244:247], a[52:55], a[244:247], v[244:247]
    ds_read_b64_tr_b16 a[28:29], v45 offset:8192
    v_mfma_f32_16x16x32_bf16 v[244:247], a[48:51], a[228:231], v[244:247]
    v_mfma_f32_16x16x32_bf16 a[112:115], a[48:51], a[232:235], a[112:115]
    buffer_load_dwordx4 a[184:187], v37, s[8:11], s62 offen sc1
    ds_read_b64_tr_b16 a[30:31], v45 offset:9216
    v_mfma_f32_16x16x32_bf16 a[112:115], a[52:55], a[248:251], a[112:115]
    v_mfma_f32_16x16x32_bf16 a[116:119], a[52:55], a[252:255], a[116:119]
    v_mfma_f32_16x16x32_bf16 a[116:119], a[48:51], a[236:239], a[116:119]
    v_mfma_f32_16x16x32_bf16 a[124:127], a[56:59], a[236:239], a[124:127]
    buffer_load_dwordx4 a[188:191], v55, s[8:11], s62 offen sc1
    v_mfma_f32_16x16x32_bf16 a[124:127], a[60:63], a[252:255], a[124:127]
    v_mfma_f32_16x16x32_bf16 a[120:123], a[60:63], a[248:251], a[120:123]
    s_add_u32 s62, s62, 0x20000
    v_mfma_f32_16x16x32_bf16 a[120:123], a[56:59], a[232:235], a[120:123]
    v_mfma_f32_16x16x32_bf16 v[252:255], a[56:59], a[228:231], v[252:255]
    v_mfma_f32_16x16x32_bf16 v[252:255], a[60:63], a[244:247], v[252:255]
    v_mfma_f32_16x16x32_bf16 v[248:251], a[60:63], a[240:243], v[248:251]
    v_mfma_f32_16x16x32_bf16 v[248:251], a[56:59], a[224:227], v[248:251]
    s_waitcnt vmcnt(14) lgkmcnt(0)
    v_mfma_f32_16x16x32_bf16 v[192:195], a[0:3], a[128:131], v[192:195]
    v_mfma_f32_16x16x32_bf16 v[192:195], a[4:7], a[144:147], v[192:195]
    buffer_load_dwordx4 a[192:195], v36, s[8:11], s62 offen sc1
    ds_read_b64_tr_b16 a[32:33], v46 offset:0
    v_mfma_f32_16x16x32_bf16 v[196:199], a[4:7], a[148:151], v[196:199]
    ds_read_b64_tr_b16 a[34:35], v46 offset:1024
    v_mfma_f32_16x16x32_bf16 v[196:199], a[0:3], a[132:135], v[196:199]
    ds_read_b64_tr_b16 a[36:37], v46 offset:8192
    v_mfma_f32_16x16x32_bf16 a[64:67], a[0:3], a[136:139], a[64:67]
    ds_read_b64_tr_b16 a[38:39], v46 offset:9216
    v_mfma_f32_16x16x32_bf16 a[64:67], a[4:7], a[152:155], a[64:67]
    ds_read_b64_tr_b16 a[40:41], v47 offset:0
    v_mfma_f32_16x16x32_bf16 a[68:71], a[4:7], a[156:159], a[68:71]
    buffer_load_dwordx4 a[196:199], v54, s[8:11], s62 offen sc1
    v_mfma_f32_16x16x32_bf16 a[68:71], a[0:3], a[140:143], a[68:71]
    ds_read_b64_tr_b16 a[42:43], v47 offset:1024
    v_mfma_f32_16x16x32_bf16 a[76:79], a[8:11], a[140:143], a[76:79]
    ds_read_b64_tr_b16 a[44:45], v47 offset:8192
    v_mfma_f32_16x16x32_bf16 a[76:79], a[12:15], a[156:159], a[76:79]
    ds_read_b64_tr_b16 a[46:47], v47 offset:9216
    v_mfma_f32_16x16x32_bf16 a[72:75], a[12:15], a[152:155], a[72:75]
    ds_read_b64_tr_b16 a[48:49], v48 offset:0
    v_mfma_f32_16x16x32_bf16 a[72:75], a[8:11], a[136:139], a[72:75]
    buffer_load_dwordx4 a[200:203], v37, s[8:11], s62 offen sc1
    v_mfma_f32_16x16x32_bf16 v[204:207], a[8:11], a[132:135], v[204:207]
    ds_read_b64_tr_b16 a[50:51], v48 offset:1024
    v_mfma_f32_16x16x32_bf16 v[204:207], a[12:15], a[148:151], v[204:207]
    ds_read_b64_tr_b16 a[52:53], v48 offset:8192
    v_mfma_f32_16x16x32_bf16 v[200:203], a[12:15], a[144:147], v[200:203]
    ds_read_b64_tr_b16 a[54:55], v48 offset:9216
    v_mfma_f32_16x16x32_bf16 v[200:203], a[8:11], a[128:131], v[200:203]
    v_mfma_f32_16x16x32_bf16 v[208:211], a[16:19], a[128:131], v[208:211]
    ds_read_b64_tr_b16 a[56:57], v49 offset:0
    v_mfma_f32_16x16x32_bf16 v[208:211], a[20:23], a[144:147], v[208:211]
    buffer_load_dwordx4 a[204:207], v55, s[8:11], s62 offen sc1
    ds_read_b64_tr_b16 a[58:59], v49 offset:1024
    v_mfma_f32_16x16x32_bf16 v[212:215], a[20:23], a[148:151], v[212:215]
    ds_read_b64_tr_b16 a[60:61], v49 offset:8192
    v_mfma_f32_16x16x32_bf16 v[212:215], a[16:19], a[132:135], v[212:215]
    v_mfma_f32_16x16x32_bf16 a[80:83], a[16:19], a[136:139], a[80:83]
    ds_read_b64_tr_b16 a[62:63], v49 offset:9216
    v_mfma_f32_16x16x32_bf16 a[80:83], a[20:23], a[152:155], a[80:83]
    s_add_u32 s62, s62, 0x20000
    v_mfma_f32_16x16x32_bf16 a[84:87], a[20:23], a[156:159], a[84:87]
    s_add_u32 s52, s47, 12288
    v_mfma_f32_16x16x32_bf16 a[84:87], a[16:19], a[140:143], a[84:87]
    buffer_store_dwordx4 v[116:119], v1, s[48:51], s52 offen offset:1024 sc1
    v_mfma_f32_16x16x32_bf16 a[92:95], a[24:27], a[140:143], a[92:95]
    v_mfma_f32_16x16x32_bf16 a[92:95], a[28:31], a[156:159], a[92:95]
    v_mfma_f32_16x16x32_bf16 a[88:91], a[28:31], a[152:155], a[88:91]
    v_mfma_f32_16x16x32_bf16 a[88:91], a[24:27], a[136:139], a[88:91]
    v_mfma_f32_16x16x32_bf16 v[220:223], a[24:27], a[132:135], v[220:223]
    s_cmp_eq_u32 s45, 0
    s_cbranch_scc1 k12_ool_58
k12_oolret_59:
    v_mfma_f32_16x16x32_bf16 v[220:223], a[28:31], a[148:151], v[220:223]
    v_mfma_f32_16x16x32_bf16 v[216:219], a[28:31], a[144:147], v[216:219]
    v_mfma_f32_16x16x32_bf16 v[216:219], a[24:27], a[128:131], v[216:219]
    s_waitcnt vmcnt(9) lgkmcnt(0)
    s_barrier
    v_mfma_f32_16x16x32_bf16 v[224:227], a[32:35], a[128:131], v[224:227]
    v_mfma_f32_16x16x32_bf16 v[224:227], a[36:39], a[144:147], v[224:227]
    s_add_u32 m0, s60, 131072
    ds_read_b64_tr_b16 a[0:1], v42 offset:16384
    ds_read_b64_tr_b16 a[2:3], v42 offset:17408
    v_mfma_f32_16x16x32_bf16 v[228:231], a[36:39], a[148:151], v[228:231]
    buffer_load_dwordx4 v38, s[12:15], s61 offen offset:0 lds
    v_mfma_f32_16x16x32_bf16 v[228:231], a[32:35], a[132:135], v[228:231]
    ds_read_b64_tr_b16 a[4:5], v42 offset:24576
    v_mfma_f32_16x16x32_bf16 a[96:99], a[32:35], a[136:139], a[96:99]
    buffer_load_dwordx4 v39, s[12:15], s61 offen offset:1024 lds
    ds_read_b64_tr_b16 a[6:7], v42 offset:25600
    v_mfma_f32_16x16x32_bf16 a[96:99], a[36:39], a[152:155], a[96:99]
    ds_read_b64_tr_b16 a[8:9], v43 offset:16384
    v_mfma_f32_16x16x32_bf16 a[100:103], a[36:39], a[156:159], a[100:103]
    v_mfma_f32_16x16x32_bf16 a[100:103], a[32:35], a[140:143], a[100:103]
    buffer_load_dwordx4 v40, s[12:15], s61 offen offset:2048 lds
    ds_read_b64_tr_b16 a[10:11], v43 offset:17408
    v_mfma_f32_16x16x32_bf16 a[108:111], a[40:43], a[140:143], a[108:111]
    ds_read_b64_tr_b16 a[12:13], v43 offset:24576
    v_mfma_f32_16x16x32_bf16 a[108:111], a[44:47], a[156:159], a[108:111]
    ds_read_b64_tr_b16 a[14:15], v43 offset:25600
    v_mfma_f32_16x16x32_bf16 a[104:107], a[44:47], a[152:155], a[104:107]
    buffer_load_dwordx4 v41, s[12:15], s61 offen offset:3072 lds
    ds_read_b64_tr_b16 a[16:17], v44 offset:16384
    v_mfma_f32_16x16x32_bf16 a[104:107], a[40:43], a[136:139], a[104:107]
    v_mfma_f32_16x16x32_bf16 v[236:239], a[40:43], a[132:135], v[236:239]
    s_add_u32 s61, s61, 0x80000
    ds_read_b64_tr_b16 a[18:19], v44 offset:17408
    v_mfma_f32_16x16x32_bf16 v[236:239], a[44:47], a[148:151], v[236:239]
    buffer_load_dwordx4 a[208:211], v36, s[8:11], s62 offen sc1
    ds_read_b64_tr_b16 a[20:21], v44 offset:24576
    v_mfma_f32_16x16x32_bf16 v[232:235], a[44:47], a[144:147], v[232:235]
    ds_read_b64_tr_b16 a[22:23], v44 offset:25600
    v_mfma_f32_16x16x32_bf16 v[232:235], a[40:43], a[128:131], v[232:235]
    buffer_load_dwordx4 a[212:215], v54, s[8:11], s62 offen sc1
    v_mfma_f32_16x16x32_bf16 v[240:243], a[48:51], a[128:131], v[240:243]
    ds_read_b64_tr_b16 a[24:25], v45 offset:16384
    v_mfma_f32_16x16x32_bf16 v[240:243], a[52:55], a[144:147], v[240:243]
    ds_read_b64_tr_b16 a[26:27], v45 offset:17408
    v_mfma_f32_16x16x32_bf16 v[244:247], a[52:55], a[148:151], v[244:247]
    buffer_load_dwordx4 a[216:219], v37, s[8:11], s62 offen sc1
    ds_read_b64_tr_b16 a[28:29], v45 offset:24576
    v_mfma_f32_16x16x32_bf16 v[244:247], a[48:51], a[132:135], v[244:247]
    v_mfma_f32_16x16x32_bf16 a[112:115], a[48:51], a[136:139], a[112:115]
    ds_read_b64_tr_b16 a[30:31], v45 offset:25600
    v_mfma_f32_16x16x32_bf16 a[112:115], a[52:55], a[152:155], a[112:115]
    buffer_load_dwordx4 a[220:223], v55, s[8:11], s62 offen sc1
    v_mfma_f32_16x16x32_bf16 a[116:119], a[52:55], a[156:159], a[116:119]
    v_mfma_f32_16x16x32_bf16 a[116:119], a[48:51], a[140:143], a[116:119]
    s_add_u32 s62, s62, 0x20000
    v_mfma_f32_16x16x32_bf16 a[124:127], a[56:59], a[140:143], a[124:127]
    s_add_u32 s52, s47, 12288
    v_mfma_f32_16x16x32_bf16 a[124:127], a[60:63], a[156:159], a[124:127]
    buffer_store_dwordx4 v[120:123], v1, s[48:51], s52 offen offset:2048 sc1
    v_mfma_f32_16x16x32_bf16 a[120:123], a[60:63], a[152:155], a[120:123]
    v_mfma_f32_16x16x32_bf16 a[120:123], a[56:59], a[136:139], a[120:123]
    v_mfma_f32_16x16x32_bf16 v[252:255], a[56:59], a[132:135], v[252:255]
    v_mfma_f32_16x16x32_bf16 v[252:255], a[60:63], a[148:151], v[252:255]
    v_mfma_f32_16x16x32_bf16 v[248:251], a[60:63], a[144:147], v[248:251]
    v_mfma_f32_16x16x32_bf16 v[248:251], a[56:59], a[128:131], v[248:251]
    s_waitcnt vmcnt(14) lgkmcnt(0)
    v_mfma_f32_16x16x32_bf16 v[192:195], a[0:3], a[160:163], v[192:195]
    v_mfma_f32_16x16x32_bf16 v[192:195], a[4:7], a[176:179], v[192:195]
    buffer_load_dwordx4 a[224:227], v36, s[8:11], s62 offen sc1
    ds_read_b64_tr_b16 a[32:33], v46 offset:16384
    v_mfma_f32_16x16x32_bf16 v[196:199], a[4:7], a[180:183], v[196:199]
    ds_read_b64_tr_b16 a[34:35], v46 offset:17408
    v_mfma_f32_16x16x32_bf16 v[196:199], a[0:3], a[164:167], v[196:199]
    ds_read_b64_tr_b16 a[36:37], v46 offset:24576
    v_mfma_f32_16x16x32_bf16 a[64:67], a[0:3], a[168:171], a[64:67]
    ds_read_b64_tr_b16 a[38:39], v46 offset:25600
    v_mfma_f32_16x16x32_bf16 a[64:67], a[4:7], a[184:187], a[64:67]
    ds_read_b64_tr_b16 a[40:41], v47 offset:16384
    v_mfma_f32_16x16x32_bf16 a[68:71], a[4:7], a[188:191], a[68:71]
    buffer_load_dwordx4 a[228:231], v54, s[8:11], s62 offen sc1
    v_mfma_f32_16x16x32_bf16 a[68:71], a[0:3], a[172:175], a[68:71]
    ds_read_b64_tr_b16 a[42:43], v47 offset:17408
    v_mfma_f32_16x16x32_bf16 a[76:79], a[8:11], a[172:175], a[76:79]
    ds_read_b64_tr_b16 a[44:45], v47 offset:24576
    v_mfma_f32_16x16x32_bf16 a[76:79], a[12:15], a[188:191], a[76:79]
    ds_read_b64_tr_b16 a[46:47], v47 offset:25600
    v_mfma_f32_16x16x32_bf16 a[72:75], a[12:15], a[184:187], a[72:75]
    ds_read_b64_tr_b16 a[48:49], v48 offset:16384
    v_mfma_f32_16x16x32_bf16 a[72:75], a[8:11], a[168:171], a[72:75]
    buffer_load_dwordx4 a[232:235], v37, s[8:11], s62 offen sc1
    v_mfma_f32_16x16x32_bf16 v[204:207], a[8:11], a[164:167], v[204:207]
    ds_read_b64_tr_b16 a[50:51], v48 offset:17408
    v_mfma_f32_16x16x32_bf16 v[204:207], a[12:15], a[180:183], v[204:207]
    ds_read_b64_tr_b16 a[52:53], v48 offset:24576
    v_mfma_f32_16x16x32_bf16 v[200:203], a[12:15], a[176:179], v[200:203]
    ds_read_b64_tr_b16 a[54:55], v48 offset:25600
    v_mfma_f32_16x16x32_bf16 v[200:203], a[8:11], a[160:163], v[200:203]
    v_mfma_f32_16x16x32_bf16 v[208:211], a[16:19], a[160:163], v[208:211]
    ds_read_b64_tr_b16 a[56:57], v49 offset:16384
    v_mfma_f32_16x16x32_bf16 v[208:211], a[20:23], a[176:179], v[208:211]
    buffer_load_dwordx4 a[236:239], v55, s[8:11], s62 offen sc1
    ds_read_b64_tr_b16 a[58:59], v49 offset:17408
    v_mfma_f32_16x16x32_bf16 v[212:215], a[20:23], a[180:183], v[212:215]
    ds_read_b64_tr_b16 a[60:61], v49 offset:24576
    v_mfma_f32_16x16x32_bf16 v[212:215], a[16:19], a[164:167], v[212:215]
    v_mfma_f32_16x16x32_bf16 a[80:83], a[16:19], a[168:171], a[80:83]
    ds_read_b64_tr_b16 a[62:63], v49 offset:25600
    v_mfma_f32_16x16x32_bf16 a[80:83], a[20:23], a[184:187], a[80:83]
    s_add_u32 s62, s62, 0x20000
    v_mfma_f32_16x16x32_bf16 a[84:87], a[20:23], a[188:191], a[84:87]
    s_add_u32 s52, s47, 12288
    v_mfma_f32_16x16x32_bf16 a[84:87], a[16:19], a[172:175], a[84:87]
    buffer_store_dwordx4 v[124:127], v1, s[48:51], s52 offen offset:3072 sc1
    v_mfma_f32_16x16x32_bf16 a[92:95], a[24:27], a[172:175], a[92:95]
    v_mfma_f32_16x16x32_bf16 a[92:95], a[28:31], a[188:191], a[92:95]
    v_mfma_f32_16x16x32_bf16 a[88:91], a[28:31], a[184:187], a[88:91]
    v_mfma_f32_16x16x32_bf16 a[88:91], a[24:27], a[168:171], a[88:91]
    v_mfma_f32_16x16x32_bf16 v[220:223], a[24:27], a[164:167], v[220:223]
    v_mfma_f32_16x16x32_bf16 v[220:223], a[28:31], a[180:183], v[220:223]
    v_mfma_f32_16x16x32_bf16 v[216:219], a[28:31], a[176:179], v[216:219]
    v_mfma_f32_16x16x32_bf16 v[216:219], a[24:27], a[160:163], v[216:219]
    s_waitcnt vmcnt(10) lgkmcnt(0)
    s_barrier
    v_mfma_f32_16x16x32_bf16 v[224:227], a[32:35], a[160:163], v[224:227]
    v_mfma_f32_16x16x32_bf16 v[224:227], a[36:39], a[176:179], v[224:227]
    s_add_u32 m0, s60, 147456
    ds_read_b64_tr_b16 a[0:1], v42 offset:32768
    ds_read_b64_tr_b16 a[2:3], v42 offset:33792
    v_mfma_f32_16x16x32_bf16 v[228:231], a[36:39], a[180:183], v[228:231]
    buffer_load_dwordx4 v38, s[12:15], s61 offen offset:0 lds
    v_mfma_f32_16x16x32_bf16 v[228:231], a[32:35], a[164:167], v[228:231]
    ds_read_b64_tr_b16 a[4:5], v42 offset:40960
    v_mfma_f32_16x16x32_bf16 a[96:99], a[32:35], a[168:171], a[96:99]
    buffer_load_dwordx4 v39, s[12:15], s61 offen offset:1024 lds
    ds_read_b64_tr_b16 a[6:7], v42 offset:41984
    v_mfma_f32_16x16x32_bf16 a[96:99], a[36:39], a[184:187], a[96:99]
    ds_read_b64_tr_b16 a[8:9], v43 offset:32768
    v_mfma_f32_16x16x32_bf16 a[100:103], a[36:39], a[188:191], a[100:103]
    v_mfma_f32_16x16x32_bf16 a[100:103], a[32:35], a[172:175], a[100:103]
    buffer_load_dwordx4 v40, s[12:15], s61 offen offset:2048 lds
    ds_read_b64_tr_b16 a[10:11], v43 offset:33792
    v_mfma_f32_16x16x32_bf16 a[108:111], a[40:43], a[172:175], a[108:111]
    ds_read_b64_tr_b16 a[12:13], v43 offset:40960
    v_mfma_f32_16x16x32_bf16 a[108:111], a[44:47], a[188:191], a[108:111]
    ds_read_b64_tr_b16 a[14:15], v43 offset:41984
    v_mfma_f32_16x16x32_bf16 a[104:107], a[44:47], a[184:187], a[104:107]
    buffer_load_dwordx4 v41, s[12:15], s61 offen offset:3072 lds
    ds_read_b64_tr_b16 a[16:17], v44 offset:32768
    v_mfma_f32_16x16x32_bf16 a[104:107], a[40:43], a[168:171], a[104:107]
    v_mfma_f32_16x16x32_bf16 v[236:239], a[40:43], a[164:167], v[236:239]
    s_add_u32 s61, s61, 0x80000
    ds_read_b64_tr_b16 a[18:19], v44 offset:33792
    v_mfma_f32_16x16x32_bf16 v[236:239], a[44:47], a[180:183], v[236:239]
    buffer_load_dwordx4 a[240:243], v36, s[8:11], s62 offen sc1
    ds_read_b64_tr_b16 a[20:21], v44 offset:40960
    v_mfma_f32_16x16x32_bf16 v[232:235], a[44:47], a[176:179], v[232:235]
    ds_read_b64_tr_b16 a[22:23], v44 offset:41984
    v_mfma_f32_16x16x32_bf16 v[232:235], a[40:43], a[160:163], v[232:235]
    buffer_load_dwordx4 a[244:247], v54, s[8:11], s62 offen sc1
    v_mfma_f32_16x16x32_bf16 v[240:243], a[48:51], a[160:163], v[240:243]
    ds_read_b64_tr_b16 a[24:25], v45 offset:32768
    v_mfma_f32_16x16x32_bf16 v[240:243], a[52:55], a[176:179], v[240:243]
    ds_read_b64_tr_b16 a[26:27], v45 offset:33792
    v_mfma_f32_16x16x32_bf16 v[244:247], a[52:55], a[180:183], v[244:247]
    buffer_load_dwordx4 a[248:251], v37, s[8:11], s62 offen sc1
    ds_read_b64_tr_b16 a[28:29], v45 offset:40960
    v_mfma_f32_16x16x32_bf16 v[244:247], a[48:51], a[164:167], v[244:247]
    v_mfma_f32_16x16x32_bf16 a[112:115], a[48:51], a[168:171], a[112:115]
    ds_read_b64_tr_b16 a[30:31], v45 offset:41984
    v_mfma_f32_16x16x32_bf16 a[112:115], a[52:55], a[184:187], a[112:115]
    buffer_load_dwordx4 a[252:255], v55, s[8:11], s62 offen sc1
    v_mfma_f32_16x16x32_bf16 a[116:119], a[52:55], a[188:191], a[116:119]
    v_mfma_f32_16x16x32_bf16 a[116:119], a[48:51], a[172:175], a[116:119]
    s_add_u32 s62, s62, 0x20000
    v_mfma_f32_16x16x32_bf16 a[124:127], a[56:59], a[172:175], a[124:127]
    s_add_u32 s52, s47, 524288
    v_mfma_f32_16x16x32_bf16 a[124:127], a[60:63], a[188:191], a[124:127]
    buffer_store_dwordx4 v[136:139], v1, s[48:51], s52 offen offset:2048 sc1
    v_mfma_f32_16x16x32_bf16 a[120:123], a[60:63], a[184:187], a[120:123]
    v_mfma_f32_16x16x32_bf16 a[120:123], a[56:59], a[168:171], a[120:123]
    v_mfma_f32_16x16x32_bf16 v[252:255], a[56:59], a[164:167], v[252:255]
    s_cmp_eq_u32 s45, 0
    s_cbranch_scc1 k12_ool_60
k12_oolret_61:
    v_mfma_f32_16x16x32_bf16 v[252:255], a[60:63], a[180:183], v[252:255]
    v_mfma_f32_16x16x32_bf16 v[248:251], a[60:63], a[176:179], v[248:251]
    v_mfma_f32_16x16x32_bf16 v[248:251], a[56:59], a[160:163], v[248:251]
    s_waitcnt vmcnt(15) lgkmcnt(0)
    v_mfma_f32_16x16x32_bf16 v[192:195], a[0:3], a[192:195], v[192:195]
    v_mfma_f32_16x16x32_bf16 v[192:195], a[4:7], a[208:211], v[192:195]
    buffer_load_dwordx4 a[128:131], v36, s[8:11], s62 offen sc1
    ds_read_b64_tr_b16 a[32:33], v46 offset:32768
    v_mfma_f32_16x16x32_bf16 v[196:199], a[4:7], a[212:215], v[196:199]
    ds_read_b64_tr_b16 a[34:35], v46 offset:33792
    v_mfma_f32_16x16x32_bf16 v[196:199], a[0:3], a[196:199], v[196:199]
    ds_read_b64_tr_b16 a[36:37], v46 offset:40960
    v_mfma_f32_16x16x32_bf16 a[64:67], a[0:3], a[200:203], a[64:67]
    ds_read_b64_tr_b16 a[38:39], v46 offset:41984
    v_mfma_f32_16x16x32_bf16 a[64:67], a[4:7], a[216:219], a[64:67]
    ds_read_b64_tr_b16 a[40:41], v47 offset:32768
    v_mfma_f32_16x16x32_bf16 a[68:71], a[4:7], a[220:223], a[68:71]
    buffer_load_dwordx4 a[132:135], v54, s[8:11], s62 offen sc1
    v_mfma_f32_16x16x32_bf16 a[68:71], a[0:3], a[204:207], a[68:71]
    ds_read_b64_tr_b16 a[42:43], v47 offset:33792
    v_mfma_f32_16x16x32_bf16 a[76:79], a[8:11], a[204:207], a[76:79]
    ds_read_b64_tr_b16 a[44:45], v47 offset:40960
    v_mfma_f32_16x16x32_bf16 a[76:79], a[12:15], a[220:223], a[76:79]
    ds_read_b64_tr_b16 a[46:47], v47 offset:41984
    v_mfma_f32_16x16x32_bf16 a[72:75], a[12:15], a[216:219], a[72:75]
    ds_read_b64_tr_b16 a[48:49], v48 offset:32768
    v_mfma_f32_16x16x32_bf16 a[72:75], a[8:11], a[200:203], a[72:75]
    buffer_load_dwordx4 a[136:139], v37, s[8:11], s62 offen sc1
    v_mfma_f32_16x16x32_bf16 v[204:207], a[8:11], a[196:199], v[204:207]
    ds_read_b64_tr_b16 a[50:51], v48 offset:33792
    v_mfma_f32_16x16x32_bf16 v[204:207], a[12:15], a[212:215], v[204:207]
    ds_read_b64_tr_b16 a[52:53], v48 offset:40960
    v_mfma_f32_16x16x32_bf16 v[200:203], a[12:15], a[208:211], v[200:203]
    ds_read_b64_tr_b16 a[54:55], v48 offset:41984
    v_mfma_f32_16x16x32_bf16 v[200:203], a[8:11], a[192:195], v[200:203]
    v_mfma_f32_16x16x32_bf16 v[208:211], a[16:19], a[192:195], v[208:211]
    ds_read_b64_tr_b16 a[56:57], v49 offset:32768
    v_mfma_f32_16x16x32_bf16 v[208:211], a[20:23], a[208:211], v[208:211]
    buffer_load_dwordx4 a[140:143], v55, s[8:11], s62 offen sc1
    ds_read_b64_tr_b16 a[58:59], v49 offset:33792
    v_mfma_f32_16x16x32_bf16 v[212:215], a[20:23], a[212:215], v[212:215]
    ds_read_b64_tr_b16 a[60:61], v49 offset:40960
    v_mfma_f32_16x16x32_bf16 v[212:215], a[16:19], a[196:199], v[212:215]
    v_mfma_f32_16x16x32_bf16 a[80:83], a[16:19], a[200:203], a[80:83]
    ds_read_b64_tr_b16 a[62:63], v49 offset:41984
    v_mfma_f32_16x16x32_bf16 a[80:83], a[20:23], a[216:219], a[80:83]
    s_add_u32 s62, s62, 0x20000
    v_mfma_f32_16x16x32_bf16 a[84:87], a[20:23], a[220:223], a[84:87]
    s_add_u32 s52, s47, 524288
    v_mfma_f32_16x16x32_bf16 a[84:87], a[16:19], a[204:207], a[84:87]
    buffer_store_dwordx4 v[140:143], v1, s[48:51], s52 offen offset:3072 sc1
    v_mfma_f32_16x16x32_bf16 a[92:95], a[24:27], a[204:207], a[92:95]
    v_mfma_f32_16x16x32_bf16 a[92:95], a[28:31], a[220:223], a[92:95]
    v_mfma_f32_16x16x32_bf16 a[88:91], a[28:31], a[216:219], a[88:91]
    v_mfma_f32_16x16x32_bf16 a[88:91], a[24:27], a[200:203], a[88:91]
    v_mfma_f32_16x16x32_bf16 v[220:223], a[24:27], a[196:199], v[220:223]
    v_mfma_f32_16x16x32_bf16 v[220:223], a[28:31], a[212:215], v[220:223]
    v_mfma_f32_16x16x32_bf16 v[216:219], a[28:31], a[208:211], v[216:219]
    v_mfma_f32_16x16x32_bf16 v[216:219], a[24:27], a[192:195], v[216:219]
    s_waitcnt vmcnt(10) lgkmcnt(0)
    s_barrier
    v_mfma_f32_16x16x32_bf16 v[224:227], a[32:35], a[192:195], v[224:227]
    v_mfma_f32_16x16x32_bf16 v[224:227], a[36:39], a[208:211], v[224:227]
    s_add_u32 m0, s60, 98304
    ds_read_b64_tr_b16 a[0:1], v42 offset:49152
    ds_read_b64_tr_b16 a[2:3], v42 offset:50176
    v_mfma_f32_16x16x32_bf16 v[228:231], a[36:39], a[212:215], v[228:231]
    buffer_load_dwordx4 v38, s[12:15], s61 offen offset:0 lds
    v_mfma_f32_16x16x32_bf16 v[228:231], a[32:35], a[196:199], v[228:231]
    ds_read_b64_tr_b16 a[4:5], v42 offset:57344
    v_mfma_f32_16x16x32_bf16 a[96:99], a[32:35], a[200:203], a[96:99]
    buffer_load_dwordx4 v39, s[12:15], s61 offen offset:1024 lds
    ds_read_b64_tr_b16 a[6:7], v42 offset:58368
    v_mfma_f32_16x16x32_bf16 a[96:99], a[36:39], a[216:219], a[96:99]
    ds_read_b64_tr_b16 a[8:9], v43 offset:49152
    v_mfma_f32_16x16x32_bf16 a[100:103], a[36:39], a[220:223], a[100:103]
    v_mfma_f32_16x16x32_bf16 a[100:103], a[32:35], a[204:207], a[100:103]
    buffer_load_dwordx4 v40, s[12:15], s61 offen offset:2048 lds
    ds_read_b64_tr_b16 a[10:11], v43 offset:50176
    v_mfma_f32_16x16x32_bf16 a[108:111], a[40:43], a[204:207], a[108:111]
    ds_read_b64_tr_b16 a[12:13], v43 offset:57344
    v_mfma_f32_16x16x32_bf16 a[108:111], a[44:47], a[220:223], a[108:111]
    ds_read_b64_tr_b16 a[14:15], v43 offset:58368
    v_mfma_f32_16x16x32_bf16 a[104:107], a[44:47], a[216:219], a[104:107]
    ds_read_b64_tr_b16 a[16:17], v44 offset:49152
    v_mfma_f32_16x16x32_bf16 a[104:107], a[40:43], a[200:203], a[104:107]
    buffer_load_dwordx4 v41, s[12:15], s61 offen offset:3072 lds
    v_mfma_f32_16x16x32_bf16 v[236:239], a[40:43], a[196:199], v[236:239]
    ds_read_b64_tr_b16 a[18:19], v44 offset:50176
    v_mfma_f32_16x16x32_bf16 v[236:239], a[44:47], a[212:215], v[236:239]
    s_add_u32 s61, s61, 0x80000
    ds_read_b64_tr_b16 a[20:21], v44 offset:57344
    v_mfma_f32_16x16x32_bf16 v[232:235], a[44:47], a[208:211], v[232:235]
    buffer_load_dwordx4 a[144:147], v36, s[8:11], s62 offen sc1
    ds_read_b64_tr_b16 a[22:23], v44 offset:58368
    v_mfma_f32_16x16x32_bf16 v[232:235], a[40:43], a[192:195], v[232:235]
    v_mfma_f32_16x16x32_bf16 v[240:243], a[48:51], a[192:195], v[240:243]
    ds_read_b64_tr_b16 a[24:25], v45 offset:49152
    v_mfma_f32_16x16x32_bf16 v[240:243], a[52:55], a[208:211], v[240:243]
    buffer_load_dwordx4 a[148:151], v54, s[8:11], s62 offen sc1
    ds_read_b64_tr_b16 a[26:27], v45 offset:50176
    v_mfma_f32_16x16x32_bf16 v[244:247], a[52:55], a[212:215], v[244:247]
    ds_read_b64_tr_b16 a[28:29], v45 offset:57344
    v_mfma_f32_16x16x32_bf16 v[244:247], a[48:51], a[196:199], v[244:247]
    v_mfma_f32_16x16x32_bf16 a[112:115], a[48:51], a[200:203], a[112:115]
    buffer_load_dwordx4 a[152:155], v37, s[8:11], s62 offen sc1
    ds_read_b64_tr_b16 a[30:31], v45 offset:58368
    v_mfma_f32_16x16x32_bf16 a[112:115], a[52:55], a[216:219], a[112:115]
    v_mfma_f32_16x16x32_bf16 a[116:119], a[52:55], a[220:223], a[116:119]
    v_mfma_f32_16x16x32_bf16 a[116:119], a[48:51], a[204:207], a[116:119]
    v_mfma_f32_16x16x32_bf16 a[124:127], a[56:59], a[204:207], a[124:127]
    buffer_load_dwordx4 a[156:159], v55, s[8:11], s62 offen sc1
    v_mfma_f32_16x16x32_bf16 a[124:127], a[60:63], a[220:223], a[124:127]
    v_mfma_f32_16x16x32_bf16 a[120:123], a[60:63], a[216:219], a[120:123]
    s_add_u32 s62, s62, 0x20000
    v_mfma_f32_16x16x32_bf16 a[120:123], a[56:59], a[200:203], a[120:123]
    v_mfma_f32_16x16x32_bf16 v[252:255], a[56:59], a[196:199], v[252:255]
    s_cmp_eq_u32 s45, 0
    s_cbranch_scc1 k12_ool_62
k12_oolret_63:
    v_mfma_f32_16x16x32_bf16 v[252:255], a[60:63], a[212:215], v[252:255]
    v_mfma_f32_16x16x32_bf16 v[248:251], a[60:63], a[208:211], v[248:251]
    v_mfma_f32_16x16x32_bf16 v[248:251], a[56:59], a[192:195], v[248:251]
    s_waitcnt vmcnt(14) lgkmcnt(0)
    v_mfma_f32_16x16x32_bf16 v[192:195], a[0:3], a[224:227], v[192:195]
    v_mfma_f32_16x16x32_bf16 v[192:195], a[4:7], a[240:243], v[192:195]
    buffer_load_dwordx4 a[160:163], v36, s[8:11], s62 offen sc1
    ds_read_b64_tr_b16 a[32:33], v46 offset:49152
    v_mfma_f32_16x16x32_bf16 v[196:199], a[4:7], a[244:247], v[196:199]
    ds_read_b64_tr_b16 a[34:35], v46 offset:50176
    v_mfma_f32_16x16x32_bf16 v[196:199], a[0:3], a[228:231], v[196:199]
    ds_read_b64_tr_b16 a[36:37], v46 offset:57344
    v_mfma_f32_16x16x32_bf16 a[64:67], a[0:3], a[232:235], a[64:67]
    ds_read_b64_tr_b16 a[38:39], v46 offset:58368
    v_mfma_f32_16x16x32_bf16 a[64:67], a[4:7], a[248:251], a[64:67]
    ds_read_b64_tr_b16 a[40:41], v47 offset:49152
    v_mfma_f32_16x16x32_bf16 a[68:71], a[4:7], a[252:255], a[68:71]
    buffer_load_dwordx4 a[164:167], v54, s[8:11], s62 offen sc1
    v_mfma_f32_16x16x32_bf16 a[68:71], a[0:3], a[236:239], a[68:71]
    ds_read_b64_tr_b16 a[42:43], v47 offset:50176
    v_mfma_f32_16x16x32_bf16 a[76:79], a[8:11], a[236:239], a[76:79]
    ds_read_b64_tr_b16 a[44:45], v47 offset:57344
    v_mfma_f32_16x16x32_bf16 a[76:79], a[12:15], a[252:255], a[76:79]
    ds_read_b64_tr_b16 a[46:47], v47 offset:58368
    v_mfma_f32_16x16x32_bf16 a[72:75], a[12:15], a[248:251], a[72:75]
    ds_read_b64_tr_b16 a[48:49], v48 offset:49152
    v_mfma_f32_16x16x32_bf16 a[72:75], a[8:11], a[232:235], a[72:75]
    buffer_load_dwordx4 a[168:171], v37, s[8:11], s62 offen sc1
    v_mfma_f32_16x16x32_bf16 v[204:207], a[8:11], a[228:231], v[204:207]
    ds_read_b64_tr_b16 a[50:51], v48 offset:50176
    v_mfma_f32_16x16x32_bf16 v[204:207], a[12:15], a[244:247], v[204:207]
    ds_read_b64_tr_b16 a[52:53], v48 offset:57344
    v_mfma_f32_16x16x32_bf16 v[200:203], a[12:15], a[240:243], v[200:203]
    ds_read_b64_tr_b16 a[54:55], v48 offset:58368
    v_mfma_f32_16x16x32_bf16 v[200:203], a[8:11], a[224:227], v[200:203]
    v_mfma_f32_16x16x32_bf16 v[208:211], a[16:19], a[224:227], v[208:211]
    ds_read_b64_tr_b16 a[56:57], v49 offset:49152
    v_mfma_f32_16x16x32_bf16 v[208:211], a[20:23], a[240:243], v[208:211]
    buffer_load_dwordx4 a[172:175], v55, s[8:11], s62 offen sc1
    ds_read_b64_tr_b16 a[58:59], v49 offset:50176
    v_mfma_f32_16x16x32_bf16 v[212:215], a[20:23], a[244:247], v[212:215]
    ds_read_b64_tr_b16 a[60:61], v49 offset:57344
    v_mfma_f32_16x16x32_bf16 v[212:215], a[16:19], a[228:231], v[212:215]
    v_mfma_f32_16x16x32_bf16 a[80:83], a[16:19], a[232:235], a[80:83]
    ds_read_b64_tr_b16 a[62:63], v49 offset:58368
    v_mfma_f32_16x16x32_bf16 a[80:83], a[20:23], a[248:251], a[80:83]
    s_add_u32 s62, s62, 0x20000
    v_mfma_f32_16x16x32_bf16 a[84:87], a[20:23], a[252:255], a[84:87]
    s_add_u32 s52, s47, 528384
    v_mfma_f32_16x16x32_bf16 a[84:87], a[16:19], a[236:239], a[84:87]
    buffer_store_dwordx4 v[144:147], v1, s[48:51], s52 offen offset:0 sc1
    v_mfma_f32_16x16x32_bf16 a[92:95], a[24:27], a[236:239], a[92:95]
    v_mfma_f32_16x16x32_bf16 a[92:95], a[28:31], a[252:255], a[92:95]
    v_mfma_f32_16x16x32_bf16 a[88:91], a[28:31], a[248:251], a[88:91]
    v_mfma_f32_16x16x32_bf16 a[88:91], a[24:27], a[232:235], a[88:91]
    v_mfma_f32_16x16x32_bf16 v[220:223], a[24:27], a[228:231], v[220:223]
    v_mfma_f32_16x16x32_bf16 v[220:223], a[28:31], a[244:247], v[220:223]
    v_mfma_f32_16x16x32_bf16 v[216:219], a[28:31], a[240:243], v[216:219]
    v_mfma_f32_16x16x32_bf16 v[216:219], a[24:27], a[224:227], v[216:219]
    s_waitcnt vmcnt(9) lgkmcnt(0)
    s_barrier
    v_mfma_f32_16x16x32_bf16 v[224:227], a[32:35], a[224:227], v[224:227]
    v_mfma_f32_16x16x32_bf16 v[224:227], a[36:39], a[240:243], v[224:227]
    s_add_u32 m0, s60, 114688
    ds_read_b64_tr_b16 a[0:1], v42 offset:0
    ds_read_b64_tr_b16 a[2:3], v42 offset:1024
    v_mfma_f32_16x16x32_bf16 v[228:231], a[36:39], a[244:247], v[228:231]
    buffer_load_dwordx4 v38, s[12:15], s61 offen offset:0 lds
    v_mfma_f32_16x16x32_bf16 v[228:231], a[32:35], a[228:231], v[228:231]
    ds_read_b64_tr_b16 a[4:5], v42 offset:8192
    v_mfma_f32_16x16x32_bf16 a[96:99], a[32:35], a[232:235], a[96:99]
    buffer_load_dwordx4 v39, s[12:15], s61 offen offset:1024 lds
    ds_read_b64_tr_b16 a[6:7], v42 offset:9216
    v_mfma_f32_16x16x32_bf16 a[96:99], a[36:39], a[248:251], a[96:99]
    ds_read_b64_tr_b16 a[8:9], v43 offset:0
    v_mfma_f32_16x16x32_bf16 a[100:103], a[36:39], a[252:255], a[100:103]
    v_mfma_f32_16x16x32_bf16 a[100:103], a[32:35], a[236:239], a[100:103]
    buffer_load_dwordx4 v40, s[12:15], s61 offen offset:2048 lds
    ds_read_b64_tr_b16 a[10:11], v43 offset:1024
    v_mfma_f32_16x16x32_bf16 a[108:111], a[40:43], a[236:239], a[108:111]
    ds_read_b64_tr_b16 a[12:13], v43 offset:8192
    v_mfma_f32_16x16x32_bf16 a[108:111], a[44:47], a[252:255], a[108:111]
    ds_read_b64_tr_b16 a[14:15], v43 offset:9216
    v_mfma_f32_16x16x32_bf16 a[104:107], a[44:47], a[248:251], a[104:107]
    buffer_load_dwordx4 v41, s[12:15], s61 offen offset:3072 lds
    ds_read_b64_tr_b16 a[16:17], v44 offset:0
    v_mfma_f32_16x16x32_bf16 a[104:107], a[40:43], a[232:235], a[104:107]
    v_mfma_f32_16x16x32_bf16 v[236:239], a[40:43], a[228:231], v[236:239]
    s_add_u32 s61, s61, 0x80000
    ds_read_b64_tr_b16 a[18:19], v44 offset:1024
    v_mfma_f32_16x16x32_bf16 v[236:239], a[44:47], a[244:247], v[236:239]
    buffer_load_dwordx4 a[176:179], v36, s[8:11], s62 offen sc1
    ds_read_b64_tr_b16 a[20:21], v44 offset:8192
    v_mfma_f32_16x16x32_bf16 v[232:235], a[44:47], a[240:243], v[232:235]
    ds_read_b64_tr_b16 a[22:23], v44 offset:9216
    v_mfma_f32_16x16x32_bf16 v[232:235], a[40:43], a[224:227], v[232:235]
    buffer_load_dwordx4 a[180:183], v54, s[8:11], s62 offen sc1
    v_mfma_f32_16x16x32_bf16 v[240:243], a[48:51], a[224:227], v[240:243]
    ds_read_b64_tr_b16 a[24:25], v45 offset:0
    v_mfma_f32_16x16x32_bf16 v[240:243], a[52:55], a[240:243], v[240:243]
    ds_read_b64_tr_b16 a[26:27], v45 offset:1024
    v_mfma_f32_16x16x32_bf16 v[244:247], a[52:55], a[244:247], v[244:247]
    buffer_load_dwordx4 a[184:187], v37, s[8:11], s62 offen sc1
    ds_read_b64_tr_b16 a[28:29], v45 offset:8192
    v_mfma_f32_16x16x32_bf16 v[244:247], a[48:51], a[228:231], v[244:247]
    v_mfma_f32_16x16x32_bf16 a[112:115], a[48:51], a[232:235], a[112:115]
    ds_read_b64_tr_b16 a[30:31], v45 offset:9216
    v_mfma_f32_16x16x32_bf16 a[112:115], a[52:55], a[248:251], a[112:115]
    buffer_load_dwordx4 a[188:191], v55, s[8:11], s62 offen sc1
    v_mfma_f32_16x16x32_bf16 a[116:119], a[52:55], a[252:255], a[116:119]
    v_mfma_f32_16x16x32_bf16 a[116:119], a[48:51], a[236:239], a[116:119]
    s_add_u32 s62, s62, 0x20000
    v_mfma_f32_16x16x32_bf16 a[124:127], a[56:59], a[236:239], a[124:127]
    s_add_u32 s52, s47, 528384
    v_mfma_f32_16x16x32_bf16 a[124:127], a[60:63], a[252:255], a[124:127]
    buffer_store_dwordx4 v[148:151], v1, s[48:51], s52 offen offset:1024 sc1
    v_mfma_f32_16x16x32_bf16 a[120:123], a[60:63], a[248:251], a[120:123]
    v_mfma_f32_16x16x32_bf16 a[120:123], a[56:59], a[232:235], a[120:123]
    v_mfma_f32_16x16x32_bf16 v[252:255], a[56:59], a[228:231], v[252:255]
    s_cmp_eq_u32 s45, 0
    s_cbranch_scc1 k12_ool_64
k12_oolret_65:
    v_mfma_f32_16x16x32_bf16 v[252:255], a[60:63], a[244:247], v[252:255]
    v_mfma_f32_16x16x32_bf16 v[248:251], a[60:63], a[240:243], v[248:251]
    v_mfma_f32_16x16x32_bf16 v[248:251], a[56:59], a[224:227], v[248:251]
    s_waitcnt vmcnt(14) lgkmcnt(0)
    v_mfma_f32_16x16x32_bf16 v[192:195], a[0:3], a[128:131], v[192:195]
    v_mfma_f32_16x16x32_bf16 v[192:195], a[4:7], a[144:147], v[192:195]
    buffer_load_dwordx4 a[192:195], v36, s[8:11], s62 offen sc1
    ds_read_b64_tr_b16 a[32:33], v46 offset:0
    v_mfma_f32_16x16x32_bf16 v[196:199], a[4:7], a[148:151], v[196:199]
    ds_read_b64_tr_b16 a[34:35], v46 offset:1024
    v_mfma_f32_16x16x32_bf16 v[196:199], a[0:3], a[132:135], v[196:199]
    ds_read_b64_tr_b16 a[36:37], v46 offset:8192
    v_mfma_f32_16x16x32_bf16 a[64:67], a[0:3], a[136:139], a[64:67]
    ds_read_b64_tr_b16 a[38:39], v46 offset:9216
    v_mfma_f32_16x16x32_bf16 a[64:67], a[4:7], a[152:155], a[64:67]
    ds_read_b64_tr_b16 a[40:41], v47 offset:0
    v_mfma_f32_16x16x32_bf16 a[68:71], a[4:7], a[156:159], a[68:71]
    buffer_load_dwordx4 a[196:199], v54, s[8:11], s62 offen sc1
    v_mfma_f32_16x16x32_bf16 a[68:71], a[0:3], a[140:143], a[68:71]
    ds_read_b64_tr_b16 a[42:43], v47 offset:1024
    v_mfma_f32_16x16x32_bf16 a[76:79], a[8:11], a[140:143], a[76:79]
    ds_read_b64_tr_b16 a[44:45], v47 offset:8192
    v_mfma_f32_16x16x32_bf16 a[76:79], a[12:15], a[156:159], a[76:79]
    ds_read_b64_tr_b16 a[46:47], v47 offset:9216
    v_mfma_f32_16x16x32_bf16 a[72:75], a[12:15], a[152:155], a[72:75]
    ds_read_b64_tr_b16 a[48:49], v48 offset:0
    v_mfma_f32_16x16x32_bf16 a[72:75], a[8:11], a[136:139], a[72:75]
    buffer_load_dwordx4 a[200:203], v37, s[8:11], s62 offen sc1
    v_mfma_f32_16x16x32_bf16 v[204:207], a[8:11], a[132:135], v[204:207]
    ds_read_b64_tr_b16 a[50:51], v48 offset:1024
    v_mfma_f32_16x16x32_bf16 v[204:207], a[12:15], a[148:151], v[204:207]
    ds_read_b64_tr_b16 a[52:53], v48 offset:8192
    v_mfma_f32_16x16x32_bf16 v[200:203], a[12:15], a[144:147], v[200:203]
    ds_read_b64_tr_b16 a[54:55], v48 offset:9216
    v_mfma_f32_16x16x32_bf16 v[200:203], a[8:11], a[128:131], v[200:203]
    v_mfma_f32_16x16x32_bf16 v[208:211], a[16:19], a[128:131], v[208:211]
    ds_read_b64_tr_b16 a[56:57], v49 offset:0
    v_mfma_f32_16x16x32_bf16 v[208:211], a[20:23], a[144:147], v[208:211]
    buffer_load_dwordx4 a[204:207], v55, s[8:11], s62 offen sc1
    ds_read_b64_tr_b16 a[58:59], v49 offset:1024
    v_mfma_f32_16x16x32_bf16 v[212:215], a[20:23], a[148:151], v[212:215]
    ds_read_b64_tr_b16 a[60:61], v49 offset:8192
    v_mfma_f32_16x16x32_bf16 v[212:215], a[16:19], a[132:135], v[212:215]
    v_mfma_f32_16x16x32_bf16 a[80:83], a[16:19], a[136:139], a[80:83]
    ds_read_b64_tr_b16 a[62:63], v49 offset:9216
    v_mfma_f32_16x16x32_bf16 a[80:83], a[20:23], a[152:155], a[80:83]
    s_add_u32 s62, s62, 0x20000
    v_mfma_f32_16x16x32_bf16 a[84:87], a[20:23], a[156:159], a[84:87]
    s_add_u32 s52, s47, 528384
    v_mfma_f32_16x16x32_bf16 a[84:87], a[16:19], a[140:143], a[84:87]
    buffer_store_dwordx4 v[152:155], v1, s[48:51], s52 offen offset:2048 sc1
    v_mfma_f32_16x16x32_bf16 a[92:95], a[24:27], a[140:143], a[92:95]
    v_mfma_f32_16x16x32_bf16 a[92:95], a[28:31], a[156:159], a[92:95]
    v_mfma_f32_16x16x32_bf16 a[88:91], a[28:31], a[152:155], a[88:91]
    v_mfma_f32_16x16x32_bf16 a[88:91], a[24:27], a[136:139], a[88:91]
    v_mfma_f32_16x16x32_bf16 v[220:223], a[24:27], a[132:135], v[220:223]
    v_mfma_f32_16x16x32_bf16 v[220:223], a[28:31], a[148:151], v[220:223]
    v_mfma_f32_16x16x32_bf16 v[216:219], a[28:31], a[144:147], v[216:219]
    v_mfma_f32_16x16x32_bf16 v[216:219], a[24:27], a[128:131], v[216:219]
    s_waitcnt vmcnt(10) lgkmcnt(0)
    s_barrier
    v_mfma_f32_16x16x32_bf16 v[224:227], a[32:35], a[128:131], v[224:227]
    v_mfma_f32_16x16x32_bf16 v[224:227], a[36:39], a[144:147], v[224:227]
    s_add_u32 m0, s60, 131072
    ds_read_b64_tr_b16 a[0:1], v42 offset:16384
    ds_read_b64_tr_b16 a[2:3], v42 offset:17408
    v_mfma_f32_16x16x32_bf16 v[228:231], a[36:39], a[148:151], v[228:231]
    buffer_load_dwordx4 v38, s[12:15], s61 offen offset:0 lds
    v_mfma_f32_16x16x32_bf16 v[228:231], a[32:35], a[132:135], v[228:231]
    ds_read_b64_tr_b16 a[4:5], v42 offset:24576
    v_mfma_f32_16x16x32_bf16 a[96:99], a[32:35], a[136:139], a[96:99]
    buffer_load_dwordx4 v39, s[12:15], s61 offen offset:1024 lds
    ds_read_b64_tr_b16 a[6:7], v42 offset:25600
    v_mfma_f32_16x16x32_bf16 a[96:99], a[36:39], a[152:155], a[96:99]
    ds_read_b64_tr_b16 a[8:9], v43 offset:16384
    v_mfma_f32_16x16x32_bf16 a[100:103], a[36:39], a[156:159], a[100:103]
    v_mfma_f32_16x16x32_bf16 a[100:103], a[32:35], a[140:143], a[100:103]
    buffer_load_dwordx4 v40, s[12:15], s61 offen offset:2048 lds
    ds_read_b64_tr_b16 a[10:11], v43 offset:17408
    v_mfma_f32_16x16x32_bf16 a[108:111], a[40:43], a[140:143], a[108:111]
    ds_read_b64_tr_b16 a[12:13], v43 offset:24576
    v_mfma_f32_16x16x32_bf16 a[108:111], a[44:47], a[156:159], a[108:111]
    ds_read_b64_tr_b16 a[14:15], v43 offset:25600
    v_mfma_f32_16x16x32_bf16 a[104:107], a[44:47], a[152:155], a[104:107]
    buffer_load_dwordx4 v41, s[12:15], s61 offen offset:3072 lds
    ds_read_b64_tr_b16 a[16:17], v44 offset:16384
    v_mfma_f32_16x16x32_bf16 a[104:107], a[40:43], a[136:139], a[104:107]
    v_mfma_f32_16x16x32_bf16 v[236:239], a[40:43], a[132:135], v[236:239]
    s_add_u32 s61, s61, 0x80000
    ds_read_b64_tr_b16 a[18:19], v44 offset:17408
    v_mfma_f32_16x16x32_bf16 v[236:239], a[44:47], a[148:151], v[236:239]
    buffer_load_dwordx4 a[208:211], v36, s[8:11], s62 offen sc1
    ds_read_b64_tr_b16 a[20:21], v44 offset:24576
    v_mfma_f32_16x16x32_bf16 v[232:235], a[44:47], a[144:147], v[232:235]
    ds_read_b64_tr_b16 a[22:23], v44 offset:25600
    v_mfma_f32_16x16x32_bf16 v[232:235], a[40:43], a[128:131], v[232:235]
    buffer_load_dwordx4 a[212:215], v54, s[8:11], s62 offen sc1
    v_mfma_f32_16x16x32_bf16 v[240:243], a[48:51], a[128:131], v[240:243]
    ds_read_b64_tr_b16 a[24:25], v45 offset:16384
    v_mfma_f32_16x16x32_bf16 v[240:243], a[52:55], a[144:147], v[240:243]
    ds_read_b64_tr_b16 a[26:27], v45 offset:17408
    v_mfma_f32_16x16x32_bf16 v[244:247], a[52:55], a[148:151], v[244:247]
    buffer_load_dwordx4 a[216:219], v37, s[8:11], s62 offen sc1
    ds_read_b64_tr_b16 a[28:29], v45 offset:24576
    v_mfma_f32_16x16x32_bf16 v[244:247], a[48:51], a[132:135], v[244:247]
    v_mfma_f32_16x16x32_bf16 a[112:115], a[48:51], a[136:139], a[112:115]
    ds_read_b64_tr_b16 a[30:31], v45 offset:25600
    v_mfma_f32_16x16x32_bf16 a[112:115], a[52:55], a[152:155], a[112:115]
    buffer_load_dwordx4 a[220:223], v55, s[8:11], s62 offen sc1
    v_mfma_f32_16x16x32_bf16 a[116:119], a[52:55], a[156:159], a[116:119]
    v_mfma_f32_16x16x32_bf16 a[116:119], a[48:51], a[140:143], a[116:119]
    s_add_u32 s62, s62, 0x20000
    v_mfma_f32_16x16x32_bf16 a[124:127], a[56:59], a[140:143], a[124:127]
    s_add_u32 s52, s47, 528384
    v_mfma_f32_16x16x32_bf16 a[124:127], a[60:63], a[156:159], a[124:127]
    buffer_store_dwordx4 v[156:159], v1, s[48:51], s52 offen offset:3072 sc1
    v_mfma_f32_16x16x32_bf16 a[120:123], a[60:63], a[152:155], a[120:123]
    v_mfma_f32_16x16x32_bf16 a[120:123], a[56:59], a[136:139], a[120:123]
    v_mfma_f32_16x16x32_bf16 v[252:255], a[56:59], a[132:135], v[252:255]
    v_mfma_f32_16x16x32_bf16 v[252:255], a[60:63], a[148:151], v[252:255]
    v_mfma_f32_16x16x32_bf16 v[248:251], a[60:63], a[144:147], v[248:251]
    v_mfma_f32_16x16x32_bf16 v[248:251], a[56:59], a[128:131], v[248:251]
    s_waitcnt vmcnt(15) lgkmcnt(0)
    v_mfma_f32_16x16x32_bf16 v[192:195], a[0:3], a[160:163], v[192:195]
    v_mfma_f32_16x16x32_bf16 v[192:195], a[4:7], a[176:179], v[192:195]
    buffer_load_dwordx4 a[224:227], v36, s[8:11], s62 offen sc1
    ds_read_b64_tr_b16 a[32:33], v46 offset:16384
    v_mfma_f32_16x16x32_bf16 v[196:199], a[4:7], a[180:183], v[196:199]
    ds_read_b64_tr_b16 a[34:35], v46 offset:17408
    v_mfma_f32_16x16x32_bf16 v[196:199], a[0:3], a[164:167], v[196:199]
    ds_read_b64_tr_b16 a[36:37], v46 offset:24576
    v_mfma_f32_16x16x32_bf16 a[64:67], a[0:3], a[168:171], a[64:67]
    ds_read_b64_tr_b16 a[38:39], v46 offset:25600
    v_mfma_f32_16x16x32_bf16 a[64:67], a[4:7], a[184:187], a[64:67]
    ds_read_b64_tr_b16 a[40:41], v47 offset:16384
    v_mfma_f32_16x16x32_bf16 a[68:71], a[4:7], a[188:191], a[68:71]
    buffer_load_dwordx4 a[228:231], v54, s[8:11], s62 offen sc1
    v_mfma_f32_16x16x32_bf16 a[68:71], a[0:3], a[172:175], a[68:71]
    ds_read_b64_tr_b16 a[42:43], v47 offset:17408
    v_mfma_f32_16x16x32_bf16 a[76:79], a[8:11], a[172:175], a[76:79]
    ds_read_b64_tr_b16 a[44:45], v47 offset:24576
    v_mfma_f32_16x16x32_bf16 a[76:79], a[12:15], a[188:191], a[76:79]
    ds_read_b64_tr_b16 a[46:47], v47 offset:25600
    v_mfma_f32_16x16x32_bf16 a[72:75], a[12:15], a[184:187], a[72:75]
    ds_read_b64_tr_b16 a[48:49], v48 offset:16384
    v_mfma_f32_16x16x32_bf16 a[72:75], a[8:11], a[168:171], a[72:75]
    buffer_load_dwordx4 a[232:235], v37, s[8:11], s62 offen sc1
    v_mfma_f32_16x16x32_bf16 v[204:207], a[8:11], a[164:167], v[204:207]
    ds_read_b64_tr_b16 a[50:51], v48 offset:17408
    v_mfma_f32_16x16x32_bf16 v[204:207], a[12:15], a[180:183], v[204:207]
    ds_read_b64_tr_b16 a[52:53], v48 offset:24576
    v_mfma_f32_16x16x32_bf16 v[200:203], a[12:15], a[176:179], v[200:203]
    ds_read_b64_tr_b16 a[54:55], v48 offset:25600
    v_mfma_f32_16x16x32_bf16 v[200:203], a[8:11], a[160:163], v[200:203]
    v_mfma_f32_16x16x32_bf16 v[208:211], a[16:19], a[160:163], v[208:211]
    ds_read_b64_tr_b16 a[56:57], v49 offset:16384
    v_mfma_f32_16x16x32_bf16 v[208:211], a[20:23], a[176:179], v[208:211]
    buffer_load_dwordx4 a[236:239], v55, s[8:11], s62 offen sc1
    ds_read_b64_tr_b16 a[58:59], v49 offset:17408
    v_mfma_f32_16x16x32_bf16 v[212:215], a[20:23], a[180:183], v[212:215]
    ds_read_b64_tr_b16 a[60:61], v49 offset:24576
    v_mfma_f32_16x16x32_bf16 v[212:215], a[16:19], a[164:167], v[212:215]
    v_mfma_f32_16x16x32_bf16 a[80:83], a[16:19], a[168:171], a[80:83]
    ds_read_b64_tr_b16 a[62:63], v49 offset:25600
    v_mfma_f32_16x16x32_bf16 a[80:83], a[20:23], a[184:187], a[80:83]
    s_add_u32 s62, s62, 0x20000
    v_mfma_f32_16x16x32_bf16 a[84:87], a[20:23], a[188:191], a[84:87]
    s_add_u32 s52, s47, 532480
    v_mfma_f32_16x16x32_bf16 a[84:87], a[16:19], a[172:175], a[84:87]
    buffer_store_dwordx4 v[168:171], v1, s[48:51], s52 offen offset:2048 sc1
    v_mfma_f32_16x16x32_bf16 a[92:95], a[24:27], a[172:175], a[92:95]
    v_mfma_f32_16x16x32_bf16 a[92:95], a[28:31], a[188:191], a[92:95]
    v_mfma_f32_16x16x32_bf16 a[88:91], a[28:31], a[184:187], a[88:91]
    v_mfma_f32_16x16x32_bf16 a[88:91], a[24:27], a[168:171], a[88:91]
    v_mfma_f32_16x16x32_bf16 v[220:223], a[24:27], a[164:167], v[220:223]
    v_mfma_f32_16x16x32_bf16 v[220:223], a[28:31], a[180:183], v[220:223]
    v_mfma_f32_16x16x32_bf16 v[216:219], a[28:31], a[176:179], v[216:219]
    v_mfma_f32_16x16x32_bf16 v[216:219], a[24:27], a[160:163], v[216:219]
    s_waitcnt vmcnt(10) lgkmcnt(0)
    s_barrier
    v_mfma_f32_16x16x32_bf16 v[224:227], a[32:35], a[160:163], v[224:227]
    s_cmp_eq_u32 s56, 0
    s_cbranch_scc1 k12_ool_66
k12_oolret_67:
    v_mfma_f32_16x16x32_bf16 v[224:227], a[36:39], a[176:179], v[224:227]
    s_add_u32 m0, s60, 147456
    ds_read_b64_tr_b16 a[0:1], v42 offset:32768
    ds_read_b64_tr_b16 a[2:3], v42 offset:33792
    v_mfma_f32_16x16x32_bf16 v[228:231], a[36:39], a[180:183], v[228:231]
    buffer_load_dwordx4 v38, s[12:15], s61 offen offset:0 lds
    v_mfma_f32_16x16x32_bf16 v[228:231], a[32:35], a[164:167], v[228:231]
    ds_read_b64_tr_b16 a[4:5], v42 offset:40960
    v_mfma_f32_16x16x32_bf16 a[96:99], a[32:35], a[168:171], a[96:99]
    buffer_load_dwordx4 v39, s[12:15], s61 offen offset:1024 lds
    ds_read_b64_tr_b16 a[6:7], v42 offset:41984
    v_mfma_f32_16x16x32_bf16 a[96:99], a[36:39], a[184:187], a[96:99]
    ds_read_b64_tr_b16 a[8:9], v43 offset:32768
    v_mfma_f32_16x16x32_bf16 a[100:103], a[36:39], a[188:191], a[100:103]
    v_mfma_f32_16x16x32_bf16 a[100:103], a[32:35], a[172:175], a[100:103]
    buffer_load_dwordx4 v40, s[12:15], s61 offen offset:2048 lds
    ds_read_b64_tr_b16 a[10:11], v43 offset:33792
    v_mfma_f32_16x16x32_bf16 a[108:111], a[40:43], a[172:175], a[108:111]
    s_mov_b32 s32, s60
    ds_read_b64_tr_b16 a[12:13], v43 offset:40960
    v_mfma_f32_16x16x32_bf16 a[108:111], a[44:47], a[188:191], a[108:111]
    ds_read_b64_tr_b16 a[14:15], v43 offset:41984
    v_mfma_f32_16x16x32_bf16 a[104:107], a[44:47], a[184:187], a[104:107]
    s_mov_b32 s34, s60
    ds_read_b64_tr_b16 a[16:17], v44 offset:32768
    v_mfma_f32_16x16x32_bf16 a[104:107], a[40:43], a[168:171], a[104:107]
    buffer_load_dwordx4 v41, s[12:15], s61 offen offset:3072 lds
    v_mfma_f32_16x16x32_bf16 v[236:239], a[40:43], a[164:167], v[236:239]
    ds_read_b64_tr_b16 a[18:19], v44 offset:33792
    v_mfma_f32_16x16x32_bf16 v[236:239], a[44:47], a[180:183], v[236:239]
    s_mov_b32 s33, s60
    ds_read_b64_tr_b16 a[20:21], v44 offset:40960
    v_mfma_f32_16x16x32_bf16 v[232:235], a[44:47], a[176:179], v[232:235]
    s_add_u32 s61, s61, 0x80000
    buffer_load_dwordx4 a[240:243], v36, s[8:11], s62 offen sc1
    ds_read_b64_tr_b16 a[22:23], v44 offset:41984
    v_mfma_f32_16x16x32_bf16 v[232:235], a[40:43], a[160:163], v[232:235]
    v_mfma_f32_16x16x32_bf16 v[240:243], a[48:51], a[160:163], v[240:243]
    s_add_u32 s35, s60, 0x10000
    ds_read_b64_tr_b16 a[24:25], v45 offset:32768
    v_mfma_f32_16x16x32_bf16 v[240:243], a[52:55], a[176:179], v[240:243]
    buffer_load_dwordx4 a[244:247], v54, s[8:11], s62 offen sc1
    ds_read_b64_tr_b16 a[26:27], v45 offset:33792
    v_mfma_f32_16x16x32_bf16 v[244:247], a[52:55], a[180:183], v[244:247]
    ds_read_b64_tr_b16 a[28:29], v45 offset:40960
    v_mfma_f32_16x16x32_bf16 v[244:247], a[48:51], a[164:167], v[244:247]
    v_mfma_f32_16x16x32_bf16 a[112:115], a[48:51], a[168:171], a[112:115]
    buffer_load_dwordx4 a[248:251], v37, s[8:11], s62 offen sc1
    ds_read_b64_tr_b16 a[30:31], v45 offset:41984
    v_mfma_f32_16x16x32_bf16 a[112:115], a[52:55], a[184:187], a[112:115]
    v_mfma_f32_16x16x32_bf16 a[116:119], a[52:55], a[188:191], a[116:119]
    v_mfma_f32_16x16x32_bf16 a[116:119], a[48:51], a[172:175], a[116:119]
    v_mfma_f32_16x16x32_bf16 a[124:127], a[56:59], a[172:175], a[124:127]
    buffer_load_dwordx4 a[252:255], v55, s[8:11], s62 offen sc1
    v_mfma_f32_16x16x32_bf16 a[124:127], a[60:63], a[188:191], a[124:127]
    v_mfma_f32_16x16x32_bf16 a[120:123], a[60:63], a[184:187], a[120:123]
    s_add_u32 s62, s62, 0x20000
    v_mfma_f32_16x16x32_bf16 a[120:123], a[56:59], a[168:171], a[120:123]
    v_mfma_f32_16x16x32_bf16 v[252:255], a[56:59], a[164:167], v[252:255]
    v_mfma_f32_16x16x32_bf16 v[252:255], a[60:63], a[180:183], v[252:255]
    v_mfma_f32_16x16x32_bf16 v[248:251], a[60:63], a[176:179], v[248:251]
    v_mfma_f32_16x16x32_bf16 v[248:251], a[56:59], a[160:163], v[248:251]
    s_waitcnt vmcnt(14) lgkmcnt(0)
    v_mfma_f32_16x16x32_bf16 v[192:195], a[0:3], a[192:195], v[192:195]
    v_mfma_f32_16x16x32_bf16 v[192:195], a[4:7], a[208:211], v[192:195]
    buffer_load_dwordx4 a[128:131], v36, s[8:11], s62 offen sc1
    ds_read_b64_tr_b16 a[32:33], v46 offset:32768
    v_mfma_f32_16x16x32_bf16 v[196:199], a[4:7], a[212:215], v[196:199]
    ds_read_b64_tr_b16 a[34:35], v46 offset:33792
    v_mfma_f32_16x16x32_bf16 v[196:199], a[0:3], a[196:199], v[196:199]
    ds_read_b64_tr_b16 a[36:37], v46 offset:40960
    v_mfma_f32_16x16x32_bf16 a[64:67], a[0:3], a[200:203], a[64:67]
    ds_read_b64_tr_b16 a[38:39], v46 offset:41984
    v_mfma_f32_16x16x32_bf16 a[64:67], a[4:7], a[216:219], a[64:67]
    ds_read_b64_tr_b16 a[40:41], v47 offset:32768
    v_mfma_f32_16x16x32_bf16 a[68:71], a[4:7], a[220:223], a[68:71]
    buffer_load_dwordx4 a[132:135], v54, s[8:11], s62 offen sc1
    v_mfma_f32_16x16x32_bf16 a[68:71], a[0:3], a[204:207], a[68:71]
    ds_read_b64_tr_b16 a[42:43], v47 offset:33792
    v_mfma_f32_16x16x32_bf16 a[76:79], a[8:11], a[204:207], a[76:79]
    ds_read_b64_tr_b16 a[44:45], v47 offset:40960
    v_mfma_f32_16x16x32_bf16 a[76:79], a[12:15], a[220:223], a[76:79]
    ds_read_b64_tr_b16 a[46:47], v47 offset:41984
    v_mfma_f32_16x16x32_bf16 a[72:75], a[12:15], a[216:219], a[72:75]
    ds_read_b64_tr_b16 a[48:49], v48 offset:32768
    v_mfma_f32_16x16x32_bf16 a[72:75], a[8:11], a[200:203], a[72:75]
    buffer_load_dwordx4 a[136:139], v37, s[8:11], s62 offen sc1
    v_mfma_f32_16x16x32_bf16 v[204:207], a[8:11], a[196:199], v[204:207]
    ds_read_b64_tr_b16 a[50:51], v48 offset:33792
    v_mfma_f32_16x16x32_bf16 v[204:207], a[12:15], a[212:215], v[204:207]
    ds_read_b64_tr_b16 a[52:53], v48 offset:40960
    v_mfma_f32_16x16x32_bf16 v[200:203], a[12:15], a[208:211], v[200:203]
    ds_read_b64_tr_b16 a[54:55], v48 offset:41984
    v_mfma_f32_16x16x32_bf16 v[200:203], a[8:11], a[192:195], v[200:203]
    v_mfma_f32_16x16x32_bf16 v[208:211], a[16:19], a[192:195], v[208:211]
    ds_read_b64_tr_b16 a[56:57], v49 offset:32768
    v_mfma_f32_16x16x32_bf16 v[208:211], a[20:23], a[208:211], v[208:211]
    buffer_load_dwordx4 a[140:143], v55, s[8:11], s62 offen sc1
    ds_read_b64_tr_b16 a[58:59], v49 offset:33792
    v_mfma_f32_16x16x32_bf16 v[212:215], a[20:23], a[212:215], v[212:215]
    ds_read_b64_tr_b16 a[60:61], v49 offset:40960
    v_mfma_f32_16x16x32_bf16 v[212:215], a[16:19], a[196:199], v[212:215]
    v_mfma_f32_16x16x32_bf16 a[80:83], a[16:19], a[200:203], a[80:83]
    ds_read_b64_tr_b16 a[62:63], v49 offset:41984
    v_mfma_f32_16x16x32_bf16 a[80:83], a[20:23], a[216:219], a[80:83]
    s_add_u32 s62, s62, 0x20000
    v_mfma_f32_16x16x32_bf16 a[84:87], a[20:23], a[220:223], a[84:87]
    s_add_u32 s52, s47, 532480
    v_mfma_f32_16x16x32_bf16 a[84:87], a[16:19], a[204:207], a[84:87]
    buffer_store_dwordx4 v[172:175], v1, s[48:51], s52 offen offset:3072 sc1
    v_mfma_f32_16x16x32_bf16 a[92:95], a[24:27], a[204:207], a[92:95]
    v_mfma_f32_16x16x32_bf16 a[92:95], a[28:31], a[220:223], a[92:95]
    v_mfma_f32_16x16x32_bf16 a[88:91], a[28:31], a[216:219], a[88:91]
    v_mfma_f32_16x16x32_bf16 a[88:91], a[24:27], a[200:203], a[88:91]
    v_mfma_f32_16x16x32_bf16 v[220:223], a[24:27], a[196:199], v[220:223]
    v_add_co_u32 v2, vcc, 0x4000, v2
    s_nop 1
    v_addc_co_u32 v3, vcc, 0, v3, vcc
    global_load_dword v51, v[2:3], off
    v_mfma_f32_16x16x32_bf16 v[220:223], a[28:31], a[212:215], v[220:223]
    v_mfma_f32_16x16x32_bf16 v[216:219], a[28:31], a[208:211], v[216:219]
    v_mfma_f32_16x16x32_bf16 v[216:219], a[24:27], a[192:195], v[216:219]
    s_waitcnt vmcnt(9) lgkmcnt(0)
    s_barrier
    v_mfma_f32_16x16x32_bf16 v[224:227], a[32:35], a[192:195], v[224:227]
    v_mfma_f32_16x16x32_bf16 v[224:227], a[36:39], a[208:211], v[224:227]
    s_add_u32 m0, s60, 98304
    ds_read_b64_tr_b16 a[0:1], v42 offset:49152
    ds_read_b64_tr_b16 a[2:3], v42 offset:50176
    v_mfma_f32_16x16x32_bf16 v[228:231], a[36:39], a[212:215], v[228:231]
    buffer_load_dwordx4 v38, s[12:15], s61 offen offset:0 lds
    v_mfma_f32_16x16x32_bf16 v[228:231], a[32:35], a[196:199], v[228:231]
    ds_read_b64_tr_b16 a[4:5], v42 offset:57344
    v_mfma_f32_16x16x32_bf16 a[96:99], a[32:35], a[200:203], a[96:99]
    buffer_load_dwordx4 v39, s[12:15], s61 offen offset:1024 lds
    ds_read_b64_tr_b16 a[6:7], v42 offset:58368
    v_mfma_f32_16x16x32_bf16 a[96:99], a[36:39], a[216:219], a[96:99]
    ds_read_b64_tr_b16 a[8:9], v43 offset:49152
    v_mfma_f32_16x16x32_bf16 a[100:103], a[36:39], a[220:223], a[100:103]
    v_mfma_f32_16x16x32_bf16 a[100:103], a[32:35], a[204:207], a[100:103]
    buffer_load_dwordx4 v40, s[12:15], s61 offen offset:2048 lds
    ds_read_b64_tr_b16 a[10:11], v43 offset:50176
    v_mfma_f32_16x16x32_bf16 a[108:111], a[40:43], a[204:207], a[108:111]
    ds_read_b64_tr_b16 a[12:13], v43 offset:57344
    v_mfma_f32_16x16x32_bf16 a[108:111], a[44:47], a[220:223], a[108:111]
    ds_read_b64_tr_b16 a[14:15], v43 offset:58368
    v_mfma_f32_16x16x32_bf16 a[104:107], a[44:47], a[216:219], a[104:107]
    buffer_load_dwordx4 v41, s[12:15], s61 offen offset:3072 lds
    ds_read_b64_tr_b16 a[16:17], v44 offset:49152
    v_mfma_f32_16x16x32_bf16 a[104:107], a[40:43], a[200:203], a[104:107]
    v_mfma_f32_16x16x32_bf16 v[236:239], a[40:43], a[196:199], v[236:239]
    s_add_u32 s61, s61, 0x80000
    ds_read_b64_tr_b16 a[18:19], v44 offset:50176
    v_mfma_f32_16x16x32_bf16 v[236:239], a[44:47], a[212:215], v[236:239]
    buffer_load_dwordx4 a[144:147], v36, s[8:11], s62 offen sc1
    ds_read_b64_tr_b16 a[20:21], v44 offset:57344
    v_mfma_f32_16x16x32_bf16 v[232:235], a[44:47], a[208:211], v[232:235]
    ds_read_b64_tr_b16 a[22:23], v44 offset:58368
    v_mfma_f32_16x16x32_bf16 v[232:235], a[40:43], a[192:195], v[232:235]
    buffer_load_dwordx4 a[148:151], v54, s[8:11], s62 offen sc1
    v_mfma_f32_16x16x32_bf16 v[240:243], a[48:51], a[192:195], v[240:243]
    ds_read_b64_tr_b16 a[24:25], v45 offset:49152
    v_mfma_f32_16x16x32_bf16 v[240:243], a[52:55], a[208:211], v[240:243]
    ds_read_b64_tr_b16 a[26:27], v45 offset:50176
    v_mfma_f32_16x16x32_bf16 v[244:247], a[52:55], a[212:215], v[244:247]
    buffer_load_dwordx4 a[152:155], v37, s[8:11], s62 offen sc1
    ds_read_b64_tr_b16 a[28:29], v45 offset:57344
    v_mfma_f32_16x16x32_bf16 v[244:247], a[48:51], a[196:199], v[244:247]
    v_mfma_f32_16x16x32_bf16 a[112:115], a[48:51], a[200:203], a[112:115]
    ds_read_b64_tr_b16 a[30:31], v45 offset:58368
    v_mfma_f32_16x16x32_bf16 a[112:115], a[52:55], a[216:219], a[112:115]
    buffer_load_dwordx4 a[156:159], v55, s[8:11], s62 offen sc1
    v_mfma_f32_16x16x32_bf16 a[116:119], a[52:55], a[220:223], a[116:119]
    v_mfma_f32_16x16x32_bf16 a[116:119], a[48:51], a[204:207], a[116:119]
    s_add_u32 s62, s62, 0x20000
    v_mfma_f32_16x16x32_bf16 a[124:127], a[56:59], a[204:207], a[124:127]
    s_add_u32 s52, s47, 536576
    v_mfma_f32_16x16x32_bf16 a[124:127], a[60:63], a[220:223], a[124:127]
    buffer_store_dwordx4 v[176:179], v1, s[48:51], s52 offen offset:0 sc1
    v_mfma_f32_16x16x32_bf16 a[120:123], a[60:63], a[216:219], a[120:123]
    v_mfma_f32_16x16x32_bf16 a[120:123], a[56:59], a[200:203], a[120:123]
    v_mfma_f32_16x16x32_bf16 v[252:255], a[56:59], a[196:199], v[252:255]
    v_mfma_f32_16x16x32_bf16 v[252:255], a[60:63], a[212:215], v[252:255]
    v_mfma_f32_16x16x32_bf16 v[248:251], a[60:63], a[208:211], v[248:251]
    v_mfma_f32_16x16x32_bf16 v[248:251], a[56:59], a[192:195], v[248:251]
    s_waitcnt vmcnt(14) lgkmcnt(0)
    v_mfma_f32_16x16x32_bf16 v[192:195], a[0:3], a[224:227], v[192:195]
    v_mfma_f32_16x16x32_bf16 v[192:195], a[4:7], a[240:243], v[192:195]
    buffer_load_dwordx4 a[160:163], v36, s[8:11], s62 offen sc1
    ds_read_b64_tr_b16 a[32:33], v46 offset:49152
    v_mfma_f32_16x16x32_bf16 v[196:199], a[4:7], a[244:247], v[196:199]
    ds_read_b64_tr_b16 a[34:35], v46 offset:50176
    v_mfma_f32_16x16x32_bf16 v[196:199], a[0:3], a[228:231], v[196:199]
    ds_read_b64_tr_b16 a[36:37], v46 offset:57344
    v_mfma_f32_16x16x32_bf16 a[64:67], a[0:3], a[232:235], a[64:67]
    ds_read_b64_tr_b16 a[38:39], v46 offset:58368
    v_mfma_f32_16x16x32_bf16 a[64:67], a[4:7], a[248:251], a[64:67]
    ds_read_b64_tr_b16 a[40:41], v47 offset:49152
    v_mfma_f32_16x16x32_bf16 a[68:71], a[4:7], a[252:255], a[68:71]
    buffer_load_dwordx4 a[164:167], v54, s[8:11], s62 offen sc1
    v_mfma_f32_16x16x32_bf16 a[68:71], a[0:3], a[236:239], a[68:71]
    ds_read_b64_tr_b16 a[42:43], v47 offset:50176
    v_mfma_f32_16x16x32_bf16 a[76:79], a[8:11], a[236:239], a[76:79]
    ds_read_b64_tr_b16 a[44:45], v47 offset:57344
    v_mfma_f32_16x16x32_bf16 a[76:79], a[12:15], a[252:255], a[76:79]
    ds_read_b64_tr_b16 a[46:47], v47 offset:58368
    v_mfma_f32_16x16x32_bf16 a[72:75], a[12:15], a[248:251], a[72:75]
    ds_read_b64_tr_b16 a[48:49], v48 offset:49152
    v_mfma_f32_16x16x32_bf16 a[72:75], a[8:11], a[232:235], a[72:75]
    buffer_load_dwordx4 a[168:171], v37, s[8:11], s62 offen sc1
    v_mfma_f32_16x16x32_bf16 v[204:207], a[8:11], a[228:231], v[204:207]
    ds_read_b64_tr_b16 a[50:51], v48 offset:50176
    v_mfma_f32_16x16x32_bf16 v[204:207], a[12:15], a[244:247], v[204:207]
    ds_read_b64_tr_b16 a[52:53], v48 offset:57344
    v_mfma_f32_16x16x32_bf16 v[200:203], a[12:15], a[240:243], v[200:203]
    ds_read_b64_tr_b16 a[54:55], v48 offset:58368
    v_mfma_f32_16x16x32_bf16 v[200:203], a[8:11], a[224:227], v[200:203]
    v_mfma_f32_16x16x32_bf16 v[208:211], a[16:19], a[224:227], v[208:211]
    ds_read_b64_tr_b16 a[56:57], v49 offset:49152
    v_mfma_f32_16x16x32_bf16 v[208:211], a[20:23], a[240:243], v[208:211]
    buffer_load_dwordx4 a[172:175], v55, s[8:11], s62 offen sc1
    ds_read_b64_tr_b16 a[58:59], v49 offset:50176
    v_mfma_f32_16x16x32_bf16 v[212:215], a[20:23], a[244:247], v[212:215]
    ds_read_b64_tr_b16 a[60:61], v49 offset:57344
    v_mfma_f32_16x16x32_bf16 v[212:215], a[16:19], a[228:231], v[212:215]
    v_mfma_f32_16x16x32_bf16 a[80:83], a[16:19], a[232:235], a[80:83]
    ds_read_b64_tr_b16 a[62:63], v49 offset:58368
    v_mfma_f32_16x16x32_bf16 a[80:83], a[20:23], a[248:251], a[80:83]
    s_add_u32 s62, s62, 0x20000
    v_mfma_f32_16x16x32_bf16 a[84:87], a[20:23], a[252:255], a[84:87]
    s_add_u32 s52, s47, 536576
    v_mfma_f32_16x16x32_bf16 a[84:87], a[16:19], a[236:239], a[84:87]
    buffer_store_dwordx4 v[180:183], v1, s[48:51], s52 offen offset:1024 sc1
    v_mfma_f32_16x16x32_bf16 a[92:95], a[24:27], a[236:239], a[92:95]
    v_mfma_f32_16x16x32_bf16 a[92:95], a[28:31], a[252:255], a[92:95]
    v_mfma_f32_16x16x32_bf16 a[88:91], a[28:31], a[248:251], a[88:91]
    v_mfma_f32_16x16x32_bf16 a[88:91], a[24:27], a[232:235], a[88:91]
    v_mfma_f32_16x16x32_bf16 v[220:223], a[24:27], a[228:231], v[220:223]
    v_mfma_f32_16x16x32_bf16 v[220:223], a[28:31], a[244:247], v[220:223]
    v_mfma_f32_16x16x32_bf16 v[216:219], a[28:31], a[240:243], v[216:219]
    v_mfma_f32_16x16x32_bf16 v[216:219], a[24:27], a[224:227], v[216:219]
    s_waitcnt vmcnt(10) lgkmcnt(0)
    s_barrier
    v_mfma_f32_16x16x32_bf16 v[224:227], a[32:35], a[224:227], v[224:227]
    s_cmp_eq_u32 s30, 0
    s_cbranch_scc1 k12_ool_68
k12_oolret_69:
    v_mfma_f32_16x16x32_bf16 v[224:227], a[36:39], a[240:243], v[224:227]
    s_add_u32 m0, s60, 114688
    ds_read_b64_tr_b16 a[0:1], v42 offset:0
    ds_read_b64_tr_b16 a[2:3], v42 offset:1024
    v_mfma_f32_16x16x32_bf16 v[228:231], a[36:39], a[244:247], v[228:231]
    buffer_load_dwordx4 v38, s[12:15], s61 offen offset:0 lds
    v_mfma_f32_16x16x32_bf16 v[228:231], a[32:35], a[228:231], v[228:231]
    ds_read_b64_tr_b16 a[4:5], v42 offset:8192
    v_mfma_f32_16x16x32_bf16 a[96:99], a[32:35], a[232:235], a[96:99]
    buffer_load_dwordx4 v39, s[12:15], s61 offen offset:1024 lds
    ds_read_b64_tr_b16 a[6:7], v42 offset:9216
    v_mfma_f32_16x16x32_bf16 a[96:99], a[36:39], a[248:251], a[96:99]
    ds_read_b64_tr_b16 a[8:9], v43 offset:0
    v_mfma_f32_16x16x32_bf16 a[100:103], a[36:39], a[252:255], a[100:103]
    v_mfma_f32_16x16x32_bf16 a[100:103], a[32:35], a[236:239], a[100:103]
    buffer_load_dwordx4 v40, s[12:15], s61 offen offset:2048 lds
    ds_read_b64_tr_b16 a[10:11], v43 offset:1024
    v_mfma_f32_16x16x32_bf16 a[108:111], a[40:43], a[236:239], a[108:111]
    ds_read_b64_tr_b16 a[12:13], v43 offset:8192
    v_mfma_f32_16x16x32_bf16 a[108:111], a[44:47], a[252:255], a[108:111]
    ds_read_b64_tr_b16 a[14:15], v43 offset:9216
    v_mfma_f32_16x16x32_bf16 a[104:107], a[44:47], a[248:251], a[104:107]
    buffer_load_dwordx4 v41, s[12:15], s61 offen offset:3072 lds
    ds_read_b64_tr_b16 a[16:17], v44 offset:0
    v_mfma_f32_16x16x32_bf16 a[104:107], a[40:43], a[232:235], a[104:107]
    v_mfma_f32_16x16x32_bf16 v[236:239], a[40:43], a[228:231], v[236:239]
    s_add_u32 s61, s61, 0x80000
    ds_read_b64_tr_b16 a[18:19], v44 offset:1024
    v_mfma_f32_16x16x32_bf16 v[236:239], a[44:47], a[244:247], v[236:239]
    buffer_load_dwordx4 a[176:179], v36, s[8:11], s62 offen sc1
    ds_read_b64_tr_b16 a[20:21], v44 offset:8192
    v_mfma_f32_16x16x32_bf16 v[232:235], a[44:47], a[240:243], v[232:235]
    ds_read_b64_tr_b16 a[22:23], v44 offset:9216
    v_mfma_f32_16x16x32_bf16 v[232:235], a[40:43], a[224:227], v[232:235]
    buffer_load_dwordx4 a[180:183], v54, s[8:11], s62 offen sc1
    v_mfma_f32_16x16x32_bf16 v[240:243], a[48:51], a[224:227], v[240:243]
    ds_read_b64_tr_b16 a[24:25], v45 offset:0
    v_mfma_f32_16x16x32_bf16 v[240:243], a[52:55], a[240:243], v[240:243]
    ds_read_b64_tr_b16 a[26:27], v45 offset:1024
    v_mfma_f32_16x16x32_bf16 v[244:247], a[52:55], a[244:247], v[244:247]
    buffer_load_dwordx4 a[184:187], v37, s[8:11], s62 offen sc1
    ds_read_b64_tr_b16 a[28:29], v45 offset:8192
    v_mfma_f32_16x16x32_bf16 v[244:247], a[48:51], a[228:231], v[244:247]
    v_mfma_f32_16x16x32_bf16 a[112:115], a[48:51], a[232:235], a[112:115]
    ds_read_b64_tr_b16 a[30:31], v45 offset:9216
    v_mfma_f32_16x16x32_bf16 a[112:115], a[52:55], a[248:251], a[112:115]
    buffer_load_dwordx4 a[188:191], v55, s[8:11], s62 offen sc1
    v_mfma_f32_16x16x32_bf16 a[116:119], a[52:55], a[252:255], a[116:119]
    v_mfma_f32_16x16x32_bf16 a[116:119], a[48:51], a[236:239], a[116:119]
    s_add_u32 s62, s62, 0x20000
    v_mfma_f32_16x16x32_bf16 a[124:127], a[56:59], a[236:239], a[124:127]
    s_add_u32 s52, s47, 536576
    v_mfma_f32_16x16x32_bf16 a[124:127], a[60:63], a[252:255], a[124:127]
    buffer_store_dwordx4 v[184:187], v1, s[48:51], s52 offen offset:2048 sc1
    v_mfma_f32_16x16x32_bf16 a[120:123], a[60:63], a[248:251], a[120:123]
    v_mfma_f32_16x16x32_bf16 a[120:123], a[56:59], a[232:235], a[120:123]
    v_mfma_f32_16x16x32_bf16 v[252:255], a[56:59], a[228:231], v[252:255]
    v_mfma_f32_16x16x32_bf16 v[252:255], a[60:63], a[244:247], v[252:255]
    v_mfma_f32_16x16x32_bf16 v[248:251], a[60:63], a[240:243], v[248:251]
    v_mfma_f32_16x16x32_bf16 v[248:251], a[56:59], a[224:227], v[248:251]
    s_waitcnt vmcnt(15) lgkmcnt(0)
    v_mfma_f32_16x16x32_bf16 v[192:195], a[0:3], a[128:131], v[192:195]
    v_mfma_f32_16x16x32_bf16 v[192:195], a[4:7], a[144:147], v[192:195]
    s_add_u32 s52, s47, 536576
    ds_read_b64_tr_b16 a[32:33], v46 offset:0
    ds_read_b64_tr_b16 a[34:35], v46 offset:1024
    v_mfma_f32_16x16x32_bf16 v[196:199], a[4:7], a[148:151], v[196:199]
    buffer_store_dwordx4 v[188:191], v1, s[48:51], s52 offen offset:3072 sc1
    v_mfma_f32_16x16x32_bf16 v[196:199], a[0:3], a[132:135], v[196:199]
    ds_read_b64_tr_b16 a[36:37], v46 offset:8192
    v_mfma_f32_16x16x32_bf16 a[64:67], a[0:3], a[136:139], a[64:67]
    ds_read_b64_tr_b16 a[38:39], v46 offset:9216
    v_mfma_f32_16x16x32_bf16 a[64:67], a[4:7], a[152:155], a[64:67]
    ds_read_b64_tr_b16 a[40:41], v47 offset:0
    v_mfma_f32_16x16x32_bf16 a[68:71], a[4:7], a[156:159], a[68:71]
    v_mfma_f32_16x16x32_bf16 a[68:71], a[0:3], a[140:143], a[68:71]
    ds_read_b64_tr_b16 a[42:43], v47 offset:1024
    v_mfma_f32_16x16x32_bf16 a[76:79], a[8:11], a[140:143], a[76:79]
    ds_read_b64_tr_b16 a[44:45], v47 offset:8192
    v_mfma_f32_16x16x32_bf16 a[76:79], a[12:15], a[156:159], a[76:79]
    ds_read_b64_tr_b16 a[46:47], v47 offset:9216
    v_mfma_f32_16x16x32_bf16 a[72:75], a[12:15], a[152:155], a[72:75]
    ds_read_b64_tr_b16 a[48:49], v48 offset:0
    v_mfma_f32_16x16x32_bf16 a[72:75], a[8:11], a[136:139], a[72:75]
    v_mfma_f32_16x16x32_bf16 v[204:207], a[8:11], a[132:135], v[204:207]
    ds_read_b64_tr_b16 a[50:51], v48 offset:1024
    v_mfma_f32_16x16x32_bf16 v[204:207], a[12:15], a[148:151], v[204:207]
    ds_read_b64_tr_b16 a[52:53], v48 offset:8192
    v_mfma_f32_16x16x32_bf16 v[200:203], a[12:15], a[144:147], v[200:203]
    ds_read_b64_tr_b16 a[54:55], v48 offset:9216
    v_mfma_f32_16x16x32_bf16 v[200:203], a[8:11], a[128:131], v[200:203]
    v_mfma_f32_16x16x32_bf16 v[208:211], a[16:19], a[128:131], v[208:211]
    ds_read_b64_tr_b16 a[56:57], v49 offset:0
    v_mfma_f32_16x16x32_bf16 v[208:211], a[20:23], a[144:147], v[208:211]
    ds_read_b64_tr_b16 a[58:59], v49 offset:1024
    v_mfma_f32_16x16x32_bf16 v[212:215], a[20:23], a[148:151], v[212:215]
    ds_read_b64_tr_b16 a[60:61], v49 offset:8192
    v_mfma_f32_16x16x32_bf16 v[212:215], a[16:19], a[132:135], v[212:215]
    v_mfma_f32_16x16x32_bf16 a[80:83], a[16:19], a[136:139], a[80:83]
    ds_read_b64_tr_b16 a[62:63], v49 offset:9216
    v_mfma_f32_16x16x32_bf16 a[80:83], a[20:23], a[152:155], a[80:83]
    v_mfma_f32_16x16x32_bf16 a[84:87], a[20:23], a[156:159], a[84:87]
    v_mfma_f32_16x16x32_bf16 a[84:87], a[16:19], a[140:143], a[84:87]
    v_mfma_f32_16x16x32_bf16 a[92:95], a[24:27], a[140:143], a[92:95]
    v_mfma_f32_16x16x32_bf16 a[92:95], a[28:31], a[156:159], a[92:95]
    v_mfma_f32_16x16x32_bf16 a[88:91], a[28:31], a[152:155], a[88:91]
    v_mfma_f32_16x16x32_bf16 a[88:91], a[24:27], a[136:139], a[88:91]
    v_mfma_f32_16x16x32_bf16 v[220:223], a[24:27], a[132:135], v[220:223]
    s_cmp_eq_u32 s30, 0
    s_cbranch_scc1 k12_ool_72
k12_oolret_73:
    v_mfma_f32_16x16x32_bf16 v[220:223], a[28:31], a[148:151], v[220:223]
    v_mfma_f32_16x16x32_bf16 v[216:219], a[28:31], a[144:147], v[216:219]
    v_mfma_f32_16x16x32_bf16 v[216:219], a[24:27], a[128:131], v[216:219]
    s_waitcnt vmcnt(6) lgkmcnt(0)
    s_barrier
    v_mfma_f32_16x16x32_bf16 v[224:227], a[32:35], a[128:131], v[224:227]
    v_mfma_f32_16x16x32_bf16 v[224:227], a[36:39], a[144:147], v[224:227]
    s_mov_b32 m0, s34
    ds_read_b64_tr_b16 a[0:1], v42 offset:16384
    ds_read_b64_tr_b16 a[2:3], v42 offset:17408
    v_mfma_f32_16x16x32_bf16 v[228:231], a[36:39], a[148:151], v[228:231]
    buffer_load_dwordx4 v1, s[16:19], s32 offen offset:0 sc1 lds
    v_mfma_f32_16x16x32_bf16 v[228:231], a[32:35], a[132:135], v[228:231]
    ds_read_b64_tr_b16 a[4:5], v42 offset:24576
    v_mfma_f32_16x16x32_bf16 a[96:99], a[32:35], a[136:139], a[96:99]
    buffer_load_dwordx4 v1, s[16:19], s32 offen offset:1024 sc1 lds
    ds_read_b64_tr_b16 a[6:7], v42 offset:25600
    v_mfma_f32_16x16x32_bf16 a[96:99], a[36:39], a[152:155], a[96:99]
    ds_read_b64_tr_b16 a[8:9], v43 offset:16384
    v_mfma_f32_16x16x32_bf16 a[100:103], a[36:39], a[156:159], a[100:103]
    v_mfma_f32_16x16x32_bf16 a[100:103], a[32:35], a[140:143], a[100:103]
    buffer_load_dwordx4 v1, s[16:19], s32 offen offset:2048 sc1 lds
    ds_read_b64_tr_b16 a[10:11], v43 offset:17408
    v_mfma_f32_16x16x32_bf16 a[108:111], a[40:43], a[140:143], a[108:111]
    ds_read_b64_tr_b16 a[12:13], v43 offset:24576
    v_mfma_f32_16x16x32_bf16 a[108:111], a[44:47], a[156:159], a[108:111]
    ds_read_b64_tr_b16 a[14:15], v43 offset:25600
    v_mfma_f32_16x16x32_bf16 a[104:107], a[44:47], a[152:155], a[104:107]
    ds_read_b64_tr_b16 a[16:17], v44 offset:16384
    v_mfma_f32_16x16x32_bf16 a[104:107], a[40:43], a[136:139], a[104:107]
    buffer_load_dwordx4 v1, s[16:19], s32 offen offset:3072 sc1 lds
    v_mfma_f32_16x16x32_bf16 v[236:239], a[40:43], a[132:135], v[236:239]
    ds_read_b64_tr_b16 a[18:19], v44 offset:17408
    v_mfma_f32_16x16x32_bf16 v[236:239], a[44:47], a[148:151], v[236:239]
    s_add_u32 s32, s32, 0x80000
    ds_read_b64_tr_b16 a[20:21], v44 offset:24576
    v_mfma_f32_16x16x32_bf16 v[232:235], a[44:47], a[144:147], v[232:235]
    s_add_u32 s34, s34, 0x4000
    ds_read_b64_tr_b16 a[22:23], v44 offset:25600
    s_mov_b32 m0, s34
    v_mfma_f32_16x16x32_bf16 v[232:235], a[40:43], a[128:131], v[232:235]
    buffer_load_dwordx4 v1, s[16:19], s32 offen offset:0 sc1 lds
    v_mfma_f32_16x16x32_bf16 v[240:243], a[48:51], a[128:131], v[240:243]
    ds_read_b64_tr_b16 a[24:25], v45 offset:16384
    v_mfma_f32_16x16x32_bf16 v[240:243], a[52:55], a[144:147], v[240:243]
    buffer_load_dwordx4 v1, s[16:19], s32 offen offset:1024 sc1 lds
    ds_read_b64_tr_b16 a[26:27], v45 offset:17408
    v_mfma_f32_16x16x32_bf16 v[244:247], a[52:55], a[148:151], v[244:247]
    ds_read_b64_tr_b16 a[28:29], v45 offset:24576
    v_mfma_f32_16x16x32_bf16 v[244:247], a[48:51], a[132:135], v[244:247]
    v_mfma_f32_16x16x32_bf16 a[112:115], a[48:51], a[136:139], a[112:115]
    buffer_load_dwordx4 v1, s[16:19], s32 offen offset:2048 sc1 lds
    ds_read_b64_tr_b16 a[30:31], v45 offset:25600
    v_mfma_f32_16x16x32_bf16 a[112:115], a[52:55], a[152:155], a[112:115]
    v_mfma_f32_16x16x32_bf16 a[116:119], a[52:55], a[156:159], a[116:119]
    v_mfma_f32_16x16x32_bf16 a[116:119], a[48:51], a[140:143], a[116:119]
    v_mfma_f32_16x16x32_bf16 a[124:127], a[56:59], a[140:143], a[124:127]
    buffer_load_dwordx4 v1, s[16:19], s32 offen offset:3072 sc1 lds
    v_mfma_f32_16x16x32_bf16 a[124:127], a[60:63], a[156:159], a[124:127]
    v_mfma_f32_16x16x32_bf16 a[120:123], a[60:63], a[152:155], a[120:123]
    s_add_u32 s32, s32, 0x80000
    v_mfma_f32_16x16x32_bf16 a[120:123], a[56:59], a[136:139], a[120:123]
    s_add_u32 s34, s34, 0x4000
    v_mfma_f32_16x16x32_bf16 v[252:255], a[56:59], a[132:135], v[252:255]
    v_mfma_f32_16x16x32_bf16 v[252:255], a[60:63], a[148:151], v[252:255]
    v_mfma_f32_16x16x32_bf16 v[248:251], a[60:63], a[144:147], v[248:251]
    v_mfma_f32_16x16x32_bf16 v[248:251], a[56:59], a[128:131], v[248:251]
    s_waitcnt vmcnt(10) lgkmcnt(0)
    v_mfma_f32_16x16x32_bf16 v[192:195], a[0:3], a[160:163], v[192:195]
    v_mfma_f32_16x16x32_bf16 v[192:195], a[4:7], a[176:179], v[192:195]
    s_mov_b32 m0, s35
    ds_read_b64_tr_b16 a[32:33], v46 offset:16384
    ds_read_b64_tr_b16 a[34:35], v46 offset:17408
    v_mfma_f32_16x16x32_bf16 v[196:199], a[4:7], a[180:183], v[196:199]
    buffer_load_dwordx4 v1, s[20:23], s33 offen offset:0 sc1 lds
    v_mfma_f32_16x16x32_bf16 v[196:199], a[0:3], a[164:167], v[196:199]
    ds_read_b64_tr_b16 a[36:37], v46 offset:24576
    v_mfma_f32_16x16x32_bf16 a[64:67], a[0:3], a[168:171], a[64:67]
    buffer_load_dwordx4 v1, s[20:23], s33 offen offset:1024 sc1 lds
    ds_read_b64_tr_b16 a[38:39], v46 offset:25600
    v_mfma_f32_16x16x32_bf16 a[64:67], a[4:7], a[184:187], a[64:67]
    ds_read_b64_tr_b16 a[40:41], v47 offset:16384
    v_mfma_f32_16x16x32_bf16 a[68:71], a[4:7], a[188:191], a[68:71]
    v_mfma_f32_16x16x32_bf16 a[68:71], a[0:3], a[172:175], a[68:71]
    buffer_load_dwordx4 v1, s[20:23], s33 offen offset:2048 sc1 lds
    ds_read_b64_tr_b16 a[42:43], v47 offset:17408
    v_mfma_f32_16x16x32_bf16 a[76:79], a[8:11], a[172:175], a[76:79]
    ds_read_b64_tr_b16 a[44:45], v47 offset:24576
    v_mfma_f32_16x16x32_bf16 a[76:79], a[12:15], a[188:191], a[76:79]
    ds_read_b64_tr_b16 a[46:47], v47 offset:25600
    v_mfma_f32_16x16x32_bf16 a[72:75], a[12:15], a[184:187], a[72:75]
    ds_read_b64_tr_b16 a[48:49], v48 offset:16384
    v_mfma_f32_16x16x32_bf16 a[72:75], a[8:11], a[168:171], a[72:75]
    buffer_load_dwordx4 v1, s[20:23], s33 offen offset:3072 sc1 lds
    v_mfma_f32_16x16x32_bf16 v[204:207], a[8:11], a[164:167], v[204:207]
    ds_read_b64_tr_b16 a[50:51], v48 offset:17408
    v_mfma_f32_16x16x32_bf16 v[204:207], a[12:15], a[180:183], v[204:207]
    s_add_u32 s33, s33, 0x80000
    ds_read_b64_tr_b16 a[52:53], v48 offset:24576
    v_mfma_f32_16x16x32_bf16 v[200:203], a[12:15], a[176:179], v[200:203]
    s_add_u32 s35, s35, 0x4000
    ds_read_b64_tr_b16 a[54:55], v48 offset:25600
    s_mov_b32 m0, s34
    v_mfma_f32_16x16x32_bf16 v[200:203], a[8:11], a[160:163], v[200:203]
    buffer_load_dwordx4 v1, s[16:19], s32 offen offset:0 sc1 lds
    v_mfma_f32_16x16x32_bf16 v[208:211], a[16:19], a[160:163], v[208:211]
    ds_read_b64_tr_b16 a[56:57], v49 offset:16384
    v_mfma_f32_16x16x32_bf16 v[208:211], a[20:23], a[176:179], v[208:211]
    buffer_load_dwordx4 v1, s[16:19], s32 offen offset:1024 sc1 lds
    ds_read_b64_tr_b16 a[58:59], v49 offset:17408
    v_mfma_f32_16x16x32_bf16 v[212:215], a[20:23], a[180:183], v[212:215]
    ds_read_b64_tr_b16 a[60:61], v49 offset:24576
    v_mfma_f32_16x16x32_bf16 v[212:215], a[16:19], a[164:167], v[212:215]
    v_mfma_f32_16x16x32_bf16 a[80:83], a[16:19], a[168:171], a[80:83]
    buffer_load_dwordx4 v1, s[16:19], s32 offen offset:2048 sc1 lds
    ds_read_b64_tr_b16 a[62:63], v49 offset:25600
    v_mfma_f32_16x16x32_bf16 a[80:83], a[20:23], a[184:187], a[80:83]
    v_mfma_f32_16x16x32_bf16 a[84:87], a[20:23], a[188:191], a[84:87]
    v_mfma_f32_16x16x32_bf16 a[84:87], a[16:19], a[172:175], a[84:87]
    v_mfma_f32_16x16x32_bf16 a[92:95], a[24:27], a[172:175], a[92:95]
    buffer_load_dwordx4 v1, s[16:19], s32 offen offset:3072 sc1 lds
    v_mfma_f32_16x16x32_bf16 a[92:95], a[28:31], a[188:191], a[92:95]
    v_mfma_f32_16x16x32_bf16 a[88:91], a[28:31], a[184:187], a[88:91]
    s_add_u32 s32, s32, 0x80000
    v_mfma_f32_16x16x32_bf16 a[88:91], a[24:27], a[168:171], a[88:91]
    s_add_u32 s34, s34, 0x4000
    v_mfma_f32_16x16x32_bf16 v[220:223], a[24:27], a[164:167], v[220:223]
    v_mfma_f32_16x16x32_bf16 v[220:223], a[28:31], a[180:183], v[220:223]
    v_mfma_f32_16x16x32_bf16 v[216:219], a[28:31], a[176:179], v[216:219]
    v_mfma_f32_16x16x32_bf16 v[216:219], a[24:27], a[160:163], v[216:219]
    s_waitcnt vmcnt(63) lgkmcnt(0)
    s_barrier
    v_mfma_f32_16x16x32_bf16 v[224:227], a[32:35], a[160:163], v[224:227]
    v_mfma_f32_16x16x32_bf16 v[224:227], a[36:39], a[176:179], v[224:227]
    s_mov_b32 m0, s35
    v_mfma_f32_16x16x32_bf16 v[228:231], a[36:39], a[180:183], v[228:231]
    buffer_load_dwordx4 v1, s[20:23], s33 offen offset:0 sc1 lds
    v_mfma_f32_16x16x32_bf16 v[228:231], a[32:35], a[164:167], v[228:231]
    v_mfma_f32_16x16x32_bf16 a[96:99], a[32:35], a[168:171], a[96:99]
    v_mfma_f32_16x16x32_bf16 a[96:99], a[36:39], a[184:187], a[96:99]
    v_mfma_f32_16x16x32_bf16 a[100:103], a[36:39], a[188:191], a[100:103]
    v_mfma_f32_16x16x32_bf16 a[100:103], a[32:35], a[172:175], a[100:103]
    buffer_load_dwordx4 v1, s[20:23], s33 offen offset:1024 sc1 lds
    v_mfma_f32_16x16x32_bf16 a[108:111], a[40:43], a[172:175], a[108:111]
    v_mfma_f32_16x16x32_bf16 a[108:111], a[44:47], a[188:191], a[108:111]
    v_mfma_f32_16x16x32_bf16 a[104:107], a[44:47], a[184:187], a[104:107]
    v_mfma_f32_16x16x32_bf16 a[104:107], a[40:43], a[168:171], a[104:107]
    v_mfma_f32_16x16x32_bf16 v[236:239], a[40:43], a[164:167], v[236:239]
    v_mfma_f32_16x16x32_bf16 v[236:239], a[44:47], a[180:183], v[236:239]
    v_mfma_f32_16x16x32_bf16 v[232:235], a[44:47], a[176:179], v[232:235]
    buffer_load_dwordx4 v1, s[20:23], s33 offen offset:2048 sc1 lds
    v_mfma_f32_16x16x32_bf16 v[232:235], a[40:43], a[160:163], v[232:235]
    v_mfma_f32_16x16x32_bf16 v[240:243], a[48:51], a[160:163], v[240:243]
    v_mfma_f32_16x16x32_bf16 v[240:243], a[52:55], a[176:179], v[240:243]
    v_mfma_f32_16x16x32_bf16 v[244:247], a[52:55], a[180:183], v[244:247]
    v_mfma_f32_16x16x32_bf16 v[244:247], a[48:51], a[164:167], v[244:247]
    v_mfma_f32_16x16x32_bf16 a[112:115], a[48:51], a[168:171], a[112:115]
    buffer_load_dwordx4 v1, s[20:23], s33 offen offset:3072 sc1 lds
    v_mfma_f32_16x16x32_bf16 a[112:115], a[52:55], a[184:187], a[112:115]
    v_mfma_f32_16x16x32_bf16 a[116:119], a[52:55], a[188:191], a[116:119]
    v_mfma_f32_16x16x32_bf16 a[116:119], a[48:51], a[172:175], a[116:119]
    v_mfma_f32_16x16x32_bf16 a[124:127], a[56:59], a[172:175], a[124:127]
    v_mfma_f32_16x16x32_bf16 a[124:127], a[60:63], a[188:191], a[124:127]
    v_mfma_f32_16x16x32_bf16 a[120:123], a[60:63], a[184:187], a[120:123]
    s_add_u32 s33, s33, 0x80000
    v_mfma_f32_16x16x32_bf16 a[120:123], a[56:59], a[168:171], a[120:123]
    s_add_u32 s35, s35, 0x4000
    v_mfma_f32_16x16x32_bf16 v[252:255], a[56:59], a[164:167], v[252:255]
    v_mfma_f32_16x16x32_bf16 v[252:255], a[60:63], a[180:183], v[252:255]
    v_mfma_f32_16x16x32_bf16 v[248:251], a[60:63], a[176:179], v[248:251]
    v_mfma_f32_16x16x32_bf16 v[248:251], a[56:59], a[160:163], v[248:251]
    s_add_u32 s3, s54, 64
    s_add_u32 s5, s55, 64
    s_mov_b32 s63, s57
    s_load_dwordx2 s[44:45], s[0:1], 40
    s_load_dwordx2 s[46:47], s[0:1], 64
    s_load_dwordx4 s[48:51], s[0:1], 72
    s_mov_b32 s40, 0x3e0293ee
    s_mov_b32 s41, 0x3e0293ee
    s_mov_b32 m0, s34
    s_nop 0
    buffer_load_dwordx4 v1, s[16:19], s32 offen offset:0 sc1 lds
    buffer_load_dwordx4 v1, s[16:19], s32 offen offset:1024 sc1 lds
    buffer_load_dwordx4 v1, s[16:19], s32 offen offset:2048 sc1 lds
    buffer_load_dwordx4 v1, s[16:19], s32 offen offset:3072 sc1 lds
    s_mov_b32 m0, s35
    s_nop 0
    buffer_load_dwordx4 v1, s[20:23], s33 offen offset:0 sc1 lds
    buffer_load_dwordx4 v1, s[20:23], s33 offen offset:1024 sc1 lds
    buffer_load_dwordx4 v1, s[20:23], s33 offen offset:2048 sc1 lds
    buffer_load_dwordx4 v1, s[20:23], s33 offen offset:3072 sc1 lds
    s_add_u32 s32, s32, 0x80000
    s_add_u32 s33, s33, 0x80000
    s_add_u32 s34, s34, 0x4000
    s_and_b32 s34, s34, 0xffff
    s_add_u32 s35, s35, 0x4000
    s_and_b32 s35, s35, 0xffff
    s_or_b32 s35, s35, 0x10000
    v_mov_b32 v2, v1
    v_or_b32 v3, 0x10000, v1
    v_mov_b32 v56, v3
    s_mov_b32 s52, 0x4000
    s_mov_b32 s53, 0
    s_lshl_b32 s62, s28, 6
    s_mul_i32 s31, s29, s29
    s_add_u32 s62, s62, s31
    s_lshr_b32 s31, s30, 1
    s_lshl_b32 s4, s31, 23
    s_add_u32 s4, s4, 0x6000000
    s_add_u32 s8, s6, s4
    s_addc_u32 s9, s7, 0
    s_and_b32 s9, s9, 0xffff
    s_mov_b32 s10, 0
    s_mov_b32 s58, 0
    s_mov_b32 s14, 0x700000
    s_mov_b32 s59, 0x700000
    s_lshl_b32 s54, s62, 12
    s_waitcnt vmcnt(16) lgkmcnt(0)
    s_barrier
    s_cmp_eq_u32 s63, 0
    s_cbranch_scc1 k12_ool_74
k12_oolret_75:
    v_mov_b32 v59, 0
    ds_read_b128 a[128:131], v2 offset:0
    ds_read_b128 a[132:135], v2 offset:1024
    ds_read_b128 a[136:139], v2 offset:2048
    ds_read_b128 a[140:143], v2 offset:3072
    ds_read_b128 a[144:147], v2 offset:4096
    ds_read_b128 a[148:151], v2 offset:5120
    ds_read_b128 a[152:155], v2 offset:6144
    ds_read_b128 a[156:159], v2 offset:7168
    ds_read_b128 a[160:163], v2 offset:8192
    ds_read_b128 a[164:167], v2 offset:9216
    ds_read_b128 a[168:171], v2 offset:10240
    ds_read_b128 a[172:175], v2 offset:11264
    ds_read_b128 a[176:179], v2 offset:12288
    ds_read_b128 a[180:183], v2 offset:13312
    ds_read_b128 a[184:187], v2 offset:14336
    ds_read_b128 a[188:191], v2 offset:15360
    s_cmp_lt_u32 s30, 2
    s_cselect_b64 s[12:13], s[46:47], s[48:49]
    s_cselect_b64 s[60:61], s[44:45], s[50:51]
    s_cselect_b32 s55, 0x800000, s14
    s_and_b32 s13, s13, 0xffff
    v_accvgpr_read_b32 v128, a64
    v_accvgpr_read_b32 v129, a65
    v_accvgpr_read_b32 v130, a66
    v_accvgpr_read_b32 v131, a67
    v_pk_mul_f32 v[128:129], v[128:129], s[40:41]
    v_pk_mul_f32 v[130:131], v[130:131], s[40:41]
    v_cvt_pk_bf16_f32 v96, v128, v129
    v_cvt_pk_bf16_f32 v97, v130, v131
    v_accvgpr_read_b32 v132, a72
    v_accvgpr_read_b32 v133, a73
    v_accvgpr_read_b32 v134, a74
    v_accvgpr_read_b32 v135, a75
    v_pk_mul_f32 v[132:133], v[132:133], s[40:41]
    v_pk_mul_f32 v[134:135], v[134:135], s[40:41]
    v_cvt_pk_bf16_f32 v98, v132, v133
    v_cvt_pk_bf16_f32 v99, v134, v135
    v_accvgpr_read_b32 v136, a80
    v_accvgpr_read_b32 v137, a81
    v_accvgpr_read_b32 v138, a82
    v_accvgpr_read_b32 v139, a83
    v_pk_mul_f32 v[136:137], v[136:137], s[40:41]
    v_pk_mul_f32 v[138:139], v[138:139], s[40:41]
    v_cvt_pk_bf16_f32 v100, v136, v137
    v_cvt_pk_bf16_f32 v101, v138, v139
    v_accvgpr_read_b32 v140, a88
    v_accvgpr_read_b32 v141, a89
    v_accvgpr_read_b32 v142, a90
    v_accvgpr_read_b32 v143, a91
    v_pk_mul_f32 v[140:141], v[140:141], s[40:41]
    v_pk_mul_f32 v[142:143], v[142:143], s[40:41]
    v_cvt_pk_bf16_f32 v102, v140, v141
    v_cvt_pk_bf16_f32 v103, v142, v143
    v_accvgpr_read_b32 v128, a96
    v_accvgpr_read_b32 v129, a97
    v_accvgpr_read_b32 v130, a98
    v_accvgpr_read_b32 v131, a99
    v_pk_mul_f32 v[128:129], v[128:129], s[40:41]
    v_pk_mul_f32 v[130:131], v[130:131], s[40:41]
    v_cvt_pk_bf16_f32 v104, v128, v129
    v_cvt_pk_bf16_f32 v105, v130, v131
    v_accvgpr_read_b32 v132, a104
    v_accvgpr_read_b32 v133, a105
    v_accvgpr_read_b32 v134, a106
    v_accvgpr_read_b32 v135, a107
    v_pk_mul_f32 v[132:133], v[132:133], s[40:41]
    v_pk_mul_f32 v[134:135], v[134:135], s[40:41]
    v_cvt_pk_bf16_f32 v106, v132, v133
    v_cvt_pk_bf16_f32 v107, v134, v135
    v_accvgpr_read_b32 v136, a112
    v_accvgpr_read_b32 v137, a113
    v_accvgpr_read_b32 v138, a114
    v_accvgpr_read_b32 v139, a115
    v_pk_mul_f32 v[136:137], v[136:137], s[40:41]
    v_pk_mul_f32 v[138:139], v[138:139], s[40:41]
    v_cvt_pk_bf16_f32 v108, v136, v137
    v_cvt_pk_bf16_f32 v109, v138, v139
    v_accvgpr_read_b32 v140, a120
    v_accvgpr_read_b32 v141, a121
    v_accvgpr_read_b32 v142, a122
    v_accvgpr_read_b32 v143, a123
    v_pk_mul_f32 v[140:141], v[140:141], s[40:41]
    v_pk_mul_f32 v[142:143], v[142:143], s[40:41]
    v_cvt_pk_bf16_f32 v110, v140, v141
    v_cvt_pk_bf16_f32 v111, v142, v143
    v_accvgpr_read_b32 v128, a68
    v_accvgpr_read_b32 v129, a69
    v_accvgpr_read_b32 v130, a70
    v_accvgpr_read_b32 v131, a71
    v_pk_mul_f32 v[128:129], v[128:129], s[40:41]
    v_pk_mul_f32 v[130:131], v[130:131], s[40:41]
    v_cvt_pk_bf16_f32 v112, v128, v129
    v_cvt_pk_bf16_f32 v113, v130, v131
    v_accvgpr_read_b32 v132, a76
    v_accvgpr_read_b32 v133, a77
    v_accvgpr_read_b32 v134, a78
    v_accvgpr_read_b32 v135, a79
    v_pk_mul_f32 v[132:133], v[132:133], s[40:41]
    v_pk_mul_f32 v[134:135], v[134:135], s[40:41]
    v_cvt_pk_bf16_f32 v114, v132, v133
    v_cvt_pk_bf16_f32 v115, v134, v135
    v_accvgpr_read_b32 v136, a84
    v_accvgpr_read_b32 v137, a85
    v_accvgpr_read_b32 v138, a86
    v_accvgpr_read_b32 v139, a87
    v_pk_mul_f32 v[136:137], v[136:137], s[40:41]
    v_pk_mul_f32 v[138:139], v[138:139], s[40:41]
    v_cvt_pk_bf16_f32 v116, v136, v137
    v_cvt_pk_bf16_f32 v117, v138, v139
    v_accvgpr_read_b32 v140, a92
    v_accvgpr_read_b32 v141, a93
    v_accvgpr_read_b32 v142, a94
    v_accvgpr_read_b32 v143, a95
    v_pk_mul_f32 v[140:141], v[140:141], s[40:41]
    v_pk_mul_f32 v[142:143], v[142:143], s[40:41]
    v_cvt_pk_bf16_f32 v118, v140, v141
    v_cvt_pk_bf16_f32 v119, v142, v143
    v_accvgpr_read_b32 v128, a100
    v_accvgpr_read_b32 v129, a101
    v_accvgpr_read_b32 v130, a102
    v_accvgpr_read_b32 v131, a103
    v_pk_mul_f32 v[128:129], v[128:129], s[40:41]
    v_pk_mul_f32 v[130:131], v[130:131], s[40:41]
    v_cvt_pk_bf16_f32 v120, v128, v129
    v_cvt_pk_bf16_f32 v121, v130, v131
    v_accvgpr_read_b32 v132, a108
    v_accvgpr_read_b32 v133, a109
    v_accvgpr_read_b32 v134, a110
    v_accvgpr_read_b32 v135, a111
    v_pk_mul_f32 v[132:133], v[132:133], s[40:41]
    v_pk_mul_f32 v[134:135], v[134:135], s[40:41]
    v_cvt_pk_bf16_f32 v122, v132, v133
    v_cvt_pk_bf16_f32 v123, v134, v135
    v_accvgpr_read_b32 v136, a116
    v_accvgpr_read_b32 v137, a117
    v_accvgpr_read_b32 v138, a118
    v_accvgpr_read_b32 v139, a119
    v_pk_mul_f32 v[136:137], v[136:137], s[40:41]
    v_pk_mul_f32 v[138:139], v[138:139], s[40:41]
    v_cvt_pk_bf16_f32 v124, v136, v137
    v_cvt_pk_bf16_f32 v125, v138, v139
    v_accvgpr_read_b32 v140, a124
    v_accvgpr_read_b32 v141, a125
    v_accvgpr_read_b32 v142, a126
    v_accvgpr_read_b32 v143, a127
    v_pk_mul_f32 v[140:141], v[140:141], s[40:41]
    v_pk_mul_f32 v[142:143], v[142:143], s[40:41]
    v_cvt_pk_bf16_f32 v126, v140, v141
    v_cvt_pk_bf16_f32 v127, v142, v143
    v_pk_mul_f32 v[192:193], v[192:193], s[40:41]
    v_pk_mul_f32 v[194:195], v[194:195], s[40:41]
    v_cvt_pk_bf16_f32 v64, v192, v193
    v_cvt_pk_bf16_f32 v65, v194, v195
    v_pk_mul_f32 v[200:201], v[200:201], s[40:41]
    v_pk_mul_f32 v[202:203], v[202:203], s[40:41]
    v_cvt_pk_bf16_f32 v66, v200, v201
    v_cvt_pk_bf16_f32 v67, v202, v203
    v_pk_mul_f32 v[208:209], v[208:209], s[40:41]
    v_pk_mul_f32 v[210:211], v[210:211], s[40:41]
    v_cvt_pk_bf16_f32 v68, v208, v209
    v_cvt_pk_bf16_f32 v69, v210, v211
    v_pk_mul_f32 v[216:217], v[216:217], s[40:41]
    v_pk_mul_f32 v[218:219], v[218:219], s[40:41]
    v_cvt_pk_bf16_f32 v70, v216, v217
    v_cvt_pk_bf16_f32 v71, v218, v219
    v_pk_mul_f32 v[224:225], v[224:225], s[40:41]
    v_pk_mul_f32 v[226:227], v[226:227], s[40:41]
    v_cvt_pk_bf16_f32 v72, v224, v225
    v_cvt_pk_bf16_f32 v73, v226, v227
    v_pk_mul_f32 v[232:233], v[232:233], s[40:41]
    v_pk_mul_f32 v[234:235], v[234:235], s[40:41]
    v_cvt_pk_bf16_f32 v74, v232, v233
    v_cvt_pk_bf16_f32 v75, v234, v235
    v_pk_mul_f32 v[240:241], v[240:241], s[40:41]
    v_pk_mul_f32 v[242:243], v[242:243], s[40:41]
    v_cvt_pk_bf16_f32 v76, v240, v241
    v_cvt_pk_bf16_f32 v77, v242, v243
    v_pk_mul_f32 v[248:249], v[248:249], s[40:41]
    v_pk_mul_f32 v[250:251], v[250:251], s[40:41]
    v_cvt_pk_bf16_f32 v78, v248, v249
    v_cvt_pk_bf16_f32 v79, v250, v251
    v_pk_mul_f32 v[196:197], v[196:197], s[40:41]
    v_pk_mul_f32 v[198:199], v[198:199], s[40:41]
    v_cvt_pk_bf16_f32 v80, v196, v197
    v_cvt_pk_bf16_f32 v81, v198, v199
    v_pk_mul_f32 v[204:205], v[204:205], s[40:41]
    v_pk_mul_f32 v[206:207], v[206:207], s[40:41]
    v_cvt_pk_bf16_f32 v82, v204, v205
    v_cvt_pk_bf16_f32 v83, v206, v207
    v_pk_mul_f32 v[212:213], v[212:213], s[40:41]
    v_pk_mul_f32 v[214:215], v[214:215], s[40:41]
    v_cvt_pk_bf16_f32 v84, v212, v213
    v_cvt_pk_bf16_f32 v85, v214, v215
    v_pk_mul_f32 v[220:221], v[220:221], s[40:41]
    v_pk_mul_f32 v[222:223], v[222:223], s[40:41]
    v_cvt_pk_bf16_f32 v86, v220, v221
    v_cvt_pk_bf16_f32 v87, v222, v223
    v_pk_mul_f32 v[228:229], v[228:229], s[40:41]
    v_pk_mul_f32 v[230:231], v[230:231], s[40:41]
    v_cvt_pk_bf16_f32 v88, v228, v229
    v_cvt_pk_bf16_f32 v89, v230, v231
    v_pk_mul_f32 v[236:237], v[236:237], s[40:41]
    v_pk_mul_f32 v[238:239], v[238:239], s[40:41]
    v_cvt_pk_bf16_f32 v90, v236, v237
    v_cvt_pk_bf16_f32 v91, v238, v239
    v_pk_mul_f32 v[244:245], v[244:245], s[40:41]
    v_pk_mul_f32 v[246:247], v[246:247], s[40:41]
    v_cvt_pk_bf16_f32 v92, v244, v245
    v_cvt_pk_bf16_f32 v93, v246, v247
    v_pk_mul_f32 v[252:253], v[252:253], s[40:41]
    v_pk_mul_f32 v[254:255], v[254:255], s[40:41]
    v_cvt_pk_bf16_f32 v94, v252, v253
    v_cvt_pk_bf16_f32 v95, v254, v255
    v_add_u32 v2, 0x4000, v1
    v_mov_b32 v8, 0
    v_mov_b32 v232, 0
    v_mov_b32 v9, 0
    v_mov_b32 v233, 0
    v_mov_b32 v10, 0
    v_mov_b32 v234, 0
    v_mov_b32 v11, 0
    v_mov_b32 v235, 0
    s_mov_b32 s36, 0
    s_mov_b32 s37, 0x40004000
    v_mfma_f32_32x32x16_bf16 v[16:31], v[232:235], v[232:235], 0
    v_mfma_f32_32x32x16_bf16 v[32:47], v[232:235], v[232:235], 0
    v_and_b32 v6, 0xf0, v1
    v_cmp_eq_u32 vcc, 0, v6
    v_mov_b32 v6, 0x3f803f80
    v_lshrrev_b32 v229, 7, v1
    s_and_b32 s4, s30, 1
    s_lshl_b32 s31, s4, 11
    v_lshl_add_u32 v230, v1, 1, s31
    v_lshl_add_u32 v229, s4, 4, v229
    v_mul_u32_u24 v228, 7168, v229
    v_and_b32 v7, 0x70, v1
    v_add_u32 v228, v228, v7
    v_lshlrev_b32 v229, 5, v229
    v_and_b32 v57, 0x10, v1
    v_add_u32 v229, v229, v57
    v_lshrrev_b32 v7, 5, v7
    v_lshl_add_u32 v229, v7, 15, v229
    v_cndmask_b32 v60, 0, v6, vcc
    v_cndmask_b32 v61, 0, v6, vcc
    v_cndmask_b32 v62, 0, v6, vcc
    v_cndmask_b32 v63, 0, v6, vcc
    v_mov_b32 v12, 0
    v_mov_b32 v13, 0
    v_mov_b32 v14, 0
    v_mov_b32 v15, 0
    v_mov_b32 v48, 0
    v_mov_b32 v49, 0
    v_mov_b32 v50, 0
    v_mov_b32 v51, 0
    v_mov_b32 v248, 0
    v_mov_b32 v249, 0
    v_mov_b32 v250, 0
    v_mov_b32 v251, 0
    v_mov_b32 v252, 0
    v_mov_b32 v253, 0
    v_mov_b32 v254, 0
    v_mov_b32 v255, 0
    s_waitcnt lgkmcnt(0)
    s_cmp_ge_u32 s36, s42
    s_cbranch_scc1 k2_prep_76
k2_prepret_77:
    v_mfma_f32_16x16x32_bf16 v[128:131], a[128:131], v[64:67], v[16:19]
    v_mfma_f32_16x16x32_bf16 v[128:131], a[132:135], v[68:71], v[128:131]
    v_mfma_f32_16x16x32_bf16 v[128:131], a[136:139], v[72:75], v[128:131]
    v_mfma_f32_16x16x32_bf16 v[128:131], a[140:143], v[76:79], v[128:131]
    s_add_u32 s36, s36, 32
    v_mfma_f32_16x16x32_bf16 v[132:135], a[140:143], v[92:95], v[20:23]
    v_mfma_f32_16x16x32_bf16 v[132:135], a[136:139], v[88:91], v[132:135]
    v_mfma_f32_16x16x32_bf16 v[132:135], a[132:135], v[84:87], v[132:135]
    v_mfma_f32_16x16x32_bf16 v[132:135], a[128:131], v[80:83], v[132:135]
    v_mfma_f32_16x16x32_bf16 v[136:139], a[128:131], v[96:99], v[24:27]
    v_mfma_f32_16x16x32_bf16 v[136:139], a[132:135], v[100:103], v[136:139]
    v_mfma_f32_16x16x32_bf16 v[136:139], a[136:139], v[104:107], v[136:139]
    v_mfma_f32_16x16x32_bf16 v[136:139], a[140:143], v[108:111], v[136:139]
    v_mfma_f32_16x16x32_bf16 v[140:143], a[140:143], v[124:127], v[28:31]
    v_mfma_f32_16x16x32_bf16 v[140:143], a[136:139], v[120:123], v[140:143]
    v_mfma_f32_16x16x32_bf16 v[140:143], a[132:135], v[116:119], v[140:143]
    v_mfma_f32_16x16x32_bf16 v[140:143], a[128:131], v[112:115], v[140:143]
    v_mfma_f32_16x16x32_bf16 v[156:159], a[144:147], v[112:115], v[44:47]
    v_mfma_f32_16x16x32_bf16 v[156:159], a[148:151], v[116:119], v[156:159]
    v_mfma_f32_16x16x32_bf16 v[156:159], a[152:155], v[120:123], v[156:159]
    v_mfma_f32_16x16x32_bf16 v[156:159], a[156:159], v[124:127], v[156:159]
    v_mfma_f32_16x16x32_bf16 v[152:155], a[156:159], v[108:111], v[40:43]
    v_mfma_f32_16x16x32_bf16 v[152:155], a[152:155], v[104:107], v[152:155]
    v_mfma_f32_16x16x32_bf16 v[152:155], a[148:151], v[100:103], v[152:155]
    v_mfma_f32_16x16x32_bf16 v[152:155], a[144:147], v[96:99], v[152:155]
    v_mfma_f32_16x16x32_bf16 v[148:151], a[144:147], v[80:83], v[36:39]
    v_mfma_f32_16x16x32_bf16 v[148:151], a[148:151], v[84:87], v[148:151]
    v_mfma_f32_16x16x32_bf16 v[148:151], a[152:155], v[88:91], v[148:151]
    v_mfma_f32_16x16x32_bf16 v[148:151], a[156:159], v[92:95], v[148:151]
    v_mfma_f32_16x16x32_bf16 v[144:147], a[156:159], v[76:79], v[32:35]
    v_mfma_f32_16x16x32_bf16 v[144:147], a[152:155], v[72:75], v[144:147]
    v_mfma_f32_16x16x32_bf16 v[144:147], a[148:151], v[68:71], v[144:147]
    v_mfma_f32_16x16x32_bf16 v[144:147], a[144:147], v[64:67], v[144:147]
    v_mfma_f32_32x32x16_bf16 a[0:15], v[232:235], v[232:235], 0
    v_mfma_f32_32x32x16_bf16 a[16:31], v[232:235], v[232:235], 0
    v_mfma_f32_32x32x16_bf16 a[32:47], v[232:235], v[232:235], 0
    v_mfma_f32_32x32x16_bf16 a[48:63], v[232:235], v[232:235], 0
    v_mfma_f32_32x32x16_bf16 a[64:79], v[232:235], v[232:235], 0
    v_mfma_f32_32x32x16_bf16 a[80:95], v[232:235], v[232:235], 0
    v_mfma_f32_32x32x16_bf16 a[96:111], v[232:235], v[232:235], 0
    v_mfma_f32_32x32x16_bf16 a[112:127], v[232:235], v[232:235], 0
    v_max_f32 v52, v128, v129
    v_max3_f32 v52, v52, v130, v131
    v_max3_f32 v52, v52, v144, v145
    v_max3_f32 v52, v52, v146, v147
    v_max_f32 v53, v132, v133
    v_max3_f32 v53, v53, v134, v135
    v_max3_f32 v53, v53, v148, v149
    v_max3_f32 v53, v53, v150, v151
    v_max_f32 v54, v136, v137
    v_max3_f32 v54, v54, v138, v139
    v_max3_f32 v54, v54, v152, v153
    v_max3_f32 v54, v54, v154, v155
    v_max_f32 v55, v140, v141
    v_max3_f32 v55, v55, v142, v143
    v_max3_f32 v55, v55, v156, v157
    v_max3_f32 v55, v55, v158, v159
    v_mov_b32 v224, v52
    v_mov_b32 v225, v53
    v_mov_b32 v226, v54
    v_mov_b32 v227, v55
    s_nop 1
    v_permlane16_swap_b32 v52, v224
    v_permlane16_swap_b32 v53, v225
    v_permlane16_swap_b32 v54, v226
    v_permlane16_swap_b32 v55, v227
    s_nop 1
    v_max_f32 v52, v52, v224
    v_max_f32 v53, v53, v225
    v_max_f32 v54, v54, v226
    v_max_f32 v55, v55, v227
    v_mov_b32 v224, v52
    v_mov_b32 v225, v53
    v_mov_b32 v226, v54
    v_mov_b32 v227, v55
    s_nop 1
    v_permlane32_swap_b32 v52, v224
    v_permlane32_swap_b32 v53, v225
    v_permlane32_swap_b32 v54, v226
    v_permlane32_swap_b32 v55, v227
    s_nop 1
    v_max_f32 v52, v52, v224
    v_max_f32 v53, v53, v225
    v_max_f32 v54, v54, v226
    v_max_f32 v55, v55, v227
    v_add_f32 v52, 0x41400000, v52
    v_add_f32 v53, 0x41400000, v53
    v_add_f32 v54, 0x41400000, v54
    v_add_f32 v55, 0x41400000, v55
    v_sub_f32 v16, 0, v52
    v_sub_f32 v17, 0, v52
    v_sub_f32 v18, 0, v52
    v_sub_f32 v19, 0, v52
    v_sub_f32 v20, 0, v53
    v_sub_f32 v21, 0, v53
    v_sub_f32 v22, 0, v53
    v_sub_f32 v23, 0, v53
    v_sub_f32 v24, 0, v54
    v_sub_f32 v25, 0, v54
    v_sub_f32 v26, 0, v54
    v_sub_f32 v27, 0, v54
    v_sub_f32 v28, 0, v55
    v_sub_f32 v29, 0, v55
    v_sub_f32 v30, 0, v55
    v_sub_f32 v31, 0, v55
    v_sub_f32 v32, 0, v52
    v_sub_f32 v33, 0, v52
    v_sub_f32 v34, 0, v52
    v_sub_f32 v35, 0, v52
    v_sub_f32 v36, 0, v53
    v_sub_f32 v37, 0, v53
    v_sub_f32 v38, 0, v53
    v_sub_f32 v39, 0, v53
    v_sub_f32 v40, 0, v54
    v_sub_f32 v41, 0, v54
    v_sub_f32 v42, 0, v54
    v_sub_f32 v43, 0, v54
    v_sub_f32 v44, 0, v55
    v_sub_f32 v45, 0, v55
    v_sub_f32 v46, 0, v55
    v_sub_f32 v47, 0, v55
    v_sub_f32 v8, 0, v52
    v_sub_f32 v9, 0, v53
    v_sub_f32 v10, 0, v54
    v_sub_f32 v11, 0, v55
    s_cmp_ge_u32 s36, s42
    s_cbranch_scc1 k2_prep_84
k2_prepret_85:
    v_mfma_f32_16x16x32_bf16 v[160:163], a[160:163], v[64:67], v[16:19]
    v_sub_f32 v128, v128, v52
    v_sub_f32 v129, v129, v52
    v_sub_f32 v130, v130, v52
    v_mfma_f32_16x16x32_bf16 v[160:163], a[164:167], v[68:71], v[160:163]
    v_exp_f32 v232, v128
    v_sub_f32 v131, v131, v52
    v_mfma_f32_16x16x32_bf16 v[160:163], a[168:171], v[72:75], v[160:163]
    v_exp_f32 v233, v129
    v_sub_f32 v144, v144, v52
    v_mfma_f32_16x16x32_bf16 v[160:163], a[172:175], v[76:79], v[160:163]
    s_add_u32 s36, s36, 32
    s_cmp_eq_u32 s30, 0
    s_cbranch_scc1 k12_ool_78
k12_oolret_79:
    v_sub_f32 v145, v145, v52
    v_mfma_f32_16x16x32_bf16 v[164:167], a[172:175], v[92:95], v[20:23]
    v_exp_f32 v234, v130
    v_cvt_pk_bf16_f32 v192, v232, v233
    v_mfma_f32_16x16x32_bf16 v[164:167], a[168:171], v[88:91], v[164:167]
    v_exp_f32 v235, v131
    v_sub_f32 v146, v146, v52
    v_mfma_f32_16x16x32_bf16 v[164:167], a[164:167], v[84:87], v[164:167]
    v_exp_f32 v236, v144
    v_sub_f32 v147, v147, v52
    v_mfma_f32_16x16x32_bf16 v[164:167], a[160:163], v[80:83], v[164:167]
    v_cvt_pk_bf16_f32 v193, v234, v235
    v_exp_f32 v237, v145
    v_mfma_f32_16x16x32_bf16 v[168:171], a[160:163], v[96:99], v[24:27]
    v_exp_f32 v238, v146
    v_sub_f32 v132, v132, v53
    v_mfma_f32_16x16x32_bf16 v[168:171], a[164:167], v[100:103], v[168:171]
    v_sub_f32 v133, v133, v53
    v_cvt_pk_bf16_f32 v194, v236, v237
    v_or3_b32 v57, v192, v193, v194
    v_mfma_f32_16x16x32_bf16 v[168:171], a[168:171], v[104:107], v[168:171]
    v_exp_f32 v239, v147
    v_sub_f32 v134, v134, v53
    v_mfma_f32_16x16x32_bf16 v[168:171], a[172:175], v[108:111], v[168:171]
    v_exp_f32 v240, v132
    v_sub_f32 v135, v135, v53
    v_mfma_f32_16x16x32_bf16 v[172:175], a[172:175], v[124:127], v[28:31]
    v_cvt_pk_bf16_f32 v195, v238, v239
    v_exp_f32 v241, v133
    v_mfma_f32_16x16x32_bf16 v[172:175], a[168:171], v[120:123], v[172:175]
    v_exp_f32 v242, v134
    v_sub_f32 v148, v148, v53
    v_mfma_f32_16x16x32_bf16 v[172:175], a[164:167], v[116:119], v[172:175]
    v_sub_f32 v149, v149, v53
    v_cvt_pk_bf16_f32 v196, v240, v241
    v_exp_f32 v243, v135
    v_mfma_f32_16x16x32_bf16 v[172:175], a[160:163], v[112:115], v[172:175]
    v_or3_b32 v57, v57, v195, v196
    v_exp_f32 v244, v148
    v_mfma_f32_16x16x32_bf16 v[188:191], a[176:179], v[112:115], v[44:47]
    v_sub_f32 v150, v150, v53
    v_sub_f32 v151, v151, v53
    v_cvt_pk_bf16_f32 v197, v242, v243
    v_mfma_f32_16x16x32_bf16 v[188:191], a[180:183], v[116:119], v[188:191]
    v_exp_f32 v245, v149
    v_exp_f32 v246, v150
    v_mfma_f32_16x16x32_bf16 v[188:191], a[184:187], v[120:123], v[188:191]
    v_sub_f32 v136, v136, v54
    v_sub_f32 v137, v137, v54
    v_cvt_pk_bf16_f32 v198, v244, v245
    v_mfma_f32_16x16x32_bf16 v[188:191], a[188:191], v[124:127], v[188:191]
    v_exp_f32 v247, v151
    v_or3_b32 v57, v57, v197, v198
    v_mfma_f32_16x16x32_bf16 v[184:187], a[188:191], v[108:111], v[40:43]
    v_exp_f32 v232, v136
    v_sub_f32 v138, v138, v54
    v_mfma_f32_16x16x32_bf16 v[184:187], a[184:187], v[104:107], v[184:187]
    ds_read_b128 a[192:195], v3 offset:0
    v_sub_f32 v139, v139, v54
    v_cvt_pk_bf16_f32 v199, v246, v247
    v_mfma_f32_16x16x32_bf16 v[184:187], a[180:183], v[100:103], v[184:187]
    v_exp_f32 v233, v137
    v_exp_f32 v234, v138
    v_mfma_f32_16x16x32_bf16 v[184:187], a[176:179], v[96:99], v[184:187]
    v_sub_f32 v152, v152, v54
    v_sub_f32 v153, v153, v54
    v_cvt_pk_bf16_f32 v200, v232, v233
    v_mfma_f32_16x16x32_bf16 v[180:183], a[176:179], v[80:83], v[36:39]
    v_exp_f32 v235, v139
    v_or3_b32 v57, v57, v199, v200
    v_mfma_f32_16x16x32_bf16 v[180:183], a[180:183], v[84:87], v[180:183]
    v_exp_f32 v236, v152
    v_sub_f32 v154, v154, v54
    v_mfma_f32_16x16x32_bf16 v[180:183], a[184:187], v[88:91], v[180:183]
    v_sub_f32 v155, v155, v54
    v_cvt_pk_bf16_f32 v201, v234, v235
    v_exp_f32 v237, v153
    v_mfma_f32_16x16x32_bf16 v[180:183], a[188:191], v[92:95], v[180:183]
    ds_read_b128 a[196:199], v3 offset:1024
    v_exp_f32 v238, v154
    v_mfma_f32_16x16x32_bf16 v[176:179], a[188:191], v[76:79], v[32:35]
    v_sub_f32 v140, v140, v55
    v_sub_f32 v141, v141, v55
    v_cvt_pk_bf16_f32 v202, v236, v237
    v_mfma_f32_16x16x32_bf16 v[176:179], a[184:187], v[72:75], v[176:179]
    v_exp_f32 v239, v155
    v_or3_b32 v57, v57, v201, v202
    v_mfma_f32_16x16x32_bf16 v[176:179], a[180:183], v[68:71], v[176:179]
    s_cmp_eq_u32 s30, 0
    s_cbranch_scc1 k12_ool_82
k12_oolret_83:
    v_exp_f32 v240, v140
    v_mfma_f32_16x16x32_bf16 v[176:179], a[176:179], v[64:67], v[176:179]
    s_waitcnt vmcnt(8)
    s_barrier
    v_sub_f32 v142, v142, v55
    v_sub_f32 v143, v143, v55
    v_cvt_pk_bf16_f32 v203, v238, v239
    v_exp_f32 v241, v141
    v_exp_f32 v242, v142
    v_sub_f32 v156, v156, v55
    v_sub_f32 v157, v157, v55
    ds_read_b128 a[200:203], v3 offset:2048
    v_cvt_pk_bf16_f32 v204, v240, v241
    v_exp_f32 v243, v143
    v_or3_b32 v57, v57, v203, v204
    v_exp_f32 v244, v156
    v_sub_f32 v158, v158, v55
    v_sub_f32 v159, v159, v55
    v_cvt_pk_bf16_f32 v205, v242, v243
    v_exp_f32 v245, v157
    v_exp_f32 v246, v158
    v_cvt_pk_bf16_f32 v206, v244, v245
    ds_read_b128 a[204:207], v3 offset:3072
    v_exp_f32 v247, v159
    v_or3_b32 v57, v57, v205, v206
    v_cvt_pk_bf16_f32 v207, v246, v247
    v_bitop3_b32 v57, v57, v207, s37 bitop3:0xa8
    v_cmp_ne_u32 vcc, 0, v57
    s_cbranch_vccnz k2_tramp_86
k2_ret_87:
    s_mov_b32 s24, s60
    s_and_b32 s25, s61, 0xffff
    s_mov_b32 s26, s55
    s_lshl_b32 s63, s29, 1
    s_sub_u32 s63, s63, 1
    s_cbranch_scc1 k2_dm3_89
k2_dloop_88:
    v_mfma_f32_16x16x32_bf16 v[12:15], v[60:63], v[192:195], v[12:15]
    v_exp_f32 v232, v160
    v_mfma_f32_16x16x32_bf16 v[48:51], v[60:63], v[196:199], v[48:51]
    s_mov_b32 m0, s34
    ds_read_b128 a[208:211], v3 offset:4096
    v_mfma_f32_16x16x32_bf16 v[248:251], v[60:63], v[200:203], v[248:251]
    s_add_u32 s53, s53, 8192
    buffer_load_dwordx4 v1, s[16:19], s32 offen offset:0 sc1 lds
    v_mfma_f32_16x16x32_bf16 v[252:255], v[60:63], v[204:207], v[252:255]
    s_waitcnt lgkmcnt(3)
    v_exp_f32 v233, v161
    v_mfma_f32_16x16x32_bf16 a[12:15], a[192:195], v[204:207], a[12:15]
    s_and_b32 s53, s53, 0xffff
    v_exp_f32 v234, v162
    v_mfma_f32_16x16x32_bf16 a[8:11], a[192:195], v[200:203], a[8:11]
    s_add_u32 s34, s34, 0x4000
    ds_read_b128 a[212:215], v3 offset:5120
    v_cvt_pk_bf16_f32 v208, v232, v233
    v_mfma_f32_16x16x32_bf16 a[4:7], a[192:195], v[196:199], a[4:7]
    v_exp_f32 v235, v163
    v_mfma_f32_16x16x32_bf16 a[0:3], a[192:195], v[192:195], a[0:3]
    buffer_load_dwordx4 v1, s[16:19], s32 offen offset:1024 sc1 lds
    v_mfma_f32_16x16x32_bf16 a[16:19], a[196:199], v[192:195], a[16:19]
    v_exp_f32 v236, v176
    v_mfma_f32_16x16x32_bf16 a[20:23], a[196:199], v[196:199], a[20:23]
    ds_read_b128 a[216:219], v3 offset:6144
    v_cvt_pk_bf16_f32 v209, v234, v235
    v_mfma_f32_16x16x32_bf16 a[24:27], a[196:199], v[200:203], a[24:27]
    v_exp_f32 v237, v177
    v_mfma_f32_16x16x32_bf16 a[28:31], a[196:199], v[204:207], a[28:31]
    s_waitcnt lgkmcnt(3)
    v_exp_f32 v238, v178
    v_mfma_f32_16x16x32_bf16 a[44:47], a[200:203], v[204:207], a[44:47]
    s_and_b32 s34, s34, 0xffff
    ds_read_b128 a[220:223], v3 offset:7168
    v_cvt_pk_bf16_f32 v210, v236, v237
    v_mfma_f32_16x16x32_bf16 a[40:43], a[200:203], v[200:203], a[40:43]
    s_and_b32 s60, s62, 31
    buffer_load_dwordx4 v1, s[16:19], s32 offen offset:2048 sc1 lds
    v_mfma_f32_16x16x32_bf16 a[36:39], a[200:203], v[196:199], a[36:39]
    v_exp_f32 v239, v179
    v_mfma_f32_16x16x32_bf16 a[32:35], a[200:203], v[192:195], a[32:35]
    s_lshr_b32 s61, s62, 5
    v_or3_b32 v57, v208, v209, v210
    v_add_u32 v3, s53, v56
    v_mfma_f32_16x16x32_bf16 a[48:51], a[204:207], v[192:195], a[48:51]
    v_exp_f32 v240, v164
    v_mfma_f32_16x16x32_bf16 a[52:55], a[204:207], v[196:199], a[52:55]
    ds_read_b128 a[128:131], v2 offset:0
    v_cvt_pk_bf16_f32 v211, v238, v239
    v_mfma_f32_16x16x32_bf16 a[56:59], a[204:207], v[200:203], a[56:59]
    s_mul_i32 s57, s60, 229376
    v_exp_f32 v241, v165
    v_mfma_f32_16x16x32_bf16 a[60:63], a[204:207], v[204:207], a[60:63]
    s_waitcnt lgkmcnt(3)
    buffer_load_dwordx4 v1, s[16:19], s32 offen offset:3072 sc1 lds
    v_mfma_f32_16x16x32_bf16 a[76:79], a[208:211], v[204:207], a[76:79]
    s_add_u32 s32, s32, 0x80000
    v_exp_f32 v242, v166
    v_mfma_f32_16x16x32_bf16 a[72:75], a[208:211], v[200:203], a[72:75]
    s_lshl_b32 s4, s61, 7
    ds_read_b128 a[132:135], v2 offset:1024
    v_cvt_pk_bf16_f32 v212, v240, v241
    v_mfma_f32_16x16x32_bf16 a[68:71], a[208:211], v[196:199], a[68:71]
    v_exp_f32 v243, v167
    v_mfma_f32_16x16x32_bf16 a[64:67], a[208:211], v[192:195], a[64:67]
    s_add_u32 s57, s57, s4
    v_or3_b32 v57, v57, v211, v212
    v_cvt_pk_bf16_f32 v213, v242, v243
    v_mfma_f32_16x16x32_bf16 a[80:83], a[212:215], v[192:195], a[80:83]
    s_waitcnt vmcnt(9)
    v_exp_f32 v244, v180
    v_mfma_f32_16x16x32_bf16 a[84:87], a[212:215], v[196:199], a[84:87]
    buffer_store_dwordx4 a[224:227], v229, s[8:11], s58 offen offset:0 sc1
    ds_read_b128 a[136:139], v2 offset:2048
    v_mfma_f32_16x16x32_bf16 a[88:91], a[212:215], v[200:203], a[88:91]
    s_add_u32 s56, s57, 57344
    v_exp_f32 v245, v181
    v_mfma_f32_16x16x32_bf16 a[92:95], a[212:215], v[204:207], a[92:95]
    s_waitcnt lgkmcnt(3)
    v_exp_f32 v246, v182
    v_mfma_f32_16x16x32_bf16 a[108:111], a[216:219], v[204:207], a[108:111]
    ds_read_b128 a[140:143], v2 offset:3072
    v_cvt_pk_bf16_f32 v214, v244, v245
    v_mfma_f32_16x16x32_bf16 a[104:107], a[216:219], v[200:203], a[104:107]
    s_add_u32 s62, s62, 1
    v_exp_f32 v247, v183
    v_mfma_f32_16x16x32_bf16 a[100:103], a[216:219], v[196:199], a[100:103]
    v_or3_b32 v57, v57, v213, v214
    v_mfma_f32_16x16x32_bf16 a[96:99], a[216:219], v[192:195], a[96:99]
    v_exp_f32 v232, v168
    v_mfma_f32_16x16x32_bf16 a[112:115], a[220:223], v[192:195], a[112:115]
    ds_read_b128 a[144:147], v2 offset:4096
    v_cvt_pk_bf16_f32 v215, v246, v247
    v_mfma_f32_16x16x32_bf16 a[116:119], a[220:223], v[196:199], a[116:119]
    buffer_store_dwordx4 a[228:231], v229, s[8:11], s58 offen offset:256 sc1
    v_mfma_f32_16x16x32_bf16 a[120:123], a[220:223], v[200:203], a[120:123]
    v_exp_f32 v233, v169
    v_mfma_f32_16x16x32_bf16 a[124:127], a[220:223], v[204:207], a[124:127]
    s_waitcnt lgkmcnt(3)
    v_exp_f32 v234, v170
    v_mfma_f32_16x16x32_bf16 v[128:131], a[128:131], v[64:67], v[16:19]
    ds_read_b128 a[148:151], v2 offset:5120
    v_cvt_pk_bf16_f32 v216, v232, v233
    v_mfma_f32_16x16x32_bf16 v[128:131], a[132:135], v[68:71], v[128:131]
    s_waitcnt lgkmcnt(2)
    v_exp_f32 v235, v171
    v_mfma_f32_16x16x32_bf16 v[128:131], a[136:139], v[72:75], v[128:131]
    v_or3_b32 v57, v57, v215, v216
    v_mfma_f32_16x16x32_bf16 v[128:131], a[140:143], v[76:79], v[128:131]
    s_add_u32 s36, s36, 32
    v_exp_f32 v236, v184
    v_mfma_f32_16x16x32_bf16 v[132:135], a[140:143], v[92:95], v[20:23]
    ds_read_b128 a[152:155], v2 offset:6144
    v_cvt_pk_bf16_f32 v217, v234, v235
    v_mfma_f32_16x16x32_bf16 v[132:135], a[136:139], v[88:91], v[132:135]
    s_lshl_b32 s58, s61, 17
    buffer_load_dwordx4 a[224:227], v228, s[12:15], s57 offen nt
    v_mfma_f32_16x16x32_bf16 v[132:135], a[132:135], v[84:87], v[132:135]
    s_add_u32 s52, s52, 8192
    v_exp_f32 v237, v185
    v_mfma_f32_16x16x32_bf16 v[132:135], a[128:131], v[80:83], v[132:135]
    v_exp_f32 v238, v186
    v_mfma_f32_16x16x32_bf16 v[136:139], a[128:131], v[96:99], v[24:27]
    s_lshl_b32 s60, s60, 10
    ds_read_b128 a[156:159], v2 offset:7168
    v_cvt_pk_bf16_f32 v218, v236, v237
    v_mfma_f32_16x16x32_bf16 v[136:139], a[132:135], v[100:103], v[136:139]
    s_and_b32 s52, s52, 0xffff
    v_exp_f32 v239, v187
    v_mfma_f32_16x16x32_bf16 v[136:139], a[136:139], v[104:107], v[136:139]
    v_or3_b32 v57, v57, v217, v218
    v_mfma_f32_16x16x32_bf16 v[136:139], a[140:143], v[108:111], v[136:139]
    v_add_u32 v2, s52, v1
    v_cvt_pk_bf16_f32 v219, v238, v239
    v_mfma_f32_16x16x32_bf16 v[140:143], a[140:143], v[124:127], v[28:31]
    s_add_u32 s58, s58, s60
    v_exp_f32 v240, v172
    v_mfma_f32_16x16x32_bf16 v[140:143], a[136:139], v[120:123], v[140:143]
    buffer_load_dwordx4 a[228:231], v228, s[12:15], s56 offen nt
    v_mfma_f32_16x16x32_bf16 v[140:143], a[132:135], v[116:119], v[140:143]
    v_exp_f32 v241, v173
    v_mfma_f32_16x16x32_bf16 v[140:143], a[128:131], v[112:115], v[140:143]
    s_waitcnt lgkmcnt(2)
    ds_read_b128 a[192:195], v3 offset:0
    v_cvt_pk_bf16_f32 v220, v240, v241
    v_mfma_f32_16x16x32_bf16 v[156:159], a[144:147], v[112:115], v[44:47]
    s_mov_b32 s10, s59
    v_exp_f32 v242, v174
    v_mfma_f32_16x16x32_bf16 v[156:159], a[148:151], v[116:119], v[156:159]
    s_waitcnt lgkmcnt(1)
    v_exp_f32 v243, v175
    v_mfma_f32_16x16x32_bf16 v[156:159], a[152:155], v[120:123], v[156:159]
    ds_read_b128 a[196:199], v3 offset:1024
    v_or3_b32 v57, v57, v219, v220
    v_mfma_f32_16x16x32_bf16 v[156:159], a[156:159], v[124:127], v[156:159]
    v_exp_f32 v244, v188
    v_mfma_f32_16x16x32_bf16 v[152:155], a[156:159], v[108:111], v[40:43]
    v_cvt_pk_bf16_f32 v221, v242, v243
    v_mfma_f32_16x16x32_bf16 v[152:155], a[152:155], v[104:107], v[152:155]
    buffer_load_dword v7, v230, s[24:27], s54 offen
    v_mfma_f32_16x16x32_bf16 v[152:155], a[148:151], v[100:103], v[152:155]
    v_exp_f32 v245, v189
    v_mfma_f32_16x16x32_bf16 v[152:155], a[144:147], v[96:99], v[152:155]
    ds_read_b128 a[200:203], v3 offset:2048
    v_cvt_pk_bf16_f32 v222, v244, v245
    v_mfma_f32_16x16x32_bf16 v[148:151], a[144:147], v[80:83], v[36:39]
    v_exp_f32 v246, v190
    v_mfma_f32_16x16x32_bf16 v[148:151], a[148:151], v[84:87], v[148:151]
    v_exp_f32 v247, v191
    v_mfma_f32_16x16x32_bf16 v[148:151], a[152:155], v[88:91], v[148:151]
    ds_read_b128 a[204:207], v3 offset:3072
    v_or3_b32 v57, v57, v221, v222
    v_mfma_f32_16x16x32_bf16 v[148:151], a[156:159], v[92:95], v[148:151]
    v_cvt_pk_bf16_f32 v223, v246, v247
    v_mfma_f32_16x16x32_bf16 v[144:147], a[156:159], v[76:79], v[32:35]
    s_add_u32 s54, s54, 4096
    v_mfma_f32_16x16x32_bf16 v[144:147], a[152:155], v[72:75], v[144:147]
    v_bitop3_b32 v57, v57, v223, s37 bitop3:0xa8
    v_cmp_ne_u32 vcc, 0, v57
    v_mfma_f32_16x16x32_bf16 v[144:147], a[148:151], v[68:71], v[144:147]
    v_mfma_f32_16x16x32_bf16 v[144:147], a[144:147], v[64:67], v[144:147]
    s_cbranch_vccnz k2_tramp_90
k2_ret_91:
    v_mfma_f32_16x16x32_bf16 v[12:15], v[60:63], v[208:211], v[12:15]
    v_exp_f32 v232, v128
    v_mfma_f32_16x16x32_bf16 v[48:51], v[60:63], v[212:215], v[48:51]
    s_mov_b32 m0, s35
    ds_read_b128 a[208:211], v3 offset:4096
    v_mfma_f32_16x16x32_bf16 v[248:251], v[60:63], v[216:219], v[248:251]
    s_add_u32 s53, s53, 8192
    buffer_load_dwordx4 v1, s[20:23], s33 offen offset:0 sc1 lds
    v_mfma_f32_16x16x32_bf16 v[252:255], v[60:63], v[220:223], v[252:255]
    s_waitcnt lgkmcnt(3)
    v_exp_f32 v233, v129
    v_mfma_f32_16x16x32_bf16 a[12:15], a[192:195], v[220:223], a[12:15]
    s_and_b32 s53, s53, 0xffff
    v_exp_f32 v234, v130
    v_mfma_f32_16x16x32_bf16 a[8:11], a[192:195], v[216:219], a[8:11]
    ds_read_b128 a[212:215], v3 offset:5120
    v_cvt_pk_bf16_f32 v192, v232, v233
    v_mfma_f32_16x16x32_bf16 a[4:7], a[192:195], v[212:215], a[4:7]
    v_exp_f32 v235, v131
    v_mfma_f32_16x16x32_bf16 a[0:3], a[192:195], v[208:211], a[0:3]
    v_exp_f32 v236, v144
    v_mfma_f32_16x16x32_bf16 a[16:19], a[196:199], v[208:211], a[16:19]
    ds_read_b128 a[216:219], v3 offset:6144
    v_cvt_pk_bf16_f32 v193, v234, v235
    v_mfma_f32_16x16x32_bf16 a[20:23], a[196:199], v[212:215], a[20:23]
    v_exp_f32 v237, v145
    v_mfma_f32_16x16x32_bf16 a[24:27], a[196:199], v[216:219], a[24:27]
    v_mfma_f32_16x16x32_bf16 a[28:31], a[196:199], v[220:223], a[28:31]
    s_waitcnt lgkmcnt(3)
    v_exp_f32 v238, v146
    v_mfma_f32_16x16x32_bf16 a[44:47], a[200:203], v[220:223], a[44:47]
    ds_read_b128 a[220:223], v3 offset:7168
    v_cvt_pk_bf16_f32 v194, v236, v237
    v_mfma_f32_16x16x32_bf16 a[40:43], a[200:203], v[216:219], a[40:43]
    v_exp_f32 v239, v147
    v_mfma_f32_16x16x32_bf16 a[36:39], a[200:203], v[212:215], a[36:39]
    v_or3_b32 v57, v192, v193, v194
    v_mfma_f32_16x16x32_bf16 a[32:35], a[200:203], v[208:211], a[32:35]
    s_add_u32 s35, s35, 0x4000
    v_add_u32 v3, s53, v56
    v_cvt_pk_bf16_f32 v195, v238, v239
    v_mfma_f32_16x16x32_bf16 a[48:51], a[204:207], v[208:211], a[48:51]
    v_exp_f32 v240, v132
    v_mfma_f32_16x16x32_bf16 a[52:55], a[204:207], v[212:215], a[52:55]
    buffer_load_dwordx4 v1, s[20:23], s33 offen offset:1024 sc1 lds
    ds_read_b128 a[128:131], v2 offset:0
    v_mfma_f32_16x16x32_bf16 a[56:59], a[204:207], v[216:219], a[56:59]
    v_exp_f32 v241, v133
    v_mfma_f32_16x16x32_bf16 a[60:63], a[204:207], v[220:223], a[60:63]
    s_waitcnt lgkmcnt(3)
    v_exp_f32 v242, v134
    v_mfma_f32_16x16x32_bf16 a[76:79], a[208:211], v[220:223], a[76:79]
    ds_read_b128 a[132:135], v2 offset:1024
    v_cvt_pk_bf16_f32 v196, v240, v241
    v_mfma_f32_16x16x32_bf16 a[72:75], a[208:211], v[216:219], a[72:75]
    v_exp_f32 v243, v135
    v_mfma_f32_16x16x32_bf16 a[68:71], a[208:211], v[212:215], a[68:71]
    v_or3_b32 v57, v57, v195, v196
    v_mfma_f32_16x16x32_bf16 a[64:67], a[208:211], v[208:211], a[64:67]
    v_exp_f32 v244, v148
    v_mfma_f32_16x16x32_bf16 a[80:83], a[212:215], v[208:211], a[80:83]
    ds_read_b128 a[136:139], v2 offset:2048
    v_cvt_pk_bf16_f32 v197, v242, v243
    v_mfma_f32_16x16x32_bf16 a[84:87], a[212:215], v[212:215], a[84:87]
    v_exp_f32 v245, v149
    v_mfma_f32_16x16x32_bf16 a[88:91], a[212:215], v[216:219], a[88:91]
    v_mfma_f32_16x16x32_bf16 a[92:95], a[212:215], v[220:223], a[92:95]
    s_waitcnt lgkmcnt(3)
    v_exp_f32 v246, v150
    v_mfma_f32_16x16x32_bf16 a[108:111], a[216:219], v[220:223], a[108:111]
    ds_read_b128 a[140:143], v2 offset:3072
    v_cvt_pk_bf16_f32 v198, v244, v245
    v_mfma_f32_16x16x32_bf16 a[104:107], a[216:219], v[216:219], a[104:107]
    v_exp_f32 v247, v151
    v_mfma_f32_16x16x32_bf16 a[100:103], a[216:219], v[212:215], a[100:103]
    v_or3_b32 v57, v57, v197, v198
    v_mfma_f32_16x16x32_bf16 a[96:99], a[216:219], v[208:211], a[96:99]
    s_and_b32 s35, s35, 0xffff
    v_exp_f32 v232, v136
    v_mfma_f32_16x16x32_bf16 a[112:115], a[220:223], v[208:211], a[112:115]
    ds_read_b128 a[144:147], v2 offset:4096
    v_cvt_pk_bf16_f32 v199, v246, v247
    v_mfma_f32_16x16x32_bf16 a[116:119], a[220:223], v[212:215], a[116:119]
    buffer_load_dwordx4 v1, s[20:23], s33 offen offset:2048 sc1 lds
    v_mfma_f32_16x16x32_bf16 a[120:123], a[220:223], v[216:219], a[120:123]
    v_exp_f32 v233, v137
    v_mfma_f32_16x16x32_bf16 a[124:127], a[220:223], v[220:223], a[124:127]
    s_waitcnt lgkmcnt(3)
    v_exp_f32 v234, v138
    v_mfma_f32_16x16x32_bf16 v[160:163], a[128:131], v[64:67], v[16:19]
    ds_read_b128 a[148:151], v2 offset:5120
    v_cvt_pk_bf16_f32 v200, v232, v233
    v_mfma_f32_16x16x32_bf16 v[160:163], a[132:135], v[68:71], v[160:163]
    s_waitcnt lgkmcnt(2)
    v_exp_f32 v235, v139
    v_mfma_f32_16x16x32_bf16 v[160:163], a[136:139], v[72:75], v[160:163]
    v_or3_b32 v57, v57, v199, v200
    v_mfma_f32_16x16x32_bf16 v[160:163], a[140:143], v[76:79], v[160:163]
    s_or_b32 s35, s35, 0x10000
    v_exp_f32 v236, v152
    v_mfma_f32_16x16x32_bf16 v[164:167], a[140:143], v[92:95], v[20:23]
    s_add_u32 s36, s36, 32
    ds_read_b128 a[152:155], v2 offset:6144
    v_cvt_pk_bf16_f32 v201, v234, v235
    v_mfma_f32_16x16x32_bf16 v[164:167], a[136:139], v[88:91], v[164:167]
    v_exp_f32 v237, v153
    v_mfma_f32_16x16x32_bf16 v[164:167], a[132:135], v[84:87], v[164:167]
    s_add_u32 s52, s52, 8192
    v_mfma_f32_16x16x32_bf16 v[164:167], a[128:131], v[80:83], v[164:167]
    v_exp_f32 v238, v154
    v_mfma_f32_16x16x32_bf16 v[168:171], a[128:131], v[96:99], v[24:27]
    s_and_b32 s52, s52, 0xffff
    ds_read_b128 a[156:159], v2 offset:7168
    v_cvt_pk_bf16_f32 v202, v236, v237
    v_mfma_f32_16x16x32_bf16 v[168:171], a[132:135], v[100:103], v[168:171]
    v_exp_f32 v239, v155
    v_mfma_f32_16x16x32_bf16 v[168:171], a[136:139], v[104:107], v[168:171]
    v_or3_b32 v57, v57, v201, v202
    v_mfma_f32_16x16x32_bf16 v[168:171], a[140:143], v[108:111], v[168:171]
    v_add_u32 v2, s52, v1
    v_cvt_pk_bf16_f32 v203, v238, v239
    v_mfma_f32_16x16x32_bf16 v[172:175], a[140:143], v[124:127], v[28:31]
    v_exp_f32 v240, v140
    v_mfma_f32_16x16x32_bf16 v[172:175], a[136:139], v[120:123], v[172:175]
    buffer_load_dwordx4 v1, s[20:23], s33 offen offset:3072 sc1 lds
    v_mfma_f32_16x16x32_bf16 v[172:175], a[132:135], v[116:119], v[172:175]
    s_add_u32 s33, s33, 0x80000
    v_exp_f32 v241, v141
    v_mfma_f32_16x16x32_bf16 v[172:175], a[128:131], v[112:115], v[172:175]
    s_waitcnt lgkmcnt(2)
    ds_read_b128 a[192:195], v3 offset:0
    v_cvt_pk_bf16_f32 v204, v240, v241
    v_mfma_f32_16x16x32_bf16 v[188:191], a[144:147], v[112:115], v[44:47]
    v_exp_f32 v242, v142
    v_mfma_f32_16x16x32_bf16 v[188:191], a[148:151], v[116:119], v[188:191]
    s_waitcnt lgkmcnt(1)
    v_exp_f32 v243, v143
    v_mfma_f32_16x16x32_bf16 v[188:191], a[152:155], v[120:123], v[188:191]
    ds_read_b128 a[196:199], v3 offset:1024
    v_or3_b32 v57, v57, v203, v204
    v_mfma_f32_16x16x32_bf16 v[188:191], a[156:159], v[124:127], v[188:191]
    v_exp_f32 v244, v156
    v_mfma_f32_16x16x32_bf16 v[184:187], a[156:159], v[108:111], v[40:43]
    v_cvt_pk_bf16_f32 v205, v242, v243
    v_mfma_f32_16x16x32_bf16 v[184:187], a[152:155], v[104:107], v[184:187]
    v_exp_f32 v245, v157
    v_mfma_f32_16x16x32_bf16 v[184:187], a[148:151], v[100:103], v[184:187]
    ds_read_b128 a[200:203], v3 offset:2048
    v_mfma_f32_16x16x32_bf16 v[184:187], a[144:147], v[96:99], v[184:187]
    s_sub_u32 s63, s63, 1
    v_exp_f32 v246, v158
    v_mfma_f32_16x16x32_bf16 v[180:183], a[144:147], v[80:83], v[36:39]
    v_cvt_pk_bf16_f32 v206, v244, v245
    v_mfma_f32_16x16x32_bf16 v[180:183], a[148:151], v[84:87], v[180:183]
    v_exp_f32 v247, v159
    v_mfma_f32_16x16x32_bf16 v[180:183], a[152:155], v[88:91], v[180:183]
    ds_read_b128 a[204:207], v3 offset:3072
    v_or3_b32 v57, v57, v205, v206
    v_mfma_f32_16x16x32_bf16 v[180:183], a[156:159], v[92:95], v[180:183]
    v_cvt_pk_bf16_f32 v207, v246, v247
    v_mfma_f32_16x16x32_bf16 v[176:179], a[156:159], v[76:79], v[32:35]
    v_mfma_f32_16x16x32_bf16 v[176:179], a[152:155], v[72:75], v[176:179]
    v_bitop3_b32 v57, v57, v207, s37 bitop3:0xa8
    v_cmp_ne_u32 vcc, 0, v57
    v_mfma_f32_16x16x32_bf16 v[176:179], a[148:151], v[68:71], v[176:179]
    v_mfma_f32_16x16x32_bf16 v[176:179], a[144:147], v[64:67], v[176:179]
    s_waitcnt vmcnt(13)
    s_barrier
    s_cbranch_vccnz k2_tramp_92
k2_ret_93:
    s_cmp_lg_u32 s63, 0
    s_cbranch_scc1 k2_dloop_88
    v_mfma_f32_16x16x32_bf16 v[12:15], v[60:63], v[192:195], v[12:15]
    v_exp_f32 v232, v160
    v_mfma_f32_16x16x32_bf16 v[48:51], v[60:63], v[196:199], v[48:51]
    s_mov_b32 m0, s34
    ds_read_b128 a[208:211], v3 offset:4096
    v_mfma_f32_16x16x32_bf16 v[248:251], v[60:63], v[200:203], v[248:251]
    s_add_u32 s53, s53, 8192
    buffer_load_dwordx4 v1, s[16:19], s32 offen offset:0 sc1 lds
    v_mfma_f32_16x16x32_bf16 v[252:255], v[60:63], v[204:207], v[252:255]
    s_waitcnt lgkmcnt(3)
    v_exp_f32 v233, v161
    v_mfma_f32_16x16x32_bf16 a[12:15], a[192:195], v[204:207], a[12:15]
    s_sub_u32 s40, s36, s38
    v_exp_f32 v234, v162
    v_mfma_f32_16x16x32_bf16 a[8:11], a[192:195], v[200:203], a[8:11]
    s_and_b32 s53, s53, 0xffff
    ds_read_b128 a[212:215], v3 offset:5120
    v_cvt_pk_bf16_f32 v208, v232, v233
    v_mfma_f32_16x16x32_bf16 a[4:7], a[192:195], v[196:199], a[4:7]
    s_add_u32 s34, s34, 0x4000
    v_subrev_u32 v6, s40, v4
    v_cmp_gt_i32 s[44:45], 0, v6
    v_mfma_f32_16x16x32_bf16 a[0:3], a[192:195], v[192:195], a[0:3]
    v_exp_f32 v235, v163
    v_mfma_f32_16x16x32_bf16 a[16:19], a[196:199], v[192:195], a[16:19]
    buffer_load_dwordx4 v1, s[16:19], s32 offen offset:1024 sc1 lds
    ds_read_b128 a[216:219], v3 offset:6144
    v_mfma_f32_16x16x32_bf16 a[20:23], a[196:199], v[196:199], a[20:23]
    v_exp_f32 v236, v176
    v_mfma_f32_16x16x32_bf16 a[24:27], a[196:199], v[200:203], a[24:27]
    v_cmp_gt_i32 s[46:47], 1, v6
    v_cvt_pk_bf16_f32 v209, v234, v235
    v_mfma_f32_16x16x32_bf16 a[28:31], a[196:199], v[204:207], a[28:31]
    s_waitcnt lgkmcnt(3)
    v_cmp_gt_i32 s[48:49], 2, v6
    v_cmp_gt_i32 s[50:51], 3, v6
    v_mfma_f32_16x16x32_bf16 a[44:47], a[200:203], v[204:207], a[44:47]
    s_and_b32 s34, s34, 0xffff
    v_exp_f32 v237, v177
    v_mfma_f32_16x16x32_bf16 a[40:43], a[200:203], v[200:203], a[40:43]
    s_and_b32 s60, s62, 31
    v_exp_f32 v238, v178
    v_mfma_f32_16x16x32_bf16 a[36:39], a[200:203], v[196:199], a[36:39]
    ds_read_b128 a[220:223], v3 offset:7168
    v_cvt_pk_bf16_f32 v210, v236, v237
    v_mfma_f32_16x16x32_bf16 a[32:35], a[200:203], v[192:195], a[32:35]
    s_lshr_b32 s61, s62, 5
    buffer_load_dwordx4 v1, s[16:19], s32 offen offset:2048 sc1 lds
    v_mfma_f32_16x16x32_bf16 a[48:51], a[204:207], v[192:195], a[48:51]
    v_cndmask_b32 v16, v8, v5, s[44:45]
    v_or3_b32 v57, v208, v209, v210
    v_mfma_f32_16x16x32_bf16 a[52:55], a[204:207], v[196:199], a[52:55]
    v_exp_f32 v239, v179
    v_mfma_f32_16x16x32_bf16 a[56:59], a[204:207], v[200:203], a[56:59]
    s_mul_i32 s57, s60, 229376
    v_cndmask_b32 v17, v8, v5, s[46:47]
    v_add_u32 v3, s53, v56
    v_mfma_f32_16x16x32_bf16 a[60:63], a[204:207], v[204:207], a[60:63]
    s_waitcnt lgkmcnt(2)
    v_exp_f32 v240, v164
    v_mfma_f32_16x16x32_bf16 a[76:79], a[208:211], v[204:207], a[76:79]
    v_cvt_pk_bf16_f32 v211, v238, v239
    v_cndmask_b32 v18, v8, v5, s[48:49]
    v_mfma_f32_16x16x32_bf16 a[72:75], a[208:211], v[200:203], a[72:75]
    s_lshl_b32 s4, s61, 7
    ds_read_b128 a[128:131], v2 offset:0
    v_cndmask_b32 v19, v8, v5, s[50:51]
    v_mfma_f32_16x16x32_bf16 a[68:71], a[208:211], v[196:199], a[68:71]
    v_exp_f32 v241, v165
    v_mfma_f32_16x16x32_bf16 a[64:67], a[208:211], v[192:195], a[64:67]
    s_add_u32 s57, s57, s4
    buffer_load_dwordx4 v1, s[16:19], s32 offen offset:3072 sc1 lds
    s_add_u32 s32, s32, 0x80000
    v_mfma_f32_16x16x32_bf16 a[80:83], a[212:215], v[192:195], a[80:83]
    s_waitcnt vmcnt(9)
    v_cmp_gt_i32 s[44:45], 16, v6
    v_exp_f32 v242, v166
    v_mfma_f32_16x16x32_bf16 a[84:87], a[212:215], v[196:199], a[84:87]
    ds_read_b128 a[132:135], v2 offset:1024
    v_cvt_pk_bf16_f32 v212, v240, v241
    v_mfma_f32_16x16x32_bf16 a[88:91], a[212:215], v[200:203], a[88:91]
    s_add_u32 s56, s57, 57344
    v_cmp_gt_i32 s[46:47], 17, v6
    v_exp_f32 v243, v167
    v_mfma_f32_16x16x32_bf16 a[92:95], a[212:215], v[204:207], a[92:95]
    s_waitcnt lgkmcnt(2)
    v_or3_b32 v57, v57, v211, v212
    v_cmp_gt_i32 s[48:49], 18, v6
    v_mfma_f32_16x16x32_bf16 a[108:111], a[216:219], v[204:207], a[108:111]
    v_exp_f32 v244, v180
    v_mfma_f32_16x16x32_bf16 a[104:107], a[216:219], v[200:203], a[104:107]
    s_add_u32 s62, s62, 1
    v_cvt_pk_bf16_f32 v213, v242, v243
    v_cmp_gt_i32 s[50:51], 19, v6
    v_mfma_f32_16x16x32_bf16 a[100:103], a[216:219], v[196:199], a[100:103]
    buffer_store_dwordx4 a[224:227], v229, s[8:11], s58 offen offset:0 sc1
    ds_read_b128 a[136:139], v2 offset:2048
    v_mfma_f32_16x16x32_bf16 a[96:99], a[216:219], v[192:195], a[96:99]
    v_exp_f32 v245, v181
    v_mfma_f32_16x16x32_bf16 a[112:115], a[220:223], v[192:195], a[112:115]
    v_cndmask_b32 v32, v8, v5, s[44:45]
    v_exp_f32 v246, v182
    v_mfma_f32_16x16x32_bf16 a[116:119], a[220:223], v[196:199], a[116:119]
    ds_read_b128 a[140:143], v2 offset:3072
    v_cndmask_b32 v33, v8, v5, s[46:47]
    v_cvt_pk_bf16_f32 v214, v244, v245
    v_cndmask_b32 v34, v8, v5, s[48:49]
    v_cndmask_b32 v35, v8, v5, s[50:51]
    v_mfma_f32_16x16x32_bf16 a[120:123], a[220:223], v[200:203], a[120:123]
    v_exp_f32 v247, v183
    v_mfma_f32_16x16x32_bf16 a[124:127], a[220:223], v[204:207], a[124:127]
    s_waitcnt lgkmcnt(2)
    v_or3_b32 v57, v57, v213, v214
    v_cvt_pk_bf16_f32 v215, v246, v247
    v_mfma_f32_16x16x32_bf16 v[128:131], a[128:131], v[64:67], v[16:19]
    v_exp_f32 v232, v168
    v_mfma_f32_16x16x32_bf16 v[128:131], a[132:135], v[68:71], v[128:131]
    s_waitcnt lgkmcnt(0)
    buffer_store_dwordx4 a[228:231], v229, s[8:11], s58 offen offset:256 sc1
    ds_read_b128 a[144:147], v2 offset:4096
    v_mfma_f32_16x16x32_bf16 v[128:131], a[136:139], v[72:75], v[128:131]
    v_exp_f32 v233, v169
    v_mfma_f32_16x16x32_bf16 v[128:131], a[140:143], v[76:79], v[128:131]
    s_add_u32 s36, s36, 32
    v_exp_f32 v234, v170
    v_mfma_f32_16x16x32_bf16 v[132:135], a[140:143], v[92:95], v[20:23]
    ds_read_b128 a[148:151], v2 offset:5120
    v_cvt_pk_bf16_f32 v216, v232, v233
    v_mfma_f32_16x16x32_bf16 v[132:135], a[136:139], v[88:91], v[132:135]
    s_lshl_b32 s58, s61, 17
    v_exp_f32 v235, v171
    v_mfma_f32_16x16x32_bf16 v[132:135], a[132:135], v[84:87], v[132:135]
    s_add_u32 s52, s52, 8192
    v_or3_b32 v57, v57, v215, v216
    v_cvt_pk_bf16_f32 v217, v234, v235
    v_mfma_f32_16x16x32_bf16 v[132:135], a[128:131], v[80:83], v[132:135]
    v_exp_f32 v236, v184
    v_mfma_f32_16x16x32_bf16 v[136:139], a[128:131], v[96:99], v[24:27]
    s_lshl_b32 s60, s60, 10
    buffer_load_dwordx4 a[224:227], v228, s[12:15], s57 offen nt
    ds_read_b128 a[152:155], v2 offset:6144
    v_mfma_f32_16x16x32_bf16 v[136:139], a[132:135], v[100:103], v[136:139]
    s_and_b32 s52, s52, 0xffff
    v_exp_f32 v237, v185
    v_mfma_f32_16x16x32_bf16 v[136:139], a[136:139], v[104:107], v[136:139]
    v_exp_f32 v238, v186
    v_mfma_f32_16x16x32_bf16 v[136:139], a[140:143], v[108:111], v[136:139]
    ds_read_b128 a[156:159], v2 offset:7168
    v_cvt_pk_bf16_f32 v218, v236, v237
    v_mfma_f32_16x16x32_bf16 v[140:143], a[140:143], v[124:127], v[28:31]
    s_add_u32 s58, s58, s60
    v_exp_f32 v239, v187
    v_mfma_f32_16x16x32_bf16 v[140:143], a[136:139], v[120:123], v[140:143]
    v_or3_b32 v57, v57, v217, v218
    v_add_u32 v2, s52, v1
    v_mfma_f32_16x16x32_bf16 v[140:143], a[132:135], v[116:119], v[140:143]
    v_exp_f32 v240, v172
    v_mfma_f32_16x16x32_bf16 v[140:143], a[128:131], v[112:115], v[140:143]
    s_waitcnt lgkmcnt(2)
    ds_read_b128 a[192:195], v3 offset:0
    v_cvt_pk_bf16_f32 v219, v238, v239
    v_mfma_f32_16x16x32_bf16 v[156:159], a[144:147], v[112:115], v[44:47]
    s_mov_b32 s10, s59
    buffer_load_dwordx4 a[228:231], v228, s[12:15], s56 offen nt
    v_mfma_f32_16x16x32_bf16 v[156:159], a[148:151], v[116:119], v[156:159]
    s_waitcnt lgkmcnt(1)
    v_exp_f32 v241, v173
    v_mfma_f32_16x16x32_bf16 v[156:159], a[152:155], v[120:123], v[156:159]
    v_exp_f32 v242, v174
    v_mfma_f32_16x16x32_bf16 v[156:159], a[156:159], v[124:127], v[156:159]
    v_cvt_pk_bf16_f32 v220, v240, v241
    v_or3_b32 v57, v57, v219, v220
    v_mfma_f32_16x16x32_bf16 v[152:155], a[156:159], v[108:111], v[40:43]
    v_exp_f32 v243, v175
    v_mfma_f32_16x16x32_bf16 v[152:155], a[152:155], v[104:107], v[152:155]
    ds_read_b128 a[196:199], v3 offset:1024
    v_cvt_pk_bf16_f32 v221, v242, v243
    v_mfma_f32_16x16x32_bf16 v[152:155], a[148:151], v[100:103], v[152:155]
    v_exp_f32 v244, v188
    v_mfma_f32_16x16x32_bf16 v[152:155], a[144:147], v[96:99], v[152:155]
    buffer_load_dword v7, v230, s[24:27], s54 offen
    ds_read_b128 a[200:203], v3 offset:2048
    v_mfma_f32_16x16x32_bf16 v[148:151], a[144:147], v[80:83], v[36:39]
    v_exp_f32 v245, v189
    v_mfma_f32_16x16x32_bf16 v[148:151], a[148:151], v[84:87], v[148:151]
    v_exp_f32 v246, v190
    v_mfma_f32_16x16x32_bf16 v[148:151], a[152:155], v[88:91], v[148:151]
    v_cvt_pk_bf16_f32 v222, v244, v245
    v_or3_b32 v57, v57, v221, v222
    v_mfma_f32_16x16x32_bf16 v[148:151], a[156:159], v[92:95], v[148:151]
    v_exp_f32 v247, v191
    v_mfma_f32_16x16x32_bf16 v[144:147], a[156:159], v[76:79], v[32:35]
    s_add_u32 s54, s54, 4096
    ds_read_b128 a[204:207], v3 offset:3072
    v_cvt_pk_bf16_f32 v223, v246, v247
    v_mfma_f32_16x16x32_bf16 v[144:147], a[152:155], v[72:75], v[144:147]
    v_bitop3_b32 v57, v57, v223, s37 bitop3:0xa8
    v_cmp_ne_u32 vcc, 0, v57
    v_mfma_f32_16x16x32_bf16 v[144:147], a[148:151], v[68:71], v[144:147]
    v_mfma_f32_16x16x32_bf16 v[144:147], a[144:147], v[64:67], v[144:147]
    s_cbranch_vccnz k2_tramp_94
k2_ret_95:
    v_mfma_f32_16x16x32_bf16 v[12:15], v[60:63], v[208:211], v[12:15]
    v_exp_f32 v232, v128
    v_mfma_f32_16x16x32_bf16 v[48:51], v[60:63], v[212:215], v[48:51]
    s_mov_b32 m0, s35
    ds_read_b128 a[208:211], v3 offset:4096
    v_mfma_f32_16x16x32_bf16 v[248:251], v[60:63], v[216:219], v[248:251]
    s_add_u32 s53, s53, 8192
    buffer_load_dwordx4 v1, s[20:23], s33 offen offset:0 sc1 lds
    v_mfma_f32_16x16x32_bf16 v[252:255], v[60:63], v[220:223], v[252:255]
    s_waitcnt lgkmcnt(3)
    v_exp_f32 v233, v129
    v_mfma_f32_16x16x32_bf16 a[12:15], a[192:195], v[220:223], a[12:15]
    s_sub_u32 s40, s36, s38
    v_exp_f32 v234, v130
    v_mfma_f32_16x16x32_bf16 a[8:11], a[192:195], v[216:219], a[8:11]
    s_and_b32 s53, s53, 0xffff
    ds_read_b128 a[212:215], v3 offset:5120
    v_cvt_pk_bf16_f32 v192, v232, v233
    v_mfma_f32_16x16x32_bf16 a[4:7], a[192:195], v[212:215], a[4:7]
    v_subrev_u32 v6, s40, v4
    v_cmp_gt_i32 s[44:45], 0, v6
    v_mfma_f32_16x16x32_bf16 a[0:3], a[192:195], v[208:211], a[0:3]
    v_exp_f32 v235, v131
    v_mfma_f32_16x16x32_bf16 a[16:19], a[196:199], v[208:211], a[16:19]
    v_exp_f32 v236, v144
    v_mfma_f32_16x16x32_bf16 a[20:23], a[196:199], v[212:215], a[20:23]
    v_cmp_gt_i32 s[46:47], 1, v6
    v_cvt_pk_bf16_f32 v193, v234, v235
    v_mfma_f32_16x16x32_bf16 a[24:27], a[196:199], v[216:219], a[24:27]
    ds_read_b128 a[216:219], v3 offset:6144
    v_cmp_gt_i32 s[48:49], 2, v6
    v_mfma_f32_16x16x32_bf16 a[28:31], a[196:199], v[220:223], a[28:31]
    s_waitcnt lgkmcnt(3)
    v_exp_f32 v237, v145
    v_mfma_f32_16x16x32_bf16 a[44:47], a[200:203], v[220:223], a[44:47]
    v_cmp_gt_i32 s[50:51], 3, v6
    v_cvt_pk_bf16_f32 v194, v236, v237
    v_mfma_f32_16x16x32_bf16 a[40:43], a[200:203], v[216:219], a[40:43]
    v_exp_f32 v238, v146
    v_mfma_f32_16x16x32_bf16 a[36:39], a[200:203], v[212:215], a[36:39]
    ds_read_b128 a[220:223], v3 offset:7168
    v_cndmask_b32 v16, v8, v5, s[44:45]
    v_mfma_f32_16x16x32_bf16 a[32:35], a[200:203], v[208:211], a[32:35]
    s_add_u32 s35, s35, 0x4000
    v_exp_f32 v239, v147
    v_mfma_f32_16x16x32_bf16 a[48:51], a[204:207], v[208:211], a[48:51]
    v_or3_b32 v57, v192, v193, v194
    v_cndmask_b32 v17, v8, v5, s[46:47]
    v_mfma_f32_16x16x32_bf16 a[52:55], a[204:207], v[212:215], a[52:55]
    v_add_u32 v3, s53, v56
    v_cvt_pk_bf16_f32 v195, v238, v239
    v_mfma_f32_16x16x32_bf16 a[56:59], a[204:207], v[216:219], a[56:59]
    v_exp_f32 v240, v132
    v_mfma_f32_16x16x32_bf16 a[60:63], a[204:207], v[220:223], a[60:63]
    s_waitcnt lgkmcnt(2)
    ds_read_b128 a[128:131], v2 offset:0
    v_cndmask_b32 v18, v8, v5, s[48:49]
    v_mfma_f32_16x16x32_bf16 a[76:79], a[208:211], v[220:223], a[76:79]
    buffer_load_dwordx4 v1, s[20:23], s33 offen offset:1024 sc1 lds
    ds_read_b128 a[132:135], v2 offset:1024
    v_mfma_f32_16x16x32_bf16 a[72:75], a[208:211], v[216:219], a[72:75]
    v_exp_f32 v241, v133
    v_mfma_f32_16x16x32_bf16 a[68:71], a[208:211], v[212:215], a[68:71]
    v_cndmask_b32 v19, v8, v5, s[50:51]
    v_cmp_gt_i32 s[44:45], 16, v6
    v_mfma_f32_16x16x32_bf16 a[64:67], a[208:211], v[208:211], a[64:67]
    v_exp_f32 v242, v134
    v_mfma_f32_16x16x32_bf16 a[80:83], a[212:215], v[208:211], a[80:83]
    v_cvt_pk_bf16_f32 v196, v240, v241
    v_cmp_gt_i32 s[46:47], 17, v6
    v_mfma_f32_16x16x32_bf16 a[84:87], a[212:215], v[212:215], a[84:87]
    v_exp_f32 v243, v135
    v_mfma_f32_16x16x32_bf16 a[88:91], a[212:215], v[216:219], a[88:91]
    v_or3_b32 v57, v57, v195, v196
    v_cmp_gt_i32 s[48:49], 18, v6
    v_mfma_f32_16x16x32_bf16 a[92:95], a[212:215], v[220:223], a[92:95]
    s_waitcnt lgkmcnt(2)
    v_exp_f32 v244, v148
    v_mfma_f32_16x16x32_bf16 a[108:111], a[216:219], v[220:223], a[108:111]
    v_cvt_pk_bf16_f32 v197, v242, v243
    v_cmp_gt_i32 s[50:51], 19, v6
    v_mfma_f32_16x16x32_bf16 a[104:107], a[216:219], v[216:219], a[104:107]
    ds_read_b128 a[136:139], v2 offset:2048
    v_cndmask_b32 v32, v8, v5, s[44:45]
    v_mfma_f32_16x16x32_bf16 a[100:103], a[216:219], v[212:215], a[100:103]
    v_exp_f32 v245, v149
    v_mfma_f32_16x16x32_bf16 a[96:99], a[216:219], v[208:211], a[96:99]
    s_and_b32 s35, s35, 0xffff
    v_exp_f32 v246, v150
    v_mfma_f32_16x16x32_bf16 a[112:115], a[220:223], v[208:211], a[112:115]
    v_cndmask_b32 v33, v8, v5, s[46:47]
    v_cvt_pk_bf16_f32 v198, v244, v245
    v_mfma_f32_16x16x32_bf16 a[116:119], a[220:223], v[212:215], a[116:119]
    ds_read_b128 a[140:143], v2 offset:3072
    v_cndmask_b32 v34, v8, v5, s[48:49]
    v_cndmask_b32 v35, v8, v5, s[50:51]
    v_mfma_f32_16x16x32_bf16 a[120:123], a[220:223], v[216:219], a[120:123]
    v_exp_f32 v247, v151
    v_mfma_f32_16x16x32_bf16 a[124:127], a[220:223], v[220:223], a[124:127]
    s_waitcnt lgkmcnt(2)
    v_or3_b32 v57, v57, v197, v198
    v_cvt_pk_bf16_f32 v199, v246, v247
    v_mfma_f32_16x16x32_bf16 v[160:163], a[128:131], v[64:67], v[16:19]
    v_exp_f32 v232, v136
    v_mfma_f32_16x16x32_bf16 v[160:163], a[132:135], v[68:71], v[160:163]
    s_waitcnt lgkmcnt(0)
    buffer_load_dwordx4 v1, s[20:23], s33 offen offset:2048 sc1 lds
    ds_read_b128 a[144:147], v2 offset:4096
    v_mfma_f32_16x16x32_bf16 v[160:163], a[136:139], v[72:75], v[160:163]
    v_exp_f32 v233, v137
    v_mfma_f32_16x16x32_bf16 v[160:163], a[140:143], v[76:79], v[160:163]
    s_or_b32 s35, s35, 0x10000
    v_exp_f32 v234, v138
    v_mfma_f32_16x16x32_bf16 v[164:167], a[140:143], v[92:95], v[20:23]
    s_add_u32 s36, s36, 32
    ds_read_b128 a[148:151], v2 offset:5120
    v_cvt_pk_bf16_f32 v200, v232, v233
    v_mfma_f32_16x16x32_bf16 v[164:167], a[136:139], v[88:91], v[164:167]
    v_exp_f32 v235, v139
    v_mfma_f32_16x16x32_bf16 v[164:167], a[132:135], v[84:87], v[164:167]
    s_add_u32 s52, s52, 8192
    v_or3_b32 v57, v57, v199, v200
    v_cvt_pk_bf16_f32 v201, v234, v235
    v_mfma_f32_16x16x32_bf16 v[164:167], a[128:131], v[80:83], v[164:167]
    v_exp_f32 v236, v152
    v_mfma_f32_16x16x32_bf16 v[168:171], a[128:131], v[96:99], v[24:27]
    s_and_b32 s52, s52, 0xffff
    ds_read_b128 a[152:155], v2 offset:6144
    ds_read_b128 a[156:159], v2 offset:7168
    v_mfma_f32_16x16x32_bf16 v[168:171], a[132:135], v[100:103], v[168:171]
    v_exp_f32 v237, v153
    v_mfma_f32_16x16x32_bf16 v[168:171], a[136:139], v[104:107], v[168:171]
    v_exp_f32 v238, v154
    v_mfma_f32_16x16x32_bf16 v[168:171], a[140:143], v[108:111], v[168:171]
    v_cvt_pk_bf16_f32 v202, v236, v237
    v_or3_b32 v57, v57, v201, v202
    v_mfma_f32_16x16x32_bf16 v[172:175], a[140:143], v[124:127], v[28:31]
    v_exp_f32 v239, v155
    v_mfma_f32_16x16x32_bf16 v[172:175], a[136:139], v[120:123], v[172:175]
    v_add_u32 v2, s52, v1
    v_cvt_pk_bf16_f32 v203, v238, v239
    v_mfma_f32_16x16x32_bf16 v[172:175], a[132:135], v[116:119], v[172:175]
    v_exp_f32 v240, v140
    v_mfma_f32_16x16x32_bf16 v[172:175], a[128:131], v[112:115], v[172:175]
    s_waitcnt lgkmcnt(2)
    buffer_load_dwordx4 v1, s[20:23], s33 offen offset:3072 sc1 lds
    s_add_u32 s33, s33, 0x80000
    v_mfma_f32_16x16x32_bf16 v[188:191], a[144:147], v[112:115], v[44:47]
    v_exp_f32 v241, v141
    v_mfma_f32_16x16x32_bf16 v[188:191], a[148:151], v[116:119], v[188:191]
    s_waitcnt lgkmcnt(0)
    ds_read_b128 a[192:195], v3 offset:0
    v_cvt_pk_bf16_f32 v204, v240, v241
    v_mfma_f32_16x16x32_bf16 v[188:191], a[152:155], v[120:123], v[188:191]
    v_exp_f32 v242, v142
    v_mfma_f32_16x16x32_bf16 v[188:191], a[156:159], v[124:127], v[188:191]
    v_exp_f32 v243, v143
    v_mfma_f32_16x16x32_bf16 v[184:187], a[156:159], v[108:111], v[40:43]
    ds_read_b128 a[196:199], v3 offset:1024
    v_or3_b32 v57, v57, v203, v204
    v_mfma_f32_16x16x32_bf16 v[184:187], a[152:155], v[104:107], v[184:187]
    v_exp_f32 v244, v156
    v_mfma_f32_16x16x32_bf16 v[184:187], a[148:151], v[100:103], v[184:187]
    ds_read_b128 a[200:203], v3 offset:2048
    v_cvt_pk_bf16_f32 v205, v242, v243
    v_mfma_f32_16x16x32_bf16 v[184:187], a[144:147], v[96:99], v[184:187]
    v_exp_f32 v245, v157
    v_mfma_f32_16x16x32_bf16 v[180:183], a[144:147], v[80:83], v[36:39]
    v_exp_f32 v246, v158
    v_mfma_f32_16x16x32_bf16 v[180:183], a[148:151], v[84:87], v[180:183]
    v_cvt_pk_bf16_f32 v206, v244, v245
    v_or3_b32 v57, v57, v205, v206
    v_mfma_f32_16x16x32_bf16 v[180:183], a[152:155], v[88:91], v[180:183]
    v_exp_f32 v247, v159
    v_mfma_f32_16x16x32_bf16 v[180:183], a[156:159], v[92:95], v[180:183]
    ds_read_b128 a[204:207], v3 offset:3072
    v_cvt_pk_bf16_f32 v207, v246, v247
    v_mfma_f32_16x16x32_bf16 v[176:179], a[156:159], v[76:79], v[32:35]
    v_mfma_f32_16x16x32_bf16 v[176:179], a[152:155], v[72:75], v[176:179]
    v_bitop3_b32 v57, v57, v207, s37 bitop3:0xa8
    v_cmp_ne_u32 vcc, 0, v57
    v_mfma_f32_16x16x32_bf16 v[176:179], a[148:151], v[68:71], v[176:179]
    v_mfma_f32_16x16x32_bf16 v[176:179], a[144:147], v[64:67], v[176:179]
    s_waitcnt vmcnt(13)
    s_barrier
    s_cbranch_vccnz k2_tramp_96
k2_ret_97:
k2_dm3_89:
    v_mfma_f32_16x16x32_bf16 v[12:15], v[60:63], v[192:195], v[12:15]
    v_exp_f32 v232, v160
    v_mfma_f32_16x16x32_bf16 v[48:51], v[60:63], v[196:199], v[48:51]
    s_mov_b32 m0, s34
    ds_read_b128 a[208:211], v3 offset:4096
    v_mfma_f32_16x16x32_bf16 v[248:251], v[60:63], v[200:203], v[248:251]
    s_add_u32 s53, s53, 8192
    v_exp_f32 v233, v161
    v_mfma_f32_16x16x32_bf16 v[252:255], v[60:63], v[204:207], v[252:255]
    s_waitcnt lgkmcnt(3)
    buffer_load_dwordx4 v1, s[16:19], s32 offen offset:0 sc1 lds
    v_mfma_f32_16x16x32_bf16 a[12:15], a[192:195], v[204:207], a[12:15]
    s_sub_u32 s40, s36, s38
    s_sub_u32 s40, s40, 64
    v_exp_f32 v234, v162
    v_cvt_pk_bf16_f32 v208, v232, v233
    v_mfma_f32_16x16x32_bf16 a[8:11], a[192:195], v[200:203], a[8:11]
    s_and_b32 s53, s53, 0xffff
    ds_read_b128 a[212:215], v3 offset:5120
    v_subrev_u32 v6, s40, v4
    v_mfma_f32_16x16x32_bf16 a[4:7], a[192:195], v[196:199], a[4:7]
    s_add_u32 s34, s34, 0x4000
    v_exp_f32 v235, v163
    v_cmp_gt_i32 s[44:45], 0, v6
    v_mfma_f32_16x16x32_bf16 a[0:3], a[192:195], v[192:195], a[0:3]
    v_exp_f32 v236, v176
    v_cvt_pk_bf16_f32 v209, v234, v235
    v_mfma_f32_16x16x32_bf16 a[16:19], a[196:199], v[192:195], a[16:19]
    buffer_load_dwordx4 v1, s[16:19], s32 offen offset:1024 sc1 lds
    ds_read_b128 a[216:219], v3 offset:6144
    v_mfma_f32_16x16x32_bf16 a[20:23], a[196:199], v[196:199], a[20:23]
    v_cmp_gt_i32 s[46:47], 1, v6
    v_exp_f32 v237, v177
    v_mfma_f32_16x16x32_bf16 a[24:27], a[196:199], v[200:203], a[24:27]
    v_cmp_gt_i32 s[48:49], 2, v6
    v_exp_f32 v238, v178
    v_mfma_f32_16x16x32_bf16 a[28:31], a[196:199], v[204:207], a[28:31]
    s_waitcnt lgkmcnt(3)
    v_cvt_pk_bf16_f32 v210, v236, v237
    v_cmp_gt_i32 s[50:51], 3, v6
    v_mfma_f32_16x16x32_bf16 a[44:47], a[200:203], v[204:207], a[44:47]
    s_and_b32 s34, s34, 0xffff
    v_exp_f32 v239, v179
    v_mfma_f32_16x16x32_bf16 a[40:43], a[200:203], v[200:203], a[40:43]
    s_and_b32 s60, s62, 31
    ds_read_b128 a[220:223], v3 offset:7168
    v_or3_b32 v57, v208, v209, v210
    v_cndmask_b32 v20, v9, v5, s[44:45]
    v_mfma_f32_16x16x32_bf16 a[36:39], a[200:203], v[196:199], a[36:39]
    buffer_load_dwordx4 v1, s[16:19], s32 offen offset:2048 sc1 lds
    v_mfma_f32_16x16x32_bf16 a[32:35], a[200:203], v[192:195], a[32:35]
    s_lshr_b32 s61, s62, 5
    v_exp_f32 v240, v164
    v_cvt_pk_bf16_f32 v211, v238, v239
    v_mfma_f32_16x16x32_bf16 a[48:51], a[204:207], v[192:195], a[48:51]
    v_cndmask_b32 v21, v9, v5, s[46:47]
    v_add_u32 v3, s53, v56
    v_mfma_f32_16x16x32_bf16 a[52:55], a[204:207], v[196:199], a[52:55]
    s_mul_i32 s57, s60, 229376
    v_exp_f32 v241, v165
    v_mfma_f32_16x16x32_bf16 a[56:59], a[204:207], v[200:203], a[56:59]
    ds_read_b128 a[128:131], v2 offset:0
    v_cndmask_b32 v22, v9, v5, s[48:49]
    v_cvt_pk_bf16_f32 v212, v240, v241
    v_mfma_f32_16x16x32_bf16 a[60:63], a[204:207], v[204:207], a[60:63]
    s_waitcnt lgkmcnt(3)
    v_exp_f32 v242, v166
    v_mfma_f32_16x16x32_bf16 a[76:79], a[208:211], v[204:207], a[76:79]
    s_lshl_b32 s4, s61, 7
    v_cndmask_b32 v23, v9, v5, s[50:51]
    v_or3_b32 v57, v57, v211, v212
    v_mfma_f32_16x16x32_bf16 a[72:75], a[208:211], v[200:203], a[72:75]
    buffer_load_dwordx4 v1, s[16:19], s32 offen offset:3072 sc1 lds
    ds_read_b128 a[132:135], v2 offset:1024
    s_add_u32 s32, s32, 0x80000
    v_mfma_f32_16x16x32_bf16 a[68:71], a[208:211], v[196:199], a[68:71]
    v_exp_f32 v243, v167
    v_mfma_f32_16x16x32_bf16 a[64:67], a[208:211], v[192:195], a[64:67]
    s_add_u32 s57, s57, s4
    v_cmp_gt_i32 s[44:45], 16, v6
    v_cvt_pk_bf16_f32 v213, v242, v243
    v_mfma_f32_16x16x32_bf16 a[80:83], a[212:215], v[192:195], a[80:83]
    s_waitcnt vmcnt(9)
    v_exp_f32 v244, v180
    v_mfma_f32_16x16x32_bf16 a[84:87], a[212:215], v[196:199], a[84:87]
    s_add_u32 s56, s57, 57344
    ds_read_b128 a[136:139], v2 offset:2048
    v_cmp_gt_i32 s[46:47], 17, v6
    v_mfma_f32_16x16x32_bf16 a[88:91], a[212:215], v[200:203], a[88:91]
    v_exp_f32 v245, v181
    v_cmp_gt_i32 s[48:49], 18, v6
    v_mfma_f32_16x16x32_bf16 a[92:95], a[212:215], v[204:207], a[92:95]
    s_waitcnt lgkmcnt(3)
    v_exp_f32 v246, v182
    v_mfma_f32_16x16x32_bf16 a[108:111], a[216:219], v[204:207], a[108:111]
    s_add_u32 s62, s62, 1
    v_cmp_gt_i32 s[50:51], 19, v6
    v_cvt_pk_bf16_f32 v214, v244, v245
    v_mfma_f32_16x16x32_bf16 a[104:107], a[216:219], v[200:203], a[104:107]
    buffer_store_dwordx4 a[224:227], v229, s[8:11], s58 offen offset:0 sc1
    ds_read_b128 a[140:143], v2 offset:3072
    ds_read_b128 a[144:147], v2 offset:4096
    v_mfma_f32_16x16x32_bf16 a[100:103], a[216:219], v[196:199], a[100:103]
    v_exp_f32 v247, v183
    v_mfma_f32_16x16x32_bf16 a[96:99], a[216:219], v[192:195], a[96:99]
    v_cndmask_b32 v36, v9, v5, s[44:45]
    v_or3_b32 v57, v57, v213, v214
    v_mfma_f32_16x16x32_bf16 a[112:115], a[220:223], v[192:195], a[112:115]
    v_exp_f32 v232, v168
    v_mfma_f32_16x16x32_bf16 a[116:119], a[220:223], v[196:199], a[116:119]
    v_cndmask_b32 v37, v9, v5, s[46:47]
    v_cvt_pk_bf16_f32 v215, v246, v247
    v_cndmask_b32 v38, v9, v5, s[48:49]
    v_cndmask_b32 v39, v9, v5, s[50:51]
    v_mfma_f32_16x16x32_bf16 a[120:123], a[220:223], v[200:203], a[120:123]
    v_exp_f32 v233, v169
    v_mfma_f32_16x16x32_bf16 a[124:127], a[220:223], v[204:207], a[124:127]
    s_waitcnt lgkmcnt(3)
    buffer_store_dwordx4 a[228:231], v229, s[8:11], s58 offen offset:256 sc1
    v_exp_f32 v234, v170
    v_mfma_f32_16x16x32_bf16 v[132:135], a[128:131], v[80:83], v[20:23]
    ds_read_b128 a[148:151], v2 offset:5120
    v_cvt_pk_bf16_f32 v216, v232, v233
    v_mfma_f32_16x16x32_bf16 v[132:135], a[132:135], v[84:87], v[132:135]
    s_waitcnt lgkmcnt(2)
    v_exp_f32 v235, v171
    v_mfma_f32_16x16x32_bf16 v[132:135], a[136:139], v[88:91], v[132:135]
    s_lshl_b32 s58, s61, 17
    ds_read_b128 a[152:155], v2 offset:6144
    v_or3_b32 v57, v57, v215, v216
    v_mfma_f32_16x16x32_bf16 v[132:135], a[140:143], v[92:95], v[132:135]
    s_add_u32 s36, s36, 32
    v_exp_f32 v236, v184
    v_mfma_f32_16x16x32_bf16 v[136:139], a[140:143], v[108:111], v[24:27]
    s_lshl_b32 s60, s60, 10
    v_cvt_pk_bf16_f32 v217, v234, v235
    v_exp_f32 v237, v185
    v_mfma_f32_16x16x32_bf16 v[136:139], a[136:139], v[104:107], v[136:139]
    buffer_load_dwordx4 a[224:227], v228, s[12:15], s57 offen nt
    ds_read_b128 a[156:159], v2 offset:7168
    v_mfma_f32_16x16x32_bf16 v[136:139], a[132:135], v[100:103], v[136:139]
    s_add_u32 s52, s52, 8192
    v_exp_f32 v238, v186
    v_mfma_f32_16x16x32_bf16 v[136:139], a[128:131], v[96:99], v[136:139]
    s_add_u32 s58, s58, s60
    v_cvt_pk_bf16_f32 v218, v236, v237
    v_or3_b32 v57, v57, v217, v218
    v_mfma_f32_16x16x32_bf16 v[140:143], a[128:131], v[112:115], v[28:31]
    s_and_b32 s52, s52, 0xffff
    v_exp_f32 v239, v187
    v_mfma_f32_16x16x32_bf16 v[140:143], a[132:135], v[116:119], v[140:143]
    v_add_u32 v2, s52, v1
    v_cvt_pk_bf16_f32 v219, v238, v239
    v_mfma_f32_16x16x32_bf16 v[140:143], a[136:139], v[120:123], v[140:143]
    s_mov_b32 s10, s59
    v_exp_f32 v240, v172
    v_mfma_f32_16x16x32_bf16 v[140:143], a[140:143], v[124:127], v[140:143]
    s_waitcnt lgkmcnt(2)
    ds_read_b128 a[192:195], v3 offset:0
    s_waitcnt lgkmcnt(1)
    v_mfma_f32_16x16x32_bf16 v[156:159], a[156:159], v[124:127], v[44:47]
    v_exp_f32 v241, v173
    v_mfma_f32_16x16x32_bf16 v[156:159], a[152:155], v[120:123], v[156:159]
    buffer_load_dwordx4 a[228:231], v228, s[12:15], s56 offen nt
    v_exp_f32 v242, v174
    v_mfma_f32_16x16x32_bf16 v[156:159], a[148:151], v[116:119], v[156:159]
    ds_read_b128 a[196:199], v3 offset:1024
    v_cvt_pk_bf16_f32 v220, v240, v241
    v_mfma_f32_16x16x32_bf16 v[156:159], a[144:147], v[112:115], v[156:159]
    v_exp_f32 v243, v175
    v_mfma_f32_16x16x32_bf16 v[152:155], a[144:147], v[96:99], v[40:43]
    v_or3_b32 v57, v57, v219, v220
    v_cvt_pk_bf16_f32 v221, v242, v243
    v_mfma_f32_16x16x32_bf16 v[152:155], a[148:151], v[100:103], v[152:155]
    ds_read_b128 a[200:203], v3 offset:2048
    v_exp_f32 v244, v188
    v_mfma_f32_16x16x32_bf16 v[152:155], a[152:155], v[104:107], v[152:155]
    buffer_load_dword v7, v230, s[24:27], s54 offen
    v_exp_f32 v245, v189
    v_mfma_f32_16x16x32_bf16 v[152:155], a[156:159], v[108:111], v[152:155]
    v_exp_f32 v246, v190
    v_mfma_f32_16x16x32_bf16 v[148:151], a[156:159], v[92:95], v[36:39]
    s_add_u32 s54, s54, 4096
    v_cvt_pk_bf16_f32 v222, v244, v245
    v_or3_b32 v57, v57, v221, v222
    v_mfma_f32_16x16x32_bf16 v[148:151], a[152:155], v[88:91], v[148:151]
    v_exp_f32 v247, v191
    v_mfma_f32_16x16x32_bf16 v[148:151], a[148:151], v[84:87], v[148:151]
    ds_read_b128 a[204:207], v3 offset:3072
    v_cvt_pk_bf16_f32 v223, v246, v247
    v_mfma_f32_16x16x32_bf16 v[148:151], a[144:147], v[80:83], v[148:151]
    v_bitop3_b32 v57, v57, v223, s37 bitop3:0xa8
    v_cmp_ne_u32 vcc, 0, v57
    s_cbranch_vccnz k2_tramp_98
k2_ret_99:
    v_mfma_f32_16x16x32_bf16 v[12:15], v[60:63], v[208:211], v[12:15]
    v_exp_f32 v232, v132
    v_mfma_f32_16x16x32_bf16 v[48:51], v[60:63], v[212:215], v[48:51]
    s_mov_b32 m0, s35
    ds_read_b128 a[208:211], v3 offset:4096
    v_mfma_f32_16x16x32_bf16 v[248:251], v[60:63], v[216:219], v[248:251]
    s_add_u32 s53, s53, 8192
    buffer_load_dwordx4 v1, s[20:23], s33 offen offset:0 sc1 lds
    v_mfma_f32_16x16x32_bf16 v[252:255], v[60:63], v[220:223], v[252:255]
    s_waitcnt lgkmcnt(3)
    v_exp_f32 v233, v133
    v_mfma_f32_16x16x32_bf16 a[12:15], a[192:195], v[220:223], a[12:15]
    s_sub_u32 s40, s36, s38
    s_sub_u32 s40, s40, 64
    v_exp_f32 v234, v134
    v_mfma_f32_16x16x32_bf16 a[8:11], a[192:195], v[216:219], a[8:11]
    s_and_b32 s53, s53, 0xffff
    ds_read_b128 a[212:215], v3 offset:5120
    v_subrev_u32 v6, s40, v4
    v_mfma_f32_16x16x32_bf16 a[4:7], a[192:195], v[212:215], a[4:7]
    v_cvt_pk_bf16_f32 v196, v232, v233
    v_cmp_gt_i32 s[44:45], 0, v6
    v_mfma_f32_16x16x32_bf16 a[0:3], a[192:195], v[208:211], a[0:3]
    v_exp_f32 v235, v135
    v_mfma_f32_16x16x32_bf16 a[16:19], a[196:199], v[208:211], a[16:19]
    ds_read_b128 a[216:219], v3 offset:6144
    v_cmp_gt_i32 s[46:47], 1, v6
    v_mfma_f32_16x16x32_bf16 a[20:23], a[196:199], v[212:215], a[20:23]
    v_exp_f32 v236, v148
    v_mfma_f32_16x16x32_bf16 a[24:27], a[196:199], v[216:219], a[24:27]
    v_cvt_pk_bf16_f32 v197, v234, v235
    v_cmp_gt_i32 s[48:49], 2, v6
    v_mfma_f32_16x16x32_bf16 a[28:31], a[196:199], v[220:223], a[28:31]
    s_waitcnt lgkmcnt(3)
    v_cmp_gt_i32 s[50:51], 3, v6
    v_mfma_f32_16x16x32_bf16 a[44:47], a[200:203], v[220:223], a[44:47]
    v_exp_f32 v237, v149
    v_mfma_f32_16x16x32_bf16 a[40:43], a[200:203], v[216:219], a[40:43]
    s_add_u32 s35, s35, 0x4000
    ds_read_b128 a[220:223], v3 offset:7168
    v_cndmask_b32 v20, v9, v5, s[44:45]
    v_mfma_f32_16x16x32_bf16 a[36:39], a[200:203], v[212:215], a[36:39]
    v_exp_f32 v238, v150
    v_mfma_f32_16x16x32_bf16 a[32:35], a[200:203], v[208:211], a[32:35]
    v_cvt_pk_bf16_f32 v198, v236, v237
    v_cndmask_b32 v21, v9, v5, s[46:47]
    v_mfma_f32_16x16x32_bf16 a[48:51], a[204:207], v[208:211], a[48:51]
    buffer_load_dwordx4 v1, s[20:23], s33 offen offset:1024 sc1 lds
    ds_read_b128 a[128:131], v2 offset:0
    v_mfma_f32_16x16x32_bf16 a[52:55], a[204:207], v[212:215], a[52:55]
    v_add_u32 v3, s53, v56
    v_cndmask_b32 v22, v9, v5, s[48:49]
    v_mfma_f32_16x16x32_bf16 a[56:59], a[204:207], v[216:219], a[56:59]
    v_exp_f32 v239, v151
    v_mfma_f32_16x16x32_bf16 a[60:63], a[204:207], v[220:223], a[60:63]
    s_waitcnt lgkmcnt(3)
    v_or3_b32 v57, v196, v197, v198
    v_cndmask_b32 v23, v9, v5, s[50:51]
    v_mfma_f32_16x16x32_bf16 a[76:79], a[208:211], v[220:223], a[76:79]
    v_exp_f32 v240, v136
    v_mfma_f32_16x16x32_bf16 a[72:75], a[208:211], v[216:219], a[72:75]
    v_cvt_pk_bf16_f32 v199, v238, v239
    v_cmp_gt_i32 s[44:45], 16, v6
    v_mfma_f32_16x16x32_bf16 a[68:71], a[208:211], v[212:215], a[68:71]
    ds_read_b128 a[132:135], v2 offset:1024
    v_cmp_gt_i32 s[46:47], 17, v6
    v_mfma_f32_16x16x32_bf16 a[64:67], a[208:211], v[208:211], a[64:67]
    v_exp_f32 v241, v137
    v_mfma_f32_16x16x32_bf16 a[80:83], a[212:215], v[208:211], a[80:83]
    ds_read_b128 a[136:139], v2 offset:2048
    v_cmp_gt_i32 s[48:49], 18, v6
    v_mfma_f32_16x16x32_bf16 a[84:87], a[212:215], v[212:215], a[84:87]
    v_exp_f32 v242, v138
    v_mfma_f32_16x16x32_bf16 a[88:91], a[212:215], v[216:219], a[88:91]
    v_cvt_pk_bf16_f32 v200, v240, v241
    v_cmp_gt_i32 s[50:51], 19, v6
    v_mfma_f32_16x16x32_bf16 a[92:95], a[212:215], v[220:223], a[92:95]
    s_waitcnt lgkmcnt(3)
    v_exp_f32 v243, v139
    v_mfma_f32_16x16x32_bf16 a[108:111], a[216:219], v[220:223], a[108:111]
    s_and_b32 s35, s35, 0xffff
    ds_read_b128 a[140:143], v2 offset:3072
    v_or3_b32 v57, v57, v199, v200
    v_mfma_f32_16x16x32_bf16 a[104:107], a[216:219], v[216:219], a[104:107]
    v_cndmask_b32 v36, v9, v5, s[44:45]
    v_cndmask_b32 v37, v9, v5, s[46:47]
    v_mfma_f32_16x16x32_bf16 a[100:103], a[216:219], v[212:215], a[100:103]
    v_exp_f32 v244, v152
    v_mfma_f32_16x16x32_bf16 a[96:99], a[216:219], v[208:211], a[96:99]
    ds_read_b128 a[144:147], v2 offset:4096
    v_cvt_pk_bf16_f32 v201, v242, v243
    v_mfma_f32_16x16x32_bf16 a[112:115], a[220:223], v[208:211], a[112:115]
    buffer_load_dwordx4 v1, s[20:23], s33 offen offset:2048 sc1 lds
    ds_read_b128 a[148:151], v2 offset:5120
    v_mfma_f32_16x16x32_bf16 a[116:119], a[220:223], v[212:215], a[116:119]
    v_cndmask_b32 v38, v9, v5, s[48:49]
    v_cndmask_b32 v39, v9, v5, s[50:51]
    v_mfma_f32_16x16x32_bf16 a[120:123], a[220:223], v[216:219], a[120:123]
    s_or_b32 s35, s35, 0x10000
    v_exp_f32 v245, v153
    v_mfma_f32_16x16x32_bf16 a[124:127], a[220:223], v[220:223], a[124:127]
    s_waitcnt lgkmcnt(4)
    v_exp_f32 v246, v154
    v_mfma_f32_16x16x32_bf16 v[164:167], a[128:131], v[80:83], v[20:23]
    ds_read_b128 a[152:155], v2 offset:6144
    v_cvt_pk_bf16_f32 v202, v244, v245
    v_mfma_f32_16x16x32_bf16 v[164:167], a[132:135], v[84:87], v[164:167]
    s_waitcnt lgkmcnt(3)
    v_exp_f32 v247, v155
    v_mfma_f32_16x16x32_bf16 v[164:167], a[136:139], v[88:91], v[164:167]
    v_or3_b32 v57, v57, v201, v202
    v_cvt_pk_bf16_f32 v203, v246, v247
    v_mfma_f32_16x16x32_bf16 v[164:167], a[140:143], v[92:95], v[164:167]
    s_add_u32 s36, s36, 32
    v_exp_f32 v232, v140
    v_mfma_f32_16x16x32_bf16 v[168:171], a[140:143], v[108:111], v[24:27]
    ds_read_b128 a[156:159], v2 offset:7168
    v_mfma_f32_16x16x32_bf16 v[168:171], a[136:139], v[104:107], v[168:171]
    v_exp_f32 v233, v141
    v_mfma_f32_16x16x32_bf16 v[168:171], a[132:135], v[100:103], v[168:171]
    s_add_u32 s52, s52, 8192
    v_exp_f32 v234, v142
    v_mfma_f32_16x16x32_bf16 v[168:171], a[128:131], v[96:99], v[168:171]
    ds_read_b128 a[192:195], v3 offset:0
    v_cvt_pk_bf16_f32 v204, v232, v233
    v_mfma_f32_16x16x32_bf16 v[172:175], a[128:131], v[112:115], v[28:31]
    s_and_b32 s52, s52, 0xffff
    v_add_u32 v2, s52, v1
    v_or3_b32 v57, v57, v203, v204
    v_mfma_f32_16x16x32_bf16 v[172:175], a[132:135], v[116:119], v[172:175]
    buffer_load_dwordx4 v1, s[20:23], s33 offen offset:3072 sc1 lds
    s_add_u32 s33, s33, 0x80000
    v_mfma_f32_16x16x32_bf16 v[172:175], a[136:139], v[120:123], v[172:175]
    v_exp_f32 v235, v143
    v_mfma_f32_16x16x32_bf16 v[172:175], a[140:143], v[124:127], v[172:175]
    s_waitcnt lgkmcnt(3)
    ds_read_b128 a[196:199], v3 offset:1024
    s_waitcnt lgkmcnt(2)
    v_mfma_f32_16x16x32_bf16 v[188:191], a[156:159], v[124:127], v[44:47]
    v_exp_f32 v236, v156
    v_mfma_f32_16x16x32_bf16 v[188:191], a[152:155], v[120:123], v[188:191]
    v_cvt_pk_bf16_f32 v205, v234, v235
    v_mfma_f32_16x16x32_bf16 v[188:191], a[148:151], v[116:119], v[188:191]
    v_exp_f32 v237, v157
    v_mfma_f32_16x16x32_bf16 v[188:191], a[144:147], v[112:115], v[188:191]
    ds_read_b128 a[200:203], v3 offset:2048
    v_cvt_pk_bf16_f32 v206, v236, v237
    v_mfma_f32_16x16x32_bf16 v[184:187], a[144:147], v[96:99], v[40:43]
    v_exp_f32 v238, v158
    v_mfma_f32_16x16x32_bf16 v[184:187], a[148:151], v[100:103], v[184:187]
    v_exp_f32 v239, v159
    v_mfma_f32_16x16x32_bf16 v[184:187], a[152:155], v[104:107], v[184:187]
    ds_read_b128 a[204:207], v3 offset:3072
    v_or3_b32 v57, v57, v205, v206
    v_mfma_f32_16x16x32_bf16 v[184:187], a[156:159], v[108:111], v[184:187]
    v_cvt_pk_bf16_f32 v207, v238, v239
    v_mfma_f32_16x16x32_bf16 v[180:183], a[156:159], v[92:95], v[36:39]
    v_mfma_f32_16x16x32_bf16 v[180:183], a[152:155], v[88:91], v[180:183]
    v_bitop3_b32 v57, v57, v207, s37 bitop3:0xa8
    v_cmp_ne_u32 vcc, 0, v57
    v_mfma_f32_16x16x32_bf16 v[180:183], a[148:151], v[84:87], v[180:183]
    v_mfma_f32_16x16x32_bf16 v[180:183], a[144:147], v[80:83], v[180:183]
    s_waitcnt vmcnt(13)
    s_barrier
    s_cbranch_vccnz k2_tramp_100
k2_ret_101:
    v_mfma_f32_16x16x32_bf16 v[48:51], v[60:63], v[196:199], v[48:51]
    ds_read_b128 a[208:211], v3 offset:4096
    ds_read_b128 a[212:215], v3 offset:5120
    v_mfma_f32_16x16x32_bf16 v[248:251], v[60:63], v[200:203], v[248:251]
    s_mov_b32 m0, s34
    v_exp_f32 v232, v164
    v_mfma_f32_16x16x32_bf16 v[252:255], v[60:63], v[204:207], v[252:255]
    s_waitcnt lgkmcnt(4)
    buffer_load_dwordx4 v1, s[16:19], s32 offen offset:0 sc1 lds
    ds_read_b128 a[216:219], v3 offset:6144
    v_mfma_f32_16x16x32_bf16 a[12:15], a[192:195], v[204:207], a[12:15]
    s_add_u32 s53, s53, 8192
    v_exp_f32 v233, v165
    v_mfma_f32_16x16x32_bf16 a[8:11], a[192:195], v[200:203], a[8:11]
    s_and_b32 s53, s53, 0xffff
    v_mov_b32 v16, v10
    v_mov_b32 v17, v10
    v_mfma_f32_16x16x32_bf16 a[4:7], a[192:195], v[196:199], a[4:7]
    s_add_u32 s34, s34, 0x4000
    v_exp_f32 v234, v166
    v_mfma_f32_16x16x32_bf16 a[20:23], a[196:199], v[196:199], a[20:23]
    ds_read_b128 a[220:223], v3 offset:7168
    v_cvt_pk_bf16_f32 v212, v232, v233
    v_mfma_f32_16x16x32_bf16 a[24:27], a[196:199], v[200:203], a[24:27]
    v_mov_b32 v18, v10
    v_mov_b32 v19, v10
    v_mfma_f32_16x16x32_bf16 a[28:31], a[196:199], v[204:207], a[28:31]
    s_waitcnt lgkmcnt(4)
    v_exp_f32 v235, v167
    v_mfma_f32_16x16x32_bf16 a[44:47], a[200:203], v[204:207], a[44:47]
    buffer_load_dwordx4 v1, s[16:19], s32 offen offset:1024 sc1 lds
    ds_read_b128 a[128:131], v2 offset:0
    v_mfma_f32_16x16x32_bf16 a[40:43], a[200:203], v[200:203], a[40:43]
    v_mov_b32 v20, v11
    v_add_u32 v3, s53, v56
    v_mfma_f32_16x16x32_bf16 a[36:39], a[200:203], v[196:199], a[36:39]
    s_and_b32 s34, s34, 0xffff
    v_mov_b32 v21, v11
    v_mov_b32 v22, v11
    v_mfma_f32_16x16x32_bf16 a[52:55], a[204:207], v[196:199], a[52:55]
    v_exp_f32 v236, v180
    v_mfma_f32_16x16x32_bf16 a[56:59], a[204:207], v[200:203], a[56:59]
    ds_read_b128 a[132:135], v2 offset:1024
    v_cvt_pk_bf16_f32 v213, v234, v235
    v_mfma_f32_16x16x32_bf16 a[60:63], a[204:207], v[204:207], a[60:63]
    s_waitcnt lgkmcnt(4)
    v_mov_b32 v23, v11
    v_mov_b32 v32, v10
    v_mfma_f32_16x16x32_bf16 a[76:79], a[208:211], v[204:207], a[76:79]
    v_exp_f32 v237, v181
    v_mfma_f32_16x16x32_bf16 a[72:75], a[208:211], v[200:203], a[72:75]
    ds_read_b128 a[136:139], v2 offset:2048
    v_mov_b32 v33, v10
    v_mfma_f32_16x16x32_bf16 a[68:71], a[208:211], v[196:199], a[68:71]
    buffer_load_dwordx4 v1, s[16:19], s32 offen offset:2048 sc1 lds
    v_mov_b32 v34, v10
    v_mfma_f32_16x16x32_bf16 a[84:87], a[212:215], v[196:199], a[84:87]
    v_exp_f32 v238, v182
    v_mfma_f32_16x16x32_bf16 a[88:91], a[212:215], v[200:203], a[88:91]
    ds_read_b128 a[140:143], v2 offset:3072
    v_cvt_pk_bf16_f32 v214, v236, v237
    v_mfma_f32_16x16x32_bf16 a[92:95], a[212:215], v[204:207], a[92:95]
    s_waitcnt lgkmcnt(4)
    v_mov_b32 v35, v10
    v_mov_b32 v36, v11
    v_mfma_f32_16x16x32_bf16 a[108:111], a[216:219], v[204:207], a[108:111]
    ds_read_b128 a[144:147], v2 offset:4096
    v_exp_f32 v239, v183
    v_mfma_f32_16x16x32_bf16 a[104:107], a[216:219], v[200:203], a[104:107]
    v_mov_b32 v37, v11
    v_or3_b32 v57, v212, v213, v214
    v_mov_b32 v38, v11
    v_mov_b32 v39, v11
    v_mfma_f32_16x16x32_bf16 a[100:103], a[216:219], v[196:199], a[100:103]
    buffer_load_dwordx4 v1, s[16:19], s32 offen offset:3072 sc1 lds
    ds_read_b128 a[148:151], v2 offset:5120
    v_mfma_f32_16x16x32_bf16 a[116:119], a[220:223], v[196:199], a[116:119]
    s_add_u32 s32, s32, 0x80000
    s_cmp_ge_u32 s36, s43
    s_cbranch_scc1 k2_prep_102
k2_prepret_103:
    v_mfma_f32_16x16x32_bf16 a[120:123], a[220:223], v[200:203], a[120:123]
    s_waitcnt vmcnt(9)
    v_exp_f32 v240, v168
    v_mfma_f32_16x16x32_bf16 a[124:127], a[220:223], v[204:207], a[124:127]
    s_waitcnt lgkmcnt(4)
    ds_read_b128 a[152:155], v2 offset:6144
    v_cvt_pk_bf16_f32 v215, v238, v239
    v_mfma_f32_16x16x32_bf16 v[128:131], a[128:131], v[96:99], v[16:19]
    v_exp_f32 v241, v169
    v_mfma_f32_16x16x32_bf16 v[128:131], a[132:135], v[100:103], v[128:131]
    s_waitcnt lgkmcnt(3)
    ds_read_b128 a[156:159], v2 offset:7168
    v_exp_f32 v242, v170
    v_mfma_f32_16x16x32_bf16 v[128:131], a[136:139], v[104:107], v[128:131]
    ds_read_b128 a[160:163], v2 offset:8192
    v_cvt_pk_bf16_f32 v216, v240, v241
    v_mfma_f32_16x16x32_bf16 v[128:131], a[140:143], v[108:111], v[128:131]
    s_add_u32 s36, s36, 64
    buffer_store_dwordx4 a[224:227], v229, s[8:11], s58 offen offset:0 sc1
    v_exp_f32 v243, v171
    v_mfma_f32_16x16x32_bf16 v[132:135], a[140:143], v[124:127], v[20:23]
    ds_read_b128 a[164:167], v2 offset:9216
    v_or3_b32 v57, v57, v215, v216
    v_mfma_f32_16x16x32_bf16 v[132:135], a[136:139], v[120:123], v[132:135]
    v_exp_f32 v244, v184
    v_mfma_f32_16x16x32_bf16 v[132:135], a[132:135], v[116:119], v[132:135]
    s_add_u32 s52, s52, 16384
    ds_read_b128 a[168:171], v2 offset:10240
    v_cvt_pk_bf16_f32 v217, v242, v243
    v_mfma_f32_16x16x32_bf16 v[132:135], a[128:131], v[112:115], v[132:135]
    s_waitcnt lgkmcnt(5)
    v_exp_f32 v245, v185
    v_mfma_f32_16x16x32_bf16 v[148:151], a[144:147], v[112:115], v[36:39]
    s_and_b32 s52, s52, 0xffff
    ds_read_b128 a[172:175], v2 offset:11264
    ds_read_b128 a[176:179], v2 offset:12288
    v_mfma_f32_16x16x32_bf16 v[148:151], a[148:151], v[116:119], v[148:151]
    s_waitcnt lgkmcnt(5)
    v_exp_f32 v246, v186
    v_mfma_f32_16x16x32_bf16 v[148:151], a[152:155], v[120:123], v[148:151]
    ds_read_b128 a[180:183], v2 offset:13312
    v_cvt_pk_bf16_f32 v218, v244, v245
    v_mfma_f32_16x16x32_bf16 v[148:151], a[156:159], v[124:127], v[148:151]
    v_exp_f32 v247, v187
    v_mfma_f32_16x16x32_bf16 v[144:147], a[156:159], v[108:111], v[32:35]
    ds_read_b128 a[184:187], v2 offset:14336
    v_or3_b32 v57, v57, v217, v218
    v_mfma_f32_16x16x32_bf16 v[144:147], a[152:155], v[104:107], v[144:147]
    v_exp_f32 v232, v172
    v_mfma_f32_16x16x32_bf16 v[144:147], a[148:151], v[100:103], v[144:147]
    ds_read_b128 a[188:191], v2 offset:15360
    v_cvt_pk_bf16_f32 v219, v246, v247
    v_mfma_f32_16x16x32_bf16 v[144:147], a[144:147], v[96:99], v[144:147]
    s_waitcnt lgkmcnt(6)
    v_exp_f32 v233, v173
    v_mfma_f32_16x16x32_bf16 v[136:139], a[160:163], v[96:99], v[24:27]
    buffer_store_dwordx4 a[228:231], v229, s[8:11], s58 offen offset:256 sc1
    ds_read_b128 a[192:195], v3 offset:0
    v_mfma_f32_16x16x32_bf16 v[136:139], a[164:167], v[100:103], v[136:139]
    s_waitcnt lgkmcnt(5)
    v_add_u32 v2, s52, v1
    v_cvt_pk_bf16_f32 v220, v232, v233
    v_mfma_f32_16x16x32_bf16 v[136:139], a[168:171], v[104:107], v[136:139]
    v_exp_f32 v234, v174
    v_mfma_f32_16x16x32_bf16 v[136:139], a[172:175], v[108:111], v[136:139]
    v_exp_f32 v235, v175
    v_mfma_f32_16x16x32_bf16 v[140:143], a[172:175], v[124:127], v[28:31]
    ds_read_b128 a[196:199], v3 offset:1024
    v_or3_b32 v57, v57, v219, v220
    v_mfma_f32_16x16x32_bf16 v[140:143], a[168:171], v[120:123], v[140:143]
    v_exp_f32 v236, v188
    v_mfma_f32_16x16x32_bf16 v[140:143], a[164:167], v[116:119], v[140:143]
    ds_read_b128 a[200:203], v3 offset:2048
    v_cvt_pk_bf16_f32 v221, v234, v235
    v_mfma_f32_16x16x32_bf16 v[140:143], a[160:163], v[112:115], v[140:143]
    s_waitcnt lgkmcnt(5)
    v_exp_f32 v237, v189
    v_mfma_f32_16x16x32_bf16 v[156:159], a[176:179], v[112:115], v[44:47]
    v_exp_f32 v238, v190
    v_mfma_f32_16x16x32_bf16 v[156:159], a[180:183], v[116:119], v[156:159]
    s_waitcnt lgkmcnt(3)
    v_cvt_pk_bf16_f32 v222, v236, v237
    v_or3_b32 v57, v57, v221, v222
    v_mfma_f32_16x16x32_bf16 v[156:159], a[184:187], v[120:123], v[156:159]
    v_exp_f32 v239, v191
    v_mfma_f32_16x16x32_bf16 v[156:159], a[188:191], v[124:127], v[156:159]
    ds_read_b128 a[204:207], v3 offset:3072
    v_cvt_pk_bf16_f32 v223, v238, v239
    v_mfma_f32_16x16x32_bf16 v[152:155], a[188:191], v[108:111], v[40:43]
    v_mfma_f32_16x16x32_bf16 v[152:155], a[184:187], v[104:107], v[152:155]
    v_bitop3_b32 v57, v57, v223, s37 bitop3:0xa8
    v_cmp_ne_u32 vcc, 0, v57
    v_mfma_f32_16x16x32_bf16 v[152:155], a[180:183], v[100:103], v[152:155]
    v_mfma_f32_16x16x32_bf16 v[152:155], a[176:179], v[96:99], v[152:155]
    s_cbranch_vccnz k2_tramp_104
k2_ret_105:
    v_mfma_f32_16x16x32_bf16 v[48:51], v[60:63], v[212:215], v[48:51]
    ds_read_b128 a[208:211], v3 offset:4096
    ds_read_b128 a[212:215], v3 offset:5120
    v_mfma_f32_16x16x32_bf16 v[248:251], v[60:63], v[216:219], v[248:251]
    s_mov_b32 m0, s35
    v_exp_f32 v232, v128
    v_mfma_f32_16x16x32_bf16 v[252:255], v[60:63], v[220:223], v[252:255]
    s_waitcnt lgkmcnt(4)
    ds_read_b128 a[216:219], v3 offset:6144
    v_exp_f32 v233, v129
    v_mfma_f32_16x16x32_bf16 a[12:15], a[192:195], v[220:223], a[12:15]
    s_add_u32 s53, s53, 8192
    buffer_load_dwordx4 v1, s[20:23], s33 offen offset:0 sc1 lds
    v_mfma_f32_16x16x32_bf16 a[8:11], a[192:195], v[216:219], a[8:11]
    s_and_b32 s53, s53, 0xffff
    v_exp_f32 v234, v130
    v_cvt_pk_bf16_f32 v192, v232, v233
    v_mfma_f32_16x16x32_bf16 a[4:7], a[192:195], v[212:215], a[4:7]
    ds_read_b128 a[220:223], v3 offset:7168
    v_mfma_f32_16x16x32_bf16 a[20:23], a[196:199], v[212:215], a[20:23]
    s_add_u32 s35, s35, 0x4000
    v_exp_f32 v235, v131
    v_mfma_f32_16x16x32_bf16 a[24:27], a[196:199], v[216:219], a[24:27]
    v_exp_f32 v236, v144
    v_cvt_pk_bf16_f32 v193, v234, v235
    v_mfma_f32_16x16x32_bf16 a[28:31], a[196:199], v[220:223], a[28:31]
    s_waitcnt lgkmcnt(4)
    buffer_load_dwordx4 v1, s[20:23], s33 offen offset:1024 sc1 lds
    ds_read_b128 a[128:131], v2 offset:0
    v_mfma_f32_16x16x32_bf16 a[44:47], a[200:203], v[220:223], a[44:47]
    v_add_u32 v3, s53, v56
    v_exp_f32 v237, v145
    v_mfma_f32_16x16x32_bf16 a[40:43], a[200:203], v[216:219], a[40:43]
    ds_read_b128 a[132:135], v2 offset:1024
    v_cvt_pk_bf16_f32 v194, v236, v237
    v_mfma_f32_16x16x32_bf16 a[36:39], a[200:203], v[212:215], a[36:39]
    ds_read_b128 a[136:139], v2 offset:2048
    v_exp_f32 v238, v146
    v_mfma_f32_16x16x32_bf16 a[52:55], a[204:207], v[212:215], a[52:55]
    s_and_b32 s35, s35, 0xffff
    v_exp_f32 v239, v147
    v_mfma_f32_16x16x32_bf16 a[56:59], a[204:207], v[216:219], a[56:59]
    ds_read_b128 a[140:143], v2 offset:3072
    v_or3_b32 v57, v192, v193, v194
    v_mfma_f32_16x16x32_bf16 a[60:63], a[204:207], v[220:223], a[60:63]
    s_waitcnt lgkmcnt(6)
    v_exp_f32 v240, v132
    v_mfma_f32_16x16x32_bf16 a[76:79], a[208:211], v[220:223], a[76:79]
    s_or_b32 s35, s35, 0x10000
    buffer_load_dwordx4 v1, s[20:23], s33 offen offset:2048 sc1 lds
    ds_read_b128 a[144:147], v2 offset:4096
    v_mfma_f32_16x16x32_bf16 a[72:75], a[208:211], v[216:219], a[72:75]
    v_cvt_pk_bf16_f32 v195, v238, v239
    v_exp_f32 v241, v133
    v_mfma_f32_16x16x32_bf16 a[68:71], a[208:211], v[212:215], a[68:71]
    v_exp_f32 v242, v134
    v_mfma_f32_16x16x32_bf16 a[84:87], a[212:215], v[212:215], a[84:87]
    ds_read_b128 a[148:151], v2 offset:5120
    v_cvt_pk_bf16_f32 v196, v240, v241
    v_mfma_f32_16x16x32_bf16 a[88:91], a[212:215], v[216:219], a[88:91]
    v_exp_f32 v243, v135
    v_mfma_f32_16x16x32_bf16 a[92:95], a[212:215], v[220:223], a[92:95]
    s_waitcnt lgkmcnt(6)
    ds_read_b128 a[152:155], v2 offset:6144
    v_or3_b32 v57, v57, v195, v196
    v_cvt_pk_bf16_f32 v197, v242, v243
    v_mfma_f32_16x16x32_bf16 a[108:111], a[216:219], v[220:223], a[108:111]
    buffer_load_dwordx4 v1, s[20:23], s33 offen offset:3072 sc1 lds
    ds_read_b128 a[156:159], v2 offset:7168
    v_mfma_f32_16x16x32_bf16 a[104:107], a[216:219], v[216:219], a[104:107]
    s_add_u32 s33, s33, 0x80000
    v_exp_f32 v244, v148
    v_mfma_f32_16x16x32_bf16 a[100:103], a[216:219], v[212:215], a[100:103]
    v_exp_f32 v245, v149
    v_mfma_f32_16x16x32_bf16 a[116:119], a[220:223], v[212:215], a[116:119]
    ds_read_b128 a[160:163], v2 offset:8192
    s_cmp_ge_u32 s36, s43
    s_cbranch_scc1 k2_prep_106
k2_prepret_107:
    v_mfma_f32_16x16x32_bf16 a[120:123], a[220:223], v[216:219], a[120:123]
    v_exp_f32 v246, v150
    v_mfma_f32_16x16x32_bf16 a[124:127], a[220:223], v[220:223], a[124:127]
    s_waitcnt lgkmcnt(7)
    ds_read_b128 a[164:167], v2 offset:9216
    v_cvt_pk_bf16_f32 v198, v244, v245
    v_mfma_f32_16x16x32_bf16 v[160:163], a[128:131], v[96:99], v[16:19]
    s_waitcnt vmcnt(12)
    s_barrier
    v_exp_f32 v247, v151
    v_mfma_f32_16x16x32_bf16 v[160:163], a[132:135], v[100:103], v[160:163]
    s_waitcnt lgkmcnt(6)
    v_or3_b32 v57, v57, v197, v198
    v_cvt_pk_bf16_f32 v199, v246, v247
    v_mfma_f32_16x16x32_bf16 v[160:163], a[136:139], v[104:107], v[160:163]
    s_mov_b32 m0, s34
    ds_read_b128 a[168:171], v2 offset:10240
    v_exp_f32 v232, v136
    v_mfma_f32_16x16x32_bf16 v[160:163], a[140:143], v[108:111], v[160:163]
    s_add_u32 s36, s36, 64
    buffer_load_dwordx4 v1, s[16:19], s32 offen offset:0 sc1 lds
    ds_read_b128 a[172:175], v2 offset:11264
    v_mfma_f32_16x16x32_bf16 v[164:167], a[140:143], v[124:127], v[20:23]
    v_exp_f32 v233, v137
    v_mfma_f32_16x16x32_bf16 v[164:167], a[136:139], v[120:123], v[164:167]
    v_exp_f32 v234, v138
    v_mfma_f32_16x16x32_bf16 v[164:167], a[132:135], v[116:119], v[164:167]
    s_add_u32 s52, s52, 16384
    ds_read_b128 a[176:179], v2 offset:12288
    v_cvt_pk_bf16_f32 v200, v232, v233
    v_mfma_f32_16x16x32_bf16 v[164:167], a[128:131], v[112:115], v[164:167]
    s_waitcnt lgkmcnt(7)
    v_exp_f32 v235, v139
    v_or3_b32 v57, v57, v199, v200
    v_mfma_f32_16x16x32_bf16 v[180:183], a[144:147], v[112:115], v[36:39]
    s_add_u32 s34, s34, 0x4000
    ds_read_b128 a[180:183], v2 offset:13312
    v_cvt_pk_bf16_f32 v201, v234, v235
    v_mfma_f32_16x16x32_bf16 v[180:183], a[148:151], v[116:119], v[180:183]
    s_waitcnt lgkmcnt(6)
    v_exp_f32 v236, v152
    v_mfma_f32_16x16x32_bf16 v[180:183], a[152:155], v[120:123], v[180:183]
    s_and_b32 s52, s52, 0xffff
    buffer_load_dwordx4 v1, s[16:19], s32 offen offset:1024 sc1 lds
    ds_read_b128 a[184:187], v2 offset:14336
    v_mfma_f32_16x16x32_bf16 v[180:183], a[156:159], v[124:127], v[180:183]
    ds_read_b128 a[188:191], v2 offset:15360
    v_exp_f32 v237, v153
    v_mfma_f32_16x16x32_bf16 v[176:179], a[156:159], v[108:111], v[32:35]
    v_exp_f32 v238, v154
    v_mfma_f32_16x16x32_bf16 v[176:179], a[152:155], v[104:107], v[176:179]
    v_cvt_pk_bf16_f32 v202, v236, v237
    v_or3_b32 v57, v57, v201, v202
    v_mfma_f32_16x16x32_bf16 v[176:179], a[148:151], v[100:103], v[176:179]
    s_and_b32 s34, s34, 0xffff
    v_exp_f32 v239, v155
    v_mfma_f32_16x16x32_bf16 v[176:179], a[144:147], v[96:99], v[176:179]
    s_waitcnt lgkmcnt(6)
    v_add_u32 v2, s52, v1
    v_cvt_pk_bf16_f32 v203, v238, v239
    v_mfma_f32_16x16x32_bf16 v[168:171], a[160:163], v[96:99], v[24:27]
    ds_read_b128 a[192:195], v3 offset:0
    v_exp_f32 v240, v140
    v_mfma_f32_16x16x32_bf16 v[168:171], a[164:167], v[100:103], v[168:171]
    s_waitcnt lgkmcnt(5)
    v_exp_f32 v241, v141
    v_mfma_f32_16x16x32_bf16 v[168:171], a[168:171], v[104:107], v[168:171]
    buffer_load_dwordx4 v1, s[16:19], s32 offen offset:2048 sc1 lds
    ds_read_b128 a[196:199], v3 offset:8192
    v_mfma_f32_16x16x32_bf16 v[168:171], a[172:175], v[108:111], v[168:171]
    v_exp_f32 v242, v142
    v_mfma_f32_16x16x32_bf16 v[172:175], a[172:175], v[124:127], v[28:31]
    ds_read_b128 a[200:203], v3 offset:1024
    v_cvt_pk_bf16_f32 v204, v240, v241
    v_or3_b32 v57, v57, v203, v204
    v_mfma_f32_16x16x32_bf16 v[172:175], a[168:171], v[120:123], v[172:175]
    v_exp_f32 v243, v143
    v_mfma_f32_16x16x32_bf16 v[172:175], a[164:167], v[116:119], v[172:175]
    ds_read_b128 a[204:207], v3 offset:9216
    v_cvt_pk_bf16_f32 v205, v242, v243
    v_mfma_f32_16x16x32_bf16 v[172:175], a[160:163], v[112:115], v[172:175]
    s_waitcnt lgkmcnt(6)
    v_exp_f32 v244, v156
    v_mfma_f32_16x16x32_bf16 v[188:191], a[176:179], v[112:115], v[44:47]
    v_exp_f32 v245, v157
    v_mfma_f32_16x16x32_bf16 v[188:191], a[180:183], v[116:119], v[188:191]
    s_waitcnt lgkmcnt(4)
    buffer_load_dwordx4 v1, s[16:19], s32 offen offset:3072 sc1 lds
    ds_read_b128 a[208:211], v3 offset:2048
    ds_read_b128 a[212:215], v3 offset:10240
    v_mfma_f32_16x16x32_bf16 v[188:191], a[184:187], v[120:123], v[188:191]
    s_add_u32 s32, s32, 0x80000
    v_exp_f32 v246, v158
    v_mfma_f32_16x16x32_bf16 v[188:191], a[188:191], v[124:127], v[188:191]
    v_cvt_pk_bf16_f32 v206, v244, v245
    v_or3_b32 v57, v57, v205, v206
    v_mfma_f32_16x16x32_bf16 v[184:187], a[188:191], v[108:111], v[40:43]
    v_exp_f32 v247, v159
    v_mfma_f32_16x16x32_bf16 v[184:187], a[184:187], v[104:107], v[184:187]
    ds_read_b128 a[216:219], v3 offset:3072
    ds_read_b128 a[220:223], v3 offset:11264
    v_cvt_pk_bf16_f32 v207, v246, v247
    v_mfma_f32_16x16x32_bf16 v[184:187], a[180:183], v[100:103], v[184:187]
    v_bitop3_b32 v57, v57, v207, s37 bitop3:0xa8
    v_cmp_ne_u32 vcc, 0, v57
    v_mfma_f32_16x16x32_bf16 v[184:187], a[176:179], v[96:99], v[184:187]
    s_cbranch_vccnz k2_tramp_108
k2_ret_109:
    s_load_dwordx2 s[4:5], s[0:1], 40
    s_add_u32 s24, s6, 0x3000000
    s_addc_u32 s25, s7, 0
    s_and_b32 s25, s25, 0xffff
    s_mov_b32 s26, 0x1000000
    s_mov_b32 s27, 0x00020000
    s_lshl_b32 s31, s28, 19
    s_lshl_b32 s44, s38, 6
    s_add_u32 s44, s44, s31
    s_add_u32 s45, s44, 131072
    s_add_u32 s46, s44, 262144
    s_add_u32 s47, s44, 393216
    s_add_u32 s48, s44, 4096
    s_add_u32 s49, s44, 135168
    s_add_u32 s50, s44, 266240
    s_add_u32 s51, s44, 397312
    v_mov_b32 v13, v12
    v_mov_b32 v49, v48
    s_nop 1
    v_permlane16_swap_b32 v12, v13
    v_permlane16_swap_b32 v48, v49
    s_nop 1
    v_add_f32 v12, v12, v13
    v_add_f32 v48, v48, v49
    v_mov_b32 v13, v12
    v_mov_b32 v49, v48
    s_nop 1
    v_permlane32_swap_b32 v12, v13
    v_permlane32_swap_b32 v48, v49
    s_nop 1
    v_add_f32 v12, v12, v13
    v_add_f32 v48, v48, v49
    v_rcp_f32 v13, v12
    v_rcp_f32 v49, v48
    v_rcp_f32 v12, v12
    v_rcp_f32 v48, v48
    s_nop 0
    v_accvgpr_read_b32 v68, a0
    v_accvgpr_read_b32 v69, a1
    v_accvgpr_read_b32 v70, a2
    v_accvgpr_read_b32 v71, a3
    v_accvgpr_read_b32 v72, a16
    v_accvgpr_read_b32 v73, a17
    v_accvgpr_read_b32 v74, a18
    v_accvgpr_read_b32 v75, a19
    v_pk_mul_f32 v[68:69], v[68:69], v[12:13]
    v_pk_mul_f32 v[70:71], v[70:71], v[12:13]
    v_pk_mul_f32 v[72:73], v[72:73], v[12:13]
    v_pk_mul_f32 v[74:75], v[74:75], v[12:13]
    v_cvt_pk_bf16_f32 v64, v68, v69
    v_cvt_pk_bf16_f32 v65, v70, v71
    v_cvt_pk_bf16_f32 v66, v72, v73
    v_cvt_pk_bf16_f32 v67, v74, v75
    buffer_store_dwordx4 v[64:67], v1, s[24:27], s44 offen sc1
    v_accvgpr_read_b32 v80, a32
    v_accvgpr_read_b32 v81, a33
    v_accvgpr_read_b32 v82, a34
    v_accvgpr_read_b32 v83, a35
    v_accvgpr_read_b32 v84, a48
    v_accvgpr_read_b32 v85, a49
    v_accvgpr_read_b32 v86, a50
    v_accvgpr_read_b32 v87, a51
    v_pk_mul_f32 v[80:81], v[80:81], v[12:13]
    v_pk_mul_f32 v[82:83], v[82:83], v[12:13]
    v_pk_mul_f32 v[84:85], v[84:85], v[12:13]
    v_pk_mul_f32 v[86:87], v[86:87], v[12:13]
    v_cvt_pk_bf16_f32 v76, v80, v81
    v_cvt_pk_bf16_f32 v77, v82, v83
    v_cvt_pk_bf16_f32 v78, v84, v85
    v_cvt_pk_bf16_f32 v79, v86, v87
    buffer_store_dwordx4 v[76:79], v1, s[24:27], s45 offen sc1
    v_accvgpr_read_b32 v68, a64
    v_accvgpr_read_b32 v69, a65
    v_accvgpr_read_b32 v70, a66
    v_accvgpr_read_b32 v71, a67
    v_accvgpr_read_b32 v72, a80
    v_accvgpr_read_b32 v73, a81
    v_accvgpr_read_b32 v74, a82
    v_accvgpr_read_b32 v75, a83
    v_pk_mul_f32 v[68:69], v[68:69], v[12:13]
    v_pk_mul_f32 v[70:71], v[70:71], v[12:13]
    v_pk_mul_f32 v[72:73], v[72:73], v[12:13]
    v_pk_mul_f32 v[74:75], v[74:75], v[12:13]
    v_cvt_pk_bf16_f32 v64, v68, v69
    v_cvt_pk_bf16_f32 v65, v70, v71
    v_cvt_pk_bf16_f32 v66, v72, v73
    v_cvt_pk_bf16_f32 v67, v74, v75
    buffer_store_dwordx4 v[64:67], v1, s[24:27], s46 offen sc1
    v_accvgpr_read_b32 v80, a96
    v_accvgpr_read_b32 v81, a97
    v_accvgpr_read_b32 v82, a98
    v_accvgpr_read_b32 v83, a99
    v_accvgpr_read_b32 v84, a112
    v_accvgpr_read_b32 v85, a113
    v_accvgpr_read_b32 v86, a114
    v_accvgpr_read_b32 v87, a115
    v_pk_mul_f32 v[80:81], v[80:81], v[12:13]
    v_pk_mul_f32 v[82:83], v[82:83], v[12:13]
    v_pk_mul_f32 v[84:85], v[84:85], v[12:13]
    v_pk_mul_f32 v[86:87], v[86:87], v[12:13]
    v_cvt_pk_bf16_f32 v76, v80, v81
    v_cvt_pk_bf16_f32 v77, v82, v83
    v_cvt_pk_bf16_f32 v78, v84, v85
    v_cvt_pk_bf16_f32 v79, v86, v87
    buffer_store_dwordx4 v[76:79], v1, s[24:27], s47 offen sc1
    v_accvgpr_read_b32 v68, a4
    v_accvgpr_read_b32 v69, a5
    v_accvgpr_read_b32 v70, a6
    v_accvgpr_read_b32 v71, a7
    v_accvgpr_read_b32 v72, a20
    v_accvgpr_read_b32 v73, a21
    v_accvgpr_read_b32 v74, a22
    v_accvgpr_read_b32 v75, a23
    v_pk_mul_f32 v[68:69], v[68:69], v[48:49]
    v_pk_mul_f32 v[70:71], v[70:71], v[48:49]
    v_pk_mul_f32 v[72:73], v[72:73], v[48:49]
    v_pk_mul_f32 v[74:75], v[74:75], v[48:49]
    v_cvt_pk_bf16_f32 v64, v68, v69
    v_cvt_pk_bf16_f32 v65, v70, v71
    v_cvt_pk_bf16_f32 v66, v72, v73
    v_cvt_pk_bf16_f32 v67, v74, v75
    buffer_store_dwordx4 v[64:67], v1, s[24:27], s48 offen sc1
    v_accvgpr_read_b32 v80, a36
    v_accvgpr_read_b32 v81, a37
    v_accvgpr_read_b32 v82, a38
    v_accvgpr_read_b32 v83, a39
    v_accvgpr_read_b32 v84, a52
    v_accvgpr_read_b32 v85, a53
    v_accvgpr_read_b32 v86, a54
    v_accvgpr_read_b32 v87, a55
    v_pk_mul_f32 v[80:81], v[80:81], v[48:49]
    v_pk_mul_f32 v[82:83], v[82:83], v[48:49]
    v_pk_mul_f32 v[84:85], v[84:85], v[48:49]
    v_pk_mul_f32 v[86:87], v[86:87], v[48:49]
    v_cvt_pk_bf16_f32 v76, v80, v81
    v_cvt_pk_bf16_f32 v77, v82, v83
    v_cvt_pk_bf16_f32 v78, v84, v85
    v_cvt_pk_bf16_f32 v79, v86, v87
    buffer_store_dwordx4 v[76:79], v1, s[24:27], s49 offen sc1
    v_accvgpr_read_b32 v68, a68
    v_accvgpr_read_b32 v69, a69
    v_accvgpr_read_b32 v70, a70
    v_accvgpr_read_b32 v71, a71
    v_accvgpr_read_b32 v72, a84
    v_accvgpr_read_b32 v73, a85
    v_accvgpr_read_b32 v74, a86
    v_accvgpr_read_b32 v75, a87
    v_pk_mul_f32 v[68:69], v[68:69], v[48:49]
    v_pk_mul_f32 v[70:71], v[70:71], v[48:49]
    v_pk_mul_f32 v[72:73], v[72:73], v[48:49]
    v_pk_mul_f32 v[74:75], v[74:75], v[48:49]
    v_cvt_pk_bf16_f32 v64, v68, v69
    v_cvt_pk_bf16_f32 v65, v70, v71
    v_cvt_pk_bf16_f32 v66, v72, v73
    v_cvt_pk_bf16_f32 v67, v74, v75
    buffer_store_dwordx4 v[64:67], v1, s[24:27], s50 offen sc1
    v_accvgpr_read_b32 v80, a100
    v_accvgpr_read_b32 v81, a101
    v_accvgpr_read_b32 v82, a102
    v_accvgpr_read_b32 v83, a103
    v_accvgpr_read_b32 v84, a116
    v_accvgpr_read_b32 v85, a117
    v_accvgpr_read_b32 v86, a118
    v_accvgpr_read_b32 v87, a119
    v_pk_mul_f32 v[80:81], v[80:81], v[48:49]
    v_pk_mul_f32 v[82:83], v[82:83], v[48:49]
    v_pk_mul_f32 v[84:85], v[84:85], v[48:49]
    v_pk_mul_f32 v[86:87], v[86:87], v[48:49]
    v_cvt_pk_bf16_f32 v76, v80, v81
    v_cvt_pk_bf16_f32 v77, v82, v83
    v_cvt_pk_bf16_f32 v78, v84, v85
    v_cvt_pk_bf16_f32 v79, v86, v87
    buffer_store_dwordx4 v[76:79], v1, s[24:27], s51 offen sc1
    s_nop 1
    s_lshr_b32 s31, s2, 3
    s_bfe_u32 s56, s2, 0x10002
    s_and_b32 s54, s2, 1
    s_and_b32 s55, s31, 7
    s_lshl_b32 s54, s54, 3
    s_add_u32 s54, s54, s55
    s_and_b32 s55, s2, 2
    s_lshl_b32 s55, s55, 1
    s_lshr_b32 s31, s31, 3
    s_add_u32 s55, s55, s31
    v_lshrrev_b32 v87, 4, v1
    v_lshrrev_b32 v72, 4, v87
    s_lshl_b32 s57, s54, 7
    s_lshl_b32 s31, s30, 5
    s_add_u32 s57, s57, s31
    s_lshl_b32 s31, s57, 6
    v_add_u32 v88, s31, v1
    v_add_u32 v89, 0x20000, v88
    v_bfe_u32 v84, v87, 1, 3
    v_xor_b32 v84, v84, v72
    v_and_b32 v85, 16, v1
    v_lshl_add_u32 v85, v72, 11, v85
    s_lshl_b32 s31, s30, 15
    s_lshl_b32 s58, s55, 8
    s_add_u32 s31, s31, s58
    v_add_u32 v85, s31, v85
    v_xor_b32 v86, 0, v84
    v_lshl_add_u32 v86, v86, 5, v85
    v_add_u32 v90, 0, v86
    v_xor_b32 v86, 4, v84
    v_lshl_add_u32 v86, v86, 5, v85
    v_add_u32 v91, 7168, v86
    v_xor_b32 v86, 0, v84
    v_lshl_add_u32 v86, v86, 5, v85
    v_add_u32 v92, 14336, v86
    v_xor_b32 v86, 4, v84
    v_lshl_add_u32 v86, v86, 5, v85
    v_add_u32 v93, 21504, v86
    v_and_b32 v84, 15, v87
    v_add_u32 v85, s57, v84
    v_lshlrev_b32 v77, 2, v85
    v_lshl_add_u32 v77, v72, 13, v77
    s_lshl_b32 s31, s56, 7
    s_add_u32 s58, s58, s31
    v_lshl_add_u32 v80, v72, 3, s58
    v_lshl_add_u32 v78, v85, 11, v80
    v_add_u32 v79, 0x8000, v78
    v_lshrrev_b32 v85, 2, v84
    v_lshl_add_u32 v85, v72, 2, v85
    v_and_b32 v84, 7, v85
    s_lshl_b32 s31, s56, 2
    v_xor_b32 v84, s31, v84
    v_lshlrev_b32 v85, 8, v85
    v_and_b32 v86, 3, v87
    v_lshl_add_u32 v85, v86, 3, v85
    s_add_u32 s31, s2, 1
    s_and_b32 s31, s31, 3
    v_add_u32 v73, s31, v86
    v_and_b32 v73, 3, v73
    v_lshlrev_b32 v73, 7, v73
    v_xor_b32 v86, 0, v84
    v_lshl_add_u32 v64, v86, 5, v85
    v_xor_b32 v86, 1, v84
    v_lshl_add_u32 v65, v86, 5, v85
    v_xor_b32 v86, 2, v84
    v_lshl_add_u32 v66, v86, 5, v85
    v_xor_b32 v86, 3, v84
    v_lshl_add_u32 v67, v86, 5, v85
    v_xor_b32 v86, 4, v84
    v_lshl_add_u32 v68, v86, 5, v85
    v_xor_b32 v86, 5, v84
    v_lshl_add_u32 v69, v86, 5, v85
    v_xor_b32 v86, 6, v84
    v_lshl_add_u32 v70, v86, 5, v85
    v_xor_b32 v86, 7, v84
    v_lshl_add_u32 v71, v86, 5, v85
    s_lshl_b32 s61, s31, 20
    s_lshl_b32 s62, s31, 21
    s_lshl_b32 s60, s30, 12
    s_lshl_b32 s59, s54, 10
    s_lshl_b32 s31, s56, 9
    s_add_u32 s59, s59, s31
    s_lshr_b32 s31, s28, 2
    s_lshl_b32 s31, s31, 7
    s_lshl_b32 s57, s29, 10
    s_sub_u32 s58, 0x3c00, s57
    s_add_u32 s57, s57, s31
    s_add_u32 s58, s58, s31
    v_mov_b32 v75, 0
    v_mov_b32 v76, 1
    s_lshl_b32 s31, s56, 23
    s_add_u32 s31, s31, 0x3000000
    s_add_u32 s8, s6, s31
    s_addc_u32 s9, s7, 0
    s_and_b32 s9, s9, 0xffff
    s_mov_b32 s10, 0x800000
    s_lshl_b32 s31, s56, 22
    s_waitcnt lgkmcnt(0)
    s_add_u32 s12, s4, s31
    s_addc_u32 s13, s5, 0
    s_and_b32 s13, s13, 0xffff
    s_mov_b32 s14, 0x400000
    s_load_dwordx2 s[4:5], s[0:1], 80
    v_mov_b32 v12, -1
    v_mov_b32 v13, -1
    v_mov_b32 v14, -1
    v_mov_b32 v15, -1
    s_waitcnt lgkmcnt(0)
    s_mov_b32 s26, -1
    s_lshl_b32 s31, s2, 14
    s_add_u32 s31, s31, s60
    s_add_u32 s40, s31, 0x2000000
    buffer_store_dwordx4 v[12:15], v1, s[24:27], s40 offen offset:0 sc1
    buffer_store_dwordx4 v[12:15], v1, s[24:27], s40 offen offset:1024 sc1
    buffer_store_dwordx4 v[12:15], v1, s[24:27], s40 offen offset:2048 sc1
    buffer_store_dwordx4 v[12:15], v1, s[24:27], s40 offen offset:3072 sc1
    s_lshr_b32 s31, s31, 1
    s_add_u32 s40, s31, 0x1900000
    buffer_store_dwordx4 v[12:15], v1, s[24:27], s40 offen offset:0 sc1
    buffer_store_dwordx4 v[12:15], v1, s[24:27], s40 offen offset:1024 sc1
    s_mov_b32 s26, 0x1000000
    s_and_b32 s31, s2, 7
    s_mul_i32 s31, s31, 28
    s_lshr_b32 s40, s2, 3
    s_add_u32 s31, s31, s40
    s_lshl_b32 s31, s31, 15
    s_lshl_b32 s40, s30, 13
    s_add_u32 s31, s31, s40
    s_mov_b32 s44, s4
    s_mov_b32 s47, 0x00020000
    s_and_b32 s45, s5, 0xffff
    s_cmp_ge_u32 s2, 224
    s_cselect_b32 s46, 0, 7340032
    s_add_u32 m0, s40, 131072
    s_nop 0
    buffer_load_dwordx4 v1, s[44:47], s31 offen offset:0 lds
    buffer_load_dwordx4 v1, s[44:47], s31 offen offset:1024 lds
    buffer_load_dwordx4 v1, s[44:47], s31 offen offset:2048 lds
    buffer_load_dwordx4 v1, s[44:47], s31 offen offset:3072 lds
    s_add_u32 s31, s31, 4096
    s_add_u32 m0, s40, 135168
    s_nop 0
    buffer_load_dwordx4 v1, s[44:47], s31 offen offset:0 lds
    buffer_load_dwordx4 v1, s[44:47], s31 offen offset:1024 lds
    buffer_load_dwordx4 v1, s[44:47], s31 offen offset:2048 lds
    buffer_load_dwordx4 v1, s[44:47], s31 offen offset:3072 lds
    s_add_u32 s31, s31, 4096
    s_lshl_b32 s63, s29, 1
    s_sub_u32 s63, 13, s63
    s_cbranch_scc1 k2_sdone_111
k2_sloop_110:
    v_mfma_f32_16x16x32_bf16 v[248:251], v[60:63], v[192:195], v[248:251]
    v_exp_f32 v232, v160
    v_mfma_f32_16x16x32_bf16 v[248:251], v[60:63], v[200:203], v[248:251]
    s_mov_b32 m0, s35
    ds_read_b128 a[224:227], v3 offset:4096
    v_mfma_f32_16x16x32_bf16 v[252:255], v[60:63], v[204:207], v[252:255]
    s_add_u32 s53, s53, 16384
    buffer_load_dwordx4 v1, s[20:23], s33 offen offset:0 sc1 lds
    ds_read_b128 a[228:231], v3 offset:12288
    v_mfma_f32_16x16x32_bf16 v[252:255], v[60:63], v[196:199], v[252:255]
    s_waitcnt lgkmcnt(8)
    v_exp_f32 v233, v161
    v_mfma_f32_16x16x32_bf16 a[12:15], a[192:195], v[196:199], a[12:15]
    s_and_b32 s53, s53, 0xffff
    v_exp_f32 v234, v162
    v_mfma_f32_16x16x32_bf16 a[12:15], a[196:199], v[204:207], a[12:15]
    ds_read_b128 a[232:235], v3 offset:5120
    v_cvt_pk_bf16_f32 v208, v232, v233
    v_mfma_f32_16x16x32_bf16 a[8:11], a[196:199], v[200:203], a[8:11]
    v_exp_f32 v235, v163
    v_mfma_f32_16x16x32_bf16 a[8:11], a[192:195], v[192:195], a[8:11]
    s_waitcnt lgkmcnt(7)
    ds_read_b128 a[236:239], v3 offset:13312
    v_cvt_pk_bf16_f32 v209, v234, v235
    v_mfma_f32_16x16x32_bf16 a[24:27], a[200:203], v[192:195], a[24:27]
    s_add_u32 s35, s35, 0x4000
    v_exp_f32 v236, v176
    v_mfma_f32_16x16x32_bf16 a[24:27], a[204:207], v[200:203], a[24:27]
    buffer_load_dwordx4 v1, s[20:23], s33 offen offset:1024 sc1 lds
    ds_read_b128 a[240:243], v3 offset:6144
    v_mfma_f32_16x16x32_bf16 a[28:31], a[204:207], v[204:207], a[28:31]
    v_exp_f32 v237, v177
    v_mfma_f32_16x16x32_bf16 a[28:31], a[200:203], v[196:199], a[28:31]
    s_waitcnt lgkmcnt(7)
    ds_read_b128 a[244:247], v3 offset:14336
    v_cvt_pk_bf16_f32 v210, v236, v237
    v_mfma_f32_16x16x32_bf16 a[44:47], a[208:211], v[196:199], a[44:47]
    v_exp_f32 v238, v178
    v_mfma_f32_16x16x32_bf16 a[44:47], a[212:215], v[204:207], a[44:47]
    ds_read_b128 a[248:251], v3 offset:7168
    v_or3_b32 v57, v208, v209, v210
    v_mfma_f32_16x16x32_bf16 a[40:43], a[212:215], v[200:203], a[40:43]
    v_exp_f32 v239, v179
    v_mfma_f32_16x16x32_bf16 a[40:43], a[208:211], v[192:195], a[40:43]
    s_waitcnt lgkmcnt(7)
    ds_read_b128 a[252:255], v3 offset:15360
    v_cvt_pk_bf16_f32 v211, v238, v239
    v_mfma_f32_16x16x32_bf16 a[56:59], a[216:219], v[192:195], a[56:59]
    s_and_b32 s35, s35, 0xffff
    v_exp_f32 v240, v164
    v_mfma_f32_16x16x32_bf16 a[56:59], a[220:223], v[200:203], a[56:59]
    ds_read_b128 a[128:131], v2 offset:0
    v_add_u32 v3, s53, v56
    v_mfma_f32_16x16x32_bf16 a[60:63], a[220:223], v[204:207], a[60:63]
    v_exp_f32 v241, v165
    v_mfma_f32_16x16x32_bf16 a[60:63], a[216:219], v[196:199], a[60:63]
    s_waitcnt lgkmcnt(7)
    buffer_load_dwordx4 v1, s[20:23], s33 offen offset:2048 sc1 lds
    ds_read_b128 a[132:135], v2 offset:1024
    v_mfma_f32_16x16x32_bf16 a[76:79], a[224:227], v[196:199], a[76:79]
    v_exp_f32 v242, v166
    v_mfma_f32_16x16x32_bf16 a[76:79], a[228:231], v[204:207], a[76:79]
    s_or_b32 s35, s35, 0x10000
    ds_read_b128 a[136:139], v2 offset:2048
    v_cvt_pk_bf16_f32 v212, v240, v241
    v_mfma_f32_16x16x32_bf16 a[72:75], a[228:231], v[200:203], a[72:75]
    v_exp_f32 v243, v167
    v_mfma_f32_16x16x32_bf16 a[72:75], a[224:227], v[192:195], a[72:75]
    s_waitcnt lgkmcnt(7)
    ds_read_b128 a[140:143], v2 offset:3072
    v_or3_b32 v57, v57, v211, v212
    v_mfma_f32_16x16x32_bf16 a[88:91], a[232:235], v[192:195], a[88:91]
    v_exp_f32 v244, v180
    v_mfma_f32_16x16x32_bf16 a[88:91], a[236:239], v[200:203], a[88:91]
    ds_read_b128 a[144:147], v2 offset:4096
    v_cvt_pk_bf16_f32 v213, v242, v243
    v_mfma_f32_16x16x32_bf16 a[92:95], a[236:239], v[204:207], a[92:95]
    v_exp_f32 v245, v181
    v_mfma_f32_16x16x32_bf16 a[92:95], a[232:235], v[196:199], a[92:95]
    s_waitcnt lgkmcnt(7)
    buffer_load_dwordx4 v1, s[20:23], s33 offen offset:3072 sc1 lds
    ds_read_b128 a[148:151], v2 offset:5120
    v_mfma_f32_16x16x32_bf16 a[108:111], a[240:243], v[196:199], a[108:111]
    s_add_u32 s33, s33, 0x80000
    v_exp_f32 v246, v182
    v_mfma_f32_16x16x32_bf16 a[108:111], a[244:247], v[204:207], a[108:111]
    ds_read_b128 a[152:155], v2 offset:6144
    v_cvt_pk_bf16_f32 v214, v244, v245
    v_mfma_f32_16x16x32_bf16 a[104:107], a[244:247], v[200:203], a[104:107]
    v_exp_f32 v247, v183
    v_mfma_f32_16x16x32_bf16 a[104:107], a[240:243], v[192:195], a[104:107]
    s_waitcnt lgkmcnt(7)
    ds_read_b128 a[156:159], v2 offset:7168
    v_or3_b32 v57, v57, v213, v214
    v_mfma_f32_16x16x32_bf16 a[120:123], a[248:251], v[192:195], a[120:123]
    v_exp_f32 v232, v168
    v_mfma_f32_16x16x32_bf16 a[120:123], a[252:255], v[200:203], a[120:123]
    ds_read_b128 a[160:163], v2 offset:8192
    v_cvt_pk_bf16_f32 v215, v246, v247
    v_mfma_f32_16x16x32_bf16 a[124:127], a[252:255], v[204:207], a[124:127]
    v_exp_f32 v233, v169
    v_mfma_f32_16x16x32_bf16 a[124:127], a[248:251], v[196:199], a[124:127]
    s_waitcnt lgkmcnt(7)
    ds_read_b128 a[164:167], v2 offset:9216
    v_cvt_pk_bf16_f32 v216, v232, v233
    v_mfma_f32_16x16x32_bf16 v[128:131], a[128:131], v[96:99], v[16:19]
    s_waitcnt vmcnt(12)
    s_barrier
    v_exp_f32 v234, v170
    v_mfma_f32_16x16x32_bf16 v[128:131], a[132:135], v[100:103], v[128:131]
    s_waitcnt lgkmcnt(6)
    ds_read_b128 a[168:171], v2 offset:10240
    v_or3_b32 v57, v57, v215, v216
    v_mfma_f32_16x16x32_bf16 v[128:131], a[136:139], v[104:107], v[128:131]
    s_mov_b32 m0, s34
    v_exp_f32 v235, v171
    v_mfma_f32_16x16x32_bf16 v[128:131], a[140:143], v[108:111], v[128:131]
    s_add_u32 s36, s36, 64
    buffer_load_dwordx4 v1, s[16:19], s32 offen offset:0 sc1 lds
    ds_read_b128 a[172:175], v2 offset:11264
    v_mfma_f32_16x16x32_bf16 v[132:135], a[140:143], v[124:127], v[20:23]
    v_exp_f32 v236, v184
    v_mfma_f32_16x16x32_bf16 v[132:135], a[136:139], v[120:123], v[132:135]
    ds_read_b128 a[176:179], v2 offset:12288
    v_cvt_pk_bf16_f32 v217, v234, v235
    v_mfma_f32_16x16x32_bf16 v[132:135], a[132:135], v[116:119], v[132:135]
    s_add_u32 s52, s52, 16384
    v_exp_f32 v237, v185
    v_mfma_f32_16x16x32_bf16 v[132:135], a[128:131], v[112:115], v[132:135]
    s_waitcnt lgkmcnt(7)
    ds_read_b128 a[180:183], v2 offset:13312
    v_cvt_pk_bf16_f32 v218, v236, v237
    v_mfma_f32_16x16x32_bf16 v[148:151], a[144:147], v[112:115], v[36:39]
    s_add_u32 s34, s34, 0x4000
    v_exp_f32 v238, v186
    v_mfma_f32_16x16x32_bf16 v[148:151], a[148:151], v[116:119], v[148:151]
    s_waitcnt lgkmcnt(6)
    buffer_load_dwordx4 v1, s[16:19], s32 offen offset:1024 sc1 lds
    ds_read_b128 a[184:187], v2 offset:14336
    v_mfma_f32_16x16x32_bf16 v[148:151], a[152:155], v[120:123], v[148:151]
    s_and_b32 s52, s52, 0xffff
    v_exp_f32 v239, v187
    v_mfma_f32_16x16x32_bf16 v[148:151], a[156:159], v[124:127], v[148:151]
    ds_read_b128 a[188:191], v2 offset:15360
    v_or3_b32 v57, v57, v217, v218
    v_mfma_f32_16x16x32_bf16 v[144:147], a[156:159], v[108:111], v[32:35]
    v_exp_f32 v240, v172
    v_mfma_f32_16x16x32_bf16 v[144:147], a[152:155], v[104:107], v[144:147]
    v_cvt_pk_bf16_f32 v219, v238, v239
    v_add_u32 v2, s52, v1
    v_mfma_f32_16x16x32_bf16 v[144:147], a[148:151], v[100:103], v[144:147]
    s_and_b32 s34, s34, 0xffff
    v_exp_f32 v241, v173
    v_mfma_f32_16x16x32_bf16 v[144:147], a[144:147], v[96:99], v[144:147]
    s_waitcnt lgkmcnt(6)
    ds_read_b128 a[192:195], v3 offset:0
    v_cvt_pk_bf16_f32 v220, v240, v241
    v_mfma_f32_16x16x32_bf16 v[136:139], a[160:163], v[96:99], v[24:27]
    v_exp_f32 v242, v174
    v_mfma_f32_16x16x32_bf16 v[136:139], a[164:167], v[100:103], v[136:139]
    s_waitcnt lgkmcnt(5)
    buffer_load_dwordx4 v1, s[16:19], s32 offen offset:2048 sc1 lds
    ds_read_b128 a[196:199], v3 offset:8192
    v_mfma_f32_16x16x32_bf16 v[136:139], a[168:171], v[104:107], v[136:139]
    v_exp_f32 v243, v175
    v_mfma_f32_16x16x32_bf16 v[136:139], a[172:175], v[108:111], v[136:139]
    ds_read_b128 a[200:203], v3 offset:1024
    v_or3_b32 v57, v57, v219, v220
    v_mfma_f32_16x16x32_bf16 v[140:143], a[172:175], v[124:127], v[28:31]
    v_exp_f32 v244, v188
    v_mfma_f32_16x16x32_bf16 v[140:143], a[168:171], v[120:123], v[140:143]
    ds_read_b128 a[204:207], v3 offset:9216
    v_cvt_pk_bf16_f32 v221, v242, v243
    v_mfma_f32_16x16x32_bf16 v[140:143], a[164:167], v[116:119], v[140:143]
    v_exp_f32 v245, v189
    v_mfma_f32_16x16x32_bf16 v[140:143], a[160:163], v[112:115], v[140:143]
    s_waitcnt lgkmcnt(6)
    buffer_load_dwordx4 v1, s[16:19], s32 offen offset:3072 sc1 lds
    ds_read_b128 a[208:211], v3 offset:2048
    v_mfma_f32_16x16x32_bf16 v[156:159], a[176:179], v[112:115], v[44:47]
    s_add_u32 s32, s32, 0x80000
    v_exp_f32 v246, v190
    v_mfma_f32_16x16x32_bf16 v[156:159], a[180:183], v[116:119], v[156:159]
    s_waitcnt lgkmcnt(5)
    ds_read_b128 a[212:215], v3 offset:10240
    v_cvt_pk_bf16_f32 v222, v244, v245
    v_mfma_f32_16x16x32_bf16 v[156:159], a[184:187], v[120:123], v[156:159]
    v_exp_f32 v247, v191
    v_mfma_f32_16x16x32_bf16 v[156:159], a[188:191], v[124:127], v[156:159]
    ds_read_b128 a[216:219], v3 offset:3072
    v_or3_b32 v57, v57, v221, v222
    v_mfma_f32_16x16x32_bf16 v[152:155], a[188:191], v[108:111], v[40:43]
    ds_read_b128 a[220:223], v3 offset:11264
    v_cvt_pk_bf16_f32 v223, v246, v247
    v_mfma_f32_16x16x32_bf16 v[152:155], a[184:187], v[104:107], v[152:155]
    v_bitop3_b32 v57, v57, v223, s37 bitop3:0xa8
    v_cmp_ne_u32 vcc, 0, v57
    v_mfma_f32_16x16x32_bf16 v[152:155], a[180:183], v[100:103], v[152:155]
    v_mfma_f32_16x16x32_bf16 v[152:155], a[176:179], v[96:99], v[152:155]
    s_cbranch_vccnz k2_tramp_112
k2_ret_113:
    v_mfma_f32_16x16x32_bf16 v[248:251], v[60:63], v[208:211], v[248:251]
    v_exp_f32 v232, v128
    v_mfma_f32_16x16x32_bf16 v[248:251], v[60:63], v[216:219], v[248:251]
    s_mov_b32 m0, s35
    ds_read_b128 a[224:227], v3 offset:4096
    v_mfma_f32_16x16x32_bf16 v[252:255], v[60:63], v[220:223], v[252:255]
    s_add_u32 s53, s53, 16384
    buffer_load_dwordx4 v1, s[20:23], s33 offen offset:0 sc1 lds
    ds_read_b128 a[228:231], v3 offset:12288
    v_mfma_f32_16x16x32_bf16 v[252:255], v[60:63], v[212:215], v[252:255]
    s_waitcnt lgkmcnt(8)
    v_exp_f32 v233, v129
    v_mfma_f32_16x16x32_bf16 a[12:15], a[192:195], v[212:215], a[12:15]
    s_and_b32 s53, s53, 0xffff
    v_exp_f32 v234, v130
    v_mfma_f32_16x16x32_bf16 a[12:15], a[196:199], v[220:223], a[12:15]
    ds_read_b128 a[232:235], v3 offset:5120
    v_cvt_pk_bf16_f32 v192, v232, v233
    v_mfma_f32_16x16x32_bf16 a[8:11], a[196:199], v[216:219], a[8:11]
    v_exp_f32 v235, v131
    v_mfma_f32_16x16x32_bf16 a[8:11], a[192:195], v[208:211], a[8:11]
    s_waitcnt lgkmcnt(7)
    ds_read_b128 a[236:239], v3 offset:13312
    v_cvt_pk_bf16_f32 v193, v234, v235
    v_mfma_f32_16x16x32_bf16 a[24:27], a[200:203], v[208:211], a[24:27]
    s_add_u32 s35, s35, 0x4000
    v_exp_f32 v236, v144
    v_mfma_f32_16x16x32_bf16 a[24:27], a[204:207], v[216:219], a[24:27]
    buffer_load_dwordx4 v1, s[20:23], s33 offen offset:1024 sc1 lds
    ds_read_b128 a[240:243], v3 offset:6144
    v_mfma_f32_16x16x32_bf16 a[28:31], a[204:207], v[220:223], a[28:31]
    v_exp_f32 v237, v145
    v_mfma_f32_16x16x32_bf16 a[28:31], a[200:203], v[212:215], a[28:31]
    s_waitcnt lgkmcnt(7)
    ds_read_b128 a[244:247], v3 offset:14336
    v_cvt_pk_bf16_f32 v194, v236, v237
    v_mfma_f32_16x16x32_bf16 a[44:47], a[208:211], v[212:215], a[44:47]
    v_exp_f32 v238, v146
    v_mfma_f32_16x16x32_bf16 a[44:47], a[212:215], v[220:223], a[44:47]
    ds_read_b128 a[248:251], v3 offset:7168
    v_or3_b32 v57, v192, v193, v194
    v_mfma_f32_16x16x32_bf16 a[40:43], a[212:215], v[216:219], a[40:43]
    v_exp_f32 v239, v147
    v_mfma_f32_16x16x32_bf16 a[40:43], a[208:211], v[208:211], a[40:43]
    s_waitcnt lgkmcnt(7)
    ds_read_b128 a[252:255], v3 offset:15360
    v_cvt_pk_bf16_f32 v195, v238, v239
    v_mfma_f32_16x16x32_bf16 a[56:59], a[216:219], v[208:211], a[56:59]
    s_and_b32 s35, s35, 0xffff
    v_exp_f32 v240, v132
    v_mfma_f32_16x16x32_bf16 a[56:59], a[220:223], v[216:219], a[56:59]
    ds_read_b128 a[128:131], v2 offset:0
    v_add_u32 v3, s53, v56
    v_mfma_f32_16x16x32_bf16 a[60:63], a[220:223], v[220:223], a[60:63]
    v_exp_f32 v241, v133
    v_mfma_f32_16x16x32_bf16 a[60:63], a[216:219], v[212:215], a[60:63]
    s_waitcnt lgkmcnt(7)
    buffer_load_dwordx4 v1, s[20:23], s33 offen offset:2048 sc1 lds
    ds_read_b128 a[132:135], v2 offset:1024
    v_mfma_f32_16x16x32_bf16 a[76:79], a[224:227], v[212:215], a[76:79]
    v_exp_f32 v242, v134
    v_mfma_f32_16x16x32_bf16 a[76:79], a[228:231], v[220:223], a[76:79]
    s_or_b32 s35, s35, 0x10000
    ds_read_b128 a[136:139], v2 offset:2048
    v_cvt_pk_bf16_f32 v196, v240, v241
    v_mfma_f32_16x16x32_bf16 a[72:75], a[228:231], v[216:219], a[72:75]
    v_exp_f32 v243, v135
    v_mfma_f32_16x16x32_bf16 a[72:75], a[224:227], v[208:211], a[72:75]
    s_waitcnt lgkmcnt(7)
    ds_read_b128 a[140:143], v2 offset:3072
    v_or3_b32 v57, v57, v195, v196
    v_mfma_f32_16x16x32_bf16 a[88:91], a[232:235], v[208:211], a[88:91]
    v_exp_f32 v244, v148
    v_mfma_f32_16x16x32_bf16 a[88:91], a[236:239], v[216:219], a[88:91]
    ds_read_b128 a[144:147], v2 offset:4096
    v_cvt_pk_bf16_f32 v197, v242, v243
    v_mfma_f32_16x16x32_bf16 a[92:95], a[236:239], v[220:223], a[92:95]
    v_exp_f32 v245, v149
    v_mfma_f32_16x16x32_bf16 a[92:95], a[232:235], v[212:215], a[92:95]
    s_waitcnt lgkmcnt(7)
    buffer_load_dwordx4 v1, s[20:23], s33 offen offset:3072 sc1 lds
    ds_read_b128 a[148:151], v2 offset:5120
    v_mfma_f32_16x16x32_bf16 a[108:111], a[240:243], v[212:215], a[108:111]
    s_add_u32 s33, s33, 0x80000
    v_exp_f32 v246, v150
    v_mfma_f32_16x16x32_bf16 a[108:111], a[244:247], v[220:223], a[108:111]
    ds_read_b128 a[152:155], v2 offset:6144
    v_cvt_pk_bf16_f32 v198, v244, v245
    v_mfma_f32_16x16x32_bf16 a[104:107], a[244:247], v[216:219], a[104:107]
    v_exp_f32 v247, v151
    v_mfma_f32_16x16x32_bf16 a[104:107], a[240:243], v[208:211], a[104:107]
    s_waitcnt lgkmcnt(7)
    ds_read_b128 a[156:159], v2 offset:7168
    v_or3_b32 v57, v57, v197, v198
    v_mfma_f32_16x16x32_bf16 a[120:123], a[248:251], v[208:211], a[120:123]
    v_exp_f32 v232, v136
    v_mfma_f32_16x16x32_bf16 a[120:123], a[252:255], v[216:219], a[120:123]
    ds_read_b128 a[160:163], v2 offset:8192
    v_cvt_pk_bf16_f32 v199, v246, v247
    v_mfma_f32_16x16x32_bf16 a[124:127], a[252:255], v[220:223], a[124:127]
    v_exp_f32 v233, v137
    v_mfma_f32_16x16x32_bf16 a[124:127], a[248:251], v[212:215], a[124:127]
    s_waitcnt lgkmcnt(7)
    ds_read_b128 a[164:167], v2 offset:9216
    v_cvt_pk_bf16_f32 v200, v232, v233
    v_mfma_f32_16x16x32_bf16 v[160:163], a[128:131], v[96:99], v[16:19]
    s_waitcnt vmcnt(12)
    s_barrier
    v_exp_f32 v234, v138
    v_mfma_f32_16x16x32_bf16 v[160:163], a[132:135], v[100:103], v[160:163]
    s_waitcnt lgkmcnt(6)
    ds_read_b128 a[168:171], v2 offset:10240
    v_or3_b32 v57, v57, v199, v200
    v_mfma_f32_16x16x32_bf16 v[160:163], a[136:139], v[104:107], v[160:163]
    s_mov_b32 m0, s34
    v_exp_f32 v235, v139
    v_mfma_f32_16x16x32_bf16 v[160:163], a[140:143], v[108:111], v[160:163]
    s_add_u32 s36, s36, 64
    buffer_load_dwordx4 v1, s[16:19], s32 offen offset:0 sc1 lds
    ds_read_b128 a[172:175], v2 offset:11264
    v_mfma_f32_16x16x32_bf16 v[164:167], a[140:143], v[124:127], v[20:23]
    v_exp_f32 v236, v152
    v_mfma_f32_16x16x32_bf16 v[164:167], a[136:139], v[120:123], v[164:167]
    ds_read_b128 a[176:179], v2 offset:12288
    v_cvt_pk_bf16_f32 v201, v234, v235
    v_mfma_f32_16x16x32_bf16 v[164:167], a[132:135], v[116:119], v[164:167]
    s_add_u32 s52, s52, 16384
    v_exp_f32 v237, v153
    v_mfma_f32_16x16x32_bf16 v[164:167], a[128:131], v[112:115], v[164:167]
    s_waitcnt lgkmcnt(7)
    ds_read_b128 a[180:183], v2 offset:13312
    v_cvt_pk_bf16_f32 v202, v236, v237
    v_mfma_f32_16x16x32_bf16 v[180:183], a[144:147], v[112:115], v[36:39]
    s_add_u32 s34, s34, 0x4000
    v_exp_f32 v238, v154
    v_mfma_f32_16x16x32_bf16 v[180:183], a[148:151], v[116:119], v[180:183]
    s_waitcnt lgkmcnt(6)
    buffer_load_dwordx4 v1, s[16:19], s32 offen offset:1024 sc1 lds
    ds_read_b128 a[184:187], v2 offset:14336
    v_mfma_f32_16x16x32_bf16 v[180:183], a[152:155], v[120:123], v[180:183]
    s_and_b32 s52, s52, 0xffff
    v_exp_f32 v239, v155
    v_mfma_f32_16x16x32_bf16 v[180:183], a[156:159], v[124:127], v[180:183]
    ds_read_b128 a[188:191], v2 offset:15360
    v_or3_b32 v57, v57, v201, v202
    v_mfma_f32_16x16x32_bf16 v[176:179], a[156:159], v[108:111], v[32:35]
    v_exp_f32 v240, v140
    v_mfma_f32_16x16x32_bf16 v[176:179], a[152:155], v[104:107], v[176:179]
    v_cvt_pk_bf16_f32 v203, v238, v239
    v_add_u32 v2, s52, v1
    v_mfma_f32_16x16x32_bf16 v[176:179], a[148:151], v[100:103], v[176:179]
    s_and_b32 s34, s34, 0xffff
    v_exp_f32 v241, v141
    v_mfma_f32_16x16x32_bf16 v[176:179], a[144:147], v[96:99], v[176:179]
    s_waitcnt lgkmcnt(6)
    ds_read_b128 a[192:195], v3 offset:0
    v_cvt_pk_bf16_f32 v204, v240, v241
    v_mfma_f32_16x16x32_bf16 v[168:171], a[160:163], v[96:99], v[24:27]
    v_exp_f32 v242, v142
    v_mfma_f32_16x16x32_bf16 v[168:171], a[164:167], v[100:103], v[168:171]
    s_waitcnt lgkmcnt(5)
    buffer_load_dwordx4 v1, s[16:19], s32 offen offset:2048 sc1 lds
    ds_read_b128 a[196:199], v3 offset:8192
    v_mfma_f32_16x16x32_bf16 v[168:171], a[168:171], v[104:107], v[168:171]
    v_exp_f32 v243, v143
    v_mfma_f32_16x16x32_bf16 v[168:171], a[172:175], v[108:111], v[168:171]
    ds_read_b128 a[200:203], v3 offset:1024
    v_or3_b32 v57, v57, v203, v204
    v_mfma_f32_16x16x32_bf16 v[172:175], a[172:175], v[124:127], v[28:31]
    v_exp_f32 v244, v156
    v_mfma_f32_16x16x32_bf16 v[172:175], a[168:171], v[120:123], v[172:175]
    ds_read_b128 a[204:207], v3 offset:9216
    v_cvt_pk_bf16_f32 v205, v242, v243
    v_mfma_f32_16x16x32_bf16 v[172:175], a[164:167], v[116:119], v[172:175]
    v_exp_f32 v245, v157
    v_mfma_f32_16x16x32_bf16 v[172:175], a[160:163], v[112:115], v[172:175]
    s_waitcnt lgkmcnt(6)
    buffer_load_dwordx4 v1, s[16:19], s32 offen offset:3072 sc1 lds
    ds_read_b128 a[208:211], v3 offset:2048
    v_mfma_f32_16x16x32_bf16 v[188:191], a[176:179], v[112:115], v[44:47]
    s_sub_u32 s63, s63, 1
    v_exp_f32 v246, v158
    v_mfma_f32_16x16x32_bf16 v[188:191], a[180:183], v[116:119], v[188:191]
    s_waitcnt lgkmcnt(5)
    ds_read_b128 a[212:215], v3 offset:10240
    v_cvt_pk_bf16_f32 v206, v244, v245
    v_mfma_f32_16x16x32_bf16 v[188:191], a[184:187], v[120:123], v[188:191]
    s_add_u32 s32, s32, 0x80000
    v_exp_f32 v247, v159
    v_mfma_f32_16x16x32_bf16 v[188:191], a[188:191], v[124:127], v[188:191]
    ds_read_b128 a[216:219], v3 offset:3072
    v_or3_b32 v57, v57, v205, v206
    v_mfma_f32_16x16x32_bf16 v[184:187], a[188:191], v[108:111], v[40:43]
    ds_read_b128 a[220:223], v3 offset:11264
    v_cvt_pk_bf16_f32 v207, v246, v247
    v_mfma_f32_16x16x32_bf16 v[184:187], a[184:187], v[104:107], v[184:187]
    v_bitop3_b32 v57, v57, v207, s37 bitop3:0xa8
    v_cmp_ne_u32 vcc, 0, v57
    v_mfma_f32_16x16x32_bf16 v[184:187], a[180:183], v[100:103], v[184:187]
    v_mfma_f32_16x16x32_bf16 v[184:187], a[176:179], v[96:99], v[184:187]
    s_cbranch_vccnz k2_tramp_114
k2_ret_115:
    s_cmp_lg_u32 s63, 0
    s_cbranch_scc1 k2_sloop_110
    v_mfma_f32_16x16x32_bf16 v[248:251], v[60:63], v[192:195], v[248:251]
    v_exp_f32 v232, v160
    v_mfma_f32_16x16x32_bf16 v[248:251], v[60:63], v[200:203], v[248:251]
    s_mov_b32 m0, s35
    ds_read_b128 a[224:227], v3 offset:4096
    v_exp_f32 v233, v161
    v_mfma_f32_16x16x32_bf16 v[252:255], v[60:63], v[204:207], v[252:255]
    s_add_u32 s53, s53, 16384
    buffer_load_dwordx4 v1, s[20:23], s33 offen offset:0 sc1 lds
    ds_read_b128 a[228:231], v3 offset:12288
    v_mfma_f32_16x16x32_bf16 v[252:255], v[60:63], v[196:199], v[252:255]
    s_waitcnt lgkmcnt(8)
    v_exp_f32 v234, v162
    v_cvt_pk_bf16_f32 v208, v232, v233
    v_mfma_f32_16x16x32_bf16 a[12:15], a[192:195], v[196:199], a[12:15]
    s_sub_u32 s40, s36, s39
    ds_read_b128 a[232:235], v3 offset:5120
    v_mfma_f32_16x16x32_bf16 a[12:15], a[196:199], v[204:207], a[12:15]
    s_and_b32 s53, s53, 0xffff
    v_subrev_u32 v6, s40, v4
    v_cmp_gt_i32 s[44:45], 0, v6
    v_mfma_f32_16x16x32_bf16 a[8:11], a[196:199], v[200:203], a[8:11]
    v_exp_f32 v235, v163
    v_cmp_gt_i32 s[46:47], 1, v6
    v_mfma_f32_16x16x32_bf16 a[8:11], a[192:195], v[192:195], a[8:11]
    s_waitcnt lgkmcnt(7)
    ds_read_b128 a[236:239], v3 offset:13312
    v_cmp_gt_i32 s[48:49], 2, v6
    v_cmp_gt_i32 s[50:51], 3, v6
    v_mfma_f32_16x16x32_bf16 a[24:27], a[200:203], v[192:195], a[24:27]
    s_add_u32 s35, s35, 0x4000
    v_exp_f32 v236, v176
    v_mfma_f32_16x16x32_bf16 a[24:27], a[204:207], v[200:203], a[24:27]
    ds_read_b128 a[240:243], v3 offset:6144
    v_cvt_pk_bf16_f32 v209, v234, v235
    v_cndmask_b32 v16, v10, v5, s[44:45]
    v_mfma_f32_16x16x32_bf16 a[28:31], a[204:207], v[204:207], a[28:31]
    v_exp_f32 v237, v177
    v_mfma_f32_16x16x32_bf16 a[28:31], a[200:203], v[196:199], a[28:31]
    s_waitcnt lgkmcnt(7)
    ds_read_b128 a[244:247], v3 offset:14336
    v_cndmask_b32 v17, v10, v5, s[46:47]
    v_cndmask_b32 v18, v10, v5, s[48:49]
    v_mfma_f32_16x16x32_bf16 a[44:47], a[208:211], v[196:199], a[44:47]
    buffer_load_dwordx4 v1, s[20:23], s33 offen offset:1024 sc1 lds
    ds_read_b128 a[248:251], v3 offset:7168
    v_mfma_f32_16x16x32_bf16 a[44:47], a[212:215], v[204:207], a[44:47]
    v_cndmask_b32 v19, v10, v5, s[50:51]
    v_cvt_pk_bf16_f32 v210, v236, v237
    v_mfma_f32_16x16x32_bf16 a[40:43], a[212:215], v[200:203], a[40:43]
    v_exp_f32 v238, v178
    v_cmp_gt_i32 s[44:45], 16, v6
    v_mfma_f32_16x16x32_bf16 a[40:43], a[208:211], v[192:195], a[40:43]
    s_waitcnt lgkmcnt(7)
    v_cmp_gt_i32 s[46:47], 17, v6
    v_cmp_gt_i32 s[48:49], 18, v6
    v_mfma_f32_16x16x32_bf16 a[56:59], a[216:219], v[192:195], a[56:59]
    s_and_b32 s35, s35, 0xffff
    v_exp_f32 v239, v179
    v_mfma_f32_16x16x32_bf16 a[56:59], a[220:223], v[200:203], a[56:59]
    ds_read_b128 a[252:255], v3 offset:15360
    v_or3_b32 v57, v208, v209, v210
    v_cmp_gt_i32 s[50:51], 19, v6
    v_mfma_f32_16x16x32_bf16 a[60:63], a[220:223], v[204:207], a[60:63]
    v_exp_f32 v240, v164
    v_mfma_f32_16x16x32_bf16 a[60:63], a[216:219], v[196:199], a[60:63]
    s_waitcnt lgkmcnt(6)
    v_cndmask_b32 v32, v10, v5, s[44:45]
    v_cvt_pk_bf16_f32 v211, v238, v239
    v_cndmask_b32 v33, v10, v5, s[46:47]
    v_mfma_f32_16x16x32_bf16 a[76:79], a[224:227], v[196:199], a[76:79]
    ds_read_b128 a[128:131], v2 offset:0
    v_cndmask_b32 v34, v10, v5, s[48:49]
    v_mfma_f32_16x16x32_bf16 a[76:79], a[228:231], v[204:207], a[76:79]
    s_or_b32 s35, s35, 0x10000
    v_add_u32 v3, s53, v56
    v_cndmask_b32 v35, v10, v5, s[50:51]
    v_mfma_f32_16x16x32_bf16 a[72:75], a[228:231], v[200:203], a[72:75]
    buffer_load_dwordx4 v1, s[20:23], s33 offen offset:2048 sc1 lds
    v_exp_f32 v241, v165
    v_mfma_f32_16x16x32_bf16 a[72:75], a[224:227], v[192:195], a[72:75]
    s_waitcnt lgkmcnt(5)
    ds_read_b128 a[132:135], v2 offset:1024
    v_cmp_gt_i32 s[44:45], 32, v6
    v_mfma_f32_16x16x32_bf16 a[88:91], a[232:235], v[192:195], a[88:91]
    v_exp_f32 v242, v166
    v_cmp_gt_i32 s[46:47], 33, v6
    v_mfma_f32_16x16x32_bf16 a[88:91], a[236:239], v[200:203], a[88:91]
    ds_read_b128 a[136:139], v2 offset:2048
    v_cvt_pk_bf16_f32 v212, v240, v241
    v_mfma_f32_16x16x32_bf16 a[92:95], a[236:239], v[204:207], a[92:95]
    v_cmp_gt_i32 s[48:49], 34, v6
    v_cmp_gt_i32 s[50:51], 35, v6
    v_mfma_f32_16x16x32_bf16 a[92:95], a[232:235], v[196:199], a[92:95]
    s_waitcnt lgkmcnt(5)
    v_exp_f32 v243, v167
    v_or3_b32 v57, v57, v211, v212
    v_mfma_f32_16x16x32_bf16 a[108:111], a[240:243], v[196:199], a[108:111]
    ds_read_b128 a[140:143], v2 offset:3072
    v_cndmask_b32 v24, v10, v5, s[44:45]
    v_mfma_f32_16x16x32_bf16 a[108:111], a[244:247], v[204:207], a[108:111]
    v_cndmask_b32 v25, v10, v5, s[46:47]
    v_exp_f32 v244, v180
    v_mfma_f32_16x16x32_bf16 a[104:107], a[244:247], v[200:203], a[104:107]
    v_cvt_pk_bf16_f32 v213, v242, v243
    v_cndmask_b32 v26, v10, v5, s[48:49]
    v_mfma_f32_16x16x32_bf16 a[104:107], a[240:243], v[192:195], a[104:107]
    s_waitcnt lgkmcnt(4)
    ds_read_b128 a[144:147], v2 offset:4096
    v_cndmask_b32 v27, v10, v5, s[50:51]
    v_mfma_f32_16x16x32_bf16 a[120:123], a[248:251], v[192:195], a[120:123]
    v_exp_f32 v245, v181
    v_cmp_gt_i32 s[44:45], 48, v6
    v_mfma_f32_16x16x32_bf16 a[120:123], a[252:255], v[200:203], a[120:123]
    buffer_load_dwordx4 v1, s[20:23], s33 offen offset:3072 sc1 lds
    ds_read_b128 a[148:151], v2 offset:5120
    ds_read_b128 a[152:155], v2 offset:6144
    v_cmp_gt_i32 s[46:47], 49, v6
    s_add_u32 s33, s33, 0x80000
    v_cmp_gt_i32 s[48:49], 50, v6
    v_exp_f32 v246, v182
    v_cvt_pk_bf16_f32 v214, v244, v245
    v_cmp_gt_i32 s[50:51], 51, v6
    v_cndmask_b32 v40, v10, v5, s[44:45]
    v_mfma_f32_16x16x32_bf16 a[124:127], a[252:255], v[204:207], a[124:127]
    v_exp_f32 v247, v183
    v_or3_b32 v57, v57, v213, v214
    v_cndmask_b32 v41, v10, v5, s[46:47]
    v_mfma_f32_16x16x32_bf16 a[124:127], a[248:251], v[196:199], a[124:127]
    s_waitcnt lgkmcnt(5)
    ds_read_b128 a[156:159], v2 offset:7168
    v_cndmask_b32 v42, v10, v5, s[48:49]
    v_cndmask_b32 v43, v10, v5, s[50:51]
    v_mfma_f32_16x16x32_bf16 v[128:131], a[128:131], v[96:99], v[16:19]
    s_waitcnt vmcnt(4)
    s_barrier
    v_exp_f32 v232, v168
    v_mfma_f32_16x16x32_bf16 v[128:131], a[132:135], v[100:103], v[128:131]
    s_waitcnt lgkmcnt(4)
    ds_read_b128 a[160:163], v2 offset:8192
    v_cvt_pk_bf16_f32 v215, v246, v247
    v_mfma_f32_16x16x32_bf16 v[128:131], a[136:139], v[104:107], v[128:131]
    v_exp_f32 v233, v169
    v_mfma_f32_16x16x32_bf16 v[128:131], a[140:143], v[108:111], v[128:131]
    s_add_u32 s36, s36, 64
    ds_read_b128 a[164:167], v2 offset:9216
    v_cvt_pk_bf16_f32 v216, v232, v233
    v_mfma_f32_16x16x32_bf16 v[132:135], a[140:143], v[124:127], v[20:23]
    v_exp_f32 v234, v170
    v_mfma_f32_16x16x32_bf16 v[132:135], a[136:139], v[120:123], v[132:135]
    ds_read_b128 a[168:171], v2 offset:10240
    v_or3_b32 v57, v57, v215, v216
    v_mfma_f32_16x16x32_bf16 v[132:135], a[132:135], v[116:119], v[132:135]
    s_add_u32 s52, s52, 16384
    v_exp_f32 v235, v171
    v_mfma_f32_16x16x32_bf16 v[132:135], a[128:131], v[112:115], v[132:135]
    s_waitcnt lgkmcnt(5)
    ds_read_b128 a[172:175], v2 offset:11264
    v_cvt_pk_bf16_f32 v217, v234, v235
    v_mfma_f32_16x16x32_bf16 v[148:151], a[144:147], v[112:115], v[36:39]
    s_and_b32 s52, s52, 0xffff
    v_exp_f32 v236, v184
    v_mfma_f32_16x16x32_bf16 v[148:151], a[148:151], v[116:119], v[148:151]
    s_waitcnt lgkmcnt(4)
    ds_read_b128 a[176:179], v2 offset:12288
    ds_read_b128 a[180:183], v2 offset:13312
    v_mfma_f32_16x16x32_bf16 v[148:151], a[152:155], v[120:123], v[148:151]
    v_exp_f32 v237, v185
    v_mfma_f32_16x16x32_bf16 v[148:151], a[156:159], v[124:127], v[148:151]
    v_exp_f32 v238, v186
    v_mfma_f32_16x16x32_bf16 v[144:147], a[156:159], v[108:111], v[32:35]
    ds_read_b128 a[184:187], v2 offset:14336
    v_cvt_pk_bf16_f32 v218, v236, v237
    v_mfma_f32_16x16x32_bf16 v[144:147], a[152:155], v[104:107], v[144:147]
    v_exp_f32 v239, v187
    v_mfma_f32_16x16x32_bf16 v[144:147], a[148:151], v[100:103], v[144:147]
    ds_read_b128 a[188:191], v2 offset:15360
    v_or3_b32 v57, v57, v217, v218
    v_mfma_f32_16x16x32_bf16 v[144:147], a[144:147], v[96:99], v[144:147]
    s_waitcnt lgkmcnt(6)
    v_exp_f32 v240, v172
    v_mfma_f32_16x16x32_bf16 v[136:139], a[160:163], v[96:99], v[24:27]
    v_cvt_pk_bf16_f32 v219, v238, v239
    v_add_u32 v2, s52, v1
    v_mfma_f32_16x16x32_bf16 v[136:139], a[164:167], v[100:103], v[136:139]
    s_waitcnt lgkmcnt(4)
    v_exp_f32 v241, v173
    v_mfma_f32_16x16x32_bf16 v[136:139], a[168:171], v[104:107], v[136:139]
    ds_read_b128 a[192:195], v3 offset:0
    v_cvt_pk_bf16_f32 v220, v240, v241
    v_mfma_f32_16x16x32_bf16 v[136:139], a[172:175], v[108:111], v[136:139]
    v_exp_f32 v242, v174
    v_mfma_f32_16x16x32_bf16 v[140:143], a[172:175], v[124:127], v[28:31]
    ds_read_b128 a[196:199], v3 offset:8192
    v_or3_b32 v57, v57, v219, v220
    v_mfma_f32_16x16x32_bf16 v[140:143], a[168:171], v[120:123], v[140:143]
    v_exp_f32 v243, v175
    v_mfma_f32_16x16x32_bf16 v[140:143], a[164:167], v[116:119], v[140:143]
    ds_read_b128 a[200:203], v3 offset:1024
    v_cvt_pk_bf16_f32 v221, v242, v243
    v_mfma_f32_16x16x32_bf16 v[140:143], a[160:163], v[112:115], v[140:143]
    s_waitcnt lgkmcnt(5)
    v_exp_f32 v244, v188
    v_mfma_f32_16x16x32_bf16 v[156:159], a[176:179], v[112:115], v[44:47]
    ds_read_b128 a[204:207], v3 offset:9216
    ds_read_b128 a[208:211], v3 offset:2048
    v_mfma_f32_16x16x32_bf16 v[156:159], a[180:183], v[116:119], v[156:159]
    s_waitcnt lgkmcnt(5)
    v_exp_f32 v245, v189
    v_mfma_f32_16x16x32_bf16 v[156:159], a[184:187], v[120:123], v[156:159]
    v_exp_f32 v246, v190
    v_mfma_f32_16x16x32_bf16 v[156:159], a[188:191], v[124:127], v[156:159]
    ds_read_b128 a[212:215], v3 offset:10240
    v_cvt_pk_bf16_f32 v222, v244, v245
    v_mfma_f32_16x16x32_bf16 v[152:155], a[188:191], v[108:111], v[40:43]
    v_exp_f32 v247, v191
    v_mfma_f32_16x16x32_bf16 v[152:155], a[184:187], v[104:107], v[152:155]
    ds_read_b128 a[216:219], v3 offset:3072
    v_or3_b32 v57, v57, v221, v222
    v_mfma_f32_16x16x32_bf16 v[152:155], a[180:183], v[100:103], v[152:155]
    ds_read_b128 a[220:223], v3 offset:11264
    v_cvt_pk_bf16_f32 v223, v246, v247
    v_bitop3_b32 v57, v57, v223, s37 bitop3:0xa8
    v_mfma_f32_16x16x32_bf16 v[152:155], a[176:179], v[96:99], v[152:155]
    v_cmp_ne_u32 vcc, 0, v57
    s_cbranch_vccnz k2_tramp_116
k2_ret_117:
    v_mfma_f32_16x16x32_bf16 v[248:251], v[60:63], v[208:211], v[248:251]
    ds_read_b128 a[224:227], v3 offset:4096
    v_exp_f32 v232, v128
    v_mfma_f32_16x16x32_bf16 v[248:251], v[60:63], v[216:219], v[248:251]
    v_exp_f32 v233, v129
    v_mfma_f32_16x16x32_bf16 v[252:255], v[60:63], v[220:223], v[252:255]
    s_add_u32 s53, s53, 16384
    ds_read_b128 a[228:231], v3 offset:12288
    v_exp_f32 v234, v130
    v_mfma_f32_16x16x32_bf16 v[252:255], v[60:63], v[212:215], v[252:255]
    s_waitcnt lgkmcnt(8)
    v_cvt_pk_bf16_f32 v192, v232, v233
    v_exp_f32 v235, v131
    v_mfma_f32_16x16x32_bf16 a[12:15], a[192:195], v[212:215], a[12:15]
    s_sub_u32 s40, s36, s39
    s_sub_u32 s40, s40, 64
    ds_read_b128 a[232:235], v3 offset:5120
    v_mfma_f32_16x16x32_bf16 a[12:15], a[196:199], v[220:223], a[12:15]
    s_and_b32 s53, s53, 0xffff
    v_subrev_u32 v6, s40, v4
    v_cmp_gt_i32 s[44:45], 0, v6
    v_cvt_pk_bf16_f32 v193, v234, v235
    v_mfma_f32_16x16x32_bf16 a[8:11], a[196:199], v[216:219], a[8:11]
    v_exp_f32 v236, v144
    v_cmp_gt_i32 s[46:47], 1, v6
    v_mfma_f32_16x16x32_bf16 a[8:11], a[192:195], v[208:211], a[8:11]
    s_waitcnt lgkmcnt(7)
    ds_read_b128 a[236:239], v3 offset:13312
    v_exp_f32 v237, v145
    v_mfma_f32_16x16x32_bf16 a[24:27], a[200:203], v[208:211], a[24:27]
    ds_read_b128 a[240:243], v3 offset:6144
    v_cmp_gt_i32 s[48:49], 2, v6
    v_cmp_gt_i32 s[50:51], 3, v6
    v_mfma_f32_16x16x32_bf16 a[24:27], a[204:207], v[216:219], a[24:27]
    v_exp_f32 v238, v146
    v_cndmask_b32 v20, v11, v5, s[44:45]
    v_mfma_f32_16x16x32_bf16 a[28:31], a[204:207], v[220:223], a[28:31]
    v_cvt_pk_bf16_f32 v194, v236, v237
    v_cndmask_b32 v21, v11, v5, s[46:47]
    v_or3_b32 v57, v192, v193, v194
    v_mfma_f32_16x16x32_bf16 a[28:31], a[200:203], v[212:215], a[28:31]
    s_waitcnt lgkmcnt(7)
    v_exp_f32 v239, v147
    v_cndmask_b32 v22, v11, v5, s[48:49]
    v_mfma_f32_16x16x32_bf16 a[44:47], a[208:211], v[212:215], a[44:47]
    ds_read_b128 a[244:247], v3 offset:14336
    v_cndmask_b32 v23, v11, v5, s[50:51]
    v_cvt_pk_bf16_f32 v195, v238, v239
    v_mfma_f32_16x16x32_bf16 a[44:47], a[212:215], v[220:223], a[44:47]
    v_exp_f32 v240, v132
    v_cmp_gt_i32 s[44:45], 16, v6
    v_mfma_f32_16x16x32_bf16 a[40:43], a[212:215], v[216:219], a[40:43]
    ds_read_b128 a[248:251], v3 offset:7168
    v_cmp_gt_i32 s[46:47], 17, v6
    v_cmp_gt_i32 s[48:49], 18, v6
    v_mfma_f32_16x16x32_bf16 a[40:43], a[208:211], v[208:211], a[40:43]
    s_waitcnt lgkmcnt(7)
    ds_read_b128 a[252:255], v3 offset:15360
    v_exp_f32 v241, v133
    v_mfma_f32_16x16x32_bf16 a[56:59], a[216:219], v[208:211], a[56:59]
    v_exp_f32 v242, v134
    v_cmp_gt_i32 s[50:51], 19, v6
    v_mfma_f32_16x16x32_bf16 a[56:59], a[220:223], v[216:219], a[56:59]
    v_cvt_pk_bf16_f32 v196, v240, v241
    v_cndmask_b32 v36, v11, v5, s[44:45]
    v_or3_b32 v57, v57, v195, v196
    v_mfma_f32_16x16x32_bf16 a[60:63], a[220:223], v[220:223], a[60:63]
    v_exp_f32 v243, v135
    v_cndmask_b32 v37, v11, v5, s[46:47]
    v_mfma_f32_16x16x32_bf16 a[60:63], a[216:219], v[212:215], a[60:63]
    s_waitcnt lgkmcnt(6)
    ds_read_b128 a[128:131], v2 offset:0
    v_cndmask_b32 v38, v11, v5, s[48:49]
    v_add_u32 v3, s53, v56
    v_mfma_f32_16x16x32_bf16 a[76:79], a[224:227], v[212:215], a[76:79]
    ds_read_b128 a[132:135], v2 offset:1024
    v_exp_f32 v244, v148
    v_mfma_f32_16x16x32_bf16 a[76:79], a[228:231], v[220:223], a[76:79]
    ds_read_b128 a[136:139], v2 offset:2048
    v_cvt_pk_bf16_f32 v197, v242, v243
    v_cndmask_b32 v39, v11, v5, s[50:51]
    v_mfma_f32_16x16x32_bf16 a[72:75], a[228:231], v[216:219], a[72:75]
    v_cmp_gt_i32 s[44:45], 32, v6
    v_exp_f32 v245, v149
    v_mfma_f32_16x16x32_bf16 a[72:75], a[224:227], v[208:211], a[72:75]
    s_waitcnt lgkmcnt(7)
    ds_read_b128 a[140:143], v2 offset:3072
    ds_read_b128 a[144:147], v2 offset:4096
    v_cmp_gt_i32 s[46:47], 33, v6
    v_mfma_f32_16x16x32_bf16 a[88:91], a[232:235], v[208:211], a[88:91]
    v_exp_f32 v246, v150
    v_cmp_gt_i32 s[48:49], 34, v6
    v_mfma_f32_16x16x32_bf16 a[88:91], a[236:239], v[216:219], a[88:91]
    ds_read_b128 a[148:151], v2 offset:5120
    v_cvt_pk_bf16_f32 v198, v244, v245
    v_cmp_gt_i32 s[50:51], 35, v6
    v_mfma_f32_16x16x32_bf16 a[92:95], a[236:239], v[220:223], a[92:95]
    v_exp_f32 v247, v151
    v_or3_b32 v57, v57, v197, v198
    v_mfma_f32_16x16x32_bf16 a[92:95], a[232:235], v[212:215], a[92:95]
    s_waitcnt lgkmcnt(8)
    ds_read_b128 a[152:155], v2 offset:6144
    v_cndmask_b32 v28, v11, v5, s[44:45]
    v_cndmask_b32 v29, v11, v5, s[46:47]
    v_mfma_f32_16x16x32_bf16 a[108:111], a[240:243], v[212:215], a[108:111]
    ds_read_b128 a[156:159], v2 offset:7168
    v_exp_f32 v232, v136
    v_mfma_f32_16x16x32_bf16 a[108:111], a[244:247], v[220:223], a[108:111]
    ds_read_b128 a[160:163], v2 offset:8192
    v_cvt_pk_bf16_f32 v199, v246, v247
    v_cndmask_b32 v30, v11, v5, s[48:49]
    v_mfma_f32_16x16x32_bf16 a[104:107], a[244:247], v[216:219], a[104:107]
    v_cndmask_b32 v31, v11, v5, s[50:51]
    v_exp_f32 v233, v137
    v_mfma_f32_16x16x32_bf16 a[104:107], a[240:243], v[208:211], a[104:107]
    s_waitcnt lgkmcnt(9)
    ds_read_b128 a[164:167], v2 offset:9216
    ds_read_b128 a[168:171], v2 offset:10240
    v_cmp_gt_i32 s[44:45], 48, v6
    v_mfma_f32_16x16x32_bf16 a[120:123], a[248:251], v[208:211], a[120:123]
    v_exp_f32 v234, v138
    v_cmp_gt_i32 s[46:47], 49, v6
    v_mfma_f32_16x16x32_bf16 a[120:123], a[252:255], v[216:219], a[120:123]
    ds_read_b128 a[172:175], v2 offset:11264
    ds_read_b128 a[176:179], v2 offset:12288
    v_cvt_pk_bf16_f32 v200, v232, v233
    v_cmp_gt_i32 s[48:49], 50, v6
    v_exp_f32 v235, v139
    v_cmp_gt_i32 s[50:51], 51, v6
    v_or3_b32 v57, v57, v199, v200
    v_cndmask_b32 v44, v11, v5, s[44:45]
    v_mfma_f32_16x16x32_bf16 a[124:127], a[252:255], v[220:223], a[124:127]
    ds_read_b128 a[180:183], v2 offset:13312
    v_exp_f32 v236, v152
    v_cvt_pk_bf16_f32 v201, v234, v235
    v_cndmask_b32 v45, v11, v5, s[46:47]
    v_mfma_f32_16x16x32_bf16 a[124:127], a[248:251], v[212:215], a[124:127]
    s_waitcnt lgkmcnt(12)
    ds_read_b128 a[184:187], v2 offset:14336
    v_cndmask_b32 v46, v11, v5, s[48:49]
    v_cndmask_b32 v47, v11, v5, s[50:51]
    v_mfma_f32_16x16x32_bf16 v[164:167], a[128:131], v[112:115], v[20:23]
    v_exp_f32 v237, v153
    v_mfma_f32_16x16x32_bf16 v[164:167], a[132:135], v[116:119], v[164:167]
    s_waitcnt lgkmcnt(11)
    ds_read_b128 a[188:191], v2 offset:15360
    v_exp_f32 v238, v154
    v_mfma_f32_16x16x32_bf16 v[164:167], a[136:139], v[120:123], v[164:167]
    v_cvt_pk_bf16_f32 v202, v236, v237
    v_exp_f32 v239, v155
    v_mfma_f32_16x16x32_bf16 v[164:167], a[140:143], v[124:127], v[164:167]
    s_waitcnt lgkmcnt(10)
    s_waitcnt lgkmcnt(8)
    v_or3_b32 v57, v57, v201, v202
    v_mfma_f32_16x16x32_bf16 v[180:183], a[156:159], v[124:127], v[36:39]
    s_add_u32 s36, s36, 64
    ds_read_b128 a[192:195], v3 offset:0
    v_exp_f32 v240, v140
    v_mfma_f32_16x16x32_bf16 v[180:183], a[152:155], v[120:123], v[180:183]
    ds_read_b128 a[196:199], v3 offset:8192
    v_cvt_pk_bf16_f32 v203, v238, v239
    v_mfma_f32_16x16x32_bf16 v[180:183], a[148:151], v[116:119], v[180:183]
    s_add_u32 s52, s52, 16384
    ds_read_b128 a[200:203], v3 offset:1024
    v_exp_f32 v241, v141
    v_mfma_f32_16x16x32_bf16 v[180:183], a[144:147], v[112:115], v[180:183]
    s_waitcnt lgkmcnt(9)
    v_exp_f32 v242, v142
    v_cvt_pk_bf16_f32 v204, v240, v241
    v_mfma_f32_16x16x32_bf16 v[172:175], a[160:163], v[112:115], v[28:31]
    s_and_b32 s52, s52, 0xffff
    v_add_u32 v2, s52, v1
    v_exp_f32 v243, v143
    v_mfma_f32_16x16x32_bf16 v[172:175], a[164:167], v[116:119], v[172:175]
    s_waitcnt lgkmcnt(7)
    ds_read_b128 a[204:207], v3 offset:9216
    v_or3_b32 v57, v57, v203, v204
    v_cvt_pk_bf16_f32 v205, v242, v243
    v_mfma_f32_16x16x32_bf16 v[172:175], a[168:171], v[120:123], v[172:175]
    ds_read_b128 a[208:211], v3 offset:2048
    v_exp_f32 v244, v156
    v_mfma_f32_16x16x32_bf16 v[172:175], a[172:175], v[124:127], v[172:175]
    s_waitcnt lgkmcnt(7)
    s_waitcnt lgkmcnt(5)
    v_exp_f32 v245, v157
    v_mfma_f32_16x16x32_bf16 v[188:191], a[188:191], v[124:127], v[44:47]
    ds_read_b128 a[212:215], v3 offset:10240
    v_exp_f32 v246, v158
    v_mfma_f32_16x16x32_bf16 v[188:191], a[184:187], v[120:123], v[188:191]
    v_cvt_pk_bf16_f32 v206, v244, v245
    v_exp_f32 v247, v159
    v_mfma_f32_16x16x32_bf16 v[188:191], a[180:183], v[116:119], v[188:191]
    ds_read_b128 a[216:219], v3 offset:3072
    v_or3_b32 v57, v57, v205, v206
    v_cvt_pk_bf16_f32 v207, v246, v247
    v_mfma_f32_16x16x32_bf16 v[188:191], a[176:179], v[112:115], v[188:191]
    ds_read_b128 a[220:223], v3 offset:11264
    v_bitop3_b32 v57, v57, v207, s37 bitop3:0xa8
    v_cmp_ne_u32 vcc, 0, v57
    s_cbranch_vccnz k2_tramp_118
k2_ret_119:
k2_sdone_111:
    s_add_u32 s16, s6, 0x4811000
    s_addc_u32 s17, s7, 0
    s_and_b32 s17, s17, 0xffff
    s_mov_b32 s18, 0x4000
    s_mov_b32 s19, 0x00020000
    v_mfma_f32_16x16x32_bf16 v[248:251], v[60:63], v[192:195], v[248:251]
    s_waitcnt vmcnt(0)
    s_barrier
    v_exp_f32 v232, v164
    v_mfma_f32_16x16x32_bf16 v[248:251], v[60:63], v[200:203], v[248:251]
    ds_read_b128 a[224:227], v3 offset:4096
    s_cmp_eq_u32 s30, 0
    s_cbranch_scc1 k12_ool_122
k12_oolret_123:
    v_mfma_f32_16x16x32_bf16 v[252:255], v[60:63], v[204:207], v[252:255]
    s_add_u32 m0, s60, 0
    v_exp_f32 v233, v165
    v_mfma_f32_16x16x32_bf16 v[252:255], v[60:63], v[196:199], v[252:255]
    s_waitcnt lgkmcnt(7)
    buffer_load_dwordx4 v90, s[12:15], s61 offen offset:0 lds
    ds_read_b128 a[228:231], v3 offset:12288
    v_mfma_f32_16x16x32_bf16 a[12:15], a[192:195], v[196:199], a[12:15]
    s_add_u32 s53, s53, 16384
    v_exp_f32 v234, v166
    v_cvt_pk_bf16_f32 v212, v232, v233
    v_mfma_f32_16x16x32_bf16 a[12:15], a[196:199], v[204:207], a[12:15]
    s_and_b32 s53, s53, 0xffff
    buffer_load_dwordx4 v91, s[12:15], s61 offen offset:1024 lds
    ds_read_b128 a[232:235], v3 offset:5120
    v_mfma_f32_16x16x32_bf16 a[8:11], a[196:199], v[200:203], a[8:11]
    ds_read_b128 a[236:239], v3 offset:13312
    v_exp_f32 v235, v167
    v_mfma_f32_16x16x32_bf16 a[8:11], a[192:195], v[192:195], a[8:11]
    s_waitcnt lgkmcnt(8)
    v_exp_f32 v236, v180
    v_mfma_f32_16x16x32_bf16 a[24:27], a[200:203], v[192:195], a[24:27]
    buffer_load_dwordx4 v92, s[12:15], s61 offen offset:2048 lds
    ds_read_b128 a[240:243], v3 offset:6144
    v_mfma_f32_16x16x32_bf16 a[24:27], a[204:207], v[200:203], a[24:27]
    v_cvt_pk_bf16_f32 v213, v234, v235
    v_exp_f32 v237, v181
    v_mfma_f32_16x16x32_bf16 a[28:31], a[204:207], v[204:207], a[28:31]
    buffer_load_dwordx4 v93, s[12:15], s61 offen offset:3072 lds
    ds_read_b128 a[244:247], v3 offset:14336
    v_mfma_f32_16x16x32_bf16 a[28:31], a[200:203], v[196:199], a[28:31]
    s_waitcnt lgkmcnt(8)
    v_exp_f32 v238, v182
    v_cvt_pk_bf16_f32 v214, v236, v237
    v_mfma_f32_16x16x32_bf16 a[44:47], a[208:211], v[196:199], a[44:47]
    s_add_u32 s61, s61, 0x20000
    s_and_b32 s61, s61, 0x3fffff
    ds_read_b128 a[248:251], v3 offset:7168
    v_mfma_f32_16x16x32_bf16 a[44:47], a[212:215], v[204:207], a[44:47]
    s_add_u32 m0, s60, 16384
    v_exp_f32 v239, v183
    v_or3_b32 v57, v212, v213, v214
    v_mfma_f32_16x16x32_bf16 a[40:43], a[212:215], v[200:203], a[40:43]
    buffer_load_dwordx4 v90, s[12:15], s61 offen offset:0 lds
    buffer_load_dwordx4 v91, s[12:15], s61 offen offset:1024 lds
    ds_read_b128 a[252:255], v3 offset:15360
    v_mfma_f32_16x16x32_bf16 a[40:43], a[208:211], v[192:195], a[40:43]
    s_waitcnt lgkmcnt(8)
    v_exp_f32 v240, v172
    v_cvt_pk_bf16_f32 v215, v238, v239
    v_mfma_f32_16x16x32_bf16 a[56:59], a[216:219], v[192:195], a[56:59]
    v_mfma_f32_16x16x32_bf16 a[56:59], a[220:223], v[200:203], a[56:59]
    v_add_u32 v3, s53, v56
    ds_read_b128 a[192:195], v3 offset:0
    v_mfma_f32_16x16x32_bf16 a[60:63], a[220:223], v[204:207], a[60:63]
    ds_read_b128 a[196:199], v3 offset:8192
    v_exp_f32 v241, v173
    v_mfma_f32_16x16x32_bf16 a[60:63], a[216:219], v[196:199], a[60:63]
    s_waitcnt lgkmcnt(8)
    buffer_load_dwordx4 v92, s[12:15], s61 offen offset:2048 lds
    buffer_load_dwordx4 v93, s[12:15], s61 offen offset:3072 lds
    ds_read_b128 a[200:203], v3 offset:1024
    v_mfma_f32_16x16x32_bf16 a[76:79], a[224:227], v[196:199], a[76:79]
    v_exp_f32 v242, v174
    v_cvt_pk_bf16_f32 v220, v240, v241
    v_mfma_f32_16x16x32_bf16 a[76:79], a[228:231], v[204:207], a[76:79]
    ds_read_b128 a[204:207], v3 offset:9216
    ds_read_b128 a[208:211], v3 offset:2048
    v_or3_b32 v57, v57, v215, v220
    v_mfma_f32_16x16x32_bf16 a[72:75], a[228:231], v[200:203], a[72:75]
    s_add_u32 s61, s61, 0x20000
    s_and_b32 s61, s61, 0x3fffff
    ds_read_b128 a[212:215], v3 offset:10240
    v_exp_f32 v243, v175
    v_mfma_f32_16x16x32_bf16 a[72:75], a[224:227], v[192:195], a[72:75]
    s_waitcnt lgkmcnt(10)
    ds_read_b128 a[216:219], v3 offset:3072
    s_add_u32 m0, s60, 32768
    v_mfma_f32_16x16x32_bf16 a[88:91], a[232:235], v[192:195], a[88:91]
    buffer_load_dwordx4 v90, s[12:15], s61 offen offset:0 lds
    ds_read_b128 a[220:223], v3 offset:11264
    v_mfma_f32_16x16x32_bf16 a[88:91], a[236:239], v[200:203], a[88:91]
    v_exp_f32 v244, v188
    v_cvt_pk_bf16_f32 v221, v242, v243
    v_mfma_f32_16x16x32_bf16 a[92:95], a[236:239], v[204:207], a[92:95]
    buffer_load_dwordx4 v91, s[12:15], s61 offen offset:1024 lds
    ds_read_b128 a[224:227], v3 offset:4096
    v_mfma_f32_16x16x32_bf16 a[92:95], a[232:235], v[196:199], a[92:95]
    s_waitcnt lgkmcnt(11)
    ds_read_b128 a[228:231], v3 offset:12288
    v_exp_f32 v245, v189
    v_mfma_f32_16x16x32_bf16 a[108:111], a[240:243], v[196:199], a[108:111]
    buffer_load_dwordx4 v92, s[12:15], s61 offen offset:2048 lds
    ds_read_b128 a[232:235], v3 offset:5120
    v_mfma_f32_16x16x32_bf16 a[108:111], a[244:247], v[204:207], a[108:111]
    v_exp_f32 v246, v190
    v_mfma_f32_16x16x32_bf16 a[104:107], a[244:247], v[200:203], a[104:107]
    ds_read_b128 a[236:239], v3 offset:13312
    v_cvt_pk_bf16_f32 v222, v244, v245
    v_or3_b32 v57, v57, v221, v222
    v_mfma_f32_16x16x32_bf16 a[104:107], a[240:243], v[192:195], a[104:107]
    s_waitcnt lgkmcnt(12)
    v_exp_f32 v247, v191
    v_mfma_f32_16x16x32_bf16 a[120:123], a[248:251], v[192:195], a[120:123]
    buffer_load_dwordx4 v93, s[12:15], s61 offen offset:3072 lds
    ds_read_b128 a[240:243], v3 offset:6144
    ds_read_b128 a[244:247], v3 offset:14336
    v_mfma_f32_16x16x32_bf16 a[120:123], a[252:255], v[200:203], a[120:123]
    s_add_u32 s61, s61, 0x20000
    s_and_b32 s61, s61, 0x3fffff
    v_cvt_pk_bf16_f32 v223, v246, v247
    v_bitop3_b32 v57, v57, v223, s37 bitop3:0xa8
    v_mfma_f32_16x16x32_bf16 a[124:127], a[252:255], v[204:207], a[124:127]
    v_cmp_ne_u32 vcc, 0, v57
    v_mfma_f32_16x16x32_bf16 a[124:127], a[248:251], v[196:199], a[124:127]
    buffer_load_dword v74, v73, s[16:19], s59 offen sc1
    ds_read_b128 a[248:251], v3 offset:7168
    ds_read_b128 a[252:255], v3 offset:15360
    s_cbranch_vccnz k2_tramp_120
k2_ret_121:
    v_lshrrev_b32 v6, 4, v1
    v_and_b32 v6, 31, v6
    s_getpc_b64 s[40:41]
pc_124:
    s_add_u32 s40, s40, op_head-pc_124
    s_addc_u32 s41, s41, 0
    v_lshlrev_b32 v224, 7, v6
    v_mov_b32 v225, s41
    v_add_co_u32 v224, vcc, s40, v224
    s_nop 1
    v_addc_co_u32 v225, vcc, 0, v225, vcc
    global_load_dword v7, v[224:225], off
    v_mfma_f32_16x16x32_bf16 v[252:255], v[60:63], v[212:215], v[252:255]
    s_lshl_b32 s31, s28, 19
    v_mov_b32 v249, v248
    s_nop 1
    v_permlane16_swap_b32 v248, v249
    v_mfma_f32_16x16x32_bf16 v[252:255], v[60:63], v[220:223], v[252:255]
    s_waitcnt lgkmcnt(0)
    s_nop 1
    v_add_f32 v248, v248, v249
    v_mov_b32 v249, v248
    v_mfma_f32_16x16x32_bf16 a[12:15], a[196:199], v[220:223], a[12:15]
    s_lshl_b32 s44, s39, 6
    s_nop 1
    v_permlane32_swap_b32 v248, v249
    s_nop 1
    v_mfma_f32_16x16x32_bf16 a[12:15], a[192:195], v[212:215], a[12:15]
    s_add_u32 s44, s44, s31
    s_add_u32 s45, s44, 131072
    v_add_f32 v248, v248, v249
    v_rcp_f32 v249, v248
    v_mfma_f32_16x16x32_bf16 a[28:31], a[200:203], v[212:215], a[28:31]
    s_add_u32 s46, s44, 262144
    v_rcp_f32 v248, v248
    s_nop 0
    s_add_u32 s47, s44, 393216
    v_mfma_f32_16x16x32_bf16 a[28:31], a[204:207], v[220:223], a[28:31]
    s_add_u32 s48, s44, 4096
    v_accvgpr_read_b32 v132, a8
    v_accvgpr_read_b32 v133, a9
    v_accvgpr_read_b32 v134, a10
    v_mfma_f32_16x16x32_bf16 a[44:47], a[212:215], v[220:223], a[44:47]
    s_add_u32 s49, s44, 135168
    v_accvgpr_read_b32 v135, a11
    v_accvgpr_read_b32 v136, a24
    v_accvgpr_read_b32 v137, a25
    v_mfma_f32_16x16x32_bf16 a[44:47], a[208:211], v[212:215], a[44:47]
    s_add_u32 s50, s44, 266240
    v_accvgpr_read_b32 v138, a26
    v_accvgpr_read_b32 v139, a27
    v_mul_f32 v132, v132, v248
    v_mfma_f32_16x16x32_bf16 a[60:63], a[216:219], v[212:215], a[60:63]
    s_add_u32 s51, s44, 397312
    v_mul_f32 v133, v133, v248
    v_mul_f32 v134, v134, v248
    v_mul_f32 v135, v135, v248
    v_mfma_f32_16x16x32_bf16 a[60:63], a[220:223], v[220:223], a[60:63]
    v_mul_f32 v136, v136, v248
    v_mul_f32 v137, v137, v248
    v_mul_f32 v138, v138, v248
    v_mfma_f32_16x16x32_bf16 a[76:79], a[228:231], v[220:223], a[76:79]
    v_mul_f32 v139, v139, v248
    v_cvt_pk_bf16_f32 v128, v132, v133
    v_cvt_pk_bf16_f32 v129, v134, v135
    v_mfma_f32_16x16x32_bf16 a[76:79], a[224:227], v[212:215], a[76:79]
    v_cvt_pk_bf16_f32 v130, v136, v137
    v_cvt_pk_bf16_f32 v131, v138, v139
    buffer_store_dwordx4 v[128:131], v1, s[24:27], s44 offen sc1
    v_mfma_f32_16x16x32_bf16 a[92:95], a[232:235], v[212:215], a[92:95]
    v_accvgpr_read_b32 v144, a40
    v_accvgpr_read_b32 v145, a41
    v_accvgpr_read_b32 v146, a42
    v_mfma_f32_16x16x32_bf16 a[92:95], a[236:239], v[220:223], a[92:95]
    v_accvgpr_read_b32 v147, a43
    v_accvgpr_read_b32 v148, a56
    v_mov_b32 v253, v252
    v_mfma_f32_16x16x32_bf16 a[108:111], a[244:247], v[220:223], a[108:111]
    v_accvgpr_read_b32 v149, a57
    v_accvgpr_read_b32 v150, a58
    s_nop 1
    v_mfma_f32_16x16x32_bf16 a[108:111], a[240:243], v[212:215], a[108:111]
    v_accvgpr_read_b32 v151, a59
    v_permlane16_swap_b32 v252, v253
    v_mul_f32 v144, v144, v248
    v_mfma_f32_16x16x32_bf16 a[124:127], a[248:251], v[212:215], a[124:127]
    s_nop 1
    v_mul_f32 v145, v145, v248
    v_add_f32 v252, v252, v253
    v_mfma_f32_16x16x32_bf16 a[124:127], a[252:255], v[220:223], a[124:127]
    v_mul_f32 v146, v146, v248
    v_mov_b32 v253, v252
    v_mul_f32 v147, v147, v248
    s_nop 1
    v_mul_f32 v148, v148, v248
    v_mul_f32 v149, v149, v248
    v_permlane32_swap_b32 v252, v253
    v_mul_f32 v150, v150, v248
    s_nop 1
    v_mul_f32 v151, v151, v248
    v_add_f32 v252, v252, v253
    v_cvt_pk_bf16_f32 v140, v144, v145
    v_rcp_f32 v253, v252
    v_cvt_pk_bf16_f32 v141, v146, v147
    v_rcp_f32 v252, v252
    v_cvt_pk_bf16_f32 v142, v148, v149
    s_nop 0
    v_cvt_pk_bf16_f32 v143, v150, v151
    buffer_store_dwordx4 v[140:143], v1, s[24:27], s45 offen sc1
    v_accvgpr_read_b32 v156, a72
    v_accvgpr_read_b32 v157, a73
    v_accvgpr_read_b32 v158, a74
    v_accvgpr_read_b32 v159, a75
    v_accvgpr_read_b32 v160, a88
    v_accvgpr_read_b32 v161, a89
    v_accvgpr_read_b32 v162, a90
    v_accvgpr_read_b32 v163, a91
    v_mul_f32 v156, v156, v248
    v_mul_f32 v157, v157, v248
    v_mul_f32 v158, v158, v248
    v_mul_f32 v159, v159, v248
    v_mul_f32 v160, v160, v248
    v_mul_f32 v161, v161, v248
    v_mul_f32 v162, v162, v248
    v_mul_f32 v163, v163, v248
    v_cvt_pk_bf16_f32 v152, v156, v157
    v_cvt_pk_bf16_f32 v153, v158, v159
    v_cvt_pk_bf16_f32 v154, v160, v161
    v_cvt_pk_bf16_f32 v155, v162, v163
    buffer_store_dwordx4 v[152:155], v1, s[24:27], s46 offen sc1
    v_accvgpr_read_b32 v168, a104
    v_accvgpr_read_b32 v169, a105
    v_accvgpr_read_b32 v170, a106
    v_accvgpr_read_b32 v171, a107
    v_accvgpr_read_b32 v172, a120
    v_accvgpr_read_b32 v173, a121
    v_accvgpr_read_b32 v174, a122
    v_accvgpr_read_b32 v175, a123
    v_mul_f32 v168, v168, v248
    v_mul_f32 v169, v169, v248
    v_mul_f32 v170, v170, v248
    v_mul_f32 v171, v171, v248
    v_mul_f32 v172, v172, v248
    v_mul_f32 v173, v173, v248
    v_mul_f32 v174, v174, v248
    v_mul_f32 v175, v175, v248
    v_cvt_pk_bf16_f32 v164, v168, v169
    v_cvt_pk_bf16_f32 v165, v170, v171
    v_cvt_pk_bf16_f32 v166, v172, v173
    v_cvt_pk_bf16_f32 v167, v174, v175
    buffer_store_dwordx4 v[164:167], v1, s[24:27], s47 offen sc1
    v_accvgpr_read_b32 v132, a12
    v_accvgpr_read_b32 v133, a13
    v_accvgpr_read_b32 v134, a14
    v_accvgpr_read_b32 v135, a15
    v_accvgpr_read_b32 v136, a28
    v_accvgpr_read_b32 v137, a29
    v_accvgpr_read_b32 v138, a30
    v_accvgpr_read_b32 v139, a31
    v_pk_mul_f32 v[132:133], v[132:133], v[252:253]
    v_pk_mul_f32 v[134:135], v[134:135], v[252:253]
    v_pk_mul_f32 v[136:137], v[136:137], v[252:253]
    v_pk_mul_f32 v[138:139], v[138:139], v[252:253]
    v_cvt_pk_bf16_f32 v128, v132, v133
    v_cvt_pk_bf16_f32 v129, v134, v135
    v_cvt_pk_bf16_f32 v130, v136, v137
    v_cvt_pk_bf16_f32 v131, v138, v139
    v_accvgpr_read_b32 v144, a44
    v_accvgpr_read_b32 v145, a45
    v_accvgpr_read_b32 v146, a46
    v_accvgpr_read_b32 v147, a47
    v_accvgpr_read_b32 v148, a60
    v_accvgpr_read_b32 v149, a61
    v_accvgpr_read_b32 v150, a62
    v_accvgpr_read_b32 v151, a63
    v_pk_mul_f32 v[144:145], v[144:145], v[252:253]
    v_pk_mul_f32 v[146:147], v[146:147], v[252:253]
    v_pk_mul_f32 v[148:149], v[148:149], v[252:253]
    v_pk_mul_f32 v[150:151], v[150:151], v[252:253]
    v_cvt_pk_bf16_f32 v140, v144, v145
    v_cvt_pk_bf16_f32 v141, v146, v147
    v_cvt_pk_bf16_f32 v142, v148, v149
    v_cvt_pk_bf16_f32 v143, v150, v151
    v_accvgpr_read_b32 v156, a76
    v_accvgpr_read_b32 v157, a77
    v_accvgpr_read_b32 v158, a78
    v_accvgpr_read_b32 v159, a79
    v_accvgpr_read_b32 v160, a92
    v_accvgpr_read_b32 v161, a93
    v_accvgpr_read_b32 v162, a94
    v_accvgpr_read_b32 v163, a95
    v_pk_mul_f32 v[156:157], v[156:157], v[252:253]
    v_pk_mul_f32 v[158:159], v[158:159], v[252:253]
    v_pk_mul_f32 v[160:161], v[160:161], v[252:253]
    v_pk_mul_f32 v[162:163], v[162:163], v[252:253]
    v_cvt_pk_bf16_f32 v152, v156, v157
    v_cvt_pk_bf16_f32 v153, v158, v159
    v_cvt_pk_bf16_f32 v154, v160, v161
    v_cvt_pk_bf16_f32 v155, v162, v163
    v_accvgpr_read_b32 v168, a108
    v_accvgpr_read_b32 v169, a109
    v_accvgpr_read_b32 v170, a110
    v_accvgpr_read_b32 v171, a111
    v_accvgpr_read_b32 v172, a124
    v_accvgpr_read_b32 v173, a125
    v_accvgpr_read_b32 v174, a126
    v_accvgpr_read_b32 v175, a127
    v_pk_mul_f32 v[168:169], v[168:169], v[252:253]
    v_pk_mul_f32 v[170:171], v[170:171], v[252:253]
    v_pk_mul_f32 v[172:173], v[172:173], v[252:253]
    v_pk_mul_f32 v[174:175], v[174:175], v[252:253]
    v_cvt_pk_bf16_f32 v164, v168, v169
    v_cvt_pk_bf16_f32 v165, v170, v171
    v_cvt_pk_bf16_f32 v166, v172, v173
    v_cvt_pk_bf16_f32 v167, v174, v175
    buffer_store_dwordx4 v[128:131], v1, s[24:27], s48 offen sc1
    buffer_store_dwordx4 v[140:143], v1, s[24:27], s49 offen sc1
    buffer_store_dwordx4 v[152:155], v1, s[24:27], s50 offen sc1
    buffer_store_dwordx4 v[164:167], v1, s[24:27], s51 offen sc1
op_head:
    s_load_dwordx2 s[28:29], s[0:1], 0
    s_load_dwordx2 s[42:43], s[0:1], 56
    s_waitcnt vmcnt(8)
    v_cmp_le_u32 vcc, 4, v74
    v_mov_b32 v56, 0
    v_mov_b32 v57, 0
    v_mov_b32 v58, 0
    v_mov_b32 v59, 0
    s_nop 1
    v_mfma_f32_32x32x16_bf16 v[128:143], v[56:59], v[56:59], 0
    v_mfma_f32_32x32x16_bf16 v[144:159], v[56:59], v[56:59], 0
    v_mfma_f32_32x32x16_bf16 v[160:175], v[56:59], v[56:59], 0
    v_mfma_f32_32x32x16_bf16 v[176:191], v[56:59], v[56:59], 0
    s_mov_b32 s33, vcc_lo
    s_bitcmp1_b32 s33, 0
    s_cbranch_scc0 op_late_125
    buffer_load_dwordx4 a[128:131], v88, s[8:11], s62 offen offset:0 sc1
    buffer_load_dwordx4 a[132:135], v88, s[8:11], s62 offen offset:1024 sc1
    buffer_load_dwordx4 a[136:139], v89, s[8:11], s62 offen offset:0 sc1
    buffer_load_dwordx4 a[140:143], v89, s[8:11], s62 offen offset:1024 sc1
    s_add_u32 s62, s62, 0x40000
    s_and_b32 s62, s62, 0x7fffff
    buffer_load_dwordx4 a[144:147], v88, s[8:11], s62 offen offset:0 sc1
    buffer_load_dwordx4 a[148:151], v88, s[8:11], s62 offen offset:1024 sc1
    buffer_load_dwordx4 a[152:155], v89, s[8:11], s62 offen offset:0 sc1
    buffer_load_dwordx4 a[156:159], v89, s[8:11], s62 offen offset:1024 sc1
    s_add_u32 s62, s62, 0x40000
    s_and_b32 s62, s62, 0x7fffff
    buffer_load_dwordx4 a[160:163], v88, s[8:11], s62 offen offset:0 sc1
    buffer_load_dwordx4 a[164:167], v88, s[8:11], s62 offen offset:1024 sc1
    buffer_load_dwordx4 a[168:171], v89, s[8:11], s62 offen offset:0 sc1
    buffer_load_dwordx4 a[172:175], v89, s[8:11], s62 offen offset:1024 sc1
    s_add_u32 s62, s62, 0x40000
    s_and_b32 s62, s62, 0x7fffff
    s_waitcnt vmcnt(12)
    s_branch op_join_126
op_late_125:
    s_waitcnt vmcnt(0)
op_join_126:
    s_barrier
    s_cmp_eq_u32 s30, 0
    s_cbranch_scc1 k12_ool_127
k12_oolret_128:
    s_bitcmp0_b32 s33, 0
    s_cbranch_scc1 k12_ool_131
k12_oolret_132:
    ds_read_b64_tr_b16 a[0:1], v64 offset:0
    ds_read_b64_tr_b16 a[2:3], v64 offset:4096
    ds_read_b64_tr_b16 a[4:5], v65 offset:0
    ds_read_b64_tr_b16 a[6:7], v65 offset:4096
    ds_read_b64_tr_b16 a[8:9], v66 offset:0
    ds_read_b64_tr_b16 a[10:11], v66 offset:4096
    ds_read_b64_tr_b16 a[12:13], v67 offset:0
    ds_read_b64_tr_b16 a[14:15], v67 offset:4096
    ds_read_b64_tr_b16 a[16:17], v68 offset:0
    ds_read_b64_tr_b16 a[18:19], v68 offset:4096
    ds_read_b64_tr_b16 a[20:21], v69 offset:0
    ds_read_b64_tr_b16 a[22:23], v69 offset:4096
    ds_read_b64_tr_b16 a[24:25], v70 offset:0
    ds_read_b64_tr_b16 a[26:27], v70 offset:4096
    ds_read_b64_tr_b16 a[28:29], v71 offset:0
    ds_read_b64_tr_b16 a[30:31], v71 offset:4096
    ds_read_b64_tr_b16 a[32:33], v64 offset:8192
    ds_read_b64_tr_b16 a[34:35], v64 offset:12288
    ds_read_b64_tr_b16 a[36:37], v65 offset:8192
    ds_read_b64_tr_b16 a[38:39], v65 offset:12288
    ds_read_b64_tr_b16 a[40:41], v66 offset:8192
    ds_read_b64_tr_b16 a[42:43], v66 offset:12288
    ds_read_b64_tr_b16 a[44:45], v67 offset:8192
    ds_read_b64_tr_b16 a[46:47], v67 offset:12288
    ds_read_b64_tr_b16 a[48:49], v68 offset:8192
    ds_read_b64_tr_b16 a[50:51], v68 offset:12288
    ds_read_b64_tr_b16 a[52:53], v69 offset:8192
    ds_read_b64_tr_b16 a[54:55], v69 offset:12288
    ds_read_b64_tr_b16 a[56:57], v70 offset:8192
    ds_read_b64_tr_b16 a[58:59], v70 offset:12288
    ds_read_b64_tr_b16 a[60:61], v71 offset:8192
    ds_read_b64_tr_b16 a[62:63], v71 offset:12288
    s_add_u32 s24, s6, 0x4000000
    s_addc_u32 s25, s7, 0
    s_and_b32 s25, s25, 0xffff
    s_mov_b32 s26, 0x400000
    s_mov_b32 s27, 0x00020000
    s_add_u32 s36, s6, 0x5000000
    s_addc_u32 s37, s7, 0
    s_and_b32 s37, s37, 0xffff
    s_mov_b32 s38, 0x800000
    s_mov_b32 s39, 0x00020000
    s_add_u32 s48, s6, 0x4807000
    s_addc_u32 s49, s7, 0
    s_and_b32 s49, s49, 0xffff
    s_mov_b32 s50, 0x8000
    s_mov_b32 s51, 0x00020000
    s_lshl_b32 s52, s2, 14
    s_add_u32 s52, s52, s60
    s_xor_b32 s53, s52, 0x10000
    s_lshl_b32 s57, s2, 7
    s_xor_b32 s58, s57, 0x200
    v_lshrrev_b32 v56, 4, v1
    s_lshl_b32 s31, s30, 6
    s_and_b32 s31, s31, 64
    v_add_u32 v56, s31, v56
    s_mov_b32 s31, (code_end-op_tail)/128
    v_min_u32 v56, s31, v56
    s_getpc_b64 s[40:41]
pc_133:
    s_add_u32 s40, s40, op_tail-pc_133
    s_addc_u32 s41, s41, 0
    v_lshlrev_b32 v82, 7, v56
    v_mov_b32 v83, s41
    v_add_co_u32 v82, vcc, s40, v82
    s_nop 1
    v_addc_co_u32 v83, vcc, 0, v83, vcc
    v_lshlrev_b32 v94, 3, v1
    s_and_b32 s35, s2, 7
    s_mul_i32 s35, s35, 28
    s_lshr_b32 s31, s2, 3
    s_add_u32 s55, s35, s31
    s_lshl_b32 s3, s55, 15
    s_lshl_b32 s31, s30, 13
    s_add_u32 s3, s3, s31
    s_add_u32 s35, s31, 65536
    s_mov_b32 s63, 0
    s_waitcnt vmcnt(8) lgkmcnt(0)
    s_mov_b32 s20, s28
    s_and_b32 s21, s29, 0xffff
    s_mov_b32 s22, 0x400000
    s_mov_b32 s23, 0x00020000
    s_mov_b32 s44, s42
    s_and_b32 s45, s43, 0xffff
    s_mov_b32 s46, 0x800
    s_mov_b32 s47, 0x00020000
op_loop_134:
    v_mfma_f32_16x16x32_bf16 v[160:163], a[16:19], a[128:131], v[160:163]
    s_add_u32 m0, s60, 49152
    ds_read_b64_tr_b16 a[64:65], v64 offset:16384
    ds_read_b64_tr_b16 a[66:67], v64 offset:20480
    v_mfma_f32_16x16x32_bf16 v[160:163], a[48:51], a[136:139], v[160:163]
    buffer_load_dwordx4 v90, s[12:15], s61 offen offset:0 lds
    ds_read_b64_tr_b16 a[68:69], v65 offset:16384
    v_mfma_f32_16x16x32_bf16 v[164:167], a[48:51], a[140:143], v[164:167]
    ds_read_b64_tr_b16 a[70:71], v65 offset:20480
    ds_read_b64_tr_b16 a[72:73], v66 offset:16384
    v_mfma_f32_16x16x32_bf16 v[164:167], a[16:19], a[132:135], v[164:167]
    buffer_load_dwordx4 v91, s[12:15], s61 offen offset:1024 lds
    ds_read_b64_tr_b16 a[74:75], v66 offset:20480
    v_mfma_f32_16x16x32_bf16 v[172:175], a[20:23], a[132:135], v[172:175]
    ds_read_b64_tr_b16 a[76:77], v67 offset:16384
    ds_read_b64_tr_b16 a[78:79], v67 offset:20480
    v_mfma_f32_16x16x32_bf16 v[172:175], a[52:55], a[140:143], v[172:175]
    ds_read_b64_tr_b16 a[80:81], v68 offset:16384
    v_mfma_f32_16x16x32_bf16 v[168:171], a[52:55], a[136:139], v[168:171]
    ds_read_b64_tr_b16 a[82:83], v68 offset:20480
    v_mfma_f32_16x16x32_bf16 v[168:171], a[20:23], a[128:131], v[168:171]
    buffer_load_dwordx4 v92, s[12:15], s61 offen offset:2048 lds
    ds_read_b64_tr_b16 a[84:85], v69 offset:16384
    v_mfma_f32_16x16x32_bf16 v[176:179], a[24:27], a[128:131], v[176:179]
    ds_read_b64_tr_b16 a[86:87], v69 offset:20480
    ds_read_b64_tr_b16 a[88:89], v70 offset:16384
    v_mfma_f32_16x16x32_bf16 v[176:179], a[56:59], a[136:139], v[176:179]
    ds_read_b64_tr_b16 a[90:91], v70 offset:20480
    v_mfma_f32_16x16x32_bf16 v[180:183], a[56:59], a[140:143], v[180:183]
    buffer_load_dwordx4 v93, s[12:15], s61 offen offset:3072 lds
    ds_read_b64_tr_b16 a[92:93], v71 offset:16384
    v_mfma_f32_16x16x32_bf16 v[180:183], a[24:27], a[132:135], v[180:183]
    ds_read_b64_tr_b16 a[94:95], v71 offset:20480
    ds_read_b64_tr_b16 a[96:97], v64 offset:24576
    v_mfma_f32_16x16x32_bf16 v[188:191], a[28:31], a[132:135], v[188:191]
    ds_read_b64_tr_b16 a[98:99], v64 offset:28672
    v_mfma_f32_16x16x32_bf16 v[188:191], a[60:63], a[140:143], v[188:191]
    ds_read_b64_tr_b16 a[100:101], v65 offset:24576
    v_mfma_f32_16x16x32_bf16 v[184:187], a[60:63], a[136:139], v[184:187]
    buffer_load_dwordx4 a[176:179], v88, s[8:11], s62 offen offset:0 sc1
    ds_read_b64_tr_b16 a[102:103], v65 offset:28672
    v_mfma_f32_16x16x32_bf16 v[184:187], a[28:31], a[128:131], v[184:187]
    s_add_u32 s61, s61, 0x20000
    s_and_b32 s61, s61, 0x3fffff
    ds_read_b64_tr_b16 a[104:105], v66 offset:24576
    ds_read_b64_tr_b16 a[106:107], v66 offset:28672
    v_mfma_f32_16x16x32_bf16 v[128:131], a[0:3], a[128:131], v[128:131]
    ds_read_b64_tr_b16 a[108:109], v67 offset:24576
    v_mfma_f32_16x16x32_bf16 v[128:131], a[32:35], a[136:139], v[128:131]
    buffer_load_dwordx4 a[180:183], v88, s[8:11], s62 offen offset:1024 sc1
    ds_read_b64_tr_b16 a[110:111], v67 offset:28672
    v_mfma_f32_16x16x32_bf16 v[132:135], a[32:35], a[140:143], v[132:135]
    ds_read_b64_tr_b16 a[112:113], v68 offset:24576
    v_mfma_f32_16x16x32_bf16 v[132:135], a[0:3], a[132:135], v[132:135]
    ds_read_b64_tr_b16 a[114:115], v68 offset:28672
    ds_read_b64_tr_b16 a[116:117], v69 offset:24576
    v_mfma_f32_16x16x32_bf16 v[140:143], a[4:7], a[132:135], v[140:143]
    ds_read_b64_tr_b16 a[118:119], v69 offset:28672
    v_mfma_f32_16x16x32_bf16 v[140:143], a[36:39], a[140:143], v[140:143]
    buffer_load_dwordx4 a[184:187], v89, s[8:11], s62 offen offset:0 sc1
    ds_read_b64_tr_b16 a[120:121], v70 offset:24576
    v_mfma_f32_16x16x32_bf16 v[136:139], a[36:39], a[136:139], v[136:139]
    ds_read_b64_tr_b16 a[122:123], v70 offset:28672
    ds_read_b64_tr_b16 a[124:125], v71 offset:24576
    v_mfma_f32_16x16x32_bf16 v[136:139], a[4:7], a[128:131], v[136:139]
    ds_read_b64_tr_b16 a[126:127], v71 offset:28672
    v_mfma_f32_16x16x32_bf16 v[144:147], a[8:11], a[128:131], v[144:147]
    buffer_load_dwordx4 a[188:191], v89, s[8:11], s62 offen offset:1024 sc1
    v_mfma_f32_16x16x32_bf16 v[144:147], a[40:43], a[136:139], v[144:147]
    v_mfma_f32_16x16x32_bf16 v[148:151], a[40:43], a[140:143], v[148:151]
    v_mfma_f32_16x16x32_bf16 v[148:151], a[8:11], a[132:135], v[148:151]
    v_mfma_f32_16x16x32_bf16 v[156:159], a[12:15], a[132:135], v[156:159]
    s_cmp_eq_u32 s63, 7
    s_cbranch_scc1 k12_ool_137
k12_oolret_138:
    v_mfma_f32_16x16x32_bf16 v[156:159], a[44:47], a[140:143], v[156:159]
    s_add_u32 s62, s62, 0x40000
    s_and_b32 s62, s62, 0x7fffff
    v_mfma_f32_16x16x32_bf16 v[152:155], a[44:47], a[136:139], v[152:155]
    v_mfma_f32_16x16x32_bf16 v[152:155], a[12:15], a[128:131], v[152:155]
    s_waitcnt vmcnt(12) lgkmcnt(0)
    s_barrier
    v_mfma_f32_16x16x32_bf16 v[160:163], a[80:83], a[144:147], v[160:163]
    s_add_u32 s32, s63, 1
    s_lshr_b32 s32, s32, 1
    ds_read_b64_tr_b16 a[0:1], v64 offset:32768
    v_cmp_le_u32 vcc, 4, v74
    v_mfma_f32_16x16x32_bf16 v[160:163], a[112:115], a[152:155], v[160:163]
    s_add_u32 m0, s60, 0
    ds_read_b64_tr_b16 a[2:3], v64 offset:36864
    ds_read_b64_tr_b16 a[4:5], v65 offset:32768
    v_mfma_f32_16x16x32_bf16 v[164:167], a[112:115], a[156:159], v[164:167]
    s_or_b32 s33, vcc_lo, 16
    buffer_load_dwordx4 v90, s[12:15], s61 offen offset:0 lds
    ds_read_b64_tr_b16 a[6:7], v65 offset:36864
    v_mfma_f32_16x16x32_bf16 v[164:167], a[80:83], a[148:151], v[164:167]
    ds_read_b64_tr_b16 a[8:9], v66 offset:32768
    ds_read_b64_tr_b16 a[10:11], v66 offset:36864
    v_mfma_f32_16x16x32_bf16 v[172:175], a[84:87], a[148:151], v[172:175]
    buffer_load_dwordx4 v91, s[12:15], s61 offen offset:1024 lds
    ds_read_b64_tr_b16 a[12:13], v67 offset:32768
    v_mfma_f32_16x16x32_bf16 v[172:175], a[116:119], a[156:159], v[172:175]
    ds_read_b64_tr_b16 a[14:15], v67 offset:36864
    ds_read_b64_tr_b16 a[16:17], v68 offset:32768
    v_mfma_f32_16x16x32_bf16 v[168:171], a[116:119], a[152:155], v[168:171]
    s_bitcmp0_b32 s33, s32
    s_cbranch_scc1 k12_ool_141
k12_oolret_142:
    v_mfma_f32_16x16x32_bf16 v[168:171], a[84:87], a[144:147], v[168:171]
    ds_read_b64_tr_b16 a[18:19], v68 offset:36864
    ds_read_b64_tr_b16 a[20:21], v69 offset:32768
    v_mfma_f32_16x16x32_bf16 v[176:179], a[88:91], a[144:147], v[176:179]
    buffer_load_dwordx4 v92, s[12:15], s61 offen offset:2048 lds
    ds_read_b64_tr_b16 a[22:23], v69 offset:36864
    v_mfma_f32_16x16x32_bf16 v[176:179], a[120:123], a[152:155], v[176:179]
    ds_read_b64_tr_b16 a[24:25], v70 offset:32768
    ds_read_b64_tr_b16 a[26:27], v70 offset:36864
    v_mfma_f32_16x16x32_bf16 v[180:183], a[120:123], a[156:159], v[180:183]
    buffer_load_dwordx4 v93, s[12:15], s61 offen offset:3072 lds
    ds_read_b64_tr_b16 a[28:29], v71 offset:32768
    v_mfma_f32_16x16x32_bf16 v[180:183], a[88:91], a[148:151], v[180:183]
    ds_read_b64_tr_b16 a[30:31], v71 offset:36864
    ds_read_b64_tr_b16 a[32:33], v64 offset:40960
    v_mfma_f32_16x16x32_bf16 v[188:191], a[92:95], a[148:151], v[188:191]
    ds_read_b64_tr_b16 a[34:35], v64 offset:45056
    v_mfma_f32_16x16x32_bf16 v[188:191], a[124:127], a[156:159], v[188:191]
    ds_read_b64_tr_b16 a[36:37], v65 offset:40960
    v_mfma_f32_16x16x32_bf16 v[184:187], a[124:127], a[152:155], v[184:187]
    buffer_load_dwordx4 a[128:131], v88, s[8:11], s62 offen offset:0 sc1
    ds_read_b64_tr_b16 a[38:39], v65 offset:45056
    v_mfma_f32_16x16x32_bf16 v[184:187], a[92:95], a[144:147], v[184:187]
    s_add_u32 s61, s61, 0x20000
    s_and_b32 s61, s61, 0x3fffff
    ds_read_b64_tr_b16 a[40:41], v66 offset:40960
    ds_read_b64_tr_b16 a[42:43], v66 offset:45056
    v_mfma_f32_16x16x32_bf16 v[128:131], a[64:67], a[144:147], v[128:131]
    ds_read_b64_tr_b16 a[44:45], v67 offset:40960
    v_mfma_f32_16x16x32_bf16 v[128:131], a[96:99], a[152:155], v[128:131]
    buffer_load_dwordx4 a[132:135], v88, s[8:11], s62 offen offset:1024 sc1
    ds_read_b64_tr_b16 a[46:47], v67 offset:45056
    v_mfma_f32_16x16x32_bf16 v[132:135], a[96:99], a[156:159], v[132:135]
    ds_read_b64_tr_b16 a[48:49], v68 offset:40960
    v_mfma_f32_16x16x32_bf16 v[132:135], a[64:67], a[148:151], v[132:135]
    ds_read_b64_tr_b16 a[50:51], v68 offset:45056
    ds_read_b64_tr_b16 a[52:53], v69 offset:40960
    v_mfma_f32_16x16x32_bf16 v[140:143], a[68:71], a[148:151], v[140:143]
    ds_read_b64_tr_b16 a[54:55], v69 offset:45056
    v_mfma_f32_16x16x32_bf16 v[140:143], a[100:103], a[156:159], v[140:143]
    buffer_load_dwordx4 a[136:139], v89, s[8:11], s62 offen offset:0 sc1
    ds_read_b64_tr_b16 a[56:57], v70 offset:40960
    v_mfma_f32_16x16x32_bf16 v[136:139], a[100:103], a[152:155], v[136:139]
    ds_read_b64_tr_b16 a[58:59], v70 offset:45056
    ds_read_b64_tr_b16 a[60:61], v71 offset:40960
    v_mfma_f32_16x16x32_bf16 v[136:139], a[68:71], a[144:147], v[136:139]
    ds_read_b64_tr_b16 a[62:63], v71 offset:45056
    v_mfma_f32_16x16x32_bf16 v[144:147], a[72:75], a[144:147], v[144:147]
    buffer_load_dwordx4 a[140:143], v89, s[8:11], s62 offen offset:1024 sc1
    v_mfma_f32_16x16x32_bf16 v[144:147], a[104:107], a[152:155], v[144:147]
    v_mfma_f32_16x16x32_bf16 v[148:151], a[104:107], a[156:159], v[148:151]
    s_cmp_eq_u32 s63, 6
    s_cbranch_scc1 k12_ool_143
k12_oolret_144:
    v_mfma_f32_16x16x32_bf16 v[148:151], a[72:75], a[148:151], v[148:151]
    v_mfma_f32_16x16x32_bf16 v[156:159], a[76:79], a[148:151], v[156:159]
    v_mfma_f32_16x16x32_bf16 v[156:159], a[108:111], a[156:159], v[156:159]
    s_add_u32 s62, s62, 0x40000
    s_and_b32 s62, s62, 0x7fffff
    v_mfma_f32_16x16x32_bf16 v[152:155], a[108:111], a[152:155], v[152:155]
    v_mfma_f32_16x16x32_bf16 v[152:155], a[76:79], a[144:147], v[152:155]
    s_waitcnt vmcnt(12) lgkmcnt(0)
    s_barrier
    v_mfma_f32_16x16x32_bf16 v[160:163], a[16:19], a[160:163], v[160:163]
    s_add_u32 m0, s60, 16384
    buffer_load_dword v74, v73, s[16:19], s59 offen sc1
    ds_read_b64_tr_b16 a[64:65], v64 offset:49152
    v_mfma_f32_16x16x32_bf16 v[160:163], a[48:51], a[168:171], v[160:163]
    buffer_load_dwordx4 v90, s[12:15], s61 offen offset:0 lds
    ds_read_b64_tr_b16 a[66:67], v64 offset:53248
    v_mfma_f32_16x16x32_bf16 v[164:167], a[48:51], a[172:175], v[164:167]
    ds_read_b64_tr_b16 a[68:69], v65 offset:49152
    ds_read_b64_tr_b16 a[70:71], v65 offset:53248
    v_mfma_f32_16x16x32_bf16 v[164:167], a[16:19], a[164:167], v[164:167]
    ds_read_b64_tr_b16 a[72:73], v66 offset:49152
    ds_read_b64_tr_b16 a[74:75], v66 offset:53248
    v_mfma_f32_16x16x32_bf16 v[172:175], a[20:23], a[164:167], v[172:175]
    buffer_load_dwordx4 v91, s[12:15], s61 offen offset:1024 lds
    ds_read_b64_tr_b16 a[76:77], v67 offset:49152
    v_mfma_f32_16x16x32_bf16 v[172:175], a[52:55], a[172:175], v[172:175]
    ds_read_b64_tr_b16 a[78:79], v67 offset:53248
    ds_read_b64_tr_b16 a[80:81], v68 offset:49152
    v_mfma_f32_16x16x32_bf16 v[168:171], a[52:55], a[168:171], v[168:171]
    ds_read_b64_tr_b16 a[82:83], v68 offset:53248
    v_mfma_f32_16x16x32_bf16 v[168:171], a[20:23], a[160:163], v[168:171]
    buffer_load_dwordx4 v92, s[12:15], s61 offen offset:2048 lds
    ds_read_b64_tr_b16 a[84:85], v69 offset:49152
    v_mfma_f32_16x16x32_bf16 v[176:179], a[24:27], a[160:163], v[176:179]
    ds_read_b64_tr_b16 a[86:87], v69 offset:53248
    ds_read_b64_tr_b16 a[88:89], v70 offset:49152
    v_mfma_f32_16x16x32_bf16 v[176:179], a[56:59], a[168:171], v[176:179]
    ds_read_b64_tr_b16 a[90:91], v70 offset:53248
    v_mfma_f32_16x16x32_bf16 v[180:183], a[56:59], a[172:175], v[180:183]
    buffer_load_dwordx4 v93, s[12:15], s61 offen offset:3072 lds
    ds_read_b64_tr_b16 a[92:93], v71 offset:49152
    v_mfma_f32_16x16x32_bf16 v[180:183], a[24:27], a[164:167], v[180:183]
    ds_read_b64_tr_b16 a[94:95], v71 offset:53248
    ds_read_b64_tr_b16 a[96:97], v64 offset:57344
    v_mfma_f32_16x16x32_bf16 v[188:191], a[28:31], a[164:167], v[188:191]
    ds_read_b64_tr_b16 a[98:99], v64 offset:61440
    v_mfma_f32_16x16x32_bf16 v[188:191], a[60:63], a[172:175], v[188:191]
    ds_read_b64_tr_b16 a[100:101], v65 offset:57344
    v_mfma_f32_16x16x32_bf16 v[184:187], a[60:63], a[168:171], v[184:187]
    buffer_load_dwordx4 a[144:147], v88, s[8:11], s62 offen offset:0 sc1
    ds_read_b64_tr_b16 a[102:103], v65 offset:61440
    v_mfma_f32_16x16x32_bf16 v[184:187], a[28:31], a[160:163], v[184:187]
    s_add_u32 s61, s61, 0x20000
    s_and_b32 s61, s61, 0x3fffff
    ds_read_b64_tr_b16 a[104:105], v66 offset:57344
    ds_read_b64_tr_b16 a[106:107], v66 offset:61440
    v_mfma_f32_16x16x32_bf16 v[128:131], a[0:3], a[160:163], v[128:131]
    ds_read_b64_tr_b16 a[108:109], v67 offset:57344
    v_mfma_f32_16x16x32_bf16 v[128:131], a[32:35], a[168:171], v[128:131]
    buffer_load_dwordx4 a[148:151], v88, s[8:11], s62 offen offset:1024 sc1
    ds_read_b64_tr_b16 a[110:111], v67 offset:61440
    v_mfma_f32_16x16x32_bf16 v[132:135], a[32:35], a[172:175], v[132:135]
    ds_read_b64_tr_b16 a[112:113], v68 offset:57344
    v_mfma_f32_16x16x32_bf16 v[132:135], a[0:3], a[164:167], v[132:135]
    ds_read_b64_tr_b16 a[114:115], v68 offset:61440
    ds_read_b64_tr_b16 a[116:117], v69 offset:57344
    v_mfma_f32_16x16x32_bf16 v[140:143], a[4:7], a[164:167], v[140:143]
    ds_read_b64_tr_b16 a[118:119], v69 offset:61440
    v_mfma_f32_16x16x32_bf16 v[140:143], a[36:39], a[172:175], v[140:143]
    buffer_load_dwordx4 a[152:155], v89, s[8:11], s62 offen offset:0 sc1
    ds_read_b64_tr_b16 a[120:121], v70 offset:57344
    v_mfma_f32_16x16x32_bf16 v[136:139], a[36:39], a[168:171], v[136:139]
    ds_read_b64_tr_b16 a[122:123], v70 offset:61440
    ds_read_b64_tr_b16 a[124:125], v71 offset:57344
    v_mfma_f32_16x16x32_bf16 v[136:139], a[4:7], a[160:163], v[136:139]
    ds_read_b64_tr_b16 a[126:127], v71 offset:61440
    v_mfma_f32_16x16x32_bf16 v[144:147], a[8:11], a[160:163], v[144:147]
    buffer_load_dwordx4 a[156:159], v89, s[8:11], s62 offen offset:1024 sc1
    v_mfma_f32_16x16x32_bf16 v[144:147], a[40:43], a[168:171], v[144:147]
    v_mfma_f32_16x16x32_bf16 v[148:151], a[40:43], a[172:175], v[148:151]
    v_mfma_f32_16x16x32_bf16 v[148:151], a[8:11], a[164:167], v[148:151]
    v_mfma_f32_16x16x32_bf16 v[156:159], a[12:15], a[164:167], v[156:159]
    v_mfma_f32_16x16x32_bf16 v[156:159], a[44:47], a[172:175], v[156:159]
    s_add_u32 s62, s62, 0x40000
    s_and_b32 s62, s62, 0x7fffff
    v_mfma_f32_16x16x32_bf16 v[152:155], a[44:47], a[168:171], v[152:155]
    v_mfma_f32_16x16x32_bf16 v[152:155], a[12:15], a[160:163], v[152:155]
    s_waitcnt vmcnt(12) lgkmcnt(0)
    s_barrier
    v_mfma_f32_16x16x32_bf16 v[160:163], a[80:83], a[176:179], v[160:163]
    s_add_u32 m0, s60, 32768
    ds_read_b64_tr_b16 a[0:1], v64 offset:0
    ds_read_b64_tr_b16 a[2:3], v64 offset:4096
    v_mfma_f32_16x16x32_bf16 v[160:163], a[112:115], a[184:187], v[160:163]
    buffer_load_dwordx4 v90, s[12:15], s61 offen offset:0 lds
    ds_read_b64_tr_b16 a[4:5], v65 offset:0
    v_mfma_f32_16x16x32_bf16 v[164:167], a[112:115], a[188:191], v[164:167]
    ds_read_b64_tr_b16 a[6:7], v65 offset:4096
    ds_read_b64_tr_b16 a[8:9], v66 offset:0
    v_mfma_f32_16x16x32_bf16 v[164:167], a[80:83], a[180:183], v[164:167]
    buffer_load_dwordx4 v91, s[12:15], s61 offen offset:1024 lds
    ds_read_b64_tr_b16 a[10:11], v66 offset:4096
    v_mfma_f32_16x16x32_bf16 v[172:175], a[84:87], a[180:183], v[172:175]
    ds_read_b64_tr_b16 a[12:13], v67 offset:0
    ds_read_b64_tr_b16 a[14:15], v67 offset:4096
    v_mfma_f32_16x16x32_bf16 v[172:175], a[116:119], a[188:191], v[172:175]
    ds_read_b64_tr_b16 a[16:17], v68 offset:0
    v_mfma_f32_16x16x32_bf16 v[168:171], a[116:119], a[184:187], v[168:171]
    ds_read_b64_tr_b16 a[18:19], v68 offset:4096
    v_mfma_f32_16x16x32_bf16 v[168:171], a[84:87], a[176:179], v[168:171]
    buffer_load_dwordx4 v92, s[12:15], s61 offen offset:2048 lds
    ds_read_b64_tr_b16 a[20:21], v69 offset:0
    v_mfma_f32_16x16x32_bf16 v[176:179], a[88:91], a[176:179], v[176:179]
    ds_read_b64_tr_b16 a[22:23], v69 offset:4096
    ds_read_b64_tr_b16 a[24:25], v70 offset:0
    v_mfma_f32_16x16x32_bf16 v[176:179], a[120:123], a[184:187], v[176:179]
    ds_read_b64_tr_b16 a[26:27], v70 offset:4096
    v_mfma_f32_16x16x32_bf16 v[180:183], a[120:123], a[188:191], v[180:183]
    buffer_load_dwordx4 v93, s[12:15], s61 offen offset:3072 lds
    ds_read_b64_tr_b16 a[28:29], v71 offset:0
    v_mfma_f32_16x16x32_bf16 v[180:183], a[88:91], a[180:183], v[180:183]
    ds_read_b64_tr_b16 a[30:31], v71 offset:4096
    ds_read_b64_tr_b16 a[32:33], v64 offset:8192
    v_mfma_f32_16x16x32_bf16 v[188:191], a[92:95], a[180:183], v[188:191]
    ds_read_b64_tr_b16 a[34:35], v64 offset:12288
    v_mfma_f32_16x16x32_bf16 v[188:191], a[124:127], a[188:191], v[188:191]
    ds_read_b64_tr_b16 a[36:37], v65 offset:8192
    v_mfma_f32_16x16x32_bf16 v[184:187], a[124:127], a[184:187], v[184:187]
    buffer_load_dwordx4 a[160:163], v88, s[8:11], s62 offen offset:0 sc1
    ds_read_b64_tr_b16 a[38:39], v65 offset:12288
    v_mfma_f32_16x16x32_bf16 v[184:187], a[92:95], a[176:179], v[184:187]
    s_add_u32 s61, s61, 0x20000
    s_and_b32 s61, s61, 0x3fffff
    ds_read_b64_tr_b16 a[40:41], v66 offset:8192
    ds_read_b64_tr_b16 a[42:43], v66 offset:12288
    v_mfma_f32_16x16x32_bf16 v[128:131], a[64:67], a[176:179], v[128:131]
    ds_read_b64_tr_b16 a[44:45], v67 offset:8192
    v_mfma_f32_16x16x32_bf16 v[128:131], a[96:99], a[184:187], v[128:131]
    buffer_load_dwordx4 a[164:167], v88, s[8:11], s62 offen offset:1024 sc1
    ds_read_b64_tr_b16 a[46:47], v67 offset:12288
    v_mfma_f32_16x16x32_bf16 v[132:135], a[96:99], a[188:191], v[132:135]
    ds_read_b64_tr_b16 a[48:49], v68 offset:8192
    v_mfma_f32_16x16x32_bf16 v[132:135], a[64:67], a[180:183], v[132:135]
    ds_read_b64_tr_b16 a[50:51], v68 offset:12288
    ds_read_b64_tr_b16 a[52:53], v69 offset:8192
    v_mfma_f32_16x16x32_bf16 v[140:143], a[68:71], a[180:183], v[140:143]
    ds_read_b64_tr_b16 a[54:55], v69 offset:12288
    v_mfma_f32_16x16x32_bf16 v[140:143], a[100:103], a[188:191], v[140:143]
    buffer_load_dwordx4 a[168:171], v89, s[8:11], s62 offen offset:0 sc1
    ds_read_b64_tr_b16 a[56:57], v70 offset:8192
    v_mfma_f32_16x16x32_bf16 v[136:139], a[100:103], a[184:187], v[136:139]
    ds_read_b64_tr_b16 a[58:59], v70 offset:12288
    ds_read_b64_tr_b16 a[60:61], v71 offset:8192
    v_mfma_f32_16x16x32_bf16 v[136:139], a[68:71], a[176:179], v[136:139]
    ds_read_b64_tr_b16 a[62:63], v71 offset:12288
    v_mfma_f32_16x16x32_bf16 v[144:147], a[72:75], a[176:179], v[144:147]
    buffer_load_dwordx4 a[172:175], v89, s[8:11], s62 offen offset:1024 sc1
    v_mfma_f32_16x16x32_bf16 v[144:147], a[104:107], a[184:187], v[144:147]
    v_mfma_f32_16x16x32_bf16 v[148:151], a[104:107], a[188:191], v[148:151]
    v_mfma_f32_16x16x32_bf16 v[148:151], a[72:75], a[180:183], v[148:151]
    v_mfma_f32_16x16x32_bf16 v[156:159], a[76:79], a[180:183], v[156:159]
    v_mfma_f32_16x16x32_bf16 v[156:159], a[108:111], a[188:191], v[156:159]
    s_add_u32 s62, s62, 0x40000
    s_and_b32 s62, s62, 0x7fffff
    v_mfma_f32_16x16x32_bf16 v[152:155], a[108:111], a[184:187], v[152:155]
    s_add_u32 s63, s63, 1
    v_mfma_f32_16x16x32_bf16 v[152:155], a[76:79], a[176:179], v[152:155]
    s_waitcnt vmcnt(12) lgkmcnt(0)
    s_barrier
    s_cmp_lt_u32 s63, 8
    s_cbranch_scc1 op_loop_134
op_tail:
    s_nop 1
    v_cvt_pk_bf16_f32 v160, v160, v161
    v_cvt_pk_bf16_f32 v161, v162, v163
    v_cvt_pk_bf16_f32 v162, v164, v165
    v_cvt_pk_bf16_f32 v163, v166, v167
    v_min_u32 v160, -2, v160
    v_min_u32 v161, -2, v161
    v_min_u32 v162, -2, v162
    v_min_u32 v163, -2, v163
    buffer_store_dwordx4 v[160:163], v1, s[36:39], s52 offen offset:0 sc1
    v_cvt_pk_bf16_f32 v168, v168, v169
    v_cvt_pk_bf16_f32 v169, v170, v171
    v_cvt_pk_bf16_f32 v170, v172, v173
    v_cvt_pk_bf16_f32 v171, v174, v175
    v_min_u32 v168, -2, v168
    v_min_u32 v169, -2, v169
    v_min_u32 v170, -2, v170
    v_min_u32 v171, -2, v171
    buffer_store_dwordx4 v[168:171], v1, s[36:39], s52 offen offset:1024 sc1
    v_cvt_pk_bf16_f32 v176, v176, v177
    v_cvt_pk_bf16_f32 v177, v178, v179
    v_cvt_pk_bf16_f32 v178, v180, v181
    v_cvt_pk_bf16_f32 v179, v182, v183
    v_min_u32 v176, -2, v176
    v_min_u32 v177, -2, v177
    v_min_u32 v178, -2, v178
    v_min_u32 v179, -2, v179
    buffer_store_dwordx4 v[176:179], v1, s[36:39], s52 offen offset:2048 sc1
    v_cvt_pk_bf16_f32 v184, v184, v185
    v_cvt_pk_bf16_f32 v185, v186, v187
    v_cvt_pk_bf16_f32 v186, v188, v189
    v_cvt_pk_bf16_f32 v187, v190, v191
    v_min_u32 v184, -2, v184
    v_min_u32 v185, -2, v185
    v_min_u32 v186, -2, v186
    v_min_u32 v187, -2, v187
    buffer_store_dwordx4 v[184:187], v1, s[36:39], s52 offen offset:3072 sc1
    s_add_u32 s32, s6, 0x4800000
    s_addc_u32 s33, s7, 0
    s_and_b32 s33, s33, 0xffff
    s_mov_b32 s34, 0x6000
    s_mov_b32 s35, 0x00020000
    s_waitcnt vmcnt(4) lgkmcnt(0)
    v_lshlrev_b32 v58, 16, v192
    v_and_b32 v59, 0xffff0000, v192
    v_pk_add_f32 v[128:129], v[128:129], v[58:59]
    v_lshlrev_b32 v58, 16, v193
    v_and_b32 v59, 0xffff0000, v193
    v_pk_add_f32 v[130:131], v[130:131], v[58:59]
    v_lshlrev_b32 v58, 16, v200
    v_and_b32 v59, 0xffff0000, v200
    v_pk_add_f32 v[132:133], v[132:133], v[58:59]
    v_lshlrev_b32 v58, 16, v201
    v_and_b32 v59, 0xffff0000, v201
    v_pk_add_f32 v[134:135], v[134:135], v[58:59]
    v_lshlrev_b32 v58, 16, v194
    v_and_b32 v59, 0xffff0000, v194
    v_pk_add_f32 v[136:137], v[136:137], v[58:59]
    v_lshlrev_b32 v58, 16, v195
    v_and_b32 v59, 0xffff0000, v195
    v_pk_add_f32 v[138:139], v[138:139], v[58:59]
    v_lshlrev_b32 v58, 16, v202
    v_and_b32 v59, 0xffff0000, v202
    v_pk_add_f32 v[140:141], v[140:141], v[58:59]
    v_lshlrev_b32 v58, 16, v203
    v_and_b32 v59, 0xffff0000, v203
    v_pk_add_f32 v[142:143], v[142:143], v[58:59]
    v_lshlrev_b32 v58, 16, v196
    v_and_b32 v59, 0xffff0000, v196
    v_pk_add_f32 v[144:145], v[144:145], v[58:59]
    v_lshlrev_b32 v58, 16, v197
    v_and_b32 v59, 0xffff0000, v197
    v_pk_add_f32 v[146:147], v[146:147], v[58:59]
    v_lshlrev_b32 v58, 16, v204
    v_and_b32 v59, 0xffff0000, v204
    v_pk_add_f32 v[148:149], v[148:149], v[58:59]
    v_lshlrev_b32 v58, 16, v205
    v_and_b32 v59, 0xffff0000, v205
    v_pk_add_f32 v[150:151], v[150:151], v[58:59]
    v_lshlrev_b32 v58, 16, v198
    v_and_b32 v59, 0xffff0000, v198
    v_pk_add_f32 v[152:153], v[152:153], v[58:59]
    v_lshlrev_b32 v58, 16, v199
    v_and_b32 v59, 0xffff0000, v199
    v_pk_add_f32 v[154:155], v[154:155], v[58:59]
    v_lshlrev_b32 v58, 16, v206
    v_and_b32 v59, 0xffff0000, v206
    v_pk_add_f32 v[156:157], v[156:157], v[58:59]
    v_lshlrev_b32 v58, 16, v207
    v_and_b32 v59, 0xffff0000, v207
    v_pk_add_f32 v[158:159], v[158:159], v[58:59]
    v_and_b32 v58, 1, v72
    v_lshrrev_b32 v59, 1, v72
    v_lshlrev_b32 v58, 5, v58
    v_lshl_add_u32 v58, v59, 4, v58
    v_lshlrev_b32 v59, 3, v72
    v_sub_u32 v58, v58, v59
    v_add_u32 v78, v78, v58
    v_add_u32 v79, v79, v58
    v_lshlrev_b32 v32, 16, v208
    v_and_b32 v33, 0xffff0000, v208
    v_lshlrev_b32 v34, 16, v209
    v_and_b32 v35, 0xffff0000, v209
    v_lshlrev_b32 v36, 16, v210
    v_and_b32 v37, 0xffff0000, v210
    v_lshlrev_b32 v38, 16, v211
    v_and_b32 v39, 0xffff0000, v211
    v_lshlrev_b32 v40, 16, v212
    v_and_b32 v41, 0xffff0000, v212
    v_lshlrev_b32 v42, 16, v213
    v_and_b32 v43, 0xffff0000, v213
    v_lshlrev_b32 v44, 16, v214
    v_and_b32 v45, 0xffff0000, v214
    v_lshlrev_b32 v46, 16, v215
    v_and_b32 v47, 0xffff0000, v215
    s_or_b32 s31, s54, s30
    s_cbranch_scc1 op_nowr_145
    v_pk_add_f32 v[56:57], v[32:33], v[34:35]
    v_pk_add_f32 v[56:57], v[56:57], v[36:37]
    v_pk_add_f32 v[56:57], v[56:57], v[38:39]
    v_pk_add_f32 v[56:57], v[56:57], v[40:41]
    v_pk_add_f32 v[56:57], v[56:57], v[42:43]
    v_pk_add_f32 v[56:57], v[56:57], v[44:45]
    v_pk_add_f32 v[56:57], v[56:57], v[46:47]
    v_add_f32 v56, v56, v57
    v_mov_b32 v57, v56
    s_nop 1
    v_permlane16_swap_b32 v56, v57
    s_nop 1
    v_add_f32 v56, v56, v57
    v_mov_b32 v57, v56
    s_nop 1
    v_permlane32_swap_b32 v56, v57
    s_nop 1
    v_add_f32 v56, v56, v57
    s_mov_b32 s31, 24704
    s_mov_b32 s34, 24708
    s_mov_b64 exec, 1
    buffer_atomic_add_f32 v56, v75, s[32:35], s31 offen
    s_mov_b64 exec, -1
    s_mov_b32 s34, 24576
op_nowr_145:
    v_mov_b32 v208, 0
    v_mov_b32 v209, 0
    v_mov_b32 v210, 0
    v_mov_b32 v211, 0
    v_mov_b32 v212, 0
    v_mov_b32 v213, 0
    v_mov_b32 v214, 0
    v_mov_b32 v215, 0
    v_mov_b32 v216, 0
    v_mov_b32 v217, 0
    v_mov_b32 v218, 0
    v_mov_b32 v219, 0
    s_mov_b32 s40, 1048576
op_xspin_146:
    buffer_load_dwordx4 v[224:227], v1, s[36:39], s53 offen offset:0 sc1
    buffer_load_dwordx4 v[228:231], v1, s[36:39], s53 offen offset:1024 sc1
    buffer_load_dwordx4 v[232:235], v1, s[36:39], s53 offen offset:2048 sc1
    buffer_load_dwordx4 v[236:239], v1, s[36:39], s53 offen offset:3072 sc1
    s_sub_u32 s40, s40, 1
    s_waitcnt vmcnt(0)
    s_cbranch_scc1 op_xok_147
    v_max3_u32 v56, v224, v225, v226
    v_max3_u32 v56, v56, v227, v228
    v_max3_u32 v56, v56, v229, v230
    v_max3_u32 v56, v56, v231, v232
    v_max3_u32 v56, v56, v233, v234
    v_max3_u32 v56, v56, v235, v236
    v_max3_u32 v56, v56, v237, v238
    v_max_u32 v56, v56, v239
    v_cmp_eq_u32 vcc, -1, v56
    s_cbranch_vccz op_xok_147
    s_sleep 2
    s_branch op_xspin_146
op_xok_147:
    v_lshlrev_b32 v56, 16, v224
    v_and_b32 v57, 0xffff0000, v224
    v_lshlrev_b32 v58, 16, v225
    v_and_b32 v59, 0xffff0000, v225
    v_pk_add_f32 v[128:129], v[128:129], v[56:57]
    v_pk_add_f32 v[130:131], v[130:131], v[58:59]
    v_cvt_pk_bf16_f32 v192, v128, v129
    v_cvt_pk_bf16_f32 v193, v130, v131
    v_lshlrev_b32 v128, 16, v192
    v_and_b32 v129, 0xffff0000, v192
    v_lshlrev_b32 v130, 16, v193
    v_and_b32 v131, 0xffff0000, v193
    v_pk_add_f32 v[208:209], v[208:209], v[128:129]
    v_pk_fma_f32 v[210:211], v[128:129], v[128:129], v[210:211]
    v_pk_fma_f32 v[212:213], v[128:129], v[32:33], v[212:213]
    v_pk_add_f32 v[208:209], v[208:209], v[130:131]
    v_pk_fma_f32 v[210:211], v[130:131], v[130:131], v[210:211]
    v_pk_fma_f32 v[212:213], v[130:131], v[34:35], v[212:213]
    v_lshlrev_b32 v56, 16, v226
    v_and_b32 v57, 0xffff0000, v226
    v_lshlrev_b32 v58, 16, v227
    v_and_b32 v59, 0xffff0000, v227
    v_pk_add_f32 v[132:133], v[132:133], v[56:57]
    v_pk_add_f32 v[134:135], v[134:135], v[58:59]
    v_cvt_pk_bf16_f32 v200, v132, v133
    v_cvt_pk_bf16_f32 v201, v134, v135
    v_lshlrev_b32 v132, 16, v200
    v_and_b32 v133, 0xffff0000, v200
    v_lshlrev_b32 v134, 16, v201
    v_and_b32 v135, 0xffff0000, v201
    v_pk_add_f32 v[214:215], v[214:215], v[132:133]
    v_pk_fma_f32 v[216:217], v[132:133], v[132:133], v[216:217]
    v_pk_fma_f32 v[218:219], v[132:133], v[32:33], v[218:219]
    v_pk_add_f32 v[214:215], v[214:215], v[134:135]
    v_pk_fma_f32 v[216:217], v[134:135], v[134:135], v[216:217]
    v_pk_fma_f32 v[218:219], v[134:135], v[34:35], v[218:219]
    v_lshlrev_b32 v56, 16, v228
    v_and_b32 v57, 0xffff0000, v228
    v_lshlrev_b32 v58, 16, v229
    v_and_b32 v59, 0xffff0000, v229
    v_pk_add_f32 v[136:137], v[136:137], v[56:57]
    v_pk_add_f32 v[138:139], v[138:139], v[58:59]
    v_cvt_pk_bf16_f32 v194, v136, v137
    v_cvt_pk_bf16_f32 v195, v138, v139
    v_lshlrev_b32 v136, 16, v194
    v_and_b32 v137, 0xffff0000, v194
    v_lshlrev_b32 v138, 16, v195
    v_and_b32 v139, 0xffff0000, v195
    v_permlane16_swap_b32 v192, v194
    v_permlane16_swap_b32 v193, v195
    buffer_store_dwordx4 v[192:195], v78, s[24:27], 0 offen offset:0 sc1
    v_pk_add_f32 v[208:209], v[208:209], v[136:137]
    v_pk_fma_f32 v[210:211], v[136:137], v[136:137], v[210:211]
    v_pk_fma_f32 v[212:213], v[136:137], v[36:37], v[212:213]
    v_pk_add_f32 v[208:209], v[208:209], v[138:139]
    v_pk_fma_f32 v[210:211], v[138:139], v[138:139], v[210:211]
    v_pk_fma_f32 v[212:213], v[138:139], v[38:39], v[212:213]
    v_lshlrev_b32 v56, 16, v230
    v_and_b32 v57, 0xffff0000, v230
    v_lshlrev_b32 v58, 16, v231
    v_and_b32 v59, 0xffff0000, v231
    v_pk_add_f32 v[140:141], v[140:141], v[56:57]
    v_pk_add_f32 v[142:143], v[142:143], v[58:59]
    v_cvt_pk_bf16_f32 v202, v140, v141
    v_cvt_pk_bf16_f32 v203, v142, v143
    v_lshlrev_b32 v140, 16, v202
    v_and_b32 v141, 0xffff0000, v202
    v_lshlrev_b32 v142, 16, v203
    v_and_b32 v143, 0xffff0000, v203
    v_permlane16_swap_b32 v200, v202
    v_permlane16_swap_b32 v201, v203
    buffer_store_dwordx4 v[200:203], v79, s[24:27], 0 offen offset:0 sc1
    v_pk_add_f32 v[214:215], v[214:215], v[140:141]
    v_pk_fma_f32 v[216:217], v[140:141], v[140:141], v[216:217]
    v_pk_fma_f32 v[218:219], v[140:141], v[36:37], v[218:219]
    v_pk_add_f32 v[214:215], v[214:215], v[142:143]
    v_pk_fma_f32 v[216:217], v[142:143], v[142:143], v[216:217]
    v_pk_fma_f32 v[218:219], v[142:143], v[38:39], v[218:219]
    v_lshlrev_b32 v56, 16, v232
    v_and_b32 v57, 0xffff0000, v232
    v_lshlrev_b32 v58, 16, v233
    v_and_b32 v59, 0xffff0000, v233
    v_pk_add_f32 v[144:145], v[144:145], v[56:57]
    v_pk_add_f32 v[146:147], v[146:147], v[58:59]
    v_cvt_pk_bf16_f32 v196, v144, v145
    v_cvt_pk_bf16_f32 v197, v146, v147
    v_lshlrev_b32 v144, 16, v196
    v_and_b32 v145, 0xffff0000, v196
    v_lshlrev_b32 v146, 16, v197
    v_and_b32 v147, 0xffff0000, v197
    v_pk_add_f32 v[208:209], v[208:209], v[144:145]
    v_pk_fma_f32 v[210:211], v[144:145], v[144:145], v[210:211]
    v_pk_fma_f32 v[212:213], v[144:145], v[40:41], v[212:213]
    v_pk_add_f32 v[208:209], v[208:209], v[146:147]
    v_pk_fma_f32 v[210:211], v[146:147], v[146:147], v[210:211]
    v_pk_fma_f32 v[212:213], v[146:147], v[42:43], v[212:213]
    v_lshlrev_b32 v56, 16, v234
    v_and_b32 v57, 0xffff0000, v234
    v_lshlrev_b32 v58, 16, v235
    v_and_b32 v59, 0xffff0000, v235
    v_pk_add_f32 v[148:149], v[148:149], v[56:57]
    v_pk_add_f32 v[150:151], v[150:151], v[58:59]
    v_cvt_pk_bf16_f32 v204, v148, v149
    v_cvt_pk_bf16_f32 v205, v150, v151
    v_lshlrev_b32 v148, 16, v204
    v_and_b32 v149, 0xffff0000, v204
    v_lshlrev_b32 v150, 16, v205
    v_and_b32 v151, 0xffff0000, v205
    v_pk_add_f32 v[214:215], v[214:215], v[148:149]
    v_pk_fma_f32 v[216:217], v[148:149], v[148:149], v[216:217]
    v_pk_fma_f32 v[218:219], v[148:149], v[40:41], v[218:219]
    v_pk_add_f32 v[214:215], v[214:215], v[150:151]
    v_pk_fma_f32 v[216:217], v[150:151], v[150:151], v[216:217]
    v_pk_fma_f32 v[218:219], v[150:151], v[42:43], v[218:219]
    v_lshlrev_b32 v56, 16, v236
    v_and_b32 v57, 0xffff0000, v236
    v_lshlrev_b32 v58, 16, v237
    v_and_b32 v59, 0xffff0000, v237
    v_pk_add_f32 v[152:153], v[152:153], v[56:57]
    v_pk_add_f32 v[154:155], v[154:155], v[58:59]
    v_cvt_pk_bf16_f32 v198, v152, v153
    v_cvt_pk_bf16_f32 v199, v154, v155
    v_lshlrev_b32 v152, 16, v198
    v_and_b32 v153, 0xffff0000, v198
    v_lshlrev_b32 v154, 16, v199
    v_and_b32 v155, 0xffff0000, v199
    v_permlane16_swap_b32 v196, v198
    v_permlane16_swap_b32 v197, v199
    buffer_store_dwordx4 v[196:199], v78, s[24:27], 0 offen offset:64 sc1
    v_pk_add_f32 v[208:209], v[208:209], v[152:153]
    v_pk_fma_f32 v[210:211], v[152:153], v[152:153], v[210:211]
    v_pk_fma_f32 v[212:213], v[152:153], v[44:45], v[212:213]
    v_pk_add_f32 v[208:209], v[208:209], v[154:155]
    v_pk_fma_f32 v[210:211], v[154:155], v[154:155], v[210:211]
    v_pk_fma_f32 v[212:213], v[154:155], v[46:47], v[212:213]
    v_lshlrev_b32 v56, 16, v238
    v_and_b32 v57, 0xffff0000, v238
    v_lshlrev_b32 v58, 16, v239
    v_and_b32 v59, 0xffff0000, v239
    v_pk_add_f32 v[156:157], v[156:157], v[56:57]
    v_pk_add_f32 v[158:159], v[158:159], v[58:59]
    v_cvt_pk_bf16_f32 v206, v156, v157
    v_cvt_pk_bf16_f32 v207, v158, v159
    v_lshlrev_b32 v156, 16, v206
    v_and_b32 v157, 0xffff0000, v206
    v_lshlrev_b32 v158, 16, v207
    v_and_b32 v159, 0xffff0000, v207
    v_permlane16_swap_b32 v204, v206
    v_permlane16_swap_b32 v205, v207
    buffer_store_dwordx4 v[204:207], v79, s[24:27], 0 offen offset:64 sc1
    v_pk_add_f32 v[214:215], v[214:215], v[156:157]
    v_pk_fma_f32 v[216:217], v[156:157], v[156:157], v[216:217]
    v_pk_fma_f32 v[218:219], v[156:157], v[44:45], v[218:219]
    v_pk_add_f32 v[214:215], v[214:215], v[158:159]
    v_pk_fma_f32 v[216:217], v[158:159], v[158:159], v[216:217]
    v_pk_fma_f32 v[218:219], v[158:159], v[46:47], v[218:219]
    v_add_f32 v48, v208, v209
    v_add_f32 v49, v210, v211
    v_add_f32 v50, v212, v213
    v_add_f32 v52, v214, v215
    v_add_f32 v53, v216, v217
    v_add_f32 v54, v218, v219
    v_mov_b32 v56, v48
    v_mov_b32 v57, v49
    v_mov_b32 v58, v50
    v_mov_b32 v59, v52
    v_mov_b32 v60, v53
    v_mov_b32 v61, v54
    s_nop 1
    v_permlane16_swap_b32 v48, v56
    v_permlane16_swap_b32 v49, v57
    v_permlane16_swap_b32 v50, v58
    v_permlane16_swap_b32 v52, v59
    v_permlane16_swap_b32 v53, v60
    v_permlane16_swap_b32 v54, v61
    s_nop 1
    v_add_f32 v48, v48, v56
    v_add_f32 v49, v49, v57
    v_add_f32 v50, v50, v58
    v_add_f32 v52, v52, v59
    v_add_f32 v53, v53, v60
    v_add_f32 v54, v54, v61
    v_mov_b32 v56, v48
    v_mov_b32 v57, v49
    v_mov_b32 v58, v50
    v_mov_b32 v59, v52
    v_mov_b32 v60, v53
    v_mov_b32 v61, v54
    s_nop 1
    v_permlane32_swap_b32 v48, v56
    v_permlane32_swap_b32 v49, v57
    v_permlane32_swap_b32 v50, v58
    v_permlane32_swap_b32 v52, v59
    v_permlane32_swap_b32 v53, v60
    v_permlane32_swap_b32 v54, v61
    s_nop 1
    v_add_f32 v48, v48, v56
    v_add_f32 v49, v49, v57
    v_add_f32 v50, v50, v58
    v_add_f32 v52, v52, v59
    v_add_f32 v53, v53, v60
    v_add_f32 v54, v54, v61
    v_cmp_eq_u32 s[40:41], 1, v72
    v_cmp_eq_u32 s[42:43], 2, v72
    s_nop 1
    v_cndmask_b32 v48, v48, v49, s[40:41]
    v_cndmask_b32 v48, v48, v50, s[42:43]
    buffer_atomic_add_f32 v48, v77, s[32:35], 0 offen offset:0
    v_cndmask_b32 v52, v52, v53, s[40:41]
    v_cndmask_b32 v52, v52, v54, s[42:43]
    buffer_atomic_add_f32 v52, v77, s[32:35], 0 offen offset:64
    s_load_dwordx2 s[42:43], s[0:1], 88
    s_load_dwordx2 s[56:57], s[0:1], 56
    s_add_u32 s16, s6, 0x4815000
    s_addc_u32 s17, s7, 0
    s_and_b32 s17, s17, 0xffff
    s_mov_b32 s18, 0x1000
    s_mov_b32 s19, 0x00020000
    v_lshrrev_b32 v3, 4, v1
    v_lshl_add_u32 v2, s30, 6, v3
    v_and_b32 v4, 31, v3
    v_lshrrev_b32 v5, 5, v3
    v_lshlrev_b32 v7, 4, v4
    v_and_b32 v8, 15, v3
    v_lshlrev_b32 v6, 7, v8
    s_bfe_u32 s31, s2, 0x20003
    s_lshl_b32 s31, s31, 7
    v_lshlrev_b32 v12, 9, v3
    v_and_b32 v14, 3, v3
    v_lshlrev_b32 v14, 7, v14
    s_and_b32 s59, s2, 7
    s_lshl_b32 s59, s59, 9
    s_setreg_imm32_b32 hwreg(HW_REG_MODE, 4, 2), 3
    s_waitcnt vmcnt(0) lgkmcnt(0)
    s_barrier
    s_cmp_lg_u32 s30, 0
    s_cbranch_scc1 ff_nosig_148
    s_mov_b64 exec, 0xff
    buffer_atomic_add v76, v12, s[16:19], s31 offen sc1
    s_mov_b64 exec, -1
ff_nosig_148:
    s_lshl_b32 s40, s30, 13
    s_add_u32 m0, s40, 65536
    s_add_u32 s41, s3, 0
    buffer_load_dwordx4 v1, s[44:47], s41 offen offset:0 sc1 lds
    buffer_load_dwordx4 v1, s[44:47], s41 offen offset:1024 sc1 lds
    buffer_load_dwordx4 v1, s[44:47], s41 offen offset:2048 sc1 lds
    buffer_load_dwordx4 v1, s[44:47], s41 offen offset:3072 sc1 lds
    s_waitcnt vmcnt(0)
    s_lshl_b32 s40, s30, 13
    s_add_u32 m0, s40, 69632
    s_add_u32 s41, s3, 4096
    buffer_load_dwordx4 v1, s[44:47], s41 offen offset:0 sc1 lds
    buffer_load_dwordx4 v1, s[44:47], s41 offen offset:1024 sc1 lds
    buffer_load_dwordx4 v1, s[44:47], s41 offen offset:2048 sc1 lds
    buffer_load_dwordx4 v1, s[44:47], s41 offen offset:3072 sc1 lds
    s_waitcnt vmcnt(0)
    s_lshl_b32 s40, s30, 13
    s_add_u32 m0, s40, 98304
    s_add_u32 s41, s3, 8388608
    buffer_load_dwordx4 v1, s[44:47], s41 offen offset:0 sc1 lds
    buffer_load_dwordx4 v1, s[44:47], s41 offen offset:1024 sc1 lds
    buffer_load_dwordx4 v1, s[44:47], s41 offen offset:2048 sc1 lds
    buffer_load_dwordx4 v1, s[44:47], s41 offen offset:3072 sc1 lds
    s_waitcnt vmcnt(0)
    s_lshl_b32 s40, s30, 13
    s_add_u32 m0, s40, 102400
    s_add_u32 s41, s3, 8392704
    buffer_load_dwordx4 v1, s[44:47], s41 offen offset:0 sc1 lds
    buffer_load_dwordx4 v1, s[44:47], s41 offen offset:1024 sc1 lds
    buffer_load_dwordx4 v1, s[44:47], s41 offen offset:2048 sc1 lds
    buffer_load_dwordx4 v1, s[44:47], s41 offen offset:3072 sc1 lds
    s_lshl_b32 s41, s30, 9
    s_add_u32 s41, s41, 131072
    v_lshrrev_b32 v9, 1, v1
    v_add_u32 v9, s41, v9
    ds_read_b64 v[96:97], v9 offset:0
    ds_read_b64 v[98:99], v9 offset:2048
    ds_read_b64 v[100:101], v9 offset:4096
    ds_read_b64 v[102:103], v9 offset:6144
    ds_read_b64 v[104:105], v9 offset:8192
    ds_read_b64 v[106:107], v9 offset:10240
    ds_read_b64 v[108:109], v9 offset:12288
    ds_read_b64 v[110:111], v9 offset:14336
    ds_read_b64 v[112:113], v9 offset:16384
    ds_read_b64 v[114:115], v9 offset:18432
    ds_read_b64 v[116:117], v9 offset:20480
    ds_read_b64 v[118:119], v9 offset:22528
    ds_read_b64 v[120:121], v9 offset:24576
    ds_read_b64 v[122:123], v9 offset:26624
    ds_read_b64 v[124:125], v9 offset:28672
    ds_read_b64 v[126:127], v9 offset:30720
    s_mov_b32 s54, 0x05040100
    s_mov_b32 s53, 0x07060302
    s_waitcnt lgkmcnt(0)
    v_perm_b32 v144, v98, v96, s54
    v_perm_b32 v145, v98, v96, s53
    v_perm_b32 v146, v99, v97, s54
    v_perm_b32 v147, v99, v97, s53
    v_perm_b32 v148, v102, v100, s54
    v_perm_b32 v149, v102, v100, s53
    v_perm_b32 v150, v103, v101, s54
    v_perm_b32 v151, v103, v101, s53
    v_perm_b32 v152, v106, v104, s54
    v_perm_b32 v153, v106, v104, s53
    v_perm_b32 v154, v107, v105, s54
    v_perm_b32 v155, v107, v105, s53
    v_perm_b32 v156, v110, v108, s54
    v_perm_b32 v157, v110, v108, s53
    v_perm_b32 v158, v111, v109, s54
    v_perm_b32 v159, v111, v109, s53
    v_perm_b32 v160, v114, v112, s54
    v_perm_b32 v161, v114, v112, s53
    v_perm_b32 v162, v115, v113, s54
    v_perm_b32 v163, v115, v113, s53
    v_perm_b32 v164, v118, v116, s54
    v_perm_b32 v165, v118, v116, s53
    v_perm_b32 v166, v119, v117, s54
    v_perm_b32 v167, v119, v117, s53
    v_perm_b32 v168, v122, v120, s54
    v_perm_b32 v169, v122, v120, s53
    v_perm_b32 v170, v123, v121, s54
    v_perm_b32 v171, v123, v121, s53
    v_perm_b32 v172, v126, v124, s54
    v_perm_b32 v173, v126, v124, s53
    v_perm_b32 v174, v127, v125, s54
    v_perm_b32 v175, v127, v125, s53
    s_mov_b32 s34, 24708
    s_mov_b32 s36, s42
    s_and_b32 s37, s43, 0xffff
    s_mov_b32 s38, 0x400000
    s_mov_b32 s39, 0x00020000
    s_add_u32 s48, s6, 0x4900000
    s_addc_u32 s49, s7, 0
    s_and_b32 s49, s49, 0xffff
    s_mov_b32 s50, 0x1c0000
    s_mov_b32 s51, 0x00020000
    v_lshlrev_b32 v10, 5, v2
    v_lshl_add_u32 v11, s30, 1, v5
    s_lshl_b32 s31, s2, 3
    v_add_u32 v11, s31, v11
    v_lshl_add_u32 v0, v11, 11, v7
    s_cmp_lg_u32 s30, 0
    s_cbranch_scc1 ff_go_149
    s_mov_b32 s52, 1048576
ff_poll_150:
    buffer_load_dword v13, v14, s[16:19], s59 offen sc1
    s_sub_u32 s52, s52, 1
    s_cbranch_scc1 ff_go_149
    s_waitcnt vmcnt(0)
    v_cmp_gt_u32 vcc, 64, v13
    s_cbranch_vccz ff_go_149
    s_sleep 4
    s_branch ff_poll_150
ff_go_149:
    s_barrier
    s_mov_b32 s31, 0
    buffer_load_dwordx4 v[16:19], v10, s[32:35], s31 offen sc1
    buffer_load_dwordx4 v[20:23], v10, s[32:35], s31 offen offset:16 sc1
    s_mov_b32 s31, 8192
    buffer_load_dwordx4 v[24:27], v10, s[32:35], s31 offen sc1
    buffer_load_dwordx4 v[28:31], v10, s[32:35], s31 offen offset:16 sc1
    s_mov_b32 s31, 16384
    buffer_load_dwordx4 v[32:35], v10, s[32:35], s31 offen sc1
    buffer_load_dwordx4 v[36:39], v10, s[32:35], s31 offen offset:16 sc1
    s_mov_b32 s31, 24704
    buffer_load_dword v10, v75, s[32:35], s31 offen sc1
    s_mov_b32 s52, 0x3a800000
    s_mov_b32 s53, 0x3a800000
    s_mov_b32 s54, 0x7ff
    v_mov_b32 v14, 0x3727c5ac
    v_mov_b32 v15, v14
    v_mov_b32 v12, 0xff800000
    v_mov_b32 v13, v12
    s_waitcnt vmcnt(0)
    v_sub_f32 v56, 0, v10
    v_sub_f32 v57, 0, v10
    v_pk_mul_f32 v[16:17], v[16:17], s[52:53]
    v_pk_fma_f32 v[24:25], v[24:25], s[52:53], v[14:15]
    v_pk_fma_f32 v[32:33], v[16:17], v[56:57], v[32:33]
    v_pk_fma_f32 v[24:25], v[16:17], v[16:17], v[24:25] neg_lo:[1,0,0] neg_hi:[1,0,0]
    v_pk_mul_f32 v[18:19], v[18:19], s[52:53]
    v_pk_fma_f32 v[26:27], v[26:27], s[52:53], v[14:15]
    v_pk_fma_f32 v[34:35], v[18:19], v[56:57], v[34:35]
    v_pk_fma_f32 v[26:27], v[18:19], v[18:19], v[26:27] neg_lo:[1,0,0] neg_hi:[1,0,0]
    v_pk_mul_f32 v[20:21], v[20:21], s[52:53]
    v_pk_fma_f32 v[28:29], v[28:29], s[52:53], v[14:15]
    v_pk_fma_f32 v[36:37], v[20:21], v[56:57], v[36:37]
    v_pk_fma_f32 v[28:29], v[20:21], v[20:21], v[28:29] neg_lo:[1,0,0] neg_hi:[1,0,0]
    v_pk_mul_f32 v[22:23], v[22:23], s[52:53]
    v_pk_fma_f32 v[30:31], v[30:31], s[52:53], v[14:15]
    v_pk_fma_f32 v[38:39], v[22:23], v[56:57], v[38:39]
    v_pk_fma_f32 v[30:31], v[22:23], v[22:23], v[30:31] neg_lo:[1,0,0] neg_hi:[1,0,0]
    v_max_f32 v24, v14, v24
    v_max_f32 v25, v14, v25
    v_max_f32 v26, v14, v26
    v_max_f32 v27, v14, v27
    v_max_f32 v28, v14, v28
    v_max_f32 v29, v14, v29
    v_max_f32 v30, v14, v30
    v_max_f32 v31, v14, v31
    v_rsq_f32 v24, v24
    v_rsq_f32 v25, v25
    v_rsq_f32 v26, v26
    v_rsq_f32 v27, v27
    v_rsq_f32 v28, v28
    v_rsq_f32 v29, v29
    v_rsq_f32 v30, v30
    v_rsq_f32 v31, v31
    v_pk_mul_f32 v[32:33], v[32:33], v[24:25]
    v_pk_mul_f32 v[34:35], v[34:35], v[26:27]
    v_pk_mul_f32 v[36:37], v[36:37], v[28:29]
    v_pk_mul_f32 v[38:39], v[38:39], v[30:31]
    v_bfi_b32 v32, s54, 0, v32
    v_med3_f32 v13, v12, v13, v32
    v_max_f32 v12, v12, v32
    v_bfi_b32 v33, s54, 1, v33
    v_med3_f32 v13, v12, v13, v33
    v_max_f32 v12, v12, v33
    v_bfi_b32 v34, s54, 2, v34
    v_med3_f32 v13, v12, v13, v34
    v_max_f32 v12, v12, v34
    v_bfi_b32 v35, s54, 3, v35
    v_med3_f32 v13, v12, v13, v35
    v_max_f32 v12, v12, v35
    v_bfi_b32 v36, s54, 4, v36
    v_med3_f32 v13, v12, v13, v36
    v_max_f32 v12, v12, v36
    v_bfi_b32 v37, s54, 5, v37
    v_med3_f32 v13, v12, v13, v37
    v_max_f32 v12, v12, v37
    v_bfi_b32 v38, s54, 6, v38
    v_med3_f32 v13, v12, v13, v38
    v_max_f32 v12, v12, v38
    v_bfi_b32 v39, s54, 7, v39
    v_med3_f32 v13, v12, v13, v39
    v_max_f32 v12, v12, v39
    v_lshl_or_b32 v12, v2, 3, v12
    v_lshl_or_b32 v13, v2, 3, v13
    s_nop 1
    v_mov_b32_dpp v14, v12 quad_perm:[1,0,3,2] row_mask:0xf bank_mask:0xf
    v_mov_b32_dpp v15, v13 quad_perm:[1,0,3,2] row_mask:0xf bank_mask:0xf
    v_max_f32 v15, v15, v13
    v_med3_f32 v13, v12, v14, v15
    v_max_f32 v12, v12, v14
    s_nop 1
    v_mov_b32_dpp v14, v12 quad_perm:[2,3,0,1] row_mask:0xf bank_mask:0xf
    v_mov_b32_dpp v15, v13 quad_perm:[2,3,0,1] row_mask:0xf bank_mask:0xf
    v_max_f32 v15, v15, v13
    v_med3_f32 v13, v12, v14, v15
    v_max_f32 v12, v12, v14
    s_nop 1
    v_mov_b32_dpp v14, v12 row_half_mirror row_mask:0xf bank_mask:0xf
    v_mov_b32_dpp v15, v13 row_half_mirror row_mask:0xf bank_mask:0xf
    v_max_f32 v15, v15, v13
    v_med3_f32 v13, v12, v14, v15
    v_max_f32 v12, v12, v14
    s_nop 1
    v_mov_b32_dpp v14, v12 row_mirror row_mask:0xf bank_mask:0xf
    v_mov_b32_dpp v15, v13 row_mirror row_mask:0xf bank_mask:0xf
    v_max_f32 v15, v15, v13
    v_med3_f32 v13, v12, v14, v15
    v_max_f32 v12, v12, v14
    v_mov_b32 v14, v12
    v_mov_b32 v15, v13
    s_nop 1
    v_permlane16_swap_b32 v12, v14
    v_permlane16_swap_b32 v13, v15
    s_nop 1
    v_max_f32 v15, v15, v13
    v_med3_f32 v13, v12, v14, v15
    v_max_f32 v12, v12, v14
    v_mov_b32 v14, v12
    v_mov_b32 v15, v13
    s_nop 1
    v_permlane32_swap_b32 v12, v14
    v_permlane32_swap_b32 v13, v15
    s_nop 1
    v_max_f32 v15, v15, v13
    v_med3_f32 v13, v12, v14, v15
    v_max_f32 v12, v12, v14
    s_lshl_b32 s31, s30, 3
    s_add_u32 s31, s31, 8192
    v_mov_b32 v14, s31
    ds_write_b64 v14, v[12:13]
    v_mov_b32 v14, 8192
    s_waitcnt lgkmcnt(0)
    s_barrier
    ds_read_b128 v[16:19], v14
    ds_read_b128 v[20:23], v14 offset:16
    v_cmp_eq_u32 vcc, 0, v5
    s_waitcnt lgkmcnt(0)
    v_max_f32 v19, v19, v17
    v_med3_f32 v17, v16, v18, v19
    v_max_f32 v16, v16, v18
    v_max_f32 v23, v23, v21
    v_med3_f32 v21, v20, v22, v23
    v_max_f32 v20, v20, v22
    v_max_f32 v21, v21, v17
    v_med3_f32 v17, v16, v20, v21
    v_max_f32 v16, v16, v20
    v_and_b32 v16, 0x7ff, v16
    v_and_b32 v17, 0x7ff, v17
    v_cndmask_b32 v15, v17, v16, vcc
    v_lshl_add_u32 v12, v15, 11, v7
    buffer_load_dwordx4 v[40:43], v12, s[24:27], 0 offen offset:0 sc1
    buffer_load_dwordx4 v[44:47], v12, s[24:27], 0 offen offset:512 sc1
    buffer_load_dwordx4 v[48:51], v12, s[24:27], 0 offen offset:1024 sc1
    buffer_load_dwordx4 v[52:55], v12, s[24:27], 0 offen offset:1536 sc1
    buffer_load_dwordx4 v[128:131], v0, s[24:27], 0 offen offset:0 sc1
    buffer_load_dwordx4 v[132:135], v0, s[24:27], 0 offen offset:512 sc1
    buffer_load_dwordx4 v[136:139], v0, s[24:27], 0 offen offset:1024 sc1
    buffer_load_dwordx4 v[140:143], v0, s[24:27], 0 offen offset:1536 sc1
    v_cmp_eq_u32 vcc, v16, v11
    v_cmp_eq_u32 s[52:53], v17, v11
    v_mov_b32 v13, 0x7fffffff
    s_or_b64 vcc, vcc, s[52:53]
    v_cndmask_b32 v0, v0, v13, vcc
    v_lshl_add_u32 v12, v5, 11, v7
    v_add_u32 v12, 4096, v12
    s_mov_b32 s58, 0
    s_waitcnt vmcnt(4)
ff_ln_151:
    v_lshlrev_b32 v216, 16, v40
    v_and_b32 v217, 0xffff0000, v40
    v_lshlrev_b32 v218, 16, v41
    v_and_b32 v219, 0xffff0000, v41
    v_lshlrev_b32 v220, 16, v42
    v_and_b32 v221, 0xffff0000, v42
    v_lshlrev_b32 v222, 16, v43
    v_and_b32 v223, 0xffff0000, v43
    v_lshlrev_b32 v224, 16, v44
    v_and_b32 v225, 0xffff0000, v44
    v_lshlrev_b32 v226, 16, v45
    v_and_b32 v227, 0xffff0000, v45
    v_lshlrev_b32 v228, 16, v46
    v_and_b32 v229, 0xffff0000, v46
    v_lshlrev_b32 v230, 16, v47
    v_and_b32 v231, 0xffff0000, v47
    v_lshlrev_b32 v232, 16, v48
    v_and_b32 v233, 0xffff0000, v48
    v_lshlrev_b32 v234, 16, v49
    v_and_b32 v235, 0xffff0000, v49
    v_lshlrev_b32 v236, 16, v50
    v_and_b32 v237, 0xffff0000, v50
    v_lshlrev_b32 v238, 16, v51
    v_and_b32 v239, 0xffff0000, v51
    v_lshlrev_b32 v240, 16, v52
    v_and_b32 v241, 0xffff0000, v52
    v_lshlrev_b32 v242, 16, v53
    v_and_b32 v243, 0xffff0000, v53
    v_lshlrev_b32 v244, 16, v54
    v_and_b32 v245, 0xffff0000, v54
    v_lshlrev_b32 v246, 16, v55
    v_and_b32 v247, 0xffff0000, v55
    v_pk_add_f32 v[208:209], v[216:217], v[218:219]
    v_pk_add_f32 v[210:211], v[220:221], v[222:223]
    v_pk_add_f32 v[208:209], v[208:209], v[224:225]
    v_pk_add_f32 v[210:211], v[210:211], v[226:227]
    v_pk_add_f32 v[208:209], v[208:209], v[228:229]
    v_pk_add_f32 v[210:211], v[210:211], v[230:231]
    v_pk_add_f32 v[208:209], v[208:209], v[232:233]
    v_pk_add_f32 v[210:211], v[210:211], v[234:235]
    v_pk_add_f32 v[208:209], v[208:209], v[236:237]
    v_pk_add_f32 v[210:211], v[210:211], v[238:239]
    v_pk_add_f32 v[208:209], v[208:209], v[240:241]
    v_pk_add_f32 v[210:211], v[210:211], v[242:243]
    v_pk_add_f32 v[208:209], v[208:209], v[244:245]
    v_pk_add_f32 v[210:211], v[210:211], v[246:247]
    v_pk_add_f32 v[208:209], v[208:209], v[210:211]
    v_add_f32 v208, v208, v209
    s_nop 1
    v_add_f32_dpp v208, v208, v208 quad_perm:[1,0,3,2] row_mask:0xf bank_mask:0xf
    s_nop 1
    v_add_f32_dpp v208, v208, v208 quad_perm:[2,3,0,1] row_mask:0xf bank_mask:0xf
    s_nop 1
    v_add_f32_dpp v208, v208, v208 row_half_mirror row_mask:0xf bank_mask:0xf
    s_nop 1
    v_add_f32_dpp v208, v208, v208 row_mirror row_mask:0xf bank_mask:0xf
    v_mov_b32 v210, v208
    s_nop 1
    v_permlane16_swap_b32 v208, v210
    s_nop 1
    v_add_f32 v208, v208, v210
    v_mul_f32 v208, 0xba800000, v208
    v_mov_b32 v209, v208
    v_pk_add_f32 v[210:211], v[216:217], v[208:209]
    v_pk_add_f32 v[214:215], v[218:219], v[208:209]
    v_pk_mul_f32 v[212:213], v[210:211], v[210:211]
    v_pk_fma_f32 v[212:213], v[214:215], v[214:215], v[212:213]
    v_pk_add_f32 v[210:211], v[220:221], v[208:209]
    v_pk_add_f32 v[214:215], v[222:223], v[208:209]
    v_pk_fma_f32 v[212:213], v[210:211], v[210:211], v[212:213]
    v_pk_fma_f32 v[212:213], v[214:215], v[214:215], v[212:213]
    v_pk_add_f32 v[210:211], v[224:225], v[208:209]
    v_pk_add_f32 v[214:215], v[226:227], v[208:209]
    v_pk_fma_f32 v[212:213], v[210:211], v[210:211], v[212:213]
    v_pk_fma_f32 v[212:213], v[214:215], v[214:215], v[212:213]
    v_pk_add_f32 v[210:211], v[228:229], v[208:209]
    v_pk_add_f32 v[214:215], v[230:231], v[208:209]
    v_pk_fma_f32 v[212:213], v[210:211], v[210:211], v[212:213]
    v_pk_fma_f32 v[212:213], v[214:215], v[214:215], v[212:213]
    v_pk_add_f32 v[210:211], v[232:233], v[208:209]
    v_pk_add_f32 v[214:215], v[234:235], v[208:209]
    v_pk_fma_f32 v[212:213], v[210:211], v[210:211], v[212:213]
    v_pk_fma_f32 v[212:213], v[214:215], v[214:215], v[212:213]
    v_pk_add_f32 v[210:211], v[236:237], v[208:209]
    v_pk_add_f32 v[214:215], v[238:239], v[208:209]
    v_pk_fma_f32 v[212:213], v[210:211], v[210:211], v[212:213]
    v_pk_fma_f32 v[212:213], v[214:215], v[214:215], v[212:213]
    v_pk_add_f32 v[210:211], v[240:241], v[208:209]
    v_pk_add_f32 v[214:215], v[242:243], v[208:209]
    v_pk_fma_f32 v[212:213], v[210:211], v[210:211], v[212:213]
    v_pk_fma_f32 v[212:213], v[214:215], v[214:215], v[212:213]
    v_pk_add_f32 v[210:211], v[244:245], v[208:209]
    v_pk_add_f32 v[214:215], v[246:247], v[208:209]
    v_pk_fma_f32 v[212:213], v[210:211], v[210:211], v[212:213]
    v_pk_fma_f32 v[212:213], v[214:215], v[214:215], v[212:213]
    v_add_f32 v212, v212, v213
    s_nop 1
    v_add_f32_dpp v212, v212, v212 quad_perm:[1,0,3,2] row_mask:0xf bank_mask:0xf
    s_nop 1
    v_add_f32_dpp v212, v212, v212 quad_perm:[2,3,0,1] row_mask:0xf bank_mask:0xf
    s_nop 1
    v_add_f32_dpp v212, v212, v212 row_half_mirror row_mask:0xf bank_mask:0xf
    s_nop 1
    v_add_f32_dpp v212, v212, v212 row_mirror row_mask:0xf bank_mask:0xf
    v_mov_b32 v210, v212
    s_nop 1
    v_permlane16_swap_b32 v212, v210
    s_nop 1
    v_add_f32 v212, v212, v210
    v_mul_f32 v212, 0x3a800000, v212
    v_cvt_pk_bf16_f32 v214, v208, v212
    v_and_b32 v212, 0xffff0000, v214
    v_lshlrev_b32 v214, 16, v214
    v_add_f32 v212, 0x3727c5ac, v212
    v_mov_b32 v215, v214
    v_cvt_pk_bf16_f32 v212, v212, v212
    v_and_b32 v212, 0xffff0000, v212
    v_sqrt_f32 v212, v212
    v_pk_add_f32 v[176:177], v[216:217], v[214:215]
    v_pk_add_f32 v[178:179], v[218:219], v[214:215]
    v_pk_add_f32 v[180:181], v[220:221], v[214:215]
    v_pk_add_f32 v[182:183], v[222:223], v[214:215]
    v_pk_add_f32 v[184:185], v[224:225], v[214:215]
    v_pk_add_f32 v[186:187], v[226:227], v[214:215]
    v_pk_add_f32 v[188:189], v[228:229], v[214:215]
    v_pk_add_f32 v[190:191], v[230:231], v[214:215]
    v_pk_add_f32 v[192:193], v[232:233], v[214:215]
    v_pk_add_f32 v[194:195], v[234:235], v[214:215]
    v_pk_add_f32 v[196:197], v[236:237], v[214:215]
    v_pk_add_f32 v[198:199], v[238:239], v[214:215]
    v_pk_add_f32 v[200:201], v[240:241], v[214:215]
    v_pk_add_f32 v[202:203], v[242:243], v[214:215]
    v_pk_add_f32 v[204:205], v[244:245], v[214:215]
    v_pk_add_f32 v[206:207], v[246:247], v[214:215]
    v_cvt_pk_bf16_f32 v212, v212, v212
    v_and_b32 v212, 0xffff0000, v212
    v_rcp_f32 v212, v212
    v_cvt_pk_bf16_f32 v40, v176, v177
    v_cvt_pk_bf16_f32 v41, v178, v179
    v_cvt_pk_bf16_f32 v42, v180, v181
    v_cvt_pk_bf16_f32 v43, v182, v183
    v_cvt_pk_bf16_f32 v44, v184, v185
    v_cvt_pk_bf16_f32 v45, v186, v187
    v_cvt_pk_bf16_f32 v46, v188, v189
    v_cvt_pk_bf16_f32 v47, v190, v191
    v_cvt_pk_bf16_f32 v48, v192, v193
    v_cvt_pk_bf16_f32 v49, v194, v195
    v_cvt_pk_bf16_f32 v50, v196, v197
    v_cvt_pk_bf16_f32 v51, v198, v199
    v_cvt_pk_bf16_f32 v52, v200, v201
    v_cvt_pk_bf16_f32 v53, v202, v203
    v_cvt_pk_bf16_f32 v54, v204, v205
    v_cvt_pk_bf16_f32 v55, v206, v207
    v_mov_b32 v213, v212
    v_lshlrev_b32 v176, 16, v40
    v_and_b32 v177, 0xffff0000, v40
    v_lshlrev_b32 v178, 16, v41
    v_and_b32 v179, 0xffff0000, v41
    v_lshlrev_b32 v180, 16, v42
    v_and_b32 v181, 0xffff0000, v42
    v_lshlrev_b32 v182, 16, v43
    v_and_b32 v183, 0xffff0000, v43
    v_lshlrev_b32 v184, 16, v44
    v_and_b32 v185, 0xffff0000, v44
    v_lshlrev_b32 v186, 16, v45
    v_and_b32 v187, 0xffff0000, v45
    v_lshlrev_b32 v188, 16, v46
    v_and_b32 v189, 0xffff0000, v46
    v_lshlrev_b32 v190, 16, v47
    v_and_b32 v191, 0xffff0000, v47
    v_lshlrev_b32 v192, 16, v48
    v_and_b32 v193, 0xffff0000, v48
    v_lshlrev_b32 v194, 16, v49
    v_and_b32 v195, 0xffff0000, v49
    v_lshlrev_b32 v196, 16, v50
    v_and_b32 v197, 0xffff0000, v50
    v_lshlrev_b32 v198, 16, v51
    v_and_b32 v199, 0xffff0000, v51
    v_lshlrev_b32 v200, 16, v52
    v_and_b32 v201, 0xffff0000, v52
    v_lshlrev_b32 v202, 16, v53
    v_and_b32 v203, 0xffff0000, v53
    v_lshlrev_b32 v204, 16, v54
    v_and_b32 v205, 0xffff0000, v54
    v_lshlrev_b32 v206, 16, v55
    v_and_b32 v207, 0xffff0000, v55
    v_pk_mul_f32 v[176:177], v[176:177], v[212:213]
    v_pk_mul_f32 v[178:179], v[178:179], v[212:213]
    v_pk_mul_f32 v[180:181], v[180:181], v[212:213]
    v_pk_mul_f32 v[182:183], v[182:183], v[212:213]
    v_pk_mul_f32 v[184:185], v[184:185], v[212:213]
    v_pk_mul_f32 v[186:187], v[186:187], v[212:213]
    v_pk_mul_f32 v[188:189], v[188:189], v[212:213]
    v_pk_mul_f32 v[190:191], v[190:191], v[212:213]
    v_pk_mul_f32 v[192:193], v[192:193], v[212:213]
    v_pk_mul_f32 v[194:195], v[194:195], v[212:213]
    v_pk_mul_f32 v[196:197], v[196:197], v[212:213]
    v_pk_mul_f32 v[198:199], v[198:199], v[212:213]
    v_pk_mul_f32 v[200:201], v[200:201], v[212:213]
    v_pk_mul_f32 v[202:203], v[202:203], v[212:213]
    v_pk_mul_f32 v[204:205], v[204:205], v[212:213]
    v_pk_mul_f32 v[206:207], v[206:207], v[212:213]
    v_cvt_pk_bf16_f32 v40, v176, v177
    v_cvt_pk_bf16_f32 v41, v178, v179
    v_cvt_pk_bf16_f32 v42, v180, v181
    v_cvt_pk_bf16_f32 v43, v182, v183
    v_cvt_pk_bf16_f32 v44, v184, v185
    v_cvt_pk_bf16_f32 v45, v186, v187
    v_cvt_pk_bf16_f32 v46, v188, v189
    v_cvt_pk_bf16_f32 v47, v190, v191
    v_cvt_pk_bf16_f32 v48, v192, v193
    v_cvt_pk_bf16_f32 v49, v194, v195
    v_cvt_pk_bf16_f32 v50, v196, v197
    v_cvt_pk_bf16_f32 v51, v198, v199
    v_cvt_pk_bf16_f32 v52, v200, v201
    v_cvt_pk_bf16_f32 v53, v202, v203
    v_cvt_pk_bf16_f32 v54, v204, v205
    v_cvt_pk_bf16_f32 v55, v206, v207
    s_cmp_lg_u32 s58, 0
    s_cbranch_scc1 ff_own_152
    ds_write_b128 v12, v[40:43] offset:0
    ds_write_b128 v12, v[44:47] offset:512
    ds_write_b128 v12, v[48:51] offset:1024
    ds_write_b128 v12, v[52:55] offset:1536
    s_cmp_ge_u32 s2, 224
    s_cbranch_scc1 ff_red_153
    v_lshrrev_b32 v12, 4, v3
    v_and_b32 v13, 1, v3
    v_lshlrev_b32 v13, 11, v13
    v_lshl_add_u32 v13, v12, 3, v13
    s_lshl_b32 s54, s30, 9
    s_add_u32 s54, s54, 4096
    v_add_u32 v13, s54, v13
    v_lshlrev_b32 v14, 3, v3
    s_lshl_b32 s54, s30, 13
    s_add_u32 s54, s54, 65536
    v_add_u32 v14, s54, v14
    ds_read_b64_tr_b16 a[0:1], v14 offset:0
    ds_read_b64_tr_b16 a[2:3], v14 offset:512
    ds_read_b64_tr_b16 a[4:5], v14 offset:1024
    ds_read_b64_tr_b16 a[6:7], v14 offset:1536
    ds_read_b64_tr_b16 a[8:9], v14 offset:2048
    ds_read_b64_tr_b16 a[10:11], v14 offset:2560
    ds_read_b64_tr_b16 a[12:13], v14 offset:3072
    ds_read_b64_tr_b16 a[14:15], v14 offset:3584
    ds_read_b64_tr_b16 a[16:17], v14 offset:4096
    ds_read_b64_tr_b16 a[18:19], v14 offset:4608
    ds_read_b64_tr_b16 a[20:21], v14 offset:5120
    ds_read_b64_tr_b16 a[22:23], v14 offset:5632
    ds_read_b64_tr_b16 a[24:25], v14 offset:6144
    ds_read_b64_tr_b16 a[26:27], v14 offset:6656
    ds_read_b64_tr_b16 a[28:29], v14 offset:7168
    ds_read_b64_tr_b16 a[30:31], v14 offset:7680
    ds_read_b64_tr_b16 a[32:33], v14 offset:32768
    ds_read_b64_tr_b16 a[34:35], v14 offset:33280
    ds_read_b64_tr_b16 a[36:37], v14 offset:33792
    ds_read_b64_tr_b16 a[38:39], v14 offset:34304
    ds_read_b64_tr_b16 a[40:41], v14 offset:34816
    ds_read_b64_tr_b16 a[42:43], v14 offset:35328
    ds_read_b64_tr_b16 a[44:45], v14 offset:35840
    ds_read_b64_tr_b16 a[46:47], v14 offset:36352
    ds_read_b64_tr_b16 a[48:49], v14 offset:36864
    ds_read_b64_tr_b16 a[50:51], v14 offset:37376
    ds_read_b64_tr_b16 a[52:53], v14 offset:37888
    ds_read_b64_tr_b16 a[54:55], v14 offset:38400
    ds_read_b64_tr_b16 a[56:57], v14 offset:38912
    ds_read_b64_tr_b16 a[58:59], v14 offset:39424
    ds_read_b64_tr_b16 a[60:61], v14 offset:39936
    ds_read_b64_tr_b16 a[62:63], v14 offset:40448
    ds_read_b64 a[64:65], v13 offset:0
    ds_read_b64 a[66:67], v13 offset:32
    ds_read_b64 a[68:69], v13 offset:64
    ds_read_b64 a[70:71], v13 offset:96
    ds_read_b64 a[72:73], v13 offset:128
    ds_read_b64 a[74:75], v13 offset:160
    ds_read_b64 a[76:77], v13 offset:192
    ds_read_b64 a[78:79], v13 offset:224
    ds_read_b64 a[80:81], v13 offset:256
    ds_read_b64 a[82:83], v13 offset:288
    ds_read_b64 a[84:85], v13 offset:320
    ds_read_b64 a[86:87], v13 offset:352
    ds_read_b64 a[88:89], v13 offset:384
    ds_read_b64 a[90:91], v13 offset:416
    ds_read_b64 a[92:93], v13 offset:448
    ds_read_b64 a[94:95], v13 offset:480
    v_lshlrev_b32 v13, 6, v8
    v_lshl_add_u32 v13, v12, 4, v13
    s_lshl_b32 s54, s30, 11
    s_add_u32 s54, s54, 8448
    v_add_u32 v13, s54, v13
    s_waitcnt lgkmcnt(0)
    v_mfma_f32_16x16x32_bf16 v[16:19], a[0:3], a[64:67], 0
    v_mfma_f32_16x16x32_bf16 v[20:23], a[32:35], a[64:67], 0
    v_mfma_f32_16x16x32_bf16 v[16:19], a[4:7], a[68:71], v[16:19]
    v_mfma_f32_16x16x32_bf16 v[20:23], a[36:39], a[68:71], v[20:23]
    v_mfma_f32_16x16x32_bf16 v[16:19], a[8:11], a[72:75], v[16:19]
    v_mfma_f32_16x16x32_bf16 v[20:23], a[40:43], a[72:75], v[20:23]
    v_mfma_f32_16x16x32_bf16 v[16:19], a[12:15], a[76:79], v[16:19]
    v_mfma_f32_16x16x32_bf16 v[20:23], a[44:47], a[76:79], v[20:23]
    v_mfma_f32_16x16x32_bf16 v[16:19], a[16:19], a[80:83], v[16:19]
    v_mfma_f32_16x16x32_bf16 v[20:23], a[48:51], a[80:83], v[20:23]
    v_mfma_f32_16x16x32_bf16 v[16:19], a[20:23], a[84:87], v[16:19]
    v_mfma_f32_16x16x32_bf16 v[20:23], a[52:55], a[84:87], v[20:23]
    v_mfma_f32_16x16x32_bf16 v[16:19], a[24:27], a[88:91], v[16:19]
    v_mfma_f32_16x16x32_bf16 v[20:23], a[56:59], a[88:91], v[20:23]
    v_mfma_f32_16x16x32_bf16 v[16:19], a[28:31], a[92:95], v[16:19]
    v_mfma_f32_16x16x32_bf16 v[20:23], a[60:63], a[92:95], v[20:23]
    s_nop 7
    ds_write_b128 v13, v[16:19]
    ds_write_b128 v13, v[20:23] offset:1024
    v_lshlrev_b32 v13, 2, v4
    v_add_u32 v13, 8448, v13
    s_waitcnt lgkmcnt(0)
    s_barrier
    ds_read2st64_b32 v[16:17], v13 offset0:0 offset1:4
    ds_read2st64_b32 v[18:19], v13 offset0:8 offset1:12
    ds_read2st64_b32 v[20:21], v13 offset0:16 offset1:20
    ds_read2st64_b32 v[22:23], v13 offset0:24 offset1:28
    s_waitcnt lgkmcnt(0)
    v_pk_add_f32 v[16:17], v[16:17], v[20:21]
    v_pk_add_f32 v[18:19], v[18:19], v[22:23]
    v_pk_add_f32 v[16:17], v[16:17], v[18:19]
    v_cvt_pk_bf16_f32 v16, v16, v17
    v_and_b32 v20, 0xffff0000, v16
    v_lshlrev_b32 v16, 16, v16
    v_mul_f32 v17, 0xbfb8aa3b, v16
    v_exp_f32 v17, v17
    s_lshl_b32 s54, s55, 13
    v_add_f32 v17, 1.0, v17
    v_rcp_f32 v17, v17
    s_add_u32 s53, s54, 4096
    v_mul_f32 v16, v16, v17
    v_cvt_pk_bf16_f32 v16, v16, v16
    v_and_b32 v16, 0xffff0000, v16
    v_mul_f32 v16, v16, v20
    s_nop 1
    v_mov_b32_dpp v17, v16 quad_perm:[1,0,3,2] row_mask:0xf bank_mask:0xf
    v_cvt_pk_bf16_f32 v16, v16, v17
    v_lshlrev_b32 v13, 4, v2
    v_readlane_b32 s8, v16, 0
    v_readlane_b32 s9, v16, 2
    v_readlane_b32 s10, v16, 4
    v_readlane_b32 s11, v16, 6
    v_readlane_b32 s12, v16, 8
    v_readlane_b32 s13, v16, 10
    v_readlane_b32 s14, v16, 12
    v_readlane_b32 s15, v16, 14
    v_readlane_b32 s16, v16, 16
    v_readlane_b32 s17, v16, 18
    v_readlane_b32 s18, v16, 20
    v_readlane_b32 s19, v16, 22
    v_readlane_b32 s20, v16, 24
    v_readlane_b32 s21, v16, 26
    v_readlane_b32 s22, v16, 28
    v_readlane_b32 s23, v16, 30
    v_dot2_f32_bf16 v24, v144, s8, 0
    v_dot2_f32_bf16 v25, v145, s8, 0
    v_dot2_f32_bf16 v26, v146, s8, 0
    v_dot2_f32_bf16 v27, v147, s8, 0
    v_dot2_f32_bf16 v24, v148, s9, v24
    v_dot2_f32_bf16 v25, v149, s9, v25
    v_dot2_f32_bf16 v26, v150, s9, v26
    v_dot2_f32_bf16 v27, v151, s9, v27
    v_dot2_f32_bf16 v24, v152, s10, v24
    v_dot2_f32_bf16 v25, v153, s10, v25
    v_dot2_f32_bf16 v26, v154, s10, v26
    v_dot2_f32_bf16 v27, v155, s10, v27
    v_dot2_f32_bf16 v24, v156, s11, v24
    v_dot2_f32_bf16 v25, v157, s11, v25
    v_dot2_f32_bf16 v26, v158, s11, v26
    v_dot2_f32_bf16 v27, v159, s11, v27
    v_dot2_f32_bf16 v24, v160, s12, v24
    v_dot2_f32_bf16 v25, v161, s12, v25
    v_dot2_f32_bf16 v26, v162, s12, v26
    v_dot2_f32_bf16 v27, v163, s12, v27
    v_dot2_f32_bf16 v24, v164, s13, v24
    v_dot2_f32_bf16 v25, v165, s13, v25
    v_dot2_f32_bf16 v26, v166, s13, v26
    v_dot2_f32_bf16 v27, v167, s13, v27
    v_dot2_f32_bf16 v24, v168, s14, v24
    v_dot2_f32_bf16 v25, v169, s14, v25
    v_dot2_f32_bf16 v26, v170, s14, v26
    v_dot2_f32_bf16 v27, v171, s14, v27
    v_dot2_f32_bf16 v24, v172, s15, v24
    v_dot2_f32_bf16 v25, v173, s15, v25
    v_dot2_f32_bf16 v26, v174, s15, v26
    v_dot2_f32_bf16 v27, v175, s15, v27
    v_dot2_f32_bf16 v28, v144, s16, 0
    v_dot2_f32_bf16 v29, v145, s16, 0
    v_dot2_f32_bf16 v30, v146, s16, 0
    v_dot2_f32_bf16 v31, v147, s16, 0
    v_dot2_f32_bf16 v28, v148, s17, v28
    v_dot2_f32_bf16 v29, v149, s17, v29
    v_dot2_f32_bf16 v30, v150, s17, v30
    v_dot2_f32_bf16 v31, v151, s17, v31
    v_dot2_f32_bf16 v28, v152, s18, v28
    v_dot2_f32_bf16 v29, v153, s18, v29
    v_dot2_f32_bf16 v30, v154, s18, v30
    v_dot2_f32_bf16 v31, v155, s18, v31
    v_dot2_f32_bf16 v28, v156, s19, v28
    v_dot2_f32_bf16 v29, v157, s19, v29
    v_dot2_f32_bf16 v30, v158, s19, v30
    v_dot2_f32_bf16 v31, v159, s19, v31
    v_dot2_f32_bf16 v28, v160, s20, v28
    v_dot2_f32_bf16 v29, v161, s20, v29
    v_dot2_f32_bf16 v30, v162, s20, v30
    v_dot2_f32_bf16 v31, v163, s20, v31
    v_dot2_f32_bf16 v28, v164, s21, v28
    v_dot2_f32_bf16 v29, v165, s21, v29
    v_dot2_f32_bf16 v30, v166, s21, v30
    v_dot2_f32_bf16 v31, v167, s21, v31
    v_dot2_f32_bf16 v28, v168, s22, v28
    v_dot2_f32_bf16 v29, v169, s22, v29
    v_dot2_f32_bf16 v30, v170, s22, v30
    v_dot2_f32_bf16 v31, v171, s22, v31
    v_dot2_f32_bf16 v28, v172, s23, v28
    v_dot2_f32_bf16 v29, v173, s23, v29
    v_dot2_f32_bf16 v30, v174, s23, v30
    v_dot2_f32_bf16 v31, v175, s23, v31
    s_nop 2
    v_min_u32 v24, -2, v24
    v_min_u32 v25, -2, v25
    v_min_u32 v26, -2, v26
    v_min_u32 v27, -2, v27
    v_min_u32 v28, -2, v28
    v_min_u32 v29, -2, v29
    v_min_u32 v30, -2, v30
    v_min_u32 v31, -2, v31
    buffer_store_dwordx4 v[24:27], v13, s[48:51], s54 offen sc1
    buffer_store_dwordx4 v[28:31], v13, s[48:51], s53 offen sc1
    s_waitcnt vmcnt(2)
    v_mov_b32 v40, v128
    v_mov_b32 v41, v129
    v_mov_b32 v42, v130
    v_mov_b32 v43, v131
    v_mov_b32 v44, v132
    v_mov_b32 v45, v133
    v_mov_b32 v46, v134
    v_mov_b32 v47, v135
    v_mov_b32 v48, v136
    v_mov_b32 v49, v137
    v_mov_b32 v50, v138
    v_mov_b32 v51, v139
    v_mov_b32 v52, v140
    v_mov_b32 v53, v141
    v_mov_b32 v54, v142
    v_mov_b32 v55, v143
    s_mov_b32 s58, 1
    s_branch ff_ln_151
ff_own_152:
    v_lshlrev_b32 v176, 16, v40
    v_and_b32 v177, 0xffff0000, v40
    v_lshlrev_b32 v178, 16, v41
    v_and_b32 v179, 0xffff0000, v41
    v_lshlrev_b32 v180, 16, v42
    v_and_b32 v181, 0xffff0000, v42
    v_lshlrev_b32 v182, 16, v43
    v_and_b32 v183, 0xffff0000, v43
    v_lshlrev_b32 v184, 16, v44
    v_and_b32 v185, 0xffff0000, v44
    v_lshlrev_b32 v186, 16, v45
    v_and_b32 v187, 0xffff0000, v45
    v_lshlrev_b32 v188, 16, v46
    v_and_b32 v189, 0xffff0000, v46
    v_lshlrev_b32 v190, 16, v47
    v_and_b32 v191, 0xffff0000, v47
    v_lshlrev_b32 v192, 16, v48
    v_and_b32 v193, 0xffff0000, v48
    v_lshlrev_b32 v194, 16, v49
    v_and_b32 v195, 0xffff0000, v49
    v_lshlrev_b32 v196, 16, v50
    v_and_b32 v197, 0xffff0000, v50
    v_lshlrev_b32 v198, 16, v51
    v_and_b32 v199, 0xffff0000, v51
    v_lshlrev_b32 v200, 16, v52
    v_and_b32 v201, 0xffff0000, v52
    v_lshlrev_b32 v202, 16, v53
    v_and_b32 v203, 0xffff0000, v53
    v_lshlrev_b32 v204, 16, v54
    v_and_b32 v205, 0xffff0000, v54
    v_lshlrev_b32 v206, 16, v55
    v_and_b32 v207, 0xffff0000, v55
    v_pk_add_f32 v[176:177], v[176:177], v[216:217]
    v_pk_add_f32 v[178:179], v[178:179], v[218:219]
    v_pk_add_f32 v[180:181], v[180:181], v[220:221]
    v_pk_add_f32 v[182:183], v[182:183], v[222:223]
    v_pk_add_f32 v[184:185], v[184:185], v[224:225]
    v_pk_add_f32 v[186:187], v[186:187], v[226:227]
    v_pk_add_f32 v[188:189], v[188:189], v[228:229]
    v_pk_add_f32 v[190:191], v[190:191], v[230:231]
    v_pk_add_f32 v[192:193], v[192:193], v[232:233]
    v_pk_add_f32 v[194:195], v[194:195], v[234:235]
    v_pk_add_f32 v[196:197], v[196:197], v[236:237]
    v_pk_add_f32 v[198:199], v[198:199], v[238:239]
    v_pk_add_f32 v[200:201], v[200:201], v[240:241]
    v_pk_add_f32 v[202:203], v[202:203], v[242:243]
    v_pk_add_f32 v[204:205], v[204:205], v[244:245]
    v_pk_add_f32 v[206:207], v[206:207], v[246:247]
    v_cvt_pk_bf16_f32 v40, v176, v177
    v_cvt_pk_bf16_f32 v41, v178, v179
    v_cvt_pk_bf16_f32 v42, v180, v181
    v_cvt_pk_bf16_f32 v43, v182, v183
    v_cvt_pk_bf16_f32 v44, v184, v185
    v_cvt_pk_bf16_f32 v45, v186, v187
    v_cvt_pk_bf16_f32 v46, v188, v189
    v_cvt_pk_bf16_f32 v47, v190, v191
    v_cvt_pk_bf16_f32 v48, v192, v193
    v_cvt_pk_bf16_f32 v49, v194, v195
    v_cvt_pk_bf16_f32 v50, v196, v197
    v_cvt_pk_bf16_f32 v51, v198, v199
    v_cvt_pk_bf16_f32 v52, v200, v201
    v_cvt_pk_bf16_f32 v53, v202, v203
    v_cvt_pk_bf16_f32 v54, v204, v205
    v_cvt_pk_bf16_f32 v55, v206, v207
    buffer_store_dwordx4 v[40:43], v0, s[36:39], 0 offen offset:0 sc1
    buffer_store_dwordx4 v[44:47], v0, s[36:39], 0 offen offset:512 sc1
    buffer_store_dwordx4 v[48:51], v0, s[36:39], 0 offen offset:1024 sc1
    buffer_store_dwordx4 v[52:55], v0, s[36:39], 0 offen offset:1536 sc1
    s_cmp_ge_u32 s2, 224
    s_cbranch_scc1 ff_red2_154
    s_branch ff_fin_155
ff_red_153:
    s_sub_u32 s40, s2, 224
    s_lshr_b32 s41, s40, 4
    s_and_b32 s42, s40, 15
    s_mov_b32 s8, s56
    s_and_b32 s9, s57, 0xffff
    s_mov_b32 s10, 0x800
    s_mov_b32 s11, 0x00020000
    buffer_load_dwordx4 v[96:99], v7, s[8:11], 0 offen offset:0
    buffer_load_dwordx4 v[100:103], v7, s[8:11], 0 offen offset:512
    buffer_load_dwordx4 v[104:107], v7, s[8:11], 0 offen offset:1024
    buffer_load_dwordx4 v[108:111], v7, s[8:11], 0 offen offset:1536
    s_lshl_b32 s43, s41, 5
    v_readlane_b32 s46, v15, s43
    s_lshl_b32 s47, s42, 7
    v_lshl_add_u32 v9, v8, 3, s47
    s_lshl_b32 s46, s46, 11
    s_lshl_b32 s31, s41, 11
    s_add_u32 s31, s31, 4096
    v_add_u32 v12, s31, v9
    s_waitcnt lgkmcnt(0)
    ds_read_b64 v[32:33], v12
    buffer_load_dwordx2 v[34:35], v9, s[24:27], s46 offen sc1
    v_lshrrev_b32 v10, 4, v2
    v_lshlrev_b32 v10, 13, v10
    v_lshl_add_u32 v10, v8, 4, v10
    s_lshl_b32 s47, s40, 8
    s_waitcnt vmcnt(1)
    v_dot2_f32_bf16 v12, v40, v96, 0
    v_dot2_f32_bf16 v12, v41, v97, v12
    v_dot2_f32_bf16 v12, v42, v98, v12
    v_dot2_f32_bf16 v12, v43, v99, v12
    v_dot2_f32_bf16 v12, v44, v100, v12
    v_dot2_f32_bf16 v12, v45, v101, v12
    v_dot2_f32_bf16 v12, v46, v102, v12
    v_dot2_f32_bf16 v12, v47, v103, v12
    v_dot2_f32_bf16 v12, v48, v104, v12
    v_dot2_f32_bf16 v12, v49, v105, v12
    v_dot2_f32_bf16 v12, v50, v106, v12
    v_dot2_f32_bf16 v12, v51, v107, v12
    v_dot2_f32_bf16 v12, v52, v108, v12
    v_dot2_f32_bf16 v12, v53, v109, v12
    v_dot2_f32_bf16 v12, v54, v110, v12
    v_dot2_f32_bf16 v12, v55, v111, v12
    s_nop 2
    s_nop 1
    v_add_f32_dpp v12, v12, v12 quad_perm:[1,0,3,2] row_mask:0xf bank_mask:0xf
    s_nop 1
    v_add_f32_dpp v12, v12, v12 quad_perm:[2,3,0,1] row_mask:0xf bank_mask:0xf
    s_nop 1
    v_add_f32_dpp v12, v12, v12 row_half_mirror row_mask:0xf bank_mask:0xf
    s_nop 1
    v_add_f32_dpp v12, v12, v12 row_mirror row_mask:0xf bank_mask:0xf
    v_mov_b32 v13, v12
    s_nop 1
    v_permlane16_swap_b32 v12, v13
    s_nop 1
    v_add_f32 v12, v12, v13
    v_cvt_pk_bf16_f32 v12, v12, v12
    v_and_b32 v12, 0xffff0000, v12
    v_mul_f32 v12, 0xbfb8aa3b, v12
    v_exp_f32 v12, v12
    s_lshl_b32 s44, s42, 1
    v_add_f32 v12, 1.0, v12
    v_rcp_f32 v12, v12
    s_add_u32 s44, s44, s41
    s_lshl_b32 s44, s44, 11
    v_cvt_pk_bf16_f32 v12, v12, v12
    v_and_b32 v12, 0xffff0000, v12
    v_mov_b32 v40, v128
    v_mov_b32 v41, v129
    v_mov_b32 v42, v130
    v_mov_b32 v43, v131
    v_mov_b32 v44, v132
    v_mov_b32 v45, v133
    v_mov_b32 v46, v134
    v_mov_b32 v47, v135
    v_mov_b32 v48, v136
    v_mov_b32 v49, v137
    v_mov_b32 v50, v138
    v_mov_b32 v51, v139
    v_mov_b32 v52, v140
    v_mov_b32 v53, v141
    v_mov_b32 v54, v142
    v_mov_b32 v55, v143
    v_readlane_b32 s45, v12, s43
    s_mov_b32 s58, 1
    s_branch ff_ln_151
ff_red2_154:
    s_mov_b32 s52, 1048576
ff_rpoll_157:
    s_mov_b32 s53, s47
    buffer_load_dwordx4 v[96:99], v10, s[48:51], s53 offen sc1
    s_add_u32 s53, s53, 0x20000
    buffer_load_dwordx4 v[100:103], v10, s[48:51], s53 offen sc1
    s_add_u32 s53, s53, 0x20000
    buffer_load_dwordx4 v[104:107], v10, s[48:51], s53 offen sc1
    s_add_u32 s53, s53, 0x20000
    buffer_load_dwordx4 v[108:111], v10, s[48:51], s53 offen sc1
    s_add_u32 s53, s53, 0x20000
    buffer_load_dwordx4 v[112:115], v10, s[48:51], s53 offen sc1
    s_add_u32 s53, s53, 0x20000
    buffer_load_dwordx4 v[116:119], v10, s[48:51], s53 offen sc1
    s_add_u32 s53, s53, 0x20000
    buffer_load_dwordx4 v[120:123], v10, s[48:51], s53 offen sc1
    s_add_u32 s53, s53, 0x20000
    buffer_load_dwordx4 v[124:127], v10, s[48:51], s53 offen sc1
    s_add_u32 s53, s53, 0x20000
    buffer_load_dwordx4 v[128:131], v10, s[48:51], s53 offen sc1
    s_add_u32 s53, s53, 0x20000
    buffer_load_dwordx4 v[132:135], v10, s[48:51], s53 offen sc1
    s_add_u32 s53, s53, 0x20000
    buffer_load_dwordx4 v[136:139], v10, s[48:51], s53 offen sc1
    s_add_u32 s53, s53, 0x20000
    buffer_load_dwordx4 v[140:143], v10, s[48:51], s53 offen sc1
    s_add_u32 s53, s53, 0x20000
    buffer_load_dwordx4 v[144:147], v10, s[48:51], s53 offen sc1
    s_add_u32 s53, s53, 0x20000
    buffer_load_dwordx4 v[148:151], v10, s[48:51], s53 offen sc1
    s_add_u32 s53, s53, 0x20000
    v_mov_b32 v13, 0
    s_waitcnt vmcnt(13)
    v_max3_u32 v13, v13, v96, v97
    v_max3_u32 v13, v13, v98, v99
    s_waitcnt vmcnt(12)
    v_max3_u32 v13, v13, v100, v101
    v_max3_u32 v13, v13, v102, v103
    s_waitcnt vmcnt(11)
    v_max3_u32 v13, v13, v104, v105
    v_max3_u32 v13, v13, v106, v107
    s_waitcnt vmcnt(10)
    v_max3_u32 v13, v13, v108, v109
    v_max3_u32 v13, v13, v110, v111
    s_waitcnt vmcnt(9)
    v_max3_u32 v13, v13, v112, v113
    v_max3_u32 v13, v13, v114, v115
    s_waitcnt vmcnt(8)
    v_max3_u32 v13, v13, v116, v117
    v_max3_u32 v13, v13, v118, v119
    s_waitcnt vmcnt(7)
    v_max3_u32 v13, v13, v120, v121
    v_max3_u32 v13, v13, v122, v123
    s_waitcnt vmcnt(6)
    v_max3_u32 v13, v13, v124, v125
    v_max3_u32 v13, v13, v126, v127
    s_waitcnt vmcnt(5)
    v_max3_u32 v13, v13, v128, v129
    v_max3_u32 v13, v13, v130, v131
    s_waitcnt vmcnt(4)
    v_max3_u32 v13, v13, v132, v133
    v_max3_u32 v13, v13, v134, v135
    s_waitcnt vmcnt(3)
    v_max3_u32 v13, v13, v136, v137
    v_max3_u32 v13, v13, v138, v139
    s_waitcnt vmcnt(2)
    v_max3_u32 v13, v13, v140, v141
    v_max3_u32 v13, v13, v142, v143
    s_waitcnt vmcnt(1)
    v_max3_u32 v13, v13, v144, v145
    v_max3_u32 v13, v13, v146, v147
    s_waitcnt vmcnt(0)
    v_max3_u32 v13, v13, v148, v149
    v_max3_u32 v13, v13, v150, v151
    s_sub_u32 s52, s52, 1
    s_cbranch_scc1 ff_rgo_156
    v_cmp_eq_u32 vcc, -1, v13
    s_cbranch_vccnz ff_rpoll_157
ff_rgo_156:
    v_pk_add_f32 v[96:97], v[96:97], v[100:101]
    v_pk_add_f32 v[98:99], v[98:99], v[102:103]
    v_pk_add_f32 v[96:97], v[96:97], v[104:105]
    v_pk_add_f32 v[98:99], v[98:99], v[106:107]
    v_pk_add_f32 v[96:97], v[96:97], v[108:109]
    v_pk_add_f32 v[98:99], v[98:99], v[110:111]
    v_pk_add_f32 v[96:97], v[96:97], v[112:113]
    v_pk_add_f32 v[98:99], v[98:99], v[114:115]
    v_pk_add_f32 v[96:97], v[96:97], v[116:117]
    v_pk_add_f32 v[98:99], v[98:99], v[118:119]
    v_pk_add_f32 v[96:97], v[96:97], v[120:121]
    v_pk_add_f32 v[98:99], v[98:99], v[122:123]
    v_pk_add_f32 v[96:97], v[96:97], v[124:125]
    v_pk_add_f32 v[98:99], v[98:99], v[126:127]
    v_pk_add_f32 v[96:97], v[96:97], v[128:129]
    v_pk_add_f32 v[98:99], v[98:99], v[130:131]
    v_pk_add_f32 v[96:97], v[96:97], v[132:133]
    v_pk_add_f32 v[98:99], v[98:99], v[134:135]
    v_pk_add_f32 v[96:97], v[96:97], v[136:137]
    v_pk_add_f32 v[98:99], v[98:99], v[138:139]
    v_pk_add_f32 v[96:97], v[96:97], v[140:141]
    v_pk_add_f32 v[98:99], v[98:99], v[142:143]
    v_pk_add_f32 v[96:97], v[96:97], v[144:145]
    v_pk_add_f32 v[98:99], v[98:99], v[146:147]
    v_pk_add_f32 v[96:97], v[96:97], v[148:149]
    v_pk_add_f32 v[98:99], v[98:99], v[150:151]
    v_mov_b32 v100, v96
    v_mov_b32 v101, v97
    v_mov_b32 v102, v98
    v_mov_b32 v103, v99
    s_nop 1
    v_permlane16_swap_b32 v96, v100
    v_permlane16_swap_b32 v97, v101
    v_permlane16_swap_b32 v98, v102
    v_permlane16_swap_b32 v99, v103
    s_nop 1
    v_add_f32 v96, v96, v100
    v_add_f32 v97, v97, v101
    v_add_f32 v98, v98, v102
    v_add_f32 v99, v99, v103
    v_mov_b32 v100, v96
    v_mov_b32 v101, v97
    v_mov_b32 v102, v98
    v_mov_b32 v103, v99
    s_nop 1
    v_permlane32_swap_b32 v96, v100
    v_permlane32_swap_b32 v97, v101
    v_permlane32_swap_b32 v98, v102
    v_permlane32_swap_b32 v99, v103
    s_nop 1
    v_add_f32 v96, v96, v100
    v_add_f32 v97, v97, v101
    v_add_f32 v98, v98, v102
    v_add_f32 v99, v99, v103
    v_lshlrev_b32 v14, 4, v8
    s_lshl_b32 s31, s30, 8
    v_add_u32 v13, s31, v14
    ds_write_b128 v13, v[96:99]
    s_waitcnt lgkmcnt(0)
    s_barrier
    ds_read_b128 v[96:99], v14 offset:0
    ds_read_b128 v[100:103], v14 offset:256
    ds_read_b128 v[104:107], v14 offset:512
    ds_read_b128 v[108:111], v14 offset:768
    s_waitcnt lgkmcnt(0)
    v_pk_add_f32 v[96:97], v[96:97], v[100:101]
    v_pk_add_f32 v[98:99], v[98:99], v[102:103]
    v_pk_add_f32 v[96:97], v[96:97], v[104:105]
    v_pk_add_f32 v[98:99], v[98:99], v[106:107]
    v_pk_add_f32 v[96:97], v[96:97], v[108:109]
    v_pk_add_f32 v[98:99], v[98:99], v[110:111]
    v_cvt_pk_bf16_f32 v20, v96, v97
    v_lshlrev_b32 v21, 16, v20
    v_and_b32 v22, 0xffff0000, v20
    v_mul_f32 v21, s45, v21
    v_mul_f32 v22, s45, v22
    v_cvt_pk_bf16_f32 v20, v21, v22
    v_lshlrev_b32 v21, 16, v20
    v_and_b32 v22, 0xffff0000, v20
    v_lshlrev_b32 v23, 16, v32
    v_and_b32 v24, 0xffff0000, v32
    v_add_f32 v21, v21, v23
    v_add_f32 v22, v22, v24
    v_cvt_pk_bf16_f32 v20, v21, v22
    v_lshlrev_b32 v21, 16, v20
    v_and_b32 v22, 0xffff0000, v20
    v_lshlrev_b32 v23, 16, v34
    v_and_b32 v24, 0xffff0000, v34
    v_add_f32 v21, v21, v23
    v_add_f32 v22, v22, v24
    v_cvt_pk_bf16_f32 v26, v21, v22
    v_cvt_pk_bf16_f32 v20, v98, v99
    v_lshlrev_b32 v21, 16, v20
    v_and_b32 v22, 0xffff0000, v20
    v_mul_f32 v21, s45, v21
    v_mul_f32 v22, s45, v22
    v_cvt_pk_bf16_f32 v20, v21, v22
    v_lshlrev_b32 v21, 16, v20
    v_and_b32 v22, 0xffff0000, v20
    v_lshlrev_b32 v23, 16, v33
    v_and_b32 v24, 0xffff0000, v33
    v_add_f32 v21, v21, v23
    v_add_f32 v22, v22, v24
    v_cvt_pk_bf16_f32 v20, v21, v22
    v_lshlrev_b32 v21, 16, v20
    v_and_b32 v22, 0xffff0000, v20
    v_lshlrev_b32 v23, 16, v35
    v_and_b32 v24, 0xffff0000, v35
    v_add_f32 v21, v21, v23
    v_add_f32 v22, v22, v24
    v_cvt_pk_bf16_f32 v27, v21, v22
    v_cmp_gt_u32 vcc, 16, v2
    s_and_saveexec_b64 s[52:53], vcc
    s_cbranch_execz ff_fin_155
    buffer_store_dwordx2 v[26:27], v9, s[36:39], s46 offen sc1
ff_fin_155:
    s_mov_b64 exec, -1
k12_end_1:
    s_endpgm
k2_prep_76:
    s_sub_u32 s40, s36, s38
    v_subrev_u32 v6, s40, v4
    v_cmp_gt_i32 s[44:45], 0, v6
    v_cmp_gt_i32 s[46:47], 1, v6
    v_cmp_gt_i32 s[48:49], 2, v6
    v_cmp_gt_i32 s[50:51], 3, v6
    v_cndmask_b32 v16, v8, v5, s[44:45]
    v_cndmask_b32 v17, v8, v5, s[46:47]
    v_cndmask_b32 v18, v8, v5, s[48:49]
    v_cndmask_b32 v19, v8, v5, s[50:51]
    v_cmp_gt_i32 s[44:45], 16, v6
    v_cmp_gt_i32 s[46:47], 17, v6
    v_cmp_gt_i32 s[48:49], 18, v6
    v_cmp_gt_i32 s[50:51], 19, v6
    v_cndmask_b32 v32, v8, v5, s[44:45]
    v_cndmask_b32 v33, v8, v5, s[46:47]
    v_cndmask_b32 v34, v8, v5, s[48:49]
    v_cndmask_b32 v35, v8, v5, s[50:51]
    s_nop 1
    s_branch k2_prepret_77
k2_prep_84:
    s_sub_u32 s40, s36, s38
    v_subrev_u32 v6, s40, v4
    v_cmp_gt_i32 s[44:45], 0, v6
    v_cmp_gt_i32 s[46:47], 1, v6
    v_cmp_gt_i32 s[48:49], 2, v6
    v_cmp_gt_i32 s[50:51], 3, v6
    v_cndmask_b32 v16, v8, v5, s[44:45]
    v_cndmask_b32 v17, v8, v5, s[46:47]
    v_cndmask_b32 v18, v8, v5, s[48:49]
    v_cndmask_b32 v19, v8, v5, s[50:51]
    v_cmp_gt_i32 s[44:45], 16, v6
    v_cmp_gt_i32 s[46:47], 17, v6
    v_cmp_gt_i32 s[48:49], 18, v6
    v_cmp_gt_i32 s[50:51], 19, v6
    v_cndmask_b32 v32, v8, v5, s[44:45]
    v_cndmask_b32 v33, v8, v5, s[46:47]
    v_cndmask_b32 v34, v8, v5, s[48:49]
    v_cndmask_b32 v35, v8, v5, s[50:51]
    s_nop 1
    s_branch k2_prepret_85
k2_prep_102:
    s_sub_u32 s40, s36, s39
    v_subrev_u32 v6, s40, v4
    v_cmp_gt_i32 s[44:45], 0, v6
    v_cmp_gt_i32 s[46:47], 1, v6
    v_cmp_gt_i32 s[48:49], 2, v6
    v_cmp_gt_i32 s[50:51], 3, v6
    v_cndmask_b32 v16, v10, v5, s[44:45]
    v_cndmask_b32 v17, v10, v5, s[46:47]
    v_cndmask_b32 v18, v10, v5, s[48:49]
    v_cndmask_b32 v19, v10, v5, s[50:51]
    v_cmp_gt_i32 s[44:45], 16, v6
    v_cmp_gt_i32 s[46:47], 17, v6
    v_cmp_gt_i32 s[48:49], 18, v6
    v_cmp_gt_i32 s[50:51], 19, v6
    v_cndmask_b32 v32, v10, v5, s[44:45]
    v_cndmask_b32 v33, v10, v5, s[46:47]
    v_cndmask_b32 v34, v10, v5, s[48:49]
    v_cndmask_b32 v35, v10, v5, s[50:51]
    v_cmp_gt_i32 s[44:45], 32, v6
    v_cmp_gt_i32 s[46:47], 33, v6
    v_cmp_gt_i32 s[48:49], 34, v6
    v_cmp_gt_i32 s[50:51], 35, v6
    v_cndmask_b32 v24, v10, v5, s[44:45]
    v_cndmask_b32 v25, v10, v5, s[46:47]
    v_cndmask_b32 v26, v10, v5, s[48:49]
    v_cndmask_b32 v27, v10, v5, s[50:51]
    v_cmp_gt_i32 s[44:45], 48, v6
    v_cmp_gt_i32 s[46:47], 49, v6
    v_cmp_gt_i32 s[48:49], 50, v6
    v_cmp_gt_i32 s[50:51], 51, v6
    v_cndmask_b32 v40, v10, v5, s[44:45]
    v_cndmask_b32 v41, v10, v5, s[46:47]
    v_cndmask_b32 v42, v10, v5, s[48:49]
    v_cndmask_b32 v43, v10, v5, s[50:51]
    s_nop 1
    s_branch k2_prepret_103
k2_prep_106:
    s_sub_u32 s40, s36, s39
    s_sub_u32 s40, s40, 64
    v_subrev_u32 v6, s40, v4
    v_cmp_gt_i32 s[44:45], 0, v6
    v_cmp_gt_i32 s[46:47], 1, v6
    v_cmp_gt_i32 s[48:49], 2, v6
    v_cmp_gt_i32 s[50:51], 3, v6
    v_cndmask_b32 v20, v11, v5, s[44:45]
    v_cndmask_b32 v21, v11, v5, s[46:47]
    v_cndmask_b32 v22, v11, v5, s[48:49]
    v_cndmask_b32 v23, v11, v5, s[50:51]
    v_cmp_gt_i32 s[44:45], 16, v6
    v_cmp_gt_i32 s[46:47], 17, v6
    v_cmp_gt_i32 s[48:49], 18, v6
    v_cmp_gt_i32 s[50:51], 19, v6
    v_cndmask_b32 v36, v11, v5, s[44:45]
    v_cndmask_b32 v37, v11, v5, s[46:47]
    v_cndmask_b32 v38, v11, v5, s[48:49]
    v_cndmask_b32 v39, v11, v5, s[50:51]
    v_cmp_gt_i32 s[44:45], 32, v6
    v_cmp_gt_i32 s[46:47], 33, v6
    v_cmp_gt_i32 s[48:49], 34, v6
    v_cmp_gt_i32 s[50:51], 35, v6
    v_cndmask_b32 v28, v11, v5, s[44:45]
    v_cndmask_b32 v29, v11, v5, s[46:47]
    v_cndmask_b32 v30, v11, v5, s[48:49]
    v_cndmask_b32 v31, v11, v5, s[50:51]
    v_cmp_gt_i32 s[44:45], 48, v6
    v_cmp_gt_i32 s[46:47], 49, v6
    v_cmp_gt_i32 s[48:49], 50, v6
    v_cmp_gt_i32 s[50:51], 51, v6
    v_cndmask_b32 v44, v11, v5, s[44:45]
    v_cndmask_b32 v45, v11, v5, s[46:47]
    v_cndmask_b32 v46, v11, v5, s[48:49]
    v_cndmask_b32 v47, v11, v5, s[50:51]
    s_nop 1
    s_branch k2_prepret_107
k12_ool_10:
    buffer_load_dword v52, v8, s[24:27], 0 offen sc1
    s_branch k12_oolret_11
k12_ool_14:
    v_readfirstlane_b32 s31, v52
    s_cmp_ge_u32 s31, 256
    s_cbranch_scc1 spin_ok_12
    s_mov_b32 s40, 1048576
spin_13:
    s_sleep 8
    buffer_load_dword v52, v8, s[24:27], 0 offen sc1
    s_waitcnt vmcnt(0)
    v_readfirstlane_b32 s31, v52
    s_sub_u32 s40, s40, 1
    s_cselect_b32 s31, -1, s31
    s_cmp_lt_u32 s31, 256
    s_cbranch_scc1 spin_13
spin_ok_12:
    s_branch k12_oolret_15
k12_ool_16:
    s_mov_b64 exec, 1
    buffer_atomic_add v9, v8, s[24:27], 0 offen sc1
    s_mov_b64 exec, -1
    s_branch k12_oolret_17
k12_ool_18:
    buffer_load_dword v51, v50, s[12:15], s56 offen
    s_branch k12_oolret_19
k12_ool_20:
    s_add_u32 m0, s60, 131072
    s_nop 0
    buffer_load_dwordx4 v38, s[12:15], s61 offen offset:0 lds
    buffer_load_dwordx4 v39, s[12:15], s61 offen offset:1024 lds
    buffer_load_dwordx4 v40, s[12:15], s61 offen offset:2048 lds
    buffer_load_dwordx4 v41, s[12:15], s61 offen offset:3072 lds
    s_add_u32 s61, s61, 0x80000
    s_add_u32 m0, s60, 147456
    s_nop 0
    buffer_load_dwordx4 v38, s[12:15], s61 offen offset:0 lds
    buffer_load_dwordx4 v39, s[12:15], s61 offen offset:1024 lds
    buffer_load_dwordx4 v40, s[12:15], s61 offen offset:2048 lds
    buffer_load_dwordx4 v41, s[12:15], s61 offen offset:3072 lds
    s_add_u32 s61, s61, 0x80000
    s_branch k12_oolret_21
k12_ool_22:
    s_mov_b64 exec, 1
    buffer_atomic_add v9, v8, s[24:27], 0 offen sc1
    s_mov_b64 exec, -1
    s_branch k12_oolret_23
k12_ool_24:
    buffer_load_dword v51, v50, s[12:15], s56 offen
    s_branch k12_oolret_25
k12_ool_26:
    global_load_dword v51, v[2:3], off
    s_branch k12_oolret_27
k12_ool_30:
    buffer_load_dword v52, v8, s[24:27], 0 offen sc1
    s_branch k12_oolret_31
k12_ool_34:
    v_readfirstlane_b32 s31, v52
    s_cmp_ge_u32 s31, 256
    s_cbranch_scc1 spin_ok_32
    s_mov_b32 s40, 1048576
spin_33:
    s_sleep 8
    buffer_load_dword v52, v8, s[24:27], 0 offen sc1
    s_waitcnt vmcnt(0)
    v_readfirstlane_b32 s31, v52
    s_sub_u32 s40, s40, 1
    s_cselect_b32 s31, -1, s31
    s_cmp_lt_u32 s31, 256
    s_cbranch_scc1 spin_33
spin_ok_32:
    s_branch k12_oolret_35
k12_ool_36:
    s_mov_b64 exec, 1
    buffer_atomic_add v9, v8, s[24:27], 0 offen sc1
    s_mov_b64 exec, -1
    s_branch k12_oolret_37
k12_ool_38:
    buffer_load_dword v51, v50, s[12:15], s56 offen
    s_branch k12_oolret_39
k12_ool_40:
    s_add_u32 m0, s60, 131072
    s_nop 0
    buffer_load_dwordx4 v38, s[12:15], s61 offen offset:0 lds
    buffer_load_dwordx4 v39, s[12:15], s61 offen offset:1024 lds
    buffer_load_dwordx4 v40, s[12:15], s61 offen offset:2048 lds
    buffer_load_dwordx4 v41, s[12:15], s61 offen offset:3072 lds
    s_add_u32 s61, s61, 0x80000
    s_add_u32 m0, s60, 147456
    s_nop 0
    buffer_load_dwordx4 v38, s[12:15], s61 offen offset:0 lds
    buffer_load_dwordx4 v39, s[12:15], s61 offen offset:1024 lds
    buffer_load_dwordx4 v40, s[12:15], s61 offen offset:2048 lds
    buffer_load_dwordx4 v41, s[12:15], s61 offen offset:3072 lds
    s_add_u32 s61, s61, 0x80000
    s_branch k12_oolret_41
k12_ool_42:
    s_mov_b64 exec, 1
    buffer_atomic_add v9, v8, s[24:27], 0 offen sc1
    s_mov_b64 exec, -1
    s_branch k12_oolret_43
k12_ool_44:
    buffer_load_dword v51, v50, s[12:15], s56 offen
    s_branch k12_oolret_45
k12_ool_46:
    global_load_dword v51, v[2:3], off
    s_branch k12_oolret_47
k12_ool_48:
    s_add_u32 s52, s47, 528384
    buffer_store_dwordx4 v[152:155], v1, s[48:51], s52 offen offset:2048 sc1
    s_branch k12_oolret_49
k12_ool_50:
    s_add_u32 s52, s47, 528384
    buffer_store_dwordx4 v[156:159], v1, s[48:51], s52 offen offset:3072 sc1
    s_branch k12_oolret_51
k12_ool_52:
    s_add_u32 s52, s47, 532480
    buffer_store_dwordx4 v[168:171], v1, s[48:51], s52 offen offset:2048 sc1
    s_branch k12_oolret_53
k12_ool_54:
    s_add_u32 s52, s47, 532480
    buffer_store_dwordx4 v[172:175], v1, s[48:51], s52 offen offset:3072 sc1
    s_branch k12_oolret_55
k12_ool_56:
    s_add_u32 s52, s47, 536576
    buffer_store_dwordx4 v[176:179], v1, s[48:51], s52 offen offset:0 sc1
    s_branch k12_oolret_57
k12_ool_58:
    s_add_u32 s52, s47, 536576
    buffer_store_dwordx4 v[180:183], v1, s[48:51], s52 offen offset:1024 sc1
    s_branch k12_oolret_59
k12_ool_60:
    s_add_u32 s52, s47, 536576
    buffer_store_dwordx4 v[184:187], v1, s[48:51], s52 offen offset:2048 sc1
    s_branch k12_oolret_61
k12_ool_62:
    s_add_u32 s52, s47, 536576
    buffer_store_dwordx4 v[188:191], v1, s[48:51], s52 offen offset:3072 sc1
    s_branch k12_oolret_63
k12_ool_64:
    s_mov_b32 s50, 0
    s_branch k12_oolret_65
k12_ool_66:
    s_mov_b64 exec, 1
    buffer_atomic_add v9, v8, s[24:27], s54 offen sc1
    s_mov_b64 exec, -1
    s_branch k12_oolret_67
k12_ool_68:
    buffer_load_dword v52, v8, s[24:27], s55 offen sc1
    s_branch k12_oolret_69
k12_ool_72:
    s_waitcnt vmcnt(10)
    v_readfirstlane_b32 s31, v52
    s_cmp_ge_u32 s31, 2
    s_cbranch_scc1 spin_ok_70
    s_mov_b32 s40, 1048576
spin_71:
    s_sleep 8
    buffer_load_dword v52, v8, s[24:27], s55 offen sc1
    s_waitcnt vmcnt(0)
    v_readfirstlane_b32 s31, v52
    s_sub_u32 s40, s40, 1
    s_cselect_b32 s31, -1, s31
    s_cmp_lt_u32 s31, 2
    s_cbranch_scc1 spin_71
spin_ok_70:
    s_branch k12_oolret_73
k12_ool_74:
    s_mov_b64 exec, 1
    buffer_atomic_add v9, v8, s[24:27], s3 offen sc1
    s_mov_b64 exec, -1
    s_branch k12_oolret_75
k12_ool_78:
    buffer_load_dword v58, v59, s[24:27], s5 offen sc1
    s_branch k12_oolret_79
k12_ool_82:
    s_waitcnt vmcnt(0)
    v_readfirstlane_b32 s31, v58
    s_cmp_ge_u32 s31, 14
    s_cbranch_scc1 spin_ok_80
    s_mov_b32 s40, 1048576
spin_81:
    s_sleep 8
    buffer_load_dword v58, v59, s[24:27], s5 offen sc1
    s_waitcnt vmcnt(0)
    v_readfirstlane_b32 s31, v58
    s_sub_u32 s40, s40, 1
    s_cselect_b32 s31, -1, s31
    s_cmp_lt_u32 s31, 14
    s_cbranch_scc1 spin_81
spin_ok_80:
    s_branch k12_oolret_83
k12_ool_122:
    s_mov_b64 exec, 1
    buffer_atomic_add v76, v75, s[16:19], s57 offen sc1
    s_mov_b64 exec, -1
    s_branch k12_oolret_123
k12_ool_127:
    s_mov_b64 exec, 1
    buffer_atomic_add v76, v75, s[16:19], s58 offen sc1
    s_mov_b64 exec, -1
    s_branch k12_oolret_128
k12_ool_131:
    s_mov_b32 s34, 1048576
op_spin_129:
    buffer_load_dword v74, v73, s[16:19], s59 offen sc1
    s_waitcnt vmcnt(0)
    v_cmp_le_u32 vcc, 4, v74
    s_sub_u32 s34, s34, 1
    s_cbranch_scc1 op_ok_130
    s_mov_b32 s33, vcc_lo
    s_bitcmp1_b32 s33, 0
    s_cbranch_scc1 op_ok_130
    s_sleep 4
    s_branch op_spin_129
op_ok_130:
    buffer_load_dwordx4 a[128:131], v88, s[8:11], s62 offen offset:0 sc1
    buffer_load_dwordx4 a[132:135], v88, s[8:11], s62 offen offset:1024 sc1
    buffer_load_dwordx4 a[136:139], v89, s[8:11], s62 offen offset:0 sc1
    buffer_load_dwordx4 a[140:143], v89, s[8:11], s62 offen offset:1024 sc1
    s_add_u32 s62, s62, 0x40000
    s_and_b32 s62, s62, 0x7fffff
    buffer_load_dwordx4 a[144:147], v88, s[8:11], s62 offen offset:0 sc1
    buffer_load_dwordx4 a[148:151], v88, s[8:11], s62 offen offset:1024 sc1
    buffer_load_dwordx4 a[152:155], v89, s[8:11], s62 offen offset:0 sc1
    buffer_load_dwordx4 a[156:159], v89, s[8:11], s62 offen offset:1024 sc1
    s_add_u32 s62, s62, 0x40000
    s_and_b32 s62, s62, 0x7fffff
    buffer_load_dwordx4 a[160:163], v88, s[8:11], s62 offen offset:0 sc1
    buffer_load_dwordx4 a[164:167], v88, s[8:11], s62 offen offset:1024 sc1
    buffer_load_dwordx4 a[168:171], v89, s[8:11], s62 offen offset:0 sc1
    buffer_load_dwordx4 a[172:175], v89, s[8:11], s62 offen offset:1024 sc1
    s_add_u32 s62, s62, 0x40000
    s_and_b32 s62, s62, 0x7fffff
    s_branch k12_oolret_132
k12_ool_137:
    buffer_load_dwordx2 v[192:193], v78, s[20:23], 0 offen offset:0
    buffer_load_dwordx2 v[194:195], v78, s[20:23], 0 offen offset:32
    buffer_load_dwordx2 v[196:197], v78, s[20:23], 0 offen offset:64
    buffer_load_dwordx2 v[198:199], v78, s[20:23], 0 offen offset:96
    buffer_load_dwordx2 v[200:201], v79, s[20:23], 0 offen offset:0
    buffer_load_dwordx2 v[202:203], v79, s[20:23], 0 offen offset:32
    buffer_load_dwordx2 v[204:205], v79, s[20:23], 0 offen offset:64
    buffer_load_dwordx2 v[206:207], v79, s[20:23], 0 offen offset:96
    buffer_load_dwordx2 v[208:209], v80, s[44:47], 0 offen offset:0
    buffer_load_dwordx2 v[210:211], v80, s[44:47], 0 offen offset:32
    buffer_load_dwordx2 v[212:213], v80, s[44:47], 0 offen offset:64
    buffer_load_dwordx2 v[214:215], v80, s[44:47], 0 offen offset:96
    global_load_dword v84, v[82:83], off
    s_mov_b32 s10, 0
    s_mov_b32 s14, 0
    s_mov_b32 s34, 1048576
ff_spin_135:
    v_cmp_gt_u32 vcc, 4, v95
    s_cbranch_vccz ff_ok_136
    s_sub_u32 s34, s34, 1
    s_cbranch_scc1 ff_ok_136
    s_sleep 4
    buffer_load_dword v95, v94, s[16:19], 0 offen sc1
    s_waitcnt vmcnt(0)
    s_branch ff_spin_135
ff_ok_136:
    s_add_u32 s44, s6, 0x6000000
    s_addc_u32 s45, s7, 0
    s_and_b32 s45, s45, 0xffff
    s_cmp_ge_u32 s2, 224
    s_cselect_b32 s46, 0, 0x1000000
    s_branch k12_oolret_138
k12_ool_141:
    s_mov_b32 s34, 1048576
op_spin_139:
    buffer_load_dword v74, v73, s[16:19], s59 offen sc1
    s_waitcnt vmcnt(0)
    v_cmp_le_u32 vcc, 4, v74
    s_sub_u32 s34, s34, 1
    s_cbranch_scc1 op_ok_140
    s_mov_b32 s33, vcc_lo
    s_bitcmp1_b32 s33, s32
    s_cbranch_scc1 op_ok_140
    s_sleep 4
    s_branch op_spin_139
op_ok_140:
    s_branch k12_oolret_142
k12_ool_143:
    buffer_load_dword v95, v94, s[16:19], 0 offen sc1
    s_branch k12_oolret_144
k2_tramp_86:
    s_call_b64 s[40:41], k2_rare_158
    s_branch k2_ret_87
k2_tramp_90:
    s_call_b64 s[40:41], k2_rare_159
    s_branch k2_ret_91
k2_tramp_92:
    s_call_b64 s[40:41], k2_rare_158
    s_branch k2_ret_93
k2_tramp_94:
    s_call_b64 s[40:41], k2_rare_159
    s_branch k2_ret_95
k2_tramp_96:
    s_call_b64 s[40:41], k2_rare_158
    s_branch k2_ret_97
k2_tramp_98:
    s_call_b64 s[40:41], k2_rare_159
    s_branch k2_ret_99
k2_tramp_100:
    s_call_b64 s[40:41], k2_rare_164
    s_branch k2_ret_101
k2_tramp_104:
    s_call_b64 s[40:41], k2_rare_165
    s_branch k2_ret_105
k2_tramp_108:
    s_call_b64 s[40:41], k2_rare_166
    s_branch k2_ret_109
k2_tramp_112:
    s_call_b64 s[40:41], k2_rare_167
    s_branch k2_ret_113
k2_tramp_114:
    s_call_b64 s[40:41], k2_rare_166
    s_branch k2_ret_115
k2_tramp_116:
    s_call_b64 s[40:41], k2_rare_167
    s_branch k2_ret_117
k2_tramp_118:
    s_call_b64 s[40:41], k2_rare_166
    s_branch k2_ret_119
k2_tramp_120:
    s_call_b64 s[40:41], k2_rare_171
    s_branch k2_ret_121
k2_rare_158:
    s_nop 7
    v_max_f32 v52, v128, v129
    v_max3_f32 v52, v52, v130, v131
    v_max3_f32 v52, v52, v144, v145
    v_max3_f32 v52, v52, v146, v147
    v_max_f32 v53, v132, v133
    v_max3_f32 v53, v53, v134, v135
    v_max3_f32 v53, v53, v148, v149
    v_max3_f32 v53, v53, v150, v151
    v_max_f32 v54, v136, v137
    v_max3_f32 v54, v54, v138, v139
    v_max3_f32 v54, v54, v152, v153
    v_max3_f32 v54, v54, v154, v155
    v_max_f32 v55, v140, v141
    v_max3_f32 v55, v55, v142, v143
    v_max3_f32 v55, v55, v156, v157
    v_max3_f32 v55, v55, v158, v159
    v_mov_b32 v224, v52
    v_mov_b32 v225, v53
    v_mov_b32 v226, v54
    v_mov_b32 v227, v55
    s_nop 1
    v_permlane16_swap_b32 v52, v224
    v_permlane16_swap_b32 v53, v225
    v_permlane16_swap_b32 v54, v226
    v_permlane16_swap_b32 v55, v227
    s_nop 1
    v_max_f32 v52, v52, v224
    v_max_f32 v53, v53, v225
    v_max_f32 v54, v54, v226
    v_max_f32 v55, v55, v227
    v_mov_b32 v224, v52
    v_mov_b32 v225, v53
    v_mov_b32 v226, v54
    v_mov_b32 v227, v55
    s_nop 1
    v_permlane32_swap_b32 v52, v224
    v_permlane32_swap_b32 v53, v225
    v_permlane32_swap_b32 v54, v226
    v_permlane32_swap_b32 v55, v227
    s_nop 1
    v_max_f32 v52, v52, v224
    v_max_f32 v53, v53, v225
    v_max_f32 v54, v54, v226
    v_max_f32 v55, v55, v227
    v_add_f32 v52, 0x41400000, v52
    v_max_f32 v52, 0, v52
    v_add_f32 v53, 0x41400000, v53
    v_max_f32 v53, 0, v53
    v_add_f32 v54, 0x41400000, v54
    v_max_f32 v54, 0, v54
    v_add_f32 v55, 0x41400000, v55
    v_max_f32 v55, 0, v55
    v_sub_f32 v128, v128, v52
    v_sub_f32 v129, v129, v52
    v_sub_f32 v130, v130, v52
    v_sub_f32 v131, v131, v52
    v_sub_f32 v132, v132, v53
    v_sub_f32 v133, v133, v53
    v_sub_f32 v134, v134, v53
    v_sub_f32 v135, v135, v53
    v_sub_f32 v136, v136, v54
    v_sub_f32 v137, v137, v54
    v_sub_f32 v138, v138, v54
    v_sub_f32 v139, v139, v54
    v_sub_f32 v140, v140, v55
    v_sub_f32 v141, v141, v55
    v_sub_f32 v142, v142, v55
    v_sub_f32 v143, v143, v55
    v_sub_f32 v144, v144, v52
    v_sub_f32 v145, v145, v52
    v_sub_f32 v146, v146, v52
    v_sub_f32 v147, v147, v52
    v_sub_f32 v148, v148, v53
    v_sub_f32 v149, v149, v53
    v_sub_f32 v150, v150, v53
    v_sub_f32 v151, v151, v53
    v_sub_f32 v152, v152, v54
    v_sub_f32 v153, v153, v54
    v_sub_f32 v154, v154, v54
    v_sub_f32 v155, v155, v54
    v_sub_f32 v156, v156, v55
    v_sub_f32 v157, v157, v55
    v_sub_f32 v158, v158, v55
    v_sub_f32 v159, v159, v55
    v_sub_f32 v160, v160, v52
    v_sub_f32 v16, v16, v52
    v_sub_f32 v161, v161, v52
    v_sub_f32 v17, v17, v52
    v_sub_f32 v162, v162, v52
    v_sub_f32 v18, v18, v52
    v_sub_f32 v163, v163, v52
    v_sub_f32 v19, v19, v52
    v_sub_f32 v164, v164, v53
    v_sub_f32 v20, v20, v53
    v_sub_f32 v165, v165, v53
    v_sub_f32 v21, v21, v53
    v_sub_f32 v166, v166, v53
    v_sub_f32 v22, v22, v53
    v_sub_f32 v167, v167, v53
    v_sub_f32 v23, v23, v53
    v_sub_f32 v168, v168, v54
    v_sub_f32 v24, v24, v54
    v_sub_f32 v169, v169, v54
    v_sub_f32 v25, v25, v54
    v_sub_f32 v170, v170, v54
    v_sub_f32 v26, v26, v54
    v_sub_f32 v171, v171, v54
    v_sub_f32 v27, v27, v54
    v_sub_f32 v172, v172, v55
    v_sub_f32 v28, v28, v55
    v_sub_f32 v173, v173, v55
    v_sub_f32 v29, v29, v55
    v_sub_f32 v174, v174, v55
    v_sub_f32 v30, v30, v55
    v_sub_f32 v175, v175, v55
    v_sub_f32 v31, v31, v55
    v_sub_f32 v176, v176, v52
    v_sub_f32 v32, v32, v52
    v_sub_f32 v177, v177, v52
    v_sub_f32 v33, v33, v52
    v_sub_f32 v178, v178, v52
    v_sub_f32 v34, v34, v52
    v_sub_f32 v179, v179, v52
    v_sub_f32 v35, v35, v52
    v_sub_f32 v180, v180, v53
    v_sub_f32 v36, v36, v53
    v_sub_f32 v181, v181, v53
    v_sub_f32 v37, v37, v53
    v_sub_f32 v182, v182, v53
    v_sub_f32 v38, v38, v53
    v_sub_f32 v183, v183, v53
    v_sub_f32 v39, v39, v53
    v_sub_f32 v184, v184, v54
    v_sub_f32 v40, v40, v54
    v_sub_f32 v185, v185, v54
    v_sub_f32 v41, v41, v54
    v_sub_f32 v186, v186, v54
    v_sub_f32 v42, v42, v54
    v_sub_f32 v187, v187, v54
    v_sub_f32 v43, v43, v54
    v_sub_f32 v188, v188, v55
    v_sub_f32 v44, v44, v55
    v_sub_f32 v189, v189, v55
    v_sub_f32 v45, v45, v55
    v_sub_f32 v190, v190, v55
    v_sub_f32 v46, v46, v55
    v_sub_f32 v191, v191, v55
    v_sub_f32 v47, v47, v55
    v_sub_f32 v8, v8, v52
    v_exp_f32 v52, -v52
    v_sub_f32 v9, v9, v53
    v_exp_f32 v53, -v53
    v_sub_f32 v10, v10, v54
    v_exp_f32 v54, -v54
    v_sub_f32 v11, v11, v55
    v_exp_f32 v55, -v55
    s_nop 0
    v_mul_f32 v12, v12, v52
    v_mul_f32 v48, v48, v53
    v_mul_f32 v248, v248, v54
    v_mul_f32 v252, v252, v55
    v_accvgpr_read_b32 v224, a0
    v_accvgpr_read_b32 v225, a1
    v_accvgpr_read_b32 v226, a2
    v_accvgpr_read_b32 v227, a3
    v_mul_f32 v224, v224, v52
    v_mul_f32 v225, v225, v52
    v_mul_f32 v226, v226, v52
    v_mul_f32 v227, v227, v52
    v_accvgpr_write_b32 a0, v224
    v_accvgpr_write_b32 a1, v225
    v_accvgpr_write_b32 a2, v226
    v_accvgpr_write_b32 a3, v227
    v_accvgpr_read_b32 v224, a4
    v_accvgpr_read_b32 v225, a5
    v_accvgpr_read_b32 v226, a6
    v_accvgpr_read_b32 v227, a7
    v_mul_f32 v224, v224, v53
    v_mul_f32 v225, v225, v53
    v_mul_f32 v226, v226, v53
    v_mul_f32 v227, v227, v53
    v_accvgpr_write_b32 a4, v224
    v_accvgpr_write_b32 a5, v225
    v_accvgpr_write_b32 a6, v226
    v_accvgpr_write_b32 a7, v227
    v_accvgpr_read_b32 v224, a8
    v_accvgpr_read_b32 v225, a9
    v_accvgpr_read_b32 v226, a10
    v_accvgpr_read_b32 v227, a11
    v_mul_f32 v224, v224, v54
    v_mul_f32 v225, v225, v54
    v_mul_f32 v226, v226, v54
    v_mul_f32 v227, v227, v54
    v_accvgpr_write_b32 a8, v224
    v_accvgpr_write_b32 a9, v225
    v_accvgpr_write_b32 a10, v226
    v_accvgpr_write_b32 a11, v227
    v_accvgpr_read_b32 v224, a12
    v_accvgpr_read_b32 v225, a13
    v_accvgpr_read_b32 v226, a14
    v_accvgpr_read_b32 v227, a15
    v_mul_f32 v224, v224, v55
    v_mul_f32 v225, v225, v55
    v_mul_f32 v226, v226, v55
    v_mul_f32 v227, v227, v55
    v_accvgpr_write_b32 a12, v224
    v_accvgpr_write_b32 a13, v225
    v_accvgpr_write_b32 a14, v226
    v_accvgpr_write_b32 a15, v227
    v_accvgpr_read_b32 v224, a16
    v_accvgpr_read_b32 v225, a17
    v_accvgpr_read_b32 v226, a18
    v_accvgpr_read_b32 v227, a19
    v_mul_f32 v224, v224, v52
    v_mul_f32 v225, v225, v52
    v_mul_f32 v226, v226, v52
    v_mul_f32 v227, v227, v52
    v_accvgpr_write_b32 a16, v224
    v_accvgpr_write_b32 a17, v225
    v_accvgpr_write_b32 a18, v226
    v_accvgpr_write_b32 a19, v227
    v_accvgpr_read_b32 v224, a20
    v_accvgpr_read_b32 v225, a21
    v_accvgpr_read_b32 v226, a22
    v_accvgpr_read_b32 v227, a23
    v_mul_f32 v224, v224, v53
    v_mul_f32 v225, v225, v53
    v_mul_f32 v226, v226, v53
    v_mul_f32 v227, v227, v53
    v_accvgpr_write_b32 a20, v224
    v_accvgpr_write_b32 a21, v225
    v_accvgpr_write_b32 a22, v226
    v_accvgpr_write_b32 a23, v227
    v_accvgpr_read_b32 v224, a24
    v_accvgpr_read_b32 v225, a25
    v_accvgpr_read_b32 v226, a26
    v_accvgpr_read_b32 v227, a27
    v_mul_f32 v224, v224, v54
    v_mul_f32 v225, v225, v54
    v_mul_f32 v226, v226, v54
    v_mul_f32 v227, v227, v54
    v_accvgpr_write_b32 a24, v224
    v_accvgpr_write_b32 a25, v225
    v_accvgpr_write_b32 a26, v226
    v_accvgpr_write_b32 a27, v227
    v_accvgpr_read_b32 v224, a28
    v_accvgpr_read_b32 v225, a29
    v_accvgpr_read_b32 v226, a30
    v_accvgpr_read_b32 v227, a31
    v_mul_f32 v224, v224, v55
    v_mul_f32 v225, v225, v55
    v_mul_f32 v226, v226, v55
    v_mul_f32 v227, v227, v55
    v_accvgpr_write_b32 a28, v224
    v_accvgpr_write_b32 a29, v225
    v_accvgpr_write_b32 a30, v226
    v_accvgpr_write_b32 a31, v227
    v_accvgpr_read_b32 v224, a32
    v_accvgpr_read_b32 v225, a33
    v_accvgpr_read_b32 v226, a34
    v_accvgpr_read_b32 v227, a35
    v_mul_f32 v224, v224, v52
    v_mul_f32 v225, v225, v52
    v_mul_f32 v226, v226, v52
    v_mul_f32 v227, v227, v52
    v_accvgpr_write_b32 a32, v224
    v_accvgpr_write_b32 a33, v225
    v_accvgpr_write_b32 a34, v226
    v_accvgpr_write_b32 a35, v227
    v_accvgpr_read_b32 v224, a36
    v_accvgpr_read_b32 v225, a37
    v_accvgpr_read_b32 v226, a38
    v_accvgpr_read_b32 v227, a39
    v_mul_f32 v224, v224, v53
    v_mul_f32 v225, v225, v53
    v_mul_f32 v226, v226, v53
    v_mul_f32 v227, v227, v53
    v_accvgpr_write_b32 a36, v224
    v_accvgpr_write_b32 a37, v225
    v_accvgpr_write_b32 a38, v226
    v_accvgpr_write_b32 a39, v227
    v_accvgpr_read_b32 v224, a40
    v_accvgpr_read_b32 v225, a41
    v_accvgpr_read_b32 v226, a42
    v_accvgpr_read_b32 v227, a43
    v_mul_f32 v224, v224, v54
    v_mul_f32 v225, v225, v54
    v_mul_f32 v226, v226, v54
    v_mul_f32 v227, v227, v54
    v_accvgpr_write_b32 a40, v224
    v_accvgpr_write_b32 a41, v225
    v_accvgpr_write_b32 a42, v226
    v_accvgpr_write_b32 a43, v227
    v_accvgpr_read_b32 v224, a44
    v_accvgpr_read_b32 v225, a45
    v_accvgpr_read_b32 v226, a46
    v_accvgpr_read_b32 v227, a47
    v_mul_f32 v224, v224, v55
    v_mul_f32 v225, v225, v55
    v_mul_f32 v226, v226, v55
    v_mul_f32 v227, v227, v55
    v_accvgpr_write_b32 a44, v224
    v_accvgpr_write_b32 a45, v225
    v_accvgpr_write_b32 a46, v226
    v_accvgpr_write_b32 a47, v227
    v_accvgpr_read_b32 v224, a48
    v_accvgpr_read_b32 v225, a49
    v_accvgpr_read_b32 v226, a50
    v_accvgpr_read_b32 v227, a51
    v_mul_f32 v224, v224, v52
    v_mul_f32 v225, v225, v52
    v_mul_f32 v226, v226, v52
    v_mul_f32 v227, v227, v52
    v_accvgpr_write_b32 a48, v224
    v_accvgpr_write_b32 a49, v225
    v_accvgpr_write_b32 a50, v226
    v_accvgpr_write_b32 a51, v227
    v_accvgpr_read_b32 v224, a52
    v_accvgpr_read_b32 v225, a53
    v_accvgpr_read_b32 v226, a54
    v_accvgpr_read_b32 v227, a55
    v_mul_f32 v224, v224, v53
    v_mul_f32 v225, v225, v53
    v_mul_f32 v226, v226, v53
    v_mul_f32 v227, v227, v53
    v_accvgpr_write_b32 a52, v224
    v_accvgpr_write_b32 a53, v225
    v_accvgpr_write_b32 a54, v226
    v_accvgpr_write_b32 a55, v227
    v_accvgpr_read_b32 v224, a56
    v_accvgpr_read_b32 v225, a57
    v_accvgpr_read_b32 v226, a58
    v_accvgpr_read_b32 v227, a59
    v_mul_f32 v224, v224, v54
    v_mul_f32 v225, v225, v54
    v_mul_f32 v226, v226, v54
    v_mul_f32 v227, v227, v54
    v_accvgpr_write_b32 a56, v224
    v_accvgpr_write_b32 a57, v225
    v_accvgpr_write_b32 a58, v226
    v_accvgpr_write_b32 a59, v227
    v_accvgpr_read_b32 v224, a60
    v_accvgpr_read_b32 v225, a61
    v_accvgpr_read_b32 v226, a62
    v_accvgpr_read_b32 v227, a63
    v_mul_f32 v224, v224, v55
    v_mul_f32 v225, v225, v55
    v_mul_f32 v226, v226, v55
    v_mul_f32 v227, v227, v55
    v_accvgpr_write_b32 a60, v224
    v_accvgpr_write_b32 a61, v225
    v_accvgpr_write_b32 a62, v226
    v_accvgpr_write_b32 a63, v227
    v_accvgpr_read_b32 v224, a64
    v_accvgpr_read_b32 v225, a65
    v_accvgpr_read_b32 v226, a66
    v_accvgpr_read_b32 v227, a67
    v_mul_f32 v224, v224, v52
    v_mul_f32 v225, v225, v52
    v_mul_f32 v226, v226, v52
    v_mul_f32 v227, v227, v52
    v_accvgpr_write_b32 a64, v224
    v_accvgpr_write_b32 a65, v225
    v_accvgpr_write_b32 a66, v226
    v_accvgpr_write_b32 a67, v227
    v_accvgpr_read_b32 v224, a68
    v_accvgpr_read_b32 v225, a69
    v_accvgpr_read_b32 v226, a70
    v_accvgpr_read_b32 v227, a71
    v_mul_f32 v224, v224, v53
    v_mul_f32 v225, v225, v53
    v_mul_f32 v226, v226, v53
    v_mul_f32 v227, v227, v53
    v_accvgpr_write_b32 a68, v224
    v_accvgpr_write_b32 a69, v225
    v_accvgpr_write_b32 a70, v226
    v_accvgpr_write_b32 a71, v227
    v_accvgpr_read_b32 v224, a72
    v_accvgpr_read_b32 v225, a73
    v_accvgpr_read_b32 v226, a74
    v_accvgpr_read_b32 v227, a75
    v_mul_f32 v224, v224, v54
    v_mul_f32 v225, v225, v54
    v_mul_f32 v226, v226, v54
    v_mul_f32 v227, v227, v54
    v_accvgpr_write_b32 a72, v224
    v_accvgpr_write_b32 a73, v225
    v_accvgpr_write_b32 a74, v226
    v_accvgpr_write_b32 a75, v227
    v_accvgpr_read_b32 v224, a76
    v_accvgpr_read_b32 v225, a77
    v_accvgpr_read_b32 v226, a78
    v_accvgpr_read_b32 v227, a79
    v_mul_f32 v224, v224, v55
    v_mul_f32 v225, v225, v55
    v_mul_f32 v226, v226, v55
    v_mul_f32 v227, v227, v55
    v_accvgpr_write_b32 a76, v224
    v_accvgpr_write_b32 a77, v225
    v_accvgpr_write_b32 a78, v226
    v_accvgpr_write_b32 a79, v227
    v_accvgpr_read_b32 v224, a80
    v_accvgpr_read_b32 v225, a81
    v_accvgpr_read_b32 v226, a82
    v_accvgpr_read_b32 v227, a83
    v_mul_f32 v224, v224, v52
    v_mul_f32 v225, v225, v52
    v_mul_f32 v226, v226, v52
    v_mul_f32 v227, v227, v52
    v_accvgpr_write_b32 a80, v224
    v_accvgpr_write_b32 a81, v225
    v_accvgpr_write_b32 a82, v226
    v_accvgpr_write_b32 a83, v227
    v_accvgpr_read_b32 v224, a84
    v_accvgpr_read_b32 v225, a85
    v_accvgpr_read_b32 v226, a86
    v_accvgpr_read_b32 v227, a87
    v_mul_f32 v224, v224, v53
    v_mul_f32 v225, v225, v53
    v_mul_f32 v226, v226, v53
    v_mul_f32 v227, v227, v53
    v_accvgpr_write_b32 a84, v224
    v_accvgpr_write_b32 a85, v225
    v_accvgpr_write_b32 a86, v226
    v_accvgpr_write_b32 a87, v227
    v_accvgpr_read_b32 v224, a88
    v_accvgpr_read_b32 v225, a89
    v_accvgpr_read_b32 v226, a90
    v_accvgpr_read_b32 v227, a91
    v_mul_f32 v224, v224, v54
    v_mul_f32 v225, v225, v54
    v_mul_f32 v226, v226, v54
    v_mul_f32 v227, v227, v54
    v_accvgpr_write_b32 a88, v224
    v_accvgpr_write_b32 a89, v225
    v_accvgpr_write_b32 a90, v226
    v_accvgpr_write_b32 a91, v227
    v_accvgpr_read_b32 v224, a92
    v_accvgpr_read_b32 v225, a93
    v_accvgpr_read_b32 v226, a94
    v_accvgpr_read_b32 v227, a95
    v_mul_f32 v224, v224, v55
    v_mul_f32 v225, v225, v55
    v_mul_f32 v226, v226, v55
    v_mul_f32 v227, v227, v55
    v_accvgpr_write_b32 a92, v224
    v_accvgpr_write_b32 a93, v225
    v_accvgpr_write_b32 a94, v226
    v_accvgpr_write_b32 a95, v227
    v_accvgpr_read_b32 v224, a96
    v_accvgpr_read_b32 v225, a97
    v_accvgpr_read_b32 v226, a98
    v_accvgpr_read_b32 v227, a99
    v_mul_f32 v224, v224, v52
    v_mul_f32 v225, v225, v52
    v_mul_f32 v226, v226, v52
    v_mul_f32 v227, v227, v52
    v_accvgpr_write_b32 a96, v224
    v_accvgpr_write_b32 a97, v225
    v_accvgpr_write_b32 a98, v226
    v_accvgpr_write_b32 a99, v227
    v_accvgpr_read_b32 v224, a100
    v_accvgpr_read_b32 v225, a101
    v_accvgpr_read_b32 v226, a102
    v_accvgpr_read_b32 v227, a103
    v_mul_f32 v224, v224, v53
    v_mul_f32 v225, v225, v53
    v_mul_f32 v226, v226, v53
    v_mul_f32 v227, v227, v53
    v_accvgpr_write_b32 a100, v224
    v_accvgpr_write_b32 a101, v225
    v_accvgpr_write_b32 a102, v226
    v_accvgpr_write_b32 a103, v227
    v_accvgpr_read_b32 v224, a104
    v_accvgpr_read_b32 v225, a105
    v_accvgpr_read_b32 v226, a106
    v_accvgpr_read_b32 v227, a107
    v_mul_f32 v224, v224, v54
    v_mul_f32 v225, v225, v54
    v_mul_f32 v226, v226, v54
    v_mul_f32 v227, v227, v54
    v_accvgpr_write_b32 a104, v224
    v_accvgpr_write_b32 a105, v225
    v_accvgpr_write_b32 a106, v226
    v_accvgpr_write_b32 a107, v227
    v_accvgpr_read_b32 v224, a108
    v_accvgpr_read_b32 v225, a109
    v_accvgpr_read_b32 v226, a110
    v_accvgpr_read_b32 v227, a111
    v_mul_f32 v224, v224, v55
    v_mul_f32 v225, v225, v55
    v_mul_f32 v226, v226, v55
    v_mul_f32 v227, v227, v55
    v_accvgpr_write_b32 a108, v224
    v_accvgpr_write_b32 a109, v225
    v_accvgpr_write_b32 a110, v226
    v_accvgpr_write_b32 a111, v227
    v_accvgpr_read_b32 v224, a112
    v_accvgpr_read_b32 v225, a113
    v_accvgpr_read_b32 v226, a114
    v_accvgpr_read_b32 v227, a115
    v_mul_f32 v224, v224, v52
    v_mul_f32 v225, v225, v52
    v_mul_f32 v226, v226, v52
    v_mul_f32 v227, v227, v52
    v_accvgpr_write_b32 a112, v224
    v_accvgpr_write_b32 a113, v225
    v_accvgpr_write_b32 a114, v226
    v_accvgpr_write_b32 a115, v227
    v_accvgpr_read_b32 v224, a116
    v_accvgpr_read_b32 v225, a117
    v_accvgpr_read_b32 v226, a118
    v_accvgpr_read_b32 v227, a119
    v_mul_f32 v224, v224, v53
    v_mul_f32 v225, v225, v53
    v_mul_f32 v226, v226, v53
    v_mul_f32 v227, v227, v53
    v_accvgpr_write_b32 a116, v224
    v_accvgpr_write_b32 a117, v225
    v_accvgpr_write_b32 a118, v226
    v_accvgpr_write_b32 a119, v227
    v_accvgpr_read_b32 v224, a120
    v_accvgpr_read_b32 v225, a121
    v_accvgpr_read_b32 v226, a122
    v_accvgpr_read_b32 v227, a123
    v_mul_f32 v224, v224, v54
    v_mul_f32 v225, v225, v54
    v_mul_f32 v226, v226, v54
    v_mul_f32 v227, v227, v54
    v_accvgpr_write_b32 a120, v224
    v_accvgpr_write_b32 a121, v225
    v_accvgpr_write_b32 a122, v226
    v_accvgpr_write_b32 a123, v227
    v_accvgpr_read_b32 v224, a124
    v_accvgpr_read_b32 v225, a125
    v_accvgpr_read_b32 v226, a126
    v_accvgpr_read_b32 v227, a127
    v_mul_f32 v224, v224, v55
    v_mul_f32 v225, v225, v55
    v_mul_f32 v226, v226, v55
    v_mul_f32 v227, v227, v55
    v_accvgpr_write_b32 a124, v224
    v_accvgpr_write_b32 a125, v225
    v_accvgpr_write_b32 a126, v226
    v_accvgpr_write_b32 a127, v227
    v_exp_f32 v232, v128
    v_exp_f32 v233, v129
    v_exp_f32 v234, v130
    v_exp_f32 v235, v131
    s_nop 0
    v_cvt_pk_bf16_f32 v192, v232, v233
    v_cvt_pk_bf16_f32 v193, v234, v235
    v_exp_f32 v232, v144
    v_exp_f32 v233, v145
    v_exp_f32 v234, v146
    v_exp_f32 v235, v147
    s_nop 0
    v_cvt_pk_bf16_f32 v194, v232, v233
    v_cvt_pk_bf16_f32 v195, v234, v235
    v_exp_f32 v232, v132
    v_exp_f32 v233, v133
    v_exp_f32 v234, v134
    v_exp_f32 v235, v135
    s_nop 0
    v_cvt_pk_bf16_f32 v196, v232, v233
    v_cvt_pk_bf16_f32 v197, v234, v235
    v_exp_f32 v232, v148
    v_exp_f32 v233, v149
    v_exp_f32 v234, v150
    v_exp_f32 v235, v151
    s_nop 0
    v_cvt_pk_bf16_f32 v198, v232, v233
    v_cvt_pk_bf16_f32 v199, v234, v235
    v_exp_f32 v232, v136
    v_exp_f32 v233, v137
    v_exp_f32 v234, v138
    v_exp_f32 v235, v139
    s_nop 0
    v_cvt_pk_bf16_f32 v200, v232, v233
    v_cvt_pk_bf16_f32 v201, v234, v235
    v_exp_f32 v232, v152
    v_exp_f32 v233, v153
    v_exp_f32 v234, v154
    v_exp_f32 v235, v155
    s_nop 0
    v_cvt_pk_bf16_f32 v202, v232, v233
    v_cvt_pk_bf16_f32 v203, v234, v235
    v_exp_f32 v232, v140
    v_exp_f32 v233, v141
    v_exp_f32 v234, v142
    v_exp_f32 v235, v143
    s_nop 0
    v_cvt_pk_bf16_f32 v204, v232, v233
    v_cvt_pk_bf16_f32 v205, v234, v235
    v_exp_f32 v232, v156
    v_exp_f32 v233, v157
    v_exp_f32 v234, v158
    v_exp_f32 v235, v159
    s_nop 0
    v_cvt_pk_bf16_f32 v206, v232, v233
    v_cvt_pk_bf16_f32 v207, v234, v235
    s_nop 3
    s_setpc_b64 s[40:41]
k2_rare_159:
    s_nop 7
    v_max_f32 v52, v160, v161
    v_max3_f32 v52, v52, v162, v163
    v_max3_f32 v52, v52, v176, v177
    v_max3_f32 v52, v52, v178, v179
    v_max_f32 v53, v164, v165
    v_max3_f32 v53, v53, v166, v167
    v_max3_f32 v53, v53, v180, v181
    v_max3_f32 v53, v53, v182, v183
    v_max_f32 v54, v168, v169
    v_max3_f32 v54, v54, v170, v171
    v_max3_f32 v54, v54, v184, v185
    v_max3_f32 v54, v54, v186, v187
    v_max_f32 v55, v172, v173
    v_max3_f32 v55, v55, v174, v175
    v_max3_f32 v55, v55, v188, v189
    v_max3_f32 v55, v55, v190, v191
    v_mov_b32 v224, v52
    v_mov_b32 v225, v53
    v_mov_b32 v226, v54
    v_mov_b32 v227, v55
    s_nop 1
    v_permlane16_swap_b32 v52, v224
    v_permlane16_swap_b32 v53, v225
    v_permlane16_swap_b32 v54, v226
    v_permlane16_swap_b32 v55, v227
    s_nop 1
    v_max_f32 v52, v52, v224
    v_max_f32 v53, v53, v225
    v_max_f32 v54, v54, v226
    v_max_f32 v55, v55, v227
    v_mov_b32 v224, v52
    v_mov_b32 v225, v53
    v_mov_b32 v226, v54
    v_mov_b32 v227, v55
    s_nop 1
    v_permlane32_swap_b32 v52, v224
    v_permlane32_swap_b32 v53, v225
    v_permlane32_swap_b32 v54, v226
    v_permlane32_swap_b32 v55, v227
    s_nop 1
    v_max_f32 v52, v52, v224
    v_max_f32 v53, v53, v225
    v_max_f32 v54, v54, v226
    v_max_f32 v55, v55, v227
    v_add_f32 v52, 0x41400000, v52
    v_max_f32 v52, 0, v52
    v_add_f32 v53, 0x41400000, v53
    v_max_f32 v53, 0, v53
    v_add_f32 v54, 0x41400000, v54
    v_max_f32 v54, 0, v54
    v_add_f32 v55, 0x41400000, v55
    v_max_f32 v55, 0, v55
    v_sub_f32 v160, v160, v52
    v_sub_f32 v161, v161, v52
    v_sub_f32 v162, v162, v52
    v_sub_f32 v163, v163, v52
    v_sub_f32 v164, v164, v53
    v_sub_f32 v165, v165, v53
    v_sub_f32 v166, v166, v53
    v_sub_f32 v167, v167, v53
    v_sub_f32 v168, v168, v54
    v_sub_f32 v169, v169, v54
    v_sub_f32 v170, v170, v54
    v_sub_f32 v171, v171, v54
    v_sub_f32 v172, v172, v55
    v_sub_f32 v173, v173, v55
    v_sub_f32 v174, v174, v55
    v_sub_f32 v175, v175, v55
    v_sub_f32 v176, v176, v52
    v_sub_f32 v177, v177, v52
    v_sub_f32 v178, v178, v52
    v_sub_f32 v179, v179, v52
    v_sub_f32 v180, v180, v53
    v_sub_f32 v181, v181, v53
    v_sub_f32 v182, v182, v53
    v_sub_f32 v183, v183, v53
    v_sub_f32 v184, v184, v54
    v_sub_f32 v185, v185, v54
    v_sub_f32 v186, v186, v54
    v_sub_f32 v187, v187, v54
    v_sub_f32 v188, v188, v55
    v_sub_f32 v189, v189, v55
    v_sub_f32 v190, v190, v55
    v_sub_f32 v191, v191, v55
    v_sub_f32 v128, v128, v52
    v_sub_f32 v16, v16, v52
    v_sub_f32 v129, v129, v52
    v_sub_f32 v17, v17, v52
    v_sub_f32 v130, v130, v52
    v_sub_f32 v18, v18, v52
    v_sub_f32 v131, v131, v52
    v_sub_f32 v19, v19, v52
    v_sub_f32 v132, v132, v53
    v_sub_f32 v20, v20, v53
    v_sub_f32 v133, v133, v53
    v_sub_f32 v21, v21, v53
    v_sub_f32 v134, v134, v53
    v_sub_f32 v22, v22, v53
    v_sub_f32 v135, v135, v53
    v_sub_f32 v23, v23, v53
    v_sub_f32 v136, v136, v54
    v_sub_f32 v24, v24, v54
    v_sub_f32 v137, v137, v54
    v_sub_f32 v25, v25, v54
    v_sub_f32 v138, v138, v54
    v_sub_f32 v26, v26, v54
    v_sub_f32 v139, v139, v54
    v_sub_f32 v27, v27, v54
    v_sub_f32 v140, v140, v55
    v_sub_f32 v28, v28, v55
    v_sub_f32 v141, v141, v55
    v_sub_f32 v29, v29, v55
    v_sub_f32 v142, v142, v55
    v_sub_f32 v30, v30, v55
    v_sub_f32 v143, v143, v55
    v_sub_f32 v31, v31, v55
    v_sub_f32 v144, v144, v52
    v_sub_f32 v32, v32, v52
    v_sub_f32 v145, v145, v52
    v_sub_f32 v33, v33, v52
    v_sub_f32 v146, v146, v52
    v_sub_f32 v34, v34, v52
    v_sub_f32 v147, v147, v52
    v_sub_f32 v35, v35, v52
    v_sub_f32 v148, v148, v53
    v_sub_f32 v36, v36, v53
    v_sub_f32 v149, v149, v53
    v_sub_f32 v37, v37, v53
    v_sub_f32 v150, v150, v53
    v_sub_f32 v38, v38, v53
    v_sub_f32 v151, v151, v53
    v_sub_f32 v39, v39, v53
    v_sub_f32 v152, v152, v54
    v_sub_f32 v40, v40, v54
    v_sub_f32 v153, v153, v54
    v_sub_f32 v41, v41, v54
    v_sub_f32 v154, v154, v54
    v_sub_f32 v42, v42, v54
    v_sub_f32 v155, v155, v54
    v_sub_f32 v43, v43, v54
    v_sub_f32 v156, v156, v55
    v_sub_f32 v44, v44, v55
    v_sub_f32 v157, v157, v55
    v_sub_f32 v45, v45, v55
    v_sub_f32 v158, v158, v55
    v_sub_f32 v46, v46, v55
    v_sub_f32 v159, v159, v55
    v_sub_f32 v47, v47, v55
    v_sub_f32 v8, v8, v52
    v_exp_f32 v52, -v52
    v_sub_f32 v9, v9, v53
    v_exp_f32 v53, -v53
    v_sub_f32 v10, v10, v54
    v_exp_f32 v54, -v54
    v_sub_f32 v11, v11, v55
    v_exp_f32 v55, -v55
    s_nop 0
    v_mul_f32 v12, v12, v52
    v_mul_f32 v48, v48, v53
    v_mul_f32 v248, v248, v54
    v_mul_f32 v252, v252, v55
    v_accvgpr_read_b32 v224, a0
    v_accvgpr_read_b32 v225, a1
    v_accvgpr_read_b32 v226, a2
    v_accvgpr_read_b32 v227, a3
    v_mul_f32 v224, v224, v52
    v_mul_f32 v225, v225, v52
    v_mul_f32 v226, v226, v52
    v_mul_f32 v227, v227, v52
    v_accvgpr_write_b32 a0, v224
    v_accvgpr_write_b32 a1, v225
    v_accvgpr_write_b32 a2, v226
    v_accvgpr_write_b32 a3, v227
    v_accvgpr_read_b32 v224, a4
    v_accvgpr_read_b32 v225, a5
    v_accvgpr_read_b32 v226, a6
    v_accvgpr_read_b32 v227, a7
    v_mul_f32 v224, v224, v53
    v_mul_f32 v225, v225, v53
    v_mul_f32 v226, v226, v53
    v_mul_f32 v227, v227, v53
    v_accvgpr_write_b32 a4, v224
    v_accvgpr_write_b32 a5, v225
    v_accvgpr_write_b32 a6, v226
    v_accvgpr_write_b32 a7, v227
    v_accvgpr_read_b32 v224, a8
    v_accvgpr_read_b32 v225, a9
    v_accvgpr_read_b32 v226, a10
    v_accvgpr_read_b32 v227, a11
    v_mul_f32 v224, v224, v54
    v_mul_f32 v225, v225, v54
    v_mul_f32 v226, v226, v54
    v_mul_f32 v227, v227, v54
    v_accvgpr_write_b32 a8, v224
    v_accvgpr_write_b32 a9, v225
    v_accvgpr_write_b32 a10, v226
    v_accvgpr_write_b32 a11, v227
    v_accvgpr_read_b32 v224, a12
    v_accvgpr_read_b32 v225, a13
    v_accvgpr_read_b32 v226, a14
    v_accvgpr_read_b32 v227, a15
    v_mul_f32 v224, v224, v55
    v_mul_f32 v225, v225, v55
    v_mul_f32 v226, v226, v55
    v_mul_f32 v227, v227, v55
    v_accvgpr_write_b32 a12, v224
    v_accvgpr_write_b32 a13, v225
    v_accvgpr_write_b32 a14, v226
    v_accvgpr_write_b32 a15, v227
    v_accvgpr_read_b32 v224, a16
    v_accvgpr_read_b32 v225, a17
    v_accvgpr_read_b32 v226, a18
    v_accvgpr_read_b32 v227, a19
    v_mul_f32 v224, v224, v52
    v_mul_f32 v225, v225, v52
    v_mul_f32 v226, v226, v52
    v_mul_f32 v227, v227, v52
    v_accvgpr_write_b32 a16, v224
    v_accvgpr_write_b32 a17, v225
    v_accvgpr_write_b32 a18, v226
    v_accvgpr_write_b32 a19, v227
    v_accvgpr_read_b32 v224, a20
    v_accvgpr_read_b32 v225, a21
    v_accvgpr_read_b32 v226, a22
    v_accvgpr_read_b32 v227, a23
    v_mul_f32 v224, v224, v53
    v_mul_f32 v225, v225, v53
    v_mul_f32 v226, v226, v53
    v_mul_f32 v227, v227, v53
    v_accvgpr_write_b32 a20, v224
    v_accvgpr_write_b32 a21, v225
    v_accvgpr_write_b32 a22, v226
    v_accvgpr_write_b32 a23, v227
    v_accvgpr_read_b32 v224, a24
    v_accvgpr_read_b32 v225, a25
    v_accvgpr_read_b32 v226, a26
    v_accvgpr_read_b32 v227, a27
    v_mul_f32 v224, v224, v54
    v_mul_f32 v225, v225, v54
    v_mul_f32 v226, v226, v54
    v_mul_f32 v227, v227, v54
    v_accvgpr_write_b32 a24, v224
    v_accvgpr_write_b32 a25, v225
    v_accvgpr_write_b32 a26, v226
    v_accvgpr_write_b32 a27, v227
    v_accvgpr_read_b32 v224, a28
    v_accvgpr_read_b32 v225, a29
    v_accvgpr_read_b32 v226, a30
    v_accvgpr_read_b32 v227, a31
    v_mul_f32 v224, v224, v55
    v_mul_f32 v225, v225, v55
    v_mul_f32 v226, v226, v55
    v_mul_f32 v227, v227, v55
    v_accvgpr_write_b32 a28, v224
    v_accvgpr_write_b32 a29, v225
    v_accvgpr_write_b32 a30, v226
    v_accvgpr_write_b32 a31, v227
    v_accvgpr_read_b32 v224, a32
    v_accvgpr_read_b32 v225, a33
    v_accvgpr_read_b32 v226, a34
    v_accvgpr_read_b32 v227, a35
    v_mul_f32 v224, v224, v52
    v_mul_f32 v225, v225, v52
    v_mul_f32 v226, v226, v52
    v_mul_f32 v227, v227, v52
    v_accvgpr_write_b32 a32, v224
    v_accvgpr_write_b32 a33, v225
    v_accvgpr_write_b32 a34, v226
    v_accvgpr_write_b32 a35, v227
    v_accvgpr_read_b32 v224, a36
    v_accvgpr_read_b32 v225, a37
    v_accvgpr_read_b32 v226, a38
    v_accvgpr_read_b32 v227, a39
    v_mul_f32 v224, v224, v53
    v_mul_f32 v225, v225, v53
    v_mul_f32 v226, v226, v53
    v_mul_f32 v227, v227, v53
    v_accvgpr_write_b32 a36, v224
    v_accvgpr_write_b32 a37, v225
    v_accvgpr_write_b32 a38, v226
    v_accvgpr_write_b32 a39, v227
    v_accvgpr_read_b32 v224, a40
    v_accvgpr_read_b32 v225, a41
    v_accvgpr_read_b32 v226, a42
    v_accvgpr_read_b32 v227, a43
    v_mul_f32 v224, v224, v54
    v_mul_f32 v225, v225, v54
    v_mul_f32 v226, v226, v54
    v_mul_f32 v227, v227, v54
    v_accvgpr_write_b32 a40, v224
    v_accvgpr_write_b32 a41, v225
    v_accvgpr_write_b32 a42, v226
    v_accvgpr_write_b32 a43, v227
    v_accvgpr_read_b32 v224, a44
    v_accvgpr_read_b32 v225, a45
    v_accvgpr_read_b32 v226, a46
    v_accvgpr_read_b32 v227, a47
    v_mul_f32 v224, v224, v55
    v_mul_f32 v225, v225, v55
    v_mul_f32 v226, v226, v55
    v_mul_f32 v227, v227, v55
    v_accvgpr_write_b32 a44, v224
    v_accvgpr_write_b32 a45, v225
    v_accvgpr_write_b32 a46, v226
    v_accvgpr_write_b32 a47, v227
    v_accvgpr_read_b32 v224, a48
    v_accvgpr_read_b32 v225, a49
    v_accvgpr_read_b32 v226, a50
    v_accvgpr_read_b32 v227, a51
    v_mul_f32 v224, v224, v52
    v_mul_f32 v225, v225, v52
    v_mul_f32 v226, v226, v52
    v_mul_f32 v227, v227, v52
    v_accvgpr_write_b32 a48, v224
    v_accvgpr_write_b32 a49, v225
    v_accvgpr_write_b32 a50, v226
    v_accvgpr_write_b32 a51, v227
    v_accvgpr_read_b32 v224, a52
    v_accvgpr_read_b32 v225, a53
    v_accvgpr_read_b32 v226, a54
    v_accvgpr_read_b32 v227, a55
    v_mul_f32 v224, v224, v53
    v_mul_f32 v225, v225, v53
    v_mul_f32 v226, v226, v53
    v_mul_f32 v227, v227, v53
    v_accvgpr_write_b32 a52, v224
    v_accvgpr_write_b32 a53, v225
    v_accvgpr_write_b32 a54, v226
    v_accvgpr_write_b32 a55, v227
    v_accvgpr_read_b32 v224, a56
    v_accvgpr_read_b32 v225, a57
    v_accvgpr_read_b32 v226, a58
    v_accvgpr_read_b32 v227, a59
    v_mul_f32 v224, v224, v54
    v_mul_f32 v225, v225, v54
    v_mul_f32 v226, v226, v54
    v_mul_f32 v227, v227, v54
    v_accvgpr_write_b32 a56, v224
    v_accvgpr_write_b32 a57, v225
    v_accvgpr_write_b32 a58, v226
    v_accvgpr_write_b32 a59, v227
    v_accvgpr_read_b32 v224, a60
    v_accvgpr_read_b32 v225, a61
    v_accvgpr_read_b32 v226, a62
    v_accvgpr_read_b32 v227, a63
    v_mul_f32 v224, v224, v55
    v_mul_f32 v225, v225, v55
    v_mul_f32 v226, v226, v55
    v_mul_f32 v227, v227, v55
    v_accvgpr_write_b32 a60, v224
    v_accvgpr_write_b32 a61, v225
    v_accvgpr_write_b32 a62, v226
    v_accvgpr_write_b32 a63, v227
    v_accvgpr_read_b32 v224, a64
    v_accvgpr_read_b32 v225, a65
    v_accvgpr_read_b32 v226, a66
    v_accvgpr_read_b32 v227, a67
    v_mul_f32 v224, v224, v52
    v_mul_f32 v225, v225, v52
    v_mul_f32 v226, v226, v52
    v_mul_f32 v227, v227, v52
    v_accvgpr_write_b32 a64, v224
    v_accvgpr_write_b32 a65, v225
    v_accvgpr_write_b32 a66, v226
    v_accvgpr_write_b32 a67, v227
    v_accvgpr_read_b32 v224, a68
    v_accvgpr_read_b32 v225, a69
    v_accvgpr_read_b32 v226, a70
    v_accvgpr_read_b32 v227, a71
    v_mul_f32 v224, v224, v53
    v_mul_f32 v225, v225, v53
    v_mul_f32 v226, v226, v53
    v_mul_f32 v227, v227, v53
    v_accvgpr_write_b32 a68, v224
    v_accvgpr_write_b32 a69, v225
    v_accvgpr_write_b32 a70, v226
    v_accvgpr_write_b32 a71, v227
    v_accvgpr_read_b32 v224, a72
    v_accvgpr_read_b32 v225, a73
    v_accvgpr_read_b32 v226, a74
    v_accvgpr_read_b32 v227, a75
    v_mul_f32 v224, v224, v54
    v_mul_f32 v225, v225, v54
    v_mul_f32 v226, v226, v54
    v_mul_f32 v227, v227, v54
    v_accvgpr_write_b32 a72, v224
    v_accvgpr_write_b32 a73, v225
    v_accvgpr_write_b32 a74, v226
    v_accvgpr_write_b32 a75, v227
    v_accvgpr_read_b32 v224, a76
    v_accvgpr_read_b32 v225, a77
    v_accvgpr_read_b32 v226, a78
    v_accvgpr_read_b32 v227, a79
    v_mul_f32 v224, v224, v55
    v_mul_f32 v225, v225, v55
    v_mul_f32 v226, v226, v55
    v_mul_f32 v227, v227, v55
    v_accvgpr_write_b32 a76, v224
    v_accvgpr_write_b32 a77, v225
    v_accvgpr_write_b32 a78, v226
    v_accvgpr_write_b32 a79, v227
    v_accvgpr_read_b32 v224, a80
    v_accvgpr_read_b32 v225, a81
    v_accvgpr_read_b32 v226, a82
    v_accvgpr_read_b32 v227, a83
    v_mul_f32 v224, v224, v52
    v_mul_f32 v225, v225, v52
    v_mul_f32 v226, v226, v52
    v_mul_f32 v227, v227, v52
    v_accvgpr_write_b32 a80, v224
    v_accvgpr_write_b32 a81, v225
    v_accvgpr_write_b32 a82, v226
    v_accvgpr_write_b32 a83, v227
    v_accvgpr_read_b32 v224, a84
    v_accvgpr_read_b32 v225, a85
    v_accvgpr_read_b32 v226, a86
    v_accvgpr_read_b32 v227, a87
    v_mul_f32 v224, v224, v53
    v_mul_f32 v225, v225, v53
    v_mul_f32 v226, v226, v53
    v_mul_f32 v227, v227, v53
    v_accvgpr_write_b32 a84, v224
    v_accvgpr_write_b32 a85, v225
    v_accvgpr_write_b32 a86, v226
    v_accvgpr_write_b32 a87, v227
    v_accvgpr_read_b32 v224, a88
    v_accvgpr_read_b32 v225, a89
    v_accvgpr_read_b32 v226, a90
    v_accvgpr_read_b32 v227, a91
    v_mul_f32 v224, v224, v54
    v_mul_f32 v225, v225, v54
    v_mul_f32 v226, v226, v54
    v_mul_f32 v227, v227, v54
    v_accvgpr_write_b32 a88, v224
    v_accvgpr_write_b32 a89, v225
    v_accvgpr_write_b32 a90, v226
    v_accvgpr_write_b32 a91, v227
    v_accvgpr_read_b32 v224, a92
    v_accvgpr_read_b32 v225, a93
    v_accvgpr_read_b32 v226, a94
    v_accvgpr_read_b32 v227, a95
    v_mul_f32 v224, v224, v55
    v_mul_f32 v225, v225, v55
    v_mul_f32 v226, v226, v55
    v_mul_f32 v227, v227, v55
    v_accvgpr_write_b32 a92, v224
    v_accvgpr_write_b32 a93, v225
    v_accvgpr_write_b32 a94, v226
    v_accvgpr_write_b32 a95, v227
    v_accvgpr_read_b32 v224, a96
    v_accvgpr_read_b32 v225, a97
    v_accvgpr_read_b32 v226, a98
    v_accvgpr_read_b32 v227, a99
    v_mul_f32 v224, v224, v52
    v_mul_f32 v225, v225, v52
    v_mul_f32 v226, v226, v52
    v_mul_f32 v227, v227, v52
    v_accvgpr_write_b32 a96, v224
    v_accvgpr_write_b32 a97, v225
    v_accvgpr_write_b32 a98, v226
    v_accvgpr_write_b32 a99, v227
    v_accvgpr_read_b32 v224, a100
    v_accvgpr_read_b32 v225, a101
    v_accvgpr_read_b32 v226, a102
    v_accvgpr_read_b32 v227, a103
    v_mul_f32 v224, v224, v53
    v_mul_f32 v225, v225, v53
    v_mul_f32 v226, v226, v53
    v_mul_f32 v227, v227, v53
    v_accvgpr_write_b32 a100, v224
    v_accvgpr_write_b32 a101, v225
    v_accvgpr_write_b32 a102, v226
    v_accvgpr_write_b32 a103, v227
    v_accvgpr_read_b32 v224, a104
    v_accvgpr_read_b32 v225, a105
    v_accvgpr_read_b32 v226, a106
    v_accvgpr_read_b32 v227, a107
    v_mul_f32 v224, v224, v54
    v_mul_f32 v225, v225, v54
    v_mul_f32 v226, v226, v54
    v_mul_f32 v227, v227, v54
    v_accvgpr_write_b32 a104, v224
    v_accvgpr_write_b32 a105, v225
    v_accvgpr_write_b32 a106, v226
    v_accvgpr_write_b32 a107, v227
    v_accvgpr_read_b32 v224, a108
    v_accvgpr_read_b32 v225, a109
    v_accvgpr_read_b32 v226, a110
    v_accvgpr_read_b32 v227, a111
    v_mul_f32 v224, v224, v55
    v_mul_f32 v225, v225, v55
    v_mul_f32 v226, v226, v55
    v_mul_f32 v227, v227, v55
    v_accvgpr_write_b32 a108, v224
    v_accvgpr_write_b32 a109, v225
    v_accvgpr_write_b32 a110, v226
    v_accvgpr_write_b32 a111, v227
    v_accvgpr_read_b32 v224, a112
    v_accvgpr_read_b32 v225, a113
    v_accvgpr_read_b32 v226, a114
    v_accvgpr_read_b32 v227, a115
    v_mul_f32 v224, v224, v52
    v_mul_f32 v225, v225, v52
    v_mul_f32 v226, v226, v52
    v_mul_f32 v227, v227, v52
    v_accvgpr_write_b32 a112, v224
    v_accvgpr_write_b32 a113, v225
    v_accvgpr_write_b32 a114, v226
    v_accvgpr_write_b32 a115, v227
    v_accvgpr_read_b32 v224, a116
    v_accvgpr_read_b32 v225, a117
    v_accvgpr_read_b32 v226, a118
    v_accvgpr_read_b32 v227, a119
    v_mul_f32 v224, v224, v53
    v_mul_f32 v225, v225, v53
    v_mul_f32 v226, v226, v53
    v_mul_f32 v227, v227, v53
    v_accvgpr_write_b32 a116, v224
    v_accvgpr_write_b32 a117, v225
    v_accvgpr_write_b32 a118, v226
    v_accvgpr_write_b32 a119, v227
    v_accvgpr_read_b32 v224, a120
    v_accvgpr_read_b32 v225, a121
    v_accvgpr_read_b32 v226, a122
    v_accvgpr_read_b32 v227, a123
    v_mul_f32 v224, v224, v54
    v_mul_f32 v225, v225, v54
    v_mul_f32 v226, v226, v54
    v_mul_f32 v227, v227, v54
    v_accvgpr_write_b32 a120, v224
    v_accvgpr_write_b32 a121, v225
    v_accvgpr_write_b32 a122, v226
    v_accvgpr_write_b32 a123, v227
    v_accvgpr_read_b32 v224, a124
    v_accvgpr_read_b32 v225, a125
    v_accvgpr_read_b32 v226, a126
    v_accvgpr_read_b32 v227, a127
    v_mul_f32 v224, v224, v55
    v_mul_f32 v225, v225, v55
    v_mul_f32 v226, v226, v55
    v_mul_f32 v227, v227, v55
    v_accvgpr_write_b32 a124, v224
    v_accvgpr_write_b32 a125, v225
    v_accvgpr_write_b32 a126, v226
    v_accvgpr_write_b32 a127, v227
    v_exp_f32 v232, v160
    v_exp_f32 v233, v161
    v_exp_f32 v234, v162
    v_exp_f32 v235, v163
    s_nop 0
    v_cvt_pk_bf16_f32 v208, v232, v233
    v_cvt_pk_bf16_f32 v209, v234, v235
    v_exp_f32 v232, v176
    v_exp_f32 v233, v177
    v_exp_f32 v234, v178
    v_exp_f32 v235, v179
    s_nop 0
    v_cvt_pk_bf16_f32 v210, v232, v233
    v_cvt_pk_bf16_f32 v211, v234, v235
    v_exp_f32 v232, v164
    v_exp_f32 v233, v165
    v_exp_f32 v234, v166
    v_exp_f32 v235, v167
    s_nop 0
    v_cvt_pk_bf16_f32 v212, v232, v233
    v_cvt_pk_bf16_f32 v213, v234, v235
    v_exp_f32 v232, v180
    v_exp_f32 v233, v181
    v_exp_f32 v234, v182
    v_exp_f32 v235, v183
    s_nop 0
    v_cvt_pk_bf16_f32 v214, v232, v233
    v_cvt_pk_bf16_f32 v215, v234, v235
    v_exp_f32 v232, v168
    v_exp_f32 v233, v169
    v_exp_f32 v234, v170
    v_exp_f32 v235, v171
    s_nop 0
    v_cvt_pk_bf16_f32 v216, v232, v233
    v_cvt_pk_bf16_f32 v217, v234, v235
    v_exp_f32 v232, v184
    v_exp_f32 v233, v185
    v_exp_f32 v234, v186
    v_exp_f32 v235, v187
    s_nop 0
    v_cvt_pk_bf16_f32 v218, v232, v233
    v_cvt_pk_bf16_f32 v219, v234, v235
    v_exp_f32 v232, v172
    v_exp_f32 v233, v173
    v_exp_f32 v234, v174
    v_exp_f32 v235, v175
    s_nop 0
    v_cvt_pk_bf16_f32 v220, v232, v233
    v_cvt_pk_bf16_f32 v221, v234, v235
    v_exp_f32 v232, v188
    v_exp_f32 v233, v189
    v_exp_f32 v234, v190
    v_exp_f32 v235, v191
    s_nop 0
    v_cvt_pk_bf16_f32 v222, v232, v233
    v_cvt_pk_bf16_f32 v223, v234, v235
    s_nop 3
    s_setpc_b64 s[40:41]
k2_rare_164:
    s_nop 7
    v_max_f32 v53, v132, v133
    v_max3_f32 v53, v53, v134, v135
    v_max3_f32 v53, v53, v148, v149
    v_max3_f32 v53, v53, v150, v151
    v_max_f32 v54, v136, v137
    v_max3_f32 v54, v54, v138, v139
    v_max3_f32 v54, v54, v152, v153
    v_max3_f32 v54, v54, v154, v155
    v_max_f32 v55, v140, v141
    v_max3_f32 v55, v55, v142, v143
    v_max3_f32 v55, v55, v156, v157
    v_max3_f32 v55, v55, v158, v159
    v_mov_b32 v225, v53
    v_mov_b32 v226, v54
    v_mov_b32 v227, v55
    s_nop 1
    v_permlane16_swap_b32 v53, v225
    v_permlane16_swap_b32 v54, v226
    v_permlane16_swap_b32 v55, v227
    s_nop 1
    v_max_f32 v53, v53, v225
    v_max_f32 v54, v54, v226
    v_max_f32 v55, v55, v227
    v_mov_b32 v225, v53
    v_mov_b32 v226, v54
    v_mov_b32 v227, v55
    s_nop 1
    v_permlane32_swap_b32 v53, v225
    v_permlane32_swap_b32 v54, v226
    v_permlane32_swap_b32 v55, v227
    s_nop 1
    v_max_f32 v53, v53, v225
    v_max_f32 v54, v54, v226
    v_max_f32 v55, v55, v227
    v_add_f32 v53, 0x41400000, v53
    v_max_f32 v53, 0, v53
    v_add_f32 v54, 0x41400000, v54
    v_max_f32 v54, 0, v54
    v_add_f32 v55, 0x41400000, v55
    v_max_f32 v55, 0, v55
    v_sub_f32 v132, v132, v53
    v_sub_f32 v133, v133, v53
    v_sub_f32 v134, v134, v53
    v_sub_f32 v135, v135, v53
    v_sub_f32 v136, v136, v54
    v_sub_f32 v137, v137, v54
    v_sub_f32 v138, v138, v54
    v_sub_f32 v139, v139, v54
    v_sub_f32 v140, v140, v55
    v_sub_f32 v141, v141, v55
    v_sub_f32 v142, v142, v55
    v_sub_f32 v143, v143, v55
    v_sub_f32 v148, v148, v53
    v_sub_f32 v149, v149, v53
    v_sub_f32 v150, v150, v53
    v_sub_f32 v151, v151, v53
    v_sub_f32 v152, v152, v54
    v_sub_f32 v153, v153, v54
    v_sub_f32 v154, v154, v54
    v_sub_f32 v155, v155, v54
    v_sub_f32 v156, v156, v55
    v_sub_f32 v157, v157, v55
    v_sub_f32 v158, v158, v55
    v_sub_f32 v159, v159, v55
    v_sub_f32 v164, v164, v53
    v_sub_f32 v20, v20, v53
    v_sub_f32 v165, v165, v53
    v_sub_f32 v21, v21, v53
    v_sub_f32 v166, v166, v53
    v_sub_f32 v22, v22, v53
    v_sub_f32 v167, v167, v53
    v_sub_f32 v23, v23, v53
    v_sub_f32 v168, v168, v54
    v_sub_f32 v24, v24, v54
    v_sub_f32 v169, v169, v54
    v_sub_f32 v25, v25, v54
    v_sub_f32 v170, v170, v54
    v_sub_f32 v26, v26, v54
    v_sub_f32 v171, v171, v54
    v_sub_f32 v27, v27, v54
    v_sub_f32 v172, v172, v55
    v_sub_f32 v28, v28, v55
    v_sub_f32 v173, v173, v55
    v_sub_f32 v29, v29, v55
    v_sub_f32 v174, v174, v55
    v_sub_f32 v30, v30, v55
    v_sub_f32 v175, v175, v55
    v_sub_f32 v31, v31, v55
    v_sub_f32 v180, v180, v53
    v_sub_f32 v36, v36, v53
    v_sub_f32 v181, v181, v53
    v_sub_f32 v37, v37, v53
    v_sub_f32 v182, v182, v53
    v_sub_f32 v38, v38, v53
    v_sub_f32 v183, v183, v53
    v_sub_f32 v39, v39, v53
    v_sub_f32 v184, v184, v54
    v_sub_f32 v40, v40, v54
    v_sub_f32 v185, v185, v54
    v_sub_f32 v41, v41, v54
    v_sub_f32 v186, v186, v54
    v_sub_f32 v42, v42, v54
    v_sub_f32 v187, v187, v54
    v_sub_f32 v43, v43, v54
    v_sub_f32 v188, v188, v55
    v_sub_f32 v44, v44, v55
    v_sub_f32 v189, v189, v55
    v_sub_f32 v45, v45, v55
    v_sub_f32 v190, v190, v55
    v_sub_f32 v46, v46, v55
    v_sub_f32 v191, v191, v55
    v_sub_f32 v47, v47, v55
    v_sub_f32 v9, v9, v53
    v_exp_f32 v53, -v53
    v_sub_f32 v10, v10, v54
    v_exp_f32 v54, -v54
    v_sub_f32 v11, v11, v55
    v_exp_f32 v55, -v55
    s_nop 0
    v_mul_f32 v48, v48, v53
    v_mul_f32 v248, v248, v54
    v_mul_f32 v252, v252, v55
    v_accvgpr_read_b32 v224, a4
    v_accvgpr_read_b32 v225, a5
    v_accvgpr_read_b32 v226, a6
    v_accvgpr_read_b32 v227, a7
    v_mul_f32 v224, v224, v53
    v_mul_f32 v225, v225, v53
    v_mul_f32 v226, v226, v53
    v_mul_f32 v227, v227, v53
    v_accvgpr_write_b32 a4, v224
    v_accvgpr_write_b32 a5, v225
    v_accvgpr_write_b32 a6, v226
    v_accvgpr_write_b32 a7, v227
    v_accvgpr_read_b32 v224, a8
    v_accvgpr_read_b32 v225, a9
    v_accvgpr_read_b32 v226, a10
    v_accvgpr_read_b32 v227, a11
    v_mul_f32 v224, v224, v54
    v_mul_f32 v225, v225, v54
    v_mul_f32 v226, v226, v54
    v_mul_f32 v227, v227, v54
    v_accvgpr_write_b32 a8, v224
    v_accvgpr_write_b32 a9, v225
    v_accvgpr_write_b32 a10, v226
    v_accvgpr_write_b32 a11, v227
    v_accvgpr_read_b32 v224, a12
    v_accvgpr_read_b32 v225, a13
    v_accvgpr_read_b32 v226, a14
    v_accvgpr_read_b32 v227, a15
    v_mul_f32 v224, v224, v55
    v_mul_f32 v225, v225, v55
    v_mul_f32 v226, v226, v55
    v_mul_f32 v227, v227, v55
    v_accvgpr_write_b32 a12, v224
    v_accvgpr_write_b32 a13, v225
    v_accvgpr_write_b32 a14, v226
    v_accvgpr_write_b32 a15, v227
    v_accvgpr_read_b32 v224, a20
    v_accvgpr_read_b32 v225, a21
    v_accvgpr_read_b32 v226, a22
    v_accvgpr_read_b32 v227, a23
    v_mul_f32 v224, v224, v53
    v_mul_f32 v225, v225, v53
    v_mul_f32 v226, v226, v53
    v_mul_f32 v227, v227, v53
    v_accvgpr_write_b32 a20, v224
    v_accvgpr_write_b32 a21, v225
    v_accvgpr_write_b32 a22, v226
    v_accvgpr_write_b32 a23, v227
    v_accvgpr_read_b32 v224, a24
    v_accvgpr_read_b32 v225, a25
    v_accvgpr_read_b32 v226, a26
    v_accvgpr_read_b32 v227, a27
    v_mul_f32 v224, v224, v54
    v_mul_f32 v225, v225, v54
    v_mul_f32 v226, v226, v54
    v_mul_f32 v227, v227, v54
    v_accvgpr_write_b32 a24, v224
    v_accvgpr_write_b32 a25, v225
    v_accvgpr_write_b32 a26, v226
    v_accvgpr_write_b32 a27, v227
    v_accvgpr_read_b32 v224, a28
    v_accvgpr_read_b32 v225, a29
    v_accvgpr_read_b32 v226, a30
    v_accvgpr_read_b32 v227, a31
    v_mul_f32 v224, v224, v55
    v_mul_f32 v225, v225, v55
    v_mul_f32 v226, v226, v55
    v_mul_f32 v227, v227, v55
    v_accvgpr_write_b32 a28, v224
    v_accvgpr_write_b32 a29, v225
    v_accvgpr_write_b32 a30, v226
    v_accvgpr_write_b32 a31, v227
    v_accvgpr_read_b32 v224, a36
    v_accvgpr_read_b32 v225, a37
    v_accvgpr_read_b32 v226, a38
    v_accvgpr_read_b32 v227, a39
    v_mul_f32 v224, v224, v53
    v_mul_f32 v225, v225, v53
    v_mul_f32 v226, v226, v53
    v_mul_f32 v227, v227, v53
    v_accvgpr_write_b32 a36, v224
    v_accvgpr_write_b32 a37, v225
    v_accvgpr_write_b32 a38, v226
    v_accvgpr_write_b32 a39, v227
    v_accvgpr_read_b32 v224, a40
    v_accvgpr_read_b32 v225, a41
    v_accvgpr_read_b32 v226, a42
    v_accvgpr_read_b32 v227, a43
    v_mul_f32 v224, v224, v54
    v_mul_f32 v225, v225, v54
    v_mul_f32 v226, v226, v54
    v_mul_f32 v227, v227, v54
    v_accvgpr_write_b32 a40, v224
    v_accvgpr_write_b32 a41, v225
    v_accvgpr_write_b32 a42, v226
    v_accvgpr_write_b32 a43, v227
    v_accvgpr_read_b32 v224, a44
    v_accvgpr_read_b32 v225, a45
    v_accvgpr_read_b32 v226, a46
    v_accvgpr_read_b32 v227, a47
    v_mul_f32 v224, v224, v55
    v_mul_f32 v225, v225, v55
    v_mul_f32 v226, v226, v55
    v_mul_f32 v227, v227, v55
    v_accvgpr_write_b32 a44, v224
    v_accvgpr_write_b32 a45, v225
    v_accvgpr_write_b32 a46, v226
    v_accvgpr_write_b32 a47, v227
    v_accvgpr_read_b32 v224, a52
    v_accvgpr_read_b32 v225, a53
    v_accvgpr_read_b32 v226, a54
    v_accvgpr_read_b32 v227, a55
    v_mul_f32 v224, v224, v53
    v_mul_f32 v225, v225, v53
    v_mul_f32 v226, v226, v53
    v_mul_f32 v227, v227, v53
    v_accvgpr_write_b32 a52, v224
    v_accvgpr_write_b32 a53, v225
    v_accvgpr_write_b32 a54, v226
    v_accvgpr_write_b32 a55, v227
    v_accvgpr_read_b32 v224, a56
    v_accvgpr_read_b32 v225, a57
    v_accvgpr_read_b32 v226, a58
    v_accvgpr_read_b32 v227, a59
    v_mul_f32 v224, v224, v54
    v_mul_f32 v225, v225, v54
    v_mul_f32 v226, v226, v54
    v_mul_f32 v227, v227, v54
    v_accvgpr_write_b32 a56, v224
    v_accvgpr_write_b32 a57, v225
    v_accvgpr_write_b32 a58, v226
    v_accvgpr_write_b32 a59, v227
    v_accvgpr_read_b32 v224, a60
    v_accvgpr_read_b32 v225, a61
    v_accvgpr_read_b32 v226, a62
    v_accvgpr_read_b32 v227, a63
    v_mul_f32 v224, v224, v55
    v_mul_f32 v225, v225, v55
    v_mul_f32 v226, v226, v55
    v_mul_f32 v227, v227, v55
    v_accvgpr_write_b32 a60, v224
    v_accvgpr_write_b32 a61, v225
    v_accvgpr_write_b32 a62, v226
    v_accvgpr_write_b32 a63, v227
    v_accvgpr_read_b32 v224, a68
    v_accvgpr_read_b32 v225, a69
    v_accvgpr_read_b32 v226, a70
    v_accvgpr_read_b32 v227, a71
    v_mul_f32 v224, v224, v53
    v_mul_f32 v225, v225, v53
    v_mul_f32 v226, v226, v53
    v_mul_f32 v227, v227, v53
    v_accvgpr_write_b32 a68, v224
    v_accvgpr_write_b32 a69, v225
    v_accvgpr_write_b32 a70, v226
    v_accvgpr_write_b32 a71, v227
    v_accvgpr_read_b32 v224, a72
    v_accvgpr_read_b32 v225, a73
    v_accvgpr_read_b32 v226, a74
    v_accvgpr_read_b32 v227, a75
    v_mul_f32 v224, v224, v54
    v_mul_f32 v225, v225, v54
    v_mul_f32 v226, v226, v54
    v_mul_f32 v227, v227, v54
    v_accvgpr_write_b32 a72, v224
    v_accvgpr_write_b32 a73, v225
    v_accvgpr_write_b32 a74, v226
    v_accvgpr_write_b32 a75, v227
    v_accvgpr_read_b32 v224, a76
    v_accvgpr_read_b32 v225, a77
    v_accvgpr_read_b32 v226, a78
    v_accvgpr_read_b32 v227, a79
    v_mul_f32 v224, v224, v55
    v_mul_f32 v225, v225, v55
    v_mul_f32 v226, v226, v55
    v_mul_f32 v227, v227, v55
    v_accvgpr_write_b32 a76, v224
    v_accvgpr_write_b32 a77, v225
    v_accvgpr_write_b32 a78, v226
    v_accvgpr_write_b32 a79, v227
    v_accvgpr_read_b32 v224, a84
    v_accvgpr_read_b32 v225, a85
    v_accvgpr_read_b32 v226, a86
    v_accvgpr_read_b32 v227, a87
    v_mul_f32 v224, v224, v53
    v_mul_f32 v225, v225, v53
    v_mul_f32 v226, v226, v53
    v_mul_f32 v227, v227, v53
    v_accvgpr_write_b32 a84, v224
    v_accvgpr_write_b32 a85, v225
    v_accvgpr_write_b32 a86, v226
    v_accvgpr_write_b32 a87, v227
    v_accvgpr_read_b32 v224, a88
    v_accvgpr_read_b32 v225, a89
    v_accvgpr_read_b32 v226, a90
    v_accvgpr_read_b32 v227, a91
    v_mul_f32 v224, v224, v54
    v_mul_f32 v225, v225, v54
    v_mul_f32 v226, v226, v54
    v_mul_f32 v227, v227, v54
    v_accvgpr_write_b32 a88, v224
    v_accvgpr_write_b32 a89, v225
    v_accvgpr_write_b32 a90, v226
    v_accvgpr_write_b32 a91, v227
    v_accvgpr_read_b32 v224, a92
    v_accvgpr_read_b32 v225, a93
    v_accvgpr_read_b32 v226, a94
    v_accvgpr_read_b32 v227, a95
    v_mul_f32 v224, v224, v55
    v_mul_f32 v225, v225, v55
    v_mul_f32 v226, v226, v55
    v_mul_f32 v227, v227, v55
    v_accvgpr_write_b32 a92, v224
    v_accvgpr_write_b32 a93, v225
    v_accvgpr_write_b32 a94, v226
    v_accvgpr_write_b32 a95, v227
    v_accvgpr_read_b32 v224, a100
    v_accvgpr_read_b32 v225, a101
    v_accvgpr_read_b32 v226, a102
    v_accvgpr_read_b32 v227, a103
    v_mul_f32 v224, v224, v53
    v_mul_f32 v225, v225, v53
    v_mul_f32 v226, v226, v53
    v_mul_f32 v227, v227, v53
    v_accvgpr_write_b32 a100, v224
    v_accvgpr_write_b32 a101, v225
    v_accvgpr_write_b32 a102, v226
    v_accvgpr_write_b32 a103, v227
    v_accvgpr_read_b32 v224, a104
    v_accvgpr_read_b32 v225, a105
    v_accvgpr_read_b32 v226, a106
    v_accvgpr_read_b32 v227, a107
    v_mul_f32 v224, v224, v54
    v_mul_f32 v225, v225, v54
    v_mul_f32 v226, v226, v54
    v_mul_f32 v227, v227, v54
    v_accvgpr_write_b32 a104, v224
    v_accvgpr_write_b32 a105, v225
    v_accvgpr_write_b32 a106, v226
    v_accvgpr_write_b32 a107, v227
    v_accvgpr_read_b32 v224, a108
    v_accvgpr_read_b32 v225, a109
    v_accvgpr_read_b32 v226, a110
    v_accvgpr_read_b32 v227, a111
    v_mul_f32 v224, v224, v55
    v_mul_f32 v225, v225, v55
    v_mul_f32 v226, v226, v55
    v_mul_f32 v227, v227, v55
    v_accvgpr_write_b32 a108, v224
    v_accvgpr_write_b32 a109, v225
    v_accvgpr_write_b32 a110, v226
    v_accvgpr_write_b32 a111, v227
    v_accvgpr_read_b32 v224, a116
    v_accvgpr_read_b32 v225, a117
    v_accvgpr_read_b32 v226, a118
    v_accvgpr_read_b32 v227, a119
    v_mul_f32 v224, v224, v53
    v_mul_f32 v225, v225, v53
    v_mul_f32 v226, v226, v53
    v_mul_f32 v227, v227, v53
    v_accvgpr_write_b32 a116, v224
    v_accvgpr_write_b32 a117, v225
    v_accvgpr_write_b32 a118, v226
    v_accvgpr_write_b32 a119, v227
    v_accvgpr_read_b32 v224, a120
    v_accvgpr_read_b32 v225, a121
    v_accvgpr_read_b32 v226, a122
    v_accvgpr_read_b32 v227, a123
    v_mul_f32 v224, v224, v54
    v_mul_f32 v225, v225, v54
    v_mul_f32 v226, v226, v54
    v_mul_f32 v227, v227, v54
    v_accvgpr_write_b32 a120, v224
    v_accvgpr_write_b32 a121, v225
    v_accvgpr_write_b32 a122, v226
    v_accvgpr_write_b32 a123, v227
    v_accvgpr_read_b32 v224, a124
    v_accvgpr_read_b32 v225, a125
    v_accvgpr_read_b32 v226, a126
    v_accvgpr_read_b32 v227, a127
    v_mul_f32 v224, v224, v55
    v_mul_f32 v225, v225, v55
    v_mul_f32 v226, v226, v55
    v_mul_f32 v227, v227, v55
    v_accvgpr_write_b32 a124, v224
    v_accvgpr_write_b32 a125, v225
    v_accvgpr_write_b32 a126, v226
    v_accvgpr_write_b32 a127, v227
    v_exp_f32 v232, v132
    v_exp_f32 v233, v133
    v_exp_f32 v234, v134
    v_exp_f32 v235, v135
    s_nop 0
    v_cvt_pk_bf16_f32 v196, v232, v233
    v_cvt_pk_bf16_f32 v197, v234, v235
    v_exp_f32 v232, v148
    v_exp_f32 v233, v149
    v_exp_f32 v234, v150
    v_exp_f32 v235, v151
    s_nop 0
    v_cvt_pk_bf16_f32 v198, v232, v233
    v_cvt_pk_bf16_f32 v199, v234, v235
    v_exp_f32 v232, v136
    v_exp_f32 v233, v137
    v_exp_f32 v234, v138
    v_exp_f32 v235, v139
    s_nop 0
    v_cvt_pk_bf16_f32 v200, v232, v233
    v_cvt_pk_bf16_f32 v201, v234, v235
    v_exp_f32 v232, v152
    v_exp_f32 v233, v153
    v_exp_f32 v234, v154
    v_exp_f32 v235, v155
    s_nop 0
    v_cvt_pk_bf16_f32 v202, v232, v233
    v_cvt_pk_bf16_f32 v203, v234, v235
    v_exp_f32 v232, v140
    v_exp_f32 v233, v141
    v_exp_f32 v234, v142
    v_exp_f32 v235, v143
    s_nop 0
    v_cvt_pk_bf16_f32 v204, v232, v233
    v_cvt_pk_bf16_f32 v205, v234, v235
    v_exp_f32 v232, v156
    v_exp_f32 v233, v157
    v_exp_f32 v234, v158
    v_exp_f32 v235, v159
    s_nop 0
    v_cvt_pk_bf16_f32 v206, v232, v233
    v_cvt_pk_bf16_f32 v207, v234, v235
    s_nop 3
    s_setpc_b64 s[40:41]
k2_rare_165:
    s_nop 7
    v_max_f32 v53, v164, v165
    v_max3_f32 v53, v53, v166, v167
    v_max3_f32 v53, v53, v180, v181
    v_max3_f32 v53, v53, v182, v183
    v_max_f32 v54, v168, v169
    v_max3_f32 v54, v54, v170, v171
    v_max3_f32 v54, v54, v184, v185
    v_max3_f32 v54, v54, v186, v187
    v_max_f32 v55, v172, v173
    v_max3_f32 v55, v55, v174, v175
    v_max3_f32 v55, v55, v188, v189
    v_max3_f32 v55, v55, v190, v191
    v_mov_b32 v225, v53
    v_mov_b32 v226, v54
    v_mov_b32 v227, v55
    s_nop 1
    v_permlane16_swap_b32 v53, v225
    v_permlane16_swap_b32 v54, v226
    v_permlane16_swap_b32 v55, v227
    s_nop 1
    v_max_f32 v53, v53, v225
    v_max_f32 v54, v54, v226
    v_max_f32 v55, v55, v227
    v_mov_b32 v225, v53
    v_mov_b32 v226, v54
    v_mov_b32 v227, v55
    s_nop 1
    v_permlane32_swap_b32 v53, v225
    v_permlane32_swap_b32 v54, v226
    v_permlane32_swap_b32 v55, v227
    s_nop 1
    v_max_f32 v53, v53, v225
    v_max_f32 v54, v54, v226
    v_max_f32 v55, v55, v227
    v_add_f32 v53, 0x41400000, v53
    v_max_f32 v53, 0, v53
    v_add_f32 v54, 0x41400000, v54
    v_max_f32 v54, 0, v54
    v_add_f32 v55, 0x41400000, v55
    v_max_f32 v55, 0, v55
    v_sub_f32 v164, v164, v53
    v_sub_f32 v165, v165, v53
    v_sub_f32 v166, v166, v53
    v_sub_f32 v167, v167, v53
    v_sub_f32 v168, v168, v54
    v_sub_f32 v169, v169, v54
    v_sub_f32 v170, v170, v54
    v_sub_f32 v171, v171, v54
    v_sub_f32 v172, v172, v55
    v_sub_f32 v173, v173, v55
    v_sub_f32 v174, v174, v55
    v_sub_f32 v175, v175, v55
    v_sub_f32 v180, v180, v53
    v_sub_f32 v181, v181, v53
    v_sub_f32 v182, v182, v53
    v_sub_f32 v183, v183, v53
    v_sub_f32 v184, v184, v54
    v_sub_f32 v185, v185, v54
    v_sub_f32 v186, v186, v54
    v_sub_f32 v187, v187, v54
    v_sub_f32 v188, v188, v55
    v_sub_f32 v189, v189, v55
    v_sub_f32 v190, v190, v55
    v_sub_f32 v191, v191, v55
    v_sub_f32 v128, v128, v54
    v_sub_f32 v16, v16, v54
    v_sub_f32 v129, v129, v54
    v_sub_f32 v17, v17, v54
    v_sub_f32 v130, v130, v54
    v_sub_f32 v18, v18, v54
    v_sub_f32 v131, v131, v54
    v_sub_f32 v19, v19, v54
    v_sub_f32 v132, v132, v55
    v_sub_f32 v20, v20, v55
    v_sub_f32 v133, v133, v55
    v_sub_f32 v21, v21, v55
    v_sub_f32 v134, v134, v55
    v_sub_f32 v22, v22, v55
    v_sub_f32 v135, v135, v55
    v_sub_f32 v23, v23, v55
    v_sub_f32 v136, v136, v54
    v_sub_f32 v24, v24, v54
    v_sub_f32 v137, v137, v54
    v_sub_f32 v25, v25, v54
    v_sub_f32 v138, v138, v54
    v_sub_f32 v26, v26, v54
    v_sub_f32 v139, v139, v54
    v_sub_f32 v27, v27, v54
    v_sub_f32 v140, v140, v55
    v_sub_f32 v28, v28, v55
    v_sub_f32 v141, v141, v55
    v_sub_f32 v29, v29, v55
    v_sub_f32 v142, v142, v55
    v_sub_f32 v30, v30, v55
    v_sub_f32 v143, v143, v55
    v_sub_f32 v31, v31, v55
    v_sub_f32 v144, v144, v54
    v_sub_f32 v32, v32, v54
    v_sub_f32 v145, v145, v54
    v_sub_f32 v33, v33, v54
    v_sub_f32 v146, v146, v54
    v_sub_f32 v34, v34, v54
    v_sub_f32 v147, v147, v54
    v_sub_f32 v35, v35, v54
    v_sub_f32 v148, v148, v55
    v_sub_f32 v36, v36, v55
    v_sub_f32 v149, v149, v55
    v_sub_f32 v37, v37, v55
    v_sub_f32 v150, v150, v55
    v_sub_f32 v38, v38, v55
    v_sub_f32 v151, v151, v55
    v_sub_f32 v39, v39, v55
    v_sub_f32 v152, v152, v54
    v_sub_f32 v40, v40, v54
    v_sub_f32 v153, v153, v54
    v_sub_f32 v41, v41, v54
    v_sub_f32 v154, v154, v54
    v_sub_f32 v42, v42, v54
    v_sub_f32 v155, v155, v54
    v_sub_f32 v43, v43, v54
    v_sub_f32 v156, v156, v55
    v_sub_f32 v44, v44, v55
    v_sub_f32 v157, v157, v55
    v_sub_f32 v45, v45, v55
    v_sub_f32 v158, v158, v55
    v_sub_f32 v46, v46, v55
    v_sub_f32 v159, v159, v55
    v_sub_f32 v47, v47, v55
    v_sub_f32 v9, v9, v53
    v_exp_f32 v53, -v53
    v_sub_f32 v10, v10, v54
    v_exp_f32 v54, -v54
    v_sub_f32 v11, v11, v55
    v_exp_f32 v55, -v55
    s_nop 0
    v_mul_f32 v48, v48, v53
    v_mul_f32 v248, v248, v54
    v_mul_f32 v252, v252, v55
    v_accvgpr_read_b32 v224, a4
    v_accvgpr_read_b32 v225, a5
    v_accvgpr_read_b32 v226, a6
    v_accvgpr_read_b32 v227, a7
    v_mul_f32 v224, v224, v53
    v_mul_f32 v225, v225, v53
    v_mul_f32 v226, v226, v53
    v_mul_f32 v227, v227, v53
    v_accvgpr_write_b32 a4, v224
    v_accvgpr_write_b32 a5, v225
    v_accvgpr_write_b32 a6, v226
    v_accvgpr_write_b32 a7, v227
    v_accvgpr_read_b32 v224, a8
    v_accvgpr_read_b32 v225, a9
    v_accvgpr_read_b32 v226, a10
    v_accvgpr_read_b32 v227, a11
    v_mul_f32 v224, v224, v54
    v_mul_f32 v225, v225, v54
    v_mul_f32 v226, v226, v54
    v_mul_f32 v227, v227, v54
    v_accvgpr_write_b32 a8, v224
    v_accvgpr_write_b32 a9, v225
    v_accvgpr_write_b32 a10, v226
    v_accvgpr_write_b32 a11, v227
    v_accvgpr_read_b32 v224, a12
    v_accvgpr_read_b32 v225, a13
    v_accvgpr_read_b32 v226, a14
    v_accvgpr_read_b32 v227, a15
    v_mul_f32 v224, v224, v55
    v_mul_f32 v225, v225, v55
    v_mul_f32 v226, v226, v55
    v_mul_f32 v227, v227, v55
    v_accvgpr_write_b32 a12, v224
    v_accvgpr_write_b32 a13, v225
    v_accvgpr_write_b32 a14, v226
    v_accvgpr_write_b32 a15, v227
    v_accvgpr_read_b32 v224, a20
    v_accvgpr_read_b32 v225, a21
    v_accvgpr_read_b32 v226, a22
    v_accvgpr_read_b32 v227, a23
    v_mul_f32 v224, v224, v53
    v_mul_f32 v225, v225, v53
    v_mul_f32 v226, v226, v53
    v_mul_f32 v227, v227, v53
    v_accvgpr_write_b32 a20, v224
    v_accvgpr_write_b32 a21, v225
    v_accvgpr_write_b32 a22, v226
    v_accvgpr_write_b32 a23, v227
    v_accvgpr_read_b32 v224, a24
    v_accvgpr_read_b32 v225, a25
    v_accvgpr_read_b32 v226, a26
    v_accvgpr_read_b32 v227, a27
    v_mul_f32 v224, v224, v54
    v_mul_f32 v225, v225, v54
    v_mul_f32 v226, v226, v54
    v_mul_f32 v227, v227, v54
    v_accvgpr_write_b32 a24, v224
    v_accvgpr_write_b32 a25, v225
    v_accvgpr_write_b32 a26, v226
    v_accvgpr_write_b32 a27, v227
    v_accvgpr_read_b32 v224, a28
    v_accvgpr_read_b32 v225, a29
    v_accvgpr_read_b32 v226, a30
    v_accvgpr_read_b32 v227, a31
    v_mul_f32 v224, v224, v55
    v_mul_f32 v225, v225, v55
    v_mul_f32 v226, v226, v55
    v_mul_f32 v227, v227, v55
    v_accvgpr_write_b32 a28, v224
    v_accvgpr_write_b32 a29, v225
    v_accvgpr_write_b32 a30, v226
    v_accvgpr_write_b32 a31, v227
    v_accvgpr_read_b32 v224, a36
    v_accvgpr_read_b32 v225, a37
    v_accvgpr_read_b32 v226, a38
    v_accvgpr_read_b32 v227, a39
    v_mul_f32 v224, v224, v53
    v_mul_f32 v225, v225, v53
    v_mul_f32 v226, v226, v53
    v_mul_f32 v227, v227, v53
    v_accvgpr_write_b32 a36, v224
    v_accvgpr_write_b32 a37, v225
    v_accvgpr_write_b32 a38, v226
    v_accvgpr_write_b32 a39, v227
    v_accvgpr_read_b32 v224, a40
    v_accvgpr_read_b32 v225, a41
    v_accvgpr_read_b32 v226, a42
    v_accvgpr_read_b32 v227, a43
    v_mul_f32 v224, v224, v54
    v_mul_f32 v225, v225, v54
    v_mul_f32 v226, v226, v54
    v_mul_f32 v227, v227, v54
    v_accvgpr_write_b32 a40, v224
    v_accvgpr_write_b32 a41, v225
    v_accvgpr_write_b32 a42, v226
    v_accvgpr_write_b32 a43, v227
    v_accvgpr_read_b32 v224, a44
    v_accvgpr_read_b32 v225, a45
    v_accvgpr_read_b32 v226, a46
    v_accvgpr_read_b32 v227, a47
    v_mul_f32 v224, v224, v55
    v_mul_f32 v225, v225, v55
    v_mul_f32 v226, v226, v55
    v_mul_f32 v227, v227, v55
    v_accvgpr_write_b32 a44, v224
    v_accvgpr_write_b32 a45, v225
    v_accvgpr_write_b32 a46, v226
    v_accvgpr_write_b32 a47, v227
    v_accvgpr_read_b32 v224, a52
    v_accvgpr_read_b32 v225, a53
    v_accvgpr_read_b32 v226, a54
    v_accvgpr_read_b32 v227, a55
    v_mul_f32 v224, v224, v53
    v_mul_f32 v225, v225, v53
    v_mul_f32 v226, v226, v53
    v_mul_f32 v227, v227, v53
    v_accvgpr_write_b32 a52, v224
    v_accvgpr_write_b32 a53, v225
    v_accvgpr_write_b32 a54, v226
    v_accvgpr_write_b32 a55, v227
    v_accvgpr_read_b32 v224, a56
    v_accvgpr_read_b32 v225, a57
    v_accvgpr_read_b32 v226, a58
    v_accvgpr_read_b32 v227, a59
    v_mul_f32 v224, v224, v54
    v_mul_f32 v225, v225, v54
    v_mul_f32 v226, v226, v54
    v_mul_f32 v227, v227, v54
    v_accvgpr_write_b32 a56, v224
    v_accvgpr_write_b32 a57, v225
    v_accvgpr_write_b32 a58, v226
    v_accvgpr_write_b32 a59, v227
    v_accvgpr_read_b32 v224, a60
    v_accvgpr_read_b32 v225, a61
    v_accvgpr_read_b32 v226, a62
    v_accvgpr_read_b32 v227, a63
    v_mul_f32 v224, v224, v55
    v_mul_f32 v225, v225, v55
    v_mul_f32 v226, v226, v55
    v_mul_f32 v227, v227, v55
    v_accvgpr_write_b32 a60, v224
    v_accvgpr_write_b32 a61, v225
    v_accvgpr_write_b32 a62, v226
    v_accvgpr_write_b32 a63, v227
    v_accvgpr_read_b32 v224, a68
    v_accvgpr_read_b32 v225, a69
    v_accvgpr_read_b32 v226, a70
    v_accvgpr_read_b32 v227, a71
    v_mul_f32 v224, v224, v53
    v_mul_f32 v225, v225, v53
    v_mul_f32 v226, v226, v53
    v_mul_f32 v227, v227, v53
    v_accvgpr_write_b32 a68, v224
    v_accvgpr_write_b32 a69, v225
    v_accvgpr_write_b32 a70, v226
    v_accvgpr_write_b32 a71, v227
    v_accvgpr_read_b32 v224, a72
    v_accvgpr_read_b32 v225, a73
    v_accvgpr_read_b32 v226, a74
    v_accvgpr_read_b32 v227, a75
    v_mul_f32 v224, v224, v54
    v_mul_f32 v225, v225, v54
    v_mul_f32 v226, v226, v54
    v_mul_f32 v227, v227, v54
    v_accvgpr_write_b32 a72, v224
    v_accvgpr_write_b32 a73, v225
    v_accvgpr_write_b32 a74, v226
    v_accvgpr_write_b32 a75, v227
    v_accvgpr_read_b32 v224, a76
    v_accvgpr_read_b32 v225, a77
    v_accvgpr_read_b32 v226, a78
    v_accvgpr_read_b32 v227, a79
    v_mul_f32 v224, v224, v55
    v_mul_f32 v225, v225, v55
    v_mul_f32 v226, v226, v55
    v_mul_f32 v227, v227, v55
    v_accvgpr_write_b32 a76, v224
    v_accvgpr_write_b32 a77, v225
    v_accvgpr_write_b32 a78, v226
    v_accvgpr_write_b32 a79, v227
    v_accvgpr_read_b32 v224, a84
    v_accvgpr_read_b32 v225, a85
    v_accvgpr_read_b32 v226, a86
    v_accvgpr_read_b32 v227, a87
    v_mul_f32 v224, v224, v53
    v_mul_f32 v225, v225, v53
    v_mul_f32 v226, v226, v53
    v_mul_f32 v227, v227, v53
    v_accvgpr_write_b32 a84, v224
    v_accvgpr_write_b32 a85, v225
    v_accvgpr_write_b32 a86, v226
    v_accvgpr_write_b32 a87, v227
    v_accvgpr_read_b32 v224, a88
    v_accvgpr_read_b32 v225, a89
    v_accvgpr_read_b32 v226, a90
    v_accvgpr_read_b32 v227, a91
    v_mul_f32 v224, v224, v54
    v_mul_f32 v225, v225, v54
    v_mul_f32 v226, v226, v54
    v_mul_f32 v227, v227, v54
    v_accvgpr_write_b32 a88, v224
    v_accvgpr_write_b32 a89, v225
    v_accvgpr_write_b32 a90, v226
    v_accvgpr_write_b32 a91, v227
    v_accvgpr_read_b32 v224, a92
    v_accvgpr_read_b32 v225, a93
    v_accvgpr_read_b32 v226, a94
    v_accvgpr_read_b32 v227, a95
    v_mul_f32 v224, v224, v55
    v_mul_f32 v225, v225, v55
    v_mul_f32 v226, v226, v55
    v_mul_f32 v227, v227, v55
    v_accvgpr_write_b32 a92, v224
    v_accvgpr_write_b32 a93, v225
    v_accvgpr_write_b32 a94, v226
    v_accvgpr_write_b32 a95, v227
    v_accvgpr_read_b32 v224, a100
    v_accvgpr_read_b32 v225, a101
    v_accvgpr_read_b32 v226, a102
    v_accvgpr_read_b32 v227, a103
    v_mul_f32 v224, v224, v53
    v_mul_f32 v225, v225, v53
    v_mul_f32 v226, v226, v53
    v_mul_f32 v227, v227, v53
    v_accvgpr_write_b32 a100, v224
    v_accvgpr_write_b32 a101, v225
    v_accvgpr_write_b32 a102, v226
    v_accvgpr_write_b32 a103, v227
    v_accvgpr_read_b32 v224, a104
    v_accvgpr_read_b32 v225, a105
    v_accvgpr_read_b32 v226, a106
    v_accvgpr_read_b32 v227, a107
    v_mul_f32 v224, v224, v54
    v_mul_f32 v225, v225, v54
    v_mul_f32 v226, v226, v54
    v_mul_f32 v227, v227, v54
    v_accvgpr_write_b32 a104, v224
    v_accvgpr_write_b32 a105, v225
    v_accvgpr_write_b32 a106, v226
    v_accvgpr_write_b32 a107, v227
    v_accvgpr_read_b32 v224, a108
    v_accvgpr_read_b32 v225, a109
    v_accvgpr_read_b32 v226, a110
    v_accvgpr_read_b32 v227, a111
    v_mul_f32 v224, v224, v55
    v_mul_f32 v225, v225, v55
    v_mul_f32 v226, v226, v55
    v_mul_f32 v227, v227, v55
    v_accvgpr_write_b32 a108, v224
    v_accvgpr_write_b32 a109, v225
    v_accvgpr_write_b32 a110, v226
    v_accvgpr_write_b32 a111, v227
    v_accvgpr_read_b32 v224, a116
    v_accvgpr_read_b32 v225, a117
    v_accvgpr_read_b32 v226, a118
    v_accvgpr_read_b32 v227, a119
    v_mul_f32 v224, v224, v53
    v_mul_f32 v225, v225, v53
    v_mul_f32 v226, v226, v53
    v_mul_f32 v227, v227, v53
    v_accvgpr_write_b32 a116, v224
    v_accvgpr_write_b32 a117, v225
    v_accvgpr_write_b32 a118, v226
    v_accvgpr_write_b32 a119, v227
    v_accvgpr_read_b32 v224, a120
    v_accvgpr_read_b32 v225, a121
    v_accvgpr_read_b32 v226, a122
    v_accvgpr_read_b32 v227, a123
    v_mul_f32 v224, v224, v54
    v_mul_f32 v225, v225, v54
    v_mul_f32 v226, v226, v54
    v_mul_f32 v227, v227, v54
    v_accvgpr_write_b32 a120, v224
    v_accvgpr_write_b32 a121, v225
    v_accvgpr_write_b32 a122, v226
    v_accvgpr_write_b32 a123, v227
    v_accvgpr_read_b32 v224, a124
    v_accvgpr_read_b32 v225, a125
    v_accvgpr_read_b32 v226, a126
    v_accvgpr_read_b32 v227, a127
    v_mul_f32 v224, v224, v55
    v_mul_f32 v225, v225, v55
    v_mul_f32 v226, v226, v55
    v_mul_f32 v227, v227, v55
    v_accvgpr_write_b32 a124, v224
    v_accvgpr_write_b32 a125, v225
    v_accvgpr_write_b32 a126, v226
    v_accvgpr_write_b32 a127, v227
    v_exp_f32 v232, v164
    v_exp_f32 v233, v165
    v_exp_f32 v234, v166
    v_exp_f32 v235, v167
    s_nop 0
    v_cvt_pk_bf16_f32 v212, v232, v233
    v_cvt_pk_bf16_f32 v213, v234, v235
    v_exp_f32 v232, v180
    v_exp_f32 v233, v181
    v_exp_f32 v234, v182
    v_exp_f32 v235, v183
    s_nop 0
    v_cvt_pk_bf16_f32 v214, v232, v233
    v_cvt_pk_bf16_f32 v215, v234, v235
    v_exp_f32 v232, v168
    v_exp_f32 v233, v169
    v_exp_f32 v234, v170
    v_exp_f32 v235, v171
    s_nop 0
    v_cvt_pk_bf16_f32 v216, v232, v233
    v_cvt_pk_bf16_f32 v217, v234, v235
    v_exp_f32 v232, v184
    v_exp_f32 v233, v185
    v_exp_f32 v234, v186
    v_exp_f32 v235, v187
    s_nop 0
    v_cvt_pk_bf16_f32 v218, v232, v233
    v_cvt_pk_bf16_f32 v219, v234, v235
    v_exp_f32 v232, v172
    v_exp_f32 v233, v173
    v_exp_f32 v234, v174
    v_exp_f32 v235, v175
    s_nop 0
    v_cvt_pk_bf16_f32 v220, v232, v233
    v_cvt_pk_bf16_f32 v221, v234, v235
    v_exp_f32 v232, v188
    v_exp_f32 v233, v189
    v_exp_f32 v234, v190
    v_exp_f32 v235, v191
    s_nop 0
    v_cvt_pk_bf16_f32 v222, v232, v233
    v_cvt_pk_bf16_f32 v223, v234, v235
    s_nop 3
    s_setpc_b64 s[40:41]
k2_rare_166:
    s_nop 7
    v_max_f32 v54, v128, v129
    v_max3_f32 v54, v54, v130, v131
    v_max3_f32 v54, v54, v144, v145
    v_max3_f32 v54, v54, v146, v147
    v_max3_f32 v54, v54, v136, v137
    v_max3_f32 v54, v54, v138, v139
    v_max3_f32 v54, v54, v152, v153
    v_max3_f32 v54, v54, v154, v155
    v_max_f32 v55, v132, v133
    v_max3_f32 v55, v55, v134, v135
    v_max3_f32 v55, v55, v148, v149
    v_max3_f32 v55, v55, v150, v151
    v_max3_f32 v55, v55, v140, v141
    v_max3_f32 v55, v55, v142, v143
    v_max3_f32 v55, v55, v156, v157
    v_max3_f32 v55, v55, v158, v159
    v_mov_b32 v226, v54
    v_mov_b32 v227, v55
    s_nop 1
    v_permlane16_swap_b32 v54, v226
    v_permlane16_swap_b32 v55, v227
    s_nop 1
    v_max_f32 v54, v54, v226
    v_max_f32 v55, v55, v227
    v_mov_b32 v226, v54
    v_mov_b32 v227, v55
    s_nop 1
    v_permlane32_swap_b32 v54, v226
    v_permlane32_swap_b32 v55, v227
    s_nop 1
    v_max_f32 v54, v54, v226
    v_max_f32 v55, v55, v227
    v_add_f32 v54, 0x41400000, v54
    v_max_f32 v54, 0, v54
    v_add_f32 v55, 0x41400000, v55
    v_max_f32 v55, 0, v55
    v_sub_f32 v128, v128, v54
    v_sub_f32 v129, v129, v54
    v_sub_f32 v130, v130, v54
    v_sub_f32 v131, v131, v54
    v_sub_f32 v132, v132, v55
    v_sub_f32 v133, v133, v55
    v_sub_f32 v134, v134, v55
    v_sub_f32 v135, v135, v55
    v_sub_f32 v136, v136, v54
    v_sub_f32 v137, v137, v54
    v_sub_f32 v138, v138, v54
    v_sub_f32 v139, v139, v54
    v_sub_f32 v140, v140, v55
    v_sub_f32 v141, v141, v55
    v_sub_f32 v142, v142, v55
    v_sub_f32 v143, v143, v55
    v_sub_f32 v144, v144, v54
    v_sub_f32 v145, v145, v54
    v_sub_f32 v146, v146, v54
    v_sub_f32 v147, v147, v54
    v_sub_f32 v148, v148, v55
    v_sub_f32 v149, v149, v55
    v_sub_f32 v150, v150, v55
    v_sub_f32 v151, v151, v55
    v_sub_f32 v152, v152, v54
    v_sub_f32 v153, v153, v54
    v_sub_f32 v154, v154, v54
    v_sub_f32 v155, v155, v54
    v_sub_f32 v156, v156, v55
    v_sub_f32 v157, v157, v55
    v_sub_f32 v158, v158, v55
    v_sub_f32 v159, v159, v55
    v_sub_f32 v160, v160, v54
    v_sub_f32 v16, v16, v54
    v_sub_f32 v161, v161, v54
    v_sub_f32 v17, v17, v54
    v_sub_f32 v162, v162, v54
    v_sub_f32 v18, v18, v54
    v_sub_f32 v163, v163, v54
    v_sub_f32 v19, v19, v54
    v_sub_f32 v164, v164, v55
    v_sub_f32 v20, v20, v55
    v_sub_f32 v165, v165, v55
    v_sub_f32 v21, v21, v55
    v_sub_f32 v166, v166, v55
    v_sub_f32 v22, v22, v55
    v_sub_f32 v167, v167, v55
    v_sub_f32 v23, v23, v55
    v_sub_f32 v168, v168, v54
    v_sub_f32 v24, v24, v54
    v_sub_f32 v169, v169, v54
    v_sub_f32 v25, v25, v54
    v_sub_f32 v170, v170, v54
    v_sub_f32 v26, v26, v54
    v_sub_f32 v171, v171, v54
    v_sub_f32 v27, v27, v54
    v_sub_f32 v172, v172, v55
    v_sub_f32 v28, v28, v55
    v_sub_f32 v173, v173, v55
    v_sub_f32 v29, v29, v55
    v_sub_f32 v174, v174, v55
    v_sub_f32 v30, v30, v55
    v_sub_f32 v175, v175, v55
    v_sub_f32 v31, v31, v55
    v_sub_f32 v176, v176, v54
    v_sub_f32 v32, v32, v54
    v_sub_f32 v177, v177, v54
    v_sub_f32 v33, v33, v54
    v_sub_f32 v178, v178, v54
    v_sub_f32 v34, v34, v54
    v_sub_f32 v179, v179, v54
    v_sub_f32 v35, v35, v54
    v_sub_f32 v180, v180, v55
    v_sub_f32 v36, v36, v55
    v_sub_f32 v181, v181, v55
    v_sub_f32 v37, v37, v55
    v_sub_f32 v182, v182, v55
    v_sub_f32 v38, v38, v55
    v_sub_f32 v183, v183, v55
    v_sub_f32 v39, v39, v55
    v_sub_f32 v184, v184, v54
    v_sub_f32 v40, v40, v54
    v_sub_f32 v185, v185, v54
    v_sub_f32 v41, v41, v54
    v_sub_f32 v186, v186, v54
    v_sub_f32 v42, v42, v54
    v_sub_f32 v187, v187, v54
    v_sub_f32 v43, v43, v54
    v_sub_f32 v188, v188, v55
    v_sub_f32 v44, v44, v55
    v_sub_f32 v189, v189, v55
    v_sub_f32 v45, v45, v55
    v_sub_f32 v190, v190, v55
    v_sub_f32 v46, v46, v55
    v_sub_f32 v191, v191, v55
    v_sub_f32 v47, v47, v55
    v_sub_f32 v10, v10, v54
    v_exp_f32 v54, -v54
    v_sub_f32 v11, v11, v55
    v_exp_f32 v55, -v55
    s_nop 0
    v_mul_f32 v248, v248, v54
    v_mul_f32 v252, v252, v55
    v_accvgpr_read_b32 v224, a8
    v_accvgpr_read_b32 v225, a9
    v_accvgpr_read_b32 v226, a10
    v_accvgpr_read_b32 v227, a11
    v_mul_f32 v224, v224, v54
    v_mul_f32 v225, v225, v54
    v_mul_f32 v226, v226, v54
    v_mul_f32 v227, v227, v54
    v_accvgpr_write_b32 a8, v224
    v_accvgpr_write_b32 a9, v225
    v_accvgpr_write_b32 a10, v226
    v_accvgpr_write_b32 a11, v227
    v_accvgpr_read_b32 v224, a12
    v_accvgpr_read_b32 v225, a13
    v_accvgpr_read_b32 v226, a14
    v_accvgpr_read_b32 v227, a15
    v_mul_f32 v224, v224, v55
    v_mul_f32 v225, v225, v55
    v_mul_f32 v226, v226, v55
    v_mul_f32 v227, v227, v55
    v_accvgpr_write_b32 a12, v224
    v_accvgpr_write_b32 a13, v225
    v_accvgpr_write_b32 a14, v226
    v_accvgpr_write_b32 a15, v227
    v_accvgpr_read_b32 v224, a24
    v_accvgpr_read_b32 v225, a25
    v_accvgpr_read_b32 v226, a26
    v_accvgpr_read_b32 v227, a27
    v_mul_f32 v224, v224, v54
    v_mul_f32 v225, v225, v54
    v_mul_f32 v226, v226, v54
    v_mul_f32 v227, v227, v54
    v_accvgpr_write_b32 a24, v224
    v_accvgpr_write_b32 a25, v225
    v_accvgpr_write_b32 a26, v226
    v_accvgpr_write_b32 a27, v227
    v_accvgpr_read_b32 v224, a28
    v_accvgpr_read_b32 v225, a29
    v_accvgpr_read_b32 v226, a30
    v_accvgpr_read_b32 v227, a31
    v_mul_f32 v224, v224, v55
    v_mul_f32 v225, v225, v55
    v_mul_f32 v226, v226, v55
    v_mul_f32 v227, v227, v55
    v_accvgpr_write_b32 a28, v224
    v_accvgpr_write_b32 a29, v225
    v_accvgpr_write_b32 a30, v226
    v_accvgpr_write_b32 a31, v227
    v_accvgpr_read_b32 v224, a40
    v_accvgpr_read_b32 v225, a41
    v_accvgpr_read_b32 v226, a42
    v_accvgpr_read_b32 v227, a43
    v_mul_f32 v224, v224, v54
    v_mul_f32 v225, v225, v54
    v_mul_f32 v226, v226, v54
    v_mul_f32 v227, v227, v54
    v_accvgpr_write_b32 a40, v224
    v_accvgpr_write_b32 a41, v225
    v_accvgpr_write_b32 a42, v226
    v_accvgpr_write_b32 a43, v227
    v_accvgpr_read_b32 v224, a44
    v_accvgpr_read_b32 v225, a45
    v_accvgpr_read_b32 v226, a46
    v_accvgpr_read_b32 v227, a47
    v_mul_f32 v224, v224, v55
    v_mul_f32 v225, v225, v55
    v_mul_f32 v226, v226, v55
    v_mul_f32 v227, v227, v55
    v_accvgpr_write_b32 a44, v224
    v_accvgpr_write_b32 a45, v225
    v_accvgpr_write_b32 a46, v226
    v_accvgpr_write_b32 a47, v227
    v_accvgpr_read_b32 v224, a56
    v_accvgpr_read_b32 v225, a57
    v_accvgpr_read_b32 v226, a58
    v_accvgpr_read_b32 v227, a59
    v_mul_f32 v224, v224, v54
    v_mul_f32 v225, v225, v54
    v_mul_f32 v226, v226, v54
    v_mul_f32 v227, v227, v54
    v_accvgpr_write_b32 a56, v224
    v_accvgpr_write_b32 a57, v225
    v_accvgpr_write_b32 a58, v226
    v_accvgpr_write_b32 a59, v227
    v_accvgpr_read_b32 v224, a60
    v_accvgpr_read_b32 v225, a61
    v_accvgpr_read_b32 v226, a62
    v_accvgpr_read_b32 v227, a63
    v_mul_f32 v224, v224, v55
    v_mul_f32 v225, v225, v55
    v_mul_f32 v226, v226, v55
    v_mul_f32 v227, v227, v55
    v_accvgpr_write_b32 a60, v224
    v_accvgpr_write_b32 a61, v225
    v_accvgpr_write_b32 a62, v226
    v_accvgpr_write_b32 a63, v227
    v_accvgpr_read_b32 v224, a72
    v_accvgpr_read_b32 v225, a73
    v_accvgpr_read_b32 v226, a74
    v_accvgpr_read_b32 v227, a75
    v_mul_f32 v224, v224, v54
    v_mul_f32 v225, v225, v54
    v_mul_f32 v226, v226, v54
    v_mul_f32 v227, v227, v54
    v_accvgpr_write_b32 a72, v224
    v_accvgpr_write_b32 a73, v225
    v_accvgpr_write_b32 a74, v226
    v_accvgpr_write_b32 a75, v227
    v_accvgpr_read_b32 v224, a76
    v_accvgpr_read_b32 v225, a77
    v_accvgpr_read_b32 v226, a78
    v_accvgpr_read_b32 v227, a79
    v_mul_f32 v224, v224, v55
    v_mul_f32 v225, v225, v55
    v_mul_f32 v226, v226, v55
    v_mul_f32 v227, v227, v55
    v_accvgpr_write_b32 a76, v224
    v_accvgpr_write_b32 a77, v225
    v_accvgpr_write_b32 a78, v226
    v_accvgpr_write_b32 a79, v227
    v_accvgpr_read_b32 v224, a88
    v_accvgpr_read_b32 v225, a89
    v_accvgpr_read_b32 v226, a90
    v_accvgpr_read_b32 v227, a91
    v_mul_f32 v224, v224, v54
    v_mul_f32 v225, v225, v54
    v_mul_f32 v226, v226, v54
    v_mul_f32 v227, v227, v54
    v_accvgpr_write_b32 a88, v224
    v_accvgpr_write_b32 a89, v225
    v_accvgpr_write_b32 a90, v226
    v_accvgpr_write_b32 a91, v227
    v_accvgpr_read_b32 v224, a92
    v_accvgpr_read_b32 v225, a93
    v_accvgpr_read_b32 v226, a94
    v_accvgpr_read_b32 v227, a95
    v_mul_f32 v224, v224, v55
    v_mul_f32 v225, v225, v55
    v_mul_f32 v226, v226, v55
    v_mul_f32 v227, v227, v55
    v_accvgpr_write_b32 a92, v224
    v_accvgpr_write_b32 a93, v225
    v_accvgpr_write_b32 a94, v226
    v_accvgpr_write_b32 a95, v227
    v_accvgpr_read_b32 v224, a104
    v_accvgpr_read_b32 v225, a105
    v_accvgpr_read_b32 v226, a106
    v_accvgpr_read_b32 v227, a107
    v_mul_f32 v224, v224, v54
    v_mul_f32 v225, v225, v54
    v_mul_f32 v226, v226, v54
    v_mul_f32 v227, v227, v54
    v_accvgpr_write_b32 a104, v224
    v_accvgpr_write_b32 a105, v225
    v_accvgpr_write_b32 a106, v226
    v_accvgpr_write_b32 a107, v227
    v_accvgpr_read_b32 v224, a108
    v_accvgpr_read_b32 v225, a109
    v_accvgpr_read_b32 v226, a110
    v_accvgpr_read_b32 v227, a111
    v_mul_f32 v224, v224, v55
    v_mul_f32 v225, v225, v55
    v_mul_f32 v226, v226, v55
    v_mul_f32 v227, v227, v55
    v_accvgpr_write_b32 a108, v224
    v_accvgpr_write_b32 a109, v225
    v_accvgpr_write_b32 a110, v226
    v_accvgpr_write_b32 a111, v227
    v_accvgpr_read_b32 v224, a120
    v_accvgpr_read_b32 v225, a121
    v_accvgpr_read_b32 v226, a122
    v_accvgpr_read_b32 v227, a123
    v_mul_f32 v224, v224, v54
    v_mul_f32 v225, v225, v54
    v_mul_f32 v226, v226, v54
    v_mul_f32 v227, v227, v54
    v_accvgpr_write_b32 a120, v224
    v_accvgpr_write_b32 a121, v225
    v_accvgpr_write_b32 a122, v226
    v_accvgpr_write_b32 a123, v227
    v_accvgpr_read_b32 v224, a124
    v_accvgpr_read_b32 v225, a125
    v_accvgpr_read_b32 v226, a126
    v_accvgpr_read_b32 v227, a127
    v_mul_f32 v224, v224, v55
    v_mul_f32 v225, v225, v55
    v_mul_f32 v226, v226, v55
    v_mul_f32 v227, v227, v55
    v_accvgpr_write_b32 a124, v224
    v_accvgpr_write_b32 a125, v225
    v_accvgpr_write_b32 a126, v226
    v_accvgpr_write_b32 a127, v227
    v_exp_f32 v232, v128
    v_exp_f32 v233, v129
    v_exp_f32 v234, v130
    v_exp_f32 v235, v131
    s_nop 0
    v_cvt_pk_bf16_f32 v192, v232, v233
    v_cvt_pk_bf16_f32 v193, v234, v235
    v_exp_f32 v232, v144
    v_exp_f32 v233, v145
    v_exp_f32 v234, v146
    v_exp_f32 v235, v147
    s_nop 0
    v_cvt_pk_bf16_f32 v194, v232, v233
    v_cvt_pk_bf16_f32 v195, v234, v235
    v_exp_f32 v232, v132
    v_exp_f32 v233, v133
    v_exp_f32 v234, v134
    v_exp_f32 v235, v135
    s_nop 0
    v_cvt_pk_bf16_f32 v196, v232, v233
    v_cvt_pk_bf16_f32 v197, v234, v235
    v_exp_f32 v232, v148
    v_exp_f32 v233, v149
    v_exp_f32 v234, v150
    v_exp_f32 v235, v151
    s_nop 0
    v_cvt_pk_bf16_f32 v198, v232, v233
    v_cvt_pk_bf16_f32 v199, v234, v235
    v_exp_f32 v232, v136
    v_exp_f32 v233, v137
    v_exp_f32 v234, v138
    v_exp_f32 v235, v139
    s_nop 0
    v_cvt_pk_bf16_f32 v200, v232, v233
    v_cvt_pk_bf16_f32 v201, v234, v235
    v_exp_f32 v232, v152
    v_exp_f32 v233, v153
    v_exp_f32 v234, v154
    v_exp_f32 v235, v155
    s_nop 0
    v_cvt_pk_bf16_f32 v202, v232, v233
    v_cvt_pk_bf16_f32 v203, v234, v235
    v_exp_f32 v232, v140
    v_exp_f32 v233, v141
    v_exp_f32 v234, v142
    v_exp_f32 v235, v143
    s_nop 0
    v_cvt_pk_bf16_f32 v204, v232, v233
    v_cvt_pk_bf16_f32 v205, v234, v235
    v_exp_f32 v232, v156
    v_exp_f32 v233, v157
    v_exp_f32 v234, v158
    v_exp_f32 v235, v159
    s_nop 0
    v_cvt_pk_bf16_f32 v206, v232, v233
    v_cvt_pk_bf16_f32 v207, v234, v235
    s_nop 3
    s_setpc_b64 s[40:41]
k2_rare_167:
    s_nop 7
    v_max_f32 v54, v160, v161
    v_max3_f32 v54, v54, v162, v163
    v_max3_f32 v54, v54, v176, v177
    v_max3_f32 v54, v54, v178, v179
    v_max3_f32 v54, v54, v168, v169
    v_max3_f32 v54, v54, v170, v171
    v_max3_f32 v54, v54, v184, v185
    v_max3_f32 v54, v54, v186, v187
    v_max_f32 v55, v164, v165
    v_max3_f32 v55, v55, v166, v167
    v_max3_f32 v55, v55, v180, v181
    v_max3_f32 v55, v55, v182, v183
    v_max3_f32 v55, v55, v172, v173
    v_max3_f32 v55, v55, v174, v175
    v_max3_f32 v55, v55, v188, v189
    v_max3_f32 v55, v55, v190, v191
    v_mov_b32 v226, v54
    v_mov_b32 v227, v55
    s_nop 1
    v_permlane16_swap_b32 v54, v226
    v_permlane16_swap_b32 v55, v227
    s_nop 1
    v_max_f32 v54, v54, v226
    v_max_f32 v55, v55, v227
    v_mov_b32 v226, v54
    v_mov_b32 v227, v55
    s_nop 1
    v_permlane32_swap_b32 v54, v226
    v_permlane32_swap_b32 v55, v227
    s_nop 1
    v_max_f32 v54, v54, v226
    v_max_f32 v55, v55, v227
    v_add_f32 v54, 0x41400000, v54
    v_max_f32 v54, 0, v54
    v_add_f32 v55, 0x41400000, v55
    v_max_f32 v55, 0, v55
    v_sub_f32 v160, v160, v54
    v_sub_f32 v161, v161, v54
    v_sub_f32 v162, v162, v54
    v_sub_f32 v163, v163, v54
    v_sub_f32 v164, v164, v55
    v_sub_f32 v165, v165, v55
    v_sub_f32 v166, v166, v55
    v_sub_f32 v167, v167, v55
    v_sub_f32 v168, v168, v54
    v_sub_f32 v169, v169, v54
    v_sub_f32 v170, v170, v54
    v_sub_f32 v171, v171, v54
    v_sub_f32 v172, v172, v55
    v_sub_f32 v173, v173, v55
    v_sub_f32 v174, v174, v55
    v_sub_f32 v175, v175, v55
    v_sub_f32 v176, v176, v54
    v_sub_f32 v177, v177, v54
    v_sub_f32 v178, v178, v54
    v_sub_f32 v179, v179, v54
    v_sub_f32 v180, v180, v55
    v_sub_f32 v181, v181, v55
    v_sub_f32 v182, v182, v55
    v_sub_f32 v183, v183, v55
    v_sub_f32 v184, v184, v54
    v_sub_f32 v185, v185, v54
    v_sub_f32 v186, v186, v54
    v_sub_f32 v187, v187, v54
    v_sub_f32 v188, v188, v55
    v_sub_f32 v189, v189, v55
    v_sub_f32 v190, v190, v55
    v_sub_f32 v191, v191, v55
    v_sub_f32 v128, v128, v54
    v_sub_f32 v16, v16, v54
    v_sub_f32 v129, v129, v54
    v_sub_f32 v17, v17, v54
    v_sub_f32 v130, v130, v54
    v_sub_f32 v18, v18, v54
    v_sub_f32 v131, v131, v54
    v_sub_f32 v19, v19, v54
    v_sub_f32 v132, v132, v55
    v_sub_f32 v20, v20, v55
    v_sub_f32 v133, v133, v55
    v_sub_f32 v21, v21, v55
    v_sub_f32 v134, v134, v55
    v_sub_f32 v22, v22, v55
    v_sub_f32 v135, v135, v55
    v_sub_f32 v23, v23, v55
    v_sub_f32 v136, v136, v54
    v_sub_f32 v24, v24, v54
    v_sub_f32 v137, v137, v54
    v_sub_f32 v25, v25, v54
    v_sub_f32 v138, v138, v54
    v_sub_f32 v26, v26, v54
    v_sub_f32 v139, v139, v54
    v_sub_f32 v27, v27, v54
    v_sub_f32 v140, v140, v55
    v_sub_f32 v28, v28, v55
    v_sub_f32 v141, v141, v55
    v_sub_f32 v29, v29, v55
    v_sub_f32 v142, v142, v55
    v_sub_f32 v30, v30, v55
    v_sub_f32 v143, v143, v55
    v_sub_f32 v31, v31, v55
    v_sub_f32 v144, v144, v54
    v_sub_f32 v32, v32, v54
    v_sub_f32 v145, v145, v54
    v_sub_f32 v33, v33, v54
    v_sub_f32 v146, v146, v54
    v_sub_f32 v34, v34, v54
    v_sub_f32 v147, v147, v54
    v_sub_f32 v35, v35, v54
    v_sub_f32 v148, v148, v55
    v_sub_f32 v36, v36, v55
    v_sub_f32 v149, v149, v55
    v_sub_f32 v37, v37, v55
    v_sub_f32 v150, v150, v55
    v_sub_f32 v38, v38, v55
    v_sub_f32 v151, v151, v55
    v_sub_f32 v39, v39, v55
    v_sub_f32 v152, v152, v54
    v_sub_f32 v40, v40, v54
    v_sub_f32 v153, v153, v54
    v_sub_f32 v41, v41, v54
    v_sub_f32 v154, v154, v54
    v_sub_f32 v42, v42, v54
    v_sub_f32 v155, v155, v54
    v_sub_f32 v43, v43, v54
    v_sub_f32 v156, v156, v55
    v_sub_f32 v44, v44, v55
    v_sub_f32 v157, v157, v55
    v_sub_f32 v45, v45, v55
    v_sub_f32 v158, v158, v55
    v_sub_f32 v46, v46, v55
    v_sub_f32 v159, v159, v55
    v_sub_f32 v47, v47, v55
    v_sub_f32 v10, v10, v54
    v_exp_f32 v54, -v54
    v_sub_f32 v11, v11, v55
    v_exp_f32 v55, -v55
    s_nop 0
    v_mul_f32 v248, v248, v54
    v_mul_f32 v252, v252, v55
    v_accvgpr_read_b32 v224, a8
    v_accvgpr_read_b32 v225, a9
    v_accvgpr_read_b32 v226, a10
    v_accvgpr_read_b32 v227, a11
    v_mul_f32 v224, v224, v54
    v_mul_f32 v225, v225, v54
    v_mul_f32 v226, v226, v54
    v_mul_f32 v227, v227, v54
    v_accvgpr_write_b32 a8, v224
    v_accvgpr_write_b32 a9, v225
    v_accvgpr_write_b32 a10, v226
    v_accvgpr_write_b32 a11, v227
    v_accvgpr_read_b32 v224, a12
    v_accvgpr_read_b32 v225, a13
    v_accvgpr_read_b32 v226, a14
    v_accvgpr_read_b32 v227, a15
    v_mul_f32 v224, v224, v55
    v_mul_f32 v225, v225, v55
    v_mul_f32 v226, v226, v55
    v_mul_f32 v227, v227, v55
    v_accvgpr_write_b32 a12, v224
    v_accvgpr_write_b32 a13, v225
    v_accvgpr_write_b32 a14, v226
    v_accvgpr_write_b32 a15, v227
    v_accvgpr_read_b32 v224, a24
    v_accvgpr_read_b32 v225, a25
    v_accvgpr_read_b32 v226, a26
    v_accvgpr_read_b32 v227, a27
    v_mul_f32 v224, v224, v54
    v_mul_f32 v225, v225, v54
    v_mul_f32 v226, v226, v54
    v_mul_f32 v227, v227, v54
    v_accvgpr_write_b32 a24, v224
    v_accvgpr_write_b32 a25, v225
    v_accvgpr_write_b32 a26, v226
    v_accvgpr_write_b32 a27, v227
    v_accvgpr_read_b32 v224, a28
    v_accvgpr_read_b32 v225, a29
    v_accvgpr_read_b32 v226, a30
    v_accvgpr_read_b32 v227, a31
    v_mul_f32 v224, v224, v55
    v_mul_f32 v225, v225, v55
    v_mul_f32 v226, v226, v55
    v_mul_f32 v227, v227, v55
    v_accvgpr_write_b32 a28, v224
    v_accvgpr_write_b32 a29, v225
    v_accvgpr_write_b32 a30, v226
    v_accvgpr_write_b32 a31, v227
    v_accvgpr_read_b32 v224, a40
    v_accvgpr_read_b32 v225, a41
    v_accvgpr_read_b32 v226, a42
    v_accvgpr_read_b32 v227, a43
    v_mul_f32 v224, v224, v54
    v_mul_f32 v225, v225, v54
    v_mul_f32 v226, v226, v54
    v_mul_f32 v227, v227, v54
    v_accvgpr_write_b32 a40, v224
    v_accvgpr_write_b32 a41, v225
    v_accvgpr_write_b32 a42, v226
    v_accvgpr_write_b32 a43, v227
    v_accvgpr_read_b32 v224, a44
    v_accvgpr_read_b32 v225, a45
    v_accvgpr_read_b32 v226, a46
    v_accvgpr_read_b32 v227, a47
    v_mul_f32 v224, v224, v55
    v_mul_f32 v225, v225, v55
    v_mul_f32 v226, v226, v55
    v_mul_f32 v227, v227, v55
    v_accvgpr_write_b32 a44, v224
    v_accvgpr_write_b32 a45, v225
    v_accvgpr_write_b32 a46, v226
    v_accvgpr_write_b32 a47, v227
    v_accvgpr_read_b32 v224, a56
    v_accvgpr_read_b32 v225, a57
    v_accvgpr_read_b32 v226, a58
    v_accvgpr_read_b32 v227, a59
    v_mul_f32 v224, v224, v54
    v_mul_f32 v225, v225, v54
    v_mul_f32 v226, v226, v54
    v_mul_f32 v227, v227, v54
    v_accvgpr_write_b32 a56, v224
    v_accvgpr_write_b32 a57, v225
    v_accvgpr_write_b32 a58, v226
    v_accvgpr_write_b32 a59, v227
    v_accvgpr_read_b32 v224, a60
    v_accvgpr_read_b32 v225, a61
    v_accvgpr_read_b32 v226, a62
    v_accvgpr_read_b32 v227, a63
    v_mul_f32 v224, v224, v55
    v_mul_f32 v225, v225, v55
    v_mul_f32 v226, v226, v55
    v_mul_f32 v227, v227, v55
    v_accvgpr_write_b32 a60, v224
    v_accvgpr_write_b32 a61, v225
    v_accvgpr_write_b32 a62, v226
    v_accvgpr_write_b32 a63, v227
    v_accvgpr_read_b32 v224, a72
    v_accvgpr_read_b32 v225, a73
    v_accvgpr_read_b32 v226, a74
    v_accvgpr_read_b32 v227, a75
    v_mul_f32 v224, v224, v54
    v_mul_f32 v225, v225, v54
    v_mul_f32 v226, v226, v54
    v_mul_f32 v227, v227, v54
    v_accvgpr_write_b32 a72, v224
    v_accvgpr_write_b32 a73, v225
    v_accvgpr_write_b32 a74, v226
    v_accvgpr_write_b32 a75, v227
    v_accvgpr_read_b32 v224, a76
    v_accvgpr_read_b32 v225, a77
    v_accvgpr_read_b32 v226, a78
    v_accvgpr_read_b32 v227, a79
    v_mul_f32 v224, v224, v55
    v_mul_f32 v225, v225, v55
    v_mul_f32 v226, v226, v55
    v_mul_f32 v227, v227, v55
    v_accvgpr_write_b32 a76, v224
    v_accvgpr_write_b32 a77, v225
    v_accvgpr_write_b32 a78, v226
    v_accvgpr_write_b32 a79, v227
    v_accvgpr_read_b32 v224, a88
    v_accvgpr_read_b32 v225, a89
    v_accvgpr_read_b32 v226, a90
    v_accvgpr_read_b32 v227, a91
    v_mul_f32 v224, v224, v54
    v_mul_f32 v225, v225, v54
    v_mul_f32 v226, v226, v54
    v_mul_f32 v227, v227, v54
    v_accvgpr_write_b32 a88, v224
    v_accvgpr_write_b32 a89, v225
    v_accvgpr_write_b32 a90, v226
    v_accvgpr_write_b32 a91, v227
    v_accvgpr_read_b32 v224, a92
    v_accvgpr_read_b32 v225, a93
    v_accvgpr_read_b32 v226, a94
    v_accvgpr_read_b32 v227, a95
    v_mul_f32 v224, v224, v55
    v_mul_f32 v225, v225, v55
    v_mul_f32 v226, v226, v55
    v_mul_f32 v227, v227, v55
    v_accvgpr_write_b32 a92, v224
    v_accvgpr_write_b32 a93, v225
    v_accvgpr_write_b32 a94, v226
    v_accvgpr_write_b32 a95, v227
    v_accvgpr_read_b32 v224, a104
    v_accvgpr_read_b32 v225, a105
    v_accvgpr_read_b32 v226, a106
    v_accvgpr_read_b32 v227, a107
    v_mul_f32 v224, v224, v54
    v_mul_f32 v225, v225, v54
    v_mul_f32 v226, v226, v54
    v_mul_f32 v227, v227, v54
    v_accvgpr_write_b32 a104, v224
    v_accvgpr_write_b32 a105, v225
    v_accvgpr_write_b32 a106, v226
    v_accvgpr_write_b32 a107, v227
    v_accvgpr_read_b32 v224, a108
    v_accvgpr_read_b32 v225, a109
    v_accvgpr_read_b32 v226, a110
    v_accvgpr_read_b32 v227, a111
    v_mul_f32 v224, v224, v55
    v_mul_f32 v225, v225, v55
    v_mul_f32 v226, v226, v55
    v_mul_f32 v227, v227, v55
    v_accvgpr_write_b32 a108, v224
    v_accvgpr_write_b32 a109, v225
    v_accvgpr_write_b32 a110, v226
    v_accvgpr_write_b32 a111, v227
    v_accvgpr_read_b32 v224, a120
    v_accvgpr_read_b32 v225, a121
    v_accvgpr_read_b32 v226, a122
    v_accvgpr_read_b32 v227, a123
    v_mul_f32 v224, v224, v54
    v_mul_f32 v225, v225, v54
    v_mul_f32 v226, v226, v54
    v_mul_f32 v227, v227, v54
    v_accvgpr_write_b32 a120, v224
    v_accvgpr_write_b32 a121, v225
    v_accvgpr_write_b32 a122, v226
    v_accvgpr_write_b32 a123, v227
    v_accvgpr_read_b32 v224, a124
    v_accvgpr_read_b32 v225, a125
    v_accvgpr_read_b32 v226, a126
    v_accvgpr_read_b32 v227, a127
    v_mul_f32 v224, v224, v55
    v_mul_f32 v225, v225, v55
    v_mul_f32 v226, v226, v55
    v_mul_f32 v227, v227, v55
    v_accvgpr_write_b32 a124, v224
    v_accvgpr_write_b32 a125, v225
    v_accvgpr_write_b32 a126, v226
    v_accvgpr_write_b32 a127, v227
    v_exp_f32 v232, v160
    v_exp_f32 v233, v161
    v_exp_f32 v234, v162
    v_exp_f32 v235, v163
    s_nop 0
    v_cvt_pk_bf16_f32 v208, v232, v233
    v_cvt_pk_bf16_f32 v209, v234, v235
    v_exp_f32 v232, v176
    v_exp_f32 v233, v177
    v_exp_f32 v234, v178
    v_exp_f32 v235, v179
    s_nop 0
    v_cvt_pk_bf16_f32 v210, v232, v233
    v_cvt_pk_bf16_f32 v211, v234, v235
    v_exp_f32 v232, v164
    v_exp_f32 v233, v165
    v_exp_f32 v234, v166
    v_exp_f32 v235, v167
    s_nop 0
    v_cvt_pk_bf16_f32 v212, v232, v233
    v_cvt_pk_bf16_f32 v213, v234, v235
    v_exp_f32 v232, v180
    v_exp_f32 v233, v181
    v_exp_f32 v234, v182
    v_exp_f32 v235, v183
    s_nop 0
    v_cvt_pk_bf16_f32 v214, v232, v233
    v_cvt_pk_bf16_f32 v215, v234, v235
    v_exp_f32 v232, v168
    v_exp_f32 v233, v169
    v_exp_f32 v234, v170
    v_exp_f32 v235, v171
    s_nop 0
    v_cvt_pk_bf16_f32 v216, v232, v233
    v_cvt_pk_bf16_f32 v217, v234, v235
    v_exp_f32 v232, v184
    v_exp_f32 v233, v185
    v_exp_f32 v234, v186
    v_exp_f32 v235, v187
    s_nop 0
    v_cvt_pk_bf16_f32 v218, v232, v233
    v_cvt_pk_bf16_f32 v219, v234, v235
    v_exp_f32 v232, v172
    v_exp_f32 v233, v173
    v_exp_f32 v234, v174
    v_exp_f32 v235, v175
    s_nop 0
    v_cvt_pk_bf16_f32 v220, v232, v233
    v_cvt_pk_bf16_f32 v221, v234, v235
    v_exp_f32 v232, v188
    v_exp_f32 v233, v189
    v_exp_f32 v234, v190
    v_exp_f32 v235, v191
    s_nop 0
    v_cvt_pk_bf16_f32 v222, v232, v233
    v_cvt_pk_bf16_f32 v223, v234, v235
    s_nop 3
    s_setpc_b64 s[40:41]
k2_rare_171:
    s_nop 7
    v_max_f32 v55, v164, v165
    v_max3_f32 v55, v55, v166, v167
    v_max3_f32 v55, v55, v180, v181
    v_max3_f32 v55, v55, v182, v183
    v_max3_f32 v55, v55, v172, v173
    v_max3_f32 v55, v55, v174, v175
    v_max3_f32 v55, v55, v188, v189
    v_max3_f32 v55, v55, v190, v191
    v_mov_b32 v227, v55
    s_nop 1
    v_permlane16_swap_b32 v55, v227
    s_nop 1
    v_max_f32 v55, v55, v227
    v_mov_b32 v227, v55
    s_nop 1
    v_permlane32_swap_b32 v55, v227
    s_nop 1
    v_max_f32 v55, v55, v227
    v_add_f32 v55, 0x41400000, v55
    v_max_f32 v55, 0, v55
    v_sub_f32 v164, v164, v55
    v_sub_f32 v165, v165, v55
    v_sub_f32 v166, v166, v55
    v_sub_f32 v167, v167, v55
    v_sub_f32 v172, v172, v55
    v_sub_f32 v173, v173, v55
    v_sub_f32 v174, v174, v55
    v_sub_f32 v175, v175, v55
    v_sub_f32 v180, v180, v55
    v_sub_f32 v181, v181, v55
    v_sub_f32 v182, v182, v55
    v_sub_f32 v183, v183, v55
    v_sub_f32 v188, v188, v55
    v_sub_f32 v189, v189, v55
    v_sub_f32 v190, v190, v55
    v_sub_f32 v191, v191, v55
    v_sub_f32 v11, v11, v55
    v_exp_f32 v55, -v55
    s_nop 0
    v_mul_f32 v252, v252, v55
    v_accvgpr_read_b32 v224, a12
    v_accvgpr_read_b32 v225, a13
    v_accvgpr_read_b32 v226, a14
    v_accvgpr_read_b32 v227, a15
    v_mul_f32 v224, v224, v55
    v_mul_f32 v225, v225, v55
    v_mul_f32 v226, v226, v55
    v_mul_f32 v227, v227, v55
    v_accvgpr_write_b32 a12, v224
    v_accvgpr_write_b32 a13, v225
    v_accvgpr_write_b32 a14, v226
    v_accvgpr_write_b32 a15, v227
    v_accvgpr_read_b32 v224, a28
    v_accvgpr_read_b32 v225, a29
    v_accvgpr_read_b32 v226, a30
    v_accvgpr_read_b32 v227, a31
    v_mul_f32 v224, v224, v55
    v_mul_f32 v225, v225, v55
    v_mul_f32 v226, v226, v55
    v_mul_f32 v227, v227, v55
    v_accvgpr_write_b32 a28, v224
    v_accvgpr_write_b32 a29, v225
    v_accvgpr_write_b32 a30, v226
    v_accvgpr_write_b32 a31, v227
    v_accvgpr_read_b32 v224, a44
    v_accvgpr_read_b32 v225, a45
    v_accvgpr_read_b32 v226, a46
    v_accvgpr_read_b32 v227, a47
    v_mul_f32 v224, v224, v55
    v_mul_f32 v225, v225, v55
    v_mul_f32 v226, v226, v55
    v_mul_f32 v227, v227, v55
    v_accvgpr_write_b32 a44, v224
    v_accvgpr_write_b32 a45, v225
    v_accvgpr_write_b32 a46, v226
    v_accvgpr_write_b32 a47, v227
    v_accvgpr_read_b32 v224, a60
    v_accvgpr_read_b32 v225, a61
    v_accvgpr_read_b32 v226, a62
    v_accvgpr_read_b32 v227, a63
    v_mul_f32 v224, v224, v55
    v_mul_f32 v225, v225, v55
    v_mul_f32 v226, v226, v55
    v_mul_f32 v227, v227, v55
    v_accvgpr_write_b32 a60, v224
    v_accvgpr_write_b32 a61, v225
    v_accvgpr_write_b32 a62, v226
    v_accvgpr_write_b32 a63, v227
    v_accvgpr_read_b32 v224, a76
    v_accvgpr_read_b32 v225, a77
    v_accvgpr_read_b32 v226, a78
    v_accvgpr_read_b32 v227, a79
    v_mul_f32 v224, v224, v55
    v_mul_f32 v225, v225, v55
    v_mul_f32 v226, v226, v55
    v_mul_f32 v227, v227, v55
    v_accvgpr_write_b32 a76, v224
    v_accvgpr_write_b32 a77, v225
    v_accvgpr_write_b32 a78, v226
    v_accvgpr_write_b32 a79, v227
    v_accvgpr_read_b32 v224, a92
    v_accvgpr_read_b32 v225, a93
    v_accvgpr_read_b32 v226, a94
    v_accvgpr_read_b32 v227, a95
    v_mul_f32 v224, v224, v55
    v_mul_f32 v225, v225, v55
    v_mul_f32 v226, v226, v55
    v_mul_f32 v227, v227, v55
    v_accvgpr_write_b32 a92, v224
    v_accvgpr_write_b32 a93, v225
    v_accvgpr_write_b32 a94, v226
    v_accvgpr_write_b32 a95, v227
    v_accvgpr_read_b32 v224, a108
    v_accvgpr_read_b32 v225, a109
    v_accvgpr_read_b32 v226, a110
    v_accvgpr_read_b32 v227, a111
    v_mul_f32 v224, v224, v55
    v_mul_f32 v225, v225, v55
    v_mul_f32 v226, v226, v55
    v_mul_f32 v227, v227, v55
    v_accvgpr_write_b32 a108, v224
    v_accvgpr_write_b32 a109, v225
    v_accvgpr_write_b32 a110, v226
    v_accvgpr_write_b32 a111, v227
    v_accvgpr_read_b32 v224, a124
    v_accvgpr_read_b32 v225, a125
    v_accvgpr_read_b32 v226, a126
    v_accvgpr_read_b32 v227, a127
    v_mul_f32 v224, v224, v55
    v_mul_f32 v225, v225, v55
    v_mul_f32 v226, v226, v55
    v_mul_f32 v227, v227, v55
    v_accvgpr_write_b32 a124, v224
    v_accvgpr_write_b32 a125, v225
    v_accvgpr_write_b32 a126, v226
    v_accvgpr_write_b32 a127, v227
    v_exp_f32 v232, v164
    v_exp_f32 v233, v165
    v_exp_f32 v234, v166
    v_exp_f32 v235, v167
    s_nop 0
    v_cvt_pk_bf16_f32 v212, v232, v233
    v_cvt_pk_bf16_f32 v213, v234, v235
    v_exp_f32 v232, v180
    v_exp_f32 v233, v181
    v_exp_f32 v234, v182
    v_exp_f32 v235, v183
    s_nop 0
    v_cvt_pk_bf16_f32 v214, v232, v233
    v_cvt_pk_bf16_f32 v215, v234, v235
    v_exp_f32 v232, v172
    v_exp_f32 v233, v173
    v_exp_f32 v234, v174
    v_exp_f32 v235, v175
    s_nop 0
    v_cvt_pk_bf16_f32 v220, v232, v233
    v_cvt_pk_bf16_f32 v221, v234, v235
    v_exp_f32 v232, v188
    v_exp_f32 v233, v189
    v_exp_f32 v234, v190
    v_exp_f32 v235, v191
    s_nop 0
    v_cvt_pk_bf16_f32 v222, v232, v233
    v_cvt_pk_bf16_f32 v223, v234, v235
    s_nop 3
    s_setpc_b64 s[40:41]
code_end:
    s_endpgm
.section .rodata,"a"
.p2align 6
.amdhsa_kernel sequential_preLN__compressed_kv_cla__moe_arch_mod__prompt_kernel
  .amdhsa_next_free_vgpr 512
  .amdhsa_next_free_sgpr 102
  .amdhsa_accum_offset 256
  .amdhsa_group_segment_fixed_size 0
  .amdhsa_kernarg_size 112
  .amdhsa_user_sgpr_count 2
  .amdhsa_user_sgpr_kernarg_segment_ptr 1
  .amdhsa_system_sgpr_workgroup_id_x 1
.end_amdhsa_kernel
```

```asm
; @launch grid=(256,1,1) block=(256,1,1) lds=163840
.amdgcn_target "amdgcn-amd-amdhsa--gfx950"
.text
.globl sequential_preLN__compressed_kv_cla__moe_arch_mod__prompt_kernel
.p2align 8
.type sequential_preLN__compressed_kv_cla__moe_arch_mod__prompt_kernel,@function
sequential_preLN__compressed_kv_cla__moe_arch_mod__prompt_kernel:
    s_cmp_ge_u32 s2, 256
    s_cbranch_scc1 k12_end_1
    s_load_dwordx4 s[36:39], s[0:1], 0
    s_load_dwordx4 s[40:43], s[0:1], 24
    s_load_dwordx2 s[4:5], s[0:1], 16
    s_load_dwordx4 s[60:63], s[0:1], 96
    s_lshr_b32 s59, s2, 3
    s_lshl_b32 s58, s59, 4
    v_add_u32 v6, s58, v0
    v_cmp_gt_u32 vcc, 48, v0
    v_cmp_gt_u32 s[56:57], 64, v0
    s_nop 0
    v_cndmask_b32 v6, v6, v0, vcc
    s_getpc_b64 s[52:53]
pc_2:
    s_add_u32 s52, s52, k12_code0-pc_2
    s_addc_u32 s53, s53, 0
    v_lshlrev_b32 v58, 7, v6
    v_mov_b32 v59, s53
    v_add_co_u32 v58, vcc, s52, v58
    s_nop 1
    v_addc_co_u32 v59, vcc, 0, v59, vcc
k12_code0:
    s_mov_b64 exec, s[56:57]
    s_cbranch_execz k12_nocode_3
    global_load_dword v51, v[58:59], off
k12_nocode_3:
    s_mov_b64 exec, -1
    s_and_b32 s58, s2, 7
    s_lshr_b32 s59, s2, 3
    s_and_b32 s45, s59, 7
    s_lshr_b32 s57, s59, 3
    s_and_b32 s44, s57, 1
    s_lshl_b32 s52, s58, 1
    s_add_u32 s44, s44, s52
    s_lshr_b32 s57, s57, 1
    v_lshrrev_b32 v2, 6, v0
    v_and_b32 v3, 63, v0
    v_readfirstlane_b32 s30, v2
    v_lshlrev_b32 v1, 4, v3
    v_lshrrev_b32 v60, 5, v3
    v_lshl_add_u32 v60, v2, 1, v60
    v_and_b32 v61, 31, v3
    v_lshlrev_b32 v6, 11, v60
    v_lshl_add_u32 v62, v61, 4, v6
    s_lshl_b32 s52, s2, 14
    v_lshrrev_b32 v56, 3, v3
    v_and_b32 v57, 7, v3
    v_lshrrev_b32 v58, 1, v56
    v_xor_b32 v6, v57, v58
    v_xor_b32 v7, 4, v6
    v_lshl_add_u32 v58, v2, 6, v56
    v_lshlrev_b32 v58, 10, v58
    s_lshl_b32 s47, s45, 18
    v_add_u32 v58, s47, v58
    v_lshl_add_u32 v10, v6, 4, v58
    v_lshl_add_u32 v11, v7, 4, v58
    v_add_u32 v17, 54272, v11
    v_add_u32 v16, 47104, v10
    v_add_u32 v15, 39936, v11
    v_add_u32 v14, 32768, v10
    v_add_u32 v13, 21504, v11
    v_add_u32 v12, 14336, v10
    v_add_u32 v11, 7168, v11
    v_add_u32 v10, 0, v10
    v_lshrrev_b32 v6, 5, v3
    v_bfe_u32 v7, v3, 1, 4
    v_and_b32 v59, 1, v3
    v_lshl_add_u32 v58, v2, 4, v6
    v_lshlrev_b32 v58, 13, v58
    v_lshl_add_u32 v58, v59, 4, v58
    s_lshl_b32 s47, s44, 9
    v_add_u32 v58, s47, v58
    v_xor_b32 v7, v7, v6
    v_xor_b32 v6, 0, v7
    v_lshl_add_u32 v6, v6, 5, v58
    v_add_u32 v18, 0, v6
    v_xor_b32 v6, 2, v7
    v_lshl_add_u32 v6, v6, 5, v58
    v_add_u32 v19, 15360, v6
    v_xor_b32 v6, 0, v7
    v_lshl_add_u32 v6, v6, 5, v58
    v_add_u32 v20, 30720, v6
    v_xor_b32 v6, 2, v7
    v_lshl_add_u32 v6, v6, 5, v58
    v_add_u32 v21, 46080, v6
    v_xor_b32 v6, 4, v7
    v_lshl_add_u32 v6, v6, 5, v58
    v_add_u32 v22, 65536, v6
    v_xor_b32 v6, 6, v7
    v_lshl_add_u32 v6, v6, 5, v58
    v_add_u32 v23, 80896, v6
    v_xor_b32 v6, 4, v7
    v_lshl_add_u32 v6, v6, 5, v58
    v_add_u32 v24, 96256, v6
    v_xor_b32 v6, 6, v7
    v_lshl_add_u32 v6, v6, 5, v58
    v_add_u32 v25, 111616, v6
    s_lshl_b32 s48, s30, 13
    s_mov_b32 s49, 0
    s_mov_b32 s50, 0
    s_waitcnt lgkmcnt(0)
    s_mov_b32 s24, s36
    s_and_b32 s25, s37, 0xffff
    s_mov_b32 s26, 0x400000
    s_mov_b32 s27, 0x00020000
    s_mov_b32 s16, s38
    s_and_b32 s17, s39, 0xffff
    s_mov_b32 s18, 0x200000
    s_mov_b32 s19, 0x00020000
    s_cmp_eq_u32 s57, 0
    s_cselect_b32 s20, s40, s42
    s_cselect_b32 s21, s41, s43
    s_and_b32 s21, s21, 0xffff
    s_mov_b32 s22, 0x400000
    s_mov_b32 s23, 0x00020000
    v_lshlrev_b32 v6, 17, v1
    s_mov_b64 exec, 1
    buffer_load_dword v51, v62, s[24:27], s52 offen
    global_load_dword v51, v6, s[60:61]
    buffer_load_dword v51, v6, s[20:23], 0 offen
    global_load_dword v51, v6, s[62:63]
    global_load_dword v51, v6, s[4:5]
    s_mov_b64 exec, -1
    s_add_u32 m0, s48, 0
    s_nop 0
    buffer_load_dwordx4 v10, s[16:19], s49 offen offset:0 lds
    buffer_load_dwordx4 v11, s[16:19], s49 offen offset:1024 lds
    buffer_load_dwordx4 v12, s[16:19], s49 offen offset:2048 lds
    buffer_load_dwordx4 v13, s[16:19], s49 offen offset:3072 lds
    buffer_load_dwordx4 v[64:67], v62, s[24:27], s52 offen offset:0
    buffer_load_dwordx4 v[68:71], v62, s[24:27], s52 offen offset:512
    buffer_load_dwordx4 v[72:75], v62, s[24:27], s52 offen offset:1024
    buffer_load_dwordx4 v[76:79], v62, s[24:27], s52 offen offset:1536
    s_add_u32 m0, s48, 65536
    s_nop 0
    buffer_load_dwordx4 v18, s[20:23], s50 offen offset:0 lds
    buffer_load_dwordx4 v19, s[20:23], s50 offen offset:1024 lds
    buffer_load_dwordx4 v20, s[20:23], s50 offen offset:2048 lds
    buffer_load_dwordx4 v21, s[20:23], s50 offen offset:3072 lds
    s_mov_b64 s[6:7], s[62:63]
    s_add_u32 s8, s6, 0x0
    s_addc_u32 s9, s7, 0
    s_and_b32 s9, s9, 0xffff
    s_mov_b32 s10, 0x400000
    s_mov_b32 s11, 0x00020000
    s_mov_b32 s12, s4
    s_and_b32 s13, s5, 0xffff
    s_mov_b32 s14, 0x800000
    s_mov_b32 s15, 0x00020000
    s_add_u32 s32, s6, 0x1000000
    s_addc_u32 s33, s7, 0
    s_and_b32 s33, s33, 0xffff
    s_mov_b32 s34, 0x2000000
    s_mov_b32 s35, 0x00020000
    s_mov_b32 s24, s60
    s_and_b32 s25, s61, 0xffff
    s_mov_b32 s26, 0x100
    s_mov_b32 s27, 0x00020000
    s_lshl_b32 s28, s58, 2
    s_and_b32 s31, s59, 3
    s_add_u32 s28, s28, s31
    s_lshr_b32 s29, s59, 2
    s_lshl_b32 s42, s29, 7
    s_sub_u32 s43, 1920, s42
    s_lshl_b32 s31, s30, 4
    s_add_u32 s38, s42, s31
    s_add_u32 s39, s43, s31
    s_lshl_b32 s60, s30, 12
    s_mov_b32 s61, 0
    s_mov_b32 s62, 0
    s_lshl_b32 s47, s44, 1
    s_lshr_b32 s52, s30, 1
    s_add_u32 s47, s47, s52
    s_lshl_b32 s47, s47, 14
    s_lshl_b32 s52, s45, 1
    s_and_b32 s53, s30, 1
    s_add_u32 s52, s52, s53
    s_lshl_b32 s52, s52, 20
    s_add_u32 s47, s47, s52
    s_lshl_b32 s52, s57, 24
    s_add_u32 s47, s47, s52
    s_lshl_b32 s54, s44, 8
    s_lshr_b32 s55, s28, 1
    s_lshl_b32 s55, s55, 8
    s_and_b32 s53, s59, 3
    s_add_u32 s53, s53, 1
    s_cmp_eq_u32 s30, 0
    s_cselect_b32 s53, s53, -1
    s_cselect_b32 s46, 6, -1
    v_lshlrev_b32 v6, 13, v56
    v_lshl_add_u32 v50, v57, 7, v6
    s_lshl_b32 s56, s30, 5
    s_add_u32 s56, s56, s59
    s_lshl_b32 s56, s56, 16
    s_lshl_b32 s52, s58, 10
    s_add_u32 s56, s56, s52
    s_add_u32 s63, s30, 1
    v_mul_u32_u24 v6, 2064, v60
    v_lshl_add_u32 v6, v61, 4, v6
    v_add_u32 v54, 131072, v6
    v_mul_u32_u24 v7, 2064, v57
    v_lshl_add_u32 v7, v56, 4, v7
    v_lshl_add_u32 v7, v2, 9, v7
    v_add_u32 v55, 131072, v7
    v_lshrrev_b32 v7, 2, v56
    v_lshl_add_u32 v7, v2, 3, v7
    v_lshlrev_b32 v7, 17, v7
    v_and_b32 v6, 3, v56
    v_lshl_add_u32 v7, v6, 8, v7
    v_lshl_add_u32 v7, v57, 4, v7
    s_lshr_b32 s52, s2, 1
    s_lshl_b32 s52, s52, 10
    s_and_b32 s31, s2, 1
    s_lshl_b32 s31, s31, 7
    s_add_u32 s52, s52, s31
    v_add_u32 v53, s52, v7
    v_and_b32 v56, 15, v3
    v_lshrrev_b32 v57, 4, v3
    v_lshrrev_b32 v6, 1, v56
    v_xor_b32 v6, v6, v57
    v_and_b32 v7, 1, v2
    v_lshl_add_u32 v7, v7, 7, v56
    v_lshlrev_b32 v7, 7, v7
    v_lshl_add_u32 v26, v6, 4, v7
    v_xor_b32 v27, 64, v26
    v_lshrrev_b32 v6, 2, v56
    v_and_b32 v58, 1, v57
    v_lshl_add_u32 v58, v58, 2, v6
    v_lshl_add_u32 v59, v57, 3, v6
    v_and_b32 v63, 3, v3
    v_lshlrev_b32 v7, 9, v59
    v_lshrrev_b32 v6, 1, v2
    v_lshl_add_u32 v7, v6, 8, v7
    v_lshl_add_u32 v7, v63, 3, v7
    v_add_u32 v7, 65536, v7
    v_lshlrev_b32 v59, 8, v59
    v_lshl_add_u32 v59, v63, 3, v59
    v_add_u32 v59, 98304, v59
    v_xor_b32 v6, 0, v58
    v_lshl_add_u32 v28, v6, 5, v7
    v_lshl_add_u32 v42, v6, 5, v59
    v_xor_b32 v6, 1, v58
    v_lshl_add_u32 v29, v6, 5, v7
    v_lshl_add_u32 v43, v6, 5, v59
    v_xor_b32 v6, 2, v58
    v_lshl_add_u32 v30, v6, 5, v7
    v_lshl_add_u32 v44, v6, 5, v59
    v_xor_b32 v6, 3, v58
    v_lshl_add_u32 v31, v6, 5, v7
    v_lshl_add_u32 v45, v6, 5, v59
    v_xor_b32 v6, 4, v58
    v_lshl_add_u32 v32, v6, 5, v7
    v_lshl_add_u32 v46, v6, 5, v59
    v_xor_b32 v6, 5, v58
    v_lshl_add_u32 v33, v6, 5, v7
    v_lshl_add_u32 v47, v6, 5, v59
    v_xor_b32 v6, 6, v58
    v_lshl_add_u32 v34, v6, 5, v7
    v_lshl_add_u32 v48, v6, 5, v59
    v_xor_b32 v6, 7, v58
    v_lshl_add_u32 v35, v6, 5, v7
    v_lshl_add_u32 v49, v6, 5, v59
    s_lshl_b32 s31, s38, 6
    v_add_u32 v36, s31, v1
    s_lshl_b32 s31, s39, 6
    v_add_u32 v37, s31, v1
    v_bfe_u32 v6, v3, 1, 3
    v_and_b32 v7, 1, v3
    v_lshl_add_u32 v58, v2, 4, v57
    v_lshlrev_b32 v58, 13, v58
    v_lshl_add_u32 v58, v7, 4, v58
    s_lshl_b32 s31, s28, 8
    v_add_u32 v58, s31, v58
    v_xor_b32 v6, v6, v57
    v_xor_b32 v7, 0, v6
    v_lshl_add_u32 v7, v7, 5, v58
    v_add_u32 v38, 0, v7
    v_xor_b32 v7, 0, v6
    v_lshl_add_u32 v7, v7, 5, v58
    v_add_u32 v39, 31744, v7
    v_xor_b32 v7, 4, v6
    v_lshl_add_u32 v7, v7, 5, v58
    v_add_u32 v40, 63488, v7
    v_xor_b32 v7, 4, v6
    v_lshl_add_u32 v7, v7, 5, v58
    v_add_u32 v41, 95232, v7
    v_lshlrev_b32 v6, 2, v57
    v_sub_u32 v4, v56, v6
    v_mov_b32 v5, 0xff800000
    v_mov_b32 v8, 0
    v_mov_b32 v9, 1
    s_lshl_b32 s52, s59, 2
    s_add_u32 s52, s52, s30
    v_and_b32 v6, 1, v3
    v_lshl_add_u32 v6, s52, 1, v6
    s_getpc_b64 s[40:41]
pc_4:
    s_add_u32 s40, s40, k12_qcode-pc_4
    s_addc_u32 s41, s41, 0
    v_lshlrev_b32 v2, 7, v6
    v_mov_b32 v3, s41
    v_add_co_u32 v2, vcc, s40, v2
    s_nop 1
    v_addc_co_u32 v3, vcc, 0, v3, vcc
    v_mov_b32 v56, 0
    v_mov_b32 v57, 0
    v_mov_b32 v58, 0
    v_mov_b32 v59, 0
    s_nop 1
    v_mfma_f32_32x32x16_bf16 a[128:143], v[56:59], v[56:59], 0
    v_mfma_f32_32x32x16_bf16 a[144:159], v[56:59], v[56:59], 0
    v_mfma_f32_32x32x16_bf16 a[160:175], v[56:59], v[56:59], 0
    v_mfma_f32_32x32x16_bf16 a[176:191], v[56:59], v[56:59], 0
    v_mfma_f32_32x32x16_bf16 v[128:143], v[56:59], v[56:59], 0
    v_mfma_f32_32x32x16_bf16 v[144:159], v[56:59], v[56:59], 0
    v_mfma_f32_32x32x16_bf16 v[160:175], v[56:59], v[56:59], 0
    v_mfma_f32_32x32x16_bf16 v[176:191], v[56:59], v[56:59], 0
    v_mfma_f32_32x32x16_bf16 v[192:207], v[56:59], v[56:59], 0
    v_mfma_f32_32x32x16_bf16 v[208:223], v[56:59], v[56:59], 0
    v_mfma_f32_32x32x16_bf16 v[224:239], v[56:59], v[56:59], 0
    v_mfma_f32_32x32x16_bf16 v[240:255], v[56:59], v[56:59], 0
    s_add_u32 m0, s48, 4096
    s_nop 0
    buffer_load_dwordx4 v14, s[16:19], s49 offen offset:0 lds
    buffer_load_dwordx4 v15, s[16:19], s49 offen offset:1024 lds
    buffer_load_dwordx4 v16, s[16:19], s49 offen offset:2048 lds
    buffer_load_dwordx4 v17, s[16:19], s49 offen offset:3072 lds
    s_add_u32 s49, s49, 128
    s_add_u32 m0, s48, 69632
    s_nop 0
    buffer_load_dwordx4 v22, s[20:23], s50 offen offset:0 lds
    buffer_load_dwordx4 v23, s[20:23], s50 offen offset:1024 lds
    buffer_load_dwordx4 v24, s[20:23], s50 offen offset:2048 lds
    buffer_load_dwordx4 v25, s[20:23], s50 offen offset:3072 lds
    s_add_u32 s50, s50, 0x80000
    s_waitcnt vmcnt(12)
    v_lshlrev_b32 v80, 16, v64
    v_and_b32 v81, 0xffff0000, v64
    v_lshlrev_b32 v82, 16, v65
    v_and_b32 v83, 0xffff0000, v65
    v_lshlrev_b32 v84, 16, v66
    v_and_b32 v85, 0xffff0000, v66
    v_lshlrev_b32 v86, 16, v67
    v_and_b32 v87, 0xffff0000, v67
    v_lshlrev_b32 v88, 16, v68
    v_and_b32 v89, 0xffff0000, v68
    v_lshlrev_b32 v90, 16, v69
    v_and_b32 v91, 0xffff0000, v69
    v_lshlrev_b32 v92, 16, v70
    v_and_b32 v93, 0xffff0000, v70
    v_lshlrev_b32 v94, 16, v71
    v_and_b32 v95, 0xffff0000, v71
    v_lshlrev_b32 v96, 16, v72
    v_and_b32 v97, 0xffff0000, v72
    v_lshlrev_b32 v98, 16, v73
    v_and_b32 v99, 0xffff0000, v73
    v_lshlrev_b32 v100, 16, v74
    v_and_b32 v101, 0xffff0000, v74
    v_lshlrev_b32 v102, 16, v75
    v_and_b32 v103, 0xffff0000, v75
    v_lshlrev_b32 v104, 16, v76
    v_and_b32 v105, 0xffff0000, v76
    v_lshlrev_b32 v106, 16, v77
    v_and_b32 v107, 0xffff0000, v77
    v_lshlrev_b32 v108, 16, v78
    v_and_b32 v109, 0xffff0000, v78
    v_lshlrev_b32 v110, 16, v79
    v_and_b32 v111, 0xffff0000, v79
    v_pk_add_f32 v[112:113], v[80:81], v[82:83]
    v_pk_add_f32 v[114:115], v[84:85], v[86:87]
    v_pk_add_f32 v[112:113], v[112:113], v[88:89]
    v_pk_add_f32 v[114:115], v[114:115], v[90:91]
    v_pk_add_f32 v[112:113], v[112:113], v[92:93]
    v_pk_add_f32 v[114:115], v[114:115], v[94:95]
    v_pk_add_f32 v[112:113], v[112:113], v[96:97]
    v_pk_add_f32 v[114:115], v[114:115], v[98:99]
    v_pk_add_f32 v[112:113], v[112:113], v[100:101]
    v_pk_add_f32 v[114:115], v[114:115], v[102:103]
    v_pk_add_f32 v[112:113], v[112:113], v[104:105]
    v_pk_add_f32 v[114:115], v[114:115], v[106:107]
    s_add_u32 m0, s48, 32768
    s_nop 0
    buffer_load_dwordx4 v10, s[16:19], s49 offen offset:0 lds
    buffer_load_dwordx4 v11, s[16:19], s49 offen offset:1024 lds
    buffer_load_dwordx4 v12, s[16:19], s49 offen offset:2048 lds
    buffer_load_dwordx4 v13, s[16:19], s49 offen offset:3072 lds
    v_pk_add_f32 v[112:113], v[112:113], v[108:109]
    v_pk_add_f32 v[114:115], v[114:115], v[110:111]
    v_pk_add_f32 v[112:113], v[112:113], v[114:115]
    v_add_f32 v112, v112, v113
    s_nop 1
    v_add_f32_dpp v112, v112, v112 quad_perm:[1,0,3,2] row_mask:0xf bank_mask:0xf
    s_nop 1
    v_add_f32_dpp v112, v112, v112 quad_perm:[2,3,0,1] row_mask:0xf bank_mask:0xf
    s_nop 1
    v_add_f32_dpp v112, v112, v112 row_half_mirror row_mask:0xf bank_mask:0xf
    s_nop 1
    v_add_f32_dpp v112, v112, v112 row_mirror row_mask:0xf bank_mask:0xf
    v_mov_b32 v114, v112
    s_nop 1
    v_permlane16_swap_b32 v112, v114
    s_nop 1
    v_add_f32 v112, v112, v114
    v_mul_f32 v112, 0xba800000, v112
    v_mov_b32 v113, v112
    v_pk_add_f32 v[114:115], v[80:81], v[112:113]
    v_pk_add_f32 v[118:119], v[82:83], v[112:113]
    v_pk_mul_f32 v[116:117], v[114:115], v[114:115]
    v_pk_fma_f32 v[116:117], v[118:119], v[118:119], v[116:117]
    v_pk_add_f32 v[114:115], v[84:85], v[112:113]
    v_pk_add_f32 v[118:119], v[86:87], v[112:113]
    v_pk_fma_f32 v[116:117], v[114:115], v[114:115], v[116:117]
    v_pk_fma_f32 v[116:117], v[118:119], v[118:119], v[116:117]
    v_pk_add_f32 v[114:115], v[88:89], v[112:113]
    v_pk_add_f32 v[118:119], v[90:91], v[112:113]
    v_pk_fma_f32 v[116:117], v[114:115], v[114:115], v[116:117]
    v_pk_fma_f32 v[116:117], v[118:119], v[118:119], v[116:117]
    v_pk_add_f32 v[114:115], v[92:93], v[112:113]
    v_pk_add_f32 v[118:119], v[94:95], v[112:113]
    v_pk_fma_f32 v[116:117], v[114:115], v[114:115], v[116:117]
    v_pk_fma_f32 v[116:117], v[118:119], v[118:119], v[116:117]
    v_pk_add_f32 v[114:115], v[96:97], v[112:113]
    v_pk_add_f32 v[118:119], v[98:99], v[112:113]
    v_pk_fma_f32 v[116:117], v[114:115], v[114:115], v[116:117]
    v_pk_fma_f32 v[116:117], v[118:119], v[118:119], v[116:117]
    v_pk_add_f32 v[114:115], v[100:101], v[112:113]
    v_pk_add_f32 v[118:119], v[102:103], v[112:113]
    v_pk_fma_f32 v[116:117], v[114:115], v[114:115], v[116:117]
    v_pk_fma_f32 v[116:117], v[118:119], v[118:119], v[116:117]
    v_pk_add_f32 v[114:115], v[104:105], v[112:113]
    s_add_u32 m0, s48, 98304
    s_nop 0
    buffer_load_dwordx4 v18, s[20:23], s50 offen offset:0 lds
    buffer_load_dwordx4 v19, s[20:23], s50 offen offset:1024 lds
    buffer_load_dwordx4 v20, s[20:23], s50 offen offset:2048 lds
    buffer_load_dwordx4 v21, s[20:23], s50 offen offset:3072 lds
    v_pk_add_f32 v[118:119], v[106:107], v[112:113]
    v_pk_fma_f32 v[116:117], v[114:115], v[114:115], v[116:117]
    v_pk_fma_f32 v[116:117], v[118:119], v[118:119], v[116:117]
    v_pk_add_f32 v[114:115], v[108:109], v[112:113]
    v_pk_add_f32 v[118:119], v[110:111], v[112:113]
    v_pk_fma_f32 v[116:117], v[114:115], v[114:115], v[116:117]
    v_pk_fma_f32 v[116:117], v[118:119], v[118:119], v[116:117]
    v_add_f32 v116, v116, v117
    s_nop 1
    v_add_f32_dpp v116, v116, v116 quad_perm:[1,0,3,2] row_mask:0xf bank_mask:0xf
    s_nop 1
    v_add_f32_dpp v116, v116, v116 quad_perm:[2,3,0,1] row_mask:0xf bank_mask:0xf
    s_nop 1
    v_add_f32_dpp v116, v116, v116 row_half_mirror row_mask:0xf bank_mask:0xf
    s_nop 1
    v_add_f32_dpp v116, v116, v116 row_mirror row_mask:0xf bank_mask:0xf
    v_mov_b32 v114, v116
    s_nop 1
    v_permlane16_swap_b32 v116, v114
    s_nop 1
    v_add_f32 v116, v116, v114
    v_mul_f32 v116, 0x3a800000, v116
    v_cvt_pk_bf16_f32 v118, v112, v116
    v_and_b32 v116, 0xffff0000, v118
    v_lshlrev_b32 v118, 16, v118
    v_add_f32 v116, 0x3727c5ac, v116
    v_mov_b32 v119, v118
    v_cvt_pk_bf16_f32 v116, v116, v116
    v_and_b32 v116, 0xffff0000, v116
    v_sqrt_f32 v116, v116
    v_pk_add_f32 v[80:81], v[80:81], v[118:119]
    v_pk_add_f32 v[82:83], v[82:83], v[118:119]
    v_pk_add_f32 v[84:85], v[84:85], v[118:119]
    v_pk_add_f32 v[86:87], v[86:87], v[118:119]
    v_pk_add_f32 v[88:89], v[88:89], v[118:119]
    v_pk_add_f32 v[90:91], v[90:91], v[118:119]
    v_pk_add_f32 v[92:93], v[92:93], v[118:119]
    v_pk_add_f32 v[94:95], v[94:95], v[118:119]
    v_pk_add_f32 v[96:97], v[96:97], v[118:119]
    v_pk_add_f32 v[98:99], v[98:99], v[118:119]
    v_pk_add_f32 v[100:101], v[100:101], v[118:119]
    v_pk_add_f32 v[102:103], v[102:103], v[118:119]
    v_pk_add_f32 v[104:105], v[104:105], v[118:119]
    s_add_u32 m0, s48, 36864
    s_nop 0
    buffer_load_dwordx4 v14, s[16:19], s49 offen offset:0 lds
    buffer_load_dwordx4 v15, s[16:19], s49 offen offset:1024 lds
    buffer_load_dwordx4 v16, s[16:19], s49 offen offset:2048 lds
    buffer_load_dwordx4 v17, s[16:19], s49 offen offset:3072 lds
    s_add_u32 s49, s49, 128
    v_pk_add_f32 v[106:107], v[106:107], v[118:119]
    v_pk_add_f32 v[108:109], v[108:109], v[118:119]
    v_pk_add_f32 v[110:111], v[110:111], v[118:119]
    v_cvt_pk_bf16_f32 v116, v116, v116
    v_and_b32 v116, 0xffff0000, v116
    v_rcp_f32 v116, v116
    v_cvt_pk_bf16_f32 v64, v80, v81
    v_cvt_pk_bf16_f32 v65, v82, v83
    v_cvt_pk_bf16_f32 v66, v84, v85
    v_cvt_pk_bf16_f32 v67, v86, v87
    v_cvt_pk_bf16_f32 v68, v88, v89
    v_cvt_pk_bf16_f32 v69, v90, v91
    v_cvt_pk_bf16_f32 v70, v92, v93
    v_cvt_pk_bf16_f32 v71, v94, v95
    v_cvt_pk_bf16_f32 v72, v96, v97
    v_cvt_pk_bf16_f32 v73, v98, v99
    v_cvt_pk_bf16_f32 v74, v100, v101
    v_cvt_pk_bf16_f32 v75, v102, v103
    v_cvt_pk_bf16_f32 v76, v104, v105
    v_cvt_pk_bf16_f32 v77, v106, v107
    v_cvt_pk_bf16_f32 v78, v108, v109
    v_cvt_pk_bf16_f32 v79, v110, v111
    v_mov_b32 v117, v116
    v_lshlrev_b32 v80, 16, v64
    v_and_b32 v81, 0xffff0000, v64
    v_lshlrev_b32 v82, 16, v65
    v_and_b32 v83, 0xffff0000, v65
    v_lshlrev_b32 v84, 16, v66
    v_and_b32 v85, 0xffff0000, v66
    v_lshlrev_b32 v86, 16, v67
    v_and_b32 v87, 0xffff0000, v67
    v_lshlrev_b32 v88, 16, v68
    v_and_b32 v89, 0xffff0000, v68
    v_lshlrev_b32 v90, 16, v69
    v_and_b32 v91, 0xffff0000, v69
    v_lshlrev_b32 v92, 16, v70
    v_and_b32 v93, 0xffff0000, v70
    v_lshlrev_b32 v94, 16, v71
    v_and_b32 v95, 0xffff0000, v71
    v_lshlrev_b32 v96, 16, v72
    v_and_b32 v97, 0xffff0000, v72
    v_lshlrev_b32 v98, 16, v73
    v_and_b32 v99, 0xffff0000, v73
    v_lshlrev_b32 v100, 16, v74
    s_add_u32 m0, s48, 102400
    s_nop 0
    buffer_load_dwordx4 v22, s[20:23], s50 offen offset:0 lds
    buffer_load_dwordx4 v23, s[20:23], s50 offen offset:1024 lds
    buffer_load_dwordx4 v24, s[20:23], s50 offen offset:2048 lds
    buffer_load_dwordx4 v25, s[20:23], s50 offen offset:3072 lds
    s_add_u32 s50, s50, 0x80000
    v_and_b32 v101, 0xffff0000, v74
    v_lshlrev_b32 v102, 16, v75
    v_and_b32 v103, 0xffff0000, v75
    v_lshlrev_b32 v104, 16, v76
    v_and_b32 v105, 0xffff0000, v76
    v_lshlrev_b32 v106, 16, v77
    v_and_b32 v107, 0xffff0000, v77
    v_lshlrev_b32 v108, 16, v78
    v_and_b32 v109, 0xffff0000, v78
    v_lshlrev_b32 v110, 16, v79
    v_and_b32 v111, 0xffff0000, v79
    v_pk_mul_f32 v[80:81], v[80:81], v[116:117]
    v_pk_mul_f32 v[82:83], v[82:83], v[116:117]
    v_pk_mul_f32 v[84:85], v[84:85], v[116:117]
    v_pk_mul_f32 v[86:87], v[86:87], v[116:117]
    v_pk_mul_f32 v[88:89], v[88:89], v[116:117]
    v_pk_mul_f32 v[90:91], v[90:91], v[116:117]
    v_pk_mul_f32 v[92:93], v[92:93], v[116:117]
    v_pk_mul_f32 v[94:95], v[94:95], v[116:117]
    v_pk_mul_f32 v[96:97], v[96:97], v[116:117]
    v_pk_mul_f32 v[98:99], v[98:99], v[116:117]
    v_pk_mul_f32 v[100:101], v[100:101], v[116:117]
    v_pk_mul_f32 v[102:103], v[102:103], v[116:117]
    v_pk_mul_f32 v[104:105], v[104:105], v[116:117]
    v_pk_mul_f32 v[106:107], v[106:107], v[116:117]
    v_pk_mul_f32 v[108:109], v[108:109], v[116:117]
    v_pk_mul_f32 v[110:111], v[110:111], v[116:117]
    v_cvt_pk_bf16_f32 v64, v80, v81
    v_cvt_pk_bf16_f32 v65, v82, v83
    v_cvt_pk_bf16_f32 v66, v84, v85
    v_cvt_pk_bf16_f32 v67, v86, v87
    v_cvt_pk_bf16_f32 v68, v88, v89
    v_cvt_pk_bf16_f32 v69, v90, v91
    v_cvt_pk_bf16_f32 v70, v92, v93
    v_cvt_pk_bf16_f32 v71, v94, v95
    v_cvt_pk_bf16_f32 v72, v96, v97
    v_cvt_pk_bf16_f32 v73, v98, v99
    v_cvt_pk_bf16_f32 v74, v100, v101
    v_cvt_pk_bf16_f32 v75, v102, v103
    v_cvt_pk_bf16_f32 v76, v104, v105
    v_cvt_pk_bf16_f32 v77, v106, v107
    v_cvt_pk_bf16_f32 v78, v108, v109
    v_cvt_pk_bf16_f32 v79, v110, v111
    ds_write_b128 v54, v[64:67] offset:0
    ds_write_b128 v54, v[68:71] offset:512
    ds_write_b128 v54, v[72:75] offset:1024
    ds_write_b128 v54, v[76:79] offset:1536
    s_waitcnt vmcnt(16) lgkmcnt(0)
    s_barrier
    ds_read_b128 a[64:67], v55 offset:0
    ds_read_b128 a[68:71], v55 offset:128
    ds_read_b128 a[72:75], v55 offset:256
    ds_read_b128 a[76:79], v55 offset:384
    v_add_u32 v54, 4096, v36
    v_add_u32 v55, 4096, v37
    v_mfma_f32_32x32x16_bf16 v[64:79], v[56:59], v[56:59], 0
    v_mfma_f32_32x32x16_bf16 v[80:95], v[56:59], v[56:59], 0
    v_mfma_f32_32x32x16_bf16 v[96:111], v[56:59], v[56:59], 0
    v_mfma_f32_32x32x16_bf16 v[112:127], v[56:59], v[56:59], 0
    s_cmp_ge_u32 s2, 22
    s_cbranch_scc1 k12_nostat_5
    s_lshl_b32 s52, s2, 12
    s_add_u32 s52, s52, 0x3800000
    s_mov_b32 s34, -1
    v_lshlrev_b32 v6, 4, v0
    buffer_store_dwordx4 v[56:59], v6, s[32:35], s52 offen sc1
    s_mov_b32 s34, 0x2000000
k12_nostat_5:
    ds_read_b128 a[192:195], v26 offset:0
    ds_read_b64_tr_b16 a[0:1], v28 offset:0
    ds_read_b128 a[196:199], v27 offset:0
    ds_read_b64_tr_b16 a[2:3], v28 offset:2048
    ds_read_b128 a[200:203], v26 offset:2048
    ds_read_b64_tr_b16 a[4:5], v28 offset:16384
    ds_read_b128 a[204:207], v27 offset:2048
    ds_read_b64_tr_b16 a[6:7], v28 offset:18432
    ds_read_b128 a[208:211], v26 offset:4096
    ds_read_b64_tr_b16 a[8:9], v29 offset:0
    ds_read_b128 a[212:215], v27 offset:4096
    ds_read_b64_tr_b16 a[10:11], v29 offset:2048
    ds_read_b128 a[216:219], v26 offset:6144
    ds_read_b64_tr_b16 a[12:13], v29 offset:16384
    ds_read_b128 a[220:223], v27 offset:6144
    ds_read_b64_tr_b16 a[14:15], v29 offset:18432
    ds_read_b128 a[224:227], v26 offset:8192
    ds_read_b64_tr_b16 a[16:17], v30 offset:0
    ds_read_b128 a[228:231], v27 offset:8192
    ds_read_b64_tr_b16 a[18:19], v30 offset:2048
    ds_read_b128 a[232:235], v26 offset:10240
    ds_read_b64_tr_b16 a[20:21], v30 offset:16384
    ds_read_b128 a[236:239], v27 offset:10240
    ds_read_b64_tr_b16 a[22:23], v30 offset:18432
    ds_read_b128 a[240:243], v26 offset:12288
    ds_read_b64_tr_b16 a[24:25], v31 offset:0
    ds_read_b128 a[244:247], v27 offset:12288
    ds_read_b64_tr_b16 a[26:27], v31 offset:2048
    ds_read_b128 a[248:251], v26 offset:14336
    ds_read_b64_tr_b16 a[28:29], v31 offset:16384
    ds_read_b128 a[252:255], v27 offset:14336
    ds_read_b64_tr_b16 a[30:31], v31 offset:18432
    s_mov_b32 s51, 0
    s_waitcnt lgkmcnt(15)
    s_mov_b32 s52, 0
    buffer_store_dwordx4 a[64:67], v53, s[8:11], s52 offen sc1
    s_mov_b32 s52, 262144
    buffer_store_dwordx4 a[68:71], v53, s[8:11], s52 offen sc1
    s_mov_b32 s52, 524288
    buffer_store_dwordx4 a[72:75], v53, s[8:11], s52 offen sc1
    s_mov_b32 s52, 786432
    buffer_store_dwordx4 a[76:79], v53, s[8:11], s52 offen sc1
    s_waitcnt lgkmcnt(0)
    s_cmp_lg_u32 s57, 0
    s_cbranch_scc1 k12_v_6
k12_loop_8:
    v_mfma_f32_16x16x32_bf16 v[64:67], a[0:3], a[192:195], v[64:67]
    v_mfma_f32_16x16x32_bf16 v[64:67], a[4:7], a[196:199], v[64:67]
    ds_read_b64_tr_b16 a[32:33], v32 offset:0
    v_mfma_f32_16x16x32_bf16 v[80:83], a[4:7], a[204:207], v[80:83]
    v_mfma_f32_16x16x32_bf16 v[80:83], a[0:3], a[200:203], v[80:83]
    ds_read_b64_tr_b16 a[34:35], v32 offset:2048
    v_mfma_f32_16x16x32_bf16 v[96:99], a[0:3], a[208:211], v[96:99]
    s_cmp_eq_u32 s51, s46
    s_cbranch_scc1 k12_ool_10
k12_oolret_11:
    v_mfma_f32_16x16x32_bf16 v[96:99], a[4:7], a[212:215], v[96:99]
    v_mfma_f32_16x16x32_bf16 v[112:115], a[4:7], a[220:223], v[112:115]
    ds_read_b64_tr_b16 a[36:37], v32 offset:16384
    v_mfma_f32_16x16x32_bf16 v[112:115], a[0:3], a[216:219], v[112:115]
    v_mfma_f32_16x16x32_bf16 v[128:131], a[0:3], a[224:227], v[128:131]
    v_mfma_f32_16x16x32_bf16 v[128:131], a[4:7], a[228:231], v[128:131]
    ds_read_b64_tr_b16 a[38:39], v32 offset:18432
    v_mfma_f32_16x16x32_bf16 v[144:147], a[4:7], a[236:239], v[144:147]
    v_mfma_f32_16x16x32_bf16 v[144:147], a[0:3], a[232:235], v[144:147]
    v_mfma_f32_16x16x32_bf16 a[128:131], a[0:3], a[240:243], a[128:131]
    ds_read_b64_tr_b16 a[40:41], v33 offset:0
    v_mfma_f32_16x16x32_bf16 a[128:131], a[4:7], a[244:247], a[128:131]
    v_mfma_f32_16x16x32_bf16 a[160:163], a[4:7], a[252:255], a[160:163]
    v_mfma_f32_16x16x32_bf16 a[160:163], a[0:3], a[248:251], a[160:163]
    ds_read_b64_tr_b16 a[42:43], v33 offset:2048
    v_mfma_f32_16x16x32_bf16 a[164:167], a[8:11], a[248:251], a[164:167]
    v_mfma_f32_16x16x32_bf16 a[164:167], a[12:15], a[252:255], a[164:167]
    v_mfma_f32_16x16x32_bf16 a[132:135], a[12:15], a[244:247], a[132:135]
    ds_read_b64_tr_b16 a[44:45], v33 offset:16384
    v_mfma_f32_16x16x32_bf16 a[132:135], a[8:11], a[240:243], a[132:135]
    v_mfma_f32_16x16x32_bf16 v[240:243], a[8:11], a[232:235], v[240:243]
    v_mfma_f32_16x16x32_bf16 v[240:243], a[12:15], a[236:239], v[240:243]
    ds_read_b64_tr_b16 a[46:47], v33 offset:18432
    v_mfma_f32_16x16x32_bf16 v[224:227], a[12:15], a[228:231], v[224:227]
    v_mfma_f32_16x16x32_bf16 v[224:227], a[8:11], a[224:227], v[224:227]
    ds_read_b64_tr_b16 a[48:49], v34 offset:0
    v_mfma_f32_16x16x32_bf16 v[208:211], a[8:11], a[216:219], v[208:211]
    v_mfma_f32_16x16x32_bf16 v[208:211], a[12:15], a[220:223], v[208:211]
    v_mfma_f32_16x16x32_bf16 v[192:195], a[12:15], a[212:215], v[192:195]
    ds_read_b64_tr_b16 a[50:51], v34 offset:2048
    v_mfma_f32_16x16x32_bf16 v[192:195], a[8:11], a[208:211], v[192:195]
    v_mfma_f32_16x16x32_bf16 v[176:179], a[8:11], a[200:203], v[176:179]
    v_mfma_f32_16x16x32_bf16 v[176:179], a[12:15], a[204:207], v[176:179]
    ds_read_b64_tr_b16 a[52:53], v34 offset:16384
    v_mfma_f32_16x16x32_bf16 v[160:163], a[12:15], a[196:199], v[160:163]
    v_mfma_f32_16x16x32_bf16 v[160:163], a[8:11], a[192:195], v[160:163]
    v_mfma_f32_16x16x32_bf16 v[68:71], a[16:19], a[192:195], v[68:71]
    ds_read_b64_tr_b16 a[54:55], v34 offset:18432
    v_mfma_f32_16x16x32_bf16 v[68:71], a[20:23], a[196:199], v[68:71]
    v_mfma_f32_16x16x32_bf16 v[84:87], a[20:23], a[204:207], v[84:87]
    v_mfma_f32_16x16x32_bf16 v[84:87], a[16:19], a[200:203], v[84:87]
    ds_read_b64_tr_b16 a[56:57], v35 offset:0
    v_mfma_f32_16x16x32_bf16 v[100:103], a[16:19], a[208:211], v[100:103]
    v_mfma_f32_16x16x32_bf16 v[100:103], a[20:23], a[212:215], v[100:103]
    v_mfma_f32_16x16x32_bf16 v[116:119], a[20:23], a[220:223], v[116:119]
    ds_read_b64_tr_b16 a[58:59], v35 offset:2048
    v_mfma_f32_16x16x32_bf16 v[116:119], a[16:19], a[216:219], v[116:119]
    v_mfma_f32_16x16x32_bf16 v[132:135], a[16:19], a[224:227], v[132:135]
    v_mfma_f32_16x16x32_bf16 v[132:135], a[20:23], a[228:231], v[132:135]
    ds_read_b64_tr_b16 a[60:61], v35 offset:16384
    v_mfma_f32_16x16x32_bf16 v[148:151], a[20:23], a[236:239], v[148:151]
    v_mfma_f32_16x16x32_bf16 v[148:151], a[16:19], a[232:235], v[148:151]
    v_mfma_f32_16x16x32_bf16 a[136:139], a[16:19], a[240:243], a[136:139]
    ds_read_b64_tr_b16 a[62:63], v35 offset:18432
    v_mfma_f32_16x16x32_bf16 a[136:139], a[20:23], a[244:247], a[136:139]
    v_mfma_f32_16x16x32_bf16 a[168:171], a[20:23], a[252:255], a[168:171]
    v_mfma_f32_16x16x32_bf16 a[168:171], a[16:19], a[248:251], a[168:171]
    v_mfma_f32_16x16x32_bf16 a[172:175], a[24:27], a[248:251], a[172:175]
    v_mfma_f32_16x16x32_bf16 a[172:175], a[28:31], a[252:255], a[172:175]
    v_mfma_f32_16x16x32_bf16 a[140:143], a[28:31], a[244:247], a[140:143]
    v_mfma_f32_16x16x32_bf16 a[140:143], a[24:27], a[240:243], a[140:143]
    v_mfma_f32_16x16x32_bf16 v[244:247], a[24:27], a[232:235], v[244:247]
    v_mfma_f32_16x16x32_bf16 v[244:247], a[28:31], a[236:239], v[244:247]
    v_mfma_f32_16x16x32_bf16 v[228:231], a[28:31], a[228:231], v[228:231]
    v_mfma_f32_16x16x32_bf16 v[228:231], a[24:27], a[224:227], v[228:231]
    v_mfma_f32_16x16x32_bf16 v[212:215], a[24:27], a[216:219], v[212:215]
    v_mfma_f32_16x16x32_bf16 v[212:215], a[28:31], a[220:223], v[212:215]
    v_mfma_f32_16x16x32_bf16 v[196:199], a[28:31], a[212:215], v[196:199]
    v_mfma_f32_16x16x32_bf16 v[196:199], a[24:27], a[208:211], v[196:199]
    v_mfma_f32_16x16x32_bf16 v[180:183], a[24:27], a[200:203], v[180:183]
    v_mfma_f32_16x16x32_bf16 v[180:183], a[28:31], a[204:207], v[180:183]
    v_mfma_f32_16x16x32_bf16 v[164:167], a[28:31], a[196:199], v[164:167]
    v_mfma_f32_16x16x32_bf16 v[164:167], a[24:27], a[192:195], v[164:167]
    s_waitcnt vmcnt(0) lgkmcnt(0)
    s_cmp_eq_u32 s51, s46
    s_cbranch_scc1 k12_ool_14
k12_oolret_15:
    s_barrier
    v_mfma_f32_16x16x32_bf16 v[72:75], a[32:35], a[192:195], v[72:75]
    s_cmp_ge_u32 s49, 1024
    s_cselect_b32 s18, 0, s18
    s_cselect_b32 s22, 0, s22
    v_mfma_f32_16x16x32_bf16 v[72:75], a[36:39], a[196:199], v[72:75]
    s_add_u32 m0, s48, 0
    ds_read_b128 a[64:67], v26 offset:32768
    v_mfma_f32_16x16x32_bf16 v[88:91], a[36:39], a[204:207], v[88:91]
    buffer_load_dwordx4 v10, s[16:19], s49 offen offset:0 lds
    ds_read_b64_tr_b16 a[0:1], v28 offset:32768
    v_mfma_f32_16x16x32_bf16 v[88:91], a[32:35], a[200:203], v[88:91]
    ds_read_b128 a[68:71], v27 offset:32768
    v_mfma_f32_16x16x32_bf16 v[104:107], a[32:35], a[208:211], v[104:107]
    buffer_load_dwordx4 v11, s[16:19], s49 offen offset:1024 lds
    v_mfma_f32_16x16x32_bf16 v[104:107], a[36:39], a[212:215], v[104:107]
    ds_read_b64_tr_b16 a[2:3], v28 offset:34816
    v_mfma_f32_16x16x32_bf16 v[120:123], a[36:39], a[220:223], v[120:123]
    v_mfma_f32_16x16x32_bf16 v[120:123], a[32:35], a[216:219], v[120:123]
    ds_read_b128 a[72:75], v26 offset:34816
    v_mfma_f32_16x16x32_bf16 v[136:139], a[32:35], a[224:227], v[136:139]
    buffer_load_dwordx4 v12, s[16:19], s49 offen offset:2048 lds
    ds_read_b64_tr_b16 a[4:5], v28 offset:49152
    v_mfma_f32_16x16x32_bf16 v[136:139], a[36:39], a[228:231], v[136:139]
    v_mfma_f32_16x16x32_bf16 v[152:155], a[36:39], a[236:239], v[152:155]
    ds_read_b128 a[76:79], v27 offset:34816
    v_mfma_f32_16x16x32_bf16 v[152:155], a[32:35], a[232:235], v[152:155]
    buffer_load_dwordx4 v13, s[16:19], s49 offen offset:3072 lds
    v_mfma_f32_16x16x32_bf16 a[144:147], a[32:35], a[240:243], a[144:147]
    ds_read_b64_tr_b16 a[6:7], v28 offset:51200
    v_mfma_f32_16x16x32_bf16 a[144:147], a[36:39], a[244:247], a[144:147]
    s_add_u32 m0, s48, 4096
    ds_read_b128 a[80:83], v26 offset:36864
    v_mfma_f32_16x16x32_bf16 a[176:179], a[36:39], a[252:255], a[176:179]
    v_mfma_f32_16x16x32_bf16 a[176:179], a[32:35], a[248:251], a[176:179]
    buffer_load_dwordx4 v14, s[16:19], s49 offen offset:0 lds
    ds_read_b64_tr_b16 a[8:9], v29 offset:32768
    v_mfma_f32_16x16x32_bf16 a[180:183], a[40:43], a[248:251], a[180:183]
    v_mfma_f32_16x16x32_bf16 a[180:183], a[44:47], a[252:255], a[180:183]
    ds_read_b128 a[84:87], v27 offset:36864
    v_mfma_f32_16x16x32_bf16 a[148:151], a[44:47], a[244:247], a[148:151]
    buffer_load_dwordx4 v15, s[16:19], s49 offen offset:1024 lds
    ds_read_b64_tr_b16 a[10:11], v29 offset:34816
    v_mfma_f32_16x16x32_bf16 a[148:151], a[40:43], a[240:243], a[148:151]
    v_mfma_f32_16x16x32_bf16 v[248:251], a[40:43], a[232:235], v[248:251]
    ds_read_b128 a[88:91], v26 offset:38912
    v_mfma_f32_16x16x32_bf16 v[248:251], a[44:47], a[236:239], v[248:251]
    v_mfma_f32_16x16x32_bf16 v[232:235], a[44:47], a[228:231], v[232:235]
    buffer_load_dwordx4 v16, s[16:19], s49 offen offset:2048 lds
    ds_read_b64_tr_b16 a[12:13], v29 offset:49152
    v_mfma_f32_16x16x32_bf16 v[232:235], a[40:43], a[224:227], v[232:235]
    ds_read_b128 a[92:95], v27 offset:38912
    v_mfma_f32_16x16x32_bf16 v[216:219], a[40:43], a[216:219], v[216:219]
    v_mfma_f32_16x16x32_bf16 v[216:219], a[44:47], a[220:223], v[216:219]
    buffer_load_dwordx4 v17, s[16:19], s49 offen offset:3072 lds
    ds_read_b64_tr_b16 a[14:15], v29 offset:51200
    v_mfma_f32_16x16x32_bf16 v[200:203], a[44:47], a[212:215], v[200:203]
    ds_read_b128 a[96:99], v26 offset:40960
    v_mfma_f32_16x16x32_bf16 v[200:203], a[40:43], a[208:211], v[200:203]
    s_add_u32 s49, s49, 128
    v_mfma_f32_16x16x32_bf16 v[184:187], a[40:43], a[200:203], v[184:187]
    s_add_u32 m0, s48, 65536
    ds_read_b64_tr_b16 a[16:17], v30 offset:32768
    v_mfma_f32_16x16x32_bf16 v[184:187], a[44:47], a[204:207], v[184:187]
    buffer_load_dwordx4 v18, s[20:23], s50 offen offset:0 lds
    v_mfma_f32_16x16x32_bf16 v[168:171], a[44:47], a[196:199], v[168:171]
    ds_read_b128 a[100:103], v27 offset:40960
    v_mfma_f32_16x16x32_bf16 v[168:171], a[40:43], a[192:195], v[168:171]
    ds_read_b64_tr_b16 a[18:19], v30 offset:34816
    v_mfma_f32_16x16x32_bf16 v[76:79], a[48:51], a[192:195], v[76:79]
    buffer_load_dwordx4 v19, s[20:23], s50 offen offset:1024 lds
    v_mfma_f32_16x16x32_bf16 v[76:79], a[52:55], a[196:199], v[76:79]
    ds_read_b128 a[104:107], v26 offset:43008
    v_mfma_f32_16x16x32_bf16 v[92:95], a[52:55], a[204:207], v[92:95]
    v_mfma_f32_16x16x32_bf16 v[92:95], a[48:51], a[200:203], v[92:95]
    buffer_load_dwordx4 v20, s[20:23], s50 offen offset:2048 lds
    ds_read_b64_tr_b16 a[20:21], v30 offset:49152
    v_mfma_f32_16x16x32_bf16 v[108:111], a[48:51], a[208:211], v[108:111]
    ds_read_b128 a[108:111], v27 offset:43008
    v_mfma_f32_16x16x32_bf16 v[108:111], a[52:55], a[212:215], v[108:111]
    v_mfma_f32_16x16x32_bf16 v[124:127], a[52:55], a[220:223], v[124:127]
    ds_read_b64_tr_b16 a[22:23], v30 offset:51200
    v_mfma_f32_16x16x32_bf16 v[124:127], a[48:51], a[216:219], v[124:127]
    buffer_load_dwordx4 v21, s[20:23], s50 offen offset:3072 lds
    v_mfma_f32_16x16x32_bf16 v[140:143], a[48:51], a[224:227], v[140:143]
    s_add_u32 m0, s48, 69632
    ds_read_b128 a[112:115], v26 offset:45056
    v_mfma_f32_16x16x32_bf16 v[140:143], a[52:55], a[228:231], v[140:143]
    ds_read_b64_tr_b16 a[24:25], v31 offset:32768
    v_mfma_f32_16x16x32_bf16 v[156:159], a[52:55], a[236:239], v[156:159]
    buffer_load_dwordx4 v22, s[20:23], s50 offen offset:0 lds
    v_mfma_f32_16x16x32_bf16 v[156:159], a[48:51], a[232:235], v[156:159]
    ds_read_b128 a[116:119], v27 offset:45056
    v_mfma_f32_16x16x32_bf16 a[152:155], a[48:51], a[240:243], a[152:155]
    v_mfma_f32_16x16x32_bf16 a[152:155], a[52:55], a[244:247], a[152:155]
    ds_read_b64_tr_b16 a[26:27], v31 offset:34816
    v_mfma_f32_16x16x32_bf16 a[184:187], a[52:55], a[252:255], a[184:187]
    buffer_load_dwordx4 v23, s[20:23], s50 offen offset:1024 lds
    ds_read_b128 a[120:123], v26 offset:47104
    v_mfma_f32_16x16x32_bf16 a[184:187], a[48:51], a[248:251], a[184:187]
    v_mfma_f32_16x16x32_bf16 a[188:191], a[56:59], a[248:251], a[188:191]
    ds_read_b64_tr_b16 a[28:29], v31 offset:49152
    v_mfma_f32_16x16x32_bf16 a[188:191], a[60:63], a[252:255], a[188:191]
    buffer_load_dwordx4 v24, s[20:23], s50 offen offset:2048 lds
    v_mfma_f32_16x16x32_bf16 a[156:159], a[60:63], a[244:247], a[156:159]
    ds_read_b128 a[124:127], v27 offset:47104
    v_mfma_f32_16x16x32_bf16 a[156:159], a[56:59], a[240:243], a[156:159]
    ds_read_b64_tr_b16 a[30:31], v31 offset:51200
    v_mfma_f32_16x16x32_bf16 v[252:255], a[56:59], a[232:235], v[252:255]
    v_mfma_f32_16x16x32_bf16 v[252:255], a[60:63], a[236:239], v[252:255]
    buffer_load_dwordx4 v25, s[20:23], s50 offen offset:3072 lds
    v_mfma_f32_16x16x32_bf16 v[236:239], a[60:63], a[228:231], v[236:239]
    v_mfma_f32_16x16x32_bf16 v[236:239], a[56:59], a[224:227], v[236:239]
    s_add_u32 s50, s50, 0x80000
    v_mfma_f32_16x16x32_bf16 v[220:223], a[56:59], a[216:219], v[220:223]
    v_mfma_f32_16x16x32_bf16 v[220:223], a[60:63], a[220:223], v[220:223]
    s_cmp_eq_u32 s51, s53
    s_cbranch_scc1 k12_ool_16
k12_oolret_17:
    v_mfma_f32_16x16x32_bf16 v[204:207], a[60:63], a[212:215], v[204:207]
    s_cmp_eq_u32 s51, s63
    s_cbranch_scc1 k12_ool_18
k12_oolret_19:
    v_mfma_f32_16x16x32_bf16 v[204:207], a[56:59], a[208:211], v[204:207]
    s_cmp_eq_u32 s51, 6
    s_cbranch_scc1 k12_ool_20
k12_oolret_21:
    v_mfma_f32_16x16x32_bf16 v[188:191], a[56:59], a[200:203], v[188:191]
    v_mfma_f32_16x16x32_bf16 v[188:191], a[60:63], a[204:207], v[188:191]
    s_add_u32 s51, s51, 1
    v_mfma_f32_16x16x32_bf16 v[172:175], a[60:63], a[196:199], v[172:175]
    v_mfma_f32_16x16x32_bf16 v[172:175], a[56:59], a[192:195], v[172:175]
    s_waitcnt lgkmcnt(0)
    s_cmp_eq_u32 s51, 7
    s_cbranch_scc1 k12_last_9
    v_mfma_f32_16x16x32_bf16 v[64:67], a[0:3], a[64:67], v[64:67]
    v_mfma_f32_16x16x32_bf16 v[64:67], a[4:7], a[68:71], v[64:67]
    ds_read_b64_tr_b16 a[32:33], v32 offset:32768
    v_mfma_f32_16x16x32_bf16 v[80:83], a[4:7], a[76:79], v[80:83]
    v_mfma_f32_16x16x32_bf16 v[80:83], a[0:3], a[72:75], v[80:83]
    ds_read_b64_tr_b16 a[34:35], v32 offset:34816
    v_mfma_f32_16x16x32_bf16 v[96:99], a[0:3], a[80:83], v[96:99]
    v_mfma_f32_16x16x32_bf16 v[96:99], a[4:7], a[84:87], v[96:99]
    v_mfma_f32_16x16x32_bf16 v[112:115], a[4:7], a[92:95], v[112:115]
    ds_read_b64_tr_b16 a[36:37], v32 offset:49152
    v_mfma_f32_16x16x32_bf16 v[112:115], a[0:3], a[88:91], v[112:115]
    v_mfma_f32_16x16x32_bf16 v[128:131], a[0:3], a[96:99], v[128:131]
    v_mfma_f32_16x16x32_bf16 v[128:131], a[4:7], a[100:103], v[128:131]
    ds_read_b64_tr_b16 a[38:39], v32 offset:51200
    v_mfma_f32_16x16x32_bf16 v[144:147], a[4:7], a[108:111], v[144:147]
    v_mfma_f32_16x16x32_bf16 v[144:147], a[0:3], a[104:107], v[144:147]
    v_mfma_f32_16x16x32_bf16 a[128:131], a[0:3], a[112:115], a[128:131]
    ds_read_b64_tr_b16 a[40:41], v33 offset:32768
    v_mfma_f32_16x16x32_bf16 a[128:131], a[4:7], a[116:119], a[128:131]
    v_mfma_f32_16x16x32_bf16 a[160:163], a[4:7], a[124:127], a[160:163]
    v_mfma_f32_16x16x32_bf16 a[160:163], a[0:3], a[120:123], a[160:163]
    ds_read_b64_tr_b16 a[42:43], v33 offset:34816
    v_mfma_f32_16x16x32_bf16 a[164:167], a[8:11], a[120:123], a[164:167]
    v_mfma_f32_16x16x32_bf16 a[164:167], a[12:15], a[124:127], a[164:167]
    v_mfma_f32_16x16x32_bf16 a[132:135], a[12:15], a[116:119], a[132:135]
    ds_read_b64_tr_b16 a[44:45], v33 offset:49152
    v_mfma_f32_16x16x32_bf16 a[132:135], a[8:11], a[112:115], a[132:135]
    v_mfma_f32_16x16x32_bf16 v[240:243], a[8:11], a[104:107], v[240:243]
    v_mfma_f32_16x16x32_bf16 v[240:243], a[12:15], a[108:111], v[240:243]
    ds_read_b64_tr_b16 a[46:47], v33 offset:51200
    v_mfma_f32_16x16x32_bf16 v[224:227], a[12:15], a[100:103], v[224:227]
    v_mfma_f32_16x16x32_bf16 v[224:227], a[8:11], a[96:99], v[224:227]
    ds_read_b64_tr_b16 a[48:49], v34 offset:32768
    v_mfma_f32_16x16x32_bf16 v[208:211], a[8:11], a[88:91], v[208:211]
    v_mfma_f32_16x16x32_bf16 v[208:211], a[12:15], a[92:95], v[208:211]
    v_mfma_f32_16x16x32_bf16 v[192:195], a[12:15], a[84:87], v[192:195]
    ds_read_b64_tr_b16 a[50:51], v34 offset:34816
    v_mfma_f32_16x16x32_bf16 v[192:195], a[8:11], a[80:83], v[192:195]
    v_mfma_f32_16x16x32_bf16 v[176:179], a[8:11], a[72:75], v[176:179]
    v_mfma_f32_16x16x32_bf16 v[176:179], a[12:15], a[76:79], v[176:179]
    ds_read_b64_tr_b16 a[52:53], v34 offset:49152
    v_mfma_f32_16x16x32_bf16 v[160:163], a[12:15], a[68:71], v[160:163]
    v_mfma_f32_16x16x32_bf16 v[160:163], a[8:11], a[64:67], v[160:163]
    v_mfma_f32_16x16x32_bf16 v[68:71], a[16:19], a[64:67], v[68:71]
    ds_read_b64_tr_b16 a[54:55], v34 offset:51200
    v_mfma_f32_16x16x32_bf16 v[68:71], a[20:23], a[68:71], v[68:71]
    v_mfma_f32_16x16x32_bf16 v[84:87], a[20:23], a[76:79], v[84:87]
    v_mfma_f32_16x16x32_bf16 v[84:87], a[16:19], a[72:75], v[84:87]
    ds_read_b64_tr_b16 a[56:57], v35 offset:32768
    v_mfma_f32_16x16x32_bf16 v[100:103], a[16:19], a[80:83], v[100:103]
    v_mfma_f32_16x16x32_bf16 v[100:103], a[20:23], a[84:87], v[100:103]
    v_mfma_f32_16x16x32_bf16 v[116:119], a[20:23], a[92:95], v[116:119]
    ds_read_b64_tr_b16 a[58:59], v35 offset:34816
    v_mfma_f32_16x16x32_bf16 v[116:119], a[16:19], a[88:91], v[116:119]
    v_mfma_f32_16x16x32_bf16 v[132:135], a[16:19], a[96:99], v[132:135]
    v_mfma_f32_16x16x32_bf16 v[132:135], a[20:23], a[100:103], v[132:135]
    ds_read_b64_tr_b16 a[60:61], v35 offset:49152
    v_mfma_f32_16x16x32_bf16 v[148:151], a[20:23], a[108:111], v[148:151]
    v_mfma_f32_16x16x32_bf16 v[148:151], a[16:19], a[104:107], v[148:151]
    v_mfma_f32_16x16x32_bf16 a[136:139], a[16:19], a[112:115], a[136:139]
    ds_read_b64_tr_b16 a[62:63], v35 offset:51200
    v_mfma_f32_16x16x32_bf16 a[136:139], a[20:23], a[116:119], a[136:139]
    v_mfma_f32_16x16x32_bf16 a[168:171], a[20:23], a[124:127], a[168:171]
    v_mfma_f32_16x16x32_bf16 a[168:171], a[16:19], a[120:123], a[168:171]
    v_mfma_f32_16x16x32_bf16 a[172:175], a[24:27], a[120:123], a[172:175]
    v_mfma_f32_16x16x32_bf16 a[172:175], a[28:31], a[124:127], a[172:175]
    v_mfma_f32_16x16x32_bf16 a[140:143], a[28:31], a[116:119], a[140:143]
    v_mfma_f32_16x16x32_bf16 a[140:143], a[24:27], a[112:115], a[140:143]
    v_mfma_f32_16x16x32_bf16 v[244:247], a[24:27], a[104:107], v[244:247]
    v_mfma_f32_16x16x32_bf16 v[244:247], a[28:31], a[108:111], v[244:247]
    v_mfma_f32_16x16x32_bf16 v[228:231], a[28:31], a[100:103], v[228:231]
    v_mfma_f32_16x16x32_bf16 v[228:231], a[24:27], a[96:99], v[228:231]
    v_mfma_f32_16x16x32_bf16 v[212:215], a[24:27], a[88:91], v[212:215]
    v_mfma_f32_16x16x32_bf16 v[212:215], a[28:31], a[92:95], v[212:215]
    v_mfma_f32_16x16x32_bf16 v[196:199], a[28:31], a[84:87], v[196:199]
    v_mfma_f32_16x16x32_bf16 v[196:199], a[24:27], a[80:83], v[196:199]
    v_mfma_f32_16x16x32_bf16 v[180:183], a[24:27], a[72:75], v[180:183]
    v_mfma_f32_16x16x32_bf16 v[180:183], a[28:31], a[76:79], v[180:183]
    v_mfma_f32_16x16x32_bf16 v[164:167], a[28:31], a[68:71], v[164:167]
    v_mfma_f32_16x16x32_bf16 v[164:167], a[24:27], a[64:67], v[164:167]
    s_waitcnt vmcnt(0) lgkmcnt(0)
    s_barrier
    v_mfma_f32_16x16x32_bf16 v[72:75], a[32:35], a[64:67], v[72:75]
    v_mfma_f32_16x16x32_bf16 v[72:75], a[36:39], a[68:71], v[72:75]
    s_add_u32 m0, s48, 32768
    ds_read_b128 a[192:195], v26 offset:0
    v_mfma_f32_16x16x32_bf16 v[88:91], a[36:39], a[76:79], v[88:91]
    buffer_load_dwordx4 v10, s[16:19], s49 offen offset:0 lds
    ds_read_b64_tr_b16 a[0:1], v28 offset:0
    v_mfma_f32_16x16x32_bf16 v[88:91], a[32:35], a[72:75], v[88:91]
    ds_read_b128 a[196:199], v27 offset:0
    v_mfma_f32_16x16x32_bf16 v[104:107], a[32:35], a[80:83], v[104:107]
    buffer_load_dwordx4 v11, s[16:19], s49 offen offset:1024 lds
    v_mfma_f32_16x16x32_bf16 v[104:107], a[36:39], a[84:87], v[104:107]
    ds_read_b64_tr_b16 a[2:3], v28 offset:2048
    v_mfma_f32_16x16x32_bf16 v[120:123], a[36:39], a[92:95], v[120:123]
    v_mfma_f32_16x16x32_bf16 v[120:123], a[32:35], a[88:91], v[120:123]
    ds_read_b128 a[200:203], v26 offset:2048
    v_mfma_f32_16x16x32_bf16 v[136:139], a[32:35], a[96:99], v[136:139]
    buffer_load_dwordx4 v12, s[16:19], s49 offen offset:2048 lds
    ds_read_b64_tr_b16 a[4:5], v28 offset:16384
    v_mfma_f32_16x16x32_bf16 v[136:139], a[36:39], a[100:103], v[136:139]
    v_mfma_f32_16x16x32_bf16 v[152:155], a[36:39], a[108:111], v[152:155]
    ds_read_b128 a[204:207], v27 offset:2048
    v_mfma_f32_16x16x32_bf16 v[152:155], a[32:35], a[104:107], v[152:155]
    buffer_load_dwordx4 v13, s[16:19], s49 offen offset:3072 lds
    v_mfma_f32_16x16x32_bf16 a[144:147], a[32:35], a[112:115], a[144:147]
    ds_read_b64_tr_b16 a[6:7], v28 offset:18432
    v_mfma_f32_16x16x32_bf16 a[144:147], a[36:39], a[116:119], a[144:147]
    s_add_u32 m0, s48, 36864
    ds_read_b128 a[208:211], v26 offset:4096
    v_mfma_f32_16x16x32_bf16 a[176:179], a[36:39], a[124:127], a[176:179]
    v_mfma_f32_16x16x32_bf16 a[176:179], a[32:35], a[120:123], a[176:179]
    buffer_load_dwordx4 v14, s[16:19], s49 offen offset:0 lds
    ds_read_b64_tr_b16 a[8:9], v29 offset:0
    v_mfma_f32_16x16x32_bf16 a[180:183], a[40:43], a[120:123], a[180:183]
    v_mfma_f32_16x16x32_bf16 a[180:183], a[44:47], a[124:127], a[180:183]
    ds_read_b128 a[212:215], v27 offset:4096
    v_mfma_f32_16x16x32_bf16 a[148:151], a[44:47], a[116:119], a[148:151]
    buffer_load_dwordx4 v15, s[16:19], s49 offen offset:1024 lds
    ds_read_b64_tr_b16 a[10:11], v29 offset:2048
    v_mfma_f32_16x16x32_bf16 a[148:151], a[40:43], a[112:115], a[148:151]
    v_mfma_f32_16x16x32_bf16 v[248:251], a[40:43], a[104:107], v[248:251]
    ds_read_b128 a[216:219], v26 offset:6144
    v_mfma_f32_16x16x32_bf16 v[248:251], a[44:47], a[108:111], v[248:251]
    v_mfma_f32_16x16x32_bf16 v[232:235], a[44:47], a[100:103], v[232:235]
    buffer_load_dwordx4 v16, s[16:19], s49 offen offset:2048 lds
    ds_read_b64_tr_b16 a[12:13], v29 offset:16384
    v_mfma_f32_16x16x32_bf16 v[232:235], a[40:43], a[96:99], v[232:235]
    ds_read_b128 a[220:223], v27 offset:6144
    v_mfma_f32_16x16x32_bf16 v[216:219], a[40:43], a[88:91], v[216:219]
    v_mfma_f32_16x16x32_bf16 v[216:219], a[44:47], a[92:95], v[216:219]
    buffer_load_dwordx4 v17, s[16:19], s49 offen offset:3072 lds
    ds_read_b64_tr_b16 a[14:15], v29 offset:18432
    v_mfma_f32_16x16x32_bf16 v[200:203], a[44:47], a[84:87], v[200:203]
    ds_read_b128 a[224:227], v26 offset:8192
    v_mfma_f32_16x16x32_bf16 v[200:203], a[40:43], a[80:83], v[200:203]
    s_add_u32 s49, s49, 128
    v_mfma_f32_16x16x32_bf16 v[184:187], a[40:43], a[72:75], v[184:187]
    s_add_u32 m0, s48, 98304
    ds_read_b64_tr_b16 a[16:17], v30 offset:0
    v_mfma_f32_16x16x32_bf16 v[184:187], a[44:47], a[76:79], v[184:187]
    buffer_load_dwordx4 v18, s[20:23], s50 offen offset:0 lds
    v_mfma_f32_16x16x32_bf16 v[168:171], a[44:47], a[68:71], v[168:171]
    ds_read_b128 a[228:231], v27 offset:8192
    v_mfma_f32_16x16x32_bf16 v[168:171], a[40:43], a[64:67], v[168:171]
    ds_read_b64_tr_b16 a[18:19], v30 offset:2048
    v_mfma_f32_16x16x32_bf16 v[76:79], a[48:51], a[64:67], v[76:79]
    buffer_load_dwordx4 v19, s[20:23], s50 offen offset:1024 lds
    v_mfma_f32_16x16x32_bf16 v[76:79], a[52:55], a[68:71], v[76:79]
    ds_read_b128 a[232:235], v26 offset:10240
    v_mfma_f32_16x16x32_bf16 v[92:95], a[52:55], a[76:79], v[92:95]
    v_mfma_f32_16x16x32_bf16 v[92:95], a[48:51], a[72:75], v[92:95]
    buffer_load_dwordx4 v20, s[20:23], s50 offen offset:2048 lds
    ds_read_b64_tr_b16 a[20:21], v30 offset:16384
    v_mfma_f32_16x16x32_bf16 v[108:111], a[48:51], a[80:83], v[108:111]
    ds_read_b128 a[236:239], v27 offset:10240
    v_mfma_f32_16x16x32_bf16 v[108:111], a[52:55], a[84:87], v[108:111]
    v_mfma_f32_16x16x32_bf16 v[124:127], a[52:55], a[92:95], v[124:127]
    ds_read_b64_tr_b16 a[22:23], v30 offset:18432
    v_mfma_f32_16x16x32_bf16 v[124:127], a[48:51], a[88:91], v[124:127]
    buffer_load_dwordx4 v21, s[20:23], s50 offen offset:3072 lds
    v_mfma_f32_16x16x32_bf16 v[140:143], a[48:51], a[96:99], v[140:143]
    s_add_u32 m0, s48, 102400
    ds_read_b128 a[240:243], v26 offset:12288
    v_mfma_f32_16x16x32_bf16 v[140:143], a[52:55], a[100:103], v[140:143]
    ds_read_b64_tr_b16 a[24:25], v31 offset:0
    v_mfma_f32_16x16x32_bf16 v[156:159], a[52:55], a[108:111], v[156:159]
    buffer_load_dwordx4 v22, s[20:23], s50 offen offset:0 lds
    v_mfma_f32_16x16x32_bf16 v[156:159], a[48:51], a[104:107], v[156:159]
    ds_read_b128 a[244:247], v27 offset:12288
    v_mfma_f32_16x16x32_bf16 a[152:155], a[48:51], a[112:115], a[152:155]
    v_mfma_f32_16x16x32_bf16 a[152:155], a[52:55], a[116:119], a[152:155]
    ds_read_b64_tr_b16 a[26:27], v31 offset:2048
    v_mfma_f32_16x16x32_bf16 a[184:187], a[52:55], a[124:127], a[184:187]
    buffer_load_dwordx4 v23, s[20:23], s50 offen offset:1024 lds
    ds_read_b128 a[248:251], v26 offset:14336
    v_mfma_f32_16x16x32_bf16 a[184:187], a[48:51], a[120:123], a[184:187]
    v_mfma_f32_16x16x32_bf16 a[188:191], a[56:59], a[120:123], a[188:191]
    ds_read_b64_tr_b16 a[28:29], v31 offset:16384
    v_mfma_f32_16x16x32_bf16 a[188:191], a[60:63], a[124:127], a[188:191]
    buffer_load_dwordx4 v24, s[20:23], s50 offen offset:2048 lds
    v_mfma_f32_16x16x32_bf16 a[156:159], a[60:63], a[116:119], a[156:159]
    ds_read_b128 a[252:255], v27 offset:14336
    v_mfma_f32_16x16x32_bf16 a[156:159], a[56:59], a[112:115], a[156:159]
    ds_read_b64_tr_b16 a[30:31], v31 offset:18432
    v_mfma_f32_16x16x32_bf16 v[252:255], a[56:59], a[104:107], v[252:255]
    v_mfma_f32_16x16x32_bf16 v[252:255], a[60:63], a[108:111], v[252:255]
    buffer_load_dwordx4 v25, s[20:23], s50 offen offset:3072 lds
    v_mfma_f32_16x16x32_bf16 v[236:239], a[60:63], a[100:103], v[236:239]
    v_mfma_f32_16x16x32_bf16 v[236:239], a[56:59], a[96:99], v[236:239]
    s_add_u32 s50, s50, 0x80000
    v_mfma_f32_16x16x32_bf16 v[220:223], a[56:59], a[88:91], v[220:223]
    v_mfma_f32_16x16x32_bf16 v[220:223], a[60:63], a[92:95], v[220:223]
    s_cmp_eq_u32 s51, s53
    s_cbranch_scc1 k12_ool_22
k12_oolret_23:
    v_mfma_f32_16x16x32_bf16 v[204:207], a[60:63], a[84:87], v[204:207]
    s_cmp_eq_u32 s51, s63
    s_cbranch_scc1 k12_ool_24
k12_oolret_25:
    v_mfma_f32_16x16x32_bf16 v[204:207], a[56:59], a[80:83], v[204:207]
    s_cmp_eq_u32 s51, 5
    s_cbranch_scc1 k12_ool_26
k12_oolret_27:
    v_mfma_f32_16x16x32_bf16 v[188:191], a[56:59], a[72:75], v[188:191]
    v_mfma_f32_16x16x32_bf16 v[188:191], a[60:63], a[76:79], v[188:191]
    s_add_u32 s51, s51, 1
    v_mfma_f32_16x16x32_bf16 v[172:175], a[60:63], a[68:71], v[172:175]
    v_mfma_f32_16x16x32_bf16 v[172:175], a[56:59], a[64:67], v[172:175]
    s_waitcnt lgkmcnt(0)
    s_branch k12_loop_8
k12_last_9:
    v_mfma_f32_16x16x32_bf16 v[64:67], a[0:3], a[64:67], v[64:67]
    buffer_load_dwordx4 a[192:195], v36, s[8:11], s62 offen sc1
    v_mfma_f32_16x16x32_bf16 v[64:67], a[4:7], a[68:71], v[64:67]
    ds_read_b64_tr_b16 a[32:33], v32 offset:32768
    v_mfma_f32_16x16x32_bf16 v[160:163], a[12:15], a[68:71], v[160:163]
    buffer_load_dwordx4 a[196:199], v54, s[8:11], s62 offen sc1
    ds_read_b64_tr_b16 a[34:35], v32 offset:34816
    v_mfma_f32_16x16x32_bf16 v[160:163], a[8:11], a[64:67], v[160:163]
    v_mfma_f32_16x16x32_bf16 v[80:83], a[0:3], a[72:75], v[80:83]
    buffer_load_dwordx4 a[200:203], v37, s[8:11], s62 offen sc1
    v_mfma_f32_16x16x32_bf16 v[80:83], a[4:7], a[76:79], v[80:83]
    ds_read_b64_tr_b16 a[36:37], v32 offset:49152
    v_mfma_f32_16x16x32_bf16 v[176:179], a[12:15], a[76:79], v[176:179]
    buffer_load_dwordx4 a[204:207], v55, s[8:11], s62 offen sc1
    v_mfma_f32_16x16x32_bf16 v[176:179], a[8:11], a[72:75], v[176:179]
    s_add_u32 s62, s62, 0x20000
    buffer_load_dwordx4 a[208:211], v36, s[8:11], s62 offen sc1
    ds_read_b64_tr_b16 a[38:39], v32 offset:51200
    v_mfma_f32_16x16x32_bf16 v[96:99], a[0:3], a[80:83], v[96:99]
    v_mfma_f32_16x16x32_bf16 v[96:99], a[4:7], a[84:87], v[96:99]
    v_cvt_pk_bf16_f32 v64, v64, v65
    v_cvt_pk_bf16_f32 v65, v66, v67
    v_mfma_f32_16x16x32_bf16 v[192:195], a[12:15], a[84:87], v[192:195]
    v_cvt_pk_bf16_f32 v66, v160, v161
    v_cvt_pk_bf16_f32 v67, v162, v163
    v_mfma_f32_16x16x32_bf16 v[192:195], a[8:11], a[80:83], v[192:195]
    buffer_load_dwordx4 a[212:215], v54, s[8:11], s62 offen sc1
    ds_read_b64_tr_b16 a[40:41], v33 offset:32768
    v_mfma_f32_16x16x32_bf16 v[112:115], a[0:3], a[88:91], v[112:115]
    buffer_load_dwordx4 a[216:219], v37, s[8:11], s62 offen sc1
    ds_read_b64_tr_b16 a[42:43], v33 offset:34816
    v_mfma_f32_16x16x32_bf16 v[112:115], a[4:7], a[92:95], v[112:115]
    v_cvt_pk_bf16_f32 v80, v80, v81
    v_cvt_pk_bf16_f32 v81, v82, v83
    v_mfma_f32_16x16x32_bf16 v[208:211], a[12:15], a[92:95], v[208:211]
    v_cvt_pk_bf16_f32 v82, v176, v177
    v_cvt_pk_bf16_f32 v83, v178, v179
    v_mfma_f32_16x16x32_bf16 v[208:211], a[8:11], a[88:91], v[208:211]
    buffer_load_dwordx4 a[220:223], v55, s[8:11], s62 offen sc1
    ds_read_b64_tr_b16 a[44:45], v33 offset:49152
    v_mfma_f32_16x16x32_bf16 v[128:131], a[0:3], a[96:99], v[128:131]
    s_add_u32 s62, s62, 0x20000
    buffer_load_dwordx4 a[224:227], v36, s[8:11], s62 offen sc1
    v_mfma_f32_16x16x32_bf16 v[128:131], a[4:7], a[100:103], v[128:131]
    v_cvt_pk_bf16_f32 v96, v96, v97
    v_cvt_pk_bf16_f32 v97, v98, v99
    v_mfma_f32_16x16x32_bf16 v[224:227], a[12:15], a[100:103], v[224:227]
    buffer_load_dwordx4 a[228:231], v54, s[8:11], s62 offen sc1
    ds_read_b64_tr_b16 a[46:47], v33 offset:51200
    v_mfma_f32_16x16x32_bf16 v[224:227], a[8:11], a[96:99], v[224:227]
    v_cvt_pk_bf16_f32 v98, v192, v193
    v_cvt_pk_bf16_f32 v99, v194, v195
    v_mfma_f32_16x16x32_bf16 v[144:147], a[0:3], a[104:107], v[144:147]
    buffer_load_dwordx4 a[232:235], v37, s[8:11], s62 offen sc1
    ds_read_b64_tr_b16 a[48:49], v34 offset:32768
    v_mfma_f32_16x16x32_bf16 v[144:147], a[4:7], a[108:111], v[144:147]
    v_cvt_pk_bf16_f32 v112, v112, v113
    v_cvt_pk_bf16_f32 v113, v114, v115
    v_mfma_f32_16x16x32_bf16 v[240:243], a[12:15], a[108:111], v[240:243]
    buffer_load_dwordx4 a[236:239], v55, s[8:11], s62 offen sc1
    ds_read_b64_tr_b16 a[50:51], v34 offset:34816
    v_mfma_f32_16x16x32_bf16 v[240:243], a[8:11], a[104:107], v[240:243]
    s_add_u32 s62, s62, 0x20000
    v_cvt_pk_bf16_f32 v114, v208, v209
    v_cvt_pk_bf16_f32 v115, v210, v211
    v_mfma_f32_16x16x32_bf16 a[128:131], a[0:3], a[112:115], a[128:131]
    buffer_load_dwordx4 a[240:243], v36, s[8:11], s62 offen sc1
    ds_read_b64_tr_b16 a[52:53], v34 offset:49152
    v_mfma_f32_16x16x32_bf16 a[128:131], a[4:7], a[116:119], a[128:131]
    v_cvt_pk_bf16_f32 v128, v128, v129
    v_cvt_pk_bf16_f32 v129, v130, v131
    v_mfma_f32_16x16x32_bf16 a[132:135], a[12:15], a[116:119], a[132:135]
    buffer_load_dwordx4 a[244:247], v54, s[8:11], s62 offen sc1
    buffer_load_dwordx4 a[248:251], v37, s[8:11], s62 offen sc1
    v_mfma_f32_16x16x32_bf16 a[132:135], a[8:11], a[112:115], a[132:135]
    v_cvt_pk_bf16_f32 v130, v224, v225
    v_cvt_pk_bf16_f32 v131, v226, v227
    v_mfma_f32_16x16x32_bf16 a[160:163], a[0:3], a[120:123], a[160:163]
    buffer_load_dwordx4 a[252:255], v55, s[8:11], s62 offen sc1
    ds_read_b64_tr_b16 a[54:55], v34 offset:51200
    v_mfma_f32_16x16x32_bf16 a[160:163], a[4:7], a[124:127], a[160:163]
    s_add_u32 s62, s62, 0x20000
    v_cvt_pk_bf16_f32 v144, v144, v145
    v_cvt_pk_bf16_f32 v145, v146, v147
    v_mfma_f32_16x16x32_bf16 a[164:167], a[12:15], a[124:127], a[164:167]
    ds_read_b64_tr_b16 a[56:57], v35 offset:32768
    v_cvt_pk_bf16_f32 v146, v240, v241
    v_mfma_f32_16x16x32_bf16 a[164:167], a[8:11], a[120:123], a[164:167]
    v_cvt_pk_bf16_f32 v147, v242, v243
    v_mfma_f32_16x16x32_bf16 v[68:71], a[16:19], a[64:67], v[68:71]
    s_add_u32 s52, s47, 0
    ds_read_b64_tr_b16 a[58:59], v35 offset:34816
    v_mfma_f32_16x16x32_bf16 v[68:71], a[20:23], a[68:71], v[68:71]
    v_accvgpr_read_b32 v56, a128
    v_accvgpr_read_b32 v57, a129
    v_mfma_f32_16x16x32_bf16 v[164:167], a[28:31], a[68:71], v[164:167]
    v_accvgpr_read_b32 v58, a130
    v_accvgpr_read_b32 v59, a131
    v_mfma_f32_16x16x32_bf16 v[164:167], a[24:27], a[64:67], v[164:167]
    buffer_store_dwordx4 v[64:67], v1, s[32:35], s52 offen offset:0 sc1
    ds_read_b64_tr_b16 a[60:61], v35 offset:49152
    v_mfma_f32_16x16x32_bf16 v[84:87], a[16:19], a[72:75], v[84:87]
    v_accvgpr_read_b32 v60, a132
    v_accvgpr_read_b32 v61, a133
    v_mfma_f32_16x16x32_bf16 v[84:87], a[20:23], a[76:79], v[84:87]
    v_accvgpr_read_b32 v62, a134
    v_accvgpr_read_b32 v63, a135
    v_mfma_f32_16x16x32_bf16 v[180:183], a[28:31], a[76:79], v[180:183]
    v_cvt_pk_bf16_f32 v160, v56, v57
    v_cvt_pk_bf16_f32 v161, v58, v59
    v_mfma_f32_16x16x32_bf16 v[180:183], a[24:27], a[72:75], v[180:183]
    ds_read_b64_tr_b16 a[62:63], v35 offset:51200
    v_cvt_pk_bf16_f32 v162, v60, v61
    v_mfma_f32_16x16x32_bf16 v[100:103], a[16:19], a[80:83], v[100:103]
    v_cvt_pk_bf16_f32 v163, v62, v63
    v_accvgpr_read_b32 v56, a160
    v_mfma_f32_16x16x32_bf16 v[100:103], a[20:23], a[84:87], v[100:103]
    v_accvgpr_read_b32 v57, a161
    v_accvgpr_read_b32 v58, a162
    v_mfma_f32_16x16x32_bf16 v[196:199], a[28:31], a[84:87], v[196:199]
    v_accvgpr_read_b32 v59, a163
    v_accvgpr_read_b32 v60, a164
    v_mfma_f32_16x16x32_bf16 v[196:199], a[24:27], a[80:83], v[196:199]
    s_add_u32 s52, s47, 8192
    v_accvgpr_read_b32 v61, a165
    v_accvgpr_read_b32 v62, a166
    v_mfma_f32_16x16x32_bf16 v[116:119], a[16:19], a[88:91], v[116:119]
    v_accvgpr_read_b32 v63, a167
    v_cvt_pk_bf16_f32 v176, v56, v57
    v_mfma_f32_16x16x32_bf16 v[116:119], a[20:23], a[92:95], v[116:119]
    v_cvt_pk_bf16_f32 v177, v58, v59
    v_cvt_pk_bf16_f32 v68, v68, v69
    v_mfma_f32_16x16x32_bf16 v[212:215], a[28:31], a[92:95], v[212:215]
    v_cvt_pk_bf16_f32 v178, v60, v61
    v_cvt_pk_bf16_f32 v69, v70, v71
    v_mfma_f32_16x16x32_bf16 v[212:215], a[24:27], a[88:91], v[212:215]
    v_cvt_pk_bf16_f32 v179, v62, v63
    v_cvt_pk_bf16_f32 v70, v164, v165
    v_mfma_f32_16x16x32_bf16 v[132:135], a[16:19], a[96:99], v[132:135]
    v_cvt_pk_bf16_f32 v71, v166, v167
    v_cvt_pk_bf16_f32 v84, v84, v85
    v_mfma_f32_16x16x32_bf16 v[132:135], a[20:23], a[100:103], v[132:135]
    buffer_store_dwordx4 v[96:99], v1, s[32:35], s52 offen offset:0 sc1
    v_cvt_pk_bf16_f32 v85, v86, v87
    v_mfma_f32_16x16x32_bf16 v[228:231], a[28:31], a[100:103], v[228:231]
    v_cvt_pk_bf16_f32 v86, v180, v181
    v_cvt_pk_bf16_f32 v87, v182, v183
    v_mfma_f32_16x16x32_bf16 v[228:231], a[24:27], a[96:99], v[228:231]
    v_cvt_pk_bf16_f32 v100, v100, v101
    v_cvt_pk_bf16_f32 v101, v102, v103
    v_mfma_f32_16x16x32_bf16 v[148:151], a[16:19], a[104:107], v[148:151]
    v_cvt_pk_bf16_f32 v102, v196, v197
    v_cvt_pk_bf16_f32 v103, v198, v199
    v_mfma_f32_16x16x32_bf16 v[148:151], a[20:23], a[108:111], v[148:151]
    v_cvt_pk_bf16_f32 v116, v116, v117
    v_cvt_pk_bf16_f32 v117, v118, v119
    v_mfma_f32_16x16x32_bf16 v[244:247], a[28:31], a[108:111], v[244:247]
    v_cvt_pk_bf16_f32 v118, v212, v213
    v_cvt_pk_bf16_f32 v119, v214, v215
    v_mfma_f32_16x16x32_bf16 v[244:247], a[24:27], a[104:107], v[244:247]
    s_add_u32 s52, s47, 524288
    v_mfma_f32_16x16x32_bf16 a[136:139], a[16:19], a[112:115], a[136:139]
    buffer_store_dwordx4 v[128:131], v1, s[32:35], s52 offen offset:0 sc1
    v_mfma_f32_16x16x32_bf16 a[136:139], a[20:23], a[116:119], a[136:139]
    v_cvt_pk_bf16_f32 v132, v132, v133
    v_cvt_pk_bf16_f32 v133, v134, v135
    v_mfma_f32_16x16x32_bf16 a[140:143], a[28:31], a[116:119], a[140:143]
    v_cvt_pk_bf16_f32 v134, v228, v229
    v_cvt_pk_bf16_f32 v135, v230, v231
    v_mfma_f32_16x16x32_bf16 a[140:143], a[24:27], a[112:115], a[140:143]
    v_mfma_f32_16x16x32_bf16 a[168:171], a[16:19], a[120:123], a[168:171]
    s_waitcnt lgkmcnt(0)
    v_mfma_f32_16x16x32_bf16 a[168:171], a[20:23], a[124:127], a[168:171]
    v_cvt_pk_bf16_f32 v148, v148, v149
    v_cvt_pk_bf16_f32 v149, v150, v151
    v_mfma_f32_16x16x32_bf16 a[172:175], a[28:31], a[124:127], a[172:175]
    v_cvt_pk_bf16_f32 v150, v244, v245
    v_cvt_pk_bf16_f32 v151, v246, v247
    v_mfma_f32_16x16x32_bf16 a[172:175], a[24:27], a[120:123], a[172:175]
    v_mfma_f32_16x16x32_bf16 v[72:75], a[32:35], a[64:67], v[72:75]
    v_mfma_f32_16x16x32_bf16 v[72:75], a[36:39], a[68:71], v[72:75]
    v_accvgpr_read_b32 v56, a136
    v_accvgpr_read_b32 v57, a137
    v_mfma_f32_16x16x32_bf16 v[168:171], a[44:47], a[68:71], v[168:171]
    s_add_u32 s52, s47, 532480
    v_accvgpr_read_b32 v58, a138
    v_accvgpr_read_b32 v59, a139
    v_mfma_f32_16x16x32_bf16 v[168:171], a[40:43], a[64:67], v[168:171]
    v_accvgpr_read_b32 v60, a140
    v_accvgpr_read_b32 v61, a141
    v_mfma_f32_16x16x32_bf16 v[88:91], a[32:35], a[72:75], v[88:91]
    v_accvgpr_read_b32 v62, a142
    v_accvgpr_read_b32 v63, a143
    v_mfma_f32_16x16x32_bf16 v[88:91], a[36:39], a[76:79], v[88:91]
    v_cvt_pk_bf16_f32 v164, v56, v57
    v_cvt_pk_bf16_f32 v165, v58, v59
    v_mfma_f32_16x16x32_bf16 v[184:187], a[44:47], a[76:79], v[184:187]
    buffer_store_dwordx4 v[160:163], v1, s[32:35], s52 offen offset:0 sc1
    v_mfma_f32_16x16x32_bf16 v[184:187], a[40:43], a[72:75], v[184:187]
    v_cvt_pk_bf16_f32 v166, v60, v61
    v_cvt_pk_bf16_f32 v167, v62, v63
    v_mfma_f32_16x16x32_bf16 v[104:107], a[32:35], a[80:83], v[104:107]
    v_accvgpr_read_b32 v56, a168
    v_accvgpr_read_b32 v57, a169
    v_mfma_f32_16x16x32_bf16 v[104:107], a[36:39], a[84:87], v[104:107]
    v_accvgpr_read_b32 v58, a170
    v_accvgpr_read_b32 v59, a171
    v_mfma_f32_16x16x32_bf16 v[200:203], a[44:47], a[84:87], v[200:203]
    v_accvgpr_read_b32 v60, a172
    v_accvgpr_read_b32 v61, a173
    v_mfma_f32_16x16x32_bf16 v[200:203], a[40:43], a[80:83], v[200:203]
    v_accvgpr_read_b32 v62, a174
    v_accvgpr_read_b32 v63, a175
    v_mfma_f32_16x16x32_bf16 v[120:123], a[32:35], a[88:91], v[120:123]
    v_cvt_pk_bf16_f32 v180, v56, v57
    v_cvt_pk_bf16_f32 v181, v58, v59
    v_mfma_f32_16x16x32_bf16 v[120:123], a[36:39], a[92:95], v[120:123]
    v_cvt_pk_bf16_f32 v72, v72, v73
    v_cvt_pk_bf16_f32 v182, v60, v61
    v_mfma_f32_16x16x32_bf16 v[216:219], a[44:47], a[92:95], v[216:219]
    s_add_u32 s52, s47, 0
    v_cvt_pk_bf16_f32 v73, v74, v75
    v_cvt_pk_bf16_f32 v183, v62, v63
    v_mfma_f32_16x16x32_bf16 v[216:219], a[40:43], a[88:91], v[216:219]
    v_cvt_pk_bf16_f32 v74, v168, v169
    v_cvt_pk_bf16_f32 v75, v170, v171
    v_mfma_f32_16x16x32_bf16 v[136:139], a[32:35], a[96:99], v[136:139]
    v_cvt_pk_bf16_f32 v88, v88, v89
    v_cvt_pk_bf16_f32 v89, v90, v91
    v_mfma_f32_16x16x32_bf16 v[136:139], a[36:39], a[100:103], v[136:139]
    v_cvt_pk_bf16_f32 v90, v184, v185
    v_cvt_pk_bf16_f32 v91, v186, v187
    v_mfma_f32_16x16x32_bf16 v[232:235], a[44:47], a[100:103], v[232:235]
    buffer_store_dwordx4 v[68:71], v1, s[32:35], s52 offen offset:1024 sc1
    v_mfma_f32_16x16x32_bf16 v[232:235], a[40:43], a[96:99], v[232:235]
    v_cvt_pk_bf16_f32 v104, v104, v105
    v_cvt_pk_bf16_f32 v105, v106, v107
    v_mfma_f32_16x16x32_bf16 v[152:155], a[32:35], a[104:107], v[152:155]
    v_cvt_pk_bf16_f32 v106, v200, v201
    v_cvt_pk_bf16_f32 v107, v202, v203
    v_mfma_f32_16x16x32_bf16 v[152:155], a[36:39], a[108:111], v[152:155]
    v_cvt_pk_bf16_f32 v120, v120, v121
    v_cvt_pk_bf16_f32 v121, v122, v123
    v_mfma_f32_16x16x32_bf16 v[248:251], a[44:47], a[108:111], v[248:251]
    v_cvt_pk_bf16_f32 v122, v216, v217
    v_cvt_pk_bf16_f32 v123, v218, v219
    v_mfma_f32_16x16x32_bf16 v[248:251], a[40:43], a[104:107], v[248:251]
    v_mfma_f32_16x16x32_bf16 a[144:147], a[32:35], a[112:115], a[144:147]
    v_mfma_f32_16x16x32_bf16 a[144:147], a[36:39], a[116:119], a[144:147]
    s_add_u32 s52, s47, 8192
    v_cvt_pk_bf16_f32 v136, v136, v137
    v_cvt_pk_bf16_f32 v137, v138, v139
    v_mfma_f32_16x16x32_bf16 a[148:151], a[44:47], a[116:119], a[148:151]
    v_cvt_pk_bf16_f32 v138, v232, v233
    v_cvt_pk_bf16_f32 v139, v234, v235
    v_mfma_f32_16x16x32_bf16 a[148:151], a[40:43], a[112:115], a[148:151]
    buffer_store_dwordx4 v[100:103], v1, s[32:35], s52 offen offset:1024 sc1
    v_mfma_f32_16x16x32_bf16 a[176:179], a[32:35], a[120:123], a[176:179]
    v_mfma_f32_16x16x32_bf16 a[176:179], a[36:39], a[124:127], a[176:179]
    v_cvt_pk_bf16_f32 v152, v152, v153
    v_cvt_pk_bf16_f32 v153, v154, v155
    v_mfma_f32_16x16x32_bf16 a[180:183], a[44:47], a[124:127], a[180:183]
    v_cvt_pk_bf16_f32 v154, v248, v249
    v_cvt_pk_bf16_f32 v155, v250, v251
    v_mfma_f32_16x16x32_bf16 a[180:183], a[40:43], a[120:123], a[180:183]
    v_mfma_f32_16x16x32_bf16 v[76:79], a[48:51], a[64:67], v[76:79]
    s_waitcnt vmcnt(16)
    s_barrier
    v_mfma_f32_16x16x32_bf16 v[76:79], a[52:55], a[68:71], v[76:79]
    ds_read_b64_tr_b16 a[0:1], v42 offset:32768
    v_accvgpr_read_b32 v56, a144
    v_mfma_f32_16x16x32_bf16 v[172:175], a[60:63], a[68:71], v[172:175]
    v_accvgpr_read_b32 v57, a145
    v_accvgpr_read_b32 v58, a146
    v_mfma_f32_16x16x32_bf16 v[172:175], a[56:59], a[64:67], v[172:175]
    ds_read_b64_tr_b16 a[2:3], v42 offset:33792
    v_accvgpr_read_b32 v59, a147
    v_mfma_f32_16x16x32_bf16 v[92:95], a[48:51], a[72:75], v[92:95]
    v_accvgpr_read_b32 v60, a148
    v_accvgpr_read_b32 v61, a149
    v_mfma_f32_16x16x32_bf16 v[92:95], a[52:55], a[76:79], v[92:95]
    s_add_u32 s52, s47, 524288
    ds_read_b64_tr_b16 a[4:5], v42 offset:40960
    v_accvgpr_read_b32 v62, a150
    v_mfma_f32_16x16x32_bf16 v[188:191], a[60:63], a[76:79], v[188:191]
    v_accvgpr_read_b32 v63, a151
    v_cvt_pk_bf16_f32 v168, v56, v57
    v_mfma_f32_16x16x32_bf16 v[188:191], a[56:59], a[72:75], v[188:191]
    v_cvt_pk_bf16_f32 v169, v58, v59
    v_cvt_pk_bf16_f32 v170, v60, v61
    v_mfma_f32_16x16x32_bf16 v[108:111], a[48:51], a[80:83], v[108:111]
    ds_read_b64_tr_b16 a[6:7], v42 offset:41984
    v_cvt_pk_bf16_f32 v171, v62, v63
    v_mfma_f32_16x16x32_bf16 v[108:111], a[52:55], a[84:87], v[108:111]
    v_accvgpr_read_b32 v56, a176
    v_accvgpr_read_b32 v57, a177
    v_mfma_f32_16x16x32_bf16 v[204:207], a[60:63], a[84:87], v[204:207]
    v_accvgpr_read_b32 v58, a178
    v_accvgpr_read_b32 v59, a179
    v_mfma_f32_16x16x32_bf16 v[204:207], a[56:59], a[80:83], v[204:207]
    ds_read_b64_tr_b16 a[8:9], v43 offset:32768
    v_accvgpr_read_b32 v60, a180
    v_mfma_f32_16x16x32_bf16 v[124:127], a[48:51], a[88:91], v[124:127]
    buffer_store_dwordx4 v[132:135], v1, s[32:35], s52 offen offset:1024 sc1
    v_accvgpr_read_b32 v61, a181
    v_mfma_f32_16x16x32_bf16 v[124:127], a[52:55], a[92:95], v[124:127]
    v_accvgpr_read_b32 v62, a182
    v_accvgpr_read_b32 v63, a183
    v_mfma_f32_16x16x32_bf16 v[220:223], a[60:63], a[92:95], v[220:223]
    ds_read_b64_tr_b16 a[10:11], v43 offset:33792
    v_cvt_pk_bf16_f32 v184, v56, v57
    v_mfma_f32_16x16x32_bf16 v[220:223], a[56:59], a[88:91], v[220:223]
    v_cvt_pk_bf16_f32 v185, v58, v59
    v_cvt_pk_bf16_f32 v76, v76, v77
    v_mfma_f32_16x16x32_bf16 v[140:143], a[48:51], a[96:99], v[140:143]
    s_add_u32 s52, s47, 532480
    v_cvt_pk_bf16_f32 v186, v60, v61
    v_cvt_pk_bf16_f32 v77, v78, v79
    v_mfma_f32_16x16x32_bf16 v[140:143], a[52:55], a[100:103], v[140:143]
    ds_read_b64_tr_b16 a[12:13], v43 offset:40960
    v_cvt_pk_bf16_f32 v187, v62, v63
    v_mfma_f32_16x16x32_bf16 v[236:239], a[60:63], a[100:103], v[236:239]
    v_cvt_pk_bf16_f32 v78, v172, v173
    v_cvt_pk_bf16_f32 v79, v174, v175
    v_mfma_f32_16x16x32_bf16 v[236:239], a[56:59], a[96:99], v[236:239]
    ds_read_b64_tr_b16 a[14:15], v43 offset:41984
    ds_read_b64_tr_b16 a[16:17], v44 offset:32768
    v_mfma_f32_16x16x32_bf16 v[156:159], a[48:51], a[104:107], v[156:159]
    v_cvt_pk_bf16_f32 v92, v92, v93
    v_cvt_pk_bf16_f32 v93, v94, v95
    v_mfma_f32_16x16x32_bf16 v[156:159], a[52:55], a[108:111], v[156:159]
    ds_read_b64_tr_b16 a[18:19], v44 offset:33792
    v_cvt_pk_bf16_f32 v94, v188, v189
    v_mfma_f32_16x16x32_bf16 v[252:255], a[60:63], a[108:111], v[252:255]
    ds_read_b64_tr_b16 a[20:21], v44 offset:40960
    v_cvt_pk_bf16_f32 v95, v190, v191
    v_mfma_f32_16x16x32_bf16 v[252:255], a[56:59], a[104:107], v[252:255]
    ds_read_b64_tr_b16 a[22:23], v44 offset:41984
    v_cvt_pk_bf16_f32 v108, v108, v109
    v_mfma_f32_16x16x32_bf16 a[152:155], a[48:51], a[112:115], a[152:155]
    v_cvt_pk_bf16_f32 v109, v110, v111
    v_cvt_pk_bf16_f32 v110, v204, v205
    v_mfma_f32_16x16x32_bf16 a[152:155], a[52:55], a[116:119], a[152:155]
    ds_read_b64_tr_b16 a[24:25], v45 offset:32768
    v_cvt_pk_bf16_f32 v111, v206, v207
    v_mfma_f32_16x16x32_bf16 a[156:159], a[60:63], a[116:119], a[156:159]
    buffer_store_dwordx4 v[164:167], v1, s[32:35], s52 offen offset:1024 sc1
    ds_read_b64_tr_b16 a[26:27], v45 offset:33792
    v_mfma_f32_16x16x32_bf16 a[156:159], a[56:59], a[112:115], a[156:159]
    ds_read_b64_tr_b16 a[28:29], v45 offset:40960
    v_cvt_pk_bf16_f32 v124, v124, v125
    v_mfma_f32_16x16x32_bf16 a[184:187], a[48:51], a[120:123], a[184:187]
    v_cvt_pk_bf16_f32 v125, v126, v127
    v_cvt_pk_bf16_f32 v126, v220, v221
    v_mfma_f32_16x16x32_bf16 a[184:187], a[52:55], a[124:127], a[184:187]
    ds_read_b64_tr_b16 a[30:31], v45 offset:41984
    v_cvt_pk_bf16_f32 v127, v222, v223
    v_mfma_f32_16x16x32_bf16 a[188:191], a[60:63], a[124:127], a[188:191]
    v_cvt_pk_bf16_f32 v140, v140, v141
    v_cvt_pk_bf16_f32 v141, v142, v143
    v_mfma_f32_16x16x32_bf16 a[188:191], a[56:59], a[120:123], a[188:191]
    v_cvt_pk_bf16_f32 v142, v236, v237
    v_cvt_pk_bf16_f32 v143, v238, v239
    v_cvt_pk_bf16_f32 v156, v156, v157
    v_cvt_pk_bf16_f32 v157, v158, v159
    v_cvt_pk_bf16_f32 v158, v252, v253
    v_cvt_pk_bf16_f32 v159, v254, v255
    v_accvgpr_read_b32 v56, a152
    v_accvgpr_read_b32 v57, a153
    v_accvgpr_read_b32 v58, a154
    v_accvgpr_read_b32 v59, a155
    v_accvgpr_read_b32 v60, a156
    v_accvgpr_read_b32 v61, a157
    v_accvgpr_read_b32 v62, a158
    v_accvgpr_read_b32 v63, a159
    v_cvt_pk_bf16_f32 v172, v56, v57
    v_cvt_pk_bf16_f32 v173, v58, v59
    v_cvt_pk_bf16_f32 v174, v60, v61
    v_cvt_pk_bf16_f32 v175, v62, v63
    v_accvgpr_read_b32 v56, a184
    v_accvgpr_read_b32 v57, a185
    v_accvgpr_read_b32 v58, a186
    v_accvgpr_read_b32 v59, a187
    v_accvgpr_read_b32 v60, a188
    v_accvgpr_read_b32 v61, a189
    v_accvgpr_read_b32 v62, a190
    v_accvgpr_read_b32 v63, a191
    v_cvt_pk_bf16_f32 v188, v56, v57
    v_cvt_pk_bf16_f32 v189, v58, v59
    v_cvt_pk_bf16_f32 v190, v60, v61
    v_cvt_pk_bf16_f32 v191, v62, v63
    s_branch k12_join_7
k12_v_6:
k12_loop_28:
    v_mfma_f32_16x16x32_bf16 v[64:67], a[192:195], a[0:3], v[64:67]
    v_mfma_f32_16x16x32_bf16 v[64:67], a[196:199], a[4:7], v[64:67]
    ds_read_b64_tr_b16 a[32:33], v32 offset:0
    v_mfma_f32_16x16x32_bf16 v[160:163], a[204:207], a[4:7], v[160:163]
    v_mfma_f32_16x16x32_bf16 v[160:163], a[200:203], a[0:3], v[160:163]
    ds_read_b64_tr_b16 a[34:35], v32 offset:2048
    v_mfma_f32_16x16x32_bf16 v[96:99], a[208:211], a[0:3], v[96:99]
    s_cmp_eq_u32 s51, s46
    s_cbranch_scc1 k12_ool_30
k12_oolret_31:
    v_mfma_f32_16x16x32_bf16 v[96:99], a[212:215], a[4:7], v[96:99]
    v_mfma_f32_16x16x32_bf16 v[192:195], a[220:223], a[4:7], v[192:195]
    ds_read_b64_tr_b16 a[36:37], v32 offset:16384
    v_mfma_f32_16x16x32_bf16 v[192:195], a[216:219], a[0:3], v[192:195]
    v_mfma_f32_16x16x32_bf16 v[128:131], a[224:227], a[0:3], v[128:131]
    v_mfma_f32_16x16x32_bf16 v[128:131], a[228:231], a[4:7], v[128:131]
    ds_read_b64_tr_b16 a[38:39], v32 offset:18432
    v_mfma_f32_16x16x32_bf16 v[224:227], a[236:239], a[4:7], v[224:227]
    v_mfma_f32_16x16x32_bf16 v[224:227], a[232:235], a[0:3], v[224:227]
    v_mfma_f32_16x16x32_bf16 a[128:131], a[240:243], a[0:3], a[128:131]
    ds_read_b64_tr_b16 a[40:41], v33 offset:0
    v_mfma_f32_16x16x32_bf16 a[128:131], a[244:247], a[4:7], a[128:131]
    v_mfma_f32_16x16x32_bf16 a[132:135], a[252:255], a[4:7], a[132:135]
    v_mfma_f32_16x16x32_bf16 a[132:135], a[248:251], a[0:3], a[132:135]
    ds_read_b64_tr_b16 a[42:43], v33 offset:2048
    v_mfma_f32_16x16x32_bf16 a[140:143], a[248:251], a[8:11], a[140:143]
    v_mfma_f32_16x16x32_bf16 a[140:143], a[252:255], a[12:15], a[140:143]
    v_mfma_f32_16x16x32_bf16 a[136:139], a[244:247], a[12:15], a[136:139]
    ds_read_b64_tr_b16 a[44:45], v33 offset:16384
    v_mfma_f32_16x16x32_bf16 a[136:139], a[240:243], a[8:11], a[136:139]
    v_mfma_f32_16x16x32_bf16 v[228:231], a[232:235], a[8:11], v[228:231]
    v_mfma_f32_16x16x32_bf16 v[228:231], a[236:239], a[12:15], v[228:231]
    ds_read_b64_tr_b16 a[46:47], v33 offset:18432
    v_mfma_f32_16x16x32_bf16 v[132:135], a[228:231], a[12:15], v[132:135]
    v_mfma_f32_16x16x32_bf16 v[132:135], a[224:227], a[8:11], v[132:135]
    ds_read_b64_tr_b16 a[48:49], v34 offset:0
    v_mfma_f32_16x16x32_bf16 v[196:199], a[216:219], a[8:11], v[196:199]
    v_mfma_f32_16x16x32_bf16 v[196:199], a[220:223], a[12:15], v[196:199]
    v_mfma_f32_16x16x32_bf16 v[100:103], a[212:215], a[12:15], v[100:103]
    ds_read_b64_tr_b16 a[50:51], v34 offset:2048
    v_mfma_f32_16x16x32_bf16 v[100:103], a[208:211], a[8:11], v[100:103]
    v_mfma_f32_16x16x32_bf16 v[164:167], a[200:203], a[8:11], v[164:167]
    v_mfma_f32_16x16x32_bf16 v[164:167], a[204:207], a[12:15], v[164:167]
    ds_read_b64_tr_b16 a[52:53], v34 offset:16384
    v_mfma_f32_16x16x32_bf16 v[68:71], a[196:199], a[12:15], v[68:71]
    v_mfma_f32_16x16x32_bf16 v[68:71], a[192:195], a[8:11], v[68:71]
    v_mfma_f32_16x16x32_bf16 v[72:75], a[192:195], a[16:19], v[72:75]
    ds_read_b64_tr_b16 a[54:55], v34 offset:18432
    v_mfma_f32_16x16x32_bf16 v[72:75], a[196:199], a[20:23], v[72:75]
    v_mfma_f32_16x16x32_bf16 v[168:171], a[204:207], a[20:23], v[168:171]
    v_mfma_f32_16x16x32_bf16 v[168:171], a[200:203], a[16:19], v[168:171]
    ds_read_b64_tr_b16 a[56:57], v35 offset:0
    v_mfma_f32_16x16x32_bf16 v[104:107], a[208:211], a[16:19], v[104:107]
    v_mfma_f32_16x16x32_bf16 v[104:107], a[212:215], a[20:23], v[104:107]
    v_mfma_f32_16x16x32_bf16 v[200:203], a[220:223], a[20:23], v[200:203]
    ds_read_b64_tr_b16 a[58:59], v35 offset:2048
    v_mfma_f32_16x16x32_bf16 v[200:203], a[216:219], a[16:19], v[200:203]
    v_mfma_f32_16x16x32_bf16 v[136:139], a[224:227], a[16:19], v[136:139]
    v_mfma_f32_16x16x32_bf16 v[136:139], a[228:231], a[20:23], v[136:139]
    ds_read_b64_tr_b16 a[60:61], v35 offset:16384
    v_mfma_f32_16x16x32_bf16 v[232:235], a[236:239], a[20:23], v[232:235]
    v_mfma_f32_16x16x32_bf16 v[232:235], a[232:235], a[16:19], v[232:235]
    v_mfma_f32_16x16x32_bf16 a[144:147], a[240:243], a[16:19], a[144:147]
    ds_read_b64_tr_b16 a[62:63], v35 offset:18432
    v_mfma_f32_16x16x32_bf16 a[144:147], a[244:247], a[20:23], a[144:147]
    v_mfma_f32_16x16x32_bf16 a[148:151], a[252:255], a[20:23], a[148:151]
    v_mfma_f32_16x16x32_bf16 a[148:151], a[248:251], a[16:19], a[148:151]
    v_mfma_f32_16x16x32_bf16 a[156:159], a[248:251], a[24:27], a[156:159]
    v_mfma_f32_16x16x32_bf16 a[156:159], a[252:255], a[28:31], a[156:159]
    v_mfma_f32_16x16x32_bf16 a[152:155], a[244:247], a[28:31], a[152:155]
    v_mfma_f32_16x16x32_bf16 a[152:155], a[240:243], a[24:27], a[152:155]
    v_mfma_f32_16x16x32_bf16 v[236:239], a[232:235], a[24:27], v[236:239]
    v_mfma_f32_16x16x32_bf16 v[236:239], a[236:239], a[28:31], v[236:239]
    v_mfma_f32_16x16x32_bf16 v[140:143], a[228:231], a[28:31], v[140:143]
    v_mfma_f32_16x16x32_bf16 v[140:143], a[224:227], a[24:27], v[140:143]
    v_mfma_f32_16x16x32_bf16 v[204:207], a[216:219], a[24:27], v[204:207]
    v_mfma_f32_16x16x32_bf16 v[204:207], a[220:223], a[28:31], v[204:207]
    v_mfma_f32_16x16x32_bf16 v[108:111], a[212:215], a[28:31], v[108:111]
    v_mfma_f32_16x16x32_bf16 v[108:111], a[208:211], a[24:27], v[108:111]
    v_mfma_f32_16x16x32_bf16 v[172:175], a[200:203], a[24:27], v[172:175]
    v_mfma_f32_16x16x32_bf16 v[172:175], a[204:207], a[28:31], v[172:175]
    v_mfma_f32_16x16x32_bf16 v[76:79], a[196:199], a[28:31], v[76:79]
    v_mfma_f32_16x16x32_bf16 v[76:79], a[192:195], a[24:27], v[76:79]
    s_waitcnt vmcnt(0) lgkmcnt(0)
    s_cmp_eq_u32 s51, s46
    s_cbranch_scc1 k12_ool_34
k12_oolret_35:
    s_barrier
    v_mfma_f32_16x16x32_bf16 v[80:83], a[192:195], a[32:35], v[80:83]
    s_cmp_ge_u32 s49, 1024
    s_cselect_b32 s18, 0, s18
    s_cselect_b32 s22, 0, s22
    v_mfma_f32_16x16x32_bf16 v[80:83], a[196:199], a[36:39], v[80:83]
    s_add_u32 m0, s48, 0
    ds_read_b128 a[64:67], v26 offset:32768
    v_mfma_f32_16x16x32_bf16 v[176:179], a[204:207], a[36:39], v[176:179]
    buffer_load_dwordx4 v10, s[16:19], s49 offen offset:0 lds
    ds_read_b64_tr_b16 a[0:1], v28 offset:32768
    v_mfma_f32_16x16x32_bf16 v[176:179], a[200:203], a[32:35], v[176:179]
    ds_read_b128 a[68:71], v27 offset:32768
    v_mfma_f32_16x16x32_bf16 v[112:115], a[208:211], a[32:35], v[112:115]
    buffer_load_dwordx4 v11, s[16:19], s49 offen offset:1024 lds
    v_mfma_f32_16x16x32_bf16 v[112:115], a[212:215], a[36:39], v[112:115]
    ds_read_b64_tr_b16 a[2:3], v28 offset:34816
    v_mfma_f32_16x16x32_bf16 v[208:211], a[220:223], a[36:39], v[208:211]
    v_mfma_f32_16x16x32_bf16 v[208:211], a[216:219], a[32:35], v[208:211]
    ds_read_b128 a[72:75], v26 offset:34816
    v_mfma_f32_16x16x32_bf16 v[144:147], a[224:227], a[32:35], v[144:147]
    buffer_load_dwordx4 v12, s[16:19], s49 offen offset:2048 lds
    ds_read_b64_tr_b16 a[4:5], v28 offset:49152
    v_mfma_f32_16x16x32_bf16 v[144:147], a[228:231], a[36:39], v[144:147]
    v_mfma_f32_16x16x32_bf16 v[240:243], a[236:239], a[36:39], v[240:243]
    ds_read_b128 a[76:79], v27 offset:34816
    v_mfma_f32_16x16x32_bf16 v[240:243], a[232:235], a[32:35], v[240:243]
    buffer_load_dwordx4 v13, s[16:19], s49 offen offset:3072 lds
    v_mfma_f32_16x16x32_bf16 a[160:163], a[240:243], a[32:35], a[160:163]
    ds_read_b64_tr_b16 a[6:7], v28 offset:51200
    v_mfma_f32_16x16x32_bf16 a[160:163], a[244:247], a[36:39], a[160:163]
    s_add_u32 m0, s48, 4096
    ds_read_b128 a[80:83], v26 offset:36864
    v_mfma_f32_16x16x32_bf16 a[164:167], a[252:255], a[36:39], a[164:167]
    v_mfma_f32_16x16x32_bf16 a[164:167], a[248:251], a[32:35], a[164:167]
    buffer_load_dwordx4 v14, s[16:19], s49 offen offset:0 lds
    ds_read_b64_tr_b16 a[8:9], v29 offset:32768
    v_mfma_f32_16x16x32_bf16 a[172:175], a[248:251], a[40:43], a[172:175]
    v_mfma_f32_16x16x32_bf16 a[172:175], a[252:255], a[44:47], a[172:175]
    ds_read_b128 a[84:87], v27 offset:36864
    v_mfma_f32_16x16x32_bf16 a[168:171], a[244:247], a[44:47], a[168:171]
    buffer_load_dwordx4 v15, s[16:19], s49 offen offset:1024 lds
    ds_read_b64_tr_b16 a[10:11], v29 offset:34816
    v_mfma_f32_16x16x32_bf16 a[168:171], a[240:243], a[40:43], a[168:171]
    v_mfma_f32_16x16x32_bf16 v[244:247], a[232:235], a[40:43], v[244:247]
    ds_read_b128 a[88:91], v26 offset:38912
    v_mfma_f32_16x16x32_bf16 v[244:247], a[236:239], a[44:47], v[244:247]
    v_mfma_f32_16x16x32_bf16 v[148:151], a[228:231], a[44:47], v[148:151]
    buffer_load_dwordx4 v16, s[16:19], s49 offen offset:2048 lds
    ds_read_b64_tr_b16 a[12:13], v29 offset:49152
    v_mfma_f32_16x16x32_bf16 v[148:151], a[224:227], a[40:43], v[148:151]
    ds_read_b128 a[92:95], v27 offset:38912
    v_mfma_f32_16x16x32_bf16 v[212:215], a[216:219], a[40:43], v[212:215]
    v_mfma_f32_16x16x32_bf16 v[212:215], a[220:223], a[44:47], v[212:215]
    buffer_load_dwordx4 v17, s[16:19], s49 offen offset:3072 lds
    ds_read_b64_tr_b16 a[14:15], v29 offset:51200
    v_mfma_f32_16x16x32_bf16 v[116:119], a[212:215], a[44:47], v[116:119]
    ds_read_b128 a[96:99], v26 offset:40960
    v_mfma_f32_16x16x32_bf16 v[116:119], a[208:211], a[40:43], v[116:119]
    s_add_u32 s49, s49, 128
    v_mfma_f32_16x16x32_bf16 v[180:183], a[200:203], a[40:43], v[180:183]
    s_add_u32 m0, s48, 65536
    ds_read_b64_tr_b16 a[16:17], v30 offset:32768
    v_mfma_f32_16x16x32_bf16 v[180:183], a[204:207], a[44:47], v[180:183]
    buffer_load_dwordx4 v18, s[20:23], s50 offen offset:0 lds
    v_mfma_f32_16x16x32_bf16 v[84:87], a[196:199], a[44:47], v[84:87]
    ds_read_b128 a[100:103], v27 offset:40960
    v_mfma_f32_16x16x32_bf16 v[84:87], a[192:195], a[40:43], v[84:87]
    ds_read_b64_tr_b16 a[18:19], v30 offset:34816
    v_mfma_f32_16x16x32_bf16 v[88:91], a[192:195], a[48:51], v[88:91]
    buffer_load_dwordx4 v19, s[20:23], s50 offen offset:1024 lds
    v_mfma_f32_16x16x32_bf16 v[88:91], a[196:199], a[52:55], v[88:91]
    ds_read_b128 a[104:107], v26 offset:43008
    v_mfma_f32_16x16x32_bf16 v[184:187], a[204:207], a[52:55], v[184:187]
    v_mfma_f32_16x16x32_bf16 v[184:187], a[200:203], a[48:51], v[184:187]
    buffer_load_dwordx4 v20, s[20:23], s50 offen offset:2048 lds
    ds_read_b64_tr_b16 a[20:21], v30 offset:49152
    v_mfma_f32_16x16x32_bf16 v[120:123], a[208:211], a[48:51], v[120:123]
    ds_read_b128 a[108:111], v27 offset:43008
    v_mfma_f32_16x16x32_bf16 v[120:123], a[212:215], a[52:55], v[120:123]
    v_mfma_f32_16x16x32_bf16 v[216:219], a[220:223], a[52:55], v[216:219]
    ds_read_b64_tr_b16 a[22:23], v30 offset:51200
    v_mfma_f32_16x16x32_bf16 v[216:219], a[216:219], a[48:51], v[216:219]
    buffer_load_dwordx4 v21, s[20:23], s50 offen offset:3072 lds
    v_mfma_f32_16x16x32_bf16 v[152:155], a[224:227], a[48:51], v[152:155]
    s_add_u32 m0, s48, 69632
    ds_read_b128 a[112:115], v26 offset:45056
    v_mfma_f32_16x16x32_bf16 v[152:155], a[228:231], a[52:55], v[152:155]
    ds_read_b64_tr_b16 a[24:25], v31 offset:32768
    v_mfma_f32_16x16x32_bf16 v[248:251], a[236:239], a[52:55], v[248:251]
    buffer_load_dwordx4 v22, s[20:23], s50 offen offset:0 lds
    v_mfma_f32_16x16x32_bf16 v[248:251], a[232:235], a[48:51], v[248:251]
    ds_read_b128 a[116:119], v27 offset:45056
    v_mfma_f32_16x16x32_bf16 a[176:179], a[240:243], a[48:51], a[176:179]
    v_mfma_f32_16x16x32_bf16 a[176:179], a[244:247], a[52:55], a[176:179]
    ds_read_b64_tr_b16 a[26:27], v31 offset:34816
    v_mfma_f32_16x16x32_bf16 a[180:183], a[252:255], a[52:55], a[180:183]
    buffer_load_dwordx4 v23, s[20:23], s50 offen offset:1024 lds
    ds_read_b128 a[120:123], v26 offset:47104
    v_mfma_f32_16x16x32_bf16 a[180:183], a[248:251], a[48:51], a[180:183]
    v_mfma_f32_16x16x32_bf16 a[188:191], a[248:251], a[56:59], a[188:191]
    ds_read_b64_tr_b16 a[28:29], v31 offset:49152
    v_mfma_f32_16x16x32_bf16 a[188:191], a[252:255], a[60:63], a[188:191]
    buffer_load_dwordx4 v24, s[20:23], s50 offen offset:2048 lds
    v_mfma_f32_16x16x32_bf16 a[184:187], a[244:247], a[60:63], a[184:187]
    ds_read_b128 a[124:127], v27 offset:47104
    v_mfma_f32_16x16x32_bf16 a[184:187], a[240:243], a[56:59], a[184:187]
    ds_read_b64_tr_b16 a[30:31], v31 offset:51200
    v_mfma_f32_16x16x32_bf16 v[252:255], a[232:235], a[56:59], v[252:255]
    v_mfma_f32_16x16x32_bf16 v[252:255], a[236:239], a[60:63], v[252:255]
    buffer_load_dwordx4 v25, s[20:23], s50 offen offset:3072 lds
    v_mfma_f32_16x16x32_bf16 v[156:159], a[228:231], a[60:63], v[156:159]
    v_mfma_f32_16x16x32_bf16 v[156:159], a[224:227], a[56:59], v[156:159]
    s_add_u32 s50, s50, 0x80000
    v_mfma_f32_16x16x32_bf16 v[220:223], a[216:219], a[56:59], v[220:223]
    v_mfma_f32_16x16x32_bf16 v[220:223], a[220:223], a[60:63], v[220:223]
    s_cmp_eq_u32 s51, s53
    s_cbranch_scc1 k12_ool_36
k12_oolret_37:
    v_mfma_f32_16x16x32_bf16 v[124:127], a[212:215], a[60:63], v[124:127]
    s_cmp_eq_u32 s51, s63
    s_cbranch_scc1 k12_ool_38
k12_oolret_39:
    v_mfma_f32_16x16x32_bf16 v[124:127], a[208:211], a[56:59], v[124:127]
    s_cmp_eq_u32 s51, 6
    s_cbranch_scc1 k12_ool_40
k12_oolret_41:
    v_mfma_f32_16x16x32_bf16 v[188:191], a[200:203], a[56:59], v[188:191]
    v_mfma_f32_16x16x32_bf16 v[188:191], a[204:207], a[60:63], v[188:191]
    s_add_u32 s51, s51, 1
    v_mfma_f32_16x16x32_bf16 v[92:95], a[196:199], a[60:63], v[92:95]
    v_mfma_f32_16x16x32_bf16 v[92:95], a[192:195], a[56:59], v[92:95]
    s_waitcnt lgkmcnt(0)
    s_cmp_eq_u32 s51, 7
    s_cbranch_scc1 k12_last_29
    v_mfma_f32_16x16x32_bf16 v[64:67], a[64:67], a[0:3], v[64:67]
    v_mfma_f32_16x16x32_bf16 v[64:67], a[68:71], a[4:7], v[64:67]
    ds_read_b64_tr_b16 a[32:33], v32 offset:32768
    v_mfma_f32_16x16x32_bf16 v[160:163], a[76:79], a[4:7], v[160:163]
    v_mfma_f32_16x16x32_bf16 v[160:163], a[72:75], a[0:3], v[160:163]
    ds_read_b64_tr_b16 a[34:35], v32 offset:34816
    v_mfma_f32_16x16x32_bf16 v[96:99], a[80:83], a[0:3], v[96:99]
    v_mfma_f32_16x16x32_bf16 v[96:99], a[84:87], a[4:7], v[96:99]
    v_mfma_f32_16x16x32_bf16 v[192:195], a[92:95], a[4:7], v[192:195]
    ds_read_b64_tr_b16 a[36:37], v32 offset:49152
    v_mfma_f32_16x16x32_bf16 v[192:195], a[88:91], a[0:3], v[192:195]
    v_mfma_f32_16x16x32_bf16 v[128:131], a[96:99], a[0:3], v[128:131]
    v_mfma_f32_16x16x32_bf16 v[128:131], a[100:103], a[4:7], v[128:131]
    ds_read_b64_tr_b16 a[38:39], v32 offset:51200
    v_mfma_f32_16x16x32_bf16 v[224:227], a[108:111], a[4:7], v[224:227]
    v_mfma_f32_16x16x32_bf16 v[224:227], a[104:107], a[0:3], v[224:227]
    v_mfma_f32_16x16x32_bf16 a[128:131], a[112:115], a[0:3], a[128:131]
    ds_read_b64_tr_b16 a[40:41], v33 offset:32768
    v_mfma_f32_16x16x32_bf16 a[128:131], a[116:119], a[4:7], a[128:131]
    v_mfma_f32_16x16x32_bf16 a[132:135], a[124:127], a[4:7], a[132:135]
    v_mfma_f32_16x16x32_bf16 a[132:135], a[120:123], a[0:3], a[132:135]
    ds_read_b64_tr_b16 a[42:43], v33 offset:34816
    v_mfma_f32_16x16x32_bf16 a[140:143], a[120:123], a[8:11], a[140:143]
    v_mfma_f32_16x16x32_bf16 a[140:143], a[124:127], a[12:15], a[140:143]
    v_mfma_f32_16x16x32_bf16 a[136:139], a[116:119], a[12:15], a[136:139]
    ds_read_b64_tr_b16 a[44:45], v33 offset:49152
    v_mfma_f32_16x16x32_bf16 a[136:139], a[112:115], a[8:11], a[136:139]
    v_mfma_f32_16x16x32_bf16 v[228:231], a[104:107], a[8:11], v[228:231]
    v_mfma_f32_16x16x32_bf16 v[228:231], a[108:111], a[12:15], v[228:231]
    ds_read_b64_tr_b16 a[46:47], v33 offset:51200
    v_mfma_f32_16x16x32_bf16 v[132:135], a[100:103], a[12:15], v[132:135]
    v_mfma_f32_16x16x32_bf16 v[132:135], a[96:99], a[8:11], v[132:135]
    ds_read_b64_tr_b16 a[48:49], v34 offset:32768
    v_mfma_f32_16x16x32_bf16 v[196:199], a[88:91], a[8:11], v[196:199]
    v_mfma_f32_16x16x32_bf16 v[196:199], a[92:95], a[12:15], v[196:199]
    v_mfma_f32_16x16x32_bf16 v[100:103], a[84:87], a[12:15], v[100:103]
    ds_read_b64_tr_b16 a[50:51], v34 offset:34816
    v_mfma_f32_16x16x32_bf16 v[100:103], a[80:83], a[8:11], v[100:103]
    v_mfma_f32_16x16x32_bf16 v[164:167], a[72:75], a[8:11], v[164:167]
    v_mfma_f32_16x16x32_bf16 v[164:167], a[76:79], a[12:15], v[164:167]
    ds_read_b64_tr_b16 a[52:53], v34 offset:49152
    v_mfma_f32_16x16x32_bf16 v[68:71], a[68:71], a[12:15], v[68:71]
    v_mfma_f32_16x16x32_bf16 v[68:71], a[64:67], a[8:11], v[68:71]
    v_mfma_f32_16x16x32_bf16 v[72:75], a[64:67], a[16:19], v[72:75]
    ds_read_b64_tr_b16 a[54:55], v34 offset:51200
    v_mfma_f32_16x16x32_bf16 v[72:75], a[68:71], a[20:23], v[72:75]
    v_mfma_f32_16x16x32_bf16 v[168:171], a[76:79], a[20:23], v[168:171]
    v_mfma_f32_16x16x32_bf16 v[168:171], a[72:75], a[16:19], v[168:171]
    ds_read_b64_tr_b16 a[56:57], v35 offset:32768
    v_mfma_f32_16x16x32_bf16 v[104:107], a[80:83], a[16:19], v[104:107]
    v_mfma_f32_16x16x32_bf16 v[104:107], a[84:87], a[20:23], v[104:107]
    v_mfma_f32_16x16x32_bf16 v[200:203], a[92:95], a[20:23], v[200:203]
    ds_read_b64_tr_b16 a[58:59], v35 offset:34816
    v_mfma_f32_16x16x32_bf16 v[200:203], a[88:91], a[16:19], v[200:203]
    v_mfma_f32_16x16x32_bf16 v[136:139], a[96:99], a[16:19], v[136:139]
    v_mfma_f32_16x16x32_bf16 v[136:139], a[100:103], a[20:23], v[136:139]
    ds_read_b64_tr_b16 a[60:61], v35 offset:49152
    v_mfma_f32_16x16x32_bf16 v[232:235], a[108:111], a[20:23], v[232:235]
    v_mfma_f32_16x16x32_bf16 v[232:235], a[104:107], a[16:19], v[232:235]
    v_mfma_f32_16x16x32_bf16 a[144:147], a[112:115], a[16:19], a[144:147]
    ds_read_b64_tr_b16 a[62:63], v35 offset:51200
    v_mfma_f32_16x16x32_bf16 a[144:147], a[116:119], a[20:23], a[144:147]
    v_mfma_f32_16x16x32_bf16 a[148:151], a[124:127], a[20:23], a[148:151]
    v_mfma_f32_16x16x32_bf16 a[148:151], a[120:123], a[16:19], a[148:151]
    v_mfma_f32_16x16x32_bf16 a[156:159], a[120:123], a[24:27], a[156:159]
    v_mfma_f32_16x16x32_bf16 a[156:159], a[124:127], a[28:31], a[156:159]
    v_mfma_f32_16x16x32_bf16 a[152:155], a[116:119], a[28:31], a[152:155]
    v_mfma_f32_16x16x32_bf16 a[152:155], a[112:115], a[24:27], a[152:155]
    v_mfma_f32_16x16x32_bf16 v[236:239], a[104:107], a[24:27], v[236:239]
    v_mfma_f32_16x16x32_bf16 v[236:239], a[108:111], a[28:31], v[236:239]
    v_mfma_f32_16x16x32_bf16 v[140:143], a[100:103], a[28:31], v[140:143]
    v_mfma_f32_16x16x32_bf16 v[140:143], a[96:99], a[24:27], v[140:143]
    v_mfma_f32_16x16x32_bf16 v[204:207], a[88:91], a[24:27], v[204:207]
    v_mfma_f32_16x16x32_bf16 v[204:207], a[92:95], a[28:31], v[204:207]
    v_mfma_f32_16x16x32_bf16 v[108:111], a[84:87], a[28:31], v[108:111]
    v_mfma_f32_16x16x32_bf16 v[108:111], a[80:83], a[24:27], v[108:111]
    v_mfma_f32_16x16x32_bf16 v[172:175], a[72:75], a[24:27], v[172:175]
    v_mfma_f32_16x16x32_bf16 v[172:175], a[76:79], a[28:31], v[172:175]
    v_mfma_f32_16x16x32_bf16 v[76:79], a[68:71], a[28:31], v[76:79]
    v_mfma_f32_16x16x32_bf16 v[76:79], a[64:67], a[24:27], v[76:79]
    s_waitcnt vmcnt(0) lgkmcnt(0)
    s_barrier
    v_mfma_f32_16x16x32_bf16 v[80:83], a[64:67], a[32:35], v[80:83]
    v_mfma_f32_16x16x32_bf16 v[80:83], a[68:71], a[36:39], v[80:83]
    s_add_u32 m0, s48, 32768
    ds_read_b128 a[192:195], v26 offset:0
    v_mfma_f32_16x16x32_bf16 v[176:179], a[76:79], a[36:39], v[176:179]
    buffer_load_dwordx4 v10, s[16:19], s49 offen offset:0 lds
    ds_read_b64_tr_b16 a[0:1], v28 offset:0
    v_mfma_f32_16x16x32_bf16 v[176:179], a[72:75], a[32:35], v[176:179]
    ds_read_b128 a[196:199], v27 offset:0
    v_mfma_f32_16x16x32_bf16 v[112:115], a[80:83], a[32:35], v[112:115]
    buffer_load_dwordx4 v11, s[16:19], s49 offen offset:1024 lds
    v_mfma_f32_16x16x32_bf16 v[112:115], a[84:87], a[36:39], v[112:115]
    ds_read_b64_tr_b16 a[2:3], v28 offset:2048
    v_mfma_f32_16x16x32_bf16 v[208:211], a[92:95], a[36:39], v[208:211]
    v_mfma_f32_16x16x32_bf16 v[208:211], a[88:91], a[32:35], v[208:211]
    ds_read_b128 a[200:203], v26 offset:2048
    v_mfma_f32_16x16x32_bf16 v[144:147], a[96:99], a[32:35], v[144:147]
    buffer_load_dwordx4 v12, s[16:19], s49 offen offset:2048 lds
    ds_read_b64_tr_b16 a[4:5], v28 offset:16384
    v_mfma_f32_16x16x32_bf16 v[144:147], a[100:103], a[36:39], v[144:147]
    v_mfma_f32_16x16x32_bf16 v[240:243], a[108:111], a[36:39], v[240:243]
    ds_read_b128 a[204:207], v27 offset:2048
    v_mfma_f32_16x16x32_bf16 v[240:243], a[104:107], a[32:35], v[240:243]
    buffer_load_dwordx4 v13, s[16:19], s49 offen offset:3072 lds
    v_mfma_f32_16x16x32_bf16 a[160:163], a[112:115], a[32:35], a[160:163]
    ds_read_b64_tr_b16 a[6:7], v28 offset:18432
    v_mfma_f32_16x16x32_bf16 a[160:163], a[116:119], a[36:39], a[160:163]
    s_add_u32 m0, s48, 36864
    ds_read_b128 a[208:211], v26 offset:4096
    v_mfma_f32_16x16x32_bf16 a[164:167], a[124:127], a[36:39], a[164:167]
    v_mfma_f32_16x16x32_bf16 a[164:167], a[120:123], a[32:35], a[164:167]
    buffer_load_dwordx4 v14, s[16:19], s49 offen offset:0 lds
    ds_read_b64_tr_b16 a[8:9], v29 offset:0
    v_mfma_f32_16x16x32_bf16 a[172:175], a[120:123], a[40:43], a[172:175]
    v_mfma_f32_16x16x32_bf16 a[172:175], a[124:127], a[44:47], a[172:175]
    ds_read_b128 a[212:215], v27 offset:4096
    v_mfma_f32_16x16x32_bf16 a[168:171], a[116:119], a[44:47], a[168:171]
    buffer_load_dwordx4 v15, s[16:19], s49 offen offset:1024 lds
    ds_read_b64_tr_b16 a[10:11], v29 offset:2048
    v_mfma_f32_16x16x32_bf16 a[168:171], a[112:115], a[40:43], a[168:171]
    v_mfma_f32_16x16x32_bf16 v[244:247], a[104:107], a[40:43], v[244:247]
    ds_read_b128 a[216:219], v26 offset:6144
    v_mfma_f32_16x16x32_bf16 v[244:247], a[108:111], a[44:47], v[244:247]
    v_mfma_f32_16x16x32_bf16 v[148:151], a[100:103], a[44:47], v[148:151]
    buffer_load_dwordx4 v16, s[16:19], s49 offen offset:2048 lds
    ds_read_b64_tr_b16 a[12:13], v29 offset:16384
    v_mfma_f32_16x16x32_bf16 v[148:151], a[96:99], a[40:43], v[148:151]
    ds_read_b128 a[220:223], v27 offset:6144
    v_mfma_f32_16x16x32_bf16 v[212:215], a[88:91], a[40:43], v[212:215]
    v_mfma_f32_16x16x32_bf16 v[212:215], a[92:95], a[44:47], v[212:215]
    buffer_load_dwordx4 v17, s[16:19], s49 offen offset:3072 lds
    ds_read_b64_tr_b16 a[14:15], v29 offset:18432
    v_mfma_f32_16x16x32_bf16 v[116:119], a[84:87], a[44:47], v[116:119]
    ds_read_b128 a[224:227], v26 offset:8192
    v_mfma_f32_16x16x32_bf16 v[116:119], a[80:83], a[40:43], v[116:119]
    s_add_u32 s49, s49, 128
    v_mfma_f32_16x16x32_bf16 v[180:183], a[72:75], a[40:43], v[180:183]
    s_add_u32 m0, s48, 98304
    ds_read_b64_tr_b16 a[16:17], v30 offset:0
    v_mfma_f32_16x16x32_bf16 v[180:183], a[76:79], a[44:47], v[180:183]
    buffer_load_dwordx4 v18, s[20:23], s50 offen offset:0 lds
    v_mfma_f32_16x16x32_bf16 v[84:87], a[68:71], a[44:47], v[84:87]
    ds_read_b128 a[228:231], v27 offset:8192
    v_mfma_f32_16x16x32_bf16 v[84:87], a[64:67], a[40:43], v[84:87]
    ds_read_b64_tr_b16 a[18:19], v30 offset:2048
    v_mfma_f32_16x16x32_bf16 v[88:91], a[64:67], a[48:51], v[88:91]
    buffer_load_dwordx4 v19, s[20:23], s50 offen offset:1024 lds
    v_mfma_f32_16x16x32_bf16 v[88:91], a[68:71], a[52:55], v[88:91]
    ds_read_b128 a[232:235], v26 offset:10240
    v_mfma_f32_16x16x32_bf16 v[184:187], a[76:79], a[52:55], v[184:187]
    v_mfma_f32_16x16x32_bf16 v[184:187], a[72:75], a[48:51], v[184:187]
    buffer_load_dwordx4 v20, s[20:23], s50 offen offset:2048 lds
    ds_read_b64_tr_b16 a[20:21], v30 offset:16384
    v_mfma_f32_16x16x32_bf16 v[120:123], a[80:83], a[48:51], v[120:123]
    ds_read_b128 a[236:239], v27 offset:10240
    v_mfma_f32_16x16x32_bf16 v[120:123], a[84:87], a[52:55], v[120:123]
    v_mfma_f32_16x16x32_bf16 v[216:219], a[92:95], a[52:55], v[216:219]
    ds_read_b64_tr_b16 a[22:23], v30 offset:18432
    v_mfma_f32_16x16x32_bf16 v[216:219], a[88:91], a[48:51], v[216:219]
    buffer_load_dwordx4 v21, s[20:23], s50 offen offset:3072 lds
    v_mfma_f32_16x16x32_bf16 v[152:155], a[96:99], a[48:51], v[152:155]
    s_add_u32 m0, s48, 102400
    ds_read_b128 a[240:243], v26 offset:12288
    v_mfma_f32_16x16x32_bf16 v[152:155], a[100:103], a[52:55], v[152:155]
    ds_read_b64_tr_b16 a[24:25], v31 offset:0
    v_mfma_f32_16x16x32_bf16 v[248:251], a[108:111], a[52:55], v[248:251]
    buffer_load_dwordx4 v22, s[20:23], s50 offen offset:0 lds
    v_mfma_f32_16x16x32_bf16 v[248:251], a[104:107], a[48:51], v[248:251]
    ds_read_b128 a[244:247], v27 offset:12288
    v_mfma_f32_16x16x32_bf16 a[176:179], a[112:115], a[48:51], a[176:179]
    v_mfma_f32_16x16x32_bf16 a[176:179], a[116:119], a[52:55], a[176:179]
    ds_read_b64_tr_b16 a[26:27], v31 offset:2048
    v_mfma_f32_16x16x32_bf16 a[180:183], a[124:127], a[52:55], a[180:183]
    buffer_load_dwordx4 v23, s[20:23], s50 offen offset:1024 lds
    ds_read_b128 a[248:251], v26 offset:14336
    v_mfma_f32_16x16x32_bf16 a[180:183], a[120:123], a[48:51], a[180:183]
    v_mfma_f32_16x16x32_bf16 a[188:191], a[120:123], a[56:59], a[188:191]
    ds_read_b64_tr_b16 a[28:29], v31 offset:16384
    v_mfma_f32_16x16x32_bf16 a[188:191], a[124:127], a[60:63], a[188:191]
    buffer_load_dwordx4 v24, s[20:23], s50 offen offset:2048 lds
    v_mfma_f32_16x16x32_bf16 a[184:187], a[116:119], a[60:63], a[184:187]
    ds_read_b128 a[252:255], v27 offset:14336
    v_mfma_f32_16x16x32_bf16 a[184:187], a[112:115], a[56:59], a[184:187]
    ds_read_b64_tr_b16 a[30:31], v31 offset:18432
    v_mfma_f32_16x16x32_bf16 v[252:255], a[104:107], a[56:59], v[252:255]
    v_mfma_f32_16x16x32_bf16 v[252:255], a[108:111], a[60:63], v[252:255]
    buffer_load_dwordx4 v25, s[20:23], s50 offen offset:3072 lds
    v_mfma_f32_16x16x32_bf16 v[156:159], a[100:103], a[60:63], v[156:159]
    v_mfma_f32_16x16x32_bf16 v[156:159], a[96:99], a[56:59], v[156:159]
    s_add_u32 s50, s50, 0x80000
    v_mfma_f32_16x16x32_bf16 v[220:223], a[88:91], a[56:59], v[220:223]
    v_mfma_f32_16x16x32_bf16 v[220:223], a[92:95], a[60:63], v[220:223]
    s_cmp_eq_u32 s51, s53
    s_cbranch_scc1 k12_ool_42
k12_oolret_43:
    v_mfma_f32_16x16x32_bf16 v[124:127], a[84:87], a[60:63], v[124:127]
    s_cmp_eq_u32 s51, s63
    s_cbranch_scc1 k12_ool_44
k12_oolret_45:
    v_mfma_f32_16x16x32_bf16 v[124:127], a[80:83], a[56:59], v[124:127]
    s_cmp_eq_u32 s51, 5
    s_cbranch_scc1 k12_ool_46
k12_oolret_47:
    v_mfma_f32_16x16x32_bf16 v[188:191], a[72:75], a[56:59], v[188:191]
    v_mfma_f32_16x16x32_bf16 v[188:191], a[76:79], a[60:63], v[188:191]
    s_add_u32 s51, s51, 1
    v_mfma_f32_16x16x32_bf16 v[92:95], a[68:71], a[60:63], v[92:95]
    v_mfma_f32_16x16x32_bf16 v[92:95], a[64:67], a[56:59], v[92:95]
    s_waitcnt lgkmcnt(0)
    s_branch k12_loop_28
k12_last_29:
    v_mfma_f32_16x16x32_bf16 v[64:67], a[64:67], a[0:3], v[64:67]
    buffer_load_dwordx4 a[192:195], v36, s[8:11], s62 offen sc1
    v_mfma_f32_16x16x32_bf16 v[64:67], a[68:71], a[4:7], v[64:67]
    ds_read_b64_tr_b16 a[32:33], v32 offset:32768
    v_mfma_f32_16x16x32_bf16 v[160:163], a[76:79], a[4:7], v[160:163]
    buffer_load_dwordx4 a[196:199], v54, s[8:11], s62 offen sc1
    ds_read_b64_tr_b16 a[34:35], v32 offset:34816
    v_mfma_f32_16x16x32_bf16 v[160:163], a[72:75], a[0:3], v[160:163]
    v_mfma_f32_16x16x32_bf16 v[96:99], a[80:83], a[0:3], v[96:99]
    buffer_load_dwordx4 a[200:203], v37, s[8:11], s62 offen sc1
    v_mfma_f32_16x16x32_bf16 v[96:99], a[84:87], a[4:7], v[96:99]
    ds_read_b64_tr_b16 a[36:37], v32 offset:49152
    v_mfma_f32_16x16x32_bf16 v[192:195], a[92:95], a[4:7], v[192:195]
    buffer_load_dwordx4 a[204:207], v55, s[8:11], s62 offen sc1
    v_mfma_f32_16x16x32_bf16 v[192:195], a[88:91], a[0:3], v[192:195]
    s_add_u32 s62, s62, 0x20000
    buffer_load_dwordx4 a[208:211], v36, s[8:11], s62 offen sc1
    ds_read_b64_tr_b16 a[38:39], v32 offset:51200
    v_mfma_f32_16x16x32_bf16 v[128:131], a[96:99], a[0:3], v[128:131]
    v_mfma_f32_16x16x32_bf16 v[128:131], a[100:103], a[4:7], v[128:131]
    v_cvt_pk_bf16_f32 v64, v64, v65
    v_cvt_pk_bf16_f32 v65, v66, v67
    v_mfma_f32_16x16x32_bf16 v[224:227], a[108:111], a[4:7], v[224:227]
    v_cvt_pk_bf16_f32 v66, v160, v161
    v_cvt_pk_bf16_f32 v67, v162, v163
    v_mfma_f32_16x16x32_bf16 v[224:227], a[104:107], a[0:3], v[224:227]
    buffer_load_dwordx4 a[212:215], v54, s[8:11], s62 offen sc1
    ds_read_b64_tr_b16 a[40:41], v33 offset:32768
    v_mfma_f32_16x16x32_bf16 a[128:131], a[112:115], a[0:3], a[128:131]
    buffer_load_dwordx4 a[216:219], v37, s[8:11], s62 offen sc1
    ds_read_b64_tr_b16 a[42:43], v33 offset:34816
    v_mfma_f32_16x16x32_bf16 a[128:131], a[116:119], a[4:7], a[128:131]
    v_cvt_pk_bf16_f32 v96, v96, v97
    v_cvt_pk_bf16_f32 v97, v98, v99
    v_mfma_f32_16x16x32_bf16 a[132:135], a[124:127], a[4:7], a[132:135]
    v_cvt_pk_bf16_f32 v98, v192, v193
    v_cvt_pk_bf16_f32 v99, v194, v195
    v_mfma_f32_16x16x32_bf16 a[132:135], a[120:123], a[0:3], a[132:135]
    buffer_load_dwordx4 a[220:223], v55, s[8:11], s62 offen sc1
    ds_read_b64_tr_b16 a[44:45], v33 offset:49152
    v_mfma_f32_16x16x32_bf16 v[68:71], a[64:67], a[8:11], v[68:71]
    s_add_u32 s62, s62, 0x20000
    buffer_load_dwordx4 a[224:227], v36, s[8:11], s62 offen sc1
    v_mfma_f32_16x16x32_bf16 v[68:71], a[68:71], a[12:15], v[68:71]
    v_cvt_pk_bf16_f32 v128, v128, v129
    v_cvt_pk_bf16_f32 v129, v130, v131
    v_mfma_f32_16x16x32_bf16 v[164:167], a[76:79], a[12:15], v[164:167]
    buffer_load_dwordx4 a[228:231], v54, s[8:11], s62 offen sc1
    ds_read_b64_tr_b16 a[46:47], v33 offset:51200
    v_mfma_f32_16x16x32_bf16 v[164:167], a[72:75], a[8:11], v[164:167]
    v_cvt_pk_bf16_f32 v130, v224, v225
    v_cvt_pk_bf16_f32 v131, v226, v227
    v_mfma_f32_16x16x32_bf16 v[100:103], a[80:83], a[8:11], v[100:103]
    buffer_load_dwordx4 a[232:235], v37, s[8:11], s62 offen sc1
    ds_read_b64_tr_b16 a[48:49], v34 offset:32768
    v_mfma_f32_16x16x32_bf16 v[100:103], a[84:87], a[12:15], v[100:103]
    v_accvgpr_read_b32 v56, a128
    v_accvgpr_read_b32 v57, a129
    v_mfma_f32_16x16x32_bf16 v[196:199], a[92:95], a[12:15], v[196:199]
    buffer_load_dwordx4 a[236:239], v55, s[8:11], s62 offen sc1
    ds_read_b64_tr_b16 a[50:51], v34 offset:34816
    v_mfma_f32_16x16x32_bf16 v[196:199], a[88:91], a[8:11], v[196:199]
    s_add_u32 s62, s62, 0x20000
    v_accvgpr_read_b32 v58, a130
    v_accvgpr_read_b32 v59, a131
    v_mfma_f32_16x16x32_bf16 v[132:135], a[96:99], a[8:11], v[132:135]
    v_accvgpr_read_b32 v60, a132
    v_accvgpr_read_b32 v61, a133
    v_mfma_f32_16x16x32_bf16 v[132:135], a[100:103], a[12:15], v[132:135]
    v_accvgpr_read_b32 v62, a134
    v_accvgpr_read_b32 v63, a135
    v_mfma_f32_16x16x32_bf16 v[228:231], a[108:111], a[12:15], v[228:231]
    buffer_load_dwordx4 a[240:243], v36, s[8:11], s62 offen sc1
    ds_read_b64_tr_b16 a[52:53], v34 offset:49152
    v_mfma_f32_16x16x32_bf16 v[228:231], a[104:107], a[8:11], v[228:231]
    v_cvt_pk_bf16_f32 v160, v56, v57
    v_cvt_pk_bf16_f32 v161, v58, v59
    v_mfma_f32_16x16x32_bf16 a[136:139], a[112:115], a[8:11], a[136:139]
    v_cvt_pk_bf16_f32 v68, v68, v69
    v_cvt_pk_bf16_f32 v162, v60, v61
    v_mfma_f32_16x16x32_bf16 a[136:139], a[116:119], a[12:15], a[136:139]
    buffer_load_dwordx4 a[244:247], v54, s[8:11], s62 offen sc1
    v_cvt_pk_bf16_f32 v69, v70, v71
    v_mfma_f32_16x16x32_bf16 a[140:143], a[124:127], a[12:15], a[140:143]
    v_cvt_pk_bf16_f32 v163, v62, v63
    v_cvt_pk_bf16_f32 v70, v164, v165
    v_mfma_f32_16x16x32_bf16 a[140:143], a[120:123], a[8:11], a[140:143]
    buffer_load_dwordx4 a[248:251], v37, s[8:11], s62 offen sc1
    v_cvt_pk_bf16_f32 v71, v166, v167
    v_mfma_f32_16x16x32_bf16 v[72:75], a[64:67], a[16:19], v[72:75]
    ds_read_b64_tr_b16 a[54:55], v34 offset:51200
    v_cvt_pk_bf16_f32 v100, v100, v101
    v_mfma_f32_16x16x32_bf16 v[72:75], a[68:71], a[20:23], v[72:75]
    buffer_load_dwordx4 a[252:255], v55, s[8:11], s62 offen sc1
    v_cvt_pk_bf16_f32 v101, v102, v103
    v_mfma_f32_16x16x32_bf16 v[168:171], a[76:79], a[20:23], v[168:171]
    s_add_u32 s62, s62, 0x20000
    ds_read_b64_tr_b16 a[56:57], v35 offset:32768
    v_cvt_pk_bf16_f32 v102, v196, v197
    v_mfma_f32_16x16x32_bf16 v[168:171], a[72:75], a[16:19], v[168:171]
    s_add_u32 s52, s47, 0
    ds_read_b64_tr_b16 a[58:59], v35 offset:34816
    v_cvt_pk_bf16_f32 v103, v198, v199
    v_mfma_f32_16x16x32_bf16 v[104:107], a[80:83], a[16:19], v[104:107]
    v_cvt_pk_bf16_f32 v132, v132, v133
    v_cvt_pk_bf16_f32 v133, v134, v135
    v_mfma_f32_16x16x32_bf16 v[104:107], a[84:87], a[20:23], v[104:107]
    v_cvt_pk_bf16_f32 v134, v228, v229
    v_cvt_pk_bf16_f32 v135, v230, v231
    v_mfma_f32_16x16x32_bf16 v[200:203], a[92:95], a[20:23], v[200:203]
    buffer_store_dwordx4 v[64:67], v1, s[32:35], s52 offen offset:0 sc1
    ds_read_b64_tr_b16 a[60:61], v35 offset:49152
    v_mfma_f32_16x16x32_bf16 v[200:203], a[88:91], a[16:19], v[200:203]
    v_accvgpr_read_b32 v56, a136
    v_accvgpr_read_b32 v57, a137
    v_mfma_f32_16x16x32_bf16 v[136:139], a[96:99], a[16:19], v[136:139]
    ds_read_b64_tr_b16 a[62:63], v35 offset:51200
    v_accvgpr_read_b32 v58, a138
    v_mfma_f32_16x16x32_bf16 v[136:139], a[100:103], a[20:23], v[136:139]
    v_accvgpr_read_b32 v59, a139
    v_accvgpr_read_b32 v60, a140
    v_mfma_f32_16x16x32_bf16 v[232:235], a[108:111], a[20:23], v[232:235]
    v_accvgpr_read_b32 v61, a141
    v_accvgpr_read_b32 v62, a142
    v_mfma_f32_16x16x32_bf16 v[232:235], a[104:107], a[16:19], v[232:235]
    s_add_u32 s52, s47, 8192
    v_accvgpr_read_b32 v63, a143
    v_cvt_pk_bf16_f32 v164, v56, v57
    v_mfma_f32_16x16x32_bf16 a[144:147], a[112:115], a[16:19], a[144:147]
    v_cvt_pk_bf16_f32 v165, v58, v59
    v_cvt_pk_bf16_f32 v72, v72, v73
    v_mfma_f32_16x16x32_bf16 a[144:147], a[116:119], a[20:23], a[144:147]
    v_cvt_pk_bf16_f32 v166, v60, v61
    v_cvt_pk_bf16_f32 v73, v74, v75
    v_mfma_f32_16x16x32_bf16 a[148:151], a[124:127], a[20:23], a[148:151]
    v_cvt_pk_bf16_f32 v167, v62, v63
    v_cvt_pk_bf16_f32 v74, v168, v169
    v_mfma_f32_16x16x32_bf16 a[148:151], a[120:123], a[16:19], a[148:151]
    v_cvt_pk_bf16_f32 v75, v170, v171
    v_cvt_pk_bf16_f32 v104, v104, v105
    v_mfma_f32_16x16x32_bf16 v[76:79], a[64:67], a[24:27], v[76:79]
    v_cvt_pk_bf16_f32 v105, v106, v107
    v_cvt_pk_bf16_f32 v106, v200, v201
    v_mfma_f32_16x16x32_bf16 v[76:79], a[68:71], a[28:31], v[76:79]
    buffer_store_dwordx4 v[96:99], v1, s[32:35], s52 offen offset:0 sc1
    v_mfma_f32_16x16x32_bf16 v[172:175], a[76:79], a[28:31], v[172:175]
    v_cvt_pk_bf16_f32 v107, v202, v203
    v_cvt_pk_bf16_f32 v136, v136, v137
    v_mfma_f32_16x16x32_bf16 v[172:175], a[72:75], a[24:27], v[172:175]
    v_cvt_pk_bf16_f32 v137, v138, v139
    v_cvt_pk_bf16_f32 v138, v232, v233
    v_mfma_f32_16x16x32_bf16 v[108:111], a[80:83], a[24:27], v[108:111]
    v_cvt_pk_bf16_f32 v139, v234, v235
    v_mfma_f32_16x16x32_bf16 v[108:111], a[84:87], a[28:31], v[108:111]
    v_accvgpr_read_b32 v56, a144
    v_accvgpr_read_b32 v57, a145
    v_mfma_f32_16x16x32_bf16 v[204:207], a[92:95], a[28:31], v[204:207]
    v_accvgpr_read_b32 v58, a146
    v_accvgpr_read_b32 v59, a147
    v_mfma_f32_16x16x32_bf16 v[204:207], a[88:91], a[24:27], v[204:207]
    s_add_u32 s52, s47, 524288
    v_accvgpr_read_b32 v60, a148
    v_accvgpr_read_b32 v61, a149
    v_mfma_f32_16x16x32_bf16 v[140:143], a[96:99], a[24:27], v[140:143]
    v_accvgpr_read_b32 v62, a150
    v_accvgpr_read_b32 v63, a151
    v_mfma_f32_16x16x32_bf16 v[140:143], a[100:103], a[28:31], v[140:143]
    v_cvt_pk_bf16_f32 v168, v56, v57
    v_cvt_pk_bf16_f32 v169, v58, v59
    v_mfma_f32_16x16x32_bf16 v[236:239], a[108:111], a[28:31], v[236:239]
    v_cvt_pk_bf16_f32 v76, v76, v77
    v_cvt_pk_bf16_f32 v170, v60, v61
    v_mfma_f32_16x16x32_bf16 v[236:239], a[104:107], a[24:27], v[236:239]
    buffer_store_dwordx4 v[128:131], v1, s[32:35], s52 offen offset:0 sc1
    v_mfma_f32_16x16x32_bf16 a[152:155], a[112:115], a[24:27], a[152:155]
    s_waitcnt lgkmcnt(0)
    v_cvt_pk_bf16_f32 v77, v78, v79
    v_cvt_pk_bf16_f32 v171, v62, v63
    v_mfma_f32_16x16x32_bf16 a[152:155], a[116:119], a[28:31], a[152:155]
    v_cvt_pk_bf16_f32 v78, v172, v173
    v_cvt_pk_bf16_f32 v79, v174, v175
    v_mfma_f32_16x16x32_bf16 a[156:159], a[124:127], a[28:31], a[156:159]
    v_cvt_pk_bf16_f32 v108, v108, v109
    v_cvt_pk_bf16_f32 v109, v110, v111
    v_mfma_f32_16x16x32_bf16 a[156:159], a[120:123], a[24:27], a[156:159]
    v_cvt_pk_bf16_f32 v110, v204, v205
    v_cvt_pk_bf16_f32 v111, v206, v207
    v_mfma_f32_16x16x32_bf16 v[80:83], a[64:67], a[32:35], v[80:83]
    v_mfma_f32_16x16x32_bf16 v[80:83], a[68:71], a[36:39], v[80:83]
    v_cvt_pk_bf16_f32 v140, v140, v141
    v_cvt_pk_bf16_f32 v141, v142, v143
    v_mfma_f32_16x16x32_bf16 v[176:179], a[76:79], a[36:39], v[176:179]
    s_add_u32 s52, s47, 532480
    v_cvt_pk_bf16_f32 v142, v236, v237
    v_cvt_pk_bf16_f32 v143, v238, v239
    v_mfma_f32_16x16x32_bf16 v[176:179], a[72:75], a[32:35], v[176:179]
    buffer_store_dwordx4 v[160:163], v1, s[32:35], s52 offen offset:0 sc1
    v_mfma_f32_16x16x32_bf16 v[112:115], a[80:83], a[32:35], v[112:115]
    v_mfma_f32_16x16x32_bf16 v[112:115], a[84:87], a[36:39], v[112:115]
    v_accvgpr_read_b32 v56, a152
    v_accvgpr_read_b32 v57, a153
    v_mfma_f32_16x16x32_bf16 v[208:211], a[92:95], a[36:39], v[208:211]
    v_accvgpr_read_b32 v58, a154
    v_accvgpr_read_b32 v59, a155
    v_mfma_f32_16x16x32_bf16 v[208:211], a[88:91], a[32:35], v[208:211]
    v_accvgpr_read_b32 v60, a156
    v_accvgpr_read_b32 v61, a157
    v_mfma_f32_16x16x32_bf16 v[144:147], a[96:99], a[32:35], v[144:147]
    v_accvgpr_read_b32 v62, a158
    v_accvgpr_read_b32 v63, a159
    v_mfma_f32_16x16x32_bf16 v[144:147], a[100:103], a[36:39], v[144:147]
    v_cvt_pk_bf16_f32 v172, v56, v57
    v_cvt_pk_bf16_f32 v173, v58, v59
    v_mfma_f32_16x16x32_bf16 v[240:243], a[108:111], a[36:39], v[240:243]
    v_cvt_pk_bf16_f32 v80, v80, v81
    v_cvt_pk_bf16_f32 v174, v60, v61
    v_mfma_f32_16x16x32_bf16 v[240:243], a[104:107], a[32:35], v[240:243]
    v_cvt_pk_bf16_f32 v81, v82, v83
    v_cvt_pk_bf16_f32 v175, v62, v63
    v_mfma_f32_16x16x32_bf16 a[160:163], a[112:115], a[32:35], a[160:163]
    v_cvt_pk_bf16_f32 v82, v176, v177
    v_cvt_pk_bf16_f32 v83, v178, v179
    v_mfma_f32_16x16x32_bf16 a[160:163], a[116:119], a[36:39], a[160:163]
    v_cvt_pk_bf16_f32 v112, v112, v113
    v_cvt_pk_bf16_f32 v113, v114, v115
    v_mfma_f32_16x16x32_bf16 a[164:167], a[124:127], a[36:39], a[164:167]
    s_add_u32 s52, s47, 0
    v_cvt_pk_bf16_f32 v114, v208, v209
    v_cvt_pk_bf16_f32 v115, v210, v211
    v_mfma_f32_16x16x32_bf16 a[164:167], a[120:123], a[32:35], a[164:167]
    buffer_store_dwordx4 v[68:71], v1, s[32:35], s52 offen offset:1024 sc1
    v_mfma_f32_16x16x32_bf16 v[84:87], a[64:67], a[40:43], v[84:87]
    v_mfma_f32_16x16x32_bf16 v[84:87], a[68:71], a[44:47], v[84:87]
    v_cvt_pk_bf16_f32 v144, v144, v145
    v_cvt_pk_bf16_f32 v145, v146, v147
    v_mfma_f32_16x16x32_bf16 v[180:183], a[76:79], a[44:47], v[180:183]
    v_cvt_pk_bf16_f32 v146, v240, v241
    v_cvt_pk_bf16_f32 v147, v242, v243
    v_mfma_f32_16x16x32_bf16 v[180:183], a[72:75], a[40:43], v[180:183]
    v_mfma_f32_16x16x32_bf16 v[116:119], a[80:83], a[40:43], v[116:119]
    v_mfma_f32_16x16x32_bf16 v[116:119], a[84:87], a[44:47], v[116:119]
    v_accvgpr_read_b32 v56, a160
    v_accvgpr_read_b32 v57, a161
    v_mfma_f32_16x16x32_bf16 v[212:215], a[92:95], a[44:47], v[212:215]
    v_accvgpr_read_b32 v58, a162
    v_accvgpr_read_b32 v59, a163
    v_mfma_f32_16x16x32_bf16 v[212:215], a[88:91], a[40:43], v[212:215]
    v_accvgpr_read_b32 v60, a164
    v_accvgpr_read_b32 v61, a165
    v_mfma_f32_16x16x32_bf16 v[148:151], a[96:99], a[40:43], v[148:151]
    v_accvgpr_read_b32 v62, a166
    v_accvgpr_read_b32 v63, a167
    v_mfma_f32_16x16x32_bf16 v[148:151], a[100:103], a[44:47], v[148:151]
    s_add_u32 s52, s47, 8192
    v_cvt_pk_bf16_f32 v176, v56, v57
    v_cvt_pk_bf16_f32 v177, v58, v59
    v_mfma_f32_16x16x32_bf16 v[244:247], a[108:111], a[44:47], v[244:247]
    v_cvt_pk_bf16_f32 v84, v84, v85
    v_cvt_pk_bf16_f32 v178, v60, v61
    v_mfma_f32_16x16x32_bf16 v[244:247], a[104:107], a[40:43], v[244:247]
    v_cvt_pk_bf16_f32 v85, v86, v87
    v_cvt_pk_bf16_f32 v179, v62, v63
    v_mfma_f32_16x16x32_bf16 a[168:171], a[112:115], a[40:43], a[168:171]
    v_cvt_pk_bf16_f32 v86, v180, v181
    v_cvt_pk_bf16_f32 v87, v182, v183
    v_mfma_f32_16x16x32_bf16 a[168:171], a[116:119], a[44:47], a[168:171]
    buffer_store_dwordx4 v[100:103], v1, s[32:35], s52 offen offset:1024 sc1
    v_mfma_f32_16x16x32_bf16 a[172:175], a[124:127], a[44:47], a[172:175]
    v_cvt_pk_bf16_f32 v116, v116, v117
    v_cvt_pk_bf16_f32 v117, v118, v119
    v_mfma_f32_16x16x32_bf16 a[172:175], a[120:123], a[40:43], a[172:175]
    v_cvt_pk_bf16_f32 v118, v212, v213
    v_cvt_pk_bf16_f32 v119, v214, v215
    v_mfma_f32_16x16x32_bf16 v[88:91], a[64:67], a[48:51], v[88:91]
    s_waitcnt vmcnt(16)
    s_barrier
    v_mfma_f32_16x16x32_bf16 v[88:91], a[68:71], a[52:55], v[88:91]
    ds_read_b64_tr_b16 a[0:1], v42 offset:32768
    v_cvt_pk_bf16_f32 v148, v148, v149
    v_mfma_f32_16x16x32_bf16 v[184:187], a[76:79], a[52:55], v[184:187]
    v_cvt_pk_bf16_f32 v149, v150, v151
    v_cvt_pk_bf16_f32 v150, v244, v245
    v_mfma_f32_16x16x32_bf16 v[184:187], a[72:75], a[48:51], v[184:187]
    ds_read_b64_tr_b16 a[2:3], v42 offset:33792
    v_cvt_pk_bf16_f32 v151, v246, v247
    v_mfma_f32_16x16x32_bf16 v[120:123], a[80:83], a[48:51], v[120:123]
    ds_read_b64_tr_b16 a[4:5], v42 offset:40960
    ds_read_b64_tr_b16 a[6:7], v42 offset:41984
    v_mfma_f32_16x16x32_bf16 v[120:123], a[84:87], a[52:55], v[120:123]
    s_add_u32 s52, s47, 524288
    v_accvgpr_read_b32 v56, a168
    v_accvgpr_read_b32 v57, a169
    v_mfma_f32_16x16x32_bf16 v[216:219], a[92:95], a[52:55], v[216:219]
    v_accvgpr_read_b32 v58, a170
    v_accvgpr_read_b32 v59, a171
    v_mfma_f32_16x16x32_bf16 v[216:219], a[88:91], a[48:51], v[216:219]
    ds_read_b64_tr_b16 a[8:9], v43 offset:32768
    v_accvgpr_read_b32 v60, a172
    v_mfma_f32_16x16x32_bf16 v[152:155], a[96:99], a[48:51], v[152:155]
    buffer_store_dwordx4 v[132:135], v1, s[32:35], s52 offen offset:1024 sc1
    ds_read_b64_tr_b16 a[10:11], v43 offset:33792
    v_mfma_f32_16x16x32_bf16 v[152:155], a[100:103], a[52:55], v[152:155]
    v_accvgpr_read_b32 v61, a173
    v_accvgpr_read_b32 v62, a174
    v_mfma_f32_16x16x32_bf16 v[248:251], a[108:111], a[52:55], v[248:251]
    v_accvgpr_read_b32 v63, a175
    v_cvt_pk_bf16_f32 v180, v56, v57
    v_mfma_f32_16x16x32_bf16 v[248:251], a[104:107], a[48:51], v[248:251]
    v_cvt_pk_bf16_f32 v181, v58, v59
    v_cvt_pk_bf16_f32 v88, v88, v89
    v_mfma_f32_16x16x32_bf16 a[176:179], a[112:115], a[48:51], a[176:179]
    v_cvt_pk_bf16_f32 v182, v60, v61
    v_cvt_pk_bf16_f32 v89, v90, v91
    v_mfma_f32_16x16x32_bf16 a[176:179], a[116:119], a[52:55], a[176:179]
    ds_read_b64_tr_b16 a[12:13], v43 offset:40960
    v_cvt_pk_bf16_f32 v183, v62, v63
    v_mfma_f32_16x16x32_bf16 a[180:183], a[124:127], a[52:55], a[180:183]
    v_cvt_pk_bf16_f32 v90, v184, v185
    v_cvt_pk_bf16_f32 v91, v186, v187
    v_mfma_f32_16x16x32_bf16 a[180:183], a[120:123], a[48:51], a[180:183]
    ds_read_b64_tr_b16 a[14:15], v43 offset:41984
    ds_read_b64_tr_b16 a[16:17], v44 offset:32768
    v_mfma_f32_16x16x32_bf16 v[92:95], a[64:67], a[56:59], v[92:95]
    s_add_u32 s52, s47, 532480
    v_cvt_pk_bf16_f32 v120, v120, v121
    v_cvt_pk_bf16_f32 v121, v122, v123
    v_mfma_f32_16x16x32_bf16 v[92:95], a[68:71], a[60:63], v[92:95]
    ds_read_b64_tr_b16 a[18:19], v44 offset:33792
    v_cvt_pk_bf16_f32 v122, v216, v217
    v_mfma_f32_16x16x32_bf16 v[188:191], a[76:79], a[60:63], v[188:191]
    ds_read_b64_tr_b16 a[20:21], v44 offset:40960
    v_cvt_pk_bf16_f32 v123, v218, v219
    v_mfma_f32_16x16x32_bf16 v[188:191], a[72:75], a[56:59], v[188:191]
    ds_read_b64_tr_b16 a[22:23], v44 offset:41984
    v_cvt_pk_bf16_f32 v152, v152, v153
    v_mfma_f32_16x16x32_bf16 v[124:127], a[80:83], a[56:59], v[124:127]
    v_cvt_pk_bf16_f32 v153, v154, v155
    v_cvt_pk_bf16_f32 v154, v248, v249
    v_mfma_f32_16x16x32_bf16 v[124:127], a[84:87], a[60:63], v[124:127]
    ds_read_b64_tr_b16 a[24:25], v45 offset:32768
    v_cvt_pk_bf16_f32 v155, v250, v251
    v_mfma_f32_16x16x32_bf16 v[220:223], a[92:95], a[60:63], v[220:223]
    buffer_store_dwordx4 v[164:167], v1, s[32:35], s52 offen offset:1024 sc1
    ds_read_b64_tr_b16 a[26:27], v45 offset:33792
    v_mfma_f32_16x16x32_bf16 v[220:223], a[88:91], a[56:59], v[220:223]
    ds_read_b64_tr_b16 a[28:29], v45 offset:40960
    v_accvgpr_read_b32 v56, a176
    v_mfma_f32_16x16x32_bf16 v[156:159], a[96:99], a[56:59], v[156:159]
    v_accvgpr_read_b32 v57, a177
    v_accvgpr_read_b32 v58, a178
    v_mfma_f32_16x16x32_bf16 v[156:159], a[100:103], a[60:63], v[156:159]
    ds_read_b64_tr_b16 a[30:31], v45 offset:41984
    v_accvgpr_read_b32 v59, a179
    v_mfma_f32_16x16x32_bf16 v[252:255], a[108:111], a[60:63], v[252:255]
    v_accvgpr_read_b32 v60, a180
    v_accvgpr_read_b32 v61, a181
    v_mfma_f32_16x16x32_bf16 v[252:255], a[104:107], a[56:59], v[252:255]
    v_accvgpr_read_b32 v62, a182
    v_accvgpr_read_b32 v63, a183
    v_mfma_f32_16x16x32_bf16 a[184:187], a[112:115], a[56:59], a[184:187]
    v_cvt_pk_bf16_f32 v184, v56, v57
    v_cvt_pk_bf16_f32 v185, v58, v59
    v_mfma_f32_16x16x32_bf16 a[184:187], a[116:119], a[60:63], a[184:187]
    v_cvt_pk_bf16_f32 v92, v92, v93
    v_cvt_pk_bf16_f32 v186, v60, v61
    v_mfma_f32_16x16x32_bf16 a[188:191], a[124:127], a[60:63], a[188:191]
    v_cvt_pk_bf16_f32 v93, v94, v95
    v_cvt_pk_bf16_f32 v187, v62, v63
    v_mfma_f32_16x16x32_bf16 a[188:191], a[120:123], a[56:59], a[188:191]
    v_cvt_pk_bf16_f32 v94, v188, v189
    v_cvt_pk_bf16_f32 v95, v190, v191
    v_cvt_pk_bf16_f32 v124, v124, v125
    v_cvt_pk_bf16_f32 v125, v126, v127
    v_cvt_pk_bf16_f32 v126, v220, v221
    v_cvt_pk_bf16_f32 v127, v222, v223
    v_cvt_pk_bf16_f32 v156, v156, v157
    v_cvt_pk_bf16_f32 v157, v158, v159
    v_cvt_pk_bf16_f32 v158, v252, v253
    v_cvt_pk_bf16_f32 v159, v254, v255
    v_accvgpr_read_b32 v56, a184
    v_accvgpr_read_b32 v57, a185
    v_accvgpr_read_b32 v58, a186
    v_accvgpr_read_b32 v59, a187
    v_accvgpr_read_b32 v60, a188
    v_accvgpr_read_b32 v61, a189
    v_accvgpr_read_b32 v62, a190
    v_accvgpr_read_b32 v63, a191
    v_cvt_pk_bf16_f32 v188, v56, v57
    v_cvt_pk_bf16_f32 v189, v58, v59
    v_cvt_pk_bf16_f32 v190, v60, v61
    v_cvt_pk_bf16_f32 v191, v62, v63
k12_join_7:
k12_qcode:
    s_mov_b64 s[48:49], s[32:33]
    s_mov_b32 s51, 0x00020000
    s_cmp_eq_u32 s45, 0
    s_mov_b32 s50, s34
    s_cselect_b32 s56, s30, -1
    s_cselect_b32 s57, -1, s30
    s_waitcnt vmcnt(16) lgkmcnt(0)
    v_mfma_f32_16x16x32_bf16 v[192:195], a[0:3], a[192:195], 0
    v_mfma_f32_16x16x32_bf16 v[192:195], a[4:7], a[208:211], v[192:195]
    buffer_load_dwordx4 a[128:131], v36, s[8:11], s62 offen sc1
    ds_read_b64_tr_b16 a[32:33], v46 offset:32768
    v_mfma_f32_16x16x32_bf16 v[196:199], a[4:7], a[212:215], 0
    ds_read_b64_tr_b16 a[34:35], v46 offset:33792
    v_mfma_f32_16x16x32_bf16 v[196:199], a[0:3], a[196:199], v[196:199]
    ds_read_b64_tr_b16 a[36:37], v46 offset:40960
    v_mfma_f32_16x16x32_bf16 a[64:67], a[0:3], a[200:203], 0
    ds_read_b64_tr_b16 a[38:39], v46 offset:41984
    v_mfma_f32_16x16x32_bf16 a[64:67], a[4:7], a[216:219], a[64:67]
    ds_read_b64_tr_b16 a[40:41], v47 offset:32768
    v_mfma_f32_16x16x32_bf16 a[68:71], a[4:7], a[220:223], 0
    s_lshl_b32 s31, s28, 14
    v_mfma_f32_16x16x32_bf16 a[68:71], a[0:3], a[204:207], a[68:71]
    s_add_u32 s16, s6, s31
    s_addc_u32 s17, s7, 0
    buffer_load_dwordx4 a[132:135], v54, s[8:11], s62 offen sc1
    ds_read_b64_tr_b16 a[42:43], v47 offset:33792
    v_mfma_f32_16x16x32_bf16 a[76:79], a[8:11], a[204:207], 0
    ds_read_b64_tr_b16 a[44:45], v47 offset:40960
    v_mfma_f32_16x16x32_bf16 a[76:79], a[12:15], a[220:223], a[76:79]
    s_add_u32 s20, s16, 0x2000000
    s_addc_u32 s21, s17, 0
    ds_read_b64_tr_b16 a[46:47], v47 offset:41984
    v_mfma_f32_16x16x32_bf16 a[72:75], a[12:15], a[216:219], 0
    ds_read_b64_tr_b16 a[48:49], v48 offset:32768
    v_mfma_f32_16x16x32_bf16 a[72:75], a[8:11], a[200:203], a[72:75]
    s_add_u32 s16, s16, 0x1000000
    s_addc_u32 s17, s17, 0
    v_mfma_f32_16x16x32_bf16 v[204:207], a[8:11], a[196:199], 0
    ds_read_b64_tr_b16 a[50:51], v48 offset:33792
    v_mfma_f32_16x16x32_bf16 v[204:207], a[12:15], a[212:215], v[204:207]
    s_and_b32 s17, s17, 0xffff
    ds_read_b64_tr_b16 a[52:53], v48 offset:40960
    v_mfma_f32_16x16x32_bf16 v[200:203], a[12:15], a[208:211], 0
    buffer_load_dwordx4 a[136:139], v37, s[8:11], s62 offen sc1
    ds_read_b64_tr_b16 a[54:55], v48 offset:41984
    v_mfma_f32_16x16x32_bf16 v[200:203], a[8:11], a[192:195], v[200:203]
    s_and_b32 s21, s21, 0xffff
    v_mfma_f32_16x16x32_bf16 v[208:211], a[16:19], a[192:195], 0
    ds_read_b64_tr_b16 a[56:57], v49 offset:32768
    v_mfma_f32_16x16x32_bf16 v[208:211], a[20:23], a[208:211], v[208:211]
    s_lshl_b32 s31, s29, 20
    ds_read_b64_tr_b16 a[58:59], v49 offset:33792
    v_mfma_f32_16x16x32_bf16 v[212:215], a[20:23], a[212:215], 0
    ds_read_b64_tr_b16 a[60:61], v49 offset:40960
    v_mfma_f32_16x16x32_bf16 v[212:215], a[16:19], a[196:199], v[212:215]
    s_sub_u32 s18, 0xf84000, s31
    v_mfma_f32_16x16x32_bf16 a[80:83], a[16:19], a[200:203], 0
    buffer_load_dwordx4 a[140:143], v55, s[8:11], s62 offen sc1
    ds_read_b64_tr_b16 a[62:63], v49 offset:41984
    v_mfma_f32_16x16x32_bf16 a[80:83], a[20:23], a[216:219], a[80:83]
    s_mov_b32 s22, s18
    v_mfma_f32_16x16x32_bf16 a[84:87], a[20:23], a[220:223], 0
    v_mfma_f32_16x16x32_bf16 a[84:87], a[16:19], a[204:207], a[84:87]
    s_add_u32 s24, s6, 0x4806000
    s_addc_u32 s25, s7, 0
    v_mfma_f32_16x16x32_bf16 a[92:95], a[24:27], a[204:207], 0
    v_mfma_f32_16x16x32_bf16 a[92:95], a[28:31], a[220:223], a[92:95]
    s_and_b32 s25, s25, 0xffff
    v_mfma_f32_16x16x32_bf16 a[88:91], a[28:31], a[216:219], 0
    s_add_u32 s62, s62, 0x20000
    v_mfma_f32_16x16x32_bf16 a[88:91], a[24:27], a[200:203], a[88:91]
    s_mov_b32 s26, 4096
    v_mfma_f32_16x16x32_bf16 v[220:223], a[24:27], a[196:199], 0
    s_cmp_eq_u32 s45, 0
    s_cbranch_scc1 k12_ool_48
k12_oolret_49:
    v_mfma_f32_16x16x32_bf16 v[220:223], a[28:31], a[212:215], v[220:223]
    v_mfma_f32_16x16x32_bf16 v[216:219], a[28:31], a[208:211], 0
    v_mfma_f32_16x16x32_bf16 v[216:219], a[24:27], a[192:195], v[216:219]
    s_waitcnt vmcnt(28) lgkmcnt(0)
    s_barrier
    v_mfma_f32_16x16x32_bf16 v[224:227], a[32:35], a[192:195], 0
    v_mfma_f32_16x16x32_bf16 v[224:227], a[36:39], a[208:211], v[224:227]
    s_add_u32 m0, s60, 98304
    ds_read_b64_tr_b16 a[0:1], v42 offset:49152
    ds_read_b64_tr_b16 a[2:3], v42 offset:50176
    v_mfma_f32_16x16x32_bf16 v[228:231], a[36:39], a[212:215], 0
    buffer_load_dwordx4 v38, s[12:15], s61 offen offset:0 lds
    v_mfma_f32_16x16x32_bf16 v[228:231], a[32:35], a[196:199], v[228:231]
    ds_read_b64_tr_b16 a[4:5], v42 offset:57344
    v_mfma_f32_16x16x32_bf16 a[96:99], a[32:35], a[200:203], 0
    buffer_load_dwordx4 v39, s[12:15], s61 offen offset:1024 lds
    ds_read_b64_tr_b16 a[6:7], v42 offset:58368
    v_mfma_f32_16x16x32_bf16 a[96:99], a[36:39], a[216:219], a[96:99]
    ds_read_b64_tr_b16 a[8:9], v43 offset:49152
    v_mfma_f32_16x16x32_bf16 a[100:103], a[36:39], a[220:223], 0
    v_mfma_f32_16x16x32_bf16 a[100:103], a[32:35], a[204:207], a[100:103]
    buffer_load_dwordx4 v40, s[12:15], s61 offen offset:2048 lds
    ds_read_b64_tr_b16 a[10:11], v43 offset:50176
    v_mfma_f32_16x16x32_bf16 a[108:111], a[40:43], a[204:207], 0
    ds_read_b64_tr_b16 a[12:13], v43 offset:57344
    v_mfma_f32_16x16x32_bf16 a[108:111], a[44:47], a[220:223], a[108:111]
    ds_read_b64_tr_b16 a[14:15], v43 offset:58368
    v_mfma_f32_16x16x32_bf16 a[104:107], a[44:47], a[216:219], 0
    buffer_load_dwordx4 v41, s[12:15], s61 offen offset:3072 lds
    ds_read_b64_tr_b16 a[16:17], v44 offset:49152
    v_mfma_f32_16x16x32_bf16 a[104:107], a[40:43], a[200:203], a[104:107]
    v_mfma_f32_16x16x32_bf16 v[236:239], a[40:43], a[196:199], 0
    s_add_u32 s61, s61, 0x80000
    ds_read_b64_tr_b16 a[18:19], v44 offset:50176
    v_mfma_f32_16x16x32_bf16 v[236:239], a[44:47], a[212:215], v[236:239]
    buffer_load_dwordx4 a[144:147], v36, s[8:11], s62 offen sc1
    ds_read_b64_tr_b16 a[20:21], v44 offset:57344
    v_mfma_f32_16x16x32_bf16 v[232:235], a[44:47], a[208:211], 0
    ds_read_b64_tr_b16 a[22:23], v44 offset:58368
    v_mfma_f32_16x16x32_bf16 v[232:235], a[40:43], a[192:195], v[232:235]
    buffer_load_dwordx4 a[148:151], v54, s[8:11], s62 offen sc1
    v_mfma_f32_16x16x32_bf16 v[240:243], a[48:51], a[192:195], 0
    ds_read_b64_tr_b16 a[24:25], v45 offset:49152
    v_mfma_f32_16x16x32_bf16 v[240:243], a[52:55], a[208:211], v[240:243]
    ds_read_b64_tr_b16 a[26:27], v45 offset:50176
    v_mfma_f32_16x16x32_bf16 v[244:247], a[52:55], a[212:215], 0
    buffer_load_dwordx4 a[152:155], v37, s[8:11], s62 offen sc1
    ds_read_b64_tr_b16 a[28:29], v45 offset:57344
    v_mfma_f32_16x16x32_bf16 v[244:247], a[48:51], a[196:199], v[244:247]
    v_mfma_f32_16x16x32_bf16 a[112:115], a[48:51], a[200:203], 0
    ds_read_b64_tr_b16 a[30:31], v45 offset:58368
    v_mfma_f32_16x16x32_bf16 a[112:115], a[52:55], a[216:219], a[112:115]
    buffer_load_dwordx4 a[156:159], v55, s[8:11], s62 offen sc1
    v_mfma_f32_16x16x32_bf16 a[116:119], a[52:55], a[220:223], 0
    v_mfma_f32_16x16x32_bf16 a[116:119], a[48:51], a[204:207], a[116:119]
    s_add_u32 s62, s62, 0x20000
    v_mfma_f32_16x16x32_bf16 a[124:127], a[56:59], a[204:207], 0
    s_add_u32 s52, s47, 0
    v_mfma_f32_16x16x32_bf16 a[124:127], a[60:63], a[220:223], a[124:127]
    buffer_store_dwordx4 v[72:75], v1, s[48:51], s52 offen offset:2048 sc1
    v_mfma_f32_16x16x32_bf16 a[120:123], a[60:63], a[216:219], 0
    v_mfma_f32_16x16x32_bf16 a[120:123], a[56:59], a[200:203], a[120:123]
    v_mfma_f32_16x16x32_bf16 v[252:255], a[56:59], a[196:199], 0
    v_mfma_f32_16x16x32_bf16 v[252:255], a[60:63], a[212:215], v[252:255]
    v_mfma_f32_16x16x32_bf16 v[248:251], a[60:63], a[208:211], 0
    v_mfma_f32_16x16x32_bf16 v[248:251], a[56:59], a[192:195], v[248:251]
    s_waitcnt vmcnt(21) lgkmcnt(0)
    v_mfma_f32_16x16x32_bf16 v[192:195], a[0:3], a[224:227], v[192:195]
    v_mfma_f32_16x16x32_bf16 v[192:195], a[4:7], a[240:243], v[192:195]
    buffer_load_dwordx4 a[160:163], v36, s[8:11], s62 offen sc1
    ds_read_b64_tr_b16 a[32:33], v46 offset:49152
    v_mfma_f32_16x16x32_bf16 v[196:199], a[4:7], a[244:247], v[196:199]
    ds_read_b64_tr_b16 a[34:35], v46 offset:50176
    v_mfma_f32_16x16x32_bf16 v[196:199], a[0:3], a[228:231], v[196:199]
    ds_read_b64_tr_b16 a[36:37], v46 offset:57344
    v_mfma_f32_16x16x32_bf16 a[64:67], a[0:3], a[232:235], a[64:67]
    ds_read_b64_tr_b16 a[38:39], v46 offset:58368
    v_mfma_f32_16x16x32_bf16 a[64:67], a[4:7], a[248:251], a[64:67]
    ds_read_b64_tr_b16 a[40:41], v47 offset:49152
    v_mfma_f32_16x16x32_bf16 a[68:71], a[4:7], a[252:255], a[68:71]
    buffer_load_dwordx4 a[164:167], v54, s[8:11], s62 offen sc1
    v_mfma_f32_16x16x32_bf16 a[68:71], a[0:3], a[236:239], a[68:71]
    ds_read_b64_tr_b16 a[42:43], v47 offset:50176
    v_mfma_f32_16x16x32_bf16 a[76:79], a[8:11], a[236:239], a[76:79]
    ds_read_b64_tr_b16 a[44:45], v47 offset:57344
    v_mfma_f32_16x16x32_bf16 a[76:79], a[12:15], a[252:255], a[76:79]
    ds_read_b64_tr_b16 a[46:47], v47 offset:58368
    v_mfma_f32_16x16x32_bf16 a[72:75], a[12:15], a[248:251], a[72:75]
    ds_read_b64_tr_b16 a[48:49], v48 offset:49152
    v_mfma_f32_16x16x32_bf16 a[72:75], a[8:11], a[232:235], a[72:75]
    buffer_load_dwordx4 a[168:171], v37, s[8:11], s62 offen sc1
    v_mfma_f32_16x16x32_bf16 v[204:207], a[8:11], a[228:231], v[204:207]
    ds_read_b64_tr_b16 a[50:51], v48 offset:50176
    v_mfma_f32_16x16x32_bf16 v[204:207], a[12:15], a[244:247], v[204:207]
    ds_read_b64_tr_b16 a[52:53], v48 offset:57344
    v_mfma_f32_16x16x32_bf16 v[200:203], a[12:15], a[240:243], v[200:203]
    ds_read_b64_tr_b16 a[54:55], v48 offset:58368
    v_mfma_f32_16x16x32_bf16 v[200:203], a[8:11], a[224:227], v[200:203]
    v_mfma_f32_16x16x32_bf16 v[208:211], a[16:19], a[224:227], v[208:211]
    ds_read_b64_tr_b16 a[56:57], v49 offset:49152
    v_mfma_f32_16x16x32_bf16 v[208:211], a[20:23], a[240:243], v[208:211]
    buffer_load_dwordx4 a[172:175], v55, s[8:11], s62 offen sc1
    ds_read_b64_tr_b16 a[58:59], v49 offset:50176
    v_mfma_f32_16x16x32_bf16 v[212:215], a[20:23], a[244:247], v[212:215]
    ds_read_b64_tr_b16 a[60:61], v49 offset:57344
    v_mfma_f32_16x16x32_bf16 v[212:215], a[16:19], a[228:231], v[212:215]
    v_mfma_f32_16x16x32_bf16 a[80:83], a[16:19], a[232:235], a[80:83]
    ds_read_b64_tr_b16 a[62:63], v49 offset:58368
    v_mfma_f32_16x16x32_bf16 a[80:83], a[20:23], a[248:251], a[80:83]
    s_add_u32 s62, s62, 0x20000
    v_mfma_f32_16x16x32_bf16 a[84:87], a[20:23], a[252:255], a[84:87]
    s_add_u32 s52, s47, 0
    v_mfma_f32_16x16x32_bf16 a[84:87], a[16:19], a[236:239], a[84:87]
    buffer_store_dwordx4 v[76:79], v1, s[48:51], s52 offen offset:3072 sc1
    v_mfma_f32_16x16x32_bf16 a[92:95], a[24:27], a[236:239], a[92:95]
    v_mfma_f32_16x16x32_bf16 a[92:95], a[28:31], a[252:255], a[92:95]
    v_mfma_f32_16x16x32_bf16 a[88:91], a[28:31], a[248:251], a[88:91]
    v_mfma_f32_16x16x32_bf16 a[88:91], a[24:27], a[232:235], a[88:91]
    v_mfma_f32_16x16x32_bf16 v[220:223], a[24:27], a[228:231], v[220:223]
    s_cmp_eq_u32 s45, 0
    s_cbranch_scc1 k12_ool_50
k12_oolret_51:
    v_mfma_f32_16x16x32_bf16 v[220:223], a[28:31], a[244:247], v[220:223]
    v_mfma_f32_16x16x32_bf16 v[216:219], a[28:31], a[240:243], v[216:219]
    v_mfma_f32_16x16x32_bf16 v[216:219], a[24:27], a[224:227], v[216:219]
    s_waitcnt vmcnt(10) lgkmcnt(0)
    s_barrier
    v_mfma_f32_16x16x32_bf16 v[224:227], a[32:35], a[224:227], v[224:227]
    v_mfma_f32_16x16x32_bf16 v[224:227], a[36:39], a[240:243], v[224:227]
    s_add_u32 m0, s60, 114688
    ds_read_b64_tr_b16 a[0:1], v42 offset:0
    ds_read_b64_tr_b16 a[2:3], v42 offset:1024
    v_mfma_f32_16x16x32_bf16 v[228:231], a[36:39], a[244:247], v[228:231]
    buffer_load_dwordx4 v38, s[12:15], s61 offen offset:0 lds
    v_mfma_f32_16x16x32_bf16 v[228:231], a[32:35], a[228:231], v[228:231]
    ds_read_b64_tr_b16 a[4:5], v42 offset:8192
    v_mfma_f32_16x16x32_bf16 a[96:99], a[32:35], a[232:235], a[96:99]
    buffer_load_dwordx4 v39, s[12:15], s61 offen offset:1024 lds
    ds_read_b64_tr_b16 a[6:7], v42 offset:9216
    v_mfma_f32_16x16x32_bf16 a[96:99], a[36:39], a[248:251], a[96:99]
    ds_read_b64_tr_b16 a[8:9], v43 offset:0
    v_mfma_f32_16x16x32_bf16 a[100:103], a[36:39], a[252:255], a[100:103]
    v_mfma_f32_16x16x32_bf16 a[100:103], a[32:35], a[236:239], a[100:103]
    buffer_load_dwordx4 v40, s[12:15], s61 offen offset:2048 lds
    ds_read_b64_tr_b16 a[10:11], v43 offset:1024
    v_mfma_f32_16x16x32_bf16 a[108:111], a[40:43], a[236:239], a[108:111]
    ds_read_b64_tr_b16 a[12:13], v43 offset:8192
    v_mfma_f32_16x16x32_bf16 a[108:111], a[44:47], a[252:255], a[108:111]
    ds_read_b64_tr_b16 a[14:15], v43 offset:9216
    v_mfma_f32_16x16x32_bf16 a[104:107], a[44:47], a[248:251], a[104:107]
    buffer_load_dwordx4 v41, s[12:15], s61 offen offset:3072 lds
    ds_read_b64_tr_b16 a[16:17], v44 offset:0
    v_mfma_f32_16x16x32_bf16 a[104:107], a[40:43], a[232:235], a[104:107]
    v_mfma_f32_16x16x32_bf16 v[236:239], a[40:43], a[228:231], v[236:239]
    s_add_u32 s61, s61, 0x80000
    ds_read_b64_tr_b16 a[18:19], v44 offset:1024
    v_mfma_f32_16x16x32_bf16 v[236:239], a[44:47], a[244:247], v[236:239]
    buffer_load_dwordx4 a[176:179], v36, s[8:11], s62 offen sc1
    ds_read_b64_tr_b16 a[20:21], v44 offset:8192
    v_mfma_f32_16x16x32_bf16 v[232:235], a[44:47], a[240:243], v[232:235]
    ds_read_b64_tr_b16 a[22:23], v44 offset:9216
    v_mfma_f32_16x16x32_bf16 v[232:235], a[40:43], a[224:227], v[232:235]
    buffer_load_dwordx4 a[180:183], v54, s[8:11], s62 offen sc1
    v_mfma_f32_16x16x32_bf16 v[240:243], a[48:51], a[224:227], v[240:243]
    ds_read_b64_tr_b16 a[24:25], v45 offset:0
    v_mfma_f32_16x16x32_bf16 v[240:243], a[52:55], a[240:243], v[240:243]
    ds_read_b64_tr_b16 a[26:27], v45 offset:1024
    v_mfma_f32_16x16x32_bf16 v[244:247], a[52:55], a[244:247], v[244:247]
    buffer_load_dwordx4 a[184:187], v37, s[8:11], s62 offen sc1
    ds_read_b64_tr_b16 a[28:29], v45 offset:8192
    v_mfma_f32_16x16x32_bf16 v[244:247], a[48:51], a[228:231], v[244:247]
    v_mfma_f32_16x16x32_bf16 a[112:115], a[48:51], a[232:235], a[112:115]
    ds_read_b64_tr_b16 a[30:31], v45 offset:9216
    v_mfma_f32_16x16x32_bf16 a[112:115], a[52:55], a[248:251], a[112:115]
    buffer_load_dwordx4 a[188:191], v55, s[8:11], s62 offen sc1
    v_mfma_f32_16x16x32_bf16 a[116:119], a[52:55], a[252:255], a[116:119]
    v_mfma_f32_16x16x32_bf16 a[116:119], a[48:51], a[236:239], a[116:119]
    s_add_u32 s62, s62, 0x20000
    v_mfma_f32_16x16x32_bf16 a[124:127], a[56:59], a[236:239], a[124:127]
    s_add_u32 s52, s47, 4096
    v_mfma_f32_16x16x32_bf16 a[124:127], a[60:63], a[252:255], a[124:127]
    buffer_store_dwordx4 v[80:83], v1, s[48:51], s52 offen offset:0 sc1
    v_mfma_f32_16x16x32_bf16 a[120:123], a[60:63], a[248:251], a[120:123]
    v_mfma_f32_16x16x32_bf16 a[120:123], a[56:59], a[232:235], a[120:123]
    v_mfma_f32_16x16x32_bf16 v[252:255], a[56:59], a[228:231], v[252:255]
    v_mfma_f32_16x16x32_bf16 v[252:255], a[60:63], a[244:247], v[252:255]
    v_mfma_f32_16x16x32_bf16 v[248:251], a[60:63], a[240:243], v[248:251]
    v_mfma_f32_16x16x32_bf16 v[248:251], a[56:59], a[224:227], v[248:251]
    s_waitcnt vmcnt(15) lgkmcnt(0)
    v_mfma_f32_16x16x32_bf16 v[192:195], a[0:3], a[128:131], v[192:195]
    v_mfma_f32_16x16x32_bf16 v[192:195], a[4:7], a[144:147], v[192:195]
    buffer_load_dwordx4 a[192:195], v36, s[8:11], s62 offen sc1
    ds_read_b64_tr_b16 a[32:33], v46 offset:0
    v_mfma_f32_16x16x32_bf16 v[196:199], a[4:7], a[148:151], v[196:199]
    ds_read_b64_tr_b16 a[34:35], v46 offset:1024
    v_mfma_f32_16x16x32_bf16 v[196:199], a[0:3], a[132:135], v[196:199]
    ds_read_b64_tr_b16 a[36:37], v46 offset:8192
    v_mfma_f32_16x16x32_bf16 a[64:67], a[0:3], a[136:139], a[64:67]
    ds_read_b64_tr_b16 a[38:39], v46 offset:9216
    v_mfma_f32_16x16x32_bf16 a[64:67], a[4:7], a[152:155], a[64:67]
    ds_read_b64_tr_b16 a[40:41], v47 offset:0
    v_mfma_f32_16x16x32_bf16 a[68:71], a[4:7], a[156:159], a[68:71]
    buffer_load_dwordx4 a[196:199], v54, s[8:11], s62 offen sc1
    v_mfma_f32_16x16x32_bf16 a[68:71], a[0:3], a[140:143], a[68:71]
    ds_read_b64_tr_b16 a[42:43], v47 offset:1024
    v_mfma_f32_16x16x32_bf16 a[76:79], a[8:11], a[140:143], a[76:79]
    ds_read_b64_tr_b16 a[44:45], v47 offset:8192
    v_mfma_f32_16x16x32_bf16 a[76:79], a[12:15], a[156:159], a[76:79]
    ds_read_b64_tr_b16 a[46:47], v47 offset:9216
    v_mfma_f32_16x16x32_bf16 a[72:75], a[12:15], a[152:155], a[72:75]
    ds_read_b64_tr_b16 a[48:49], v48 offset:0
    v_mfma_f32_16x16x32_bf16 a[72:75], a[8:11], a[136:139], a[72:75]
    buffer_load_dwordx4 a[200:203], v37, s[8:11], s62 offen sc1
    v_mfma_f32_16x16x32_bf16 v[204:207], a[8:11], a[132:135], v[204:207]
    ds_read_b64_tr_b16 a[50:51], v48 offset:1024
    v_mfma_f32_16x16x32_bf16 v[204:207], a[12:15], a[148:151], v[204:207]
    ds_read_b64_tr_b16 a[52:53], v48 offset:8192
    v_mfma_f32_16x16x32_bf16 v[200:203], a[12:15], a[144:147], v[200:203]
    ds_read_b64_tr_b16 a[54:55], v48 offset:9216
    v_mfma_f32_16x16x32_bf16 v[200:203], a[8:11], a[128:131], v[200:203]
    v_mfma_f32_16x16x32_bf16 v[208:211], a[16:19], a[128:131], v[208:211]
    ds_read_b64_tr_b16 a[56:57], v49 offset:0
    v_mfma_f32_16x16x32_bf16 v[208:211], a[20:23], a[144:147], v[208:211]
    buffer_load_dwordx4 a[204:207], v55, s[8:11], s62 offen sc1
    ds_read_b64_tr_b16 a[58:59], v49 offset:1024
    v_mfma_f32_16x16x32_bf16 v[212:215], a[20:23], a[148:151], v[212:215]
    ds_read_b64_tr_b16 a[60:61], v49 offset:8192
    v_mfma_f32_16x16x32_bf16 v[212:215], a[16:19], a[132:135], v[212:215]
    v_mfma_f32_16x16x32_bf16 a[80:83], a[16:19], a[136:139], a[80:83]
    ds_read_b64_tr_b16 a[62:63], v49 offset:9216
    v_mfma_f32_16x16x32_bf16 a[80:83], a[20:23], a[152:155], a[80:83]
    s_add_u32 s62, s62, 0x20000
    v_mfma_f32_16x16x32_bf16 a[84:87], a[20:23], a[156:159], a[84:87]
    s_add_u32 s52, s47, 4096
    v_mfma_f32_16x16x32_bf16 a[84:87], a[16:19], a[140:143], a[84:87]
    buffer_store_dwordx4 v[84:87], v1, s[48:51], s52 offen offset:1024 sc1
    v_mfma_f32_16x16x32_bf16 a[92:95], a[24:27], a[140:143], a[92:95]
    v_mfma_f32_16x16x32_bf16 a[92:95], a[28:31], a[156:159], a[92:95]
    v_mfma_f32_16x16x32_bf16 a[88:91], a[28:31], a[152:155], a[88:91]
    v_mfma_f32_16x16x32_bf16 a[88:91], a[24:27], a[136:139], a[88:91]
    v_mfma_f32_16x16x32_bf16 v[220:223], a[24:27], a[132:135], v[220:223]
    v_mfma_f32_16x16x32_bf16 v[220:223], a[28:31], a[148:151], v[220:223]
    v_mfma_f32_16x16x32_bf16 v[216:219], a[28:31], a[144:147], v[216:219]
    v_mfma_f32_16x16x32_bf16 v[216:219], a[24:27], a[128:131], v[216:219]
    s_waitcnt vmcnt(10) lgkmcnt(0)
    s_barrier
    v_mfma_f32_16x16x32_bf16 v[224:227], a[32:35], a[128:131], v[224:227]
    v_mfma_f32_16x16x32_bf16 v[224:227], a[36:39], a[144:147], v[224:227]
    s_add_u32 m0, s60, 131072
    ds_read_b64_tr_b16 a[0:1], v42 offset:16384
    ds_read_b64_tr_b16 a[2:3], v42 offset:17408
    v_mfma_f32_16x16x32_bf16 v[228:231], a[36:39], a[148:151], v[228:231]
    buffer_load_dwordx4 v38, s[12:15], s61 offen offset:0 lds
    v_mfma_f32_16x16x32_bf16 v[228:231], a[32:35], a[132:135], v[228:231]
    ds_read_b64_tr_b16 a[4:5], v42 offset:24576
    v_mfma_f32_16x16x32_bf16 a[96:99], a[32:35], a[136:139], a[96:99]
    buffer_load_dwordx4 v39, s[12:15], s61 offen offset:1024 lds
    ds_read_b64_tr_b16 a[6:7], v42 offset:25600
    v_mfma_f32_16x16x32_bf16 a[96:99], a[36:39], a[152:155], a[96:99]
    ds_read_b64_tr_b16 a[8:9], v43 offset:16384
    v_mfma_f32_16x16x32_bf16 a[100:103], a[36:39], a[156:159], a[100:103]
    v_mfma_f32_16x16x32_bf16 a[100:103], a[32:35], a[140:143], a[100:103]
    buffer_load_dwordx4 v40, s[12:15], s61 offen offset:2048 lds
    ds_read_b64_tr_b16 a[10:11], v43 offset:17408
    v_mfma_f32_16x16x32_bf16 a[108:111], a[40:43], a[140:143], a[108:111]
    ds_read_b64_tr_b16 a[12:13], v43 offset:24576
    v_mfma_f32_16x16x32_bf16 a[108:111], a[44:47], a[156:159], a[108:111]
    ds_read_b64_tr_b16 a[14:15], v43 offset:25600
    v_mfma_f32_16x16x32_bf16 a[104:107], a[44:47], a[152:155], a[104:107]
    ds_read_b64_tr_b16 a[16:17], v44 offset:16384
    v_mfma_f32_16x16x32_bf16 a[104:107], a[40:43], a[136:139], a[104:107]
    buffer_load_dwordx4 v41, s[12:15], s61 offen offset:3072 lds
    v_mfma_f32_16x16x32_bf16 v[236:239], a[40:43], a[132:135], v[236:239]
    ds_read_b64_tr_b16 a[18:19], v44 offset:17408
    v_mfma_f32_16x16x32_bf16 v[236:239], a[44:47], a[148:151], v[236:239]
    s_add_u32 s61, s61, 0x80000
    ds_read_b64_tr_b16 a[20:21], v44 offset:24576
    v_mfma_f32_16x16x32_bf16 v[232:235], a[44:47], a[144:147], v[232:235]
    buffer_load_dwordx4 a[208:211], v36, s[8:11], s62 offen sc1
    ds_read_b64_tr_b16 a[22:23], v44 offset:25600
    v_mfma_f32_16x16x32_bf16 v[232:235], a[40:43], a[128:131], v[232:235]
    v_mfma_f32_16x16x32_bf16 v[240:243], a[48:51], a[128:131], v[240:243]
    ds_read_b64_tr_b16 a[24:25], v45 offset:16384
    v_mfma_f32_16x16x32_bf16 v[240:243], a[52:55], a[144:147], v[240:243]
    buffer_load_dwordx4 a[212:215], v54, s[8:11], s62 offen sc1
    ds_read_b64_tr_b16 a[26:27], v45 offset:17408
    v_mfma_f32_16x16x32_bf16 v[244:247], a[52:55], a[148:151], v[244:247]
    ds_read_b64_tr_b16 a[28:29], v45 offset:24576
    v_mfma_f32_16x16x32_bf16 v[244:247], a[48:51], a[132:135], v[244:247]
    v_mfma_f32_16x16x32_bf16 a[112:115], a[48:51], a[136:139], a[112:115]
    buffer_load_dwordx4 a[216:219], v37, s[8:11], s62 offen sc1
    ds_read_b64_tr_b16 a[30:31], v45 offset:25600
    v_mfma_f32_16x16x32_bf16 a[112:115], a[52:55], a[152:155], a[112:115]
    v_mfma_f32_16x16x32_bf16 a[116:119], a[52:55], a[156:159], a[116:119]
    v_mfma_f32_16x16x32_bf16 a[116:119], a[48:51], a[140:143], a[116:119]
    v_mfma_f32_16x16x32_bf16 a[124:127], a[56:59], a[140:143], a[124:127]
    buffer_load_dwordx4 a[220:223], v55, s[8:11], s62 offen sc1
    v_mfma_f32_16x16x32_bf16 a[124:127], a[60:63], a[156:159], a[124:127]
    v_mfma_f32_16x16x32_bf16 a[120:123], a[60:63], a[152:155], a[120:123]
    s_add_u32 s62, s62, 0x20000
    v_mfma_f32_16x16x32_bf16 a[120:123], a[56:59], a[136:139], a[120:123]
    v_mfma_f32_16x16x32_bf16 v[252:255], a[56:59], a[132:135], v[252:255]
    s_cmp_eq_u32 s45, 0
    s_cbranch_scc1 k12_ool_52
k12_oolret_53:
    v_mfma_f32_16x16x32_bf16 v[252:255], a[60:63], a[148:151], v[252:255]
    v_mfma_f32_16x16x32_bf16 v[248:251], a[60:63], a[144:147], v[248:251]
    v_mfma_f32_16x16x32_bf16 v[248:251], a[56:59], a[128:131], v[248:251]
    s_waitcnt vmcnt(14) lgkmcnt(0)
    v_mfma_f32_16x16x32_bf16 v[192:195], a[0:3], a[160:163], v[192:195]
    v_mfma_f32_16x16x32_bf16 v[192:195], a[4:7], a[176:179], v[192:195]
    buffer_load_dwordx4 a[224:227], v36, s[8:11], s62 offen sc1
    ds_read_b64_tr_b16 a[32:33], v46 offset:16384
    v_mfma_f32_16x16x32_bf16 v[196:199], a[4:7], a[180:183], v[196:199]
    ds_read_b64_tr_b16 a[34:35], v46 offset:17408
    v_mfma_f32_16x16x32_bf16 v[196:199], a[0:3], a[164:167], v[196:199]
    ds_read_b64_tr_b16 a[36:37], v46 offset:24576
    v_mfma_f32_16x16x32_bf16 a[64:67], a[0:3], a[168:171], a[64:67]
    ds_read_b64_tr_b16 a[38:39], v46 offset:25600
    v_mfma_f32_16x16x32_bf16 a[64:67], a[4:7], a[184:187], a[64:67]
    ds_read_b64_tr_b16 a[40:41], v47 offset:16384
    v_mfma_f32_16x16x32_bf16 a[68:71], a[4:7], a[188:191], a[68:71]
    buffer_load_dwordx4 a[228:231], v54, s[8:11], s62 offen sc1
    v_mfma_f32_16x16x32_bf16 a[68:71], a[0:3], a[172:175], a[68:71]
    ds_read_b64_tr_b16 a[42:43], v47 offset:17408
    v_mfma_f32_16x16x32_bf16 a[76:79], a[8:11], a[172:175], a[76:79]
    ds_read_b64_tr_b16 a[44:45], v47 offset:24576
    v_mfma_f32_16x16x32_bf16 a[76:79], a[12:15], a[188:191], a[76:79]
    ds_read_b64_tr_b16 a[46:47], v47 offset:25600
    v_mfma_f32_16x16x32_bf16 a[72:75], a[12:15], a[184:187], a[72:75]
    ds_read_b64_tr_b16 a[48:49], v48 offset:16384
    v_mfma_f32_16x16x32_bf16 a[72:75], a[8:11], a[168:171], a[72:75]
    buffer_load_dwordx4 a[232:235], v37, s[8:11], s62 offen sc1
    v_mfma_f32_16x16x32_bf16 v[204:207], a[8:11], a[164:167], v[204:207]
    ds_read_b64_tr_b16 a[50:51], v48 offset:17408
    v_mfma_f32_16x16x32_bf16 v[204:207], a[12:15], a[180:183], v[204:207]
    ds_read_b64_tr_b16 a[52:53], v48 offset:24576
    v_mfma_f32_16x16x32_bf16 v[200:203], a[12:15], a[176:179], v[200:203]
    ds_read_b64_tr_b16 a[54:55], v48 offset:25600
    v_mfma_f32_16x16x32_bf16 v[200:203], a[8:11], a[160:163], v[200:203]
    v_mfma_f32_16x16x32_bf16 v[208:211], a[16:19], a[160:163], v[208:211]
    ds_read_b64_tr_b16 a[56:57], v49 offset:16384
    v_mfma_f32_16x16x32_bf16 v[208:211], a[20:23], a[176:179], v[208:211]
    buffer_load_dwordx4 a[236:239], v55, s[8:11], s62 offen sc1
    ds_read_b64_tr_b16 a[58:59], v49 offset:17408
    v_mfma_f32_16x16x32_bf16 v[212:215], a[20:23], a[180:183], v[212:215]
    ds_read_b64_tr_b16 a[60:61], v49 offset:24576
    v_mfma_f32_16x16x32_bf16 v[212:215], a[16:19], a[164:167], v[212:215]
    v_mfma_f32_16x16x32_bf16 a[80:83], a[16:19], a[168:171], a[80:83]
    ds_read_b64_tr_b16 a[62:63], v49 offset:25600
    v_mfma_f32_16x16x32_bf16 a[80:83], a[20:23], a[184:187], a[80:83]
    s_add_u32 s62, s62, 0x20000
    v_mfma_f32_16x16x32_bf16 a[84:87], a[20:23], a[188:191], a[84:87]
    s_add_u32 s52, s47, 4096
    v_mfma_f32_16x16x32_bf16 a[84:87], a[16:19], a[172:175], a[84:87]
    buffer_store_dwordx4 v[88:91], v1, s[48:51], s52 offen offset:2048 sc1
    v_mfma_f32_16x16x32_bf16 a[92:95], a[24:27], a[172:175], a[92:95]
    v_mfma_f32_16x16x32_bf16 a[92:95], a[28:31], a[188:191], a[92:95]
    v_mfma_f32_16x16x32_bf16 a[88:91], a[28:31], a[184:187], a[88:91]
    v_mfma_f32_16x16x32_bf16 a[88:91], a[24:27], a[168:171], a[88:91]
    v_mfma_f32_16x16x32_bf16 v[220:223], a[24:27], a[164:167], v[220:223]
    v_mfma_f32_16x16x32_bf16 v[220:223], a[28:31], a[180:183], v[220:223]
    v_mfma_f32_16x16x32_bf16 v[216:219], a[28:31], a[176:179], v[216:219]
    v_mfma_f32_16x16x32_bf16 v[216:219], a[24:27], a[160:163], v[216:219]
    s_waitcnt vmcnt(9) lgkmcnt(0)
    s_barrier
    v_mfma_f32_16x16x32_bf16 v[224:227], a[32:35], a[160:163], v[224:227]
    v_mfma_f32_16x16x32_bf16 v[224:227], a[36:39], a[176:179], v[224:227]
    s_add_u32 m0, s60, 147456
    ds_read_b64_tr_b16 a[0:1], v42 offset:32768
    ds_read_b64_tr_b16 a[2:3], v42 offset:33792
    v_mfma_f32_16x16x32_bf16 v[228:231], a[36:39], a[180:183], v[228:231]
    buffer_load_dwordx4 v38, s[12:15], s61 offen offset:0 lds
    v_mfma_f32_16x16x32_bf16 v[228:231], a[32:35], a[164:167], v[228:231]
    ds_read_b64_tr_b16 a[4:5], v42 offset:40960
    v_mfma_f32_16x16x32_bf16 a[96:99], a[32:35], a[168:171], a[96:99]
    buffer_load_dwordx4 v39, s[12:15], s61 offen offset:1024 lds
    ds_read_b64_tr_b16 a[6:7], v42 offset:41984
    v_mfma_f32_16x16x32_bf16 a[96:99], a[36:39], a[184:187], a[96:99]
    ds_read_b64_tr_b16 a[8:9], v43 offset:32768
    v_mfma_f32_16x16x32_bf16 a[100:103], a[36:39], a[188:191], a[100:103]
    v_mfma_f32_16x16x32_bf16 a[100:103], a[32:35], a[172:175], a[100:103]
    buffer_load_dwordx4 v40, s[12:15], s61 offen offset:2048 lds
    ds_read_b64_tr_b16 a[10:11], v43 offset:33792
    v_mfma_f32_16x16x32_bf16 a[108:111], a[40:43], a[172:175], a[108:111]
    ds_read_b64_tr_b16 a[12:13], v43 offset:40960
    v_mfma_f32_16x16x32_bf16 a[108:111], a[44:47], a[188:191], a[108:111]
    ds_read_b64_tr_b16 a[14:15], v43 offset:41984
    v_mfma_f32_16x16x32_bf16 a[104:107], a[44:47], a[184:187], a[104:107]
    buffer_load_dwordx4 v41, s[12:15], s61 offen offset:3072 lds
    ds_read_b64_tr_b16 a[16:17], v44 offset:32768
    v_mfma_f32_16x16x32_bf16 a[104:107], a[40:43], a[168:171], a[104:107]
    v_mfma_f32_16x16x32_bf16 v[236:239], a[40:43], a[164:167], v[236:239]
    s_add_u32 s61, s61, 0x80000
    ds_read_b64_tr_b16 a[18:19], v44 offset:33792
    v_mfma_f32_16x16x32_bf16 v[236:239], a[44:47], a[180:183], v[236:239]
    buffer_load_dwordx4 a[240:243], v36, s[8:11], s62 offen sc1
    ds_read_b64_tr_b16 a[20:21], v44 offset:40960
    v_mfma_f32_16x16x32_bf16 v[232:235], a[44:47], a[176:179], v[232:235]
    ds_read_b64_tr_b16 a[22:23], v44 offset:41984
    v_mfma_f32_16x16x32_bf16 v[232:235], a[40:43], a[160:163], v[232:235]
    buffer_load_dwordx4 a[244:247], v54, s[8:11], s62 offen sc1
    v_mfma_f32_16x16x32_bf16 v[240:243], a[48:51], a[160:163], v[240:243]
    ds_read_b64_tr_b16 a[24:25], v45 offset:32768
    v_mfma_f32_16x16x32_bf16 v[240:243], a[52:55], a[176:179], v[240:243]
    ds_read_b64_tr_b16 a[26:27], v45 offset:33792
    v_mfma_f32_16x16x32_bf16 v[244:247], a[52:55], a[180:183], v[244:247]
    buffer_load_dwordx4 a[248:251], v37, s[8:11], s62 offen sc1
    ds_read_b64_tr_b16 a[28:29], v45 offset:40960
    v_mfma_f32_16x16x32_bf16 v[244:247], a[48:51], a[164:167], v[244:247]
    v_mfma_f32_16x16x32_bf16 a[112:115], a[48:51], a[168:171], a[112:115]
    ds_read_b64_tr_b16 a[30:31], v45 offset:41984
    v_mfma_f32_16x16x32_bf16 a[112:115], a[52:55], a[184:187], a[112:115]
    buffer_load_dwordx4 a[252:255], v55, s[8:11], s62 offen sc1
    v_mfma_f32_16x16x32_bf16 a[116:119], a[52:55], a[188:191], a[116:119]
    v_mfma_f32_16x16x32_bf16 a[116:119], a[48:51], a[172:175], a[116:119]
    s_add_u32 s62, s62, 0x20000
    v_mfma_f32_16x16x32_bf16 a[124:127], a[56:59], a[172:175], a[124:127]
    s_add_u32 s52, s47, 4096
    v_mfma_f32_16x16x32_bf16 a[124:127], a[60:63], a[188:191], a[124:127]
    buffer_store_dwordx4 v[92:95], v1, s[48:51], s52 offen offset:3072 sc1
    v_mfma_f32_16x16x32_bf16 a[120:123], a[60:63], a[184:187], a[120:123]
    v_mfma_f32_16x16x32_bf16 a[120:123], a[56:59], a[168:171], a[120:123]
    v_mfma_f32_16x16x32_bf16 v[252:255], a[56:59], a[164:167], v[252:255]
    s_cmp_eq_u32 s45, 0
    s_cbranch_scc1 k12_ool_54
k12_oolret_55:
    v_mfma_f32_16x16x32_bf16 v[252:255], a[60:63], a[180:183], v[252:255]
    v_mfma_f32_16x16x32_bf16 v[248:251], a[60:63], a[176:179], v[248:251]
    v_mfma_f32_16x16x32_bf16 v[248:251], a[56:59], a[160:163], v[248:251]
    s_waitcnt vmcnt(14) lgkmcnt(0)
    v_mfma_f32_16x16x32_bf16 v[192:195], a[0:3], a[192:195], v[192:195]
    v_mfma_f32_16x16x32_bf16 v[192:195], a[4:7], a[208:211], v[192:195]
    buffer_load_dwordx4 a[128:131], v36, s[8:11], s62 offen sc1
    ds_read_b64_tr_b16 a[32:33], v46 offset:32768
    v_mfma_f32_16x16x32_bf16 v[196:199], a[4:7], a[212:215], v[196:199]
    ds_read_b64_tr_b16 a[34:35], v46 offset:33792
    v_mfma_f32_16x16x32_bf16 v[196:199], a[0:3], a[196:199], v[196:199]
    ds_read_b64_tr_b16 a[36:37], v46 offset:40960
    v_mfma_f32_16x16x32_bf16 a[64:67], a[0:3], a[200:203], a[64:67]
    ds_read_b64_tr_b16 a[38:39], v46 offset:41984
    v_mfma_f32_16x16x32_bf16 a[64:67], a[4:7], a[216:219], a[64:67]
    ds_read_b64_tr_b16 a[40:41], v47 offset:32768
    v_mfma_f32_16x16x32_bf16 a[68:71], a[4:7], a[220:223], a[68:71]
    buffer_load_dwordx4 a[132:135], v54, s[8:11], s62 offen sc1
    v_mfma_f32_16x16x32_bf16 a[68:71], a[0:3], a[204:207], a[68:71]
    ds_read_b64_tr_b16 a[42:43], v47 offset:33792
    v_mfma_f32_16x16x32_bf16 a[76:79], a[8:11], a[204:207], a[76:79]
    ds_read_b64_tr_b16 a[44:45], v47 offset:40960
    v_mfma_f32_16x16x32_bf16 a[76:79], a[12:15], a[220:223], a[76:79]
    ds_read_b64_tr_b16 a[46:47], v47 offset:41984
    v_mfma_f32_16x16x32_bf16 a[72:75], a[12:15], a[216:219], a[72:75]
    ds_read_b64_tr_b16 a[48:49], v48 offset:32768
    v_mfma_f32_16x16x32_bf16 a[72:75], a[8:11], a[200:203], a[72:75]
    buffer_load_dwordx4 a[136:139], v37, s[8:11], s62 offen sc1
    v_mfma_f32_16x16x32_bf16 v[204:207], a[8:11], a[196:199], v[204:207]
    ds_read_b64_tr_b16 a[50:51], v48 offset:33792
    v_mfma_f32_16x16x32_bf16 v[204:207], a[12:15], a[212:215], v[204:207]
    ds_read_b64_tr_b16 a[52:53], v48 offset:40960
    v_mfma_f32_16x16x32_bf16 v[200:203], a[12:15], a[208:211], v[200:203]
    ds_read_b64_tr_b16 a[54:55], v48 offset:41984
    v_mfma_f32_16x16x32_bf16 v[200:203], a[8:11], a[192:195], v[200:203]
    v_mfma_f32_16x16x32_bf16 v[208:211], a[16:19], a[192:195], v[208:211]
    ds_read_b64_tr_b16 a[56:57], v49 offset:32768
    v_mfma_f32_16x16x32_bf16 v[208:211], a[20:23], a[208:211], v[208:211]
    buffer_load_dwordx4 a[140:143], v55, s[8:11], s62 offen sc1
    ds_read_b64_tr_b16 a[58:59], v49 offset:33792
    v_mfma_f32_16x16x32_bf16 v[212:215], a[20:23], a[212:215], v[212:215]
    ds_read_b64_tr_b16 a[60:61], v49 offset:40960
    v_mfma_f32_16x16x32_bf16 v[212:215], a[16:19], a[196:199], v[212:215]
    v_mfma_f32_16x16x32_bf16 a[80:83], a[16:19], a[200:203], a[80:83]
    ds_read_b64_tr_b16 a[62:63], v49 offset:41984
    v_mfma_f32_16x16x32_bf16 a[80:83], a[20:23], a[216:219], a[80:83]
    s_add_u32 s62, s62, 0x20000
    v_mfma_f32_16x16x32_bf16 a[84:87], a[20:23], a[220:223], a[84:87]
    s_add_u32 s52, s47, 8192
    v_mfma_f32_16x16x32_bf16 a[84:87], a[16:19], a[204:207], a[84:87]
    buffer_store_dwordx4 v[104:107], v1, s[48:51], s52 offen offset:2048 sc1
    v_mfma_f32_16x16x32_bf16 a[92:95], a[24:27], a[204:207], a[92:95]
    v_mfma_f32_16x16x32_bf16 a[92:95], a[28:31], a[220:223], a[92:95]
    v_mfma_f32_16x16x32_bf16 a[88:91], a[28:31], a[216:219], a[88:91]
    v_mfma_f32_16x16x32_bf16 a[88:91], a[24:27], a[200:203], a[88:91]
    v_mfma_f32_16x16x32_bf16 v[220:223], a[24:27], a[196:199], v[220:223]
    v_mfma_f32_16x16x32_bf16 v[220:223], a[28:31], a[212:215], v[220:223]
    v_mfma_f32_16x16x32_bf16 v[216:219], a[28:31], a[208:211], v[216:219]
    v_mfma_f32_16x16x32_bf16 v[216:219], a[24:27], a[192:195], v[216:219]
    s_waitcnt vmcnt(10) lgkmcnt(0)
    s_barrier
    v_mfma_f32_16x16x32_bf16 v[224:227], a[32:35], a[192:195], v[224:227]
    v_mfma_f32_16x16x32_bf16 v[224:227], a[36:39], a[208:211], v[224:227]
    s_add_u32 m0, s60, 98304
    ds_read_b64_tr_b16 a[0:1], v42 offset:49152
    ds_read_b64_tr_b16 a[2:3], v42 offset:50176
    v_mfma_f32_16x16x32_bf16 v[228:231], a[36:39], a[212:215], v[228:231]
    buffer_load_dwordx4 v38, s[12:15], s61 offen offset:0 lds
    v_mfma_f32_16x16x32_bf16 v[228:231], a[32:35], a[196:199], v[228:231]
    ds_read_b64_tr_b16 a[4:5], v42 offset:57344
    v_mfma_f32_16x16x32_bf16 a[96:99], a[32:35], a[200:203], a[96:99]
    buffer_load_dwordx4 v39, s[12:15], s61 offen offset:1024 lds
    ds_read_b64_tr_b16 a[6:7], v42 offset:58368
    v_mfma_f32_16x16x32_bf16 a[96:99], a[36:39], a[216:219], a[96:99]
    ds_read_b64_tr_b16 a[8:9], v43 offset:49152
    v_mfma_f32_16x16x32_bf16 a[100:103], a[36:39], a[220:223], a[100:103]
    v_mfma_f32_16x16x32_bf16 a[100:103], a[32:35], a[204:207], a[100:103]
    buffer_load_dwordx4 v40, s[12:15], s61 offen offset:2048 lds
    ds_read_b64_tr_b16 a[10:11], v43 offset:50176
    v_mfma_f32_16x16x32_bf16 a[108:111], a[40:43], a[204:207], a[108:111]
    ds_read_b64_tr_b16 a[12:13], v43 offset:57344
    v_mfma_f32_16x16x32_bf16 a[108:111], a[44:47], a[220:223], a[108:111]
    ds_read_b64_tr_b16 a[14:15], v43 offset:58368
    v_mfma_f32_16x16x32_bf16 a[104:107], a[44:47], a[216:219], a[104:107]
    buffer_load_dwordx4 v41, s[12:15], s61 offen offset:3072 lds
    ds_read_b64_tr_b16 a[16:17], v44 offset:49152
    v_mfma_f32_16x16x32_bf16 a[104:107], a[40:43], a[200:203], a[104:107]
    v_mfma_f32_16x16x32_bf16 v[236:239], a[40:43], a[196:199], v[236:239]
    s_add_u32 s61, s61, 0x80000
    ds_read_b64_tr_b16 a[18:19], v44 offset:50176
    v_mfma_f32_16x16x32_bf16 v[236:239], a[44:47], a[212:215], v[236:239]
    buffer_load_dwordx4 a[144:147], v36, s[8:11], s62 offen sc1
    ds_read_b64_tr_b16 a[20:21], v44 offset:57344
    v_mfma_f32_16x16x32_bf16 v[232:235], a[44:47], a[208:211], v[232:235]
    ds_read_b64_tr_b16 a[22:23], v44 offset:58368
    v_mfma_f32_16x16x32_bf16 v[232:235], a[40:43], a[192:195], v[232:235]
    buffer_load_dwordx4 a[148:151], v54, s[8:11], s62 offen sc1
    v_mfma_f32_16x16x32_bf16 v[240:243], a[48:51], a[192:195], v[240:243]
    ds_read_b64_tr_b16 a[24:25], v45 offset:49152
    v_mfma_f32_16x16x32_bf16 v[240:243], a[52:55], a[208:211], v[240:243]
    ds_read_b64_tr_b16 a[26:27], v45 offset:50176
    v_mfma_f32_16x16x32_bf16 v[244:247], a[52:55], a[212:215], v[244:247]
    buffer_load_dwordx4 a[152:155], v37, s[8:11], s62 offen sc1
    ds_read_b64_tr_b16 a[28:29], v45 offset:57344
    v_mfma_f32_16x16x32_bf16 v[244:247], a[48:51], a[196:199], v[244:247]
    v_mfma_f32_16x16x32_bf16 a[112:115], a[48:51], a[200:203], a[112:115]
    ds_read_b64_tr_b16 a[30:31], v45 offset:58368
    v_mfma_f32_16x16x32_bf16 a[112:115], a[52:55], a[216:219], a[112:115]
    buffer_load_dwordx4 a[156:159], v55, s[8:11], s62 offen sc1
    v_mfma_f32_16x16x32_bf16 a[116:119], a[52:55], a[220:223], a[116:119]
    v_mfma_f32_16x16x32_bf16 a[116:119], a[48:51], a[204:207], a[116:119]
    s_add_u32 s62, s62, 0x20000
    v_mfma_f32_16x16x32_bf16 a[124:127], a[56:59], a[204:207], a[124:127]
    s_add_u32 s52, s47, 8192
    v_mfma_f32_16x16x32_bf16 a[124:127], a[60:63], a[220:223], a[124:127]
    buffer_store_dwordx4 v[108:111], v1, s[48:51], s52 offen offset:3072 sc1
    v_mfma_f32_16x16x32_bf16 a[120:123], a[60:63], a[216:219], a[120:123]
    v_mfma_f32_16x16x32_bf16 a[120:123], a[56:59], a[200:203], a[120:123]
    v_mfma_f32_16x16x32_bf16 v[252:255], a[56:59], a[196:199], v[252:255]
    v_mfma_f32_16x16x32_bf16 v[252:255], a[60:63], a[212:215], v[252:255]
    v_mfma_f32_16x16x32_bf16 v[248:251], a[60:63], a[208:211], v[248:251]
    v_mfma_f32_16x16x32_bf16 v[248:251], a[56:59], a[192:195], v[248:251]
    s_waitcnt vmcnt(15) lgkmcnt(0)
    v_mfma_f32_16x16x32_bf16 v[192:195], a[0:3], a[224:227], v[192:195]
    v_mfma_f32_16x16x32_bf16 v[192:195], a[4:7], a[240:243], v[192:195]
    buffer_load_dwordx4 a[160:163], v36, s[8:11], s62 offen sc1
    ds_read_b64_tr_b16 a[32:33], v46 offset:49152
    v_mfma_f32_16x16x32_bf16 v[196:199], a[4:7], a[244:247], v[196:199]
    ds_read_b64_tr_b16 a[34:35], v46 offset:50176
    v_mfma_f32_16x16x32_bf16 v[196:199], a[0:3], a[228:231], v[196:199]
    ds_read_b64_tr_b16 a[36:37], v46 offset:57344
    v_mfma_f32_16x16x32_bf16 a[64:67], a[0:3], a[232:235], a[64:67]
    ds_read_b64_tr_b16 a[38:39], v46 offset:58368
    v_mfma_f32_16x16x32_bf16 a[64:67], a[4:7], a[248:251], a[64:67]
    ds_read_b64_tr_b16 a[40:41], v47 offset:49152
    v_mfma_f32_16x16x32_bf16 a[68:71], a[4:7], a[252:255], a[68:71]
    buffer_load_dwordx4 a[164:167], v54, s[8:11], s62 offen sc1
    v_mfma_f32_16x16x32_bf16 a[68:71], a[0:3], a[236:239], a[68:71]
    ds_read_b64_tr_b16 a[42:43], v47 offset:50176
    v_mfma_f32_16x16x32_bf16 a[76:79], a[8:11], a[236:239], a[76:79]
    ds_read_b64_tr_b16 a[44:45], v47 offset:57344
    v_mfma_f32_16x16x32_bf16 a[76:79], a[12:15], a[252:255], a[76:79]
    ds_read_b64_tr_b16 a[46:47], v47 offset:58368
    v_mfma_f32_16x16x32_bf16 a[72:75], a[12:15], a[248:251], a[72:75]
    ds_read_b64_tr_b16 a[48:49], v48 offset:49152
    v_mfma_f32_16x16x32_bf16 a[72:75], a[8:11], a[232:235], a[72:75]
    buffer_load_dwordx4 a[168:171], v37, s[8:11], s62 offen sc1
    v_mfma_f32_16x16x32_bf16 v[204:207], a[8:11], a[228:231], v[204:207]
    ds_read_b64_tr_b16 a[50:51], v48 offset:50176
    v_mfma_f32_16x16x32_bf16 v[204:207], a[12:15], a[244:247], v[204:207]
    ds_read_b64_tr_b16 a[52:53], v48 offset:57344
    v_mfma_f32_16x16x32_bf16 v[200:203], a[12:15], a[240:243], v[200:203]
    ds_read_b64_tr_b16 a[54:55], v48 offset:58368
    v_mfma_f32_16x16x32_bf16 v[200:203], a[8:11], a[224:227], v[200:203]
    v_mfma_f32_16x16x32_bf16 v[208:211], a[16:19], a[224:227], v[208:211]
    ds_read_b64_tr_b16 a[56:57], v49 offset:49152
    v_mfma_f32_16x16x32_bf16 v[208:211], a[20:23], a[240:243], v[208:211]
    buffer_load_dwordx4 a[172:175], v55, s[8:11], s62 offen sc1
    ds_read_b64_tr_b16 a[58:59], v49 offset:50176
    v_mfma_f32_16x16x32_bf16 v[212:215], a[20:23], a[244:247], v[212:215]
    ds_read_b64_tr_b16 a[60:61], v49 offset:57344
    v_mfma_f32_16x16x32_bf16 v[212:215], a[16:19], a[228:231], v[212:215]
    v_mfma_f32_16x16x32_bf16 a[80:83], a[16:19], a[232:235], a[80:83]
    ds_read_b64_tr_b16 a[62:63], v49 offset:58368
    v_mfma_f32_16x16x32_bf16 a[80:83], a[20:23], a[248:251], a[80:83]
    s_add_u32 s62, s62, 0x20000
    v_mfma_f32_16x16x32_bf16 a[84:87], a[20:23], a[252:255], a[84:87]
    s_add_u32 s52, s47, 12288
    v_mfma_f32_16x16x32_bf16 a[84:87], a[16:19], a[236:239], a[84:87]
    buffer_store_dwordx4 v[112:115], v1, s[48:51], s52 offen offset:0 sc1
    v_mfma_f32_16x16x32_bf16 a[92:95], a[24:27], a[236:239], a[92:95]
    v_mfma_f32_16x16x32_bf16 a[92:95], a[28:31], a[252:255], a[92:95]
    v_mfma_f32_16x16x32_bf16 a[88:91], a[28:31], a[248:251], a[88:91]
    v_mfma_f32_16x16x32_bf16 a[88:91], a[24:27], a[232:235], a[88:91]
    v_mfma_f32_16x16x32_bf16 v[220:223], a[24:27], a[228:231], v[220:223]
    s_cmp_eq_u32 s45, 0
    s_cbranch_scc1 k12_ool_56
k12_oolret_57:
    v_mfma_f32_16x16x32_bf16 v[220:223], a[28:31], a[244:247], v[220:223]
    v_mfma_f32_16x16x32_bf16 v[216:219], a[28:31], a[240:243], v[216:219]
    v_mfma_f32_16x16x32_bf16 v[216:219], a[24:27], a[224:227], v[216:219]
    s_waitcnt vmcnt(10) lgkmcnt(0)
    s_barrier
    v_mfma_f32_16x16x32_bf16 v[224:227], a[32:35], a[224:227], v[224:227]
    v_mfma_f32_16x16x32_bf16 v[224:227], a[36:39], a[240:243], v[224:227]
    s_add_u32 m0, s60, 114688
    ds_read_b64_tr_b16 a[0:1], v42 offset:0
    ds_read_b64_tr_b16 a[2:3], v42 offset:1024
    v_mfma_f32_16x16x32_bf16 v[228:231], a[36:39], a[244:247], v[228:231]
    buffer_load_dwordx4 v38, s[12:15], s61 offen offset:0 lds
    v_mfma_f32_16x16x32_bf16 v[228:231], a[32:35], a[228:231], v[228:231]
    ds_read_b64_tr_b16 a[4:5], v42 offset:8192
    v_mfma_f32_16x16x32_bf16 a[96:99], a[32:35], a[232:235], a[96:99]
    buffer_load_dwordx4 v39, s[12:15], s61 offen offset:1024 lds
    ds_read_b64_tr_b16 a[6:7], v42 offset:9216
    v_mfma_f32_16x16x32_bf16 a[96:99], a[36:39], a[248:251], a[96:99]
    ds_read_b64_tr_b16 a[8:9], v43 offset:0
    v_mfma_f32_16x16x32_bf16 a[100:103], a[36:39], a[252:255], a[100:103]
    v_mfma_f32_16x16x32_bf16 a[100:103], a[32:35], a[236:239], a[100:103]
    buffer_load_dwordx4 v40, s[12:15], s61 offen offset:2048 lds
    ds_read_b64_tr_b16 a[10:11], v43 offset:1024
    v_mfma_f32_16x16x32_bf16 a[108:111], a[40:43], a[236:239], a[108:111]
    ds_read_b64_tr_b16 a[12:13], v43 offset:8192
    v_mfma_f32_16x16x32_bf16 a[108:111], a[44:47], a[252:255], a[108:111]
    ds_read_b64_tr_b16 a[14:15], v43 offset:9216
    v_mfma_f32_16x16x32_bf16 a[104:107], a[44:47], a[248:251], a[104:107]
    ds_read_b64_tr_b16 a[16:17], v44 offset:0
    v_mfma_f32_16x16x32_bf16 a[104:107], a[40:43], a[232:235], a[104:107]
    buffer_load_dwordx4 v41, s[12:15], s61 offen offset:3072 lds
    v_mfma_f32_16x16x32_bf16 v[236:239], a[40:43], a[228:231], v[236:239]
    ds_read_b64_tr_b16 a[18:19], v44 offset:1024
    v_mfma_f32_16x16x32_bf16 v[236:239], a[44:47], a[244:247], v[236:239]
    s_add_u32 s61, s61, 0x80000
    ds_read_b64_tr_b16 a[20:21], v44 offset:8192
    v_mfma_f32_16x16x32_bf16 v[232:235], a[44:47], a[240:243], v[232:235]
    buffer_load_dwordx4 a[176:179], v36, s[8:11], s62 offen sc1
    ds_read_b64_tr_b16 a[22:23], v44 offset:9216
    v_mfma_f32_16x16x32_bf16 v[232:235], a[40:43], a[224:227], v[232:235]
    v_mfma_f32_16x16x32_bf16 v[240:243], a[48:51], a[224:227], v[240:243]
    ds_read_b64_tr_b16 a[24:25], v45 offset:0
    v_mfma_f32_16x16x32_bf16 v[240:243], a[52:55], a[240:243], v[240:243]
    buffer_load_dwordx4 a[180:183], v54, s[8:11], s62 offen sc1
    ds_read_b64_tr_b16 a[26:27], v45 offset:1024
    v_mfma_f32_16x16x32_bf16 v[244:247], a[52:55], a[244:247], v[244:247]
    ds_read_b64_tr_b16 a[28:29], v45 offset:8192
    v_mfma_f32_16x16x32_bf16 v[244:247], a[48:51], a[228:231], v[244:247]
    v_mfma_f32_16x16x32_bf16 a[112:115], a[48:51], a[232:235], a[112:115]
    buffer_load_dwordx4 a[184:187], v37, s[8:11], s62 offen sc1
    ds_read_b64_tr_b16 a[30:31], v45 offset:9216
    v_mfma_f32_16x16x32_bf16 a[112:115], a[52:55], a[248:251], a[112:115]
    v_mfma_f32_16x16x32_bf16 a[116:119], a[52:55], a[252:255], a[116:119]
    v_mfma_f32_16x16x32_bf16 a[116:119], a[48:51], a[236:239], a[116:119]
    v_mfma_f32_16x16x32_bf16 a[124:127], a[56:59], a[236:239], a[124:127]
    buffer_load_dwordx4 a[188:191], v55, s[8:11], s62 offen sc1
    v_mfma_f32_16x16x32_bf16 a[124:127], a[60:63], a[252:255], a[124:127]
    v_mfma_f32_16x16x32_bf16 a[120:123], a[60:63], a[248:251], a[120:123]
    s_add_u32 s62, s62, 0x20000
    v_mfma_f32_16x16x32_bf16 a[120:123], a[56:59], a[232:235], a[120:123]
    v_mfma_f32_16x16x32_bf16 v[252:255], a[56:59], a[228:231], v[252:255]
    v_mfma_f32_16x16x32_bf16 v[252:255], a[60:63], a[244:247], v[252:255]
    v_mfma_f32_16x16x32_bf16 v[248:251], a[60:63], a[240:243], v[248:251]
    v_mfma_f32_16x16x32_bf16 v[248:251], a[56:59], a[224:227], v[248:251]
    s_waitcnt vmcnt(14) lgkmcnt(0)
    v_mfma_f32_16x16x32_bf16 v[192:195], a[0:3], a[128:131], v[192:195]
    v_mfma_f32_16x16x32_bf16 v[192:195], a[4:7], a[144:147], v[192:195]
    buffer_load_dwordx4 a[192:195], v36, s[8:11], s62 offen sc1
    ds_read_b64_tr_b16 a[32:33], v46 offset:0
    v_mfma_f32_16x16x32_bf16 v[196:199], a[4:7], a[148:151], v[196:199]
    ds_read_b64_tr_b16 a[34:35], v46 offset:1024
    v_mfma_f32_16x16x32_bf16 v[196:199], a[0:3], a[132:135], v[196:199]
    ds_read_b64_tr_b16 a[36:37], v46 offset:8192
    v_mfma_f32_16x16x32_bf16 a[64:67], a[0:3], a[136:139], a[64:67]
    ds_read_b64_tr_b16 a[38:39], v46 offset:9216
    v_mfma_f32_16x16x32_bf16 a[64:67], a[4:7], a[152:155], a[64:67]
    ds_read_b64_tr_b16 a[40:41], v47 offset:0
    v_mfma_f32_16x16x32_bf16 a[68:71], a[4:7], a[156:159], a[68:71]
    buffer_load_dwordx4 a[196:199], v54, s[8:11], s62 offen sc1
    v_mfma_f32_16x16x32_bf16 a[68:71], a[0:3], a[140:143], a[68:71]
    ds_read_b64_tr_b16 a[42:43], v47 offset:1024
    v_mfma_f32_16x16x32_bf16 a[76:79], a[8:11], a[140:143], a[76:79]
    ds_read_b64_tr_b16 a[44:45], v47 offset:8192
    v_mfma_f32_16x16x32_bf16 a[76:79], a[12:15], a[156:159], a[76:79]
    ds_read_b64_tr_b16 a[46:47], v47 offset:9216
    v_mfma_f32_16x16x32_bf16 a[72:75], a[12:15], a[152:155], a[72:75]
    ds_read_b64_tr_b16 a[48:49], v48 offset:0
    v_mfma_f32_16x16x32_bf16 a[72:75], a[8:11], a[136:139], a[72:75]
    buffer_load_dwordx4 a[200:203], v37, s[8:11], s62 offen sc1
    v_mfma_f32_16x16x32_bf16 v[204:207], a[8:11], a[132:135], v[204:207]
    ds_read_b64_tr_b16 a[50:51], v48 offset:1024
    v_mfma_f32_16x16x32_bf16 v[204:207], a[12:15], a[148:151], v[204:207]
    ds_read_b64_tr_b16 a[52:53], v48 offset:8192
    v_mfma_f32_16x16x32_bf16 v[200:203], a[12:15], a[144:147], v[200:203]
    ds_read_b64_tr_b16 a[54:55], v48 offset:9216
    v_mfma_f32_16x16x32_bf16 v[200:203], a[8:11], a[128:131], v[200:203]
    v_mfma_f32_16x16x32_bf16 v[208:211], a[16:19], a[128:131], v[208:211]
    ds_read_b64_tr_b16 a[56:57], v49 offset:0
    v_mfma_f32_16x16x32_bf16 v[208:211], a[20:23], a[144:147], v[208:211]
    buffer_load_dwordx4 a[204:207], v55, s[8:11], s62 offen sc1
    ds_read_b64_tr_b16 a[58:59], v49 offset:1024
    v_mfma_f32_16x16x32_bf16 v[212:215], a[20:23], a[148:151], v[212:215]
    ds_read_b64_tr_b16 a[60:61], v49 offset:8192
    v_mfma_f32_16x16x32_bf16 v[212:215], a[16:19], a[132:135], v[212:215]
    v_mfma_f32_16x16x32_bf16 a[80:83], a[16:19], a[136:139], a[80:83]
    ds_read_b64_tr_b16 a[62:63], v49 offset:9216
    v_mfma_f32_16x16x32_bf16 a[80:83], a[20:23], a[152:155], a[80:83]
    s_add_u32 s62, s62, 0x20000
    v_mfma_f32_16x16x32_bf16 a[84:87], a[20:23], a[156:159], a[84:87]
    s_add_u32 s52, s47, 12288
    v_mfma_f32_16x16x32_bf16 a[84:87], a[16:19], a[140:143], a[84:87]
    buffer_store_dwordx4 v[116:119], v1, s[48:51], s52 offen offset:1024 sc1
    v_mfma_f32_16x16x32_bf16 a[92:95], a[24:27], a[140:143], a[92:95]
    v_mfma_f32_16x16x32_bf16 a[92:95], a[28:31], a[156:159], a[92:95]
    v_mfma_f32_16x16x32_bf16 a[88:91], a[28:31], a[152:155], a[88:91]
    v_mfma_f32_16x16x32_bf16 a[88:91], a[24:27], a[136:139], a[88:91]
    v_mfma_f32_16x16x32_bf16 v[220:223], a[24:27], a[132:135], v[220:223]
    s_cmp_eq_u32 s45, 0
    s_cbranch_scc1 k12_ool_58
k12_oolret_59:
    v_mfma_f32_16x16x32_bf16 v[220:223], a[28:31], a[148:151], v[220:223]
    v_mfma_f32_16x16x32_bf16 v[216:219], a[28:31], a[144:147], v[216:219]
    v_mfma_f32_16x16x32_bf16 v[216:219], a[24:27], a[128:131], v[216:219]
    s_waitcnt vmcnt(9) lgkmcnt(0)
    s_barrier
    v_mfma_f32_16x16x32_bf16 v[224:227], a[32:35], a[128:131], v[224:227]
    v_mfma_f32_16x16x32_bf16 v[224:227], a[36:39], a[144:147], v[224:227]
    s_add_u32 m0, s60, 131072
    ds_read_b64_tr_b16 a[0:1], v42 offset:16384
    ds_read_b64_tr_b16 a[2:3], v42 offset:17408
    v_mfma_f32_16x16x32_bf16 v[228:231], a[36:39], a[148:151], v[228:231]
    buffer_load_dwordx4 v38, s[12:15], s61 offen offset:0 lds
    v_mfma_f32_16x16x32_bf16 v[228:231], a[32:35], a[132:135], v[228:231]
    ds_read_b64_tr_b16 a[4:5], v42 offset:24576
    v_mfma_f32_16x16x32_bf16 a[96:99], a[32:35], a[136:139], a[96:99]
    buffer_load_dwordx4 v39, s[12:15], s61 offen offset:1024 lds
    ds_read_b64_tr_b16 a[6:7], v42 offset:25600
    v_mfma_f32_16x16x32_bf16 a[96:99], a[36:39], a[152:155], a[96:99]
    ds_read_b64_tr_b16 a[8:9], v43 offset:16384
    v_mfma_f32_16x16x32_bf16 a[100:103], a[36:39], a[156:159], a[100:103]
    v_mfma_f32_16x16x32_bf16 a[100:103], a[32:35], a[140:143], a[100:103]
    buffer_load_dwordx4 v40, s[12:15], s61 offen offset:2048 lds
    ds_read_b64_tr_b16 a[10:11], v43 offset:17408
    v_mfma_f32_16x16x32_bf16 a[108:111], a[40:43], a[140:143], a[108:111]
    ds_read_b64_tr_b16 a[12:13], v43 offset:24576
    v_mfma_f32_16x16x32_bf16 a[108:111], a[44:47], a[156:159], a[108:111]
    ds_read_b64_tr_b16 a[14:15], v43 offset:25600
    v_mfma_f32_16x16x32_bf16 a[104:107], a[44:47], a[152:155], a[104:107]
    buffer_load_dwordx4 v41, s[12:15], s61 offen offset:3072 lds
    ds_read_b64_tr_b16 a[16:17], v44 offset:16384
    v_mfma_f32_16x16x32_bf16 a[104:107], a[40:43], a[136:139], a[104:107]
    v_mfma_f32_16x16x32_bf16 v[236:239], a[40:43], a[132:135], v[236:239]
    s_add_u32 s61, s61, 0x80000
    ds_read_b64_tr_b16 a[18:19], v44 offset:17408
    v_mfma_f32_16x16x32_bf16 v[236:239], a[44:47], a[148:151], v[236:239]
    buffer_load_dwordx4 a[208:211], v36, s[8:11], s62 offen sc1
    ds_read_b64_tr_b16 a[20:21], v44 offset:24576
    v_mfma_f32_16x16x32_bf16 v[232:235], a[44:47], a[144:147], v[232:235]
    ds_read_b64_tr_b16 a[22:23], v44 offset:25600
    v_mfma_f32_16x16x32_bf16 v[232:235], a[40:43], a[128:131], v[232:235]
    buffer_load_dwordx4 a[212:215], v54, s[8:11], s62 offen sc1
    v_mfma_f32_16x16x32_bf16 v[240:243], a[48:51], a[128:131], v[240:243]
    ds_read_b64_tr_b16 a[24:25], v45 offset:16384
    v_mfma_f32_16x16x32_bf16 v[240:243], a[52:55], a[144:147], v[240:243]
    ds_read_b64_tr_b16 a[26:27], v45 offset:17408
    v_mfma_f32_16x16x32_bf16 v[244:247], a[52:55], a[148:151], v[244:247]
    buffer_load_dwordx4 a[216:219], v37, s[8:11], s62 offen sc1
    ds_read_b64_tr_b16 a[28:29], v45 offset:24576
    v_mfma_f32_16x16x32_bf16 v[244:247], a[48:51], a[132:135], v[244:247]
    v_mfma_f32_16x16x32_bf16 a[112:115], a[48:51], a[136:139], a[112:115]
    ds_read_b64_tr_b16 a[30:31], v45 offset:25600
    v_mfma_f32_16x16x32_bf16 a[112:115], a[52:55], a[152:155], a[112:115]
    buffer_load_dwordx4 a[220:223], v55, s[8:11], s62 offen sc1
    v_mfma_f32_16x16x32_bf16 a[116:119], a[52:55], a[156:159], a[116:119]
    v_mfma_f32_16x16x32_bf16 a[116:119], a[48:51], a[140:143], a[116:119]
    s_add_u32 s62, s62, 0x20000
    v_mfma_f32_16x16x32_bf16 a[124:127], a[56:59], a[140:143], a[124:127]
    s_add_u32 s52, s47, 12288
    v_mfma_f32_16x16x32_bf16 a[124:127], a[60:63], a[156:159], a[124:127]
    buffer_store_dwordx4 v[120:123], v1, s[48:51], s52 offen offset:2048 sc1
    v_mfma_f32_16x16x32_bf16 a[120:123], a[60:63], a[152:155], a[120:123]
    v_mfma_f32_16x16x32_bf16 a[120:123], a[56:59], a[136:139], a[120:123]
    v_mfma_f32_16x16x32_bf16 v[252:255], a[56:59], a[132:135], v[252:255]
    v_mfma_f32_16x16x32_bf16 v[252:255], a[60:63], a[148:151], v[252:255]
    v_mfma_f32_16x16x32_bf16 v[248:251], a[60:63], a[144:147], v[248:251]
    v_mfma_f32_16x16x32_bf16 v[248:251], a[56:59], a[128:131], v[248:251]
    s_waitcnt vmcnt(14) lgkmcnt(0)
    v_mfma_f32_16x16x32_bf16 v[192:195], a[0:3], a[160:163], v[192:195]
    v_mfma_f32_16x16x32_bf16 v[192:195], a[4:7], a[176:179], v[192:195]
    buffer_load_dwordx4 a[224:227], v36, s[8:11], s62 offen sc1
    ds_read_b64_tr_b16 a[32:33], v46 offset:16384
    v_mfma_f32_16x16x32_bf16 v[196:199], a[4:7], a[180:183], v[196:199]
    ds_read_b64_tr_b16 a[34:35], v46 offset:17408
    v_mfma_f32_16x16x32_bf16 v[196:199], a[0:3], a[164:167], v[196:199]
    ds_read_b64_tr_b16 a[36:37], v46 offset:24576
    v_mfma_f32_16x16x32_bf16 a[64:67], a[0:3], a[168:171], a[64:67]
    ds_read_b64_tr_b16 a[38:39], v46 offset:25600
    v_mfma_f32_16x16x32_bf16 a[64:67], a[4:7], a[184:187], a[64:67]
    ds_read_b64_tr_b16 a[40:41], v47 offset:16384
    v_mfma_f32_16x16x32_bf16 a[68:71], a[4:7], a[188:191], a[68:71]
    buffer_load_dwordx4 a[228:231], v54, s[8:11], s62 offen sc1
    v_mfma_f32_16x16x32_bf16 a[68:71], a[0:3], a[172:175], a[68:71]
    ds_read_b64_tr_b16 a[42:43], v47 offset:17408
    v_mfma_f32_16x16x32_bf16 a[76:79], a[8:11], a[172:175], a[76:79]
    ds_read_b64_tr_b16 a[44:45], v47 offset:24576
    v_mfma_f32_16x16x32_bf16 a[76:79], a[12:15], a[188:191], a[76:79]
    ds_read_b64_tr_b16 a[46:47], v47 offset:25600
    v_mfma_f32_16x16x32_bf16 a[72:75], a[12:15], a[184:187], a[72:75]
    ds_read_b64_tr_b16 a[48:49], v48 offset:16384
    v_mfma_f32_16x16x32_bf16 a[72:75], a[8:11], a[168:171], a[72:75]
    buffer_load_dwordx4 a[232:235], v37, s[8:11], s62 offen sc1
    v_mfma_f32_16x16x32_bf16 v[204:207], a[8:11], a[164:167], v[204:207]
    ds_read_b64_tr_b16 a[50:51], v48 offset:17408
    v_mfma_f32_16x16x32_bf16 v[204:207], a[12:15], a[180:183], v[204:207]
    ds_read_b64_tr_b16 a[52:53], v48 offset:24576
    v_mfma_f32_16x16x32_bf16 v[200:203], a[12:15], a[176:179], v[200:203]
    ds_read_b64_tr_b16 a[54:55], v48 offset:25600
    v_mfma_f32_16x16x32_bf16 v[200:203], a[8:11], a[160:163], v[200:203]
    v_mfma_f32_16x16x32_bf16 v[208:211], a[16:19], a[160:163], v[208:211]
    ds_read_b64_tr_b16 a[56:57], v49 offset:16384
    v_mfma_f32_16x16x32_bf16 v[208:211], a[20:23], a[176:179], v[208:211]
    buffer_load_dwordx4 a[236:239], v55, s[8:11], s62 offen sc1
    ds_read_b64_tr_b16 a[58:59], v49 offset:17408
    v_mfma_f32_16x16x32_bf16 v[212:215], a[20:23], a[180:183], v[212:215]
    ds_read_b64_tr_b16 a[60:61], v49 offset:24576
    v_mfma_f32_16x16x32_bf16 v[212:215], a[16:19], a[164:167], v[212:215]
    v_mfma_f32_16x16x32_bf16 a[80:83], a[16:19], a[168:171], a[80:83]
    ds_read_b64_tr_b16 a[62:63], v49 offset:25600
    v_mfma_f32_16x16x32_bf16 a[80:83], a[20:23], a[184:187], a[80:83]
    s_add_u32 s62, s62, 0x20000
    v_mfma_f32_16x16x32_bf16 a[84:87], a[20:23], a[188:191], a[84:87]
    s_add_u32 s52, s47, 12288
    v_mfma_f32_16x16x32_bf16 a[84:87], a[16:19], a[172:175], a[84:87]
    buffer_store_dwordx4 v[124:127], v1, s[48:51], s52 offen offset:3072 sc1
    v_mfma_f32_16x16x32_bf16 a[92:95], a[24:27], a[172:175], a[92:95]
    v_mfma_f32_16x16x32_bf16 a[92:95], a[28:31], a[188:191], a[92:95]
    v_mfma_f32_16x16x32_bf16 a[88:91], a[28:31], a[184:187], a[88:91]
    v_mfma_f32_16x16x32_bf16 a[88:91], a[24:27], a[168:171], a[88:91]
    v_mfma_f32_16x16x32_bf16 v[220:223], a[24:27], a[164:167], v[220:223]
    v_mfma_f32_16x16x32_bf16 v[220:223], a[28:31], a[180:183], v[220:223]
    v_mfma_f32_16x16x32_bf16 v[216:219], a[28:31], a[176:179], v[216:219]
    v_mfma_f32_16x16x32_bf16 v[216:219], a[24:27], a[160:163], v[216:219]
    s_waitcnt vmcnt(10) lgkmcnt(0)
    s_barrier
    v_mfma_f32_16x16x32_bf16 v[224:227], a[32:35], a[160:163], v[224:227]
    v_mfma_f32_16x16x32_bf16 v[224:227], a[36:39], a[176:179], v[224:227]
    s_add_u32 m0, s60, 147456
    ds_read_b64_tr_b16 a[0:1], v42 offset:32768
    ds_read_b64_tr_b16 a[2:3], v42 offset:33792
    v_mfma_f32_16x16x32_bf16 v[228:231], a[36:39], a[180:183], v[228:231]
    buffer_load_dwordx4 v38, s[12:15], s61 offen offset:0 lds
    v_mfma_f32_16x16x32_bf16 v[228:231], a[32:35], a[164:167], v[228:231]
    ds_read_b64_tr_b16 a[4:5], v42 offset:40960
    v_mfma_f32_16x16x32_bf16 a[96:99], a[32:35], a[168:171], a[96:99]
    buffer_load_dwordx4 v39, s[12:15], s61 offen offset:1024 lds
    ds_read_b64_tr_b16 a[6:7], v42 offset:41984
    v_mfma_f32_16x16x32_bf16 a[96:99], a[36:39], a[184:187], a[96:99]
    ds_read_b64_tr_b16 a[8:9], v43 offset:32768
    v_mfma_f32_16x16x32_bf16 a[100:103], a[36:39], a[188:191], a[100:103]
    v_mfma_f32_16x16x32_bf16 a[100:103], a[32:35], a[172:175], a[100:103]
    buffer_load_dwordx4 v40, s[12:15], s61 offen offset:2048 lds
    ds_read_b64_tr_b16 a[10:11], v43 offset:33792
    v_mfma_f32_16x16x32_bf16 a[108:111], a[40:43], a[172:175], a[108:111]
    ds_read_b64_tr_b16 a[12:13], v43 offset:40960
    v_mfma_f32_16x16x32_bf16 a[108:111], a[44:47], a[188:191], a[108:111]
    ds_read_b64_tr_b16 a[14:15], v43 offset:41984
    v_mfma_f32_16x16x32_bf16 a[104:107], a[44:47], a[184:187], a[104:107]
    buffer_load_dwordx4 v41, s[12:15], s61 offen offset:3072 lds
    ds_read_b64_tr_b16 a[16:17], v44 offset:32768
    v_mfma_f32_16x16x32_bf16 a[104:107], a[40:43], a[168:171], a[104:107]
    v_mfma_f32_16x16x32_bf16 v[236:239], a[40:43], a[164:167], v[236:239]
    s_add_u32 s61, s61, 0x80000
    ds_read_b64_tr_b16 a[18:19], v44 offset:33792
    v_mfma_f32_16x16x32_bf16 v[236:239], a[44:47], a[180:183], v[236:239]
    buffer_load_dwordx4 a[240:243], v36, s[8:11], s62 offen sc1
    ds_read_b64_tr_b16 a[20:21], v44 offset:40960
    v_mfma_f32_16x16x32_bf16 v[232:235], a[44:47], a[176:179], v[232:235]
    ds_read_b64_tr_b16 a[22:23], v44 offset:41984
    v_mfma_f32_16x16x32_bf16 v[232:235], a[40:43], a[160:163], v[232:235]
    buffer_load_dwordx4 a[244:247], v54, s[8:11], s62 offen sc1
    v_mfma_f32_16x16x32_bf16 v[240:243], a[48:51], a[160:163], v[240:243]
    ds_read_b64_tr_b16 a[24:25], v45 offset:32768
    v_mfma_f32_16x16x32_bf16 v[240:243], a[52:55], a[176:179], v[240:243]
    ds_read_b64_tr_b16 a[26:27], v45 offset:33792
    v_mfma_f32_16x16x32_bf16 v[244:247], a[52:55], a[180:183], v[244:247]
    buffer_load_dwordx4 a[248:251], v37, s[8:11], s62 offen sc1
    ds_read_b64_tr_b16 a[28:29], v45 offset:40960
    v_mfma_f32_16x16x32_bf16 v[244:247], a[48:51], a[164:167], v[244:247]
    v_mfma_f32_16x16x32_bf16 a[112:115], a[48:51], a[168:171], a[112:115]
    ds_read_b64_tr_b16 a[30:31], v45 offset:41984
    v_mfma_f32_16x16x32_bf16 a[112:115], a[52:55], a[184:187], a[112:115]
    buffer_load_dwordx4 a[252:255], v55, s[8:11], s62 offen sc1
    v_mfma_f32_16x16x32_bf16 a[116:119], a[52:55], a[188:191], a[116:119]
    v_mfma_f32_16x16x32_bf16 a[116:119], a[48:51], a[172:175], a[116:119]
    s_add_u32 s62, s62, 0x20000
    v_mfma_f32_16x16x32_bf16 a[124:127], a[56:59], a[172:175], a[124:127]
    s_add_u32 s52, s47, 524288
    v_mfma_f32_16x16x32_bf16 a[124:127], a[60:63], a[188:191], a[124:127]
    buffer_store_dwordx4 v[136:139], v1, s[48:51], s52 offen offset:2048 sc1
    v_mfma_f32_16x16x32_bf16 a[120:123], a[60:63], a[184:187], a[120:123]
    v_mfma_f32_16x16x32_bf16 a[120:123], a[56:59], a[168:171], a[120:123]
    v_mfma_f32_16x16x32_bf16 v[252:255], a[56:59], a[164:167], v[252:255]
    s_cmp_eq_u32 s45, 0
    s_cbranch_scc1 k12_ool_60
k12_oolret_61:
    v_mfma_f32_16x16x32_bf16 v[252:255], a[60:63], a[180:183], v[252:255]
    v_mfma_f32_16x16x32_bf16 v[248:251], a[60:63], a[176:179], v[248:251]
    v_mfma_f32_16x16x32_bf16 v[248:251], a[56:59], a[160:163], v[248:251]
    s_waitcnt vmcnt(15) lgkmcnt(0)
    v_mfma_f32_16x16x32_bf16 v[192:195], a[0:3], a[192:195], v[192:195]
    v_mfma_f32_16x16x32_bf16 v[192:195], a[4:7], a[208:211], v[192:195]
    buffer_load_dwordx4 a[128:131], v36, s[8:11], s62 offen sc1
    ds_read_b64_tr_b16 a[32:33], v46 offset:32768
    v_mfma_f32_16x16x32_bf16 v[196:199], a[4:7], a[212:215], v[196:199]
    ds_read_b64_tr_b16 a[34:35], v46 offset:33792
    v_mfma_f32_16x16x32_bf16 v[196:199], a[0:3], a[196:199], v[196:199]
    ds_read_b64_tr_b16 a[36:37], v46 offset:40960
    v_mfma_f32_16x16x32_bf16 a[64:67], a[0:3], a[200:203], a[64:67]
    ds_read_b64_tr_b16 a[38:39], v46 offset:41984
    v_mfma_f32_16x16x32_bf16 a[64:67], a[4:7], a[216:219], a[64:67]
    ds_read_b64_tr_b16 a[40:41], v47 offset:32768
    v_mfma_f32_16x16x32_bf16 a[68:71], a[4:7], a[220:223], a[68:71]
    buffer_load_dwordx4 a[132:135], v54, s[8:11], s62 offen sc1
    v_mfma_f32_16x16x32_bf16 a[68:71], a[0:3], a[204:207], a[68:71]
    ds_read_b64_tr_b16 a[42:43], v47 offset:33792
    v_mfma_f32_16x16x32_bf16 a[76:79], a[8:11], a[204:207], a[76:79]
    ds_read_b64_tr_b16 a[44:45], v47 offset:40960
    v_mfma_f32_16x16x32_bf16 a[76:79], a[12:15], a[220:223], a[76:79]
    ds_read_b64_tr_b16 a[46:47], v47 offset:41984
    v_mfma_f32_16x16x32_bf16 a[72:75], a[12:15], a[216:219], a[72:75]
    ds_read_b64_tr_b16 a[48:49], v48 offset:32768
    v_mfma_f32_16x16x32_bf16 a[72:75], a[8:11], a[200:203], a[72:75]
    buffer_load_dwordx4 a[136:139], v37, s[8:11], s62 offen sc1
    v_mfma_f32_16x16x32_bf16 v[204:207], a[8:11], a[196:199], v[204:207]
    ds_read_b64_tr_b16 a[50:51], v48 offset:33792
    v_mfma_f32_16x16x32_bf16 v[204:207], a[12:15], a[212:215], v[204:207]
    ds_read_b64_tr_b16 a[52:53], v48 offset:40960
    v_mfma_f32_16x16x32_bf16 v[200:203], a[12:15], a[208:211], v[200:203]
    ds_read_b64_tr_b16 a[54:55], v48 offset:41984
    v_mfma_f32_16x16x32_bf16 v[200:203], a[8:11], a[192:195], v[200:203]
    v_mfma_f32_16x16x32_bf16 v[208:211], a[16:19], a[192:195], v[208:211]
    ds_read_b64_tr_b16 a[56:57], v49 offset:32768
    v_mfma_f32_16x16x32_bf16 v[208:211], a[20:23], a[208:211], v[208:211]
    buffer_load_dwordx4 a[140:143], v55, s[8:11], s62 offen sc1
    ds_read_b64_tr_b16 a[58:59], v49 offset:33792
    v_mfma_f32_16x16x32_bf16 v[212:215], a[20:23], a[212:215], v[212:215]
    ds_read_b64_tr_b16 a[60:61], v49 offset:40960
    v_mfma_f32_16x16x32_bf16 v[212:215], a[16:19], a[196:199], v[212:215]
    v_mfma_f32_16x16x32_bf16 a[80:83], a[16:19], a[200:203], a[80:83]
    ds_read_b64_tr_b16 a[62:63], v49 offset:41984
    v_mfma_f32_16x16x32_bf16 a[80:83], a[20:23], a[216:219], a[80:83]
    s_add_u32 s62, s62, 0x20000
    v_mfma_f32_16x16x32_bf16 a[84:87], a[20:23], a[220:223], a[84:87]
    s_add_u32 s52, s47, 524288
    v_mfma_f32_16x16x32_bf16 a[84:87], a[16:19], a[204:207], a[84:87]
    buffer_store_dwordx4 v[140:143], v1, s[48:51], s52 offen offset:3072 sc1
    v_mfma_f32_16x16x32_bf16 a[92:95], a[24:27], a[204:207], a[92:95]
    v_mfma_f32_16x16x32_bf16 a[92:95], a[28:31], a[220:223], a[92:95]
    v_mfma_f32_16x16x32_bf16 a[88:91], a[28:31], a[216:219], a[88:91]
    v_mfma_f32_16x16x32_bf16 a[88:91], a[24:27], a[200:203], a[88:91]
    v_mfma_f32_16x16x32_bf16 v[220:223], a[24:27], a[196:199], v[220:223]
    v_mfma_f32_16x16x32_bf16 v[220:223], a[28:31], a[212:215], v[220:223]
    v_mfma_f32_16x16x32_bf16 v[216:219], a[28:31], a[208:211], v[216:219]
    v_mfma_f32_16x16x32_bf16 v[216:219], a[24:27], a[192:195], v[216:219]
    s_waitcnt vmcnt(10) lgkmcnt(0)
    s_barrier
    v_mfma_f32_16x16x32_bf16 v[224:227], a[32:35], a[192:195], v[224:227]
    v_mfma_f32_16x16x32_bf16 v[224:227], a[36:39], a[208:211], v[224:227]
    s_add_u32 m0, s60, 98304
    ds_read_b64_tr_b16 a[0:1], v42 offset:49152
    ds_read_b64_tr_b16 a[2:3], v42 offset:50176
    v_mfma_f32_16x16x32_bf16 v[228:231], a[36:39], a[212:215], v[228:231]
    buffer_load_dwordx4 v38, s[12:15], s61 offen offset:0 lds
    v_mfma_f32_16x16x32_bf16 v[228:231], a[32:35], a[196:199], v[228:231]
    ds_read_b64_tr_b16 a[4:5], v42 offset:57344
    v_mfma_f32_16x16x32_bf16 a[96:99], a[32:35], a[200:203], a[96:99]
    buffer_load_dwordx4 v39, s[12:15], s61 offen offset:1024 lds
    ds_read_b64_tr_b16 a[6:7], v42 offset:58368
    v_mfma_f32_16x16x32_bf16 a[96:99], a[36:39], a[216:219], a[96:99]
    ds_read_b64_tr_b16 a[8:9], v43 offset:49152
    v_mfma_f32_16x16x32_bf16 a[100:103], a[36:39], a[220:223], a[100:103]
    v_mfma_f32_16x16x32_bf16 a[100:103], a[32:35], a[204:207], a[100:103]
    buffer_load_dwordx4 v40, s[12:15], s61 offen offset:2048 lds
    ds_read_b64_tr_b16 a[10:11], v43 offset:50176
    v_mfma_f32_16x16x32_bf16 a[108:111], a[40:43], a[204:207], a[108:111]
    ds_read_b64_tr_b16 a[12:13], v43 offset:57344
    v_mfma_f32_16x16x32_bf16 a[108:111], a[44:47], a[220:223], a[108:111]
    ds_read_b64_tr_b16 a[14:15], v43 offset:58368
    v_mfma_f32_16x16x32_bf16 a[104:107], a[44:47], a[216:219], a[104:107]
    ds_read_b64_tr_b16 a[16:17], v44 offset:49152
    v_mfma_f32_16x16x32_bf16 a[104:107], a[40:43], a[200:203], a[104:107]
    buffer_load_dwordx4 v41, s[12:15], s61 offen offset:3072 lds
    v_mfma_f32_16x16x32_bf16 v[236:239], a[40:43], a[196:199], v[236:239]
    ds_read_b64_tr_b16 a[18:19], v44 offset:50176
    v_mfma_f32_16x16x32_bf16 v[236:239], a[44:47], a[212:215], v[236:239]
    s_add_u32 s61, s61, 0x80000
    ds_read_b64_tr_b16 a[20:21], v44 offset:57344
    v_mfma_f32_16x16x32_bf16 v[232:235], a[44:47], a[208:211], v[232:235]
    buffer_load_dwordx4 a[144:147], v36, s[8:11], s62 offen sc1
    ds_read_b64_tr_b16 a[22:23], v44 offset:58368
    v_mfma_f32_16x16x32_bf16 v[232:235], a[40:43], a[192:195], v[232:235]
    v_mfma_f32_16x16x32_bf16 v[240:243], a[48:51], a[192:195], v[240:243]
    ds_read_b64_tr_b16 a[24:25], v45 offset:49152
    v_mfma_f32_16x16x32_bf16 v[240:243], a[52:55], a[208:211], v[240:243]
    buffer_load_dwordx4 a[148:151], v54, s[8:11], s62 offen sc1
    ds_read_b64_tr_b16 a[26:27], v45 offset:50176
    v_mfma_f32_16x16x32_bf16 v[244:247], a[52:55], a[212:215], v[244:247]
    ds_read_b64_tr_b16 a[28:29], v45 offset:57344
    v_mfma_f32_16x16x32_bf16 v[244:247], a[48:51], a[196:199], v[244:247]
    v_mfma_f32_16x16x32_bf16 a[112:115], a[48:51], a[200:203], a[112:115]
    buffer_load_dwordx4 a[152:155], v37, s[8:11], s62 offen sc1
    ds_read_b64_tr_b16 a[30:31], v45 offset:58368
    v_mfma_f32_16x16x32_bf16 a[112:115], a[52:55], a[216:219], a[112:115]
    v_mfma_f32_16x16x32_bf16 a[116:119], a[52:55], a[220:223], a[116:119]
    v_mfma_f32_16x16x32_bf16 a[116:119], a[48:51], a[204:207], a[116:119]
    v_mfma_f32_16x16x32_bf16 a[124:127], a[56:59], a[204:207], a[124:127]
    buffer_load_dwordx4 a[156:159], v55, s[8:11], s62 offen sc1
    v_mfma_f32_16x16x32_bf16 a[124:127], a[60:63], a[220:223], a[124:127]
    v_mfma_f32_16x16x32_bf16 a[120:123], a[60:63], a[216:219], a[120:123]
    s_add_u32 s62, s62, 0x20000
    v_mfma_f32_16x16x32_bf16 a[120:123], a[56:59], a[200:203], a[120:123]
    v_mfma_f32_16x16x32_bf16 v[252:255], a[56:59], a[196:199], v[252:255]
    s_cmp_eq_u32 s45, 0
    s_cbranch_scc1 k12_ool_62
k12_oolret_63:
    v_mfma_f32_16x16x32_bf16 v[252:255], a[60:63], a[212:215], v[252:255]
    v_mfma_f32_16x16x32_bf16 v[248:251], a[60:63], a[208:211], v[248:251]
    v_mfma_f32_16x16x32_bf16 v[248:251], a[56:59], a[192:195], v[248:251]
    s_waitcnt vmcnt(14) lgkmcnt(0)
    v_mfma_f32_16x16x32_bf16 v[192:195], a[0:3], a[224:227], v[192:195]
    v_mfma_f32_16x16x32_bf16 v[192:195], a[4:7], a[240:243], v[192:195]
    buffer_load_dwordx4 a[160:163], v36, s[8:11], s62 offen sc1
    ds_read_b64_tr_b16 a[32:33], v46 offset:49152
    v_mfma_f32_16x16x32_bf16 v[196:199], a[4:7], a[244:247], v[196:199]
    ds_read_b64_tr_b16 a[34:35], v46 offset:50176
    v_mfma_f32_16x16x32_bf16 v[196:199], a[0:3], a[228:231], v[196:199]
    ds_read_b64_tr_b16 a[36:37], v46 offset:57344
    v_mfma_f32_16x16x32_bf16 a[64:67], a[0:3], a[232:235], a[64:67]
    ds_read_b64_tr_b16 a[38:39], v46 offset:58368
    v_mfma_f32_16x16x32_bf16 a[64:67], a[4:7], a[248:251], a[64:67]
    ds_read_b64_tr_b16 a[40:41], v47 offset:49152
    v_mfma_f32_16x16x32_bf16 a[68:71], a[4:7], a[252:255], a[68:71]
    buffer_load_dwordx4 a[164:167], v54, s[8:11], s62 offen sc1
    v_mfma_f32_16x16x32_bf16 a[68:71], a[0:3], a[236:239], a[68:71]
    ds_read_b64_tr_b16 a[42:43], v47 offset:50176
    v_mfma_f32_16x16x32_bf16 a[76:79], a[8:11], a[236:239], a[76:79]
    ds_read_b64_tr_b16 a[44:45], v47 offset:57344
    v_mfma_f32_16x16x32_bf16 a[76:79], a[12:15], a[252:255], a[76:79]
    ds_read_b64_tr_b16 a[46:47], v47 offset:58368
    v_mfma_f32_16x16x32_bf16 a[72:75], a[12:15], a[248:251], a[72:75]
    ds_read_b64_tr_b16 a[48:49], v48 offset:49152
    v_mfma_f32_16x16x32_bf16 a[72:75], a[8:11], a[232:235], a[72:75]
    buffer_load_dwordx4 a[168:171], v37, s[8:11], s62 offen sc1
    v_mfma_f32_16x16x32_bf16 v[204:207], a[8:11], a[228:231], v[204:207]
    ds_read_b64_tr_b16 a[50:51], v48 offset:50176
    v_mfma_f32_16x16x32_bf16 v[204:207], a[12:15], a[244:247], v[204:207]
    ds_read_b64_tr_b16 a[52:53], v48 offset:57344
    v_mfma_f32_16x16x32_bf16 v[200:203], a[12:15], a[240:243], v[200:203]
    ds_read_b64_tr_b16 a[54:55], v48 offset:58368
    v_mfma_f32_16x16x32_bf16 v[200:203], a[8:11], a[224:227], v[200:203]
    v_mfma_f32_16x16x32_bf16 v[208:211], a[16:19], a[224:227], v[208:211]
    ds_read_b64_tr_b16 a[56:57], v49 offset:49152
    v_mfma_f32_16x16x32_bf16 v[208:211], a[20:23], a[240:243], v[208:211]
    buffer_load_dwordx4 a[172:175], v55, s[8:11], s62 offen sc1
    ds_read_b64_tr_b16 a[58:59], v49 offset:50176
    v_mfma_f32_16x16x32_bf16 v[212:215], a[20:23], a[244:247], v[212:215]
    ds_read_b64_tr_b16 a[60:61], v49 offset:57344
    v_mfma_f32_16x16x32_bf16 v[212:215], a[16:19], a[228:231], v[212:215]
    v_mfma_f32_16x16x32_bf16 a[80:83], a[16:19], a[232:235], a[80:83]
    ds_read_b64_tr_b16 a[62:63], v49 offset:58368
    v_mfma_f32_16x16x32_bf16 a[80:83], a[20:23], a[248:251], a[80:83]
    s_add_u32 s62, s62, 0x20000
    v_mfma_f32_16x16x32_bf16 a[84:87], a[20:23], a[252:255], a[84:87]
    s_add_u32 s52, s47, 528384
    v_mfma_f32_16x16x32_bf16 a[84:87], a[16:19], a[236:239], a[84:87]
    buffer_store_dwordx4 v[144:147], v1, s[48:51], s52 offen offset:0 sc1
    v_mfma_f32_16x16x32_bf16 a[92:95], a[24:27], a[236:239], a[92:95]
    v_mfma_f32_16x16x32_bf16 a[92:95], a[28:31], a[252:255], a[92:95]
    v_mfma_f32_16x16x32_bf16 a[88:91], a[28:31], a[248:251], a[88:91]
    v_mfma_f32_16x16x32_bf16 a[88:91], a[24:27], a[232:235], a[88:91]
    v_mfma_f32_16x16x32_bf16 v[220:223], a[24:27], a[228:231], v[220:223]
    v_mfma_f32_16x16x32_bf16 v[220:223], a[28:31], a[244:247], v[220:223]
    v_mfma_f32_16x16x32_bf16 v[216:219], a[28:31], a[240:243], v[216:219]
    v_mfma_f32_16x16x32_bf16 v[216:219], a[24:27], a[224:227], v[216:219]
    s_waitcnt vmcnt(9) lgkmcnt(0)
    s_barrier
    v_mfma_f32_16x16x32_bf16 v[224:227], a[32:35], a[224:227], v[224:227]
    v_mfma_f32_16x16x32_bf16 v[224:227], a[36:39], a[240:243], v[224:227]
    s_add_u32 m0, s60, 114688
    ds_read_b64_tr_b16 a[0:1], v42 offset:0
    ds_read_b64_tr_b16 a[2:3], v42 offset:1024
    v_mfma_f32_16x16x32_bf16 v[228:231], a[36:39], a[244:247], v[228:231]
    buffer_load_dwordx4 v38, s[12:15], s61 offen offset:0 lds
    v_mfma_f32_16x16x32_bf16 v[228:231], a[32:35], a[228:231], v[228:231]
    ds_read_b64_tr_b16 a[4:5], v42 offset:8192
    v_mfma_f32_16x16x32_bf16 a[96:99], a[32:35], a[232:235], a[96:99]
    buffer_load_dwordx4 v39, s[12:15], s61 offen offset:1024 lds
    ds_read_b64_tr_b16 a[6:7], v42 offset:9216
    v_mfma_f32_16x16x32_bf16 a[96:99], a[36:39], a[248:251], a[96:99]
    ds_read_b64_tr_b16 a[8:9], v43 offset:0
    v_mfma_f32_16x16x32_bf16 a[100:103], a[36:39], a[252:255], a[100:103]
    v_mfma_f32_16x16x32_bf16 a[100:103], a[32:35], a[236:239], a[100:103]
    buffer_load_dwordx4 v40, s[12:15], s61 offen offset:2048 lds
    ds_read_b64_tr_b16 a[10:11], v43 offset:1024
    v_mfma_f32_16x16x32_bf16 a[108:111], a[40:43], a[236:239], a[108:111]
    ds_read_b64_tr_b16 a[12:13], v43 offset:8192
    v_mfma_f32_16x16x32_bf16 a[108:111], a[44:47], a[252:255], a[108:111]
    ds_read_b64_tr_b16 a[14:15], v43 offset:9216
    v_mfma_f32_16x16x32_bf16 a[104:107], a[44:47], a[248:251], a[104:107]
    buffer_load_dwordx4 v41, s[12:15], s61 offen offset:3072 lds
    ds_read_b64_tr_b16 a[16:17], v44 offset:0
    v_mfma_f32_16x16x32_bf16 a[104:107], a[40:43], a[232:235], a[104:107]
    v_mfma_f32_16x16x32_bf16 v[236:239], a[40:43], a[228:231], v[236:239]
    s_add_u32 s61, s61, 0x80000
    ds_read_b64_tr_b16 a[18:19], v44 offset:1024
    v_mfma_f32_16x16x32_bf16 v[236:239], a[44:47], a[244:247], v[236:239]
    buffer_load_dwordx4 a[176:179], v36, s[8:11], s62 offen sc1
    ds_read_b64_tr_b16 a[20:21], v44 offset:8192
    v_mfma_f32_16x16x32_bf16 v[232:235], a[44:47], a[240:243], v[232:235]
    ds_read_b64_tr_b16 a[22:23], v44 offset:9216
    v_mfma_f32_16x16x32_bf16 v[232:235], a[40:43], a[224:227], v[232:235]
    buffer_load_dwordx4 a[180:183], v54, s[8:11], s62 offen sc1
    v_mfma_f32_16x16x32_bf16 v[240:243], a[48:51], a[224:227], v[240:243]
    ds_read_b64_tr_b16 a[24:25], v45 offset:0
    v_mfma_f32_16x16x32_bf16 v[240:243], a[52:55], a[240:243], v[240:243]
    ds_read_b64_tr_b16 a[26:27], v45 offset:1024
    v_mfma_f32_16x16x32_bf16 v[244:247], a[52:55], a[244:247], v[244:247]
    buffer_load_dwordx4 a[184:187], v37, s[8:11], s62 offen sc1
    ds_read_b64_tr_b16 a[28:29], v45 offset:8192
    v_mfma_f32_16x16x32_bf16 v[244:247], a[48:51], a[228:231], v[244:247]
    v_mfma_f32_16x16x32_bf16 a[112:115], a[48:51], a[232:235], a[112:115]
    ds_read_b64_tr_b16 a[30:31], v45 offset:9216
    v_mfma_f32_16x16x32_bf16 a[112:115], a[52:55], a[248:251], a[112:115]
    buffer_load_dwordx4 a[188:191], v55, s[8:11], s62 offen sc1
    v_mfma_f32_16x16x32_bf16 a[116:119], a[52:55], a[252:255], a[116:119]
    v_mfma_f32_16x16x32_bf16 a[116:119], a[48:51], a[236:239], a[116:119]
    s_add_u32 s62, s62, 0x20000
    v_mfma_f32_16x16x32_bf16 a[124:127], a[56:59], a[236:239], a[124:127]
    s_add_u32 s52, s47, 528384
    v_mfma_f32_16x16x32_bf16 a[124:127], a[60:63], a[252:255], a[124:127]
    buffer_store_dwordx4 v[148:151], v1, s[48:51], s52 offen offset:1024 sc1
    v_mfma_f32_16x16x32_bf16 a[120:123], a[60:63], a[248:251], a[120:123]
    v_mfma_f32_16x16x32_bf16 a[120:123], a[56:59], a[232:235], a[120:123]
    v_mfma_f32_16x16x32_bf16 v[252:255], a[56:59], a[228:231], v[252:255]
    s_cmp_eq_u32 s45, 0
    s_cbranch_scc1 k12_ool_64
k12_oolret_65:
    v_mfma_f32_16x16x32_bf16 v[252:255], a[60:63], a[244:247], v[252:255]
    v_mfma_f32_16x16x32_bf16 v[248:251], a[60:63], a[240:243], v[248:251]
    v_mfma_f32_16x16x32_bf16 v[248:251], a[56:59], a[224:227], v[248:251]
    s_waitcnt vmcnt(14) lgkmcnt(0)
    v_mfma_f32_16x16x32_bf16 v[192:195], a[0:3], a[128:131], v[192:195]
    v_mfma_f32_16x16x32_bf16 v[192:195], a[4:7], a[144:147], v[192:195]
    buffer_load_dwordx4 a[192:195], v36, s[8:11], s62 offen sc1
    ds_read_b64_tr_b16 a[32:33], v46 offset:0
    v_mfma_f32_16x16x32_bf16 v[196:199], a[4:7], a[148:151], v[196:199]
    ds_read_b64_tr_b16 a[34:35], v46 offset:1024
    v_mfma_f32_16x16x32_bf16 v[196:199], a[0:3], a[132:135], v[196:199]
    ds_read_b64_tr_b16 a[36:37], v46 offset:8192
    v_mfma_f32_16x16x32_bf16 a[64:67], a[0:3], a[136:139], a[64:67]
    ds_read_b64_tr_b16 a[38:39], v46 offset:9216
    v_mfma_f32_16x16x32_bf16 a[64:67], a[4:7], a[152:155], a[64:67]
    ds_read_b64_tr_b16 a[40:41], v47 offset:0
    v_mfma_f32_16x16x32_bf16 a[68:71], a[4:7], a[156:159], a[68:71]
    buffer_load_dwordx4 a[196:199], v54, s[8:11], s62 offen sc1
    v_mfma_f32_16x16x32_bf16 a[68:71], a[0:3], a[140:143], a[68:71]
    ds_read_b64_tr_b16 a[42:43], v47 offset:1024
    v_mfma_f32_16x16x32_bf16 a[76:79], a[8:11], a[140:143], a[76:79]
    ds_read_b64_tr_b16 a[44:45], v47 offset:8192
    v_mfma_f32_16x16x32_bf16 a[76:79], a[12:15], a[156:159], a[76:79]
    ds_read_b64_tr_b16 a[46:47], v47 offset:9216
    v_mfma_f32_16x16x32_bf16 a[72:75], a[12:15], a[152:155], a[72:75]
    ds_read_b64_tr_b16 a[48:49], v48 offset:0
    v_mfma_f32_16x16x32_bf16 a[72:75], a[8:11], a[136:139], a[72:75]
    buffer_load_dwordx4 a[200:203], v37, s[8:11], s62 offen sc1
    v_mfma_f32_16x16x32_bf16 v[204:207], a[8:11], a[132:135], v[204:207]
    ds_read_b64_tr_b16 a[50:51], v48 offset:1024
    v_mfma_f32_16x16x32_bf16 v[204:207], a[12:15], a[148:151], v[204:207]
    ds_read_b64_tr_b16 a[52:53], v48 offset:8192
    v_mfma_f32_16x16x32_bf16 v[200:203], a[12:15], a[144:147], v[200:203]
    ds_read_b64_tr_b16 a[54:55], v48 offset:9216
    v_mfma_f32_16x16x32_bf16 v[200:203], a[8:11], a[128:131], v[200:203]
    v_mfma_f32_16x16x32_bf16 v[208:211], a[16:19], a[128:131], v[208:211]
    ds_read_b64_tr_b16 a[56:57], v49 offset:0
    v_mfma_f32_16x16x32_bf16 v[208:211], a[20:23], a[144:147], v[208:211]
    buffer_load_dwordx4 a[204:207], v55, s[8:11], s62 offen sc1
    ds_read_b64_tr_b16 a[58:59], v49 offset:1024
    v_mfma_f32_16x16x32_bf16 v[212:215], a[20:23], a[148:151], v[212:215]
    ds_read_b64_tr_b16 a[60:61], v49 offset:8192
    v_mfma_f32_16x16x32_bf16 v[212:215], a[16:19], a[132:135], v[212:215]
    v_mfma_f32_16x16x32_bf16 a[80:83], a[16:19], a[136:139], a[80:83]
    ds_read_b64_tr_b16 a[62:63], v49 offset:9216
    v_mfma_f32_16x16x32_bf16 a[80:83], a[20:23], a[152:155], a[80:83]
    s_add_u32 s62, s62, 0x20000
    v_mfma_f32_16x16x32_bf16 a[84:87], a[20:23], a[156:159], a[84:87]
    s_add_u32 s52, s47, 528384
    v_mfma_f32_16x16x32_bf16 a[84:87], a[16:19], a[140:143], a[84:87]
    buffer_store_dwordx4 v[152:155], v1, s[48:51], s52 offen offset:2048 sc1
    v_mfma_f32_16x16x32_bf16 a[92:95], a[24:27], a[140:143], a[92:95]
    v_mfma_f32_16x16x32_bf16 a[92:95], a[28:31], a[156:159], a[92:95]
    v_mfma_f32_16x16x32_bf16 a[88:91], a[28:31], a[152:155], a[88:91]
    v_mfma_f32_16x16x32_bf16 a[88:91], a[24:27], a[136:139], a[88:91]
    v_mfma_f32_16x16x32_bf16 v[220:223], a[24:27], a[132:135], v[220:223]
    v_mfma_f32_16x16x32_bf16 v[220:223], a[28:31], a[148:151], v[220:223]
    v_mfma_f32_16x16x32_bf16 v[216:219], a[28:31], a[144:147], v[216:219]
    v_mfma_f32_16x16x32_bf16 v[216:219], a[24:27], a[128:131], v[216:219]
    s_waitcnt vmcnt(10) lgkmcnt(0)
    s_barrier
    v_mfma_f32_16x16x32_bf16 v[224:227], a[32:35], a[128:131], v[224:227]
    v_mfma_f32_16x16x32_bf16 v[224:227], a[36:39], a[144:147], v[224:227]
    s_add_u32 m0, s60, 131072
    ds_read_b64_tr_b16 a[0:1], v42 offset:16384
    ds_read_b64_tr_b16 a[2:3], v42 offset:17408
    v_mfma_f32_16x16x32_bf16 v[228:231], a[36:39], a[148:151], v[228:231]
    buffer_load_dwordx4 v38, s[12:15], s61 offen offset:0 lds
    v_mfma_f32_16x16x32_bf16 v[228:231], a[32:35], a[132:135], v[228:231]
    ds_read_b64_tr_b16 a[4:5], v42 offset:24576
    v_mfma_f32_16x16x32_bf16 a[96:99], a[32:35], a[136:139], a[96:99]
    buffer_load_dwordx4 v39, s[12:15], s61 offen offset:1024 lds
    ds_read_b64_tr_b16 a[6:7], v42 offset:25600
    v_mfma_f32_16x16x32_bf16 a[96:99], a[36:39], a[152:155], a[96:99]
    ds_read_b64_tr_b16 a[8:9], v43 offset:16384
    v_mfma_f32_16x16x32_bf16 a[100:103], a[36:39], a[156:159], a[100:103]
    v_mfma_f32_16x16x32_bf16 a[100:103], a[32:35], a[140:143], a[100:103]
    buffer_load_dwordx4 v40, s[12:15], s61 offen offset:2048 lds
    ds_read_b64_tr_b16 a[10:11], v43 offset:17408
    v_mfma_f32_16x16x32_bf16 a[108:111], a[40:43], a[140:143], a[108:111]
    ds_read_b64_tr_b16 a[12:13], v43 offset:24576
    v_mfma_f32_16x16x32_bf16 a[108:111], a[44:47], a[156:159], a[108:111]
    ds_read_b64_tr_b16 a[14:15], v43 offset:25600
    v_mfma_f32_16x16x32_bf16 a[104:107], a[44:47], a[152:155], a[104:107]
    buffer_load_dwordx4 v41, s[12:15], s61 offen offset:3072 lds
    ds_read_b64_tr_b16 a[16:17], v44 offset:16384
    v_mfma_f32_16x16x32_bf16 a[104:107], a[40:43], a[136:139], a[104:107]
    v_mfma_f32_16x16x32_bf16 v[236:239], a[40:43], a[132:135], v[236:239]
    s_add_u32 s61, s61, 0x80000
    ds_read_b64_tr_b16 a[18:19], v44 offset:17408
    v_mfma_f32_16x16x32_bf16 v[236:239], a[44:47], a[148:151], v[236:239]
    buffer_load_dwordx4 a[208:211], v36, s[8:11], s62 offen sc1
    ds_read_b64_tr_b16 a[20:21], v44 offset:24576
    v_mfma_f32_16x16x32_bf16 v[232:235], a[44:47], a[144:147], v[232:235]
    ds_read_b64_tr_b16 a[22:23], v44 offset:25600
    v_mfma_f32_16x16x32_bf16 v[232:235], a[40:43], a[128:131], v[232:235]
    buffer_load_dwordx4 a[212:215], v54, s[8:11], s62 offen sc1
    v_mfma_f32_16x16x32_bf16 v[240:243], a[48:51], a[128:131], v[240:243]
    ds_read_b64_tr_b16 a[24:25], v45 offset:16384
    v_mfma_f32_16x16x32_bf16 v[240:243], a[52:55], a[144:147], v[240:243]
    ds_read_b64_tr_b16 a[26:27], v45 offset:17408
    v_mfma_f32_16x16x32_bf16 v[244:247], a[52:55], a[148:151], v[244:247]
    buffer_load_dwordx4 a[216:219], v37, s[8:11], s62 offen sc1
    ds_read_b64_tr_b16 a[28:29], v45 offset:24576
    v_mfma_f32_16x16x32_bf16 v[244:247], a[48:51], a[132:135], v[244:247]
    v_mfma_f32_16x16x32_bf16 a[112:115], a[48:51], a[136:139], a[112:115]
    ds_read_b64_tr_b16 a[30:31], v45 offset:25600
    v_mfma_f32_16x16x32_bf16 a[112:115], a[52:55], a[152:155], a[112:115]
    buffer_load_dwordx4 a[220:223], v55, s[8:11], s62 offen sc1
    v_mfma_f32_16x16x32_bf16 a[116:119], a[52:55], a[156:159], a[116:119]
    v_mfma_f32_16x16x32_bf16 a[116:119], a[48:51], a[140:143], a[116:119]
    s_add_u32 s62, s62, 0x20000
    v_mfma_f32_16x16x32_bf16 a[124:127], a[56:59], a[140:143], a[124:127]
    s_add_u32 s52, s47, 528384
    v_mfma_f32_16x16x32_bf16 a[124:127], a[60:63], a[156:159], a[124:127]
    buffer_store_dwordx4 v[156:159], v1, s[48:51], s52 offen offset:3072 sc1
    v_mfma_f32_16x16x32_bf16 a[120:123], a[60:63], a[152:155], a[120:123]
    v_mfma_f32_16x16x32_bf16 a[120:123], a[56:59], a[136:139], a[120:123]
    v_mfma_f32_16x16x32_bf16 v[252:255], a[56:59], a[132:135], v[252:255]
    v_mfma_f32_16x16x32_bf16 v[252:255], a[60:63], a[148:151], v[252:255]
    v_mfma_f32_16x16x32_bf16 v[248:251], a[60:63], a[144:147], v[248:251]
    v_mfma_f32_16x16x32_bf16 v[248:251], a[56:59], a[128:131], v[248:251]
    s_waitcnt vmcnt(15) lgkmcnt(0)
    v_mfma_f32_16x16x32_bf16 v[192:195], a[0:3], a[160:163], v[192:195]
    v_mfma_f32_16x16x32_bf16 v[192:195], a[4:7], a[176:179], v[192:195]
    buffer_load_dwordx4 a[224:227], v36, s[8:11], s62 offen sc1
    ds_read_b64_tr_b16 a[32:33], v46 offset:16384
    v_mfma_f32_16x16x32_bf16 v[196:199], a[4:7], a[180:183], v[196:199]
    ds_read_b64_tr_b16 a[34:35], v46 offset:17408
    v_mfma_f32_16x16x32_bf16 v[196:199], a[0:3], a[164:167], v[196:199]
    ds_read_b64_tr_b16 a[36:37], v46 offset:24576
    v_mfma_f32_16x16x32_bf16 a[64:67], a[0:3], a[168:171], a[64:67]
    ds_read_b64_tr_b16 a[38:39], v46 offset:25600
    v_mfma_f32_16x16x32_bf16 a[64:67], a[4:7], a[184:187], a[64:67]
    ds_read_b64_tr_b16 a[40:41], v47 offset:16384
    v_mfma_f32_16x16x32_bf16 a[68:71], a[4:7], a[188:191], a[68:71]
    buffer_load_dwordx4 a[228:231], v54, s[8:11], s62 offen sc1
    v_mfma_f32_16x16x32_bf16 a[68:71], a[0:3], a[172:175], a[68:71]
    ds_read_b64_tr_b16 a[42:43], v47 offset:17408
    v_mfma_f32_16x16x32_bf16 a[76:79], a[8:11], a[172:175], a[76:79]
    ds_read_b64_tr_b16 a[44:45], v47 offset:24576
    v_mfma_f32_16x16x32_bf16 a[76:79], a[12:15], a[188:191], a[76:79]
    ds_read_b64_tr_b16 a[46:47], v47 offset:25600
    v_mfma_f32_16x16x32_bf16 a[72:75], a[12:15], a[184:187], a[72:75]
    ds_read_b64_tr_b16 a[48:49], v48 offset:16384
    v_mfma_f32_16x16x32_bf16 a[72:75], a[8:11], a[168:171], a[72:75]
    buffer_load_dwordx4 a[232:235], v37, s[8:11], s62 offen sc1
    v_mfma_f32_16x16x32_bf16 v[204:207], a[8:11], a[164:167], v[204:207]
    ds_read_b64_tr_b16 a[50:51], v48 offset:17408
    v_mfma_f32_16x16x32_bf16 v[204:207], a[12:15], a[180:183], v[204:207]
    ds_read_b64_tr_b16 a[52:53], v48 offset:24576
    v_mfma_f32_16x16x32_bf16 v[200:203], a[12:15], a[176:179], v[200:203]
    ds_read_b64_tr_b16 a[54:55], v48 offset:25600
    v_mfma_f32_16x16x32_bf16 v[200:203], a[8:11], a[160:163], v[200:203]
    v_mfma_f32_16x16x32_bf16 v[208:211], a[16:19], a[160:163], v[208:211]
    ds_read_b64_tr_b16 a[56:57], v49 offset:16384
    v_mfma_f32_16x16x32_bf16 v[208:211], a[20:23], a[176:179], v[208:211]
    buffer_load_dwordx4 a[236:239], v55, s[8:11], s62 offen sc1
    ds_read_b64_tr_b16 a[58:59], v49 offset:17408
    v_mfma_f32_16x16x32_bf16 v[212:215], a[20:23], a[180:183], v[212:215]
    ds_read_b64_tr_b16 a[60:61], v49 offset:24576
    v_mfma_f32_16x16x32_bf16 v[212:215], a[16:19], a[164:167], v[212:215]
    v_mfma_f32_16x16x32_bf16 a[80:83], a[16:19], a[168:171], a[80:83]
    ds_read_b64_tr_b16 a[62:63], v49 offset:25600
    v_mfma_f32_16x16x32_bf16 a[80:83], a[20:23], a[184:187], a[80:83]
    s_add_u32 s62, s62, 0x20000
    v_mfma_f32_16x16x32_bf16 a[84:87], a[20:23], a[188:191], a[84:87]
    s_add_u32 s52, s47, 532480
    v_mfma_f32_16x16x32_bf16 a[84:87], a[16:19], a[172:175], a[84:87]
    buffer_store_dwordx4 v[168:171], v1, s[48:51], s52 offen offset:2048 sc1
    v_mfma_f32_16x16x32_bf16 a[92:95], a[24:27], a[172:175], a[92:95]
    v_mfma_f32_16x16x32_bf16 a[92:95], a[28:31], a[188:191], a[92:95]
    v_mfma_f32_16x16x32_bf16 a[88:91], a[28:31], a[184:187], a[88:91]
    v_mfma_f32_16x16x32_bf16 a[88:91], a[24:27], a[168:171], a[88:91]
    v_mfma_f32_16x16x32_bf16 v[220:223], a[24:27], a[164:167], v[220:223]
    v_mfma_f32_16x16x32_bf16 v[220:223], a[28:31], a[180:183], v[220:223]
    v_mfma_f32_16x16x32_bf16 v[216:219], a[28:31], a[176:179], v[216:219]
    v_mfma_f32_16x16x32_bf16 v[216:219], a[24:27], a[160:163], v[216:219]
    s_waitcnt vmcnt(10) lgkmcnt(0)
    s_barrier
    v_mfma_f32_16x16x32_bf16 v[224:227], a[32:35], a[160:163], v[224:227]
    s_cmp_eq_u32 s56, 0
    s_cbranch_scc1 k12_ool_66
k12_oolret_67:
    v_mfma_f32_16x16x32_bf16 v[224:227], a[36:39], a[176:179], v[224:227]
    s_add_u32 m0, s60, 147456
    ds_read_b64_tr_b16 a[0:1], v42 offset:32768
    ds_read_b64_tr_b16 a[2:3], v42 offset:33792
    v_mfma_f32_16x16x32_bf16 v[228:231], a[36:39], a[180:183], v[228:231]
    buffer_load_dwordx4 v38, s[12:15], s61 offen offset:0 lds
    v_mfma_f32_16x16x32_bf16 v[228:231], a[32:35], a[164:167], v[228:231]
    ds_read_b64_tr_b16 a[4:5], v42 offset:40960
    v_mfma_f32_16x16x32_bf16 a[96:99], a[32:35], a[168:171], a[96:99]
    buffer_load_dwordx4 v39, s[12:15], s61 offen offset:1024 lds
    ds_read_b64_tr_b16 a[6:7], v42 offset:41984
    v_mfma_f32_16x16x32_bf16 a[96:99], a[36:39], a[184:187], a[96:99]
    ds_read_b64_tr_b16 a[8:9], v43 offset:32768
    v_mfma_f32_16x16x32_bf16 a[100:103], a[36:39], a[188:191], a[100:103]
    v_mfma_f32_16x16x32_bf16 a[100:103], a[32:35], a[172:175], a[100:103]
    buffer_load_dwordx4 v40, s[12:15], s61 offen offset:2048 lds
    ds_read_b64_tr_b16 a[10:11], v43 offset:33792
    v_mfma_f32_16x16x32_bf16 a[108:111], a[40:43], a[172:175], a[108:111]
    s_mov_b32 s32, s60
    ds_read_b64_tr_b16 a[12:13], v43 offset:40960
    v_mfma_f32_16x16x32_bf16 a[108:111], a[44:47], a[188:191], a[108:111]
    ds_read_b64_tr_b16 a[14:15], v43 offset:41984
    v_mfma_f32_16x16x32_bf16 a[104:107], a[44:47], a[184:187], a[104:107]
    s_mov_b32 s34, s60
    ds_read_b64_tr_b16 a[16:17], v44 offset:32768
    v_mfma_f32_16x16x32_bf16 a[104:107], a[40:43], a[168:171], a[104:107]
    buffer_load_dwordx4 v41, s[12:15], s61 offen offset:3072 lds
    v_mfma_f32_16x16x32_bf16 v[236:239], a[40:43], a[164:167], v[236:239]
    ds_read_b64_tr_b16 a[18:19], v44 offset:33792
    v_mfma_f32_16x16x32_bf16 v[236:239], a[44:47], a[180:183], v[236:239]
    s_mov_b32 s33, s60
    ds_read_b64_tr_b16 a[20:21], v44 offset:40960
    v_mfma_f32_16x16x32_bf16 v[232:235], a[44:47], a[176:179], v[232:235]
    s_add_u32 s61, s61, 0x80000
    buffer_load_dwordx4 a[240:243], v36, s[8:11], s62 offen sc1
    ds_read_b64_tr_b16 a[22:23], v44 offset:41984
    v_mfma_f32_16x16x32_bf16 v[232:235], a[40:43], a[160:163], v[232:235]
    v_mfma_f32_16x16x32_bf16 v[240:243], a[48:51], a[160:163], v[240:243]
    s_add_u32 s35, s60, 0x10000
    ds_read_b64_tr_b16 a[24:25], v45 offset:32768
    v_mfma_f32_16x16x32_bf16 v[240:243], a[52:55], a[176:179], v[240:243]
    buffer_load_dwordx4 a[244:247], v54, s[8:11], s62 offen sc1
    ds_read_b64_tr_b16 a[26:27], v45 offset:33792
    v_mfma_f32_16x16x32_bf16 v[244:247], a[52:55], a[180:183], v[244:247]
    ds_read_b64_tr_b16 a[28:29], v45 offset:40960
    v_mfma_f32_16x16x32_bf16 v[244:247], a[48:51], a[164:167], v[244:247]
    v_mfma_f32_16x16x32_bf16 a[112:115], a[48:51], a[168:171], a[112:115]
    buffer_load_dwordx4 a[248:251], v37, s[8:11], s62 offen sc1
    ds_read_b64_tr_b16 a[30:31], v45 offset:41984
    v_mfma_f32_16x16x32_bf16 a[112:115], a[52:55], a[184:187], a[112:115]
    v_mfma_f32_16x16x32_bf16 a[116:119], a[52:55], a[188:191], a[116:119]
    v_mfma_f32_16x16x32_bf16 a[116:119], a[48:51], a[172:175], a[116:119]
    v_mfma_f32_16x16x32_bf16 a[124:127], a[56:59], a[172:175], a[124:127]
    buffer_load_dwordx4 a[252:255], v55, s[8:11], s62 offen sc1
    v_mfma_f32_16x16x32_bf16 a[124:127], a[60:63], a[188:191], a[124:127]
    v_mfma_f32_16x16x32_bf16 a[120:123], a[60:63], a[184:187], a[120:123]
    s_add_u32 s62, s62, 0x20000
    v_mfma_f32_16x16x32_bf16 a[120:123], a[56:59], a[168:171], a[120:123]
    v_mfma_f32_16x16x32_bf16 v[252:255], a[56:59], a[164:167], v[252:255]
    v_mfma_f32_16x16x32_bf16 v[252:255], a[60:63], a[180:183], v[252:255]
    v_mfma_f32_16x16x32_bf16 v[248:251], a[60:63], a[176:179], v[248:251]
    v_mfma_f32_16x16x32_bf16 v[248:251], a[56:59], a[160:163], v[248:251]
    s_waitcnt vmcnt(14) lgkmcnt(0)
    v_mfma_f32_16x16x32_bf16 v[192:195], a[0:3], a[192:195], v[192:195]
    v_mfma_f32_16x16x32_bf16 v[192:195], a[4:7], a[208:211], v[192:195]
    buffer_load_dwordx4 a[128:131], v36, s[8:11], s62 offen sc1
    ds_read_b64_tr_b16 a[32:33], v46 offset:32768
    v_mfma_f32_16x16x32_bf16 v[196:199], a[4:7], a[212:215], v[196:199]
    ds_read_b64_tr_b16 a[34:35], v46 offset:33792
    v_mfma_f32_16x16x32_bf16 v[196:199], a[0:3], a[196:199], v[196:199]
    ds_read_b64_tr_b16 a[36:37], v46 offset:40960
    v_mfma_f32_16x16x32_bf16 a[64:67], a[0:3], a[200:203], a[64:67]
    ds_read_b64_tr_b16 a[38:39], v46 offset:41984
    v_mfma_f32_16x16x32_bf16 a[64:67], a[4:7], a[216:219], a[64:67]
    ds_read_b64_tr_b16 a[40:41], v47 offset:32768
    v_mfma_f32_16x16x32_bf16 a[68:71], a[4:7], a[220:223], a[68:71]
    buffer_load_dwordx4 a[132:135], v54, s[8:11], s62 offen sc1
    v_mfma_f32_16x16x32_bf16 a[68:71], a[0:3], a[204:207], a[68:71]
    ds_read_b64_tr_b16 a[42:43], v47 offset:33792
    v_mfma_f32_16x16x32_bf16 a[76:79], a[8:11], a[204:207], a[76:79]
    ds_read_b64_tr_b16 a[44:45], v47 offset:40960
    v_mfma_f32_16x16x32_bf16 a[76:79], a[12:15], a[220:223], a[76:79]
    ds_read_b64_tr_b16 a[46:47], v47 offset:41984
    v_mfma_f32_16x16x32_bf16 a[72:75], a[12:15], a[216:219], a[72:75]
    ds_read_b64_tr_b16 a[48:49], v48 offset:32768
    v_mfma_f32_16x16x32_bf16 a[72:75], a[8:11], a[200:203], a[72:75]
    buffer_load_dwordx4 a[136:139], v37, s[8:11], s62 offen sc1
    v_mfma_f32_16x16x32_bf16 v[204:207], a[8:11], a[196:199], v[204:207]
    ds_read_b64_tr_b16 a[50:51], v48 offset:33792
    v_mfma_f32_16x16x32_bf16 v[204:207], a[12:15], a[212:215], v[204:207]
    ds_read_b64_tr_b16 a[52:53], v48 offset:40960
    v_mfma_f32_16x16x32_bf16 v[200:203], a[12:15], a[208:211], v[200:203]
    ds_read_b64_tr_b16 a[54:55], v48 offset:41984
    v_mfma_f32_16x16x32_bf16 v[200:203], a[8:11], a[192:195], v[200:203]
    v_mfma_f32_16x16x32_bf16 v[208:211], a[16:19], a[192:195], v[208:211]
    ds_read_b64_tr_b16 a[56:57], v49 offset:32768
    v_mfma_f32_16x16x32_bf16 v[208:211], a[20:23], a[208:211], v[208:211]
    buffer_load_dwordx4 a[140:143], v55, s[8:11], s62 offen sc1
    ds_read_b64_tr_b16 a[58:59], v49 offset:33792
    v_mfma_f32_16x16x32_bf16 v[212:215], a[20:23], a[212:215], v[212:215]
    ds_read_b64_tr_b16 a[60:61], v49 offset:40960
    v_mfma_f32_16x16x32_bf16 v[212:215], a[16:19], a[196:199], v[212:215]
    v_mfma_f32_16x16x32_bf16 a[80:83], a[16:19], a[200:203], a[80:83]
    ds_read_b64_tr_b16 a[62:63], v49 offset:41984
    v_mfma_f32_16x16x32_bf16 a[80:83], a[20:23], a[216:219], a[80:83]
    s_add_u32 s62, s62, 0x20000
    v_mfma_f32_16x16x32_bf16 a[84:87], a[20:23], a[220:223], a[84:87]
    s_add_u32 s52, s47, 532480
    v_mfma_f32_16x16x32_bf16 a[84:87], a[16:19], a[204:207], a[84:87]
    buffer_store_dwordx4 v[172:175], v1, s[48:51], s52 offen offset:3072 sc1
    v_mfma_f32_16x16x32_bf16 a[92:95], a[24:27], a[204:207], a[92:95]
    v_mfma_f32_16x16x32_bf16 a[92:95], a[28:31], a[220:223], a[92:95]
    v_mfma_f32_16x16x32_bf16 a[88:91], a[28:31], a[216:219], a[88:91]
    v_mfma_f32_16x16x32_bf16 a[88:91], a[24:27], a[200:203], a[88:91]
    v_mfma_f32_16x16x32_bf16 v[220:223], a[24:27], a[196:199], v[220:223]
    v_add_co_u32 v2, vcc, 0x4000, v2
    s_nop 1
    v_addc_co_u32 v3, vcc, 0, v3, vcc
    global_load_dword v51, v[2:3], off
    v_mfma_f32_16x16x32_bf16 v[220:223], a[28:31], a[212:215], v[220:223]
    v_mfma_f32_16x16x32_bf16 v[216:219], a[28:31], a[208:211], v[216:219]
    v_mfma_f32_16x16x32_bf16 v[216:219], a[24:27], a[192:195], v[216:219]
    s_waitcnt vmcnt(9) lgkmcnt(0)
    s_barrier
    v_mfma_f32_16x16x32_bf16 v[224:227], a[32:35], a[192:195], v[224:227]
    v_mfma_f32_16x16x32_bf16 v[224:227], a[36:39], a[208:211], v[224:227]
    s_add_u32 m0, s60, 98304
    ds_read_b64_tr_b16 a[0:1], v42 offset:49152
    ds_read_b64_tr_b16 a[2:3], v42 offset:50176
    v_mfma_f32_16x16x32_bf16 v[228:231], a[36:39], a[212:215], v[228:231]
    buffer_load_dwordx4 v38, s[12:15], s61 offen offset:0 lds
    v_mfma_f32_16x16x32_bf16 v[228:231], a[32:35], a[196:199], v[228:231]
    ds_read_b64_tr_b16 a[4:5], v42 offset:57344
    v_mfma_f32_16x16x32_bf16 a[96:99], a[32:35], a[200:203], a[96:99]
    buffer_load_dwordx4 v39, s[12:15], s61 offen offset:1024 lds
    ds_read_b64_tr_b16 a[6:7], v42 offset:58368
    v_mfma_f32_16x16x32_bf16 a[96:99], a[36:39], a[216:219], a[96:99]
    ds_read_b64_tr_b16 a[8:9], v43 offset:49152
    v_mfma_f32_16x16x32_bf16 a[100:103], a[36:39], a[220:223], a[100:103]
    v_mfma_f32_16x16x32_bf16 a[100:103], a[32:35], a[204:207], a[100:103]
    buffer_load_dwordx4 v40, s[12:15], s61 offen offset:2048 lds
    ds_read_b64_tr_b16 a[10:11], v43 offset:50176
    v_mfma_f32_16x16x32_bf16 a[108:111], a[40:43], a[204:207], a[108:111]
    ds_read_b64_tr_b16 a[12:13], v43 offset:57344
    v_mfma_f32_16x16x32_bf16 a[108:111], a[44:47], a[220:223], a[108:111]
    ds_read_b64_tr_b16 a[14:15], v43 offset:58368
    v_mfma_f32_16x16x32_bf16 a[104:107], a[44:47], a[216:219], a[104:107]
    buffer_load_dwordx4 v41, s[12:15], s61 offen offset:3072 lds
    ds_read_b64_tr_b16 a[16:17], v44 offset:49152
    v_mfma_f32_16x16x32_bf16 a[104:107], a[40:43], a[200:203], a[104:107]
    v_mfma_f32_16x16x32_bf16 v[236:239], a[40:43], a[196:199], v[236:239]
    s_add_u32 s61, s61, 0x80000
    ds_read_b64_tr_b16 a[18:19], v44 offset:50176
    v_mfma_f32_16x16x32_bf16 v[236:239], a[44:47], a[212:215], v[236:239]
    buffer_load_dwordx4 a[144:147], v36, s[8:11], s62 offen sc1
    ds_read_b64_tr_b16 a[20:21], v44 offset:57344
    v_mfma_f32_16x16x32_bf16 v[232:235], a[44:47], a[208:211], v[232:235]
    ds_read_b64_tr_b16 a[22:23], v44 offset:58368
    v_mfma_f32_16x16x32_bf16 v[232:235], a[40:43], a[192:195], v[232:235]
    buffer_load_dwordx4 a[148:151], v54, s[8:11], s62 offen sc1
    v_mfma_f32_16x16x32_bf16 v[240:243], a[48:51], a[192:195], v[240:243]
    ds_read_b64_tr_b16 a[24:25], v45 offset:49152
    v_mfma_f32_16x16x32_bf16 v[240:243], a[52:55], a[208:211], v[240:243]
    ds_read_b64_tr_b16 a[26:27], v45 offset:50176
    v_mfma_f32_16x16x32_bf16 v[244:247], a[52:55], a[212:215], v[244:247]
    buffer_load_dwordx4 a[152:155], v37, s[8:11], s62 offen sc1
    ds_read_b64_tr_b16 a[28:29], v45 offset:57344
    v_mfma_f32_16x16x32_bf16 v[244:247], a[48:51], a[196:199], v[244:247]
    v_mfma_f32_16x16x32_bf16 a[112:115], a[48:51], a[200:203], a[112:115]
    ds_read_b64_tr_b16 a[30:31], v45 offset:58368
    v_mfma_f32_16x16x32_bf16 a[112:115], a[52:55], a[216:219], a[112:115]
    buffer_load_dwordx4 a[156:159], v55, s[8:11], s62 offen sc1
    v_mfma_f32_16x16x32_bf16 a[116:119], a[52:55], a[220:223], a[116:119]
    v_mfma_f32_16x16x32_bf16 a[116:119], a[48:51], a[204:207], a[116:119]
    s_add_u32 s62, s62, 0x20000
    v_mfma_f32_16x16x32_bf16 a[124:127], a[56:59], a[204:207], a[124:127]
    s_add_u32 s52, s47, 536576
    v_mfma_f32_16x16x32_bf16 a[124:127], a[60:63], a[220:223], a[124:127]
    buffer_store_dwordx4 v[176:179], v1, s[48:51], s52 offen offset:0 sc1
    v_mfma_f32_16x16x32_bf16 a[120:123], a[60:63], a[216:219], a[120:123]
    v_mfma_f32_16x16x32_bf16 a[120:123], a[56:59], a[200:203], a[120:123]
    v_mfma_f32_16x16x32_bf16 v[252:255], a[56:59], a[196:199], v[252:255]
    v_mfma_f32_16x16x32_bf16 v[252:255], a[60:63], a[212:215], v[252:255]
    v_mfma_f32_16x16x32_bf16 v[248:251], a[60:63], a[208:211], v[248:251]
    v_mfma_f32_16x16x32_bf16 v[248:251], a[56:59], a[192:195], v[248:251]
    s_waitcnt vmcnt(14) lgkmcnt(0)
    v_mfma_f32_16x16x32_bf16 v[192:195], a[0:3], a[224:227], v[192:195]
    v_mfma_f32_16x16x32_bf16 v[192:195], a[4:7], a[240:243], v[192:195]
    buffer_load_dwordx4 a[160:163], v36, s[8:11], s62 offen sc1
    ds_read_b64_tr_b16 a[32:33], v46 offset:49152
    v_mfma_f32_16x16x32_bf16 v[196:199], a[4:7], a[244:247], v[196:199]
    ds_read_b64_tr_b16 a[34:35], v46 offset:50176
    v_mfma_f32_16x16x32_bf16 v[196:199], a[0:3], a[228:231], v[196:199]
    ds_read_b64_tr_b16 a[36:37], v46 offset:57344
    v_mfma_f32_16x16x32_bf16 a[64:67], a[0:3], a[232:235], a[64:67]
    ds_read_b64_tr_b16 a[38:39], v46 offset:58368
    v_mfma_f32_16x16x32_bf16 a[64:67], a[4:7], a[248:251], a[64:67]
    ds_read_b64_tr_b16 a[40:41], v47 offset:49152
    v_mfma_f32_16x16x32_bf16 a[68:71], a[4:7], a[252:255], a[68:71]
    buffer_load_dwordx4 a[164:167], v54, s[8:11], s62 offen sc1
    v_mfma_f32_16x16x32_bf16 a[68:71], a[0:3], a[236:239], a[68:71]
    ds_read_b64_tr_b16 a[42:43], v47 offset:50176
    v_mfma_f32_16x16x32_bf16 a[76:79], a[8:11], a[236:239], a[76:79]
    ds_read_b64_tr_b16 a[44:45], v47 offset:57344
    v_mfma_f32_16x16x32_bf16 a[76:79], a[12:15], a[252:255], a[76:79]
    ds_read_b64_tr_b16 a[46:47], v47 offset:58368
    v_mfma_f32_16x16x32_bf16 a[72:75], a[12:15], a[248:251], a[72:75]
    ds_read_b64_tr_b16 a[48:49], v48 offset:49152
    v_mfma_f32_16x16x32_bf16 a[72:75], a[8:11], a[232:235], a[72:75]
    buffer_load_dwordx4 a[168:171], v37, s[8:11], s62 offen sc1
    v_mfma_f32_16x16x32_bf16 v[204:207], a[8:11], a[228:231], v[204:207]
    ds_read_b64_tr_b16 a[50:51], v48 offset:50176
    v_mfma_f32_16x16x32_bf16 v[204:207], a[12:15], a[244:247], v[204:207]
    ds_read_b64_tr_b16 a[52:53], v48 offset:57344
    v_mfma_f32_16x16x32_bf16 v[200:203], a[12:15], a[240:243], v[200:203]
    ds_read_b64_tr_b16 a[54:55], v48 offset:58368
    v_mfma_f32_16x16x32_bf16 v[200:203], a[8:11], a[224:227], v[200:203]
    v_mfma_f32_16x16x32_bf16 v[208:211], a[16:19], a[224:227], v[208:211]
    ds_read_b64_tr_b16 a[56:57], v49 offset:49152
    v_mfma_f32_16x16x32_bf16 v[208:211], a[20:23], a[240:243], v[208:211]
    buffer_load_dwordx4 a[172:175], v55, s[8:11], s62 offen sc1
    ds_read_b64_tr_b16 a[58:59], v49 offset:50176
    v_mfma_f32_16x16x32_bf16 v[212:215], a[20:23], a[244:247], v[212:215]
    ds_read_b64_tr_b16 a[60:61], v49 offset:57344
    v_mfma_f32_16x16x32_bf16 v[212:215], a[16:19], a[228:231], v[212:215]
    v_mfma_f32_16x16x32_bf16 a[80:83], a[16:19], a[232:235], a[80:83]
    ds_read_b64_tr_b16 a[62:63], v49 offset:58368
    v_mfma_f32_16x16x32_bf16 a[80:83], a[20:23], a[248:251], a[80:83]
    s_add_u32 s62, s62, 0x20000
    v_mfma_f32_16x16x32_bf16 a[84:87], a[20:23], a[252:255], a[84:87]
    s_add_u32 s52, s47, 536576
    v_mfma_f32_16x16x32_bf16 a[84:87], a[16:19], a[236:239], a[84:87]
    buffer_store_dwordx4 v[180:183], v1, s[48:51], s52 offen offset:1024 sc1
    v_mfma_f32_16x16x32_bf16 a[92:95], a[24:27], a[236:239], a[92:95]
    v_mfma_f32_16x16x32_bf16 a[92:95], a[28:31], a[252:255], a[92:95]
    v_mfma_f32_16x16x32_bf16 a[88:91], a[28:31], a[248:251], a[88:91]
    v_mfma_f32_16x16x32_bf16 a[88:91], a[24:27], a[232:235], a[88:91]
    v_mfma_f32_16x16x32_bf16 v[220:223], a[24:27], a[228:231], v[220:223]
    v_mfma_f32_16x16x32_bf16 v[220:223], a[28:31], a[244:247], v[220:223]
    v_mfma_f32_16x16x32_bf16 v[216:219], a[28:31], a[240:243], v[216:219]
    v_mfma_f32_16x16x32_bf16 v[216:219], a[24:27], a[224:227], v[216:219]
    s_waitcnt vmcnt(10) lgkmcnt(0)
    s_barrier
    v_mfma_f32_16x16x32_bf16 v[224:227], a[32:35], a[224:227], v[224:227]
    s_cmp_eq_u32 s30, 0
    s_cbranch_scc1 k12_ool_68
k12_oolret_69:
    v_mfma_f32_16x16x32_bf16 v[224:227], a[36:39], a[240:243], v[224:227]
    s_add_u32 m0, s60, 114688
    ds_read_b64_tr_b16 a[0:1], v42 offset:0
    ds_read_b64_tr_b16 a[2:3], v42 offset:1024
    v_mfma_f32_16x16x32_bf16 v[228:231], a[36:39], a[244:247], v[228:231]
    buffer_load_dwordx4 v38, s[12:15], s61 offen offset:0 lds
    v_mfma_f32_16x16x32_bf16 v[228:231], a[32:35], a[228:231], v[228:231]
    ds_read_b64_tr_b16 a[4:5], v42 offset:8192
    v_mfma_f32_16x16x32_bf16 a[96:99], a[32:35], a[232:235], a[96:99]
    buffer_load_dwordx4 v39, s[12:15], s61 offen offset:1024 lds
    ds_read_b64_tr_b16 a[6:7], v42 offset:9216
    v_mfma_f32_16x16x32_bf16 a[96:99], a[36:39], a[248:251], a[96:99]
    ds_read_b64_tr_b16 a[8:9], v43 offset:0
    v_mfma_f32_16x16x32_bf16 a[100:103], a[36:39], a[252:255], a[100:103]
    v_mfma_f32_16x16x32_bf16 a[100:103], a[32:35], a[236:239], a[100:103]
    buffer_load_dwordx4 v40, s[12:15], s61 offen offset:2048 lds
    ds_read_b64_tr_b16 a[10:11], v43 offset:1024
    v_mfma_f32_16x16x32_bf16 a[108:111], a[40:43], a[236:239], a[108:111]
    ds_read_b64_tr_b16 a[12:13], v43 offset:8192
    v_mfma_f32_16x16x32_bf16 a[108:111], a[44:47], a[252:255], a[108:111]
    ds_read_b64_tr_b16 a[14:15], v43 offset:9216
    v_mfma_f32_16x16x32_bf16 a[104:107], a[44:47], a[248:251], a[104:107]
    buffer_load_dwordx4 v41, s[12:15], s61 offen offset:3072 lds
    ds_read_b64_tr_b16 a[16:17], v44 offset:0
    v_mfma_f32_16x16x32_bf16 a[104:107], a[40:43], a[232:235], a[104:107]
    v_mfma_f32_16x16x32_bf16 v[236:239], a[40:43], a[228:231], v[236:239]
    s_add_u32 s61, s61, 0x80000
    ds_read_b64_tr_b16 a[18:19], v44 offset:1024
    v_mfma_f32_16x16x32_bf16 v[236:239], a[44:47], a[244:247], v[236:239]
    buffer_load_dwordx4 a[176:179], v36, s[8:11], s62 offen sc1
    ds_read_b64_tr_b16 a[20:21], v44 offset:8192
    v_mfma_f32_16x16x32_bf16 v[232:235], a[44:47], a[240:243], v[232:235]
    ds_read_b64_tr_b16 a[22:23], v44 offset:9216
    v_mfma_f32_16x16x32_bf16 v[232:235], a[40:43], a[224:227], v[232:235]
    buffer_load_dwordx4 a[180:183], v54, s[8:11], s62 offen sc1
    v_mfma_f32_16x16x32_bf16 v[240:243], a[48:51], a[224:227], v[240:243]
    ds_read_b64_tr_b16 a[24:25], v45 offset:0
    v_mfma_f32_16x16x32_bf16 v[240:243], a[52:55], a[240:243], v[240:243]
    ds_read_b64_tr_b16 a[26:27], v45 offset:1024
    v_mfma_f32_16x16x32_bf16 v[244:247], a[52:55], a[244:247], v[244:247]
    buffer_load_dwordx4 a[184:187], v37, s[8:11], s62 offen sc1
    ds_read_b64_tr_b16 a[28:29], v45 offset:8192
    v_mfma_f32_16x16x32_bf16 v[244:247], a[48:51], a[228:231], v[244:247]
    v_mfma_f32_16x16x32_bf16 a[112:115], a[48:51], a[232:235], a[112:115]
    ds_read_b64_tr_b16 a[30:31], v45 offset:9216
    v_mfma_f32_16x16x32_bf16 a[112:115], a[52:55], a[248:251], a[112:115]
    buffer_load_dwordx4 a[188:191], v55, s[8:11], s62 offen sc1
    v_mfma_f32_16x16x32_bf16 a[116:119], a[52:55], a[252:255], a[116:119]
    v_mfma_f32_16x16x32_bf16 a[116:119], a[48:51], a[236:239], a[116:119]
    s_add_u32 s62, s62, 0x20000
    v_mfma_f32_16x16x32_bf16 a[124:127], a[56:59], a[236:239], a[124:127]
    s_add_u32 s52, s47, 536576
    v_mfma_f32_16x16x32_bf16 a[124:127], a[60:63], a[252:255], a[124:127]
    buffer_store_dwordx4 v[184:187], v1, s[48:51], s52 offen offset:2048 sc1
    v_mfma_f32_16x16x32_bf16 a[120:123], a[60:63], a[248:251], a[120:123]
    v_mfma_f32_16x16x32_bf16 a[120:123], a[56:59], a[232:235], a[120:123]
    v_mfma_f32_16x16x32_bf16 v[252:255], a[56:59], a[228:231], v[252:255]
    v_mfma_f32_16x16x32_bf16 v[252:255], a[60:63], a[244:247], v[252:255]
    v_mfma_f32_16x16x32_bf16 v[248:251], a[60:63], a[240:243], v[248:251]
    v_mfma_f32_16x16x32_bf16 v[248:251], a[56:59], a[224:227], v[248:251]
    s_waitcnt vmcnt(15) lgkmcnt(0)
    v_mfma_f32_16x16x32_bf16 v[192:195], a[0:3], a[128:131], v[192:195]
    v_mfma_f32_16x16x32_bf16 v[192:195], a[4:7], a[144:147], v[192:195]
    s_add_u32 s52, s47, 536576
    ds_read_b64_tr_b16 a[32:33], v46 offset:0
    ds_read_b64_tr_b16 a[34:35], v46 offset:1024
    v_mfma_f32_16x16x32_bf16 v[196:199], a[4:7], a[148:151], v[196:199]
    buffer_store_dwordx4 v[188:191], v1, s[48:51], s52 offen offset:3072 sc1
    v_mfma_f32_16x16x32_bf16 v[196:199], a[0:3], a[132:135], v[196:199]
    ds_read_b64_tr_b16 a[36:37], v46 offset:8192
    v_mfma_f32_16x16x32_bf16 a[64:67], a[0:3], a[136:139], a[64:67]
    ds_read_b64_tr_b16 a[38:39], v46 offset:9216
    v_mfma_f32_16x16x32_bf16 a[64:67], a[4:7], a[152:155], a[64:67]
    ds_read_b64_tr_b16 a[40:41], v47 offset:0
    v_mfma_f32_16x16x32_bf16 a[68:71], a[4:7], a[156:159], a[68:71]
    v_mfma_f32_16x16x32_bf16 a[68:71], a[0:3], a[140:143], a[68:71]
    ds_read_b64_tr_b16 a[42:43], v47 offset:1024
    v_mfma_f32_16x16x32_bf16 a[76:79], a[8:11], a[140:143], a[76:79]
    ds_read_b64_tr_b16 a[44:45], v47 offset:8192
    v_mfma_f32_16x16x32_bf16 a[76:79], a[12:15], a[156:159], a[76:79]
    ds_read_b64_tr_b16 a[46:47], v47 offset:9216
    v_mfma_f32_16x16x32_bf16 a[72:75], a[12:15], a[152:155], a[72:75]
    ds_read_b64_tr_b16 a[48:49], v48 offset:0
    v_mfma_f32_16x16x32_bf16 a[72:75], a[8:11], a[136:139], a[72:75]
    v_mfma_f32_16x16x32_bf16 v[204:207], a[8:11], a[132:135], v[204:207]
    ds_read_b64_tr_b16 a[50:51], v48 offset:1024
    v_mfma_f32_16x16x32_bf16 v[204:207], a[12:15], a[148:151], v[204:207]
    ds_read_b64_tr_b16 a[52:53], v48 offset:8192
    v_mfma_f32_16x16x32_bf16 v[200:203], a[12:15], a[144:147], v[200:203]
    ds_read_b64_tr_b16 a[54:55], v48 offset:9216
    v_mfma_f32_16x16x32_bf16 v[200:203], a[8:11], a[128:131], v[200:203]
    v_mfma_f32_16x16x32_bf16 v[208:211], a[16:19], a[128:131], v[208:211]
    ds_read_b64_tr_b16 a[56:57], v49 offset:0
    v_mfma_f32_16x16x32_bf16 v[208:211], a[20:23], a[144:147], v[208:211]
    ds_read_b64_tr_b16 a[58:59], v49 offset:1024
    v_mfma_f32_16x16x32_bf16 v[212:215], a[20:23], a[148:151], v[212:215]
    ds_read_b64_tr_b16 a[60:61], v49 offset:8192
    v_mfma_f32_16x16x32_bf16 v[212:215], a[16:19], a[132:135], v[212:215]
    v_mfma_f32_16x16x32_bf16 a[80:83], a[16:19], a[136:139], a[80:83]
    ds_read_b64_tr_b16 a[62:63], v49 offset:9216
    v_mfma_f32_16x16x32_bf16 a[80:83], a[20:23], a[152:155], a[80:83]
    v_mfma_f32_16x16x32_bf16 a[84:87], a[20:23], a[156:159], a[84:87]
    v_mfma_f32_16x16x32_bf16 a[84:87], a[16:19], a[140:143], a[84:87]
    v_mfma_f32_16x16x32_bf16 a[92:95], a[24:27], a[140:143], a[92:95]
    v_mfma_f32_16x16x32_bf16 a[92:95], a[28:31], a[156:159], a[92:95]
    v_mfma_f32_16x16x32_bf16 a[88:91], a[28:31], a[152:155], a[88:91]
    v_mfma_f32_16x16x32_bf16 a[88:91], a[24:27], a[136:139], a[88:91]
    v_mfma_f32_16x16x32_bf16 v[220:223], a[24:27], a[132:135], v[220:223]
    s_cmp_eq_u32 s30, 0
    s_cbranch_scc1 k12_ool_72
k12_oolret_73:
    v_mfma_f32_16x16x32_bf16 v[220:223], a[28:31], a[148:151], v[220:223]
    v_mfma_f32_16x16x32_bf16 v[216:219], a[28:31], a[144:147], v[216:219]
    v_mfma_f32_16x16x32_bf16 v[216:219], a[24:27], a[128:131], v[216:219]
    s_waitcnt vmcnt(6) lgkmcnt(0)
    s_barrier
    v_mfma_f32_16x16x32_bf16 v[224:227], a[32:35], a[128:131], v[224:227]
    v_mfma_f32_16x16x32_bf16 v[224:227], a[36:39], a[144:147], v[224:227]
    s_mov_b32 m0, s34
    ds_read_b64_tr_b16 a[0:1], v42 offset:16384
    ds_read_b64_tr_b16 a[2:3], v42 offset:17408
    v_mfma_f32_16x16x32_bf16 v[228:231], a[36:39], a[148:151], v[228:231]
    buffer_load_dwordx4 v1, s[16:19], s32 offen offset:0 sc1 lds
    v_mfma_f32_16x16x32_bf16 v[228:231], a[32:35], a[132:135], v[228:231]
    ds_read_b64_tr_b16 a[4:5], v42 offset:24576
    v_mfma_f32_16x16x32_bf16 a[96:99], a[32:35], a[136:139], a[96:99]
    buffer_load_dwordx4 v1, s[16:19], s32 offen offset:1024 sc1 lds
    ds_read_b64_tr_b16 a[6:7], v42 offset:25600
    v_mfma_f32_16x16x32_bf16 a[96:99], a[36:39], a[152:155], a[96:99]
    ds_read_b64_tr_b16 a[8:9], v43 offset:16384
    v_mfma_f32_16x16x32_bf16 a[100:103], a[36:39], a[156:159], a[100:103]
    v_mfma_f32_16x16x32_bf16 a[100:103], a[32:35], a[140:143], a[100:103]
    buffer_load_dwordx4 v1, s[16:19], s32 offen offset:2048 sc1 lds
    ds_read_b64_tr_b16 a[10:11], v43 offset:17408
    v_mfma_f32_16x16x32_bf16 a[108:111], a[40:43], a[140:143], a[108:111]
    ds_read_b64_tr_b16 a[12:13], v43 offset:24576
    v_mfma_f32_16x16x32_bf16 a[108:111], a[44:47], a[156:159], a[108:111]
    ds_read_b64_tr_b16 a[14:15], v43 offset:25600
    v_mfma_f32_16x16x32_bf16 a[104:107], a[44:47], a[152:155], a[104:107]
    ds_read_b64_tr_b16 a[16:17], v44 offset:16384
    v_mfma_f32_16x16x32_bf16 a[104:107], a[40:43], a[136:139], a[104:107]
    buffer_load_dwordx4 v1, s[16:19], s32 offen offset:3072 sc1 lds
    v_mfma_f32_16x16x32_bf16 v[236:239], a[40:43], a[132:135], v[236:239]
    ds_read_b64_tr_b16 a[18:19], v44 offset:17408
    v_mfma_f32_16x16x32_bf16 v[236:239], a[44:47], a[148:151], v[236:239]
    s_add_u32 s32, s32, 0x80000
    ds_read_b64_tr_b16 a[20:21], v44 offset:24576
    v_mfma_f32_16x16x32_bf16 v[232:235], a[44:47], a[144:147], v[232:235]
    s_add_u32 s34, s34, 0x4000
    ds_read_b64_tr_b16 a[22:23], v44 offset:25600
    s_mov_b32 m0, s34
    v_mfma_f32_16x16x32_bf16 v[232:235], a[40:43], a[128:131], v[232:235]
    buffer_load_dwordx4 v1, s[16:19], s32 offen offset:0 sc1 lds
    v_mfma_f32_16x16x32_bf16 v[240:243], a[48:51], a[128:131], v[240:243]
    ds_read_b64_tr_b16 a[24:25], v45 offset:16384
    v_mfma_f32_16x16x32_bf16 v[240:243], a[52:55], a[144:147], v[240:243]
    buffer_load_dwordx4 v1, s[16:19], s32 offen offset:1024 sc1 lds
    ds_read_b64_tr_b16 a[26:27], v45 offset:17408
    v_mfma_f32_16x16x32_bf16 v[244:247], a[52:55], a[148:151], v[244:247]
    ds_read_b64_tr_b16 a[28:29], v45 offset:24576
    v_mfma_f32_16x16x32_bf16 v[244:247], a[48:51], a[132:135], v[244:247]
    v_mfma_f32_16x16x32_bf16 a[112:115], a[48:51], a[136:139], a[112:115]
    buffer_load_dwordx4 v1, s[16:19], s32 offen offset:2048 sc1 lds
    ds_read_b64_tr_b16 a[30:31], v45 offset:25600
    v_mfma_f32_16x16x32_bf16 a[112:115], a[52:55], a[152:155], a[112:115]
    v_mfma_f32_16x16x32_bf16 a[116:119], a[52:55], a[156:159], a[116:119]
    v_mfma_f32_16x16x32_bf16 a[116:119], a[48:51], a[140:143], a[116:119]
    v_mfma_f32_16x16x32_bf16 a[124:127], a[56:59], a[140:143], a[124:127]
    buffer_load_dwordx4 v1, s[16:19], s32 offen offset:3072 sc1 lds
    v_mfma_f32_16x16x32_bf16 a[124:127], a[60:63], a[156:159], a[124:127]
    v_mfma_f32_16x16x32_bf16 a[120:123], a[60:63], a[152:155], a[120:123]
    s_add_u32 s32, s32, 0x80000
    v_mfma_f32_16x16x32_bf16 a[120:123], a[56:59], a[136:139], a[120:123]
    s_add_u32 s34, s34, 0x4000
    v_mfma_f32_16x16x32_bf16 v[252:255], a[56:59], a[132:135], v[252:255]
    v_mfma_f32_16x16x32_bf16 v[252:255], a[60:63], a[148:151], v[252:255]
    v_mfma_f32_16x16x32_bf16 v[248:251], a[60:63], a[144:147], v[248:251]
    v_mfma_f32_16x16x32_bf16 v[248:251], a[56:59], a[128:131], v[248:251]
    s_waitcnt vmcnt(10) lgkmcnt(0)
    v_mfma_f32_16x16x32_bf16 v[192:195], a[0:3], a[160:163], v[192:195]
    v_mfma_f32_16x16x32_bf16 v[192:195], a[4:7], a[176:179], v[192:195]
    s_mov_b32 m0, s35
    ds_read_b64_tr_b16 a[32:33], v46 offset:16384
    ds_read_b64_tr_b16 a[34:35], v46 offset:17408
    v_mfma_f32_16x16x32_bf16 v[196:199], a[4:7], a[180:183], v[196:199]
    buffer_load_dwordx4 v1, s[20:23], s33 offen offset:0 sc1 lds
    v_mfma_f32_16x16x32_bf16 v[196:199], a[0:3], a[164:167], v[196:199]
    ds_read_b64_tr_b16 a[36:37], v46 offset:24576
    v_mfma_f32_16x16x32_bf16 a[64:67], a[0:3], a[168:171], a[64:67]
    buffer_load_dwordx4 v1, s[20:23], s33 offen offset:1024 sc1 lds
    ds_read_b64_tr_b16 a[38:39], v46 offset:25600
    v_mfma_f32_16x16x32_bf16 a[64:67], a[4:7], a[184:187], a[64:67]
    ds_read_b64_tr_b16 a[40:41], v47 offset:16384
    v_mfma_f32_16x16x32_bf16 a[68:71], a[4:7], a[188:191], a[68:71]
    v_mfma_f32_16x16x32_bf16 a[68:71], a[0:3], a[172:175], a[68:71]
    buffer_load_dwordx4 v1, s[20:23], s33 offen offset:2048 sc1 lds
    ds_read_b64_tr_b16 a[42:43], v47 offset:17408
    v_mfma_f32_16x16x32_bf16 a[76:79], a[8:11], a[172:175], a[76:79]
    ds_read_b64_tr_b16 a[44:45], v47 offset:24576
    v_mfma_f32_16x16x32_bf16 a[76:79], a[12:15], a[188:191], a[76:79]
    ds_read_b64_tr_b16 a[46:47], v47 offset:25600
    v_mfma_f32_16x16x32_bf16 a[72:75], a[12:15], a[184:187], a[72:75]
    ds_read_b64_tr_b16 a[48:49], v48 offset:16384
    v_mfma_f32_16x16x32_bf16 a[72:75], a[8:11], a[168:171], a[72:75]
    buffer_load_dwordx4 v1, s[20:23], s33 offen offset:3072 sc1 lds
    v_mfma_f32_16x16x32_bf16 v[204:207], a[8:11], a[164:167], v[204:207]
    ds_read_b64_tr_b16 a[50:51], v48 offset:17408
    v_mfma_f32_16x16x32_bf16 v[204:207], a[12:15], a[180:183], v[204:207]
    s_add_u32 s33, s33, 0x80000
    ds_read_b64_tr_b16 a[52:53], v48 offset:24576
    v_mfma_f32_16x16x32_bf16 v[200:203], a[12:15], a[176:179], v[200:203]
    s_add_u32 s35, s35, 0x4000
    ds_read_b64_tr_b16 a[54:55], v48 offset:25600
    s_mov_b32 m0, s34
    v_mfma_f32_16x16x32_bf16 v[200:203], a[8:11], a[160:163], v[200:203]
    buffer_load_dwordx4 v1, s[16:19], s32 offen offset:0 sc1 lds
    v_mfma_f32_16x16x32_bf16 v[208:211], a[16:19], a[160:163], v[208:211]
    ds_read_b64_tr_b16 a[56:57], v49 offset:16384
    v_mfma_f32_16x16x32_bf16 v[208:211], a[20:23], a[176:179], v[208:211]
    buffer_load_dwordx4 v1, s[16:19], s32 offen offset:1024 sc1 lds
    ds_read_b64_tr_b16 a[58:59], v49 offset:17408
    v_mfma_f32_16x16x32_bf16 v[212:215], a[20:23], a[180:183], v[212:215]
    ds_read_b64_tr_b16 a[60:61], v49 offset:24576
    v_mfma_f32_16x16x32_bf16 v[212:215], a[16:19], a[164:167], v[212:215]
    v_mfma_f32_16x16x32_bf16 a[80:83], a[16:19], a[168:171], a[80:83]
    buffer_load_dwordx4 v1, s[16:19], s32 offen offset:2048 sc1 lds
    ds_read_b64_tr_b16 a[62:63], v49 offset:25600
    v_mfma_f32_16x16x32_bf16 a[80:83], a[20:23], a[184:187], a[80:83]
    v_mfma_f32_16x16x32_bf16 a[84:87], a[20:23], a[188:191], a[84:87]
    v_mfma_f32_16x16x32_bf16 a[84:87], a[16:19], a[172:175], a[84:87]
    v_mfma_f32_16x16x32_bf16 a[92:95], a[24:27], a[172:175], a[92:95]
    buffer_load_dwordx4 v1, s[16:19], s32 offen offset:3072 sc1 lds
    v_mfma_f32_16x16x32_bf16 a[92:95], a[28:31], a[188:191], a[92:95]
    v_mfma_f32_16x16x32_bf16 a[88:91], a[28:31], a[184:187], a[88:91]
    s_add_u32 s32, s32, 0x80000
    v_mfma_f32_16x16x32_bf16 a[88:91], a[24:27], a[168:171], a[88:91]
    s_add_u32 s34, s34, 0x4000
    v_mfma_f32_16x16x32_bf16 v[220:223], a[24:27], a[164:167], v[220:223]
    v_mfma_f32_16x16x32_bf16 v[220:223], a[28:31], a[180:183], v[220:223]
    v_mfma_f32_16x16x32_bf16 v[216:219], a[28:31], a[176:179], v[216:219]
    v_mfma_f32_16x16x32_bf16 v[216:219], a[24:27], a[160:163], v[216:219]
    s_waitcnt vmcnt(63) lgkmcnt(0)
    s_barrier
    v_mfma_f32_16x16x32_bf16 v[224:227], a[32:35], a[160:163], v[224:227]
    v_mfma_f32_16x16x32_bf16 v[224:227], a[36:39], a[176:179], v[224:227]
    s_mov_b32 m0, s35
    v_mfma_f32_16x16x32_bf16 v[228:231], a[36:39], a[180:183], v[228:231]
    buffer_load_dwordx4 v1, s[20:23], s33 offen offset:0 sc1 lds
    v_mfma_f32_16x16x32_bf16 v[228:231], a[32:35], a[164:167], v[228:231]
    v_mfma_f32_16x16x32_bf16 a[96:99], a[32:35], a[168:171], a[96:99]
    v_mfma_f32_16x16x32_bf16 a[96:99], a[36:39], a[184:187], a[96:99]
    v_mfma_f32_16x16x32_bf16 a[100:103], a[36:39], a[188:191], a[100:103]
    v_mfma_f32_16x16x32_bf16 a[100:103], a[32:35], a[172:175], a[100:103]
    buffer_load_dwordx4 v1, s[20:23], s33 offen offset:1024 sc1 lds
    v_mfma_f32_16x16x32_bf16 a[108:111], a[40:43], a[172:175], a[108:111]
    v_mfma_f32_16x16x32_bf16 a[108:111], a[44:47], a[188:191], a[108:111]
    v_mfma_f32_16x16x32_bf16 a[104:107], a[44:47], a[184:187], a[104:107]
    v_mfma_f32_16x16x32_bf16 a[104:107], a[40:43], a[168:171], a[104:107]
    v_mfma_f32_16x16x32_bf16 v[236:239], a[40:43], a[164:167], v[236:239]
    v_mfma_f32_16x16x32_bf16 v[236:239], a[44:47], a[180:183], v[236:239]
    v_mfma_f32_16x16x32_bf16 v[232:235], a[44:47], a[176:179], v[232:235]
    buffer_load_dwordx4 v1, s[20:23], s33 offen offset:2048 sc1 lds
    v_mfma_f32_16x16x32_bf16 v[232:235], a[40:43], a[160:163], v[232:235]
    v_mfma_f32_16x16x32_bf16 v[240:243], a[48:51], a[160:163], v[240:243]
    v_mfma_f32_16x16x32_bf16 v[240:243], a[52:55], a[176:179], v[240:243]
    v_mfma_f32_16x16x32_bf16 v[244:247], a[52:55], a[180:183], v[244:247]
    v_mfma_f32_16x16x32_bf16 v[244:247], a[48:51], a[164:167], v[244:247]
    v_mfma_f32_16x16x32_bf16 a[112:115], a[48:51], a[168:171], a[112:115]
    buffer_load_dwordx4 v1, s[20:23], s33 offen offset:3072 sc1 lds
    v_mfma_f32_16x16x32_bf16 a[112:115], a[52:55], a[184:187], a[112:115]
    v_mfma_f32_16x16x32_bf16 a[116:119], a[52:55], a[188:191], a[116:119]
    v_mfma_f32_16x16x32_bf16 a[116:119], a[48:51], a[172:175], a[116:119]
    v_mfma_f32_16x16x32_bf16 a[124:127], a[56:59], a[172:175], a[124:127]
    v_mfma_f32_16x16x32_bf16 a[124:127], a[60:63], a[188:191], a[124:127]
    v_mfma_f32_16x16x32_bf16 a[120:123], a[60:63], a[184:187], a[120:123]
    s_add_u32 s33, s33, 0x80000
    v_mfma_f32_16x16x32_bf16 a[120:123], a[56:59], a[168:171], a[120:123]
    s_add_u32 s35, s35, 0x4000
    v_mfma_f32_16x16x32_bf16 v[252:255], a[56:59], a[164:167], v[252:255]
    v_mfma_f32_16x16x32_bf16 v[252:255], a[60:63], a[180:183], v[252:255]
    v_mfma_f32_16x16x32_bf16 v[248:251], a[60:63], a[176:179], v[248:251]
    v_mfma_f32_16x16x32_bf16 v[248:251], a[56:59], a[160:163], v[248:251]
    s_add_u32 s3, s54, 64
    s_add_u32 s5, s55, 64
    s_mov_b32 s63, s57
    s_load_dwordx2 s[44:45], s[0:1], 40
    s_load_dwordx2 s[46:47], s[0:1], 64
    s_load_dwordx4 s[48:51], s[0:1], 72
    s_mov_b32 s40, 0x3e0293ee
    s_mov_b32 s41, 0x3e0293ee
    s_mov_b32 m0, s34
    s_nop 0
    buffer_load_dwordx4 v1, s[16:19], s32 offen offset:0 sc1 lds
    buffer_load_dwordx4 v1, s[16:19], s32 offen offset:1024 sc1 lds
    buffer_load_dwordx4 v1, s[16:19], s32 offen offset:2048 sc1 lds
    buffer_load_dwordx4 v1, s[16:19], s32 offen offset:3072 sc1 lds
    s_mov_b32 m0, s35
    s_nop 0
    buffer_load_dwordx4 v1, s[20:23], s33 offen offset:0 sc1 lds
    buffer_load_dwordx4 v1, s[20:23], s33 offen offset:1024 sc1 lds
    buffer_load_dwordx4 v1, s[20:23], s33 offen offset:2048 sc1 lds
    buffer_load_dwordx4 v1, s[20:23], s33 offen offset:3072 sc1 lds
    s_add_u32 s32, s32, 0x80000
    s_add_u32 s33, s33, 0x80000
    s_add_u32 s34, s34, 0x4000
    s_and_b32 s34, s34, 0xffff
    s_add_u32 s35, s35, 0x4000
    s_and_b32 s35, s35, 0xffff
    s_or_b32 s35, s35, 0x10000
    v_mov_b32 v2, v1
    v_or_b32 v3, 0x10000, v1
    v_mov_b32 v56, v3
    s_mov_b32 s52, 0x4000
    s_mov_b32 s53, 0
    s_lshl_b32 s62, s28, 6
    s_mul_i32 s31, s29, s29
    s_add_u32 s62, s62, s31
    s_lshr_b32 s31, s30, 1
    s_lshl_b32 s4, s31, 23
    s_add_u32 s4, s4, 0x6000000
    s_add_u32 s8, s6, s4
    s_addc_u32 s9, s7, 0
    s_and_b32 s9, s9, 0xffff
    s_mov_b32 s10, 0
    s_mov_b32 s58, 0
    s_mov_b32 s14, 0x700000
    s_mov_b32 s59, 0x700000
    s_lshl_b32 s54, s62, 12
    s_waitcnt vmcnt(16) lgkmcnt(0)
    s_barrier
    s_cmp_eq_u32 s63, 0
    s_cbranch_scc1 k12_ool_74
k12_oolret_75:
    v_mov_b32 v59, 0
    ds_read_b128 a[128:131], v2 offset:0
    ds_read_b128 a[132:135], v2 offset:1024
    ds_read_b128 a[136:139], v2 offset:2048
    ds_read_b128 a[140:143], v2 offset:3072
    ds_read_b128 a[144:147], v2 offset:4096
    ds_read_b128 a[148:151], v2 offset:5120
    ds_read_b128 a[152:155], v2 offset:6144
    ds_read_b128 a[156:159], v2 offset:7168
    ds_read_b128 a[160:163], v2 offset:8192
    ds_read_b128 a[164:167], v2 offset:9216
    ds_read_b128 a[168:171], v2 offset:10240
    ds_read_b128 a[172:175], v2 offset:11264
    ds_read_b128 a[176:179], v2 offset:12288
    ds_read_b128 a[180:183], v2 offset:13312
    ds_read_b128 a[184:187], v2 offset:14336
    ds_read_b128 a[188:191], v2 offset:15360
    s_cmp_lt_u32 s30, 2
    s_cselect_b64 s[12:13], s[46:47], s[48:49]
    s_cselect_b64 s[60:61], s[44:45], s[50:51]
    s_cselect_b32 s55, 0x800000, s14
    s_and_b32 s13, s13, 0xffff
    v_accvgpr_read_b32 v128, a64
    v_accvgpr_read_b32 v129, a65
    v_accvgpr_read_b32 v130, a66
    v_accvgpr_read_b32 v131, a67
    v_pk_mul_f32 v[128:129], v[128:129], s[40:41]
    v_pk_mul_f32 v[130:131], v[130:131], s[40:41]
    v_cvt_pk_bf16_f32 v96, v128, v129
    v_cvt_pk_bf16_f32 v97, v130, v131
    v_accvgpr_read_b32 v132, a72
    v_accvgpr_read_b32 v133, a73
    v_accvgpr_read_b32 v134, a74
    v_accvgpr_read_b32 v135, a75
    v_pk_mul_f32 v[132:133], v[132:133], s[40:41]
    v_pk_mul_f32 v[134:135], v[134:135], s[40:41]
    v_cvt_pk_bf16_f32 v98, v132, v133
    v_cvt_pk_bf16_f32 v99, v134, v135
    v_accvgpr_read_b32 v136, a80
    v_accvgpr_read_b32 v137, a81
    v_accvgpr_read_b32 v138, a82
    v_accvgpr_read_b32 v139, a83
    v_pk_mul_f32 v[136:137], v[136:137], s[40:41]
    v_pk_mul_f32 v[138:139], v[138:139], s[40:41]
    v_cvt_pk_bf16_f32 v100, v136, v137
    v_cvt_pk_bf16_f32 v101, v138, v139
    v_accvgpr_read_b32 v140, a88
    v_accvgpr_read_b32 v141, a89
    v_accvgpr_read_b32 v142, a90
    v_accvgpr_read_b32 v143, a91
    v_pk_mul_f32 v[140:141], v[140:141], s[40:41]
    v_pk_mul_f32 v[142:143], v[142:143], s[40:41]
    v_cvt_pk_bf16_f32 v102, v140, v141
    v_cvt_pk_bf16_f32 v103, v142, v143
    v_accvgpr_read_b32 v128, a96
    v_accvgpr_read_b32 v129, a97
    v_accvgpr_read_b32 v130, a98
    v_accvgpr_read_b32 v131, a99
    v_pk_mul_f32 v[128:129], v[128:129], s[40:41]
    v_pk_mul_f32 v[130:131], v[130:131], s[40:41]
    v_cvt_pk_bf16_f32 v104, v128, v129
    v_cvt_pk_bf16_f32 v105, v130, v131
    v_accvgpr_read_b32 v132, a104
    v_accvgpr_read_b32 v133, a105
    v_accvgpr_read_b32 v134, a106
    v_accvgpr_read_b32 v135, a107
    v_pk_mul_f32 v[132:133], v[132:133], s[40:41]
    v_pk_mul_f32 v[134:135], v[134:135], s[40:41]
    v_cvt_pk_bf16_f32 v106, v132, v133
    v_cvt_pk_bf16_f32 v107, v134, v135
    v_accvgpr_read_b32 v136, a112
    v_accvgpr_read_b32 v137, a113
    v_accvgpr_read_b32 v138, a114
    v_accvgpr_read_b32 v139, a115
    v_pk_mul_f32 v[136:137], v[136:137], s[40:41]
    v_pk_mul_f32 v[138:139], v[138:139], s[40:41]
    v_cvt_pk_bf16_f32 v108, v136, v137
    v_cvt_pk_bf16_f32 v109, v138, v139
    v_accvgpr_read_b32 v140, a120
    v_accvgpr_read_b32 v141, a121
    v_accvgpr_read_b32 v142, a122
    v_accvgpr_read_b32 v143, a123
    v_pk_mul_f32 v[140:141], v[140:141], s[40:41]
    v_pk_mul_f32 v[142:143], v[142:143], s[40:41]
    v_cvt_pk_bf16_f32 v110, v140, v141
    v_cvt_pk_bf16_f32 v111, v142, v143
    v_accvgpr_read_b32 v128, a68
    v_accvgpr_read_b32 v129, a69
    v_accvgpr_read_b32 v130, a70
    v_accvgpr_read_b32 v131, a71
    v_pk_mul_f32 v[128:129], v[128:129], s[40:41]
    v_pk_mul_f32 v[130:131], v[130:131], s[40:41]
    v_cvt_pk_bf16_f32 v112, v128, v129
    v_cvt_pk_bf16_f32 v113, v130, v131
    v_accvgpr_read_b32 v132, a76
    v_accvgpr_read_b32 v133, a77
    v_accvgpr_read_b32 v134, a78
    v_accvgpr_read_b32 v135, a79
    v_pk_mul_f32 v[132:133], v[132:133], s[40:41]
    v_pk_mul_f32 v[134:135], v[134:135], s[40:41]
    v_cvt_pk_bf16_f32 v114, v132, v133
    v_cvt_pk_bf16_f32 v115, v134, v135
    v_accvgpr_read_b32 v136, a84
    v_accvgpr_read_b32 v137, a85
    v_accvgpr_read_b32 v138, a86
    v_accvgpr_read_b32 v139, a87
    v_pk_mul_f32 v[136:137], v[136:137], s[40:41]
    v_pk_mul_f32 v[138:139], v[138:139], s[40:41]
    v_cvt_pk_bf16_f32 v116, v136, v137
    v_cvt_pk_bf16_f32 v117, v138, v139
    v_accvgpr_read_b32 v140, a92
    v_accvgpr_read_b32 v141, a93
    v_accvgpr_read_b32 v142, a94
    v_accvgpr_read_b32 v143, a95
    v_pk_mul_f32 v[140:141], v[140:141], s[40:41]
    v_pk_mul_f32 v[142:143], v[142:143], s[40:41]
    v_cvt_pk_bf16_f32 v118, v140, v141
    v_cvt_pk_bf16_f32 v119, v142, v143
    v_accvgpr_read_b32 v128, a100
    v_accvgpr_read_b32 v129, a101
    v_accvgpr_read_b32 v130, a102
    v_accvgpr_read_b32 v131, a103
    v_pk_mul_f32 v[128:129], v[128:129], s[40:41]
    v_pk_mul_f32 v[130:131], v[130:131], s[40:41]
    v_cvt_pk_bf16_f32 v120, v128, v129
    v_cvt_pk_bf16_f32 v121, v130, v131
    v_accvgpr_read_b32 v132, a108
    v_accvgpr_read_b32 v133, a109
    v_accvgpr_read_b32 v134, a110
    v_accvgpr_read_b32 v135, a111
    v_pk_mul_f32 v[132:133], v[132:133], s[40:41]
    v_pk_mul_f32 v[134:135], v[134:135], s[40:41]
    v_cvt_pk_bf16_f32 v122, v132, v133
    v_cvt_pk_bf16_f32 v123, v134, v135
    v_accvgpr_read_b32 v136, a116
    v_accvgpr_read_b32 v137, a117
    v_accvgpr_read_b32 v138, a118
    v_accvgpr_read_b32 v139, a119
    v_pk_mul_f32 v[136:137], v[136:137], s[40:41]
    v_pk_mul_f32 v[138:139], v[138:139], s[40:41]
    v_cvt_pk_bf16_f32 v124, v136, v137
    v_cvt_pk_bf16_f32 v125, v138, v139
    v_accvgpr_read_b32 v140, a124
    v_accvgpr_read_b32 v141, a125
    v_accvgpr_read_b32 v142, a126
    v_accvgpr_read_b32 v143, a127
    v_pk_mul_f32 v[140:141], v[140:141], s[40:41]
    v_pk_mul_f32 v[142:143], v[142:143], s[40:41]
    v_cvt_pk_bf16_f32 v126, v140, v141
    v_cvt_pk_bf16_f32 v127, v142, v143
    v_pk_mul_f32 v[192:193], v[192:193], s[40:41]
    v_pk_mul_f32 v[194:195], v[194:195], s[40:41]
    v_cvt_pk_bf16_f32 v64, v192, v193
    v_cvt_pk_bf16_f32 v65, v194, v195
    v_pk_mul_f32 v[200:201], v[200:201], s[40:41]
    v_pk_mul_f32 v[202:203], v[202:203], s[40:41]
    v_cvt_pk_bf16_f32 v66, v200, v201
    v_cvt_pk_bf16_f32 v67, v202, v203
    v_pk_mul_f32 v[208:209], v[208:209], s[40:41]
    v_pk_mul_f32 v[210:211], v[210:211], s[40:41]
    v_cvt_pk_bf16_f32 v68, v208, v209
    v_cvt_pk_bf16_f32 v69, v210, v211
    v_pk_mul_f32 v[216:217], v[216:217], s[40:41]
    v_pk_mul_f32 v[218:219], v[218:219], s[40:41]
    v_cvt_pk_bf16_f32 v70, v216, v217
    v_cvt_pk_bf16_f32 v71, v218, v219
    v_pk_mul_f32 v[224:225], v[224:225], s[40:41]
    v_pk_mul_f32 v[226:227], v[226:227], s[40:41]
    v_cvt_pk_bf16_f32 v72, v224, v225
    v_cvt_pk_bf16_f32 v73, v226, v227
    v_pk_mul_f32 v[232:233], v[232:233], s[40:41]
    v_pk_mul_f32 v[234:235], v[234:235], s[40:41]
    v_cvt_pk_bf16_f32 v74, v232, v233
    v_cvt_pk_bf16_f32 v75, v234, v235
    v_pk_mul_f32 v[240:241], v[240:241], s[40:41]
    v_pk_mul_f32 v[242:243], v[242:243], s[40:41]
    v_cvt_pk_bf16_f32 v76, v240, v241
    v_cvt_pk_bf16_f32 v77, v242, v243
    v_pk_mul_f32 v[248:249], v[248:249], s[40:41]
    v_pk_mul_f32 v[250:251], v[250:251], s[40:41]
    v_cvt_pk_bf16_f32 v78, v248, v249
    v_cvt_pk_bf16_f32 v79, v250, v251
    v_pk_mul_f32 v[196:197], v[196:197], s[40:41]
    v_pk_mul_f32 v[198:199], v[198:199], s[40:41]
    v_cvt_pk_bf16_f32 v80, v196, v197
    v_cvt_pk_bf16_f32 v81, v198, v199
    v_pk_mul_f32 v[204:205], v[204:205], s[40:41]
    v_pk_mul_f32 v[206:207], v[206:207], s[40:41]
    v_cvt_pk_bf16_f32 v82, v204, v205
    v_cvt_pk_bf16_f32 v83, v206, v207
    v_pk_mul_f32 v[212:213], v[212:213], s[40:41]
    v_pk_mul_f32 v[214:215], v[214:215], s[40:41]
    v_cvt_pk_bf16_f32 v84, v212, v213
    v_cvt_pk_bf16_f32 v85, v214, v215
    v_pk_mul_f32 v[220:221], v[220:221], s[40:41]
    v_pk_mul_f32 v[222:223], v[222:223], s[40:41]
    v_cvt_pk_bf16_f32 v86, v220, v221
    v_cvt_pk_bf16_f32 v87, v222, v223
    v_pk_mul_f32 v[228:229], v[228:229], s[40:41]
    v_pk_mul_f32 v[230:231], v[230:231], s[40:41]
    v_cvt_pk_bf16_f32 v88, v228, v229
    v_cvt_pk_bf16_f32 v89, v230, v231
    v_pk_mul_f32 v[236:237], v[236:237], s[40:41]
    v_pk_mul_f32 v[238:239], v[238:239], s[40:41]
    v_cvt_pk_bf16_f32 v90, v236, v237
    v_cvt_pk_bf16_f32 v91, v238, v239
    v_pk_mul_f32 v[244:245], v[244:245], s[40:41]
    v_pk_mul_f32 v[246:247], v[246:247], s[40:41]
    v_cvt_pk_bf16_f32 v92, v244, v245
    v_cvt_pk_bf16_f32 v93, v246, v247
    v_pk_mul_f32 v[252:253], v[252:253], s[40:41]
    v_pk_mul_f32 v[254:255], v[254:255], s[40:41]
    v_cvt_pk_bf16_f32 v94, v252, v253
    v_cvt_pk_bf16_f32 v95, v254, v255
    v_add_u32 v2, 0x4000, v1
    v_mov_b32 v8, 0
    v_mov_b32 v232, 0
    v_mov_b32 v9, 0
    v_mov_b32 v233, 0
    v_mov_b32 v10, 0
    v_mov_b32 v234, 0
    v_mov_b32 v11, 0
    v_mov_b32 v235, 0
    s_mov_b32 s36, 0
    s_mov_b32 s37, 0x40004000
    v_mfma_f32_32x32x16_bf16 v[16:31], v[232:235], v[232:235], 0
    v_mfma_f32_32x32x16_bf16 v[32:47], v[232:235], v[232:235], 0
    v_and_b32 v6, 0xf0, v1
    v_cmp_eq_u32 vcc, 0, v6
    v_mov_b32 v6, 0x3f803f80
    v_lshrrev_b32 v229, 7, v1
    s_and_b32 s4, s30, 1
    s_lshl_b32 s31, s4, 11
    v_lshl_add_u32 v230, v1, 1, s31
    v_lshl_add_u32 v229, s4, 4, v229
    v_mul_u32_u24 v228, 7168, v229
    v_and_b32 v7, 0x70, v1
    v_add_u32 v228, v228, v7
    v_lshlrev_b32 v229, 5, v229
    v_and_b32 v57, 0x10, v1
    v_add_u32 v229, v229, v57
    v_lshrrev_b32 v7, 5, v7
    v_lshl_add_u32 v229, v7, 15, v229
    v_cndmask_b32 v60, 0, v6, vcc
    v_cndmask_b32 v61, 0, v6, vcc
    v_cndmask_b32 v62, 0, v6, vcc
    v_cndmask_b32 v63, 0, v6, vcc
    v_mov_b32 v12, 0
    v_mov_b32 v13, 0
    v_mov_b32 v14, 0
    v_mov_b32 v15, 0
    v_mov_b32 v48, 0
    v_mov_b32 v49, 0
    v_mov_b32 v50, 0
    v_mov_b32 v51, 0
    v_mov_b32 v248, 0
    v_mov_b32 v249, 0
    v_mov_b32 v250, 0
    v_mov_b32 v251, 0
    v_mov_b32 v252, 0
    v_mov_b32 v253, 0
    v_mov_b32 v254, 0
    v_mov_b32 v255, 0
    s_waitcnt lgkmcnt(0)
    s_cmp_ge_u32 s36, s42
    s_cbranch_scc1 k2_prep_76
k2_prepret_77:
    v_mfma_f32_16x16x32_bf16 v[128:131], a[128:131], v[64:67], v[16:19]
    v_mfma_f32_16x16x32_bf16 v[128:131], a[132:135], v[68:71], v[128:131]
    v_mfma_f32_16x16x32_bf16 v[128:131], a[136:139], v[72:75], v[128:131]
    v_mfma_f32_16x16x32_bf16 v[128:131], a[140:143], v[76:79], v[128:131]
    s_add_u32 s36, s36, 32
    v_mfma_f32_16x16x32_bf16 v[132:135], a[140:143], v[92:95], v[20:23]
    v_mfma_f32_16x16x32_bf16 v[132:135], a[136:139], v[88:91], v[132:135]
    v_mfma_f32_16x16x32_bf16 v[132:135], a[132:135], v[84:87], v[132:135]
    v_mfma_f32_16x16x32_bf16 v[132:135], a[128:131], v[80:83], v[132:135]
    v_mfma_f32_16x16x32_bf16 v[136:139], a[128:131], v[96:99], v[24:27]
    v_mfma_f32_16x16x32_bf16 v[136:139], a[132:135], v[100:103], v[136:139]
    v_mfma_f32_16x16x32_bf16 v[136:139], a[136:139], v[104:107], v[136:139]
    v_mfma_f32_16x16x32_bf16 v[136:139], a[140:143], v[108:111], v[136:139]
    v_mfma_f32_16x16x32_bf16 v[140:143], a[140:143], v[124:127], v[28:31]
    v_mfma_f32_16x16x32_bf16 v[140:143], a[136:139], v[120:123], v[140:143]
    v_mfma_f32_16x16x32_bf16 v[140:143], a[132:135], v[116:119], v[140:143]
    v_mfma_f32_16x16x32_bf16 v[140:143], a[128:131], v[112:115], v[140:143]
    v_mfma_f32_16x16x32_bf16 v[156:159], a[144:147], v[112:115], v[44:47]
    v_mfma_f32_16x16x32_bf16 v[156:159], a[148:151], v[116:119], v[156:159]
    v_mfma_f32_16x16x32_bf16 v[156:159], a[152:155], v[120:123], v[156:159]
    v_mfma_f32_16x16x32_bf16 v[156:159], a[156:159], v[124:127], v[156:159]
    v_mfma_f32_16x16x32_bf16 v[152:155], a[156:159], v[108:111], v[40:43]
    v_mfma_f32_16x16x32_bf16 v[152:155], a[152:155], v[104:107], v[152:155]
    v_mfma_f32_16x16x32_bf16 v[152:155], a[148:151], v[100:103], v[152:155]
    v_mfma_f32_16x16x32_bf16 v[152:155], a[144:147], v[96:99], v[152:155]
    v_mfma_f32_16x16x32_bf16 v[148:151], a[144:147], v[80:83], v[36:39]
    v_mfma_f32_16x16x32_bf16 v[148:151], a[148:151], v[84:87], v[148:151]
    v_mfma_f32_16x16x32_bf16 v[148:151], a[152:155], v[88:91], v[148:151]
    v_mfma_f32_16x16x32_bf16 v[148:151], a[156:159], v[92:95], v[148:151]
    v_mfma_f32_16x16x32_bf16 v[144:147], a[156:159], v[76:79], v[32:35]
    v_mfma_f32_16x16x32_bf16 v[144:147], a[152:155], v[72:75], v[144:147]
    v_mfma_f32_16x16x32_bf16 v[144:147], a[148:151], v[68:71], v[144:147]
    v_mfma_f32_16x16x32_bf16 v[144:147], a[144:147], v[64:67], v[144:147]
    v_mfma_f32_32x32x16_bf16 a[0:15], v[232:235], v[232:235], 0
    v_mfma_f32_32x32x16_bf16 a[16:31], v[232:235], v[232:235], 0
    v_mfma_f32_32x32x16_bf16 a[32:47], v[232:235], v[232:235], 0
    v_mfma_f32_32x32x16_bf16 a[48:63], v[232:235], v[232:235], 0
    v_mfma_f32_32x32x16_bf16 a[64:79], v[232:235], v[232:235], 0
    v_mfma_f32_32x32x16_bf16 a[80:95], v[232:235], v[232:235], 0
    v_mfma_f32_32x32x16_bf16 a[96:111], v[232:235], v[232:235], 0
    v_mfma_f32_32x32x16_bf16 a[112:127], v[232:235], v[232:235], 0
    v_max_f32 v52, v128, v129
    v_max3_f32 v52, v52, v130, v131
    v_max3_f32 v52, v52, v144, v145
    v_max3_f32 v52, v52, v146, v147
    v_max_f32 v53, v132, v133
    v_max3_f32 v53, v53, v134, v135
    v_max3_f32 v53, v53, v148, v149
    v_max3_f32 v53, v53, v150, v151
    v_max_f32 v54, v136, v137
    v_max3_f32 v54, v54, v138, v139
    v_max3_f32 v54, v54, v152, v153
    v_max3_f32 v54, v54, v154, v155
    v_max_f32 v55, v140, v141
    v_max3_f32 v55, v55, v142, v143
    v_max3_f32 v55, v55, v156, v157
    v_max3_f32 v55, v55, v158, v159
    v_mov_b32 v224, v52
    v_mov_b32 v225, v53
    v_mov_b32 v226, v54
    v_mov_b32 v227, v55
    s_nop 1
    v_permlane16_swap_b32 v52, v224
    v_permlane16_swap_b32 v53, v225
    v_permlane16_swap_b32 v54, v226
    v_permlane16_swap_b32 v55, v227
    s_nop 1
    v_max_f32 v52, v52, v224
    v_max_f32 v53, v53, v225
    v_max_f32 v54, v54, v226
    v_max_f32 v55, v55, v227
    v_mov_b32 v224, v52
    v_mov_b32 v225, v53
    v_mov_b32 v226, v54
    v_mov_b32 v227, v55
    s_nop 1
    v_permlane32_swap_b32 v52, v224
    v_permlane32_swap_b32 v53, v225
    v_permlane32_swap_b32 v54, v226
    v_permlane32_swap_b32 v55, v227
    s_nop 1
    v_max_f32 v52, v52, v224
    v_max_f32 v53, v53, v225
    v_max_f32 v54, v54, v226
    v_max_f32 v55, v55, v227
    v_add_f32 v52, 0x41400000, v52
    v_add_f32 v53, 0x41400000, v53
    v_add_f32 v54, 0x41400000, v54
    v_add_f32 v55, 0x41400000, v55
    v_sub_f32 v16, 0, v52
    v_sub_f32 v17, 0, v52
    v_sub_f32 v18, 0, v52
    v_sub_f32 v19, 0, v52
    v_sub_f32 v20, 0, v53
    v_sub_f32 v21, 0, v53
    v_sub_f32 v22, 0, v53
    v_sub_f32 v23, 0, v53
    v_sub_f32 v24, 0, v54
    v_sub_f32 v25, 0, v54
    v_sub_f32 v26, 0, v54
    v_sub_f32 v27, 0, v54
    v_sub_f32 v28, 0, v55
    v_sub_f32 v29, 0, v55
    v_sub_f32 v30, 0, v55
    v_sub_f32 v31, 0, v55
    v_sub_f32 v32, 0, v52
    v_sub_f32 v33, 0, v52
    v_sub_f32 v34, 0, v52
    v_sub_f32 v35, 0, v52
    v_sub_f32 v36, 0, v53
    v_sub_f32 v37, 0, v53
    v_sub_f32 v38, 0, v53
    v_sub_f32 v39, 0, v53
    v_sub_f32 v40, 0, v54
    v_sub_f32 v41, 0, v54
    v_sub_f32 v42, 0, v54
    v_sub_f32 v43, 0, v54
    v_sub_f32 v44, 0, v55
    v_sub_f32 v45, 0, v55
    v_sub_f32 v46, 0, v55
    v_sub_f32 v47, 0, v55
    v_sub_f32 v8, 0, v52
    v_sub_f32 v9, 0, v53
    v_sub_f32 v10, 0, v54
    v_sub_f32 v11, 0, v55
    s_cmp_ge_u32 s36, s42
    s_cbranch_scc1 k2_prep_84
k2_prepret_85:
    v_mfma_f32_16x16x32_bf16 v[160:163], a[160:163], v[64:67], v[16:19]
    v_sub_f32 v128, v128, v52
    v_sub_f32 v129, v129, v52
    v_sub_f32 v130, v130, v52
    v_mfma_f32_16x16x32_bf16 v[160:163], a[164:167], v[68:71], v[160:163]
    v_exp_f32 v232, v128
    v_sub_f32 v131, v131, v52
    v_mfma_f32_16x16x32_bf16 v[160:163], a[168:171], v[72:75], v[160:163]
    v_exp_f32 v233, v129
    v_sub_f32 v144, v144, v52
    v_mfma_f32_16x16x32_bf16 v[160:163], a[172:175], v[76:79], v[160:163]
    s_add_u32 s36, s36, 32
    s_cmp_eq_u32 s30, 0
    s_cbranch_scc1 k12_ool_78
k12_oolret_79:
    v_sub_f32 v145, v145, v52
    v_mfma_f32_16x16x32_bf16 v[164:167], a[172:175], v[92:95], v[20:23]
    v_exp_f32 v234, v130
    v_cvt_pk_bf16_f32 v192, v232, v233
    v_mfma_f32_16x16x32_bf16 v[164:167], a[168:171], v[88:91], v[164:167]
    v_exp_f32 v235, v131
    v_sub_f32 v146, v146, v52
    v_mfma_f32_16x16x32_bf16 v[164:167], a[164:167], v[84:87], v[164:167]
    v_exp_f32 v236, v144
    v_sub_f32 v147, v147, v52
    v_mfma_f32_16x16x32_bf16 v[164:167], a[160:163], v[80:83], v[164:167]
    v_cvt_pk_bf16_f32 v193, v234, v235
    v_exp_f32 v237, v145
    v_mfma_f32_16x16x32_bf16 v[168:171], a[160:163], v[96:99], v[24:27]
    v_exp_f32 v238, v146
    v_sub_f32 v132, v132, v53
    v_mfma_f32_16x16x32_bf16 v[168:171], a[164:167], v[100:103], v[168:171]
    v_sub_f32 v133, v133, v53
    v_cvt_pk_bf16_f32 v194, v236, v237
    v_or3_b32 v57, v192, v193, v194
    v_mfma_f32_16x16x32_bf16 v[168:171], a[168:171], v[104:107], v[168:171]
    v_exp_f32 v239, v147
    v_sub_f32 v134, v134, v53
    v_mfma_f32_16x16x32_bf16 v[168:171], a[172:175], v[108:111], v[168:171]
    v_exp_f32 v240, v132
    v_sub_f32 v135, v135, v53
    v_mfma_f32_16x16x32_bf16 v[172:175], a[172:175], v[124:127], v[28:31]
    v_cvt_pk_bf16_f32 v195, v238, v239
    v_exp_f32 v241, v133
    v_mfma_f32_16x16x32_bf16 v[172:175], a[168:171], v[120:123], v[172:175]
    v_exp_f32 v242, v134
    v_sub_f32 v148, v148, v53
    v_mfma_f32_16x16x32_bf16 v[172:175], a[164:167], v[116:119], v[172:175]
    v_sub_f32 v149, v149, v53
    v_cvt_pk_bf16_f32 v196, v240, v241
    v_exp_f32 v243, v135
    v_mfma_f32_16x16x32_bf16 v[172:175], a[160:163], v[112:115], v[172:175]
    v_or3_b32 v57, v57, v195, v196
    v_exp_f32 v244, v148
    v_mfma_f32_16x16x32_bf16 v[188:191], a[176:179], v[112:115], v[44:47]
    v_sub_f32 v150, v150, v53
    v_sub_f32 v151, v151, v53
    v_cvt_pk_bf16_f32 v197, v242, v243
    v_mfma_f32_16x16x32_bf16 v[188:191], a[180:183], v[116:119], v[188:191]
    v_exp_f32 v245, v149
    v_exp_f32 v246, v150
    v_mfma_f32_16x16x32_bf16 v[188:191], a[184:187], v[120:123], v[188:191]
    v_sub_f32 v136, v136, v54
    v_sub_f32 v137, v137, v54
    v_cvt_pk_bf16_f32 v198, v244, v245
    v_mfma_f32_16x16x32_bf16 v[188:191], a[188:191], v[124:127], v[188:191]
    v_exp_f32 v247, v151
    v_or3_b32 v57, v57, v197, v198
    v_mfma_f32_16x16x32_bf16 v[184:187], a[188:191], v[108:111], v[40:43]
    v_exp_f32 v232, v136
    v_sub_f32 v138, v138, v54
    v_mfma_f32_16x16x32_bf16 v[184:187], a[184:187], v[104:107], v[184:187]
    ds_read_b128 a[192:195], v3 offset:0
    v_sub_f32 v139, v139, v54
    v_cvt_pk_bf16_f32 v199, v246, v247
    v_mfma_f32_16x16x32_bf16 v[184:187], a[180:183], v[100:103], v[184:187]
    v_exp_f32 v233, v137
    v_exp_f32 v234, v138
    v_mfma_f32_16x16x32_bf16 v[184:187], a[176:179], v[96:99], v[184:187]
    v_sub_f32 v152, v152, v54
    v_sub_f32 v153, v153, v54
    v_cvt_pk_bf16_f32 v200, v232, v233
    v_mfma_f32_16x16x32_bf16 v[180:183], a[176:179], v[80:83], v[36:39]
    v_exp_f32 v235, v139
    v_or3_b32 v57, v57, v199, v200
    v_mfma_f32_16x16x32_bf16 v[180:183], a[180:183], v[84:87], v[180:183]
    v_exp_f32 v236, v152
    v_sub_f32 v154, v154, v54
    v_mfma_f32_16x16x32_bf16 v[180:183], a[184:187], v[88:91], v[180:183]
    v_sub_f32 v155, v155, v54
    v_cvt_pk_bf16_f32 v201, v234, v235
    v_exp_f32 v237, v153
    v_mfma_f32_16x16x32_bf16 v[180:183], a[188:191], v[92:95], v[180:183]
    ds_read_b128 a[196:199], v3 offset:1024
    v_exp_f32 v238, v154
    v_mfma_f32_16x16x32_bf16 v[176:179], a[188:191], v[76:79], v[32:35]
    v_sub_f32 v140, v140, v55
    v_sub_f32 v141, v141, v55
    v_cvt_pk_bf16_f32 v202, v236, v237
    v_mfma_f32_16x16x32_bf16 v[176:179], a[184:187], v[72:75], v[176:179]
    v_exp_f32 v239, v155
    v_or3_b32 v57, v57, v201, v202
    v_mfma_f32_16x16x32_bf16 v[176:179], a[180:183], v[68:71], v[176:179]
    s_cmp_eq_u32 s30, 0
    s_cbranch_scc1 k12_ool_82
k12_oolret_83:
    v_exp_f32 v240, v140
    v_mfma_f32_16x16x32_bf16 v[176:179], a[176:179], v[64:67], v[176:179]
    s_waitcnt vmcnt(8)
    s_barrier
    v_sub_f32 v142, v142, v55
    v_sub_f32 v143, v143, v55
    v_cvt_pk_bf16_f32 v203, v238, v239
    v_exp_f32 v241, v141
    v_exp_f32 v242, v142
    v_sub_f32 v156, v156, v55
    v_sub_f32 v157, v157, v55
    ds_read_b128 a[200:203], v3 offset:2048
    v_cvt_pk_bf16_f32 v204, v240, v241
    v_exp_f32 v243, v143
    v_or3_b32 v57, v57, v203, v204
    v_exp_f32 v244, v156
    v_sub_f32 v158, v158, v55
    v_sub_f32 v159, v159, v55
    v_cvt_pk_bf16_f32 v205, v242, v243
    v_exp_f32 v245, v157
    v_exp_f32 v246, v158
    v_cvt_pk_bf16_f32 v206, v244, v245
    ds_read_b128 a[204:207], v3 offset:3072
    v_exp_f32 v247, v159
    v_or3_b32 v57, v57, v205, v206
    v_cvt_pk_bf16_f32 v207, v246, v247
    v_bitop3_b32 v57, v57, v207, s37 bitop3:0xa8
    v_cmp_ne_u32 vcc, 0, v57
    s_cbranch_vccnz k2_tramp_86
k2_ret_87:
    s_mov_b32 s24, s60
    s_and_b32 s25, s61, 0xffff
    s_mov_b32 s26, s55
    s_lshl_b32 s63, s29, 1
    s_sub_u32 s63, s63, 1
    s_cbranch_scc1 k2_dm3_89
k2_dloop_88:
    v_mfma_f32_16x16x32_bf16 v[12:15], v[60:63], v[192:195], v[12:15]
    v_exp_f32 v232, v160
    v_mfma_f32_16x16x32_bf16 v[48:51], v[60:63], v[196:199], v[48:51]
    s_mov_b32 m0, s34
    ds_read_b128 a[208:211], v3 offset:4096
    v_mfma_f32_16x16x32_bf16 v[248:251], v[60:63], v[200:203], v[248:251]
    s_add_u32 s53, s53, 8192
    buffer_load_dwordx4 v1, s[16:19], s32 offen offset:0 sc1 lds
    v_mfma_f32_16x16x32_bf16 v[252:255], v[60:63], v[204:207], v[252:255]
    s_waitcnt lgkmcnt(3)
    v_exp_f32 v233, v161
    v_mfma_f32_16x16x32_bf16 a[12:15], a[192:195], v[204:207], a[12:15]
    s_and_b32 s53, s53, 0xffff
    v_exp_f32 v234, v162
    v_mfma_f32_16x16x32_bf16 a[8:11], a[192:195], v[200:203], a[8:11]
    s_add_u32 s34, s34, 0x4000
    ds_read_b128 a[212:215], v3 offset:5120
    v_cvt_pk_bf16_f32 v208, v232, v233
    v_mfma_f32_16x16x32_bf16 a[4:7], a[192:195], v[196:199], a[4:7]
    v_exp_f32 v235, v163
    v_mfma_f32_16x16x32_bf16 a[0:3], a[192:195], v[192:195], a[0:3]
    buffer_load_dwordx4 v1, s[16:19], s32 offen offset:1024 sc1 lds
    v_mfma_f32_16x16x32_bf16 a[16:19], a[196:199], v[192:195], a[16:19]
    v_exp_f32 v236, v176
    v_mfma_f32_16x16x32_bf16 a[20:23], a[196:199], v[196:199], a[20:23]
    ds_read_b128 a[216:219], v3 offset:6144
    v_cvt_pk_bf16_f32 v209, v234, v235
    v_mfma_f32_16x16x32_bf16 a[24:27], a[196:199], v[200:203], a[24:27]
    v_exp_f32 v237, v177
    v_mfma_f32_16x16x32_bf16 a[28:31], a[196:199], v[204:207], a[28:31]
    s_waitcnt lgkmcnt(3)
    v_exp_f32 v238, v178
    v_mfma_f32_16x16x32_bf16 a[44:47], a[200:203], v[204:207], a[44:47]
    s_and_b32 s34, s34, 0xffff
    ds_read_b128 a[220:223], v3 offset:7168
    v_cvt_pk_bf16_f32 v210, v236, v237
    v_mfma_f32_16x16x32_bf16 a[40:43], a[200:203], v[200:203], a[40:43]
    s_and_b32 s60, s62, 31
    buffer_load_dwordx4 v1, s[16:19], s32 offen offset:2048 sc1 lds
    v_mfma_f32_16x16x32_bf16 a[36:39], a[200:203], v[196:199], a[36:39]
    v_exp_f32 v239, v179
    v_mfma_f32_16x16x32_bf16 a[32:35], a[200:203], v[192:195], a[32:35]
    s_lshr_b32 s61, s62, 5
    v_or3_b32 v57, v208, v209, v210
    v_add_u32 v3, s53, v56
    v_mfma_f32_16x16x32_bf16 a[48:51], a[204:207], v[192:195], a[48:51]
    v_exp_f32 v240, v164
    v_mfma_f32_16x16x32_bf16 a[52:55], a[204:207], v[196:199], a[52:55]
    ds_read_b128 a[128:131], v2 offset:0
    v_cvt_pk_bf16_f32 v211, v238, v239
    v_mfma_f32_16x16x32_bf16 a[56:59], a[204:207], v[200:203], a[56:59]
    s_mul_i32 s57, s60, 229376
    v_exp_f32 v241, v165
    v_mfma_f32_16x16x32_bf16 a[60:63], a[204:207], v[204:207], a[60:63]
    s_waitcnt lgkmcnt(3)
    buffer_load_dwordx4 v1, s[16:19], s32 offen offset:3072 sc1 lds
    v_mfma_f32_16x16x32_bf16 a[76:79], a[208:211], v[204:207], a[76:79]
    s_add_u32 s32, s32, 0x80000
    v_exp_f32 v242, v166
    v_mfma_f32_16x16x32_bf16 a[72:75], a[208:211], v[200:203], a[72:75]
    s_lshl_b32 s4, s61, 7
    ds_read_b128 a[132:135], v2 offset:1024
    v_cvt_pk_bf16_f32 v212, v240, v241
    v_mfma_f32_16x16x32_bf16 a[68:71], a[208:211], v[196:199], a[68:71]
    v_exp_f32 v243, v167
    v_mfma_f32_16x16x32_bf16 a[64:67], a[208:211], v[192:195], a[64:67]
    s_add_u32 s57, s57, s4
    v_or3_b32 v57, v57, v211, v212
    v_cvt_pk_bf16_f32 v213, v242, v243
    v_mfma_f32_16x16x32_bf16 a[80:83], a[212:215], v[192:195], a[80:83]
    s_waitcnt vmcnt(9)
    v_exp_f32 v244, v180
    v_mfma_f32_16x16x32_bf16 a[84:87], a[212:215], v[196:199], a[84:87]
    buffer_store_dwordx4 a[224:227], v229, s[8:11], s58 offen offset:0 sc1
    ds_read_b128 a[136:139], v2 offset:2048
    v_mfma_f32_16x16x32_bf16 a[88:91], a[212:215], v[200:203], a[88:91]
    s_add_u32 s56, s57, 57344
    v_exp_f32 v245, v181
    v_mfma_f32_16x16x32_bf16 a[92:95], a[212:215], v[204:207], a[92:95]
    s_waitcnt lgkmcnt(3)
    v_exp_f32 v246, v182
    v_mfma_f32_16x16x32_bf16 a[108:111], a[216:219], v[204:207], a[108:111]
    ds_read_b128 a[140:143], v2 offset:3072
    v_cvt_pk_bf16_f32 v214, v244, v245
    v_mfma_f32_16x16x32_bf16 a[104:107], a[216:219], v[200:203], a[104:107]
    s_add_u32 s62, s62, 1
    v_exp_f32 v247, v183
    v_mfma_f32_16x16x32_bf16 a[100:103], a[216:219], v[196:199], a[100:103]
    v_or3_b32 v57, v57, v213, v214
    v_mfma_f32_16x16x32_bf16 a[96:99], a[216:219], v[192:195], a[96:99]
    v_exp_f32 v232, v168
    v_mfma_f32_16x16x32_bf16 a[112:115], a[220:223], v[192:195], a[112:115]
    ds_read_b128 a[144:147], v2 offset:4096
    v_cvt_pk_bf16_f32 v215, v246, v247
    v_mfma_f32_16x16x32_bf16 a[116:119], a[220:223], v[196:199], a[116:119]
    buffer_store_dwordx4 a[228:231], v229, s[8:11], s58 offen offset:256 sc1
    v_mfma_f32_16x16x32_bf16 a[120:123], a[220:223], v[200:203], a[120:123]
    v_exp_f32 v233, v169
    v_mfma_f32_16x16x32_bf16 a[124:127], a[220:223], v[204:207], a[124:127]
    s_waitcnt lgkmcnt(3)
    v_exp_f32 v234, v170
    v_mfma_f32_16x16x32_bf16 v[128:131], a[128:131], v[64:67], v[16:19]
    ds_read_b128 a[148:151], v2 offset:5120
    v_cvt_pk_bf16_f32 v216, v232, v233
    v_mfma_f32_16x16x32_bf16 v[128:131], a[132:135], v[68:71], v[128:131]
    s_waitcnt lgkmcnt(2)
    v_exp_f32 v235, v171
    v_mfma_f32_16x16x32_bf16 v[128:131], a[136:139], v[72:75], v[128:131]
    v_or3_b32 v57, v57, v215, v216
    v_mfma_f32_16x16x32_bf16 v[128:131], a[140:143], v[76:79], v[128:131]
    s_add_u32 s36, s36, 32
    v_exp_f32 v236, v184
    v_mfma_f32_16x16x32_bf16 v[132:135], a[140:143], v[92:95], v[20:23]
    ds_read_b128 a[152:155], v2 offset:6144
    v_cvt_pk_bf16_f32 v217, v234, v235
    v_mfma_f32_16x16x32_bf16 v[132:135], a[136:139], v[88:91], v[132:135]
    s_lshl_b32 s58, s61, 17
    buffer_load_dwordx4 a[224:227], v228, s[12:15], s57 offen nt
    v_mfma_f32_16x16x32_bf16 v[132:135], a[132:135], v[84:87], v[132:135]
    s_add_u32 s52, s52, 8192
    v_exp_f32 v237, v185
    v_mfma_f32_16x16x32_bf16 v[132:135], a[128:131], v[80:83], v[132:135]
    v_exp_f32 v238, v186
    v_mfma_f32_16x16x32_bf16 v[136:139], a[128:131], v[96:99], v[24:27]
    s_lshl_b32 s60, s60, 10
    ds_read_b128 a[156:159], v2 offset:7168
    v_cvt_pk_bf16_f32 v218, v236, v237
    v_mfma_f32_16x16x32_bf16 v[136:139], a[132:135], v[100:103], v[136:139]
    s_and_b32 s52, s52, 0xffff
    v_exp_f32 v239, v187
    v_mfma_f32_16x16x32_bf16 v[136:139], a[136:139], v[104:107], v[136:139]
    v_or3_b32 v57, v57, v217, v218
    v_mfma_f32_16x16x32_bf16 v[136:139], a[140:143], v[108:111], v[136:139]
    v_add_u32 v2, s52, v1
    v_cvt_pk_bf16_f32 v219, v238, v239
    v_mfma_f32_16x16x32_bf16 v[140:143], a[140:143], v[124:127], v[28:31]
    s_add_u32 s58, s58, s60
    v_exp_f32 v240, v172
    v_mfma_f32_16x16x32_bf16 v[140:143], a[136:139], v[120:123], v[140:143]
    buffer_load_dwordx4 a[228:231], v228, s[12:15], s56 offen nt
    v_mfma_f32_16x16x32_bf16 v[140:143], a[132:135], v[116:119], v[140:143]
    v_exp_f32 v241, v173
    v_mfma_f32_16x16x32_bf16 v[140:143], a[128:131], v[112:115], v[140:143]
    s_waitcnt lgkmcnt(2)
    ds_read_b128 a[192:195], v3 offset:0
    v_cvt_pk_bf16_f32 v220, v240, v241
    v_mfma_f32_16x16x32_bf16 v[156:159], a[144:147], v[112:115], v[44:47]
    s_mov_b32 s10, s59
    v_exp_f32 v242, v174
    v_mfma_f32_16x16x32_bf16 v[156:159], a[148:151], v[116:119], v[156:159]
    s_waitcnt lgkmcnt(1)
    v_exp_f32 v243, v175
    v_mfma_f32_16x16x32_bf16 v[156:159], a[152:155], v[120:123], v[156:159]
    ds_read_b128 a[196:199], v3 offset:1024
    v_or3_b32 v57, v57, v219, v220
    v_mfma_f32_16x16x32_bf16 v[156:159], a[156:159], v[124:127], v[156:159]
    v_exp_f32 v244, v188
    v_mfma_f32_16x16x32_bf16 v[152:155], a[156:159], v[108:111], v[40:43]
    v_cvt_pk_bf16_f32 v221, v242, v243
    v_mfma_f32_16x16x32_bf16 v[152:155], a[152:155], v[104:107], v[152:155]
    buffer_load_dword v7, v230, s[24:27], s54 offen
    v_mfma_f32_16x16x32_bf16 v[152:155], a[148:151], v[100:103], v[152:155]
    v_exp_f32 v245, v189
    v_mfma_f32_16x16x32_bf16 v[152:155], a[144:147], v[96:99], v[152:155]
    ds_read_b128 a[200:203], v3 offset:2048
    v_cvt_pk_bf16_f32 v222, v244, v245
    v_mfma_f32_16x16x32_bf16 v[148:151], a[144:147], v[80:83], v[36:39]
    v_exp_f32 v246, v190
    v_mfma_f32_16x16x32_bf16 v[148:151], a[148:151], v[84:87], v[148:151]
    v_exp_f32 v247, v191
    v_mfma_f32_16x16x32_bf16 v[148:151], a[152:155], v[88:91], v[148:151]
    ds_read_b128 a[204:207], v3 offset:3072
    v_or3_b32 v57, v57, v221, v222
    v_mfma_f32_16x16x32_bf16 v[148:151], a[156:159], v[92:95], v[148:151]
    v_cvt_pk_bf16_f32 v223, v246, v247
    v_mfma_f32_16x16x32_bf16 v[144:147], a[156:159], v[76:79], v[32:35]
    s_add_u32 s54, s54, 4096
    v_mfma_f32_16x16x32_bf16 v[144:147], a[152:155], v[72:75], v[144:147]
    v_bitop3_b32 v57, v57, v223, s37 bitop3:0xa8
    v_cmp_ne_u32 vcc, 0, v57
    v_mfma_f32_16x16x32_bf16 v[144:147], a[148:151], v[68:71], v[144:147]
    v_mfma_f32_16x16x32_bf16 v[144:147], a[144:147], v[64:67], v[144:147]
    s_cbranch_vccnz k2_tramp_90
k2_ret_91:
    v_mfma_f32_16x16x32_bf16 v[12:15], v[60:63], v[208:211], v[12:15]
    v_exp_f32 v232, v128
    v_mfma_f32_16x16x32_bf16 v[48:51], v[60:63], v[212:215], v[48:51]
    s_mov_b32 m0, s35
    ds_read_b128 a[208:211], v3 offset:4096
    v_mfma_f32_16x16x32_bf16 v[248:251], v[60:63], v[216:219], v[248:251]
    s_add_u32 s53, s53, 8192
    buffer_load_dwordx4 v1, s[20:23], s33 offen offset:0 sc1 lds
    v_mfma_f32_16x16x32_bf16 v[252:255], v[60:63], v[220:223], v[252:255]
    s_waitcnt lgkmcnt(3)
    v_exp_f32 v233, v129
    v_mfma_f32_16x16x32_bf16 a[12:15], a[192:195], v[220:223], a[12:15]
    s_and_b32 s53, s53, 0xffff
    v_exp_f32 v234, v130
    v_mfma_f32_16x16x32_bf16 a[8:11], a[192:195], v[216:219], a[8:11]
    ds_read_b128 a[212:215], v3 offset:5120
    v_cvt_pk_bf16_f32 v192, v232, v233
    v_mfma_f32_16x16x32_bf16 a[4:7], a[192:195], v[212:215], a[4:7]
    v_exp_f32 v235, v131
    v_mfma_f32_16x16x32_bf16 a[0:3], a[192:195], v[208:211], a[0:3]
    v_exp_f32 v236, v144
    v_mfma_f32_16x16x32_bf16 a[16:19], a[196:199], v[208:211], a[16:19]
    ds_read_b128 a[216:219], v3 offset:6144
    v_cvt_pk_bf16_f32 v193, v234, v235
    v_mfma_f32_16x16x32_bf16 a[20:23], a[196:199], v[212:215], a[20:23]
    v_exp_f32 v237, v145
    v_mfma_f32_16x16x32_bf16 a[24:27], a[196:199], v[216:219], a[24:27]
    v_mfma_f32_16x16x32_bf16 a[28:31], a[196:199], v[220:223], a[28:31]
    s_waitcnt lgkmcnt(3)
    v_exp_f32 v238, v146
    v_mfma_f32_16x16x32_bf16 a[44:47], a[200:203], v[220:223], a[44:47]
    ds_read_b128 a[220:223], v3 offset:7168
    v_cvt_pk_bf16_f32 v194, v236, v237
    v_mfma_f32_16x16x32_bf16 a[40:43], a[200:203], v[216:219], a[40:43]
    v_exp_f32 v239, v147
    v_mfma_f32_16x16x32_bf16 a[36:39], a[200:203], v[212:215], a[36:39]
    v_or3_b32 v57, v192, v193, v194
    v_mfma_f32_16x16x32_bf16 a[32:35], a[200:203], v[208:211], a[32:35]
    s_add_u32 s35, s35, 0x4000
    v_add_u32 v3, s53, v56
    v_cvt_pk_bf16_f32 v195, v238, v239
    v_mfma_f32_16x16x32_bf16 a[48:51], a[204:207], v[208:211], a[48:51]
    v_exp_f32 v240, v132
    v_mfma_f32_16x16x32_bf16 a[52:55], a[204:207], v[212:215], a[52:55]
    buffer_load_dwordx4 v1, s[20:23], s33 offen offset:1024 sc1 lds
    ds_read_b128 a[128:131], v2 offset:0
    v_mfma_f32_16x16x32_bf16 a[56:59], a[204:207], v[216:219], a[56:59]
    v_exp_f32 v241, v133
    v_mfma_f32_16x16x32_bf16 a[60:63], a[204:207], v[220:223], a[60:63]
    s_waitcnt lgkmcnt(3)
    v_exp_f32 v242, v134
    v_mfma_f32_16x16x32_bf16 a[76:79], a[208:211], v[220:223], a[76:79]
    ds_read_b128 a[132:135], v2 offset:1024
    v_cvt_pk_bf16_f32 v196, v240, v241
    v_mfma_f32_16x16x32_bf16 a[72:75], a[208:211], v[216:219], a[72:75]
    v_exp_f32 v243, v135
    v_mfma_f32_16x16x32_bf16 a[68:71], a[208:211], v[212:215], a[68:71]
    v_or3_b32 v57, v57, v195, v196
    v_mfma_f32_16x16x32_bf16 a[64:67], a[208:211], v[208:211], a[64:67]
    v_exp_f32 v244, v148
    v_mfma_f32_16x16x32_bf16 a[80:83], a[212:215], v[208:211], a[80:83]
    ds_read_b128 a[136:139], v2 offset:2048
    v_cvt_pk_bf16_f32 v197, v242, v243
    v_mfma_f32_16x16x32_bf16 a[84:87], a[212:215], v[212:215], a[84:87]
    v_exp_f32 v245, v149
    v_mfma_f32_16x16x32_bf16 a[88:91], a[212:215], v[216:219], a[88:91]
    v_mfma_f32_16x16x32_bf16 a[92:95], a[212:215], v[220:223], a[92:95]
    s_waitcnt lgkmcnt(3)
    v_exp_f32 v246, v150
    v_mfma_f32_16x16x32_bf16 a[108:111], a[216:219], v[220:223], a[108:111]
    ds_read_b128 a[140:143], v2 offset:3072
    v_cvt_pk_bf16_f32 v198, v244, v245
    v_mfma_f32_16x16x32_bf16 a[104:107], a[216:219], v[216:219], a[104:107]
    v_exp_f32 v247, v151
    v_mfma_f32_16x16x32_bf16 a[100:103], a[216:219], v[212:215], a[100:103]
    v_or3_b32 v57, v57, v197, v198
    v_mfma_f32_16x16x32_bf16 a[96:99], a[216:219], v[208:211], a[96:99]
    s_and_b32 s35, s35, 0xffff
    v_exp_f32 v232, v136
    v_mfma_f32_16x16x32_bf16 a[112:115], a[220:223], v[208:211], a[112:115]
    ds_read_b128 a[144:147], v2 offset:4096
    v_cvt_pk_bf16_f32 v199, v246, v247
    v_mfma_f32_16x16x32_bf16 a[116:119], a[220:223], v[212:215], a[116:119]
    buffer_load_dwordx4 v1, s[20:23], s33 offen offset:2048 sc1 lds
    v_mfma_f32_16x16x32_bf16 a[120:123], a[220:223], v[216:219], a[120:123]
    v_exp_f32 v233, v137
    v_mfma_f32_16x16x32_bf16 a[124:127], a[220:223], v[220:223], a[124:127]
    s_waitcnt lgkmcnt(3)
    v_exp_f32 v234, v138
    v_mfma_f32_16x16x32_bf16 v[160:163], a[128:131], v[64:67], v[16:19]
    ds_read_b128 a[148:151], v2 offset:5120
    v_cvt_pk_bf16_f32 v200, v232, v233
    v_mfma_f32_16x16x32_bf16 v[160:163], a[132:135], v[68:71], v[160:163]
    s_waitcnt lgkmcnt(2)
    v_exp_f32 v235, v139
    v_mfma_f32_16x16x32_bf16 v[160:163], a[136:139], v[72:75], v[160:163]
    v_or3_b32 v57, v57, v199, v200
    v_mfma_f32_16x16x32_bf16 v[160:163], a[140:143], v[76:79], v[160:163]
    s_or_b32 s35, s35, 0x10000
    v_exp_f32 v236, v152
    v_mfma_f32_16x16x32_bf16 v[164:167], a[140:143], v[92:95], v[20:23]
    s_add_u32 s36, s36, 32
    ds_read_b128 a[152:155], v2 offset:6144
    v_cvt_pk_bf16_f32 v201, v234, v235
    v_mfma_f32_16x16x32_bf16 v[164:167], a[136:139], v[88:91], v[164:167]
    v_exp_f32 v237, v153
    v_mfma_f32_16x16x32_bf16 v[164:167], a[132:135], v[84:87], v[164:167]
    s_add_u32 s52, s52, 8192
    v_mfma_f32_16x16x32_bf16 v[164:167], a[128:131], v[80:83], v[164:167]
    v_exp_f32 v238, v154
    v_mfma_f32_16x16x32_bf16 v[168:171], a[128:131], v[96:99], v[24:27]
    s_and_b32 s52, s52, 0xffff
    ds_read_b128 a[156:159], v2 offset:7168
    v_cvt_pk_bf16_f32 v202, v236, v237
    v_mfma_f32_16x16x32_bf16 v[168:171], a[132:135], v[100:103], v[168:171]
    v_exp_f32 v239, v155
    v_mfma_f32_16x16x32_bf16 v[168:171], a[136:139], v[104:107], v[168:171]
    v_or3_b32 v57, v57, v201, v202
    v_mfma_f32_16x16x32_bf16 v[168:171], a[140:143], v[108:111], v[168:171]
    v_add_u32 v2, s52, v1
    v_cvt_pk_bf16_f32 v203, v238, v239
    v_mfma_f32_16x16x32_bf16 v[172:175], a[140:143], v[124:127], v[28:31]
    v_exp_f32 v240, v140
    v_mfma_f32_16x16x32_bf16 v[172:175], a[136:139], v[120:123], v[172:175]
    buffer_load_dwordx4 v1, s[20:23], s33 offen offset:3072 sc1 lds
    v_mfma_f32_16x16x32_bf16 v[172:175], a[132:135], v[116:119], v[172:175]
    s_add_u32 s33, s33, 0x80000
    v_exp_f32 v241, v141
    v_mfma_f32_16x16x32_bf16 v[172:175], a[128:131], v[112:115], v[172:175]
    s_waitcnt lgkmcnt(2)
    ds_read_b128 a[192:195], v3 offset:0
    v_cvt_pk_bf16_f32 v204, v240, v241
    v_mfma_f32_16x16x32_bf16 v[188:191], a[144:147], v[112:115], v[44:47]
    v_exp_f32 v242, v142
    v_mfma_f32_16x16x32_bf16 v[188:191], a[148:151], v[116:119], v[188:191]
    s_waitcnt lgkmcnt(1)
    v_exp_f32 v243, v143
    v_mfma_f32_16x16x32_bf16 v[188:191], a[152:155], v[120:123], v[188:191]
    ds_read_b128 a[196:199], v3 offset:1024
    v_or3_b32 v57, v57, v203, v204
    v_mfma_f32_16x16x32_bf16 v[188:191], a[156:159], v[124:127], v[188:191]
    v_exp_f32 v244, v156
    v_mfma_f32_16x16x32_bf16 v[184:187], a[156:159], v[108:111], v[40:43]
    v_cvt_pk_bf16_f32 v205, v242, v243
    v_mfma_f32_16x16x32_bf16 v[184:187], a[152:155], v[104:107], v[184:187]
    v_exp_f32 v245, v157
    v_mfma_f32_16x16x32_bf16 v[184:187], a[148:151], v[100:103], v[184:187]
    ds_read_b128 a[200:203], v3 offset:2048
    v_mfma_f32_16x16x32_bf16 v[184:187], a[144:147], v[96:99], v[184:187]
    s_sub_u32 s63, s63, 1
    v_exp_f32 v246, v158
    v_mfma_f32_16x16x32_bf16 v[180:183], a[144:147], v[80:83], v[36:39]
    v_cvt_pk_bf16_f32 v206, v244, v245
    v_mfma_f32_16x16x32_bf16 v[180:183], a[148:151], v[84:87], v[180:183]
    v_exp_f32 v247, v159
    v_mfma_f32_16x16x32_bf16 v[180:183], a[152:155], v[88:91], v[180:183]
    ds_read_b128 a[204:207], v3 offset:3072
    v_or3_b32 v57, v57, v205, v206
    v_mfma_f32_16x16x32_bf16 v[180:183], a[156:159], v[92:95], v[180:183]
    v_cvt_pk_bf16_f32 v207, v246, v247
    v_mfma_f32_16x16x32_bf16 v[176:179], a[156:159], v[76:79], v[32:35]
    v_mfma_f32_16x16x32_bf16 v[176:179], a[152:155], v[72:75], v[176:179]
    v_bitop3_b32 v57, v57, v207, s37 bitop3:0xa8
    v_cmp_ne_u32 vcc, 0, v57
    v_mfma_f32_16x16x32_bf16 v[176:179], a[148:151], v[68:71], v[176:179]
    v_mfma_f32_16x16x32_bf16 v[176:179], a[144:147], v[64:67], v[176:179]
    s_waitcnt vmcnt(13)
    s_barrier
    s_cbranch_vccnz k2_tramp_92
k2_ret_93:
    s_cmp_lg_u32 s63, 0
    s_cbranch_scc1 k2_dloop_88
    v_mfma_f32_16x16x32_bf16 v[12:15], v[60:63], v[192:195], v[12:15]
    v_exp_f32 v232, v160
    v_mfma_f32_16x16x32_bf16 v[48:51], v[60:63], v[196:199], v[48:51]
    s_mov_b32 m0, s34
    ds_read_b128 a[208:211], v3 offset:4096
    v_mfma_f32_16x16x32_bf16 v[248:251], v[60:63], v[200:203], v[248:251]
    s_add_u32 s53, s53, 8192
    buffer_load_dwordx4 v1, s[16:19], s32 offen offset:0 sc1 lds
    v_mfma_f32_16x16x32_bf16 v[252:255], v[60:63], v[204:207], v[252:255]
    s_waitcnt lgkmcnt(3)
    v_exp_f32 v233, v161
    v_mfma_f32_16x16x32_bf16 a[12:15], a[192:195], v[204:207], a[12:15]
    s_sub_u32 s40, s36, s38
    v_exp_f32 v234, v162
    v_mfma_f32_16x16x32_bf16 a[8:11], a[192:195], v[200:203], a[8:11]
    s_and_b32 s53, s53, 0xffff
    ds_read_b128 a[212:215], v3 offset:5120
    v_cvt_pk_bf16_f32 v208, v232, v233
    v_mfma_f32_16x16x32_bf16 a[4:7], a[192:195], v[196:199], a[4:7]
    s_add_u32 s34, s34, 0x4000
    v_subrev_u32 v6, s40, v4
    v_cmp_gt_i32 s[44:45], 0, v6
    v_mfma_f32_16x16x32_bf16 a[0:3], a[192:195], v[192:195], a[0:3]
    v_exp_f32 v235, v163
    v_mfma_f32_16x16x32_bf16 a[16:19], a[196:199], v[192:195], a[16:19]
    buffer_load_dwordx4 v1, s[16:19], s32 offen offset:1024 sc1 lds
    ds_read_b128 a[216:219], v3 offset:6144
    v_mfma_f32_16x16x32_bf16 a[20:23], a[196:199], v[196:199], a[20:23]
    v_exp_f32 v236, v176
    v_mfma_f32_16x16x32_bf16 a[24:27], a[196:199], v[200:203], a[24:27]
    v_cmp_gt_i32 s[46:47], 1, v6
    v_cvt_pk_bf16_f32 v209, v234, v235
    v_mfma_f32_16x16x32_bf16 a[28:31], a[196:199], v[204:207], a[28:31]
    s_waitcnt lgkmcnt(3)
    v_cmp_gt_i32 s[48:49], 2, v6
    v_cmp_gt_i32 s[50:51], 3, v6
    v_mfma_f32_16x16x32_bf16 a[44:47], a[200:203], v[204:207], a[44:47]
    s_and_b32 s34, s34, 0xffff
    v_exp_f32 v237, v177
    v_mfma_f32_16x16x32_bf16 a[40:43], a[200:203], v[200:203], a[40:43]
    s_and_b32 s60, s62, 31
    v_exp_f32 v238, v178
    v_mfma_f32_16x16x32_bf16 a[36:39], a[200:203], v[196:199], a[36:39]
    ds_read_b128 a[220:223], v3 offset:7168
    v_cvt_pk_bf16_f32 v210, v236, v237
    v_mfma_f32_16x16x32_bf16 a[32:35], a[200:203], v[192:195], a[32:35]
    s_lshr_b32 s61, s62, 5
    buffer_load_dwordx4 v1, s[16:19], s32 offen offset:2048 sc1 lds
    v_mfma_f32_16x16x32_bf16 a[48:51], a[204:207], v[192:195], a[48:51]
    v_cndmask_b32 v16, v8, v5, s[44:45]
    v_or3_b32 v57, v208, v209, v210
    v_mfma_f32_16x16x32_bf16 a[52:55], a[204:207], v[196:199], a[52:55]
    v_exp_f32 v239, v179
    v_mfma_f32_16x16x32_bf16 a[56:59], a[204:207], v[200:203], a[56:59]
    s_mul_i32 s57, s60, 229376
    v_cndmask_b32 v17, v8, v5, s[46:47]
    v_add_u32 v3, s53, v56
    v_mfma_f32_16x16x32_bf16 a[60:63], a[204:207], v[204:207], a[60:63]
    s_waitcnt lgkmcnt(2)
    v_exp_f32 v240, v164
    v_mfma_f32_16x16x32_bf16 a[76:79], a[208:211], v[204:207], a[76:79]
    v_cvt_pk_bf16_f32 v211, v238, v239
    v_cndmask_b32 v18, v8, v5, s[48:49]
    v_mfma_f32_16x16x32_bf16 a[72:75], a[208:211], v[200:203], a[72:75]
    s_lshl_b32 s4, s61, 7
    ds_read_b128 a[128:131], v2 offset:0
    v_cndmask_b32 v19, v8, v5, s[50:51]
    v_mfma_f32_16x16x32_bf16 a[68:71], a[208:211], v[196:199], a[68:71]
    v_exp_f32 v241, v165
    v_mfma_f32_16x16x32_bf16 a[64:67], a[208:211], v[192:195], a[64:67]
    s_add_u32 s57, s57, s4
    buffer_load_dwordx4 v1, s[16:19], s32 offen offset:3072 sc1 lds
    s_add_u32 s32, s32, 0x80000
    v_mfma_f32_16x16x32_bf16 a[80:83], a[212:215], v[192:195], a[80:83]
    s_waitcnt vmcnt(9)
    v_cmp_gt_i32 s[44:45], 16, v6
    v_exp_f32 v242, v166
    v_mfma_f32_16x16x32_bf16 a[84:87], a[212:215], v[196:199], a[84:87]
    ds_read_b128 a[132:135], v2 offset:1024
    v_cvt_pk_bf16_f32 v212, v240, v241
    v_mfma_f32_16x16x32_bf16 a[88:91], a[212:215], v[200:203], a[88:91]
    s_add_u32 s56, s57, 57344
    v_cmp_gt_i32 s[46:47], 17, v6
    v_exp_f32 v243, v167
    v_mfma_f32_16x16x32_bf16 a[92:95], a[212:215], v[204:207], a[92:95]
    s_waitcnt lgkmcnt(2)
    v_or3_b32 v57, v57, v211, v212
    v_cmp_gt_i32 s[48:49], 18, v6
    v_mfma_f32_16x16x32_bf16 a[108:111], a[216:219], v[204:207], a[108:111]
    v_exp_f32 v244, v180
    v_mfma_f32_16x16x32_bf16 a[104:107], a[216:219], v[200:203], a[104:107]
    s_add_u32 s62, s62, 1
    v_cvt_pk_bf16_f32 v213, v242, v243
    v_cmp_gt_i32 s[50:51], 19, v6
    v_mfma_f32_16x16x32_bf16 a[100:103], a[216:219], v[196:199], a[100:103]
    buffer_store_dwordx4 a[224:227], v229, s[8:11], s58 offen offset:0 sc1
    ds_read_b128 a[136:139], v2 offset:2048
    v_mfma_f32_16x16x32_bf16 a[96:99], a[216:219], v[192:195], a[96:99]
    v_exp_f32 v245, v181
    v_mfma_f32_16x16x32_bf16 a[112:115], a[220:223], v[192:195], a[112:115]
    v_cndmask_b32 v32, v8, v5, s[44:45]
    v_exp_f32 v246, v182
    v_mfma_f32_16x16x32_bf16 a[116:119], a[220:223], v[196:199], a[116:119]
    ds_read_b128 a[140:143], v2 offset:3072
    v_cndmask_b32 v33, v8, v5, s[46:47]
    v_cvt_pk_bf16_f32 v214, v244, v245
    v_cndmask_b32 v34, v8, v5, s[48:49]
    v_cndmask_b32 v35, v8, v5, s[50:51]
    v_mfma_f32_16x16x32_bf16 a[120:123], a[220:223], v[200:203], a[120:123]
    v_exp_f32 v247, v183
    v_mfma_f32_16x16x32_bf16 a[124:127], a[220:223], v[204:207], a[124:127]
    s_waitcnt lgkmcnt(2)
    v_or3_b32 v57, v57, v213, v214
    v_cvt_pk_bf16_f32 v215, v246, v247
    v_mfma_f32_16x16x32_bf16 v[128:131], a[128:131], v[64:67], v[16:19]
    v_exp_f32 v232, v168
    v_mfma_f32_16x16x32_bf16 v[128:131], a[132:135], v[68:71], v[128:131]
    s_waitcnt lgkmcnt(0)
    buffer_store_dwordx4 a[228:231], v229, s[8:11], s58 offen offset:256 sc1
    ds_read_b128 a[144:147], v2 offset:4096
    v_mfma_f32_16x16x32_bf16 v[128:131], a[136:139], v[72:75], v[128:131]
    v_exp_f32 v233, v169
    v_mfma_f32_16x16x32_bf16 v[128:131], a[140:143], v[76:79], v[128:131]
    s_add_u32 s36, s36, 32
    v_exp_f32 v234, v170
    v_mfma_f32_16x16x32_bf16 v[132:135], a[140:143], v[92:95], v[20:23]
    ds_read_b128 a[148:151], v2 offset:5120
    v_cvt_pk_bf16_f32 v216, v232, v233
    v_mfma_f32_16x16x32_bf16 v[132:135], a[136:139], v[88:91], v[132:135]
    s_lshl_b32 s58, s61, 17
    v_exp_f32 v235, v171
    v_mfma_f32_16x16x32_bf16 v[132:135], a[132:135], v[84:87], v[132:135]
    s_add_u32 s52, s52, 8192
    v_or3_b32 v57, v57, v215, v216
    v_cvt_pk_bf16_f32 v217, v234, v235
    v_mfma_f32_16x16x32_bf16 v[132:135], a[128:131], v[80:83], v[132:135]
    v_exp_f32 v236, v184
    v_mfma_f32_16x16x32_bf16 v[136:139], a[128:131], v[96:99], v[24:27]
    s_lshl_b32 s60, s60, 10
    buffer_load_dwordx4 a[224:227], v228, s[12:15], s57 offen nt
    ds_read_b128 a[152:155], v2 offset:6144
    v_mfma_f32_16x16x32_bf16 v[136:139], a[132:135], v[100:103], v[136:139]
    s_and_b32 s52, s52, 0xffff
    v_exp_f32 v237, v185
    v_mfma_f32_16x16x32_bf16 v[136:139], a[136:139], v[104:107], v[136:139]
    v_exp_f32 v238, v186
    v_mfma_f32_16x16x32_bf16 v[136:139], a[140:143], v[108:111], v[136:139]
    ds_read_b128 a[156:159], v2 offset:7168
    v_cvt_pk_bf16_f32 v218, v236, v237
    v_mfma_f32_16x16x32_bf16 v[140:143], a[140:143], v[124:127], v[28:31]
    s_add_u32 s58, s58, s60
    v_exp_f32 v239, v187
    v_mfma_f32_16x16x32_bf16 v[140:143], a[136:139], v[120:123], v[140:143]
    v_or3_b32 v57, v57, v217, v218
    v_add_u32 v2, s52, v1
    v_mfma_f32_16x16x32_bf16 v[140:143], a[132:135], v[116:119], v[140:143]
    v_exp_f32 v240, v172
    v_mfma_f32_16x16x32_bf16 v[140:143], a[128:131], v[112:115], v[140:143]
    s_waitcnt lgkmcnt(2)
    ds_read_b128 a[192:195], v3 offset:0
    v_cvt_pk_bf16_f32 v219, v238, v239
    v_mfma_f32_16x16x32_bf16 v[156:159], a[144:147], v[112:115], v[44:47]
    s_mov_b32 s10, s59
    buffer_load_dwordx4 a[228:231], v228, s[12:15], s56 offen nt
    v_mfma_f32_16x16x32_bf16 v[156:159], a[148:151], v[116:119], v[156:159]
    s_waitcnt lgkmcnt(1)
    v_exp_f32 v241, v173
    v_mfma_f32_16x16x32_bf16 v[156:159], a[152:155], v[120:123], v[156:159]
    v_exp_f32 v242, v174
    v_mfma_f32_16x16x32_bf16 v[156:159], a[156:159], v[124:127], v[156:159]
    v_cvt_pk_bf16_f32 v220, v240, v241
    v_or3_b32 v57, v57, v219, v220
    v_mfma_f32_16x16x32_bf16 v[152:155], a[156:159], v[108:111], v[40:43]
    v_exp_f32 v243, v175
    v_mfma_f32_16x16x32_bf16 v[152:155], a[152:155], v[104:107], v[152:155]
    ds_read_b128 a[196:199], v3 offset:1024
    v_cvt_pk_bf16_f32 v221, v242, v243
    v_mfma_f32_16x16x32_bf16 v[152:155], a[148:151], v[100:103], v[152:155]
    v_exp_f32 v244, v188
    v_mfma_f32_16x16x32_bf16 v[152:155], a[144:147], v[96:99], v[152:155]
    buffer_load_dword v7, v230, s[24:27], s54 offen
    ds_read_b128 a[200:203], v3 offset:2048
    v_mfma_f32_16x16x32_bf16 v[148:151], a[144:147], v[80:83], v[36:39]
    v_exp_f32 v245, v189
    v_mfma_f32_16x16x32_bf16 v[148:151], a[148:151], v[84:87], v[148:151]
    v_exp_f32 v246, v190
    v_mfma_f32_16x16x32_bf16 v[148:151], a[152:155], v[88:91], v[148:151]
    v_cvt_pk_bf16_f32 v222, v244, v245
    v_or3_b32 v57, v57, v221, v222
    v_mfma_f32_16x16x32_bf16 v[148:151], a[156:159], v[92:95], v[148:151]
    v_exp_f32 v247, v191
    v_mfma_f32_16x16x32_bf16 v[144:147], a[156:159], v[76:79], v[32:35]
    s_add_u32 s54, s54, 4096
    ds_read_b128 a[204:207], v3 offset:3072
    v_cvt_pk_bf16_f32 v223, v246, v247
    v_mfma_f32_16x16x32_bf16 v[144:147], a[152:155], v[72:75], v[144:147]
    v_bitop3_b32 v57, v57, v223, s37 bitop3:0xa8
    v_cmp_ne_u32 vcc, 0, v57
    v_mfma_f32_16x16x32_bf16 v[144:147], a[148:151], v[68:71], v[144:147]
    v_mfma_f32_16x16x32_bf16 v[144:147], a[144:147], v[64:67], v[144:147]
    s_cbranch_vccnz k2_tramp_94
k2_ret_95:
    v_mfma_f32_16x16x32_bf16 v[12:15], v[60:63], v[208:211], v[12:15]
    v_exp_f32 v232, v128
    v_mfma_f32_16x16x32_bf16 v[48:51], v[60:63], v[212:215], v[48:51]
    s_mov_b32 m0, s35
    ds_read_b128 a[208:211], v3 offset:4096
    v_mfma_f32_16x16x32_bf16 v[248:251], v[60:63], v[216:219], v[248:251]
    s_add_u32 s53, s53, 8192
    buffer_load_dwordx4 v1, s[20:23], s33 offen offset:0 sc1 lds
    v_mfma_f32_16x16x32_bf16 v[252:255], v[60:63], v[220:223], v[252:255]
    s_waitcnt lgkmcnt(3)
    v_exp_f32 v233, v129
    v_mfma_f32_16x16x32_bf16 a[12:15], a[192:195], v[220:223], a[12:15]
    s_sub_u32 s40, s36, s38
    v_exp_f32 v234, v130
    v_mfma_f32_16x16x32_bf16 a[8:11], a[192:195], v[216:219], a[8:11]
    s_and_b32 s53, s53, 0xffff
    ds_read_b128 a[212:215], v3 offset:5120
    v_cvt_pk_bf16_f32 v192, v232, v233
    v_mfma_f32_16x16x32_bf16 a[4:7], a[192:195], v[212:215], a[4:7]
    v_subrev_u32 v6, s40, v4
    v_cmp_gt_i32 s[44:45], 0, v6
    v_mfma_f32_16x16x32_bf16 a[0:3], a[192:195], v[208:211], a[0:3]
    v_exp_f32 v235, v131
    v_mfma_f32_16x16x32_bf16 a[16:19], a[196:199], v[208:211], a[16:19]
    v_exp_f32 v236, v144
    v_mfma_f32_16x16x32_bf16 a[20:23], a[196:199], v[212:215], a[20:23]
    v_cmp_gt_i32 s[46:47], 1, v6
    v_cvt_pk_bf16_f32 v193, v234, v235
    v_mfma_f32_16x16x32_bf16 a[24:27], a[196:199], v[216:219], a[24:27]
    ds_read_b128 a[216:219], v3 offset:6144
    v_cmp_gt_i32 s[48:49], 2, v6
    v_mfma_f32_16x16x32_bf16 a[28:31], a[196:199], v[220:223], a[28:31]
    s_waitcnt lgkmcnt(3)
    v_exp_f32 v237, v145
    v_mfma_f32_16x16x32_bf16 a[44:47], a[200:203], v[220:223], a[44:47]
    v_cmp_gt_i32 s[50:51], 3, v6
    v_cvt_pk_bf16_f32 v194, v236, v237
    v_mfma_f32_16x16x32_bf16 a[40:43], a[200:203], v[216:219], a[40:43]
    v_exp_f32 v238, v146
    v_mfma_f32_16x16x32_bf16 a[36:39], a[200:203], v[212:215], a[36:39]
    ds_read_b128 a[220:223], v3 offset:7168
    v_cndmask_b32 v16, v8, v5, s[44:45]
    v_mfma_f32_16x16x32_bf16 a[32:35], a[200:203], v[208:211], a[32:35]
    s_add_u32 s35, s35, 0x4000
    v_exp_f32 v239, v147
    v_mfma_f32_16x16x32_bf16 a[48:51], a[204:207], v[208:211], a[48:51]
    v_or3_b32 v57, v192, v193, v194
    v_cndmask_b32 v17, v8, v5, s[46:47]
    v_mfma_f32_16x16x32_bf16 a[52:55], a[204:207], v[212:215], a[52:55]
    v_add_u32 v3, s53, v56
    v_cvt_pk_bf16_f32 v195, v238, v239
    v_mfma_f32_16x16x32_bf16 a[56:59], a[204:207], v[216:219], a[56:59]
    v_exp_f32 v240, v132
    v_mfma_f32_16x16x32_bf16 a[60:63], a[204:207], v[220:223], a[60:63]
    s_waitcnt lgkmcnt(2)
    ds_read_b128 a[128:131], v2 offset:0
    v_cndmask_b32 v18, v8, v5, s[48:49]
    v_mfma_f32_16x16x32_bf16 a[76:79], a[208:211], v[220:223], a[76:79]
    buffer_load_dwordx4 v1, s[20:23], s33 offen offset:1024 sc1 lds
    ds_read_b128 a[132:135], v2 offset:1024
    v_mfma_f32_16x16x32_bf16 a[72:75], a[208:211], v[216:219], a[72:75]
    v_exp_f32 v241, v133
    v_mfma_f32_16x16x32_bf16 a[68:71], a[208:211], v[212:215], a[68:71]
    v_cndmask_b32 v19, v8, v5, s[50:51]
    v_cmp_gt_i32 s[44:45], 16, v6
    v_mfma_f32_16x16x32_bf16 a[64:67], a[208:211], v[208:211], a[64:67]
    v_exp_f32 v242, v134
    v_mfma_f32_16x16x32_bf16 a[80:83], a[212:215], v[208:211], a[80:83]
    v_cvt_pk_bf16_f32 v196, v240, v241
    v_cmp_gt_i32 s[46:47], 17, v6
    v_mfma_f32_16x16x32_bf16 a[84:87], a[212:215], v[212:215], a[84:87]
    v_exp_f32 v243, v135
    v_mfma_f32_16x16x32_bf16 a[88:91], a[212:215], v[216:219], a[88:91]
    v_or3_b32 v57, v57, v195, v196
    v_cmp_gt_i32 s[48:49], 18, v6
    v_mfma_f32_16x16x32_bf16 a[92:95], a[212:215], v[220:223], a[92:95]
    s_waitcnt lgkmcnt(2)
    v_exp_f32 v244, v148
    v_mfma_f32_16x16x32_bf16 a[108:111], a[216:219], v[220:223], a[108:111]
    v_cvt_pk_bf16_f32 v197, v242, v243
    v_cmp_gt_i32 s[50:51], 19, v6
    v_mfma_f32_16x16x32_bf16 a[104:107], a[216:219], v[216:219], a[104:107]
    ds_read_b128 a[136:139], v2 offset:2048
    v_cndmask_b32 v32, v8, v5, s[44:45]
    v_mfma_f32_16x16x32_bf16 a[100:103], a[216:219], v[212:215], a[100:103]
    v_exp_f32 v245, v149
    v_mfma_f32_16x16x32_bf16 a[96:99], a[216:219], v[208:211], a[96:99]
    s_and_b32 s35, s35, 0xffff
    v_exp_f32 v246, v150
    v_mfma_f32_16x16x32_bf16 a[112:115], a[220:223], v[208:211], a[112:115]
    v_cndmask_b32 v33, v8, v5, s[46:47]
    v_cvt_pk_bf16_f32 v198, v244, v245
    v_mfma_f32_16x16x32_bf16 a[116:119], a[220:223], v[212:215], a[116:119]
    ds_read_b128 a[140:143], v2 offset:3072
    v_cndmask_b32 v34, v8, v5, s[48:49]
    v_cndmask_b32 v35, v8, v5, s[50:51]
    v_mfma_f32_16x16x32_bf16 a[120:123], a[220:223], v[216:219], a[120:123]
    v_exp_f32 v247, v151
    v_mfma_f32_16x16x32_bf16 a[124:127], a[220:223], v[220:223], a[124:127]
    s_waitcnt lgkmcnt(2)
    v_or3_b32 v57, v57, v197, v198
    v_cvt_pk_bf16_f32 v199, v246, v247
    v_mfma_f32_16x16x32_bf16 v[160:163], a[128:131], v[64:67], v[16:19]
    v_exp_f32 v232, v136
    v_mfma_f32_16x16x32_bf16 v[160:163], a[132:135], v[68:71], v[160:163]
    s_waitcnt lgkmcnt(0)
    buffer_load_dwordx4 v1, s[20:23], s33 offen offset:2048 sc1 lds
    ds_read_b128 a[144:147], v2 offset:4096
    v_mfma_f32_16x16x32_bf16 v[160:163], a[136:139], v[72:75], v[160:163]
    v_exp_f32 v233, v137
    v_mfma_f32_16x16x32_bf16 v[160:163], a[140:143], v[76:79], v[160:163]
    s_or_b32 s35, s35, 0x10000
    v_exp_f32 v234, v138
    v_mfma_f32_16x16x32_bf16 v[164:167], a[140:143], v[92:95], v[20:23]
    s_add_u32 s36, s36, 32
    ds_read_b128 a[148:151], v2 offset:5120
    v_cvt_pk_bf16_f32 v200, v232, v233
    v_mfma_f32_16x16x32_bf16 v[164:167], a[136:139], v[88:91], v[164:167]
    v_exp_f32 v235, v139
    v_mfma_f32_16x16x32_bf16 v[164:167], a[132:135], v[84:87], v[164:167]
    s_add_u32 s52, s52, 8192
    v_or3_b32 v57, v57, v199, v200
    v_cvt_pk_bf16_f32 v201, v234, v235
    v_mfma_f32_16x16x32_bf16 v[164:167], a[128:131], v[80:83], v[164:167]
    v_exp_f32 v236, v152
    v_mfma_f32_16x16x32_bf16 v[168:171], a[128:131], v[96:99], v[24:27]
    s_and_b32 s52, s52, 0xffff
    ds_read_b128 a[152:155], v2 offset:6144
    ds_read_b128 a[156:159], v2 offset:7168
    v_mfma_f32_16x16x32_bf16 v[168:171], a[132:135], v[100:103], v[168:171]
    v_exp_f32 v237, v153
    v_mfma_f32_16x16x32_bf16 v[168:171], a[136:139], v[104:107], v[168:171]
    v_exp_f32 v238, v154
    v_mfma_f32_16x16x32_bf16 v[168:171], a[140:143], v[108:111], v[168:171]
    v_cvt_pk_bf16_f32 v202, v236, v237
    v_or3_b32 v57, v57, v201, v202
    v_mfma_f32_16x16x32_bf16 v[172:175], a[140:143], v[124:127], v[28:31]
    v_exp_f32 v239, v155
    v_mfma_f32_16x16x32_bf16 v[172:175], a[136:139], v[120:123], v[172:175]
    v_add_u32 v2, s52, v1
    v_cvt_pk_bf16_f32 v203, v238, v239
    v_mfma_f32_16x16x32_bf16 v[172:175], a[132:135], v[116:119], v[172:175]
    v_exp_f32 v240, v140
    v_mfma_f32_16x16x32_bf16 v[172:175], a[128:131], v[112:115], v[172:175]
    s_waitcnt lgkmcnt(2)
    buffer_load_dwordx4 v1, s[20:23], s33 offen offset:3072 sc1 lds
    s_add_u32 s33, s33, 0x80000
    v_mfma_f32_16x16x32_bf16 v[188:191], a[144:147], v[112:115], v[44:47]
    v_exp_f32 v241, v141
    v_mfma_f32_16x16x32_bf16 v[188:191], a[148:151], v[116:119], v[188:191]
    s_waitcnt lgkmcnt(0)
    ds_read_b128 a[192:195], v3 offset:0
    v_cvt_pk_bf16_f32 v204, v240, v241
    v_mfma_f32_16x16x32_bf16 v[188:191], a[152:155], v[120:123], v[188:191]
    v_exp_f32 v242, v142
    v_mfma_f32_16x16x32_bf16 v[188:191], a[156:159], v[124:127], v[188:191]
    v_exp_f32 v243, v143
    v_mfma_f32_16x16x32_bf16 v[184:187], a[156:159], v[108:111], v[40:43]
    ds_read_b128 a[196:199], v3 offset:1024
    v_or3_b32 v57, v57, v203, v204
    v_mfma_f32_16x16x32_bf16 v[184:187], a[152:155], v[104:107], v[184:187]
    v_exp_f32 v244, v156
    v_mfma_f32_16x16x32_bf16 v[184:187], a[148:151], v[100:103], v[184:187]
    ds_read_b128 a[200:203], v3 offset:2048
    v_cvt_pk_bf16_f32 v205, v242, v243
    v_mfma_f32_16x16x32_bf16 v[184:187], a[144:147], v[96:99], v[184:187]
    v_exp_f32 v245, v157
    v_mfma_f32_16x16x32_bf16 v[180:183], a[144:147], v[80:83], v[36:39]
    v_exp_f32 v246, v158
    v_mfma_f32_16x16x32_bf16 v[180:183], a[148:151], v[84:87], v[180:183]
    v_cvt_pk_bf16_f32 v206, v244, v245
    v_or3_b32 v57, v57, v205, v206
    v_mfma_f32_16x16x32_bf16 v[180:183], a[152:155], v[88:91], v[180:183]
    v_exp_f32 v247, v159
    v_mfma_f32_16x16x32_bf16 v[180:183], a[156:159], v[92:95], v[180:183]
    ds_read_b128 a[204:207], v3 offset:3072
    v_cvt_pk_bf16_f32 v207, v246, v247
    v_mfma_f32_16x16x32_bf16 v[176:179], a[156:159], v[76:79], v[32:35]
    v_mfma_f32_16x16x32_bf16 v[176:179], a[152:155], v[72:75], v[176:179]
    v_bitop3_b32 v57, v57, v207, s37 bitop3:0xa8
    v_cmp_ne_u32 vcc, 0, v57
    v_mfma_f32_16x16x32_bf16 v[176:179], a[148:151], v[68:71], v[176:179]
    v_mfma_f32_16x16x32_bf16 v[176:179], a[144:147], v[64:67], v[176:179]
    s_waitcnt vmcnt(13)
    s_barrier
    s_cbranch_vccnz k2_tramp_96
k2_ret_97:
k2_dm3_89:
    v_mfma_f32_16x16x32_bf16 v[12:15], v[60:63], v[192:195], v[12:15]
    v_exp_f32 v232, v160
    v_mfma_f32_16x16x32_bf16 v[48:51], v[60:63], v[196:199], v[48:51]
    s_mov_b32 m0, s34
    ds_read_b128 a[208:211], v3 offset:4096
    v_mfma_f32_16x16x32_bf16 v[248:251], v[60:63], v[200:203], v[248:251]
    s_add_u32 s53, s53, 8192
    v_exp_f32 v233, v161
    v_mfma_f32_16x16x32_bf16 v[252:255], v[60:63], v[204:207], v[252:255]
    s_waitcnt lgkmcnt(3)
    buffer_load_dwordx4 v1, s[16:19], s32 offen offset:0 sc1 lds
    v_mfma_f32_16x16x32_bf16 a[12:15], a[192:195], v[204:207], a[12:15]
    s_sub_u32 s40, s36, s38
    s_sub_u32 s40, s40, 64
    v_exp_f32 v234, v162
    v_cvt_pk_bf16_f32 v208, v232, v233
    v_mfma_f32_16x16x32_bf16 a[8:11], a[192:195], v[200:203], a[8:11]
    s_and_b32 s53, s53, 0xffff
    ds_read_b128 a[212:215], v3 offset:5120
    v_subrev_u32 v6, s40, v4
    v_mfma_f32_16x16x32_bf16 a[4:7], a[192:195], v[196:199], a[4:7]
    s_add_u32 s34, s34, 0x4000
    v_exp_f32 v235, v163
    v_cmp_gt_i32 s[44:45], 0, v6
    v_mfma_f32_16x16x32_bf16 a[0:3], a[192:195], v[192:195], a[0:3]
    v_exp_f32 v236, v176
    v_cvt_pk_bf16_f32 v209, v234, v235
    v_mfma_f32_16x16x32_bf16 a[16:19], a[196:199], v[192:195], a[16:19]
    buffer_load_dwordx4 v1, s[16:19], s32 offen offset:1024 sc1 lds
    ds_read_b128 a[216:219], v3 offset:6144
    v_mfma_f32_16x16x32_bf16 a[20:23], a[196:199], v[196:199], a[20:23]
    v_cmp_gt_i32 s[46:47], 1, v6
    v_exp_f32 v237, v177
    v_mfma_f32_16x16x32_bf16 a[24:27], a[196:199], v[200:203], a[24:27]
    v_cmp_gt_i32 s[48:49], 2, v6
    v_exp_f32 v238, v178
    v_mfma_f32_16x16x32_bf16 a[28:31], a[196:199], v[204:207], a[28:31]
    s_waitcnt lgkmcnt(3)
    v_cvt_pk_bf16_f32 v210, v236, v237
    v_cmp_gt_i32 s[50:51], 3, v6
    v_mfma_f32_16x16x32_bf16 a[44:47], a[200:203], v[204:207], a[44:47]
    s_and_b32 s34, s34, 0xffff
    v_exp_f32 v239, v179
    v_mfma_f32_16x16x32_bf16 a[40:43], a[200:203], v[200:203], a[40:43]
    s_and_b32 s60, s62, 31
    ds_read_b128 a[220:223], v3 offset:7168
    v_or3_b32 v57, v208, v209, v210
    v_cndmask_b32 v20, v9, v5, s[44:45]
    v_mfma_f32_16x16x32_bf16 a[36:39], a[200:203], v[196:199], a[36:39]
    buffer_load_dwordx4 v1, s[16:19], s32 offen offset:2048 sc1 lds
    v_mfma_f32_16x16x32_bf16 a[32:35], a[200:203], v[192:195], a[32:35]
    s_lshr_b32 s61, s62, 5
    v_exp_f32 v240, v164
    v_cvt_pk_bf16_f32 v211, v238, v239
    v_mfma_f32_16x16x32_bf16 a[48:51], a[204:207], v[192:195], a[48:51]
    v_cndmask_b32 v21, v9, v5, s[46:47]
    v_add_u32 v3, s53, v56
    v_mfma_f32_16x16x32_bf16 a[52:55], a[204:207], v[196:199], a[52:55]
    s_mul_i32 s57, s60, 229376
    v_exp_f32 v241, v165
    v_mfma_f32_16x16x32_bf16 a[56:59], a[204:207], v[200:203], a[56:59]
    ds_read_b128 a[128:131], v2 offset:0
    v_cndmask_b32 v22, v9, v5, s[48:49]
    v_cvt_pk_bf16_f32 v212, v240, v241
    v_mfma_f32_16x16x32_bf16 a[60:63], a[204:207], v[204:207], a[60:63]
    s_waitcnt lgkmcnt(3)
    v_exp_f32 v242, v166
    v_mfma_f32_16x16x32_bf16 a[76:79], a[208:211], v[204:207], a[76:79]
    s_lshl_b32 s4, s61, 7
    v_cndmask_b32 v23, v9, v5, s[50:51]
    v_or3_b32 v57, v57, v211, v212
    v_mfma_f32_16x16x32_bf16 a[72:75], a[208:211], v[200:203], a[72:75]
    buffer_load_dwordx4 v1, s[16:19], s32 offen offset:3072 sc1 lds
    ds_read_b128 a[132:135], v2 offset:1024
    s_add_u32 s32, s32, 0x80000
    v_mfma_f32_16x16x32_bf16 a[68:71], a[208:211], v[196:199], a[68:71]
    v_exp_f32 v243, v167
    v_mfma_f32_16x16x32_bf16 a[64:67], a[208:211], v[192:195], a[64:67]
    s_add_u32 s57, s57, s4
    v_cmp_gt_i32 s[44:45], 16, v6
    v_cvt_pk_bf16_f32 v213, v242, v243
    v_mfma_f32_16x16x32_bf16 a[80:83], a[212:215], v[192:195], a[80:83]
    s_waitcnt vmcnt(9)
    v_exp_f32 v244, v180
    v_mfma_f32_16x16x32_bf16 a[84:87], a[212:215], v[196:199], a[84:87]
    s_add_u32 s56, s57, 57344
    ds_read_b128 a[136:139], v2 offset:2048
    v_cmp_gt_i32 s[46:47], 17, v6
    v_mfma_f32_16x16x32_bf16 a[88:91], a[212:215], v[200:203], a[88:91]
    v_exp_f32 v245, v181
    v_cmp_gt_i32 s[48:49], 18, v6
    v_mfma_f32_16x16x32_bf16 a[92:95], a[212:215], v[204:207], a[92:95]
    s_waitcnt lgkmcnt(3)
    v_exp_f32 v246, v182
    v_mfma_f32_16x16x32_bf16 a[108:111], a[216:219], v[204:207], a[108:111]
    s_add_u32 s62, s62, 1
    v_cmp_gt_i32 s[50:51], 19, v6
    v_cvt_pk_bf16_f32 v214, v244, v245
    v_mfma_f32_16x16x32_bf16 a[104:107], a[216:219], v[200:203], a[104:107]
    buffer_store_dwordx4 a[224:227], v229, s[8:11], s58 offen offset:0 sc1
    ds_read_b128 a[140:143], v2 offset:3072
    ds_read_b128 a[144:147], v2 offset:4096
    v_mfma_f32_16x16x32_bf16 a[100:103], a[216:219], v[196:199], a[100:103]
    v_exp_f32 v247, v183
    v_mfma_f32_16x16x32_bf16 a[96:99], a[216:219], v[192:195], a[96:99]
    v_cndmask_b32 v36, v9, v5, s[44:45]
    v_or3_b32 v57, v57, v213, v214
    v_mfma_f32_16x16x32_bf16 a[112:115], a[220:223], v[192:195], a[112:115]
    v_exp_f32 v232, v168
    v_mfma_f32_16x16x32_bf16 a[116:119], a[220:223], v[196:199], a[116:119]
    v_cndmask_b32 v37, v9, v5, s[46:47]
    v_cvt_pk_bf16_f32 v215, v246, v247
    v_cndmask_b32 v38, v9, v5, s[48:49]
    v_cndmask_b32 v39, v9, v5, s[50:51]
    v_mfma_f32_16x16x32_bf16 a[120:123], a[220:223], v[200:203], a[120:123]
    v_exp_f32 v233, v169
    v_mfma_f32_16x16x32_bf16 a[124:127], a[220:223], v[204:207], a[124:127]
    s_waitcnt lgkmcnt(3)
    buffer_store_dwordx4 a[228:231], v229, s[8:11], s58 offen offset:256 sc1
    v_exp_f32 v234, v170
    v_mfma_f32_16x16x32_bf16 v[132:135], a[128:131], v[80:83], v[20:23]
    ds_read_b128 a[148:151], v2 offset:5120
    v_cvt_pk_bf16_f32 v216, v232, v233
    v_mfma_f32_16x16x32_bf16 v[132:135], a[132:135], v[84:87], v[132:135]
    s_waitcnt lgkmcnt(2)
    v_exp_f32 v235, v171
    v_mfma_f32_16x16x32_bf16 v[132:135], a[136:139], v[88:91], v[132:135]
    s_lshl_b32 s58, s61, 17
    ds_read_b128 a[152:155], v2 offset:6144
    v_or3_b32 v57, v57, v215, v216
    v_mfma_f32_16x16x32_bf16 v[132:135], a[140:143], v[92:95], v[132:135]
    s_add_u32 s36, s36, 32
    v_exp_f32 v236, v184
    v_mfma_f32_16x16x32_bf16 v[136:139], a[140:143], v[108:111], v[24:27]
    s_lshl_b32 s60, s60, 10
    v_cvt_pk_bf16_f32 v217, v234, v235
    v_exp_f32 v237, v185
    v_mfma_f32_16x16x32_bf16 v[136:139], a[136:139], v[104:107], v[136:139]
    buffer_load_dwordx4 a[224:227], v228, s[12:15], s57 offen nt
    ds_read_b128 a[156:159], v2 offset:7168
    v_mfma_f32_16x16x32_bf16 v[136:139], a[132:135], v[100:103], v[136:139]
    s_add_u32 s52, s52, 8192
    v_exp_f32 v238, v186
    v_mfma_f32_16x16x32_bf16 v[136:139], a[128:131], v[96:99], v[136:139]
    s_add_u32 s58, s58, s60
    v_cvt_pk_bf16_f32 v218, v236, v237
    v_or3_b32 v57, v57, v217, v218
    v_mfma_f32_16x16x32_bf16 v[140:143], a[128:131], v[112:115], v[28:31]
    s_and_b32 s52, s52, 0xffff
    v_exp_f32 v239, v187
    v_mfma_f32_16x16x32_bf16 v[140:143], a[132:135], v[116:119], v[140:143]
    v_add_u32 v2, s52, v1
    v_cvt_pk_bf16_f32 v219, v238, v239
    v_mfma_f32_16x16x32_bf16 v[140:143], a[136:139], v[120:123], v[140:143]
    s_mov_b32 s10, s59
    v_exp_f32 v240, v172
    v_mfma_f32_16x16x32_bf16 v[140:143], a[140:143], v[124:127], v[140:143]
    s_waitcnt lgkmcnt(2)
    ds_read_b128 a[192:195], v3 offset:0
    s_waitcnt lgkmcnt(1)
    v_mfma_f32_16x16x32_bf16 v[156:159], a[156:159], v[124:127], v[44:47]
    v_exp_f32 v241, v173
    v_mfma_f32_16x16x32_bf16 v[156:159], a[152:155], v[120:123], v[156:159]
    buffer_load_dwordx4 a[228:231], v228, s[12:15], s56 offen nt
    v_exp_f32 v242, v174
    v_mfma_f32_16x16x32_bf16 v[156:159], a[148:151], v[116:119], v[156:159]
    ds_read_b128 a[196:199], v3 offset:1024
    v_cvt_pk_bf16_f32 v220, v240, v241
    v_mfma_f32_16x16x32_bf16 v[156:159], a[144:147], v[112:115], v[156:159]
    v_exp_f32 v243, v175
    v_mfma_f32_16x16x32_bf16 v[152:155], a[144:147], v[96:99], v[40:43]
    v_or3_b32 v57, v57, v219, v220
    v_cvt_pk_bf16_f32 v221, v242, v243
    v_mfma_f32_16x16x32_bf16 v[152:155], a[148:151], v[100:103], v[152:155]
    ds_read_b128 a[200:203], v3 offset:2048
    v_exp_f32 v244, v188
    v_mfma_f32_16x16x32_bf16 v[152:155], a[152:155], v[104:107], v[152:155]
    buffer_load_dword v7, v230, s[24:27], s54 offen
    v_exp_f32 v245, v189
    v_mfma_f32_16x16x32_bf16 v[152:155], a[156:159], v[108:111], v[152:155]
    v_exp_f32 v246, v190
    v_mfma_f32_16x16x32_bf16 v[148:151], a[156:159], v[92:95], v[36:39]
    s_add_u32 s54, s54, 4096
    v_cvt_pk_bf16_f32 v222, v244, v245
    v_or3_b32 v57, v57, v221, v222
    v_mfma_f32_16x16x32_bf16 v[148:151], a[152:155], v[88:91], v[148:151]
    v_exp_f32 v247, v191
    v_mfma_f32_16x16x32_bf16 v[148:151], a[148:151], v[84:87], v[148:151]
    ds_read_b128 a[204:207], v3 offset:3072
    v_cvt_pk_bf16_f32 v223, v246, v247
    v_mfma_f32_16x16x32_bf16 v[148:151], a[144:147], v[80:83], v[148:151]
    v_bitop3_b32 v57, v57, v223, s37 bitop3:0xa8
    v_cmp_ne_u32 vcc, 0, v57
    s_cbranch_vccnz k2_tramp_98
k2_ret_99:
    v_mfma_f32_16x16x32_bf16 v[12:15], v[60:63], v[208:211], v[12:15]
    v_exp_f32 v232, v132
    v_mfma_f32_16x16x32_bf16 v[48:51], v[60:63], v[212:215], v[48:51]
    s_mov_b32 m0, s35
    ds_read_b128 a[208:211], v3 offset:4096
    v_mfma_f32_16x16x32_bf16 v[248:251], v[60:63], v[216:219], v[248:251]
    s_add_u32 s53, s53, 8192
    buffer_load_dwordx4 v1, s[20:23], s33 offen offset:0 sc1 lds
    v_mfma_f32_16x16x32_bf16 v[252:255], v[60:63], v[220:223], v[252:255]
    s_waitcnt lgkmcnt(3)
    v_exp_f32 v233, v133
    v_mfma_f32_16x16x32_bf16 a[12:15], a[192:195], v[220:223], a[12:15]
    s_sub_u32 s40, s36, s38
    s_sub_u32 s40, s40, 64
    v_exp_f32 v234, v134
    v_mfma_f32_16x16x32_bf16 a[8:11], a[192:195], v[216:219], a[8:11]
    s_and_b32 s53, s53, 0xffff
    ds_read_b128 a[212:215], v3 offset:5120
    v_subrev_u32 v6, s40, v4
    v_mfma_f32_16x16x32_bf16 a[4:7], a[192:195], v[212:215], a[4:7]
    v_cvt_pk_bf16_f32 v196, v232, v233
    v_cmp_gt_i32 s[44:45], 0, v6
    v_mfma_f32_16x16x32_bf16 a[0:3], a[192:195], v[208:211], a[0:3]
    v_exp_f32 v235, v135
    v_mfma_f32_16x16x32_bf16 a[16:19], a[196:199], v[208:211], a[16:19]
    ds_read_b128 a[216:219], v3 offset:6144
    v_cmp_gt_i32 s[46:47], 1, v6
    v_mfma_f32_16x16x32_bf16 a[20:23], a[196:199], v[212:215], a[20:23]
    v_exp_f32 v236, v148
    v_mfma_f32_16x16x32_bf16 a[24:27], a[196:199], v[216:219], a[24:27]
    v_cvt_pk_bf16_f32 v197, v234, v235
    v_cmp_gt_i32 s[48:49], 2, v6
    v_mfma_f32_16x16x32_bf16 a[28:31], a[196:199], v[220:223], a[28:31]
    s_waitcnt lgkmcnt(3)
    v_cmp_gt_i32 s[50:51], 3, v6
    v_mfma_f32_16x16x32_bf16 a[44:47], a[200:203], v[220:223], a[44:47]
    v_exp_f32 v237, v149
    v_mfma_f32_16x16x32_bf16 a[40:43], a[200:203], v[216:219], a[40:43]
    s_add_u32 s35, s35, 0x4000
    ds_read_b128 a[220:223], v3 offset:7168
    v_cndmask_b32 v20, v9, v5, s[44:45]
    v_mfma_f32_16x16x32_bf16 a[36:39], a[200:203], v[212:215], a[36:39]
    v_exp_f32 v238, v150
    v_mfma_f32_16x16x32_bf16 a[32:35], a[200:203], v[208:211], a[32:35]
    v_cvt_pk_bf16_f32 v198, v236, v237
    v_cndmask_b32 v21, v9, v5, s[46:47]
    v_mfma_f32_16x16x32_bf16 a[48:51], a[204:207], v[208:211], a[48:51]
    buffer_load_dwordx4 v1, s[20:23], s33 offen offset:1024 sc1 lds
    ds_read_b128 a[128:131], v2 offset:0
    v_mfma_f32_16x16x32_bf16 a[52:55], a[204:207], v[212:215], a[52:55]
    v_add_u32 v3, s53, v56
    v_cndmask_b32 v22, v9, v5, s[48:49]
    v_mfma_f32_16x16x32_bf16 a[56:59], a[204:207], v[216:219], a[56:59]
    v_exp_f32 v239, v151
    v_mfma_f32_16x16x32_bf16 a[60:63], a[204:207], v[220:223], a[60:63]
    s_waitcnt lgkmcnt(3)
    v_or3_b32 v57, v196, v197, v198
    v_cndmask_b32 v23, v9, v5, s[50:51]
    v_mfma_f32_16x16x32_bf16 a[76:79], a[208:211], v[220:223], a[76:79]
    v_exp_f32 v240, v136
    v_mfma_f32_16x16x32_bf16 a[72:75], a[208:211], v[216:219], a[72:75]
    v_cvt_pk_bf16_f32 v199, v238, v239
    v_cmp_gt_i32 s[44:45], 16, v6
    v_mfma_f32_16x16x32_bf16 a[68:71], a[208:211], v[212:215], a[68:71]
    ds_read_b128 a[132:135], v2 offset:1024
    v_cmp_gt_i32 s[46:47], 17, v6
    v_mfma_f32_16x16x32_bf16 a[64:67], a[208:211], v[208:211], a[64:67]
    v_exp_f32 v241, v137
    v_mfma_f32_16x16x32_bf16 a[80:83], a[212:215], v[208:211], a[80:83]
    ds_read_b128 a[136:139], v2 offset:2048
    v_cmp_gt_i32 s[48:49], 18, v6
    v_mfma_f32_16x16x32_bf16 a[84:87], a[212:215], v[212:215], a[84:87]
    v_exp_f32 v242, v138
    v_mfma_f32_16x16x32_bf16 a[88:91], a[212:215], v[216:219], a[88:91]
    v_cvt_pk_bf16_f32 v200, v240, v241
    v_cmp_gt_i32 s[50:51], 19, v6
    v_mfma_f32_16x16x32_bf16 a[92:95], a[212:215], v[220:223], a[92:95]
    s_waitcnt lgkmcnt(3)
    v_exp_f32 v243, v139
    v_mfma_f32_16x16x32_bf16 a[108:111], a[216:219], v[220:223], a[108:111]
    s_and_b32 s35, s35, 0xffff
    ds_read_b128 a[140:143], v2 offset:3072
    v_or3_b32 v57, v57, v199, v200
    v_mfma_f32_16x16x32_bf16 a[104:107], a[216:219], v[216:219], a[104:107]
    v_cndmask_b32 v36, v9, v5, s[44:45]
    v_cndmask_b32 v37, v9, v5, s[46:47]
    v_mfma_f32_16x16x32_bf16 a[100:103], a[216:219], v[212:215], a[100:103]
    v_exp_f32 v244, v152
    v_mfma_f32_16x16x32_bf16 a[96:99], a[216:219], v[208:211], a[96:99]
    ds_read_b128 a[144:147], v2 offset:4096
    v_cvt_pk_bf16_f32 v201, v242, v243
    v_mfma_f32_16x16x32_bf16 a[112:115], a[220:223], v[208:211], a[112:115]
    buffer_load_dwordx4 v1, s[20:23], s33 offen offset:2048 sc1 lds
    ds_read_b128 a[148:151], v2 offset:5120
    v_mfma_f32_16x16x32_bf16 a[116:119], a[220:223], v[212:215], a[116:119]
    v_cndmask_b32 v38, v9, v5, s[48:49]
    v_cndmask_b32 v39, v9, v5, s[50:51]
    v_mfma_f32_16x16x32_bf16 a[120:123], a[220:223], v[216:219], a[120:123]
    s_or_b32 s35, s35, 0x10000
    v_exp_f32 v245, v153
    v_mfma_f32_16x16x32_bf16 a[124:127], a[220:223], v[220:223], a[124:127]
    s_waitcnt lgkmcnt(4)
    v_exp_f32 v246, v154
    v_mfma_f32_16x16x32_bf16 v[164:167], a[128:131], v[80:83], v[20:23]
    ds_read_b128 a[152:155], v2 offset:6144
    v_cvt_pk_bf16_f32 v202, v244, v245
    v_mfma_f32_16x16x32_bf16 v[164:167], a[132:135], v[84:87], v[164:167]
    s_waitcnt lgkmcnt(3)
    v_exp_f32 v247, v155
    v_mfma_f32_16x16x32_bf16 v[164:167], a[136:139], v[88:91], v[164:167]
    v_or3_b32 v57, v57, v201, v202
    v_cvt_pk_bf16_f32 v203, v246, v247
    v_mfma_f32_16x16x32_bf16 v[164:167], a[140:143], v[92:95], v[164:167]
    s_add_u32 s36, s36, 32
    v_exp_f32 v232, v140
    v_mfma_f32_16x16x32_bf16 v[168:171], a[140:143], v[108:111], v[24:27]
    ds_read_b128 a[156:159], v2 offset:7168
    v_mfma_f32_16x16x32_bf16 v[168:171], a[136:139], v[104:107], v[168:171]
    v_exp_f32 v233, v141
    v_mfma_f32_16x16x32_bf16 v[168:171], a[132:135], v[100:103], v[168:171]
    s_add_u32 s52, s52, 8192
    v_exp_f32 v234, v142
    v_mfma_f32_16x16x32_bf16 v[168:171], a[128:131], v[96:99], v[168:171]
    ds_read_b128 a[192:195], v3 offset:0
    v_cvt_pk_bf16_f32 v204, v232, v233
    v_mfma_f32_16x16x32_bf16 v[172:175], a[128:131], v[112:115], v[28:31]
    s_and_b32 s52, s52, 0xffff
    v_add_u32 v2, s52, v1
    v_or3_b32 v57, v57, v203, v204
    v_mfma_f32_16x16x32_bf16 v[172:175], a[132:135], v[116:119], v[172:175]
    buffer_load_dwordx4 v1, s[20:23], s33 offen offset:3072 sc1 lds
    s_add_u32 s33, s33, 0x80000
    v_mfma_f32_16x16x32_bf16 v[172:175], a[136:139], v[120:123], v[172:175]
    v_exp_f32 v235, v143
    v_mfma_f32_16x16x32_bf16 v[172:175], a[140:143], v[124:127], v[172:175]
    s_waitcnt lgkmcnt(3)
    ds_read_b128 a[196:199], v3 offset:1024
    s_waitcnt lgkmcnt(2)
    v_mfma_f32_16x16x32_bf16 v[188:191], a[156:159], v[124:127], v[44:47]
    v_exp_f32 v236, v156
    v_mfma_f32_16x16x32_bf16 v[188:191], a[152:155], v[120:123], v[188:191]
    v_cvt_pk_bf16_f32 v205, v234, v235
    v_mfma_f32_16x16x32_bf16 v[188:191], a[148:151], v[116:119], v[188:191]
    v_exp_f32 v237, v157
    v_mfma_f32_16x16x32_bf16 v[188:191], a[144:147], v[112:115], v[188:191]
    ds_read_b128 a[200:203], v3 offset:2048
    v_cvt_pk_bf16_f32 v206, v236, v237
    v_mfma_f32_16x16x32_bf16 v[184:187], a[144:147], v[96:99], v[40:43]
    v_exp_f32 v238, v158
    v_mfma_f32_16x16x32_bf16 v[184:187], a[148:151], v[100:103], v[184:187]
    v_exp_f32 v239, v159
    v_mfma_f32_16x16x32_bf16 v[184:187], a[152:155], v[104:107], v[184:187]
    ds_read_b128 a[204:207], v3 offset:3072
    v_or3_b32 v57, v57, v205, v206
    v_mfma_f32_16x16x32_bf16 v[184:187], a[156:159], v[108:111], v[184:187]
    v_cvt_pk_bf16_f32 v207, v238, v239
    v_mfma_f32_16x16x32_bf16 v[180:183], a[156:159], v[92:95], v[36:39]
    v_mfma_f32_16x16x32_bf16 v[180:183], a[152:155], v[88:91], v[180:183]
    v_bitop3_b32 v57, v57, v207, s37 bitop3:0xa8
    v_cmp_ne_u32 vcc, 0, v57
    v_mfma_f32_16x16x32_bf16 v[180:183], a[148:151], v[84:87], v[180:183]
    v_mfma_f32_16x16x32_bf16 v[180:183], a[144:147], v[80:83], v[180:183]
    s_waitcnt vmcnt(13)
    s_barrier
    s_cbranch_vccnz k2_tramp_100
k2_ret_101:
    v_mfma_f32_16x16x32_bf16 v[48:51], v[60:63], v[196:199], v[48:51]
    ds_read_b128 a[208:211], v3 offset:4096
    ds_read_b128 a[212:215], v3 offset:5120
    v_mfma_f32_16x16x32_bf16 v[248:251], v[60:63], v[200:203], v[248:251]
    s_mov_b32 m0, s34
    v_exp_f32 v232, v164
    v_mfma_f32_16x16x32_bf16 v[252:255], v[60:63], v[204:207], v[252:255]
    s_waitcnt lgkmcnt(4)
    buffer_load_dwordx4 v1, s[16:19], s32 offen offset:0 sc1 lds
    ds_read_b128 a[216:219], v3 offset:6144
    v_mfma_f32_16x16x32_bf16 a[12:15], a[192:195], v[204:207], a[12:15]
    s_add_u32 s53, s53, 8192
    v_exp_f32 v233, v165
    v_mfma_f32_16x16x32_bf16 a[8:11], a[192:195], v[200:203], a[8:11]
    s_and_b32 s53, s53, 0xffff
    v_mov_b32 v16, v10
    v_mov_b32 v17, v10
    v_mfma_f32_16x16x32_bf16 a[4:7], a[192:195], v[196:199], a[4:7]
    s_add_u32 s34, s34, 0x4000
    v_exp_f32 v234, v166
    v_mfma_f32_16x16x32_bf16 a[20:23], a[196:199], v[196:199], a[20:23]
    ds_read_b128 a[220:223], v3 offset:7168
    v_cvt_pk_bf16_f32 v212, v232, v233
    v_mfma_f32_16x16x32_bf16 a[24:27], a[196:199], v[200:203], a[24:27]
    v_mov_b32 v18, v10
    v_mov_b32 v19, v10
    v_mfma_f32_16x16x32_bf16 a[28:31], a[196:199], v[204:207], a[28:31]
    s_waitcnt lgkmcnt(4)
    v_exp_f32 v235, v167
    v_mfma_f32_16x16x32_bf16 a[44:47], a[200:203], v[204:207], a[44:47]
    buffer_load_dwordx4 v1, s[16:19], s32 offen offset:1024 sc1 lds
    ds_read_b128 a[128:131], v2 offset:0
    v_mfma_f32_16x16x32_bf16 a[40:43], a[200:203], v[200:203], a[40:43]
    v_mov_b32 v20, v11
    v_add_u32 v3, s53, v56
    v_mfma_f32_16x16x32_bf16 a[36:39], a[200:203], v[196:199], a[36:39]
    s_and_b32 s34, s34, 0xffff
    v_mov_b32 v21, v11
    v_mov_b32 v22, v11
    v_mfma_f32_16x16x32_bf16 a[52:55], a[204:207], v[196:199], a[52:55]
    v_exp_f32 v236, v180
    v_mfma_f32_16x16x32_bf16 a[56:59], a[204:207], v[200:203], a[56:59]
    ds_read_b128 a[132:135], v2 offset:1024
    v_cvt_pk_bf16_f32 v213, v234, v235
    v_mfma_f32_16x16x32_bf16 a[60:63], a[204:207], v[204:207], a[60:63]
    s_waitcnt lgkmcnt(4)
    v_mov_b32 v23, v11
    v_mov_b32 v32, v10
    v_mfma_f32_16x16x32_bf16 a[76:79], a[208:211], v[204:207], a[76:79]
    v_exp_f32 v237, v181
    v_mfma_f32_16x16x32_bf16 a[72:75], a[208:211], v[200:203], a[72:75]
    ds_read_b128 a[136:139], v2 offset:2048
    v_mov_b32 v33, v10
    v_mfma_f32_16x16x32_bf16 a[68:71], a[208:211], v[196:199], a[68:71]
    buffer_load_dwordx4 v1, s[16:19], s32 offen offset:2048 sc1 lds
    v_mov_b32 v34, v10
    v_mfma_f32_16x16x32_bf16 a[84:87], a[212:215], v[196:199], a[84:87]
    v_exp_f32 v238, v182
    v_mfma_f32_16x16x32_bf16 a[88:91], a[212:215], v[200:203], a[88:91]
    ds_read_b128 a[140:143], v2 offset:3072
    v_cvt_pk_bf16_f32 v214, v236, v237
    v_mfma_f32_16x16x32_bf16 a[92:95], a[212:215], v[204:207], a[92:95]
    s_waitcnt lgkmcnt(4)
    v_mov_b32 v35, v10
    v_mov_b32 v36, v11
    v_mfma_f32_16x16x32_bf16 a[108:111], a[216:219], v[204:207], a[108:111]
    ds_read_b128 a[144:147], v2 offset:4096
    v_exp_f32 v239, v183
    v_mfma_f32_16x16x32_bf16 a[104:107], a[216:219], v[200:203], a[104:107]
    v_mov_b32 v37, v11
    v_or3_b32 v57, v212, v213, v214
    v_mov_b32 v38, v11
    v_mov_b32 v39, v11
    v_mfma_f32_16x16x32_bf16 a[100:103], a[216:219], v[196:199], a[100:103]
    buffer_load_dwordx4 v1, s[16:19], s32 offen offset:3072 sc1 lds
    ds_read_b128 a[148:151], v2 offset:5120
    v_mfma_f32_16x16x32_bf16 a[116:119], a[220:223], v[196:199], a[116:119]
    s_add_u32 s32, s32, 0x80000
    s_cmp_ge_u32 s36, s43
    s_cbranch_scc1 k2_prep_102
k2_prepret_103:
    v_mfma_f32_16x16x32_bf16 a[120:123], a[220:223], v[200:203], a[120:123]
    s_waitcnt vmcnt(9)
    v_exp_f32 v240, v168
    v_mfma_f32_16x16x32_bf16 a[124:127], a[220:223], v[204:207], a[124:127]
    s_waitcnt lgkmcnt(4)
    ds_read_b128 a[152:155], v2 offset:6144
    v_cvt_pk_bf16_f32 v215, v238, v239
    v_mfma_f32_16x16x32_bf16 v[128:131], a[128:131], v[96:99], v[16:19]
    v_exp_f32 v241, v169
    v_mfma_f32_16x16x32_bf16 v[128:131], a[132:135], v[100:103], v[128:131]
    s_waitcnt lgkmcnt(3)
    ds_read_b128 a[156:159], v2 offset:7168
    v_exp_f32 v242, v170
    v_mfma_f32_16x16x32_bf16 v[128:131], a[136:139], v[104:107], v[128:131]
    ds_read_b128 a[160:163], v2 offset:8192
    v_cvt_pk_bf16_f32 v216, v240, v241
    v_mfma_f32_16x16x32_bf16 v[128:131], a[140:143], v[108:111], v[128:131]
    s_add_u32 s36, s36, 64
    buffer_store_dwordx4 a[224:227], v229, s[8:11], s58 offen offset:0 sc1
    v_exp_f32 v243, v171
    v_mfma_f32_16x16x32_bf16 v[132:135], a[140:143], v[124:127], v[20:23]
    ds_read_b128 a[164:167], v2 offset:9216
    v_or3_b32 v57, v57, v215, v216
    v_mfma_f32_16x16x32_bf16 v[132:135], a[136:139], v[120:123], v[132:135]
    v_exp_f32 v244, v184
    v_mfma_f32_16x16x32_bf16 v[132:135], a[132:135], v[116:119], v[132:135]
    s_add_u32 s52, s52, 16384
    ds_read_b128 a[168:171], v2 offset:10240
    v_cvt_pk_bf16_f32 v217, v242, v243
    v_mfma_f32_16x16x32_bf16 v[132:135], a[128:131], v[112:115], v[132:135]
    s_waitcnt lgkmcnt(5)
    v_exp_f32 v245, v185
    v_mfma_f32_16x16x32_bf16 v[148:151], a[144:147], v[112:115], v[36:39]
    s_and_b32 s52, s52, 0xffff
    ds_read_b128 a[172:175], v2 offset:11264
    ds_read_b128 a[176:179], v2 offset:12288
    v_mfma_f32_16x16x32_bf16 v[148:151], a[148:151], v[116:119], v[148:151]
    s_waitcnt lgkmcnt(5)
    v_exp_f32 v246, v186
    v_mfma_f32_16x16x32_bf16 v[148:151], a[152:155], v[120:123], v[148:151]
    ds_read_b128 a[180:183], v2 offset:13312
    v_cvt_pk_bf16_f32 v218, v244, v245
    v_mfma_f32_16x16x32_bf16 v[148:151], a[156:159], v[124:127], v[148:151]
    v_exp_f32 v247, v187
    v_mfma_f32_16x16x32_bf16 v[144:147], a[156:159], v[108:111], v[32:35]
    ds_read_b128 a[184:187], v2 offset:14336
    v_or3_b32 v57, v57, v217, v218
    v_mfma_f32_16x16x32_bf16 v[144:147], a[152:155], v[104:107], v[144:147]
    v_exp_f32 v232, v172
    v_mfma_f32_16x16x32_bf16 v[144:147], a[148:151], v[100:103], v[144:147]
    ds_read_b128 a[188:191], v2 offset:15360
    v_cvt_pk_bf16_f32 v219, v246, v247
    v_mfma_f32_16x16x32_bf16 v[144:147], a[144:147], v[96:99], v[144:147]
    s_waitcnt lgkmcnt(6)
    v_exp_f32 v233, v173
    v_mfma_f32_16x16x32_bf16 v[136:139], a[160:163], v[96:99], v[24:27]
    buffer_store_dwordx4 a[228:231], v229, s[8:11], s58 offen offset:256 sc1
    ds_read_b128 a[192:195], v3 offset:0
    v_mfma_f32_16x16x32_bf16 v[136:139], a[164:167], v[100:103], v[136:139]
    s_waitcnt lgkmcnt(5)
    v_add_u32 v2, s52, v1
    v_cvt_pk_bf16_f32 v220, v232, v233
    v_mfma_f32_16x16x32_bf16 v[136:139], a[168:171], v[104:107], v[136:139]
    v_exp_f32 v234, v174
    v_mfma_f32_16x16x32_bf16 v[136:139], a[172:175], v[108:111], v[136:139]
    v_exp_f32 v235, v175
    v_mfma_f32_16x16x32_bf16 v[140:143], a[172:175], v[124:127], v[28:31]
    ds_read_b128 a[196:199], v3 offset:1024
    v_or3_b32 v57, v57, v219, v220
    v_mfma_f32_16x16x32_bf16 v[140:143], a[168:171], v[120:123], v[140:143]
    v_exp_f32 v236, v188
    v_mfma_f32_16x16x32_bf16 v[140:143], a[164:167], v[116:119], v[140:143]
    ds_read_b128 a[200:203], v3 offset:2048
    v_cvt_pk_bf16_f32 v221, v234, v235
    v_mfma_f32_16x16x32_bf16 v[140:143], a[160:163], v[112:115], v[140:143]
    s_waitcnt lgkmcnt(5)
    v_exp_f32 v237, v189
    v_mfma_f32_16x16x32_bf16 v[156:159], a[176:179], v[112:115], v[44:47]
    v_exp_f32 v238, v190
    v_mfma_f32_16x16x32_bf16 v[156:159], a[180:183], v[116:119], v[156:159]
    s_waitcnt lgkmcnt(3)
    v_cvt_pk_bf16_f32 v222, v236, v237
    v_or3_b32 v57, v57, v221, v222
    v_mfma_f32_16x16x32_bf16 v[156:159], a[184:187], v[120:123], v[156:159]
    v_exp_f32 v239, v191
    v_mfma_f32_16x16x32_bf16 v[156:159], a[188:191], v[124:127], v[156:159]
    ds_read_b128 a[204:207], v3 offset:3072
    v_cvt_pk_bf16_f32 v223, v238, v239
    v_mfma_f32_16x16x32_bf16 v[152:155], a[188:191], v[108:111], v[40:43]
    v_mfma_f32_16x16x32_bf16 v[152:155], a[184:187], v[104:107], v[152:155]
    v_bitop3_b32 v57, v57, v223, s37 bitop3:0xa8
    v_cmp_ne_u32 vcc, 0, v57
    v_mfma_f32_16x16x32_bf16 v[152:155], a[180:183], v[100:103], v[152:155]
    v_mfma_f32_16x16x32_bf16 v[152:155], a[176:179], v[96:99], v[152:155]
    s_cbranch_vccnz k2_tramp_104
k2_ret_105:
    v_mfma_f32_16x16x32_bf16 v[48:51], v[60:63], v[212:215], v[48:51]
    ds_read_b128 a[208:211], v3 offset:4096
    ds_read_b128 a[212:215], v3 offset:5120
    v_mfma_f32_16x16x32_bf16 v[248:251], v[60:63], v[216:219], v[248:251]
    s_mov_b32 m0, s35
    v_exp_f32 v232, v128
    v_mfma_f32_16x16x32_bf16 v[252:255], v[60:63], v[220:223], v[252:255]
    s_waitcnt lgkmcnt(4)
    ds_read_b128 a[216:219], v3 offset:6144
    v_exp_f32 v233, v129
    v_mfma_f32_16x16x32_bf16 a[12:15], a[192:195], v[220:223], a[12:15]
    s_add_u32 s53, s53, 8192
    buffer_load_dwordx4 v1, s[20:23], s33 offen offset:0 sc1 lds
    v_mfma_f32_16x16x32_bf16 a[8:11], a[192:195], v[216:219], a[8:11]
    s_and_b32 s53, s53, 0xffff
    v_exp_f32 v234, v130
    v_cvt_pk_bf16_f32 v192, v232, v233
    v_mfma_f32_16x16x32_bf16 a[4:7], a[192:195], v[212:215], a[4:7]
    ds_read_b128 a[220:223], v3 offset:7168
    v_mfma_f32_16x16x32_bf16 a[20:23], a[196:199], v[212:215], a[20:23]
    s_add_u32 s35, s35, 0x4000
    v_exp_f32 v235, v131
    v_mfma_f32_16x16x32_bf16 a[24:27], a[196:199], v[216:219], a[24:27]
    v_exp_f32 v236, v144
    v_cvt_pk_bf16_f32 v193, v234, v235
    v_mfma_f32_16x16x32_bf16 a[28:31], a[196:199], v[220:223], a[28:31]
    s_waitcnt lgkmcnt(4)
    buffer_load_dwordx4 v1, s[20:23], s33 offen offset:1024 sc1 lds
    ds_read_b128 a[128:131], v2 offset:0
    v_mfma_f32_16x16x32_bf16 a[44:47], a[200:203], v[220:223], a[44:47]
    v_add_u32 v3, s53, v56
    v_exp_f32 v237, v145
    v_mfma_f32_16x16x32_bf16 a[40:43], a[200:203], v[216:219], a[40:43]
    ds_read_b128 a[132:135], v2 offset:1024
    v_cvt_pk_bf16_f32 v194, v236, v237
    v_mfma_f32_16x16x32_bf16 a[36:39], a[200:203], v[212:215], a[36:39]
    ds_read_b128 a[136:139], v2 offset:2048
    v_exp_f32 v238, v146
    v_mfma_f32_16x16x32_bf16 a[52:55], a[204:207], v[212:215], a[52:55]
    s_and_b32 s35, s35, 0xffff
    v_exp_f32 v239, v147
    v_mfma_f32_16x16x32_bf16 a[56:59], a[204:207], v[216:219], a[56:59]
    ds_read_b128 a[140:143], v2 offset:3072
    v_or3_b32 v57, v192, v193, v194
    v_mfma_f32_16x16x32_bf16 a[60:63], a[204:207], v[220:223], a[60:63]
    s_waitcnt lgkmcnt(6)
    v_exp_f32 v240, v132
    v_mfma_f32_16x16x32_bf16 a[76:79], a[208:211], v[220:223], a[76:79]
    s_or_b32 s35, s35, 0x10000
    buffer_load_dwordx4 v1, s[20:23], s33 offen offset:2048 sc1 lds
    ds_read_b128 a[144:147], v2 offset:4096
    v_mfma_f32_16x16x32_bf16 a[72:75], a[208:211], v[216:219], a[72:75]
    v_cvt_pk_bf16_f32 v195, v238, v239
    v_exp_f32 v241, v133
    v_mfma_f32_16x16x32_bf16 a[68:71], a[208:211], v[212:215], a[68:71]
    v_exp_f32 v242, v134
    v_mfma_f32_16x16x32_bf16 a[84:87], a[212:215], v[212:215], a[84:87]
    ds_read_b128 a[148:151], v2 offset:5120
    v_cvt_pk_bf16_f32 v196, v240, v241
    v_mfma_f32_16x16x32_bf16 a[88:91], a[212:215], v[216:219], a[88:91]
    v_exp_f32 v243, v135
    v_mfma_f32_16x16x32_bf16 a[92:95], a[212:215], v[220:223], a[92:95]
    s_waitcnt lgkmcnt(6)
    ds_read_b128 a[152:155], v2 offset:6144
    v_or3_b32 v57, v57, v195, v196
    v_cvt_pk_bf16_f32 v197, v242, v243
    v_mfma_f32_16x16x32_bf16 a[108:111], a[216:219], v[220:223], a[108:111]
    buffer_load_dwordx4 v1, s[20:23], s33 offen offset:3072 sc1 lds
    ds_read_b128 a[156:159], v2 offset:7168
    v_mfma_f32_16x16x32_bf16 a[104:107], a[216:219], v[216:219], a[104:107]
    s_add_u32 s33, s33, 0x80000
    v_exp_f32 v244, v148
    v_mfma_f32_16x16x32_bf16 a[100:103], a[216:219], v[212:215], a[100:103]
    v_exp_f32 v245, v149
    v_mfma_f32_16x16x32_bf16 a[116:119], a[220:223], v[212:215], a[116:119]
    ds_read_b128 a[160:163], v2 offset:8192
    s_cmp_ge_u32 s36, s43
    s_cbranch_scc1 k2_prep_106
k2_prepret_107:
    v_mfma_f32_16x16x32_bf16 a[120:123], a[220:223], v[216:219], a[120:123]
    v_exp_f32 v246, v150
    v_mfma_f32_16x16x32_bf16 a[124:127], a[220:223], v[220:223], a[124:127]
    s_waitcnt lgkmcnt(7)
    ds_read_b128 a[164:167], v2 offset:9216
    v_cvt_pk_bf16_f32 v198, v244, v245
    v_mfma_f32_16x16x32_bf16 v[160:163], a[128:131], v[96:99], v[16:19]
    s_waitcnt vmcnt(12)
    s_barrier
    v_exp_f32 v247, v151
    v_mfma_f32_16x16x32_bf16 v[160:163], a[132:135], v[100:103], v[160:163]
    s_waitcnt lgkmcnt(6)
    v_or3_b32 v57, v57, v197, v198
    v_cvt_pk_bf16_f32 v199, v246, v247
    v_mfma_f32_16x16x32_bf16 v[160:163], a[136:139], v[104:107], v[160:163]
    s_mov_b32 m0, s34
    ds_read_b128 a[168:171], v2 offset:10240
    v_exp_f32 v232, v136
    v_mfma_f32_16x16x32_bf16 v[160:163], a[140:143], v[108:111], v[160:163]
    s_add_u32 s36, s36, 64
    buffer_load_dwordx4 v1, s[16:19], s32 offen offset:0 sc1 lds
    ds_read_b128 a[172:175], v2 offset:11264
    v_mfma_f32_16x16x32_bf16 v[164:167], a[140:143], v[124:127], v[20:23]
    v_exp_f32 v233, v137
    v_mfma_f32_16x16x32_bf16 v[164:167], a[136:139], v[120:123], v[164:167]
    v_exp_f32 v234, v138
    v_mfma_f32_16x16x32_bf16 v[164:167], a[132:135], v[116:119], v[164:167]
    s_add_u32 s52, s52, 16384
    ds_read_b128 a[176:179], v2 offset:12288
    v_cvt_pk_bf16_f32 v200, v232, v233
    v_mfma_f32_16x16x32_bf16 v[164:167], a[128:131], v[112:115], v[164:167]
    s_waitcnt lgkmcnt(7)
    v_exp_f32 v235, v139
    v_or3_b32 v57, v57, v199, v200
    v_mfma_f32_16x16x32_bf16 v[180:183], a[144:147], v[112:115], v[36:39]
    s_add_u32 s34, s34, 0x4000
    ds_read_b128 a[180:183], v2 offset:13312
    v_cvt_pk_bf16_f32 v201, v234, v235
    v_mfma_f32_16x16x32_bf16 v[180:183], a[148:151], v[116:119], v[180:183]
    s_waitcnt lgkmcnt(6)
    v_exp_f32 v236, v152
    v_mfma_f32_16x16x32_bf16 v[180:183], a[152:155], v[120:123], v[180:183]
    s_and_b32 s52, s52, 0xffff
    buffer_load_dwordx4 v1, s[16:19], s32 offen offset:1024 sc1 lds
    ds_read_b128 a[184:187], v2 offset:14336
    v_mfma_f32_16x16x32_bf16 v[180:183], a[156:159], v[124:127], v[180:183]
    ds_read_b128 a[188:191], v2 offset:15360
    v_exp_f32 v237, v153
    v_mfma_f32_16x16x32_bf16 v[176:179], a[156:159], v[108:111], v[32:35]
    v_exp_f32 v238, v154
    v_mfma_f32_16x16x32_bf16 v[176:179], a[152:155], v[104:107], v[176:179]
    v_cvt_pk_bf16_f32 v202, v236, v237
    v_or3_b32 v57, v57, v201, v202
    v_mfma_f32_16x16x32_bf16 v[176:179], a[148:151], v[100:103], v[176:179]
    s_and_b32 s34, s34, 0xffff
    v_exp_f32 v239, v155
    v_mfma_f32_16x16x32_bf16 v[176:179], a[144:147], v[96:99], v[176:179]
    s_waitcnt lgkmcnt(6)
    v_add_u32 v2, s52, v1
    v_cvt_pk_bf16_f32 v203, v238, v239
    v_mfma_f32_16x16x32_bf16 v[168:171], a[160:163], v[96:99], v[24:27]
    ds_read_b128 a[192:195], v3 offset:0
    v_exp_f32 v240, v140
    v_mfma_f32_16x16x32_bf16 v[168:171], a[164:167], v[100:103], v[168:171]
    s_waitcnt lgkmcnt(5)
    v_exp_f32 v241, v141
    v_mfma_f32_16x16x32_bf16 v[168:171], a[168:171], v[104:107], v[168:171]
    buffer_load_dwordx4 v1, s[16:19], s32 offen offset:2048 sc1 lds
    ds_read_b128 a[196:199], v3 offset:8192
    v_mfma_f32_16x16x32_bf16 v[168:171], a[172:175], v[108:111], v[168:171]
    v_exp_f32 v242, v142
    v_mfma_f32_16x16x32_bf16 v[172:175], a[172:175], v[124:127], v[28:31]
    ds_read_b128 a[200:203], v3 offset:1024
    v_cvt_pk_bf16_f32 v204, v240, v241
    v_or3_b32 v57, v57, v203, v204
    v_mfma_f32_16x16x32_bf16 v[172:175], a[168:171], v[120:123], v[172:175]
    v_exp_f32 v243, v143
    v_mfma_f32_16x16x32_bf16 v[172:175], a[164:167], v[116:119], v[172:175]
    ds_read_b128 a[204:207], v3 offset:9216
    v_cvt_pk_bf16_f32 v205, v242, v243
    v_mfma_f32_16x16x32_bf16 v[172:175], a[160:163], v[112:115], v[172:175]
    s_waitcnt lgkmcnt(6)
    v_exp_f32 v244, v156
    v_mfma_f32_16x16x32_bf16 v[188:191], a[176:179], v[112:115], v[44:47]
    v_exp_f32 v245, v157
    v_mfma_f32_16x16x32_bf16 v[188:191], a[180:183], v[116:119], v[188:191]
    s_waitcnt lgkmcnt(4)
    buffer_load_dwordx4 v1, s[16:19], s32 offen offset:3072 sc1 lds
    ds_read_b128 a[208:211], v3 offset:2048
    ds_read_b128 a[212:215], v3 offset:10240
    v_mfma_f32_16x16x32_bf16 v[188:191], a[184:187], v[120:123], v[188:191]
    s_add_u32 s32, s32, 0x80000
    v_exp_f32 v246, v158
    v_mfma_f32_16x16x32_bf16 v[188:191], a[188:191], v[124:127], v[188:191]
    v_cvt_pk_bf16_f32 v206, v244, v245
    v_or3_b32 v57, v57, v205, v206
    v_mfma_f32_16x16x32_bf16 v[184:187], a[188:191], v[108:111], v[40:43]
    v_exp_f32 v247, v159
    v_mfma_f32_16x16x32_bf16 v[184:187], a[184:187], v[104:107], v[184:187]
    ds_read_b128 a[216:219], v3 offset:3072
    ds_read_b128 a[220:223], v3 offset:11264
    v_cvt_pk_bf16_f32 v207, v246, v247
    v_mfma_f32_16x16x32_bf16 v[184:187], a[180:183], v[100:103], v[184:187]
    v_bitop3_b32 v57, v57, v207, s37 bitop3:0xa8
    v_cmp_ne_u32 vcc, 0, v57
    v_mfma_f32_16x16x32_bf16 v[184:187], a[176:179], v[96:99], v[184:187]
    s_cbranch_vccnz k2_tramp_108
k2_ret_109:
    s_load_dwordx2 s[4:5], s[0:1], 40
    s_add_u32 s24, s6, 0x3000000
    s_addc_u32 s25, s7, 0
    s_and_b32 s25, s25, 0xffff
    s_mov_b32 s26, 0x1000000
    s_mov_b32 s27, 0x00020000
    s_lshl_b32 s31, s28, 19
    s_lshl_b32 s44, s38, 6
    s_add_u32 s44, s44, s31
    s_add_u32 s45, s44, 131072
    s_add_u32 s46, s44, 262144
    s_add_u32 s47, s44, 393216
    s_add_u32 s48, s44, 4096
    s_add_u32 s49, s44, 135168
    s_add_u32 s50, s44, 266240
    s_add_u32 s51, s44, 397312
    v_mov_b32 v13, v12
    v_mov_b32 v49, v48
    s_nop 1
    v_permlane16_swap_b32 v12, v13
    v_permlane16_swap_b32 v48, v49
    s_nop 1
    v_add_f32 v12, v12, v13
    v_add_f32 v48, v48, v49
    v_mov_b32 v13, v12
    v_mov_b32 v49, v48
    s_nop 1
    v_permlane32_swap_b32 v12, v13
    v_permlane32_swap_b32 v48, v49
    s_nop 1
    v_add_f32 v12, v12, v13
    v_add_f32 v48, v48, v49
    v_rcp_f32 v13, v12
    v_rcp_f32 v49, v48
    v_rcp_f32 v12, v12
    v_rcp_f32 v48, v48
    s_nop 0
    v_accvgpr_read_b32 v68, a0
    v_accvgpr_read_b32 v69, a1
    v_accvgpr_read_b32 v70, a2
    v_accvgpr_read_b32 v71, a3
    v_accvgpr_read_b32 v72, a16
    v_accvgpr_read_b32 v73, a17
    v_accvgpr_read_b32 v74, a18
    v_accvgpr_read_b32 v75, a19
    v_pk_mul_f32 v[68:69], v[68:69], v[12:13]
    v_pk_mul_f32 v[70:71], v[70:71], v[12:13]
    v_pk_mul_f32 v[72:73], v[72:73], v[12:13]
    v_pk_mul_f32 v[74:75], v[74:75], v[12:13]
    v_cvt_pk_bf16_f32 v64, v68, v69
    v_cvt_pk_bf16_f32 v65, v70, v71
    v_cvt_pk_bf16_f32 v66, v72, v73
    v_cvt_pk_bf16_f32 v67, v74, v75
    buffer_store_dwordx4 v[64:67], v1, s[24:27], s44 offen sc1
    v_accvgpr_read_b32 v80, a32
    v_accvgpr_read_b32 v81, a33
    v_accvgpr_read_b32 v82, a34
    v_accvgpr_read_b32 v83, a35
    v_accvgpr_read_b32 v84, a48
    v_accvgpr_read_b32 v85, a49
    v_accvgpr_read_b32 v86, a50
    v_accvgpr_read_b32 v87, a51
    v_pk_mul_f32 v[80:81], v[80:81], v[12:13]
    v_pk_mul_f32 v[82:83], v[82:83], v[12:13]
    v_pk_mul_f32 v[84:85], v[84:85], v[12:13]
    v_pk_mul_f32 v[86:87], v[86:87], v[12:13]
    v_cvt_pk_bf16_f32 v76, v80, v81
    v_cvt_pk_bf16_f32 v77, v82, v83
    v_cvt_pk_bf16_f32 v78, v84, v85
    v_cvt_pk_bf16_f32 v79, v86, v87
    buffer_store_dwordx4 v[76:79], v1, s[24:27], s45 offen sc1
    v_accvgpr_read_b32 v68, a64
    v_accvgpr_read_b32 v69, a65
    v_accvgpr_read_b32 v70, a66
    v_accvgpr_read_b32 v71, a67
    v_accvgpr_read_b32 v72, a80
    v_accvgpr_read_b32 v73, a81
    v_accvgpr_read_b32 v74, a82
    v_accvgpr_read_b32 v75, a83
    v_pk_mul_f32 v[68:69], v[68:69], v[12:13]
    v_pk_mul_f32 v[70:71], v[70:71], v[12:13]
    v_pk_mul_f32 v[72:73], v[72:73], v[12:13]
    v_pk_mul_f32 v[74:75], v[74:75], v[12:13]
    v_cvt_pk_bf16_f32 v64, v68, v69
    v_cvt_pk_bf16_f32 v65, v70, v71
    v_cvt_pk_bf16_f32 v66, v72, v73
    v_cvt_pk_bf16_f32 v67, v74, v75
    buffer_store_dwordx4 v[64:67], v1, s[24:27], s46 offen sc1
    v_accvgpr_read_b32 v80, a96
    v_accvgpr_read_b32 v81, a97
    v_accvgpr_read_b32 v82, a98
    v_accvgpr_read_b32 v83, a99
    v_accvgpr_read_b32 v84, a112
    v_accvgpr_read_b32 v85, a113
    v_accvgpr_read_b32 v86, a114
    v_accvgpr_read_b32 v87, a115
    v_pk_mul_f32 v[80:81], v[80:81], v[12:13]
    v_pk_mul_f32 v[82:83], v[82:83], v[12:13]
    v_pk_mul_f32 v[84:85], v[84:85], v[12:13]
    v_pk_mul_f32 v[86:87], v[86:87], v[12:13]
    v_cvt_pk_bf16_f32 v76, v80, v81
    v_cvt_pk_bf16_f32 v77, v82, v83
    v_cvt_pk_bf16_f32 v78, v84, v85
    v_cvt_pk_bf16_f32 v79, v86, v87
    buffer_store_dwordx4 v[76:79], v1, s[24:27], s47 offen sc1
    v_accvgpr_read_b32 v68, a4
    v_accvgpr_read_b32 v69, a5
    v_accvgpr_read_b32 v70, a6
    v_accvgpr_read_b32 v71, a7
    v_accvgpr_read_b32 v72, a20
    v_accvgpr_read_b32 v73, a21
    v_accvgpr_read_b32 v74, a22
    v_accvgpr_read_b32 v75, a23
    v_pk_mul_f32 v[68:69], v[68:69], v[48:49]
    v_pk_mul_f32 v[70:71], v[70:71], v[48:49]
    v_pk_mul_f32 v[72:73], v[72:73], v[48:49]
    v_pk_mul_f32 v[74:75], v[74:75], v[48:49]
    v_cvt_pk_bf16_f32 v64, v68, v69
    v_cvt_pk_bf16_f32 v65, v70, v71
    v_cvt_pk_bf16_f32 v66, v72, v73
    v_cvt_pk_bf16_f32 v67, v74, v75
    buffer_store_dwordx4 v[64:67], v1, s[24:27], s48 offen sc1
    v_accvgpr_read_b32 v80, a36
    v_accvgpr_read_b32 v81, a37
    v_accvgpr_read_b32 v82, a38
    v_accvgpr_read_b32 v83, a39
    v_accvgpr_read_b32 v84, a52
    v_accvgpr_read_b32 v85, a53
    v_accvgpr_read_b32 v86, a54
    v_accvgpr_read_b32 v87, a55
    v_pk_mul_f32 v[80:81], v[80:81], v[48:49]
    v_pk_mul_f32 v[82:83], v[82:83], v[48:49]
    v_pk_mul_f32 v[84:85], v[84:85], v[48:49]
    v_pk_mul_f32 v[86:87], v[86:87], v[48:49]
    v_cvt_pk_bf16_f32 v76, v80, v81
    v_cvt_pk_bf16_f32 v77, v82, v83
    v_cvt_pk_bf16_f32 v78, v84, v85
    v_cvt_pk_bf16_f32 v79, v86, v87
    buffer_store_dwordx4 v[76:79], v1, s[24:27], s49 offen sc1
    v_accvgpr_read_b32 v68, a68
    v_accvgpr_read_b32 v69, a69
    v_accvgpr_read_b32 v70, a70
    v_accvgpr_read_b32 v71, a71
    v_accvgpr_read_b32 v72, a84
    v_accvgpr_read_b32 v73, a85
    v_accvgpr_read_b32 v74, a86
    v_accvgpr_read_b32 v75, a87
    v_pk_mul_f32 v[68:69], v[68:69], v[48:49]
    v_pk_mul_f32 v[70:71], v[70:71], v[48:49]
    v_pk_mul_f32 v[72:73], v[72:73], v[48:49]
    v_pk_mul_f32 v[74:75], v[74:75], v[48:49]
    v_cvt_pk_bf16_f32 v64, v68, v69
    v_cvt_pk_bf16_f32 v65, v70, v71
    v_cvt_pk_bf16_f32 v66, v72, v73
    v_cvt_pk_bf16_f32 v67, v74, v75
    buffer_store_dwordx4 v[64:67], v1, s[24:27], s50 offen sc1
    v_accvgpr_read_b32 v80, a100
    v_accvgpr_read_b32 v81, a101
    v_accvgpr_read_b32 v82, a102
    v_accvgpr_read_b32 v83, a103
    v_accvgpr_read_b32 v84, a116
    v_accvgpr_read_b32 v85, a117
    v_accvgpr_read_b32 v86, a118
    v_accvgpr_read_b32 v87, a119
    v_pk_mul_f32 v[80:81], v[80:81], v[48:49]
    v_pk_mul_f32 v[82:83], v[82:83], v[48:49]
    v_pk_mul_f32 v[84:85], v[84:85], v[48:49]
    v_pk_mul_f32 v[86:87], v[86:87], v[48:49]
    v_cvt_pk_bf16_f32 v76, v80, v81
    v_cvt_pk_bf16_f32 v77, v82, v83
    v_cvt_pk_bf16_f32 v78, v84, v85
    v_cvt_pk_bf16_f32 v79, v86, v87
    buffer_store_dwordx4 v[76:79], v1, s[24:27], s51 offen sc1
    s_nop 1
    s_lshr_b32 s31, s2, 3
    s_bfe_u32 s56, s2, 0x10002
    s_and_b32 s54, s2, 1
    s_and_b32 s55, s31, 7
    s_lshl_b32 s54, s54, 3
    s_add_u32 s54, s54, s55
    s_and_b32 s55, s2, 2
    s_lshl_b32 s55, s55, 1
    s_lshr_b32 s31, s31, 3
    s_add_u32 s55, s55, s31
    v_lshrrev_b32 v87, 4, v1
    v_lshrrev_b32 v72, 4, v87
    s_lshl_b32 s57, s54, 7
    s_lshl_b32 s31, s30, 5
    s_add_u32 s57, s57, s31
    s_lshl_b32 s31, s57, 6
    v_add_u32 v88, s31, v1
    v_add_u32 v89, 0x20000, v88
    v_bfe_u32 v84, v87, 1, 3
    v_xor_b32 v84, v84, v72
    v_and_b32 v85, 16, v1
    v_lshl_add_u32 v85, v72, 11, v85
    s_lshl_b32 s31, s30, 15
    s_lshl_b32 s58, s55, 8
    s_add_u32 s31, s31, s58
    v_add_u32 v85, s31, v85
    v_xor_b32 v86, 0, v84
    v_lshl_add_u32 v86, v86, 5, v85
    v_add_u32 v90, 0, v86
    v_xor_b32 v86, 4, v84
    v_lshl_add_u32 v86, v86, 5, v85
    v_add_u32 v91, 7168, v86
    v_xor_b32 v86, 0, v84
    v_lshl_add_u32 v86, v86, 5, v85
    v_add_u32 v92, 14336, v86
    v_xor_b32 v86, 4, v84
    v_lshl_add_u32 v86, v86, 5, v85
    v_add_u32 v93, 21504, v86
    v_and_b32 v84, 15, v87
    v_add_u32 v85, s57, v84
    v_lshlrev_b32 v77, 2, v85
    v_lshl_add_u32 v77, v72, 13, v77
    s_lshl_b32 s31, s56, 7
    s_add_u32 s58, s58, s31
    v_lshl_add_u32 v80, v72, 3, s58
    v_lshl_add_u32 v78, v85, 11, v80
    v_add_u32 v79, 0x8000, v78
    v_lshrrev_b32 v85, 2, v84
    v_lshl_add_u32 v85, v72, 2, v85
    v_and_b32 v84, 7, v85
    s_lshl_b32 s31, s56, 2
    v_xor_b32 v84, s31, v84
    v_lshlrev_b32 v85, 8, v85
    v_and_b32 v86, 3, v87
    v_lshl_add_u32 v85, v86, 3, v85
    s_add_u32 s31, s2, 1
    s_and_b32 s31, s31, 3
    v_add_u32 v73, s31, v86
    v_and_b32 v73, 3, v73
    v_lshlrev_b32 v73, 7, v73
    v_xor_b32 v86, 0, v84
    v_lshl_add_u32 v64, v86, 5, v85
    v_xor_b32 v86, 1, v84
    v_lshl_add_u32 v65, v86, 5, v85
    v_xor_b32 v86, 2, v84
    v_lshl_add_u32 v66, v86, 5, v85
    v_xor_b32 v86, 3, v84
    v_lshl_add_u32 v67, v86, 5, v85
    v_xor_b32 v86, 4, v84
    v_lshl_add_u32 v68, v86, 5, v85
    v_xor_b32 v86, 5, v84
    v_lshl_add_u32 v69, v86, 5, v85
    v_xor_b32 v86, 6, v84
    v_lshl_add_u32 v70, v86, 5, v85
    v_xor_b32 v86, 7, v84
    v_lshl_add_u32 v71, v86, 5, v85
    s_lshl_b32 s61, s31, 20
    s_lshl_b32 s62, s31, 21
    s_lshl_b32 s60, s30, 12
    s_lshl_b32 s59, s54, 10
    s_lshl_b32 s31, s56, 9
    s_add_u32 s59, s59, s31
    s_lshr_b32 s31, s28, 2
    s_lshl_b32 s31, s31, 7
    s_lshl_b32 s57, s29, 10
    s_sub_u32 s58, 0x3c00, s57
    s_add_u32 s57, s57, s31
    s_add_u32 s58, s58, s31
    v_mov_b32 v75, 0
    v_mov_b32 v76, 1
    s_lshl_b32 s31, s56, 23
    s_add_u32 s31, s31, 0x3000000
    s_add_u32 s8, s6, s31
    s_addc_u32 s9, s7, 0
    s_and_b32 s9, s9, 0xffff
    s_mov_b32 s10, 0x800000
    s_lshl_b32 s31, s56, 22
    s_waitcnt lgkmcnt(0)
    s_add_u32 s12, s4, s31
    s_addc_u32 s13, s5, 0
    s_and_b32 s13, s13, 0xffff
    s_mov_b32 s14, 0x400000
    s_load_dwordx2 s[4:5], s[0:1], 80
    v_mov_b32 v12, -1
    v_mov_b32 v13, -1
    v_mov_b32 v14, -1
    v_mov_b32 v15, -1
    s_waitcnt lgkmcnt(0)
    s_mov_b32 s26, -1
    s_lshl_b32 s31, s2, 14
    s_add_u32 s31, s31, s60
    s_add_u32 s40, s31, 0x2000000
    buffer_store_dwordx4 v[12:15], v1, s[24:27], s40 offen offset:0 sc1
    buffer_store_dwordx4 v[12:15], v1, s[24:27], s40 offen offset:1024 sc1
    buffer_store_dwordx4 v[12:15], v1, s[24:27], s40 offen offset:2048 sc1
    buffer_store_dwordx4 v[12:15], v1, s[24:27], s40 offen offset:3072 sc1
    s_lshr_b32 s31, s31, 1
    s_add_u32 s40, s31, 0x1900000
    buffer_store_dwordx4 v[12:15], v1, s[24:27], s40 offen offset:0 sc1
    buffer_store_dwordx4 v[12:15], v1, s[24:27], s40 offen offset:1024 sc1
    s_mov_b32 s26, 0x1000000
    s_and_b32 s31, s2, 7
    s_mul_i32 s31, s31, 28
    s_lshr_b32 s40, s2, 3
    s_add_u32 s31, s31, s40
    s_lshl_b32 s31, s31, 15
    s_lshl_b32 s40, s30, 13
    s_add_u32 s31, s31, s40
    s_mov_b32 s44, s4
    s_mov_b32 s47, 0x00020000
    s_and_b32 s45, s5, 0xffff
    s_cmp_ge_u32 s2, 224
    s_cselect_b32 s46, 0, 7340032
    s_add_u32 m0, s40, 131072
    s_nop 0
    buffer_load_dwordx4 v1, s[44:47], s31 offen offset:0 lds
    buffer_load_dwordx4 v1, s[44:47], s31 offen offset:1024 lds
    buffer_load_dwordx4 v1, s[44:47], s31 offen offset:2048 lds
    buffer_load_dwordx4 v1, s[44:47], s31 offen offset:3072 lds
    s_add_u32 s31, s31, 4096
    s_add_u32 m0, s40, 135168
    s_nop 0
    buffer_load_dwordx4 v1, s[44:47], s31 offen offset:0 lds
    buffer_load_dwordx4 v1, s[44:47], s31 offen offset:1024 lds
    buffer_load_dwordx4 v1, s[44:47], s31 offen offset:2048 lds
    buffer_load_dwordx4 v1, s[44:47], s31 offen offset:3072 lds
    s_add_u32 s31, s31, 4096
    s_lshl_b32 s63, s29, 1
    s_sub_u32 s63, 13, s63
    s_cbranch_scc1 k2_sdone_111
k2_sloop_110:
    v_mfma_f32_16x16x32_bf16 v[248:251], v[60:63], v[192:195], v[248:251]
    v_exp_f32 v232, v160
    v_mfma_f32_16x16x32_bf16 v[248:251], v[60:63], v[200:203], v[248:251]
    s_mov_b32 m0, s35
    ds_read_b128 a[224:227], v3 offset:4096
    v_mfma_f32_16x16x32_bf16 v[252:255], v[60:63], v[204:207], v[252:255]
    s_add_u32 s53, s53, 16384
    buffer_load_dwordx4 v1, s[20:23], s33 offen offset:0 sc1 lds
    ds_read_b128 a[228:231], v3 offset:12288
    v_mfma_f32_16x16x32_bf16 v[252:255], v[60:63], v[196:199], v[252:255]
    s_waitcnt lgkmcnt(8)
    v_exp_f32 v233, v161
    v_mfma_f32_16x16x32_bf16 a[12:15], a[192:195], v[196:199], a[12:15]
    s_and_b32 s53, s53, 0xffff
    v_exp_f32 v234, v162
    v_mfma_f32_16x16x32_bf16 a[12:15], a[196:199], v[204:207], a[12:15]
    ds_read_b128 a[232:235], v3 offset:5120
    v_cvt_pk_bf16_f32 v208, v232, v233
    v_mfma_f32_16x16x32_bf16 a[8:11], a[196:199], v[200:203], a[8:11]
    v_exp_f32 v235, v163
    v_mfma_f32_16x16x32_bf16 a[8:11], a[192:195], v[192:195], a[8:11]
    s_waitcnt lgkmcnt(7)
    ds_read_b128 a[236:239], v3 offset:13312
    v_cvt_pk_bf16_f32 v209, v234, v235
    v_mfma_f32_16x16x32_bf16 a[24:27], a[200:203], v[192:195], a[24:27]
    s_add_u32 s35, s35, 0x4000
    v_exp_f32 v236, v176
    v_mfma_f32_16x16x32_bf16 a[24:27], a[204:207], v[200:203], a[24:27]
    buffer_load_dwordx4 v1, s[20:23], s33 offen offset:1024 sc1 lds
    ds_read_b128 a[240:243], v3 offset:6144
    v_mfma_f32_16x16x32_bf16 a[28:31], a[204:207], v[204:207], a[28:31]
    v_exp_f32 v237, v177
    v_mfma_f32_16x16x32_bf16 a[28:31], a[200:203], v[196:199], a[28:31]
    s_waitcnt lgkmcnt(7)
    ds_read_b128 a[244:247], v3 offset:14336
    v_cvt_pk_bf16_f32 v210, v236, v237
    v_mfma_f32_16x16x32_bf16 a[44:47], a[208:211], v[196:199], a[44:47]
    v_exp_f32 v238, v178
    v_mfma_f32_16x16x32_bf16 a[44:47], a[212:215], v[204:207], a[44:47]
    ds_read_b128 a[248:251], v3 offset:7168
    v_or3_b32 v57, v208, v209, v210
    v_mfma_f32_16x16x32_bf16 a[40:43], a[212:215], v[200:203], a[40:43]
    v_exp_f32 v239, v179
    v_mfma_f32_16x16x32_bf16 a[40:43], a[208:211], v[192:195], a[40:43]
    s_waitcnt lgkmcnt(7)
    ds_read_b128 a[252:255], v3 offset:15360
    v_cvt_pk_bf16_f32 v211, v238, v239
    v_mfma_f32_16x16x32_bf16 a[56:59], a[216:219], v[192:195], a[56:59]
    s_and_b32 s35, s35, 0xffff
    v_exp_f32 v240, v164
    v_mfma_f32_16x16x32_bf16 a[56:59], a[220:223], v[200:203], a[56:59]
    ds_read_b128 a[128:131], v2 offset:0
    v_add_u32 v3, s53, v56
    v_mfma_f32_16x16x32_bf16 a[60:63], a[220:223], v[204:207], a[60:63]
    v_exp_f32 v241, v165
    v_mfma_f32_16x16x32_bf16 a[60:63], a[216:219], v[196:199], a[60:63]
    s_waitcnt lgkmcnt(7)
    buffer_load_dwordx4 v1, s[20:23], s33 offen offset:2048 sc1 lds
    ds_read_b128 a[132:135], v2 offset:1024
    v_mfma_f32_16x16x32_bf16 a[76:79], a[224:227], v[196:199], a[76:79]
    v_exp_f32 v242, v166
    v_mfma_f32_16x16x32_bf16 a[76:79], a[228:231], v[204:207], a[76:79]
    s_or_b32 s35, s35, 0x10000
    ds_read_b128 a[136:139], v2 offset:2048
    v_cvt_pk_bf16_f32 v212, v240, v241
    v_mfma_f32_16x16x32_bf16 a[72:75], a[228:231], v[200:203], a[72:75]
    v_exp_f32 v243, v167
    v_mfma_f32_16x16x32_bf16 a[72:75], a[224:227], v[192:195], a[72:75]
    s_waitcnt lgkmcnt(7)
    ds_read_b128 a[140:143], v2 offset:3072
    v_or3_b32 v57, v57, v211, v212
    v_mfma_f32_16x16x32_bf16 a[88:91], a[232:235], v[192:195], a[88:91]
    v_exp_f32 v244, v180
    v_mfma_f32_16x16x32_bf16 a[88:91], a[236:239], v[200:203], a[88:91]
    ds_read_b128 a[144:147], v2 offset:4096
    v_cvt_pk_bf16_f32 v213, v242, v243
    v_mfma_f32_16x16x32_bf16 a[92:95], a[236:239], v[204:207], a[92:95]
    v_exp_f32 v245, v181
    v_mfma_f32_16x16x32_bf16 a[92:95], a[232:235], v[196:199], a[92:95]
    s_waitcnt lgkmcnt(7)
    buffer_load_dwordx4 v1, s[20:23], s33 offen offset:3072 sc1 lds
    ds_read_b128 a[148:151], v2 offset:5120
    v_mfma_f32_16x16x32_bf16 a[108:111], a[240:243], v[196:199], a[108:111]
    s_add_u32 s33, s33, 0x80000
    v_exp_f32 v246, v182
    v_mfma_f32_16x16x32_bf16 a[108:111], a[244:247], v[204:207], a[108:111]
    ds_read_b128 a[152:155], v2 offset:6144
    v_cvt_pk_bf16_f32 v214, v244, v245
    v_mfma_f32_16x16x32_bf16 a[104:107], a[244:247], v[200:203], a[104:107]
    v_exp_f32 v247, v183
    v_mfma_f32_16x16x32_bf16 a[104:107], a[240:243], v[192:195], a[104:107]
    s_waitcnt lgkmcnt(7)
    ds_read_b128 a[156:159], v2 offset:7168
    v_or3_b32 v57, v57, v213, v214
    v_mfma_f32_16x16x32_bf16 a[120:123], a[248:251], v[192:195], a[120:123]
    v_exp_f32 v232, v168
    v_mfma_f32_16x16x32_bf16 a[120:123], a[252:255], v[200:203], a[120:123]
    ds_read_b128 a[160:163], v2 offset:8192
    v_cvt_pk_bf16_f32 v215, v246, v247
    v_mfma_f32_16x16x32_bf16 a[124:127], a[252:255], v[204:207], a[124:127]
    v_exp_f32 v233, v169
    v_mfma_f32_16x16x32_bf16 a[124:127], a[248:251], v[196:199], a[124:127]
    s_waitcnt lgkmcnt(7)
    ds_read_b128 a[164:167], v2 offset:9216
    v_cvt_pk_bf16_f32 v216, v232, v233
    v_mfma_f32_16x16x32_bf16 v[128:131], a[128:131], v[96:99], v[16:19]
    s_waitcnt vmcnt(12)
    s_barrier
    v_exp_f32 v234, v170
    v_mfma_f32_16x16x32_bf16 v[128:131], a[132:135], v[100:103], v[128:131]
    s_waitcnt lgkmcnt(6)
    ds_read_b128 a[168:171], v2 offset:10240
    v_or3_b32 v57, v57, v215, v216
    v_mfma_f32_16x16x32_bf16 v[128:131], a[136:139], v[104:107], v[128:131]
    s_mov_b32 m0, s34
    v_exp_f32 v235, v171
    v_mfma_f32_16x16x32_bf16 v[128:131], a[140:143], v[108:111], v[128:131]
    s_add_u32 s36, s36, 64
    buffer_load_dwordx4 v1, s[16:19], s32 offen offset:0 sc1 lds
    ds_read_b128 a[172:175], v2 offset:11264
    v_mfma_f32_16x16x32_bf16 v[132:135], a[140:143], v[124:127], v[20:23]
    v_exp_f32 v236, v184
    v_mfma_f32_16x16x32_bf16 v[132:135], a[136:139], v[120:123], v[132:135]
    ds_read_b128 a[176:179], v2 offset:12288
    v_cvt_pk_bf16_f32 v217, v234, v235
    v_mfma_f32_16x16x32_bf16 v[132:135], a[132:135], v[116:119], v[132:135]
    s_add_u32 s52, s52, 16384
    v_exp_f32 v237, v185
    v_mfma_f32_16x16x32_bf16 v[132:135], a[128:131], v[112:115], v[132:135]
    s_waitcnt lgkmcnt(7)
    ds_read_b128 a[180:183], v2 offset:13312
    v_cvt_pk_bf16_f32 v218, v236, v237
    v_mfma_f32_16x16x32_bf16 v[148:151], a[144:147], v[112:115], v[36:39]
    s_add_u32 s34, s34, 0x4000
    v_exp_f32 v238, v186
    v_mfma_f32_16x16x32_bf16 v[148:151], a[148:151], v[116:119], v[148:151]
    s_waitcnt lgkmcnt(6)
    buffer_load_dwordx4 v1, s[16:19], s32 offen offset:1024 sc1 lds
    ds_read_b128 a[184:187], v2 offset:14336
    v_mfma_f32_16x16x32_bf16 v[148:151], a[152:155], v[120:123], v[148:151]
    s_and_b32 s52, s52, 0xffff
    v_exp_f32 v239, v187
    v_mfma_f32_16x16x32_bf16 v[148:151], a[156:159], v[124:127], v[148:151]
    ds_read_b128 a[188:191], v2 offset:15360
    v_or3_b32 v57, v57, v217, v218
    v_mfma_f32_16x16x32_bf16 v[144:147], a[156:159], v[108:111], v[32:35]
    v_exp_f32 v240, v172
    v_mfma_f32_16x16x32_bf16 v[144:147], a[152:155], v[104:107], v[144:147]
    v_cvt_pk_bf16_f32 v219, v238, v239
    v_add_u32 v2, s52, v1
    v_mfma_f32_16x16x32_bf16 v[144:147], a[148:151], v[100:103], v[144:147]
    s_and_b32 s34, s34, 0xffff
    v_exp_f32 v241, v173
    v_mfma_f32_16x16x32_bf16 v[144:147], a[144:147], v[96:99], v[144:147]
    s_waitcnt lgkmcnt(6)
    ds_read_b128 a[192:195], v3 offset:0
    v_cvt_pk_bf16_f32 v220, v240, v241
    v_mfma_f32_16x16x32_bf16 v[136:139], a[160:163], v[96:99], v[24:27]
    v_exp_f32 v242, v174
    v_mfma_f32_16x16x32_bf16 v[136:139], a[164:167], v[100:103], v[136:139]
    s_waitcnt lgkmcnt(5)
    buffer_load_dwordx4 v1, s[16:19], s32 offen offset:2048 sc1 lds
    ds_read_b128 a[196:199], v3 offset:8192
    v_mfma_f32_16x16x32_bf16 v[136:139], a[168:171], v[104:107], v[136:139]
    v_exp_f32 v243, v175
    v_mfma_f32_16x16x32_bf16 v[136:139], a[172:175], v[108:111], v[136:139]
    ds_read_b128 a[200:203], v3 offset:1024
    v_or3_b32 v57, v57, v219, v220
    v_mfma_f32_16x16x32_bf16 v[140:143], a[172:175], v[124:127], v[28:31]
    v_exp_f32 v244, v188
    v_mfma_f32_16x16x32_bf16 v[140:143], a[168:171], v[120:123], v[140:143]
    ds_read_b128 a[204:207], v3 offset:9216
    v_cvt_pk_bf16_f32 v221, v242, v243
    v_mfma_f32_16x16x32_bf16 v[140:143], a[164:167], v[116:119], v[140:143]
    v_exp_f32 v245, v189
    v_mfma_f32_16x16x32_bf16 v[140:143], a[160:163], v[112:115], v[140:143]
    s_waitcnt lgkmcnt(6)
    buffer_load_dwordx4 v1, s[16:19], s32 offen offset:3072 sc1 lds
    ds_read_b128 a[208:211], v3 offset:2048
    v_mfma_f32_16x16x32_bf16 v[156:159], a[176:179], v[112:115], v[44:47]
    s_add_u32 s32, s32, 0x80000
    v_exp_f32 v246, v190
    v_mfma_f32_16x16x32_bf16 v[156:159], a[180:183], v[116:119], v[156:159]
    s_waitcnt lgkmcnt(5)
    ds_read_b128 a[212:215], v3 offset:10240
    v_cvt_pk_bf16_f32 v222, v244, v245
    v_mfma_f32_16x16x32_bf16 v[156:159], a[184:187], v[120:123], v[156:159]
    v_exp_f32 v247, v191
    v_mfma_f32_16x16x32_bf16 v[156:159], a[188:191], v[124:127], v[156:159]
    ds_read_b128 a[216:219], v3 offset:3072
    v_or3_b32 v57, v57, v221, v222
    v_mfma_f32_16x16x32_bf16 v[152:155], a[188:191], v[108:111], v[40:43]
    ds_read_b128 a[220:223], v3 offset:11264
    v_cvt_pk_bf16_f32 v223, v246, v247
    v_mfma_f32_16x16x32_bf16 v[152:155], a[184:187], v[104:107], v[152:155]
    v_bitop3_b32 v57, v57, v223, s37 bitop3:0xa8
    v_cmp_ne_u32 vcc, 0, v57
    v_mfma_f32_16x16x32_bf16 v[152:155], a[180:183], v[100:103], v[152:155]
    v_mfma_f32_16x16x32_bf16 v[152:155], a[176:179], v[96:99], v[152:155]
    s_cbranch_vccnz k2_tramp_112
k2_ret_113:
    v_mfma_f32_16x16x32_bf16 v[248:251], v[60:63], v[208:211], v[248:251]
    v_exp_f32 v232, v128
    v_mfma_f32_16x16x32_bf16 v[248:251], v[60:63], v[216:219], v[248:251]
    s_mov_b32 m0, s35
    ds_read_b128 a[224:227], v3 offset:4096
    v_mfma_f32_16x16x32_bf16 v[252:255], v[60:63], v[220:223], v[252:255]
    s_add_u32 s53, s53, 16384
    buffer_load_dwordx4 v1, s[20:23], s33 offen offset:0 sc1 lds
    ds_read_b128 a[228:231], v3 offset:12288
    v_mfma_f32_16x16x32_bf16 v[252:255], v[60:63], v[212:215], v[252:255]
    s_waitcnt lgkmcnt(8)
    v_exp_f32 v233, v129
    v_mfma_f32_16x16x32_bf16 a[12:15], a[192:195], v[212:215], a[12:15]
    s_and_b32 s53, s53, 0xffff
    v_exp_f32 v234, v130
    v_mfma_f32_16x16x32_bf16 a[12:15], a[196:199], v[220:223], a[12:15]
    ds_read_b128 a[232:235], v3 offset:5120
    v_cvt_pk_bf16_f32 v192, v232, v233
    v_mfma_f32_16x16x32_bf16 a[8:11], a[196:199], v[216:219], a[8:11]
    v_exp_f32 v235, v131
    v_mfma_f32_16x16x32_bf16 a[8:11], a[192:195], v[208:211], a[8:11]
    s_waitcnt lgkmcnt(7)
    ds_read_b128 a[236:239], v3 offset:13312
    v_cvt_pk_bf16_f32 v193, v234, v235
    v_mfma_f32_16x16x32_bf16 a[24:27], a[200:203], v[208:211], a[24:27]
    s_add_u32 s35, s35, 0x4000
    v_exp_f32 v236, v144
    v_mfma_f32_16x16x32_bf16 a[24:27], a[204:207], v[216:219], a[24:27]
    buffer_load_dwordx4 v1, s[20:23], s33 offen offset:1024 sc1 lds
    ds_read_b128 a[240:243], v3 offset:6144
    v_mfma_f32_16x16x32_bf16 a[28:31], a[204:207], v[220:223], a[28:31]
    v_exp_f32 v237, v145
    v_mfma_f32_16x16x32_bf16 a[28:31], a[200:203], v[212:215], a[28:31]
    s_waitcnt lgkmcnt(7)
    ds_read_b128 a[244:247], v3 offset:14336
    v_cvt_pk_bf16_f32 v194, v236, v237
    v_mfma_f32_16x16x32_bf16 a[44:47], a[208:211], v[212:215], a[44:47]
    v_exp_f32 v238, v146
    v_mfma_f32_16x16x32_bf16 a[44:47], a[212:215], v[220:223], a[44:47]
    ds_read_b128 a[248:251], v3 offset:7168
    v_or3_b32 v57, v192, v193, v194
    v_mfma_f32_16x16x32_bf16 a[40:43], a[212:215], v[216:219], a[40:43]
    v_exp_f32 v239, v147
    v_mfma_f32_16x16x32_bf16 a[40:43], a[208:211], v[208:211], a[40:43]
    s_waitcnt lgkmcnt(7)
    ds_read_b128 a[252:255], v3 offset:15360
    v_cvt_pk_bf16_f32 v195, v238, v239
    v_mfma_f32_16x16x32_bf16 a[56:59], a[216:219], v[208:211], a[56:59]
    s_and_b32 s35, s35, 0xffff
    v_exp_f32 v240, v132
    v_mfma_f32_16x16x32_bf16 a[56:59], a[220:223], v[216:219], a[56:59]
    ds_read_b128 a[128:131], v2 offset:0
    v_add_u32 v3, s53, v56
    v_mfma_f32_16x16x32_bf16 a[60:63], a[220:223], v[220:223], a[60:63]
    v_exp_f32 v241, v133
    v_mfma_f32_16x16x32_bf16 a[60:63], a[216:219], v[212:215], a[60:63]
    s_waitcnt lgkmcnt(7)
    buffer_load_dwordx4 v1, s[20:23], s33 offen offset:2048 sc1 lds
    ds_read_b128 a[132:135], v2 offset:1024
    v_mfma_f32_16x16x32_bf16 a[76:79], a[224:227], v[212:215], a[76:79]
    v_exp_f32 v242, v134
    v_mfma_f32_16x16x32_bf16 a[76:79], a[228:231], v[220:223], a[76:79]
    s_or_b32 s35, s35, 0x10000
    ds_read_b128 a[136:139], v2 offset:2048
    v_cvt_pk_bf16_f32 v196, v240, v241
    v_mfma_f32_16x16x32_bf16 a[72:75], a[228:231], v[216:219], a[72:75]
    v_exp_f32 v243, v135
    v_mfma_f32_16x16x32_bf16 a[72:75], a[224:227], v[208:211], a[72:75]
    s_waitcnt lgkmcnt(7)
    ds_read_b128 a[140:143], v2 offset:3072
    v_or3_b32 v57, v57, v195, v196
    v_mfma_f32_16x16x32_bf16 a[88:91], a[232:235], v[208:211], a[88:91]
    v_exp_f32 v244, v148
    v_mfma_f32_16x16x32_bf16 a[88:91], a[236:239], v[216:219], a[88:91]
    ds_read_b128 a[144:147], v2 offset:4096
    v_cvt_pk_bf16_f32 v197, v242, v243
    v_mfma_f32_16x16x32_bf16 a[92:95], a[236:239], v[220:223], a[92:95]
    v_exp_f32 v245, v149
    v_mfma_f32_16x16x32_bf16 a[92:95], a[232:235], v[212:215], a[92:95]
    s_waitcnt lgkmcnt(7)
    buffer_load_dwordx4 v1, s[20:23], s33 offen offset:3072 sc1 lds
    ds_read_b128 a[148:151], v2 offset:5120
    v_mfma_f32_16x16x32_bf16 a[108:111], a[240:243], v[212:215], a[108:111]
    s_add_u32 s33, s33, 0x80000
    v_exp_f32 v246, v150
    v_mfma_f32_16x16x32_bf16 a[108:111], a[244:247], v[220:223], a[108:111]
    ds_read_b128 a[152:155], v2 offset:6144
    v_cvt_pk_bf16_f32 v198, v244, v245
    v_mfma_f32_16x16x32_bf16 a[104:107], a[244:247], v[216:219], a[104:107]
    v_exp_f32 v247, v151
    v_mfma_f32_16x16x32_bf16 a[104:107], a[240:243], v[208:211], a[104:107]
    s_waitcnt lgkmcnt(7)
    ds_read_b128 a[156:159], v2 offset:7168
    v_or3_b32 v57, v57, v197, v198
    v_mfma_f32_16x16x32_bf16 a[120:123], a[248:251], v[208:211], a[120:123]
    v_exp_f32 v232, v136
    v_mfma_f32_16x16x32_bf16 a[120:123], a[252:255], v[216:219], a[120:123]
    ds_read_b128 a[160:163], v2 offset:8192
    v_cvt_pk_bf16_f32 v199, v246, v247
    v_mfma_f32_16x16x32_bf16 a[124:127], a[252:255], v[220:223], a[124:127]
    v_exp_f32 v233, v137
    v_mfma_f32_16x16x32_bf16 a[124:127], a[248:251], v[212:215], a[124:127]
    s_waitcnt lgkmcnt(7)
    ds_read_b128 a[164:167], v2 offset:9216
    v_cvt_pk_bf16_f32 v200, v232, v233
    v_mfma_f32_16x16x32_bf16 v[160:163], a[128:131], v[96:99], v[16:19]
    s_waitcnt vmcnt(12)
    s_barrier
    v_exp_f32 v234, v138
    v_mfma_f32_16x16x32_bf16 v[160:163], a[132:135], v[100:103], v[160:163]
    s_waitcnt lgkmcnt(6)
    ds_read_b128 a[168:171], v2 offset:10240
    v_or3_b32 v57, v57, v199, v200
    v_mfma_f32_16x16x32_bf16 v[160:163], a[136:139], v[104:107], v[160:163]
    s_mov_b32 m0, s34
    v_exp_f32 v235, v139
    v_mfma_f32_16x16x32_bf16 v[160:163], a[140:143], v[108:111], v[160:163]
    s_add_u32 s36, s36, 64
    buffer_load_dwordx4 v1, s[16:19], s32 offen offset:0 sc1 lds
    ds_read_b128 a[172:175], v2 offset:11264
    v_mfma_f32_16x16x32_bf16 v[164:167], a[140:143], v[124:127], v[20:23]
    v_exp_f32 v236, v152
    v_mfma_f32_16x16x32_bf16 v[164:167], a[136:139], v[120:123], v[164:167]
    ds_read_b128 a[176:179], v2 offset:12288
    v_cvt_pk_bf16_f32 v201, v234, v235
    v_mfma_f32_16x16x32_bf16 v[164:167], a[132:135], v[116:119], v[164:167]
    s_add_u32 s52, s52, 16384
    v_exp_f32 v237, v153
    v_mfma_f32_16x16x32_bf16 v[164:167], a[128:131], v[112:115], v[164:167]
    s_waitcnt lgkmcnt(7)
    ds_read_b128 a[180:183], v2 offset:13312
    v_cvt_pk_bf16_f32 v202, v236, v237
    v_mfma_f32_16x16x32_bf16 v[180:183], a[144:147], v[112:115], v[36:39]
    s_add_u32 s34, s34, 0x4000
    v_exp_f32 v238, v154
    v_mfma_f32_16x16x32_bf16 v[180:183], a[148:151], v[116:119], v[180:183]
    s_waitcnt lgkmcnt(6)
    buffer_load_dwordx4 v1, s[16:19], s32 offen offset:1024 sc1 lds
    ds_read_b128 a[184:187], v2 offset:14336
    v_mfma_f32_16x16x32_bf16 v[180:183], a[152:155], v[120:123], v[180:183]
    s_and_b32 s52, s52, 0xffff
    v_exp_f32 v239, v155
    v_mfma_f32_16x16x32_bf16 v[180:183], a[156:159], v[124:127], v[180:183]
    ds_read_b128 a[188:191], v2 offset:15360
    v_or3_b32 v57, v57, v201, v202
    v_mfma_f32_16x16x32_bf16 v[176:179], a[156:159], v[108:111], v[32:35]
    v_exp_f32 v240, v140
    v_mfma_f32_16x16x32_bf16 v[176:179], a[152:155], v[104:107], v[176:179]
    v_cvt_pk_bf16_f32 v203, v238, v239
    v_add_u32 v2, s52, v1
    v_mfma_f32_16x16x32_bf16 v[176:179], a[148:151], v[100:103], v[176:179]
    s_and_b32 s34, s34, 0xffff
    v_exp_f32 v241, v141
    v_mfma_f32_16x16x32_bf16 v[176:179], a[144:147], v[96:99], v[176:179]
    s_waitcnt lgkmcnt(6)
    ds_read_b128 a[192:195], v3 offset:0
    v_cvt_pk_bf16_f32 v204, v240, v241
    v_mfma_f32_16x16x32_bf16 v[168:171], a[160:163], v[96:99], v[24:27]
    v_exp_f32 v242, v142
    v_mfma_f32_16x16x32_bf16 v[168:171], a[164:167], v[100:103], v[168:171]
    s_waitcnt lgkmcnt(5)
    buffer_load_dwordx4 v1, s[16:19], s32 offen offset:2048 sc1 lds
    ds_read_b128 a[196:199], v3 offset:8192
    v_mfma_f32_16x16x32_bf16 v[168:171], a[168:171], v[104:107], v[168:171]
    v_exp_f32 v243, v143
    v_mfma_f32_16x16x32_bf16 v[168:171], a[172:175], v[108:111], v[168:171]
    ds_read_b128 a[200:203], v3 offset:1024
    v_or3_b32 v57, v57, v203, v204
    v_mfma_f32_16x16x32_bf16 v[172:175], a[172:175], v[124:127], v[28:31]
    v_exp_f32 v244, v156
    v_mfma_f32_16x16x32_bf16 v[172:175], a[168:171], v[120:123], v[172:175]
    ds_read_b128 a[204:207], v3 offset:9216
    v_cvt_pk_bf16_f32 v205, v242, v243
    v_mfma_f32_16x16x32_bf16 v[172:175], a[164:167], v[116:119], v[172:175]
    v_exp_f32 v245, v157
    v_mfma_f32_16x16x32_bf16 v[172:175], a[160:163], v[112:115], v[172:175]
    s_waitcnt lgkmcnt(6)
    buffer_load_dwordx4 v1, s[16:19], s32 offen offset:3072 sc1 lds
    ds_read_b128 a[208:211], v3 offset:2048
    v_mfma_f32_16x16x32_bf16 v[188:191], a[176:179], v[112:115], v[44:47]
    s_sub_u32 s63, s63, 1
    v_exp_f32 v246, v158
    v_mfma_f32_16x16x32_bf16 v[188:191], a[180:183], v[116:119], v[188:191]
    s_waitcnt lgkmcnt(5)
    ds_read_b128 a[212:215], v3 offset:10240
    v_cvt_pk_bf16_f32 v206, v244, v245
    v_mfma_f32_16x16x32_bf16 v[188:191], a[184:187], v[120:123], v[188:191]
    s_add_u32 s32, s32, 0x80000
    v_exp_f32 v247, v159
    v_mfma_f32_16x16x32_bf16 v[188:191], a[188:191], v[124:127], v[188:191]
    ds_read_b128 a[216:219], v3 offset:3072
    v_or3_b32 v57, v57, v205, v206
    v_mfma_f32_16x16x32_bf16 v[184:187], a[188:191], v[108:111], v[40:43]
    ds_read_b128 a[220:223], v3 offset:11264
    v_cvt_pk_bf16_f32 v207, v246, v247
    v_mfma_f32_16x16x32_bf16 v[184:187], a[184:187], v[104:107], v[184:187]
    v_bitop3_b32 v57, v57, v207, s37 bitop3:0xa8
    v_cmp_ne_u32 vcc, 0, v57
    v_mfma_f32_16x16x32_bf16 v[184:187], a[180:183], v[100:103], v[184:187]
    v_mfma_f32_16x16x32_bf16 v[184:187], a[176:179], v[96:99], v[184:187]
    s_cbranch_vccnz k2_tramp_114
k2_ret_115:
    s_cmp_lg_u32 s63, 0
    s_cbranch_scc1 k2_sloop_110
    v_mfma_f32_16x16x32_bf16 v[248:251], v[60:63], v[192:195], v[248:251]
    v_exp_f32 v232, v160
    v_mfma_f32_16x16x32_bf16 v[248:251], v[60:63], v[200:203], v[248:251]
    s_mov_b32 m0, s35
    ds_read_b128 a[224:227], v3 offset:4096
    v_exp_f32 v233, v161
    v_mfma_f32_16x16x32_bf16 v[252:255], v[60:63], v[204:207], v[252:255]
    s_add_u32 s53, s53, 16384
    buffer_load_dwordx4 v1, s[20:23], s33 offen offset:0 sc1 lds
    ds_read_b128 a[228:231], v3 offset:12288
    v_mfma_f32_16x16x32_bf16 v[252:255], v[60:63], v[196:199], v[252:255]
    s_waitcnt lgkmcnt(8)
    v_exp_f32 v234, v162
    v_cvt_pk_bf16_f32 v208, v232, v233
    v_mfma_f32_16x16x32_bf16 a[12:15], a[192:195], v[196:199], a[12:15]
    s_sub_u32 s40, s36, s39
    ds_read_b128 a[232:235], v3 offset:5120
    v_mfma_f32_16x16x32_bf16 a[12:15], a[196:199], v[204:207], a[12:15]
    s_and_b32 s53, s53, 0xffff
    v_subrev_u32 v6, s40, v4
    v_cmp_gt_i32 s[44:45], 0, v6
    v_mfma_f32_16x16x32_bf16 a[8:11], a[196:199], v[200:203], a[8:11]
    v_exp_f32 v235, v163
    v_cmp_gt_i32 s[46:47], 1, v6
    v_mfma_f32_16x16x32_bf16 a[8:11], a[192:195], v[192:195], a[8:11]
    s_waitcnt lgkmcnt(7)
    ds_read_b128 a[236:239], v3 offset:13312
    v_cmp_gt_i32 s[48:49], 2, v6
    v_cmp_gt_i32 s[50:51], 3, v6
    v_mfma_f32_16x16x32_bf16 a[24:27], a[200:203], v[192:195], a[24:27]
    s_add_u32 s35, s35, 0x4000
    v_exp_f32 v236, v176
    v_mfma_f32_16x16x32_bf16 a[24:27], a[204:207], v[200:203], a[24:27]
    ds_read_b128 a[240:243], v3 offset:6144
    v_cvt_pk_bf16_f32 v209, v234, v235
    v_cndmask_b32 v16, v10, v5, s[44:45]
    v_mfma_f32_16x16x32_bf16 a[28:31], a[204:207], v[204:207], a[28:31]
    v_exp_f32 v237, v177
    v_mfma_f32_16x16x32_bf16 a[28:31], a[200:203], v[196:199], a[28:31]
    s_waitcnt lgkmcnt(7)
    ds_read_b128 a[244:247], v3 offset:14336
    v_cndmask_b32 v17, v10, v5, s[46:47]
    v_cndmask_b32 v18, v10, v5, s[48:49]
    v_mfma_f32_16x16x32_bf16 a[44:47], a[208:211], v[196:199], a[44:47]
    buffer_load_dwordx4 v1, s[20:23], s33 offen offset:1024 sc1 lds
    ds_read_b128 a[248:251], v3 offset:7168
    v_mfma_f32_16x16x32_bf16 a[44:47], a[212:215], v[204:207], a[44:47]
    v_cndmask_b32 v19, v10, v5, s[50:51]
    v_cvt_pk_bf16_f32 v210, v236, v237
    v_mfma_f32_16x16x32_bf16 a[40:43], a[212:215], v[200:203], a[40:43]
    v_exp_f32 v238, v178
    v_cmp_gt_i32 s[44:45], 16, v6
    v_mfma_f32_16x16x32_bf16 a[40:43], a[208:211], v[192:195], a[40:43]
    s_waitcnt lgkmcnt(7)
    v_cmp_gt_i32 s[46:47], 17, v6
    v_cmp_gt_i32 s[48:49], 18, v6
    v_mfma_f32_16x16x32_bf16 a[56:59], a[216:219], v[192:195], a[56:59]
    s_and_b32 s35, s35, 0xffff
    v_exp_f32 v239, v179
    v_mfma_f32_16x16x32_bf16 a[56:59], a[220:223], v[200:203], a[56:59]
    ds_read_b128 a[252:255], v3 offset:15360
    v_or3_b32 v57, v208, v209, v210
    v_cmp_gt_i32 s[50:51], 19, v6
    v_mfma_f32_16x16x32_bf16 a[60:63], a[220:223], v[204:207], a[60:63]
    v_exp_f32 v240, v164
    v_mfma_f32_16x16x32_bf16 a[60:63], a[216:219], v[196:199], a[60:63]
    s_waitcnt lgkmcnt(6)
    v_cndmask_b32 v32, v10, v5, s[44:45]
    v_cvt_pk_bf16_f32 v211, v238, v239
    v_cndmask_b32 v33, v10, v5, s[46:47]
    v_mfma_f32_16x16x32_bf16 a[76:79], a[224:227], v[196:199], a[76:79]
    ds_read_b128 a[128:131], v2 offset:0
    v_cndmask_b32 v34, v10, v5, s[48:49]
    v_mfma_f32_16x16x32_bf16 a[76:79], a[228:231], v[204:207], a[76:79]
    s_or_b32 s35, s35, 0x10000
    v_add_u32 v3, s53, v56
    v_cndmask_b32 v35, v10, v5, s[50:51]
    v_mfma_f32_16x16x32_bf16 a[72:75], a[228:231], v[200:203], a[72:75]
    buffer_load_dwordx4 v1, s[20:23], s33 offen offset:2048 sc1 lds
    v_exp_f32 v241, v165
    v_mfma_f32_16x16x32_bf16 a[72:75], a[224:227], v[192:195], a[72:75]
    s_waitcnt lgkmcnt(5)
    ds_read_b128 a[132:135], v2 offset:1024
    v_cmp_gt_i32 s[44:45], 32, v6
    v_mfma_f32_16x16x32_bf16 a[88:91], a[232:235], v[192:195], a[88:91]
    v_exp_f32 v242, v166
    v_cmp_gt_i32 s[46:47], 33, v6
    v_mfma_f32_16x16x32_bf16 a[88:91], a[236:239], v[200:203], a[88:91]
    ds_read_b128 a[136:139], v2 offset:2048
    v_cvt_pk_bf16_f32 v212, v240, v241
    v_mfma_f32_16x16x32_bf16 a[92:95], a[236:239], v[204:207], a[92:95]
    v_cmp_gt_i32 s[48:49], 34, v6
    v_cmp_gt_i32 s[50:51], 35, v6
    v_mfma_f32_16x16x32_bf16 a[92:95], a[232:235], v[196:199], a[92:95]
    s_waitcnt lgkmcnt(5)
    v_exp_f32 v243, v167
    v_or3_b32 v57, v57, v211, v212
    v_mfma_f32_16x16x32_bf16 a[108:111], a[240:243], v[196:199], a[108:111]
    ds_read_b128 a[140:143], v2 offset:3072
    v_cndmask_b32 v24, v10, v5, s[44:45]
    v_mfma_f32_16x16x32_bf16 a[108:111], a[244:247], v[204:207], a[108:111]
    v_cndmask_b32 v25, v10, v5, s[46:47]
    v_exp_f32 v244, v180
    v_mfma_f32_16x16x32_bf16 a[104:107], a[244:247], v[200:203], a[104:107]
    v_cvt_pk_bf16_f32 v213, v242, v243
    v_cndmask_b32 v26, v10, v5, s[48:49]
    v_mfma_f32_16x16x32_bf16 a[104:107], a[240:243], v[192:195], a[104:107]
    s_waitcnt lgkmcnt(4)
    ds_read_b128 a[144:147], v2 offset:4096
    v_cndmask_b32 v27, v10, v5, s[50:51]
    v_mfma_f32_16x16x32_bf16 a[120:123], a[248:251], v[192:195], a[120:123]
    v_exp_f32 v245, v181
    v_cmp_gt_i32 s[44:45], 48, v6
    v_mfma_f32_16x16x32_bf16 a[120:123], a[252:255], v[200:203], a[120:123]
    buffer_load_dwordx4 v1, s[20:23], s33 offen offset:3072 sc1 lds
    ds_read_b128 a[148:151], v2 offset:5120
    ds_read_b128 a[152:155], v2 offset:6144
    v_cmp_gt_i32 s[46:47], 49, v6
    s_add_u32 s33, s33, 0x80000
    v_cmp_gt_i32 s[48:49], 50, v6
    v_exp_f32 v246, v182
    v_cvt_pk_bf16_f32 v214, v244, v245
    v_cmp_gt_i32 s[50:51], 51, v6
    v_cndmask_b32 v40, v10, v5, s[44:45]
    v_mfma_f32_16x16x32_bf16 a[124:127], a[252:255], v[204:207], a[124:127]
    v_exp_f32 v247, v183
    v_or3_b32 v57, v57, v213, v214
    v_cndmask_b32 v41, v10, v5, s[46:47]
    v_mfma_f32_16x16x32_bf16 a[124:127], a[248:251], v[196:199], a[124:127]
    s_waitcnt lgkmcnt(5)
    ds_read_b128 a[156:159], v2 offset:7168
    v_cndmask_b32 v42, v10, v5, s[48:49]
    v_cndmask_b32 v43, v10, v5, s[50:51]
    v_mfma_f32_16x16x32_bf16 v[128:131], a[128:131], v[96:99], v[16:19]
    s_waitcnt vmcnt(4)
    s_barrier
    v_exp_f32 v232, v168
    v_mfma_f32_16x16x32_bf16 v[128:131], a[132:135], v[100:103], v[128:131]
    s_waitcnt lgkmcnt(4)
    ds_read_b128 a[160:163], v2 offset:8192
    v_cvt_pk_bf16_f32 v215, v246, v247
    v_mfma_f32_16x16x32_bf16 v[128:131], a[136:139], v[104:107], v[128:131]
    v_exp_f32 v233, v169
    v_mfma_f32_16x16x32_bf16 v[128:131], a[140:143], v[108:111], v[128:131]
    s_add_u32 s36, s36, 64
    ds_read_b128 a[164:167], v2 offset:9216
    v_cvt_pk_bf16_f32 v216, v232, v233
    v_mfma_f32_16x16x32_bf16 v[132:135], a[140:143], v[124:127], v[20:23]
    v_exp_f32 v234, v170
    v_mfma_f32_16x16x32_bf16 v[132:135], a[136:139], v[120:123], v[132:135]
    ds_read_b128 a[168:171], v2 offset:10240
    v_or3_b32 v57, v57, v215, v216
    v_mfma_f32_16x16x32_bf16 v[132:135], a[132:135], v[116:119], v[132:135]
    s_add_u32 s52, s52, 16384
    v_exp_f32 v235, v171
    v_mfma_f32_16x16x32_bf16 v[132:135], a[128:131], v[112:115], v[132:135]
    s_waitcnt lgkmcnt(5)
    ds_read_b128 a[172:175], v2 offset:11264
    v_cvt_pk_bf16_f32 v217, v234, v235
    v_mfma_f32_16x16x32_bf16 v[148:151], a[144:147], v[112:115], v[36:39]
    s_and_b32 s52, s52, 0xffff
    v_exp_f32 v236, v184
    v_mfma_f32_16x16x32_bf16 v[148:151], a[148:151], v[116:119], v[148:151]
    s_waitcnt lgkmcnt(4)
    ds_read_b128 a[176:179], v2 offset:12288
    ds_read_b128 a[180:183], v2 offset:13312
    v_mfma_f32_16x16x32_bf16 v[148:151], a[152:155], v[120:123], v[148:151]
    v_exp_f32 v237, v185
    v_mfma_f32_16x16x32_bf16 v[148:151], a[156:159], v[124:127], v[148:151]
    v_exp_f32 v238, v186
    v_mfma_f32_16x16x32_bf16 v[144:147], a[156:159], v[108:111], v[32:35]
    ds_read_b128 a[184:187], v2 offset:14336
    v_cvt_pk_bf16_f32 v218, v236, v237
    v_mfma_f32_16x16x32_bf16 v[144:147], a[152:155], v[104:107], v[144:147]
    v_exp_f32 v239, v187
    v_mfma_f32_16x16x32_bf16 v[144:147], a[148:151], v[100:103], v[144:147]
    ds_read_b128 a[188:191], v2 offset:15360
    v_or3_b32 v57, v57, v217, v218
    v_mfma_f32_16x16x32_bf16 v[144:147], a[144:147], v[96:99], v[144:147]
    s_waitcnt lgkmcnt(6)
    v_exp_f32 v240, v172
    v_mfma_f32_16x16x32_bf16 v[136:139], a[160:163], v[96:99], v[24:27]
    v_cvt_pk_bf16_f32 v219, v238, v239
    v_add_u32 v2, s52, v1
    v_mfma_f32_16x16x32_bf16 v[136:139], a[164:167], v[100:103], v[136:139]
    s_waitcnt lgkmcnt(4)
    v_exp_f32 v241, v173
    v_mfma_f32_16x16x32_bf16 v[136:139], a[168:171], v[104:107], v[136:139]
    ds_read_b128 a[192:195], v3 offset:0
    v_cvt_pk_bf16_f32 v220, v240, v241
    v_mfma_f32_16x16x32_bf16 v[136:139], a[172:175], v[108:111], v[136:139]
    v_exp_f32 v242, v174
    v_mfma_f32_16x16x32_bf16 v[140:143], a[172:175], v[124:127], v[28:31]
    ds_read_b128 a[196:199], v3 offset:8192
    v_or3_b32 v57, v57, v219, v220
    v_mfma_f32_16x16x32_bf16 v[140:143], a[168:171], v[120:123], v[140:143]
    v_exp_f32 v243, v175
    v_mfma_f32_16x16x32_bf16 v[140:143], a[164:167], v[116:119], v[140:143]
    ds_read_b128 a[200:203], v3 offset:1024
    v_cvt_pk_bf16_f32 v221, v242, v243
    v_mfma_f32_16x16x32_bf16 v[140:143], a[160:163], v[112:115], v[140:143]
    s_waitcnt lgkmcnt(5)
    v_exp_f32 v244, v188
    v_mfma_f32_16x16x32_bf16 v[156:159], a[176:179], v[112:115], v[44:47]
    ds_read_b128 a[204:207], v3 offset:9216
    ds_read_b128 a[208:211], v3 offset:2048
    v_mfma_f32_16x16x32_bf16 v[156:159], a[180:183], v[116:119], v[156:159]
    s_waitcnt lgkmcnt(5)
    v_exp_f32 v245, v189
    v_mfma_f32_16x16x32_bf16 v[156:159], a[184:187], v[120:123], v[156:159]
    v_exp_f32 v246, v190
    v_mfma_f32_16x16x32_bf16 v[156:159], a[188:191], v[124:127], v[156:159]
    ds_read_b128 a[212:215], v3 offset:10240
    v_cvt_pk_bf16_f32 v222, v244, v245
    v_mfma_f32_16x16x32_bf16 v[152:155], a[188:191], v[108:111], v[40:43]
    v_exp_f32 v247, v191
    v_mfma_f32_16x16x32_bf16 v[152:155], a[184:187], v[104:107], v[152:155]
    ds_read_b128 a[216:219], v3 offset:3072
    v_or3_b32 v57, v57, v221, v222
    v_mfma_f32_16x16x32_bf16 v[152:155], a[180:183], v[100:103], v[152:155]
    ds_read_b128 a[220:223], v3 offset:11264
    v_cvt_pk_bf16_f32 v223, v246, v247
    v_bitop3_b32 v57, v57, v223, s37 bitop3:0xa8
    v_mfma_f32_16x16x32_bf16 v[152:155], a[176:179], v[96:99], v[152:155]
    v_cmp_ne_u32 vcc, 0, v57
    s_cbranch_vccnz k2_tramp_116
k2_ret_117:
    v_mfma_f32_16x16x32_bf16 v[248:251], v[60:63], v[208:211], v[248:251]
    ds_read_b128 a[224:227], v3 offset:4096
    v_exp_f32 v232, v128
    v_mfma_f32_16x16x32_bf16 v[248:251], v[60:63], v[216:219], v[248:251]
    v_exp_f32 v233, v129
    v_mfma_f32_16x16x32_bf16 v[252:255], v[60:63], v[220:223], v[252:255]
    s_add_u32 s53, s53, 16384
    ds_read_b128 a[228:231], v3 offset:12288
    v_exp_f32 v234, v130
    v_mfma_f32_16x16x32_bf16 v[252:255], v[60:63], v[212:215], v[252:255]
    s_waitcnt lgkmcnt(8)
    v_cvt_pk_bf16_f32 v192, v232, v233
    v_exp_f32 v235, v131
    v_mfma_f32_16x16x32_bf16 a[12:15], a[192:195], v[212:215], a[12:15]
    s_sub_u32 s40, s36, s39
    s_sub_u32 s40, s40, 64
    ds_read_b128 a[232:235], v3 offset:5120
    v_mfma_f32_16x16x32_bf16 a[12:15], a[196:199], v[220:223], a[12:15]
    s_and_b32 s53, s53, 0xffff
    v_subrev_u32 v6, s40, v4
    v_cmp_gt_i32 s[44:45], 0, v6
    v_cvt_pk_bf16_f32 v193, v234, v235
    v_mfma_f32_16x16x32_bf16 a[8:11], a[196:199], v[216:219], a[8:11]
    v_exp_f32 v236, v144
    v_cmp_gt_i32 s[46:47], 1, v6
    v_mfma_f32_16x16x32_bf16 a[8:11], a[192:195], v[208:211], a[8:11]
    s_waitcnt lgkmcnt(7)
    ds_read_b128 a[236:239], v3 offset:13312
    v_exp_f32 v237, v145
    v_mfma_f32_16x16x32_bf16 a[24:27], a[200:203], v[208:211], a[24:27]
    ds_read_b128 a[240:243], v3 offset:6144
    v_cmp_gt_i32 s[48:49], 2, v6
    v_cmp_gt_i32 s[50:51], 3, v6
    v_mfma_f32_16x16x32_bf16 a[24:27], a[204:207], v[216:219], a[24:27]
    v_exp_f32 v238, v146
    v_cndmask_b32 v20, v11, v5, s[44:45]
    v_mfma_f32_16x16x32_bf16 a[28:31], a[204:207], v[220:223], a[28:31]
    v_cvt_pk_bf16_f32 v194, v236, v237
    v_cndmask_b32 v21, v11, v5, s[46:47]
    v_or3_b32 v57, v192, v193, v194
    v_mfma_f32_16x16x32_bf16 a[28:31], a[200:203], v[212:215], a[28:31]
    s_waitcnt lgkmcnt(7)
    v_exp_f32 v239, v147
    v_cndmask_b32 v22, v11, v5, s[48:49]
    v_mfma_f32_16x16x32_bf16 a[44:47], a[208:211], v[212:215], a[44:47]
    ds_read_b128 a[244:247], v3 offset:14336
    v_cndmask_b32 v23, v11, v5, s[50:51]
    v_cvt_pk_bf16_f32 v195, v238, v239
    v_mfma_f32_16x16x32_bf16 a[44:47], a[212:215], v[220:223], a[44:47]
    v_exp_f32 v240, v132
    v_cmp_gt_i32 s[44:45], 16, v6
    v_mfma_f32_16x16x32_bf16 a[40:43], a[212:215], v[216:219], a[40:43]
    ds_read_b128 a[248:251], v3 offset:7168
    v_cmp_gt_i32 s[46:47], 17, v6
    v_cmp_gt_i32 s[48:49], 18, v6
    v_mfma_f32_16x16x32_bf16 a[40:43], a[208:211], v[208:211], a[40:43]
    s_waitcnt lgkmcnt(7)
    ds_read_b128 a[252:255], v3 offset:15360
    v_exp_f32 v241, v133
    v_mfma_f32_16x16x32_bf16 a[56:59], a[216:219], v[208:211], a[56:59]
    v_exp_f32 v242, v134
    v_cmp_gt_i32 s[50:51], 19, v6
    v_mfma_f32_16x16x32_bf16 a[56:59], a[220:223], v[216:219], a[56:59]
    v_cvt_pk_bf16_f32 v196, v240, v241
    v_cndmask_b32 v36, v11, v5, s[44:45]
    v_or3_b32 v57, v57, v195, v196
    v_mfma_f32_16x16x32_bf16 a[60:63], a[220:223], v[220:223], a[60:63]
    v_exp_f32 v243, v135
    v_cndmask_b32 v37, v11, v5, s[46:47]
    v_mfma_f32_16x16x32_bf16 a[60:63], a[216:219], v[212:215], a[60:63]
    s_waitcnt lgkmcnt(6)
    ds_read_b128 a[128:131], v2 offset:0
    v_cndmask_b32 v38, v11, v5, s[48:49]
    v_add_u32 v3, s53, v56
    v_mfma_f32_16x16x32_bf16 a[76:79], a[224:227], v[212:215], a[76:79]
    ds_read_b128 a[132:135], v2 offset:1024
    v_exp_f32 v244, v148
    v_mfma_f32_16x16x32_bf16 a[76:79], a[228:231], v[220:223], a[76:79]
    ds_read_b128 a[136:139], v2 offset:2048
    v_cvt_pk_bf16_f32 v197, v242, v243
    v_cndmask_b32 v39, v11, v5, s[50:51]
    v_mfma_f32_16x16x32_bf16 a[72:75], a[228:231], v[216:219], a[72:75]
    v_cmp_gt_i32 s[44:45], 32, v6
    v_exp_f32 v245, v149
    v_mfma_f32_16x16x32_bf16 a[72:75], a[224:227], v[208:211], a[72:75]
    s_waitcnt lgkmcnt(7)
    ds_read_b128 a[140:143], v2 offset:3072
    ds_read_b128 a[144:147], v2 offset:4096
    v_cmp_gt_i32 s[46:47], 33, v6
    v_mfma_f32_16x16x32_bf16 a[88:91], a[232:235], v[208:211], a[88:91]
    v_exp_f32 v246, v150
    v_cmp_gt_i32 s[48:49], 34, v6
    v_mfma_f32_16x16x32_bf16 a[88:91], a[236:239], v[216:219], a[88:91]
    ds_read_b128 a[148:151], v2 offset:5120
    v_cvt_pk_bf16_f32 v198, v244, v245
    v_cmp_gt_i32 s[50:51], 35, v6
    v_mfma_f32_16x16x32_bf16 a[92:95], a[236:239], v[220:223], a[92:95]
    v_exp_f32 v247, v151
    v_or3_b32 v57, v57, v197, v198
    v_mfma_f32_16x16x32_bf16 a[92:95], a[232:235], v[212:215], a[92:95]
    s_waitcnt lgkmcnt(8)
    ds_read_b128 a[152:155], v2 offset:6144
    v_cndmask_b32 v28, v11, v5, s[44:45]
    v_cndmask_b32 v29, v11, v5, s[46:47]
    v_mfma_f32_16x16x32_bf16 a[108:111], a[240:243], v[212:215], a[108:111]
    ds_read_b128 a[156:159], v2 offset:7168
    v_exp_f32 v232, v136
    v_mfma_f32_16x16x32_bf16 a[108:111], a[244:247], v[220:223], a[108:111]
    ds_read_b128 a[160:163], v2 offset:8192
    v_cvt_pk_bf16_f32 v199, v246, v247
    v_cndmask_b32 v30, v11, v5, s[48:49]
    v_mfma_f32_16x16x32_bf16 a[104:107], a[244:247], v[216:219], a[104:107]
    v_cndmask_b32 v31, v11, v5, s[50:51]
    v_exp_f32 v233, v137
    v_mfma_f32_16x16x32_bf16 a[104:107], a[240:243], v[208:211], a[104:107]
    s_waitcnt lgkmcnt(9)
    ds_read_b128 a[164:167], v2 offset:9216
    ds_read_b128 a[168:171], v2 offset:10240
    v_cmp_gt_i32 s[44:45], 48, v6
    v_mfma_f32_16x16x32_bf16 a[120:123], a[248:251], v[208:211], a[120:123]
    v_exp_f32 v234, v138
    v_cmp_gt_i32 s[46:47], 49, v6
    v_mfma_f32_16x16x32_bf16 a[120:123], a[252:255], v[216:219], a[120:123]
    ds_read_b128 a[172:175], v2 offset:11264
    ds_read_b128 a[176:179], v2 offset:12288
    v_cvt_pk_bf16_f32 v200, v232, v233
    v_cmp_gt_i32 s[48:49], 50, v6
    v_exp_f32 v235, v139
    v_cmp_gt_i32 s[50:51], 51, v6
    v_or3_b32 v57, v57, v199, v200
    v_cndmask_b32 v44, v11, v5, s[44:45]
    v_mfma_f32_16x16x32_bf16 a[124:127], a[252:255], v[220:223], a[124:127]
    ds_read_b128 a[180:183], v2 offset:13312
    v_exp_f32 v236, v152
    v_cvt_pk_bf16_f32 v201, v234, v235
    v_cndmask_b32 v45, v11, v5, s[46:47]
    v_mfma_f32_16x16x32_bf16 a[124:127], a[248:251], v[212:215], a[124:127]
    s_waitcnt lgkmcnt(12)
    ds_read_b128 a[184:187], v2 offset:14336
    v_cndmask_b32 v46, v11, v5, s[48:49]
    v_cndmask_b32 v47, v11, v5, s[50:51]
    v_mfma_f32_16x16x32_bf16 v[164:167], a[128:131], v[112:115], v[20:23]
    v_exp_f32 v237, v153
    v_mfma_f32_16x16x32_bf16 v[164:167], a[132:135], v[116:119], v[164:167]
    s_waitcnt lgkmcnt(11)
    ds_read_b128 a[188:191], v2 offset:15360
    v_exp_f32 v238, v154
    v_mfma_f32_16x16x32_bf16 v[164:167], a[136:139], v[120:123], v[164:167]
    v_cvt_pk_bf16_f32 v202, v236, v237
    v_exp_f32 v239, v155
    v_mfma_f32_16x16x32_bf16 v[164:167], a[140:143], v[124:127], v[164:167]
    s_waitcnt lgkmcnt(10)
    s_waitcnt lgkmcnt(8)
    v_or3_b32 v57, v57, v201, v202
    v_mfma_f32_16x16x32_bf16 v[180:183], a[156:159], v[124:127], v[36:39]
    s_add_u32 s36, s36, 64
    ds_read_b128 a[192:195], v3 offset:0
    v_exp_f32 v240, v140
    v_mfma_f32_16x16x32_bf16 v[180:183], a[152:155], v[120:123], v[180:183]
    ds_read_b128 a[196:199], v3 offset:8192
    v_cvt_pk_bf16_f32 v203, v238, v239
    v_mfma_f32_16x16x32_bf16 v[180:183], a[148:151], v[116:119], v[180:183]
    s_add_u32 s52, s52, 16384
    ds_read_b128 a[200:203], v3 offset:1024
    v_exp_f32 v241, v141
    v_mfma_f32_16x16x32_bf16 v[180:183], a[144:147], v[112:115], v[180:183]
    s_waitcnt lgkmcnt(9)
    v_exp_f32 v242, v142
    v_cvt_pk_bf16_f32 v204, v240, v241
    v_mfma_f32_16x16x32_bf16 v[172:175], a[160:163], v[112:115], v[28:31]
    s_and_b32 s52, s52, 0xffff
    v_add_u32 v2, s52, v1
    v_exp_f32 v243, v143
    v_mfma_f32_16x16x32_bf16 v[172:175], a[164:167], v[116:119], v[172:175]
    s_waitcnt lgkmcnt(7)
    ds_read_b128 a[204:207], v3 offset:9216
    v_or3_b32 v57, v57, v203, v204
    v_cvt_pk_bf16_f32 v205, v242, v243
    v_mfma_f32_16x16x32_bf16 v[172:175], a[168:171], v[120:123], v[172:175]
    ds_read_b128 a[208:211], v3 offset:2048
    v_exp_f32 v244, v156
    v_mfma_f32_16x16x32_bf16 v[172:175], a[172:175], v[124:127], v[172:175]
    s_waitcnt lgkmcnt(7)
    s_waitcnt lgkmcnt(5)
    v_exp_f32 v245, v157
    v_mfma_f32_16x16x32_bf16 v[188:191], a[188:191], v[124:127], v[44:47]
    ds_read_b128 a[212:215], v3 offset:10240
    v_exp_f32 v246, v158
    v_mfma_f32_16x16x32_bf16 v[188:191], a[184:187], v[120:123], v[188:191]
    v_cvt_pk_bf16_f32 v206, v244, v245
    v_exp_f32 v247, v159
    v_mfma_f32_16x16x32_bf16 v[188:191], a[180:183], v[116:119], v[188:191]
    ds_read_b128 a[216:219], v3 offset:3072
    v_or3_b32 v57, v57, v205, v206
    v_cvt_pk_bf16_f32 v207, v246, v247
    v_mfma_f32_16x16x32_bf16 v[188:191], a[176:179], v[112:115], v[188:191]
    ds_read_b128 a[220:223], v3 offset:11264
    v_bitop3_b32 v57, v57, v207, s37 bitop3:0xa8
    v_cmp_ne_u32 vcc, 0, v57
    s_cbranch_vccnz k2_tramp_118
k2_ret_119:
k2_sdone_111:
    s_add_u32 s16, s6, 0x4811000
    s_addc_u32 s17, s7, 0
    s_and_b32 s17, s17, 0xffff
    s_mov_b32 s18, 0x4000
    s_mov_b32 s19, 0x00020000
    v_mfma_f32_16x16x32_bf16 v[248:251], v[60:63], v[192:195], v[248:251]
    s_waitcnt vmcnt(0)
    s_barrier
    v_exp_f32 v232, v164
    v_mfma_f32_16x16x32_bf16 v[248:251], v[60:63], v[200:203], v[248:251]
    ds_read_b128 a[224:227], v3 offset:4096
    s_cmp_eq_u32 s30, 0
    s_cbranch_scc1 k12_ool_122
k12_oolret_123:
    v_mfma_f32_16x16x32_bf16 v[252:255], v[60:63], v[204:207], v[252:255]
    s_add_u32 m0, s60, 0
    v_exp_f32 v233, v165
    v_mfma_f32_16x16x32_bf16 v[252:255], v[60:63], v[196:199], v[252:255]
    s_waitcnt lgkmcnt(7)
    buffer_load_dwordx4 v90, s[12:15], s61 offen offset:0 lds
    ds_read_b128 a[228:231], v3 offset:12288
    v_mfma_f32_16x16x32_bf16 a[12:15], a[192:195], v[196:199], a[12:15]
    s_add_u32 s53, s53, 16384
    v_exp_f32 v234, v166
    v_cvt_pk_bf16_f32 v212, v232, v233
    v_mfma_f32_16x16x32_bf16 a[12:15], a[196:199], v[204:207], a[12:15]
    s_and_b32 s53, s53, 0xffff
    buffer_load_dwordx4 v91, s[12:15], s61 offen offset:1024 lds
    ds_read_b128 a[232:235], v3 offset:5120
    v_mfma_f32_16x16x32_bf16 a[8:11], a[196:199], v[200:203], a[8:11]
    ds_read_b128 a[236:239], v3 offset:13312
    v_exp_f32 v235, v167
    v_mfma_f32_16x16x32_bf16 a[8:11], a[192:195], v[192:195], a[8:11]
    s_waitcnt lgkmcnt(8)
    v_exp_f32 v236, v180
    v_mfma_f32_16x16x32_bf16 a[24:27], a[200:203], v[192:195], a[24:27]
    buffer_load_dwordx4 v92, s[12:15], s61 offen offset:2048 lds
    ds_read_b128 a[240:243], v3 offset:6144
    v_mfma_f32_16x16x32_bf16 a[24:27], a[204:207], v[200:203], a[24:27]
    v_cvt_pk_bf16_f32 v213, v234, v235
    v_exp_f32 v237, v181
    v_mfma_f32_16x16x32_bf16 a[28:31], a[204:207], v[204:207], a[28:31]
    buffer_load_dwordx4 v93, s[12:15], s61 offen offset:3072 lds
    ds_read_b128 a[244:247], v3 offset:14336
    v_mfma_f32_16x16x32_bf16 a[28:31], a[200:203], v[196:199], a[28:31]
    s_waitcnt lgkmcnt(8)
    v_exp_f32 v238, v182
    v_cvt_pk_bf16_f32 v214, v236, v237
    v_mfma_f32_16x16x32_bf16 a[44:47], a[208:211], v[196:199], a[44:47]
    s_add_u32 s61, s61, 0x20000
    s_and_b32 s61, s61, 0x3fffff
    ds_read_b128 a[248:251], v3 offset:7168
    v_mfma_f32_16x16x32_bf16 a[44:47], a[212:215], v[204:207], a[44:47]
    s_add_u32 m0, s60, 16384
    v_exp_f32 v239, v183
    v_or3_b32 v57, v212, v213, v214
    v_mfma_f32_16x16x32_bf16 a[40:43], a[212:215], v[200:203], a[40:43]
    buffer_load_dwordx4 v90, s[12:15], s61 offen offset:0 lds
    buffer_load_dwordx4 v91, s[12:15], s61 offen offset:1024 lds
    ds_read_b128 a[252:255], v3 offset:15360
    v_mfma_f32_16x16x32_bf16 a[40:43], a[208:211], v[192:195], a[40:43]
    s_waitcnt lgkmcnt(8)
    v_exp_f32 v240, v172
    v_cvt_pk_bf16_f32 v215, v238, v239
    v_mfma_f32_16x16x32_bf16 a[56:59], a[216:219], v[192:195], a[56:59]
    v_mfma_f32_16x16x32_bf16 a[56:59], a[220:223], v[200:203], a[56:59]
    v_add_u32 v3, s53, v56
    ds_read_b128 a[192:195], v3 offset:0
    v_mfma_f32_16x16x32_bf16 a[60:63], a[220:223], v[204:207], a[60:63]
    ds_read_b128 a[196:199], v3 offset:8192
    v_exp_f32 v241, v173
    v_mfma_f32_16x16x32_bf16 a[60:63], a[216:219], v[196:199], a[60:63]
    s_waitcnt lgkmcnt(8)
    buffer_load_dwordx4 v92, s[12:15], s61 offen offset:2048 lds
    buffer_load_dwordx4 v93, s[12:15], s61 offen offset:3072 lds
    ds_read_b128 a[200:203], v3 offset:1024
    v_mfma_f32_16x16x32_bf16 a[76:79], a[224:227], v[196:199], a[76:79]
    v_exp_f32 v242, v174
    v_cvt_pk_bf16_f32 v220, v240, v241
    v_mfma_f32_16x16x32_bf16 a[76:79], a[228:231], v[204:207], a[76:79]
    ds_read_b128 a[204:207], v3 offset:9216
    ds_read_b128 a[208:211], v3 offset:2048
    v_or3_b32 v57, v57, v215, v220
    v_mfma_f32_16x16x32_bf16 a[72:75], a[228:231], v[200:203], a[72:75]
    s_add_u32 s61, s61, 0x20000
    s_and_b32 s61, s61, 0x3fffff
    ds_read_b128 a[212:215], v3 offset:10240
    v_exp_f32 v243, v175
    v_mfma_f32_16x16x32_bf16 a[72:75], a[224:227], v[192:195], a[72:75]
    s_waitcnt lgkmcnt(10)
    ds_read_b128 a[216:219], v3 offset:3072
    s_add_u32 m0, s60, 32768
    v_mfma_f32_16x16x32_bf16 a[88:91], a[232:235], v[192:195], a[88:91]
    buffer_load_dwordx4 v90, s[12:15], s61 offen offset:0 lds
    ds_read_b128 a[220:223], v3 offset:11264
    v_mfma_f32_16x16x32_bf16 a[88:91], a[236:239], v[200:203], a[88:91]
    v_exp_f32 v244, v188
    v_cvt_pk_bf16_f32 v221, v242, v243
    v_mfma_f32_16x16x32_bf16 a[92:95], a[236:239], v[204:207], a[92:95]
    buffer_load_dwordx4 v91, s[12:15], s61 offen offset:1024 lds
    ds_read_b128 a[224:227], v3 offset:4096
    v_mfma_f32_16x16x32_bf16 a[92:95], a[232:235], v[196:199], a[92:95]
    s_waitcnt lgkmcnt(11)
    ds_read_b128 a[228:231], v3 offset:12288
    v_exp_f32 v245, v189
    v_mfma_f32_16x16x32_bf16 a[108:111], a[240:243], v[196:199], a[108:111]
    buffer_load_dwordx4 v92, s[12:15], s61 offen offset:2048 lds
    ds_read_b128 a[232:235], v3 offset:5120
    v_mfma_f32_16x16x32_bf16 a[108:111], a[244:247], v[204:207], a[108:111]
    v_exp_f32 v246, v190
    v_mfma_f32_16x16x32_bf16 a[104:107], a[244:247], v[200:203], a[104:107]
    ds_read_b128 a[236:239], v3 offset:13312
    v_cvt_pk_bf16_f32 v222, v244, v245
    v_or3_b32 v57, v57, v221, v222
    v_mfma_f32_16x16x32_bf16 a[104:107], a[240:243], v[192:195], a[104:107]
    s_waitcnt lgkmcnt(12)
    v_exp_f32 v247, v191
    v_mfma_f32_16x16x32_bf16 a[120:123], a[248:251], v[192:195], a[120:123]
    buffer_load_dwordx4 v93, s[12:15], s61 offen offset:3072 lds
    ds_read_b128 a[240:243], v3 offset:6144
    ds_read_b128 a[244:247], v3 offset:14336
    v_mfma_f32_16x16x32_bf16 a[120:123], a[252:255], v[200:203], a[120:123]
    s_add_u32 s61, s61, 0x20000
    s_and_b32 s61, s61, 0x3fffff
    v_cvt_pk_bf16_f32 v223, v246, v247
    v_bitop3_b32 v57, v57, v223, s37 bitop3:0xa8
    v_mfma_f32_16x16x32_bf16 a[124:127], a[252:255], v[204:207], a[124:127]
    v_cmp_ne_u32 vcc, 0, v57
    v_mfma_f32_16x16x32_bf16 a[124:127], a[248:251], v[196:199], a[124:127]
    buffer_load_dword v74, v73, s[16:19], s59 offen sc1
    ds_read_b128 a[248:251], v3 offset:7168
    ds_read_b128 a[252:255], v3 offset:15360
    s_cbranch_vccnz k2_tramp_120
k2_ret_121:
    v_lshrrev_b32 v6, 4, v1
    v_and_b32 v6, 31, v6
    s_getpc_b64 s[40:41]
pc_124:
    s_add_u32 s40, s40, op_head-pc_124
    s_addc_u32 s41, s41, 0
    v_lshlrev_b32 v224, 7, v6
    v_mov_b32 v225, s41
    v_add_co_u32 v224, vcc, s40, v224
    s_nop 1
    v_addc_co_u32 v225, vcc, 0, v225, vcc
    global_load_dword v7, v[224:225], off
    v_mfma_f32_16x16x32_bf16 v[252:255], v[60:63], v[212:215], v[252:255]
    s_lshl_b32 s31, s28, 19
    v_mov_b32 v249, v248
    s_nop 1
    v_permlane16_swap_b32 v248, v249
    v_mfma_f32_16x16x32_bf16 v[252:255], v[60:63], v[220:223], v[252:255]
    s_waitcnt lgkmcnt(0)
    s_nop 1
    v_add_f32 v248, v248, v249
    v_mov_b32 v249, v248
    v_mfma_f32_16x16x32_bf16 a[12:15], a[196:199], v[220:223], a[12:15]
    s_lshl_b32 s44, s39, 6
    s_nop 1
    v_permlane32_swap_b32 v248, v249
    s_nop 1
    v_mfma_f32_16x16x32_bf16 a[12:15], a[192:195], v[212:215], a[12:15]
    s_add_u32 s44, s44, s31
    s_add_u32 s45, s44, 131072
    v_add_f32 v248, v248, v249
    v_rcp_f32 v249, v248
    v_mfma_f32_16x16x32_bf16 a[28:31], a[200:203], v[212:215], a[28:31]
    s_add_u32 s46, s44, 262144
    v_rcp_f32 v248, v248
    s_nop 0
    s_add_u32 s47, s44, 393216
    v_mfma_f32_16x16x32_bf16 a[28:31], a[204:207], v[220:223], a[28:31]
    s_add_u32 s48, s44, 4096
    v_accvgpr_read_b32 v132, a8
    v_accvgpr_read_b32 v133, a9
    v_accvgpr_read_b32 v134, a10
    v_mfma_f32_16x16x32_bf16 a[44:47], a[212:215], v[220:223], a[44:47]
    s_add_u32 s49, s44, 135168
    v_accvgpr_read_b32 v135, a11
    v_accvgpr_read_b32 v136, a24
    v_accvgpr_read_b32 v137, a25
    v_mfma_f32_16x16x32_bf16 a[44:47], a[208:211], v[212:215], a[44:47]
    s_add_u32 s50, s44, 266240
    v_accvgpr_read_b32 v138, a26
    v_accvgpr_read_b32 v139, a27
    v_mul_f32 v132, v132, v248
    v_mfma_f32_16x16x32_bf16 a[60:63], a[216:219], v[212:215], a[60:63]
    s_add_u32 s51, s44, 397312
    v_mul_f32 v133, v133, v248
    v_mul_f32 v134, v134, v248
    v_mul_f32 v135, v135, v248
    v_mfma_f32_16x16x32_bf16 a[60:63], a[220:223], v[220:223], a[60:63]
    v_mul_f32 v136, v136, v248
    v_mul_f32 v137, v137, v248
    v_mul_f32 v138, v138, v248
    v_mfma_f32_16x16x32_bf16 a[76:79], a[228:231], v[220:223], a[76:79]
    v_mul_f32 v139, v139, v248
    v_cvt_pk_bf16_f32 v128, v132, v133
    v_cvt_pk_bf16_f32 v129, v134, v135
    v_mfma_f32_16x16x32_bf16 a[76:79], a[224:227], v[212:215], a[76:79]
    v_cvt_pk_bf16_f32 v130, v136, v137
    v_cvt_pk_bf16_f32 v131, v138, v139
    buffer_store_dwordx4 v[128:131], v1, s[24:27], s44 offen sc1
    v_mfma_f32_16x16x32_bf16 a[92:95], a[232:235], v[212:215], a[92:95]
    v_accvgpr_read_b32 v144, a40
    v_accvgpr_read_b32 v145, a41
    v_accvgpr_read_b32 v146, a42
    v_mfma_f32_16x16x32_bf16 a[92:95], a[236:239], v[220:223], a[92:95]
    v_accvgpr_read_b32 v147, a43
    v_accvgpr_read_b32 v148, a56
    v_mov_b32 v253, v252
    v_mfma_f32_16x16x32_bf16 a[108:111], a[244:247], v[220:223], a[108:111]
    v_accvgpr_read_b32 v149, a57
    v_accvgpr_read_b32 v150, a58
    s_nop 1
    v_mfma_f32_16x16x32_bf16 a[108:111], a[240:243], v[212:215], a[108:111]
    v_accvgpr_read_b32 v151, a59
    v_permlane16_swap_b32 v252, v253
    v_mul_f32 v144, v144, v248
    v_mfma_f32_16x16x32_bf16 a[124:127], a[248:251], v[212:215], a[124:127]
    s_nop 1
    v_mul_f32 v145, v145, v248
    v_add_f32 v252, v252, v253
    v_mfma_f32_16x16x32_bf16 a[124:127], a[252:255], v[220:223], a[124:127]
    v_mul_f32 v146, v146, v248
    v_mov_b32 v253, v252
    v_mul_f32 v147, v147, v248
    s_nop 1
    v_mul_f32 v148, v148, v248
    v_mul_f32 v149, v149, v248
    v_permlane32_swap_b32 v252, v253
    v_mul_f32 v150, v150, v248
    s_nop 1
    v_mul_f32 v151, v151, v248
    v_add_f32 v252, v252, v253
    v_cvt_pk_bf16_f32 v140, v144, v145
    v_rcp_f32 v253, v252
    v_cvt_pk_bf16_f32 v141, v146, v147
    v_rcp_f32 v252, v252
    v_cvt_pk_bf16_f32 v142, v148, v149
    s_nop 0
    v_cvt_pk_bf16_f32 v143, v150, v151
    buffer_store_dwordx4 v[140:143], v1, s[24:27], s45 offen sc1
    v_accvgpr_read_b32 v156, a72
    v_accvgpr_read_b32 v157, a73
    v_accvgpr_read_b32 v158, a74
    v_accvgpr_read_b32 v159, a75
    v_accvgpr_read_b32 v160, a88
    v_accvgpr_read_b32 v161, a89
    v_accvgpr_read_b32 v162, a90
    v_accvgpr_read_b32 v163, a91
    v_mul_f32 v156, v156, v248
    v_mul_f32 v157, v157, v248
    v_mul_f32 v158, v158, v248
    v_mul_f32 v159, v159, v248
    v_mul_f32 v160, v160, v248
    v_mul_f32 v161, v161, v248
    v_mul_f32 v162, v162, v248
    v_mul_f32 v163, v163, v248
    v_cvt_pk_bf16_f32 v152, v156, v157
    v_cvt_pk_bf16_f32 v153, v158, v159
    v_cvt_pk_bf16_f32 v154, v160, v161
    v_cvt_pk_bf16_f32 v155, v162, v163
    buffer_store_dwordx4 v[152:155], v1, s[24:27], s46 offen sc1
    v_accvgpr_read_b32 v168, a104
    v_accvgpr_read_b32 v169, a105
    v_accvgpr_read_b32 v170, a106
    v_accvgpr_read_b32 v171, a107
    v_accvgpr_read_b32 v172, a120
    v_accvgpr_read_b32 v173, a121
    v_accvgpr_read_b32 v174, a122
    v_accvgpr_read_b32 v175, a123
    v_mul_f32 v168, v168, v248
    v_mul_f32 v169, v169, v248
    v_mul_f32 v170, v170, v248
    v_mul_f32 v171, v171, v248
    v_mul_f32 v172, v172, v248
    v_mul_f32 v173, v173, v248
    v_mul_f32 v174, v174, v248
    v_mul_f32 v175, v175, v248
    v_cvt_pk_bf16_f32 v164, v168, v169
    v_cvt_pk_bf16_f32 v165, v170, v171
    v_cvt_pk_bf16_f32 v166, v172, v173
    v_cvt_pk_bf16_f32 v167, v174, v175
    buffer_store_dwordx4 v[164:167], v1, s[24:27], s47 offen sc1
    v_accvgpr_read_b32 v132, a12
    v_accvgpr_read_b32 v133, a13
    v_accvgpr_read_b32 v134, a14
    v_accvgpr_read_b32 v135, a15
    v_accvgpr_read_b32 v136, a28
    v_accvgpr_read_b32 v137, a29
    v_accvgpr_read_b32 v138, a30
    v_accvgpr_read_b32 v139, a31
    v_pk_mul_f32 v[132:133], v[132:133], v[252:253]
    v_pk_mul_f32 v[134:135], v[134:135], v[252:253]
    v_pk_mul_f32 v[136:137], v[136:137], v[252:253]
    v_pk_mul_f32 v[138:139], v[138:139], v[252:253]
    v_cvt_pk_bf16_f32 v128, v132, v133
    v_cvt_pk_bf16_f32 v129, v134, v135
    v_cvt_pk_bf16_f32 v130, v136, v137
    v_cvt_pk_bf16_f32 v131, v138, v139
    v_accvgpr_read_b32 v144, a44
    v_accvgpr_read_b32 v145, a45
    v_accvgpr_read_b32 v146, a46
    v_accvgpr_read_b32 v147, a47
    v_accvgpr_read_b32 v148, a60
    v_accvgpr_read_b32 v149, a61
    v_accvgpr_read_b32 v150, a62
    v_accvgpr_read_b32 v151, a63
    v_pk_mul_f32 v[144:145], v[144:145], v[252:253]
    v_pk_mul_f32 v[146:147], v[146:147], v[252:253]
    v_pk_mul_f32 v[148:149], v[148:149], v[252:253]
    v_pk_mul_f32 v[150:151], v[150:151], v[252:253]
    v_cvt_pk_bf16_f32 v140, v144, v145
    v_cvt_pk_bf16_f32 v141, v146, v147
    v_cvt_pk_bf16_f32 v142, v148, v149
    v_cvt_pk_bf16_f32 v143, v150, v151
    v_accvgpr_read_b32 v156, a76
    v_accvgpr_read_b32 v157, a77
    v_accvgpr_read_b32 v158, a78
    v_accvgpr_read_b32 v159, a79
    v_accvgpr_read_b32 v160, a92
    v_accvgpr_read_b32 v161, a93
    v_accvgpr_read_b32 v162, a94
    v_accvgpr_read_b32 v163, a95
    v_pk_mul_f32 v[156:157], v[156:157], v[252:253]
    v_pk_mul_f32 v[158:159], v[158:159], v[252:253]
    v_pk_mul_f32 v[160:161], v[160:161], v[252:253]
    v_pk_mul_f32 v[162:163], v[162:163], v[252:253]
    v_cvt_pk_bf16_f32 v152, v156, v157
    v_cvt_pk_bf16_f32 v153, v158, v159
    v_cvt_pk_bf16_f32 v154, v160, v161
    v_cvt_pk_bf16_f32 v155, v162, v163
    v_accvgpr_read_b32 v168, a108
    v_accvgpr_read_b32 v169, a109
    v_accvgpr_read_b32 v170, a110
    v_accvgpr_read_b32 v171, a111
    v_accvgpr_read_b32 v172, a124
    v_accvgpr_read_b32 v173, a125
    v_accvgpr_read_b32 v174, a126
    v_accvgpr_read_b32 v175, a127
    v_pk_mul_f32 v[168:169], v[168:169], v[252:253]
    v_pk_mul_f32 v[170:171], v[170:171], v[252:253]
    v_pk_mul_f32 v[172:173], v[172:173], v[252:253]
    v_pk_mul_f32 v[174:175], v[174:175], v[252:253]
    v_cvt_pk_bf16_f32 v164, v168, v169
    v_cvt_pk_bf16_f32 v165, v170, v171
    v_cvt_pk_bf16_f32 v166, v172, v173
    v_cvt_pk_bf16_f32 v167, v174, v175
    buffer_store_dwordx4 v[128:131], v1, s[24:27], s48 offen sc1
    buffer_store_dwordx4 v[140:143], v1, s[24:27], s49 offen sc1
    buffer_store_dwordx4 v[152:155], v1, s[24:27], s50 offen sc1
    buffer_store_dwordx4 v[164:167], v1, s[24:27], s51 offen sc1
op_head:
    s_load_dwordx2 s[28:29], s[0:1], 0
    s_load_dwordx2 s[42:43], s[0:1], 56
    s_waitcnt vmcnt(8)
    v_cmp_le_u32 vcc, 4, v74
    v_mov_b32 v56, 0
    v_mov_b32 v57, 0
    v_mov_b32 v58, 0
    v_mov_b32 v59, 0
    s_nop 1
    v_mfma_f32_32x32x16_bf16 v[128:143], v[56:59], v[56:59], 0
    v_mfma_f32_32x32x16_bf16 v[144:159], v[56:59], v[56:59], 0
    v_mfma_f32_32x32x16_bf16 v[160:175], v[56:59], v[56:59], 0
    v_mfma_f32_32x32x16_bf16 v[176:191], v[56:59], v[56:59], 0
    s_mov_b32 s33, vcc_lo
    s_bitcmp1_b32 s33, 0
    s_cbranch_scc0 op_late_125
    buffer_load_dwordx4 a[128:131], v88, s[8:11], s62 offen offset:0 sc1
    buffer_load_dwordx4 a[132:135], v88, s[8:11], s62 offen offset:1024 sc1
    buffer_load_dwordx4 a[136:139], v89, s[8:11], s62 offen offset:0 sc1
    buffer_load_dwordx4 a[140:143], v89, s[8:11], s62 offen offset:1024 sc1
    s_add_u32 s62, s62, 0x40000
    s_and_b32 s62, s62, 0x7fffff
    buffer_load_dwordx4 a[144:147], v88, s[8:11], s62 offen offset:0 sc1
    buffer_load_dwordx4 a[148:151], v88, s[8:11], s62 offen offset:1024 sc1
    buffer_load_dwordx4 a[152:155], v89, s[8:11], s62 offen offset:0 sc1
    buffer_load_dwordx4 a[156:159], v89, s[8:11], s62 offen offset:1024 sc1
    s_add_u32 s62, s62, 0x40000
    s_and_b32 s62, s62, 0x7fffff
    buffer_load_dwordx4 a[160:163], v88, s[8:11], s62 offen offset:0 sc1
    buffer_load_dwordx4 a[164:167], v88, s[8:11], s62 offen offset:1024 sc1
    buffer_load_dwordx4 a[168:171], v89, s[8:11], s62 offen offset:0 sc1
    buffer_load_dwordx4 a[172:175], v89, s[8:11], s62 offen offset:1024 sc1
    s_add_u32 s62, s62, 0x40000
    s_and_b32 s62, s62, 0x7fffff
    s_waitcnt vmcnt(12)
    s_branch op_join_126
op_late_125:
    s_waitcnt vmcnt(0)
op_join_126:
    s_barrier
    s_cmp_eq_u32 s30, 0
    s_cbranch_scc1 k12_ool_127
k12_oolret_128:
    s_bitcmp0_b32 s33, 0
    s_cbranch_scc1 k12_ool_131
k12_oolret_132:
    ds_read_b64_tr_b16 a[0:1], v64 offset:0
    ds_read_b64_tr_b16 a[2:3], v64 offset:4096
    ds_read_b64_tr_b16 a[4:5], v65 offset:0
    ds_read_b64_tr_b16 a[6:7], v65 offset:4096
    ds_read_b64_tr_b16 a[8:9], v66 offset:0
    ds_read_b64_tr_b16 a[10:11], v66 offset:4096
    ds_read_b64_tr_b16 a[12:13], v67 offset:0
    ds_read_b64_tr_b16 a[14:15], v67 offset:4096
    ds_read_b64_tr_b16 a[16:17], v68 offset:0
    ds_read_b64_tr_b16 a[18:19], v68 offset:4096
    ds_read_b64_tr_b16 a[20:21], v69 offset:0
    ds_read_b64_tr_b16 a[22:23], v69 offset:4096
    ds_read_b64_tr_b16 a[24:25], v70 offset:0
    ds_read_b64_tr_b16 a[26:27], v70 offset:4096
    ds_read_b64_tr_b16 a[28:29], v71 offset:0
    ds_read_b64_tr_b16 a[30:31], v71 offset:4096
    ds_read_b64_tr_b16 a[32:33], v64 offset:8192
    ds_read_b64_tr_b16 a[34:35], v64 offset:12288
    ds_read_b64_tr_b16 a[36:37], v65 offset:8192
    ds_read_b64_tr_b16 a[38:39], v65 offset:12288
    ds_read_b64_tr_b16 a[40:41], v66 offset:8192
    ds_read_b64_tr_b16 a[42:43], v66 offset:12288
    ds_read_b64_tr_b16 a[44:45], v67 offset:8192
    ds_read_b64_tr_b16 a[46:47], v67 offset:12288
    ds_read_b64_tr_b16 a[48:49], v68 offset:8192
    ds_read_b64_tr_b16 a[50:51], v68 offset:12288
    ds_read_b64_tr_b16 a[52:53], v69 offset:8192
    ds_read_b64_tr_b16 a[54:55], v69 offset:12288
    ds_read_b64_tr_b16 a[56:57], v70 offset:8192
    ds_read_b64_tr_b16 a[58:59], v70 offset:12288
    ds_read_b64_tr_b16 a[60:61], v71 offset:8192
    ds_read_b64_tr_b16 a[62:63], v71 offset:12288
    s_add_u32 s24, s6, 0x4000000
    s_addc_u32 s25, s7, 0
    s_and_b32 s25, s25, 0xffff
    s_mov_b32 s26, 0x400000
    s_mov_b32 s27, 0x00020000
    s_add_u32 s36, s6, 0x5000000
    s_addc_u32 s37, s7, 0
    s_and_b32 s37, s37, 0xffff
    s_mov_b32 s38, 0x800000
    s_mov_b32 s39, 0x00020000
    s_add_u32 s48, s6, 0x4807000
    s_addc_u32 s49, s7, 0
    s_and_b32 s49, s49, 0xffff
    s_mov_b32 s50, 0x8000
    s_mov_b32 s51, 0x00020000
    s_lshl_b32 s52, s2, 14
    s_add_u32 s52, s52, s60
    s_xor_b32 s53, s52, 0x10000
    s_lshl_b32 s57, s2, 7
    s_xor_b32 s58, s57, 0x200
    v_lshrrev_b32 v56, 4, v1
    s_lshl_b32 s31, s30, 6
    s_and_b32 s31, s31, 64
    v_add_u32 v56, s31, v56
    s_mov_b32 s31, (code_end-op_tail)/128
    v_min_u32 v56, s31, v56
    s_getpc_b64 s[40:41]
pc_133:
    s_add_u32 s40, s40, op_tail-pc_133
    s_addc_u32 s41, s41, 0
    v_lshlrev_b32 v82, 7, v56
    v_mov_b32 v83, s41
    v_add_co_u32 v82, vcc, s40, v82
    s_nop 1
    v_addc_co_u32 v83, vcc, 0, v83, vcc
    v_lshlrev_b32 v94, 3, v1
    s_and_b32 s35, s2, 7
    s_mul_i32 s35, s35, 28
    s_lshr_b32 s31, s2, 3
    s_add_u32 s55, s35, s31
    s_lshl_b32 s3, s55, 15
    s_lshl_b32 s31, s30, 13
    s_add_u32 s3, s3, s31
    s_add_u32 s35, s31, 65536
    s_mov_b32 s63, 0
    s_waitcnt vmcnt(8) lgkmcnt(0)
    s_mov_b32 s20, s28
    s_and_b32 s21, s29, 0xffff
    s_mov_b32 s22, 0x400000
    s_mov_b32 s23, 0x00020000
    s_mov_b32 s44, s42
    s_and_b32 s45, s43, 0xffff
    s_mov_b32 s46, 0x800
    s_mov_b32 s47, 0x00020000
op_loop_134:
    v_mfma_f32_16x16x32_bf16 v[160:163], a[16:19], a[128:131], v[160:163]
    s_add_u32 m0, s60, 49152
    ds_read_b64_tr_b16 a[64:65], v64 offset:16384
    ds_read_b64_tr_b16 a[66:67], v64 offset:20480
    v_mfma_f32_16x16x32_bf16 v[160:163], a[48:51], a[136:139], v[160:163]
    buffer_load_dwordx4 v90, s[12:15], s61 offen offset:0 lds
    ds_read_b64_tr_b16 a[68:69], v65 offset:16384
    v_mfma_f32_16x16x32_bf16 v[164:167], a[48:51], a[140:143], v[164:167]
    ds_read_b64_tr_b16 a[70:71], v65 offset:20480
    ds_read_b64_tr_b16 a[72:73], v66 offset:16384
    v_mfma_f32_16x16x32_bf16 v[164:167], a[16:19], a[132:135], v[164:167]
    buffer_load_dwordx4 v91, s[12:15], s61 offen offset:1024 lds
    ds_read_b64_tr_b16 a[74:75], v66 offset:20480
    v_mfma_f32_16x16x32_bf16 v[172:175], a[20:23], a[132:135], v[172:175]
    ds_read_b64_tr_b16 a[76:77], v67 offset:16384
    ds_read_b64_tr_b16 a[78:79], v67 offset:20480
    v_mfma_f32_16x16x32_bf16 v[172:175], a[52:55], a[140:143], v[172:175]
    ds_read_b64_tr_b16 a[80:81], v68 offset:16384
    v_mfma_f32_16x16x32_bf16 v[168:171], a[52:55], a[136:139], v[168:171]
    ds_read_b64_tr_b16 a[82:83], v68 offset:20480
    v_mfma_f32_16x16x32_bf16 v[168:171], a[20:23], a[128:131], v[168:171]
    buffer_load_dwordx4 v92, s[12:15], s61 offen offset:2048 lds
    ds_read_b64_tr_b16 a[84:85], v69 offset:16384
    v_mfma_f32_16x16x32_bf16 v[176:179], a[24:27], a[128:131], v[176:179]
    ds_read_b64_tr_b16 a[86:87], v69 offset:20480
    ds_read_b64_tr_b16 a[88:89], v70 offset:16384
    v_mfma_f32_16x16x32_bf16 v[176:179], a[56:59], a[136:139], v[176:179]
    ds_read_b64_tr_b16 a[90:91], v70 offset:20480
    v_mfma_f32_16x16x32_bf16 v[180:183], a[56:59], a[140:143], v[180:183]
    buffer_load_dwordx4 v93, s[12:15], s61 offen offset:3072 lds
    ds_read_b64_tr_b16 a[92:93], v71 offset:16384
    v_mfma_f32_16x16x32_bf16 v[180:183], a[24:27], a[132:135], v[180:183]
    ds_read_b64_tr_b16 a[94:95], v71 offset:20480
    ds_read_b64_tr_b16 a[96:97], v64 offset:24576
    v_mfma_f32_16x16x32_bf16 v[188:191], a[28:31], a[132:135], v[188:191]
    ds_read_b64_tr_b16 a[98:99], v64 offset:28672
    v_mfma_f32_16x16x32_bf16 v[188:191], a[60:63], a[140:143], v[188:191]
    ds_read_b64_tr_b16 a[100:101], v65 offset:24576
    v_mfma_f32_16x16x32_bf16 v[184:187], a[60:63], a[136:139], v[184:187]
    buffer_load_dwordx4 a[176:179], v88, s[8:11], s62 offen offset:0 sc1
    ds_read_b64_tr_b16 a[102:103], v65 offset:28672
    v_mfma_f32_16x16x32_bf16 v[184:187], a[28:31], a[128:131], v[184:187]
    s_add_u32 s61, s61, 0x20000
    s_and_b32 s61, s61, 0x3fffff
    ds_read_b64_tr_b16 a[104:105], v66 offset:24576
    ds_read_b64_tr_b16 a[106:107], v66 offset:28672
    v_mfma_f32_16x16x32_bf16 v[128:131], a[0:3], a[128:131], v[128:131]
    ds_read_b64_tr_b16 a[108:109], v67 offset:24576
    v_mfma_f32_16x16x32_bf16 v[128:131], a[32:35], a[136:139], v[128:131]
    buffer_load_dwordx4 a[180:183], v88, s[8:11], s62 offen offset:1024 sc1
    ds_read_b64_tr_b16 a[110:111], v67 offset:28672
    v_mfma_f32_16x16x32_bf16 v[132:135], a[32:35], a[140:143], v[132:135]
    ds_read_b64_tr_b16 a[112:113], v68 offset:24576
    v_mfma_f32_16x16x32_bf16 v[132:135], a[0:3], a[132:135], v[132:135]
    ds_read_b64_tr_b16 a[114:115], v68 offset:28672
    ds_read_b64_tr_b16 a[116:117], v69 offset:24576
    v_mfma_f32_16x16x32_bf16 v[140:143], a[4:7], a[132:135], v[140:143]
    ds_read_b64_tr_b16 a[118:119], v69 offset:28672
    v_mfma_f32_16x16x32_bf16 v[140:143], a[36:39], a[140:143], v[140:143]
    buffer_load_dwordx4 a[184:187], v89, s[8:11], s62 offen offset:0 sc1
    ds_read_b64_tr_b16 a[120:121], v70 offset:24576
    v_mfma_f32_16x16x32_bf16 v[136:139], a[36:39], a[136:139], v[136:139]
    ds_read_b64_tr_b16 a[122:123], v70 offset:28672
    ds_read_b64_tr_b16 a[124:125], v71 offset:24576
    v_mfma_f32_16x16x32_bf16 v[136:139], a[4:7], a[128:131], v[136:139]
    ds_read_b64_tr_b16 a[126:127], v71 offset:28672
    v_mfma_f32_16x16x32_bf16 v[144:147], a[8:11], a[128:131], v[144:147]
    buffer_load_dwordx4 a[188:191], v89, s[8:11], s62 offen offset:1024 sc1
    v_mfma_f32_16x16x32_bf16 v[144:147], a[40:43], a[136:139], v[144:147]
    v_mfma_f32_16x16x32_bf16 v[148:151], a[40:43], a[140:143], v[148:151]
    v_mfma_f32_16x16x32_bf16 v[148:151], a[8:11], a[132:135], v[148:151]
    v_mfma_f32_16x16x32_bf16 v[156:159], a[12:15], a[132:135], v[156:159]
    s_cmp_eq_u32 s63, 7
    s_cbranch_scc1 k12_ool_137
k12_oolret_138:
    v_mfma_f32_16x16x32_bf16 v[156:159], a[44:47], a[140:143], v[156:159]
    s_add_u32 s62, s62, 0x40000
    s_and_b32 s62, s62, 0x7fffff
    v_mfma_f32_16x16x32_bf16 v[152:155], a[44:47], a[136:139], v[152:155]
    v_mfma_f32_16x16x32_bf16 v[152:155], a[12:15], a[128:131], v[152:155]
    s_waitcnt vmcnt(12) lgkmcnt(0)
    s_barrier
    v_mfma_f32_16x16x32_bf16 v[160:163], a[80:83], a[144:147], v[160:163]
    s_add_u32 s32, s63, 1
    s_lshr_b32 s32, s32, 1
    ds_read_b64_tr_b16 a[0:1], v64 offset:32768
    v_cmp_le_u32 vcc, 4, v74
    v_mfma_f32_16x16x32_bf16 v[160:163], a[112:115], a[152:155], v[160:163]
    s_add_u32 m0, s60, 0
    ds_read_b64_tr_b16 a[2:3], v64 offset:36864
    ds_read_b64_tr_b16 a[4:5], v65 offset:32768
    v_mfma_f32_16x16x32_bf16 v[164:167], a[112:115], a[156:159], v[164:167]
    s_or_b32 s33, vcc_lo, 16
    buffer_load_dwordx4 v90, s[12:15], s61 offen offset:0 lds
    ds_read_b64_tr_b16 a[6:7], v65 offset:36864
    v_mfma_f32_16x16x32_bf16 v[164:167], a[80:83], a[148:151], v[164:167]
    ds_read_b64_tr_b16 a[8:9], v66 offset:32768
    ds_read_b64_tr_b16 a[10:11], v66 offset:36864
    v_mfma_f32_16x16x32_bf16 v[172:175], a[84:87], a[148:151], v[172:175]
    buffer_load_dwordx4 v91, s[12:15], s61 offen offset:1024 lds
    ds_read_b64_tr_b16 a[12:13], v67 offset:32768
    v_mfma_f32_16x16x32_bf16 v[172:175], a[116:119], a[156:159], v[172:175]
    ds_read_b64_tr_b16 a[14:15], v67 offset:36864
    ds_read_b64_tr_b16 a[16:17], v68 offset:32768
    v_mfma_f32_16x16x32_bf16 v[168:171], a[116:119], a[152:155], v[168:171]
    s_bitcmp0_b32 s33, s32
    s_cbranch_scc1 k12_ool_141
k12_oolret_142:
    v_mfma_f32_16x16x32_bf16 v[168:171], a[84:87], a[144:147], v[168:171]
    ds_read_b64_tr_b16 a[18:19], v68 offset:36864
    ds_read_b64_tr_b16 a[20:21], v69 offset:32768
    v_mfma_f32_16x16x32_bf16 v[176:179], a[88:91], a[144:147], v[176:179]
    buffer_load_dwordx4 v92, s[12:15], s61 offen offset:2048 lds
    ds_read_b64_tr_b16 a[22:23], v69 offset:36864
    v_mfma_f32_16x16x32_bf16 v[176:179], a[120:123], a[152:155], v[176:179]
    ds_read_b64_tr_b16 a[24:25], v70 offset:32768
    ds_read_b64_tr_b16 a[26:27], v70 offset:36864
    v_mfma_f32_16x16x32_bf16 v[180:183], a[120:123], a[156:159], v[180:183]
    buffer_load_dwordx4 v93, s[12:15], s61 offen offset:3072 lds
    ds_read_b64_tr_b16 a[28:29], v71 offset:32768
    v_mfma_f32_16x16x32_bf16 v[180:183], a[88:91], a[148:151], v[180:183]
    ds_read_b64_tr_b16 a[30:31], v71 offset:36864
    ds_read_b64_tr_b16 a[32:33], v64 offset:40960
    v_mfma_f32_16x16x32_bf16 v[188:191], a[92:95], a[148:151], v[188:191]
    ds_read_b64_tr_b16 a[34:35], v64 offset:45056
    v_mfma_f32_16x16x32_bf16 v[188:191], a[124:127], a[156:159], v[188:191]
    ds_read_b64_tr_b16 a[36:37], v65 offset:40960
    v_mfma_f32_16x16x32_bf16 v[184:187], a[124:127], a[152:155], v[184:187]
    buffer_load_dwordx4 a[128:131], v88, s[8:11], s62 offen offset:0 sc1
    ds_read_b64_tr_b16 a[38:39], v65 offset:45056
    v_mfma_f32_16x16x32_bf16 v[184:187], a[92:95], a[144:147], v[184:187]
    s_add_u32 s61, s61, 0x20000
    s_and_b32 s61, s61, 0x3fffff
    ds_read_b64_tr_b16 a[40:41], v66 offset:40960
    ds_read_b64_tr_b16 a[42:43], v66 offset:45056
    v_mfma_f32_16x16x32_bf16 v[128:131], a[64:67], a[144:147], v[128:131]
    ds_read_b64_tr_b16 a[44:45], v67 offset:40960
    v_mfma_f32_16x16x32_bf16 v[128:131], a[96:99], a[152:155], v[128:131]
    buffer_load_dwordx4 a[132:135], v88, s[8:11], s62 offen offset:1024 sc1
    ds_read_b64_tr_b16 a[46:47], v67 offset:45056
    v_mfma_f32_16x16x32_bf16 v[132:135], a[96:99], a[156:159], v[132:135]
    ds_read_b64_tr_b16 a[48:49], v68 offset:40960
    v_mfma_f32_16x16x32_bf16 v[132:135], a[64:67], a[148:151], v[132:135]
    ds_read_b64_tr_b16 a[50:51], v68 offset:45056
    ds_read_b64_tr_b16 a[52:53], v69 offset:40960
    v_mfma_f32_16x16x32_bf16 v[140:143], a[68:71], a[148:151], v[140:143]
    ds_read_b64_tr_b16 a[54:55], v69 offset:45056
    v_mfma_f32_16x16x32_bf16 v[140:143], a[100:103], a[156:159], v[140:143]
    buffer_load_dwordx4 a[136:139], v89, s[8:11], s62 offen offset:0 sc1
    ds_read_b64_tr_b16 a[56:57], v70 offset:40960
    v_mfma_f32_16x16x32_bf16 v[136:139], a[100:103], a[152:155], v[136:139]
    ds_read_b64_tr_b16 a[58:59], v70 offset:45056
    ds_read_b64_tr_b16 a[60:61], v71 offset:40960
    v_mfma_f32_16x16x32_bf16 v[136:139], a[68:71], a[144:147], v[136:139]
    ds_read_b64_tr_b16 a[62:63], v71 offset:45056
    v_mfma_f32_16x16x32_bf16 v[144:147], a[72:75], a[144:147], v[144:147]
    buffer_load_dwordx4 a[140:143], v89, s[8:11], s62 offen offset:1024 sc1
    v_mfma_f32_16x16x32_bf16 v[144:147], a[104:107], a[152:155], v[144:147]
    v_mfma_f32_16x16x32_bf16 v[148:151], a[104:107], a[156:159], v[148:151]
    s_cmp_eq_u32 s63, 6
    s_cbranch_scc1 k12_ool_143
k12_oolret_144:
    v_mfma_f32_16x16x32_bf16 v[148:151], a[72:75], a[148:151], v[148:151]
    v_mfma_f32_16x16x32_bf16 v[156:159], a[76:79], a[148:151], v[156:159]
    v_mfma_f32_16x16x32_bf16 v[156:159], a[108:111], a[156:159], v[156:159]
    s_add_u32 s62, s62, 0x40000
    s_and_b32 s62, s62, 0x7fffff
    v_mfma_f32_16x16x32_bf16 v[152:155], a[108:111], a[152:155], v[152:155]
    v_mfma_f32_16x16x32_bf16 v[152:155], a[76:79], a[144:147], v[152:155]
    s_waitcnt vmcnt(12) lgkmcnt(0)
    s_barrier
    v_mfma_f32_16x16x32_bf16 v[160:163], a[16:19], a[160:163], v[160:163]
    s_add_u32 m0, s60, 16384
    buffer_load_dword v74, v73, s[16:19], s59 offen sc1
    ds_read_b64_tr_b16 a[64:65], v64 offset:49152
    v_mfma_f32_16x16x32_bf16 v[160:163], a[48:51], a[168:171], v[160:163]
    buffer_load_dwordx4 v90, s[12:15], s61 offen offset:0 lds
    ds_read_b64_tr_b16 a[66:67], v64 offset:53248
    v_mfma_f32_16x16x32_bf16 v[164:167], a[48:51], a[172:175], v[164:167]
    ds_read_b64_tr_b16 a[68:69], v65 offset:49152
    ds_read_b64_tr_b16 a[70:71], v65 offset:53248
    v_mfma_f32_16x16x32_bf16 v[164:167], a[16:19], a[164:167], v[164:167]
    ds_read_b64_tr_b16 a[72:73], v66 offset:49152
    ds_read_b64_tr_b16 a[74:75], v66 offset:53248
    v_mfma_f32_16x16x32_bf16 v[172:175], a[20:23], a[164:167], v[172:175]
    buffer_load_dwordx4 v91, s[12:15], s61 offen offset:1024 lds
    ds_read_b64_tr_b16 a[76:77], v67 offset:49152
    v_mfma_f32_16x16x32_bf16 v[172:175], a[52:55], a[172:175], v[172:175]
    ds_read_b64_tr_b16 a[78:79], v67 offset:53248
    ds_read_b64_tr_b16 a[80:81], v68 offset:49152
    v_mfma_f32_16x16x32_bf16 v[168:171], a[52:55], a[168:171], v[168:171]
    ds_read_b64_tr_b16 a[82:83], v68 offset:53248
    v_mfma_f32_16x16x32_bf16 v[168:171], a[20:23], a[160:163], v[168:171]
    buffer_load_dwordx4 v92, s[12:15], s61 offen offset:2048 lds
    ds_read_b64_tr_b16 a[84:85], v69 offset:49152
    v_mfma_f32_16x16x32_bf16 v[176:179], a[24:27], a[160:163], v[176:179]
    ds_read_b64_tr_b16 a[86:87], v69 offset:53248
    ds_read_b64_tr_b16 a[88:89], v70 offset:49152
    v_mfma_f32_16x16x32_bf16 v[176:179], a[56:59], a[168:171], v[176:179]
    ds_read_b64_tr_b16 a[90:91], v70 offset:53248
    v_mfma_f32_16x16x32_bf16 v[180:183], a[56:59], a[172:175], v[180:183]
    buffer_load_dwordx4 v93, s[12:15], s61 offen offset:3072 lds
    ds_read_b64_tr_b16 a[92:93], v71 offset:49152
    v_mfma_f32_16x16x32_bf16 v[180:183], a[24:27], a[164:167], v[180:183]
    ds_read_b64_tr_b16 a[94:95], v71 offset:53248
    ds_read_b64_tr_b16 a[96:97], v64 offset:57344
    v_mfma_f32_16x16x32_bf16 v[188:191], a[28:31], a[164:167], v[188:191]
    ds_read_b64_tr_b16 a[98:99], v64 offset:61440
    v_mfma_f32_16x16x32_bf16 v[188:191], a[60:63], a[172:175], v[188:191]
    ds_read_b64_tr_b16 a[100:101], v65 offset:57344
    v_mfma_f32_16x16x32_bf16 v[184:187], a[60:63], a[168:171], v[184:187]
    buffer_load_dwordx4 a[144:147], v88, s[8:11], s62 offen offset:0 sc1
    ds_read_b64_tr_b16 a[102:103], v65 offset:61440
    v_mfma_f32_16x16x32_bf16 v[184:187], a[28:31], a[160:163], v[184:187]
    s_add_u32 s61, s61, 0x20000
    s_and_b32 s61, s61, 0x3fffff
    ds_read_b64_tr_b16 a[104:105], v66 offset:57344
    ds_read_b64_tr_b16 a[106:107], v66 offset:61440
    v_mfma_f32_16x16x32_bf16 v[128:131], a[0:3], a[160:163], v[128:131]
    ds_read_b64_tr_b16 a[108:109], v67 offset:57344
    v_mfma_f32_16x16x32_bf16 v[128:131], a[32:35], a[168:171], v[128:131]
    buffer_load_dwordx4 a[148:151], v88, s[8:11], s62 offen offset:1024 sc1
    ds_read_b64_tr_b16 a[110:111], v67 offset:61440
    v_mfma_f32_16x16x32_bf16 v[132:135], a[32:35], a[172:175], v[132:135]
    ds_read_b64_tr_b16 a[112:113], v68 offset:57344
    v_mfma_f32_16x16x32_bf16 v[132:135], a[0:3], a[164:167], v[132:135]
    ds_read_b64_tr_b16 a[114:115], v68 offset:61440
    ds_read_b64_tr_b16 a[116:117], v69 offset:57344
    v_mfma_f32_16x16x32_bf16 v[140:143], a[4:7], a[164:167], v[140:143]
    ds_read_b64_tr_b16 a[118:119], v69 offset:61440
    v_mfma_f32_16x16x32_bf16 v[140:143], a[36:39], a[172:175], v[140:143]
    buffer_load_dwordx4 a[152:155], v89, s[8:11], s62 offen offset:0 sc1
    ds_read_b64_tr_b16 a[120:121], v70 offset:57344
    v_mfma_f32_16x16x32_bf16 v[136:139], a[36:39], a[168:171], v[136:139]
    ds_read_b64_tr_b16 a[122:123], v70 offset:61440
    ds_read_b64_tr_b16 a[124:125], v71 offset:57344
    v_mfma_f32_16x16x32_bf16 v[136:139], a[4:7], a[160:163], v[136:139]
    ds_read_b64_tr_b16 a[126:127], v71 offset:61440
    v_mfma_f32_16x16x32_bf16 v[144:147], a[8:11], a[160:163], v[144:147]
    buffer_load_dwordx4 a[156:159], v89, s[8:11], s62 offen offset:1024 sc1
    v_mfma_f32_16x16x32_bf16 v[144:147], a[40:43], a[168:171], v[144:147]
    v_mfma_f32_16x16x32_bf16 v[148:151], a[40:43], a[172:175], v[148:151]
    v_mfma_f32_16x16x32_bf16 v[148:151], a[8:11], a[164:167], v[148:151]
    v_mfma_f32_16x16x32_bf16 v[156:159], a[12:15], a[164:167], v[156:159]
    v_mfma_f32_16x16x32_bf16 v[156:159], a[44:47], a[172:175], v[156:159]
    s_add_u32 s62, s62, 0x40000
    s_and_b32 s62, s62, 0x7fffff
    v_mfma_f32_16x16x32_bf16 v[152:155], a[44:47], a[168:171], v[152:155]
    v_mfma_f32_16x16x32_bf16 v[152:155], a[12:15], a[160:163], v[152:155]
    s_waitcnt vmcnt(12) lgkmcnt(0)
    s_barrier
    v_mfma_f32_16x16x32_bf16 v[160:163], a[80:83], a[176:179], v[160:163]
    s_add_u32 m0, s60, 32768
    ds_read_b64_tr_b16 a[0:1], v64 offset:0
    ds_read_b64_tr_b16 a[2:3], v64 offset:4096
    v_mfma_f32_16x16x32_bf16 v[160:163], a[112:115], a[184:187], v[160:163]
    buffer_load_dwordx4 v90, s[12:15], s61 offen offset:0 lds
    ds_read_b64_tr_b16 a[4:5], v65 offset:0
    v_mfma_f32_16x16x32_bf16 v[164:167], a[112:115], a[188:191], v[164:167]
    ds_read_b64_tr_b16 a[6:7], v65 offset:4096
    ds_read_b64_tr_b16 a[8:9], v66 offset:0
    v_mfma_f32_16x16x32_bf16 v[164:167], a[80:83], a[180:183], v[164:167]
    buffer_load_dwordx4 v91, s[12:15], s61 offen offset:1024 lds
    ds_read_b64_tr_b16 a[10:11], v66 offset:4096
    v_mfma_f32_16x16x32_bf16 v[172:175], a[84:87], a[180:183], v[172:175]
    ds_read_b64_tr_b16 a[12:13], v67 offset:0
    ds_read_b64_tr_b16 a[14:15], v67 offset:4096
    v_mfma_f32_16x16x32_bf16 v[172:175], a[116:119], a[188:191], v[172:175]
    ds_read_b64_tr_b16 a[16:17], v68 offset:0
    v_mfma_f32_16x16x32_bf16 v[168:171], a[116:119], a[184:187], v[168:171]
    ds_read_b64_tr_b16 a[18:19], v68 offset:4096
    v_mfma_f32_16x16x32_bf16 v[168:171], a[84:87], a[176:179], v[168:171]
    buffer_load_dwordx4 v92, s[12:15], s61 offen offset:2048 lds
    ds_read_b64_tr_b16 a[20:21], v69 offset:0
    v_mfma_f32_16x16x32_bf16 v[176:179], a[88:91], a[176:179], v[176:179]
    ds_read_b64_tr_b16 a[22:23], v69 offset:4096
    ds_read_b64_tr_b16 a[24:25], v70 offset:0
    v_mfma_f32_16x16x32_bf16 v[176:179], a[120:123], a[184:187], v[176:179]
    ds_read_b64_tr_b16 a[26:27], v70 offset:4096
    v_mfma_f32_16x16x32_bf16 v[180:183], a[120:123], a[188:191], v[180:183]
    buffer_load_dwordx4 v93, s[12:15], s61 offen offset:3072 lds
    ds_read_b64_tr_b16 a[28:29], v71 offset:0
    v_mfma_f32_16x16x32_bf16 v[180:183], a[88:91], a[180:183], v[180:183]
    ds_read_b64_tr_b16 a[30:31], v71 offset:4096
    ds_read_b64_tr_b16 a[32:33], v64 offset:8192
    v_mfma_f32_16x16x32_bf16 v[188:191], a[92:95], a[180:183], v[188:191]
    ds_read_b64_tr_b16 a[34:35], v64 offset:12288
    v_mfma_f32_16x16x32_bf16 v[188:191], a[124:127], a[188:191], v[188:191]
    ds_read_b64_tr_b16 a[36:37], v65 offset:8192
    v_mfma_f32_16x16x32_bf16 v[184:187], a[124:127], a[184:187], v[184:187]
    buffer_load_dwordx4 a[160:163], v88, s[8:11], s62 offen offset:0 sc1
    ds_read_b64_tr_b16 a[38:39], v65 offset:12288
    v_mfma_f32_16x16x32_bf16 v[184:187], a[92:95], a[176:179], v[184:187]
    s_add_u32 s61, s61, 0x20000
    s_and_b32 s61, s61, 0x3fffff
    ds_read_b64_tr_b16 a[40:41], v66 offset:8192
    ds_read_b64_tr_b16 a[42:43], v66 offset:12288
    v_mfma_f32_16x16x32_bf16 v[128:131], a[64:67], a[176:179], v[128:131]
    ds_read_b64_tr_b16 a[44:45], v67 offset:8192
    v_mfma_f32_16x16x32_bf16 v[128:131], a[96:99], a[184:187], v[128:131]
    buffer_load_dwordx4 a[164:167], v88, s[8:11], s62 offen offset:1024 sc1
    ds_read_b64_tr_b16 a[46:47], v67 offset:12288
    v_mfma_f32_16x16x32_bf16 v[132:135], a[96:99], a[188:191], v[132:135]
    ds_read_b64_tr_b16 a[48:49], v68 offset:8192
    v_mfma_f32_16x16x32_bf16 v[132:135], a[64:67], a[180:183], v[132:135]
    ds_read_b64_tr_b16 a[50:51], v68 offset:12288
    ds_read_b64_tr_b16 a[52:53], v69 offset:8192
    v_mfma_f32_16x16x32_bf16 v[140:143], a[68:71], a[180:183], v[140:143]
    ds_read_b64_tr_b16 a[54:55], v69 offset:12288
    v_mfma_f32_16x16x32_bf16 v[140:143], a[100:103], a[188:191], v[140:143]
    buffer_load_dwordx4 a[168:171], v89, s[8:11], s62 offen offset:0 sc1
    ds_read_b64_tr_b16 a[56:57], v70 offset:8192
    v_mfma_f32_16x16x32_bf16 v[136:139], a[100:103], a[184:187], v[136:139]
    ds_read_b64_tr_b16 a[58:59], v70 offset:12288
    ds_read_b64_tr_b16 a[60:61], v71 offset:8192
    v_mfma_f32_16x16x32_bf16 v[136:139], a[68:71], a[176:179], v[136:139]
    ds_read_b64_tr_b16 a[62:63], v71 offset:12288
    v_mfma_f32_16x16x32_bf16 v[144:147], a[72:75], a[176:179], v[144:147]
    buffer_load_dwordx4 a[172:175], v89, s[8:11], s62 offen offset:1024 sc1
    v_mfma_f32_16x16x32_bf16 v[144:147], a[104:107], a[184:187], v[144:147]
    v_mfma_f32_16x16x32_bf16 v[148:151], a[104:107], a[188:191], v[148:151]
    v_mfma_f32_16x16x32_bf16 v[148:151], a[72:75], a[180:183], v[148:151]
    v_mfma_f32_16x16x32_bf16 v[156:159], a[76:79], a[180:183], v[156:159]
    v_mfma_f32_16x16x32_bf16 v[156:159], a[108:111], a[188:191], v[156:159]
    s_add_u32 s62, s62, 0x40000
    s_and_b32 s62, s62, 0x7fffff
    v_mfma_f32_16x16x32_bf16 v[152:155], a[108:111], a[184:187], v[152:155]
    s_add_u32 s63, s63, 1
    v_mfma_f32_16x16x32_bf16 v[152:155], a[76:79], a[176:179], v[152:155]
    s_waitcnt vmcnt(12) lgkmcnt(0)
    s_barrier
    s_cmp_lt_u32 s63, 8
    s_cbranch_scc1 op_loop_134
op_tail:
    s_nop 1
    v_cvt_pk_bf16_f32 v160, v160, v161
    v_cvt_pk_bf16_f32 v161, v162, v163
    v_cvt_pk_bf16_f32 v162, v164, v165
    v_cvt_pk_bf16_f32 v163, v166, v167
    v_min_u32 v160, -2, v160
    v_min_u32 v161, -2, v161
    v_min_u32 v162, -2, v162
    v_min_u32 v163, -2, v163
    buffer_store_dwordx4 v[160:163], v1, s[36:39], s52 offen offset:0 sc1
    v_cvt_pk_bf16_f32 v168, v168, v169
    v_cvt_pk_bf16_f32 v169, v170, v171
    v_cvt_pk_bf16_f32 v170, v172, v173
    v_cvt_pk_bf16_f32 v171, v174, v175
    v_min_u32 v168, -2, v168
    v_min_u32 v169, -2, v169
    v_min_u32 v170, -2, v170
    v_min_u32 v171, -2, v171
    buffer_store_dwordx4 v[168:171], v1, s[36:39], s52 offen offset:1024 sc1
    v_cvt_pk_bf16_f32 v176, v176, v177
    v_cvt_pk_bf16_f32 v177, v178, v179
    v_cvt_pk_bf16_f32 v178, v180, v181
    v_cvt_pk_bf16_f32 v179, v182, v183
    v_min_u32 v176, -2, v176
    v_min_u32 v177, -2, v177
    v_min_u32 v178, -2, v178
    v_min_u32 v179, -2, v179
    buffer_store_dwordx4 v[176:179], v1, s[36:39], s52 offen offset:2048 sc1
    v_cvt_pk_bf16_f32 v184, v184, v185
    v_cvt_pk_bf16_f32 v185, v186, v187
    v_cvt_pk_bf16_f32 v186, v188, v189
    v_cvt_pk_bf16_f32 v187, v190, v191
    v_min_u32 v184, -2, v184
    v_min_u32 v185, -2, v185
    v_min_u32 v186, -2, v186
    v_min_u32 v187, -2, v187
    buffer_store_dwordx4 v[184:187], v1, s[36:39], s52 offen offset:3072 sc1
    s_add_u32 s32, s6, 0x4800000
    s_addc_u32 s33, s7, 0
    s_and_b32 s33, s33, 0xffff
    s_mov_b32 s34, 0x6000
    s_mov_b32 s35, 0x00020000
    s_waitcnt vmcnt(4) lgkmcnt(0)
    v_lshlrev_b32 v58, 16, v192
    v_and_b32 v59, 0xffff0000, v192
    v_pk_add_f32 v[128:129], v[128:129], v[58:59]
    v_lshlrev_b32 v58, 16, v193
    v_and_b32 v59, 0xffff0000, v193
    v_pk_add_f32 v[130:131], v[130:131], v[58:59]
    v_lshlrev_b32 v58, 16, v200
    v_and_b32 v59, 0xffff0000, v200
    v_pk_add_f32 v[132:133], v[132:133], v[58:59]
    v_lshlrev_b32 v58, 16, v201
    v_and_b32 v59, 0xffff0000, v201
    v_pk_add_f32 v[134:135], v[134:135], v[58:59]
    v_lshlrev_b32 v58, 16, v194
    v_and_b32 v59, 0xffff0000, v194
    v_pk_add_f32 v[136:137], v[136:137], v[58:59]
    v_lshlrev_b32 v58, 16, v195
    v_and_b32 v59, 0xffff0000, v195
    v_pk_add_f32 v[138:139], v[138:139], v[58:59]
    v_lshlrev_b32 v58, 16, v202
    v_and_b32 v59, 0xffff0000, v202
    v_pk_add_f32 v[140:141], v[140:141], v[58:59]
    v_lshlrev_b32 v58, 16, v203
    v_and_b32 v59, 0xffff0000, v203
    v_pk_add_f32 v[142:143], v[142:143], v[58:59]
    v_lshlrev_b32 v58, 16, v196
    v_and_b32 v59, 0xffff0000, v196
    v_pk_add_f32 v[144:145], v[144:145], v[58:59]
    v_lshlrev_b32 v58, 16, v197
    v_and_b32 v59, 0xffff0000, v197
    v_pk_add_f32 v[146:147], v[146:147], v[58:59]
    v_lshlrev_b32 v58, 16, v204
    v_and_b32 v59, 0xffff0000, v204
    v_pk_add_f32 v[148:149], v[148:149], v[58:59]
    v_lshlrev_b32 v58, 16, v205
    v_and_b32 v59, 0xffff0000, v205
    v_pk_add_f32 v[150:151], v[150:151], v[58:59]
    v_lshlrev_b32 v58, 16, v198
    v_and_b32 v59, 0xffff0000, v198
    v_pk_add_f32 v[152:153], v[152:153], v[58:59]
    v_lshlrev_b32 v58, 16, v199
    v_and_b32 v59, 0xffff0000, v199
    v_pk_add_f32 v[154:155], v[154:155], v[58:59]
    v_lshlrev_b32 v58, 16, v206
    v_and_b32 v59, 0xffff0000, v206
    v_pk_add_f32 v[156:157], v[156:157], v[58:59]
    v_lshlrev_b32 v58, 16, v207
    v_and_b32 v59, 0xffff0000, v207
    v_pk_add_f32 v[158:159], v[158:159], v[58:59]
    v_and_b32 v58, 1, v72
    v_lshrrev_b32 v59, 1, v72
    v_lshlrev_b32 v58, 5, v58
    v_lshl_add_u32 v58, v59, 4, v58
    v_lshlrev_b32 v59, 3, v72
    v_sub_u32 v58, v58, v59
    v_add_u32 v78, v78, v58
    v_add_u32 v79, v79, v58
    v_lshlrev_b32 v32, 16, v208
    v_and_b32 v33, 0xffff0000, v208
    v_lshlrev_b32 v34, 16, v209
    v_and_b32 v35, 0xffff0000, v209
    v_lshlrev_b32 v36, 16, v210
    v_and_b32 v37, 0xffff0000, v210
    v_lshlrev_b32 v38, 16, v211
    v_and_b32 v39, 0xffff0000, v211
    v_lshlrev_b32 v40, 16, v212
    v_and_b32 v41, 0xffff0000, v212
    v_lshlrev_b32 v42, 16, v213
    v_and_b32 v43, 0xffff0000, v213
    v_lshlrev_b32 v44, 16, v214
    v_and_b32 v45, 0xffff0000, v214
    v_lshlrev_b32 v46, 16, v215
    v_and_b32 v47, 0xffff0000, v215
    s_or_b32 s31, s54, s30
    s_cbranch_scc1 op_nowr_145
    v_pk_add_f32 v[56:57], v[32:33], v[34:35]
    v_pk_add_f32 v[56:57], v[56:57], v[36:37]
    v_pk_add_f32 v[56:57], v[56:57], v[38:39]
    v_pk_add_f32 v[56:57], v[56:57], v[40:41]
    v_pk_add_f32 v[56:57], v[56:57], v[42:43]
    v_pk_add_f32 v[56:57], v[56:57], v[44:45]
    v_pk_add_f32 v[56:57], v[56:57], v[46:47]
    v_add_f32 v56, v56, v57
    v_mov_b32 v57, v56
    s_nop 1
    v_permlane16_swap_b32 v56, v57
    s_nop 1
    v_add_f32 v56, v56, v57
    v_mov_b32 v57, v56
    s_nop 1
    v_permlane32_swap_b32 v56, v57
    s_nop 1
    v_add_f32 v56, v56, v57
    s_mov_b32 s31, 24704
    s_mov_b32 s34, 24708
    s_mov_b64 exec, 1
    buffer_atomic_add_f32 v56, v75, s[32:35], s31 offen
    s_mov_b64 exec, -1
    s_mov_b32 s34, 24576
op_nowr_145:
    v_mov_b32 v208, 0
    v_mov_b32 v209, 0
    v_mov_b32 v210, 0
    v_mov_b32 v211, 0
    v_mov_b32 v212, 0
    v_mov_b32 v213, 0
    v_mov_b32 v214, 0
    v_mov_b32 v215, 0
    v_mov_b32 v216, 0
    v_mov_b32 v217, 0
    v_mov_b32 v218, 0
    v_mov_b32 v219, 0
    s_mov_b32 s40, 1048576
op_xspin_146:
    buffer_load_dwordx4 v[224:227], v1, s[36:39], s53 offen offset:0 sc1
    buffer_load_dwordx4 v[228:231], v1, s[36:39], s53 offen offset:1024 sc1
    buffer_load_dwordx4 v[232:235], v1, s[36:39], s53 offen offset:2048 sc1
    buffer_load_dwordx4 v[236:239], v1, s[36:39], s53 offen offset:3072 sc1
    s_sub_u32 s40, s40, 1
    s_waitcnt vmcnt(0)
    s_cbranch_scc1 op_xok_147
    v_max3_u32 v56, v224, v225, v226
    v_max3_u32 v56, v56, v227, v228
    v_max3_u32 v56, v56, v229, v230
    v_max3_u32 v56, v56, v231, v232
    v_max3_u32 v56, v56, v233, v234
    v_max3_u32 v56, v56, v235, v236
    v_max3_u32 v56, v56, v237, v238
    v_max_u32 v56, v56, v239
    v_cmp_eq_u32 vcc, -1, v56
    s_cbranch_vccz op_xok_147
    s_sleep 2
    s_branch op_xspin_146
op_xok_147:
    v_lshlrev_b32 v56, 16, v224
    v_and_b32 v57, 0xffff0000, v224
    v_lshlrev_b32 v58, 16, v225
    v_and_b32 v59, 0xffff0000, v225
    v_pk_add_f32 v[128:129], v[128:129], v[56:57]
    v_pk_add_f32 v[130:131], v[130:131], v[58:59]
    v_cvt_pk_bf16_f32 v192, v128, v129
    v_cvt_pk_bf16_f32 v193, v130, v131
    v_lshlrev_b32 v128, 16, v192
    v_and_b32 v129, 0xffff0000, v192
    v_lshlrev_b32 v130, 16, v193
    v_and_b32 v131, 0xffff0000, v193
    v_pk_add_f32 v[208:209], v[208:209], v[128:129]
    v_pk_fma_f32 v[210:211], v[128:129], v[128:129], v[210:211]
    v_pk_fma_f32 v[212:213], v[128:129], v[32:33], v[212:213]
    v_pk_add_f32 v[208:209], v[208:209], v[130:131]
    v_pk_fma_f32 v[210:211], v[130:131], v[130:131], v[210:211]
    v_pk_fma_f32 v[212:213], v[130:131], v[34:35], v[212:213]
    v_lshlrev_b32 v56, 16, v226
    v_and_b32 v57, 0xffff0000, v226
    v_lshlrev_b32 v58, 16, v227
    v_and_b32 v59, 0xffff0000, v227
    v_pk_add_f32 v[132:133], v[132:133], v[56:57]
    v_pk_add_f32 v[134:135], v[134:135], v[58:59]
    v_cvt_pk_bf16_f32 v200, v132, v133
    v_cvt_pk_bf16_f32 v201, v134, v135
    v_lshlrev_b32 v132, 16, v200
    v_and_b32 v133, 0xffff0000, v200
    v_lshlrev_b32 v134, 16, v201
    v_and_b32 v135, 0xffff0000, v201
    v_pk_add_f32 v[214:215], v[214:215], v[132:133]
    v_pk_fma_f32 v[216:217], v[132:133], v[132:133], v[216:217]
    v_pk_fma_f32 v[218:219], v[132:133], v[32:33], v[218:219]
    v_pk_add_f32 v[214:215], v[214:215], v[134:135]
    v_pk_fma_f32 v[216:217], v[134:135], v[134:135], v[216:217]
    v_pk_fma_f32 v[218:219], v[134:135], v[34:35], v[218:219]
    v_lshlrev_b32 v56, 16, v228
    v_and_b32 v57, 0xffff0000, v228
    v_lshlrev_b32 v58, 16, v229
    v_and_b32 v59, 0xffff0000, v229
    v_pk_add_f32 v[136:137], v[136:137], v[56:57]
    v_pk_add_f32 v[138:139], v[138:139], v[58:59]
    v_cvt_pk_bf16_f32 v194, v136, v137
    v_cvt_pk_bf16_f32 v195, v138, v139
    v_lshlrev_b32 v136, 16, v194
    v_and_b32 v137, 0xffff0000, v194
    v_lshlrev_b32 v138, 16, v195
    v_and_b32 v139, 0xffff0000, v195
    v_permlane16_swap_b32 v192, v194
    v_permlane16_swap_b32 v193, v195
    buffer_store_dwordx4 v[192:195], v78, s[24:27], 0 offen offset:0 sc1
    v_pk_add_f32 v[208:209], v[208:209], v[136:137]
    v_pk_fma_f32 v[210:211], v[136:137], v[136:137], v[210:211]
    v_pk_fma_f32 v[212:213], v[136:137], v[36:37], v[212:213]
    v_pk_add_f32 v[208:209], v[208:209], v[138:139]
    v_pk_fma_f32 v[210:211], v[138:139], v[138:139], v[210:211]
    v_pk_fma_f32 v[212:213], v[138:139], v[38:39], v[212:213]
    v_lshlrev_b32 v56, 16, v230
    v_and_b32 v57, 0xffff0000, v230
    v_lshlrev_b32 v58, 16, v231
    v_and_b32 v59, 0xffff0000, v231
    v_pk_add_f32 v[140:141], v[140:141], v[56:57]
    v_pk_add_f32 v[142:143], v[142:143], v[58:59]
    v_cvt_pk_bf16_f32 v202, v140, v141
    v_cvt_pk_bf16_f32 v203, v142, v143
    v_lshlrev_b32 v140, 16, v202
    v_and_b32 v141, 0xffff0000, v202
    v_lshlrev_b32 v142, 16, v203
    v_and_b32 v143, 0xffff0000, v203
    v_permlane16_swap_b32 v200, v202
    v_permlane16_swap_b32 v201, v203
    buffer_store_dwordx4 v[200:203], v79, s[24:27], 0 offen offset:0 sc1
    v_pk_add_f32 v[214:215], v[214:215], v[140:141]
    v_pk_fma_f32 v[216:217], v[140:141], v[140:141], v[216:217]
    v_pk_fma_f32 v[218:219], v[140:141], v[36:37], v[218:219]
    v_pk_add_f32 v[214:215], v[214:215], v[142:143]
    v_pk_fma_f32 v[216:217], v[142:143], v[142:143], v[216:217]
    v_pk_fma_f32 v[218:219], v[142:143], v[38:39], v[218:219]
    v_lshlrev_b32 v56, 16, v232
    v_and_b32 v57, 0xffff0000, v232
    v_lshlrev_b32 v58, 16, v233
    v_and_b32 v59, 0xffff0000, v233
    v_pk_add_f32 v[144:145], v[144:145], v[56:57]
    v_pk_add_f32 v[146:147], v[146:147], v[58:59]
    v_cvt_pk_bf16_f32 v196, v144, v145
    v_cvt_pk_bf16_f32 v197, v146, v147
    v_lshlrev_b32 v144, 16, v196
    v_and_b32 v145, 0xffff0000, v196
    v_lshlrev_b32 v146, 16, v197
    v_and_b32 v147, 0xffff0000, v197
    v_pk_add_f32 v[208:209], v[208:209], v[144:145]
    v_pk_fma_f32 v[210:211], v[144:145], v[144:145], v[210:211]
    v_pk_fma_f32 v[212:213], v[144:145], v[40:41], v[212:213]
    v_pk_add_f32 v[208:209], v[208:209], v[146:147]
    v_pk_fma_f32 v[210:211], v[146:147], v[146:147], v[210:211]
    v_pk_fma_f32 v[212:213], v[146:147], v[42:43], v[212:213]
    v_lshlrev_b32 v56, 16, v234
    v_and_b32 v57, 0xffff0000, v234
    v_lshlrev_b32 v58, 16, v235
    v_and_b32 v59, 0xffff0000, v235
    v_pk_add_f32 v[148:149], v[148:149], v[56:57]
    v_pk_add_f32 v[150:151], v[150:151], v[58:59]
    v_cvt_pk_bf16_f32 v204, v148, v149
    v_cvt_pk_bf16_f32 v205, v150, v151
    v_lshlrev_b32 v148, 16, v204
    v_and_b32 v149, 0xffff0000, v204
    v_lshlrev_b32 v150, 16, v205
    v_and_b32 v151, 0xffff0000, v205
    v_pk_add_f32 v[214:215], v[214:215], v[148:149]
    v_pk_fma_f32 v[216:217], v[148:149], v[148:149], v[216:217]
    v_pk_fma_f32 v[218:219], v[148:149], v[40:41], v[218:219]
    v_pk_add_f32 v[214:215], v[214:215], v[150:151]
    v_pk_fma_f32 v[216:217], v[150:151], v[150:151], v[216:217]
    v_pk_fma_f32 v[218:219], v[150:151], v[42:43], v[218:219]
    v_lshlrev_b32 v56, 16, v236
    v_and_b32 v57, 0xffff0000, v236
    v_lshlrev_b32 v58, 16, v237
    v_and_b32 v59, 0xffff0000, v237
    v_pk_add_f32 v[152:153], v[152:153], v[56:57]
    v_pk_add_f32 v[154:155], v[154:155], v[58:59]
    v_cvt_pk_bf16_f32 v198, v152, v153
    v_cvt_pk_bf16_f32 v199, v154, v155
    v_lshlrev_b32 v152, 16, v198
    v_and_b32 v153, 0xffff0000, v198
    v_lshlrev_b32 v154, 16, v199
    v_and_b32 v155, 0xffff0000, v199
    v_permlane16_swap_b32 v196, v198
    v_permlane16_swap_b32 v197, v199
    buffer_store_dwordx4 v[196:199], v78, s[24:27], 0 offen offset:64 sc1
    v_pk_add_f32 v[208:209], v[208:209], v[152:153]
    v_pk_fma_f32 v[210:211], v[152:153], v[152:153], v[210:211]
    v_pk_fma_f32 v[212:213], v[152:153], v[44:45], v[212:213]
    v_pk_add_f32 v[208:209], v[208:209], v[154:155]
    v_pk_fma_f32 v[210:211], v[154:155], v[154:155], v[210:211]
    v_pk_fma_f32 v[212:213], v[154:155], v[46:47], v[212:213]
    v_lshlrev_b32 v56, 16, v238
    v_and_b32 v57, 0xffff0000, v238
    v_lshlrev_b32 v58, 16, v239
    v_and_b32 v59, 0xffff0000, v239
    v_pk_add_f32 v[156:157], v[156:157], v[56:57]
    v_pk_add_f32 v[158:159], v[158:159], v[58:59]
    v_cvt_pk_bf16_f32 v206, v156, v157
    v_cvt_pk_bf16_f32 v207, v158, v159
    v_lshlrev_b32 v156, 16, v206
    v_and_b32 v157, 0xffff0000, v206
    v_lshlrev_b32 v158, 16, v207
    v_and_b32 v159, 0xffff0000, v207
    v_permlane16_swap_b32 v204, v206
    v_permlane16_swap_b32 v205, v207
    buffer_store_dwordx4 v[204:207], v79, s[24:27], 0 offen offset:64 sc1
    v_pk_add_f32 v[214:215], v[214:215], v[156:157]
    v_pk_fma_f32 v[216:217], v[156:157], v[156:157], v[216:217]
    v_pk_fma_f32 v[218:219], v[156:157], v[44:45], v[218:219]
    v_pk_add_f32 v[214:215], v[214:215], v[158:159]
    v_pk_fma_f32 v[216:217], v[158:159], v[158:159], v[216:217]
    v_pk_fma_f32 v[218:219], v[158:159], v[46:47], v[218:219]
    v_add_f32 v48, v208, v209
    v_add_f32 v49, v210, v211
    v_add_f32 v50, v212, v213
    v_add_f32 v52, v214, v215
    v_add_f32 v53, v216, v217
    v_add_f32 v54, v218, v219
    v_mov_b32 v56, v48
    v_mov_b32 v57, v49
    v_mov_b32 v58, v50
    v_mov_b32 v59, v52
    v_mov_b32 v60, v53
    v_mov_b32 v61, v54
    s_nop 1
    v_permlane16_swap_b32 v48, v56
    v_permlane16_swap_b32 v49, v57
    v_permlane16_swap_b32 v50, v58
    v_permlane16_swap_b32 v52, v59
    v_permlane16_swap_b32 v53, v60
    v_permlane16_swap_b32 v54, v61
    s_nop 1
    v_add_f32 v48, v48, v56
    v_add_f32 v49, v49, v57
    v_add_f32 v50, v50, v58
    v_add_f32 v52, v52, v59
    v_add_f32 v53, v53, v60
    v_add_f32 v54, v54, v61
    v_mov_b32 v56, v48
    v_mov_b32 v57, v49
    v_mov_b32 v58, v50
    v_mov_b32 v59, v52
    v_mov_b32 v60, v53
    v_mov_b32 v61, v54
    s_nop 1
    v_permlane32_swap_b32 v48, v56
    v_permlane32_swap_b32 v49, v57
    v_permlane32_swap_b32 v50, v58
    v_permlane32_swap_b32 v52, v59
    v_permlane32_swap_b32 v53, v60
    v_permlane32_swap_b32 v54, v61
    s_nop 1
    v_add_f32 v48, v48, v56
    v_add_f32 v49, v49, v57
    v_add_f32 v50, v50, v58
    v_add_f32 v52, v52, v59
    v_add_f32 v53, v53, v60
    v_add_f32 v54, v54, v61
    v_cmp_eq_u32 s[40:41], 1, v72
    v_cmp_eq_u32 s[42:43], 2, v72
    s_nop 1
    v_cndmask_b32 v48, v48, v49, s[40:41]
    v_cndmask_b32 v48, v48, v50, s[42:43]
    buffer_atomic_add_f32 v48, v77, s[32:35], 0 offen offset:0
    v_cndmask_b32 v52, v52, v53, s[40:41]
    v_cndmask_b32 v52, v52, v54, s[42:43]
    buffer_atomic_add_f32 v52, v77, s[32:35], 0 offen offset:64
    s_load_dwordx2 s[42:43], s[0:1], 88
    s_load_dwordx2 s[56:57], s[0:1], 56
    s_add_u32 s16, s6, 0x4815000
    s_addc_u32 s17, s7, 0
    s_and_b32 s17, s17, 0xffff
    s_mov_b32 s18, 0x1000
    s_mov_b32 s19, 0x00020000
    v_lshrrev_b32 v3, 4, v1
    v_lshl_add_u32 v2, s30, 6, v3
    v_and_b32 v4, 31, v3
    v_lshrrev_b32 v5, 5, v3
    v_lshlrev_b32 v7, 4, v4
    v_and_b32 v8, 15, v3
    v_lshlrev_b32 v6, 7, v8
    s_bfe_u32 s31, s2, 0x20003
    s_lshl_b32 s31, s31, 7
    v_lshlrev_b32 v12, 9, v3
    v_and_b32 v14, 3, v3
    v_lshlrev_b32 v14, 7, v14
    s_and_b32 s59, s2, 7
    s_lshl_b32 s59, s59, 9
    s_setreg_imm32_b32 hwreg(HW_REG_MODE, 4, 2), 3
    s_waitcnt vmcnt(0) lgkmcnt(0)
    s_barrier
    s_cmp_lg_u32 s30, 0
    s_cbranch_scc1 ff_nosig_148
    s_mov_b64 exec, 0xff
    buffer_atomic_add v76, v12, s[16:19], s31 offen sc1
    s_mov_b64 exec, -1
ff_nosig_148:
    s_lshl_b32 s40, s30, 13
    s_add_u32 m0, s40, 65536
    s_add_u32 s41, s3, 0
    buffer_load_dwordx4 v1, s[44:47], s41 offen offset:0 sc1 lds
    buffer_load_dwordx4 v1, s[44:47], s41 offen offset:1024 sc1 lds
    buffer_load_dwordx4 v1, s[44:47], s41 offen offset:2048 sc1 lds
    buffer_load_dwordx4 v1, s[44:47], s41 offen offset:3072 sc1 lds
    s_waitcnt vmcnt(0)
    s_lshl_b32 s40, s30, 13
    s_add_u32 m0, s40, 69632
    s_add_u32 s41, s3, 4096
    buffer_load_dwordx4 v1, s[44:47], s41 offen offset:0 sc1 lds
    buffer_load_dwordx4 v1, s[44:47], s41 offen offset:1024 sc1 lds
    buffer_load_dwordx4 v1, s[44:47], s41 offen offset:2048 sc1 lds
    buffer_load_dwordx4 v1, s[44:47], s41 offen offset:3072 sc1 lds
    s_waitcnt vmcnt(0)
    s_lshl_b32 s40, s30, 13
    s_add_u32 m0, s40, 98304
    s_add_u32 s41, s3, 8388608
    buffer_load_dwordx4 v1, s[44:47], s41 offen offset:0 sc1 lds
    buffer_load_dwordx4 v1, s[44:47], s41 offen offset:1024 sc1 lds
    buffer_load_dwordx4 v1, s[44:47], s41 offen offset:2048 sc1 lds
    buffer_load_dwordx4 v1, s[44:47], s41 offen offset:3072 sc1 lds
    s_waitcnt vmcnt(0)
    s_lshl_b32 s40, s30, 13
    s_add_u32 m0, s40, 102400
    s_add_u32 s41, s3, 8392704
    buffer_load_dwordx4 v1, s[44:47], s41 offen offset:0 sc1 lds
    buffer_load_dwordx4 v1, s[44:47], s41 offen offset:1024 sc1 lds
    buffer_load_dwordx4 v1, s[44:47], s41 offen offset:2048 sc1 lds
    buffer_load_dwordx4 v1, s[44:47], s41 offen offset:3072 sc1 lds
    s_lshl_b32 s41, s30, 9
    s_add_u32 s41, s41, 131072
    v_lshrrev_b32 v9, 1, v1
    v_add_u32 v9, s41, v9
    ds_read_b64 v[96:97], v9 offset:0
    ds_read_b64 v[98:99], v9 offset:2048
    ds_read_b64 v[100:101], v9 offset:4096
    ds_read_b64 v[102:103], v9 offset:6144
    ds_read_b64 v[104:105], v9 offset:8192
    ds_read_b64 v[106:107], v9 offset:10240
    ds_read_b64 v[108:109], v9 offset:12288
    ds_read_b64 v[110:111], v9 offset:14336
    ds_read_b64 v[112:113], v9 offset:16384
    ds_read_b64 v[114:115], v9 offset:18432
    ds_read_b64 v[116:117], v9 offset:20480
    ds_read_b64 v[118:119], v9 offset:22528
    ds_read_b64 v[120:121], v9 offset:24576
    ds_read_b64 v[122:123], v9 offset:26624
    ds_read_b64 v[124:125], v9 offset:28672
    ds_read_b64 v[126:127], v9 offset:30720
    s_mov_b32 s54, 0x05040100
    s_mov_b32 s53, 0x07060302
    s_waitcnt lgkmcnt(0)
    v_perm_b32 v144, v98, v96, s54
    v_perm_b32 v145, v98, v96, s53
    v_perm_b32 v146, v99, v97, s54
    v_perm_b32 v147, v99, v97, s53
    v_perm_b32 v148, v102, v100, s54
    v_perm_b32 v149, v102, v100, s53
    v_perm_b32 v150, v103, v101, s54
    v_perm_b32 v151, v103, v101, s53
    v_perm_b32 v152, v106, v104, s54
    v_perm_b32 v153, v106, v104, s53
    v_perm_b32 v154, v107, v105, s54
    v_perm_b32 v155, v107, v105, s53
    v_perm_b32 v156, v110, v108, s54
    v_perm_b32 v157, v110, v108, s53
    v_perm_b32 v158, v111, v109, s54
    v_perm_b32 v159, v111, v109, s53
    v_perm_b32 v160, v114, v112, s54
    v_perm_b32 v161, v114, v112, s53
    v_perm_b32 v162, v115, v113, s54
    v_perm_b32 v163, v115, v113, s53
    v_perm_b32 v164, v118, v116, s54
    v_perm_b32 v165, v118, v116, s53
    v_perm_b32 v166, v119, v117, s54
    v_perm_b32 v167, v119, v117, s53
    v_perm_b32 v168, v122, v120, s54
    v_perm_b32 v169, v122, v120, s53
    v_perm_b32 v170, v123, v121, s54
    v_perm_b32 v171, v123, v121, s53
    v_perm_b32 v172, v126, v124, s54
    v_perm_b32 v173, v126, v124, s53
    v_perm_b32 v174, v127, v125, s54
    v_perm_b32 v175, v127, v125, s53
    s_mov_b32 s34, 24708
    s_mov_b32 s36, s42
    s_and_b32 s37, s43, 0xffff
    s_mov_b32 s38, 0x400000
    s_mov_b32 s39, 0x00020000
    s_add_u32 s48, s6, 0x4900000
    s_addc_u32 s49, s7, 0
    s_and_b32 s49, s49, 0xffff
    s_mov_b32 s50, 0x1c0000
    s_mov_b32 s51, 0x00020000
    v_lshlrev_b32 v10, 5, v2
    v_lshl_add_u32 v11, s30, 1, v5
    s_lshl_b32 s31, s2, 3
    v_add_u32 v11, s31, v11
    v_lshl_add_u32 v0, v11, 11, v7
    s_cmp_lg_u32 s30, 0
    s_cbranch_scc1 ff_go_149
    s_mov_b32 s52, 1048576
ff_poll_150:
    buffer_load_dword v13, v14, s[16:19], s59 offen sc1
    s_sub_u32 s52, s52, 1
    s_cbranch_scc1 ff_go_149
    s_waitcnt vmcnt(0)
    v_cmp_gt_u32 vcc, 64, v13
    s_cbranch_vccz ff_go_149
    s_sleep 4
    s_branch ff_poll_150
ff_go_149:
    s_barrier
    s_mov_b32 s31, 0
    buffer_load_dwordx4 v[16:19], v10, s[32:35], s31 offen sc1
    buffer_load_dwordx4 v[20:23], v10, s[32:35], s31 offen offset:16 sc1
    s_mov_b32 s31, 8192
    buffer_load_dwordx4 v[24:27], v10, s[32:35], s31 offen sc1
    buffer_load_dwordx4 v[28:31], v10, s[32:35], s31 offen offset:16 sc1
    s_mov_b32 s31, 16384
    buffer_load_dwordx4 v[32:35], v10, s[32:35], s31 offen sc1
    buffer_load_dwordx4 v[36:39], v10, s[32:35], s31 offen offset:16 sc1
    s_mov_b32 s31, 24704
    buffer_load_dword v10, v75, s[32:35], s31 offen sc1
    s_mov_b32 s52, 0x3a800000
    s_mov_b32 s53, 0x3a800000
    s_mov_b32 s54, 0x7ff
    v_mov_b32 v14, 0x3727c5ac
    v_mov_b32 v15, v14
    v_mov_b32 v12, 0xff800000
    v_mov_b32 v13, v12
    s_waitcnt vmcnt(0)
    v_sub_f32 v56, 0, v10
    v_sub_f32 v57, 0, v10
    v_pk_mul_f32 v[16:17], v[16:17], s[52:53]
    v_pk_fma_f32 v[24:25], v[24:25], s[52:53], v[14:15]
    v_pk_fma_f32 v[32:33], v[16:17], v[56:57], v[32:33]
    v_pk_fma_f32 v[24:25], v[16:17], v[16:17], v[24:25] neg_lo:[1,0,0] neg_hi:[1,0,0]
    v_pk_mul_f32 v[18:19], v[18:19], s[52:53]
    v_pk_fma_f32 v[26:27], v[26:27], s[52:53], v[14:15]
    v_pk_fma_f32 v[34:35], v[18:19], v[56:57], v[34:35]
    v_pk_fma_f32 v[26:27], v[18:19], v[18:19], v[26:27] neg_lo:[1,0,0] neg_hi:[1,0,0]
    v_pk_mul_f32 v[20:21], v[20:21], s[52:53]
    v_pk_fma_f32 v[28:29], v[28:29], s[52:53], v[14:15]
    v_pk_fma_f32 v[36:37], v[20:21], v[56:57], v[36:37]
    v_pk_fma_f32 v[28:29], v[20:21], v[20:21], v[28:29] neg_lo:[1,0,0] neg_hi:[1,0,0]
    v_pk_mul_f32 v[22:23], v[22:23], s[52:53]
    v_pk_fma_f32 v[30:31], v[30:31], s[52:53], v[14:15]
    v_pk_fma_f32 v[38:39], v[22:23], v[56:57], v[38:39]
    v_pk_fma_f32 v[30:31], v[22:23], v[22:23], v[30:31] neg_lo:[1,0,0] neg_hi:[1,0,0]
    v_max_f32 v24, v14, v24
    v_max_f32 v25, v14, v25
    v_max_f32 v26, v14, v26
    v_max_f32 v27, v14, v27
    v_max_f32 v28, v14, v28
    v_max_f32 v29, v14, v29
    v_max_f32 v30, v14, v30
    v_max_f32 v31, v14, v31
    v_rsq_f32 v24, v24
    v_rsq_f32 v25, v25
    v_rsq_f32 v26, v26
    v_rsq_f32 v27, v27
    v_rsq_f32 v28, v28
    v_rsq_f32 v29, v29
    v_rsq_f32 v30, v30
    v_rsq_f32 v31, v31
    v_pk_mul_f32 v[32:33], v[32:33], v[24:25]
    v_pk_mul_f32 v[34:35], v[34:35], v[26:27]
    v_pk_mul_f32 v[36:37], v[36:37], v[28:29]
    v_pk_mul_f32 v[38:39], v[38:39], v[30:31]
    v_bfi_b32 v32, s54, 0, v32
    v_med3_f32 v13, v12, v13, v32
    v_max_f32 v12, v12, v32
    v_bfi_b32 v33, s54, 1, v33
    v_med3_f32 v13, v12, v13, v33
    v_max_f32 v12, v12, v33
    v_bfi_b32 v34, s54, 2, v34
    v_med3_f32 v13, v12, v13, v34
    v_max_f32 v12, v12, v34
    v_bfi_b32 v35, s54, 3, v35
    v_med3_f32 v13, v12, v13, v35
    v_max_f32 v12, v12, v35
    v_bfi_b32 v36, s54, 4, v36
    v_med3_f32 v13, v12, v13, v36
    v_max_f32 v12, v12, v36
    v_bfi_b32 v37, s54, 5, v37
    v_med3_f32 v13, v12, v13, v37
    v_max_f32 v12, v12, v37
    v_bfi_b32 v38, s54, 6, v38
    v_med3_f32 v13, v12, v13, v38
    v_max_f32 v12, v12, v38
    v_bfi_b32 v39, s54, 7, v39
    v_med3_f32 v13, v12, v13, v39
    v_max_f32 v12, v12, v39
    v_lshl_or_b32 v12, v2, 3, v12
    v_lshl_or_b32 v13, v2, 3, v13
    s_nop 1
    v_mov_b32_dpp v14, v12 quad_perm:[1,0,3,2] row_mask:0xf bank_mask:0xf
    v_mov_b32_dpp v15, v13 quad_perm:[1,0,3,2] row_mask:0xf bank_mask:0xf
    v_max_f32 v15, v15, v13
    v_med3_f32 v13, v12, v14, v15
    v_max_f32 v12, v12, v14
    s_nop 1
    v_mov_b32_dpp v14, v12 quad_perm:[2,3,0,1] row_mask:0xf bank_mask:0xf
    v_mov_b32_dpp v15, v13 quad_perm:[2,3,0,1] row_mask:0xf bank_mask:0xf
    v_max_f32 v15, v15, v13
    v_med3_f32 v13, v12, v14, v15
    v_max_f32 v12, v12, v14
    s_nop 1
    v_mov_b32_dpp v14, v12 row_half_mirror row_mask:0xf bank_mask:0xf
    v_mov_b32_dpp v15, v13 row_half_mirror row_mask:0xf bank_mask:0xf
    v_max_f32 v15, v15, v13
    v_med3_f32 v13, v12, v14, v15
    v_max_f32 v12, v12, v14
    s_nop 1
    v_mov_b32_dpp v14, v12 row_mirror row_mask:0xf bank_mask:0xf
    v_mov_b32_dpp v15, v13 row_mirror row_mask:0xf bank_mask:0xf
    v_max_f32 v15, v15, v13
    v_med3_f32 v13, v12, v14, v15
    v_max_f32 v12, v12, v14
    v_mov_b32 v14, v12
    v_mov_b32 v15, v13
    s_nop 1
    v_permlane16_swap_b32 v12, v14
    v_permlane16_swap_b32 v13, v15
    s_nop 1
    v_max_f32 v15, v15, v13
    v_med3_f32 v13, v12, v14, v15
    v_max_f32 v12, v12, v14
    v_mov_b32 v14, v12
    v_mov_b32 v15, v13
    s_nop 1
    v_permlane32_swap_b32 v12, v14
    v_permlane32_swap_b32 v13, v15
    s_nop 1
    v_max_f32 v15, v15, v13
    v_med3_f32 v13, v12, v14, v15
    v_max_f32 v12, v12, v14
    s_lshl_b32 s31, s30, 3
    s_add_u32 s31, s31, 8192
    v_mov_b32 v14, s31
    ds_write_b64 v14, v[12:13]
    v_mov_b32 v14, 8192
    s_waitcnt lgkmcnt(0)
    s_barrier
    ds_read_b128 v[16:19], v14
    ds_read_b128 v[20:23], v14 offset:16
    v_cmp_eq_u32 vcc, 0, v5
    s_waitcnt lgkmcnt(0)
    v_max_f32 v19, v19, v17
    v_med3_f32 v17, v16, v18, v19
    v_max_f32 v16, v16, v18
    v_max_f32 v23, v23, v21
    v_med3_f32 v21, v20, v22, v23
    v_max_f32 v20, v20, v22
    v_max_f32 v21, v21, v17
    v_med3_f32 v17, v16, v20, v21
    v_max_f32 v16, v16, v20
    v_and_b32 v16, 0x7ff, v16
    v_and_b32 v17, 0x7ff, v17
    v_cndmask_b32 v15, v17, v16, vcc
    v_lshl_add_u32 v12, v15, 11, v7
    buffer_load_dwordx4 v[40:43], v12, s[24:27], 0 offen offset:0 sc1
    buffer_load_dwordx4 v[44:47], v12, s[24:27], 0 offen offset:512 sc1
    buffer_load_dwordx4 v[48:51], v12, s[24:27], 0 offen offset:1024 sc1
    buffer_load_dwordx4 v[52:55], v12, s[24:27], 0 offen offset:1536 sc1
    buffer_load_dwordx4 v[128:131], v0, s[24:27], 0 offen offset:0 sc1
    buffer_load_dwordx4 v[132:135], v0, s[24:27], 0 offen offset:512 sc1
    buffer_load_dwordx4 v[136:139], v0, s[24:27], 0 offen offset:1024 sc1
    buffer_load_dwordx4 v[140:143], v0, s[24:27], 0 offen offset:1536 sc1
    v_cmp_eq_u32 vcc, v16, v11
    v_cmp_eq_u32 s[52:53], v17, v11
    v_mov_b32 v13, 0x7fffffff
    s_or_b64 vcc, vcc, s[52:53]
    v_cndmask_b32 v0, v0, v13, vcc
    v_lshl_add_u32 v12, v5, 11, v7
    v_add_u32 v12, 4096, v12
    s_mov_b32 s58, 0
    s_waitcnt vmcnt(4)
ff_ln_151:
    v_lshlrev_b32 v216, 16, v40
    v_and_b32 v217, 0xffff0000, v40
    v_lshlrev_b32 v218, 16, v41
    v_and_b32 v219, 0xffff0000, v41
    v_lshlrev_b32 v220, 16, v42
    v_and_b32 v221, 0xffff0000, v42
    v_lshlrev_b32 v222, 16, v43
    v_and_b32 v223, 0xffff0000, v43
    v_lshlrev_b32 v224, 16, v44
    v_and_b32 v225, 0xffff0000, v44
    v_lshlrev_b32 v226, 16, v45
    v_and_b32 v227, 0xffff0000, v45
    v_lshlrev_b32 v228, 16, v46
    v_and_b32 v229, 0xffff0000, v46
    v_lshlrev_b32 v230, 16, v47
    v_and_b32 v231, 0xffff0000, v47
    v_lshlrev_b32 v232, 16, v48
    v_and_b32 v233, 0xffff0000, v48
    v_lshlrev_b32 v234, 16, v49
    v_and_b32 v235, 0xffff0000, v49
    v_lshlrev_b32 v236, 16, v50
    v_and_b32 v237, 0xffff0000, v50
    v_lshlrev_b32 v238, 16, v51
    v_and_b32 v239, 0xffff0000, v51
    v_lshlrev_b32 v240, 16, v52
    v_and_b32 v241, 0xffff0000, v52
    v_lshlrev_b32 v242, 16, v53
    v_and_b32 v243, 0xffff0000, v53
    v_lshlrev_b32 v244, 16, v54
    v_and_b32 v245, 0xffff0000, v54
    v_lshlrev_b32 v246, 16, v55
    v_and_b32 v247, 0xffff0000, v55
    v_pk_add_f32 v[208:209], v[216:217], v[218:219]
    v_pk_add_f32 v[210:211], v[220:221], v[222:223]
    v_pk_add_f32 v[208:209], v[208:209], v[224:225]
    v_pk_add_f32 v[210:211], v[210:211], v[226:227]
    v_pk_add_f32 v[208:209], v[208:209], v[228:229]
    v_pk_add_f32 v[210:211], v[210:211], v[230:231]
    v_pk_add_f32 v[208:209], v[208:209], v[232:233]
    v_pk_add_f32 v[210:211], v[210:211], v[234:235]
    v_pk_add_f32 v[208:209], v[208:209], v[236:237]
    v_pk_add_f32 v[210:211], v[210:211], v[238:239]
    v_pk_add_f32 v[208:209], v[208:209], v[240:241]
    v_pk_add_f32 v[210:211], v[210:211], v[242:243]
    v_pk_add_f32 v[208:209], v[208:209], v[244:245]
    v_pk_add_f32 v[210:211], v[210:211], v[246:247]
    v_pk_add_f32 v[208:209], v[208:209], v[210:211]
    v_add_f32 v208, v208, v209
    s_nop 1
    v_add_f32_dpp v208, v208, v208 quad_perm:[1,0,3,2] row_mask:0xf bank_mask:0xf
    s_nop 1
    v_add_f32_dpp v208, v208, v208 quad_perm:[2,3,0,1] row_mask:0xf bank_mask:0xf
    s_nop 1
    v_add_f32_dpp v208, v208, v208 row_half_mirror row_mask:0xf bank_mask:0xf
    s_nop 1
    v_add_f32_dpp v208, v208, v208 row_mirror row_mask:0xf bank_mask:0xf
    v_mov_b32 v210, v208
    s_nop 1
    v_permlane16_swap_b32 v208, v210
    s_nop 1
    v_add_f32 v208, v208, v210
    v_mul_f32 v208, 0xba800000, v208
    v_mov_b32 v209, v208
    v_pk_add_f32 v[210:211], v[216:217], v[208:209]
    v_pk_add_f32 v[214:215], v[218:219], v[208:209]
    v_pk_mul_f32 v[212:213], v[210:211], v[210:211]
    v_pk_fma_f32 v[212:213], v[214:215], v[214:215], v[212:213]
    v_pk_add_f32 v[210:211], v[220:221], v[208:209]
    v_pk_add_f32 v[214:215], v[222:223], v[208:209]
    v_pk_fma_f32 v[212:213], v[210:211], v[210:211], v[212:213]
    v_pk_fma_f32 v[212:213], v[214:215], v[214:215], v[212:213]
    v_pk_add_f32 v[210:211], v[224:225], v[208:209]
    v_pk_add_f32 v[214:215], v[226:227], v[208:209]
    v_pk_fma_f32 v[212:213], v[210:211], v[210:211], v[212:213]
    v_pk_fma_f32 v[212:213], v[214:215], v[214:215], v[212:213]
    v_pk_add_f32 v[210:211], v[228:229], v[208:209]
    v_pk_add_f32 v[214:215], v[230:231], v[208:209]
    v_pk_fma_f32 v[212:213], v[210:211], v[210:211], v[212:213]
    v_pk_fma_f32 v[212:213], v[214:215], v[214:215], v[212:213]
    v_pk_add_f32 v[210:211], v[232:233], v[208:209]
    v_pk_add_f32 v[214:215], v[234:235], v[208:209]
    v_pk_fma_f32 v[212:213], v[210:211], v[210:211], v[212:213]
    v_pk_fma_f32 v[212:213], v[214:215], v[214:215], v[212:213]
    v_pk_add_f32 v[210:211], v[236:237], v[208:209]
    v_pk_add_f32 v[214:215], v[238:239], v[208:209]
    v_pk_fma_f32 v[212:213], v[210:211], v[210:211], v[212:213]
    v_pk_fma_f32 v[212:213], v[214:215], v[214:215], v[212:213]
    v_pk_add_f32 v[210:211], v[240:241], v[208:209]
    v_pk_add_f32 v[214:215], v[242:243], v[208:209]
    v_pk_fma_f32 v[212:213], v[210:211], v[210:211], v[212:213]
    v_pk_fma_f32 v[212:213], v[214:215], v[214:215], v[212:213]
    v_pk_add_f32 v[210:211], v[244:245], v[208:209]
    v_pk_add_f32 v[214:215], v[246:247], v[208:209]
    v_pk_fma_f32 v[212:213], v[210:211], v[210:211], v[212:213]
    v_pk_fma_f32 v[212:213], v[214:215], v[214:215], v[212:213]
    v_add_f32 v212, v212, v213
    s_nop 1
    v_add_f32_dpp v212, v212, v212 quad_perm:[1,0,3,2] row_mask:0xf bank_mask:0xf
    s_nop 1
    v_add_f32_dpp v212, v212, v212 quad_perm:[2,3,0,1] row_mask:0xf bank_mask:0xf
    s_nop 1
    v_add_f32_dpp v212, v212, v212 row_half_mirror row_mask:0xf bank_mask:0xf
    s_nop 1
    v_add_f32_dpp v212, v212, v212 row_mirror row_mask:0xf bank_mask:0xf
    v_mov_b32 v210, v212
    s_nop 1
    v_permlane16_swap_b32 v212, v210
    s_nop 1
    v_add_f32 v212, v212, v210
    v_mul_f32 v212, 0x3a800000, v212
    v_cvt_pk_bf16_f32 v214, v208, v212
    v_and_b32 v212, 0xffff0000, v214
    v_lshlrev_b32 v214, 16, v214
    v_add_f32 v212, 0x3727c5ac, v212
    v_mov_b32 v215, v214
    v_cvt_pk_bf16_f32 v212, v212, v212
    v_and_b32 v212, 0xffff0000, v212
    v_sqrt_f32 v212, v212
    v_pk_add_f32 v[176:177], v[216:217], v[214:215]
    v_pk_add_f32 v[178:179], v[218:219], v[214:215]
    v_pk_add_f32 v[180:181], v[220:221], v[214:215]
    v_pk_add_f32 v[182:183], v[222:223], v[214:215]
    v_pk_add_f32 v[184:185], v[224:225], v[214:215]
    v_pk_add_f32 v[186:187], v[226:227], v[214:215]
    v_pk_add_f32 v[188:189], v[228:229], v[214:215]
    v_pk_add_f32 v[190:191], v[230:231], v[214:215]
    v_pk_add_f32 v[192:193], v[232:233], v[214:215]
    v_pk_add_f32 v[194:195], v[234:235], v[214:215]
    v_pk_add_f32 v[196:197], v[236:237], v[214:215]
    v_pk_add_f32 v[198:199], v[238:239], v[214:215]
    v_pk_add_f32 v[200:201], v[240:241], v[214:215]
    v_pk_add_f32 v[202:203], v[242:243], v[214:215]
    v_pk_add_f32 v[204:205], v[244:245], v[214:215]
    v_pk_add_f32 v[206:207], v[246:247], v[214:215]
    v_cvt_pk_bf16_f32 v212, v212, v212
    v_and_b32 v212, 0xffff0000, v212
    v_rcp_f32 v212, v212
    v_cvt_pk_bf16_f32 v40, v176, v177
    v_cvt_pk_bf16_f32 v41, v178, v179
    v_cvt_pk_bf16_f32 v42, v180, v181
    v_cvt_pk_bf16_f32 v43, v182, v183
    v_cvt_pk_bf16_f32 v44, v184, v185
    v_cvt_pk_bf16_f32 v45, v186, v187
    v_cvt_pk_bf16_f32 v46, v188, v189
    v_cvt_pk_bf16_f32 v47, v190, v191
    v_cvt_pk_bf16_f32 v48, v192, v193
    v_cvt_pk_bf16_f32 v49, v194, v195
    v_cvt_pk_bf16_f32 v50, v196, v197
    v_cvt_pk_bf16_f32 v51, v198, v199
    v_cvt_pk_bf16_f32 v52, v200, v201
    v_cvt_pk_bf16_f32 v53, v202, v203
    v_cvt_pk_bf16_f32 v54, v204, v205
    v_cvt_pk_bf16_f32 v55, v206, v207
    v_mov_b32 v213, v212
    v_lshlrev_b32 v176, 16, v40
    v_and_b32 v177, 0xffff0000, v40
    v_lshlrev_b32 v178, 16, v41
    v_and_b32 v179, 0xffff0000, v41
    v_lshlrev_b32 v180, 16, v42
    v_and_b32 v181, 0xffff0000, v42
    v_lshlrev_b32 v182, 16, v43
    v_and_b32 v183, 0xffff0000, v43
    v_lshlrev_b32 v184, 16, v44
    v_and_b32 v185, 0xffff0000, v44
    v_lshlrev_b32 v186, 16, v45
    v_and_b32 v187, 0xffff0000, v45
    v_lshlrev_b32 v188, 16, v46
    v_and_b32 v189, 0xffff0000, v46
    v_lshlrev_b32 v190, 16, v47
    v_and_b32 v191, 0xffff0000, v47
    v_lshlrev_b32 v192, 16, v48
    v_and_b32 v193, 0xffff0000, v48
    v_lshlrev_b32 v194, 16, v49
    v_and_b32 v195, 0xffff0000, v49
    v_lshlrev_b32 v196, 16, v50
    v_and_b32 v197, 0xffff0000, v50
    v_lshlrev_b32 v198, 16, v51
    v_and_b32 v199, 0xffff0000, v51
    v_lshlrev_b32 v200, 16, v52
    v_and_b32 v201, 0xffff0000, v52
    v_lshlrev_b32 v202, 16, v53
    v_and_b32 v203, 0xffff0000, v53
    v_lshlrev_b32 v204, 16, v54
    v_and_b32 v205, 0xffff0000, v54
    v_lshlrev_b32 v206, 16, v55
    v_and_b32 v207, 0xffff0000, v55
    v_pk_mul_f32 v[176:177], v[176:177], v[212:213]
    v_pk_mul_f32 v[178:179], v[178:179], v[212:213]
    v_pk_mul_f32 v[180:181], v[180:181], v[212:213]
    v_pk_mul_f32 v[182:183], v[182:183], v[212:213]
    v_pk_mul_f32 v[184:185], v[184:185], v[212:213]
    v_pk_mul_f32 v[186:187], v[186:187], v[212:213]
    v_pk_mul_f32 v[188:189], v[188:189], v[212:213]
    v_pk_mul_f32 v[190:191], v[190:191], v[212:213]
    v_pk_mul_f32 v[192:193], v[192:193], v[212:213]
    v_pk_mul_f32 v[194:195], v[194:195], v[212:213]
    v_pk_mul_f32 v[196:197], v[196:197], v[212:213]
    v_pk_mul_f32 v[198:199], v[198:199], v[212:213]
    v_pk_mul_f32 v[200:201], v[200:201], v[212:213]
    v_pk_mul_f32 v[202:203], v[202:203], v[212:213]
    v_pk_mul_f32 v[204:205], v[204:205], v[212:213]
    v_pk_mul_f32 v[206:207], v[206:207], v[212:213]
    v_cvt_pk_bf16_f32 v40, v176, v177
    v_cvt_pk_bf16_f32 v41, v178, v179
    v_cvt_pk_bf16_f32 v42, v180, v181
    v_cvt_pk_bf16_f32 v43, v182, v183
    v_cvt_pk_bf16_f32 v44, v184, v185
    v_cvt_pk_bf16_f32 v45, v186, v187
    v_cvt_pk_bf16_f32 v46, v188, v189
    v_cvt_pk_bf16_f32 v47, v190, v191
    v_cvt_pk_bf16_f32 v48, v192, v193
    v_cvt_pk_bf16_f32 v49, v194, v195
    v_cvt_pk_bf16_f32 v50, v196, v197
    v_cvt_pk_bf16_f32 v51, v198, v199
    v_cvt_pk_bf16_f32 v52, v200, v201
    v_cvt_pk_bf16_f32 v53, v202, v203
    v_cvt_pk_bf16_f32 v54, v204, v205
    v_cvt_pk_bf16_f32 v55, v206, v207
    s_cmp_lg_u32 s58, 0
    s_cbranch_scc1 ff_own_152
    ds_write_b128 v12, v[40:43] offset:0
    ds_write_b128 v12, v[44:47] offset:512
    ds_write_b128 v12, v[48:51] offset:1024
    ds_write_b128 v12, v[52:55] offset:1536
    s_cmp_ge_u32 s2, 224
    s_cbranch_scc1 ff_red_153
    v_lshrrev_b32 v12, 4, v3
    v_and_b32 v13, 1, v3
    v_lshlrev_b32 v13, 11, v13
    v_lshl_add_u32 v13, v12, 3, v13
    s_lshl_b32 s54, s30, 9
    s_add_u32 s54, s54, 4096
    v_add_u32 v13, s54, v13
    v_lshlrev_b32 v14, 3, v3
    s_lshl_b32 s54, s30, 13
    s_add_u32 s54, s54, 65536
    v_add_u32 v14, s54, v14
    ds_read_b64_tr_b16 a[0:1], v14 offset:0
    ds_read_b64_tr_b16 a[2:3], v14 offset:512
    ds_read_b64_tr_b16 a[4:5], v14 offset:1024
    ds_read_b64_tr_b16 a[6:7], v14 offset:1536
    ds_read_b64_tr_b16 a[8:9], v14 offset:2048
    ds_read_b64_tr_b16 a[10:11], v14 offset:2560
    ds_read_b64_tr_b16 a[12:13], v14 offset:3072
    ds_read_b64_tr_b16 a[14:15], v14 offset:3584
    ds_read_b64_tr_b16 a[16:17], v14 offset:4096
    ds_read_b64_tr_b16 a[18:19], v14 offset:4608
    ds_read_b64_tr_b16 a[20:21], v14 offset:5120
    ds_read_b64_tr_b16 a[22:23], v14 offset:5632
    ds_read_b64_tr_b16 a[24:25], v14 offset:6144
    ds_read_b64_tr_b16 a[26:27], v14 offset:6656
    ds_read_b64_tr_b16 a[28:29], v14 offset:7168
    ds_read_b64_tr_b16 a[30:31], v14 offset:7680
    ds_read_b64_tr_b16 a[32:33], v14 offset:32768
    ds_read_b64_tr_b16 a[34:35], v14 offset:33280
    ds_read_b64_tr_b16 a[36:37], v14 offset:33792
    ds_read_b64_tr_b16 a[38:39], v14 offset:34304
    ds_read_b64_tr_b16 a[40:41], v14 offset:34816
    ds_read_b64_tr_b16 a[42:43], v14 offset:35328
    ds_read_b64_tr_b16 a[44:45], v14 offset:35840
    ds_read_b64_tr_b16 a[46:47], v14 offset:36352
    ds_read_b64_tr_b16 a[48:49], v14 offset:36864
    ds_read_b64_tr_b16 a[50:51], v14 offset:37376
    ds_read_b64_tr_b16 a[52:53], v14 offset:37888
    ds_read_b64_tr_b16 a[54:55], v14 offset:38400
    ds_read_b64_tr_b16 a[56:57], v14 offset:38912
    ds_read_b64_tr_b16 a[58:59], v14 offset:39424
    ds_read_b64_tr_b16 a[60:61], v14 offset:39936
    ds_read_b64_tr_b16 a[62:63], v14 offset:40448
    ds_read_b64 a[64:65], v13 offset:0
    ds_read_b64 a[66:67], v13 offset:32
    ds_read_b64 a[68:69], v13 offset:64
    ds_read_b64 a[70:71], v13 offset:96
    ds_read_b64 a[72:73], v13 offset:128
    ds_read_b64 a[74:75], v13 offset:160
    ds_read_b64 a[76:77], v13 offset:192
    ds_read_b64 a[78:79], v13 offset:224
    ds_read_b64 a[80:81], v13 offset:256
    ds_read_b64 a[82:83], v13 offset:288
    ds_read_b64 a[84:85], v13 offset:320
    ds_read_b64 a[86:87], v13 offset:352
    ds_read_b64 a[88:89], v13 offset:384
    ds_read_b64 a[90:91], v13 offset:416
    ds_read_b64 a[92:93], v13 offset:448
    ds_read_b64 a[94:95], v13 offset:480
    v_lshlrev_b32 v13, 6, v8
    v_lshl_add_u32 v13, v12, 4, v13
    s_lshl_b32 s54, s30, 11
    s_add_u32 s54, s54, 8448
    v_add_u32 v13, s54, v13
    s_waitcnt lgkmcnt(0)
    v_mfma_f32_16x16x32_bf16 v[16:19], a[0:3], a[64:67], 0
    v_mfma_f32_16x16x32_bf16 v[20:23], a[32:35], a[64:67], 0
    v_mfma_f32_16x16x32_bf16 v[16:19], a[4:7], a[68:71], v[16:19]
    v_mfma_f32_16x16x32_bf16 v[20:23], a[36:39], a[68:71], v[20:23]
    v_mfma_f32_16x16x32_bf16 v[16:19], a[8:11], a[72:75], v[16:19]
    v_mfma_f32_16x16x32_bf16 v[20:23], a[40:43], a[72:75], v[20:23]
    v_mfma_f32_16x16x32_bf16 v[16:19], a[12:15], a[76:79], v[16:19]
    v_mfma_f32_16x16x32_bf16 v[20:23], a[44:47], a[76:79], v[20:23]
    v_mfma_f32_16x16x32_bf16 v[16:19], a[16:19], a[80:83], v[16:19]
    v_mfma_f32_16x16x32_bf16 v[20:23], a[48:51], a[80:83], v[20:23]
    v_mfma_f32_16x16x32_bf16 v[16:19], a[20:23], a[84:87], v[16:19]
    v_mfma_f32_16x16x32_bf16 v[20:23], a[52:55], a[84:87], v[20:23]
    v_mfma_f32_16x16x32_bf16 v[16:19], a[24:27], a[88:91], v[16:19]
    v_mfma_f32_16x16x32_bf16 v[20:23], a[56:59], a[88:91], v[20:23]
    v_mfma_f32_16x16x32_bf16 v[16:19], a[28:31], a[92:95], v[16:19]
    v_mfma_f32_16x16x32_bf16 v[20:23], a[60:63], a[92:95], v[20:23]
    s_nop 7
    ds_write_b128 v13, v[16:19]
    ds_write_b128 v13, v[20:23] offset:1024
    v_lshlrev_b32 v13, 2, v4
    v_add_u32 v13, 8448, v13
    s_waitcnt lgkmcnt(0)
    s_barrier
    ds_read2st64_b32 v[16:17], v13 offset0:0 offset1:4
    ds_read2st64_b32 v[18:19], v13 offset0:8 offset1:12
    ds_read2st64_b32 v[20:21], v13 offset0:16 offset1:20
    ds_read2st64_b32 v[22:23], v13 offset0:24 offset1:28
    s_waitcnt lgkmcnt(0)
    v_pk_add_f32 v[16:17], v[16:17], v[20:21]
    v_pk_add_f32 v[18:19], v[18:19], v[22:23]
    v_pk_add_f32 v[16:17], v[16:17], v[18:19]
    v_cvt_pk_bf16_f32 v16, v16, v17
    v_and_b32 v20, 0xffff0000, v16
    v_lshlrev_b32 v16, 16, v16
    v_mul_f32 v17, 0xbfb8aa3b, v16
    v_exp_f32 v17, v17
    s_lshl_b32 s54, s55, 13
    v_add_f32 v17, 1.0, v17
    v_rcp_f32 v17, v17
    s_add_u32 s53, s54, 4096
    v_mul_f32 v16, v16, v17
    v_cvt_pk_bf16_f32 v16, v16, v16
    v_and_b32 v16, 0xffff0000, v16
    v_mul_f32 v16, v16, v20
    s_nop 1
    v_mov_b32_dpp v17, v16 quad_perm:[1,0,3,2] row_mask:0xf bank_mask:0xf
    v_cvt_pk_bf16_f32 v16, v16, v17
    v_lshlrev_b32 v13, 4, v2
    v_readlane_b32 s8, v16, 0
    v_readlane_b32 s9, v16, 2
    v_readlane_b32 s10, v16, 4
    v_readlane_b32 s11, v16, 6
    v_readlane_b32 s12, v16, 8
    v_readlane_b32 s13, v16, 10
    v_readlane_b32 s14, v16, 12
    v_readlane_b32 s15, v16, 14
    v_readlane_b32 s16, v16, 16
    v_readlane_b32 s17, v16, 18
    v_readlane_b32 s18, v16, 20
    v_readlane_b32 s19, v16, 22
    v_readlane_b32 s20, v16, 24
    v_readlane_b32 s21, v16, 26
    v_readlane_b32 s22, v16, 28
    v_readlane_b32 s23, v16, 30
    v_dot2_f32_bf16 v24, v144, s8, 0
    v_dot2_f32_bf16 v25, v145, s8, 0
    v_dot2_f32_bf16 v26, v146, s8, 0
    v_dot2_f32_bf16 v27, v147, s8, 0
    v_dot2_f32_bf16 v24, v148, s9, v24
    v_dot2_f32_bf16 v25, v149, s9, v25
    v_dot2_f32_bf16 v26, v150, s9, v26
    v_dot2_f32_bf16 v27, v151, s9, v27
    v_dot2_f32_bf16 v24, v152, s10, v24
    v_dot2_f32_bf16 v25, v153, s10, v25
    v_dot2_f32_bf16 v26, v154, s10, v26
    v_dot2_f32_bf16 v27, v155, s10, v27
    v_dot2_f32_bf16 v24, v156, s11, v24
    v_dot2_f32_bf16 v25, v157, s11, v25
    v_dot2_f32_bf16 v26, v158, s11, v26
    v_dot2_f32_bf16 v27, v159, s11, v27
    v_dot2_f32_bf16 v24, v160, s12, v24
    v_dot2_f32_bf16 v25, v161, s12, v25
    v_dot2_f32_bf16 v26, v162, s12, v26
    v_dot2_f32_bf16 v27, v163, s12, v27
    v_dot2_f32_bf16 v24, v164, s13, v24
    v_dot2_f32_bf16 v25, v165, s13, v25
    v_dot2_f32_bf16 v26, v166, s13, v26
    v_dot2_f32_bf16 v27, v167, s13, v27
    v_dot2_f32_bf16 v24, v168, s14, v24
    v_dot2_f32_bf16 v25, v169, s14, v25
    v_dot2_f32_bf16 v26, v170, s14, v26
    v_dot2_f32_bf16 v27, v171, s14, v27
    v_dot2_f32_bf16 v24, v172, s15, v24
    v_dot2_f32_bf16 v25, v173, s15, v25
    v_dot2_f32_bf16 v26, v174, s15, v26
    v_dot2_f32_bf16 v27, v175, s15, v27
    v_dot2_f32_bf16 v28, v144, s16, 0
    v_dot2_f32_bf16 v29, v145, s16, 0
    v_dot2_f32_bf16 v30, v146, s16, 0
    v_dot2_f32_bf16 v31, v147, s16, 0
    v_dot2_f32_bf16 v28, v148, s17, v28
    v_dot2_f32_bf16 v29, v149, s17, v29
    v_dot2_f32_bf16 v30, v150, s17, v30
    v_dot2_f32_bf16 v31, v151, s17, v31
    v_dot2_f32_bf16 v28, v152, s18, v28
    v_dot2_f32_bf16 v29, v153, s18, v29
    v_dot2_f32_bf16 v30, v154, s18, v30
    v_dot2_f32_bf16 v31, v155, s18, v31
    v_dot2_f32_bf16 v28, v156, s19, v28
    v_dot2_f32_bf16 v29, v157, s19, v29
    v_dot2_f32_bf16 v30, v158, s19, v30
    v_dot2_f32_bf16 v31, v159, s19, v31
    v_dot2_f32_bf16 v28, v160, s20, v28
    v_dot2_f32_bf16 v29, v161, s20, v29
    v_dot2_f32_bf16 v30, v162, s20, v30
    v_dot2_f32_bf16 v31, v163, s20, v31
    v_dot2_f32_bf16 v28, v164, s21, v28
    v_dot2_f32_bf16 v29, v165, s21, v29
    v_dot2_f32_bf16 v30, v166, s21, v30
    v_dot2_f32_bf16 v31, v167, s21, v31
    v_dot2_f32_bf16 v28, v168, s22, v28
    v_dot2_f32_bf16 v29, v169, s22, v29
    v_dot2_f32_bf16 v30, v170, s22, v30
    v_dot2_f32_bf16 v31, v171, s22, v31
    v_dot2_f32_bf16 v28, v172, s23, v28
    v_dot2_f32_bf16 v29, v173, s23, v29
    v_dot2_f32_bf16 v30, v174, s23, v30
    v_dot2_f32_bf16 v31, v175, s23, v31
    s_nop 2
    v_min_u32 v24, -2, v24
    v_min_u32 v25, -2, v25
    v_min_u32 v26, -2, v26
    v_min_u32 v27, -2, v27
    v_min_u32 v28, -2, v28
    v_min_u32 v29, -2, v29
    v_min_u32 v30, -2, v30
    v_min_u32 v31, -2, v31
    buffer_store_dwordx4 v[24:27], v13, s[48:51], s54 offen sc1
    buffer_store_dwordx4 v[28:31], v13, s[48:51], s53 offen sc1
    s_waitcnt vmcnt(2)
    v_mov_b32 v40, v128
    v_mov_b32 v41, v129
    v_mov_b32 v42, v130
    v_mov_b32 v43, v131
    v_mov_b32 v44, v132
    v_mov_b32 v45, v133
    v_mov_b32 v46, v134
    v_mov_b32 v47, v135
    v_mov_b32 v48, v136
    v_mov_b32 v49, v137
    v_mov_b32 v50, v138
    v_mov_b32 v51, v139
    v_mov_b32 v52, v140
    v_mov_b32 v53, v141
    v_mov_b32 v54, v142
    v_mov_b32 v55, v143
    s_mov_b32 s58, 1
    s_branch ff_ln_151
ff_own_152:
    v_lshlrev_b32 v176, 16, v40
    v_and_b32 v177, 0xffff0000, v40
    v_lshlrev_b32 v178, 16, v41
    v_and_b32 v179, 0xffff0000, v41
    v_lshlrev_b32 v180, 16, v42
    v_and_b32 v181, 0xffff0000, v42
    v_lshlrev_b32 v182, 16, v43
    v_and_b32 v183, 0xffff0000, v43
    v_lshlrev_b32 v184, 16, v44
    v_and_b32 v185, 0xffff0000, v44
    v_lshlrev_b32 v186, 16, v45
    v_and_b32 v187, 0xffff0000, v45
    v_lshlrev_b32 v188, 16, v46
    v_and_b32 v189, 0xffff0000, v46
    v_lshlrev_b32 v190, 16, v47
    v_and_b32 v191, 0xffff0000, v47
    v_lshlrev_b32 v192, 16, v48
    v_and_b32 v193, 0xffff0000, v48
    v_lshlrev_b32 v194, 16, v49
    v_and_b32 v195, 0xffff0000, v49
    v_lshlrev_b32 v196, 16, v50
    v_and_b32 v197, 0xffff0000, v50
    v_lshlrev_b32 v198, 16, v51
    v_and_b32 v199, 0xffff0000, v51
    v_lshlrev_b32 v200, 16, v52
    v_and_b32 v201, 0xffff0000, v52
    v_lshlrev_b32 v202, 16, v53
    v_and_b32 v203, 0xffff0000, v53
    v_lshlrev_b32 v204, 16, v54
    v_and_b32 v205, 0xffff0000, v54
    v_lshlrev_b32 v206, 16, v55
    v_and_b32 v207, 0xffff0000, v55
    v_pk_add_f32 v[176:177], v[176:177], v[216:217]
    v_pk_add_f32 v[178:179], v[178:179], v[218:219]
    v_pk_add_f32 v[180:181], v[180:181], v[220:221]
    v_pk_add_f32 v[182:183], v[182:183], v[222:223]
    v_pk_add_f32 v[184:185], v[184:185], v[224:225]
    v_pk_add_f32 v[186:187], v[186:187], v[226:227]
    v_pk_add_f32 v[188:189], v[188:189], v[228:229]
    v_pk_add_f32 v[190:191], v[190:191], v[230:231]
    v_pk_add_f32 v[192:193], v[192:193], v[232:233]
    v_pk_add_f32 v[194:195], v[194:195], v[234:235]
    v_pk_add_f32 v[196:197], v[196:197], v[236:237]
    v_pk_add_f32 v[198:199], v[198:199], v[238:239]
    v_pk_add_f32 v[200:201], v[200:201], v[240:241]
    v_pk_add_f32 v[202:203], v[202:203], v[242:243]
    v_pk_add_f32 v[204:205], v[204:205], v[244:245]
    v_pk_add_f32 v[206:207], v[206:207], v[246:247]
    v_cvt_pk_bf16_f32 v40, v176, v177
    v_cvt_pk_bf16_f32 v41, v178, v179
    v_cvt_pk_bf16_f32 v42, v180, v181
    v_cvt_pk_bf16_f32 v43, v182, v183
    v_cvt_pk_bf16_f32 v44, v184, v185
    v_cvt_pk_bf16_f32 v45, v186, v187
    v_cvt_pk_bf16_f32 v46, v188, v189
    v_cvt_pk_bf16_f32 v47, v190, v191
    v_cvt_pk_bf16_f32 v48, v192, v193
    v_cvt_pk_bf16_f32 v49, v194, v195
    v_cvt_pk_bf16_f32 v50, v196, v197
    v_cvt_pk_bf16_f32 v51, v198, v199
    v_cvt_pk_bf16_f32 v52, v200, v201
    v_cvt_pk_bf16_f32 v53, v202, v203
    v_cvt_pk_bf16_f32 v54, v204, v205
    v_cvt_pk_bf16_f32 v55, v206, v207
    buffer_store_dwordx4 v[40:43], v0, s[36:39], 0 offen offset:0 sc1
    buffer_store_dwordx4 v[44:47], v0, s[36:39], 0 offen offset:512 sc1
    buffer_store_dwordx4 v[48:51], v0, s[36:39], 0 offen offset:1024 sc1
    buffer_store_dwordx4 v[52:55], v0, s[36:39], 0 offen offset:1536 sc1
    s_cmp_ge_u32 s2, 224
    s_cbranch_scc1 ff_red2_154
    s_branch ff_fin_155
ff_red_153:
    s_sub_u32 s40, s2, 224
    s_lshr_b32 s41, s40, 4
    s_and_b32 s42, s40, 15
    s_mov_b32 s8, s56
    s_and_b32 s9, s57, 0xffff
    s_mov_b32 s10, 0x800
    s_mov_b32 s11, 0x00020000
    buffer_load_dwordx4 v[96:99], v7, s[8:11], 0 offen offset:0
    buffer_load_dwordx4 v[100:103], v7, s[8:11], 0 offen offset:512
    buffer_load_dwordx4 v[104:107], v7, s[8:11], 0 offen offset:1024
    buffer_load_dwordx4 v[108:111], v7, s[8:11], 0 offen offset:1536
    s_lshl_b32 s43, s41, 5
    v_readlane_b32 s46, v15, s43
    s_lshl_b32 s47, s42, 7
    v_lshl_add_u32 v9, v8, 3, s47
    s_lshl_b32 s46, s46, 11
    s_lshl_b32 s31, s41, 11
    s_add_u32 s31, s31, 4096
    v_add_u32 v12, s31, v9
    s_waitcnt lgkmcnt(0)
    ds_read_b64 v[32:33], v12
    buffer_load_dwordx2 v[34:35], v9, s[24:27], s46 offen sc1
    v_lshrrev_b32 v10, 4, v2
    v_lshlrev_b32 v10, 13, v10
    v_lshl_add_u32 v10, v8, 4, v10
    s_lshl_b32 s47, s40, 8
    s_waitcnt vmcnt(1)
    v_dot2_f32_bf16 v12, v40, v96, 0
    v_dot2_f32_bf16 v12, v41, v97, v12
    v_dot2_f32_bf16 v12, v42, v98, v12
    v_dot2_f32_bf16 v12, v43, v99, v12
    v_dot2_f32_bf16 v12, v44, v100, v12
    v_dot2_f32_bf16 v12, v45, v101, v12
    v_dot2_f32_bf16 v12, v46, v102, v12
    v_dot2_f32_bf16 v12, v47, v103, v12
    v_dot2_f32_bf16 v12, v48, v104, v12
    v_dot2_f32_bf16 v12, v49, v105, v12
    v_dot2_f32_bf16 v12, v50, v106, v12
    v_dot2_f32_bf16 v12, v51, v107, v12
    v_dot2_f32_bf16 v12, v52, v108, v12
    v_dot2_f32_bf16 v12, v53, v109, v12
    v_dot2_f32_bf16 v12, v54, v110, v12
    v_dot2_f32_bf16 v12, v55, v111, v12
    s_nop 2
    s_nop 1
    v_add_f32_dpp v12, v12, v12 quad_perm:[1,0,3,2] row_mask:0xf bank_mask:0xf
    s_nop 1
    v_add_f32_dpp v12, v12, v12 quad_perm:[2,3,0,1] row_mask:0xf bank_mask:0xf
    s_nop 1
    v_add_f32_dpp v12, v12, v12 row_half_mirror row_mask:0xf bank_mask:0xf
    s_nop 1
    v_add_f32_dpp v12, v12, v12 row_mirror row_mask:0xf bank_mask:0xf
    v_mov_b32 v13, v12
    s_nop 1
    v_permlane16_swap_b32 v12, v13
    s_nop 1
    v_add_f32 v12, v12, v13
    v_cvt_pk_bf16_f32 v12, v12, v12
    v_and_b32 v12, 0xffff0000, v12
    v_mul_f32 v12, 0xbfb8aa3b, v12
    v_exp_f32 v12, v12
    s_lshl_b32 s44, s42, 1
    v_add_f32 v12, 1.0, v12
    v_rcp_f32 v12, v12
    s_add_u32 s44, s44, s41
    s_lshl_b32 s44, s44, 11
    v_cvt_pk_bf16_f32 v12, v12, v12
    v_and_b32 v12, 0xffff0000, v12
    v_mov_b32 v40, v128
    v_mov_b32 v41, v129
    v_mov_b32 v42, v130
    v_mov_b32 v43, v131
    v_mov_b32 v44, v132
    v_mov_b32 v45, v133
    v_mov_b32 v46, v134
    v_mov_b32 v47, v135
    v_mov_b32 v48, v136
    v_mov_b32 v49, v137
    v_mov_b32 v50, v138
    v_mov_b32 v51, v139
    v_mov_b32 v52, v140
    v_mov_b32 v53, v141
    v_mov_b32 v54, v142
    v_mov_b32 v55, v143
    v_readlane_b32 s45, v12, s43
    s_mov_b32 s58, 1
    s_branch ff_ln_151
ff_red2_154:
    s_mov_b32 s52, 1048576
ff_rpoll_157:
    s_mov_b32 s53, s47
    buffer_load_dwordx4 v[96:99], v10, s[48:51], s53 offen sc1
    s_add_u32 s53, s53, 0x20000
    buffer_load_dwordx4 v[100:103], v10, s[48:51], s53 offen sc1
    s_add_u32 s53, s53, 0x20000
    buffer_load_dwordx4 v[104:107], v10, s[48:51], s53 offen sc1
    s_add_u32 s53, s53, 0x20000
    buffer_load_dwordx4 v[108:111], v10, s[48:51], s53 offen sc1
    s_add_u32 s53, s53, 0x20000
    buffer_load_dwordx4 v[112:115], v10, s[48:51], s53 offen sc1
    s_add_u32 s53, s53, 0x20000
    buffer_load_dwordx4 v[116:119], v10, s[48:51], s53 offen sc1
    s_add_u32 s53, s53, 0x20000
    buffer_load_dwordx4 v[120:123], v10, s[48:51], s53 offen sc1
    s_add_u32 s53, s53, 0x20000
    buffer_load_dwordx4 v[124:127], v10, s[48:51], s53 offen sc1
    s_add_u32 s53, s53, 0x20000
    buffer_load_dwordx4 v[128:131], v10, s[48:51], s53 offen sc1
    s_add_u32 s53, s53, 0x20000
    buffer_load_dwordx4 v[132:135], v10, s[48:51], s53 offen sc1
    s_add_u32 s53, s53, 0x20000
    buffer_load_dwordx4 v[136:139], v10, s[48:51], s53 offen sc1
    s_add_u32 s53, s53, 0x20000
    buffer_load_dwordx4 v[140:143], v10, s[48:51], s53 offen sc1
    s_add_u32 s53, s53, 0x20000
    buffer_load_dwordx4 v[144:147], v10, s[48:51], s53 offen sc1
    s_add_u32 s53, s53, 0x20000
    buffer_load_dwordx4 v[148:151], v10, s[48:51], s53 offen sc1
    s_add_u32 s53, s53, 0x20000
    v_mov_b32 v13, 0
    s_waitcnt vmcnt(13)
    v_max3_u32 v13, v13, v96, v97
    v_max3_u32 v13, v13, v98, v99
    s_waitcnt vmcnt(12)
    v_max3_u32 v13, v13, v100, v101
    v_max3_u32 v13, v13, v102, v103
    s_waitcnt vmcnt(11)
    v_max3_u32 v13, v13, v104, v105
    v_max3_u32 v13, v13, v106, v107
    s_waitcnt vmcnt(10)
    v_max3_u32 v13, v13, v108, v109
    v_max3_u32 v13, v13, v110, v111
    s_waitcnt vmcnt(9)
    v_max3_u32 v13, v13, v112, v113
    v_max3_u32 v13, v13, v114, v115
    s_waitcnt vmcnt(8)
    v_max3_u32 v13, v13, v116, v117
    v_max3_u32 v13, v13, v118, v119
    s_waitcnt vmcnt(7)
    v_max3_u32 v13, v13, v120, v121
    v_max3_u32 v13, v13, v122, v123
    s_waitcnt vmcnt(6)
    v_max3_u32 v13, v13, v124, v125
    v_max3_u32 v13, v13, v126, v127
    s_waitcnt vmcnt(5)
    v_max3_u32 v13, v13, v128, v129
    v_max3_u32 v13, v13, v130, v131
    s_waitcnt vmcnt(4)
    v_max3_u32 v13, v13, v132, v133
    v_max3_u32 v13, v13, v134, v135
    s_waitcnt vmcnt(3)
    v_max3_u32 v13, v13, v136, v137
    v_max3_u32 v13, v13, v138, v139
    s_waitcnt vmcnt(2)
    v_max3_u32 v13, v13, v140, v141
    v_max3_u32 v13, v13, v142, v143
    s_waitcnt vmcnt(1)
    v_max3_u32 v13, v13, v144, v145
    v_max3_u32 v13, v13, v146, v147
    s_waitcnt vmcnt(0)
    v_max3_u32 v13, v13, v148, v149
    v_max3_u32 v13, v13, v150, v151
    s_sub_u32 s52, s52, 1
    s_cbranch_scc1 ff_rgo_156
    v_cmp_eq_u32 vcc, -1, v13
    s_cbranch_vccnz ff_rpoll_157
ff_rgo_156:
    v_pk_add_f32 v[96:97], v[96:97], v[100:101]
    v_pk_add_f32 v[98:99], v[98:99], v[102:103]
    v_pk_add_f32 v[96:97], v[96:97], v[104:105]
    v_pk_add_f32 v[98:99], v[98:99], v[106:107]
    v_pk_add_f32 v[96:97], v[96:97], v[108:109]
    v_pk_add_f32 v[98:99], v[98:99], v[110:111]
    v_pk_add_f32 v[96:97], v[96:97], v[112:113]
    v_pk_add_f32 v[98:99], v[98:99], v[114:115]
    v_pk_add_f32 v[96:97], v[96:97], v[116:117]
    v_pk_add_f32 v[98:99], v[98:99], v[118:119]
    v_pk_add_f32 v[96:97], v[96:97], v[120:121]
    v_pk_add_f32 v[98:99], v[98:99], v[122:123]
    v_pk_add_f32 v[96:97], v[96:97], v[124:125]
    v_pk_add_f32 v[98:99], v[98:99], v[126:127]
    v_pk_add_f32 v[96:97], v[96:97], v[128:129]
    v_pk_add_f32 v[98:99], v[98:99], v[130:131]
    v_pk_add_f32 v[96:97], v[96:97], v[132:133]
    v_pk_add_f32 v[98:99], v[98:99], v[134:135]
    v_pk_add_f32 v[96:97], v[96:97], v[136:137]
    v_pk_add_f32 v[98:99], v[98:99], v[138:139]
    v_pk_add_f32 v[96:97], v[96:97], v[140:141]
    v_pk_add_f32 v[98:99], v[98:99], v[142:143]
    v_pk_add_f32 v[96:97], v[96:97], v[144:145]
    v_pk_add_f32 v[98:99], v[98:99], v[146:147]
    v_pk_add_f32 v[96:97], v[96:97], v[148:149]
    v_pk_add_f32 v[98:99], v[98:99], v[150:151]
    v_mov_b32 v100, v96
    v_mov_b32 v101, v97
    v_mov_b32 v102, v98
    v_mov_b32 v103, v99
    s_nop 1
    v_permlane16_swap_b32 v96, v100
    v_permlane16_swap_b32 v97, v101
    v_permlane16_swap_b32 v98, v102
    v_permlane16_swap_b32 v99, v103
    s_nop 1
    v_add_f32 v96, v96, v100
    v_add_f32 v97, v97, v101
    v_add_f32 v98, v98, v102
    v_add_f32 v99, v99, v103
    v_mov_b32 v100, v96
    v_mov_b32 v101, v97
    v_mov_b32 v102, v98
    v_mov_b32 v103, v99
    s_nop 1
    v_permlane32_swap_b32 v96, v100
    v_permlane32_swap_b32 v97, v101
    v_permlane32_swap_b32 v98, v102
    v_permlane32_swap_b32 v99, v103
    s_nop 1
    v_add_f32 v96, v96, v100
    v_add_f32 v97, v97, v101
    v_add_f32 v98, v98, v102
    v_add_f32 v99, v99, v103
    v_lshlrev_b32 v14, 4, v8
    s_lshl_b32 s31, s30, 8
    v_add_u32 v13, s31, v14
    ds_write_b128 v13, v[96:99]
    s_waitcnt lgkmcnt(0)
    s_barrier
    ds_read_b128 v[96:99], v14 offset:0
    ds_read_b128 v[100:103], v14 offset:256
    ds_read_b128 v[104:107], v14 offset:512
    ds_read_b128 v[108:111], v14 offset:768
    s_waitcnt lgkmcnt(0)
    v_pk_add_f32 v[96:97], v[96:97], v[100:101]
    v_pk_add_f32 v[98:99], v[98:99], v[102:103]
    v_pk_add_f32 v[96:97], v[96:97], v[104:105]
    v_pk_add_f32 v[98:99], v[98:99], v[106:107]
    v_pk_add_f32 v[96:97], v[96:97], v[108:109]
    v_pk_add_f32 v[98:99], v[98:99], v[110:111]
    v_cvt_pk_bf16_f32 v20, v96, v97
    v_lshlrev_b32 v21, 16, v20
    v_and_b32 v22, 0xffff0000, v20
    v_mul_f32 v21, s45, v21
    v_mul_f32 v22, s45, v22
    v_cvt_pk_bf16_f32 v20, v21, v22
    v_lshlrev_b32 v21, 16, v20
    v_and_b32 v22, 0xffff0000, v20
    v_lshlrev_b32 v23, 16, v32
    v_and_b32 v24, 0xffff0000, v32
    v_add_f32 v21, v21, v23
    v_add_f32 v22, v22, v24
    v_cvt_pk_bf16_f32 v20, v21, v22
    v_lshlrev_b32 v21, 16, v20
    v_and_b32 v22, 0xffff0000, v20
    v_lshlrev_b32 v23, 16, v34
    v_and_b32 v24, 0xffff0000, v34
    v_add_f32 v21, v21, v23
    v_add_f32 v22, v22, v24
    v_cvt_pk_bf16_f32 v26, v21, v22
    v_cvt_pk_bf16_f32 v20, v98, v99
    v_lshlrev_b32 v21, 16, v20
    v_and_b32 v22, 0xffff0000, v20
    v_mul_f32 v21, s45, v21
    v_mul_f32 v22, s45, v22
    v_cvt_pk_bf16_f32 v20, v21, v22
    v_lshlrev_b32 v21, 16, v20
    v_and_b32 v22, 0xffff0000, v20
    v_lshlrev_b32 v23, 16, v33
    v_and_b32 v24, 0xffff0000, v33
    v_add_f32 v21, v21, v23
    v_add_f32 v22, v22, v24
    v_cvt_pk_bf16_f32 v20, v21, v22
    v_lshlrev_b32 v21, 16, v20
    v_and_b32 v22, 0xffff0000, v20
    v_lshlrev_b32 v23, 16, v35
    v_and_b32 v24, 0xffff0000, v35
    v_add_f32 v21, v21, v23
    v_add_f32 v22, v22, v24
    v_cvt_pk_bf16_f32 v27, v21, v22
    v_cmp_gt_u32 vcc, 16, v2
    s_and_saveexec_b64 s[52:53], vcc
    s_cbranch_execz ff_fin_155
    buffer_store_dwordx2 v[26:27], v9, s[36:39], s46 offen sc1
ff_fin_155:
    s_mov_b64 exec, -1
k12_end_1:
    s_endpgm
k2_prep_76:
    s_sub_u32 s40, s36, s38
    v_subrev_u32 v6, s40, v4
    v_cmp_gt_i32 s[44:45], 0, v6
    v_cmp_gt_i32 s[46:47], 1, v6
    v_cmp_gt_i32 s[48:49], 2, v6
    v_cmp_gt_i32 s[50:51], 3, v6
    v_cndmask_b32 v16, v8, v5, s[44:45]
    v_cndmask_b32 v17, v8, v5, s[46:47]
    v_cndmask_b32 v18, v8, v5, s[48:49]
    v_cndmask_b32 v19, v8, v5, s[50:51]
    v_cmp_gt_i32 s[44:45], 16, v6
    v_cmp_gt_i32 s[46:47], 17, v6
    v_cmp_gt_i32 s[48:49], 18, v6
    v_cmp_gt_i32 s[50:51], 19, v6
    v_cndmask_b32 v32, v8, v5, s[44:45]
    v_cndmask_b32 v33, v8, v5, s[46:47]
    v_cndmask_b32 v34, v8, v5, s[48:49]
    v_cndmask_b32 v35, v8, v5, s[50:51]
    s_nop 1
    s_branch k2_prepret_77
k2_prep_84:
    s_sub_u32 s40, s36, s38
    v_subrev_u32 v6, s40, v4
    v_cmp_gt_i32 s[44:45], 0, v6
    v_cmp_gt_i32 s[46:47], 1, v6
    v_cmp_gt_i32 s[48:49], 2, v6
    v_cmp_gt_i32 s[50:51], 3, v6
    v_cndmask_b32 v16, v8, v5, s[44:45]
    v_cndmask_b32 v17, v8, v5, s[46:47]
    v_cndmask_b32 v18, v8, v5, s[48:49]
    v_cndmask_b32 v19, v8, v5, s[50:51]
    v_cmp_gt_i32 s[44:45], 16, v6
    v_cmp_gt_i32 s[46:47], 17, v6
    v_cmp_gt_i32 s[48:49], 18, v6
    v_cmp_gt_i32 s[50:51], 19, v6
    v_cndmask_b32 v32, v8, v5, s[44:45]
    v_cndmask_b32 v33, v8, v5, s[46:47]
    v_cndmask_b32 v34, v8, v5, s[48:49]
    v_cndmask_b32 v35, v8, v5, s[50:51]
    s_nop 1
    s_branch k2_prepret_85
k2_prep_102:
    s_sub_u32 s40, s36, s39
    v_subrev_u32 v6, s40, v4
    v_cmp_gt_i32 s[44:45], 0, v6
    v_cmp_gt_i32 s[46:47], 1, v6
    v_cmp_gt_i32 s[48:49], 2, v6
    v_cmp_gt_i32 s[50:51], 3, v6
    v_cndmask_b32 v16, v10, v5, s[44:45]
    v_cndmask_b32 v17, v10, v5, s[46:47]
    v_cndmask_b32 v18, v10, v5, s[48:49]
    v_cndmask_b32 v19, v10, v5, s[50:51]
    v_cmp_gt_i32 s[44:45], 16, v6
    v_cmp_gt_i32 s[46:47], 17, v6
    v_cmp_gt_i32 s[48:49], 18, v6
    v_cmp_gt_i32 s[50:51], 19, v6
    v_cndmask_b32 v32, v10, v5, s[44:45]
    v_cndmask_b32 v33, v10, v5, s[46:47]
    v_cndmask_b32 v34, v10, v5, s[48:49]
    v_cndmask_b32 v35, v10, v5, s[50:51]
    v_cmp_gt_i32 s[44:45], 32, v6
    v_cmp_gt_i32 s[46:47], 33, v6
    v_cmp_gt_i32 s[48:49], 34, v6
    v_cmp_gt_i32 s[50:51], 35, v6
    v_cndmask_b32 v24, v10, v5, s[44:45]
    v_cndmask_b32 v25, v10, v5, s[46:47]
    v_cndmask_b32 v26, v10, v5, s[48:49]
    v_cndmask_b32 v27, v10, v5, s[50:51]
    v_cmp_gt_i32 s[44:45], 48, v6
    v_cmp_gt_i32 s[46:47], 49, v6
    v_cmp_gt_i32 s[48:49], 50, v6
    v_cmp_gt_i32 s[50:51], 51, v6
    v_cndmask_b32 v40, v10, v5, s[44:45]
    v_cndmask_b32 v41, v10, v5, s[46:47]
    v_cndmask_b32 v42, v10, v5, s[48:49]
    v_cndmask_b32 v43, v10, v5, s[50:51]
    s_nop 1
    s_branch k2_prepret_103
k2_prep_106:
    s_sub_u32 s40, s36, s39
    s_sub_u32 s40, s40, 64
    v_subrev_u32 v6, s40, v4
    v_cmp_gt_i32 s[44:45], 0, v6
    v_cmp_gt_i32 s[46:47], 1, v6
    v_cmp_gt_i32 s[48:49], 2, v6
    v_cmp_gt_i32 s[50:51], 3, v6
    v_cndmask_b32 v20, v11, v5, s[44:45]
    v_cndmask_b32 v21, v11, v5, s[46:47]
    v_cndmask_b32 v22, v11, v5, s[48:49]
    v_cndmask_b32 v23, v11, v5, s[50:51]
    v_cmp_gt_i32 s[44:45], 16, v6
    v_cmp_gt_i32 s[46:47], 17, v6
    v_cmp_gt_i32 s[48:49], 18, v6
    v_cmp_gt_i32 s[50:51], 19, v6
    v_cndmask_b32 v36, v11, v5, s[44:45]
    v_cndmask_b32 v37, v11, v5, s[46:47]
    v_cndmask_b32 v38, v11, v5, s[48:49]
    v_cndmask_b32 v39, v11, v5, s[50:51]
    v_cmp_gt_i32 s[44:45], 32, v6
    v_cmp_gt_i32 s[46:47], 33, v6
    v_cmp_gt_i32 s[48:49], 34, v6
    v_cmp_gt_i32 s[50:51], 35, v6
    v_cndmask_b32 v28, v11, v5, s[44:45]
    v_cndmask_b32 v29, v11, v5, s[46:47]
    v_cndmask_b32 v30, v11, v5, s[48:49]
    v_cndmask_b32 v31, v11, v5, s[50:51]
    v_cmp_gt_i32 s[44:45], 48, v6
    v_cmp_gt_i32 s[46:47], 49, v6
    v_cmp_gt_i32 s[48:49], 50, v6
    v_cmp_gt_i32 s[50:51], 51, v6
    v_cndmask_b32 v44, v11, v5, s[44:45]
    v_cndmask_b32 v45, v11, v5, s[46:47]
    v_cndmask_b32 v46, v11, v5, s[48:49]
    v_cndmask_b32 v47, v11, v5, s[50:51]
    s_nop 1
    s_branch k2_prepret_107
k12_ool_10:
    buffer_load_dword v52, v8, s[24:27], 0 offen sc1
    s_branch k12_oolret_11
k12_ool_14:
    v_readfirstlane_b32 s31, v52
    s_cmp_ge_u32 s31, 256
    s_cbranch_scc1 spin_ok_12
    s_mov_b32 s40, 1048576
spin_13:
    s_sleep 8
    buffer_load_dword v52, v8, s[24:27], 0 offen sc1
    s_waitcnt vmcnt(0)
    v_readfirstlane_b32 s31, v52
    s_sub_u32 s40, s40, 1
    s_cselect_b32 s31, -1, s31
    s_cmp_lt_u32 s31, 256
    s_cbranch_scc1 spin_13
spin_ok_12:
    s_branch k12_oolret_15
k12_ool_16:
    s_mov_b64 exec, 1
    buffer_atomic_add v9, v8, s[24:27], 0 offen sc1
    s_mov_b64 exec, -1
    s_branch k12_oolret_17
k12_ool_18:
    buffer_load_dword v51, v50, s[12:15], s56 offen
    s_branch k12_oolret_19
k12_ool_20:
    s_add_u32 m0, s60, 131072
    s_nop 0
    buffer_load_dwordx4 v38, s[12:15], s61 offen offset:0 lds
    buffer_load_dwordx4 v39, s[12:15], s61 offen offset:1024 lds
    buffer_load_dwordx4 v40, s[12:15], s61 offen offset:2048 lds
    buffer_load_dwordx4 v41, s[12:15], s61 offen offset:3072 lds
    s_add_u32 s61, s61, 0x80000
    s_add_u32 m0, s60, 147456
    s_nop 0
    buffer_load_dwordx4 v38, s[12:15], s61 offen offset:0 lds
    buffer_load_dwordx4 v39, s[12:15], s61 offen offset:1024 lds
    buffer_load_dwordx4 v40, s[12:15], s61 offen offset:2048 lds
    buffer_load_dwordx4 v41, s[12:15], s61 offen offset:3072 lds
    s_add_u32 s61, s61, 0x80000
    s_branch k12_oolret_21
k12_ool_22:
    s_mov_b64 exec, 1
    buffer_atomic_add v9, v8, s[24:27], 0 offen sc1
    s_mov_b64 exec, -1
    s_branch k12_oolret_23
k12_ool_24:
    buffer_load_dword v51, v50, s[12:15], s56 offen
    s_branch k12_oolret_25
k12_ool_26:
    global_load_dword v51, v[2:3], off
    s_branch k12_oolret_27
k12_ool_30:
    buffer_load_dword v52, v8, s[24:27], 0 offen sc1
    s_branch k12_oolret_31
k12_ool_34:
    v_readfirstlane_b32 s31, v52
    s_cmp_ge_u32 s31, 256
    s_cbranch_scc1 spin_ok_32
    s_mov_b32 s40, 1048576
spin_33:
    s_sleep 8
    buffer_load_dword v52, v8, s[24:27], 0 offen sc1
    s_waitcnt vmcnt(0)
    v_readfirstlane_b32 s31, v52
    s_sub_u32 s40, s40, 1
    s_cselect_b32 s31, -1, s31
    s_cmp_lt_u32 s31, 256
    s_cbranch_scc1 spin_33
spin_ok_32:
    s_branch k12_oolret_35
k12_ool_36:
    s_mov_b64 exec, 1
    buffer_atomic_add v9, v8, s[24:27], 0 offen sc1
    s_mov_b64 exec, -1
    s_branch k12_oolret_37
k12_ool_38:
    buffer_load_dword v51, v50, s[12:15], s56 offen
    s_branch k12_oolret_39
k12_ool_40:
    s_add_u32 m0, s60, 131072
    s_nop 0
    buffer_load_dwordx4 v38, s[12:15], s61 offen offset:0 lds
    buffer_load_dwordx4 v39, s[12:15], s61 offen offset:1024 lds
    buffer_load_dwordx4 v40, s[12:15], s61 offen offset:2048 lds
    buffer_load_dwordx4 v41, s[12:15], s61 offen offset:3072 lds
    s_add_u32 s61, s61, 0x80000
    s_add_u32 m0, s60, 147456
    s_nop 0
    buffer_load_dwordx4 v38, s[12:15], s61 offen offset:0 lds
    buffer_load_dwordx4 v39, s[12:15], s61 offen offset:1024 lds
    buffer_load_dwordx4 v40, s[12:15], s61 offen offset:2048 lds
    buffer_load_dwordx4 v41, s[12:15], s61 offen offset:3072 lds
    s_add_u32 s61, s61, 0x80000
    s_branch k12_oolret_41
k12_ool_42:
    s_mov_b64 exec, 1
    buffer_atomic_add v9, v8, s[24:27], 0 offen sc1
    s_mov_b64 exec, -1
    s_branch k12_oolret_43
k12_ool_44:
    buffer_load_dword v51, v50, s[12:15], s56 offen
    s_branch k12_oolret_45
k12_ool_46:
    global_load_dword v51, v[2:3], off
    s_branch k12_oolret_47
k12_ool_48:
    s_add_u32 s52, s47, 528384
    buffer_store_dwordx4 v[152:155], v1, s[48:51], s52 offen offset:2048 sc1
    s_branch k12_oolret_49
k12_ool_50:
    s_add_u32 s52, s47, 528384
    buffer_store_dwordx4 v[156:159], v1, s[48:51], s52 offen offset:3072 sc1
    s_branch k12_oolret_51
k12_ool_52:
    s_add_u32 s52, s47, 532480
    buffer_store_dwordx4 v[168:171], v1, s[48:51], s52 offen offset:2048 sc1
    s_branch k12_oolret_53
k12_ool_54:
    s_add_u32 s52, s47, 532480
    buffer_store_dwordx4 v[172:175], v1, s[48:51], s52 offen offset:3072 sc1
    s_branch k12_oolret_55
k12_ool_56:
    s_add_u32 s52, s47, 536576
    buffer_store_dwordx4 v[176:179], v1, s[48:51], s52 offen offset:0 sc1
    s_branch k12_oolret_57
k12_ool_58:
    s_add_u32 s52, s47, 536576
    buffer_store_dwordx4 v[180:183], v1, s[48:51], s52 offen offset:1024 sc1
    s_branch k12_oolret_59
k12_ool_60:
    s_add_u32 s52, s47, 536576
    buffer_store_dwordx4 v[184:187], v1, s[48:51], s52 offen offset:2048 sc1
    s_branch k12_oolret_61
k12_ool_62:
    s_add_u32 s52, s47, 536576
    buffer_store_dwordx4 v[188:191], v1, s[48:51], s52 offen offset:3072 sc1
    s_branch k12_oolret_63
k12_ool_64:
    s_mov_b32 s50, 0
    s_branch k12_oolret_65
k12_ool_66:
    s_mov_b64 exec, 1
    buffer_atomic_add v9, v8, s[24:27], s54 offen sc1
    s_mov_b64 exec, -1
    s_branch k12_oolret_67
k12_ool_68:
    buffer_load_dword v52, v8, s[24:27], s55 offen sc1
    s_branch k12_oolret_69
k12_ool_72:
    s_waitcnt vmcnt(10)
    v_readfirstlane_b32 s31, v52
    s_cmp_ge_u32 s31, 2
    s_cbranch_scc1 spin_ok_70
    s_mov_b32 s40, 1048576
spin_71:
    s_sleep 8
    buffer_load_dword v52, v8, s[24:27], s55 offen sc1
    s_waitcnt vmcnt(0)
    v_readfirstlane_b32 s31, v52
    s_sub_u32 s40, s40, 1
    s_cselect_b32 s31, -1, s31
    s_cmp_lt_u32 s31, 2
    s_cbranch_scc1 spin_71
spin_ok_70:
    s_branch k12_oolret_73
k12_ool_74:
    s_mov_b64 exec, 1
    buffer_atomic_add v9, v8, s[24:27], s3 offen sc1
    s_mov_b64 exec, -1
    s_branch k12_oolret_75
k12_ool_78:
    buffer_load_dword v58, v59, s[24:27], s5 offen sc1
    s_branch k12_oolret_79
k12_ool_82:
    s_waitcnt vmcnt(0)
    v_readfirstlane_b32 s31, v58
    s_cmp_ge_u32 s31, 14
    s_cbranch_scc1 spin_ok_80
    s_mov_b32 s40, 1048576
spin_81:
    s_sleep 8
    buffer_load_dword v58, v59, s[24:27], s5 offen sc1
    s_waitcnt vmcnt(0)
    v_readfirstlane_b32 s31, v58
    s_sub_u32 s40, s40, 1
    s_cselect_b32 s31, -1, s31
    s_cmp_lt_u32 s31, 14
    s_cbranch_scc1 spin_81
spin_ok_80:
    s_branch k12_oolret_83
k12_ool_122:
    s_mov_b64 exec, 1
    buffer_atomic_add v76, v75, s[16:19], s57 offen sc1
    s_mov_b64 exec, -1
    s_branch k12_oolret_123
k12_ool_127:
    s_mov_b64 exec, 1
    buffer_atomic_add v76, v75, s[16:19], s58 offen sc1
    s_mov_b64 exec, -1
    s_branch k12_oolret_128
k12_ool_131:
    s_mov_b32 s34, 1048576
op_spin_129:
    buffer_load_dword v74, v73, s[16:19], s59 offen sc1
    s_waitcnt vmcnt(0)
    v_cmp_le_u32 vcc, 4, v74
    s_sub_u32 s34, s34, 1
    s_cbranch_scc1 op_ok_130
    s_mov_b32 s33, vcc_lo
    s_bitcmp1_b32 s33, 0
    s_cbranch_scc1 op_ok_130
    s_sleep 4
    s_branch op_spin_129
op_ok_130:
    buffer_load_dwordx4 a[128:131], v88, s[8:11], s62 offen offset:0 sc1
    buffer_load_dwordx4 a[132:135], v88, s[8:11], s62 offen offset:1024 sc1
    buffer_load_dwordx4 a[136:139], v89, s[8:11], s62 offen offset:0 sc1
    buffer_load_dwordx4 a[140:143], v89, s[8:11], s62 offen offset:1024 sc1
    s_add_u32 s62, s62, 0x40000
    s_and_b32 s62, s62, 0x7fffff
    buffer_load_dwordx4 a[144:147], v88, s[8:11], s62 offen offset:0 sc1
    buffer_load_dwordx4 a[148:151], v88, s[8:11], s62 offen offset:1024 sc1
    buffer_load_dwordx4 a[152:155], v89, s[8:11], s62 offen offset:0 sc1
    buffer_load_dwordx4 a[156:159], v89, s[8:11], s62 offen offset:1024 sc1
    s_add_u32 s62, s62, 0x40000
    s_and_b32 s62, s62, 0x7fffff
    buffer_load_dwordx4 a[160:163], v88, s[8:11], s62 offen offset:0 sc1
    buffer_load_dwordx4 a[164:167], v88, s[8:11], s62 offen offset:1024 sc1
    buffer_load_dwordx4 a[168:171], v89, s[8:11], s62 offen offset:0 sc1
    buffer_load_dwordx4 a[172:175], v89, s[8:11], s62 offen offset:1024 sc1
    s_add_u32 s62, s62, 0x40000
    s_and_b32 s62, s62, 0x7fffff
    s_branch k12_oolret_132
k12_ool_137:
    buffer_load_dwordx2 v[192:193], v78, s[20:23], 0 offen offset:0
    buffer_load_dwordx2 v[194:195], v78, s[20:23], 0 offen offset:32
    buffer_load_dwordx2 v[196:197], v78, s[20:23], 0 offen offset:64
    buffer_load_dwordx2 v[198:199], v78, s[20:23], 0 offen offset:96
    buffer_load_dwordx2 v[200:201], v79, s[20:23], 0 offen offset:0
    buffer_load_dwordx2 v[202:203], v79, s[20:23], 0 offen offset:32
    buffer_load_dwordx2 v[204:205], v79, s[20:23], 0 offen offset:64
    buffer_load_dwordx2 v[206:207], v79, s[20:23], 0 offen offset:96
    buffer_load_dwordx2 v[208:209], v80, s[44:47], 0 offen offset:0
    buffer_load_dwordx2 v[210:211], v80, s[44:47], 0 offen offset:32
    buffer_load_dwordx2 v[212:213], v80, s[44:47], 0 offen offset:64
    buffer_load_dwordx2 v[214:215], v80, s[44:47], 0 offen offset:96
    global_load_dword v84, v[82:83], off
    s_mov_b32 s10, 0
    s_mov_b32 s14, 0
    s_mov_b32 s34, 1048576
ff_spin_135:
    v_cmp_gt_u32 vcc, 4, v95
    s_cbranch_vccz ff_ok_136
    s_sub_u32 s34, s34, 1
    s_cbranch_scc1 ff_ok_136
    s_sleep 4
    buffer_load_dword v95, v94, s[16:19], 0 offen sc1
    s_waitcnt vmcnt(0)
    s_branch ff_spin_135
ff_ok_136:
    s_add_u32 s44, s6, 0x6000000
    s_addc_u32 s45, s7, 0
    s_and_b32 s45, s45, 0xffff
    s_cmp_ge_u32 s2, 224
    s_cselect_b32 s46, 0, 0x1000000
    s_branch k12_oolret_138
k12_ool_141:
    s_mov_b32 s34, 1048576
op_spin_139:
    buffer_load_dword v74, v73, s[16:19], s59 offen sc1
    s_waitcnt vmcnt(0)
    v_cmp_le_u32 vcc, 4, v74
    s_sub_u32 s34, s34, 1
    s_cbranch_scc1 op_ok_140
    s_mov_b32 s33, vcc_lo
    s_bitcmp1_b32 s33, s32
    s_cbranch_scc1 op_ok_140
    s_sleep 4
    s_branch op_spin_139
op_ok_140:
    s_branch k12_oolret_142
k12_ool_143:
    buffer_load_dword v95, v94, s[16:19], 0 offen sc1
    s_branch k12_oolret_144
k2_tramp_86:
    s_call_b64 s[40:41], k2_rare_158
    s_branch k2_ret_87
k2_tramp_90:
    s_call_b64 s[40:41], k2_rare_159
    s_branch k2_ret_91
k2_tramp_92:
    s_call_b64 s[40:41], k2_rare_158
    s_branch k2_ret_93
k2_tramp_94:
    s_call_b64 s[40:41], k2_rare_159
    s_branch k2_ret_95
k2_tramp_96:
    s_call_b64 s[40:41], k2_rare_158
    s_branch k2_ret_97
k2_tramp_98:
    s_call_b64 s[40:41], k2_rare_159
    s_branch k2_ret_99
k2_tramp_100:
    s_call_b64 s[40:41], k2_rare_164
    s_branch k2_ret_101
k2_tramp_104:
    s_call_b64 s[40:41], k2_rare_165
    s_branch k2_ret_105
k2_tramp_108:
    s_call_b64 s[40:41], k2_rare_166
    s_branch k2_ret_109
k2_tramp_112:
    s_call_b64 s[40:41], k2_rare_167
    s_branch k2_ret_113
k2_tramp_114:
    s_call_b64 s[40:41], k2_rare_166
    s_branch k2_ret_115
k2_tramp_116:
    s_call_b64 s[40:41], k2_rare_167
    s_branch k2_ret_117
k2_tramp_118:
    s_call_b64 s[40:41], k2_rare_166
    s_branch k2_ret_119
k2_tramp_120:
    s_call_b64 s[40:41], k2_rare_171
    s_branch k2_ret_121
k2_rare_158:
    s_nop 7
    v_max_f32 v52, v128, v129
    v_max3_f32 v52, v52, v130, v131
    v_max3_f32 v52, v52, v144, v145
    v_max3_f32 v52, v52, v146, v147
    v_max_f32 v53, v132, v133
    v_max3_f32 v53, v53, v134, v135
    v_max3_f32 v53, v53, v148, v149
    v_max3_f32 v53, v53, v150, v151
    v_max_f32 v54, v136, v137
    v_max3_f32 v54, v54, v138, v139
    v_max3_f32 v54, v54, v152, v153
    v_max3_f32 v54, v54, v154, v155
    v_max_f32 v55, v140, v141
    v_max3_f32 v55, v55, v142, v143
    v_max3_f32 v55, v55, v156, v157
    v_max3_f32 v55, v55, v158, v159
    v_mov_b32 v224, v52
    v_mov_b32 v225, v53
    v_mov_b32 v226, v54
    v_mov_b32 v227, v55
    s_nop 1
    v_permlane16_swap_b32 v52, v224
    v_permlane16_swap_b32 v53, v225
    v_permlane16_swap_b32 v54, v226
    v_permlane16_swap_b32 v55, v227
    s_nop 1
    v_max_f32 v52, v52, v224
    v_max_f32 v53, v53, v225
    v_max_f32 v54, v54, v226
    v_max_f32 v55, v55, v227
    v_mov_b32 v224, v52
    v_mov_b32 v225, v53
    v_mov_b32 v226, v54
    v_mov_b32 v227, v55
    s_nop 1
    v_permlane32_swap_b32 v52, v224
    v_permlane32_swap_b32 v53, v225
    v_permlane32_swap_b32 v54, v226
    v_permlane32_swap_b32 v55, v227
    s_nop 1
    v_max_f32 v52, v52, v224
    v_max_f32 v53, v53, v225
    v_max_f32 v54, v54, v226
    v_max_f32 v55, v55, v227
    v_add_f32 v52, 0x41400000, v52
    v_max_f32 v52, 0, v52
    v_add_f32 v53, 0x41400000, v53
    v_max_f32 v53, 0, v53
    v_add_f32 v54, 0x41400000, v54
    v_max_f32 v54, 0, v54
    v_add_f32 v55, 0x41400000, v55
    v_max_f32 v55, 0, v55
    v_sub_f32 v128, v128, v52
    v_sub_f32 v129, v129, v52
    v_sub_f32 v130, v130, v52
    v_sub_f32 v131, v131, v52
    v_sub_f32 v132, v132, v53
    v_sub_f32 v133, v133, v53
    v_sub_f32 v134, v134, v53
    v_sub_f32 v135, v135, v53
    v_sub_f32 v136, v136, v54
    v_sub_f32 v137, v137, v54
    v_sub_f32 v138, v138, v54
    v_sub_f32 v139, v139, v54
    v_sub_f32 v140, v140, v55
    v_sub_f32 v141, v141, v55
    v_sub_f32 v142, v142, v55
    v_sub_f32 v143, v143, v55
    v_sub_f32 v144, v144, v52
    v_sub_f32 v145, v145, v52
    v_sub_f32 v146, v146, v52
    v_sub_f32 v147, v147, v52
    v_sub_f32 v148, v148, v53
    v_sub_f32 v149, v149, v53
    v_sub_f32 v150, v150, v53
    v_sub_f32 v151, v151, v53
    v_sub_f32 v152, v152, v54
    v_sub_f32 v153, v153, v54
    v_sub_f32 v154, v154, v54
    v_sub_f32 v155, v155, v54
    v_sub_f32 v156, v156, v55
    v_sub_f32 v157, v157, v55
    v_sub_f32 v158, v158, v55
    v_sub_f32 v159, v159, v55
    v_sub_f32 v160, v160, v52
    v_sub_f32 v16, v16, v52
    v_sub_f32 v161, v161, v52
    v_sub_f32 v17, v17, v52
    v_sub_f32 v162, v162, v52
    v_sub_f32 v18, v18, v52
    v_sub_f32 v163, v163, v52
    v_sub_f32 v19, v19, v52
    v_sub_f32 v164, v164, v53
    v_sub_f32 v20, v20, v53
    v_sub_f32 v165, v165, v53
    v_sub_f32 v21, v21, v53
    v_sub_f32 v166, v166, v53
    v_sub_f32 v22, v22, v53
    v_sub_f32 v167, v167, v53
    v_sub_f32 v23, v23, v53
    v_sub_f32 v168, v168, v54
    v_sub_f32 v24, v24, v54
    v_sub_f32 v169, v169, v54
    v_sub_f32 v25, v25, v54
    v_sub_f32 v170, v170, v54
    v_sub_f32 v26, v26, v54
    v_sub_f32 v171, v171, v54
    v_sub_f32 v27, v27, v54
    v_sub_f32 v172, v172, v55
    v_sub_f32 v28, v28, v55
    v_sub_f32 v173, v173, v55
    v_sub_f32 v29, v29, v55
    v_sub_f32 v174, v174, v55
    v_sub_f32 v30, v30, v55
    v_sub_f32 v175, v175, v55
    v_sub_f32 v31, v31, v55
    v_sub_f32 v176, v176, v52
    v_sub_f32 v32, v32, v52
    v_sub_f32 v177, v177, v52
    v_sub_f32 v33, v33, v52
    v_sub_f32 v178, v178, v52
    v_sub_f32 v34, v34, v52
    v_sub_f32 v179, v179, v52
    v_sub_f32 v35, v35, v52
    v_sub_f32 v180, v180, v53
    v_sub_f32 v36, v36, v53
    v_sub_f32 v181, v181, v53
    v_sub_f32 v37, v37, v53
    v_sub_f32 v182, v182, v53
    v_sub_f32 v38, v38, v53
    v_sub_f32 v183, v183, v53
    v_sub_f32 v39, v39, v53
    v_sub_f32 v184, v184, v54
    v_sub_f32 v40, v40, v54
    v_sub_f32 v185, v185, v54
    v_sub_f32 v41, v41, v54
    v_sub_f32 v186, v186, v54
    v_sub_f32 v42, v42, v54
    v_sub_f32 v187, v187, v54
    v_sub_f32 v43, v43, v54
    v_sub_f32 v188, v188, v55
    v_sub_f32 v44, v44, v55
    v_sub_f32 v189, v189, v55
    v_sub_f32 v45, v45, v55
    v_sub_f32 v190, v190, v55
    v_sub_f32 v46, v46, v55
    v_sub_f32 v191, v191, v55
    v_sub_f32 v47, v47, v55
    v_sub_f32 v8, v8, v52
    v_exp_f32 v52, -v52
    v_sub_f32 v9, v9, v53
    v_exp_f32 v53, -v53
    v_sub_f32 v10, v10, v54
    v_exp_f32 v54, -v54
    v_sub_f32 v11, v11, v55
    v_exp_f32 v55, -v55
    s_nop 0
    v_mul_f32 v12, v12, v52
    v_mul_f32 v48, v48, v53
    v_mul_f32 v248, v248, v54
    v_mul_f32 v252, v252, v55
    v_accvgpr_read_b32 v224, a0
    v_accvgpr_read_b32 v225, a1
    v_accvgpr_read_b32 v226, a2
    v_accvgpr_read_b32 v227, a3
    v_mul_f32 v224, v224, v52
    v_mul_f32 v225, v225, v52
    v_mul_f32 v226, v226, v52
    v_mul_f32 v227, v227, v52
    v_accvgpr_write_b32 a0, v224
    v_accvgpr_write_b32 a1, v225
    v_accvgpr_write_b32 a2, v226
    v_accvgpr_write_b32 a3, v227
    v_accvgpr_read_b32 v224, a4
    v_accvgpr_read_b32 v225, a5
    v_accvgpr_read_b32 v226, a6
    v_accvgpr_read_b32 v227, a7
    v_mul_f32 v224, v224, v53
    v_mul_f32 v225, v225, v53
    v_mul_f32 v226, v226, v53
    v_mul_f32 v227, v227, v53
    v_accvgpr_write_b32 a4, v224
    v_accvgpr_write_b32 a5, v225
    v_accvgpr_write_b32 a6, v226
    v_accvgpr_write_b32 a7, v227
    v_accvgpr_read_b32 v224, a8
    v_accvgpr_read_b32 v225, a9
    v_accvgpr_read_b32 v226, a10
    v_accvgpr_read_b32 v227, a11
    v_mul_f32 v224, v224, v54
    v_mul_f32 v225, v225, v54
    v_mul_f32 v226, v226, v54
    v_mul_f32 v227, v227, v54
    v_accvgpr_write_b32 a8, v224
    v_accvgpr_write_b32 a9, v225
    v_accvgpr_write_b32 a10, v226
    v_accvgpr_write_b32 a11, v227
    v_accvgpr_read_b32 v224, a12
    v_accvgpr_read_b32 v225, a13
    v_accvgpr_read_b32 v226, a14
    v_accvgpr_read_b32 v227, a15
    v_mul_f32 v224, v224, v55
    v_mul_f32 v225, v225, v55
    v_mul_f32 v226, v226, v55
    v_mul_f32 v227, v227, v55
    v_accvgpr_write_b32 a12, v224
    v_accvgpr_write_b32 a13, v225
    v_accvgpr_write_b32 a14, v226
    v_accvgpr_write_b32 a15, v227
    v_accvgpr_read_b32 v224, a16
    v_accvgpr_read_b32 v225, a17
    v_accvgpr_read_b32 v226, a18
    v_accvgpr_read_b32 v227, a19
    v_mul_f32 v224, v224, v52
    v_mul_f32 v225, v225, v52
    v_mul_f32 v226, v226, v52
    v_mul_f32 v227, v227, v52
    v_accvgpr_write_b32 a16, v224
    v_accvgpr_write_b32 a17, v225
    v_accvgpr_write_b32 a18, v226
    v_accvgpr_write_b32 a19, v227
    v_accvgpr_read_b32 v224, a20
    v_accvgpr_read_b32 v225, a21
    v_accvgpr_read_b32 v226, a22
    v_accvgpr_read_b32 v227, a23
    v_mul_f32 v224, v224, v53
    v_mul_f32 v225, v225, v53
    v_mul_f32 v226, v226, v53
    v_mul_f32 v227, v227, v53
    v_accvgpr_write_b32 a20, v224
    v_accvgpr_write_b32 a21, v225
    v_accvgpr_write_b32 a22, v226
    v_accvgpr_write_b32 a23, v227
    v_accvgpr_read_b32 v224, a24
    v_accvgpr_read_b32 v225, a25
    v_accvgpr_read_b32 v226, a26
    v_accvgpr_read_b32 v227, a27
    v_mul_f32 v224, v224, v54
    v_mul_f32 v225, v225, v54
    v_mul_f32 v226, v226, v54
    v_mul_f32 v227, v227, v54
    v_accvgpr_write_b32 a24, v224
    v_accvgpr_write_b32 a25, v225
    v_accvgpr_write_b32 a26, v226
    v_accvgpr_write_b32 a27, v227
    v_accvgpr_read_b32 v224, a28
    v_accvgpr_read_b32 v225, a29
    v_accvgpr_read_b32 v226, a30
    v_accvgpr_read_b32 v227, a31
    v_mul_f32 v224, v224, v55
    v_mul_f32 v225, v225, v55
    v_mul_f32 v226, v226, v55
    v_mul_f32 v227, v227, v55
    v_accvgpr_write_b32 a28, v224
    v_accvgpr_write_b32 a29, v225
    v_accvgpr_write_b32 a30, v226
    v_accvgpr_write_b32 a31, v227
    v_accvgpr_read_b32 v224, a32
    v_accvgpr_read_b32 v225, a33
    v_accvgpr_read_b32 v226, a34
    v_accvgpr_read_b32 v227, a35
    v_mul_f32 v224, v224, v52
    v_mul_f32 v225, v225, v52
    v_mul_f32 v226, v226, v52
    v_mul_f32 v227, v227, v52
    v_accvgpr_write_b32 a32, v224
    v_accvgpr_write_b32 a33, v225
    v_accvgpr_write_b32 a34, v226
    v_accvgpr_write_b32 a35, v227
    v_accvgpr_read_b32 v224, a36
    v_accvgpr_read_b32 v225, a37
    v_accvgpr_read_b32 v226, a38
    v_accvgpr_read_b32 v227, a39
    v_mul_f32 v224, v224, v53
    v_mul_f32 v225, v225, v53
    v_mul_f32 v226, v226, v53
    v_mul_f32 v227, v227, v53
    v_accvgpr_write_b32 a36, v224
    v_accvgpr_write_b32 a37, v225
    v_accvgpr_write_b32 a38, v226
    v_accvgpr_write_b32 a39, v227
    v_accvgpr_read_b32 v224, a40
    v_accvgpr_read_b32 v225, a41
    v_accvgpr_read_b32 v226, a42
    v_accvgpr_read_b32 v227, a43
    v_mul_f32 v224, v224, v54
    v_mul_f32 v225, v225, v54
    v_mul_f32 v226, v226, v54
    v_mul_f32 v227, v227, v54
    v_accvgpr_write_b32 a40, v224
    v_accvgpr_write_b32 a41, v225
    v_accvgpr_write_b32 a42, v226
    v_accvgpr_write_b32 a43, v227
    v_accvgpr_read_b32 v224, a44
    v_accvgpr_read_b32 v225, a45
    v_accvgpr_read_b32 v226, a46
    v_accvgpr_read_b32 v227, a47
    v_mul_f32 v224, v224, v55
    v_mul_f32 v225, v225, v55
    v_mul_f32 v226, v226, v55
    v_mul_f32 v227, v227, v55
    v_accvgpr_write_b32 a44, v224
    v_accvgpr_write_b32 a45, v225
    v_accvgpr_write_b32 a46, v226
    v_accvgpr_write_b32 a47, v227
    v_accvgpr_read_b32 v224, a48
    v_accvgpr_read_b32 v225, a49
    v_accvgpr_read_b32 v226, a50
    v_accvgpr_read_b32 v227, a51
    v_mul_f32 v224, v224, v52
    v_mul_f32 v225, v225, v52
    v_mul_f32 v226, v226, v52
    v_mul_f32 v227, v227, v52
    v_accvgpr_write_b32 a48, v224
    v_accvgpr_write_b32 a49, v225
    v_accvgpr_write_b32 a50, v226
    v_accvgpr_write_b32 a51, v227
    v_accvgpr_read_b32 v224, a52
    v_accvgpr_read_b32 v225, a53
    v_accvgpr_read_b32 v226, a54
    v_accvgpr_read_b32 v227, a55
    v_mul_f32 v224, v224, v53
    v_mul_f32 v225, v225, v53
    v_mul_f32 v226, v226, v53
    v_mul_f32 v227, v227, v53
    v_accvgpr_write_b32 a52, v224
    v_accvgpr_write_b32 a53, v225
    v_accvgpr_write_b32 a54, v226
    v_accvgpr_write_b32 a55, v227
    v_accvgpr_read_b32 v224, a56
    v_accvgpr_read_b32 v225, a57
    v_accvgpr_read_b32 v226, a58
    v_accvgpr_read_b32 v227, a59
    v_mul_f32 v224, v224, v54
    v_mul_f32 v225, v225, v54
    v_mul_f32 v226, v226, v54
    v_mul_f32 v227, v227, v54
    v_accvgpr_write_b32 a56, v224
    v_accvgpr_write_b32 a57, v225
    v_accvgpr_write_b32 a58, v226
    v_accvgpr_write_b32 a59, v227
    v_accvgpr_read_b32 v224, a60
    v_accvgpr_read_b32 v225, a61
    v_accvgpr_read_b32 v226, a62
    v_accvgpr_read_b32 v227, a63
    v_mul_f32 v224, v224, v55
    v_mul_f32 v225, v225, v55
    v_mul_f32 v226, v226, v55
    v_mul_f32 v227, v227, v55
    v_accvgpr_write_b32 a60, v224
    v_accvgpr_write_b32 a61, v225
    v_accvgpr_write_b32 a62, v226
    v_accvgpr_write_b32 a63, v227
    v_accvgpr_read_b32 v224, a64
    v_accvgpr_read_b32 v225, a65
    v_accvgpr_read_b32 v226, a66
    v_accvgpr_read_b32 v227, a67
    v_mul_f32 v224, v224, v52
    v_mul_f32 v225, v225, v52
    v_mul_f32 v226, v226, v52
    v_mul_f32 v227, v227, v52
    v_accvgpr_write_b32 a64, v224
    v_accvgpr_write_b32 a65, v225
    v_accvgpr_write_b32 a66, v226
    v_accvgpr_write_b32 a67, v227
    v_accvgpr_read_b32 v224, a68
    v_accvgpr_read_b32 v225, a69
    v_accvgpr_read_b32 v226, a70
    v_accvgpr_read_b32 v227, a71
    v_mul_f32 v224, v224, v53
    v_mul_f32 v225, v225, v53
    v_mul_f32 v226, v226, v53
    v_mul_f32 v227, v227, v53
    v_accvgpr_write_b32 a68, v224
    v_accvgpr_write_b32 a69, v225
    v_accvgpr_write_b32 a70, v226
    v_accvgpr_write_b32 a71, v227
    v_accvgpr_read_b32 v224, a72
    v_accvgpr_read_b32 v225, a73
    v_accvgpr_read_b32 v226, a74
    v_accvgpr_read_b32 v227, a75
    v_mul_f32 v224, v224, v54
    v_mul_f32 v225, v225, v54
    v_mul_f32 v226, v226, v54
    v_mul_f32 v227, v227, v54
    v_accvgpr_write_b32 a72, v224
    v_accvgpr_write_b32 a73, v225
    v_accvgpr_write_b32 a74, v226
    v_accvgpr_write_b32 a75, v227
    v_accvgpr_read_b32 v224, a76
    v_accvgpr_read_b32 v225, a77
    v_accvgpr_read_b32 v226, a78
    v_accvgpr_read_b32 v227, a79
    v_mul_f32 v224, v224, v55
    v_mul_f32 v225, v225, v55
    v_mul_f32 v226, v226, v55
    v_mul_f32 v227, v227, v55
    v_accvgpr_write_b32 a76, v224
    v_accvgpr_write_b32 a77, v225
    v_accvgpr_write_b32 a78, v226
    v_accvgpr_write_b32 a79, v227
    v_accvgpr_read_b32 v224, a80
    v_accvgpr_read_b32 v225, a81
    v_accvgpr_read_b32 v226, a82
    v_accvgpr_read_b32 v227, a83
    v_mul_f32 v224, v224, v52
    v_mul_f32 v225, v225, v52
    v_mul_f32 v226, v226, v52
    v_mul_f32 v227, v227, v52
    v_accvgpr_write_b32 a80, v224
    v_accvgpr_write_b32 a81, v225
    v_accvgpr_write_b32 a82, v226
    v_accvgpr_write_b32 a83, v227
    v_accvgpr_read_b32 v224, a84
    v_accvgpr_read_b32 v225, a85
    v_accvgpr_read_b32 v226, a86
    v_accvgpr_read_b32 v227, a87
    v_mul_f32 v224, v224, v53
    v_mul_f32 v225, v225, v53
    v_mul_f32 v226, v226, v53
    v_mul_f32 v227, v227, v53
    v_accvgpr_write_b32 a84, v224
    v_accvgpr_write_b32 a85, v225
    v_accvgpr_write_b32 a86, v226
    v_accvgpr_write_b32 a87, v227
    v_accvgpr_read_b32 v224, a88
    v_accvgpr_read_b32 v225, a89
    v_accvgpr_read_b32 v226, a90
    v_accvgpr_read_b32 v227, a91
    v_mul_f32 v224, v224, v54
    v_mul_f32 v225, v225, v54
    v_mul_f32 v226, v226, v54
    v_mul_f32 v227, v227, v54
    v_accvgpr_write_b32 a88, v224
    v_accvgpr_write_b32 a89, v225
    v_accvgpr_write_b32 a90, v226
    v_accvgpr_write_b32 a91, v227
    v_accvgpr_read_b32 v224, a92
    v_accvgpr_read_b32 v225, a93
    v_accvgpr_read_b32 v226, a94
    v_accvgpr_read_b32 v227, a95
    v_mul_f32 v224, v224, v55
    v_mul_f32 v225, v225, v55
    v_mul_f32 v226, v226, v55
    v_mul_f32 v227, v227, v55
    v_accvgpr_write_b32 a92, v224
    v_accvgpr_write_b32 a93, v225
    v_accvgpr_write_b32 a94, v226
    v_accvgpr_write_b32 a95, v227
    v_accvgpr_read_b32 v224, a96
    v_accvgpr_read_b32 v225, a97
    v_accvgpr_read_b32 v226, a98
    v_accvgpr_read_b32 v227, a99
    v_mul_f32 v224, v224, v52
    v_mul_f32 v225, v225, v52
    v_mul_f32 v226, v226, v52
    v_mul_f32 v227, v227, v52
    v_accvgpr_write_b32 a96, v224
    v_accvgpr_write_b32 a97, v225
    v_accvgpr_write_b32 a98, v226
    v_accvgpr_write_b32 a99, v227
    v_accvgpr_read_b32 v224, a100
    v_accvgpr_read_b32 v225, a101
    v_accvgpr_read_b32 v226, a102
    v_accvgpr_read_b32 v227, a103
    v_mul_f32 v224, v224, v53
    v_mul_f32 v225, v225, v53
    v_mul_f32 v226, v226, v53
    v_mul_f32 v227, v227, v53
    v_accvgpr_write_b32 a100, v224
    v_accvgpr_write_b32 a101, v225
    v_accvgpr_write_b32 a102, v226
    v_accvgpr_write_b32 a103, v227
    v_accvgpr_read_b32 v224, a104
    v_accvgpr_read_b32 v225, a105
    v_accvgpr_read_b32 v226, a106
    v_accvgpr_read_b32 v227, a107
    v_mul_f32 v224, v224, v54
    v_mul_f32 v225, v225, v54
    v_mul_f32 v226, v226, v54
    v_mul_f32 v227, v227, v54
    v_accvgpr_write_b32 a104, v224
    v_accvgpr_write_b32 a105, v225
    v_accvgpr_write_b32 a106, v226
    v_accvgpr_write_b32 a107, v227
    v_accvgpr_read_b32 v224, a108
    v_accvgpr_read_b32 v225, a109
    v_accvgpr_read_b32 v226, a110
    v_accvgpr_read_b32 v227, a111
    v_mul_f32 v224, v224, v55
    v_mul_f32 v225, v225, v55
    v_mul_f32 v226, v226, v55
    v_mul_f32 v227, v227, v55
    v_accvgpr_write_b32 a108, v224
    v_accvgpr_write_b32 a109, v225
    v_accvgpr_write_b32 a110, v226
    v_accvgpr_write_b32 a111, v227
    v_accvgpr_read_b32 v224, a112
    v_accvgpr_read_b32 v225, a113
    v_accvgpr_read_b32 v226, a114
    v_accvgpr_read_b32 v227, a115
    v_mul_f32 v224, v224, v52
    v_mul_f32 v225, v225, v52
    v_mul_f32 v226, v226, v52
    v_mul_f32 v227, v227, v52
    v_accvgpr_write_b32 a112, v224
    v_accvgpr_write_b32 a113, v225
    v_accvgpr_write_b32 a114, v226
    v_accvgpr_write_b32 a115, v227
    v_accvgpr_read_b32 v224, a116
    v_accvgpr_read_b32 v225, a117
    v_accvgpr_read_b32 v226, a118
    v_accvgpr_read_b32 v227, a119
    v_mul_f32 v224, v224, v53
    v_mul_f32 v225, v225, v53
    v_mul_f32 v226, v226, v53
    v_mul_f32 v227, v227, v53
    v_accvgpr_write_b32 a116, v224
    v_accvgpr_write_b32 a117, v225
    v_accvgpr_write_b32 a118, v226
    v_accvgpr_write_b32 a119, v227
    v_accvgpr_read_b32 v224, a120
    v_accvgpr_read_b32 v225, a121
    v_accvgpr_read_b32 v226, a122
    v_accvgpr_read_b32 v227, a123
    v_mul_f32 v224, v224, v54
    v_mul_f32 v225, v225, v54
    v_mul_f32 v226, v226, v54
    v_mul_f32 v227, v227, v54
    v_accvgpr_write_b32 a120, v224
    v_accvgpr_write_b32 a121, v225
    v_accvgpr_write_b32 a122, v226
    v_accvgpr_write_b32 a123, v227
    v_accvgpr_read_b32 v224, a124
    v_accvgpr_read_b32 v225, a125
    v_accvgpr_read_b32 v226, a126
    v_accvgpr_read_b32 v227, a127
    v_mul_f32 v224, v224, v55
    v_mul_f32 v225, v225, v55
    v_mul_f32 v226, v226, v55
    v_mul_f32 v227, v227, v55
    v_accvgpr_write_b32 a124, v224
    v_accvgpr_write_b32 a125, v225
    v_accvgpr_write_b32 a126, v226
    v_accvgpr_write_b32 a127, v227
    v_exp_f32 v232, v128
    v_exp_f32 v233, v129
    v_exp_f32 v234, v130
    v_exp_f32 v235, v131
    s_nop 0
    v_cvt_pk_bf16_f32 v192, v232, v233
    v_cvt_pk_bf16_f32 v193, v234, v235
    v_exp_f32 v232, v144
    v_exp_f32 v233, v145
    v_exp_f32 v234, v146
    v_exp_f32 v235, v147
    s_nop 0
    v_cvt_pk_bf16_f32 v194, v232, v233
    v_cvt_pk_bf16_f32 v195, v234, v235
    v_exp_f32 v232, v132
    v_exp_f32 v233, v133
    v_exp_f32 v234, v134
    v_exp_f32 v235, v135
    s_nop 0
    v_cvt_pk_bf16_f32 v196, v232, v233
    v_cvt_pk_bf16_f32 v197, v234, v235
    v_exp_f32 v232, v148
    v_exp_f32 v233, v149
    v_exp_f32 v234, v150
    v_exp_f32 v235, v151
    s_nop 0
    v_cvt_pk_bf16_f32 v198, v232, v233
    v_cvt_pk_bf16_f32 v199, v234, v235
    v_exp_f32 v232, v136
    v_exp_f32 v233, v137
    v_exp_f32 v234, v138
    v_exp_f32 v235, v139
    s_nop 0
    v_cvt_pk_bf16_f32 v200, v232, v233
    v_cvt_pk_bf16_f32 v201, v234, v235
    v_exp_f32 v232, v152
    v_exp_f32 v233, v153
    v_exp_f32 v234, v154
    v_exp_f32 v235, v155
    s_nop 0
    v_cvt_pk_bf16_f32 v202, v232, v233
    v_cvt_pk_bf16_f32 v203, v234, v235
    v_exp_f32 v232, v140
    v_exp_f32 v233, v141
    v_exp_f32 v234, v142
    v_exp_f32 v235, v143
    s_nop 0
    v_cvt_pk_bf16_f32 v204, v232, v233
    v_cvt_pk_bf16_f32 v205, v234, v235
    v_exp_f32 v232, v156
    v_exp_f32 v233, v157
    v_exp_f32 v234, v158
    v_exp_f32 v235, v159
    s_nop 0
    v_cvt_pk_bf16_f32 v206, v232, v233
    v_cvt_pk_bf16_f32 v207, v234, v235
    s_nop 3
    s_setpc_b64 s[40:41]
k2_rare_159:
    s_nop 7
    v_max_f32 v52, v160, v161
    v_max3_f32 v52, v52, v162, v163
    v_max3_f32 v52, v52, v176, v177
    v_max3_f32 v52, v52, v178, v179
    v_max_f32 v53, v164, v165
    v_max3_f32 v53, v53, v166, v167
    v_max3_f32 v53, v53, v180, v181
    v_max3_f32 v53, v53, v182, v183
    v_max_f32 v54, v168, v169
    v_max3_f32 v54, v54, v170, v171
    v_max3_f32 v54, v54, v184, v185
    v_max3_f32 v54, v54, v186, v187
    v_max_f32 v55, v172, v173
    v_max3_f32 v55, v55, v174, v175
    v_max3_f32 v55, v55, v188, v189
    v_max3_f32 v55, v55, v190, v191
    v_mov_b32 v224, v52
    v_mov_b32 v225, v53
    v_mov_b32 v226, v54
    v_mov_b32 v227, v55
    s_nop 1
    v_permlane16_swap_b32 v52, v224
    v_permlane16_swap_b32 v53, v225
    v_permlane16_swap_b32 v54, v226
    v_permlane16_swap_b32 v55, v227
    s_nop 1
    v_max_f32 v52, v52, v224
    v_max_f32 v53, v53, v225
    v_max_f32 v54, v54, v226
    v_max_f32 v55, v55, v227
    v_mov_b32 v224, v52
    v_mov_b32 v225, v53
    v_mov_b32 v226, v54
    v_mov_b32 v227, v55
    s_nop 1
    v_permlane32_swap_b32 v52, v224
    v_permlane32_swap_b32 v53, v225
    v_permlane32_swap_b32 v54, v226
    v_permlane32_swap_b32 v55, v227
    s_nop 1
    v_max_f32 v52, v52, v224
    v_max_f32 v53, v53, v225
    v_max_f32 v54, v54, v226
    v_max_f32 v55, v55, v227
    v_add_f32 v52, 0x41400000, v52
    v_max_f32 v52, 0, v52
    v_add_f32 v53, 0x41400000, v53
    v_max_f32 v53, 0, v53
    v_add_f32 v54, 0x41400000, v54
    v_max_f32 v54, 0, v54
    v_add_f32 v55, 0x41400000, v55
    v_max_f32 v55, 0, v55
    v_sub_f32 v160, v160, v52
    v_sub_f32 v161, v161, v52
    v_sub_f32 v162, v162, v52
    v_sub_f32 v163, v163, v52
    v_sub_f32 v164, v164, v53
    v_sub_f32 v165, v165, v53
    v_sub_f32 v166, v166, v53
    v_sub_f32 v167, v167, v53
    v_sub_f32 v168, v168, v54
    v_sub_f32 v169, v169, v54
    v_sub_f32 v170, v170, v54
    v_sub_f32 v171, v171, v54
    v_sub_f32 v172, v172, v55
    v_sub_f32 v173, v173, v55
    v_sub_f32 v174, v174, v55
    v_sub_f32 v175, v175, v55
    v_sub_f32 v176, v176, v52
    v_sub_f32 v177, v177, v52
    v_sub_f32 v178, v178, v52
    v_sub_f32 v179, v179, v52
    v_sub_f32 v180, v180, v53
    v_sub_f32 v181, v181, v53
    v_sub_f32 v182, v182, v53
    v_sub_f32 v183, v183, v53
    v_sub_f32 v184, v184, v54
    v_sub_f32 v185, v185, v54
    v_sub_f32 v186, v186, v54
    v_sub_f32 v187, v187, v54
    v_sub_f32 v188, v188, v55
    v_sub_f32 v189, v189, v55
    v_sub_f32 v190, v190, v55
    v_sub_f32 v191, v191, v55
    v_sub_f32 v128, v128, v52
    v_sub_f32 v16, v16, v52
    v_sub_f32 v129, v129, v52
    v_sub_f32 v17, v17, v52
    v_sub_f32 v130, v130, v52
    v_sub_f32 v18, v18, v52
    v_sub_f32 v131, v131, v52
    v_sub_f32 v19, v19, v52
    v_sub_f32 v132, v132, v53
    v_sub_f32 v20, v20, v53
    v_sub_f32 v133, v133, v53
    v_sub_f32 v21, v21, v53
    v_sub_f32 v134, v134, v53
    v_sub_f32 v22, v22, v53
    v_sub_f32 v135, v135, v53
    v_sub_f32 v23, v23, v53
    v_sub_f32 v136, v136, v54
    v_sub_f32 v24, v24, v54
    v_sub_f32 v137, v137, v54
    v_sub_f32 v25, v25, v54
    v_sub_f32 v138, v138, v54
    v_sub_f32 v26, v26, v54
    v_sub_f32 v139, v139, v54
    v_sub_f32 v27, v27, v54
    v_sub_f32 v140, v140, v55
    v_sub_f32 v28, v28, v55
    v_sub_f32 v141, v141, v55
    v_sub_f32 v29, v29, v55
    v_sub_f32 v142, v142, v55
    v_sub_f32 v30, v30, v55
    v_sub_f32 v143, v143, v55
    v_sub_f32 v31, v31, v55
    v_sub_f32 v144, v144, v52
    v_sub_f32 v32, v32, v52
    v_sub_f32 v145, v145, v52
    v_sub_f32 v33, v33, v52
    v_sub_f32 v146, v146, v52
    v_sub_f32 v34, v34, v52
    v_sub_f32 v147, v147, v52
    v_sub_f32 v35, v35, v52
    v_sub_f32 v148, v148, v53
    v_sub_f32 v36, v36, v53
    v_sub_f32 v149, v149, v53
    v_sub_f32 v37, v37, v53
    v_sub_f32 v150, v150, v53
    v_sub_f32 v38, v38, v53
    v_sub_f32 v151, v151, v53
    v_sub_f32 v39, v39, v53
    v_sub_f32 v152, v152, v54
    v_sub_f32 v40, v40, v54
    v_sub_f32 v153, v153, v54
    v_sub_f32 v41, v41, v54
    v_sub_f32 v154, v154, v54
    v_sub_f32 v42, v42, v54
    v_sub_f32 v155, v155, v54
    v_sub_f32 v43, v43, v54
    v_sub_f32 v156, v156, v55
    v_sub_f32 v44, v44, v55
    v_sub_f32 v157, v157, v55
    v_sub_f32 v45, v45, v55
    v_sub_f32 v158, v158, v55
    v_sub_f32 v46, v46, v55
    v_sub_f32 v159, v159, v55
    v_sub_f32 v47, v47, v55
    v_sub_f32 v8, v8, v52
    v_exp_f32 v52, -v52
    v_sub_f32 v9, v9, v53
    v_exp_f32 v53, -v53
    v_sub_f32 v10, v10, v54
    v_exp_f32 v54, -v54
    v_sub_f32 v11, v11, v55
    v_exp_f32 v55, -v55
    s_nop 0
    v_mul_f32 v12, v12, v52
    v_mul_f32 v48, v48, v53
    v_mul_f32 v248, v248, v54
    v_mul_f32 v252, v252, v55
    v_accvgpr_read_b32 v224, a0
    v_accvgpr_read_b32 v225, a1
    v_accvgpr_read_b32 v226, a2
    v_accvgpr_read_b32 v227, a3
    v_mul_f32 v224, v224, v52
    v_mul_f32 v225, v225, v52
    v_mul_f32 v226, v226, v52
    v_mul_f32 v227, v227, v52
    v_accvgpr_write_b32 a0, v224
    v_accvgpr_write_b32 a1, v225
    v_accvgpr_write_b32 a2, v226
    v_accvgpr_write_b32 a3, v227
    v_accvgpr_read_b32 v224, a4
    v_accvgpr_read_b32 v225, a5
    v_accvgpr_read_b32 v226, a6
    v_accvgpr_read_b32 v227, a7
    v_mul_f32 v224, v224, v53
    v_mul_f32 v225, v225, v53
    v_mul_f32 v226, v226, v53
    v_mul_f32 v227, v227, v53
    v_accvgpr_write_b32 a4, v224
    v_accvgpr_write_b32 a5, v225
    v_accvgpr_write_b32 a6, v226
    v_accvgpr_write_b32 a7, v227
    v_accvgpr_read_b32 v224, a8
    v_accvgpr_read_b32 v225, a9
    v_accvgpr_read_b32 v226, a10
    v_accvgpr_read_b32 v227, a11
    v_mul_f32 v224, v224, v54
    v_mul_f32 v225, v225, v54
    v_mul_f32 v226, v226, v54
    v_mul_f32 v227, v227, v54
    v_accvgpr_write_b32 a8, v224
    v_accvgpr_write_b32 a9, v225
    v_accvgpr_write_b32 a10, v226
    v_accvgpr_write_b32 a11, v227
    v_accvgpr_read_b32 v224, a12
    v_accvgpr_read_b32 v225, a13
    v_accvgpr_read_b32 v226, a14
    v_accvgpr_read_b32 v227, a15
    v_mul_f32 v224, v224, v55
    v_mul_f32 v225, v225, v55
    v_mul_f32 v226, v226, v55
    v_mul_f32 v227, v227, v55
    v_accvgpr_write_b32 a12, v224
    v_accvgpr_write_b32 a13, v225
    v_accvgpr_write_b32 a14, v226
    v_accvgpr_write_b32 a15, v227
    v_accvgpr_read_b32 v224, a16
    v_accvgpr_read_b32 v225, a17
    v_accvgpr_read_b32 v226, a18
    v_accvgpr_read_b32 v227, a19
    v_mul_f32 v224, v224, v52
    v_mul_f32 v225, v225, v52
    v_mul_f32 v226, v226, v52
    v_mul_f32 v227, v227, v52
    v_accvgpr_write_b32 a16, v224
    v_accvgpr_write_b32 a17, v225
    v_accvgpr_write_b32 a18, v226
    v_accvgpr_write_b32 a19, v227
    v_accvgpr_read_b32 v224, a20
    v_accvgpr_read_b32 v225, a21
    v_accvgpr_read_b32 v226, a22
    v_accvgpr_read_b32 v227, a23
    v_mul_f32 v224, v224, v53
    v_mul_f32 v225, v225, v53
    v_mul_f32 v226, v226, v53
    v_mul_f32 v227, v227, v53
    v_accvgpr_write_b32 a20, v224
    v_accvgpr_write_b32 a21, v225
    v_accvgpr_write_b32 a22, v226
    v_accvgpr_write_b32 a23, v227
    v_accvgpr_read_b32 v224, a24
    v_accvgpr_read_b32 v225, a25
    v_accvgpr_read_b32 v226, a26
    v_accvgpr_read_b32 v227, a27
    v_mul_f32 v224, v224, v54
    v_mul_f32 v225, v225, v54
    v_mul_f32 v226, v226, v54
    v_mul_f32 v227, v227, v54
    v_accvgpr_write_b32 a24, v224
    v_accvgpr_write_b32 a25, v225
    v_accvgpr_write_b32 a26, v226
    v_accvgpr_write_b32 a27, v227
    v_accvgpr_read_b32 v224, a28
    v_accvgpr_read_b32 v225, a29
    v_accvgpr_read_b32 v226, a30
    v_accvgpr_read_b32 v227, a31
    v_mul_f32 v224, v224, v55
    v_mul_f32 v225, v225, v55
    v_mul_f32 v226, v226, v55
    v_mul_f32 v227, v227, v55
    v_accvgpr_write_b32 a28, v224
    v_accvgpr_write_b32 a29, v225
    v_accvgpr_write_b32 a30, v226
    v_accvgpr_write_b32 a31, v227
    v_accvgpr_read_b32 v224, a32
    v_accvgpr_read_b32 v225, a33
    v_accvgpr_read_b32 v226, a34
    v_accvgpr_read_b32 v227, a35
    v_mul_f32 v224, v224, v52
    v_mul_f32 v225, v225, v52
    v_mul_f32 v226, v226, v52
    v_mul_f32 v227, v227, v52
    v_accvgpr_write_b32 a32, v224
    v_accvgpr_write_b32 a33, v225
    v_accvgpr_write_b32 a34, v226
    v_accvgpr_write_b32 a35, v227
    v_accvgpr_read_b32 v224, a36
    v_accvgpr_read_b32 v225, a37
    v_accvgpr_read_b32 v226, a38
    v_accvgpr_read_b32 v227, a39
    v_mul_f32 v224, v224, v53
    v_mul_f32 v225, v225, v53
    v_mul_f32 v226, v226, v53
    v_mul_f32 v227, v227, v53
    v_accvgpr_write_b32 a36, v224
    v_accvgpr_write_b32 a37, v225
    v_accvgpr_write_b32 a38, v226
    v_accvgpr_write_b32 a39, v227
    v_accvgpr_read_b32 v224, a40
    v_accvgpr_read_b32 v225, a41
    v_accvgpr_read_b32 v226, a42
    v_accvgpr_read_b32 v227, a43
    v_mul_f32 v224, v224, v54
    v_mul_f32 v225, v225, v54
    v_mul_f32 v226, v226, v54
    v_mul_f32 v227, v227, v54
    v_accvgpr_write_b32 a40, v224
    v_accvgpr_write_b32 a41, v225
    v_accvgpr_write_b32 a42, v226
    v_accvgpr_write_b32 a43, v227
    v_accvgpr_read_b32 v224, a44
    v_accvgpr_read_b32 v225, a45
    v_accvgpr_read_b32 v226, a46
    v_accvgpr_read_b32 v227, a47
    v_mul_f32 v224, v224, v55
    v_mul_f32 v225, v225, v55
    v_mul_f32 v226, v226, v55
    v_mul_f32 v227, v227, v55
    v_accvgpr_write_b32 a44, v224
    v_accvgpr_write_b32 a45, v225
    v_accvgpr_write_b32 a46, v226
    v_accvgpr_write_b32 a47, v227
    v_accvgpr_read_b32 v224, a48
    v_accvgpr_read_b32 v225, a49
    v_accvgpr_read_b32 v226, a50
    v_accvgpr_read_b32 v227, a51
    v_mul_f32 v224, v224, v52
    v_mul_f32 v225, v225, v52
    v_mul_f32 v226, v226, v52
    v_mul_f32 v227, v227, v52
    v_accvgpr_write_b32 a48, v224
    v_accvgpr_write_b32 a49, v225
    v_accvgpr_write_b32 a50, v226
    v_accvgpr_write_b32 a51, v227
    v_accvgpr_read_b32 v224, a52
    v_accvgpr_read_b32 v225, a53
    v_accvgpr_read_b32 v226, a54
    v_accvgpr_read_b32 v227, a55
    v_mul_f32 v224, v224, v53
    v_mul_f32 v225, v225, v53
    v_mul_f32 v226, v226, v53
    v_mul_f32 v227, v227, v53
    v_accvgpr_write_b32 a52, v224
    v_accvgpr_write_b32 a53, v225
    v_accvgpr_write_b32 a54, v226
    v_accvgpr_write_b32 a55, v227
    v_accvgpr_read_b32 v224, a56
    v_accvgpr_read_b32 v225, a57
    v_accvgpr_read_b32 v226, a58
    v_accvgpr_read_b32 v227, a59
    v_mul_f32 v224, v224, v54
    v_mul_f32 v225, v225, v54
    v_mul_f32 v226, v226, v54
    v_mul_f32 v227, v227, v54
    v_accvgpr_write_b32 a56, v224
    v_accvgpr_write_b32 a57, v225
    v_accvgpr_write_b32 a58, v226
    v_accvgpr_write_b32 a59, v227
    v_accvgpr_read_b32 v224, a60
    v_accvgpr_read_b32 v225, a61
    v_accvgpr_read_b32 v226, a62
    v_accvgpr_read_b32 v227, a63
    v_mul_f32 v224, v224, v55
    v_mul_f32 v225, v225, v55
    v_mul_f32 v226, v226, v55
    v_mul_f32 v227, v227, v55
    v_accvgpr_write_b32 a60, v224
    v_accvgpr_write_b32 a61, v225
    v_accvgpr_write_b32 a62, v226
    v_accvgpr_write_b32 a63, v227
    v_accvgpr_read_b32 v224, a64
    v_accvgpr_read_b32 v225, a65
    v_accvgpr_read_b32 v226, a66
    v_accvgpr_read_b32 v227, a67
    v_mul_f32 v224, v224, v52
    v_mul_f32 v225, v225, v52
    v_mul_f32 v226, v226, v52
    v_mul_f32 v227, v227, v52
    v_accvgpr_write_b32 a64, v224
    v_accvgpr_write_b32 a65, v225
    v_accvgpr_write_b32 a66, v226
    v_accvgpr_write_b32 a67, v227
    v_accvgpr_read_b32 v224, a68
    v_accvgpr_read_b32 v225, a69
    v_accvgpr_read_b32 v226, a70
    v_accvgpr_read_b32 v227, a71
    v_mul_f32 v224, v224, v53
    v_mul_f32 v225, v225, v53
    v_mul_f32 v226, v226, v53
    v_mul_f32 v227, v227, v53
    v_accvgpr_write_b32 a68, v224
    v_accvgpr_write_b32 a69, v225
    v_accvgpr_write_b32 a70, v226
    v_accvgpr_write_b32 a71, v227
    v_accvgpr_read_b32 v224, a72
    v_accvgpr_read_b32 v225, a73
    v_accvgpr_read_b32 v226, a74
    v_accvgpr_read_b32 v227, a75
    v_mul_f32 v224, v224, v54
    v_mul_f32 v225, v225, v54
    v_mul_f32 v226, v226, v54
    v_mul_f32 v227, v227, v54
    v_accvgpr_write_b32 a72, v224
    v_accvgpr_write_b32 a73, v225
    v_accvgpr_write_b32 a74, v226
    v_accvgpr_write_b32 a75, v227
    v_accvgpr_read_b32 v224, a76
    v_accvgpr_read_b32 v225, a77
    v_accvgpr_read_b32 v226, a78
    v_accvgpr_read_b32 v227, a79
    v_mul_f32 v224, v224, v55
    v_mul_f32 v225, v225, v55
    v_mul_f32 v226, v226, v55
    v_mul_f32 v227, v227, v55
    v_accvgpr_write_b32 a76, v224
    v_accvgpr_write_b32 a77, v225
    v_accvgpr_write_b32 a78, v226
    v_accvgpr_write_b32 a79, v227
    v_accvgpr_read_b32 v224, a80
    v_accvgpr_read_b32 v225, a81
    v_accvgpr_read_b32 v226, a82
    v_accvgpr_read_b32 v227, a83
    v_mul_f32 v224, v224, v52
    v_mul_f32 v225, v225, v52
    v_mul_f32 v226, v226, v52
    v_mul_f32 v227, v227, v52
    v_accvgpr_write_b32 a80, v224
    v_accvgpr_write_b32 a81, v225
    v_accvgpr_write_b32 a82, v226
    v_accvgpr_write_b32 a83, v227
    v_accvgpr_read_b32 v224, a84
    v_accvgpr_read_b32 v225, a85
    v_accvgpr_read_b32 v226, a86
    v_accvgpr_read_b32 v227, a87
    v_mul_f32 v224, v224, v53
    v_mul_f32 v225, v225, v53
    v_mul_f32 v226, v226, v53
    v_mul_f32 v227, v227, v53
    v_accvgpr_write_b32 a84, v224
    v_accvgpr_write_b32 a85, v225
    v_accvgpr_write_b32 a86, v226
    v_accvgpr_write_b32 a87, v227
    v_accvgpr_read_b32 v224, a88
    v_accvgpr_read_b32 v225, a89
    v_accvgpr_read_b32 v226, a90
    v_accvgpr_read_b32 v227, a91
    v_mul_f32 v224, v224, v54
    v_mul_f32 v225, v225, v54
    v_mul_f32 v226, v226, v54
    v_mul_f32 v227, v227, v54
    v_accvgpr_write_b32 a88, v224
    v_accvgpr_write_b32 a89, v225
    v_accvgpr_write_b32 a90, v226
    v_accvgpr_write_b32 a91, v227
    v_accvgpr_read_b32 v224, a92
    v_accvgpr_read_b32 v225, a93
    v_accvgpr_read_b32 v226, a94
    v_accvgpr_read_b32 v227, a95
    v_mul_f32 v224, v224, v55
    v_mul_f32 v225, v225, v55
    v_mul_f32 v226, v226, v55
    v_mul_f32 v227, v227, v55
    v_accvgpr_write_b32 a92, v224
    v_accvgpr_write_b32 a93, v225
    v_accvgpr_write_b32 a94, v226
    v_accvgpr_write_b32 a95, v227
    v_accvgpr_read_b32 v224, a96
    v_accvgpr_read_b32 v225, a97
    v_accvgpr_read_b32 v226, a98
    v_accvgpr_read_b32 v227, a99
    v_mul_f32 v224, v224, v52
    v_mul_f32 v225, v225, v52
    v_mul_f32 v226, v226, v52
    v_mul_f32 v227, v227, v52
    v_accvgpr_write_b32 a96, v224
    v_accvgpr_write_b32 a97, v225
    v_accvgpr_write_b32 a98, v226
    v_accvgpr_write_b32 a99, v227
    v_accvgpr_read_b32 v224, a100
    v_accvgpr_read_b32 v225, a101
    v_accvgpr_read_b32 v226, a102
    v_accvgpr_read_b32 v227, a103
    v_mul_f32 v224, v224, v53
    v_mul_f32 v225, v225, v53
    v_mul_f32 v226, v226, v53
    v_mul_f32 v227, v227, v53
    v_accvgpr_write_b32 a100, v224
    v_accvgpr_write_b32 a101, v225
    v_accvgpr_write_b32 a102, v226
    v_accvgpr_write_b32 a103, v227
    v_accvgpr_read_b32 v224, a104
    v_accvgpr_read_b32 v225, a105
    v_accvgpr_read_b32 v226, a106
    v_accvgpr_read_b32 v227, a107
    v_mul_f32 v224, v224, v54
    v_mul_f32 v225, v225, v54
    v_mul_f32 v226, v226, v54
    v_mul_f32 v227, v227, v54
    v_accvgpr_write_b32 a104, v224
    v_accvgpr_write_b32 a105, v225
    v_accvgpr_write_b32 a106, v226
    v_accvgpr_write_b32 a107, v227
    v_accvgpr_read_b32 v224, a108
    v_accvgpr_read_b32 v225, a109
    v_accvgpr_read_b32 v226, a110
    v_accvgpr_read_b32 v227, a111
    v_mul_f32 v224, v224, v55
    v_mul_f32 v225, v225, v55
    v_mul_f32 v226, v226, v55
    v_mul_f32 v227, v227, v55
    v_accvgpr_write_b32 a108, v224
    v_accvgpr_write_b32 a109, v225
    v_accvgpr_write_b32 a110, v226
    v_accvgpr_write_b32 a111, v227
    v_accvgpr_read_b32 v224, a112
    v_accvgpr_read_b32 v225, a113
    v_accvgpr_read_b32 v226, a114
    v_accvgpr_read_b32 v227, a115
    v_mul_f32 v224, v224, v52
    v_mul_f32 v225, v225, v52
    v_mul_f32 v226, v226, v52
    v_mul_f32 v227, v227, v52
    v_accvgpr_write_b32 a112, v224
    v_accvgpr_write_b32 a113, v225
    v_accvgpr_write_b32 a114, v226
    v_accvgpr_write_b32 a115, v227
    v_accvgpr_read_b32 v224, a116
    v_accvgpr_read_b32 v225, a117
    v_accvgpr_read_b32 v226, a118
    v_accvgpr_read_b32 v227, a119
    v_mul_f32 v224, v224, v53
    v_mul_f32 v225, v225, v53
    v_mul_f32 v226, v226, v53
    v_mul_f32 v227, v227, v53
    v_accvgpr_write_b32 a116, v224
    v_accvgpr_write_b32 a117, v225
    v_accvgpr_write_b32 a118, v226
    v_accvgpr_write_b32 a119, v227
    v_accvgpr_read_b32 v224, a120
    v_accvgpr_read_b32 v225, a121
    v_accvgpr_read_b32 v226, a122
    v_accvgpr_read_b32 v227, a123
    v_mul_f32 v224, v224, v54
    v_mul_f32 v225, v225, v54
    v_mul_f32 v226, v226, v54
    v_mul_f32 v227, v227, v54
    v_accvgpr_write_b32 a120, v224
    v_accvgpr_write_b32 a121, v225
    v_accvgpr_write_b32 a122, v226
    v_accvgpr_write_b32 a123, v227
    v_accvgpr_read_b32 v224, a124
    v_accvgpr_read_b32 v225, a125
    v_accvgpr_read_b32 v226, a126
    v_accvgpr_read_b32 v227, a127
    v_mul_f32 v224, v224, v55
    v_mul_f32 v225, v225, v55
    v_mul_f32 v226, v226, v55
    v_mul_f32 v227, v227, v55
    v_accvgpr_write_b32 a124, v224
    v_accvgpr_write_b32 a125, v225
    v_accvgpr_write_b32 a126, v226
    v_accvgpr_write_b32 a127, v227
    v_exp_f32 v232, v160
    v_exp_f32 v233, v161
    v_exp_f32 v234, v162
    v_exp_f32 v235, v163
    s_nop 0
    v_cvt_pk_bf16_f32 v208, v232, v233
    v_cvt_pk_bf16_f32 v209, v234, v235
    v_exp_f32 v232, v176
    v_exp_f32 v233, v177
    v_exp_f32 v234, v178
    v_exp_f32 v235, v179
    s_nop 0
    v_cvt_pk_bf16_f32 v210, v232, v233
    v_cvt_pk_bf16_f32 v211, v234, v235
    v_exp_f32 v232, v164
    v_exp_f32 v233, v165
    v_exp_f32 v234, v166
    v_exp_f32 v235, v167
    s_nop 0
    v_cvt_pk_bf16_f32 v212, v232, v233
    v_cvt_pk_bf16_f32 v213, v234, v235
    v_exp_f32 v232, v180
    v_exp_f32 v233, v181
    v_exp_f32 v234, v182
    v_exp_f32 v235, v183
    s_nop 0
    v_cvt_pk_bf16_f32 v214, v232, v233
    v_cvt_pk_bf16_f32 v215, v234, v235
    v_exp_f32 v232, v168
    v_exp_f32 v233, v169
    v_exp_f32 v234, v170
    v_exp_f32 v235, v171
    s_nop 0
    v_cvt_pk_bf16_f32 v216, v232, v233
    v_cvt_pk_bf16_f32 v217, v234, v235
    v_exp_f32 v232, v184
    v_exp_f32 v233, v185
    v_exp_f32 v234, v186
    v_exp_f32 v235, v187
    s_nop 0
    v_cvt_pk_bf16_f32 v218, v232, v233
    v_cvt_pk_bf16_f32 v219, v234, v235
    v_exp_f32 v232, v172
    v_exp_f32 v233, v173
    v_exp_f32 v234, v174
    v_exp_f32 v235, v175
    s_nop 0
    v_cvt_pk_bf16_f32 v220, v232, v233
    v_cvt_pk_bf16_f32 v221, v234, v235
    v_exp_f32 v232, v188
    v_exp_f32 v233, v189
    v_exp_f32 v234, v190
    v_exp_f32 v235, v191
    s_nop 0
    v_cvt_pk_bf16_f32 v222, v232, v233
    v_cvt_pk_bf16_f32 v223, v234, v235
    s_nop 3
    s_setpc_b64 s[40:41]
k2_rare_164:
    s_nop 7
    v_max_f32 v53, v132, v133
    v_max3_f32 v53, v53, v134, v135
    v_max3_f32 v53, v53, v148, v149
    v_max3_f32 v53, v53, v150, v151
    v_max_f32 v54, v136, v137
    v_max3_f32 v54, v54, v138, v139
    v_max3_f32 v54, v54, v152, v153
    v_max3_f32 v54, v54, v154, v155
    v_max_f32 v55, v140, v141
    v_max3_f32 v55, v55, v142, v143
    v_max3_f32 v55, v55, v156, v157
    v_max3_f32 v55, v55, v158, v159
    v_mov_b32 v225, v53
    v_mov_b32 v226, v54
    v_mov_b32 v227, v55
    s_nop 1
    v_permlane16_swap_b32 v53, v225
    v_permlane16_swap_b32 v54, v226
    v_permlane16_swap_b32 v55, v227
    s_nop 1
    v_max_f32 v53, v53, v225
    v_max_f32 v54, v54, v226
    v_max_f32 v55, v55, v227
    v_mov_b32 v225, v53
    v_mov_b32 v226, v54
    v_mov_b32 v227, v55
    s_nop 1
    v_permlane32_swap_b32 v53, v225
    v_permlane32_swap_b32 v54, v226
    v_permlane32_swap_b32 v55, v227
    s_nop 1
    v_max_f32 v53, v53, v225
    v_max_f32 v54, v54, v226
    v_max_f32 v55, v55, v227
    v_add_f32 v53, 0x41400000, v53
    v_max_f32 v53, 0, v53
    v_add_f32 v54, 0x41400000, v54
    v_max_f32 v54, 0, v54
    v_add_f32 v55, 0x41400000, v55
    v_max_f32 v55, 0, v55
    v_sub_f32 v132, v132, v53
    v_sub_f32 v133, v133, v53
    v_sub_f32 v134, v134, v53
    v_sub_f32 v135, v135, v53
    v_sub_f32 v136, v136, v54
    v_sub_f32 v137, v137, v54
    v_sub_f32 v138, v138, v54
    v_sub_f32 v139, v139, v54
    v_sub_f32 v140, v140, v55
    v_sub_f32 v141, v141, v55
    v_sub_f32 v142, v142, v55
    v_sub_f32 v143, v143, v55
    v_sub_f32 v148, v148, v53
    v_sub_f32 v149, v149, v53
    v_sub_f32 v150, v150, v53
    v_sub_f32 v151, v151, v53
    v_sub_f32 v152, v152, v54
    v_sub_f32 v153, v153, v54
    v_sub_f32 v154, v154, v54
    v_sub_f32 v155, v155, v54
    v_sub_f32 v156, v156, v55
    v_sub_f32 v157, v157, v55
    v_sub_f32 v158, v158, v55
    v_sub_f32 v159, v159, v55
    v_sub_f32 v164, v164, v53
    v_sub_f32 v20, v20, v53
    v_sub_f32 v165, v165, v53
    v_sub_f32 v21, v21, v53
    v_sub_f32 v166, v166, v53
    v_sub_f32 v22, v22, v53
    v_sub_f32 v167, v167, v53
    v_sub_f32 v23, v23, v53
    v_sub_f32 v168, v168, v54
    v_sub_f32 v24, v24, v54
    v_sub_f32 v169, v169, v54
    v_sub_f32 v25, v25, v54
    v_sub_f32 v170, v170, v54
    v_sub_f32 v26, v26, v54
    v_sub_f32 v171, v171, v54
    v_sub_f32 v27, v27, v54
    v_sub_f32 v172, v172, v55
    v_sub_f32 v28, v28, v55
    v_sub_f32 v173, v173, v55
    v_sub_f32 v29, v29, v55
    v_sub_f32 v174, v174, v55
    v_sub_f32 v30, v30, v55
    v_sub_f32 v175, v175, v55
    v_sub_f32 v31, v31, v55
    v_sub_f32 v180, v180, v53
    v_sub_f32 v36, v36, v53
    v_sub_f32 v181, v181, v53
    v_sub_f32 v37, v37, v53
    v_sub_f32 v182, v182, v53
    v_sub_f32 v38, v38, v53
    v_sub_f32 v183, v183, v53
    v_sub_f32 v39, v39, v53
    v_sub_f32 v184, v184, v54
    v_sub_f32 v40, v40, v54
    v_sub_f32 v185, v185, v54
    v_sub_f32 v41, v41, v54
    v_sub_f32 v186, v186, v54
    v_sub_f32 v42, v42, v54
    v_sub_f32 v187, v187, v54
    v_sub_f32 v43, v43, v54
    v_sub_f32 v188, v188, v55
    v_sub_f32 v44, v44, v55
    v_sub_f32 v189, v189, v55
    v_sub_f32 v45, v45, v55
    v_sub_f32 v190, v190, v55
    v_sub_f32 v46, v46, v55
    v_sub_f32 v191, v191, v55
    v_sub_f32 v47, v47, v55
    v_sub_f32 v9, v9, v53
    v_exp_f32 v53, -v53
    v_sub_f32 v10, v10, v54
    v_exp_f32 v54, -v54
    v_sub_f32 v11, v11, v55
    v_exp_f32 v55, -v55
    s_nop 0
    v_mul_f32 v48, v48, v53
    v_mul_f32 v248, v248, v54
    v_mul_f32 v252, v252, v55
    v_accvgpr_read_b32 v224, a4
    v_accvgpr_read_b32 v225, a5
    v_accvgpr_read_b32 v226, a6
    v_accvgpr_read_b32 v227, a7
    v_mul_f32 v224, v224, v53
    v_mul_f32 v225, v225, v53
    v_mul_f32 v226, v226, v53
    v_mul_f32 v227, v227, v53
    v_accvgpr_write_b32 a4, v224
    v_accvgpr_write_b32 a5, v225
    v_accvgpr_write_b32 a6, v226
    v_accvgpr_write_b32 a7, v227
    v_accvgpr_read_b32 v224, a8
    v_accvgpr_read_b32 v225, a9
    v_accvgpr_read_b32 v226, a10
    v_accvgpr_read_b32 v227, a11
    v_mul_f32 v224, v224, v54
    v_mul_f32 v225, v225, v54
    v_mul_f32 v226, v226, v54
    v_mul_f32 v227, v227, v54
    v_accvgpr_write_b32 a8, v224
    v_accvgpr_write_b32 a9, v225
    v_accvgpr_write_b32 a10, v226
    v_accvgpr_write_b32 a11, v227
    v_accvgpr_read_b32 v224, a12
    v_accvgpr_read_b32 v225, a13
    v_accvgpr_read_b32 v226, a14
    v_accvgpr_read_b32 v227, a15
    v_mul_f32 v224, v224, v55
    v_mul_f32 v225, v225, v55
    v_mul_f32 v226, v226, v55
    v_mul_f32 v227, v227, v55
    v_accvgpr_write_b32 a12, v224
    v_accvgpr_write_b32 a13, v225
    v_accvgpr_write_b32 a14, v226
    v_accvgpr_write_b32 a15, v227
    v_accvgpr_read_b32 v224, a20
    v_accvgpr_read_b32 v225, a21
    v_accvgpr_read_b32 v226, a22
    v_accvgpr_read_b32 v227, a23
    v_mul_f32 v224, v224, v53
    v_mul_f32 v225, v225, v53
    v_mul_f32 v226, v226, v53
    v_mul_f32 v227, v227, v53
    v_accvgpr_write_b32 a20, v224
    v_accvgpr_write_b32 a21, v225
    v_accvgpr_write_b32 a22, v226
    v_accvgpr_write_b32 a23, v227
    v_accvgpr_read_b32 v224, a24
    v_accvgpr_read_b32 v225, a25
    v_accvgpr_read_b32 v226, a26
    v_accvgpr_read_b32 v227, a27
    v_mul_f32 v224, v224, v54
    v_mul_f32 v225, v225, v54
    v_mul_f32 v226, v226, v54
    v_mul_f32 v227, v227, v54
    v_accvgpr_write_b32 a24, v224
    v_accvgpr_write_b32 a25, v225
    v_accvgpr_write_b32 a26, v226
    v_accvgpr_write_b32 a27, v227
    v_accvgpr_read_b32 v224, a28
    v_accvgpr_read_b32 v225, a29
    v_accvgpr_read_b32 v226, a30
    v_accvgpr_read_b32 v227, a31
    v_mul_f32 v224, v224, v55
    v_mul_f32 v225, v225, v55
    v_mul_f32 v226, v226, v55
    v_mul_f32 v227, v227, v55
    v_accvgpr_write_b32 a28, v224
    v_accvgpr_write_b32 a29, v225
    v_accvgpr_write_b32 a30, v226
    v_accvgpr_write_b32 a31, v227
    v_accvgpr_read_b32 v224, a36
    v_accvgpr_read_b32 v225, a37
    v_accvgpr_read_b32 v226, a38
    v_accvgpr_read_b32 v227, a39
    v_mul_f32 v224, v224, v53
    v_mul_f32 v225, v225, v53
    v_mul_f32 v226, v226, v53
    v_mul_f32 v227, v227, v53
    v_accvgpr_write_b32 a36, v224
    v_accvgpr_write_b32 a37, v225
    v_accvgpr_write_b32 a38, v226
    v_accvgpr_write_b32 a39, v227
    v_accvgpr_read_b32 v224, a40
    v_accvgpr_read_b32 v225, a41
    v_accvgpr_read_b32 v226, a42
    v_accvgpr_read_b32 v227, a43
    v_mul_f32 v224, v224, v54
    v_mul_f32 v225, v225, v54
    v_mul_f32 v226, v226, v54
    v_mul_f32 v227, v227, v54
    v_accvgpr_write_b32 a40, v224
    v_accvgpr_write_b32 a41, v225
    v_accvgpr_write_b32 a42, v226
    v_accvgpr_write_b32 a43, v227
    v_accvgpr_read_b32 v224, a44
    v_accvgpr_read_b32 v225, a45
    v_accvgpr_read_b32 v226, a46
    v_accvgpr_read_b32 v227, a47
    v_mul_f32 v224, v224, v55
    v_mul_f32 v225, v225, v55
    v_mul_f32 v226, v226, v55
    v_mul_f32 v227, v227, v55
    v_accvgpr_write_b32 a44, v224
    v_accvgpr_write_b32 a45, v225
    v_accvgpr_write_b32 a46, v226
    v_accvgpr_write_b32 a47, v227
    v_accvgpr_read_b32 v224, a52
    v_accvgpr_read_b32 v225, a53
    v_accvgpr_read_b32 v226, a54
    v_accvgpr_read_b32 v227, a55
    v_mul_f32 v224, v224, v53
    v_mul_f32 v225, v225, v53
    v_mul_f32 v226, v226, v53
    v_mul_f32 v227, v227, v53
    v_accvgpr_write_b32 a52, v224
    v_accvgpr_write_b32 a53, v225
    v_accvgpr_write_b32 a54, v226
    v_accvgpr_write_b32 a55, v227
    v_accvgpr_read_b32 v224, a56
    v_accvgpr_read_b32 v225, a57
    v_accvgpr_read_b32 v226, a58
    v_accvgpr_read_b32 v227, a59
    v_mul_f32 v224, v224, v54
    v_mul_f32 v225, v225, v54
    v_mul_f32 v226, v226, v54
    v_mul_f32 v227, v227, v54
    v_accvgpr_write_b32 a56, v224
    v_accvgpr_write_b32 a57, v225
    v_accvgpr_write_b32 a58, v226
    v_accvgpr_write_b32 a59, v227
    v_accvgpr_read_b32 v224, a60
    v_accvgpr_read_b32 v225, a61
    v_accvgpr_read_b32 v226, a62
    v_accvgpr_read_b32 v227, a63
    v_mul_f32 v224, v224, v55
    v_mul_f32 v225, v225, v55
    v_mul_f32 v226, v226, v55
    v_mul_f32 v227, v227, v55
    v_accvgpr_write_b32 a60, v224
    v_accvgpr_write_b32 a61, v225
    v_accvgpr_write_b32 a62, v226
    v_accvgpr_write_b32 a63, v227
    v_accvgpr_read_b32 v224, a68
    v_accvgpr_read_b32 v225, a69
    v_accvgpr_read_b32 v226, a70
    v_accvgpr_read_b32 v227, a71
    v_mul_f32 v224, v224, v53
    v_mul_f32 v225, v225, v53
    v_mul_f32 v226, v226, v53
    v_mul_f32 v227, v227, v53
    v_accvgpr_write_b32 a68, v224
    v_accvgpr_write_b32 a69, v225
    v_accvgpr_write_b32 a70, v226
    v_accvgpr_write_b32 a71, v227
    v_accvgpr_read_b32 v224, a72
    v_accvgpr_read_b32 v225, a73
    v_accvgpr_read_b32 v226, a74
    v_accvgpr_read_b32 v227, a75
    v_mul_f32 v224, v224, v54
    v_mul_f32 v225, v225, v54
    v_mul_f32 v226, v226, v54
    v_mul_f32 v227, v227, v54
    v_accvgpr_write_b32 a72, v224
    v_accvgpr_write_b32 a73, v225
    v_accvgpr_write_b32 a74, v226
    v_accvgpr_write_b32 a75, v227
    v_accvgpr_read_b32 v224, a76
    v_accvgpr_read_b32 v225, a77
    v_accvgpr_read_b32 v226, a78
    v_accvgpr_read_b32 v227, a79
    v_mul_f32 v224, v224, v55
    v_mul_f32 v225, v225, v55
    v_mul_f32 v226, v226, v55
    v_mul_f32 v227, v227, v55
    v_accvgpr_write_b32 a76, v224
    v_accvgpr_write_b32 a77, v225
    v_accvgpr_write_b32 a78, v226
    v_accvgpr_write_b32 a79, v227
    v_accvgpr_read_b32 v224, a84
    v_accvgpr_read_b32 v225, a85
    v_accvgpr_read_b32 v226, a86
    v_accvgpr_read_b32 v227, a87
    v_mul_f32 v224, v224, v53
    v_mul_f32 v225, v225, v53
    v_mul_f32 v226, v226, v53
    v_mul_f32 v227, v227, v53
    v_accvgpr_write_b32 a84, v224
    v_accvgpr_write_b32 a85, v225
    v_accvgpr_write_b32 a86, v226
    v_accvgpr_write_b32 a87, v227
    v_accvgpr_read_b32 v224, a88
    v_accvgpr_read_b32 v225, a89
    v_accvgpr_read_b32 v226, a90
    v_accvgpr_read_b32 v227, a91
    v_mul_f32 v224, v224, v54
    v_mul_f32 v225, v225, v54
    v_mul_f32 v226, v226, v54
    v_mul_f32 v227, v227, v54
    v_accvgpr_write_b32 a88, v224
    v_accvgpr_write_b32 a89, v225
    v_accvgpr_write_b32 a90, v226
    v_accvgpr_write_b32 a91, v227
    v_accvgpr_read_b32 v224, a92
    v_accvgpr_read_b32 v225, a93
    v_accvgpr_read_b32 v226, a94
    v_accvgpr_read_b32 v227, a95
    v_mul_f32 v224, v224, v55
    v_mul_f32 v225, v225, v55
    v_mul_f32 v226, v226, v55
    v_mul_f32 v227, v227, v55
    v_accvgpr_write_b32 a92, v224
    v_accvgpr_write_b32 a93, v225
    v_accvgpr_write_b32 a94, v226
    v_accvgpr_write_b32 a95, v227
    v_accvgpr_read_b32 v224, a100
    v_accvgpr_read_b32 v225, a101
    v_accvgpr_read_b32 v226, a102
    v_accvgpr_read_b32 v227, a103
    v_mul_f32 v224, v224, v53
    v_mul_f32 v225, v225, v53
    v_mul_f32 v226, v226, v53
    v_mul_f32 v227, v227, v53
    v_accvgpr_write_b32 a100, v224
    v_accvgpr_write_b32 a101, v225
    v_accvgpr_write_b32 a102, v226
    v_accvgpr_write_b32 a103, v227
    v_accvgpr_read_b32 v224, a104
    v_accvgpr_read_b32 v225, a105
    v_accvgpr_read_b32 v226, a106
    v_accvgpr_read_b32 v227, a107
    v_mul_f32 v224, v224, v54
    v_mul_f32 v225, v225, v54
    v_mul_f32 v226, v226, v54
    v_mul_f32 v227, v227, v54
    v_accvgpr_write_b32 a104, v224
    v_accvgpr_write_b32 a105, v225
    v_accvgpr_write_b32 a106, v226
    v_accvgpr_write_b32 a107, v227
    v_accvgpr_read_b32 v224, a108
    v_accvgpr_read_b32 v225, a109
    v_accvgpr_read_b32 v226, a110
    v_accvgpr_read_b32 v227, a111
    v_mul_f32 v224, v224, v55
    v_mul_f32 v225, v225, v55
    v_mul_f32 v226, v226, v55
    v_mul_f32 v227, v227, v55
    v_accvgpr_write_b32 a108, v224
    v_accvgpr_write_b32 a109, v225
    v_accvgpr_write_b32 a110, v226
    v_accvgpr_write_b32 a111, v227
    v_accvgpr_read_b32 v224, a116
    v_accvgpr_read_b32 v225, a117
    v_accvgpr_read_b32 v226, a118
    v_accvgpr_read_b32 v227, a119
    v_mul_f32 v224, v224, v53
    v_mul_f32 v225, v225, v53
    v_mul_f32 v226, v226, v53
    v_mul_f32 v227, v227, v53
    v_accvgpr_write_b32 a116, v224
    v_accvgpr_write_b32 a117, v225
    v_accvgpr_write_b32 a118, v226
    v_accvgpr_write_b32 a119, v227
    v_accvgpr_read_b32 v224, a120
    v_accvgpr_read_b32 v225, a121
    v_accvgpr_read_b32 v226, a122
    v_accvgpr_read_b32 v227, a123
    v_mul_f32 v224, v224, v54
    v_mul_f32 v225, v225, v54
    v_mul_f32 v226, v226, v54
    v_mul_f32 v227, v227, v54
    v_accvgpr_write_b32 a120, v224
    v_accvgpr_write_b32 a121, v225
    v_accvgpr_write_b32 a122, v226
    v_accvgpr_write_b32 a123, v227
    v_accvgpr_read_b32 v224, a124
    v_accvgpr_read_b32 v225, a125
    v_accvgpr_read_b32 v226, a126
    v_accvgpr_read_b32 v227, a127
    v_mul_f32 v224, v224, v55
    v_mul_f32 v225, v225, v55
    v_mul_f32 v226, v226, v55
    v_mul_f32 v227, v227, v55
    v_accvgpr_write_b32 a124, v224
    v_accvgpr_write_b32 a125, v225
    v_accvgpr_write_b32 a126, v226
    v_accvgpr_write_b32 a127, v227
    v_exp_f32 v232, v132
    v_exp_f32 v233, v133
    v_exp_f32 v234, v134
    v_exp_f32 v235, v135
    s_nop 0
    v_cvt_pk_bf16_f32 v196, v232, v233
    v_cvt_pk_bf16_f32 v197, v234, v235
    v_exp_f32 v232, v148
    v_exp_f32 v233, v149
    v_exp_f32 v234, v150
    v_exp_f32 v235, v151
    s_nop 0
    v_cvt_pk_bf16_f32 v198, v232, v233
    v_cvt_pk_bf16_f32 v199, v234, v235
    v_exp_f32 v232, v136
    v_exp_f32 v233, v137
    v_exp_f32 v234, v138
    v_exp_f32 v235, v139
    s_nop 0
    v_cvt_pk_bf16_f32 v200, v232, v233
    v_cvt_pk_bf16_f32 v201, v234, v235
    v_exp_f32 v232, v152
    v_exp_f32 v233, v153
    v_exp_f32 v234, v154
    v_exp_f32 v235, v155
    s_nop 0
    v_cvt_pk_bf16_f32 v202, v232, v233
    v_cvt_pk_bf16_f32 v203, v234, v235
    v_exp_f32 v232, v140
    v_exp_f32 v233, v141
    v_exp_f32 v234, v142
    v_exp_f32 v235, v143
    s_nop 0
    v_cvt_pk_bf16_f32 v204, v232, v233
    v_cvt_pk_bf16_f32 v205, v234, v235
    v_exp_f32 v232, v156
    v_exp_f32 v233, v157
    v_exp_f32 v234, v158
    v_exp_f32 v235, v159
    s_nop 0
    v_cvt_pk_bf16_f32 v206, v232, v233
    v_cvt_pk_bf16_f32 v207, v234, v235
    s_nop 3
    s_setpc_b64 s[40:41]
k2_rare_165:
    s_nop 7
    v_max_f32 v53, v164, v165
    v_max3_f32 v53, v53, v166, v167
    v_max3_f32 v53, v53, v180, v181
    v_max3_f32 v53, v53, v182, v183
    v_max_f32 v54, v168, v169
    v_max3_f32 v54, v54, v170, v171
    v_max3_f32 v54, v54, v184, v185
    v_max3_f32 v54, v54, v186, v187
    v_max_f32 v55, v172, v173
    v_max3_f32 v55, v55, v174, v175
    v_max3_f32 v55, v55, v188, v189
    v_max3_f32 v55, v55, v190, v191
    v_mov_b32 v225, v53
    v_mov_b32 v226, v54
    v_mov_b32 v227, v55
    s_nop 1
    v_permlane16_swap_b32 v53, v225
    v_permlane16_swap_b32 v54, v226
    v_permlane16_swap_b32 v55, v227
    s_nop 1
    v_max_f32 v53, v53, v225
    v_max_f32 v54, v54, v226
    v_max_f32 v55, v55, v227
    v_mov_b32 v225, v53
    v_mov_b32 v226, v54
    v_mov_b32 v227, v55
    s_nop 1
    v_permlane32_swap_b32 v53, v225
    v_permlane32_swap_b32 v54, v226
    v_permlane32_swap_b32 v55, v227
    s_nop 1
    v_max_f32 v53, v53, v225
    v_max_f32 v54, v54, v226
    v_max_f32 v55, v55, v227
    v_add_f32 v53, 0x41400000, v53
    v_max_f32 v53, 0, v53
    v_add_f32 v54, 0x41400000, v54
    v_max_f32 v54, 0, v54
    v_add_f32 v55, 0x41400000, v55
    v_max_f32 v55, 0, v55
    v_sub_f32 v164, v164, v53
    v_sub_f32 v165, v165, v53
    v_sub_f32 v166, v166, v53
    v_sub_f32 v167, v167, v53
    v_sub_f32 v168, v168, v54
    v_sub_f32 v169, v169, v54
    v_sub_f32 v170, v170, v54
    v_sub_f32 v171, v171, v54
    v_sub_f32 v172, v172, v55
    v_sub_f32 v173, v173, v55
    v_sub_f32 v174, v174, v55
    v_sub_f32 v175, v175, v55
    v_sub_f32 v180, v180, v53
    v_sub_f32 v181, v181, v53
    v_sub_f32 v182, v182, v53
    v_sub_f32 v183, v183, v53
    v_sub_f32 v184, v184, v54
    v_sub_f32 v185, v185, v54
    v_sub_f32 v186, v186, v54
    v_sub_f32 v187, v187, v54
    v_sub_f32 v188, v188, v55
    v_sub_f32 v189, v189, v55
    v_sub_f32 v190, v190, v55
    v_sub_f32 v191, v191, v55
    v_sub_f32 v128, v128, v54
    v_sub_f32 v16, v16, v54
    v_sub_f32 v129, v129, v54
    v_sub_f32 v17, v17, v54
    v_sub_f32 v130, v130, v54
    v_sub_f32 v18, v18, v54
    v_sub_f32 v131, v131, v54
    v_sub_f32 v19, v19, v54
    v_sub_f32 v132, v132, v55
    v_sub_f32 v20, v20, v55
    v_sub_f32 v133, v133, v55
    v_sub_f32 v21, v21, v55
    v_sub_f32 v134, v134, v55
    v_sub_f32 v22, v22, v55
    v_sub_f32 v135, v135, v55
    v_sub_f32 v23, v23, v55
    v_sub_f32 v136, v136, v54
    v_sub_f32 v24, v24, v54
    v_sub_f32 v137, v137, v54
    v_sub_f32 v25, v25, v54
    v_sub_f32 v138, v138, v54
    v_sub_f32 v26, v26, v54
    v_sub_f32 v139, v139, v54
    v_sub_f32 v27, v27, v54
    v_sub_f32 v140, v140, v55
    v_sub_f32 v28, v28, v55
    v_sub_f32 v141, v141, v55
    v_sub_f32 v29, v29, v55
    v_sub_f32 v142, v142, v55
    v_sub_f32 v30, v30, v55
    v_sub_f32 v143, v143, v55
    v_sub_f32 v31, v31, v55
    v_sub_f32 v144, v144, v54
    v_sub_f32 v32, v32, v54
    v_sub_f32 v145, v145, v54
    v_sub_f32 v33, v33, v54
    v_sub_f32 v146, v146, v54
    v_sub_f32 v34, v34, v54
    v_sub_f32 v147, v147, v54
    v_sub_f32 v35, v35, v54
    v_sub_f32 v148, v148, v55
    v_sub_f32 v36, v36, v55
    v_sub_f32 v149, v149, v55
    v_sub_f32 v37, v37, v55
    v_sub_f32 v150, v150, v55
    v_sub_f32 v38, v38, v55
    v_sub_f32 v151, v151, v55
    v_sub_f32 v39, v39, v55
    v_sub_f32 v152, v152, v54
    v_sub_f32 v40, v40, v54
    v_sub_f32 v153, v153, v54
    v_sub_f32 v41, v41, v54
    v_sub_f32 v154, v154, v54
    v_sub_f32 v42, v42, v54
    v_sub_f32 v155, v155, v54
    v_sub_f32 v43, v43, v54
    v_sub_f32 v156, v156, v55
    v_sub_f32 v44, v44, v55
    v_sub_f32 v157, v157, v55
    v_sub_f32 v45, v45, v55
    v_sub_f32 v158, v158, v55
    v_sub_f32 v46, v46, v55
    v_sub_f32 v159, v159, v55
    v_sub_f32 v47, v47, v55
    v_sub_f32 v9, v9, v53
    v_exp_f32 v53, -v53
    v_sub_f32 v10, v10, v54
    v_exp_f32 v54, -v54
    v_sub_f32 v11, v11, v55
    v_exp_f32 v55, -v55
    s_nop 0
    v_mul_f32 v48, v48, v53
    v_mul_f32 v248, v248, v54
    v_mul_f32 v252, v252, v55
    v_accvgpr_read_b32 v224, a4
    v_accvgpr_read_b32 v225, a5
    v_accvgpr_read_b32 v226, a6
    v_accvgpr_read_b32 v227, a7
    v_mul_f32 v224, v224, v53
    v_mul_f32 v225, v225, v53
    v_mul_f32 v226, v226, v53
    v_mul_f32 v227, v227, v53
    v_accvgpr_write_b32 a4, v224
    v_accvgpr_write_b32 a5, v225
    v_accvgpr_write_b32 a6, v226
    v_accvgpr_write_b32 a7, v227
    v_accvgpr_read_b32 v224, a8
    v_accvgpr_read_b32 v225, a9
    v_accvgpr_read_b32 v226, a10
    v_accvgpr_read_b32 v227, a11
    v_mul_f32 v224, v224, v54
    v_mul_f32 v225, v225, v54
    v_mul_f32 v226, v226, v54
    v_mul_f32 v227, v227, v54
    v_accvgpr_write_b32 a8, v224
    v_accvgpr_write_b32 a9, v225
    v_accvgpr_write_b32 a10, v226
    v_accvgpr_write_b32 a11, v227
    v_accvgpr_read_b32 v224, a12
    v_accvgpr_read_b32 v225, a13
    v_accvgpr_read_b32 v226, a14
    v_accvgpr_read_b32 v227, a15
    v_mul_f32 v224, v224, v55
    v_mul_f32 v225, v225, v55
    v_mul_f32 v226, v226, v55
    v_mul_f32 v227, v227, v55
    v_accvgpr_write_b32 a12, v224
    v_accvgpr_write_b32 a13, v225
    v_accvgpr_write_b32 a14, v226
    v_accvgpr_write_b32 a15, v227
    v_accvgpr_read_b32 v224, a20
    v_accvgpr_read_b32 v225, a21
    v_accvgpr_read_b32 v226, a22
    v_accvgpr_read_b32 v227, a23
    v_mul_f32 v224, v224, v53
    v_mul_f32 v225, v225, v53
    v_mul_f32 v226, v226, v53
    v_mul_f32 v227, v227, v53
    v_accvgpr_write_b32 a20, v224
    v_accvgpr_write_b32 a21, v225
    v_accvgpr_write_b32 a22, v226
    v_accvgpr_write_b32 a23, v227
    v_accvgpr_read_b32 v224, a24
    v_accvgpr_read_b32 v225, a25
    v_accvgpr_read_b32 v226, a26
    v_accvgpr_read_b32 v227, a27
    v_mul_f32 v224, v224, v54
    v_mul_f32 v225, v225, v54
    v_mul_f32 v226, v226, v54
    v_mul_f32 v227, v227, v54
    v_accvgpr_write_b32 a24, v224
    v_accvgpr_write_b32 a25, v225
    v_accvgpr_write_b32 a26, v226
    v_accvgpr_write_b32 a27, v227
    v_accvgpr_read_b32 v224, a28
    v_accvgpr_read_b32 v225, a29
    v_accvgpr_read_b32 v226, a30
    v_accvgpr_read_b32 v227, a31
    v_mul_f32 v224, v224, v55
    v_mul_f32 v225, v225, v55
    v_mul_f32 v226, v226, v55
    v_mul_f32 v227, v227, v55
    v_accvgpr_write_b32 a28, v224
    v_accvgpr_write_b32 a29, v225
    v_accvgpr_write_b32 a30, v226
    v_accvgpr_write_b32 a31, v227
    v_accvgpr_read_b32 v224, a36
    v_accvgpr_read_b32 v225, a37
    v_accvgpr_read_b32 v226, a38
    v_accvgpr_read_b32 v227, a39
    v_mul_f32 v224, v224, v53
    v_mul_f32 v225, v225, v53
    v_mul_f32 v226, v226, v53
    v_mul_f32 v227, v227, v53
    v_accvgpr_write_b32 a36, v224
    v_accvgpr_write_b32 a37, v225
    v_accvgpr_write_b32 a38, v226
    v_accvgpr_write_b32 a39, v227
    v_accvgpr_read_b32 v224, a40
    v_accvgpr_read_b32 v225, a41
    v_accvgpr_read_b32 v226, a42
    v_accvgpr_read_b32 v227, a43
    v_mul_f32 v224, v224, v54
    v_mul_f32 v225, v225, v54
    v_mul_f32 v226, v226, v54
    v_mul_f32 v227, v227, v54
    v_accvgpr_write_b32 a40, v224
    v_accvgpr_write_b32 a41, v225
    v_accvgpr_write_b32 a42, v226
    v_accvgpr_write_b32 a43, v227
    v_accvgpr_read_b32 v224, a44
    v_accvgpr_read_b32 v225, a45
    v_accvgpr_read_b32 v226, a46
    v_accvgpr_read_b32 v227, a47
    v_mul_f32 v224, v224, v55
    v_mul_f32 v225, v225, v55
    v_mul_f32 v226, v226, v55
    v_mul_f32 v227, v227, v55
    v_accvgpr_write_b32 a44, v224
    v_accvgpr_write_b32 a45, v225
    v_accvgpr_write_b32 a46, v226
    v_accvgpr_write_b32 a47, v227
    v_accvgpr_read_b32 v224, a52
    v_accvgpr_read_b32 v225, a53
    v_accvgpr_read_b32 v226, a54
    v_accvgpr_read_b32 v227, a55
    v_mul_f32 v224, v224, v53
    v_mul_f32 v225, v225, v53
    v_mul_f32 v226, v226, v53
    v_mul_f32 v227, v227, v53
    v_accvgpr_write_b32 a52, v224
    v_accvgpr_write_b32 a53, v225
    v_accvgpr_write_b32 a54, v226
    v_accvgpr_write_b32 a55, v227
    v_accvgpr_read_b32 v224, a56
    v_accvgpr_read_b32 v225, a57
    v_accvgpr_read_b32 v226, a58
    v_accvgpr_read_b32 v227, a59
    v_mul_f32 v224, v224, v54
    v_mul_f32 v225, v225, v54
    v_mul_f32 v226, v226, v54
    v_mul_f32 v227, v227, v54
    v_accvgpr_write_b32 a56, v224
    v_accvgpr_write_b32 a57, v225
    v_accvgpr_write_b32 a58, v226
    v_accvgpr_write_b32 a59, v227
    v_accvgpr_read_b32 v224, a60
    v_accvgpr_read_b32 v225, a61
    v_accvgpr_read_b32 v226, a62
    v_accvgpr_read_b32 v227, a63
    v_mul_f32 v224, v224, v55
    v_mul_f32 v225, v225, v55
    v_mul_f32 v226, v226, v55
    v_mul_f32 v227, v227, v55
    v_accvgpr_write_b32 a60, v224
    v_accvgpr_write_b32 a61, v225
    v_accvgpr_write_b32 a62, v226
    v_accvgpr_write_b32 a63, v227
    v_accvgpr_read_b32 v224, a68
    v_accvgpr_read_b32 v225, a69
    v_accvgpr_read_b32 v226, a70
    v_accvgpr_read_b32 v227, a71
    v_mul_f32 v224, v224, v53
    v_mul_f32 v225, v225, v53
    v_mul_f32 v226, v226, v53
    v_mul_f32 v227, v227, v53
    v_accvgpr_write_b32 a68, v224
    v_accvgpr_write_b32 a69, v225
    v_accvgpr_write_b32 a70, v226
    v_accvgpr_write_b32 a71, v227
    v_accvgpr_read_b32 v224, a72
    v_accvgpr_read_b32 v225, a73
    v_accvgpr_read_b32 v226, a74
    v_accvgpr_read_b32 v227, a75
    v_mul_f32 v224, v224, v54
    v_mul_f32 v225, v225, v54
    v_mul_f32 v226, v226, v54
    v_mul_f32 v227, v227, v54
    v_accvgpr_write_b32 a72, v224
    v_accvgpr_write_b32 a73, v225
    v_accvgpr_write_b32 a74, v226
    v_accvgpr_write_b32 a75, v227
    v_accvgpr_read_b32 v224, a76
    v_accvgpr_read_b32 v225, a77
    v_accvgpr_read_b32 v226, a78
    v_accvgpr_read_b32 v227, a79
    v_mul_f32 v224, v224, v55
    v_mul_f32 v225, v225, v55
    v_mul_f32 v226, v226, v55
    v_mul_f32 v227, v227, v55
    v_accvgpr_write_b32 a76, v224
    v_accvgpr_write_b32 a77, v225
    v_accvgpr_write_b32 a78, v226
    v_accvgpr_write_b32 a79, v227
    v_accvgpr_read_b32 v224, a84
    v_accvgpr_read_b32 v225, a85
    v_accvgpr_read_b32 v226, a86
    v_accvgpr_read_b32 v227, a87
    v_mul_f32 v224, v224, v53
    v_mul_f32 v225, v225, v53
    v_mul_f32 v226, v226, v53
    v_mul_f32 v227, v227, v53
    v_accvgpr_write_b32 a84, v224
    v_accvgpr_write_b32 a85, v225
    v_accvgpr_write_b32 a86, v226
    v_accvgpr_write_b32 a87, v227
    v_accvgpr_read_b32 v224, a88
    v_accvgpr_read_b32 v225, a89
    v_accvgpr_read_b32 v226, a90
    v_accvgpr_read_b32 v227, a91
    v_mul_f32 v224, v224, v54
    v_mul_f32 v225, v225, v54
    v_mul_f32 v226, v226, v54
    v_mul_f32 v227, v227, v54
    v_accvgpr_write_b32 a88, v224
    v_accvgpr_write_b32 a89, v225
    v_accvgpr_write_b32 a90, v226
    v_accvgpr_write_b32 a91, v227
    v_accvgpr_read_b32 v224, a92
    v_accvgpr_read_b32 v225, a93
    v_accvgpr_read_b32 v226, a94
    v_accvgpr_read_b32 v227, a95
    v_mul_f32 v224, v224, v55
    v_mul_f32 v225, v225, v55
    v_mul_f32 v226, v226, v55
    v_mul_f32 v227, v227, v55
    v_accvgpr_write_b32 a92, v224
    v_accvgpr_write_b32 a93, v225
    v_accvgpr_write_b32 a94, v226
    v_accvgpr_write_b32 a95, v227
    v_accvgpr_read_b32 v224, a100
    v_accvgpr_read_b32 v225, a101
    v_accvgpr_read_b32 v226, a102
    v_accvgpr_read_b32 v227, a103
    v_mul_f32 v224, v224, v53
    v_mul_f32 v225, v225, v53
    v_mul_f32 v226, v226, v53
    v_mul_f32 v227, v227, v53
    v_accvgpr_write_b32 a100, v224
    v_accvgpr_write_b32 a101, v225
    v_accvgpr_write_b32 a102, v226
    v_accvgpr_write_b32 a103, v227
    v_accvgpr_read_b32 v224, a104
    v_accvgpr_read_b32 v225, a105
    v_accvgpr_read_b32 v226, a106
    v_accvgpr_read_b32 v227, a107
    v_mul_f32 v224, v224, v54
    v_mul_f32 v225, v225, v54
    v_mul_f32 v226, v226, v54
    v_mul_f32 v227, v227, v54
    v_accvgpr_write_b32 a104, v224
    v_accvgpr_write_b32 a105, v225
    v_accvgpr_write_b32 a106, v226
    v_accvgpr_write_b32 a107, v227
    v_accvgpr_read_b32 v224, a108
    v_accvgpr_read_b32 v225, a109
    v_accvgpr_read_b32 v226, a110
    v_accvgpr_read_b32 v227, a111
    v_mul_f32 v224, v224, v55
    v_mul_f32 v225, v225, v55
    v_mul_f32 v226, v226, v55
    v_mul_f32 v227, v227, v55
    v_accvgpr_write_b32 a108, v224
    v_accvgpr_write_b32 a109, v225
    v_accvgpr_write_b32 a110, v226
    v_accvgpr_write_b32 a111, v227
    v_accvgpr_read_b32 v224, a116
    v_accvgpr_read_b32 v225, a117
    v_accvgpr_read_b32 v226, a118
    v_accvgpr_read_b32 v227, a119
    v_mul_f32 v224, v224, v53
    v_mul_f32 v225, v225, v53
    v_mul_f32 v226, v226, v53
    v_mul_f32 v227, v227, v53
    v_accvgpr_write_b32 a116, v224
    v_accvgpr_write_b32 a117, v225
    v_accvgpr_write_b32 a118, v226
    v_accvgpr_write_b32 a119, v227
    v_accvgpr_read_b32 v224, a120
    v_accvgpr_read_b32 v225, a121
    v_accvgpr_read_b32 v226, a122
    v_accvgpr_read_b32 v227, a123
    v_mul_f32 v224, v224, v54
    v_mul_f32 v225, v225, v54
    v_mul_f32 v226, v226, v54
    v_mul_f32 v227, v227, v54
    v_accvgpr_write_b32 a120, v224
    v_accvgpr_write_b32 a121, v225
    v_accvgpr_write_b32 a122, v226
    v_accvgpr_write_b32 a123, v227
    v_accvgpr_read_b32 v224, a124
    v_accvgpr_read_b32 v225, a125
    v_accvgpr_read_b32 v226, a126
    v_accvgpr_read_b32 v227, a127
    v_mul_f32 v224, v224, v55
    v_mul_f32 v225, v225, v55
    v_mul_f32 v226, v226, v55
    v_mul_f32 v227, v227, v55
    v_accvgpr_write_b32 a124, v224
    v_accvgpr_write_b32 a125, v225
    v_accvgpr_write_b32 a126, v226
    v_accvgpr_write_b32 a127, v227
    v_exp_f32 v232, v164
    v_exp_f32 v233, v165
    v_exp_f32 v234, v166
    v_exp_f32 v235, v167
    s_nop 0
    v_cvt_pk_bf16_f32 v212, v232, v233
    v_cvt_pk_bf16_f32 v213, v234, v235
    v_exp_f32 v232, v180
    v_exp_f32 v233, v181
    v_exp_f32 v234, v182
    v_exp_f32 v235, v183
    s_nop 0
    v_cvt_pk_bf16_f32 v214, v232, v233
    v_cvt_pk_bf16_f32 v215, v234, v235
    v_exp_f32 v232, v168
    v_exp_f32 v233, v169
    v_exp_f32 v234, v170
    v_exp_f32 v235, v171
    s_nop 0
    v_cvt_pk_bf16_f32 v216, v232, v233
    v_cvt_pk_bf16_f32 v217, v234, v235
    v_exp_f32 v232, v184
    v_exp_f32 v233, v185
    v_exp_f32 v234, v186
    v_exp_f32 v235, v187
    s_nop 0
    v_cvt_pk_bf16_f32 v218, v232, v233
    v_cvt_pk_bf16_f32 v219, v234, v235
    v_exp_f32 v232, v172
    v_exp_f32 v233, v173
    v_exp_f32 v234, v174
    v_exp_f32 v235, v175
    s_nop 0
    v_cvt_pk_bf16_f32 v220, v232, v233
    v_cvt_pk_bf16_f32 v221, v234, v235
    v_exp_f32 v232, v188
    v_exp_f32 v233, v189
    v_exp_f32 v234, v190
    v_exp_f32 v235, v191
    s_nop 0
    v_cvt_pk_bf16_f32 v222, v232, v233
    v_cvt_pk_bf16_f32 v223, v234, v235
    s_nop 3
    s_setpc_b64 s[40:41]
k2_rare_166:
    s_nop 7
    v_max_f32 v54, v128, v129
    v_max3_f32 v54, v54, v130, v131
    v_max3_f32 v54, v54, v144, v145
    v_max3_f32 v54, v54, v146, v147
    v_max3_f32 v54, v54, v136, v137
    v_max3_f32 v54, v54, v138, v139
    v_max3_f32 v54, v54, v152, v153
    v_max3_f32 v54, v54, v154, v155
    v_max_f32 v55, v132, v133
    v_max3_f32 v55, v55, v134, v135
    v_max3_f32 v55, v55, v148, v149
    v_max3_f32 v55, v55, v150, v151
    v_max3_f32 v55, v55, v140, v141
    v_max3_f32 v55, v55, v142, v143
    v_max3_f32 v55, v55, v156, v157
    v_max3_f32 v55, v55, v158, v159
    v_mov_b32 v226, v54
    v_mov_b32 v227, v55
    s_nop 1
    v_permlane16_swap_b32 v54, v226
    v_permlane16_swap_b32 v55, v227
    s_nop 1
    v_max_f32 v54, v54, v226
    v_max_f32 v55, v55, v227
    v_mov_b32 v226, v54
    v_mov_b32 v227, v55
    s_nop 1
    v_permlane32_swap_b32 v54, v226
    v_permlane32_swap_b32 v55, v227
    s_nop 1
    v_max_f32 v54, v54, v226
    v_max_f32 v55, v55, v227
    v_add_f32 v54, 0x41400000, v54
    v_max_f32 v54, 0, v54
    v_add_f32 v55, 0x41400000, v55
    v_max_f32 v55, 0, v55
    v_sub_f32 v128, v128, v54
    v_sub_f32 v129, v129, v54
    v_sub_f32 v130, v130, v54
    v_sub_f32 v131, v131, v54
    v_sub_f32 v132, v132, v55
    v_sub_f32 v133, v133, v55
    v_sub_f32 v134, v134, v55
    v_sub_f32 v135, v135, v55
    v_sub_f32 v136, v136, v54
    v_sub_f32 v137, v137, v54
    v_sub_f32 v138, v138, v54
    v_sub_f32 v139, v139, v54
    v_sub_f32 v140, v140, v55
    v_sub_f32 v141, v141, v55
    v_sub_f32 v142, v142, v55
    v_sub_f32 v143, v143, v55
    v_sub_f32 v144, v144, v54
    v_sub_f32 v145, v145, v54
    v_sub_f32 v146, v146, v54
    v_sub_f32 v147, v147, v54
    v_sub_f32 v148, v148, v55
    v_sub_f32 v149, v149, v55
    v_sub_f32 v150, v150, v55
    v_sub_f32 v151, v151, v55
    v_sub_f32 v152, v152, v54
    v_sub_f32 v153, v153, v54
    v_sub_f32 v154, v154, v54
    v_sub_f32 v155, v155, v54
    v_sub_f32 v156, v156, v55
    v_sub_f32 v157, v157, v55
    v_sub_f32 v158, v158, v55
    v_sub_f32 v159, v159, v55
    v_sub_f32 v160, v160, v54
    v_sub_f32 v16, v16, v54
    v_sub_f32 v161, v161, v54
    v_sub_f32 v17, v17, v54
    v_sub_f32 v162, v162, v54
    v_sub_f32 v18, v18, v54
    v_sub_f32 v163, v163, v54
    v_sub_f32 v19, v19, v54
    v_sub_f32 v164, v164, v55
    v_sub_f32 v20, v20, v55
    v_sub_f32 v165, v165, v55
    v_sub_f32 v21, v21, v55
    v_sub_f32 v166, v166, v55
    v_sub_f32 v22, v22, v55
    v_sub_f32 v167, v167, v55
    v_sub_f32 v23, v23, v55
    v_sub_f32 v168, v168, v54
    v_sub_f32 v24, v24, v54
    v_sub_f32 v169, v169, v54
    v_sub_f32 v25, v25, v54
    v_sub_f32 v170, v170, v54
    v_sub_f32 v26, v26, v54
    v_sub_f32 v171, v171, v54
    v_sub_f32 v27, v27, v54
    v_sub_f32 v172, v172, v55
    v_sub_f32 v28, v28, v55
    v_sub_f32 v173, v173, v55
    v_sub_f32 v29, v29, v55
    v_sub_f32 v174, v174, v55
    v_sub_f32 v30, v30, v55
    v_sub_f32 v175, v175, v55
    v_sub_f32 v31, v31, v55
    v_sub_f32 v176, v176, v54
    v_sub_f32 v32, v32, v54
    v_sub_f32 v177, v177, v54
    v_sub_f32 v33, v33, v54
    v_sub_f32 v178, v178, v54
    v_sub_f32 v34, v34, v54
    v_sub_f32 v179, v179, v54
    v_sub_f32 v35, v35, v54
    v_sub_f32 v180, v180, v55
    v_sub_f32 v36, v36, v55
    v_sub_f32 v181, v181, v55
    v_sub_f32 v37, v37, v55
    v_sub_f32 v182, v182, v55
    v_sub_f32 v38, v38, v55
    v_sub_f32 v183, v183, v55
    v_sub_f32 v39, v39, v55
    v_sub_f32 v184, v184, v54
    v_sub_f32 v40, v40, v54
    v_sub_f32 v185, v185, v54
    v_sub_f32 v41, v41, v54
    v_sub_f32 v186, v186, v54
    v_sub_f32 v42, v42, v54
    v_sub_f32 v187, v187, v54
    v_sub_f32 v43, v43, v54
    v_sub_f32 v188, v188, v55
    v_sub_f32 v44, v44, v55
    v_sub_f32 v189, v189, v55
    v_sub_f32 v45, v45, v55
    v_sub_f32 v190, v190, v55
    v_sub_f32 v46, v46, v55
    v_sub_f32 v191, v191, v55
    v_sub_f32 v47, v47, v55
    v_sub_f32 v10, v10, v54
    v_exp_f32 v54, -v54
    v_sub_f32 v11, v11, v55
    v_exp_f32 v55, -v55
    s_nop 0
    v_mul_f32 v248, v248, v54
    v_mul_f32 v252, v252, v55
    v_accvgpr_read_b32 v224, a8
    v_accvgpr_read_b32 v225, a9
    v_accvgpr_read_b32 v226, a10
    v_accvgpr_read_b32 v227, a11
    v_mul_f32 v224, v224, v54
    v_mul_f32 v225, v225, v54
    v_mul_f32 v226, v226, v54
    v_mul_f32 v227, v227, v54
    v_accvgpr_write_b32 a8, v224
    v_accvgpr_write_b32 a9, v225
    v_accvgpr_write_b32 a10, v226
    v_accvgpr_write_b32 a11, v227
    v_accvgpr_read_b32 v224, a12
    v_accvgpr_read_b32 v225, a13
    v_accvgpr_read_b32 v226, a14
    v_accvgpr_read_b32 v227, a15
    v_mul_f32 v224, v224, v55
    v_mul_f32 v225, v225, v55
    v_mul_f32 v226, v226, v55
    v_mul_f32 v227, v227, v55
    v_accvgpr_write_b32 a12, v224
    v_accvgpr_write_b32 a13, v225
    v_accvgpr_write_b32 a14, v226
    v_accvgpr_write_b32 a15, v227
    v_accvgpr_read_b32 v224, a24
    v_accvgpr_read_b32 v225, a25
    v_accvgpr_read_b32 v226, a26
    v_accvgpr_read_b32 v227, a27
    v_mul_f32 v224, v224, v54
    v_mul_f32 v225, v225, v54
    v_mul_f32 v226, v226, v54
    v_mul_f32 v227, v227, v54
    v_accvgpr_write_b32 a24, v224
    v_accvgpr_write_b32 a25, v225
    v_accvgpr_write_b32 a26, v226
    v_accvgpr_write_b32 a27, v227
    v_accvgpr_read_b32 v224, a28
    v_accvgpr_read_b32 v225, a29
    v_accvgpr_read_b32 v226, a30
    v_accvgpr_read_b32 v227, a31
    v_mul_f32 v224, v224, v55
    v_mul_f32 v225, v225, v55
    v_mul_f32 v226, v226, v55
    v_mul_f32 v227, v227, v55
    v_accvgpr_write_b32 a28, v224
    v_accvgpr_write_b32 a29, v225
    v_accvgpr_write_b32 a30, v226
    v_accvgpr_write_b32 a31, v227
    v_accvgpr_read_b32 v224, a40
    v_accvgpr_read_b32 v225, a41
    v_accvgpr_read_b32 v226, a42
    v_accvgpr_read_b32 v227, a43
    v_mul_f32 v224, v224, v54
    v_mul_f32 v225, v225, v54
    v_mul_f32 v226, v226, v54
    v_mul_f32 v227, v227, v54
    v_accvgpr_write_b32 a40, v224
    v_accvgpr_write_b32 a41, v225
    v_accvgpr_write_b32 a42, v226
    v_accvgpr_write_b32 a43, v227
    v_accvgpr_read_b32 v224, a44
    v_accvgpr_read_b32 v225, a45
    v_accvgpr_read_b32 v226, a46
    v_accvgpr_read_b32 v227, a47
    v_mul_f32 v224, v224, v55
    v_mul_f32 v225, v225, v55
    v_mul_f32 v226, v226, v55
    v_mul_f32 v227, v227, v55
    v_accvgpr_write_b32 a44, v224
    v_accvgpr_write_b32 a45, v225
    v_accvgpr_write_b32 a46, v226
    v_accvgpr_write_b32 a47, v227
    v_accvgpr_read_b32 v224, a56
    v_accvgpr_read_b32 v225, a57
    v_accvgpr_read_b32 v226, a58
    v_accvgpr_read_b32 v227, a59
    v_mul_f32 v224, v224, v54
    v_mul_f32 v225, v225, v54
    v_mul_f32 v226, v226, v54
    v_mul_f32 v227, v227, v54
    v_accvgpr_write_b32 a56, v224
    v_accvgpr_write_b32 a57, v225
    v_accvgpr_write_b32 a58, v226
    v_accvgpr_write_b32 a59, v227
    v_accvgpr_read_b32 v224, a60
    v_accvgpr_read_b32 v225, a61
    v_accvgpr_read_b32 v226, a62
    v_accvgpr_read_b32 v227, a63
    v_mul_f32 v224, v224, v55
    v_mul_f32 v225, v225, v55
    v_mul_f32 v226, v226, v55
    v_mul_f32 v227, v227, v55
    v_accvgpr_write_b32 a60, v224
    v_accvgpr_write_b32 a61, v225
    v_accvgpr_write_b32 a62, v226
    v_accvgpr_write_b32 a63, v227
    v_accvgpr_read_b32 v224, a72
    v_accvgpr_read_b32 v225, a73
    v_accvgpr_read_b32 v226, a74
    v_accvgpr_read_b32 v227, a75
    v_mul_f32 v224, v224, v54
    v_mul_f32 v225, v225, v54
    v_mul_f32 v226, v226, v54
    v_mul_f32 v227, v227, v54
    v_accvgpr_write_b32 a72, v224
    v_accvgpr_write_b32 a73, v225
    v_accvgpr_write_b32 a74, v226
    v_accvgpr_write_b32 a75, v227
    v_accvgpr_read_b32 v224, a76
    v_accvgpr_read_b32 v225, a77
    v_accvgpr_read_b32 v226, a78
    v_accvgpr_read_b32 v227, a79
    v_mul_f32 v224, v224, v55
    v_mul_f32 v225, v225, v55
    v_mul_f32 v226, v226, v55
    v_mul_f32 v227, v227, v55
    v_accvgpr_write_b32 a76, v224
    v_accvgpr_write_b32 a77, v225
    v_accvgpr_write_b32 a78, v226
    v_accvgpr_write_b32 a79, v227
    v_accvgpr_read_b32 v224, a88
    v_accvgpr_read_b32 v225, a89
    v_accvgpr_read_b32 v226, a90
    v_accvgpr_read_b32 v227, a91
    v_mul_f32 v224, v224, v54
    v_mul_f32 v225, v225, v54
    v_mul_f32 v226, v226, v54
    v_mul_f32 v227, v227, v54
    v_accvgpr_write_b32 a88, v224
    v_accvgpr_write_b32 a89, v225
    v_accvgpr_write_b32 a90, v226
    v_accvgpr_write_b32 a91, v227
    v_accvgpr_read_b32 v224, a92
    v_accvgpr_read_b32 v225, a93
    v_accvgpr_read_b32 v226, a94
    v_accvgpr_read_b32 v227, a95
    v_mul_f32 v224, v224, v55
    v_mul_f32 v225, v225, v55
    v_mul_f32 v226, v226, v55
    v_mul_f32 v227, v227, v55
    v_accvgpr_write_b32 a92, v224
    v_accvgpr_write_b32 a93, v225
    v_accvgpr_write_b32 a94, v226
    v_accvgpr_write_b32 a95, v227
    v_accvgpr_read_b32 v224, a104
    v_accvgpr_read_b32 v225, a105
    v_accvgpr_read_b32 v226, a106
    v_accvgpr_read_b32 v227, a107
    v_mul_f32 v224, v224, v54
    v_mul_f32 v225, v225, v54
    v_mul_f32 v226, v226, v54
    v_mul_f32 v227, v227, v54
    v_accvgpr_write_b32 a104, v224
    v_accvgpr_write_b32 a105, v225
    v_accvgpr_write_b32 a106, v226
    v_accvgpr_write_b32 a107, v227
    v_accvgpr_read_b32 v224, a108
    v_accvgpr_read_b32 v225, a109
    v_accvgpr_read_b32 v226, a110
    v_accvgpr_read_b32 v227, a111
    v_mul_f32 v224, v224, v55
    v_mul_f32 v225, v225, v55
    v_mul_f32 v226, v226, v55
    v_mul_f32 v227, v227, v55
    v_accvgpr_write_b32 a108, v224
    v_accvgpr_write_b32 a109, v225
    v_accvgpr_write_b32 a110, v226
    v_accvgpr_write_b32 a111, v227
    v_accvgpr_read_b32 v224, a120
    v_accvgpr_read_b32 v225, a121
    v_accvgpr_read_b32 v226, a122
    v_accvgpr_read_b32 v227, a123
    v_mul_f32 v224, v224, v54
    v_mul_f32 v225, v225, v54
    v_mul_f32 v226, v226, v54
    v_mul_f32 v227, v227, v54
    v_accvgpr_write_b32 a120, v224
    v_accvgpr_write_b32 a121, v225
    v_accvgpr_write_b32 a122, v226
    v_accvgpr_write_b32 a123, v227
    v_accvgpr_read_b32 v224, a124
    v_accvgpr_read_b32 v225, a125
    v_accvgpr_read_b32 v226, a126
    v_accvgpr_read_b32 v227, a127
    v_mul_f32 v224, v224, v55
    v_mul_f32 v225, v225, v55
    v_mul_f32 v226, v226, v55
    v_mul_f32 v227, v227, v55
    v_accvgpr_write_b32 a124, v224
    v_accvgpr_write_b32 a125, v225
    v_accvgpr_write_b32 a126, v226
    v_accvgpr_write_b32 a127, v227
    v_exp_f32 v232, v128
    v_exp_f32 v233, v129
    v_exp_f32 v234, v130
    v_exp_f32 v235, v131
    s_nop 0
    v_cvt_pk_bf16_f32 v192, v232, v233
    v_cvt_pk_bf16_f32 v193, v234, v235
    v_exp_f32 v232, v144
    v_exp_f32 v233, v145
    v_exp_f32 v234, v146
    v_exp_f32 v235, v147
    s_nop 0
    v_cvt_pk_bf16_f32 v194, v232, v233
    v_cvt_pk_bf16_f32 v195, v234, v235
    v_exp_f32 v232, v132
    v_exp_f32 v233, v133
    v_exp_f32 v234, v134
    v_exp_f32 v235, v135
    s_nop 0
    v_cvt_pk_bf16_f32 v196, v232, v233
    v_cvt_pk_bf16_f32 v197, v234, v235
    v_exp_f32 v232, v148
    v_exp_f32 v233, v149
    v_exp_f32 v234, v150
    v_exp_f32 v235, v151
    s_nop 0
    v_cvt_pk_bf16_f32 v198, v232, v233
    v_cvt_pk_bf16_f32 v199, v234, v235
    v_exp_f32 v232, v136
    v_exp_f32 v233, v137
    v_exp_f32 v234, v138
    v_exp_f32 v235, v139
    s_nop 0
    v_cvt_pk_bf16_f32 v200, v232, v233
    v_cvt_pk_bf16_f32 v201, v234, v235
    v_exp_f32 v232, v152
    v_exp_f32 v233, v153
    v_exp_f32 v234, v154
    v_exp_f32 v235, v155
    s_nop 0
    v_cvt_pk_bf16_f32 v202, v232, v233
    v_cvt_pk_bf16_f32 v203, v234, v235
    v_exp_f32 v232, v140
    v_exp_f32 v233, v141
    v_exp_f32 v234, v142
    v_exp_f32 v235, v143
    s_nop 0
    v_cvt_pk_bf16_f32 v204, v232, v233
    v_cvt_pk_bf16_f32 v205, v234, v235
    v_exp_f32 v232, v156
    v_exp_f32 v233, v157
    v_exp_f32 v234, v158
    v_exp_f32 v235, v159
    s_nop 0
    v_cvt_pk_bf16_f32 v206, v232, v233
    v_cvt_pk_bf16_f32 v207, v234, v235
    s_nop 3
    s_setpc_b64 s[40:41]
k2_rare_167:
    s_nop 7
    v_max_f32 v54, v160, v161
    v_max3_f32 v54, v54, v162, v163
    v_max3_f32 v54, v54, v176, v177
    v_max3_f32 v54, v54, v178, v179
    v_max3_f32 v54, v54, v168, v169
    v_max3_f32 v54, v54, v170, v171
    v_max3_f32 v54, v54, v184, v185
    v_max3_f32 v54, v54, v186, v187
    v_max_f32 v55, v164, v165
    v_max3_f32 v55, v55, v166, v167
    v_max3_f32 v55, v55, v180, v181
    v_max3_f32 v55, v55, v182, v183
    v_max3_f32 v55, v55, v172, v173
    v_max3_f32 v55, v55, v174, v175
    v_max3_f32 v55, v55, v188, v189
    v_max3_f32 v55, v55, v190, v191
    v_mov_b32 v226, v54
    v_mov_b32 v227, v55
    s_nop 1
    v_permlane16_swap_b32 v54, v226
    v_permlane16_swap_b32 v55, v227
    s_nop 1
    v_max_f32 v54, v54, v226
    v_max_f32 v55, v55, v227
    v_mov_b32 v226, v54
    v_mov_b32 v227, v55
    s_nop 1
    v_permlane32_swap_b32 v54, v226
    v_permlane32_swap_b32 v55, v227
    s_nop 1
    v_max_f32 v54, v54, v226
    v_max_f32 v55, v55, v227
    v_add_f32 v54, 0x41400000, v54
    v_max_f32 v54, 0, v54
    v_add_f32 v55, 0x41400000, v55
    v_max_f32 v55, 0, v55
    v_sub_f32 v160, v160, v54
    v_sub_f32 v161, v161, v54
    v_sub_f32 v162, v162, v54
    v_sub_f32 v163, v163, v54
    v_sub_f32 v164, v164, v55
    v_sub_f32 v165, v165, v55
    v_sub_f32 v166, v166, v55
    v_sub_f32 v167, v167, v55
    v_sub_f32 v168, v168, v54
    v_sub_f32 v169, v169, v54
    v_sub_f32 v170, v170, v54
    v_sub_f32 v171, v171, v54
    v_sub_f32 v172, v172, v55
    v_sub_f32 v173, v173, v55
    v_sub_f32 v174, v174, v55
    v_sub_f32 v175, v175, v55
    v_sub_f32 v176, v176, v54
    v_sub_f32 v177, v177, v54
    v_sub_f32 v178, v178, v54
    v_sub_f32 v179, v179, v54
    v_sub_f32 v180, v180, v55
    v_sub_f32 v181, v181, v55
    v_sub_f32 v182, v182, v55
    v_sub_f32 v183, v183, v55
    v_sub_f32 v184, v184, v54
    v_sub_f32 v185, v185, v54
    v_sub_f32 v186, v186, v54
    v_sub_f32 v187, v187, v54
    v_sub_f32 v188, v188, v55
    v_sub_f32 v189, v189, v55
    v_sub_f32 v190, v190, v55
    v_sub_f32 v191, v191, v55
    v_sub_f32 v128, v128, v54
    v_sub_f32 v16, v16, v54
    v_sub_f32 v129, v129, v54
    v_sub_f32 v17, v17, v54
    v_sub_f32 v130, v130, v54
    v_sub_f32 v18, v18, v54
    v_sub_f32 v131, v131, v54
    v_sub_f32 v19, v19, v54
    v_sub_f32 v132, v132, v55
    v_sub_f32 v20, v20, v55
    v_sub_f32 v133, v133, v55
    v_sub_f32 v21, v21, v55
    v_sub_f32 v134, v134, v55
    v_sub_f32 v22, v22, v55
    v_sub_f32 v135, v135, v55
    v_sub_f32 v23, v23, v55
    v_sub_f32 v136, v136, v54
    v_sub_f32 v24, v24, v54
    v_sub_f32 v137, v137, v54
    v_sub_f32 v25, v25, v54
    v_sub_f32 v138, v138, v54
    v_sub_f32 v26, v26, v54
    v_sub_f32 v139, v139, v54
    v_sub_f32 v27, v27, v54
    v_sub_f32 v140, v140, v55
    v_sub_f32 v28, v28, v55
    v_sub_f32 v141, v141, v55
    v_sub_f32 v29, v29, v55
    v_sub_f32 v142, v142, v55
    v_sub_f32 v30, v30, v55
    v_sub_f32 v143, v143, v55
    v_sub_f32 v31, v31, v55
    v_sub_f32 v144, v144, v54
    v_sub_f32 v32, v32, v54
    v_sub_f32 v145, v145, v54
    v_sub_f32 v33, v33, v54
    v_sub_f32 v146, v146, v54
    v_sub_f32 v34, v34, v54
    v_sub_f32 v147, v147, v54
    v_sub_f32 v35, v35, v54
    v_sub_f32 v148, v148, v55
    v_sub_f32 v36, v36, v55
    v_sub_f32 v149, v149, v55
    v_sub_f32 v37, v37, v55
    v_sub_f32 v150, v150, v55
    v_sub_f32 v38, v38, v55
    v_sub_f32 v151, v151, v55
    v_sub_f32 v39, v39, v55
    v_sub_f32 v152, v152, v54
    v_sub_f32 v40, v40, v54
    v_sub_f32 v153, v153, v54
    v_sub_f32 v41, v41, v54
    v_sub_f32 v154, v154, v54
    v_sub_f32 v42, v42, v54
    v_sub_f32 v155, v155, v54
    v_sub_f32 v43, v43, v54
    v_sub_f32 v156, v156, v55
    v_sub_f32 v44, v44, v55
    v_sub_f32 v157, v157, v55
    v_sub_f32 v45, v45, v55
    v_sub_f32 v158, v158, v55
    v_sub_f32 v46, v46, v55
    v_sub_f32 v159, v159, v55
    v_sub_f32 v47, v47, v55
    v_sub_f32 v10, v10, v54
    v_exp_f32 v54, -v54
    v_sub_f32 v11, v11, v55
    v_exp_f32 v55, -v55
    s_nop 0
    v_mul_f32 v248, v248, v54
    v_mul_f32 v252, v252, v55
    v_accvgpr_read_b32 v224, a8
    v_accvgpr_read_b32 v225, a9
    v_accvgpr_read_b32 v226, a10
    v_accvgpr_read_b32 v227, a11
    v_mul_f32 v224, v224, v54
    v_mul_f32 v225, v225, v54
    v_mul_f32 v226, v226, v54
    v_mul_f32 v227, v227, v54
    v_accvgpr_write_b32 a8, v224
    v_accvgpr_write_b32 a9, v225
    v_accvgpr_write_b32 a10, v226
    v_accvgpr_write_b32 a11, v227
    v_accvgpr_read_b32 v224, a12
    v_accvgpr_read_b32 v225, a13
    v_accvgpr_read_b32 v226, a14
    v_accvgpr_read_b32 v227, a15
    v_mul_f32 v224, v224, v55
    v_mul_f32 v225, v225, v55
    v_mul_f32 v226, v226, v55
    v_mul_f32 v227, v227, v55
    v_accvgpr_write_b32 a12, v224
    v_accvgpr_write_b32 a13, v225
    v_accvgpr_write_b32 a14, v226
    v_accvgpr_write_b32 a15, v227
    v_accvgpr_read_b32 v224, a24
    v_accvgpr_read_b32 v225, a25
    v_accvgpr_read_b32 v226, a26
    v_accvgpr_read_b32 v227, a27
    v_mul_f32 v224, v224, v54
    v_mul_f32 v225, v225, v54
    v_mul_f32 v226, v226, v54
    v_mul_f32 v227, v227, v54
    v_accvgpr_write_b32 a24, v224
    v_accvgpr_write_b32 a25, v225
    v_accvgpr_write_b32 a26, v226
    v_accvgpr_write_b32 a27, v227
    v_accvgpr_read_b32 v224, a28
    v_accvgpr_read_b32 v225, a29
    v_accvgpr_read_b32 v226, a30
    v_accvgpr_read_b32 v227, a31
    v_mul_f32 v224, v224, v55
    v_mul_f32 v225, v225, v55
    v_mul_f32 v226, v226, v55
    v_mul_f32 v227, v227, v55
    v_accvgpr_write_b32 a28, v224
    v_accvgpr_write_b32 a29, v225
    v_accvgpr_write_b32 a30, v226
    v_accvgpr_write_b32 a31, v227
    v_accvgpr_read_b32 v224, a40
    v_accvgpr_read_b32 v225, a41
    v_accvgpr_read_b32 v226, a42
    v_accvgpr_read_b32 v227, a43
    v_mul_f32 v224, v224, v54
    v_mul_f32 v225, v225, v54
    v_mul_f32 v226, v226, v54
    v_mul_f32 v227, v227, v54
    v_accvgpr_write_b32 a40, v224
    v_accvgpr_write_b32 a41, v225
    v_accvgpr_write_b32 a42, v226
    v_accvgpr_write_b32 a43, v227
    v_accvgpr_read_b32 v224, a44
    v_accvgpr_read_b32 v225, a45
    v_accvgpr_read_b32 v226, a46
    v_accvgpr_read_b32 v227, a47
    v_mul_f32 v224, v224, v55
    v_mul_f32 v225, v225, v55
    v_mul_f32 v226, v226, v55
    v_mul_f32 v227, v227, v55
    v_accvgpr_write_b32 a44, v224
    v_accvgpr_write_b32 a45, v225
    v_accvgpr_write_b32 a46, v226
    v_accvgpr_write_b32 a47, v227
    v_accvgpr_read_b32 v224, a56
    v_accvgpr_read_b32 v225, a57
    v_accvgpr_read_b32 v226, a58
    v_accvgpr_read_b32 v227, a59
    v_mul_f32 v224, v224, v54
    v_mul_f32 v225, v225, v54
    v_mul_f32 v226, v226, v54
    v_mul_f32 v227, v227, v54
    v_accvgpr_write_b32 a56, v224
    v_accvgpr_write_b32 a57, v225
    v_accvgpr_write_b32 a58, v226
    v_accvgpr_write_b32 a59, v227
    v_accvgpr_read_b32 v224, a60
    v_accvgpr_read_b32 v225, a61
    v_accvgpr_read_b32 v226, a62
    v_accvgpr_read_b32 v227, a63
    v_mul_f32 v224, v224, v55
    v_mul_f32 v225, v225, v55
    v_mul_f32 v226, v226, v55
    v_mul_f32 v227, v227, v55
    v_accvgpr_write_b32 a60, v224
    v_accvgpr_write_b32 a61, v225
    v_accvgpr_write_b32 a62, v226
    v_accvgpr_write_b32 a63, v227
    v_accvgpr_read_b32 v224, a72
    v_accvgpr_read_b32 v225, a73
    v_accvgpr_read_b32 v226, a74
    v_accvgpr_read_b32 v227, a75
    v_mul_f32 v224, v224, v54
    v_mul_f32 v225, v225, v54
    v_mul_f32 v226, v226, v54
    v_mul_f32 v227, v227, v54
    v_accvgpr_write_b32 a72, v224
    v_accvgpr_write_b32 a73, v225
    v_accvgpr_write_b32 a74, v226
    v_accvgpr_write_b32 a75, v227
    v_accvgpr_read_b32 v224, a76
    v_accvgpr_read_b32 v225, a77
    v_accvgpr_read_b32 v226, a78
    v_accvgpr_read_b32 v227, a79
    v_mul_f32 v224, v224, v55
    v_mul_f32 v225, v225, v55
    v_mul_f32 v226, v226, v55
    v_mul_f32 v227, v227, v55
    v_accvgpr_write_b32 a76, v224
    v_accvgpr_write_b32 a77, v225
    v_accvgpr_write_b32 a78, v226
    v_accvgpr_write_b32 a79, v227
    v_accvgpr_read_b32 v224, a88
    v_accvgpr_read_b32 v225, a89
    v_accvgpr_read_b32 v226, a90
    v_accvgpr_read_b32 v227, a91
    v_mul_f32 v224, v224, v54
    v_mul_f32 v225, v225, v54
    v_mul_f32 v226, v226, v54
    v_mul_f32 v227, v227, v54
    v_accvgpr_write_b32 a88, v224
    v_accvgpr_write_b32 a89, v225
    v_accvgpr_write_b32 a90, v226
    v_accvgpr_write_b32 a91, v227
    v_accvgpr_read_b32 v224, a92
    v_accvgpr_read_b32 v225, a93
    v_accvgpr_read_b32 v226, a94
    v_accvgpr_read_b32 v227, a95
    v_mul_f32 v224, v224, v55
    v_mul_f32 v225, v225, v55
    v_mul_f32 v226, v226, v55
    v_mul_f32 v227, v227, v55
    v_accvgpr_write_b32 a92, v224
    v_accvgpr_write_b32 a93, v225
    v_accvgpr_write_b32 a94, v226
    v_accvgpr_write_b32 a95, v227
    v_accvgpr_read_b32 v224, a104
    v_accvgpr_read_b32 v225, a105
    v_accvgpr_read_b32 v226, a106
    v_accvgpr_read_b32 v227, a107
    v_mul_f32 v224, v224, v54
    v_mul_f32 v225, v225, v54
    v_mul_f32 v226, v226, v54
    v_mul_f32 v227, v227, v54
    v_accvgpr_write_b32 a104, v224
    v_accvgpr_write_b32 a105, v225
    v_accvgpr_write_b32 a106, v226
    v_accvgpr_write_b32 a107, v227
    v_accvgpr_read_b32 v224, a108
    v_accvgpr_read_b32 v225, a109
    v_accvgpr_read_b32 v226, a110
    v_accvgpr_read_b32 v227, a111
    v_mul_f32 v224, v224, v55
    v_mul_f32 v225, v225, v55
    v_mul_f32 v226, v226, v55
    v_mul_f32 v227, v227, v55
    v_accvgpr_write_b32 a108, v224
    v_accvgpr_write_b32 a109, v225
    v_accvgpr_write_b32 a110, v226
    v_accvgpr_write_b32 a111, v227
    v_accvgpr_read_b32 v224, a120
    v_accvgpr_read_b32 v225, a121
    v_accvgpr_read_b32 v226, a122
    v_accvgpr_read_b32 v227, a123
    v_mul_f32 v224, v224, v54
    v_mul_f32 v225, v225, v54
    v_mul_f32 v226, v226, v54
    v_mul_f32 v227, v227, v54
    v_accvgpr_write_b32 a120, v224
    v_accvgpr_write_b32 a121, v225
    v_accvgpr_write_b32 a122, v226
    v_accvgpr_write_b32 a123, v227
    v_accvgpr_read_b32 v224, a124
    v_accvgpr_read_b32 v225, a125
    v_accvgpr_read_b32 v226, a126
    v_accvgpr_read_b32 v227, a127
    v_mul_f32 v224, v224, v55
    v_mul_f32 v225, v225, v55
    v_mul_f32 v226, v226, v55
    v_mul_f32 v227, v227, v55
    v_accvgpr_write_b32 a124, v224
    v_accvgpr_write_b32 a125, v225
    v_accvgpr_write_b32 a126, v226
    v_accvgpr_write_b32 a127, v227
    v_exp_f32 v232, v160
    v_exp_f32 v233, v161
    v_exp_f32 v234, v162
    v_exp_f32 v235, v163
    s_nop 0
    v_cvt_pk_bf16_f32 v208, v232, v233
    v_cvt_pk_bf16_f32 v209, v234, v235
    v_exp_f32 v232, v176
    v_exp_f32 v233, v177
    v_exp_f32 v234, v178
    v_exp_f32 v235, v179
    s_nop 0
    v_cvt_pk_bf16_f32 v210, v232, v233
    v_cvt_pk_bf16_f32 v211, v234, v235
    v_exp_f32 v232, v164
    v_exp_f32 v233, v165
    v_exp_f32 v234, v166
    v_exp_f32 v235, v167
    s_nop 0
    v_cvt_pk_bf16_f32 v212, v232, v233
    v_cvt_pk_bf16_f32 v213, v234, v235
    v_exp_f32 v232, v180
    v_exp_f32 v233, v181
    v_exp_f32 v234, v182
    v_exp_f32 v235, v183
    s_nop 0
    v_cvt_pk_bf16_f32 v214, v232, v233
    v_cvt_pk_bf16_f32 v215, v234, v235
    v_exp_f32 v232, v168
    v_exp_f32 v233, v169
    v_exp_f32 v234, v170
    v_exp_f32 v235, v171
    s_nop 0
    v_cvt_pk_bf16_f32 v216, v232, v233
    v_cvt_pk_bf16_f32 v217, v234, v235
    v_exp_f32 v232, v184
    v_exp_f32 v233, v185
    v_exp_f32 v234, v186
    v_exp_f32 v235, v187
    s_nop 0
    v_cvt_pk_bf16_f32 v218, v232, v233
    v_cvt_pk_bf16_f32 v219, v234, v235
    v_exp_f32 v232, v172
    v_exp_f32 v233, v173
    v_exp_f32 v234, v174
    v_exp_f32 v235, v175
    s_nop 0
    v_cvt_pk_bf16_f32 v220, v232, v233
    v_cvt_pk_bf16_f32 v221, v234, v235
    v_exp_f32 v232, v188
    v_exp_f32 v233, v189
    v_exp_f32 v234, v190
    v_exp_f32 v235, v191
    s_nop 0
    v_cvt_pk_bf16_f32 v222, v232, v233
    v_cvt_pk_bf16_f32 v223, v234, v235
    s_nop 3
    s_setpc_b64 s[40:41]
k2_rare_171:
    s_nop 7
    v_max_f32 v55, v164, v165
    v_max3_f32 v55, v55, v166, v167
    v_max3_f32 v55, v55, v180, v181
    v_max3_f32 v55, v55, v182, v183
    v_max3_f32 v55, v55, v172, v173
    v_max3_f32 v55, v55, v174, v175
    v_max3_f32 v55, v55, v188, v189
    v_max3_f32 v55, v55, v190, v191
    v_mov_b32 v227, v55
    s_nop 1
    v_permlane16_swap_b32 v55, v227
    s_nop 1
    v_max_f32 v55, v55, v227
    v_mov_b32 v227, v55
    s_nop 1
    v_permlane32_swap_b32 v55, v227
    s_nop 1
    v_max_f32 v55, v55, v227
    v_add_f32 v55, 0x41400000, v55
    v_max_f32 v55, 0, v55
    v_sub_f32 v164, v164, v55
    v_sub_f32 v165, v165, v55
    v_sub_f32 v166, v166, v55
    v_sub_f32 v167, v167, v55
    v_sub_f32 v172, v172, v55
    v_sub_f32 v173, v173, v55
    v_sub_f32 v174, v174, v55
    v_sub_f32 v175, v175, v55
    v_sub_f32 v180, v180, v55
    v_sub_f32 v181, v181, v55
    v_sub_f32 v182, v182, v55
    v_sub_f32 v183, v183, v55
    v_sub_f32 v188, v188, v55
    v_sub_f32 v189, v189, v55
    v_sub_f32 v190, v190, v55
    v_sub_f32 v191, v191, v55
    v_sub_f32 v11, v11, v55
    v_exp_f32 v55, -v55
    s_nop 0
    v_mul_f32 v252, v252, v55
    v_accvgpr_read_b32 v224, a12
    v_accvgpr_read_b32 v225, a13
    v_accvgpr_read_b32 v226, a14
    v_accvgpr_read_b32 v227, a15
    v_mul_f32 v224, v224, v55
    v_mul_f32 v225, v225, v55
    v_mul_f32 v226, v226, v55
    v_mul_f32 v227, v227, v55
    v_accvgpr_write_b32 a12, v224
    v_accvgpr_write_b32 a13, v225
    v_accvgpr_write_b32 a14, v226
    v_accvgpr_write_b32 a15, v227
    v_accvgpr_read_b32 v224, a28
    v_accvgpr_read_b32 v225, a29
    v_accvgpr_read_b32 v226, a30
    v_accvgpr_read_b32 v227, a31
    v_mul_f32 v224, v224, v55
    v_mul_f32 v225, v225, v55
    v_mul_f32 v226, v226, v55
    v_mul_f32 v227, v227, v55
    v_accvgpr_write_b32 a28, v224
    v_accvgpr_write_b32 a29, v225
    v_accvgpr_write_b32 a30, v226
    v_accvgpr_write_b32 a31, v227
    v_accvgpr_read_b32 v224, a44
    v_accvgpr_read_b32 v225, a45
    v_accvgpr_read_b32 v226, a46
    v_accvgpr_read_b32 v227, a47
    v_mul_f32 v224, v224, v55
    v_mul_f32 v225, v225, v55
    v_mul_f32 v226, v226, v55
    v_mul_f32 v227, v227, v55
    v_accvgpr_write_b32 a44, v224
    v_accvgpr_write_b32 a45, v225
    v_accvgpr_write_b32 a46, v226
    v_accvgpr_write_b32 a47, v227
    v_accvgpr_read_b32 v224, a60
    v_accvgpr_read_b32 v225, a61
    v_accvgpr_read_b32 v226, a62
    v_accvgpr_read_b32 v227, a63
    v_mul_f32 v224, v224, v55
    v_mul_f32 v225, v225, v55
    v_mul_f32 v226, v226, v55
    v_mul_f32 v227, v227, v55
    v_accvgpr_write_b32 a60, v224
    v_accvgpr_write_b32 a61, v225
    v_accvgpr_write_b32 a62, v226
    v_accvgpr_write_b32 a63, v227
    v_accvgpr_read_b32 v224, a76
    v_accvgpr_read_b32 v225, a77
    v_accvgpr_read_b32 v226, a78
    v_accvgpr_read_b32 v227, a79
    v_mul_f32 v224, v224, v55
    v_mul_f32 v225, v225, v55
    v_mul_f32 v226, v226, v55
    v_mul_f32 v227, v227, v55
    v_accvgpr_write_b32 a76, v224
    v_accvgpr_write_b32 a77, v225
    v_accvgpr_write_b32 a78, v226
    v_accvgpr_write_b32 a79, v227
    v_accvgpr_read_b32 v224, a92
    v_accvgpr_read_b32 v225, a93
    v_accvgpr_read_b32 v226, a94
    v_accvgpr_read_b32 v227, a95
    v_mul_f32 v224, v224, v55
    v_mul_f32 v225, v225, v55
    v_mul_f32 v226, v226, v55
    v_mul_f32 v227, v227, v55
    v_accvgpr_write_b32 a92, v224
    v_accvgpr_write_b32 a93, v225
    v_accvgpr_write_b32 a94, v226
    v_accvgpr_write_b32 a95, v227
    v_accvgpr_read_b32 v224, a108
    v_accvgpr_read_b32 v225, a109
    v_accvgpr_read_b32 v226, a110
    v_accvgpr_read_b32 v227, a111
    v_mul_f32 v224, v224, v55
    v_mul_f32 v225, v225, v55
    v_mul_f32 v226, v226, v55
    v_mul_f32 v227, v227, v55
    v_accvgpr_write_b32 a108, v224
    v_accvgpr_write_b32 a109, v225
    v_accvgpr_write_b32 a110, v226
    v_accvgpr_write_b32 a111, v227
    v_accvgpr_read_b32 v224, a124
    v_accvgpr_read_b32 v225, a125
    v_accvgpr_read_b32 v226, a126
    v_accvgpr_read_b32 v227, a127
    v_mul_f32 v224, v224, v55
    v_mul_f32 v225, v225, v55
    v_mul_f32 v226, v226, v55
    v_mul_f32 v227, v227, v55
    v_accvgpr_write_b32 a124, v224
    v_accvgpr_write_b32 a125, v225
    v_accvgpr_write_b32 a126, v226
    v_accvgpr_write_b32 a127, v227
    v_exp_f32 v232, v164
    v_exp_f32 v233, v165
    v_exp_f32 v234, v166
    v_exp_f32 v235, v167
    s_nop 0
    v_cvt_pk_bf16_f32 v212, v232, v233
    v_cvt_pk_bf16_f32 v213, v234, v235
    v_exp_f32 v232, v180
    v_exp_f32 v233, v181
    v_exp_f32 v234, v182
    v_exp_f32 v235, v183
    s_nop 0
    v_cvt_pk_bf16_f32 v214, v232, v233
    v_cvt_pk_bf16_f32 v215, v234, v235
    v_exp_f32 v232, v172
    v_exp_f32 v233, v173
    v_exp_f32 v234, v174
    v_exp_f32 v235, v175
    s_nop 0
    v_cvt_pk_bf16_f32 v220, v232, v233
    v_cvt_pk_bf16_f32 v221, v234, v235
    v_exp_f32 v232, v188
    v_exp_f32 v233, v189
    v_exp_f32 v234, v190
    v_exp_f32 v235, v191
    s_nop 0
    v_cvt_pk_bf16_f32 v222, v232, v233
    v_cvt_pk_bf16_f32 v223, v234, v235
    s_nop 3
    s_setpc_b64 s[40:41]
code_end:
    s_endpgm
.section .rodata,"a"
.p2align 6
.amdhsa_kernel sequential_preLN__compressed_kv_cla__moe_arch_mod__prompt_kernel
  .amdhsa_next_free_vgpr 512
  .amdhsa_next_free_sgpr 102
  .amdhsa_accum_offset 256
  .amdhsa_group_segment_fixed_size 0
  .amdhsa_kernarg_size 112
  .amdhsa_user_sgpr_count 2
  .amdhsa_user_sgpr_kernarg_segment_ptr 1
  .amdhsa_system_sgpr_workgroup_id_x 1
.end_amdhsa_kernel
```

```asm
; @launch grid=(256,1,1) block=(256,1,1) lds=163840
.amdgcn_target "amdgcn-amd-amdhsa--gfx950"
.text
.globl sequential_preLN__compressed_kv_cla__moe_arch_mod__prompt_kernel
.p2align 8
.type sequential_preLN__compressed_kv_cla__moe_arch_mod__prompt_kernel,@function
sequential_preLN__compressed_kv_cla__moe_arch_mod__prompt_kernel:
    s_cmp_ge_u32 s2, 256
    s_cbranch_scc1 k12_end_1
    s_load_dwordx4 s[36:39], s[0:1], 0
    s_load_dwordx4 s[40:43], s[0:1], 24
    s_load_dwordx2 s[4:5], s[0:1], 16
    s_load_dwordx4 s[60:63], s[0:1], 96
    s_lshr_b32 s59, s2, 3
    s_lshl_b32 s58, s59, 4
    v_add_u32 v6, s58, v0
    v_cmp_gt_u32 vcc, 48, v0
    v_cmp_gt_u32 s[56:57], 64, v0
    s_nop 0
    v_cndmask_b32 v6, v6, v0, vcc
    s_getpc_b64 s[52:53]
pc_2:
    s_add_u32 s52, s52, k12_code0-pc_2
    s_addc_u32 s53, s53, 0
    v_lshlrev_b32 v58, 7, v6
    v_mov_b32 v59, s53
    v_add_co_u32 v58, vcc, s52, v58
    s_nop 1
    v_addc_co_u32 v59, vcc, 0, v59, vcc
k12_code0:
    s_mov_b64 exec, s[56:57]
    s_cbranch_execz k12_nocode_3
    global_load_dword v51, v[58:59], off
k12_nocode_3:
    s_mov_b64 exec, -1
    s_and_b32 s58, s2, 7
    s_lshr_b32 s59, s2, 3
    s_and_b32 s45, s59, 7
    s_lshr_b32 s57, s59, 3
    s_and_b32 s44, s57, 1
    s_lshl_b32 s52, s58, 1
    s_add_u32 s44, s44, s52
    s_lshr_b32 s57, s57, 1
    v_lshrrev_b32 v2, 6, v0
    v_and_b32 v3, 63, v0
    v_readfirstlane_b32 s30, v2
    v_lshlrev_b32 v1, 4, v3
    v_lshrrev_b32 v60, 5, v3
    v_lshl_add_u32 v60, v2, 1, v60
    v_and_b32 v61, 31, v3
    v_lshlrev_b32 v6, 11, v60
    v_lshl_add_u32 v62, v61, 4, v6
    s_lshl_b32 s52, s2, 14
    v_lshrrev_b32 v56, 3, v3
    v_and_b32 v57, 7, v3
    v_lshrrev_b32 v58, 1, v56
    v_xor_b32 v6, v57, v58
    v_xor_b32 v7, 4, v6
    v_lshl_add_u32 v58, v2, 6, v56
    v_lshlrev_b32 v58, 10, v58
    s_lshl_b32 s47, s45, 18
    v_add_u32 v58, s47, v58
    v_lshl_add_u32 v10, v6, 4, v58
    v_lshl_add_u32 v11, v7, 4, v58
    v_add_u32 v17, 54272, v11
    v_add_u32 v16, 47104, v10
    v_add_u32 v15, 39936, v11
    v_add_u32 v14, 32768, v10
    v_add_u32 v13, 21504, v11
    v_add_u32 v12, 14336, v10
    v_add_u32 v11, 7168, v11
    v_add_u32 v10, 0, v10
    v_lshrrev_b32 v6, 5, v3
    v_bfe_u32 v7, v3, 1, 4
    v_and_b32 v59, 1, v3
    v_lshl_add_u32 v58, v2, 4, v6
    v_lshlrev_b32 v58, 13, v58
    v_lshl_add_u32 v58, v59, 4, v58
    s_lshl_b32 s47, s44, 9
    v_add_u32 v58, s47, v58
    v_xor_b32 v7, v7, v6
    v_xor_b32 v6, 0, v7
    v_lshl_add_u32 v6, v6, 5, v58
    v_add_u32 v18, 0, v6
    v_xor_b32 v6, 2, v7
    v_lshl_add_u32 v6, v6, 5, v58
    v_add_u32 v19, 15360, v6
    v_xor_b32 v6, 0, v7
    v_lshl_add_u32 v6, v6, 5, v58
    v_add_u32 v20, 30720, v6
    v_xor_b32 v6, 2, v7
    v_lshl_add_u32 v6, v6, 5, v58
    v_add_u32 v21, 46080, v6
    v_xor_b32 v6, 4, v7
    v_lshl_add_u32 v6, v6, 5, v58
    v_add_u32 v22, 65536, v6
    v_xor_b32 v6, 6, v7
    v_lshl_add_u32 v6, v6, 5, v58
    v_add_u32 v23, 80896, v6
    v_xor_b32 v6, 4, v7
    v_lshl_add_u32 v6, v6, 5, v58
    v_add_u32 v24, 96256, v6
    v_xor_b32 v6, 6, v7
    v_lshl_add_u32 v6, v6, 5, v58
    v_add_u32 v25, 111616, v6
    s_lshl_b32 s48, s30, 13
    s_mov_b32 s49, 0
    s_mov_b32 s50, 0
    s_waitcnt lgkmcnt(0)
    s_mov_b32 s24, s36
    s_and_b32 s25, s37, 0xffff
    s_mov_b32 s26, 0x400000
    s_mov_b32 s27, 0x00020000
    s_mov_b32 s16, s38
    s_and_b32 s17, s39, 0xffff
    s_mov_b32 s18, 0x200000
    s_mov_b32 s19, 0x00020000
    s_cmp_eq_u32 s57, 0
    s_cselect_b32 s20, s40, s42
    s_cselect_b32 s21, s41, s43
    s_and_b32 s21, s21, 0xffff
    s_mov_b32 s22, 0x400000
    s_mov_b32 s23, 0x00020000
    v_lshlrev_b32 v6, 17, v1
    s_mov_b64 exec, 1
    buffer_load_dword v51, v62, s[24:27], s52 offen
    global_load_dword v51, v6, s[60:61]
    buffer_load_dword v51, v6, s[20:23], 0 offen
    global_load_dword v51, v6, s[62:63]
    global_load_dword v51, v6, s[4:5]
    s_mov_b64 exec, -1
    s_add_u32 m0, s48, 0
    s_nop 0
    buffer_load_dwordx4 v10, s[16:19], s49 offen offset:0 lds
    buffer_load_dwordx4 v11, s[16:19], s49 offen offset:1024 lds
    buffer_load_dwordx4 v12, s[16:19], s49 offen offset:2048 lds
    buffer_load_dwordx4 v13, s[16:19], s49 offen offset:3072 lds
    buffer_load_dwordx4 v[64:67], v62, s[24:27], s52 offen offset:0
    buffer_load_dwordx4 v[68:71], v62, s[24:27], s52 offen offset:512
    buffer_load_dwordx4 v[72:75], v62, s[24:27], s52 offen offset:1024
    buffer_load_dwordx4 v[76:79], v62, s[24:27], s52 offen offset:1536
    s_add_u32 m0, s48, 65536
    s_nop 0
    buffer_load_dwordx4 v18, s[20:23], s50 offen offset:0 lds
    buffer_load_dwordx4 v19, s[20:23], s50 offen offset:1024 lds
    buffer_load_dwordx4 v20, s[20:23], s50 offen offset:2048 lds
    buffer_load_dwordx4 v21, s[20:23], s50 offen offset:3072 lds
    s_mov_b64 s[6:7], s[62:63]
    s_add_u32 s8, s6, 0x0
    s_addc_u32 s9, s7, 0
    s_and_b32 s9, s9, 0xffff
    s_mov_b32 s10, 0x400000
    s_mov_b32 s11, 0x00020000
    s_mov_b32 s12, s4
    s_and_b32 s13, s5, 0xffff
    s_mov_b32 s14, 0x800000
    s_mov_b32 s15, 0x00020000
    s_add_u32 s32, s6, 0x1000000
    s_addc_u32 s33, s7, 0
    s_and_b32 s33, s33, 0xffff
    s_mov_b32 s34, 0x2000000
    s_mov_b32 s35, 0x00020000
    s_mov_b32 s24, s60
    s_and_b32 s25, s61, 0xffff
    s_mov_b32 s26, 0x100
    s_mov_b32 s27, 0x00020000
    s_lshl_b32 s28, s58, 2
    s_and_b32 s31, s59, 3
    s_add_u32 s28, s28, s31
    s_lshr_b32 s29, s59, 2
    s_lshl_b32 s42, s29, 7
    s_sub_u32 s43, 1920, s42
    s_lshl_b32 s31, s30, 4
    s_add_u32 s38, s42, s31
    s_add_u32 s39, s43, s31
    s_lshl_b32 s60, s30, 12
    s_mov_b32 s61, 0
    s_mov_b32 s62, 0
    s_lshl_b32 s47, s44, 1
    s_lshr_b32 s52, s30, 1
    s_add_u32 s47, s47, s52
    s_lshl_b32 s47, s47, 14
    s_lshl_b32 s52, s45, 1
    s_and_b32 s53, s30, 1
    s_add_u32 s52, s52, s53
    s_lshl_b32 s52, s52, 20
    s_add_u32 s47, s47, s52
    s_lshl_b32 s52, s57, 24
    s_add_u32 s47, s47, s52
    s_lshl_b32 s54, s44, 8
    s_lshr_b32 s55, s28, 1
    s_lshl_b32 s55, s55, 8
    s_and_b32 s53, s59, 3
    s_add_u32 s53, s53, 1
    s_cmp_eq_u32 s30, 0
    s_cselect_b32 s53, s53, -1
    s_cselect_b32 s46, 6, -1
    v_lshlrev_b32 v6, 13, v56
    v_lshl_add_u32 v50, v57, 7, v6
    s_lshl_b32 s56, s30, 5
    s_add_u32 s56, s56, s59
    s_lshl_b32 s56, s56, 16
    s_lshl_b32 s52, s58, 10
    s_add_u32 s56, s56, s52
    s_add_u32 s63, s30, 1
    v_mul_u32_u24 v6, 2064, v60
    v_lshl_add_u32 v6, v61, 4, v6
    v_add_u32 v54, 131072, v6
    v_mul_u32_u24 v7, 2064, v57
    v_lshl_add_u32 v7, v56, 4, v7
    v_lshl_add_u32 v7, v2, 9, v7
    v_add_u32 v55, 131072, v7
    v_lshrrev_b32 v7, 2, v56
    v_lshl_add_u32 v7, v2, 3, v7
    v_lshlrev_b32 v7, 17, v7
    v_and_b32 v6, 3, v56
    v_lshl_add_u32 v7, v6, 8, v7
    v_lshl_add_u32 v7, v57, 4, v7
    s_lshr_b32 s52, s2, 1
    s_lshl_b32 s52, s52, 10
    s_and_b32 s31, s2, 1
    s_lshl_b32 s31, s31, 7
    s_add_u32 s52, s52, s31
    v_add_u32 v53, s52, v7
    v_and_b32 v56, 15, v3
    v_lshrrev_b32 v57, 4, v3
    v_lshrrev_b32 v6, 1, v56
    v_xor_b32 v6, v6, v57
    v_and_b32 v7, 1, v2
    v_lshl_add_u32 v7, v7, 7, v56
    v_lshlrev_b32 v7, 7, v7
    v_lshl_add_u32 v26, v6, 4, v7
    v_xor_b32 v27, 64, v26
    v_lshrrev_b32 v6, 2, v56
    v_and_b32 v58, 1, v57
    v_lshl_add_u32 v58, v58, 2, v6
    v_lshl_add_u32 v59, v57, 3, v6
    v_and_b32 v63, 3, v3
    v_lshlrev_b32 v7, 9, v59
    v_lshrrev_b32 v6, 1, v2
    v_lshl_add_u32 v7, v6, 8, v7
    v_lshl_add_u32 v7, v63, 3, v7
    v_add_u32 v7, 65536, v7
    v_lshlrev_b32 v59, 8, v59
    v_lshl_add_u32 v59, v63, 3, v59
    v_add_u32 v59, 98304, v59
    v_xor_b32 v6, 0, v58
    v_lshl_add_u32 v28, v6, 5, v7
    v_lshl_add_u32 v42, v6, 5, v59
    v_xor_b32 v6, 1, v58
    v_lshl_add_u32 v29, v6, 5, v7
    v_lshl_add_u32 v43, v6, 5, v59
    v_xor_b32 v6, 2, v58
    v_lshl_add_u32 v30, v6, 5, v7
    v_lshl_add_u32 v44, v6, 5, v59
    v_xor_b32 v6, 3, v58
    v_lshl_add_u32 v31, v6, 5, v7
    v_lshl_add_u32 v45, v6, 5, v59
    v_xor_b32 v6, 4, v58
    v_lshl_add_u32 v32, v6, 5, v7
    v_lshl_add_u32 v46, v6, 5, v59
    v_xor_b32 v6, 5, v58
    v_lshl_add_u32 v33, v6, 5, v7
    v_lshl_add_u32 v47, v6, 5, v59
    v_xor_b32 v6, 6, v58
    v_lshl_add_u32 v34, v6, 5, v7
    v_lshl_add_u32 v48, v6, 5, v59
    v_xor_b32 v6, 7, v58
    v_lshl_add_u32 v35, v6, 5, v7
    v_lshl_add_u32 v49, v6, 5, v59
    s_lshl_b32 s31, s38, 6
    v_add_u32 v36, s31, v1
    s_lshl_b32 s31, s39, 6
    v_add_u32 v37, s31, v1
    v_bfe_u32 v6, v3, 1, 3
    v_and_b32 v7, 1, v3
    v_lshl_add_u32 v58, v2, 4, v57
    v_lshlrev_b32 v58, 13, v58
    v_lshl_add_u32 v58, v7, 4, v58
    s_lshl_b32 s31, s28, 8
    v_add_u32 v58, s31, v58
    v_xor_b32 v6, v6, v57
    v_xor_b32 v7, 0, v6
    v_lshl_add_u32 v7, v7, 5, v58
    v_add_u32 v38, 0, v7
    v_xor_b32 v7, 0, v6
    v_lshl_add_u32 v7, v7, 5, v58
    v_add_u32 v39, 31744, v7
    v_xor_b32 v7, 4, v6
    v_lshl_add_u32 v7, v7, 5, v58
    v_add_u32 v40, 63488, v7
    v_xor_b32 v7, 4, v6
    v_lshl_add_u32 v7, v7, 5, v58
    v_add_u32 v41, 95232, v7
    v_lshlrev_b32 v6, 2, v57
    v_sub_u32 v4, v56, v6
    v_mov_b32 v5, 0xff800000
    v_mov_b32 v8, 0
    v_mov_b32 v9, 1
    s_lshl_b32 s52, s59, 2
    s_add_u32 s52, s52, s30
    v_and_b32 v6, 1, v3
    v_lshl_add_u32 v6, s52, 1, v6
    s_getpc_b64 s[40:41]
pc_4:
    s_add_u32 s40, s40, k12_qcode-pc_4
    s_addc_u32 s41, s41, 0
    v_lshlrev_b32 v2, 7, v6
    v_mov_b32 v3, s41
    v_add_co_u32 v2, vcc, s40, v2
    s_nop 1
    v_addc_co_u32 v3, vcc, 0, v3, vcc
    v_mov_b32 v56, 0
    v_mov_b32 v57, 0
    v_mov_b32 v58, 0
    v_mov_b32 v59, 0
    s_nop 1
    v_mfma_f32_32x32x16_bf16 a[128:143], v[56:59], v[56:59], 0
    v_mfma_f32_32x32x16_bf16 a[144:159], v[56:59], v[56:59], 0
    v_mfma_f32_32x32x16_bf16 a[160:175], v[56:59], v[56:59], 0
    v_mfma_f32_32x32x16_bf16 a[176:191], v[56:59], v[56:59], 0
    v_mfma_f32_32x32x16_bf16 v[128:143], v[56:59], v[56:59], 0
    v_mfma_f32_32x32x16_bf16 v[144:159], v[56:59], v[56:59], 0
    v_mfma_f32_32x32x16_bf16 v[160:175], v[56:59], v[56:59], 0
    v_mfma_f32_32x32x16_bf16 v[176:191], v[56:59], v[56:59], 0
    v_mfma_f32_32x32x16_bf16 v[192:207], v[56:59], v[56:59], 0
    v_mfma_f32_32x32x16_bf16 v[208:223], v[56:59], v[56:59], 0
    v_mfma_f32_32x32x16_bf16 v[224:239], v[56:59], v[56:59], 0
    v_mfma_f32_32x32x16_bf16 v[240:255], v[56:59], v[56:59], 0
    s_add_u32 m0, s48, 4096
    s_nop 0
    buffer_load_dwordx4 v14, s[16:19], s49 offen offset:0 lds
    buffer_load_dwordx4 v15, s[16:19], s49 offen offset:1024 lds
    buffer_load_dwordx4 v16, s[16:19], s49 offen offset:2048 lds
    buffer_load_dwordx4 v17, s[16:19], s49 offen offset:3072 lds
    s_add_u32 s49, s49, 128
    s_add_u32 m0, s48, 69632
    s_nop 0
    buffer_load_dwordx4 v22, s[20:23], s50 offen offset:0 lds
    buffer_load_dwordx4 v23, s[20:23], s50 offen offset:1024 lds
    buffer_load_dwordx4 v24, s[20:23], s50 offen offset:2048 lds
    buffer_load_dwordx4 v25, s[20:23], s50 offen offset:3072 lds
    s_add_u32 s50, s50, 0x80000
    s_waitcnt vmcnt(12)
    v_lshlrev_b32 v80, 16, v64
    v_and_b32 v81, 0xffff0000, v64
    v_lshlrev_b32 v82, 16, v65
    v_and_b32 v83, 0xffff0000, v65
    v_lshlrev_b32 v84, 16, v66
    v_and_b32 v85, 0xffff0000, v66
    v_lshlrev_b32 v86, 16, v67
    v_and_b32 v87, 0xffff0000, v67
    v_lshlrev_b32 v88, 16, v68
    v_and_b32 v89, 0xffff0000, v68
    v_lshlrev_b32 v90, 16, v69
    v_and_b32 v91, 0xffff0000, v69
    v_lshlrev_b32 v92, 16, v70
    v_and_b32 v93, 0xffff0000, v70
    v_lshlrev_b32 v94, 16, v71
    v_and_b32 v95, 0xffff0000, v71
    v_lshlrev_b32 v96, 16, v72
    v_and_b32 v97, 0xffff0000, v72
    v_lshlrev_b32 v98, 16, v73
    v_and_b32 v99, 0xffff0000, v73
    v_lshlrev_b32 v100, 16, v74
    v_and_b32 v101, 0xffff0000, v74
    v_lshlrev_b32 v102, 16, v75
    v_and_b32 v103, 0xffff0000, v75
    v_lshlrev_b32 v104, 16, v76
    v_and_b32 v105, 0xffff0000, v76
    v_lshlrev_b32 v106, 16, v77
    v_and_b32 v107, 0xffff0000, v77
    v_lshlrev_b32 v108, 16, v78
    v_and_b32 v109, 0xffff0000, v78
    v_lshlrev_b32 v110, 16, v79
    v_and_b32 v111, 0xffff0000, v79
    v_pk_add_f32 v[112:113], v[80:81], v[82:83]
    v_pk_add_f32 v[114:115], v[84:85], v[86:87]
    v_pk_add_f32 v[112:113], v[112:113], v[88:89]
    v_pk_add_f32 v[114:115], v[114:115], v[90:91]
    v_pk_add_f32 v[112:113], v[112:113], v[92:93]
    v_pk_add_f32 v[114:115], v[114:115], v[94:95]
    v_pk_add_f32 v[112:113], v[112:113], v[96:97]
    v_pk_add_f32 v[114:115], v[114:115], v[98:99]
    v_pk_add_f32 v[112:113], v[112:113], v[100:101]
    v_pk_add_f32 v[114:115], v[114:115], v[102:103]
    v_pk_add_f32 v[112:113], v[112:113], v[104:105]
    v_pk_add_f32 v[114:115], v[114:115], v[106:107]
    s_add_u32 m0, s48, 32768
    s_nop 0
    buffer_load_dwordx4 v10, s[16:19], s49 offen offset:0 lds
    buffer_load_dwordx4 v11, s[16:19], s49 offen offset:1024 lds
    buffer_load_dwordx4 v12, s[16:19], s49 offen offset:2048 lds
    buffer_load_dwordx4 v13, s[16:19], s49 offen offset:3072 lds
    v_pk_add_f32 v[112:113], v[112:113], v[108:109]
    v_pk_add_f32 v[114:115], v[114:115], v[110:111]
    v_pk_add_f32 v[112:113], v[112:113], v[114:115]
    v_add_f32 v112, v112, v113
    s_nop 1
    v_add_f32_dpp v112, v112, v112 quad_perm:[1,0,3,2] row_mask:0xf bank_mask:0xf
    s_nop 1
    v_add_f32_dpp v112, v112, v112 quad_perm:[2,3,0,1] row_mask:0xf bank_mask:0xf
    s_nop 1
    v_add_f32_dpp v112, v112, v112 row_half_mirror row_mask:0xf bank_mask:0xf
    s_nop 1
    v_add_f32_dpp v112, v112, v112 row_mirror row_mask:0xf bank_mask:0xf
    v_mov_b32 v114, v112
    s_nop 1
    v_permlane16_swap_b32 v112, v114
    s_nop 1
    v_add_f32 v112, v112, v114
    v_mul_f32 v112, 0xba800000, v112
    v_mov_b32 v113, v112
    v_pk_add_f32 v[114:115], v[80:81], v[112:113]
    v_pk_add_f32 v[118:119], v[82:83], v[112:113]
    v_pk_mul_f32 v[116:117], v[114:115], v[114:115]
    v_pk_fma_f32 v[116:117], v[118:119], v[118:119], v[116:117]
    v_pk_add_f32 v[114:115], v[84:85], v[112:113]
    v_pk_add_f32 v[118:119], v[86:87], v[112:113]
    v_pk_fma_f32 v[116:117], v[114:115], v[114:115], v[116:117]
    v_pk_fma_f32 v[116:117], v[118:119], v[118:119], v[116:117]
    v_pk_add_f32 v[114:115], v[88:89], v[112:113]
    v_pk_add_f32 v[118:119], v[90:91], v[112:113]
    v_pk_fma_f32 v[116:117], v[114:115], v[114:115], v[116:117]
    v_pk_fma_f32 v[116:117], v[118:119], v[118:119], v[116:117]
    v_pk_add_f32 v[114:115], v[92:93], v[112:113]
    v_pk_add_f32 v[118:119], v[94:95], v[112:113]
    v_pk_fma_f32 v[116:117], v[114:115], v[114:115], v[116:117]
    v_pk_fma_f32 v[116:117], v[118:119], v[118:119], v[116:117]
    v_pk_add_f32 v[114:115], v[96:97], v[112:113]
    v_pk_add_f32 v[118:119], v[98:99], v[112:113]
    v_pk_fma_f32 v[116:117], v[114:115], v[114:115], v[116:117]
    v_pk_fma_f32 v[116:117], v[118:119], v[118:119], v[116:117]
    v_pk_add_f32 v[114:115], v[100:101], v[112:113]
    v_pk_add_f32 v[118:119], v[102:103], v[112:113]
    v_pk_fma_f32 v[116:117], v[114:115], v[114:115], v[116:117]
    v_pk_fma_f32 v[116:117], v[118:119], v[118:119], v[116:117]
    v_pk_add_f32 v[114:115], v[104:105], v[112:113]
    s_add_u32 m0, s48, 98304
    s_nop 0
    buffer_load_dwordx4 v18, s[20:23], s50 offen offset:0 lds
    buffer_load_dwordx4 v19, s[20:23], s50 offen offset:1024 lds
    buffer_load_dwordx4 v20, s[20:23], s50 offen offset:2048 lds
    buffer_load_dwordx4 v21, s[20:23], s50 offen offset:3072 lds
    v_pk_add_f32 v[118:119], v[106:107], v[112:113]
    v_pk_fma_f32 v[116:117], v[114:115], v[114:115], v[116:117]
    v_pk_fma_f32 v[116:117], v[118:119], v[118:119], v[116:117]
    v_pk_add_f32 v[114:115], v[108:109], v[112:113]
    v_pk_add_f32 v[118:119], v[110:111], v[112:113]
    v_pk_fma_f32 v[116:117], v[114:115], v[114:115], v[116:117]
    v_pk_fma_f32 v[116:117], v[118:119], v[118:119], v[116:117]
    v_add_f32 v116, v116, v117
    s_nop 1
    v_add_f32_dpp v116, v116, v116 quad_perm:[1,0,3,2] row_mask:0xf bank_mask:0xf
    s_nop 1
    v_add_f32_dpp v116, v116, v116 quad_perm:[2,3,0,1] row_mask:0xf bank_mask:0xf
    s_nop 1
    v_add_f32_dpp v116, v116, v116 row_half_mirror row_mask:0xf bank_mask:0xf
    s_nop 1
    v_add_f32_dpp v116, v116, v116 row_mirror row_mask:0xf bank_mask:0xf
    v_mov_b32 v114, v116
    s_nop 1
    v_permlane16_swap_b32 v116, v114
    s_nop 1
    v_add_f32 v116, v116, v114
    v_mul_f32 v116, 0x3a800000, v116
    v_cvt_pk_bf16_f32 v118, v112, v116
    v_and_b32 v116, 0xffff0000, v118
    v_lshlrev_b32 v118, 16, v118
    v_add_f32 v116, 0x3727c5ac, v116
    v_mov_b32 v119, v118
    v_cvt_pk_bf16_f32 v116, v116, v116
    v_and_b32 v116, 0xffff0000, v116
    v_sqrt_f32 v116, v116
    v_pk_add_f32 v[80:81], v[80:81], v[118:119]
    v_pk_add_f32 v[82:83], v[82:83], v[118:119]
    v_pk_add_f32 v[84:85], v[84:85], v[118:119]
    v_pk_add_f32 v[86:87], v[86:87], v[118:119]
    v_pk_add_f32 v[88:89], v[88:89], v[118:119]
    v_pk_add_f32 v[90:91], v[90:91], v[118:119]
    v_pk_add_f32 v[92:93], v[92:93], v[118:119]
    v_pk_add_f32 v[94:95], v[94:95], v[118:119]
    v_pk_add_f32 v[96:97], v[96:97], v[118:119]
    v_pk_add_f32 v[98:99], v[98:99], v[118:119]
    v_pk_add_f32 v[100:101], v[100:101], v[118:119]
    v_pk_add_f32 v[102:103], v[102:103], v[118:119]
    v_pk_add_f32 v[104:105], v[104:105], v[118:119]
    s_add_u32 m0, s48, 36864
    s_nop 0
    buffer_load_dwordx4 v14, s[16:19], s49 offen offset:0 lds
    buffer_load_dwordx4 v15, s[16:19], s49 offen offset:1024 lds
    buffer_load_dwordx4 v16, s[16:19], s49 offen offset:2048 lds
    buffer_load_dwordx4 v17, s[16:19], s49 offen offset:3072 lds
    s_add_u32 s49, s49, 128
    v_pk_add_f32 v[106:107], v[106:107], v[118:119]
    v_pk_add_f32 v[108:109], v[108:109], v[118:119]
    v_pk_add_f32 v[110:111], v[110:111], v[118:119]
    v_cvt_pk_bf16_f32 v116, v116, v116
    v_and_b32 v116, 0xffff0000, v116
    v_rcp_f32 v116, v116
    v_cvt_pk_bf16_f32 v64, v80, v81
    v_cvt_pk_bf16_f32 v65, v82, v83
    v_cvt_pk_bf16_f32 v66, v84, v85
    v_cvt_pk_bf16_f32 v67, v86, v87
    v_cvt_pk_bf16_f32 v68, v88, v89
    v_cvt_pk_bf16_f32 v69, v90, v91
    v_cvt_pk_bf16_f32 v70, v92, v93
    v_cvt_pk_bf16_f32 v71, v94, v95
    v_cvt_pk_bf16_f32 v72, v96, v97
    v_cvt_pk_bf16_f32 v73, v98, v99
    v_cvt_pk_bf16_f32 v74, v100, v101
    v_cvt_pk_bf16_f32 v75, v102, v103
    v_cvt_pk_bf16_f32 v76, v104, v105
    v_cvt_pk_bf16_f32 v77, v106, v107
    v_cvt_pk_bf16_f32 v78, v108, v109
    v_cvt_pk_bf16_f32 v79, v110, v111
    v_mov_b32 v117, v116
    v_lshlrev_b32 v80, 16, v64
    v_and_b32 v81, 0xffff0000, v64
    v_lshlrev_b32 v82, 16, v65
    v_and_b32 v83, 0xffff0000, v65
    v_lshlrev_b32 v84, 16, v66
    v_and_b32 v85, 0xffff0000, v66
    v_lshlrev_b32 v86, 16, v67
    v_and_b32 v87, 0xffff0000, v67
    v_lshlrev_b32 v88, 16, v68
    v_and_b32 v89, 0xffff0000, v68
    v_lshlrev_b32 v90, 16, v69
    v_and_b32 v91, 0xffff0000, v69
    v_lshlrev_b32 v92, 16, v70
    v_and_b32 v93, 0xffff0000, v70
    v_lshlrev_b32 v94, 16, v71
    v_and_b32 v95, 0xffff0000, v71
    v_lshlrev_b32 v96, 16, v72
    v_and_b32 v97, 0xffff0000, v72
    v_lshlrev_b32 v98, 16, v73
    v_and_b32 v99, 0xffff0000, v73
    v_lshlrev_b32 v100, 16, v74
    s_add_u32 m0, s48, 102400
    s_nop 0
    buffer_load_dwordx4 v22, s[20:23], s50 offen offset:0 lds
    buffer_load_dwordx4 v23, s[20:23], s50 offen offset:1024 lds
    buffer_load_dwordx4 v24, s[20:23], s50 offen offset:2048 lds
    buffer_load_dwordx4 v25, s[20:23], s50 offen offset:3072 lds
    s_add_u32 s50, s50, 0x80000
    v_and_b32 v101, 0xffff0000, v74
    v_lshlrev_b32 v102, 16, v75
    v_and_b32 v103, 0xffff0000, v75
    v_lshlrev_b32 v104, 16, v76
    v_and_b32 v105, 0xffff0000, v76
    v_lshlrev_b32 v106, 16, v77
    v_and_b32 v107, 0xffff0000, v77
    v_lshlrev_b32 v108, 16, v78
    v_and_b32 v109, 0xffff0000, v78
    v_lshlrev_b32 v110, 16, v79
    v_and_b32 v111, 0xffff0000, v79
    v_pk_mul_f32 v[80:81], v[80:81], v[116:117]
    v_pk_mul_f32 v[82:83], v[82:83], v[116:117]
    v_pk_mul_f32 v[84:85], v[84:85], v[116:117]
    v_pk_mul_f32 v[86:87], v[86:87], v[116:117]
    v_pk_mul_f32 v[88:89], v[88:89], v[116:117]
    v_pk_mul_f32 v[90:91], v[90:91], v[116:117]
    v_pk_mul_f32 v[92:93], v[92:93], v[116:117]
    v_pk_mul_f32 v[94:95], v[94:95], v[116:117]
    v_pk_mul_f32 v[96:97], v[96:97], v[116:117]
    v_pk_mul_f32 v[98:99], v[98:99], v[116:117]
    v_pk_mul_f32 v[100:101], v[100:101], v[116:117]
    v_pk_mul_f32 v[102:103], v[102:103], v[116:117]
    v_pk_mul_f32 v[104:105], v[104:105], v[116:117]
    v_pk_mul_f32 v[106:107], v[106:107], v[116:117]
    v_pk_mul_f32 v[108:109], v[108:109], v[116:117]
    v_pk_mul_f32 v[110:111], v[110:111], v[116:117]
    v_cvt_pk_bf16_f32 v64, v80, v81
    v_cvt_pk_bf16_f32 v65, v82, v83
    v_cvt_pk_bf16_f32 v66, v84, v85
    v_cvt_pk_bf16_f32 v67, v86, v87
    v_cvt_pk_bf16_f32 v68, v88, v89
    v_cvt_pk_bf16_f32 v69, v90, v91
    v_cvt_pk_bf16_f32 v70, v92, v93
    v_cvt_pk_bf16_f32 v71, v94, v95
    v_cvt_pk_bf16_f32 v72, v96, v97
    v_cvt_pk_bf16_f32 v73, v98, v99
    v_cvt_pk_bf16_f32 v74, v100, v101
    v_cvt_pk_bf16_f32 v75, v102, v103
    v_cvt_pk_bf16_f32 v76, v104, v105
    v_cvt_pk_bf16_f32 v77, v106, v107
    v_cvt_pk_bf16_f32 v78, v108, v109
    v_cvt_pk_bf16_f32 v79, v110, v111
    ds_write_b128 v54, v[64:67] offset:0
    ds_write_b128 v54, v[68:71] offset:512
    ds_write_b128 v54, v[72:75] offset:1024
    ds_write_b128 v54, v[76:79] offset:1536
    s_waitcnt vmcnt(16) lgkmcnt(0)
    s_barrier
    ds_read_b128 a[64:67], v55 offset:0
    ds_read_b128 a[68:71], v55 offset:128
    ds_read_b128 a[72:75], v55 offset:256
    ds_read_b128 a[76:79], v55 offset:384
    v_add_u32 v54, 4096, v36
    v_add_u32 v55, 4096, v37
    v_mfma_f32_32x32x16_bf16 v[64:79], v[56:59], v[56:59], 0
    v_mfma_f32_32x32x16_bf16 v[80:95], v[56:59], v[56:59], 0
    v_mfma_f32_32x32x16_bf16 v[96:111], v[56:59], v[56:59], 0
    v_mfma_f32_32x32x16_bf16 v[112:127], v[56:59], v[56:59], 0
    s_cmp_ge_u32 s2, 22
    s_cbranch_scc1 k12_nostat_5
    s_lshl_b32 s52, s2, 12
    s_add_u32 s52, s52, 0x3800000
    s_mov_b32 s34, -1
    v_lshlrev_b32 v6, 4, v0
    buffer_store_dwordx4 v[56:59], v6, s[32:35], s52 offen sc1
    s_mov_b32 s34, 0x2000000
k12_nostat_5:
    ds_read_b128 a[192:195], v26 offset:0
    ds_read_b64_tr_b16 a[0:1], v28 offset:0
    ds_read_b128 a[196:199], v27 offset:0
    ds_read_b64_tr_b16 a[2:3], v28 offset:2048
    ds_read_b128 a[200:203], v26 offset:2048
    ds_read_b64_tr_b16 a[4:5], v28 offset:16384
    ds_read_b128 a[204:207], v27 offset:2048
    ds_read_b64_tr_b16 a[6:7], v28 offset:18432
    ds_read_b128 a[208:211], v26 offset:4096
    ds_read_b64_tr_b16 a[8:9], v29 offset:0
    ds_read_b128 a[212:215], v27 offset:4096
    ds_read_b64_tr_b16 a[10:11], v29 offset:2048
    ds_read_b128 a[216:219], v26 offset:6144
    ds_read_b64_tr_b16 a[12:13], v29 offset:16384
    ds_read_b128 a[220:223], v27 offset:6144
    ds_read_b64_tr_b16 a[14:15], v29 offset:18432
    ds_read_b128 a[224:227], v26 offset:8192
    ds_read_b64_tr_b16 a[16:17], v30 offset:0
    ds_read_b128 a[228:231], v27 offset:8192
    ds_read_b64_tr_b16 a[18:19], v30 offset:2048
    ds_read_b128 a[232:235], v26 offset:10240
    ds_read_b64_tr_b16 a[20:21], v30 offset:16384
    ds_read_b128 a[236:239], v27 offset:10240
    ds_read_b64_tr_b16 a[22:23], v30 offset:18432
    ds_read_b128 a[240:243], v26 offset:12288
    ds_read_b64_tr_b16 a[24:25], v31 offset:0
    ds_read_b128 a[244:247], v27 offset:12288
    ds_read_b64_tr_b16 a[26:27], v31 offset:2048
    ds_read_b128 a[248:251], v26 offset:14336
    ds_read_b64_tr_b16 a[28:29], v31 offset:16384
    ds_read_b128 a[252:255], v27 offset:14336
    ds_read_b64_tr_b16 a[30:31], v31 offset:18432
    s_mov_b32 s51, 0
    s_waitcnt lgkmcnt(15)
    s_mov_b32 s52, 0
    buffer_store_dwordx4 a[64:67], v53, s[8:11], s52 offen sc1
    s_mov_b32 s52, 262144
    buffer_store_dwordx4 a[68:71], v53, s[8:11], s52 offen sc1
    s_mov_b32 s52, 524288
    buffer_store_dwordx4 a[72:75], v53, s[8:11], s52 offen sc1
    s_mov_b32 s52, 786432
    buffer_store_dwordx4 a[76:79], v53, s[8:11], s52 offen sc1
    s_waitcnt lgkmcnt(0)
    s_cmp_lg_u32 s57, 0
    s_cbranch_scc1 k12_v_6
k12_loop_8:
    v_mfma_f32_16x16x32_bf16 v[64:67], a[0:3], a[192:195], v[64:67]
    v_mfma_f32_16x16x32_bf16 v[64:67], a[4:7], a[196:199], v[64:67]
    ds_read_b64_tr_b16 a[32:33], v32 offset:0
    v_mfma_f32_16x16x32_bf16 v[80:83], a[4:7], a[204:207], v[80:83]
    v_mfma_f32_16x16x32_bf16 v[80:83], a[0:3], a[200:203], v[80:83]
    ds_read_b64_tr_b16 a[34:35], v32 offset:2048
    v_mfma_f32_16x16x32_bf16 v[96:99], a[0:3], a[208:211], v[96:99]
    s_cmp_eq_u32 s51, s46
    s_cbranch_scc1 k12_ool_10
k12_oolret_11:
    v_mfma_f32_16x16x32_bf16 v[96:99], a[4:7], a[212:215], v[96:99]
    v_mfma_f32_16x16x32_bf16 v[112:115], a[4:7], a[220:223], v[112:115]
    ds_read_b64_tr_b16 a[36:37], v32 offset:16384
    v_mfma_f32_16x16x32_bf16 v[112:115], a[0:3], a[216:219], v[112:115]
    v_mfma_f32_16x16x32_bf16 v[128:131], a[0:3], a[224:227], v[128:131]
    v_mfma_f32_16x16x32_bf16 v[128:131], a[4:7], a[228:231], v[128:131]
    ds_read_b64_tr_b16 a[38:39], v32 offset:18432
    v_mfma_f32_16x16x32_bf16 v[144:147], a[4:7], a[236:239], v[144:147]
    v_mfma_f32_16x16x32_bf16 v[144:147], a[0:3], a[232:235], v[144:147]
    v_mfma_f32_16x16x32_bf16 a[128:131], a[0:3], a[240:243], a[128:131]
    ds_read_b64_tr_b16 a[40:41], v33 offset:0
    v_mfma_f32_16x16x32_bf16 a[128:131], a[4:7], a[244:247], a[128:131]
    v_mfma_f32_16x16x32_bf16 a[160:163], a[4:7], a[252:255], a[160:163]
    v_mfma_f32_16x16x32_bf16 a[160:163], a[0:3], a[248:251], a[160:163]
    ds_read_b64_tr_b16 a[42:43], v33 offset:2048
    v_mfma_f32_16x16x32_bf16 a[164:167], a[8:11], a[248:251], a[164:167]
    v_mfma_f32_16x16x32_bf16 a[164:167], a[12:15], a[252:255], a[164:167]
    v_mfma_f32_16x16x32_bf16 a[132:135], a[12:15], a[244:247], a[132:135]
    ds_read_b64_tr_b16 a[44:45], v33 offset:16384
    v_mfma_f32_16x16x32_bf16 a[132:135], a[8:11], a[240:243], a[132:135]
    v_mfma_f32_16x16x32_bf16 v[240:243], a[8:11], a[232:235], v[240:243]
    v_mfma_f32_16x16x32_bf16 v[240:243], a[12:15], a[236:239], v[240:243]
    ds_read_b64_tr_b16 a[46:47], v33 offset:18432
    v_mfma_f32_16x16x32_bf16 v[224:227], a[12:15], a[228:231], v[224:227]
    v_mfma_f32_16x16x32_bf16 v[224:227], a[8:11], a[224:227], v[224:227]
    ds_read_b64_tr_b16 a[48:49], v34 offset:0
    v_mfma_f32_16x16x32_bf16 v[208:211], a[8:11], a[216:219], v[208:211]
    v_mfma_f32_16x16x32_bf16 v[208:211], a[12:15], a[220:223], v[208:211]
    v_mfma_f32_16x16x32_bf16 v[192:195], a[12:15], a[212:215], v[192:195]
    ds_read_b64_tr_b16 a[50:51], v34 offset:2048
    v_mfma_f32_16x16x32_bf16 v[192:195], a[8:11], a[208:211], v[192:195]
    v_mfma_f32_16x16x32_bf16 v[176:179], a[8:11], a[200:203], v[176:179]
    v_mfma_f32_16x16x32_bf16 v[176:179], a[12:15], a[204:207], v[176:179]
    ds_read_b64_tr_b16 a[52:53], v34 offset:16384
    v_mfma_f32_16x16x32_bf16 v[160:163], a[12:15], a[196:199], v[160:163]
    v_mfma_f32_16x16x32_bf16 v[160:163], a[8:11], a[192:195], v[160:163]
    v_mfma_f32_16x16x32_bf16 v[68:71], a[16:19], a[192:195], v[68:71]
    ds_read_b64_tr_b16 a[54:55], v34 offset:18432
    v_mfma_f32_16x16x32_bf16 v[68:71], a[20:23], a[196:199], v[68:71]
    v_mfma_f32_16x16x32_bf16 v[84:87], a[20:23], a[204:207], v[84:87]
    v_mfma_f32_16x16x32_bf16 v[84:87], a[16:19], a[200:203], v[84:87]
    ds_read_b64_tr_b16 a[56:57], v35 offset:0
    v_mfma_f32_16x16x32_bf16 v[100:103], a[16:19], a[208:211], v[100:103]
    v_mfma_f32_16x16x32_bf16 v[100:103], a[20:23], a[212:215], v[100:103]
    v_mfma_f32_16x16x32_bf16 v[116:119], a[20:23], a[220:223], v[116:119]
    ds_read_b64_tr_b16 a[58:59], v35 offset:2048
    v_mfma_f32_16x16x32_bf16 v[116:119], a[16:19], a[216:219], v[116:119]
    v_mfma_f32_16x16x32_bf16 v[132:135], a[16:19], a[224:227], v[132:135]
    v_mfma_f32_16x16x32_bf16 v[132:135], a[20:23], a[228:231], v[132:135]
    ds_read_b64_tr_b16 a[60:61], v35 offset:16384
    v_mfma_f32_16x16x32_bf16 v[148:151], a[20:23], a[236:239], v[148:151]
    v_mfma_f32_16x16x32_bf16 v[148:151], a[16:19], a[232:235], v[148:151]
    v_mfma_f32_16x16x32_bf16 a[136:139], a[16:19], a[240:243], a[136:139]
    ds_read_b64_tr_b16 a[62:63], v35 offset:18432
    v_mfma_f32_16x16x32_bf16 a[136:139], a[20:23], a[244:247], a[136:139]
    v_mfma_f32_16x16x32_bf16 a[168:171], a[20:23], a[252:255], a[168:171]
    v_mfma_f32_16x16x32_bf16 a[168:171], a[16:19], a[248:251], a[168:171]
    v_mfma_f32_16x16x32_bf16 a[172:175], a[24:27], a[248:251], a[172:175]
    v_mfma_f32_16x16x32_bf16 a[172:175], a[28:31], a[252:255], a[172:175]
    v_mfma_f32_16x16x32_bf16 a[140:143], a[28:31], a[244:247], a[140:143]
    v_mfma_f32_16x16x32_bf16 a[140:143], a[24:27], a[240:243], a[140:143]
    v_mfma_f32_16x16x32_bf16 v[244:247], a[24:27], a[232:235], v[244:247]
    v_mfma_f32_16x16x32_bf16 v[244:247], a[28:31], a[236:239], v[244:247]
    v_mfma_f32_16x16x32_bf16 v[228:231], a[28:31], a[228:231], v[228:231]
    v_mfma_f32_16x16x32_bf16 v[228:231], a[24:27], a[224:227], v[228:231]
    v_mfma_f32_16x16x32_bf16 v[212:215], a[24:27], a[216:219], v[212:215]
    v_mfma_f32_16x16x32_bf16 v[212:215], a[28:31], a[220:223], v[212:215]
    v_mfma_f32_16x16x32_bf16 v[196:199], a[28:31], a[212:215], v[196:199]
    v_mfma_f32_16x16x32_bf16 v[196:199], a[24:27], a[208:211], v[196:199]
    v_mfma_f32_16x16x32_bf16 v[180:183], a[24:27], a[200:203], v[180:183]
    v_mfma_f32_16x16x32_bf16 v[180:183], a[28:31], a[204:207], v[180:183]
    v_mfma_f32_16x16x32_bf16 v[164:167], a[28:31], a[196:199], v[164:167]
    v_mfma_f32_16x16x32_bf16 v[164:167], a[24:27], a[192:195], v[164:167]
    s_waitcnt vmcnt(0) lgkmcnt(0)
    s_cmp_eq_u32 s51, s46
    s_cbranch_scc1 k12_ool_14
k12_oolret_15:
    s_barrier
    v_mfma_f32_16x16x32_bf16 v[72:75], a[32:35], a[192:195], v[72:75]
    s_cmp_ge_u32 s49, 1024
    s_cselect_b32 s18, 0, s18
    s_cselect_b32 s22, 0, s22
    v_mfma_f32_16x16x32_bf16 v[72:75], a[36:39], a[196:199], v[72:75]
    s_add_u32 m0, s48, 0
    ds_read_b128 a[64:67], v26 offset:32768
    v_mfma_f32_16x16x32_bf16 v[88:91], a[36:39], a[204:207], v[88:91]
    buffer_load_dwordx4 v10, s[16:19], s49 offen offset:0 lds
    ds_read_b64_tr_b16 a[0:1], v28 offset:32768
    v_mfma_f32_16x16x32_bf16 v[88:91], a[32:35], a[200:203], v[88:91]
    ds_read_b128 a[68:71], v27 offset:32768
    v_mfma_f32_16x16x32_bf16 v[104:107], a[32:35], a[208:211], v[104:107]
    buffer_load_dwordx4 v11, s[16:19], s49 offen offset:1024 lds
    v_mfma_f32_16x16x32_bf16 v[104:107], a[36:39], a[212:215], v[104:107]
    ds_read_b64_tr_b16 a[2:3], v28 offset:34816
    v_mfma_f32_16x16x32_bf16 v[120:123], a[36:39], a[220:223], v[120:123]
    v_mfma_f32_16x16x32_bf16 v[120:123], a[32:35], a[216:219], v[120:123]
    ds_read_b128 a[72:75], v26 offset:34816
    v_mfma_f32_16x16x32_bf16 v[136:139], a[32:35], a[224:227], v[136:139]
    buffer_load_dwordx4 v12, s[16:19], s49 offen offset:2048 lds
    ds_read_b64_tr_b16 a[4:5], v28 offset:49152
    v_mfma_f32_16x16x32_bf16 v[136:139], a[36:39], a[228:231], v[136:139]
    v_mfma_f32_16x16x32_bf16 v[152:155], a[36:39], a[236:239], v[152:155]
    ds_read_b128 a[76:79], v27 offset:34816
    v_mfma_f32_16x16x32_bf16 v[152:155], a[32:35], a[232:235], v[152:155]
    buffer_load_dwordx4 v13, s[16:19], s49 offen offset:3072 lds
    v_mfma_f32_16x16x32_bf16 a[144:147], a[32:35], a[240:243], a[144:147]
    ds_read_b64_tr_b16 a[6:7], v28 offset:51200
    v_mfma_f32_16x16x32_bf16 a[144:147], a[36:39], a[244:247], a[144:147]
    s_add_u32 m0, s48, 4096
    ds_read_b128 a[80:83], v26 offset:36864
    v_mfma_f32_16x16x32_bf16 a[176:179], a[36:39], a[252:255], a[176:179]
    v_mfma_f32_16x16x32_bf16 a[176:179], a[32:35], a[248:251], a[176:179]
    buffer_load_dwordx4 v14, s[16:19], s49 offen offset:0 lds
    ds_read_b64_tr_b16 a[8:9], v29 offset:32768
    v_mfma_f32_16x16x32_bf16 a[180:183], a[40:43], a[248:251], a[180:183]
    v_mfma_f32_16x16x32_bf16 a[180:183], a[44:47], a[252:255], a[180:183]
    ds_read_b128 a[84:87], v27 offset:36864
    v_mfma_f32_16x16x32_bf16 a[148:151], a[44:47], a[244:247], a[148:151]
    buffer_load_dwordx4 v15, s[16:19], s49 offen offset:1024 lds
    ds_read_b64_tr_b16 a[10:11], v29 offset:34816
    v_mfma_f32_16x16x32_bf16 a[148:151], a[40:43], a[240:243], a[148:151]
    v_mfma_f32_16x16x32_bf16 v[248:251], a[40:43], a[232:235], v[248:251]
    ds_read_b128 a[88:91], v26 offset:38912
    v_mfma_f32_16x16x32_bf16 v[248:251], a[44:47], a[236:239], v[248:251]
    v_mfma_f32_16x16x32_bf16 v[232:235], a[44:47], a[228:231], v[232:235]
    buffer_load_dwordx4 v16, s[16:19], s49 offen offset:2048 lds
    ds_read_b64_tr_b16 a[12:13], v29 offset:49152
    v_mfma_f32_16x16x32_bf16 v[232:235], a[40:43], a[224:227], v[232:235]
    ds_read_b128 a[92:95], v27 offset:38912
    v_mfma_f32_16x16x32_bf16 v[216:219], a[40:43], a[216:219], v[216:219]
    v_mfma_f32_16x16x32_bf16 v[216:219], a[44:47], a[220:223], v[216:219]
    buffer_load_dwordx4 v17, s[16:19], s49 offen offset:3072 lds
    ds_read_b64_tr_b16 a[14:15], v29 offset:51200
    v_mfma_f32_16x16x32_bf16 v[200:203], a[44:47], a[212:215], v[200:203]
    ds_read_b128 a[96:99], v26 offset:40960
    v_mfma_f32_16x16x32_bf16 v[200:203], a[40:43], a[208:211], v[200:203]
    s_add_u32 s49, s49, 128
    v_mfma_f32_16x16x32_bf16 v[184:187], a[40:43], a[200:203], v[184:187]
    s_add_u32 m0, s48, 65536
    ds_read_b64_tr_b16 a[16:17], v30 offset:32768
    v_mfma_f32_16x16x32_bf16 v[184:187], a[44:47], a[204:207], v[184:187]
    buffer_load_dwordx4 v18, s[20:23], s50 offen offset:0 lds
    v_mfma_f32_16x16x32_bf16 v[168:171], a[44:47], a[196:199], v[168:171]
    ds_read_b128 a[100:103], v27 offset:40960
    v_mfma_f32_16x16x32_bf16 v[168:171], a[40:43], a[192:195], v[168:171]
    ds_read_b64_tr_b16 a[18:19], v30 offset:34816
    v_mfma_f32_16x16x32_bf16 v[76:79], a[48:51], a[192:195], v[76:79]
    buffer_load_dwordx4 v19, s[20:23], s50 offen offset:1024 lds
    v_mfma_f32_16x16x32_bf16 v[76:79], a[52:55], a[196:199], v[76:79]
    ds_read_b128 a[104:107], v26 offset:43008
    v_mfma_f32_16x16x32_bf16 v[92:95], a[52:55], a[204:207], v[92:95]
    v_mfma_f32_16x16x32_bf16 v[92:95], a[48:51], a[200:203], v[92:95]
    buffer_load_dwordx4 v20, s[20:23], s50 offen offset:2048 lds
    ds_read_b64_tr_b16 a[20:21], v30 offset:49152
    v_mfma_f32_16x16x32_bf16 v[108:111], a[48:51], a[208:211], v[108:111]
    ds_read_b128 a[108:111], v27 offset:43008
    v_mfma_f32_16x16x32_bf16 v[108:111], a[52:55], a[212:215], v[108:111]
    v_mfma_f32_16x16x32_bf16 v[124:127], a[52:55], a[220:223], v[124:127]
    ds_read_b64_tr_b16 a[22:23], v30 offset:51200
    v_mfma_f32_16x16x32_bf16 v[124:127], a[48:51], a[216:219], v[124:127]
    buffer_load_dwordx4 v21, s[20:23], s50 offen offset:3072 lds
    v_mfma_f32_16x16x32_bf16 v[140:143], a[48:51], a[224:227], v[140:143]
    s_add_u32 m0, s48, 69632
    ds_read_b128 a[112:115], v26 offset:45056
    v_mfma_f32_16x16x32_bf16 v[140:143], a[52:55], a[228:231], v[140:143]
    ds_read_b64_tr_b16 a[24:25], v31 offset:32768
    v_mfma_f32_16x16x32_bf16 v[156:159], a[52:55], a[236:239], v[156:159]
    buffer_load_dwordx4 v22, s[20:23], s50 offen offset:0 lds
    v_mfma_f32_16x16x32_bf16 v[156:159], a[48:51], a[232:235], v[156:159]
    ds_read_b128 a[116:119], v27 offset:45056
    v_mfma_f32_16x16x32_bf16 a[152:155], a[48:51], a[240:243], a[152:155]
    v_mfma_f32_16x16x32_bf16 a[152:155], a[52:55], a[244:247], a[152:155]
    ds_read_b64_tr_b16 a[26:27], v31 offset:34816
    v_mfma_f32_16x16x32_bf16 a[184:187], a[52:55], a[252:255], a[184:187]
    buffer_load_dwordx4 v23, s[20:23], s50 offen offset:1024 lds
    ds_read_b128 a[120:123], v26 offset:47104
    v_mfma_f32_16x16x32_bf16 a[184:187], a[48:51], a[248:251], a[184:187]
    v_mfma_f32_16x16x32_bf16 a[188:191], a[56:59], a[248:251], a[188:191]
    ds_read_b64_tr_b16 a[28:29], v31 offset:49152
    v_mfma_f32_16x16x32_bf16 a[188:191], a[60:63], a[252:255], a[188:191]
    buffer_load_dwordx4 v24, s[20:23], s50 offen offset:2048 lds
    v_mfma_f32_16x16x32_bf16 a[156:159], a[60:63], a[244:247], a[156:159]
    ds_read_b128 a[124:127], v27 offset:47104
    v_mfma_f32_16x16x32_bf16 a[156:159], a[56:59], a[240:243], a[156:159]
    ds_read_b64_tr_b16 a[30:31], v31 offset:51200
    v_mfma_f32_16x16x32_bf16 v[252:255], a[56:59], a[232:235], v[252:255]
    v_mfma_f32_16x16x32_bf16 v[252:255], a[60:63], a[236:239], v[252:255]
    buffer_load_dwordx4 v25, s[20:23], s50 offen offset:3072 lds
    v_mfma_f32_16x16x32_bf16 v[236:239], a[60:63], a[228:231], v[236:239]
    v_mfma_f32_16x16x32_bf16 v[236:239], a[56:59], a[224:227], v[236:239]
    s_add_u32 s50, s50, 0x80000
    v_mfma_f32_16x16x32_bf16 v[220:223], a[56:59], a[216:219], v[220:223]
    v_mfma_f32_16x16x32_bf16 v[220:223], a[60:63], a[220:223], v[220:223]
    s_cmp_eq_u32 s51, s53
    s_cbranch_scc1 k12_ool_16
k12_oolret_17:
    v_mfma_f32_16x16x32_bf16 v[204:207], a[60:63], a[212:215], v[204:207]
    s_cmp_eq_u32 s51, s63
    s_cbranch_scc1 k12_ool_18
k12_oolret_19:
    v_mfma_f32_16x16x32_bf16 v[204:207], a[56:59], a[208:211], v[204:207]
    s_cmp_eq_u32 s51, 6
    s_cbranch_scc1 k12_ool_20
k12_oolret_21:
    v_mfma_f32_16x16x32_bf16 v[188:191], a[56:59], a[200:203], v[188:191]
    v_mfma_f32_16x16x32_bf16 v[188:191], a[60:63], a[204:207], v[188:191]
    s_add_u32 s51, s51, 1
    v_mfma_f32_16x16x32_bf16 v[172:175], a[60:63], a[196:199], v[172:175]
    v_mfma_f32_16x16x32_bf16 v[172:175], a[56:59], a[192:195], v[172:175]
    s_waitcnt lgkmcnt(0)
    s_cmp_eq_u32 s51, 7
    s_cbranch_scc1 k12_last_9
    v_mfma_f32_16x16x32_bf16 v[64:67], a[0:3], a[64:67], v[64:67]
    v_mfma_f32_16x16x32_bf16 v[64:67], a[4:7], a[68:71], v[64:67]
    ds_read_b64_tr_b16 a[32:33], v32 offset:32768
    v_mfma_f32_16x16x32_bf16 v[80:83], a[4:7], a[76:79], v[80:83]
    v_mfma_f32_16x16x32_bf16 v[80:83], a[0:3], a[72:75], v[80:83]
    ds_read_b64_tr_b16 a[34:35], v32 offset:34816
    v_mfma_f32_16x16x32_bf16 v[96:99], a[0:3], a[80:83], v[96:99]
    v_mfma_f32_16x16x32_bf16 v[96:99], a[4:7], a[84:87], v[96:99]
    v_mfma_f32_16x16x32_bf16 v[112:115], a[4:7], a[92:95], v[112:115]
    ds_read_b64_tr_b16 a[36:37], v32 offset:49152
    v_mfma_f32_16x16x32_bf16 v[112:115], a[0:3], a[88:91], v[112:115]
    v_mfma_f32_16x16x32_bf16 v[128:131], a[0:3], a[96:99], v[128:131]
    v_mfma_f32_16x16x32_bf16 v[128:131], a[4:7], a[100:103], v[128:131]
    ds_read_b64_tr_b16 a[38:39], v32 offset:51200
    v_mfma_f32_16x16x32_bf16 v[144:147], a[4:7], a[108:111], v[144:147]
    v_mfma_f32_16x16x32_bf16 v[144:147], a[0:3], a[104:107], v[144:147]
    v_mfma_f32_16x16x32_bf16 a[128:131], a[0:3], a[112:115], a[128:131]
    ds_read_b64_tr_b16 a[40:41], v33 offset:32768
    v_mfma_f32_16x16x32_bf16 a[128:131], a[4:7], a[116:119], a[128:131]
    v_mfma_f32_16x16x32_bf16 a[160:163], a[4:7], a[124:127], a[160:163]
    v_mfma_f32_16x16x32_bf16 a[160:163], a[0:3], a[120:123], a[160:163]
    ds_read_b64_tr_b16 a[42:43], v33 offset:34816
    v_mfma_f32_16x16x32_bf16 a[164:167], a[8:11], a[120:123], a[164:167]
    v_mfma_f32_16x16x32_bf16 a[164:167], a[12:15], a[124:127], a[164:167]
    v_mfma_f32_16x16x32_bf16 a[132:135], a[12:15], a[116:119], a[132:135]
    ds_read_b64_tr_b16 a[44:45], v33 offset:49152
    v_mfma_f32_16x16x32_bf16 a[132:135], a[8:11], a[112:115], a[132:135]
    v_mfma_f32_16x16x32_bf16 v[240:243], a[8:11], a[104:107], v[240:243]
    v_mfma_f32_16x16x32_bf16 v[240:243], a[12:15], a[108:111], v[240:243]
    ds_read_b64_tr_b16 a[46:47], v33 offset:51200
    v_mfma_f32_16x16x32_bf16 v[224:227], a[12:15], a[100:103], v[224:227]
    v_mfma_f32_16x16x32_bf16 v[224:227], a[8:11], a[96:99], v[224:227]
    ds_read_b64_tr_b16 a[48:49], v34 offset:32768
    v_mfma_f32_16x16x32_bf16 v[208:211], a[8:11], a[88:91], v[208:211]
    v_mfma_f32_16x16x32_bf16 v[208:211], a[12:15], a[92:95], v[208:211]
    v_mfma_f32_16x16x32_bf16 v[192:195], a[12:15], a[84:87], v[192:195]
    ds_read_b64_tr_b16 a[50:51], v34 offset:34816
    v_mfma_f32_16x16x32_bf16 v[192:195], a[8:11], a[80:83], v[192:195]
    v_mfma_f32_16x16x32_bf16 v[176:179], a[8:11], a[72:75], v[176:179]
    v_mfma_f32_16x16x32_bf16 v[176:179], a[12:15], a[76:79], v[176:179]
    ds_read_b64_tr_b16 a[52:53], v34 offset:49152
    v_mfma_f32_16x16x32_bf16 v[160:163], a[12:15], a[68:71], v[160:163]
    v_mfma_f32_16x16x32_bf16 v[160:163], a[8:11], a[64:67], v[160:163]
    v_mfma_f32_16x16x32_bf16 v[68:71], a[16:19], a[64:67], v[68:71]
    ds_read_b64_tr_b16 a[54:55], v34 offset:51200
    v_mfma_f32_16x16x32_bf16 v[68:71], a[20:23], a[68:71], v[68:71]
    v_mfma_f32_16x16x32_bf16 v[84:87], a[20:23], a[76:79], v[84:87]
    v_mfma_f32_16x16x32_bf16 v[84:87], a[16:19], a[72:75], v[84:87]
    ds_read_b64_tr_b16 a[56:57], v35 offset:32768
    v_mfma_f32_16x16x32_bf16 v[100:103], a[16:19], a[80:83], v[100:103]
    v_mfma_f32_16x16x32_bf16 v[100:103], a[20:23], a[84:87], v[100:103]
    v_mfma_f32_16x16x32_bf16 v[116:119], a[20:23], a[92:95], v[116:119]
    ds_read_b64_tr_b16 a[58:59], v35 offset:34816
    v_mfma_f32_16x16x32_bf16 v[116:119], a[16:19], a[88:91], v[116:119]
    v_mfma_f32_16x16x32_bf16 v[132:135], a[16:19], a[96:99], v[132:135]
    v_mfma_f32_16x16x32_bf16 v[132:135], a[20:23], a[100:103], v[132:135]
    ds_read_b64_tr_b16 a[60:61], v35 offset:49152
    v_mfma_f32_16x16x32_bf16 v[148:151], a[20:23], a[108:111], v[148:151]
    v_mfma_f32_16x16x32_bf16 v[148:151], a[16:19], a[104:107], v[148:151]
    v_mfma_f32_16x16x32_bf16 a[136:139], a[16:19], a[112:115], a[136:139]
    ds_read_b64_tr_b16 a[62:63], v35 offset:51200
    v_mfma_f32_16x16x32_bf16 a[136:139], a[20:23], a[116:119], a[136:139]
    v_mfma_f32_16x16x32_bf16 a[168:171], a[20:23], a[124:127], a[168:171]
    v_mfma_f32_16x16x32_bf16 a[168:171], a[16:19], a[120:123], a[168:171]
    v_mfma_f32_16x16x32_bf16 a[172:175], a[24:27], a[120:123], a[172:175]
    v_mfma_f32_16x16x32_bf16 a[172:175], a[28:31], a[124:127], a[172:175]
    v_mfma_f32_16x16x32_bf16 a[140:143], a[28:31], a[116:119], a[140:143]
    v_mfma_f32_16x16x32_bf16 a[140:143], a[24:27], a[112:115], a[140:143]
    v_mfma_f32_16x16x32_bf16 v[244:247], a[24:27], a[104:107], v[244:247]
    v_mfma_f32_16x16x32_bf16 v[244:247], a[28:31], a[108:111], v[244:247]
    v_mfma_f32_16x16x32_bf16 v[228:231], a[28:31], a[100:103], v[228:231]
    v_mfma_f32_16x16x32_bf16 v[228:231], a[24:27], a[96:99], v[228:231]
    v_mfma_f32_16x16x32_bf16 v[212:215], a[24:27], a[88:91], v[212:215]
    v_mfma_f32_16x16x32_bf16 v[212:215], a[28:31], a[92:95], v[212:215]
    v_mfma_f32_16x16x32_bf16 v[196:199], a[28:31], a[84:87], v[196:199]
    v_mfma_f32_16x16x32_bf16 v[196:199], a[24:27], a[80:83], v[196:199]
    v_mfma_f32_16x16x32_bf16 v[180:183], a[24:27], a[72:75], v[180:183]
    v_mfma_f32_16x16x32_bf16 v[180:183], a[28:31], a[76:79], v[180:183]
    v_mfma_f32_16x16x32_bf16 v[164:167], a[28:31], a[68:71], v[164:167]
    v_mfma_f32_16x16x32_bf16 v[164:167], a[24:27], a[64:67], v[164:167]
    s_waitcnt vmcnt(0) lgkmcnt(0)
    s_barrier
    v_mfma_f32_16x16x32_bf16 v[72:75], a[32:35], a[64:67], v[72:75]
    v_mfma_f32_16x16x32_bf16 v[72:75], a[36:39], a[68:71], v[72:75]
    s_add_u32 m0, s48, 32768
    ds_read_b128 a[192:195], v26 offset:0
    v_mfma_f32_16x16x32_bf16 v[88:91], a[36:39], a[76:79], v[88:91]
    buffer_load_dwordx4 v10, s[16:19], s49 offen offset:0 lds
    ds_read_b64_tr_b16 a[0:1], v28 offset:0
    v_mfma_f32_16x16x32_bf16 v[88:91], a[32:35], a[72:75], v[88:91]
    ds_read_b128 a[196:199], v27 offset:0
    v_mfma_f32_16x16x32_bf16 v[104:107], a[32:35], a[80:83], v[104:107]
    buffer_load_dwordx4 v11, s[16:19], s49 offen offset:1024 lds
    v_mfma_f32_16x16x32_bf16 v[104:107], a[36:39], a[84:87], v[104:107]
    ds_read_b64_tr_b16 a[2:3], v28 offset:2048
    v_mfma_f32_16x16x32_bf16 v[120:123], a[36:39], a[92:95], v[120:123]
    v_mfma_f32_16x16x32_bf16 v[120:123], a[32:35], a[88:91], v[120:123]
    ds_read_b128 a[200:203], v26 offset:2048
    v_mfma_f32_16x16x32_bf16 v[136:139], a[32:35], a[96:99], v[136:139]
    buffer_load_dwordx4 v12, s[16:19], s49 offen offset:2048 lds
    ds_read_b64_tr_b16 a[4:5], v28 offset:16384
    v_mfma_f32_16x16x32_bf16 v[136:139], a[36:39], a[100:103], v[136:139]
    v_mfma_f32_16x16x32_bf16 v[152:155], a[36:39], a[108:111], v[152:155]
    ds_read_b128 a[204:207], v27 offset:2048
    v_mfma_f32_16x16x32_bf16 v[152:155], a[32:35], a[104:107], v[152:155]
    buffer_load_dwordx4 v13, s[16:19], s49 offen offset:3072 lds
    v_mfma_f32_16x16x32_bf16 a[144:147], a[32:35], a[112:115], a[144:147]
    ds_read_b64_tr_b16 a[6:7], v28 offset:18432
    v_mfma_f32_16x16x32_bf16 a[144:147], a[36:39], a[116:119], a[144:147]
    s_add_u32 m0, s48, 36864
    ds_read_b128 a[208:211], v26 offset:4096
    v_mfma_f32_16x16x32_bf16 a[176:179], a[36:39], a[124:127], a[176:179]
    v_mfma_f32_16x16x32_bf16 a[176:179], a[32:35], a[120:123], a[176:179]
    buffer_load_dwordx4 v14, s[16:19], s49 offen offset:0 lds
    ds_read_b64_tr_b16 a[8:9], v29 offset:0
    v_mfma_f32_16x16x32_bf16 a[180:183], a[40:43], a[120:123], a[180:183]
    v_mfma_f32_16x16x32_bf16 a[180:183], a[44:47], a[124:127], a[180:183]
    ds_read_b128 a[212:215], v27 offset:4096
    v_mfma_f32_16x16x32_bf16 a[148:151], a[44:47], a[116:119], a[148:151]
    buffer_load_dwordx4 v15, s[16:19], s49 offen offset:1024 lds
    ds_read_b64_tr_b16 a[10:11], v29 offset:2048
    v_mfma_f32_16x16x32_bf16 a[148:151], a[40:43], a[112:115], a[148:151]
    v_mfma_f32_16x16x32_bf16 v[248:251], a[40:43], a[104:107], v[248:251]
    ds_read_b128 a[216:219], v26 offset:6144
    v_mfma_f32_16x16x32_bf16 v[248:251], a[44:47], a[108:111], v[248:251]
    v_mfma_f32_16x16x32_bf16 v[232:235], a[44:47], a[100:103], v[232:235]
    buffer_load_dwordx4 v16, s[16:19], s49 offen offset:2048 lds
    ds_read_b64_tr_b16 a[12:13], v29 offset:16384
    v_mfma_f32_16x16x32_bf16 v[232:235], a[40:43], a[96:99], v[232:235]
    ds_read_b128 a[220:223], v27 offset:6144
    v_mfma_f32_16x16x32_bf16 v[216:219], a[40:43], a[88:91], v[216:219]
    v_mfma_f32_16x16x32_bf16 v[216:219], a[44:47], a[92:95], v[216:219]
    buffer_load_dwordx4 v17, s[16:19], s49 offen offset:3072 lds
    ds_read_b64_tr_b16 a[14:15], v29 offset:18432
    v_mfma_f32_16x16x32_bf16 v[200:203], a[44:47], a[84:87], v[200:203]
    ds_read_b128 a[224:227], v26 offset:8192
    v_mfma_f32_16x16x32_bf16 v[200:203], a[40:43], a[80:83], v[200:203]
    s_add_u32 s49, s49, 128
    v_mfma_f32_16x16x32_bf16 v[184:187], a[40:43], a[72:75], v[184:187]
    s_add_u32 m0, s48, 98304
    ds_read_b64_tr_b16 a[16:17], v30 offset:0
    v_mfma_f32_16x16x32_bf16 v[184:187], a[44:47], a[76:79], v[184:187]
    buffer_load_dwordx4 v18, s[20:23], s50 offen offset:0 lds
    v_mfma_f32_16x16x32_bf16 v[168:171], a[44:47], a[68:71], v[168:171]
    ds_read_b128 a[228:231], v27 offset:8192
    v_mfma_f32_16x16x32_bf16 v[168:171], a[40:43], a[64:67], v[168:171]
    ds_read_b64_tr_b16 a[18:19], v30 offset:2048
    v_mfma_f32_16x16x32_bf16 v[76:79], a[48:51], a[64:67], v[76:79]
    buffer_load_dwordx4 v19, s[20:23], s50 offen offset:1024 lds
    v_mfma_f32_16x16x32_bf16 v[76:79], a[52:55], a[68:71], v[76:79]
    ds_read_b128 a[232:235], v26 offset:10240
    v_mfma_f32_16x16x32_bf16 v[92:95], a[52:55], a[76:79], v[92:95]
    v_mfma_f32_16x16x32_bf16 v[92:95], a[48:51], a[72:75], v[92:95]
    buffer_load_dwordx4 v20, s[20:23], s50 offen offset:2048 lds
    ds_read_b64_tr_b16 a[20:21], v30 offset:16384
    v_mfma_f32_16x16x32_bf16 v[108:111], a[48:51], a[80:83], v[108:111]
    ds_read_b128 a[236:239], v27 offset:10240
    v_mfma_f32_16x16x32_bf16 v[108:111], a[52:55], a[84:87], v[108:111]
    v_mfma_f32_16x16x32_bf16 v[124:127], a[52:55], a[92:95], v[124:127]
    ds_read_b64_tr_b16 a[22:23], v30 offset:18432
    v_mfma_f32_16x16x32_bf16 v[124:127], a[48:51], a[88:91], v[124:127]
    buffer_load_dwordx4 v21, s[20:23], s50 offen offset:3072 lds
    v_mfma_f32_16x16x32_bf16 v[140:143], a[48:51], a[96:99], v[140:143]
    s_add_u32 m0, s48, 102400
    ds_read_b128 a[240:243], v26 offset:12288
    v_mfma_f32_16x16x32_bf16 v[140:143], a[52:55], a[100:103], v[140:143]
    ds_read_b64_tr_b16 a[24:25], v31 offset:0
    v_mfma_f32_16x16x32_bf16 v[156:159], a[52:55], a[108:111], v[156:159]
    buffer_load_dwordx4 v22, s[20:23], s50 offen offset:0 lds
    v_mfma_f32_16x16x32_bf16 v[156:159], a[48:51], a[104:107], v[156:159]
    ds_read_b128 a[244:247], v27 offset:12288
    v_mfma_f32_16x16x32_bf16 a[152:155], a[48:51], a[112:115], a[152:155]
    v_mfma_f32_16x16x32_bf16 a[152:155], a[52:55], a[116:119], a[152:155]
    ds_read_b64_tr_b16 a[26:27], v31 offset:2048
    v_mfma_f32_16x16x32_bf16 a[184:187], a[52:55], a[124:127], a[184:187]
    buffer_load_dwordx4 v23, s[20:23], s50 offen offset:1024 lds
    ds_read_b128 a[248:251], v26 offset:14336
    v_mfma_f32_16x16x32_bf16 a[184:187], a[48:51], a[120:123], a[184:187]
    v_mfma_f32_16x16x32_bf16 a[188:191], a[56:59], a[120:123], a[188:191]
    ds_read_b64_tr_b16 a[28:29], v31 offset:16384
    v_mfma_f32_16x16x32_bf16 a[188:191], a[60:63], a[124:127], a[188:191]
    buffer_load_dwordx4 v24, s[20:23], s50 offen offset:2048 lds
    v_mfma_f32_16x16x32_bf16 a[156:159], a[60:63], a[116:119], a[156:159]
    ds_read_b128 a[252:255], v27 offset:14336
    v_mfma_f32_16x16x32_bf16 a[156:159], a[56:59], a[112:115], a[156:159]
    ds_read_b64_tr_b16 a[30:31], v31 offset:18432
    v_mfma_f32_16x16x32_bf16 v[252:255], a[56:59], a[104:107], v[252:255]
    v_mfma_f32_16x16x32_bf16 v[252:255], a[60:63], a[108:111], v[252:255]
    buffer_load_dwordx4 v25, s[20:23], s50 offen offset:3072 lds
    v_mfma_f32_16x16x32_bf16 v[236:239], a[60:63], a[100:103], v[236:239]
    v_mfma_f32_16x16x32_bf16 v[236:239], a[56:59], a[96:99], v[236:239]
    s_add_u32 s50, s50, 0x80000
    v_mfma_f32_16x16x32_bf16 v[220:223], a[56:59], a[88:91], v[220:223]
    v_mfma_f32_16x16x32_bf16 v[220:223], a[60:63], a[92:95], v[220:223]
    s_cmp_eq_u32 s51, s53
    s_cbranch_scc1 k12_ool_22
k12_oolret_23:
    v_mfma_f32_16x16x32_bf16 v[204:207], a[60:63], a[84:87], v[204:207]
    s_cmp_eq_u32 s51, s63
    s_cbranch_scc1 k12_ool_24
k12_oolret_25:
    v_mfma_f32_16x16x32_bf16 v[204:207], a[56:59], a[80:83], v[204:207]
    s_cmp_eq_u32 s51, 5
    s_cbranch_scc1 k12_ool_26
k12_oolret_27:
    v_mfma_f32_16x16x32_bf16 v[188:191], a[56:59], a[72:75], v[188:191]
    v_mfma_f32_16x16x32_bf16 v[188:191], a[60:63], a[76:79], v[188:191]
    s_add_u32 s51, s51, 1
    v_mfma_f32_16x16x32_bf16 v[172:175], a[60:63], a[68:71], v[172:175]
    v_mfma_f32_16x16x32_bf16 v[172:175], a[56:59], a[64:67], v[172:175]
    s_waitcnt lgkmcnt(0)
    s_branch k12_loop_8
k12_last_9:
    v_mfma_f32_16x16x32_bf16 v[64:67], a[0:3], a[64:67], v[64:67]
    buffer_load_dwordx4 a[192:195], v36, s[8:11], s62 offen sc1
    v_mfma_f32_16x16x32_bf16 v[64:67], a[4:7], a[68:71], v[64:67]
    ds_read_b64_tr_b16 a[32:33], v32 offset:32768
    v_mfma_f32_16x16x32_bf16 v[160:163], a[12:15], a[68:71], v[160:163]
    buffer_load_dwordx4 a[196:199], v54, s[8:11], s62 offen sc1
    ds_read_b64_tr_b16 a[34:35], v32 offset:34816
    v_mfma_f32_16x16x32_bf16 v[160:163], a[8:11], a[64:67], v[160:163]
    v_mfma_f32_16x16x32_bf16 v[80:83], a[0:3], a[72:75], v[80:83]
    buffer_load_dwordx4 a[200:203], v37, s[8:11], s62 offen sc1
    v_mfma_f32_16x16x32_bf16 v[80:83], a[4:7], a[76:79], v[80:83]
    ds_read_b64_tr_b16 a[36:37], v32 offset:49152
    v_mfma_f32_16x16x32_bf16 v[176:179], a[12:15], a[76:79], v[176:179]
    buffer_load_dwordx4 a[204:207], v55, s[8:11], s62 offen sc1
    v_mfma_f32_16x16x32_bf16 v[176:179], a[8:11], a[72:75], v[176:179]
    s_add_u32 s62, s62, 0x20000
    buffer_load_dwordx4 a[208:211], v36, s[8:11], s62 offen sc1
    ds_read_b64_tr_b16 a[38:39], v32 offset:51200
    v_mfma_f32_16x16x32_bf16 v[96:99], a[0:3], a[80:83], v[96:99]
    v_mfma_f32_16x16x32_bf16 v[96:99], a[4:7], a[84:87], v[96:99]
    v_cvt_pk_bf16_f32 v64, v64, v65
    v_cvt_pk_bf16_f32 v65, v66, v67
    v_mfma_f32_16x16x32_bf16 v[192:195], a[12:15], a[84:87], v[192:195]
    v_cvt_pk_bf16_f32 v66, v160, v161
    v_cvt_pk_bf16_f32 v67, v162, v163
    v_mfma_f32_16x16x32_bf16 v[192:195], a[8:11], a[80:83], v[192:195]
    buffer_load_dwordx4 a[212:215], v54, s[8:11], s62 offen sc1
    ds_read_b64_tr_b16 a[40:41], v33 offset:32768
    v_mfma_f32_16x16x32_bf16 v[112:115], a[0:3], a[88:91], v[112:115]
    buffer_load_dwordx4 a[216:219], v37, s[8:11], s62 offen sc1
    ds_read_b64_tr_b16 a[42:43], v33 offset:34816
    v_mfma_f32_16x16x32_bf16 v[112:115], a[4:7], a[92:95], v[112:115]
    v_cvt_pk_bf16_f32 v80, v80, v81
    v_cvt_pk_bf16_f32 v81, v82, v83
    v_mfma_f32_16x16x32_bf16 v[208:211], a[12:15], a[92:95], v[208:211]
    v_cvt_pk_bf16_f32 v82, v176, v177
    v_cvt_pk_bf16_f32 v83, v178, v179
    v_mfma_f32_16x16x32_bf16 v[208:211], a[8:11], a[88:91], v[208:211]
    buffer_load_dwordx4 a[220:223], v55, s[8:11], s62 offen sc1
    ds_read_b64_tr_b16 a[44:45], v33 offset:49152
    v_mfma_f32_16x16x32_bf16 v[128:131], a[0:3], a[96:99], v[128:131]
    s_add_u32 s62, s62, 0x20000
    buffer_load_dwordx4 a[224:227], v36, s[8:11], s62 offen sc1
    v_mfma_f32_16x16x32_bf16 v[128:131], a[4:7], a[100:103], v[128:131]
    v_cvt_pk_bf16_f32 v96, v96, v97
    v_cvt_pk_bf16_f32 v97, v98, v99
    v_mfma_f32_16x16x32_bf16 v[224:227], a[12:15], a[100:103], v[224:227]
    buffer_load_dwordx4 a[228:231], v54, s[8:11], s62 offen sc1
    ds_read_b64_tr_b16 a[46:47], v33 offset:51200
    v_mfma_f32_16x16x32_bf16 v[224:227], a[8:11], a[96:99], v[224:227]
    v_cvt_pk_bf16_f32 v98, v192, v193
    v_cvt_pk_bf16_f32 v99, v194, v195
    v_mfma_f32_16x16x32_bf16 v[144:147], a[0:3], a[104:107], v[144:147]
    buffer_load_dwordx4 a[232:235], v37, s[8:11], s62 offen sc1
    ds_read_b64_tr_b16 a[48:49], v34 offset:32768
    v_mfma_f32_16x16x32_bf16 v[144:147], a[4:7], a[108:111], v[144:147]
    v_cvt_pk_bf16_f32 v112, v112, v113
    v_cvt_pk_bf16_f32 v113, v114, v115
    v_mfma_f32_16x16x32_bf16 v[240:243], a[12:15], a[108:111], v[240:243]
    buffer_load_dwordx4 a[236:239], v55, s[8:11], s62 offen sc1
    ds_read_b64_tr_b16 a[50:51], v34 offset:34816
    v_mfma_f32_16x16x32_bf16 v[240:243], a[8:11], a[104:107], v[240:243]
    s_add_u32 s62, s62, 0x20000
    v_cvt_pk_bf16_f32 v114, v208, v209
    v_cvt_pk_bf16_f32 v115, v210, v211
    v_mfma_f32_16x16x32_bf16 a[128:131], a[0:3], a[112:115], a[128:131]
    buffer_load_dwordx4 a[240:243], v36, s[8:11], s62 offen sc1
    ds_read_b64_tr_b16 a[52:53], v34 offset:49152
    v_mfma_f32_16x16x32_bf16 a[128:131], a[4:7], a[116:119], a[128:131]
    v_cvt_pk_bf16_f32 v128, v128, v129
    v_cvt_pk_bf16_f32 v129, v130, v131
    v_mfma_f32_16x16x32_bf16 a[132:135], a[12:15], a[116:119], a[132:135]
    buffer_load_dwordx4 a[244:247], v54, s[8:11], s62 offen sc1
    buffer_load_dwordx4 a[248:251], v37, s[8:11], s62 offen sc1
    v_mfma_f32_16x16x32_bf16 a[132:135], a[8:11], a[112:115], a[132:135]
    v_cvt_pk_bf16_f32 v130, v224, v225
    v_cvt_pk_bf16_f32 v131, v226, v227
    v_mfma_f32_16x16x32_bf16 a[160:163], a[0:3], a[120:123], a[160:163]
    buffer_load_dwordx4 a[252:255], v55, s[8:11], s62 offen sc1
    ds_read_b64_tr_b16 a[54:55], v34 offset:51200
    v_mfma_f32_16x16x32_bf16 a[160:163], a[4:7], a[124:127], a[160:163]
    s_add_u32 s62, s62, 0x20000
    v_cvt_pk_bf16_f32 v144, v144, v145
    v_cvt_pk_bf16_f32 v145, v146, v147
    v_mfma_f32_16x16x32_bf16 a[164:167], a[12:15], a[124:127], a[164:167]
    ds_read_b64_tr_b16 a[56:57], v35 offset:32768
    v_cvt_pk_bf16_f32 v146, v240, v241
    v_mfma_f32_16x16x32_bf16 a[164:167], a[8:11], a[120:123], a[164:167]
    v_cvt_pk_bf16_f32 v147, v242, v243
    v_mfma_f32_16x16x32_bf16 v[68:71], a[16:19], a[64:67], v[68:71]
    s_add_u32 s52, s47, 0
    ds_read_b64_tr_b16 a[58:59], v35 offset:34816
    v_mfma_f32_16x16x32_bf16 v[68:71], a[20:23], a[68:71], v[68:71]
    v_accvgpr_read_b32 v56, a128
    v_accvgpr_read_b32 v57, a129
    v_mfma_f32_16x16x32_bf16 v[164:167], a[28:31], a[68:71], v[164:167]
    v_accvgpr_read_b32 v58, a130
    v_accvgpr_read_b32 v59, a131
    v_mfma_f32_16x16x32_bf16 v[164:167], a[24:27], a[64:67], v[164:167]
    buffer_store_dwordx4 v[64:67], v1, s[32:35], s52 offen offset:0 sc1
    ds_read_b64_tr_b16 a[60:61], v35 offset:49152
    v_mfma_f32_16x16x32_bf16 v[84:87], a[16:19], a[72:75], v[84:87]
    v_accvgpr_read_b32 v60, a132
    v_accvgpr_read_b32 v61, a133
    v_mfma_f32_16x16x32_bf16 v[84:87], a[20:23], a[76:79], v[84:87]
    v_accvgpr_read_b32 v62, a134
    v_accvgpr_read_b32 v63, a135
    v_mfma_f32_16x16x32_bf16 v[180:183], a[28:31], a[76:79], v[180:183]
    v_cvt_pk_bf16_f32 v160, v56, v57
    v_cvt_pk_bf16_f32 v161, v58, v59
    v_mfma_f32_16x16x32_bf16 v[180:183], a[24:27], a[72:75], v[180:183]
    ds_read_b64_tr_b16 a[62:63], v35 offset:51200
    v_cvt_pk_bf16_f32 v162, v60, v61
    v_mfma_f32_16x16x32_bf16 v[100:103], a[16:19], a[80:83], v[100:103]
    v_cvt_pk_bf16_f32 v163, v62, v63
    v_accvgpr_read_b32 v56, a160
    v_mfma_f32_16x16x32_bf16 v[100:103], a[20:23], a[84:87], v[100:103]
    v_accvgpr_read_b32 v57, a161
    v_accvgpr_read_b32 v58, a162
    v_mfma_f32_16x16x32_bf16 v[196:199], a[28:31], a[84:87], v[196:199]
    v_accvgpr_read_b32 v59, a163
    v_accvgpr_read_b32 v60, a164
    v_mfma_f32_16x16x32_bf16 v[196:199], a[24:27], a[80:83], v[196:199]
    s_add_u32 s52, s47, 8192
    v_accvgpr_read_b32 v61, a165
    v_accvgpr_read_b32 v62, a166
    v_mfma_f32_16x16x32_bf16 v[116:119], a[16:19], a[88:91], v[116:119]
    v_accvgpr_read_b32 v63, a167
    v_cvt_pk_bf16_f32 v176, v56, v57
    v_mfma_f32_16x16x32_bf16 v[116:119], a[20:23], a[92:95], v[116:119]
    v_cvt_pk_bf16_f32 v177, v58, v59
    v_cvt_pk_bf16_f32 v68, v68, v69
    v_mfma_f32_16x16x32_bf16 v[212:215], a[28:31], a[92:95], v[212:215]
    v_cvt_pk_bf16_f32 v178, v60, v61
    v_cvt_pk_bf16_f32 v69, v70, v71
    v_mfma_f32_16x16x32_bf16 v[212:215], a[24:27], a[88:91], v[212:215]
    v_cvt_pk_bf16_f32 v179, v62, v63
    v_cvt_pk_bf16_f32 v70, v164, v165
    v_mfma_f32_16x16x32_bf16 v[132:135], a[16:19], a[96:99], v[132:135]
    v_cvt_pk_bf16_f32 v71, v166, v167
    v_cvt_pk_bf16_f32 v84, v84, v85
    v_mfma_f32_16x16x32_bf16 v[132:135], a[20:23], a[100:103], v[132:135]
    buffer_store_dwordx4 v[96:99], v1, s[32:35], s52 offen offset:0 sc1
    v_cvt_pk_bf16_f32 v85, v86, v87
    v_mfma_f32_16x16x32_bf16 v[228:231], a[28:31], a[100:103], v[228:231]
    v_cvt_pk_bf16_f32 v86, v180, v181
    v_cvt_pk_bf16_f32 v87, v182, v183
    v_mfma_f32_16x16x32_bf16 v[228:231], a[24:27], a[96:99], v[228:231]
    v_cvt_pk_bf16_f32 v100, v100, v101
    v_cvt_pk_bf16_f32 v101, v102, v103
    v_mfma_f32_16x16x32_bf16 v[148:151], a[16:19], a[104:107], v[148:151]
    v_cvt_pk_bf16_f32 v102, v196, v197
    v_cvt_pk_bf16_f32 v103, v198, v199
    v_mfma_f32_16x16x32_bf16 v[148:151], a[20:23], a[108:111], v[148:151]
    v_cvt_pk_bf16_f32 v116, v116, v117
    v_cvt_pk_bf16_f32 v117, v118, v119
    v_mfma_f32_16x16x32_bf16 v[244:247], a[28:31], a[108:111], v[244:247]
    v_cvt_pk_bf16_f32 v118, v212, v213
    v_cvt_pk_bf16_f32 v119, v214, v215
    v_mfma_f32_16x16x32_bf16 v[244:247], a[24:27], a[104:107], v[244:247]
    s_add_u32 s52, s47, 524288
    v_mfma_f32_16x16x32_bf16 a[136:139], a[16:19], a[112:115], a[136:139]
    buffer_store_dwordx4 v[128:131], v1, s[32:35], s52 offen offset:0 sc1
    v_mfma_f32_16x16x32_bf16 a[136:139], a[20:23], a[116:119], a[136:139]
    v_cvt_pk_bf16_f32 v132, v132, v133
    v_cvt_pk_bf16_f32 v133, v134, v135
    v_mfma_f32_16x16x32_bf16 a[140:143], a[28:31], a[116:119], a[140:143]
    v_cvt_pk_bf16_f32 v134, v228, v229
    v_cvt_pk_bf16_f32 v135, v230, v231
    v_mfma_f32_16x16x32_bf16 a[140:143], a[24:27], a[112:115], a[140:143]
    v_mfma_f32_16x16x32_bf16 a[168:171], a[16:19], a[120:123], a[168:171]
    s_waitcnt lgkmcnt(0)
    v_mfma_f32_16x16x32_bf16 a[168:171], a[20:23], a[124:127], a[168:171]
    v_cvt_pk_bf16_f32 v148, v148, v149
    v_cvt_pk_bf16_f32 v149, v150, v151
    v_mfma_f32_16x16x32_bf16 a[172:175], a[28:31], a[124:127], a[172:175]
    v_cvt_pk_bf16_f32 v150, v244, v245
    v_cvt_pk_bf16_f32 v151, v246, v247
    v_mfma_f32_16x16x32_bf16 a[172:175], a[24:27], a[120:123], a[172:175]
    v_mfma_f32_16x16x32_bf16 v[72:75], a[32:35], a[64:67], v[72:75]
    v_mfma_f32_16x16x32_bf16 v[72:75], a[36:39], a[68:71], v[72:75]
    v_accvgpr_read_b32 v56, a136
    v_accvgpr_read_b32 v57, a137
    v_mfma_f32_16x16x32_bf16 v[168:171], a[44:47], a[68:71], v[168:171]
    s_add_u32 s52, s47, 532480
    v_accvgpr_read_b32 v58, a138
    v_accvgpr_read_b32 v59, a139
    v_mfma_f32_16x16x32_bf16 v[168:171], a[40:43], a[64:67], v[168:171]
    v_accvgpr_read_b32 v60, a140
    v_accvgpr_read_b32 v61, a141
    v_mfma_f32_16x16x32_bf16 v[88:91], a[32:35], a[72:75], v[88:91]
    v_accvgpr_read_b32 v62, a142
    v_accvgpr_read_b32 v63, a143
    v_mfma_f32_16x16x32_bf16 v[88:91], a[36:39], a[76:79], v[88:91]
    v_cvt_pk_bf16_f32 v164, v56, v57
    v_cvt_pk_bf16_f32 v165, v58, v59
    v_mfma_f32_16x16x32_bf16 v[184:187], a[44:47], a[76:79], v[184:187]
    buffer_store_dwordx4 v[160:163], v1, s[32:35], s52 offen offset:0 sc1
    v_mfma_f32_16x16x32_bf16 v[184:187], a[40:43], a[72:75], v[184:187]
    v_cvt_pk_bf16_f32 v166, v60, v61
    v_cvt_pk_bf16_f32 v167, v62, v63
    v_mfma_f32_16x16x32_bf16 v[104:107], a[32:35], a[80:83], v[104:107]
    v_accvgpr_read_b32 v56, a168
    v_accvgpr_read_b32 v57, a169
    v_mfma_f32_16x16x32_bf16 v[104:107], a[36:39], a[84:87], v[104:107]
    v_accvgpr_read_b32 v58, a170
    v_accvgpr_read_b32 v59, a171
    v_mfma_f32_16x16x32_bf16 v[200:203], a[44:47], a[84:87], v[200:203]
    v_accvgpr_read_b32 v60, a172
    v_accvgpr_read_b32 v61, a173
    v_mfma_f32_16x16x32_bf16 v[200:203], a[40:43], a[80:83], v[200:203]
    v_accvgpr_read_b32 v62, a174
    v_accvgpr_read_b32 v63, a175
    v_mfma_f32_16x16x32_bf16 v[120:123], a[32:35], a[88:91], v[120:123]
    v_cvt_pk_bf16_f32 v180, v56, v57
    v_cvt_pk_bf16_f32 v181, v58, v59
    v_mfma_f32_16x16x32_bf16 v[120:123], a[36:39], a[92:95], v[120:123]
    v_cvt_pk_bf16_f32 v72, v72, v73
    v_cvt_pk_bf16_f32 v182, v60, v61
    v_mfma_f32_16x16x32_bf16 v[216:219], a[44:47], a[92:95], v[216:219]
    s_add_u32 s52, s47, 0
    v_cvt_pk_bf16_f32 v73, v74, v75
    v_cvt_pk_bf16_f32 v183, v62, v63
    v_mfma_f32_16x16x32_bf16 v[216:219], a[40:43], a[88:91], v[216:219]
    v_cvt_pk_bf16_f32 v74, v168, v169
    v_cvt_pk_bf16_f32 v75, v170, v171
    v_mfma_f32_16x16x32_bf16 v[136:139], a[32:35], a[96:99], v[136:139]
    v_cvt_pk_bf16_f32 v88, v88, v89
    v_cvt_pk_bf16_f32 v89, v90, v91
    v_mfma_f32_16x16x32_bf16 v[136:139], a[36:39], a[100:103], v[136:139]
    v_cvt_pk_bf16_f32 v90, v184, v185
    v_cvt_pk_bf16_f32 v91, v186, v187
    v_mfma_f32_16x16x32_bf16 v[232:235], a[44:47], a[100:103], v[232:235]
    buffer_store_dwordx4 v[68:71], v1, s[32:35], s52 offen offset:1024 sc1
    v_mfma_f32_16x16x32_bf16 v[232:235], a[40:43], a[96:99], v[232:235]
    v_cvt_pk_bf16_f32 v104, v104, v105
    v_cvt_pk_bf16_f32 v105, v106, v107
    v_mfma_f32_16x16x32_bf16 v[152:155], a[32:35], a[104:107], v[152:155]
    v_cvt_pk_bf16_f32 v106, v200, v201
    v_cvt_pk_bf16_f32 v107, v202, v203
    v_mfma_f32_16x16x32_bf16 v[152:155], a[36:39], a[108:111], v[152:155]
    v_cvt_pk_bf16_f32 v120, v120, v121
    v_cvt_pk_bf16_f32 v121, v122, v123
    v_mfma_f32_16x16x32_bf16 v[248:251], a[44:47], a[108:111], v[248:251]
    v_cvt_pk_bf16_f32 v122, v216, v217
    v_cvt_pk_bf16_f32 v123, v218, v219
    v_mfma_f32_16x16x32_bf16 v[248:251], a[40:43], a[104:107], v[248:251]
    v_mfma_f32_16x16x32_bf16 a[144:147], a[32:35], a[112:115], a[144:147]
    v_mfma_f32_16x16x32_bf16 a[144:147], a[36:39], a[116:119], a[144:147]
    s_add_u32 s52, s47, 8192
    v_cvt_pk_bf16_f32 v136, v136, v137
    v_cvt_pk_bf16_f32 v137, v138, v139
    v_mfma_f32_16x16x32_bf16 a[148:151], a[44:47], a[116:119], a[148:151]
    v_cvt_pk_bf16_f32 v138, v232, v233
    v_cvt_pk_bf16_f32 v139, v234, v235
    v_mfma_f32_16x16x32_bf16 a[148:151], a[40:43], a[112:115], a[148:151]
    buffer_store_dwordx4 v[100:103], v1, s[32:35], s52 offen offset:1024 sc1
    v_mfma_f32_16x16x32_bf16 a[176:179], a[32:35], a[120:123], a[176:179]
    v_mfma_f32_16x16x32_bf16 a[176:179], a[36:39], a[124:127], a[176:179]
    v_cvt_pk_bf16_f32 v152, v152, v153
    v_cvt_pk_bf16_f32 v153, v154, v155
    v_mfma_f32_16x16x32_bf16 a[180:183], a[44:47], a[124:127], a[180:183]
    v_cvt_pk_bf16_f32 v154, v248, v249
    v_cvt_pk_bf16_f32 v155, v250, v251
    v_mfma_f32_16x16x32_bf16 a[180:183], a[40:43], a[120:123], a[180:183]
    v_mfma_f32_16x16x32_bf16 v[76:79], a[48:51], a[64:67], v[76:79]
    s_waitcnt vmcnt(16)
    s_barrier
    v_mfma_f32_16x16x32_bf16 v[76:79], a[52:55], a[68:71], v[76:79]
    ds_read_b64_tr_b16 a[0:1], v42 offset:32768
    v_accvgpr_read_b32 v56, a144
    v_mfma_f32_16x16x32_bf16 v[172:175], a[60:63], a[68:71], v[172:175]
    v_accvgpr_read_b32 v57, a145
    v_accvgpr_read_b32 v58, a146
    v_mfma_f32_16x16x32_bf16 v[172:175], a[56:59], a[64:67], v[172:175]
    ds_read_b64_tr_b16 a[2:3], v42 offset:33792
    v_accvgpr_read_b32 v59, a147
    v_mfma_f32_16x16x32_bf16 v[92:95], a[48:51], a[72:75], v[92:95]
    v_accvgpr_read_b32 v60, a148
    v_accvgpr_read_b32 v61, a149
    v_mfma_f32_16x16x32_bf16 v[92:95], a[52:55], a[76:79], v[92:95]
    s_add_u32 s52, s47, 524288
    ds_read_b64_tr_b16 a[4:5], v42 offset:40960
    v_accvgpr_read_b32 v62, a150
    v_mfma_f32_16x16x32_bf16 v[188:191], a[60:63], a[76:79], v[188:191]
    v_accvgpr_read_b32 v63, a151
    v_cvt_pk_bf16_f32 v168, v56, v57
    v_mfma_f32_16x16x32_bf16 v[188:191], a[56:59], a[72:75], v[188:191]
    v_cvt_pk_bf16_f32 v169, v58, v59
    v_cvt_pk_bf16_f32 v170, v60, v61
    v_mfma_f32_16x16x32_bf16 v[108:111], a[48:51], a[80:83], v[108:111]
    ds_read_b64_tr_b16 a[6:7], v42 offset:41984
    v_cvt_pk_bf16_f32 v171, v62, v63
    v_mfma_f32_16x16x32_bf16 v[108:111], a[52:55], a[84:87], v[108:111]
    v_accvgpr_read_b32 v56, a176
    v_accvgpr_read_b32 v57, a177
    v_mfma_f32_16x16x32_bf16 v[204:207], a[60:63], a[84:87], v[204:207]
    v_accvgpr_read_b32 v58, a178
    v_accvgpr_read_b32 v59, a179
    v_mfma_f32_16x16x32_bf16 v[204:207], a[56:59], a[80:83], v[204:207]
    ds_read_b64_tr_b16 a[8:9], v43 offset:32768
    v_accvgpr_read_b32 v60, a180
    v_mfma_f32_16x16x32_bf16 v[124:127], a[48:51], a[88:91], v[124:127]
    buffer_store_dwordx4 v[132:135], v1, s[32:35], s52 offen offset:1024 sc1
    v_accvgpr_read_b32 v61, a181
    v_mfma_f32_16x16x32_bf16 v[124:127], a[52:55], a[92:95], v[124:127]
    v_accvgpr_read_b32 v62, a182
    v_accvgpr_read_b32 v63, a183
    v_mfma_f32_16x16x32_bf16 v[220:223], a[60:63], a[92:95], v[220:223]
    ds_read_b64_tr_b16 a[10:11], v43 offset:33792
    v_cvt_pk_bf16_f32 v184, v56, v57
    v_mfma_f32_16x16x32_bf16 v[220:223], a[56:59], a[88:91], v[220:223]
    v_cvt_pk_bf16_f32 v185, v58, v59
    v_cvt_pk_bf16_f32 v76, v76, v77
    v_mfma_f32_16x16x32_bf16 v[140:143], a[48:51], a[96:99], v[140:143]
    s_add_u32 s52, s47, 532480
    v_cvt_pk_bf16_f32 v186, v60, v61
    v_cvt_pk_bf16_f32 v77, v78, v79
    v_mfma_f32_16x16x32_bf16 v[140:143], a[52:55], a[100:103], v[140:143]
    ds_read_b64_tr_b16 a[12:13], v43 offset:40960
    v_cvt_pk_bf16_f32 v187, v62, v63
    v_mfma_f32_16x16x32_bf16 v[236:239], a[60:63], a[100:103], v[236:239]
    v_cvt_pk_bf16_f32 v78, v172, v173
    v_cvt_pk_bf16_f32 v79, v174, v175
    v_mfma_f32_16x16x32_bf16 v[236:239], a[56:59], a[96:99], v[236:239]
    ds_read_b64_tr_b16 a[14:15], v43 offset:41984
    ds_read_b64_tr_b16 a[16:17], v44 offset:32768
    v_mfma_f32_16x16x32_bf16 v[156:159], a[48:51], a[104:107], v[156:159]
    v_cvt_pk_bf16_f32 v92, v92, v93
    v_cvt_pk_bf16_f32 v93, v94, v95
    v_mfma_f32_16x16x32_bf16 v[156:159], a[52:55], a[108:111], v[156:159]
    ds_read_b64_tr_b16 a[18:19], v44 offset:33792
    v_cvt_pk_bf16_f32 v94, v188, v189
    v_mfma_f32_16x16x32_bf16 v[252:255], a[60:63], a[108:111], v[252:255]
    ds_read_b64_tr_b16 a[20:21], v44 offset:40960
    v_cvt_pk_bf16_f32 v95, v190, v191
    v_mfma_f32_16x16x32_bf16 v[252:255], a[56:59], a[104:107], v[252:255]
    ds_read_b64_tr_b16 a[22:23], v44 offset:41984
    v_cvt_pk_bf16_f32 v108, v108, v109
    v_mfma_f32_16x16x32_bf16 a[152:155], a[48:51], a[112:115], a[152:155]
    v_cvt_pk_bf16_f32 v109, v110, v111
    v_cvt_pk_bf16_f32 v110, v204, v205
    v_mfma_f32_16x16x32_bf16 a[152:155], a[52:55], a[116:119], a[152:155]
    ds_read_b64_tr_b16 a[24:25], v45 offset:32768
    v_cvt_pk_bf16_f32 v111, v206, v207
    v_mfma_f32_16x16x32_bf16 a[156:159], a[60:63], a[116:119], a[156:159]
    buffer_store_dwordx4 v[164:167], v1, s[32:35], s52 offen offset:1024 sc1
    ds_read_b64_tr_b16 a[26:27], v45 offset:33792
    v_mfma_f32_16x16x32_bf16 a[156:159], a[56:59], a[112:115], a[156:159]
    ds_read_b64_tr_b16 a[28:29], v45 offset:40960
    v_cvt_pk_bf16_f32 v124, v124, v125
    v_mfma_f32_16x16x32_bf16 a[184:187], a[48:51], a[120:123], a[184:187]
    v_cvt_pk_bf16_f32 v125, v126, v127
    v_cvt_pk_bf16_f32 v126, v220, v221
    v_mfma_f32_16x16x32_bf16 a[184:187], a[52:55], a[124:127], a[184:187]
    ds_read_b64_tr_b16 a[30:31], v45 offset:41984
    v_cvt_pk_bf16_f32 v127, v222, v223
    v_mfma_f32_16x16x32_bf16 a[188:191], a[60:63], a[124:127], a[188:191]
    v_cvt_pk_bf16_f32 v140, v140, v141
    v_cvt_pk_bf16_f32 v141, v142, v143
    v_mfma_f32_16x16x32_bf16 a[188:191], a[56:59], a[120:123], a[188:191]
    v_cvt_pk_bf16_f32 v142, v236, v237
    v_cvt_pk_bf16_f32 v143, v238, v239
    v_cvt_pk_bf16_f32 v156, v156, v157
    v_cvt_pk_bf16_f32 v157, v158, v159
    v_cvt_pk_bf16_f32 v158, v252, v253
    v_cvt_pk_bf16_f32 v159, v254, v255
    v_accvgpr_read_b32 v56, a152
    v_accvgpr_read_b32 v57, a153
    v_accvgpr_read_b32 v58, a154
    v_accvgpr_read_b32 v59, a155
    v_accvgpr_read_b32 v60, a156
    v_accvgpr_read_b32 v61, a157
    v_accvgpr_read_b32 v62, a158
    v_accvgpr_read_b32 v63, a159
    v_cvt_pk_bf16_f32 v172, v56, v57
    v_cvt_pk_bf16_f32 v173, v58, v59
    v_cvt_pk_bf16_f32 v174, v60, v61
    v_cvt_pk_bf16_f32 v175, v62, v63
    v_accvgpr_read_b32 v56, a184
    v_accvgpr_read_b32 v57, a185
    v_accvgpr_read_b32 v58, a186
    v_accvgpr_read_b32 v59, a187
    v_accvgpr_read_b32 v60, a188
    v_accvgpr_read_b32 v61, a189
    v_accvgpr_read_b32 v62, a190
    v_accvgpr_read_b32 v63, a191
    v_cvt_pk_bf16_f32 v188, v56, v57
    v_cvt_pk_bf16_f32 v189, v58, v59
    v_cvt_pk_bf16_f32 v190, v60, v61
    v_cvt_pk_bf16_f32 v191, v62, v63
    s_branch k12_join_7
k12_v_6:
k12_loop_28:
    v_mfma_f32_16x16x32_bf16 v[64:67], a[192:195], a[0:3], v[64:67]
    v_mfma_f32_16x16x32_bf16 v[64:67], a[196:199], a[4:7], v[64:67]
    ds_read_b64_tr_b16 a[32:33], v32 offset:0
    v_mfma_f32_16x16x32_bf16 v[160:163], a[204:207], a[4:7], v[160:163]
    v_mfma_f32_16x16x32_bf16 v[160:163], a[200:203], a[0:3], v[160:163]
    ds_read_b64_tr_b16 a[34:35], v32 offset:2048
    v_mfma_f32_16x16x32_bf16 v[96:99], a[208:211], a[0:3], v[96:99]
    s_cmp_eq_u32 s51, s46
    s_cbranch_scc1 k12_ool_30
k12_oolret_31:
    v_mfma_f32_16x16x32_bf16 v[96:99], a[212:215], a[4:7], v[96:99]
    v_mfma_f32_16x16x32_bf16 v[192:195], a[220:223], a[4:7], v[192:195]
    ds_read_b64_tr_b16 a[36:37], v32 offset:16384
    v_mfma_f32_16x16x32_bf16 v[192:195], a[216:219], a[0:3], v[192:195]
    v_mfma_f32_16x16x32_bf16 v[128:131], a[224:227], a[0:3], v[128:131]
    v_mfma_f32_16x16x32_bf16 v[128:131], a[228:231], a[4:7], v[128:131]
    ds_read_b64_tr_b16 a[38:39], v32 offset:18432
    v_mfma_f32_16x16x32_bf16 v[224:227], a[236:239], a[4:7], v[224:227]
    v_mfma_f32_16x16x32_bf16 v[224:227], a[232:235], a[0:3], v[224:227]
    v_mfma_f32_16x16x32_bf16 a[128:131], a[240:243], a[0:3], a[128:131]
    ds_read_b64_tr_b16 a[40:41], v33 offset:0
    v_mfma_f32_16x16x32_bf16 a[128:131], a[244:247], a[4:7], a[128:131]
    v_mfma_f32_16x16x32_bf16 a[132:135], a[252:255], a[4:7], a[132:135]
    v_mfma_f32_16x16x32_bf16 a[132:135], a[248:251], a[0:3], a[132:135]
    ds_read_b64_tr_b16 a[42:43], v33 offset:2048
    v_mfma_f32_16x16x32_bf16 a[140:143], a[248:251], a[8:11], a[140:143]
    v_mfma_f32_16x16x32_bf16 a[140:143], a[252:255], a[12:15], a[140:143]
    v_mfma_f32_16x16x32_bf16 a[136:139], a[244:247], a[12:15], a[136:139]
    ds_read_b64_tr_b16 a[44:45], v33 offset:16384
    v_mfma_f32_16x16x32_bf16 a[136:139], a[240:243], a[8:11], a[136:139]
    v_mfma_f32_16x16x32_bf16 v[228:231], a[232:235], a[8:11], v[228:231]
    v_mfma_f32_16x16x32_bf16 v[228:231], a[236:239], a[12:15], v[228:231]
    ds_read_b64_tr_b16 a[46:47], v33 offset:18432
    v_mfma_f32_16x16x32_bf16 v[132:135], a[228:231], a[12:15], v[132:135]
    v_mfma_f32_16x16x32_bf16 v[132:135], a[224:227], a[8:11], v[132:135]
    ds_read_b64_tr_b16 a[48:49], v34 offset:0
    v_mfma_f32_16x16x32_bf16 v[196:199], a[216:219], a[8:11], v[196:199]
    v_mfma_f32_16x16x32_bf16 v[196:199], a[220:223], a[12:15], v[196:199]
    v_mfma_f32_16x16x32_bf16 v[100:103], a[212:215], a[12:15], v[100:103]
    ds_read_b64_tr_b16 a[50:51], v34 offset:2048
    v_mfma_f32_16x16x32_bf16 v[100:103], a[208:211], a[8:11], v[100:103]
    v_mfma_f32_16x16x32_bf16 v[164:167], a[200:203], a[8:11], v[164:167]
    v_mfma_f32_16x16x32_bf16 v[164:167], a[204:207], a[12:15], v[164:167]
    ds_read_b64_tr_b16 a[52:53], v34 offset:16384
    v_mfma_f32_16x16x32_bf16 v[68:71], a[196:199], a[12:15], v[68:71]
    v_mfma_f32_16x16x32_bf16 v[68:71], a[192:195], a[8:11], v[68:71]
    v_mfma_f32_16x16x32_bf16 v[72:75], a[192:195], a[16:19], v[72:75]
    ds_read_b64_tr_b16 a[54:55], v34 offset:18432
    v_mfma_f32_16x16x32_bf16 v[72:75], a[196:199], a[20:23], v[72:75]
    v_mfma_f32_16x16x32_bf16 v[168:171], a[204:207], a[20:23], v[168:171]
    v_mfma_f32_16x16x32_bf16 v[168:171], a[200:203], a[16:19], v[168:171]
    ds_read_b64_tr_b16 a[56:57], v35 offset:0
    v_mfma_f32_16x16x32_bf16 v[104:107], a[208:211], a[16:19], v[104:107]
    v_mfma_f32_16x16x32_bf16 v[104:107], a[212:215], a[20:23], v[104:107]
    v_mfma_f32_16x16x32_bf16 v[200:203], a[220:223], a[20:23], v[200:203]
    ds_read_b64_tr_b16 a[58:59], v35 offset:2048
    v_mfma_f32_16x16x32_bf16 v[200:203], a[216:219], a[16:19], v[200:203]
    v_mfma_f32_16x16x32_bf16 v[136:139], a[224:227], a[16:19], v[136:139]
    v_mfma_f32_16x16x32_bf16 v[136:139], a[228:231], a[20:23], v[136:139]
    ds_read_b64_tr_b16 a[60:61], v35 offset:16384
    v_mfma_f32_16x16x32_bf16 v[232:235], a[236:239], a[20:23], v[232:235]
    v_mfma_f32_16x16x32_bf16 v[232:235], a[232:235], a[16:19], v[232:235]
    v_mfma_f32_16x16x32_bf16 a[144:147], a[240:243], a[16:19], a[144:147]
    ds_read_b64_tr_b16 a[62:63], v35 offset:18432
    v_mfma_f32_16x16x32_bf16 a[144:147], a[244:247], a[20:23], a[144:147]
    v_mfma_f32_16x16x32_bf16 a[148:151], a[252:255], a[20:23], a[148:151]
    v_mfma_f32_16x16x32_bf16 a[148:151], a[248:251], a[16:19], a[148:151]
    v_mfma_f32_16x16x32_bf16 a[156:159], a[248:251], a[24:27], a[156:159]
    v_mfma_f32_16x16x32_bf16 a[156:159], a[252:255], a[28:31], a[156:159]
    v_mfma_f32_16x16x32_bf16 a[152:155], a[244:247], a[28:31], a[152:155]
    v_mfma_f32_16x16x32_bf16 a[152:155], a[240:243], a[24:27], a[152:155]
    v_mfma_f32_16x16x32_bf16 v[236:239], a[232:235], a[24:27], v[236:239]
    v_mfma_f32_16x16x32_bf16 v[236:239], a[236:239], a[28:31], v[236:239]
    v_mfma_f32_16x16x32_bf16 v[140:143], a[228:231], a[28:31], v[140:143]
    v_mfma_f32_16x16x32_bf16 v[140:143], a[224:227], a[24:27], v[140:143]
    v_mfma_f32_16x16x32_bf16 v[204:207], a[216:219], a[24:27], v[204:207]
    v_mfma_f32_16x16x32_bf16 v[204:207], a[220:223], a[28:31], v[204:207]
    v_mfma_f32_16x16x32_bf16 v[108:111], a[212:215], a[28:31], v[108:111]
    v_mfma_f32_16x16x32_bf16 v[108:111], a[208:211], a[24:27], v[108:111]
    v_mfma_f32_16x16x32_bf16 v[172:175], a[200:203], a[24:27], v[172:175]
    v_mfma_f32_16x16x32_bf16 v[172:175], a[204:207], a[28:31], v[172:175]
    v_mfma_f32_16x16x32_bf16 v[76:79], a[196:199], a[28:31], v[76:79]
    v_mfma_f32_16x16x32_bf16 v[76:79], a[192:195], a[24:27], v[76:79]
    s_waitcnt vmcnt(0) lgkmcnt(0)
    s_cmp_eq_u32 s51, s46
    s_cbranch_scc1 k12_ool_34
k12_oolret_35:
    s_barrier
    v_mfma_f32_16x16x32_bf16 v[80:83], a[192:195], a[32:35], v[80:83]
    s_cmp_ge_u32 s49, 1024
    s_cselect_b32 s18, 0, s18
    s_cselect_b32 s22, 0, s22
    v_mfma_f32_16x16x32_bf16 v[80:83], a[196:199], a[36:39], v[80:83]
    s_add_u32 m0, s48, 0
    ds_read_b128 a[64:67], v26 offset:32768
    v_mfma_f32_16x16x32_bf16 v[176:179], a[204:207], a[36:39], v[176:179]
    buffer_load_dwordx4 v10, s[16:19], s49 offen offset:0 lds
    ds_read_b64_tr_b16 a[0:1], v28 offset:32768
    v_mfma_f32_16x16x32_bf16 v[176:179], a[200:203], a[32:35], v[176:179]
    ds_read_b128 a[68:71], v27 offset:32768
    v_mfma_f32_16x16x32_bf16 v[112:115], a[208:211], a[32:35], v[112:115]
    buffer_load_dwordx4 v11, s[16:19], s49 offen offset:1024 lds
    v_mfma_f32_16x16x32_bf16 v[112:115], a[212:215], a[36:39], v[112:115]
    ds_read_b64_tr_b16 a[2:3], v28 offset:34816
    v_mfma_f32_16x16x32_bf16 v[208:211], a[220:223], a[36:39], v[208:211]
    v_mfma_f32_16x16x32_bf16 v[208:211], a[216:219], a[32:35], v[208:211]
    ds_read_b128 a[72:75], v26 offset:34816
    v_mfma_f32_16x16x32_bf16 v[144:147], a[224:227], a[32:35], v[144:147]
    buffer_load_dwordx4 v12, s[16:19], s49 offen offset:2048 lds
    ds_read_b64_tr_b16 a[4:5], v28 offset:49152
    v_mfma_f32_16x16x32_bf16 v[144:147], a[228:231], a[36:39], v[144:147]
    v_mfma_f32_16x16x32_bf16 v[240:243], a[236:239], a[36:39], v[240:243]
    ds_read_b128 a[76:79], v27 offset:34816
    v_mfma_f32_16x16x32_bf16 v[240:243], a[232:235], a[32:35], v[240:243]
    buffer_load_dwordx4 v13, s[16:19], s49 offen offset:3072 lds
    v_mfma_f32_16x16x32_bf16 a[160:163], a[240:243], a[32:35], a[160:163]
    ds_read_b64_tr_b16 a[6:7], v28 offset:51200
    v_mfma_f32_16x16x32_bf16 a[160:163], a[244:247], a[36:39], a[160:163]
    s_add_u32 m0, s48, 4096
    ds_read_b128 a[80:83], v26 offset:36864
    v_mfma_f32_16x16x32_bf16 a[164:167], a[252:255], a[36:39], a[164:167]
    v_mfma_f32_16x16x32_bf16 a[164:167], a[248:251], a[32:35], a[164:167]
    buffer_load_dwordx4 v14, s[16:19], s49 offen offset:0 lds
    ds_read_b64_tr_b16 a[8:9], v29 offset:32768
    v_mfma_f32_16x16x32_bf16 a[172:175], a[248:251], a[40:43], a[172:175]
    v_mfma_f32_16x16x32_bf16 a[172:175], a[252:255], a[44:47], a[172:175]
    ds_read_b128 a[84:87], v27 offset:36864
    v_mfma_f32_16x16x32_bf16 a[168:171], a[244:247], a[44:47], a[168:171]
    buffer_load_dwordx4 v15, s[16:19], s49 offen offset:1024 lds
    ds_read_b64_tr_b16 a[10:11], v29 offset:34816
    v_mfma_f32_16x16x32_bf16 a[168:171], a[240:243], a[40:43], a[168:171]
    v_mfma_f32_16x16x32_bf16 v[244:247], a[232:235], a[40:43], v[244:247]
    ds_read_b128 a[88:91], v26 offset:38912
    v_mfma_f32_16x16x32_bf16 v[244:247], a[236:239], a[44:47], v[244:247]
    v_mfma_f32_16x16x32_bf16 v[148:151], a[228:231], a[44:47], v[148:151]
    buffer_load_dwordx4 v16, s[16:19], s49 offen offset:2048 lds
    ds_read_b64_tr_b16 a[12:13], v29 offset:49152
    v_mfma_f32_16x16x32_bf16 v[148:151], a[224:227], a[40:43], v[148:151]
    ds_read_b128 a[92:95], v27 offset:38912
    v_mfma_f32_16x16x32_bf16 v[212:215], a[216:219], a[40:43], v[212:215]
    v_mfma_f32_16x16x32_bf16 v[212:215], a[220:223], a[44:47], v[212:215]
    buffer_load_dwordx4 v17, s[16:19], s49 offen offset:3072 lds
    ds_read_b64_tr_b16 a[14:15], v29 offset:51200
    v_mfma_f32_16x16x32_bf16 v[116:119], a[212:215], a[44:47], v[116:119]
    ds_read_b128 a[96:99], v26 offset:40960
    v_mfma_f32_16x16x32_bf16 v[116:119], a[208:211], a[40:43], v[116:119]
    s_add_u32 s49, s49, 128
    v_mfma_f32_16x16x32_bf16 v[180:183], a[200:203], a[40:43], v[180:183]
    s_add_u32 m0, s48, 65536
    ds_read_b64_tr_b16 a[16:17], v30 offset:32768
    v_mfma_f32_16x16x32_bf16 v[180:183], a[204:207], a[44:47], v[180:183]
    buffer_load_dwordx4 v18, s[20:23], s50 offen offset:0 lds
    v_mfma_f32_16x16x32_bf16 v[84:87], a[196:199], a[44:47], v[84:87]
    ds_read_b128 a[100:103], v27 offset:40960
    v_mfma_f32_16x16x32_bf16 v[84:87], a[192:195], a[40:43], v[84:87]
    ds_read_b64_tr_b16 a[18:19], v30 offset:34816
    v_mfma_f32_16x16x32_bf16 v[88:91], a[192:195], a[48:51], v[88:91]
    buffer_load_dwordx4 v19, s[20:23], s50 offen offset:1024 lds
    v_mfma_f32_16x16x32_bf16 v[88:91], a[196:199], a[52:55], v[88:91]
    ds_read_b128 a[104:107], v26 offset:43008
    v_mfma_f32_16x16x32_bf16 v[184:187], a[204:207], a[52:55], v[184:187]
    v_mfma_f32_16x16x32_bf16 v[184:187], a[200:203], a[48:51], v[184:187]
    buffer_load_dwordx4 v20, s[20:23], s50 offen offset:2048 lds
    ds_read_b64_tr_b16 a[20:21], v30 offset:49152
    v_mfma_f32_16x16x32_bf16 v[120:123], a[208:211], a[48:51], v[120:123]
    ds_read_b128 a[108:111], v27 offset:43008
    v_mfma_f32_16x16x32_bf16 v[120:123], a[212:215], a[52:55], v[120:123]
    v_mfma_f32_16x16x32_bf16 v[216:219], a[220:223], a[52:55], v[216:219]
    ds_read_b64_tr_b16 a[22:23], v30 offset:51200
    v_mfma_f32_16x16x32_bf16 v[216:219], a[216:219], a[48:51], v[216:219]
    buffer_load_dwordx4 v21, s[20:23], s50 offen offset:3072 lds
    v_mfma_f32_16x16x32_bf16 v[152:155], a[224:227], a[48:51], v[152:155]
    s_add_u32 m0, s48, 69632
    ds_read_b128 a[112:115], v26 offset:45056
    v_mfma_f32_16x16x32_bf16 v[152:155], a[228:231], a[52:55], v[152:155]
    ds_read_b64_tr_b16 a[24:25], v31 offset:32768
    v_mfma_f32_16x16x32_bf16 v[248:251], a[236:239], a[52:55], v[248:251]
    buffer_load_dwordx4 v22, s[20:23], s50 offen offset:0 lds
    v_mfma_f32_16x16x32_bf16 v[248:251], a[232:235], a[48:51], v[248:251]
    ds_read_b128 a[116:119], v27 offset:45056
    v_mfma_f32_16x16x32_bf16 a[176:179], a[240:243], a[48:51], a[176:179]
    v_mfma_f32_16x16x32_bf16 a[176:179], a[244:247], a[52:55], a[176:179]
    ds_read_b64_tr_b16 a[26:27], v31 offset:34816
    v_mfma_f32_16x16x32_bf16 a[180:183], a[252:255], a[52:55], a[180:183]
    buffer_load_dwordx4 v23, s[20:23], s50 offen offset:1024 lds
    ds_read_b128 a[120:123], v26 offset:47104
    v_mfma_f32_16x16x32_bf16 a[180:183], a[248:251], a[48:51], a[180:183]
    v_mfma_f32_16x16x32_bf16 a[188:191], a[248:251], a[56:59], a[188:191]
    ds_read_b64_tr_b16 a[28:29], v31 offset:49152
    v_mfma_f32_16x16x32_bf16 a[188:191], a[252:255], a[60:63], a[188:191]
    buffer_load_dwordx4 v24, s[20:23], s50 offen offset:2048 lds
    v_mfma_f32_16x16x32_bf16 a[184:187], a[244:247], a[60:63], a[184:187]
    ds_read_b128 a[124:127], v27 offset:47104
    v_mfma_f32_16x16x32_bf16 a[184:187], a[240:243], a[56:59], a[184:187]
    ds_read_b64_tr_b16 a[30:31], v31 offset:51200
    v_mfma_f32_16x16x32_bf16 v[252:255], a[232:235], a[56:59], v[252:255]
    v_mfma_f32_16x16x32_bf16 v[252:255], a[236:239], a[60:63], v[252:255]
    buffer_load_dwordx4 v25, s[20:23], s50 offen offset:3072 lds
    v_mfma_f32_16x16x32_bf16 v[156:159], a[228:231], a[60:63], v[156:159]
    v_mfma_f32_16x16x32_bf16 v[156:159], a[224:227], a[56:59], v[156:159]
    s_add_u32 s50, s50, 0x80000
    v_mfma_f32_16x16x32_bf16 v[220:223], a[216:219], a[56:59], v[220:223]
    v_mfma_f32_16x16x32_bf16 v[220:223], a[220:223], a[60:63], v[220:223]
    s_cmp_eq_u32 s51, s53
    s_cbranch_scc1 k12_ool_36
k12_oolret_37:
    v_mfma_f32_16x16x32_bf16 v[124:127], a[212:215], a[60:63], v[124:127]
    s_cmp_eq_u32 s51, s63
    s_cbranch_scc1 k12_ool_38
k12_oolret_39:
    v_mfma_f32_16x16x32_bf16 v[124:127], a[208:211], a[56:59], v[124:127]
    s_cmp_eq_u32 s51, 6
    s_cbranch_scc1 k12_ool_40
k12_oolret_41:
    v_mfma_f32_16x16x32_bf16 v[188:191], a[200:203], a[56:59], v[188:191]
    v_mfma_f32_16x16x32_bf16 v[188:191], a[204:207], a[60:63], v[188:191]
    s_add_u32 s51, s51, 1
    v_mfma_f32_16x16x32_bf16 v[92:95], a[196:199], a[60:63], v[92:95]
    v_mfma_f32_16x16x32_bf16 v[92:95], a[192:195], a[56:59], v[92:95]
    s_waitcnt lgkmcnt(0)
    s_cmp_eq_u32 s51, 7
    s_cbranch_scc1 k12_last_29
    v_mfma_f32_16x16x32_bf16 v[64:67], a[64:67], a[0:3], v[64:67]
    v_mfma_f32_16x16x32_bf16 v[64:67], a[68:71], a[4:7], v[64:67]
    ds_read_b64_tr_b16 a[32:33], v32 offset:32768
    v_mfma_f32_16x16x32_bf16 v[160:163], a[76:79], a[4:7], v[160:163]
    v_mfma_f32_16x16x32_bf16 v[160:163], a[72:75], a[0:3], v[160:163]
    ds_read_b64_tr_b16 a[34:35], v32 offset:34816
    v_mfma_f32_16x16x32_bf16 v[96:99], a[80:83], a[0:3], v[96:99]
    v_mfma_f32_16x16x32_bf16 v[96:99], a[84:87], a[4:7], v[96:99]
    v_mfma_f32_16x16x32_bf16 v[192:195], a[92:95], a[4:7], v[192:195]
    ds_read_b64_tr_b16 a[36:37], v32 offset:49152
    v_mfma_f32_16x16x32_bf16 v[192:195], a[88:91], a[0:3], v[192:195]
    v_mfma_f32_16x16x32_bf16 v[128:131], a[96:99], a[0:3], v[128:131]
    v_mfma_f32_16x16x32_bf16 v[128:131], a[100:103], a[4:7], v[128:131]
    ds_read_b64_tr_b16 a[38:39], v32 offset:51200
    v_mfma_f32_16x16x32_bf16 v[224:227], a[108:111], a[4:7], v[224:227]
    v_mfma_f32_16x16x32_bf16 v[224:227], a[104:107], a[0:3], v[224:227]
    v_mfma_f32_16x16x32_bf16 a[128:131], a[112:115], a[0:3], a[128:131]
    ds_read_b64_tr_b16 a[40:41], v33 offset:32768
    v_mfma_f32_16x16x32_bf16 a[128:131], a[116:119], a[4:7], a[128:131]
    v_mfma_f32_16x16x32_bf16 a[132:135], a[124:127], a[4:7], a[132:135]
    v_mfma_f32_16x16x32_bf16 a[132:135], a[120:123], a[0:3], a[132:135]
    ds_read_b64_tr_b16 a[42:43], v33 offset:34816
    v_mfma_f32_16x16x32_bf16 a[140:143], a[120:123], a[8:11], a[140:143]
    v_mfma_f32_16x16x32_bf16 a[140:143], a[124:127], a[12:15], a[140:143]
    v_mfma_f32_16x16x32_bf16 a[136:139], a[116:119], a[12:15], a[136:139]
    ds_read_b64_tr_b16 a[44:45], v33 offset:49152
    v_mfma_f32_16x16x32_bf16 a[136:139], a[112:115], a[8:11], a[136:139]
    v_mfma_f32_16x16x32_bf16 v[228:231], a[104:107], a[8:11], v[228:231]
    v_mfma_f32_16x16x32_bf16 v[228:231], a[108:111], a[12:15], v[228:231]
    ds_read_b64_tr_b16 a[46:47], v33 offset:51200
    v_mfma_f32_16x16x32_bf16 v[132:135], a[100:103], a[12:15], v[132:135]
    v_mfma_f32_16x16x32_bf16 v[132:135], a[96:99], a[8:11], v[132:135]
    ds_read_b64_tr_b16 a[48:49], v34 offset:32768
    v_mfma_f32_16x16x32_bf16 v[196:199], a[88:91], a[8:11], v[196:199]
    v_mfma_f32_16x16x32_bf16 v[196:199], a[92:95], a[12:15], v[196:199]
    v_mfma_f32_16x16x32_bf16 v[100:103], a[84:87], a[12:15], v[100:103]
    ds_read_b64_tr_b16 a[50:51], v34 offset:34816
    v_mfma_f32_16x16x32_bf16 v[100:103], a[80:83], a[8:11], v[100:103]
    v_mfma_f32_16x16x32_bf16 v[164:167], a[72:75], a[8:11], v[164:167]
    v_mfma_f32_16x16x32_bf16 v[164:167], a[76:79], a[12:15], v[164:167]
    ds_read_b64_tr_b16 a[52:53], v34 offset:49152
    v_mfma_f32_16x16x32_bf16 v[68:71], a[68:71], a[12:15], v[68:71]
    v_mfma_f32_16x16x32_bf16 v[68:71], a[64:67], a[8:11], v[68:71]
    v_mfma_f32_16x16x32_bf16 v[72:75], a[64:67], a[16:19], v[72:75]
    ds_read_b64_tr_b16 a[54:55], v34 offset:51200
    v_mfma_f32_16x16x32_bf16 v[72:75], a[68:71], a[20:23], v[72:75]
    v_mfma_f32_16x16x32_bf16 v[168:171], a[76:79], a[20:23], v[168:171]
    v_mfma_f32_16x16x32_bf16 v[168:171], a[72:75], a[16:19], v[168:171]
    ds_read_b64_tr_b16 a[56:57], v35 offset:32768
    v_mfma_f32_16x16x32_bf16 v[104:107], a[80:83], a[16:19], v[104:107]
    v_mfma_f32_16x16x32_bf16 v[104:107], a[84:87], a[20:23], v[104:107]
    v_mfma_f32_16x16x32_bf16 v[200:203], a[92:95], a[20:23], v[200:203]
    ds_read_b64_tr_b16 a[58:59], v35 offset:34816
    v_mfma_f32_16x16x32_bf16 v[200:203], a[88:91], a[16:19], v[200:203]
    v_mfma_f32_16x16x32_bf16 v[136:139], a[96:99], a[16:19], v[136:139]
    v_mfma_f32_16x16x32_bf16 v[136:139], a[100:103], a[20:23], v[136:139]
    ds_read_b64_tr_b16 a[60:61], v35 offset:49152
    v_mfma_f32_16x16x32_bf16 v[232:235], a[108:111], a[20:23], v[232:235]
    v_mfma_f32_16x16x32_bf16 v[232:235], a[104:107], a[16:19], v[232:235]
    v_mfma_f32_16x16x32_bf16 a[144:147], a[112:115], a[16:19], a[144:147]
    ds_read_b64_tr_b16 a[62:63], v35 offset:51200
    v_mfma_f32_16x16x32_bf16 a[144:147], a[116:119], a[20:23], a[144:147]
    v_mfma_f32_16x16x32_bf16 a[148:151], a[124:127], a[20:23], a[148:151]
    v_mfma_f32_16x16x32_bf16 a[148:151], a[120:123], a[16:19], a[148:151]
    v_mfma_f32_16x16x32_bf16 a[156:159], a[120:123], a[24:27], a[156:159]
    v_mfma_f32_16x16x32_bf16 a[156:159], a[124:127], a[28:31], a[156:159]
    v_mfma_f32_16x16x32_bf16 a[152:155], a[116:119], a[28:31], a[152:155]
    v_mfma_f32_16x16x32_bf16 a[152:155], a[112:115], a[24:27], a[152:155]
    v_mfma_f32_16x16x32_bf16 v[236:239], a[104:107], a[24:27], v[236:239]
    v_mfma_f32_16x16x32_bf16 v[236:239], a[108:111], a[28:31], v[236:239]
    v_mfma_f32_16x16x32_bf16 v[140:143], a[100:103], a[28:31], v[140:143]
    v_mfma_f32_16x16x32_bf16 v[140:143], a[96:99], a[24:27], v[140:143]
    v_mfma_f32_16x16x32_bf16 v[204:207], a[88:91], a[24:27], v[204:207]
    v_mfma_f32_16x16x32_bf16 v[204:207], a[92:95], a[28:31], v[204:207]
    v_mfma_f32_16x16x32_bf16 v[108:111], a[84:87], a[28:31], v[108:111]
    v_mfma_f32_16x16x32_bf16 v[108:111], a[80:83], a[24:27], v[108:111]
    v_mfma_f32_16x16x32_bf16 v[172:175], a[72:75], a[24:27], v[172:175]
    v_mfma_f32_16x16x32_bf16 v[172:175], a[76:79], a[28:31], v[172:175]
    v_mfma_f32_16x16x32_bf16 v[76:79], a[68:71], a[28:31], v[76:79]
    v_mfma_f32_16x16x32_bf16 v[76:79], a[64:67], a[24:27], v[76:79]
    s_waitcnt vmcnt(0) lgkmcnt(0)
    s_barrier
    v_mfma_f32_16x16x32_bf16 v[80:83], a[64:67], a[32:35], v[80:83]
    v_mfma_f32_16x16x32_bf16 v[80:83], a[68:71], a[36:39], v[80:83]
    s_add_u32 m0, s48, 32768
    ds_read_b128 a[192:195], v26 offset:0
    v_mfma_f32_16x16x32_bf16 v[176:179], a[76:79], a[36:39], v[176:179]
    buffer_load_dwordx4 v10, s[16:19], s49 offen offset:0 lds
    ds_read_b64_tr_b16 a[0:1], v28 offset:0
    v_mfma_f32_16x16x32_bf16 v[176:179], a[72:75], a[32:35], v[176:179]
    ds_read_b128 a[196:199], v27 offset:0
    v_mfma_f32_16x16x32_bf16 v[112:115], a[80:83], a[32:35], v[112:115]
    buffer_load_dwordx4 v11, s[16:19], s49 offen offset:1024 lds
    v_mfma_f32_16x16x32_bf16 v[112:115], a[84:87], a[36:39], v[112:115]
    ds_read_b64_tr_b16 a[2:3], v28 offset:2048
    v_mfma_f32_16x16x32_bf16 v[208:211], a[92:95], a[36:39], v[208:211]
    v_mfma_f32_16x16x32_bf16 v[208:211], a[88:91], a[32:35], v[208:211]
    ds_read_b128 a[200:203], v26 offset:2048
    v_mfma_f32_16x16x32_bf16 v[144:147], a[96:99], a[32:35], v[144:147]
    buffer_load_dwordx4 v12, s[16:19], s49 offen offset:2048 lds
    ds_read_b64_tr_b16 a[4:5], v28 offset:16384
    v_mfma_f32_16x16x32_bf16 v[144:147], a[100:103], a[36:39], v[144:147]
    v_mfma_f32_16x16x32_bf16 v[240:243], a[108:111], a[36:39], v[240:243]
    ds_read_b128 a[204:207], v27 offset:2048
    v_mfma_f32_16x16x32_bf16 v[240:243], a[104:107], a[32:35], v[240:243]
    buffer_load_dwordx4 v13, s[16:19], s49 offen offset:3072 lds
    v_mfma_f32_16x16x32_bf16 a[160:163], a[112:115], a[32:35], a[160:163]
    ds_read_b64_tr_b16 a[6:7], v28 offset:18432
    v_mfma_f32_16x16x32_bf16 a[160:163], a[116:119], a[36:39], a[160:163]
    s_add_u32 m0, s48, 36864
    ds_read_b128 a[208:211], v26 offset:4096
    v_mfma_f32_16x16x32_bf16 a[164:167], a[124:127], a[36:39], a[164:167]
    v_mfma_f32_16x16x32_bf16 a[164:167], a[120:123], a[32:35], a[164:167]
    buffer_load_dwordx4 v14, s[16:19], s49 offen offset:0 lds
    ds_read_b64_tr_b16 a[8:9], v29 offset:0
    v_mfma_f32_16x16x32_bf16 a[172:175], a[120:123], a[40:43], a[172:175]
    v_mfma_f32_16x16x32_bf16 a[172:175], a[124:127], a[44:47], a[172:175]
    ds_read_b128 a[212:215], v27 offset:4096
    v_mfma_f32_16x16x32_bf16 a[168:171], a[116:119], a[44:47], a[168:171]
    buffer_load_dwordx4 v15, s[16:19], s49 offen offset:1024 lds
    ds_read_b64_tr_b16 a[10:11], v29 offset:2048
    v_mfma_f32_16x16x32_bf16 a[168:171], a[112:115], a[40:43], a[168:171]
    v_mfma_f32_16x16x32_bf16 v[244:247], a[104:107], a[40:43], v[244:247]
    ds_read_b128 a[216:219], v26 offset:6144
    v_mfma_f32_16x16x32_bf16 v[244:247], a[108:111], a[44:47], v[244:247]
    v_mfma_f32_16x16x32_bf16 v[148:151], a[100:103], a[44:47], v[148:151]
    buffer_load_dwordx4 v16, s[16:19], s49 offen offset:2048 lds
    ds_read_b64_tr_b16 a[12:13], v29 offset:16384
    v_mfma_f32_16x16x32_bf16 v[148:151], a[96:99], a[40:43], v[148:151]
    ds_read_b128 a[220:223], v27 offset:6144
    v_mfma_f32_16x16x32_bf16 v[212:215], a[88:91], a[40:43], v[212:215]
    v_mfma_f32_16x16x32_bf16 v[212:215], a[92:95], a[44:47], v[212:215]
    buffer_load_dwordx4 v17, s[16:19], s49 offen offset:3072 lds
    ds_read_b64_tr_b16 a[14:15], v29 offset:18432
    v_mfma_f32_16x16x32_bf16 v[116:119], a[84:87], a[44:47], v[116:119]
    ds_read_b128 a[224:227], v26 offset:8192
    v_mfma_f32_16x16x32_bf16 v[116:119], a[80:83], a[40:43], v[116:119]
    s_add_u32 s49, s49, 128
    v_mfma_f32_16x16x32_bf16 v[180:183], a[72:75], a[40:43], v[180:183]
    s_add_u32 m0, s48, 98304
    ds_read_b64_tr_b16 a[16:17], v30 offset:0
    v_mfma_f32_16x16x32_bf16 v[180:183], a[76:79], a[44:47], v[180:183]
    buffer_load_dwordx4 v18, s[20:23], s50 offen offset:0 lds
    v_mfma_f32_16x16x32_bf16 v[84:87], a[68:71], a[44:47], v[84:87]
    ds_read_b128 a[228:231], v27 offset:8192
    v_mfma_f32_16x16x32_bf16 v[84:87], a[64:67], a[40:43], v[84:87]
    ds_read_b64_tr_b16 a[18:19], v30 offset:2048
    v_mfma_f32_16x16x32_bf16 v[88:91], a[64:67], a[48:51], v[88:91]
    buffer_load_dwordx4 v19, s[20:23], s50 offen offset:1024 lds
    v_mfma_f32_16x16x32_bf16 v[88:91], a[68:71], a[52:55], v[88:91]
    ds_read_b128 a[232:235], v26 offset:10240
    v_mfma_f32_16x16x32_bf16 v[184:187], a[76:79], a[52:55], v[184:187]
    v_mfma_f32_16x16x32_bf16 v[184:187], a[72:75], a[48:51], v[184:187]
    buffer_load_dwordx4 v20, s[20:23], s50 offen offset:2048 lds
    ds_read_b64_tr_b16 a[20:21], v30 offset:16384
    v_mfma_f32_16x16x32_bf16 v[120:123], a[80:83], a[48:51], v[120:123]
    ds_read_b128 a[236:239], v27 offset:10240
    v_mfma_f32_16x16x32_bf16 v[120:123], a[84:87], a[52:55], v[120:123]
    v_mfma_f32_16x16x32_bf16 v[216:219], a[92:95], a[52:55], v[216:219]
    ds_read_b64_tr_b16 a[22:23], v30 offset:18432
    v_mfma_f32_16x16x32_bf16 v[216:219], a[88:91], a[48:51], v[216:219]
    buffer_load_dwordx4 v21, s[20:23], s50 offen offset:3072 lds
    v_mfma_f32_16x16x32_bf16 v[152:155], a[96:99], a[48:51], v[152:155]
    s_add_u32 m0, s48, 102400
    ds_read_b128 a[240:243], v26 offset:12288
    v_mfma_f32_16x16x32_bf16 v[152:155], a[100:103], a[52:55], v[152:155]
    ds_read_b64_tr_b16 a[24:25], v31 offset:0
    v_mfma_f32_16x16x32_bf16 v[248:251], a[108:111], a[52:55], v[248:251]
    buffer_load_dwordx4 v22, s[20:23], s50 offen offset:0 lds
    v_mfma_f32_16x16x32_bf16 v[248:251], a[104:107], a[48:51], v[248:251]
    ds_read_b128 a[244:247], v27 offset:12288
    v_mfma_f32_16x16x32_bf16 a[176:179], a[112:115], a[48:51], a[176:179]
    v_mfma_f32_16x16x32_bf16 a[176:179], a[116:119], a[52:55], a[176:179]
    ds_read_b64_tr_b16 a[26:27], v31 offset:2048
    v_mfma_f32_16x16x32_bf16 a[180:183], a[124:127], a[52:55], a[180:183]
    buffer_load_dwordx4 v23, s[20:23], s50 offen offset:1024 lds
    ds_read_b128 a[248:251], v26 offset:14336
    v_mfma_f32_16x16x32_bf16 a[180:183], a[120:123], a[48:51], a[180:183]
    v_mfma_f32_16x16x32_bf16 a[188:191], a[120:123], a[56:59], a[188:191]
    ds_read_b64_tr_b16 a[28:29], v31 offset:16384
    v_mfma_f32_16x16x32_bf16 a[188:191], a[124:127], a[60:63], a[188:191]
    buffer_load_dwordx4 v24, s[20:23], s50 offen offset:2048 lds
    v_mfma_f32_16x16x32_bf16 a[184:187], a[116:119], a[60:63], a[184:187]
    ds_read_b128 a[252:255], v27 offset:14336
    v_mfma_f32_16x16x32_bf16 a[184:187], a[112:115], a[56:59], a[184:187]
    ds_read_b64_tr_b16 a[30:31], v31 offset:18432
    v_mfma_f32_16x16x32_bf16 v[252:255], a[104:107], a[56:59], v[252:255]
    v_mfma_f32_16x16x32_bf16 v[252:255], a[108:111], a[60:63], v[252:255]
    buffer_load_dwordx4 v25, s[20:23], s50 offen offset:3072 lds
    v_mfma_f32_16x16x32_bf16 v[156:159], a[100:103], a[60:63], v[156:159]
    v_mfma_f32_16x16x32_bf16 v[156:159], a[96:99], a[56:59], v[156:159]
    s_add_u32 s50, s50, 0x80000
    v_mfma_f32_16x16x32_bf16 v[220:223], a[88:91], a[56:59], v[220:223]
    v_mfma_f32_16x16x32_bf16 v[220:223], a[92:95], a[60:63], v[220:223]
    s_cmp_eq_u32 s51, s53
    s_cbranch_scc1 k12_ool_42
k12_oolret_43:
    v_mfma_f32_16x16x32_bf16 v[124:127], a[84:87], a[60:63], v[124:127]
    s_cmp_eq_u32 s51, s63
    s_cbranch_scc1 k12_ool_44
k12_oolret_45:
    v_mfma_f32_16x16x32_bf16 v[124:127], a[80:83], a[56:59], v[124:127]
    s_cmp_eq_u32 s51, 5
    s_cbranch_scc1 k12_ool_46
k12_oolret_47:
    v_mfma_f32_16x16x32_bf16 v[188:191], a[72:75], a[56:59], v[188:191]
    v_mfma_f32_16x16x32_bf16 v[188:191], a[76:79], a[60:63], v[188:191]
    s_add_u32 s51, s51, 1
    v_mfma_f32_16x16x32_bf16 v[92:95], a[68:71], a[60:63], v[92:95]
    v_mfma_f32_16x16x32_bf16 v[92:95], a[64:67], a[56:59], v[92:95]
    s_waitcnt lgkmcnt(0)
    s_branch k12_loop_28
k12_last_29:
    v_mfma_f32_16x16x32_bf16 v[64:67], a[64:67], a[0:3], v[64:67]
    buffer_load_dwordx4 a[192:195], v36, s[8:11], s62 offen sc1
    v_mfma_f32_16x16x32_bf16 v[64:67], a[68:71], a[4:7], v[64:67]
    ds_read_b64_tr_b16 a[32:33], v32 offset:32768
    v_mfma_f32_16x16x32_bf16 v[160:163], a[76:79], a[4:7], v[160:163]
    buffer_load_dwordx4 a[196:199], v54, s[8:11], s62 offen sc1
    ds_read_b64_tr_b16 a[34:35], v32 offset:34816
    v_mfma_f32_16x16x32_bf16 v[160:163], a[72:75], a[0:3], v[160:163]
    v_mfma_f32_16x16x32_bf16 v[96:99], a[80:83], a[0:3], v[96:99]
    buffer_load_dwordx4 a[200:203], v37, s[8:11], s62 offen sc1
    v_mfma_f32_16x16x32_bf16 v[96:99], a[84:87], a[4:7], v[96:99]
    ds_read_b64_tr_b16 a[36:37], v32 offset:49152
    v_mfma_f32_16x16x32_bf16 v[192:195], a[92:95], a[4:7], v[192:195]
    buffer_load_dwordx4 a[204:207], v55, s[8:11], s62 offen sc1
    v_mfma_f32_16x16x32_bf16 v[192:195], a[88:91], a[0:3], v[192:195]
    s_add_u32 s62, s62, 0x20000
    buffer_load_dwordx4 a[208:211], v36, s[8:11], s62 offen sc1
    ds_read_b64_tr_b16 a[38:39], v32 offset:51200
    v_mfma_f32_16x16x32_bf16 v[128:131], a[96:99], a[0:3], v[128:131]
    v_mfma_f32_16x16x32_bf16 v[128:131], a[100:103], a[4:7], v[128:131]
    v_cvt_pk_bf16_f32 v64, v64, v65
    v_cvt_pk_bf16_f32 v65, v66, v67
    v_mfma_f32_16x16x32_bf16 v[224:227], a[108:111], a[4:7], v[224:227]
    v_cvt_pk_bf16_f32 v66, v160, v161
    v_cvt_pk_bf16_f32 v67, v162, v163
    v_mfma_f32_16x16x32_bf16 v[224:227], a[104:107], a[0:3], v[224:227]
    buffer_load_dwordx4 a[212:215], v54, s[8:11], s62 offen sc1
    ds_read_b64_tr_b16 a[40:41], v33 offset:32768
    v_mfma_f32_16x16x32_bf16 a[128:131], a[112:115], a[0:3], a[128:131]
    buffer_load_dwordx4 a[216:219], v37, s[8:11], s62 offen sc1
    ds_read_b64_tr_b16 a[42:43], v33 offset:34816
    v_mfma_f32_16x16x32_bf16 a[128:131], a[116:119], a[4:7], a[128:131]
    v_cvt_pk_bf16_f32 v96, v96, v97
    v_cvt_pk_bf16_f32 v97, v98, v99
    v_mfma_f32_16x16x32_bf16 a[132:135], a[124:127], a[4:7], a[132:135]
    v_cvt_pk_bf16_f32 v98, v192, v193
    v_cvt_pk_bf16_f32 v99, v194, v195
    v_mfma_f32_16x16x32_bf16 a[132:135], a[120:123], a[0:3], a[132:135]
    buffer_load_dwordx4 a[220:223], v55, s[8:11], s62 offen sc1
    ds_read_b64_tr_b16 a[44:45], v33 offset:49152
    v_mfma_f32_16x16x32_bf16 v[68:71], a[64:67], a[8:11], v[68:71]
    s_add_u32 s62, s62, 0x20000
    buffer_load_dwordx4 a[224:227], v36, s[8:11], s62 offen sc1
    v_mfma_f32_16x16x32_bf16 v[68:71], a[68:71], a[12:15], v[68:71]
    v_cvt_pk_bf16_f32 v128, v128, v129
    v_cvt_pk_bf16_f32 v129, v130, v131
    v_mfma_f32_16x16x32_bf16 v[164:167], a[76:79], a[12:15], v[164:167]
    buffer_load_dwordx4 a[228:231], v54, s[8:11], s62 offen sc1
    ds_read_b64_tr_b16 a[46:47], v33 offset:51200
    v_mfma_f32_16x16x32_bf16 v[164:167], a[72:75], a[8:11], v[164:167]
    v_cvt_pk_bf16_f32 v130, v224, v225
    v_cvt_pk_bf16_f32 v131, v226, v227
    v_mfma_f32_16x16x32_bf16 v[100:103], a[80:83], a[8:11], v[100:103]
    buffer_load_dwordx4 a[232:235], v37, s[8:11], s62 offen sc1
    ds_read_b64_tr_b16 a[48:49], v34 offset:32768
    v_mfma_f32_16x16x32_bf16 v[100:103], a[84:87], a[12:15], v[100:103]
    v_accvgpr_read_b32 v56, a128
    v_accvgpr_read_b32 v57, a129
    v_mfma_f32_16x16x32_bf16 v[196:199], a[92:95], a[12:15], v[196:199]
    buffer_load_dwordx4 a[236:239], v55, s[8:11], s62 offen sc1
    ds_read_b64_tr_b16 a[50:51], v34 offset:34816
    v_mfma_f32_16x16x32_bf16 v[196:199], a[88:91], a[8:11], v[196:199]
    s_add_u32 s62, s62, 0x20000
    v_accvgpr_read_b32 v58, a130
    v_accvgpr_read_b32 v59, a131
    v_mfma_f32_16x16x32_bf16 v[132:135], a[96:99], a[8:11], v[132:135]
    v_accvgpr_read_b32 v60, a132
    v_accvgpr_read_b32 v61, a133
    v_mfma_f32_16x16x32_bf16 v[132:135], a[100:103], a[12:15], v[132:135]
    v_accvgpr_read_b32 v62, a134
    v_accvgpr_read_b32 v63, a135
    v_mfma_f32_16x16x32_bf16 v[228:231], a[108:111], a[12:15], v[228:231]
    buffer_load_dwordx4 a[240:243], v36, s[8:11], s62 offen sc1
    ds_read_b64_tr_b16 a[52:53], v34 offset:49152
    v_mfma_f32_16x16x32_bf16 v[228:231], a[104:107], a[8:11], v[228:231]
    v_cvt_pk_bf16_f32 v160, v56, v57
    v_cvt_pk_bf16_f32 v161, v58, v59
    v_mfma_f32_16x16x32_bf16 a[136:139], a[112:115], a[8:11], a[136:139]
    v_cvt_pk_bf16_f32 v68, v68, v69
    v_cvt_pk_bf16_f32 v162, v60, v61
    v_mfma_f32_16x16x32_bf16 a[136:139], a[116:119], a[12:15], a[136:139]
    buffer_load_dwordx4 a[244:247], v54, s[8:11], s62 offen sc1
    v_cvt_pk_bf16_f32 v69, v70, v71
    v_mfma_f32_16x16x32_bf16 a[140:143], a[124:127], a[12:15], a[140:143]
    v_cvt_pk_bf16_f32 v163, v62, v63
    v_cvt_pk_bf16_f32 v70, v164, v165
    v_mfma_f32_16x16x32_bf16 a[140:143], a[120:123], a[8:11], a[140:143]
    buffer_load_dwordx4 a[248:251], v37, s[8:11], s62 offen sc1
    v_cvt_pk_bf16_f32 v71, v166, v167
    v_mfma_f32_16x16x32_bf16 v[72:75], a[64:67], a[16:19], v[72:75]
    ds_read_b64_tr_b16 a[54:55], v34 offset:51200
    v_cvt_pk_bf16_f32 v100, v100, v101
    v_mfma_f32_16x16x32_bf16 v[72:75], a[68:71], a[20:23], v[72:75]
    buffer_load_dwordx4 a[252:255], v55, s[8:11], s62 offen sc1
    v_cvt_pk_bf16_f32 v101, v102, v103
    v_mfma_f32_16x16x32_bf16 v[168:171], a[76:79], a[20:23], v[168:171]
    s_add_u32 s62, s62, 0x20000
    ds_read_b64_tr_b16 a[56:57], v35 offset:32768
    v_cvt_pk_bf16_f32 v102, v196, v197
    v_mfma_f32_16x16x32_bf16 v[168:171], a[72:75], a[16:19], v[168:171]
    s_add_u32 s52, s47, 0
    ds_read_b64_tr_b16 a[58:59], v35 offset:34816
    v_cvt_pk_bf16_f32 v103, v198, v199
    v_mfma_f32_16x16x32_bf16 v[104:107], a[80:83], a[16:19], v[104:107]
    v_cvt_pk_bf16_f32 v132, v132, v133
    v_cvt_pk_bf16_f32 v133, v134, v135
    v_mfma_f32_16x16x32_bf16 v[104:107], a[84:87], a[20:23], v[104:107]
    v_cvt_pk_bf16_f32 v134, v228, v229
    v_cvt_pk_bf16_f32 v135, v230, v231
    v_mfma_f32_16x16x32_bf16 v[200:203], a[92:95], a[20:23], v[200:203]
    buffer_store_dwordx4 v[64:67], v1, s[32:35], s52 offen offset:0 sc1
    ds_read_b64_tr_b16 a[60:61], v35 offset:49152
    v_mfma_f32_16x16x32_bf16 v[200:203], a[88:91], a[16:19], v[200:203]
    v_accvgpr_read_b32 v56, a136
    v_accvgpr_read_b32 v57, a137
    v_mfma_f32_16x16x32_bf16 v[136:139], a[96:99], a[16:19], v[136:139]
    ds_read_b64_tr_b16 a[62:63], v35 offset:51200
    v_accvgpr_read_b32 v58, a138
    v_mfma_f32_16x16x32_bf16 v[136:139], a[100:103], a[20:23], v[136:139]
    v_accvgpr_read_b32 v59, a139
    v_accvgpr_read_b32 v60, a140
    v_mfma_f32_16x16x32_bf16 v[232:235], a[108:111], a[20:23], v[232:235]
    v_accvgpr_read_b32 v61, a141
    v_accvgpr_read_b32 v62, a142
    v_mfma_f32_16x16x32_bf16 v[232:235], a[104:107], a[16:19], v[232:235]
    s_add_u32 s52, s47, 8192
    v_accvgpr_read_b32 v63, a143
    v_cvt_pk_bf16_f32 v164, v56, v57
    v_mfma_f32_16x16x32_bf16 a[144:147], a[112:115], a[16:19], a[144:147]
    v_cvt_pk_bf16_f32 v165, v58, v59
    v_cvt_pk_bf16_f32 v72, v72, v73
    v_mfma_f32_16x16x32_bf16 a[144:147], a[116:119], a[20:23], a[144:147]
    v_cvt_pk_bf16_f32 v166, v60, v61
    v_cvt_pk_bf16_f32 v73, v74, v75
    v_mfma_f32_16x16x32_bf16 a[148:151], a[124:127], a[20:23], a[148:151]
    v_cvt_pk_bf16_f32 v167, v62, v63
    v_cvt_pk_bf16_f32 v74, v168, v169
    v_mfma_f32_16x16x32_bf16 a[148:151], a[120:123], a[16:19], a[148:151]
    v_cvt_pk_bf16_f32 v75, v170, v171
    v_cvt_pk_bf16_f32 v104, v104, v105
    v_mfma_f32_16x16x32_bf16 v[76:79], a[64:67], a[24:27], v[76:79]
    v_cvt_pk_bf16_f32 v105, v106, v107
    v_cvt_pk_bf16_f32 v106, v200, v201
    v_mfma_f32_16x16x32_bf16 v[76:79], a[68:71], a[28:31], v[76:79]
    buffer_store_dwordx4 v[96:99], v1, s[32:35], s52 offen offset:0 sc1
    v_mfma_f32_16x16x32_bf16 v[172:175], a[76:79], a[28:31], v[172:175]
    v_cvt_pk_bf16_f32 v107, v202, v203
    v_cvt_pk_bf16_f32 v136, v136, v137
    v_mfma_f32_16x16x32_bf16 v[172:175], a[72:75], a[24:27], v[172:175]
    v_cvt_pk_bf16_f32 v137, v138, v139
    v_cvt_pk_bf16_f32 v138, v232, v233
    v_mfma_f32_16x16x32_bf16 v[108:111], a[80:83], a[24:27], v[108:111]
    v_cvt_pk_bf16_f32 v139, v234, v235
    v_mfma_f32_16x16x32_bf16 v[108:111], a[84:87], a[28:31], v[108:111]
    v_accvgpr_read_b32 v56, a144
    v_accvgpr_read_b32 v57, a145
    v_mfma_f32_16x16x32_bf16 v[204:207], a[92:95], a[28:31], v[204:207]
    v_accvgpr_read_b32 v58, a146
    v_accvgpr_read_b32 v59, a147
    v_mfma_f32_16x16x32_bf16 v[204:207], a[88:91], a[24:27], v[204:207]
    s_add_u32 s52, s47, 524288
    v_accvgpr_read_b32 v60, a148
    v_accvgpr_read_b32 v61, a149
    v_mfma_f32_16x16x32_bf16 v[140:143], a[96:99], a[24:27], v[140:143]
    v_accvgpr_read_b32 v62, a150
    v_accvgpr_read_b32 v63, a151
    v_mfma_f32_16x16x32_bf16 v[140:143], a[100:103], a[28:31], v[140:143]
    v_cvt_pk_bf16_f32 v168, v56, v57
    v_cvt_pk_bf16_f32 v169, v58, v59
    v_mfma_f32_16x16x32_bf16 v[236:239], a[108:111], a[28:31], v[236:239]
    v_cvt_pk_bf16_f32 v76, v76, v77
    v_cvt_pk_bf16_f32 v170, v60, v61
    v_mfma_f32_16x16x32_bf16 v[236:239], a[104:107], a[24:27], v[236:239]
    buffer_store_dwordx4 v[128:131], v1, s[32:35], s52 offen offset:0 sc1
    v_mfma_f32_16x16x32_bf16 a[152:155], a[112:115], a[24:27], a[152:155]
    s_waitcnt lgkmcnt(0)
    v_cvt_pk_bf16_f32 v77, v78, v79
    v_cvt_pk_bf16_f32 v171, v62, v63
    v_mfma_f32_16x16x32_bf16 a[152:155], a[116:119], a[28:31], a[152:155]
    v_cvt_pk_bf16_f32 v78, v172, v173
    v_cvt_pk_bf16_f32 v79, v174, v175
    v_mfma_f32_16x16x32_bf16 a[156:159], a[124:127], a[28:31], a[156:159]
    v_cvt_pk_bf16_f32 v108, v108, v109
    v_cvt_pk_bf16_f32 v109, v110, v111
    v_mfma_f32_16x16x32_bf16 a[156:159], a[120:123], a[24:27], a[156:159]
    v_cvt_pk_bf16_f32 v110, v204, v205
    v_cvt_pk_bf16_f32 v111, v206, v207
    v_mfma_f32_16x16x32_bf16 v[80:83], a[64:67], a[32:35], v[80:83]
    v_mfma_f32_16x16x32_bf16 v[80:83], a[68:71], a[36:39], v[80:83]
    v_cvt_pk_bf16_f32 v140, v140, v141
    v_cvt_pk_bf16_f32 v141, v142, v143
    v_mfma_f32_16x16x32_bf16 v[176:179], a[76:79], a[36:39], v[176:179]
    s_add_u32 s52, s47, 532480
    v_cvt_pk_bf16_f32 v142, v236, v237
    v_cvt_pk_bf16_f32 v143, v238, v239
    v_mfma_f32_16x16x32_bf16 v[176:179], a[72:75], a[32:35], v[176:179]
    buffer_store_dwordx4 v[160:163], v1, s[32:35], s52 offen offset:0 sc1
    v_mfma_f32_16x16x32_bf16 v[112:115], a[80:83], a[32:35], v[112:115]
    v_mfma_f32_16x16x32_bf16 v[112:115], a[84:87], a[36:39], v[112:115]
    v_accvgpr_read_b32 v56, a152
    v_accvgpr_read_b32 v57, a153
    v_mfma_f32_16x16x32_bf16 v[208:211], a[92:95], a[36:39], v[208:211]
    v_accvgpr_read_b32 v58, a154
    v_accvgpr_read_b32 v59, a155
    v_mfma_f32_16x16x32_bf16 v[208:211], a[88:91], a[32:35], v[208:211]
    v_accvgpr_read_b32 v60, a156
    v_accvgpr_read_b32 v61, a157
    v_mfma_f32_16x16x32_bf16 v[144:147], a[96:99], a[32:35], v[144:147]
    v_accvgpr_read_b32 v62, a158
    v_accvgpr_read_b32 v63, a159
    v_mfma_f32_16x16x32_bf16 v[144:147], a[100:103], a[36:39], v[144:147]
    v_cvt_pk_bf16_f32 v172, v56, v57
    v_cvt_pk_bf16_f32 v173, v58, v59
    v_mfma_f32_16x16x32_bf16 v[240:243], a[108:111], a[36:39], v[240:243]
    v_cvt_pk_bf16_f32 v80, v80, v81
    v_cvt_pk_bf16_f32 v174, v60, v61
    v_mfma_f32_16x16x32_bf16 v[240:243], a[104:107], a[32:35], v[240:243]
    v_cvt_pk_bf16_f32 v81, v82, v83
    v_cvt_pk_bf16_f32 v175, v62, v63
    v_mfma_f32_16x16x32_bf16 a[160:163], a[112:115], a[32:35], a[160:163]
    v_cvt_pk_bf16_f32 v82, v176, v177
    v_cvt_pk_bf16_f32 v83, v178, v179
    v_mfma_f32_16x16x32_bf16 a[160:163], a[116:119], a[36:39], a[160:163]
    v_cvt_pk_bf16_f32 v112, v112, v113
    v_cvt_pk_bf16_f32 v113, v114, v115
    v_mfma_f32_16x16x32_bf16 a[164:167], a[124:127], a[36:39], a[164:167]
    s_add_u32 s52, s47, 0
    v_cvt_pk_bf16_f32 v114, v208, v209
    v_cvt_pk_bf16_f32 v115, v210, v211
    v_mfma_f32_16x16x32_bf16 a[164:167], a[120:123], a[32:35], a[164:167]
    buffer_store_dwordx4 v[68:71], v1, s[32:35], s52 offen offset:1024 sc1
    v_mfma_f32_16x16x32_bf16 v[84:87], a[64:67], a[40:43], v[84:87]
    v_mfma_f32_16x16x32_bf16 v[84:87], a[68:71], a[44:47], v[84:87]
    v_cvt_pk_bf16_f32 v144, v144, v145
    v_cvt_pk_bf16_f32 v145, v146, v147
    v_mfma_f32_16x16x32_bf16 v[180:183], a[76:79], a[44:47], v[180:183]
    v_cvt_pk_bf16_f32 v146, v240, v241
    v_cvt_pk_bf16_f32 v147, v242, v243
    v_mfma_f32_16x16x32_bf16 v[180:183], a[72:75], a[40:43], v[180:183]
    v_mfma_f32_16x16x32_bf16 v[116:119], a[80:83], a[40:43], v[116:119]
    v_mfma_f32_16x16x32_bf16 v[116:119], a[84:87], a[44:47], v[116:119]
    v_accvgpr_read_b32 v56, a160
    v_accvgpr_read_b32 v57, a161
    v_mfma_f32_16x16x32_bf16 v[212:215], a[92:95], a[44:47], v[212:215]
    v_accvgpr_read_b32 v58, a162
    v_accvgpr_read_b32 v59, a163
    v_mfma_f32_16x16x32_bf16 v[212:215], a[88:91], a[40:43], v[212:215]
    v_accvgpr_read_b32 v60, a164
    v_accvgpr_read_b32 v61, a165
    v_mfma_f32_16x16x32_bf16 v[148:151], a[96:99], a[40:43], v[148:151]
    v_accvgpr_read_b32 v62, a166
    v_accvgpr_read_b32 v63, a167
    v_mfma_f32_16x16x32_bf16 v[148:151], a[100:103], a[44:47], v[148:151]
    s_add_u32 s52, s47, 8192
    v_cvt_pk_bf16_f32 v176, v56, v57
    v_cvt_pk_bf16_f32 v177, v58, v59
    v_mfma_f32_16x16x32_bf16 v[244:247], a[108:111], a[44:47], v[244:247]
    v_cvt_pk_bf16_f32 v84, v84, v85
    v_cvt_pk_bf16_f32 v178, v60, v61
    v_mfma_f32_16x16x32_bf16 v[244:247], a[104:107], a[40:43], v[244:247]
    v_cvt_pk_bf16_f32 v85, v86, v87
    v_cvt_pk_bf16_f32 v179, v62, v63
    v_mfma_f32_16x16x32_bf16 a[168:171], a[112:115], a[40:43], a[168:171]
    v_cvt_pk_bf16_f32 v86, v180, v181
    v_cvt_pk_bf16_f32 v87, v182, v183
    v_mfma_f32_16x16x32_bf16 a[168:171], a[116:119], a[44:47], a[168:171]
    buffer_store_dwordx4 v[100:103], v1, s[32:35], s52 offen offset:1024 sc1
    v_mfma_f32_16x16x32_bf16 a[172:175], a[124:127], a[44:47], a[172:175]
    v_cvt_pk_bf16_f32 v116, v116, v117
    v_cvt_pk_bf16_f32 v117, v118, v119
    v_mfma_f32_16x16x32_bf16 a[172:175], a[120:123], a[40:43], a[172:175]
    v_cvt_pk_bf16_f32 v118, v212, v213
    v_cvt_pk_bf16_f32 v119, v214, v215
    v_mfma_f32_16x16x32_bf16 v[88:91], a[64:67], a[48:51], v[88:91]
    s_waitcnt vmcnt(16)
    s_barrier
    v_mfma_f32_16x16x32_bf16 v[88:91], a[68:71], a[52:55], v[88:91]
    ds_read_b64_tr_b16 a[0:1], v42 offset:32768
    v_cvt_pk_bf16_f32 v148, v148, v149
    v_mfma_f32_16x16x32_bf16 v[184:187], a[76:79], a[52:55], v[184:187]
    v_cvt_pk_bf16_f32 v149, v150, v151
    v_cvt_pk_bf16_f32 v150, v244, v245
    v_mfma_f32_16x16x32_bf16 v[184:187], a[72:75], a[48:51], v[184:187]
    ds_read_b64_tr_b16 a[2:3], v42 offset:33792
    v_cvt_pk_bf16_f32 v151, v246, v247
    v_mfma_f32_16x16x32_bf16 v[120:123], a[80:83], a[48:51], v[120:123]
    ds_read_b64_tr_b16 a[4:5], v42 offset:40960
    ds_read_b64_tr_b16 a[6:7], v42 offset:41984
    v_mfma_f32_16x16x32_bf16 v[120:123], a[84:87], a[52:55], v[120:123]
    s_add_u32 s52, s47, 524288
    v_accvgpr_read_b32 v56, a168
    v_accvgpr_read_b32 v57, a169
    v_mfma_f32_16x16x32_bf16 v[216:219], a[92:95], a[52:55], v[216:219]
    v_accvgpr_read_b32 v58, a170
    v_accvgpr_read_b32 v59, a171
    v_mfma_f32_16x16x32_bf16 v[216:219], a[88:91], a[48:51], v[216:219]
    ds_read_b64_tr_b16 a[8:9], v43 offset:32768
    v_accvgpr_read_b32 v60, a172
    v_mfma_f32_16x16x32_bf16 v[152:155], a[96:99], a[48:51], v[152:155]
    buffer_store_dwordx4 v[132:135], v1, s[32:35], s52 offen offset:1024 sc1
    ds_read_b64_tr_b16 a[10:11], v43 offset:33792
    v_mfma_f32_16x16x32_bf16 v[152:155], a[100:103], a[52:55], v[152:155]
    v_accvgpr_read_b32 v61, a173
    v_accvgpr_read_b32 v62, a174
    v_mfma_f32_16x16x32_bf16 v[248:251], a[108:111], a[52:55], v[248:251]
    v_accvgpr_read_b32 v63, a175
    v_cvt_pk_bf16_f32 v180, v56, v57
    v_mfma_f32_16x16x32_bf16 v[248:251], a[104:107], a[48:51], v[248:251]
    v_cvt_pk_bf16_f32 v181, v58, v59
    v_cvt_pk_bf16_f32 v88, v88, v89
    v_mfma_f32_16x16x32_bf16 a[176:179], a[112:115], a[48:51], a[176:179]
    v_cvt_pk_bf16_f32 v182, v60, v61
    v_cvt_pk_bf16_f32 v89, v90, v91
    v_mfma_f32_16x16x32_bf16 a[176:179], a[116:119], a[52:55], a[176:179]
    ds_read_b64_tr_b16 a[12:13], v43 offset:40960
    v_cvt_pk_bf16_f32 v183, v62, v63
    v_mfma_f32_16x16x32_bf16 a[180:183], a[124:127], a[52:55], a[180:183]
    v_cvt_pk_bf16_f32 v90, v184, v185
    v_cvt_pk_bf16_f32 v91, v186, v187
    v_mfma_f32_16x16x32_bf16 a[180:183], a[120:123], a[48:51], a[180:183]
    ds_read_b64_tr_b16 a[14:15], v43 offset:41984
    ds_read_b64_tr_b16 a[16:17], v44 offset:32768
    v_mfma_f32_16x16x32_bf16 v[92:95], a[64:67], a[56:59], v[92:95]
    s_add_u32 s52, s47, 532480
    v_cvt_pk_bf16_f32 v120, v120, v121
    v_cvt_pk_bf16_f32 v121, v122, v123
    v_mfma_f32_16x16x32_bf16 v[92:95], a[68:71], a[60:63], v[92:95]
    ds_read_b64_tr_b16 a[18:19], v44 offset:33792
    v_cvt_pk_bf16_f32 v122, v216, v217
    v_mfma_f32_16x16x32_bf16 v[188:191], a[76:79], a[60:63], v[188:191]
    ds_read_b64_tr_b16 a[20:21], v44 offset:40960
    v_cvt_pk_bf16_f32 v123, v218, v219
    v_mfma_f32_16x16x32_bf16 v[188:191], a[72:75], a[56:59], v[188:191]
    ds_read_b64_tr_b16 a[22:23], v44 offset:41984
    v_cvt_pk_bf16_f32 v152, v152, v153
    v_mfma_f32_16x16x32_bf16 v[124:127], a[80:83], a[56:59], v[124:127]
    v_cvt_pk_bf16_f32 v153, v154, v155
    v_cvt_pk_bf16_f32 v154, v248, v249
    v_mfma_f32_16x16x32_bf16 v[124:127], a[84:87], a[60:63], v[124:127]
    ds_read_b64_tr_b16 a[24:25], v45 offset:32768
    v_cvt_pk_bf16_f32 v155, v250, v251
    v_mfma_f32_16x16x32_bf16 v[220:223], a[92:95], a[60:63], v[220:223]
    buffer_store_dwordx4 v[164:167], v1, s[32:35], s52 offen offset:1024 sc1
    ds_read_b64_tr_b16 a[26:27], v45 offset:33792
    v_mfma_f32_16x16x32_bf16 v[220:223], a[88:91], a[56:59], v[220:223]
    ds_read_b64_tr_b16 a[28:29], v45 offset:40960
    v_accvgpr_read_b32 v56, a176
    v_mfma_f32_16x16x32_bf16 v[156:159], a[96:99], a[56:59], v[156:159]
    v_accvgpr_read_b32 v57, a177
    v_accvgpr_read_b32 v58, a178
    v_mfma_f32_16x16x32_bf16 v[156:159], a[100:103], a[60:63], v[156:159]
    ds_read_b64_tr_b16 a[30:31], v45 offset:41984
    v_accvgpr_read_b32 v59, a179
    v_mfma_f32_16x16x32_bf16 v[252:255], a[108:111], a[60:63], v[252:255]
    v_accvgpr_read_b32 v60, a180
    v_accvgpr_read_b32 v61, a181
    v_mfma_f32_16x16x32_bf16 v[252:255], a[104:107], a[56:59], v[252:255]
    v_accvgpr_read_b32 v62, a182
    v_accvgpr_read_b32 v63, a183
    v_mfma_f32_16x16x32_bf16 a[184:187], a[112:115], a[56:59], a[184:187]
    v_cvt_pk_bf16_f32 v184, v56, v57
    v_cvt_pk_bf16_f32 v185, v58, v59
    v_mfma_f32_16x16x32_bf16 a[184:187], a[116:119], a[60:63], a[184:187]
    v_cvt_pk_bf16_f32 v92, v92, v93
    v_cvt_pk_bf16_f32 v186, v60, v61
    v_mfma_f32_16x16x32_bf16 a[188:191], a[124:127], a[60:63], a[188:191]
    v_cvt_pk_bf16_f32 v93, v94, v95
    v_cvt_pk_bf16_f32 v187, v62, v63
    v_mfma_f32_16x16x32_bf16 a[188:191], a[120:123], a[56:59], a[188:191]
    v_cvt_pk_bf16_f32 v94, v188, v189
    v_cvt_pk_bf16_f32 v95, v190, v191
    v_cvt_pk_bf16_f32 v124, v124, v125
    v_cvt_pk_bf16_f32 v125, v126, v127
    v_cvt_pk_bf16_f32 v126, v220, v221
    v_cvt_pk_bf16_f32 v127, v222, v223
    v_cvt_pk_bf16_f32 v156, v156, v157
    v_cvt_pk_bf16_f32 v157, v158, v159
    v_cvt_pk_bf16_f32 v158, v252, v253
    v_cvt_pk_bf16_f32 v159, v254, v255
    v_accvgpr_read_b32 v56, a184
    v_accvgpr_read_b32 v57, a185
    v_accvgpr_read_b32 v58, a186
    v_accvgpr_read_b32 v59, a187
    v_accvgpr_read_b32 v60, a188
    v_accvgpr_read_b32 v61, a189
    v_accvgpr_read_b32 v62, a190
    v_accvgpr_read_b32 v63, a191
    v_cvt_pk_bf16_f32 v188, v56, v57
    v_cvt_pk_bf16_f32 v189, v58, v59
    v_cvt_pk_bf16_f32 v190, v60, v61
    v_cvt_pk_bf16_f32 v191, v62, v63
k12_join_7:
k12_qcode:
    s_mov_b64 s[48:49], s[32:33]
    s_mov_b32 s51, 0x00020000
    s_cmp_eq_u32 s45, 0
    s_mov_b32 s50, s34
    s_cselect_b32 s56, s30, -1
    s_cselect_b32 s57, -1, s30
    s_waitcnt vmcnt(16) lgkmcnt(0)
    v_mfma_f32_16x16x32_bf16 v[192:195], a[0:3], a[192:195], 0
    v_mfma_f32_16x16x32_bf16 v[192:195], a[4:7], a[208:211], v[192:195]
    buffer_load_dwordx4 a[128:131], v36, s[8:11], s62 offen sc1
    ds_read_b64_tr_b16 a[32:33], v46 offset:32768
    v_mfma_f32_16x16x32_bf16 v[196:199], a[4:7], a[212:215], 0
    ds_read_b64_tr_b16 a[34:35], v46 offset:33792
    v_mfma_f32_16x16x32_bf16 v[196:199], a[0:3], a[196:199], v[196:199]
    ds_read_b64_tr_b16 a[36:37], v46 offset:40960
    v_mfma_f32_16x16x32_bf16 a[64:67], a[0:3], a[200:203], 0
    ds_read_b64_tr_b16 a[38:39], v46 offset:41984
    v_mfma_f32_16x16x32_bf16 a[64:67], a[4:7], a[216:219], a[64:67]
    ds_read_b64_tr_b16 a[40:41], v47 offset:32768
    v_mfma_f32_16x16x32_bf16 a[68:71], a[4:7], a[220:223], 0
    s_lshl_b32 s31, s28, 14
    v_mfma_f32_16x16x32_bf16 a[68:71], a[0:3], a[204:207], a[68:71]
    s_add_u32 s16, s6, s31
    s_addc_u32 s17, s7, 0
    buffer_load_dwordx4 a[132:135], v54, s[8:11], s62 offen sc1
    ds_read_b64_tr_b16 a[42:43], v47 offset:33792
    v_mfma_f32_16x16x32_bf16 a[76:79], a[8:11], a[204:207], 0
    ds_read_b64_tr_b16 a[44:45], v47 offset:40960
    v_mfma_f32_16x16x32_bf16 a[76:79], a[12:15], a[220:223], a[76:79]
    s_add_u32 s20, s16, 0x2000000
    s_addc_u32 s21, s17, 0
    ds_read_b64_tr_b16 a[46:47], v47 offset:41984
    v_mfma_f32_16x16x32_bf16 a[72:75], a[12:15], a[216:219], 0
    ds_read_b64_tr_b16 a[48:49], v48 offset:32768
    v_mfma_f32_16x16x32_bf16 a[72:75], a[8:11], a[200:203], a[72:75]
    s_add_u32 s16, s16, 0x1000000
    s_addc_u32 s17, s17, 0
    v_mfma_f32_16x16x32_bf16 v[204:207], a[8:11], a[196:199], 0
    ds_read_b64_tr_b16 a[50:51], v48 offset:33792
    v_mfma_f32_16x16x32_bf16 v[204:207], a[12:15], a[212:215], v[204:207]
    s_and_b32 s17, s17, 0xffff
    ds_read_b64_tr_b16 a[52:53], v48 offset:40960
    v_mfma_f32_16x16x32_bf16 v[200:203], a[12:15], a[208:211], 0
    buffer_load_dwordx4 a[136:139], v37, s[8:11], s62 offen sc1
    ds_read_b64_tr_b16 a[54:55], v48 offset:41984
    v_mfma_f32_16x16x32_bf16 v[200:203], a[8:11], a[192:195], v[200:203]
    s_and_b32 s21, s21, 0xffff
    v_mfma_f32_16x16x32_bf16 v[208:211], a[16:19], a[192:195], 0
    ds_read_b64_tr_b16 a[56:57], v49 offset:32768
    v_mfma_f32_16x16x32_bf16 v[208:211], a[20:23], a[208:211], v[208:211]
    s_lshl_b32 s31, s29, 20
    ds_read_b64_tr_b16 a[58:59], v49 offset:33792
    v_mfma_f32_16x16x32_bf16 v[212:215], a[20:23], a[212:215], 0
    ds_read_b64_tr_b16 a[60:61], v49 offset:40960
    v_mfma_f32_16x16x32_bf16 v[212:215], a[16:19], a[196:199], v[212:215]
    s_sub_u32 s18, 0xf84000, s31
    v_mfma_f32_16x16x32_bf16 a[80:83], a[16:19], a[200:203], 0
    buffer_load_dwordx4 a[140:143], v55, s[8:11], s62 offen sc1
    ds_read_b64_tr_b16 a[62:63], v49 offset:41984
    v_mfma_f32_16x16x32_bf16 a[80:83], a[20:23], a[216:219], a[80:83]
    s_mov_b32 s22, s18
    v_mfma_f32_16x16x32_bf16 a[84:87], a[20:23], a[220:223], 0
    v_mfma_f32_16x16x32_bf16 a[84:87], a[16:19], a[204:207], a[84:87]
    s_add_u32 s24, s6, 0x4806000
    s_addc_u32 s25, s7, 0
    v_mfma_f32_16x16x32_bf16 a[92:95], a[24:27], a[204:207], 0
    v_mfma_f32_16x16x32_bf16 a[92:95], a[28:31], a[220:223], a[92:95]
    s_and_b32 s25, s25, 0xffff
    v_mfma_f32_16x16x32_bf16 a[88:91], a[28:31], a[216:219], 0
    s_add_u32 s62, s62, 0x20000
    v_mfma_f32_16x16x32_bf16 a[88:91], a[24:27], a[200:203], a[88:91]
    s_mov_b32 s26, 4096
    v_mfma_f32_16x16x32_bf16 v[220:223], a[24:27], a[196:199], 0
    s_cmp_eq_u32 s45, 0
    s_cbranch_scc1 k12_ool_48
k12_oolret_49:
    v_mfma_f32_16x16x32_bf16 v[220:223], a[28:31], a[212:215], v[220:223]
    v_mfma_f32_16x16x32_bf16 v[216:219], a[28:31], a[208:211], 0
    v_mfma_f32_16x16x32_bf16 v[216:219], a[24:27], a[192:195], v[216:219]
    s_waitcnt vmcnt(28) lgkmcnt(0)
    s_barrier
    v_mfma_f32_16x16x32_bf16 v[224:227], a[32:35], a[192:195], 0
    v_mfma_f32_16x16x32_bf16 v[224:227], a[36:39], a[208:211], v[224:227]
    s_add_u32 m0, s60, 98304
    ds_read_b64_tr_b16 a[0:1], v42 offset:49152
    ds_read_b64_tr_b16 a[2:3], v42 offset:50176
    v_mfma_f32_16x16x32_bf16 v[228:231], a[36:39], a[212:215], 0
    buffer_load_dwordx4 v38, s[12:15], s61 offen offset:0 lds
    v_mfma_f32_16x16x32_bf16 v[228:231], a[32:35], a[196:199], v[228:231]
    ds_read_b64_tr_b16 a[4:5], v42 offset:57344
    v_mfma_f32_16x16x32_bf16 a[96:99], a[32:35], a[200:203], 0
    buffer_load_dwordx4 v39, s[12:15], s61 offen offset:1024 lds
    ds_read_b64_tr_b16 a[6:7], v42 offset:58368
    v_mfma_f32_16x16x32_bf16 a[96:99], a[36:39], a[216:219], a[96:99]
    ds_read_b64_tr_b16 a[8:9], v43 offset:49152
    v_mfma_f32_16x16x32_bf16 a[100:103], a[36:39], a[220:223], 0
    v_mfma_f32_16x16x32_bf16 a[100:103], a[32:35], a[204:207], a[100:103]
    buffer_load_dwordx4 v40, s[12:15], s61 offen offset:2048 lds
    ds_read_b64_tr_b16 a[10:11], v43 offset:50176
    v_mfma_f32_16x16x32_bf16 a[108:111], a[40:43], a[204:207], 0
    ds_read_b64_tr_b16 a[12:13], v43 offset:57344
    v_mfma_f32_16x16x32_bf16 a[108:111], a[44:47], a[220:223], a[108:111]
    ds_read_b64_tr_b16 a[14:15], v43 offset:58368
    v_mfma_f32_16x16x32_bf16 a[104:107], a[44:47], a[216:219], 0
    buffer_load_dwordx4 v41, s[12:15], s61 offen offset:3072 lds
    ds_read_b64_tr_b16 a[16:17], v44 offset:49152
    v_mfma_f32_16x16x32_bf16 a[104:107], a[40:43], a[200:203], a[104:107]
    v_mfma_f32_16x16x32_bf16 v[236:239], a[40:43], a[196:199], 0
    s_add_u32 s61, s61, 0x80000
    ds_read_b64_tr_b16 a[18:19], v44 offset:50176
    v_mfma_f32_16x16x32_bf16 v[236:239], a[44:47], a[212:215], v[236:239]
    buffer_load_dwordx4 a[144:147], v36, s[8:11], s62 offen sc1
    ds_read_b64_tr_b16 a[20:21], v44 offset:57344
    v_mfma_f32_16x16x32_bf16 v[232:235], a[44:47], a[208:211], 0
    ds_read_b64_tr_b16 a[22:23], v44 offset:58368
    v_mfma_f32_16x16x32_bf16 v[232:235], a[40:43], a[192:195], v[232:235]
    buffer_load_dwordx4 a[148:151], v54, s[8:11], s62 offen sc1
    v_mfma_f32_16x16x32_bf16 v[240:243], a[48:51], a[192:195], 0
    ds_read_b64_tr_b16 a[24:25], v45 offset:49152
    v_mfma_f32_16x16x32_bf16 v[240:243], a[52:55], a[208:211], v[240:243]
    ds_read_b64_tr_b16 a[26:27], v45 offset:50176
    v_mfma_f32_16x16x32_bf16 v[244:247], a[52:55], a[212:215], 0
    buffer_load_dwordx4 a[152:155], v37, s[8:11], s62 offen sc1
    ds_read_b64_tr_b16 a[28:29], v45 offset:57344
    v_mfma_f32_16x16x32_bf16 v[244:247], a[48:51], a[196:199], v[244:247]
    v_mfma_f32_16x16x32_bf16 a[112:115], a[48:51], a[200:203], 0
    ds_read_b64_tr_b16 a[30:31], v45 offset:58368
    v_mfma_f32_16x16x32_bf16 a[112:115], a[52:55], a[216:219], a[112:115]
    buffer_load_dwordx4 a[156:159], v55, s[8:11], s62 offen sc1
    v_mfma_f32_16x16x32_bf16 a[116:119], a[52:55], a[220:223], 0
    v_mfma_f32_16x16x32_bf16 a[116:119], a[48:51], a[204:207], a[116:119]
    s_add_u32 s62, s62, 0x20000
    v_mfma_f32_16x16x32_bf16 a[124:127], a[56:59], a[204:207], 0
    s_add_u32 s52, s47, 0
    v_mfma_f32_16x16x32_bf16 a[124:127], a[60:63], a[220:223], a[124:127]
    buffer_store_dwordx4 v[72:75], v1, s[48:51], s52 offen offset:2048 sc1
    v_mfma_f32_16x16x32_bf16 a[120:123], a[60:63], a[216:219], 0
    v_mfma_f32_16x16x32_bf16 a[120:123], a[56:59], a[200:203], a[120:123]
    v_mfma_f32_16x16x32_bf16 v[252:255], a[56:59], a[196:199], 0
    v_mfma_f32_16x16x32_bf16 v[252:255], a[60:63], a[212:215], v[252:255]
    v_mfma_f32_16x16x32_bf16 v[248:251], a[60:63], a[208:211], 0
    v_mfma_f32_16x16x32_bf16 v[248:251], a[56:59], a[192:195], v[248:251]
    s_waitcnt vmcnt(21) lgkmcnt(0)
    v_mfma_f32_16x16x32_bf16 v[192:195], a[0:3], a[224:227], v[192:195]
    v_mfma_f32_16x16x32_bf16 v[192:195], a[4:7], a[240:243], v[192:195]
    buffer_load_dwordx4 a[160:163], v36, s[8:11], s62 offen sc1
    ds_read_b64_tr_b16 a[32:33], v46 offset:49152
    v_mfma_f32_16x16x32_bf16 v[196:199], a[4:7], a[244:247], v[196:199]
    ds_read_b64_tr_b16 a[34:35], v46 offset:50176
    v_mfma_f32_16x16x32_bf16 v[196:199], a[0:3], a[228:231], v[196:199]
    ds_read_b64_tr_b16 a[36:37], v46 offset:57344
    v_mfma_f32_16x16x32_bf16 a[64:67], a[0:3], a[232:235], a[64:67]
    ds_read_b64_tr_b16 a[38:39], v46 offset:58368
    v_mfma_f32_16x16x32_bf16 a[64:67], a[4:7], a[248:251], a[64:67]
    ds_read_b64_tr_b16 a[40:41], v47 offset:49152
    v_mfma_f32_16x16x32_bf16 a[68:71], a[4:7], a[252:255], a[68:71]
    buffer_load_dwordx4 a[164:167], v54, s[8:11], s62 offen sc1
    v_mfma_f32_16x16x32_bf16 a[68:71], a[0:3], a[236:239], a[68:71]
    ds_read_b64_tr_b16 a[42:43], v47 offset:50176
    v_mfma_f32_16x16x32_bf16 a[76:79], a[8:11], a[236:239], a[76:79]
    ds_read_b64_tr_b16 a[44:45], v47 offset:57344
    v_mfma_f32_16x16x32_bf16 a[76:79], a[12:15], a[252:255], a[76:79]
    ds_read_b64_tr_b16 a[46:47], v47 offset:58368
    v_mfma_f32_16x16x32_bf16 a[72:75], a[12:15], a[248:251], a[72:75]
    ds_read_b64_tr_b16 a[48:49], v48 offset:49152
    v_mfma_f32_16x16x32_bf16 a[72:75], a[8:11], a[232:235], a[72:75]
    buffer_load_dwordx4 a[168:171], v37, s[8:11], s62 offen sc1
    v_mfma_f32_16x16x32_bf16 v[204:207], a[8:11], a[228:231], v[204:207]
    ds_read_b64_tr_b16 a[50:51], v48 offset:50176
    v_mfma_f32_16x16x32_bf16 v[204:207], a[12:15], a[244:247], v[204:207]
    ds_read_b64_tr_b16 a[52:53], v48 offset:57344
    v_mfma_f32_16x16x32_bf16 v[200:203], a[12:15], a[240:243], v[200:203]
    ds_read_b64_tr_b16 a[54:55], v48 offset:58368
    v_mfma_f32_16x16x32_bf16 v[200:203], a[8:11], a[224:227], v[200:203]
    v_mfma_f32_16x16x32_bf16 v[208:211], a[16:19], a[224:227], v[208:211]
    ds_read_b64_tr_b16 a[56:57], v49 offset:49152
    v_mfma_f32_16x16x32_bf16 v[208:211], a[20:23], a[240:243], v[208:211]
    buffer_load_dwordx4 a[172:175], v55, s[8:11], s62 offen sc1
    ds_read_b64_tr_b16 a[58:59], v49 offset:50176
    v_mfma_f32_16x16x32_bf16 v[212:215], a[20:23], a[244:247], v[212:215]
    ds_read_b64_tr_b16 a[60:61], v49 offset:57344
    v_mfma_f32_16x16x32_bf16 v[212:215], a[16:19], a[228:231], v[212:215]
    v_mfma_f32_16x16x32_bf16 a[80:83], a[16:19], a[232:235], a[80:83]
    ds_read_b64_tr_b16 a[62:63], v49 offset:58368
    v_mfma_f32_16x16x32_bf16 a[80:83], a[20:23], a[248:251], a[80:83]
    s_add_u32 s62, s62, 0x20000
    v_mfma_f32_16x16x32_bf16 a[84:87], a[20:23], a[252:255], a[84:87]
    s_add_u32 s52, s47, 0
    v_mfma_f32_16x16x32_bf16 a[84:87], a[16:19], a[236:239], a[84:87]
    buffer_store_dwordx4 v[76:79], v1, s[48:51], s52 offen offset:3072 sc1
    v_mfma_f32_16x16x32_bf16 a[92:95], a[24:27], a[236:239], a[92:95]
    v_mfma_f32_16x16x32_bf16 a[92:95], a[28:31], a[252:255], a[92:95]
    v_mfma_f32_16x16x32_bf16 a[88:91], a[28:31], a[248:251], a[88:91]
    v_mfma_f32_16x16x32_bf16 a[88:91], a[24:27], a[232:235], a[88:91]
    v_mfma_f32_16x16x32_bf16 v[220:223], a[24:27], a[228:231], v[220:223]
    s_cmp_eq_u32 s45, 0
    s_cbranch_scc1 k12_ool_50
k12_oolret_51:
    v_mfma_f32_16x16x32_bf16 v[220:223], a[28:31], a[244:247], v[220:223]
    v_mfma_f32_16x16x32_bf16 v[216:219], a[28:31], a[240:243], v[216:219]
    v_mfma_f32_16x16x32_bf16 v[216:219], a[24:27], a[224:227], v[216:219]
    s_waitcnt vmcnt(10) lgkmcnt(0)
    s_barrier
    v_mfma_f32_16x16x32_bf16 v[224:227], a[32:35], a[224:227], v[224:227]
    v_mfma_f32_16x16x32_bf16 v[224:227], a[36:39], a[240:243], v[224:227]
    s_add_u32 m0, s60, 114688
    ds_read_b64_tr_b16 a[0:1], v42 offset:0
    ds_read_b64_tr_b16 a[2:3], v42 offset:1024
    v_mfma_f32_16x16x32_bf16 v[228:231], a[36:39], a[244:247], v[228:231]
    buffer_load_dwordx4 v38, s[12:15], s61 offen offset:0 lds
    v_mfma_f32_16x16x32_bf16 v[228:231], a[32:35], a[228:231], v[228:231]
    ds_read_b64_tr_b16 a[4:5], v42 offset:8192
    v_mfma_f32_16x16x32_bf16 a[96:99], a[32:35], a[232:235], a[96:99]
    buffer_load_dwordx4 v39, s[12:15], s61 offen offset:1024 lds
    ds_read_b64_tr_b16 a[6:7], v42 offset:9216
    v_mfma_f32_16x16x32_bf16 a[96:99], a[36:39], a[248:251], a[96:99]
    ds_read_b64_tr_b16 a[8:9], v43 offset:0
    v_mfma_f32_16x16x32_bf16 a[100:103], a[36:39], a[252:255], a[100:103]
    v_mfma_f32_16x16x32_bf16 a[100:103], a[32:35], a[236:239], a[100:103]
    buffer_load_dwordx4 v40, s[12:15], s61 offen offset:2048 lds
    ds_read_b64_tr_b16 a[10:11], v43 offset:1024
    v_mfma_f32_16x16x32_bf16 a[108:111], a[40:43], a[236:239], a[108:111]
    ds_read_b64_tr_b16 a[12:13], v43 offset:8192
    v_mfma_f32_16x16x32_bf16 a[108:111], a[44:47], a[252:255], a[108:111]
    ds_read_b64_tr_b16 a[14:15], v43 offset:9216
    v_mfma_f32_16x16x32_bf16 a[104:107], a[44:47], a[248:251], a[104:107]
    buffer_load_dwordx4 v41, s[12:15], s61 offen offset:3072 lds
    ds_read_b64_tr_b16 a[16:17], v44 offset:0
    v_mfma_f32_16x16x32_bf16 a[104:107], a[40:43], a[232:235], a[104:107]
    v_mfma_f32_16x16x32_bf16 v[236:239], a[40:43], a[228:231], v[236:239]
    s_add_u32 s61, s61, 0x80000
    ds_read_b64_tr_b16 a[18:19], v44 offset:1024
    v_mfma_f32_16x16x32_bf16 v[236:239], a[44:47], a[244:247], v[236:239]
    buffer_load_dwordx4 a[176:179], v36, s[8:11], s62 offen sc1
    ds_read_b64_tr_b16 a[20:21], v44 offset:8192
    v_mfma_f32_16x16x32_bf16 v[232:235], a[44:47], a[240:243], v[232:235]
    ds_read_b64_tr_b16 a[22:23], v44 offset:9216
    v_mfma_f32_16x16x32_bf16 v[232:235], a[40:43], a[224:227], v[232:235]
    buffer_load_dwordx4 a[180:183], v54, s[8:11], s62 offen sc1
    v_mfma_f32_16x16x32_bf16 v[240:243], a[48:51], a[224:227], v[240:243]
    ds_read_b64_tr_b16 a[24:25], v45 offset:0
    v_mfma_f32_16x16x32_bf16 v[240:243], a[52:55], a[240:243], v[240:243]
    ds_read_b64_tr_b16 a[26:27], v45 offset:1024
    v_mfma_f32_16x16x32_bf16 v[244:247], a[52:55], a[244:247], v[244:247]
    buffer_load_dwordx4 a[184:187], v37, s[8:11], s62 offen sc1
    ds_read_b64_tr_b16 a[28:29], v45 offset:8192
    v_mfma_f32_16x16x32_bf16 v[244:247], a[48:51], a[228:231], v[244:247]
    v_mfma_f32_16x16x32_bf16 a[112:115], a[48:51], a[232:235], a[112:115]
    ds_read_b64_tr_b16 a[30:31], v45 offset:9216
    v_mfma_f32_16x16x32_bf16 a[112:115], a[52:55], a[248:251], a[112:115]
    buffer_load_dwordx4 a[188:191], v55, s[8:11], s62 offen sc1
    v_mfma_f32_16x16x32_bf16 a[116:119], a[52:55], a[252:255], a[116:119]
    v_mfma_f32_16x16x32_bf16 a[116:119], a[48:51], a[236:239], a[116:119]
    s_add_u32 s62, s62, 0x20000
    v_mfma_f32_16x16x32_bf16 a[124:127], a[56:59], a[236:239], a[124:127]
    s_add_u32 s52, s47, 4096
    v_mfma_f32_16x16x32_bf16 a[124:127], a[60:63], a[252:255], a[124:127]
    buffer_store_dwordx4 v[80:83], v1, s[48:51], s52 offen offset:0 sc1
    v_mfma_f32_16x16x32_bf16 a[120:123], a[60:63], a[248:251], a[120:123]
    v_mfma_f32_16x16x32_bf16 a[120:123], a[56:59], a[232:235], a[120:123]
    v_mfma_f32_16x16x32_bf16 v[252:255], a[56:59], a[228:231], v[252:255]
    v_mfma_f32_16x16x32_bf16 v[252:255], a[60:63], a[244:247], v[252:255]
    v_mfma_f32_16x16x32_bf16 v[248:251], a[60:63], a[240:243], v[248:251]
    v_mfma_f32_16x16x32_bf16 v[248:251], a[56:59], a[224:227], v[248:251]
    s_waitcnt vmcnt(15) lgkmcnt(0)
    v_mfma_f32_16x16x32_bf16 v[192:195], a[0:3], a[128:131], v[192:195]
    v_mfma_f32_16x16x32_bf16 v[192:195], a[4:7], a[144:147], v[192:195]
    buffer_load_dwordx4 a[192:195], v36, s[8:11], s62 offen sc1
    ds_read_b64_tr_b16 a[32:33], v46 offset:0
    v_mfma_f32_16x16x32_bf16 v[196:199], a[4:7], a[148:151], v[196:199]
    ds_read_b64_tr_b16 a[34:35], v46 offset:1024
    v_mfma_f32_16x16x32_bf16 v[196:199], a[0:3], a[132:135], v[196:199]
    ds_read_b64_tr_b16 a[36:37], v46 offset:8192
    v_mfma_f32_16x16x32_bf16 a[64:67], a[0:3], a[136:139], a[64:67]
    ds_read_b64_tr_b16 a[38:39], v46 offset:9216
    v_mfma_f32_16x16x32_bf16 a[64:67], a[4:7], a[152:155], a[64:67]
    ds_read_b64_tr_b16 a[40:41], v47 offset:0
    v_mfma_f32_16x16x32_bf16 a[68:71], a[4:7], a[156:159], a[68:71]
    buffer_load_dwordx4 a[196:199], v54, s[8:11], s62 offen sc1
    v_mfma_f32_16x16x32_bf16 a[68:71], a[0:3], a[140:143], a[68:71]
    ds_read_b64_tr_b16 a[42:43], v47 offset:1024
    v_mfma_f32_16x16x32_bf16 a[76:79], a[8:11], a[140:143], a[76:79]
    ds_read_b64_tr_b16 a[44:45], v47 offset:8192
    v_mfma_f32_16x16x32_bf16 a[76:79], a[12:15], a[156:159], a[76:79]
    ds_read_b64_tr_b16 a[46:47], v47 offset:9216
    v_mfma_f32_16x16x32_bf16 a[72:75], a[12:15], a[152:155], a[72:75]
    ds_read_b64_tr_b16 a[48:49], v48 offset:0
    v_mfma_f32_16x16x32_bf16 a[72:75], a[8:11], a[136:139], a[72:75]
    buffer_load_dwordx4 a[200:203], v37, s[8:11], s62 offen sc1
    v_mfma_f32_16x16x32_bf16 v[204:207], a[8:11], a[132:135], v[204:207]
    ds_read_b64_tr_b16 a[50:51], v48 offset:1024
    v_mfma_f32_16x16x32_bf16 v[204:207], a[12:15], a[148:151], v[204:207]
    ds_read_b64_tr_b16 a[52:53], v48 offset:8192
    v_mfma_f32_16x16x32_bf16 v[200:203], a[12:15], a[144:147], v[200:203]
    ds_read_b64_tr_b16 a[54:55], v48 offset:9216
    v_mfma_f32_16x16x32_bf16 v[200:203], a[8:11], a[128:131], v[200:203]
    v_mfma_f32_16x16x32_bf16 v[208:211], a[16:19], a[128:131], v[208:211]
    ds_read_b64_tr_b16 a[56:57], v49 offset:0
    v_mfma_f32_16x16x32_bf16 v[208:211], a[20:23], a[144:147], v[208:211]
    buffer_load_dwordx4 a[204:207], v55, s[8:11], s62 offen sc1
    ds_read_b64_tr_b16 a[58:59], v49 offset:1024
    v_mfma_f32_16x16x32_bf16 v[212:215], a[20:23], a[148:151], v[212:215]
    ds_read_b64_tr_b16 a[60:61], v49 offset:8192
    v_mfma_f32_16x16x32_bf16 v[212:215], a[16:19], a[132:135], v[212:215]
    v_mfma_f32_16x16x32_bf16 a[80:83], a[16:19], a[136:139], a[80:83]
    ds_read_b64_tr_b16 a[62:63], v49 offset:9216
    v_mfma_f32_16x16x32_bf16 a[80:83], a[20:23], a[152:155], a[80:83]
    s_add_u32 s62, s62, 0x20000
    v_mfma_f32_16x16x32_bf16 a[84:87], a[20:23], a[156:159], a[84:87]
    s_add_u32 s52, s47, 4096
    v_mfma_f32_16x16x32_bf16 a[84:87], a[16:19], a[140:143], a[84:87]
    buffer_store_dwordx4 v[84:87], v1, s[48:51], s52 offen offset:1024 sc1
    v_mfma_f32_16x16x32_bf16 a[92:95], a[24:27], a[140:143], a[92:95]
    v_mfma_f32_16x16x32_bf16 a[92:95], a[28:31], a[156:159], a[92:95]
    v_mfma_f32_16x16x32_bf16 a[88:91], a[28:31], a[152:155], a[88:91]
    v_mfma_f32_16x16x32_bf16 a[88:91], a[24:27], a[136:139], a[88:91]
    v_mfma_f32_16x16x32_bf16 v[220:223], a[24:27], a[132:135], v[220:223]
    v_mfma_f32_16x16x32_bf16 v[220:223], a[28:31], a[148:151], v[220:223]
    v_mfma_f32_16x16x32_bf16 v[216:219], a[28:31], a[144:147], v[216:219]
    v_mfma_f32_16x16x32_bf16 v[216:219], a[24:27], a[128:131], v[216:219]
    s_waitcnt vmcnt(10) lgkmcnt(0)
    s_barrier
    v_mfma_f32_16x16x32_bf16 v[224:227], a[32:35], a[128:131], v[224:227]
    v_mfma_f32_16x16x32_bf16 v[224:227], a[36:39], a[144:147], v[224:227]
    s_add_u32 m0, s60, 131072
    ds_read_b64_tr_b16 a[0:1], v42 offset:16384
    ds_read_b64_tr_b16 a[2:3], v42 offset:17408
    v_mfma_f32_16x16x32_bf16 v[228:231], a[36:39], a[148:151], v[228:231]
    buffer_load_dwordx4 v38, s[12:15], s61 offen offset:0 lds
    v_mfma_f32_16x16x32_bf16 v[228:231], a[32:35], a[132:135], v[228:231]
    ds_read_b64_tr_b16 a[4:5], v42 offset:24576
    v_mfma_f32_16x16x32_bf16 a[96:99], a[32:35], a[136:139], a[96:99]
    buffer_load_dwordx4 v39, s[12:15], s61 offen offset:1024 lds
    ds_read_b64_tr_b16 a[6:7], v42 offset:25600
    v_mfma_f32_16x16x32_bf16 a[96:99], a[36:39], a[152:155], a[96:99]
    ds_read_b64_tr_b16 a[8:9], v43 offset:16384
    v_mfma_f32_16x16x32_bf16 a[100:103], a[36:39], a[156:159], a[100:103]
    v_mfma_f32_16x16x32_bf16 a[100:103], a[32:35], a[140:143], a[100:103]
    buffer_load_dwordx4 v40, s[12:15], s61 offen offset:2048 lds
    ds_read_b64_tr_b16 a[10:11], v43 offset:17408
    v_mfma_f32_16x16x32_bf16 a[108:111], a[40:43], a[140:143], a[108:111]
    ds_read_b64_tr_b16 a[12:13], v43 offset:24576
    v_mfma_f32_16x16x32_bf16 a[108:111], a[44:47], a[156:159], a[108:111]
    ds_read_b64_tr_b16 a[14:15], v43 offset:25600
    v_mfma_f32_16x16x32_bf16 a[104:107], a[44:47], a[152:155], a[104:107]
    ds_read_b64_tr_b16 a[16:17], v44 offset:16384
    v_mfma_f32_16x16x32_bf16 a[104:107], a[40:43], a[136:139], a[104:107]
    buffer_load_dwordx4 v41, s[12:15], s61 offen offset:3072 lds
    v_mfma_f32_16x16x32_bf16 v[236:239], a[40:43], a[132:135], v[236:239]
    ds_read_b64_tr_b16 a[18:19], v44 offset:17408
    v_mfma_f32_16x16x32_bf16 v[236:239], a[44:47], a[148:151], v[236:239]
    s_add_u32 s61, s61, 0x80000
    ds_read_b64_tr_b16 a[20:21], v44 offset:24576
    v_mfma_f32_16x16x32_bf16 v[232:235], a[44:47], a[144:147], v[232:235]
    buffer_load_dwordx4 a[208:211], v36, s[8:11], s62 offen sc1
    ds_read_b64_tr_b16 a[22:23], v44 offset:25600
    v_mfma_f32_16x16x32_bf16 v[232:235], a[40:43], a[128:131], v[232:235]
    v_mfma_f32_16x16x32_bf16 v[240:243], a[48:51], a[128:131], v[240:243]
    ds_read_b64_tr_b16 a[24:25], v45 offset:16384
    v_mfma_f32_16x16x32_bf16 v[240:243], a[52:55], a[144:147], v[240:243]
    buffer_load_dwordx4 a[212:215], v54, s[8:11], s62 offen sc1
    ds_read_b64_tr_b16 a[26:27], v45 offset:17408
    v_mfma_f32_16x16x32_bf16 v[244:247], a[52:55], a[148:151], v[244:247]
    ds_read_b64_tr_b16 a[28:29], v45 offset:24576
    v_mfma_f32_16x16x32_bf16 v[244:247], a[48:51], a[132:135], v[244:247]
    v_mfma_f32_16x16x32_bf16 a[112:115], a[48:51], a[136:139], a[112:115]
    buffer_load_dwordx4 a[216:219], v37, s[8:11], s62 offen sc1
    ds_read_b64_tr_b16 a[30:31], v45 offset:25600
    v_mfma_f32_16x16x32_bf16 a[112:115], a[52:55], a[152:155], a[112:115]
    v_mfma_f32_16x16x32_bf16 a[116:119], a[52:55], a[156:159], a[116:119]
    v_mfma_f32_16x16x32_bf16 a[116:119], a[48:51], a[140:143], a[116:119]
    v_mfma_f32_16x16x32_bf16 a[124:127], a[56:59], a[140:143], a[124:127]
    buffer_load_dwordx4 a[220:223], v55, s[8:11], s62 offen sc1
    v_mfma_f32_16x16x32_bf16 a[124:127], a[60:63], a[156:159], a[124:127]
    v_mfma_f32_16x16x32_bf16 a[120:123], a[60:63], a[152:155], a[120:123]
    s_add_u32 s62, s62, 0x20000
    v_mfma_f32_16x16x32_bf16 a[120:123], a[56:59], a[136:139], a[120:123]
    v_mfma_f32_16x16x32_bf16 v[252:255], a[56:59], a[132:135], v[252:255]
    s_cmp_eq_u32 s45, 0
    s_cbranch_scc1 k12_ool_52
k12_oolret_53:
    v_mfma_f32_16x16x32_bf16 v[252:255], a[60:63], a[148:151], v[252:255]
    v_mfma_f32_16x16x32_bf16 v[248:251], a[60:63], a[144:147], v[248:251]
    v_mfma_f32_16x16x32_bf16 v[248:251], a[56:59], a[128:131], v[248:251]
    s_waitcnt vmcnt(14) lgkmcnt(0)
    v_mfma_f32_16x16x32_bf16 v[192:195], a[0:3], a[160:163], v[192:195]
    v_mfma_f32_16x16x32_bf16 v[192:195], a[4:7], a[176:179], v[192:195]
    buffer_load_dwordx4 a[224:227], v36, s[8:11], s62 offen sc1
    ds_read_b64_tr_b16 a[32:33], v46 offset:16384
    v_mfma_f32_16x16x32_bf16 v[196:199], a[4:7], a[180:183], v[196:199]
    ds_read_b64_tr_b16 a[34:35], v46 offset:17408
    v_mfma_f32_16x16x32_bf16 v[196:199], a[0:3], a[164:167], v[196:199]
    ds_read_b64_tr_b16 a[36:37], v46 offset:24576
    v_mfma_f32_16x16x32_bf16 a[64:67], a[0:3], a[168:171], a[64:67]
    ds_read_b64_tr_b16 a[38:39], v46 offset:25600
    v_mfma_f32_16x16x32_bf16 a[64:67], a[4:7], a[184:187], a[64:67]
    ds_read_b64_tr_b16 a[40:41], v47 offset:16384
    v_mfma_f32_16x16x32_bf16 a[68:71], a[4:7], a[188:191], a[68:71]
    buffer_load_dwordx4 a[228:231], v54, s[8:11], s62 offen sc1
    v_mfma_f32_16x16x32_bf16 a[68:71], a[0:3], a[172:175], a[68:71]
    ds_read_b64_tr_b16 a[42:43], v47 offset:17408
    v_mfma_f32_16x16x32_bf16 a[76:79], a[8:11], a[172:175], a[76:79]
    ds_read_b64_tr_b16 a[44:45], v47 offset:24576
    v_mfma_f32_16x16x32_bf16 a[76:79], a[12:15], a[188:191], a[76:79]
    ds_read_b64_tr_b16 a[46:47], v47 offset:25600
    v_mfma_f32_16x16x32_bf16 a[72:75], a[12:15], a[184:187], a[72:75]
    ds_read_b64_tr_b16 a[48:49], v48 offset:16384
    v_mfma_f32_16x16x32_bf16 a[72:75], a[8:11], a[168:171], a[72:75]
    buffer_load_dwordx4 a[232:235], v37, s[8:11], s62 offen sc1
    v_mfma_f32_16x16x32_bf16 v[204:207], a[8:11], a[164:167], v[204:207]
    ds_read_b64_tr_b16 a[50:51], v48 offset:17408
    v_mfma_f32_16x16x32_bf16 v[204:207], a[12:15], a[180:183], v[204:207]
    ds_read_b64_tr_b16 a[52:53], v48 offset:24576
    v_mfma_f32_16x16x32_bf16 v[200:203], a[12:15], a[176:179], v[200:203]
    ds_read_b64_tr_b16 a[54:55], v48 offset:25600
    v_mfma_f32_16x16x32_bf16 v[200:203], a[8:11], a[160:163], v[200:203]
    v_mfma_f32_16x16x32_bf16 v[208:211], a[16:19], a[160:163], v[208:211]
    ds_read_b64_tr_b16 a[56:57], v49 offset:16384
    v_mfma_f32_16x16x32_bf16 v[208:211], a[20:23], a[176:179], v[208:211]
    buffer_load_dwordx4 a[236:239], v55, s[8:11], s62 offen sc1
    ds_read_b64_tr_b16 a[58:59], v49 offset:17408
    v_mfma_f32_16x16x32_bf16 v[212:215], a[20:23], a[180:183], v[212:215]
    ds_read_b64_tr_b16 a[60:61], v49 offset:24576
    v_mfma_f32_16x16x32_bf16 v[212:215], a[16:19], a[164:167], v[212:215]
    v_mfma_f32_16x16x32_bf16 a[80:83], a[16:19], a[168:171], a[80:83]
    ds_read_b64_tr_b16 a[62:63], v49 offset:25600
    v_mfma_f32_16x16x32_bf16 a[80:83], a[20:23], a[184:187], a[80:83]
    s_add_u32 s62, s62, 0x20000
    v_mfma_f32_16x16x32_bf16 a[84:87], a[20:23], a[188:191], a[84:87]
    s_add_u32 s52, s47, 4096
    v_mfma_f32_16x16x32_bf16 a[84:87], a[16:19], a[172:175], a[84:87]
    buffer_store_dwordx4 v[88:91], v1, s[48:51], s52 offen offset:2048 sc1
    v_mfma_f32_16x16x32_bf16 a[92:95], a[24:27], a[172:175], a[92:95]
    v_mfma_f32_16x16x32_bf16 a[92:95], a[28:31], a[188:191], a[92:95]
    v_mfma_f32_16x16x32_bf16 a[88:91], a[28:31], a[184:187], a[88:91]
    v_mfma_f32_16x16x32_bf16 a[88:91], a[24:27], a[168:171], a[88:91]
    v_mfma_f32_16x16x32_bf16 v[220:223], a[24:27], a[164:167], v[220:223]
    v_mfma_f32_16x16x32_bf16 v[220:223], a[28:31], a[180:183], v[220:223]
    v_mfma_f32_16x16x32_bf16 v[216:219], a[28:31], a[176:179], v[216:219]
    v_mfma_f32_16x16x32_bf16 v[216:219], a[24:27], a[160:163], v[216:219]
    s_waitcnt vmcnt(9) lgkmcnt(0)
    s_barrier
    v_mfma_f32_16x16x32_bf16 v[224:227], a[32:35], a[160:163], v[224:227]
    v_mfma_f32_16x16x32_bf16 v[224:227], a[36:39], a[176:179], v[224:227]
    s_add_u32 m0, s60, 147456
    ds_read_b64_tr_b16 a[0:1], v42 offset:32768
    ds_read_b64_tr_b16 a[2:3], v42 offset:33792
    v_mfma_f32_16x16x32_bf16 v[228:231], a[36:39], a[180:183], v[228:231]
    buffer_load_dwordx4 v38, s[12:15], s61 offen offset:0 lds
    v_mfma_f32_16x16x32_bf16 v[228:231], a[32:35], a[164:167], v[228:231]
    ds_read_b64_tr_b16 a[4:5], v42 offset:40960
    v_mfma_f32_16x16x32_bf16 a[96:99], a[32:35], a[168:171], a[96:99]
    buffer_load_dwordx4 v39, s[12:15], s61 offen offset:1024 lds
    ds_read_b64_tr_b16 a[6:7], v42 offset:41984
    v_mfma_f32_16x16x32_bf16 a[96:99], a[36:39], a[184:187], a[96:99]
    ds_read_b64_tr_b16 a[8:9], v43 offset:32768
    v_mfma_f32_16x16x32_bf16 a[100:103], a[36:39], a[188:191], a[100:103]
    v_mfma_f32_16x16x32_bf16 a[100:103], a[32:35], a[172:175], a[100:103]
    buffer_load_dwordx4 v40, s[12:15], s61 offen offset:2048 lds
    ds_read_b64_tr_b16 a[10:11], v43 offset:33792
    v_mfma_f32_16x16x32_bf16 a[108:111], a[40:43], a[172:175], a[108:111]
    ds_read_b64_tr_b16 a[12:13], v43 offset:40960
    v_mfma_f32_16x16x32_bf16 a[108:111], a[44:47], a[188:191], a[108:111]
    ds_read_b64_tr_b16 a[14:15], v43 offset:41984
    v_mfma_f32_16x16x32_bf16 a[104:107], a[44:47], a[184:187], a[104:107]
    buffer_load_dwordx4 v41, s[12:15], s61 offen offset:3072 lds
    ds_read_b64_tr_b16 a[16:17], v44 offset:32768
    v_mfma_f32_16x16x32_bf16 a[104:107], a[40:43], a[168:171], a[104:107]
    v_mfma_f32_16x16x32_bf16 v[236:239], a[40:43], a[164:167], v[236:239]
    s_add_u32 s61, s61, 0x80000
    ds_read_b64_tr_b16 a[18:19], v44 offset:33792
    v_mfma_f32_16x16x32_bf16 v[236:239], a[44:47], a[180:183], v[236:239]
    buffer_load_dwordx4 a[240:243], v36, s[8:11], s62 offen sc1
    ds_read_b64_tr_b16 a[20:21], v44 offset:40960
    v_mfma_f32_16x16x32_bf16 v[232:235], a[44:47], a[176:179], v[232:235]
    ds_read_b64_tr_b16 a[22:23], v44 offset:41984
    v_mfma_f32_16x16x32_bf16 v[232:235], a[40:43], a[160:163], v[232:235]
    buffer_load_dwordx4 a[244:247], v54, s[8:11], s62 offen sc1
    v_mfma_f32_16x16x32_bf16 v[240:243], a[48:51], a[160:163], v[240:243]
    ds_read_b64_tr_b16 a[24:25], v45 offset:32768
    v_mfma_f32_16x16x32_bf16 v[240:243], a[52:55], a[176:179], v[240:243]
    ds_read_b64_tr_b16 a[26:27], v45 offset:33792
    v_mfma_f32_16x16x32_bf16 v[244:247], a[52:55], a[180:183], v[244:247]
    buffer_load_dwordx4 a[248:251], v37, s[8:11], s62 offen sc1
    ds_read_b64_tr_b16 a[28:29], v45 offset:40960
    v_mfma_f32_16x16x32_bf16 v[244:247], a[48:51], a[164:167], v[244:247]
    v_mfma_f32_16x16x32_bf16 a[112:115], a[48:51], a[168:171], a[112:115]
    ds_read_b64_tr_b16 a[30:31], v45 offset:41984
    v_mfma_f32_16x16x32_bf16 a[112:115], a[52:55], a[184:187], a[112:115]
    buffer_load_dwordx4 a[252:255], v55, s[8:11], s62 offen sc1
    v_mfma_f32_16x16x32_bf16 a[116:119], a[52:55], a[188:191], a[116:119]
    v_mfma_f32_16x16x32_bf16 a[116:119], a[48:51], a[172:175], a[116:119]
    s_add_u32 s62, s62, 0x20000
    v_mfma_f32_16x16x32_bf16 a[124:127], a[56:59], a[172:175], a[124:127]
    s_add_u32 s52, s47, 4096
    v_mfma_f32_16x16x32_bf16 a[124:127], a[60:63], a[188:191], a[124:127]
    buffer_store_dwordx4 v[92:95], v1, s[48:51], s52 offen offset:3072 sc1
    v_mfma_f32_16x16x32_bf16 a[120:123], a[60:63], a[184:187], a[120:123]
    v_mfma_f32_16x16x32_bf16 a[120:123], a[56:59], a[168:171], a[120:123]
    v_mfma_f32_16x16x32_bf16 v[252:255], a[56:59], a[164:167], v[252:255]
    s_cmp_eq_u32 s45, 0
    s_cbranch_scc1 k12_ool_54
k12_oolret_55:
    v_mfma_f32_16x16x32_bf16 v[252:255], a[60:63], a[180:183], v[252:255]
    v_mfma_f32_16x16x32_bf16 v[248:251], a[60:63], a[176:179], v[248:251]
    v_mfma_f32_16x16x32_bf16 v[248:251], a[56:59], a[160:163], v[248:251]
    s_waitcnt vmcnt(14) lgkmcnt(0)
    v_mfma_f32_16x16x32_bf16 v[192:195], a[0:3], a[192:195], v[192:195]
    v_mfma_f32_16x16x32_bf16 v[192:195], a[4:7], a[208:211], v[192:195]
    buffer_load_dwordx4 a[128:131], v36, s[8:11], s62 offen sc1
    ds_read_b64_tr_b16 a[32:33], v46 offset:32768
    v_mfma_f32_16x16x32_bf16 v[196:199], a[4:7], a[212:215], v[196:199]
    ds_read_b64_tr_b16 a[34:35], v46 offset:33792
    v_mfma_f32_16x16x32_bf16 v[196:199], a[0:3], a[196:199], v[196:199]
    ds_read_b64_tr_b16 a[36:37], v46 offset:40960
    v_mfma_f32_16x16x32_bf16 a[64:67], a[0:3], a[200:203], a[64:67]
    ds_read_b64_tr_b16 a[38:39], v46 offset:41984
    v_mfma_f32_16x16x32_bf16 a[64:67], a[4:7], a[216:219], a[64:67]
    ds_read_b64_tr_b16 a[40:41], v47 offset:32768
    v_mfma_f32_16x16x32_bf16 a[68:71], a[4:7], a[220:223], a[68:71]
    buffer_load_dwordx4 a[132:135], v54, s[8:11], s62 offen sc1
    v_mfma_f32_16x16x32_bf16 a[68:71], a[0:3], a[204:207], a[68:71]
    ds_read_b64_tr_b16 a[42:43], v47 offset:33792
    v_mfma_f32_16x16x32_bf16 a[76:79], a[8:11], a[204:207], a[76:79]
    ds_read_b64_tr_b16 a[44:45], v47 offset:40960
    v_mfma_f32_16x16x32_bf16 a[76:79], a[12:15], a[220:223], a[76:79]
    ds_read_b64_tr_b16 a[46:47], v47 offset:41984
    v_mfma_f32_16x16x32_bf16 a[72:75], a[12:15], a[216:219], a[72:75]
    ds_read_b64_tr_b16 a[48:49], v48 offset:32768
    v_mfma_f32_16x16x32_bf16 a[72:75], a[8:11], a[200:203], a[72:75]
    buffer_load_dwordx4 a[136:139], v37, s[8:11], s62 offen sc1
    v_mfma_f32_16x16x32_bf16 v[204:207], a[8:11], a[196:199], v[204:207]
    ds_read_b64_tr_b16 a[50:51], v48 offset:33792
    v_mfma_f32_16x16x32_bf16 v[204:207], a[12:15], a[212:215], v[204:207]
    ds_read_b64_tr_b16 a[52:53], v48 offset:40960
    v_mfma_f32_16x16x32_bf16 v[200:203], a[12:15], a[208:211], v[200:203]
    ds_read_b64_tr_b16 a[54:55], v48 offset:41984
    v_mfma_f32_16x16x32_bf16 v[200:203], a[8:11], a[192:195], v[200:203]
    v_mfma_f32_16x16x32_bf16 v[208:211], a[16:19], a[192:195], v[208:211]
    ds_read_b64_tr_b16 a[56:57], v49 offset:32768
    v_mfma_f32_16x16x32_bf16 v[208:211], a[20:23], a[208:211], v[208:211]
    buffer_load_dwordx4 a[140:143], v55, s[8:11], s62 offen sc1
    ds_read_b64_tr_b16 a[58:59], v49 offset:33792
    v_mfma_f32_16x16x32_bf16 v[212:215], a[20:23], a[212:215], v[212:215]
    ds_read_b64_tr_b16 a[60:61], v49 offset:40960
    v_mfma_f32_16x16x32_bf16 v[212:215], a[16:19], a[196:199], v[212:215]
    v_mfma_f32_16x16x32_bf16 a[80:83], a[16:19], a[200:203], a[80:83]
    ds_read_b64_tr_b16 a[62:63], v49 offset:41984
    v_mfma_f32_16x16x32_bf16 a[80:83], a[20:23], a[216:219], a[80:83]
    s_add_u32 s62, s62, 0x20000
    v_mfma_f32_16x16x32_bf16 a[84:87], a[20:23], a[220:223], a[84:87]
    s_add_u32 s52, s47, 8192
    v_mfma_f32_16x16x32_bf16 a[84:87], a[16:19], a[204:207], a[84:87]
    buffer_store_dwordx4 v[104:107], v1, s[48:51], s52 offen offset:2048 sc1
    v_mfma_f32_16x16x32_bf16 a[92:95], a[24:27], a[204:207], a[92:95]
    v_mfma_f32_16x16x32_bf16 a[92:95], a[28:31], a[220:223], a[92:95]
    v_mfma_f32_16x16x32_bf16 a[88:91], a[28:31], a[216:219], a[88:91]
    v_mfma_f32_16x16x32_bf16 a[88:91], a[24:27], a[200:203], a[88:91]
    v_mfma_f32_16x16x32_bf16 v[220:223], a[24:27], a[196:199], v[220:223]
    v_mfma_f32_16x16x32_bf16 v[220:223], a[28:31], a[212:215], v[220:223]
    v_mfma_f32_16x16x32_bf16 v[216:219], a[28:31], a[208:211], v[216:219]
    v_mfma_f32_16x16x32_bf16 v[216:219], a[24:27], a[192:195], v[216:219]
    s_waitcnt vmcnt(10) lgkmcnt(0)
    s_barrier
    v_mfma_f32_16x16x32_bf16 v[224:227], a[32:35], a[192:195], v[224:227]
    v_mfma_f32_16x16x32_bf16 v[224:227], a[36:39], a[208:211], v[224:227]
    s_add_u32 m0, s60, 98304
    ds_read_b64_tr_b16 a[0:1], v42 offset:49152
    ds_read_b64_tr_b16 a[2:3], v42 offset:50176
    v_mfma_f32_16x16x32_bf16 v[228:231], a[36:39], a[212:215], v[228:231]
    buffer_load_dwordx4 v38, s[12:15], s61 offen offset:0 lds
    v_mfma_f32_16x16x32_bf16 v[228:231], a[32:35], a[196:199], v[228:231]
    ds_read_b64_tr_b16 a[4:5], v42 offset:57344
    v_mfma_f32_16x16x32_bf16 a[96:99], a[32:35], a[200:203], a[96:99]
    buffer_load_dwordx4 v39, s[12:15], s61 offen offset:1024 lds
    ds_read_b64_tr_b16 a[6:7], v42 offset:58368
    v_mfma_f32_16x16x32_bf16 a[96:99], a[36:39], a[216:219], a[96:99]
    ds_read_b64_tr_b16 a[8:9], v43 offset:49152
    v_mfma_f32_16x16x32_bf16 a[100:103], a[36:39], a[220:223], a[100:103]
    v_mfma_f32_16x16x32_bf16 a[100:103], a[32:35], a[204:207], a[100:103]
    buffer_load_dwordx4 v40, s[12:15], s61 offen offset:2048 lds
    ds_read_b64_tr_b16 a[10:11], v43 offset:50176
    v_mfma_f32_16x16x32_bf16 a[108:111], a[40:43], a[204:207], a[108:111]
    ds_read_b64_tr_b16 a[12:13], v43 offset:57344
    v_mfma_f32_16x16x32_bf16 a[108:111], a[44:47], a[220:223], a[108:111]
    ds_read_b64_tr_b16 a[14:15], v43 offset:58368
    v_mfma_f32_16x16x32_bf16 a[104:107], a[44:47], a[216:219], a[104:107]
    buffer_load_dwordx4 v41, s[12:15], s61 offen offset:3072 lds
    ds_read_b64_tr_b16 a[16:17], v44 offset:49152
    v_mfma_f32_16x16x32_bf16 a[104:107], a[40:43], a[200:203], a[104:107]
    v_mfma_f32_16x16x32_bf16 v[236:239], a[40:43], a[196:199], v[236:239]
    s_add_u32 s61, s61, 0x80000
    ds_read_b64_tr_b16 a[18:19], v44 offset:50176
    v_mfma_f32_16x16x32_bf16 v[236:239], a[44:47], a[212:215], v[236:239]
    buffer_load_dwordx4 a[144:147], v36, s[8:11], s62 offen sc1
    ds_read_b64_tr_b16 a[20:21], v44 offset:57344
    v_mfma_f32_16x16x32_bf16 v[232:235], a[44:47], a[208:211], v[232:235]
    ds_read_b64_tr_b16 a[22:23], v44 offset:58368
    v_mfma_f32_16x16x32_bf16 v[232:235], a[40:43], a[192:195], v[232:235]
    buffer_load_dwordx4 a[148:151], v54, s[8:11], s62 offen sc1
    v_mfma_f32_16x16x32_bf16 v[240:243], a[48:51], a[192:195], v[240:243]
    ds_read_b64_tr_b16 a[24:25], v45 offset:49152
    v_mfma_f32_16x16x32_bf16 v[240:243], a[52:55], a[208:211], v[240:243]
    ds_read_b64_tr_b16 a[26:27], v45 offset:50176
    v_mfma_f32_16x16x32_bf16 v[244:247], a[52:55], a[212:215], v[244:247]
    buffer_load_dwordx4 a[152:155], v37, s[8:11], s62 offen sc1
    ds_read_b64_tr_b16 a[28:29], v45 offset:57344
    v_mfma_f32_16x16x32_bf16 v[244:247], a[48:51], a[196:199], v[244:247]
    v_mfma_f32_16x16x32_bf16 a[112:115], a[48:51], a[200:203], a[112:115]
    ds_read_b64_tr_b16 a[30:31], v45 offset:58368
    v_mfma_f32_16x16x32_bf16 a[112:115], a[52:55], a[216:219], a[112:115]
    buffer_load_dwordx4 a[156:159], v55, s[8:11], s62 offen sc1
    v_mfma_f32_16x16x32_bf16 a[116:119], a[52:55], a[220:223], a[116:119]
    v_mfma_f32_16x16x32_bf16 a[116:119], a[48:51], a[204:207], a[116:119]
    s_add_u32 s62, s62, 0x20000
    v_mfma_f32_16x16x32_bf16 a[124:127], a[56:59], a[204:207], a[124:127]
    s_add_u32 s52, s47, 8192
    v_mfma_f32_16x16x32_bf16 a[124:127], a[60:63], a[220:223], a[124:127]
    buffer_store_dwordx4 v[108:111], v1, s[48:51], s52 offen offset:3072 sc1
    v_mfma_f32_16x16x32_bf16 a[120:123], a[60:63], a[216:219], a[120:123]
    v_mfma_f32_16x16x32_bf16 a[120:123], a[56:59], a[200:203], a[120:123]
    v_mfma_f32_16x16x32_bf16 v[252:255], a[56:59], a[196:199], v[252:255]
    v_mfma_f32_16x16x32_bf16 v[252:255], a[60:63], a[212:215], v[252:255]
    v_mfma_f32_16x16x32_bf16 v[248:251], a[60:63], a[208:211], v[248:251]
    v_mfma_f32_16x16x32_bf16 v[248:251], a[56:59], a[192:195], v[248:251]
    s_waitcnt vmcnt(15) lgkmcnt(0)
    v_mfma_f32_16x16x32_bf16 v[192:195], a[0:3], a[224:227], v[192:195]
    v_mfma_f32_16x16x32_bf16 v[192:195], a[4:7], a[240:243], v[192:195]
    buffer_load_dwordx4 a[160:163], v36, s[8:11], s62 offen sc1
    ds_read_b64_tr_b16 a[32:33], v46 offset:49152
    v_mfma_f32_16x16x32_bf16 v[196:199], a[4:7], a[244:247], v[196:199]
    ds_read_b64_tr_b16 a[34:35], v46 offset:50176
    v_mfma_f32_16x16x32_bf16 v[196:199], a[0:3], a[228:231], v[196:199]
    ds_read_b64_tr_b16 a[36:37], v46 offset:57344
    v_mfma_f32_16x16x32_bf16 a[64:67], a[0:3], a[232:235], a[64:67]
    ds_read_b64_tr_b16 a[38:39], v46 offset:58368
    v_mfma_f32_16x16x32_bf16 a[64:67], a[4:7], a[248:251], a[64:67]
    ds_read_b64_tr_b16 a[40:41], v47 offset:49152
    v_mfma_f32_16x16x32_bf16 a[68:71], a[4:7], a[252:255], a[68:71]
    buffer_load_dwordx4 a[164:167], v54, s[8:11], s62 offen sc1
    v_mfma_f32_16x16x32_bf16 a[68:71], a[0:3], a[236:239], a[68:71]
    ds_read_b64_tr_b16 a[42:43], v47 offset:50176
    v_mfma_f32_16x16x32_bf16 a[76:79], a[8:11], a[236:239], a[76:79]
    ds_read_b64_tr_b16 a[44:45], v47 offset:57344
    v_mfma_f32_16x16x32_bf16 a[76:79], a[12:15], a[252:255], a[76:79]
    ds_read_b64_tr_b16 a[46:47], v47 offset:58368
    v_mfma_f32_16x16x32_bf16 a[72:75], a[12:15], a[248:251], a[72:75]
    ds_read_b64_tr_b16 a[48:49], v48 offset:49152
    v_mfma_f32_16x16x32_bf16 a[72:75], a[8:11], a[232:235], a[72:75]
    buffer_load_dwordx4 a[168:171], v37, s[8:11], s62 offen sc1
    v_mfma_f32_16x16x32_bf16 v[204:207], a[8:11], a[228:231], v[204:207]
    ds_read_b64_tr_b16 a[50:51], v48 offset:50176
    v_mfma_f32_16x16x32_bf16 v[204:207], a[12:15], a[244:247], v[204:207]
    ds_read_b64_tr_b16 a[52:53], v48 offset:57344
    v_mfma_f32_16x16x32_bf16 v[200:203], a[12:15], a[240:243], v[200:203]
    ds_read_b64_tr_b16 a[54:55], v48 offset:58368
    v_mfma_f32_16x16x32_bf16 v[200:203], a[8:11], a[224:227], v[200:203]
    v_mfma_f32_16x16x32_bf16 v[208:211], a[16:19], a[224:227], v[208:211]
    ds_read_b64_tr_b16 a[56:57], v49 offset:49152
    v_mfma_f32_16x16x32_bf16 v[208:211], a[20:23], a[240:243], v[208:211]
    buffer_load_dwordx4 a[172:175], v55, s[8:11], s62 offen sc1
    ds_read_b64_tr_b16 a[58:59], v49 offset:50176
    v_mfma_f32_16x16x32_bf16 v[212:215], a[20:23], a[244:247], v[212:215]
    ds_read_b64_tr_b16 a[60:61], v49 offset:57344
    v_mfma_f32_16x16x32_bf16 v[212:215], a[16:19], a[228:231], v[212:215]
    v_mfma_f32_16x16x32_bf16 a[80:83], a[16:19], a[232:235], a[80:83]
    ds_read_b64_tr_b16 a[62:63], v49 offset:58368
    v_mfma_f32_16x16x32_bf16 a[80:83], a[20:23], a[248:251], a[80:83]
    s_add_u32 s62, s62, 0x20000
    v_mfma_f32_16x16x32_bf16 a[84:87], a[20:23], a[252:255], a[84:87]
    s_add_u32 s52, s47, 12288
    v_mfma_f32_16x16x32_bf16 a[84:87], a[16:19], a[236:239], a[84:87]
    buffer_store_dwordx4 v[112:115], v1, s[48:51], s52 offen offset:0 sc1
    v_mfma_f32_16x16x32_bf16 a[92:95], a[24:27], a[236:239], a[92:95]
    v_mfma_f32_16x16x32_bf16 a[92:95], a[28:31], a[252:255], a[92:95]
    v_mfma_f32_16x16x32_bf16 a[88:91], a[28:31], a[248:251], a[88:91]
    v_mfma_f32_16x16x32_bf16 a[88:91], a[24:27], a[232:235], a[88:91]
    v_mfma_f32_16x16x32_bf16 v[220:223], a[24:27], a[228:231], v[220:223]
    s_cmp_eq_u32 s45, 0
    s_cbranch_scc1 k12_ool_56
k12_oolret_57:
    v_mfma_f32_16x16x32_bf16 v[220:223], a[28:31], a[244:247], v[220:223]
    v_mfma_f32_16x16x32_bf16 v[216:219], a[28:31], a[240:243], v[216:219]
    v_mfma_f32_16x16x32_bf16 v[216:219], a[24:27], a[224:227], v[216:219]
    s_waitcnt vmcnt(10) lgkmcnt(0)
    s_barrier
    v_mfma_f32_16x16x32_bf16 v[224:227], a[32:35], a[224:227], v[224:227]
    v_mfma_f32_16x16x32_bf16 v[224:227], a[36:39], a[240:243], v[224:227]
    s_add_u32 m0, s60, 114688
    ds_read_b64_tr_b16 a[0:1], v42 offset:0
    ds_read_b64_tr_b16 a[2:3], v42 offset:1024
    v_mfma_f32_16x16x32_bf16 v[228:231], a[36:39], a[244:247], v[228:231]
    buffer_load_dwordx4 v38, s[12:15], s61 offen offset:0 lds
    v_mfma_f32_16x16x32_bf16 v[228:231], a[32:35], a[228:231], v[228:231]
    ds_read_b64_tr_b16 a[4:5], v42 offset:8192
    v_mfma_f32_16x16x32_bf16 a[96:99], a[32:35], a[232:235], a[96:99]
    buffer_load_dwordx4 v39, s[12:15], s61 offen offset:1024 lds
    ds_read_b64_tr_b16 a[6:7], v42 offset:9216
    v_mfma_f32_16x16x32_bf16 a[96:99], a[36:39], a[248:251], a[96:99]
    ds_read_b64_tr_b16 a[8:9], v43 offset:0
    v_mfma_f32_16x16x32_bf16 a[100:103], a[36:39], a[252:255], a[100:103]
    v_mfma_f32_16x16x32_bf16 a[100:103], a[32:35], a[236:239], a[100:103]
    buffer_load_dwordx4 v40, s[12:15], s61 offen offset:2048 lds
    ds_read_b64_tr_b16 a[10:11], v43 offset:1024
    v_mfma_f32_16x16x32_bf16 a[108:111], a[40:43], a[236:239], a[108:111]
    ds_read_b64_tr_b16 a[12:13], v43 offset:8192
    v_mfma_f32_16x16x32_bf16 a[108:111], a[44:47], a[252:255], a[108:111]
    ds_read_b64_tr_b16 a[14:15], v43 offset:9216
    v_mfma_f32_16x16x32_bf16 a[104:107], a[44:47], a[248:251], a[104:107]
    ds_read_b64_tr_b16 a[16:17], v44 offset:0
    v_mfma_f32_16x16x32_bf16 a[104:107], a[40:43], a[232:235], a[104:107]
    buffer_load_dwordx4 v41, s[12:15], s61 offen offset:3072 lds
    v_mfma_f32_16x16x32_bf16 v[236:239], a[40:43], a[228:231], v[236:239]
    ds_read_b64_tr_b16 a[18:19], v44 offset:1024
    v_mfma_f32_16x16x32_bf16 v[236:239], a[44:47], a[244:247], v[236:239]
    s_add_u32 s61, s61, 0x80000
    ds_read_b64_tr_b16 a[20:21], v44 offset:8192
    v_mfma_f32_16x16x32_bf16 v[232:235], a[44:47], a[240:243], v[232:235]
    buffer_load_dwordx4 a[176:179], v36, s[8:11], s62 offen sc1
    ds_read_b64_tr_b16 a[22:23], v44 offset:9216
    v_mfma_f32_16x16x32_bf16 v[232:235], a[40:43], a[224:227], v[232:235]
    v_mfma_f32_16x16x32_bf16 v[240:243], a[48:51], a[224:227], v[240:243]
    ds_read_b64_tr_b16 a[24:25], v45 offset:0
    v_mfma_f32_16x16x32_bf16 v[240:243], a[52:55], a[240:243], v[240:243]
    buffer_load_dwordx4 a[180:183], v54, s[8:11], s62 offen sc1
    ds_read_b64_tr_b16 a[26:27], v45 offset:1024
    v_mfma_f32_16x16x32_bf16 v[244:247], a[52:55], a[244:247], v[244:247]
    ds_read_b64_tr_b16 a[28:29], v45 offset:8192
    v_mfma_f32_16x16x32_bf16 v[244:247], a[48:51], a[228:231], v[244:247]
    v_mfma_f32_16x16x32_bf16 a[112:115], a[48:51], a[232:235], a[112:115]
    buffer_load_dwordx4 a[184:187], v37, s[8:11], s62 offen sc1
    ds_read_b64_tr_b16 a[30:31], v45 offset:9216
    v_mfma_f32_16x16x32_bf16 a[112:115], a[52:55], a[248:251], a[112:115]
    v_mfma_f32_16x16x32_bf16 a[116:119], a[52:55], a[252:255], a[116:119]
    v_mfma_f32_16x16x32_bf16 a[116:119], a[48:51], a[236:239], a[116:119]
    v_mfma_f32_16x16x32_bf16 a[124:127], a[56:59], a[236:239], a[124:127]
    buffer_load_dwordx4 a[188:191], v55, s[8:11], s62 offen sc1
    v_mfma_f32_16x16x32_bf16 a[124:127], a[60:63], a[252:255], a[124:127]
    v_mfma_f32_16x16x32_bf16 a[120:123], a[60:63], a[248:251], a[120:123]
    s_add_u32 s62, s62, 0x20000
    v_mfma_f32_16x16x32_bf16 a[120:123], a[56:59], a[232:235], a[120:123]
    v_mfma_f32_16x16x32_bf16 v[252:255], a[56:59], a[228:231], v[252:255]
    v_mfma_f32_16x16x32_bf16 v[252:255], a[60:63], a[244:247], v[252:255]
    v_mfma_f32_16x16x32_bf16 v[248:251], a[60:63], a[240:243], v[248:251]
    v_mfma_f32_16x16x32_bf16 v[248:251], a[56:59], a[224:227], v[248:251]
    s_waitcnt vmcnt(14) lgkmcnt(0)
    v_mfma_f32_16x16x32_bf16 v[192:195], a[0:3], a[128:131], v[192:195]
    v_mfma_f32_16x16x32_bf16 v[192:195], a[4:7], a[144:147], v[192:195]
    buffer_load_dwordx4 a[192:195], v36, s[8:11], s62 offen sc1
    ds_read_b64_tr_b16 a[32:33], v46 offset:0
    v_mfma_f32_16x16x32_bf16 v[196:199], a[4:7], a[148:151], v[196:199]
    ds_read_b64_tr_b16 a[34:35], v46 offset:1024
    v_mfma_f32_16x16x32_bf16 v[196:199], a[0:3], a[132:135], v[196:199]
    ds_read_b64_tr_b16 a[36:37], v46 offset:8192
    v_mfma_f32_16x16x32_bf16 a[64:67], a[0:3], a[136:139], a[64:67]
    ds_read_b64_tr_b16 a[38:39], v46 offset:9216
    v_mfma_f32_16x16x32_bf16 a[64:67], a[4:7], a[152:155], a[64:67]
    ds_read_b64_tr_b16 a[40:41], v47 offset:0
    v_mfma_f32_16x16x32_bf16 a[68:71], a[4:7], a[156:159], a[68:71]
    buffer_load_dwordx4 a[196:199], v54, s[8:11], s62 offen sc1
    v_mfma_f32_16x16x32_bf16 a[68:71], a[0:3], a[140:143], a[68:71]
    ds_read_b64_tr_b16 a[42:43], v47 offset:1024
    v_mfma_f32_16x16x32_bf16 a[76:79], a[8:11], a[140:143], a[76:79]
    ds_read_b64_tr_b16 a[44:45], v47 offset:8192
    v_mfma_f32_16x16x32_bf16 a[76:79], a[12:15], a[156:159], a[76:79]
    ds_read_b64_tr_b16 a[46:47], v47 offset:9216
    v_mfma_f32_16x16x32_bf16 a[72:75], a[12:15], a[152:155], a[72:75]
    ds_read_b64_tr_b16 a[48:49], v48 offset:0
    v_mfma_f32_16x16x32_bf16 a[72:75], a[8:11], a[136:139], a[72:75]
    buffer_load_dwordx4 a[200:203], v37, s[8:11], s62 offen sc1
    v_mfma_f32_16x16x32_bf16 v[204:207], a[8:11], a[132:135], v[204:207]
    ds_read_b64_tr_b16 a[50:51], v48 offset:1024
    v_mfma_f32_16x16x32_bf16 v[204:207], a[12:15], a[148:151], v[204:207]
    ds_read_b64_tr_b16 a[52:53], v48 offset:8192
    v_mfma_f32_16x16x32_bf16 v[200:203], a[12:15], a[144:147], v[200:203]
    ds_read_b64_tr_b16 a[54:55], v48 offset:9216
    v_mfma_f32_16x16x32_bf16 v[200:203], a[8:11], a[128:131], v[200:203]
    v_mfma_f32_16x16x32_bf16 v[208:211], a[16:19], a[128:131], v[208:211]
    ds_read_b64_tr_b16 a[56:57], v49 offset:0
    v_mfma_f32_16x16x32_bf16 v[208:211], a[20:23], a[144:147], v[208:211]
    buffer_load_dwordx4 a[204:207], v55, s[8:11], s62 offen sc1
    ds_read_b64_tr_b16 a[58:59], v49 offset:1024
    v_mfma_f32_16x16x32_bf16 v[212:215], a[20:23], a[148:151], v[212:215]
    ds_read_b64_tr_b16 a[60:61], v49 offset:8192
    v_mfma_f32_16x16x32_bf16 v[212:215], a[16:19], a[132:135], v[212:215]
    v_mfma_f32_16x16x32_bf16 a[80:83], a[16:19], a[136:139], a[80:83]
    ds_read_b64_tr_b16 a[62:63], v49 offset:9216
    v_mfma_f32_16x16x32_bf16 a[80:83], a[20:23], a[152:155], a[80:83]
    s_add_u32 s62, s62, 0x20000
    v_mfma_f32_16x16x32_bf16 a[84:87], a[20:23], a[156:159], a[84:87]
    s_add_u32 s52, s47, 12288
    v_mfma_f32_16x16x32_bf16 a[84:87], a[16:19], a[140:143], a[84:87]
    buffer_store_dwordx4 v[116:119], v1, s[48:51], s52 offen offset:1024 sc1
    v_mfma_f32_16x16x32_bf16 a[92:95], a[24:27], a[140:143], a[92:95]
    v_mfma_f32_16x16x32_bf16 a[92:95], a[28:31], a[156:159], a[92:95]
    v_mfma_f32_16x16x32_bf16 a[88:91], a[28:31], a[152:155], a[88:91]
    v_mfma_f32_16x16x32_bf16 a[88:91], a[24:27], a[136:139], a[88:91]
    v_mfma_f32_16x16x32_bf16 v[220:223], a[24:27], a[132:135], v[220:223]
    s_cmp_eq_u32 s45, 0
    s_cbranch_scc1 k12_ool_58
k12_oolret_59:
    v_mfma_f32_16x16x32_bf16 v[220:223], a[28:31], a[148:151], v[220:223]
    v_mfma_f32_16x16x32_bf16 v[216:219], a[28:31], a[144:147], v[216:219]
    v_mfma_f32_16x16x32_bf16 v[216:219], a[24:27], a[128:131], v[216:219]
    s_waitcnt vmcnt(9) lgkmcnt(0)
    s_barrier
    v_mfma_f32_16x16x32_bf16 v[224:227], a[32:35], a[128:131], v[224:227]
    v_mfma_f32_16x16x32_bf16 v[224:227], a[36:39], a[144:147], v[224:227]
    s_add_u32 m0, s60, 131072
    ds_read_b64_tr_b16 a[0:1], v42 offset:16384
    ds_read_b64_tr_b16 a[2:3], v42 offset:17408
    v_mfma_f32_16x16x32_bf16 v[228:231], a[36:39], a[148:151], v[228:231]
    buffer_load_dwordx4 v38, s[12:15], s61 offen offset:0 lds
    v_mfma_f32_16x16x32_bf16 v[228:231], a[32:35], a[132:135], v[228:231]
    ds_read_b64_tr_b16 a[4:5], v42 offset:24576
    v_mfma_f32_16x16x32_bf16 a[96:99], a[32:35], a[136:139], a[96:99]
    buffer_load_dwordx4 v39, s[12:15], s61 offen offset:1024 lds
    ds_read_b64_tr_b16 a[6:7], v42 offset:25600
    v_mfma_f32_16x16x32_bf16 a[96:99], a[36:39], a[152:155], a[96:99]
    ds_read_b64_tr_b16 a[8:9], v43 offset:16384
    v_mfma_f32_16x16x32_bf16 a[100:103], a[36:39], a[156:159], a[100:103]
    v_mfma_f32_16x16x32_bf16 a[100:103], a[32:35], a[140:143], a[100:103]
    buffer_load_dwordx4 v40, s[12:15], s61 offen offset:2048 lds
    ds_read_b64_tr_b16 a[10:11], v43 offset:17408
    v_mfma_f32_16x16x32_bf16 a[108:111], a[40:43], a[140:143], a[108:111]
    ds_read_b64_tr_b16 a[12:13], v43 offset:24576
    v_mfma_f32_16x16x32_bf16 a[108:111], a[44:47], a[156:159], a[108:111]
    ds_read_b64_tr_b16 a[14:15], v43 offset:25600
    v_mfma_f32_16x16x32_bf16 a[104:107], a[44:47], a[152:155], a[104:107]
    buffer_load_dwordx4 v41, s[12:15], s61 offen offset:3072 lds
    ds_read_b64_tr_b16 a[16:17], v44 offset:16384
    v_mfma_f32_16x16x32_bf16 a[104:107], a[40:43], a[136:139], a[104:107]
    v_mfma_f32_16x16x32_bf16 v[236:239], a[40:43], a[132:135], v[236:239]
    s_add_u32 s61, s61, 0x80000
    ds_read_b64_tr_b16 a[18:19], v44 offset:17408
    v_mfma_f32_16x16x32_bf16 v[236:239], a[44:47], a[148:151], v[236:239]
    buffer_load_dwordx4 a[208:211], v36, s[8:11], s62 offen sc1
    ds_read_b64_tr_b16 a[20:21], v44 offset:24576
    v_mfma_f32_16x16x32_bf16 v[232:235], a[44:47], a[144:147], v[232:235]
    ds_read_b64_tr_b16 a[22:23], v44 offset:25600
    v_mfma_f32_16x16x32_bf16 v[232:235], a[40:43], a[128:131], v[232:235]
    buffer_load_dwordx4 a[212:215], v54, s[8:11], s62 offen sc1
    v_mfma_f32_16x16x32_bf16 v[240:243], a[48:51], a[128:131], v[240:243]
    ds_read_b64_tr_b16 a[24:25], v45 offset:16384
    v_mfma_f32_16x16x32_bf16 v[240:243], a[52:55], a[144:147], v[240:243]
    ds_read_b64_tr_b16 a[26:27], v45 offset:17408
    v_mfma_f32_16x16x32_bf16 v[244:247], a[52:55], a[148:151], v[244:247]
    buffer_load_dwordx4 a[216:219], v37, s[8:11], s62 offen sc1
    ds_read_b64_tr_b16 a[28:29], v45 offset:24576
    v_mfma_f32_16x16x32_bf16 v[244:247], a[48:51], a[132:135], v[244:247]
    v_mfma_f32_16x16x32_bf16 a[112:115], a[48:51], a[136:139], a[112:115]
    ds_read_b64_tr_b16 a[30:31], v45 offset:25600
    v_mfma_f32_16x16x32_bf16 a[112:115], a[52:55], a[152:155], a[112:115]
    buffer_load_dwordx4 a[220:223], v55, s[8:11], s62 offen sc1
    v_mfma_f32_16x16x32_bf16 a[116:119], a[52:55], a[156:159], a[116:119]
    v_mfma_f32_16x16x32_bf16 a[116:119], a[48:51], a[140:143], a[116:119]
    s_add_u32 s62, s62, 0x20000
    v_mfma_f32_16x16x32_bf16 a[124:127], a[56:59], a[140:143], a[124:127]
    s_add_u32 s52, s47, 12288
    v_mfma_f32_16x16x32_bf16 a[124:127], a[60:63], a[156:159], a[124:127]
    buffer_store_dwordx4 v[120:123], v1, s[48:51], s52 offen offset:2048 sc1
    v_mfma_f32_16x16x32_bf16 a[120:123], a[60:63], a[152:155], a[120:123]
    v_mfma_f32_16x16x32_bf16 a[120:123], a[56:59], a[136:139], a[120:123]
    v_mfma_f32_16x16x32_bf16 v[252:255], a[56:59], a[132:135], v[252:255]
    v_mfma_f32_16x16x32_bf16 v[252:255], a[60:63], a[148:151], v[252:255]
    v_mfma_f32_16x16x32_bf16 v[248:251], a[60:63], a[144:147], v[248:251]
    v_mfma_f32_16x16x32_bf16 v[248:251], a[56:59], a[128:131], v[248:251]
    s_waitcnt vmcnt(14) lgkmcnt(0)
    v_mfma_f32_16x16x32_bf16 v[192:195], a[0:3], a[160:163], v[192:195]
    v_mfma_f32_16x16x32_bf16 v[192:195], a[4:7], a[176:179], v[192:195]
    buffer_load_dwordx4 a[224:227], v36, s[8:11], s62 offen sc1
    ds_read_b64_tr_b16 a[32:33], v46 offset:16384
    v_mfma_f32_16x16x32_bf16 v[196:199], a[4:7], a[180:183], v[196:199]
    ds_read_b64_tr_b16 a[34:35], v46 offset:17408
    v_mfma_f32_16x16x32_bf16 v[196:199], a[0:3], a[164:167], v[196:199]
    ds_read_b64_tr_b16 a[36:37], v46 offset:24576
    v_mfma_f32_16x16x32_bf16 a[64:67], a[0:3], a[168:171], a[64:67]
    ds_read_b64_tr_b16 a[38:39], v46 offset:25600
    v_mfma_f32_16x16x32_bf16 a[64:67], a[4:7], a[184:187], a[64:67]
    ds_read_b64_tr_b16 a[40:41], v47 offset:16384
    v_mfma_f32_16x16x32_bf16 a[68:71], a[4:7], a[188:191], a[68:71]
    buffer_load_dwordx4 a[228:231], v54, s[8:11], s62 offen sc1
    v_mfma_f32_16x16x32_bf16 a[68:71], a[0:3], a[172:175], a[68:71]
    ds_read_b64_tr_b16 a[42:43], v47 offset:17408
    v_mfma_f32_16x16x32_bf16 a[76:79], a[8:11], a[172:175], a[76:79]
    ds_read_b64_tr_b16 a[44:45], v47 offset:24576
    v_mfma_f32_16x16x32_bf16 a[76:79], a[12:15], a[188:191], a[76:79]
    ds_read_b64_tr_b16 a[46:47], v47 offset:25600
    v_mfma_f32_16x16x32_bf16 a[72:75], a[12:15], a[184:187], a[72:75]
    ds_read_b64_tr_b16 a[48:49], v48 offset:16384
    v_mfma_f32_16x16x32_bf16 a[72:75], a[8:11], a[168:171], a[72:75]
    buffer_load_dwordx4 a[232:235], v37, s[8:11], s62 offen sc1
    v_mfma_f32_16x16x32_bf16 v[204:207], a[8:11], a[164:167], v[204:207]
    ds_read_b64_tr_b16 a[50:51], v48 offset:17408
    v_mfma_f32_16x16x32_bf16 v[204:207], a[12:15], a[180:183], v[204:207]
    ds_read_b64_tr_b16 a[52:53], v48 offset:24576
    v_mfma_f32_16x16x32_bf16 v[200:203], a[12:15], a[176:179], v[200:203]
    ds_read_b64_tr_b16 a[54:55], v48 offset:25600
    v_mfma_f32_16x16x32_bf16 v[200:203], a[8:11], a[160:163], v[200:203]
    v_mfma_f32_16x16x32_bf16 v[208:211], a[16:19], a[160:163], v[208:211]
    ds_read_b64_tr_b16 a[56:57], v49 offset:16384
    v_mfma_f32_16x16x32_bf16 v[208:211], a[20:23], a[176:179], v[208:211]
    buffer_load_dwordx4 a[236:239], v55, s[8:11], s62 offen sc1
    ds_read_b64_tr_b16 a[58:59], v49 offset:17408
    v_mfma_f32_16x16x32_bf16 v[212:215], a[20:23], a[180:183], v[212:215]
    ds_read_b64_tr_b16 a[60:61], v49 offset:24576
    v_mfma_f32_16x16x32_bf16 v[212:215], a[16:19], a[164:167], v[212:215]
    v_mfma_f32_16x16x32_bf16 a[80:83], a[16:19], a[168:171], a[80:83]
    ds_read_b64_tr_b16 a[62:63], v49 offset:25600
    v_mfma_f32_16x16x32_bf16 a[80:83], a[20:23], a[184:187], a[80:83]
    s_add_u32 s62, s62, 0x20000
    v_mfma_f32_16x16x32_bf16 a[84:87], a[20:23], a[188:191], a[84:87]
    s_add_u32 s52, s47, 12288
    v_mfma_f32_16x16x32_bf16 a[84:87], a[16:19], a[172:175], a[84:87]
    buffer_store_dwordx4 v[124:127], v1, s[48:51], s52 offen offset:3072 sc1
    v_mfma_f32_16x16x32_bf16 a[92:95], a[24:27], a[172:175], a[92:95]
    v_mfma_f32_16x16x32_bf16 a[92:95], a[28:31], a[188:191], a[92:95]
    v_mfma_f32_16x16x32_bf16 a[88:91], a[28:31], a[184:187], a[88:91]
    v_mfma_f32_16x16x32_bf16 a[88:91], a[24:27], a[168:171], a[88:91]
    v_mfma_f32_16x16x32_bf16 v[220:223], a[24:27], a[164:167], v[220:223]
    v_mfma_f32_16x16x32_bf16 v[220:223], a[28:31], a[180:183], v[220:223]
    v_mfma_f32_16x16x32_bf16 v[216:219], a[28:31], a[176:179], v[216:219]
    v_mfma_f32_16x16x32_bf16 v[216:219], a[24:27], a[160:163], v[216:219]
    s_waitcnt vmcnt(10) lgkmcnt(0)
    s_barrier
    v_mfma_f32_16x16x32_bf16 v[224:227], a[32:35], a[160:163], v[224:227]
    v_mfma_f32_16x16x32_bf16 v[224:227], a[36:39], a[176:179], v[224:227]
    s_add_u32 m0, s60, 147456
    ds_read_b64_tr_b16 a[0:1], v42 offset:32768
    ds_read_b64_tr_b16 a[2:3], v42 offset:33792
    v_mfma_f32_16x16x32_bf16 v[228:231], a[36:39], a[180:183], v[228:231]
    buffer_load_dwordx4 v38, s[12:15], s61 offen offset:0 lds
    v_mfma_f32_16x16x32_bf16 v[228:231], a[32:35], a[164:167], v[228:231]
    ds_read_b64_tr_b16 a[4:5], v42 offset:40960
    v_mfma_f32_16x16x32_bf16 a[96:99], a[32:35], a[168:171], a[96:99]
    buffer_load_dwordx4 v39, s[12:15], s61 offen offset:1024 lds
    ds_read_b64_tr_b16 a[6:7], v42 offset:41984
    v_mfma_f32_16x16x32_bf16 a[96:99], a[36:39], a[184:187], a[96:99]
    ds_read_b64_tr_b16 a[8:9], v43 offset:32768
    v_mfma_f32_16x16x32_bf16 a[100:103], a[36:39], a[188:191], a[100:103]
    v_mfma_f32_16x16x32_bf16 a[100:103], a[32:35], a[172:175], a[100:103]
    buffer_load_dwordx4 v40, s[12:15], s61 offen offset:2048 lds
    ds_read_b64_tr_b16 a[10:11], v43 offset:33792
    v_mfma_f32_16x16x32_bf16 a[108:111], a[40:43], a[172:175], a[108:111]
    ds_read_b64_tr_b16 a[12:13], v43 offset:40960
    v_mfma_f32_16x16x32_bf16 a[108:111], a[44:47], a[188:191], a[108:111]
    ds_read_b64_tr_b16 a[14:15], v43 offset:41984
    v_mfma_f32_16x16x32_bf16 a[104:107], a[44:47], a[184:187], a[104:107]
    buffer_load_dwordx4 v41, s[12:15], s61 offen offset:3072 lds
    ds_read_b64_tr_b16 a[16:17], v44 offset:32768
    v_mfma_f32_16x16x32_bf16 a[104:107], a[40:43], a[168:171], a[104:107]
    v_mfma_f32_16x16x32_bf16 v[236:239], a[40:43], a[164:167], v[236:239]
    s_add_u32 s61, s61, 0x80000
    ds_read_b64_tr_b16 a[18:19], v44 offset:33792
    v_mfma_f32_16x16x32_bf16 v[236:239], a[44:47], a[180:183], v[236:239]
    buffer_load_dwordx4 a[240:243], v36, s[8:11], s62 offen sc1
    ds_read_b64_tr_b16 a[20:21], v44 offset:40960
    v_mfma_f32_16x16x32_bf16 v[232:235], a[44:47], a[176:179], v[232:235]
    ds_read_b64_tr_b16 a[22:23], v44 offset:41984
    v_mfma_f32_16x16x32_bf16 v[232:235], a[40:43], a[160:163], v[232:235]
    buffer_load_dwordx4 a[244:247], v54, s[8:11], s62 offen sc1
    v_mfma_f32_16x16x32_bf16 v[240:243], a[48:51], a[160:163], v[240:243]
    ds_read_b64_tr_b16 a[24:25], v45 offset:32768
    v_mfma_f32_16x16x32_bf16 v[240:243], a[52:55], a[176:179], v[240:243]
    ds_read_b64_tr_b16 a[26:27], v45 offset:33792
    v_mfma_f32_16x16x32_bf16 v[244:247], a[52:55], a[180:183], v[244:247]
    buffer_load_dwordx4 a[248:251], v37, s[8:11], s62 offen sc1
    ds_read_b64_tr_b16 a[28:29], v45 offset:40960
    v_mfma_f32_16x16x32_bf16 v[244:247], a[48:51], a[164:167], v[244:247]
    v_mfma_f32_16x16x32_bf16 a[112:115], a[48:51], a[168:171], a[112:115]
    ds_read_b64_tr_b16 a[30:31], v45 offset:41984
    v_mfma_f32_16x16x32_bf16 a[112:115], a[52:55], a[184:187], a[112:115]
    buffer_load_dwordx4 a[252:255], v55, s[8:11], s62 offen sc1
    v_mfma_f32_16x16x32_bf16 a[116:119], a[52:55], a[188:191], a[116:119]
    v_mfma_f32_16x16x32_bf16 a[116:119], a[48:51], a[172:175], a[116:119]
    s_add_u32 s62, s62, 0x20000
    v_mfma_f32_16x16x32_bf16 a[124:127], a[56:59], a[172:175], a[124:127]
    s_add_u32 s52, s47, 524288
    v_mfma_f32_16x16x32_bf16 a[124:127], a[60:63], a[188:191], a[124:127]
    buffer_store_dwordx4 v[136:139], v1, s[48:51], s52 offen offset:2048 sc1
    v_mfma_f32_16x16x32_bf16 a[120:123], a[60:63], a[184:187], a[120:123]
    v_mfma_f32_16x16x32_bf16 a[120:123], a[56:59], a[168:171], a[120:123]
    v_mfma_f32_16x16x32_bf16 v[252:255], a[56:59], a[164:167], v[252:255]
    s_cmp_eq_u32 s45, 0
    s_cbranch_scc1 k12_ool_60
k12_oolret_61:
    v_mfma_f32_16x16x32_bf16 v[252:255], a[60:63], a[180:183], v[252:255]
    v_mfma_f32_16x16x32_bf16 v[248:251], a[60:63], a[176:179], v[248:251]
    v_mfma_f32_16x16x32_bf16 v[248:251], a[56:59], a[160:163], v[248:251]
    s_waitcnt vmcnt(15) lgkmcnt(0)
    v_mfma_f32_16x16x32_bf16 v[192:195], a[0:3], a[192:195], v[192:195]
    v_mfma_f32_16x16x32_bf16 v[192:195], a[4:7], a[208:211], v[192:195]
    buffer_load_dwordx4 a[128:131], v36, s[8:11], s62 offen sc1
    ds_read_b64_tr_b16 a[32:33], v46 offset:32768
    v_mfma_f32_16x16x32_bf16 v[196:199], a[4:7], a[212:215], v[196:199]
    ds_read_b64_tr_b16 a[34:35], v46 offset:33792
    v_mfma_f32_16x16x32_bf16 v[196:199], a[0:3], a[196:199], v[196:199]
    ds_read_b64_tr_b16 a[36:37], v46 offset:40960
    v_mfma_f32_16x16x32_bf16 a[64:67], a[0:3], a[200:203], a[64:67]
    ds_read_b64_tr_b16 a[38:39], v46 offset:41984
    v_mfma_f32_16x16x32_bf16 a[64:67], a[4:7], a[216:219], a[64:67]
    ds_read_b64_tr_b16 a[40:41], v47 offset:32768
    v_mfma_f32_16x16x32_bf16 a[68:71], a[4:7], a[220:223], a[68:71]
    buffer_load_dwordx4 a[132:135], v54, s[8:11], s62 offen sc1
    v_mfma_f32_16x16x32_bf16 a[68:71], a[0:3], a[204:207], a[68:71]
    ds_read_b64_tr_b16 a[42:43], v47 offset:33792
    v_mfma_f32_16x16x32_bf16 a[76:79], a[8:11], a[204:207], a[76:79]
    ds_read_b64_tr_b16 a[44:45], v47 offset:40960
    v_mfma_f32_16x16x32_bf16 a[76:79], a[12:15], a[220:223], a[76:79]
    ds_read_b64_tr_b16 a[46:47], v47 offset:41984
    v_mfma_f32_16x16x32_bf16 a[72:75], a[12:15], a[216:219], a[72:75]
    ds_read_b64_tr_b16 a[48:49], v48 offset:32768
    v_mfma_f32_16x16x32_bf16 a[72:75], a[8:11], a[200:203], a[72:75]
    buffer_load_dwordx4 a[136:139], v37, s[8:11], s62 offen sc1
    v_mfma_f32_16x16x32_bf16 v[204:207], a[8:11], a[196:199], v[204:207]
    ds_read_b64_tr_b16 a[50:51], v48 offset:33792
    v_mfma_f32_16x16x32_bf16 v[204:207], a[12:15], a[212:215], v[204:207]
    ds_read_b64_tr_b16 a[52:53], v48 offset:40960
    v_mfma_f32_16x16x32_bf16 v[200:203], a[12:15], a[208:211], v[200:203]
    ds_read_b64_tr_b16 a[54:55], v48 offset:41984
    v_mfma_f32_16x16x32_bf16 v[200:203], a[8:11], a[192:195], v[200:203]
    v_mfma_f32_16x16x32_bf16 v[208:211], a[16:19], a[192:195], v[208:211]
    ds_read_b64_tr_b16 a[56:57], v49 offset:32768
    v_mfma_f32_16x16x32_bf16 v[208:211], a[20:23], a[208:211], v[208:211]
    buffer_load_dwordx4 a[140:143], v55, s[8:11], s62 offen sc1
    ds_read_b64_tr_b16 a[58:59], v49 offset:33792
    v_mfma_f32_16x16x32_bf16 v[212:215], a[20:23], a[212:215], v[212:215]
    ds_read_b64_tr_b16 a[60:61], v49 offset:40960
    v_mfma_f32_16x16x32_bf16 v[212:215], a[16:19], a[196:199], v[212:215]
    v_mfma_f32_16x16x32_bf16 a[80:83], a[16:19], a[200:203], a[80:83]
    ds_read_b64_tr_b16 a[62:63], v49 offset:41984
    v_mfma_f32_16x16x32_bf16 a[80:83], a[20:23], a[216:219], a[80:83]
    s_add_u32 s62, s62, 0x20000
    v_mfma_f32_16x16x32_bf16 a[84:87], a[20:23], a[220:223], a[84:87]
    s_add_u32 s52, s47, 524288
    v_mfma_f32_16x16x32_bf16 a[84:87], a[16:19], a[204:207], a[84:87]
    buffer_store_dwordx4 v[140:143], v1, s[48:51], s52 offen offset:3072 sc1
    v_mfma_f32_16x16x32_bf16 a[92:95], a[24:27], a[204:207], a[92:95]
    v_mfma_f32_16x16x32_bf16 a[92:95], a[28:31], a[220:223], a[92:95]
    v_mfma_f32_16x16x32_bf16 a[88:91], a[28:31], a[216:219], a[88:91]
    v_mfma_f32_16x16x32_bf16 a[88:91], a[24:27], a[200:203], a[88:91]
    v_mfma_f32_16x16x32_bf16 v[220:223], a[24:27], a[196:199], v[220:223]
    v_mfma_f32_16x16x32_bf16 v[220:223], a[28:31], a[212:215], v[220:223]
    v_mfma_f32_16x16x32_bf16 v[216:219], a[28:31], a[208:211], v[216:219]
    v_mfma_f32_16x16x32_bf16 v[216:219], a[24:27], a[192:195], v[216:219]
    s_waitcnt vmcnt(10) lgkmcnt(0)
    s_barrier
    v_mfma_f32_16x16x32_bf16 v[224:227], a[32:35], a[192:195], v[224:227]
    v_mfma_f32_16x16x32_bf16 v[224:227], a[36:39], a[208:211], v[224:227]
    s_add_u32 m0, s60, 98304
    ds_read_b64_tr_b16 a[0:1], v42 offset:49152
    ds_read_b64_tr_b16 a[2:3], v42 offset:50176
    v_mfma_f32_16x16x32_bf16 v[228:231], a[36:39], a[212:215], v[228:231]
    buffer_load_dwordx4 v38, s[12:15], s61 offen offset:0 lds
    v_mfma_f32_16x16x32_bf16 v[228:231], a[32:35], a[196:199], v[228:231]
    ds_read_b64_tr_b16 a[4:5], v42 offset:57344
    v_mfma_f32_16x16x32_bf16 a[96:99], a[32:35], a[200:203], a[96:99]
    buffer_load_dwordx4 v39, s[12:15], s61 offen offset:1024 lds
    ds_read_b64_tr_b16 a[6:7], v42 offset:58368
    v_mfma_f32_16x16x32_bf16 a[96:99], a[36:39], a[216:219], a[96:99]
    ds_read_b64_tr_b16 a[8:9], v43 offset:49152
    v_mfma_f32_16x16x32_bf16 a[100:103], a[36:39], a[220:223], a[100:103]
    v_mfma_f32_16x16x32_bf16 a[100:103], a[32:35], a[204:207], a[100:103]
    buffer_load_dwordx4 v40, s[12:15], s61 offen offset:2048 lds
    ds_read_b64_tr_b16 a[10:11], v43 offset:50176
    v_mfma_f32_16x16x32_bf16 a[108:111], a[40:43], a[204:207], a[108:111]
    ds_read_b64_tr_b16 a[12:13], v43 offset:57344
    v_mfma_f32_16x16x32_bf16 a[108:111], a[44:47], a[220:223], a[108:111]
    ds_read_b64_tr_b16 a[14:15], v43 offset:58368
    v_mfma_f32_16x16x32_bf16 a[104:107], a[44:47], a[216:219], a[104:107]
    ds_read_b64_tr_b16 a[16:17], v44 offset:49152
    v_mfma_f32_16x16x32_bf16 a[104:107], a[40:43], a[200:203], a[104:107]
    buffer_load_dwordx4 v41, s[12:15], s61 offen offset:3072 lds
    v_mfma_f32_16x16x32_bf16 v[236:239], a[40:43], a[196:199], v[236:239]
    ds_read_b64_tr_b16 a[18:19], v44 offset:50176
    v_mfma_f32_16x16x32_bf16 v[236:239], a[44:47], a[212:215], v[236:239]
    s_add_u32 s61, s61, 0x80000
    ds_read_b64_tr_b16 a[20:21], v44 offset:57344
    v_mfma_f32_16x16x32_bf16 v[232:235], a[44:47], a[208:211], v[232:235]
    buffer_load_dwordx4 a[144:147], v36, s[8:11], s62 offen sc1
    ds_read_b64_tr_b16 a[22:23], v44 offset:58368
    v_mfma_f32_16x16x32_bf16 v[232:235], a[40:43], a[192:195], v[232:235]
    v_mfma_f32_16x16x32_bf16 v[240:243], a[48:51], a[192:195], v[240:243]
    ds_read_b64_tr_b16 a[24:25], v45 offset:49152
    v_mfma_f32_16x16x32_bf16 v[240:243], a[52:55], a[208:211], v[240:243]
    buffer_load_dwordx4 a[148:151], v54, s[8:11], s62 offen sc1
    ds_read_b64_tr_b16 a[26:27], v45 offset:50176
    v_mfma_f32_16x16x32_bf16 v[244:247], a[52:55], a[212:215], v[244:247]
    ds_read_b64_tr_b16 a[28:29], v45 offset:57344
    v_mfma_f32_16x16x32_bf16 v[244:247], a[48:51], a[196:199], v[244:247]
    v_mfma_f32_16x16x32_bf16 a[112:115], a[48:51], a[200:203], a[112:115]
    buffer_load_dwordx4 a[152:155], v37, s[8:11], s62 offen sc1
    ds_read_b64_tr_b16 a[30:31], v45 offset:58368
    v_mfma_f32_16x16x32_bf16 a[112:115], a[52:55], a[216:219], a[112:115]
    v_mfma_f32_16x16x32_bf16 a[116:119], a[52:55], a[220:223], a[116:119]
    v_mfma_f32_16x16x32_bf16 a[116:119], a[48:51], a[204:207], a[116:119]
    v_mfma_f32_16x16x32_bf16 a[124:127], a[56:59], a[204:207], a[124:127]
    buffer_load_dwordx4 a[156:159], v55, s[8:11], s62 offen sc1
    v_mfma_f32_16x16x32_bf16 a[124:127], a[60:63], a[220:223], a[124:127]
    v_mfma_f32_16x16x32_bf16 a[120:123], a[60:63], a[216:219], a[120:123]
    s_add_u32 s62, s62, 0x20000
    v_mfma_f32_16x16x32_bf16 a[120:123], a[56:59], a[200:203], a[120:123]
    v_mfma_f32_16x16x32_bf16 v[252:255], a[56:59], a[196:199], v[252:255]
    s_cmp_eq_u32 s45, 0
    s_cbranch_scc1 k12_ool_62
k12_oolret_63:
    v_mfma_f32_16x16x32_bf16 v[252:255], a[60:63], a[212:215], v[252:255]
    v_mfma_f32_16x16x32_bf16 v[248:251], a[60:63], a[208:211], v[248:251]
    v_mfma_f32_16x16x32_bf16 v[248:251], a[56:59], a[192:195], v[248:251]
    s_waitcnt vmcnt(14) lgkmcnt(0)
    v_mfma_f32_16x16x32_bf16 v[192:195], a[0:3], a[224:227], v[192:195]
    v_mfma_f32_16x16x32_bf16 v[192:195], a[4:7], a[240:243], v[192:195]
    buffer_load_dwordx4 a[160:163], v36, s[8:11], s62 offen sc1
    ds_read_b64_tr_b16 a[32:33], v46 offset:49152
    v_mfma_f32_16x16x32_bf16 v[196:199], a[4:7], a[244:247], v[196:199]
    ds_read_b64_tr_b16 a[34:35], v46 offset:50176
    v_mfma_f32_16x16x32_bf16 v[196:199], a[0:3], a[228:231], v[196:199]
    ds_read_b64_tr_b16 a[36:37], v46 offset:57344
    v_mfma_f32_16x16x32_bf16 a[64:67], a[0:3], a[232:235], a[64:67]
    ds_read_b64_tr_b16 a[38:39], v46 offset:58368
    v_mfma_f32_16x16x32_bf16 a[64:67], a[4:7], a[248:251], a[64:67]
    ds_read_b64_tr_b16 a[40:41], v47 offset:49152
    v_mfma_f32_16x16x32_bf16 a[68:71], a[4:7], a[252:255], a[68:71]
    buffer_load_dwordx4 a[164:167], v54, s[8:11], s62 offen sc1
    v_mfma_f32_16x16x32_bf16 a[68:71], a[0:3], a[236:239], a[68:71]
    ds_read_b64_tr_b16 a[42:43], v47 offset:50176
    v_mfma_f32_16x16x32_bf16 a[76:79], a[8:11], a[236:239], a[76:79]
    ds_read_b64_tr_b16 a[44:45], v47 offset:57344
    v_mfma_f32_16x16x32_bf16 a[76:79], a[12:15], a[252:255], a[76:79]
    ds_read_b64_tr_b16 a[46:47], v47 offset:58368
    v_mfma_f32_16x16x32_bf16 a[72:75], a[12:15], a[248:251], a[72:75]
    ds_read_b64_tr_b16 a[48:49], v48 offset:49152
    v_mfma_f32_16x16x32_bf16 a[72:75], a[8:11], a[232:235], a[72:75]
    buffer_load_dwordx4 a[168:171], v37, s[8:11], s62 offen sc1
    v_mfma_f32_16x16x32_bf16 v[204:207], a[8:11], a[228:231], v[204:207]
    ds_read_b64_tr_b16 a[50:51], v48 offset:50176
    v_mfma_f32_16x16x32_bf16 v[204:207], a[12:15], a[244:247], v[204:207]
    ds_read_b64_tr_b16 a[52:53], v48 offset:57344
    v_mfma_f32_16x16x32_bf16 v[200:203], a[12:15], a[240:243], v[200:203]
    ds_read_b64_tr_b16 a[54:55], v48 offset:58368
    v_mfma_f32_16x16x32_bf16 v[200:203], a[8:11], a[224:227], v[200:203]
    v_mfma_f32_16x16x32_bf16 v[208:211], a[16:19], a[224:227], v[208:211]
    ds_read_b64_tr_b16 a[56:57], v49 offset:49152
    v_mfma_f32_16x16x32_bf16 v[208:211], a[20:23], a[240:243], v[208:211]
    buffer_load_dwordx4 a[172:175], v55, s[8:11], s62 offen sc1
    ds_read_b64_tr_b16 a[58:59], v49 offset:50176
    v_mfma_f32_16x16x32_bf16 v[212:215], a[20:23], a[244:247], v[212:215]
    ds_read_b64_tr_b16 a[60:61], v49 offset:57344
    v_mfma_f32_16x16x32_bf16 v[212:215], a[16:19], a[228:231], v[212:215]
    v_mfma_f32_16x16x32_bf16 a[80:83], a[16:19], a[232:235], a[80:83]
    ds_read_b64_tr_b16 a[62:63], v49 offset:58368
    v_mfma_f32_16x16x32_bf16 a[80:83], a[20:23], a[248:251], a[80:83]
    s_add_u32 s62, s62, 0x20000
    v_mfma_f32_16x16x32_bf16 a[84:87], a[20:23], a[252:255], a[84:87]
    s_add_u32 s52, s47, 528384
    v_mfma_f32_16x16x32_bf16 a[84:87], a[16:19], a[236:239], a[84:87]
    buffer_store_dwordx4 v[144:147], v1, s[48:51], s52 offen offset:0 sc1
    v_mfma_f32_16x16x32_bf16 a[92:95], a[24:27], a[236:239], a[92:95]
    v_mfma_f32_16x16x32_bf16 a[92:95], a[28:31], a[252:255], a[92:95]
    v_mfma_f32_16x16x32_bf16 a[88:91], a[28:31], a[248:251], a[88:91]
    v_mfma_f32_16x16x32_bf16 a[88:91], a[24:27], a[232:235], a[88:91]
    v_mfma_f32_16x16x32_bf16 v[220:223], a[24:27], a[228:231], v[220:223]
    v_mfma_f32_16x16x32_bf16 v[220:223], a[28:31], a[244:247], v[220:223]
    v_mfma_f32_16x16x32_bf16 v[216:219], a[28:31], a[240:243], v[216:219]
    v_mfma_f32_16x16x32_bf16 v[216:219], a[24:27], a[224:227], v[216:219]
    s_waitcnt vmcnt(9) lgkmcnt(0)
    s_barrier
    v_mfma_f32_16x16x32_bf16 v[224:227], a[32:35], a[224:227], v[224:227]
    v_mfma_f32_16x16x32_bf16 v[224:227], a[36:39], a[240:243], v[224:227]
    s_add_u32 m0, s60, 114688
    ds_read_b64_tr_b16 a[0:1], v42 offset:0
    ds_read_b64_tr_b16 a[2:3], v42 offset:1024
    v_mfma_f32_16x16x32_bf16 v[228:231], a[36:39], a[244:247], v[228:231]
    buffer_load_dwordx4 v38, s[12:15], s61 offen offset:0 lds
    v_mfma_f32_16x16x32_bf16 v[228:231], a[32:35], a[228:231], v[228:231]
    ds_read_b64_tr_b16 a[4:5], v42 offset:8192
    v_mfma_f32_16x16x32_bf16 a[96:99], a[32:35], a[232:235], a[96:99]
    buffer_load_dwordx4 v39, s[12:15], s61 offen offset:1024 lds
    ds_read_b64_tr_b16 a[6:7], v42 offset:9216
    v_mfma_f32_16x16x32_bf16 a[96:99], a[36:39], a[248:251], a[96:99]
    ds_read_b64_tr_b16 a[8:9], v43 offset:0
    v_mfma_f32_16x16x32_bf16 a[100:103], a[36:39], a[252:255], a[100:103]
    v_mfma_f32_16x16x32_bf16 a[100:103], a[32:35], a[236:239], a[100:103]
    buffer_load_dwordx4 v40, s[12:15], s61 offen offset:2048 lds
    ds_read_b64_tr_b16 a[10:11], v43 offset:1024
    v_mfma_f32_16x16x32_bf16 a[108:111], a[40:43], a[236:239], a[108:111]
    ds_read_b64_tr_b16 a[12:13], v43 offset:8192
    v_mfma_f32_16x16x32_bf16 a[108:111], a[44:47], a[252:255], a[108:111]
    ds_read_b64_tr_b16 a[14:15], v43 offset:9216
    v_mfma_f32_16x16x32_bf16 a[104:107], a[44:47], a[248:251], a[104:107]
    buffer_load_dwordx4 v41, s[12:15], s61 offen offset:3072 lds
    ds_read_b64_tr_b16 a[16:17], v44 offset:0
    v_mfma_f32_16x16x32_bf16 a[104:107], a[40:43], a[232:235], a[104:107]
    v_mfma_f32_16x16x32_bf16 v[236:239], a[40:43], a[228:231], v[236:239]
    s_add_u32 s61, s61, 0x80000
    ds_read_b64_tr_b16 a[18:19], v44 offset:1024
    v_mfma_f32_16x16x32_bf16 v[236:239], a[44:47], a[244:247], v[236:239]
    buffer_load_dwordx4 a[176:179], v36, s[8:11], s62 offen sc1
    ds_read_b64_tr_b16 a[20:21], v44 offset:8192
    v_mfma_f32_16x16x32_bf16 v[232:235], a[44:47], a[240:243], v[232:235]
    ds_read_b64_tr_b16 a[22:23], v44 offset:9216
    v_mfma_f32_16x16x32_bf16 v[232:235], a[40:43], a[224:227], v[232:235]
    buffer_load_dwordx4 a[180:183], v54, s[8:11], s62 offen sc1
    v_mfma_f32_16x16x32_bf16 v[240:243], a[48:51], a[224:227], v[240:243]
    ds_read_b64_tr_b16 a[24:25], v45 offset:0
    v_mfma_f32_16x16x32_bf16 v[240:243], a[52:55], a[240:243], v[240:243]
    ds_read_b64_tr_b16 a[26:27], v45 offset:1024
    v_mfma_f32_16x16x32_bf16 v[244:247], a[52:55], a[244:247], v[244:247]
    buffer_load_dwordx4 a[184:187], v37, s[8:11], s62 offen sc1
    ds_read_b64_tr_b16 a[28:29], v45 offset:8192
    v_mfma_f32_16x16x32_bf16 v[244:247], a[48:51], a[228:231], v[244:247]
    v_mfma_f32_16x16x32_bf16 a[112:115], a[48:51], a[232:235], a[112:115]
    ds_read_b64_tr_b16 a[30:31], v45 offset:9216
    v_mfma_f32_16x16x32_bf16 a[112:115], a[52:55], a[248:251], a[112:115]
    buffer_load_dwordx4 a[188:191], v55, s[8:11], s62 offen sc1
    v_mfma_f32_16x16x32_bf16 a[116:119], a[52:55], a[252:255], a[116:119]
    v_mfma_f32_16x16x32_bf16 a[116:119], a[48:51], a[236:239], a[116:119]
    s_add_u32 s62, s62, 0x20000
    v_mfma_f32_16x16x32_bf16 a[124:127], a[56:59], a[236:239], a[124:127]
    s_add_u32 s52, s47, 528384
    v_mfma_f32_16x16x32_bf16 a[124:127], a[60:63], a[252:255], a[124:127]
    buffer_store_dwordx4 v[148:151], v1, s[48:51], s52 offen offset:1024 sc1
    v_mfma_f32_16x16x32_bf16 a[120:123], a[60:63], a[248:251], a[120:123]
    v_mfma_f32_16x16x32_bf16 a[120:123], a[56:59], a[232:235], a[120:123]
    v_mfma_f32_16x16x32_bf16 v[252:255], a[56:59], a[228:231], v[252:255]
    s_cmp_eq_u32 s45, 0
    s_cbranch_scc1 k12_ool_64
k12_oolret_65:
    v_mfma_f32_16x16x32_bf16 v[252:255], a[60:63], a[244:247], v[252:255]
    v_mfma_f32_16x16x32_bf16 v[248:251], a[60:63], a[240:243], v[248:251]
    v_mfma_f32_16x16x32_bf16 v[248:251], a[56:59], a[224:227], v[248:251]
    s_waitcnt vmcnt(14) lgkmcnt(0)
    v_mfma_f32_16x16x32_bf16 v[192:195], a[0:3], a[128:131], v[192:195]
    v_mfma_f32_16x16x32_bf16 v[192:195], a[4:7], a[144:147], v[192:195]
    buffer_load_dwordx4 a[192:195], v36, s[8:11], s62 offen sc1
    ds_read_b64_tr_b16 a[32:33], v46 offset:0
    v_mfma_f32_16x16x32_bf16 v[196:199], a[4:7], a[148:151], v[196:199]
    ds_read_b64_tr_b16 a[34:35], v46 offset:1024
    v_mfma_f32_16x16x32_bf16 v[196:199], a[0:3], a[132:135], v[196:199]
    ds_read_b64_tr_b16 a[36:37], v46 offset:8192
    v_mfma_f32_16x16x32_bf16 a[64:67], a[0:3], a[136:139], a[64:67]
    ds_read_b64_tr_b16 a[38:39], v46 offset:9216
    v_mfma_f32_16x16x32_bf16 a[64:67], a[4:7], a[152:155], a[64:67]
    ds_read_b64_tr_b16 a[40:41], v47 offset:0
    v_mfma_f32_16x16x32_bf16 a[68:71], a[4:7], a[156:159], a[68:71]
    buffer_load_dwordx4 a[196:199], v54, s[8:11], s62 offen sc1
    v_mfma_f32_16x16x32_bf16 a[68:71], a[0:3], a[140:143], a[68:71]
    ds_read_b64_tr_b16 a[42:43], v47 offset:1024
    v_mfma_f32_16x16x32_bf16 a[76:79], a[8:11], a[140:143], a[76:79]
    ds_read_b64_tr_b16 a[44:45], v47 offset:8192
    v_mfma_f32_16x16x32_bf16 a[76:79], a[12:15], a[156:159], a[76:79]
    ds_read_b64_tr_b16 a[46:47], v47 offset:9216
    v_mfma_f32_16x16x32_bf16 a[72:75], a[12:15], a[152:155], a[72:75]
    ds_read_b64_tr_b16 a[48:49], v48 offset:0
    v_mfma_f32_16x16x32_bf16 a[72:75], a[8:11], a[136:139], a[72:75]
    buffer_load_dwordx4 a[200:203], v37, s[8:11], s62 offen sc1
    v_mfma_f32_16x16x32_bf16 v[204:207], a[8:11], a[132:135], v[204:207]
    ds_read_b64_tr_b16 a[50:51], v48 offset:1024
    v_mfma_f32_16x16x32_bf16 v[204:207], a[12:15], a[148:151], v[204:207]
    ds_read_b64_tr_b16 a[52:53], v48 offset:8192
    v_mfma_f32_16x16x32_bf16 v[200:203], a[12:15], a[144:147], v[200:203]
    ds_read_b64_tr_b16 a[54:55], v48 offset:9216
    v_mfma_f32_16x16x32_bf16 v[200:203], a[8:11], a[128:131], v[200:203]
    v_mfma_f32_16x16x32_bf16 v[208:211], a[16:19], a[128:131], v[208:211]
    ds_read_b64_tr_b16 a[56:57], v49 offset:0
    v_mfma_f32_16x16x32_bf16 v[208:211], a[20:23], a[144:147], v[208:211]
    buffer_load_dwordx4 a[204:207], v55, s[8:11], s62 offen sc1
    ds_read_b64_tr_b16 a[58:59], v49 offset:1024
    v_mfma_f32_16x16x32_bf16 v[212:215], a[20:23], a[148:151], v[212:215]
    ds_read_b64_tr_b16 a[60:61], v49 offset:8192
    v_mfma_f32_16x16x32_bf16 v[212:215], a[16:19], a[132:135], v[212:215]
    v_mfma_f32_16x16x32_bf16 a[80:83], a[16:19], a[136:139], a[80:83]
    ds_read_b64_tr_b16 a[62:63], v49 offset:9216
    v_mfma_f32_16x16x32_bf16 a[80:83], a[20:23], a[152:155], a[80:83]
    s_add_u32 s62, s62, 0x20000
    v_mfma_f32_16x16x32_bf16 a[84:87], a[20:23], a[156:159], a[84:87]
    s_add_u32 s52, s47, 528384
    v_mfma_f32_16x16x32_bf16 a[84:87], a[16:19], a[140:143], a[84:87]
    buffer_store_dwordx4 v[152:155], v1, s[48:51], s52 offen offset:2048 sc1
    v_mfma_f32_16x16x32_bf16 a[92:95], a[24:27], a[140:143], a[92:95]
    v_mfma_f32_16x16x32_bf16 a[92:95], a[28:31], a[156:159], a[92:95]
    v_mfma_f32_16x16x32_bf16 a[88:91], a[28:31], a[152:155], a[88:91]
    v_mfma_f32_16x16x32_bf16 a[88:91], a[24:27], a[136:139], a[88:91]
    v_mfma_f32_16x16x32_bf16 v[220:223], a[24:27], a[132:135], v[220:223]
    v_mfma_f32_16x16x32_bf16 v[220:223], a[28:31], a[148:151], v[220:223]
    v_mfma_f32_16x16x32_bf16 v[216:219], a[28:31], a[144:147], v[216:219]
    v_mfma_f32_16x16x32_bf16 v[216:219], a[24:27], a[128:131], v[216:219]
    s_waitcnt vmcnt(10) lgkmcnt(0)
    s_barrier
    v_mfma_f32_16x16x32_bf16 v[224:227], a[32:35], a[128:131], v[224:227]
    v_mfma_f32_16x16x32_bf16 v[224:227], a[36:39], a[144:147], v[224:227]
    s_add_u32 m0, s60, 131072
    ds_read_b64_tr_b16 a[0:1], v42 offset:16384
    ds_read_b64_tr_b16 a[2:3], v42 offset:17408
    v_mfma_f32_16x16x32_bf16 v[228:231], a[36:39], a[148:151], v[228:231]
    buffer_load_dwordx4 v38, s[12:15], s61 offen offset:0 lds
    v_mfma_f32_16x16x32_bf16 v[228:231], a[32:35], a[132:135], v[228:231]
    ds_read_b64_tr_b16 a[4:5], v42 offset:24576
    v_mfma_f32_16x16x32_bf16 a[96:99], a[32:35], a[136:139], a[96:99]
    buffer_load_dwordx4 v39, s[12:15], s61 offen offset:1024 lds
    ds_read_b64_tr_b16 a[6:7], v42 offset:25600
    v_mfma_f32_16x16x32_bf16 a[96:99], a[36:39], a[152:155], a[96:99]
    ds_read_b64_tr_b16 a[8:9], v43 offset:16384
    v_mfma_f32_16x16x32_bf16 a[100:103], a[36:39], a[156:159], a[100:103]
    v_mfma_f32_16x16x32_bf16 a[100:103], a[32:35], a[140:143], a[100:103]
    buffer_load_dwordx4 v40, s[12:15], s61 offen offset:2048 lds
    ds_read_b64_tr_b16 a[10:11], v43 offset:17408
    v_mfma_f32_16x16x32_bf16 a[108:111], a[40:43], a[140:143], a[108:111]
    ds_read_b64_tr_b16 a[12:13], v43 offset:24576
    v_mfma_f32_16x16x32_bf16 a[108:111], a[44:47], a[156:159], a[108:111]
    ds_read_b64_tr_b16 a[14:15], v43 offset:25600
    v_mfma_f32_16x16x32_bf16 a[104:107], a[44:47], a[152:155], a[104:107]
    buffer_load_dwordx4 v41, s[12:15], s61 offen offset:3072 lds
    ds_read_b64_tr_b16 a[16:17], v44 offset:16384
    v_mfma_f32_16x16x32_bf16 a[104:107], a[40:43], a[136:139], a[104:107]
    v_mfma_f32_16x16x32_bf16 v[236:239], a[40:43], a[132:135], v[236:239]
    s_add_u32 s61, s61, 0x80000
    ds_read_b64_tr_b16 a[18:19], v44 offset:17408
    v_mfma_f32_16x16x32_bf16 v[236:239], a[44:47], a[148:151], v[236:239]
    buffer_load_dwordx4 a[208:211], v36, s[8:11], s62 offen sc1
    ds_read_b64_tr_b16 a[20:21], v44 offset:24576
    v_mfma_f32_16x16x32_bf16 v[232:235], a[44:47], a[144:147], v[232:235]
    ds_read_b64_tr_b16 a[22:23], v44 offset:25600
    v_mfma_f32_16x16x32_bf16 v[232:235], a[40:43], a[128:131], v[232:235]
    buffer_load_dwordx4 a[212:215], v54, s[8:11], s62 offen sc1
    v_mfma_f32_16x16x32_bf16 v[240:243], a[48:51], a[128:131], v[240:243]
    ds_read_b64_tr_b16 a[24:25], v45 offset:16384
    v_mfma_f32_16x16x32_bf16 v[240:243], a[52:55], a[144:147], v[240:243]
    ds_read_b64_tr_b16 a[26:27], v45 offset:17408
    v_mfma_f32_16x16x32_bf16 v[244:247], a[52:55], a[148:151], v[244:247]
    buffer_load_dwordx4 a[216:219], v37, s[8:11], s62 offen sc1
    ds_read_b64_tr_b16 a[28:29], v45 offset:24576
    v_mfma_f32_16x16x32_bf16 v[244:247], a[48:51], a[132:135], v[244:247]
    v_mfma_f32_16x16x32_bf16 a[112:115], a[48:51], a[136:139], a[112:115]
    ds_read_b64_tr_b16 a[30:31], v45 offset:25600
    v_mfma_f32_16x16x32_bf16 a[112:115], a[52:55], a[152:155], a[112:115]
    buffer_load_dwordx4 a[220:223], v55, s[8:11], s62 offen sc1
    v_mfma_f32_16x16x32_bf16 a[116:119], a[52:55], a[156:159], a[116:119]
    v_mfma_f32_16x16x32_bf16 a[116:119], a[48:51], a[140:143], a[116:119]
    s_add_u32 s62, s62, 0x20000
    v_mfma_f32_16x16x32_bf16 a[124:127], a[56:59], a[140:143], a[124:127]
    s_add_u32 s52, s47, 528384
    v_mfma_f32_16x16x32_bf16 a[124:127], a[60:63], a[156:159], a[124:127]
    buffer_store_dwordx4 v[156:159], v1, s[48:51], s52 offen offset:3072 sc1
    v_mfma_f32_16x16x32_bf16 a[120:123], a[60:63], a[152:155], a[120:123]
    v_mfma_f32_16x16x32_bf16 a[120:123], a[56:59], a[136:139], a[120:123]
    v_mfma_f32_16x16x32_bf16 v[252:255], a[56:59], a[132:135], v[252:255]
    v_mfma_f32_16x16x32_bf16 v[252:255], a[60:63], a[148:151], v[252:255]
    v_mfma_f32_16x16x32_bf16 v[248:251], a[60:63], a[144:147], v[248:251]
    v_mfma_f32_16x16x32_bf16 v[248:251], a[56:59], a[128:131], v[248:251]
    s_waitcnt vmcnt(15) lgkmcnt(0)
    v_mfma_f32_16x16x32_bf16 v[192:195], a[0:3], a[160:163], v[192:195]
    v_mfma_f32_16x16x32_bf16 v[192:195], a[4:7], a[176:179], v[192:195]
    buffer_load_dwordx4 a[224:227], v36, s[8:11], s62 offen sc1
    ds_read_b64_tr_b16 a[32:33], v46 offset:16384
    v_mfma_f32_16x16x32_bf16 v[196:199], a[4:7], a[180:183], v[196:199]
    ds_read_b64_tr_b16 a[34:35], v46 offset:17408
    v_mfma_f32_16x16x32_bf16 v[196:199], a[0:3], a[164:167], v[196:199]
    ds_read_b64_tr_b16 a[36:37], v46 offset:24576
    v_mfma_f32_16x16x32_bf16 a[64:67], a[0:3], a[168:171], a[64:67]
    ds_read_b64_tr_b16 a[38:39], v46 offset:25600
    v_mfma_f32_16x16x32_bf16 a[64:67], a[4:7], a[184:187], a[64:67]
    ds_read_b64_tr_b16 a[40:41], v47 offset:16384
    v_mfma_f32_16x16x32_bf16 a[68:71], a[4:7], a[188:191], a[68:71]
    buffer_load_dwordx4 a[228:231], v54, s[8:11], s62 offen sc1
    v_mfma_f32_16x16x32_bf16 a[68:71], a[0:3], a[172:175], a[68:71]
    ds_read_b64_tr_b16 a[42:43], v47 offset:17408
    v_mfma_f32_16x16x32_bf16 a[76:79], a[8:11], a[172:175], a[76:79]
    ds_read_b64_tr_b16 a[44:45], v47 offset:24576
    v_mfma_f32_16x16x32_bf16 a[76:79], a[12:15], a[188:191], a[76:79]
    ds_read_b64_tr_b16 a[46:47], v47 offset:25600
    v_mfma_f32_16x16x32_bf16 a[72:75], a[12:15], a[184:187], a[72:75]
    ds_read_b64_tr_b16 a[48:49], v48 offset:16384
    v_mfma_f32_16x16x32_bf16 a[72:75], a[8:11], a[168:171], a[72:75]
    buffer_load_dwordx4 a[232:235], v37, s[8:11], s62 offen sc1
    v_mfma_f32_16x16x32_bf16 v[204:207], a[8:11], a[164:167], v[204:207]
    ds_read_b64_tr_b16 a[50:51], v48 offset:17408
    v_mfma_f32_16x16x32_bf16 v[204:207], a[12:15], a[180:183], v[204:207]
    ds_read_b64_tr_b16 a[52:53], v48 offset:24576
    v_mfma_f32_16x16x32_bf16 v[200:203], a[12:15], a[176:179], v[200:203]
    ds_read_b64_tr_b16 a[54:55], v48 offset:25600
    v_mfma_f32_16x16x32_bf16 v[200:203], a[8:11], a[160:163], v[200:203]
    v_mfma_f32_16x16x32_bf16 v[208:211], a[16:19], a[160:163], v[208:211]
    ds_read_b64_tr_b16 a[56:57], v49 offset:16384
    v_mfma_f32_16x16x32_bf16 v[208:211], a[20:23], a[176:179], v[208:211]
    buffer_load_dwordx4 a[236:239], v55, s[8:11], s62 offen sc1
    ds_read_b64_tr_b16 a[58:59], v49 offset:17408
    v_mfma_f32_16x16x32_bf16 v[212:215], a[20:23], a[180:183], v[212:215]
    ds_read_b64_tr_b16 a[60:61], v49 offset:24576
    v_mfma_f32_16x16x32_bf16 v[212:215], a[16:19], a[164:167], v[212:215]
    v_mfma_f32_16x16x32_bf16 a[80:83], a[16:19], a[168:171], a[80:83]
    ds_read_b64_tr_b16 a[62:63], v49 offset:25600
    v_mfma_f32_16x16x32_bf16 a[80:83], a[20:23], a[184:187], a[80:83]
    s_add_u32 s62, s62, 0x20000
    v_mfma_f32_16x16x32_bf16 a[84:87], a[20:23], a[188:191], a[84:87]
    s_add_u32 s52, s47, 532480
    v_mfma_f32_16x16x32_bf16 a[84:87], a[16:19], a[172:175], a[84:87]
    buffer_store_dwordx4 v[168:171], v1, s[48:51], s52 offen offset:2048 sc1
    v_mfma_f32_16x16x32_bf16 a[92:95], a[24:27], a[172:175], a[92:95]
    v_mfma_f32_16x16x32_bf16 a[92:95], a[28:31], a[188:191], a[92:95]
    v_mfma_f32_16x16x32_bf16 a[88:91], a[28:31], a[184:187], a[88:91]
    v_mfma_f32_16x16x32_bf16 a[88:91], a[24:27], a[168:171], a[88:91]
    v_mfma_f32_16x16x32_bf16 v[220:223], a[24:27], a[164:167], v[220:223]
    v_mfma_f32_16x16x32_bf16 v[220:223], a[28:31], a[180:183], v[220:223]
    v_mfma_f32_16x16x32_bf16 v[216:219], a[28:31], a[176:179], v[216:219]
    v_mfma_f32_16x16x32_bf16 v[216:219], a[24:27], a[160:163], v[216:219]
    s_waitcnt vmcnt(10) lgkmcnt(0)
    s_barrier
    v_mfma_f32_16x16x32_bf16 v[224:227], a[32:35], a[160:163], v[224:227]
    s_cmp_eq_u32 s56, 0
    s_cbranch_scc1 k12_ool_66
k12_oolret_67:
    v_mfma_f32_16x16x32_bf16 v[224:227], a[36:39], a[176:179], v[224:227]
    s_add_u32 m0, s60, 147456
    ds_read_b64_tr_b16 a[0:1], v42 offset:32768
    ds_read_b64_tr_b16 a[2:3], v42 offset:33792
    v_mfma_f32_16x16x32_bf16 v[228:231], a[36:39], a[180:183], v[228:231]
    buffer_load_dwordx4 v38, s[12:15], s61 offen offset:0 lds
    v_mfma_f32_16x16x32_bf16 v[228:231], a[32:35], a[164:167], v[228:231]
    ds_read_b64_tr_b16 a[4:5], v42 offset:40960
    v_mfma_f32_16x16x32_bf16 a[96:99], a[32:35], a[168:171], a[96:99]
    buffer_load_dwordx4 v39, s[12:15], s61 offen offset:1024 lds
    ds_read_b64_tr_b16 a[6:7], v42 offset:41984
    v_mfma_f32_16x16x32_bf16 a[96:99], a[36:39], a[184:187], a[96:99]
    ds_read_b64_tr_b16 a[8:9], v43 offset:32768
    v_mfma_f32_16x16x32_bf16 a[100:103], a[36:39], a[188:191], a[100:103]
    v_mfma_f32_16x16x32_bf16 a[100:103], a[32:35], a[172:175], a[100:103]
    buffer_load_dwordx4 v40, s[12:15], s61 offen offset:2048 lds
    ds_read_b64_tr_b16 a[10:11], v43 offset:33792
    v_mfma_f32_16x16x32_bf16 a[108:111], a[40:43], a[172:175], a[108:111]
    s_mov_b32 s32, s60
    ds_read_b64_tr_b16 a[12:13], v43 offset:40960
    v_mfma_f32_16x16x32_bf16 a[108:111], a[44:47], a[188:191], a[108:111]
    ds_read_b64_tr_b16 a[14:15], v43 offset:41984
    v_mfma_f32_16x16x32_bf16 a[104:107], a[44:47], a[184:187], a[104:107]
    s_mov_b32 s34, s60
    ds_read_b64_tr_b16 a[16:17], v44 offset:32768
    v_mfma_f32_16x16x32_bf16 a[104:107], a[40:43], a[168:171], a[104:107]
    buffer_load_dwordx4 v41, s[12:15], s61 offen offset:3072 lds
    v_mfma_f32_16x16x32_bf16 v[236:239], a[40:43], a[164:167], v[236:239]
    ds_read_b64_tr_b16 a[18:19], v44 offset:33792
    v_mfma_f32_16x16x32_bf16 v[236:239], a[44:47], a[180:183], v[236:239]
    s_mov_b32 s33, s60
    ds_read_b64_tr_b16 a[20:21], v44 offset:40960
    v_mfma_f32_16x16x32_bf16 v[232:235], a[44:47], a[176:179], v[232:235]
    s_add_u32 s61, s61, 0x80000
    buffer_load_dwordx4 a[240:243], v36, s[8:11], s62 offen sc1
    ds_read_b64_tr_b16 a[22:23], v44 offset:41984
    v_mfma_f32_16x16x32_bf16 v[232:235], a[40:43], a[160:163], v[232:235]
    v_mfma_f32_16x16x32_bf16 v[240:243], a[48:51], a[160:163], v[240:243]
    s_add_u32 s35, s60, 0x10000
    ds_read_b64_tr_b16 a[24:25], v45 offset:32768
    v_mfma_f32_16x16x32_bf16 v[240:243], a[52:55], a[176:179], v[240:243]
    buffer_load_dwordx4 a[244:247], v54, s[8:11], s62 offen sc1
    ds_read_b64_tr_b16 a[26:27], v45 offset:33792
    v_mfma_f32_16x16x32_bf16 v[244:247], a[52:55], a[180:183], v[244:247]
    ds_read_b64_tr_b16 a[28:29], v45 offset:40960
    v_mfma_f32_16x16x32_bf16 v[244:247], a[48:51], a[164:167], v[244:247]
    v_mfma_f32_16x16x32_bf16 a[112:115], a[48:51], a[168:171], a[112:115]
    buffer_load_dwordx4 a[248:251], v37, s[8:11], s62 offen sc1
    ds_read_b64_tr_b16 a[30:31], v45 offset:41984
    v_mfma_f32_16x16x32_bf16 a[112:115], a[52:55], a[184:187], a[112:115]
    v_mfma_f32_16x16x32_bf16 a[116:119], a[52:55], a[188:191], a[116:119]
    v_mfma_f32_16x16x32_bf16 a[116:119], a[48:51], a[172:175], a[116:119]
    v_mfma_f32_16x16x32_bf16 a[124:127], a[56:59], a[172:175], a[124:127]
    buffer_load_dwordx4 a[252:255], v55, s[8:11], s62 offen sc1
    v_mfma_f32_16x16x32_bf16 a[124:127], a[60:63], a[188:191], a[124:127]
    v_mfma_f32_16x16x32_bf16 a[120:123], a[60:63], a[184:187], a[120:123]
    s_add_u32 s62, s62, 0x20000
    v_mfma_f32_16x16x32_bf16 a[120:123], a[56:59], a[168:171], a[120:123]
    v_mfma_f32_16x16x32_bf16 v[252:255], a[56:59], a[164:167], v[252:255]
    v_mfma_f32_16x16x32_bf16 v[252:255], a[60:63], a[180:183], v[252:255]
    v_mfma_f32_16x16x32_bf16 v[248:251], a[60:63], a[176:179], v[248:251]
    v_mfma_f32_16x16x32_bf16 v[248:251], a[56:59], a[160:163], v[248:251]
    s_waitcnt vmcnt(14) lgkmcnt(0)
    v_mfma_f32_16x16x32_bf16 v[192:195], a[0:3], a[192:195], v[192:195]
    v_mfma_f32_16x16x32_bf16 v[192:195], a[4:7], a[208:211], v[192:195]
    buffer_load_dwordx4 a[128:131], v36, s[8:11], s62 offen sc1
    ds_read_b64_tr_b16 a[32:33], v46 offset:32768
    v_mfma_f32_16x16x32_bf16 v[196:199], a[4:7], a[212:215], v[196:199]
    ds_read_b64_tr_b16 a[34:35], v46 offset:33792
    v_mfma_f32_16x16x32_bf16 v[196:199], a[0:3], a[196:199], v[196:199]
    ds_read_b64_tr_b16 a[36:37], v46 offset:40960
    v_mfma_f32_16x16x32_bf16 a[64:67], a[0:3], a[200:203], a[64:67]
    ds_read_b64_tr_b16 a[38:39], v46 offset:41984
    v_mfma_f32_16x16x32_bf16 a[64:67], a[4:7], a[216:219], a[64:67]
    ds_read_b64_tr_b16 a[40:41], v47 offset:32768
    v_mfma_f32_16x16x32_bf16 a[68:71], a[4:7], a[220:223], a[68:71]
    buffer_load_dwordx4 a[132:135], v54, s[8:11], s62 offen sc1
    v_mfma_f32_16x16x32_bf16 a[68:71], a[0:3], a[204:207], a[68:71]
    ds_read_b64_tr_b16 a[42:43], v47 offset:33792
    v_mfma_f32_16x16x32_bf16 a[76:79], a[8:11], a[204:207], a[76:79]
    ds_read_b64_tr_b16 a[44:45], v47 offset:40960
    v_mfma_f32_16x16x32_bf16 a[76:79], a[12:15], a[220:223], a[76:79]
    ds_read_b64_tr_b16 a[46:47], v47 offset:41984
    v_mfma_f32_16x16x32_bf16 a[72:75], a[12:15], a[216:219], a[72:75]
    ds_read_b64_tr_b16 a[48:49], v48 offset:32768
    v_mfma_f32_16x16x32_bf16 a[72:75], a[8:11], a[200:203], a[72:75]
    buffer_load_dwordx4 a[136:139], v37, s[8:11], s62 offen sc1
    v_mfma_f32_16x16x32_bf16 v[204:207], a[8:11], a[196:199], v[204:207]
    ds_read_b64_tr_b16 a[50:51], v48 offset:33792
    v_mfma_f32_16x16x32_bf16 v[204:207], a[12:15], a[212:215], v[204:207]
    ds_read_b64_tr_b16 a[52:53], v48 offset:40960
    v_mfma_f32_16x16x32_bf16 v[200:203], a[12:15], a[208:211], v[200:203]
    ds_read_b64_tr_b16 a[54:55], v48 offset:41984
    v_mfma_f32_16x16x32_bf16 v[200:203], a[8:11], a[192:195], v[200:203]
    v_mfma_f32_16x16x32_bf16 v[208:211], a[16:19], a[192:195], v[208:211]
    ds_read_b64_tr_b16 a[56:57], v49 offset:32768
    v_mfma_f32_16x16x32_bf16 v[208:211], a[20:23], a[208:211], v[208:211]
    buffer_load_dwordx4 a[140:143], v55, s[8:11], s62 offen sc1
    ds_read_b64_tr_b16 a[58:59], v49 offset:33792
    v_mfma_f32_16x16x32_bf16 v[212:215], a[20:23], a[212:215], v[212:215]
    ds_read_b64_tr_b16 a[60:61], v49 offset:40960
    v_mfma_f32_16x16x32_bf16 v[212:215], a[16:19], a[196:199], v[212:215]
    v_mfma_f32_16x16x32_bf16 a[80:83], a[16:19], a[200:203], a[80:83]
    ds_read_b64_tr_b16 a[62:63], v49 offset:41984
    v_mfma_f32_16x16x32_bf16 a[80:83], a[20:23], a[216:219], a[80:83]
    s_add_u32 s62, s62, 0x20000
    v_mfma_f32_16x16x32_bf16 a[84:87], a[20:23], a[220:223], a[84:87]
    s_add_u32 s52, s47, 532480
    v_mfma_f32_16x16x32_bf16 a[84:87], a[16:19], a[204:207], a[84:87]
    buffer_store_dwordx4 v[172:175], v1, s[48:51], s52 offen offset:3072 sc1
    v_mfma_f32_16x16x32_bf16 a[92:95], a[24:27], a[204:207], a[92:95]
    v_mfma_f32_16x16x32_bf16 a[92:95], a[28:31], a[220:223], a[92:95]
    v_mfma_f32_16x16x32_bf16 a[88:91], a[28:31], a[216:219], a[88:91]
    v_mfma_f32_16x16x32_bf16 a[88:91], a[24:27], a[200:203], a[88:91]
    v_mfma_f32_16x16x32_bf16 v[220:223], a[24:27], a[196:199], v[220:223]
    v_add_co_u32 v2, vcc, 0x4000, v2
    s_nop 1
    v_addc_co_u32 v3, vcc, 0, v3, vcc
    global_load_dword v51, v[2:3], off
    v_mfma_f32_16x16x32_bf16 v[220:223], a[28:31], a[212:215], v[220:223]
    v_mfma_f32_16x16x32_bf16 v[216:219], a[28:31], a[208:211], v[216:219]
    v_mfma_f32_16x16x32_bf16 v[216:219], a[24:27], a[192:195], v[216:219]
    s_waitcnt vmcnt(9) lgkmcnt(0)
    s_barrier
    v_mfma_f32_16x16x32_bf16 v[224:227], a[32:35], a[192:195], v[224:227]
    v_mfma_f32_16x16x32_bf16 v[224:227], a[36:39], a[208:211], v[224:227]
    s_add_u32 m0, s60, 98304
    ds_read_b64_tr_b16 a[0:1], v42 offset:49152
    ds_read_b64_tr_b16 a[2:3], v42 offset:50176
    v_mfma_f32_16x16x32_bf16 v[228:231], a[36:39], a[212:215], v[228:231]
    buffer_load_dwordx4 v38, s[12:15], s61 offen offset:0 lds
    v_mfma_f32_16x16x32_bf16 v[228:231], a[32:35], a[196:199], v[228:231]
    ds_read_b64_tr_b16 a[4:5], v42 offset:57344
    v_mfma_f32_16x16x32_bf16 a[96:99], a[32:35], a[200:203], a[96:99]
    buffer_load_dwordx4 v39, s[12:15], s61 offen offset:1024 lds
    ds_read_b64_tr_b16 a[6:7], v42 offset:58368
    v_mfma_f32_16x16x32_bf16 a[96:99], a[36:39], a[216:219], a[96:99]
    ds_read_b64_tr_b16 a[8:9], v43 offset:49152
    v_mfma_f32_16x16x32_bf16 a[100:103], a[36:39], a[220:223], a[100:103]
    v_mfma_f32_16x16x32_bf16 a[100:103], a[32:35], a[204:207], a[100:103]
    buffer_load_dwordx4 v40, s[12:15], s61 offen offset:2048 lds
    ds_read_b64_tr_b16 a[10:11], v43 offset:50176
    v_mfma_f32_16x16x32_bf16 a[108:111], a[40:43], a[204:207], a[108:111]
    ds_read_b64_tr_b16 a[12:13], v43 offset:57344
    v_mfma_f32_16x16x32_bf16 a[108:111], a[44:47], a[220:223], a[108:111]
    ds_read_b64_tr_b16 a[14:15], v43 offset:58368
    v_mfma_f32_16x16x32_bf16 a[104:107], a[44:47], a[216:219], a[104:107]
    buffer_load_dwordx4 v41, s[12:15], s61 offen offset:3072 lds
    ds_read_b64_tr_b16 a[16:17], v44 offset:49152
    v_mfma_f32_16x16x32_bf16 a[104:107], a[40:43], a[200:203], a[104:107]
    v_mfma_f32_16x16x32_bf16 v[236:239], a[40:43], a[196:199], v[236:239]
    s_add_u32 s61, s61, 0x80000
    ds_read_b64_tr_b16 a[18:19], v44 offset:50176
    v_mfma_f32_16x16x32_bf16 v[236:239], a[44:47], a[212:215], v[236:239]
    buffer_load_dwordx4 a[144:147], v36, s[8:11], s62 offen sc1
    ds_read_b64_tr_b16 a[20:21], v44 offset:57344
    v_mfma_f32_16x16x32_bf16 v[232:235], a[44:47], a[208:211], v[232:235]
    ds_read_b64_tr_b16 a[22:23], v44 offset:58368
    v_mfma_f32_16x16x32_bf16 v[232:235], a[40:43], a[192:195], v[232:235]
    buffer_load_dwordx4 a[148:151], v54, s[8:11], s62 offen sc1
    v_mfma_f32_16x16x32_bf16 v[240:243], a[48:51], a[192:195], v[240:243]
    ds_read_b64_tr_b16 a[24:25], v45 offset:49152
    v_mfma_f32_16x16x32_bf16 v[240:243], a[52:55], a[208:211], v[240:243]
    ds_read_b64_tr_b16 a[26:27], v45 offset:50176
    v_mfma_f32_16x16x32_bf16 v[244:247], a[52:55], a[212:215], v[244:247]
    buffer_load_dwordx4 a[152:155], v37, s[8:11], s62 offen sc1
    ds_read_b64_tr_b16 a[28:29], v45 offset:57344
    v_mfma_f32_16x16x32_bf16 v[244:247], a[48:51], a[196:199], v[244:247]
    v_mfma_f32_16x16x32_bf16 a[112:115], a[48:51], a[200:203], a[112:115]
    ds_read_b64_tr_b16 a[30:31], v45 offset:58368
    v_mfma_f32_16x16x32_bf16 a[112:115], a[52:55], a[216:219], a[112:115]
    buffer_load_dwordx4 a[156:159], v55, s[8:11], s62 offen sc1
    v_mfma_f32_16x16x32_bf16 a[116:119], a[52:55], a[220:223], a[116:119]
    v_mfma_f32_16x16x32_bf16 a[116:119], a[48:51], a[204:207], a[116:119]
    s_add_u32 s62, s62, 0x20000
    v_mfma_f32_16x16x32_bf16 a[124:127], a[56:59], a[204:207], a[124:127]
    s_add_u32 s52, s47, 536576
    v_mfma_f32_16x16x32_bf16 a[124:127], a[60:63], a[220:223], a[124:127]
    buffer_store_dwordx4 v[176:179], v1, s[48:51], s52 offen offset:0 sc1
    v_mfma_f32_16x16x32_bf16 a[120:123], a[60:63], a[216:219], a[120:123]
    v_mfma_f32_16x16x32_bf16 a[120:123], a[56:59], a[200:203], a[120:123]
    v_mfma_f32_16x16x32_bf16 v[252:255], a[56:59], a[196:199], v[252:255]
    v_mfma_f32_16x16x32_bf16 v[252:255], a[60:63], a[212:215], v[252:255]
    v_mfma_f32_16x16x32_bf16 v[248:251], a[60:63], a[208:211], v[248:251]
    v_mfma_f32_16x16x32_bf16 v[248:251], a[56:59], a[192:195], v[248:251]
    s_waitcnt vmcnt(14) lgkmcnt(0)
    v_mfma_f32_16x16x32_bf16 v[192:195], a[0:3], a[224:227], v[192:195]
    v_mfma_f32_16x16x32_bf16 v[192:195], a[4:7], a[240:243], v[192:195]
    buffer_load_dwordx4 a[160:163], v36, s[8:11], s62 offen sc1
    ds_read_b64_tr_b16 a[32:33], v46 offset:49152
    v_mfma_f32_16x16x32_bf16 v[196:199], a[4:7], a[244:247], v[196:199]
    ds_read_b64_tr_b16 a[34:35], v46 offset:50176
    v_mfma_f32_16x16x32_bf16 v[196:199], a[0:3], a[228:231], v[196:199]
    ds_read_b64_tr_b16 a[36:37], v46 offset:57344
    v_mfma_f32_16x16x32_bf16 a[64:67], a[0:3], a[232:235], a[64:67]
    ds_read_b64_tr_b16 a[38:39], v46 offset:58368
    v_mfma_f32_16x16x32_bf16 a[64:67], a[4:7], a[248:251], a[64:67]
    ds_read_b64_tr_b16 a[40:41], v47 offset:49152
    v_mfma_f32_16x16x32_bf16 a[68:71], a[4:7], a[252:255], a[68:71]
    buffer_load_dwordx4 a[164:167], v54, s[8:11], s62 offen sc1
    v_mfma_f32_16x16x32_bf16 a[68:71], a[0:3], a[236:239], a[68:71]
    ds_read_b64_tr_b16 a[42:43], v47 offset:50176
    v_mfma_f32_16x16x32_bf16 a[76:79], a[8:11], a[236:239], a[76:79]
    ds_read_b64_tr_b16 a[44:45], v47 offset:57344
    v_mfma_f32_16x16x32_bf16 a[76:79], a[12:15], a[252:255], a[76:79]
    ds_read_b64_tr_b16 a[46:47], v47 offset:58368
    v_mfma_f32_16x16x32_bf16 a[72:75], a[12:15], a[248:251], a[72:75]
    ds_read_b64_tr_b16 a[48:49], v48 offset:49152
    v_mfma_f32_16x16x32_bf16 a[72:75], a[8:11], a[232:235], a[72:75]
    buffer_load_dwordx4 a[168:171], v37, s[8:11], s62 offen sc1
    v_mfma_f32_16x16x32_bf16 v[204:207], a[8:11], a[228:231], v[204:207]
    ds_read_b64_tr_b16 a[50:51], v48 offset:50176
    v_mfma_f32_16x16x32_bf16 v[204:207], a[12:15], a[244:247], v[204:207]
    ds_read_b64_tr_b16 a[52:53], v48 offset:57344
    v_mfma_f32_16x16x32_bf16 v[200:203], a[12:15], a[240:243], v[200:203]
    ds_read_b64_tr_b16 a[54:55], v48 offset:58368
    v_mfma_f32_16x16x32_bf16 v[200:203], a[8:11], a[224:227], v[200:203]
    v_mfma_f32_16x16x32_bf16 v[208:211], a[16:19], a[224:227], v[208:211]
    ds_read_b64_tr_b16 a[56:57], v49 offset:49152
    v_mfma_f32_16x16x32_bf16 v[208:211], a[20:23], a[240:243], v[208:211]
    buffer_load_dwordx4 a[172:175], v55, s[8:11], s62 offen sc1
    ds_read_b64_tr_b16 a[58:59], v49 offset:50176
    v_mfma_f32_16x16x32_bf16 v[212:215], a[20:23], a[244:247], v[212:215]
    ds_read_b64_tr_b16 a[60:61], v49 offset:57344
    v_mfma_f32_16x16x32_bf16 v[212:215], a[16:19], a[228:231], v[212:215]
    v_mfma_f32_16x16x32_bf16 a[80:83], a[16:19], a[232:235], a[80:83]
    ds_read_b64_tr_b16 a[62:63], v49 offset:58368
    v_mfma_f32_16x16x32_bf16 a[80:83], a[20:23], a[248:251], a[80:83]
    s_add_u32 s62, s62, 0x20000
    v_mfma_f32_16x16x32_bf16 a[84:87], a[20:23], a[252:255], a[84:87]
    s_add_u32 s52, s47, 536576
    v_mfma_f32_16x16x32_bf16 a[84:87], a[16:19], a[236:239], a[84:87]
    buffer_store_dwordx4 v[180:183], v1, s[48:51], s52 offen offset:1024 sc1
    v_mfma_f32_16x16x32_bf16 a[92:95], a[24:27], a[236:239], a[92:95]
    v_mfma_f32_16x16x32_bf16 a[92:95], a[28:31], a[252:255], a[92:95]
    v_mfma_f32_16x16x32_bf16 a[88:91], a[28:31], a[248:251], a[88:91]
    v_mfma_f32_16x16x32_bf16 a[88:91], a[24:27], a[232:235], a[88:91]
    v_mfma_f32_16x16x32_bf16 v[220:223], a[24:27], a[228:231], v[220:223]
    v_mfma_f32_16x16x32_bf16 v[220:223], a[28:31], a[244:247], v[220:223]
    v_mfma_f32_16x16x32_bf16 v[216:219], a[28:31], a[240:243], v[216:219]
    v_mfma_f32_16x16x32_bf16 v[216:219], a[24:27], a[224:227], v[216:219]
    s_waitcnt vmcnt(10) lgkmcnt(0)
    s_barrier
    v_mfma_f32_16x16x32_bf16 v[224:227], a[32:35], a[224:227], v[224:227]
    s_cmp_eq_u32 s30, 0
    s_cbranch_scc1 k12_ool_68
k12_oolret_69:
    v_mfma_f32_16x16x32_bf16 v[224:227], a[36:39], a[240:243], v[224:227]
    s_add_u32 m0, s60, 114688
    ds_read_b64_tr_b16 a[0:1], v42 offset:0
    ds_read_b64_tr_b16 a[2:3], v42 offset:1024
    v_mfma_f32_16x16x32_bf16 v[228:231], a[36:39], a[244:247], v[228:231]
    buffer_load_dwordx4 v38, s[12:15], s61 offen offset:0 lds
    v_mfma_f32_16x16x32_bf16 v[228:231], a[32:35], a[228:231], v[228:231]
    ds_read_b64_tr_b16 a[4:5], v42 offset:8192
    v_mfma_f32_16x16x32_bf16 a[96:99], a[32:35], a[232:235], a[96:99]
    buffer_load_dwordx4 v39, s[12:15], s61 offen offset:1024 lds
    ds_read_b64_tr_b16 a[6:7], v42 offset:9216
    v_mfma_f32_16x16x32_bf16 a[96:99], a[36:39], a[248:251], a[96:99]
    ds_read_b64_tr_b16 a[8:9], v43 offset:0
    v_mfma_f32_16x16x32_bf16 a[100:103], a[36:39], a[252:255], a[100:103]
    v_mfma_f32_16x16x32_bf16 a[100:103], a[32:35], a[236:239], a[100:103]
    buffer_load_dwordx4 v40, s[12:15], s61 offen offset:2048 lds
    ds_read_b64_tr_b16 a[10:11], v43 offset:1024
    v_mfma_f32_16x16x32_bf16 a[108:111], a[40:43], a[236:239], a[108:111]
    ds_read_b64_tr_b16 a[12:13], v43 offset:8192
    v_mfma_f32_16x16x32_bf16 a[108:111], a[44:47], a[252:255], a[108:111]
    ds_read_b64_tr_b16 a[14:15], v43 offset:9216
    v_mfma_f32_16x16x32_bf16 a[104:107], a[44:47], a[248:251], a[104:107]
    buffer_load_dwordx4 v41, s[12:15], s61 offen offset:3072 lds
    ds_read_b64_tr_b16 a[16:17], v44 offset:0
    v_mfma_f32_16x16x32_bf16 a[104:107], a[40:43], a[232:235], a[104:107]
    v_mfma_f32_16x16x32_bf16 v[236:239], a[40:43], a[228:231], v[236:239]
    s_add_u32 s61, s61, 0x80000
    ds_read_b64_tr_b16 a[18:19], v44 offset:1024
    v_mfma_f32_16x16x32_bf16 v[236:239], a[44:47], a[244:247], v[236:239]
    buffer_load_dwordx4 a[176:179], v36, s[8:11], s62 offen sc1
    ds_read_b64_tr_b16 a[20:21], v44 offset:8192
    v_mfma_f32_16x16x32_bf16 v[232:235], a[44:47], a[240:243], v[232:235]
    ds_read_b64_tr_b16 a[22:23], v44 offset:9216
    v_mfma_f32_16x16x32_bf16 v[232:235], a[40:43], a[224:227], v[232:235]
    buffer_load_dwordx4 a[180:183], v54, s[8:11], s62 offen sc1
    v_mfma_f32_16x16x32_bf16 v[240:243], a[48:51], a[224:227], v[240:243]
    ds_read_b64_tr_b16 a[24:25], v45 offset:0
    v_mfma_f32_16x16x32_bf16 v[240:243], a[52:55], a[240:243], v[240:243]
    ds_read_b64_tr_b16 a[26:27], v45 offset:1024
    v_mfma_f32_16x16x32_bf16 v[244:247], a[52:55], a[244:247], v[244:247]
    buffer_load_dwordx4 a[184:187], v37, s[8:11], s62 offen sc1
    ds_read_b64_tr_b16 a[28:29], v45 offset:8192
    v_mfma_f32_16x16x32_bf16 v[244:247], a[48:51], a[228:231], v[244:247]
    v_mfma_f32_16x16x32_bf16 a[112:115], a[48:51], a[232:235], a[112:115]
    ds_read_b64_tr_b16 a[30:31], v45 offset:9216
    v_mfma_f32_16x16x32_bf16 a[112:115], a[52:55], a[248:251], a[112:115]
    buffer_load_dwordx4 a[188:191], v55, s[8:11], s62 offen sc1
    v_mfma_f32_16x16x32_bf16 a[116:119], a[52:55], a[252:255], a[116:119]
    v_mfma_f32_16x16x32_bf16 a[116:119], a[48:51], a[236:239], a[116:119]
    s_add_u32 s62, s62, 0x20000
    v_mfma_f32_16x16x32_bf16 a[124:127], a[56:59], a[236:239], a[124:127]
    s_add_u32 s52, s47, 536576
    v_mfma_f32_16x16x32_bf16 a[124:127], a[60:63], a[252:255], a[124:127]
    buffer_store_dwordx4 v[184:187], v1, s[48:51], s52 offen offset:2048 sc1
    v_mfma_f32_16x16x32_bf16 a[120:123], a[60:63], a[248:251], a[120:123]
    v_mfma_f32_16x16x32_bf16 a[120:123], a[56:59], a[232:235], a[120:123]
    v_mfma_f32_16x16x32_bf16 v[252:255], a[56:59], a[228:231], v[252:255]
    v_mfma_f32_16x16x32_bf16 v[252:255], a[60:63], a[244:247], v[252:255]
    v_mfma_f32_16x16x32_bf16 v[248:251], a[60:63], a[240:243], v[248:251]
    v_mfma_f32_16x16x32_bf16 v[248:251], a[56:59], a[224:227], v[248:251]
    s_waitcnt vmcnt(15) lgkmcnt(0)
    v_mfma_f32_16x16x32_bf16 v[192:195], a[0:3], a[128:131], v[192:195]
    v_mfma_f32_16x16x32_bf16 v[192:195], a[4:7], a[144:147], v[192:195]
    s_add_u32 s52, s47, 536576
    ds_read_b64_tr_b16 a[32:33], v46 offset:0
    ds_read_b64_tr_b16 a[34:35], v46 offset:1024
    v_mfma_f32_16x16x32_bf16 v[196:199], a[4:7], a[148:151], v[196:199]
    buffer_store_dwordx4 v[188:191], v1, s[48:51], s52 offen offset:3072 sc1
    v_mfma_f32_16x16x32_bf16 v[196:199], a[0:3], a[132:135], v[196:199]
    ds_read_b64_tr_b16 a[36:37], v46 offset:8192
    v_mfma_f32_16x16x32_bf16 a[64:67], a[0:3], a[136:139], a[64:67]
    ds_read_b64_tr_b16 a[38:39], v46 offset:9216
    v_mfma_f32_16x16x32_bf16 a[64:67], a[4:7], a[152:155], a[64:67]
    ds_read_b64_tr_b16 a[40:41], v47 offset:0
    v_mfma_f32_16x16x32_bf16 a[68:71], a[4:7], a[156:159], a[68:71]
    v_mfma_f32_16x16x32_bf16 a[68:71], a[0:3], a[140:143], a[68:71]
    ds_read_b64_tr_b16 a[42:43], v47 offset:1024
    v_mfma_f32_16x16x32_bf16 a[76:79], a[8:11], a[140:143], a[76:79]
    ds_read_b64_tr_b16 a[44:45], v47 offset:8192
    v_mfma_f32_16x16x32_bf16 a[76:79], a[12:15], a[156:159], a[76:79]
    ds_read_b64_tr_b16 a[46:47], v47 offset:9216
    v_mfma_f32_16x16x32_bf16 a[72:75], a[12:15], a[152:155], a[72:75]
    ds_read_b64_tr_b16 a[48:49], v48 offset:0
    v_mfma_f32_16x16x32_bf16 a[72:75], a[8:11], a[136:139], a[72:75]
    v_mfma_f32_16x16x32_bf16 v[204:207], a[8:11], a[132:135], v[204:207]
    ds_read_b64_tr_b16 a[50:51], v48 offset:1024
    v_mfma_f32_16x16x32_bf16 v[204:207], a[12:15], a[148:151], v[204:207]
    ds_read_b64_tr_b16 a[52:53], v48 offset:8192
    v_mfma_f32_16x16x32_bf16 v[200:203], a[12:15], a[144:147], v[200:203]
    ds_read_b64_tr_b16 a[54:55], v48 offset:9216
    v_mfma_f32_16x16x32_bf16 v[200:203], a[8:11], a[128:131], v[200:203]
    v_mfma_f32_16x16x32_bf16 v[208:211], a[16:19], a[128:131], v[208:211]
    ds_read_b64_tr_b16 a[56:57], v49 offset:0
    v_mfma_f32_16x16x32_bf16 v[208:211], a[20:23], a[144:147], v[208:211]
    ds_read_b64_tr_b16 a[58:59], v49 offset:1024
    v_mfma_f32_16x16x32_bf16 v[212:215], a[20:23], a[148:151], v[212:215]
    ds_read_b64_tr_b16 a[60:61], v49 offset:8192
    v_mfma_f32_16x16x32_bf16 v[212:215], a[16:19], a[132:135], v[212:215]
    v_mfma_f32_16x16x32_bf16 a[80:83], a[16:19], a[136:139], a[80:83]
    ds_read_b64_tr_b16 a[62:63], v49 offset:9216
    v_mfma_f32_16x16x32_bf16 a[80:83], a[20:23], a[152:155], a[80:83]
    v_mfma_f32_16x16x32_bf16 a[84:87], a[20:23], a[156:159], a[84:87]
    v_mfma_f32_16x16x32_bf16 a[84:87], a[16:19], a[140:143], a[84:87]
    v_mfma_f32_16x16x32_bf16 a[92:95], a[24:27], a[140:143], a[92:95]
    v_mfma_f32_16x16x32_bf16 a[92:95], a[28:31], a[156:159], a[92:95]
    v_mfma_f32_16x16x32_bf16 a[88:91], a[28:31], a[152:155], a[88:91]
    v_mfma_f32_16x16x32_bf16 a[88:91], a[24:27], a[136:139], a[88:91]
    v_mfma_f32_16x16x32_bf16 v[220:223], a[24:27], a[132:135], v[220:223]
    s_cmp_eq_u32 s30, 0
    s_cbranch_scc1 k12_ool_72
k12_oolret_73:
    v_mfma_f32_16x16x32_bf16 v[220:223], a[28:31], a[148:151], v[220:223]
    v_mfma_f32_16x16x32_bf16 v[216:219], a[28:31], a[144:147], v[216:219]
    v_mfma_f32_16x16x32_bf16 v[216:219], a[24:27], a[128:131], v[216:219]
    s_waitcnt vmcnt(6) lgkmcnt(0)
    s_barrier
    v_mfma_f32_16x16x32_bf16 v[224:227], a[32:35], a[128:131], v[224:227]
    v_mfma_f32_16x16x32_bf16 v[224:227], a[36:39], a[144:147], v[224:227]
    s_mov_b32 m0, s34
    ds_read_b64_tr_b16 a[0:1], v42 offset:16384
    ds_read_b64_tr_b16 a[2:3], v42 offset:17408
    v_mfma_f32_16x16x32_bf16 v[228:231], a[36:39], a[148:151], v[228:231]
    buffer_load_dwordx4 v1, s[16:19], s32 offen offset:0 sc1 lds
    v_mfma_f32_16x16x32_bf16 v[228:231], a[32:35], a[132:135], v[228:231]
    ds_read_b64_tr_b16 a[4:5], v42 offset:24576
    v_mfma_f32_16x16x32_bf16 a[96:99], a[32:35], a[136:139], a[96:99]
    buffer_load_dwordx4 v1, s[16:19], s32 offen offset:1024 sc1 lds
    ds_read_b64_tr_b16 a[6:7], v42 offset:25600
    v_mfma_f32_16x16x32_bf16 a[96:99], a[36:39], a[152:155], a[96:99]
    ds_read_b64_tr_b16 a[8:9], v43 offset:16384
    v_mfma_f32_16x16x32_bf16 a[100:103], a[36:39], a[156:159], a[100:103]
    v_mfma_f32_16x16x32_bf16 a[100:103], a[32:35], a[140:143], a[100:103]
    buffer_load_dwordx4 v1, s[16:19], s32 offen offset:2048 sc1 lds
    ds_read_b64_tr_b16 a[10:11], v43 offset:17408
    v_mfma_f32_16x16x32_bf16 a[108:111], a[40:43], a[140:143], a[108:111]
    ds_read_b64_tr_b16 a[12:13], v43 offset:24576
    v_mfma_f32_16x16x32_bf16 a[108:111], a[44:47], a[156:159], a[108:111]
    ds_read_b64_tr_b16 a[14:15], v43 offset:25600
    v_mfma_f32_16x16x32_bf16 a[104:107], a[44:47], a[152:155], a[104:107]
    ds_read_b64_tr_b16 a[16:17], v44 offset:16384
    v_mfma_f32_16x16x32_bf16 a[104:107], a[40:43], a[136:139], a[104:107]
    buffer_load_dwordx4 v1, s[16:19], s32 offen offset:3072 sc1 lds
    v_mfma_f32_16x16x32_bf16 v[236:239], a[40:43], a[132:135], v[236:239]
    ds_read_b64_tr_b16 a[18:19], v44 offset:17408
    v_mfma_f32_16x16x32_bf16 v[236:239], a[44:47], a[148:151], v[236:239]
    s_add_u32 s32, s32, 0x80000
    ds_read_b64_tr_b16 a[20:21], v44 offset:24576
    v_mfma_f32_16x16x32_bf16 v[232:235], a[44:47], a[144:147], v[232:235]
    s_add_u32 s34, s34, 0x4000
    ds_read_b64_tr_b16 a[22:23], v44 offset:25600
    s_mov_b32 m0, s34
    v_mfma_f32_16x16x32_bf16 v[232:235], a[40:43], a[128:131], v[232:235]
    buffer_load_dwordx4 v1, s[16:19], s32 offen offset:0 sc1 lds
    v_mfma_f32_16x16x32_bf16 v[240:243], a[48:51], a[128:131], v[240:243]
    ds_read_b64_tr_b16 a[24:25], v45 offset:16384
    v_mfma_f32_16x16x32_bf16 v[240:243], a[52:55], a[144:147], v[240:243]
    buffer_load_dwordx4 v1, s[16:19], s32 offen offset:1024 sc1 lds
    ds_read_b64_tr_b16 a[26:27], v45 offset:17408
    v_mfma_f32_16x16x32_bf16 v[244:247], a[52:55], a[148:151], v[244:247]
    ds_read_b64_tr_b16 a[28:29], v45 offset:24576
    v_mfma_f32_16x16x32_bf16 v[244:247], a[48:51], a[132:135], v[244:247]
    v_mfma_f32_16x16x32_bf16 a[112:115], a[48:51], a[136:139], a[112:115]
    buffer_load_dwordx4 v1, s[16:19], s32 offen offset:2048 sc1 lds
    ds_read_b64_tr_b16 a[30:31], v45 offset:25600
    v_mfma_f32_16x16x32_bf16 a[112:115], a[52:55], a[152:155], a[112:115]
    v_mfma_f32_16x16x32_bf16 a[116:119], a[52:55], a[156:159], a[116:119]
    v_mfma_f32_16x16x32_bf16 a[116:119], a[48:51], a[140:143], a[116:119]
    v_mfma_f32_16x16x32_bf16 a[124:127], a[56:59], a[140:143], a[124:127]
    buffer_load_dwordx4 v1, s[16:19], s32 offen offset:3072 sc1 lds
    v_mfma_f32_16x16x32_bf16 a[124:127], a[60:63], a[156:159], a[124:127]
    v_mfma_f32_16x16x32_bf16 a[120:123], a[60:63], a[152:155], a[120:123]
    s_add_u32 s32, s32, 0x80000
    v_mfma_f32_16x16x32_bf16 a[120:123], a[56:59], a[136:139], a[120:123]
    s_add_u32 s34, s34, 0x4000
    v_mfma_f32_16x16x32_bf16 v[252:255], a[56:59], a[132:135], v[252:255]
    v_mfma_f32_16x16x32_bf16 v[252:255], a[60:63], a[148:151], v[252:255]
    v_mfma_f32_16x16x32_bf16 v[248:251], a[60:63], a[144:147], v[248:251]
    v_mfma_f32_16x16x32_bf16 v[248:251], a[56:59], a[128:131], v[248:251]
    s_waitcnt vmcnt(10) lgkmcnt(0)
    v_mfma_f32_16x16x32_bf16 v[192:195], a[0:3], a[160:163], v[192:195]
    v_mfma_f32_16x16x32_bf16 v[192:195], a[4:7], a[176:179], v[192:195]
    s_mov_b32 m0, s35
    ds_read_b64_tr_b16 a[32:33], v46 offset:16384
    ds_read_b64_tr_b16 a[34:35], v46 offset:17408
    v_mfma_f32_16x16x32_bf16 v[196:199], a[4:7], a[180:183], v[196:199]
    buffer_load_dwordx4 v1, s[20:23], s33 offen offset:0 sc1 lds
    v_mfma_f32_16x16x32_bf16 v[196:199], a[0:3], a[164:167], v[196:199]
    ds_read_b64_tr_b16 a[36:37], v46 offset:24576
    v_mfma_f32_16x16x32_bf16 a[64:67], a[0:3], a[168:171], a[64:67]
    buffer_load_dwordx4 v1, s[20:23], s33 offen offset:1024 sc1 lds
    ds_read_b64_tr_b16 a[38:39], v46 offset:25600
    v_mfma_f32_16x16x32_bf16 a[64:67], a[4:7], a[184:187], a[64:67]
    ds_read_b64_tr_b16 a[40:41], v47 offset:16384
    v_mfma_f32_16x16x32_bf16 a[68:71], a[4:7], a[188:191], a[68:71]
    v_mfma_f32_16x16x32_bf16 a[68:71], a[0:3], a[172:175], a[68:71]
    buffer_load_dwordx4 v1, s[20:23], s33 offen offset:2048 sc1 lds
    ds_read_b64_tr_b16 a[42:43], v47 offset:17408
    v_mfma_f32_16x16x32_bf16 a[76:79], a[8:11], a[172:175], a[76:79]
    ds_read_b64_tr_b16 a[44:45], v47 offset:24576
    v_mfma_f32_16x16x32_bf16 a[76:79], a[12:15], a[188:191], a[76:79]
    ds_read_b64_tr_b16 a[46:47], v47 offset:25600
    v_mfma_f32_16x16x32_bf16 a[72:75], a[12:15], a[184:187], a[72:75]
    ds_read_b64_tr_b16 a[48:49], v48 offset:16384
    v_mfma_f32_16x16x32_bf16 a[72:75], a[8:11], a[168:171], a[72:75]
    buffer_load_dwordx4 v1, s[20:23], s33 offen offset:3072 sc1 lds
    v_mfma_f32_16x16x32_bf16 v[204:207], a[8:11], a[164:167], v[204:207]
    ds_read_b64_tr_b16 a[50:51], v48 offset:17408
    v_mfma_f32_16x16x32_bf16 v[204:207], a[12:15], a[180:183], v[204:207]
    s_add_u32 s33, s33, 0x80000
    ds_read_b64_tr_b16 a[52:53], v48 offset:24576
    v_mfma_f32_16x16x32_bf16 v[200:203], a[12:15], a[176:179], v[200:203]
    s_add_u32 s35, s35, 0x4000
    ds_read_b64_tr_b16 a[54:55], v48 offset:25600
    s_mov_b32 m0, s34
    v_mfma_f32_16x16x32_bf16 v[200:203], a[8:11], a[160:163], v[200:203]
    buffer_load_dwordx4 v1, s[16:19], s32 offen offset:0 sc1 lds
    v_mfma_f32_16x16x32_bf16 v[208:211], a[16:19], a[160:163], v[208:211]
    ds_read_b64_tr_b16 a[56:57], v49 offset:16384
    v_mfma_f32_16x16x32_bf16 v[208:211], a[20:23], a[176:179], v[208:211]
    buffer_load_dwordx4 v1, s[16:19], s32 offen offset:1024 sc1 lds
    ds_read_b64_tr_b16 a[58:59], v49 offset:17408
    v_mfma_f32_16x16x32_bf16 v[212:215], a[20:23], a[180:183], v[212:215]
    ds_read_b64_tr_b16 a[60:61], v49 offset:24576
    v_mfma_f32_16x16x32_bf16 v[212:215], a[16:19], a[164:167], v[212:215]
    v_mfma_f32_16x16x32_bf16 a[80:83], a[16:19], a[168:171], a[80:83]
    buffer_load_dwordx4 v1, s[16:19], s32 offen offset:2048 sc1 lds
    ds_read_b64_tr_b16 a[62:63], v49 offset:25600
    v_mfma_f32_16x16x32_bf16 a[80:83], a[20:23], a[184:187], a[80:83]
    v_mfma_f32_16x16x32_bf16 a[84:87], a[20:23], a[188:191], a[84:87]
    v_mfma_f32_16x16x32_bf16 a[84:87], a[16:19], a[172:175], a[84:87]
    v_mfma_f32_16x16x32_bf16 a[92:95], a[24:27], a[172:175], a[92:95]
    buffer_load_dwordx4 v1, s[16:19], s32 offen offset:3072 sc1 lds
    v_mfma_f32_16x16x32_bf16 a[92:95], a[28:31], a[188:191], a[92:95]
    v_mfma_f32_16x16x32_bf16 a[88:91], a[28:31], a[184:187], a[88:91]
    s_add_u32 s32, s32, 0x80000
    v_mfma_f32_16x16x32_bf16 a[88:91], a[24:27], a[168:171], a[88:91]
    s_add_u32 s34, s34, 0x4000
    v_mfma_f32_16x16x32_bf16 v[220:223], a[24:27], a[164:167], v[220:223]
    v_mfma_f32_16x16x32_bf16 v[220:223], a[28:31], a[180:183], v[220:223]
    v_mfma_f32_16x16x32_bf16 v[216:219], a[28:31], a[176:179], v[216:219]
    v_mfma_f32_16x16x32_bf16 v[216:219], a[24:27], a[160:163], v[216:219]
    s_waitcnt vmcnt(63) lgkmcnt(0)
    s_barrier
    v_mfma_f32_16x16x32_bf16 v[224:227], a[32:35], a[160:163], v[224:227]
    v_mfma_f32_16x16x32_bf16 v[224:227], a[36:39], a[176:179], v[224:227]
    s_mov_b32 m0, s35
    v_mfma_f32_16x16x32_bf16 v[228:231], a[36:39], a[180:183], v[228:231]
    buffer_load_dwordx4 v1, s[20:23], s33 offen offset:0 sc1 lds
    v_mfma_f32_16x16x32_bf16 v[228:231], a[32:35], a[164:167], v[228:231]
    v_mfma_f32_16x16x32_bf16 a[96:99], a[32:35], a[168:171], a[96:99]
    v_mfma_f32_16x16x32_bf16 a[96:99], a[36:39], a[184:187], a[96:99]
    v_mfma_f32_16x16x32_bf16 a[100:103], a[36:39], a[188:191], a[100:103]
    v_mfma_f32_16x16x32_bf16 a[100:103], a[32:35], a[172:175], a[100:103]
    buffer_load_dwordx4 v1, s[20:23], s33 offen offset:1024 sc1 lds
    v_mfma_f32_16x16x32_bf16 a[108:111], a[40:43], a[172:175], a[108:111]
    v_mfma_f32_16x16x32_bf16 a[108:111], a[44:47], a[188:191], a[108:111]
    v_mfma_f32_16x16x32_bf16 a[104:107], a[44:47], a[184:187], a[104:107]
    v_mfma_f32_16x16x32_bf16 a[104:107], a[40:43], a[168:171], a[104:107]
    v_mfma_f32_16x16x32_bf16 v[236:239], a[40:43], a[164:167], v[236:239]
    v_mfma_f32_16x16x32_bf16 v[236:239], a[44:47], a[180:183], v[236:239]
    v_mfma_f32_16x16x32_bf16 v[232:235], a[44:47], a[176:179], v[232:235]
    buffer_load_dwordx4 v1, s[20:23], s33 offen offset:2048 sc1 lds
    v_mfma_f32_16x16x32_bf16 v[232:235], a[40:43], a[160:163], v[232:235]
    v_mfma_f32_16x16x32_bf16 v[240:243], a[48:51], a[160:163], v[240:243]
    v_mfma_f32_16x16x32_bf16 v[240:243], a[52:55], a[176:179], v[240:243]
    v_mfma_f32_16x16x32_bf16 v[244:247], a[52:55], a[180:183], v[244:247]
    v_mfma_f32_16x16x32_bf16 v[244:247], a[48:51], a[164:167], v[244:247]
    v_mfma_f32_16x16x32_bf16 a[112:115], a[48:51], a[168:171], a[112:115]
    buffer_load_dwordx4 v1, s[20:23], s33 offen offset:3072 sc1 lds
    v_mfma_f32_16x16x32_bf16 a[112:115], a[52:55], a[184:187], a[112:115]
    v_mfma_f32_16x16x32_bf16 a[116:119], a[52:55], a[188:191], a[116:119]
    v_mfma_f32_16x16x32_bf16 a[116:119], a[48:51], a[172:175], a[116:119]
    v_mfma_f32_16x16x32_bf16 a[124:127], a[56:59], a[172:175], a[124:127]
    v_mfma_f32_16x16x32_bf16 a[124:127], a[60:63], a[188:191], a[124:127]
    v_mfma_f32_16x16x32_bf16 a[120:123], a[60:63], a[184:187], a[120:123]
    s_add_u32 s33, s33, 0x80000
    v_mfma_f32_16x16x32_bf16 a[120:123], a[56:59], a[168:171], a[120:123]
    s_add_u32 s35, s35, 0x4000
    v_mfma_f32_16x16x32_bf16 v[252:255], a[56:59], a[164:167], v[252:255]
    v_mfma_f32_16x16x32_bf16 v[252:255], a[60:63], a[180:183], v[252:255]
    v_mfma_f32_16x16x32_bf16 v[248:251], a[60:63], a[176:179], v[248:251]
    v_mfma_f32_16x16x32_bf16 v[248:251], a[56:59], a[160:163], v[248:251]
    s_add_u32 s3, s54, 64
    s_add_u32 s5, s55, 64
    s_mov_b32 s63, s57
    s_load_dwordx2 s[44:45], s[0:1], 40
    s_load_dwordx2 s[46:47], s[0:1], 64
    s_load_dwordx4 s[48:51], s[0:1], 72
    s_mov_b32 s40, 0x3e0293ee
    s_mov_b32 s41, 0x3e0293ee
    s_mov_b32 m0, s34
    s_nop 0
    buffer_load_dwordx4 v1, s[16:19], s32 offen offset:0 sc1 lds
    buffer_load_dwordx4 v1, s[16:19], s32 offen offset:1024 sc1 lds
    buffer_load_dwordx4 v1, s[16:19], s32 offen offset:2048 sc1 lds
    buffer_load_dwordx4 v1, s[16:19], s32 offen offset:3072 sc1 lds
    s_mov_b32 m0, s35
    s_nop 0
    buffer_load_dwordx4 v1, s[20:23], s33 offen offset:0 sc1 lds
    buffer_load_dwordx4 v1, s[20:23], s33 offen offset:1024 sc1 lds
    buffer_load_dwordx4 v1, s[20:23], s33 offen offset:2048 sc1 lds
    buffer_load_dwordx4 v1, s[20:23], s33 offen offset:3072 sc1 lds
    s_add_u32 s32, s32, 0x80000
    s_add_u32 s33, s33, 0x80000
    s_add_u32 s34, s34, 0x4000
    s_and_b32 s34, s34, 0xffff
    s_add_u32 s35, s35, 0x4000
    s_and_b32 s35, s35, 0xffff
    s_or_b32 s35, s35, 0x10000
    v_mov_b32 v2, v1
    v_or_b32 v3, 0x10000, v1
    v_mov_b32 v56, v3
    s_mov_b32 s52, 0x4000
    s_mov_b32 s53, 0
    s_lshl_b32 s62, s28, 6
    s_mul_i32 s31, s29, s29
    s_add_u32 s62, s62, s31
    s_lshr_b32 s31, s30, 1
    s_lshl_b32 s4, s31, 23
    s_add_u32 s4, s4, 0x6000000
    s_add_u32 s8, s6, s4
    s_addc_u32 s9, s7, 0
    s_and_b32 s9, s9, 0xffff
    s_mov_b32 s10, 0
    s_mov_b32 s58, 0
    s_mov_b32 s14, 0x700000
    s_mov_b32 s59, 0x700000
    s_lshl_b32 s54, s62, 12
    s_waitcnt vmcnt(16) lgkmcnt(0)
    s_barrier
    s_cmp_eq_u32 s63, 0
    s_cbranch_scc1 k12_ool_74
k12_oolret_75:
    v_mov_b32 v59, 0
    ds_read_b128 a[128:131], v2 offset:0
    ds_read_b128 a[132:135], v2 offset:1024
    ds_read_b128 a[136:139], v2 offset:2048
    ds_read_b128 a[140:143], v2 offset:3072
    ds_read_b128 a[144:147], v2 offset:4096
    ds_read_b128 a[148:151], v2 offset:5120
    ds_read_b128 a[152:155], v2 offset:6144
    ds_read_b128 a[156:159], v2 offset:7168
    ds_read_b128 a[160:163], v2 offset:8192
    ds_read_b128 a[164:167], v2 offset:9216
    ds_read_b128 a[168:171], v2 offset:10240
    ds_read_b128 a[172:175], v2 offset:11264
    ds_read_b128 a[176:179], v2 offset:12288
    ds_read_b128 a[180:183], v2 offset:13312
    ds_read_b128 a[184:187], v2 offset:14336
    ds_read_b128 a[188:191], v2 offset:15360
    s_cmp_lt_u32 s30, 2
    s_cselect_b64 s[12:13], s[46:47], s[48:49]
    s_cselect_b64 s[60:61], s[44:45], s[50:51]
    s_cselect_b32 s55, 0x800000, s14
    s_and_b32 s13, s13, 0xffff
    v_accvgpr_read_b32 v128, a64
    v_accvgpr_read_b32 v129, a65
    v_accvgpr_read_b32 v130, a66
    v_accvgpr_read_b32 v131, a67
    v_pk_mul_f32 v[128:129], v[128:129], s[40:41]
    v_pk_mul_f32 v[130:131], v[130:131], s[40:41]
    v_cvt_pk_bf16_f32 v96, v128, v129
    v_cvt_pk_bf16_f32 v97, v130, v131
    v_accvgpr_read_b32 v132, a72
    v_accvgpr_read_b32 v133, a73
    v_accvgpr_read_b32 v134, a74
    v_accvgpr_read_b32 v135, a75
    v_pk_mul_f32 v[132:133], v[132:133], s[40:41]
    v_pk_mul_f32 v[134:135], v[134:135], s[40:41]
    v_cvt_pk_bf16_f32 v98, v132, v133
    v_cvt_pk_bf16_f32 v99, v134, v135
    v_accvgpr_read_b32 v136, a80
    v_accvgpr_read_b32 v137, a81
    v_accvgpr_read_b32 v138, a82
    v_accvgpr_read_b32 v139, a83
    v_pk_mul_f32 v[136:137], v[136:137], s[40:41]
    v_pk_mul_f32 v[138:139], v[138:139], s[40:41]
    v_cvt_pk_bf16_f32 v100, v136, v137
    v_cvt_pk_bf16_f32 v101, v138, v139
    v_accvgpr_read_b32 v140, a88
    v_accvgpr_read_b32 v141, a89
    v_accvgpr_read_b32 v142, a90
    v_accvgpr_read_b32 v143, a91
    v_pk_mul_f32 v[140:141], v[140:141], s[40:41]
    v_pk_mul_f32 v[142:143], v[142:143], s[40:41]
    v_cvt_pk_bf16_f32 v102, v140, v141
    v_cvt_pk_bf16_f32 v103, v142, v143
    v_accvgpr_read_b32 v128, a96
    v_accvgpr_read_b32 v129, a97
    v_accvgpr_read_b32 v130, a98
    v_accvgpr_read_b32 v131, a99
    v_pk_mul_f32 v[128:129], v[128:129], s[40:41]
    v_pk_mul_f32 v[130:131], v[130:131], s[40:41]
    v_cvt_pk_bf16_f32 v104, v128, v129
    v_cvt_pk_bf16_f32 v105, v130, v131
    v_accvgpr_read_b32 v132, a104
    v_accvgpr_read_b32 v133, a105
    v_accvgpr_read_b32 v134, a106
    v_accvgpr_read_b32 v135, a107
    v_pk_mul_f32 v[132:133], v[132:133], s[40:41]
    v_pk_mul_f32 v[134:135], v[134:135], s[40:41]
    v_cvt_pk_bf16_f32 v106, v132, v133
    v_cvt_pk_bf16_f32 v107, v134, v135
    v_accvgpr_read_b32 v136, a112
    v_accvgpr_read_b32 v137, a113
    v_accvgpr_read_b32 v138, a114
    v_accvgpr_read_b32 v139, a115
    v_pk_mul_f32 v[136:137], v[136:137], s[40:41]
    v_pk_mul_f32 v[138:139], v[138:139], s[40:41]
    v_cvt_pk_bf16_f32 v108, v136, v137
    v_cvt_pk_bf16_f32 v109, v138, v139
    v_accvgpr_read_b32 v140, a120
    v_accvgpr_read_b32 v141, a121
    v_accvgpr_read_b32 v142, a122
    v_accvgpr_read_b32 v143, a123
    v_pk_mul_f32 v[140:141], v[140:141], s[40:41]
    v_pk_mul_f32 v[142:143], v[142:143], s[40:41]
    v_cvt_pk_bf16_f32 v110, v140, v141
    v_cvt_pk_bf16_f32 v111, v142, v143
    v_accvgpr_read_b32 v128, a68
    v_accvgpr_read_b32 v129, a69
    v_accvgpr_read_b32 v130, a70
    v_accvgpr_read_b32 v131, a71
    v_pk_mul_f32 v[128:129], v[128:129], s[40:41]
    v_pk_mul_f32 v[130:131], v[130:131], s[40:41]
    v_cvt_pk_bf16_f32 v112, v128, v129
    v_cvt_pk_bf16_f32 v113, v130, v131
    v_accvgpr_read_b32 v132, a76
    v_accvgpr_read_b32 v133, a77
    v_accvgpr_read_b32 v134, a78
    v_accvgpr_read_b32 v135, a79
    v_pk_mul_f32 v[132:133], v[132:133], s[40:41]
    v_pk_mul_f32 v[134:135], v[134:135], s[40:41]
    v_cvt_pk_bf16_f32 v114, v132, v133
    v_cvt_pk_bf16_f32 v115, v134, v135
    v_accvgpr_read_b32 v136, a84
    v_accvgpr_read_b32 v137, a85
    v_accvgpr_read_b32 v138, a86
    v_accvgpr_read_b32 v139, a87
    v_pk_mul_f32 v[136:137], v[136:137], s[40:41]
    v_pk_mul_f32 v[138:139], v[138:139], s[40:41]
    v_cvt_pk_bf16_f32 v116, v136, v137
    v_cvt_pk_bf16_f32 v117, v138, v139
    v_accvgpr_read_b32 v140, a92
    v_accvgpr_read_b32 v141, a93
    v_accvgpr_read_b32 v142, a94
    v_accvgpr_read_b32 v143, a95
    v_pk_mul_f32 v[140:141], v[140:141], s[40:41]
    v_pk_mul_f32 v[142:143], v[142:143], s[40:41]
    v_cvt_pk_bf16_f32 v118, v140, v141
    v_cvt_pk_bf16_f32 v119, v142, v143
    v_accvgpr_read_b32 v128, a100
    v_accvgpr_read_b32 v129, a101
    v_accvgpr_read_b32 v130, a102
    v_accvgpr_read_b32 v131, a103
    v_pk_mul_f32 v[128:129], v[128:129], s[40:41]
    v_pk_mul_f32 v[130:131], v[130:131], s[40:41]
    v_cvt_pk_bf16_f32 v120, v128, v129
    v_cvt_pk_bf16_f32 v121, v130, v131
    v_accvgpr_read_b32 v132, a108
    v_accvgpr_read_b32 v133, a109
    v_accvgpr_read_b32 v134, a110
    v_accvgpr_read_b32 v135, a111
    v_pk_mul_f32 v[132:133], v[132:133], s[40:41]
    v_pk_mul_f32 v[134:135], v[134:135], s[40:41]
    v_cvt_pk_bf16_f32 v122, v132, v133
    v_cvt_pk_bf16_f32 v123, v134, v135
    v_accvgpr_read_b32 v136, a116
    v_accvgpr_read_b32 v137, a117
    v_accvgpr_read_b32 v138, a118
    v_accvgpr_read_b32 v139, a119
    v_pk_mul_f32 v[136:137], v[136:137], s[40:41]
    v_pk_mul_f32 v[138:139], v[138:139], s[40:41]
    v_cvt_pk_bf16_f32 v124, v136, v137
    v_cvt_pk_bf16_f32 v125, v138, v139
    v_accvgpr_read_b32 v140, a124
    v_accvgpr_read_b32 v141, a125
    v_accvgpr_read_b32 v142, a126
    v_accvgpr_read_b32 v143, a127
    v_pk_mul_f32 v[140:141], v[140:141], s[40:41]
    v_pk_mul_f32 v[142:143], v[142:143], s[40:41]
    v_cvt_pk_bf16_f32 v126, v140, v141
    v_cvt_pk_bf16_f32 v127, v142, v143
    v_pk_mul_f32 v[192:193], v[192:193], s[40:41]
    v_pk_mul_f32 v[194:195], v[194:195], s[40:41]
    v_cvt_pk_bf16_f32 v64, v192, v193
    v_cvt_pk_bf16_f32 v65, v194, v195
    v_pk_mul_f32 v[200:201], v[200:201], s[40:41]
    v_pk_mul_f32 v[202:203], v[202:203], s[40:41]
    v_cvt_pk_bf16_f32 v66, v200, v201
    v_cvt_pk_bf16_f32 v67, v202, v203
    v_pk_mul_f32 v[208:209], v[208:209], s[40:41]
    v_pk_mul_f32 v[210:211], v[210:211], s[40:41]
    v_cvt_pk_bf16_f32 v68, v208, v209
    v_cvt_pk_bf16_f32 v69, v210, v211
    v_pk_mul_f32 v[216:217], v[216:217], s[40:41]
    v_pk_mul_f32 v[218:219], v[218:219], s[40:41]
    v_cvt_pk_bf16_f32 v70, v216, v217
    v_cvt_pk_bf16_f32 v71, v218, v219
    v_pk_mul_f32 v[224:225], v[224:225], s[40:41]
    v_pk_mul_f32 v[226:227], v[226:227], s[40:41]
    v_cvt_pk_bf16_f32 v72, v224, v225
    v_cvt_pk_bf16_f32 v73, v226, v227
    v_pk_mul_f32 v[232:233], v[232:233], s[40:41]
    v_pk_mul_f32 v[234:235], v[234:235], s[40:41]
    v_cvt_pk_bf16_f32 v74, v232, v233
    v_cvt_pk_bf16_f32 v75, v234, v235
    v_pk_mul_f32 v[240:241], v[240:241], s[40:41]
    v_pk_mul_f32 v[242:243], v[242:243], s[40:41]
    v_cvt_pk_bf16_f32 v76, v240, v241
    v_cvt_pk_bf16_f32 v77, v242, v243
    v_pk_mul_f32 v[248:249], v[248:249], s[40:41]
    v_pk_mul_f32 v[250:251], v[250:251], s[40:41]
    v_cvt_pk_bf16_f32 v78, v248, v249
    v_cvt_pk_bf16_f32 v79, v250, v251
    v_pk_mul_f32 v[196:197], v[196:197], s[40:41]
    v_pk_mul_f32 v[198:199], v[198:199], s[40:41]
    v_cvt_pk_bf16_f32 v80, v196, v197
    v_cvt_pk_bf16_f32 v81, v198, v199
    v_pk_mul_f32 v[204:205], v[204:205], s[40:41]
    v_pk_mul_f32 v[206:207], v[206:207], s[40:41]
    v_cvt_pk_bf16_f32 v82, v204, v205
    v_cvt_pk_bf16_f32 v83, v206, v207
    v_pk_mul_f32 v[212:213], v[212:213], s[40:41]
    v_pk_mul_f32 v[214:215], v[214:215], s[40:41]
    v_cvt_pk_bf16_f32 v84, v212, v213
    v_cvt_pk_bf16_f32 v85, v214, v215
    v_pk_mul_f32 v[220:221], v[220:221], s[40:41]
    v_pk_mul_f32 v[222:223], v[222:223], s[40:41]
    v_cvt_pk_bf16_f32 v86, v220, v221
    v_cvt_pk_bf16_f32 v87, v222, v223
    v_pk_mul_f32 v[228:229], v[228:229], s[40:41]
    v_pk_mul_f32 v[230:231], v[230:231], s[40:41]
    v_cvt_pk_bf16_f32 v88, v228, v229
    v_cvt_pk_bf16_f32 v89, v230, v231
    v_pk_mul_f32 v[236:237], v[236:237], s[40:41]
    v_pk_mul_f32 v[238:239], v[238:239], s[40:41]
    v_cvt_pk_bf16_f32 v90, v236, v237
    v_cvt_pk_bf16_f32 v91, v238, v239
    v_pk_mul_f32 v[244:245], v[244:245], s[40:41]
    v_pk_mul_f32 v[246:247], v[246:247], s[40:41]
    v_cvt_pk_bf16_f32 v92, v244, v245
    v_cvt_pk_bf16_f32 v93, v246, v247
    v_pk_mul_f32 v[252:253], v[252:253], s[40:41]
    v_pk_mul_f32 v[254:255], v[254:255], s[40:41]
    v_cvt_pk_bf16_f32 v94, v252, v253
    v_cvt_pk_bf16_f32 v95, v254, v255
    v_add_u32 v2, 0x4000, v1
    v_mov_b32 v8, 0
    v_mov_b32 v232, 0
    v_mov_b32 v9, 0
    v_mov_b32 v233, 0
    v_mov_b32 v10, 0
    v_mov_b32 v234, 0
    v_mov_b32 v11, 0
    v_mov_b32 v235, 0
    s_mov_b32 s36, 0
    s_mov_b32 s37, 0x40004000
    v_mfma_f32_32x32x16_bf16 v[16:31], v[232:235], v[232:235], 0
    v_mfma_f32_32x32x16_bf16 v[32:47], v[232:235], v[232:235], 0
    v_and_b32 v6, 0xf0, v1
    v_cmp_eq_u32 vcc, 0, v6
    v_mov_b32 v6, 0x3f803f80
    v_lshrrev_b32 v229, 7, v1
    s_and_b32 s4, s30, 1
    s_lshl_b32 s31, s4, 11
    v_lshl_add_u32 v230, v1, 1, s31
    v_lshl_add_u32 v229, s4, 4, v229
    v_mul_u32_u24 v228, 7168, v229
    v_and_b32 v7, 0x70, v1
    v_add_u32 v228, v228, v7
    v_lshlrev_b32 v229, 5, v229
    v_and_b32 v57, 0x10, v1
    v_add_u32 v229, v229, v57
    v_lshrrev_b32 v7, 5, v7
    v_lshl_add_u32 v229, v7, 15, v229
    v_cndmask_b32 v60, 0, v6, vcc
    v_cndmask_b32 v61, 0, v6, vcc
    v_cndmask_b32 v62, 0, v6, vcc
    v_cndmask_b32 v63, 0, v6, vcc
    v_mov_b32 v12, 0
    v_mov_b32 v13, 0
    v_mov_b32 v14, 0
    v_mov_b32 v15, 0
    v_mov_b32 v48, 0
    v_mov_b32 v49, 0
    v_mov_b32 v50, 0
    v_mov_b32 v51, 0
    v_mov_b32 v248, 0
    v_mov_b32 v249, 0
    v_mov_b32 v250, 0
    v_mov_b32 v251, 0
    v_mov_b32 v252, 0
    v_mov_b32 v253, 0
    v_mov_b32 v254, 0
    v_mov_b32 v255, 0
    s_waitcnt lgkmcnt(0)
    s_cmp_ge_u32 s36, s42
    s_cbranch_scc1 k2_prep_76
k2_prepret_77:
    v_mfma_f32_16x16x32_bf16 v[128:131], a[128:131], v[64:67], v[16:19]
    v_mfma_f32_16x16x32_bf16 v[128:131], a[132:135], v[68:71], v[128:131]
    v_mfma_f32_16x16x32_bf16 v[128:131], a[136:139], v[72:75], v[128:131]
    v_mfma_f32_16x16x32_bf16 v[128:131], a[140:143], v[76:79], v[128:131]
    s_add_u32 s36, s36, 32
    v_mfma_f32_16x16x32_bf16 v[132:135], a[140:143], v[92:95], v[20:23]
    v_mfma_f32_16x16x32_bf16 v[132:135], a[136:139], v[88:91], v[132:135]
    v_mfma_f32_16x16x32_bf16 v[132:135], a[132:135], v[84:87], v[132:135]
    v_mfma_f32_16x16x32_bf16 v[132:135], a[128:131], v[80:83], v[132:135]
    v_mfma_f32_16x16x32_bf16 v[136:139], a[128:131], v[96:99], v[24:27]
    v_mfma_f32_16x16x32_bf16 v[136:139], a[132:135], v[100:103], v[136:139]
    v_mfma_f32_16x16x32_bf16 v[136:139], a[136:139], v[104:107], v[136:139]
    v_mfma_f32_16x16x32_bf16 v[136:139], a[140:143], v[108:111], v[136:139]
    v_mfma_f32_16x16x32_bf16 v[140:143], a[140:143], v[124:127], v[28:31]
    v_mfma_f32_16x16x32_bf16 v[140:143], a[136:139], v[120:123], v[140:143]
    v_mfma_f32_16x16x32_bf16 v[140:143], a[132:135], v[116:119], v[140:143]
    v_mfma_f32_16x16x32_bf16 v[140:143], a[128:131], v[112:115], v[140:143]
    v_mfma_f32_16x16x32_bf16 v[156:159], a[144:147], v[112:115], v[44:47]
    v_mfma_f32_16x16x32_bf16 v[156:159], a[148:151], v[116:119], v[156:159]
    v_mfma_f32_16x16x32_bf16 v[156:159], a[152:155], v[120:123], v[156:159]
    v_mfma_f32_16x16x32_bf16 v[156:159], a[156:159], v[124:127], v[156:159]
    v_mfma_f32_16x16x32_bf16 v[152:155], a[156:159], v[108:111], v[40:43]
    v_mfma_f32_16x16x32_bf16 v[152:155], a[152:155], v[104:107], v[152:155]
    v_mfma_f32_16x16x32_bf16 v[152:155], a[148:151], v[100:103], v[152:155]
    v_mfma_f32_16x16x32_bf16 v[152:155], a[144:147], v[96:99], v[152:155]
    v_mfma_f32_16x16x32_bf16 v[148:151], a[144:147], v[80:83], v[36:39]
    v_mfma_f32_16x16x32_bf16 v[148:151], a[148:151], v[84:87], v[148:151]
    v_mfma_f32_16x16x32_bf16 v[148:151], a[152:155], v[88:91], v[148:151]
    v_mfma_f32_16x16x32_bf16 v[148:151], a[156:159], v[92:95], v[148:151]
    v_mfma_f32_16x16x32_bf16 v[144:147], a[156:159], v[76:79], v[32:35]
    v_mfma_f32_16x16x32_bf16 v[144:147], a[152:155], v[72:75], v[144:147]
    v_mfma_f32_16x16x32_bf16 v[144:147], a[148:151], v[68:71], v[144:147]
    v_mfma_f32_16x16x32_bf16 v[144:147], a[144:147], v[64:67], v[144:147]
    v_mfma_f32_32x32x16_bf16 a[0:15], v[232:235], v[232:235], 0
    v_mfma_f32_32x32x16_bf16 a[16:31], v[232:235], v[232:235], 0
    v_mfma_f32_32x32x16_bf16 a[32:47], v[232:235], v[232:235], 0
    v_mfma_f32_32x32x16_bf16 a[48:63], v[232:235], v[232:235], 0
    v_mfma_f32_32x32x16_bf16 a[64:79], v[232:235], v[232:235], 0
    v_mfma_f32_32x32x16_bf16 a[80:95], v[232:235], v[232:235], 0
    v_mfma_f32_32x32x16_bf16 a[96:111], v[232:235], v[232:235], 0
    v_mfma_f32_32x32x16_bf16 a[112:127], v[232:235], v[232:235], 0
    v_max_f32 v52, v128, v129
    v_max3_f32 v52, v52, v130, v131
    v_max3_f32 v52, v52, v144, v145
    v_max3_f32 v52, v52, v146, v147
    v_max_f32 v53, v132, v133
    v_max3_f32 v53, v53, v134, v135
    v_max3_f32 v53, v53, v148, v149
    v_max3_f32 v53, v53, v150, v151
    v_max_f32 v54, v136, v137
    v_max3_f32 v54, v54, v138, v139
    v_max3_f32 v54, v54, v152, v153
    v_max3_f32 v54, v54, v154, v155
    v_max_f32 v55, v140, v141
    v_max3_f32 v55, v55, v142, v143
    v_max3_f32 v55, v55, v156, v157
    v_max3_f32 v55, v55, v158, v159
    v_mov_b32 v224, v52
    v_mov_b32 v225, v53
    v_mov_b32 v226, v54
    v_mov_b32 v227, v55
    s_nop 1
    v_permlane16_swap_b32 v52, v224
    v_permlane16_swap_b32 v53, v225
    v_permlane16_swap_b32 v54, v226
    v_permlane16_swap_b32 v55, v227
    s_nop 1
    v_max_f32 v52, v52, v224
    v_max_f32 v53, v53, v225
    v_max_f32 v54, v54, v226
    v_max_f32 v55, v55, v227
    v_mov_b32 v224, v52
    v_mov_b32 v225, v53
    v_mov_b32 v226, v54
    v_mov_b32 v227, v55
    s_nop 1
    v_permlane32_swap_b32 v52, v224
    v_permlane32_swap_b32 v53, v225
    v_permlane32_swap_b32 v54, v226
    v_permlane32_swap_b32 v55, v227
    s_nop 1
    v_max_f32 v52, v52, v224
    v_max_f32 v53, v53, v225
    v_max_f32 v54, v54, v226
    v_max_f32 v55, v55, v227
    v_add_f32 v52, 0x41400000, v52
    v_add_f32 v53, 0x41400000, v53
    v_add_f32 v54, 0x41400000, v54
    v_add_f32 v55, 0x41400000, v55
    v_sub_f32 v16, 0, v52
    v_sub_f32 v17, 0, v52
    v_sub_f32 v18, 0, v52
    v_sub_f32 v19, 0, v52
    v_sub_f32 v20, 0, v53
    v_sub_f32 v21, 0, v53
    v_sub_f32 v22, 0, v53
    v_sub_f32 v23, 0, v53
    v_sub_f32 v24, 0, v54
    v_sub_f32 v25, 0, v54
    v_sub_f32 v26, 0, v54
    v_sub_f32 v27, 0, v54
    v_sub_f32 v28, 0, v55
    v_sub_f32 v29, 0, v55
    v_sub_f32 v30, 0, v55
    v_sub_f32 v31, 0, v55
    v_sub_f32 v32, 0, v52
    v_sub_f32 v33, 0, v52
    v_sub_f32 v34, 0, v52
    v_sub_f32 v35, 0, v52
    v_sub_f32 v36, 0, v53
    v_sub_f32 v37, 0, v53
    v_sub_f32 v38, 0, v53
    v_sub_f32 v39, 0, v53
    v_sub_f32 v40, 0, v54
    v_sub_f32 v41, 0, v54
    v_sub_f32 v42, 0, v54
    v_sub_f32 v43, 0, v54
    v_sub_f32 v44, 0, v55
    v_sub_f32 v45, 0, v55
    v_sub_f32 v46, 0, v55
    v_sub_f32 v47, 0, v55
    v_sub_f32 v8, 0, v52
    v_sub_f32 v9, 0, v53
    v_sub_f32 v10, 0, v54
    v_sub_f32 v11, 0, v55
    s_cmp_ge_u32 s36, s42
    s_cbranch_scc1 k2_prep_84
k2_prepret_85:
    v_mfma_f32_16x16x32_bf16 v[160:163], a[160:163], v[64:67], v[16:19]
    v_sub_f32 v128, v128, v52
    v_sub_f32 v129, v129, v52
    v_sub_f32 v130, v130, v52
    v_mfma_f32_16x16x32_bf16 v[160:163], a[164:167], v[68:71], v[160:163]
    v_exp_f32 v232, v128
    v_sub_f32 v131, v131, v52
    v_mfma_f32_16x16x32_bf16 v[160:163], a[168:171], v[72:75], v[160:163]
    v_exp_f32 v233, v129
    v_sub_f32 v144, v144, v52
    v_mfma_f32_16x16x32_bf16 v[160:163], a[172:175], v[76:79], v[160:163]
    s_add_u32 s36, s36, 32
    s_cmp_eq_u32 s30, 0
    s_cbranch_scc1 k12_ool_78
k12_oolret_79:
    v_sub_f32 v145, v145, v52
    v_mfma_f32_16x16x32_bf16 v[164:167], a[172:175], v[92:95], v[20:23]
    v_exp_f32 v234, v130
    v_cvt_pk_bf16_f32 v192, v232, v233
    v_mfma_f32_16x16x32_bf16 v[164:167], a[168:171], v[88:91], v[164:167]
    v_exp_f32 v235, v131
    v_sub_f32 v146, v146, v52
    v_mfma_f32_16x16x32_bf16 v[164:167], a[164:167], v[84:87], v[164:167]
    v_exp_f32 v236, v144
    v_sub_f32 v147, v147, v52
    v_mfma_f32_16x16x32_bf16 v[164:167], a[160:163], v[80:83], v[164:167]
    v_cvt_pk_bf16_f32 v193, v234, v235
    v_exp_f32 v237, v145
    v_mfma_f32_16x16x32_bf16 v[168:171], a[160:163], v[96:99], v[24:27]
    v_exp_f32 v238, v146
    v_sub_f32 v132, v132, v53
    v_mfma_f32_16x16x32_bf16 v[168:171], a[164:167], v[100:103], v[168:171]
    v_sub_f32 v133, v133, v53
    v_cvt_pk_bf16_f32 v194, v236, v237
    v_or3_b32 v57, v192, v193, v194
    v_mfma_f32_16x16x32_bf16 v[168:171], a[168:171], v[104:107], v[168:171]
    v_exp_f32 v239, v147
    v_sub_f32 v134, v134, v53
    v_mfma_f32_16x16x32_bf16 v[168:171], a[172:175], v[108:111], v[168:171]
    v_exp_f32 v240, v132
    v_sub_f32 v135, v135, v53
    v_mfma_f32_16x16x32_bf16 v[172:175], a[172:175], v[124:127], v[28:31]
    v_cvt_pk_bf16_f32 v195, v238, v239
    v_exp_f32 v241, v133
    v_mfma_f32_16x16x32_bf16 v[172:175], a[168:171], v[120:123], v[172:175]
    v_exp_f32 v242, v134
    v_sub_f32 v148, v148, v53
    v_mfma_f32_16x16x32_bf16 v[172:175], a[164:167], v[116:119], v[172:175]
    v_sub_f32 v149, v149, v53
    v_cvt_pk_bf16_f32 v196, v240, v241
    v_exp_f32 v243, v135
    v_mfma_f32_16x16x32_bf16 v[172:175], a[160:163], v[112:115], v[172:175]
    v_or3_b32 v57, v57, v195, v196
    v_exp_f32 v244, v148
    v_mfma_f32_16x16x32_bf16 v[188:191], a[176:179], v[112:115], v[44:47]
    v_sub_f32 v150, v150, v53
    v_sub_f32 v151, v151, v53
    v_cvt_pk_bf16_f32 v197, v242, v243
    v_mfma_f32_16x16x32_bf16 v[188:191], a[180:183], v[116:119], v[188:191]
    v_exp_f32 v245, v149
    v_exp_f32 v246, v150
    v_mfma_f32_16x16x32_bf16 v[188:191], a[184:187], v[120:123], v[188:191]
    v_sub_f32 v136, v136, v54
    v_sub_f32 v137, v137, v54
    v_cvt_pk_bf16_f32 v198, v244, v245
    v_mfma_f32_16x16x32_bf16 v[188:191], a[188:191], v[124:127], v[188:191]
    v_exp_f32 v247, v151
    v_or3_b32 v57, v57, v197, v198
    v_mfma_f32_16x16x32_bf16 v[184:187], a[188:191], v[108:111], v[40:43]
    v_exp_f32 v232, v136
    v_sub_f32 v138, v138, v54
    v_mfma_f32_16x16x32_bf16 v[184:187], a[184:187], v[104:107], v[184:187]
    ds_read_b128 a[192:195], v3 offset:0
    v_sub_f32 v139, v139, v54
    v_cvt_pk_bf16_f32 v199, v246, v247
    v_mfma_f32_16x16x32_bf16 v[184:187], a[180:183], v[100:103], v[184:187]
    v_exp_f32 v233, v137
    v_exp_f32 v234, v138
    v_mfma_f32_16x16x32_bf16 v[184:187], a[176:179], v[96:99], v[184:187]
    v_sub_f32 v152, v152, v54
    v_sub_f32 v153, v153, v54
    v_cvt_pk_bf16_f32 v200, v232, v233
    v_mfma_f32_16x16x32_bf16 v[180:183], a[176:179], v[80:83], v[36:39]
    v_exp_f32 v235, v139
    v_or3_b32 v57, v57, v199, v200
    v_mfma_f32_16x16x32_bf16 v[180:183], a[180:183], v[84:87], v[180:183]
    v_exp_f32 v236, v152
    v_sub_f32 v154, v154, v54
    v_mfma_f32_16x16x32_bf16 v[180:183], a[184:187], v[88:91], v[180:183]
    v_sub_f32 v155, v155, v54
    v_cvt_pk_bf16_f32 v201, v234, v235
    v_exp_f32 v237, v153
    v_mfma_f32_16x16x32_bf16 v[180:183], a[188:191], v[92:95], v[180:183]
    ds_read_b128 a[196:199], v3 offset:1024
    v_exp_f32 v238, v154
    v_mfma_f32_16x16x32_bf16 v[176:179], a[188:191], v[76:79], v[32:35]
    v_sub_f32 v140, v140, v55
    v_sub_f32 v141, v141, v55
    v_cvt_pk_bf16_f32 v202, v236, v237
    v_mfma_f32_16x16x32_bf16 v[176:179], a[184:187], v[72:75], v[176:179]
    v_exp_f32 v239, v155
    v_or3_b32 v57, v57, v201, v202
    v_mfma_f32_16x16x32_bf16 v[176:179], a[180:183], v[68:71], v[176:179]
    s_cmp_eq_u32 s30, 0
    s_cbranch_scc1 k12_ool_82
k12_oolret_83:
    v_exp_f32 v240, v140
    v_mfma_f32_16x16x32_bf16 v[176:179], a[176:179], v[64:67], v[176:179]
    s_waitcnt vmcnt(8)
    s_barrier
    v_sub_f32 v142, v142, v55
    v_sub_f32 v143, v143, v55
    v_cvt_pk_bf16_f32 v203, v238, v239
    v_exp_f32 v241, v141
    v_exp_f32 v242, v142
    v_sub_f32 v156, v156, v55
    v_sub_f32 v157, v157, v55
    ds_read_b128 a[200:203], v3 offset:2048
    v_cvt_pk_bf16_f32 v204, v240, v241
    v_exp_f32 v243, v143
    v_or3_b32 v57, v57, v203, v204
    v_exp_f32 v244, v156
    v_sub_f32 v158, v158, v55
    v_sub_f32 v159, v159, v55
    v_cvt_pk_bf16_f32 v205, v242, v243
    v_exp_f32 v245, v157
    v_exp_f32 v246, v158
    v_cvt_pk_bf16_f32 v206, v244, v245
    ds_read_b128 a[204:207], v3 offset:3072
    v_exp_f32 v247, v159
    v_or3_b32 v57, v57, v205, v206
    v_cvt_pk_bf16_f32 v207, v246, v247
    v_bitop3_b32 v57, v57, v207, s37 bitop3:0xa8
    v_cmp_ne_u32 vcc, 0, v57
    s_cbranch_vccnz k2_tramp_86
k2_ret_87:
    s_mov_b32 s24, s60
    s_and_b32 s25, s61, 0xffff
    s_mov_b32 s26, s55
    s_lshl_b32 s63, s29, 1
    s_sub_u32 s63, s63, 1
    s_cbranch_scc1 k2_dm3_89
k2_dloop_88:
    v_mfma_f32_16x16x32_bf16 v[12:15], v[60:63], v[192:195], v[12:15]
    v_exp_f32 v232, v160
    v_mfma_f32_16x16x32_bf16 v[48:51], v[60:63], v[196:199], v[48:51]
    s_mov_b32 m0, s34
    ds_read_b128 a[208:211], v3 offset:4096
    v_mfma_f32_16x16x32_bf16 v[248:251], v[60:63], v[200:203], v[248:251]
    s_add_u32 s53, s53, 8192
    buffer_load_dwordx4 v1, s[16:19], s32 offen offset:0 sc1 lds
    v_mfma_f32_16x16x32_bf16 v[252:255], v[60:63], v[204:207], v[252:255]
    s_waitcnt lgkmcnt(3)
    v_exp_f32 v233, v161
    v_mfma_f32_16x16x32_bf16 a[12:15], a[192:195], v[204:207], a[12:15]
    s_and_b32 s53, s53, 0xffff
    v_exp_f32 v234, v162
    v_mfma_f32_16x16x32_bf16 a[8:11], a[192:195], v[200:203], a[8:11]
    s_add_u32 s34, s34, 0x4000
    ds_read_b128 a[212:215], v3 offset:5120
    v_cvt_pk_bf16_f32 v208, v232, v233
    v_mfma_f32_16x16x32_bf16 a[4:7], a[192:195], v[196:199], a[4:7]
    v_exp_f32 v235, v163
    v_mfma_f32_16x16x32_bf16 a[0:3], a[192:195], v[192:195], a[0:3]
    buffer_load_dwordx4 v1, s[16:19], s32 offen offset:1024 sc1 lds
    v_mfma_f32_16x16x32_bf16 a[16:19], a[196:199], v[192:195], a[16:19]
    v_exp_f32 v236, v176
    v_mfma_f32_16x16x32_bf16 a[20:23], a[196:199], v[196:199], a[20:23]
    ds_read_b128 a[216:219], v3 offset:6144
    v_cvt_pk_bf16_f32 v209, v234, v235
    v_mfma_f32_16x16x32_bf16 a[24:27], a[196:199], v[200:203], a[24:27]
    v_exp_f32 v237, v177
    v_mfma_f32_16x16x32_bf16 a[28:31], a[196:199], v[204:207], a[28:31]
    s_waitcnt lgkmcnt(3)
    v_exp_f32 v238, v178
    v_mfma_f32_16x16x32_bf16 a[44:47], a[200:203], v[204:207], a[44:47]
    s_and_b32 s34, s34, 0xffff
    ds_read_b128 a[220:223], v3 offset:7168
    v_cvt_pk_bf16_f32 v210, v236, v237
    v_mfma_f32_16x16x32_bf16 a[40:43], a[200:203], v[200:203], a[40:43]
    s_and_b32 s60, s62, 31
    buffer_load_dwordx4 v1, s[16:19], s32 offen offset:2048 sc1 lds
    v_mfma_f32_16x16x32_bf16 a[36:39], a[200:203], v[196:199], a[36:39]
    v_exp_f32 v239, v179
    v_mfma_f32_16x16x32_bf16 a[32:35], a[200:203], v[192:195], a[32:35]
    s_lshr_b32 s61, s62, 5
    v_or3_b32 v57, v208, v209, v210
    v_add_u32 v3, s53, v56
    v_mfma_f32_16x16x32_bf16 a[48:51], a[204:207], v[192:195], a[48:51]
    v_exp_f32 v240, v164
    v_mfma_f32_16x16x32_bf16 a[52:55], a[204:207], v[196:199], a[52:55]
    ds_read_b128 a[128:131], v2 offset:0
    v_cvt_pk_bf16_f32 v211, v238, v239
    v_mfma_f32_16x16x32_bf16 a[56:59], a[204:207], v[200:203], a[56:59]
    s_mul_i32 s57, s60, 229376
    v_exp_f32 v241, v165
    v_mfma_f32_16x16x32_bf16 a[60:63], a[204:207], v[204:207], a[60:63]
    s_waitcnt lgkmcnt(3)
    buffer_load_dwordx4 v1, s[16:19], s32 offen offset:3072 sc1 lds
    v_mfma_f32_16x16x32_bf16 a[76:79], a[208:211], v[204:207], a[76:79]
    s_add_u32 s32, s32, 0x80000
    v_exp_f32 v242, v166
    v_mfma_f32_16x16x32_bf16 a[72:75], a[208:211], v[200:203], a[72:75]
    s_lshl_b32 s4, s61, 7
    ds_read_b128 a[132:135], v2 offset:1024
    v_cvt_pk_bf16_f32 v212, v240, v241
    v_mfma_f32_16x16x32_bf16 a[68:71], a[208:211], v[196:199], a[68:71]
    v_exp_f32 v243, v167
    v_mfma_f32_16x16x32_bf16 a[64:67], a[208:211], v[192:195], a[64:67]
    s_add_u32 s57, s57, s4
    v_or3_b32 v57, v57, v211, v212
    v_cvt_pk_bf16_f32 v213, v242, v243
    v_mfma_f32_16x16x32_bf16 a[80:83], a[212:215], v[192:195], a[80:83]
    s_waitcnt vmcnt(9)
    v_exp_f32 v244, v180
    v_mfma_f32_16x16x32_bf16 a[84:87], a[212:215], v[196:199], a[84:87]
    buffer_store_dwordx4 a[224:227], v229, s[8:11], s58 offen offset:0 sc1
    ds_read_b128 a[136:139], v2 offset:2048
    v_mfma_f32_16x16x32_bf16 a[88:91], a[212:215], v[200:203], a[88:91]
    s_add_u32 s56, s57, 57344
    v_exp_f32 v245, v181
    v_mfma_f32_16x16x32_bf16 a[92:95], a[212:215], v[204:207], a[92:95]
    s_waitcnt lgkmcnt(3)
    v_exp_f32 v246, v182
    v_mfma_f32_16x16x32_bf16 a[108:111], a[216:219], v[204:207], a[108:111]
    ds_read_b128 a[140:143], v2 offset:3072
    v_cvt_pk_bf16_f32 v214, v244, v245
    v_mfma_f32_16x16x32_bf16 a[104:107], a[216:219], v[200:203], a[104:107]
    s_add_u32 s62, s62, 1
    v_exp_f32 v247, v183
    v_mfma_f32_16x16x32_bf16 a[100:103], a[216:219], v[196:199], a[100:103]
    v_or3_b32 v57, v57, v213, v214
    v_mfma_f32_16x16x32_bf16 a[96:99], a[216:219], v[192:195], a[96:99]
    v_exp_f32 v232, v168
    v_mfma_f32_16x16x32_bf16 a[112:115], a[220:223], v[192:195], a[112:115]
    ds_read_b128 a[144:147], v2 offset:4096
    v_cvt_pk_bf16_f32 v215, v246, v247
    v_mfma_f32_16x16x32_bf16 a[116:119], a[220:223], v[196:199], a[116:119]
    buffer_store_dwordx4 a[228:231], v229, s[8:11], s58 offen offset:256 sc1
    v_mfma_f32_16x16x32_bf16 a[120:123], a[220:223], v[200:203], a[120:123]
    v_exp_f32 v233, v169
    v_mfma_f32_16x16x32_bf16 a[124:127], a[220:223], v[204:207], a[124:127]
    s_waitcnt lgkmcnt(3)
    v_exp_f32 v234, v170
    v_mfma_f32_16x16x32_bf16 v[128:131], a[128:131], v[64:67], v[16:19]
    ds_read_b128 a[148:151], v2 offset:5120
    v_cvt_pk_bf16_f32 v216, v232, v233
    v_mfma_f32_16x16x32_bf16 v[128:131], a[132:135], v[68:71], v[128:131]
    s_waitcnt lgkmcnt(2)
    v_exp_f32 v235, v171
    v_mfma_f32_16x16x32_bf16 v[128:131], a[136:139], v[72:75], v[128:131]
    v_or3_b32 v57, v57, v215, v216
    v_mfma_f32_16x16x32_bf16 v[128:131], a[140:143], v[76:79], v[128:131]
    s_add_u32 s36, s36, 32
    v_exp_f32 v236, v184
    v_mfma_f32_16x16x32_bf16 v[132:135], a[140:143], v[92:95], v[20:23]
    ds_read_b128 a[152:155], v2 offset:6144
    v_cvt_pk_bf16_f32 v217, v234, v235
    v_mfma_f32_16x16x32_bf16 v[132:135], a[136:139], v[88:91], v[132:135]
    s_lshl_b32 s58, s61, 17
    buffer_load_dwordx4 a[224:227], v228, s[12:15], s57 offen nt
    v_mfma_f32_16x16x32_bf16 v[132:135], a[132:135], v[84:87], v[132:135]
    s_add_u32 s52, s52, 8192
    v_exp_f32 v237, v185
    v_mfma_f32_16x16x32_bf16 v[132:135], a[128:131], v[80:83], v[132:135]
    v_exp_f32 v238, v186
    v_mfma_f32_16x16x32_bf16 v[136:139], a[128:131], v[96:99], v[24:27]
    s_lshl_b32 s60, s60, 10
    ds_read_b128 a[156:159], v2 offset:7168
    v_cvt_pk_bf16_f32 v218, v236, v237
    v_mfma_f32_16x16x32_bf16 v[136:139], a[132:135], v[100:103], v[136:139]
    s_and_b32 s52, s52, 0xffff
    v_exp_f32 v239, v187
    v_mfma_f32_16x16x32_bf16 v[136:139], a[136:139], v[104:107], v[136:139]
    v_or3_b32 v57, v57, v217, v218
    v_mfma_f32_16x16x32_bf16 v[136:139], a[140:143], v[108:111], v[136:139]
    v_add_u32 v2, s52, v1
    v_cvt_pk_bf16_f32 v219, v238, v239
    v_mfma_f32_16x16x32_bf16 v[140:143], a[140:143], v[124:127], v[28:31]
    s_add_u32 s58, s58, s60
    v_exp_f32 v240, v172
    v_mfma_f32_16x16x32_bf16 v[140:143], a[136:139], v[120:123], v[140:143]
    buffer_load_dwordx4 a[228:231], v228, s[12:15], s56 offen nt
    v_mfma_f32_16x16x32_bf16 v[140:143], a[132:135], v[116:119], v[140:143]
    v_exp_f32 v241, v173
    v_mfma_f32_16x16x32_bf16 v[140:143], a[128:131], v[112:115], v[140:143]
    s_waitcnt lgkmcnt(2)
    ds_read_b128 a[192:195], v3 offset:0
    v_cvt_pk_bf16_f32 v220, v240, v241
    v_mfma_f32_16x16x32_bf16 v[156:159], a[144:147], v[112:115], v[44:47]
    s_mov_b32 s10, s59
    v_exp_f32 v242, v174
    v_mfma_f32_16x16x32_bf16 v[156:159], a[148:151], v[116:119], v[156:159]
    s_waitcnt lgkmcnt(1)
    v_exp_f32 v243, v175
    v_mfma_f32_16x16x32_bf16 v[156:159], a[152:155], v[120:123], v[156:159]
    ds_read_b128 a[196:199], v3 offset:1024
    v_or3_b32 v57, v57, v219, v220
    v_mfma_f32_16x16x32_bf16 v[156:159], a[156:159], v[124:127], v[156:159]
    v_exp_f32 v244, v188
    v_mfma_f32_16x16x32_bf16 v[152:155], a[156:159], v[108:111], v[40:43]
    v_cvt_pk_bf16_f32 v221, v242, v243
    v_mfma_f32_16x16x32_bf16 v[152:155], a[152:155], v[104:107], v[152:155]
    buffer_load_dword v7, v230, s[24:27], s54 offen
    v_mfma_f32_16x16x32_bf16 v[152:155], a[148:151], v[100:103], v[152:155]
    v_exp_f32 v245, v189
    v_mfma_f32_16x16x32_bf16 v[152:155], a[144:147], v[96:99], v[152:155]
    ds_read_b128 a[200:203], v3 offset:2048
    v_cvt_pk_bf16_f32 v222, v244, v245
    v_mfma_f32_16x16x32_bf16 v[148:151], a[144:147], v[80:83], v[36:39]
    v_exp_f32 v246, v190
    v_mfma_f32_16x16x32_bf16 v[148:151], a[148:151], v[84:87], v[148:151]
    v_exp_f32 v247, v191
    v_mfma_f32_16x16x32_bf16 v[148:151], a[152:155], v[88:91], v[148:151]
    ds_read_b128 a[204:207], v3 offset:3072
    v_or3_b32 v57, v57, v221, v222
    v_mfma_f32_16x16x32_bf16 v[148:151], a[156:159], v[92:95], v[148:151]
    v_cvt_pk_bf16_f32 v223, v246, v247
    v_mfma_f32_16x16x32_bf16 v[144:147], a[156:159], v[76:79], v[32:35]
    s_add_u32 s54, s54, 4096
    v_mfma_f32_16x16x32_bf16 v[144:147], a[152:155], v[72:75], v[144:147]
    v_bitop3_b32 v57, v57, v223, s37 bitop3:0xa8
    v_cmp_ne_u32 vcc, 0, v57
    v_mfma_f32_16x16x32_bf16 v[144:147], a[148:151], v[68:71], v[144:147]
    v_mfma_f32_16x16x32_bf16 v[144:147], a[144:147], v[64:67], v[144:147]
    s_cbranch_vccnz k2_tramp_90
k2_ret_91:
    v_mfma_f32_16x16x32_bf16 v[12:15], v[60:63], v[208:211], v[12:15]
    v_exp_f32 v232, v128
    v_mfma_f32_16x16x32_bf16 v[48:51], v[60:63], v[212:215], v[48:51]
    s_mov_b32 m0, s35
    ds_read_b128 a[208:211], v3 offset:4096
    v_mfma_f32_16x16x32_bf16 v[248:251], v[60:63], v[216:219], v[248:251]
    s_add_u32 s53, s53, 8192
    buffer_load_dwordx4 v1, s[20:23], s33 offen offset:0 sc1 lds
    v_mfma_f32_16x16x32_bf16 v[252:255], v[60:63], v[220:223], v[252:255]
    s_waitcnt lgkmcnt(3)
    v_exp_f32 v233, v129
    v_mfma_f32_16x16x32_bf16 a[12:15], a[192:195], v[220:223], a[12:15]
    s_and_b32 s53, s53, 0xffff
    v_exp_f32 v234, v130
    v_mfma_f32_16x16x32_bf16 a[8:11], a[192:195], v[216:219], a[8:11]
    ds_read_b128 a[212:215], v3 offset:5120
    v_cvt_pk_bf16_f32 v192, v232, v233
    v_mfma_f32_16x16x32_bf16 a[4:7], a[192:195], v[212:215], a[4:7]
    v_exp_f32 v235, v131
    v_mfma_f32_16x16x32_bf16 a[0:3], a[192:195], v[208:211], a[0:3]
    v_exp_f32 v236, v144
    v_mfma_f32_16x16x32_bf16 a[16:19], a[196:199], v[208:211], a[16:19]
    ds_read_b128 a[216:219], v3 offset:6144
    v_cvt_pk_bf16_f32 v193, v234, v235
    v_mfma_f32_16x16x32_bf16 a[20:23], a[196:199], v[212:215], a[20:23]
    v_exp_f32 v237, v145
    v_mfma_f32_16x16x32_bf16 a[24:27], a[196:199], v[216:219], a[24:27]
    v_mfma_f32_16x16x32_bf16 a[28:31], a[196:199], v[220:223], a[28:31]
    s_waitcnt lgkmcnt(3)
    v_exp_f32 v238, v146
    v_mfma_f32_16x16x32_bf16 a[44:47], a[200:203], v[220:223], a[44:47]
    ds_read_b128 a[220:223], v3 offset:7168
    v_cvt_pk_bf16_f32 v194, v236, v237
    v_mfma_f32_16x16x32_bf16 a[40:43], a[200:203], v[216:219], a[40:43]
    v_exp_f32 v239, v147
    v_mfma_f32_16x16x32_bf16 a[36:39], a[200:203], v[212:215], a[36:39]
    v_or3_b32 v57, v192, v193, v194
    v_mfma_f32_16x16x32_bf16 a[32:35], a[200:203], v[208:211], a[32:35]
    s_add_u32 s35, s35, 0x4000
    v_add_u32 v3, s53, v56
    v_cvt_pk_bf16_f32 v195, v238, v239
    v_mfma_f32_16x16x32_bf16 a[48:51], a[204:207], v[208:211], a[48:51]
    v_exp_f32 v240, v132
    v_mfma_f32_16x16x32_bf16 a[52:55], a[204:207], v[212:215], a[52:55]
    buffer_load_dwordx4 v1, s[20:23], s33 offen offset:1024 sc1 lds
    ds_read_b128 a[128:131], v2 offset:0
    v_mfma_f32_16x16x32_bf16 a[56:59], a[204:207], v[216:219], a[56:59]
    v_exp_f32 v241, v133
    v_mfma_f32_16x16x32_bf16 a[60:63], a[204:207], v[220:223], a[60:63]
    s_waitcnt lgkmcnt(3)
    v_exp_f32 v242, v134
    v_mfma_f32_16x16x32_bf16 a[76:79], a[208:211], v[220:223], a[76:79]
    ds_read_b128 a[132:135], v2 offset:1024
    v_cvt_pk_bf16_f32 v196, v240, v241
    v_mfma_f32_16x16x32_bf16 a[72:75], a[208:211], v[216:219], a[72:75]
    v_exp_f32 v243, v135
    v_mfma_f32_16x16x32_bf16 a[68:71], a[208:211], v[212:215], a[68:71]
    v_or3_b32 v57, v57, v195, v196
    v_mfma_f32_16x16x32_bf16 a[64:67], a[208:211], v[208:211], a[64:67]
    v_exp_f32 v244, v148
    v_mfma_f32_16x16x32_bf16 a[80:83], a[212:215], v[208:211], a[80:83]
    ds_read_b128 a[136:139], v2 offset:2048
    v_cvt_pk_bf16_f32 v197, v242, v243
    v_mfma_f32_16x16x32_bf16 a[84:87], a[212:215], v[212:215], a[84:87]
    v_exp_f32 v245, v149
    v_mfma_f32_16x16x32_bf16 a[88:91], a[212:215], v[216:219], a[88:91]
    v_mfma_f32_16x16x32_bf16 a[92:95], a[212:215], v[220:223], a[92:95]
    s_waitcnt lgkmcnt(3)
    v_exp_f32 v246, v150
    v_mfma_f32_16x16x32_bf16 a[108:111], a[216:219], v[220:223], a[108:111]
    ds_read_b128 a[140:143], v2 offset:3072
    v_cvt_pk_bf16_f32 v198, v244, v245
    v_mfma_f32_16x16x32_bf16 a[104:107], a[216:219], v[216:219], a[104:107]
    v_exp_f32 v247, v151
    v_mfma_f32_16x16x32_bf16 a[100:103], a[216:219], v[212:215], a[100:103]
    v_or3_b32 v57, v57, v197, v198
    v_mfma_f32_16x16x32_bf16 a[96:99], a[216:219], v[208:211], a[96:99]
    s_and_b32 s35, s35, 0xffff
    v_exp_f32 v232, v136
    v_mfma_f32_16x16x32_bf16 a[112:115], a[220:223], v[208:211], a[112:115]
    ds_read_b128 a[144:147], v2 offset:4096
    v_cvt_pk_bf16_f32 v199, v246, v247
    v_mfma_f32_16x16x32_bf16 a[116:119], a[220:223], v[212:215], a[116:119]
    buffer_load_dwordx4 v1, s[20:23], s33 offen offset:2048 sc1 lds
    v_mfma_f32_16x16x32_bf16 a[120:123], a[220:223], v[216:219], a[120:123]
    v_exp_f32 v233, v137
    v_mfma_f32_16x16x32_bf16 a[124:127], a[220:223], v[220:223], a[124:127]
    s_waitcnt lgkmcnt(3)
    v_exp_f32 v234, v138
    v_mfma_f32_16x16x32_bf16 v[160:163], a[128:131], v[64:67], v[16:19]
    ds_read_b128 a[148:151], v2 offset:5120
    v_cvt_pk_bf16_f32 v200, v232, v233
    v_mfma_f32_16x16x32_bf16 v[160:163], a[132:135], v[68:71], v[160:163]
    s_waitcnt lgkmcnt(2)
    v_exp_f32 v235, v139
    v_mfma_f32_16x16x32_bf16 v[160:163], a[136:139], v[72:75], v[160:163]
    v_or3_b32 v57, v57, v199, v200
    v_mfma_f32_16x16x32_bf16 v[160:163], a[140:143], v[76:79], v[160:163]
    s_or_b32 s35, s35, 0x10000
    v_exp_f32 v236, v152
    v_mfma_f32_16x16x32_bf16 v[164:167], a[140:143], v[92:95], v[20:23]
    s_add_u32 s36, s36, 32
    ds_read_b128 a[152:155], v2 offset:6144
    v_cvt_pk_bf16_f32 v201, v234, v235
    v_mfma_f32_16x16x32_bf16 v[164:167], a[136:139], v[88:91], v[164:167]
    v_exp_f32 v237, v153
    v_mfma_f32_16x16x32_bf16 v[164:167], a[132:135], v[84:87], v[164:167]
    s_add_u32 s52, s52, 8192
    v_mfma_f32_16x16x32_bf16 v[164:167], a[128:131], v[80:83], v[164:167]
    v_exp_f32 v238, v154
    v_mfma_f32_16x16x32_bf16 v[168:171], a[128:131], v[96:99], v[24:27]
    s_and_b32 s52, s52, 0xffff
    ds_read_b128 a[156:159], v2 offset:7168
    v_cvt_pk_bf16_f32 v202, v236, v237
    v_mfma_f32_16x16x32_bf16 v[168:171], a[132:135], v[100:103], v[168:171]
    v_exp_f32 v239, v155
    v_mfma_f32_16x16x32_bf16 v[168:171], a[136:139], v[104:107], v[168:171]
    v_or3_b32 v57, v57, v201, v202
    v_mfma_f32_16x16x32_bf16 v[168:171], a[140:143], v[108:111], v[168:171]
    v_add_u32 v2, s52, v1
    v_cvt_pk_bf16_f32 v203, v238, v239
    v_mfma_f32_16x16x32_bf16 v[172:175], a[140:143], v[124:127], v[28:31]
    v_exp_f32 v240, v140
    v_mfma_f32_16x16x32_bf16 v[172:175], a[136:139], v[120:123], v[172:175]
    buffer_load_dwordx4 v1, s[20:23], s33 offen offset:3072 sc1 lds
    v_mfma_f32_16x16x32_bf16 v[172:175], a[132:135], v[116:119], v[172:175]
    s_add_u32 s33, s33, 0x80000
    v_exp_f32 v241, v141
    v_mfma_f32_16x16x32_bf16 v[172:175], a[128:131], v[112:115], v[172:175]
    s_waitcnt lgkmcnt(2)
    ds_read_b128 a[192:195], v3 offset:0
    v_cvt_pk_bf16_f32 v204, v240, v241
    v_mfma_f32_16x16x32_bf16 v[188:191], a[144:147], v[112:115], v[44:47]
    v_exp_f32 v242, v142
    v_mfma_f32_16x16x32_bf16 v[188:191], a[148:151], v[116:119], v[188:191]
    s_waitcnt lgkmcnt(1)
    v_exp_f32 v243, v143
    v_mfma_f32_16x16x32_bf16 v[188:191], a[152:155], v[120:123], v[188:191]
    ds_read_b128 a[196:199], v3 offset:1024
    v_or3_b32 v57, v57, v203, v204
    v_mfma_f32_16x16x32_bf16 v[188:191], a[156:159], v[124:127], v[188:191]
    v_exp_f32 v244, v156
    v_mfma_f32_16x16x32_bf16 v[184:187], a[156:159], v[108:111], v[40:43]
    v_cvt_pk_bf16_f32 v205, v242, v243
    v_mfma_f32_16x16x32_bf16 v[184:187], a[152:155], v[104:107], v[184:187]
    v_exp_f32 v245, v157
    v_mfma_f32_16x16x32_bf16 v[184:187], a[148:151], v[100:103], v[184:187]
    ds_read_b128 a[200:203], v3 offset:2048
    v_mfma_f32_16x16x32_bf16 v[184:187], a[144:147], v[96:99], v[184:187]
    s_sub_u32 s63, s63, 1
    v_exp_f32 v246, v158
    v_mfma_f32_16x16x32_bf16 v[180:183], a[144:147], v[80:83], v[36:39]
    v_cvt_pk_bf16_f32 v206, v244, v245
    v_mfma_f32_16x16x32_bf16 v[180:183], a[148:151], v[84:87], v[180:183]
    v_exp_f32 v247, v159
    v_mfma_f32_16x16x32_bf16 v[180:183], a[152:155], v[88:91], v[180:183]
    ds_read_b128 a[204:207], v3 offset:3072
    v_or3_b32 v57, v57, v205, v206
    v_mfma_f32_16x16x32_bf16 v[180:183], a[156:159], v[92:95], v[180:183]
    v_cvt_pk_bf16_f32 v207, v246, v247
    v_mfma_f32_16x16x32_bf16 v[176:179], a[156:159], v[76:79], v[32:35]
    v_mfma_f32_16x16x32_bf16 v[176:179], a[152:155], v[72:75], v[176:179]
    v_bitop3_b32 v57, v57, v207, s37 bitop3:0xa8
    v_cmp_ne_u32 vcc, 0, v57
    v_mfma_f32_16x16x32_bf16 v[176:179], a[148:151], v[68:71], v[176:179]
    v_mfma_f32_16x16x32_bf16 v[176:179], a[144:147], v[64:67], v[176:179]
    s_waitcnt vmcnt(13)
    s_barrier
    s_cbranch_vccnz k2_tramp_92
k2_ret_93:
    s_cmp_lg_u32 s63, 0
    s_cbranch_scc1 k2_dloop_88
    v_mfma_f32_16x16x32_bf16 v[12:15], v[60:63], v[192:195], v[12:15]
    v_exp_f32 v232, v160
    v_mfma_f32_16x16x32_bf16 v[48:51], v[60:63], v[196:199], v[48:51]
    s_mov_b32 m0, s34
    ds_read_b128 a[208:211], v3 offset:4096
    v_mfma_f32_16x16x32_bf16 v[248:251], v[60:63], v[200:203], v[248:251]
    s_add_u32 s53, s53, 8192
    buffer_load_dwordx4 v1, s[16:19], s32 offen offset:0 sc1 lds
    v_mfma_f32_16x16x32_bf16 v[252:255], v[60:63], v[204:207], v[252:255]
    s_waitcnt lgkmcnt(3)
    v_exp_f32 v233, v161
    v_mfma_f32_16x16x32_bf16 a[12:15], a[192:195], v[204:207], a[12:15]
    s_sub_u32 s40, s36, s38
    v_exp_f32 v234, v162
    v_mfma_f32_16x16x32_bf16 a[8:11], a[192:195], v[200:203], a[8:11]
    s_and_b32 s53, s53, 0xffff
    ds_read_b128 a[212:215], v3 offset:5120
    v_cvt_pk_bf16_f32 v208, v232, v233
    v_mfma_f32_16x16x32_bf16 a[4:7], a[192:195], v[196:199], a[4:7]
    s_add_u32 s34, s34, 0x4000
    v_subrev_u32 v6, s40, v4
    v_cmp_gt_i32 s[44:45], 0, v6
    v_mfma_f32_16x16x32_bf16 a[0:3], a[192:195], v[192:195], a[0:3]
    v_exp_f32 v235, v163
    v_mfma_f32_16x16x32_bf16 a[16:19], a[196:199], v[192:195], a[16:19]
    buffer_load_dwordx4 v1, s[16:19], s32 offen offset:1024 sc1 lds
    ds_read_b128 a[216:219], v3 offset:6144
    v_mfma_f32_16x16x32_bf16 a[20:23], a[196:199], v[196:199], a[20:23]
    v_exp_f32 v236, v176
    v_mfma_f32_16x16x32_bf16 a[24:27], a[196:199], v[200:203], a[24:27]
    v_cmp_gt_i32 s[46:47], 1, v6
    v_cvt_pk_bf16_f32 v209, v234, v235
    v_mfma_f32_16x16x32_bf16 a[28:31], a[196:199], v[204:207], a[28:31]
    s_waitcnt lgkmcnt(3)
    v_cmp_gt_i32 s[48:49], 2, v6
    v_cmp_gt_i32 s[50:51], 3, v6
    v_mfma_f32_16x16x32_bf16 a[44:47], a[200:203], v[204:207], a[44:47]
    s_and_b32 s34, s34, 0xffff
    v_exp_f32 v237, v177
    v_mfma_f32_16x16x32_bf16 a[40:43], a[200:203], v[200:203], a[40:43]
    s_and_b32 s60, s62, 31
    v_exp_f32 v238, v178
    v_mfma_f32_16x16x32_bf16 a[36:39], a[200:203], v[196:199], a[36:39]
    ds_read_b128 a[220:223], v3 offset:7168
    v_cvt_pk_bf16_f32 v210, v236, v237
    v_mfma_f32_16x16x32_bf16 a[32:35], a[200:203], v[192:195], a[32:35]
    s_lshr_b32 s61, s62, 5
    buffer_load_dwordx4 v1, s[16:19], s32 offen offset:2048 sc1 lds
    v_mfma_f32_16x16x32_bf16 a[48:51], a[204:207], v[192:195], a[48:51]
    v_cndmask_b32 v16, v8, v5, s[44:45]
    v_or3_b32 v57, v208, v209, v210
    v_mfma_f32_16x16x32_bf16 a[52:55], a[204:207], v[196:199], a[52:55]
    v_exp_f32 v239, v179
    v_mfma_f32_16x16x32_bf16 a[56:59], a[204:207], v[200:203], a[56:59]
    s_mul_i32 s57, s60, 229376
    v_cndmask_b32 v17, v8, v5, s[46:47]
    v_add_u32 v3, s53, v56
    v_mfma_f32_16x16x32_bf16 a[60:63], a[204:207], v[204:207], a[60:63]
    s_waitcnt lgkmcnt(2)
    v_exp_f32 v240, v164
    v_mfma_f32_16x16x32_bf16 a[76:79], a[208:211], v[204:207], a[76:79]
    v_cvt_pk_bf16_f32 v211, v238, v239
    v_cndmask_b32 v18, v8, v5, s[48:49]
    v_mfma_f32_16x16x32_bf16 a[72:75], a[208:211], v[200:203], a[72:75]
    s_lshl_b32 s4, s61, 7
    ds_read_b128 a[128:131], v2 offset:0
    v_cndmask_b32 v19, v8, v5, s[50:51]
    v_mfma_f32_16x16x32_bf16 a[68:71], a[208:211], v[196:199], a[68:71]
    v_exp_f32 v241, v165
    v_mfma_f32_16x16x32_bf16 a[64:67], a[208:211], v[192:195], a[64:67]
    s_add_u32 s57, s57, s4
    buffer_load_dwordx4 v1, s[16:19], s32 offen offset:3072 sc1 lds
    s_add_u32 s32, s32, 0x80000
    v_mfma_f32_16x16x32_bf16 a[80:83], a[212:215], v[192:195], a[80:83]
    s_waitcnt vmcnt(9)
    v_cmp_gt_i32 s[44:45], 16, v6
    v_exp_f32 v242, v166
    v_mfma_f32_16x16x32_bf16 a[84:87], a[212:215], v[196:199], a[84:87]
    ds_read_b128 a[132:135], v2 offset:1024
    v_cvt_pk_bf16_f32 v212, v240, v241
    v_mfma_f32_16x16x32_bf16 a[88:91], a[212:215], v[200:203], a[88:91]
    s_add_u32 s56, s57, 57344
    v_cmp_gt_i32 s[46:47], 17, v6
    v_exp_f32 v243, v167
    v_mfma_f32_16x16x32_bf16 a[92:95], a[212:215], v[204:207], a[92:95]
    s_waitcnt lgkmcnt(2)
    v_or3_b32 v57, v57, v211, v212
    v_cmp_gt_i32 s[48:49], 18, v6
    v_mfma_f32_16x16x32_bf16 a[108:111], a[216:219], v[204:207], a[108:111]
    v_exp_f32 v244, v180
    v_mfma_f32_16x16x32_bf16 a[104:107], a[216:219], v[200:203], a[104:107]
    s_add_u32 s62, s62, 1
    v_cvt_pk_bf16_f32 v213, v242, v243
    v_cmp_gt_i32 s[50:51], 19, v6
    v_mfma_f32_16x16x32_bf16 a[100:103], a[216:219], v[196:199], a[100:103]
    buffer_store_dwordx4 a[224:227], v229, s[8:11], s58 offen offset:0 sc1
    ds_read_b128 a[136:139], v2 offset:2048
    v_mfma_f32_16x16x32_bf16 a[96:99], a[216:219], v[192:195], a[96:99]
    v_exp_f32 v245, v181
    v_mfma_f32_16x16x32_bf16 a[112:115], a[220:223], v[192:195], a[112:115]
    v_cndmask_b32 v32, v8, v5, s[44:45]
    v_exp_f32 v246, v182
    v_mfma_f32_16x16x32_bf16 a[116:119], a[220:223], v[196:199], a[116:119]
    ds_read_b128 a[140:143], v2 offset:3072
    v_cndmask_b32 v33, v8, v5, s[46:47]
    v_cvt_pk_bf16_f32 v214, v244, v245
    v_cndmask_b32 v34, v8, v5, s[48:49]
    v_cndmask_b32 v35, v8, v5, s[50:51]
    v_mfma_f32_16x16x32_bf16 a[120:123], a[220:223], v[200:203], a[120:123]
    v_exp_f32 v247, v183
    v_mfma_f32_16x16x32_bf16 a[124:127], a[220:223], v[204:207], a[124:127]
    s_waitcnt lgkmcnt(2)
    v_or3_b32 v57, v57, v213, v214
    v_cvt_pk_bf16_f32 v215, v246, v247
    v_mfma_f32_16x16x32_bf16 v[128:131], a[128:131], v[64:67], v[16:19]
    v_exp_f32 v232, v168
    v_mfma_f32_16x16x32_bf16 v[128:131], a[132:135], v[68:71], v[128:131]
    s_waitcnt lgkmcnt(0)
    buffer_store_dwordx4 a[228:231], v229, s[8:11], s58 offen offset:256 sc1
    ds_read_b128 a[144:147], v2 offset:4096
    v_mfma_f32_16x16x32_bf16 v[128:131], a[136:139], v[72:75], v[128:131]
    v_exp_f32 v233, v169
    v_mfma_f32_16x16x32_bf16 v[128:131], a[140:143], v[76:79], v[128:131]
    s_add_u32 s36, s36, 32
    v_exp_f32 v234, v170
    v_mfma_f32_16x16x32_bf16 v[132:135], a[140:143], v[92:95], v[20:23]
    ds_read_b128 a[148:151], v2 offset:5120
    v_cvt_pk_bf16_f32 v216, v232, v233
    v_mfma_f32_16x16x32_bf16 v[132:135], a[136:139], v[88:91], v[132:135]
    s_lshl_b32 s58, s61, 17
    v_exp_f32 v235, v171
    v_mfma_f32_16x16x32_bf16 v[132:135], a[132:135], v[84:87], v[132:135]
    s_add_u32 s52, s52, 8192
    v_or3_b32 v57, v57, v215, v216
    v_cvt_pk_bf16_f32 v217, v234, v235
    v_mfma_f32_16x16x32_bf16 v[132:135], a[128:131], v[80:83], v[132:135]
    v_exp_f32 v236, v184
    v_mfma_f32_16x16x32_bf16 v[136:139], a[128:131], v[96:99], v[24:27]
    s_lshl_b32 s60, s60, 10
    buffer_load_dwordx4 a[224:227], v228, s[12:15], s57 offen nt
    ds_read_b128 a[152:155], v2 offset:6144
    v_mfma_f32_16x16x32_bf16 v[136:139], a[132:135], v[100:103], v[136:139]
    s_and_b32 s52, s52, 0xffff
    v_exp_f32 v237, v185
    v_mfma_f32_16x16x32_bf16 v[136:139], a[136:139], v[104:107], v[136:139]
    v_exp_f32 v238, v186
    v_mfma_f32_16x16x32_bf16 v[136:139], a[140:143], v[108:111], v[136:139]
    ds_read_b128 a[156:159], v2 offset:7168
    v_cvt_pk_bf16_f32 v218, v236, v237
    v_mfma_f32_16x16x32_bf16 v[140:143], a[140:143], v[124:127], v[28:31]
    s_add_u32 s58, s58, s60
    v_exp_f32 v239, v187
    v_mfma_f32_16x16x32_bf16 v[140:143], a[136:139], v[120:123], v[140:143]
    v_or3_b32 v57, v57, v217, v218
    v_add_u32 v2, s52, v1
    v_mfma_f32_16x16x32_bf16 v[140:143], a[132:135], v[116:119], v[140:143]
    v_exp_f32 v240, v172
    v_mfma_f32_16x16x32_bf16 v[140:143], a[128:131], v[112:115], v[140:143]
    s_waitcnt lgkmcnt(2)
    ds_read_b128 a[192:195], v3 offset:0
    v_cvt_pk_bf16_f32 v219, v238, v239
    v_mfma_f32_16x16x32_bf16 v[156:159], a[144:147], v[112:115], v[44:47]
    s_mov_b32 s10, s59
    buffer_load_dwordx4 a[228:231], v228, s[12:15], s56 offen nt
    v_mfma_f32_16x16x32_bf16 v[156:159], a[148:151], v[116:119], v[156:159]
    s_waitcnt lgkmcnt(1)
    v_exp_f32 v241, v173
    v_mfma_f32_16x16x32_bf16 v[156:159], a[152:155], v[120:123], v[156:159]
    v_exp_f32 v242, v174
    v_mfma_f32_16x16x32_bf16 v[156:159], a[156:159], v[124:127], v[156:159]
    v_cvt_pk_bf16_f32 v220, v240, v241
    v_or3_b32 v57, v57, v219, v220
    v_mfma_f32_16x16x32_bf16 v[152:155], a[156:159], v[108:111], v[40:43]
    v_exp_f32 v243, v175
    v_mfma_f32_16x16x32_bf16 v[152:155], a[152:155], v[104:107], v[152:155]
    ds_read_b128 a[196:199], v3 offset:1024
    v_cvt_pk_bf16_f32 v221, v242, v243
    v_mfma_f32_16x16x32_bf16 v[152:155], a[148:151], v[100:103], v[152:155]
    v_exp_f32 v244, v188
    v_mfma_f32_16x16x32_bf16 v[152:155], a[144:147], v[96:99], v[152:155]
    buffer_load_dword v7, v230, s[24:27], s54 offen
    ds_read_b128 a[200:203], v3 offset:2048
    v_mfma_f32_16x16x32_bf16 v[148:151], a[144:147], v[80:83], v[36:39]
    v_exp_f32 v245, v189
    v_mfma_f32_16x16x32_bf16 v[148:151], a[148:151], v[84:87], v[148:151]
    v_exp_f32 v246, v190
    v_mfma_f32_16x16x32_bf16 v[148:151], a[152:155], v[88:91], v[148:151]
    v_cvt_pk_bf16_f32 v222, v244, v245
    v_or3_b32 v57, v57, v221, v222
    v_mfma_f32_16x16x32_bf16 v[148:151], a[156:159], v[92:95], v[148:151]
    v_exp_f32 v247, v191
    v_mfma_f32_16x16x32_bf16 v[144:147], a[156:159], v[76:79], v[32:35]
    s_add_u32 s54, s54, 4096
    ds_read_b128 a[204:207], v3 offset:3072
    v_cvt_pk_bf16_f32 v223, v246, v247
    v_mfma_f32_16x16x32_bf16 v[144:147], a[152:155], v[72:75], v[144:147]
    v_bitop3_b32 v57, v57, v223, s37 bitop3:0xa8
    v_cmp_ne_u32 vcc, 0, v57
    v_mfma_f32_16x16x32_bf16 v[144:147], a[148:151], v[68:71], v[144:147]
    v_mfma_f32_16x16x32_bf16 v[144:147], a[144:147], v[64:67], v[144:147]
    s_cbranch_vccnz k2_tramp_94
k2_ret_95:
    v_mfma_f32_16x16x32_bf16 v[12:15], v[60:63], v[208:211], v[12:15]
    v_exp_f32 v232, v128
    v_mfma_f32_16x16x32_bf16 v[48:51], v[60:63], v[212:215], v[48:51]
    s_mov_b32 m0, s35
    ds_read_b128 a[208:211], v3 offset:4096
    v_mfma_f32_16x16x32_bf16 v[248:251], v[60:63], v[216:219], v[248:251]
    s_add_u32 s53, s53, 8192
    buffer_load_dwordx4 v1, s[20:23], s33 offen offset:0 sc1 lds
    v_mfma_f32_16x16x32_bf16 v[252:255], v[60:63], v[220:223], v[252:255]
    s_waitcnt lgkmcnt(3)
    v_exp_f32 v233, v129
    v_mfma_f32_16x16x32_bf16 a[12:15], a[192:195], v[220:223], a[12:15]
    s_sub_u32 s40, s36, s38
    v_exp_f32 v234, v130
    v_mfma_f32_16x16x32_bf16 a[8:11], a[192:195], v[216:219], a[8:11]
    s_and_b32 s53, s53, 0xffff
    ds_read_b128 a[212:215], v3 offset:5120
    v_cvt_pk_bf16_f32 v192, v232, v233
    v_mfma_f32_16x16x32_bf16 a[4:7], a[192:195], v[212:215], a[4:7]
    v_subrev_u32 v6, s40, v4
    v_cmp_gt_i32 s[44:45], 0, v6
    v_mfma_f32_16x16x32_bf16 a[0:3], a[192:195], v[208:211], a[0:3]
    v_exp_f32 v235, v131
    v_mfma_f32_16x16x32_bf16 a[16:19], a[196:199], v[208:211], a[16:19]
    v_exp_f32 v236, v144
    v_mfma_f32_16x16x32_bf16 a[20:23], a[196:199], v[212:215], a[20:23]
    v_cmp_gt_i32 s[46:47], 1, v6
    v_cvt_pk_bf16_f32 v193, v234, v235
    v_mfma_f32_16x16x32_bf16 a[24:27], a[196:199], v[216:219], a[24:27]
    ds_read_b128 a[216:219], v3 offset:6144
    v_cmp_gt_i32 s[48:49], 2, v6
    v_mfma_f32_16x16x32_bf16 a[28:31], a[196:199], v[220:223], a[28:31]
    s_waitcnt lgkmcnt(3)
    v_exp_f32 v237, v145
    v_mfma_f32_16x16x32_bf16 a[44:47], a[200:203], v[220:223], a[44:47]
    v_cmp_gt_i32 s[50:51], 3, v6
    v_cvt_pk_bf16_f32 v194, v236, v237
    v_mfma_f32_16x16x32_bf16 a[40:43], a[200:203], v[216:219], a[40:43]
    v_exp_f32 v238, v146
    v_mfma_f32_16x16x32_bf16 a[36:39], a[200:203], v[212:215], a[36:39]
    ds_read_b128 a[220:223], v3 offset:7168
    v_cndmask_b32 v16, v8, v5, s[44:45]
    v_mfma_f32_16x16x32_bf16 a[32:35], a[200:203], v[208:211], a[32:35]
    s_add_u32 s35, s35, 0x4000
    v_exp_f32 v239, v147
    v_mfma_f32_16x16x32_bf16 a[48:51], a[204:207], v[208:211], a[48:51]
    v_or3_b32 v57, v192, v193, v194
    v_cndmask_b32 v17, v8, v5, s[46:47]
    v_mfma_f32_16x16x32_bf16 a[52:55], a[204:207], v[212:215], a[52:55]
    v_add_u32 v3, s53, v56
    v_cvt_pk_bf16_f32 v195, v238, v239
    v_mfma_f32_16x16x32_bf16 a[56:59], a[204:207], v[216:219], a[56:59]
    v_exp_f32 v240, v132
    v_mfma_f32_16x16x32_bf16 a[60:63], a[204:207], v[220:223], a[60:63]
    s_waitcnt lgkmcnt(2)
    ds_read_b128 a[128:131], v2 offset:0
    v_cndmask_b32 v18, v8, v5, s[48:49]
    v_mfma_f32_16x16x32_bf16 a[76:79], a[208:211], v[220:223], a[76:79]
    buffer_load_dwordx4 v1, s[20:23], s33 offen offset:1024 sc1 lds
    ds_read_b128 a[132:135], v2 offset:1024
    v_mfma_f32_16x16x32_bf16 a[72:75], a[208:211], v[216:219], a[72:75]
    v_exp_f32 v241, v133
    v_mfma_f32_16x16x32_bf16 a[68:71], a[208:211], v[212:215], a[68:71]
    v_cndmask_b32 v19, v8, v5, s[50:51]
    v_cmp_gt_i32 s[44:45], 16, v6
    v_mfma_f32_16x16x32_bf16 a[64:67], a[208:211], v[208:211], a[64:67]
    v_exp_f32 v242, v134
    v_mfma_f32_16x16x32_bf16 a[80:83], a[212:215], v[208:211], a[80:83]
    v_cvt_pk_bf16_f32 v196, v240, v241
    v_cmp_gt_i32 s[46:47], 17, v6
    v_mfma_f32_16x16x32_bf16 a[84:87], a[212:215], v[212:215], a[84:87]
    v_exp_f32 v243, v135
    v_mfma_f32_16x16x32_bf16 a[88:91], a[212:215], v[216:219], a[88:91]
    v_or3_b32 v57, v57, v195, v196
    v_cmp_gt_i32 s[48:49], 18, v6
    v_mfma_f32_16x16x32_bf16 a[92:95], a[212:215], v[220:223], a[92:95]
    s_waitcnt lgkmcnt(2)
    v_exp_f32 v244, v148
    v_mfma_f32_16x16x32_bf16 a[108:111], a[216:219], v[220:223], a[108:111]
    v_cvt_pk_bf16_f32 v197, v242, v243
    v_cmp_gt_i32 s[50:51], 19, v6
    v_mfma_f32_16x16x32_bf16 a[104:107], a[216:219], v[216:219], a[104:107]
    ds_read_b128 a[136:139], v2 offset:2048
    v_cndmask_b32 v32, v8, v5, s[44:45]
    v_mfma_f32_16x16x32_bf16 a[100:103], a[216:219], v[212:215], a[100:103]
    v_exp_f32 v245, v149
    v_mfma_f32_16x16x32_bf16 a[96:99], a[216:219], v[208:211], a[96:99]
    s_and_b32 s35, s35, 0xffff
    v_exp_f32 v246, v150
    v_mfma_f32_16x16x32_bf16 a[112:115], a[220:223], v[208:211], a[112:115]
    v_cndmask_b32 v33, v8, v5, s[46:47]
    v_cvt_pk_bf16_f32 v198, v244, v245
    v_mfma_f32_16x16x32_bf16 a[116:119], a[220:223], v[212:215], a[116:119]
    ds_read_b128 a[140:143], v2 offset:3072
    v_cndmask_b32 v34, v8, v5, s[48:49]
    v_cndmask_b32 v35, v8, v5, s[50:51]
    v_mfma_f32_16x16x32_bf16 a[120:123], a[220:223], v[216:219], a[120:123]
    v_exp_f32 v247, v151
    v_mfma_f32_16x16x32_bf16 a[124:127], a[220:223], v[220:223], a[124:127]
    s_waitcnt lgkmcnt(2)
    v_or3_b32 v57, v57, v197, v198
    v_cvt_pk_bf16_f32 v199, v246, v247
    v_mfma_f32_16x16x32_bf16 v[160:163], a[128:131], v[64:67], v[16:19]
    v_exp_f32 v232, v136
    v_mfma_f32_16x16x32_bf16 v[160:163], a[132:135], v[68:71], v[160:163]
    s_waitcnt lgkmcnt(0)
    buffer_load_dwordx4 v1, s[20:23], s33 offen offset:2048 sc1 lds
    ds_read_b128 a[144:147], v2 offset:4096
    v_mfma_f32_16x16x32_bf16 v[160:163], a[136:139], v[72:75], v[160:163]
    v_exp_f32 v233, v137
    v_mfma_f32_16x16x32_bf16 v[160:163], a[140:143], v[76:79], v[160:163]
    s_or_b32 s35, s35, 0x10000
    v_exp_f32 v234, v138
    v_mfma_f32_16x16x32_bf16 v[164:167], a[140:143], v[92:95], v[20:23]
    s_add_u32 s36, s36, 32
    ds_read_b128 a[148:151], v2 offset:5120
    v_cvt_pk_bf16_f32 v200, v232, v233
    v_mfma_f32_16x16x32_bf16 v[164:167], a[136:139], v[88:91], v[164:167]
    v_exp_f32 v235, v139
    v_mfma_f32_16x16x32_bf16 v[164:167], a[132:135], v[84:87], v[164:167]
    s_add_u32 s52, s52, 8192
    v_or3_b32 v57, v57, v199, v200
    v_cvt_pk_bf16_f32 v201, v234, v235
    v_mfma_f32_16x16x32_bf16 v[164:167], a[128:131], v[80:83], v[164:167]
    v_exp_f32 v236, v152
    v_mfma_f32_16x16x32_bf16 v[168:171], a[128:131], v[96:99], v[24:27]
    s_and_b32 s52, s52, 0xffff
    ds_read_b128 a[152:155], v2 offset:6144
    ds_read_b128 a[156:159], v2 offset:7168
    v_mfma_f32_16x16x32_bf16 v[168:171], a[132:135], v[100:103], v[168:171]
    v_exp_f32 v237, v153
    v_mfma_f32_16x16x32_bf16 v[168:171], a[136:139], v[104:107], v[168:171]
    v_exp_f32 v238, v154
    v_mfma_f32_16x16x32_bf16 v[168:171], a[140:143], v[108:111], v[168:171]
    v_cvt_pk_bf16_f32 v202, v236, v237
    v_or3_b32 v57, v57, v201, v202
    v_mfma_f32_16x16x32_bf16 v[172:175], a[140:143], v[124:127], v[28:31]
    v_exp_f32 v239, v155
    v_mfma_f32_16x16x32_bf16 v[172:175], a[136:139], v[120:123], v[172:175]
    v_add_u32 v2, s52, v1
    v_cvt_pk_bf16_f32 v203, v238, v239
    v_mfma_f32_16x16x32_bf16 v[172:175], a[132:135], v[116:119], v[172:175]
    v_exp_f32 v240, v140
    v_mfma_f32_16x16x32_bf16 v[172:175], a[128:131], v[112:115], v[172:175]
    s_waitcnt lgkmcnt(2)
    buffer_load_dwordx4 v1, s[20:23], s33 offen offset:3072 sc1 lds
    s_add_u32 s33, s33, 0x80000
    v_mfma_f32_16x16x32_bf16 v[188:191], a[144:147], v[112:115], v[44:47]
    v_exp_f32 v241, v141
    v_mfma_f32_16x16x32_bf16 v[188:191], a[148:151], v[116:119], v[188:191]
    s_waitcnt lgkmcnt(0)
    ds_read_b128 a[192:195], v3 offset:0
    v_cvt_pk_bf16_f32 v204, v240, v241
    v_mfma_f32_16x16x32_bf16 v[188:191], a[152:155], v[120:123], v[188:191]
    v_exp_f32 v242, v142
    v_mfma_f32_16x16x32_bf16 v[188:191], a[156:159], v[124:127], v[188:191]
    v_exp_f32 v243, v143
    v_mfma_f32_16x16x32_bf16 v[184:187], a[156:159], v[108:111], v[40:43]
    ds_read_b128 a[196:199], v3 offset:1024
    v_or3_b32 v57, v57, v203, v204
    v_mfma_f32_16x16x32_bf16 v[184:187], a[152:155], v[104:107], v[184:187]
    v_exp_f32 v244, v156
    v_mfma_f32_16x16x32_bf16 v[184:187], a[148:151], v[100:103], v[184:187]
    ds_read_b128 a[200:203], v3 offset:2048
    v_cvt_pk_bf16_f32 v205, v242, v243
    v_mfma_f32_16x16x32_bf16 v[184:187], a[144:147], v[96:99], v[184:187]
    v_exp_f32 v245, v157
    v_mfma_f32_16x16x32_bf16 v[180:183], a[144:147], v[80:83], v[36:39]
    v_exp_f32 v246, v158
    v_mfma_f32_16x16x32_bf16 v[180:183], a[148:151], v[84:87], v[180:183]
    v_cvt_pk_bf16_f32 v206, v244, v245
    v_or3_b32 v57, v57, v205, v206
    v_mfma_f32_16x16x32_bf16 v[180:183], a[152:155], v[88:91], v[180:183]
    v_exp_f32 v247, v159
    v_mfma_f32_16x16x32_bf16 v[180:183], a[156:159], v[92:95], v[180:183]
    ds_read_b128 a[204:207], v3 offset:3072
    v_cvt_pk_bf16_f32 v207, v246, v247
    v_mfma_f32_16x16x32_bf16 v[176:179], a[156:159], v[76:79], v[32:35]
    v_mfma_f32_16x16x32_bf16 v[176:179], a[152:155], v[72:75], v[176:179]
    v_bitop3_b32 v57, v57, v207, s37 bitop3:0xa8
    v_cmp_ne_u32 vcc, 0, v57
    v_mfma_f32_16x16x32_bf16 v[176:179], a[148:151], v[68:71], v[176:179]
    v_mfma_f32_16x16x32_bf16 v[176:179], a[144:147], v[64:67], v[176:179]
    s_waitcnt vmcnt(13)
    s_barrier
    s_cbranch_vccnz k2_tramp_96
k2_ret_97:
k2_dm3_89:
    v_mfma_f32_16x16x32_bf16 v[12:15], v[60:63], v[192:195], v[12:15]
    v_exp_f32 v232, v160
    v_mfma_f32_16x16x32_bf16 v[48:51], v[60:63], v[196:199], v[48:51]
    s_mov_b32 m0, s34
    ds_read_b128 a[208:211], v3 offset:4096
    v_mfma_f32_16x16x32_bf16 v[248:251], v[60:63], v[200:203], v[248:251]
    s_add_u32 s53, s53, 8192
    v_exp_f32 v233, v161
    v_mfma_f32_16x16x32_bf16 v[252:255], v[60:63], v[204:207], v[252:255]
    s_waitcnt lgkmcnt(3)
    buffer_load_dwordx4 v1, s[16:19], s32 offen offset:0 sc1 lds
    v_mfma_f32_16x16x32_bf16 a[12:15], a[192:195], v[204:207], a[12:15]
    s_sub_u32 s40, s36, s38
    s_sub_u32 s40, s40, 64
    v_exp_f32 v234, v162
    v_cvt_pk_bf16_f32 v208, v232, v233
    v_mfma_f32_16x16x32_bf16 a[8:11], a[192:195], v[200:203], a[8:11]
    s_and_b32 s53, s53, 0xffff
    ds_read_b128 a[212:215], v3 offset:5120
    v_subrev_u32 v6, s40, v4
    v_mfma_f32_16x16x32_bf16 a[4:7], a[192:195], v[196:199], a[4:7]
    s_add_u32 s34, s34, 0x4000
    v_exp_f32 v235, v163
    v_cmp_gt_i32 s[44:45], 0, v6
    v_mfma_f32_16x16x32_bf16 a[0:3], a[192:195], v[192:195], a[0:3]
    v_exp_f32 v236, v176
    v_cvt_pk_bf16_f32 v209, v234, v235
    v_mfma_f32_16x16x32_bf16 a[16:19], a[196:199], v[192:195], a[16:19]
    buffer_load_dwordx4 v1, s[16:19], s32 offen offset:1024 sc1 lds
    ds_read_b128 a[216:219], v3 offset:6144
    v_mfma_f32_16x16x32_bf16 a[20:23], a[196:199], v[196:199], a[20:23]
    v_cmp_gt_i32 s[46:47], 1, v6
    v_exp_f32 v237, v177
    v_mfma_f32_16x16x32_bf16 a[24:27], a[196:199], v[200:203], a[24:27]
    v_cmp_gt_i32 s[48:49], 2, v6
    v_exp_f32 v238, v178
    v_mfma_f32_16x16x32_bf16 a[28:31], a[196:199], v[204:207], a[28:31]
    s_waitcnt lgkmcnt(3)
    v_cvt_pk_bf16_f32 v210, v236, v237
    v_cmp_gt_i32 s[50:51], 3, v6
    v_mfma_f32_16x16x32_bf16 a[44:47], a[200:203], v[204:207], a[44:47]
    s_and_b32 s34, s34, 0xffff
    v_exp_f32 v239, v179
    v_mfma_f32_16x16x32_bf16 a[40:43], a[200:203], v[200:203], a[40:43]
    s_and_b32 s60, s62, 31
    ds_read_b128 a[220:223], v3 offset:7168
    v_or3_b32 v57, v208, v209, v210
    v_cndmask_b32 v20, v9, v5, s[44:45]
    v_mfma_f32_16x16x32_bf16 a[36:39], a[200:203], v[196:199], a[36:39]
    buffer_load_dwordx4 v1, s[16:19], s32 offen offset:2048 sc1 lds
    v_mfma_f32_16x16x32_bf16 a[32:35], a[200:203], v[192:195], a[32:35]
    s_lshr_b32 s61, s62, 5
    v_exp_f32 v240, v164
    v_cvt_pk_bf16_f32 v211, v238, v239
    v_mfma_f32_16x16x32_bf16 a[48:51], a[204:207], v[192:195], a[48:51]
    v_cndmask_b32 v21, v9, v5, s[46:47]
    v_add_u32 v3, s53, v56
    v_mfma_f32_16x16x32_bf16 a[52:55], a[204:207], v[196:199], a[52:55]
    s_mul_i32 s57, s60, 229376
    v_exp_f32 v241, v165
    v_mfma_f32_16x16x32_bf16 a[56:59], a[204:207], v[200:203], a[56:59]
    ds_read_b128 a[128:131], v2 offset:0
    v_cndmask_b32 v22, v9, v5, s[48:49]
    v_cvt_pk_bf16_f32 v212, v240, v241
    v_mfma_f32_16x16x32_bf16 a[60:63], a[204:207], v[204:207], a[60:63]
    s_waitcnt lgkmcnt(3)
    v_exp_f32 v242, v166
    v_mfma_f32_16x16x32_bf16 a[76:79], a[208:211], v[204:207], a[76:79]
    s_lshl_b32 s4, s61, 7
    v_cndmask_b32 v23, v9, v5, s[50:51]
    v_or3_b32 v57, v57, v211, v212
    v_mfma_f32_16x16x32_bf16 a[72:75], a[208:211], v[200:203], a[72:75]
    buffer_load_dwordx4 v1, s[16:19], s32 offen offset:3072 sc1 lds
    ds_read_b128 a[132:135], v2 offset:1024
    s_add_u32 s32, s32, 0x80000
    v_mfma_f32_16x16x32_bf16 a[68:71], a[208:211], v[196:199], a[68:71]
    v_exp_f32 v243, v167
    v_mfma_f32_16x16x32_bf16 a[64:67], a[208:211], v[192:195], a[64:67]
    s_add_u32 s57, s57, s4
    v_cmp_gt_i32 s[44:45], 16, v6
    v_cvt_pk_bf16_f32 v213, v242, v243
    v_mfma_f32_16x16x32_bf16 a[80:83], a[212:215], v[192:195], a[80:83]
    s_waitcnt vmcnt(9)
    v_exp_f32 v244, v180
    v_mfma_f32_16x16x32_bf16 a[84:87], a[212:215], v[196:199], a[84:87]
    s_add_u32 s56, s57, 57344
    ds_read_b128 a[136:139], v2 offset:2048
    v_cmp_gt_i32 s[46:47], 17, v6
    v_mfma_f32_16x16x32_bf16 a[88:91], a[212:215], v[200:203], a[88:91]
    v_exp_f32 v245, v181
    v_cmp_gt_i32 s[48:49], 18, v6
    v_mfma_f32_16x16x32_bf16 a[92:95], a[212:215], v[204:207], a[92:95]
    s_waitcnt lgkmcnt(3)
    v_exp_f32 v246, v182
    v_mfma_f32_16x16x32_bf16 a[108:111], a[216:219], v[204:207], a[108:111]
    s_add_u32 s62, s62, 1
    v_cmp_gt_i32 s[50:51], 19, v6
    v_cvt_pk_bf16_f32 v214, v244, v245
    v_mfma_f32_16x16x32_bf16 a[104:107], a[216:219], v[200:203], a[104:107]
    buffer_store_dwordx4 a[224:227], v229, s[8:11], s58 offen offset:0 sc1
    ds_read_b128 a[140:143], v2 offset:3072
    ds_read_b128 a[144:147], v2 offset:4096
    v_mfma_f32_16x16x32_bf16 a[100:103], a[216:219], v[196:199], a[100:103]
    v_exp_f32 v247, v183
    v_mfma_f32_16x16x32_bf16 a[96:99], a[216:219], v[192:195], a[96:99]
    v_cndmask_b32 v36, v9, v5, s[44:45]
    v_or3_b32 v57, v57, v213, v214
    v_mfma_f32_16x16x32_bf16 a[112:115], a[220:223], v[192:195], a[112:115]
    v_exp_f32 v232, v168
    v_mfma_f32_16x16x32_bf16 a[116:119], a[220:223], v[196:199], a[116:119]
    v_cndmask_b32 v37, v9, v5, s[46:47]
    v_cvt_pk_bf16_f32 v215, v246, v247
    v_cndmask_b32 v38, v9, v5, s[48:49]
    v_cndmask_b32 v39, v9, v5, s[50:51]
    v_mfma_f32_16x16x32_bf16 a[120:123], a[220:223], v[200:203], a[120:123]
    v_exp_f32 v233, v169
    v_mfma_f32_16x16x32_bf16 a[124:127], a[220:223], v[204:207], a[124:127]
    s_waitcnt lgkmcnt(3)
    buffer_store_dwordx4 a[228:231], v229, s[8:11], s58 offen offset:256 sc1
    v_exp_f32 v234, v170
    v_mfma_f32_16x16x32_bf16 v[132:135], a[128:131], v[80:83], v[20:23]
    ds_read_b128 a[148:151], v2 offset:5120
    v_cvt_pk_bf16_f32 v216, v232, v233
    v_mfma_f32_16x16x32_bf16 v[132:135], a[132:135], v[84:87], v[132:135]
    s_waitcnt lgkmcnt(2)
    v_exp_f32 v235, v171
    v_mfma_f32_16x16x32_bf16 v[132:135], a[136:139], v[88:91], v[132:135]
    s_lshl_b32 s58, s61, 17
    ds_read_b128 a[152:155], v2 offset:6144
    v_or3_b32 v57, v57, v215, v216
    v_mfma_f32_16x16x32_bf16 v[132:135], a[140:143], v[92:95], v[132:135]
    s_add_u32 s36, s36, 32
    v_exp_f32 v236, v184
    v_mfma_f32_16x16x32_bf16 v[136:139], a[140:143], v[108:111], v[24:27]
    s_lshl_b32 s60, s60, 10
    v_cvt_pk_bf16_f32 v217, v234, v235
    v_exp_f32 v237, v185
    v_mfma_f32_16x16x32_bf16 v[136:139], a[136:139], v[104:107], v[136:139]
    buffer_load_dwordx4 a[224:227], v228, s[12:15], s57 offen nt
    ds_read_b128 a[156:159], v2 offset:7168
    v_mfma_f32_16x16x32_bf16 v[136:139], a[132:135], v[100:103], v[136:139]
    s_add_u32 s52, s52, 8192
    v_exp_f32 v238, v186
    v_mfma_f32_16x16x32_bf16 v[136:139], a[128:131], v[96:99], v[136:139]
    s_add_u32 s58, s58, s60
    v_cvt_pk_bf16_f32 v218, v236, v237
    v_or3_b32 v57, v57, v217, v218
    v_mfma_f32_16x16x32_bf16 v[140:143], a[128:131], v[112:115], v[28:31]
    s_and_b32 s52, s52, 0xffff
    v_exp_f32 v239, v187
    v_mfma_f32_16x16x32_bf16 v[140:143], a[132:135], v[116:119], v[140:143]
    v_add_u32 v2, s52, v1
    v_cvt_pk_bf16_f32 v219, v238, v239
    v_mfma_f32_16x16x32_bf16 v[140:143], a[136:139], v[120:123], v[140:143]
    s_mov_b32 s10, s59
    v_exp_f32 v240, v172
    v_mfma_f32_16x16x32_bf16 v[140:143], a[140:143], v[124:127], v[140:143]
    s_waitcnt lgkmcnt(2)
    ds_read_b128 a[192:195], v3 offset:0
    s_waitcnt lgkmcnt(1)
    v_mfma_f32_16x16x32_bf16 v[156:159], a[156:159], v[124:127], v[44:47]
    v_exp_f32 v241, v173
    v_mfma_f32_16x16x32_bf16 v[156:159], a[152:155], v[120:123], v[156:159]
    buffer_load_dwordx4 a[228:231], v228, s[12:15], s56 offen nt
    v_exp_f32 v242, v174
    v_mfma_f32_16x16x32_bf16 v[156:159], a[148:151], v[116:119], v[156:159]
    ds_read_b128 a[196:199], v3 offset:1024
    v_cvt_pk_bf16_f32 v220, v240, v241
    v_mfma_f32_16x16x32_bf16 v[156:159], a[144:147], v[112:115], v[156:159]
    v_exp_f32 v243, v175
    v_mfma_f32_16x16x32_bf16 v[152:155], a[144:147], v[96:99], v[40:43]
    v_or3_b32 v57, v57, v219, v220
    v_cvt_pk_bf16_f32 v221, v242, v243
    v_mfma_f32_16x16x32_bf16 v[152:155], a[148:151], v[100:103], v[152:155]
    ds_read_b128 a[200:203], v3 offset:2048
    v_exp_f32 v244, v188
    v_mfma_f32_16x16x32_bf16 v[152:155], a[152:155], v[104:107], v[152:155]
    buffer_load_dword v7, v230, s[24:27], s54 offen
    v_exp_f32 v245, v189
    v_mfma_f32_16x16x32_bf16 v[152:155], a[156:159], v[108:111], v[152:155]
    v_exp_f32 v246, v190
    v_mfma_f32_16x16x32_bf16 v[148:151], a[156:159], v[92:95], v[36:39]
    s_add_u32 s54, s54, 4096
    v_cvt_pk_bf16_f32 v222, v244, v245
    v_or3_b32 v57, v57, v221, v222
    v_mfma_f32_16x16x32_bf16 v[148:151], a[152:155], v[88:91], v[148:151]
    v_exp_f32 v247, v191
    v_mfma_f32_16x16x32_bf16 v[148:151], a[148:151], v[84:87], v[148:151]
    ds_read_b128 a[204:207], v3 offset:3072
    v_cvt_pk_bf16_f32 v223, v246, v247
    v_mfma_f32_16x16x32_bf16 v[148:151], a[144:147], v[80:83], v[148:151]
    v_bitop3_b32 v57, v57, v223, s37 bitop3:0xa8
    v_cmp_ne_u32 vcc, 0, v57
    s_cbranch_vccnz k2_tramp_98
k2_ret_99:
    v_mfma_f32_16x16x32_bf16 v[12:15], v[60:63], v[208:211], v[12:15]
    v_exp_f32 v232, v132
    v_mfma_f32_16x16x32_bf16 v[48:51], v[60:63], v[212:215], v[48:51]
    s_mov_b32 m0, s35
    ds_read_b128 a[208:211], v3 offset:4096
    v_mfma_f32_16x16x32_bf16 v[248:251], v[60:63], v[216:219], v[248:251]
    s_add_u32 s53, s53, 8192
    buffer_load_dwordx4 v1, s[20:23], s33 offen offset:0 sc1 lds
    v_mfma_f32_16x16x32_bf16 v[252:255], v[60:63], v[220:223], v[252:255]
    s_waitcnt lgkmcnt(3)
    v_exp_f32 v233, v133
    v_mfma_f32_16x16x32_bf16 a[12:15], a[192:195], v[220:223], a[12:15]
    s_sub_u32 s40, s36, s38
    s_sub_u32 s40, s40, 64
    v_exp_f32 v234, v134
    v_mfma_f32_16x16x32_bf16 a[8:11], a[192:195], v[216:219], a[8:11]
    s_and_b32 s53, s53, 0xffff
    ds_read_b128 a[212:215], v3 offset:5120
    v_subrev_u32 v6, s40, v4
    v_mfma_f32_16x16x32_bf16 a[4:7], a[192:195], v[212:215], a[4:7]
    v_cvt_pk_bf16_f32 v196, v232, v233
    v_cmp_gt_i32 s[44:45], 0, v6
    v_mfma_f32_16x16x32_bf16 a[0:3], a[192:195], v[208:211], a[0:3]
    v_exp_f32 v235, v135
    v_mfma_f32_16x16x32_bf16 a[16:19], a[196:199], v[208:211], a[16:19]
    ds_read_b128 a[216:219], v3 offset:6144
    v_cmp_gt_i32 s[46:47], 1, v6
    v_mfma_f32_16x16x32_bf16 a[20:23], a[196:199], v[212:215], a[20:23]
    v_exp_f32 v236, v148
    v_mfma_f32_16x16x32_bf16 a[24:27], a[196:199], v[216:219], a[24:27]
    v_cvt_pk_bf16_f32 v197, v234, v235
    v_cmp_gt_i32 s[48:49], 2, v6
    v_mfma_f32_16x16x32_bf16 a[28:31], a[196:199], v[220:223], a[28:31]
    s_waitcnt lgkmcnt(3)
    v_cmp_gt_i32 s[50:51], 3, v6
    v_mfma_f32_16x16x32_bf16 a[44:47], a[200:203], v[220:223], a[44:47]
    v_exp_f32 v237, v149
    v_mfma_f32_16x16x32_bf16 a[40:43], a[200:203], v[216:219], a[40:43]
    s_add_u32 s35, s35, 0x4000
    ds_read_b128 a[220:223], v3 offset:7168
    v_cndmask_b32 v20, v9, v5, s[44:45]
    v_mfma_f32_16x16x32_bf16 a[36:39], a[200:203], v[212:215], a[36:39]
    v_exp_f32 v238, v150
    v_mfma_f32_16x16x32_bf16 a[32:35], a[200:203], v[208:211], a[32:35]
    v_cvt_pk_bf16_f32 v198, v236, v237
    v_cndmask_b32 v21, v9, v5, s[46:47]
    v_mfma_f32_16x16x32_bf16 a[48:51], a[204:207], v[208:211], a[48:51]
    buffer_load_dwordx4 v1, s[20:23], s33 offen offset:1024 sc1 lds
    ds_read_b128 a[128:131], v2 offset:0
    v_mfma_f32_16x16x32_bf16 a[52:55], a[204:207], v[212:215], a[52:55]
    v_add_u32 v3, s53, v56
    v_cndmask_b32 v22, v9, v5, s[48:49]
    v_mfma_f32_16x16x32_bf16 a[56:59], a[204:207], v[216:219], a[56:59]
    v_exp_f32 v239, v151
    v_mfma_f32_16x16x32_bf16 a[60:63], a[204:207], v[220:223], a[60:63]
    s_waitcnt lgkmcnt(3)
    v_or3_b32 v57, v196, v197, v198
    v_cndmask_b32 v23, v9, v5, s[50:51]
    v_mfma_f32_16x16x32_bf16 a[76:79], a[208:211], v[220:223], a[76:79]
    v_exp_f32 v240, v136
    v_mfma_f32_16x16x32_bf16 a[72:75], a[208:211], v[216:219], a[72:75]
    v_cvt_pk_bf16_f32 v199, v238, v239
    v_cmp_gt_i32 s[44:45], 16, v6
    v_mfma_f32_16x16x32_bf16 a[68:71], a[208:211], v[212:215], a[68:71]
    ds_read_b128 a[132:135], v2 offset:1024
    v_cmp_gt_i32 s[46:47], 17, v6
    v_mfma_f32_16x16x32_bf16 a[64:67], a[208:211], v[208:211], a[64:67]
    v_exp_f32 v241, v137
    v_mfma_f32_16x16x32_bf16 a[80:83], a[212:215], v[208:211], a[80:83]
    ds_read_b128 a[136:139], v2 offset:2048
    v_cmp_gt_i32 s[48:49], 18, v6
    v_mfma_f32_16x16x32_bf16 a[84:87], a[212:215], v[212:215], a[84:87]
    v_exp_f32 v242, v138
    v_mfma_f32_16x16x32_bf16 a[88:91], a[212:215], v[216:219], a[88:91]
    v_cvt_pk_bf16_f32 v200, v240, v241
    v_cmp_gt_i32 s[50:51], 19, v6
    v_mfma_f32_16x16x32_bf16 a[92:95], a[212:215], v[220:223], a[92:95]
    s_waitcnt lgkmcnt(3)
    v_exp_f32 v243, v139
    v_mfma_f32_16x16x32_bf16 a[108:111], a[216:219], v[220:223], a[108:111]
    s_and_b32 s35, s35, 0xffff
    ds_read_b128 a[140:143], v2 offset:3072
    v_or3_b32 v57, v57, v199, v200
    v_mfma_f32_16x16x32_bf16 a[104:107], a[216:219], v[216:219], a[104:107]
    v_cndmask_b32 v36, v9, v5, s[44:45]
    v_cndmask_b32 v37, v9, v5, s[46:47]
    v_mfma_f32_16x16x32_bf16 a[100:103], a[216:219], v[212:215], a[100:103]
    v_exp_f32 v244, v152
    v_mfma_f32_16x16x32_bf16 a[96:99], a[216:219], v[208:211], a[96:99]
    ds_read_b128 a[144:147], v2 offset:4096
    v_cvt_pk_bf16_f32 v201, v242, v243
    v_mfma_f32_16x16x32_bf16 a[112:115], a[220:223], v[208:211], a[112:115]
    buffer_load_dwordx4 v1, s[20:23], s33 offen offset:2048 sc1 lds
    ds_read_b128 a[148:151], v2 offset:5120
    v_mfma_f32_16x16x32_bf16 a[116:119], a[220:223], v[212:215], a[116:119]
    v_cndmask_b32 v38, v9, v5, s[48:49]
    v_cndmask_b32 v39, v9, v5, s[50:51]
    v_mfma_f32_16x16x32_bf16 a[120:123], a[220:223], v[216:219], a[120:123]
    s_or_b32 s35, s35, 0x10000
    v_exp_f32 v245, v153
    v_mfma_f32_16x16x32_bf16 a[124:127], a[220:223], v[220:223], a[124:127]
    s_waitcnt lgkmcnt(4)
    v_exp_f32 v246, v154
    v_mfma_f32_16x16x32_bf16 v[164:167], a[128:131], v[80:83], v[20:23]
    ds_read_b128 a[152:155], v2 offset:6144
    v_cvt_pk_bf16_f32 v202, v244, v245
    v_mfma_f32_16x16x32_bf16 v[164:167], a[132:135], v[84:87], v[164:167]
    s_waitcnt lgkmcnt(3)
    v_exp_f32 v247, v155
    v_mfma_f32_16x16x32_bf16 v[164:167], a[136:139], v[88:91], v[164:167]
    v_or3_b32 v57, v57, v201, v202
    v_cvt_pk_bf16_f32 v203, v246, v247
    v_mfma_f32_16x16x32_bf16 v[164:167], a[140:143], v[92:95], v[164:167]
    s_add_u32 s36, s36, 32
    v_exp_f32 v232, v140
    v_mfma_f32_16x16x32_bf16 v[168:171], a[140:143], v[108:111], v[24:27]
    ds_read_b128 a[156:159], v2 offset:7168
    v_mfma_f32_16x16x32_bf16 v[168:171], a[136:139], v[104:107], v[168:171]
    v_exp_f32 v233, v141
    v_mfma_f32_16x16x32_bf16 v[168:171], a[132:135], v[100:103], v[168:171]
    s_add_u32 s52, s52, 8192
    v_exp_f32 v234, v142
    v_mfma_f32_16x16x32_bf16 v[168:171], a[128:131], v[96:99], v[168:171]
    ds_read_b128 a[192:195], v3 offset:0
    v_cvt_pk_bf16_f32 v204, v232, v233
    v_mfma_f32_16x16x32_bf16 v[172:175], a[128:131], v[112:115], v[28:31]
    s_and_b32 s52, s52, 0xffff
    v_add_u32 v2, s52, v1
    v_or3_b32 v57, v57, v203, v204
    v_mfma_f32_16x16x32_bf16 v[172:175], a[132:135], v[116:119], v[172:175]
    buffer_load_dwordx4 v1, s[20:23], s33 offen offset:3072 sc1 lds
    s_add_u32 s33, s33, 0x80000
    v_mfma_f32_16x16x32_bf16 v[172:175], a[136:139], v[120:123], v[172:175]
    v_exp_f32 v235, v143
    v_mfma_f32_16x16x32_bf16 v[172:175], a[140:143], v[124:127], v[172:175]
    s_waitcnt lgkmcnt(3)
    ds_read_b128 a[196:199], v3 offset:1024
    s_waitcnt lgkmcnt(2)
    v_mfma_f32_16x16x32_bf16 v[188:191], a[156:159], v[124:127], v[44:47]
    v_exp_f32 v236, v156
    v_mfma_f32_16x16x32_bf16 v[188:191], a[152:155], v[120:123], v[188:191]
    v_cvt_pk_bf16_f32 v205, v234, v235
    v_mfma_f32_16x16x32_bf16 v[188:191], a[148:151], v[116:119], v[188:191]
    v_exp_f32 v237, v157
    v_mfma_f32_16x16x32_bf16 v[188:191], a[144:147], v[112:115], v[188:191]
    ds_read_b128 a[200:203], v3 offset:2048
    v_cvt_pk_bf16_f32 v206, v236, v237
    v_mfma_f32_16x16x32_bf16 v[184:187], a[144:147], v[96:99], v[40:43]
    v_exp_f32 v238, v158
    v_mfma_f32_16x16x32_bf16 v[184:187], a[148:151], v[100:103], v[184:187]
    v_exp_f32 v239, v159
    v_mfma_f32_16x16x32_bf16 v[184:187], a[152:155], v[104:107], v[184:187]
    ds_read_b128 a[204:207], v3 offset:3072
    v_or3_b32 v57, v57, v205, v206
    v_mfma_f32_16x16x32_bf16 v[184:187], a[156:159], v[108:111], v[184:187]
    v_cvt_pk_bf16_f32 v207, v238, v239
    v_mfma_f32_16x16x32_bf16 v[180:183], a[156:159], v[92:95], v[36:39]
    v_mfma_f32_16x16x32_bf16 v[180:183], a[152:155], v[88:91], v[180:183]
    v_bitop3_b32 v57, v57, v207, s37 bitop3:0xa8
    v_cmp_ne_u32 vcc, 0, v57
    v_mfma_f32_16x16x32_bf16 v[180:183], a[148:151], v[84:87], v[180:183]
    v_mfma_f32_16x16x32_bf16 v[180:183], a[144:147], v[80:83], v[180:183]
    s_waitcnt vmcnt(13)
    s_barrier
    s_cbranch_vccnz k2_tramp_100
k2_ret_101:
    v_mfma_f32_16x16x32_bf16 v[48:51], v[60:63], v[196:199], v[48:51]
    ds_read_b128 a[208:211], v3 offset:4096
    ds_read_b128 a[212:215], v3 offset:5120
    v_mfma_f32_16x16x32_bf16 v[248:251], v[60:63], v[200:203], v[248:251]
    s_mov_b32 m0, s34
    v_exp_f32 v232, v164
    v_mfma_f32_16x16x32_bf16 v[252:255], v[60:63], v[204:207], v[252:255]
    s_waitcnt lgkmcnt(4)
    buffer_load_dwordx4 v1, s[16:19], s32 offen offset:0 sc1 lds
    ds_read_b128 a[216:219], v3 offset:6144
    v_mfma_f32_16x16x32_bf16 a[12:15], a[192:195], v[204:207], a[12:15]
    s_add_u32 s53, s53, 8192
    v_exp_f32 v233, v165
    v_mfma_f32_16x16x32_bf16 a[8:11], a[192:195], v[200:203], a[8:11]
    s_and_b32 s53, s53, 0xffff
    v_mov_b32 v16, v10
    v_mov_b32 v17, v10
    v_mfma_f32_16x16x32_bf16 a[4:7], a[192:195], v[196:199], a[4:7]
    s_add_u32 s34, s34, 0x4000
    v_exp_f32 v234, v166
    v_mfma_f32_16x16x32_bf16 a[20:23], a[196:199], v[196:199], a[20:23]
    ds_read_b128 a[220:223], v3 offset:7168
    v_cvt_pk_bf16_f32 v212, v232, v233
    v_mfma_f32_16x16x32_bf16 a[24:27], a[196:199], v[200:203], a[24:27]
    v_mov_b32 v18, v10
    v_mov_b32 v19, v10
    v_mfma_f32_16x16x32_bf16 a[28:31], a[196:199], v[204:207], a[28:31]
    s_waitcnt lgkmcnt(4)
    v_exp_f32 v235, v167
    v_mfma_f32_16x16x32_bf16 a[44:47], a[200:203], v[204:207], a[44:47]
    buffer_load_dwordx4 v1, s[16:19], s32 offen offset:1024 sc1 lds
    ds_read_b128 a[128:131], v2 offset:0
    v_mfma_f32_16x16x32_bf16 a[40:43], a[200:203], v[200:203], a[40:43]
    v_mov_b32 v20, v11
    v_add_u32 v3, s53, v56
    v_mfma_f32_16x16x32_bf16 a[36:39], a[200:203], v[196:199], a[36:39]
    s_and_b32 s34, s34, 0xffff
    v_mov_b32 v21, v11
    v_mov_b32 v22, v11
    v_mfma_f32_16x16x32_bf16 a[52:55], a[204:207], v[196:199], a[52:55]
    v_exp_f32 v236, v180
    v_mfma_f32_16x16x32_bf16 a[56:59], a[204:207], v[200:203], a[56:59]
    ds_read_b128 a[132:135], v2 offset:1024
    v_cvt_pk_bf16_f32 v213, v234, v235
    v_mfma_f32_16x16x32_bf16 a[60:63], a[204:207], v[204:207], a[60:63]
    s_waitcnt lgkmcnt(4)
    v_mov_b32 v23, v11
    v_mov_b32 v32, v10
    v_mfma_f32_16x16x32_bf16 a[76:79], a[208:211], v[204:207], a[76:79]
    v_exp_f32 v237, v181
    v_mfma_f32_16x16x32_bf16 a[72:75], a[208:211], v[200:203], a[72:75]
    ds_read_b128 a[136:139], v2 offset:2048
    v_mov_b32 v33, v10
    v_mfma_f32_16x16x32_bf16 a[68:71], a[208:211], v[196:199], a[68:71]
    buffer_load_dwordx4 v1, s[16:19], s32 offen offset:2048 sc1 lds
    v_mov_b32 v34, v10
    v_mfma_f32_16x16x32_bf16 a[84:87], a[212:215], v[196:199], a[84:87]
    v_exp_f32 v238, v182
    v_mfma_f32_16x16x32_bf16 a[88:91], a[212:215], v[200:203], a[88:91]
    ds_read_b128 a[140:143], v2 offset:3072
    v_cvt_pk_bf16_f32 v214, v236, v237
    v_mfma_f32_16x16x32_bf16 a[92:95], a[212:215], v[204:207], a[92:95]
    s_waitcnt lgkmcnt(4)
    v_mov_b32 v35, v10
    v_mov_b32 v36, v11
    v_mfma_f32_16x16x32_bf16 a[108:111], a[216:219], v[204:207], a[108:111]
    ds_read_b128 a[144:147], v2 offset:4096
    v_exp_f32 v239, v183
    v_mfma_f32_16x16x32_bf16 a[104:107], a[216:219], v[200:203], a[104:107]
    v_mov_b32 v37, v11
    v_or3_b32 v57, v212, v213, v214
    v_mov_b32 v38, v11
    v_mov_b32 v39, v11
    v_mfma_f32_16x16x32_bf16 a[100:103], a[216:219], v[196:199], a[100:103]
    buffer_load_dwordx4 v1, s[16:19], s32 offen offset:3072 sc1 lds
    ds_read_b128 a[148:151], v2 offset:5120
    v_mfma_f32_16x16x32_bf16 a[116:119], a[220:223], v[196:199], a[116:119]
    s_add_u32 s32, s32, 0x80000
    s_cmp_ge_u32 s36, s43
    s_cbranch_scc1 k2_prep_102
k2_prepret_103:
    v_mfma_f32_16x16x32_bf16 a[120:123], a[220:223], v[200:203], a[120:123]
    s_waitcnt vmcnt(9)
    v_exp_f32 v240, v168
    v_mfma_f32_16x16x32_bf16 a[124:127], a[220:223], v[204:207], a[124:127]
    s_waitcnt lgkmcnt(4)
    ds_read_b128 a[152:155], v2 offset:6144
    v_cvt_pk_bf16_f32 v215, v238, v239
    v_mfma_f32_16x16x32_bf16 v[128:131], a[128:131], v[96:99], v[16:19]
    v_exp_f32 v241, v169
    v_mfma_f32_16x16x32_bf16 v[128:131], a[132:135], v[100:103], v[128:131]
    s_waitcnt lgkmcnt(3)
    ds_read_b128 a[156:159], v2 offset:7168
    v_exp_f32 v242, v170
    v_mfma_f32_16x16x32_bf16 v[128:131], a[136:139], v[104:107], v[128:131]
    ds_read_b128 a[160:163], v2 offset:8192
    v_cvt_pk_bf16_f32 v216, v240, v241
    v_mfma_f32_16x16x32_bf16 v[128:131], a[140:143], v[108:111], v[128:131]
    s_add_u32 s36, s36, 64
    buffer_store_dwordx4 a[224:227], v229, s[8:11], s58 offen offset:0 sc1
    v_exp_f32 v243, v171
    v_mfma_f32_16x16x32_bf16 v[132:135], a[140:143], v[124:127], v[20:23]
    ds_read_b128 a[164:167], v2 offset:9216
    v_or3_b32 v57, v57, v215, v216
    v_mfma_f32_16x16x32_bf16 v[132:135], a[136:139], v[120:123], v[132:135]
    v_exp_f32 v244, v184
    v_mfma_f32_16x16x32_bf16 v[132:135], a[132:135], v[116:119], v[132:135]
    s_add_u32 s52, s52, 16384
    ds_read_b128 a[168:171], v2 offset:10240
    v_cvt_pk_bf16_f32 v217, v242, v243
    v_mfma_f32_16x16x32_bf16 v[132:135], a[128:131], v[112:115], v[132:135]
    s_waitcnt lgkmcnt(5)
    v_exp_f32 v245, v185
    v_mfma_f32_16x16x32_bf16 v[148:151], a[144:147], v[112:115], v[36:39]
    s_and_b32 s52, s52, 0xffff
    ds_read_b128 a[172:175], v2 offset:11264
    ds_read_b128 a[176:179], v2 offset:12288
    v_mfma_f32_16x16x32_bf16 v[148:151], a[148:151], v[116:119], v[148:151]
    s_waitcnt lgkmcnt(5)
    v_exp_f32 v246, v186
    v_mfma_f32_16x16x32_bf16 v[148:151], a[152:155], v[120:123], v[148:151]
    ds_read_b128 a[180:183], v2 offset:13312
    v_cvt_pk_bf16_f32 v218, v244, v245
    v_mfma_f32_16x16x32_bf16 v[148:151], a[156:159], v[124:127], v[148:151]
    v_exp_f32 v247, v187
    v_mfma_f32_16x16x32_bf16 v[144:147], a[156:159], v[108:111], v[32:35]
    ds_read_b128 a[184:187], v2 offset:14336
    v_or3_b32 v57, v57, v217, v218
    v_mfma_f32_16x16x32_bf16 v[144:147], a[152:155], v[104:107], v[144:147]
    v_exp_f32 v232, v172
    v_mfma_f32_16x16x32_bf16 v[144:147], a[148:151], v[100:103], v[144:147]
    ds_read_b128 a[188:191], v2 offset:15360
    v_cvt_pk_bf16_f32 v219, v246, v247
    v_mfma_f32_16x16x32_bf16 v[144:147], a[144:147], v[96:99], v[144:147]
    s_waitcnt lgkmcnt(6)
    v_exp_f32 v233, v173
    v_mfma_f32_16x16x32_bf16 v[136:139], a[160:163], v[96:99], v[24:27]
    buffer_store_dwordx4 a[228:231], v229, s[8:11], s58 offen offset:256 sc1
    ds_read_b128 a[192:195], v3 offset:0
    v_mfma_f32_16x16x32_bf16 v[136:139], a[164:167], v[100:103], v[136:139]
    s_waitcnt lgkmcnt(5)
    v_add_u32 v2, s52, v1
    v_cvt_pk_bf16_f32 v220, v232, v233
    v_mfma_f32_16x16x32_bf16 v[136:139], a[168:171], v[104:107], v[136:139]
    v_exp_f32 v234, v174
    v_mfma_f32_16x16x32_bf16 v[136:139], a[172:175], v[108:111], v[136:139]
    v_exp_f32 v235, v175
    v_mfma_f32_16x16x32_bf16 v[140:143], a[172:175], v[124:127], v[28:31]
    ds_read_b128 a[196:199], v3 offset:1024
    v_or3_b32 v57, v57, v219, v220
    v_mfma_f32_16x16x32_bf16 v[140:143], a[168:171], v[120:123], v[140:143]
    v_exp_f32 v236, v188
    v_mfma_f32_16x16x32_bf16 v[140:143], a[164:167], v[116:119], v[140:143]
    ds_read_b128 a[200:203], v3 offset:2048
    v_cvt_pk_bf16_f32 v221, v234, v235
    v_mfma_f32_16x16x32_bf16 v[140:143], a[160:163], v[112:115], v[140:143]
    s_waitcnt lgkmcnt(5)
    v_exp_f32 v237, v189
    v_mfma_f32_16x16x32_bf16 v[156:159], a[176:179], v[112:115], v[44:47]
    v_exp_f32 v238, v190
    v_mfma_f32_16x16x32_bf16 v[156:159], a[180:183], v[116:119], v[156:159]
    s_waitcnt lgkmcnt(3)
    v_cvt_pk_bf16_f32 v222, v236, v237
    v_or3_b32 v57, v57, v221, v222
    v_mfma_f32_16x16x32_bf16 v[156:159], a[184:187], v[120:123], v[156:159]
    v_exp_f32 v239, v191
    v_mfma_f32_16x16x32_bf16 v[156:159], a[188:191], v[124:127], v[156:159]
    ds_read_b128 a[204:207], v3 offset:3072
    v_cvt_pk_bf16_f32 v223, v238, v239
    v_mfma_f32_16x16x32_bf16 v[152:155], a[188:191], v[108:111], v[40:43]
    v_mfma_f32_16x16x32_bf16 v[152:155], a[184:187], v[104:107], v[152:155]
    v_bitop3_b32 v57, v57, v223, s37 bitop3:0xa8
    v_cmp_ne_u32 vcc, 0, v57
    v_mfma_f32_16x16x32_bf16 v[152:155], a[180:183], v[100:103], v[152:155]
    v_mfma_f32_16x16x32_bf16 v[152:155], a[176:179], v[96:99], v[152:155]
    s_cbranch_vccnz k2_tramp_104
k2_ret_105:
    v_mfma_f32_16x16x32_bf16 v[48:51], v[60:63], v[212:215], v[48:51]
    ds_read_b128 a[208:211], v3 offset:4096
    ds_read_b128 a[212:215], v3 offset:5120
    v_mfma_f32_16x16x32_bf16 v[248:251], v[60:63], v[216:219], v[248:251]
    s_mov_b32 m0, s35
    v_exp_f32 v232, v128
    v_mfma_f32_16x16x32_bf16 v[252:255], v[60:63], v[220:223], v[252:255]
    s_waitcnt lgkmcnt(4)
    ds_read_b128 a[216:219], v3 offset:6144
    v_exp_f32 v233, v129
    v_mfma_f32_16x16x32_bf16 a[12:15], a[192:195], v[220:223], a[12:15]
    s_add_u32 s53, s53, 8192
    buffer_load_dwordx4 v1, s[20:23], s33 offen offset:0 sc1 lds
    v_mfma_f32_16x16x32_bf16 a[8:11], a[192:195], v[216:219], a[8:11]
    s_and_b32 s53, s53, 0xffff
    v_exp_f32 v234, v130
    v_cvt_pk_bf16_f32 v192, v232, v233
    v_mfma_f32_16x16x32_bf16 a[4:7], a[192:195], v[212:215], a[4:7]
    ds_read_b128 a[220:223], v3 offset:7168
    v_mfma_f32_16x16x32_bf16 a[20:23], a[196:199], v[212:215], a[20:23]
    s_add_u32 s35, s35, 0x4000
    v_exp_f32 v235, v131
    v_mfma_f32_16x16x32_bf16 a[24:27], a[196:199], v[216:219], a[24:27]
    v_exp_f32 v236, v144
    v_cvt_pk_bf16_f32 v193, v234, v235
    v_mfma_f32_16x16x32_bf16 a[28:31], a[196:199], v[220:223], a[28:31]
    s_waitcnt lgkmcnt(4)
    buffer_load_dwordx4 v1, s[20:23], s33 offen offset:1024 sc1 lds
    ds_read_b128 a[128:131], v2 offset:0
    v_mfma_f32_16x16x32_bf16 a[44:47], a[200:203], v[220:223], a[44:47]
    v_add_u32 v3, s53, v56
    v_exp_f32 v237, v145
    v_mfma_f32_16x16x32_bf16 a[40:43], a[200:203], v[216:219], a[40:43]
    ds_read_b128 a[132:135], v2 offset:1024
    v_cvt_pk_bf16_f32 v194, v236, v237
    v_mfma_f32_16x16x32_bf16 a[36:39], a[200:203], v[212:215], a[36:39]
    ds_read_b128 a[136:139], v2 offset:2048
    v_exp_f32 v238, v146
    v_mfma_f32_16x16x32_bf16 a[52:55], a[204:207], v[212:215], a[52:55]
    s_and_b32 s35, s35, 0xffff
    v_exp_f32 v239, v147
    v_mfma_f32_16x16x32_bf16 a[56:59], a[204:207], v[216:219], a[56:59]
    ds_read_b128 a[140:143], v2 offset:3072
    v_or3_b32 v57, v192, v193, v194
    v_mfma_f32_16x16x32_bf16 a[60:63], a[204:207], v[220:223], a[60:63]
    s_waitcnt lgkmcnt(6)
    v_exp_f32 v240, v132
    v_mfma_f32_16x16x32_bf16 a[76:79], a[208:211], v[220:223], a[76:79]
    s_or_b32 s35, s35, 0x10000
    buffer_load_dwordx4 v1, s[20:23], s33 offen offset:2048 sc1 lds
    ds_read_b128 a[144:147], v2 offset:4096
    v_mfma_f32_16x16x32_bf16 a[72:75], a[208:211], v[216:219], a[72:75]
    v_cvt_pk_bf16_f32 v195, v238, v239
    v_exp_f32 v241, v133
    v_mfma_f32_16x16x32_bf16 a[68:71], a[208:211], v[212:215], a[68:71]
    v_exp_f32 v242, v134
    v_mfma_f32_16x16x32_bf16 a[84:87], a[212:215], v[212:215], a[84:87]
    ds_read_b128 a[148:151], v2 offset:5120
    v_cvt_pk_bf16_f32 v196, v240, v241
    v_mfma_f32_16x16x32_bf16 a[88:91], a[212:215], v[216:219], a[88:91]
    v_exp_f32 v243, v135
    v_mfma_f32_16x16x32_bf16 a[92:95], a[212:215], v[220:223], a[92:95]
    s_waitcnt lgkmcnt(6)
    ds_read_b128 a[152:155], v2 offset:6144
    v_or3_b32 v57, v57, v195, v196
    v_cvt_pk_bf16_f32 v197, v242, v243
    v_mfma_f32_16x16x32_bf16 a[108:111], a[216:219], v[220:223], a[108:111]
    buffer_load_dwordx4 v1, s[20:23], s33 offen offset:3072 sc1 lds
    ds_read_b128 a[156:159], v2 offset:7168
    v_mfma_f32_16x16x32_bf16 a[104:107], a[216:219], v[216:219], a[104:107]
    s_add_u32 s33, s33, 0x80000
    v_exp_f32 v244, v148
    v_mfma_f32_16x16x32_bf16 a[100:103], a[216:219], v[212:215], a[100:103]
    v_exp_f32 v245, v149
    v_mfma_f32_16x16x32_bf16 a[116:119], a[220:223], v[212:215], a[116:119]
    ds_read_b128 a[160:163], v2 offset:8192
    s_cmp_ge_u32 s36, s43
    s_cbranch_scc1 k2_prep_106
k2_prepret_107:
    v_mfma_f32_16x16x32_bf16 a[120:123], a[220:223], v[216:219], a[120:123]
    v_exp_f32 v246, v150
    v_mfma_f32_16x16x32_bf16 a[124:127], a[220:223], v[220:223], a[124:127]
    s_waitcnt lgkmcnt(7)
    ds_read_b128 a[164:167], v2 offset:9216
    v_cvt_pk_bf16_f32 v198, v244, v245
    v_mfma_f32_16x16x32_bf16 v[160:163], a[128:131], v[96:99], v[16:19]
    s_waitcnt vmcnt(12)
    s_barrier
    v_exp_f32 v247, v151
    v_mfma_f32_16x16x32_bf16 v[160:163], a[132:135], v[100:103], v[160:163]
    s_waitcnt lgkmcnt(6)
    v_or3_b32 v57, v57, v197, v198
    v_cvt_pk_bf16_f32 v199, v246, v247
    v_mfma_f32_16x16x32_bf16 v[160:163], a[136:139], v[104:107], v[160:163]
    s_mov_b32 m0, s34
    ds_read_b128 a[168:171], v2 offset:10240
    v_exp_f32 v232, v136
    v_mfma_f32_16x16x32_bf16 v[160:163], a[140:143], v[108:111], v[160:163]
    s_add_u32 s36, s36, 64
    buffer_load_dwordx4 v1, s[16:19], s32 offen offset:0 sc1 lds
    ds_read_b128 a[172:175], v2 offset:11264
    v_mfma_f32_16x16x32_bf16 v[164:167], a[140:143], v[124:127], v[20:23]
    v_exp_f32 v233, v137
    v_mfma_f32_16x16x32_bf16 v[164:167], a[136:139], v[120:123], v[164:167]
    v_exp_f32 v234, v138
    v_mfma_f32_16x16x32_bf16 v[164:167], a[132:135], v[116:119], v[164:167]
    s_add_u32 s52, s52, 16384
    ds_read_b128 a[176:179], v2 offset:12288
    v_cvt_pk_bf16_f32 v200, v232, v233
    v_mfma_f32_16x16x32_bf16 v[164:167], a[128:131], v[112:115], v[164:167]
    s_waitcnt lgkmcnt(7)
    v_exp_f32 v235, v139
    v_or3_b32 v57, v57, v199, v200
    v_mfma_f32_16x16x32_bf16 v[180:183], a[144:147], v[112:115], v[36:39]
    s_add_u32 s34, s34, 0x4000
    ds_read_b128 a[180:183], v2 offset:13312
    v_cvt_pk_bf16_f32 v201, v234, v235
    v_mfma_f32_16x16x32_bf16 v[180:183], a[148:151], v[116:119], v[180:183]
    s_waitcnt lgkmcnt(6)
    v_exp_f32 v236, v152
    v_mfma_f32_16x16x32_bf16 v[180:183], a[152:155], v[120:123], v[180:183]
    s_and_b32 s52, s52, 0xffff
    buffer_load_dwordx4 v1, s[16:19], s32 offen offset:1024 sc1 lds
    ds_read_b128 a[184:187], v2 offset:14336
    v_mfma_f32_16x16x32_bf16 v[180:183], a[156:159], v[124:127], v[180:183]
    ds_read_b128 a[188:191], v2 offset:15360
    v_exp_f32 v237, v153
    v_mfma_f32_16x16x32_bf16 v[176:179], a[156:159], v[108:111], v[32:35]
    v_exp_f32 v238, v154
    v_mfma_f32_16x16x32_bf16 v[176:179], a[152:155], v[104:107], v[176:179]
    v_cvt_pk_bf16_f32 v202, v236, v237
    v_or3_b32 v57, v57, v201, v202
    v_mfma_f32_16x16x32_bf16 v[176:179], a[148:151], v[100:103], v[176:179]
    s_and_b32 s34, s34, 0xffff
    v_exp_f32 v239, v155
    v_mfma_f32_16x16x32_bf16 v[176:179], a[144:147], v[96:99], v[176:179]
    s_waitcnt lgkmcnt(6)
    v_add_u32 v2, s52, v1
    v_cvt_pk_bf16_f32 v203, v238, v239
    v_mfma_f32_16x16x32_bf16 v[168:171], a[160:163], v[96:99], v[24:27]
    ds_read_b128 a[192:195], v3 offset:0
    v_exp_f32 v240, v140
    v_mfma_f32_16x16x32_bf16 v[168:171], a[164:167], v[100:103], v[168:171]
    s_waitcnt lgkmcnt(5)
    v_exp_f32 v241, v141
    v_mfma_f32_16x16x32_bf16 v[168:171], a[168:171], v[104:107], v[168:171]
    buffer_load_dwordx4 v1, s[16:19], s32 offen offset:2048 sc1 lds
    ds_read_b128 a[196:199], v3 offset:8192
    v_mfma_f32_16x16x32_bf16 v[168:171], a[172:175], v[108:111], v[168:171]
    v_exp_f32 v242, v142
    v_mfma_f32_16x16x32_bf16 v[172:175], a[172:175], v[124:127], v[28:31]
    ds_read_b128 a[200:203], v3 offset:1024
    v_cvt_pk_bf16_f32 v204, v240, v241
    v_or3_b32 v57, v57, v203, v204
    v_mfma_f32_16x16x32_bf16 v[172:175], a[168:171], v[120:123], v[172:175]
    v_exp_f32 v243, v143
    v_mfma_f32_16x16x32_bf16 v[172:175], a[164:167], v[116:119], v[172:175]
    ds_read_b128 a[204:207], v3 offset:9216
    v_cvt_pk_bf16_f32 v205, v242, v243
    v_mfma_f32_16x16x32_bf16 v[172:175], a[160:163], v[112:115], v[172:175]
    s_waitcnt lgkmcnt(6)
    v_exp_f32 v244, v156
    v_mfma_f32_16x16x32_bf16 v[188:191], a[176:179], v[112:115], v[44:47]
    v_exp_f32 v245, v157
    v_mfma_f32_16x16x32_bf16 v[188:191], a[180:183], v[116:119], v[188:191]
    s_waitcnt lgkmcnt(4)
    buffer_load_dwordx4 v1, s[16:19], s32 offen offset:3072 sc1 lds
    ds_read_b128 a[208:211], v3 offset:2048
    ds_read_b128 a[212:215], v3 offset:10240
    v_mfma_f32_16x16x32_bf16 v[188:191], a[184:187], v[120:123], v[188:191]
    s_add_u32 s32, s32, 0x80000
    v_exp_f32 v246, v158
    v_mfma_f32_16x16x32_bf16 v[188:191], a[188:191], v[124:127], v[188:191]
    v_cvt_pk_bf16_f32 v206, v244, v245
    v_or3_b32 v57, v57, v205, v206
    v_mfma_f32_16x16x32_bf16 v[184:187], a[188:191], v[108:111], v[40:43]
    v_exp_f32 v247, v159
    v_mfma_f32_16x16x32_bf16 v[184:187], a[184:187], v[104:107], v[184:187]
    ds_read_b128 a[216:219], v3 offset:3072
    ds_read_b128 a[220:223], v3 offset:11264
    v_cvt_pk_bf16_f32 v207, v246, v247
    v_mfma_f32_16x16x32_bf16 v[184:187], a[180:183], v[100:103], v[184:187]
    v_bitop3_b32 v57, v57, v207, s37 bitop3:0xa8
    v_cmp_ne_u32 vcc, 0, v57
    v_mfma_f32_16x16x32_bf16 v[184:187], a[176:179], v[96:99], v[184:187]
    s_cbranch_vccnz k2_tramp_108
k2_ret_109:
    s_load_dwordx2 s[4:5], s[0:1], 40
    s_add_u32 s24, s6, 0x3000000
    s_addc_u32 s25, s7, 0
    s_and_b32 s25, s25, 0xffff
    s_mov_b32 s26, 0x1000000
    s_mov_b32 s27, 0x00020000
    s_lshl_b32 s31, s28, 19
    s_lshl_b32 s44, s38, 6
    s_add_u32 s44, s44, s31
    s_add_u32 s45, s44, 131072
    s_add_u32 s46, s44, 262144
    s_add_u32 s47, s44, 393216
    s_add_u32 s48, s44, 4096
    s_add_u32 s49, s44, 135168
    s_add_u32 s50, s44, 266240
    s_add_u32 s51, s44, 397312
    v_mov_b32 v13, v12
    v_mov_b32 v49, v48
    s_nop 1
    v_permlane16_swap_b32 v12, v13
    v_permlane16_swap_b32 v48, v49
    s_nop 1
    v_add_f32 v12, v12, v13
    v_add_f32 v48, v48, v49
    v_mov_b32 v13, v12
    v_mov_b32 v49, v48
    s_nop 1
    v_permlane32_swap_b32 v12, v13
    v_permlane32_swap_b32 v48, v49
    s_nop 1
    v_add_f32 v12, v12, v13
    v_add_f32 v48, v48, v49
    v_rcp_f32 v13, v12
    v_rcp_f32 v49, v48
    v_rcp_f32 v12, v12
    v_rcp_f32 v48, v48
    s_nop 0
    v_accvgpr_read_b32 v68, a0
    v_accvgpr_read_b32 v69, a1
    v_accvgpr_read_b32 v70, a2
    v_accvgpr_read_b32 v71, a3
    v_accvgpr_read_b32 v72, a16
    v_accvgpr_read_b32 v73, a17
    v_accvgpr_read_b32 v74, a18
    v_accvgpr_read_b32 v75, a19
    v_pk_mul_f32 v[68:69], v[68:69], v[12:13]
    v_pk_mul_f32 v[70:71], v[70:71], v[12:13]
    v_pk_mul_f32 v[72:73], v[72:73], v[12:13]
    v_pk_mul_f32 v[74:75], v[74:75], v[12:13]
    v_cvt_pk_bf16_f32 v64, v68, v69
    v_cvt_pk_bf16_f32 v65, v70, v71
    v_cvt_pk_bf16_f32 v66, v72, v73
    v_cvt_pk_bf16_f32 v67, v74, v75
    buffer_store_dwordx4 v[64:67], v1, s[24:27], s44 offen sc1
    v_accvgpr_read_b32 v80, a32
    v_accvgpr_read_b32 v81, a33
    v_accvgpr_read_b32 v82, a34
    v_accvgpr_read_b32 v83, a35
    v_accvgpr_read_b32 v84, a48
    v_accvgpr_read_b32 v85, a49
    v_accvgpr_read_b32 v86, a50
    v_accvgpr_read_b32 v87, a51
    v_pk_mul_f32 v[80:81], v[80:81], v[12:13]
    v_pk_mul_f32 v[82:83], v[82:83], v[12:13]
    v_pk_mul_f32 v[84:85], v[84:85], v[12:13]
    v_pk_mul_f32 v[86:87], v[86:87], v[12:13]
    v_cvt_pk_bf16_f32 v76, v80, v81
    v_cvt_pk_bf16_f32 v77, v82, v83
    v_cvt_pk_bf16_f32 v78, v84, v85
    v_cvt_pk_bf16_f32 v79, v86, v87
    buffer_store_dwordx4 v[76:79], v1, s[24:27], s45 offen sc1
    v_accvgpr_read_b32 v68, a64
    v_accvgpr_read_b32 v69, a65
    v_accvgpr_read_b32 v70, a66
    v_accvgpr_read_b32 v71, a67
    v_accvgpr_read_b32 v72, a80
    v_accvgpr_read_b32 v73, a81
    v_accvgpr_read_b32 v74, a82
    v_accvgpr_read_b32 v75, a83
    v_pk_mul_f32 v[68:69], v[68:69], v[12:13]
    v_pk_mul_f32 v[70:71], v[70:71], v[12:13]
    v_pk_mul_f32 v[72:73], v[72:73], v[12:13]
    v_pk_mul_f32 v[74:75], v[74:75], v[12:13]
    v_cvt_pk_bf16_f32 v64, v68, v69
    v_cvt_pk_bf16_f32 v65, v70, v71
    v_cvt_pk_bf16_f32 v66, v72, v73
    v_cvt_pk_bf16_f32 v67, v74, v75
    buffer_store_dwordx4 v[64:67], v1, s[24:27], s46 offen sc1
    v_accvgpr_read_b32 v80, a96
    v_accvgpr_read_b32 v81, a97
    v_accvgpr_read_b32 v82, a98
    v_accvgpr_read_b32 v83, a99
    v_accvgpr_read_b32 v84, a112
    v_accvgpr_read_b32 v85, a113
    v_accvgpr_read_b32 v86, a114
    v_accvgpr_read_b32 v87, a115
    v_pk_mul_f32 v[80:81], v[80:81], v[12:13]
    v_pk_mul_f32 v[82:83], v[82:83], v[12:13]
    v_pk_mul_f32 v[84:85], v[84:85], v[12:13]
    v_pk_mul_f32 v[86:87], v[86:87], v[12:13]
    v_cvt_pk_bf16_f32 v76, v80, v81
    v_cvt_pk_bf16_f32 v77, v82, v83
    v_cvt_pk_bf16_f32 v78, v84, v85
    v_cvt_pk_bf16_f32 v79, v86, v87
    buffer_store_dwordx4 v[76:79], v1, s[24:27], s47 offen sc1
    v_accvgpr_read_b32 v68, a4
    v_accvgpr_read_b32 v69, a5
    v_accvgpr_read_b32 v70, a6
    v_accvgpr_read_b32 v71, a7
    v_accvgpr_read_b32 v72, a20
    v_accvgpr_read_b32 v73, a21
    v_accvgpr_read_b32 v74, a22
    v_accvgpr_read_b32 v75, a23
    v_pk_mul_f32 v[68:69], v[68:69], v[48:49]
    v_pk_mul_f32 v[70:71], v[70:71], v[48:49]
    v_pk_mul_f32 v[72:73], v[72:73], v[48:49]
    v_pk_mul_f32 v[74:75], v[74:75], v[48:49]
    v_cvt_pk_bf16_f32 v64, v68, v69
    v_cvt_pk_bf16_f32 v65, v70, v71
    v_cvt_pk_bf16_f32 v66, v72, v73
    v_cvt_pk_bf16_f32 v67, v74, v75
    buffer_store_dwordx4 v[64:67], v1, s[24:27], s48 offen sc1
    v_accvgpr_read_b32 v80, a36
    v_accvgpr_read_b32 v81, a37
    v_accvgpr_read_b32 v82, a38
    v_accvgpr_read_b32 v83, a39
    v_accvgpr_read_b32 v84, a52
    v_accvgpr_read_b32 v85, a53
    v_accvgpr_read_b32 v86, a54
    v_accvgpr_read_b32 v87, a55
    v_pk_mul_f32 v[80:81], v[80:81], v[48:49]
    v_pk_mul_f32 v[82:83], v[82:83], v[48:49]
    v_pk_mul_f32 v[84:85], v[84:85], v[48:49]
    v_pk_mul_f32 v[86:87], v[86:87], v[48:49]
    v_cvt_pk_bf16_f32 v76, v80, v81
    v_cvt_pk_bf16_f32 v77, v82, v83
    v_cvt_pk_bf16_f32 v78, v84, v85
    v_cvt_pk_bf16_f32 v79, v86, v87
    buffer_store_dwordx4 v[76:79], v1, s[24:27], s49 offen sc1
    v_accvgpr_read_b32 v68, a68
    v_accvgpr_read_b32 v69, a69
    v_accvgpr_read_b32 v70, a70
    v_accvgpr_read_b32 v71, a71
    v_accvgpr_read_b32 v72, a84
    v_accvgpr_read_b32 v73, a85
    v_accvgpr_read_b32 v74, a86
    v_accvgpr_read_b32 v75, a87
    v_pk_mul_f32 v[68:69], v[68:69], v[48:49]
    v_pk_mul_f32 v[70:71], v[70:71], v[48:49]
    v_pk_mul_f32 v[72:73], v[72:73], v[48:49]
    v_pk_mul_f32 v[74:75], v[74:75], v[48:49]
    v_cvt_pk_bf16_f32 v64, v68, v69
    v_cvt_pk_bf16_f32 v65, v70, v71
    v_cvt_pk_bf16_f32 v66, v72, v73
    v_cvt_pk_bf16_f32 v67, v74, v75
    buffer_store_dwordx4 v[64:67], v1, s[24:27], s50 offen sc1
    v_accvgpr_read_b32 v80, a100
    v_accvgpr_read_b32 v81, a101
    v_accvgpr_read_b32 v82, a102
    v_accvgpr_read_b32 v83, a103
    v_accvgpr_read_b32 v84, a116
    v_accvgpr_read_b32 v85, a117
    v_accvgpr_read_b32 v86, a118
    v_accvgpr_read_b32 v87, a119
    v_pk_mul_f32 v[80:81], v[80:81], v[48:49]
    v_pk_mul_f32 v[82:83], v[82:83], v[48:49]
    v_pk_mul_f32 v[84:85], v[84:85], v[48:49]
    v_pk_mul_f32 v[86:87], v[86:87], v[48:49]
    v_cvt_pk_bf16_f32 v76, v80, v81
    v_cvt_pk_bf16_f32 v77, v82, v83
    v_cvt_pk_bf16_f32 v78, v84, v85
    v_cvt_pk_bf16_f32 v79, v86, v87
    buffer_store_dwordx4 v[76:79], v1, s[24:27], s51 offen sc1
    s_nop 1
    s_lshr_b32 s31, s2, 3
    s_bfe_u32 s56, s2, 0x10002
    s_and_b32 s54, s2, 1
    s_and_b32 s55, s31, 7
    s_lshl_b32 s54, s54, 3
    s_add_u32 s54, s54, s55
    s_and_b32 s55, s2, 2
    s_lshl_b32 s55, s55, 1
    s_lshr_b32 s31, s31, 3
    s_add_u32 s55, s55, s31
    v_lshrrev_b32 v87, 4, v1
    v_lshrrev_b32 v72, 4, v87
    s_lshl_b32 s57, s54, 7
    s_lshl_b32 s31, s30, 5
    s_add_u32 s57, s57, s31
    s_lshl_b32 s31, s57, 6
    v_add_u32 v88, s31, v1
    v_add_u32 v89, 0x20000, v88
    v_bfe_u32 v84, v87, 1, 3
    v_xor_b32 v84, v84, v72
    v_and_b32 v85, 16, v1
    v_lshl_add_u32 v85, v72, 11, v85
    s_lshl_b32 s31, s30, 15
    s_lshl_b32 s58, s55, 8
    s_add_u32 s31, s31, s58
    v_add_u32 v85, s31, v85
    v_xor_b32 v86, 0, v84
    v_lshl_add_u32 v86, v86, 5, v85
    v_add_u32 v90, 0, v86
    v_xor_b32 v86, 4, v84
    v_lshl_add_u32 v86, v86, 5, v85
    v_add_u32 v91, 7168, v86
    v_xor_b32 v86, 0, v84
    v_lshl_add_u32 v86, v86, 5, v85
    v_add_u32 v92, 14336, v86
    v_xor_b32 v86, 4, v84
    v_lshl_add_u32 v86, v86, 5, v85
    v_add_u32 v93, 21504, v86
    v_and_b32 v84, 15, v87
    v_add_u32 v85, s57, v84
    v_lshlrev_b32 v77, 2, v85
    v_lshl_add_u32 v77, v72, 13, v77
    s_lshl_b32 s31, s56, 7
    s_add_u32 s58, s58, s31
    v_lshl_add_u32 v80, v72, 3, s58
    v_lshl_add_u32 v78, v85, 11, v80
    v_add_u32 v79, 0x8000, v78
    v_lshrrev_b32 v85, 2, v84
    v_lshl_add_u32 v85, v72, 2, v85
    v_and_b32 v84, 7, v85
    s_lshl_b32 s31, s56, 2
    v_xor_b32 v84, s31, v84
    v_lshlrev_b32 v85, 8, v85
    v_and_b32 v86, 3, v87
    v_lshl_add_u32 v85, v86, 3, v85
    s_add_u32 s31, s2, 1
    s_and_b32 s31, s31, 3
    v_add_u32 v73, s31, v86
    v_and_b32 v73, 3, v73
    v_lshlrev_b32 v73, 7, v73
    v_xor_b32 v86, 0, v84
    v_lshl_add_u32 v64, v86, 5, v85
    v_xor_b32 v86, 1, v84
    v_lshl_add_u32 v65, v86, 5, v85
    v_xor_b32 v86, 2, v84
    v_lshl_add_u32 v66, v86, 5, v85
    v_xor_b32 v86, 3, v84
    v_lshl_add_u32 v67, v86, 5, v85
    v_xor_b32 v86, 4, v84
    v_lshl_add_u32 v68, v86, 5, v85
    v_xor_b32 v86, 5, v84
    v_lshl_add_u32 v69, v86, 5, v85
    v_xor_b32 v86, 6, v84
    v_lshl_add_u32 v70, v86, 5, v85
    v_xor_b32 v86, 7, v84
    v_lshl_add_u32 v71, v86, 5, v85
    s_lshl_b32 s61, s31, 20
    s_lshl_b32 s62, s31, 21
    s_lshl_b32 s60, s30, 12
    s_lshl_b32 s59, s54, 10
    s_lshl_b32 s31, s56, 9
    s_add_u32 s59, s59, s31
    s_lshr_b32 s31, s28, 2
    s_lshl_b32 s31, s31, 7
    s_lshl_b32 s57, s29, 10
    s_sub_u32 s58, 0x3c00, s57
    s_add_u32 s57, s57, s31
    s_add_u32 s58, s58, s31
    v_mov_b32 v75, 0
    v_mov_b32 v76, 1
    s_lshl_b32 s31, s56, 23
    s_add_u32 s31, s31, 0x3000000
    s_add_u32 s8, s6, s31
    s_addc_u32 s9, s7, 0
    s_and_b32 s9, s9, 0xffff
    s_mov_b32 s10, 0x800000
    s_lshl_b32 s31, s56, 22
    s_waitcnt lgkmcnt(0)
    s_add_u32 s12, s4, s31
    s_addc_u32 s13, s5, 0
    s_and_b32 s13, s13, 0xffff
    s_mov_b32 s14, 0x400000
    s_load_dwordx2 s[4:5], s[0:1], 80
    v_mov_b32 v12, -1
    v_mov_b32 v13, -1
    v_mov_b32 v14, -1
    v_mov_b32 v15, -1
    s_waitcnt lgkmcnt(0)
    s_mov_b32 s26, -1
    s_lshl_b32 s31, s2, 14
    s_add_u32 s31, s31, s60
    s_add_u32 s40, s31, 0x2000000
    buffer_store_dwordx4 v[12:15], v1, s[24:27], s40 offen offset:0 sc1
    buffer_store_dwordx4 v[12:15], v1, s[24:27], s40 offen offset:1024 sc1
    buffer_store_dwordx4 v[12:15], v1, s[24:27], s40 offen offset:2048 sc1
    buffer_store_dwordx4 v[12:15], v1, s[24:27], s40 offen offset:3072 sc1
    s_lshr_b32 s31, s31, 2
    s_add_u32 s40, s31, 0x1900000
    buffer_store_dwordx4 v[12:15], v1, s[24:27], s40 offen sc1
    s_mov_b32 s26, 0x1000000
    s_and_b32 s31, s2, 7
    s_mul_i32 s31, s31, 28
    s_lshr_b32 s40, s2, 3
    s_add_u32 s31, s31, s40
    s_lshl_b32 s31, s31, 15
    s_lshl_b32 s40, s30, 13
    s_add_u32 s31, s31, s40
    s_mov_b32 s44, s4
    s_mov_b32 s47, 0x00020000
    s_and_b32 s45, s5, 0xffff
    s_cmp_ge_u32 s2, 224
    s_cselect_b32 s46, 0, 7340032
    s_add_u32 m0, s40, 131072
    s_nop 0
    buffer_load_dwordx4 v1, s[44:47], s31 offen offset:0 lds
    buffer_load_dwordx4 v1, s[44:47], s31 offen offset:1024 lds
    buffer_load_dwordx4 v1, s[44:47], s31 offen offset:2048 lds
    buffer_load_dwordx4 v1, s[44:47], s31 offen offset:3072 lds
    s_add_u32 s31, s31, 4096
    s_add_u32 m0, s40, 135168
    s_nop 0
    buffer_load_dwordx4 v1, s[44:47], s31 offen offset:0 lds
    buffer_load_dwordx4 v1, s[44:47], s31 offen offset:1024 lds
    buffer_load_dwordx4 v1, s[44:47], s31 offen offset:2048 lds
    buffer_load_dwordx4 v1, s[44:47], s31 offen offset:3072 lds
    s_add_u32 s31, s31, 4096
    s_lshl_b32 s63, s29, 1
    s_sub_u32 s63, 13, s63
    s_cbranch_scc1 k2_sdone_111
k2_sloop_110:
    v_mfma_f32_16x16x32_bf16 v[248:251], v[60:63], v[192:195], v[248:251]
    v_exp_f32 v232, v160
    v_mfma_f32_16x16x32_bf16 v[248:251], v[60:63], v[200:203], v[248:251]
    s_mov_b32 m0, s35
    ds_read_b128 a[224:227], v3 offset:4096
    v_mfma_f32_16x16x32_bf16 v[252:255], v[60:63], v[204:207], v[252:255]
    s_add_u32 s53, s53, 16384
    buffer_load_dwordx4 v1, s[20:23], s33 offen offset:0 sc1 lds
    ds_read_b128 a[228:231], v3 offset:12288
    v_mfma_f32_16x16x32_bf16 v[252:255], v[60:63], v[196:199], v[252:255]
    s_waitcnt lgkmcnt(8)
    v_exp_f32 v233, v161
    v_mfma_f32_16x16x32_bf16 a[12:15], a[192:195], v[196:199], a[12:15]
    s_and_b32 s53, s53, 0xffff
    v_exp_f32 v234, v162
    v_mfma_f32_16x16x32_bf16 a[12:15], a[196:199], v[204:207], a[12:15]
    ds_read_b128 a[232:235], v3 offset:5120
    v_cvt_pk_bf16_f32 v208, v232, v233
    v_mfma_f32_16x16x32_bf16 a[8:11], a[196:199], v[200:203], a[8:11]
    v_exp_f32 v235, v163
    v_mfma_f32_16x16x32_bf16 a[8:11], a[192:195], v[192:195], a[8:11]
    s_waitcnt lgkmcnt(7)
    ds_read_b128 a[236:239], v3 offset:13312
    v_cvt_pk_bf16_f32 v209, v234, v235
    v_mfma_f32_16x16x32_bf16 a[24:27], a[200:203], v[192:195], a[24:27]
    s_add_u32 s35, s35, 0x4000
    v_exp_f32 v236, v176
    v_mfma_f32_16x16x32_bf16 a[24:27], a[204:207], v[200:203], a[24:27]
    buffer_load_dwordx4 v1, s[20:23], s33 offen offset:1024 sc1 lds
    ds_read_b128 a[240:243], v3 offset:6144
    v_mfma_f32_16x16x32_bf16 a[28:31], a[204:207], v[204:207], a[28:31]
    v_exp_f32 v237, v177
    v_mfma_f32_16x16x32_bf16 a[28:31], a[200:203], v[196:199], a[28:31]
    s_waitcnt lgkmcnt(7)
    ds_read_b128 a[244:247], v3 offset:14336
    v_cvt_pk_bf16_f32 v210, v236, v237
    v_mfma_f32_16x16x32_bf16 a[44:47], a[208:211], v[196:199], a[44:47]
    v_exp_f32 v238, v178
    v_mfma_f32_16x16x32_bf16 a[44:47], a[212:215], v[204:207], a[44:47]
    ds_read_b128 a[248:251], v3 offset:7168
    v_or3_b32 v57, v208, v209, v210
    v_mfma_f32_16x16x32_bf16 a[40:43], a[212:215], v[200:203], a[40:43]
    v_exp_f32 v239, v179
    v_mfma_f32_16x16x32_bf16 a[40:43], a[208:211], v[192:195], a[40:43]
    s_waitcnt lgkmcnt(7)
    ds_read_b128 a[252:255], v3 offset:15360
    v_cvt_pk_bf16_f32 v211, v238, v239
    v_mfma_f32_16x16x32_bf16 a[56:59], a[216:219], v[192:195], a[56:59]
    s_and_b32 s35, s35, 0xffff
    v_exp_f32 v240, v164
    v_mfma_f32_16x16x32_bf16 a[56:59], a[220:223], v[200:203], a[56:59]
    ds_read_b128 a[128:131], v2 offset:0
    v_add_u32 v3, s53, v56
    v_mfma_f32_16x16x32_bf16 a[60:63], a[220:223], v[204:207], a[60:63]
    v_exp_f32 v241, v165
    v_mfma_f32_16x16x32_bf16 a[60:63], a[216:219], v[196:199], a[60:63]
    s_waitcnt lgkmcnt(7)
    buffer_load_dwordx4 v1, s[20:23], s33 offen offset:2048 sc1 lds
    ds_read_b128 a[132:135], v2 offset:1024
    v_mfma_f32_16x16x32_bf16 a[76:79], a[224:227], v[196:199], a[76:79]
    v_exp_f32 v242, v166
    v_mfma_f32_16x16x32_bf16 a[76:79], a[228:231], v[204:207], a[76:79]
    s_or_b32 s35, s35, 0x10000
    ds_read_b128 a[136:139], v2 offset:2048
    v_cvt_pk_bf16_f32 v212, v240, v241
    v_mfma_f32_16x16x32_bf16 a[72:75], a[228:231], v[200:203], a[72:75]
    v_exp_f32 v243, v167
    v_mfma_f32_16x16x32_bf16 a[72:75], a[224:227], v[192:195], a[72:75]
    s_waitcnt lgkmcnt(7)
    ds_read_b128 a[140:143], v2 offset:3072
    v_or3_b32 v57, v57, v211, v212
    v_mfma_f32_16x16x32_bf16 a[88:91], a[232:235], v[192:195], a[88:91]
    v_exp_f32 v244, v180
    v_mfma_f32_16x16x32_bf16 a[88:91], a[236:239], v[200:203], a[88:91]
    ds_read_b128 a[144:147], v2 offset:4096
    v_cvt_pk_bf16_f32 v213, v242, v243
    v_mfma_f32_16x16x32_bf16 a[92:95], a[236:239], v[204:207], a[92:95]
    v_exp_f32 v245, v181
    v_mfma_f32_16x16x32_bf16 a[92:95], a[232:235], v[196:199], a[92:95]
    s_waitcnt lgkmcnt(7)
    buffer_load_dwordx4 v1, s[20:23], s33 offen offset:3072 sc1 lds
    ds_read_b128 a[148:151], v2 offset:5120
    v_mfma_f32_16x16x32_bf16 a[108:111], a[240:243], v[196:199], a[108:111]
    s_add_u32 s33, s33, 0x80000
    v_exp_f32 v246, v182
    v_mfma_f32_16x16x32_bf16 a[108:111], a[244:247], v[204:207], a[108:111]
    ds_read_b128 a[152:155], v2 offset:6144
    v_cvt_pk_bf16_f32 v214, v244, v245
    v_mfma_f32_16x16x32_bf16 a[104:107], a[244:247], v[200:203], a[104:107]
    v_exp_f32 v247, v183
    v_mfma_f32_16x16x32_bf16 a[104:107], a[240:243], v[192:195], a[104:107]
    s_waitcnt lgkmcnt(7)
    ds_read_b128 a[156:159], v2 offset:7168
    v_or3_b32 v57, v57, v213, v214
    v_mfma_f32_16x16x32_bf16 a[120:123], a[248:251], v[192:195], a[120:123]
    v_exp_f32 v232, v168
    v_mfma_f32_16x16x32_bf16 a[120:123], a[252:255], v[200:203], a[120:123]
    ds_read_b128 a[160:163], v2 offset:8192
    v_cvt_pk_bf16_f32 v215, v246, v247
    v_mfma_f32_16x16x32_bf16 a[124:127], a[252:255], v[204:207], a[124:127]
    v_exp_f32 v233, v169
    v_mfma_f32_16x16x32_bf16 a[124:127], a[248:251], v[196:199], a[124:127]
    s_waitcnt lgkmcnt(7)
    ds_read_b128 a[164:167], v2 offset:9216
    v_cvt_pk_bf16_f32 v216, v232, v233
    v_mfma_f32_16x16x32_bf16 v[128:131], a[128:131], v[96:99], v[16:19]
    s_waitcnt vmcnt(12)
    s_barrier
    v_exp_f32 v234, v170
    v_mfma_f32_16x16x32_bf16 v[128:131], a[132:135], v[100:103], v[128:131]
    s_waitcnt lgkmcnt(6)
    ds_read_b128 a[168:171], v2 offset:10240
    v_or3_b32 v57, v57, v215, v216
    v_mfma_f32_16x16x32_bf16 v[128:131], a[136:139], v[104:107], v[128:131]
    s_mov_b32 m0, s34
    v_exp_f32 v235, v171
    v_mfma_f32_16x16x32_bf16 v[128:131], a[140:143], v[108:111], v[128:131]
    s_add_u32 s36, s36, 64
    buffer_load_dwordx4 v1, s[16:19], s32 offen offset:0 sc1 lds
    ds_read_b128 a[172:175], v2 offset:11264
    v_mfma_f32_16x16x32_bf16 v[132:135], a[140:143], v[124:127], v[20:23]
    v_exp_f32 v236, v184
    v_mfma_f32_16x16x32_bf16 v[132:135], a[136:139], v[120:123], v[132:135]
    ds_read_b128 a[176:179], v2 offset:12288
    v_cvt_pk_bf16_f32 v217, v234, v235
    v_mfma_f32_16x16x32_bf16 v[132:135], a[132:135], v[116:119], v[132:135]
    s_add_u32 s52, s52, 16384
    v_exp_f32 v237, v185
    v_mfma_f32_16x16x32_bf16 v[132:135], a[128:131], v[112:115], v[132:135]
    s_waitcnt lgkmcnt(7)
    ds_read_b128 a[180:183], v2 offset:13312
    v_cvt_pk_bf16_f32 v218, v236, v237
    v_mfma_f32_16x16x32_bf16 v[148:151], a[144:147], v[112:115], v[36:39]
    s_add_u32 s34, s34, 0x4000
    v_exp_f32 v238, v186
    v_mfma_f32_16x16x32_bf16 v[148:151], a[148:151], v[116:119], v[148:151]
    s_waitcnt lgkmcnt(6)
    buffer_load_dwordx4 v1, s[16:19], s32 offen offset:1024 sc1 lds
    ds_read_b128 a[184:187], v2 offset:14336
    v_mfma_f32_16x16x32_bf16 v[148:151], a[152:155], v[120:123], v[148:151]
    s_and_b32 s52, s52, 0xffff
    v_exp_f32 v239, v187
    v_mfma_f32_16x16x32_bf16 v[148:151], a[156:159], v[124:127], v[148:151]
    ds_read_b128 a[188:191], v2 offset:15360
    v_or3_b32 v57, v57, v217, v218
    v_mfma_f32_16x16x32_bf16 v[144:147], a[156:159], v[108:111], v[32:35]
    v_exp_f32 v240, v172
    v_mfma_f32_16x16x32_bf16 v[144:147], a[152:155], v[104:107], v[144:147]
    v_cvt_pk_bf16_f32 v219, v238, v239
    v_add_u32 v2, s52, v1
    v_mfma_f32_16x16x32_bf16 v[144:147], a[148:151], v[100:103], v[144:147]
    s_and_b32 s34, s34, 0xffff
    v_exp_f32 v241, v173
    v_mfma_f32_16x16x32_bf16 v[144:147], a[144:147], v[96:99], v[144:147]
    s_waitcnt lgkmcnt(6)
    ds_read_b128 a[192:195], v3 offset:0
    v_cvt_pk_bf16_f32 v220, v240, v241
    v_mfma_f32_16x16x32_bf16 v[136:139], a[160:163], v[96:99], v[24:27]
    v_exp_f32 v242, v174
    v_mfma_f32_16x16x32_bf16 v[136:139], a[164:167], v[100:103], v[136:139]
    s_waitcnt lgkmcnt(5)
    buffer_load_dwordx4 v1, s[16:19], s32 offen offset:2048 sc1 lds
    ds_read_b128 a[196:199], v3 offset:8192
    v_mfma_f32_16x16x32_bf16 v[136:139], a[168:171], v[104:107], v[136:139]
    v_exp_f32 v243, v175
    v_mfma_f32_16x16x32_bf16 v[136:139], a[172:175], v[108:111], v[136:139]
    ds_read_b128 a[200:203], v3 offset:1024
    v_or3_b32 v57, v57, v219, v220
    v_mfma_f32_16x16x32_bf16 v[140:143], a[172:175], v[124:127], v[28:31]
    v_exp_f32 v244, v188
    v_mfma_f32_16x16x32_bf16 v[140:143], a[168:171], v[120:123], v[140:143]
    ds_read_b128 a[204:207], v3 offset:9216
    v_cvt_pk_bf16_f32 v221, v242, v243
    v_mfma_f32_16x16x32_bf16 v[140:143], a[164:167], v[116:119], v[140:143]
    v_exp_f32 v245, v189
    v_mfma_f32_16x16x32_bf16 v[140:143], a[160:163], v[112:115], v[140:143]
    s_waitcnt lgkmcnt(6)
    buffer_load_dwordx4 v1, s[16:19], s32 offen offset:3072 sc1 lds
    ds_read_b128 a[208:211], v3 offset:2048
    v_mfma_f32_16x16x32_bf16 v[156:159], a[176:179], v[112:115], v[44:47]
    s_add_u32 s32, s32, 0x80000
    v_exp_f32 v246, v190
    v_mfma_f32_16x16x32_bf16 v[156:159], a[180:183], v[116:119], v[156:159]
    s_waitcnt lgkmcnt(5)
    ds_read_b128 a[212:215], v3 offset:10240
    v_cvt_pk_bf16_f32 v222, v244, v245
    v_mfma_f32_16x16x32_bf16 v[156:159], a[184:187], v[120:123], v[156:159]
    v_exp_f32 v247, v191
    v_mfma_f32_16x16x32_bf16 v[156:159], a[188:191], v[124:127], v[156:159]
    ds_read_b128 a[216:219], v3 offset:3072
    v_or3_b32 v57, v57, v221, v222
    v_mfma_f32_16x16x32_bf16 v[152:155], a[188:191], v[108:111], v[40:43]
    ds_read_b128 a[220:223], v3 offset:11264
    v_cvt_pk_bf16_f32 v223, v246, v247
    v_mfma_f32_16x16x32_bf16 v[152:155], a[184:187], v[104:107], v[152:155]
    v_bitop3_b32 v57, v57, v223, s37 bitop3:0xa8
    v_cmp_ne_u32 vcc, 0, v57
    v_mfma_f32_16x16x32_bf16 v[152:155], a[180:183], v[100:103], v[152:155]
    v_mfma_f32_16x16x32_bf16 v[152:155], a[176:179], v[96:99], v[152:155]
    s_cbranch_vccnz k2_tramp_112
k2_ret_113:
    v_mfma_f32_16x16x32_bf16 v[248:251], v[60:63], v[208:211], v[248:251]
    v_exp_f32 v232, v128
    v_mfma_f32_16x16x32_bf16 v[248:251], v[60:63], v[216:219], v[248:251]
    s_mov_b32 m0, s35
    ds_read_b128 a[224:227], v3 offset:4096
    v_mfma_f32_16x16x32_bf16 v[252:255], v[60:63], v[220:223], v[252:255]
    s_add_u32 s53, s53, 16384
    buffer_load_dwordx4 v1, s[20:23], s33 offen offset:0 sc1 lds
    ds_read_b128 a[228:231], v3 offset:12288
    v_mfma_f32_16x16x32_bf16 v[252:255], v[60:63], v[212:215], v[252:255]
    s_waitcnt lgkmcnt(8)
    v_exp_f32 v233, v129
    v_mfma_f32_16x16x32_bf16 a[12:15], a[192:195], v[212:215], a[12:15]
    s_and_b32 s53, s53, 0xffff
    v_exp_f32 v234, v130
    v_mfma_f32_16x16x32_bf16 a[12:15], a[196:199], v[220:223], a[12:15]
    ds_read_b128 a[232:235], v3 offset:5120
    v_cvt_pk_bf16_f32 v192, v232, v233
    v_mfma_f32_16x16x32_bf16 a[8:11], a[196:199], v[216:219], a[8:11]
    v_exp_f32 v235, v131
    v_mfma_f32_16x16x32_bf16 a[8:11], a[192:195], v[208:211], a[8:11]
    s_waitcnt lgkmcnt(7)
    ds_read_b128 a[236:239], v3 offset:13312
    v_cvt_pk_bf16_f32 v193, v234, v235
    v_mfma_f32_16x16x32_bf16 a[24:27], a[200:203], v[208:211], a[24:27]
    s_add_u32 s35, s35, 0x4000
    v_exp_f32 v236, v144
    v_mfma_f32_16x16x32_bf16 a[24:27], a[204:207], v[216:219], a[24:27]
    buffer_load_dwordx4 v1, s[20:23], s33 offen offset:1024 sc1 lds
    ds_read_b128 a[240:243], v3 offset:6144
    v_mfma_f32_16x16x32_bf16 a[28:31], a[204:207], v[220:223], a[28:31]
    v_exp_f32 v237, v145
    v_mfma_f32_16x16x32_bf16 a[28:31], a[200:203], v[212:215], a[28:31]
    s_waitcnt lgkmcnt(7)
    ds_read_b128 a[244:247], v3 offset:14336
    v_cvt_pk_bf16_f32 v194, v236, v237
    v_mfma_f32_16x16x32_bf16 a[44:47], a[208:211], v[212:215], a[44:47]
    v_exp_f32 v238, v146
    v_mfma_f32_16x16x32_bf16 a[44:47], a[212:215], v[220:223], a[44:47]
    ds_read_b128 a[248:251], v3 offset:7168
    v_or3_b32 v57, v192, v193, v194
    v_mfma_f32_16x16x32_bf16 a[40:43], a[212:215], v[216:219], a[40:43]
    v_exp_f32 v239, v147
    v_mfma_f32_16x16x32_bf16 a[40:43], a[208:211], v[208:211], a[40:43]
    s_waitcnt lgkmcnt(7)
    ds_read_b128 a[252:255], v3 offset:15360
    v_cvt_pk_bf16_f32 v195, v238, v239
    v_mfma_f32_16x16x32_bf16 a[56:59], a[216:219], v[208:211], a[56:59]
    s_and_b32 s35, s35, 0xffff
    v_exp_f32 v240, v132
    v_mfma_f32_16x16x32_bf16 a[56:59], a[220:223], v[216:219], a[56:59]
    ds_read_b128 a[128:131], v2 offset:0
    v_add_u32 v3, s53, v56
    v_mfma_f32_16x16x32_bf16 a[60:63], a[220:223], v[220:223], a[60:63]
    v_exp_f32 v241, v133
    v_mfma_f32_16x16x32_bf16 a[60:63], a[216:219], v[212:215], a[60:63]
    s_waitcnt lgkmcnt(7)
    buffer_load_dwordx4 v1, s[20:23], s33 offen offset:2048 sc1 lds
    ds_read_b128 a[132:135], v2 offset:1024
    v_mfma_f32_16x16x32_bf16 a[76:79], a[224:227], v[212:215], a[76:79]
    v_exp_f32 v242, v134
    v_mfma_f32_16x16x32_bf16 a[76:79], a[228:231], v[220:223], a[76:79]
    s_or_b32 s35, s35, 0x10000
    ds_read_b128 a[136:139], v2 offset:2048
    v_cvt_pk_bf16_f32 v196, v240, v241
    v_mfma_f32_16x16x32_bf16 a[72:75], a[228:231], v[216:219], a[72:75]
    v_exp_f32 v243, v135
    v_mfma_f32_16x16x32_bf16 a[72:75], a[224:227], v[208:211], a[72:75]
    s_waitcnt lgkmcnt(7)
    ds_read_b128 a[140:143], v2 offset:3072
    v_or3_b32 v57, v57, v195, v196
    v_mfma_f32_16x16x32_bf16 a[88:91], a[232:235], v[208:211], a[88:91]
    v_exp_f32 v244, v148
    v_mfma_f32_16x16x32_bf16 a[88:91], a[236:239], v[216:219], a[88:91]
    ds_read_b128 a[144:147], v2 offset:4096
    v_cvt_pk_bf16_f32 v197, v242, v243
    v_mfma_f32_16x16x32_bf16 a[92:95], a[236:239], v[220:223], a[92:95]
    v_exp_f32 v245, v149
    v_mfma_f32_16x16x32_bf16 a[92:95], a[232:235], v[212:215], a[92:95]
    s_waitcnt lgkmcnt(7)
    buffer_load_dwordx4 v1, s[20:23], s33 offen offset:3072 sc1 lds
    ds_read_b128 a[148:151], v2 offset:5120
    v_mfma_f32_16x16x32_bf16 a[108:111], a[240:243], v[212:215], a[108:111]
    s_add_u32 s33, s33, 0x80000
    v_exp_f32 v246, v150
    v_mfma_f32_16x16x32_bf16 a[108:111], a[244:247], v[220:223], a[108:111]
    ds_read_b128 a[152:155], v2 offset:6144
    v_cvt_pk_bf16_f32 v198, v244, v245
    v_mfma_f32_16x16x32_bf16 a[104:107], a[244:247], v[216:219], a[104:107]
    v_exp_f32 v247, v151
    v_mfma_f32_16x16x32_bf16 a[104:107], a[240:243], v[208:211], a[104:107]
    s_waitcnt lgkmcnt(7)
    ds_read_b128 a[156:159], v2 offset:7168
    v_or3_b32 v57, v57, v197, v198
    v_mfma_f32_16x16x32_bf16 a[120:123], a[248:251], v[208:211], a[120:123]
    v_exp_f32 v232, v136
    v_mfma_f32_16x16x32_bf16 a[120:123], a[252:255], v[216:219], a[120:123]
    ds_read_b128 a[160:163], v2 offset:8192
    v_cvt_pk_bf16_f32 v199, v246, v247
    v_mfma_f32_16x16x32_bf16 a[124:127], a[252:255], v[220:223], a[124:127]
    v_exp_f32 v233, v137
    v_mfma_f32_16x16x32_bf16 a[124:127], a[248:251], v[212:215], a[124:127]
    s_waitcnt lgkmcnt(7)
    ds_read_b128 a[164:167], v2 offset:9216
    v_cvt_pk_bf16_f32 v200, v232, v233
    v_mfma_f32_16x16x32_bf16 v[160:163], a[128:131], v[96:99], v[16:19]
    s_waitcnt vmcnt(12)
    s_barrier
    v_exp_f32 v234, v138
    v_mfma_f32_16x16x32_bf16 v[160:163], a[132:135], v[100:103], v[160:163]
    s_waitcnt lgkmcnt(6)
    ds_read_b128 a[168:171], v2 offset:10240
    v_or3_b32 v57, v57, v199, v200
    v_mfma_f32_16x16x32_bf16 v[160:163], a[136:139], v[104:107], v[160:163]
    s_mov_b32 m0, s34
    v_exp_f32 v235, v139
    v_mfma_f32_16x16x32_bf16 v[160:163], a[140:143], v[108:111], v[160:163]
    s_add_u32 s36, s36, 64
    buffer_load_dwordx4 v1, s[16:19], s32 offen offset:0 sc1 lds
    ds_read_b128 a[172:175], v2 offset:11264
    v_mfma_f32_16x16x32_bf16 v[164:167], a[140:143], v[124:127], v[20:23]
    v_exp_f32 v236, v152
    v_mfma_f32_16x16x32_bf16 v[164:167], a[136:139], v[120:123], v[164:167]
    ds_read_b128 a[176:179], v2 offset:12288
    v_cvt_pk_bf16_f32 v201, v234, v235
    v_mfma_f32_16x16x32_bf16 v[164:167], a[132:135], v[116:119], v[164:167]
    s_add_u32 s52, s52, 16384
    v_exp_f32 v237, v153
    v_mfma_f32_16x16x32_bf16 v[164:167], a[128:131], v[112:115], v[164:167]
    s_waitcnt lgkmcnt(7)
    ds_read_b128 a[180:183], v2 offset:13312
    v_cvt_pk_bf16_f32 v202, v236, v237
    v_mfma_f32_16x16x32_bf16 v[180:183], a[144:147], v[112:115], v[36:39]
    s_add_u32 s34, s34, 0x4000
    v_exp_f32 v238, v154
    v_mfma_f32_16x16x32_bf16 v[180:183], a[148:151], v[116:119], v[180:183]
    s_waitcnt lgkmcnt(6)
    buffer_load_dwordx4 v1, s[16:19], s32 offen offset:1024 sc1 lds
    ds_read_b128 a[184:187], v2 offset:14336
    v_mfma_f32_16x16x32_bf16 v[180:183], a[152:155], v[120:123], v[180:183]
    s_and_b32 s52, s52, 0xffff
    v_exp_f32 v239, v155
    v_mfma_f32_16x16x32_bf16 v[180:183], a[156:159], v[124:127], v[180:183]
    ds_read_b128 a[188:191], v2 offset:15360
    v_or3_b32 v57, v57, v201, v202
    v_mfma_f32_16x16x32_bf16 v[176:179], a[156:159], v[108:111], v[32:35]
    v_exp_f32 v240, v140
    v_mfma_f32_16x16x32_bf16 v[176:179], a[152:155], v[104:107], v[176:179]
    v_cvt_pk_bf16_f32 v203, v238, v239
    v_add_u32 v2, s52, v1
    v_mfma_f32_16x16x32_bf16 v[176:179], a[148:151], v[100:103], v[176:179]
    s_and_b32 s34, s34, 0xffff
    v_exp_f32 v241, v141
    v_mfma_f32_16x16x32_bf16 v[176:179], a[144:147], v[96:99], v[176:179]
    s_waitcnt lgkmcnt(6)
    ds_read_b128 a[192:195], v3 offset:0
    v_cvt_pk_bf16_f32 v204, v240, v241
    v_mfma_f32_16x16x32_bf16 v[168:171], a[160:163], v[96:99], v[24:27]
    v_exp_f32 v242, v142
    v_mfma_f32_16x16x32_bf16 v[168:171], a[164:167], v[100:103], v[168:171]
    s_waitcnt lgkmcnt(5)
    buffer_load_dwordx4 v1, s[16:19], s32 offen offset:2048 sc1 lds
    ds_read_b128 a[196:199], v3 offset:8192
    v_mfma_f32_16x16x32_bf16 v[168:171], a[168:171], v[104:107], v[168:171]
    v_exp_f32 v243, v143
    v_mfma_f32_16x16x32_bf16 v[168:171], a[172:175], v[108:111], v[168:171]
    ds_read_b128 a[200:203], v3 offset:1024
    v_or3_b32 v57, v57, v203, v204
    v_mfma_f32_16x16x32_bf16 v[172:175], a[172:175], v[124:127], v[28:31]
    v_exp_f32 v244, v156
    v_mfma_f32_16x16x32_bf16 v[172:175], a[168:171], v[120:123], v[172:175]
    ds_read_b128 a[204:207], v3 offset:9216
    v_cvt_pk_bf16_f32 v205, v242, v243
    v_mfma_f32_16x16x32_bf16 v[172:175], a[164:167], v[116:119], v[172:175]
    v_exp_f32 v245, v157
    v_mfma_f32_16x16x32_bf16 v[172:175], a[160:163], v[112:115], v[172:175]
    s_waitcnt lgkmcnt(6)
    buffer_load_dwordx4 v1, s[16:19], s32 offen offset:3072 sc1 lds
    ds_read_b128 a[208:211], v3 offset:2048
    v_mfma_f32_16x16x32_bf16 v[188:191], a[176:179], v[112:115], v[44:47]
    s_sub_u32 s63, s63, 1
    v_exp_f32 v246, v158
    v_mfma_f32_16x16x32_bf16 v[188:191], a[180:183], v[116:119], v[188:191]
    s_waitcnt lgkmcnt(5)
    ds_read_b128 a[212:215], v3 offset:10240
    v_cvt_pk_bf16_f32 v206, v244, v245
    v_mfma_f32_16x16x32_bf16 v[188:191], a[184:187], v[120:123], v[188:191]
    s_add_u32 s32, s32, 0x80000
    v_exp_f32 v247, v159
    v_mfma_f32_16x16x32_bf16 v[188:191], a[188:191], v[124:127], v[188:191]
    ds_read_b128 a[216:219], v3 offset:3072
    v_or3_b32 v57, v57, v205, v206
    v_mfma_f32_16x16x32_bf16 v[184:187], a[188:191], v[108:111], v[40:43]
    ds_read_b128 a[220:223], v3 offset:11264
    v_cvt_pk_bf16_f32 v207, v246, v247
    v_mfma_f32_16x16x32_bf16 v[184:187], a[184:187], v[104:107], v[184:187]
    v_bitop3_b32 v57, v57, v207, s37 bitop3:0xa8
    v_cmp_ne_u32 vcc, 0, v57
    v_mfma_f32_16x16x32_bf16 v[184:187], a[180:183], v[100:103], v[184:187]
    v_mfma_f32_16x16x32_bf16 v[184:187], a[176:179], v[96:99], v[184:187]
    s_cbranch_vccnz k2_tramp_114
k2_ret_115:
    s_cmp_lg_u32 s63, 0
    s_cbranch_scc1 k2_sloop_110
    v_mfma_f32_16x16x32_bf16 v[248:251], v[60:63], v[192:195], v[248:251]
    v_exp_f32 v232, v160
    v_mfma_f32_16x16x32_bf16 v[248:251], v[60:63], v[200:203], v[248:251]
    s_mov_b32 m0, s35
    ds_read_b128 a[224:227], v3 offset:4096
    v_exp_f32 v233, v161
    v_mfma_f32_16x16x32_bf16 v[252:255], v[60:63], v[204:207], v[252:255]
    s_add_u32 s53, s53, 16384
    buffer_load_dwordx4 v1, s[20:23], s33 offen offset:0 sc1 lds
    ds_read_b128 a[228:231], v3 offset:12288
    v_mfma_f32_16x16x32_bf16 v[252:255], v[60:63], v[196:199], v[252:255]
    s_waitcnt lgkmcnt(8)
    v_exp_f32 v234, v162
    v_cvt_pk_bf16_f32 v208, v232, v233
    v_mfma_f32_16x16x32_bf16 a[12:15], a[192:195], v[196:199], a[12:15]
    s_sub_u32 s40, s36, s39
    ds_read_b128 a[232:235], v3 offset:5120
    v_mfma_f32_16x16x32_bf16 a[12:15], a[196:199], v[204:207], a[12:15]
    s_and_b32 s53, s53, 0xffff
    v_subrev_u32 v6, s40, v4
    v_cmp_gt_i32 s[44:45], 0, v6
    v_mfma_f32_16x16x32_bf16 a[8:11], a[196:199], v[200:203], a[8:11]
    v_exp_f32 v235, v163
    v_cmp_gt_i32 s[46:47], 1, v6
    v_mfma_f32_16x16x32_bf16 a[8:11], a[192:195], v[192:195], a[8:11]
    s_waitcnt lgkmcnt(7)
    ds_read_b128 a[236:239], v3 offset:13312
    v_cmp_gt_i32 s[48:49], 2, v6
    v_cmp_gt_i32 s[50:51], 3, v6
    v_mfma_f32_16x16x32_bf16 a[24:27], a[200:203], v[192:195], a[24:27]
    s_add_u32 s35, s35, 0x4000
    v_exp_f32 v236, v176
    v_mfma_f32_16x16x32_bf16 a[24:27], a[204:207], v[200:203], a[24:27]
    ds_read_b128 a[240:243], v3 offset:6144
    v_cvt_pk_bf16_f32 v209, v234, v235
    v_cndmask_b32 v16, v10, v5, s[44:45]
    v_mfma_f32_16x16x32_bf16 a[28:31], a[204:207], v[204:207], a[28:31]
    v_exp_f32 v237, v177
    v_mfma_f32_16x16x32_bf16 a[28:31], a[200:203], v[196:199], a[28:31]
    s_waitcnt lgkmcnt(7)
    ds_read_b128 a[244:247], v3 offset:14336
    v_cndmask_b32 v17, v10, v5, s[46:47]
    v_cndmask_b32 v18, v10, v5, s[48:49]
    v_mfma_f32_16x16x32_bf16 a[44:47], a[208:211], v[196:199], a[44:47]
    buffer_load_dwordx4 v1, s[20:23], s33 offen offset:1024 sc1 lds
    ds_read_b128 a[248:251], v3 offset:7168
    v_mfma_f32_16x16x32_bf16 a[44:47], a[212:215], v[204:207], a[44:47]
    v_cndmask_b32 v19, v10, v5, s[50:51]
    v_cvt_pk_bf16_f32 v210, v236, v237
    v_mfma_f32_16x16x32_bf16 a[40:43], a[212:215], v[200:203], a[40:43]
    v_exp_f32 v238, v178
    v_cmp_gt_i32 s[44:45], 16, v6
    v_mfma_f32_16x16x32_bf16 a[40:43], a[208:211], v[192:195], a[40:43]
    s_waitcnt lgkmcnt(7)
    v_cmp_gt_i32 s[46:47], 17, v6
    v_cmp_gt_i32 s[48:49], 18, v6
    v_mfma_f32_16x16x32_bf16 a[56:59], a[216:219], v[192:195], a[56:59]
    s_and_b32 s35, s35, 0xffff
    v_exp_f32 v239, v179
    v_mfma_f32_16x16x32_bf16 a[56:59], a[220:223], v[200:203], a[56:59]
    ds_read_b128 a[252:255], v3 offset:15360
    v_or3_b32 v57, v208, v209, v210
    v_cmp_gt_i32 s[50:51], 19, v6
    v_mfma_f32_16x16x32_bf16 a[60:63], a[220:223], v[204:207], a[60:63]
    v_exp_f32 v240, v164
    v_mfma_f32_16x16x32_bf16 a[60:63], a[216:219], v[196:199], a[60:63]
    s_waitcnt lgkmcnt(6)
    v_cndmask_b32 v32, v10, v5, s[44:45]
    v_cvt_pk_bf16_f32 v211, v238, v239
    v_cndmask_b32 v33, v10, v5, s[46:47]
    v_mfma_f32_16x16x32_bf16 a[76:79], a[224:227], v[196:199], a[76:79]
    ds_read_b128 a[128:131], v2 offset:0
    v_cndmask_b32 v34, v10, v5, s[48:49]
    v_mfma_f32_16x16x32_bf16 a[76:79], a[228:231], v[204:207], a[76:79]
    s_or_b32 s35, s35, 0x10000
    v_add_u32 v3, s53, v56
    v_cndmask_b32 v35, v10, v5, s[50:51]
    v_mfma_f32_16x16x32_bf16 a[72:75], a[228:231], v[200:203], a[72:75]
    buffer_load_dwordx4 v1, s[20:23], s33 offen offset:2048 sc1 lds
    v_exp_f32 v241, v165
    v_mfma_f32_16x16x32_bf16 a[72:75], a[224:227], v[192:195], a[72:75]
    s_waitcnt lgkmcnt(5)
    ds_read_b128 a[132:135], v2 offset:1024
    v_cmp_gt_i32 s[44:45], 32, v6
    v_mfma_f32_16x16x32_bf16 a[88:91], a[232:235], v[192:195], a[88:91]
    v_exp_f32 v242, v166
    v_cmp_gt_i32 s[46:47], 33, v6
    v_mfma_f32_16x16x32_bf16 a[88:91], a[236:239], v[200:203], a[88:91]
    ds_read_b128 a[136:139], v2 offset:2048
    v_cvt_pk_bf16_f32 v212, v240, v241
    v_mfma_f32_16x16x32_bf16 a[92:95], a[236:239], v[204:207], a[92:95]
    v_cmp_gt_i32 s[48:49], 34, v6
    v_cmp_gt_i32 s[50:51], 35, v6
    v_mfma_f32_16x16x32_bf16 a[92:95], a[232:235], v[196:199], a[92:95]
    s_waitcnt lgkmcnt(5)
    v_exp_f32 v243, v167
    v_or3_b32 v57, v57, v211, v212
    v_mfma_f32_16x16x32_bf16 a[108:111], a[240:243], v[196:199], a[108:111]
    ds_read_b128 a[140:143], v2 offset:3072
    v_cndmask_b32 v24, v10, v5, s[44:45]
    v_mfma_f32_16x16x32_bf16 a[108:111], a[244:247], v[204:207], a[108:111]
    v_cndmask_b32 v25, v10, v5, s[46:47]
    v_exp_f32 v244, v180
    v_mfma_f32_16x16x32_bf16 a[104:107], a[244:247], v[200:203], a[104:107]
    v_cvt_pk_bf16_f32 v213, v242, v243
    v_cndmask_b32 v26, v10, v5, s[48:49]
    v_mfma_f32_16x16x32_bf16 a[104:107], a[240:243], v[192:195], a[104:107]
    s_waitcnt lgkmcnt(4)
    ds_read_b128 a[144:147], v2 offset:4096
    v_cndmask_b32 v27, v10, v5, s[50:51]
    v_mfma_f32_16x16x32_bf16 a[120:123], a[248:251], v[192:195], a[120:123]
    v_exp_f32 v245, v181
    v_cmp_gt_i32 s[44:45], 48, v6
    v_mfma_f32_16x16x32_bf16 a[120:123], a[252:255], v[200:203], a[120:123]
    buffer_load_dwordx4 v1, s[20:23], s33 offen offset:3072 sc1 lds
    ds_read_b128 a[148:151], v2 offset:5120
    ds_read_b128 a[152:155], v2 offset:6144
    v_cmp_gt_i32 s[46:47], 49, v6
    s_add_u32 s33, s33, 0x80000
    v_cmp_gt_i32 s[48:49], 50, v6
    v_exp_f32 v246, v182
    v_cvt_pk_bf16_f32 v214, v244, v245
    v_cmp_gt_i32 s[50:51], 51, v6
    v_cndmask_b32 v40, v10, v5, s[44:45]
    v_mfma_f32_16x16x32_bf16 a[124:127], a[252:255], v[204:207], a[124:127]
    v_exp_f32 v247, v183
    v_or3_b32 v57, v57, v213, v214
    v_cndmask_b32 v41, v10, v5, s[46:47]
    v_mfma_f32_16x16x32_bf16 a[124:127], a[248:251], v[196:199], a[124:127]
    s_waitcnt lgkmcnt(5)
    ds_read_b128 a[156:159], v2 offset:7168
    v_cndmask_b32 v42, v10, v5, s[48:49]
    v_cndmask_b32 v43, v10, v5, s[50:51]
    v_mfma_f32_16x16x32_bf16 v[128:131], a[128:131], v[96:99], v[16:19]
    s_waitcnt vmcnt(4)
    s_barrier
    v_exp_f32 v232, v168
    v_mfma_f32_16x16x32_bf16 v[128:131], a[132:135], v[100:103], v[128:131]
    s_waitcnt lgkmcnt(4)
    ds_read_b128 a[160:163], v2 offset:8192
    v_cvt_pk_bf16_f32 v215, v246, v247
    v_mfma_f32_16x16x32_bf16 v[128:131], a[136:139], v[104:107], v[128:131]
    v_exp_f32 v233, v169
    v_mfma_f32_16x16x32_bf16 v[128:131], a[140:143], v[108:111], v[128:131]
    s_add_u32 s36, s36, 64
    ds_read_b128 a[164:167], v2 offset:9216
    v_cvt_pk_bf16_f32 v216, v232, v233
    v_mfma_f32_16x16x32_bf16 v[132:135], a[140:143], v[124:127], v[20:23]
    v_exp_f32 v234, v170
    v_mfma_f32_16x16x32_bf16 v[132:135], a[136:139], v[120:123], v[132:135]
    ds_read_b128 a[168:171], v2 offset:10240
    v_or3_b32 v57, v57, v215, v216
    v_mfma_f32_16x16x32_bf16 v[132:135], a[132:135], v[116:119], v[132:135]
    s_add_u32 s52, s52, 16384
    v_exp_f32 v235, v171
    v_mfma_f32_16x16x32_bf16 v[132:135], a[128:131], v[112:115], v[132:135]
    s_waitcnt lgkmcnt(5)
    ds_read_b128 a[172:175], v2 offset:11264
    v_cvt_pk_bf16_f32 v217, v234, v235
    v_mfma_f32_16x16x32_bf16 v[148:151], a[144:147], v[112:115], v[36:39]
    s_and_b32 s52, s52, 0xffff
    v_exp_f32 v236, v184
    v_mfma_f32_16x16x32_bf16 v[148:151], a[148:151], v[116:119], v[148:151]
    s_waitcnt lgkmcnt(4)
    ds_read_b128 a[176:179], v2 offset:12288
    ds_read_b128 a[180:183], v2 offset:13312
    v_mfma_f32_16x16x32_bf16 v[148:151], a[152:155], v[120:123], v[148:151]
    v_exp_f32 v237, v185
    v_mfma_f32_16x16x32_bf16 v[148:151], a[156:159], v[124:127], v[148:151]
    v_exp_f32 v238, v186
    v_mfma_f32_16x16x32_bf16 v[144:147], a[156:159], v[108:111], v[32:35]
    ds_read_b128 a[184:187], v2 offset:14336
    v_cvt_pk_bf16_f32 v218, v236, v237
    v_mfma_f32_16x16x32_bf16 v[144:147], a[152:155], v[104:107], v[144:147]
    v_exp_f32 v239, v187
    v_mfma_f32_16x16x32_bf16 v[144:147], a[148:151], v[100:103], v[144:147]
    ds_read_b128 a[188:191], v2 offset:15360
    v_or3_b32 v57, v57, v217, v218
    v_mfma_f32_16x16x32_bf16 v[144:147], a[144:147], v[96:99], v[144:147]
    s_waitcnt lgkmcnt(6)
    v_exp_f32 v240, v172
    v_mfma_f32_16x16x32_bf16 v[136:139], a[160:163], v[96:99], v[24:27]
    v_cvt_pk_bf16_f32 v219, v238, v239
    v_add_u32 v2, s52, v1
    v_mfma_f32_16x16x32_bf16 v[136:139], a[164:167], v[100:103], v[136:139]
    s_waitcnt lgkmcnt(4)
    v_exp_f32 v241, v173
    v_mfma_f32_16x16x32_bf16 v[136:139], a[168:171], v[104:107], v[136:139]
    ds_read_b128 a[192:195], v3 offset:0
    v_cvt_pk_bf16_f32 v220, v240, v241
    v_mfma_f32_16x16x32_bf16 v[136:139], a[172:175], v[108:111], v[136:139]
    v_exp_f32 v242, v174
    v_mfma_f32_16x16x32_bf16 v[140:143], a[172:175], v[124:127], v[28:31]
    ds_read_b128 a[196:199], v3 offset:8192
    v_or3_b32 v57, v57, v219, v220
    v_mfma_f32_16x16x32_bf16 v[140:143], a[168:171], v[120:123], v[140:143]
    v_exp_f32 v243, v175
    v_mfma_f32_16x16x32_bf16 v[140:143], a[164:167], v[116:119], v[140:143]
    ds_read_b128 a[200:203], v3 offset:1024
    v_cvt_pk_bf16_f32 v221, v242, v243
    v_mfma_f32_16x16x32_bf16 v[140:143], a[160:163], v[112:115], v[140:143]
    s_waitcnt lgkmcnt(5)
    v_exp_f32 v244, v188
    v_mfma_f32_16x16x32_bf16 v[156:159], a[176:179], v[112:115], v[44:47]
    ds_read_b128 a[204:207], v3 offset:9216
    ds_read_b128 a[208:211], v3 offset:2048
    v_mfma_f32_16x16x32_bf16 v[156:159], a[180:183], v[116:119], v[156:159]
    s_waitcnt lgkmcnt(5)
    v_exp_f32 v245, v189
    v_mfma_f32_16x16x32_bf16 v[156:159], a[184:187], v[120:123], v[156:159]
    v_exp_f32 v246, v190
    v_mfma_f32_16x16x32_bf16 v[156:159], a[188:191], v[124:127], v[156:159]
    ds_read_b128 a[212:215], v3 offset:10240
    v_cvt_pk_bf16_f32 v222, v244, v245
    v_mfma_f32_16x16x32_bf16 v[152:155], a[188:191], v[108:111], v[40:43]
    v_exp_f32 v247, v191
    v_mfma_f32_16x16x32_bf16 v[152:155], a[184:187], v[104:107], v[152:155]
    ds_read_b128 a[216:219], v3 offset:3072
    v_or3_b32 v57, v57, v221, v222
    v_mfma_f32_16x16x32_bf16 v[152:155], a[180:183], v[100:103], v[152:155]
    ds_read_b128 a[220:223], v3 offset:11264
    v_cvt_pk_bf16_f32 v223, v246, v247
    v_bitop3_b32 v57, v57, v223, s37 bitop3:0xa8
    v_mfma_f32_16x16x32_bf16 v[152:155], a[176:179], v[96:99], v[152:155]
    v_cmp_ne_u32 vcc, 0, v57
    s_cbranch_vccnz k2_tramp_116
k2_ret_117:
    v_mfma_f32_16x16x32_bf16 v[248:251], v[60:63], v[208:211], v[248:251]
    ds_read_b128 a[224:227], v3 offset:4096
    v_exp_f32 v232, v128
    v_mfma_f32_16x16x32_bf16 v[248:251], v[60:63], v[216:219], v[248:251]
    v_exp_f32 v233, v129
    v_mfma_f32_16x16x32_bf16 v[252:255], v[60:63], v[220:223], v[252:255]
    s_add_u32 s53, s53, 16384
    ds_read_b128 a[228:231], v3 offset:12288
    v_exp_f32 v234, v130
    v_mfma_f32_16x16x32_bf16 v[252:255], v[60:63], v[212:215], v[252:255]
    s_waitcnt lgkmcnt(8)
    v_cvt_pk_bf16_f32 v192, v232, v233
    v_exp_f32 v235, v131
    v_mfma_f32_16x16x32_bf16 a[12:15], a[192:195], v[212:215], a[12:15]
    s_sub_u32 s40, s36, s39
    s_sub_u32 s40, s40, 64
    ds_read_b128 a[232:235], v3 offset:5120
    v_mfma_f32_16x16x32_bf16 a[12:15], a[196:199], v[220:223], a[12:15]
    s_and_b32 s53, s53, 0xffff
    v_subrev_u32 v6, s40, v4
    v_cmp_gt_i32 s[44:45], 0, v6
    v_cvt_pk_bf16_f32 v193, v234, v235
    v_mfma_f32_16x16x32_bf16 a[8:11], a[196:199], v[216:219], a[8:11]
    v_exp_f32 v236, v144
    v_cmp_gt_i32 s[46:47], 1, v6
    v_mfma_f32_16x16x32_bf16 a[8:11], a[192:195], v[208:211], a[8:11]
    s_waitcnt lgkmcnt(7)
    ds_read_b128 a[236:239], v3 offset:13312
    v_exp_f32 v237, v145
    v_mfma_f32_16x16x32_bf16 a[24:27], a[200:203], v[208:211], a[24:27]
    ds_read_b128 a[240:243], v3 offset:6144
    v_cmp_gt_i32 s[48:49], 2, v6
    v_cmp_gt_i32 s[50:51], 3, v6
    v_mfma_f32_16x16x32_bf16 a[24:27], a[204:207], v[216:219], a[24:27]
    v_exp_f32 v238, v146
    v_cndmask_b32 v20, v11, v5, s[44:45]
    v_mfma_f32_16x16x32_bf16 a[28:31], a[204:207], v[220:223], a[28:31]
    v_cvt_pk_bf16_f32 v194, v236, v237
    v_cndmask_b32 v21, v11, v5, s[46:47]
    v_or3_b32 v57, v192, v193, v194
    v_mfma_f32_16x16x32_bf16 a[28:31], a[200:203], v[212:215], a[28:31]
    s_waitcnt lgkmcnt(7)
    v_exp_f32 v239, v147
    v_cndmask_b32 v22, v11, v5, s[48:49]
    v_mfma_f32_16x16x32_bf16 a[44:47], a[208:211], v[212:215], a[44:47]
    ds_read_b128 a[244:247], v3 offset:14336
    v_cndmask_b32 v23, v11, v5, s[50:51]
    v_cvt_pk_bf16_f32 v195, v238, v239
    v_mfma_f32_16x16x32_bf16 a[44:47], a[212:215], v[220:223], a[44:47]
    v_exp_f32 v240, v132
    v_cmp_gt_i32 s[44:45], 16, v6
    v_mfma_f32_16x16x32_bf16 a[40:43], a[212:215], v[216:219], a[40:43]
    ds_read_b128 a[248:251], v3 offset:7168
    v_cmp_gt_i32 s[46:47], 17, v6
    v_cmp_gt_i32 s[48:49], 18, v6
    v_mfma_f32_16x16x32_bf16 a[40:43], a[208:211], v[208:211], a[40:43]
    s_waitcnt lgkmcnt(7)
    ds_read_b128 a[252:255], v3 offset:15360
    v_exp_f32 v241, v133
    v_mfma_f32_16x16x32_bf16 a[56:59], a[216:219], v[208:211], a[56:59]
    v_exp_f32 v242, v134
    v_cmp_gt_i32 s[50:51], 19, v6
    v_mfma_f32_16x16x32_bf16 a[56:59], a[220:223], v[216:219], a[56:59]
    v_cvt_pk_bf16_f32 v196, v240, v241
    v_cndmask_b32 v36, v11, v5, s[44:45]
    v_or3_b32 v57, v57, v195, v196
    v_mfma_f32_16x16x32_bf16 a[60:63], a[220:223], v[220:223], a[60:63]
    v_exp_f32 v243, v135
    v_cndmask_b32 v37, v11, v5, s[46:47]
    v_mfma_f32_16x16x32_bf16 a[60:63], a[216:219], v[212:215], a[60:63]
    s_waitcnt lgkmcnt(6)
    ds_read_b128 a[128:131], v2 offset:0
    v_cndmask_b32 v38, v11, v5, s[48:49]
    v_add_u32 v3, s53, v56
    v_mfma_f32_16x16x32_bf16 a[76:79], a[224:227], v[212:215], a[76:79]
    ds_read_b128 a[132:135], v2 offset:1024
    v_exp_f32 v244, v148
    v_mfma_f32_16x16x32_bf16 a[76:79], a[228:231], v[220:223], a[76:79]
    ds_read_b128 a[136:139], v2 offset:2048
    v_cvt_pk_bf16_f32 v197, v242, v243
    v_cndmask_b32 v39, v11, v5, s[50:51]
    v_mfma_f32_16x16x32_bf16 a[72:75], a[228:231], v[216:219], a[72:75]
    v_cmp_gt_i32 s[44:45], 32, v6
    v_exp_f32 v245, v149
    v_mfma_f32_16x16x32_bf16 a[72:75], a[224:227], v[208:211], a[72:75]
    s_waitcnt lgkmcnt(7)
    ds_read_b128 a[140:143], v2 offset:3072
    ds_read_b128 a[144:147], v2 offset:4096
    v_cmp_gt_i32 s[46:47], 33, v6
    v_mfma_f32_16x16x32_bf16 a[88:91], a[232:235], v[208:211], a[88:91]
    v_exp_f32 v246, v150
    v_cmp_gt_i32 s[48:49], 34, v6
    v_mfma_f32_16x16x32_bf16 a[88:91], a[236:239], v[216:219], a[88:91]
    ds_read_b128 a[148:151], v2 offset:5120
    v_cvt_pk_bf16_f32 v198, v244, v245
    v_cmp_gt_i32 s[50:51], 35, v6
    v_mfma_f32_16x16x32_bf16 a[92:95], a[236:239], v[220:223], a[92:95]
    v_exp_f32 v247, v151
    v_or3_b32 v57, v57, v197, v198
    v_mfma_f32_16x16x32_bf16 a[92:95], a[232:235], v[212:215], a[92:95]
    s_waitcnt lgkmcnt(8)
    ds_read_b128 a[152:155], v2 offset:6144
    v_cndmask_b32 v28, v11, v5, s[44:45]
    v_cndmask_b32 v29, v11, v5, s[46:47]
    v_mfma_f32_16x16x32_bf16 a[108:111], a[240:243], v[212:215], a[108:111]
    ds_read_b128 a[156:159], v2 offset:7168
    v_exp_f32 v232, v136
    v_mfma_f32_16x16x32_bf16 a[108:111], a[244:247], v[220:223], a[108:111]
    ds_read_b128 a[160:163], v2 offset:8192
    v_cvt_pk_bf16_f32 v199, v246, v247
    v_cndmask_b32 v30, v11, v5, s[48:49]
    v_mfma_f32_16x16x32_bf16 a[104:107], a[244:247], v[216:219], a[104:107]
    v_cndmask_b32 v31, v11, v5, s[50:51]
    v_exp_f32 v233, v137
    v_mfma_f32_16x16x32_bf16 a[104:107], a[240:243], v[208:211], a[104:107]
    s_waitcnt lgkmcnt(9)
    ds_read_b128 a[164:167], v2 offset:9216
    ds_read_b128 a[168:171], v2 offset:10240
    v_cmp_gt_i32 s[44:45], 48, v6
    v_mfma_f32_16x16x32_bf16 a[120:123], a[248:251], v[208:211], a[120:123]
    v_exp_f32 v234, v138
    v_cmp_gt_i32 s[46:47], 49, v6
    v_mfma_f32_16x16x32_bf16 a[120:123], a[252:255], v[216:219], a[120:123]
    ds_read_b128 a[172:175], v2 offset:11264
    ds_read_b128 a[176:179], v2 offset:12288
    v_cvt_pk_bf16_f32 v200, v232, v233
    v_cmp_gt_i32 s[48:49], 50, v6
    v_exp_f32 v235, v139
    v_cmp_gt_i32 s[50:51], 51, v6
    v_or3_b32 v57, v57, v199, v200
    v_cndmask_b32 v44, v11, v5, s[44:45]
    v_mfma_f32_16x16x32_bf16 a[124:127], a[252:255], v[220:223], a[124:127]
    ds_read_b128 a[180:183], v2 offset:13312
    v_exp_f32 v236, v152
    v_cvt_pk_bf16_f32 v201, v234, v235
    v_cndmask_b32 v45, v11, v5, s[46:47]
    v_mfma_f32_16x16x32_bf16 a[124:127], a[248:251], v[212:215], a[124:127]
    s_waitcnt lgkmcnt(12)
    ds_read_b128 a[184:187], v2 offset:14336
    v_cndmask_b32 v46, v11, v5, s[48:49]
    v_cndmask_b32 v47, v11, v5, s[50:51]
    v_mfma_f32_16x16x32_bf16 v[164:167], a[128:131], v[112:115], v[20:23]
    v_exp_f32 v237, v153
    v_mfma_f32_16x16x32_bf16 v[164:167], a[132:135], v[116:119], v[164:167]
    s_waitcnt lgkmcnt(11)
    ds_read_b128 a[188:191], v2 offset:15360
    v_exp_f32 v238, v154
    v_mfma_f32_16x16x32_bf16 v[164:167], a[136:139], v[120:123], v[164:167]
    v_cvt_pk_bf16_f32 v202, v236, v237
    v_exp_f32 v239, v155
    v_mfma_f32_16x16x32_bf16 v[164:167], a[140:143], v[124:127], v[164:167]
    s_waitcnt lgkmcnt(10)
    s_waitcnt lgkmcnt(8)
    v_or3_b32 v57, v57, v201, v202
    v_mfma_f32_16x16x32_bf16 v[180:183], a[156:159], v[124:127], v[36:39]
    s_add_u32 s36, s36, 64
    ds_read_b128 a[192:195], v3 offset:0
    v_exp_f32 v240, v140
    v_mfma_f32_16x16x32_bf16 v[180:183], a[152:155], v[120:123], v[180:183]
    ds_read_b128 a[196:199], v3 offset:8192
    v_cvt_pk_bf16_f32 v203, v238, v239
    v_mfma_f32_16x16x32_bf16 v[180:183], a[148:151], v[116:119], v[180:183]
    s_add_u32 s52, s52, 16384
    ds_read_b128 a[200:203], v3 offset:1024
    v_exp_f32 v241, v141
    v_mfma_f32_16x16x32_bf16 v[180:183], a[144:147], v[112:115], v[180:183]
    s_waitcnt lgkmcnt(9)
    v_exp_f32 v242, v142
    v_cvt_pk_bf16_f32 v204, v240, v241
    v_mfma_f32_16x16x32_bf16 v[172:175], a[160:163], v[112:115], v[28:31]
    s_and_b32 s52, s52, 0xffff
    v_add_u32 v2, s52, v1
    v_exp_f32 v243, v143
    v_mfma_f32_16x16x32_bf16 v[172:175], a[164:167], v[116:119], v[172:175]
    s_waitcnt lgkmcnt(7)
    ds_read_b128 a[204:207], v3 offset:9216
    v_or3_b32 v57, v57, v203, v204
    v_cvt_pk_bf16_f32 v205, v242, v243
    v_mfma_f32_16x16x32_bf16 v[172:175], a[168:171], v[120:123], v[172:175]
    ds_read_b128 a[208:211], v3 offset:2048
    v_exp_f32 v244, v156
    v_mfma_f32_16x16x32_bf16 v[172:175], a[172:175], v[124:127], v[172:175]
    s_waitcnt lgkmcnt(7)
    s_waitcnt lgkmcnt(5)
    v_exp_f32 v245, v157
    v_mfma_f32_16x16x32_bf16 v[188:191], a[188:191], v[124:127], v[44:47]
    ds_read_b128 a[212:215], v3 offset:10240
    v_exp_f32 v246, v158
    v_mfma_f32_16x16x32_bf16 v[188:191], a[184:187], v[120:123], v[188:191]
    v_cvt_pk_bf16_f32 v206, v244, v245
    v_exp_f32 v247, v159
    v_mfma_f32_16x16x32_bf16 v[188:191], a[180:183], v[116:119], v[188:191]
    ds_read_b128 a[216:219], v3 offset:3072
    v_or3_b32 v57, v57, v205, v206
    v_cvt_pk_bf16_f32 v207, v246, v247
    v_mfma_f32_16x16x32_bf16 v[188:191], a[176:179], v[112:115], v[188:191]
    ds_read_b128 a[220:223], v3 offset:11264
    v_bitop3_b32 v57, v57, v207, s37 bitop3:0xa8
    v_cmp_ne_u32 vcc, 0, v57
    s_cbranch_vccnz k2_tramp_118
k2_ret_119:
k2_sdone_111:
    s_add_u32 s16, s6, 0x4811000
    s_addc_u32 s17, s7, 0
    s_and_b32 s17, s17, 0xffff
    s_mov_b32 s18, 0x4000
    s_mov_b32 s19, 0x00020000
    v_mfma_f32_16x16x32_bf16 v[248:251], v[60:63], v[192:195], v[248:251]
    s_waitcnt vmcnt(0)
    s_barrier
    v_exp_f32 v232, v164
    v_mfma_f32_16x16x32_bf16 v[248:251], v[60:63], v[200:203], v[248:251]
    ds_read_b128 a[224:227], v3 offset:4096
    s_cmp_eq_u32 s30, 0
    s_cbranch_scc1 k12_ool_122
k12_oolret_123:
    v_mfma_f32_16x16x32_bf16 v[252:255], v[60:63], v[204:207], v[252:255]
    s_add_u32 m0, s60, 0
    v_exp_f32 v233, v165
    v_mfma_f32_16x16x32_bf16 v[252:255], v[60:63], v[196:199], v[252:255]
    s_waitcnt lgkmcnt(7)
    buffer_load_dwordx4 v90, s[12:15], s61 offen offset:0 lds
    ds_read_b128 a[228:231], v3 offset:12288
    v_mfma_f32_16x16x32_bf16 a[12:15], a[192:195], v[196:199], a[12:15]
    s_add_u32 s53, s53, 16384
    v_exp_f32 v234, v166
    v_cvt_pk_bf16_f32 v212, v232, v233
    v_mfma_f32_16x16x32_bf16 a[12:15], a[196:199], v[204:207], a[12:15]
    s_and_b32 s53, s53, 0xffff
    buffer_load_dwordx4 v91, s[12:15], s61 offen offset:1024 lds
    ds_read_b128 a[232:235], v3 offset:5120
    v_mfma_f32_16x16x32_bf16 a[8:11], a[196:199], v[200:203], a[8:11]
    ds_read_b128 a[236:239], v3 offset:13312
    v_exp_f32 v235, v167
    v_mfma_f32_16x16x32_bf16 a[8:11], a[192:195], v[192:195], a[8:11]
    s_waitcnt lgkmcnt(8)
    v_exp_f32 v236, v180
    v_mfma_f32_16x16x32_bf16 a[24:27], a[200:203], v[192:195], a[24:27]
    buffer_load_dwordx4 v92, s[12:15], s61 offen offset:2048 lds
    ds_read_b128 a[240:243], v3 offset:6144
    v_mfma_f32_16x16x32_bf16 a[24:27], a[204:207], v[200:203], a[24:27]
    v_cvt_pk_bf16_f32 v213, v234, v235
    v_exp_f32 v237, v181
    v_mfma_f32_16x16x32_bf16 a[28:31], a[204:207], v[204:207], a[28:31]
    buffer_load_dwordx4 v93, s[12:15], s61 offen offset:3072 lds
    ds_read_b128 a[244:247], v3 offset:14336
    v_mfma_f32_16x16x32_bf16 a[28:31], a[200:203], v[196:199], a[28:31]
    s_waitcnt lgkmcnt(8)
    v_exp_f32 v238, v182
    v_cvt_pk_bf16_f32 v214, v236, v237
    v_mfma_f32_16x16x32_bf16 a[44:47], a[208:211], v[196:199], a[44:47]
    s_add_u32 s61, s61, 0x20000
    s_and_b32 s61, s61, 0x3fffff
    ds_read_b128 a[248:251], v3 offset:7168
    v_mfma_f32_16x16x32_bf16 a[44:47], a[212:215], v[204:207], a[44:47]
    s_add_u32 m0, s60, 16384
    v_exp_f32 v239, v183
    v_or3_b32 v57, v212, v213, v214
    v_mfma_f32_16x16x32_bf16 a[40:43], a[212:215], v[200:203], a[40:43]
    buffer_load_dwordx4 v90, s[12:15], s61 offen offset:0 lds
    buffer_load_dwordx4 v91, s[12:15], s61 offen offset:1024 lds
    ds_read_b128 a[252:255], v3 offset:15360
    v_mfma_f32_16x16x32_bf16 a[40:43], a[208:211], v[192:195], a[40:43]
    s_waitcnt lgkmcnt(8)
    v_exp_f32 v240, v172
    v_cvt_pk_bf16_f32 v215, v238, v239
    v_mfma_f32_16x16x32_bf16 a[56:59], a[216:219], v[192:195], a[56:59]
    v_mfma_f32_16x16x32_bf16 a[56:59], a[220:223], v[200:203], a[56:59]
    v_add_u32 v3, s53, v56
    ds_read_b128 a[192:195], v3 offset:0
    v_mfma_f32_16x16x32_bf16 a[60:63], a[220:223], v[204:207], a[60:63]
    ds_read_b128 a[196:199], v3 offset:8192
    v_exp_f32 v241, v173
    v_mfma_f32_16x16x32_bf16 a[60:63], a[216:219], v[196:199], a[60:63]
    s_waitcnt lgkmcnt(8)
    buffer_load_dwordx4 v92, s[12:15], s61 offen offset:2048 lds
    buffer_load_dwordx4 v93, s[12:15], s61 offen offset:3072 lds
    ds_read_b128 a[200:203], v3 offset:1024
    v_mfma_f32_16x16x32_bf16 a[76:79], a[224:227], v[196:199], a[76:79]
    v_exp_f32 v242, v174
    v_cvt_pk_bf16_f32 v220, v240, v241
    v_mfma_f32_16x16x32_bf16 a[76:79], a[228:231], v[204:207], a[76:79]
    ds_read_b128 a[204:207], v3 offset:9216
    ds_read_b128 a[208:211], v3 offset:2048
    v_or3_b32 v57, v57, v215, v220
    v_mfma_f32_16x16x32_bf16 a[72:75], a[228:231], v[200:203], a[72:75]
    s_add_u32 s61, s61, 0x20000
    s_and_b32 s61, s61, 0x3fffff
    ds_read_b128 a[212:215], v3 offset:10240
    v_exp_f32 v243, v175
    v_mfma_f32_16x16x32_bf16 a[72:75], a[224:227], v[192:195], a[72:75]
    s_waitcnt lgkmcnt(10)
    ds_read_b128 a[216:219], v3 offset:3072
    s_add_u32 m0, s60, 32768
    v_mfma_f32_16x16x32_bf16 a[88:91], a[232:235], v[192:195], a[88:91]
    buffer_load_dwordx4 v90, s[12:15], s61 offen offset:0 lds
    ds_read_b128 a[220:223], v3 offset:11264
    v_mfma_f32_16x16x32_bf16 a[88:91], a[236:239], v[200:203], a[88:91]
    v_exp_f32 v244, v188
    v_cvt_pk_bf16_f32 v221, v242, v243
    v_mfma_f32_16x16x32_bf16 a[92:95], a[236:239], v[204:207], a[92:95]
    buffer_load_dwordx4 v91, s[12:15], s61 offen offset:1024 lds
    ds_read_b128 a[224:227], v3 offset:4096
    v_mfma_f32_16x16x32_bf16 a[92:95], a[232:235], v[196:199], a[92:95]
    s_waitcnt lgkmcnt(11)
    ds_read_b128 a[228:231], v3 offset:12288
    v_exp_f32 v245, v189
    v_mfma_f32_16x16x32_bf16 a[108:111], a[240:243], v[196:199], a[108:111]
    buffer_load_dwordx4 v92, s[12:15], s61 offen offset:2048 lds
    ds_read_b128 a[232:235], v3 offset:5120
    v_mfma_f32_16x16x32_bf16 a[108:111], a[244:247], v[204:207], a[108:111]
    v_exp_f32 v246, v190
    v_mfma_f32_16x16x32_bf16 a[104:107], a[244:247], v[200:203], a[104:107]
    ds_read_b128 a[236:239], v3 offset:13312
    v_cvt_pk_bf16_f32 v222, v244, v245
    v_or3_b32 v57, v57, v221, v222
    v_mfma_f32_16x16x32_bf16 a[104:107], a[240:243], v[192:195], a[104:107]
    s_waitcnt lgkmcnt(12)
    v_exp_f32 v247, v191
    v_mfma_f32_16x16x32_bf16 a[120:123], a[248:251], v[192:195], a[120:123]
    buffer_load_dwordx4 v93, s[12:15], s61 offen offset:3072 lds
    ds_read_b128 a[240:243], v3 offset:6144
    ds_read_b128 a[244:247], v3 offset:14336
    v_mfma_f32_16x16x32_bf16 a[120:123], a[252:255], v[200:203], a[120:123]
    s_add_u32 s61, s61, 0x20000
    s_and_b32 s61, s61, 0x3fffff
    v_cvt_pk_bf16_f32 v223, v246, v247
    v_bitop3_b32 v57, v57, v223, s37 bitop3:0xa8
    v_mfma_f32_16x16x32_bf16 a[124:127], a[252:255], v[204:207], a[124:127]
    v_cmp_ne_u32 vcc, 0, v57
    v_mfma_f32_16x16x32_bf16 a[124:127], a[248:251], v[196:199], a[124:127]
    buffer_load_dword v74, v73, s[16:19], s59 offen sc1
    ds_read_b128 a[248:251], v3 offset:7168
    ds_read_b128 a[252:255], v3 offset:15360
    s_cbranch_vccnz k2_tramp_120
k2_ret_121:
    v_lshrrev_b32 v6, 4, v1
    v_and_b32 v6, 31, v6
    s_getpc_b64 s[40:41]
pc_124:
    s_add_u32 s40, s40, op_head-pc_124
    s_addc_u32 s41, s41, 0
    v_lshlrev_b32 v224, 7, v6
    v_mov_b32 v225, s41
    v_add_co_u32 v224, vcc, s40, v224
    s_nop 1
    v_addc_co_u32 v225, vcc, 0, v225, vcc
    global_load_dword v7, v[224:225], off
    v_mfma_f32_16x16x32_bf16 v[252:255], v[60:63], v[212:215], v[252:255]
    s_lshl_b32 s31, s28, 19
    v_mov_b32 v249, v248
    s_nop 1
    v_permlane16_swap_b32 v248, v249
    v_mfma_f32_16x16x32_bf16 v[252:255], v[60:63], v[220:223], v[252:255]
    s_waitcnt lgkmcnt(0)
    s_nop 1
    v_add_f32 v248, v248, v249
    v_mov_b32 v249, v248
    v_mfma_f32_16x16x32_bf16 a[12:15], a[196:199], v[220:223], a[12:15]
    s_lshl_b32 s44, s39, 6
    s_nop 1
    v_permlane32_swap_b32 v248, v249
    s_nop 1
    v_mfma_f32_16x16x32_bf16 a[12:15], a[192:195], v[212:215], a[12:15]
    s_add_u32 s44, s44, s31
    s_add_u32 s45, s44, 131072
    v_add_f32 v248, v248, v249
    v_rcp_f32 v249, v248
    v_mfma_f32_16x16x32_bf16 a[28:31], a[200:203], v[212:215], a[28:31]
    s_add_u32 s46, s44, 262144
    v_rcp_f32 v248, v248
    s_nop 0
    s_add_u32 s47, s44, 393216
    v_mfma_f32_16x16x32_bf16 a[28:31], a[204:207], v[220:223], a[28:31]
    s_add_u32 s48, s44, 4096
    v_accvgpr_read_b32 v132, a8
    v_accvgpr_read_b32 v133, a9
    v_accvgpr_read_b32 v134, a10
    v_mfma_f32_16x16x32_bf16 a[44:47], a[212:215], v[220:223], a[44:47]
    s_add_u32 s49, s44, 135168
    v_accvgpr_read_b32 v135, a11
    v_accvgpr_read_b32 v136, a24
    v_accvgpr_read_b32 v137, a25
    v_mfma_f32_16x16x32_bf16 a[44:47], a[208:211], v[212:215], a[44:47]
    s_add_u32 s50, s44, 266240
    v_accvgpr_read_b32 v138, a26
    v_accvgpr_read_b32 v139, a27
    v_mul_f32 v132, v132, v248
    v_mfma_f32_16x16x32_bf16 a[60:63], a[216:219], v[212:215], a[60:63]
    s_add_u32 s51, s44, 397312
    v_mul_f32 v133, v133, v248
    v_mul_f32 v134, v134, v248
    v_mul_f32 v135, v135, v248
    v_mfma_f32_16x16x32_bf16 a[60:63], a[220:223], v[220:223], a[60:63]
    v_mul_f32 v136, v136, v248
    v_mul_f32 v137, v137, v248
    v_mul_f32 v138, v138, v248
    v_mfma_f32_16x16x32_bf16 a[76:79], a[228:231], v[220:223], a[76:79]
    v_mul_f32 v139, v139, v248
    v_cvt_pk_bf16_f32 v128, v132, v133
    v_cvt_pk_bf16_f32 v129, v134, v135
    v_mfma_f32_16x16x32_bf16 a[76:79], a[224:227], v[212:215], a[76:79]
    v_cvt_pk_bf16_f32 v130, v136, v137
    v_cvt_pk_bf16_f32 v131, v138, v139
    buffer_store_dwordx4 v[128:131], v1, s[24:27], s44 offen sc1
    v_mfma_f32_16x16x32_bf16 a[92:95], a[232:235], v[212:215], a[92:95]
    v_accvgpr_read_b32 v144, a40
    v_accvgpr_read_b32 v145, a41
    v_accvgpr_read_b32 v146, a42
    v_mfma_f32_16x16x32_bf16 a[92:95], a[236:239], v[220:223], a[92:95]
    v_accvgpr_read_b32 v147, a43
    v_accvgpr_read_b32 v148, a56
    v_mov_b32 v253, v252
    v_mfma_f32_16x16x32_bf16 a[108:111], a[244:247], v[220:223], a[108:111]
    v_accvgpr_read_b32 v149, a57
    v_accvgpr_read_b32 v150, a58
    s_nop 1
    v_mfma_f32_16x16x32_bf16 a[108:111], a[240:243], v[212:215], a[108:111]
    v_accvgpr_read_b32 v151, a59
    v_permlane16_swap_b32 v252, v253
    v_mul_f32 v144, v144, v248
    v_mfma_f32_16x16x32_bf16 a[124:127], a[248:251], v[212:215], a[124:127]
    s_nop 1
    v_mul_f32 v145, v145, v248
    v_add_f32 v252, v252, v253
    v_mfma_f32_16x16x32_bf16 a[124:127], a[252:255], v[220:223], a[124:127]
    v_mul_f32 v146, v146, v248
    v_mov_b32 v253, v252
    v_mul_f32 v147, v147, v248
    s_nop 1
    v_mul_f32 v148, v148, v248
    v_mul_f32 v149, v149, v248
    v_permlane32_swap_b32 v252, v253
    v_mul_f32 v150, v150, v248
    s_nop 1
    v_mul_f32 v151, v151, v248
    v_add_f32 v252, v252, v253
    v_cvt_pk_bf16_f32 v140, v144, v145
    v_rcp_f32 v253, v252
    v_cvt_pk_bf16_f32 v141, v146, v147
    v_rcp_f32 v252, v252
    v_cvt_pk_bf16_f32 v142, v148, v149
    s_nop 0
    v_cvt_pk_bf16_f32 v143, v150, v151
    buffer_store_dwordx4 v[140:143], v1, s[24:27], s45 offen sc1
    v_accvgpr_read_b32 v156, a72
    v_accvgpr_read_b32 v157, a73
    v_accvgpr_read_b32 v158, a74
    v_accvgpr_read_b32 v159, a75
    v_accvgpr_read_b32 v160, a88
    v_accvgpr_read_b32 v161, a89
    v_accvgpr_read_b32 v162, a90
    v_accvgpr_read_b32 v163, a91
    v_mul_f32 v156, v156, v248
    v_mul_f32 v157, v157, v248
    v_mul_f32 v158, v158, v248
    v_mul_f32 v159, v159, v248
    v_mul_f32 v160, v160, v248
    v_mul_f32 v161, v161, v248
    v_mul_f32 v162, v162, v248
    v_mul_f32 v163, v163, v248
    v_cvt_pk_bf16_f32 v152, v156, v157
    v_cvt_pk_bf16_f32 v153, v158, v159
    v_cvt_pk_bf16_f32 v154, v160, v161
    v_cvt_pk_bf16_f32 v155, v162, v163
    buffer_store_dwordx4 v[152:155], v1, s[24:27], s46 offen sc1
    v_accvgpr_read_b32 v168, a104
    v_accvgpr_read_b32 v169, a105
    v_accvgpr_read_b32 v170, a106
    v_accvgpr_read_b32 v171, a107
    v_accvgpr_read_b32 v172, a120
    v_accvgpr_read_b32 v173, a121
    v_accvgpr_read_b32 v174, a122
    v_accvgpr_read_b32 v175, a123
    v_mul_f32 v168, v168, v248
    v_mul_f32 v169, v169, v248
    v_mul_f32 v170, v170, v248
    v_mul_f32 v171, v171, v248
    v_mul_f32 v172, v172, v248
    v_mul_f32 v173, v173, v248
    v_mul_f32 v174, v174, v248
    v_mul_f32 v175, v175, v248
    v_cvt_pk_bf16_f32 v164, v168, v169
    v_cvt_pk_bf16_f32 v165, v170, v171
    v_cvt_pk_bf16_f32 v166, v172, v173
    v_cvt_pk_bf16_f32 v167, v174, v175
    buffer_store_dwordx4 v[164:167], v1, s[24:27], s47 offen sc1
    v_accvgpr_read_b32 v132, a12
    v_accvgpr_read_b32 v133, a13
    v_accvgpr_read_b32 v134, a14
    v_accvgpr_read_b32 v135, a15
    v_accvgpr_read_b32 v136, a28
    v_accvgpr_read_b32 v137, a29
    v_accvgpr_read_b32 v138, a30
    v_accvgpr_read_b32 v139, a31
    v_pk_mul_f32 v[132:133], v[132:133], v[252:253]
    v_pk_mul_f32 v[134:135], v[134:135], v[252:253]
    v_pk_mul_f32 v[136:137], v[136:137], v[252:253]
    v_pk_mul_f32 v[138:139], v[138:139], v[252:253]
    v_cvt_pk_bf16_f32 v128, v132, v133
    v_cvt_pk_bf16_f32 v129, v134, v135
    v_cvt_pk_bf16_f32 v130, v136, v137
    v_cvt_pk_bf16_f32 v131, v138, v139
    v_accvgpr_read_b32 v144, a44
    v_accvgpr_read_b32 v145, a45
    v_accvgpr_read_b32 v146, a46
    v_accvgpr_read_b32 v147, a47
    v_accvgpr_read_b32 v148, a60
    v_accvgpr_read_b32 v149, a61
    v_accvgpr_read_b32 v150, a62
    v_accvgpr_read_b32 v151, a63
    v_pk_mul_f32 v[144:145], v[144:145], v[252:253]
    v_pk_mul_f32 v[146:147], v[146:147], v[252:253]
    v_pk_mul_f32 v[148:149], v[148:149], v[252:253]
    v_pk_mul_f32 v[150:151], v[150:151], v[252:253]
    v_cvt_pk_bf16_f32 v140, v144, v145
    v_cvt_pk_bf16_f32 v141, v146, v147
    v_cvt_pk_bf16_f32 v142, v148, v149
    v_cvt_pk_bf16_f32 v143, v150, v151
    v_accvgpr_read_b32 v156, a76
    v_accvgpr_read_b32 v157, a77
    v_accvgpr_read_b32 v158, a78
    v_accvgpr_read_b32 v159, a79
    v_accvgpr_read_b32 v160, a92
    v_accvgpr_read_b32 v161, a93
    v_accvgpr_read_b32 v162, a94
    v_accvgpr_read_b32 v163, a95
    v_pk_mul_f32 v[156:157], v[156:157], v[252:253]
    v_pk_mul_f32 v[158:159], v[158:159], v[252:253]
    v_pk_mul_f32 v[160:161], v[160:161], v[252:253]
    v_pk_mul_f32 v[162:163], v[162:163], v[252:253]
    v_cvt_pk_bf16_f32 v152, v156, v157
    v_cvt_pk_bf16_f32 v153, v158, v159
    v_cvt_pk_bf16_f32 v154, v160, v161
    v_cvt_pk_bf16_f32 v155, v162, v163
    v_accvgpr_read_b32 v168, a108
    v_accvgpr_read_b32 v169, a109
    v_accvgpr_read_b32 v170, a110
    v_accvgpr_read_b32 v171, a111
    v_accvgpr_read_b32 v172, a124
    v_accvgpr_read_b32 v173, a125
    v_accvgpr_read_b32 v174, a126
    v_accvgpr_read_b32 v175, a127
    v_pk_mul_f32 v[168:169], v[168:169], v[252:253]
    v_pk_mul_f32 v[170:171], v[170:171], v[252:253]
    v_pk_mul_f32 v[172:173], v[172:173], v[252:253]
    v_pk_mul_f32 v[174:175], v[174:175], v[252:253]
    v_cvt_pk_bf16_f32 v164, v168, v169
    v_cvt_pk_bf16_f32 v165, v170, v171
    v_cvt_pk_bf16_f32 v166, v172, v173
    v_cvt_pk_bf16_f32 v167, v174, v175
    buffer_store_dwordx4 v[128:131], v1, s[24:27], s48 offen sc1
    buffer_store_dwordx4 v[140:143], v1, s[24:27], s49 offen sc1
    buffer_store_dwordx4 v[152:155], v1, s[24:27], s50 offen sc1
    buffer_store_dwordx4 v[164:167], v1, s[24:27], s51 offen sc1
op_head:
    s_load_dwordx2 s[28:29], s[0:1], 0
    s_load_dwordx2 s[42:43], s[0:1], 56
    s_waitcnt vmcnt(8)
    v_cmp_le_u32 vcc, 4, v74
    v_mov_b32 v56, 0
    v_mov_b32 v57, 0
    v_mov_b32 v58, 0
    v_mov_b32 v59, 0
    s_nop 1
    v_mfma_f32_32x32x16_bf16 v[128:143], v[56:59], v[56:59], 0
    v_mfma_f32_32x32x16_bf16 v[144:159], v[56:59], v[56:59], 0
    v_mfma_f32_32x32x16_bf16 v[160:175], v[56:59], v[56:59], 0
    v_mfma_f32_32x32x16_bf16 v[176:191], v[56:59], v[56:59], 0
    s_mov_b32 s33, vcc_lo
    s_bitcmp1_b32 s33, 0
    s_cbranch_scc0 op_late_125
    buffer_load_dwordx4 a[128:131], v88, s[8:11], s62 offen offset:0 sc1
    buffer_load_dwordx4 a[132:135], v88, s[8:11], s62 offen offset:1024 sc1
    buffer_load_dwordx4 a[136:139], v89, s[8:11], s62 offen offset:0 sc1
    buffer_load_dwordx4 a[140:143], v89, s[8:11], s62 offen offset:1024 sc1
    s_add_u32 s62, s62, 0x40000
    s_and_b32 s62, s62, 0x7fffff
    buffer_load_dwordx4 a[144:147], v88, s[8:11], s62 offen offset:0 sc1
    buffer_load_dwordx4 a[148:151], v88, s[8:11], s62 offen offset:1024 sc1
    buffer_load_dwordx4 a[152:155], v89, s[8:11], s62 offen offset:0 sc1
    buffer_load_dwordx4 a[156:159], v89, s[8:11], s62 offen offset:1024 sc1
    s_add_u32 s62, s62, 0x40000
    s_and_b32 s62, s62, 0x7fffff
    buffer_load_dwordx4 a[160:163], v88, s[8:11], s62 offen offset:0 sc1
    buffer_load_dwordx4 a[164:167], v88, s[8:11], s62 offen offset:1024 sc1
    buffer_load_dwordx4 a[168:171], v89, s[8:11], s62 offen offset:0 sc1
    buffer_load_dwordx4 a[172:175], v89, s[8:11], s62 offen offset:1024 sc1
    s_add_u32 s62, s62, 0x40000
    s_and_b32 s62, s62, 0x7fffff
    s_waitcnt vmcnt(12)
    s_branch op_join_126
op_late_125:
    s_waitcnt vmcnt(0)
op_join_126:
    s_barrier
    s_cmp_eq_u32 s30, 0
    s_cbranch_scc1 k12_ool_127
k12_oolret_128:
    s_bitcmp0_b32 s33, 0
    s_cbranch_scc1 k12_ool_131
k12_oolret_132:
    ds_read_b64_tr_b16 a[0:1], v64 offset:0
    ds_read_b64_tr_b16 a[2:3], v64 offset:4096
    ds_read_b64_tr_b16 a[4:5], v65 offset:0
    ds_read_b64_tr_b16 a[6:7], v65 offset:4096
    ds_read_b64_tr_b16 a[8:9], v66 offset:0
    ds_read_b64_tr_b16 a[10:11], v66 offset:4096
    ds_read_b64_tr_b16 a[12:13], v67 offset:0
    ds_read_b64_tr_b16 a[14:15], v67 offset:4096
    ds_read_b64_tr_b16 a[16:17], v68 offset:0
    ds_read_b64_tr_b16 a[18:19], v68 offset:4096
    ds_read_b64_tr_b16 a[20:21], v69 offset:0
    ds_read_b64_tr_b16 a[22:23], v69 offset:4096
    ds_read_b64_tr_b16 a[24:25], v70 offset:0
    ds_read_b64_tr_b16 a[26:27], v70 offset:4096
    ds_read_b64_tr_b16 a[28:29], v71 offset:0
    ds_read_b64_tr_b16 a[30:31], v71 offset:4096
    ds_read_b64_tr_b16 a[32:33], v64 offset:8192
    ds_read_b64_tr_b16 a[34:35], v64 offset:12288
    ds_read_b64_tr_b16 a[36:37], v65 offset:8192
    ds_read_b64_tr_b16 a[38:39], v65 offset:12288
    ds_read_b64_tr_b16 a[40:41], v66 offset:8192
    ds_read_b64_tr_b16 a[42:43], v66 offset:12288
    ds_read_b64_tr_b16 a[44:45], v67 offset:8192
    ds_read_b64_tr_b16 a[46:47], v67 offset:12288
    ds_read_b64_tr_b16 a[48:49], v68 offset:8192
    ds_read_b64_tr_b16 a[50:51], v68 offset:12288
    ds_read_b64_tr_b16 a[52:53], v69 offset:8192
    ds_read_b64_tr_b16 a[54:55], v69 offset:12288
    ds_read_b64_tr_b16 a[56:57], v70 offset:8192
    ds_read_b64_tr_b16 a[58:59], v70 offset:12288
    ds_read_b64_tr_b16 a[60:61], v71 offset:8192
    ds_read_b64_tr_b16 a[62:63], v71 offset:12288
    s_add_u32 s24, s6, 0x4000000
    s_addc_u32 s25, s7, 0
    s_and_b32 s25, s25, 0xffff
    s_mov_b32 s26, 0x400000
    s_mov_b32 s27, 0x00020000
    s_add_u32 s36, s6, 0x5000000
    s_addc_u32 s37, s7, 0
    s_and_b32 s37, s37, 0xffff
    s_mov_b32 s38, 0x800000
    s_mov_b32 s39, 0x00020000
    s_add_u32 s48, s6, 0x4807000
    s_addc_u32 s49, s7, 0
    s_and_b32 s49, s49, 0xffff
    s_mov_b32 s50, 0x8000
    s_mov_b32 s51, 0x00020000
    s_lshl_b32 s52, s2, 14
    s_add_u32 s52, s52, s60
    s_xor_b32 s53, s52, 0x10000
    s_lshl_b32 s57, s2, 7
    s_xor_b32 s58, s57, 0x200
    v_lshrrev_b32 v56, 4, v1
    s_lshl_b32 s31, s30, 6
    s_and_b32 s31, s31, 64
    v_add_u32 v56, s31, v56
    s_mov_b32 s31, (code_end-op_tail)/128
    v_min_u32 v56, s31, v56
    s_getpc_b64 s[40:41]
pc_133:
    s_add_u32 s40, s40, op_tail-pc_133
    s_addc_u32 s41, s41, 0
    v_lshlrev_b32 v82, 7, v56
    v_mov_b32 v83, s41
    v_add_co_u32 v82, vcc, s40, v82
    s_nop 1
    v_addc_co_u32 v83, vcc, 0, v83, vcc
    v_lshlrev_b32 v94, 3, v1
    s_and_b32 s35, s2, 7
    s_mul_i32 s35, s35, 28
    s_lshr_b32 s31, s2, 3
    s_add_u32 s55, s35, s31
    s_lshl_b32 s3, s55, 15
    s_lshl_b32 s31, s30, 13
    s_add_u32 s3, s3, s31
    s_add_u32 s35, s31, 65536
    s_mov_b32 s63, 0
    s_waitcnt vmcnt(8) lgkmcnt(0)
    s_mov_b32 s20, s28
    s_and_b32 s21, s29, 0xffff
    s_mov_b32 s22, 0x400000
    s_mov_b32 s23, 0x00020000
    s_mov_b32 s44, s42
    s_and_b32 s45, s43, 0xffff
    s_mov_b32 s46, 0x800
    s_mov_b32 s47, 0x00020000
op_loop_134:
    v_mfma_f32_16x16x32_bf16 v[160:163], a[16:19], a[128:131], v[160:163]
    s_add_u32 m0, s60, 49152
    ds_read_b64_tr_b16 a[64:65], v64 offset:16384
    ds_read_b64_tr_b16 a[66:67], v64 offset:20480
    v_mfma_f32_16x16x32_bf16 v[160:163], a[48:51], a[136:139], v[160:163]
    buffer_load_dwordx4 v90, s[12:15], s61 offen offset:0 lds
    ds_read_b64_tr_b16 a[68:69], v65 offset:16384
    v_mfma_f32_16x16x32_bf16 v[164:167], a[48:51], a[140:143], v[164:167]
    ds_read_b64_tr_b16 a[70:71], v65 offset:20480
    ds_read_b64_tr_b16 a[72:73], v66 offset:16384
    v_mfma_f32_16x16x32_bf16 v[164:167], a[16:19], a[132:135], v[164:167]
    buffer_load_dwordx4 v91, s[12:15], s61 offen offset:1024 lds
    ds_read_b64_tr_b16 a[74:75], v66 offset:20480
    v_mfma_f32_16x16x32_bf16 v[172:175], a[20:23], a[132:135], v[172:175]
    ds_read_b64_tr_b16 a[76:77], v67 offset:16384
    ds_read_b64_tr_b16 a[78:79], v67 offset:20480
    v_mfma_f32_16x16x32_bf16 v[172:175], a[52:55], a[140:143], v[172:175]
    ds_read_b64_tr_b16 a[80:81], v68 offset:16384
    v_mfma_f32_16x16x32_bf16 v[168:171], a[52:55], a[136:139], v[168:171]
    ds_read_b64_tr_b16 a[82:83], v68 offset:20480
    v_mfma_f32_16x16x32_bf16 v[168:171], a[20:23], a[128:131], v[168:171]
    buffer_load_dwordx4 v92, s[12:15], s61 offen offset:2048 lds
    ds_read_b64_tr_b16 a[84:85], v69 offset:16384
    v_mfma_f32_16x16x32_bf16 v[176:179], a[24:27], a[128:131], v[176:179]
    ds_read_b64_tr_b16 a[86:87], v69 offset:20480
    ds_read_b64_tr_b16 a[88:89], v70 offset:16384
    v_mfma_f32_16x16x32_bf16 v[176:179], a[56:59], a[136:139], v[176:179]
    ds_read_b64_tr_b16 a[90:91], v70 offset:20480
    v_mfma_f32_16x16x32_bf16 v[180:183], a[56:59], a[140:143], v[180:183]
    buffer_load_dwordx4 v93, s[12:15], s61 offen offset:3072 lds
    ds_read_b64_tr_b16 a[92:93], v71 offset:16384
    v_mfma_f32_16x16x32_bf16 v[180:183], a[24:27], a[132:135], v[180:183]
    ds_read_b64_tr_b16 a[94:95], v71 offset:20480
    ds_read_b64_tr_b16 a[96:97], v64 offset:24576
    v_mfma_f32_16x16x32_bf16 v[188:191], a[28:31], a[132:135], v[188:191]
    ds_read_b64_tr_b16 a[98:99], v64 offset:28672
    v_mfma_f32_16x16x32_bf16 v[188:191], a[60:63], a[140:143], v[188:191]
    ds_read_b64_tr_b16 a[100:101], v65 offset:24576
    v_mfma_f32_16x16x32_bf16 v[184:187], a[60:63], a[136:139], v[184:187]
    buffer_load_dwordx4 a[176:179], v88, s[8:11], s62 offen offset:0 sc1
    ds_read_b64_tr_b16 a[102:103], v65 offset:28672
    v_mfma_f32_16x16x32_bf16 v[184:187], a[28:31], a[128:131], v[184:187]
    s_add_u32 s61, s61, 0x20000
    s_and_b32 s61, s61, 0x3fffff
    ds_read_b64_tr_b16 a[104:105], v66 offset:24576
    ds_read_b64_tr_b16 a[106:107], v66 offset:28672
    v_mfma_f32_16x16x32_bf16 v[128:131], a[0:3], a[128:131], v[128:131]
    ds_read_b64_tr_b16 a[108:109], v67 offset:24576
    v_mfma_f32_16x16x32_bf16 v[128:131], a[32:35], a[136:139], v[128:131]
    buffer_load_dwordx4 a[180:183], v88, s[8:11], s62 offen offset:1024 sc1
    ds_read_b64_tr_b16 a[110:111], v67 offset:28672
    v_mfma_f32_16x16x32_bf16 v[132:135], a[32:35], a[140:143], v[132:135]
    ds_read_b64_tr_b16 a[112:113], v68 offset:24576
    v_mfma_f32_16x16x32_bf16 v[132:135], a[0:3], a[132:135], v[132:135]
    ds_read_b64_tr_b16 a[114:115], v68 offset:28672
    ds_read_b64_tr_b16 a[116:117], v69 offset:24576
    v_mfma_f32_16x16x32_bf16 v[140:143], a[4:7], a[132:135], v[140:143]
    ds_read_b64_tr_b16 a[118:119], v69 offset:28672
    v_mfma_f32_16x16x32_bf16 v[140:143], a[36:39], a[140:143], v[140:143]
    buffer_load_dwordx4 a[184:187], v89, s[8:11], s62 offen offset:0 sc1
    ds_read_b64_tr_b16 a[120:121], v70 offset:24576
    v_mfma_f32_16x16x32_bf16 v[136:139], a[36:39], a[136:139], v[136:139]
    ds_read_b64_tr_b16 a[122:123], v70 offset:28672
    ds_read_b64_tr_b16 a[124:125], v71 offset:24576
    v_mfma_f32_16x16x32_bf16 v[136:139], a[4:7], a[128:131], v[136:139]
    ds_read_b64_tr_b16 a[126:127], v71 offset:28672
    v_mfma_f32_16x16x32_bf16 v[144:147], a[8:11], a[128:131], v[144:147]
    buffer_load_dwordx4 a[188:191], v89, s[8:11], s62 offen offset:1024 sc1
    v_mfma_f32_16x16x32_bf16 v[144:147], a[40:43], a[136:139], v[144:147]
    v_mfma_f32_16x16x32_bf16 v[148:151], a[40:43], a[140:143], v[148:151]
    v_mfma_f32_16x16x32_bf16 v[148:151], a[8:11], a[132:135], v[148:151]
    v_mfma_f32_16x16x32_bf16 v[156:159], a[12:15], a[132:135], v[156:159]
    s_cmp_eq_u32 s63, 7
    s_cbranch_scc1 k12_ool_137
k12_oolret_138:
    v_mfma_f32_16x16x32_bf16 v[156:159], a[44:47], a[140:143], v[156:159]
    s_add_u32 s62, s62, 0x40000
    s_and_b32 s62, s62, 0x7fffff
    v_mfma_f32_16x16x32_bf16 v[152:155], a[44:47], a[136:139], v[152:155]
    v_mfma_f32_16x16x32_bf16 v[152:155], a[12:15], a[128:131], v[152:155]
    s_waitcnt vmcnt(12) lgkmcnt(0)
    s_barrier
    v_mfma_f32_16x16x32_bf16 v[160:163], a[80:83], a[144:147], v[160:163]
    s_add_u32 s32, s63, 1
    s_lshr_b32 s32, s32, 1
    ds_read_b64_tr_b16 a[0:1], v64 offset:32768
    v_cmp_le_u32 vcc, 4, v74
    v_mfma_f32_16x16x32_bf16 v[160:163], a[112:115], a[152:155], v[160:163]
    s_add_u32 m0, s60, 0
    ds_read_b64_tr_b16 a[2:3], v64 offset:36864
    ds_read_b64_tr_b16 a[4:5], v65 offset:32768
    v_mfma_f32_16x16x32_bf16 v[164:167], a[112:115], a[156:159], v[164:167]
    s_or_b32 s33, vcc_lo, 16
    buffer_load_dwordx4 v90, s[12:15], s61 offen offset:0 lds
    ds_read_b64_tr_b16 a[6:7], v65 offset:36864
    v_mfma_f32_16x16x32_bf16 v[164:167], a[80:83], a[148:151], v[164:167]
    ds_read_b64_tr_b16 a[8:9], v66 offset:32768
    ds_read_b64_tr_b16 a[10:11], v66 offset:36864
    v_mfma_f32_16x16x32_bf16 v[172:175], a[84:87], a[148:151], v[172:175]
    buffer_load_dwordx4 v91, s[12:15], s61 offen offset:1024 lds
    ds_read_b64_tr_b16 a[12:13], v67 offset:32768
    v_mfma_f32_16x16x32_bf16 v[172:175], a[116:119], a[156:159], v[172:175]
    ds_read_b64_tr_b16 a[14:15], v67 offset:36864
    ds_read_b64_tr_b16 a[16:17], v68 offset:32768
    v_mfma_f32_16x16x32_bf16 v[168:171], a[116:119], a[152:155], v[168:171]
    s_bitcmp0_b32 s33, s32
    s_cbranch_scc1 k12_ool_141
k12_oolret_142:
    v_mfma_f32_16x16x32_bf16 v[168:171], a[84:87], a[144:147], v[168:171]
    ds_read_b64_tr_b16 a[18:19], v68 offset:36864
    ds_read_b64_tr_b16 a[20:21], v69 offset:32768
    v_mfma_f32_16x16x32_bf16 v[176:179], a[88:91], a[144:147], v[176:179]
    buffer_load_dwordx4 v92, s[12:15], s61 offen offset:2048 lds
    ds_read_b64_tr_b16 a[22:23], v69 offset:36864
    v_mfma_f32_16x16x32_bf16 v[176:179], a[120:123], a[152:155], v[176:179]
    ds_read_b64_tr_b16 a[24:25], v70 offset:32768
    ds_read_b64_tr_b16 a[26:27], v70 offset:36864
    v_mfma_f32_16x16x32_bf16 v[180:183], a[120:123], a[156:159], v[180:183]
    buffer_load_dwordx4 v93, s[12:15], s61 offen offset:3072 lds
    ds_read_b64_tr_b16 a[28:29], v71 offset:32768
    v_mfma_f32_16x16x32_bf16 v[180:183], a[88:91], a[148:151], v[180:183]
    ds_read_b64_tr_b16 a[30:31], v71 offset:36864
    ds_read_b64_tr_b16 a[32:33], v64 offset:40960
    v_mfma_f32_16x16x32_bf16 v[188:191], a[92:95], a[148:151], v[188:191]
    ds_read_b64_tr_b16 a[34:35], v64 offset:45056
    v_mfma_f32_16x16x32_bf16 v[188:191], a[124:127], a[156:159], v[188:191]
    ds_read_b64_tr_b16 a[36:37], v65 offset:40960
    v_mfma_f32_16x16x32_bf16 v[184:187], a[124:127], a[152:155], v[184:187]
    buffer_load_dwordx4 a[128:131], v88, s[8:11], s62 offen offset:0 sc1
    ds_read_b64_tr_b16 a[38:39], v65 offset:45056
    v_mfma_f32_16x16x32_bf16 v[184:187], a[92:95], a[144:147], v[184:187]
    s_add_u32 s61, s61, 0x20000
    s_and_b32 s61, s61, 0x3fffff
    ds_read_b64_tr_b16 a[40:41], v66 offset:40960
    ds_read_b64_tr_b16 a[42:43], v66 offset:45056
    v_mfma_f32_16x16x32_bf16 v[128:131], a[64:67], a[144:147], v[128:131]
    ds_read_b64_tr_b16 a[44:45], v67 offset:40960
    v_mfma_f32_16x16x32_bf16 v[128:131], a[96:99], a[152:155], v[128:131]
    buffer_load_dwordx4 a[132:135], v88, s[8:11], s62 offen offset:1024 sc1
    ds_read_b64_tr_b16 a[46:47], v67 offset:45056
    v_mfma_f32_16x16x32_bf16 v[132:135], a[96:99], a[156:159], v[132:135]
    ds_read_b64_tr_b16 a[48:49], v68 offset:40960
    v_mfma_f32_16x16x32_bf16 v[132:135], a[64:67], a[148:151], v[132:135]
    ds_read_b64_tr_b16 a[50:51], v68 offset:45056
    ds_read_b64_tr_b16 a[52:53], v69 offset:40960
    v_mfma_f32_16x16x32_bf16 v[140:143], a[68:71], a[148:151], v[140:143]
    ds_read_b64_tr_b16 a[54:55], v69 offset:45056
    v_mfma_f32_16x16x32_bf16 v[140:143], a[100:103], a[156:159], v[140:143]
    buffer_load_dwordx4 a[136:139], v89, s[8:11], s62 offen offset:0 sc1
    ds_read_b64_tr_b16 a[56:57], v70 offset:40960
    v_mfma_f32_16x16x32_bf16 v[136:139], a[100:103], a[152:155], v[136:139]
    ds_read_b64_tr_b16 a[58:59], v70 offset:45056
    ds_read_b64_tr_b16 a[60:61], v71 offset:40960
    v_mfma_f32_16x16x32_bf16 v[136:139], a[68:71], a[144:147], v[136:139]
    ds_read_b64_tr_b16 a[62:63], v71 offset:45056
    v_mfma_f32_16x16x32_bf16 v[144:147], a[72:75], a[144:147], v[144:147]
    buffer_load_dwordx4 a[140:143], v89, s[8:11], s62 offen offset:1024 sc1
    v_mfma_f32_16x16x32_bf16 v[144:147], a[104:107], a[152:155], v[144:147]
    v_mfma_f32_16x16x32_bf16 v[148:151], a[104:107], a[156:159], v[148:151]
    s_cmp_eq_u32 s63, 6
    s_cbranch_scc1 k12_ool_143
k12_oolret_144:
    v_mfma_f32_16x16x32_bf16 v[148:151], a[72:75], a[148:151], v[148:151]
    v_mfma_f32_16x16x32_bf16 v[156:159], a[76:79], a[148:151], v[156:159]
    v_mfma_f32_16x16x32_bf16 v[156:159], a[108:111], a[156:159], v[156:159]
    s_add_u32 s62, s62, 0x40000
    s_and_b32 s62, s62, 0x7fffff
    v_mfma_f32_16x16x32_bf16 v[152:155], a[108:111], a[152:155], v[152:155]
    v_mfma_f32_16x16x32_bf16 v[152:155], a[76:79], a[144:147], v[152:155]
    s_waitcnt vmcnt(12) lgkmcnt(0)
    s_barrier
    v_mfma_f32_16x16x32_bf16 v[160:163], a[16:19], a[160:163], v[160:163]
    s_add_u32 m0, s60, 16384
    buffer_load_dword v74, v73, s[16:19], s59 offen sc1
    ds_read_b64_tr_b16 a[64:65], v64 offset:49152
    v_mfma_f32_16x16x32_bf16 v[160:163], a[48:51], a[168:171], v[160:163]
    buffer_load_dwordx4 v90, s[12:15], s61 offen offset:0 lds
    ds_read_b64_tr_b16 a[66:67], v64 offset:53248
    v_mfma_f32_16x16x32_bf16 v[164:167], a[48:51], a[172:175], v[164:167]
    ds_read_b64_tr_b16 a[68:69], v65 offset:49152
    ds_read_b64_tr_b16 a[70:71], v65 offset:53248
    v_mfma_f32_16x16x32_bf16 v[164:167], a[16:19], a[164:167], v[164:167]
    ds_read_b64_tr_b16 a[72:73], v66 offset:49152
    ds_read_b64_tr_b16 a[74:75], v66 offset:53248
    v_mfma_f32_16x16x32_bf16 v[172:175], a[20:23], a[164:167], v[172:175]
    buffer_load_dwordx4 v91, s[12:15], s61 offen offset:1024 lds
    ds_read_b64_tr_b16 a[76:77], v67 offset:49152
    v_mfma_f32_16x16x32_bf16 v[172:175], a[52:55], a[172:175], v[172:175]
    ds_read_b64_tr_b16 a[78:79], v67 offset:53248
    ds_read_b64_tr_b16 a[80:81], v68 offset:49152
    v_mfma_f32_16x16x32_bf16 v[168:171], a[52:55], a[168:171], v[168:171]
    ds_read_b64_tr_b16 a[82:83], v68 offset:53248
    v_mfma_f32_16x16x32_bf16 v[168:171], a[20:23], a[160:163], v[168:171]
    buffer_load_dwordx4 v92, s[12:15], s61 offen offset:2048 lds
    ds_read_b64_tr_b16 a[84:85], v69 offset:49152
    v_mfma_f32_16x16x32_bf16 v[176:179], a[24:27], a[160:163], v[176:179]
    ds_read_b64_tr_b16 a[86:87], v69 offset:53248
    ds_read_b64_tr_b16 a[88:89], v70 offset:49152
    v_mfma_f32_16x16x32_bf16 v[176:179], a[56:59], a[168:171], v[176:179]
    ds_read_b64_tr_b16 a[90:91], v70 offset:53248
    v_mfma_f32_16x16x32_bf16 v[180:183], a[56:59], a[172:175], v[180:183]
    buffer_load_dwordx4 v93, s[12:15], s61 offen offset:3072 lds
    ds_read_b64_tr_b16 a[92:93], v71 offset:49152
    v_mfma_f32_16x16x32_bf16 v[180:183], a[24:27], a[164:167], v[180:183]
    ds_read_b64_tr_b16 a[94:95], v71 offset:53248
    ds_read_b64_tr_b16 a[96:97], v64 offset:57344
    v_mfma_f32_16x16x32_bf16 v[188:191], a[28:31], a[164:167], v[188:191]
    ds_read_b64_tr_b16 a[98:99], v64 offset:61440
    v_mfma_f32_16x16x32_bf16 v[188:191], a[60:63], a[172:175], v[188:191]
    ds_read_b64_tr_b16 a[100:101], v65 offset:57344
    v_mfma_f32_16x16x32_bf16 v[184:187], a[60:63], a[168:171], v[184:187]
    buffer_load_dwordx4 a[144:147], v88, s[8:11], s62 offen offset:0 sc1
    ds_read_b64_tr_b16 a[102:103], v65 offset:61440
    v_mfma_f32_16x16x32_bf16 v[184:187], a[28:31], a[160:163], v[184:187]
    s_add_u32 s61, s61, 0x20000
    s_and_b32 s61, s61, 0x3fffff
    ds_read_b64_tr_b16 a[104:105], v66 offset:57344
    ds_read_b64_tr_b16 a[106:107], v66 offset:61440
    v_mfma_f32_16x16x32_bf16 v[128:131], a[0:3], a[160:163], v[128:131]
    ds_read_b64_tr_b16 a[108:109], v67 offset:57344
    v_mfma_f32_16x16x32_bf16 v[128:131], a[32:35], a[168:171], v[128:131]
    buffer_load_dwordx4 a[148:151], v88, s[8:11], s62 offen offset:1024 sc1
    ds_read_b64_tr_b16 a[110:111], v67 offset:61440
    v_mfma_f32_16x16x32_bf16 v[132:135], a[32:35], a[172:175], v[132:135]
    ds_read_b64_tr_b16 a[112:113], v68 offset:57344
    v_mfma_f32_16x16x32_bf16 v[132:135], a[0:3], a[164:167], v[132:135]
    ds_read_b64_tr_b16 a[114:115], v68 offset:61440
    ds_read_b64_tr_b16 a[116:117], v69 offset:57344
    v_mfma_f32_16x16x32_bf16 v[140:143], a[4:7], a[164:167], v[140:143]
    ds_read_b64_tr_b16 a[118:119], v69 offset:61440
    v_mfma_f32_16x16x32_bf16 v[140:143], a[36:39], a[172:175], v[140:143]
    buffer_load_dwordx4 a[152:155], v89, s[8:11], s62 offen offset:0 sc1
    ds_read_b64_tr_b16 a[120:121], v70 offset:57344
    v_mfma_f32_16x16x32_bf16 v[136:139], a[36:39], a[168:171], v[136:139]
    ds_read_b64_tr_b16 a[122:123], v70 offset:61440
    ds_read_b64_tr_b16 a[124:125], v71 offset:57344
    v_mfma_f32_16x16x32_bf16 v[136:139], a[4:7], a[160:163], v[136:139]
    ds_read_b64_tr_b16 a[126:127], v71 offset:61440
    v_mfma_f32_16x16x32_bf16 v[144:147], a[8:11], a[160:163], v[144:147]
    buffer_load_dwordx4 a[156:159], v89, s[8:11], s62 offen offset:1024 sc1
    v_mfma_f32_16x16x32_bf16 v[144:147], a[40:43], a[168:171], v[144:147]
    v_mfma_f32_16x16x32_bf16 v[148:151], a[40:43], a[172:175], v[148:151]
    v_mfma_f32_16x16x32_bf16 v[148:151], a[8:11], a[164:167], v[148:151]
    v_mfma_f32_16x16x32_bf16 v[156:159], a[12:15], a[164:167], v[156:159]
    v_mfma_f32_16x16x32_bf16 v[156:159], a[44:47], a[172:175], v[156:159]
    s_add_u32 s62, s62, 0x40000
    s_and_b32 s62, s62, 0x7fffff
    v_mfma_f32_16x16x32_bf16 v[152:155], a[44:47], a[168:171], v[152:155]
    v_mfma_f32_16x16x32_bf16 v[152:155], a[12:15], a[160:163], v[152:155]
    s_waitcnt vmcnt(12) lgkmcnt(0)
    s_barrier
    v_mfma_f32_16x16x32_bf16 v[160:163], a[80:83], a[176:179], v[160:163]
    s_add_u32 m0, s60, 32768
    ds_read_b64_tr_b16 a[0:1], v64 offset:0
    ds_read_b64_tr_b16 a[2:3], v64 offset:4096
    v_mfma_f32_16x16x32_bf16 v[160:163], a[112:115], a[184:187], v[160:163]
    buffer_load_dwordx4 v90, s[12:15], s61 offen offset:0 lds
    ds_read_b64_tr_b16 a[4:5], v65 offset:0
    v_mfma_f32_16x16x32_bf16 v[164:167], a[112:115], a[188:191], v[164:167]
    ds_read_b64_tr_b16 a[6:7], v65 offset:4096
    ds_read_b64_tr_b16 a[8:9], v66 offset:0
    v_mfma_f32_16x16x32_bf16 v[164:167], a[80:83], a[180:183], v[164:167]
    buffer_load_dwordx4 v91, s[12:15], s61 offen offset:1024 lds
    ds_read_b64_tr_b16 a[10:11], v66 offset:4096
    v_mfma_f32_16x16x32_bf16 v[172:175], a[84:87], a[180:183], v[172:175]
    ds_read_b64_tr_b16 a[12:13], v67 offset:0
    ds_read_b64_tr_b16 a[14:15], v67 offset:4096
    v_mfma_f32_16x16x32_bf16 v[172:175], a[116:119], a[188:191], v[172:175]
    ds_read_b64_tr_b16 a[16:17], v68 offset:0
    v_mfma_f32_16x16x32_bf16 v[168:171], a[116:119], a[184:187], v[168:171]
    ds_read_b64_tr_b16 a[18:19], v68 offset:4096
    v_mfma_f32_16x16x32_bf16 v[168:171], a[84:87], a[176:179], v[168:171]
    buffer_load_dwordx4 v92, s[12:15], s61 offen offset:2048 lds
    ds_read_b64_tr_b16 a[20:21], v69 offset:0
    v_mfma_f32_16x16x32_bf16 v[176:179], a[88:91], a[176:179], v[176:179]
    ds_read_b64_tr_b16 a[22:23], v69 offset:4096
    ds_read_b64_tr_b16 a[24:25], v70 offset:0
    v_mfma_f32_16x16x32_bf16 v[176:179], a[120:123], a[184:187], v[176:179]
    ds_read_b64_tr_b16 a[26:27], v70 offset:4096
    v_mfma_f32_16x16x32_bf16 v[180:183], a[120:123], a[188:191], v[180:183]
    buffer_load_dwordx4 v93, s[12:15], s61 offen offset:3072 lds
    ds_read_b64_tr_b16 a[28:29], v71 offset:0
    v_mfma_f32_16x16x32_bf16 v[180:183], a[88:91], a[180:183], v[180:183]
    ds_read_b64_tr_b16 a[30:31], v71 offset:4096
    ds_read_b64_tr_b16 a[32:33], v64 offset:8192
    v_mfma_f32_16x16x32_bf16 v[188:191], a[92:95], a[180:183], v[188:191]
    ds_read_b64_tr_b16 a[34:35], v64 offset:12288
    v_mfma_f32_16x16x32_bf16 v[188:191], a[124:127], a[188:191], v[188:191]
    ds_read_b64_tr_b16 a[36:37], v65 offset:8192
    v_mfma_f32_16x16x32_bf16 v[184:187], a[124:127], a[184:187], v[184:187]
    buffer_load_dwordx4 a[160:163], v88, s[8:11], s62 offen offset:0 sc1
    ds_read_b64_tr_b16 a[38:39], v65 offset:12288
    v_mfma_f32_16x16x32_bf16 v[184:187], a[92:95], a[176:179], v[184:187]
    s_add_u32 s61, s61, 0x20000
    s_and_b32 s61, s61, 0x3fffff
    ds_read_b64_tr_b16 a[40:41], v66 offset:8192
    ds_read_b64_tr_b16 a[42:43], v66 offset:12288
    v_mfma_f32_16x16x32_bf16 v[128:131], a[64:67], a[176:179], v[128:131]
    ds_read_b64_tr_b16 a[44:45], v67 offset:8192
    v_mfma_f32_16x16x32_bf16 v[128:131], a[96:99], a[184:187], v[128:131]
    buffer_load_dwordx4 a[164:167], v88, s[8:11], s62 offen offset:1024 sc1
    ds_read_b64_tr_b16 a[46:47], v67 offset:12288
    v_mfma_f32_16x16x32_bf16 v[132:135], a[96:99], a[188:191], v[132:135]
    ds_read_b64_tr_b16 a[48:49], v68 offset:8192
    v_mfma_f32_16x16x32_bf16 v[132:135], a[64:67], a[180:183], v[132:135]
    ds_read_b64_tr_b16 a[50:51], v68 offset:12288
    ds_read_b64_tr_b16 a[52:53], v69 offset:8192
    v_mfma_f32_16x16x32_bf16 v[140:143], a[68:71], a[180:183], v[140:143]
    ds_read_b64_tr_b16 a[54:55], v69 offset:12288
    v_mfma_f32_16x16x32_bf16 v[140:143], a[100:103], a[188:191], v[140:143]
    buffer_load_dwordx4 a[168:171], v89, s[8:11], s62 offen offset:0 sc1
    ds_read_b64_tr_b16 a[56:57], v70 offset:8192
    v_mfma_f32_16x16x32_bf16 v[136:139], a[100:103], a[184:187], v[136:139]
    ds_read_b64_tr_b16 a[58:59], v70 offset:12288
    ds_read_b64_tr_b16 a[60:61], v71 offset:8192
    v_mfma_f32_16x16x32_bf16 v[136:139], a[68:71], a[176:179], v[136:139]
    ds_read_b64_tr_b16 a[62:63], v71 offset:12288
    v_mfma_f32_16x16x32_bf16 v[144:147], a[72:75], a[176:179], v[144:147]
    buffer_load_dwordx4 a[172:175], v89, s[8:11], s62 offen offset:1024 sc1
    v_mfma_f32_16x16x32_bf16 v[144:147], a[104:107], a[184:187], v[144:147]
    v_mfma_f32_16x16x32_bf16 v[148:151], a[104:107], a[188:191], v[148:151]
    v_mfma_f32_16x16x32_bf16 v[148:151], a[72:75], a[180:183], v[148:151]
    v_mfma_f32_16x16x32_bf16 v[156:159], a[76:79], a[180:183], v[156:159]
    v_mfma_f32_16x16x32_bf16 v[156:159], a[108:111], a[188:191], v[156:159]
    s_add_u32 s62, s62, 0x40000
    s_and_b32 s62, s62, 0x7fffff
    v_mfma_f32_16x16x32_bf16 v[152:155], a[108:111], a[184:187], v[152:155]
    s_add_u32 s63, s63, 1
    v_mfma_f32_16x16x32_bf16 v[152:155], a[76:79], a[176:179], v[152:155]
    s_waitcnt vmcnt(12) lgkmcnt(0)
    s_barrier
    s_cmp_lt_u32 s63, 8
    s_cbranch_scc1 op_loop_134
op_tail:
    s_nop 1
    v_cvt_pk_bf16_f32 v160, v160, v161
    v_cvt_pk_bf16_f32 v161, v162, v163
    v_cvt_pk_bf16_f32 v162, v164, v165
    v_cvt_pk_bf16_f32 v163, v166, v167
    v_min_u32 v160, -2, v160
    v_min_u32 v161, -2, v161
    v_min_u32 v162, -2, v162
    v_min_u32 v163, -2, v163
    buffer_store_dwordx4 v[160:163], v1, s[36:39], s52 offen offset:0 sc1
    v_cvt_pk_bf16_f32 v168, v168, v169
    v_cvt_pk_bf16_f32 v169, v170, v171
    v_cvt_pk_bf16_f32 v170, v172, v173
    v_cvt_pk_bf16_f32 v171, v174, v175
    v_min_u32 v168, -2, v168
    v_min_u32 v169, -2, v169
    v_min_u32 v170, -2, v170
    v_min_u32 v171, -2, v171
    buffer_store_dwordx4 v[168:171], v1, s[36:39], s52 offen offset:1024 sc1
    v_cvt_pk_bf16_f32 v176, v176, v177
    v_cvt_pk_bf16_f32 v177, v178, v179
    v_cvt_pk_bf16_f32 v178, v180, v181
    v_cvt_pk_bf16_f32 v179, v182, v183
    v_min_u32 v176, -2, v176
    v_min_u32 v177, -2, v177
    v_min_u32 v178, -2, v178
    v_min_u32 v179, -2, v179
    buffer_store_dwordx4 v[176:179], v1, s[36:39], s52 offen offset:2048 sc1
    v_cvt_pk_bf16_f32 v184, v184, v185
    v_cvt_pk_bf16_f32 v185, v186, v187
    v_cvt_pk_bf16_f32 v186, v188, v189
    v_cvt_pk_bf16_f32 v187, v190, v191
    v_min_u32 v184, -2, v184
    v_min_u32 v185, -2, v185
    v_min_u32 v186, -2, v186
    v_min_u32 v187, -2, v187
    buffer_store_dwordx4 v[184:187], v1, s[36:39], s52 offen offset:3072 sc1
    s_add_u32 s32, s6, 0x4800000
    s_addc_u32 s33, s7, 0
    s_and_b32 s33, s33, 0xffff
    s_mov_b32 s34, 0x6000
    s_mov_b32 s35, 0x00020000
    s_waitcnt vmcnt(4) lgkmcnt(0)
    v_lshlrev_b32 v58, 16, v192
    v_and_b32 v59, 0xffff0000, v192
    v_pk_add_f32 v[128:129], v[128:129], v[58:59]
    v_lshlrev_b32 v58, 16, v193
    v_and_b32 v59, 0xffff0000, v193
    v_pk_add_f32 v[130:131], v[130:131], v[58:59]
    v_lshlrev_b32 v58, 16, v200
    v_and_b32 v59, 0xffff0000, v200
    v_pk_add_f32 v[132:133], v[132:133], v[58:59]
    v_lshlrev_b32 v58, 16, v201
    v_and_b32 v59, 0xffff0000, v201
    v_pk_add_f32 v[134:135], v[134:135], v[58:59]
    v_lshlrev_b32 v58, 16, v194
    v_and_b32 v59, 0xffff0000, v194
    v_pk_add_f32 v[136:137], v[136:137], v[58:59]
    v_lshlrev_b32 v58, 16, v195
    v_and_b32 v59, 0xffff0000, v195
    v_pk_add_f32 v[138:139], v[138:139], v[58:59]
    v_lshlrev_b32 v58, 16, v202
    v_and_b32 v59, 0xffff0000, v202
    v_pk_add_f32 v[140:141], v[140:141], v[58:59]
    v_lshlrev_b32 v58, 16, v203
    v_and_b32 v59, 0xffff0000, v203
    v_pk_add_f32 v[142:143], v[142:143], v[58:59]
    v_lshlrev_b32 v58, 16, v196
    v_and_b32 v59, 0xffff0000, v196
    v_pk_add_f32 v[144:145], v[144:145], v[58:59]
    v_lshlrev_b32 v58, 16, v197
    v_and_b32 v59, 0xffff0000, v197
    v_pk_add_f32 v[146:147], v[146:147], v[58:59]
    v_lshlrev_b32 v58, 16, v204
    v_and_b32 v59, 0xffff0000, v204
    v_pk_add_f32 v[148:149], v[148:149], v[58:59]
    v_lshlrev_b32 v58, 16, v205
    v_and_b32 v59, 0xffff0000, v205
    v_pk_add_f32 v[150:151], v[150:151], v[58:59]
    v_lshlrev_b32 v58, 16, v198
    v_and_b32 v59, 0xffff0000, v198
    v_pk_add_f32 v[152:153], v[152:153], v[58:59]
    v_lshlrev_b32 v58, 16, v199
    v_and_b32 v59, 0xffff0000, v199
    v_pk_add_f32 v[154:155], v[154:155], v[58:59]
    v_lshlrev_b32 v58, 16, v206
    v_and_b32 v59, 0xffff0000, v206
    v_pk_add_f32 v[156:157], v[156:157], v[58:59]
    v_lshlrev_b32 v58, 16, v207
    v_and_b32 v59, 0xffff0000, v207
    v_pk_add_f32 v[158:159], v[158:159], v[58:59]
    v_and_b32 v58, 1, v72
    v_lshrrev_b32 v59, 1, v72
    v_lshlrev_b32 v58, 5, v58
    v_lshl_add_u32 v58, v59, 4, v58
    v_lshlrev_b32 v59, 3, v72
    v_sub_u32 v58, v58, v59
    v_add_u32 v78, v78, v58
    v_add_u32 v79, v79, v58
    v_lshlrev_b32 v32, 16, v208
    v_and_b32 v33, 0xffff0000, v208
    v_lshlrev_b32 v34, 16, v209
    v_and_b32 v35, 0xffff0000, v209
    v_lshlrev_b32 v36, 16, v210
    v_and_b32 v37, 0xffff0000, v210
    v_lshlrev_b32 v38, 16, v211
    v_and_b32 v39, 0xffff0000, v211
    v_lshlrev_b32 v40, 16, v212
    v_and_b32 v41, 0xffff0000, v212
    v_lshlrev_b32 v42, 16, v213
    v_and_b32 v43, 0xffff0000, v213
    v_lshlrev_b32 v44, 16, v214
    v_and_b32 v45, 0xffff0000, v214
    v_lshlrev_b32 v46, 16, v215
    v_and_b32 v47, 0xffff0000, v215
    s_or_b32 s31, s54, s30
    s_cbranch_scc1 op_nowr_145
    v_pk_add_f32 v[56:57], v[32:33], v[34:35]
    v_pk_add_f32 v[56:57], v[56:57], v[36:37]
    v_pk_add_f32 v[56:57], v[56:57], v[38:39]
    v_pk_add_f32 v[56:57], v[56:57], v[40:41]
    v_pk_add_f32 v[56:57], v[56:57], v[42:43]
    v_pk_add_f32 v[56:57], v[56:57], v[44:45]
    v_pk_add_f32 v[56:57], v[56:57], v[46:47]
    v_add_f32 v56, v56, v57
    v_mov_b32 v57, v56
    s_nop 1
    v_permlane16_swap_b32 v56, v57
    s_nop 1
    v_add_f32 v56, v56, v57
    v_mov_b32 v57, v56
    s_nop 1
    v_permlane32_swap_b32 v56, v57
    s_nop 1
    v_add_f32 v56, v56, v57
    s_mov_b32 s31, 24704
    s_mov_b32 s34, 24708
    s_mov_b64 exec, 1
    buffer_atomic_add_f32 v56, v75, s[32:35], s31 offen
    s_mov_b64 exec, -1
    s_mov_b32 s34, 24576
op_nowr_145:
    v_mov_b32 v208, 0
    v_mov_b32 v209, 0
    v_mov_b32 v210, 0
    v_mov_b32 v211, 0
    v_mov_b32 v212, 0
    v_mov_b32 v213, 0
    v_mov_b32 v214, 0
    v_mov_b32 v215, 0
    v_mov_b32 v216, 0
    v_mov_b32 v217, 0
    v_mov_b32 v218, 0
    v_mov_b32 v219, 0
    s_mov_b32 s40, 1048576
op_xspin_146:
    buffer_load_dwordx4 v[224:227], v1, s[36:39], s53 offen offset:0 sc1
    buffer_load_dwordx4 v[228:231], v1, s[36:39], s53 offen offset:1024 sc1
    buffer_load_dwordx4 v[232:235], v1, s[36:39], s53 offen offset:2048 sc1
    buffer_load_dwordx4 v[236:239], v1, s[36:39], s53 offen offset:3072 sc1
    s_sub_u32 s40, s40, 1
    s_waitcnt vmcnt(0)
    s_cbranch_scc1 op_xok_147
    v_max3_u32 v56, v224, v225, v226
    v_max3_u32 v56, v56, v227, v228
    v_max3_u32 v56, v56, v229, v230
    v_max3_u32 v56, v56, v231, v232
    v_max3_u32 v56, v56, v233, v234
    v_max3_u32 v56, v56, v235, v236
    v_max3_u32 v56, v56, v237, v238
    v_max_u32 v56, v56, v239
    v_cmp_eq_u32 vcc, -1, v56
    s_cbranch_vccz op_xok_147
    s_sleep 2
    s_branch op_xspin_146
op_xok_147:
    v_lshlrev_b32 v56, 16, v224
    v_and_b32 v57, 0xffff0000, v224
    v_lshlrev_b32 v58, 16, v225
    v_and_b32 v59, 0xffff0000, v225
    v_pk_add_f32 v[128:129], v[128:129], v[56:57]
    v_pk_add_f32 v[130:131], v[130:131], v[58:59]
    v_cvt_pk_bf16_f32 v192, v128, v129
    v_cvt_pk_bf16_f32 v193, v130, v131
    v_lshlrev_b32 v128, 16, v192
    v_and_b32 v129, 0xffff0000, v192
    v_lshlrev_b32 v130, 16, v193
    v_and_b32 v131, 0xffff0000, v193
    v_pk_add_f32 v[208:209], v[208:209], v[128:129]
    v_pk_fma_f32 v[210:211], v[128:129], v[128:129], v[210:211]
    v_pk_fma_f32 v[212:213], v[128:129], v[32:33], v[212:213]
    v_pk_add_f32 v[208:209], v[208:209], v[130:131]
    v_pk_fma_f32 v[210:211], v[130:131], v[130:131], v[210:211]
    v_pk_fma_f32 v[212:213], v[130:131], v[34:35], v[212:213]
    v_lshlrev_b32 v56, 16, v226
    v_and_b32 v57, 0xffff0000, v226
    v_lshlrev_b32 v58, 16, v227
    v_and_b32 v59, 0xffff0000, v227
    v_pk_add_f32 v[132:133], v[132:133], v[56:57]
    v_pk_add_f32 v[134:135], v[134:135], v[58:59]
    v_cvt_pk_bf16_f32 v200, v132, v133
    v_cvt_pk_bf16_f32 v201, v134, v135
    v_lshlrev_b32 v132, 16, v200
    v_and_b32 v133, 0xffff0000, v200
    v_lshlrev_b32 v134, 16, v201
    v_and_b32 v135, 0xffff0000, v201
    v_pk_add_f32 v[214:215], v[214:215], v[132:133]
    v_pk_fma_f32 v[216:217], v[132:133], v[132:133], v[216:217]
    v_pk_fma_f32 v[218:219], v[132:133], v[32:33], v[218:219]
    v_pk_add_f32 v[214:215], v[214:215], v[134:135]
    v_pk_fma_f32 v[216:217], v[134:135], v[134:135], v[216:217]
    v_pk_fma_f32 v[218:219], v[134:135], v[34:35], v[218:219]
    v_lshlrev_b32 v56, 16, v228
    v_and_b32 v57, 0xffff0000, v228
    v_lshlrev_b32 v58, 16, v229
    v_and_b32 v59, 0xffff0000, v229
    v_pk_add_f32 v[136:137], v[136:137], v[56:57]
    v_pk_add_f32 v[138:139], v[138:139], v[58:59]
    v_cvt_pk_bf16_f32 v194, v136, v137
    v_cvt_pk_bf16_f32 v195, v138, v139
    v_lshlrev_b32 v136, 16, v194
    v_and_b32 v137, 0xffff0000, v194
    v_lshlrev_b32 v138, 16, v195
    v_and_b32 v139, 0xffff0000, v195
    v_permlane16_swap_b32 v192, v194
    v_permlane16_swap_b32 v193, v195
    buffer_store_dwordx4 v[192:195], v78, s[24:27], 0 offen offset:0 sc1
    v_pk_add_f32 v[208:209], v[208:209], v[136:137]
    v_pk_fma_f32 v[210:211], v[136:137], v[136:137], v[210:211]
    v_pk_fma_f32 v[212:213], v[136:137], v[36:37], v[212:213]
    v_pk_add_f32 v[208:209], v[208:209], v[138:139]
    v_pk_fma_f32 v[210:211], v[138:139], v[138:139], v[210:211]
    v_pk_fma_f32 v[212:213], v[138:139], v[38:39], v[212:213]
    v_lshlrev_b32 v56, 16, v230
    v_and_b32 v57, 0xffff0000, v230
    v_lshlrev_b32 v58, 16, v231
    v_and_b32 v59, 0xffff0000, v231
    v_pk_add_f32 v[140:141], v[140:141], v[56:57]
    v_pk_add_f32 v[142:143], v[142:143], v[58:59]
    v_cvt_pk_bf16_f32 v202, v140, v141
    v_cvt_pk_bf16_f32 v203, v142, v143
    v_lshlrev_b32 v140, 16, v202
    v_and_b32 v141, 0xffff0000, v202
    v_lshlrev_b32 v142, 16, v203
    v_and_b32 v143, 0xffff0000, v203
    v_permlane16_swap_b32 v200, v202
    v_permlane16_swap_b32 v201, v203
    buffer_store_dwordx4 v[200:203], v79, s[24:27], 0 offen offset:0 sc1
    v_pk_add_f32 v[214:215], v[214:215], v[140:141]
    v_pk_fma_f32 v[216:217], v[140:141], v[140:141], v[216:217]
    v_pk_fma_f32 v[218:219], v[140:141], v[36:37], v[218:219]
    v_pk_add_f32 v[214:215], v[214:215], v[142:143]
    v_pk_fma_f32 v[216:217], v[142:143], v[142:143], v[216:217]
    v_pk_fma_f32 v[218:219], v[142:143], v[38:39], v[218:219]
    v_lshlrev_b32 v56, 16, v232
    v_and_b32 v57, 0xffff0000, v232
    v_lshlrev_b32 v58, 16, v233
    v_and_b32 v59, 0xffff0000, v233
    v_pk_add_f32 v[144:145], v[144:145], v[56:57]
    v_pk_add_f32 v[146:147], v[146:147], v[58:59]
    v_cvt_pk_bf16_f32 v196, v144, v145
    v_cvt_pk_bf16_f32 v197, v146, v147
    v_lshlrev_b32 v144, 16, v196
    v_and_b32 v145, 0xffff0000, v196
    v_lshlrev_b32 v146, 16, v197
    v_and_b32 v147, 0xffff0000, v197
    v_pk_add_f32 v[208:209], v[208:209], v[144:145]
    v_pk_fma_f32 v[210:211], v[144:145], v[144:145], v[210:211]
    v_pk_fma_f32 v[212:213], v[144:145], v[40:41], v[212:213]
    v_pk_add_f32 v[208:209], v[208:209], v[146:147]
    v_pk_fma_f32 v[210:211], v[146:147], v[146:147], v[210:211]
    v_pk_fma_f32 v[212:213], v[146:147], v[42:43], v[212:213]
    v_lshlrev_b32 v56, 16, v234
    v_and_b32 v57, 0xffff0000, v234
    v_lshlrev_b32 v58, 16, v235
    v_and_b32 v59, 0xffff0000, v235
    v_pk_add_f32 v[148:149], v[148:149], v[56:57]
    v_pk_add_f32 v[150:151], v[150:151], v[58:59]
    v_cvt_pk_bf16_f32 v204, v148, v149
    v_cvt_pk_bf16_f32 v205, v150, v151
    v_lshlrev_b32 v148, 16, v204
    v_and_b32 v149, 0xffff0000, v204
    v_lshlrev_b32 v150, 16, v205
    v_and_b32 v151, 0xffff0000, v205
    v_pk_add_f32 v[214:215], v[214:215], v[148:149]
    v_pk_fma_f32 v[216:217], v[148:149], v[148:149], v[216:217]
    v_pk_fma_f32 v[218:219], v[148:149], v[40:41], v[218:219]
    v_pk_add_f32 v[214:215], v[214:215], v[150:151]
    v_pk_fma_f32 v[216:217], v[150:151], v[150:151], v[216:217]
    v_pk_fma_f32 v[218:219], v[150:151], v[42:43], v[218:219]
    v_lshlrev_b32 v56, 16, v236
    v_and_b32 v57, 0xffff0000, v236
    v_lshlrev_b32 v58, 16, v237
    v_and_b32 v59, 0xffff0000, v237
    v_pk_add_f32 v[152:153], v[152:153], v[56:57]
    v_pk_add_f32 v[154:155], v[154:155], v[58:59]
    v_cvt_pk_bf16_f32 v198, v152, v153
    v_cvt_pk_bf16_f32 v199, v154, v155
    v_lshlrev_b32 v152, 16, v198
    v_and_b32 v153, 0xffff0000, v198
    v_lshlrev_b32 v154, 16, v199
    v_and_b32 v155, 0xffff0000, v199
    v_permlane16_swap_b32 v196, v198
    v_permlane16_swap_b32 v197, v199
    buffer_store_dwordx4 v[196:199], v78, s[24:27], 0 offen offset:64 sc1
    v_pk_add_f32 v[208:209], v[208:209], v[152:153]
    v_pk_fma_f32 v[210:211], v[152:153], v[152:153], v[210:211]
    v_pk_fma_f32 v[212:213], v[152:153], v[44:45], v[212:213]
    v_pk_add_f32 v[208:209], v[208:209], v[154:155]
    v_pk_fma_f32 v[210:211], v[154:155], v[154:155], v[210:211]
    v_pk_fma_f32 v[212:213], v[154:155], v[46:47], v[212:213]
    v_lshlrev_b32 v56, 16, v238
    v_and_b32 v57, 0xffff0000, v238
    v_lshlrev_b32 v58, 16, v239
    v_and_b32 v59, 0xffff0000, v239
    v_pk_add_f32 v[156:157], v[156:157], v[56:57]
    v_pk_add_f32 v[158:159], v[158:159], v[58:59]
    v_cvt_pk_bf16_f32 v206, v156, v157
    v_cvt_pk_bf16_f32 v207, v158, v159
    v_lshlrev_b32 v156, 16, v206
    v_and_b32 v157, 0xffff0000, v206
    v_lshlrev_b32 v158, 16, v207
    v_and_b32 v159, 0xffff0000, v207
    v_permlane16_swap_b32 v204, v206
    v_permlane16_swap_b32 v205, v207
    buffer_store_dwordx4 v[204:207], v79, s[24:27], 0 offen offset:64 sc1
    v_pk_add_f32 v[214:215], v[214:215], v[156:157]
    v_pk_fma_f32 v[216:217], v[156:157], v[156:157], v[216:217]
    v_pk_fma_f32 v[218:219], v[156:157], v[44:45], v[218:219]
    v_pk_add_f32 v[214:215], v[214:215], v[158:159]
    v_pk_fma_f32 v[216:217], v[158:159], v[158:159], v[216:217]
    v_pk_fma_f32 v[218:219], v[158:159], v[46:47], v[218:219]
    v_add_f32 v48, v208, v209
    v_add_f32 v49, v210, v211
    v_add_f32 v50, v212, v213
    v_add_f32 v52, v214, v215
    v_add_f32 v53, v216, v217
    v_add_f32 v54, v218, v219
    v_mov_b32 v56, v48
    v_mov_b32 v57, v49
    v_mov_b32 v58, v50
    v_mov_b32 v59, v52
    v_mov_b32 v60, v53
    v_mov_b32 v61, v54
    s_nop 1
    v_permlane16_swap_b32 v48, v56
    v_permlane16_swap_b32 v49, v57
    v_permlane16_swap_b32 v50, v58
    v_permlane16_swap_b32 v52, v59
    v_permlane16_swap_b32 v53, v60
    v_permlane16_swap_b32 v54, v61
    s_nop 1
    v_add_f32 v48, v48, v56
    v_add_f32 v49, v49, v57
    v_add_f32 v50, v50, v58
    v_add_f32 v52, v52, v59
    v_add_f32 v53, v53, v60
    v_add_f32 v54, v54, v61
    v_mov_b32 v56, v48
    v_mov_b32 v57, v49
    v_mov_b32 v58, v50
    v_mov_b32 v59, v52
    v_mov_b32 v60, v53
    v_mov_b32 v61, v54
    s_nop 1
    v_permlane32_swap_b32 v48, v56
    v_permlane32_swap_b32 v49, v57
    v_permlane32_swap_b32 v50, v58
    v_permlane32_swap_b32 v52, v59
    v_permlane32_swap_b32 v53, v60
    v_permlane32_swap_b32 v54, v61
    s_nop 1
    v_add_f32 v48, v48, v56
    v_add_f32 v49, v49, v57
    v_add_f32 v50, v50, v58
    v_add_f32 v52, v52, v59
    v_add_f32 v53, v53, v60
    v_add_f32 v54, v54, v61
    v_cmp_eq_u32 s[40:41], 1, v72
    v_cmp_eq_u32 s[42:43], 2, v72
    s_nop 1
    v_cndmask_b32 v48, v48, v49, s[40:41]
    v_cndmask_b32 v48, v48, v50, s[42:43]
    buffer_atomic_add_f32 v48, v77, s[32:35], 0 offen offset:0
    v_cndmask_b32 v52, v52, v53, s[40:41]
    v_cndmask_b32 v52, v52, v54, s[42:43]
    buffer_atomic_add_f32 v52, v77, s[32:35], 0 offen offset:64
    s_load_dwordx2 s[42:43], s[0:1], 88
    s_load_dwordx2 s[56:57], s[0:1], 56
    s_add_u32 s16, s6, 0x4815000
    s_addc_u32 s17, s7, 0
    s_and_b32 s17, s17, 0xffff
    s_mov_b32 s18, 0x1000
    s_mov_b32 s19, 0x00020000
    v_lshrrev_b32 v3, 4, v1
    v_lshl_add_u32 v2, s30, 6, v3
    v_and_b32 v4, 31, v3
    v_lshrrev_b32 v5, 5, v3
    v_lshlrev_b32 v7, 4, v4
    v_and_b32 v8, 15, v3
    v_lshlrev_b32 v6, 7, v8
    s_bfe_u32 s31, s2, 0x20003
    s_lshl_b32 s31, s31, 7
    v_lshlrev_b32 v12, 9, v3
    v_and_b32 v14, 3, v3
    v_lshlrev_b32 v14, 7, v14
    s_and_b32 s59, s2, 7
    s_lshl_b32 s59, s59, 9
    s_setreg_imm32_b32 hwreg(HW_REG_MODE, 4, 2), 3
    s_waitcnt vmcnt(0) lgkmcnt(0)
    s_barrier
    s_cmp_lg_u32 s30, 0
    s_cbranch_scc1 ff_nosig_148
    s_mov_b64 exec, 0xff
    buffer_atomic_add v76, v12, s[16:19], s31 offen sc1
    s_mov_b64 exec, -1
ff_nosig_148:
    s_lshl_b32 s40, s30, 13
    s_add_u32 m0, s40, 65536
    s_add_u32 s41, s3, 0
    buffer_load_dwordx4 v1, s[44:47], s41 offen offset:0 sc1 lds
    buffer_load_dwordx4 v1, s[44:47], s41 offen offset:1024 sc1 lds
    buffer_load_dwordx4 v1, s[44:47], s41 offen offset:2048 sc1 lds
    buffer_load_dwordx4 v1, s[44:47], s41 offen offset:3072 sc1 lds
    s_lshl_b32 s41, s30, 9
    s_add_u32 s41, s41, 131072
    v_lshrrev_b32 v9, 1, v1
    v_add_u32 v9, s41, v9
    ds_read_b64 v[96:97], v9 offset:0
    ds_read_b64 v[98:99], v9 offset:2048
    ds_read_b64 v[100:101], v9 offset:4096
    ds_read_b64 v[102:103], v9 offset:6144
    ds_read_b64 v[104:105], v9 offset:8192
    ds_read_b64 v[106:107], v9 offset:10240
    ds_read_b64 v[108:109], v9 offset:12288
    ds_read_b64 v[110:111], v9 offset:14336
    ds_read_b64 v[112:113], v9 offset:16384
    ds_read_b64 v[114:115], v9 offset:18432
    ds_read_b64 v[116:117], v9 offset:20480
    ds_read_b64 v[118:119], v9 offset:22528
    ds_read_b64 v[120:121], v9 offset:24576
    ds_read_b64 v[122:123], v9 offset:26624
    ds_read_b64 v[124:125], v9 offset:28672
    ds_read_b64 v[126:127], v9 offset:30720
    s_mov_b32 s54, 0x05040100
    s_mov_b32 s53, 0x07060302
    s_waitcnt lgkmcnt(0)
    v_perm_b32 v144, v98, v96, s54
    v_perm_b32 v145, v98, v96, s53
    v_perm_b32 v146, v99, v97, s54
    v_perm_b32 v147, v99, v97, s53
    v_perm_b32 v148, v102, v100, s54
    v_perm_b32 v149, v102, v100, s53
    v_perm_b32 v150, v103, v101, s54
    v_perm_b32 v151, v103, v101, s53
    v_perm_b32 v152, v106, v104, s54
    v_perm_b32 v153, v106, v104, s53
    v_perm_b32 v154, v107, v105, s54
    v_perm_b32 v155, v107, v105, s53
    v_perm_b32 v156, v110, v108, s54
    v_perm_b32 v157, v110, v108, s53
    v_perm_b32 v158, v111, v109, s54
    v_perm_b32 v159, v111, v109, s53
    v_perm_b32 v160, v114, v112, s54
    v_perm_b32 v161, v114, v112, s53
    v_perm_b32 v162, v115, v113, s54
    v_perm_b32 v163, v115, v113, s53
    v_perm_b32 v164, v118, v116, s54
    v_perm_b32 v165, v118, v116, s53
    v_perm_b32 v166, v119, v117, s54
    v_perm_b32 v167, v119, v117, s53
    v_perm_b32 v168, v122, v120, s54
    v_perm_b32 v169, v122, v120, s53
    v_perm_b32 v170, v123, v121, s54
    v_perm_b32 v171, v123, v121, s53
    v_perm_b32 v172, v126, v124, s54
    v_perm_b32 v173, v126, v124, s53
    v_perm_b32 v174, v127, v125, s54
    v_perm_b32 v175, v127, v125, s53
    s_waitcnt vmcnt(0)
    s_lshl_b32 s40, s30, 13
    s_add_u32 m0, s40, 69632
    s_add_u32 s41, s3, 4096
    buffer_load_dwordx4 v1, s[44:47], s41 offen offset:0 sc1 lds
    buffer_load_dwordx4 v1, s[44:47], s41 offen offset:1024 sc1 lds
    buffer_load_dwordx4 v1, s[44:47], s41 offen offset:2048 sc1 lds
    buffer_load_dwordx4 v1, s[44:47], s41 offen offset:3072 sc1 lds
    s_waitcnt vmcnt(0)
    s_lshl_b32 s40, s30, 13
    s_add_u32 m0, s40, 98304
    s_add_u32 s41, s3, 8388608
    buffer_load_dwordx4 v1, s[44:47], s41 offen offset:0 sc1 lds
    buffer_load_dwordx4 v1, s[44:47], s41 offen offset:1024 sc1 lds
    buffer_load_dwordx4 v1, s[44:47], s41 offen offset:2048 sc1 lds
    buffer_load_dwordx4 v1, s[44:47], s41 offen offset:3072 sc1 lds
    s_waitcnt vmcnt(0)
    s_lshl_b32 s40, s30, 13
    s_add_u32 m0, s40, 102400
    s_add_u32 s41, s3, 8392704
    buffer_load_dwordx4 v1, s[44:47], s41 offen offset:0 sc1 lds
    buffer_load_dwordx4 v1, s[44:47], s41 offen offset:1024 sc1 lds
    buffer_load_dwordx4 v1, s[44:47], s41 offen offset:2048 sc1 lds
    buffer_load_dwordx4 v1, s[44:47], s41 offen offset:3072 sc1 lds
    s_mov_b32 s34, 24708
    s_mov_b32 s36, s42
    s_and_b32 s37, s43, 0xffff
    s_mov_b32 s38, 0x400000
    s_mov_b32 s39, 0x00020000
    s_add_u32 s48, s6, 0x4900000
    s_addc_u32 s49, s7, 0
    s_and_b32 s49, s49, 0xffff
    s_mov_b32 s50, 0xe0000
    s_mov_b32 s51, 0x00020000
    v_lshlrev_b32 v10, 5, v2
    v_lshl_add_u32 v11, s30, 1, v5
    s_lshl_b32 s31, s2, 3
    v_add_u32 v11, s31, v11
    v_lshl_add_u32 v0, v11, 11, v7
    s_cmp_lg_u32 s30, 0
    s_cbranch_scc1 ff_go_149
    s_mov_b32 s52, 1048576
ff_poll_150:
    buffer_load_dword v13, v14, s[16:19], s59 offen sc1
    s_sub_u32 s52, s52, 1
    s_cbranch_scc1 ff_go_149
    s_waitcnt vmcnt(0)
    v_cmp_gt_u32 vcc, 64, v13
    s_cbranch_vccz ff_go_149
    s_sleep 4
    s_branch ff_poll_150
ff_go_149:
    s_barrier
    s_mov_b32 s31, 0
    buffer_load_dwordx4 v[16:19], v10, s[32:35], s31 offen sc1
    buffer_load_dwordx4 v[20:23], v10, s[32:35], s31 offen offset:16 sc1
    s_mov_b32 s31, 8192
    buffer_load_dwordx4 v[24:27], v10, s[32:35], s31 offen sc1
    buffer_load_dwordx4 v[28:31], v10, s[32:35], s31 offen offset:16 sc1
    s_mov_b32 s31, 16384
    buffer_load_dwordx4 v[32:35], v10, s[32:35], s31 offen sc1
    buffer_load_dwordx4 v[36:39], v10, s[32:35], s31 offen offset:16 sc1
    s_mov_b32 s31, 24704
    buffer_load_dword v10, v75, s[32:35], s31 offen sc1
    s_mov_b32 s52, 0x3a800000
    s_mov_b32 s53, 0x3a800000
    s_mov_b32 s54, 0x7ff
    v_mov_b32 v14, 0x3727c5ac
    v_mov_b32 v15, v14
    v_mov_b32 v12, 0xff800000
    v_mov_b32 v13, v12
    s_waitcnt vmcnt(0)
    v_sub_f32 v56, 0, v10
    v_sub_f32 v57, 0, v10
    v_pk_mul_f32 v[16:17], v[16:17], s[52:53]
    v_pk_fma_f32 v[24:25], v[24:25], s[52:53], v[14:15]
    v_pk_fma_f32 v[32:33], v[16:17], v[56:57], v[32:33]
    v_pk_fma_f32 v[24:25], v[16:17], v[16:17], v[24:25] neg_lo:[1,0,0] neg_hi:[1,0,0]
    v_pk_mul_f32 v[18:19], v[18:19], s[52:53]
    v_pk_fma_f32 v[26:27], v[26:27], s[52:53], v[14:15]
    v_pk_fma_f32 v[34:35], v[18:19], v[56:57], v[34:35]
    v_pk_fma_f32 v[26:27], v[18:19], v[18:19], v[26:27] neg_lo:[1,0,0] neg_hi:[1,0,0]
    v_pk_mul_f32 v[20:21], v[20:21], s[52:53]
    v_pk_fma_f32 v[28:29], v[28:29], s[52:53], v[14:15]
    v_pk_fma_f32 v[36:37], v[20:21], v[56:57], v[36:37]
    v_pk_fma_f32 v[28:29], v[20:21], v[20:21], v[28:29] neg_lo:[1,0,0] neg_hi:[1,0,0]
    v_pk_mul_f32 v[22:23], v[22:23], s[52:53]
    v_pk_fma_f32 v[30:31], v[30:31], s[52:53], v[14:15]
    v_pk_fma_f32 v[38:39], v[22:23], v[56:57], v[38:39]
    v_pk_fma_f32 v[30:31], v[22:23], v[22:23], v[30:31] neg_lo:[1,0,0] neg_hi:[1,0,0]
    v_max_f32 v24, v14, v24
    v_max_f32 v25, v14, v25
    v_max_f32 v26, v14, v26
    v_max_f32 v27, v14, v27
    v_max_f32 v28, v14, v28
    v_max_f32 v29, v14, v29
    v_max_f32 v30, v14, v30
    v_max_f32 v31, v14, v31
    v_rsq_f32 v24, v24
    v_rsq_f32 v25, v25
    v_rsq_f32 v26, v26
    v_rsq_f32 v27, v27
    v_rsq_f32 v28, v28
    v_rsq_f32 v29, v29
    v_rsq_f32 v30, v30
    v_rsq_f32 v31, v31
    v_pk_mul_f32 v[32:33], v[32:33], v[24:25]
    v_pk_mul_f32 v[34:35], v[34:35], v[26:27]
    v_pk_mul_f32 v[36:37], v[36:37], v[28:29]
    v_pk_mul_f32 v[38:39], v[38:39], v[30:31]
    v_bfi_b32 v32, s54, 0, v32
    v_med3_f32 v13, v12, v13, v32
    v_max_f32 v12, v12, v32
    v_bfi_b32 v33, s54, 1, v33
    v_med3_f32 v13, v12, v13, v33
    v_max_f32 v12, v12, v33
    v_bfi_b32 v34, s54, 2, v34
    v_med3_f32 v13, v12, v13, v34
    v_max_f32 v12, v12, v34
    v_bfi_b32 v35, s54, 3, v35
    v_med3_f32 v13, v12, v13, v35
    v_max_f32 v12, v12, v35
    v_bfi_b32 v36, s54, 4, v36
    v_med3_f32 v13, v12, v13, v36
    v_max_f32 v12, v12, v36
    v_bfi_b32 v37, s54, 5, v37
    v_med3_f32 v13, v12, v13, v37
    v_max_f32 v12, v12, v37
    v_bfi_b32 v38, s54, 6, v38
    v_med3_f32 v13, v12, v13, v38
    v_max_f32 v12, v12, v38
    v_bfi_b32 v39, s54, 7, v39
    v_med3_f32 v13, v12, v13, v39
    v_max_f32 v12, v12, v39
    v_lshl_or_b32 v12, v2, 3, v12
    v_lshl_or_b32 v13, v2, 3, v13
    s_nop 1
    v_mov_b32_dpp v14, v12 quad_perm:[1,0,3,2] row_mask:0xf bank_mask:0xf
    v_mov_b32_dpp v15, v13 quad_perm:[1,0,3,2] row_mask:0xf bank_mask:0xf
    v_max_f32 v15, v15, v13
    v_med3_f32 v13, v12, v14, v15
    v_max_f32 v12, v12, v14
    s_nop 1
    v_mov_b32_dpp v14, v12 quad_perm:[2,3,0,1] row_mask:0xf bank_mask:0xf
    v_mov_b32_dpp v15, v13 quad_perm:[2,3,0,1] row_mask:0xf bank_mask:0xf
    v_max_f32 v15, v15, v13
    v_med3_f32 v13, v12, v14, v15
    v_max_f32 v12, v12, v14
    s_nop 1
    v_mov_b32_dpp v14, v12 row_half_mirror row_mask:0xf bank_mask:0xf
    v_mov_b32_dpp v15, v13 row_half_mirror row_mask:0xf bank_mask:0xf
    v_max_f32 v15, v15, v13
    v_med3_f32 v13, v12, v14, v15
    v_max_f32 v12, v12, v14
    s_nop 1
    v_mov_b32_dpp v14, v12 row_mirror row_mask:0xf bank_mask:0xf
    v_mov_b32_dpp v15, v13 row_mirror row_mask:0xf bank_mask:0xf
    v_max_f32 v15, v15, v13
    v_med3_f32 v13, v12, v14, v15
    v_max_f32 v12, v12, v14
    v_mov_b32 v14, v12
    v_mov_b32 v15, v13
    s_nop 1
    v_permlane16_swap_b32 v12, v14
    v_permlane16_swap_b32 v13, v15
    s_nop 1
    v_max_f32 v15, v15, v13
    v_med3_f32 v13, v12, v14, v15
    v_max_f32 v12, v12, v14
    v_mov_b32 v14, v12
    v_mov_b32 v15, v13
    s_nop 1
    v_permlane32_swap_b32 v12, v14
    v_permlane32_swap_b32 v13, v15
    s_nop 1
    v_max_f32 v15, v15, v13
    v_med3_f32 v13, v12, v14, v15
    v_max_f32 v12, v12, v14
    s_lshl_b32 s31, s30, 3
    s_add_u32 s31, s31, 8192
    v_mov_b32 v14, s31
    ds_write_b64 v14, v[12:13]
    v_mov_b32 v14, 8192
    s_waitcnt lgkmcnt(0)
    s_barrier
    ds_read_b128 v[16:19], v14
    ds_read_b128 v[20:23], v14 offset:16
    v_cmp_eq_u32 vcc, 0, v5
    s_waitcnt lgkmcnt(0)
    v_max_f32 v19, v19, v17
    v_med3_f32 v17, v16, v18, v19
    v_max_f32 v16, v16, v18
    v_max_f32 v23, v23, v21
    v_med3_f32 v21, v20, v22, v23
    v_max_f32 v20, v20, v22
    v_max_f32 v21, v21, v17
    v_med3_f32 v17, v16, v20, v21
    v_max_f32 v16, v16, v20
    v_and_b32 v16, 0x7ff, v16
    v_and_b32 v17, 0x7ff, v17
    v_cndmask_b32 v15, v17, v16, vcc
    v_lshl_add_u32 v12, v15, 11, v7
    buffer_load_dwordx4 v[40:43], v12, s[24:27], 0 offen offset:0 sc1
    buffer_load_dwordx4 v[44:47], v12, s[24:27], 0 offen offset:512 sc1
    buffer_load_dwordx4 v[48:51], v12, s[24:27], 0 offen offset:1024 sc1
    buffer_load_dwordx4 v[52:55], v12, s[24:27], 0 offen offset:1536 sc1
    buffer_load_dwordx4 v[128:131], v0, s[24:27], 0 offen offset:0 sc1
    buffer_load_dwordx4 v[132:135], v0, s[24:27], 0 offen offset:512 sc1
    buffer_load_dwordx4 v[136:139], v0, s[24:27], 0 offen offset:1024 sc1
    buffer_load_dwordx4 v[140:143], v0, s[24:27], 0 offen offset:1536 sc1
    v_cmp_eq_u32 vcc, v16, v11
    v_cmp_eq_u32 s[52:53], v17, v11
    v_mov_b32 v13, 0x7fffffff
    s_or_b64 vcc, vcc, s[52:53]
    v_cndmask_b32 v0, v0, v13, vcc
    v_lshl_add_u32 v12, v5, 11, v7
    v_add_u32 v12, 4096, v12
    s_mov_b32 s58, 0
    s_waitcnt vmcnt(8)
    v_lshlrev_b32 v14, 3, v3
    s_lshl_b32 s54, s30, 13
    s_add_u32 s54, s54, 65536
    v_add_u32 v14, s54, v14
    ds_read_b64_tr_b16 a[0:1], v14 offset:0
    ds_read_b64_tr_b16 a[2:3], v14 offset:512
    ds_read_b64_tr_b16 a[4:5], v14 offset:1024
    ds_read_b64_tr_b16 a[6:7], v14 offset:1536
    ds_read_b64_tr_b16 a[8:9], v14 offset:2048
    ds_read_b64_tr_b16 a[10:11], v14 offset:2560
    ds_read_b64_tr_b16 a[12:13], v14 offset:3072
    ds_read_b64_tr_b16 a[14:15], v14 offset:3584
    ds_read_b64_tr_b16 a[16:17], v14 offset:4096
    ds_read_b64_tr_b16 a[18:19], v14 offset:4608
    ds_read_b64_tr_b16 a[20:21], v14 offset:5120
    ds_read_b64_tr_b16 a[22:23], v14 offset:5632
    ds_read_b64_tr_b16 a[24:25], v14 offset:6144
    ds_read_b64_tr_b16 a[26:27], v14 offset:6656
    ds_read_b64_tr_b16 a[28:29], v14 offset:7168
    ds_read_b64_tr_b16 a[30:31], v14 offset:7680
    ds_read_b64_tr_b16 a[32:33], v14 offset:32768
    ds_read_b64_tr_b16 a[34:35], v14 offset:33280
    ds_read_b64_tr_b16 a[36:37], v14 offset:33792
    ds_read_b64_tr_b16 a[38:39], v14 offset:34304
    ds_read_b64_tr_b16 a[40:41], v14 offset:34816
    ds_read_b64_tr_b16 a[42:43], v14 offset:35328
    ds_read_b64_tr_b16 a[44:45], v14 offset:35840
    ds_read_b64_tr_b16 a[46:47], v14 offset:36352
    ds_read_b64_tr_b16 a[48:49], v14 offset:36864
    ds_read_b64_tr_b16 a[50:51], v14 offset:37376
    ds_read_b64_tr_b16 a[52:53], v14 offset:37888
    ds_read_b64_tr_b16 a[54:55], v14 offset:38400
    ds_read_b64_tr_b16 a[56:57], v14 offset:38912
    ds_read_b64_tr_b16 a[58:59], v14 offset:39424
    ds_read_b64_tr_b16 a[60:61], v14 offset:39936
    ds_read_b64_tr_b16 a[62:63], v14 offset:40448
    s_waitcnt vmcnt(4)
ff_ln_151:
    v_lshlrev_b32 v216, 16, v40
    v_and_b32 v217, 0xffff0000, v40
    v_lshlrev_b32 v218, 16, v41
    v_and_b32 v219, 0xffff0000, v41
    v_lshlrev_b32 v220, 16, v42
    v_and_b32 v221, 0xffff0000, v42
    v_lshlrev_b32 v222, 16, v43
    v_and_b32 v223, 0xffff0000, v43
    v_lshlrev_b32 v224, 16, v44
    v_and_b32 v225, 0xffff0000, v44
    v_lshlrev_b32 v226, 16, v45
    v_and_b32 v227, 0xffff0000, v45
    v_lshlrev_b32 v228, 16, v46
    v_and_b32 v229, 0xffff0000, v46
    v_lshlrev_b32 v230, 16, v47
    v_and_b32 v231, 0xffff0000, v47
    v_lshlrev_b32 v232, 16, v48
    v_and_b32 v233, 0xffff0000, v48
    v_lshlrev_b32 v234, 16, v49
    v_and_b32 v235, 0xffff0000, v49
    v_lshlrev_b32 v236, 16, v50
    v_and_b32 v237, 0xffff0000, v50
    v_lshlrev_b32 v238, 16, v51
    v_and_b32 v239, 0xffff0000, v51
    v_lshlrev_b32 v240, 16, v52
    v_and_b32 v241, 0xffff0000, v52
    v_lshlrev_b32 v242, 16, v53
    v_and_b32 v243, 0xffff0000, v53
    v_lshlrev_b32 v244, 16, v54
    v_and_b32 v245, 0xffff0000, v54
    v_lshlrev_b32 v246, 16, v55
    v_and_b32 v247, 0xffff0000, v55
    v_pk_add_f32 v[208:209], v[216:217], v[218:219]
    v_pk_add_f32 v[210:211], v[220:221], v[222:223]
    v_pk_add_f32 v[208:209], v[208:209], v[224:225]
    v_pk_add_f32 v[210:211], v[210:211], v[226:227]
    v_pk_add_f32 v[208:209], v[208:209], v[228:229]
    v_pk_add_f32 v[210:211], v[210:211], v[230:231]
    v_pk_add_f32 v[208:209], v[208:209], v[232:233]
    v_pk_add_f32 v[210:211], v[210:211], v[234:235]
    v_pk_add_f32 v[208:209], v[208:209], v[236:237]
    v_pk_add_f32 v[210:211], v[210:211], v[238:239]
    v_pk_add_f32 v[208:209], v[208:209], v[240:241]
    v_pk_add_f32 v[210:211], v[210:211], v[242:243]
    v_pk_add_f32 v[208:209], v[208:209], v[244:245]
    v_pk_add_f32 v[210:211], v[210:211], v[246:247]
    v_pk_add_f32 v[208:209], v[208:209], v[210:211]
    v_add_f32 v208, v208, v209
    s_nop 1
    v_add_f32_dpp v208, v208, v208 quad_perm:[1,0,3,2] row_mask:0xf bank_mask:0xf
    s_nop 1
    v_add_f32_dpp v208, v208, v208 quad_perm:[2,3,0,1] row_mask:0xf bank_mask:0xf
    s_nop 1
    v_add_f32_dpp v208, v208, v208 row_half_mirror row_mask:0xf bank_mask:0xf
    s_nop 1
    v_add_f32_dpp v208, v208, v208 row_mirror row_mask:0xf bank_mask:0xf
    v_mov_b32 v210, v208
    s_nop 1
    v_permlane16_swap_b32 v208, v210
    s_nop 1
    v_add_f32 v208, v208, v210
    v_mul_f32 v208, 0xba800000, v208
    v_mov_b32 v209, v208
    v_pk_add_f32 v[210:211], v[216:217], v[208:209]
    v_pk_add_f32 v[214:215], v[218:219], v[208:209]
    v_pk_mul_f32 v[212:213], v[210:211], v[210:211]
    v_pk_fma_f32 v[212:213], v[214:215], v[214:215], v[212:213]
    v_pk_add_f32 v[210:211], v[220:221], v[208:209]
    v_pk_add_f32 v[214:215], v[222:223], v[208:209]
    v_pk_fma_f32 v[212:213], v[210:211], v[210:211], v[212:213]
    v_pk_fma_f32 v[212:213], v[214:215], v[214:215], v[212:213]
    v_pk_add_f32 v[210:211], v[224:225], v[208:209]
    v_pk_add_f32 v[214:215], v[226:227], v[208:209]
    v_pk_fma_f32 v[212:213], v[210:211], v[210:211], v[212:213]
    v_pk_fma_f32 v[212:213], v[214:215], v[214:215], v[212:213]
    v_pk_add_f32 v[210:211], v[228:229], v[208:209]
    v_pk_add_f32 v[214:215], v[230:231], v[208:209]
    v_pk_fma_f32 v[212:213], v[210:211], v[210:211], v[212:213]
    v_pk_fma_f32 v[212:213], v[214:215], v[214:215], v[212:213]
    v_pk_add_f32 v[210:211], v[232:233], v[208:209]
    v_pk_add_f32 v[214:215], v[234:235], v[208:209]
    v_pk_fma_f32 v[212:213], v[210:211], v[210:211], v[212:213]
    v_pk_fma_f32 v[212:213], v[214:215], v[214:215], v[212:213]
    v_pk_add_f32 v[210:211], v[236:237], v[208:209]
    v_pk_add_f32 v[214:215], v[238:239], v[208:209]
    v_pk_fma_f32 v[212:213], v[210:211], v[210:211], v[212:213]
    v_pk_fma_f32 v[212:213], v[214:215], v[214:215], v[212:213]
    v_pk_add_f32 v[210:211], v[240:241], v[208:209]
    v_pk_add_f32 v[214:215], v[242:243], v[208:209]
    v_pk_fma_f32 v[212:213], v[210:211], v[210:211], v[212:213]
    v_pk_fma_f32 v[212:213], v[214:215], v[214:215], v[212:213]
    v_pk_add_f32 v[210:211], v[244:245], v[208:209]
    v_pk_add_f32 v[214:215], v[246:247], v[208:209]
    v_pk_fma_f32 v[212:213], v[210:211], v[210:211], v[212:213]
    v_pk_fma_f32 v[212:213], v[214:215], v[214:215], v[212:213]
    v_add_f32 v212, v212, v213
    s_nop 1
    v_add_f32_dpp v212, v212, v212 quad_perm:[1,0,3,2] row_mask:0xf bank_mask:0xf
    s_nop 1
    v_add_f32_dpp v212, v212, v212 quad_perm:[2,3,0,1] row_mask:0xf bank_mask:0xf
    s_nop 1
    v_add_f32_dpp v212, v212, v212 row_half_mirror row_mask:0xf bank_mask:0xf
    s_nop 1
    v_add_f32_dpp v212, v212, v212 row_mirror row_mask:0xf bank_mask:0xf
    v_mov_b32 v210, v212
    s_nop 1
    v_permlane16_swap_b32 v212, v210
    s_nop 1
    v_add_f32 v212, v212, v210
    v_mul_f32 v212, 0x3a800000, v212
    v_cvt_pk_bf16_f32 v214, v208, v212
    v_and_b32 v212, 0xffff0000, v214
    v_lshlrev_b32 v214, 16, v214
    v_add_f32 v212, 0x3727c5ac, v212
    v_mov_b32 v215, v214
    v_cvt_pk_bf16_f32 v212, v212, v212
    v_and_b32 v212, 0xffff0000, v212
    v_sqrt_f32 v212, v212
    v_pk_add_f32 v[176:177], v[216:217], v[214:215]
    v_pk_add_f32 v[178:179], v[218:219], v[214:215]
    v_pk_add_f32 v[180:181], v[220:221], v[214:215]
    v_pk_add_f32 v[182:183], v[222:223], v[214:215]
    v_pk_add_f32 v[184:185], v[224:225], v[214:215]
    v_pk_add_f32 v[186:187], v[226:227], v[214:215]
    v_pk_add_f32 v[188:189], v[228:229], v[214:215]
    v_pk_add_f32 v[190:191], v[230:231], v[214:215]
    v_pk_add_f32 v[192:193], v[232:233], v[214:215]
    v_pk_add_f32 v[194:195], v[234:235], v[214:215]
    v_pk_add_f32 v[196:197], v[236:237], v[214:215]
    v_pk_add_f32 v[198:199], v[238:239], v[214:215]
    v_pk_add_f32 v[200:201], v[240:241], v[214:215]
    v_pk_add_f32 v[202:203], v[242:243], v[214:215]
    v_pk_add_f32 v[204:205], v[244:245], v[214:215]
    v_pk_add_f32 v[206:207], v[246:247], v[214:215]
    v_cvt_pk_bf16_f32 v212, v212, v212
    v_and_b32 v212, 0xffff0000, v212
    v_rcp_f32 v212, v212
    v_cvt_pk_bf16_f32 v40, v176, v177
    v_cvt_pk_bf16_f32 v41, v178, v179
    v_cvt_pk_bf16_f32 v42, v180, v181
    v_cvt_pk_bf16_f32 v43, v182, v183
    v_cvt_pk_bf16_f32 v44, v184, v185
    v_cvt_pk_bf16_f32 v45, v186, v187
    v_cvt_pk_bf16_f32 v46, v188, v189
    v_cvt_pk_bf16_f32 v47, v190, v191
    v_cvt_pk_bf16_f32 v48, v192, v193
    v_cvt_pk_bf16_f32 v49, v194, v195
    v_cvt_pk_bf16_f32 v50, v196, v197
    v_cvt_pk_bf16_f32 v51, v198, v199
    v_cvt_pk_bf16_f32 v52, v200, v201
    v_cvt_pk_bf16_f32 v53, v202, v203
    v_cvt_pk_bf16_f32 v54, v204, v205
    v_cvt_pk_bf16_f32 v55, v206, v207
    v_mov_b32 v213, v212
    v_lshlrev_b32 v176, 16, v40
    v_and_b32 v177, 0xffff0000, v40
    v_lshlrev_b32 v178, 16, v41
    v_and_b32 v179, 0xffff0000, v41
    v_lshlrev_b32 v180, 16, v42
    v_and_b32 v181, 0xffff0000, v42
    v_lshlrev_b32 v182, 16, v43
    v_and_b32 v183, 0xffff0000, v43
    v_lshlrev_b32 v184, 16, v44
    v_and_b32 v185, 0xffff0000, v44
    v_lshlrev_b32 v186, 16, v45
    v_and_b32 v187, 0xffff0000, v45
    v_lshlrev_b32 v188, 16, v46
    v_and_b32 v189, 0xffff0000, v46
    v_lshlrev_b32 v190, 16, v47
    v_and_b32 v191, 0xffff0000, v47
    v_lshlrev_b32 v192, 16, v48
    v_and_b32 v193, 0xffff0000, v48
    v_lshlrev_b32 v194, 16, v49
    v_and_b32 v195, 0xffff0000, v49
    v_lshlrev_b32 v196, 16, v50
    v_and_b32 v197, 0xffff0000, v50
    v_lshlrev_b32 v198, 16, v51
    v_and_b32 v199, 0xffff0000, v51
    v_lshlrev_b32 v200, 16, v52
    v_and_b32 v201, 0xffff0000, v52
    v_lshlrev_b32 v202, 16, v53
    v_and_b32 v203, 0xffff0000, v53
    v_lshlrev_b32 v204, 16, v54
    v_and_b32 v205, 0xffff0000, v54
    v_lshlrev_b32 v206, 16, v55
    v_and_b32 v207, 0xffff0000, v55
    v_pk_mul_f32 v[176:177], v[176:177], v[212:213]
    v_pk_mul_f32 v[178:179], v[178:179], v[212:213]
    v_pk_mul_f32 v[180:181], v[180:181], v[212:213]
    v_pk_mul_f32 v[182:183], v[182:183], v[212:213]
    v_pk_mul_f32 v[184:185], v[184:185], v[212:213]
    v_pk_mul_f32 v[186:187], v[186:187], v[212:213]
    v_pk_mul_f32 v[188:189], v[188:189], v[212:213]
    v_pk_mul_f32 v[190:191], v[190:191], v[212:213]
    v_pk_mul_f32 v[192:193], v[192:193], v[212:213]
    v_pk_mul_f32 v[194:195], v[194:195], v[212:213]
    v_pk_mul_f32 v[196:197], v[196:197], v[212:213]
    v_pk_mul_f32 v[198:199], v[198:199], v[212:213]
    v_pk_mul_f32 v[200:201], v[200:201], v[212:213]
    v_pk_mul_f32 v[202:203], v[202:203], v[212:213]
    v_pk_mul_f32 v[204:205], v[204:205], v[212:213]
    v_pk_mul_f32 v[206:207], v[206:207], v[212:213]
    v_cvt_pk_bf16_f32 v40, v176, v177
    v_cvt_pk_bf16_f32 v41, v178, v179
    v_cvt_pk_bf16_f32 v42, v180, v181
    v_cvt_pk_bf16_f32 v43, v182, v183
    v_cvt_pk_bf16_f32 v44, v184, v185
    v_cvt_pk_bf16_f32 v45, v186, v187
    v_cvt_pk_bf16_f32 v46, v188, v189
    v_cvt_pk_bf16_f32 v47, v190, v191
    v_cvt_pk_bf16_f32 v48, v192, v193
    v_cvt_pk_bf16_f32 v49, v194, v195
    v_cvt_pk_bf16_f32 v50, v196, v197
    v_cvt_pk_bf16_f32 v51, v198, v199
    v_cvt_pk_bf16_f32 v52, v200, v201
    v_cvt_pk_bf16_f32 v53, v202, v203
    v_cvt_pk_bf16_f32 v54, v204, v205
    v_cvt_pk_bf16_f32 v55, v206, v207
    s_cmp_lg_u32 s58, 0
    s_cbranch_scc1 ff_own_152
    ds_write_b128 v12, v[40:43] offset:0
    ds_write_b128 v12, v[44:47] offset:512
    ds_write_b128 v12, v[48:51] offset:1024
    ds_write_b128 v12, v[52:55] offset:1536
    s_cmp_ge_u32 s2, 224
    s_cbranch_scc1 ff_red_153
    v_lshrrev_b32 v12, 4, v3
    v_and_b32 v13, 1, v3
    v_lshlrev_b32 v13, 11, v13
    v_lshl_add_u32 v13, v12, 3, v13
    s_lshl_b32 s54, s30, 9
    s_add_u32 s54, s54, 4096
    v_add_u32 v13, s54, v13
    ds_read_b64 a[64:65], v13 offset:0
    ds_read_b64 a[66:67], v13 offset:32
    ds_read_b64 a[68:69], v13 offset:64
    ds_read_b64 a[70:71], v13 offset:96
    ds_read_b64 a[72:73], v13 offset:128
    ds_read_b64 a[74:75], v13 offset:160
    ds_read_b64 a[76:77], v13 offset:192
    ds_read_b64 a[78:79], v13 offset:224
    ds_read_b64 a[80:81], v13 offset:256
    ds_read_b64 a[82:83], v13 offset:288
    ds_read_b64 a[84:85], v13 offset:320
    ds_read_b64 a[86:87], v13 offset:352
    ds_read_b64 a[88:89], v13 offset:384
    ds_read_b64 a[90:91], v13 offset:416
    ds_read_b64 a[92:93], v13 offset:448
    ds_read_b64 a[94:95], v13 offset:480
    v_lshlrev_b32 v13, 6, v8
    v_lshl_add_u32 v13, v12, 4, v13
    s_lshl_b32 s54, s30, 11
    s_add_u32 s54, s54, 8448
    v_add_u32 v13, s54, v13
    s_waitcnt lgkmcnt(0)
    v_mfma_f32_16x16x32_bf16 v[16:19], a[0:3], a[64:67], 0
    v_mfma_f32_16x16x32_bf16 v[20:23], a[32:35], a[64:67], 0
    v_mfma_f32_16x16x32_bf16 v[16:19], a[4:7], a[68:71], v[16:19]
    v_mfma_f32_16x16x32_bf16 v[20:23], a[36:39], a[68:71], v[20:23]
    v_mfma_f32_16x16x32_bf16 v[16:19], a[8:11], a[72:75], v[16:19]
    v_mfma_f32_16x16x32_bf16 v[20:23], a[40:43], a[72:75], v[20:23]
    v_mfma_f32_16x16x32_bf16 v[16:19], a[12:15], a[76:79], v[16:19]
    v_mfma_f32_16x16x32_bf16 v[20:23], a[44:47], a[76:79], v[20:23]
    v_mfma_f32_16x16x32_bf16 v[16:19], a[16:19], a[80:83], v[16:19]
    v_mfma_f32_16x16x32_bf16 v[20:23], a[48:51], a[80:83], v[20:23]
    v_mfma_f32_16x16x32_bf16 v[16:19], a[20:23], a[84:87], v[16:19]
    v_mfma_f32_16x16x32_bf16 v[20:23], a[52:55], a[84:87], v[20:23]
    v_mfma_f32_16x16x32_bf16 v[16:19], a[24:27], a[88:91], v[16:19]
    v_mfma_f32_16x16x32_bf16 v[20:23], a[56:59], a[88:91], v[20:23]
    v_mfma_f32_16x16x32_bf16 v[16:19], a[28:31], a[92:95], v[16:19]
    v_mfma_f32_16x16x32_bf16 v[20:23], a[60:63], a[92:95], v[20:23]
    s_nop 7
    ds_write_b128 v13, v[16:19]
    ds_write_b128 v13, v[20:23] offset:1024
    v_lshlrev_b32 v13, 2, v4
    v_add_u32 v13, 8448, v13
    s_waitcnt lgkmcnt(0)
    s_barrier
    ds_read2st64_b32 v[16:17], v13 offset0:0 offset1:4
    ds_read2st64_b32 v[18:19], v13 offset0:8 offset1:12
    ds_read2st64_b32 v[20:21], v13 offset0:16 offset1:20
    ds_read2st64_b32 v[22:23], v13 offset0:24 offset1:28
    s_waitcnt lgkmcnt(0)
    v_pk_add_f32 v[16:17], v[16:17], v[20:21]
    v_pk_add_f32 v[18:19], v[18:19], v[22:23]
    v_pk_add_f32 v[16:17], v[16:17], v[18:19]
    v_cvt_pk_bf16_f32 v16, v16, v17
    v_and_b32 v20, 0xffff0000, v16
    v_lshlrev_b32 v16, 16, v16
    v_mul_f32 v17, 0xbfb8aa3b, v16
    v_exp_f32 v17, v17
    s_lshl_b32 s54, s55, 12
    v_add_f32 v17, 1.0, v17
    v_rcp_f32 v17, v17
    s_add_u32 s53, s54, 4096
    v_mul_f32 v16, v16, v17
    v_cvt_pk_bf16_f32 v16, v16, v16
    v_and_b32 v16, 0xffff0000, v16
    v_mul_f32 v16, v16, v20
    s_nop 1
    v_mov_b32_dpp v17, v16 quad_perm:[1,0,3,2] row_mask:0xf bank_mask:0xf
    v_cvt_pk_bf16_f32 v16, v16, v17
    v_lshlrev_b32 v13, 4, v2
    v_readlane_b32 s8, v16, 0
    v_readlane_b32 s9, v16, 2
    v_readlane_b32 s10, v16, 4
    v_readlane_b32 s11, v16, 6
    v_readlane_b32 s12, v16, 8
    v_readlane_b32 s13, v16, 10
    v_readlane_b32 s14, v16, 12
    v_readlane_b32 s15, v16, 14
    v_readlane_b32 s16, v16, 16
    v_readlane_b32 s17, v16, 18
    v_readlane_b32 s18, v16, 20
    v_readlane_b32 s19, v16, 22
    v_readlane_b32 s20, v16, 24
    v_readlane_b32 s21, v16, 26
    v_readlane_b32 s22, v16, 28
    v_readlane_b32 s23, v16, 30
    v_dot2_f32_bf16 v24, v144, s8, 0
    v_dot2_f32_bf16 v25, v145, s8, 0
    v_dot2_f32_bf16 v26, v146, s8, 0
    v_dot2_f32_bf16 v27, v147, s8, 0
    v_dot2_f32_bf16 v24, v148, s9, v24
    v_dot2_f32_bf16 v25, v149, s9, v25
    v_dot2_f32_bf16 v26, v150, s9, v26
    v_dot2_f32_bf16 v27, v151, s9, v27
    v_dot2_f32_bf16 v24, v152, s10, v24
    v_dot2_f32_bf16 v25, v153, s10, v25
    v_dot2_f32_bf16 v26, v154, s10, v26
    v_dot2_f32_bf16 v27, v155, s10, v27
    v_dot2_f32_bf16 v24, v156, s11, v24
    v_dot2_f32_bf16 v25, v157, s11, v25
    v_dot2_f32_bf16 v26, v158, s11, v26
    v_dot2_f32_bf16 v27, v159, s11, v27
    v_dot2_f32_bf16 v24, v160, s12, v24
    v_dot2_f32_bf16 v25, v161, s12, v25
    v_dot2_f32_bf16 v26, v162, s12, v26
    v_dot2_f32_bf16 v27, v163, s12, v27
    v_dot2_f32_bf16 v24, v164, s13, v24
    v_dot2_f32_bf16 v25, v165, s13, v25
    v_dot2_f32_bf16 v26, v166, s13, v26
    v_dot2_f32_bf16 v27, v167, s13, v27
    v_dot2_f32_bf16 v24, v168, s14, v24
    v_dot2_f32_bf16 v25, v169, s14, v25
    v_dot2_f32_bf16 v26, v170, s14, v26
    v_dot2_f32_bf16 v27, v171, s14, v27
    v_dot2_f32_bf16 v24, v172, s15, v24
    v_dot2_f32_bf16 v25, v173, s15, v25
    v_dot2_f32_bf16 v26, v174, s15, v26
    v_dot2_f32_bf16 v27, v175, s15, v27
    v_dot2_f32_bf16 v28, v144, s16, 0
    v_dot2_f32_bf16 v29, v145, s16, 0
    v_dot2_f32_bf16 v30, v146, s16, 0
    v_dot2_f32_bf16 v31, v147, s16, 0
    v_dot2_f32_bf16 v28, v148, s17, v28
    v_dot2_f32_bf16 v29, v149, s17, v29
    v_dot2_f32_bf16 v30, v150, s17, v30
    v_dot2_f32_bf16 v31, v151, s17, v31
    v_dot2_f32_bf16 v28, v152, s18, v28
    v_dot2_f32_bf16 v29, v153, s18, v29
    v_dot2_f32_bf16 v30, v154, s18, v30
    v_dot2_f32_bf16 v31, v155, s18, v31
    v_dot2_f32_bf16 v28, v156, s19, v28
    v_dot2_f32_bf16 v29, v157, s19, v29
    v_dot2_f32_bf16 v30, v158, s19, v30
    v_dot2_f32_bf16 v31, v159, s19, v31
    v_dot2_f32_bf16 v28, v160, s20, v28
    v_dot2_f32_bf16 v29, v161, s20, v29
    v_dot2_f32_bf16 v30, v162, s20, v30
    v_dot2_f32_bf16 v31, v163, s20, v31
    v_dot2_f32_bf16 v28, v164, s21, v28
    v_dot2_f32_bf16 v29, v165, s21, v29
    v_dot2_f32_bf16 v30, v166, s21, v30
    v_dot2_f32_bf16 v31, v167, s21, v31
    v_dot2_f32_bf16 v28, v168, s22, v28
    v_dot2_f32_bf16 v29, v169, s22, v29
    v_dot2_f32_bf16 v30, v170, s22, v30
    v_dot2_f32_bf16 v31, v171, s22, v31
    v_dot2_f32_bf16 v28, v172, s23, v28
    v_dot2_f32_bf16 v29, v173, s23, v29
    v_dot2_f32_bf16 v30, v174, s23, v30
    v_dot2_f32_bf16 v31, v175, s23, v31
    s_nop 2
    v_cvt_pk_bf16_f32 v24, v24, v25
    v_cvt_pk_bf16_f32 v25, v26, v27
    v_cvt_pk_bf16_f32 v26, v28, v29
    v_cvt_pk_bf16_f32 v27, v30, v31
    v_min_u32 v24, -2, v24
    v_min_u32 v25, -2, v25
    v_min_u32 v26, -2, v26
    v_min_u32 v27, -2, v27
    buffer_store_dwordx4 v[24:27], v13, s[48:51], s54 offen sc1
    s_waitcnt vmcnt(1)
    v_mov_b32 v40, v128
    v_mov_b32 v41, v129
    v_mov_b32 v42, v130
    v_mov_b32 v43, v131
    v_mov_b32 v44, v132
    v_mov_b32 v45, v133
    v_mov_b32 v46, v134
    v_mov_b32 v47, v135
    v_mov_b32 v48, v136
    v_mov_b32 v49, v137
    v_mov_b32 v50, v138
    v_mov_b32 v51, v139
    v_mov_b32 v52, v140
    v_mov_b32 v53, v141
    v_mov_b32 v54, v142
    v_mov_b32 v55, v143
    s_mov_b32 s58, 1
    s_branch ff_ln_151
ff_own_152:
    v_lshlrev_b32 v176, 16, v40
    v_and_b32 v177, 0xffff0000, v40
    v_lshlrev_b32 v178, 16, v41
    v_and_b32 v179, 0xffff0000, v41
    v_lshlrev_b32 v180, 16, v42
    v_and_b32 v181, 0xffff0000, v42
    v_lshlrev_b32 v182, 16, v43
    v_and_b32 v183, 0xffff0000, v43
    v_lshlrev_b32 v184, 16, v44
    v_and_b32 v185, 0xffff0000, v44
    v_lshlrev_b32 v186, 16, v45
    v_and_b32 v187, 0xffff0000, v45
    v_lshlrev_b32 v188, 16, v46
    v_and_b32 v189, 0xffff0000, v46
    v_lshlrev_b32 v190, 16, v47
    v_and_b32 v191, 0xffff0000, v47
    v_lshlrev_b32 v192, 16, v48
    v_and_b32 v193, 0xffff0000, v48
    v_lshlrev_b32 v194, 16, v49
    v_and_b32 v195, 0xffff0000, v49
    v_lshlrev_b32 v196, 16, v50
    v_and_b32 v197, 0xffff0000, v50
    v_lshlrev_b32 v198, 16, v51
    v_and_b32 v199, 0xffff0000, v51
    v_lshlrev_b32 v200, 16, v52
    v_and_b32 v201, 0xffff0000, v52
    v_lshlrev_b32 v202, 16, v53
    v_and_b32 v203, 0xffff0000, v53
    v_lshlrev_b32 v204, 16, v54
    v_and_b32 v205, 0xffff0000, v54
    v_lshlrev_b32 v206, 16, v55
    v_and_b32 v207, 0xffff0000, v55
    v_pk_add_f32 v[176:177], v[176:177], v[216:217]
    v_pk_add_f32 v[178:179], v[178:179], v[218:219]
    v_pk_add_f32 v[180:181], v[180:181], v[220:221]
    v_pk_add_f32 v[182:183], v[182:183], v[222:223]
    v_pk_add_f32 v[184:185], v[184:185], v[224:225]
    v_pk_add_f32 v[186:187], v[186:187], v[226:227]
    v_pk_add_f32 v[188:189], v[188:189], v[228:229]
    v_pk_add_f32 v[190:191], v[190:191], v[230:231]
    v_pk_add_f32 v[192:193], v[192:193], v[232:233]
    v_pk_add_f32 v[194:195], v[194:195], v[234:235]
    v_pk_add_f32 v[196:197], v[196:197], v[236:237]
    v_pk_add_f32 v[198:199], v[198:199], v[238:239]
    v_pk_add_f32 v[200:201], v[200:201], v[240:241]
    v_pk_add_f32 v[202:203], v[202:203], v[242:243]
    v_pk_add_f32 v[204:205], v[204:205], v[244:245]
    v_pk_add_f32 v[206:207], v[206:207], v[246:247]
    v_cvt_pk_bf16_f32 v40, v176, v177
    v_cvt_pk_bf16_f32 v41, v178, v179
    v_cvt_pk_bf16_f32 v42, v180, v181
    v_cvt_pk_bf16_f32 v43, v182, v183
    v_cvt_pk_bf16_f32 v44, v184, v185
    v_cvt_pk_bf16_f32 v45, v186, v187
    v_cvt_pk_bf16_f32 v46, v188, v189
    v_cvt_pk_bf16_f32 v47, v190, v191
    v_cvt_pk_bf16_f32 v48, v192, v193
    v_cvt_pk_bf16_f32 v49, v194, v195
    v_cvt_pk_bf16_f32 v50, v196, v197
    v_cvt_pk_bf16_f32 v51, v198, v199
    v_cvt_pk_bf16_f32 v52, v200, v201
    v_cvt_pk_bf16_f32 v53, v202, v203
    v_cvt_pk_bf16_f32 v54, v204, v205
    v_cvt_pk_bf16_f32 v55, v206, v207
    buffer_store_dwordx4 v[40:43], v0, s[36:39], 0 offen offset:0 sc1
    buffer_store_dwordx4 v[44:47], v0, s[36:39], 0 offen offset:512 sc1
    buffer_store_dwordx4 v[48:51], v0, s[36:39], 0 offen offset:1024 sc1
    buffer_store_dwordx4 v[52:55], v0, s[36:39], 0 offen offset:1536 sc1
    s_cmp_ge_u32 s2, 224
    s_cbranch_scc1 ff_red2_154
    s_branch ff_fin_155
ff_red_153:
    s_sub_u32 s40, s2, 224
    s_mov_b32 s8, s56
    s_and_b32 s9, s57, 0xffff
    s_mov_b32 s10, 0x800
    s_mov_b32 s11, 0x00020000
    buffer_load_dwordx4 v[96:99], v7, s[8:11], 0 offen offset:0
    buffer_load_dwordx4 v[100:103], v7, s[8:11], 0 offen offset:512
    buffer_load_dwordx4 v[104:107], v7, s[8:11], 0 offen offset:1024
    buffer_load_dwordx4 v[108:111], v7, s[8:11], 0 offen offset:1536
    v_and_b32 v8, 7, v3
    s_lshl_b32 s47, s40, 6
    v_lshl_add_u32 v9, v8, 3, s47
    v_lshl_add_u32 v12, v5, 11, v9
    v_add_u32 v12, 4096, v12
    v_lshl_add_u32 v9, v15, 11, v9
    s_waitcnt lgkmcnt(0)
    ds_read_b64 v[32:33], v12
    buffer_load_dwordx2 v[34:35], v9, s[24:27], 0 offen sc1
    v_lshrrev_b32 v10, 3, v2
    v_lshlrev_b32 v10, 12, v10
    v_lshl_add_u32 v10, v8, 4, v10
    s_lshl_b32 s47, s40, 7
    s_waitcnt vmcnt(1)
    v_dot2_f32_bf16 v36, v40, v96, 0
    v_dot2_f32_bf16 v36, v41, v97, v36
    v_dot2_f32_bf16 v36, v42, v98, v36
    v_dot2_f32_bf16 v36, v43, v99, v36
    v_dot2_f32_bf16 v36, v44, v100, v36
    v_dot2_f32_bf16 v36, v45, v101, v36
    v_dot2_f32_bf16 v36, v46, v102, v36
    v_dot2_f32_bf16 v36, v47, v103, v36
    v_dot2_f32_bf16 v36, v48, v104, v36
    v_dot2_f32_bf16 v36, v49, v105, v36
    v_dot2_f32_bf16 v36, v50, v106, v36
    v_dot2_f32_bf16 v36, v51, v107, v36
    v_dot2_f32_bf16 v36, v52, v108, v36
    v_dot2_f32_bf16 v36, v53, v109, v36
    v_dot2_f32_bf16 v36, v54, v110, v36
    v_dot2_f32_bf16 v36, v55, v111, v36
    s_nop 2
    s_nop 1
    v_add_f32_dpp v36, v36, v36 quad_perm:[1,0,3,2] row_mask:0xf bank_mask:0xf
    s_nop 1
    v_add_f32_dpp v36, v36, v36 quad_perm:[2,3,0,1] row_mask:0xf bank_mask:0xf
    s_nop 1
    v_add_f32_dpp v36, v36, v36 row_half_mirror row_mask:0xf bank_mask:0xf
    s_nop 1
    v_add_f32_dpp v36, v36, v36 row_mirror row_mask:0xf bank_mask:0xf
    v_mov_b32 v13, v36
    s_nop 1
    v_permlane16_swap_b32 v36, v13
    s_nop 1
    v_add_f32 v36, v36, v13
    v_cvt_pk_bf16_f32 v36, v36, v36
    v_and_b32 v36, 0xffff0000, v36
    v_mul_f32 v36, 0xbfb8aa3b, v36
    v_exp_f32 v36, v36
    s_nop 0
    v_add_f32 v36, 1.0, v36
    v_rcp_f32 v36, v36
    s_nop 0
    v_cvt_pk_bf16_f32 v36, v36, v36
    v_and_b32 v36, 0xffff0000, v36
    v_mov_b32 v40, v128
    v_mov_b32 v41, v129
    v_mov_b32 v42, v130
    v_mov_b32 v43, v131
    v_mov_b32 v44, v132
    v_mov_b32 v45, v133
    v_mov_b32 v46, v134
    v_mov_b32 v47, v135
    v_mov_b32 v48, v136
    v_mov_b32 v49, v137
    v_mov_b32 v50, v138
    v_mov_b32 v51, v139
    v_mov_b32 v52, v140
    v_mov_b32 v53, v141
    v_mov_b32 v54, v142
    v_mov_b32 v55, v143
    s_mov_b32 s58, 1
    s_branch ff_ln_151
ff_red2_154:
    s_mov_b32 s52, 1048576
ff_rpoll_157:
    s_mov_b32 s53, s47
    buffer_load_dwordx4 v[96:99], v10, s[48:51], s53 offen sc1
    s_add_u32 s53, s53, 0x20000
    buffer_load_dwordx4 v[100:103], v10, s[48:51], s53 offen sc1
    s_add_u32 s53, s53, 0x20000
    buffer_load_dwordx4 v[104:107], v10, s[48:51], s53 offen sc1
    s_add_u32 s53, s53, 0x20000
    buffer_load_dwordx4 v[108:111], v10, s[48:51], s53 offen sc1
    s_add_u32 s53, s53, 0x20000
    buffer_load_dwordx4 v[112:115], v10, s[48:51], s53 offen sc1
    s_add_u32 s53, s53, 0x20000
    buffer_load_dwordx4 v[116:119], v10, s[48:51], s53 offen sc1
    s_add_u32 s53, s53, 0x20000
    buffer_load_dwordx4 v[120:123], v10, s[48:51], s53 offen sc1
    s_add_u32 s53, s53, 0x20000
    v_mov_b32 v13, 0
    s_waitcnt vmcnt(6)
    v_max3_u32 v13, v13, v96, v97
    v_max3_u32 v13, v13, v98, v99
    s_waitcnt vmcnt(5)
    v_max3_u32 v13, v13, v100, v101
    v_max3_u32 v13, v13, v102, v103
    s_waitcnt vmcnt(4)
    v_max3_u32 v13, v13, v104, v105
    v_max3_u32 v13, v13, v106, v107
    s_waitcnt vmcnt(3)
    v_max3_u32 v13, v13, v108, v109
    v_max3_u32 v13, v13, v110, v111
    s_waitcnt vmcnt(2)
    v_max3_u32 v13, v13, v112, v113
    v_max3_u32 v13, v13, v114, v115
    s_waitcnt vmcnt(1)
    v_max3_u32 v13, v13, v116, v117
    v_max3_u32 v13, v13, v118, v119
    s_waitcnt vmcnt(0)
    v_max3_u32 v13, v13, v120, v121
    v_max3_u32 v13, v13, v122, v123
    s_sub_u32 s52, s52, 1
    s_cbranch_scc1 ff_rgo_156
    v_cmp_eq_u32 vcc, -1, v13
    s_cbranch_vccnz ff_rpoll_157
ff_rgo_156:
    s_mov_b32 s52, 0x00003f80
    s_mov_b32 s53, 0x3f800000
    v_dot2_f32_bf16 v128, v96, s52, 0
    v_dot2_f32_bf16 v129, v96, s53, 0
    v_dot2_f32_bf16 v130, v97, s52, 0
    v_dot2_f32_bf16 v131, v97, s53, 0
    v_dot2_f32_bf16 v132, v98, s52, 0
    v_dot2_f32_bf16 v133, v98, s53, 0
    v_dot2_f32_bf16 v134, v99, s52, 0
    v_dot2_f32_bf16 v135, v99, s53, 0
    v_dot2_f32_bf16 v128, v100, s52, v128
    v_dot2_f32_bf16 v129, v100, s53, v129
    v_dot2_f32_bf16 v130, v101, s52, v130
    v_dot2_f32_bf16 v131, v101, s53, v131
    v_dot2_f32_bf16 v132, v102, s52, v132
    v_dot2_f32_bf16 v133, v102, s53, v133
    v_dot2_f32_bf16 v134, v103, s52, v134
    v_dot2_f32_bf16 v135, v103, s53, v135
    v_dot2_f32_bf16 v128, v104, s52, v128
    v_dot2_f32_bf16 v129, v104, s53, v129
    v_dot2_f32_bf16 v130, v105, s52, v130
    v_dot2_f32_bf16 v131, v105, s53, v131
    v_dot2_f32_bf16 v132, v106, s52, v132
    v_dot2_f32_bf16 v133, v106, s53, v133
    v_dot2_f32_bf16 v134, v107, s52, v134
    v_dot2_f32_bf16 v135, v107, s53, v135
    v_dot2_f32_bf16 v128, v108, s52, v128
    v_dot2_f32_bf16 v129, v108, s53, v129
    v_dot2_f32_bf16 v130, v109, s52, v130
    v_dot2_f32_bf16 v131, v109, s53, v131
    v_dot2_f32_bf16 v132, v110, s52, v132
    v_dot2_f32_bf16 v133, v110, s53, v133
    v_dot2_f32_bf16 v134, v111, s52, v134
    v_dot2_f32_bf16 v135, v111, s53, v135
    v_dot2_f32_bf16 v128, v112, s52, v128
    v_dot2_f32_bf16 v129, v112, s53, v129
    v_dot2_f32_bf16 v130, v113, s52, v130
    v_dot2_f32_bf16 v131, v113, s53, v131
    v_dot2_f32_bf16 v132, v114, s52, v132
    v_dot2_f32_bf16 v133, v114, s53, v133
    v_dot2_f32_bf16 v134, v115, s52, v134
    v_dot2_f32_bf16 v135, v115, s53, v135
    v_dot2_f32_bf16 v128, v116, s52, v128
    v_dot2_f32_bf16 v129, v116, s53, v129
    v_dot2_f32_bf16 v130, v117, s52, v130
    v_dot2_f32_bf16 v131, v117, s53, v131
    v_dot2_f32_bf16 v132, v118, s52, v132
    v_dot2_f32_bf16 v133, v118, s53, v133
    v_dot2_f32_bf16 v134, v119, s52, v134
    v_dot2_f32_bf16 v135, v119, s53, v135
    v_dot2_f32_bf16 v128, v120, s52, v128
    v_dot2_f32_bf16 v129, v120, s53, v129
    v_dot2_f32_bf16 v130, v121, s52, v130
    v_dot2_f32_bf16 v131, v121, s53, v131
    v_dot2_f32_bf16 v132, v122, s52, v132
    v_dot2_f32_bf16 v133, v122, s53, v133
    v_dot2_f32_bf16 v134, v123, s52, v134
    v_dot2_f32_bf16 v135, v123, s53, v135
    s_nop 2
    v_permlane32_swap_b32 v128, v132
    v_permlane32_swap_b32 v129, v133
    v_permlane32_swap_b32 v130, v134
    v_permlane32_swap_b32 v131, v135
    s_nop 1
    v_add_f32 v128, v128, v132
    v_add_f32 v129, v129, v133
    v_add_f32 v130, v130, v134
    v_add_f32 v131, v131, v135
    s_nop 1
    v_add_f32_dpp v128, v128, v128 row_ror:8 row_mask:0xf bank_mask:0xf
    v_add_f32_dpp v129, v129, v129 row_ror:8 row_mask:0xf bank_mask:0xf
    v_add_f32_dpp v130, v130, v130 row_ror:8 row_mask:0xf bank_mask:0xf
    v_add_f32_dpp v131, v131, v131 row_ror:8 row_mask:0xf bank_mask:0xf
    v_mov_b32 v132, v128
    v_mov_b32 v133, v129
    v_mov_b32 v134, v130
    v_mov_b32 v135, v131
    s_nop 1
    v_permlane16_swap_b32 v128, v132
    v_permlane16_swap_b32 v129, v133
    v_permlane16_swap_b32 v130, v134
    v_permlane16_swap_b32 v131, v135
    s_nop 1
    v_add_f32 v128, v128, v132
    v_add_f32 v129, v129, v133
    v_add_f32 v130, v130, v134
    v_add_f32 v131, v131, v135
    v_lshlrev_b32 v14, 4, v8
    v_lshl_add_u32 v14, v5, 7, v14
    s_lshl_b32 s31, s30, 8
    v_add_u32 v13, s31, v14
    ds_write_b128 v13, v[128:131]
    s_waitcnt lgkmcnt(0)
    s_barrier
    ds_read_b128 v[96:99], v14 offset:0
    ds_read_b128 v[100:103], v14 offset:256
    ds_read_b128 v[104:107], v14 offset:512
    ds_read_b128 v[108:111], v14 offset:768
    s_waitcnt lgkmcnt(0)
    v_pk_add_f32 v[96:97], v[96:97], v[100:101]
    v_pk_add_f32 v[98:99], v[98:99], v[102:103]
    v_pk_add_f32 v[96:97], v[96:97], v[104:105]
    v_pk_add_f32 v[98:99], v[98:99], v[106:107]
    v_pk_add_f32 v[96:97], v[96:97], v[108:109]
    v_pk_add_f32 v[98:99], v[98:99], v[110:111]
    v_cvt_pk_bf16_f32 v20, v96, v97
    v_lshlrev_b32 v21, 16, v20
    v_and_b32 v22, 0xffff0000, v20
    v_mul_f32 v21, v36, v21
    v_mul_f32 v22, v36, v22
    v_cvt_pk_bf16_f32 v20, v21, v22
    v_lshlrev_b32 v21, 16, v20
    v_and_b32 v22, 0xffff0000, v20
    v_lshlrev_b32 v23, 16, v32
    v_and_b32 v24, 0xffff0000, v32
    v_add_f32 v21, v21, v23
    v_add_f32 v22, v22, v24
    v_cvt_pk_bf16_f32 v20, v21, v22
    v_lshlrev_b32 v21, 16, v20
    v_and_b32 v22, 0xffff0000, v20
    v_lshlrev_b32 v23, 16, v34
    v_and_b32 v24, 0xffff0000, v34
    v_add_f32 v21, v21, v23
    v_add_f32 v22, v22, v24
    v_cvt_pk_bf16_f32 v26, v21, v22
    v_cvt_pk_bf16_f32 v20, v98, v99
    v_lshlrev_b32 v21, 16, v20
    v_and_b32 v22, 0xffff0000, v20
    v_mul_f32 v21, v36, v21
    v_mul_f32 v22, v36, v22
    v_cvt_pk_bf16_f32 v20, v21, v22
    v_lshlrev_b32 v21, 16, v20
    v_and_b32 v22, 0xffff0000, v20
    v_lshlrev_b32 v23, 16, v33
    v_and_b32 v24, 0xffff0000, v33
    v_add_f32 v21, v21, v23
    v_add_f32 v22, v22, v24
    v_cvt_pk_bf16_f32 v20, v21, v22
    v_lshlrev_b32 v21, 16, v20
    v_and_b32 v22, 0xffff0000, v20
    v_lshlrev_b32 v23, 16, v35
    v_and_b32 v24, 0xffff0000, v35
    v_add_f32 v21, v21, v23
    v_add_f32 v22, v22, v24
    v_cvt_pk_bf16_f32 v27, v21, v22
    s_cmp_lg_u32 s30, 0
    s_cbranch_scc1 ff_fin_155
    s_mov_b32 exec_lo, 0xff
    s_mov_b32 exec_hi, 0xff
    buffer_store_dwordx2 v[26:27], v9, s[36:39], 0 offen sc1
ff_fin_155:
    s_mov_b64 exec, -1
k12_end_1:
    s_endpgm
k2_prep_76:
    s_sub_u32 s40, s36, s38
    v_subrev_u32 v6, s40, v4
    v_cmp_gt_i32 s[44:45], 0, v6
    v_cmp_gt_i32 s[46:47], 1, v6
    v_cmp_gt_i32 s[48:49], 2, v6
    v_cmp_gt_i32 s[50:51], 3, v6
    v_cndmask_b32 v16, v8, v5, s[44:45]
    v_cndmask_b32 v17, v8, v5, s[46:47]
    v_cndmask_b32 v18, v8, v5, s[48:49]
    v_cndmask_b32 v19, v8, v5, s[50:51]
    v_cmp_gt_i32 s[44:45], 16, v6
    v_cmp_gt_i32 s[46:47], 17, v6
    v_cmp_gt_i32 s[48:49], 18, v6
    v_cmp_gt_i32 s[50:51], 19, v6
    v_cndmask_b32 v32, v8, v5, s[44:45]
    v_cndmask_b32 v33, v8, v5, s[46:47]
    v_cndmask_b32 v34, v8, v5, s[48:49]
    v_cndmask_b32 v35, v8, v5, s[50:51]
    s_nop 1
    s_branch k2_prepret_77
k2_prep_84:
    s_sub_u32 s40, s36, s38
    v_subrev_u32 v6, s40, v4
    v_cmp_gt_i32 s[44:45], 0, v6
    v_cmp_gt_i32 s[46:47], 1, v6
    v_cmp_gt_i32 s[48:49], 2, v6
    v_cmp_gt_i32 s[50:51], 3, v6
    v_cndmask_b32 v16, v8, v5, s[44:45]
    v_cndmask_b32 v17, v8, v5, s[46:47]
    v_cndmask_b32 v18, v8, v5, s[48:49]
    v_cndmask_b32 v19, v8, v5, s[50:51]
    v_cmp_gt_i32 s[44:45], 16, v6
    v_cmp_gt_i32 s[46:47], 17, v6
    v_cmp_gt_i32 s[48:49], 18, v6
    v_cmp_gt_i32 s[50:51], 19, v6
    v_cndmask_b32 v32, v8, v5, s[44:45]
    v_cndmask_b32 v33, v8, v5, s[46:47]
    v_cndmask_b32 v34, v8, v5, s[48:49]
    v_cndmask_b32 v35, v8, v5, s[50:51]
    s_nop 1
    s_branch k2_prepret_85
k2_prep_102:
    s_sub_u32 s40, s36, s39
    v_subrev_u32 v6, s40, v4
    v_cmp_gt_i32 s[44:45], 0, v6
    v_cmp_gt_i32 s[46:47], 1, v6
    v_cmp_gt_i32 s[48:49], 2, v6
    v_cmp_gt_i32 s[50:51], 3, v6
    v_cndmask_b32 v16, v10, v5, s[44:45]
    v_cndmask_b32 v17, v10, v5, s[46:47]
    v_cndmask_b32 v18, v10, v5, s[48:49]
    v_cndmask_b32 v19, v10, v5, s[50:51]
    v_cmp_gt_i32 s[44:45], 16, v6
    v_cmp_gt_i32 s[46:47], 17, v6
    v_cmp_gt_i32 s[48:49], 18, v6
    v_cmp_gt_i32 s[50:51], 19, v6
    v_cndmask_b32 v32, v10, v5, s[44:45]
    v_cndmask_b32 v33, v10, v5, s[46:47]
    v_cndmask_b32 v34, v10, v5, s[48:49]
    v_cndmask_b32 v35, v10, v5, s[50:51]
    v_cmp_gt_i32 s[44:45], 32, v6
    v_cmp_gt_i32 s[46:47], 33, v6
    v_cmp_gt_i32 s[48:49], 34, v6
    v_cmp_gt_i32 s[50:51], 35, v6
    v_cndmask_b32 v24, v10, v5, s[44:45]
    v_cndmask_b32 v25, v10, v5, s[46:47]
    v_cndmask_b32 v26, v10, v5, s[48:49]
    v_cndmask_b32 v27, v10, v5, s[50:51]
    v_cmp_gt_i32 s[44:45], 48, v6
    v_cmp_gt_i32 s[46:47], 49, v6
    v_cmp_gt_i32 s[48:49], 50, v6
    v_cmp_gt_i32 s[50:51], 51, v6
    v_cndmask_b32 v40, v10, v5, s[44:45]
    v_cndmask_b32 v41, v10, v5, s[46:47]
    v_cndmask_b32 v42, v10, v5, s[48:49]
    v_cndmask_b32 v43, v10, v5, s[50:51]
    s_nop 1
    s_branch k2_prepret_103
k2_prep_106:
    s_sub_u32 s40, s36, s39
    s_sub_u32 s40, s40, 64
    v_subrev_u32 v6, s40, v4
    v_cmp_gt_i32 s[44:45], 0, v6
    v_cmp_gt_i32 s[46:47], 1, v6
    v_cmp_gt_i32 s[48:49], 2, v6
    v_cmp_gt_i32 s[50:51], 3, v6
    v_cndmask_b32 v20, v11, v5, s[44:45]
    v_cndmask_b32 v21, v11, v5, s[46:47]
    v_cndmask_b32 v22, v11, v5, s[48:49]
    v_cndmask_b32 v23, v11, v5, s[50:51]
    v_cmp_gt_i32 s[44:45], 16, v6
    v_cmp_gt_i32 s[46:47], 17, v6
    v_cmp_gt_i32 s[48:49], 18, v6
    v_cmp_gt_i32 s[50:51], 19, v6
    v_cndmask_b32 v36, v11, v5, s[44:45]
    v_cndmask_b32 v37, v11, v5, s[46:47]
    v_cndmask_b32 v38, v11, v5, s[48:49]
    v_cndmask_b32 v39, v11, v5, s[50:51]
    v_cmp_gt_i32 s[44:45], 32, v6
    v_cmp_gt_i32 s[46:47], 33, v6
    v_cmp_gt_i32 s[48:49], 34, v6
    v_cmp_gt_i32 s[50:51], 35, v6
    v_cndmask_b32 v28, v11, v5, s[44:45]
    v_cndmask_b32 v29, v11, v5, s[46:47]
    v_cndmask_b32 v30, v11, v5, s[48:49]
    v_cndmask_b32 v31, v11, v5, s[50:51]
    v_cmp_gt_i32 s[44:45], 48, v6
    v_cmp_gt_i32 s[46:47], 49, v6
    v_cmp_gt_i32 s[48:49], 50, v6
    v_cmp_gt_i32 s[50:51], 51, v6
    v_cndmask_b32 v44, v11, v5, s[44:45]
    v_cndmask_b32 v45, v11, v5, s[46:47]
    v_cndmask_b32 v46, v11, v5, s[48:49]
    v_cndmask_b32 v47, v11, v5, s[50:51]
    s_nop 1
    s_branch k2_prepret_107
k12_ool_10:
    buffer_load_dword v52, v8, s[24:27], 0 offen sc1
    s_branch k12_oolret_11
k12_ool_14:
    v_readfirstlane_b32 s31, v52
    s_cmp_ge_u32 s31, 256
    s_cbranch_scc1 spin_ok_12
    s_mov_b32 s40, 1048576
spin_13:
    s_sleep 8
    buffer_load_dword v52, v8, s[24:27], 0 offen sc1
    s_waitcnt vmcnt(0)
    v_readfirstlane_b32 s31, v52
    s_sub_u32 s40, s40, 1
    s_cselect_b32 s31, -1, s31
    s_cmp_lt_u32 s31, 256
    s_cbranch_scc1 spin_13
spin_ok_12:
    s_branch k12_oolret_15
k12_ool_16:
    s_mov_b64 exec, 1
    buffer_atomic_add v9, v8, s[24:27], 0 offen sc1
    s_mov_b64 exec, -1
    s_branch k12_oolret_17
k12_ool_18:
    buffer_load_dword v51, v50, s[12:15], s56 offen
    s_branch k12_oolret_19
k12_ool_20:
    s_add_u32 m0, s60, 131072
    s_nop 0
    buffer_load_dwordx4 v38, s[12:15], s61 offen offset:0 lds
    buffer_load_dwordx4 v39, s[12:15], s61 offen offset:1024 lds
    buffer_load_dwordx4 v40, s[12:15], s61 offen offset:2048 lds
    buffer_load_dwordx4 v41, s[12:15], s61 offen offset:3072 lds
    s_add_u32 s61, s61, 0x80000
    s_add_u32 m0, s60, 147456
    s_nop 0
    buffer_load_dwordx4 v38, s[12:15], s61 offen offset:0 lds
    buffer_load_dwordx4 v39, s[12:15], s61 offen offset:1024 lds
    buffer_load_dwordx4 v40, s[12:15], s61 offen offset:2048 lds
    buffer_load_dwordx4 v41, s[12:15], s61 offen offset:3072 lds
    s_add_u32 s61, s61, 0x80000
    s_branch k12_oolret_21
k12_ool_22:
    s_mov_b64 exec, 1
    buffer_atomic_add v9, v8, s[24:27], 0 offen sc1
    s_mov_b64 exec, -1
    s_branch k12_oolret_23
k12_ool_24:
    buffer_load_dword v51, v50, s[12:15], s56 offen
    s_branch k12_oolret_25
k12_ool_26:
    global_load_dword v51, v[2:3], off
    s_branch k12_oolret_27
k12_ool_30:
    buffer_load_dword v52, v8, s[24:27], 0 offen sc1
    s_branch k12_oolret_31
k12_ool_34:
    v_readfirstlane_b32 s31, v52
    s_cmp_ge_u32 s31, 256
    s_cbranch_scc1 spin_ok_32
    s_mov_b32 s40, 1048576
spin_33:
    s_sleep 8
    buffer_load_dword v52, v8, s[24:27], 0 offen sc1
    s_waitcnt vmcnt(0)
    v_readfirstlane_b32 s31, v52
    s_sub_u32 s40, s40, 1
    s_cselect_b32 s31, -1, s31
    s_cmp_lt_u32 s31, 256
    s_cbranch_scc1 spin_33
spin_ok_32:
    s_branch k12_oolret_35
k12_ool_36:
    s_mov_b64 exec, 1
    buffer_atomic_add v9, v8, s[24:27], 0 offen sc1
    s_mov_b64 exec, -1
    s_branch k12_oolret_37
k12_ool_38:
    buffer_load_dword v51, v50, s[12:15], s56 offen
    s_branch k12_oolret_39
k12_ool_40:
    s_add_u32 m0, s60, 131072
    s_nop 0
    buffer_load_dwordx4 v38, s[12:15], s61 offen offset:0 lds
    buffer_load_dwordx4 v39, s[12:15], s61 offen offset:1024 lds
    buffer_load_dwordx4 v40, s[12:15], s61 offen offset:2048 lds
    buffer_load_dwordx4 v41, s[12:15], s61 offen offset:3072 lds
    s_add_u32 s61, s61, 0x80000
    s_add_u32 m0, s60, 147456
    s_nop 0
    buffer_load_dwordx4 v38, s[12:15], s61 offen offset:0 lds
    buffer_load_dwordx4 v39, s[12:15], s61 offen offset:1024 lds
    buffer_load_dwordx4 v40, s[12:15], s61 offen offset:2048 lds
    buffer_load_dwordx4 v41, s[12:15], s61 offen offset:3072 lds
    s_add_u32 s61, s61, 0x80000
    s_branch k12_oolret_41
k12_ool_42:
    s_mov_b64 exec, 1
    buffer_atomic_add v9, v8, s[24:27], 0 offen sc1
    s_mov_b64 exec, -1
    s_branch k12_oolret_43
k12_ool_44:
    buffer_load_dword v51, v50, s[12:15], s56 offen
    s_branch k12_oolret_45
k12_ool_46:
    global_load_dword v51, v[2:3], off
    s_branch k12_oolret_47
k12_ool_48:
    s_add_u32 s52, s47, 528384
    buffer_store_dwordx4 v[152:155], v1, s[48:51], s52 offen offset:2048 sc1
    s_branch k12_oolret_49
k12_ool_50:
    s_add_u32 s52, s47, 528384
    buffer_store_dwordx4 v[156:159], v1, s[48:51], s52 offen offset:3072 sc1
    s_branch k12_oolret_51
k12_ool_52:
    s_add_u32 s52, s47, 532480
    buffer_store_dwordx4 v[168:171], v1, s[48:51], s52 offen offset:2048 sc1
    s_branch k12_oolret_53
k12_ool_54:
    s_add_u32 s52, s47, 532480
    buffer_store_dwordx4 v[172:175], v1, s[48:51], s52 offen offset:3072 sc1
    s_branch k12_oolret_55
k12_ool_56:
    s_add_u32 s52, s47, 536576
    buffer_store_dwordx4 v[176:179], v1, s[48:51], s52 offen offset:0 sc1
    s_branch k12_oolret_57
k12_ool_58:
    s_add_u32 s52, s47, 536576
    buffer_store_dwordx4 v[180:183], v1, s[48:51], s52 offen offset:1024 sc1
    s_branch k12_oolret_59
k12_ool_60:
    s_add_u32 s52, s47, 536576
    buffer_store_dwordx4 v[184:187], v1, s[48:51], s52 offen offset:2048 sc1
    s_branch k12_oolret_61
k12_ool_62:
    s_add_u32 s52, s47, 536576
    buffer_store_dwordx4 v[188:191], v1, s[48:51], s52 offen offset:3072 sc1
    s_branch k12_oolret_63
k12_ool_64:
    s_mov_b32 s50, 0
    s_branch k12_oolret_65
k12_ool_66:
    s_mov_b64 exec, 1
    buffer_atomic_add v9, v8, s[24:27], s54 offen sc1
    s_mov_b64 exec, -1
    s_branch k12_oolret_67
k12_ool_68:
    buffer_load_dword v52, v8, s[24:27], s55 offen sc1
    s_branch k12_oolret_69
k12_ool_72:
    s_waitcnt vmcnt(10)
    v_readfirstlane_b32 s31, v52
    s_cmp_ge_u32 s31, 2
    s_cbranch_scc1 spin_ok_70
    s_mov_b32 s40, 1048576
spin_71:
    s_sleep 8
    buffer_load_dword v52, v8, s[24:27], s55 offen sc1
    s_waitcnt vmcnt(0)
    v_readfirstlane_b32 s31, v52
    s_sub_u32 s40, s40, 1
    s_cselect_b32 s31, -1, s31
    s_cmp_lt_u32 s31, 2
    s_cbranch_scc1 spin_71
spin_ok_70:
    s_branch k12_oolret_73
k12_ool_74:
    s_mov_b64 exec, 1
    buffer_atomic_add v9, v8, s[24:27], s3 offen sc1
    s_mov_b64 exec, -1
    s_branch k12_oolret_75
k12_ool_78:
    buffer_load_dword v58, v59, s[24:27], s5 offen sc1
    s_branch k12_oolret_79
k12_ool_82:
    s_waitcnt vmcnt(0)
    v_readfirstlane_b32 s31, v58
    s_cmp_ge_u32 s31, 14
    s_cbranch_scc1 spin_ok_80
    s_mov_b32 s40, 1048576
spin_81:
    s_sleep 8
    buffer_load_dword v58, v59, s[24:27], s5 offen sc1
    s_waitcnt vmcnt(0)
    v_readfirstlane_b32 s31, v58
    s_sub_u32 s40, s40, 1
    s_cselect_b32 s31, -1, s31
    s_cmp_lt_u32 s31, 14
    s_cbranch_scc1 spin_81
spin_ok_80:
    s_branch k12_oolret_83
k12_ool_122:
    s_mov_b64 exec, 1
    buffer_atomic_add v76, v75, s[16:19], s57 offen sc1
    s_mov_b64 exec, -1
    s_branch k12_oolret_123
k12_ool_127:
    s_mov_b64 exec, 1
    buffer_atomic_add v76, v75, s[16:19], s58 offen sc1
    s_mov_b64 exec, -1
    s_branch k12_oolret_128
k12_ool_131:
    s_mov_b32 s34, 1048576
op_spin_129:
    buffer_load_dword v74, v73, s[16:19], s59 offen sc1
    s_waitcnt vmcnt(0)
    v_cmp_le_u32 vcc, 4, v74
    s_sub_u32 s34, s34, 1
    s_cbranch_scc1 op_ok_130
    s_mov_b32 s33, vcc_lo
    s_bitcmp1_b32 s33, 0
    s_cbranch_scc1 op_ok_130
    s_sleep 4
    s_branch op_spin_129
op_ok_130:
    buffer_load_dwordx4 a[128:131], v88, s[8:11], s62 offen offset:0 sc1
    buffer_load_dwordx4 a[132:135], v88, s[8:11], s62 offen offset:1024 sc1
    buffer_load_dwordx4 a[136:139], v89, s[8:11], s62 offen offset:0 sc1
    buffer_load_dwordx4 a[140:143], v89, s[8:11], s62 offen offset:1024 sc1
    s_add_u32 s62, s62, 0x40000
    s_and_b32 s62, s62, 0x7fffff
    buffer_load_dwordx4 a[144:147], v88, s[8:11], s62 offen offset:0 sc1
    buffer_load_dwordx4 a[148:151], v88, s[8:11], s62 offen offset:1024 sc1
    buffer_load_dwordx4 a[152:155], v89, s[8:11], s62 offen offset:0 sc1
    buffer_load_dwordx4 a[156:159], v89, s[8:11], s62 offen offset:1024 sc1
    s_add_u32 s62, s62, 0x40000
    s_and_b32 s62, s62, 0x7fffff
    buffer_load_dwordx4 a[160:163], v88, s[8:11], s62 offen offset:0 sc1
    buffer_load_dwordx4 a[164:167], v88, s[8:11], s62 offen offset:1024 sc1
    buffer_load_dwordx4 a[168:171], v89, s[8:11], s62 offen offset:0 sc1
    buffer_load_dwordx4 a[172:175], v89, s[8:11], s62 offen offset:1024 sc1
    s_add_u32 s62, s62, 0x40000
    s_and_b32 s62, s62, 0x7fffff
    s_branch k12_oolret_132
k12_ool_137:
    buffer_load_dwordx2 v[192:193], v78, s[20:23], 0 offen offset:0
    buffer_load_dwordx2 v[194:195], v78, s[20:23], 0 offen offset:32
    buffer_load_dwordx2 v[196:197], v78, s[20:23], 0 offen offset:64
    buffer_load_dwordx2 v[198:199], v78, s[20:23], 0 offen offset:96
    buffer_load_dwordx2 v[200:201], v79, s[20:23], 0 offen offset:0
    buffer_load_dwordx2 v[202:203], v79, s[20:23], 0 offen offset:32
    buffer_load_dwordx2 v[204:205], v79, s[20:23], 0 offen offset:64
    buffer_load_dwordx2 v[206:207], v79, s[20:23], 0 offen offset:96
    buffer_load_dwordx2 v[208:209], v80, s[44:47], 0 offen offset:0
    buffer_load_dwordx2 v[210:211], v80, s[44:47], 0 offen offset:32
    buffer_load_dwordx2 v[212:213], v80, s[44:47], 0 offen offset:64
    buffer_load_dwordx2 v[214:215], v80, s[44:47], 0 offen offset:96
    global_load_dword v84, v[82:83], off
    s_mov_b32 s10, 0
    s_mov_b32 s14, 0
    s_mov_b32 s34, 1048576
ff_spin_135:
    v_cmp_gt_u32 vcc, 4, v95
    s_cbranch_vccz ff_ok_136
    s_sub_u32 s34, s34, 1
    s_cbranch_scc1 ff_ok_136
    s_sleep 4
    buffer_load_dword v95, v94, s[16:19], 0 offen sc1
    s_waitcnt vmcnt(0)
    s_branch ff_spin_135
ff_ok_136:
    s_add_u32 s44, s6, 0x6000000
    s_addc_u32 s45, s7, 0
    s_and_b32 s45, s45, 0xffff
    s_cmp_ge_u32 s2, 224
    s_cselect_b32 s46, 0, 0x1000000
    s_branch k12_oolret_138
k12_ool_141:
    s_mov_b32 s34, 1048576
op_spin_139:
    buffer_load_dword v74, v73, s[16:19], s59 offen sc1
    s_waitcnt vmcnt(0)
    v_cmp_le_u32 vcc, 4, v74
    s_sub_u32 s34, s34, 1
    s_cbranch_scc1 op_ok_140
    s_mov_b32 s33, vcc_lo
    s_bitcmp1_b32 s33, s32
    s_cbranch_scc1 op_ok_140
    s_sleep 4
    s_branch op_spin_139
op_ok_140:
    s_branch k12_oolret_142
k12_ool_143:
    buffer_load_dword v95, v94, s[16:19], 0 offen sc1
    s_branch k12_oolret_144
k2_tramp_86:
    s_call_b64 s[40:41], k2_rare_158
    s_branch k2_ret_87
k2_tramp_90:
    s_call_b64 s[40:41], k2_rare_159
    s_branch k2_ret_91
k2_tramp_92:
    s_call_b64 s[40:41], k2_rare_158
    s_branch k2_ret_93
k2_tramp_94:
    s_call_b64 s[40:41], k2_rare_159
    s_branch k2_ret_95
k2_tramp_96:
    s_call_b64 s[40:41], k2_rare_158
    s_branch k2_ret_97
k2_tramp_98:
    s_call_b64 s[40:41], k2_rare_159
    s_branch k2_ret_99
k2_tramp_100:
    s_call_b64 s[40:41], k2_rare_164
    s_branch k2_ret_101
k2_tramp_104:
    s_call_b64 s[40:41], k2_rare_165
    s_branch k2_ret_105
k2_tramp_108:
    s_call_b64 s[40:41], k2_rare_166
    s_branch k2_ret_109
k2_tramp_112:
    s_call_b64 s[40:41], k2_rare_167
    s_branch k2_ret_113
k2_tramp_114:
    s_call_b64 s[40:41], k2_rare_166
    s_branch k2_ret_115
k2_tramp_116:
    s_call_b64 s[40:41], k2_rare_167
    s_branch k2_ret_117
k2_tramp_118:
    s_call_b64 s[40:41], k2_rare_166
    s_branch k2_ret_119
k2_tramp_120:
    s_call_b64 s[40:41], k2_rare_171
    s_branch k2_ret_121
k2_rare_158:
    s_nop 7
    v_max_f32 v52, v128, v129
    v_max3_f32 v52, v52, v130, v131
    v_max3_f32 v52, v52, v144, v145
    v_max3_f32 v52, v52, v146, v147
    v_max_f32 v53, v132, v133
    v_max3_f32 v53, v53, v134, v135
    v_max3_f32 v53, v53, v148, v149
    v_max3_f32 v53, v53, v150, v151
    v_max_f32 v54, v136, v137
    v_max3_f32 v54, v54, v138, v139
    v_max3_f32 v54, v54, v152, v153
    v_max3_f32 v54, v54, v154, v155
    v_max_f32 v55, v140, v141
    v_max3_f32 v55, v55, v142, v143
    v_max3_f32 v55, v55, v156, v157
    v_max3_f32 v55, v55, v158, v159
    v_mov_b32 v224, v52
    v_mov_b32 v225, v53
    v_mov_b32 v226, v54
    v_mov_b32 v227, v55
    s_nop 1
    v_permlane16_swap_b32 v52, v224
    v_permlane16_swap_b32 v53, v225
    v_permlane16_swap_b32 v54, v226
    v_permlane16_swap_b32 v55, v227
    s_nop 1
    v_max_f32 v52, v52, v224
    v_max_f32 v53, v53, v225
    v_max_f32 v54, v54, v226
    v_max_f32 v55, v55, v227
    v_mov_b32 v224, v52
    v_mov_b32 v225, v53
    v_mov_b32 v226, v54
    v_mov_b32 v227, v55
    s_nop 1
    v_permlane32_swap_b32 v52, v224
    v_permlane32_swap_b32 v53, v225
    v_permlane32_swap_b32 v54, v226
    v_permlane32_swap_b32 v55, v227
    s_nop 1
    v_max_f32 v52, v52, v224
    v_max_f32 v53, v53, v225
    v_max_f32 v54, v54, v226
    v_max_f32 v55, v55, v227
    v_add_f32 v52, 0x41400000, v52
    v_max_f32 v52, 0, v52
    v_add_f32 v53, 0x41400000, v53
    v_max_f32 v53, 0, v53
    v_add_f32 v54, 0x41400000, v54
    v_max_f32 v54, 0, v54
    v_add_f32 v55, 0x41400000, v55
    v_max_f32 v55, 0, v55
    v_sub_f32 v128, v128, v52
    v_sub_f32 v129, v129, v52
    v_sub_f32 v130, v130, v52
    v_sub_f32 v131, v131, v52
    v_sub_f32 v132, v132, v53
    v_sub_f32 v133, v133, v53
    v_sub_f32 v134, v134, v53
    v_sub_f32 v135, v135, v53
    v_sub_f32 v136, v136, v54
    v_sub_f32 v137, v137, v54
    v_sub_f32 v138, v138, v54
    v_sub_f32 v139, v139, v54
    v_sub_f32 v140, v140, v55
    v_sub_f32 v141, v141, v55
    v_sub_f32 v142, v142, v55
    v_sub_f32 v143, v143, v55
    v_sub_f32 v144, v144, v52
    v_sub_f32 v145, v145, v52
    v_sub_f32 v146, v146, v52
    v_sub_f32 v147, v147, v52
    v_sub_f32 v148, v148, v53
    v_sub_f32 v149, v149, v53
    v_sub_f32 v150, v150, v53
    v_sub_f32 v151, v151, v53
    v_sub_f32 v152, v152, v54
    v_sub_f32 v153, v153, v54
    v_sub_f32 v154, v154, v54
    v_sub_f32 v155, v155, v54
    v_sub_f32 v156, v156, v55
    v_sub_f32 v157, v157, v55
    v_sub_f32 v158, v158, v55
    v_sub_f32 v159, v159, v55
    v_sub_f32 v160, v160, v52
    v_sub_f32 v16, v16, v52
    v_sub_f32 v161, v161, v52
    v_sub_f32 v17, v17, v52
    v_sub_f32 v162, v162, v52
    v_sub_f32 v18, v18, v52
    v_sub_f32 v163, v163, v52
    v_sub_f32 v19, v19, v52
    v_sub_f32 v164, v164, v53
    v_sub_f32 v20, v20, v53
    v_sub_f32 v165, v165, v53
    v_sub_f32 v21, v21, v53
    v_sub_f32 v166, v166, v53
    v_sub_f32 v22, v22, v53
    v_sub_f32 v167, v167, v53
    v_sub_f32 v23, v23, v53
    v_sub_f32 v168, v168, v54
    v_sub_f32 v24, v24, v54
    v_sub_f32 v169, v169, v54
    v_sub_f32 v25, v25, v54
    v_sub_f32 v170, v170, v54
    v_sub_f32 v26, v26, v54
    v_sub_f32 v171, v171, v54
    v_sub_f32 v27, v27, v54
    v_sub_f32 v172, v172, v55
    v_sub_f32 v28, v28, v55
    v_sub_f32 v173, v173, v55
    v_sub_f32 v29, v29, v55
    v_sub_f32 v174, v174, v55
    v_sub_f32 v30, v30, v55
    v_sub_f32 v175, v175, v55
    v_sub_f32 v31, v31, v55
    v_sub_f32 v176, v176, v52
    v_sub_f32 v32, v32, v52
    v_sub_f32 v177, v177, v52
    v_sub_f32 v33, v33, v52
    v_sub_f32 v178, v178, v52
    v_sub_f32 v34, v34, v52
    v_sub_f32 v179, v179, v52
    v_sub_f32 v35, v35, v52
    v_sub_f32 v180, v180, v53
    v_sub_f32 v36, v36, v53
    v_sub_f32 v181, v181, v53
    v_sub_f32 v37, v37, v53
    v_sub_f32 v182, v182, v53
    v_sub_f32 v38, v38, v53
    v_sub_f32 v183, v183, v53
    v_sub_f32 v39, v39, v53
    v_sub_f32 v184, v184, v54
    v_sub_f32 v40, v40, v54
    v_sub_f32 v185, v185, v54
    v_sub_f32 v41, v41, v54
    v_sub_f32 v186, v186, v54
    v_sub_f32 v42, v42, v54
    v_sub_f32 v187, v187, v54
    v_sub_f32 v43, v43, v54
    v_sub_f32 v188, v188, v55
    v_sub_f32 v44, v44, v55
    v_sub_f32 v189, v189, v55
    v_sub_f32 v45, v45, v55
    v_sub_f32 v190, v190, v55
    v_sub_f32 v46, v46, v55
    v_sub_f32 v191, v191, v55
    v_sub_f32 v47, v47, v55
    v_sub_f32 v8, v8, v52
    v_exp_f32 v52, -v52
    v_sub_f32 v9, v9, v53
    v_exp_f32 v53, -v53
    v_sub_f32 v10, v10, v54
    v_exp_f32 v54, -v54
    v_sub_f32 v11, v11, v55
    v_exp_f32 v55, -v55
    s_nop 0
    v_mul_f32 v12, v12, v52
    v_mul_f32 v48, v48, v53
    v_mul_f32 v248, v248, v54
    v_mul_f32 v252, v252, v55
    v_accvgpr_read_b32 v224, a0
    v_accvgpr_read_b32 v225, a1
    v_accvgpr_read_b32 v226, a2
    v_accvgpr_read_b32 v227, a3
    v_mul_f32 v224, v224, v52
    v_mul_f32 v225, v225, v52
    v_mul_f32 v226, v226, v52
    v_mul_f32 v227, v227, v52
    v_accvgpr_write_b32 a0, v224
    v_accvgpr_write_b32 a1, v225
    v_accvgpr_write_b32 a2, v226
    v_accvgpr_write_b32 a3, v227
    v_accvgpr_read_b32 v224, a4
    v_accvgpr_read_b32 v225, a5
    v_accvgpr_read_b32 v226, a6
    v_accvgpr_read_b32 v227, a7
    v_mul_f32 v224, v224, v53
    v_mul_f32 v225, v225, v53
    v_mul_f32 v226, v226, v53
    v_mul_f32 v227, v227, v53
    v_accvgpr_write_b32 a4, v224
    v_accvgpr_write_b32 a5, v225
    v_accvgpr_write_b32 a6, v226
    v_accvgpr_write_b32 a7, v227
    v_accvgpr_read_b32 v224, a8
    v_accvgpr_read_b32 v225, a9
    v_accvgpr_read_b32 v226, a10
    v_accvgpr_read_b32 v227, a11
    v_mul_f32 v224, v224, v54
    v_mul_f32 v225, v225, v54
    v_mul_f32 v226, v226, v54
    v_mul_f32 v227, v227, v54
    v_accvgpr_write_b32 a8, v224
    v_accvgpr_write_b32 a9, v225
    v_accvgpr_write_b32 a10, v226
    v_accvgpr_write_b32 a11, v227
    v_accvgpr_read_b32 v224, a12
    v_accvgpr_read_b32 v225, a13
    v_accvgpr_read_b32 v226, a14
    v_accvgpr_read_b32 v227, a15
    v_mul_f32 v224, v224, v55
    v_mul_f32 v225, v225, v55
    v_mul_f32 v226, v226, v55
    v_mul_f32 v227, v227, v55
    v_accvgpr_write_b32 a12, v224
    v_accvgpr_write_b32 a13, v225
    v_accvgpr_write_b32 a14, v226
    v_accvgpr_write_b32 a15, v227
    v_accvgpr_read_b32 v224, a16
    v_accvgpr_read_b32 v225, a17
    v_accvgpr_read_b32 v226, a18
    v_accvgpr_read_b32 v227, a19
    v_mul_f32 v224, v224, v52
    v_mul_f32 v225, v225, v52
    v_mul_f32 v226, v226, v52
    v_mul_f32 v227, v227, v52
    v_accvgpr_write_b32 a16, v224
    v_accvgpr_write_b32 a17, v225
    v_accvgpr_write_b32 a18, v226
    v_accvgpr_write_b32 a19, v227
    v_accvgpr_read_b32 v224, a20
    v_accvgpr_read_b32 v225, a21
    v_accvgpr_read_b32 v226, a22
    v_accvgpr_read_b32 v227, a23
    v_mul_f32 v224, v224, v53
    v_mul_f32 v225, v225, v53
    v_mul_f32 v226, v226, v53
    v_mul_f32 v227, v227, v53
    v_accvgpr_write_b32 a20, v224
    v_accvgpr_write_b32 a21, v225
    v_accvgpr_write_b32 a22, v226
    v_accvgpr_write_b32 a23, v227
    v_accvgpr_read_b32 v224, a24
    v_accvgpr_read_b32 v225, a25
    v_accvgpr_read_b32 v226, a26
    v_accvgpr_read_b32 v227, a27
    v_mul_f32 v224, v224, v54
    v_mul_f32 v225, v225, v54
    v_mul_f32 v226, v226, v54
    v_mul_f32 v227, v227, v54
    v_accvgpr_write_b32 a24, v224
    v_accvgpr_write_b32 a25, v225
    v_accvgpr_write_b32 a26, v226
    v_accvgpr_write_b32 a27, v227
    v_accvgpr_read_b32 v224, a28
    v_accvgpr_read_b32 v225, a29
    v_accvgpr_read_b32 v226, a30
    v_accvgpr_read_b32 v227, a31
    v_mul_f32 v224, v224, v55
    v_mul_f32 v225, v225, v55
    v_mul_f32 v226, v226, v55
    v_mul_f32 v227, v227, v55
    v_accvgpr_write_b32 a28, v224
    v_accvgpr_write_b32 a29, v225
    v_accvgpr_write_b32 a30, v226
    v_accvgpr_write_b32 a31, v227
    v_accvgpr_read_b32 v224, a32
    v_accvgpr_read_b32 v225, a33
    v_accvgpr_read_b32 v226, a34
    v_accvgpr_read_b32 v227, a35
    v_mul_f32 v224, v224, v52
    v_mul_f32 v225, v225, v52
    v_mul_f32 v226, v226, v52
    v_mul_f32 v227, v227, v52
    v_accvgpr_write_b32 a32, v224
    v_accvgpr_write_b32 a33, v225
    v_accvgpr_write_b32 a34, v226
    v_accvgpr_write_b32 a35, v227
    v_accvgpr_read_b32 v224, a36
    v_accvgpr_read_b32 v225, a37
    v_accvgpr_read_b32 v226, a38
    v_accvgpr_read_b32 v227, a39
    v_mul_f32 v224, v224, v53
    v_mul_f32 v225, v225, v53
    v_mul_f32 v226, v226, v53
    v_mul_f32 v227, v227, v53
    v_accvgpr_write_b32 a36, v224
    v_accvgpr_write_b32 a37, v225
    v_accvgpr_write_b32 a38, v226
    v_accvgpr_write_b32 a39, v227
    v_accvgpr_read_b32 v224, a40
    v_accvgpr_read_b32 v225, a41
    v_accvgpr_read_b32 v226, a42
    v_accvgpr_read_b32 v227, a43
    v_mul_f32 v224, v224, v54
    v_mul_f32 v225, v225, v54
    v_mul_f32 v226, v226, v54
    v_mul_f32 v227, v227, v54
    v_accvgpr_write_b32 a40, v224
    v_accvgpr_write_b32 a41, v225
    v_accvgpr_write_b32 a42, v226
    v_accvgpr_write_b32 a43, v227
    v_accvgpr_read_b32 v224, a44
    v_accvgpr_read_b32 v225, a45
    v_accvgpr_read_b32 v226, a46
    v_accvgpr_read_b32 v227, a47
    v_mul_f32 v224, v224, v55
    v_mul_f32 v225, v225, v55
    v_mul_f32 v226, v226, v55
    v_mul_f32 v227, v227, v55
    v_accvgpr_write_b32 a44, v224
    v_accvgpr_write_b32 a45, v225
    v_accvgpr_write_b32 a46, v226
    v_accvgpr_write_b32 a47, v227
    v_accvgpr_read_b32 v224, a48
    v_accvgpr_read_b32 v225, a49
    v_accvgpr_read_b32 v226, a50
    v_accvgpr_read_b32 v227, a51
    v_mul_f32 v224, v224, v52
    v_mul_f32 v225, v225, v52
    v_mul_f32 v226, v226, v52
    v_mul_f32 v227, v227, v52
    v_accvgpr_write_b32 a48, v224
    v_accvgpr_write_b32 a49, v225
    v_accvgpr_write_b32 a50, v226
    v_accvgpr_write_b32 a51, v227
    v_accvgpr_read_b32 v224, a52
    v_accvgpr_read_b32 v225, a53
    v_accvgpr_read_b32 v226, a54
    v_accvgpr_read_b32 v227, a55
    v_mul_f32 v224, v224, v53
    v_mul_f32 v225, v225, v53
    v_mul_f32 v226, v226, v53
    v_mul_f32 v227, v227, v53
    v_accvgpr_write_b32 a52, v224
    v_accvgpr_write_b32 a53, v225
    v_accvgpr_write_b32 a54, v226
    v_accvgpr_write_b32 a55, v227
    v_accvgpr_read_b32 v224, a56
    v_accvgpr_read_b32 v225, a57
    v_accvgpr_read_b32 v226, a58
    v_accvgpr_read_b32 v227, a59
    v_mul_f32 v224, v224, v54
    v_mul_f32 v225, v225, v54
    v_mul_f32 v226, v226, v54
    v_mul_f32 v227, v227, v54
    v_accvgpr_write_b32 a56, v224
    v_accvgpr_write_b32 a57, v225
    v_accvgpr_write_b32 a58, v226
    v_accvgpr_write_b32 a59, v227
    v_accvgpr_read_b32 v224, a60
    v_accvgpr_read_b32 v225, a61
    v_accvgpr_read_b32 v226, a62
    v_accvgpr_read_b32 v227, a63
    v_mul_f32 v224, v224, v55
    v_mul_f32 v225, v225, v55
    v_mul_f32 v226, v226, v55
    v_mul_f32 v227, v227, v55
    v_accvgpr_write_b32 a60, v224
    v_accvgpr_write_b32 a61, v225
    v_accvgpr_write_b32 a62, v226
    v_accvgpr_write_b32 a63, v227
    v_accvgpr_read_b32 v224, a64
    v_accvgpr_read_b32 v225, a65
    v_accvgpr_read_b32 v226, a66
    v_accvgpr_read_b32 v227, a67
    v_mul_f32 v224, v224, v52
    v_mul_f32 v225, v225, v52
    v_mul_f32 v226, v226, v52
    v_mul_f32 v227, v227, v52
    v_accvgpr_write_b32 a64, v224
    v_accvgpr_write_b32 a65, v225
    v_accvgpr_write_b32 a66, v226
    v_accvgpr_write_b32 a67, v227
    v_accvgpr_read_b32 v224, a68
    v_accvgpr_read_b32 v225, a69
    v_accvgpr_read_b32 v226, a70
    v_accvgpr_read_b32 v227, a71
    v_mul_f32 v224, v224, v53
    v_mul_f32 v225, v225, v53
    v_mul_f32 v226, v226, v53
    v_mul_f32 v227, v227, v53
    v_accvgpr_write_b32 a68, v224
    v_accvgpr_write_b32 a69, v225
    v_accvgpr_write_b32 a70, v226
    v_accvgpr_write_b32 a71, v227
    v_accvgpr_read_b32 v224, a72
    v_accvgpr_read_b32 v225, a73
    v_accvgpr_read_b32 v226, a74
    v_accvgpr_read_b32 v227, a75
    v_mul_f32 v224, v224, v54
    v_mul_f32 v225, v225, v54
    v_mul_f32 v226, v226, v54
    v_mul_f32 v227, v227, v54
    v_accvgpr_write_b32 a72, v224
    v_accvgpr_write_b32 a73, v225
    v_accvgpr_write_b32 a74, v226
    v_accvgpr_write_b32 a75, v227
    v_accvgpr_read_b32 v224, a76
    v_accvgpr_read_b32 v225, a77
    v_accvgpr_read_b32 v226, a78
    v_accvgpr_read_b32 v227, a79
    v_mul_f32 v224, v224, v55
    v_mul_f32 v225, v225, v55
    v_mul_f32 v226, v226, v55
    v_mul_f32 v227, v227, v55
    v_accvgpr_write_b32 a76, v224
    v_accvgpr_write_b32 a77, v225
    v_accvgpr_write_b32 a78, v226
    v_accvgpr_write_b32 a79, v227
    v_accvgpr_read_b32 v224, a80
    v_accvgpr_read_b32 v225, a81
    v_accvgpr_read_b32 v226, a82
    v_accvgpr_read_b32 v227, a83
    v_mul_f32 v224, v224, v52
    v_mul_f32 v225, v225, v52
    v_mul_f32 v226, v226, v52
    v_mul_f32 v227, v227, v52
    v_accvgpr_write_b32 a80, v224
    v_accvgpr_write_b32 a81, v225
    v_accvgpr_write_b32 a82, v226
    v_accvgpr_write_b32 a83, v227
    v_accvgpr_read_b32 v224, a84
    v_accvgpr_read_b32 v225, a85
    v_accvgpr_read_b32 v226, a86
    v_accvgpr_read_b32 v227, a87
    v_mul_f32 v224, v224, v53
    v_mul_f32 v225, v225, v53
    v_mul_f32 v226, v226, v53
    v_mul_f32 v227, v227, v53
    v_accvgpr_write_b32 a84, v224
    v_accvgpr_write_b32 a85, v225
    v_accvgpr_write_b32 a86, v226
    v_accvgpr_write_b32 a87, v227
    v_accvgpr_read_b32 v224, a88
    v_accvgpr_read_b32 v225, a89
    v_accvgpr_read_b32 v226, a90
    v_accvgpr_read_b32 v227, a91
    v_mul_f32 v224, v224, v54
    v_mul_f32 v225, v225, v54
    v_mul_f32 v226, v226, v54
    v_mul_f32 v227, v227, v54
    v_accvgpr_write_b32 a88, v224
    v_accvgpr_write_b32 a89, v225
    v_accvgpr_write_b32 a90, v226
    v_accvgpr_write_b32 a91, v227
    v_accvgpr_read_b32 v224, a92
    v_accvgpr_read_b32 v225, a93
    v_accvgpr_read_b32 v226, a94
    v_accvgpr_read_b32 v227, a95
    v_mul_f32 v224, v224, v55
    v_mul_f32 v225, v225, v55
    v_mul_f32 v226, v226, v55
    v_mul_f32 v227, v227, v55
    v_accvgpr_write_b32 a92, v224
    v_accvgpr_write_b32 a93, v225
    v_accvgpr_write_b32 a94, v226
    v_accvgpr_write_b32 a95, v227
    v_accvgpr_read_b32 v224, a96
    v_accvgpr_read_b32 v225, a97
    v_accvgpr_read_b32 v226, a98
    v_accvgpr_read_b32 v227, a99
    v_mul_f32 v224, v224, v52
    v_mul_f32 v225, v225, v52
    v_mul_f32 v226, v226, v52
    v_mul_f32 v227, v227, v52
    v_accvgpr_write_b32 a96, v224
    v_accvgpr_write_b32 a97, v225
    v_accvgpr_write_b32 a98, v226
    v_accvgpr_write_b32 a99, v227
    v_accvgpr_read_b32 v224, a100
    v_accvgpr_read_b32 v225, a101
    v_accvgpr_read_b32 v226, a102
    v_accvgpr_read_b32 v227, a103
    v_mul_f32 v224, v224, v53
    v_mul_f32 v225, v225, v53
    v_mul_f32 v226, v226, v53
    v_mul_f32 v227, v227, v53
    v_accvgpr_write_b32 a100, v224
    v_accvgpr_write_b32 a101, v225
    v_accvgpr_write_b32 a102, v226
    v_accvgpr_write_b32 a103, v227
    v_accvgpr_read_b32 v224, a104
    v_accvgpr_read_b32 v225, a105
    v_accvgpr_read_b32 v226, a106
    v_accvgpr_read_b32 v227, a107
    v_mul_f32 v224, v224, v54
    v_mul_f32 v225, v225, v54
    v_mul_f32 v226, v226, v54
    v_mul_f32 v227, v227, v54
    v_accvgpr_write_b32 a104, v224
    v_accvgpr_write_b32 a105, v225
    v_accvgpr_write_b32 a106, v226
    v_accvgpr_write_b32 a107, v227
    v_accvgpr_read_b32 v224, a108
    v_accvgpr_read_b32 v225, a109
    v_accvgpr_read_b32 v226, a110
    v_accvgpr_read_b32 v227, a111
    v_mul_f32 v224, v224, v55
    v_mul_f32 v225, v225, v55
    v_mul_f32 v226, v226, v55
    v_mul_f32 v227, v227, v55
    v_accvgpr_write_b32 a108, v224
    v_accvgpr_write_b32 a109, v225
    v_accvgpr_write_b32 a110, v226
    v_accvgpr_write_b32 a111, v227
    v_accvgpr_read_b32 v224, a112
    v_accvgpr_read_b32 v225, a113
    v_accvgpr_read_b32 v226, a114
    v_accvgpr_read_b32 v227, a115
    v_mul_f32 v224, v224, v52
    v_mul_f32 v225, v225, v52
    v_mul_f32 v226, v226, v52
    v_mul_f32 v227, v227, v52
    v_accvgpr_write_b32 a112, v224
    v_accvgpr_write_b32 a113, v225
    v_accvgpr_write_b32 a114, v226
    v_accvgpr_write_b32 a115, v227
    v_accvgpr_read_b32 v224, a116
    v_accvgpr_read_b32 v225, a117
    v_accvgpr_read_b32 v226, a118
    v_accvgpr_read_b32 v227, a119
    v_mul_f32 v224, v224, v53
    v_mul_f32 v225, v225, v53
    v_mul_f32 v226, v226, v53
    v_mul_f32 v227, v227, v53
    v_accvgpr_write_b32 a116, v224
    v_accvgpr_write_b32 a117, v225
    v_accvgpr_write_b32 a118, v226
    v_accvgpr_write_b32 a119, v227
    v_accvgpr_read_b32 v224, a120
    v_accvgpr_read_b32 v225, a121
    v_accvgpr_read_b32 v226, a122
    v_accvgpr_read_b32 v227, a123
    v_mul_f32 v224, v224, v54
    v_mul_f32 v225, v225, v54
    v_mul_f32 v226, v226, v54
    v_mul_f32 v227, v227, v54
    v_accvgpr_write_b32 a120, v224
    v_accvgpr_write_b32 a121, v225
    v_accvgpr_write_b32 a122, v226
    v_accvgpr_write_b32 a123, v227
    v_accvgpr_read_b32 v224, a124
    v_accvgpr_read_b32 v225, a125
    v_accvgpr_read_b32 v226, a126
    v_accvgpr_read_b32 v227, a127
    v_mul_f32 v224, v224, v55
    v_mul_f32 v225, v225, v55
    v_mul_f32 v226, v226, v55
    v_mul_f32 v227, v227, v55
    v_accvgpr_write_b32 a124, v224
    v_accvgpr_write_b32 a125, v225
    v_accvgpr_write_b32 a126, v226
    v_accvgpr_write_b32 a127, v227
    v_exp_f32 v232, v128
    v_exp_f32 v233, v129
    v_exp_f32 v234, v130
    v_exp_f32 v235, v131
    s_nop 0
    v_cvt_pk_bf16_f32 v192, v232, v233
    v_cvt_pk_bf16_f32 v193, v234, v235
    v_exp_f32 v232, v144
    v_exp_f32 v233, v145
    v_exp_f32 v234, v146
    v_exp_f32 v235, v147
    s_nop 0
    v_cvt_pk_bf16_f32 v194, v232, v233
    v_cvt_pk_bf16_f32 v195, v234, v235
    v_exp_f32 v232, v132
    v_exp_f32 v233, v133
    v_exp_f32 v234, v134
    v_exp_f32 v235, v135
    s_nop 0
    v_cvt_pk_bf16_f32 v196, v232, v233
    v_cvt_pk_bf16_f32 v197, v234, v235
    v_exp_f32 v232, v148
    v_exp_f32 v233, v149
    v_exp_f32 v234, v150
    v_exp_f32 v235, v151
    s_nop 0
    v_cvt_pk_bf16_f32 v198, v232, v233
    v_cvt_pk_bf16_f32 v199, v234, v235
    v_exp_f32 v232, v136
    v_exp_f32 v233, v137
    v_exp_f32 v234, v138
    v_exp_f32 v235, v139
    s_nop 0
    v_cvt_pk_bf16_f32 v200, v232, v233
    v_cvt_pk_bf16_f32 v201, v234, v235
    v_exp_f32 v232, v152
    v_exp_f32 v233, v153
    v_exp_f32 v234, v154
    v_exp_f32 v235, v155
    s_nop 0
    v_cvt_pk_bf16_f32 v202, v232, v233
    v_cvt_pk_bf16_f32 v203, v234, v235
    v_exp_f32 v232, v140
    v_exp_f32 v233, v141
    v_exp_f32 v234, v142
    v_exp_f32 v235, v143
    s_nop 0
    v_cvt_pk_bf16_f32 v204, v232, v233
    v_cvt_pk_bf16_f32 v205, v234, v235
    v_exp_f32 v232, v156
    v_exp_f32 v233, v157
    v_exp_f32 v234, v158
    v_exp_f32 v235, v159
    s_nop 0
    v_cvt_pk_bf16_f32 v206, v232, v233
    v_cvt_pk_bf16_f32 v207, v234, v235
    s_nop 3
    s_setpc_b64 s[40:41]
k2_rare_159:
    s_nop 7
    v_max_f32 v52, v160, v161
    v_max3_f32 v52, v52, v162, v163
    v_max3_f32 v52, v52, v176, v177
    v_max3_f32 v52, v52, v178, v179
    v_max_f32 v53, v164, v165
    v_max3_f32 v53, v53, v166, v167
    v_max3_f32 v53, v53, v180, v181
    v_max3_f32 v53, v53, v182, v183
    v_max_f32 v54, v168, v169
    v_max3_f32 v54, v54, v170, v171
    v_max3_f32 v54, v54, v184, v185
    v_max3_f32 v54, v54, v186, v187
    v_max_f32 v55, v172, v173
    v_max3_f32 v55, v55, v174, v175
    v_max3_f32 v55, v55, v188, v189
    v_max3_f32 v55, v55, v190, v191
    v_mov_b32 v224, v52
    v_mov_b32 v225, v53
    v_mov_b32 v226, v54
    v_mov_b32 v227, v55
    s_nop 1
    v_permlane16_swap_b32 v52, v224
    v_permlane16_swap_b32 v53, v225
    v_permlane16_swap_b32 v54, v226
    v_permlane16_swap_b32 v55, v227
    s_nop 1
    v_max_f32 v52, v52, v224
    v_max_f32 v53, v53, v225
    v_max_f32 v54, v54, v226
    v_max_f32 v55, v55, v227
    v_mov_b32 v224, v52
    v_mov_b32 v225, v53
    v_mov_b32 v226, v54
    v_mov_b32 v227, v55
    s_nop 1
    v_permlane32_swap_b32 v52, v224
    v_permlane32_swap_b32 v53, v225
    v_permlane32_swap_b32 v54, v226
    v_permlane32_swap_b32 v55, v227
    s_nop 1
    v_max_f32 v52, v52, v224
    v_max_f32 v53, v53, v225
    v_max_f32 v54, v54, v226
    v_max_f32 v55, v55, v227
    v_add_f32 v52, 0x41400000, v52
    v_max_f32 v52, 0, v52
    v_add_f32 v53, 0x41400000, v53
    v_max_f32 v53, 0, v53
    v_add_f32 v54, 0x41400000, v54
    v_max_f32 v54, 0, v54
    v_add_f32 v55, 0x41400000, v55
    v_max_f32 v55, 0, v55
    v_sub_f32 v160, v160, v52
    v_sub_f32 v161, v161, v52
    v_sub_f32 v162, v162, v52
    v_sub_f32 v163, v163, v52
    v_sub_f32 v164, v164, v53
    v_sub_f32 v165, v165, v53
    v_sub_f32 v166, v166, v53
    v_sub_f32 v167, v167, v53
    v_sub_f32 v168, v168, v54
    v_sub_f32 v169, v169, v54
    v_sub_f32 v170, v170, v54
    v_sub_f32 v171, v171, v54
    v_sub_f32 v172, v172, v55
    v_sub_f32 v173, v173, v55
    v_sub_f32 v174, v174, v55
    v_sub_f32 v175, v175, v55
    v_sub_f32 v176, v176, v52
    v_sub_f32 v177, v177, v52
    v_sub_f32 v178, v178, v52
    v_sub_f32 v179, v179, v52
    v_sub_f32 v180, v180, v53
    v_sub_f32 v181, v181, v53
    v_sub_f32 v182, v182, v53
    v_sub_f32 v183, v183, v53
    v_sub_f32 v184, v184, v54
    v_sub_f32 v185, v185, v54
    v_sub_f32 v186, v186, v54
    v_sub_f32 v187, v187, v54
    v_sub_f32 v188, v188, v55
    v_sub_f32 v189, v189, v55
    v_sub_f32 v190, v190, v55
    v_sub_f32 v191, v191, v55
    v_sub_f32 v128, v128, v52
    v_sub_f32 v16, v16, v52
    v_sub_f32 v129, v129, v52
    v_sub_f32 v17, v17, v52
    v_sub_f32 v130, v130, v52
    v_sub_f32 v18, v18, v52
    v_sub_f32 v131, v131, v52
    v_sub_f32 v19, v19, v52
    v_sub_f32 v132, v132, v53
    v_sub_f32 v20, v20, v53
    v_sub_f32 v133, v133, v53
    v_sub_f32 v21, v21, v53
    v_sub_f32 v134, v134, v53
    v_sub_f32 v22, v22, v53
    v_sub_f32 v135, v135, v53
    v_sub_f32 v23, v23, v53
    v_sub_f32 v136, v136, v54
    v_sub_f32 v24, v24, v54
    v_sub_f32 v137, v137, v54
    v_sub_f32 v25, v25, v54
    v_sub_f32 v138, v138, v54
    v_sub_f32 v26, v26, v54
    v_sub_f32 v139, v139, v54
    v_sub_f32 v27, v27, v54
    v_sub_f32 v140, v140, v55
    v_sub_f32 v28, v28, v55
    v_sub_f32 v141, v141, v55
    v_sub_f32 v29, v29, v55
    v_sub_f32 v142, v142, v55
    v_sub_f32 v30, v30, v55
    v_sub_f32 v143, v143, v55
    v_sub_f32 v31, v31, v55
    v_sub_f32 v144, v144, v52
    v_sub_f32 v32, v32, v52
    v_sub_f32 v145, v145, v52
    v_sub_f32 v33, v33, v52
    v_sub_f32 v146, v146, v52
    v_sub_f32 v34, v34, v52
    v_sub_f32 v147, v147, v52
    v_sub_f32 v35, v35, v52
    v_sub_f32 v148, v148, v53
    v_sub_f32 v36, v36, v53
    v_sub_f32 v149, v149, v53
    v_sub_f32 v37, v37, v53
    v_sub_f32 v150, v150, v53
    v_sub_f32 v38, v38, v53
    v_sub_f32 v151, v151, v53
    v_sub_f32 v39, v39, v53
    v_sub_f32 v152, v152, v54
    v_sub_f32 v40, v40, v54
    v_sub_f32 v153, v153, v54
    v_sub_f32 v41, v41, v54
    v_sub_f32 v154, v154, v54
    v_sub_f32 v42, v42, v54
    v_sub_f32 v155, v155, v54
    v_sub_f32 v43, v43, v54
    v_sub_f32 v156, v156, v55
    v_sub_f32 v44, v44, v55
    v_sub_f32 v157, v157, v55
    v_sub_f32 v45, v45, v55
    v_sub_f32 v158, v158, v55
    v_sub_f32 v46, v46, v55
    v_sub_f32 v159, v159, v55
    v_sub_f32 v47, v47, v55
    v_sub_f32 v8, v8, v52
    v_exp_f32 v52, -v52
    v_sub_f32 v9, v9, v53
    v_exp_f32 v53, -v53
    v_sub_f32 v10, v10, v54
    v_exp_f32 v54, -v54
    v_sub_f32 v11, v11, v55
    v_exp_f32 v55, -v55
    s_nop 0
    v_mul_f32 v12, v12, v52
    v_mul_f32 v48, v48, v53
    v_mul_f32 v248, v248, v54
    v_mul_f32 v252, v252, v55
    v_accvgpr_read_b32 v224, a0
    v_accvgpr_read_b32 v225, a1
    v_accvgpr_read_b32 v226, a2
    v_accvgpr_read_b32 v227, a3
    v_mul_f32 v224, v224, v52
    v_mul_f32 v225, v225, v52
    v_mul_f32 v226, v226, v52
    v_mul_f32 v227, v227, v52
    v_accvgpr_write_b32 a0, v224
    v_accvgpr_write_b32 a1, v225
    v_accvgpr_write_b32 a2, v226
    v_accvgpr_write_b32 a3, v227
    v_accvgpr_read_b32 v224, a4
    v_accvgpr_read_b32 v225, a5
    v_accvgpr_read_b32 v226, a6
    v_accvgpr_read_b32 v227, a7
    v_mul_f32 v224, v224, v53
    v_mul_f32 v225, v225, v53
    v_mul_f32 v226, v226, v53
    v_mul_f32 v227, v227, v53
    v_accvgpr_write_b32 a4, v224
    v_accvgpr_write_b32 a5, v225
    v_accvgpr_write_b32 a6, v226
    v_accvgpr_write_b32 a7, v227
    v_accvgpr_read_b32 v224, a8
    v_accvgpr_read_b32 v225, a9
    v_accvgpr_read_b32 v226, a10
    v_accvgpr_read_b32 v227, a11
    v_mul_f32 v224, v224, v54
    v_mul_f32 v225, v225, v54
    v_mul_f32 v226, v226, v54
    v_mul_f32 v227, v227, v54
    v_accvgpr_write_b32 a8, v224
    v_accvgpr_write_b32 a9, v225
    v_accvgpr_write_b32 a10, v226
    v_accvgpr_write_b32 a11, v227
    v_accvgpr_read_b32 v224, a12
    v_accvgpr_read_b32 v225, a13
    v_accvgpr_read_b32 v226, a14
    v_accvgpr_read_b32 v227, a15
    v_mul_f32 v224, v224, v55
    v_mul_f32 v225, v225, v55
    v_mul_f32 v226, v226, v55
    v_mul_f32 v227, v227, v55
    v_accvgpr_write_b32 a12, v224
    v_accvgpr_write_b32 a13, v225
    v_accvgpr_write_b32 a14, v226
    v_accvgpr_write_b32 a15, v227
    v_accvgpr_read_b32 v224, a16
    v_accvgpr_read_b32 v225, a17
    v_accvgpr_read_b32 v226, a18
    v_accvgpr_read_b32 v227, a19
    v_mul_f32 v224, v224, v52
    v_mul_f32 v225, v225, v52
    v_mul_f32 v226, v226, v52
    v_mul_f32 v227, v227, v52
    v_accvgpr_write_b32 a16, v224
    v_accvgpr_write_b32 a17, v225
    v_accvgpr_write_b32 a18, v226
    v_accvgpr_write_b32 a19, v227
    v_accvgpr_read_b32 v224, a20
    v_accvgpr_read_b32 v225, a21
    v_accvgpr_read_b32 v226, a22
    v_accvgpr_read_b32 v227, a23
    v_mul_f32 v224, v224, v53
    v_mul_f32 v225, v225, v53
    v_mul_f32 v226, v226, v53
    v_mul_f32 v227, v227, v53
    v_accvgpr_write_b32 a20, v224
    v_accvgpr_write_b32 a21, v225
    v_accvgpr_write_b32 a22, v226
    v_accvgpr_write_b32 a23, v227
    v_accvgpr_read_b32 v224, a24
    v_accvgpr_read_b32 v225, a25
    v_accvgpr_read_b32 v226, a26
    v_accvgpr_read_b32 v227, a27
    v_mul_f32 v224, v224, v54
    v_mul_f32 v225, v225, v54
    v_mul_f32 v226, v226, v54
    v_mul_f32 v227, v227, v54
    v_accvgpr_write_b32 a24, v224
    v_accvgpr_write_b32 a25, v225
    v_accvgpr_write_b32 a26, v226
    v_accvgpr_write_b32 a27, v227
    v_accvgpr_read_b32 v224, a28
    v_accvgpr_read_b32 v225, a29
    v_accvgpr_read_b32 v226, a30
    v_accvgpr_read_b32 v227, a31
    v_mul_f32 v224, v224, v55
    v_mul_f32 v225, v225, v55
    v_mul_f32 v226, v226, v55
    v_mul_f32 v227, v227, v55
    v_accvgpr_write_b32 a28, v224
    v_accvgpr_write_b32 a29, v225
    v_accvgpr_write_b32 a30, v226
    v_accvgpr_write_b32 a31, v227
    v_accvgpr_read_b32 v224, a32
    v_accvgpr_read_b32 v225, a33
    v_accvgpr_read_b32 v226, a34
    v_accvgpr_read_b32 v227, a35
    v_mul_f32 v224, v224, v52
    v_mul_f32 v225, v225, v52
    v_mul_f32 v226, v226, v52
    v_mul_f32 v227, v227, v52
    v_accvgpr_write_b32 a32, v224
    v_accvgpr_write_b32 a33, v225
    v_accvgpr_write_b32 a34, v226
    v_accvgpr_write_b32 a35, v227
    v_accvgpr_read_b32 v224, a36
    v_accvgpr_read_b32 v225, a37
    v_accvgpr_read_b32 v226, a38
    v_accvgpr_read_b32 v227, a39
    v_mul_f32 v224, v224, v53
    v_mul_f32 v225, v225, v53
    v_mul_f32 v226, v226, v53
    v_mul_f32 v227, v227, v53
    v_accvgpr_write_b32 a36, v224
    v_accvgpr_write_b32 a37, v225
    v_accvgpr_write_b32 a38, v226
    v_accvgpr_write_b32 a39, v227
    v_accvgpr_read_b32 v224, a40
    v_accvgpr_read_b32 v225, a41
    v_accvgpr_read_b32 v226, a42
    v_accvgpr_read_b32 v227, a43
    v_mul_f32 v224, v224, v54
    v_mul_f32 v225, v225, v54
    v_mul_f32 v226, v226, v54
    v_mul_f32 v227, v227, v54
    v_accvgpr_write_b32 a40, v224
    v_accvgpr_write_b32 a41, v225
    v_accvgpr_write_b32 a42, v226
    v_accvgpr_write_b32 a43, v227
    v_accvgpr_read_b32 v224, a44
    v_accvgpr_read_b32 v225, a45
    v_accvgpr_read_b32 v226, a46
    v_accvgpr_read_b32 v227, a47
    v_mul_f32 v224, v224, v55
    v_mul_f32 v225, v225, v55
    v_mul_f32 v226, v226, v55
    v_mul_f32 v227, v227, v55
    v_accvgpr_write_b32 a44, v224
    v_accvgpr_write_b32 a45, v225
    v_accvgpr_write_b32 a46, v226
    v_accvgpr_write_b32 a47, v227
    v_accvgpr_read_b32 v224, a48
    v_accvgpr_read_b32 v225, a49
    v_accvgpr_read_b32 v226, a50
    v_accvgpr_read_b32 v227, a51
    v_mul_f32 v224, v224, v52
    v_mul_f32 v225, v225, v52
    v_mul_f32 v226, v226, v52
    v_mul_f32 v227, v227, v52
    v_accvgpr_write_b32 a48, v224
    v_accvgpr_write_b32 a49, v225
    v_accvgpr_write_b32 a50, v226
    v_accvgpr_write_b32 a51, v227
    v_accvgpr_read_b32 v224, a52
    v_accvgpr_read_b32 v225, a53
    v_accvgpr_read_b32 v226, a54
    v_accvgpr_read_b32 v227, a55
    v_mul_f32 v224, v224, v53
    v_mul_f32 v225, v225, v53
    v_mul_f32 v226, v226, v53
    v_mul_f32 v227, v227, v53
    v_accvgpr_write_b32 a52, v224
    v_accvgpr_write_b32 a53, v225
    v_accvgpr_write_b32 a54, v226
    v_accvgpr_write_b32 a55, v227
    v_accvgpr_read_b32 v224, a56
    v_accvgpr_read_b32 v225, a57
    v_accvgpr_read_b32 v226, a58
    v_accvgpr_read_b32 v227, a59
    v_mul_f32 v224, v224, v54
    v_mul_f32 v225, v225, v54
    v_mul_f32 v226, v226, v54
    v_mul_f32 v227, v227, v54
    v_accvgpr_write_b32 a56, v224
    v_accvgpr_write_b32 a57, v225
    v_accvgpr_write_b32 a58, v226
    v_accvgpr_write_b32 a59, v227
    v_accvgpr_read_b32 v224, a60
    v_accvgpr_read_b32 v225, a61
    v_accvgpr_read_b32 v226, a62
    v_accvgpr_read_b32 v227, a63
    v_mul_f32 v224, v224, v55
    v_mul_f32 v225, v225, v55
    v_mul_f32 v226, v226, v55
    v_mul_f32 v227, v227, v55
    v_accvgpr_write_b32 a60, v224
    v_accvgpr_write_b32 a61, v225
    v_accvgpr_write_b32 a62, v226
    v_accvgpr_write_b32 a63, v227
    v_accvgpr_read_b32 v224, a64
    v_accvgpr_read_b32 v225, a65
    v_accvgpr_read_b32 v226, a66
    v_accvgpr_read_b32 v227, a67
    v_mul_f32 v224, v224, v52
    v_mul_f32 v225, v225, v52
    v_mul_f32 v226, v226, v52
    v_mul_f32 v227, v227, v52
    v_accvgpr_write_b32 a64, v224
    v_accvgpr_write_b32 a65, v225
    v_accvgpr_write_b32 a66, v226
    v_accvgpr_write_b32 a67, v227
    v_accvgpr_read_b32 v224, a68
    v_accvgpr_read_b32 v225, a69
    v_accvgpr_read_b32 v226, a70
    v_accvgpr_read_b32 v227, a71
    v_mul_f32 v224, v224, v53
    v_mul_f32 v225, v225, v53
    v_mul_f32 v226, v226, v53
    v_mul_f32 v227, v227, v53
    v_accvgpr_write_b32 a68, v224
    v_accvgpr_write_b32 a69, v225
    v_accvgpr_write_b32 a70, v226
    v_accvgpr_write_b32 a71, v227
    v_accvgpr_read_b32 v224, a72
    v_accvgpr_read_b32 v225, a73
    v_accvgpr_read_b32 v226, a74
    v_accvgpr_read_b32 v227, a75
    v_mul_f32 v224, v224, v54
    v_mul_f32 v225, v225, v54
    v_mul_f32 v226, v226, v54
    v_mul_f32 v227, v227, v54
    v_accvgpr_write_b32 a72, v224
    v_accvgpr_write_b32 a73, v225
    v_accvgpr_write_b32 a74, v226
    v_accvgpr_write_b32 a75, v227
    v_accvgpr_read_b32 v224, a76
    v_accvgpr_read_b32 v225, a77
    v_accvgpr_read_b32 v226, a78
    v_accvgpr_read_b32 v227, a79
    v_mul_f32 v224, v224, v55
    v_mul_f32 v225, v225, v55
    v_mul_f32 v226, v226, v55
    v_mul_f32 v227, v227, v55
    v_accvgpr_write_b32 a76, v224
    v_accvgpr_write_b32 a77, v225
    v_accvgpr_write_b32 a78, v226
    v_accvgpr_write_b32 a79, v227
    v_accvgpr_read_b32 v224, a80
    v_accvgpr_read_b32 v225, a81
    v_accvgpr_read_b32 v226, a82
    v_accvgpr_read_b32 v227, a83
    v_mul_f32 v224, v224, v52
    v_mul_f32 v225, v225, v52
    v_mul_f32 v226, v226, v52
    v_mul_f32 v227, v227, v52
    v_accvgpr_write_b32 a80, v224
    v_accvgpr_write_b32 a81, v225
    v_accvgpr_write_b32 a82, v226
    v_accvgpr_write_b32 a83, v227
    v_accvgpr_read_b32 v224, a84
    v_accvgpr_read_b32 v225, a85
    v_accvgpr_read_b32 v226, a86
    v_accvgpr_read_b32 v227, a87
    v_mul_f32 v224, v224, v53
    v_mul_f32 v225, v225, v53
    v_mul_f32 v226, v226, v53
    v_mul_f32 v227, v227, v53
    v_accvgpr_write_b32 a84, v224
    v_accvgpr_write_b32 a85, v225
    v_accvgpr_write_b32 a86, v226
    v_accvgpr_write_b32 a87, v227
    v_accvgpr_read_b32 v224, a88
    v_accvgpr_read_b32 v225, a89
    v_accvgpr_read_b32 v226, a90
    v_accvgpr_read_b32 v227, a91
    v_mul_f32 v224, v224, v54
    v_mul_f32 v225, v225, v54
    v_mul_f32 v226, v226, v54
    v_mul_f32 v227, v227, v54
    v_accvgpr_write_b32 a88, v224
    v_accvgpr_write_b32 a89, v225
    v_accvgpr_write_b32 a90, v226
    v_accvgpr_write_b32 a91, v227
    v_accvgpr_read_b32 v224, a92
    v_accvgpr_read_b32 v225, a93
    v_accvgpr_read_b32 v226, a94
    v_accvgpr_read_b32 v227, a95
    v_mul_f32 v224, v224, v55
    v_mul_f32 v225, v225, v55
    v_mul_f32 v226, v226, v55
    v_mul_f32 v227, v227, v55
    v_accvgpr_write_b32 a92, v224
    v_accvgpr_write_b32 a93, v225
    v_accvgpr_write_b32 a94, v226
    v_accvgpr_write_b32 a95, v227
    v_accvgpr_read_b32 v224, a96
    v_accvgpr_read_b32 v225, a97
    v_accvgpr_read_b32 v226, a98
    v_accvgpr_read_b32 v227, a99
    v_mul_f32 v224, v224, v52
    v_mul_f32 v225, v225, v52
    v_mul_f32 v226, v226, v52
    v_mul_f32 v227, v227, v52
    v_accvgpr_write_b32 a96, v224
    v_accvgpr_write_b32 a97, v225
    v_accvgpr_write_b32 a98, v226
    v_accvgpr_write_b32 a99, v227
    v_accvgpr_read_b32 v224, a100
    v_accvgpr_read_b32 v225, a101
    v_accvgpr_read_b32 v226, a102
    v_accvgpr_read_b32 v227, a103
    v_mul_f32 v224, v224, v53
    v_mul_f32 v225, v225, v53
    v_mul_f32 v226, v226, v53
    v_mul_f32 v227, v227, v53
    v_accvgpr_write_b32 a100, v224
    v_accvgpr_write_b32 a101, v225
    v_accvgpr_write_b32 a102, v226
    v_accvgpr_write_b32 a103, v227
    v_accvgpr_read_b32 v224, a104
    v_accvgpr_read_b32 v225, a105
    v_accvgpr_read_b32 v226, a106
    v_accvgpr_read_b32 v227, a107
    v_mul_f32 v224, v224, v54
    v_mul_f32 v225, v225, v54
    v_mul_f32 v226, v226, v54
    v_mul_f32 v227, v227, v54
    v_accvgpr_write_b32 a104, v224
    v_accvgpr_write_b32 a105, v225
    v_accvgpr_write_b32 a106, v226
    v_accvgpr_write_b32 a107, v227
    v_accvgpr_read_b32 v224, a108
    v_accvgpr_read_b32 v225, a109
    v_accvgpr_read_b32 v226, a110
    v_accvgpr_read_b32 v227, a111
    v_mul_f32 v224, v224, v55
    v_mul_f32 v225, v225, v55
    v_mul_f32 v226, v226, v55
    v_mul_f32 v227, v227, v55
    v_accvgpr_write_b32 a108, v224
    v_accvgpr_write_b32 a109, v225
    v_accvgpr_write_b32 a110, v226
    v_accvgpr_write_b32 a111, v227
    v_accvgpr_read_b32 v224, a112
    v_accvgpr_read_b32 v225, a113
    v_accvgpr_read_b32 v226, a114
    v_accvgpr_read_b32 v227, a115
    v_mul_f32 v224, v224, v52
    v_mul_f32 v225, v225, v52
    v_mul_f32 v226, v226, v52
    v_mul_f32 v227, v227, v52
    v_accvgpr_write_b32 a112, v224
    v_accvgpr_write_b32 a113, v225
    v_accvgpr_write_b32 a114, v226
    v_accvgpr_write_b32 a115, v227
    v_accvgpr_read_b32 v224, a116
    v_accvgpr_read_b32 v225, a117
    v_accvgpr_read_b32 v226, a118
    v_accvgpr_read_b32 v227, a119
    v_mul_f32 v224, v224, v53
    v_mul_f32 v225, v225, v53
    v_mul_f32 v226, v226, v53
    v_mul_f32 v227, v227, v53
    v_accvgpr_write_b32 a116, v224
    v_accvgpr_write_b32 a117, v225
    v_accvgpr_write_b32 a118, v226
    v_accvgpr_write_b32 a119, v227
    v_accvgpr_read_b32 v224, a120
    v_accvgpr_read_b32 v225, a121
    v_accvgpr_read_b32 v226, a122
    v_accvgpr_read_b32 v227, a123
    v_mul_f32 v224, v224, v54
    v_mul_f32 v225, v225, v54
    v_mul_f32 v226, v226, v54
    v_mul_f32 v227, v227, v54
    v_accvgpr_write_b32 a120, v224
    v_accvgpr_write_b32 a121, v225
    v_accvgpr_write_b32 a122, v226
    v_accvgpr_write_b32 a123, v227
    v_accvgpr_read_b32 v224, a124
    v_accvgpr_read_b32 v225, a125
    v_accvgpr_read_b32 v226, a126
    v_accvgpr_read_b32 v227, a127
    v_mul_f32 v224, v224, v55
    v_mul_f32 v225, v225, v55
    v_mul_f32 v226, v226, v55
    v_mul_f32 v227, v227, v55
    v_accvgpr_write_b32 a124, v224
    v_accvgpr_write_b32 a125, v225
    v_accvgpr_write_b32 a126, v226
    v_accvgpr_write_b32 a127, v227
    v_exp_f32 v232, v160
    v_exp_f32 v233, v161
    v_exp_f32 v234, v162
    v_exp_f32 v235, v163
    s_nop 0
    v_cvt_pk_bf16_f32 v208, v232, v233
    v_cvt_pk_bf16_f32 v209, v234, v235
    v_exp_f32 v232, v176
    v_exp_f32 v233, v177
    v_exp_f32 v234, v178
    v_exp_f32 v235, v179
    s_nop 0
    v_cvt_pk_bf16_f32 v210, v232, v233
    v_cvt_pk_bf16_f32 v211, v234, v235
    v_exp_f32 v232, v164
    v_exp_f32 v233, v165
    v_exp_f32 v234, v166
    v_exp_f32 v235, v167
    s_nop 0
    v_cvt_pk_bf16_f32 v212, v232, v233
    v_cvt_pk_bf16_f32 v213, v234, v235
    v_exp_f32 v232, v180
    v_exp_f32 v233, v181
    v_exp_f32 v234, v182
    v_exp_f32 v235, v183
    s_nop 0
    v_cvt_pk_bf16_f32 v214, v232, v233
    v_cvt_pk_bf16_f32 v215, v234, v235
    v_exp_f32 v232, v168
    v_exp_f32 v233, v169
    v_exp_f32 v234, v170
    v_exp_f32 v235, v171
    s_nop 0
    v_cvt_pk_bf16_f32 v216, v232, v233
    v_cvt_pk_bf16_f32 v217, v234, v235
    v_exp_f32 v232, v184
    v_exp_f32 v233, v185
    v_exp_f32 v234, v186
    v_exp_f32 v235, v187
    s_nop 0
    v_cvt_pk_bf16_f32 v218, v232, v233
    v_cvt_pk_bf16_f32 v219, v234, v235
    v_exp_f32 v232, v172
    v_exp_f32 v233, v173
    v_exp_f32 v234, v174
    v_exp_f32 v235, v175
    s_nop 0
    v_cvt_pk_bf16_f32 v220, v232, v233
    v_cvt_pk_bf16_f32 v221, v234, v235
    v_exp_f32 v232, v188
    v_exp_f32 v233, v189
    v_exp_f32 v234, v190
    v_exp_f32 v235, v191
    s_nop 0
    v_cvt_pk_bf16_f32 v222, v232, v233
    v_cvt_pk_bf16_f32 v223, v234, v235
    s_nop 3
    s_setpc_b64 s[40:41]
k2_rare_164:
    s_nop 7
    v_max_f32 v53, v132, v133
    v_max3_f32 v53, v53, v134, v135
    v_max3_f32 v53, v53, v148, v149
    v_max3_f32 v53, v53, v150, v151
    v_max_f32 v54, v136, v137
    v_max3_f32 v54, v54, v138, v139
    v_max3_f32 v54, v54, v152, v153
    v_max3_f32 v54, v54, v154, v155
    v_max_f32 v55, v140, v141
    v_max3_f32 v55, v55, v142, v143
    v_max3_f32 v55, v55, v156, v157
    v_max3_f32 v55, v55, v158, v159
    v_mov_b32 v225, v53
    v_mov_b32 v226, v54
    v_mov_b32 v227, v55
    s_nop 1
    v_permlane16_swap_b32 v53, v225
    v_permlane16_swap_b32 v54, v226
    v_permlane16_swap_b32 v55, v227
    s_nop 1
    v_max_f32 v53, v53, v225
    v_max_f32 v54, v54, v226
    v_max_f32 v55, v55, v227
    v_mov_b32 v225, v53
    v_mov_b32 v226, v54
    v_mov_b32 v227, v55
    s_nop 1
    v_permlane32_swap_b32 v53, v225
    v_permlane32_swap_b32 v54, v226
    v_permlane32_swap_b32 v55, v227
    s_nop 1
    v_max_f32 v53, v53, v225
    v_max_f32 v54, v54, v226
    v_max_f32 v55, v55, v227
    v_add_f32 v53, 0x41400000, v53
    v_max_f32 v53, 0, v53
    v_add_f32 v54, 0x41400000, v54
    v_max_f32 v54, 0, v54
    v_add_f32 v55, 0x41400000, v55
    v_max_f32 v55, 0, v55
    v_sub_f32 v132, v132, v53
    v_sub_f32 v133, v133, v53
    v_sub_f32 v134, v134, v53
    v_sub_f32 v135, v135, v53
    v_sub_f32 v136, v136, v54
    v_sub_f32 v137, v137, v54
    v_sub_f32 v138, v138, v54
    v_sub_f32 v139, v139, v54
    v_sub_f32 v140, v140, v55
    v_sub_f32 v141, v141, v55
    v_sub_f32 v142, v142, v55
    v_sub_f32 v143, v143, v55
    v_sub_f32 v148, v148, v53
    v_sub_f32 v149, v149, v53
    v_sub_f32 v150, v150, v53
    v_sub_f32 v151, v151, v53
    v_sub_f32 v152, v152, v54
    v_sub_f32 v153, v153, v54
    v_sub_f32 v154, v154, v54
    v_sub_f32 v155, v155, v54
    v_sub_f32 v156, v156, v55
    v_sub_f32 v157, v157, v55
    v_sub_f32 v158, v158, v55
    v_sub_f32 v159, v159, v55
    v_sub_f32 v164, v164, v53
    v_sub_f32 v20, v20, v53
    v_sub_f32 v165, v165, v53
    v_sub_f32 v21, v21, v53
    v_sub_f32 v166, v166, v53
    v_sub_f32 v22, v22, v53
    v_sub_f32 v167, v167, v53
    v_sub_f32 v23, v23, v53
    v_sub_f32 v168, v168, v54
    v_sub_f32 v24, v24, v54
    v_sub_f32 v169, v169, v54
    v_sub_f32 v25, v25, v54
    v_sub_f32 v170, v170, v54
    v_sub_f32 v26, v26, v54
    v_sub_f32 v171, v171, v54
    v_sub_f32 v27, v27, v54
    v_sub_f32 v172, v172, v55
    v_sub_f32 v28, v28, v55
    v_sub_f32 v173, v173, v55
    v_sub_f32 v29, v29, v55
    v_sub_f32 v174, v174, v55
    v_sub_f32 v30, v30, v55
    v_sub_f32 v175, v175, v55
    v_sub_f32 v31, v31, v55
    v_sub_f32 v180, v180, v53
    v_sub_f32 v36, v36, v53
    v_sub_f32 v181, v181, v53
    v_sub_f32 v37, v37, v53
    v_sub_f32 v182, v182, v53
    v_sub_f32 v38, v38, v53
    v_sub_f32 v183, v183, v53
    v_sub_f32 v39, v39, v53
    v_sub_f32 v184, v184, v54
    v_sub_f32 v40, v40, v54
    v_sub_f32 v185, v185, v54
    v_sub_f32 v41, v41, v54
    v_sub_f32 v186, v186, v54
    v_sub_f32 v42, v42, v54
    v_sub_f32 v187, v187, v54
    v_sub_f32 v43, v43, v54
    v_sub_f32 v188, v188, v55
    v_sub_f32 v44, v44, v55
    v_sub_f32 v189, v189, v55
    v_sub_f32 v45, v45, v55
    v_sub_f32 v190, v190, v55
    v_sub_f32 v46, v46, v55
    v_sub_f32 v191, v191, v55
    v_sub_f32 v47, v47, v55
    v_sub_f32 v9, v9, v53
    v_exp_f32 v53, -v53
    v_sub_f32 v10, v10, v54
    v_exp_f32 v54, -v54
    v_sub_f32 v11, v11, v55
    v_exp_f32 v55, -v55
    s_nop 0
    v_mul_f32 v48, v48, v53
    v_mul_f32 v248, v248, v54
    v_mul_f32 v252, v252, v55
    v_accvgpr_read_b32 v224, a4
    v_accvgpr_read_b32 v225, a5
    v_accvgpr_read_b32 v226, a6
    v_accvgpr_read_b32 v227, a7
    v_mul_f32 v224, v224, v53
    v_mul_f32 v225, v225, v53
    v_mul_f32 v226, v226, v53
    v_mul_f32 v227, v227, v53
    v_accvgpr_write_b32 a4, v224
    v_accvgpr_write_b32 a5, v225
    v_accvgpr_write_b32 a6, v226
    v_accvgpr_write_b32 a7, v227
    v_accvgpr_read_b32 v224, a8
    v_accvgpr_read_b32 v225, a9
    v_accvgpr_read_b32 v226, a10
    v_accvgpr_read_b32 v227, a11
    v_mul_f32 v224, v224, v54
    v_mul_f32 v225, v225, v54
    v_mul_f32 v226, v226, v54
    v_mul_f32 v227, v227, v54
    v_accvgpr_write_b32 a8, v224
    v_accvgpr_write_b32 a9, v225
    v_accvgpr_write_b32 a10, v226
    v_accvgpr_write_b32 a11, v227
    v_accvgpr_read_b32 v224, a12
    v_accvgpr_read_b32 v225, a13
    v_accvgpr_read_b32 v226, a14
    v_accvgpr_read_b32 v227, a15
    v_mul_f32 v224, v224, v55
    v_mul_f32 v225, v225, v55
    v_mul_f32 v226, v226, v55
    v_mul_f32 v227, v227, v55
    v_accvgpr_write_b32 a12, v224
    v_accvgpr_write_b32 a13, v225
    v_accvgpr_write_b32 a14, v226
    v_accvgpr_write_b32 a15, v227
    v_accvgpr_read_b32 v224, a20
    v_accvgpr_read_b32 v225, a21
    v_accvgpr_read_b32 v226, a22
    v_accvgpr_read_b32 v227, a23
    v_mul_f32 v224, v224, v53
    v_mul_f32 v225, v225, v53
    v_mul_f32 v226, v226, v53
    v_mul_f32 v227, v227, v53
    v_accvgpr_write_b32 a20, v224
    v_accvgpr_write_b32 a21, v225
    v_accvgpr_write_b32 a22, v226
    v_accvgpr_write_b32 a23, v227
    v_accvgpr_read_b32 v224, a24
    v_accvgpr_read_b32 v225, a25
    v_accvgpr_read_b32 v226, a26
    v_accvgpr_read_b32 v227, a27
    v_mul_f32 v224, v224, v54
    v_mul_f32 v225, v225, v54
    v_mul_f32 v226, v226, v54
    v_mul_f32 v227, v227, v54
    v_accvgpr_write_b32 a24, v224
    v_accvgpr_write_b32 a25, v225
    v_accvgpr_write_b32 a26, v226
    v_accvgpr_write_b32 a27, v227
    v_accvgpr_read_b32 v224, a28
    v_accvgpr_read_b32 v225, a29
    v_accvgpr_read_b32 v226, a30
    v_accvgpr_read_b32 v227, a31
    v_mul_f32 v224, v224, v55
    v_mul_f32 v225, v225, v55
    v_mul_f32 v226, v226, v55
    v_mul_f32 v227, v227, v55
    v_accvgpr_write_b32 a28, v224
    v_accvgpr_write_b32 a29, v225
    v_accvgpr_write_b32 a30, v226
    v_accvgpr_write_b32 a31, v227
    v_accvgpr_read_b32 v224, a36
    v_accvgpr_read_b32 v225, a37
    v_accvgpr_read_b32 v226, a38
    v_accvgpr_read_b32 v227, a39
    v_mul_f32 v224, v224, v53
    v_mul_f32 v225, v225, v53
    v_mul_f32 v226, v226, v53
    v_mul_f32 v227, v227, v53
    v_accvgpr_write_b32 a36, v224
    v_accvgpr_write_b32 a37, v225
    v_accvgpr_write_b32 a38, v226
    v_accvgpr_write_b32 a39, v227
    v_accvgpr_read_b32 v224, a40
    v_accvgpr_read_b32 v225, a41
    v_accvgpr_read_b32 v226, a42
    v_accvgpr_read_b32 v227, a43
    v_mul_f32 v224, v224, v54
    v_mul_f32 v225, v225, v54
    v_mul_f32 v226, v226, v54
    v_mul_f32 v227, v227, v54
    v_accvgpr_write_b32 a40, v224
    v_accvgpr_write_b32 a41, v225
    v_accvgpr_write_b32 a42, v226
    v_accvgpr_write_b32 a43, v227
    v_accvgpr_read_b32 v224, a44
    v_accvgpr_read_b32 v225, a45
    v_accvgpr_read_b32 v226, a46
    v_accvgpr_read_b32 v227, a47
    v_mul_f32 v224, v224, v55
    v_mul_f32 v225, v225, v55
    v_mul_f32 v226, v226, v55
    v_mul_f32 v227, v227, v55
    v_accvgpr_write_b32 a44, v224
    v_accvgpr_write_b32 a45, v225
    v_accvgpr_write_b32 a46, v226
    v_accvgpr_write_b32 a47, v227
    v_accvgpr_read_b32 v224, a52
    v_accvgpr_read_b32 v225, a53
    v_accvgpr_read_b32 v226, a54
    v_accvgpr_read_b32 v227, a55
    v_mul_f32 v224, v224, v53
    v_mul_f32 v225, v225, v53
    v_mul_f32 v226, v226, v53
    v_mul_f32 v227, v227, v53
    v_accvgpr_write_b32 a52, v224
    v_accvgpr_write_b32 a53, v225
    v_accvgpr_write_b32 a54, v226
    v_accvgpr_write_b32 a55, v227
    v_accvgpr_read_b32 v224, a56
    v_accvgpr_read_b32 v225, a57
    v_accvgpr_read_b32 v226, a58
    v_accvgpr_read_b32 v227, a59
    v_mul_f32 v224, v224, v54
    v_mul_f32 v225, v225, v54
    v_mul_f32 v226, v226, v54
    v_mul_f32 v227, v227, v54
    v_accvgpr_write_b32 a56, v224
    v_accvgpr_write_b32 a57, v225
    v_accvgpr_write_b32 a58, v226
    v_accvgpr_write_b32 a59, v227
    v_accvgpr_read_b32 v224, a60
    v_accvgpr_read_b32 v225, a61
    v_accvgpr_read_b32 v226, a62
    v_accvgpr_read_b32 v227, a63
    v_mul_f32 v224, v224, v55
    v_mul_f32 v225, v225, v55
    v_mul_f32 v226, v226, v55
    v_mul_f32 v227, v227, v55
    v_accvgpr_write_b32 a60, v224
    v_accvgpr_write_b32 a61, v225
    v_accvgpr_write_b32 a62, v226
    v_accvgpr_write_b32 a63, v227
    v_accvgpr_read_b32 v224, a68
    v_accvgpr_read_b32 v225, a69
    v_accvgpr_read_b32 v226, a70
    v_accvgpr_read_b32 v227, a71
    v_mul_f32 v224, v224, v53
    v_mul_f32 v225, v225, v53
    v_mul_f32 v226, v226, v53
    v_mul_f32 v227, v227, v53
    v_accvgpr_write_b32 a68, v224
    v_accvgpr_write_b32 a69, v225
    v_accvgpr_write_b32 a70, v226
    v_accvgpr_write_b32 a71, v227
    v_accvgpr_read_b32 v224, a72
    v_accvgpr_read_b32 v225, a73
    v_accvgpr_read_b32 v226, a74
    v_accvgpr_read_b32 v227, a75
    v_mul_f32 v224, v224, v54
    v_mul_f32 v225, v225, v54
    v_mul_f32 v226, v226, v54
    v_mul_f32 v227, v227, v54
    v_accvgpr_write_b32 a72, v224
    v_accvgpr_write_b32 a73, v225
    v_accvgpr_write_b32 a74, v226
    v_accvgpr_write_b32 a75, v227
    v_accvgpr_read_b32 v224, a76
    v_accvgpr_read_b32 v225, a77
    v_accvgpr_read_b32 v226, a78
    v_accvgpr_read_b32 v227, a79
    v_mul_f32 v224, v224, v55
    v_mul_f32 v225, v225, v55
    v_mul_f32 v226, v226, v55
    v_mul_f32 v227, v227, v55
    v_accvgpr_write_b32 a76, v224
    v_accvgpr_write_b32 a77, v225
    v_accvgpr_write_b32 a78, v226
    v_accvgpr_write_b32 a79, v227
    v_accvgpr_read_b32 v224, a84
    v_accvgpr_read_b32 v225, a85
    v_accvgpr_read_b32 v226, a86
    v_accvgpr_read_b32 v227, a87
    v_mul_f32 v224, v224, v53
    v_mul_f32 v225, v225, v53
    v_mul_f32 v226, v226, v53
    v_mul_f32 v227, v227, v53
    v_accvgpr_write_b32 a84, v224
    v_accvgpr_write_b32 a85, v225
    v_accvgpr_write_b32 a86, v226
    v_accvgpr_write_b32 a87, v227
    v_accvgpr_read_b32 v224, a88
    v_accvgpr_read_b32 v225, a89
    v_accvgpr_read_b32 v226, a90
    v_accvgpr_read_b32 v227, a91
    v_mul_f32 v224, v224, v54
    v_mul_f32 v225, v225, v54
    v_mul_f32 v226, v226, v54
    v_mul_f32 v227, v227, v54
    v_accvgpr_write_b32 a88, v224
    v_accvgpr_write_b32 a89, v225
    v_accvgpr_write_b32 a90, v226
    v_accvgpr_write_b32 a91, v227
    v_accvgpr_read_b32 v224, a92
    v_accvgpr_read_b32 v225, a93
    v_accvgpr_read_b32 v226, a94
    v_accvgpr_read_b32 v227, a95
    v_mul_f32 v224, v224, v55
    v_mul_f32 v225, v225, v55
    v_mul_f32 v226, v226, v55
    v_mul_f32 v227, v227, v55
    v_accvgpr_write_b32 a92, v224
    v_accvgpr_write_b32 a93, v225
    v_accvgpr_write_b32 a94, v226
    v_accvgpr_write_b32 a95, v227
    v_accvgpr_read_b32 v224, a100
    v_accvgpr_read_b32 v225, a101
    v_accvgpr_read_b32 v226, a102
    v_accvgpr_read_b32 v227, a103
    v_mul_f32 v224, v224, v53
    v_mul_f32 v225, v225, v53
    v_mul_f32 v226, v226, v53
    v_mul_f32 v227, v227, v53
    v_accvgpr_write_b32 a100, v224
    v_accvgpr_write_b32 a101, v225
    v_accvgpr_write_b32 a102, v226
    v_accvgpr_write_b32 a103, v227
    v_accvgpr_read_b32 v224, a104
    v_accvgpr_read_b32 v225, a105
    v_accvgpr_read_b32 v226, a106
    v_accvgpr_read_b32 v227, a107
    v_mul_f32 v224, v224, v54
    v_mul_f32 v225, v225, v54
    v_mul_f32 v226, v226, v54
    v_mul_f32 v227, v227, v54
    v_accvgpr_write_b32 a104, v224
    v_accvgpr_write_b32 a105, v225
    v_accvgpr_write_b32 a106, v226
    v_accvgpr_write_b32 a107, v227
    v_accvgpr_read_b32 v224, a108
    v_accvgpr_read_b32 v225, a109
    v_accvgpr_read_b32 v226, a110
    v_accvgpr_read_b32 v227, a111
    v_mul_f32 v224, v224, v55
    v_mul_f32 v225, v225, v55
    v_mul_f32 v226, v226, v55
    v_mul_f32 v227, v227, v55
    v_accvgpr_write_b32 a108, v224
    v_accvgpr_write_b32 a109, v225
    v_accvgpr_write_b32 a110, v226
    v_accvgpr_write_b32 a111, v227
    v_accvgpr_read_b32 v224, a116
    v_accvgpr_read_b32 v225, a117
    v_accvgpr_read_b32 v226, a118
    v_accvgpr_read_b32 v227, a119
    v_mul_f32 v224, v224, v53
    v_mul_f32 v225, v225, v53
    v_mul_f32 v226, v226, v53
    v_mul_f32 v227, v227, v53
    v_accvgpr_write_b32 a116, v224
    v_accvgpr_write_b32 a117, v225
    v_accvgpr_write_b32 a118, v226
    v_accvgpr_write_b32 a119, v227
    v_accvgpr_read_b32 v224, a120
    v_accvgpr_read_b32 v225, a121
    v_accvgpr_read_b32 v226, a122
    v_accvgpr_read_b32 v227, a123
    v_mul_f32 v224, v224, v54
    v_mul_f32 v225, v225, v54
    v_mul_f32 v226, v226, v54
    v_mul_f32 v227, v227, v54
    v_accvgpr_write_b32 a120, v224
    v_accvgpr_write_b32 a121, v225
    v_accvgpr_write_b32 a122, v226
    v_accvgpr_write_b32 a123, v227
    v_accvgpr_read_b32 v224, a124
    v_accvgpr_read_b32 v225, a125
    v_accvgpr_read_b32 v226, a126
    v_accvgpr_read_b32 v227, a127
    v_mul_f32 v224, v224, v55
    v_mul_f32 v225, v225, v55
    v_mul_f32 v226, v226, v55
    v_mul_f32 v227, v227, v55
    v_accvgpr_write_b32 a124, v224
    v_accvgpr_write_b32 a125, v225
    v_accvgpr_write_b32 a126, v226
    v_accvgpr_write_b32 a127, v227
    v_exp_f32 v232, v132
    v_exp_f32 v233, v133
    v_exp_f32 v234, v134
    v_exp_f32 v235, v135
    s_nop 0
    v_cvt_pk_bf16_f32 v196, v232, v233
    v_cvt_pk_bf16_f32 v197, v234, v235
    v_exp_f32 v232, v148
    v_exp_f32 v233, v149
    v_exp_f32 v234, v150
    v_exp_f32 v235, v151
    s_nop 0
    v_cvt_pk_bf16_f32 v198, v232, v233
    v_cvt_pk_bf16_f32 v199, v234, v235
    v_exp_f32 v232, v136
    v_exp_f32 v233, v137
    v_exp_f32 v234, v138
    v_exp_f32 v235, v139
    s_nop 0
    v_cvt_pk_bf16_f32 v200, v232, v233
    v_cvt_pk_bf16_f32 v201, v234, v235
    v_exp_f32 v232, v152
    v_exp_f32 v233, v153
    v_exp_f32 v234, v154
    v_exp_f32 v235, v155
    s_nop 0
    v_cvt_pk_bf16_f32 v202, v232, v233
    v_cvt_pk_bf16_f32 v203, v234, v235
    v_exp_f32 v232, v140
    v_exp_f32 v233, v141
    v_exp_f32 v234, v142
    v_exp_f32 v235, v143
    s_nop 0
    v_cvt_pk_bf16_f32 v204, v232, v233
    v_cvt_pk_bf16_f32 v205, v234, v235
    v_exp_f32 v232, v156
    v_exp_f32 v233, v157
    v_exp_f32 v234, v158
    v_exp_f32 v235, v159
    s_nop 0
    v_cvt_pk_bf16_f32 v206, v232, v233
    v_cvt_pk_bf16_f32 v207, v234, v235
    s_nop 3
    s_setpc_b64 s[40:41]
k2_rare_165:
    s_nop 7
    v_max_f32 v53, v164, v165
    v_max3_f32 v53, v53, v166, v167
    v_max3_f32 v53, v53, v180, v181
    v_max3_f32 v53, v53, v182, v183
    v_max_f32 v54, v168, v169
    v_max3_f32 v54, v54, v170, v171
    v_max3_f32 v54, v54, v184, v185
    v_max3_f32 v54, v54, v186, v187
    v_max_f32 v55, v172, v173
    v_max3_f32 v55, v55, v174, v175
    v_max3_f32 v55, v55, v188, v189
    v_max3_f32 v55, v55, v190, v191
    v_mov_b32 v225, v53
    v_mov_b32 v226, v54
    v_mov_b32 v227, v55
    s_nop 1
    v_permlane16_swap_b32 v53, v225
    v_permlane16_swap_b32 v54, v226
    v_permlane16_swap_b32 v55, v227
    s_nop 1
    v_max_f32 v53, v53, v225
    v_max_f32 v54, v54, v226
    v_max_f32 v55, v55, v227
    v_mov_b32 v225, v53
    v_mov_b32 v226, v54
    v_mov_b32 v227, v55
    s_nop 1
    v_permlane32_swap_b32 v53, v225
    v_permlane32_swap_b32 v54, v226
    v_permlane32_swap_b32 v55, v227
    s_nop 1
    v_max_f32 v53, v53, v225
    v_max_f32 v54, v54, v226
    v_max_f32 v55, v55, v227
    v_add_f32 v53, 0x41400000, v53
    v_max_f32 v53, 0, v53
    v_add_f32 v54, 0x41400000, v54
    v_max_f32 v54, 0, v54
    v_add_f32 v55, 0x41400000, v55
    v_max_f32 v55, 0, v55
    v_sub_f32 v164, v164, v53
    v_sub_f32 v165, v165, v53
    v_sub_f32 v166, v166, v53
    v_sub_f32 v167, v167, v53
    v_sub_f32 v168, v168, v54
    v_sub_f32 v169, v169, v54
    v_sub_f32 v170, v170, v54
    v_sub_f32 v171, v171, v54
    v_sub_f32 v172, v172, v55
    v_sub_f32 v173, v173, v55
    v_sub_f32 v174, v174, v55
    v_sub_f32 v175, v175, v55
    v_sub_f32 v180, v180, v53
    v_sub_f32 v181, v181, v53
    v_sub_f32 v182, v182, v53
    v_sub_f32 v183, v183, v53
    v_sub_f32 v184, v184, v54
    v_sub_f32 v185, v185, v54
    v_sub_f32 v186, v186, v54
    v_sub_f32 v187, v187, v54
    v_sub_f32 v188, v188, v55
    v_sub_f32 v189, v189, v55
    v_sub_f32 v190, v190, v55
    v_sub_f32 v191, v191, v55
    v_sub_f32 v128, v128, v54
    v_sub_f32 v16, v16, v54
    v_sub_f32 v129, v129, v54
    v_sub_f32 v17, v17, v54
    v_sub_f32 v130, v130, v54
    v_sub_f32 v18, v18, v54
    v_sub_f32 v131, v131, v54
    v_sub_f32 v19, v19, v54
    v_sub_f32 v132, v132, v55
    v_sub_f32 v20, v20, v55
    v_sub_f32 v133, v133, v55
    v_sub_f32 v21, v21, v55
    v_sub_f32 v134, v134, v55
    v_sub_f32 v22, v22, v55
    v_sub_f32 v135, v135, v55
    v_sub_f32 v23, v23, v55
    v_sub_f32 v136, v136, v54
    v_sub_f32 v24, v24, v54
    v_sub_f32 v137, v137, v54
    v_sub_f32 v25, v25, v54
    v_sub_f32 v138, v138, v54
    v_sub_f32 v26, v26, v54
    v_sub_f32 v139, v139, v54
    v_sub_f32 v27, v27, v54
    v_sub_f32 v140, v140, v55
    v_sub_f32 v28, v28, v55
    v_sub_f32 v141, v141, v55
    v_sub_f32 v29, v29, v55
    v_sub_f32 v142, v142, v55
    v_sub_f32 v30, v30, v55
    v_sub_f32 v143, v143, v55
    v_sub_f32 v31, v31, v55
    v_sub_f32 v144, v144, v54
    v_sub_f32 v32, v32, v54
    v_sub_f32 v145, v145, v54
    v_sub_f32 v33, v33, v54
    v_sub_f32 v146, v146, v54
    v_sub_f32 v34, v34, v54
    v_sub_f32 v147, v147, v54
    v_sub_f32 v35, v35, v54
    v_sub_f32 v148, v148, v55
    v_sub_f32 v36, v36, v55
    v_sub_f32 v149, v149, v55
    v_sub_f32 v37, v37, v55
    v_sub_f32 v150, v150, v55
    v_sub_f32 v38, v38, v55
    v_sub_f32 v151, v151, v55
    v_sub_f32 v39, v39, v55
    v_sub_f32 v152, v152, v54
    v_sub_f32 v40, v40, v54
    v_sub_f32 v153, v153, v54
    v_sub_f32 v41, v41, v54
    v_sub_f32 v154, v154, v54
    v_sub_f32 v42, v42, v54
    v_sub_f32 v155, v155, v54
    v_sub_f32 v43, v43, v54
    v_sub_f32 v156, v156, v55
    v_sub_f32 v44, v44, v55
    v_sub_f32 v157, v157, v55
    v_sub_f32 v45, v45, v55
    v_sub_f32 v158, v158, v55
    v_sub_f32 v46, v46, v55
    v_sub_f32 v159, v159, v55
    v_sub_f32 v47, v47, v55
    v_sub_f32 v9, v9, v53
    v_exp_f32 v53, -v53
    v_sub_f32 v10, v10, v54
    v_exp_f32 v54, -v54
    v_sub_f32 v11, v11, v55
    v_exp_f32 v55, -v55
    s_nop 0
    v_mul_f32 v48, v48, v53
    v_mul_f32 v248, v248, v54
    v_mul_f32 v252, v252, v55
    v_accvgpr_read_b32 v224, a4
    v_accvgpr_read_b32 v225, a5
    v_accvgpr_read_b32 v226, a6
    v_accvgpr_read_b32 v227, a7
    v_mul_f32 v224, v224, v53
    v_mul_f32 v225, v225, v53
    v_mul_f32 v226, v226, v53
    v_mul_f32 v227, v227, v53
    v_accvgpr_write_b32 a4, v224
    v_accvgpr_write_b32 a5, v225
    v_accvgpr_write_b32 a6, v226
    v_accvgpr_write_b32 a7, v227
    v_accvgpr_read_b32 v224, a8
    v_accvgpr_read_b32 v225, a9
    v_accvgpr_read_b32 v226, a10
    v_accvgpr_read_b32 v227, a11
    v_mul_f32 v224, v224, v54
    v_mul_f32 v225, v225, v54
    v_mul_f32 v226, v226, v54
    v_mul_f32 v227, v227, v54
    v_accvgpr_write_b32 a8, v224
    v_accvgpr_write_b32 a9, v225
    v_accvgpr_write_b32 a10, v226
    v_accvgpr_write_b32 a11, v227
    v_accvgpr_read_b32 v224, a12
    v_accvgpr_read_b32 v225, a13
    v_accvgpr_read_b32 v226, a14
    v_accvgpr_read_b32 v227, a15
    v_mul_f32 v224, v224, v55
    v_mul_f32 v225, v225, v55
    v_mul_f32 v226, v226, v55
    v_mul_f32 v227, v227, v55
    v_accvgpr_write_b32 a12, v224
    v_accvgpr_write_b32 a13, v225
    v_accvgpr_write_b32 a14, v226
    v_accvgpr_write_b32 a15, v227
    v_accvgpr_read_b32 v224, a20
    v_accvgpr_read_b32 v225, a21
    v_accvgpr_read_b32 v226, a22
    v_accvgpr_read_b32 v227, a23
    v_mul_f32 v224, v224, v53
    v_mul_f32 v225, v225, v53
    v_mul_f32 v226, v226, v53
    v_mul_f32 v227, v227, v53
    v_accvgpr_write_b32 a20, v224
    v_accvgpr_write_b32 a21, v225
    v_accvgpr_write_b32 a22, v226
    v_accvgpr_write_b32 a23, v227
    v_accvgpr_read_b32 v224, a24
    v_accvgpr_read_b32 v225, a25
    v_accvgpr_read_b32 v226, a26
    v_accvgpr_read_b32 v227, a27
    v_mul_f32 v224, v224, v54
    v_mul_f32 v225, v225, v54
    v_mul_f32 v226, v226, v54
    v_mul_f32 v227, v227, v54
    v_accvgpr_write_b32 a24, v224
    v_accvgpr_write_b32 a25, v225
    v_accvgpr_write_b32 a26, v226
    v_accvgpr_write_b32 a27, v227
    v_accvgpr_read_b32 v224, a28
    v_accvgpr_read_b32 v225, a29
    v_accvgpr_read_b32 v226, a30
    v_accvgpr_read_b32 v227, a31
    v_mul_f32 v224, v224, v55
    v_mul_f32 v225, v225, v55
    v_mul_f32 v226, v226, v55
    v_mul_f32 v227, v227, v55
    v_accvgpr_write_b32 a28, v224
    v_accvgpr_write_b32 a29, v225
    v_accvgpr_write_b32 a30, v226
    v_accvgpr_write_b32 a31, v227
    v_accvgpr_read_b32 v224, a36
    v_accvgpr_read_b32 v225, a37
    v_accvgpr_read_b32 v226, a38
    v_accvgpr_read_b32 v227, a39
    v_mul_f32 v224, v224, v53
    v_mul_f32 v225, v225, v53
    v_mul_f32 v226, v226, v53
    v_mul_f32 v227, v227, v53
    v_accvgpr_write_b32 a36, v224
    v_accvgpr_write_b32 a37, v225
    v_accvgpr_write_b32 a38, v226
    v_accvgpr_write_b32 a39, v227
    v_accvgpr_read_b32 v224, a40
    v_accvgpr_read_b32 v225, a41
    v_accvgpr_read_b32 v226, a42
    v_accvgpr_read_b32 v227, a43
    v_mul_f32 v224, v224, v54
    v_mul_f32 v225, v225, v54
    v_mul_f32 v226, v226, v54
    v_mul_f32 v227, v227, v54
    v_accvgpr_write_b32 a40, v224
    v_accvgpr_write_b32 a41, v225
    v_accvgpr_write_b32 a42, v226
    v_accvgpr_write_b32 a43, v227
    v_accvgpr_read_b32 v224, a44
    v_accvgpr_read_b32 v225, a45
    v_accvgpr_read_b32 v226, a46
    v_accvgpr_read_b32 v227, a47
    v_mul_f32 v224, v224, v55
    v_mul_f32 v225, v225, v55
    v_mul_f32 v226, v226, v55
    v_mul_f32 v227, v227, v55
    v_accvgpr_write_b32 a44, v224
    v_accvgpr_write_b32 a45, v225
    v_accvgpr_write_b32 a46, v226
    v_accvgpr_write_b32 a47, v227
    v_accvgpr_read_b32 v224, a52
    v_accvgpr_read_b32 v225, a53
    v_accvgpr_read_b32 v226, a54
    v_accvgpr_read_b32 v227, a55
    v_mul_f32 v224, v224, v53
    v_mul_f32 v225, v225, v53
    v_mul_f32 v226, v226, v53
    v_mul_f32 v227, v227, v53
    v_accvgpr_write_b32 a52, v224
    v_accvgpr_write_b32 a53, v225
    v_accvgpr_write_b32 a54, v226
    v_accvgpr_write_b32 a55, v227
    v_accvgpr_read_b32 v224, a56
    v_accvgpr_read_b32 v225, a57
    v_accvgpr_read_b32 v226, a58
    v_accvgpr_read_b32 v227, a59
    v_mul_f32 v224, v224, v54
    v_mul_f32 v225, v225, v54
    v_mul_f32 v226, v226, v54
    v_mul_f32 v227, v227, v54
    v_accvgpr_write_b32 a56, v224
    v_accvgpr_write_b32 a57, v225
    v_accvgpr_write_b32 a58, v226
    v_accvgpr_write_b32 a59, v227
    v_accvgpr_read_b32 v224, a60
    v_accvgpr_read_b32 v225, a61
    v_accvgpr_read_b32 v226, a62
    v_accvgpr_read_b32 v227, a63
    v_mul_f32 v224, v224, v55
    v_mul_f32 v225, v225, v55
    v_mul_f32 v226, v226, v55
    v_mul_f32 v227, v227, v55
    v_accvgpr_write_b32 a60, v224
    v_accvgpr_write_b32 a61, v225
    v_accvgpr_write_b32 a62, v226
    v_accvgpr_write_b32 a63, v227
    v_accvgpr_read_b32 v224, a68
    v_accvgpr_read_b32 v225, a69
    v_accvgpr_read_b32 v226, a70
    v_accvgpr_read_b32 v227, a71
    v_mul_f32 v224, v224, v53
    v_mul_f32 v225, v225, v53
    v_mul_f32 v226, v226, v53
    v_mul_f32 v227, v227, v53
    v_accvgpr_write_b32 a68, v224
    v_accvgpr_write_b32 a69, v225
    v_accvgpr_write_b32 a70, v226
    v_accvgpr_write_b32 a71, v227
    v_accvgpr_read_b32 v224, a72
    v_accvgpr_read_b32 v225, a73
    v_accvgpr_read_b32 v226, a74
    v_accvgpr_read_b32 v227, a75
    v_mul_f32 v224, v224, v54
    v_mul_f32 v225, v225, v54
    v_mul_f32 v226, v226, v54
    v_mul_f32 v227, v227, v54
    v_accvgpr_write_b32 a72, v224
    v_accvgpr_write_b32 a73, v225
    v_accvgpr_write_b32 a74, v226
    v_accvgpr_write_b32 a75, v227
    v_accvgpr_read_b32 v224, a76
    v_accvgpr_read_b32 v225, a77
    v_accvgpr_read_b32 v226, a78
    v_accvgpr_read_b32 v227, a79
    v_mul_f32 v224, v224, v55
    v_mul_f32 v225, v225, v55
    v_mul_f32 v226, v226, v55
    v_mul_f32 v227, v227, v55
    v_accvgpr_write_b32 a76, v224
    v_accvgpr_write_b32 a77, v225
    v_accvgpr_write_b32 a78, v226
    v_accvgpr_write_b32 a79, v227
    v_accvgpr_read_b32 v224, a84
    v_accvgpr_read_b32 v225, a85
    v_accvgpr_read_b32 v226, a86
    v_accvgpr_read_b32 v227, a87
    v_mul_f32 v224, v224, v53
    v_mul_f32 v225, v225, v53
    v_mul_f32 v226, v226, v53
    v_mul_f32 v227, v227, v53
    v_accvgpr_write_b32 a84, v224
    v_accvgpr_write_b32 a85, v225
    v_accvgpr_write_b32 a86, v226
    v_accvgpr_write_b32 a87, v227
    v_accvgpr_read_b32 v224, a88
    v_accvgpr_read_b32 v225, a89
    v_accvgpr_read_b32 v226, a90
    v_accvgpr_read_b32 v227, a91
    v_mul_f32 v224, v224, v54
    v_mul_f32 v225, v225, v54
    v_mul_f32 v226, v226, v54
    v_mul_f32 v227, v227, v54
    v_accvgpr_write_b32 a88, v224
    v_accvgpr_write_b32 a89, v225
    v_accvgpr_write_b32 a90, v226
    v_accvgpr_write_b32 a91, v227
    v_accvgpr_read_b32 v224, a92
    v_accvgpr_read_b32 v225, a93
    v_accvgpr_read_b32 v226, a94
    v_accvgpr_read_b32 v227, a95
    v_mul_f32 v224, v224, v55
    v_mul_f32 v225, v225, v55
    v_mul_f32 v226, v226, v55
    v_mul_f32 v227, v227, v55
    v_accvgpr_write_b32 a92, v224
    v_accvgpr_write_b32 a93, v225
    v_accvgpr_write_b32 a94, v226
    v_accvgpr_write_b32 a95, v227
    v_accvgpr_read_b32 v224, a100
    v_accvgpr_read_b32 v225, a101
    v_accvgpr_read_b32 v226, a102
    v_accvgpr_read_b32 v227, a103
    v_mul_f32 v224, v224, v53
    v_mul_f32 v225, v225, v53
    v_mul_f32 v226, v226, v53
    v_mul_f32 v227, v227, v53
    v_accvgpr_write_b32 a100, v224
    v_accvgpr_write_b32 a101, v225
    v_accvgpr_write_b32 a102, v226
    v_accvgpr_write_b32 a103, v227
    v_accvgpr_read_b32 v224, a104
    v_accvgpr_read_b32 v225, a105
    v_accvgpr_read_b32 v226, a106
    v_accvgpr_read_b32 v227, a107
    v_mul_f32 v224, v224, v54
    v_mul_f32 v225, v225, v54
    v_mul_f32 v226, v226, v54
    v_mul_f32 v227, v227, v54
    v_accvgpr_write_b32 a104, v224
    v_accvgpr_write_b32 a105, v225
    v_accvgpr_write_b32 a106, v226
    v_accvgpr_write_b32 a107, v227
    v_accvgpr_read_b32 v224, a108
    v_accvgpr_read_b32 v225, a109
    v_accvgpr_read_b32 v226, a110
    v_accvgpr_read_b32 v227, a111
    v_mul_f32 v224, v224, v55
    v_mul_f32 v225, v225, v55
    v_mul_f32 v226, v226, v55
    v_mul_f32 v227, v227, v55
    v_accvgpr_write_b32 a108, v224
    v_accvgpr_write_b32 a109, v225
    v_accvgpr_write_b32 a110, v226
    v_accvgpr_write_b32 a111, v227
    v_accvgpr_read_b32 v224, a116
    v_accvgpr_read_b32 v225, a117
    v_accvgpr_read_b32 v226, a118
    v_accvgpr_read_b32 v227, a119
    v_mul_f32 v224, v224, v53
    v_mul_f32 v225, v225, v53
    v_mul_f32 v226, v226, v53
    v_mul_f32 v227, v227, v53
    v_accvgpr_write_b32 a116, v224
    v_accvgpr_write_b32 a117, v225
    v_accvgpr_write_b32 a118, v226
    v_accvgpr_write_b32 a119, v227
    v_accvgpr_read_b32 v224, a120
    v_accvgpr_read_b32 v225, a121
    v_accvgpr_read_b32 v226, a122
    v_accvgpr_read_b32 v227, a123
    v_mul_f32 v224, v224, v54
    v_mul_f32 v225, v225, v54
    v_mul_f32 v226, v226, v54
    v_mul_f32 v227, v227, v54
    v_accvgpr_write_b32 a120, v224
    v_accvgpr_write_b32 a121, v225
    v_accvgpr_write_b32 a122, v226
    v_accvgpr_write_b32 a123, v227
    v_accvgpr_read_b32 v224, a124
    v_accvgpr_read_b32 v225, a125
    v_accvgpr_read_b32 v226, a126
    v_accvgpr_read_b32 v227, a127
    v_mul_f32 v224, v224, v55
    v_mul_f32 v225, v225, v55
    v_mul_f32 v226, v226, v55
    v_mul_f32 v227, v227, v55
    v_accvgpr_write_b32 a124, v224
    v_accvgpr_write_b32 a125, v225
    v_accvgpr_write_b32 a126, v226
    v_accvgpr_write_b32 a127, v227
    v_exp_f32 v232, v164
    v_exp_f32 v233, v165
    v_exp_f32 v234, v166
    v_exp_f32 v235, v167
    s_nop 0
    v_cvt_pk_bf16_f32 v212, v232, v233
    v_cvt_pk_bf16_f32 v213, v234, v235
    v_exp_f32 v232, v180
    v_exp_f32 v233, v181
    v_exp_f32 v234, v182
    v_exp_f32 v235, v183
    s_nop 0
    v_cvt_pk_bf16_f32 v214, v232, v233
    v_cvt_pk_bf16_f32 v215, v234, v235
    v_exp_f32 v232, v168
    v_exp_f32 v233, v169
    v_exp_f32 v234, v170
    v_exp_f32 v235, v171
    s_nop 0
    v_cvt_pk_bf16_f32 v216, v232, v233
    v_cvt_pk_bf16_f32 v217, v234, v235
    v_exp_f32 v232, v184
    v_exp_f32 v233, v185
    v_exp_f32 v234, v186
    v_exp_f32 v235, v187
    s_nop 0
    v_cvt_pk_bf16_f32 v218, v232, v233
    v_cvt_pk_bf16_f32 v219, v234, v235
    v_exp_f32 v232, v172
    v_exp_f32 v233, v173
    v_exp_f32 v234, v174
    v_exp_f32 v235, v175
    s_nop 0
    v_cvt_pk_bf16_f32 v220, v232, v233
    v_cvt_pk_bf16_f32 v221, v234, v235
    v_exp_f32 v232, v188
    v_exp_f32 v233, v189
    v_exp_f32 v234, v190
    v_exp_f32 v235, v191
    s_nop 0
    v_cvt_pk_bf16_f32 v222, v232, v233
    v_cvt_pk_bf16_f32 v223, v234, v235
    s_nop 3
    s_setpc_b64 s[40:41]
k2_rare_166:
    s_nop 7
    v_max_f32 v54, v128, v129
    v_max3_f32 v54, v54, v130, v131
    v_max3_f32 v54, v54, v144, v145
    v_max3_f32 v54, v54, v146, v147
    v_max3_f32 v54, v54, v136, v137
    v_max3_f32 v54, v54, v138, v139
    v_max3_f32 v54, v54, v152, v153
    v_max3_f32 v54, v54, v154, v155
    v_max_f32 v55, v132, v133
    v_max3_f32 v55, v55, v134, v135
    v_max3_f32 v55, v55, v148, v149
    v_max3_f32 v55, v55, v150, v151
    v_max3_f32 v55, v55, v140, v141
    v_max3_f32 v55, v55, v142, v143
    v_max3_f32 v55, v55, v156, v157
    v_max3_f32 v55, v55, v158, v159
    v_mov_b32 v226, v54
    v_mov_b32 v227, v55
    s_nop 1
    v_permlane16_swap_b32 v54, v226
    v_permlane16_swap_b32 v55, v227
    s_nop 1
    v_max_f32 v54, v54, v226
    v_max_f32 v55, v55, v227
    v_mov_b32 v226, v54
    v_mov_b32 v227, v55
    s_nop 1
    v_permlane32_swap_b32 v54, v226
    v_permlane32_swap_b32 v55, v227
    s_nop 1
    v_max_f32 v54, v54, v226
    v_max_f32 v55, v55, v227
    v_add_f32 v54, 0x41400000, v54
    v_max_f32 v54, 0, v54
    v_add_f32 v55, 0x41400000, v55
    v_max_f32 v55, 0, v55
    v_sub_f32 v128, v128, v54
    v_sub_f32 v129, v129, v54
    v_sub_f32 v130, v130, v54
    v_sub_f32 v131, v131, v54
    v_sub_f32 v132, v132, v55
    v_sub_f32 v133, v133, v55
    v_sub_f32 v134, v134, v55
    v_sub_f32 v135, v135, v55
    v_sub_f32 v136, v136, v54
    v_sub_f32 v137, v137, v54
    v_sub_f32 v138, v138, v54
    v_sub_f32 v139, v139, v54
    v_sub_f32 v140, v140, v55
    v_sub_f32 v141, v141, v55
    v_sub_f32 v142, v142, v55
    v_sub_f32 v143, v143, v55
    v_sub_f32 v144, v144, v54
    v_sub_f32 v145, v145, v54
    v_sub_f32 v146, v146, v54
    v_sub_f32 v147, v147, v54
    v_sub_f32 v148, v148, v55
    v_sub_f32 v149, v149, v55
    v_sub_f32 v150, v150, v55
    v_sub_f32 v151, v151, v55
    v_sub_f32 v152, v152, v54
    v_sub_f32 v153, v153, v54
    v_sub_f32 v154, v154, v54
    v_sub_f32 v155, v155, v54
    v_sub_f32 v156, v156, v55
    v_sub_f32 v157, v157, v55
    v_sub_f32 v158, v158, v55
    v_sub_f32 v159, v159, v55
    v_sub_f32 v160, v160, v54
    v_sub_f32 v16, v16, v54
    v_sub_f32 v161, v161, v54
    v_sub_f32 v17, v17, v54
    v_sub_f32 v162, v162, v54
    v_sub_f32 v18, v18, v54
    v_sub_f32 v163, v163, v54
    v_sub_f32 v19, v19, v54
    v_sub_f32 v164, v164, v55
    v_sub_f32 v20, v20, v55
    v_sub_f32 v165, v165, v55
    v_sub_f32 v21, v21, v55
    v_sub_f32 v166, v166, v55
    v_sub_f32 v22, v22, v55
    v_sub_f32 v167, v167, v55
    v_sub_f32 v23, v23, v55
    v_sub_f32 v168, v168, v54
    v_sub_f32 v24, v24, v54
    v_sub_f32 v169, v169, v54
    v_sub_f32 v25, v25, v54
    v_sub_f32 v170, v170, v54
    v_sub_f32 v26, v26, v54
    v_sub_f32 v171, v171, v54
    v_sub_f32 v27, v27, v54
    v_sub_f32 v172, v172, v55
    v_sub_f32 v28, v28, v55
    v_sub_f32 v173, v173, v55
    v_sub_f32 v29, v29, v55
    v_sub_f32 v174, v174, v55
    v_sub_f32 v30, v30, v55
    v_sub_f32 v175, v175, v55
    v_sub_f32 v31, v31, v55
    v_sub_f32 v176, v176, v54
    v_sub_f32 v32, v32, v54
    v_sub_f32 v177, v177, v54
    v_sub_f32 v33, v33, v54
    v_sub_f32 v178, v178, v54
    v_sub_f32 v34, v34, v54
    v_sub_f32 v179, v179, v54
    v_sub_f32 v35, v35, v54
    v_sub_f32 v180, v180, v55
    v_sub_f32 v36, v36, v55
    v_sub_f32 v181, v181, v55
    v_sub_f32 v37, v37, v55
    v_sub_f32 v182, v182, v55
    v_sub_f32 v38, v38, v55
    v_sub_f32 v183, v183, v55
    v_sub_f32 v39, v39, v55
    v_sub_f32 v184, v184, v54
    v_sub_f32 v40, v40, v54
    v_sub_f32 v185, v185, v54
    v_sub_f32 v41, v41, v54
    v_sub_f32 v186, v186, v54
    v_sub_f32 v42, v42, v54
    v_sub_f32 v187, v187, v54
    v_sub_f32 v43, v43, v54
    v_sub_f32 v188, v188, v55
    v_sub_f32 v44, v44, v55
    v_sub_f32 v189, v189, v55
    v_sub_f32 v45, v45, v55
    v_sub_f32 v190, v190, v55
    v_sub_f32 v46, v46, v55
    v_sub_f32 v191, v191, v55
    v_sub_f32 v47, v47, v55
    v_sub_f32 v10, v10, v54
    v_exp_f32 v54, -v54
    v_sub_f32 v11, v11, v55
    v_exp_f32 v55, -v55
    s_nop 0
    v_mul_f32 v248, v248, v54
    v_mul_f32 v252, v252, v55
    v_accvgpr_read_b32 v224, a8
    v_accvgpr_read_b32 v225, a9
    v_accvgpr_read_b32 v226, a10
    v_accvgpr_read_b32 v227, a11
    v_mul_f32 v224, v224, v54
    v_mul_f32 v225, v225, v54
    v_mul_f32 v226, v226, v54
    v_mul_f32 v227, v227, v54
    v_accvgpr_write_b32 a8, v224
    v_accvgpr_write_b32 a9, v225
    v_accvgpr_write_b32 a10, v226
    v_accvgpr_write_b32 a11, v227
    v_accvgpr_read_b32 v224, a12
    v_accvgpr_read_b32 v225, a13
    v_accvgpr_read_b32 v226, a14
    v_accvgpr_read_b32 v227, a15
    v_mul_f32 v224, v224, v55
    v_mul_f32 v225, v225, v55
    v_mul_f32 v226, v226, v55
    v_mul_f32 v227, v227, v55
    v_accvgpr_write_b32 a12, v224
    v_accvgpr_write_b32 a13, v225
    v_accvgpr_write_b32 a14, v226
    v_accvgpr_write_b32 a15, v227
    v_accvgpr_read_b32 v224, a24
    v_accvgpr_read_b32 v225, a25
    v_accvgpr_read_b32 v226, a26
    v_accvgpr_read_b32 v227, a27
    v_mul_f32 v224, v224, v54
    v_mul_f32 v225, v225, v54
    v_mul_f32 v226, v226, v54
    v_mul_f32 v227, v227, v54
    v_accvgpr_write_b32 a24, v224
    v_accvgpr_write_b32 a25, v225
    v_accvgpr_write_b32 a26, v226
    v_accvgpr_write_b32 a27, v227
    v_accvgpr_read_b32 v224, a28
    v_accvgpr_read_b32 v225, a29
    v_accvgpr_read_b32 v226, a30
    v_accvgpr_read_b32 v227, a31
    v_mul_f32 v224, v224, v55
    v_mul_f32 v225, v225, v55
    v_mul_f32 v226, v226, v55
    v_mul_f32 v227, v227, v55
    v_accvgpr_write_b32 a28, v224
    v_accvgpr_write_b32 a29, v225
    v_accvgpr_write_b32 a30, v226
    v_accvgpr_write_b32 a31, v227
    v_accvgpr_read_b32 v224, a40
    v_accvgpr_read_b32 v225, a41
    v_accvgpr_read_b32 v226, a42
    v_accvgpr_read_b32 v227, a43
    v_mul_f32 v224, v224, v54
    v_mul_f32 v225, v225, v54
    v_mul_f32 v226, v226, v54
    v_mul_f32 v227, v227, v54
    v_accvgpr_write_b32 a40, v224
    v_accvgpr_write_b32 a41, v225
    v_accvgpr_write_b32 a42, v226
    v_accvgpr_write_b32 a43, v227
    v_accvgpr_read_b32 v224, a44
    v_accvgpr_read_b32 v225, a45
    v_accvgpr_read_b32 v226, a46
    v_accvgpr_read_b32 v227, a47
    v_mul_f32 v224, v224, v55
    v_mul_f32 v225, v225, v55
    v_mul_f32 v226, v226, v55
    v_mul_f32 v227, v227, v55
    v_accvgpr_write_b32 a44, v224
    v_accvgpr_write_b32 a45, v225
    v_accvgpr_write_b32 a46, v226
    v_accvgpr_write_b32 a47, v227
    v_accvgpr_read_b32 v224, a56
    v_accvgpr_read_b32 v225, a57
    v_accvgpr_read_b32 v226, a58
    v_accvgpr_read_b32 v227, a59
    v_mul_f32 v224, v224, v54
    v_mul_f32 v225, v225, v54
    v_mul_f32 v226, v226, v54
    v_mul_f32 v227, v227, v54
    v_accvgpr_write_b32 a56, v224
    v_accvgpr_write_b32 a57, v225
    v_accvgpr_write_b32 a58, v226
    v_accvgpr_write_b32 a59, v227
    v_accvgpr_read_b32 v224, a60
    v_accvgpr_read_b32 v225, a61
    v_accvgpr_read_b32 v226, a62
    v_accvgpr_read_b32 v227, a63
    v_mul_f32 v224, v224, v55
    v_mul_f32 v225, v225, v55
    v_mul_f32 v226, v226, v55
    v_mul_f32 v227, v227, v55
    v_accvgpr_write_b32 a60, v224
    v_accvgpr_write_b32 a61, v225
    v_accvgpr_write_b32 a62, v226
    v_accvgpr_write_b32 a63, v227
    v_accvgpr_read_b32 v224, a72
    v_accvgpr_read_b32 v225, a73
    v_accvgpr_read_b32 v226, a74
    v_accvgpr_read_b32 v227, a75
    v_mul_f32 v224, v224, v54
    v_mul_f32 v225, v225, v54
    v_mul_f32 v226, v226, v54
    v_mul_f32 v227, v227, v54
    v_accvgpr_write_b32 a72, v224
    v_accvgpr_write_b32 a73, v225
    v_accvgpr_write_b32 a74, v226
    v_accvgpr_write_b32 a75, v227
    v_accvgpr_read_b32 v224, a76
    v_accvgpr_read_b32 v225, a77
    v_accvgpr_read_b32 v226, a78
    v_accvgpr_read_b32 v227, a79
    v_mul_f32 v224, v224, v55
    v_mul_f32 v225, v225, v55
    v_mul_f32 v226, v226, v55
    v_mul_f32 v227, v227, v55
    v_accvgpr_write_b32 a76, v224
    v_accvgpr_write_b32 a77, v225
    v_accvgpr_write_b32 a78, v226
    v_accvgpr_write_b32 a79, v227
    v_accvgpr_read_b32 v224, a88
    v_accvgpr_read_b32 v225, a89
    v_accvgpr_read_b32 v226, a90
    v_accvgpr_read_b32 v227, a91
    v_mul_f32 v224, v224, v54
    v_mul_f32 v225, v225, v54
    v_mul_f32 v226, v226, v54
    v_mul_f32 v227, v227, v54
    v_accvgpr_write_b32 a88, v224
    v_accvgpr_write_b32 a89, v225
    v_accvgpr_write_b32 a90, v226
    v_accvgpr_write_b32 a91, v227
    v_accvgpr_read_b32 v224, a92
    v_accvgpr_read_b32 v225, a93
    v_accvgpr_read_b32 v226, a94
    v_accvgpr_read_b32 v227, a95
    v_mul_f32 v224, v224, v55
    v_mul_f32 v225, v225, v55
    v_mul_f32 v226, v226, v55
    v_mul_f32 v227, v227, v55
    v_accvgpr_write_b32 a92, v224
    v_accvgpr_write_b32 a93, v225
    v_accvgpr_write_b32 a94, v226
    v_accvgpr_write_b32 a95, v227
    v_accvgpr_read_b32 v224, a104
    v_accvgpr_read_b32 v225, a105
    v_accvgpr_read_b32 v226, a106
    v_accvgpr_read_b32 v227, a107
    v_mul_f32 v224, v224, v54
    v_mul_f32 v225, v225, v54
    v_mul_f32 v226, v226, v54
    v_mul_f32 v227, v227, v54
    v_accvgpr_write_b32 a104, v224
    v_accvgpr_write_b32 a105, v225
    v_accvgpr_write_b32 a106, v226
    v_accvgpr_write_b32 a107, v227
    v_accvgpr_read_b32 v224, a108
    v_accvgpr_read_b32 v225, a109
    v_accvgpr_read_b32 v226, a110
    v_accvgpr_read_b32 v227, a111
    v_mul_f32 v224, v224, v55
    v_mul_f32 v225, v225, v55
    v_mul_f32 v226, v226, v55
    v_mul_f32 v227, v227, v55
    v_accvgpr_write_b32 a108, v224
    v_accvgpr_write_b32 a109, v225
    v_accvgpr_write_b32 a110, v226
    v_accvgpr_write_b32 a111, v227
    v_accvgpr_read_b32 v224, a120
    v_accvgpr_read_b32 v225, a121
    v_accvgpr_read_b32 v226, a122
    v_accvgpr_read_b32 v227, a123
    v_mul_f32 v224, v224, v54
    v_mul_f32 v225, v225, v54
    v_mul_f32 v226, v226, v54
    v_mul_f32 v227, v227, v54
    v_accvgpr_write_b32 a120, v224
    v_accvgpr_write_b32 a121, v225
    v_accvgpr_write_b32 a122, v226
    v_accvgpr_write_b32 a123, v227
    v_accvgpr_read_b32 v224, a124
    v_accvgpr_read_b32 v225, a125
    v_accvgpr_read_b32 v226, a126
    v_accvgpr_read_b32 v227, a127
    v_mul_f32 v224, v224, v55
    v_mul_f32 v225, v225, v55
    v_mul_f32 v226, v226, v55
    v_mul_f32 v227, v227, v55
    v_accvgpr_write_b32 a124, v224
    v_accvgpr_write_b32 a125, v225
    v_accvgpr_write_b32 a126, v226
    v_accvgpr_write_b32 a127, v227
    v_exp_f32 v232, v128
    v_exp_f32 v233, v129
    v_exp_f32 v234, v130
    v_exp_f32 v235, v131
    s_nop 0
    v_cvt_pk_bf16_f32 v192, v232, v233
    v_cvt_pk_bf16_f32 v193, v234, v235
    v_exp_f32 v232, v144
    v_exp_f32 v233, v145
    v_exp_f32 v234, v146
    v_exp_f32 v235, v147
    s_nop 0
    v_cvt_pk_bf16_f32 v194, v232, v233
    v_cvt_pk_bf16_f32 v195, v234, v235
    v_exp_f32 v232, v132
    v_exp_f32 v233, v133
    v_exp_f32 v234, v134
    v_exp_f32 v235, v135
    s_nop 0
    v_cvt_pk_bf16_f32 v196, v232, v233
    v_cvt_pk_bf16_f32 v197, v234, v235
    v_exp_f32 v232, v148
    v_exp_f32 v233, v149
    v_exp_f32 v234, v150
    v_exp_f32 v235, v151
    s_nop 0
    v_cvt_pk_bf16_f32 v198, v232, v233
    v_cvt_pk_bf16_f32 v199, v234, v235
    v_exp_f32 v232, v136
    v_exp_f32 v233, v137
    v_exp_f32 v234, v138
    v_exp_f32 v235, v139
    s_nop 0
    v_cvt_pk_bf16_f32 v200, v232, v233
    v_cvt_pk_bf16_f32 v201, v234, v235
    v_exp_f32 v232, v152
    v_exp_f32 v233, v153
    v_exp_f32 v234, v154
    v_exp_f32 v235, v155
    s_nop 0
    v_cvt_pk_bf16_f32 v202, v232, v233
    v_cvt_pk_bf16_f32 v203, v234, v235
    v_exp_f32 v232, v140
    v_exp_f32 v233, v141
    v_exp_f32 v234, v142
    v_exp_f32 v235, v143
    s_nop 0
    v_cvt_pk_bf16_f32 v204, v232, v233
    v_cvt_pk_bf16_f32 v205, v234, v235
    v_exp_f32 v232, v156
    v_exp_f32 v233, v157
    v_exp_f32 v234, v158
    v_exp_f32 v235, v159
    s_nop 0
    v_cvt_pk_bf16_f32 v206, v232, v233
    v_cvt_pk_bf16_f32 v207, v234, v235
    s_nop 3
    s_setpc_b64 s[40:41]
k2_rare_167:
    s_nop 7
    v_max_f32 v54, v160, v161
    v_max3_f32 v54, v54, v162, v163
    v_max3_f32 v54, v54, v176, v177
    v_max3_f32 v54, v54, v178, v179
    v_max3_f32 v54, v54, v168, v169
    v_max3_f32 v54, v54, v170, v171
    v_max3_f32 v54, v54, v184, v185
    v_max3_f32 v54, v54, v186, v187
    v_max_f32 v55, v164, v165
    v_max3_f32 v55, v55, v166, v167
    v_max3_f32 v55, v55, v180, v181
    v_max3_f32 v55, v55, v182, v183
    v_max3_f32 v55, v55, v172, v173
    v_max3_f32 v55, v55, v174, v175
    v_max3_f32 v55, v55, v188, v189
    v_max3_f32 v55, v55, v190, v191
    v_mov_b32 v226, v54
    v_mov_b32 v227, v55
    s_nop 1
    v_permlane16_swap_b32 v54, v226
    v_permlane16_swap_b32 v55, v227
    s_nop 1
    v_max_f32 v54, v54, v226
    v_max_f32 v55, v55, v227
    v_mov_b32 v226, v54
    v_mov_b32 v227, v55
    s_nop 1
    v_permlane32_swap_b32 v54, v226
    v_permlane32_swap_b32 v55, v227
    s_nop 1
    v_max_f32 v54, v54, v226
    v_max_f32 v55, v55, v227
    v_add_f32 v54, 0x41400000, v54
    v_max_f32 v54, 0, v54
    v_add_f32 v55, 0x41400000, v55
    v_max_f32 v55, 0, v55
    v_sub_f32 v160, v160, v54
    v_sub_f32 v161, v161, v54
    v_sub_f32 v162, v162, v54
    v_sub_f32 v163, v163, v54
    v_sub_f32 v164, v164, v55
    v_sub_f32 v165, v165, v55
    v_sub_f32 v166, v166, v55
    v_sub_f32 v167, v167, v55
    v_sub_f32 v168, v168, v54
    v_sub_f32 v169, v169, v54
    v_sub_f32 v170, v170, v54
    v_sub_f32 v171, v171, v54
    v_sub_f32 v172, v172, v55
    v_sub_f32 v173, v173, v55
    v_sub_f32 v174, v174, v55
    v_sub_f32 v175, v175, v55
    v_sub_f32 v176, v176, v54
    v_sub_f32 v177, v177, v54
    v_sub_f32 v178, v178, v54
    v_sub_f32 v179, v179, v54
    v_sub_f32 v180, v180, v55
    v_sub_f32 v181, v181, v55
    v_sub_f32 v182, v182, v55
    v_sub_f32 v183, v183, v55
    v_sub_f32 v184, v184, v54
    v_sub_f32 v185, v185, v54
    v_sub_f32 v186, v186, v54
    v_sub_f32 v187, v187, v54
    v_sub_f32 v188, v188, v55
    v_sub_f32 v189, v189, v55
    v_sub_f32 v190, v190, v55
    v_sub_f32 v191, v191, v55
    v_sub_f32 v128, v128, v54
    v_sub_f32 v16, v16, v54
    v_sub_f32 v129, v129, v54
    v_sub_f32 v17, v17, v54
    v_sub_f32 v130, v130, v54
    v_sub_f32 v18, v18, v54
    v_sub_f32 v131, v131, v54
    v_sub_f32 v19, v19, v54
    v_sub_f32 v132, v132, v55
    v_sub_f32 v20, v20, v55
    v_sub_f32 v133, v133, v55
    v_sub_f32 v21, v21, v55
    v_sub_f32 v134, v134, v55
    v_sub_f32 v22, v22, v55
    v_sub_f32 v135, v135, v55
    v_sub_f32 v23, v23, v55
    v_sub_f32 v136, v136, v54
    v_sub_f32 v24, v24, v54
    v_sub_f32 v137, v137, v54
    v_sub_f32 v25, v25, v54
    v_sub_f32 v138, v138, v54
    v_sub_f32 v26, v26, v54
    v_sub_f32 v139, v139, v54
    v_sub_f32 v27, v27, v54
    v_sub_f32 v140, v140, v55
    v_sub_f32 v28, v28, v55
    v_sub_f32 v141, v141, v55
    v_sub_f32 v29, v29, v55
    v_sub_f32 v142, v142, v55
    v_sub_f32 v30, v30, v55
    v_sub_f32 v143, v143, v55
    v_sub_f32 v31, v31, v55
    v_sub_f32 v144, v144, v54
    v_sub_f32 v32, v32, v54
    v_sub_f32 v145, v145, v54
    v_sub_f32 v33, v33, v54
    v_sub_f32 v146, v146, v54
    v_sub_f32 v34, v34, v54
    v_sub_f32 v147, v147, v54
    v_sub_f32 v35, v35, v54
    v_sub_f32 v148, v148, v55
    v_sub_f32 v36, v36, v55
    v_sub_f32 v149, v149, v55
    v_sub_f32 v37, v37, v55
    v_sub_f32 v150, v150, v55
    v_sub_f32 v38, v38, v55
    v_sub_f32 v151, v151, v55
    v_sub_f32 v39, v39, v55
    v_sub_f32 v152, v152, v54
    v_sub_f32 v40, v40, v54
    v_sub_f32 v153, v153, v54
    v_sub_f32 v41, v41, v54
    v_sub_f32 v154, v154, v54
    v_sub_f32 v42, v42, v54
    v_sub_f32 v155, v155, v54
    v_sub_f32 v43, v43, v54
    v_sub_f32 v156, v156, v55
    v_sub_f32 v44, v44, v55
    v_sub_f32 v157, v157, v55
    v_sub_f32 v45, v45, v55
    v_sub_f32 v158, v158, v55
    v_sub_f32 v46, v46, v55
    v_sub_f32 v159, v159, v55
    v_sub_f32 v47, v47, v55
    v_sub_f32 v10, v10, v54
    v_exp_f32 v54, -v54
    v_sub_f32 v11, v11, v55
    v_exp_f32 v55, -v55
    s_nop 0
    v_mul_f32 v248, v248, v54
    v_mul_f32 v252, v252, v55
    v_accvgpr_read_b32 v224, a8
    v_accvgpr_read_b32 v225, a9
    v_accvgpr_read_b32 v226, a10
    v_accvgpr_read_b32 v227, a11
    v_mul_f32 v224, v224, v54
    v_mul_f32 v225, v225, v54
    v_mul_f32 v226, v226, v54
    v_mul_f32 v227, v227, v54
    v_accvgpr_write_b32 a8, v224
    v_accvgpr_write_b32 a9, v225
    v_accvgpr_write_b32 a10, v226
    v_accvgpr_write_b32 a11, v227
    v_accvgpr_read_b32 v224, a12
    v_accvgpr_read_b32 v225, a13
    v_accvgpr_read_b32 v226, a14
    v_accvgpr_read_b32 v227, a15
    v_mul_f32 v224, v224, v55
    v_mul_f32 v225, v225, v55
    v_mul_f32 v226, v226, v55
    v_mul_f32 v227, v227, v55
    v_accvgpr_write_b32 a12, v224
    v_accvgpr_write_b32 a13, v225
    v_accvgpr_write_b32 a14, v226
    v_accvgpr_write_b32 a15, v227
    v_accvgpr_read_b32 v224, a24
    v_accvgpr_read_b32 v225, a25
    v_accvgpr_read_b32 v226, a26
    v_accvgpr_read_b32 v227, a27
    v_mul_f32 v224, v224, v54
    v_mul_f32 v225, v225, v54
    v_mul_f32 v226, v226, v54
    v_mul_f32 v227, v227, v54
    v_accvgpr_write_b32 a24, v224
    v_accvgpr_write_b32 a25, v225
    v_accvgpr_write_b32 a26, v226
    v_accvgpr_write_b32 a27, v227
    v_accvgpr_read_b32 v224, a28
    v_accvgpr_read_b32 v225, a29
    v_accvgpr_read_b32 v226, a30
    v_accvgpr_read_b32 v227, a31
    v_mul_f32 v224, v224, v55
    v_mul_f32 v225, v225, v55
    v_mul_f32 v226, v226, v55
    v_mul_f32 v227, v227, v55
    v_accvgpr_write_b32 a28, v224
    v_accvgpr_write_b32 a29, v225
    v_accvgpr_write_b32 a30, v226
    v_accvgpr_write_b32 a31, v227
    v_accvgpr_read_b32 v224, a40
    v_accvgpr_read_b32 v225, a41
    v_accvgpr_read_b32 v226, a42
    v_accvgpr_read_b32 v227, a43
    v_mul_f32 v224, v224, v54
    v_mul_f32 v225, v225, v54
    v_mul_f32 v226, v226, v54
    v_mul_f32 v227, v227, v54
    v_accvgpr_write_b32 a40, v224
    v_accvgpr_write_b32 a41, v225
    v_accvgpr_write_b32 a42, v226
    v_accvgpr_write_b32 a43, v227
    v_accvgpr_read_b32 v224, a44
    v_accvgpr_read_b32 v225, a45
    v_accvgpr_read_b32 v226, a46
    v_accvgpr_read_b32 v227, a47
    v_mul_f32 v224, v224, v55
    v_mul_f32 v225, v225, v55
    v_mul_f32 v226, v226, v55
    v_mul_f32 v227, v227, v55
    v_accvgpr_write_b32 a44, v224
    v_accvgpr_write_b32 a45, v225
    v_accvgpr_write_b32 a46, v226
    v_accvgpr_write_b32 a47, v227
    v_accvgpr_read_b32 v224, a56
    v_accvgpr_read_b32 v225, a57
    v_accvgpr_read_b32 v226, a58
    v_accvgpr_read_b32 v227, a59
    v_mul_f32 v224, v224, v54
    v_mul_f32 v225, v225, v54
    v_mul_f32 v226, v226, v54
    v_mul_f32 v227, v227, v54
    v_accvgpr_write_b32 a56, v224
    v_accvgpr_write_b32 a57, v225
    v_accvgpr_write_b32 a58, v226
    v_accvgpr_write_b32 a59, v227
    v_accvgpr_read_b32 v224, a60
    v_accvgpr_read_b32 v225, a61
    v_accvgpr_read_b32 v226, a62
    v_accvgpr_read_b32 v227, a63
    v_mul_f32 v224, v224, v55
    v_mul_f32 v225, v225, v55
    v_mul_f32 v226, v226, v55
    v_mul_f32 v227, v227, v55
    v_accvgpr_write_b32 a60, v224
    v_accvgpr_write_b32 a61, v225
    v_accvgpr_write_b32 a62, v226
    v_accvgpr_write_b32 a63, v227
    v_accvgpr_read_b32 v224, a72
    v_accvgpr_read_b32 v225, a73
    v_accvgpr_read_b32 v226, a74
    v_accvgpr_read_b32 v227, a75
    v_mul_f32 v224, v224, v54
    v_mul_f32 v225, v225, v54
    v_mul_f32 v226, v226, v54
    v_mul_f32 v227, v227, v54
    v_accvgpr_write_b32 a72, v224
    v_accvgpr_write_b32 a73, v225
    v_accvgpr_write_b32 a74, v226
    v_accvgpr_write_b32 a75, v227
    v_accvgpr_read_b32 v224, a76
    v_accvgpr_read_b32 v225, a77
    v_accvgpr_read_b32 v226, a78
    v_accvgpr_read_b32 v227, a79
    v_mul_f32 v224, v224, v55
    v_mul_f32 v225, v225, v55
    v_mul_f32 v226, v226, v55
    v_mul_f32 v227, v227, v55
    v_accvgpr_write_b32 a76, v224
    v_accvgpr_write_b32 a77, v225
    v_accvgpr_write_b32 a78, v226
    v_accvgpr_write_b32 a79, v227
    v_accvgpr_read_b32 v224, a88
    v_accvgpr_read_b32 v225, a89
    v_accvgpr_read_b32 v226, a90
    v_accvgpr_read_b32 v227, a91
    v_mul_f32 v224, v224, v54
    v_mul_f32 v225, v225, v54
    v_mul_f32 v226, v226, v54
    v_mul_f32 v227, v227, v54
    v_accvgpr_write_b32 a88, v224
    v_accvgpr_write_b32 a89, v225
    v_accvgpr_write_b32 a90, v226
    v_accvgpr_write_b32 a91, v227
    v_accvgpr_read_b32 v224, a92
    v_accvgpr_read_b32 v225, a93
    v_accvgpr_read_b32 v226, a94
    v_accvgpr_read_b32 v227, a95
    v_mul_f32 v224, v224, v55
    v_mul_f32 v225, v225, v55
    v_mul_f32 v226, v226, v55
    v_mul_f32 v227, v227, v55
    v_accvgpr_write_b32 a92, v224
    v_accvgpr_write_b32 a93, v225
    v_accvgpr_write_b32 a94, v226
    v_accvgpr_write_b32 a95, v227
    v_accvgpr_read_b32 v224, a104
    v_accvgpr_read_b32 v225, a105
    v_accvgpr_read_b32 v226, a106
    v_accvgpr_read_b32 v227, a107
    v_mul_f32 v224, v224, v54
    v_mul_f32 v225, v225, v54
    v_mul_f32 v226, v226, v54
    v_mul_f32 v227, v227, v54
    v_accvgpr_write_b32 a104, v224
    v_accvgpr_write_b32 a105, v225
    v_accvgpr_write_b32 a106, v226
    v_accvgpr_write_b32 a107, v227
    v_accvgpr_read_b32 v224, a108
    v_accvgpr_read_b32 v225, a109
    v_accvgpr_read_b32 v226, a110
    v_accvgpr_read_b32 v227, a111
    v_mul_f32 v224, v224, v55
    v_mul_f32 v225, v225, v55
    v_mul_f32 v226, v226, v55
    v_mul_f32 v227, v227, v55
    v_accvgpr_write_b32 a108, v224
    v_accvgpr_write_b32 a109, v225
    v_accvgpr_write_b32 a110, v226
    v_accvgpr_write_b32 a111, v227
    v_accvgpr_read_b32 v224, a120
    v_accvgpr_read_b32 v225, a121
    v_accvgpr_read_b32 v226, a122
    v_accvgpr_read_b32 v227, a123
    v_mul_f32 v224, v224, v54
    v_mul_f32 v225, v225, v54
    v_mul_f32 v226, v226, v54
    v_mul_f32 v227, v227, v54
    v_accvgpr_write_b32 a120, v224
    v_accvgpr_write_b32 a121, v225
    v_accvgpr_write_b32 a122, v226
    v_accvgpr_write_b32 a123, v227
    v_accvgpr_read_b32 v224, a124
    v_accvgpr_read_b32 v225, a125
    v_accvgpr_read_b32 v226, a126
    v_accvgpr_read_b32 v227, a127
    v_mul_f32 v224, v224, v55
    v_mul_f32 v225, v225, v55
    v_mul_f32 v226, v226, v55
    v_mul_f32 v227, v227, v55
    v_accvgpr_write_b32 a124, v224
    v_accvgpr_write_b32 a125, v225
    v_accvgpr_write_b32 a126, v226
    v_accvgpr_write_b32 a127, v227
    v_exp_f32 v232, v160
    v_exp_f32 v233, v161
    v_exp_f32 v234, v162
    v_exp_f32 v235, v163
    s_nop 0
    v_cvt_pk_bf16_f32 v208, v232, v233
    v_cvt_pk_bf16_f32 v209, v234, v235
    v_exp_f32 v232, v176
    v_exp_f32 v233, v177
    v_exp_f32 v234, v178
    v_exp_f32 v235, v179
    s_nop 0
    v_cvt_pk_bf16_f32 v210, v232, v233
    v_cvt_pk_bf16_f32 v211, v234, v235
    v_exp_f32 v232, v164
    v_exp_f32 v233, v165
    v_exp_f32 v234, v166
    v_exp_f32 v235, v167
    s_nop 0
    v_cvt_pk_bf16_f32 v212, v232, v233
    v_cvt_pk_bf16_f32 v213, v234, v235
    v_exp_f32 v232, v180
    v_exp_f32 v233, v181
    v_exp_f32 v234, v182
    v_exp_f32 v235, v183
    s_nop 0
    v_cvt_pk_bf16_f32 v214, v232, v233
    v_cvt_pk_bf16_f32 v215, v234, v235
    v_exp_f32 v232, v168
    v_exp_f32 v233, v169
    v_exp_f32 v234, v170
    v_exp_f32 v235, v171
    s_nop 0
    v_cvt_pk_bf16_f32 v216, v232, v233
    v_cvt_pk_bf16_f32 v217, v234, v235
    v_exp_f32 v232, v184
    v_exp_f32 v233, v185
    v_exp_f32 v234, v186
    v_exp_f32 v235, v187
    s_nop 0
    v_cvt_pk_bf16_f32 v218, v232, v233
    v_cvt_pk_bf16_f32 v219, v234, v235
    v_exp_f32 v232, v172
    v_exp_f32 v233, v173
    v_exp_f32 v234, v174
    v_exp_f32 v235, v175
    s_nop 0
    v_cvt_pk_bf16_f32 v220, v232, v233
    v_cvt_pk_bf16_f32 v221, v234, v235
    v_exp_f32 v232, v188
    v_exp_f32 v233, v189
    v_exp_f32 v234, v190
    v_exp_f32 v235, v191
    s_nop 0
    v_cvt_pk_bf16_f32 v222, v232, v233
    v_cvt_pk_bf16_f32 v223, v234, v235
    s_nop 3
    s_setpc_b64 s[40:41]
k2_rare_171:
    s_nop 7
    v_max_f32 v55, v164, v165
    v_max3_f32 v55, v55, v166, v167
    v_max3_f32 v55, v55, v180, v181
    v_max3_f32 v55, v55, v182, v183
    v_max3_f32 v55, v55, v172, v173
    v_max3_f32 v55, v55, v174, v175
    v_max3_f32 v55, v55, v188, v189
    v_max3_f32 v55, v55, v190, v191
    v_mov_b32 v227, v55
    s_nop 1
    v_permlane16_swap_b32 v55, v227
    s_nop 1
    v_max_f32 v55, v55, v227
    v_mov_b32 v227, v55
    s_nop 1
    v_permlane32_swap_b32 v55, v227
    s_nop 1
    v_max_f32 v55, v55, v227
    v_add_f32 v55, 0x41400000, v55
    v_max_f32 v55, 0, v55
    v_sub_f32 v164, v164, v55
    v_sub_f32 v165, v165, v55
    v_sub_f32 v166, v166, v55
    v_sub_f32 v167, v167, v55
    v_sub_f32 v172, v172, v55
    v_sub_f32 v173, v173, v55
    v_sub_f32 v174, v174, v55
    v_sub_f32 v175, v175, v55
    v_sub_f32 v180, v180, v55
    v_sub_f32 v181, v181, v55
    v_sub_f32 v182, v182, v55
    v_sub_f32 v183, v183, v55
    v_sub_f32 v188, v188, v55
    v_sub_f32 v189, v189, v55
    v_sub_f32 v190, v190, v55
    v_sub_f32 v191, v191, v55
    v_sub_f32 v11, v11, v55
    v_exp_f32 v55, -v55
    s_nop 0
    v_mul_f32 v252, v252, v55
    v_accvgpr_read_b32 v224, a12
    v_accvgpr_read_b32 v225, a13
    v_accvgpr_read_b32 v226, a14
    v_accvgpr_read_b32 v227, a15
    v_mul_f32 v224, v224, v55
    v_mul_f32 v225, v225, v55
    v_mul_f32 v226, v226, v55
    v_mul_f32 v227, v227, v55
    v_accvgpr_write_b32 a12, v224
    v_accvgpr_write_b32 a13, v225
    v_accvgpr_write_b32 a14, v226
    v_accvgpr_write_b32 a15, v227
    v_accvgpr_read_b32 v224, a28
    v_accvgpr_read_b32 v225, a29
    v_accvgpr_read_b32 v226, a30
    v_accvgpr_read_b32 v227, a31
    v_mul_f32 v224, v224, v55
    v_mul_f32 v225, v225, v55
    v_mul_f32 v226, v226, v55
    v_mul_f32 v227, v227, v55
    v_accvgpr_write_b32 a28, v224
    v_accvgpr_write_b32 a29, v225
    v_accvgpr_write_b32 a30, v226
    v_accvgpr_write_b32 a31, v227
    v_accvgpr_read_b32 v224, a44
    v_accvgpr_read_b32 v225, a45
    v_accvgpr_read_b32 v226, a46
    v_accvgpr_read_b32 v227, a47
    v_mul_f32 v224, v224, v55
    v_mul_f32 v225, v225, v55
    v_mul_f32 v226, v226, v55
    v_mul_f32 v227, v227, v55
    v_accvgpr_write_b32 a44, v224
    v_accvgpr_write_b32 a45, v225
    v_accvgpr_write_b32 a46, v226
    v_accvgpr_write_b32 a47, v227
    v_accvgpr_read_b32 v224, a60
    v_accvgpr_read_b32 v225, a61
    v_accvgpr_read_b32 v226, a62
    v_accvgpr_read_b32 v227, a63
    v_mul_f32 v224, v224, v55
    v_mul_f32 v225, v225, v55
    v_mul_f32 v226, v226, v55
    v_mul_f32 v227, v227, v55
    v_accvgpr_write_b32 a60, v224
    v_accvgpr_write_b32 a61, v225
    v_accvgpr_write_b32 a62, v226
    v_accvgpr_write_b32 a63, v227
    v_accvgpr_read_b32 v224, a76
    v_accvgpr_read_b32 v225, a77
    v_accvgpr_read_b32 v226, a78
    v_accvgpr_read_b32 v227, a79
    v_mul_f32 v224, v224, v55
    v_mul_f32 v225, v225, v55
    v_mul_f32 v226, v226, v55
    v_mul_f32 v227, v227, v55
    v_accvgpr_write_b32 a76, v224
    v_accvgpr_write_b32 a77, v225
    v_accvgpr_write_b32 a78, v226
    v_accvgpr_write_b32 a79, v227
    v_accvgpr_read_b32 v224, a92
    v_accvgpr_read_b32 v225, a93
    v_accvgpr_read_b32 v226, a94
    v_accvgpr_read_b32 v227, a95
    v_mul_f32 v224, v224, v55
    v_mul_f32 v225, v225, v55
    v_mul_f32 v226, v226, v55
    v_mul_f32 v227, v227, v55
    v_accvgpr_write_b32 a92, v224
    v_accvgpr_write_b32 a93, v225
    v_accvgpr_write_b32 a94, v226
    v_accvgpr_write_b32 a95, v227
    v_accvgpr_read_b32 v224, a108
    v_accvgpr_read_b32 v225, a109
    v_accvgpr_read_b32 v226, a110
    v_accvgpr_read_b32 v227, a111
    v_mul_f32 v224, v224, v55
    v_mul_f32 v225, v225, v55
    v_mul_f32 v226, v226, v55
    v_mul_f32 v227, v227, v55
    v_accvgpr_write_b32 a108, v224
    v_accvgpr_write_b32 a109, v225
    v_accvgpr_write_b32 a110, v226
    v_accvgpr_write_b32 a111, v227
    v_accvgpr_read_b32 v224, a124
    v_accvgpr_read_b32 v225, a125
    v_accvgpr_read_b32 v226, a126
    v_accvgpr_read_b32 v227, a127
    v_mul_f32 v224, v224, v55
    v_mul_f32 v225, v225, v55
    v_mul_f32 v226, v226, v55
    v_mul_f32 v227, v227, v55
    v_accvgpr_write_b32 a124, v224
    v_accvgpr_write_b32 a125, v225
    v_accvgpr_write_b32 a126, v226
    v_accvgpr_write_b32 a127, v227
    v_exp_f32 v232, v164
    v_exp_f32 v233, v165
    v_exp_f32 v234, v166
    v_exp_f32 v235, v167
    s_nop 0
    v_cvt_pk_bf16_f32 v212, v232, v233
    v_cvt_pk_bf16_f32 v213, v234, v235
    v_exp_f32 v232, v180
    v_exp_f32 v233, v181
    v_exp_f32 v234, v182
    v_exp_f32 v235, v183
    s_nop 0
    v_cvt_pk_bf16_f32 v214, v232, v233
    v_cvt_pk_bf16_f32 v215, v234, v235
    v_exp_f32 v232, v172
    v_exp_f32 v233, v173
    v_exp_f32 v234, v174
    v_exp_f32 v235, v175
    s_nop 0
    v_cvt_pk_bf16_f32 v220, v232, v233
    v_cvt_pk_bf16_f32 v221, v234, v235
    v_exp_f32 v232, v188
    v_exp_f32 v233, v189
    v_exp_f32 v234, v190
    v_exp_f32 v235, v191
    s_nop 0
    v_cvt_pk_bf16_f32 v222, v232, v233
    v_cvt_pk_bf16_f32 v223, v234, v235
    s_nop 3
    s_setpc_b64 s[40:41]
code_end:
    s_endpgm
.section .rodata,"a"
.p2align 6
.amdhsa_kernel sequential_preLN__compressed_kv_cla__moe_arch_mod__prompt_kernel
  .amdhsa_next_free_vgpr 512
  .amdhsa_next_free_sgpr 102
  .amdhsa_accum_offset 256
  .amdhsa_group_segment_fixed_size 0
  .amdhsa_kernarg_size 112
  .amdhsa_user_sgpr_count 2
  .amdhsa_user_sgpr_kernarg_segment_ptr 1
  .amdhsa_system_sgpr_workgroup_id_x 1
.end_amdhsa_kernel
```

```asm
; @launch grid=(256,1,1) block=(256,1,1) lds=163840
.amdgcn_target "amdgcn-amd-amdhsa--gfx950"
.text
.globl sequential_preLN__compressed_kv_cla__moe_arch_mod__prompt_kernel
.p2align 8
.type sequential_preLN__compressed_kv_cla__moe_arch_mod__prompt_kernel,@function
sequential_preLN__compressed_kv_cla__moe_arch_mod__prompt_kernel:
    s_cmp_ge_u32 s2, 256
    s_cbranch_scc1 k12_end_1
    s_load_dwordx4 s[36:39], s[0:1], 0
    s_load_dwordx4 s[40:43], s[0:1], 24
    s_load_dwordx2 s[4:5], s[0:1], 16
    s_load_dwordx4 s[60:63], s[0:1], 96
    s_lshr_b32 s59, s2, 3
    s_lshl_b32 s58, s59, 4
    v_add_u32 v6, s58, v0
    v_cmp_gt_u32 vcc, 48, v0
    v_cmp_gt_u32 s[56:57], 64, v0
    s_nop 0
    v_cndmask_b32 v6, v6, v0, vcc
    s_getpc_b64 s[52:53]
pc_2:
    s_add_u32 s52, s52, k12_code0-pc_2
    s_addc_u32 s53, s53, 0
    v_lshlrev_b32 v58, 7, v6
    v_mov_b32 v59, s53
    v_add_co_u32 v58, vcc, s52, v58
    s_nop 1
    v_addc_co_u32 v59, vcc, 0, v59, vcc
k12_code0:
    s_mov_b64 exec, s[56:57]
    s_cbranch_execz k12_nocode_3
    global_load_dword v51, v[58:59], off
k12_nocode_3:
    s_mov_b64 exec, -1
    s_and_b32 s58, s2, 7
    s_lshr_b32 s59, s2, 3
    s_and_b32 s45, s59, 7
    s_lshr_b32 s57, s59, 3
    s_and_b32 s44, s57, 1
    s_lshl_b32 s52, s58, 1
    s_add_u32 s44, s44, s52
    s_lshr_b32 s57, s57, 1
    v_lshrrev_b32 v2, 6, v0
    v_and_b32 v3, 63, v0
    v_readfirstlane_b32 s30, v2
    v_lshlrev_b32 v1, 4, v3
    v_lshrrev_b32 v60, 5, v3
    v_lshl_add_u32 v60, v2, 1, v60
    v_and_b32 v61, 31, v3
    v_lshlrev_b32 v6, 11, v60
    v_lshl_add_u32 v62, v61, 4, v6
    s_lshl_b32 s52, s2, 14
    v_lshrrev_b32 v56, 3, v3
    v_and_b32 v57, 7, v3
    v_lshrrev_b32 v58, 1, v56
    v_xor_b32 v6, v57, v58
    v_xor_b32 v7, 4, v6
    v_lshl_add_u32 v58, v2, 6, v56
    v_lshlrev_b32 v58, 10, v58
    s_lshl_b32 s47, s45, 18
    v_add_u32 v58, s47, v58
    v_lshl_add_u32 v10, v6, 4, v58
    v_lshl_add_u32 v11, v7, 4, v58
    v_add_u32 v17, 54272, v11
    v_add_u32 v16, 47104, v10
    v_add_u32 v15, 39936, v11
    v_add_u32 v14, 32768, v10
    v_add_u32 v13, 21504, v11
    v_add_u32 v12, 14336, v10
    v_add_u32 v11, 7168, v11
    v_add_u32 v10, 0, v10
    s_lshl_b32 s48, s30, 13
    s_mov_b32 s49, 0
    s_mov_b32 s50, 0
    s_waitcnt lgkmcnt(0)
    s_mov_b32 s24, s36
    s_and_b32 s25, s37, 0xffff
    s_mov_b32 s26, 0x400000
    s_mov_b32 s27, 0x00020000
    s_mov_b32 s16, s38
    s_and_b32 s17, s39, 0xffff
    s_mov_b32 s18, 0x200000
    s_mov_b32 s19, 0x00020000
    s_cmp_eq_u32 s57, 0
    s_cselect_b32 s20, s40, s42
    s_cselect_b32 s21, s41, s43
    s_and_b32 s21, s21, 0xffff
    s_mov_b32 s22, 0x400000
    s_mov_b32 s23, 0x00020000
    v_lshlrev_b32 v6, 17, v1
    s_mov_b64 exec, 1
    buffer_load_dword v51, v62, s[24:27], s52 offen
    global_load_dword v51, v6, s[60:61]
    buffer_load_dword v51, v6, s[20:23], 0 offen
    global_load_dword v51, v6, s[62:63]
    global_load_dword v51, v6, s[4:5]
    s_mov_b64 exec, -1
    s_add_u32 m0, s48, 0
    s_nop 0
    buffer_load_dwordx4 v10, s[16:19], s49 offen offset:0 lds
    buffer_load_dwordx4 v11, s[16:19], s49 offen offset:1024 lds
    buffer_load_dwordx4 v12, s[16:19], s49 offen offset:2048 lds
    buffer_load_dwordx4 v13, s[16:19], s49 offen offset:3072 lds
    buffer_load_dwordx4 v[64:67], v62, s[24:27], s52 offen offset:0
    buffer_load_dwordx4 v[68:71], v62, s[24:27], s52 offen offset:512
    buffer_load_dwordx4 v[72:75], v62, s[24:27], s52 offen offset:1024
    buffer_load_dwordx4 v[76:79], v62, s[24:27], s52 offen offset:1536
    v_lshrrev_b32 v6, 5, v3
    v_bfe_u32 v7, v3, 1, 4
    v_and_b32 v59, 1, v3
    v_lshl_add_u32 v58, v2, 4, v6
    v_lshlrev_b32 v58, 13, v58
    v_lshl_add_u32 v58, v59, 4, v58
    s_lshl_b32 s47, s44, 9
    v_add_u32 v58, s47, v58
    v_xor_b32 v7, v7, v6
    v_xor_b32 v6, 0, v7
    v_lshl_add_u32 v6, v6, 5, v58
    v_add_u32 v18, 0, v6
    v_xor_b32 v6, 2, v7
    v_lshl_add_u32 v6, v6, 5, v58
    v_add_u32 v19, 15360, v6
    v_xor_b32 v6, 0, v7
    v_lshl_add_u32 v6, v6, 5, v58
    v_add_u32 v20, 30720, v6
    v_xor_b32 v6, 2, v7
    v_lshl_add_u32 v6, v6, 5, v58
    v_add_u32 v21, 46080, v6
    v_xor_b32 v6, 4, v7
    v_lshl_add_u32 v6, v6, 5, v58
    v_add_u32 v22, 65536, v6
    v_xor_b32 v6, 6, v7
    v_lshl_add_u32 v6, v6, 5, v58
    v_add_u32 v23, 80896, v6
    v_xor_b32 v6, 4, v7
    v_lshl_add_u32 v6, v6, 5, v58
    v_add_u32 v24, 96256, v6
    v_xor_b32 v6, 6, v7
    v_lshl_add_u32 v6, v6, 5, v58
    v_add_u32 v25, 111616, v6
    s_add_u32 m0, s48, 65536
    s_nop 0
    buffer_load_dwordx4 v18, s[20:23], s50 offen offset:0 lds
    buffer_load_dwordx4 v19, s[20:23], s50 offen offset:1024 lds
    buffer_load_dwordx4 v20, s[20:23], s50 offen offset:2048 lds
    buffer_load_dwordx4 v21, s[20:23], s50 offen offset:3072 lds
    s_mov_b64 s[6:7], s[62:63]
    s_add_u32 s8, s6, 0x0
    s_addc_u32 s9, s7, 0
    s_and_b32 s9, s9, 0xffff
    s_mov_b32 s10, 0x400000
    s_mov_b32 s11, 0x00020000
    s_mov_b32 s12, s4
    s_and_b32 s13, s5, 0xffff
    s_mov_b32 s14, 0x800000
    s_mov_b32 s15, 0x00020000
    s_add_u32 s32, s6, 0x1000000
    s_addc_u32 s33, s7, 0
    s_and_b32 s33, s33, 0xffff
    s_mov_b32 s34, 0x2000000
    s_mov_b32 s35, 0x00020000
    s_mov_b32 s24, s60
    s_and_b32 s25, s61, 0xffff
    s_mov_b32 s26, 0x100
    s_mov_b32 s27, 0x00020000
    s_lshl_b32 s28, s58, 2
    s_and_b32 s31, s59, 3
    s_add_u32 s28, s28, s31
    s_lshr_b32 s29, s59, 2
    s_lshl_b32 s42, s29, 7
    s_sub_u32 s43, 1920, s42
    s_lshl_b32 s31, s30, 4
    s_add_u32 s38, s42, s31
    s_add_u32 s39, s43, s31
    s_lshl_b32 s60, s30, 12
    s_mov_b32 s61, 0
    s_mov_b32 s62, 0
    s_lshl_b32 s47, s44, 1
    s_lshr_b32 s52, s30, 1
    s_add_u32 s47, s47, s52
    s_lshl_b32 s47, s47, 14
    s_lshl_b32 s52, s45, 1
    s_and_b32 s53, s30, 1
    s_add_u32 s52, s52, s53
    s_lshl_b32 s52, s52, 20
    s_add_u32 s47, s47, s52
    s_lshl_b32 s52, s57, 24
    s_add_u32 s47, s47, s52
    s_lshl_b32 s54, s44, 8
    s_lshr_b32 s55, s28, 1
    s_lshl_b32 s55, s55, 8
    s_and_b32 s53, s59, 3
    s_add_u32 s53, s53, 1
    s_cmp_eq_u32 s30, 0
    s_cselect_b32 s53, s53, -1
    s_cselect_b32 s46, 6, -1
    v_lshlrev_b32 v6, 13, v56
    v_lshl_add_u32 v50, v57, 7, v6
    s_lshl_b32 s56, s30, 5
    s_add_u32 s56, s56, s59
    s_lshl_b32 s56, s56, 16
    s_lshl_b32 s52, s58, 10
    s_add_u32 s56, s56, s52
    s_add_u32 s63, s30, 1
    v_mul_u32_u24 v6, 2064, v60
    v_lshl_add_u32 v6, v61, 4, v6
    v_add_u32 v54, 131072, v6
    v_mul_u32_u24 v7, 2064, v57
    v_lshl_add_u32 v7, v56, 4, v7
    v_lshl_add_u32 v7, v2, 9, v7
    v_add_u32 v55, 131072, v7
    v_lshrrev_b32 v7, 2, v56
    v_lshl_add_u32 v7, v2, 3, v7
    v_lshlrev_b32 v7, 17, v7
    v_and_b32 v6, 3, v56
    v_lshl_add_u32 v7, v6, 8, v7
    v_lshl_add_u32 v7, v57, 4, v7
    s_lshr_b32 s52, s2, 1
    s_lshl_b32 s52, s52, 10
    s_and_b32 s31, s2, 1
    s_lshl_b32 s31, s31, 7
    s_add_u32 s52, s52, s31
    v_add_u32 v53, s52, v7
    v_and_b32 v56, 15, v3
    v_lshrrev_b32 v57, 4, v3
    v_lshrrev_b32 v6, 1, v56
    v_xor_b32 v6, v6, v57
    v_and_b32 v7, 1, v2
    v_lshl_add_u32 v7, v7, 7, v56
    v_lshlrev_b32 v7, 7, v7
    v_lshl_add_u32 v26, v6, 4, v7
    v_xor_b32 v27, 64, v26
    v_lshrrev_b32 v6, 2, v56
    v_and_b32 v58, 1, v57
    v_lshl_add_u32 v58, v58, 2, v6
    v_lshl_add_u32 v59, v57, 3, v6
    v_and_b32 v63, 3, v3
    v_lshlrev_b32 v7, 9, v59
    v_lshrrev_b32 v6, 1, v2
    v_lshl_add_u32 v7, v6, 8, v7
    v_lshl_add_u32 v7, v63, 3, v7
    v_add_u32 v7, 65536, v7
    v_lshlrev_b32 v59, 8, v59
    v_lshl_add_u32 v59, v63, 3, v59
    v_add_u32 v59, 98304, v59
    v_xor_b32 v6, 0, v58
    v_lshl_add_u32 v28, v6, 5, v7
    v_lshl_add_u32 v42, v6, 5, v59
    v_xor_b32 v6, 1, v58
    v_lshl_add_u32 v29, v6, 5, v7
    v_lshl_add_u32 v43, v6, 5, v59
    v_xor_b32 v6, 2, v58
    v_lshl_add_u32 v30, v6, 5, v7
    v_lshl_add_u32 v44, v6, 5, v59
    v_xor_b32 v6, 3, v58
    v_lshl_add_u32 v31, v6, 5, v7
    v_lshl_add_u32 v45, v6, 5, v59
    v_xor_b32 v6, 4, v58
    v_lshl_add_u32 v32, v6, 5, v7
    v_lshl_add_u32 v46, v6, 5, v59
    v_xor_b32 v6, 5, v58
    v_lshl_add_u32 v33, v6, 5, v7
    v_lshl_add_u32 v47, v6, 5, v59
    v_xor_b32 v6, 6, v58
    v_lshl_add_u32 v34, v6, 5, v7
    v_lshl_add_u32 v48, v6, 5, v59
    v_xor_b32 v6, 7, v58
    v_lshl_add_u32 v35, v6, 5, v7
    v_lshl_add_u32 v49, v6, 5, v59
    s_lshl_b32 s31, s38, 6
    v_add_u32 v36, s31, v1
    s_lshl_b32 s31, s39, 6
    v_add_u32 v37, s31, v1
    v_bfe_u32 v6, v3, 1, 3
    v_and_b32 v7, 1, v3
    v_lshl_add_u32 v58, v2, 4, v57
    v_lshlrev_b32 v58, 13, v58
    v_lshl_add_u32 v58, v7, 4, v58
    s_lshl_b32 s31, s28, 8
    v_add_u32 v58, s31, v58
    v_xor_b32 v6, v6, v57
    v_xor_b32 v7, 0, v6
    v_lshl_add_u32 v7, v7, 5, v58
    v_add_u32 v38, 0, v7
    v_xor_b32 v7, 0, v6
    v_lshl_add_u32 v7, v7, 5, v58
    v_add_u32 v39, 31744, v7
    v_xor_b32 v7, 4, v6
    v_lshl_add_u32 v7, v7, 5, v58
    v_add_u32 v40, 63488, v7
    v_xor_b32 v7, 4, v6
    v_lshl_add_u32 v7, v7, 5, v58
    v_add_u32 v41, 95232, v7
    v_lshlrev_b32 v6, 2, v57
    v_sub_u32 v4, v56, v6
    v_mov_b32 v5, 0xff800000
    v_mov_b32 v8, 0
    v_mov_b32 v9, 1
    s_lshl_b32 s52, s59, 2
    s_add_u32 s52, s52, s30
    v_and_b32 v6, 1, v3
    v_lshl_add_u32 v6, s52, 1, v6
    s_getpc_b64 s[40:41]
pc_4:
    s_add_u32 s40, s40, k12_qcode-pc_4
    s_addc_u32 s41, s41, 0
    v_lshlrev_b32 v2, 7, v6
    v_mov_b32 v3, s41
    v_add_co_u32 v2, vcc, s40, v2
    s_nop 1
    v_addc_co_u32 v3, vcc, 0, v3, vcc
    v_mov_b32 v56, 0
    v_mov_b32 v57, 0
    v_mov_b32 v58, 0
    v_mov_b32 v59, 0
    s_nop 1
    v_mfma_f32_32x32x16_bf16 a[128:143], v[56:59], v[56:59], 0
    v_mfma_f32_32x32x16_bf16 a[144:159], v[56:59], v[56:59], 0
    v_mfma_f32_32x32x16_bf16 a[160:175], v[56:59], v[56:59], 0
    v_mfma_f32_32x32x16_bf16 a[176:191], v[56:59], v[56:59], 0
    v_mfma_f32_32x32x16_bf16 v[128:143], v[56:59], v[56:59], 0
    v_mfma_f32_32x32x16_bf16 v[144:159], v[56:59], v[56:59], 0
    v_mfma_f32_32x32x16_bf16 v[160:175], v[56:59], v[56:59], 0
    v_mfma_f32_32x32x16_bf16 v[176:191], v[56:59], v[56:59], 0
    v_mfma_f32_32x32x16_bf16 v[192:207], v[56:59], v[56:59], 0
    v_mfma_f32_32x32x16_bf16 v[208:223], v[56:59], v[56:59], 0
    v_mfma_f32_32x32x16_bf16 v[224:239], v[56:59], v[56:59], 0
    v_mfma_f32_32x32x16_bf16 v[240:255], v[56:59], v[56:59], 0
    s_add_u32 m0, s48, 4096
    s_nop 0
    buffer_load_dwordx4 v14, s[16:19], s49 offen offset:0 lds
    buffer_load_dwordx4 v15, s[16:19], s49 offen offset:1024 lds
    buffer_load_dwordx4 v16, s[16:19], s49 offen offset:2048 lds
    buffer_load_dwordx4 v17, s[16:19], s49 offen offset:3072 lds
    s_add_u32 s49, s49, 128
    s_add_u32 m0, s48, 69632
    s_nop 0
    buffer_load_dwordx4 v22, s[20:23], s50 offen offset:0 lds
    buffer_load_dwordx4 v23, s[20:23], s50 offen offset:1024 lds
    buffer_load_dwordx4 v24, s[20:23], s50 offen offset:2048 lds
    buffer_load_dwordx4 v25, s[20:23], s50 offen offset:3072 lds
    s_add_u32 s50, s50, 0x80000
    s_waitcnt vmcnt(12)
    v_lshlrev_b32 v80, 16, v64
    v_and_b32 v81, 0xffff0000, v64
    v_lshlrev_b32 v82, 16, v65
    v_and_b32 v83, 0xffff0000, v65
    v_lshlrev_b32 v84, 16, v66
    v_and_b32 v85, 0xffff0000, v66
    v_lshlrev_b32 v86, 16, v67
    v_and_b32 v87, 0xffff0000, v67
    v_lshlrev_b32 v88, 16, v68
    v_and_b32 v89, 0xffff0000, v68
    v_lshlrev_b32 v90, 16, v69
    v_and_b32 v91, 0xffff0000, v69
    v_lshlrev_b32 v92, 16, v70
    v_and_b32 v93, 0xffff0000, v70
    v_lshlrev_b32 v94, 16, v71
    v_and_b32 v95, 0xffff0000, v71
    v_lshlrev_b32 v96, 16, v72
    v_and_b32 v97, 0xffff0000, v72
    v_lshlrev_b32 v98, 16, v73
    v_and_b32 v99, 0xffff0000, v73
    v_lshlrev_b32 v100, 16, v74
    v_and_b32 v101, 0xffff0000, v74
    v_lshlrev_b32 v102, 16, v75
    v_and_b32 v103, 0xffff0000, v75
    v_lshlrev_b32 v104, 16, v76
    v_and_b32 v105, 0xffff0000, v76
    v_lshlrev_b32 v106, 16, v77
    v_and_b32 v107, 0xffff0000, v77
    v_lshlrev_b32 v108, 16, v78
    v_and_b32 v109, 0xffff0000, v78
    v_lshlrev_b32 v110, 16, v79
    v_and_b32 v111, 0xffff0000, v79
    v_pk_add_f32 v[112:113], v[80:81], v[82:83]
    v_pk_add_f32 v[114:115], v[84:85], v[86:87]
    v_pk_add_f32 v[112:113], v[112:113], v[88:89]
    v_pk_add_f32 v[114:115], v[114:115], v[90:91]
    v_pk_add_f32 v[112:113], v[112:113], v[92:93]
    v_pk_add_f32 v[114:115], v[114:115], v[94:95]
    v_pk_add_f32 v[112:113], v[112:113], v[96:97]
    v_pk_add_f32 v[114:115], v[114:115], v[98:99]
    v_pk_add_f32 v[112:113], v[112:113], v[100:101]
    v_pk_add_f32 v[114:115], v[114:115], v[102:103]
    v_pk_add_f32 v[112:113], v[112:113], v[104:105]
    v_pk_add_f32 v[114:115], v[114:115], v[106:107]
    s_add_u32 m0, s48, 32768
    s_nop 0
    buffer_load_dwordx4 v10, s[16:19], s49 offen offset:0 lds
    buffer_load_dwordx4 v11, s[16:19], s49 offen offset:1024 lds
    buffer_load_dwordx4 v12, s[16:19], s49 offen offset:2048 lds
    buffer_load_dwordx4 v13, s[16:19], s49 offen offset:3072 lds
    v_pk_add_f32 v[112:113], v[112:113], v[108:109]
    v_pk_add_f32 v[114:115], v[114:115], v[110:111]
    v_pk_add_f32 v[112:113], v[112:113], v[114:115]
    v_add_f32 v112, v112, v113
    s_nop 1
    v_add_f32_dpp v112, v112, v112 quad_perm:[1,0,3,2] row_mask:0xf bank_mask:0xf
    s_nop 1
    v_add_f32_dpp v112, v112, v112 quad_perm:[2,3,0,1] row_mask:0xf bank_mask:0xf
    s_nop 1
    v_add_f32_dpp v112, v112, v112 row_half_mirror row_mask:0xf bank_mask:0xf
    s_nop 1
    v_add_f32_dpp v112, v112, v112 row_mirror row_mask:0xf bank_mask:0xf
    v_mov_b32 v114, v112
    s_nop 1
    v_permlane16_swap_b32 v112, v114
    s_nop 1
    v_add_f32 v112, v112, v114
    v_mul_f32 v112, 0xba800000, v112
    v_mov_b32 v113, v112
    v_pk_add_f32 v[114:115], v[80:81], v[112:113]
    v_pk_add_f32 v[118:119], v[82:83], v[112:113]
    v_pk_mul_f32 v[116:117], v[114:115], v[114:115]
    v_pk_fma_f32 v[116:117], v[118:119], v[118:119], v[116:117]
    v_pk_add_f32 v[114:115], v[84:85], v[112:113]
    v_pk_add_f32 v[118:119], v[86:87], v[112:113]
    v_pk_fma_f32 v[116:117], v[114:115], v[114:115], v[116:117]
    v_pk_fma_f32 v[116:117], v[118:119], v[118:119], v[116:117]
    v_pk_add_f32 v[114:115], v[88:89], v[112:113]
    v_pk_add_f32 v[118:119], v[90:91], v[112:113]
    v_pk_fma_f32 v[116:117], v[114:115], v[114:115], v[116:117]
    v_pk_fma_f32 v[116:117], v[118:119], v[118:119], v[116:117]
    v_pk_add_f32 v[114:115], v[92:93], v[112:113]
    v_pk_add_f32 v[118:119], v[94:95], v[112:113]
    v_pk_fma_f32 v[116:117], v[114:115], v[114:115], v[116:117]
    v_pk_fma_f32 v[116:117], v[118:119], v[118:119], v[116:117]
    v_pk_add_f32 v[114:115], v[96:97], v[112:113]
    v_pk_add_f32 v[118:119], v[98:99], v[112:113]
    v_pk_fma_f32 v[116:117], v[114:115], v[114:115], v[116:117]
    v_pk_fma_f32 v[116:117], v[118:119], v[118:119], v[116:117]
    v_pk_add_f32 v[114:115], v[100:101], v[112:113]
    v_pk_add_f32 v[118:119], v[102:103], v[112:113]
    v_pk_fma_f32 v[116:117], v[114:115], v[114:115], v[116:117]
    v_pk_fma_f32 v[116:117], v[118:119], v[118:119], v[116:117]
    v_pk_add_f32 v[114:115], v[104:105], v[112:113]
    s_add_u32 m0, s48, 98304
    s_nop 0
    buffer_load_dwordx4 v18, s[20:23], s50 offen offset:0 lds
    buffer_load_dwordx4 v19, s[20:23], s50 offen offset:1024 lds
    buffer_load_dwordx4 v20, s[20:23], s50 offen offset:2048 lds
    buffer_load_dwordx4 v21, s[20:23], s50 offen offset:3072 lds
    v_pk_add_f32 v[118:119], v[106:107], v[112:113]
    v_pk_fma_f32 v[116:117], v[114:115], v[114:115], v[116:117]
    v_pk_fma_f32 v[116:117], v[118:119], v[118:119], v[116:117]
    v_pk_add_f32 v[114:115], v[108:109], v[112:113]
    v_pk_add_f32 v[118:119], v[110:111], v[112:113]
    v_pk_fma_f32 v[116:117], v[114:115], v[114:115], v[116:117]
    v_pk_fma_f32 v[116:117], v[118:119], v[118:119], v[116:117]
    v_add_f32 v116, v116, v117
    s_nop 1
    v_add_f32_dpp v116, v116, v116 quad_perm:[1,0,3,2] row_mask:0xf bank_mask:0xf
    s_nop 1
    v_add_f32_dpp v116, v116, v116 quad_perm:[2,3,0,1] row_mask:0xf bank_mask:0xf
    s_nop 1
    v_add_f32_dpp v116, v116, v116 row_half_mirror row_mask:0xf bank_mask:0xf
    s_nop 1
    v_add_f32_dpp v116, v116, v116 row_mirror row_mask:0xf bank_mask:0xf
    v_mov_b32 v114, v116
    s_nop 1
    v_permlane16_swap_b32 v116, v114
    s_nop 1
    v_add_f32 v116, v116, v114
    v_mul_f32 v116, 0x3a800000, v116
    v_cvt_pk_bf16_f32 v118, v112, v116
    v_and_b32 v116, 0xffff0000, v118
    v_lshlrev_b32 v118, 16, v118
    v_add_f32 v116, 0x3727c5ac, v116
    v_mov_b32 v119, v118
    v_cvt_pk_bf16_f32 v116, v116, v116
    v_and_b32 v116, 0xffff0000, v116
    v_sqrt_f32 v116, v116
    v_pk_add_f32 v[80:81], v[80:81], v[118:119]
    v_pk_add_f32 v[82:83], v[82:83], v[118:119]
    v_pk_add_f32 v[84:85], v[84:85], v[118:119]
    v_pk_add_f32 v[86:87], v[86:87], v[118:119]
    v_pk_add_f32 v[88:89], v[88:89], v[118:119]
    v_pk_add_f32 v[90:91], v[90:91], v[118:119]
    v_pk_add_f32 v[92:93], v[92:93], v[118:119]
    v_pk_add_f32 v[94:95], v[94:95], v[118:119]
    v_pk_add_f32 v[96:97], v[96:97], v[118:119]
    v_pk_add_f32 v[98:99], v[98:99], v[118:119]
    v_pk_add_f32 v[100:101], v[100:101], v[118:119]
    v_pk_add_f32 v[102:103], v[102:103], v[118:119]
    v_pk_add_f32 v[104:105], v[104:105], v[118:119]
    s_add_u32 m0, s48, 36864
    s_nop 0
    buffer_load_dwordx4 v14, s[16:19], s49 offen offset:0 lds
    buffer_load_dwordx4 v15, s[16:19], s49 offen offset:1024 lds
    buffer_load_dwordx4 v16, s[16:19], s49 offen offset:2048 lds
    buffer_load_dwordx4 v17, s[16:19], s49 offen offset:3072 lds
    s_add_u32 s49, s49, 128
    v_pk_add_f32 v[106:107], v[106:107], v[118:119]
    v_pk_add_f32 v[108:109], v[108:109], v[118:119]
    v_pk_add_f32 v[110:111], v[110:111], v[118:119]
    v_cvt_pk_bf16_f32 v116, v116, v116
    v_and_b32 v116, 0xffff0000, v116
    v_rcp_f32 v116, v116
    v_cvt_pk_bf16_f32 v64, v80, v81
    v_cvt_pk_bf16_f32 v65, v82, v83
    v_cvt_pk_bf16_f32 v66, v84, v85
    v_cvt_pk_bf16_f32 v67, v86, v87
    v_cvt_pk_bf16_f32 v68, v88, v89
    v_cvt_pk_bf16_f32 v69, v90, v91
    v_cvt_pk_bf16_f32 v70, v92, v93
    v_cvt_pk_bf16_f32 v71, v94, v95
    v_cvt_pk_bf16_f32 v72, v96, v97
    v_cvt_pk_bf16_f32 v73, v98, v99
    v_cvt_pk_bf16_f32 v74, v100, v101
    v_cvt_pk_bf16_f32 v75, v102, v103
    v_cvt_pk_bf16_f32 v76, v104, v105
    v_cvt_pk_bf16_f32 v77, v106, v107
    v_cvt_pk_bf16_f32 v78, v108, v109
    v_cvt_pk_bf16_f32 v79, v110, v111
    v_mov_b32 v117, v116
    v_lshlrev_b32 v80, 16, v64
    v_and_b32 v81, 0xffff0000, v64
    v_lshlrev_b32 v82, 16, v65
    v_and_b32 v83, 0xffff0000, v65
    v_lshlrev_b32 v84, 16, v66
    v_and_b32 v85, 0xffff0000, v66
    v_lshlrev_b32 v86, 16, v67
    v_and_b32 v87, 0xffff0000, v67
    v_lshlrev_b32 v88, 16, v68
    v_and_b32 v89, 0xffff0000, v68
    v_lshlrev_b32 v90, 16, v69
    v_and_b32 v91, 0xffff0000, v69
    v_lshlrev_b32 v92, 16, v70
    v_and_b32 v93, 0xffff0000, v70
    v_lshlrev_b32 v94, 16, v71
    v_and_b32 v95, 0xffff0000, v71
    v_lshlrev_b32 v96, 16, v72
    v_and_b32 v97, 0xffff0000, v72
    v_lshlrev_b32 v98, 16, v73
    v_and_b32 v99, 0xffff0000, v73
    v_lshlrev_b32 v100, 16, v74
    s_add_u32 m0, s48, 102400
    s_nop 0
    buffer_load_dwordx4 v22, s[20:23], s50 offen offset:0 lds
    buffer_load_dwordx4 v23, s[20:23], s50 offen offset:1024 lds
    buffer_load_dwordx4 v24, s[20:23], s50 offen offset:2048 lds
    buffer_load_dwordx4 v25, s[20:23], s50 offen offset:3072 lds
    s_add_u32 s50, s50, 0x80000
    v_and_b32 v101, 0xffff0000, v74
    v_lshlrev_b32 v102, 16, v75
    v_and_b32 v103, 0xffff0000, v75
    v_lshlrev_b32 v104, 16, v76
    v_and_b32 v105, 0xffff0000, v76
    v_lshlrev_b32 v106, 16, v77
    v_and_b32 v107, 0xffff0000, v77
    v_lshlrev_b32 v108, 16, v78
    v_and_b32 v109, 0xffff0000, v78
    v_lshlrev_b32 v110, 16, v79
    v_and_b32 v111, 0xffff0000, v79
    v_pk_mul_f32 v[80:81], v[80:81], v[116:117]
    v_pk_mul_f32 v[82:83], v[82:83], v[116:117]
    v_pk_mul_f32 v[84:85], v[84:85], v[116:117]
    v_pk_mul_f32 v[86:87], v[86:87], v[116:117]
    v_pk_mul_f32 v[88:89], v[88:89], v[116:117]
    v_pk_mul_f32 v[90:91], v[90:91], v[116:117]
    v_pk_mul_f32 v[92:93], v[92:93], v[116:117]
    v_pk_mul_f32 v[94:95], v[94:95], v[116:117]
    v_pk_mul_f32 v[96:97], v[96:97], v[116:117]
    v_pk_mul_f32 v[98:99], v[98:99], v[116:117]
    v_pk_mul_f32 v[100:101], v[100:101], v[116:117]
    v_pk_mul_f32 v[102:103], v[102:103], v[116:117]
    v_pk_mul_f32 v[104:105], v[104:105], v[116:117]
    v_pk_mul_f32 v[106:107], v[106:107], v[116:117]
    v_pk_mul_f32 v[108:109], v[108:109], v[116:117]
    v_pk_mul_f32 v[110:111], v[110:111], v[116:117]
    v_cvt_pk_bf16_f32 v64, v80, v81
    v_cvt_pk_bf16_f32 v65, v82, v83
    v_cvt_pk_bf16_f32 v66, v84, v85
    v_cvt_pk_bf16_f32 v67, v86, v87
    v_cvt_pk_bf16_f32 v68, v88, v89
    v_cvt_pk_bf16_f32 v69, v90, v91
    v_cvt_pk_bf16_f32 v70, v92, v93
    v_cvt_pk_bf16_f32 v71, v94, v95
    v_cvt_pk_bf16_f32 v72, v96, v97
    v_cvt_pk_bf16_f32 v73, v98, v99
    v_cvt_pk_bf16_f32 v74, v100, v101
    v_cvt_pk_bf16_f32 v75, v102, v103
    v_cvt_pk_bf16_f32 v76, v104, v105
    v_cvt_pk_bf16_f32 v77, v106, v107
    v_cvt_pk_bf16_f32 v78, v108, v109
    v_cvt_pk_bf16_f32 v79, v110, v111
    ds_write_b128 v54, v[64:67] offset:0
    ds_write_b128 v54, v[68:71] offset:512
    ds_write_b128 v54, v[72:75] offset:1024
    ds_write_b128 v54, v[76:79] offset:1536
    s_waitcnt vmcnt(16) lgkmcnt(0)
    s_barrier
    ds_read_b128 a[64:67], v55 offset:0
    ds_read_b128 a[68:71], v55 offset:128
    ds_read_b128 a[72:75], v55 offset:256
    ds_read_b128 a[76:79], v55 offset:384
    v_add_u32 v54, 4096, v36
    v_add_u32 v55, 4096, v37
    v_mfma_f32_32x32x16_bf16 v[64:79], v[56:59], v[56:59], 0
    v_mfma_f32_32x32x16_bf16 v[80:95], v[56:59], v[56:59], 0
    v_mfma_f32_32x32x16_bf16 v[96:111], v[56:59], v[56:59], 0
    v_mfma_f32_32x32x16_bf16 v[112:127], v[56:59], v[56:59], 0
    s_cmp_ge_u32 s2, 22
    s_cbranch_scc1 k12_nostat_5
    s_lshl_b32 s52, s2, 12
    s_add_u32 s52, s52, 0x3800000
    s_mov_b32 s34, -1
    v_lshlrev_b32 v6, 4, v0
    buffer_store_dwordx4 v[56:59], v6, s[32:35], s52 offen sc1
    s_mov_b32 s34, 0x2000000
k12_nostat_5:
    ds_read_b128 a[192:195], v26 offset:0
    ds_read_b64_tr_b16 a[0:1], v28 offset:0
    ds_read_b128 a[196:199], v27 offset:0
    ds_read_b64_tr_b16 a[2:3], v28 offset:2048
    ds_read_b128 a[200:203], v26 offset:2048
    ds_read_b64_tr_b16 a[4:5], v28 offset:16384
    ds_read_b128 a[204:207], v27 offset:2048
    ds_read_b64_tr_b16 a[6:7], v28 offset:18432
    ds_read_b128 a[208:211], v26 offset:4096
    ds_read_b64_tr_b16 a[8:9], v29 offset:0
    ds_read_b128 a[212:215], v27 offset:4096
    ds_read_b64_tr_b16 a[10:11], v29 offset:2048
    ds_read_b128 a[216:219], v26 offset:6144
    ds_read_b64_tr_b16 a[12:13], v29 offset:16384
    ds_read_b128 a[220:223], v27 offset:6144
    ds_read_b64_tr_b16 a[14:15], v29 offset:18432
    ds_read_b128 a[224:227], v26 offset:8192
    ds_read_b64_tr_b16 a[16:17], v30 offset:0
    ds_read_b128 a[228:231], v27 offset:8192
    ds_read_b64_tr_b16 a[18:19], v30 offset:2048
    ds_read_b128 a[232:235], v26 offset:10240
    ds_read_b64_tr_b16 a[20:21], v30 offset:16384
    ds_read_b128 a[236:239], v27 offset:10240
    ds_read_b64_tr_b16 a[22:23], v30 offset:18432
    ds_read_b128 a[240:243], v26 offset:12288
    ds_read_b64_tr_b16 a[24:25], v31 offset:0
    ds_read_b128 a[244:247], v27 offset:12288
    ds_read_b64_tr_b16 a[26:27], v31 offset:2048
    ds_read_b128 a[248:251], v26 offset:14336
    ds_read_b64_tr_b16 a[28:29], v31 offset:16384
    ds_read_b128 a[252:255], v27 offset:14336
    ds_read_b64_tr_b16 a[30:31], v31 offset:18432
    s_mov_b32 s51, 0
    s_waitcnt lgkmcnt(15)
    s_mov_b32 s52, 0
    buffer_store_dwordx4 a[64:67], v53, s[8:11], s52 offen sc1
    s_mov_b32 s52, 262144
    buffer_store_dwordx4 a[68:71], v53, s[8:11], s52 offen sc1
    s_mov_b32 s52, 524288
    buffer_store_dwordx4 a[72:75], v53, s[8:11], s52 offen sc1
    s_mov_b32 s52, 786432
    buffer_store_dwordx4 a[76:79], v53, s[8:11], s52 offen sc1
    s_waitcnt lgkmcnt(0)
    s_cmp_lg_u32 s57, 0
    s_cbranch_scc1 k12_v_6
k12_loop_8:
    v_mfma_f32_16x16x32_bf16 v[64:67], a[0:3], a[192:195], v[64:67]
    v_mfma_f32_16x16x32_bf16 v[64:67], a[4:7], a[196:199], v[64:67]
    ds_read_b64_tr_b16 a[32:33], v32 offset:0
    v_mfma_f32_16x16x32_bf16 v[80:83], a[4:7], a[204:207], v[80:83]
    v_mfma_f32_16x16x32_bf16 v[80:83], a[0:3], a[200:203], v[80:83]
    ds_read_b64_tr_b16 a[34:35], v32 offset:2048
    v_mfma_f32_16x16x32_bf16 v[96:99], a[0:3], a[208:211], v[96:99]
    s_cmp_eq_u32 s51, s46
    s_cbranch_scc1 k12_ool_10
k12_oolret_11:
    v_mfma_f32_16x16x32_bf16 v[96:99], a[4:7], a[212:215], v[96:99]
    v_mfma_f32_16x16x32_bf16 v[112:115], a[4:7], a[220:223], v[112:115]
    ds_read_b64_tr_b16 a[36:37], v32 offset:16384
    v_mfma_f32_16x16x32_bf16 v[112:115], a[0:3], a[216:219], v[112:115]
    v_mfma_f32_16x16x32_bf16 v[128:131], a[0:3], a[224:227], v[128:131]
    v_mfma_f32_16x16x32_bf16 v[128:131], a[4:7], a[228:231], v[128:131]
    ds_read_b64_tr_b16 a[38:39], v32 offset:18432
    v_mfma_f32_16x16x32_bf16 v[144:147], a[4:7], a[236:239], v[144:147]
    v_mfma_f32_16x16x32_bf16 v[144:147], a[0:3], a[232:235], v[144:147]
    v_mfma_f32_16x16x32_bf16 a[128:131], a[0:3], a[240:243], a[128:131]
    ds_read_b64_tr_b16 a[40:41], v33 offset:0
    v_mfma_f32_16x16x32_bf16 a[128:131], a[4:7], a[244:247], a[128:131]
    v_mfma_f32_16x16x32_bf16 a[160:163], a[4:7], a[252:255], a[160:163]
    v_mfma_f32_16x16x32_bf16 a[160:163], a[0:3], a[248:251], a[160:163]
    ds_read_b64_tr_b16 a[42:43], v33 offset:2048
    v_mfma_f32_16x16x32_bf16 a[164:167], a[8:11], a[248:251], a[164:167]
    v_mfma_f32_16x16x32_bf16 a[164:167], a[12:15], a[252:255], a[164:167]
    v_mfma_f32_16x16x32_bf16 a[132:135], a[12:15], a[244:247], a[132:135]
    ds_read_b64_tr_b16 a[44:45], v33 offset:16384
    v_mfma_f32_16x16x32_bf16 a[132:135], a[8:11], a[240:243], a[132:135]
    v_mfma_f32_16x16x32_bf16 v[240:243], a[8:11], a[232:235], v[240:243]
    v_mfma_f32_16x16x32_bf16 v[240:243], a[12:15], a[236:239], v[240:243]
    ds_read_b64_tr_b16 a[46:47], v33 offset:18432
    v_mfma_f32_16x16x32_bf16 v[224:227], a[12:15], a[228:231], v[224:227]
    v_mfma_f32_16x16x32_bf16 v[224:227], a[8:11], a[224:227], v[224:227]
    ds_read_b64_tr_b16 a[48:49], v34 offset:0
    v_mfma_f32_16x16x32_bf16 v[208:211], a[8:11], a[216:219], v[208:211]
    v_mfma_f32_16x16x32_bf16 v[208:211], a[12:15], a[220:223], v[208:211]
    v_mfma_f32_16x16x32_bf16 v[192:195], a[12:15], a[212:215], v[192:195]
    ds_read_b64_tr_b16 a[50:51], v34 offset:2048
    v_mfma_f32_16x16x32_bf16 v[192:195], a[8:11], a[208:211], v[192:195]
    v_mfma_f32_16x16x32_bf16 v[176:179], a[8:11], a[200:203], v[176:179]
    v_mfma_f32_16x16x32_bf16 v[176:179], a[12:15], a[204:207], v[176:179]
    ds_read_b64_tr_b16 a[52:53], v34 offset:16384
    v_mfma_f32_16x16x32_bf16 v[160:163], a[12:15], a[196:199], v[160:163]
    v_mfma_f32_16x16x32_bf16 v[160:163], a[8:11], a[192:195], v[160:163]
    v_mfma_f32_16x16x32_bf16 v[68:71], a[16:19], a[192:195], v[68:71]
    ds_read_b64_tr_b16 a[54:55], v34 offset:18432
    v_mfma_f32_16x16x32_bf16 v[68:71], a[20:23], a[196:199], v[68:71]
    v_mfma_f32_16x16x32_bf16 v[84:87], a[20:23], a[204:207], v[84:87]
    v_mfma_f32_16x16x32_bf16 v[84:87], a[16:19], a[200:203], v[84:87]
    ds_read_b64_tr_b16 a[56:57], v35 offset:0
    v_mfma_f32_16x16x32_bf16 v[100:103], a[16:19], a[208:211], v[100:103]
    v_mfma_f32_16x16x32_bf16 v[100:103], a[20:23], a[212:215], v[100:103]
    v_mfma_f32_16x16x32_bf16 v[116:119], a[20:23], a[220:223], v[116:119]
    ds_read_b64_tr_b16 a[58:59], v35 offset:2048
    v_mfma_f32_16x16x32_bf16 v[116:119], a[16:19], a[216:219], v[116:119]
    v_mfma_f32_16x16x32_bf16 v[132:135], a[16:19], a[224:227], v[132:135]
    v_mfma_f32_16x16x32_bf16 v[132:135], a[20:23], a[228:231], v[132:135]
    ds_read_b64_tr_b16 a[60:61], v35 offset:16384
    v_mfma_f32_16x16x32_bf16 v[148:151], a[20:23], a[236:239], v[148:151]
    v_mfma_f32_16x16x32_bf16 v[148:151], a[16:19], a[232:235], v[148:151]
    v_mfma_f32_16x16x32_bf16 a[136:139], a[16:19], a[240:243], a[136:139]
    ds_read_b64_tr_b16 a[62:63], v35 offset:18432
    v_mfma_f32_16x16x32_bf16 a[136:139], a[20:23], a[244:247], a[136:139]
    v_mfma_f32_16x16x32_bf16 a[168:171], a[20:23], a[252:255], a[168:171]
    v_mfma_f32_16x16x32_bf16 a[168:171], a[16:19], a[248:251], a[168:171]
    v_mfma_f32_16x16x32_bf16 a[172:175], a[24:27], a[248:251], a[172:175]
    v_mfma_f32_16x16x32_bf16 a[172:175], a[28:31], a[252:255], a[172:175]
    v_mfma_f32_16x16x32_bf16 a[140:143], a[28:31], a[244:247], a[140:143]
    v_mfma_f32_16x16x32_bf16 a[140:143], a[24:27], a[240:243], a[140:143]
    v_mfma_f32_16x16x32_bf16 v[244:247], a[24:27], a[232:235], v[244:247]
    v_mfma_f32_16x16x32_bf16 v[244:247], a[28:31], a[236:239], v[244:247]
    v_mfma_f32_16x16x32_bf16 v[228:231], a[28:31], a[228:231], v[228:231]
    v_mfma_f32_16x16x32_bf16 v[228:231], a[24:27], a[224:227], v[228:231]
    v_mfma_f32_16x16x32_bf16 v[212:215], a[24:27], a[216:219], v[212:215]
    v_mfma_f32_16x16x32_bf16 v[212:215], a[28:31], a[220:223], v[212:215]
    v_mfma_f32_16x16x32_bf16 v[196:199], a[28:31], a[212:215], v[196:199]
    v_mfma_f32_16x16x32_bf16 v[196:199], a[24:27], a[208:211], v[196:199]
    v_mfma_f32_16x16x32_bf16 v[180:183], a[24:27], a[200:203], v[180:183]
    v_mfma_f32_16x16x32_bf16 v[180:183], a[28:31], a[204:207], v[180:183]
    v_mfma_f32_16x16x32_bf16 v[164:167], a[28:31], a[196:199], v[164:167]
    v_mfma_f32_16x16x32_bf16 v[164:167], a[24:27], a[192:195], v[164:167]
    s_waitcnt vmcnt(0) lgkmcnt(0)
    s_cmp_eq_u32 s51, s46
    s_cbranch_scc1 k12_ool_14
k12_oolret_15:
    s_barrier
    v_mfma_f32_16x16x32_bf16 v[72:75], a[32:35], a[192:195], v[72:75]
    s_cmp_ge_u32 s49, 1024
    s_cselect_b32 s18, 0, s18
    s_cselect_b32 s22, 0, s22
    v_mfma_f32_16x16x32_bf16 v[72:75], a[36:39], a[196:199], v[72:75]
    s_add_u32 m0, s48, 0
    ds_read_b128 a[64:67], v26 offset:32768
    v_mfma_f32_16x16x32_bf16 v[88:91], a[36:39], a[204:207], v[88:91]
    buffer_load_dwordx4 v10, s[16:19], s49 offen offset:0 lds
    ds_read_b64_tr_b16 a[0:1], v28 offset:32768
    v_mfma_f32_16x16x32_bf16 v[88:91], a[32:35], a[200:203], v[88:91]
    ds_read_b128 a[68:71], v27 offset:32768
    v_mfma_f32_16x16x32_bf16 v[104:107], a[32:35], a[208:211], v[104:107]
    buffer_load_dwordx4 v11, s[16:19], s49 offen offset:1024 lds
    v_mfma_f32_16x16x32_bf16 v[104:107], a[36:39], a[212:215], v[104:107]
    ds_read_b64_tr_b16 a[2:3], v28 offset:34816
    v_mfma_f32_16x16x32_bf16 v[120:123], a[36:39], a[220:223], v[120:123]
    v_mfma_f32_16x16x32_bf16 v[120:123], a[32:35], a[216:219], v[120:123]
    ds_read_b128 a[72:75], v26 offset:34816
    v_mfma_f32_16x16x32_bf16 v[136:139], a[32:35], a[224:227], v[136:139]
    buffer_load_dwordx4 v12, s[16:19], s49 offen offset:2048 lds
    ds_read_b64_tr_b16 a[4:5], v28 offset:49152
    v_mfma_f32_16x16x32_bf16 v[136:139], a[36:39], a[228:231], v[136:139]
    v_mfma_f32_16x16x32_bf16 v[152:155], a[36:39], a[236:239], v[152:155]
    ds_read_b128 a[76:79], v27 offset:34816
    v_mfma_f32_16x16x32_bf16 v[152:155], a[32:35], a[232:235], v[152:155]
    buffer_load_dwordx4 v13, s[16:19], s49 offen offset:3072 lds
    v_mfma_f32_16x16x32_bf16 a[144:147], a[32:35], a[240:243], a[144:147]
    ds_read_b64_tr_b16 a[6:7], v28 offset:51200
    v_mfma_f32_16x16x32_bf16 a[144:147], a[36:39], a[244:247], a[144:147]
    s_add_u32 m0, s48, 4096
    ds_read_b128 a[80:83], v26 offset:36864
    v_mfma_f32_16x16x32_bf16 a[176:179], a[36:39], a[252:255], a[176:179]
    v_mfma_f32_16x16x32_bf16 a[176:179], a[32:35], a[248:251], a[176:179]
    buffer_load_dwordx4 v14, s[16:19], s49 offen offset:0 lds
    ds_read_b64_tr_b16 a[8:9], v29 offset:32768
    v_mfma_f32_16x16x32_bf16 a[180:183], a[40:43], a[248:251], a[180:183]
    v_mfma_f32_16x16x32_bf16 a[180:183], a[44:47], a[252:255], a[180:183]
    ds_read_b128 a[84:87], v27 offset:36864
    v_mfma_f32_16x16x32_bf16 a[148:151], a[44:47], a[244:247], a[148:151]
    buffer_load_dwordx4 v15, s[16:19], s49 offen offset:1024 lds
    ds_read_b64_tr_b16 a[10:11], v29 offset:34816
    v_mfma_f32_16x16x32_bf16 a[148:151], a[40:43], a[240:243], a[148:151]
    v_mfma_f32_16x16x32_bf16 v[248:251], a[40:43], a[232:235], v[248:251]
    ds_read_b128 a[88:91], v26 offset:38912
    v_mfma_f32_16x16x32_bf16 v[248:251], a[44:47], a[236:239], v[248:251]
    v_mfma_f32_16x16x32_bf16 v[232:235], a[44:47], a[228:231], v[232:235]
    buffer_load_dwordx4 v16, s[16:19], s49 offen offset:2048 lds
    ds_read_b64_tr_b16 a[12:13], v29 offset:49152
    v_mfma_f32_16x16x32_bf16 v[232:235], a[40:43], a[224:227], v[232:235]
    ds_read_b128 a[92:95], v27 offset:38912
    v_mfma_f32_16x16x32_bf16 v[216:219], a[40:43], a[216:219], v[216:219]
    v_mfma_f32_16x16x32_bf16 v[216:219], a[44:47], a[220:223], v[216:219]
    buffer_load_dwordx4 v17, s[16:19], s49 offen offset:3072 lds
    ds_read_b64_tr_b16 a[14:15], v29 offset:51200
    v_mfma_f32_16x16x32_bf16 v[200:203], a[44:47], a[212:215], v[200:203]
    ds_read_b128 a[96:99], v26 offset:40960
    v_mfma_f32_16x16x32_bf16 v[200:203], a[40:43], a[208:211], v[200:203]
    s_add_u32 s49, s49, 128
    v_mfma_f32_16x16x32_bf16 v[184:187], a[40:43], a[200:203], v[184:187]
    s_add_u32 m0, s48, 65536
    ds_read_b64_tr_b16 a[16:17], v30 offset:32768
    v_mfma_f32_16x16x32_bf16 v[184:187], a[44:47], a[204:207], v[184:187]
    buffer_load_dwordx4 v18, s[20:23], s50 offen offset:0 lds
    v_mfma_f32_16x16x32_bf16 v[168:171], a[44:47], a[196:199], v[168:171]
    ds_read_b128 a[100:103], v27 offset:40960
    v_mfma_f32_16x16x32_bf16 v[168:171], a[40:43], a[192:195], v[168:171]
    ds_read_b64_tr_b16 a[18:19], v30 offset:34816
    v_mfma_f32_16x16x32_bf16 v[76:79], a[48:51], a[192:195], v[76:79]
    buffer_load_dwordx4 v19, s[20:23], s50 offen offset:1024 lds
    v_mfma_f32_16x16x32_bf16 v[76:79], a[52:55], a[196:199], v[76:79]
    ds_read_b128 a[104:107], v26 offset:43008
    v_mfma_f32_16x16x32_bf16 v[92:95], a[52:55], a[204:207], v[92:95]
    v_mfma_f32_16x16x32_bf16 v[92:95], a[48:51], a[200:203], v[92:95]
    buffer_load_dwordx4 v20, s[20:23], s50 offen offset:2048 lds
    ds_read_b64_tr_b16 a[20:21], v30 offset:49152
    v_mfma_f32_16x16x32_bf16 v[108:111], a[48:51], a[208:211], v[108:111]
    ds_read_b128 a[108:111], v27 offset:43008
    v_mfma_f32_16x16x32_bf16 v[108:111], a[52:55], a[212:215], v[108:111]
    v_mfma_f32_16x16x32_bf16 v[124:127], a[52:55], a[220:223], v[124:127]
    ds_read_b64_tr_b16 a[22:23], v30 offset:51200
    v_mfma_f32_16x16x32_bf16 v[124:127], a[48:51], a[216:219], v[124:127]
    buffer_load_dwordx4 v21, s[20:23], s50 offen offset:3072 lds
    v_mfma_f32_16x16x32_bf16 v[140:143], a[48:51], a[224:227], v[140:143]
    s_add_u32 m0, s48, 69632
    ds_read_b128 a[112:115], v26 offset:45056
    v_mfma_f32_16x16x32_bf16 v[140:143], a[52:55], a[228:231], v[140:143]
    ds_read_b64_tr_b16 a[24:25], v31 offset:32768
    v_mfma_f32_16x16x32_bf16 v[156:159], a[52:55], a[236:239], v[156:159]
    buffer_load_dwordx4 v22, s[20:23], s50 offen offset:0 lds
    v_mfma_f32_16x16x32_bf16 v[156:159], a[48:51], a[232:235], v[156:159]
    ds_read_b128 a[116:119], v27 offset:45056
    v_mfma_f32_16x16x32_bf16 a[152:155], a[48:51], a[240:243], a[152:155]
    v_mfma_f32_16x16x32_bf16 a[152:155], a[52:55], a[244:247], a[152:155]
    ds_read_b64_tr_b16 a[26:27], v31 offset:34816
    v_mfma_f32_16x16x32_bf16 a[184:187], a[52:55], a[252:255], a[184:187]
    buffer_load_dwordx4 v23, s[20:23], s50 offen offset:1024 lds
    ds_read_b128 a[120:123], v26 offset:47104
    v_mfma_f32_16x16x32_bf16 a[184:187], a[48:51], a[248:251], a[184:187]
    v_mfma_f32_16x16x32_bf16 a[188:191], a[56:59], a[248:251], a[188:191]
    ds_read_b64_tr_b16 a[28:29], v31 offset:49152
    v_mfma_f32_16x16x32_bf16 a[188:191], a[60:63], a[252:255], a[188:191]
    buffer_load_dwordx4 v24, s[20:23], s50 offen offset:2048 lds
    v_mfma_f32_16x16x32_bf16 a[156:159], a[60:63], a[244:247], a[156:159]
    ds_read_b128 a[124:127], v27 offset:47104
    v_mfma_f32_16x16x32_bf16 a[156:159], a[56:59], a[240:243], a[156:159]
    ds_read_b64_tr_b16 a[30:31], v31 offset:51200
    v_mfma_f32_16x16x32_bf16 v[252:255], a[56:59], a[232:235], v[252:255]
    v_mfma_f32_16x16x32_bf16 v[252:255], a[60:63], a[236:239], v[252:255]
    buffer_load_dwordx4 v25, s[20:23], s50 offen offset:3072 lds
    v_mfma_f32_16x16x32_bf16 v[236:239], a[60:63], a[228:231], v[236:239]
    v_mfma_f32_16x16x32_bf16 v[236:239], a[56:59], a[224:227], v[236:239]
    s_add_u32 s50, s50, 0x80000
    v_mfma_f32_16x16x32_bf16 v[220:223], a[56:59], a[216:219], v[220:223]
    v_mfma_f32_16x16x32_bf16 v[220:223], a[60:63], a[220:223], v[220:223]
    s_cmp_eq_u32 s51, s53
    s_cbranch_scc1 k12_ool_16
k12_oolret_17:
    v_mfma_f32_16x16x32_bf16 v[204:207], a[60:63], a[212:215], v[204:207]
    s_cmp_eq_u32 s51, s63
    s_cbranch_scc1 k12_ool_18
k12_oolret_19:
    v_mfma_f32_16x16x32_bf16 v[204:207], a[56:59], a[208:211], v[204:207]
    s_cmp_eq_u32 s51, 6
    s_cbranch_scc1 k12_ool_20
k12_oolret_21:
    v_mfma_f32_16x16x32_bf16 v[188:191], a[56:59], a[200:203], v[188:191]
    v_mfma_f32_16x16x32_bf16 v[188:191], a[60:63], a[204:207], v[188:191]
    s_add_u32 s51, s51, 1
    v_mfma_f32_16x16x32_bf16 v[172:175], a[60:63], a[196:199], v[172:175]
    v_mfma_f32_16x16x32_bf16 v[172:175], a[56:59], a[192:195], v[172:175]
    s_waitcnt lgkmcnt(0)
    s_cmp_eq_u32 s51, 7
    s_cbranch_scc1 k12_last_9
    v_mfma_f32_16x16x32_bf16 v[64:67], a[0:3], a[64:67], v[64:67]
    v_mfma_f32_16x16x32_bf16 v[64:67], a[4:7], a[68:71], v[64:67]
    ds_read_b64_tr_b16 a[32:33], v32 offset:32768
    v_mfma_f32_16x16x32_bf16 v[80:83], a[4:7], a[76:79], v[80:83]
    v_mfma_f32_16x16x32_bf16 v[80:83], a[0:3], a[72:75], v[80:83]
    ds_read_b64_tr_b16 a[34:35], v32 offset:34816
    v_mfma_f32_16x16x32_bf16 v[96:99], a[0:3], a[80:83], v[96:99]
    v_mfma_f32_16x16x32_bf16 v[96:99], a[4:7], a[84:87], v[96:99]
    v_mfma_f32_16x16x32_bf16 v[112:115], a[4:7], a[92:95], v[112:115]
    ds_read_b64_tr_b16 a[36:37], v32 offset:49152
    v_mfma_f32_16x16x32_bf16 v[112:115], a[0:3], a[88:91], v[112:115]
    v_mfma_f32_16x16x32_bf16 v[128:131], a[0:3], a[96:99], v[128:131]
    v_mfma_f32_16x16x32_bf16 v[128:131], a[4:7], a[100:103], v[128:131]
    ds_read_b64_tr_b16 a[38:39], v32 offset:51200
    v_mfma_f32_16x16x32_bf16 v[144:147], a[4:7], a[108:111], v[144:147]
    v_mfma_f32_16x16x32_bf16 v[144:147], a[0:3], a[104:107], v[144:147]
    v_mfma_f32_16x16x32_bf16 a[128:131], a[0:3], a[112:115], a[128:131]
    ds_read_b64_tr_b16 a[40:41], v33 offset:32768
    v_mfma_f32_16x16x32_bf16 a[128:131], a[4:7], a[116:119], a[128:131]
    v_mfma_f32_16x16x32_bf16 a[160:163], a[4:7], a[124:127], a[160:163]
    v_mfma_f32_16x16x32_bf16 a[160:163], a[0:3], a[120:123], a[160:163]
    ds_read_b64_tr_b16 a[42:43], v33 offset:34816
    v_mfma_f32_16x16x32_bf16 a[164:167], a[8:11], a[120:123], a[164:167]
    v_mfma_f32_16x16x32_bf16 a[164:167], a[12:15], a[124:127], a[164:167]
    v_mfma_f32_16x16x32_bf16 a[132:135], a[12:15], a[116:119], a[132:135]
    ds_read_b64_tr_b16 a[44:45], v33 offset:49152
    v_mfma_f32_16x16x32_bf16 a[132:135], a[8:11], a[112:115], a[132:135]
    v_mfma_f32_16x16x32_bf16 v[240:243], a[8:11], a[104:107], v[240:243]
    v_mfma_f32_16x16x32_bf16 v[240:243], a[12:15], a[108:111], v[240:243]
    ds_read_b64_tr_b16 a[46:47], v33 offset:51200
    v_mfma_f32_16x16x32_bf16 v[224:227], a[12:15], a[100:103], v[224:227]
    v_mfma_f32_16x16x32_bf16 v[224:227], a[8:11], a[96:99], v[224:227]
    ds_read_b64_tr_b16 a[48:49], v34 offset:32768
    v_mfma_f32_16x16x32_bf16 v[208:211], a[8:11], a[88:91], v[208:211]
    v_mfma_f32_16x16x32_bf16 v[208:211], a[12:15], a[92:95], v[208:211]
    v_mfma_f32_16x16x32_bf16 v[192:195], a[12:15], a[84:87], v[192:195]
    ds_read_b64_tr_b16 a[50:51], v34 offset:34816
    v_mfma_f32_16x16x32_bf16 v[192:195], a[8:11], a[80:83], v[192:195]
    v_mfma_f32_16x16x32_bf16 v[176:179], a[8:11], a[72:75], v[176:179]
    v_mfma_f32_16x16x32_bf16 v[176:179], a[12:15], a[76:79], v[176:179]
    ds_read_b64_tr_b16 a[52:53], v34 offset:49152
    v_mfma_f32_16x16x32_bf16 v[160:163], a[12:15], a[68:71], v[160:163]
    v_mfma_f32_16x16x32_bf16 v[160:163], a[8:11], a[64:67], v[160:163]
    v_mfma_f32_16x16x32_bf16 v[68:71], a[16:19], a[64:67], v[68:71]
    ds_read_b64_tr_b16 a[54:55], v34 offset:51200
    v_mfma_f32_16x16x32_bf16 v[68:71], a[20:23], a[68:71], v[68:71]
    v_mfma_f32_16x16x32_bf16 v[84:87], a[20:23], a[76:79], v[84:87]
    v_mfma_f32_16x16x32_bf16 v[84:87], a[16:19], a[72:75], v[84:87]
    ds_read_b64_tr_b16 a[56:57], v35 offset:32768
    v_mfma_f32_16x16x32_bf16 v[100:103], a[16:19], a[80:83], v[100:103]
    v_mfma_f32_16x16x32_bf16 v[100:103], a[20:23], a[84:87], v[100:103]
    v_mfma_f32_16x16x32_bf16 v[116:119], a[20:23], a[92:95], v[116:119]
    ds_read_b64_tr_b16 a[58:59], v35 offset:34816
    v_mfma_f32_16x16x32_bf16 v[116:119], a[16:19], a[88:91], v[116:119]
    v_mfma_f32_16x16x32_bf16 v[132:135], a[16:19], a[96:99], v[132:135]
    v_mfma_f32_16x16x32_bf16 v[132:135], a[20:23], a[100:103], v[132:135]
    ds_read_b64_tr_b16 a[60:61], v35 offset:49152
    v_mfma_f32_16x16x32_bf16 v[148:151], a[20:23], a[108:111], v[148:151]
    v_mfma_f32_16x16x32_bf16 v[148:151], a[16:19], a[104:107], v[148:151]
    v_mfma_f32_16x16x32_bf16 a[136:139], a[16:19], a[112:115], a[136:139]
    ds_read_b64_tr_b16 a[62:63], v35 offset:51200
    v_mfma_f32_16x16x32_bf16 a[136:139], a[20:23], a[116:119], a[136:139]
    v_mfma_f32_16x16x32_bf16 a[168:171], a[20:23], a[124:127], a[168:171]
    v_mfma_f32_16x16x32_bf16 a[168:171], a[16:19], a[120:123], a[168:171]
    v_mfma_f32_16x16x32_bf16 a[172:175], a[24:27], a[120:123], a[172:175]
    v_mfma_f32_16x16x32_bf16 a[172:175], a[28:31], a[124:127], a[172:175]
    v_mfma_f32_16x16x32_bf16 a[140:143], a[28:31], a[116:119], a[140:143]
    v_mfma_f32_16x16x32_bf16 a[140:143], a[24:27], a[112:115], a[140:143]
    v_mfma_f32_16x16x32_bf16 v[244:247], a[24:27], a[104:107], v[244:247]
    v_mfma_f32_16x16x32_bf16 v[244:247], a[28:31], a[108:111], v[244:247]
    v_mfma_f32_16x16x32_bf16 v[228:231], a[28:31], a[100:103], v[228:231]
    v_mfma_f32_16x16x32_bf16 v[228:231], a[24:27], a[96:99], v[228:231]
    v_mfma_f32_16x16x32_bf16 v[212:215], a[24:27], a[88:91], v[212:215]
    v_mfma_f32_16x16x32_bf16 v[212:215], a[28:31], a[92:95], v[212:215]
    v_mfma_f32_16x16x32_bf16 v[196:199], a[28:31], a[84:87], v[196:199]
    v_mfma_f32_16x16x32_bf16 v[196:199], a[24:27], a[80:83], v[196:199]
    v_mfma_f32_16x16x32_bf16 v[180:183], a[24:27], a[72:75], v[180:183]
    v_mfma_f32_16x16x32_bf16 v[180:183], a[28:31], a[76:79], v[180:183]
    v_mfma_f32_16x16x32_bf16 v[164:167], a[28:31], a[68:71], v[164:167]
    v_mfma_f32_16x16x32_bf16 v[164:167], a[24:27], a[64:67], v[164:167]
    s_waitcnt vmcnt(0) lgkmcnt(0)
    s_barrier
    v_mfma_f32_16x16x32_bf16 v[72:75], a[32:35], a[64:67], v[72:75]
    v_mfma_f32_16x16x32_bf16 v[72:75], a[36:39], a[68:71], v[72:75]
    s_add_u32 m0, s48, 32768
    ds_read_b128 a[192:195], v26 offset:0
    v_mfma_f32_16x16x32_bf16 v[88:91], a[36:39], a[76:79], v[88:91]
    buffer_load_dwordx4 v10, s[16:19], s49 offen offset:0 lds
    ds_read_b64_tr_b16 a[0:1], v28 offset:0
    v_mfma_f32_16x16x32_bf16 v[88:91], a[32:35], a[72:75], v[88:91]
    ds_read_b128 a[196:199], v27 offset:0
    v_mfma_f32_16x16x32_bf16 v[104:107], a[32:35], a[80:83], v[104:107]
    buffer_load_dwordx4 v11, s[16:19], s49 offen offset:1024 lds
    v_mfma_f32_16x16x32_bf16 v[104:107], a[36:39], a[84:87], v[104:107]
    ds_read_b64_tr_b16 a[2:3], v28 offset:2048
    v_mfma_f32_16x16x32_bf16 v[120:123], a[36:39], a[92:95], v[120:123]
    v_mfma_f32_16x16x32_bf16 v[120:123], a[32:35], a[88:91], v[120:123]
    ds_read_b128 a[200:203], v26 offset:2048
    v_mfma_f32_16x16x32_bf16 v[136:139], a[32:35], a[96:99], v[136:139]
    buffer_load_dwordx4 v12, s[16:19], s49 offen offset:2048 lds
    ds_read_b64_tr_b16 a[4:5], v28 offset:16384
    v_mfma_f32_16x16x32_bf16 v[136:139], a[36:39], a[100:103], v[136:139]
    v_mfma_f32_16x16x32_bf16 v[152:155], a[36:39], a[108:111], v[152:155]
    ds_read_b128 a[204:207], v27 offset:2048
    v_mfma_f32_16x16x32_bf16 v[152:155], a[32:35], a[104:107], v[152:155]
    buffer_load_dwordx4 v13, s[16:19], s49 offen offset:3072 lds
    v_mfma_f32_16x16x32_bf16 a[144:147], a[32:35], a[112:115], a[144:147]
    ds_read_b64_tr_b16 a[6:7], v28 offset:18432
    v_mfma_f32_16x16x32_bf16 a[144:147], a[36:39], a[116:119], a[144:147]
    s_add_u32 m0, s48, 36864
    ds_read_b128 a[208:211], v26 offset:4096
    v_mfma_f32_16x16x32_bf16 a[176:179], a[36:39], a[124:127], a[176:179]
    v_mfma_f32_16x16x32_bf16 a[176:179], a[32:35], a[120:123], a[176:179]
    buffer_load_dwordx4 v14, s[16:19], s49 offen offset:0 lds
    ds_read_b64_tr_b16 a[8:9], v29 offset:0
    v_mfma_f32_16x16x32_bf16 a[180:183], a[40:43], a[120:123], a[180:183]
    v_mfma_f32_16x16x32_bf16 a[180:183], a[44:47], a[124:127], a[180:183]
    ds_read_b128 a[212:215], v27 offset:4096
    v_mfma_f32_16x16x32_bf16 a[148:151], a[44:47], a[116:119], a[148:151]
    buffer_load_dwordx4 v15, s[16:19], s49 offen offset:1024 lds
    ds_read_b64_tr_b16 a[10:11], v29 offset:2048
    v_mfma_f32_16x16x32_bf16 a[148:151], a[40:43], a[112:115], a[148:151]
    v_mfma_f32_16x16x32_bf16 v[248:251], a[40:43], a[104:107], v[248:251]
    ds_read_b128 a[216:219], v26 offset:6144
    v_mfma_f32_16x16x32_bf16 v[248:251], a[44:47], a[108:111], v[248:251]
    v_mfma_f32_16x16x32_bf16 v[232:235], a[44:47], a[100:103], v[232:235]
    buffer_load_dwordx4 v16, s[16:19], s49 offen offset:2048 lds
    ds_read_b64_tr_b16 a[12:13], v29 offset:16384
    v_mfma_f32_16x16x32_bf16 v[232:235], a[40:43], a[96:99], v[232:235]
    ds_read_b128 a[220:223], v27 offset:6144
    v_mfma_f32_16x16x32_bf16 v[216:219], a[40:43], a[88:91], v[216:219]
    v_mfma_f32_16x16x32_bf16 v[216:219], a[44:47], a[92:95], v[216:219]
    buffer_load_dwordx4 v17, s[16:19], s49 offen offset:3072 lds
    ds_read_b64_tr_b16 a[14:15], v29 offset:18432
    v_mfma_f32_16x16x32_bf16 v[200:203], a[44:47], a[84:87], v[200:203]
    ds_read_b128 a[224:227], v26 offset:8192
    v_mfma_f32_16x16x32_bf16 v[200:203], a[40:43], a[80:83], v[200:203]
    s_add_u32 s49, s49, 128
    v_mfma_f32_16x16x32_bf16 v[184:187], a[40:43], a[72:75], v[184:187]
    s_add_u32 m0, s48, 98304
    ds_read_b64_tr_b16 a[16:17], v30 offset:0
    v_mfma_f32_16x16x32_bf16 v[184:187], a[44:47], a[76:79], v[184:187]
    buffer_load_dwordx4 v18, s[20:23], s50 offen offset:0 lds
    v_mfma_f32_16x16x32_bf16 v[168:171], a[44:47], a[68:71], v[168:171]
    ds_read_b128 a[228:231], v27 offset:8192
    v_mfma_f32_16x16x32_bf16 v[168:171], a[40:43], a[64:67], v[168:171]
    ds_read_b64_tr_b16 a[18:19], v30 offset:2048
    v_mfma_f32_16x16x32_bf16 v[76:79], a[48:51], a[64:67], v[76:79]
    buffer_load_dwordx4 v19, s[20:23], s50 offen offset:1024 lds
    v_mfma_f32_16x16x32_bf16 v[76:79], a[52:55], a[68:71], v[76:79]
    ds_read_b128 a[232:235], v26 offset:10240
    v_mfma_f32_16x16x32_bf16 v[92:95], a[52:55], a[76:79], v[92:95]
    v_mfma_f32_16x16x32_bf16 v[92:95], a[48:51], a[72:75], v[92:95]
    buffer_load_dwordx4 v20, s[20:23], s50 offen offset:2048 lds
    ds_read_b64_tr_b16 a[20:21], v30 offset:16384
    v_mfma_f32_16x16x32_bf16 v[108:111], a[48:51], a[80:83], v[108:111]
    ds_read_b128 a[236:239], v27 offset:10240
    v_mfma_f32_16x16x32_bf16 v[108:111], a[52:55], a[84:87], v[108:111]
    v_mfma_f32_16x16x32_bf16 v[124:127], a[52:55], a[92:95], v[124:127]
    ds_read_b64_tr_b16 a[22:23], v30 offset:18432
    v_mfma_f32_16x16x32_bf16 v[124:127], a[48:51], a[88:91], v[124:127]
    buffer_load_dwordx4 v21, s[20:23], s50 offen offset:3072 lds
    v_mfma_f32_16x16x32_bf16 v[140:143], a[48:51], a[96:99], v[140:143]
    s_add_u32 m0, s48, 102400
    ds_read_b128 a[240:243], v26 offset:12288
    v_mfma_f32_16x16x32_bf16 v[140:143], a[52:55], a[100:103], v[140:143]
    ds_read_b64_tr_b16 a[24:25], v31 offset:0
    v_mfma_f32_16x16x32_bf16 v[156:159], a[52:55], a[108:111], v[156:159]
    buffer_load_dwordx4 v22, s[20:23], s50 offen offset:0 lds
    v_mfma_f32_16x16x32_bf16 v[156:159], a[48:51], a[104:107], v[156:159]
    ds_read_b128 a[244:247], v27 offset:12288
    v_mfma_f32_16x16x32_bf16 a[152:155], a[48:51], a[112:115], a[152:155]
    v_mfma_f32_16x16x32_bf16 a[152:155], a[52:55], a[116:119], a[152:155]
    ds_read_b64_tr_b16 a[26:27], v31 offset:2048
    v_mfma_f32_16x16x32_bf16 a[184:187], a[52:55], a[124:127], a[184:187]
    buffer_load_dwordx4 v23, s[20:23], s50 offen offset:1024 lds
    ds_read_b128 a[248:251], v26 offset:14336
    v_mfma_f32_16x16x32_bf16 a[184:187], a[48:51], a[120:123], a[184:187]
    v_mfma_f32_16x16x32_bf16 a[188:191], a[56:59], a[120:123], a[188:191]
    ds_read_b64_tr_b16 a[28:29], v31 offset:16384
    v_mfma_f32_16x16x32_bf16 a[188:191], a[60:63], a[124:127], a[188:191]
    buffer_load_dwordx4 v24, s[20:23], s50 offen offset:2048 lds
    v_mfma_f32_16x16x32_bf16 a[156:159], a[60:63], a[116:119], a[156:159]
    ds_read_b128 a[252:255], v27 offset:14336
    v_mfma_f32_16x16x32_bf16 a[156:159], a[56:59], a[112:115], a[156:159]
    ds_read_b64_tr_b16 a[30:31], v31 offset:18432
    v_mfma_f32_16x16x32_bf16 v[252:255], a[56:59], a[104:107], v[252:255]
    v_mfma_f32_16x16x32_bf16 v[252:255], a[60:63], a[108:111], v[252:255]
    buffer_load_dwordx4 v25, s[20:23], s50 offen offset:3072 lds
    v_mfma_f32_16x16x32_bf16 v[236:239], a[60:63], a[100:103], v[236:239]
    v_mfma_f32_16x16x32_bf16 v[236:239], a[56:59], a[96:99], v[236:239]
    s_add_u32 s50, s50, 0x80000
    v_mfma_f32_16x16x32_bf16 v[220:223], a[56:59], a[88:91], v[220:223]
    v_mfma_f32_16x16x32_bf16 v[220:223], a[60:63], a[92:95], v[220:223]
    s_cmp_eq_u32 s51, s53
    s_cbranch_scc1 k12_ool_22
k12_oolret_23:
    v_mfma_f32_16x16x32_bf16 v[204:207], a[60:63], a[84:87], v[204:207]
    s_cmp_eq_u32 s51, s63
    s_cbranch_scc1 k12_ool_24
k12_oolret_25:
    v_mfma_f32_16x16x32_bf16 v[204:207], a[56:59], a[80:83], v[204:207]
    s_cmp_eq_u32 s51, 5
    s_cbranch_scc1 k12_ool_26
k12_oolret_27:
    v_mfma_f32_16x16x32_bf16 v[188:191], a[56:59], a[72:75], v[188:191]
    v_mfma_f32_16x16x32_bf16 v[188:191], a[60:63], a[76:79], v[188:191]
    s_add_u32 s51, s51, 1
    v_mfma_f32_16x16x32_bf16 v[172:175], a[60:63], a[68:71], v[172:175]
    v_mfma_f32_16x16x32_bf16 v[172:175], a[56:59], a[64:67], v[172:175]
    s_waitcnt lgkmcnt(0)
    s_branch k12_loop_8
k12_last_9:
    v_mfma_f32_16x16x32_bf16 v[64:67], a[0:3], a[64:67], v[64:67]
    buffer_load_dwordx4 a[192:195], v36, s[8:11], s62 offen sc1
    v_mfma_f32_16x16x32_bf16 v[64:67], a[4:7], a[68:71], v[64:67]
    ds_read_b64_tr_b16 a[32:33], v32 offset:32768
    v_mfma_f32_16x16x32_bf16 v[160:163], a[12:15], a[68:71], v[160:163]
    buffer_load_dwordx4 a[196:199], v54, s[8:11], s62 offen sc1
    ds_read_b64_tr_b16 a[34:35], v32 offset:34816
    v_mfma_f32_16x16x32_bf16 v[160:163], a[8:11], a[64:67], v[160:163]
    v_mfma_f32_16x16x32_bf16 v[80:83], a[0:3], a[72:75], v[80:83]
    buffer_load_dwordx4 a[200:203], v37, s[8:11], s62 offen sc1
    v_mfma_f32_16x16x32_bf16 v[80:83], a[4:7], a[76:79], v[80:83]
    ds_read_b64_tr_b16 a[36:37], v32 offset:49152
    v_mfma_f32_16x16x32_bf16 v[176:179], a[12:15], a[76:79], v[176:179]
    buffer_load_dwordx4 a[204:207], v55, s[8:11], s62 offen sc1
    v_mfma_f32_16x16x32_bf16 v[176:179], a[8:11], a[72:75], v[176:179]
    s_add_u32 s62, s62, 0x20000
    buffer_load_dwordx4 a[208:211], v36, s[8:11], s62 offen sc1
    ds_read_b64_tr_b16 a[38:39], v32 offset:51200
    v_mfma_f32_16x16x32_bf16 v[96:99], a[0:3], a[80:83], v[96:99]
    v_mfma_f32_16x16x32_bf16 v[96:99], a[4:7], a[84:87], v[96:99]
    v_cvt_pk_bf16_f32 v64, v64, v65
    v_cvt_pk_bf16_f32 v65, v66, v67
    v_mfma_f32_16x16x32_bf16 v[192:195], a[12:15], a[84:87], v[192:195]
    v_cvt_pk_bf16_f32 v66, v160, v161
    v_cvt_pk_bf16_f32 v67, v162, v163
    v_mfma_f32_16x16x32_bf16 v[192:195], a[8:11], a[80:83], v[192:195]
    buffer_load_dwordx4 a[212:215], v54, s[8:11], s62 offen sc1
    ds_read_b64_tr_b16 a[40:41], v33 offset:32768
    v_mfma_f32_16x16x32_bf16 v[112:115], a[0:3], a[88:91], v[112:115]
    buffer_load_dwordx4 a[216:219], v37, s[8:11], s62 offen sc1
    ds_read_b64_tr_b16 a[42:43], v33 offset:34816
    v_mfma_f32_16x16x32_bf16 v[112:115], a[4:7], a[92:95], v[112:115]
    v_cvt_pk_bf16_f32 v80, v80, v81
    v_cvt_pk_bf16_f32 v81, v82, v83
    v_mfma_f32_16x16x32_bf16 v[208:211], a[12:15], a[92:95], v[208:211]
    v_cvt_pk_bf16_f32 v82, v176, v177
    v_cvt_pk_bf16_f32 v83, v178, v179
    v_mfma_f32_16x16x32_bf16 v[208:211], a[8:11], a[88:91], v[208:211]
    buffer_load_dwordx4 a[220:223], v55, s[8:11], s62 offen sc1
    ds_read_b64_tr_b16 a[44:45], v33 offset:49152
    v_mfma_f32_16x16x32_bf16 v[128:131], a[0:3], a[96:99], v[128:131]
    s_add_u32 s62, s62, 0x20000
    buffer_load_dwordx4 a[224:227], v36, s[8:11], s62 offen sc1
    v_mfma_f32_16x16x32_bf16 v[128:131], a[4:7], a[100:103], v[128:131]
    v_cvt_pk_bf16_f32 v96, v96, v97
    v_cvt_pk_bf16_f32 v97, v98, v99
    v_mfma_f32_16x16x32_bf16 v[224:227], a[12:15], a[100:103], v[224:227]
    buffer_load_dwordx4 a[228:231], v54, s[8:11], s62 offen sc1
    ds_read_b64_tr_b16 a[46:47], v33 offset:51200
    v_mfma_f32_16x16x32_bf16 v[224:227], a[8:11], a[96:99], v[224:227]
    v_cvt_pk_bf16_f32 v98, v192, v193
    v_cvt_pk_bf16_f32 v99, v194, v195
    v_mfma_f32_16x16x32_bf16 v[144:147], a[0:3], a[104:107], v[144:147]
    buffer_load_dwordx4 a[232:235], v37, s[8:11], s62 offen sc1
    ds_read_b64_tr_b16 a[48:49], v34 offset:32768
    v_mfma_f32_16x16x32_bf16 v[144:147], a[4:7], a[108:111], v[144:147]
    v_cvt_pk_bf16_f32 v112, v112, v113
    v_cvt_pk_bf16_f32 v113, v114, v115
    v_mfma_f32_16x16x32_bf16 v[240:243], a[12:15], a[108:111], v[240:243]
    buffer_load_dwordx4 a[236:239], v55, s[8:11], s62 offen sc1
    ds_read_b64_tr_b16 a[50:51], v34 offset:34816
    v_mfma_f32_16x16x32_bf16 v[240:243], a[8:11], a[104:107], v[240:243]
    s_add_u32 s62, s62, 0x20000
    v_cvt_pk_bf16_f32 v114, v208, v209
    v_cvt_pk_bf16_f32 v115, v210, v211
    v_mfma_f32_16x16x32_bf16 a[128:131], a[0:3], a[112:115], a[128:131]
    buffer_load_dwordx4 a[240:243], v36, s[8:11], s62 offen sc1
    ds_read_b64_tr_b16 a[52:53], v34 offset:49152
    v_mfma_f32_16x16x32_bf16 a[128:131], a[4:7], a[116:119], a[128:131]
    v_cvt_pk_bf16_f32 v128, v128, v129
    v_cvt_pk_bf16_f32 v129, v130, v131
    v_mfma_f32_16x16x32_bf16 a[132:135], a[12:15], a[116:119], a[132:135]
    buffer_load_dwordx4 a[244:247], v54, s[8:11], s62 offen sc1
    buffer_load_dwordx4 a[248:251], v37, s[8:11], s62 offen sc1
    v_mfma_f32_16x16x32_bf16 a[132:135], a[8:11], a[112:115], a[132:135]
    v_cvt_pk_bf16_f32 v130, v224, v225
    v_cvt_pk_bf16_f32 v131, v226, v227
    v_mfma_f32_16x16x32_bf16 a[160:163], a[0:3], a[120:123], a[160:163]
    buffer_load_dwordx4 a[252:255], v55, s[8:11], s62 offen sc1
    ds_read_b64_tr_b16 a[54:55], v34 offset:51200
    v_mfma_f32_16x16x32_bf16 a[160:163], a[4:7], a[124:127], a[160:163]
    s_add_u32 s62, s62, 0x20000
    v_cvt_pk_bf16_f32 v144, v144, v145
    v_cvt_pk_bf16_f32 v145, v146, v147
    v_mfma_f32_16x16x32_bf16 a[164:167], a[12:15], a[124:127], a[164:167]
    ds_read_b64_tr_b16 a[56:57], v35 offset:32768
    v_cvt_pk_bf16_f32 v146, v240, v241
    v_mfma_f32_16x16x32_bf16 a[164:167], a[8:11], a[120:123], a[164:167]
    v_cvt_pk_bf16_f32 v147, v242, v243
    v_mfma_f32_16x16x32_bf16 v[68:71], a[16:19], a[64:67], v[68:71]
    s_add_u32 s52, s47, 0
    ds_read_b64_tr_b16 a[58:59], v35 offset:34816
    v_mfma_f32_16x16x32_bf16 v[68:71], a[20:23], a[68:71], v[68:71]
    v_accvgpr_read_b32 v56, a128
    v_accvgpr_read_b32 v57, a129
    v_mfma_f32_16x16x32_bf16 v[164:167], a[28:31], a[68:71], v[164:167]
    v_accvgpr_read_b32 v58, a130
    v_accvgpr_read_b32 v59, a131
    v_mfma_f32_16x16x32_bf16 v[164:167], a[24:27], a[64:67], v[164:167]
    buffer_store_dwordx4 v[64:67], v1, s[32:35], s52 offen offset:0 sc1
    ds_read_b64_tr_b16 a[60:61], v35 offset:49152
    v_mfma_f32_16x16x32_bf16 v[84:87], a[16:19], a[72:75], v[84:87]
    v_accvgpr_read_b32 v60, a132
    v_accvgpr_read_b32 v61, a133
    v_mfma_f32_16x16x32_bf16 v[84:87], a[20:23], a[76:79], v[84:87]
    v_accvgpr_read_b32 v62, a134
    v_accvgpr_read_b32 v63, a135
    v_mfma_f32_16x16x32_bf16 v[180:183], a[28:31], a[76:79], v[180:183]
    v_cvt_pk_bf16_f32 v160, v56, v57
    v_cvt_pk_bf16_f32 v161, v58, v59
    v_mfma_f32_16x16x32_bf16 v[180:183], a[24:27], a[72:75], v[180:183]
    ds_read_b64_tr_b16 a[62:63], v35 offset:51200
    v_cvt_pk_bf16_f32 v162, v60, v61
    v_mfma_f32_16x16x32_bf16 v[100:103], a[16:19], a[80:83], v[100:103]
    v_cvt_pk_bf16_f32 v163, v62, v63
    v_accvgpr_read_b32 v56, a160
    v_mfma_f32_16x16x32_bf16 v[100:103], a[20:23], a[84:87], v[100:103]
    v_accvgpr_read_b32 v57, a161
    v_accvgpr_read_b32 v58, a162
    v_mfma_f32_16x16x32_bf16 v[196:199], a[28:31], a[84:87], v[196:199]
    v_accvgpr_read_b32 v59, a163
    v_accvgpr_read_b32 v60, a164
    v_mfma_f32_16x16x32_bf16 v[196:199], a[24:27], a[80:83], v[196:199]
    s_add_u32 s52, s47, 8192
    v_accvgpr_read_b32 v61, a165
    v_accvgpr_read_b32 v62, a166
    v_mfma_f32_16x16x32_bf16 v[116:119], a[16:19], a[88:91], v[116:119]
    v_accvgpr_read_b32 v63, a167
    v_cvt_pk_bf16_f32 v176, v56, v57
    v_mfma_f32_16x16x32_bf16 v[116:119], a[20:23], a[92:95], v[116:119]
    v_cvt_pk_bf16_f32 v177, v58, v59
    v_cvt_pk_bf16_f32 v68, v68, v69
    v_mfma_f32_16x16x32_bf16 v[212:215], a[28:31], a[92:95], v[212:215]
    v_cvt_pk_bf16_f32 v178, v60, v61
    v_cvt_pk_bf16_f32 v69, v70, v71
    v_mfma_f32_16x16x32_bf16 v[212:215], a[24:27], a[88:91], v[212:215]
    v_cvt_pk_bf16_f32 v179, v62, v63
    v_cvt_pk_bf16_f32 v70, v164, v165
    v_mfma_f32_16x16x32_bf16 v[132:135], a[16:19], a[96:99], v[132:135]
    v_cvt_pk_bf16_f32 v71, v166, v167
    v_cvt_pk_bf16_f32 v84, v84, v85
    v_mfma_f32_16x16x32_bf16 v[132:135], a[20:23], a[100:103], v[132:135]
    buffer_store_dwordx4 v[96:99], v1, s[32:35], s52 offen offset:0 sc1
    v_cvt_pk_bf16_f32 v85, v86, v87
    v_mfma_f32_16x16x32_bf16 v[228:231], a[28:31], a[100:103], v[228:231]
    v_cvt_pk_bf16_f32 v86, v180, v181
    v_cvt_pk_bf16_f32 v87, v182, v183
    v_mfma_f32_16x16x32_bf16 v[228:231], a[24:27], a[96:99], v[228:231]
    v_cvt_pk_bf16_f32 v100, v100, v101
    v_cvt_pk_bf16_f32 v101, v102, v103
    v_mfma_f32_16x16x32_bf16 v[148:151], a[16:19], a[104:107], v[148:151]
    v_cvt_pk_bf16_f32 v102, v196, v197
    v_cvt_pk_bf16_f32 v103, v198, v199
    v_mfma_f32_16x16x32_bf16 v[148:151], a[20:23], a[108:111], v[148:151]
    v_cvt_pk_bf16_f32 v116, v116, v117
    v_cvt_pk_bf16_f32 v117, v118, v119
    v_mfma_f32_16x16x32_bf16 v[244:247], a[28:31], a[108:111], v[244:247]
    v_cvt_pk_bf16_f32 v118, v212, v213
    v_cvt_pk_bf16_f32 v119, v214, v215
    v_mfma_f32_16x16x32_bf16 v[244:247], a[24:27], a[104:107], v[244:247]
    s_add_u32 s52, s47, 524288
    v_mfma_f32_16x16x32_bf16 a[136:139], a[16:19], a[112:115], a[136:139]
    buffer_store_dwordx4 v[128:131], v1, s[32:35], s52 offen offset:0 sc1
    v_mfma_f32_16x16x32_bf16 a[136:139], a[20:23], a[116:119], a[136:139]
    v_cvt_pk_bf16_f32 v132, v132, v133
    v_cvt_pk_bf16_f32 v133, v134, v135
    v_mfma_f32_16x16x32_bf16 a[140:143], a[28:31], a[116:119], a[140:143]
    v_cvt_pk_bf16_f32 v134, v228, v229
    v_cvt_pk_bf16_f32 v135, v230, v231
    v_mfma_f32_16x16x32_bf16 a[140:143], a[24:27], a[112:115], a[140:143]
    v_mfma_f32_16x16x32_bf16 a[168:171], a[16:19], a[120:123], a[168:171]
    s_waitcnt lgkmcnt(0)
    v_mfma_f32_16x16x32_bf16 a[168:171], a[20:23], a[124:127], a[168:171]
    v_cvt_pk_bf16_f32 v148, v148, v149
    v_cvt_pk_bf16_f32 v149, v150, v151
    v_mfma_f32_16x16x32_bf16 a[172:175], a[28:31], a[124:127], a[172:175]
    v_cvt_pk_bf16_f32 v150, v244, v245
    v_cvt_pk_bf16_f32 v151, v246, v247
    v_mfma_f32_16x16x32_bf16 a[172:175], a[24:27], a[120:123], a[172:175]
    v_mfma_f32_16x16x32_bf16 v[72:75], a[32:35], a[64:67], v[72:75]
    v_mfma_f32_16x16x32_bf16 v[72:75], a[36:39], a[68:71], v[72:75]
    v_accvgpr_read_b32 v56, a136
    v_accvgpr_read_b32 v57, a137
    v_mfma_f32_16x16x32_bf16 v[168:171], a[44:47], a[68:71], v[168:171]
    s_add_u32 s52, s47, 532480
    v_accvgpr_read_b32 v58, a138
    v_accvgpr_read_b32 v59, a139
    v_mfma_f32_16x16x32_bf16 v[168:171], a[40:43], a[64:67], v[168:171]
    v_accvgpr_read_b32 v60, a140
    v_accvgpr_read_b32 v61, a141
    v_mfma_f32_16x16x32_bf16 v[88:91], a[32:35], a[72:75], v[88:91]
    v_accvgpr_read_b32 v62, a142
    v_accvgpr_read_b32 v63, a143
    v_mfma_f32_16x16x32_bf16 v[88:91], a[36:39], a[76:79], v[88:91]
    v_cvt_pk_bf16_f32 v164, v56, v57
    v_cvt_pk_bf16_f32 v165, v58, v59
    v_mfma_f32_16x16x32_bf16 v[184:187], a[44:47], a[76:79], v[184:187]
    buffer_store_dwordx4 v[160:163], v1, s[32:35], s52 offen offset:0 sc1
    v_mfma_f32_16x16x32_bf16 v[184:187], a[40:43], a[72:75], v[184:187]
    v_cvt_pk_bf16_f32 v166, v60, v61
    v_cvt_pk_bf16_f32 v167, v62, v63
    v_mfma_f32_16x16x32_bf16 v[104:107], a[32:35], a[80:83], v[104:107]
    v_accvgpr_read_b32 v56, a168
    v_accvgpr_read_b32 v57, a169
    v_mfma_f32_16x16x32_bf16 v[104:107], a[36:39], a[84:87], v[104:107]
    v_accvgpr_read_b32 v58, a170
    v_accvgpr_read_b32 v59, a171
    v_mfma_f32_16x16x32_bf16 v[200:203], a[44:47], a[84:87], v[200:203]
    v_accvgpr_read_b32 v60, a172
    v_accvgpr_read_b32 v61, a173
    v_mfma_f32_16x16x32_bf16 v[200:203], a[40:43], a[80:83], v[200:203]
    v_accvgpr_read_b32 v62, a174
    v_accvgpr_read_b32 v63, a175
    v_mfma_f32_16x16x32_bf16 v[120:123], a[32:35], a[88:91], v[120:123]
    v_cvt_pk_bf16_f32 v180, v56, v57
    v_cvt_pk_bf16_f32 v181, v58, v59
    v_mfma_f32_16x16x32_bf16 v[120:123], a[36:39], a[92:95], v[120:123]
    v_cvt_pk_bf16_f32 v72, v72, v73
    v_cvt_pk_bf16_f32 v182, v60, v61
    v_mfma_f32_16x16x32_bf16 v[216:219], a[44:47], a[92:95], v[216:219]
    s_add_u32 s52, s47, 0
    v_cvt_pk_bf16_f32 v73, v74, v75
    v_cvt_pk_bf16_f32 v183, v62, v63
    v_mfma_f32_16x16x32_bf16 v[216:219], a[40:43], a[88:91], v[216:219]
    v_cvt_pk_bf16_f32 v74, v168, v169
    v_cvt_pk_bf16_f32 v75, v170, v171
    v_mfma_f32_16x16x32_bf16 v[136:139], a[32:35], a[96:99], v[136:139]
    v_cvt_pk_bf16_f32 v88, v88, v89
    v_cvt_pk_bf16_f32 v89, v90, v91
    v_mfma_f32_16x16x32_bf16 v[136:139], a[36:39], a[100:103], v[136:139]
    v_cvt_pk_bf16_f32 v90, v184, v185
    v_cvt_pk_bf16_f32 v91, v186, v187
    v_mfma_f32_16x16x32_bf16 v[232:235], a[44:47], a[100:103], v[232:235]
    buffer_store_dwordx4 v[68:71], v1, s[32:35], s52 offen offset:1024 sc1
    v_mfma_f32_16x16x32_bf16 v[232:235], a[40:43], a[96:99], v[232:235]
    v_cvt_pk_bf16_f32 v104, v104, v105
    v_cvt_pk_bf16_f32 v105, v106, v107
    v_mfma_f32_16x16x32_bf16 v[152:155], a[32:35], a[104:107], v[152:155]
    v_cvt_pk_bf16_f32 v106, v200, v201
    v_cvt_pk_bf16_f32 v107, v202, v203
    v_mfma_f32_16x16x32_bf16 v[152:155], a[36:39], a[108:111], v[152:155]
    v_cvt_pk_bf16_f32 v120, v120, v121
    v_cvt_pk_bf16_f32 v121, v122, v123
    v_mfma_f32_16x16x32_bf16 v[248:251], a[44:47], a[108:111], v[248:251]
    v_cvt_pk_bf16_f32 v122, v216, v217
    v_cvt_pk_bf16_f32 v123, v218, v219
    v_mfma_f32_16x16x32_bf16 v[248:251], a[40:43], a[104:107], v[248:251]
    v_mfma_f32_16x16x32_bf16 a[144:147], a[32:35], a[112:115], a[144:147]
    v_mfma_f32_16x16x32_bf16 a[144:147], a[36:39], a[116:119], a[144:147]
    s_add_u32 s52, s47, 8192
    v_cvt_pk_bf16_f32 v136, v136, v137
    v_cvt_pk_bf16_f32 v137, v138, v139
    v_mfma_f32_16x16x32_bf16 a[148:151], a[44:47], a[116:119], a[148:151]
    v_cvt_pk_bf16_f32 v138, v232, v233
    v_cvt_pk_bf16_f32 v139, v234, v235
    v_mfma_f32_16x16x32_bf16 a[148:151], a[40:43], a[112:115], a[148:151]
    buffer_store_dwordx4 v[100:103], v1, s[32:35], s52 offen offset:1024 sc1
    v_mfma_f32_16x16x32_bf16 a[176:179], a[32:35], a[120:123], a[176:179]
    v_mfma_f32_16x16x32_bf16 a[176:179], a[36:39], a[124:127], a[176:179]
    v_cvt_pk_bf16_f32 v152, v152, v153
    v_cvt_pk_bf16_f32 v153, v154, v155
    v_mfma_f32_16x16x32_bf16 a[180:183], a[44:47], a[124:127], a[180:183]
    v_cvt_pk_bf16_f32 v154, v248, v249
    v_cvt_pk_bf16_f32 v155, v250, v251
    v_mfma_f32_16x16x32_bf16 a[180:183], a[40:43], a[120:123], a[180:183]
    v_mfma_f32_16x16x32_bf16 v[76:79], a[48:51], a[64:67], v[76:79]
    s_waitcnt vmcnt(16)
    s_barrier
    v_mfma_f32_16x16x32_bf16 v[76:79], a[52:55], a[68:71], v[76:79]
    ds_read_b64_tr_b16 a[0:1], v42 offset:32768
    v_accvgpr_read_b32 v56, a144
    v_mfma_f32_16x16x32_bf16 v[172:175], a[60:63], a[68:71], v[172:175]
    v_accvgpr_read_b32 v57, a145
    v_accvgpr_read_b32 v58, a146
    v_mfma_f32_16x16x32_bf16 v[172:175], a[56:59], a[64:67], v[172:175]
    ds_read_b64_tr_b16 a[2:3], v42 offset:33792
    v_accvgpr_read_b32 v59, a147
    v_mfma_f32_16x16x32_bf16 v[92:95], a[48:51], a[72:75], v[92:95]
    v_accvgpr_read_b32 v60, a148
    v_accvgpr_read_b32 v61, a149
    v_mfma_f32_16x16x32_bf16 v[92:95], a[52:55], a[76:79], v[92:95]
    s_add_u32 s52, s47, 524288
    ds_read_b64_tr_b16 a[4:5], v42 offset:40960
    v_accvgpr_read_b32 v62, a150
    v_mfma_f32_16x16x32_bf16 v[188:191], a[60:63], a[76:79], v[188:191]
    v_accvgpr_read_b32 v63, a151
    v_cvt_pk_bf16_f32 v168, v56, v57
    v_mfma_f32_16x16x32_bf16 v[188:191], a[56:59], a[72:75], v[188:191]
    v_cvt_pk_bf16_f32 v169, v58, v59
    v_cvt_pk_bf16_f32 v170, v60, v61
    v_mfma_f32_16x16x32_bf16 v[108:111], a[48:51], a[80:83], v[108:111]
    ds_read_b64_tr_b16 a[6:7], v42 offset:41984
    v_cvt_pk_bf16_f32 v171, v62, v63
    v_mfma_f32_16x16x32_bf16 v[108:111], a[52:55], a[84:87], v[108:111]
    v_accvgpr_read_b32 v56, a176
    v_accvgpr_read_b32 v57, a177
    v_mfma_f32_16x16x32_bf16 v[204:207], a[60:63], a[84:87], v[204:207]
    v_accvgpr_read_b32 v58, a178
    v_accvgpr_read_b32 v59, a179
    v_mfma_f32_16x16x32_bf16 v[204:207], a[56:59], a[80:83], v[204:207]
    ds_read_b64_tr_b16 a[8:9], v43 offset:32768
    v_accvgpr_read_b32 v60, a180
    v_mfma_f32_16x16x32_bf16 v[124:127], a[48:51], a[88:91], v[124:127]
    buffer_store_dwordx4 v[132:135], v1, s[32:35], s52 offen offset:1024 sc1
    v_accvgpr_read_b32 v61, a181
    v_mfma_f32_16x16x32_bf16 v[124:127], a[52:55], a[92:95], v[124:127]
    v_accvgpr_read_b32 v62, a182
    v_accvgpr_read_b32 v63, a183
    v_mfma_f32_16x16x32_bf16 v[220:223], a[60:63], a[92:95], v[220:223]
    ds_read_b64_tr_b16 a[10:11], v43 offset:33792
    v_cvt_pk_bf16_f32 v184, v56, v57
    v_mfma_f32_16x16x32_bf16 v[220:223], a[56:59], a[88:91], v[220:223]
    v_cvt_pk_bf16_f32 v185, v58, v59
    v_cvt_pk_bf16_f32 v76, v76, v77
    v_mfma_f32_16x16x32_bf16 v[140:143], a[48:51], a[96:99], v[140:143]
    s_add_u32 s52, s47, 532480
    v_cvt_pk_bf16_f32 v186, v60, v61
    v_cvt_pk_bf16_f32 v77, v78, v79
    v_mfma_f32_16x16x32_bf16 v[140:143], a[52:55], a[100:103], v[140:143]
    ds_read_b64_tr_b16 a[12:13], v43 offset:40960
    v_cvt_pk_bf16_f32 v187, v62, v63
    v_mfma_f32_16x16x32_bf16 v[236:239], a[60:63], a[100:103], v[236:239]
    v_cvt_pk_bf16_f32 v78, v172, v173
    v_cvt_pk_bf16_f32 v79, v174, v175
    v_mfma_f32_16x16x32_bf16 v[236:239], a[56:59], a[96:99], v[236:239]
    ds_read_b64_tr_b16 a[14:15], v43 offset:41984
    ds_read_b64_tr_b16 a[16:17], v44 offset:32768
    v_mfma_f32_16x16x32_bf16 v[156:159], a[48:51], a[104:107], v[156:159]
    v_cvt_pk_bf16_f32 v92, v92, v93
    v_cvt_pk_bf16_f32 v93, v94, v95
    v_mfma_f32_16x16x32_bf16 v[156:159], a[52:55], a[108:111], v[156:159]
    ds_read_b64_tr_b16 a[18:19], v44 offset:33792
    v_cvt_pk_bf16_f32 v94, v188, v189
    v_mfma_f32_16x16x32_bf16 v[252:255], a[60:63], a[108:111], v[252:255]
    ds_read_b64_tr_b16 a[20:21], v44 offset:40960
    v_cvt_pk_bf16_f32 v95, v190, v191
    v_mfma_f32_16x16x32_bf16 v[252:255], a[56:59], a[104:107], v[252:255]
    ds_read_b64_tr_b16 a[22:23], v44 offset:41984
    v_cvt_pk_bf16_f32 v108, v108, v109
    v_mfma_f32_16x16x32_bf16 a[152:155], a[48:51], a[112:115], a[152:155]
    v_cvt_pk_bf16_f32 v109, v110, v111
    v_cvt_pk_bf16_f32 v110, v204, v205
    v_mfma_f32_16x16x32_bf16 a[152:155], a[52:55], a[116:119], a[152:155]
    ds_read_b64_tr_b16 a[24:25], v45 offset:32768
    v_cvt_pk_bf16_f32 v111, v206, v207
    v_mfma_f32_16x16x32_bf16 a[156:159], a[60:63], a[116:119], a[156:159]
    buffer_store_dwordx4 v[164:167], v1, s[32:35], s52 offen offset:1024 sc1
    ds_read_b64_tr_b16 a[26:27], v45 offset:33792
    v_mfma_f32_16x16x32_bf16 a[156:159], a[56:59], a[112:115], a[156:159]
    ds_read_b64_tr_b16 a[28:29], v45 offset:40960
    v_cvt_pk_bf16_f32 v124, v124, v125
    v_mfma_f32_16x16x32_bf16 a[184:187], a[48:51], a[120:123], a[184:187]
    v_cvt_pk_bf16_f32 v125, v126, v127
    v_cvt_pk_bf16_f32 v126, v220, v221
    v_mfma_f32_16x16x32_bf16 a[184:187], a[52:55], a[124:127], a[184:187]
    ds_read_b64_tr_b16 a[30:31], v45 offset:41984
    v_cvt_pk_bf16_f32 v127, v222, v223
    v_mfma_f32_16x16x32_bf16 a[188:191], a[60:63], a[124:127], a[188:191]
    v_cvt_pk_bf16_f32 v140, v140, v141
    v_cvt_pk_bf16_f32 v141, v142, v143
    v_mfma_f32_16x16x32_bf16 a[188:191], a[56:59], a[120:123], a[188:191]
    v_cvt_pk_bf16_f32 v142, v236, v237
    v_cvt_pk_bf16_f32 v143, v238, v239
    v_cvt_pk_bf16_f32 v156, v156, v157
    v_cvt_pk_bf16_f32 v157, v158, v159
    v_cvt_pk_bf16_f32 v158, v252, v253
    v_cvt_pk_bf16_f32 v159, v254, v255
    v_accvgpr_read_b32 v56, a152
    v_accvgpr_read_b32 v57, a153
    v_accvgpr_read_b32 v58, a154
    v_accvgpr_read_b32 v59, a155
    v_accvgpr_read_b32 v60, a156
    v_accvgpr_read_b32 v61, a157
    v_accvgpr_read_b32 v62, a158
    v_accvgpr_read_b32 v63, a159
    v_cvt_pk_bf16_f32 v172, v56, v57
    v_cvt_pk_bf16_f32 v173, v58, v59
    v_cvt_pk_bf16_f32 v174, v60, v61
    v_cvt_pk_bf16_f32 v175, v62, v63
    v_accvgpr_read_b32 v56, a184
    v_accvgpr_read_b32 v57, a185
    v_accvgpr_read_b32 v58, a186
    v_accvgpr_read_b32 v59, a187
    v_accvgpr_read_b32 v60, a188
    v_accvgpr_read_b32 v61, a189
    v_accvgpr_read_b32 v62, a190
    v_accvgpr_read_b32 v63, a191
    v_cvt_pk_bf16_f32 v188, v56, v57
    v_cvt_pk_bf16_f32 v189, v58, v59
    v_cvt_pk_bf16_f32 v190, v60, v61
    v_cvt_pk_bf16_f32 v191, v62, v63
    s_branch k12_join_7
k12_v_6:
k12_loop_28:
    v_mfma_f32_16x16x32_bf16 v[64:67], a[192:195], a[0:3], v[64:67]
    v_mfma_f32_16x16x32_bf16 v[64:67], a[196:199], a[4:7], v[64:67]
    ds_read_b64_tr_b16 a[32:33], v32 offset:0
    v_mfma_f32_16x16x32_bf16 v[160:163], a[204:207], a[4:7], v[160:163]
    v_mfma_f32_16x16x32_bf16 v[160:163], a[200:203], a[0:3], v[160:163]
    ds_read_b64_tr_b16 a[34:35], v32 offset:2048
    v_mfma_f32_16x16x32_bf16 v[96:99], a[208:211], a[0:3], v[96:99]
    s_cmp_eq_u32 s51, s46
    s_cbranch_scc1 k12_ool_30
k12_oolret_31:
    v_mfma_f32_16x16x32_bf16 v[96:99], a[212:215], a[4:7], v[96:99]
    v_mfma_f32_16x16x32_bf16 v[192:195], a[220:223], a[4:7], v[192:195]
    ds_read_b64_tr_b16 a[36:37], v32 offset:16384
    v_mfma_f32_16x16x32_bf16 v[192:195], a[216:219], a[0:3], v[192:195]
    v_mfma_f32_16x16x32_bf16 v[128:131], a[224:227], a[0:3], v[128:131]
    v_mfma_f32_16x16x32_bf16 v[128:131], a[228:231], a[4:7], v[128:131]
    ds_read_b64_tr_b16 a[38:39], v32 offset:18432
    v_mfma_f32_16x16x32_bf16 v[224:227], a[236:239], a[4:7], v[224:227]
    v_mfma_f32_16x16x32_bf16 v[224:227], a[232:235], a[0:3], v[224:227]
    v_mfma_f32_16x16x32_bf16 a[128:131], a[240:243], a[0:3], a[128:131]
    ds_read_b64_tr_b16 a[40:41], v33 offset:0
    v_mfma_f32_16x16x32_bf16 a[128:131], a[244:247], a[4:7], a[128:131]
    v_mfma_f32_16x16x32_bf16 a[132:135], a[252:255], a[4:7], a[132:135]
    v_mfma_f32_16x16x32_bf16 a[132:135], a[248:251], a[0:3], a[132:135]
    ds_read_b64_tr_b16 a[42:43], v33 offset:2048
    v_mfma_f32_16x16x32_bf16 a[140:143], a[248:251], a[8:11], a[140:143]
    v_mfma_f32_16x16x32_bf16 a[140:143], a[252:255], a[12:15], a[140:143]
    v_mfma_f32_16x16x32_bf16 a[136:139], a[244:247], a[12:15], a[136:139]
    ds_read_b64_tr_b16 a[44:45], v33 offset:16384
    v_mfma_f32_16x16x32_bf16 a[136:139], a[240:243], a[8:11], a[136:139]
    v_mfma_f32_16x16x32_bf16 v[228:231], a[232:235], a[8:11], v[228:231]
    v_mfma_f32_16x16x32_bf16 v[228:231], a[236:239], a[12:15], v[228:231]
    ds_read_b64_tr_b16 a[46:47], v33 offset:18432
    v_mfma_f32_16x16x32_bf16 v[132:135], a[228:231], a[12:15], v[132:135]
    v_mfma_f32_16x16x32_bf16 v[132:135], a[224:227], a[8:11], v[132:135]
    ds_read_b64_tr_b16 a[48:49], v34 offset:0
    v_mfma_f32_16x16x32_bf16 v[196:199], a[216:219], a[8:11], v[196:199]
    v_mfma_f32_16x16x32_bf16 v[196:199], a[220:223], a[12:15], v[196:199]
    v_mfma_f32_16x16x32_bf16 v[100:103], a[212:215], a[12:15], v[100:103]
    ds_read_b64_tr_b16 a[50:51], v34 offset:2048
    v_mfma_f32_16x16x32_bf16 v[100:103], a[208:211], a[8:11], v[100:103]
    v_mfma_f32_16x16x32_bf16 v[164:167], a[200:203], a[8:11], v[164:167]
    v_mfma_f32_16x16x32_bf16 v[164:167], a[204:207], a[12:15], v[164:167]
    ds_read_b64_tr_b16 a[52:53], v34 offset:16384
    v_mfma_f32_16x16x32_bf16 v[68:71], a[196:199], a[12:15], v[68:71]
    v_mfma_f32_16x16x32_bf16 v[68:71], a[192:195], a[8:11], v[68:71]
    v_mfma_f32_16x16x32_bf16 v[72:75], a[192:195], a[16:19], v[72:75]
    ds_read_b64_tr_b16 a[54:55], v34 offset:18432
    v_mfma_f32_16x16x32_bf16 v[72:75], a[196:199], a[20:23], v[72:75]
    v_mfma_f32_16x16x32_bf16 v[168:171], a[204:207], a[20:23], v[168:171]
    v_mfma_f32_16x16x32_bf16 v[168:171], a[200:203], a[16:19], v[168:171]
    ds_read_b64_tr_b16 a[56:57], v35 offset:0
    v_mfma_f32_16x16x32_bf16 v[104:107], a[208:211], a[16:19], v[104:107]
    v_mfma_f32_16x16x32_bf16 v[104:107], a[212:215], a[20:23], v[104:107]
    v_mfma_f32_16x16x32_bf16 v[200:203], a[220:223], a[20:23], v[200:203]
    ds_read_b64_tr_b16 a[58:59], v35 offset:2048
    v_mfma_f32_16x16x32_bf16 v[200:203], a[216:219], a[16:19], v[200:203]
    v_mfma_f32_16x16x32_bf16 v[136:139], a[224:227], a[16:19], v[136:139]
    v_mfma_f32_16x16x32_bf16 v[136:139], a[228:231], a[20:23], v[136:139]
    ds_read_b64_tr_b16 a[60:61], v35 offset:16384
    v_mfma_f32_16x16x32_bf16 v[232:235], a[236:239], a[20:23], v[232:235]
    v_mfma_f32_16x16x32_bf16 v[232:235], a[232:235], a[16:19], v[232:235]
    v_mfma_f32_16x16x32_bf16 a[144:147], a[240:243], a[16:19], a[144:147]
    ds_read_b64_tr_b16 a[62:63], v35 offset:18432
    v_mfma_f32_16x16x32_bf16 a[144:147], a[244:247], a[20:23], a[144:147]
    v_mfma_f32_16x16x32_bf16 a[148:151], a[252:255], a[20:23], a[148:151]
    v_mfma_f32_16x16x32_bf16 a[148:151], a[248:251], a[16:19], a[148:151]
    v_mfma_f32_16x16x32_bf16 a[156:159], a[248:251], a[24:27], a[156:159]
    v_mfma_f32_16x16x32_bf16 a[156:159], a[252:255], a[28:31], a[156:159]
    v_mfma_f32_16x16x32_bf16 a[152:155], a[244:247], a[28:31], a[152:155]
    v_mfma_f32_16x16x32_bf16 a[152:155], a[240:243], a[24:27], a[152:155]
    v_mfma_f32_16x16x32_bf16 v[236:239], a[232:235], a[24:27], v[236:239]
    v_mfma_f32_16x16x32_bf16 v[236:239], a[236:239], a[28:31], v[236:239]
    v_mfma_f32_16x16x32_bf16 v[140:143], a[228:231], a[28:31], v[140:143]
    v_mfma_f32_16x16x32_bf16 v[140:143], a[224:227], a[24:27], v[140:143]
    v_mfma_f32_16x16x32_bf16 v[204:207], a[216:219], a[24:27], v[204:207]
    v_mfma_f32_16x16x32_bf16 v[204:207], a[220:223], a[28:31], v[204:207]
    v_mfma_f32_16x16x32_bf16 v[108:111], a[212:215], a[28:31], v[108:111]
    v_mfma_f32_16x16x32_bf16 v[108:111], a[208:211], a[24:27], v[108:111]
    v_mfma_f32_16x16x32_bf16 v[172:175], a[200:203], a[24:27], v[172:175]
    v_mfma_f32_16x16x32_bf16 v[172:175], a[204:207], a[28:31], v[172:175]
    v_mfma_f32_16x16x32_bf16 v[76:79], a[196:199], a[28:31], v[76:79]
    v_mfma_f32_16x16x32_bf16 v[76:79], a[192:195], a[24:27], v[76:79]
    s_waitcnt vmcnt(0) lgkmcnt(0)
    s_cmp_eq_u32 s51, s46
    s_cbranch_scc1 k12_ool_34
k12_oolret_35:
    s_barrier
    v_mfma_f32_16x16x32_bf16 v[80:83], a[192:195], a[32:35], v[80:83]
    s_cmp_ge_u32 s49, 1024
    s_cselect_b32 s18, 0, s18
    s_cselect_b32 s22, 0, s22
    v_mfma_f32_16x16x32_bf16 v[80:83], a[196:199], a[36:39], v[80:83]
    s_add_u32 m0, s48, 0
    ds_read_b128 a[64:67], v26 offset:32768
    v_mfma_f32_16x16x32_bf16 v[176:179], a[204:207], a[36:39], v[176:179]
    buffer_load_dwordx4 v10, s[16:19], s49 offen offset:0 lds
    ds_read_b64_tr_b16 a[0:1], v28 offset:32768
    v_mfma_f32_16x16x32_bf16 v[176:179], a[200:203], a[32:35], v[176:179]
    ds_read_b128 a[68:71], v27 offset:32768
    v_mfma_f32_16x16x32_bf16 v[112:115], a[208:211], a[32:35], v[112:115]
    buffer_load_dwordx4 v11, s[16:19], s49 offen offset:1024 lds
    v_mfma_f32_16x16x32_bf16 v[112:115], a[212:215], a[36:39], v[112:115]
    ds_read_b64_tr_b16 a[2:3], v28 offset:34816
    v_mfma_f32_16x16x32_bf16 v[208:211], a[220:223], a[36:39], v[208:211]
    v_mfma_f32_16x16x32_bf16 v[208:211], a[216:219], a[32:35], v[208:211]
    ds_read_b128 a[72:75], v26 offset:34816
    v_mfma_f32_16x16x32_bf16 v[144:147], a[224:227], a[32:35], v[144:147]
    buffer_load_dwordx4 v12, s[16:19], s49 offen offset:2048 lds
    ds_read_b64_tr_b16 a[4:5], v28 offset:49152
    v_mfma_f32_16x16x32_bf16 v[144:147], a[228:231], a[36:39], v[144:147]
    v_mfma_f32_16x16x32_bf16 v[240:243], a[236:239], a[36:39], v[240:243]
    ds_read_b128 a[76:79], v27 offset:34816
    v_mfma_f32_16x16x32_bf16 v[240:243], a[232:235], a[32:35], v[240:243]
    buffer_load_dwordx4 v13, s[16:19], s49 offen offset:3072 lds
    v_mfma_f32_16x16x32_bf16 a[160:163], a[240:243], a[32:35], a[160:163]
    ds_read_b64_tr_b16 a[6:7], v28 offset:51200
    v_mfma_f32_16x16x32_bf16 a[160:163], a[244:247], a[36:39], a[160:163]
    s_add_u32 m0, s48, 4096
    ds_read_b128 a[80:83], v26 offset:36864
    v_mfma_f32_16x16x32_bf16 a[164:167], a[252:255], a[36:39], a[164:167]
    v_mfma_f32_16x16x32_bf16 a[164:167], a[248:251], a[32:35], a[164:167]
    buffer_load_dwordx4 v14, s[16:19], s49 offen offset:0 lds
    ds_read_b64_tr_b16 a[8:9], v29 offset:32768
    v_mfma_f32_16x16x32_bf16 a[172:175], a[248:251], a[40:43], a[172:175]
    v_mfma_f32_16x16x32_bf16 a[172:175], a[252:255], a[44:47], a[172:175]
    ds_read_b128 a[84:87], v27 offset:36864
    v_mfma_f32_16x16x32_bf16 a[168:171], a[244:247], a[44:47], a[168:171]
    buffer_load_dwordx4 v15, s[16:19], s49 offen offset:1024 lds
    ds_read_b64_tr_b16 a[10:11], v29 offset:34816
    v_mfma_f32_16x16x32_bf16 a[168:171], a[240:243], a[40:43], a[168:171]
    v_mfma_f32_16x16x32_bf16 v[244:247], a[232:235], a[40:43], v[244:247]
    ds_read_b128 a[88:91], v26 offset:38912
    v_mfma_f32_16x16x32_bf16 v[244:247], a[236:239], a[44:47], v[244:247]
    v_mfma_f32_16x16x32_bf16 v[148:151], a[228:231], a[44:47], v[148:151]
    buffer_load_dwordx4 v16, s[16:19], s49 offen offset:2048 lds
    ds_read_b64_tr_b16 a[12:13], v29 offset:49152
    v_mfma_f32_16x16x32_bf16 v[148:151], a[224:227], a[40:43], v[148:151]
    ds_read_b128 a[92:95], v27 offset:38912
    v_mfma_f32_16x16x32_bf16 v[212:215], a[216:219], a[40:43], v[212:215]
    v_mfma_f32_16x16x32_bf16 v[212:215], a[220:223], a[44:47], v[212:215]
    buffer_load_dwordx4 v17, s[16:19], s49 offen offset:3072 lds
    ds_read_b64_tr_b16 a[14:15], v29 offset:51200
    v_mfma_f32_16x16x32_bf16 v[116:119], a[212:215], a[44:47], v[116:119]
    ds_read_b128 a[96:99], v26 offset:40960
    v_mfma_f32_16x16x32_bf16 v[116:119], a[208:211], a[40:43], v[116:119]
    s_add_u32 s49, s49, 128
    v_mfma_f32_16x16x32_bf16 v[180:183], a[200:203], a[40:43], v[180:183]
    s_add_u32 m0, s48, 65536
    ds_read_b64_tr_b16 a[16:17], v30 offset:32768
    v_mfma_f32_16x16x32_bf16 v[180:183], a[204:207], a[44:47], v[180:183]
    buffer_load_dwordx4 v18, s[20:23], s50 offen offset:0 lds
    v_mfma_f32_16x16x32_bf16 v[84:87], a[196:199], a[44:47], v[84:87]
    ds_read_b128 a[100:103], v27 offset:40960
    v_mfma_f32_16x16x32_bf16 v[84:87], a[192:195], a[40:43], v[84:87]
    ds_read_b64_tr_b16 a[18:19], v30 offset:34816
    v_mfma_f32_16x16x32_bf16 v[88:91], a[192:195], a[48:51], v[88:91]
    buffer_load_dwordx4 v19, s[20:23], s50 offen offset:1024 lds
    v_mfma_f32_16x16x32_bf16 v[88:91], a[196:199], a[52:55], v[88:91]
    ds_read_b128 a[104:107], v26 offset:43008
    v_mfma_f32_16x16x32_bf16 v[184:187], a[204:207], a[52:55], v[184:187]
    v_mfma_f32_16x16x32_bf16 v[184:187], a[200:203], a[48:51], v[184:187]
    buffer_load_dwordx4 v20, s[20:23], s50 offen offset:2048 lds
    ds_read_b64_tr_b16 a[20:21], v30 offset:49152
    v_mfma_f32_16x16x32_bf16 v[120:123], a[208:211], a[48:51], v[120:123]
    ds_read_b128 a[108:111], v27 offset:43008
    v_mfma_f32_16x16x32_bf16 v[120:123], a[212:215], a[52:55], v[120:123]
    v_mfma_f32_16x16x32_bf16 v[216:219], a[220:223], a[52:55], v[216:219]
    ds_read_b64_tr_b16 a[22:23], v30 offset:51200
    v_mfma_f32_16x16x32_bf16 v[216:219], a[216:219], a[48:51], v[216:219]
    buffer_load_dwordx4 v21, s[20:23], s50 offen offset:3072 lds
    v_mfma_f32_16x16x32_bf16 v[152:155], a[224:227], a[48:51], v[152:155]
    s_add_u32 m0, s48, 69632
    ds_read_b128 a[112:115], v26 offset:45056
    v_mfma_f32_16x16x32_bf16 v[152:155], a[228:231], a[52:55], v[152:155]
    ds_read_b64_tr_b16 a[24:25], v31 offset:32768
    v_mfma_f32_16x16x32_bf16 v[248:251], a[236:239], a[52:55], v[248:251]
    buffer_load_dwordx4 v22, s[20:23], s50 offen offset:0 lds
    v_mfma_f32_16x16x32_bf16 v[248:251], a[232:235], a[48:51], v[248:251]
    ds_read_b128 a[116:119], v27 offset:45056
    v_mfma_f32_16x16x32_bf16 a[176:179], a[240:243], a[48:51], a[176:179]
    v_mfma_f32_16x16x32_bf16 a[176:179], a[244:247], a[52:55], a[176:179]
    ds_read_b64_tr_b16 a[26:27], v31 offset:34816
    v_mfma_f32_16x16x32_bf16 a[180:183], a[252:255], a[52:55], a[180:183]
    buffer_load_dwordx4 v23, s[20:23], s50 offen offset:1024 lds
    ds_read_b128 a[120:123], v26 offset:47104
    v_mfma_f32_16x16x32_bf16 a[180:183], a[248:251], a[48:51], a[180:183]
    v_mfma_f32_16x16x32_bf16 a[188:191], a[248:251], a[56:59], a[188:191]
    ds_read_b64_tr_b16 a[28:29], v31 offset:49152
    v_mfma_f32_16x16x32_bf16 a[188:191], a[252:255], a[60:63], a[188:191]
    buffer_load_dwordx4 v24, s[20:23], s50 offen offset:2048 lds
    v_mfma_f32_16x16x32_bf16 a[184:187], a[244:247], a[60:63], a[184:187]
    ds_read_b128 a[124:127], v27 offset:47104
    v_mfma_f32_16x16x32_bf16 a[184:187], a[240:243], a[56:59], a[184:187]
    ds_read_b64_tr_b16 a[30:31], v31 offset:51200
    v_mfma_f32_16x16x32_bf16 v[252:255], a[232:235], a[56:59], v[252:255]
    v_mfma_f32_16x16x32_bf16 v[252:255], a[236:239], a[60:63], v[252:255]
    buffer_load_dwordx4 v25, s[20:23], s50 offen offset:3072 lds
    v_mfma_f32_16x16x32_bf16 v[156:159], a[228:231], a[60:63], v[156:159]
    v_mfma_f32_16x16x32_bf16 v[156:159], a[224:227], a[56:59], v[156:159]
    s_add_u32 s50, s50, 0x80000
    v_mfma_f32_16x16x32_bf16 v[220:223], a[216:219], a[56:59], v[220:223]
    v_mfma_f32_16x16x32_bf16 v[220:223], a[220:223], a[60:63], v[220:223]
    s_cmp_eq_u32 s51, s53
    s_cbranch_scc1 k12_ool_36
k12_oolret_37:
    v_mfma_f32_16x16x32_bf16 v[124:127], a[212:215], a[60:63], v[124:127]
    s_cmp_eq_u32 s51, s63
    s_cbranch_scc1 k12_ool_38
k12_oolret_39:
    v_mfma_f32_16x16x32_bf16 v[124:127], a[208:211], a[56:59], v[124:127]
    s_cmp_eq_u32 s51, 6
    s_cbranch_scc1 k12_ool_40
k12_oolret_41:
    v_mfma_f32_16x16x32_bf16 v[188:191], a[200:203], a[56:59], v[188:191]
    v_mfma_f32_16x16x32_bf16 v[188:191], a[204:207], a[60:63], v[188:191]
    s_add_u32 s51, s51, 1
    v_mfma_f32_16x16x32_bf16 v[92:95], a[196:199], a[60:63], v[92:95]
    v_mfma_f32_16x16x32_bf16 v[92:95], a[192:195], a[56:59], v[92:95]
    s_waitcnt lgkmcnt(0)
    s_cmp_eq_u32 s51, 7
    s_cbranch_scc1 k12_last_29
    v_mfma_f32_16x16x32_bf16 v[64:67], a[64:67], a[0:3], v[64:67]
    v_mfma_f32_16x16x32_bf16 v[64:67], a[68:71], a[4:7], v[64:67]
    ds_read_b64_tr_b16 a[32:33], v32 offset:32768
    v_mfma_f32_16x16x32_bf16 v[160:163], a[76:79], a[4:7], v[160:163]
    v_mfma_f32_16x16x32_bf16 v[160:163], a[72:75], a[0:3], v[160:163]
    ds_read_b64_tr_b16 a[34:35], v32 offset:34816
    v_mfma_f32_16x16x32_bf16 v[96:99], a[80:83], a[0:3], v[96:99]
    v_mfma_f32_16x16x32_bf16 v[96:99], a[84:87], a[4:7], v[96:99]
    v_mfma_f32_16x16x32_bf16 v[192:195], a[92:95], a[4:7], v[192:195]
    ds_read_b64_tr_b16 a[36:37], v32 offset:49152
    v_mfma_f32_16x16x32_bf16 v[192:195], a[88:91], a[0:3], v[192:195]
    v_mfma_f32_16x16x32_bf16 v[128:131], a[96:99], a[0:3], v[128:131]
    v_mfma_f32_16x16x32_bf16 v[128:131], a[100:103], a[4:7], v[128:131]
    ds_read_b64_tr_b16 a[38:39], v32 offset:51200
    v_mfma_f32_16x16x32_bf16 v[224:227], a[108:111], a[4:7], v[224:227]
    v_mfma_f32_16x16x32_bf16 v[224:227], a[104:107], a[0:3], v[224:227]
    v_mfma_f32_16x16x32_bf16 a[128:131], a[112:115], a[0:3], a[128:131]
    ds_read_b64_tr_b16 a[40:41], v33 offset:32768
    v_mfma_f32_16x16x32_bf16 a[128:131], a[116:119], a[4:7], a[128:131]
    v_mfma_f32_16x16x32_bf16 a[132:135], a[124:127], a[4:7], a[132:135]
    v_mfma_f32_16x16x32_bf16 a[132:135], a[120:123], a[0:3], a[132:135]
    ds_read_b64_tr_b16 a[42:43], v33 offset:34816
    v_mfma_f32_16x16x32_bf16 a[140:143], a[120:123], a[8:11], a[140:143]
    v_mfma_f32_16x16x32_bf16 a[140:143], a[124:127], a[12:15], a[140:143]
    v_mfma_f32_16x16x32_bf16 a[136:139], a[116:119], a[12:15], a[136:139]
    ds_read_b64_tr_b16 a[44:45], v33 offset:49152
    v_mfma_f32_16x16x32_bf16 a[136:139], a[112:115], a[8:11], a[136:139]
    v_mfma_f32_16x16x32_bf16 v[228:231], a[104:107], a[8:11], v[228:231]
    v_mfma_f32_16x16x32_bf16 v[228:231], a[108:111], a[12:15], v[228:231]
    ds_read_b64_tr_b16 a[46:47], v33 offset:51200
    v_mfma_f32_16x16x32_bf16 v[132:135], a[100:103], a[12:15], v[132:135]
    v_mfma_f32_16x16x32_bf16 v[132:135], a[96:99], a[8:11], v[132:135]
    ds_read_b64_tr_b16 a[48:49], v34 offset:32768
    v_mfma_f32_16x16x32_bf16 v[196:199], a[88:91], a[8:11], v[196:199]
    v_mfma_f32_16x16x32_bf16 v[196:199], a[92:95], a[12:15], v[196:199]
    v_mfma_f32_16x16x32_bf16 v[100:103], a[84:87], a[12:15], v[100:103]
    ds_read_b64_tr_b16 a[50:51], v34 offset:34816
    v_mfma_f32_16x16x32_bf16 v[100:103], a[80:83], a[8:11], v[100:103]
    v_mfma_f32_16x16x32_bf16 v[164:167], a[72:75], a[8:11], v[164:167]
    v_mfma_f32_16x16x32_bf16 v[164:167], a[76:79], a[12:15], v[164:167]
    ds_read_b64_tr_b16 a[52:53], v34 offset:49152
    v_mfma_f32_16x16x32_bf16 v[68:71], a[68:71], a[12:15], v[68:71]
    v_mfma_f32_16x16x32_bf16 v[68:71], a[64:67], a[8:11], v[68:71]
    v_mfma_f32_16x16x32_bf16 v[72:75], a[64:67], a[16:19], v[72:75]
    ds_read_b64_tr_b16 a[54:55], v34 offset:51200
    v_mfma_f32_16x16x32_bf16 v[72:75], a[68:71], a[20:23], v[72:75]
    v_mfma_f32_16x16x32_bf16 v[168:171], a[76:79], a[20:23], v[168:171]
    v_mfma_f32_16x16x32_bf16 v[168:171], a[72:75], a[16:19], v[168:171]
    ds_read_b64_tr_b16 a[56:57], v35 offset:32768
    v_mfma_f32_16x16x32_bf16 v[104:107], a[80:83], a[16:19], v[104:107]
    v_mfma_f32_16x16x32_bf16 v[104:107], a[84:87], a[20:23], v[104:107]
    v_mfma_f32_16x16x32_bf16 v[200:203], a[92:95], a[20:23], v[200:203]
    ds_read_b64_tr_b16 a[58:59], v35 offset:34816
    v_mfma_f32_16x16x32_bf16 v[200:203], a[88:91], a[16:19], v[200:203]
    v_mfma_f32_16x16x32_bf16 v[136:139], a[96:99], a[16:19], v[136:139]
    v_mfma_f32_16x16x32_bf16 v[136:139], a[100:103], a[20:23], v[136:139]
    ds_read_b64_tr_b16 a[60:61], v35 offset:49152
    v_mfma_f32_16x16x32_bf16 v[232:235], a[108:111], a[20:23], v[232:235]
    v_mfma_f32_16x16x32_bf16 v[232:235], a[104:107], a[16:19], v[232:235]
    v_mfma_f32_16x16x32_bf16 a[144:147], a[112:115], a[16:19], a[144:147]
    ds_read_b64_tr_b16 a[62:63], v35 offset:51200
    v_mfma_f32_16x16x32_bf16 a[144:147], a[116:119], a[20:23], a[144:147]
    v_mfma_f32_16x16x32_bf16 a[148:151], a[124:127], a[20:23], a[148:151]
    v_mfma_f32_16x16x32_bf16 a[148:151], a[120:123], a[16:19], a[148:151]
    v_mfma_f32_16x16x32_bf16 a[156:159], a[120:123], a[24:27], a[156:159]
    v_mfma_f32_16x16x32_bf16 a[156:159], a[124:127], a[28:31], a[156:159]
    v_mfma_f32_16x16x32_bf16 a[152:155], a[116:119], a[28:31], a[152:155]
    v_mfma_f32_16x16x32_bf16 a[152:155], a[112:115], a[24:27], a[152:155]
    v_mfma_f32_16x16x32_bf16 v[236:239], a[104:107], a[24:27], v[236:239]
    v_mfma_f32_16x16x32_bf16 v[236:239], a[108:111], a[28:31], v[236:239]
    v_mfma_f32_16x16x32_bf16 v[140:143], a[100:103], a[28:31], v[140:143]
    v_mfma_f32_16x16x32_bf16 v[140:143], a[96:99], a[24:27], v[140:143]
    v_mfma_f32_16x16x32_bf16 v[204:207], a[88:91], a[24:27], v[204:207]
    v_mfma_f32_16x16x32_bf16 v[204:207], a[92:95], a[28:31], v[204:207]
    v_mfma_f32_16x16x32_bf16 v[108:111], a[84:87], a[28:31], v[108:111]
    v_mfma_f32_16x16x32_bf16 v[108:111], a[80:83], a[24:27], v[108:111]
    v_mfma_f32_16x16x32_bf16 v[172:175], a[72:75], a[24:27], v[172:175]
    v_mfma_f32_16x16x32_bf16 v[172:175], a[76:79], a[28:31], v[172:175]
    v_mfma_f32_16x16x32_bf16 v[76:79], a[68:71], a[28:31], v[76:79]
    v_mfma_f32_16x16x32_bf16 v[76:79], a[64:67], a[24:27], v[76:79]
    s_waitcnt vmcnt(0) lgkmcnt(0)
    s_barrier
    v_mfma_f32_16x16x32_bf16 v[80:83], a[64:67], a[32:35], v[80:83]
    v_mfma_f32_16x16x32_bf16 v[80:83], a[68:71], a[36:39], v[80:83]
    s_add_u32 m0, s48, 32768
    ds_read_b128 a[192:195], v26 offset:0
    v_mfma_f32_16x16x32_bf16 v[176:179], a[76:79], a[36:39], v[176:179]
    buffer_load_dwordx4 v10, s[16:19], s49 offen offset:0 lds
    ds_read_b64_tr_b16 a[0:1], v28 offset:0
    v_mfma_f32_16x16x32_bf16 v[176:179], a[72:75], a[32:35], v[176:179]
    ds_read_b128 a[196:199], v27 offset:0
    v_mfma_f32_16x16x32_bf16 v[112:115], a[80:83], a[32:35], v[112:115]
    buffer_load_dwordx4 v11, s[16:19], s49 offen offset:1024 lds
    v_mfma_f32_16x16x32_bf16 v[112:115], a[84:87], a[36:39], v[112:115]
    ds_read_b64_tr_b16 a[2:3], v28 offset:2048
    v_mfma_f32_16x16x32_bf16 v[208:211], a[92:95], a[36:39], v[208:211]
    v_mfma_f32_16x16x32_bf16 v[208:211], a[88:91], a[32:35], v[208:211]
    ds_read_b128 a[200:203], v26 offset:2048
    v_mfma_f32_16x16x32_bf16 v[144:147], a[96:99], a[32:35], v[144:147]
    buffer_load_dwordx4 v12, s[16:19], s49 offen offset:2048 lds
    ds_read_b64_tr_b16 a[4:5], v28 offset:16384
    v_mfma_f32_16x16x32_bf16 v[144:147], a[100:103], a[36:39], v[144:147]
    v_mfma_f32_16x16x32_bf16 v[240:243], a[108:111], a[36:39], v[240:243]
    ds_read_b128 a[204:207], v27 offset:2048
    v_mfma_f32_16x16x32_bf16 v[240:243], a[104:107], a[32:35], v[240:243]
    buffer_load_dwordx4 v13, s[16:19], s49 offen offset:3072 lds
    v_mfma_f32_16x16x32_bf16 a[160:163], a[112:115], a[32:35], a[160:163]
    ds_read_b64_tr_b16 a[6:7], v28 offset:18432
    v_mfma_f32_16x16x32_bf16 a[160:163], a[116:119], a[36:39], a[160:163]
    s_add_u32 m0, s48, 36864
    ds_read_b128 a[208:211], v26 offset:4096
    v_mfma_f32_16x16x32_bf16 a[164:167], a[124:127], a[36:39], a[164:167]
    v_mfma_f32_16x16x32_bf16 a[164:167], a[120:123], a[32:35], a[164:167]
    buffer_load_dwordx4 v14, s[16:19], s49 offen offset:0 lds
    ds_read_b64_tr_b16 a[8:9], v29 offset:0
    v_mfma_f32_16x16x32_bf16 a[172:175], a[120:123], a[40:43], a[172:175]
    v_mfma_f32_16x16x32_bf16 a[172:175], a[124:127], a[44:47], a[172:175]
    ds_read_b128 a[212:215], v27 offset:4096
    v_mfma_f32_16x16x32_bf16 a[168:171], a[116:119], a[44:47], a[168:171]
    buffer_load_dwordx4 v15, s[16:19], s49 offen offset:1024 lds
    ds_read_b64_tr_b16 a[10:11], v29 offset:2048
    v_mfma_f32_16x16x32_bf16 a[168:171], a[112:115], a[40:43], a[168:171]
    v_mfma_f32_16x16x32_bf16 v[244:247], a[104:107], a[40:43], v[244:247]
    ds_read_b128 a[216:219], v26 offset:6144
    v_mfma_f32_16x16x32_bf16 v[244:247], a[108:111], a[44:47], v[244:247]
    v_mfma_f32_16x16x32_bf16 v[148:151], a[100:103], a[44:47], v[148:151]
    buffer_load_dwordx4 v16, s[16:19], s49 offen offset:2048 lds
    ds_read_b64_tr_b16 a[12:13], v29 offset:16384
    v_mfma_f32_16x16x32_bf16 v[148:151], a[96:99], a[40:43], v[148:151]
    ds_read_b128 a[220:223], v27 offset:6144
    v_mfma_f32_16x16x32_bf16 v[212:215], a[88:91], a[40:43], v[212:215]
    v_mfma_f32_16x16x32_bf16 v[212:215], a[92:95], a[44:47], v[212:215]
    buffer_load_dwordx4 v17, s[16:19], s49 offen offset:3072 lds
    ds_read_b64_tr_b16 a[14:15], v29 offset:18432
    v_mfma_f32_16x16x32_bf16 v[116:119], a[84:87], a[44:47], v[116:119]
    ds_read_b128 a[224:227], v26 offset:8192
    v_mfma_f32_16x16x32_bf16 v[116:119], a[80:83], a[40:43], v[116:119]
    s_add_u32 s49, s49, 128
    v_mfma_f32_16x16x32_bf16 v[180:183], a[72:75], a[40:43], v[180:183]
    s_add_u32 m0, s48, 98304
    ds_read_b64_tr_b16 a[16:17], v30 offset:0
    v_mfma_f32_16x16x32_bf16 v[180:183], a[76:79], a[44:47], v[180:183]
    buffer_load_dwordx4 v18, s[20:23], s50 offen offset:0 lds
    v_mfma_f32_16x16x32_bf16 v[84:87], a[68:71], a[44:47], v[84:87]
    ds_read_b128 a[228:231], v27 offset:8192
    v_mfma_f32_16x16x32_bf16 v[84:87], a[64:67], a[40:43], v[84:87]
    ds_read_b64_tr_b16 a[18:19], v30 offset:2048
    v_mfma_f32_16x16x32_bf16 v[88:91], a[64:67], a[48:51], v[88:91]
    buffer_load_dwordx4 v19, s[20:23], s50 offen offset:1024 lds
    v_mfma_f32_16x16x32_bf16 v[88:91], a[68:71], a[52:55], v[88:91]
    ds_read_b128 a[232:235], v26 offset:10240
    v_mfma_f32_16x16x32_bf16 v[184:187], a[76:79], a[52:55], v[184:187]
    v_mfma_f32_16x16x32_bf16 v[184:187], a[72:75], a[48:51], v[184:187]
    buffer_load_dwordx4 v20, s[20:23], s50 offen offset:2048 lds
    ds_read_b64_tr_b16 a[20:21], v30 offset:16384
    v_mfma_f32_16x16x32_bf16 v[120:123], a[80:83], a[48:51], v[120:123]
    ds_read_b128 a[236:239], v27 offset:10240
    v_mfma_f32_16x16x32_bf16 v[120:123], a[84:87], a[52:55], v[120:123]
    v_mfma_f32_16x16x32_bf16 v[216:219], a[92:95], a[52:55], v[216:219]
    ds_read_b64_tr_b16 a[22:23], v30 offset:18432
    v_mfma_f32_16x16x32_bf16 v[216:219], a[88:91], a[48:51], v[216:219]
    buffer_load_dwordx4 v21, s[20:23], s50 offen offset:3072 lds
    v_mfma_f32_16x16x32_bf16 v[152:155], a[96:99], a[48:51], v[152:155]
    s_add_u32 m0, s48, 102400
    ds_read_b128 a[240:243], v26 offset:12288
    v_mfma_f32_16x16x32_bf16 v[152:155], a[100:103], a[52:55], v[152:155]
    ds_read_b64_tr_b16 a[24:25], v31 offset:0
    v_mfma_f32_16x16x32_bf16 v[248:251], a[108:111], a[52:55], v[248:251]
    buffer_load_dwordx4 v22, s[20:23], s50 offen offset:0 lds
    v_mfma_f32_16x16x32_bf16 v[248:251], a[104:107], a[48:51], v[248:251]
    ds_read_b128 a[244:247], v27 offset:12288
    v_mfma_f32_16x16x32_bf16 a[176:179], a[112:115], a[48:51], a[176:179]
    v_mfma_f32_16x16x32_bf16 a[176:179], a[116:119], a[52:55], a[176:179]
    ds_read_b64_tr_b16 a[26:27], v31 offset:2048
    v_mfma_f32_16x16x32_bf16 a[180:183], a[124:127], a[52:55], a[180:183]
    buffer_load_dwordx4 v23, s[20:23], s50 offen offset:1024 lds
    ds_read_b128 a[248:251], v26 offset:14336
    v_mfma_f32_16x16x32_bf16 a[180:183], a[120:123], a[48:51], a[180:183]
    v_mfma_f32_16x16x32_bf16 a[188:191], a[120:123], a[56:59], a[188:191]
    ds_read_b64_tr_b16 a[28:29], v31 offset:16384
    v_mfma_f32_16x16x32_bf16 a[188:191], a[124:127], a[60:63], a[188:191]
    buffer_load_dwordx4 v24, s[20:23], s50 offen offset:2048 lds
    v_mfma_f32_16x16x32_bf16 a[184:187], a[116:119], a[60:63], a[184:187]
    ds_read_b128 a[252:255], v27 offset:14336
    v_mfma_f32_16x16x32_bf16 a[184:187], a[112:115], a[56:59], a[184:187]
    ds_read_b64_tr_b16 a[30:31], v31 offset:18432
    v_mfma_f32_16x16x32_bf16 v[252:255], a[104:107], a[56:59], v[252:255]
    v_mfma_f32_16x16x32_bf16 v[252:255], a[108:111], a[60:63], v[252:255]
    buffer_load_dwordx4 v25, s[20:23], s50 offen offset:3072 lds
    v_mfma_f32_16x16x32_bf16 v[156:159], a[100:103], a[60:63], v[156:159]
    v_mfma_f32_16x16x32_bf16 v[156:159], a[96:99], a[56:59], v[156:159]
    s_add_u32 s50, s50, 0x80000
    v_mfma_f32_16x16x32_bf16 v[220:223], a[88:91], a[56:59], v[220:223]
    v_mfma_f32_16x16x32_bf16 v[220:223], a[92:95], a[60:63], v[220:223]
    s_cmp_eq_u32 s51, s53
    s_cbranch_scc1 k12_ool_42
k12_oolret_43:
    v_mfma_f32_16x16x32_bf16 v[124:127], a[84:87], a[60:63], v[124:127]
    s_cmp_eq_u32 s51, s63
    s_cbranch_scc1 k12_ool_44
k12_oolret_45:
    v_mfma_f32_16x16x32_bf16 v[124:127], a[80:83], a[56:59], v[124:127]
    s_cmp_eq_u32 s51, 5
    s_cbranch_scc1 k12_ool_46
k12_oolret_47:
    v_mfma_f32_16x16x32_bf16 v[188:191], a[72:75], a[56:59], v[188:191]
    v_mfma_f32_16x16x32_bf16 v[188:191], a[76:79], a[60:63], v[188:191]
    s_add_u32 s51, s51, 1
    v_mfma_f32_16x16x32_bf16 v[92:95], a[68:71], a[60:63], v[92:95]
    v_mfma_f32_16x16x32_bf16 v[92:95], a[64:67], a[56:59], v[92:95]
    s_waitcnt lgkmcnt(0)
    s_branch k12_loop_28
k12_last_29:
    v_mfma_f32_16x16x32_bf16 v[64:67], a[64:67], a[0:3], v[64:67]
    buffer_load_dwordx4 a[192:195], v36, s[8:11], s62 offen sc1
    v_mfma_f32_16x16x32_bf16 v[64:67], a[68:71], a[4:7], v[64:67]
    ds_read_b64_tr_b16 a[32:33], v32 offset:32768
    v_mfma_f32_16x16x32_bf16 v[160:163], a[76:79], a[4:7], v[160:163]
    buffer_load_dwordx4 a[196:199], v54, s[8:11], s62 offen sc1
    ds_read_b64_tr_b16 a[34:35], v32 offset:34816
    v_mfma_f32_16x16x32_bf16 v[160:163], a[72:75], a[0:3], v[160:163]
    v_mfma_f32_16x16x32_bf16 v[96:99], a[80:83], a[0:3], v[96:99]
    buffer_load_dwordx4 a[200:203], v37, s[8:11], s62 offen sc1
    v_mfma_f32_16x16x32_bf16 v[96:99], a[84:87], a[4:7], v[96:99]
    ds_read_b64_tr_b16 a[36:37], v32 offset:49152
    v_mfma_f32_16x16x32_bf16 v[192:195], a[92:95], a[4:7], v[192:195]
    buffer_load_dwordx4 a[204:207], v55, s[8:11], s62 offen sc1
    v_mfma_f32_16x16x32_bf16 v[192:195], a[88:91], a[0:3], v[192:195]
    s_add_u32 s62, s62, 0x20000
    buffer_load_dwordx4 a[208:211], v36, s[8:11], s62 offen sc1
    ds_read_b64_tr_b16 a[38:39], v32 offset:51200
    v_mfma_f32_16x16x32_bf16 v[128:131], a[96:99], a[0:3], v[128:131]
    v_mfma_f32_16x16x32_bf16 v[128:131], a[100:103], a[4:7], v[128:131]
    v_cvt_pk_bf16_f32 v64, v64, v65
    v_cvt_pk_bf16_f32 v65, v66, v67
    v_mfma_f32_16x16x32_bf16 v[224:227], a[108:111], a[4:7], v[224:227]
    v_cvt_pk_bf16_f32 v66, v160, v161
    v_cvt_pk_bf16_f32 v67, v162, v163
    v_mfma_f32_16x16x32_bf16 v[224:227], a[104:107], a[0:3], v[224:227]
    buffer_load_dwordx4 a[212:215], v54, s[8:11], s62 offen sc1
    ds_read_b64_tr_b16 a[40:41], v33 offset:32768
    v_mfma_f32_16x16x32_bf16 a[128:131], a[112:115], a[0:3], a[128:131]
    buffer_load_dwordx4 a[216:219], v37, s[8:11], s62 offen sc1
    ds_read_b64_tr_b16 a[42:43], v33 offset:34816
    v_mfma_f32_16x16x32_bf16 a[128:131], a[116:119], a[4:7], a[128:131]
    v_cvt_pk_bf16_f32 v96, v96, v97
    v_cvt_pk_bf16_f32 v97, v98, v99
    v_mfma_f32_16x16x32_bf16 a[132:135], a[124:127], a[4:7], a[132:135]
    v_cvt_pk_bf16_f32 v98, v192, v193
    v_cvt_pk_bf16_f32 v99, v194, v195
    v_mfma_f32_16x16x32_bf16 a[132:135], a[120:123], a[0:3], a[132:135]
    buffer_load_dwordx4 a[220:223], v55, s[8:11], s62 offen sc1
    ds_read_b64_tr_b16 a[44:45], v33 offset:49152
    v_mfma_f32_16x16x32_bf16 v[68:71], a[64:67], a[8:11], v[68:71]
    s_add_u32 s62, s62, 0x20000
    buffer_load_dwordx4 a[224:227], v36, s[8:11], s62 offen sc1
    v_mfma_f32_16x16x32_bf16 v[68:71], a[68:71], a[12:15], v[68:71]
    v_cvt_pk_bf16_f32 v128, v128, v129
    v_cvt_pk_bf16_f32 v129, v130, v131
    v_mfma_f32_16x16x32_bf16 v[164:167], a[76:79], a[12:15], v[164:167]
    buffer_load_dwordx4 a[228:231], v54, s[8:11], s62 offen sc1
    ds_read_b64_tr_b16 a[46:47], v33 offset:51200
    v_mfma_f32_16x16x32_bf16 v[164:167], a[72:75], a[8:11], v[164:167]
    v_cvt_pk_bf16_f32 v130, v224, v225
    v_cvt_pk_bf16_f32 v131, v226, v227
    v_mfma_f32_16x16x32_bf16 v[100:103], a[80:83], a[8:11], v[100:103]
    buffer_load_dwordx4 a[232:235], v37, s[8:11], s62 offen sc1
    ds_read_b64_tr_b16 a[48:49], v34 offset:32768
    v_mfma_f32_16x16x32_bf16 v[100:103], a[84:87], a[12:15], v[100:103]
    v_accvgpr_read_b32 v56, a128
    v_accvgpr_read_b32 v57, a129
    v_mfma_f32_16x16x32_bf16 v[196:199], a[92:95], a[12:15], v[196:199]
    buffer_load_dwordx4 a[236:239], v55, s[8:11], s62 offen sc1
    ds_read_b64_tr_b16 a[50:51], v34 offset:34816
    v_mfma_f32_16x16x32_bf16 v[196:199], a[88:91], a[8:11], v[196:199]
    s_add_u32 s62, s62, 0x20000
    v_accvgpr_read_b32 v58, a130
    v_accvgpr_read_b32 v59, a131
    v_mfma_f32_16x16x32_bf16 v[132:135], a[96:99], a[8:11], v[132:135]
    v_accvgpr_read_b32 v60, a132
    v_accvgpr_read_b32 v61, a133
    v_mfma_f32_16x16x32_bf16 v[132:135], a[100:103], a[12:15], v[132:135]
    v_accvgpr_read_b32 v62, a134
    v_accvgpr_read_b32 v63, a135
    v_mfma_f32_16x16x32_bf16 v[228:231], a[108:111], a[12:15], v[228:231]
    buffer_load_dwordx4 a[240:243], v36, s[8:11], s62 offen sc1
    ds_read_b64_tr_b16 a[52:53], v34 offset:49152
    v_mfma_f32_16x16x32_bf16 v[228:231], a[104:107], a[8:11], v[228:231]
    v_cvt_pk_bf16_f32 v160, v56, v57
    v_cvt_pk_bf16_f32 v161, v58, v59
    v_mfma_f32_16x16x32_bf16 a[136:139], a[112:115], a[8:11], a[136:139]
    v_cvt_pk_bf16_f32 v68, v68, v69
    v_cvt_pk_bf16_f32 v162, v60, v61
    v_mfma_f32_16x16x32_bf16 a[136:139], a[116:119], a[12:15], a[136:139]
    buffer_load_dwordx4 a[244:247], v54, s[8:11], s62 offen sc1
    v_cvt_pk_bf16_f32 v69, v70, v71
    v_mfma_f32_16x16x32_bf16 a[140:143], a[124:127], a[12:15], a[140:143]
    v_cvt_pk_bf16_f32 v163, v62, v63
    v_cvt_pk_bf16_f32 v70, v164, v165
    v_mfma_f32_16x16x32_bf16 a[140:143], a[120:123], a[8:11], a[140:143]
    buffer_load_dwordx4 a[248:251], v37, s[8:11], s62 offen sc1
    v_cvt_pk_bf16_f32 v71, v166, v167
    v_mfma_f32_16x16x32_bf16 v[72:75], a[64:67], a[16:19], v[72:75]
    ds_read_b64_tr_b16 a[54:55], v34 offset:51200
    v_cvt_pk_bf16_f32 v100, v100, v101
    v_mfma_f32_16x16x32_bf16 v[72:75], a[68:71], a[20:23], v[72:75]
    buffer_load_dwordx4 a[252:255], v55, s[8:11], s62 offen sc1
    v_cvt_pk_bf16_f32 v101, v102, v103
    v_mfma_f32_16x16x32_bf16 v[168:171], a[76:79], a[20:23], v[168:171]
    s_add_u32 s62, s62, 0x20000
    ds_read_b64_tr_b16 a[56:57], v35 offset:32768
    v_cvt_pk_bf16_f32 v102, v196, v197
    v_mfma_f32_16x16x32_bf16 v[168:171], a[72:75], a[16:19], v[168:171]
    s_add_u32 s52, s47, 0
    ds_read_b64_tr_b16 a[58:59], v35 offset:34816
    v_cvt_pk_bf16_f32 v103, v198, v199
    v_mfma_f32_16x16x32_bf16 v[104:107], a[80:83], a[16:19], v[104:107]
    v_cvt_pk_bf16_f32 v132, v132, v133
    v_cvt_pk_bf16_f32 v133, v134, v135
    v_mfma_f32_16x16x32_bf16 v[104:107], a[84:87], a[20:23], v[104:107]
    v_cvt_pk_bf16_f32 v134, v228, v229
    v_cvt_pk_bf16_f32 v135, v230, v231
    v_mfma_f32_16x16x32_bf16 v[200:203], a[92:95], a[20:23], v[200:203]
    buffer_store_dwordx4 v[64:67], v1, s[32:35], s52 offen offset:0 sc1
    ds_read_b64_tr_b16 a[60:61], v35 offset:49152
    v_mfma_f32_16x16x32_bf16 v[200:203], a[88:91], a[16:19], v[200:203]
    v_accvgpr_read_b32 v56, a136
    v_accvgpr_read_b32 v57, a137
    v_mfma_f32_16x16x32_bf16 v[136:139], a[96:99], a[16:19], v[136:139]
    ds_read_b64_tr_b16 a[62:63], v35 offset:51200
    v_accvgpr_read_b32 v58, a138
    v_mfma_f32_16x16x32_bf16 v[136:139], a[100:103], a[20:23], v[136:139]
    v_accvgpr_read_b32 v59, a139
    v_accvgpr_read_b32 v60, a140
    v_mfma_f32_16x16x32_bf16 v[232:235], a[108:111], a[20:23], v[232:235]
    v_accvgpr_read_b32 v61, a141
    v_accvgpr_read_b32 v62, a142
    v_mfma_f32_16x16x32_bf16 v[232:235], a[104:107], a[16:19], v[232:235]
    s_add_u32 s52, s47, 8192
    v_accvgpr_read_b32 v63, a143
    v_cvt_pk_bf16_f32 v164, v56, v57
    v_mfma_f32_16x16x32_bf16 a[144:147], a[112:115], a[16:19], a[144:147]
    v_cvt_pk_bf16_f32 v165, v58, v59
    v_cvt_pk_bf16_f32 v72, v72, v73
    v_mfma_f32_16x16x32_bf16 a[144:147], a[116:119], a[20:23], a[144:147]
    v_cvt_pk_bf16_f32 v166, v60, v61
    v_cvt_pk_bf16_f32 v73, v74, v75
    v_mfma_f32_16x16x32_bf16 a[148:151], a[124:127], a[20:23], a[148:151]
    v_cvt_pk_bf16_f32 v167, v62, v63
    v_cvt_pk_bf16_f32 v74, v168, v169
    v_mfma_f32_16x16x32_bf16 a[148:151], a[120:123], a[16:19], a[148:151]
    v_cvt_pk_bf16_f32 v75, v170, v171
    v_cvt_pk_bf16_f32 v104, v104, v105
    v_mfma_f32_16x16x32_bf16 v[76:79], a[64:67], a[24:27], v[76:79]
    v_cvt_pk_bf16_f32 v105, v106, v107
    v_cvt_pk_bf16_f32 v106, v200, v201
    v_mfma_f32_16x16x32_bf16 v[76:79], a[68:71], a[28:31], v[76:79]
    buffer_store_dwordx4 v[96:99], v1, s[32:35], s52 offen offset:0 sc1
    v_mfma_f32_16x16x32_bf16 v[172:175], a[76:79], a[28:31], v[172:175]
    v_cvt_pk_bf16_f32 v107, v202, v203
    v_cvt_pk_bf16_f32 v136, v136, v137
    v_mfma_f32_16x16x32_bf16 v[172:175], a[72:75], a[24:27], v[172:175]
    v_cvt_pk_bf16_f32 v137, v138, v139
    v_cvt_pk_bf16_f32 v138, v232, v233
    v_mfma_f32_16x16x32_bf16 v[108:111], a[80:83], a[24:27], v[108:111]
    v_cvt_pk_bf16_f32 v139, v234, v235
    v_mfma_f32_16x16x32_bf16 v[108:111], a[84:87], a[28:31], v[108:111]
    v_accvgpr_read_b32 v56, a144
    v_accvgpr_read_b32 v57, a145
    v_mfma_f32_16x16x32_bf16 v[204:207], a[92:95], a[28:31], v[204:207]
    v_accvgpr_read_b32 v58, a146
    v_accvgpr_read_b32 v59, a147
    v_mfma_f32_16x16x32_bf16 v[204:207], a[88:91], a[24:27], v[204:207]
    s_add_u32 s52, s47, 524288
    v_accvgpr_read_b32 v60, a148
    v_accvgpr_read_b32 v61, a149
    v_mfma_f32_16x16x32_bf16 v[140:143], a[96:99], a[24:27], v[140:143]
    v_accvgpr_read_b32 v62, a150
    v_accvgpr_read_b32 v63, a151
    v_mfma_f32_16x16x32_bf16 v[140:143], a[100:103], a[28:31], v[140:143]
    v_cvt_pk_bf16_f32 v168, v56, v57
    v_cvt_pk_bf16_f32 v169, v58, v59
    v_mfma_f32_16x16x32_bf16 v[236:239], a[108:111], a[28:31], v[236:239]
    v_cvt_pk_bf16_f32 v76, v76, v77
    v_cvt_pk_bf16_f32 v170, v60, v61
    v_mfma_f32_16x16x32_bf16 v[236:239], a[104:107], a[24:27], v[236:239]
    buffer_store_dwordx4 v[128:131], v1, s[32:35], s52 offen offset:0 sc1
    v_mfma_f32_16x16x32_bf16 a[152:155], a[112:115], a[24:27], a[152:155]
    s_waitcnt lgkmcnt(0)
    v_cvt_pk_bf16_f32 v77, v78, v79
    v_cvt_pk_bf16_f32 v171, v62, v63
    v_mfma_f32_16x16x32_bf16 a[152:155], a[116:119], a[28:31], a[152:155]
    v_cvt_pk_bf16_f32 v78, v172, v173
    v_cvt_pk_bf16_f32 v79, v174, v175
    v_mfma_f32_16x16x32_bf16 a[156:159], a[124:127], a[28:31], a[156:159]
    v_cvt_pk_bf16_f32 v108, v108, v109
    v_cvt_pk_bf16_f32 v109, v110, v111
    v_mfma_f32_16x16x32_bf16 a[156:159], a[120:123], a[24:27], a[156:159]
    v_cvt_pk_bf16_f32 v110, v204, v205
    v_cvt_pk_bf16_f32 v111, v206, v207
    v_mfma_f32_16x16x32_bf16 v[80:83], a[64:67], a[32:35], v[80:83]
    v_mfma_f32_16x16x32_bf16 v[80:83], a[68:71], a[36:39], v[80:83]
    v_cvt_pk_bf16_f32 v140, v140, v141
    v_cvt_pk_bf16_f32 v141, v142, v143
    v_mfma_f32_16x16x32_bf16 v[176:179], a[76:79], a[36:39], v[176:179]
    s_add_u32 s52, s47, 532480
    v_cvt_pk_bf16_f32 v142, v236, v237
    v_cvt_pk_bf16_f32 v143, v238, v239
    v_mfma_f32_16x16x32_bf16 v[176:179], a[72:75], a[32:35], v[176:179]
    buffer_store_dwordx4 v[160:163], v1, s[32:35], s52 offen offset:0 sc1
    v_mfma_f32_16x16x32_bf16 v[112:115], a[80:83], a[32:35], v[112:115]
    v_mfma_f32_16x16x32_bf16 v[112:115], a[84:87], a[36:39], v[112:115]
    v_accvgpr_read_b32 v56, a152
    v_accvgpr_read_b32 v57, a153
    v_mfma_f32_16x16x32_bf16 v[208:211], a[92:95], a[36:39], v[208:211]
    v_accvgpr_read_b32 v58, a154
    v_accvgpr_read_b32 v59, a155
    v_mfma_f32_16x16x32_bf16 v[208:211], a[88:91], a[32:35], v[208:211]
    v_accvgpr_read_b32 v60, a156
    v_accvgpr_read_b32 v61, a157
    v_mfma_f32_16x16x32_bf16 v[144:147], a[96:99], a[32:35], v[144:147]
    v_accvgpr_read_b32 v62, a158
    v_accvgpr_read_b32 v63, a159
    v_mfma_f32_16x16x32_bf16 v[144:147], a[100:103], a[36:39], v[144:147]
    v_cvt_pk_bf16_f32 v172, v56, v57
    v_cvt_pk_bf16_f32 v173, v58, v59
    v_mfma_f32_16x16x32_bf16 v[240:243], a[108:111], a[36:39], v[240:243]
    v_cvt_pk_bf16_f32 v80, v80, v81
    v_cvt_pk_bf16_f32 v174, v60, v61
    v_mfma_f32_16x16x32_bf16 v[240:243], a[104:107], a[32:35], v[240:243]
    v_cvt_pk_bf16_f32 v81, v82, v83
    v_cvt_pk_bf16_f32 v175, v62, v63
    v_mfma_f32_16x16x32_bf16 a[160:163], a[112:115], a[32:35], a[160:163]
    v_cvt_pk_bf16_f32 v82, v176, v177
    v_cvt_pk_bf16_f32 v83, v178, v179
    v_mfma_f32_16x16x32_bf16 a[160:163], a[116:119], a[36:39], a[160:163]
    v_cvt_pk_bf16_f32 v112, v112, v113
    v_cvt_pk_bf16_f32 v113, v114, v115
    v_mfma_f32_16x16x32_bf16 a[164:167], a[124:127], a[36:39], a[164:167]
    s_add_u32 s52, s47, 0
    v_cvt_pk_bf16_f32 v114, v208, v209
    v_cvt_pk_bf16_f32 v115, v210, v211
    v_mfma_f32_16x16x32_bf16 a[164:167], a[120:123], a[32:35], a[164:167]
    buffer_store_dwordx4 v[68:71], v1, s[32:35], s52 offen offset:1024 sc1
    v_mfma_f32_16x16x32_bf16 v[84:87], a[64:67], a[40:43], v[84:87]
    v_mfma_f32_16x16x32_bf16 v[84:87], a[68:71], a[44:47], v[84:87]
    v_cvt_pk_bf16_f32 v144, v144, v145
    v_cvt_pk_bf16_f32 v145, v146, v147
    v_mfma_f32_16x16x32_bf16 v[180:183], a[76:79], a[44:47], v[180:183]
    v_cvt_pk_bf16_f32 v146, v240, v241
    v_cvt_pk_bf16_f32 v147, v242, v243
    v_mfma_f32_16x16x32_bf16 v[180:183], a[72:75], a[40:43], v[180:183]
    v_mfma_f32_16x16x32_bf16 v[116:119], a[80:83], a[40:43], v[116:119]
    v_mfma_f32_16x16x32_bf16 v[116:119], a[84:87], a[44:47], v[116:119]
    v_accvgpr_read_b32 v56, a160
    v_accvgpr_read_b32 v57, a161
    v_mfma_f32_16x16x32_bf16 v[212:215], a[92:95], a[44:47], v[212:215]
    v_accvgpr_read_b32 v58, a162
    v_accvgpr_read_b32 v59, a163
    v_mfma_f32_16x16x32_bf16 v[212:215], a[88:91], a[40:43], v[212:215]
    v_accvgpr_read_b32 v60, a164
    v_accvgpr_read_b32 v61, a165
    v_mfma_f32_16x16x32_bf16 v[148:151], a[96:99], a[40:43], v[148:151]
    v_accvgpr_read_b32 v62, a166
    v_accvgpr_read_b32 v63, a167
    v_mfma_f32_16x16x32_bf16 v[148:151], a[100:103], a[44:47], v[148:151]
    s_add_u32 s52, s47, 8192
    v_cvt_pk_bf16_f32 v176, v56, v57
    v_cvt_pk_bf16_f32 v177, v58, v59
    v_mfma_f32_16x16x32_bf16 v[244:247], a[108:111], a[44:47], v[244:247]
    v_cvt_pk_bf16_f32 v84, v84, v85
    v_cvt_pk_bf16_f32 v178, v60, v61
    v_mfma_f32_16x16x32_bf16 v[244:247], a[104:107], a[40:43], v[244:247]
    v_cvt_pk_bf16_f32 v85, v86, v87
    v_cvt_pk_bf16_f32 v179, v62, v63
    v_mfma_f32_16x16x32_bf16 a[168:171], a[112:115], a[40:43], a[168:171]
    v_cvt_pk_bf16_f32 v86, v180, v181
    v_cvt_pk_bf16_f32 v87, v182, v183
    v_mfma_f32_16x16x32_bf16 a[168:171], a[116:119], a[44:47], a[168:171]
    buffer_store_dwordx4 v[100:103], v1, s[32:35], s52 offen offset:1024 sc1
    v_mfma_f32_16x16x32_bf16 a[172:175], a[124:127], a[44:47], a[172:175]
    v_cvt_pk_bf16_f32 v116, v116, v117
    v_cvt_pk_bf16_f32 v117, v118, v119
    v_mfma_f32_16x16x32_bf16 a[172:175], a[120:123], a[40:43], a[172:175]
    v_cvt_pk_bf16_f32 v118, v212, v213
    v_cvt_pk_bf16_f32 v119, v214, v215
    v_mfma_f32_16x16x32_bf16 v[88:91], a[64:67], a[48:51], v[88:91]
    s_waitcnt vmcnt(16)
    s_barrier
    v_mfma_f32_16x16x32_bf16 v[88:91], a[68:71], a[52:55], v[88:91]
    ds_read_b64_tr_b16 a[0:1], v42 offset:32768
    v_cvt_pk_bf16_f32 v148, v148, v149
    v_mfma_f32_16x16x32_bf16 v[184:187], a[76:79], a[52:55], v[184:187]
    v_cvt_pk_bf16_f32 v149, v150, v151
    v_cvt_pk_bf16_f32 v150, v244, v245
    v_mfma_f32_16x16x32_bf16 v[184:187], a[72:75], a[48:51], v[184:187]
    ds_read_b64_tr_b16 a[2:3], v42 offset:33792
    v_cvt_pk_bf16_f32 v151, v246, v247
    v_mfma_f32_16x16x32_bf16 v[120:123], a[80:83], a[48:51], v[120:123]
    ds_read_b64_tr_b16 a[4:5], v42 offset:40960
    ds_read_b64_tr_b16 a[6:7], v42 offset:41984
    v_mfma_f32_16x16x32_bf16 v[120:123], a[84:87], a[52:55], v[120:123]
    s_add_u32 s52, s47, 524288
    v_accvgpr_read_b32 v56, a168
    v_accvgpr_read_b32 v57, a169
    v_mfma_f32_16x16x32_bf16 v[216:219], a[92:95], a[52:55], v[216:219]
    v_accvgpr_read_b32 v58, a170
    v_accvgpr_read_b32 v59, a171
    v_mfma_f32_16x16x32_bf16 v[216:219], a[88:91], a[48:51], v[216:219]
    ds_read_b64_tr_b16 a[8:9], v43 offset:32768
    v_accvgpr_read_b32 v60, a172
    v_mfma_f32_16x16x32_bf16 v[152:155], a[96:99], a[48:51], v[152:155]
    buffer_store_dwordx4 v[132:135], v1, s[32:35], s52 offen offset:1024 sc1
    ds_read_b64_tr_b16 a[10:11], v43 offset:33792
    v_mfma_f32_16x16x32_bf16 v[152:155], a[100:103], a[52:55], v[152:155]
    v_accvgpr_read_b32 v61, a173
    v_accvgpr_read_b32 v62, a174
    v_mfma_f32_16x16x32_bf16 v[248:251], a[108:111], a[52:55], v[248:251]
    v_accvgpr_read_b32 v63, a175
    v_cvt_pk_bf16_f32 v180, v56, v57
    v_mfma_f32_16x16x32_bf16 v[248:251], a[104:107], a[48:51], v[248:251]
    v_cvt_pk_bf16_f32 v181, v58, v59
    v_cvt_pk_bf16_f32 v88, v88, v89
    v_mfma_f32_16x16x32_bf16 a[176:179], a[112:115], a[48:51], a[176:179]
    v_cvt_pk_bf16_f32 v182, v60, v61
    v_cvt_pk_bf16_f32 v89, v90, v91
    v_mfma_f32_16x16x32_bf16 a[176:179], a[116:119], a[52:55], a[176:179]
    ds_read_b64_tr_b16 a[12:13], v43 offset:40960
    v_cvt_pk_bf16_f32 v183, v62, v63
    v_mfma_f32_16x16x32_bf16 a[180:183], a[124:127], a[52:55], a[180:183]
    v_cvt_pk_bf16_f32 v90, v184, v185
    v_cvt_pk_bf16_f32 v91, v186, v187
    v_mfma_f32_16x16x32_bf16 a[180:183], a[120:123], a[48:51], a[180:183]
    ds_read_b64_tr_b16 a[14:15], v43 offset:41984
    ds_read_b64_tr_b16 a[16:17], v44 offset:32768
    v_mfma_f32_16x16x32_bf16 v[92:95], a[64:67], a[56:59], v[92:95]
    s_add_u32 s52, s47, 532480
    v_cvt_pk_bf16_f32 v120, v120, v121
    v_cvt_pk_bf16_f32 v121, v122, v123
    v_mfma_f32_16x16x32_bf16 v[92:95], a[68:71], a[60:63], v[92:95]
    ds_read_b64_tr_b16 a[18:19], v44 offset:33792
    v_cvt_pk_bf16_f32 v122, v216, v217
    v_mfma_f32_16x16x32_bf16 v[188:191], a[76:79], a[60:63], v[188:191]
    ds_read_b64_tr_b16 a[20:21], v44 offset:40960
    v_cvt_pk_bf16_f32 v123, v218, v219
    v_mfma_f32_16x16x32_bf16 v[188:191], a[72:75], a[56:59], v[188:191]
    ds_read_b64_tr_b16 a[22:23], v44 offset:41984
    v_cvt_pk_bf16_f32 v152, v152, v153
    v_mfma_f32_16x16x32_bf16 v[124:127], a[80:83], a[56:59], v[124:127]
    v_cvt_pk_bf16_f32 v153, v154, v155
    v_cvt_pk_bf16_f32 v154, v248, v249
    v_mfma_f32_16x16x32_bf16 v[124:127], a[84:87], a[60:63], v[124:127]
    ds_read_b64_tr_b16 a[24:25], v45 offset:32768
    v_cvt_pk_bf16_f32 v155, v250, v251
    v_mfma_f32_16x16x32_bf16 v[220:223], a[92:95], a[60:63], v[220:223]
    buffer_store_dwordx4 v[164:167], v1, s[32:35], s52 offen offset:1024 sc1
    ds_read_b64_tr_b16 a[26:27], v45 offset:33792
    v_mfma_f32_16x16x32_bf16 v[220:223], a[88:91], a[56:59], v[220:223]
    ds_read_b64_tr_b16 a[28:29], v45 offset:40960
    v_accvgpr_read_b32 v56, a176
    v_mfma_f32_16x16x32_bf16 v[156:159], a[96:99], a[56:59], v[156:159]
    v_accvgpr_read_b32 v57, a177
    v_accvgpr_read_b32 v58, a178
    v_mfma_f32_16x16x32_bf16 v[156:159], a[100:103], a[60:63], v[156:159]
    ds_read_b64_tr_b16 a[30:31], v45 offset:41984
    v_accvgpr_read_b32 v59, a179
    v_mfma_f32_16x16x32_bf16 v[252:255], a[108:111], a[60:63], v[252:255]
    v_accvgpr_read_b32 v60, a180
    v_accvgpr_read_b32 v61, a181
    v_mfma_f32_16x16x32_bf16 v[252:255], a[104:107], a[56:59], v[252:255]
    v_accvgpr_read_b32 v62, a182
    v_accvgpr_read_b32 v63, a183
    v_mfma_f32_16x16x32_bf16 a[184:187], a[112:115], a[56:59], a[184:187]
    v_cvt_pk_bf16_f32 v184, v56, v57
    v_cvt_pk_bf16_f32 v185, v58, v59
    v_mfma_f32_16x16x32_bf16 a[184:187], a[116:119], a[60:63], a[184:187]
    v_cvt_pk_bf16_f32 v92, v92, v93
    v_cvt_pk_bf16_f32 v186, v60, v61
    v_mfma_f32_16x16x32_bf16 a[188:191], a[124:127], a[60:63], a[188:191]
    v_cvt_pk_bf16_f32 v93, v94, v95
    v_cvt_pk_bf16_f32 v187, v62, v63
    v_mfma_f32_16x16x32_bf16 a[188:191], a[120:123], a[56:59], a[188:191]
    v_cvt_pk_bf16_f32 v94, v188, v189
    v_cvt_pk_bf16_f32 v95, v190, v191
    v_cvt_pk_bf16_f32 v124, v124, v125
    v_cvt_pk_bf16_f32 v125, v126, v127
    v_cvt_pk_bf16_f32 v126, v220, v221
    v_cvt_pk_bf16_f32 v127, v222, v223
    v_cvt_pk_bf16_f32 v156, v156, v157
    v_cvt_pk_bf16_f32 v157, v158, v159
    v_cvt_pk_bf16_f32 v158, v252, v253
    v_cvt_pk_bf16_f32 v159, v254, v255
    v_accvgpr_read_b32 v56, a184
    v_accvgpr_read_b32 v57, a185
    v_accvgpr_read_b32 v58, a186
    v_accvgpr_read_b32 v59, a187
    v_accvgpr_read_b32 v60, a188
    v_accvgpr_read_b32 v61, a189
    v_accvgpr_read_b32 v62, a190
    v_accvgpr_read_b32 v63, a191
    v_cvt_pk_bf16_f32 v188, v56, v57
    v_cvt_pk_bf16_f32 v189, v58, v59
    v_cvt_pk_bf16_f32 v190, v60, v61
    v_cvt_pk_bf16_f32 v191, v62, v63
k12_join_7:
k12_qcode:
    s_mov_b64 s[48:49], s[32:33]
    s_mov_b32 s51, 0x00020000
    s_cmp_eq_u32 s45, 0
    s_mov_b32 s50, s34
    s_cselect_b32 s56, s30, -1
    s_cselect_b32 s57, -1, s30
    s_waitcnt vmcnt(16) lgkmcnt(0)
    v_mfma_f32_16x16x32_bf16 v[192:195], a[0:3], a[192:195], 0
    v_mfma_f32_16x16x32_bf16 v[192:195], a[4:7], a[208:211], v[192:195]
    buffer_load_dwordx4 a[128:131], v36, s[8:11], s62 offen sc1
    ds_read_b64_tr_b16 a[32:33], v46 offset:32768
    v_mfma_f32_16x16x32_bf16 v[196:199], a[4:7], a[212:215], 0
    ds_read_b64_tr_b16 a[34:35], v46 offset:33792
    v_mfma_f32_16x16x32_bf16 v[196:199], a[0:3], a[196:199], v[196:199]
    ds_read_b64_tr_b16 a[36:37], v46 offset:40960
    v_mfma_f32_16x16x32_bf16 a[64:67], a[0:3], a[200:203], 0
    ds_read_b64_tr_b16 a[38:39], v46 offset:41984
    v_mfma_f32_16x16x32_bf16 a[64:67], a[4:7], a[216:219], a[64:67]
    ds_read_b64_tr_b16 a[40:41], v47 offset:32768
    v_mfma_f32_16x16x32_bf16 a[68:71], a[4:7], a[220:223], 0
    s_lshl_b32 s31, s28, 14
    v_mfma_f32_16x16x32_bf16 a[68:71], a[0:3], a[204:207], a[68:71]
    s_add_u32 s16, s6, s31
    s_addc_u32 s17, s7, 0
    buffer_load_dwordx4 a[132:135], v54, s[8:11], s62 offen sc1
    ds_read_b64_tr_b16 a[42:43], v47 offset:33792
    v_mfma_f32_16x16x32_bf16 a[76:79], a[8:11], a[204:207], 0
    ds_read_b64_tr_b16 a[44:45], v47 offset:40960
    v_mfma_f32_16x16x32_bf16 a[76:79], a[12:15], a[220:223], a[76:79]
    s_add_u32 s20, s16, 0x2000000
    s_addc_u32 s21, s17, 0
    ds_read_b64_tr_b16 a[46:47], v47 offset:41984
    v_mfma_f32_16x16x32_bf16 a[72:75], a[12:15], a[216:219], 0
    ds_read_b64_tr_b16 a[48:49], v48 offset:32768
    v_mfma_f32_16x16x32_bf16 a[72:75], a[8:11], a[200:203], a[72:75]
    s_add_u32 s16, s16, 0x1000000
    s_addc_u32 s17, s17, 0
    v_mfma_f32_16x16x32_bf16 v[204:207], a[8:11], a[196:199], 0
    ds_read_b64_tr_b16 a[50:51], v48 offset:33792
    v_mfma_f32_16x16x32_bf16 v[204:207], a[12:15], a[212:215], v[204:207]
    s_and_b32 s17, s17, 0xffff
    ds_read_b64_tr_b16 a[52:53], v48 offset:40960
    v_mfma_f32_16x16x32_bf16 v[200:203], a[12:15], a[208:211], 0
    buffer_load_dwordx4 a[136:139], v37, s[8:11], s62 offen sc1
    ds_read_b64_tr_b16 a[54:55], v48 offset:41984
    v_mfma_f32_16x16x32_bf16 v[200:203], a[8:11], a[192:195], v[200:203]
    s_and_b32 s21, s21, 0xffff
    v_mfma_f32_16x16x32_bf16 v[208:211], a[16:19], a[192:195], 0
    ds_read_b64_tr_b16 a[56:57], v49 offset:32768
    v_mfma_f32_16x16x32_bf16 v[208:211], a[20:23], a[208:211], v[208:211]
    s_lshl_b32 s31, s29, 20
    ds_read_b64_tr_b16 a[58:59], v49 offset:33792
    v_mfma_f32_16x16x32_bf16 v[212:215], a[20:23], a[212:215], 0
    ds_read_b64_tr_b16 a[60:61], v49 offset:40960
    v_mfma_f32_16x16x32_bf16 v[212:215], a[16:19], a[196:199], v[212:215]
    s_sub_u32 s18, 0xf84000, s31
    v_mfma_f32_16x16x32_bf16 a[80:83], a[16:19], a[200:203], 0
    buffer_load_dwordx4 a[140:143], v55, s[8:11], s62 offen sc1
    ds_read_b64_tr_b16 a[62:63], v49 offset:41984
    v_mfma_f32_16x16x32_bf16 a[80:83], a[20:23], a[216:219], a[80:83]
    s_mov_b32 s22, s18
    v_mfma_f32_16x16x32_bf16 a[84:87], a[20:23], a[220:223], 0
    v_mfma_f32_16x16x32_bf16 a[84:87], a[16:19], a[204:207], a[84:87]
    s_add_u32 s24, s6, 0x4806000
    s_addc_u32 s25, s7, 0
    v_mfma_f32_16x16x32_bf16 a[92:95], a[24:27], a[204:207], 0
    v_mfma_f32_16x16x32_bf16 a[92:95], a[28:31], a[220:223], a[92:95]
    s_and_b32 s25, s25, 0xffff
    v_mfma_f32_16x16x32_bf16 a[88:91], a[28:31], a[216:219], 0
    s_add_u32 s62, s62, 0x20000
    v_mfma_f32_16x16x32_bf16 a[88:91], a[24:27], a[200:203], a[88:91]
    s_mov_b32 s26, 4096
    v_mfma_f32_16x16x32_bf16 v[220:223], a[24:27], a[196:199], 0
    s_cmp_eq_u32 s45, 0
    s_cbranch_scc1 k12_ool_48
k12_oolret_49:
    v_mfma_f32_16x16x32_bf16 v[220:223], a[28:31], a[212:215], v[220:223]
    v_mfma_f32_16x16x32_bf16 v[216:219], a[28:31], a[208:211], 0
    v_mfma_f32_16x16x32_bf16 v[216:219], a[24:27], a[192:195], v[216:219]
    s_waitcnt vmcnt(28) lgkmcnt(0)
    s_barrier
    v_mfma_f32_16x16x32_bf16 v[224:227], a[32:35], a[192:195], 0
    v_mfma_f32_16x16x32_bf16 v[224:227], a[36:39], a[208:211], v[224:227]
    s_add_u32 m0, s60, 98304
    ds_read_b64_tr_b16 a[0:1], v42 offset:49152
    ds_read_b64_tr_b16 a[2:3], v42 offset:50176
    v_mfma_f32_16x16x32_bf16 v[228:231], a[36:39], a[212:215], 0
    buffer_load_dwordx4 v38, s[12:15], s61 offen offset:0 lds
    v_mfma_f32_16x16x32_bf16 v[228:231], a[32:35], a[196:199], v[228:231]
    ds_read_b64_tr_b16 a[4:5], v42 offset:57344
    v_mfma_f32_16x16x32_bf16 a[96:99], a[32:35], a[200:203], 0
    buffer_load_dwordx4 v39, s[12:15], s61 offen offset:1024 lds
    ds_read_b64_tr_b16 a[6:7], v42 offset:58368
    v_mfma_f32_16x16x32_bf16 a[96:99], a[36:39], a[216:219], a[96:99]
    ds_read_b64_tr_b16 a[8:9], v43 offset:49152
    v_mfma_f32_16x16x32_bf16 a[100:103], a[36:39], a[220:223], 0
    v_mfma_f32_16x16x32_bf16 a[100:103], a[32:35], a[204:207], a[100:103]
    buffer_load_dwordx4 v40, s[12:15], s61 offen offset:2048 lds
    ds_read_b64_tr_b16 a[10:11], v43 offset:50176
    v_mfma_f32_16x16x32_bf16 a[108:111], a[40:43], a[204:207], 0
    ds_read_b64_tr_b16 a[12:13], v43 offset:57344
    v_mfma_f32_16x16x32_bf16 a[108:111], a[44:47], a[220:223], a[108:111]
    ds_read_b64_tr_b16 a[14:15], v43 offset:58368
    v_mfma_f32_16x16x32_bf16 a[104:107], a[44:47], a[216:219], 0
    buffer_load_dwordx4 v41, s[12:15], s61 offen offset:3072 lds
    ds_read_b64_tr_b16 a[16:17], v44 offset:49152
    v_mfma_f32_16x16x32_bf16 a[104:107], a[40:43], a[200:203], a[104:107]
    v_mfma_f32_16x16x32_bf16 v[236:239], a[40:43], a[196:199], 0
    s_add_u32 s61, s61, 0x80000
    ds_read_b64_tr_b16 a[18:19], v44 offset:50176
    v_mfma_f32_16x16x32_bf16 v[236:239], a[44:47], a[212:215], v[236:239]
    buffer_load_dwordx4 a[144:147], v36, s[8:11], s62 offen sc1
    ds_read_b64_tr_b16 a[20:21], v44 offset:57344
    v_mfma_f32_16x16x32_bf16 v[232:235], a[44:47], a[208:211], 0
    ds_read_b64_tr_b16 a[22:23], v44 offset:58368
    v_mfma_f32_16x16x32_bf16 v[232:235], a[40:43], a[192:195], v[232:235]
    buffer_load_dwordx4 a[148:151], v54, s[8:11], s62 offen sc1
    v_mfma_f32_16x16x32_bf16 v[240:243], a[48:51], a[192:195], 0
    ds_read_b64_tr_b16 a[24:25], v45 offset:49152
    v_mfma_f32_16x16x32_bf16 v[240:243], a[52:55], a[208:211], v[240:243]
    ds_read_b64_tr_b16 a[26:27], v45 offset:50176
    v_mfma_f32_16x16x32_bf16 v[244:247], a[52:55], a[212:215], 0
    buffer_load_dwordx4 a[152:155], v37, s[8:11], s62 offen sc1
    ds_read_b64_tr_b16 a[28:29], v45 offset:57344
    v_mfma_f32_16x16x32_bf16 v[244:247], a[48:51], a[196:199], v[244:247]
    v_mfma_f32_16x16x32_bf16 a[112:115], a[48:51], a[200:203], 0
    ds_read_b64_tr_b16 a[30:31], v45 offset:58368
    v_mfma_f32_16x16x32_bf16 a[112:115], a[52:55], a[216:219], a[112:115]
    buffer_load_dwordx4 a[156:159], v55, s[8:11], s62 offen sc1
    v_mfma_f32_16x16x32_bf16 a[116:119], a[52:55], a[220:223], 0
    v_mfma_f32_16x16x32_bf16 a[116:119], a[48:51], a[204:207], a[116:119]
    s_add_u32 s62, s62, 0x20000
    v_mfma_f32_16x16x32_bf16 a[124:127], a[56:59], a[204:207], 0
    s_add_u32 s52, s47, 0
    v_mfma_f32_16x16x32_bf16 a[124:127], a[60:63], a[220:223], a[124:127]
    buffer_store_dwordx4 v[72:75], v1, s[48:51], s52 offen offset:2048 sc1
    v_mfma_f32_16x16x32_bf16 a[120:123], a[60:63], a[216:219], 0
    v_mfma_f32_16x16x32_bf16 a[120:123], a[56:59], a[200:203], a[120:123]
    v_mfma_f32_16x16x32_bf16 v[252:255], a[56:59], a[196:199], 0
    v_mfma_f32_16x16x32_bf16 v[252:255], a[60:63], a[212:215], v[252:255]
    v_mfma_f32_16x16x32_bf16 v[248:251], a[60:63], a[208:211], 0
    v_mfma_f32_16x16x32_bf16 v[248:251], a[56:59], a[192:195], v[248:251]
    s_waitcnt vmcnt(21) lgkmcnt(0)
    v_mfma_f32_16x16x32_bf16 v[192:195], a[0:3], a[224:227], v[192:195]
    v_mfma_f32_16x16x32_bf16 v[192:195], a[4:7], a[240:243], v[192:195]
    buffer_load_dwordx4 a[160:163], v36, s[8:11], s62 offen sc1
    ds_read_b64_tr_b16 a[32:33], v46 offset:49152
    v_mfma_f32_16x16x32_bf16 v[196:199], a[4:7], a[244:247], v[196:199]
    ds_read_b64_tr_b16 a[34:35], v46 offset:50176
    v_mfma_f32_16x16x32_bf16 v[196:199], a[0:3], a[228:231], v[196:199]
    ds_read_b64_tr_b16 a[36:37], v46 offset:57344
    v_mfma_f32_16x16x32_bf16 a[64:67], a[0:3], a[232:235], a[64:67]
    ds_read_b64_tr_b16 a[38:39], v46 offset:58368
    v_mfma_f32_16x16x32_bf16 a[64:67], a[4:7], a[248:251], a[64:67]
    ds_read_b64_tr_b16 a[40:41], v47 offset:49152
    v_mfma_f32_16x16x32_bf16 a[68:71], a[4:7], a[252:255], a[68:71]
    buffer_load_dwordx4 a[164:167], v54, s[8:11], s62 offen sc1
    v_mfma_f32_16x16x32_bf16 a[68:71], a[0:3], a[236:239], a[68:71]
    ds_read_b64_tr_b16 a[42:43], v47 offset:50176
    v_mfma_f32_16x16x32_bf16 a[76:79], a[8:11], a[236:239], a[76:79]
    ds_read_b64_tr_b16 a[44:45], v47 offset:57344
    v_mfma_f32_16x16x32_bf16 a[76:79], a[12:15], a[252:255], a[76:79]
    ds_read_b64_tr_b16 a[46:47], v47 offset:58368
    v_mfma_f32_16x16x32_bf16 a[72:75], a[12:15], a[248:251], a[72:75]
    ds_read_b64_tr_b16 a[48:49], v48 offset:49152
    v_mfma_f32_16x16x32_bf16 a[72:75], a[8:11], a[232:235], a[72:75]
    buffer_load_dwordx4 a[168:171], v37, s[8:11], s62 offen sc1
    v_mfma_f32_16x16x32_bf16 v[204:207], a[8:11], a[228:231], v[204:207]
    ds_read_b64_tr_b16 a[50:51], v48 offset:50176
    v_mfma_f32_16x16x32_bf16 v[204:207], a[12:15], a[244:247], v[204:207]
    ds_read_b64_tr_b16 a[52:53], v48 offset:57344
    v_mfma_f32_16x16x32_bf16 v[200:203], a[12:15], a[240:243], v[200:203]
    ds_read_b64_tr_b16 a[54:55], v48 offset:58368
    v_mfma_f32_16x16x32_bf16 v[200:203], a[8:11], a[224:227], v[200:203]
    v_mfma_f32_16x16x32_bf16 v[208:211], a[16:19], a[224:227], v[208:211]
    ds_read_b64_tr_b16 a[56:57], v49 offset:49152
    v_mfma_f32_16x16x32_bf16 v[208:211], a[20:23], a[240:243], v[208:211]
    buffer_load_dwordx4 a[172:175], v55, s[8:11], s62 offen sc1
    ds_read_b64_tr_b16 a[58:59], v49 offset:50176
    v_mfma_f32_16x16x32_bf16 v[212:215], a[20:23], a[244:247], v[212:215]
    ds_read_b64_tr_b16 a[60:61], v49 offset:57344
    v_mfma_f32_16x16x32_bf16 v[212:215], a[16:19], a[228:231], v[212:215]
    v_mfma_f32_16x16x32_bf16 a[80:83], a[16:19], a[232:235], a[80:83]
    ds_read_b64_tr_b16 a[62:63], v49 offset:58368
    v_mfma_f32_16x16x32_bf16 a[80:83], a[20:23], a[248:251], a[80:83]
    s_add_u32 s62, s62, 0x20000
    v_mfma_f32_16x16x32_bf16 a[84:87], a[20:23], a[252:255], a[84:87]
    s_add_u32 s52, s47, 0
    v_mfma_f32_16x16x32_bf16 a[84:87], a[16:19], a[236:239], a[84:87]
    buffer_store_dwordx4 v[76:79], v1, s[48:51], s52 offen offset:3072 sc1
    v_mfma_f32_16x16x32_bf16 a[92:95], a[24:27], a[236:239], a[92:95]
    v_mfma_f32_16x16x32_bf16 a[92:95], a[28:31], a[252:255], a[92:95]
    v_mfma_f32_16x16x32_bf16 a[88:91], a[28:31], a[248:251], a[88:91]
    v_mfma_f32_16x16x32_bf16 a[88:91], a[24:27], a[232:235], a[88:91]
    v_mfma_f32_16x16x32_bf16 v[220:223], a[24:27], a[228:231], v[220:223]
    s_cmp_eq_u32 s45, 0
    s_cbranch_scc1 k12_ool_50
k12_oolret_51:
    v_mfma_f32_16x16x32_bf16 v[220:223], a[28:31], a[244:247], v[220:223]
    v_mfma_f32_16x16x32_bf16 v[216:219], a[28:31], a[240:243], v[216:219]
    v_mfma_f32_16x16x32_bf16 v[216:219], a[24:27], a[224:227], v[216:219]
    s_waitcnt vmcnt(10) lgkmcnt(0)
    s_barrier
    v_mfma_f32_16x16x32_bf16 v[224:227], a[32:35], a[224:227], v[224:227]
    v_mfma_f32_16x16x32_bf16 v[224:227], a[36:39], a[240:243], v[224:227]
    s_add_u32 m0, s60, 114688
    ds_read_b64_tr_b16 a[0:1], v42 offset:0
    ds_read_b64_tr_b16 a[2:3], v42 offset:1024
    v_mfma_f32_16x16x32_bf16 v[228:231], a[36:39], a[244:247], v[228:231]
    buffer_load_dwordx4 v38, s[12:15], s61 offen offset:0 lds
    v_mfma_f32_16x16x32_bf16 v[228:231], a[32:35], a[228:231], v[228:231]
    ds_read_b64_tr_b16 a[4:5], v42 offset:8192
    v_mfma_f32_16x16x32_bf16 a[96:99], a[32:35], a[232:235], a[96:99]
    buffer_load_dwordx4 v39, s[12:15], s61 offen offset:1024 lds
    ds_read_b64_tr_b16 a[6:7], v42 offset:9216
    v_mfma_f32_16x16x32_bf16 a[96:99], a[36:39], a[248:251], a[96:99]
    ds_read_b64_tr_b16 a[8:9], v43 offset:0
    v_mfma_f32_16x16x32_bf16 a[100:103], a[36:39], a[252:255], a[100:103]
    v_mfma_f32_16x16x32_bf16 a[100:103], a[32:35], a[236:239], a[100:103]
    buffer_load_dwordx4 v40, s[12:15], s61 offen offset:2048 lds
    ds_read_b64_tr_b16 a[10:11], v43 offset:1024
    v_mfma_f32_16x16x32_bf16 a[108:111], a[40:43], a[236:239], a[108:111]
    ds_read_b64_tr_b16 a[12:13], v43 offset:8192
    v_mfma_f32_16x16x32_bf16 a[108:111], a[44:47], a[252:255], a[108:111]
    ds_read_b64_tr_b16 a[14:15], v43 offset:9216
    v_mfma_f32_16x16x32_bf16 a[104:107], a[44:47], a[248:251], a[104:107]
    buffer_load_dwordx4 v41, s[12:15], s61 offen offset:3072 lds
    ds_read_b64_tr_b16 a[16:17], v44 offset:0
    v_mfma_f32_16x16x32_bf16 a[104:107], a[40:43], a[232:235], a[104:107]
    v_mfma_f32_16x16x32_bf16 v[236:239], a[40:43], a[228:231], v[236:239]
    s_add_u32 s61, s61, 0x80000
    ds_read_b64_tr_b16 a[18:19], v44 offset:1024
    v_mfma_f32_16x16x32_bf16 v[236:239], a[44:47], a[244:247], v[236:239]
    buffer_load_dwordx4 a[176:179], v36, s[8:11], s62 offen sc1
    ds_read_b64_tr_b16 a[20:21], v44 offset:8192
    v_mfma_f32_16x16x32_bf16 v[232:235], a[44:47], a[240:243], v[232:235]
    ds_read_b64_tr_b16 a[22:23], v44 offset:9216
    v_mfma_f32_16x16x32_bf16 v[232:235], a[40:43], a[224:227], v[232:235]
    buffer_load_dwordx4 a[180:183], v54, s[8:11], s62 offen sc1
    v_mfma_f32_16x16x32_bf16 v[240:243], a[48:51], a[224:227], v[240:243]
    ds_read_b64_tr_b16 a[24:25], v45 offset:0
    v_mfma_f32_16x16x32_bf16 v[240:243], a[52:55], a[240:243], v[240:243]
    ds_read_b64_tr_b16 a[26:27], v45 offset:1024
    v_mfma_f32_16x16x32_bf16 v[244:247], a[52:55], a[244:247], v[244:247]
    buffer_load_dwordx4 a[184:187], v37, s[8:11], s62 offen sc1
    ds_read_b64_tr_b16 a[28:29], v45 offset:8192
    v_mfma_f32_16x16x32_bf16 v[244:247], a[48:51], a[228:231], v[244:247]
    v_mfma_f32_16x16x32_bf16 a[112:115], a[48:51], a[232:235], a[112:115]
    ds_read_b64_tr_b16 a[30:31], v45 offset:9216
    v_mfma_f32_16x16x32_bf16 a[112:115], a[52:55], a[248:251], a[112:115]
    buffer_load_dwordx4 a[188:191], v55, s[8:11], s62 offen sc1
    v_mfma_f32_16x16x32_bf16 a[116:119], a[52:55], a[252:255], a[116:119]
    v_mfma_f32_16x16x32_bf16 a[116:119], a[48:51], a[236:239], a[116:119]
    s_add_u32 s62, s62, 0x20000
    v_mfma_f32_16x16x32_bf16 a[124:127], a[56:59], a[236:239], a[124:127]
    s_add_u32 s52, s47, 4096
    v_mfma_f32_16x16x32_bf16 a[124:127], a[60:63], a[252:255], a[124:127]
    buffer_store_dwordx4 v[80:83], v1, s[48:51], s52 offen offset:0 sc1
    v_mfma_f32_16x16x32_bf16 a[120:123], a[60:63], a[248:251], a[120:123]
    v_mfma_f32_16x16x32_bf16 a[120:123], a[56:59], a[232:235], a[120:123]
    v_mfma_f32_16x16x32_bf16 v[252:255], a[56:59], a[228:231], v[252:255]
    v_mfma_f32_16x16x32_bf16 v[252:255], a[60:63], a[244:247], v[252:255]
    v_mfma_f32_16x16x32_bf16 v[248:251], a[60:63], a[240:243], v[248:251]
    v_mfma_f32_16x16x32_bf16 v[248:251], a[56:59], a[224:227], v[248:251]
    s_waitcnt vmcnt(15) lgkmcnt(0)
    v_mfma_f32_16x16x32_bf16 v[192:195], a[0:3], a[128:131], v[192:195]
    v_mfma_f32_16x16x32_bf16 v[192:195], a[4:7], a[144:147], v[192:195]
    buffer_load_dwordx4 a[192:195], v36, s[8:11], s62 offen sc1
    ds_read_b64_tr_b16 a[32:33], v46 offset:0
    v_mfma_f32_16x16x32_bf16 v[196:199], a[4:7], a[148:151], v[196:199]
    ds_read_b64_tr_b16 a[34:35], v46 offset:1024
    v_mfma_f32_16x16x32_bf16 v[196:199], a[0:3], a[132:135], v[196:199]
    ds_read_b64_tr_b16 a[36:37], v46 offset:8192
    v_mfma_f32_16x16x32_bf16 a[64:67], a[0:3], a[136:139], a[64:67]
    ds_read_b64_tr_b16 a[38:39], v46 offset:9216
    v_mfma_f32_16x16x32_bf16 a[64:67], a[4:7], a[152:155], a[64:67]
    ds_read_b64_tr_b16 a[40:41], v47 offset:0
    v_mfma_f32_16x16x32_bf16 a[68:71], a[4:7], a[156:159], a[68:71]
    buffer_load_dwordx4 a[196:199], v54, s[8:11], s62 offen sc1
    v_mfma_f32_16x16x32_bf16 a[68:71], a[0:3], a[140:143], a[68:71]
    ds_read_b64_tr_b16 a[42:43], v47 offset:1024
    v_mfma_f32_16x16x32_bf16 a[76:79], a[8:11], a[140:143], a[76:79]
    ds_read_b64_tr_b16 a[44:45], v47 offset:8192
    v_mfma_f32_16x16x32_bf16 a[76:79], a[12:15], a[156:159], a[76:79]
    ds_read_b64_tr_b16 a[46:47], v47 offset:9216
    v_mfma_f32_16x16x32_bf16 a[72:75], a[12:15], a[152:155], a[72:75]
    ds_read_b64_tr_b16 a[48:49], v48 offset:0
    v_mfma_f32_16x16x32_bf16 a[72:75], a[8:11], a[136:139], a[72:75]
    buffer_load_dwordx4 a[200:203], v37, s[8:11], s62 offen sc1
    v_mfma_f32_16x16x32_bf16 v[204:207], a[8:11], a[132:135], v[204:207]
    ds_read_b64_tr_b16 a[50:51], v48 offset:1024
    v_mfma_f32_16x16x32_bf16 v[204:207], a[12:15], a[148:151], v[204:207]
    ds_read_b64_tr_b16 a[52:53], v48 offset:8192
    v_mfma_f32_16x16x32_bf16 v[200:203], a[12:15], a[144:147], v[200:203]
    ds_read_b64_tr_b16 a[54:55], v48 offset:9216
    v_mfma_f32_16x16x32_bf16 v[200:203], a[8:11], a[128:131], v[200:203]
    v_mfma_f32_16x16x32_bf16 v[208:211], a[16:19], a[128:131], v[208:211]
    ds_read_b64_tr_b16 a[56:57], v49 offset:0
    v_mfma_f32_16x16x32_bf16 v[208:211], a[20:23], a[144:147], v[208:211]
    buffer_load_dwordx4 a[204:207], v55, s[8:11], s62 offen sc1
    ds_read_b64_tr_b16 a[58:59], v49 offset:1024
    v_mfma_f32_16x16x32_bf16 v[212:215], a[20:23], a[148:151], v[212:215]
    ds_read_b64_tr_b16 a[60:61], v49 offset:8192
    v_mfma_f32_16x16x32_bf16 v[212:215], a[16:19], a[132:135], v[212:215]
    v_mfma_f32_16x16x32_bf16 a[80:83], a[16:19], a[136:139], a[80:83]
    ds_read_b64_tr_b16 a[62:63], v49 offset:9216
    v_mfma_f32_16x16x32_bf16 a[80:83], a[20:23], a[152:155], a[80:83]
    s_add_u32 s62, s62, 0x20000
    v_mfma_f32_16x16x32_bf16 a[84:87], a[20:23], a[156:159], a[84:87]
    s_add_u32 s52, s47, 4096
    v_mfma_f32_16x16x32_bf16 a[84:87], a[16:19], a[140:143], a[84:87]
    buffer_store_dwordx4 v[84:87], v1, s[48:51], s52 offen offset:1024 sc1
    v_mfma_f32_16x16x32_bf16 a[92:95], a[24:27], a[140:143], a[92:95]
    v_mfma_f32_16x16x32_bf16 a[92:95], a[28:31], a[156:159], a[92:95]
    v_mfma_f32_16x16x32_bf16 a[88:91], a[28:31], a[152:155], a[88:91]
    v_mfma_f32_16x16x32_bf16 a[88:91], a[24:27], a[136:139], a[88:91]
    v_mfma_f32_16x16x32_bf16 v[220:223], a[24:27], a[132:135], v[220:223]
    v_mfma_f32_16x16x32_bf16 v[220:223], a[28:31], a[148:151], v[220:223]
    v_mfma_f32_16x16x32_bf16 v[216:219], a[28:31], a[144:147], v[216:219]
    v_mfma_f32_16x16x32_bf16 v[216:219], a[24:27], a[128:131], v[216:219]
    s_waitcnt vmcnt(10) lgkmcnt(0)
    s_barrier
    v_mfma_f32_16x16x32_bf16 v[224:227], a[32:35], a[128:131], v[224:227]
    v_mfma_f32_16x16x32_bf16 v[224:227], a[36:39], a[144:147], v[224:227]
    s_add_u32 m0, s60, 131072
    ds_read_b64_tr_b16 a[0:1], v42 offset:16384
    ds_read_b64_tr_b16 a[2:3], v42 offset:17408
    v_mfma_f32_16x16x32_bf16 v[228:231], a[36:39], a[148:151], v[228:231]
    buffer_load_dwordx4 v38, s[12:15], s61 offen offset:0 lds
    v_mfma_f32_16x16x32_bf16 v[228:231], a[32:35], a[132:135], v[228:231]
    ds_read_b64_tr_b16 a[4:5], v42 offset:24576
    v_mfma_f32_16x16x32_bf16 a[96:99], a[32:35], a[136:139], a[96:99]
    buffer_load_dwordx4 v39, s[12:15], s61 offen offset:1024 lds
    ds_read_b64_tr_b16 a[6:7], v42 offset:25600
    v_mfma_f32_16x16x32_bf16 a[96:99], a[36:39], a[152:155], a[96:99]
    ds_read_b64_tr_b16 a[8:9], v43 offset:16384
    v_mfma_f32_16x16x32_bf16 a[100:103], a[36:39], a[156:159], a[100:103]
    v_mfma_f32_16x16x32_bf16 a[100:103], a[32:35], a[140:143], a[100:103]
    buffer_load_dwordx4 v40, s[12:15], s61 offen offset:2048 lds
    ds_read_b64_tr_b16 a[10:11], v43 offset:17408
    v_mfma_f32_16x16x32_bf16 a[108:111], a[40:43], a[140:143], a[108:111]
    ds_read_b64_tr_b16 a[12:13], v43 offset:24576
    v_mfma_f32_16x16x32_bf16 a[108:111], a[44:47], a[156:159], a[108:111]
    ds_read_b64_tr_b16 a[14:15], v43 offset:25600
    v_mfma_f32_16x16x32_bf16 a[104:107], a[44:47], a[152:155], a[104:107]
    ds_read_b64_tr_b16 a[16:17], v44 offset:16384
    v_mfma_f32_16x16x32_bf16 a[104:107], a[40:43], a[136:139], a[104:107]
    buffer_load_dwordx4 v41, s[12:15], s61 offen offset:3072 lds
    v_mfma_f32_16x16x32_bf16 v[236:239], a[40:43], a[132:135], v[236:239]
    ds_read_b64_tr_b16 a[18:19], v44 offset:17408
    v_mfma_f32_16x16x32_bf16 v[236:239], a[44:47], a[148:151], v[236:239]
    s_add_u32 s61, s61, 0x80000
    ds_read_b64_tr_b16 a[20:21], v44 offset:24576
    v_mfma_f32_16x16x32_bf16 v[232:235], a[44:47], a[144:147], v[232:235]
    buffer_load_dwordx4 a[208:211], v36, s[8:11], s62 offen sc1
    ds_read_b64_tr_b16 a[22:23], v44 offset:25600
    v_mfma_f32_16x16x32_bf16 v[232:235], a[40:43], a[128:131], v[232:235]
    v_mfma_f32_16x16x32_bf16 v[240:243], a[48:51], a[128:131], v[240:243]
    ds_read_b64_tr_b16 a[24:25], v45 offset:16384
    v_mfma_f32_16x16x32_bf16 v[240:243], a[52:55], a[144:147], v[240:243]
    buffer_load_dwordx4 a[212:215], v54, s[8:11], s62 offen sc1
    ds_read_b64_tr_b16 a[26:27], v45 offset:17408
    v_mfma_f32_16x16x32_bf16 v[244:247], a[52:55], a[148:151], v[244:247]
    ds_read_b64_tr_b16 a[28:29], v45 offset:24576
    v_mfma_f32_16x16x32_bf16 v[244:247], a[48:51], a[132:135], v[244:247]
    v_mfma_f32_16x16x32_bf16 a[112:115], a[48:51], a[136:139], a[112:115]
    buffer_load_dwordx4 a[216:219], v37, s[8:11], s62 offen sc1
    ds_read_b64_tr_b16 a[30:31], v45 offset:25600
    v_mfma_f32_16x16x32_bf16 a[112:115], a[52:55], a[152:155], a[112:115]
    v_mfma_f32_16x16x32_bf16 a[116:119], a[52:55], a[156:159], a[116:119]
    v_mfma_f32_16x16x32_bf16 a[116:119], a[48:51], a[140:143], a[116:119]
    v_mfma_f32_16x16x32_bf16 a[124:127], a[56:59], a[140:143], a[124:127]
    buffer_load_dwordx4 a[220:223], v55, s[8:11], s62 offen sc1
    v_mfma_f32_16x16x32_bf16 a[124:127], a[60:63], a[156:159], a[124:127]
    v_mfma_f32_16x16x32_bf16 a[120:123], a[60:63], a[152:155], a[120:123]
    s_add_u32 s62, s62, 0x20000
    v_mfma_f32_16x16x32_bf16 a[120:123], a[56:59], a[136:139], a[120:123]
    v_mfma_f32_16x16x32_bf16 v[252:255], a[56:59], a[132:135], v[252:255]
    s_cmp_eq_u32 s45, 0
    s_cbranch_scc1 k12_ool_52
k12_oolret_53:
    v_mfma_f32_16x16x32_bf16 v[252:255], a[60:63], a[148:151], v[252:255]
    v_mfma_f32_16x16x32_bf16 v[248:251], a[60:63], a[144:147], v[248:251]
    v_mfma_f32_16x16x32_bf16 v[248:251], a[56:59], a[128:131], v[248:251]
    s_waitcnt vmcnt(14) lgkmcnt(0)
    v_mfma_f32_16x16x32_bf16 v[192:195], a[0:3], a[160:163], v[192:195]
    v_mfma_f32_16x16x32_bf16 v[192:195], a[4:7], a[176:179], v[192:195]
    buffer_load_dwordx4 a[224:227], v36, s[8:11], s62 offen sc1
    ds_read_b64_tr_b16 a[32:33], v46 offset:16384
    v_mfma_f32_16x16x32_bf16 v[196:199], a[4:7], a[180:183], v[196:199]
    ds_read_b64_tr_b16 a[34:35], v46 offset:17408
    v_mfma_f32_16x16x32_bf16 v[196:199], a[0:3], a[164:167], v[196:199]
    ds_read_b64_tr_b16 a[36:37], v46 offset:24576
    v_mfma_f32_16x16x32_bf16 a[64:67], a[0:3], a[168:171], a[64:67]
    ds_read_b64_tr_b16 a[38:39], v46 offset:25600
    v_mfma_f32_16x16x32_bf16 a[64:67], a[4:7], a[184:187], a[64:67]
    ds_read_b64_tr_b16 a[40:41], v47 offset:16384
    v_mfma_f32_16x16x32_bf16 a[68:71], a[4:7], a[188:191], a[68:71]
    buffer_load_dwordx4 a[228:231], v54, s[8:11], s62 offen sc1
    v_mfma_f32_16x16x32_bf16 a[68:71], a[0:3], a[172:175], a[68:71]
    ds_read_b64_tr_b16 a[42:43], v47 offset:17408
    v_mfma_f32_16x16x32_bf16 a[76:79], a[8:11], a[172:175], a[76:79]
    ds_read_b64_tr_b16 a[44:45], v47 offset:24576
    v_mfma_f32_16x16x32_bf16 a[76:79], a[12:15], a[188:191], a[76:79]
    ds_read_b64_tr_b16 a[46:47], v47 offset:25600
    v_mfma_f32_16x16x32_bf16 a[72:75], a[12:15], a[184:187], a[72:75]
    ds_read_b64_tr_b16 a[48:49], v48 offset:16384
    v_mfma_f32_16x16x32_bf16 a[72:75], a[8:11], a[168:171], a[72:75]
    buffer_load_dwordx4 a[232:235], v37, s[8:11], s62 offen sc1
    v_mfma_f32_16x16x32_bf16 v[204:207], a[8:11], a[164:167], v[204:207]
    ds_read_b64_tr_b16 a[50:51], v48 offset:17408
    v_mfma_f32_16x16x32_bf16 v[204:207], a[12:15], a[180:183], v[204:207]
    ds_read_b64_tr_b16 a[52:53], v48 offset:24576
    v_mfma_f32_16x16x32_bf16 v[200:203], a[12:15], a[176:179], v[200:203]
    ds_read_b64_tr_b16 a[54:55], v48 offset:25600
    v_mfma_f32_16x16x32_bf16 v[200:203], a[8:11], a[160:163], v[200:203]
    v_mfma_f32_16x16x32_bf16 v[208:211], a[16:19], a[160:163], v[208:211]
    ds_read_b64_tr_b16 a[56:57], v49 offset:16384
    v_mfma_f32_16x16x32_bf16 v[208:211], a[20:23], a[176:179], v[208:211]
    buffer_load_dwordx4 a[236:239], v55, s[8:11], s62 offen sc1
    ds_read_b64_tr_b16 a[58:59], v49 offset:17408
    v_mfma_f32_16x16x32_bf16 v[212:215], a[20:23], a[180:183], v[212:215]
    ds_read_b64_tr_b16 a[60:61], v49 offset:24576
    v_mfma_f32_16x16x32_bf16 v[212:215], a[16:19], a[164:167], v[212:215]
    v_mfma_f32_16x16x32_bf16 a[80:83], a[16:19], a[168:171], a[80:83]
    ds_read_b64_tr_b16 a[62:63], v49 offset:25600
    v_mfma_f32_16x16x32_bf16 a[80:83], a[20:23], a[184:187], a[80:83]
    s_add_u32 s62, s62, 0x20000
    v_mfma_f32_16x16x32_bf16 a[84:87], a[20:23], a[188:191], a[84:87]
    s_add_u32 s52, s47, 4096
    v_mfma_f32_16x16x32_bf16 a[84:87], a[16:19], a[172:175], a[84:87]
    buffer_store_dwordx4 v[88:91], v1, s[48:51], s52 offen offset:2048 sc1
    v_mfma_f32_16x16x32_bf16 a[92:95], a[24:27], a[172:175], a[92:95]
    v_mfma_f32_16x16x32_bf16 a[92:95], a[28:31], a[188:191], a[92:95]
    v_mfma_f32_16x16x32_bf16 a[88:91], a[28:31], a[184:187], a[88:91]
    v_mfma_f32_16x16x32_bf16 a[88:91], a[24:27], a[168:171], a[88:91]
    v_mfma_f32_16x16x32_bf16 v[220:223], a[24:27], a[164:167], v[220:223]
    v_mfma_f32_16x16x32_bf16 v[220:223], a[28:31], a[180:183], v[220:223]
    v_mfma_f32_16x16x32_bf16 v[216:219], a[28:31], a[176:179], v[216:219]
    v_mfma_f32_16x16x32_bf16 v[216:219], a[24:27], a[160:163], v[216:219]
    s_waitcnt vmcnt(9) lgkmcnt(0)
    s_barrier
    v_mfma_f32_16x16x32_bf16 v[224:227], a[32:35], a[160:163], v[224:227]
    v_mfma_f32_16x16x32_bf16 v[224:227], a[36:39], a[176:179], v[224:227]
    s_add_u32 m0, s60, 147456
    ds_read_b64_tr_b16 a[0:1], v42 offset:32768
    ds_read_b64_tr_b16 a[2:3], v42 offset:33792
    v_mfma_f32_16x16x32_bf16 v[228:231], a[36:39], a[180:183], v[228:231]
    buffer_load_dwordx4 v38, s[12:15], s61 offen offset:0 lds
    v_mfma_f32_16x16x32_bf16 v[228:231], a[32:35], a[164:167], v[228:231]
    ds_read_b64_tr_b16 a[4:5], v42 offset:40960
    v_mfma_f32_16x16x32_bf16 a[96:99], a[32:35], a[168:171], a[96:99]
    buffer_load_dwordx4 v39, s[12:15], s61 offen offset:1024 lds
    ds_read_b64_tr_b16 a[6:7], v42 offset:41984
    v_mfma_f32_16x16x32_bf16 a[96:99], a[36:39], a[184:187], a[96:99]
    ds_read_b64_tr_b16 a[8:9], v43 offset:32768
    v_mfma_f32_16x16x32_bf16 a[100:103], a[36:39], a[188:191], a[100:103]
    v_mfma_f32_16x16x32_bf16 a[100:103], a[32:35], a[172:175], a[100:103]
    buffer_load_dwordx4 v40, s[12:15], s61 offen offset:2048 lds
    ds_read_b64_tr_b16 a[10:11], v43 offset:33792
    v_mfma_f32_16x16x32_bf16 a[108:111], a[40:43], a[172:175], a[108:111]
    ds_read_b64_tr_b16 a[12:13], v43 offset:40960
    v_mfma_f32_16x16x32_bf16 a[108:111], a[44:47], a[188:191], a[108:111]
    ds_read_b64_tr_b16 a[14:15], v43 offset:41984
    v_mfma_f32_16x16x32_bf16 a[104:107], a[44:47], a[184:187], a[104:107]
    buffer_load_dwordx4 v41, s[12:15], s61 offen offset:3072 lds
    ds_read_b64_tr_b16 a[16:17], v44 offset:32768
    v_mfma_f32_16x16x32_bf16 a[104:107], a[40:43], a[168:171], a[104:107]
    v_mfma_f32_16x16x32_bf16 v[236:239], a[40:43], a[164:167], v[236:239]
    s_add_u32 s61, s61, 0x80000
    ds_read_b64_tr_b16 a[18:19], v44 offset:33792
    v_mfma_f32_16x16x32_bf16 v[236:239], a[44:47], a[180:183], v[236:239]
    buffer_load_dwordx4 a[240:243], v36, s[8:11], s62 offen sc1
    ds_read_b64_tr_b16 a[20:21], v44 offset:40960
    v_mfma_f32_16x16x32_bf16 v[232:235], a[44:47], a[176:179], v[232:235]
    ds_read_b64_tr_b16 a[22:23], v44 offset:41984
    v_mfma_f32_16x16x32_bf16 v[232:235], a[40:43], a[160:163], v[232:235]
    buffer_load_dwordx4 a[244:247], v54, s[8:11], s62 offen sc1
    v_mfma_f32_16x16x32_bf16 v[240:243], a[48:51], a[160:163], v[240:243]
    ds_read_b64_tr_b16 a[24:25], v45 offset:32768
    v_mfma_f32_16x16x32_bf16 v[240:243], a[52:55], a[176:179], v[240:243]
    ds_read_b64_tr_b16 a[26:27], v45 offset:33792
    v_mfma_f32_16x16x32_bf16 v[244:247], a[52:55], a[180:183], v[244:247]
    buffer_load_dwordx4 a[248:251], v37, s[8:11], s62 offen sc1
    ds_read_b64_tr_b16 a[28:29], v45 offset:40960
    v_mfma_f32_16x16x32_bf16 v[244:247], a[48:51], a[164:167], v[244:247]
    v_mfma_f32_16x16x32_bf16 a[112:115], a[48:51], a[168:171], a[112:115]
    ds_read_b64_tr_b16 a[30:31], v45 offset:41984
    v_mfma_f32_16x16x32_bf16 a[112:115], a[52:55], a[184:187], a[112:115]
    buffer_load_dwordx4 a[252:255], v55, s[8:11], s62 offen sc1
    v_mfma_f32_16x16x32_bf16 a[116:119], a[52:55], a[188:191], a[116:119]
    v_mfma_f32_16x16x32_bf16 a[116:119], a[48:51], a[172:175], a[116:119]
    s_add_u32 s62, s62, 0x20000
    v_mfma_f32_16x16x32_bf16 a[124:127], a[56:59], a[172:175], a[124:127]
    s_add_u32 s52, s47, 4096
    v_mfma_f32_16x16x32_bf16 a[124:127], a[60:63], a[188:191], a[124:127]
    buffer_store_dwordx4 v[92:95], v1, s[48:51], s52 offen offset:3072 sc1
    v_mfma_f32_16x16x32_bf16 a[120:123], a[60:63], a[184:187], a[120:123]
    v_mfma_f32_16x16x32_bf16 a[120:123], a[56:59], a[168:171], a[120:123]
    v_mfma_f32_16x16x32_bf16 v[252:255], a[56:59], a[164:167], v[252:255]
    s_cmp_eq_u32 s45, 0
    s_cbranch_scc1 k12_ool_54
k12_oolret_55:
    v_mfma_f32_16x16x32_bf16 v[252:255], a[60:63], a[180:183], v[252:255]
    v_mfma_f32_16x16x32_bf16 v[248:251], a[60:63], a[176:179], v[248:251]
    v_mfma_f32_16x16x32_bf16 v[248:251], a[56:59], a[160:163], v[248:251]
    s_waitcnt vmcnt(14) lgkmcnt(0)
    v_mfma_f32_16x16x32_bf16 v[192:195], a[0:3], a[192:195], v[192:195]
    v_mfma_f32_16x16x32_bf16 v[192:195], a[4:7], a[208:211], v[192:195]
    buffer_load_dwordx4 a[128:131], v36, s[8:11], s62 offen sc1
    ds_read_b64_tr_b16 a[32:33], v46 offset:32768
    v_mfma_f32_16x16x32_bf16 v[196:199], a[4:7], a[212:215], v[196:199]
    ds_read_b64_tr_b16 a[34:35], v46 offset:33792
    v_mfma_f32_16x16x32_bf16 v[196:199], a[0:3], a[196:199], v[196:199]
    ds_read_b64_tr_b16 a[36:37], v46 offset:40960
    v_mfma_f32_16x16x32_bf16 a[64:67], a[0:3], a[200:203], a[64:67]
    ds_read_b64_tr_b16 a[38:39], v46 offset:41984
    v_mfma_f32_16x16x32_bf16 a[64:67], a[4:7], a[216:219], a[64:67]
    ds_read_b64_tr_b16 a[40:41], v47 offset:32768
    v_mfma_f32_16x16x32_bf16 a[68:71], a[4:7], a[220:223], a[68:71]
    buffer_load_dwordx4 a[132:135], v54, s[8:11], s62 offen sc1
    v_mfma_f32_16x16x32_bf16 a[68:71], a[0:3], a[204:207], a[68:71]
    ds_read_b64_tr_b16 a[42:43], v47 offset:33792
    v_mfma_f32_16x16x32_bf16 a[76:79], a[8:11], a[204:207], a[76:79]
    ds_read_b64_tr_b16 a[44:45], v47 offset:40960
    v_mfma_f32_16x16x32_bf16 a[76:79], a[12:15], a[220:223], a[76:79]
    ds_read_b64_tr_b16 a[46:47], v47 offset:41984
    v_mfma_f32_16x16x32_bf16 a[72:75], a[12:15], a[216:219], a[72:75]
    ds_read_b64_tr_b16 a[48:49], v48 offset:32768
    v_mfma_f32_16x16x32_bf16 a[72:75], a[8:11], a[200:203], a[72:75]
    buffer_load_dwordx4 a[136:139], v37, s[8:11], s62 offen sc1
    v_mfma_f32_16x16x32_bf16 v[204:207], a[8:11], a[196:199], v[204:207]
    ds_read_b64_tr_b16 a[50:51], v48 offset:33792
    v_mfma_f32_16x16x32_bf16 v[204:207], a[12:15], a[212:215], v[204:207]
    ds_read_b64_tr_b16 a[52:53], v48 offset:40960
    v_mfma_f32_16x16x32_bf16 v[200:203], a[12:15], a[208:211], v[200:203]
    ds_read_b64_tr_b16 a[54:55], v48 offset:41984
    v_mfma_f32_16x16x32_bf16 v[200:203], a[8:11], a[192:195], v[200:203]
    v_mfma_f32_16x16x32_bf16 v[208:211], a[16:19], a[192:195], v[208:211]
    ds_read_b64_tr_b16 a[56:57], v49 offset:32768
    v_mfma_f32_16x16x32_bf16 v[208:211], a[20:23], a[208:211], v[208:211]
    buffer_load_dwordx4 a[140:143], v55, s[8:11], s62 offen sc1
    ds_read_b64_tr_b16 a[58:59], v49 offset:33792
    v_mfma_f32_16x16x32_bf16 v[212:215], a[20:23], a[212:215], v[212:215]
    ds_read_b64_tr_b16 a[60:61], v49 offset:40960
    v_mfma_f32_16x16x32_bf16 v[212:215], a[16:19], a[196:199], v[212:215]
    v_mfma_f32_16x16x32_bf16 a[80:83], a[16:19], a[200:203], a[80:83]
    ds_read_b64_tr_b16 a[62:63], v49 offset:41984
    v_mfma_f32_16x16x32_bf16 a[80:83], a[20:23], a[216:219], a[80:83]
    s_add_u32 s62, s62, 0x20000
    v_mfma_f32_16x16x32_bf16 a[84:87], a[20:23], a[220:223], a[84:87]
    s_add_u32 s52, s47, 8192
    v_mfma_f32_16x16x32_bf16 a[84:87], a[16:19], a[204:207], a[84:87]
    buffer_store_dwordx4 v[104:107], v1, s[48:51], s52 offen offset:2048 sc1
    v_mfma_f32_16x16x32_bf16 a[92:95], a[24:27], a[204:207], a[92:95]
    v_mfma_f32_16x16x32_bf16 a[92:95], a[28:31], a[220:223], a[92:95]
    v_mfma_f32_16x16x32_bf16 a[88:91], a[28:31], a[216:219], a[88:91]
    v_mfma_f32_16x16x32_bf16 a[88:91], a[24:27], a[200:203], a[88:91]
    v_mfma_f32_16x16x32_bf16 v[220:223], a[24:27], a[196:199], v[220:223]
    v_mfma_f32_16x16x32_bf16 v[220:223], a[28:31], a[212:215], v[220:223]
    v_mfma_f32_16x16x32_bf16 v[216:219], a[28:31], a[208:211], v[216:219]
    v_mfma_f32_16x16x32_bf16 v[216:219], a[24:27], a[192:195], v[216:219]
    s_waitcnt vmcnt(10) lgkmcnt(0)
    s_barrier
    v_mfma_f32_16x16x32_bf16 v[224:227], a[32:35], a[192:195], v[224:227]
    v_mfma_f32_16x16x32_bf16 v[224:227], a[36:39], a[208:211], v[224:227]
    s_add_u32 m0, s60, 98304
    ds_read_b64_tr_b16 a[0:1], v42 offset:49152
    ds_read_b64_tr_b16 a[2:3], v42 offset:50176
    v_mfma_f32_16x16x32_bf16 v[228:231], a[36:39], a[212:215], v[228:231]
    buffer_load_dwordx4 v38, s[12:15], s61 offen offset:0 lds
    v_mfma_f32_16x16x32_bf16 v[228:231], a[32:35], a[196:199], v[228:231]
    ds_read_b64_tr_b16 a[4:5], v42 offset:57344
    v_mfma_f32_16x16x32_bf16 a[96:99], a[32:35], a[200:203], a[96:99]
    buffer_load_dwordx4 v39, s[12:15], s61 offen offset:1024 lds
    ds_read_b64_tr_b16 a[6:7], v42 offset:58368
    v_mfma_f32_16x16x32_bf16 a[96:99], a[36:39], a[216:219], a[96:99]
    ds_read_b64_tr_b16 a[8:9], v43 offset:49152
    v_mfma_f32_16x16x32_bf16 a[100:103], a[36:39], a[220:223], a[100:103]
    v_mfma_f32_16x16x32_bf16 a[100:103], a[32:35], a[204:207], a[100:103]
    buffer_load_dwordx4 v40, s[12:15], s61 offen offset:2048 lds
    ds_read_b64_tr_b16 a[10:11], v43 offset:50176
    v_mfma_f32_16x16x32_bf16 a[108:111], a[40:43], a[204:207], a[108:111]
    ds_read_b64_tr_b16 a[12:13], v43 offset:57344
    v_mfma_f32_16x16x32_bf16 a[108:111], a[44:47], a[220:223], a[108:111]
    ds_read_b64_tr_b16 a[14:15], v43 offset:58368
    v_mfma_f32_16x16x32_bf16 a[104:107], a[44:47], a[216:219], a[104:107]
    buffer_load_dwordx4 v41, s[12:15], s61 offen offset:3072 lds
    ds_read_b64_tr_b16 a[16:17], v44 offset:49152
    v_mfma_f32_16x16x32_bf16 a[104:107], a[40:43], a[200:203], a[104:107]
    v_mfma_f32_16x16x32_bf16 v[236:239], a[40:43], a[196:199], v[236:239]
    s_add_u32 s61, s61, 0x80000
    ds_read_b64_tr_b16 a[18:19], v44 offset:50176
    v_mfma_f32_16x16x32_bf16 v[236:239], a[44:47], a[212:215], v[236:239]
    buffer_load_dwordx4 a[144:147], v36, s[8:11], s62 offen sc1
    ds_read_b64_tr_b16 a[20:21], v44 offset:57344
    v_mfma_f32_16x16x32_bf16 v[232:235], a[44:47], a[208:211], v[232:235]
    ds_read_b64_tr_b16 a[22:23], v44 offset:58368
    v_mfma_f32_16x16x32_bf16 v[232:235], a[40:43], a[192:195], v[232:235]
    buffer_load_dwordx4 a[148:151], v54, s[8:11], s62 offen sc1
    v_mfma_f32_16x16x32_bf16 v[240:243], a[48:51], a[192:195], v[240:243]
    ds_read_b64_tr_b16 a[24:25], v45 offset:49152
    v_mfma_f32_16x16x32_bf16 v[240:243], a[52:55], a[208:211], v[240:243]
    ds_read_b64_tr_b16 a[26:27], v45 offset:50176
    v_mfma_f32_16x16x32_bf16 v[244:247], a[52:55], a[212:215], v[244:247]
    buffer_load_dwordx4 a[152:155], v37, s[8:11], s62 offen sc1
    ds_read_b64_tr_b16 a[28:29], v45 offset:57344
    v_mfma_f32_16x16x32_bf16 v[244:247], a[48:51], a[196:199], v[244:247]
    v_mfma_f32_16x16x32_bf16 a[112:115], a[48:51], a[200:203], a[112:115]
    ds_read_b64_tr_b16 a[30:31], v45 offset:58368
    v_mfma_f32_16x16x32_bf16 a[112:115], a[52:55], a[216:219], a[112:115]
    buffer_load_dwordx4 a[156:159], v55, s[8:11], s62 offen sc1
    v_mfma_f32_16x16x32_bf16 a[116:119], a[52:55], a[220:223], a[116:119]
    v_mfma_f32_16x16x32_bf16 a[116:119], a[48:51], a[204:207], a[116:119]
    s_add_u32 s62, s62, 0x20000
    v_mfma_f32_16x16x32_bf16 a[124:127], a[56:59], a[204:207], a[124:127]
    s_add_u32 s52, s47, 8192
    v_mfma_f32_16x16x32_bf16 a[124:127], a[60:63], a[220:223], a[124:127]
    buffer_store_dwordx4 v[108:111], v1, s[48:51], s52 offen offset:3072 sc1
    v_mfma_f32_16x16x32_bf16 a[120:123], a[60:63], a[216:219], a[120:123]
    v_mfma_f32_16x16x32_bf16 a[120:123], a[56:59], a[200:203], a[120:123]
    v_mfma_f32_16x16x32_bf16 v[252:255], a[56:59], a[196:199], v[252:255]
    v_mfma_f32_16x16x32_bf16 v[252:255], a[60:63], a[212:215], v[252:255]
    v_mfma_f32_16x16x32_bf16 v[248:251], a[60:63], a[208:211], v[248:251]
    v_mfma_f32_16x16x32_bf16 v[248:251], a[56:59], a[192:195], v[248:251]
    s_waitcnt vmcnt(15) lgkmcnt(0)
    v_mfma_f32_16x16x32_bf16 v[192:195], a[0:3], a[224:227], v[192:195]
    v_mfma_f32_16x16x32_bf16 v[192:195], a[4:7], a[240:243], v[192:195]
    buffer_load_dwordx4 a[160:163], v36, s[8:11], s62 offen sc1
    ds_read_b64_tr_b16 a[32:33], v46 offset:49152
    v_mfma_f32_16x16x32_bf16 v[196:199], a[4:7], a[244:247], v[196:199]
    ds_read_b64_tr_b16 a[34:35], v46 offset:50176
    v_mfma_f32_16x16x32_bf16 v[196:199], a[0:3], a[228:231], v[196:199]
    ds_read_b64_tr_b16 a[36:37], v46 offset:57344
    v_mfma_f32_16x16x32_bf16 a[64:67], a[0:3], a[232:235], a[64:67]
    ds_read_b64_tr_b16 a[38:39], v46 offset:58368
    v_mfma_f32_16x16x32_bf16 a[64:67], a[4:7], a[248:251], a[64:67]
    ds_read_b64_tr_b16 a[40:41], v47 offset:49152
    v_mfma_f32_16x16x32_bf16 a[68:71], a[4:7], a[252:255], a[68:71]
    buffer_load_dwordx4 a[164:167], v54, s[8:11], s62 offen sc1
    v_mfma_f32_16x16x32_bf16 a[68:71], a[0:3], a[236:239], a[68:71]
    ds_read_b64_tr_b16 a[42:43], v47 offset:50176
    v_mfma_f32_16x16x32_bf16 a[76:79], a[8:11], a[236:239], a[76:79]
    ds_read_b64_tr_b16 a[44:45], v47 offset:57344
    v_mfma_f32_16x16x32_bf16 a[76:79], a[12:15], a[252:255], a[76:79]
    ds_read_b64_tr_b16 a[46:47], v47 offset:58368
    v_mfma_f32_16x16x32_bf16 a[72:75], a[12:15], a[248:251], a[72:75]
    ds_read_b64_tr_b16 a[48:49], v48 offset:49152
    v_mfma_f32_16x16x32_bf16 a[72:75], a[8:11], a[232:235], a[72:75]
    buffer_load_dwordx4 a[168:171], v37, s[8:11], s62 offen sc1
    v_mfma_f32_16x16x32_bf16 v[204:207], a[8:11], a[228:231], v[204:207]
    ds_read_b64_tr_b16 a[50:51], v48 offset:50176
    v_mfma_f32_16x16x32_bf16 v[204:207], a[12:15], a[244:247], v[204:207]
    ds_read_b64_tr_b16 a[52:53], v48 offset:57344
    v_mfma_f32_16x16x32_bf16 v[200:203], a[12:15], a[240:243], v[200:203]
    ds_read_b64_tr_b16 a[54:55], v48 offset:58368
    v_mfma_f32_16x16x32_bf16 v[200:203], a[8:11], a[224:227], v[200:203]
    v_mfma_f32_16x16x32_bf16 v[208:211], a[16:19], a[224:227], v[208:211]
    ds_read_b64_tr_b16 a[56:57], v49 offset:49152
    v_mfma_f32_16x16x32_bf16 v[208:211], a[20:23], a[240:243], v[208:211]
    buffer_load_dwordx4 a[172:175], v55, s[8:11], s62 offen sc1
    ds_read_b64_tr_b16 a[58:59], v49 offset:50176
    v_mfma_f32_16x16x32_bf16 v[212:215], a[20:23], a[244:247], v[212:215]
    ds_read_b64_tr_b16 a[60:61], v49 offset:57344
    v_mfma_f32_16x16x32_bf16 v[212:215], a[16:19], a[228:231], v[212:215]
    v_mfma_f32_16x16x32_bf16 a[80:83], a[16:19], a[232:235], a[80:83]
    ds_read_b64_tr_b16 a[62:63], v49 offset:58368
    v_mfma_f32_16x16x32_bf16 a[80:83], a[20:23], a[248:251], a[80:83]
    s_add_u32 s62, s62, 0x20000
    v_mfma_f32_16x16x32_bf16 a[84:87], a[20:23], a[252:255], a[84:87]
    s_add_u32 s52, s47, 12288
    v_mfma_f32_16x16x32_bf16 a[84:87], a[16:19], a[236:239], a[84:87]
    buffer_store_dwordx4 v[112:115], v1, s[48:51], s52 offen offset:0 sc1
    v_mfma_f32_16x16x32_bf16 a[92:95], a[24:27], a[236:239], a[92:95]
    v_mfma_f32_16x16x32_bf16 a[92:95], a[28:31], a[252:255], a[92:95]
    v_mfma_f32_16x16x32_bf16 a[88:91], a[28:31], a[248:251], a[88:91]
    v_mfma_f32_16x16x32_bf16 a[88:91], a[24:27], a[232:235], a[88:91]
    v_mfma_f32_16x16x32_bf16 v[220:223], a[24:27], a[228:231], v[220:223]
    s_cmp_eq_u32 s45, 0
    s_cbranch_scc1 k12_ool_56
k12_oolret_57:
    v_mfma_f32_16x16x32_bf16 v[220:223], a[28:31], a[244:247], v[220:223]
    v_mfma_f32_16x16x32_bf16 v[216:219], a[28:31], a[240:243], v[216:219]
    v_mfma_f32_16x16x32_bf16 v[216:219], a[24:27], a[224:227], v[216:219]
    s_waitcnt vmcnt(10) lgkmcnt(0)
    s_barrier
    v_mfma_f32_16x16x32_bf16 v[224:227], a[32:35], a[224:227], v[224:227]
    v_mfma_f32_16x16x32_bf16 v[224:227], a[36:39], a[240:243], v[224:227]
    s_add_u32 m0, s60, 114688
    ds_read_b64_tr_b16 a[0:1], v42 offset:0
    ds_read_b64_tr_b16 a[2:3], v42 offset:1024
    v_mfma_f32_16x16x32_bf16 v[228:231], a[36:39], a[244:247], v[228:231]
    buffer_load_dwordx4 v38, s[12:15], s61 offen offset:0 lds
    v_mfma_f32_16x16x32_bf16 v[228:231], a[32:35], a[228:231], v[228:231]
    ds_read_b64_tr_b16 a[4:5], v42 offset:8192
    v_mfma_f32_16x16x32_bf16 a[96:99], a[32:35], a[232:235], a[96:99]
    buffer_load_dwordx4 v39, s[12:15], s61 offen offset:1024 lds
    ds_read_b64_tr_b16 a[6:7], v42 offset:9216
    v_mfma_f32_16x16x32_bf16 a[96:99], a[36:39], a[248:251], a[96:99]
    ds_read_b64_tr_b16 a[8:9], v43 offset:0
    v_mfma_f32_16x16x32_bf16 a[100:103], a[36:39], a[252:255], a[100:103]
    v_mfma_f32_16x16x32_bf16 a[100:103], a[32:35], a[236:239], a[100:103]
    buffer_load_dwordx4 v40, s[12:15], s61 offen offset:2048 lds
    ds_read_b64_tr_b16 a[10:11], v43 offset:1024
    v_mfma_f32_16x16x32_bf16 a[108:111], a[40:43], a[236:239], a[108:111]
    ds_read_b64_tr_b16 a[12:13], v43 offset:8192
    v_mfma_f32_16x16x32_bf16 a[108:111], a[44:47], a[252:255], a[108:111]
    ds_read_b64_tr_b16 a[14:15], v43 offset:9216
    v_mfma_f32_16x16x32_bf16 a[104:107], a[44:47], a[248:251], a[104:107]
    ds_read_b64_tr_b16 a[16:17], v44 offset:0
    v_mfma_f32_16x16x32_bf16 a[104:107], a[40:43], a[232:235], a[104:107]
    buffer_load_dwordx4 v41, s[12:15], s61 offen offset:3072 lds
    v_mfma_f32_16x16x32_bf16 v[236:239], a[40:43], a[228:231], v[236:239]
    ds_read_b64_tr_b16 a[18:19], v44 offset:1024
    v_mfma_f32_16x16x32_bf16 v[236:239], a[44:47], a[244:247], v[236:239]
    s_add_u32 s61, s61, 0x80000
    ds_read_b64_tr_b16 a[20:21], v44 offset:8192
    v_mfma_f32_16x16x32_bf16 v[232:235], a[44:47], a[240:243], v[232:235]
    buffer_load_dwordx4 a[176:179], v36, s[8:11], s62 offen sc1
    ds_read_b64_tr_b16 a[22:23], v44 offset:9216
    v_mfma_f32_16x16x32_bf16 v[232:235], a[40:43], a[224:227], v[232:235]
    v_mfma_f32_16x16x32_bf16 v[240:243], a[48:51], a[224:227], v[240:243]
    ds_read_b64_tr_b16 a[24:25], v45 offset:0
    v_mfma_f32_16x16x32_bf16 v[240:243], a[52:55], a[240:243], v[240:243]
    buffer_load_dwordx4 a[180:183], v54, s[8:11], s62 offen sc1
    ds_read_b64_tr_b16 a[26:27], v45 offset:1024
    v_mfma_f32_16x16x32_bf16 v[244:247], a[52:55], a[244:247], v[244:247]
    ds_read_b64_tr_b16 a[28:29], v45 offset:8192
    v_mfma_f32_16x16x32_bf16 v[244:247], a[48:51], a[228:231], v[244:247]
    v_mfma_f32_16x16x32_bf16 a[112:115], a[48:51], a[232:235], a[112:115]
    buffer_load_dwordx4 a[184:187], v37, s[8:11], s62 offen sc1
    ds_read_b64_tr_b16 a[30:31], v45 offset:9216
    v_mfma_f32_16x16x32_bf16 a[112:115], a[52:55], a[248:251], a[112:115]
    v_mfma_f32_16x16x32_bf16 a[116:119], a[52:55], a[252:255], a[116:119]
    v_mfma_f32_16x16x32_bf16 a[116:119], a[48:51], a[236:239], a[116:119]
    v_mfma_f32_16x16x32_bf16 a[124:127], a[56:59], a[236:239], a[124:127]
    buffer_load_dwordx4 a[188:191], v55, s[8:11], s62 offen sc1
    v_mfma_f32_16x16x32_bf16 a[124:127], a[60:63], a[252:255], a[124:127]
    v_mfma_f32_16x16x32_bf16 a[120:123], a[60:63], a[248:251], a[120:123]
    s_add_u32 s62, s62, 0x20000
    v_mfma_f32_16x16x32_bf16 a[120:123], a[56:59], a[232:235], a[120:123]
    v_mfma_f32_16x16x32_bf16 v[252:255], a[56:59], a[228:231], v[252:255]
    v_mfma_f32_16x16x32_bf16 v[252:255], a[60:63], a[244:247], v[252:255]
    v_mfma_f32_16x16x32_bf16 v[248:251], a[60:63], a[240:243], v[248:251]
    v_mfma_f32_16x16x32_bf16 v[248:251], a[56:59], a[224:227], v[248:251]
    s_waitcnt vmcnt(14) lgkmcnt(0)
    v_mfma_f32_16x16x32_bf16 v[192:195], a[0:3], a[128:131], v[192:195]
    v_mfma_f32_16x16x32_bf16 v[192:195], a[4:7], a[144:147], v[192:195]
    buffer_load_dwordx4 a[192:195], v36, s[8:11], s62 offen sc1
    ds_read_b64_tr_b16 a[32:33], v46 offset:0
    v_mfma_f32_16x16x32_bf16 v[196:199], a[4:7], a[148:151], v[196:199]
    ds_read_b64_tr_b16 a[34:35], v46 offset:1024
    v_mfma_f32_16x16x32_bf16 v[196:199], a[0:3], a[132:135], v[196:199]
    ds_read_b64_tr_b16 a[36:37], v46 offset:8192
    v_mfma_f32_16x16x32_bf16 a[64:67], a[0:3], a[136:139], a[64:67]
    ds_read_b64_tr_b16 a[38:39], v46 offset:9216
    v_mfma_f32_16x16x32_bf16 a[64:67], a[4:7], a[152:155], a[64:67]
    ds_read_b64_tr_b16 a[40:41], v47 offset:0
    v_mfma_f32_16x16x32_bf16 a[68:71], a[4:7], a[156:159], a[68:71]
    buffer_load_dwordx4 a[196:199], v54, s[8:11], s62 offen sc1
    v_mfma_f32_16x16x32_bf16 a[68:71], a[0:3], a[140:143], a[68:71]
    ds_read_b64_tr_b16 a[42:43], v47 offset:1024
    v_mfma_f32_16x16x32_bf16 a[76:79], a[8:11], a[140:143], a[76:79]
    ds_read_b64_tr_b16 a[44:45], v47 offset:8192
    v_mfma_f32_16x16x32_bf16 a[76:79], a[12:15], a[156:159], a[76:79]
    ds_read_b64_tr_b16 a[46:47], v47 offset:9216
    v_mfma_f32_16x16x32_bf16 a[72:75], a[12:15], a[152:155], a[72:75]
    ds_read_b64_tr_b16 a[48:49], v48 offset:0
    v_mfma_f32_16x16x32_bf16 a[72:75], a[8:11], a[136:139], a[72:75]
    buffer_load_dwordx4 a[200:203], v37, s[8:11], s62 offen sc1
    v_mfma_f32_16x16x32_bf16 v[204:207], a[8:11], a[132:135], v[204:207]
    ds_read_b64_tr_b16 a[50:51], v48 offset:1024
    v_mfma_f32_16x16x32_bf16 v[204:207], a[12:15], a[148:151], v[204:207]
    ds_read_b64_tr_b16 a[52:53], v48 offset:8192
    v_mfma_f32_16x16x32_bf16 v[200:203], a[12:15], a[144:147], v[200:203]
    ds_read_b64_tr_b16 a[54:55], v48 offset:9216
    v_mfma_f32_16x16x32_bf16 v[200:203], a[8:11], a[128:131], v[200:203]
    v_mfma_f32_16x16x32_bf16 v[208:211], a[16:19], a[128:131], v[208:211]
    ds_read_b64_tr_b16 a[56:57], v49 offset:0
    v_mfma_f32_16x16x32_bf16 v[208:211], a[20:23], a[144:147], v[208:211]
    buffer_load_dwordx4 a[204:207], v55, s[8:11], s62 offen sc1
    ds_read_b64_tr_b16 a[58:59], v49 offset:1024
    v_mfma_f32_16x16x32_bf16 v[212:215], a[20:23], a[148:151], v[212:215]
    ds_read_b64_tr_b16 a[60:61], v49 offset:8192
    v_mfma_f32_16x16x32_bf16 v[212:215], a[16:19], a[132:135], v[212:215]
    v_mfma_f32_16x16x32_bf16 a[80:83], a[16:19], a[136:139], a[80:83]
    ds_read_b64_tr_b16 a[62:63], v49 offset:9216
    v_mfma_f32_16x16x32_bf16 a[80:83], a[20:23], a[152:155], a[80:83]
    s_add_u32 s62, s62, 0x20000
    v_mfma_f32_16x16x32_bf16 a[84:87], a[20:23], a[156:159], a[84:87]
    s_add_u32 s52, s47, 12288
    v_mfma_f32_16x16x32_bf16 a[84:87], a[16:19], a[140:143], a[84:87]
    buffer_store_dwordx4 v[116:119], v1, s[48:51], s52 offen offset:1024 sc1
    v_mfma_f32_16x16x32_bf16 a[92:95], a[24:27], a[140:143], a[92:95]
    v_mfma_f32_16x16x32_bf16 a[92:95], a[28:31], a[156:159], a[92:95]
    v_mfma_f32_16x16x32_bf16 a[88:91], a[28:31], a[152:155], a[88:91]
    v_mfma_f32_16x16x32_bf16 a[88:91], a[24:27], a[136:139], a[88:91]
    v_mfma_f32_16x16x32_bf16 v[220:223], a[24:27], a[132:135], v[220:223]
    s_cmp_eq_u32 s45, 0
    s_cbranch_scc1 k12_ool_58
k12_oolret_59:
    v_mfma_f32_16x16x32_bf16 v[220:223], a[28:31], a[148:151], v[220:223]
    v_mfma_f32_16x16x32_bf16 v[216:219], a[28:31], a[144:147], v[216:219]
    v_mfma_f32_16x16x32_bf16 v[216:219], a[24:27], a[128:131], v[216:219]
    s_waitcnt vmcnt(9) lgkmcnt(0)
    s_barrier
    v_mfma_f32_16x16x32_bf16 v[224:227], a[32:35], a[128:131], v[224:227]
    v_mfma_f32_16x16x32_bf16 v[224:227], a[36:39], a[144:147], v[224:227]
    s_add_u32 m0, s60, 131072
    ds_read_b64_tr_b16 a[0:1], v42 offset:16384
    ds_read_b64_tr_b16 a[2:3], v42 offset:17408
    v_mfma_f32_16x16x32_bf16 v[228:231], a[36:39], a[148:151], v[228:231]
    buffer_load_dwordx4 v38, s[12:15], s61 offen offset:0 lds
    v_mfma_f32_16x16x32_bf16 v[228:231], a[32:35], a[132:135], v[228:231]
    ds_read_b64_tr_b16 a[4:5], v42 offset:24576
    v_mfma_f32_16x16x32_bf16 a[96:99], a[32:35], a[136:139], a[96:99]
    buffer_load_dwordx4 v39, s[12:15], s61 offen offset:1024 lds
    ds_read_b64_tr_b16 a[6:7], v42 offset:25600
    v_mfma_f32_16x16x32_bf16 a[96:99], a[36:39], a[152:155], a[96:99]
    ds_read_b64_tr_b16 a[8:9], v43 offset:16384
    v_mfma_f32_16x16x32_bf16 a[100:103], a[36:39], a[156:159], a[100:103]
    v_mfma_f32_16x16x32_bf16 a[100:103], a[32:35], a[140:143], a[100:103]
    buffer_load_dwordx4 v40, s[12:15], s61 offen offset:2048 lds
    ds_read_b64_tr_b16 a[10:11], v43 offset:17408
    v_mfma_f32_16x16x32_bf16 a[108:111], a[40:43], a[140:143], a[108:111]
    ds_read_b64_tr_b16 a[12:13], v43 offset:24576
    v_mfma_f32_16x16x32_bf16 a[108:111], a[44:47], a[156:159], a[108:111]
    ds_read_b64_tr_b16 a[14:15], v43 offset:25600
    v_mfma_f32_16x16x32_bf16 a[104:107], a[44:47], a[152:155], a[104:107]
    buffer_load_dwordx4 v41, s[12:15], s61 offen offset:3072 lds
    ds_read_b64_tr_b16 a[16:17], v44 offset:16384
    v_mfma_f32_16x16x32_bf16 a[104:107], a[40:43], a[136:139], a[104:107]
    v_mfma_f32_16x16x32_bf16 v[236:239], a[40:43], a[132:135], v[236:239]
    s_add_u32 s61, s61, 0x80000
    ds_read_b64_tr_b16 a[18:19], v44 offset:17408
    v_mfma_f32_16x16x32_bf16 v[236:239], a[44:47], a[148:151], v[236:239]
    buffer_load_dwordx4 a[208:211], v36, s[8:11], s62 offen sc1
    ds_read_b64_tr_b16 a[20:21], v44 offset:24576
    v_mfma_f32_16x16x32_bf16 v[232:235], a[44:47], a[144:147], v[232:235]
    ds_read_b64_tr_b16 a[22:23], v44 offset:25600
    v_mfma_f32_16x16x32_bf16 v[232:235], a[40:43], a[128:131], v[232:235]
    buffer_load_dwordx4 a[212:215], v54, s[8:11], s62 offen sc1
    v_mfma_f32_16x16x32_bf16 v[240:243], a[48:51], a[128:131], v[240:243]
    ds_read_b64_tr_b16 a[24:25], v45 offset:16384
    v_mfma_f32_16x16x32_bf16 v[240:243], a[52:55], a[144:147], v[240:243]
    ds_read_b64_tr_b16 a[26:27], v45 offset:17408
    v_mfma_f32_16x16x32_bf16 v[244:247], a[52:55], a[148:151], v[244:247]
    buffer_load_dwordx4 a[216:219], v37, s[8:11], s62 offen sc1
    ds_read_b64_tr_b16 a[28:29], v45 offset:24576
    v_mfma_f32_16x16x32_bf16 v[244:247], a[48:51], a[132:135], v[244:247]
    v_mfma_f32_16x16x32_bf16 a[112:115], a[48:51], a[136:139], a[112:115]
    ds_read_b64_tr_b16 a[30:31], v45 offset:25600
    v_mfma_f32_16x16x32_bf16 a[112:115], a[52:55], a[152:155], a[112:115]
    buffer_load_dwordx4 a[220:223], v55, s[8:11], s62 offen sc1
    v_mfma_f32_16x16x32_bf16 a[116:119], a[52:55], a[156:159], a[116:119]
    v_mfma_f32_16x16x32_bf16 a[116:119], a[48:51], a[140:143], a[116:119]
    s_add_u32 s62, s62, 0x20000
    v_mfma_f32_16x16x32_bf16 a[124:127], a[56:59], a[140:143], a[124:127]
    s_add_u32 s52, s47, 12288
    v_mfma_f32_16x16x32_bf16 a[124:127], a[60:63], a[156:159], a[124:127]
    buffer_store_dwordx4 v[120:123], v1, s[48:51], s52 offen offset:2048 sc1
    v_mfma_f32_16x16x32_bf16 a[120:123], a[60:63], a[152:155], a[120:123]
    v_mfma_f32_16x16x32_bf16 a[120:123], a[56:59], a[136:139], a[120:123]
    v_mfma_f32_16x16x32_bf16 v[252:255], a[56:59], a[132:135], v[252:255]
    v_mfma_f32_16x16x32_bf16 v[252:255], a[60:63], a[148:151], v[252:255]
    v_mfma_f32_16x16x32_bf16 v[248:251], a[60:63], a[144:147], v[248:251]
    v_mfma_f32_16x16x32_bf16 v[248:251], a[56:59], a[128:131], v[248:251]
    s_waitcnt vmcnt(14) lgkmcnt(0)
    v_mfma_f32_16x16x32_bf16 v[192:195], a[0:3], a[160:163], v[192:195]
    v_mfma_f32_16x16x32_bf16 v[192:195], a[4:7], a[176:179], v[192:195]
    buffer_load_dwordx4 a[224:227], v36, s[8:11], s62 offen sc1
    ds_read_b64_tr_b16 a[32:33], v46 offset:16384
    v_mfma_f32_16x16x32_bf16 v[196:199], a[4:7], a[180:183], v[196:199]
    ds_read_b64_tr_b16 a[34:35], v46 offset:17408
    v_mfma_f32_16x16x32_bf16 v[196:199], a[0:3], a[164:167], v[196:199]
    ds_read_b64_tr_b16 a[36:37], v46 offset:24576
    v_mfma_f32_16x16x32_bf16 a[64:67], a[0:3], a[168:171], a[64:67]
    ds_read_b64_tr_b16 a[38:39], v46 offset:25600
    v_mfma_f32_16x16x32_bf16 a[64:67], a[4:7], a[184:187], a[64:67]
    ds_read_b64_tr_b16 a[40:41], v47 offset:16384
    v_mfma_f32_16x16x32_bf16 a[68:71], a[4:7], a[188:191], a[68:71]
    buffer_load_dwordx4 a[228:231], v54, s[8:11], s62 offen sc1
    v_mfma_f32_16x16x32_bf16 a[68:71], a[0:3], a[172:175], a[68:71]
    ds_read_b64_tr_b16 a[42:43], v47 offset:17408
    v_mfma_f32_16x16x32_bf16 a[76:79], a[8:11], a[172:175], a[76:79]
    ds_read_b64_tr_b16 a[44:45], v47 offset:24576
    v_mfma_f32_16x16x32_bf16 a[76:79], a[12:15], a[188:191], a[76:79]
    ds_read_b64_tr_b16 a[46:47], v47 offset:25600
    v_mfma_f32_16x16x32_bf16 a[72:75], a[12:15], a[184:187], a[72:75]
    ds_read_b64_tr_b16 a[48:49], v48 offset:16384
    v_mfma_f32_16x16x32_bf16 a[72:75], a[8:11], a[168:171], a[72:75]
    buffer_load_dwordx4 a[232:235], v37, s[8:11], s62 offen sc1
    v_mfma_f32_16x16x32_bf16 v[204:207], a[8:11], a[164:167], v[204:207]
    ds_read_b64_tr_b16 a[50:51], v48 offset:17408
    v_mfma_f32_16x16x32_bf16 v[204:207], a[12:15], a[180:183], v[204:207]
    ds_read_b64_tr_b16 a[52:53], v48 offset:24576
    v_mfma_f32_16x16x32_bf16 v[200:203], a[12:15], a[176:179], v[200:203]
    ds_read_b64_tr_b16 a[54:55], v48 offset:25600
    v_mfma_f32_16x16x32_bf16 v[200:203], a[8:11], a[160:163], v[200:203]
    v_mfma_f32_16x16x32_bf16 v[208:211], a[16:19], a[160:163], v[208:211]
    ds_read_b64_tr_b16 a[56:57], v49 offset:16384
    v_mfma_f32_16x16x32_bf16 v[208:211], a[20:23], a[176:179], v[208:211]
    buffer_load_dwordx4 a[236:239], v55, s[8:11], s62 offen sc1
    ds_read_b64_tr_b16 a[58:59], v49 offset:17408
    v_mfma_f32_16x16x32_bf16 v[212:215], a[20:23], a[180:183], v[212:215]
    ds_read_b64_tr_b16 a[60:61], v49 offset:24576
    v_mfma_f32_16x16x32_bf16 v[212:215], a[16:19], a[164:167], v[212:215]
    v_mfma_f32_16x16x32_bf16 a[80:83], a[16:19], a[168:171], a[80:83]
    ds_read_b64_tr_b16 a[62:63], v49 offset:25600
    v_mfma_f32_16x16x32_bf16 a[80:83], a[20:23], a[184:187], a[80:83]
    s_add_u32 s62, s62, 0x20000
    v_mfma_f32_16x16x32_bf16 a[84:87], a[20:23], a[188:191], a[84:87]
    s_add_u32 s52, s47, 12288
    v_mfma_f32_16x16x32_bf16 a[84:87], a[16:19], a[172:175], a[84:87]
    buffer_store_dwordx4 v[124:127], v1, s[48:51], s52 offen offset:3072 sc1
    v_mfma_f32_16x16x32_bf16 a[92:95], a[24:27], a[172:175], a[92:95]
    v_mfma_f32_16x16x32_bf16 a[92:95], a[28:31], a[188:191], a[92:95]
    v_mfma_f32_16x16x32_bf16 a[88:91], a[28:31], a[184:187], a[88:91]
    v_mfma_f32_16x16x32_bf16 a[88:91], a[24:27], a[168:171], a[88:91]
    v_mfma_f32_16x16x32_bf16 v[220:223], a[24:27], a[164:167], v[220:223]
    v_mfma_f32_16x16x32_bf16 v[220:223], a[28:31], a[180:183], v[220:223]
    v_mfma_f32_16x16x32_bf16 v[216:219], a[28:31], a[176:179], v[216:219]
    v_mfma_f32_16x16x32_bf16 v[216:219], a[24:27], a[160:163], v[216:219]
    s_waitcnt vmcnt(10) lgkmcnt(0)
    s_barrier
    v_mfma_f32_16x16x32_bf16 v[224:227], a[32:35], a[160:163], v[224:227]
    v_mfma_f32_16x16x32_bf16 v[224:227], a[36:39], a[176:179], v[224:227]
    s_add_u32 m0, s60, 147456
    ds_read_b64_tr_b16 a[0:1], v42 offset:32768
    ds_read_b64_tr_b16 a[2:3], v42 offset:33792
    v_mfma_f32_16x16x32_bf16 v[228:231], a[36:39], a[180:183], v[228:231]
    buffer_load_dwordx4 v38, s[12:15], s61 offen offset:0 lds
    v_mfma_f32_16x16x32_bf16 v[228:231], a[32:35], a[164:167], v[228:231]
    ds_read_b64_tr_b16 a[4:5], v42 offset:40960
    v_mfma_f32_16x16x32_bf16 a[96:99], a[32:35], a[168:171], a[96:99]
    buffer_load_dwordx4 v39, s[12:15], s61 offen offset:1024 lds
    ds_read_b64_tr_b16 a[6:7], v42 offset:41984
    v_mfma_f32_16x16x32_bf16 a[96:99], a[36:39], a[184:187], a[96:99]
    ds_read_b64_tr_b16 a[8:9], v43 offset:32768
    v_mfma_f32_16x16x32_bf16 a[100:103], a[36:39], a[188:191], a[100:103]
    v_mfma_f32_16x16x32_bf16 a[100:103], a[32:35], a[172:175], a[100:103]
    buffer_load_dwordx4 v40, s[12:15], s61 offen offset:2048 lds
    ds_read_b64_tr_b16 a[10:11], v43 offset:33792
    v_mfma_f32_16x16x32_bf16 a[108:111], a[40:43], a[172:175], a[108:111]
    ds_read_b64_tr_b16 a[12:13], v43 offset:40960
    v_mfma_f32_16x16x32_bf16 a[108:111], a[44:47], a[188:191], a[108:111]
    ds_read_b64_tr_b16 a[14:15], v43 offset:41984
    v_mfma_f32_16x16x32_bf16 a[104:107], a[44:47], a[184:187], a[104:107]
    buffer_load_dwordx4 v41, s[12:15], s61 offen offset:3072 lds
    ds_read_b64_tr_b16 a[16:17], v44 offset:32768
    v_mfma_f32_16x16x32_bf16 a[104:107], a[40:43], a[168:171], a[104:107]
    v_mfma_f32_16x16x32_bf16 v[236:239], a[40:43], a[164:167], v[236:239]
    s_add_u32 s61, s61, 0x80000
    ds_read_b64_tr_b16 a[18:19], v44 offset:33792
    v_mfma_f32_16x16x32_bf16 v[236:239], a[44:47], a[180:183], v[236:239]
    buffer_load_dwordx4 a[240:243], v36, s[8:11], s62 offen sc1
    ds_read_b64_tr_b16 a[20:21], v44 offset:40960
    v_mfma_f32_16x16x32_bf16 v[232:235], a[44:47], a[176:179], v[232:235]
    ds_read_b64_tr_b16 a[22:23], v44 offset:41984
    v_mfma_f32_16x16x32_bf16 v[232:235], a[40:43], a[160:163], v[232:235]
    buffer_load_dwordx4 a[244:247], v54, s[8:11], s62 offen sc1
    v_mfma_f32_16x16x32_bf16 v[240:243], a[48:51], a[160:163], v[240:243]
    ds_read_b64_tr_b16 a[24:25], v45 offset:32768
    v_mfma_f32_16x16x32_bf16 v[240:243], a[52:55], a[176:179], v[240:243]
    ds_read_b64_tr_b16 a[26:27], v45 offset:33792
    v_mfma_f32_16x16x32_bf16 v[244:247], a[52:55], a[180:183], v[244:247]
    buffer_load_dwordx4 a[248:251], v37, s[8:11], s62 offen sc1
    ds_read_b64_tr_b16 a[28:29], v45 offset:40960
    v_mfma_f32_16x16x32_bf16 v[244:247], a[48:51], a[164:167], v[244:247]
    v_mfma_f32_16x16x32_bf16 a[112:115], a[48:51], a[168:171], a[112:115]
    ds_read_b64_tr_b16 a[30:31], v45 offset:41984
    v_mfma_f32_16x16x32_bf16 a[112:115], a[52:55], a[184:187], a[112:115]
    buffer_load_dwordx4 a[252:255], v55, s[8:11], s62 offen sc1
    v_mfma_f32_16x16x32_bf16 a[116:119], a[52:55], a[188:191], a[116:119]
    v_mfma_f32_16x16x32_bf16 a[116:119], a[48:51], a[172:175], a[116:119]
    s_add_u32 s62, s62, 0x20000
    v_mfma_f32_16x16x32_bf16 a[124:127], a[56:59], a[172:175], a[124:127]
    s_add_u32 s52, s47, 524288
    v_mfma_f32_16x16x32_bf16 a[124:127], a[60:63], a[188:191], a[124:127]
    buffer_store_dwordx4 v[136:139], v1, s[48:51], s52 offen offset:2048 sc1
    v_mfma_f32_16x16x32_bf16 a[120:123], a[60:63], a[184:187], a[120:123]
    v_mfma_f32_16x16x32_bf16 a[120:123], a[56:59], a[168:171], a[120:123]
    v_mfma_f32_16x16x32_bf16 v[252:255], a[56:59], a[164:167], v[252:255]
    s_cmp_eq_u32 s45, 0
    s_cbranch_scc1 k12_ool_60
k12_oolret_61:
    v_mfma_f32_16x16x32_bf16 v[252:255], a[60:63], a[180:183], v[252:255]
    v_mfma_f32_16x16x32_bf16 v[248:251], a[60:63], a[176:179], v[248:251]
    v_mfma_f32_16x16x32_bf16 v[248:251], a[56:59], a[160:163], v[248:251]
    s_waitcnt vmcnt(15) lgkmcnt(0)
    v_mfma_f32_16x16x32_bf16 v[192:195], a[0:3], a[192:195], v[192:195]
    v_mfma_f32_16x16x32_bf16 v[192:195], a[4:7], a[208:211], v[192:195]
    buffer_load_dwordx4 a[128:131], v36, s[8:11], s62 offen sc1
    ds_read_b64_tr_b16 a[32:33], v46 offset:32768
    v_mfma_f32_16x16x32_bf16 v[196:199], a[4:7], a[212:215], v[196:199]
    ds_read_b64_tr_b16 a[34:35], v46 offset:33792
    v_mfma_f32_16x16x32_bf16 v[196:199], a[0:3], a[196:199], v[196:199]
    ds_read_b64_tr_b16 a[36:37], v46 offset:40960
    v_mfma_f32_16x16x32_bf16 a[64:67], a[0:3], a[200:203], a[64:67]
    ds_read_b64_tr_b16 a[38:39], v46 offset:41984
    v_mfma_f32_16x16x32_bf16 a[64:67], a[4:7], a[216:219], a[64:67]
    ds_read_b64_tr_b16 a[40:41], v47 offset:32768
    v_mfma_f32_16x16x32_bf16 a[68:71], a[4:7], a[220:223], a[68:71]
    buffer_load_dwordx4 a[132:135], v54, s[8:11], s62 offen sc1
    v_mfma_f32_16x16x32_bf16 a[68:71], a[0:3], a[204:207], a[68:71]
    ds_read_b64_tr_b16 a[42:43], v47 offset:33792
    v_mfma_f32_16x16x32_bf16 a[76:79], a[8:11], a[204:207], a[76:79]
    ds_read_b64_tr_b16 a[44:45], v47 offset:40960
    v_mfma_f32_16x16x32_bf16 a[76:79], a[12:15], a[220:223], a[76:79]
    ds_read_b64_tr_b16 a[46:47], v47 offset:41984
    v_mfma_f32_16x16x32_bf16 a[72:75], a[12:15], a[216:219], a[72:75]
    ds_read_b64_tr_b16 a[48:49], v48 offset:32768
    v_mfma_f32_16x16x32_bf16 a[72:75], a[8:11], a[200:203], a[72:75]
    buffer_load_dwordx4 a[136:139], v37, s[8:11], s62 offen sc1
    v_mfma_f32_16x16x32_bf16 v[204:207], a[8:11], a[196:199], v[204:207]
    ds_read_b64_tr_b16 a[50:51], v48 offset:33792
    v_mfma_f32_16x16x32_bf16 v[204:207], a[12:15], a[212:215], v[204:207]
    ds_read_b64_tr_b16 a[52:53], v48 offset:40960
    v_mfma_f32_16x16x32_bf16 v[200:203], a[12:15], a[208:211], v[200:203]
    ds_read_b64_tr_b16 a[54:55], v48 offset:41984
    v_mfma_f32_16x16x32_bf16 v[200:203], a[8:11], a[192:195], v[200:203]
    v_mfma_f32_16x16x32_bf16 v[208:211], a[16:19], a[192:195], v[208:211]
    ds_read_b64_tr_b16 a[56:57], v49 offset:32768
    v_mfma_f32_16x16x32_bf16 v[208:211], a[20:23], a[208:211], v[208:211]
    buffer_load_dwordx4 a[140:143], v55, s[8:11], s62 offen sc1
    ds_read_b64_tr_b16 a[58:59], v49 offset:33792
    v_mfma_f32_16x16x32_bf16 v[212:215], a[20:23], a[212:215], v[212:215]
    ds_read_b64_tr_b16 a[60:61], v49 offset:40960
    v_mfma_f32_16x16x32_bf16 v[212:215], a[16:19], a[196:199], v[212:215]
    v_mfma_f32_16x16x32_bf16 a[80:83], a[16:19], a[200:203], a[80:83]
    ds_read_b64_tr_b16 a[62:63], v49 offset:41984
    v_mfma_f32_16x16x32_bf16 a[80:83], a[20:23], a[216:219], a[80:83]
    s_add_u32 s62, s62, 0x20000
    v_mfma_f32_16x16x32_bf16 a[84:87], a[20:23], a[220:223], a[84:87]
    s_add_u32 s52, s47, 524288
    v_mfma_f32_16x16x32_bf16 a[84:87], a[16:19], a[204:207], a[84:87]
    buffer_store_dwordx4 v[140:143], v1, s[48:51], s52 offen offset:3072 sc1
    v_mfma_f32_16x16x32_bf16 a[92:95], a[24:27], a[204:207], a[92:95]
    v_mfma_f32_16x16x32_bf16 a[92:95], a[28:31], a[220:223], a[92:95]
    v_mfma_f32_16x16x32_bf16 a[88:91], a[28:31], a[216:219], a[88:91]
    v_mfma_f32_16x16x32_bf16 a[88:91], a[24:27], a[200:203], a[88:91]
    v_mfma_f32_16x16x32_bf16 v[220:223], a[24:27], a[196:199], v[220:223]
    v_mfma_f32_16x16x32_bf16 v[220:223], a[28:31], a[212:215], v[220:223]
    v_mfma_f32_16x16x32_bf16 v[216:219], a[28:31], a[208:211], v[216:219]
    v_mfma_f32_16x16x32_bf16 v[216:219], a[24:27], a[192:195], v[216:219]
    s_waitcnt vmcnt(10) lgkmcnt(0)
    s_barrier
    v_mfma_f32_16x16x32_bf16 v[224:227], a[32:35], a[192:195], v[224:227]
    v_mfma_f32_16x16x32_bf16 v[224:227], a[36:39], a[208:211], v[224:227]
    s_add_u32 m0, s60, 98304
    ds_read_b64_tr_b16 a[0:1], v42 offset:49152
    ds_read_b64_tr_b16 a[2:3], v42 offset:50176
    v_mfma_f32_16x16x32_bf16 v[228:231], a[36:39], a[212:215], v[228:231]
    buffer_load_dwordx4 v38, s[12:15], s61 offen offset:0 lds
    v_mfma_f32_16x16x32_bf16 v[228:231], a[32:35], a[196:199], v[228:231]
    ds_read_b64_tr_b16 a[4:5], v42 offset:57344
    v_mfma_f32_16x16x32_bf16 a[96:99], a[32:35], a[200:203], a[96:99]
    buffer_load_dwordx4 v39, s[12:15], s61 offen offset:1024 lds
    ds_read_b64_tr_b16 a[6:7], v42 offset:58368
    v_mfma_f32_16x16x32_bf16 a[96:99], a[36:39], a[216:219], a[96:99]
    ds_read_b64_tr_b16 a[8:9], v43 offset:49152
    v_mfma_f32_16x16x32_bf16 a[100:103], a[36:39], a[220:223], a[100:103]
    v_mfma_f32_16x16x32_bf16 a[100:103], a[32:35], a[204:207], a[100:103]
    buffer_load_dwordx4 v40, s[12:15], s61 offen offset:2048 lds
    ds_read_b64_tr_b16 a[10:11], v43 offset:50176
    v_mfma_f32_16x16x32_bf16 a[108:111], a[40:43], a[204:207], a[108:111]
    ds_read_b64_tr_b16 a[12:13], v43 offset:57344
    v_mfma_f32_16x16x32_bf16 a[108:111], a[44:47], a[220:223], a[108:111]
    ds_read_b64_tr_b16 a[14:15], v43 offset:58368
    v_mfma_f32_16x16x32_bf16 a[104:107], a[44:47], a[216:219], a[104:107]
    ds_read_b64_tr_b16 a[16:17], v44 offset:49152
    v_mfma_f32_16x16x32_bf16 a[104:107], a[40:43], a[200:203], a[104:107]
    buffer_load_dwordx4 v41, s[12:15], s61 offen offset:3072 lds
    v_mfma_f32_16x16x32_bf16 v[236:239], a[40:43], a[196:199], v[236:239]
    ds_read_b64_tr_b16 a[18:19], v44 offset:50176
    v_mfma_f32_16x16x32_bf16 v[236:239], a[44:47], a[212:215], v[236:239]
    s_add_u32 s61, s61, 0x80000
    ds_read_b64_tr_b16 a[20:21], v44 offset:57344
    v_mfma_f32_16x16x32_bf16 v[232:235], a[44:47], a[208:211], v[232:235]
    buffer_load_dwordx4 a[144:147], v36, s[8:11], s62 offen sc1
    ds_read_b64_tr_b16 a[22:23], v44 offset:58368
    v_mfma_f32_16x16x32_bf16 v[232:235], a[40:43], a[192:195], v[232:235]
    v_mfma_f32_16x16x32_bf16 v[240:243], a[48:51], a[192:195], v[240:243]
    ds_read_b64_tr_b16 a[24:25], v45 offset:49152
    v_mfma_f32_16x16x32_bf16 v[240:243], a[52:55], a[208:211], v[240:243]
    buffer_load_dwordx4 a[148:151], v54, s[8:11], s62 offen sc1
    ds_read_b64_tr_b16 a[26:27], v45 offset:50176
    v_mfma_f32_16x16x32_bf16 v[244:247], a[52:55], a[212:215], v[244:247]
    ds_read_b64_tr_b16 a[28:29], v45 offset:57344
    v_mfma_f32_16x16x32_bf16 v[244:247], a[48:51], a[196:199], v[244:247]
    v_mfma_f32_16x16x32_bf16 a[112:115], a[48:51], a[200:203], a[112:115]
    buffer_load_dwordx4 a[152:155], v37, s[8:11], s62 offen sc1
    ds_read_b64_tr_b16 a[30:31], v45 offset:58368
    v_mfma_f32_16x16x32_bf16 a[112:115], a[52:55], a[216:219], a[112:115]
    v_mfma_f32_16x16x32_bf16 a[116:119], a[52:55], a[220:223], a[116:119]
    v_mfma_f32_16x16x32_bf16 a[116:119], a[48:51], a[204:207], a[116:119]
    v_mfma_f32_16x16x32_bf16 a[124:127], a[56:59], a[204:207], a[124:127]
    buffer_load_dwordx4 a[156:159], v55, s[8:11], s62 offen sc1
    v_mfma_f32_16x16x32_bf16 a[124:127], a[60:63], a[220:223], a[124:127]
    v_mfma_f32_16x16x32_bf16 a[120:123], a[60:63], a[216:219], a[120:123]
    s_add_u32 s62, s62, 0x20000
    v_mfma_f32_16x16x32_bf16 a[120:123], a[56:59], a[200:203], a[120:123]
    v_mfma_f32_16x16x32_bf16 v[252:255], a[56:59], a[196:199], v[252:255]
    s_cmp_eq_u32 s45, 0
    s_cbranch_scc1 k12_ool_62
k12_oolret_63:
    v_mfma_f32_16x16x32_bf16 v[252:255], a[60:63], a[212:215], v[252:255]
    v_mfma_f32_16x16x32_bf16 v[248:251], a[60:63], a[208:211], v[248:251]
    v_mfma_f32_16x16x32_bf16 v[248:251], a[56:59], a[192:195], v[248:251]
    s_waitcnt vmcnt(14) lgkmcnt(0)
    v_mfma_f32_16x16x32_bf16 v[192:195], a[0:3], a[224:227], v[192:195]
    v_mfma_f32_16x16x32_bf16 v[192:195], a[4:7], a[240:243], v[192:195]
    buffer_load_dwordx4 a[160:163], v36, s[8:11], s62 offen sc1
    ds_read_b64_tr_b16 a[32:33], v46 offset:49152
    v_mfma_f32_16x16x32_bf16 v[196:199], a[4:7], a[244:247], v[196:199]
    ds_read_b64_tr_b16 a[34:35], v46 offset:50176
    v_mfma_f32_16x16x32_bf16 v[196:199], a[0:3], a[228:231], v[196:199]
    ds_read_b64_tr_b16 a[36:37], v46 offset:57344
    v_mfma_f32_16x16x32_bf16 a[64:67], a[0:3], a[232:235], a[64:67]
    ds_read_b64_tr_b16 a[38:39], v46 offset:58368
    v_mfma_f32_16x16x32_bf16 a[64:67], a[4:7], a[248:251], a[64:67]
    ds_read_b64_tr_b16 a[40:41], v47 offset:49152
    v_mfma_f32_16x16x32_bf16 a[68:71], a[4:7], a[252:255], a[68:71]
    buffer_load_dwordx4 a[164:167], v54, s[8:11], s62 offen sc1
    v_mfma_f32_16x16x32_bf16 a[68:71], a[0:3], a[236:239], a[68:71]
    ds_read_b64_tr_b16 a[42:43], v47 offset:50176
    v_mfma_f32_16x16x32_bf16 a[76:79], a[8:11], a[236:239], a[76:79]
    ds_read_b64_tr_b16 a[44:45], v47 offset:57344
    v_mfma_f32_16x16x32_bf16 a[76:79], a[12:15], a[252:255], a[76:79]
    ds_read_b64_tr_b16 a[46:47], v47 offset:58368
    v_mfma_f32_16x16x32_bf16 a[72:75], a[12:15], a[248:251], a[72:75]
    ds_read_b64_tr_b16 a[48:49], v48 offset:49152
    v_mfma_f32_16x16x32_bf16 a[72:75], a[8:11], a[232:235], a[72:75]
    buffer_load_dwordx4 a[168:171], v37, s[8:11], s62 offen sc1
    v_mfma_f32_16x16x32_bf16 v[204:207], a[8:11], a[228:231], v[204:207]
    ds_read_b64_tr_b16 a[50:51], v48 offset:50176
    v_mfma_f32_16x16x32_bf16 v[204:207], a[12:15], a[244:247], v[204:207]
    ds_read_b64_tr_b16 a[52:53], v48 offset:57344
    v_mfma_f32_16x16x32_bf16 v[200:203], a[12:15], a[240:243], v[200:203]
    ds_read_b64_tr_b16 a[54:55], v48 offset:58368
    v_mfma_f32_16x16x32_bf16 v[200:203], a[8:11], a[224:227], v[200:203]
    v_mfma_f32_16x16x32_bf16 v[208:211], a[16:19], a[224:227], v[208:211]
    ds_read_b64_tr_b16 a[56:57], v49 offset:49152
    v_mfma_f32_16x16x32_bf16 v[208:211], a[20:23], a[240:243], v[208:211]
    buffer_load_dwordx4 a[172:175], v55, s[8:11], s62 offen sc1
    ds_read_b64_tr_b16 a[58:59], v49 offset:50176
    v_mfma_f32_16x16x32_bf16 v[212:215], a[20:23], a[244:247], v[212:215]
    ds_read_b64_tr_b16 a[60:61], v49 offset:57344
    v_mfma_f32_16x16x32_bf16 v[212:215], a[16:19], a[228:231], v[212:215]
    v_mfma_f32_16x16x32_bf16 a[80:83], a[16:19], a[232:235], a[80:83]
    ds_read_b64_tr_b16 a[62:63], v49 offset:58368
    v_mfma_f32_16x16x32_bf16 a[80:83], a[20:23], a[248:251], a[80:83]
    s_add_u32 s62, s62, 0x20000
    v_mfma_f32_16x16x32_bf16 a[84:87], a[20:23], a[252:255], a[84:87]
    s_add_u32 s52, s47, 528384
    v_mfma_f32_16x16x32_bf16 a[84:87], a[16:19], a[236:239], a[84:87]
    buffer_store_dwordx4 v[144:147], v1, s[48:51], s52 offen offset:0 sc1
    v_mfma_f32_16x16x32_bf16 a[92:95], a[24:27], a[236:239], a[92:95]
    v_mfma_f32_16x16x32_bf16 a[92:95], a[28:31], a[252:255], a[92:95]
    v_mfma_f32_16x16x32_bf16 a[88:91], a[28:31], a[248:251], a[88:91]
    v_mfma_f32_16x16x32_bf16 a[88:91], a[24:27], a[232:235], a[88:91]
    v_mfma_f32_16x16x32_bf16 v[220:223], a[24:27], a[228:231], v[220:223]
    v_mfma_f32_16x16x32_bf16 v[220:223], a[28:31], a[244:247], v[220:223]
    v_mfma_f32_16x16x32_bf16 v[216:219], a[28:31], a[240:243], v[216:219]
    v_mfma_f32_16x16x32_bf16 v[216:219], a[24:27], a[224:227], v[216:219]
    s_waitcnt vmcnt(9) lgkmcnt(0)
    s_barrier
    v_mfma_f32_16x16x32_bf16 v[224:227], a[32:35], a[224:227], v[224:227]
    v_mfma_f32_16x16x32_bf16 v[224:227], a[36:39], a[240:243], v[224:227]
    s_add_u32 m0, s60, 114688
    ds_read_b64_tr_b16 a[0:1], v42 offset:0
    ds_read_b64_tr_b16 a[2:3], v42 offset:1024
    v_mfma_f32_16x16x32_bf16 v[228:231], a[36:39], a[244:247], v[228:231]
    buffer_load_dwordx4 v38, s[12:15], s61 offen offset:0 lds
    v_mfma_f32_16x16x32_bf16 v[228:231], a[32:35], a[228:231], v[228:231]
    ds_read_b64_tr_b16 a[4:5], v42 offset:8192
    v_mfma_f32_16x16x32_bf16 a[96:99], a[32:35], a[232:235], a[96:99]
    buffer_load_dwordx4 v39, s[12:15], s61 offen offset:1024 lds
    ds_read_b64_tr_b16 a[6:7], v42 offset:9216
    v_mfma_f32_16x16x32_bf16 a[96:99], a[36:39], a[248:251], a[96:99]
    ds_read_b64_tr_b16 a[8:9], v43 offset:0
    v_mfma_f32_16x16x32_bf16 a[100:103], a[36:39], a[252:255], a[100:103]
    v_mfma_f32_16x16x32_bf16 a[100:103], a[32:35], a[236:239], a[100:103]
    buffer_load_dwordx4 v40, s[12:15], s61 offen offset:2048 lds
    ds_read_b64_tr_b16 a[10:11], v43 offset:1024
    v_mfma_f32_16x16x32_bf16 a[108:111], a[40:43], a[236:239], a[108:111]
    ds_read_b64_tr_b16 a[12:13], v43 offset:8192
    v_mfma_f32_16x16x32_bf16 a[108:111], a[44:47], a[252:255], a[108:111]
    ds_read_b64_tr_b16 a[14:15], v43 offset:9216
    v_mfma_f32_16x16x32_bf16 a[104:107], a[44:47], a[248:251], a[104:107]
    buffer_load_dwordx4 v41, s[12:15], s61 offen offset:3072 lds
    ds_read_b64_tr_b16 a[16:17], v44 offset:0
    v_mfma_f32_16x16x32_bf16 a[104:107], a[40:43], a[232:235], a[104:107]
    v_mfma_f32_16x16x32_bf16 v[236:239], a[40:43], a[228:231], v[236:239]
    s_add_u32 s61, s61, 0x80000
    ds_read_b64_tr_b16 a[18:19], v44 offset:1024
    v_mfma_f32_16x16x32_bf16 v[236:239], a[44:47], a[244:247], v[236:239]
    buffer_load_dwordx4 a[176:179], v36, s[8:11], s62 offen sc1
    ds_read_b64_tr_b16 a[20:21], v44 offset:8192
    v_mfma_f32_16x16x32_bf16 v[232:235], a[44:47], a[240:243], v[232:235]
    ds_read_b64_tr_b16 a[22:23], v44 offset:9216
    v_mfma_f32_16x16x32_bf16 v[232:235], a[40:43], a[224:227], v[232:235]
    buffer_load_dwordx4 a[180:183], v54, s[8:11], s62 offen sc1
    v_mfma_f32_16x16x32_bf16 v[240:243], a[48:51], a[224:227], v[240:243]
    ds_read_b64_tr_b16 a[24:25], v45 offset:0
    v_mfma_f32_16x16x32_bf16 v[240:243], a[52:55], a[240:243], v[240:243]
    ds_read_b64_tr_b16 a[26:27], v45 offset:1024
    v_mfma_f32_16x16x32_bf16 v[244:247], a[52:55], a[244:247], v[244:247]
    buffer_load_dwordx4 a[184:187], v37, s[8:11], s62 offen sc1
    ds_read_b64_tr_b16 a[28:29], v45 offset:8192
    v_mfma_f32_16x16x32_bf16 v[244:247], a[48:51], a[228:231], v[244:247]
    v_mfma_f32_16x16x32_bf16 a[112:115], a[48:51], a[232:235], a[112:115]
    ds_read_b64_tr_b16 a[30:31], v45 offset:9216
    v_mfma_f32_16x16x32_bf16 a[112:115], a[52:55], a[248:251], a[112:115]
    buffer_load_dwordx4 a[188:191], v55, s[8:11], s62 offen sc1
    v_mfma_f32_16x16x32_bf16 a[116:119], a[52:55], a[252:255], a[116:119]
    v_mfma_f32_16x16x32_bf16 a[116:119], a[48:51], a[236:239], a[116:119]
    s_add_u32 s62, s62, 0x20000
    v_mfma_f32_16x16x32_bf16 a[124:127], a[56:59], a[236:239], a[124:127]
    s_add_u32 s52, s47, 528384
    v_mfma_f32_16x16x32_bf16 a[124:127], a[60:63], a[252:255], a[124:127]
    buffer_store_dwordx4 v[148:151], v1, s[48:51], s52 offen offset:1024 sc1
    v_mfma_f32_16x16x32_bf16 a[120:123], a[60:63], a[248:251], a[120:123]
    v_mfma_f32_16x16x32_bf16 a[120:123], a[56:59], a[232:235], a[120:123]
    v_mfma_f32_16x16x32_bf16 v[252:255], a[56:59], a[228:231], v[252:255]
    s_cmp_eq_u32 s45, 0
    s_cbranch_scc1 k12_ool_64
k12_oolret_65:
    v_mfma_f32_16x16x32_bf16 v[252:255], a[60:63], a[244:247], v[252:255]
    v_mfma_f32_16x16x32_bf16 v[248:251], a[60:63], a[240:243], v[248:251]
    v_mfma_f32_16x16x32_bf16 v[248:251], a[56:59], a[224:227], v[248:251]
    s_waitcnt vmcnt(14) lgkmcnt(0)
    v_mfma_f32_16x16x32_bf16 v[192:195], a[0:3], a[128:131], v[192:195]
    v_mfma_f32_16x16x32_bf16 v[192:195], a[4:7], a[144:147], v[192:195]
    buffer_load_dwordx4 a[192:195], v36, s[8:11], s62 offen sc1
    ds_read_b64_tr_b16 a[32:33], v46 offset:0
    v_mfma_f32_16x16x32_bf16 v[196:199], a[4:7], a[148:151], v[196:199]
    ds_read_b64_tr_b16 a[34:35], v46 offset:1024
    v_mfma_f32_16x16x32_bf16 v[196:199], a[0:3], a[132:135], v[196:199]
    ds_read_b64_tr_b16 a[36:37], v46 offset:8192
    v_mfma_f32_16x16x32_bf16 a[64:67], a[0:3], a[136:139], a[64:67]
    ds_read_b64_tr_b16 a[38:39], v46 offset:9216
    v_mfma_f32_16x16x32_bf16 a[64:67], a[4:7], a[152:155], a[64:67]
    ds_read_b64_tr_b16 a[40:41], v47 offset:0
    v_mfma_f32_16x16x32_bf16 a[68:71], a[4:7], a[156:159], a[68:71]
    buffer_load_dwordx4 a[196:199], v54, s[8:11], s62 offen sc1
    v_mfma_f32_16x16x32_bf16 a[68:71], a[0:3], a[140:143], a[68:71]
    ds_read_b64_tr_b16 a[42:43], v47 offset:1024
    v_mfma_f32_16x16x32_bf16 a[76:79], a[8:11], a[140:143], a[76:79]
    ds_read_b64_tr_b16 a[44:45], v47 offset:8192
    v_mfma_f32_16x16x32_bf16 a[76:79], a[12:15], a[156:159], a[76:79]
    ds_read_b64_tr_b16 a[46:47], v47 offset:9216
    v_mfma_f32_16x16x32_bf16 a[72:75], a[12:15], a[152:155], a[72:75]
    ds_read_b64_tr_b16 a[48:49], v48 offset:0
    v_mfma_f32_16x16x32_bf16 a[72:75], a[8:11], a[136:139], a[72:75]
    buffer_load_dwordx4 a[200:203], v37, s[8:11], s62 offen sc1
    v_mfma_f32_16x16x32_bf16 v[204:207], a[8:11], a[132:135], v[204:207]
    ds_read_b64_tr_b16 a[50:51], v48 offset:1024
    v_mfma_f32_16x16x32_bf16 v[204:207], a[12:15], a[148:151], v[204:207]
    ds_read_b64_tr_b16 a[52:53], v48 offset:8192
    v_mfma_f32_16x16x32_bf16 v[200:203], a[12:15], a[144:147], v[200:203]
    ds_read_b64_tr_b16 a[54:55], v48 offset:9216
    v_mfma_f32_16x16x32_bf16 v[200:203], a[8:11], a[128:131], v[200:203]
    v_mfma_f32_16x16x32_bf16 v[208:211], a[16:19], a[128:131], v[208:211]
    ds_read_b64_tr_b16 a[56:57], v49 offset:0
    v_mfma_f32_16x16x32_bf16 v[208:211], a[20:23], a[144:147], v[208:211]
    buffer_load_dwordx4 a[204:207], v55, s[8:11], s62 offen sc1
    ds_read_b64_tr_b16 a[58:59], v49 offset:1024
    v_mfma_f32_16x16x32_bf16 v[212:215], a[20:23], a[148:151], v[212:215]
    ds_read_b64_tr_b16 a[60:61], v49 offset:8192
    v_mfma_f32_16x16x32_bf16 v[212:215], a[16:19], a[132:135], v[212:215]
    v_mfma_f32_16x16x32_bf16 a[80:83], a[16:19], a[136:139], a[80:83]
    ds_read_b64_tr_b16 a[62:63], v49 offset:9216
    v_mfma_f32_16x16x32_bf16 a[80:83], a[20:23], a[152:155], a[80:83]
    s_add_u32 s62, s62, 0x20000
    v_mfma_f32_16x16x32_bf16 a[84:87], a[20:23], a[156:159], a[84:87]
    s_add_u32 s52, s47, 528384
    v_mfma_f32_16x16x32_bf16 a[84:87], a[16:19], a[140:143], a[84:87]
    buffer_store_dwordx4 v[152:155], v1, s[48:51], s52 offen offset:2048 sc1
    v_mfma_f32_16x16x32_bf16 a[92:95], a[24:27], a[140:143], a[92:95]
    v_mfma_f32_16x16x32_bf16 a[92:95], a[28:31], a[156:159], a[92:95]
    v_mfma_f32_16x16x32_bf16 a[88:91], a[28:31], a[152:155], a[88:91]
    v_mfma_f32_16x16x32_bf16 a[88:91], a[24:27], a[136:139], a[88:91]
    v_mfma_f32_16x16x32_bf16 v[220:223], a[24:27], a[132:135], v[220:223]
    v_mfma_f32_16x16x32_bf16 v[220:223], a[28:31], a[148:151], v[220:223]
    v_mfma_f32_16x16x32_bf16 v[216:219], a[28:31], a[144:147], v[216:219]
    v_mfma_f32_16x16x32_bf16 v[216:219], a[24:27], a[128:131], v[216:219]
    s_waitcnt vmcnt(10) lgkmcnt(0)
    s_barrier
    v_mfma_f32_16x16x32_bf16 v[224:227], a[32:35], a[128:131], v[224:227]
    v_mfma_f32_16x16x32_bf16 v[224:227], a[36:39], a[144:147], v[224:227]
    s_add_u32 m0, s60, 131072
    ds_read_b64_tr_b16 a[0:1], v42 offset:16384
    ds_read_b64_tr_b16 a[2:3], v42 offset:17408
    v_mfma_f32_16x16x32_bf16 v[228:231], a[36:39], a[148:151], v[228:231]
    buffer_load_dwordx4 v38, s[12:15], s61 offen offset:0 lds
    v_mfma_f32_16x16x32_bf16 v[228:231], a[32:35], a[132:135], v[228:231]
    ds_read_b64_tr_b16 a[4:5], v42 offset:24576
    v_mfma_f32_16x16x32_bf16 a[96:99], a[32:35], a[136:139], a[96:99]
    buffer_load_dwordx4 v39, s[12:15], s61 offen offset:1024 lds
    ds_read_b64_tr_b16 a[6:7], v42 offset:25600
    v_mfma_f32_16x16x32_bf16 a[96:99], a[36:39], a[152:155], a[96:99]
    ds_read_b64_tr_b16 a[8:9], v43 offset:16384
    v_mfma_f32_16x16x32_bf16 a[100:103], a[36:39], a[156:159], a[100:103]
    v_mfma_f32_16x16x32_bf16 a[100:103], a[32:35], a[140:143], a[100:103]
    buffer_load_dwordx4 v40, s[12:15], s61 offen offset:2048 lds
    ds_read_b64_tr_b16 a[10:11], v43 offset:17408
    v_mfma_f32_16x16x32_bf16 a[108:111], a[40:43], a[140:143], a[108:111]
    ds_read_b64_tr_b16 a[12:13], v43 offset:24576
    v_mfma_f32_16x16x32_bf16 a[108:111], a[44:47], a[156:159], a[108:111]
    ds_read_b64_tr_b16 a[14:15], v43 offset:25600
    v_mfma_f32_16x16x32_bf16 a[104:107], a[44:47], a[152:155], a[104:107]
    buffer_load_dwordx4 v41, s[12:15], s61 offen offset:3072 lds
    ds_read_b64_tr_b16 a[16:17], v44 offset:16384
    v_mfma_f32_16x16x32_bf16 a[104:107], a[40:43], a[136:139], a[104:107]
    v_mfma_f32_16x16x32_bf16 v[236:239], a[40:43], a[132:135], v[236:239]
    s_add_u32 s61, s61, 0x80000
    ds_read_b64_tr_b16 a[18:19], v44 offset:17408
    v_mfma_f32_16x16x32_bf16 v[236:239], a[44:47], a[148:151], v[236:239]
    buffer_load_dwordx4 a[208:211], v36, s[8:11], s62 offen sc1
    ds_read_b64_tr_b16 a[20:21], v44 offset:24576
    v_mfma_f32_16x16x32_bf16 v[232:235], a[44:47], a[144:147], v[232:235]
    ds_read_b64_tr_b16 a[22:23], v44 offset:25600
    v_mfma_f32_16x16x32_bf16 v[232:235], a[40:43], a[128:131], v[232:235]
    buffer_load_dwordx4 a[212:215], v54, s[8:11], s62 offen sc1
    v_mfma_f32_16x16x32_bf16 v[240:243], a[48:51], a[128:131], v[240:243]
    ds_read_b64_tr_b16 a[24:25], v45 offset:16384
    v_mfma_f32_16x16x32_bf16 v[240:243], a[52:55], a[144:147], v[240:243]
    ds_read_b64_tr_b16 a[26:27], v45 offset:17408
    v_mfma_f32_16x16x32_bf16 v[244:247], a[52:55], a[148:151], v[244:247]
    buffer_load_dwordx4 a[216:219], v37, s[8:11], s62 offen sc1
    ds_read_b64_tr_b16 a[28:29], v45 offset:24576
    v_mfma_f32_16x16x32_bf16 v[244:247], a[48:51], a[132:135], v[244:247]
    v_mfma_f32_16x16x32_bf16 a[112:115], a[48:51], a[136:139], a[112:115]
    ds_read_b64_tr_b16 a[30:31], v45 offset:25600
    v_mfma_f32_16x16x32_bf16 a[112:115], a[52:55], a[152:155], a[112:115]
    buffer_load_dwordx4 a[220:223], v55, s[8:11], s62 offen sc1
    v_mfma_f32_16x16x32_bf16 a[116:119], a[52:55], a[156:159], a[116:119]
    v_mfma_f32_16x16x32_bf16 a[116:119], a[48:51], a[140:143], a[116:119]
    s_add_u32 s62, s62, 0x20000
    v_mfma_f32_16x16x32_bf16 a[124:127], a[56:59], a[140:143], a[124:127]
    s_add_u32 s52, s47, 528384
    v_mfma_f32_16x16x32_bf16 a[124:127], a[60:63], a[156:159], a[124:127]
    buffer_store_dwordx4 v[156:159], v1, s[48:51], s52 offen offset:3072 sc1
    v_mfma_f32_16x16x32_bf16 a[120:123], a[60:63], a[152:155], a[120:123]
    v_mfma_f32_16x16x32_bf16 a[120:123], a[56:59], a[136:139], a[120:123]
    v_mfma_f32_16x16x32_bf16 v[252:255], a[56:59], a[132:135], v[252:255]
    v_mfma_f32_16x16x32_bf16 v[252:255], a[60:63], a[148:151], v[252:255]
    v_mfma_f32_16x16x32_bf16 v[248:251], a[60:63], a[144:147], v[248:251]
    v_mfma_f32_16x16x32_bf16 v[248:251], a[56:59], a[128:131], v[248:251]
    s_waitcnt vmcnt(15) lgkmcnt(0)
    v_mfma_f32_16x16x32_bf16 v[192:195], a[0:3], a[160:163], v[192:195]
    v_mfma_f32_16x16x32_bf16 v[192:195], a[4:7], a[176:179], v[192:195]
    buffer_load_dwordx4 a[224:227], v36, s[8:11], s62 offen sc1
    ds_read_b64_tr_b16 a[32:33], v46 offset:16384
    v_mfma_f32_16x16x32_bf16 v[196:199], a[4:7], a[180:183], v[196:199]
    ds_read_b64_tr_b16 a[34:35], v46 offset:17408
    v_mfma_f32_16x16x32_bf16 v[196:199], a[0:3], a[164:167], v[196:199]
    ds_read_b64_tr_b16 a[36:37], v46 offset:24576
    v_mfma_f32_16x16x32_bf16 a[64:67], a[0:3], a[168:171], a[64:67]
    ds_read_b64_tr_b16 a[38:39], v46 offset:25600
    v_mfma_f32_16x16x32_bf16 a[64:67], a[4:7], a[184:187], a[64:67]
    ds_read_b64_tr_b16 a[40:41], v47 offset:16384
    v_mfma_f32_16x16x32_bf16 a[68:71], a[4:7], a[188:191], a[68:71]
    buffer_load_dwordx4 a[228:231], v54, s[8:11], s62 offen sc1
    v_mfma_f32_16x16x32_bf16 a[68:71], a[0:3], a[172:175], a[68:71]
    ds_read_b64_tr_b16 a[42:43], v47 offset:17408
    v_mfma_f32_16x16x32_bf16 a[76:79], a[8:11], a[172:175], a[76:79]
    ds_read_b64_tr_b16 a[44:45], v47 offset:24576
    v_mfma_f32_16x16x32_bf16 a[76:79], a[12:15], a[188:191], a[76:79]
    ds_read_b64_tr_b16 a[46:47], v47 offset:25600
    v_mfma_f32_16x16x32_bf16 a[72:75], a[12:15], a[184:187], a[72:75]
    ds_read_b64_tr_b16 a[48:49], v48 offset:16384
    v_mfma_f32_16x16x32_bf16 a[72:75], a[8:11], a[168:171], a[72:75]
    buffer_load_dwordx4 a[232:235], v37, s[8:11], s62 offen sc1
    v_mfma_f32_16x16x32_bf16 v[204:207], a[8:11], a[164:167], v[204:207]
    ds_read_b64_tr_b16 a[50:51], v48 offset:17408
    v_mfma_f32_16x16x32_bf16 v[204:207], a[12:15], a[180:183], v[204:207]
    ds_read_b64_tr_b16 a[52:53], v48 offset:24576
    v_mfma_f32_16x16x32_bf16 v[200:203], a[12:15], a[176:179], v[200:203]
    ds_read_b64_tr_b16 a[54:55], v48 offset:25600
    v_mfma_f32_16x16x32_bf16 v[200:203], a[8:11], a[160:163], v[200:203]
    v_mfma_f32_16x16x32_bf16 v[208:211], a[16:19], a[160:163], v[208:211]
    ds_read_b64_tr_b16 a[56:57], v49 offset:16384
    v_mfma_f32_16x16x32_bf16 v[208:211], a[20:23], a[176:179], v[208:211]
    buffer_load_dwordx4 a[236:239], v55, s[8:11], s62 offen sc1
    ds_read_b64_tr_b16 a[58:59], v49 offset:17408
    v_mfma_f32_16x16x32_bf16 v[212:215], a[20:23], a[180:183], v[212:215]
    ds_read_b64_tr_b16 a[60:61], v49 offset:24576
    v_mfma_f32_16x16x32_bf16 v[212:215], a[16:19], a[164:167], v[212:215]
    v_mfma_f32_16x16x32_bf16 a[80:83], a[16:19], a[168:171], a[80:83]
    ds_read_b64_tr_b16 a[62:63], v49 offset:25600
    v_mfma_f32_16x16x32_bf16 a[80:83], a[20:23], a[184:187], a[80:83]
    s_add_u32 s62, s62, 0x20000
    v_mfma_f32_16x16x32_bf16 a[84:87], a[20:23], a[188:191], a[84:87]
    s_add_u32 s52, s47, 532480
    v_mfma_f32_16x16x32_bf16 a[84:87], a[16:19], a[172:175], a[84:87]
    buffer_store_dwordx4 v[168:171], v1, s[48:51], s52 offen offset:2048 sc1
    v_mfma_f32_16x16x32_bf16 a[92:95], a[24:27], a[172:175], a[92:95]
    v_mfma_f32_16x16x32_bf16 a[92:95], a[28:31], a[188:191], a[92:95]
    v_mfma_f32_16x16x32_bf16 a[88:91], a[28:31], a[184:187], a[88:91]
    v_mfma_f32_16x16x32_bf16 a[88:91], a[24:27], a[168:171], a[88:91]
    v_mfma_f32_16x16x32_bf16 v[220:223], a[24:27], a[164:167], v[220:223]
    v_mfma_f32_16x16x32_bf16 v[220:223], a[28:31], a[180:183], v[220:223]
    v_mfma_f32_16x16x32_bf16 v[216:219], a[28:31], a[176:179], v[216:219]
    v_mfma_f32_16x16x32_bf16 v[216:219], a[24:27], a[160:163], v[216:219]
    s_waitcnt vmcnt(10) lgkmcnt(0)
    s_barrier
    v_mfma_f32_16x16x32_bf16 v[224:227], a[32:35], a[160:163], v[224:227]
    s_cmp_eq_u32 s56, 0
    s_cbranch_scc1 k12_ool_66
k12_oolret_67:
    v_mfma_f32_16x16x32_bf16 v[224:227], a[36:39], a[176:179], v[224:227]
    s_add_u32 m0, s60, 147456
    ds_read_b64_tr_b16 a[0:1], v42 offset:32768
    ds_read_b64_tr_b16 a[2:3], v42 offset:33792
    v_mfma_f32_16x16x32_bf16 v[228:231], a[36:39], a[180:183], v[228:231]
    buffer_load_dwordx4 v38, s[12:15], s61 offen offset:0 lds
    v_mfma_f32_16x16x32_bf16 v[228:231], a[32:35], a[164:167], v[228:231]
    ds_read_b64_tr_b16 a[4:5], v42 offset:40960
    v_mfma_f32_16x16x32_bf16 a[96:99], a[32:35], a[168:171], a[96:99]
    buffer_load_dwordx4 v39, s[12:15], s61 offen offset:1024 lds
    ds_read_b64_tr_b16 a[6:7], v42 offset:41984
    v_mfma_f32_16x16x32_bf16 a[96:99], a[36:39], a[184:187], a[96:99]
    ds_read_b64_tr_b16 a[8:9], v43 offset:32768
    v_mfma_f32_16x16x32_bf16 a[100:103], a[36:39], a[188:191], a[100:103]
    v_mfma_f32_16x16x32_bf16 a[100:103], a[32:35], a[172:175], a[100:103]
    buffer_load_dwordx4 v40, s[12:15], s61 offen offset:2048 lds
    ds_read_b64_tr_b16 a[10:11], v43 offset:33792
    v_mfma_f32_16x16x32_bf16 a[108:111], a[40:43], a[172:175], a[108:111]
    s_mov_b32 s32, s60
    ds_read_b64_tr_b16 a[12:13], v43 offset:40960
    v_mfma_f32_16x16x32_bf16 a[108:111], a[44:47], a[188:191], a[108:111]
    ds_read_b64_tr_b16 a[14:15], v43 offset:41984
    v_mfma_f32_16x16x32_bf16 a[104:107], a[44:47], a[184:187], a[104:107]
    s_mov_b32 s34, s60
    ds_read_b64_tr_b16 a[16:17], v44 offset:32768
    v_mfma_f32_16x16x32_bf16 a[104:107], a[40:43], a[168:171], a[104:107]
    buffer_load_dwordx4 v41, s[12:15], s61 offen offset:3072 lds
    v_mfma_f32_16x16x32_bf16 v[236:239], a[40:43], a[164:167], v[236:239]
    ds_read_b64_tr_b16 a[18:19], v44 offset:33792
    v_mfma_f32_16x16x32_bf16 v[236:239], a[44:47], a[180:183], v[236:239]
    s_mov_b32 s33, s60
    ds_read_b64_tr_b16 a[20:21], v44 offset:40960
    v_mfma_f32_16x16x32_bf16 v[232:235], a[44:47], a[176:179], v[232:235]
    s_add_u32 s61, s61, 0x80000
    buffer_load_dwordx4 a[240:243], v36, s[8:11], s62 offen sc1
    ds_read_b64_tr_b16 a[22:23], v44 offset:41984
    v_mfma_f32_16x16x32_bf16 v[232:235], a[40:43], a[160:163], v[232:235]
    v_mfma_f32_16x16x32_bf16 v[240:243], a[48:51], a[160:163], v[240:243]
    s_add_u32 s35, s60, 0x10000
    ds_read_b64_tr_b16 a[24:25], v45 offset:32768
    v_mfma_f32_16x16x32_bf16 v[240:243], a[52:55], a[176:179], v[240:243]
    buffer_load_dwordx4 a[244:247], v54, s[8:11], s62 offen sc1
    ds_read_b64_tr_b16 a[26:27], v45 offset:33792
    v_mfma_f32_16x16x32_bf16 v[244:247], a[52:55], a[180:183], v[244:247]
    ds_read_b64_tr_b16 a[28:29], v45 offset:40960
    v_mfma_f32_16x16x32_bf16 v[244:247], a[48:51], a[164:167], v[244:247]
    v_mfma_f32_16x16x32_bf16 a[112:115], a[48:51], a[168:171], a[112:115]
    buffer_load_dwordx4 a[248:251], v37, s[8:11], s62 offen sc1
    ds_read_b64_tr_b16 a[30:31], v45 offset:41984
    v_mfma_f32_16x16x32_bf16 a[112:115], a[52:55], a[184:187], a[112:115]
    v_mfma_f32_16x16x32_bf16 a[116:119], a[52:55], a[188:191], a[116:119]
    v_mfma_f32_16x16x32_bf16 a[116:119], a[48:51], a[172:175], a[116:119]
    v_mfma_f32_16x16x32_bf16 a[124:127], a[56:59], a[172:175], a[124:127]
    buffer_load_dwordx4 a[252:255], v55, s[8:11], s62 offen sc1
    v_mfma_f32_16x16x32_bf16 a[124:127], a[60:63], a[188:191], a[124:127]
    v_mfma_f32_16x16x32_bf16 a[120:123], a[60:63], a[184:187], a[120:123]
    s_add_u32 s62, s62, 0x20000
    v_mfma_f32_16x16x32_bf16 a[120:123], a[56:59], a[168:171], a[120:123]
    v_mfma_f32_16x16x32_bf16 v[252:255], a[56:59], a[164:167], v[252:255]
    v_mfma_f32_16x16x32_bf16 v[252:255], a[60:63], a[180:183], v[252:255]
    v_mfma_f32_16x16x32_bf16 v[248:251], a[60:63], a[176:179], v[248:251]
    v_mfma_f32_16x16x32_bf16 v[248:251], a[56:59], a[160:163], v[248:251]
    s_waitcnt vmcnt(14) lgkmcnt(0)
    v_mfma_f32_16x16x32_bf16 v[192:195], a[0:3], a[192:195], v[192:195]
    v_mfma_f32_16x16x32_bf16 v[192:195], a[4:7], a[208:211], v[192:195]
    buffer_load_dwordx4 a[128:131], v36, s[8:11], s62 offen sc1
    ds_read_b64_tr_b16 a[32:33], v46 offset:32768
    v_mfma_f32_16x16x32_bf16 v[196:199], a[4:7], a[212:215], v[196:199]
    ds_read_b64_tr_b16 a[34:35], v46 offset:33792
    v_mfma_f32_16x16x32_bf16 v[196:199], a[0:3], a[196:199], v[196:199]
    ds_read_b64_tr_b16 a[36:37], v46 offset:40960
    v_mfma_f32_16x16x32_bf16 a[64:67], a[0:3], a[200:203], a[64:67]
    ds_read_b64_tr_b16 a[38:39], v46 offset:41984
    v_mfma_f32_16x16x32_bf16 a[64:67], a[4:7], a[216:219], a[64:67]
    ds_read_b64_tr_b16 a[40:41], v47 offset:32768
    v_mfma_f32_16x16x32_bf16 a[68:71], a[4:7], a[220:223], a[68:71]
    buffer_load_dwordx4 a[132:135], v54, s[8:11], s62 offen sc1
    v_mfma_f32_16x16x32_bf16 a[68:71], a[0:3], a[204:207], a[68:71]
    ds_read_b64_tr_b16 a[42:43], v47 offset:33792
    v_mfma_f32_16x16x32_bf16 a[76:79], a[8:11], a[204:207], a[76:79]
    ds_read_b64_tr_b16 a[44:45], v47 offset:40960
    v_mfma_f32_16x16x32_bf16 a[76:79], a[12:15], a[220:223], a[76:79]
    ds_read_b64_tr_b16 a[46:47], v47 offset:41984
    v_mfma_f32_16x16x32_bf16 a[72:75], a[12:15], a[216:219], a[72:75]
    ds_read_b64_tr_b16 a[48:49], v48 offset:32768
    v_mfma_f32_16x16x32_bf16 a[72:75], a[8:11], a[200:203], a[72:75]
    buffer_load_dwordx4 a[136:139], v37, s[8:11], s62 offen sc1
    v_mfma_f32_16x16x32_bf16 v[204:207], a[8:11], a[196:199], v[204:207]
    ds_read_b64_tr_b16 a[50:51], v48 offset:33792
    v_mfma_f32_16x16x32_bf16 v[204:207], a[12:15], a[212:215], v[204:207]
    ds_read_b64_tr_b16 a[52:53], v48 offset:40960
    v_mfma_f32_16x16x32_bf16 v[200:203], a[12:15], a[208:211], v[200:203]
    ds_read_b64_tr_b16 a[54:55], v48 offset:41984
    v_mfma_f32_16x16x32_bf16 v[200:203], a[8:11], a[192:195], v[200:203]
    v_mfma_f32_16x16x32_bf16 v[208:211], a[16:19], a[192:195], v[208:211]
    ds_read_b64_tr_b16 a[56:57], v49 offset:32768
    v_mfma_f32_16x16x32_bf16 v[208:211], a[20:23], a[208:211], v[208:211]
    buffer_load_dwordx4 a[140:143], v55, s[8:11], s62 offen sc1
    ds_read_b64_tr_b16 a[58:59], v49 offset:33792
    v_mfma_f32_16x16x32_bf16 v[212:215], a[20:23], a[212:215], v[212:215]
    ds_read_b64_tr_b16 a[60:61], v49 offset:40960
    v_mfma_f32_16x16x32_bf16 v[212:215], a[16:19], a[196:199], v[212:215]
    v_mfma_f32_16x16x32_bf16 a[80:83], a[16:19], a[200:203], a[80:83]
    ds_read_b64_tr_b16 a[62:63], v49 offset:41984
    v_mfma_f32_16x16x32_bf16 a[80:83], a[20:23], a[216:219], a[80:83]
    s_add_u32 s62, s62, 0x20000
    v_mfma_f32_16x16x32_bf16 a[84:87], a[20:23], a[220:223], a[84:87]
    s_add_u32 s52, s47, 532480
    v_mfma_f32_16x16x32_bf16 a[84:87], a[16:19], a[204:207], a[84:87]
    buffer_store_dwordx4 v[172:175], v1, s[48:51], s52 offen offset:3072 sc1
    v_mfma_f32_16x16x32_bf16 a[92:95], a[24:27], a[204:207], a[92:95]
    v_mfma_f32_16x16x32_bf16 a[92:95], a[28:31], a[220:223], a[92:95]
    v_mfma_f32_16x16x32_bf16 a[88:91], a[28:31], a[216:219], a[88:91]
    v_mfma_f32_16x16x32_bf16 a[88:91], a[24:27], a[200:203], a[88:91]
    v_mfma_f32_16x16x32_bf16 v[220:223], a[24:27], a[196:199], v[220:223]
    v_add_co_u32 v2, vcc, 0x4000, v2
    s_nop 1
    v_addc_co_u32 v3, vcc, 0, v3, vcc
    global_load_dword v51, v[2:3], off
    v_mfma_f32_16x16x32_bf16 v[220:223], a[28:31], a[212:215], v[220:223]
    v_mfma_f32_16x16x32_bf16 v[216:219], a[28:31], a[208:211], v[216:219]
    v_mfma_f32_16x16x32_bf16 v[216:219], a[24:27], a[192:195], v[216:219]
    s_waitcnt vmcnt(9) lgkmcnt(0)
    s_barrier
    v_mfma_f32_16x16x32_bf16 v[224:227], a[32:35], a[192:195], v[224:227]
    v_mfma_f32_16x16x32_bf16 v[224:227], a[36:39], a[208:211], v[224:227]
    s_add_u32 m0, s60, 98304
    ds_read_b64_tr_b16 a[0:1], v42 offset:49152
    ds_read_b64_tr_b16 a[2:3], v42 offset:50176
    v_mfma_f32_16x16x32_bf16 v[228:231], a[36:39], a[212:215], v[228:231]
    buffer_load_dwordx4 v38, s[12:15], s61 offen offset:0 lds
    v_mfma_f32_16x16x32_bf16 v[228:231], a[32:35], a[196:199], v[228:231]
    ds_read_b64_tr_b16 a[4:5], v42 offset:57344
    v_mfma_f32_16x16x32_bf16 a[96:99], a[32:35], a[200:203], a[96:99]
    buffer_load_dwordx4 v39, s[12:15], s61 offen offset:1024 lds
    ds_read_b64_tr_b16 a[6:7], v42 offset:58368
    v_mfma_f32_16x16x32_bf16 a[96:99], a[36:39], a[216:219], a[96:99]
    ds_read_b64_tr_b16 a[8:9], v43 offset:49152
    v_mfma_f32_16x16x32_bf16 a[100:103], a[36:39], a[220:223], a[100:103]
    v_mfma_f32_16x16x32_bf16 a[100:103], a[32:35], a[204:207], a[100:103]
    buffer_load_dwordx4 v40, s[12:15], s61 offen offset:2048 lds
    ds_read_b64_tr_b16 a[10:11], v43 offset:50176
    v_mfma_f32_16x16x32_bf16 a[108:111], a[40:43], a[204:207], a[108:111]
    ds_read_b64_tr_b16 a[12:13], v43 offset:57344
    v_mfma_f32_16x16x32_bf16 a[108:111], a[44:47], a[220:223], a[108:111]
    ds_read_b64_tr_b16 a[14:15], v43 offset:58368
    v_mfma_f32_16x16x32_bf16 a[104:107], a[44:47], a[216:219], a[104:107]
    buffer_load_dwordx4 v41, s[12:15], s61 offen offset:3072 lds
    ds_read_b64_tr_b16 a[16:17], v44 offset:49152
    v_mfma_f32_16x16x32_bf16 a[104:107], a[40:43], a[200:203], a[104:107]
    v_mfma_f32_16x16x32_bf16 v[236:239], a[40:43], a[196:199], v[236:239]
    s_add_u32 s61, s61, 0x80000
    ds_read_b64_tr_b16 a[18:19], v44 offset:50176
    v_mfma_f32_16x16x32_bf16 v[236:239], a[44:47], a[212:215], v[236:239]
    buffer_load_dwordx4 a[144:147], v36, s[8:11], s62 offen sc1
    ds_read_b64_tr_b16 a[20:21], v44 offset:57344
    v_mfma_f32_16x16x32_bf16 v[232:235], a[44:47], a[208:211], v[232:235]
    ds_read_b64_tr_b16 a[22:23], v44 offset:58368
    v_mfma_f32_16x16x32_bf16 v[232:235], a[40:43], a[192:195], v[232:235]
    buffer_load_dwordx4 a[148:151], v54, s[8:11], s62 offen sc1
    v_mfma_f32_16x16x32_bf16 v[240:243], a[48:51], a[192:195], v[240:243]
    ds_read_b64_tr_b16 a[24:25], v45 offset:49152
    v_mfma_f32_16x16x32_bf16 v[240:243], a[52:55], a[208:211], v[240:243]
    ds_read_b64_tr_b16 a[26:27], v45 offset:50176
    v_mfma_f32_16x16x32_bf16 v[244:247], a[52:55], a[212:215], v[244:247]
    buffer_load_dwordx4 a[152:155], v37, s[8:11], s62 offen sc1
    ds_read_b64_tr_b16 a[28:29], v45 offset:57344
    v_mfma_f32_16x16x32_bf16 v[244:247], a[48:51], a[196:199], v[244:247]
    v_mfma_f32_16x16x32_bf16 a[112:115], a[48:51], a[200:203], a[112:115]
    ds_read_b64_tr_b16 a[30:31], v45 offset:58368
    v_mfma_f32_16x16x32_bf16 a[112:115], a[52:55], a[216:219], a[112:115]
    buffer_load_dwordx4 a[156:159], v55, s[8:11], s62 offen sc1
    v_mfma_f32_16x16x32_bf16 a[116:119], a[52:55], a[220:223], a[116:119]
    v_mfma_f32_16x16x32_bf16 a[116:119], a[48:51], a[204:207], a[116:119]
    s_add_u32 s62, s62, 0x20000
    v_mfma_f32_16x16x32_bf16 a[124:127], a[56:59], a[204:207], a[124:127]
    s_add_u32 s52, s47, 536576
    v_mfma_f32_16x16x32_bf16 a[124:127], a[60:63], a[220:223], a[124:127]
    buffer_store_dwordx4 v[176:179], v1, s[48:51], s52 offen offset:0 sc1
    v_mfma_f32_16x16x32_bf16 a[120:123], a[60:63], a[216:219], a[120:123]
    v_mfma_f32_16x16x32_bf16 a[120:123], a[56:59], a[200:203], a[120:123]
    v_mfma_f32_16x16x32_bf16 v[252:255], a[56:59], a[196:199], v[252:255]
    v_mfma_f32_16x16x32_bf16 v[252:255], a[60:63], a[212:215], v[252:255]
    v_mfma_f32_16x16x32_bf16 v[248:251], a[60:63], a[208:211], v[248:251]
    v_mfma_f32_16x16x32_bf16 v[248:251], a[56:59], a[192:195], v[248:251]
    s_waitcnt vmcnt(14) lgkmcnt(0)
    v_mfma_f32_16x16x32_bf16 v[192:195], a[0:3], a[224:227], v[192:195]
    v_mfma_f32_16x16x32_bf16 v[192:195], a[4:7], a[240:243], v[192:195]
    buffer_load_dwordx4 a[160:163], v36, s[8:11], s62 offen sc1
    ds_read_b64_tr_b16 a[32:33], v46 offset:49152
    v_mfma_f32_16x16x32_bf16 v[196:199], a[4:7], a[244:247], v[196:199]
    ds_read_b64_tr_b16 a[34:35], v46 offset:50176
    v_mfma_f32_16x16x32_bf16 v[196:199], a[0:3], a[228:231], v[196:199]
    ds_read_b64_tr_b16 a[36:37], v46 offset:57344
    v_mfma_f32_16x16x32_bf16 a[64:67], a[0:3], a[232:235], a[64:67]
    ds_read_b64_tr_b16 a[38:39], v46 offset:58368
    v_mfma_f32_16x16x32_bf16 a[64:67], a[4:7], a[248:251], a[64:67]
    ds_read_b64_tr_b16 a[40:41], v47 offset:49152
    v_mfma_f32_16x16x32_bf16 a[68:71], a[4:7], a[252:255], a[68:71]
    buffer_load_dwordx4 a[164:167], v54, s[8:11], s62 offen sc1
    v_mfma_f32_16x16x32_bf16 a[68:71], a[0:3], a[236:239], a[68:71]
    ds_read_b64_tr_b16 a[42:43], v47 offset:50176
    v_mfma_f32_16x16x32_bf16 a[76:79], a[8:11], a[236:239], a[76:79]
    ds_read_b64_tr_b16 a[44:45], v47 offset:57344
    v_mfma_f32_16x16x32_bf16 a[76:79], a[12:15], a[252:255], a[76:79]
    ds_read_b64_tr_b16 a[46:47], v47 offset:58368
    v_mfma_f32_16x16x32_bf16 a[72:75], a[12:15], a[248:251], a[72:75]
    ds_read_b64_tr_b16 a[48:49], v48 offset:49152
    v_mfma_f32_16x16x32_bf16 a[72:75], a[8:11], a[232:235], a[72:75]
    buffer_load_dwordx4 a[168:171], v37, s[8:11], s62 offen sc1
    v_mfma_f32_16x16x32_bf16 v[204:207], a[8:11], a[228:231], v[204:207]
    ds_read_b64_tr_b16 a[50:51], v48 offset:50176
    v_mfma_f32_16x16x32_bf16 v[204:207], a[12:15], a[244:247], v[204:207]
    ds_read_b64_tr_b16 a[52:53], v48 offset:57344
    v_mfma_f32_16x16x32_bf16 v[200:203], a[12:15], a[240:243], v[200:203]
    ds_read_b64_tr_b16 a[54:55], v48 offset:58368
    v_mfma_f32_16x16x32_bf16 v[200:203], a[8:11], a[224:227], v[200:203]
    v_mfma_f32_16x16x32_bf16 v[208:211], a[16:19], a[224:227], v[208:211]
    ds_read_b64_tr_b16 a[56:57], v49 offset:49152
    v_mfma_f32_16x16x32_bf16 v[208:211], a[20:23], a[240:243], v[208:211]
    buffer_load_dwordx4 a[172:175], v55, s[8:11], s62 offen sc1
    ds_read_b64_tr_b16 a[58:59], v49 offset:50176
    v_mfma_f32_16x16x32_bf16 v[212:215], a[20:23], a[244:247], v[212:215]
    ds_read_b64_tr_b16 a[60:61], v49 offset:57344
    v_mfma_f32_16x16x32_bf16 v[212:215], a[16:19], a[228:231], v[212:215]
    v_mfma_f32_16x16x32_bf16 a[80:83], a[16:19], a[232:235], a[80:83]
    ds_read_b64_tr_b16 a[62:63], v49 offset:58368
    v_mfma_f32_16x16x32_bf16 a[80:83], a[20:23], a[248:251], a[80:83]
    s_add_u32 s62, s62, 0x20000
    v_mfma_f32_16x16x32_bf16 a[84:87], a[20:23], a[252:255], a[84:87]
    s_add_u32 s52, s47, 536576
    v_mfma_f32_16x16x32_bf16 a[84:87], a[16:19], a[236:239], a[84:87]
    buffer_store_dwordx4 v[180:183], v1, s[48:51], s52 offen offset:1024 sc1
    v_mfma_f32_16x16x32_bf16 a[92:95], a[24:27], a[236:239], a[92:95]
    v_mfma_f32_16x16x32_bf16 a[92:95], a[28:31], a[252:255], a[92:95]
    v_mfma_f32_16x16x32_bf16 a[88:91], a[28:31], a[248:251], a[88:91]
    v_mfma_f32_16x16x32_bf16 a[88:91], a[24:27], a[232:235], a[88:91]
    v_mfma_f32_16x16x32_bf16 v[220:223], a[24:27], a[228:231], v[220:223]
    v_mfma_f32_16x16x32_bf16 v[220:223], a[28:31], a[244:247], v[220:223]
    v_mfma_f32_16x16x32_bf16 v[216:219], a[28:31], a[240:243], v[216:219]
    v_mfma_f32_16x16x32_bf16 v[216:219], a[24:27], a[224:227], v[216:219]
    s_waitcnt vmcnt(10) lgkmcnt(0)
    s_barrier
    v_mfma_f32_16x16x32_bf16 v[224:227], a[32:35], a[224:227], v[224:227]
    s_cmp_eq_u32 s30, 0
    s_cbranch_scc1 k12_ool_68
k12_oolret_69:
    v_mfma_f32_16x16x32_bf16 v[224:227], a[36:39], a[240:243], v[224:227]
    s_add_u32 m0, s60, 114688
    ds_read_b64_tr_b16 a[0:1], v42 offset:0
    ds_read_b64_tr_b16 a[2:3], v42 offset:1024
    v_mfma_f32_16x16x32_bf16 v[228:231], a[36:39], a[244:247], v[228:231]
    buffer_load_dwordx4 v38, s[12:15], s61 offen offset:0 lds
    v_mfma_f32_16x16x32_bf16 v[228:231], a[32:35], a[228:231], v[228:231]
    ds_read_b64_tr_b16 a[4:5], v42 offset:8192
    v_mfma_f32_16x16x32_bf16 a[96:99], a[32:35], a[232:235], a[96:99]
    buffer_load_dwordx4 v39, s[12:15], s61 offen offset:1024 lds
    ds_read_b64_tr_b16 a[6:7], v42 offset:9216
    v_mfma_f32_16x16x32_bf16 a[96:99], a[36:39], a[248:251], a[96:99]
    ds_read_b64_tr_b16 a[8:9], v43 offset:0
    v_mfma_f32_16x16x32_bf16 a[100:103], a[36:39], a[252:255], a[100:103]
    v_mfma_f32_16x16x32_bf16 a[100:103], a[32:35], a[236:239], a[100:103]
    buffer_load_dwordx4 v40, s[12:15], s61 offen offset:2048 lds
    ds_read_b64_tr_b16 a[10:11], v43 offset:1024
    v_mfma_f32_16x16x32_bf16 a[108:111], a[40:43], a[236:239], a[108:111]
    ds_read_b64_tr_b16 a[12:13], v43 offset:8192
    v_mfma_f32_16x16x32_bf16 a[108:111], a[44:47], a[252:255], a[108:111]
    ds_read_b64_tr_b16 a[14:15], v43 offset:9216
    v_mfma_f32_16x16x32_bf16 a[104:107], a[44:47], a[248:251], a[104:107]
    buffer_load_dwordx4 v41, s[12:15], s61 offen offset:3072 lds
    ds_read_b64_tr_b16 a[16:17], v44 offset:0
    v_mfma_f32_16x16x32_bf16 a[104:107], a[40:43], a[232:235], a[104:107]
    v_mfma_f32_16x16x32_bf16 v[236:239], a[40:43], a[228:231], v[236:239]
    s_add_u32 s61, s61, 0x80000
    ds_read_b64_tr_b16 a[18:19], v44 offset:1024
    v_mfma_f32_16x16x32_bf16 v[236:239], a[44:47], a[244:247], v[236:239]
    buffer_load_dwordx4 a[176:179], v36, s[8:11], s62 offen sc1
    ds_read_b64_tr_b16 a[20:21], v44 offset:8192
    v_mfma_f32_16x16x32_bf16 v[232:235], a[44:47], a[240:243], v[232:235]
    ds_read_b64_tr_b16 a[22:23], v44 offset:9216
    v_mfma_f32_16x16x32_bf16 v[232:235], a[40:43], a[224:227], v[232:235]
    buffer_load_dwordx4 a[180:183], v54, s[8:11], s62 offen sc1
    v_mfma_f32_16x16x32_bf16 v[240:243], a[48:51], a[224:227], v[240:243]
    ds_read_b64_tr_b16 a[24:25], v45 offset:0
    v_mfma_f32_16x16x32_bf16 v[240:243], a[52:55], a[240:243], v[240:243]
    ds_read_b64_tr_b16 a[26:27], v45 offset:1024
    v_mfma_f32_16x16x32_bf16 v[244:247], a[52:55], a[244:247], v[244:247]
    buffer_load_dwordx4 a[184:187], v37, s[8:11], s62 offen sc1
    ds_read_b64_tr_b16 a[28:29], v45 offset:8192
    v_mfma_f32_16x16x32_bf16 v[244:247], a[48:51], a[228:231], v[244:247]
    v_mfma_f32_16x16x32_bf16 a[112:115], a[48:51], a[232:235], a[112:115]
    ds_read_b64_tr_b16 a[30:31], v45 offset:9216
    v_mfma_f32_16x16x32_bf16 a[112:115], a[52:55], a[248:251], a[112:115]
    buffer_load_dwordx4 a[188:191], v55, s[8:11], s62 offen sc1
    v_mfma_f32_16x16x32_bf16 a[116:119], a[52:55], a[252:255], a[116:119]
    v_mfma_f32_16x16x32_bf16 a[116:119], a[48:51], a[236:239], a[116:119]
    s_add_u32 s62, s62, 0x20000
    v_mfma_f32_16x16x32_bf16 a[124:127], a[56:59], a[236:239], a[124:127]
    s_add_u32 s52, s47, 536576
    v_mfma_f32_16x16x32_bf16 a[124:127], a[60:63], a[252:255], a[124:127]
    buffer_store_dwordx4 v[184:187], v1, s[48:51], s52 offen offset:2048 sc1
    v_mfma_f32_16x16x32_bf16 a[120:123], a[60:63], a[248:251], a[120:123]
    v_mfma_f32_16x16x32_bf16 a[120:123], a[56:59], a[232:235], a[120:123]
    v_mfma_f32_16x16x32_bf16 v[252:255], a[56:59], a[228:231], v[252:255]
    v_mfma_f32_16x16x32_bf16 v[252:255], a[60:63], a[244:247], v[252:255]
    v_mfma_f32_16x16x32_bf16 v[248:251], a[60:63], a[240:243], v[248:251]
    v_mfma_f32_16x16x32_bf16 v[248:251], a[56:59], a[224:227], v[248:251]
    s_waitcnt vmcnt(15) lgkmcnt(0)
    v_mfma_f32_16x16x32_bf16 v[192:195], a[0:3], a[128:131], v[192:195]
    v_mfma_f32_16x16x32_bf16 v[192:195], a[4:7], a[144:147], v[192:195]
    s_add_u32 s52, s47, 536576
    ds_read_b64_tr_b16 a[32:33], v46 offset:0
    ds_read_b64_tr_b16 a[34:35], v46 offset:1024
    v_mfma_f32_16x16x32_bf16 v[196:199], a[4:7], a[148:151], v[196:199]
    buffer_store_dwordx4 v[188:191], v1, s[48:51], s52 offen offset:3072 sc1
    v_mfma_f32_16x16x32_bf16 v[196:199], a[0:3], a[132:135], v[196:199]
    ds_read_b64_tr_b16 a[36:37], v46 offset:8192
    v_mfma_f32_16x16x32_bf16 a[64:67], a[0:3], a[136:139], a[64:67]
    ds_read_b64_tr_b16 a[38:39], v46 offset:9216
    v_mfma_f32_16x16x32_bf16 a[64:67], a[4:7], a[152:155], a[64:67]
    ds_read_b64_tr_b16 a[40:41], v47 offset:0
    v_mfma_f32_16x16x32_bf16 a[68:71], a[4:7], a[156:159], a[68:71]
    v_mfma_f32_16x16x32_bf16 a[68:71], a[0:3], a[140:143], a[68:71]
    ds_read_b64_tr_b16 a[42:43], v47 offset:1024
    v_mfma_f32_16x16x32_bf16 a[76:79], a[8:11], a[140:143], a[76:79]
    ds_read_b64_tr_b16 a[44:45], v47 offset:8192
    v_mfma_f32_16x16x32_bf16 a[76:79], a[12:15], a[156:159], a[76:79]
    ds_read_b64_tr_b16 a[46:47], v47 offset:9216
    v_mfma_f32_16x16x32_bf16 a[72:75], a[12:15], a[152:155], a[72:75]
    ds_read_b64_tr_b16 a[48:49], v48 offset:0
    v_mfma_f32_16x16x32_bf16 a[72:75], a[8:11], a[136:139], a[72:75]
    v_mfma_f32_16x16x32_bf16 v[204:207], a[8:11], a[132:135], v[204:207]
    ds_read_b64_tr_b16 a[50:51], v48 offset:1024
    v_mfma_f32_16x16x32_bf16 v[204:207], a[12:15], a[148:151], v[204:207]
    ds_read_b64_tr_b16 a[52:53], v48 offset:8192
    v_mfma_f32_16x16x32_bf16 v[200:203], a[12:15], a[144:147], v[200:203]
    ds_read_b64_tr_b16 a[54:55], v48 offset:9216
    v_mfma_f32_16x16x32_bf16 v[200:203], a[8:11], a[128:131], v[200:203]
    v_mfma_f32_16x16x32_bf16 v[208:211], a[16:19], a[128:131], v[208:211]
    ds_read_b64_tr_b16 a[56:57], v49 offset:0
    v_mfma_f32_16x16x32_bf16 v[208:211], a[20:23], a[144:147], v[208:211]
    ds_read_b64_tr_b16 a[58:59], v49 offset:1024
    v_mfma_f32_16x16x32_bf16 v[212:215], a[20:23], a[148:151], v[212:215]
    ds_read_b64_tr_b16 a[60:61], v49 offset:8192
    v_mfma_f32_16x16x32_bf16 v[212:215], a[16:19], a[132:135], v[212:215]
    v_mfma_f32_16x16x32_bf16 a[80:83], a[16:19], a[136:139], a[80:83]
    ds_read_b64_tr_b16 a[62:63], v49 offset:9216
    v_mfma_f32_16x16x32_bf16 a[80:83], a[20:23], a[152:155], a[80:83]
    v_mfma_f32_16x16x32_bf16 a[84:87], a[20:23], a[156:159], a[84:87]
    v_mfma_f32_16x16x32_bf16 a[84:87], a[16:19], a[140:143], a[84:87]
    v_mfma_f32_16x16x32_bf16 a[92:95], a[24:27], a[140:143], a[92:95]
    v_mfma_f32_16x16x32_bf16 a[92:95], a[28:31], a[156:159], a[92:95]
    v_mfma_f32_16x16x32_bf16 a[88:91], a[28:31], a[152:155], a[88:91]
    v_mfma_f32_16x16x32_bf16 a[88:91], a[24:27], a[136:139], a[88:91]
    v_mfma_f32_16x16x32_bf16 v[220:223], a[24:27], a[132:135], v[220:223]
    s_cmp_eq_u32 s30, 0
    s_cbranch_scc1 k12_ool_72
k12_oolret_73:
    v_mfma_f32_16x16x32_bf16 v[220:223], a[28:31], a[148:151], v[220:223]
    v_mfma_f32_16x16x32_bf16 v[216:219], a[28:31], a[144:147], v[216:219]
    v_mfma_f32_16x16x32_bf16 v[216:219], a[24:27], a[128:131], v[216:219]
    s_waitcnt vmcnt(6) lgkmcnt(0)
    s_barrier
    v_mfma_f32_16x16x32_bf16 v[224:227], a[32:35], a[128:131], v[224:227]
    v_mfma_f32_16x16x32_bf16 v[224:227], a[36:39], a[144:147], v[224:227]
    s_mov_b32 m0, s34
    ds_read_b64_tr_b16 a[0:1], v42 offset:16384
    ds_read_b64_tr_b16 a[2:3], v42 offset:17408
    v_mfma_f32_16x16x32_bf16 v[228:231], a[36:39], a[148:151], v[228:231]
    buffer_load_dwordx4 v1, s[16:19], s32 offen offset:0 sc1 lds
    v_mfma_f32_16x16x32_bf16 v[228:231], a[32:35], a[132:135], v[228:231]
    ds_read_b64_tr_b16 a[4:5], v42 offset:24576
    v_mfma_f32_16x16x32_bf16 a[96:99], a[32:35], a[136:139], a[96:99]
    buffer_load_dwordx4 v1, s[16:19], s32 offen offset:1024 sc1 lds
    ds_read_b64_tr_b16 a[6:7], v42 offset:25600
    v_mfma_f32_16x16x32_bf16 a[96:99], a[36:39], a[152:155], a[96:99]
    ds_read_b64_tr_b16 a[8:9], v43 offset:16384
    v_mfma_f32_16x16x32_bf16 a[100:103], a[36:39], a[156:159], a[100:103]
    v_mfma_f32_16x16x32_bf16 a[100:103], a[32:35], a[140:143], a[100:103]
    buffer_load_dwordx4 v1, s[16:19], s32 offen offset:2048 sc1 lds
    ds_read_b64_tr_b16 a[10:11], v43 offset:17408
    v_mfma_f32_16x16x32_bf16 a[108:111], a[40:43], a[140:143], a[108:111]
    ds_read_b64_tr_b16 a[12:13], v43 offset:24576
    v_mfma_f32_16x16x32_bf16 a[108:111], a[44:47], a[156:159], a[108:111]
    ds_read_b64_tr_b16 a[14:15], v43 offset:25600
    v_mfma_f32_16x16x32_bf16 a[104:107], a[44:47], a[152:155], a[104:107]
    ds_read_b64_tr_b16 a[16:17], v44 offset:16384
    v_mfma_f32_16x16x32_bf16 a[104:107], a[40:43], a[136:139], a[104:107]
    buffer_load_dwordx4 v1, s[16:19], s32 offen offset:3072 sc1 lds
    v_mfma_f32_16x16x32_bf16 v[236:239], a[40:43], a[132:135], v[236:239]
    ds_read_b64_tr_b16 a[18:19], v44 offset:17408
    v_mfma_f32_16x16x32_bf16 v[236:239], a[44:47], a[148:151], v[236:239]
    s_add_u32 s32, s32, 0x80000
    ds_read_b64_tr_b16 a[20:21], v44 offset:24576
    v_mfma_f32_16x16x32_bf16 v[232:235], a[44:47], a[144:147], v[232:235]
    s_add_u32 s34, s34, 0x4000
    ds_read_b64_tr_b16 a[22:23], v44 offset:25600
    s_mov_b32 m0, s34
    v_mfma_f32_16x16x32_bf16 v[232:235], a[40:43], a[128:131], v[232:235]
    buffer_load_dwordx4 v1, s[16:19], s32 offen offset:0 sc1 lds
    v_mfma_f32_16x16x32_bf16 v[240:243], a[48:51], a[128:131], v[240:243]
    ds_read_b64_tr_b16 a[24:25], v45 offset:16384
    v_mfma_f32_16x16x32_bf16 v[240:243], a[52:55], a[144:147], v[240:243]
    buffer_load_dwordx4 v1, s[16:19], s32 offen offset:1024 sc1 lds
    ds_read_b64_tr_b16 a[26:27], v45 offset:17408
    v_mfma_f32_16x16x32_bf16 v[244:247], a[52:55], a[148:151], v[244:247]
    ds_read_b64_tr_b16 a[28:29], v45 offset:24576
    v_mfma_f32_16x16x32_bf16 v[244:247], a[48:51], a[132:135], v[244:247]
    v_mfma_f32_16x16x32_bf16 a[112:115], a[48:51], a[136:139], a[112:115]
    buffer_load_dwordx4 v1, s[16:19], s32 offen offset:2048 sc1 lds
    ds_read_b64_tr_b16 a[30:31], v45 offset:25600
    v_mfma_f32_16x16x32_bf16 a[112:115], a[52:55], a[152:155], a[112:115]
    v_mfma_f32_16x16x32_bf16 a[116:119], a[52:55], a[156:159], a[116:119]
    v_mfma_f32_16x16x32_bf16 a[116:119], a[48:51], a[140:143], a[116:119]
    v_mfma_f32_16x16x32_bf16 a[124:127], a[56:59], a[140:143], a[124:127]
    buffer_load_dwordx4 v1, s[16:19], s32 offen offset:3072 sc1 lds
    v_mfma_f32_16x16x32_bf16 a[124:127], a[60:63], a[156:159], a[124:127]
    v_mfma_f32_16x16x32_bf16 a[120:123], a[60:63], a[152:155], a[120:123]
    s_add_u32 s32, s32, 0x80000
    v_mfma_f32_16x16x32_bf16 a[120:123], a[56:59], a[136:139], a[120:123]
    s_add_u32 s34, s34, 0x4000
    v_mfma_f32_16x16x32_bf16 v[252:255], a[56:59], a[132:135], v[252:255]
    v_mfma_f32_16x16x32_bf16 v[252:255], a[60:63], a[148:151], v[252:255]
    v_mfma_f32_16x16x32_bf16 v[248:251], a[60:63], a[144:147], v[248:251]
    v_mfma_f32_16x16x32_bf16 v[248:251], a[56:59], a[128:131], v[248:251]
    s_waitcnt vmcnt(10) lgkmcnt(0)
    v_mfma_f32_16x16x32_bf16 v[192:195], a[0:3], a[160:163], v[192:195]
    v_mfma_f32_16x16x32_bf16 v[192:195], a[4:7], a[176:179], v[192:195]
    s_mov_b32 m0, s35
    ds_read_b64_tr_b16 a[32:33], v46 offset:16384
    ds_read_b64_tr_b16 a[34:35], v46 offset:17408
    v_mfma_f32_16x16x32_bf16 v[196:199], a[4:7], a[180:183], v[196:199]
    buffer_load_dwordx4 v1, s[20:23], s33 offen offset:0 sc1 lds
    v_mfma_f32_16x16x32_bf16 v[196:199], a[0:3], a[164:167], v[196:199]
    ds_read_b64_tr_b16 a[36:37], v46 offset:24576
    v_mfma_f32_16x16x32_bf16 a[64:67], a[0:3], a[168:171], a[64:67]
    buffer_load_dwordx4 v1, s[20:23], s33 offen offset:1024 sc1 lds
    ds_read_b64_tr_b16 a[38:39], v46 offset:25600
    v_mfma_f32_16x16x32_bf16 a[64:67], a[4:7], a[184:187], a[64:67]
    ds_read_b64_tr_b16 a[40:41], v47 offset:16384
    v_mfma_f32_16x16x32_bf16 a[68:71], a[4:7], a[188:191], a[68:71]
    v_mfma_f32_16x16x32_bf16 a[68:71], a[0:3], a[172:175], a[68:71]
    buffer_load_dwordx4 v1, s[20:23], s33 offen offset:2048 sc1 lds
    ds_read_b64_tr_b16 a[42:43], v47 offset:17408
    v_mfma_f32_16x16x32_bf16 a[76:79], a[8:11], a[172:175], a[76:79]
    ds_read_b64_tr_b16 a[44:45], v47 offset:24576
    v_mfma_f32_16x16x32_bf16 a[76:79], a[12:15], a[188:191], a[76:79]
    ds_read_b64_tr_b16 a[46:47], v47 offset:25600
    v_mfma_f32_16x16x32_bf16 a[72:75], a[12:15], a[184:187], a[72:75]
    ds_read_b64_tr_b16 a[48:49], v48 offset:16384
    v_mfma_f32_16x16x32_bf16 a[72:75], a[8:11], a[168:171], a[72:75]
    buffer_load_dwordx4 v1, s[20:23], s33 offen offset:3072 sc1 lds
    v_mfma_f32_16x16x32_bf16 v[204:207], a[8:11], a[164:167], v[204:207]
    ds_read_b64_tr_b16 a[50:51], v48 offset:17408
    v_mfma_f32_16x16x32_bf16 v[204:207], a[12:15], a[180:183], v[204:207]
    s_add_u32 s33, s33, 0x80000
    ds_read_b64_tr_b16 a[52:53], v48 offset:24576
    v_mfma_f32_16x16x32_bf16 v[200:203], a[12:15], a[176:179], v[200:203]
    s_add_u32 s35, s35, 0x4000
    ds_read_b64_tr_b16 a[54:55], v48 offset:25600
    s_mov_b32 m0, s34
    v_mfma_f32_16x16x32_bf16 v[200:203], a[8:11], a[160:163], v[200:203]
    buffer_load_dwordx4 v1, s[16:19], s32 offen offset:0 sc1 lds
    v_mfma_f32_16x16x32_bf16 v[208:211], a[16:19], a[160:163], v[208:211]
    ds_read_b64_tr_b16 a[56:57], v49 offset:16384
    v_mfma_f32_16x16x32_bf16 v[208:211], a[20:23], a[176:179], v[208:211]
    buffer_load_dwordx4 v1, s[16:19], s32 offen offset:1024 sc1 lds
    ds_read_b64_tr_b16 a[58:59], v49 offset:17408
    v_mfma_f32_16x16x32_bf16 v[212:215], a[20:23], a[180:183], v[212:215]
    ds_read_b64_tr_b16 a[60:61], v49 offset:24576
    v_mfma_f32_16x16x32_bf16 v[212:215], a[16:19], a[164:167], v[212:215]
    v_mfma_f32_16x16x32_bf16 a[80:83], a[16:19], a[168:171], a[80:83]
    buffer_load_dwordx4 v1, s[16:19], s32 offen offset:2048 sc1 lds
    ds_read_b64_tr_b16 a[62:63], v49 offset:25600
    v_mfma_f32_16x16x32_bf16 a[80:83], a[20:23], a[184:187], a[80:83]
    v_mfma_f32_16x16x32_bf16 a[84:87], a[20:23], a[188:191], a[84:87]
    v_mfma_f32_16x16x32_bf16 a[84:87], a[16:19], a[172:175], a[84:87]
    v_mfma_f32_16x16x32_bf16 a[92:95], a[24:27], a[172:175], a[92:95]
    buffer_load_dwordx4 v1, s[16:19], s32 offen offset:3072 sc1 lds
    v_mfma_f32_16x16x32_bf16 a[92:95], a[28:31], a[188:191], a[92:95]
    v_mfma_f32_16x16x32_bf16 a[88:91], a[28:31], a[184:187], a[88:91]
    s_add_u32 s32, s32, 0x80000
    v_mfma_f32_16x16x32_bf16 a[88:91], a[24:27], a[168:171], a[88:91]
    s_add_u32 s34, s34, 0x4000
    v_mfma_f32_16x16x32_bf16 v[220:223], a[24:27], a[164:167], v[220:223]
    v_mfma_f32_16x16x32_bf16 v[220:223], a[28:31], a[180:183], v[220:223]
    v_mfma_f32_16x16x32_bf16 v[216:219], a[28:31], a[176:179], v[216:219]
    v_mfma_f32_16x16x32_bf16 v[216:219], a[24:27], a[160:163], v[216:219]
    s_waitcnt vmcnt(63) lgkmcnt(0)
    s_barrier
    v_mfma_f32_16x16x32_bf16 v[224:227], a[32:35], a[160:163], v[224:227]
    v_mfma_f32_16x16x32_bf16 v[224:227], a[36:39], a[176:179], v[224:227]
    s_mov_b32 m0, s35
    v_mfma_f32_16x16x32_bf16 v[228:231], a[36:39], a[180:183], v[228:231]
    buffer_load_dwordx4 v1, s[20:23], s33 offen offset:0 sc1 lds
    v_mfma_f32_16x16x32_bf16 v[228:231], a[32:35], a[164:167], v[228:231]
    v_mfma_f32_16x16x32_bf16 a[96:99], a[32:35], a[168:171], a[96:99]
    v_mfma_f32_16x16x32_bf16 a[96:99], a[36:39], a[184:187], a[96:99]
    v_mfma_f32_16x16x32_bf16 a[100:103], a[36:39], a[188:191], a[100:103]
    v_mfma_f32_16x16x32_bf16 a[100:103], a[32:35], a[172:175], a[100:103]
    buffer_load_dwordx4 v1, s[20:23], s33 offen offset:1024 sc1 lds
    v_mfma_f32_16x16x32_bf16 a[108:111], a[40:43], a[172:175], a[108:111]
    v_mfma_f32_16x16x32_bf16 a[108:111], a[44:47], a[188:191], a[108:111]
    v_mfma_f32_16x16x32_bf16 a[104:107], a[44:47], a[184:187], a[104:107]
    v_mfma_f32_16x16x32_bf16 a[104:107], a[40:43], a[168:171], a[104:107]
    v_mfma_f32_16x16x32_bf16 v[236:239], a[40:43], a[164:167], v[236:239]
    v_mfma_f32_16x16x32_bf16 v[236:239], a[44:47], a[180:183], v[236:239]
    v_mfma_f32_16x16x32_bf16 v[232:235], a[44:47], a[176:179], v[232:235]
    buffer_load_dwordx4 v1, s[20:23], s33 offen offset:2048 sc1 lds
    v_mfma_f32_16x16x32_bf16 v[232:235], a[40:43], a[160:163], v[232:235]
    v_mfma_f32_16x16x32_bf16 v[240:243], a[48:51], a[160:163], v[240:243]
    v_mfma_f32_16x16x32_bf16 v[240:243], a[52:55], a[176:179], v[240:243]
    v_mfma_f32_16x16x32_bf16 v[244:247], a[52:55], a[180:183], v[244:247]
    v_mfma_f32_16x16x32_bf16 v[244:247], a[48:51], a[164:167], v[244:247]
    v_mfma_f32_16x16x32_bf16 a[112:115], a[48:51], a[168:171], a[112:115]
    buffer_load_dwordx4 v1, s[20:23], s33 offen offset:3072 sc1 lds
    v_mfma_f32_16x16x32_bf16 a[112:115], a[52:55], a[184:187], a[112:115]
    v_mfma_f32_16x16x32_bf16 a[116:119], a[52:55], a[188:191], a[116:119]
    v_mfma_f32_16x16x32_bf16 a[116:119], a[48:51], a[172:175], a[116:119]
    v_mfma_f32_16x16x32_bf16 a[124:127], a[56:59], a[172:175], a[124:127]
    v_mfma_f32_16x16x32_bf16 a[124:127], a[60:63], a[188:191], a[124:127]
    v_mfma_f32_16x16x32_bf16 a[120:123], a[60:63], a[184:187], a[120:123]
    s_add_u32 s33, s33, 0x80000
    v_mfma_f32_16x16x32_bf16 a[120:123], a[56:59], a[168:171], a[120:123]
    s_add_u32 s35, s35, 0x4000
    v_mfma_f32_16x16x32_bf16 v[252:255], a[56:59], a[164:167], v[252:255]
    v_mfma_f32_16x16x32_bf16 v[252:255], a[60:63], a[180:183], v[252:255]
    v_mfma_f32_16x16x32_bf16 v[248:251], a[60:63], a[176:179], v[248:251]
    v_mfma_f32_16x16x32_bf16 v[248:251], a[56:59], a[160:163], v[248:251]
    s_add_u32 s3, s54, 64
    s_add_u32 s5, s55, 64
    s_mov_b32 s63, s57
    s_load_dwordx2 s[44:45], s[0:1], 40
    s_load_dwordx2 s[46:47], s[0:1], 64
    s_load_dwordx4 s[48:51], s[0:1], 72
    s_mov_b32 s40, 0x3e0293ee
    s_mov_b32 s41, 0x3e0293ee
    s_mov_b32 m0, s34
    s_nop 0
    buffer_load_dwordx4 v1, s[16:19], s32 offen offset:0 sc1 lds
    buffer_load_dwordx4 v1, s[16:19], s32 offen offset:1024 sc1 lds
    buffer_load_dwordx4 v1, s[16:19], s32 offen offset:2048 sc1 lds
    buffer_load_dwordx4 v1, s[16:19], s32 offen offset:3072 sc1 lds
    s_mov_b32 m0, s35
    s_nop 0
    buffer_load_dwordx4 v1, s[20:23], s33 offen offset:0 sc1 lds
    buffer_load_dwordx4 v1, s[20:23], s33 offen offset:1024 sc1 lds
    buffer_load_dwordx4 v1, s[20:23], s33 offen offset:2048 sc1 lds
    buffer_load_dwordx4 v1, s[20:23], s33 offen offset:3072 sc1 lds
    s_add_u32 s32, s32, 0x80000
    s_add_u32 s33, s33, 0x80000
    s_add_u32 s34, s34, 0x4000
    s_and_b32 s34, s34, 0xffff
    s_add_u32 s35, s35, 0x4000
    s_and_b32 s35, s35, 0xffff
    s_or_b32 s35, s35, 0x10000
    v_mov_b32 v2, v1
    v_or_b32 v3, 0x10000, v1
    v_mov_b32 v56, v3
    s_mov_b32 s52, 0x4000
    s_mov_b32 s53, 0
    s_lshl_b32 s62, s28, 6
    s_mul_i32 s31, s29, s29
    s_add_u32 s62, s62, s31
    s_lshr_b32 s31, s30, 1
    s_lshl_b32 s4, s31, 23
    s_add_u32 s4, s4, 0x6000000
    s_add_u32 s8, s6, s4
    s_addc_u32 s9, s7, 0
    s_and_b32 s9, s9, 0xffff
    s_mov_b32 s10, 0
    s_mov_b32 s58, 0
    s_mov_b32 s14, 0x700000
    s_mov_b32 s59, 0x700000
    s_lshl_b32 s54, s62, 12
    s_waitcnt vmcnt(16) lgkmcnt(0)
    s_barrier
    s_cmp_eq_u32 s63, 0
    s_cbranch_scc1 k12_ool_74
k12_oolret_75:
    v_mov_b32 v59, 0
    ds_read_b128 a[128:131], v2 offset:0
    ds_read_b128 a[132:135], v2 offset:1024
    ds_read_b128 a[136:139], v2 offset:2048
    ds_read_b128 a[140:143], v2 offset:3072
    ds_read_b128 a[144:147], v2 offset:4096
    ds_read_b128 a[148:151], v2 offset:5120
    ds_read_b128 a[152:155], v2 offset:6144
    ds_read_b128 a[156:159], v2 offset:7168
    ds_read_b128 a[160:163], v2 offset:8192
    ds_read_b128 a[164:167], v2 offset:9216
    ds_read_b128 a[168:171], v2 offset:10240
    ds_read_b128 a[172:175], v2 offset:11264
    ds_read_b128 a[176:179], v2 offset:12288
    ds_read_b128 a[180:183], v2 offset:13312
    ds_read_b128 a[184:187], v2 offset:14336
    ds_read_b128 a[188:191], v2 offset:15360
    s_cmp_lt_u32 s30, 2
    s_cselect_b64 s[12:13], s[46:47], s[48:49]
    s_cselect_b64 s[60:61], s[44:45], s[50:51]
    s_cselect_b32 s55, 0x800000, s14
    s_and_b32 s13, s13, 0xffff
    v_accvgpr_read_b32 v128, a64
    v_accvgpr_read_b32 v129, a65
    v_accvgpr_read_b32 v130, a66
    v_accvgpr_read_b32 v131, a67
    v_pk_mul_f32 v[128:129], v[128:129], s[40:41]
    v_pk_mul_f32 v[130:131], v[130:131], s[40:41]
    v_cvt_pk_bf16_f32 v96, v128, v129
    v_cvt_pk_bf16_f32 v97, v130, v131
    v_accvgpr_read_b32 v132, a72
    v_accvgpr_read_b32 v133, a73
    v_accvgpr_read_b32 v134, a74
    v_accvgpr_read_b32 v135, a75
    v_pk_mul_f32 v[132:133], v[132:133], s[40:41]
    v_pk_mul_f32 v[134:135], v[134:135], s[40:41]
    v_cvt_pk_bf16_f32 v98, v132, v133
    v_cvt_pk_bf16_f32 v99, v134, v135
    v_accvgpr_read_b32 v136, a80
    v_accvgpr_read_b32 v137, a81
    v_accvgpr_read_b32 v138, a82
    v_accvgpr_read_b32 v139, a83
    v_pk_mul_f32 v[136:137], v[136:137], s[40:41]
    v_pk_mul_f32 v[138:139], v[138:139], s[40:41]
    v_cvt_pk_bf16_f32 v100, v136, v137
    v_cvt_pk_bf16_f32 v101, v138, v139
    v_accvgpr_read_b32 v140, a88
    v_accvgpr_read_b32 v141, a89
    v_accvgpr_read_b32 v142, a90
    v_accvgpr_read_b32 v143, a91
    v_pk_mul_f32 v[140:141], v[140:141], s[40:41]
    v_pk_mul_f32 v[142:143], v[142:143], s[40:41]
    v_cvt_pk_bf16_f32 v102, v140, v141
    v_cvt_pk_bf16_f32 v103, v142, v143
    v_accvgpr_read_b32 v128, a96
    v_accvgpr_read_b32 v129, a97
    v_accvgpr_read_b32 v130, a98
    v_accvgpr_read_b32 v131, a99
    v_pk_mul_f32 v[128:129], v[128:129], s[40:41]
    v_pk_mul_f32 v[130:131], v[130:131], s[40:41]
    v_cvt_pk_bf16_f32 v104, v128, v129
    v_cvt_pk_bf16_f32 v105, v130, v131
    v_accvgpr_read_b32 v132, a104
    v_accvgpr_read_b32 v133, a105
    v_accvgpr_read_b32 v134, a106
    v_accvgpr_read_b32 v135, a107
    v_pk_mul_f32 v[132:133], v[132:133], s[40:41]
    v_pk_mul_f32 v[134:135], v[134:135], s[40:41]
    v_cvt_pk_bf16_f32 v106, v132, v133
    v_cvt_pk_bf16_f32 v107, v134, v135
    v_accvgpr_read_b32 v136, a112
    v_accvgpr_read_b32 v137, a113
    v_accvgpr_read_b32 v138, a114
    v_accvgpr_read_b32 v139, a115
    v_pk_mul_f32 v[136:137], v[136:137], s[40:41]
    v_pk_mul_f32 v[138:139], v[138:139], s[40:41]
    v_cvt_pk_bf16_f32 v108, v136, v137
    v_cvt_pk_bf16_f32 v109, v138, v139
    v_accvgpr_read_b32 v140, a120
    v_accvgpr_read_b32 v141, a121
    v_accvgpr_read_b32 v142, a122
    v_accvgpr_read_b32 v143, a123
    v_pk_mul_f32 v[140:141], v[140:141], s[40:41]
    v_pk_mul_f32 v[142:143], v[142:143], s[40:41]
    v_cvt_pk_bf16_f32 v110, v140, v141
    v_cvt_pk_bf16_f32 v111, v142, v143
    v_accvgpr_read_b32 v128, a68
    v_accvgpr_read_b32 v129, a69
    v_accvgpr_read_b32 v130, a70
    v_accvgpr_read_b32 v131, a71
    v_pk_mul_f32 v[128:129], v[128:129], s[40:41]
    v_pk_mul_f32 v[130:131], v[130:131], s[40:41]
    v_cvt_pk_bf16_f32 v112, v128, v129
    v_cvt_pk_bf16_f32 v113, v130, v131
    v_accvgpr_read_b32 v132, a76
    v_accvgpr_read_b32 v133, a77
    v_accvgpr_read_b32 v134, a78
    v_accvgpr_read_b32 v135, a79
    v_pk_mul_f32 v[132:133], v[132:133], s[40:41]
    v_pk_mul_f32 v[134:135], v[134:135], s[40:41]
    v_cvt_pk_bf16_f32 v114, v132, v133
    v_cvt_pk_bf16_f32 v115, v134, v135
    v_accvgpr_read_b32 v136, a84
    v_accvgpr_read_b32 v137, a85
    v_accvgpr_read_b32 v138, a86
    v_accvgpr_read_b32 v139, a87
    v_pk_mul_f32 v[136:137], v[136:137], s[40:41]
    v_pk_mul_f32 v[138:139], v[138:139], s[40:41]
    v_cvt_pk_bf16_f32 v116, v136, v137
    v_cvt_pk_bf16_f32 v117, v138, v139
    v_accvgpr_read_b32 v140, a92
    v_accvgpr_read_b32 v141, a93
    v_accvgpr_read_b32 v142, a94
    v_accvgpr_read_b32 v143, a95
    v_pk_mul_f32 v[140:141], v[140:141], s[40:41]
    v_pk_mul_f32 v[142:143], v[142:143], s[40:41]
    v_cvt_pk_bf16_f32 v118, v140, v141
    v_cvt_pk_bf16_f32 v119, v142, v143
    v_accvgpr_read_b32 v128, a100
    v_accvgpr_read_b32 v129, a101
    v_accvgpr_read_b32 v130, a102
    v_accvgpr_read_b32 v131, a103
    v_pk_mul_f32 v[128:129], v[128:129], s[40:41]
    v_pk_mul_f32 v[130:131], v[130:131], s[40:41]
    v_cvt_pk_bf16_f32 v120, v128, v129
    v_cvt_pk_bf16_f32 v121, v130, v131
    v_accvgpr_read_b32 v132, a108
    v_accvgpr_read_b32 v133, a109
    v_accvgpr_read_b32 v134, a110
    v_accvgpr_read_b32 v135, a111
    v_pk_mul_f32 v[132:133], v[132:133], s[40:41]
    v_pk_mul_f32 v[134:135], v[134:135], s[40:41]
    v_cvt_pk_bf16_f32 v122, v132, v133
    v_cvt_pk_bf16_f32 v123, v134, v135
    v_accvgpr_read_b32 v136, a116
    v_accvgpr_read_b32 v137, a117
    v_accvgpr_read_b32 v138, a118
    v_accvgpr_read_b32 v139, a119
    v_pk_mul_f32 v[136:137], v[136:137], s[40:41]
    v_pk_mul_f32 v[138:139], v[138:139], s[40:41]
    v_cvt_pk_bf16_f32 v124, v136, v137
    v_cvt_pk_bf16_f32 v125, v138, v139
    v_accvgpr_read_b32 v140, a124
    v_accvgpr_read_b32 v141, a125
    v_accvgpr_read_b32 v142, a126
    v_accvgpr_read_b32 v143, a127
    v_pk_mul_f32 v[140:141], v[140:141], s[40:41]
    v_pk_mul_f32 v[142:143], v[142:143], s[40:41]
    v_cvt_pk_bf16_f32 v126, v140, v141
    v_cvt_pk_bf16_f32 v127, v142, v143
    v_pk_mul_f32 v[192:193], v[192:193], s[40:41]
    v_pk_mul_f32 v[194:195], v[194:195], s[40:41]
    v_cvt_pk_bf16_f32 v64, v192, v193
    v_cvt_pk_bf16_f32 v65, v194, v195
    v_pk_mul_f32 v[200:201], v[200:201], s[40:41]
    v_pk_mul_f32 v[202:203], v[202:203], s[40:41]
    v_cvt_pk_bf16_f32 v66, v200, v201
    v_cvt_pk_bf16_f32 v67, v202, v203
    v_pk_mul_f32 v[208:209], v[208:209], s[40:41]
    v_pk_mul_f32 v[210:211], v[210:211], s[40:41]
    v_cvt_pk_bf16_f32 v68, v208, v209
    v_cvt_pk_bf16_f32 v69, v210, v211
    v_pk_mul_f32 v[216:217], v[216:217], s[40:41]
    v_pk_mul_f32 v[218:219], v[218:219], s[40:41]
    v_cvt_pk_bf16_f32 v70, v216, v217
    v_cvt_pk_bf16_f32 v71, v218, v219
    v_pk_mul_f32 v[224:225], v[224:225], s[40:41]
    v_pk_mul_f32 v[226:227], v[226:227], s[40:41]
    v_cvt_pk_bf16_f32 v72, v224, v225
    v_cvt_pk_bf16_f32 v73, v226, v227
    v_pk_mul_f32 v[232:233], v[232:233], s[40:41]
    v_pk_mul_f32 v[234:235], v[234:235], s[40:41]
    v_cvt_pk_bf16_f32 v74, v232, v233
    v_cvt_pk_bf16_f32 v75, v234, v235
    v_pk_mul_f32 v[240:241], v[240:241], s[40:41]
    v_pk_mul_f32 v[242:243], v[242:243], s[40:41]
    v_cvt_pk_bf16_f32 v76, v240, v241
    v_cvt_pk_bf16_f32 v77, v242, v243
    v_pk_mul_f32 v[248:249], v[248:249], s[40:41]
    v_pk_mul_f32 v[250:251], v[250:251], s[40:41]
    v_cvt_pk_bf16_f32 v78, v248, v249
    v_cvt_pk_bf16_f32 v79, v250, v251
    v_pk_mul_f32 v[196:197], v[196:197], s[40:41]
    v_pk_mul_f32 v[198:199], v[198:199], s[40:41]
    v_cvt_pk_bf16_f32 v80, v196, v197
    v_cvt_pk_bf16_f32 v81, v198, v199
    v_pk_mul_f32 v[204:205], v[204:205], s[40:41]
    v_pk_mul_f32 v[206:207], v[206:207], s[40:41]
    v_cvt_pk_bf16_f32 v82, v204, v205
    v_cvt_pk_bf16_f32 v83, v206, v207
    v_pk_mul_f32 v[212:213], v[212:213], s[40:41]
    v_pk_mul_f32 v[214:215], v[214:215], s[40:41]
    v_cvt_pk_bf16_f32 v84, v212, v213
    v_cvt_pk_bf16_f32 v85, v214, v215
    v_pk_mul_f32 v[220:221], v[220:221], s[40:41]
    v_pk_mul_f32 v[222:223], v[222:223], s[40:41]
    v_cvt_pk_bf16_f32 v86, v220, v221
    v_cvt_pk_bf16_f32 v87, v222, v223
    v_pk_mul_f32 v[228:229], v[228:229], s[40:41]
    v_pk_mul_f32 v[230:231], v[230:231], s[40:41]
    v_cvt_pk_bf16_f32 v88, v228, v229
    v_cvt_pk_bf16_f32 v89, v230, v231
    v_pk_mul_f32 v[236:237], v[236:237], s[40:41]
    v_pk_mul_f32 v[238:239], v[238:239], s[40:41]
    v_cvt_pk_bf16_f32 v90, v236, v237
    v_cvt_pk_bf16_f32 v91, v238, v239
    v_pk_mul_f32 v[244:245], v[244:245], s[40:41]
    v_pk_mul_f32 v[246:247], v[246:247], s[40:41]
    v_cvt_pk_bf16_f32 v92, v244, v245
    v_cvt_pk_bf16_f32 v93, v246, v247
    v_pk_mul_f32 v[252:253], v[252:253], s[40:41]
    v_pk_mul_f32 v[254:255], v[254:255], s[40:41]
    v_cvt_pk_bf16_f32 v94, v252, v253
    v_cvt_pk_bf16_f32 v95, v254, v255
    v_add_u32 v2, 0x4000, v1
    v_mov_b32 v8, 0
    v_mov_b32 v232, 0
    v_mov_b32 v9, 0
    v_mov_b32 v233, 0
    v_mov_b32 v10, 0
    v_mov_b32 v234, 0
    v_mov_b32 v11, 0
    v_mov_b32 v235, 0
    s_mov_b32 s36, 0
    s_mov_b32 s37, 0x40004000
    v_mfma_f32_32x32x16_bf16 v[16:31], v[232:235], v[232:235], 0
    v_mfma_f32_32x32x16_bf16 v[32:47], v[232:235], v[232:235], 0
    v_and_b32 v6, 0xf0, v1
    v_cmp_eq_u32 vcc, 0, v6
    v_mov_b32 v6, 0x3f803f80
    v_lshrrev_b32 v229, 7, v1
    s_and_b32 s4, s30, 1
    s_lshl_b32 s31, s4, 11
    v_lshl_add_u32 v230, v1, 1, s31
    v_lshl_add_u32 v229, s4, 4, v229
    v_mul_u32_u24 v228, 7168, v229
    v_and_b32 v7, 0x70, v1
    v_add_u32 v228, v228, v7
    v_lshlrev_b32 v229, 5, v229
    v_and_b32 v57, 0x10, v1
    v_add_u32 v229, v229, v57
    v_lshrrev_b32 v7, 5, v7
    v_lshl_add_u32 v229, v7, 15, v229
    v_cndmask_b32 v60, 0, v6, vcc
    v_cndmask_b32 v61, 0, v6, vcc
    v_cndmask_b32 v62, 0, v6, vcc
    v_cndmask_b32 v63, 0, v6, vcc
    v_mov_b32 v12, 0
    v_mov_b32 v13, 0
    v_mov_b32 v14, 0
    v_mov_b32 v15, 0
    v_mov_b32 v48, 0
    v_mov_b32 v49, 0
    v_mov_b32 v50, 0
    v_mov_b32 v51, 0
    v_mov_b32 v248, 0
    v_mov_b32 v249, 0
    v_mov_b32 v250, 0
    v_mov_b32 v251, 0
    v_mov_b32 v252, 0
    v_mov_b32 v253, 0
    v_mov_b32 v254, 0
    v_mov_b32 v255, 0
    s_waitcnt lgkmcnt(0)
    s_cmp_ge_u32 s36, s42
    s_cbranch_scc1 k2_prep_76
k2_prepret_77:
    v_mfma_f32_16x16x32_bf16 v[128:131], a[128:131], v[64:67], v[16:19]
    v_mfma_f32_16x16x32_bf16 v[128:131], a[132:135], v[68:71], v[128:131]
    v_mfma_f32_16x16x32_bf16 v[128:131], a[136:139], v[72:75], v[128:131]
    v_mfma_f32_16x16x32_bf16 v[128:131], a[140:143], v[76:79], v[128:131]
    s_add_u32 s36, s36, 32
    v_mfma_f32_16x16x32_bf16 v[132:135], a[140:143], v[92:95], v[20:23]
    v_mfma_f32_16x16x32_bf16 v[132:135], a[136:139], v[88:91], v[132:135]
    v_mfma_f32_16x16x32_bf16 v[132:135], a[132:135], v[84:87], v[132:135]
    v_mfma_f32_16x16x32_bf16 v[132:135], a[128:131], v[80:83], v[132:135]
    v_mfma_f32_16x16x32_bf16 v[136:139], a[128:131], v[96:99], v[24:27]
    v_mfma_f32_16x16x32_bf16 v[136:139], a[132:135], v[100:103], v[136:139]
    v_mfma_f32_16x16x32_bf16 v[136:139], a[136:139], v[104:107], v[136:139]
    v_mfma_f32_16x16x32_bf16 v[136:139], a[140:143], v[108:111], v[136:139]
    v_mfma_f32_16x16x32_bf16 v[140:143], a[140:143], v[124:127], v[28:31]
    v_mfma_f32_16x16x32_bf16 v[140:143], a[136:139], v[120:123], v[140:143]
    v_mfma_f32_16x16x32_bf16 v[140:143], a[132:135], v[116:119], v[140:143]
    v_mfma_f32_16x16x32_bf16 v[140:143], a[128:131], v[112:115], v[140:143]
    v_mfma_f32_16x16x32_bf16 v[156:159], a[144:147], v[112:115], v[44:47]
    v_mfma_f32_16x16x32_bf16 v[156:159], a[148:151], v[116:119], v[156:159]
    v_mfma_f32_16x16x32_bf16 v[156:159], a[152:155], v[120:123], v[156:159]
    v_mfma_f32_16x16x32_bf16 v[156:159], a[156:159], v[124:127], v[156:159]
    v_mfma_f32_16x16x32_bf16 v[152:155], a[156:159], v[108:111], v[40:43]
    v_mfma_f32_16x16x32_bf16 v[152:155], a[152:155], v[104:107], v[152:155]
    v_mfma_f32_16x16x32_bf16 v[152:155], a[148:151], v[100:103], v[152:155]
    v_mfma_f32_16x16x32_bf16 v[152:155], a[144:147], v[96:99], v[152:155]
    v_mfma_f32_16x16x32_bf16 v[148:151], a[144:147], v[80:83], v[36:39]
    v_mfma_f32_16x16x32_bf16 v[148:151], a[148:151], v[84:87], v[148:151]
    v_mfma_f32_16x16x32_bf16 v[148:151], a[152:155], v[88:91], v[148:151]
    v_mfma_f32_16x16x32_bf16 v[148:151], a[156:159], v[92:95], v[148:151]
    v_mfma_f32_16x16x32_bf16 v[144:147], a[156:159], v[76:79], v[32:35]
    v_mfma_f32_16x16x32_bf16 v[144:147], a[152:155], v[72:75], v[144:147]
    v_mfma_f32_16x16x32_bf16 v[144:147], a[148:151], v[68:71], v[144:147]
    v_mfma_f32_16x16x32_bf16 v[144:147], a[144:147], v[64:67], v[144:147]
    v_mfma_f32_32x32x16_bf16 a[0:15], v[232:235], v[232:235], 0
    v_mfma_f32_32x32x16_bf16 a[16:31], v[232:235], v[232:235], 0
    v_mfma_f32_32x32x16_bf16 a[32:47], v[232:235], v[232:235], 0
    v_mfma_f32_32x32x16_bf16 a[48:63], v[232:235], v[232:235], 0
    v_mfma_f32_32x32x16_bf16 a[64:79], v[232:235], v[232:235], 0
    v_mfma_f32_32x32x16_bf16 a[80:95], v[232:235], v[232:235], 0
    v_mfma_f32_32x32x16_bf16 a[96:111], v[232:235], v[232:235], 0
    v_mfma_f32_32x32x16_bf16 a[112:127], v[232:235], v[232:235], 0
    v_max_f32 v52, v128, v129
    v_max3_f32 v52, v52, v130, v131
    v_max3_f32 v52, v52, v144, v145
    v_max3_f32 v52, v52, v146, v147
    v_max_f32 v53, v132, v133
    v_max3_f32 v53, v53, v134, v135
    v_max3_f32 v53, v53, v148, v149
    v_max3_f32 v53, v53, v150, v151
    v_max_f32 v54, v136, v137
    v_max3_f32 v54, v54, v138, v139
    v_max3_f32 v54, v54, v152, v153
    v_max3_f32 v54, v54, v154, v155
    v_max_f32 v55, v140, v141
    v_max3_f32 v55, v55, v142, v143
    v_max3_f32 v55, v55, v156, v157
    v_max3_f32 v55, v55, v158, v159
    v_mov_b32 v224, v52
    v_mov_b32 v225, v53
    v_mov_b32 v226, v54
    v_mov_b32 v227, v55
    s_nop 1
    v_permlane16_swap_b32 v52, v224
    v_permlane16_swap_b32 v53, v225
    v_permlane16_swap_b32 v54, v226
    v_permlane16_swap_b32 v55, v227
    s_nop 1
    v_max_f32 v52, v52, v224
    v_max_f32 v53, v53, v225
    v_max_f32 v54, v54, v226
    v_max_f32 v55, v55, v227
    v_mov_b32 v224, v52
    v_mov_b32 v225, v53
    v_mov_b32 v226, v54
    v_mov_b32 v227, v55
    s_nop 1
    v_permlane32_swap_b32 v52, v224
    v_permlane32_swap_b32 v53, v225
    v_permlane32_swap_b32 v54, v226
    v_permlane32_swap_b32 v55, v227
    s_nop 1
    v_max_f32 v52, v52, v224
    v_max_f32 v53, v53, v225
    v_max_f32 v54, v54, v226
    v_max_f32 v55, v55, v227
    v_add_f32 v52, 0x41400000, v52
    v_add_f32 v53, 0x41400000, v53
    v_add_f32 v54, 0x41400000, v54
    v_add_f32 v55, 0x41400000, v55
    v_sub_f32 v16, 0, v52
    v_sub_f32 v17, 0, v52
    v_sub_f32 v18, 0, v52
    v_sub_f32 v19, 0, v52
    v_sub_f32 v20, 0, v53
    v_sub_f32 v21, 0, v53
    v_sub_f32 v22, 0, v53
    v_sub_f32 v23, 0, v53
    v_sub_f32 v24, 0, v54
    v_sub_f32 v25, 0, v54
    v_sub_f32 v26, 0, v54
    v_sub_f32 v27, 0, v54
    v_sub_f32 v28, 0, v55
    v_sub_f32 v29, 0, v55
    v_sub_f32 v30, 0, v55
    v_sub_f32 v31, 0, v55
    v_sub_f32 v32, 0, v52
    v_sub_f32 v33, 0, v52
    v_sub_f32 v34, 0, v52
    v_sub_f32 v35, 0, v52
    v_sub_f32 v36, 0, v53
    v_sub_f32 v37, 0, v53
    v_sub_f32 v38, 0, v53
    v_sub_f32 v39, 0, v53
    v_sub_f32 v40, 0, v54
    v_sub_f32 v41, 0, v54
    v_sub_f32 v42, 0, v54
    v_sub_f32 v43, 0, v54
    v_sub_f32 v44, 0, v55
    v_sub_f32 v45, 0, v55
    v_sub_f32 v46, 0, v55
    v_sub_f32 v47, 0, v55
    v_sub_f32 v8, 0, v52
    v_sub_f32 v9, 0, v53
    v_sub_f32 v10, 0, v54
    v_sub_f32 v11, 0, v55
    s_cmp_ge_u32 s36, s42
    s_cbranch_scc1 k2_prep_84
k2_prepret_85:
    v_mfma_f32_16x16x32_bf16 v[160:163], a[160:163], v[64:67], v[16:19]
    v_sub_f32 v128, v128, v52
    v_sub_f32 v129, v129, v52
    v_sub_f32 v130, v130, v52
    v_mfma_f32_16x16x32_bf16 v[160:163], a[164:167], v[68:71], v[160:163]
    v_exp_f32 v232, v128
    v_sub_f32 v131, v131, v52
    v_mfma_f32_16x16x32_bf16 v[160:163], a[168:171], v[72:75], v[160:163]
    v_exp_f32 v233, v129
    v_sub_f32 v144, v144, v52
    v_mfma_f32_16x16x32_bf16 v[160:163], a[172:175], v[76:79], v[160:163]
    s_add_u32 s36, s36, 32
    s_cmp_eq_u32 s30, 0
    s_cbranch_scc1 k12_ool_78
k12_oolret_79:
    v_sub_f32 v145, v145, v52
    v_mfma_f32_16x16x32_bf16 v[164:167], a[172:175], v[92:95], v[20:23]
    v_exp_f32 v234, v130
    v_cvt_pk_bf16_f32 v192, v232, v233
    v_mfma_f32_16x16x32_bf16 v[164:167], a[168:171], v[88:91], v[164:167]
    v_exp_f32 v235, v131
    v_sub_f32 v146, v146, v52
    v_mfma_f32_16x16x32_bf16 v[164:167], a[164:167], v[84:87], v[164:167]
    v_exp_f32 v236, v144
    v_sub_f32 v147, v147, v52
    v_mfma_f32_16x16x32_bf16 v[164:167], a[160:163], v[80:83], v[164:167]
    v_cvt_pk_bf16_f32 v193, v234, v235
    v_exp_f32 v237, v145
    v_mfma_f32_16x16x32_bf16 v[168:171], a[160:163], v[96:99], v[24:27]
    v_exp_f32 v238, v146
    v_sub_f32 v132, v132, v53
    v_mfma_f32_16x16x32_bf16 v[168:171], a[164:167], v[100:103], v[168:171]
    v_sub_f32 v133, v133, v53
    v_cvt_pk_bf16_f32 v194, v236, v237
    v_or3_b32 v57, v192, v193, v194
    v_mfma_f32_16x16x32_bf16 v[168:171], a[168:171], v[104:107], v[168:171]
    v_exp_f32 v239, v147
    v_sub_f32 v134, v134, v53
    v_mfma_f32_16x16x32_bf16 v[168:171], a[172:175], v[108:111], v[168:171]
    v_exp_f32 v240, v132
    v_sub_f32 v135, v135, v53
    v_mfma_f32_16x16x32_bf16 v[172:175], a[172:175], v[124:127], v[28:31]
    v_cvt_pk_bf16_f32 v195, v238, v239
    v_exp_f32 v241, v133
    v_mfma_f32_16x16x32_bf16 v[172:175], a[168:171], v[120:123], v[172:175]
    v_exp_f32 v242, v134
    v_sub_f32 v148, v148, v53
    v_mfma_f32_16x16x32_bf16 v[172:175], a[164:167], v[116:119], v[172:175]
    v_sub_f32 v149, v149, v53
    v_cvt_pk_bf16_f32 v196, v240, v241
    v_exp_f32 v243, v135
    v_mfma_f32_16x16x32_bf16 v[172:175], a[160:163], v[112:115], v[172:175]
    v_or3_b32 v57, v57, v195, v196
    v_exp_f32 v244, v148
    v_mfma_f32_16x16x32_bf16 v[188:191], a[176:179], v[112:115], v[44:47]
    v_sub_f32 v150, v150, v53
    v_sub_f32 v151, v151, v53
    v_cvt_pk_bf16_f32 v197, v242, v243
    v_mfma_f32_16x16x32_bf16 v[188:191], a[180:183], v[116:119], v[188:191]
    v_exp_f32 v245, v149
    v_exp_f32 v246, v150
    v_mfma_f32_16x16x32_bf16 v[188:191], a[184:187], v[120:123], v[188:191]
    v_sub_f32 v136, v136, v54
    v_sub_f32 v137, v137, v54
    v_cvt_pk_bf16_f32 v198, v244, v245
    v_mfma_f32_16x16x32_bf16 v[188:191], a[188:191], v[124:127], v[188:191]
    v_exp_f32 v247, v151
    v_or3_b32 v57, v57, v197, v198
    v_mfma_f32_16x16x32_bf16 v[184:187], a[188:191], v[108:111], v[40:43]
    v_exp_f32 v232, v136
    v_sub_f32 v138, v138, v54
    v_mfma_f32_16x16x32_bf16 v[184:187], a[184:187], v[104:107], v[184:187]
    ds_read_b128 a[192:195], v3 offset:0
    v_sub_f32 v139, v139, v54
    v_cvt_pk_bf16_f32 v199, v246, v247
    v_mfma_f32_16x16x32_bf16 v[184:187], a[180:183], v[100:103], v[184:187]
    v_exp_f32 v233, v137
    v_exp_f32 v234, v138
    v_mfma_f32_16x16x32_bf16 v[184:187], a[176:179], v[96:99], v[184:187]
    v_sub_f32 v152, v152, v54
    v_sub_f32 v153, v153, v54
    v_cvt_pk_bf16_f32 v200, v232, v233
    v_mfma_f32_16x16x32_bf16 v[180:183], a[176:179], v[80:83], v[36:39]
    v_exp_f32 v235, v139
    v_or3_b32 v57, v57, v199, v200
    v_mfma_f32_16x16x32_bf16 v[180:183], a[180:183], v[84:87], v[180:183]
    v_exp_f32 v236, v152
    v_sub_f32 v154, v154, v54
    v_mfma_f32_16x16x32_bf16 v[180:183], a[184:187], v[88:91], v[180:183]
    v_sub_f32 v155, v155, v54
    v_cvt_pk_bf16_f32 v201, v234, v235
    v_exp_f32 v237, v153
    v_mfma_f32_16x16x32_bf16 v[180:183], a[188:191], v[92:95], v[180:183]
    ds_read_b128 a[196:199], v3 offset:1024
    v_exp_f32 v238, v154
    v_mfma_f32_16x16x32_bf16 v[176:179], a[188:191], v[76:79], v[32:35]
    v_sub_f32 v140, v140, v55
    v_sub_f32 v141, v141, v55
    v_cvt_pk_bf16_f32 v202, v236, v237
    v_mfma_f32_16x16x32_bf16 v[176:179], a[184:187], v[72:75], v[176:179]
    v_exp_f32 v239, v155
    v_or3_b32 v57, v57, v201, v202
    v_mfma_f32_16x16x32_bf16 v[176:179], a[180:183], v[68:71], v[176:179]
    s_cmp_eq_u32 s30, 0
    s_cbranch_scc1 k12_ool_82
k12_oolret_83:
    v_exp_f32 v240, v140
    v_mfma_f32_16x16x32_bf16 v[176:179], a[176:179], v[64:67], v[176:179]
    s_waitcnt vmcnt(8)
    s_barrier
    v_sub_f32 v142, v142, v55
    v_sub_f32 v143, v143, v55
    v_cvt_pk_bf16_f32 v203, v238, v239
    v_exp_f32 v241, v141
    v_exp_f32 v242, v142
    v_sub_f32 v156, v156, v55
    v_sub_f32 v157, v157, v55
    ds_read_b128 a[200:203], v3 offset:2048
    v_cvt_pk_bf16_f32 v204, v240, v241
    v_exp_f32 v243, v143
    v_or3_b32 v57, v57, v203, v204
    v_exp_f32 v244, v156
    v_sub_f32 v158, v158, v55
    v_sub_f32 v159, v159, v55
    v_cvt_pk_bf16_f32 v205, v242, v243
    v_exp_f32 v245, v157
    v_exp_f32 v246, v158
    v_cvt_pk_bf16_f32 v206, v244, v245
    ds_read_b128 a[204:207], v3 offset:3072
    v_exp_f32 v247, v159
    v_or3_b32 v57, v57, v205, v206
    v_cvt_pk_bf16_f32 v207, v246, v247
    v_bitop3_b32 v57, v57, v207, s37 bitop3:0xa8
    v_cmp_ne_u32 vcc, 0, v57
    s_cbranch_vccnz k2_tramp_86
k2_ret_87:
    s_mov_b32 s24, s60
    s_and_b32 s25, s61, 0xffff
    s_mov_b32 s26, s55
    s_lshl_b32 s63, s29, 1
    s_sub_u32 s63, s63, 1
    s_cbranch_scc1 k2_dm3_89
k2_dloop_88:
    v_mfma_f32_16x16x32_bf16 v[12:15], v[60:63], v[192:195], v[12:15]
    v_exp_f32 v232, v160
    v_mfma_f32_16x16x32_bf16 v[48:51], v[60:63], v[196:199], v[48:51]
    s_mov_b32 m0, s34
    ds_read_b128 a[208:211], v3 offset:4096
    v_mfma_f32_16x16x32_bf16 v[248:251], v[60:63], v[200:203], v[248:251]
    s_add_u32 s53, s53, 8192
    buffer_load_dwordx4 v1, s[16:19], s32 offen offset:0 sc1 lds
    v_mfma_f32_16x16x32_bf16 v[252:255], v[60:63], v[204:207], v[252:255]
    s_waitcnt lgkmcnt(3)
    v_exp_f32 v233, v161
    v_mfma_f32_16x16x32_bf16 a[12:15], a[192:195], v[204:207], a[12:15]
    s_and_b32 s53, s53, 0xffff
    v_exp_f32 v234, v162
    v_mfma_f32_16x16x32_bf16 a[8:11], a[192:195], v[200:203], a[8:11]
    s_add_u32 s34, s34, 0x4000
    ds_read_b128 a[212:215], v3 offset:5120
    v_cvt_pk_bf16_f32 v208, v232, v233
    v_mfma_f32_16x16x32_bf16 a[4:7], a[192:195], v[196:199], a[4:7]
    v_exp_f32 v235, v163
    v_mfma_f32_16x16x32_bf16 a[0:3], a[192:195], v[192:195], a[0:3]
    buffer_load_dwordx4 v1, s[16:19], s32 offen offset:1024 sc1 lds
    v_mfma_f32_16x16x32_bf16 a[16:19], a[196:199], v[192:195], a[16:19]
    v_exp_f32 v236, v176
    v_mfma_f32_16x16x32_bf16 a[20:23], a[196:199], v[196:199], a[20:23]
    ds_read_b128 a[216:219], v3 offset:6144
    v_cvt_pk_bf16_f32 v209, v234, v235
    v_mfma_f32_16x16x32_bf16 a[24:27], a[196:199], v[200:203], a[24:27]
    v_exp_f32 v237, v177
    v_mfma_f32_16x16x32_bf16 a[28:31], a[196:199], v[204:207], a[28:31]
    s_waitcnt lgkmcnt(3)
    v_exp_f32 v238, v178
    v_mfma_f32_16x16x32_bf16 a[44:47], a[200:203], v[204:207], a[44:47]
    s_and_b32 s34, s34, 0xffff
    ds_read_b128 a[220:223], v3 offset:7168
    v_cvt_pk_bf16_f32 v210, v236, v237
    v_mfma_f32_16x16x32_bf16 a[40:43], a[200:203], v[200:203], a[40:43]
    s_and_b32 s60, s62, 31
    buffer_load_dwordx4 v1, s[16:19], s32 offen offset:2048 sc1 lds
    v_mfma_f32_16x16x32_bf16 a[36:39], a[200:203], v[196:199], a[36:39]
    v_exp_f32 v239, v179
    v_mfma_f32_16x16x32_bf16 a[32:35], a[200:203], v[192:195], a[32:35]
    s_lshr_b32 s61, s62, 5
    v_or3_b32 v57, v208, v209, v210
    v_add_u32 v3, s53, v56
    v_mfma_f32_16x16x32_bf16 a[48:51], a[204:207], v[192:195], a[48:51]
    v_exp_f32 v240, v164
    v_mfma_f32_16x16x32_bf16 a[52:55], a[204:207], v[196:199], a[52:55]
    ds_read_b128 a[128:131], v2 offset:0
    v_cvt_pk_bf16_f32 v211, v238, v239
    v_mfma_f32_16x16x32_bf16 a[56:59], a[204:207], v[200:203], a[56:59]
    s_mul_i32 s57, s60, 229376
    v_exp_f32 v241, v165
    v_mfma_f32_16x16x32_bf16 a[60:63], a[204:207], v[204:207], a[60:63]
    s_waitcnt lgkmcnt(3)
    buffer_load_dwordx4 v1, s[16:19], s32 offen offset:3072 sc1 lds
    v_mfma_f32_16x16x32_bf16 a[76:79], a[208:211], v[204:207], a[76:79]
    s_add_u32 s32, s32, 0x80000
    v_exp_f32 v242, v166
    v_mfma_f32_16x16x32_bf16 a[72:75], a[208:211], v[200:203], a[72:75]
    s_lshl_b32 s4, s61, 7
    ds_read_b128 a[132:135], v2 offset:1024
    v_cvt_pk_bf16_f32 v212, v240, v241
    v_mfma_f32_16x16x32_bf16 a[68:71], a[208:211], v[196:199], a[68:71]
    v_exp_f32 v243, v167
    v_mfma_f32_16x16x32_bf16 a[64:67], a[208:211], v[192:195], a[64:67]
    s_add_u32 s57, s57, s4
    v_or3_b32 v57, v57, v211, v212
    v_cvt_pk_bf16_f32 v213, v242, v243
    v_mfma_f32_16x16x32_bf16 a[80:83], a[212:215], v[192:195], a[80:83]
    s_waitcnt vmcnt(9)
    v_exp_f32 v244, v180
    v_mfma_f32_16x16x32_bf16 a[84:87], a[212:215], v[196:199], a[84:87]
    buffer_store_dwordx4 a[224:227], v229, s[8:11], s58 offen offset:0 sc1
    ds_read_b128 a[136:139], v2 offset:2048
    v_mfma_f32_16x16x32_bf16 a[88:91], a[212:215], v[200:203], a[88:91]
    s_add_u32 s56, s57, 57344
    v_exp_f32 v245, v181
    v_mfma_f32_16x16x32_bf16 a[92:95], a[212:215], v[204:207], a[92:95]
    s_waitcnt lgkmcnt(3)
    v_exp_f32 v246, v182
    v_mfma_f32_16x16x32_bf16 a[108:111], a[216:219], v[204:207], a[108:111]
    ds_read_b128 a[140:143], v2 offset:3072
    v_cvt_pk_bf16_f32 v214, v244, v245
    v_mfma_f32_16x16x32_bf16 a[104:107], a[216:219], v[200:203], a[104:107]
    s_add_u32 s62, s62, 1
    v_exp_f32 v247, v183
    v_mfma_f32_16x16x32_bf16 a[100:103], a[216:219], v[196:199], a[100:103]
    v_or3_b32 v57, v57, v213, v214
    v_mfma_f32_16x16x32_bf16 a[96:99], a[216:219], v[192:195], a[96:99]
    v_exp_f32 v232, v168
    v_mfma_f32_16x16x32_bf16 a[112:115], a[220:223], v[192:195], a[112:115]
    ds_read_b128 a[144:147], v2 offset:4096
    v_cvt_pk_bf16_f32 v215, v246, v247
    v_mfma_f32_16x16x32_bf16 a[116:119], a[220:223], v[196:199], a[116:119]
    buffer_store_dwordx4 a[228:231], v229, s[8:11], s58 offen offset:256 sc1
    v_mfma_f32_16x16x32_bf16 a[120:123], a[220:223], v[200:203], a[120:123]
    v_exp_f32 v233, v169
    v_mfma_f32_16x16x32_bf16 a[124:127], a[220:223], v[204:207], a[124:127]
    s_waitcnt lgkmcnt(3)
    v_exp_f32 v234, v170
    v_mfma_f32_16x16x32_bf16 v[128:131], a[128:131], v[64:67], v[16:19]
    ds_read_b128 a[148:151], v2 offset:5120
    v_cvt_pk_bf16_f32 v216, v232, v233
    v_mfma_f32_16x16x32_bf16 v[128:131], a[132:135], v[68:71], v[128:131]
    s_waitcnt lgkmcnt(2)
    v_exp_f32 v235, v171
    v_mfma_f32_16x16x32_bf16 v[128:131], a[136:139], v[72:75], v[128:131]
    v_or3_b32 v57, v57, v215, v216
    v_mfma_f32_16x16x32_bf16 v[128:131], a[140:143], v[76:79], v[128:131]
    s_add_u32 s36, s36, 32
    v_exp_f32 v236, v184
    v_mfma_f32_16x16x32_bf16 v[132:135], a[140:143], v[92:95], v[20:23]
    ds_read_b128 a[152:155], v2 offset:6144
    v_cvt_pk_bf16_f32 v217, v234, v235
    v_mfma_f32_16x16x32_bf16 v[132:135], a[136:139], v[88:91], v[132:135]
    s_lshl_b32 s58, s61, 17
    buffer_load_dwordx4 a[224:227], v228, s[12:15], s57 offen nt
    v_mfma_f32_16x16x32_bf16 v[132:135], a[132:135], v[84:87], v[132:135]
    s_add_u32 s52, s52, 8192
    v_exp_f32 v237, v185
    v_mfma_f32_16x16x32_bf16 v[132:135], a[128:131], v[80:83], v[132:135]
    v_exp_f32 v238, v186
    v_mfma_f32_16x16x32_bf16 v[136:139], a[128:131], v[96:99], v[24:27]
    s_lshl_b32 s60, s60, 10
    ds_read_b128 a[156:159], v2 offset:7168
    v_cvt_pk_bf16_f32 v218, v236, v237
    v_mfma_f32_16x16x32_bf16 v[136:139], a[132:135], v[100:103], v[136:139]
    s_and_b32 s52, s52, 0xffff
    v_exp_f32 v239, v187
    v_mfma_f32_16x16x32_bf16 v[136:139], a[136:139], v[104:107], v[136:139]
    v_or3_b32 v57, v57, v217, v218
    v_mfma_f32_16x16x32_bf16 v[136:139], a[140:143], v[108:111], v[136:139]
    v_add_u32 v2, s52, v1
    v_cvt_pk_bf16_f32 v219, v238, v239
    v_mfma_f32_16x16x32_bf16 v[140:143], a[140:143], v[124:127], v[28:31]
    s_add_u32 s58, s58, s60
    v_exp_f32 v240, v172
    v_mfma_f32_16x16x32_bf16 v[140:143], a[136:139], v[120:123], v[140:143]
    buffer_load_dwordx4 a[228:231], v228, s[12:15], s56 offen nt
    v_mfma_f32_16x16x32_bf16 v[140:143], a[132:135], v[116:119], v[140:143]
    v_exp_f32 v241, v173
    v_mfma_f32_16x16x32_bf16 v[140:143], a[128:131], v[112:115], v[140:143]
    s_waitcnt lgkmcnt(2)
    ds_read_b128 a[192:195], v3 offset:0
    v_cvt_pk_bf16_f32 v220, v240, v241
    v_mfma_f32_16x16x32_bf16 v[156:159], a[144:147], v[112:115], v[44:47]
    s_mov_b32 s10, s59
    v_exp_f32 v242, v174
    v_mfma_f32_16x16x32_bf16 v[156:159], a[148:151], v[116:119], v[156:159]
    s_waitcnt lgkmcnt(1)
    v_exp_f32 v243, v175
    v_mfma_f32_16x16x32_bf16 v[156:159], a[152:155], v[120:123], v[156:159]
    ds_read_b128 a[196:199], v3 offset:1024
    v_or3_b32 v57, v57, v219, v220
    v_mfma_f32_16x16x32_bf16 v[156:159], a[156:159], v[124:127], v[156:159]
    v_exp_f32 v244, v188
    v_mfma_f32_16x16x32_bf16 v[152:155], a[156:159], v[108:111], v[40:43]
    v_cvt_pk_bf16_f32 v221, v242, v243
    v_mfma_f32_16x16x32_bf16 v[152:155], a[152:155], v[104:107], v[152:155]
    buffer_load_dword v7, v230, s[24:27], s54 offen
    v_mfma_f32_16x16x32_bf16 v[152:155], a[148:151], v[100:103], v[152:155]
    v_exp_f32 v245, v189
    v_mfma_f32_16x16x32_bf16 v[152:155], a[144:147], v[96:99], v[152:155]
    ds_read_b128 a[200:203], v3 offset:2048
    v_cvt_pk_bf16_f32 v222, v244, v245
    v_mfma_f32_16x16x32_bf16 v[148:151], a[144:147], v[80:83], v[36:39]
    v_exp_f32 v246, v190
    v_mfma_f32_16x16x32_bf16 v[148:151], a[148:151], v[84:87], v[148:151]
    v_exp_f32 v247, v191
    v_mfma_f32_16x16x32_bf16 v[148:151], a[152:155], v[88:91], v[148:151]
    ds_read_b128 a[204:207], v3 offset:3072
    v_or3_b32 v57, v57, v221, v222
    v_mfma_f32_16x16x32_bf16 v[148:151], a[156:159], v[92:95], v[148:151]
    v_cvt_pk_bf16_f32 v223, v246, v247
    v_mfma_f32_16x16x32_bf16 v[144:147], a[156:159], v[76:79], v[32:35]
    s_add_u32 s54, s54, 4096
    v_mfma_f32_16x16x32_bf16 v[144:147], a[152:155], v[72:75], v[144:147]
    v_bitop3_b32 v57, v57, v223, s37 bitop3:0xa8
    v_cmp_ne_u32 vcc, 0, v57
    v_mfma_f32_16x16x32_bf16 v[144:147], a[148:151], v[68:71], v[144:147]
    v_mfma_f32_16x16x32_bf16 v[144:147], a[144:147], v[64:67], v[144:147]
    s_cbranch_vccnz k2_tramp_90
k2_ret_91:
    v_mfma_f32_16x16x32_bf16 v[12:15], v[60:63], v[208:211], v[12:15]
    v_exp_f32 v232, v128
    v_mfma_f32_16x16x32_bf16 v[48:51], v[60:63], v[212:215], v[48:51]
    s_mov_b32 m0, s35
    ds_read_b128 a[208:211], v3 offset:4096
    v_mfma_f32_16x16x32_bf16 v[248:251], v[60:63], v[216:219], v[248:251]
    s_add_u32 s53, s53, 8192
    buffer_load_dwordx4 v1, s[20:23], s33 offen offset:0 sc1 lds
    v_mfma_f32_16x16x32_bf16 v[252:255], v[60:63], v[220:223], v[252:255]
    s_waitcnt lgkmcnt(3)
    v_exp_f32 v233, v129
    v_mfma_f32_16x16x32_bf16 a[12:15], a[192:195], v[220:223], a[12:15]
    s_and_b32 s53, s53, 0xffff
    v_exp_f32 v234, v130
    v_mfma_f32_16x16x32_bf16 a[8:11], a[192:195], v[216:219], a[8:11]
    ds_read_b128 a[212:215], v3 offset:5120
    v_cvt_pk_bf16_f32 v192, v232, v233
    v_mfma_f32_16x16x32_bf16 a[4:7], a[192:195], v[212:215], a[4:7]
    v_exp_f32 v235, v131
    v_mfma_f32_16x16x32_bf16 a[0:3], a[192:195], v[208:211], a[0:3]
    v_exp_f32 v236, v144
    v_mfma_f32_16x16x32_bf16 a[16:19], a[196:199], v[208:211], a[16:19]
    ds_read_b128 a[216:219], v3 offset:6144
    v_cvt_pk_bf16_f32 v193, v234, v235
    v_mfma_f32_16x16x32_bf16 a[20:23], a[196:199], v[212:215], a[20:23]
    v_exp_f32 v237, v145
    v_mfma_f32_16x16x32_bf16 a[24:27], a[196:199], v[216:219], a[24:27]
    v_mfma_f32_16x16x32_bf16 a[28:31], a[196:199], v[220:223], a[28:31]
    s_waitcnt lgkmcnt(3)
    v_exp_f32 v238, v146
    v_mfma_f32_16x16x32_bf16 a[44:47], a[200:203], v[220:223], a[44:47]
    ds_read_b128 a[220:223], v3 offset:7168
    v_cvt_pk_bf16_f32 v194, v236, v237
    v_mfma_f32_16x16x32_bf16 a[40:43], a[200:203], v[216:219], a[40:43]
    v_exp_f32 v239, v147
    v_mfma_f32_16x16x32_bf16 a[36:39], a[200:203], v[212:215], a[36:39]
    v_or3_b32 v57, v192, v193, v194
    v_mfma_f32_16x16x32_bf16 a[32:35], a[200:203], v[208:211], a[32:35]
    s_add_u32 s35, s35, 0x4000
    v_add_u32 v3, s53, v56
    v_cvt_pk_bf16_f32 v195, v238, v239
    v_mfma_f32_16x16x32_bf16 a[48:51], a[204:207], v[208:211], a[48:51]
    v_exp_f32 v240, v132
    v_mfma_f32_16x16x32_bf16 a[52:55], a[204:207], v[212:215], a[52:55]
    buffer_load_dwordx4 v1, s[20:23], s33 offen offset:1024 sc1 lds
    ds_read_b128 a[128:131], v2 offset:0
    v_mfma_f32_16x16x32_bf16 a[56:59], a[204:207], v[216:219], a[56:59]
    v_exp_f32 v241, v133
    v_mfma_f32_16x16x32_bf16 a[60:63], a[204:207], v[220:223], a[60:63]
    s_waitcnt lgkmcnt(3)
    v_exp_f32 v242, v134
    v_mfma_f32_16x16x32_bf16 a[76:79], a[208:211], v[220:223], a[76:79]
    ds_read_b128 a[132:135], v2 offset:1024
    v_cvt_pk_bf16_f32 v196, v240, v241
    v_mfma_f32_16x16x32_bf16 a[72:75], a[208:211], v[216:219], a[72:75]
    v_exp_f32 v243, v135
    v_mfma_f32_16x16x32_bf16 a[68:71], a[208:211], v[212:215], a[68:71]
    v_or3_b32 v57, v57, v195, v196
    v_mfma_f32_16x16x32_bf16 a[64:67], a[208:211], v[208:211], a[64:67]
    v_exp_f32 v244, v148
    v_mfma_f32_16x16x32_bf16 a[80:83], a[212:215], v[208:211], a[80:83]
    ds_read_b128 a[136:139], v2 offset:2048
    v_cvt_pk_bf16_f32 v197, v242, v243
    v_mfma_f32_16x16x32_bf16 a[84:87], a[212:215], v[212:215], a[84:87]
    v_exp_f32 v245, v149
    v_mfma_f32_16x16x32_bf16 a[88:91], a[212:215], v[216:219], a[88:91]
    v_mfma_f32_16x16x32_bf16 a[92:95], a[212:215], v[220:223], a[92:95]
    s_waitcnt lgkmcnt(3)
    v_exp_f32 v246, v150
    v_mfma_f32_16x16x32_bf16 a[108:111], a[216:219], v[220:223], a[108:111]
    ds_read_b128 a[140:143], v2 offset:3072
    v_cvt_pk_bf16_f32 v198, v244, v245
    v_mfma_f32_16x16x32_bf16 a[104:107], a[216:219], v[216:219], a[104:107]
    v_exp_f32 v247, v151
    v_mfma_f32_16x16x32_bf16 a[100:103], a[216:219], v[212:215], a[100:103]
    v_or3_b32 v57, v57, v197, v198
    v_mfma_f32_16x16x32_bf16 a[96:99], a[216:219], v[208:211], a[96:99]
    s_and_b32 s35, s35, 0xffff
    v_exp_f32 v232, v136
    v_mfma_f32_16x16x32_bf16 a[112:115], a[220:223], v[208:211], a[112:115]
    ds_read_b128 a[144:147], v2 offset:4096
    v_cvt_pk_bf16_f32 v199, v246, v247
    v_mfma_f32_16x16x32_bf16 a[116:119], a[220:223], v[212:215], a[116:119]
    buffer_load_dwordx4 v1, s[20:23], s33 offen offset:2048 sc1 lds
    v_mfma_f32_16x16x32_bf16 a[120:123], a[220:223], v[216:219], a[120:123]
    v_exp_f32 v233, v137
    v_mfma_f32_16x16x32_bf16 a[124:127], a[220:223], v[220:223], a[124:127]
    s_waitcnt lgkmcnt(3)
    v_exp_f32 v234, v138
    v_mfma_f32_16x16x32_bf16 v[160:163], a[128:131], v[64:67], v[16:19]
    ds_read_b128 a[148:151], v2 offset:5120
    v_cvt_pk_bf16_f32 v200, v232, v233
    v_mfma_f32_16x16x32_bf16 v[160:163], a[132:135], v[68:71], v[160:163]
    s_waitcnt lgkmcnt(2)
    v_exp_f32 v235, v139
    v_mfma_f32_16x16x32_bf16 v[160:163], a[136:139], v[72:75], v[160:163]
    v_or3_b32 v57, v57, v199, v200
    v_mfma_f32_16x16x32_bf16 v[160:163], a[140:143], v[76:79], v[160:163]
    s_or_b32 s35, s35, 0x10000
    v_exp_f32 v236, v152
    v_mfma_f32_16x16x32_bf16 v[164:167], a[140:143], v[92:95], v[20:23]
    s_add_u32 s36, s36, 32
    ds_read_b128 a[152:155], v2 offset:6144
    v_cvt_pk_bf16_f32 v201, v234, v235
    v_mfma_f32_16x16x32_bf16 v[164:167], a[136:139], v[88:91], v[164:167]
    v_exp_f32 v237, v153
    v_mfma_f32_16x16x32_bf16 v[164:167], a[132:135], v[84:87], v[164:167]
    s_add_u32 s52, s52, 8192
    v_mfma_f32_16x16x32_bf16 v[164:167], a[128:131], v[80:83], v[164:167]
    v_exp_f32 v238, v154
    v_mfma_f32_16x16x32_bf16 v[168:171], a[128:131], v[96:99], v[24:27]
    s_and_b32 s52, s52, 0xffff
    ds_read_b128 a[156:159], v2 offset:7168
    v_cvt_pk_bf16_f32 v202, v236, v237
    v_mfma_f32_16x16x32_bf16 v[168:171], a[132:135], v[100:103], v[168:171]
    v_exp_f32 v239, v155
    v_mfma_f32_16x16x32_bf16 v[168:171], a[136:139], v[104:107], v[168:171]
    v_or3_b32 v57, v57, v201, v202
    v_mfma_f32_16x16x32_bf16 v[168:171], a[140:143], v[108:111], v[168:171]
    v_add_u32 v2, s52, v1
    v_cvt_pk_bf16_f32 v203, v238, v239
    v_mfma_f32_16x16x32_bf16 v[172:175], a[140:143], v[124:127], v[28:31]
    v_exp_f32 v240, v140
    v_mfma_f32_16x16x32_bf16 v[172:175], a[136:139], v[120:123], v[172:175]
    buffer_load_dwordx4 v1, s[20:23], s33 offen offset:3072 sc1 lds
    v_mfma_f32_16x16x32_bf16 v[172:175], a[132:135], v[116:119], v[172:175]
    s_add_u32 s33, s33, 0x80000
    v_exp_f32 v241, v141
    v_mfma_f32_16x16x32_bf16 v[172:175], a[128:131], v[112:115], v[172:175]
    s_waitcnt lgkmcnt(2)
    ds_read_b128 a[192:195], v3 offset:0
    v_cvt_pk_bf16_f32 v204, v240, v241
    v_mfma_f32_16x16x32_bf16 v[188:191], a[144:147], v[112:115], v[44:47]
    v_exp_f32 v242, v142
    v_mfma_f32_16x16x32_bf16 v[188:191], a[148:151], v[116:119], v[188:191]
    s_waitcnt lgkmcnt(1)
    v_exp_f32 v243, v143
    v_mfma_f32_16x16x32_bf16 v[188:191], a[152:155], v[120:123], v[188:191]
    ds_read_b128 a[196:199], v3 offset:1024
    v_or3_b32 v57, v57, v203, v204
    v_mfma_f32_16x16x32_bf16 v[188:191], a[156:159], v[124:127], v[188:191]
    v_exp_f32 v244, v156
    v_mfma_f32_16x16x32_bf16 v[184:187], a[156:159], v[108:111], v[40:43]
    v_cvt_pk_bf16_f32 v205, v242, v243
    v_mfma_f32_16x16x32_bf16 v[184:187], a[152:155], v[104:107], v[184:187]
    v_exp_f32 v245, v157
    v_mfma_f32_16x16x32_bf16 v[184:187], a[148:151], v[100:103], v[184:187]
    ds_read_b128 a[200:203], v3 offset:2048
    v_mfma_f32_16x16x32_bf16 v[184:187], a[144:147], v[96:99], v[184:187]
    s_sub_u32 s63, s63, 1
    v_exp_f32 v246, v158
    v_mfma_f32_16x16x32_bf16 v[180:183], a[144:147], v[80:83], v[36:39]
    v_cvt_pk_bf16_f32 v206, v244, v245
    v_mfma_f32_16x16x32_bf16 v[180:183], a[148:151], v[84:87], v[180:183]
    v_exp_f32 v247, v159
    v_mfma_f32_16x16x32_bf16 v[180:183], a[152:155], v[88:91], v[180:183]
    ds_read_b128 a[204:207], v3 offset:3072
    v_or3_b32 v57, v57, v205, v206
    v_mfma_f32_16x16x32_bf16 v[180:183], a[156:159], v[92:95], v[180:183]
    v_cvt_pk_bf16_f32 v207, v246, v247
    v_mfma_f32_16x16x32_bf16 v[176:179], a[156:159], v[76:79], v[32:35]
    v_mfma_f32_16x16x32_bf16 v[176:179], a[152:155], v[72:75], v[176:179]
    v_bitop3_b32 v57, v57, v207, s37 bitop3:0xa8
    v_cmp_ne_u32 vcc, 0, v57
    v_mfma_f32_16x16x32_bf16 v[176:179], a[148:151], v[68:71], v[176:179]
    v_mfma_f32_16x16x32_bf16 v[176:179], a[144:147], v[64:67], v[176:179]
    s_waitcnt vmcnt(13)
    s_barrier
    s_cbranch_vccnz k2_tramp_92
k2_ret_93:
    s_cmp_lg_u32 s63, 0
    s_cbranch_scc1 k2_dloop_88
    v_mfma_f32_16x16x32_bf16 v[12:15], v[60:63], v[192:195], v[12:15]
    v_exp_f32 v232, v160
    v_mfma_f32_16x16x32_bf16 v[48:51], v[60:63], v[196:199], v[48:51]
    s_mov_b32 m0, s34
    ds_read_b128 a[208:211], v3 offset:4096
    v_mfma_f32_16x16x32_bf16 v[248:251], v[60:63], v[200:203], v[248:251]
    s_add_u32 s53, s53, 8192
    buffer_load_dwordx4 v1, s[16:19], s32 offen offset:0 sc1 lds
    v_mfma_f32_16x16x32_bf16 v[252:255], v[60:63], v[204:207], v[252:255]
    s_waitcnt lgkmcnt(3)
    v_exp_f32 v233, v161
    v_mfma_f32_16x16x32_bf16 a[12:15], a[192:195], v[204:207], a[12:15]
    s_sub_u32 s40, s36, s38
    v_exp_f32 v234, v162
    v_mfma_f32_16x16x32_bf16 a[8:11], a[192:195], v[200:203], a[8:11]
    s_and_b32 s53, s53, 0xffff
    ds_read_b128 a[212:215], v3 offset:5120
    v_cvt_pk_bf16_f32 v208, v232, v233
    v_mfma_f32_16x16x32_bf16 a[4:7], a[192:195], v[196:199], a[4:7]
    s_add_u32 s34, s34, 0x4000
    v_subrev_u32 v6, s40, v4
    v_cmp_gt_i32 s[44:45], 0, v6
    v_mfma_f32_16x16x32_bf16 a[0:3], a[192:195], v[192:195], a[0:3]
    v_exp_f32 v235, v163
    v_mfma_f32_16x16x32_bf16 a[16:19], a[196:199], v[192:195], a[16:19]
    buffer_load_dwordx4 v1, s[16:19], s32 offen offset:1024 sc1 lds
    ds_read_b128 a[216:219], v3 offset:6144
    v_mfma_f32_16x16x32_bf16 a[20:23], a[196:199], v[196:199], a[20:23]
    v_exp_f32 v236, v176
    v_mfma_f32_16x16x32_bf16 a[24:27], a[196:199], v[200:203], a[24:27]
    v_cmp_gt_i32 s[46:47], 1, v6
    v_cvt_pk_bf16_f32 v209, v234, v235
    v_mfma_f32_16x16x32_bf16 a[28:31], a[196:199], v[204:207], a[28:31]
    s_waitcnt lgkmcnt(3)
    v_cmp_gt_i32 s[48:49], 2, v6
    v_cmp_gt_i32 s[50:51], 3, v6
    v_mfma_f32_16x16x32_bf16 a[44:47], a[200:203], v[204:207], a[44:47]
    s_and_b32 s34, s34, 0xffff
    v_exp_f32 v237, v177
    v_mfma_f32_16x16x32_bf16 a[40:43], a[200:203], v[200:203], a[40:43]
    s_and_b32 s60, s62, 31
    v_exp_f32 v238, v178
    v_mfma_f32_16x16x32_bf16 a[36:39], a[200:203], v[196:199], a[36:39]
    ds_read_b128 a[220:223], v3 offset:7168
    v_cvt_pk_bf16_f32 v210, v236, v237
    v_mfma_f32_16x16x32_bf16 a[32:35], a[200:203], v[192:195], a[32:35]
    s_lshr_b32 s61, s62, 5
    buffer_load_dwordx4 v1, s[16:19], s32 offen offset:2048 sc1 lds
    v_mfma_f32_16x16x32_bf16 a[48:51], a[204:207], v[192:195], a[48:51]
    v_cndmask_b32 v16, v8, v5, s[44:45]
    v_or3_b32 v57, v208, v209, v210
    v_mfma_f32_16x16x32_bf16 a[52:55], a[204:207], v[196:199], a[52:55]
    v_exp_f32 v239, v179
    v_mfma_f32_16x16x32_bf16 a[56:59], a[204:207], v[200:203], a[56:59]
    s_mul_i32 s57, s60, 229376
    v_cndmask_b32 v17, v8, v5, s[46:47]
    v_add_u32 v3, s53, v56
    v_mfma_f32_16x16x32_bf16 a[60:63], a[204:207], v[204:207], a[60:63]
    s_waitcnt lgkmcnt(2)
    v_exp_f32 v240, v164
    v_mfma_f32_16x16x32_bf16 a[76:79], a[208:211], v[204:207], a[76:79]
    v_cvt_pk_bf16_f32 v211, v238, v239
    v_cndmask_b32 v18, v8, v5, s[48:49]
    v_mfma_f32_16x16x32_bf16 a[72:75], a[208:211], v[200:203], a[72:75]
    s_lshl_b32 s4, s61, 7
    ds_read_b128 a[128:131], v2 offset:0
    v_cndmask_b32 v19, v8, v5, s[50:51]
    v_mfma_f32_16x16x32_bf16 a[68:71], a[208:211], v[196:199], a[68:71]
    v_exp_f32 v241, v165
    v_mfma_f32_16x16x32_bf16 a[64:67], a[208:211], v[192:195], a[64:67]
    s_add_u32 s57, s57, s4
    buffer_load_dwordx4 v1, s[16:19], s32 offen offset:3072 sc1 lds
    s_add_u32 s32, s32, 0x80000
    v_mfma_f32_16x16x32_bf16 a[80:83], a[212:215], v[192:195], a[80:83]
    s_waitcnt vmcnt(9)
    v_cmp_gt_i32 s[44:45], 16, v6
    v_exp_f32 v242, v166
    v_mfma_f32_16x16x32_bf16 a[84:87], a[212:215], v[196:199], a[84:87]
    ds_read_b128 a[132:135], v2 offset:1024
    v_cvt_pk_bf16_f32 v212, v240, v241
    v_mfma_f32_16x16x32_bf16 a[88:91], a[212:215], v[200:203], a[88:91]
    s_add_u32 s56, s57, 57344
    v_cmp_gt_i32 s[46:47], 17, v6
    v_exp_f32 v243, v167
    v_mfma_f32_16x16x32_bf16 a[92:95], a[212:215], v[204:207], a[92:95]
    s_waitcnt lgkmcnt(2)
    v_or3_b32 v57, v57, v211, v212
    v_cmp_gt_i32 s[48:49], 18, v6
    v_mfma_f32_16x16x32_bf16 a[108:111], a[216:219], v[204:207], a[108:111]
    v_exp_f32 v244, v180
    v_mfma_f32_16x16x32_bf16 a[104:107], a[216:219], v[200:203], a[104:107]
    s_add_u32 s62, s62, 1
    v_cvt_pk_bf16_f32 v213, v242, v243
    v_cmp_gt_i32 s[50:51], 19, v6
    v_mfma_f32_16x16x32_bf16 a[100:103], a[216:219], v[196:199], a[100:103]
    buffer_store_dwordx4 a[224:227], v229, s[8:11], s58 offen offset:0 sc1
    ds_read_b128 a[136:139], v2 offset:2048
    v_mfma_f32_16x16x32_bf16 a[96:99], a[216:219], v[192:195], a[96:99]
    v_exp_f32 v245, v181
    v_mfma_f32_16x16x32_bf16 a[112:115], a[220:223], v[192:195], a[112:115]
    v_cndmask_b32 v32, v8, v5, s[44:45]
    v_exp_f32 v246, v182
    v_mfma_f32_16x16x32_bf16 a[116:119], a[220:223], v[196:199], a[116:119]
    ds_read_b128 a[140:143], v2 offset:3072
    v_cndmask_b32 v33, v8, v5, s[46:47]
    v_cvt_pk_bf16_f32 v214, v244, v245
    v_cndmask_b32 v34, v8, v5, s[48:49]
    v_cndmask_b32 v35, v8, v5, s[50:51]
    v_mfma_f32_16x16x32_bf16 a[120:123], a[220:223], v[200:203], a[120:123]
    v_exp_f32 v247, v183
    v_mfma_f32_16x16x32_bf16 a[124:127], a[220:223], v[204:207], a[124:127]
    s_waitcnt lgkmcnt(2)
    v_or3_b32 v57, v57, v213, v214
    v_cvt_pk_bf16_f32 v215, v246, v247
    v_mfma_f32_16x16x32_bf16 v[128:131], a[128:131], v[64:67], v[16:19]
    v_exp_f32 v232, v168
    v_mfma_f32_16x16x32_bf16 v[128:131], a[132:135], v[68:71], v[128:131]
    s_waitcnt lgkmcnt(0)
    buffer_store_dwordx4 a[228:231], v229, s[8:11], s58 offen offset:256 sc1
    ds_read_b128 a[144:147], v2 offset:4096
    v_mfma_f32_16x16x32_bf16 v[128:131], a[136:139], v[72:75], v[128:131]
    v_exp_f32 v233, v169
    v_mfma_f32_16x16x32_bf16 v[128:131], a[140:143], v[76:79], v[128:131]
    s_add_u32 s36, s36, 32
    v_exp_f32 v234, v170
    v_mfma_f32_16x16x32_bf16 v[132:135], a[140:143], v[92:95], v[20:23]
    ds_read_b128 a[148:151], v2 offset:5120
    v_cvt_pk_bf16_f32 v216, v232, v233
    v_mfma_f32_16x16x32_bf16 v[132:135], a[136:139], v[88:91], v[132:135]
    s_lshl_b32 s58, s61, 17
    v_exp_f32 v235, v171
    v_mfma_f32_16x16x32_bf16 v[132:135], a[132:135], v[84:87], v[132:135]
    s_add_u32 s52, s52, 8192
    v_or3_b32 v57, v57, v215, v216
    v_cvt_pk_bf16_f32 v217, v234, v235
    v_mfma_f32_16x16x32_bf16 v[132:135], a[128:131], v[80:83], v[132:135]
    v_exp_f32 v236, v184
    v_mfma_f32_16x16x32_bf16 v[136:139], a[128:131], v[96:99], v[24:27]
    s_lshl_b32 s60, s60, 10
    buffer_load_dwordx4 a[224:227], v228, s[12:15], s57 offen nt
    ds_read_b128 a[152:155], v2 offset:6144
    v_mfma_f32_16x16x32_bf16 v[136:139], a[132:135], v[100:103], v[136:139]
    s_and_b32 s52, s52, 0xffff
    v_exp_f32 v237, v185
    v_mfma_f32_16x16x32_bf16 v[136:139], a[136:139], v[104:107], v[136:139]
    v_exp_f32 v238, v186
    v_mfma_f32_16x16x32_bf16 v[136:139], a[140:143], v[108:111], v[136:139]
    ds_read_b128 a[156:159], v2 offset:7168
    v_cvt_pk_bf16_f32 v218, v236, v237
    v_mfma_f32_16x16x32_bf16 v[140:143], a[140:143], v[124:127], v[28:31]
    s_add_u32 s58, s58, s60
    v_exp_f32 v239, v187
    v_mfma_f32_16x16x32_bf16 v[140:143], a[136:139], v[120:123], v[140:143]
    v_or3_b32 v57, v57, v217, v218
    v_add_u32 v2, s52, v1
    v_mfma_f32_16x16x32_bf16 v[140:143], a[132:135], v[116:119], v[140:143]
    v_exp_f32 v240, v172
    v_mfma_f32_16x16x32_bf16 v[140:143], a[128:131], v[112:115], v[140:143]
    s_waitcnt lgkmcnt(2)
    ds_read_b128 a[192:195], v3 offset:0
    v_cvt_pk_bf16_f32 v219, v238, v239
    v_mfma_f32_16x16x32_bf16 v[156:159], a[144:147], v[112:115], v[44:47]
    s_mov_b32 s10, s59
    buffer_load_dwordx4 a[228:231], v228, s[12:15], s56 offen nt
    v_mfma_f32_16x16x32_bf16 v[156:159], a[148:151], v[116:119], v[156:159]
    s_waitcnt lgkmcnt(1)
    v_exp_f32 v241, v173
    v_mfma_f32_16x16x32_bf16 v[156:159], a[152:155], v[120:123], v[156:159]
    v_exp_f32 v242, v174
    v_mfma_f32_16x16x32_bf16 v[156:159], a[156:159], v[124:127], v[156:159]
    v_cvt_pk_bf16_f32 v220, v240, v241
    v_or3_b32 v57, v57, v219, v220
    v_mfma_f32_16x16x32_bf16 v[152:155], a[156:159], v[108:111], v[40:43]
    v_exp_f32 v243, v175
    v_mfma_f32_16x16x32_bf16 v[152:155], a[152:155], v[104:107], v[152:155]
    ds_read_b128 a[196:199], v3 offset:1024
    v_cvt_pk_bf16_f32 v221, v242, v243
    v_mfma_f32_16x16x32_bf16 v[152:155], a[148:151], v[100:103], v[152:155]
    v_exp_f32 v244, v188
    v_mfma_f32_16x16x32_bf16 v[152:155], a[144:147], v[96:99], v[152:155]
    buffer_load_dword v7, v230, s[24:27], s54 offen
    ds_read_b128 a[200:203], v3 offset:2048
    v_mfma_f32_16x16x32_bf16 v[148:151], a[144:147], v[80:83], v[36:39]
    v_exp_f32 v245, v189
    v_mfma_f32_16x16x32_bf16 v[148:151], a[148:151], v[84:87], v[148:151]
    v_exp_f32 v246, v190
    v_mfma_f32_16x16x32_bf16 v[148:151], a[152:155], v[88:91], v[148:151]
    v_cvt_pk_bf16_f32 v222, v244, v245
    v_or3_b32 v57, v57, v221, v222
    v_mfma_f32_16x16x32_bf16 v[148:151], a[156:159], v[92:95], v[148:151]
    v_exp_f32 v247, v191
    v_mfma_f32_16x16x32_bf16 v[144:147], a[156:159], v[76:79], v[32:35]
    s_add_u32 s54, s54, 4096
    ds_read_b128 a[204:207], v3 offset:3072
    v_cvt_pk_bf16_f32 v223, v246, v247
    v_mfma_f32_16x16x32_bf16 v[144:147], a[152:155], v[72:75], v[144:147]
    v_bitop3_b32 v57, v57, v223, s37 bitop3:0xa8
    v_cmp_ne_u32 vcc, 0, v57
    v_mfma_f32_16x16x32_bf16 v[144:147], a[148:151], v[68:71], v[144:147]
    v_mfma_f32_16x16x32_bf16 v[144:147], a[144:147], v[64:67], v[144:147]
    s_cbranch_vccnz k2_tramp_94
k2_ret_95:
    v_mfma_f32_16x16x32_bf16 v[12:15], v[60:63], v[208:211], v[12:15]
    v_exp_f32 v232, v128
    v_mfma_f32_16x16x32_bf16 v[48:51], v[60:63], v[212:215], v[48:51]
    s_mov_b32 m0, s35
    ds_read_b128 a[208:211], v3 offset:4096
    v_mfma_f32_16x16x32_bf16 v[248:251], v[60:63], v[216:219], v[248:251]
    s_add_u32 s53, s53, 8192
    buffer_load_dwordx4 v1, s[20:23], s33 offen offset:0 sc1 lds
    v_mfma_f32_16x16x32_bf16 v[252:255], v[60:63], v[220:223], v[252:255]
    s_waitcnt lgkmcnt(3)
    v_exp_f32 v233, v129
    v_mfma_f32_16x16x32_bf16 a[12:15], a[192:195], v[220:223], a[12:15]
    s_sub_u32 s40, s36, s38
    v_exp_f32 v234, v130
    v_mfma_f32_16x16x32_bf16 a[8:11], a[192:195], v[216:219], a[8:11]
    s_and_b32 s53, s53, 0xffff
    ds_read_b128 a[212:215], v3 offset:5120
    v_cvt_pk_bf16_f32 v192, v232, v233
    v_mfma_f32_16x16x32_bf16 a[4:7], a[192:195], v[212:215], a[4:7]
    v_subrev_u32 v6, s40, v4
    v_cmp_gt_i32 s[44:45], 0, v6
    v_mfma_f32_16x16x32_bf16 a[0:3], a[192:195], v[208:211], a[0:3]
    v_exp_f32 v235, v131
    v_mfma_f32_16x16x32_bf16 a[16:19], a[196:199], v[208:211], a[16:19]
    v_exp_f32 v236, v144
    v_mfma_f32_16x16x32_bf16 a[20:23], a[196:199], v[212:215], a[20:23]
    v_cmp_gt_i32 s[46:47], 1, v6
    v_cvt_pk_bf16_f32 v193, v234, v235
    v_mfma_f32_16x16x32_bf16 a[24:27], a[196:199], v[216:219], a[24:27]
    ds_read_b128 a[216:219], v3 offset:6144
    v_cmp_gt_i32 s[48:49], 2, v6
    v_mfma_f32_16x16x32_bf16 a[28:31], a[196:199], v[220:223], a[28:31]
    s_waitcnt lgkmcnt(3)
    v_exp_f32 v237, v145
    v_mfma_f32_16x16x32_bf16 a[44:47], a[200:203], v[220:223], a[44:47]
    v_cmp_gt_i32 s[50:51], 3, v6
    v_cvt_pk_bf16_f32 v194, v236, v237
    v_mfma_f32_16x16x32_bf16 a[40:43], a[200:203], v[216:219], a[40:43]
    v_exp_f32 v238, v146
    v_mfma_f32_16x16x32_bf16 a[36:39], a[200:203], v[212:215], a[36:39]
    ds_read_b128 a[220:223], v3 offset:7168
    v_cndmask_b32 v16, v8, v5, s[44:45]
    v_mfma_f32_16x16x32_bf16 a[32:35], a[200:203], v[208:211], a[32:35]
    s_add_u32 s35, s35, 0x4000
    v_exp_f32 v239, v147
    v_mfma_f32_16x16x32_bf16 a[48:51], a[204:207], v[208:211], a[48:51]
    v_or3_b32 v57, v192, v193, v194
    v_cndmask_b32 v17, v8, v5, s[46:47]
    v_mfma_f32_16x16x32_bf16 a[52:55], a[204:207], v[212:215], a[52:55]
    v_add_u32 v3, s53, v56
    v_cvt_pk_bf16_f32 v195, v238, v239
    v_mfma_f32_16x16x32_bf16 a[56:59], a[204:207], v[216:219], a[56:59]
    v_exp_f32 v240, v132
    v_mfma_f32_16x16x32_bf16 a[60:63], a[204:207], v[220:223], a[60:63]
    s_waitcnt lgkmcnt(2)
    ds_read_b128 a[128:131], v2 offset:0
    v_cndmask_b32 v18, v8, v5, s[48:49]
    v_mfma_f32_16x16x32_bf16 a[76:79], a[208:211], v[220:223], a[76:79]
    buffer_load_dwordx4 v1, s[20:23], s33 offen offset:1024 sc1 lds
    ds_read_b128 a[132:135], v2 offset:1024
    v_mfma_f32_16x16x32_bf16 a[72:75], a[208:211], v[216:219], a[72:75]
    v_exp_f32 v241, v133
    v_mfma_f32_16x16x32_bf16 a[68:71], a[208:211], v[212:215], a[68:71]
    v_cndmask_b32 v19, v8, v5, s[50:51]
    v_cmp_gt_i32 s[44:45], 16, v6
    v_mfma_f32_16x16x32_bf16 a[64:67], a[208:211], v[208:211], a[64:67]
    v_exp_f32 v242, v134
    v_mfma_f32_16x16x32_bf16 a[80:83], a[212:215], v[208:211], a[80:83]
    v_cvt_pk_bf16_f32 v196, v240, v241
    v_cmp_gt_i32 s[46:47], 17, v6
    v_mfma_f32_16x16x32_bf16 a[84:87], a[212:215], v[212:215], a[84:87]
    v_exp_f32 v243, v135
    v_mfma_f32_16x16x32_bf16 a[88:91], a[212:215], v[216:219], a[88:91]
    v_or3_b32 v57, v57, v195, v196
    v_cmp_gt_i32 s[48:49], 18, v6
    v_mfma_f32_16x16x32_bf16 a[92:95], a[212:215], v[220:223], a[92:95]
    s_waitcnt lgkmcnt(2)
    v_exp_f32 v244, v148
    v_mfma_f32_16x16x32_bf16 a[108:111], a[216:219], v[220:223], a[108:111]
    v_cvt_pk_bf16_f32 v197, v242, v243
    v_cmp_gt_i32 s[50:51], 19, v6
    v_mfma_f32_16x16x32_bf16 a[104:107], a[216:219], v[216:219], a[104:107]
    ds_read_b128 a[136:139], v2 offset:2048
    v_cndmask_b32 v32, v8, v5, s[44:45]
    v_mfma_f32_16x16x32_bf16 a[100:103], a[216:219], v[212:215], a[100:103]
    v_exp_f32 v245, v149
    v_mfma_f32_16x16x32_bf16 a[96:99], a[216:219], v[208:211], a[96:99]
    s_and_b32 s35, s35, 0xffff
    v_exp_f32 v246, v150
    v_mfma_f32_16x16x32_bf16 a[112:115], a[220:223], v[208:211], a[112:115]
    v_cndmask_b32 v33, v8, v5, s[46:47]
    v_cvt_pk_bf16_f32 v198, v244, v245
    v_mfma_f32_16x16x32_bf16 a[116:119], a[220:223], v[212:215], a[116:119]
    ds_read_b128 a[140:143], v2 offset:3072
    v_cndmask_b32 v34, v8, v5, s[48:49]
    v_cndmask_b32 v35, v8, v5, s[50:51]
    v_mfma_f32_16x16x32_bf16 a[120:123], a[220:223], v[216:219], a[120:123]
    v_exp_f32 v247, v151
    v_mfma_f32_16x16x32_bf16 a[124:127], a[220:223], v[220:223], a[124:127]
    s_waitcnt lgkmcnt(2)
    v_or3_b32 v57, v57, v197, v198
    v_cvt_pk_bf16_f32 v199, v246, v247
    v_mfma_f32_16x16x32_bf16 v[160:163], a[128:131], v[64:67], v[16:19]
    v_exp_f32 v232, v136
    v_mfma_f32_16x16x32_bf16 v[160:163], a[132:135], v[68:71], v[160:163]
    s_waitcnt lgkmcnt(0)
    buffer_load_dwordx4 v1, s[20:23], s33 offen offset:2048 sc1 lds
    ds_read_b128 a[144:147], v2 offset:4096
    v_mfma_f32_16x16x32_bf16 v[160:163], a[136:139], v[72:75], v[160:163]
    v_exp_f32 v233, v137
    v_mfma_f32_16x16x32_bf16 v[160:163], a[140:143], v[76:79], v[160:163]
    s_or_b32 s35, s35, 0x10000
    v_exp_f32 v234, v138
    v_mfma_f32_16x16x32_bf16 v[164:167], a[140:143], v[92:95], v[20:23]
    s_add_u32 s36, s36, 32
    ds_read_b128 a[148:151], v2 offset:5120
    v_cvt_pk_bf16_f32 v200, v232, v233
    v_mfma_f32_16x16x32_bf16 v[164:167], a[136:139], v[88:91], v[164:167]
    v_exp_f32 v235, v139
    v_mfma_f32_16x16x32_bf16 v[164:167], a[132:135], v[84:87], v[164:167]
    s_add_u32 s52, s52, 8192
    v_or3_b32 v57, v57, v199, v200
    v_cvt_pk_bf16_f32 v201, v234, v235
    v_mfma_f32_16x16x32_bf16 v[164:167], a[128:131], v[80:83], v[164:167]
    v_exp_f32 v236, v152
    v_mfma_f32_16x16x32_bf16 v[168:171], a[128:131], v[96:99], v[24:27]
    s_and_b32 s52, s52, 0xffff
    ds_read_b128 a[152:155], v2 offset:6144
    ds_read_b128 a[156:159], v2 offset:7168
    v_mfma_f32_16x16x32_bf16 v[168:171], a[132:135], v[100:103], v[168:171]
    v_exp_f32 v237, v153
    v_mfma_f32_16x16x32_bf16 v[168:171], a[136:139], v[104:107], v[168:171]
    v_exp_f32 v238, v154
    v_mfma_f32_16x16x32_bf16 v[168:171], a[140:143], v[108:111], v[168:171]
    v_cvt_pk_bf16_f32 v202, v236, v237
    v_or3_b32 v57, v57, v201, v202
    v_mfma_f32_16x16x32_bf16 v[172:175], a[140:143], v[124:127], v[28:31]
    v_exp_f32 v239, v155
    v_mfma_f32_16x16x32_bf16 v[172:175], a[136:139], v[120:123], v[172:175]
    v_add_u32 v2, s52, v1
    v_cvt_pk_bf16_f32 v203, v238, v239
    v_mfma_f32_16x16x32_bf16 v[172:175], a[132:135], v[116:119], v[172:175]
    v_exp_f32 v240, v140
    v_mfma_f32_16x16x32_bf16 v[172:175], a[128:131], v[112:115], v[172:175]
    s_waitcnt lgkmcnt(2)
    buffer_load_dwordx4 v1, s[20:23], s33 offen offset:3072 sc1 lds
    s_add_u32 s33, s33, 0x80000
    v_mfma_f32_16x16x32_bf16 v[188:191], a[144:147], v[112:115], v[44:47]
    v_exp_f32 v241, v141
    v_mfma_f32_16x16x32_bf16 v[188:191], a[148:151], v[116:119], v[188:191]
    s_waitcnt lgkmcnt(0)
    ds_read_b128 a[192:195], v3 offset:0
    v_cvt_pk_bf16_f32 v204, v240, v241
    v_mfma_f32_16x16x32_bf16 v[188:191], a[152:155], v[120:123], v[188:191]
    v_exp_f32 v242, v142
    v_mfma_f32_16x16x32_bf16 v[188:191], a[156:159], v[124:127], v[188:191]
    v_exp_f32 v243, v143
    v_mfma_f32_16x16x32_bf16 v[184:187], a[156:159], v[108:111], v[40:43]
    ds_read_b128 a[196:199], v3 offset:1024
    v_or3_b32 v57, v57, v203, v204
    v_mfma_f32_16x16x32_bf16 v[184:187], a[152:155], v[104:107], v[184:187]
    v_exp_f32 v244, v156
    v_mfma_f32_16x16x32_bf16 v[184:187], a[148:151], v[100:103], v[184:187]
    ds_read_b128 a[200:203], v3 offset:2048
    v_cvt_pk_bf16_f32 v205, v242, v243
    v_mfma_f32_16x16x32_bf16 v[184:187], a[144:147], v[96:99], v[184:187]
    v_exp_f32 v245, v157
    v_mfma_f32_16x16x32_bf16 v[180:183], a[144:147], v[80:83], v[36:39]
    v_exp_f32 v246, v158
    v_mfma_f32_16x16x32_bf16 v[180:183], a[148:151], v[84:87], v[180:183]
    v_cvt_pk_bf16_f32 v206, v244, v245
    v_or3_b32 v57, v57, v205, v206
    v_mfma_f32_16x16x32_bf16 v[180:183], a[152:155], v[88:91], v[180:183]
    v_exp_f32 v247, v159
    v_mfma_f32_16x16x32_bf16 v[180:183], a[156:159], v[92:95], v[180:183]
    ds_read_b128 a[204:207], v3 offset:3072
    v_cvt_pk_bf16_f32 v207, v246, v247
    v_mfma_f32_16x16x32_bf16 v[176:179], a[156:159], v[76:79], v[32:35]
    v_mfma_f32_16x16x32_bf16 v[176:179], a[152:155], v[72:75], v[176:179]
    v_bitop3_b32 v57, v57, v207, s37 bitop3:0xa8
    v_cmp_ne_u32 vcc, 0, v57
    v_mfma_f32_16x16x32_bf16 v[176:179], a[148:151], v[68:71], v[176:179]
    v_mfma_f32_16x16x32_bf16 v[176:179], a[144:147], v[64:67], v[176:179]
    s_waitcnt vmcnt(13)
    s_barrier
    s_cbranch_vccnz k2_tramp_96
k2_ret_97:
k2_dm3_89:
    v_mfma_f32_16x16x32_bf16 v[12:15], v[60:63], v[192:195], v[12:15]
    v_exp_f32 v232, v160
    v_mfma_f32_16x16x32_bf16 v[48:51], v[60:63], v[196:199], v[48:51]
    s_mov_b32 m0, s34
    ds_read_b128 a[208:211], v3 offset:4096
    v_mfma_f32_16x16x32_bf16 v[248:251], v[60:63], v[200:203], v[248:251]
    s_add_u32 s53, s53, 8192
    v_exp_f32 v233, v161
    v_mfma_f32_16x16x32_bf16 v[252:255], v[60:63], v[204:207], v[252:255]
    s_waitcnt lgkmcnt(3)
    buffer_load_dwordx4 v1, s[16:19], s32 offen offset:0 sc1 lds
    v_mfma_f32_16x16x32_bf16 a[12:15], a[192:195], v[204:207], a[12:15]
    s_sub_u32 s40, s36, s38
    s_sub_u32 s40, s40, 64
    v_exp_f32 v234, v162
    v_cvt_pk_bf16_f32 v208, v232, v233
    v_mfma_f32_16x16x32_bf16 a[8:11], a[192:195], v[200:203], a[8:11]
    s_and_b32 s53, s53, 0xffff
    ds_read_b128 a[212:215], v3 offset:5120
    v_subrev_u32 v6, s40, v4
    v_mfma_f32_16x16x32_bf16 a[4:7], a[192:195], v[196:199], a[4:7]
    s_add_u32 s34, s34, 0x4000
    v_exp_f32 v235, v163
    v_cmp_gt_i32 s[44:45], 0, v6
    v_mfma_f32_16x16x32_bf16 a[0:3], a[192:195], v[192:195], a[0:3]
    v_exp_f32 v236, v176
    v_cvt_pk_bf16_f32 v209, v234, v235
    v_mfma_f32_16x16x32_bf16 a[16:19], a[196:199], v[192:195], a[16:19]
    buffer_load_dwordx4 v1, s[16:19], s32 offen offset:1024 sc1 lds
    ds_read_b128 a[216:219], v3 offset:6144
    v_mfma_f32_16x16x32_bf16 a[20:23], a[196:199], v[196:199], a[20:23]
    v_cmp_gt_i32 s[46:47], 1, v6
    v_exp_f32 v237, v177
    v_mfma_f32_16x16x32_bf16 a[24:27], a[196:199], v[200:203], a[24:27]
    v_cmp_gt_i32 s[48:49], 2, v6
    v_exp_f32 v238, v178
    v_mfma_f32_16x16x32_bf16 a[28:31], a[196:199], v[204:207], a[28:31]
    s_waitcnt lgkmcnt(3)
    v_cvt_pk_bf16_f32 v210, v236, v237
    v_cmp_gt_i32 s[50:51], 3, v6
    v_mfma_f32_16x16x32_bf16 a[44:47], a[200:203], v[204:207], a[44:47]
    s_and_b32 s34, s34, 0xffff
    v_exp_f32 v239, v179
    v_mfma_f32_16x16x32_bf16 a[40:43], a[200:203], v[200:203], a[40:43]
    s_and_b32 s60, s62, 31
    ds_read_b128 a[220:223], v3 offset:7168
    v_or3_b32 v57, v208, v209, v210
    v_cndmask_b32 v20, v9, v5, s[44:45]
    v_mfma_f32_16x16x32_bf16 a[36:39], a[200:203], v[196:199], a[36:39]
    buffer_load_dwordx4 v1, s[16:19], s32 offen offset:2048 sc1 lds
    v_mfma_f32_16x16x32_bf16 a[32:35], a[200:203], v[192:195], a[32:35]
    s_lshr_b32 s61, s62, 5
    v_exp_f32 v240, v164
    v_cvt_pk_bf16_f32 v211, v238, v239
    v_mfma_f32_16x16x32_bf16 a[48:51], a[204:207], v[192:195], a[48:51]
    v_cndmask_b32 v21, v9, v5, s[46:47]
    v_add_u32 v3, s53, v56
    v_mfma_f32_16x16x32_bf16 a[52:55], a[204:207], v[196:199], a[52:55]
    s_mul_i32 s57, s60, 229376
    v_exp_f32 v241, v165
    v_mfma_f32_16x16x32_bf16 a[56:59], a[204:207], v[200:203], a[56:59]
    ds_read_b128 a[128:131], v2 offset:0
    v_cndmask_b32 v22, v9, v5, s[48:49]
    v_cvt_pk_bf16_f32 v212, v240, v241
    v_mfma_f32_16x16x32_bf16 a[60:63], a[204:207], v[204:207], a[60:63]
    s_waitcnt lgkmcnt(3)
    v_exp_f32 v242, v166
    v_mfma_f32_16x16x32_bf16 a[76:79], a[208:211], v[204:207], a[76:79]
    s_lshl_b32 s4, s61, 7
    v_cndmask_b32 v23, v9, v5, s[50:51]
    v_or3_b32 v57, v57, v211, v212
    v_mfma_f32_16x16x32_bf16 a[72:75], a[208:211], v[200:203], a[72:75]
    buffer_load_dwordx4 v1, s[16:19], s32 offen offset:3072 sc1 lds
    ds_read_b128 a[132:135], v2 offset:1024
    s_add_u32 s32, s32, 0x80000
    v_mfma_f32_16x16x32_bf16 a[68:71], a[208:211], v[196:199], a[68:71]
    v_exp_f32 v243, v167
    v_mfma_f32_16x16x32_bf16 a[64:67], a[208:211], v[192:195], a[64:67]
    s_add_u32 s57, s57, s4
    v_cmp_gt_i32 s[44:45], 16, v6
    v_cvt_pk_bf16_f32 v213, v242, v243
    v_mfma_f32_16x16x32_bf16 a[80:83], a[212:215], v[192:195], a[80:83]
    s_waitcnt vmcnt(9)
    v_exp_f32 v244, v180
    v_mfma_f32_16x16x32_bf16 a[84:87], a[212:215], v[196:199], a[84:87]
    s_add_u32 s56, s57, 57344
    ds_read_b128 a[136:139], v2 offset:2048
    v_cmp_gt_i32 s[46:47], 17, v6
    v_mfma_f32_16x16x32_bf16 a[88:91], a[212:215], v[200:203], a[88:91]
    v_exp_f32 v245, v181
    v_cmp_gt_i32 s[48:49], 18, v6
    v_mfma_f32_16x16x32_bf16 a[92:95], a[212:215], v[204:207], a[92:95]
    s_waitcnt lgkmcnt(3)
    v_exp_f32 v246, v182
    v_mfma_f32_16x16x32_bf16 a[108:111], a[216:219], v[204:207], a[108:111]
    s_add_u32 s62, s62, 1
    v_cmp_gt_i32 s[50:51], 19, v6
    v_cvt_pk_bf16_f32 v214, v244, v245
    v_mfma_f32_16x16x32_bf16 a[104:107], a[216:219], v[200:203], a[104:107]
    buffer_store_dwordx4 a[224:227], v229, s[8:11], s58 offen offset:0 sc1
    ds_read_b128 a[140:143], v2 offset:3072
    ds_read_b128 a[144:147], v2 offset:4096
    v_mfma_f32_16x16x32_bf16 a[100:103], a[216:219], v[196:199], a[100:103]
    v_exp_f32 v247, v183
    v_mfma_f32_16x16x32_bf16 a[96:99], a[216:219], v[192:195], a[96:99]
    v_cndmask_b32 v36, v9, v5, s[44:45]
    v_or3_b32 v57, v57, v213, v214
    v_mfma_f32_16x16x32_bf16 a[112:115], a[220:223], v[192:195], a[112:115]
    v_exp_f32 v232, v168
    v_mfma_f32_16x16x32_bf16 a[116:119], a[220:223], v[196:199], a[116:119]
    v_cndmask_b32 v37, v9, v5, s[46:47]
    v_cvt_pk_bf16_f32 v215, v246, v247
    v_cndmask_b32 v38, v9, v5, s[48:49]
    v_cndmask_b32 v39, v9, v5, s[50:51]
    v_mfma_f32_16x16x32_bf16 a[120:123], a[220:223], v[200:203], a[120:123]
    v_exp_f32 v233, v169
    v_mfma_f32_16x16x32_bf16 a[124:127], a[220:223], v[204:207], a[124:127]
    s_waitcnt lgkmcnt(3)
    buffer_store_dwordx4 a[228:231], v229, s[8:11], s58 offen offset:256 sc1
    v_exp_f32 v234, v170
    v_mfma_f32_16x16x32_bf16 v[132:135], a[128:131], v[80:83], v[20:23]
    ds_read_b128 a[148:151], v2 offset:5120
    v_cvt_pk_bf16_f32 v216, v232, v233
    v_mfma_f32_16x16x32_bf16 v[132:135], a[132:135], v[84:87], v[132:135]
    s_waitcnt lgkmcnt(2)
    v_exp_f32 v235, v171
    v_mfma_f32_16x16x32_bf16 v[132:135], a[136:139], v[88:91], v[132:135]
    s_lshl_b32 s58, s61, 17
    ds_read_b128 a[152:155], v2 offset:6144
    v_or3_b32 v57, v57, v215, v216
    v_mfma_f32_16x16x32_bf16 v[132:135], a[140:143], v[92:95], v[132:135]
    s_add_u32 s36, s36, 32
    v_exp_f32 v236, v184
    v_mfma_f32_16x16x32_bf16 v[136:139], a[140:143], v[108:111], v[24:27]
    s_lshl_b32 s60, s60, 10
    v_cvt_pk_bf16_f32 v217, v234, v235
    v_exp_f32 v237, v185
    v_mfma_f32_16x16x32_bf16 v[136:139], a[136:139], v[104:107], v[136:139]
    buffer_load_dwordx4 a[224:227], v228, s[12:15], s57 offen nt
    ds_read_b128 a[156:159], v2 offset:7168
    v_mfma_f32_16x16x32_bf16 v[136:139], a[132:135], v[100:103], v[136:139]
    s_add_u32 s52, s52, 8192
    v_exp_f32 v238, v186
    v_mfma_f32_16x16x32_bf16 v[136:139], a[128:131], v[96:99], v[136:139]
    s_add_u32 s58, s58, s60
    v_cvt_pk_bf16_f32 v218, v236, v237
    v_or3_b32 v57, v57, v217, v218
    v_mfma_f32_16x16x32_bf16 v[140:143], a[128:131], v[112:115], v[28:31]
    s_and_b32 s52, s52, 0xffff
    v_exp_f32 v239, v187
    v_mfma_f32_16x16x32_bf16 v[140:143], a[132:135], v[116:119], v[140:143]
    v_add_u32 v2, s52, v1
    v_cvt_pk_bf16_f32 v219, v238, v239
    v_mfma_f32_16x16x32_bf16 v[140:143], a[136:139], v[120:123], v[140:143]
    s_mov_b32 s10, s59
    v_exp_f32 v240, v172
    v_mfma_f32_16x16x32_bf16 v[140:143], a[140:143], v[124:127], v[140:143]
    s_waitcnt lgkmcnt(2)
    ds_read_b128 a[192:195], v3 offset:0
    s_waitcnt lgkmcnt(1)
    v_mfma_f32_16x16x32_bf16 v[156:159], a[156:159], v[124:127], v[44:47]
    v_exp_f32 v241, v173
    v_mfma_f32_16x16x32_bf16 v[156:159], a[152:155], v[120:123], v[156:159]
    buffer_load_dwordx4 a[228:231], v228, s[12:15], s56 offen nt
    v_exp_f32 v242, v174
    v_mfma_f32_16x16x32_bf16 v[156:159], a[148:151], v[116:119], v[156:159]
    ds_read_b128 a[196:199], v3 offset:1024
    v_cvt_pk_bf16_f32 v220, v240, v241
    v_mfma_f32_16x16x32_bf16 v[156:159], a[144:147], v[112:115], v[156:159]
    v_exp_f32 v243, v175
    v_mfma_f32_16x16x32_bf16 v[152:155], a[144:147], v[96:99], v[40:43]
    v_or3_b32 v57, v57, v219, v220
    v_cvt_pk_bf16_f32 v221, v242, v243
    v_mfma_f32_16x16x32_bf16 v[152:155], a[148:151], v[100:103], v[152:155]
    ds_read_b128 a[200:203], v3 offset:2048
    v_exp_f32 v244, v188
    v_mfma_f32_16x16x32_bf16 v[152:155], a[152:155], v[104:107], v[152:155]
    buffer_load_dword v7, v230, s[24:27], s54 offen
    v_exp_f32 v245, v189
    v_mfma_f32_16x16x32_bf16 v[152:155], a[156:159], v[108:111], v[152:155]
    v_exp_f32 v246, v190
    v_mfma_f32_16x16x32_bf16 v[148:151], a[156:159], v[92:95], v[36:39]
    s_add_u32 s54, s54, 4096
    v_cvt_pk_bf16_f32 v222, v244, v245
    v_or3_b32 v57, v57, v221, v222
    v_mfma_f32_16x16x32_bf16 v[148:151], a[152:155], v[88:91], v[148:151]
    v_exp_f32 v247, v191
    v_mfma_f32_16x16x32_bf16 v[148:151], a[148:151], v[84:87], v[148:151]
    ds_read_b128 a[204:207], v3 offset:3072
    v_cvt_pk_bf16_f32 v223, v246, v247
    v_mfma_f32_16x16x32_bf16 v[148:151], a[144:147], v[80:83], v[148:151]
    v_bitop3_b32 v57, v57, v223, s37 bitop3:0xa8
    v_cmp_ne_u32 vcc, 0, v57
    s_cbranch_vccnz k2_tramp_98
k2_ret_99:
    v_mfma_f32_16x16x32_bf16 v[12:15], v[60:63], v[208:211], v[12:15]
    v_exp_f32 v232, v132
    v_mfma_f32_16x16x32_bf16 v[48:51], v[60:63], v[212:215], v[48:51]
    s_mov_b32 m0, s35
    ds_read_b128 a[208:211], v3 offset:4096
    v_mfma_f32_16x16x32_bf16 v[248:251], v[60:63], v[216:219], v[248:251]
    s_add_u32 s53, s53, 8192
    buffer_load_dwordx4 v1, s[20:23], s33 offen offset:0 sc1 lds
    v_mfma_f32_16x16x32_bf16 v[252:255], v[60:63], v[220:223], v[252:255]
    s_waitcnt lgkmcnt(3)
    v_exp_f32 v233, v133
    v_mfma_f32_16x16x32_bf16 a[12:15], a[192:195], v[220:223], a[12:15]
    s_sub_u32 s40, s36, s38
    s_sub_u32 s40, s40, 64
    v_exp_f32 v234, v134
    v_mfma_f32_16x16x32_bf16 a[8:11], a[192:195], v[216:219], a[8:11]
    s_and_b32 s53, s53, 0xffff
    ds_read_b128 a[212:215], v3 offset:5120
    v_subrev_u32 v6, s40, v4
    v_mfma_f32_16x16x32_bf16 a[4:7], a[192:195], v[212:215], a[4:7]
    v_cvt_pk_bf16_f32 v196, v232, v233
    v_cmp_gt_i32 s[44:45], 0, v6
    v_mfma_f32_16x16x32_bf16 a[0:3], a[192:195], v[208:211], a[0:3]
    v_exp_f32 v235, v135
    v_mfma_f32_16x16x32_bf16 a[16:19], a[196:199], v[208:211], a[16:19]
    ds_read_b128 a[216:219], v3 offset:6144
    v_cmp_gt_i32 s[46:47], 1, v6
    v_mfma_f32_16x16x32_bf16 a[20:23], a[196:199], v[212:215], a[20:23]
    v_exp_f32 v236, v148
    v_mfma_f32_16x16x32_bf16 a[24:27], a[196:199], v[216:219], a[24:27]
    v_cvt_pk_bf16_f32 v197, v234, v235
    v_cmp_gt_i32 s[48:49], 2, v6
    v_mfma_f32_16x16x32_bf16 a[28:31], a[196:199], v[220:223], a[28:31]
    s_waitcnt lgkmcnt(3)
    v_cmp_gt_i32 s[50:51], 3, v6
    v_mfma_f32_16x16x32_bf16 a[44:47], a[200:203], v[220:223], a[44:47]
    v_exp_f32 v237, v149
    v_mfma_f32_16x16x32_bf16 a[40:43], a[200:203], v[216:219], a[40:43]
    s_add_u32 s35, s35, 0x4000
    ds_read_b128 a[220:223], v3 offset:7168
    v_cndmask_b32 v20, v9, v5, s[44:45]
    v_mfma_f32_16x16x32_bf16 a[36:39], a[200:203], v[212:215], a[36:39]
    v_exp_f32 v238, v150
    v_mfma_f32_16x16x32_bf16 a[32:35], a[200:203], v[208:211], a[32:35]
    v_cvt_pk_bf16_f32 v198, v236, v237
    v_cndmask_b32 v21, v9, v5, s[46:47]
    v_mfma_f32_16x16x32_bf16 a[48:51], a[204:207], v[208:211], a[48:51]
    buffer_load_dwordx4 v1, s[20:23], s33 offen offset:1024 sc1 lds
    ds_read_b128 a[128:131], v2 offset:0
    v_mfma_f32_16x16x32_bf16 a[52:55], a[204:207], v[212:215], a[52:55]
    v_add_u32 v3, s53, v56
    v_cndmask_b32 v22, v9, v5, s[48:49]
    v_mfma_f32_16x16x32_bf16 a[56:59], a[204:207], v[216:219], a[56:59]
    v_exp_f32 v239, v151
    v_mfma_f32_16x16x32_bf16 a[60:63], a[204:207], v[220:223], a[60:63]
    s_waitcnt lgkmcnt(3)
    v_or3_b32 v57, v196, v197, v198
    v_cndmask_b32 v23, v9, v5, s[50:51]
    v_mfma_f32_16x16x32_bf16 a[76:79], a[208:211], v[220:223], a[76:79]
    v_exp_f32 v240, v136
    v_mfma_f32_16x16x32_bf16 a[72:75], a[208:211], v[216:219], a[72:75]
    v_cvt_pk_bf16_f32 v199, v238, v239
    v_cmp_gt_i32 s[44:45], 16, v6
    v_mfma_f32_16x16x32_bf16 a[68:71], a[208:211], v[212:215], a[68:71]
    ds_read_b128 a[132:135], v2 offset:1024
    v_cmp_gt_i32 s[46:47], 17, v6
    v_mfma_f32_16x16x32_bf16 a[64:67], a[208:211], v[208:211], a[64:67]
    v_exp_f32 v241, v137
    v_mfma_f32_16x16x32_bf16 a[80:83], a[212:215], v[208:211], a[80:83]
    ds_read_b128 a[136:139], v2 offset:2048
    v_cmp_gt_i32 s[48:49], 18, v6
    v_mfma_f32_16x16x32_bf16 a[84:87], a[212:215], v[212:215], a[84:87]
    v_exp_f32 v242, v138
    v_mfma_f32_16x16x32_bf16 a[88:91], a[212:215], v[216:219], a[88:91]
    v_cvt_pk_bf16_f32 v200, v240, v241
    v_cmp_gt_i32 s[50:51], 19, v6
    v_mfma_f32_16x16x32_bf16 a[92:95], a[212:215], v[220:223], a[92:95]
    s_waitcnt lgkmcnt(3)
    v_exp_f32 v243, v139
    v_mfma_f32_16x16x32_bf16 a[108:111], a[216:219], v[220:223], a[108:111]
    s_and_b32 s35, s35, 0xffff
    ds_read_b128 a[140:143], v2 offset:3072
    v_or3_b32 v57, v57, v199, v200
    v_mfma_f32_16x16x32_bf16 a[104:107], a[216:219], v[216:219], a[104:107]
    v_cndmask_b32 v36, v9, v5, s[44:45]
    v_cndmask_b32 v37, v9, v5, s[46:47]
    v_mfma_f32_16x16x32_bf16 a[100:103], a[216:219], v[212:215], a[100:103]
    v_exp_f32 v244, v152
    v_mfma_f32_16x16x32_bf16 a[96:99], a[216:219], v[208:211], a[96:99]
    ds_read_b128 a[144:147], v2 offset:4096
    v_cvt_pk_bf16_f32 v201, v242, v243
    v_mfma_f32_16x16x32_bf16 a[112:115], a[220:223], v[208:211], a[112:115]
    buffer_load_dwordx4 v1, s[20:23], s33 offen offset:2048 sc1 lds
    ds_read_b128 a[148:151], v2 offset:5120
    v_mfma_f32_16x16x32_bf16 a[116:119], a[220:223], v[212:215], a[116:119]
    v_cndmask_b32 v38, v9, v5, s[48:49]
    v_cndmask_b32 v39, v9, v5, s[50:51]
    v_mfma_f32_16x16x32_bf16 a[120:123], a[220:223], v[216:219], a[120:123]
    s_or_b32 s35, s35, 0x10000
    v_exp_f32 v245, v153
    v_mfma_f32_16x16x32_bf16 a[124:127], a[220:223], v[220:223], a[124:127]
    s_waitcnt lgkmcnt(4)
    v_exp_f32 v246, v154
    v_mfma_f32_16x16x32_bf16 v[164:167], a[128:131], v[80:83], v[20:23]
    ds_read_b128 a[152:155], v2 offset:6144
    v_cvt_pk_bf16_f32 v202, v244, v245
    v_mfma_f32_16x16x32_bf16 v[164:167], a[132:135], v[84:87], v[164:167]
    s_waitcnt lgkmcnt(3)
    v_exp_f32 v247, v155
    v_mfma_f32_16x16x32_bf16 v[164:167], a[136:139], v[88:91], v[164:167]
    v_or3_b32 v57, v57, v201, v202
    v_cvt_pk_bf16_f32 v203, v246, v247
    v_mfma_f32_16x16x32_bf16 v[164:167], a[140:143], v[92:95], v[164:167]
    s_add_u32 s36, s36, 32
    v_exp_f32 v232, v140
    v_mfma_f32_16x16x32_bf16 v[168:171], a[140:143], v[108:111], v[24:27]
    ds_read_b128 a[156:159], v2 offset:7168
    v_mfma_f32_16x16x32_bf16 v[168:171], a[136:139], v[104:107], v[168:171]
    v_exp_f32 v233, v141
    v_mfma_f32_16x16x32_bf16 v[168:171], a[132:135], v[100:103], v[168:171]
    s_add_u32 s52, s52, 8192
    v_exp_f32 v234, v142
    v_mfma_f32_16x16x32_bf16 v[168:171], a[128:131], v[96:99], v[168:171]
    ds_read_b128 a[192:195], v3 offset:0
    v_cvt_pk_bf16_f32 v204, v232, v233
    v_mfma_f32_16x16x32_bf16 v[172:175], a[128:131], v[112:115], v[28:31]
    s_and_b32 s52, s52, 0xffff
    v_add_u32 v2, s52, v1
    v_or3_b32 v57, v57, v203, v204
    v_mfma_f32_16x16x32_bf16 v[172:175], a[132:135], v[116:119], v[172:175]
    buffer_load_dwordx4 v1, s[20:23], s33 offen offset:3072 sc1 lds
    s_add_u32 s33, s33, 0x80000
    v_mfma_f32_16x16x32_bf16 v[172:175], a[136:139], v[120:123], v[172:175]
    v_exp_f32 v235, v143
    v_mfma_f32_16x16x32_bf16 v[172:175], a[140:143], v[124:127], v[172:175]
    s_waitcnt lgkmcnt(3)
    ds_read_b128 a[196:199], v3 offset:1024
    s_waitcnt lgkmcnt(2)
    v_mfma_f32_16x16x32_bf16 v[188:191], a[156:159], v[124:127], v[44:47]
    v_exp_f32 v236, v156
    v_mfma_f32_16x16x32_bf16 v[188:191], a[152:155], v[120:123], v[188:191]
    v_cvt_pk_bf16_f32 v205, v234, v235
    v_mfma_f32_16x16x32_bf16 v[188:191], a[148:151], v[116:119], v[188:191]
    v_exp_f32 v237, v157
    v_mfma_f32_16x16x32_bf16 v[188:191], a[144:147], v[112:115], v[188:191]
    ds_read_b128 a[200:203], v3 offset:2048
    v_cvt_pk_bf16_f32 v206, v236, v237
    v_mfma_f32_16x16x32_bf16 v[184:187], a[144:147], v[96:99], v[40:43]
    v_exp_f32 v238, v158
    v_mfma_f32_16x16x32_bf16 v[184:187], a[148:151], v[100:103], v[184:187]
    v_exp_f32 v239, v159
    v_mfma_f32_16x16x32_bf16 v[184:187], a[152:155], v[104:107], v[184:187]
    ds_read_b128 a[204:207], v3 offset:3072
    v_or3_b32 v57, v57, v205, v206
    v_mfma_f32_16x16x32_bf16 v[184:187], a[156:159], v[108:111], v[184:187]
    v_cvt_pk_bf16_f32 v207, v238, v239
    v_mfma_f32_16x16x32_bf16 v[180:183], a[156:159], v[92:95], v[36:39]
    v_mfma_f32_16x16x32_bf16 v[180:183], a[152:155], v[88:91], v[180:183]
    v_bitop3_b32 v57, v57, v207, s37 bitop3:0xa8
    v_cmp_ne_u32 vcc, 0, v57
    v_mfma_f32_16x16x32_bf16 v[180:183], a[148:151], v[84:87], v[180:183]
    v_mfma_f32_16x16x32_bf16 v[180:183], a[144:147], v[80:83], v[180:183]
    s_waitcnt vmcnt(13)
    s_barrier
    s_cbranch_vccnz k2_tramp_100
k2_ret_101:
    v_mfma_f32_16x16x32_bf16 v[48:51], v[60:63], v[196:199], v[48:51]
    ds_read_b128 a[208:211], v3 offset:4096
    ds_read_b128 a[212:215], v3 offset:5120
    v_mfma_f32_16x16x32_bf16 v[248:251], v[60:63], v[200:203], v[248:251]
    s_mov_b32 m0, s34
    v_exp_f32 v232, v164
    v_mfma_f32_16x16x32_bf16 v[252:255], v[60:63], v[204:207], v[252:255]
    s_waitcnt lgkmcnt(4)
    buffer_load_dwordx4 v1, s[16:19], s32 offen offset:0 sc1 lds
    ds_read_b128 a[216:219], v3 offset:6144
    v_mfma_f32_16x16x32_bf16 a[12:15], a[192:195], v[204:207], a[12:15]
    s_add_u32 s53, s53, 8192
    v_exp_f32 v233, v165
    v_mfma_f32_16x16x32_bf16 a[8:11], a[192:195], v[200:203], a[8:11]
    s_and_b32 s53, s53, 0xffff
    v_mov_b32 v16, v10
    v_mov_b32 v17, v10
    v_mfma_f32_16x16x32_bf16 a[4:7], a[192:195], v[196:199], a[4:7]
    s_add_u32 s34, s34, 0x4000
    v_exp_f32 v234, v166
    v_mfma_f32_16x16x32_bf16 a[20:23], a[196:199], v[196:199], a[20:23]
    ds_read_b128 a[220:223], v3 offset:7168
    v_cvt_pk_bf16_f32 v212, v232, v233
    v_mfma_f32_16x16x32_bf16 a[24:27], a[196:199], v[200:203], a[24:27]
    v_mov_b32 v18, v10
    v_mov_b32 v19, v10
    v_mfma_f32_16x16x32_bf16 a[28:31], a[196:199], v[204:207], a[28:31]
    s_waitcnt lgkmcnt(4)
    v_exp_f32 v235, v167
    v_mfma_f32_16x16x32_bf16 a[44:47], a[200:203], v[204:207], a[44:47]
    buffer_load_dwordx4 v1, s[16:19], s32 offen offset:1024 sc1 lds
    ds_read_b128 a[128:131], v2 offset:0
    v_mfma_f32_16x16x32_bf16 a[40:43], a[200:203], v[200:203], a[40:43]
    v_mov_b32 v20, v11
    v_add_u32 v3, s53, v56
    v_mfma_f32_16x16x32_bf16 a[36:39], a[200:203], v[196:199], a[36:39]
    s_and_b32 s34, s34, 0xffff
    v_mov_b32 v21, v11
    v_mov_b32 v22, v11
    v_mfma_f32_16x16x32_bf16 a[52:55], a[204:207], v[196:199], a[52:55]
    v_exp_f32 v236, v180
    v_mfma_f32_16x16x32_bf16 a[56:59], a[204:207], v[200:203], a[56:59]
    ds_read_b128 a[132:135], v2 offset:1024
    v_cvt_pk_bf16_f32 v213, v234, v235
    v_mfma_f32_16x16x32_bf16 a[60:63], a[204:207], v[204:207], a[60:63]
    s_waitcnt lgkmcnt(4)
    v_mov_b32 v23, v11
    v_mov_b32 v32, v10
    v_mfma_f32_16x16x32_bf16 a[76:79], a[208:211], v[204:207], a[76:79]
    v_exp_f32 v237, v181
    v_mfma_f32_16x16x32_bf16 a[72:75], a[208:211], v[200:203], a[72:75]
    ds_read_b128 a[136:139], v2 offset:2048
    v_mov_b32 v33, v10
    v_mfma_f32_16x16x32_bf16 a[68:71], a[208:211], v[196:199], a[68:71]
    buffer_load_dwordx4 v1, s[16:19], s32 offen offset:2048 sc1 lds
    v_mov_b32 v34, v10
    v_mfma_f32_16x16x32_bf16 a[84:87], a[212:215], v[196:199], a[84:87]
    v_exp_f32 v238, v182
    v_mfma_f32_16x16x32_bf16 a[88:91], a[212:215], v[200:203], a[88:91]
    ds_read_b128 a[140:143], v2 offset:3072
    v_cvt_pk_bf16_f32 v214, v236, v237
    v_mfma_f32_16x16x32_bf16 a[92:95], a[212:215], v[204:207], a[92:95]
    s_waitcnt lgkmcnt(4)
    v_mov_b32 v35, v10
    v_mov_b32 v36, v11
    v_mfma_f32_16x16x32_bf16 a[108:111], a[216:219], v[204:207], a[108:111]
    ds_read_b128 a[144:147], v2 offset:4096
    v_exp_f32 v239, v183
    v_mfma_f32_16x16x32_bf16 a[104:107], a[216:219], v[200:203], a[104:107]
    v_mov_b32 v37, v11
    v_or3_b32 v57, v212, v213, v214
    v_mov_b32 v38, v11
    v_mov_b32 v39, v11
    v_mfma_f32_16x16x32_bf16 a[100:103], a[216:219], v[196:199], a[100:103]
    buffer_load_dwordx4 v1, s[16:19], s32 offen offset:3072 sc1 lds
    ds_read_b128 a[148:151], v2 offset:5120
    v_mfma_f32_16x16x32_bf16 a[116:119], a[220:223], v[196:199], a[116:119]
    s_add_u32 s32, s32, 0x80000
    s_cmp_ge_u32 s36, s43
    s_cbranch_scc1 k2_prep_102
k2_prepret_103:
    v_mfma_f32_16x16x32_bf16 a[120:123], a[220:223], v[200:203], a[120:123]
    s_waitcnt vmcnt(9)
    v_exp_f32 v240, v168
    v_mfma_f32_16x16x32_bf16 a[124:127], a[220:223], v[204:207], a[124:127]
    s_waitcnt lgkmcnt(4)
    ds_read_b128 a[152:155], v2 offset:6144
    v_cvt_pk_bf16_f32 v215, v238, v239
    v_mfma_f32_16x16x32_bf16 v[128:131], a[128:131], v[96:99], v[16:19]
    v_exp_f32 v241, v169
    v_mfma_f32_16x16x32_bf16 v[128:131], a[132:135], v[100:103], v[128:131]
    s_waitcnt lgkmcnt(3)
    ds_read_b128 a[156:159], v2 offset:7168
    v_exp_f32 v242, v170
    v_mfma_f32_16x16x32_bf16 v[128:131], a[136:139], v[104:107], v[128:131]
    ds_read_b128 a[160:163], v2 offset:8192
    v_cvt_pk_bf16_f32 v216, v240, v241
    v_mfma_f32_16x16x32_bf16 v[128:131], a[140:143], v[108:111], v[128:131]
    s_add_u32 s36, s36, 64
    buffer_store_dwordx4 a[224:227], v229, s[8:11], s58 offen offset:0 sc1
    v_exp_f32 v243, v171
    v_mfma_f32_16x16x32_bf16 v[132:135], a[140:143], v[124:127], v[20:23]
    ds_read_b128 a[164:167], v2 offset:9216
    v_or3_b32 v57, v57, v215, v216
    v_mfma_f32_16x16x32_bf16 v[132:135], a[136:139], v[120:123], v[132:135]
    v_exp_f32 v244, v184
    v_mfma_f32_16x16x32_bf16 v[132:135], a[132:135], v[116:119], v[132:135]
    s_add_u32 s52, s52, 16384
    ds_read_b128 a[168:171], v2 offset:10240
    v_cvt_pk_bf16_f32 v217, v242, v243
    v_mfma_f32_16x16x32_bf16 v[132:135], a[128:131], v[112:115], v[132:135]
    s_waitcnt lgkmcnt(5)
    v_exp_f32 v245, v185
    v_mfma_f32_16x16x32_bf16 v[148:151], a[144:147], v[112:115], v[36:39]
    s_and_b32 s52, s52, 0xffff
    ds_read_b128 a[172:175], v2 offset:11264
    ds_read_b128 a[176:179], v2 offset:12288
    v_mfma_f32_16x16x32_bf16 v[148:151], a[148:151], v[116:119], v[148:151]
    s_waitcnt lgkmcnt(5)
    v_exp_f32 v246, v186
    v_mfma_f32_16x16x32_bf16 v[148:151], a[152:155], v[120:123], v[148:151]
    ds_read_b128 a[180:183], v2 offset:13312
    v_cvt_pk_bf16_f32 v218, v244, v245
    v_mfma_f32_16x16x32_bf16 v[148:151], a[156:159], v[124:127], v[148:151]
    v_exp_f32 v247, v187
    v_mfma_f32_16x16x32_bf16 v[144:147], a[156:159], v[108:111], v[32:35]
    ds_read_b128 a[184:187], v2 offset:14336
    v_or3_b32 v57, v57, v217, v218
    v_mfma_f32_16x16x32_bf16 v[144:147], a[152:155], v[104:107], v[144:147]
    v_exp_f32 v232, v172
    v_mfma_f32_16x16x32_bf16 v[144:147], a[148:151], v[100:103], v[144:147]
    ds_read_b128 a[188:191], v2 offset:15360
    v_cvt_pk_bf16_f32 v219, v246, v247
    v_mfma_f32_16x16x32_bf16 v[144:147], a[144:147], v[96:99], v[144:147]
    s_waitcnt lgkmcnt(6)
    v_exp_f32 v233, v173
    v_mfma_f32_16x16x32_bf16 v[136:139], a[160:163], v[96:99], v[24:27]
    buffer_store_dwordx4 a[228:231], v229, s[8:11], s58 offen offset:256 sc1
    ds_read_b128 a[192:195], v3 offset:0
    v_mfma_f32_16x16x32_bf16 v[136:139], a[164:167], v[100:103], v[136:139]
    s_waitcnt lgkmcnt(5)
    v_add_u32 v2, s52, v1
    v_cvt_pk_bf16_f32 v220, v232, v233
    v_mfma_f32_16x16x32_bf16 v[136:139], a[168:171], v[104:107], v[136:139]
    v_exp_f32 v234, v174
    v_mfma_f32_16x16x32_bf16 v[136:139], a[172:175], v[108:111], v[136:139]
    v_exp_f32 v235, v175
    v_mfma_f32_16x16x32_bf16 v[140:143], a[172:175], v[124:127], v[28:31]
    ds_read_b128 a[196:199], v3 offset:1024
    v_or3_b32 v57, v57, v219, v220
    v_mfma_f32_16x16x32_bf16 v[140:143], a[168:171], v[120:123], v[140:143]
    v_exp_f32 v236, v188
    v_mfma_f32_16x16x32_bf16 v[140:143], a[164:167], v[116:119], v[140:143]
    ds_read_b128 a[200:203], v3 offset:2048
    v_cvt_pk_bf16_f32 v221, v234, v235
    v_mfma_f32_16x16x32_bf16 v[140:143], a[160:163], v[112:115], v[140:143]
    s_waitcnt lgkmcnt(5)
    v_exp_f32 v237, v189
    v_mfma_f32_16x16x32_bf16 v[156:159], a[176:179], v[112:115], v[44:47]
    v_exp_f32 v238, v190
    v_mfma_f32_16x16x32_bf16 v[156:159], a[180:183], v[116:119], v[156:159]
    s_waitcnt lgkmcnt(3)
    v_cvt_pk_bf16_f32 v222, v236, v237
    v_or3_b32 v57, v57, v221, v222
    v_mfma_f32_16x16x32_bf16 v[156:159], a[184:187], v[120:123], v[156:159]
    v_exp_f32 v239, v191
    v_mfma_f32_16x16x32_bf16 v[156:159], a[188:191], v[124:127], v[156:159]
    ds_read_b128 a[204:207], v3 offset:3072
    v_cvt_pk_bf16_f32 v223, v238, v239
    v_mfma_f32_16x16x32_bf16 v[152:155], a[188:191], v[108:111], v[40:43]
    v_mfma_f32_16x16x32_bf16 v[152:155], a[184:187], v[104:107], v[152:155]
    v_bitop3_b32 v57, v57, v223, s37 bitop3:0xa8
    v_cmp_ne_u32 vcc, 0, v57
    v_mfma_f32_16x16x32_bf16 v[152:155], a[180:183], v[100:103], v[152:155]
    v_mfma_f32_16x16x32_bf16 v[152:155], a[176:179], v[96:99], v[152:155]
    s_cbranch_vccnz k2_tramp_104
k2_ret_105:
    v_mfma_f32_16x16x32_bf16 v[48:51], v[60:63], v[212:215], v[48:51]
    ds_read_b128 a[208:211], v3 offset:4096
    ds_read_b128 a[212:215], v3 offset:5120
    v_mfma_f32_16x16x32_bf16 v[248:251], v[60:63], v[216:219], v[248:251]
    s_mov_b32 m0, s35
    v_exp_f32 v232, v128
    v_mfma_f32_16x16x32_bf16 v[252:255], v[60:63], v[220:223], v[252:255]
    s_waitcnt lgkmcnt(4)
    ds_read_b128 a[216:219], v3 offset:6144
    v_exp_f32 v233, v129
    v_mfma_f32_16x16x32_bf16 a[12:15], a[192:195], v[220:223], a[12:15]
    s_add_u32 s53, s53, 8192
    buffer_load_dwordx4 v1, s[20:23], s33 offen offset:0 sc1 lds
    v_mfma_f32_16x16x32_bf16 a[8:11], a[192:195], v[216:219], a[8:11]
    s_and_b32 s53, s53, 0xffff
    v_exp_f32 v234, v130
    v_cvt_pk_bf16_f32 v192, v232, v233
    v_mfma_f32_16x16x32_bf16 a[4:7], a[192:195], v[212:215], a[4:7]
    ds_read_b128 a[220:223], v3 offset:7168
    v_mfma_f32_16x16x32_bf16 a[20:23], a[196:199], v[212:215], a[20:23]
    s_add_u32 s35, s35, 0x4000
    v_exp_f32 v235, v131
    v_mfma_f32_16x16x32_bf16 a[24:27], a[196:199], v[216:219], a[24:27]
    v_exp_f32 v236, v144
    v_cvt_pk_bf16_f32 v193, v234, v235
    v_mfma_f32_16x16x32_bf16 a[28:31], a[196:199], v[220:223], a[28:31]
    s_waitcnt lgkmcnt(4)
    buffer_load_dwordx4 v1, s[20:23], s33 offen offset:1024 sc1 lds
    ds_read_b128 a[128:131], v2 offset:0
    v_mfma_f32_16x16x32_bf16 a[44:47], a[200:203], v[220:223], a[44:47]
    v_add_u32 v3, s53, v56
    v_exp_f32 v237, v145
    v_mfma_f32_16x16x32_bf16 a[40:43], a[200:203], v[216:219], a[40:43]
    ds_read_b128 a[132:135], v2 offset:1024
    v_cvt_pk_bf16_f32 v194, v236, v237
    v_mfma_f32_16x16x32_bf16 a[36:39], a[200:203], v[212:215], a[36:39]
    ds_read_b128 a[136:139], v2 offset:2048
    v_exp_f32 v238, v146
    v_mfma_f32_16x16x32_bf16 a[52:55], a[204:207], v[212:215], a[52:55]
    s_and_b32 s35, s35, 0xffff
    v_exp_f32 v239, v147
    v_mfma_f32_16x16x32_bf16 a[56:59], a[204:207], v[216:219], a[56:59]
    ds_read_b128 a[140:143], v2 offset:3072
    v_or3_b32 v57, v192, v193, v194
    v_mfma_f32_16x16x32_bf16 a[60:63], a[204:207], v[220:223], a[60:63]
    s_waitcnt lgkmcnt(6)
    v_exp_f32 v240, v132
    v_mfma_f32_16x16x32_bf16 a[76:79], a[208:211], v[220:223], a[76:79]
    s_or_b32 s35, s35, 0x10000
    buffer_load_dwordx4 v1, s[20:23], s33 offen offset:2048 sc1 lds
    ds_read_b128 a[144:147], v2 offset:4096
    v_mfma_f32_16x16x32_bf16 a[72:75], a[208:211], v[216:219], a[72:75]
    v_cvt_pk_bf16_f32 v195, v238, v239
    v_exp_f32 v241, v133
    v_mfma_f32_16x16x32_bf16 a[68:71], a[208:211], v[212:215], a[68:71]
    v_exp_f32 v242, v134
    v_mfma_f32_16x16x32_bf16 a[84:87], a[212:215], v[212:215], a[84:87]
    ds_read_b128 a[148:151], v2 offset:5120
    v_cvt_pk_bf16_f32 v196, v240, v241
    v_mfma_f32_16x16x32_bf16 a[88:91], a[212:215], v[216:219], a[88:91]
    v_exp_f32 v243, v135
    v_mfma_f32_16x16x32_bf16 a[92:95], a[212:215], v[220:223], a[92:95]
    s_waitcnt lgkmcnt(6)
    ds_read_b128 a[152:155], v2 offset:6144
    v_or3_b32 v57, v57, v195, v196
    v_cvt_pk_bf16_f32 v197, v242, v243
    v_mfma_f32_16x16x32_bf16 a[108:111], a[216:219], v[220:223], a[108:111]
    buffer_load_dwordx4 v1, s[20:23], s33 offen offset:3072 sc1 lds
    ds_read_b128 a[156:159], v2 offset:7168
    v_mfma_f32_16x16x32_bf16 a[104:107], a[216:219], v[216:219], a[104:107]
    s_add_u32 s33, s33, 0x80000
    v_exp_f32 v244, v148
    v_mfma_f32_16x16x32_bf16 a[100:103], a[216:219], v[212:215], a[100:103]
    v_exp_f32 v245, v149
    v_mfma_f32_16x16x32_bf16 a[116:119], a[220:223], v[212:215], a[116:119]
    ds_read_b128 a[160:163], v2 offset:8192
    s_cmp_ge_u32 s36, s43
    s_cbranch_scc1 k2_prep_106
k2_prepret_107:
    v_mfma_f32_16x16x32_bf16 a[120:123], a[220:223], v[216:219], a[120:123]
    v_exp_f32 v246, v150
    v_mfma_f32_16x16x32_bf16 a[124:127], a[220:223], v[220:223], a[124:127]
    s_waitcnt lgkmcnt(7)
    ds_read_b128 a[164:167], v2 offset:9216
    v_cvt_pk_bf16_f32 v198, v244, v245
    v_mfma_f32_16x16x32_bf16 v[160:163], a[128:131], v[96:99], v[16:19]
    s_waitcnt vmcnt(12)
    s_barrier
    v_exp_f32 v247, v151
    v_mfma_f32_16x16x32_bf16 v[160:163], a[132:135], v[100:103], v[160:163]
    s_waitcnt lgkmcnt(6)
    v_or3_b32 v57, v57, v197, v198
    v_cvt_pk_bf16_f32 v199, v246, v247
    v_mfma_f32_16x16x32_bf16 v[160:163], a[136:139], v[104:107], v[160:163]
    s_mov_b32 m0, s34
    ds_read_b128 a[168:171], v2 offset:10240
    v_exp_f32 v232, v136
    v_mfma_f32_16x16x32_bf16 v[160:163], a[140:143], v[108:111], v[160:163]
    s_add_u32 s36, s36, 64
    buffer_load_dwordx4 v1, s[16:19], s32 offen offset:0 sc1 lds
    ds_read_b128 a[172:175], v2 offset:11264
    v_mfma_f32_16x16x32_bf16 v[164:167], a[140:143], v[124:127], v[20:23]
    v_exp_f32 v233, v137
    v_mfma_f32_16x16x32_bf16 v[164:167], a[136:139], v[120:123], v[164:167]
    v_exp_f32 v234, v138
    v_mfma_f32_16x16x32_bf16 v[164:167], a[132:135], v[116:119], v[164:167]
    s_add_u32 s52, s52, 16384
    ds_read_b128 a[176:179], v2 offset:12288
    v_cvt_pk_bf16_f32 v200, v232, v233
    v_mfma_f32_16x16x32_bf16 v[164:167], a[128:131], v[112:115], v[164:167]
    s_waitcnt lgkmcnt(7)
    v_exp_f32 v235, v139
    v_or3_b32 v57, v57, v199, v200
    v_mfma_f32_16x16x32_bf16 v[180:183], a[144:147], v[112:115], v[36:39]
    s_add_u32 s34, s34, 0x4000
    ds_read_b128 a[180:183], v2 offset:13312
    v_cvt_pk_bf16_f32 v201, v234, v235
    v_mfma_f32_16x16x32_bf16 v[180:183], a[148:151], v[116:119], v[180:183]
    s_waitcnt lgkmcnt(6)
    v_exp_f32 v236, v152
    v_mfma_f32_16x16x32_bf16 v[180:183], a[152:155], v[120:123], v[180:183]
    s_and_b32 s52, s52, 0xffff
    buffer_load_dwordx4 v1, s[16:19], s32 offen offset:1024 sc1 lds
    ds_read_b128 a[184:187], v2 offset:14336
    v_mfma_f32_16x16x32_bf16 v[180:183], a[156:159], v[124:127], v[180:183]
    ds_read_b128 a[188:191], v2 offset:15360
    v_exp_f32 v237, v153
    v_mfma_f32_16x16x32_bf16 v[176:179], a[156:159], v[108:111], v[32:35]
    v_exp_f32 v238, v154
    v_mfma_f32_16x16x32_bf16 v[176:179], a[152:155], v[104:107], v[176:179]
    v_cvt_pk_bf16_f32 v202, v236, v237
    v_or3_b32 v57, v57, v201, v202
    v_mfma_f32_16x16x32_bf16 v[176:179], a[148:151], v[100:103], v[176:179]
    s_and_b32 s34, s34, 0xffff
    v_exp_f32 v239, v155
    v_mfma_f32_16x16x32_bf16 v[176:179], a[144:147], v[96:99], v[176:179]
    s_waitcnt lgkmcnt(6)
    v_add_u32 v2, s52, v1
    v_cvt_pk_bf16_f32 v203, v238, v239
    v_mfma_f32_16x16x32_bf16 v[168:171], a[160:163], v[96:99], v[24:27]
    ds_read_b128 a[192:195], v3 offset:0
    v_exp_f32 v240, v140
    v_mfma_f32_16x16x32_bf16 v[168:171], a[164:167], v[100:103], v[168:171]
    s_waitcnt lgkmcnt(5)
    v_exp_f32 v241, v141
    v_mfma_f32_16x16x32_bf16 v[168:171], a[168:171], v[104:107], v[168:171]
    buffer_load_dwordx4 v1, s[16:19], s32 offen offset:2048 sc1 lds
    ds_read_b128 a[196:199], v3 offset:8192
    v_mfma_f32_16x16x32_bf16 v[168:171], a[172:175], v[108:111], v[168:171]
    v_exp_f32 v242, v142
    v_mfma_f32_16x16x32_bf16 v[172:175], a[172:175], v[124:127], v[28:31]
    ds_read_b128 a[200:203], v3 offset:1024
    v_cvt_pk_bf16_f32 v204, v240, v241
    v_or3_b32 v57, v57, v203, v204
    v_mfma_f32_16x16x32_bf16 v[172:175], a[168:171], v[120:123], v[172:175]
    v_exp_f32 v243, v143
    v_mfma_f32_16x16x32_bf16 v[172:175], a[164:167], v[116:119], v[172:175]
    ds_read_b128 a[204:207], v3 offset:9216
    v_cvt_pk_bf16_f32 v205, v242, v243
    v_mfma_f32_16x16x32_bf16 v[172:175], a[160:163], v[112:115], v[172:175]
    s_waitcnt lgkmcnt(6)
    v_exp_f32 v244, v156
    v_mfma_f32_16x16x32_bf16 v[188:191], a[176:179], v[112:115], v[44:47]
    v_exp_f32 v245, v157
    v_mfma_f32_16x16x32_bf16 v[188:191], a[180:183], v[116:119], v[188:191]
    s_waitcnt lgkmcnt(4)
    buffer_load_dwordx4 v1, s[16:19], s32 offen offset:3072 sc1 lds
    ds_read_b128 a[208:211], v3 offset:2048
    ds_read_b128 a[212:215], v3 offset:10240
    v_mfma_f32_16x16x32_bf16 v[188:191], a[184:187], v[120:123], v[188:191]
    s_add_u32 s32, s32, 0x80000
    v_exp_f32 v246, v158
    v_mfma_f32_16x16x32_bf16 v[188:191], a[188:191], v[124:127], v[188:191]
    v_cvt_pk_bf16_f32 v206, v244, v245
    v_or3_b32 v57, v57, v205, v206
    v_mfma_f32_16x16x32_bf16 v[184:187], a[188:191], v[108:111], v[40:43]
    v_exp_f32 v247, v159
    v_mfma_f32_16x16x32_bf16 v[184:187], a[184:187], v[104:107], v[184:187]
    ds_read_b128 a[216:219], v3 offset:3072
    ds_read_b128 a[220:223], v3 offset:11264
    v_cvt_pk_bf16_f32 v207, v246, v247
    v_mfma_f32_16x16x32_bf16 v[184:187], a[180:183], v[100:103], v[184:187]
    v_bitop3_b32 v57, v57, v207, s37 bitop3:0xa8
    v_cmp_ne_u32 vcc, 0, v57
    v_mfma_f32_16x16x32_bf16 v[184:187], a[176:179], v[96:99], v[184:187]
    s_cbranch_vccnz k2_tramp_108
k2_ret_109:
    s_load_dwordx2 s[4:5], s[0:1], 40
    s_add_u32 s24, s6, 0x3000000
    s_addc_u32 s25, s7, 0
    s_and_b32 s25, s25, 0xffff
    s_mov_b32 s26, 0x1000000
    s_mov_b32 s27, 0x00020000
    s_lshl_b32 s31, s28, 19
    s_lshl_b32 s44, s38, 6
    s_add_u32 s44, s44, s31
    s_add_u32 s45, s44, 131072
    s_add_u32 s46, s44, 262144
    s_add_u32 s47, s44, 393216
    s_add_u32 s48, s44, 4096
    s_add_u32 s49, s44, 135168
    s_add_u32 s50, s44, 266240
    s_add_u32 s51, s44, 397312
    v_mov_b32 v13, v12
    v_mov_b32 v49, v48
    s_nop 1
    v_permlane16_swap_b32 v12, v13
    v_permlane16_swap_b32 v48, v49
    s_nop 1
    v_add_f32 v12, v12, v13
    v_add_f32 v48, v48, v49
    v_mov_b32 v13, v12
    v_mov_b32 v49, v48
    s_nop 1
    v_permlane32_swap_b32 v12, v13
    v_permlane32_swap_b32 v48, v49
    s_nop 1
    v_add_f32 v12, v12, v13
    v_add_f32 v48, v48, v49
    v_rcp_f32 v13, v12
    v_rcp_f32 v49, v48
    v_rcp_f32 v12, v12
    v_rcp_f32 v48, v48
    s_nop 0
    v_accvgpr_read_b32 v68, a0
    v_accvgpr_read_b32 v69, a1
    v_accvgpr_read_b32 v70, a2
    v_accvgpr_read_b32 v71, a3
    v_accvgpr_read_b32 v72, a16
    v_accvgpr_read_b32 v73, a17
    v_accvgpr_read_b32 v74, a18
    v_accvgpr_read_b32 v75, a19
    v_pk_mul_f32 v[68:69], v[68:69], v[12:13]
    v_pk_mul_f32 v[70:71], v[70:71], v[12:13]
    v_pk_mul_f32 v[72:73], v[72:73], v[12:13]
    v_pk_mul_f32 v[74:75], v[74:75], v[12:13]
    v_cvt_pk_bf16_f32 v64, v68, v69
    v_cvt_pk_bf16_f32 v65, v70, v71
    v_cvt_pk_bf16_f32 v66, v72, v73
    v_cvt_pk_bf16_f32 v67, v74, v75
    buffer_store_dwordx4 v[64:67], v1, s[24:27], s44 offen sc1
    v_accvgpr_read_b32 v80, a32
    v_accvgpr_read_b32 v81, a33
    v_accvgpr_read_b32 v82, a34
    v_accvgpr_read_b32 v83, a35
    v_accvgpr_read_b32 v84, a48
    v_accvgpr_read_b32 v85, a49
    v_accvgpr_read_b32 v86, a50
    v_accvgpr_read_b32 v87, a51
    v_pk_mul_f32 v[80:81], v[80:81], v[12:13]
    v_pk_mul_f32 v[82:83], v[82:83], v[12:13]
    v_pk_mul_f32 v[84:85], v[84:85], v[12:13]
    v_pk_mul_f32 v[86:87], v[86:87], v[12:13]
    v_cvt_pk_bf16_f32 v76, v80, v81
    v_cvt_pk_bf16_f32 v77, v82, v83
    v_cvt_pk_bf16_f32 v78, v84, v85
    v_cvt_pk_bf16_f32 v79, v86, v87
    buffer_store_dwordx4 v[76:79], v1, s[24:27], s45 offen sc1
    v_accvgpr_read_b32 v68, a64
    v_accvgpr_read_b32 v69, a65
    v_accvgpr_read_b32 v70, a66
    v_accvgpr_read_b32 v71, a67
    v_accvgpr_read_b32 v72, a80
    v_accvgpr_read_b32 v73, a81
    v_accvgpr_read_b32 v74, a82
    v_accvgpr_read_b32 v75, a83
    v_pk_mul_f32 v[68:69], v[68:69], v[12:13]
    v_pk_mul_f32 v[70:71], v[70:71], v[12:13]
    v_pk_mul_f32 v[72:73], v[72:73], v[12:13]
    v_pk_mul_f32 v[74:75], v[74:75], v[12:13]
    v_cvt_pk_bf16_f32 v64, v68, v69
    v_cvt_pk_bf16_f32 v65, v70, v71
    v_cvt_pk_bf16_f32 v66, v72, v73
    v_cvt_pk_bf16_f32 v67, v74, v75
    buffer_store_dwordx4 v[64:67], v1, s[24:27], s46 offen sc1
    v_accvgpr_read_b32 v80, a96
    v_accvgpr_read_b32 v81, a97
    v_accvgpr_read_b32 v82, a98
    v_accvgpr_read_b32 v83, a99
    v_accvgpr_read_b32 v84, a112
    v_accvgpr_read_b32 v85, a113
    v_accvgpr_read_b32 v86, a114
    v_accvgpr_read_b32 v87, a115
    v_pk_mul_f32 v[80:81], v[80:81], v[12:13]
    v_pk_mul_f32 v[82:83], v[82:83], v[12:13]
    v_pk_mul_f32 v[84:85], v[84:85], v[12:13]
    v_pk_mul_f32 v[86:87], v[86:87], v[12:13]
    v_cvt_pk_bf16_f32 v76, v80, v81
    v_cvt_pk_bf16_f32 v77, v82, v83
    v_cvt_pk_bf16_f32 v78, v84, v85
    v_cvt_pk_bf16_f32 v79, v86, v87
    buffer_store_dwordx4 v[76:79], v1, s[24:27], s47 offen sc1
    v_accvgpr_read_b32 v68, a4
    v_accvgpr_read_b32 v69, a5
    v_accvgpr_read_b32 v70, a6
    v_accvgpr_read_b32 v71, a7
    v_accvgpr_read_b32 v72, a20
    v_accvgpr_read_b32 v73, a21
    v_accvgpr_read_b32 v74, a22
    v_accvgpr_read_b32 v75, a23
    v_pk_mul_f32 v[68:69], v[68:69], v[48:49]
    v_pk_mul_f32 v[70:71], v[70:71], v[48:49]
    v_pk_mul_f32 v[72:73], v[72:73], v[48:49]
    v_pk_mul_f32 v[74:75], v[74:75], v[48:49]
    v_cvt_pk_bf16_f32 v64, v68, v69
    v_cvt_pk_bf16_f32 v65, v70, v71
    v_cvt_pk_bf16_f32 v66, v72, v73
    v_cvt_pk_bf16_f32 v67, v74, v75
    buffer_store_dwordx4 v[64:67], v1, s[24:27], s48 offen sc1
    v_accvgpr_read_b32 v80, a36
    v_accvgpr_read_b32 v81, a37
    v_accvgpr_read_b32 v82, a38
    v_accvgpr_read_b32 v83, a39
    v_accvgpr_read_b32 v84, a52
    v_accvgpr_read_b32 v85, a53
    v_accvgpr_read_b32 v86, a54
    v_accvgpr_read_b32 v87, a55
    v_pk_mul_f32 v[80:81], v[80:81], v[48:49]
    v_pk_mul_f32 v[82:83], v[82:83], v[48:49]
    v_pk_mul_f32 v[84:85], v[84:85], v[48:49]
    v_pk_mul_f32 v[86:87], v[86:87], v[48:49]
    v_cvt_pk_bf16_f32 v76, v80, v81
    v_cvt_pk_bf16_f32 v77, v82, v83
    v_cvt_pk_bf16_f32 v78, v84, v85
    v_cvt_pk_bf16_f32 v79, v86, v87
    buffer_store_dwordx4 v[76:79], v1, s[24:27], s49 offen sc1
    v_accvgpr_read_b32 v68, a68
    v_accvgpr_read_b32 v69, a69
    v_accvgpr_read_b32 v70, a70
    v_accvgpr_read_b32 v71, a71
    v_accvgpr_read_b32 v72, a84
    v_accvgpr_read_b32 v73, a85
    v_accvgpr_read_b32 v74, a86
    v_accvgpr_read_b32 v75, a87
    v_pk_mul_f32 v[68:69], v[68:69], v[48:49]
    v_pk_mul_f32 v[70:71], v[70:71], v[48:49]
    v_pk_mul_f32 v[72:73], v[72:73], v[48:49]
    v_pk_mul_f32 v[74:75], v[74:75], v[48:49]
    v_cvt_pk_bf16_f32 v64, v68, v69
    v_cvt_pk_bf16_f32 v65, v70, v71
    v_cvt_pk_bf16_f32 v66, v72, v73
    v_cvt_pk_bf16_f32 v67, v74, v75
    buffer_store_dwordx4 v[64:67], v1, s[24:27], s50 offen sc1
    v_accvgpr_read_b32 v80, a100
    v_accvgpr_read_b32 v81, a101
    v_accvgpr_read_b32 v82, a102
    v_accvgpr_read_b32 v83, a103
    v_accvgpr_read_b32 v84, a116
    v_accvgpr_read_b32 v85, a117
    v_accvgpr_read_b32 v86, a118
    v_accvgpr_read_b32 v87, a119
    v_pk_mul_f32 v[80:81], v[80:81], v[48:49]
    v_pk_mul_f32 v[82:83], v[82:83], v[48:49]
    v_pk_mul_f32 v[84:85], v[84:85], v[48:49]
    v_pk_mul_f32 v[86:87], v[86:87], v[48:49]
    v_cvt_pk_bf16_f32 v76, v80, v81
    v_cvt_pk_bf16_f32 v77, v82, v83
    v_cvt_pk_bf16_f32 v78, v84, v85
    v_cvt_pk_bf16_f32 v79, v86, v87
    buffer_store_dwordx4 v[76:79], v1, s[24:27], s51 offen sc1
    s_nop 1
    s_lshr_b32 s31, s2, 3
    s_bfe_u32 s56, s2, 0x10002
    s_and_b32 s54, s2, 1
    s_and_b32 s55, s31, 7
    s_lshl_b32 s54, s54, 3
    s_add_u32 s54, s54, s55
    s_and_b32 s55, s2, 2
    s_lshl_b32 s55, s55, 1
    s_lshr_b32 s31, s31, 3
    s_add_u32 s55, s55, s31
    v_lshrrev_b32 v87, 4, v1
    v_lshrrev_b32 v72, 4, v87
    s_lshl_b32 s57, s54, 7
    s_lshl_b32 s31, s30, 5
    s_add_u32 s57, s57, s31
    s_lshl_b32 s31, s57, 6
    v_add_u32 v88, s31, v1
    v_add_u32 v89, 0x20000, v88
    v_bfe_u32 v84, v87, 1, 3
    v_xor_b32 v84, v84, v72
    v_and_b32 v85, 16, v1
    v_lshl_add_u32 v85, v72, 11, v85
    s_lshl_b32 s31, s30, 15
    s_lshl_b32 s58, s55, 8
    s_add_u32 s31, s31, s58
    v_add_u32 v85, s31, v85
    v_xor_b32 v86, 0, v84
    v_lshl_add_u32 v86, v86, 5, v85
    v_add_u32 v90, 0, v86
    v_xor_b32 v86, 4, v84
    v_lshl_add_u32 v86, v86, 5, v85
    v_add_u32 v91, 7168, v86
    v_xor_b32 v86, 0, v84
    v_lshl_add_u32 v86, v86, 5, v85
    v_add_u32 v92, 14336, v86
    v_xor_b32 v86, 4, v84
    v_lshl_add_u32 v86, v86, 5, v85
    v_add_u32 v93, 21504, v86
    v_and_b32 v84, 15, v87
    v_add_u32 v85, s57, v84
    v_lshlrev_b32 v77, 2, v85
    v_lshl_add_u32 v77, v72, 13, v77
    s_lshl_b32 s31, s56, 7
    s_add_u32 s58, s58, s31
    v_lshl_add_u32 v80, v72, 3, s58
    v_lshl_add_u32 v78, v85, 11, v80
    v_add_u32 v79, 0x8000, v78
    v_lshrrev_b32 v85, 2, v84
    v_lshl_add_u32 v85, v72, 2, v85
    v_and_b32 v84, 7, v85
    s_lshl_b32 s31, s56, 2
    v_xor_b32 v84, s31, v84
    v_lshlrev_b32 v85, 8, v85
    v_and_b32 v86, 3, v87
    v_lshl_add_u32 v85, v86, 3, v85
    s_add_u32 s31, s2, 1
    s_and_b32 s31, s31, 3
    v_add_u32 v73, s31, v86
    v_and_b32 v73, 3, v73
    v_lshlrev_b32 v73, 7, v73
    v_xor_b32 v86, 0, v84
    v_lshl_add_u32 v64, v86, 5, v85
    v_xor_b32 v86, 1, v84
    v_lshl_add_u32 v65, v86, 5, v85
    v_xor_b32 v86, 2, v84
    v_lshl_add_u32 v66, v86, 5, v85
    v_xor_b32 v86, 3, v84
    v_lshl_add_u32 v67, v86, 5, v85
    v_xor_b32 v86, 4, v84
    v_lshl_add_u32 v68, v86, 5, v85
    v_xor_b32 v86, 5, v84
    v_lshl_add_u32 v69, v86, 5, v85
    v_xor_b32 v86, 6, v84
    v_lshl_add_u32 v70, v86, 5, v85
    v_xor_b32 v86, 7, v84
    v_lshl_add_u32 v71, v86, 5, v85
    s_lshl_b32 s61, s31, 20
    s_lshl_b32 s62, s31, 21
    s_lshl_b32 s60, s30, 12
    s_lshl_b32 s59, s54, 10
    s_lshl_b32 s31, s56, 9
    s_add_u32 s59, s59, s31
    s_lshr_b32 s31, s28, 2
    s_lshl_b32 s31, s31, 7
    s_lshl_b32 s57, s29, 10
    s_sub_u32 s58, 0x3c00, s57
    s_add_u32 s57, s57, s31
    s_add_u32 s58, s58, s31
    v_mov_b32 v75, 0
    v_mov_b32 v76, 1
    s_lshl_b32 s31, s56, 23
    s_add_u32 s31, s31, 0x3000000
    s_add_u32 s8, s6, s31
    s_addc_u32 s9, s7, 0
    s_and_b32 s9, s9, 0xffff
    s_mov_b32 s10, 0x800000
    s_lshl_b32 s31, s56, 22
    s_waitcnt lgkmcnt(0)
    s_add_u32 s12, s4, s31
    s_addc_u32 s13, s5, 0
    s_and_b32 s13, s13, 0xffff
    s_mov_b32 s14, 0x400000
    s_load_dwordx2 s[4:5], s[0:1], 80
    v_mov_b32 v12, -1
    v_mov_b32 v13, -1
    v_mov_b32 v14, -1
    v_mov_b32 v15, -1
    s_waitcnt lgkmcnt(0)
    s_mov_b32 s26, -1
    s_lshl_b32 s31, s2, 14
    s_add_u32 s31, s31, s60
    s_add_u32 s40, s31, 0x2000000
    buffer_store_dwordx4 v[12:15], v1, s[24:27], s40 offen offset:0 sc1
    buffer_store_dwordx4 v[12:15], v1, s[24:27], s40 offen offset:1024 sc1
    buffer_store_dwordx4 v[12:15], v1, s[24:27], s40 offen offset:2048 sc1
    buffer_store_dwordx4 v[12:15], v1, s[24:27], s40 offen offset:3072 sc1
    s_lshr_b32 s31, s31, 2
    s_add_u32 s40, s31, 0x1900000
    buffer_store_dwordx4 v[12:15], v1, s[24:27], s40 offen sc1
    s_mov_b32 s26, 0x1000000
    s_and_b32 s31, s2, 7
    s_mul_i32 s31, s31, 28
    s_lshr_b32 s40, s2, 3
    s_add_u32 s31, s31, s40
    s_lshl_b32 s31, s31, 15
    s_lshl_b32 s40, s30, 13
    s_add_u32 s31, s31, s40
    s_mov_b32 s44, s4
    s_mov_b32 s47, 0x00020000
    s_and_b32 s45, s5, 0xffff
    s_cmp_ge_u32 s2, 224
    s_cselect_b32 s46, 0, 7340032
    s_add_u32 m0, s40, 131072
    s_nop 0
    buffer_load_dwordx4 v1, s[44:47], s31 offen offset:0 lds
    buffer_load_dwordx4 v1, s[44:47], s31 offen offset:1024 lds
    buffer_load_dwordx4 v1, s[44:47], s31 offen offset:2048 lds
    buffer_load_dwordx4 v1, s[44:47], s31 offen offset:3072 lds
    s_add_u32 s31, s31, 4096
    s_add_u32 m0, s40, 135168
    s_nop 0
    buffer_load_dwordx4 v1, s[44:47], s31 offen offset:0 lds
    buffer_load_dwordx4 v1, s[44:47], s31 offen offset:1024 lds
    buffer_load_dwordx4 v1, s[44:47], s31 offen offset:2048 lds
    buffer_load_dwordx4 v1, s[44:47], s31 offen offset:3072 lds
    s_add_u32 s31, s31, 4096
    s_lshl_b32 s63, s29, 1
    s_sub_u32 s63, 13, s63
    s_cbranch_scc1 k2_sdone_111
k2_sloop_110:
    v_mfma_f32_16x16x32_bf16 v[248:251], v[60:63], v[192:195], v[248:251]
    v_exp_f32 v232, v160
    v_mfma_f32_16x16x32_bf16 v[248:251], v[60:63], v[200:203], v[248:251]
    s_mov_b32 m0, s35
    ds_read_b128 a[224:227], v3 offset:4096
    v_mfma_f32_16x16x32_bf16 v[252:255], v[60:63], v[204:207], v[252:255]
    s_add_u32 s53, s53, 16384
    buffer_load_dwordx4 v1, s[20:23], s33 offen offset:0 sc1 lds
    ds_read_b128 a[228:231], v3 offset:12288
    v_mfma_f32_16x16x32_bf16 v[252:255], v[60:63], v[196:199], v[252:255]
    s_waitcnt lgkmcnt(8)
    v_exp_f32 v233, v161
    v_mfma_f32_16x16x32_bf16 a[12:15], a[192:195], v[196:199], a[12:15]
    s_and_b32 s53, s53, 0xffff
    v_exp_f32 v234, v162
    v_mfma_f32_16x16x32_bf16 a[12:15], a[196:199], v[204:207], a[12:15]
    ds_read_b128 a[232:235], v3 offset:5120
    v_cvt_pk_bf16_f32 v208, v232, v233
    v_mfma_f32_16x16x32_bf16 a[8:11], a[196:199], v[200:203], a[8:11]
    v_exp_f32 v235, v163
    v_mfma_f32_16x16x32_bf16 a[8:11], a[192:195], v[192:195], a[8:11]
    s_waitcnt lgkmcnt(7)
    ds_read_b128 a[236:239], v3 offset:13312
    v_cvt_pk_bf16_f32 v209, v234, v235
    v_mfma_f32_16x16x32_bf16 a[24:27], a[200:203], v[192:195], a[24:27]
    s_add_u32 s35, s35, 0x4000
    v_exp_f32 v236, v176
    v_mfma_f32_16x16x32_bf16 a[24:27], a[204:207], v[200:203], a[24:27]
    buffer_load_dwordx4 v1, s[20:23], s33 offen offset:1024 sc1 lds
    ds_read_b128 a[240:243], v3 offset:6144
    v_mfma_f32_16x16x32_bf16 a[28:31], a[204:207], v[204:207], a[28:31]
    v_exp_f32 v237, v177
    v_mfma_f32_16x16x32_bf16 a[28:31], a[200:203], v[196:199], a[28:31]
    s_waitcnt lgkmcnt(7)
    ds_read_b128 a[244:247], v3 offset:14336
    v_cvt_pk_bf16_f32 v210, v236, v237
    v_mfma_f32_16x16x32_bf16 a[44:47], a[208:211], v[196:199], a[44:47]
    v_exp_f32 v238, v178
    v_mfma_f32_16x16x32_bf16 a[44:47], a[212:215], v[204:207], a[44:47]
    ds_read_b128 a[248:251], v3 offset:7168
    v_or3_b32 v57, v208, v209, v210
    v_mfma_f32_16x16x32_bf16 a[40:43], a[212:215], v[200:203], a[40:43]
    v_exp_f32 v239, v179
    v_mfma_f32_16x16x32_bf16 a[40:43], a[208:211], v[192:195], a[40:43]
    s_waitcnt lgkmcnt(7)
    ds_read_b128 a[252:255], v3 offset:15360
    v_cvt_pk_bf16_f32 v211, v238, v239
    v_mfma_f32_16x16x32_bf16 a[56:59], a[216:219], v[192:195], a[56:59]
    s_and_b32 s35, s35, 0xffff
    v_exp_f32 v240, v164
    v_mfma_f32_16x16x32_bf16 a[56:59], a[220:223], v[200:203], a[56:59]
    ds_read_b128 a[128:131], v2 offset:0
    v_add_u32 v3, s53, v56
    v_mfma_f32_16x16x32_bf16 a[60:63], a[220:223], v[204:207], a[60:63]
    v_exp_f32 v241, v165
    v_mfma_f32_16x16x32_bf16 a[60:63], a[216:219], v[196:199], a[60:63]
    s_waitcnt lgkmcnt(7)
    buffer_load_dwordx4 v1, s[20:23], s33 offen offset:2048 sc1 lds
    ds_read_b128 a[132:135], v2 offset:1024
    v_mfma_f32_16x16x32_bf16 a[76:79], a[224:227], v[196:199], a[76:79]
    v_exp_f32 v242, v166
    v_mfma_f32_16x16x32_bf16 a[76:79], a[228:231], v[204:207], a[76:79]
    s_or_b32 s35, s35, 0x10000
    ds_read_b128 a[136:139], v2 offset:2048
    v_cvt_pk_bf16_f32 v212, v240, v241
    v_mfma_f32_16x16x32_bf16 a[72:75], a[228:231], v[200:203], a[72:75]
    v_exp_f32 v243, v167
    v_mfma_f32_16x16x32_bf16 a[72:75], a[224:227], v[192:195], a[72:75]
    s_waitcnt lgkmcnt(7)
    ds_read_b128 a[140:143], v2 offset:3072
    v_or3_b32 v57, v57, v211, v212
    v_mfma_f32_16x16x32_bf16 a[88:91], a[232:235], v[192:195], a[88:91]
    v_exp_f32 v244, v180
    v_mfma_f32_16x16x32_bf16 a[88:91], a[236:239], v[200:203], a[88:91]
    ds_read_b128 a[144:147], v2 offset:4096
    v_cvt_pk_bf16_f32 v213, v242, v243
    v_mfma_f32_16x16x32_bf16 a[92:95], a[236:239], v[204:207], a[92:95]
    v_exp_f32 v245, v181
    v_mfma_f32_16x16x32_bf16 a[92:95], a[232:235], v[196:199], a[92:95]
    s_waitcnt lgkmcnt(7)
    buffer_load_dwordx4 v1, s[20:23], s33 offen offset:3072 sc1 lds
    ds_read_b128 a[148:151], v2 offset:5120
    v_mfma_f32_16x16x32_bf16 a[108:111], a[240:243], v[196:199], a[108:111]
    s_add_u32 s33, s33, 0x80000
    v_exp_f32 v246, v182
    v_mfma_f32_16x16x32_bf16 a[108:111], a[244:247], v[204:207], a[108:111]
    ds_read_b128 a[152:155], v2 offset:6144
    v_cvt_pk_bf16_f32 v214, v244, v245
    v_mfma_f32_16x16x32_bf16 a[104:107], a[244:247], v[200:203], a[104:107]
    v_exp_f32 v247, v183
    v_mfma_f32_16x16x32_bf16 a[104:107], a[240:243], v[192:195], a[104:107]
    s_waitcnt lgkmcnt(7)
    ds_read_b128 a[156:159], v2 offset:7168
    v_or3_b32 v57, v57, v213, v214
    v_mfma_f32_16x16x32_bf16 a[120:123], a[248:251], v[192:195], a[120:123]
    v_exp_f32 v232, v168
    v_mfma_f32_16x16x32_bf16 a[120:123], a[252:255], v[200:203], a[120:123]
    ds_read_b128 a[160:163], v2 offset:8192
    v_cvt_pk_bf16_f32 v215, v246, v247
    v_mfma_f32_16x16x32_bf16 a[124:127], a[252:255], v[204:207], a[124:127]
    v_exp_f32 v233, v169
    v_mfma_f32_16x16x32_bf16 a[124:127], a[248:251], v[196:199], a[124:127]
    s_waitcnt lgkmcnt(7)
    ds_read_b128 a[164:167], v2 offset:9216
    v_cvt_pk_bf16_f32 v216, v232, v233
    v_mfma_f32_16x16x32_bf16 v[128:131], a[128:131], v[96:99], v[16:19]
    s_waitcnt vmcnt(12)
    s_barrier
    v_exp_f32 v234, v170
    v_mfma_f32_16x16x32_bf16 v[128:131], a[132:135], v[100:103], v[128:131]
    s_waitcnt lgkmcnt(6)
    ds_read_b128 a[168:171], v2 offset:10240
    v_or3_b32 v57, v57, v215, v216
    v_mfma_f32_16x16x32_bf16 v[128:131], a[136:139], v[104:107], v[128:131]
    s_mov_b32 m0, s34
    v_exp_f32 v235, v171
    v_mfma_f32_16x16x32_bf16 v[128:131], a[140:143], v[108:111], v[128:131]
    s_add_u32 s36, s36, 64
    buffer_load_dwordx4 v1, s[16:19], s32 offen offset:0 sc1 lds
    ds_read_b128 a[172:175], v2 offset:11264
    v_mfma_f32_16x16x32_bf16 v[132:135], a[140:143], v[124:127], v[20:23]
    v_exp_f32 v236, v184
    v_mfma_f32_16x16x32_bf16 v[132:135], a[136:139], v[120:123], v[132:135]
    ds_read_b128 a[176:179], v2 offset:12288
    v_cvt_pk_bf16_f32 v217, v234, v235
    v_mfma_f32_16x16x32_bf16 v[132:135], a[132:135], v[116:119], v[132:135]
    s_add_u32 s52, s52, 16384
    v_exp_f32 v237, v185
    v_mfma_f32_16x16x32_bf16 v[132:135], a[128:131], v[112:115], v[132:135]
    s_waitcnt lgkmcnt(7)
    ds_read_b128 a[180:183], v2 offset:13312
    v_cvt_pk_bf16_f32 v218, v236, v237
    v_mfma_f32_16x16x32_bf16 v[148:151], a[144:147], v[112:115], v[36:39]
    s_add_u32 s34, s34, 0x4000
    v_exp_f32 v238, v186
    v_mfma_f32_16x16x32_bf16 v[148:151], a[148:151], v[116:119], v[148:151]
    s_waitcnt lgkmcnt(6)
    buffer_load_dwordx4 v1, s[16:19], s32 offen offset:1024 sc1 lds
    ds_read_b128 a[184:187], v2 offset:14336
    v_mfma_f32_16x16x32_bf16 v[148:151], a[152:155], v[120:123], v[148:151]
    s_and_b32 s52, s52, 0xffff
    v_exp_f32 v239, v187
    v_mfma_f32_16x16x32_bf16 v[148:151], a[156:159], v[124:127], v[148:151]
    ds_read_b128 a[188:191], v2 offset:15360
    v_or3_b32 v57, v57, v217, v218
    v_mfma_f32_16x16x32_bf16 v[144:147], a[156:159], v[108:111], v[32:35]
    v_exp_f32 v240, v172
    v_mfma_f32_16x16x32_bf16 v[144:147], a[152:155], v[104:107], v[144:147]
    v_cvt_pk_bf16_f32 v219, v238, v239
    v_add_u32 v2, s52, v1
    v_mfma_f32_16x16x32_bf16 v[144:147], a[148:151], v[100:103], v[144:147]
    s_and_b32 s34, s34, 0xffff
    v_exp_f32 v241, v173
    v_mfma_f32_16x16x32_bf16 v[144:147], a[144:147], v[96:99], v[144:147]
    s_waitcnt lgkmcnt(6)
    ds_read_b128 a[192:195], v3 offset:0
    v_cvt_pk_bf16_f32 v220, v240, v241
    v_mfma_f32_16x16x32_bf16 v[136:139], a[160:163], v[96:99], v[24:27]
    v_exp_f32 v242, v174
    v_mfma_f32_16x16x32_bf16 v[136:139], a[164:167], v[100:103], v[136:139]
    s_waitcnt lgkmcnt(5)
    buffer_load_dwordx4 v1, s[16:19], s32 offen offset:2048 sc1 lds
    ds_read_b128 a[196:199], v3 offset:8192
    v_mfma_f32_16x16x32_bf16 v[136:139], a[168:171], v[104:107], v[136:139]
    v_exp_f32 v243, v175
    v_mfma_f32_16x16x32_bf16 v[136:139], a[172:175], v[108:111], v[136:139]
    ds_read_b128 a[200:203], v3 offset:1024
    v_or3_b32 v57, v57, v219, v220
    v_mfma_f32_16x16x32_bf16 v[140:143], a[172:175], v[124:127], v[28:31]
    v_exp_f32 v244, v188
    v_mfma_f32_16x16x32_bf16 v[140:143], a[168:171], v[120:123], v[140:143]
    ds_read_b128 a[204:207], v3 offset:9216
    v_cvt_pk_bf16_f32 v221, v242, v243
    v_mfma_f32_16x16x32_bf16 v[140:143], a[164:167], v[116:119], v[140:143]
    v_exp_f32 v245, v189
    v_mfma_f32_16x16x32_bf16 v[140:143], a[160:163], v[112:115], v[140:143]
    s_waitcnt lgkmcnt(6)
    buffer_load_dwordx4 v1, s[16:19], s32 offen offset:3072 sc1 lds
    ds_read_b128 a[208:211], v3 offset:2048
    v_mfma_f32_16x16x32_bf16 v[156:159], a[176:179], v[112:115], v[44:47]
    s_add_u32 s32, s32, 0x80000
    v_exp_f32 v246, v190
    v_mfma_f32_16x16x32_bf16 v[156:159], a[180:183], v[116:119], v[156:159]
    s_waitcnt lgkmcnt(5)
    ds_read_b128 a[212:215], v3 offset:10240
    v_cvt_pk_bf16_f32 v222, v244, v245
    v_mfma_f32_16x16x32_bf16 v[156:159], a[184:187], v[120:123], v[156:159]
    v_exp_f32 v247, v191
    v_mfma_f32_16x16x32_bf16 v[156:159], a[188:191], v[124:127], v[156:159]
    ds_read_b128 a[216:219], v3 offset:3072
    v_or3_b32 v57, v57, v221, v222
    v_mfma_f32_16x16x32_bf16 v[152:155], a[188:191], v[108:111], v[40:43]
    ds_read_b128 a[220:223], v3 offset:11264
    v_cvt_pk_bf16_f32 v223, v246, v247
    v_mfma_f32_16x16x32_bf16 v[152:155], a[184:187], v[104:107], v[152:155]
    v_bitop3_b32 v57, v57, v223, s37 bitop3:0xa8
    v_cmp_ne_u32 vcc, 0, v57
    v_mfma_f32_16x16x32_bf16 v[152:155], a[180:183], v[100:103], v[152:155]
    v_mfma_f32_16x16x32_bf16 v[152:155], a[176:179], v[96:99], v[152:155]
    s_cbranch_vccnz k2_tramp_112
k2_ret_113:
    v_mfma_f32_16x16x32_bf16 v[248:251], v[60:63], v[208:211], v[248:251]
    v_exp_f32 v232, v128
    v_mfma_f32_16x16x32_bf16 v[248:251], v[60:63], v[216:219], v[248:251]
    s_mov_b32 m0, s35
    ds_read_b128 a[224:227], v3 offset:4096
    v_mfma_f32_16x16x32_bf16 v[252:255], v[60:63], v[220:223], v[252:255]
    s_add_u32 s53, s53, 16384
    buffer_load_dwordx4 v1, s[20:23], s33 offen offset:0 sc1 lds
    ds_read_b128 a[228:231], v3 offset:12288
    v_mfma_f32_16x16x32_bf16 v[252:255], v[60:63], v[212:215], v[252:255]
    s_waitcnt lgkmcnt(8)
    v_exp_f32 v233, v129
    v_mfma_f32_16x16x32_bf16 a[12:15], a[192:195], v[212:215], a[12:15]
    s_and_b32 s53, s53, 0xffff
    v_exp_f32 v234, v130
    v_mfma_f32_16x16x32_bf16 a[12:15], a[196:199], v[220:223], a[12:15]
    ds_read_b128 a[232:235], v3 offset:5120
    v_cvt_pk_bf16_f32 v192, v232, v233
    v_mfma_f32_16x16x32_bf16 a[8:11], a[196:199], v[216:219], a[8:11]
    v_exp_f32 v235, v131
    v_mfma_f32_16x16x32_bf16 a[8:11], a[192:195], v[208:211], a[8:11]
    s_waitcnt lgkmcnt(7)
    ds_read_b128 a[236:239], v3 offset:13312
    v_cvt_pk_bf16_f32 v193, v234, v235
    v_mfma_f32_16x16x32_bf16 a[24:27], a[200:203], v[208:211], a[24:27]
    s_add_u32 s35, s35, 0x4000
    v_exp_f32 v236, v144
    v_mfma_f32_16x16x32_bf16 a[24:27], a[204:207], v[216:219], a[24:27]
    buffer_load_dwordx4 v1, s[20:23], s33 offen offset:1024 sc1 lds
    ds_read_b128 a[240:243], v3 offset:6144
    v_mfma_f32_16x16x32_bf16 a[28:31], a[204:207], v[220:223], a[28:31]
    v_exp_f32 v237, v145
    v_mfma_f32_16x16x32_bf16 a[28:31], a[200:203], v[212:215], a[28:31]
    s_waitcnt lgkmcnt(7)
    ds_read_b128 a[244:247], v3 offset:14336
    v_cvt_pk_bf16_f32 v194, v236, v237
    v_mfma_f32_16x16x32_bf16 a[44:47], a[208:211], v[212:215], a[44:47]
    v_exp_f32 v238, v146
    v_mfma_f32_16x16x32_bf16 a[44:47], a[212:215], v[220:223], a[44:47]
    ds_read_b128 a[248:251], v3 offset:7168
    v_or3_b32 v57, v192, v193, v194
    v_mfma_f32_16x16x32_bf16 a[40:43], a[212:215], v[216:219], a[40:43]
    v_exp_f32 v239, v147
    v_mfma_f32_16x16x32_bf16 a[40:43], a[208:211], v[208:211], a[40:43]
    s_waitcnt lgkmcnt(7)
    ds_read_b128 a[252:255], v3 offset:15360
    v_cvt_pk_bf16_f32 v195, v238, v239
    v_mfma_f32_16x16x32_bf16 a[56:59], a[216:219], v[208:211], a[56:59]
    s_and_b32 s35, s35, 0xffff
    v_exp_f32 v240, v132
    v_mfma_f32_16x16x32_bf16 a[56:59], a[220:223], v[216:219], a[56:59]
    ds_read_b128 a[128:131], v2 offset:0
    v_add_u32 v3, s53, v56
    v_mfma_f32_16x16x32_bf16 a[60:63], a[220:223], v[220:223], a[60:63]
    v_exp_f32 v241, v133
    v_mfma_f32_16x16x32_bf16 a[60:63], a[216:219], v[212:215], a[60:63]
    s_waitcnt lgkmcnt(7)
    buffer_load_dwordx4 v1, s[20:23], s33 offen offset:2048 sc1 lds
    ds_read_b128 a[132:135], v2 offset:1024
    v_mfma_f32_16x16x32_bf16 a[76:79], a[224:227], v[212:215], a[76:79]
    v_exp_f32 v242, v134
    v_mfma_f32_16x16x32_bf16 a[76:79], a[228:231], v[220:223], a[76:79]
    s_or_b32 s35, s35, 0x10000
    ds_read_b128 a[136:139], v2 offset:2048
    v_cvt_pk_bf16_f32 v196, v240, v241
    v_mfma_f32_16x16x32_bf16 a[72:75], a[228:231], v[216:219], a[72:75]
    v_exp_f32 v243, v135
    v_mfma_f32_16x16x32_bf16 a[72:75], a[224:227], v[208:211], a[72:75]
    s_waitcnt lgkmcnt(7)
    ds_read_b128 a[140:143], v2 offset:3072
    v_or3_b32 v57, v57, v195, v196
    v_mfma_f32_16x16x32_bf16 a[88:91], a[232:235], v[208:211], a[88:91]
    v_exp_f32 v244, v148
    v_mfma_f32_16x16x32_bf16 a[88:91], a[236:239], v[216:219], a[88:91]
    ds_read_b128 a[144:147], v2 offset:4096
    v_cvt_pk_bf16_f32 v197, v242, v243
    v_mfma_f32_16x16x32_bf16 a[92:95], a[236:239], v[220:223], a[92:95]
    v_exp_f32 v245, v149
    v_mfma_f32_16x16x32_bf16 a[92:95], a[232:235], v[212:215], a[92:95]
    s_waitcnt lgkmcnt(7)
    buffer_load_dwordx4 v1, s[20:23], s33 offen offset:3072 sc1 lds
    ds_read_b128 a[148:151], v2 offset:5120
    v_mfma_f32_16x16x32_bf16 a[108:111], a[240:243], v[212:215], a[108:111]
    s_add_u32 s33, s33, 0x80000
    v_exp_f32 v246, v150
    v_mfma_f32_16x16x32_bf16 a[108:111], a[244:247], v[220:223], a[108:111]
    ds_read_b128 a[152:155], v2 offset:6144
    v_cvt_pk_bf16_f32 v198, v244, v245
    v_mfma_f32_16x16x32_bf16 a[104:107], a[244:247], v[216:219], a[104:107]
    v_exp_f32 v247, v151
    v_mfma_f32_16x16x32_bf16 a[104:107], a[240:243], v[208:211], a[104:107]
    s_waitcnt lgkmcnt(7)
    ds_read_b128 a[156:159], v2 offset:7168
    v_or3_b32 v57, v57, v197, v198
    v_mfma_f32_16x16x32_bf16 a[120:123], a[248:251], v[208:211], a[120:123]
    v_exp_f32 v232, v136
    v_mfma_f32_16x16x32_bf16 a[120:123], a[252:255], v[216:219], a[120:123]
    ds_read_b128 a[160:163], v2 offset:8192
    v_cvt_pk_bf16_f32 v199, v246, v247
    v_mfma_f32_16x16x32_bf16 a[124:127], a[252:255], v[220:223], a[124:127]
    v_exp_f32 v233, v137
    v_mfma_f32_16x16x32_bf16 a[124:127], a[248:251], v[212:215], a[124:127]
    s_waitcnt lgkmcnt(7)
    ds_read_b128 a[164:167], v2 offset:9216
    v_cvt_pk_bf16_f32 v200, v232, v233
    v_mfma_f32_16x16x32_bf16 v[160:163], a[128:131], v[96:99], v[16:19]
    s_waitcnt vmcnt(12)
    s_barrier
    v_exp_f32 v234, v138
    v_mfma_f32_16x16x32_bf16 v[160:163], a[132:135], v[100:103], v[160:163]
    s_waitcnt lgkmcnt(6)
    ds_read_b128 a[168:171], v2 offset:10240
    v_or3_b32 v57, v57, v199, v200
    v_mfma_f32_16x16x32_bf16 v[160:163], a[136:139], v[104:107], v[160:163]
    s_mov_b32 m0, s34
    v_exp_f32 v235, v139
    v_mfma_f32_16x16x32_bf16 v[160:163], a[140:143], v[108:111], v[160:163]
    s_add_u32 s36, s36, 64
    buffer_load_dwordx4 v1, s[16:19], s32 offen offset:0 sc1 lds
    ds_read_b128 a[172:175], v2 offset:11264
    v_mfma_f32_16x16x32_bf16 v[164:167], a[140:143], v[124:127], v[20:23]
    v_exp_f32 v236, v152
    v_mfma_f32_16x16x32_bf16 v[164:167], a[136:139], v[120:123], v[164:167]
    ds_read_b128 a[176:179], v2 offset:12288
    v_cvt_pk_bf16_f32 v201, v234, v235
    v_mfma_f32_16x16x32_bf16 v[164:167], a[132:135], v[116:119], v[164:167]
    s_add_u32 s52, s52, 16384
    v_exp_f32 v237, v153
    v_mfma_f32_16x16x32_bf16 v[164:167], a[128:131], v[112:115], v[164:167]
    s_waitcnt lgkmcnt(7)
    ds_read_b128 a[180:183], v2 offset:13312
    v_cvt_pk_bf16_f32 v202, v236, v237
    v_mfma_f32_16x16x32_bf16 v[180:183], a[144:147], v[112:115], v[36:39]
    s_add_u32 s34, s34, 0x4000
    v_exp_f32 v238, v154
    v_mfma_f32_16x16x32_bf16 v[180:183], a[148:151], v[116:119], v[180:183]
    s_waitcnt lgkmcnt(6)
    buffer_load_dwordx4 v1, s[16:19], s32 offen offset:1024 sc1 lds
    ds_read_b128 a[184:187], v2 offset:14336
    v_mfma_f32_16x16x32_bf16 v[180:183], a[152:155], v[120:123], v[180:183]
    s_and_b32 s52, s52, 0xffff
    v_exp_f32 v239, v155
    v_mfma_f32_16x16x32_bf16 v[180:183], a[156:159], v[124:127], v[180:183]
    ds_read_b128 a[188:191], v2 offset:15360
    v_or3_b32 v57, v57, v201, v202
    v_mfma_f32_16x16x32_bf16 v[176:179], a[156:159], v[108:111], v[32:35]
    v_exp_f32 v240, v140
    v_mfma_f32_16x16x32_bf16 v[176:179], a[152:155], v[104:107], v[176:179]
    v_cvt_pk_bf16_f32 v203, v238, v239
    v_add_u32 v2, s52, v1
    v_mfma_f32_16x16x32_bf16 v[176:179], a[148:151], v[100:103], v[176:179]
    s_and_b32 s34, s34, 0xffff
    v_exp_f32 v241, v141
    v_mfma_f32_16x16x32_bf16 v[176:179], a[144:147], v[96:99], v[176:179]
    s_waitcnt lgkmcnt(6)
    ds_read_b128 a[192:195], v3 offset:0
    v_cvt_pk_bf16_f32 v204, v240, v241
    v_mfma_f32_16x16x32_bf16 v[168:171], a[160:163], v[96:99], v[24:27]
    v_exp_f32 v242, v142
    v_mfma_f32_16x16x32_bf16 v[168:171], a[164:167], v[100:103], v[168:171]
    s_waitcnt lgkmcnt(5)
    buffer_load_dwordx4 v1, s[16:19], s32 offen offset:2048 sc1 lds
    ds_read_b128 a[196:199], v3 offset:8192
    v_mfma_f32_16x16x32_bf16 v[168:171], a[168:171], v[104:107], v[168:171]
    v_exp_f32 v243, v143
    v_mfma_f32_16x16x32_bf16 v[168:171], a[172:175], v[108:111], v[168:171]
    ds_read_b128 a[200:203], v3 offset:1024
    v_or3_b32 v57, v57, v203, v204
    v_mfma_f32_16x16x32_bf16 v[172:175], a[172:175], v[124:127], v[28:31]
    v_exp_f32 v244, v156
    v_mfma_f32_16x16x32_bf16 v[172:175], a[168:171], v[120:123], v[172:175]
    ds_read_b128 a[204:207], v3 offset:9216
    v_cvt_pk_bf16_f32 v205, v242, v243
    v_mfma_f32_16x16x32_bf16 v[172:175], a[164:167], v[116:119], v[172:175]
    v_exp_f32 v245, v157
    v_mfma_f32_16x16x32_bf16 v[172:175], a[160:163], v[112:115], v[172:175]
    s_waitcnt lgkmcnt(6)
    buffer_load_dwordx4 v1, s[16:19], s32 offen offset:3072 sc1 lds
    ds_read_b128 a[208:211], v3 offset:2048
    v_mfma_f32_16x16x32_bf16 v[188:191], a[176:179], v[112:115], v[44:47]
    s_sub_u32 s63, s63, 1
    v_exp_f32 v246, v158
    v_mfma_f32_16x16x32_bf16 v[188:191], a[180:183], v[116:119], v[188:191]
    s_waitcnt lgkmcnt(5)
    ds_read_b128 a[212:215], v3 offset:10240
    v_cvt_pk_bf16_f32 v206, v244, v245
    v_mfma_f32_16x16x32_bf16 v[188:191], a[184:187], v[120:123], v[188:191]
    s_add_u32 s32, s32, 0x80000
    v_exp_f32 v247, v159
    v_mfma_f32_16x16x32_bf16 v[188:191], a[188:191], v[124:127], v[188:191]
    ds_read_b128 a[216:219], v3 offset:3072
    v_or3_b32 v57, v57, v205, v206
    v_mfma_f32_16x16x32_bf16 v[184:187], a[188:191], v[108:111], v[40:43]
    ds_read_b128 a[220:223], v3 offset:11264
    v_cvt_pk_bf16_f32 v207, v246, v247
    v_mfma_f32_16x16x32_bf16 v[184:187], a[184:187], v[104:107], v[184:187]
    v_bitop3_b32 v57, v57, v207, s37 bitop3:0xa8
    v_cmp_ne_u32 vcc, 0, v57
    v_mfma_f32_16x16x32_bf16 v[184:187], a[180:183], v[100:103], v[184:187]
    v_mfma_f32_16x16x32_bf16 v[184:187], a[176:179], v[96:99], v[184:187]
    s_cbranch_vccnz k2_tramp_114
k2_ret_115:
    s_cmp_lg_u32 s63, 0
    s_cbranch_scc1 k2_sloop_110
    v_mfma_f32_16x16x32_bf16 v[248:251], v[60:63], v[192:195], v[248:251]
    v_exp_f32 v232, v160
    v_mfma_f32_16x16x32_bf16 v[248:251], v[60:63], v[200:203], v[248:251]
    s_mov_b32 m0, s35
    ds_read_b128 a[224:227], v3 offset:4096
    v_exp_f32 v233, v161
    v_mfma_f32_16x16x32_bf16 v[252:255], v[60:63], v[204:207], v[252:255]
    s_add_u32 s53, s53, 16384
    buffer_load_dwordx4 v1, s[20:23], s33 offen offset:0 sc1 lds
    ds_read_b128 a[228:231], v3 offset:12288
    v_mfma_f32_16x16x32_bf16 v[252:255], v[60:63], v[196:199], v[252:255]
    s_waitcnt lgkmcnt(8)
    v_exp_f32 v234, v162
    v_cvt_pk_bf16_f32 v208, v232, v233
    v_mfma_f32_16x16x32_bf16 a[12:15], a[192:195], v[196:199], a[12:15]
    s_sub_u32 s40, s36, s39
    ds_read_b128 a[232:235], v3 offset:5120
    v_mfma_f32_16x16x32_bf16 a[12:15], a[196:199], v[204:207], a[12:15]
    s_and_b32 s53, s53, 0xffff
    v_subrev_u32 v6, s40, v4
    v_cmp_gt_i32 s[44:45], 0, v6
    v_mfma_f32_16x16x32_bf16 a[8:11], a[196:199], v[200:203], a[8:11]
    v_exp_f32 v235, v163
    v_cmp_gt_i32 s[46:47], 1, v6
    v_mfma_f32_16x16x32_bf16 a[8:11], a[192:195], v[192:195], a[8:11]
    s_waitcnt lgkmcnt(7)
    ds_read_b128 a[236:239], v3 offset:13312
    v_cmp_gt_i32 s[48:49], 2, v6
    v_cmp_gt_i32 s[50:51], 3, v6
    v_mfma_f32_16x16x32_bf16 a[24:27], a[200:203], v[192:195], a[24:27]
    s_add_u32 s35, s35, 0x4000
    v_exp_f32 v236, v176
    v_mfma_f32_16x16x32_bf16 a[24:27], a[204:207], v[200:203], a[24:27]
    ds_read_b128 a[240:243], v3 offset:6144
    v_cvt_pk_bf16_f32 v209, v234, v235
    v_cndmask_b32 v16, v10, v5, s[44:45]
    v_mfma_f32_16x16x32_bf16 a[28:31], a[204:207], v[204:207], a[28:31]
    v_exp_f32 v237, v177
    v_mfma_f32_16x16x32_bf16 a[28:31], a[200:203], v[196:199], a[28:31]
    s_waitcnt lgkmcnt(7)
    ds_read_b128 a[244:247], v3 offset:14336
    v_cndmask_b32 v17, v10, v5, s[46:47]
    v_cndmask_b32 v18, v10, v5, s[48:49]
    v_mfma_f32_16x16x32_bf16 a[44:47], a[208:211], v[196:199], a[44:47]
    buffer_load_dwordx4 v1, s[20:23], s33 offen offset:1024 sc1 lds
    ds_read_b128 a[248:251], v3 offset:7168
    v_mfma_f32_16x16x32_bf16 a[44:47], a[212:215], v[204:207], a[44:47]
    v_cndmask_b32 v19, v10, v5, s[50:51]
    v_cvt_pk_bf16_f32 v210, v236, v237
    v_mfma_f32_16x16x32_bf16 a[40:43], a[212:215], v[200:203], a[40:43]
    v_exp_f32 v238, v178
    v_cmp_gt_i32 s[44:45], 16, v6
    v_mfma_f32_16x16x32_bf16 a[40:43], a[208:211], v[192:195], a[40:43]
    s_waitcnt lgkmcnt(7)
    v_cmp_gt_i32 s[46:47], 17, v6
    v_cmp_gt_i32 s[48:49], 18, v6
    v_mfma_f32_16x16x32_bf16 a[56:59], a[216:219], v[192:195], a[56:59]
    s_and_b32 s35, s35, 0xffff
    v_exp_f32 v239, v179
    v_mfma_f32_16x16x32_bf16 a[56:59], a[220:223], v[200:203], a[56:59]
    ds_read_b128 a[252:255], v3 offset:15360
    v_or3_b32 v57, v208, v209, v210
    v_cmp_gt_i32 s[50:51], 19, v6
    v_mfma_f32_16x16x32_bf16 a[60:63], a[220:223], v[204:207], a[60:63]
    v_exp_f32 v240, v164
    v_mfma_f32_16x16x32_bf16 a[60:63], a[216:219], v[196:199], a[60:63]
    s_waitcnt lgkmcnt(6)
    v_cndmask_b32 v32, v10, v5, s[44:45]
    v_cvt_pk_bf16_f32 v211, v238, v239
    v_cndmask_b32 v33, v10, v5, s[46:47]
    v_mfma_f32_16x16x32_bf16 a[76:79], a[224:227], v[196:199], a[76:79]
    ds_read_b128 a[128:131], v2 offset:0
    v_cndmask_b32 v34, v10, v5, s[48:49]
    v_mfma_f32_16x16x32_bf16 a[76:79], a[228:231], v[204:207], a[76:79]
    s_or_b32 s35, s35, 0x10000
    v_add_u32 v3, s53, v56
    v_cndmask_b32 v35, v10, v5, s[50:51]
    v_mfma_f32_16x16x32_bf16 a[72:75], a[228:231], v[200:203], a[72:75]
    buffer_load_dwordx4 v1, s[20:23], s33 offen offset:2048 sc1 lds
    v_exp_f32 v241, v165
    v_mfma_f32_16x16x32_bf16 a[72:75], a[224:227], v[192:195], a[72:75]
    s_waitcnt lgkmcnt(5)
    ds_read_b128 a[132:135], v2 offset:1024
    v_cmp_gt_i32 s[44:45], 32, v6
    v_mfma_f32_16x16x32_bf16 a[88:91], a[232:235], v[192:195], a[88:91]
    v_exp_f32 v242, v166
    v_cmp_gt_i32 s[46:47], 33, v6
    v_mfma_f32_16x16x32_bf16 a[88:91], a[236:239], v[200:203], a[88:91]
    ds_read_b128 a[136:139], v2 offset:2048
    v_cvt_pk_bf16_f32 v212, v240, v241
    v_mfma_f32_16x16x32_bf16 a[92:95], a[236:239], v[204:207], a[92:95]
    v_cmp_gt_i32 s[48:49], 34, v6
    v_cmp_gt_i32 s[50:51], 35, v6
    v_mfma_f32_16x16x32_bf16 a[92:95], a[232:235], v[196:199], a[92:95]
    s_waitcnt lgkmcnt(5)
    v_exp_f32 v243, v167
    v_or3_b32 v57, v57, v211, v212
    v_mfma_f32_16x16x32_bf16 a[108:111], a[240:243], v[196:199], a[108:111]
    ds_read_b128 a[140:143], v2 offset:3072
    v_cndmask_b32 v24, v10, v5, s[44:45]
    v_mfma_f32_16x16x32_bf16 a[108:111], a[244:247], v[204:207], a[108:111]
    v_cndmask_b32 v25, v10, v5, s[46:47]
    v_exp_f32 v244, v180
    v_mfma_f32_16x16x32_bf16 a[104:107], a[244:247], v[200:203], a[104:107]
    v_cvt_pk_bf16_f32 v213, v242, v243
    v_cndmask_b32 v26, v10, v5, s[48:49]
    v_mfma_f32_16x16x32_bf16 a[104:107], a[240:243], v[192:195], a[104:107]
    s_waitcnt lgkmcnt(4)
    ds_read_b128 a[144:147], v2 offset:4096
    v_cndmask_b32 v27, v10, v5, s[50:51]
    v_mfma_f32_16x16x32_bf16 a[120:123], a[248:251], v[192:195], a[120:123]
    v_exp_f32 v245, v181
    v_cmp_gt_i32 s[44:45], 48, v6
    v_mfma_f32_16x16x32_bf16 a[120:123], a[252:255], v[200:203], a[120:123]
    buffer_load_dwordx4 v1, s[20:23], s33 offen offset:3072 sc1 lds
    ds_read_b128 a[148:151], v2 offset:5120
    ds_read_b128 a[152:155], v2 offset:6144
    v_cmp_gt_i32 s[46:47], 49, v6
    s_add_u32 s33, s33, 0x80000
    v_cmp_gt_i32 s[48:49], 50, v6
    v_exp_f32 v246, v182
    v_cvt_pk_bf16_f32 v214, v244, v245
    v_cmp_gt_i32 s[50:51], 51, v6
    v_cndmask_b32 v40, v10, v5, s[44:45]
    v_mfma_f32_16x16x32_bf16 a[124:127], a[252:255], v[204:207], a[124:127]
    v_exp_f32 v247, v183
    v_or3_b32 v57, v57, v213, v214
    v_cndmask_b32 v41, v10, v5, s[46:47]
    v_mfma_f32_16x16x32_bf16 a[124:127], a[248:251], v[196:199], a[124:127]
    s_waitcnt lgkmcnt(5)
    ds_read_b128 a[156:159], v2 offset:7168
    v_cndmask_b32 v42, v10, v5, s[48:49]
    v_cndmask_b32 v43, v10, v5, s[50:51]
    v_mfma_f32_16x16x32_bf16 v[128:131], a[128:131], v[96:99], v[16:19]
    s_waitcnt vmcnt(4)
    s_barrier
    v_exp_f32 v232, v168
    v_mfma_f32_16x16x32_bf16 v[128:131], a[132:135], v[100:103], v[128:131]
    s_waitcnt lgkmcnt(4)
    ds_read_b128 a[160:163], v2 offset:8192
    v_cvt_pk_bf16_f32 v215, v246, v247
    v_mfma_f32_16x16x32_bf16 v[128:131], a[136:139], v[104:107], v[128:131]
    v_exp_f32 v233, v169
    v_mfma_f32_16x16x32_bf16 v[128:131], a[140:143], v[108:111], v[128:131]
    s_add_u32 s36, s36, 64
    ds_read_b128 a[164:167], v2 offset:9216
    v_cvt_pk_bf16_f32 v216, v232, v233
    v_mfma_f32_16x16x32_bf16 v[132:135], a[140:143], v[124:127], v[20:23]
    v_exp_f32 v234, v170
    v_mfma_f32_16x16x32_bf16 v[132:135], a[136:139], v[120:123], v[132:135]
    ds_read_b128 a[168:171], v2 offset:10240
    v_or3_b32 v57, v57, v215, v216
    v_mfma_f32_16x16x32_bf16 v[132:135], a[132:135], v[116:119], v[132:135]
    s_add_u32 s52, s52, 16384
    v_exp_f32 v235, v171
    v_mfma_f32_16x16x32_bf16 v[132:135], a[128:131], v[112:115], v[132:135]
    s_waitcnt lgkmcnt(5)
    ds_read_b128 a[172:175], v2 offset:11264
    v_cvt_pk_bf16_f32 v217, v234, v235
    v_mfma_f32_16x16x32_bf16 v[148:151], a[144:147], v[112:115], v[36:39]
    s_and_b32 s52, s52, 0xffff
    v_exp_f32 v236, v184
    v_mfma_f32_16x16x32_bf16 v[148:151], a[148:151], v[116:119], v[148:151]
    s_waitcnt lgkmcnt(4)
    ds_read_b128 a[176:179], v2 offset:12288
    ds_read_b128 a[180:183], v2 offset:13312
    v_mfma_f32_16x16x32_bf16 v[148:151], a[152:155], v[120:123], v[148:151]
    v_exp_f32 v237, v185
    v_mfma_f32_16x16x32_bf16 v[148:151], a[156:159], v[124:127], v[148:151]
    v_exp_f32 v238, v186
    v_mfma_f32_16x16x32_bf16 v[144:147], a[156:159], v[108:111], v[32:35]
    ds_read_b128 a[184:187], v2 offset:14336
    v_cvt_pk_bf16_f32 v218, v236, v237
    v_mfma_f32_16x16x32_bf16 v[144:147], a[152:155], v[104:107], v[144:147]
    v_exp_f32 v239, v187
    v_mfma_f32_16x16x32_bf16 v[144:147], a[148:151], v[100:103], v[144:147]
    ds_read_b128 a[188:191], v2 offset:15360
    v_or3_b32 v57, v57, v217, v218
    v_mfma_f32_16x16x32_bf16 v[144:147], a[144:147], v[96:99], v[144:147]
    s_waitcnt lgkmcnt(6)
    v_exp_f32 v240, v172
    v_mfma_f32_16x16x32_bf16 v[136:139], a[160:163], v[96:99], v[24:27]
    v_cvt_pk_bf16_f32 v219, v238, v239
    v_add_u32 v2, s52, v1
    v_mfma_f32_16x16x32_bf16 v[136:139], a[164:167], v[100:103], v[136:139]
    s_waitcnt lgkmcnt(4)
    v_exp_f32 v241, v173
    v_mfma_f32_16x16x32_bf16 v[136:139], a[168:171], v[104:107], v[136:139]
    ds_read_b128 a[192:195], v3 offset:0
    v_cvt_pk_bf16_f32 v220, v240, v241
    v_mfma_f32_16x16x32_bf16 v[136:139], a[172:175], v[108:111], v[136:139]
    v_exp_f32 v242, v174
    v_mfma_f32_16x16x32_bf16 v[140:143], a[172:175], v[124:127], v[28:31]
    ds_read_b128 a[196:199], v3 offset:8192
    v_or3_b32 v57, v57, v219, v220
    v_mfma_f32_16x16x32_bf16 v[140:143], a[168:171], v[120:123], v[140:143]
    v_exp_f32 v243, v175
    v_mfma_f32_16x16x32_bf16 v[140:143], a[164:167], v[116:119], v[140:143]
    ds_read_b128 a[200:203], v3 offset:1024
    v_cvt_pk_bf16_f32 v221, v242, v243
    v_mfma_f32_16x16x32_bf16 v[140:143], a[160:163], v[112:115], v[140:143]
    s_waitcnt lgkmcnt(5)
    v_exp_f32 v244, v188
    v_mfma_f32_16x16x32_bf16 v[156:159], a[176:179], v[112:115], v[44:47]
    ds_read_b128 a[204:207], v3 offset:9216
    ds_read_b128 a[208:211], v3 offset:2048
    v_mfma_f32_16x16x32_bf16 v[156:159], a[180:183], v[116:119], v[156:159]
    s_waitcnt lgkmcnt(5)
    v_exp_f32 v245, v189
    v_mfma_f32_16x16x32_bf16 v[156:159], a[184:187], v[120:123], v[156:159]
    v_exp_f32 v246, v190
    v_mfma_f32_16x16x32_bf16 v[156:159], a[188:191], v[124:127], v[156:159]
    ds_read_b128 a[212:215], v3 offset:10240
    v_cvt_pk_bf16_f32 v222, v244, v245
    v_mfma_f32_16x16x32_bf16 v[152:155], a[188:191], v[108:111], v[40:43]
    v_exp_f32 v247, v191
    v_mfma_f32_16x16x32_bf16 v[152:155], a[184:187], v[104:107], v[152:155]
    ds_read_b128 a[216:219], v3 offset:3072
    v_or3_b32 v57, v57, v221, v222
    v_mfma_f32_16x16x32_bf16 v[152:155], a[180:183], v[100:103], v[152:155]
    ds_read_b128 a[220:223], v3 offset:11264
    v_cvt_pk_bf16_f32 v223, v246, v247
    v_bitop3_b32 v57, v57, v223, s37 bitop3:0xa8
    v_mfma_f32_16x16x32_bf16 v[152:155], a[176:179], v[96:99], v[152:155]
    v_cmp_ne_u32 vcc, 0, v57
    s_cbranch_vccnz k2_tramp_116
k2_ret_117:
    v_mfma_f32_16x16x32_bf16 v[248:251], v[60:63], v[208:211], v[248:251]
    ds_read_b128 a[224:227], v3 offset:4096
    v_exp_f32 v232, v128
    v_mfma_f32_16x16x32_bf16 v[248:251], v[60:63], v[216:219], v[248:251]
    v_exp_f32 v233, v129
    v_mfma_f32_16x16x32_bf16 v[252:255], v[60:63], v[220:223], v[252:255]
    s_add_u32 s53, s53, 16384
    ds_read_b128 a[228:231], v3 offset:12288
    v_exp_f32 v234, v130
    v_mfma_f32_16x16x32_bf16 v[252:255], v[60:63], v[212:215], v[252:255]
    s_waitcnt lgkmcnt(8)
    v_cvt_pk_bf16_f32 v192, v232, v233
    v_exp_f32 v235, v131
    v_mfma_f32_16x16x32_bf16 a[12:15], a[192:195], v[212:215], a[12:15]
    s_sub_u32 s40, s36, s39
    s_sub_u32 s40, s40, 64
    ds_read_b128 a[232:235], v3 offset:5120
    v_mfma_f32_16x16x32_bf16 a[12:15], a[196:199], v[220:223], a[12:15]
    s_and_b32 s53, s53, 0xffff
    v_subrev_u32 v6, s40, v4
    v_cmp_gt_i32 s[44:45], 0, v6
    v_cvt_pk_bf16_f32 v193, v234, v235
    v_mfma_f32_16x16x32_bf16 a[8:11], a[196:199], v[216:219], a[8:11]
    v_exp_f32 v236, v144
    v_cmp_gt_i32 s[46:47], 1, v6
    v_mfma_f32_16x16x32_bf16 a[8:11], a[192:195], v[208:211], a[8:11]
    s_waitcnt lgkmcnt(7)
    ds_read_b128 a[236:239], v3 offset:13312
    v_exp_f32 v237, v145
    v_mfma_f32_16x16x32_bf16 a[24:27], a[200:203], v[208:211], a[24:27]
    ds_read_b128 a[240:243], v3 offset:6144
    v_cmp_gt_i32 s[48:49], 2, v6
    v_cmp_gt_i32 s[50:51], 3, v6
    v_mfma_f32_16x16x32_bf16 a[24:27], a[204:207], v[216:219], a[24:27]
    v_exp_f32 v238, v146
    v_cndmask_b32 v20, v11, v5, s[44:45]
    v_mfma_f32_16x16x32_bf16 a[28:31], a[204:207], v[220:223], a[28:31]
    v_cvt_pk_bf16_f32 v194, v236, v237
    v_cndmask_b32 v21, v11, v5, s[46:47]
    v_or3_b32 v57, v192, v193, v194
    v_mfma_f32_16x16x32_bf16 a[28:31], a[200:203], v[212:215], a[28:31]
    s_waitcnt lgkmcnt(7)
    v_exp_f32 v239, v147
    v_cndmask_b32 v22, v11, v5, s[48:49]
    v_mfma_f32_16x16x32_bf16 a[44:47], a[208:211], v[212:215], a[44:47]
    ds_read_b128 a[244:247], v3 offset:14336
    v_cndmask_b32 v23, v11, v5, s[50:51]
    v_cvt_pk_bf16_f32 v195, v238, v239
    v_mfma_f32_16x16x32_bf16 a[44:47], a[212:215], v[220:223], a[44:47]
    v_exp_f32 v240, v132
    v_cmp_gt_i32 s[44:45], 16, v6
    v_mfma_f32_16x16x32_bf16 a[40:43], a[212:215], v[216:219], a[40:43]
    ds_read_b128 a[248:251], v3 offset:7168
    v_cmp_gt_i32 s[46:47], 17, v6
    v_cmp_gt_i32 s[48:49], 18, v6
    v_mfma_f32_16x16x32_bf16 a[40:43], a[208:211], v[208:211], a[40:43]
    s_waitcnt lgkmcnt(7)
    ds_read_b128 a[252:255], v3 offset:15360
    v_exp_f32 v241, v133
    v_mfma_f32_16x16x32_bf16 a[56:59], a[216:219], v[208:211], a[56:59]
    v_exp_f32 v242, v134
    v_cmp_gt_i32 s[50:51], 19, v6
    v_mfma_f32_16x16x32_bf16 a[56:59], a[220:223], v[216:219], a[56:59]
    v_cvt_pk_bf16_f32 v196, v240, v241
    v_cndmask_b32 v36, v11, v5, s[44:45]
    v_or3_b32 v57, v57, v195, v196
    v_mfma_f32_16x16x32_bf16 a[60:63], a[220:223], v[220:223], a[60:63]
    v_exp_f32 v243, v135
    v_cndmask_b32 v37, v11, v5, s[46:47]
    v_mfma_f32_16x16x32_bf16 a[60:63], a[216:219], v[212:215], a[60:63]
    s_waitcnt lgkmcnt(6)
    ds_read_b128 a[128:131], v2 offset:0
    v_cndmask_b32 v38, v11, v5, s[48:49]
    v_add_u32 v3, s53, v56
    v_mfma_f32_16x16x32_bf16 a[76:79], a[224:227], v[212:215], a[76:79]
    ds_read_b128 a[132:135], v2 offset:1024
    v_exp_f32 v244, v148
    v_mfma_f32_16x16x32_bf16 a[76:79], a[228:231], v[220:223], a[76:79]
    ds_read_b128 a[136:139], v2 offset:2048
    v_cvt_pk_bf16_f32 v197, v242, v243
    v_cndmask_b32 v39, v11, v5, s[50:51]
    v_mfma_f32_16x16x32_bf16 a[72:75], a[228:231], v[216:219], a[72:75]
    v_cmp_gt_i32 s[44:45], 32, v6
    v_exp_f32 v245, v149
    v_mfma_f32_16x16x32_bf16 a[72:75], a[224:227], v[208:211], a[72:75]
    s_waitcnt lgkmcnt(7)
    ds_read_b128 a[140:143], v2 offset:3072
    ds_read_b128 a[144:147], v2 offset:4096
    v_cmp_gt_i32 s[46:47], 33, v6
    v_mfma_f32_16x16x32_bf16 a[88:91], a[232:235], v[208:211], a[88:91]
    v_exp_f32 v246, v150
    v_cmp_gt_i32 s[48:49], 34, v6
    v_mfma_f32_16x16x32_bf16 a[88:91], a[236:239], v[216:219], a[88:91]
    ds_read_b128 a[148:151], v2 offset:5120
    v_cvt_pk_bf16_f32 v198, v244, v245
    v_cmp_gt_i32 s[50:51], 35, v6
    v_mfma_f32_16x16x32_bf16 a[92:95], a[236:239], v[220:223], a[92:95]
    v_exp_f32 v247, v151
    v_or3_b32 v57, v57, v197, v198
    v_mfma_f32_16x16x32_bf16 a[92:95], a[232:235], v[212:215], a[92:95]
    s_waitcnt lgkmcnt(8)
    ds_read_b128 a[152:155], v2 offset:6144
    v_cndmask_b32 v28, v11, v5, s[44:45]
    v_cndmask_b32 v29, v11, v5, s[46:47]
    v_mfma_f32_16x16x32_bf16 a[108:111], a[240:243], v[212:215], a[108:111]
    ds_read_b128 a[156:159], v2 offset:7168
    v_exp_f32 v232, v136
    v_mfma_f32_16x16x32_bf16 a[108:111], a[244:247], v[220:223], a[108:111]
    ds_read_b128 a[160:163], v2 offset:8192
    v_cvt_pk_bf16_f32 v199, v246, v247
    v_cndmask_b32 v30, v11, v5, s[48:49]
    v_mfma_f32_16x16x32_bf16 a[104:107], a[244:247], v[216:219], a[104:107]
    v_cndmask_b32 v31, v11, v5, s[50:51]
    v_exp_f32 v233, v137
    v_mfma_f32_16x16x32_bf16 a[104:107], a[240:243], v[208:211], a[104:107]
    s_waitcnt lgkmcnt(9)
    ds_read_b128 a[164:167], v2 offset:9216
    ds_read_b128 a[168:171], v2 offset:10240
    v_cmp_gt_i32 s[44:45], 48, v6
    v_mfma_f32_16x16x32_bf16 a[120:123], a[248:251], v[208:211], a[120:123]
    v_exp_f32 v234, v138
    v_cmp_gt_i32 s[46:47], 49, v6
    v_mfma_f32_16x16x32_bf16 a[120:123], a[252:255], v[216:219], a[120:123]
    ds_read_b128 a[172:175], v2 offset:11264
    ds_read_b128 a[176:179], v2 offset:12288
    v_cvt_pk_bf16_f32 v200, v232, v233
    v_cmp_gt_i32 s[48:49], 50, v6
    v_exp_f32 v235, v139
    v_cmp_gt_i32 s[50:51], 51, v6
    v_or3_b32 v57, v57, v199, v200
    v_cndmask_b32 v44, v11, v5, s[44:45]
    v_mfma_f32_16x16x32_bf16 a[124:127], a[252:255], v[220:223], a[124:127]
    ds_read_b128 a[180:183], v2 offset:13312
    v_exp_f32 v236, v152
    v_cvt_pk_bf16_f32 v201, v234, v235
    v_cndmask_b32 v45, v11, v5, s[46:47]
    v_mfma_f32_16x16x32_bf16 a[124:127], a[248:251], v[212:215], a[124:127]
    s_waitcnt lgkmcnt(12)
    ds_read_b128 a[184:187], v2 offset:14336
    v_cndmask_b32 v46, v11, v5, s[48:49]
    v_cndmask_b32 v47, v11, v5, s[50:51]
    v_mfma_f32_16x16x32_bf16 v[164:167], a[128:131], v[112:115], v[20:23]
    v_exp_f32 v237, v153
    v_mfma_f32_16x16x32_bf16 v[164:167], a[132:135], v[116:119], v[164:167]
    s_waitcnt lgkmcnt(11)
    ds_read_b128 a[188:191], v2 offset:15360
    v_exp_f32 v238, v154
    v_mfma_f32_16x16x32_bf16 v[164:167], a[136:139], v[120:123], v[164:167]
    v_cvt_pk_bf16_f32 v202, v236, v237
    v_exp_f32 v239, v155
    v_mfma_f32_16x16x32_bf16 v[164:167], a[140:143], v[124:127], v[164:167]
    s_waitcnt lgkmcnt(10)
    s_waitcnt lgkmcnt(8)
    v_or3_b32 v57, v57, v201, v202
    v_mfma_f32_16x16x32_bf16 v[180:183], a[156:159], v[124:127], v[36:39]
    s_add_u32 s36, s36, 64
    ds_read_b128 a[192:195], v3 offset:0
    v_exp_f32 v240, v140
    v_mfma_f32_16x16x32_bf16 v[180:183], a[152:155], v[120:123], v[180:183]
    ds_read_b128 a[196:199], v3 offset:8192
    v_cvt_pk_bf16_f32 v203, v238, v239
    v_mfma_f32_16x16x32_bf16 v[180:183], a[148:151], v[116:119], v[180:183]
    s_add_u32 s52, s52, 16384
    ds_read_b128 a[200:203], v3 offset:1024
    v_exp_f32 v241, v141
    v_mfma_f32_16x16x32_bf16 v[180:183], a[144:147], v[112:115], v[180:183]
    s_waitcnt lgkmcnt(9)
    v_exp_f32 v242, v142
    v_cvt_pk_bf16_f32 v204, v240, v241
    v_mfma_f32_16x16x32_bf16 v[172:175], a[160:163], v[112:115], v[28:31]
    s_and_b32 s52, s52, 0xffff
    v_add_u32 v2, s52, v1
    v_exp_f32 v243, v143
    v_mfma_f32_16x16x32_bf16 v[172:175], a[164:167], v[116:119], v[172:175]
    s_waitcnt lgkmcnt(7)
    ds_read_b128 a[204:207], v3 offset:9216
    v_or3_b32 v57, v57, v203, v204
    v_cvt_pk_bf16_f32 v205, v242, v243
    v_mfma_f32_16x16x32_bf16 v[172:175], a[168:171], v[120:123], v[172:175]
    ds_read_b128 a[208:211], v3 offset:2048
    v_exp_f32 v244, v156
    v_mfma_f32_16x16x32_bf16 v[172:175], a[172:175], v[124:127], v[172:175]
    s_waitcnt lgkmcnt(7)
    s_waitcnt lgkmcnt(5)
    v_exp_f32 v245, v157
    v_mfma_f32_16x16x32_bf16 v[188:191], a[188:191], v[124:127], v[44:47]
    ds_read_b128 a[212:215], v3 offset:10240
    v_exp_f32 v246, v158
    v_mfma_f32_16x16x32_bf16 v[188:191], a[184:187], v[120:123], v[188:191]
    v_cvt_pk_bf16_f32 v206, v244, v245
    v_exp_f32 v247, v159
    v_mfma_f32_16x16x32_bf16 v[188:191], a[180:183], v[116:119], v[188:191]
    ds_read_b128 a[216:219], v3 offset:3072
    v_or3_b32 v57, v57, v205, v206
    v_cvt_pk_bf16_f32 v207, v246, v247
    v_mfma_f32_16x16x32_bf16 v[188:191], a[176:179], v[112:115], v[188:191]
    ds_read_b128 a[220:223], v3 offset:11264
    v_bitop3_b32 v57, v57, v207, s37 bitop3:0xa8
    v_cmp_ne_u32 vcc, 0, v57
    s_cbranch_vccnz k2_tramp_118
k2_ret_119:
k2_sdone_111:
    s_add_u32 s16, s6, 0x4811000
    s_addc_u32 s17, s7, 0
    s_and_b32 s17, s17, 0xffff
    s_mov_b32 s18, 0x4000
    s_mov_b32 s19, 0x00020000
    v_mfma_f32_16x16x32_bf16 v[248:251], v[60:63], v[192:195], v[248:251]
    s_waitcnt vmcnt(0)
    s_barrier
    v_exp_f32 v232, v164
    v_mfma_f32_16x16x32_bf16 v[248:251], v[60:63], v[200:203], v[248:251]
    ds_read_b128 a[224:227], v3 offset:4096
    s_cmp_eq_u32 s30, 0
    s_cbranch_scc1 k12_ool_122
k12_oolret_123:
    v_mfma_f32_16x16x32_bf16 v[252:255], v[60:63], v[204:207], v[252:255]
    s_add_u32 m0, s60, 0
    v_exp_f32 v233, v165
    v_mfma_f32_16x16x32_bf16 v[252:255], v[60:63], v[196:199], v[252:255]
    s_waitcnt lgkmcnt(7)
    buffer_load_dwordx4 v90, s[12:15], s61 offen offset:0 lds
    ds_read_b128 a[228:231], v3 offset:12288
    v_mfma_f32_16x16x32_bf16 a[12:15], a[192:195], v[196:199], a[12:15]
    s_add_u32 s53, s53, 16384
    v_exp_f32 v234, v166
    v_cvt_pk_bf16_f32 v212, v232, v233
    v_mfma_f32_16x16x32_bf16 a[12:15], a[196:199], v[204:207], a[12:15]
    s_and_b32 s53, s53, 0xffff
    buffer_load_dwordx4 v91, s[12:15], s61 offen offset:1024 lds
    ds_read_b128 a[232:235], v3 offset:5120
    v_mfma_f32_16x16x32_bf16 a[8:11], a[196:199], v[200:203], a[8:11]
    ds_read_b128 a[236:239], v3 offset:13312
    v_exp_f32 v235, v167
    v_mfma_f32_16x16x32_bf16 a[8:11], a[192:195], v[192:195], a[8:11]
    s_waitcnt lgkmcnt(8)
    v_exp_f32 v236, v180
    v_mfma_f32_16x16x32_bf16 a[24:27], a[200:203], v[192:195], a[24:27]
    buffer_load_dwordx4 v92, s[12:15], s61 offen offset:2048 lds
    ds_read_b128 a[240:243], v3 offset:6144
    v_mfma_f32_16x16x32_bf16 a[24:27], a[204:207], v[200:203], a[24:27]
    v_cvt_pk_bf16_f32 v213, v234, v235
    v_exp_f32 v237, v181
    v_mfma_f32_16x16x32_bf16 a[28:31], a[204:207], v[204:207], a[28:31]
    buffer_load_dwordx4 v93, s[12:15], s61 offen offset:3072 lds
    ds_read_b128 a[244:247], v3 offset:14336
    v_mfma_f32_16x16x32_bf16 a[28:31], a[200:203], v[196:199], a[28:31]
    s_waitcnt lgkmcnt(8)
    v_exp_f32 v238, v182
    v_cvt_pk_bf16_f32 v214, v236, v237
    v_mfma_f32_16x16x32_bf16 a[44:47], a[208:211], v[196:199], a[44:47]
    s_add_u32 s61, s61, 0x20000
    s_and_b32 s61, s61, 0x3fffff
    ds_read_b128 a[248:251], v3 offset:7168
    v_mfma_f32_16x16x32_bf16 a[44:47], a[212:215], v[204:207], a[44:47]
    s_add_u32 m0, s60, 16384
    v_exp_f32 v239, v183
    v_or3_b32 v57, v212, v213, v214
    v_mfma_f32_16x16x32_bf16 a[40:43], a[212:215], v[200:203], a[40:43]
    buffer_load_dwordx4 v90, s[12:15], s61 offen offset:0 lds
    buffer_load_dwordx4 v91, s[12:15], s61 offen offset:1024 lds
    ds_read_b128 a[252:255], v3 offset:15360
    v_mfma_f32_16x16x32_bf16 a[40:43], a[208:211], v[192:195], a[40:43]
    s_waitcnt lgkmcnt(8)
    v_exp_f32 v240, v172
    v_cvt_pk_bf16_f32 v215, v238, v239
    v_mfma_f32_16x16x32_bf16 a[56:59], a[216:219], v[192:195], a[56:59]
    v_mfma_f32_16x16x32_bf16 a[56:59], a[220:223], v[200:203], a[56:59]
    v_add_u32 v3, s53, v56
    ds_read_b128 a[192:195], v3 offset:0
    v_mfma_f32_16x16x32_bf16 a[60:63], a[220:223], v[204:207], a[60:63]
    ds_read_b128 a[196:199], v3 offset:8192
    v_exp_f32 v241, v173
    v_mfma_f32_16x16x32_bf16 a[60:63], a[216:219], v[196:199], a[60:63]
    s_waitcnt lgkmcnt(8)
    buffer_load_dwordx4 v92, s[12:15], s61 offen offset:2048 lds
    buffer_load_dwordx4 v93, s[12:15], s61 offen offset:3072 lds
    ds_read_b128 a[200:203], v3 offset:1024
    v_mfma_f32_16x16x32_bf16 a[76:79], a[224:227], v[196:199], a[76:79]
    v_exp_f32 v242, v174
    v_cvt_pk_bf16_f32 v220, v240, v241
    v_mfma_f32_16x16x32_bf16 a[76:79], a[228:231], v[204:207], a[76:79]
    ds_read_b128 a[204:207], v3 offset:9216
    ds_read_b128 a[208:211], v3 offset:2048
    v_or3_b32 v57, v57, v215, v220
    v_mfma_f32_16x16x32_bf16 a[72:75], a[228:231], v[200:203], a[72:75]
    s_add_u32 s61, s61, 0x20000
    s_and_b32 s61, s61, 0x3fffff
    ds_read_b128 a[212:215], v3 offset:10240
    v_exp_f32 v243, v175
    v_mfma_f32_16x16x32_bf16 a[72:75], a[224:227], v[192:195], a[72:75]
    s_waitcnt lgkmcnt(10)
    ds_read_b128 a[216:219], v3 offset:3072
    s_add_u32 m0, s60, 32768
    v_mfma_f32_16x16x32_bf16 a[88:91], a[232:235], v[192:195], a[88:91]
    buffer_load_dwordx4 v90, s[12:15], s61 offen offset:0 lds
    ds_read_b128 a[220:223], v3 offset:11264
    v_mfma_f32_16x16x32_bf16 a[88:91], a[236:239], v[200:203], a[88:91]
    v_exp_f32 v244, v188
    v_cvt_pk_bf16_f32 v221, v242, v243
    v_mfma_f32_16x16x32_bf16 a[92:95], a[236:239], v[204:207], a[92:95]
    buffer_load_dwordx4 v91, s[12:15], s61 offen offset:1024 lds
    ds_read_b128 a[224:227], v3 offset:4096
    v_mfma_f32_16x16x32_bf16 a[92:95], a[232:235], v[196:199], a[92:95]
    s_waitcnt lgkmcnt(11)
    ds_read_b128 a[228:231], v3 offset:12288
    v_exp_f32 v245, v189
    v_mfma_f32_16x16x32_bf16 a[108:111], a[240:243], v[196:199], a[108:111]
    buffer_load_dwordx4 v92, s[12:15], s61 offen offset:2048 lds
    ds_read_b128 a[232:235], v3 offset:5120
    v_mfma_f32_16x16x32_bf16 a[108:111], a[244:247], v[204:207], a[108:111]
    v_exp_f32 v246, v190
    v_mfma_f32_16x16x32_bf16 a[104:107], a[244:247], v[200:203], a[104:107]
    ds_read_b128 a[236:239], v3 offset:13312
    v_cvt_pk_bf16_f32 v222, v244, v245
    v_or3_b32 v57, v57, v221, v222
    v_mfma_f32_16x16x32_bf16 a[104:107], a[240:243], v[192:195], a[104:107]
    s_waitcnt lgkmcnt(12)
    v_exp_f32 v247, v191
    v_mfma_f32_16x16x32_bf16 a[120:123], a[248:251], v[192:195], a[120:123]
    buffer_load_dwordx4 v93, s[12:15], s61 offen offset:3072 lds
    ds_read_b128 a[240:243], v3 offset:6144
    ds_read_b128 a[244:247], v3 offset:14336
    v_mfma_f32_16x16x32_bf16 a[120:123], a[252:255], v[200:203], a[120:123]
    s_add_u32 s61, s61, 0x20000
    s_and_b32 s61, s61, 0x3fffff
    v_cvt_pk_bf16_f32 v223, v246, v247
    v_bitop3_b32 v57, v57, v223, s37 bitop3:0xa8
    v_mfma_f32_16x16x32_bf16 a[124:127], a[252:255], v[204:207], a[124:127]
    v_cmp_ne_u32 vcc, 0, v57
    v_mfma_f32_16x16x32_bf16 a[124:127], a[248:251], v[196:199], a[124:127]
    buffer_load_dword v74, v73, s[16:19], s59 offen sc1
    ds_read_b128 a[248:251], v3 offset:7168
    ds_read_b128 a[252:255], v3 offset:15360
    s_cbranch_vccnz k2_tramp_120
k2_ret_121:
    v_lshrrev_b32 v6, 4, v1
    v_and_b32 v6, 31, v6
    s_getpc_b64 s[40:41]
pc_124:
    s_add_u32 s40, s40, op_head-pc_124
    s_addc_u32 s41, s41, 0
    v_lshlrev_b32 v224, 7, v6
    v_mov_b32 v225, s41
    v_add_co_u32 v224, vcc, s40, v224
    s_nop 1
    v_addc_co_u32 v225, vcc, 0, v225, vcc
    global_load_dword v7, v[224:225], off
    v_mfma_f32_16x16x32_bf16 v[252:255], v[60:63], v[212:215], v[252:255]
    s_lshl_b32 s31, s28, 19
    v_mov_b32 v249, v248
    s_nop 1
    v_permlane16_swap_b32 v248, v249
    v_mfma_f32_16x16x32_bf16 v[252:255], v[60:63], v[220:223], v[252:255]
    s_waitcnt lgkmcnt(0)
    s_nop 1
    v_add_f32 v248, v248, v249
    v_mov_b32 v249, v248
    v_mfma_f32_16x16x32_bf16 a[12:15], a[196:199], v[220:223], a[12:15]
    s_lshl_b32 s44, s39, 6
    s_nop 1
    v_permlane32_swap_b32 v248, v249
    s_nop 1
    v_mfma_f32_16x16x32_bf16 a[12:15], a[192:195], v[212:215], a[12:15]
    s_add_u32 s44, s44, s31
    s_add_u32 s45, s44, 131072
    v_add_f32 v248, v248, v249
    v_rcp_f32 v249, v248
    v_mfma_f32_16x16x32_bf16 a[28:31], a[200:203], v[212:215], a[28:31]
    s_add_u32 s46, s44, 262144
    v_rcp_f32 v248, v248
    s_nop 0
    s_add_u32 s47, s44, 393216
    v_mfma_f32_16x16x32_bf16 a[28:31], a[204:207], v[220:223], a[28:31]
    s_add_u32 s48, s44, 4096
    v_accvgpr_read_b32 v132, a8
    v_accvgpr_read_b32 v133, a9
    v_accvgpr_read_b32 v134, a10
    v_mfma_f32_16x16x32_bf16 a[44:47], a[212:215], v[220:223], a[44:47]
    s_add_u32 s49, s44, 135168
    v_accvgpr_read_b32 v135, a11
    v_accvgpr_read_b32 v136, a24
    v_accvgpr_read_b32 v137, a25
    v_mfma_f32_16x16x32_bf16 a[44:47], a[208:211], v[212:215], a[44:47]
    s_add_u32 s50, s44, 266240
    v_accvgpr_read_b32 v138, a26
    v_accvgpr_read_b32 v139, a27
    v_mul_f32 v132, v132, v248
    v_mfma_f32_16x16x32_bf16 a[60:63], a[216:219], v[212:215], a[60:63]
    s_add_u32 s51, s44, 397312
    v_mul_f32 v133, v133, v248
    v_mul_f32 v134, v134, v248
    v_mul_f32 v135, v135, v248
    v_mfma_f32_16x16x32_bf16 a[60:63], a[220:223], v[220:223], a[60:63]
    v_mul_f32 v136, v136, v248
    v_mul_f32 v137, v137, v248
    v_mul_f32 v138, v138, v248
    v_mfma_f32_16x16x32_bf16 a[76:79], a[228:231], v[220:223], a[76:79]
    v_mul_f32 v139, v139, v248
    v_cvt_pk_bf16_f32 v128, v132, v133
    v_cvt_pk_bf16_f32 v129, v134, v135
    v_mfma_f32_16x16x32_bf16 a[76:79], a[224:227], v[212:215], a[76:79]
    v_cvt_pk_bf16_f32 v130, v136, v137
    v_cvt_pk_bf16_f32 v131, v138, v139
    buffer_store_dwordx4 v[128:131], v1, s[24:27], s44 offen sc1
    v_mfma_f32_16x16x32_bf16 a[92:95], a[232:235], v[212:215], a[92:95]
    v_accvgpr_read_b32 v144, a40
    v_accvgpr_read_b32 v145, a41
    v_accvgpr_read_b32 v146, a42
    v_mfma_f32_16x16x32_bf16 a[92:95], a[236:239], v[220:223], a[92:95]
    v_accvgpr_read_b32 v147, a43
    v_accvgpr_read_b32 v148, a56
    v_mov_b32 v253, v252
    v_mfma_f32_16x16x32_bf16 a[108:111], a[244:247], v[220:223], a[108:111]
    v_accvgpr_read_b32 v149, a57
    v_accvgpr_read_b32 v150, a58
    s_nop 1
    v_mfma_f32_16x16x32_bf16 a[108:111], a[240:243], v[212:215], a[108:111]
    v_accvgpr_read_b32 v151, a59
    v_permlane16_swap_b32 v252, v253
    v_mul_f32 v144, v144, v248
    v_mfma_f32_16x16x32_bf16 a[124:127], a[248:251], v[212:215], a[124:127]
    s_nop 1
    v_mul_f32 v145, v145, v248
    v_add_f32 v252, v252, v253
    v_mfma_f32_16x16x32_bf16 a[124:127], a[252:255], v[220:223], a[124:127]
    v_mul_f32 v146, v146, v248
    v_mov_b32 v253, v252
    v_mul_f32 v147, v147, v248
    s_nop 1
    v_mul_f32 v148, v148, v248
    v_mul_f32 v149, v149, v248
    v_permlane32_swap_b32 v252, v253
    v_mul_f32 v150, v150, v248
    s_nop 1
    v_mul_f32 v151, v151, v248
    v_add_f32 v252, v252, v253
    v_cvt_pk_bf16_f32 v140, v144, v145
    v_rcp_f32 v253, v252
    v_cvt_pk_bf16_f32 v141, v146, v147
    v_rcp_f32 v252, v252
    v_cvt_pk_bf16_f32 v142, v148, v149
    s_nop 0
    v_cvt_pk_bf16_f32 v143, v150, v151
    buffer_store_dwordx4 v[140:143], v1, s[24:27], s45 offen sc1
    v_accvgpr_read_b32 v156, a72
    v_accvgpr_read_b32 v157, a73
    v_accvgpr_read_b32 v158, a74
    v_accvgpr_read_b32 v159, a75
    v_accvgpr_read_b32 v160, a88
    v_accvgpr_read_b32 v161, a89
    v_accvgpr_read_b32 v162, a90
    v_accvgpr_read_b32 v163, a91
    v_mul_f32 v156, v156, v248
    v_mul_f32 v157, v157, v248
    v_mul_f32 v158, v158, v248
    v_mul_f32 v159, v159, v248
    v_mul_f32 v160, v160, v248
    v_mul_f32 v161, v161, v248
    v_mul_f32 v162, v162, v248
    v_mul_f32 v163, v163, v248
    v_cvt_pk_bf16_f32 v152, v156, v157
    v_cvt_pk_bf16_f32 v153, v158, v159
    v_cvt_pk_bf16_f32 v154, v160, v161
    v_cvt_pk_bf16_f32 v155, v162, v163
    buffer_store_dwordx4 v[152:155], v1, s[24:27], s46 offen sc1
    v_accvgpr_read_b32 v168, a104
    v_accvgpr_read_b32 v169, a105
    v_accvgpr_read_b32 v170, a106
    v_accvgpr_read_b32 v171, a107
    v_accvgpr_read_b32 v172, a120
    v_accvgpr_read_b32 v173, a121
    v_accvgpr_read_b32 v174, a122
    v_accvgpr_read_b32 v175, a123
    v_mul_f32 v168, v168, v248
    v_mul_f32 v169, v169, v248
    v_mul_f32 v170, v170, v248
    v_mul_f32 v171, v171, v248
    v_mul_f32 v172, v172, v248
    v_mul_f32 v173, v173, v248
    v_mul_f32 v174, v174, v248
    v_mul_f32 v175, v175, v248
    v_cvt_pk_bf16_f32 v164, v168, v169
    v_cvt_pk_bf16_f32 v165, v170, v171
    v_cvt_pk_bf16_f32 v166, v172, v173
    v_cvt_pk_bf16_f32 v167, v174, v175
    buffer_store_dwordx4 v[164:167], v1, s[24:27], s47 offen sc1
    v_accvgpr_read_b32 v132, a12
    v_accvgpr_read_b32 v133, a13
    v_accvgpr_read_b32 v134, a14
    v_accvgpr_read_b32 v135, a15
    v_accvgpr_read_b32 v136, a28
    v_accvgpr_read_b32 v137, a29
    v_accvgpr_read_b32 v138, a30
    v_accvgpr_read_b32 v139, a31
    v_pk_mul_f32 v[132:133], v[132:133], v[252:253]
    v_pk_mul_f32 v[134:135], v[134:135], v[252:253]
    v_pk_mul_f32 v[136:137], v[136:137], v[252:253]
    v_pk_mul_f32 v[138:139], v[138:139], v[252:253]
    v_cvt_pk_bf16_f32 v128, v132, v133
    v_cvt_pk_bf16_f32 v129, v134, v135
    v_cvt_pk_bf16_f32 v130, v136, v137
    v_cvt_pk_bf16_f32 v131, v138, v139
    v_accvgpr_read_b32 v144, a44
    v_accvgpr_read_b32 v145, a45
    v_accvgpr_read_b32 v146, a46
    v_accvgpr_read_b32 v147, a47
    v_accvgpr_read_b32 v148, a60
    v_accvgpr_read_b32 v149, a61
    v_accvgpr_read_b32 v150, a62
    v_accvgpr_read_b32 v151, a63
    v_pk_mul_f32 v[144:145], v[144:145], v[252:253]
    v_pk_mul_f32 v[146:147], v[146:147], v[252:253]
    v_pk_mul_f32 v[148:149], v[148:149], v[252:253]
    v_pk_mul_f32 v[150:151], v[150:151], v[252:253]
    v_cvt_pk_bf16_f32 v140, v144, v145
    v_cvt_pk_bf16_f32 v141, v146, v147
    v_cvt_pk_bf16_f32 v142, v148, v149
    v_cvt_pk_bf16_f32 v143, v150, v151
    v_accvgpr_read_b32 v156, a76
    v_accvgpr_read_b32 v157, a77
    v_accvgpr_read_b32 v158, a78
    v_accvgpr_read_b32 v159, a79
    v_accvgpr_read_b32 v160, a92
    v_accvgpr_read_b32 v161, a93
    v_accvgpr_read_b32 v162, a94
    v_accvgpr_read_b32 v163, a95
    v_pk_mul_f32 v[156:157], v[156:157], v[252:253]
    v_pk_mul_f32 v[158:159], v[158:159], v[252:253]
    v_pk_mul_f32 v[160:161], v[160:161], v[252:253]
    v_pk_mul_f32 v[162:163], v[162:163], v[252:253]
    v_cvt_pk_bf16_f32 v152, v156, v157
    v_cvt_pk_bf16_f32 v153, v158, v159
    v_cvt_pk_bf16_f32 v154, v160, v161
    v_cvt_pk_bf16_f32 v155, v162, v163
    v_accvgpr_read_b32 v168, a108
    v_accvgpr_read_b32 v169, a109
    v_accvgpr_read_b32 v170, a110
    v_accvgpr_read_b32 v171, a111
    v_accvgpr_read_b32 v172, a124
    v_accvgpr_read_b32 v173, a125
    v_accvgpr_read_b32 v174, a126
    v_accvgpr_read_b32 v175, a127
    v_pk_mul_f32 v[168:169], v[168:169], v[252:253]
    v_pk_mul_f32 v[170:171], v[170:171], v[252:253]
    v_pk_mul_f32 v[172:173], v[172:173], v[252:253]
    v_pk_mul_f32 v[174:175], v[174:175], v[252:253]
    v_cvt_pk_bf16_f32 v164, v168, v169
    v_cvt_pk_bf16_f32 v165, v170, v171
    v_cvt_pk_bf16_f32 v166, v172, v173
    v_cvt_pk_bf16_f32 v167, v174, v175
    buffer_store_dwordx4 v[128:131], v1, s[24:27], s48 offen sc1
    buffer_store_dwordx4 v[140:143], v1, s[24:27], s49 offen sc1
    buffer_store_dwordx4 v[152:155], v1, s[24:27], s50 offen sc1
    buffer_store_dwordx4 v[164:167], v1, s[24:27], s51 offen sc1
op_head:
    s_load_dwordx2 s[28:29], s[0:1], 0
    s_load_dwordx2 s[42:43], s[0:1], 56
    s_waitcnt vmcnt(8)
    v_cmp_le_u32 vcc, 4, v74
    v_mov_b32 v56, 0
    v_mov_b32 v57, 0
    v_mov_b32 v58, 0
    v_mov_b32 v59, 0
    s_nop 1
    v_mfma_f32_32x32x16_bf16 v[128:143], v[56:59], v[56:59], 0
    v_mfma_f32_32x32x16_bf16 v[144:159], v[56:59], v[56:59], 0
    v_mfma_f32_32x32x16_bf16 v[160:175], v[56:59], v[56:59], 0
    v_mfma_f32_32x32x16_bf16 v[176:191], v[56:59], v[56:59], 0
    s_mov_b32 s33, vcc_lo
    s_bitcmp1_b32 s33, 0
    s_cbranch_scc0 op_late_125
    buffer_load_dwordx4 a[128:131], v88, s[8:11], s62 offen offset:0 sc1
    buffer_load_dwordx4 a[132:135], v88, s[8:11], s62 offen offset:1024 sc1
    buffer_load_dwordx4 a[136:139], v89, s[8:11], s62 offen offset:0 sc1
    buffer_load_dwordx4 a[140:143], v89, s[8:11], s62 offen offset:1024 sc1
    s_add_u32 s62, s62, 0x40000
    s_and_b32 s62, s62, 0x7fffff
    buffer_load_dwordx4 a[144:147], v88, s[8:11], s62 offen offset:0 sc1
    buffer_load_dwordx4 a[148:151], v88, s[8:11], s62 offen offset:1024 sc1
    buffer_load_dwordx4 a[152:155], v89, s[8:11], s62 offen offset:0 sc1
    buffer_load_dwordx4 a[156:159], v89, s[8:11], s62 offen offset:1024 sc1
    s_add_u32 s62, s62, 0x40000
    s_and_b32 s62, s62, 0x7fffff
    buffer_load_dwordx4 a[160:163], v88, s[8:11], s62 offen offset:0 sc1
    buffer_load_dwordx4 a[164:167], v88, s[8:11], s62 offen offset:1024 sc1
    buffer_load_dwordx4 a[168:171], v89, s[8:11], s62 offen offset:0 sc1
    buffer_load_dwordx4 a[172:175], v89, s[8:11], s62 offen offset:1024 sc1
    s_add_u32 s62, s62, 0x40000
    s_and_b32 s62, s62, 0x7fffff
    s_waitcnt vmcnt(12)
    s_branch op_join_126
op_late_125:
    s_waitcnt vmcnt(0)
op_join_126:
    s_barrier
    s_cmp_eq_u32 s30, 0
    s_cbranch_scc1 k12_ool_127
k12_oolret_128:
    s_bitcmp0_b32 s33, 0
    s_cbranch_scc1 k12_ool_131
k12_oolret_132:
    ds_read_b64_tr_b16 a[0:1], v64 offset:0
    ds_read_b64_tr_b16 a[2:3], v64 offset:4096
    ds_read_b64_tr_b16 a[4:5], v65 offset:0
    ds_read_b64_tr_b16 a[6:7], v65 offset:4096
    ds_read_b64_tr_b16 a[8:9], v66 offset:0
    ds_read_b64_tr_b16 a[10:11], v66 offset:4096
    ds_read_b64_tr_b16 a[12:13], v67 offset:0
    ds_read_b64_tr_b16 a[14:15], v67 offset:4096
    ds_read_b64_tr_b16 a[16:17], v68 offset:0
    ds_read_b64_tr_b16 a[18:19], v68 offset:4096
    ds_read_b64_tr_b16 a[20:21], v69 offset:0
    ds_read_b64_tr_b16 a[22:23], v69 offset:4096
    ds_read_b64_tr_b16 a[24:25], v70 offset:0
    ds_read_b64_tr_b16 a[26:27], v70 offset:4096
    ds_read_b64_tr_b16 a[28:29], v71 offset:0
    ds_read_b64_tr_b16 a[30:31], v71 offset:4096
    ds_read_b64_tr_b16 a[32:33], v64 offset:8192
    ds_read_b64_tr_b16 a[34:35], v64 offset:12288
    ds_read_b64_tr_b16 a[36:37], v65 offset:8192
    ds_read_b64_tr_b16 a[38:39], v65 offset:12288
    ds_read_b64_tr_b16 a[40:41], v66 offset:8192
    ds_read_b64_tr_b16 a[42:43], v66 offset:12288
    ds_read_b64_tr_b16 a[44:45], v67 offset:8192
    ds_read_b64_tr_b16 a[46:47], v67 offset:12288
    ds_read_b64_tr_b16 a[48:49], v68 offset:8192
    ds_read_b64_tr_b16 a[50:51], v68 offset:12288
    ds_read_b64_tr_b16 a[52:53], v69 offset:8192
    ds_read_b64_tr_b16 a[54:55], v69 offset:12288
    ds_read_b64_tr_b16 a[56:57], v70 offset:8192
    ds_read_b64_tr_b16 a[58:59], v70 offset:12288
    ds_read_b64_tr_b16 a[60:61], v71 offset:8192
    ds_read_b64_tr_b16 a[62:63], v71 offset:12288
    s_add_u32 s24, s6, 0x4000000
    s_addc_u32 s25, s7, 0
    s_and_b32 s25, s25, 0xffff
    s_mov_b32 s26, 0x400000
    s_mov_b32 s27, 0x00020000
    s_add_u32 s36, s6, 0x5000000
    s_addc_u32 s37, s7, 0
    s_and_b32 s37, s37, 0xffff
    s_mov_b32 s38, 0x800000
    s_mov_b32 s39, 0x00020000
    s_add_u32 s48, s6, 0x4807000
    s_addc_u32 s49, s7, 0
    s_and_b32 s49, s49, 0xffff
    s_mov_b32 s50, 0x8000
    s_mov_b32 s51, 0x00020000
    s_lshl_b32 s52, s2, 14
    s_add_u32 s52, s52, s60
    s_xor_b32 s53, s52, 0x10000
    s_lshl_b32 s57, s2, 7
    s_xor_b32 s58, s57, 0x200
    v_lshrrev_b32 v56, 4, v1
    s_lshl_b32 s31, s30, 6
    s_and_b32 s31, s31, 64
    v_add_u32 v56, s31, v56
    s_mov_b32 s31, (code_end-op_tail)/128
    v_min_u32 v56, s31, v56
    s_getpc_b64 s[40:41]
pc_133:
    s_add_u32 s40, s40, op_tail-pc_133
    s_addc_u32 s41, s41, 0
    v_lshlrev_b32 v82, 7, v56
    v_mov_b32 v83, s41
    v_add_co_u32 v82, vcc, s40, v82
    s_nop 1
    v_addc_co_u32 v83, vcc, 0, v83, vcc
    v_lshlrev_b32 v94, 3, v1
    s_and_b32 s35, s2, 7
    s_mul_i32 s35, s35, 28
    s_lshr_b32 s31, s2, 3
    s_add_u32 s55, s35, s31
    s_lshl_b32 s3, s55, 15
    s_lshl_b32 s31, s30, 13
    s_add_u32 s3, s3, s31
    s_add_u32 s35, s31, 65536
    s_mov_b32 s63, 0
    s_waitcnt vmcnt(8) lgkmcnt(0)
    s_mov_b32 s20, s28
    s_and_b32 s21, s29, 0xffff
    s_mov_b32 s22, 0x400000
    s_mov_b32 s23, 0x00020000
    s_mov_b32 s44, s42
    s_and_b32 s45, s43, 0xffff
    s_mov_b32 s46, 0x800
    s_mov_b32 s47, 0x00020000
op_loop_134:
    v_mfma_f32_16x16x32_bf16 v[160:163], a[16:19], a[128:131], v[160:163]
    s_add_u32 m0, s60, 49152
    ds_read_b64_tr_b16 a[64:65], v64 offset:16384
    ds_read_b64_tr_b16 a[66:67], v64 offset:20480
    v_mfma_f32_16x16x32_bf16 v[160:163], a[48:51], a[136:139], v[160:163]
    buffer_load_dwordx4 v90, s[12:15], s61 offen offset:0 lds
    ds_read_b64_tr_b16 a[68:69], v65 offset:16384
    v_mfma_f32_16x16x32_bf16 v[164:167], a[48:51], a[140:143], v[164:167]
    ds_read_b64_tr_b16 a[70:71], v65 offset:20480
    ds_read_b64_tr_b16 a[72:73], v66 offset:16384
    v_mfma_f32_16x16x32_bf16 v[164:167], a[16:19], a[132:135], v[164:167]
    buffer_load_dwordx4 v91, s[12:15], s61 offen offset:1024 lds
    ds_read_b64_tr_b16 a[74:75], v66 offset:20480
    v_mfma_f32_16x16x32_bf16 v[172:175], a[20:23], a[132:135], v[172:175]
    ds_read_b64_tr_b16 a[76:77], v67 offset:16384
    ds_read_b64_tr_b16 a[78:79], v67 offset:20480
    v_mfma_f32_16x16x32_bf16 v[172:175], a[52:55], a[140:143], v[172:175]
    ds_read_b64_tr_b16 a[80:81], v68 offset:16384
    v_mfma_f32_16x16x32_bf16 v[168:171], a[52:55], a[136:139], v[168:171]
    ds_read_b64_tr_b16 a[82:83], v68 offset:20480
    v_mfma_f32_16x16x32_bf16 v[168:171], a[20:23], a[128:131], v[168:171]
    buffer_load_dwordx4 v92, s[12:15], s61 offen offset:2048 lds
    ds_read_b64_tr_b16 a[84:85], v69 offset:16384
    v_mfma_f32_16x16x32_bf16 v[176:179], a[24:27], a[128:131], v[176:179]
    ds_read_b64_tr_b16 a[86:87], v69 offset:20480
    ds_read_b64_tr_b16 a[88:89], v70 offset:16384
    v_mfma_f32_16x16x32_bf16 v[176:179], a[56:59], a[136:139], v[176:179]
    ds_read_b64_tr_b16 a[90:91], v70 offset:20480
    v_mfma_f32_16x16x32_bf16 v[180:183], a[56:59], a[140:143], v[180:183]
    buffer_load_dwordx4 v93, s[12:15], s61 offen offset:3072 lds
    ds_read_b64_tr_b16 a[92:93], v71 offset:16384
    v_mfma_f32_16x16x32_bf16 v[180:183], a[24:27], a[132:135], v[180:183]
    ds_read_b64_tr_b16 a[94:95], v71 offset:20480
    ds_read_b64_tr_b16 a[96:97], v64 offset:24576
    v_mfma_f32_16x16x32_bf16 v[188:191], a[28:31], a[132:135], v[188:191]
    ds_read_b64_tr_b16 a[98:99], v64 offset:28672
    v_mfma_f32_16x16x32_bf16 v[188:191], a[60:63], a[140:143], v[188:191]
    ds_read_b64_tr_b16 a[100:101], v65 offset:24576
    v_mfma_f32_16x16x32_bf16 v[184:187], a[60:63], a[136:139], v[184:187]
    buffer_load_dwordx4 a[176:179], v88, s[8:11], s62 offen offset:0 sc1
    ds_read_b64_tr_b16 a[102:103], v65 offset:28672
    v_mfma_f32_16x16x32_bf16 v[184:187], a[28:31], a[128:131], v[184:187]
    s_add_u32 s61, s61, 0x20000
    s_and_b32 s61, s61, 0x3fffff
    ds_read_b64_tr_b16 a[104:105], v66 offset:24576
    ds_read_b64_tr_b16 a[106:107], v66 offset:28672
    v_mfma_f32_16x16x32_bf16 v[128:131], a[0:3], a[128:131], v[128:131]
    ds_read_b64_tr_b16 a[108:109], v67 offset:24576
    v_mfma_f32_16x16x32_bf16 v[128:131], a[32:35], a[136:139], v[128:131]
    buffer_load_dwordx4 a[180:183], v88, s[8:11], s62 offen offset:1024 sc1
    ds_read_b64_tr_b16 a[110:111], v67 offset:28672
    v_mfma_f32_16x16x32_bf16 v[132:135], a[32:35], a[140:143], v[132:135]
    ds_read_b64_tr_b16 a[112:113], v68 offset:24576
    v_mfma_f32_16x16x32_bf16 v[132:135], a[0:3], a[132:135], v[132:135]
    ds_read_b64_tr_b16 a[114:115], v68 offset:28672
    ds_read_b64_tr_b16 a[116:117], v69 offset:24576
    v_mfma_f32_16x16x32_bf16 v[140:143], a[4:7], a[132:135], v[140:143]
    ds_read_b64_tr_b16 a[118:119], v69 offset:28672
    v_mfma_f32_16x16x32_bf16 v[140:143], a[36:39], a[140:143], v[140:143]
    buffer_load_dwordx4 a[184:187], v89, s[8:11], s62 offen offset:0 sc1
    ds_read_b64_tr_b16 a[120:121], v70 offset:24576
    v_mfma_f32_16x16x32_bf16 v[136:139], a[36:39], a[136:139], v[136:139]
    ds_read_b64_tr_b16 a[122:123], v70 offset:28672
    ds_read_b64_tr_b16 a[124:125], v71 offset:24576
    v_mfma_f32_16x16x32_bf16 v[136:139], a[4:7], a[128:131], v[136:139]
    ds_read_b64_tr_b16 a[126:127], v71 offset:28672
    v_mfma_f32_16x16x32_bf16 v[144:147], a[8:11], a[128:131], v[144:147]
    buffer_load_dwordx4 a[188:191], v89, s[8:11], s62 offen offset:1024 sc1
    v_mfma_f32_16x16x32_bf16 v[144:147], a[40:43], a[136:139], v[144:147]
    v_mfma_f32_16x16x32_bf16 v[148:151], a[40:43], a[140:143], v[148:151]
    v_mfma_f32_16x16x32_bf16 v[148:151], a[8:11], a[132:135], v[148:151]
    v_mfma_f32_16x16x32_bf16 v[156:159], a[12:15], a[132:135], v[156:159]
    s_cmp_eq_u32 s63, 7
    s_cbranch_scc1 k12_ool_137
k12_oolret_138:
    v_mfma_f32_16x16x32_bf16 v[156:159], a[44:47], a[140:143], v[156:159]
    s_add_u32 s62, s62, 0x40000
    s_and_b32 s62, s62, 0x7fffff
    v_mfma_f32_16x16x32_bf16 v[152:155], a[44:47], a[136:139], v[152:155]
    v_mfma_f32_16x16x32_bf16 v[152:155], a[12:15], a[128:131], v[152:155]
    s_waitcnt vmcnt(12) lgkmcnt(0)
    s_barrier
    v_mfma_f32_16x16x32_bf16 v[160:163], a[80:83], a[144:147], v[160:163]
    s_add_u32 s32, s63, 1
    s_lshr_b32 s32, s32, 1
    ds_read_b64_tr_b16 a[0:1], v64 offset:32768
    v_cmp_le_u32 vcc, 4, v74
    v_mfma_f32_16x16x32_bf16 v[160:163], a[112:115], a[152:155], v[160:163]
    s_add_u32 m0, s60, 0
    ds_read_b64_tr_b16 a[2:3], v64 offset:36864
    ds_read_b64_tr_b16 a[4:5], v65 offset:32768
    v_mfma_f32_16x16x32_bf16 v[164:167], a[112:115], a[156:159], v[164:167]
    s_or_b32 s33, vcc_lo, 16
    buffer_load_dwordx4 v90, s[12:15], s61 offen offset:0 lds
    ds_read_b64_tr_b16 a[6:7], v65 offset:36864
    v_mfma_f32_16x16x32_bf16 v[164:167], a[80:83], a[148:151], v[164:167]
    ds_read_b64_tr_b16 a[8:9], v66 offset:32768
    ds_read_b64_tr_b16 a[10:11], v66 offset:36864
    v_mfma_f32_16x16x32_bf16 v[172:175], a[84:87], a[148:151], v[172:175]
    buffer_load_dwordx4 v91, s[12:15], s61 offen offset:1024 lds
    ds_read_b64_tr_b16 a[12:13], v67 offset:32768
    v_mfma_f32_16x16x32_bf16 v[172:175], a[116:119], a[156:159], v[172:175]
    ds_read_b64_tr_b16 a[14:15], v67 offset:36864
    ds_read_b64_tr_b16 a[16:17], v68 offset:32768
    v_mfma_f32_16x16x32_bf16 v[168:171], a[116:119], a[152:155], v[168:171]
    s_bitcmp0_b32 s33, s32
    s_cbranch_scc1 k12_ool_141
k12_oolret_142:
    v_mfma_f32_16x16x32_bf16 v[168:171], a[84:87], a[144:147], v[168:171]
    ds_read_b64_tr_b16 a[18:19], v68 offset:36864
    ds_read_b64_tr_b16 a[20:21], v69 offset:32768
    v_mfma_f32_16x16x32_bf16 v[176:179], a[88:91], a[144:147], v[176:179]
    buffer_load_dwordx4 v92, s[12:15], s61 offen offset:2048 lds
    ds_read_b64_tr_b16 a[22:23], v69 offset:36864
    v_mfma_f32_16x16x32_bf16 v[176:179], a[120:123], a[152:155], v[176:179]
    ds_read_b64_tr_b16 a[24:25], v70 offset:32768
    ds_read_b64_tr_b16 a[26:27], v70 offset:36864
    v_mfma_f32_16x16x32_bf16 v[180:183], a[120:123], a[156:159], v[180:183]
    buffer_load_dwordx4 v93, s[12:15], s61 offen offset:3072 lds
    ds_read_b64_tr_b16 a[28:29], v71 offset:32768
    v_mfma_f32_16x16x32_bf16 v[180:183], a[88:91], a[148:151], v[180:183]
    ds_read_b64_tr_b16 a[30:31], v71 offset:36864
    ds_read_b64_tr_b16 a[32:33], v64 offset:40960
    v_mfma_f32_16x16x32_bf16 v[188:191], a[92:95], a[148:151], v[188:191]
    ds_read_b64_tr_b16 a[34:35], v64 offset:45056
    v_mfma_f32_16x16x32_bf16 v[188:191], a[124:127], a[156:159], v[188:191]
    ds_read_b64_tr_b16 a[36:37], v65 offset:40960
    v_mfma_f32_16x16x32_bf16 v[184:187], a[124:127], a[152:155], v[184:187]
    buffer_load_dwordx4 a[128:131], v88, s[8:11], s62 offen offset:0 sc1
    ds_read_b64_tr_b16 a[38:39], v65 offset:45056
    v_mfma_f32_16x16x32_bf16 v[184:187], a[92:95], a[144:147], v[184:187]
    s_add_u32 s61, s61, 0x20000
    s_and_b32 s61, s61, 0x3fffff
    ds_read_b64_tr_b16 a[40:41], v66 offset:40960
    ds_read_b64_tr_b16 a[42:43], v66 offset:45056
    v_mfma_f32_16x16x32_bf16 v[128:131], a[64:67], a[144:147], v[128:131]
    ds_read_b64_tr_b16 a[44:45], v67 offset:40960
    v_mfma_f32_16x16x32_bf16 v[128:131], a[96:99], a[152:155], v[128:131]
    buffer_load_dwordx4 a[132:135], v88, s[8:11], s62 offen offset:1024 sc1
    ds_read_b64_tr_b16 a[46:47], v67 offset:45056
    v_mfma_f32_16x16x32_bf16 v[132:135], a[96:99], a[156:159], v[132:135]
    ds_read_b64_tr_b16 a[48:49], v68 offset:40960
    v_mfma_f32_16x16x32_bf16 v[132:135], a[64:67], a[148:151], v[132:135]
    ds_read_b64_tr_b16 a[50:51], v68 offset:45056
    ds_read_b64_tr_b16 a[52:53], v69 offset:40960
    v_mfma_f32_16x16x32_bf16 v[140:143], a[68:71], a[148:151], v[140:143]
    ds_read_b64_tr_b16 a[54:55], v69 offset:45056
    v_mfma_f32_16x16x32_bf16 v[140:143], a[100:103], a[156:159], v[140:143]
    buffer_load_dwordx4 a[136:139], v89, s[8:11], s62 offen offset:0 sc1
    ds_read_b64_tr_b16 a[56:57], v70 offset:40960
    v_mfma_f32_16x16x32_bf16 v[136:139], a[100:103], a[152:155], v[136:139]
    ds_read_b64_tr_b16 a[58:59], v70 offset:45056
    ds_read_b64_tr_b16 a[60:61], v71 offset:40960
    v_mfma_f32_16x16x32_bf16 v[136:139], a[68:71], a[144:147], v[136:139]
    ds_read_b64_tr_b16 a[62:63], v71 offset:45056
    v_mfma_f32_16x16x32_bf16 v[144:147], a[72:75], a[144:147], v[144:147]
    buffer_load_dwordx4 a[140:143], v89, s[8:11], s62 offen offset:1024 sc1
    v_mfma_f32_16x16x32_bf16 v[144:147], a[104:107], a[152:155], v[144:147]
    v_mfma_f32_16x16x32_bf16 v[148:151], a[104:107], a[156:159], v[148:151]
    s_cmp_eq_u32 s63, 6
    s_cbranch_scc1 k12_ool_143
k12_oolret_144:
    v_mfma_f32_16x16x32_bf16 v[148:151], a[72:75], a[148:151], v[148:151]
    v_mfma_f32_16x16x32_bf16 v[156:159], a[76:79], a[148:151], v[156:159]
    v_mfma_f32_16x16x32_bf16 v[156:159], a[108:111], a[156:159], v[156:159]
    s_add_u32 s62, s62, 0x40000
    s_and_b32 s62, s62, 0x7fffff
    v_mfma_f32_16x16x32_bf16 v[152:155], a[108:111], a[152:155], v[152:155]
    v_mfma_f32_16x16x32_bf16 v[152:155], a[76:79], a[144:147], v[152:155]
    s_waitcnt vmcnt(12) lgkmcnt(0)
    s_barrier
    v_mfma_f32_16x16x32_bf16 v[160:163], a[16:19], a[160:163], v[160:163]
    s_add_u32 m0, s60, 16384
    buffer_load_dword v74, v73, s[16:19], s59 offen sc1
    ds_read_b64_tr_b16 a[64:65], v64 offset:49152
    v_mfma_f32_16x16x32_bf16 v[160:163], a[48:51], a[168:171], v[160:163]
    buffer_load_dwordx4 v90, s[12:15], s61 offen offset:0 lds
    ds_read_b64_tr_b16 a[66:67], v64 offset:53248
    v_mfma_f32_16x16x32_bf16 v[164:167], a[48:51], a[172:175], v[164:167]
    ds_read_b64_tr_b16 a[68:69], v65 offset:49152
    ds_read_b64_tr_b16 a[70:71], v65 offset:53248
    v_mfma_f32_16x16x32_bf16 v[164:167], a[16:19], a[164:167], v[164:167]
    ds_read_b64_tr_b16 a[72:73], v66 offset:49152
    ds_read_b64_tr_b16 a[74:75], v66 offset:53248
    v_mfma_f32_16x16x32_bf16 v[172:175], a[20:23], a[164:167], v[172:175]
    buffer_load_dwordx4 v91, s[12:15], s61 offen offset:1024 lds
    ds_read_b64_tr_b16 a[76:77], v67 offset:49152
    v_mfma_f32_16x16x32_bf16 v[172:175], a[52:55], a[172:175], v[172:175]
    ds_read_b64_tr_b16 a[78:79], v67 offset:53248
    ds_read_b64_tr_b16 a[80:81], v68 offset:49152
    v_mfma_f32_16x16x32_bf16 v[168:171], a[52:55], a[168:171], v[168:171]
    ds_read_b64_tr_b16 a[82:83], v68 offset:53248
    v_mfma_f32_16x16x32_bf16 v[168:171], a[20:23], a[160:163], v[168:171]
    buffer_load_dwordx4 v92, s[12:15], s61 offen offset:2048 lds
    ds_read_b64_tr_b16 a[84:85], v69 offset:49152
    v_mfma_f32_16x16x32_bf16 v[176:179], a[24:27], a[160:163], v[176:179]
    ds_read_b64_tr_b16 a[86:87], v69 offset:53248
    ds_read_b64_tr_b16 a[88:89], v70 offset:49152
    v_mfma_f32_16x16x32_bf16 v[176:179], a[56:59], a[168:171], v[176:179]
    ds_read_b64_tr_b16 a[90:91], v70 offset:53248
    v_mfma_f32_16x16x32_bf16 v[180:183], a[56:59], a[172:175], v[180:183]
    buffer_load_dwordx4 v93, s[12:15], s61 offen offset:3072 lds
    ds_read_b64_tr_b16 a[92:93], v71 offset:49152
    v_mfma_f32_16x16x32_bf16 v[180:183], a[24:27], a[164:167], v[180:183]
    ds_read_b64_tr_b16 a[94:95], v71 offset:53248
    ds_read_b64_tr_b16 a[96:97], v64 offset:57344
    v_mfma_f32_16x16x32_bf16 v[188:191], a[28:31], a[164:167], v[188:191]
    ds_read_b64_tr_b16 a[98:99], v64 offset:61440
    v_mfma_f32_16x16x32_bf16 v[188:191], a[60:63], a[172:175], v[188:191]
    ds_read_b64_tr_b16 a[100:101], v65 offset:57344
    v_mfma_f32_16x16x32_bf16 v[184:187], a[60:63], a[168:171], v[184:187]
    buffer_load_dwordx4 a[144:147], v88, s[8:11], s62 offen offset:0 sc1
    ds_read_b64_tr_b16 a[102:103], v65 offset:61440
    v_mfma_f32_16x16x32_bf16 v[184:187], a[28:31], a[160:163], v[184:187]
    s_add_u32 s61, s61, 0x20000
    s_and_b32 s61, s61, 0x3fffff
    ds_read_b64_tr_b16 a[104:105], v66 offset:57344
    ds_read_b64_tr_b16 a[106:107], v66 offset:61440
    v_mfma_f32_16x16x32_bf16 v[128:131], a[0:3], a[160:163], v[128:131]
    ds_read_b64_tr_b16 a[108:109], v67 offset:57344
    v_mfma_f32_16x16x32_bf16 v[128:131], a[32:35], a[168:171], v[128:131]
    buffer_load_dwordx4 a[148:151], v88, s[8:11], s62 offen offset:1024 sc1
    ds_read_b64_tr_b16 a[110:111], v67 offset:61440
    v_mfma_f32_16x16x32_bf16 v[132:135], a[32:35], a[172:175], v[132:135]
    ds_read_b64_tr_b16 a[112:113], v68 offset:57344
    v_mfma_f32_16x16x32_bf16 v[132:135], a[0:3], a[164:167], v[132:135]
    ds_read_b64_tr_b16 a[114:115], v68 offset:61440
    ds_read_b64_tr_b16 a[116:117], v69 offset:57344
    v_mfma_f32_16x16x32_bf16 v[140:143], a[4:7], a[164:167], v[140:143]
    ds_read_b64_tr_b16 a[118:119], v69 offset:61440
    v_mfma_f32_16x16x32_bf16 v[140:143], a[36:39], a[172:175], v[140:143]
    buffer_load_dwordx4 a[152:155], v89, s[8:11], s62 offen offset:0 sc1
    ds_read_b64_tr_b16 a[120:121], v70 offset:57344
    v_mfma_f32_16x16x32_bf16 v[136:139], a[36:39], a[168:171], v[136:139]
    ds_read_b64_tr_b16 a[122:123], v70 offset:61440
    ds_read_b64_tr_b16 a[124:125], v71 offset:57344
    v_mfma_f32_16x16x32_bf16 v[136:139], a[4:7], a[160:163], v[136:139]
    ds_read_b64_tr_b16 a[126:127], v71 offset:61440
    v_mfma_f32_16x16x32_bf16 v[144:147], a[8:11], a[160:163], v[144:147]
    buffer_load_dwordx4 a[156:159], v89, s[8:11], s62 offen offset:1024 sc1
    v_mfma_f32_16x16x32_bf16 v[144:147], a[40:43], a[168:171], v[144:147]
    v_mfma_f32_16x16x32_bf16 v[148:151], a[40:43], a[172:175], v[148:151]
    v_mfma_f32_16x16x32_bf16 v[148:151], a[8:11], a[164:167], v[148:151]
    v_mfma_f32_16x16x32_bf16 v[156:159], a[12:15], a[164:167], v[156:159]
    v_mfma_f32_16x16x32_bf16 v[156:159], a[44:47], a[172:175], v[156:159]
    s_add_u32 s62, s62, 0x40000
    s_and_b32 s62, s62, 0x7fffff
    v_mfma_f32_16x16x32_bf16 v[152:155], a[44:47], a[168:171], v[152:155]
    v_mfma_f32_16x16x32_bf16 v[152:155], a[12:15], a[160:163], v[152:155]
    s_waitcnt vmcnt(12) lgkmcnt(0)
    s_barrier
    v_mfma_f32_16x16x32_bf16 v[160:163], a[80:83], a[176:179], v[160:163]
    s_add_u32 m0, s60, 32768
    ds_read_b64_tr_b16 a[0:1], v64 offset:0
    ds_read_b64_tr_b16 a[2:3], v64 offset:4096
    v_mfma_f32_16x16x32_bf16 v[160:163], a[112:115], a[184:187], v[160:163]
    buffer_load_dwordx4 v90, s[12:15], s61 offen offset:0 lds
    ds_read_b64_tr_b16 a[4:5], v65 offset:0
    v_mfma_f32_16x16x32_bf16 v[164:167], a[112:115], a[188:191], v[164:167]
    ds_read_b64_tr_b16 a[6:7], v65 offset:4096
    ds_read_b64_tr_b16 a[8:9], v66 offset:0
    v_mfma_f32_16x16x32_bf16 v[164:167], a[80:83], a[180:183], v[164:167]
    buffer_load_dwordx4 v91, s[12:15], s61 offen offset:1024 lds
    ds_read_b64_tr_b16 a[10:11], v66 offset:4096
    v_mfma_f32_16x16x32_bf16 v[172:175], a[84:87], a[180:183], v[172:175]
    ds_read_b64_tr_b16 a[12:13], v67 offset:0
    ds_read_b64_tr_b16 a[14:15], v67 offset:4096
    v_mfma_f32_16x16x32_bf16 v[172:175], a[116:119], a[188:191], v[172:175]
    ds_read_b64_tr_b16 a[16:17], v68 offset:0
    v_mfma_f32_16x16x32_bf16 v[168:171], a[116:119], a[184:187], v[168:171]
    ds_read_b64_tr_b16 a[18:19], v68 offset:4096
    v_mfma_f32_16x16x32_bf16 v[168:171], a[84:87], a[176:179], v[168:171]
    buffer_load_dwordx4 v92, s[12:15], s61 offen offset:2048 lds
    ds_read_b64_tr_b16 a[20:21], v69 offset:0
    v_mfma_f32_16x16x32_bf16 v[176:179], a[88:91], a[176:179], v[176:179]
    ds_read_b64_tr_b16 a[22:23], v69 offset:4096
    ds_read_b64_tr_b16 a[24:25], v70 offset:0
    v_mfma_f32_16x16x32_bf16 v[176:179], a[120:123], a[184:187], v[176:179]
    ds_read_b64_tr_b16 a[26:27], v70 offset:4096
    v_mfma_f32_16x16x32_bf16 v[180:183], a[120:123], a[188:191], v[180:183]
    buffer_load_dwordx4 v93, s[12:15], s61 offen offset:3072 lds
    ds_read_b64_tr_b16 a[28:29], v71 offset:0
    v_mfma_f32_16x16x32_bf16 v[180:183], a[88:91], a[180:183], v[180:183]
    ds_read_b64_tr_b16 a[30:31], v71 offset:4096
    ds_read_b64_tr_b16 a[32:33], v64 offset:8192
    v_mfma_f32_16x16x32_bf16 v[188:191], a[92:95], a[180:183], v[188:191]
    ds_read_b64_tr_b16 a[34:35], v64 offset:12288
    v_mfma_f32_16x16x32_bf16 v[188:191], a[124:127], a[188:191], v[188:191]
    ds_read_b64_tr_b16 a[36:37], v65 offset:8192
    v_mfma_f32_16x16x32_bf16 v[184:187], a[124:127], a[184:187], v[184:187]
    buffer_load_dwordx4 a[160:163], v88, s[8:11], s62 offen offset:0 sc1
    ds_read_b64_tr_b16 a[38:39], v65 offset:12288
    v_mfma_f32_16x16x32_bf16 v[184:187], a[92:95], a[176:179], v[184:187]
    s_add_u32 s61, s61, 0x20000
    s_and_b32 s61, s61, 0x3fffff
    ds_read_b64_tr_b16 a[40:41], v66 offset:8192
    ds_read_b64_tr_b16 a[42:43], v66 offset:12288
    v_mfma_f32_16x16x32_bf16 v[128:131], a[64:67], a[176:179], v[128:131]
    ds_read_b64_tr_b16 a[44:45], v67 offset:8192
    v_mfma_f32_16x16x32_bf16 v[128:131], a[96:99], a[184:187], v[128:131]
    buffer_load_dwordx4 a[164:167], v88, s[8:11], s62 offen offset:1024 sc1
    ds_read_b64_tr_b16 a[46:47], v67 offset:12288
    v_mfma_f32_16x16x32_bf16 v[132:135], a[96:99], a[188:191], v[132:135]
    ds_read_b64_tr_b16 a[48:49], v68 offset:8192
    v_mfma_f32_16x16x32_bf16 v[132:135], a[64:67], a[180:183], v[132:135]
    ds_read_b64_tr_b16 a[50:51], v68 offset:12288
    ds_read_b64_tr_b16 a[52:53], v69 offset:8192
    v_mfma_f32_16x16x32_bf16 v[140:143], a[68:71], a[180:183], v[140:143]
    ds_read_b64_tr_b16 a[54:55], v69 offset:12288
    v_mfma_f32_16x16x32_bf16 v[140:143], a[100:103], a[188:191], v[140:143]
    buffer_load_dwordx4 a[168:171], v89, s[8:11], s62 offen offset:0 sc1
    ds_read_b64_tr_b16 a[56:57], v70 offset:8192
    v_mfma_f32_16x16x32_bf16 v[136:139], a[100:103], a[184:187], v[136:139]
    ds_read_b64_tr_b16 a[58:59], v70 offset:12288
    ds_read_b64_tr_b16 a[60:61], v71 offset:8192
    v_mfma_f32_16x16x32_bf16 v[136:139], a[68:71], a[176:179], v[136:139]
    ds_read_b64_tr_b16 a[62:63], v71 offset:12288
    v_mfma_f32_16x16x32_bf16 v[144:147], a[72:75], a[176:179], v[144:147]
    buffer_load_dwordx4 a[172:175], v89, s[8:11], s62 offen offset:1024 sc1
    v_mfma_f32_16x16x32_bf16 v[144:147], a[104:107], a[184:187], v[144:147]
    v_mfma_f32_16x16x32_bf16 v[148:151], a[104:107], a[188:191], v[148:151]
    v_mfma_f32_16x16x32_bf16 v[148:151], a[72:75], a[180:183], v[148:151]
    v_mfma_f32_16x16x32_bf16 v[156:159], a[76:79], a[180:183], v[156:159]
    v_mfma_f32_16x16x32_bf16 v[156:159], a[108:111], a[188:191], v[156:159]
    s_add_u32 s62, s62, 0x40000
    s_and_b32 s62, s62, 0x7fffff
    v_mfma_f32_16x16x32_bf16 v[152:155], a[108:111], a[184:187], v[152:155]
    s_add_u32 s63, s63, 1
    v_mfma_f32_16x16x32_bf16 v[152:155], a[76:79], a[176:179], v[152:155]
    s_waitcnt vmcnt(12) lgkmcnt(0)
    s_barrier
    s_cmp_lt_u32 s63, 8
    s_cbranch_scc1 op_loop_134
op_tail:
    s_nop 1
    v_cvt_pk_bf16_f32 v160, v160, v161
    v_cvt_pk_bf16_f32 v161, v162, v163
    v_cvt_pk_bf16_f32 v162, v164, v165
    v_cvt_pk_bf16_f32 v163, v166, v167
    v_min_u32 v160, -2, v160
    v_min_u32 v161, -2, v161
    v_min_u32 v162, -2, v162
    v_min_u32 v163, -2, v163
    buffer_store_dwordx4 v[160:163], v1, s[36:39], s52 offen offset:0 sc1
    v_cvt_pk_bf16_f32 v168, v168, v169
    v_cvt_pk_bf16_f32 v169, v170, v171
    v_cvt_pk_bf16_f32 v170, v172, v173
    v_cvt_pk_bf16_f32 v171, v174, v175
    v_min_u32 v168, -2, v168
    v_min_u32 v169, -2, v169
    v_min_u32 v170, -2, v170
    v_min_u32 v171, -2, v171
    buffer_store_dwordx4 v[168:171], v1, s[36:39], s52 offen offset:1024 sc1
    v_cvt_pk_bf16_f32 v176, v176, v177
    v_cvt_pk_bf16_f32 v177, v178, v179
    v_cvt_pk_bf16_f32 v178, v180, v181
    v_cvt_pk_bf16_f32 v179, v182, v183
    v_min_u32 v176, -2, v176
    v_min_u32 v177, -2, v177
    v_min_u32 v178, -2, v178
    v_min_u32 v179, -2, v179
    buffer_store_dwordx4 v[176:179], v1, s[36:39], s52 offen offset:2048 sc1
    v_cvt_pk_bf16_f32 v184, v184, v185
    v_cvt_pk_bf16_f32 v185, v186, v187
    v_cvt_pk_bf16_f32 v186, v188, v189
    v_cvt_pk_bf16_f32 v187, v190, v191
    v_min_u32 v184, -2, v184
    v_min_u32 v185, -2, v185
    v_min_u32 v186, -2, v186
    v_min_u32 v187, -2, v187
    buffer_store_dwordx4 v[184:187], v1, s[36:39], s52 offen offset:3072 sc1
    s_add_u32 s32, s6, 0x4800000
    s_addc_u32 s33, s7, 0
    s_and_b32 s33, s33, 0xffff
    s_mov_b32 s34, 0x6000
    s_mov_b32 s35, 0x00020000
    s_waitcnt vmcnt(4) lgkmcnt(0)
    v_lshlrev_b32 v58, 16, v192
    v_and_b32 v59, 0xffff0000, v192
    v_pk_add_f32 v[128:129], v[128:129], v[58:59]
    v_lshlrev_b32 v58, 16, v193
    v_and_b32 v59, 0xffff0000, v193
    v_pk_add_f32 v[130:131], v[130:131], v[58:59]
    v_lshlrev_b32 v58, 16, v200
    v_and_b32 v59, 0xffff0000, v200
    v_pk_add_f32 v[132:133], v[132:133], v[58:59]
    v_lshlrev_b32 v58, 16, v201
    v_and_b32 v59, 0xffff0000, v201
    v_pk_add_f32 v[134:135], v[134:135], v[58:59]
    v_lshlrev_b32 v58, 16, v194
    v_and_b32 v59, 0xffff0000, v194
    v_pk_add_f32 v[136:137], v[136:137], v[58:59]
    v_lshlrev_b32 v58, 16, v195
    v_and_b32 v59, 0xffff0000, v195
    v_pk_add_f32 v[138:139], v[138:139], v[58:59]
    v_lshlrev_b32 v58, 16, v202
    v_and_b32 v59, 0xffff0000, v202
    v_pk_add_f32 v[140:141], v[140:141], v[58:59]
    v_lshlrev_b32 v58, 16, v203
    v_and_b32 v59, 0xffff0000, v203
    v_pk_add_f32 v[142:143], v[142:143], v[58:59]
    v_lshlrev_b32 v58, 16, v196
    v_and_b32 v59, 0xffff0000, v196
    v_pk_add_f32 v[144:145], v[144:145], v[58:59]
    v_lshlrev_b32 v58, 16, v197
    v_and_b32 v59, 0xffff0000, v197
    v_pk_add_f32 v[146:147], v[146:147], v[58:59]
    v_lshlrev_b32 v58, 16, v204
    v_and_b32 v59, 0xffff0000, v204
    v_pk_add_f32 v[148:149], v[148:149], v[58:59]
    v_lshlrev_b32 v58, 16, v205
    v_and_b32 v59, 0xffff0000, v205
    v_pk_add_f32 v[150:151], v[150:151], v[58:59]
    v_lshlrev_b32 v58, 16, v198
    v_and_b32 v59, 0xffff0000, v198
    v_pk_add_f32 v[152:153], v[152:153], v[58:59]
    v_lshlrev_b32 v58, 16, v199
    v_and_b32 v59, 0xffff0000, v199
    v_pk_add_f32 v[154:155], v[154:155], v[58:59]
    v_lshlrev_b32 v58, 16, v206
    v_and_b32 v59, 0xffff0000, v206
    v_pk_add_f32 v[156:157], v[156:157], v[58:59]
    v_lshlrev_b32 v58, 16, v207
    v_and_b32 v59, 0xffff0000, v207
    v_pk_add_f32 v[158:159], v[158:159], v[58:59]
    v_and_b32 v58, 1, v72
    v_lshrrev_b32 v59, 1, v72
    v_lshlrev_b32 v58, 5, v58
    v_lshl_add_u32 v58, v59, 4, v58
    v_lshlrev_b32 v59, 3, v72
    v_sub_u32 v58, v58, v59
    v_add_u32 v78, v78, v58
    v_add_u32 v79, v79, v58
    v_lshlrev_b32 v32, 16, v208
    v_and_b32 v33, 0xffff0000, v208
    v_lshlrev_b32 v34, 16, v209
    v_and_b32 v35, 0xffff0000, v209
    v_lshlrev_b32 v36, 16, v210
    v_and_b32 v37, 0xffff0000, v210
    v_lshlrev_b32 v38, 16, v211
    v_and_b32 v39, 0xffff0000, v211
    v_lshlrev_b32 v40, 16, v212
    v_and_b32 v41, 0xffff0000, v212
    v_lshlrev_b32 v42, 16, v213
    v_and_b32 v43, 0xffff0000, v213
    v_lshlrev_b32 v44, 16, v214
    v_and_b32 v45, 0xffff0000, v214
    v_lshlrev_b32 v46, 16, v215
    v_and_b32 v47, 0xffff0000, v215
    s_or_b32 s31, s54, s30
    s_cbranch_scc1 op_nowr_145
    v_pk_add_f32 v[56:57], v[32:33], v[34:35]
    v_pk_add_f32 v[56:57], v[56:57], v[36:37]
    v_pk_add_f32 v[56:57], v[56:57], v[38:39]
    v_pk_add_f32 v[56:57], v[56:57], v[40:41]
    v_pk_add_f32 v[56:57], v[56:57], v[42:43]
    v_pk_add_f32 v[56:57], v[56:57], v[44:45]
    v_pk_add_f32 v[56:57], v[56:57], v[46:47]
    v_add_f32 v56, v56, v57
    v_mov_b32 v57, v56
    s_nop 1
    v_permlane16_swap_b32 v56, v57
    s_nop 1
    v_add_f32 v56, v56, v57
    v_mov_b32 v57, v56
    s_nop 1
    v_permlane32_swap_b32 v56, v57
    s_nop 1
    v_add_f32 v56, v56, v57
    s_mov_b32 s31, 24704
    s_mov_b32 s34, 24708
    s_mov_b64 exec, 1
    buffer_atomic_add_f32 v56, v75, s[32:35], s31 offen
    s_mov_b64 exec, -1
    s_mov_b32 s34, 24576
op_nowr_145:
    v_mov_b32 v208, 0
    v_mov_b32 v209, 0
    v_mov_b32 v210, 0
    v_mov_b32 v211, 0
    v_mov_b32 v212, 0
    v_mov_b32 v213, 0
    v_mov_b32 v214, 0
    v_mov_b32 v215, 0
    v_mov_b32 v216, 0
    v_mov_b32 v217, 0
    v_mov_b32 v218, 0
    v_mov_b32 v219, 0
    s_mov_b32 s40, 1048576
op_xspin_146:
    buffer_load_dwordx4 v[224:227], v1, s[36:39], s53 offen offset:0 sc1
    buffer_load_dwordx4 v[228:231], v1, s[36:39], s53 offen offset:1024 sc1
    buffer_load_dwordx4 v[232:235], v1, s[36:39], s53 offen offset:2048 sc1
    buffer_load_dwordx4 v[236:239], v1, s[36:39], s53 offen offset:3072 sc1
    s_sub_u32 s40, s40, 1
    s_waitcnt vmcnt(0)
    s_cbranch_scc1 op_xok_147
    v_max3_u32 v56, v224, v225, v226
    v_max3_u32 v56, v56, v227, v228
    v_max3_u32 v56, v56, v229, v230
    v_max3_u32 v56, v56, v231, v232
    v_max3_u32 v56, v56, v233, v234
    v_max3_u32 v56, v56, v235, v236
    v_max3_u32 v56, v56, v237, v238
    v_max_u32 v56, v56, v239
    v_cmp_eq_u32 vcc, -1, v56
    s_cbranch_vccz op_xok_147
    s_sleep 2
    s_branch op_xspin_146
op_xok_147:
    v_lshlrev_b32 v56, 16, v224
    v_and_b32 v57, 0xffff0000, v224
    v_lshlrev_b32 v58, 16, v225
    v_and_b32 v59, 0xffff0000, v225
    v_pk_add_f32 v[128:129], v[128:129], v[56:57]
    v_pk_add_f32 v[130:131], v[130:131], v[58:59]
    v_cvt_pk_bf16_f32 v192, v128, v129
    v_cvt_pk_bf16_f32 v193, v130, v131
    v_lshlrev_b32 v128, 16, v192
    v_and_b32 v129, 0xffff0000, v192
    v_lshlrev_b32 v130, 16, v193
    v_and_b32 v131, 0xffff0000, v193
    v_pk_add_f32 v[208:209], v[208:209], v[128:129]
    v_pk_fma_f32 v[210:211], v[128:129], v[128:129], v[210:211]
    v_pk_fma_f32 v[212:213], v[128:129], v[32:33], v[212:213]
    v_pk_add_f32 v[208:209], v[208:209], v[130:131]
    v_pk_fma_f32 v[210:211], v[130:131], v[130:131], v[210:211]
    v_pk_fma_f32 v[212:213], v[130:131], v[34:35], v[212:213]
    v_lshlrev_b32 v56, 16, v226
    v_and_b32 v57, 0xffff0000, v226
    v_lshlrev_b32 v58, 16, v227
    v_and_b32 v59, 0xffff0000, v227
    v_pk_add_f32 v[132:133], v[132:133], v[56:57]
    v_pk_add_f32 v[134:135], v[134:135], v[58:59]
    v_cvt_pk_bf16_f32 v200, v132, v133
    v_cvt_pk_bf16_f32 v201, v134, v135
    v_lshlrev_b32 v132, 16, v200
    v_and_b32 v133, 0xffff0000, v200
    v_lshlrev_b32 v134, 16, v201
    v_and_b32 v135, 0xffff0000, v201
    v_pk_add_f32 v[214:215], v[214:215], v[132:133]
    v_pk_fma_f32 v[216:217], v[132:133], v[132:133], v[216:217]
    v_pk_fma_f32 v[218:219], v[132:133], v[32:33], v[218:219]
    v_pk_add_f32 v[214:215], v[214:215], v[134:135]
    v_pk_fma_f32 v[216:217], v[134:135], v[134:135], v[216:217]
    v_pk_fma_f32 v[218:219], v[134:135], v[34:35], v[218:219]
    v_lshlrev_b32 v56, 16, v228
    v_and_b32 v57, 0xffff0000, v228
    v_lshlrev_b32 v58, 16, v229
    v_and_b32 v59, 0xffff0000, v229
    v_pk_add_f32 v[136:137], v[136:137], v[56:57]
    v_pk_add_f32 v[138:139], v[138:139], v[58:59]
    v_cvt_pk_bf16_f32 v194, v136, v137
    v_cvt_pk_bf16_f32 v195, v138, v139
    v_lshlrev_b32 v136, 16, v194
    v_and_b32 v137, 0xffff0000, v194
    v_lshlrev_b32 v138, 16, v195
    v_and_b32 v139, 0xffff0000, v195
    v_permlane16_swap_b32 v192, v194
    v_permlane16_swap_b32 v193, v195
    buffer_store_dwordx4 v[192:195], v78, s[24:27], 0 offen offset:0 sc1
    v_pk_add_f32 v[208:209], v[208:209], v[136:137]
    v_pk_fma_f32 v[210:211], v[136:137], v[136:137], v[210:211]
    v_pk_fma_f32 v[212:213], v[136:137], v[36:37], v[212:213]
    v_pk_add_f32 v[208:209], v[208:209], v[138:139]
    v_pk_fma_f32 v[210:211], v[138:139], v[138:139], v[210:211]
    v_pk_fma_f32 v[212:213], v[138:139], v[38:39], v[212:213]
    v_lshlrev_b32 v56, 16, v230
    v_and_b32 v57, 0xffff0000, v230
    v_lshlrev_b32 v58, 16, v231
    v_and_b32 v59, 0xffff0000, v231
    v_pk_add_f32 v[140:141], v[140:141], v[56:57]
    v_pk_add_f32 v[142:143], v[142:143], v[58:59]
    v_cvt_pk_bf16_f32 v202, v140, v141
    v_cvt_pk_bf16_f32 v203, v142, v143
    v_lshlrev_b32 v140, 16, v202
    v_and_b32 v141, 0xffff0000, v202
    v_lshlrev_b32 v142, 16, v203
    v_and_b32 v143, 0xffff0000, v203
    v_permlane16_swap_b32 v200, v202
    v_permlane16_swap_b32 v201, v203
    buffer_store_dwordx4 v[200:203], v79, s[24:27], 0 offen offset:0 sc1
    v_pk_add_f32 v[214:215], v[214:215], v[140:141]
    v_pk_fma_f32 v[216:217], v[140:141], v[140:141], v[216:217]
    v_pk_fma_f32 v[218:219], v[140:141], v[36:37], v[218:219]
    v_pk_add_f32 v[214:215], v[214:215], v[142:143]
    v_pk_fma_f32 v[216:217], v[142:143], v[142:143], v[216:217]
    v_pk_fma_f32 v[218:219], v[142:143], v[38:39], v[218:219]
    v_lshlrev_b32 v56, 16, v232
    v_and_b32 v57, 0xffff0000, v232
    v_lshlrev_b32 v58, 16, v233
    v_and_b32 v59, 0xffff0000, v233
    v_pk_add_f32 v[144:145], v[144:145], v[56:57]
    v_pk_add_f32 v[146:147], v[146:147], v[58:59]
    v_cvt_pk_bf16_f32 v196, v144, v145
    v_cvt_pk_bf16_f32 v197, v146, v147
    v_lshlrev_b32 v144, 16, v196
    v_and_b32 v145, 0xffff0000, v196
    v_lshlrev_b32 v146, 16, v197
    v_and_b32 v147, 0xffff0000, v197
    v_pk_add_f32 v[208:209], v[208:209], v[144:145]
    v_pk_fma_f32 v[210:211], v[144:145], v[144:145], v[210:211]
    v_pk_fma_f32 v[212:213], v[144:145], v[40:41], v[212:213]
    v_pk_add_f32 v[208:209], v[208:209], v[146:147]
    v_pk_fma_f32 v[210:211], v[146:147], v[146:147], v[210:211]
    v_pk_fma_f32 v[212:213], v[146:147], v[42:43], v[212:213]
    v_lshlrev_b32 v56, 16, v234
    v_and_b32 v57, 0xffff0000, v234
    v_lshlrev_b32 v58, 16, v235
    v_and_b32 v59, 0xffff0000, v235
    v_pk_add_f32 v[148:149], v[148:149], v[56:57]
    v_pk_add_f32 v[150:151], v[150:151], v[58:59]
    v_cvt_pk_bf16_f32 v204, v148, v149
    v_cvt_pk_bf16_f32 v205, v150, v151
    v_lshlrev_b32 v148, 16, v204
    v_and_b32 v149, 0xffff0000, v204
    v_lshlrev_b32 v150, 16, v205
    v_and_b32 v151, 0xffff0000, v205
    v_pk_add_f32 v[214:215], v[214:215], v[148:149]
    v_pk_fma_f32 v[216:217], v[148:149], v[148:149], v[216:217]
    v_pk_fma_f32 v[218:219], v[148:149], v[40:41], v[218:219]
    v_pk_add_f32 v[214:215], v[214:215], v[150:151]
    v_pk_fma_f32 v[216:217], v[150:151], v[150:151], v[216:217]
    v_pk_fma_f32 v[218:219], v[150:151], v[42:43], v[218:219]
    v_lshlrev_b32 v56, 16, v236
    v_and_b32 v57, 0xffff0000, v236
    v_lshlrev_b32 v58, 16, v237
    v_and_b32 v59, 0xffff0000, v237
    v_pk_add_f32 v[152:153], v[152:153], v[56:57]
    v_pk_add_f32 v[154:155], v[154:155], v[58:59]
    v_cvt_pk_bf16_f32 v198, v152, v153
    v_cvt_pk_bf16_f32 v199, v154, v155
    v_lshlrev_b32 v152, 16, v198
    v_and_b32 v153, 0xffff0000, v198
    v_lshlrev_b32 v154, 16, v199
    v_and_b32 v155, 0xffff0000, v199
    v_permlane16_swap_b32 v196, v198
    v_permlane16_swap_b32 v197, v199
    buffer_store_dwordx4 v[196:199], v78, s[24:27], 0 offen offset:64 sc1
    v_pk_add_f32 v[208:209], v[208:209], v[152:153]
    v_pk_fma_f32 v[210:211], v[152:153], v[152:153], v[210:211]
    v_pk_fma_f32 v[212:213], v[152:153], v[44:45], v[212:213]
    v_pk_add_f32 v[208:209], v[208:209], v[154:155]
    v_pk_fma_f32 v[210:211], v[154:155], v[154:155], v[210:211]
    v_pk_fma_f32 v[212:213], v[154:155], v[46:47], v[212:213]
    v_lshlrev_b32 v56, 16, v238
    v_and_b32 v57, 0xffff0000, v238
    v_lshlrev_b32 v58, 16, v239
    v_and_b32 v59, 0xffff0000, v239
    v_pk_add_f32 v[156:157], v[156:157], v[56:57]
    v_pk_add_f32 v[158:159], v[158:159], v[58:59]
    v_cvt_pk_bf16_f32 v206, v156, v157
    v_cvt_pk_bf16_f32 v207, v158, v159
    v_lshlrev_b32 v156, 16, v206
    v_and_b32 v157, 0xffff0000, v206
    v_lshlrev_b32 v158, 16, v207
    v_and_b32 v159, 0xffff0000, v207
    v_permlane16_swap_b32 v204, v206
    v_permlane16_swap_b32 v205, v207
    buffer_store_dwordx4 v[204:207], v79, s[24:27], 0 offen offset:64 sc1
    v_pk_add_f32 v[214:215], v[214:215], v[156:157]
    v_pk_fma_f32 v[216:217], v[156:157], v[156:157], v[216:217]
    v_pk_fma_f32 v[218:219], v[156:157], v[44:45], v[218:219]
    v_pk_add_f32 v[214:215], v[214:215], v[158:159]
    v_pk_fma_f32 v[216:217], v[158:159], v[158:159], v[216:217]
    v_pk_fma_f32 v[218:219], v[158:159], v[46:47], v[218:219]
    v_add_f32 v48, v208, v209
    v_add_f32 v49, v210, v211
    v_add_f32 v50, v212, v213
    v_add_f32 v52, v214, v215
    v_add_f32 v53, v216, v217
    v_add_f32 v54, v218, v219
    v_mov_b32 v56, v48
    v_mov_b32 v57, v49
    v_mov_b32 v58, v50
    v_mov_b32 v59, v52
    v_mov_b32 v60, v53
    v_mov_b32 v61, v54
    s_nop 1
    v_permlane16_swap_b32 v48, v56
    v_permlane16_swap_b32 v49, v57
    v_permlane16_swap_b32 v50, v58
    v_permlane16_swap_b32 v52, v59
    v_permlane16_swap_b32 v53, v60
    v_permlane16_swap_b32 v54, v61
    s_nop 1
    v_add_f32 v48, v48, v56
    v_add_f32 v49, v49, v57
    v_add_f32 v50, v50, v58
    v_add_f32 v52, v52, v59
    v_add_f32 v53, v53, v60
    v_add_f32 v54, v54, v61
    v_mov_b32 v56, v48
    v_mov_b32 v57, v49
    v_mov_b32 v58, v50
    v_mov_b32 v59, v52
    v_mov_b32 v60, v53
    v_mov_b32 v61, v54
    s_nop 1
    v_permlane32_swap_b32 v48, v56
    v_permlane32_swap_b32 v49, v57
    v_permlane32_swap_b32 v50, v58
    v_permlane32_swap_b32 v52, v59
    v_permlane32_swap_b32 v53, v60
    v_permlane32_swap_b32 v54, v61
    s_nop 1
    v_add_f32 v48, v48, v56
    v_add_f32 v49, v49, v57
    v_add_f32 v50, v50, v58
    v_add_f32 v52, v52, v59
    v_add_f32 v53, v53, v60
    v_add_f32 v54, v54, v61
    v_cmp_eq_u32 s[40:41], 1, v72
    v_cmp_eq_u32 s[42:43], 2, v72
    s_nop 1
    v_cndmask_b32 v48, v48, v49, s[40:41]
    v_cndmask_b32 v48, v48, v50, s[42:43]
    buffer_atomic_add_f32 v48, v77, s[32:35], 0 offen offset:0
    v_cndmask_b32 v52, v52, v53, s[40:41]
    v_cndmask_b32 v52, v52, v54, s[42:43]
    buffer_atomic_add_f32 v52, v77, s[32:35], 0 offen offset:64
    s_load_dwordx2 s[42:43], s[0:1], 88
    s_load_dwordx2 s[56:57], s[0:1], 56
    s_add_u32 s16, s6, 0x4815000
    s_addc_u32 s17, s7, 0
    s_and_b32 s17, s17, 0xffff
    s_mov_b32 s18, 0x1000
    s_mov_b32 s19, 0x00020000
    v_lshrrev_b32 v3, 4, v1
    v_lshl_add_u32 v2, s30, 6, v3
    v_and_b32 v4, 31, v3
    v_lshrrev_b32 v5, 5, v3
    v_lshlrev_b32 v7, 4, v4
    v_and_b32 v8, 15, v3
    v_lshlrev_b32 v6, 7, v8
    s_bfe_u32 s31, s2, 0x20003
    s_lshl_b32 s31, s31, 7
    v_lshlrev_b32 v12, 9, v3
    v_and_b32 v14, 3, v3
    v_lshlrev_b32 v14, 7, v14
    s_and_b32 s59, s2, 7
    s_lshl_b32 s59, s59, 9
    s_setreg_imm32_b32 hwreg(HW_REG_MODE, 4, 2), 3
    s_waitcnt vmcnt(0) lgkmcnt(0)
    s_barrier
    s_cmp_lg_u32 s30, 0
    s_cbranch_scc1 ff_nosig_148
    s_mov_b64 exec, 0xff
    buffer_atomic_add v76, v12, s[16:19], s31 offen sc1
    s_mov_b64 exec, -1
ff_nosig_148:
    s_lshl_b32 s40, s30, 13
    s_add_u32 m0, s40, 65536
    s_add_u32 s41, s3, 0
    buffer_load_dwordx4 v1, s[44:47], s41 offen offset:0 sc1 lds
    buffer_load_dwordx4 v1, s[44:47], s41 offen offset:1024 sc1 lds
    buffer_load_dwordx4 v1, s[44:47], s41 offen offset:2048 sc1 lds
    buffer_load_dwordx4 v1, s[44:47], s41 offen offset:3072 sc1 lds
    s_lshl_b32 s41, s30, 9
    s_add_u32 s41, s41, 131072
    v_lshrrev_b32 v9, 1, v1
    v_add_u32 v9, s41, v9
    ds_read_b64 v[96:97], v9 offset:0
    ds_read_b64 v[98:99], v9 offset:2048
    ds_read_b64 v[100:101], v9 offset:4096
    ds_read_b64 v[102:103], v9 offset:6144
    ds_read_b64 v[104:105], v9 offset:8192
    ds_read_b64 v[106:107], v9 offset:10240
    ds_read_b64 v[108:109], v9 offset:12288
    ds_read_b64 v[110:111], v9 offset:14336
    ds_read_b64 v[112:113], v9 offset:16384
    ds_read_b64 v[114:115], v9 offset:18432
    ds_read_b64 v[116:117], v9 offset:20480
    ds_read_b64 v[118:119], v9 offset:22528
    ds_read_b64 v[120:121], v9 offset:24576
    ds_read_b64 v[122:123], v9 offset:26624
    ds_read_b64 v[124:125], v9 offset:28672
    ds_read_b64 v[126:127], v9 offset:30720
    s_mov_b32 s54, 0x05040100
    s_mov_b32 s53, 0x07060302
    s_waitcnt lgkmcnt(0)
    v_perm_b32 v144, v98, v96, s54
    v_perm_b32 v145, v98, v96, s53
    v_perm_b32 v146, v99, v97, s54
    v_perm_b32 v147, v99, v97, s53
    v_perm_b32 v148, v102, v100, s54
    v_perm_b32 v149, v102, v100, s53
    v_perm_b32 v150, v103, v101, s54
    v_perm_b32 v151, v103, v101, s53
    v_perm_b32 v152, v106, v104, s54
    v_perm_b32 v153, v106, v104, s53
    v_perm_b32 v154, v107, v105, s54
    v_perm_b32 v155, v107, v105, s53
    v_perm_b32 v156, v110, v108, s54
    v_perm_b32 v157, v110, v108, s53
    v_perm_b32 v158, v111, v109, s54
    v_perm_b32 v159, v111, v109, s53
    v_perm_b32 v160, v114, v112, s54
    v_perm_b32 v161, v114, v112, s53
    v_perm_b32 v162, v115, v113, s54
    v_perm_b32 v163, v115, v113, s53
    v_perm_b32 v164, v118, v116, s54
    v_perm_b32 v165, v118, v116, s53
    v_perm_b32 v166, v119, v117, s54
    v_perm_b32 v167, v119, v117, s53
    v_perm_b32 v168, v122, v120, s54
    v_perm_b32 v169, v122, v120, s53
    v_perm_b32 v170, v123, v121, s54
    v_perm_b32 v171, v123, v121, s53
    v_perm_b32 v172, v126, v124, s54
    v_perm_b32 v173, v126, v124, s53
    v_perm_b32 v174, v127, v125, s54
    v_perm_b32 v175, v127, v125, s53
    s_waitcnt vmcnt(0)
    s_lshl_b32 s40, s30, 13
    s_add_u32 m0, s40, 69632
    s_add_u32 s41, s3, 4096
    buffer_load_dwordx4 v1, s[44:47], s41 offen offset:0 sc1 lds
    buffer_load_dwordx4 v1, s[44:47], s41 offen offset:1024 sc1 lds
    buffer_load_dwordx4 v1, s[44:47], s41 offen offset:2048 sc1 lds
    buffer_load_dwordx4 v1, s[44:47], s41 offen offset:3072 sc1 lds
    s_waitcnt vmcnt(0)
    s_lshl_b32 s40, s30, 13
    s_add_u32 m0, s40, 98304
    s_add_u32 s41, s3, 8388608
    buffer_load_dwordx4 v1, s[44:47], s41 offen offset:0 sc1 lds
    buffer_load_dwordx4 v1, s[44:47], s41 offen offset:1024 sc1 lds
    buffer_load_dwordx4 v1, s[44:47], s41 offen offset:2048 sc1 lds
    buffer_load_dwordx4 v1, s[44:47], s41 offen offset:3072 sc1 lds
    s_waitcnt vmcnt(0)
    s_lshl_b32 s40, s30, 13
    s_add_u32 m0, s40, 102400
    s_add_u32 s41, s3, 8392704
    buffer_load_dwordx4 v1, s[44:47], s41 offen offset:0 sc1 lds
    buffer_load_dwordx4 v1, s[44:47], s41 offen offset:1024 sc1 lds
    buffer_load_dwordx4 v1, s[44:47], s41 offen offset:2048 sc1 lds
    buffer_load_dwordx4 v1, s[44:47], s41 offen offset:3072 sc1 lds
    s_mov_b32 s34, 24708
    s_mov_b32 s36, s42
    s_and_b32 s37, s43, 0xffff
    s_mov_b32 s38, 0x400000
    s_mov_b32 s39, 0x00020000
    s_add_u32 s48, s6, 0x4900000
    s_addc_u32 s49, s7, 0
    s_and_b32 s49, s49, 0xffff
    s_mov_b32 s50, 0xe0000
    s_mov_b32 s51, 0x00020000
    v_lshlrev_b32 v10, 5, v2
    v_lshl_add_u32 v11, s30, 1, v5
    s_lshl_b32 s31, s2, 3
    v_add_u32 v11, s31, v11
    v_lshl_add_u32 v0, v11, 11, v7
    s_cmp_lg_u32 s30, 0
    s_cbranch_scc1 ff_go_149
    s_mov_b32 s52, 1048576
ff_poll_150:
    buffer_load_dword v13, v14, s[16:19], s59 offen sc1
    s_sub_u32 s52, s52, 1
    s_cbranch_scc1 ff_go_149
    s_waitcnt vmcnt(0)
    v_cmp_gt_u32 vcc, 64, v13
    s_cbranch_vccz ff_go_149
    s_sleep 4
    s_branch ff_poll_150
ff_go_149:
    s_barrier
    s_mov_b32 s31, 0
    buffer_load_dwordx4 v[16:19], v10, s[32:35], s31 offen sc1
    buffer_load_dwordx4 v[20:23], v10, s[32:35], s31 offen offset:16 sc1
    s_mov_b32 s31, 8192
    buffer_load_dwordx4 v[24:27], v10, s[32:35], s31 offen sc1
    buffer_load_dwordx4 v[28:31], v10, s[32:35], s31 offen offset:16 sc1
    s_mov_b32 s31, 16384
    buffer_load_dwordx4 v[32:35], v10, s[32:35], s31 offen sc1
    buffer_load_dwordx4 v[36:39], v10, s[32:35], s31 offen offset:16 sc1
    s_mov_b32 s31, 24704
    buffer_load_dword v10, v75, s[32:35], s31 offen sc1
    s_mov_b32 s52, 0x3a800000
    s_mov_b32 s53, 0x3a800000
    s_mov_b32 s54, 0x7ff
    v_mov_b32 v14, 0x3727c5ac
    v_mov_b32 v15, v14
    v_mov_b32 v12, 0xff800000
    v_mov_b32 v13, v12
    s_waitcnt vmcnt(0)
    v_sub_f32 v56, 0, v10
    v_sub_f32 v57, 0, v10
    v_pk_mul_f32 v[16:17], v[16:17], s[52:53]
    v_pk_fma_f32 v[24:25], v[24:25], s[52:53], v[14:15]
    v_pk_fma_f32 v[32:33], v[16:17], v[56:57], v[32:33]
    v_pk_fma_f32 v[24:25], v[16:17], v[16:17], v[24:25] neg_lo:[1,0,0] neg_hi:[1,0,0]
    v_pk_mul_f32 v[18:19], v[18:19], s[52:53]
    v_pk_fma_f32 v[26:27], v[26:27], s[52:53], v[14:15]
    v_pk_fma_f32 v[34:35], v[18:19], v[56:57], v[34:35]
    v_pk_fma_f32 v[26:27], v[18:19], v[18:19], v[26:27] neg_lo:[1,0,0] neg_hi:[1,0,0]
    v_pk_mul_f32 v[20:21], v[20:21], s[52:53]
    v_pk_fma_f32 v[28:29], v[28:29], s[52:53], v[14:15]
    v_pk_fma_f32 v[36:37], v[20:21], v[56:57], v[36:37]
    v_pk_fma_f32 v[28:29], v[20:21], v[20:21], v[28:29] neg_lo:[1,0,0] neg_hi:[1,0,0]
    v_pk_mul_f32 v[22:23], v[22:23], s[52:53]
    v_pk_fma_f32 v[30:31], v[30:31], s[52:53], v[14:15]
    v_pk_fma_f32 v[38:39], v[22:23], v[56:57], v[38:39]
    v_pk_fma_f32 v[30:31], v[22:23], v[22:23], v[30:31] neg_lo:[1,0,0] neg_hi:[1,0,0]
    v_max_f32 v24, v14, v24
    v_max_f32 v25, v14, v25
    v_max_f32 v26, v14, v26
    v_max_f32 v27, v14, v27
    v_max_f32 v28, v14, v28
    v_max_f32 v29, v14, v29
    v_max_f32 v30, v14, v30
    v_max_f32 v31, v14, v31
    v_rsq_f32 v24, v24
    v_rsq_f32 v25, v25
    v_rsq_f32 v26, v26
    v_rsq_f32 v27, v27
    v_rsq_f32 v28, v28
    v_rsq_f32 v29, v29
    v_rsq_f32 v30, v30
    v_rsq_f32 v31, v31
    v_pk_mul_f32 v[32:33], v[32:33], v[24:25]
    v_pk_mul_f32 v[34:35], v[34:35], v[26:27]
    v_pk_mul_f32 v[36:37], v[36:37], v[28:29]
    v_pk_mul_f32 v[38:39], v[38:39], v[30:31]
    v_bfi_b32 v32, s54, 0, v32
    v_med3_f32 v13, v12, v13, v32
    v_max_f32 v12, v12, v32
    v_bfi_b32 v33, s54, 1, v33
    v_med3_f32 v13, v12, v13, v33
    v_max_f32 v12, v12, v33
    v_bfi_b32 v34, s54, 2, v34
    v_med3_f32 v13, v12, v13, v34
    v_max_f32 v12, v12, v34
    v_bfi_b32 v35, s54, 3, v35
    v_med3_f32 v13, v12, v13, v35
    v_max_f32 v12, v12, v35
    v_bfi_b32 v36, s54, 4, v36
    v_med3_f32 v13, v12, v13, v36
    v_max_f32 v12, v12, v36
    v_bfi_b32 v37, s54, 5, v37
    v_med3_f32 v13, v12, v13, v37
    v_max_f32 v12, v12, v37
    v_bfi_b32 v38, s54, 6, v38
    v_med3_f32 v13, v12, v13, v38
    v_max_f32 v12, v12, v38
    v_bfi_b32 v39, s54, 7, v39
    v_med3_f32 v13, v12, v13, v39
    v_max_f32 v12, v12, v39
    v_lshl_or_b32 v12, v2, 3, v12
    v_lshl_or_b32 v13, v2, 3, v13
    s_nop 1
    v_mov_b32_dpp v14, v12 quad_perm:[1,0,3,2] row_mask:0xf bank_mask:0xf
    v_mov_b32_dpp v15, v13 quad_perm:[1,0,3,2] row_mask:0xf bank_mask:0xf
    v_max_f32 v15, v15, v13
    v_med3_f32 v13, v12, v14, v15
    v_max_f32 v12, v12, v14
    s_nop 1
    v_mov_b32_dpp v14, v12 quad_perm:[2,3,0,1] row_mask:0xf bank_mask:0xf
    v_mov_b32_dpp v15, v13 quad_perm:[2,3,0,1] row_mask:0xf bank_mask:0xf
    v_max_f32 v15, v15, v13
    v_med3_f32 v13, v12, v14, v15
    v_max_f32 v12, v12, v14
    s_nop 1
    v_mov_b32_dpp v14, v12 row_half_mirror row_mask:0xf bank_mask:0xf
    v_mov_b32_dpp v15, v13 row_half_mirror row_mask:0xf bank_mask:0xf
    v_max_f32 v15, v15, v13
    v_med3_f32 v13, v12, v14, v15
    v_max_f32 v12, v12, v14
    s_nop 1
    v_mov_b32_dpp v14, v12 row_mirror row_mask:0xf bank_mask:0xf
    v_mov_b32_dpp v15, v13 row_mirror row_mask:0xf bank_mask:0xf
    v_max_f32 v15, v15, v13
    v_med3_f32 v13, v12, v14, v15
    v_max_f32 v12, v12, v14
    v_mov_b32 v14, v12
    v_mov_b32 v15, v13
    s_nop 1
    v_permlane16_swap_b32 v12, v14
    v_permlane16_swap_b32 v13, v15
    s_nop 1
    v_max_f32 v15, v15, v13
    v_med3_f32 v13, v12, v14, v15
    v_max_f32 v12, v12, v14
    v_mov_b32 v14, v12
    v_mov_b32 v15, v13
    s_nop 1
    v_permlane32_swap_b32 v12, v14
    v_permlane32_swap_b32 v13, v15
    s_nop 1
    v_max_f32 v15, v15, v13
    v_med3_f32 v13, v12, v14, v15
    v_max_f32 v12, v12, v14
    s_lshl_b32 s31, s30, 3
    s_add_u32 s31, s31, 8192
    v_mov_b32 v14, s31
    ds_write_b64 v14, v[12:13]
    v_mov_b32 v14, 8192
    s_waitcnt lgkmcnt(0)
    s_barrier
    ds_read_b128 v[16:19], v14
    ds_read_b128 v[20:23], v14 offset:16
    v_cmp_eq_u32 vcc, 0, v5
    s_waitcnt lgkmcnt(0)
    v_max_f32 v19, v19, v17
    v_med3_f32 v17, v16, v18, v19
    v_max_f32 v16, v16, v18
    v_max_f32 v23, v23, v21
    v_med3_f32 v21, v20, v22, v23
    v_max_f32 v20, v20, v22
    v_max_f32 v21, v21, v17
    v_med3_f32 v17, v16, v20, v21
    v_max_f32 v16, v16, v20
    v_and_b32 v16, 0x7ff, v16
    v_and_b32 v17, 0x7ff, v17
    v_cndmask_b32 v15, v17, v16, vcc
    v_lshl_add_u32 v12, v15, 11, v7
    buffer_load_dwordx4 v[40:43], v12, s[24:27], 0 offen offset:0 sc1
    buffer_load_dwordx4 v[44:47], v12, s[24:27], 0 offen offset:512 sc1
    buffer_load_dwordx4 v[48:51], v12, s[24:27], 0 offen offset:1024 sc1
    buffer_load_dwordx4 v[52:55], v12, s[24:27], 0 offen offset:1536 sc1
    buffer_load_dwordx4 v[128:131], v0, s[24:27], 0 offen offset:0 sc1
    buffer_load_dwordx4 v[132:135], v0, s[24:27], 0 offen offset:512 sc1
    buffer_load_dwordx4 v[136:139], v0, s[24:27], 0 offen offset:1024 sc1
    buffer_load_dwordx4 v[140:143], v0, s[24:27], 0 offen offset:1536 sc1
    v_cmp_eq_u32 vcc, v16, v11
    v_cmp_eq_u32 s[52:53], v17, v11
    v_mov_b32 v13, 0x7fffffff
    s_or_b64 vcc, vcc, s[52:53]
    v_cndmask_b32 v0, v0, v13, vcc
    v_lshl_add_u32 v12, v5, 11, v7
    v_add_u32 v12, 4096, v12
    s_mov_b32 s58, 0
    s_waitcnt vmcnt(8)
    v_lshlrev_b32 v14, 3, v3
    s_lshl_b32 s54, s30, 13
    s_add_u32 s54, s54, 65536
    v_add_u32 v14, s54, v14
    ds_read_b64_tr_b16 a[0:1], v14 offset:0
    ds_read_b64_tr_b16 a[2:3], v14 offset:512
    ds_read_b64_tr_b16 a[4:5], v14 offset:1024
    ds_read_b64_tr_b16 a[6:7], v14 offset:1536
    ds_read_b64_tr_b16 a[8:9], v14 offset:2048
    ds_read_b64_tr_b16 a[10:11], v14 offset:2560
    ds_read_b64_tr_b16 a[12:13], v14 offset:3072
    ds_read_b64_tr_b16 a[14:15], v14 offset:3584
    ds_read_b64_tr_b16 a[16:17], v14 offset:4096
    ds_read_b64_tr_b16 a[18:19], v14 offset:4608
    ds_read_b64_tr_b16 a[20:21], v14 offset:5120
    ds_read_b64_tr_b16 a[22:23], v14 offset:5632
    ds_read_b64_tr_b16 a[24:25], v14 offset:6144
    ds_read_b64_tr_b16 a[26:27], v14 offset:6656
    ds_read_b64_tr_b16 a[28:29], v14 offset:7168
    ds_read_b64_tr_b16 a[30:31], v14 offset:7680
    ds_read_b64_tr_b16 a[32:33], v14 offset:32768
    ds_read_b64_tr_b16 a[34:35], v14 offset:33280
    ds_read_b64_tr_b16 a[36:37], v14 offset:33792
    ds_read_b64_tr_b16 a[38:39], v14 offset:34304
    ds_read_b64_tr_b16 a[40:41], v14 offset:34816
    ds_read_b64_tr_b16 a[42:43], v14 offset:35328
    ds_read_b64_tr_b16 a[44:45], v14 offset:35840
    ds_read_b64_tr_b16 a[46:47], v14 offset:36352
    ds_read_b64_tr_b16 a[48:49], v14 offset:36864
    ds_read_b64_tr_b16 a[50:51], v14 offset:37376
    ds_read_b64_tr_b16 a[52:53], v14 offset:37888
    ds_read_b64_tr_b16 a[54:55], v14 offset:38400
    ds_read_b64_tr_b16 a[56:57], v14 offset:38912
    ds_read_b64_tr_b16 a[58:59], v14 offset:39424
    ds_read_b64_tr_b16 a[60:61], v14 offset:39936
    ds_read_b64_tr_b16 a[62:63], v14 offset:40448
    s_waitcnt vmcnt(4)
ff_ln_151:
    v_lshlrev_b32 v216, 16, v40
    v_and_b32 v217, 0xffff0000, v40
    v_lshlrev_b32 v218, 16, v41
    v_and_b32 v219, 0xffff0000, v41
    v_lshlrev_b32 v220, 16, v42
    v_and_b32 v221, 0xffff0000, v42
    v_lshlrev_b32 v222, 16, v43
    v_and_b32 v223, 0xffff0000, v43
    v_lshlrev_b32 v224, 16, v44
    v_and_b32 v225, 0xffff0000, v44
    v_lshlrev_b32 v226, 16, v45
    v_and_b32 v227, 0xffff0000, v45
    v_lshlrev_b32 v228, 16, v46
    v_and_b32 v229, 0xffff0000, v46
    v_lshlrev_b32 v230, 16, v47
    v_and_b32 v231, 0xffff0000, v47
    v_lshlrev_b32 v232, 16, v48
    v_and_b32 v233, 0xffff0000, v48
    v_lshlrev_b32 v234, 16, v49
    v_and_b32 v235, 0xffff0000, v49
    v_lshlrev_b32 v236, 16, v50
    v_and_b32 v237, 0xffff0000, v50
    v_lshlrev_b32 v238, 16, v51
    v_and_b32 v239, 0xffff0000, v51
    v_lshlrev_b32 v240, 16, v52
    v_and_b32 v241, 0xffff0000, v52
    v_lshlrev_b32 v242, 16, v53
    v_and_b32 v243, 0xffff0000, v53
    v_lshlrev_b32 v244, 16, v54
    v_and_b32 v245, 0xffff0000, v54
    v_lshlrev_b32 v246, 16, v55
    v_and_b32 v247, 0xffff0000, v55
    v_pk_add_f32 v[208:209], v[216:217], v[218:219]
    v_pk_add_f32 v[210:211], v[220:221], v[222:223]
    v_pk_add_f32 v[208:209], v[208:209], v[224:225]
    v_pk_add_f32 v[210:211], v[210:211], v[226:227]
    v_pk_add_f32 v[208:209], v[208:209], v[228:229]
    v_pk_add_f32 v[210:211], v[210:211], v[230:231]
    v_pk_add_f32 v[208:209], v[208:209], v[232:233]
    v_pk_add_f32 v[210:211], v[210:211], v[234:235]
    v_pk_add_f32 v[208:209], v[208:209], v[236:237]
    v_pk_add_f32 v[210:211], v[210:211], v[238:239]
    v_pk_add_f32 v[208:209], v[208:209], v[240:241]
    v_pk_add_f32 v[210:211], v[210:211], v[242:243]
    v_pk_add_f32 v[208:209], v[208:209], v[244:245]
    v_pk_add_f32 v[210:211], v[210:211], v[246:247]
    v_pk_add_f32 v[208:209], v[208:209], v[210:211]
    v_add_f32 v208, v208, v209
    s_nop 1
    v_add_f32_dpp v208, v208, v208 quad_perm:[1,0,3,2] row_mask:0xf bank_mask:0xf
    s_nop 1
    v_add_f32_dpp v208, v208, v208 quad_perm:[2,3,0,1] row_mask:0xf bank_mask:0xf
    s_nop 1
    v_add_f32_dpp v208, v208, v208 row_half_mirror row_mask:0xf bank_mask:0xf
    s_nop 1
    v_add_f32_dpp v208, v208, v208 row_mirror row_mask:0xf bank_mask:0xf
    v_mov_b32 v210, v208
    s_nop 1
    v_permlane16_swap_b32 v208, v210
    s_nop 1
    v_add_f32 v208, v208, v210
    v_mul_f32 v208, 0xba800000, v208
    v_mov_b32 v209, v208
    v_pk_add_f32 v[210:211], v[216:217], v[208:209]
    v_pk_add_f32 v[214:215], v[218:219], v[208:209]
    v_pk_mul_f32 v[212:213], v[210:211], v[210:211]
    v_pk_fma_f32 v[212:213], v[214:215], v[214:215], v[212:213]
    v_pk_add_f32 v[210:211], v[220:221], v[208:209]
    v_pk_add_f32 v[214:215], v[222:223], v[208:209]
    v_pk_fma_f32 v[212:213], v[210:211], v[210:211], v[212:213]
    v_pk_fma_f32 v[212:213], v[214:215], v[214:215], v[212:213]
    v_pk_add_f32 v[210:211], v[224:225], v[208:209]
    v_pk_add_f32 v[214:215], v[226:227], v[208:209]
    v_pk_fma_f32 v[212:213], v[210:211], v[210:211], v[212:213]
    v_pk_fma_f32 v[212:213], v[214:215], v[214:215], v[212:213]
    v_pk_add_f32 v[210:211], v[228:229], v[208:209]
    v_pk_add_f32 v[214:215], v[230:231], v[208:209]
    v_pk_fma_f32 v[212:213], v[210:211], v[210:211], v[212:213]
    v_pk_fma_f32 v[212:213], v[214:215], v[214:215], v[212:213]
    v_pk_add_f32 v[210:211], v[232:233], v[208:209]
    v_pk_add_f32 v[214:215], v[234:235], v[208:209]
    v_pk_fma_f32 v[212:213], v[210:211], v[210:211], v[212:213]
    v_pk_fma_f32 v[212:213], v[214:215], v[214:215], v[212:213]
    v_pk_add_f32 v[210:211], v[236:237], v[208:209]
    v_pk_add_f32 v[214:215], v[238:239], v[208:209]
    v_pk_fma_f32 v[212:213], v[210:211], v[210:211], v[212:213]
    v_pk_fma_f32 v[212:213], v[214:215], v[214:215], v[212:213]
    v_pk_add_f32 v[210:211], v[240:241], v[208:209]
    v_pk_add_f32 v[214:215], v[242:243], v[208:209]
    v_pk_fma_f32 v[212:213], v[210:211], v[210:211], v[212:213]
    v_pk_fma_f32 v[212:213], v[214:215], v[214:215], v[212:213]
    v_pk_add_f32 v[210:211], v[244:245], v[208:209]
    v_pk_add_f32 v[214:215], v[246:247], v[208:209]
    v_pk_fma_f32 v[212:213], v[210:211], v[210:211], v[212:213]
    v_pk_fma_f32 v[212:213], v[214:215], v[214:215], v[212:213]
    v_add_f32 v212, v212, v213
    s_nop 1
    v_add_f32_dpp v212, v212, v212 quad_perm:[1,0,3,2] row_mask:0xf bank_mask:0xf
    s_nop 1
    v_add_f32_dpp v212, v212, v212 quad_perm:[2,3,0,1] row_mask:0xf bank_mask:0xf
    s_nop 1
    v_add_f32_dpp v212, v212, v212 row_half_mirror row_mask:0xf bank_mask:0xf
    s_nop 1
    v_add_f32_dpp v212, v212, v212 row_mirror row_mask:0xf bank_mask:0xf
    v_mov_b32 v210, v212
    s_nop 1
    v_permlane16_swap_b32 v212, v210
    s_nop 1
    v_add_f32 v212, v212, v210
    v_mul_f32 v212, 0x3a800000, v212
    v_cvt_pk_bf16_f32 v214, v208, v212
    v_and_b32 v212, 0xffff0000, v214
    v_lshlrev_b32 v214, 16, v214
    v_add_f32 v212, 0x3727c5ac, v212
    v_mov_b32 v215, v214
    v_cvt_pk_bf16_f32 v212, v212, v212
    v_and_b32 v212, 0xffff0000, v212
    v_sqrt_f32 v212, v212
    v_pk_add_f32 v[176:177], v[216:217], v[214:215]
    v_pk_add_f32 v[178:179], v[218:219], v[214:215]
    v_pk_add_f32 v[180:181], v[220:221], v[214:215]
    v_pk_add_f32 v[182:183], v[222:223], v[214:215]
    v_pk_add_f32 v[184:185], v[224:225], v[214:215]
    v_pk_add_f32 v[186:187], v[226:227], v[214:215]
    v_pk_add_f32 v[188:189], v[228:229], v[214:215]
    v_pk_add_f32 v[190:191], v[230:231], v[214:215]
    v_pk_add_f32 v[192:193], v[232:233], v[214:215]
    v_pk_add_f32 v[194:195], v[234:235], v[214:215]
    v_pk_add_f32 v[196:197], v[236:237], v[214:215]
    v_pk_add_f32 v[198:199], v[238:239], v[214:215]
    v_pk_add_f32 v[200:201], v[240:241], v[214:215]
    v_pk_add_f32 v[202:203], v[242:243], v[214:215]
    v_pk_add_f32 v[204:205], v[244:245], v[214:215]
    v_pk_add_f32 v[206:207], v[246:247], v[214:215]
    v_cvt_pk_bf16_f32 v212, v212, v212
    v_and_b32 v212, 0xffff0000, v212
    v_rcp_f32 v212, v212
    v_cvt_pk_bf16_f32 v40, v176, v177
    v_cvt_pk_bf16_f32 v41, v178, v179
    v_cvt_pk_bf16_f32 v42, v180, v181
    v_cvt_pk_bf16_f32 v43, v182, v183
    v_cvt_pk_bf16_f32 v44, v184, v185
    v_cvt_pk_bf16_f32 v45, v186, v187
    v_cvt_pk_bf16_f32 v46, v188, v189
    v_cvt_pk_bf16_f32 v47, v190, v191
    v_cvt_pk_bf16_f32 v48, v192, v193
    v_cvt_pk_bf16_f32 v49, v194, v195
    v_cvt_pk_bf16_f32 v50, v196, v197
    v_cvt_pk_bf16_f32 v51, v198, v199
    v_cvt_pk_bf16_f32 v52, v200, v201
    v_cvt_pk_bf16_f32 v53, v202, v203
    v_cvt_pk_bf16_f32 v54, v204, v205
    v_cvt_pk_bf16_f32 v55, v206, v207
    v_mov_b32 v213, v212
    v_lshlrev_b32 v176, 16, v40
    v_and_b32 v177, 0xffff0000, v40
    v_lshlrev_b32 v178, 16, v41
    v_and_b32 v179, 0xffff0000, v41
    v_lshlrev_b32 v180, 16, v42
    v_and_b32 v181, 0xffff0000, v42
    v_lshlrev_b32 v182, 16, v43
    v_and_b32 v183, 0xffff0000, v43
    v_lshlrev_b32 v184, 16, v44
    v_and_b32 v185, 0xffff0000, v44
    v_lshlrev_b32 v186, 16, v45
    v_and_b32 v187, 0xffff0000, v45
    v_lshlrev_b32 v188, 16, v46
    v_and_b32 v189, 0xffff0000, v46
    v_lshlrev_b32 v190, 16, v47
    v_and_b32 v191, 0xffff0000, v47
    v_lshlrev_b32 v192, 16, v48
    v_and_b32 v193, 0xffff0000, v48
    v_lshlrev_b32 v194, 16, v49
    v_and_b32 v195, 0xffff0000, v49
    v_lshlrev_b32 v196, 16, v50
    v_and_b32 v197, 0xffff0000, v50
    v_lshlrev_b32 v198, 16, v51
    v_and_b32 v199, 0xffff0000, v51
    v_lshlrev_b32 v200, 16, v52
    v_and_b32 v201, 0xffff0000, v52
    v_lshlrev_b32 v202, 16, v53
    v_and_b32 v203, 0xffff0000, v53
    v_lshlrev_b32 v204, 16, v54
    v_and_b32 v205, 0xffff0000, v54
    v_lshlrev_b32 v206, 16, v55
    v_and_b32 v207, 0xffff0000, v55
    v_pk_mul_f32 v[176:177], v[176:177], v[212:213]
    v_pk_mul_f32 v[178:179], v[178:179], v[212:213]
    v_pk_mul_f32 v[180:181], v[180:181], v[212:213]
    v_pk_mul_f32 v[182:183], v[182:183], v[212:213]
    v_pk_mul_f32 v[184:185], v[184:185], v[212:213]
    v_pk_mul_f32 v[186:187], v[186:187], v[212:213]
    v_pk_mul_f32 v[188:189], v[188:189], v[212:213]
    v_pk_mul_f32 v[190:191], v[190:191], v[212:213]
    v_pk_mul_f32 v[192:193], v[192:193], v[212:213]
    v_pk_mul_f32 v[194:195], v[194:195], v[212:213]
    v_pk_mul_f32 v[196:197], v[196:197], v[212:213]
    v_pk_mul_f32 v[198:199], v[198:199], v[212:213]
    v_pk_mul_f32 v[200:201], v[200:201], v[212:213]
    v_pk_mul_f32 v[202:203], v[202:203], v[212:213]
    v_pk_mul_f32 v[204:205], v[204:205], v[212:213]
    v_pk_mul_f32 v[206:207], v[206:207], v[212:213]
    v_cvt_pk_bf16_f32 v40, v176, v177
    v_cvt_pk_bf16_f32 v41, v178, v179
    v_cvt_pk_bf16_f32 v42, v180, v181
    v_cvt_pk_bf16_f32 v43, v182, v183
    v_cvt_pk_bf16_f32 v44, v184, v185
    v_cvt_pk_bf16_f32 v45, v186, v187
    v_cvt_pk_bf16_f32 v46, v188, v189
    v_cvt_pk_bf16_f32 v47, v190, v191
    v_cvt_pk_bf16_f32 v48, v192, v193
    v_cvt_pk_bf16_f32 v49, v194, v195
    v_cvt_pk_bf16_f32 v50, v196, v197
    v_cvt_pk_bf16_f32 v51, v198, v199
    v_cvt_pk_bf16_f32 v52, v200, v201
    v_cvt_pk_bf16_f32 v53, v202, v203
    v_cvt_pk_bf16_f32 v54, v204, v205
    v_cvt_pk_bf16_f32 v55, v206, v207
    s_cmp_lg_u32 s58, 0
    s_cbranch_scc1 ff_own_152
    ds_write_b128 v12, v[40:43] offset:0
    ds_write_b128 v12, v[44:47] offset:512
    ds_write_b128 v12, v[48:51] offset:1024
    ds_write_b128 v12, v[52:55] offset:1536
    s_cmp_ge_u32 s2, 224
    s_cbranch_scc1 ff_red_153
    v_lshrrev_b32 v12, 4, v3
    v_and_b32 v13, 1, v3
    v_lshlrev_b32 v13, 11, v13
    v_lshl_add_u32 v13, v12, 3, v13
    s_lshl_b32 s54, s30, 9
    s_add_u32 s54, s54, 4096
    v_add_u32 v13, s54, v13
    ds_read_b64 a[64:65], v13 offset:0
    ds_read_b64 a[66:67], v13 offset:32
    ds_read_b64 a[68:69], v13 offset:64
    ds_read_b64 a[70:71], v13 offset:96
    ds_read_b64 a[72:73], v13 offset:128
    ds_read_b64 a[74:75], v13 offset:160
    ds_read_b64 a[76:77], v13 offset:192
    ds_read_b64 a[78:79], v13 offset:224
    ds_read_b64 a[80:81], v13 offset:256
    ds_read_b64 a[82:83], v13 offset:288
    ds_read_b64 a[84:85], v13 offset:320
    ds_read_b64 a[86:87], v13 offset:352
    ds_read_b64 a[88:89], v13 offset:384
    ds_read_b64 a[90:91], v13 offset:416
    ds_read_b64 a[92:93], v13 offset:448
    ds_read_b64 a[94:95], v13 offset:480
    v_lshlrev_b32 v13, 6, v8
    v_lshl_add_u32 v13, v12, 4, v13
    s_lshl_b32 s54, s30, 11
    s_add_u32 s54, s54, 8448
    v_add_u32 v13, s54, v13
    s_waitcnt lgkmcnt(0)
    v_mfma_f32_16x16x32_bf16 v[16:19], a[0:3], a[64:67], 0
    v_mfma_f32_16x16x32_bf16 v[20:23], a[32:35], a[64:67], 0
    v_mfma_f32_16x16x32_bf16 v[16:19], a[4:7], a[68:71], v[16:19]
    v_mfma_f32_16x16x32_bf16 v[20:23], a[36:39], a[68:71], v[20:23]
    v_mfma_f32_16x16x32_bf16 v[16:19], a[8:11], a[72:75], v[16:19]
    v_mfma_f32_16x16x32_bf16 v[20:23], a[40:43], a[72:75], v[20:23]
    v_mfma_f32_16x16x32_bf16 v[16:19], a[12:15], a[76:79], v[16:19]
    v_mfma_f32_16x16x32_bf16 v[20:23], a[44:47], a[76:79], v[20:23]
    v_mfma_f32_16x16x32_bf16 v[16:19], a[16:19], a[80:83], v[16:19]
    v_mfma_f32_16x16x32_bf16 v[20:23], a[48:51], a[80:83], v[20:23]
    v_mfma_f32_16x16x32_bf16 v[16:19], a[20:23], a[84:87], v[16:19]
    v_mfma_f32_16x16x32_bf16 v[20:23], a[52:55], a[84:87], v[20:23]
    v_mfma_f32_16x16x32_bf16 v[16:19], a[24:27], a[88:91], v[16:19]
    v_mfma_f32_16x16x32_bf16 v[20:23], a[56:59], a[88:91], v[20:23]
    v_mfma_f32_16x16x32_bf16 v[16:19], a[28:31], a[92:95], v[16:19]
    v_mfma_f32_16x16x32_bf16 v[20:23], a[60:63], a[92:95], v[20:23]
    s_nop 7
    ds_write_b128 v13, v[16:19]
    ds_write_b128 v13, v[20:23] offset:1024
    v_lshlrev_b32 v13, 2, v4
    v_add_u32 v13, 8448, v13
    s_waitcnt lgkmcnt(0)
    s_barrier
    ds_read2st64_b32 v[16:17], v13 offset0:0 offset1:4
    ds_read2st64_b32 v[18:19], v13 offset0:8 offset1:12
    ds_read2st64_b32 v[20:21], v13 offset0:16 offset1:20
    ds_read2st64_b32 v[22:23], v13 offset0:24 offset1:28
    s_waitcnt lgkmcnt(0)
    v_pk_add_f32 v[16:17], v[16:17], v[20:21]
    v_pk_add_f32 v[18:19], v[18:19], v[22:23]
    v_pk_add_f32 v[16:17], v[16:17], v[18:19]
    v_cvt_pk_bf16_f32 v16, v16, v17
    v_and_b32 v20, 0xffff0000, v16
    v_lshlrev_b32 v16, 16, v16
    v_mul_f32 v17, 0xbfb8aa3b, v16
    v_exp_f32 v17, v17
    s_lshl_b32 s54, s55, 12
    v_add_f32 v17, 1.0, v17
    v_rcp_f32 v17, v17
    s_add_u32 s53, s54, 4096
    v_mul_f32 v16, v16, v17
    v_cvt_pk_bf16_f32 v16, v16, v16
    v_and_b32 v16, 0xffff0000, v16
    v_mul_f32 v16, v16, v20
    s_nop 1
    v_mov_b32_dpp v17, v16 quad_perm:[1,0,3,2] row_mask:0xf bank_mask:0xf
    v_cvt_pk_bf16_f32 v16, v16, v17
    v_lshlrev_b32 v13, 4, v2
    v_readlane_b32 s8, v16, 0
    v_readlane_b32 s9, v16, 2
    v_readlane_b32 s10, v16, 4
    v_readlane_b32 s11, v16, 6
    v_readlane_b32 s12, v16, 8
    v_readlane_b32 s13, v16, 10
    v_readlane_b32 s14, v16, 12
    v_readlane_b32 s15, v16, 14
    v_readlane_b32 s16, v16, 16
    v_readlane_b32 s17, v16, 18
    v_readlane_b32 s18, v16, 20
    v_readlane_b32 s19, v16, 22
    v_readlane_b32 s20, v16, 24
    v_readlane_b32 s21, v16, 26
    v_readlane_b32 s22, v16, 28
    v_readlane_b32 s23, v16, 30
    v_dot2_f32_bf16 v24, v144, s8, 0
    v_dot2_f32_bf16 v25, v145, s8, 0
    v_dot2_f32_bf16 v26, v146, s8, 0
    v_dot2_f32_bf16 v27, v147, s8, 0
    v_dot2_f32_bf16 v24, v148, s9, v24
    v_dot2_f32_bf16 v25, v149, s9, v25
    v_dot2_f32_bf16 v26, v150, s9, v26
    v_dot2_f32_bf16 v27, v151, s9, v27
    v_dot2_f32_bf16 v24, v152, s10, v24
    v_dot2_f32_bf16 v25, v153, s10, v25
    v_dot2_f32_bf16 v26, v154, s10, v26
    v_dot2_f32_bf16 v27, v155, s10, v27
    v_dot2_f32_bf16 v24, v156, s11, v24
    v_dot2_f32_bf16 v25, v157, s11, v25
    v_dot2_f32_bf16 v26, v158, s11, v26
    v_dot2_f32_bf16 v27, v159, s11, v27
    v_dot2_f32_bf16 v24, v160, s12, v24
    v_dot2_f32_bf16 v25, v161, s12, v25
    v_dot2_f32_bf16 v26, v162, s12, v26
    v_dot2_f32_bf16 v27, v163, s12, v27
    v_dot2_f32_bf16 v24, v164, s13, v24
    v_dot2_f32_bf16 v25, v165, s13, v25
    v_dot2_f32_bf16 v26, v166, s13, v26
    v_dot2_f32_bf16 v27, v167, s13, v27
    v_dot2_f32_bf16 v24, v168, s14, v24
    v_dot2_f32_bf16 v25, v169, s14, v25
    v_dot2_f32_bf16 v26, v170, s14, v26
    v_dot2_f32_bf16 v27, v171, s14, v27
    v_dot2_f32_bf16 v24, v172, s15, v24
    v_dot2_f32_bf16 v25, v173, s15, v25
    v_dot2_f32_bf16 v26, v174, s15, v26
    v_dot2_f32_bf16 v27, v175, s15, v27
    v_dot2_f32_bf16 v28, v144, s16, 0
    v_dot2_f32_bf16 v29, v145, s16, 0
    v_dot2_f32_bf16 v30, v146, s16, 0
    v_dot2_f32_bf16 v31, v147, s16, 0
    v_dot2_f32_bf16 v28, v148, s17, v28
    v_dot2_f32_bf16 v29, v149, s17, v29
    v_dot2_f32_bf16 v30, v150, s17, v30
    v_dot2_f32_bf16 v31, v151, s17, v31
    v_dot2_f32_bf16 v28, v152, s18, v28
    v_dot2_f32_bf16 v29, v153, s18, v29
    v_dot2_f32_bf16 v30, v154, s18, v30
    v_dot2_f32_bf16 v31, v155, s18, v31
    v_dot2_f32_bf16 v28, v156, s19, v28
    v_dot2_f32_bf16 v29, v157, s19, v29
    v_dot2_f32_bf16 v30, v158, s19, v30
    v_dot2_f32_bf16 v31, v159, s19, v31
    v_dot2_f32_bf16 v28, v160, s20, v28
    v_dot2_f32_bf16 v29, v161, s20, v29
    v_dot2_f32_bf16 v30, v162, s20, v30
    v_dot2_f32_bf16 v31, v163, s20, v31
    v_dot2_f32_bf16 v28, v164, s21, v28
    v_dot2_f32_bf16 v29, v165, s21, v29
    v_dot2_f32_bf16 v30, v166, s21, v30
    v_dot2_f32_bf16 v31, v167, s21, v31
    v_dot2_f32_bf16 v28, v168, s22, v28
    v_dot2_f32_bf16 v29, v169, s22, v29
    v_dot2_f32_bf16 v30, v170, s22, v30
    v_dot2_f32_bf16 v31, v171, s22, v31
    v_dot2_f32_bf16 v28, v172, s23, v28
    v_dot2_f32_bf16 v29, v173, s23, v29
    v_dot2_f32_bf16 v30, v174, s23, v30
    v_dot2_f32_bf16 v31, v175, s23, v31
    s_nop 2
    v_cvt_pk_bf16_f32 v24, v24, v25
    v_cvt_pk_bf16_f32 v25, v26, v27
    v_cvt_pk_bf16_f32 v26, v28, v29
    v_cvt_pk_bf16_f32 v27, v30, v31
    v_min_u32 v24, -2, v24
    v_min_u32 v25, -2, v25
    v_min_u32 v26, -2, v26
    v_min_u32 v27, -2, v27
    buffer_store_dwordx4 v[24:27], v13, s[48:51], s54 offen sc1
    s_waitcnt vmcnt(1)
    v_mov_b32 v40, v128
    v_mov_b32 v41, v129
    v_mov_b32 v42, v130
    v_mov_b32 v43, v131
    v_mov_b32 v44, v132
    v_mov_b32 v45, v133
    v_mov_b32 v46, v134
    v_mov_b32 v47, v135
    v_mov_b32 v48, v136
    v_mov_b32 v49, v137
    v_mov_b32 v50, v138
    v_mov_b32 v51, v139
    v_mov_b32 v52, v140
    v_mov_b32 v53, v141
    v_mov_b32 v54, v142
    v_mov_b32 v55, v143
    s_mov_b32 s58, 1
    s_branch ff_ln_151
ff_own_152:
    v_lshlrev_b32 v176, 16, v40
    v_and_b32 v177, 0xffff0000, v40
    v_lshlrev_b32 v178, 16, v41
    v_and_b32 v179, 0xffff0000, v41
    v_lshlrev_b32 v180, 16, v42
    v_and_b32 v181, 0xffff0000, v42
    v_lshlrev_b32 v182, 16, v43
    v_and_b32 v183, 0xffff0000, v43
    v_lshlrev_b32 v184, 16, v44
    v_and_b32 v185, 0xffff0000, v44
    v_lshlrev_b32 v186, 16, v45
    v_and_b32 v187, 0xffff0000, v45
    v_lshlrev_b32 v188, 16, v46
    v_and_b32 v189, 0xffff0000, v46
    v_lshlrev_b32 v190, 16, v47
    v_and_b32 v191, 0xffff0000, v47
    v_lshlrev_b32 v192, 16, v48
    v_and_b32 v193, 0xffff0000, v48
    v_lshlrev_b32 v194, 16, v49
    v_and_b32 v195, 0xffff0000, v49
    v_lshlrev_b32 v196, 16, v50
    v_and_b32 v197, 0xffff0000, v50
    v_lshlrev_b32 v198, 16, v51
    v_and_b32 v199, 0xffff0000, v51
    v_lshlrev_b32 v200, 16, v52
    v_and_b32 v201, 0xffff0000, v52
    v_lshlrev_b32 v202, 16, v53
    v_and_b32 v203, 0xffff0000, v53
    v_lshlrev_b32 v204, 16, v54
    v_and_b32 v205, 0xffff0000, v54
    v_lshlrev_b32 v206, 16, v55
    v_and_b32 v207, 0xffff0000, v55
    v_pk_add_f32 v[176:177], v[176:177], v[216:217]
    v_pk_add_f32 v[178:179], v[178:179], v[218:219]
    v_pk_add_f32 v[180:181], v[180:181], v[220:221]
    v_pk_add_f32 v[182:183], v[182:183], v[222:223]
    v_pk_add_f32 v[184:185], v[184:185], v[224:225]
    v_pk_add_f32 v[186:187], v[186:187], v[226:227]
    v_pk_add_f32 v[188:189], v[188:189], v[228:229]
    v_pk_add_f32 v[190:191], v[190:191], v[230:231]
    v_pk_add_f32 v[192:193], v[192:193], v[232:233]
    v_pk_add_f32 v[194:195], v[194:195], v[234:235]
    v_pk_add_f32 v[196:197], v[196:197], v[236:237]
    v_pk_add_f32 v[198:199], v[198:199], v[238:239]
    v_pk_add_f32 v[200:201], v[200:201], v[240:241]
    v_pk_add_f32 v[202:203], v[202:203], v[242:243]
    v_pk_add_f32 v[204:205], v[204:205], v[244:245]
    v_pk_add_f32 v[206:207], v[206:207], v[246:247]
    v_cvt_pk_bf16_f32 v40, v176, v177
    v_cvt_pk_bf16_f32 v41, v178, v179
    v_cvt_pk_bf16_f32 v42, v180, v181
    v_cvt_pk_bf16_f32 v43, v182, v183
    v_cvt_pk_bf16_f32 v44, v184, v185
    v_cvt_pk_bf16_f32 v45, v186, v187
    v_cvt_pk_bf16_f32 v46, v188, v189
    v_cvt_pk_bf16_f32 v47, v190, v191
    v_cvt_pk_bf16_f32 v48, v192, v193
    v_cvt_pk_bf16_f32 v49, v194, v195
    v_cvt_pk_bf16_f32 v50, v196, v197
    v_cvt_pk_bf16_f32 v51, v198, v199
    v_cvt_pk_bf16_f32 v52, v200, v201
    v_cvt_pk_bf16_f32 v53, v202, v203
    v_cvt_pk_bf16_f32 v54, v204, v205
    v_cvt_pk_bf16_f32 v55, v206, v207
    buffer_store_dwordx4 v[40:43], v0, s[36:39], 0 offen offset:0 sc1
    buffer_store_dwordx4 v[44:47], v0, s[36:39], 0 offen offset:512 sc1
    buffer_store_dwordx4 v[48:51], v0, s[36:39], 0 offen offset:1024 sc1
    buffer_store_dwordx4 v[52:55], v0, s[36:39], 0 offen offset:1536 sc1
    s_cmp_ge_u32 s2, 224
    s_cbranch_scc1 ff_red2_154
    s_branch ff_fin_155
ff_red_153:
    s_sub_u32 s40, s2, 224
    s_mov_b32 s8, s56
    s_and_b32 s9, s57, 0xffff
    s_mov_b32 s10, 0x800
    s_mov_b32 s11, 0x00020000
    buffer_load_dwordx4 v[96:99], v7, s[8:11], 0 offen offset:0
    buffer_load_dwordx4 v[100:103], v7, s[8:11], 0 offen offset:512
    buffer_load_dwordx4 v[104:107], v7, s[8:11], 0 offen offset:1024
    buffer_load_dwordx4 v[108:111], v7, s[8:11], 0 offen offset:1536
    v_and_b32 v8, 7, v3
    s_lshl_b32 s47, s40, 6
    v_lshl_add_u32 v9, v8, 3, s47
    v_lshl_add_u32 v12, v5, 11, v9
    v_add_u32 v12, 4096, v12
    v_lshl_add_u32 v9, v15, 11, v9
    s_waitcnt lgkmcnt(0)
    ds_read_b64 v[32:33], v12
    buffer_load_dwordx2 v[34:35], v9, s[24:27], 0 offen sc1
    v_lshrrev_b32 v10, 3, v2
    v_lshlrev_b32 v10, 12, v10
    v_lshl_add_u32 v10, v8, 4, v10
    s_lshl_b32 s47, s40, 7
    s_waitcnt vmcnt(1)
    v_dot2_f32_bf16 v36, v40, v96, 0
    v_dot2_f32_bf16 v36, v41, v97, v36
    v_dot2_f32_bf16 v36, v42, v98, v36
    v_dot2_f32_bf16 v36, v43, v99, v36
    v_dot2_f32_bf16 v36, v44, v100, v36
    v_dot2_f32_bf16 v36, v45, v101, v36
    v_dot2_f32_bf16 v36, v46, v102, v36
    v_dot2_f32_bf16 v36, v47, v103, v36
    v_dot2_f32_bf16 v36, v48, v104, v36
    v_dot2_f32_bf16 v36, v49, v105, v36
    v_dot2_f32_bf16 v36, v50, v106, v36
    v_dot2_f32_bf16 v36, v51, v107, v36
    v_dot2_f32_bf16 v36, v52, v108, v36
    v_dot2_f32_bf16 v36, v53, v109, v36
    v_dot2_f32_bf16 v36, v54, v110, v36
    v_dot2_f32_bf16 v36, v55, v111, v36
    s_nop 2
    s_nop 1
    v_add_f32_dpp v36, v36, v36 quad_perm:[1,0,3,2] row_mask:0xf bank_mask:0xf
    s_nop 1
    v_add_f32_dpp v36, v36, v36 quad_perm:[2,3,0,1] row_mask:0xf bank_mask:0xf
    s_nop 1
    v_add_f32_dpp v36, v36, v36 row_half_mirror row_mask:0xf bank_mask:0xf
    s_nop 1
    v_add_f32_dpp v36, v36, v36 row_mirror row_mask:0xf bank_mask:0xf
    v_mov_b32 v13, v36
    s_nop 1
    v_permlane16_swap_b32 v36, v13
    s_nop 1
    v_add_f32 v36, v36, v13
    v_cvt_pk_bf16_f32 v36, v36, v36
    v_and_b32 v36, 0xffff0000, v36
    v_mul_f32 v36, 0xbfb8aa3b, v36
    v_exp_f32 v36, v36
    s_nop 0
    v_add_f32 v36, 1.0, v36
    v_rcp_f32 v36, v36
    s_nop 0
    v_cvt_pk_bf16_f32 v36, v36, v36
    v_and_b32 v36, 0xffff0000, v36
    v_mov_b32 v40, v128
    v_mov_b32 v41, v129
    v_mov_b32 v42, v130
    v_mov_b32 v43, v131
    v_mov_b32 v44, v132
    v_mov_b32 v45, v133
    v_mov_b32 v46, v134
    v_mov_b32 v47, v135
    v_mov_b32 v48, v136
    v_mov_b32 v49, v137
    v_mov_b32 v50, v138
    v_mov_b32 v51, v139
    v_mov_b32 v52, v140
    v_mov_b32 v53, v141
    v_mov_b32 v54, v142
    v_mov_b32 v55, v143
    s_mov_b32 s58, 1
    s_branch ff_ln_151
ff_red2_154:
    s_mov_b32 s52, 1048576
ff_rpoll_157:
    s_mov_b32 s53, s47
    buffer_load_dwordx4 v[96:99], v10, s[48:51], s53 offen sc1
    s_add_u32 s53, s53, 0x20000
    buffer_load_dwordx4 v[100:103], v10, s[48:51], s53 offen sc1
    s_add_u32 s53, s53, 0x20000
    buffer_load_dwordx4 v[104:107], v10, s[48:51], s53 offen sc1
    s_add_u32 s53, s53, 0x20000
    buffer_load_dwordx4 v[108:111], v10, s[48:51], s53 offen sc1
    s_add_u32 s53, s53, 0x20000
    buffer_load_dwordx4 v[112:115], v10, s[48:51], s53 offen sc1
    s_add_u32 s53, s53, 0x20000
    buffer_load_dwordx4 v[116:119], v10, s[48:51], s53 offen sc1
    s_add_u32 s53, s53, 0x20000
    buffer_load_dwordx4 v[120:123], v10, s[48:51], s53 offen sc1
    s_add_u32 s53, s53, 0x20000
    v_mov_b32 v13, 0
    s_waitcnt vmcnt(6)
    v_max3_u32 v13, v13, v96, v97
    v_max3_u32 v13, v13, v98, v99
    s_waitcnt vmcnt(5)
    v_max3_u32 v13, v13, v100, v101
    v_max3_u32 v13, v13, v102, v103
    s_waitcnt vmcnt(4)
    v_max3_u32 v13, v13, v104, v105
    v_max3_u32 v13, v13, v106, v107
    s_waitcnt vmcnt(3)
    v_max3_u32 v13, v13, v108, v109
    v_max3_u32 v13, v13, v110, v111
    s_waitcnt vmcnt(2)
    v_max3_u32 v13, v13, v112, v113
    v_max3_u32 v13, v13, v114, v115
    s_waitcnt vmcnt(1)
    v_max3_u32 v13, v13, v116, v117
    v_max3_u32 v13, v13, v118, v119
    s_waitcnt vmcnt(0)
    v_max3_u32 v13, v13, v120, v121
    v_max3_u32 v13, v13, v122, v123
    s_sub_u32 s52, s52, 1
    s_cbranch_scc1 ff_rgo_156
    v_cmp_eq_u32 vcc, -1, v13
    s_cbranch_vccnz ff_rpoll_157
ff_rgo_156:
    s_mov_b32 s52, 0x00003f80
    s_mov_b32 s53, 0x3f800000
    v_dot2_f32_bf16 v128, v96, s52, 0
    v_dot2_f32_bf16 v129, v96, s53, 0
    v_dot2_f32_bf16 v130, v97, s52, 0
    v_dot2_f32_bf16 v131, v97, s53, 0
    v_dot2_f32_bf16 v132, v98, s52, 0
    v_dot2_f32_bf16 v133, v98, s53, 0
    v_dot2_f32_bf16 v134, v99, s52, 0
    v_dot2_f32_bf16 v135, v99, s53, 0
    v_dot2_f32_bf16 v128, v100, s52, v128
    v_dot2_f32_bf16 v129, v100, s53, v129
    v_dot2_f32_bf16 v130, v101, s52, v130
    v_dot2_f32_bf16 v131, v101, s53, v131
    v_dot2_f32_bf16 v132, v102, s52, v132
    v_dot2_f32_bf16 v133, v102, s53, v133
    v_dot2_f32_bf16 v134, v103, s52, v134
    v_dot2_f32_bf16 v135, v103, s53, v135
    v_dot2_f32_bf16 v128, v104, s52, v128
    v_dot2_f32_bf16 v129, v104, s53, v129
    v_dot2_f32_bf16 v130, v105, s52, v130
    v_dot2_f32_bf16 v131, v105, s53, v131
    v_dot2_f32_bf16 v132, v106, s52, v132
    v_dot2_f32_bf16 v133, v106, s53, v133
    v_dot2_f32_bf16 v134, v107, s52, v134
    v_dot2_f32_bf16 v135, v107, s53, v135
    v_dot2_f32_bf16 v128, v108, s52, v128
    v_dot2_f32_bf16 v129, v108, s53, v129
    v_dot2_f32_bf16 v130, v109, s52, v130
    v_dot2_f32_bf16 v131, v109, s53, v131
    v_dot2_f32_bf16 v132, v110, s52, v132
    v_dot2_f32_bf16 v133, v110, s53, v133
    v_dot2_f32_bf16 v134, v111, s52, v134
    v_dot2_f32_bf16 v135, v111, s53, v135
    v_dot2_f32_bf16 v128, v112, s52, v128
    v_dot2_f32_bf16 v129, v112, s53, v129
    v_dot2_f32_bf16 v130, v113, s52, v130
    v_dot2_f32_bf16 v131, v113, s53, v131
    v_dot2_f32_bf16 v132, v114, s52, v132
    v_dot2_f32_bf16 v133, v114, s53, v133
    v_dot2_f32_bf16 v134, v115, s52, v134
    v_dot2_f32_bf16 v135, v115, s53, v135
    v_dot2_f32_bf16 v128, v116, s52, v128
    v_dot2_f32_bf16 v129, v116, s53, v129
    v_dot2_f32_bf16 v130, v117, s52, v130
    v_dot2_f32_bf16 v131, v117, s53, v131
    v_dot2_f32_bf16 v132, v118, s52, v132
    v_dot2_f32_bf16 v133, v118, s53, v133
    v_dot2_f32_bf16 v134, v119, s52, v134
    v_dot2_f32_bf16 v135, v119, s53, v135
    v_dot2_f32_bf16 v128, v120, s52, v128
    v_dot2_f32_bf16 v129, v120, s53, v129
    v_dot2_f32_bf16 v130, v121, s52, v130
    v_dot2_f32_bf16 v131, v121, s53, v131
    v_dot2_f32_bf16 v132, v122, s52, v132
    v_dot2_f32_bf16 v133, v122, s53, v133
    v_dot2_f32_bf16 v134, v123, s52, v134
    v_dot2_f32_bf16 v135, v123, s53, v135
    s_nop 2
    v_permlane32_swap_b32 v128, v132
    v_permlane32_swap_b32 v129, v133
    v_permlane32_swap_b32 v130, v134
    v_permlane32_swap_b32 v131, v135
    s_nop 1
    v_add_f32 v128, v128, v132
    v_add_f32 v129, v129, v133
    v_add_f32 v130, v130, v134
    v_add_f32 v131, v131, v135
    s_nop 1
    v_add_f32_dpp v128, v128, v128 row_ror:8 row_mask:0xf bank_mask:0xf
    v_add_f32_dpp v129, v129, v129 row_ror:8 row_mask:0xf bank_mask:0xf
    v_add_f32_dpp v130, v130, v130 row_ror:8 row_mask:0xf bank_mask:0xf
    v_add_f32_dpp v131, v131, v131 row_ror:8 row_mask:0xf bank_mask:0xf
    v_mov_b32 v132, v128
    v_mov_b32 v133, v129
    v_mov_b32 v134, v130
    v_mov_b32 v135, v131
    s_nop 1
    v_permlane16_swap_b32 v128, v132
    v_permlane16_swap_b32 v129, v133
    v_permlane16_swap_b32 v130, v134
    v_permlane16_swap_b32 v131, v135
    s_nop 1
    v_add_f32 v128, v128, v132
    v_add_f32 v129, v129, v133
    v_add_f32 v130, v130, v134
    v_add_f32 v131, v131, v135
    v_lshlrev_b32 v14, 4, v8
    v_lshl_add_u32 v14, v5, 7, v14
    s_lshl_b32 s31, s30, 8
    v_add_u32 v13, s31, v14
    ds_write_b128 v13, v[128:131]
    s_waitcnt lgkmcnt(0)
    s_barrier
    ds_read_b128 v[96:99], v14 offset:0
    ds_read_b128 v[100:103], v14 offset:256
    ds_read_b128 v[104:107], v14 offset:512
    ds_read_b128 v[108:111], v14 offset:768
    s_waitcnt lgkmcnt(0)
    v_pk_add_f32 v[96:97], v[96:97], v[100:101]
    v_pk_add_f32 v[98:99], v[98:99], v[102:103]
    v_pk_add_f32 v[96:97], v[96:97], v[104:105]
    v_pk_add_f32 v[98:99], v[98:99], v[106:107]
    v_pk_add_f32 v[96:97], v[96:97], v[108:109]
    v_pk_add_f32 v[98:99], v[98:99], v[110:111]
    v_cvt_pk_bf16_f32 v20, v96, v97
    v_lshlrev_b32 v21, 16, v20
    v_and_b32 v22, 0xffff0000, v20
    v_mul_f32 v21, v36, v21
    v_mul_f32 v22, v36, v22
    v_cvt_pk_bf16_f32 v20, v21, v22
    v_lshlrev_b32 v21, 16, v20
    v_and_b32 v22, 0xffff0000, v20
    v_lshlrev_b32 v23, 16, v32
    v_and_b32 v24, 0xffff0000, v32
    v_add_f32 v21, v21, v23
    v_add_f32 v22, v22, v24
    v_cvt_pk_bf16_f32 v20, v21, v22
    v_lshlrev_b32 v21, 16, v20
    v_and_b32 v22, 0xffff0000, v20
    v_lshlrev_b32 v23, 16, v34
    v_and_b32 v24, 0xffff0000, v34
    v_add_f32 v21, v21, v23
    v_add_f32 v22, v22, v24
    v_cvt_pk_bf16_f32 v26, v21, v22
    v_cvt_pk_bf16_f32 v20, v98, v99
    v_lshlrev_b32 v21, 16, v20
    v_and_b32 v22, 0xffff0000, v20
    v_mul_f32 v21, v36, v21
    v_mul_f32 v22, v36, v22
    v_cvt_pk_bf16_f32 v20, v21, v22
    v_lshlrev_b32 v21, 16, v20
    v_and_b32 v22, 0xffff0000, v20
    v_lshlrev_b32 v23, 16, v33
    v_and_b32 v24, 0xffff0000, v33
    v_add_f32 v21, v21, v23
    v_add_f32 v22, v22, v24
    v_cvt_pk_bf16_f32 v20, v21, v22
    v_lshlrev_b32 v21, 16, v20
    v_and_b32 v22, 0xffff0000, v20
    v_lshlrev_b32 v23, 16, v35
    v_and_b32 v24, 0xffff0000, v35
    v_add_f32 v21, v21, v23
    v_add_f32 v22, v22, v24
    v_cvt_pk_bf16_f32 v27, v21, v22
    s_cmp_lg_u32 s30, 0
    s_cbranch_scc1 ff_fin_155
    s_mov_b32 exec_lo, 0xff
    s_mov_b32 exec_hi, 0xff
    buffer_store_dwordx2 v[26:27], v9, s[36:39], 0 offen sc1
ff_fin_155:
    s_mov_b64 exec, -1
k12_end_1:
    s_endpgm
k2_prep_76:
    s_sub_u32 s40, s36, s38
    v_subrev_u32 v6, s40, v4
    v_cmp_gt_i32 s[44:45], 0, v6
    v_cmp_gt_i32 s[46:47], 1, v6
    v_cmp_gt_i32 s[48:49], 2, v6
    v_cmp_gt_i32 s[50:51], 3, v6
    v_cndmask_b32 v16, v8, v5, s[44:45]
    v_cndmask_b32 v17, v8, v5, s[46:47]
    v_cndmask_b32 v18, v8, v5, s[48:49]
    v_cndmask_b32 v19, v8, v5, s[50:51]
    v_cmp_gt_i32 s[44:45], 16, v6
    v_cmp_gt_i32 s[46:47], 17, v6
    v_cmp_gt_i32 s[48:49], 18, v6
    v_cmp_gt_i32 s[50:51], 19, v6
    v_cndmask_b32 v32, v8, v5, s[44:45]
    v_cndmask_b32 v33, v8, v5, s[46:47]
    v_cndmask_b32 v34, v8, v5, s[48:49]
    v_cndmask_b32 v35, v8, v5, s[50:51]
    s_nop 1
    s_branch k2_prepret_77
k2_prep_84:
    s_sub_u32 s40, s36, s38
    v_subrev_u32 v6, s40, v4
    v_cmp_gt_i32 s[44:45], 0, v6
    v_cmp_gt_i32 s[46:47], 1, v6
    v_cmp_gt_i32 s[48:49], 2, v6
    v_cmp_gt_i32 s[50:51], 3, v6
    v_cndmask_b32 v16, v8, v5, s[44:45]
    v_cndmask_b32 v17, v8, v5, s[46:47]
    v_cndmask_b32 v18, v8, v5, s[48:49]
    v_cndmask_b32 v19, v8, v5, s[50:51]
    v_cmp_gt_i32 s[44:45], 16, v6
    v_cmp_gt_i32 s[46:47], 17, v6
    v_cmp_gt_i32 s[48:49], 18, v6
    v_cmp_gt_i32 s[50:51], 19, v6
    v_cndmask_b32 v32, v8, v5, s[44:45]
    v_cndmask_b32 v33, v8, v5, s[46:47]
    v_cndmask_b32 v34, v8, v5, s[48:49]
    v_cndmask_b32 v35, v8, v5, s[50:51]
    s_nop 1
    s_branch k2_prepret_85
k2_prep_102:
    s_sub_u32 s40, s36, s39
    v_subrev_u32 v6, s40, v4
    v_cmp_gt_i32 s[44:45], 0, v6
    v_cmp_gt_i32 s[46:47], 1, v6
    v_cmp_gt_i32 s[48:49], 2, v6
    v_cmp_gt_i32 s[50:51], 3, v6
    v_cndmask_b32 v16, v10, v5, s[44:45]
    v_cndmask_b32 v17, v10, v5, s[46:47]
    v_cndmask_b32 v18, v10, v5, s[48:49]
    v_cndmask_b32 v19, v10, v5, s[50:51]
    v_cmp_gt_i32 s[44:45], 16, v6
    v_cmp_gt_i32 s[46:47], 17, v6
    v_cmp_gt_i32 s[48:49], 18, v6
    v_cmp_gt_i32 s[50:51], 19, v6
    v_cndmask_b32 v32, v10, v5, s[44:45]
    v_cndmask_b32 v33, v10, v5, s[46:47]
    v_cndmask_b32 v34, v10, v5, s[48:49]
    v_cndmask_b32 v35, v10, v5, s[50:51]
    v_cmp_gt_i32 s[44:45], 32, v6
    v_cmp_gt_i32 s[46:47], 33, v6
    v_cmp_gt_i32 s[48:49], 34, v6
    v_cmp_gt_i32 s[50:51], 35, v6
    v_cndmask_b32 v24, v10, v5, s[44:45]
    v_cndmask_b32 v25, v10, v5, s[46:47]
    v_cndmask_b32 v26, v10, v5, s[48:49]
    v_cndmask_b32 v27, v10, v5, s[50:51]
    v_cmp_gt_i32 s[44:45], 48, v6
    v_cmp_gt_i32 s[46:47], 49, v6
    v_cmp_gt_i32 s[48:49], 50, v6
    v_cmp_gt_i32 s[50:51], 51, v6
    v_cndmask_b32 v40, v10, v5, s[44:45]
    v_cndmask_b32 v41, v10, v5, s[46:47]
    v_cndmask_b32 v42, v10, v5, s[48:49]
    v_cndmask_b32 v43, v10, v5, s[50:51]
    s_nop 1
    s_branch k2_prepret_103
k2_prep_106:
    s_sub_u32 s40, s36, s39
    s_sub_u32 s40, s40, 64
    v_subrev_u32 v6, s40, v4
    v_cmp_gt_i32 s[44:45], 0, v6
    v_cmp_gt_i32 s[46:47], 1, v6
    v_cmp_gt_i32 s[48:49], 2, v6
    v_cmp_gt_i32 s[50:51], 3, v6
    v_cndmask_b32 v20, v11, v5, s[44:45]
    v_cndmask_b32 v21, v11, v5, s[46:47]
    v_cndmask_b32 v22, v11, v5, s[48:49]
    v_cndmask_b32 v23, v11, v5, s[50:51]
    v_cmp_gt_i32 s[44:45], 16, v6
    v_cmp_gt_i32 s[46:47], 17, v6
    v_cmp_gt_i32 s[48:49], 18, v6
    v_cmp_gt_i32 s[50:51], 19, v6
    v_cndmask_b32 v36, v11, v5, s[44:45]
    v_cndmask_b32 v37, v11, v5, s[46:47]
    v_cndmask_b32 v38, v11, v5, s[48:49]
    v_cndmask_b32 v39, v11, v5, s[50:51]
    v_cmp_gt_i32 s[44:45], 32, v6
    v_cmp_gt_i32 s[46:47], 33, v6
    v_cmp_gt_i32 s[48:49], 34, v6
    v_cmp_gt_i32 s[50:51], 35, v6
    v_cndmask_b32 v28, v11, v5, s[44:45]
    v_cndmask_b32 v29, v11, v5, s[46:47]
    v_cndmask_b32 v30, v11, v5, s[48:49]
    v_cndmask_b32 v31, v11, v5, s[50:51]
    v_cmp_gt_i32 s[44:45], 48, v6
    v_cmp_gt_i32 s[46:47], 49, v6
    v_cmp_gt_i32 s[48:49], 50, v6
    v_cmp_gt_i32 s[50:51], 51, v6
    v_cndmask_b32 v44, v11, v5, s[44:45]
    v_cndmask_b32 v45, v11, v5, s[46:47]
    v_cndmask_b32 v46, v11, v5, s[48:49]
    v_cndmask_b32 v47, v11, v5, s[50:51]
    s_nop 1
    s_branch k2_prepret_107
k12_ool_10:
    buffer_load_dword v52, v8, s[24:27], 0 offen sc1
    s_branch k12_oolret_11
k12_ool_14:
    v_readfirstlane_b32 s31, v52
    s_cmp_ge_u32 s31, 256
    s_cbranch_scc1 spin_ok_12
    s_mov_b32 s40, 1048576
spin_13:
    s_sleep 8
    buffer_load_dword v52, v8, s[24:27], 0 offen sc1
    s_waitcnt vmcnt(0)
    v_readfirstlane_b32 s31, v52
    s_sub_u32 s40, s40, 1
    s_cselect_b32 s31, -1, s31
    s_cmp_lt_u32 s31, 256
    s_cbranch_scc1 spin_13
spin_ok_12:
    s_branch k12_oolret_15
k12_ool_16:
    s_mov_b64 exec, 1
    buffer_atomic_add v9, v8, s[24:27], 0 offen sc1
    s_mov_b64 exec, -1
    s_branch k12_oolret_17
k12_ool_18:
    buffer_load_dword v51, v50, s[12:15], s56 offen
    s_branch k12_oolret_19
k12_ool_20:
    s_add_u32 m0, s60, 131072
    s_nop 0
    buffer_load_dwordx4 v38, s[12:15], s61 offen offset:0 lds
    buffer_load_dwordx4 v39, s[12:15], s61 offen offset:1024 lds
    buffer_load_dwordx4 v40, s[12:15], s61 offen offset:2048 lds
    buffer_load_dwordx4 v41, s[12:15], s61 offen offset:3072 lds
    s_add_u32 s61, s61, 0x80000
    s_add_u32 m0, s60, 147456
    s_nop 0
    buffer_load_dwordx4 v38, s[12:15], s61 offen offset:0 lds
    buffer_load_dwordx4 v39, s[12:15], s61 offen offset:1024 lds
    buffer_load_dwordx4 v40, s[12:15], s61 offen offset:2048 lds
    buffer_load_dwordx4 v41, s[12:15], s61 offen offset:3072 lds
    s_add_u32 s61, s61, 0x80000
    s_branch k12_oolret_21
k12_ool_22:
    s_mov_b64 exec, 1
    buffer_atomic_add v9, v8, s[24:27], 0 offen sc1
    s_mov_b64 exec, -1
    s_branch k12_oolret_23
k12_ool_24:
    buffer_load_dword v51, v50, s[12:15], s56 offen
    s_branch k12_oolret_25
k12_ool_26:
    global_load_dword v51, v[2:3], off
    s_branch k12_oolret_27
k12_ool_30:
    buffer_load_dword v52, v8, s[24:27], 0 offen sc1
    s_branch k12_oolret_31
k12_ool_34:
    v_readfirstlane_b32 s31, v52
    s_cmp_ge_u32 s31, 256
    s_cbranch_scc1 spin_ok_32
    s_mov_b32 s40, 1048576
spin_33:
    s_sleep 8
    buffer_load_dword v52, v8, s[24:27], 0 offen sc1
    s_waitcnt vmcnt(0)
    v_readfirstlane_b32 s31, v52
    s_sub_u32 s40, s40, 1
    s_cselect_b32 s31, -1, s31
    s_cmp_lt_u32 s31, 256
    s_cbranch_scc1 spin_33
spin_ok_32:
    s_branch k12_oolret_35
k12_ool_36:
    s_mov_b64 exec, 1
    buffer_atomic_add v9, v8, s[24:27], 0 offen sc1
    s_mov_b64 exec, -1
    s_branch k12_oolret_37
k12_ool_38:
    buffer_load_dword v51, v50, s[12:15], s56 offen
    s_branch k12_oolret_39
k12_ool_40:
    s_add_u32 m0, s60, 131072
    s_nop 0
    buffer_load_dwordx4 v38, s[12:15], s61 offen offset:0 lds
    buffer_load_dwordx4 v39, s[12:15], s61 offen offset:1024 lds
    buffer_load_dwordx4 v40, s[12:15], s61 offen offset:2048 lds
    buffer_load_dwordx4 v41, s[12:15], s61 offen offset:3072 lds
    s_add_u32 s61, s61, 0x80000
    s_add_u32 m0, s60, 147456
    s_nop 0
    buffer_load_dwordx4 v38, s[12:15], s61 offen offset:0 lds
    buffer_load_dwordx4 v39, s[12:15], s61 offen offset:1024 lds
    buffer_load_dwordx4 v40, s[12:15], s61 offen offset:2048 lds
    buffer_load_dwordx4 v41, s[12:15], s61 offen offset:3072 lds
    s_add_u32 s61, s61, 0x80000
    s_branch k12_oolret_41
k12_ool_42:
    s_mov_b64 exec, 1
    buffer_atomic_add v9, v8, s[24:27], 0 offen sc1
    s_mov_b64 exec, -1
    s_branch k12_oolret_43
k12_ool_44:
    buffer_load_dword v51, v50, s[12:15], s56 offen
    s_branch k12_oolret_45
k12_ool_46:
    global_load_dword v51, v[2:3], off
    s_branch k12_oolret_47
k12_ool_48:
    s_add_u32 s52, s47, 528384
    buffer_store_dwordx4 v[152:155], v1, s[48:51], s52 offen offset:2048 sc1
    s_branch k12_oolret_49
k12_ool_50:
    s_add_u32 s52, s47, 528384
    buffer_store_dwordx4 v[156:159], v1, s[48:51], s52 offen offset:3072 sc1
    s_branch k12_oolret_51
k12_ool_52:
    s_add_u32 s52, s47, 532480
    buffer_store_dwordx4 v[168:171], v1, s[48:51], s52 offen offset:2048 sc1
    s_branch k12_oolret_53
k12_ool_54:
    s_add_u32 s52, s47, 532480
    buffer_store_dwordx4 v[172:175], v1, s[48:51], s52 offen offset:3072 sc1
    s_branch k12_oolret_55
k12_ool_56:
    s_add_u32 s52, s47, 536576
    buffer_store_dwordx4 v[176:179], v1, s[48:51], s52 offen offset:0 sc1
    s_branch k12_oolret_57
k12_ool_58:
    s_add_u32 s52, s47, 536576
    buffer_store_dwordx4 v[180:183], v1, s[48:51], s52 offen offset:1024 sc1
    s_branch k12_oolret_59
k12_ool_60:
    s_add_u32 s52, s47, 536576
    buffer_store_dwordx4 v[184:187], v1, s[48:51], s52 offen offset:2048 sc1
    s_branch k12_oolret_61
k12_ool_62:
    s_add_u32 s52, s47, 536576
    buffer_store_dwordx4 v[188:191], v1, s[48:51], s52 offen offset:3072 sc1
    s_branch k12_oolret_63
k12_ool_64:
    s_mov_b32 s50, 0
    s_branch k12_oolret_65
k12_ool_66:
    s_mov_b64 exec, 1
    buffer_atomic_add v9, v8, s[24:27], s54 offen sc1
    s_mov_b64 exec, -1
    s_branch k12_oolret_67
k12_ool_68:
    buffer_load_dword v52, v8, s[24:27], s55 offen sc1
    s_branch k12_oolret_69
k12_ool_72:
    s_waitcnt vmcnt(10)
    v_readfirstlane_b32 s31, v52
    s_cmp_ge_u32 s31, 2
    s_cbranch_scc1 spin_ok_70
    s_mov_b32 s40, 1048576
spin_71:
    s_sleep 8
    buffer_load_dword v52, v8, s[24:27], s55 offen sc1
    s_waitcnt vmcnt(0)
    v_readfirstlane_b32 s31, v52
    s_sub_u32 s40, s40, 1
    s_cselect_b32 s31, -1, s31
    s_cmp_lt_u32 s31, 2
    s_cbranch_scc1 spin_71
spin_ok_70:
    s_branch k12_oolret_73
k12_ool_74:
    s_mov_b64 exec, 1
    buffer_atomic_add v9, v8, s[24:27], s3 offen sc1
    s_mov_b64 exec, -1
    s_branch k12_oolret_75
k12_ool_78:
    buffer_load_dword v58, v59, s[24:27], s5 offen sc1
    s_branch k12_oolret_79
k12_ool_82:
    s_waitcnt vmcnt(0)
    v_readfirstlane_b32 s31, v58
    s_cmp_ge_u32 s31, 14
    s_cbranch_scc1 spin_ok_80
    s_mov_b32 s40, 1048576
spin_81:
    s_sleep 8
    buffer_load_dword v58, v59, s[24:27], s5 offen sc1
    s_waitcnt vmcnt(0)
    v_readfirstlane_b32 s31, v58
    s_sub_u32 s40, s40, 1
    s_cselect_b32 s31, -1, s31
    s_cmp_lt_u32 s31, 14
    s_cbranch_scc1 spin_81
spin_ok_80:
    s_branch k12_oolret_83
k12_ool_122:
    s_mov_b64 exec, 1
    buffer_atomic_add v76, v75, s[16:19], s57 offen sc1
    s_mov_b64 exec, -1
    s_branch k12_oolret_123
k12_ool_127:
    s_mov_b64 exec, 1
    buffer_atomic_add v76, v75, s[16:19], s58 offen sc1
    s_mov_b64 exec, -1
    s_branch k12_oolret_128
k12_ool_131:
    s_mov_b32 s34, 1048576
op_spin_129:
    buffer_load_dword v74, v73, s[16:19], s59 offen sc1
    s_waitcnt vmcnt(0)
    v_cmp_le_u32 vcc, 4, v74
    s_sub_u32 s34, s34, 1
    s_cbranch_scc1 op_ok_130
    s_mov_b32 s33, vcc_lo
    s_bitcmp1_b32 s33, 0
    s_cbranch_scc1 op_ok_130
    s_sleep 4
    s_branch op_spin_129
op_ok_130:
    buffer_load_dwordx4 a[128:131], v88, s[8:11], s62 offen offset:0 sc1
    buffer_load_dwordx4 a[132:135], v88, s[8:11], s62 offen offset:1024 sc1
    buffer_load_dwordx4 a[136:139], v89, s[8:11], s62 offen offset:0 sc1
    buffer_load_dwordx4 a[140:143], v89, s[8:11], s62 offen offset:1024 sc1
    s_add_u32 s62, s62, 0x40000
    s_and_b32 s62, s62, 0x7fffff
    buffer_load_dwordx4 a[144:147], v88, s[8:11], s62 offen offset:0 sc1
    buffer_load_dwordx4 a[148:151], v88, s[8:11], s62 offen offset:1024 sc1
    buffer_load_dwordx4 a[152:155], v89, s[8:11], s62 offen offset:0 sc1
    buffer_load_dwordx4 a[156:159], v89, s[8:11], s62 offen offset:1024 sc1
    s_add_u32 s62, s62, 0x40000
    s_and_b32 s62, s62, 0x7fffff
    buffer_load_dwordx4 a[160:163], v88, s[8:11], s62 offen offset:0 sc1
    buffer_load_dwordx4 a[164:167], v88, s[8:11], s62 offen offset:1024 sc1
    buffer_load_dwordx4 a[168:171], v89, s[8:11], s62 offen offset:0 sc1
    buffer_load_dwordx4 a[172:175], v89, s[8:11], s62 offen offset:1024 sc1
    s_add_u32 s62, s62, 0x40000
    s_and_b32 s62, s62, 0x7fffff
    s_branch k12_oolret_132
k12_ool_137:
    buffer_load_dwordx2 v[192:193], v78, s[20:23], 0 offen offset:0
    buffer_load_dwordx2 v[194:195], v78, s[20:23], 0 offen offset:32
    buffer_load_dwordx2 v[196:197], v78, s[20:23], 0 offen offset:64
    buffer_load_dwordx2 v[198:199], v78, s[20:23], 0 offen offset:96
    buffer_load_dwordx2 v[200:201], v79, s[20:23], 0 offen offset:0
    buffer_load_dwordx2 v[202:203], v79, s[20:23], 0 offen offset:32
    buffer_load_dwordx2 v[204:205], v79, s[20:23], 0 offen offset:64
    buffer_load_dwordx2 v[206:207], v79, s[20:23], 0 offen offset:96
    buffer_load_dwordx2 v[208:209], v80, s[44:47], 0 offen offset:0
    buffer_load_dwordx2 v[210:211], v80, s[44:47], 0 offen offset:32
    buffer_load_dwordx2 v[212:213], v80, s[44:47], 0 offen offset:64
    buffer_load_dwordx2 v[214:215], v80, s[44:47], 0 offen offset:96
    global_load_dword v84, v[82:83], off
    s_mov_b32 s10, 0
    s_mov_b32 s14, 0
    s_mov_b32 s34, 1048576
ff_spin_135:
    v_cmp_gt_u32 vcc, 4, v95
    s_cbranch_vccz ff_ok_136
    s_sub_u32 s34, s34, 1
    s_cbranch_scc1 ff_ok_136
    s_sleep 4
    buffer_load_dword v95, v94, s[16:19], 0 offen sc1
    s_waitcnt vmcnt(0)
    s_branch ff_spin_135
ff_ok_136:
    s_add_u32 s44, s6, 0x6000000
    s_addc_u32 s45, s7, 0
    s_and_b32 s45, s45, 0xffff
    s_cmp_ge_u32 s2, 224
    s_cselect_b32 s46, 0, 0x1000000
    s_branch k12_oolret_138
k12_ool_141:
    s_mov_b32 s34, 1048576
op_spin_139:
    buffer_load_dword v74, v73, s[16:19], s59 offen sc1
    s_waitcnt vmcnt(0)
    v_cmp_le_u32 vcc, 4, v74
    s_sub_u32 s34, s34, 1
    s_cbranch_scc1 op_ok_140
    s_mov_b32 s33, vcc_lo
    s_bitcmp1_b32 s33, s32
    s_cbranch_scc1 op_ok_140
    s_sleep 4
    s_branch op_spin_139
op_ok_140:
    s_branch k12_oolret_142
k12_ool_143:
    buffer_load_dword v95, v94, s[16:19], 0 offen sc1
    s_branch k12_oolret_144
k2_tramp_86:
    s_call_b64 s[40:41], k2_rare_158
    s_branch k2_ret_87
k2_tramp_90:
    s_call_b64 s[40:41], k2_rare_159
    s_branch k2_ret_91
k2_tramp_92:
    s_call_b64 s[40:41], k2_rare_158
    s_branch k2_ret_93
k2_tramp_94:
    s_call_b64 s[40:41], k2_rare_159
    s_branch k2_ret_95
k2_tramp_96:
    s_call_b64 s[40:41], k2_rare_158
    s_branch k2_ret_97
k2_tramp_98:
    s_call_b64 s[40:41], k2_rare_159
    s_branch k2_ret_99
k2_tramp_100:
    s_call_b64 s[40:41], k2_rare_164
    s_branch k2_ret_101
k2_tramp_104:
    s_call_b64 s[40:41], k2_rare_165
    s_branch k2_ret_105
k2_tramp_108:
    s_call_b64 s[40:41], k2_rare_166
    s_branch k2_ret_109
k2_tramp_112:
    s_call_b64 s[40:41], k2_rare_167
    s_branch k2_ret_113
k2_tramp_114:
    s_call_b64 s[40:41], k2_rare_166
    s_branch k2_ret_115
k2_tramp_116:
    s_call_b64 s[40:41], k2_rare_167
    s_branch k2_ret_117
k2_tramp_118:
    s_call_b64 s[40:41], k2_rare_166
    s_branch k2_ret_119
k2_tramp_120:
    s_call_b64 s[40:41], k2_rare_171
    s_branch k2_ret_121
k2_rare_158:
    s_nop 7
    v_max_f32 v52, v128, v129
    v_max3_f32 v52, v52, v130, v131
    v_max3_f32 v52, v52, v144, v145
    v_max3_f32 v52, v52, v146, v147
    v_max_f32 v53, v132, v133
    v_max3_f32 v53, v53, v134, v135
    v_max3_f32 v53, v53, v148, v149
    v_max3_f32 v53, v53, v150, v151
    v_max_f32 v54, v136, v137
    v_max3_f32 v54, v54, v138, v139
    v_max3_f32 v54, v54, v152, v153
    v_max3_f32 v54, v54, v154, v155
    v_max_f32 v55, v140, v141
    v_max3_f32 v55, v55, v142, v143
    v_max3_f32 v55, v55, v156, v157
    v_max3_f32 v55, v55, v158, v159
    v_mov_b32 v224, v52
    v_mov_b32 v225, v53
    v_mov_b32 v226, v54
    v_mov_b32 v227, v55
    s_nop 1
    v_permlane16_swap_b32 v52, v224
    v_permlane16_swap_b32 v53, v225
    v_permlane16_swap_b32 v54, v226
    v_permlane16_swap_b32 v55, v227
    s_nop 1
    v_max_f32 v52, v52, v224
    v_max_f32 v53, v53, v225
    v_max_f32 v54, v54, v226
    v_max_f32 v55, v55, v227
    v_mov_b32 v224, v52
    v_mov_b32 v225, v53
    v_mov_b32 v226, v54
    v_mov_b32 v227, v55
    s_nop 1
    v_permlane32_swap_b32 v52, v224
    v_permlane32_swap_b32 v53, v225
    v_permlane32_swap_b32 v54, v226
    v_permlane32_swap_b32 v55, v227
    s_nop 1
    v_max_f32 v52, v52, v224
    v_max_f32 v53, v53, v225
    v_max_f32 v54, v54, v226
    v_max_f32 v55, v55, v227
    v_add_f32 v52, 0x41400000, v52
    v_max_f32 v52, 0, v52
    v_add_f32 v53, 0x41400000, v53
    v_max_f32 v53, 0, v53
    v_add_f32 v54, 0x41400000, v54
    v_max_f32 v54, 0, v54
    v_add_f32 v55, 0x41400000, v55
    v_max_f32 v55, 0, v55
    v_sub_f32 v128, v128, v52
    v_sub_f32 v129, v129, v52
    v_sub_f32 v130, v130, v52
    v_sub_f32 v131, v131, v52
    v_sub_f32 v132, v132, v53
    v_sub_f32 v133, v133, v53
    v_sub_f32 v134, v134, v53
    v_sub_f32 v135, v135, v53
    v_sub_f32 v136, v136, v54
    v_sub_f32 v137, v137, v54
    v_sub_f32 v138, v138, v54
    v_sub_f32 v139, v139, v54
    v_sub_f32 v140, v140, v55
    v_sub_f32 v141, v141, v55
    v_sub_f32 v142, v142, v55
    v_sub_f32 v143, v143, v55
    v_sub_f32 v144, v144, v52
    v_sub_f32 v145, v145, v52
    v_sub_f32 v146, v146, v52
    v_sub_f32 v147, v147, v52
    v_sub_f32 v148, v148, v53
    v_sub_f32 v149, v149, v53
    v_sub_f32 v150, v150, v53
    v_sub_f32 v151, v151, v53
    v_sub_f32 v152, v152, v54
    v_sub_f32 v153, v153, v54
    v_sub_f32 v154, v154, v54
    v_sub_f32 v155, v155, v54
    v_sub_f32 v156, v156, v55
    v_sub_f32 v157, v157, v55
    v_sub_f32 v158, v158, v55
    v_sub_f32 v159, v159, v55
    v_sub_f32 v160, v160, v52
    v_sub_f32 v16, v16, v52
    v_sub_f32 v161, v161, v52
    v_sub_f32 v17, v17, v52
    v_sub_f32 v162, v162, v52
    v_sub_f32 v18, v18, v52
    v_sub_f32 v163, v163, v52
    v_sub_f32 v19, v19, v52
    v_sub_f32 v164, v164, v53
    v_sub_f32 v20, v20, v53
    v_sub_f32 v165, v165, v53
    v_sub_f32 v21, v21, v53
    v_sub_f32 v166, v166, v53
    v_sub_f32 v22, v22, v53
    v_sub_f32 v167, v167, v53
    v_sub_f32 v23, v23, v53
    v_sub_f32 v168, v168, v54
    v_sub_f32 v24, v24, v54
    v_sub_f32 v169, v169, v54
    v_sub_f32 v25, v25, v54
    v_sub_f32 v170, v170, v54
    v_sub_f32 v26, v26, v54
    v_sub_f32 v171, v171, v54
    v_sub_f32 v27, v27, v54
    v_sub_f32 v172, v172, v55
    v_sub_f32 v28, v28, v55
    v_sub_f32 v173, v173, v55
    v_sub_f32 v29, v29, v55
    v_sub_f32 v174, v174, v55
    v_sub_f32 v30, v30, v55
    v_sub_f32 v175, v175, v55
    v_sub_f32 v31, v31, v55
    v_sub_f32 v176, v176, v52
    v_sub_f32 v32, v32, v52
    v_sub_f32 v177, v177, v52
    v_sub_f32 v33, v33, v52
    v_sub_f32 v178, v178, v52
    v_sub_f32 v34, v34, v52
    v_sub_f32 v179, v179, v52
    v_sub_f32 v35, v35, v52
    v_sub_f32 v180, v180, v53
    v_sub_f32 v36, v36, v53
    v_sub_f32 v181, v181, v53
    v_sub_f32 v37, v37, v53
    v_sub_f32 v182, v182, v53
    v_sub_f32 v38, v38, v53
    v_sub_f32 v183, v183, v53
    v_sub_f32 v39, v39, v53
    v_sub_f32 v184, v184, v54
    v_sub_f32 v40, v40, v54
    v_sub_f32 v185, v185, v54
    v_sub_f32 v41, v41, v54
    v_sub_f32 v186, v186, v54
    v_sub_f32 v42, v42, v54
    v_sub_f32 v187, v187, v54
    v_sub_f32 v43, v43, v54
    v_sub_f32 v188, v188, v55
    v_sub_f32 v44, v44, v55
    v_sub_f32 v189, v189, v55
    v_sub_f32 v45, v45, v55
    v_sub_f32 v190, v190, v55
    v_sub_f32 v46, v46, v55
    v_sub_f32 v191, v191, v55
    v_sub_f32 v47, v47, v55
    v_sub_f32 v8, v8, v52
    v_exp_f32 v52, -v52
    v_sub_f32 v9, v9, v53
    v_exp_f32 v53, -v53
    v_sub_f32 v10, v10, v54
    v_exp_f32 v54, -v54
    v_sub_f32 v11, v11, v55
    v_exp_f32 v55, -v55
    s_nop 0
    v_mul_f32 v12, v12, v52
    v_mul_f32 v48, v48, v53
    v_mul_f32 v248, v248, v54
    v_mul_f32 v252, v252, v55
    v_accvgpr_read_b32 v224, a0
    v_accvgpr_read_b32 v225, a1
    v_accvgpr_read_b32 v226, a2
    v_accvgpr_read_b32 v227, a3
    v_mul_f32 v224, v224, v52
    v_mul_f32 v225, v225, v52
    v_mul_f32 v226, v226, v52
    v_mul_f32 v227, v227, v52
    v_accvgpr_write_b32 a0, v224
    v_accvgpr_write_b32 a1, v225
    v_accvgpr_write_b32 a2, v226
    v_accvgpr_write_b32 a3, v227
    v_accvgpr_read_b32 v224, a4
    v_accvgpr_read_b32 v225, a5
    v_accvgpr_read_b32 v226, a6
    v_accvgpr_read_b32 v227, a7
    v_mul_f32 v224, v224, v53
    v_mul_f32 v225, v225, v53
    v_mul_f32 v226, v226, v53
    v_mul_f32 v227, v227, v53
    v_accvgpr_write_b32 a4, v224
    v_accvgpr_write_b32 a5, v225
    v_accvgpr_write_b32 a6, v226
    v_accvgpr_write_b32 a7, v227
    v_accvgpr_read_b32 v224, a8
    v_accvgpr_read_b32 v225, a9
    v_accvgpr_read_b32 v226, a10
    v_accvgpr_read_b32 v227, a11
    v_mul_f32 v224, v224, v54
    v_mul_f32 v225, v225, v54
    v_mul_f32 v226, v226, v54
    v_mul_f32 v227, v227, v54
    v_accvgpr_write_b32 a8, v224
    v_accvgpr_write_b32 a9, v225
    v_accvgpr_write_b32 a10, v226
    v_accvgpr_write_b32 a11, v227
    v_accvgpr_read_b32 v224, a12
    v_accvgpr_read_b32 v225, a13
    v_accvgpr_read_b32 v226, a14
    v_accvgpr_read_b32 v227, a15
    v_mul_f32 v224, v224, v55
    v_mul_f32 v225, v225, v55
    v_mul_f32 v226, v226, v55
    v_mul_f32 v227, v227, v55
    v_accvgpr_write_b32 a12, v224
    v_accvgpr_write_b32 a13, v225
    v_accvgpr_write_b32 a14, v226
    v_accvgpr_write_b32 a15, v227
    v_accvgpr_read_b32 v224, a16
    v_accvgpr_read_b32 v225, a17
    v_accvgpr_read_b32 v226, a18
    v_accvgpr_read_b32 v227, a19
    v_mul_f32 v224, v224, v52
    v_mul_f32 v225, v225, v52
    v_mul_f32 v226, v226, v52
    v_mul_f32 v227, v227, v52
    v_accvgpr_write_b32 a16, v224
    v_accvgpr_write_b32 a17, v225
    v_accvgpr_write_b32 a18, v226
    v_accvgpr_write_b32 a19, v227
    v_accvgpr_read_b32 v224, a20
    v_accvgpr_read_b32 v225, a21
    v_accvgpr_read_b32 v226, a22
    v_accvgpr_read_b32 v227, a23
    v_mul_f32 v224, v224, v53
    v_mul_f32 v225, v225, v53
    v_mul_f32 v226, v226, v53
    v_mul_f32 v227, v227, v53
    v_accvgpr_write_b32 a20, v224
    v_accvgpr_write_b32 a21, v225
    v_accvgpr_write_b32 a22, v226
    v_accvgpr_write_b32 a23, v227
    v_accvgpr_read_b32 v224, a24
    v_accvgpr_read_b32 v225, a25
    v_accvgpr_read_b32 v226, a26
    v_accvgpr_read_b32 v227, a27
    v_mul_f32 v224, v224, v54
    v_mul_f32 v225, v225, v54
    v_mul_f32 v226, v226, v54
    v_mul_f32 v227, v227, v54
    v_accvgpr_write_b32 a24, v224
    v_accvgpr_write_b32 a25, v225
    v_accvgpr_write_b32 a26, v226
    v_accvgpr_write_b32 a27, v227
    v_accvgpr_read_b32 v224, a28
    v_accvgpr_read_b32 v225, a29
    v_accvgpr_read_b32 v226, a30
    v_accvgpr_read_b32 v227, a31
    v_mul_f32 v224, v224, v55
    v_mul_f32 v225, v225, v55
    v_mul_f32 v226, v226, v55
    v_mul_f32 v227, v227, v55
    v_accvgpr_write_b32 a28, v224
    v_accvgpr_write_b32 a29, v225
    v_accvgpr_write_b32 a30, v226
    v_accvgpr_write_b32 a31, v227
    v_accvgpr_read_b32 v224, a32
    v_accvgpr_read_b32 v225, a33
    v_accvgpr_read_b32 v226, a34
    v_accvgpr_read_b32 v227, a35
    v_mul_f32 v224, v224, v52
    v_mul_f32 v225, v225, v52
    v_mul_f32 v226, v226, v52
    v_mul_f32 v227, v227, v52
    v_accvgpr_write_b32 a32, v224
    v_accvgpr_write_b32 a33, v225
    v_accvgpr_write_b32 a34, v226
    v_accvgpr_write_b32 a35, v227
    v_accvgpr_read_b32 v224, a36
    v_accvgpr_read_b32 v225, a37
    v_accvgpr_read_b32 v226, a38
    v_accvgpr_read_b32 v227, a39
    v_mul_f32 v224, v224, v53
    v_mul_f32 v225, v225, v53
    v_mul_f32 v226, v226, v53
    v_mul_f32 v227, v227, v53
    v_accvgpr_write_b32 a36, v224
    v_accvgpr_write_b32 a37, v225
    v_accvgpr_write_b32 a38, v226
    v_accvgpr_write_b32 a39, v227
    v_accvgpr_read_b32 v224, a40
    v_accvgpr_read_b32 v225, a41
    v_accvgpr_read_b32 v226, a42
    v_accvgpr_read_b32 v227, a43
    v_mul_f32 v224, v224, v54
    v_mul_f32 v225, v225, v54
    v_mul_f32 v226, v226, v54
    v_mul_f32 v227, v227, v54
    v_accvgpr_write_b32 a40, v224
    v_accvgpr_write_b32 a41, v225
    v_accvgpr_write_b32 a42, v226
    v_accvgpr_write_b32 a43, v227
    v_accvgpr_read_b32 v224, a44
    v_accvgpr_read_b32 v225, a45
    v_accvgpr_read_b32 v226, a46
    v_accvgpr_read_b32 v227, a47
    v_mul_f32 v224, v224, v55
    v_mul_f32 v225, v225, v55
    v_mul_f32 v226, v226, v55
    v_mul_f32 v227, v227, v55
    v_accvgpr_write_b32 a44, v224
    v_accvgpr_write_b32 a45, v225
    v_accvgpr_write_b32 a46, v226
    v_accvgpr_write_b32 a47, v227
    v_accvgpr_read_b32 v224, a48
    v_accvgpr_read_b32 v225, a49
    v_accvgpr_read_b32 v226, a50
    v_accvgpr_read_b32 v227, a51
    v_mul_f32 v224, v224, v52
    v_mul_f32 v225, v225, v52
    v_mul_f32 v226, v226, v52
    v_mul_f32 v227, v227, v52
    v_accvgpr_write_b32 a48, v224
    v_accvgpr_write_b32 a49, v225
    v_accvgpr_write_b32 a50, v226
    v_accvgpr_write_b32 a51, v227
    v_accvgpr_read_b32 v224, a52
    v_accvgpr_read_b32 v225, a53
    v_accvgpr_read_b32 v226, a54
    v_accvgpr_read_b32 v227, a55
    v_mul_f32 v224, v224, v53
    v_mul_f32 v225, v225, v53
    v_mul_f32 v226, v226, v53
    v_mul_f32 v227, v227, v53
    v_accvgpr_write_b32 a52, v224
    v_accvgpr_write_b32 a53, v225
    v_accvgpr_write_b32 a54, v226
    v_accvgpr_write_b32 a55, v227
    v_accvgpr_read_b32 v224, a56
    v_accvgpr_read_b32 v225, a57
    v_accvgpr_read_b32 v226, a58
    v_accvgpr_read_b32 v227, a59
    v_mul_f32 v224, v224, v54
    v_mul_f32 v225, v225, v54
    v_mul_f32 v226, v226, v54
    v_mul_f32 v227, v227, v54
    v_accvgpr_write_b32 a56, v224
    v_accvgpr_write_b32 a57, v225
    v_accvgpr_write_b32 a58, v226
    v_accvgpr_write_b32 a59, v227
    v_accvgpr_read_b32 v224, a60
    v_accvgpr_read_b32 v225, a61
    v_accvgpr_read_b32 v226, a62
    v_accvgpr_read_b32 v227, a63
    v_mul_f32 v224, v224, v55
    v_mul_f32 v225, v225, v55
    v_mul_f32 v226, v226, v55
    v_mul_f32 v227, v227, v55
    v_accvgpr_write_b32 a60, v224
    v_accvgpr_write_b32 a61, v225
    v_accvgpr_write_b32 a62, v226
    v_accvgpr_write_b32 a63, v227
    v_accvgpr_read_b32 v224, a64
    v_accvgpr_read_b32 v225, a65
    v_accvgpr_read_b32 v226, a66
    v_accvgpr_read_b32 v227, a67
    v_mul_f32 v224, v224, v52
    v_mul_f32 v225, v225, v52
    v_mul_f32 v226, v226, v52
    v_mul_f32 v227, v227, v52
    v_accvgpr_write_b32 a64, v224
    v_accvgpr_write_b32 a65, v225
    v_accvgpr_write_b32 a66, v226
    v_accvgpr_write_b32 a67, v227
    v_accvgpr_read_b32 v224, a68
    v_accvgpr_read_b32 v225, a69
    v_accvgpr_read_b32 v226, a70
    v_accvgpr_read_b32 v227, a71
    v_mul_f32 v224, v224, v53
    v_mul_f32 v225, v225, v53
    v_mul_f32 v226, v226, v53
    v_mul_f32 v227, v227, v53
    v_accvgpr_write_b32 a68, v224
    v_accvgpr_write_b32 a69, v225
    v_accvgpr_write_b32 a70, v226
    v_accvgpr_write_b32 a71, v227
    v_accvgpr_read_b32 v224, a72
    v_accvgpr_read_b32 v225, a73
    v_accvgpr_read_b32 v226, a74
    v_accvgpr_read_b32 v227, a75
    v_mul_f32 v224, v224, v54
    v_mul_f32 v225, v225, v54
    v_mul_f32 v226, v226, v54
    v_mul_f32 v227, v227, v54
    v_accvgpr_write_b32 a72, v224
    v_accvgpr_write_b32 a73, v225
    v_accvgpr_write_b32 a74, v226
    v_accvgpr_write_b32 a75, v227
    v_accvgpr_read_b32 v224, a76
    v_accvgpr_read_b32 v225, a77
    v_accvgpr_read_b32 v226, a78
    v_accvgpr_read_b32 v227, a79
    v_mul_f32 v224, v224, v55
    v_mul_f32 v225, v225, v55
    v_mul_f32 v226, v226, v55
    v_mul_f32 v227, v227, v55
    v_accvgpr_write_b32 a76, v224
    v_accvgpr_write_b32 a77, v225
    v_accvgpr_write_b32 a78, v226
    v_accvgpr_write_b32 a79, v227
    v_accvgpr_read_b32 v224, a80
    v_accvgpr_read_b32 v225, a81
    v_accvgpr_read_b32 v226, a82
    v_accvgpr_read_b32 v227, a83
    v_mul_f32 v224, v224, v52
    v_mul_f32 v225, v225, v52
    v_mul_f32 v226, v226, v52
    v_mul_f32 v227, v227, v52
    v_accvgpr_write_b32 a80, v224
    v_accvgpr_write_b32 a81, v225
    v_accvgpr_write_b32 a82, v226
    v_accvgpr_write_b32 a83, v227
    v_accvgpr_read_b32 v224, a84
    v_accvgpr_read_b32 v225, a85
    v_accvgpr_read_b32 v226, a86
    v_accvgpr_read_b32 v227, a87
    v_mul_f32 v224, v224, v53
    v_mul_f32 v225, v225, v53
    v_mul_f32 v226, v226, v53
    v_mul_f32 v227, v227, v53
    v_accvgpr_write_b32 a84, v224
    v_accvgpr_write_b32 a85, v225
    v_accvgpr_write_b32 a86, v226
    v_accvgpr_write_b32 a87, v227
    v_accvgpr_read_b32 v224, a88
    v_accvgpr_read_b32 v225, a89
    v_accvgpr_read_b32 v226, a90
    v_accvgpr_read_b32 v227, a91
    v_mul_f32 v224, v224, v54
    v_mul_f32 v225, v225, v54
    v_mul_f32 v226, v226, v54
    v_mul_f32 v227, v227, v54
    v_accvgpr_write_b32 a88, v224
    v_accvgpr_write_b32 a89, v225
    v_accvgpr_write_b32 a90, v226
    v_accvgpr_write_b32 a91, v227
    v_accvgpr_read_b32 v224, a92
    v_accvgpr_read_b32 v225, a93
    v_accvgpr_read_b32 v226, a94
    v_accvgpr_read_b32 v227, a95
    v_mul_f32 v224, v224, v55
    v_mul_f32 v225, v225, v55
    v_mul_f32 v226, v226, v55
    v_mul_f32 v227, v227, v55
    v_accvgpr_write_b32 a92, v224
    v_accvgpr_write_b32 a93, v225
    v_accvgpr_write_b32 a94, v226
    v_accvgpr_write_b32 a95, v227
    v_accvgpr_read_b32 v224, a96
    v_accvgpr_read_b32 v225, a97
    v_accvgpr_read_b32 v226, a98
    v_accvgpr_read_b32 v227, a99
    v_mul_f32 v224, v224, v52
    v_mul_f32 v225, v225, v52
    v_mul_f32 v226, v226, v52
    v_mul_f32 v227, v227, v52
    v_accvgpr_write_b32 a96, v224
    v_accvgpr_write_b32 a97, v225
    v_accvgpr_write_b32 a98, v226
    v_accvgpr_write_b32 a99, v227
    v_accvgpr_read_b32 v224, a100
    v_accvgpr_read_b32 v225, a101
    v_accvgpr_read_b32 v226, a102
    v_accvgpr_read_b32 v227, a103
    v_mul_f32 v224, v224, v53
    v_mul_f32 v225, v225, v53
    v_mul_f32 v226, v226, v53
    v_mul_f32 v227, v227, v53
    v_accvgpr_write_b32 a100, v224
    v_accvgpr_write_b32 a101, v225
    v_accvgpr_write_b32 a102, v226
    v_accvgpr_write_b32 a103, v227
    v_accvgpr_read_b32 v224, a104
    v_accvgpr_read_b32 v225, a105
    v_accvgpr_read_b32 v226, a106
    v_accvgpr_read_b32 v227, a107
    v_mul_f32 v224, v224, v54
    v_mul_f32 v225, v225, v54
    v_mul_f32 v226, v226, v54
    v_mul_f32 v227, v227, v54
    v_accvgpr_write_b32 a104, v224
    v_accvgpr_write_b32 a105, v225
    v_accvgpr_write_b32 a106, v226
    v_accvgpr_write_b32 a107, v227
    v_accvgpr_read_b32 v224, a108
    v_accvgpr_read_b32 v225, a109
    v_accvgpr_read_b32 v226, a110
    v_accvgpr_read_b32 v227, a111
    v_mul_f32 v224, v224, v55
    v_mul_f32 v225, v225, v55
    v_mul_f32 v226, v226, v55
    v_mul_f32 v227, v227, v55
    v_accvgpr_write_b32 a108, v224
    v_accvgpr_write_b32 a109, v225
    v_accvgpr_write_b32 a110, v226
    v_accvgpr_write_b32 a111, v227
    v_accvgpr_read_b32 v224, a112
    v_accvgpr_read_b32 v225, a113
    v_accvgpr_read_b32 v226, a114
    v_accvgpr_read_b32 v227, a115
    v_mul_f32 v224, v224, v52
    v_mul_f32 v225, v225, v52
    v_mul_f32 v226, v226, v52
    v_mul_f32 v227, v227, v52
    v_accvgpr_write_b32 a112, v224
    v_accvgpr_write_b32 a113, v225
    v_accvgpr_write_b32 a114, v226
    v_accvgpr_write_b32 a115, v227
    v_accvgpr_read_b32 v224, a116
    v_accvgpr_read_b32 v225, a117
    v_accvgpr_read_b32 v226, a118
    v_accvgpr_read_b32 v227, a119
    v_mul_f32 v224, v224, v53
    v_mul_f32 v225, v225, v53
    v_mul_f32 v226, v226, v53
    v_mul_f32 v227, v227, v53
    v_accvgpr_write_b32 a116, v224
    v_accvgpr_write_b32 a117, v225
    v_accvgpr_write_b32 a118, v226
    v_accvgpr_write_b32 a119, v227
    v_accvgpr_read_b32 v224, a120
    v_accvgpr_read_b32 v225, a121
    v_accvgpr_read_b32 v226, a122
    v_accvgpr_read_b32 v227, a123
    v_mul_f32 v224, v224, v54
    v_mul_f32 v225, v225, v54
    v_mul_f32 v226, v226, v54
    v_mul_f32 v227, v227, v54
    v_accvgpr_write_b32 a120, v224
    v_accvgpr_write_b32 a121, v225
    v_accvgpr_write_b32 a122, v226
    v_accvgpr_write_b32 a123, v227
    v_accvgpr_read_b32 v224, a124
    v_accvgpr_read_b32 v225, a125
    v_accvgpr_read_b32 v226, a126
    v_accvgpr_read_b32 v227, a127
    v_mul_f32 v224, v224, v55
    v_mul_f32 v225, v225, v55
    v_mul_f32 v226, v226, v55
    v_mul_f32 v227, v227, v55
    v_accvgpr_write_b32 a124, v224
    v_accvgpr_write_b32 a125, v225
    v_accvgpr_write_b32 a126, v226
    v_accvgpr_write_b32 a127, v227
    v_exp_f32 v232, v128
    v_exp_f32 v233, v129
    v_exp_f32 v234, v130
    v_exp_f32 v235, v131
    s_nop 0
    v_cvt_pk_bf16_f32 v192, v232, v233
    v_cvt_pk_bf16_f32 v193, v234, v235
    v_exp_f32 v232, v144
    v_exp_f32 v233, v145
    v_exp_f32 v234, v146
    v_exp_f32 v235, v147
    s_nop 0
    v_cvt_pk_bf16_f32 v194, v232, v233
    v_cvt_pk_bf16_f32 v195, v234, v235
    v_exp_f32 v232, v132
    v_exp_f32 v233, v133
    v_exp_f32 v234, v134
    v_exp_f32 v235, v135
    s_nop 0
    v_cvt_pk_bf16_f32 v196, v232, v233
    v_cvt_pk_bf16_f32 v197, v234, v235
    v_exp_f32 v232, v148
    v_exp_f32 v233, v149
    v_exp_f32 v234, v150
    v_exp_f32 v235, v151
    s_nop 0
    v_cvt_pk_bf16_f32 v198, v232, v233
    v_cvt_pk_bf16_f32 v199, v234, v235
    v_exp_f32 v232, v136
    v_exp_f32 v233, v137
    v_exp_f32 v234, v138
    v_exp_f32 v235, v139
    s_nop 0
    v_cvt_pk_bf16_f32 v200, v232, v233
    v_cvt_pk_bf16_f32 v201, v234, v235
    v_exp_f32 v232, v152
    v_exp_f32 v233, v153
    v_exp_f32 v234, v154
    v_exp_f32 v235, v155
    s_nop 0
    v_cvt_pk_bf16_f32 v202, v232, v233
    v_cvt_pk_bf16_f32 v203, v234, v235
    v_exp_f32 v232, v140
    v_exp_f32 v233, v141
    v_exp_f32 v234, v142
    v_exp_f32 v235, v143
    s_nop 0
    v_cvt_pk_bf16_f32 v204, v232, v233
    v_cvt_pk_bf16_f32 v205, v234, v235
    v_exp_f32 v232, v156
    v_exp_f32 v233, v157
    v_exp_f32 v234, v158
    v_exp_f32 v235, v159
    s_nop 0
    v_cvt_pk_bf16_f32 v206, v232, v233
    v_cvt_pk_bf16_f32 v207, v234, v235
    s_nop 3
    s_setpc_b64 s[40:41]
k2_rare_159:
    s_nop 7
    v_max_f32 v52, v160, v161
    v_max3_f32 v52, v52, v162, v163
    v_max3_f32 v52, v52, v176, v177
    v_max3_f32 v52, v52, v178, v179
    v_max_f32 v53, v164, v165
    v_max3_f32 v53, v53, v166, v167
    v_max3_f32 v53, v53, v180, v181
    v_max3_f32 v53, v53, v182, v183
    v_max_f32 v54, v168, v169
    v_max3_f32 v54, v54, v170, v171
    v_max3_f32 v54, v54, v184, v185
    v_max3_f32 v54, v54, v186, v187
    v_max_f32 v55, v172, v173
    v_max3_f32 v55, v55, v174, v175
    v_max3_f32 v55, v55, v188, v189
    v_max3_f32 v55, v55, v190, v191
    v_mov_b32 v224, v52
    v_mov_b32 v225, v53
    v_mov_b32 v226, v54
    v_mov_b32 v227, v55
    s_nop 1
    v_permlane16_swap_b32 v52, v224
    v_permlane16_swap_b32 v53, v225
    v_permlane16_swap_b32 v54, v226
    v_permlane16_swap_b32 v55, v227
    s_nop 1
    v_max_f32 v52, v52, v224
    v_max_f32 v53, v53, v225
    v_max_f32 v54, v54, v226
    v_max_f32 v55, v55, v227
    v_mov_b32 v224, v52
    v_mov_b32 v225, v53
    v_mov_b32 v226, v54
    v_mov_b32 v227, v55
    s_nop 1
    v_permlane32_swap_b32 v52, v224
    v_permlane32_swap_b32 v53, v225
    v_permlane32_swap_b32 v54, v226
    v_permlane32_swap_b32 v55, v227
    s_nop 1
    v_max_f32 v52, v52, v224
    v_max_f32 v53, v53, v225
    v_max_f32 v54, v54, v226
    v_max_f32 v55, v55, v227
    v_add_f32 v52, 0x41400000, v52
    v_max_f32 v52, 0, v52
    v_add_f32 v53, 0x41400000, v53
    v_max_f32 v53, 0, v53
    v_add_f32 v54, 0x41400000, v54
    v_max_f32 v54, 0, v54
    v_add_f32 v55, 0x41400000, v55
    v_max_f32 v55, 0, v55
    v_sub_f32 v160, v160, v52
    v_sub_f32 v161, v161, v52
    v_sub_f32 v162, v162, v52
    v_sub_f32 v163, v163, v52
    v_sub_f32 v164, v164, v53
    v_sub_f32 v165, v165, v53
    v_sub_f32 v166, v166, v53
    v_sub_f32 v167, v167, v53
    v_sub_f32 v168, v168, v54
    v_sub_f32 v169, v169, v54
    v_sub_f32 v170, v170, v54
    v_sub_f32 v171, v171, v54
    v_sub_f32 v172, v172, v55
    v_sub_f32 v173, v173, v55
    v_sub_f32 v174, v174, v55
    v_sub_f32 v175, v175, v55
    v_sub_f32 v176, v176, v52
    v_sub_f32 v177, v177, v52
    v_sub_f32 v178, v178, v52
    v_sub_f32 v179, v179, v52
    v_sub_f32 v180, v180, v53
    v_sub_f32 v181, v181, v53
    v_sub_f32 v182, v182, v53
    v_sub_f32 v183, v183, v53
    v_sub_f32 v184, v184, v54
    v_sub_f32 v185, v185, v54
    v_sub_f32 v186, v186, v54
    v_sub_f32 v187, v187, v54
    v_sub_f32 v188, v188, v55
    v_sub_f32 v189, v189, v55
    v_sub_f32 v190, v190, v55
    v_sub_f32 v191, v191, v55
    v_sub_f32 v128, v128, v52
    v_sub_f32 v16, v16, v52
    v_sub_f32 v129, v129, v52
    v_sub_f32 v17, v17, v52
    v_sub_f32 v130, v130, v52
    v_sub_f32 v18, v18, v52
    v_sub_f32 v131, v131, v52
    v_sub_f32 v19, v19, v52
    v_sub_f32 v132, v132, v53
    v_sub_f32 v20, v20, v53
    v_sub_f32 v133, v133, v53
    v_sub_f32 v21, v21, v53
    v_sub_f32 v134, v134, v53
    v_sub_f32 v22, v22, v53
    v_sub_f32 v135, v135, v53
    v_sub_f32 v23, v23, v53
    v_sub_f32 v136, v136, v54
    v_sub_f32 v24, v24, v54
    v_sub_f32 v137, v137, v54
    v_sub_f32 v25, v25, v54
    v_sub_f32 v138, v138, v54
    v_sub_f32 v26, v26, v54
    v_sub_f32 v139, v139, v54
    v_sub_f32 v27, v27, v54
    v_sub_f32 v140, v140, v55
    v_sub_f32 v28, v28, v55
    v_sub_f32 v141, v141, v55
    v_sub_f32 v29, v29, v55
    v_sub_f32 v142, v142, v55
    v_sub_f32 v30, v30, v55
    v_sub_f32 v143, v143, v55
    v_sub_f32 v31, v31, v55
    v_sub_f32 v144, v144, v52
    v_sub_f32 v32, v32, v52
    v_sub_f32 v145, v145, v52
    v_sub_f32 v33, v33, v52
    v_sub_f32 v146, v146, v52
    v_sub_f32 v34, v34, v52
    v_sub_f32 v147, v147, v52
    v_sub_f32 v35, v35, v52
    v_sub_f32 v148, v148, v53
    v_sub_f32 v36, v36, v53
    v_sub_f32 v149, v149, v53
    v_sub_f32 v37, v37, v53
    v_sub_f32 v150, v150, v53
    v_sub_f32 v38, v38, v53
    v_sub_f32 v151, v151, v53
    v_sub_f32 v39, v39, v53
    v_sub_f32 v152, v152, v54
    v_sub_f32 v40, v40, v54
    v_sub_f32 v153, v153, v54
    v_sub_f32 v41, v41, v54
    v_sub_f32 v154, v154, v54
    v_sub_f32 v42, v42, v54
    v_sub_f32 v155, v155, v54
    v_sub_f32 v43, v43, v54
    v_sub_f32 v156, v156, v55
    v_sub_f32 v44, v44, v55
    v_sub_f32 v157, v157, v55
    v_sub_f32 v45, v45, v55
    v_sub_f32 v158, v158, v55
    v_sub_f32 v46, v46, v55
    v_sub_f32 v159, v159, v55
    v_sub_f32 v47, v47, v55
    v_sub_f32 v8, v8, v52
    v_exp_f32 v52, -v52
    v_sub_f32 v9, v9, v53
    v_exp_f32 v53, -v53
    v_sub_f32 v10, v10, v54
    v_exp_f32 v54, -v54
    v_sub_f32 v11, v11, v55
    v_exp_f32 v55, -v55
    s_nop 0
    v_mul_f32 v12, v12, v52
    v_mul_f32 v48, v48, v53
    v_mul_f32 v248, v248, v54
    v_mul_f32 v252, v252, v55
    v_accvgpr_read_b32 v224, a0
    v_accvgpr_read_b32 v225, a1
    v_accvgpr_read_b32 v226, a2
    v_accvgpr_read_b32 v227, a3
    v_mul_f32 v224, v224, v52
    v_mul_f32 v225, v225, v52
    v_mul_f32 v226, v226, v52
    v_mul_f32 v227, v227, v52
    v_accvgpr_write_b32 a0, v224
    v_accvgpr_write_b32 a1, v225
    v_accvgpr_write_b32 a2, v226
    v_accvgpr_write_b32 a3, v227
    v_accvgpr_read_b32 v224, a4
    v_accvgpr_read_b32 v225, a5
    v_accvgpr_read_b32 v226, a6
    v_accvgpr_read_b32 v227, a7
    v_mul_f32 v224, v224, v53
    v_mul_f32 v225, v225, v53
    v_mul_f32 v226, v226, v53
    v_mul_f32 v227, v227, v53
    v_accvgpr_write_b32 a4, v224
    v_accvgpr_write_b32 a5, v225
    v_accvgpr_write_b32 a6, v226
    v_accvgpr_write_b32 a7, v227
    v_accvgpr_read_b32 v224, a8
    v_accvgpr_read_b32 v225, a9
    v_accvgpr_read_b32 v226, a10
    v_accvgpr_read_b32 v227, a11
    v_mul_f32 v224, v224, v54
    v_mul_f32 v225, v225, v54
    v_mul_f32 v226, v226, v54
    v_mul_f32 v227, v227, v54
    v_accvgpr_write_b32 a8, v224
    v_accvgpr_write_b32 a9, v225
    v_accvgpr_write_b32 a10, v226
    v_accvgpr_write_b32 a11, v227
    v_accvgpr_read_b32 v224, a12
    v_accvgpr_read_b32 v225, a13
    v_accvgpr_read_b32 v226, a14
    v_accvgpr_read_b32 v227, a15
    v_mul_f32 v224, v224, v55
    v_mul_f32 v225, v225, v55
    v_mul_f32 v226, v226, v55
    v_mul_f32 v227, v227, v55
    v_accvgpr_write_b32 a12, v224
    v_accvgpr_write_b32 a13, v225
    v_accvgpr_write_b32 a14, v226
    v_accvgpr_write_b32 a15, v227
    v_accvgpr_read_b32 v224, a16
    v_accvgpr_read_b32 v225, a17
    v_accvgpr_read_b32 v226, a18
    v_accvgpr_read_b32 v227, a19
    v_mul_f32 v224, v224, v52
    v_mul_f32 v225, v225, v52
    v_mul_f32 v226, v226, v52
    v_mul_f32 v227, v227, v52
    v_accvgpr_write_b32 a16, v224
    v_accvgpr_write_b32 a17, v225
    v_accvgpr_write_b32 a18, v226
    v_accvgpr_write_b32 a19, v227
    v_accvgpr_read_b32 v224, a20
    v_accvgpr_read_b32 v225, a21
    v_accvgpr_read_b32 v226, a22
    v_accvgpr_read_b32 v227, a23
    v_mul_f32 v224, v224, v53
    v_mul_f32 v225, v225, v53
    v_mul_f32 v226, v226, v53
    v_mul_f32 v227, v227, v53
    v_accvgpr_write_b32 a20, v224
    v_accvgpr_write_b32 a21, v225
    v_accvgpr_write_b32 a22, v226
    v_accvgpr_write_b32 a23, v227
    v_accvgpr_read_b32 v224, a24
    v_accvgpr_read_b32 v225, a25
    v_accvgpr_read_b32 v226, a26
    v_accvgpr_read_b32 v227, a27
    v_mul_f32 v224, v224, v54
    v_mul_f32 v225, v225, v54
    v_mul_f32 v226, v226, v54
    v_mul_f32 v227, v227, v54
    v_accvgpr_write_b32 a24, v224
    v_accvgpr_write_b32 a25, v225
    v_accvgpr_write_b32 a26, v226
    v_accvgpr_write_b32 a27, v227
    v_accvgpr_read_b32 v224, a28
    v_accvgpr_read_b32 v225, a29
    v_accvgpr_read_b32 v226, a30
    v_accvgpr_read_b32 v227, a31
    v_mul_f32 v224, v224, v55
    v_mul_f32 v225, v225, v55
    v_mul_f32 v226, v226, v55
    v_mul_f32 v227, v227, v55
    v_accvgpr_write_b32 a28, v224
    v_accvgpr_write_b32 a29, v225
    v_accvgpr_write_b32 a30, v226
    v_accvgpr_write_b32 a31, v227
    v_accvgpr_read_b32 v224, a32
    v_accvgpr_read_b32 v225, a33
    v_accvgpr_read_b32 v226, a34
    v_accvgpr_read_b32 v227, a35
    v_mul_f32 v224, v224, v52
    v_mul_f32 v225, v225, v52
    v_mul_f32 v226, v226, v52
    v_mul_f32 v227, v227, v52
    v_accvgpr_write_b32 a32, v224
    v_accvgpr_write_b32 a33, v225
    v_accvgpr_write_b32 a34, v226
    v_accvgpr_write_b32 a35, v227
    v_accvgpr_read_b32 v224, a36
    v_accvgpr_read_b32 v225, a37
    v_accvgpr_read_b32 v226, a38
    v_accvgpr_read_b32 v227, a39
    v_mul_f32 v224, v224, v53
    v_mul_f32 v225, v225, v53
    v_mul_f32 v226, v226, v53
    v_mul_f32 v227, v227, v53
    v_accvgpr_write_b32 a36, v224
    v_accvgpr_write_b32 a37, v225
    v_accvgpr_write_b32 a38, v226
    v_accvgpr_write_b32 a39, v227
    v_accvgpr_read_b32 v224, a40
    v_accvgpr_read_b32 v225, a41
    v_accvgpr_read_b32 v226, a42
    v_accvgpr_read_b32 v227, a43
    v_mul_f32 v224, v224, v54
    v_mul_f32 v225, v225, v54
    v_mul_f32 v226, v226, v54
    v_mul_f32 v227, v227, v54
    v_accvgpr_write_b32 a40, v224
    v_accvgpr_write_b32 a41, v225
    v_accvgpr_write_b32 a42, v226
    v_accvgpr_write_b32 a43, v227
    v_accvgpr_read_b32 v224, a44
    v_accvgpr_read_b32 v225, a45
    v_accvgpr_read_b32 v226, a46
    v_accvgpr_read_b32 v227, a47
    v_mul_f32 v224, v224, v55
    v_mul_f32 v225, v225, v55
    v_mul_f32 v226, v226, v55
    v_mul_f32 v227, v227, v55
    v_accvgpr_write_b32 a44, v224
    v_accvgpr_write_b32 a45, v225
    v_accvgpr_write_b32 a46, v226
    v_accvgpr_write_b32 a47, v227
    v_accvgpr_read_b32 v224, a48
    v_accvgpr_read_b32 v225, a49
    v_accvgpr_read_b32 v226, a50
    v_accvgpr_read_b32 v227, a51
    v_mul_f32 v224, v224, v52
    v_mul_f32 v225, v225, v52
    v_mul_f32 v226, v226, v52
    v_mul_f32 v227, v227, v52
    v_accvgpr_write_b32 a48, v224
    v_accvgpr_write_b32 a49, v225
    v_accvgpr_write_b32 a50, v226
    v_accvgpr_write_b32 a51, v227
    v_accvgpr_read_b32 v224, a52
    v_accvgpr_read_b32 v225, a53
    v_accvgpr_read_b32 v226, a54
    v_accvgpr_read_b32 v227, a55
    v_mul_f32 v224, v224, v53
    v_mul_f32 v225, v225, v53
    v_mul_f32 v226, v226, v53
    v_mul_f32 v227, v227, v53
    v_accvgpr_write_b32 a52, v224
    v_accvgpr_write_b32 a53, v225
    v_accvgpr_write_b32 a54, v226
    v_accvgpr_write_b32 a55, v227
    v_accvgpr_read_b32 v224, a56
    v_accvgpr_read_b32 v225, a57
    v_accvgpr_read_b32 v226, a58
    v_accvgpr_read_b32 v227, a59
    v_mul_f32 v224, v224, v54
    v_mul_f32 v225, v225, v54
    v_mul_f32 v226, v226, v54
    v_mul_f32 v227, v227, v54
    v_accvgpr_write_b32 a56, v224
    v_accvgpr_write_b32 a57, v225
    v_accvgpr_write_b32 a58, v226
    v_accvgpr_write_b32 a59, v227
    v_accvgpr_read_b32 v224, a60
    v_accvgpr_read_b32 v225, a61
    v_accvgpr_read_b32 v226, a62
    v_accvgpr_read_b32 v227, a63
    v_mul_f32 v224, v224, v55
    v_mul_f32 v225, v225, v55
    v_mul_f32 v226, v226, v55
    v_mul_f32 v227, v227, v55
    v_accvgpr_write_b32 a60, v224
    v_accvgpr_write_b32 a61, v225
    v_accvgpr_write_b32 a62, v226
    v_accvgpr_write_b32 a63, v227
    v_accvgpr_read_b32 v224, a64
    v_accvgpr_read_b32 v225, a65
    v_accvgpr_read_b32 v226, a66
    v_accvgpr_read_b32 v227, a67
    v_mul_f32 v224, v224, v52
    v_mul_f32 v225, v225, v52
    v_mul_f32 v226, v226, v52
    v_mul_f32 v227, v227, v52
    v_accvgpr_write_b32 a64, v224
    v_accvgpr_write_b32 a65, v225
    v_accvgpr_write_b32 a66, v226
    v_accvgpr_write_b32 a67, v227
    v_accvgpr_read_b32 v224, a68
    v_accvgpr_read_b32 v225, a69
    v_accvgpr_read_b32 v226, a70
    v_accvgpr_read_b32 v227, a71
    v_mul_f32 v224, v224, v53
    v_mul_f32 v225, v225, v53
    v_mul_f32 v226, v226, v53
    v_mul_f32 v227, v227, v53
    v_accvgpr_write_b32 a68, v224
    v_accvgpr_write_b32 a69, v225
    v_accvgpr_write_b32 a70, v226
    v_accvgpr_write_b32 a71, v227
    v_accvgpr_read_b32 v224, a72
    v_accvgpr_read_b32 v225, a73
    v_accvgpr_read_b32 v226, a74
    v_accvgpr_read_b32 v227, a75
    v_mul_f32 v224, v224, v54
    v_mul_f32 v225, v225, v54
    v_mul_f32 v226, v226, v54
    v_mul_f32 v227, v227, v54
    v_accvgpr_write_b32 a72, v224
    v_accvgpr_write_b32 a73, v225
    v_accvgpr_write_b32 a74, v226
    v_accvgpr_write_b32 a75, v227
    v_accvgpr_read_b32 v224, a76
    v_accvgpr_read_b32 v225, a77
    v_accvgpr_read_b32 v226, a78
    v_accvgpr_read_b32 v227, a79
    v_mul_f32 v224, v224, v55
    v_mul_f32 v225, v225, v55
    v_mul_f32 v226, v226, v55
    v_mul_f32 v227, v227, v55
    v_accvgpr_write_b32 a76, v224
    v_accvgpr_write_b32 a77, v225
    v_accvgpr_write_b32 a78, v226
    v_accvgpr_write_b32 a79, v227
    v_accvgpr_read_b32 v224, a80
    v_accvgpr_read_b32 v225, a81
    v_accvgpr_read_b32 v226, a82
    v_accvgpr_read_b32 v227, a83
    v_mul_f32 v224, v224, v52
    v_mul_f32 v225, v225, v52
    v_mul_f32 v226, v226, v52
    v_mul_f32 v227, v227, v52
    v_accvgpr_write_b32 a80, v224
    v_accvgpr_write_b32 a81, v225
    v_accvgpr_write_b32 a82, v226
    v_accvgpr_write_b32 a83, v227
    v_accvgpr_read_b32 v224, a84
    v_accvgpr_read_b32 v225, a85
    v_accvgpr_read_b32 v226, a86
    v_accvgpr_read_b32 v227, a87
    v_mul_f32 v224, v224, v53
    v_mul_f32 v225, v225, v53
    v_mul_f32 v226, v226, v53
    v_mul_f32 v227, v227, v53
    v_accvgpr_write_b32 a84, v224
    v_accvgpr_write_b32 a85, v225
    v_accvgpr_write_b32 a86, v226
    v_accvgpr_write_b32 a87, v227
    v_accvgpr_read_b32 v224, a88
    v_accvgpr_read_b32 v225, a89
    v_accvgpr_read_b32 v226, a90
    v_accvgpr_read_b32 v227, a91
    v_mul_f32 v224, v224, v54
    v_mul_f32 v225, v225, v54
    v_mul_f32 v226, v226, v54
    v_mul_f32 v227, v227, v54
    v_accvgpr_write_b32 a88, v224
    v_accvgpr_write_b32 a89, v225
    v_accvgpr_write_b32 a90, v226
    v_accvgpr_write_b32 a91, v227
    v_accvgpr_read_b32 v224, a92
    v_accvgpr_read_b32 v225, a93
    v_accvgpr_read_b32 v226, a94
    v_accvgpr_read_b32 v227, a95
    v_mul_f32 v224, v224, v55
    v_mul_f32 v225, v225, v55
    v_mul_f32 v226, v226, v55
    v_mul_f32 v227, v227, v55
    v_accvgpr_write_b32 a92, v224
    v_accvgpr_write_b32 a93, v225
    v_accvgpr_write_b32 a94, v226
    v_accvgpr_write_b32 a95, v227
    v_accvgpr_read_b32 v224, a96
    v_accvgpr_read_b32 v225, a97
    v_accvgpr_read_b32 v226, a98
    v_accvgpr_read_b32 v227, a99
    v_mul_f32 v224, v224, v52
    v_mul_f32 v225, v225, v52
    v_mul_f32 v226, v226, v52
    v_mul_f32 v227, v227, v52
    v_accvgpr_write_b32 a96, v224
    v_accvgpr_write_b32 a97, v225
    v_accvgpr_write_b32 a98, v226
    v_accvgpr_write_b32 a99, v227
    v_accvgpr_read_b32 v224, a100
    v_accvgpr_read_b32 v225, a101
    v_accvgpr_read_b32 v226, a102
    v_accvgpr_read_b32 v227, a103
    v_mul_f32 v224, v224, v53
    v_mul_f32 v225, v225, v53
    v_mul_f32 v226, v226, v53
    v_mul_f32 v227, v227, v53
    v_accvgpr_write_b32 a100, v224
    v_accvgpr_write_b32 a101, v225
    v_accvgpr_write_b32 a102, v226
    v_accvgpr_write_b32 a103, v227
    v_accvgpr_read_b32 v224, a104
    v_accvgpr_read_b32 v225, a105
    v_accvgpr_read_b32 v226, a106
    v_accvgpr_read_b32 v227, a107
    v_mul_f32 v224, v224, v54
    v_mul_f32 v225, v225, v54
    v_mul_f32 v226, v226, v54
    v_mul_f32 v227, v227, v54
    v_accvgpr_write_b32 a104, v224
    v_accvgpr_write_b32 a105, v225
    v_accvgpr_write_b32 a106, v226
    v_accvgpr_write_b32 a107, v227
    v_accvgpr_read_b32 v224, a108
    v_accvgpr_read_b32 v225, a109
    v_accvgpr_read_b32 v226, a110
    v_accvgpr_read_b32 v227, a111
    v_mul_f32 v224, v224, v55
    v_mul_f32 v225, v225, v55
    v_mul_f32 v226, v226, v55
    v_mul_f32 v227, v227, v55
    v_accvgpr_write_b32 a108, v224
    v_accvgpr_write_b32 a109, v225
    v_accvgpr_write_b32 a110, v226
    v_accvgpr_write_b32 a111, v227
    v_accvgpr_read_b32 v224, a112
    v_accvgpr_read_b32 v225, a113
    v_accvgpr_read_b32 v226, a114
    v_accvgpr_read_b32 v227, a115
    v_mul_f32 v224, v224, v52
    v_mul_f32 v225, v225, v52
    v_mul_f32 v226, v226, v52
    v_mul_f32 v227, v227, v52
    v_accvgpr_write_b32 a112, v224
    v_accvgpr_write_b32 a113, v225
    v_accvgpr_write_b32 a114, v226
    v_accvgpr_write_b32 a115, v227
    v_accvgpr_read_b32 v224, a116
    v_accvgpr_read_b32 v225, a117
    v_accvgpr_read_b32 v226, a118
    v_accvgpr_read_b32 v227, a119
    v_mul_f32 v224, v224, v53
    v_mul_f32 v225, v225, v53
    v_mul_f32 v226, v226, v53
    v_mul_f32 v227, v227, v53
    v_accvgpr_write_b32 a116, v224
    v_accvgpr_write_b32 a117, v225
    v_accvgpr_write_b32 a118, v226
    v_accvgpr_write_b32 a119, v227
    v_accvgpr_read_b32 v224, a120
    v_accvgpr_read_b32 v225, a121
    v_accvgpr_read_b32 v226, a122
    v_accvgpr_read_b32 v227, a123
    v_mul_f32 v224, v224, v54
    v_mul_f32 v225, v225, v54
    v_mul_f32 v226, v226, v54
    v_mul_f32 v227, v227, v54
    v_accvgpr_write_b32 a120, v224
    v_accvgpr_write_b32 a121, v225
    v_accvgpr_write_b32 a122, v226
    v_accvgpr_write_b32 a123, v227
    v_accvgpr_read_b32 v224, a124
    v_accvgpr_read_b32 v225, a125
    v_accvgpr_read_b32 v226, a126
    v_accvgpr_read_b32 v227, a127
    v_mul_f32 v224, v224, v55
    v_mul_f32 v225, v225, v55
    v_mul_f32 v226, v226, v55
    v_mul_f32 v227, v227, v55
    v_accvgpr_write_b32 a124, v224
    v_accvgpr_write_b32 a125, v225
    v_accvgpr_write_b32 a126, v226
    v_accvgpr_write_b32 a127, v227
    v_exp_f32 v232, v160
    v_exp_f32 v233, v161
    v_exp_f32 v234, v162
    v_exp_f32 v235, v163
    s_nop 0
    v_cvt_pk_bf16_f32 v208, v232, v233
    v_cvt_pk_bf16_f32 v209, v234, v235
    v_exp_f32 v232, v176
    v_exp_f32 v233, v177
    v_exp_f32 v234, v178
    v_exp_f32 v235, v179
    s_nop 0
    v_cvt_pk_bf16_f32 v210, v232, v233
    v_cvt_pk_bf16_f32 v211, v234, v235
    v_exp_f32 v232, v164
    v_exp_f32 v233, v165
    v_exp_f32 v234, v166
    v_exp_f32 v235, v167
    s_nop 0
    v_cvt_pk_bf16_f32 v212, v232, v233
    v_cvt_pk_bf16_f32 v213, v234, v235
    v_exp_f32 v232, v180
    v_exp_f32 v233, v181
    v_exp_f32 v234, v182
    v_exp_f32 v235, v183
    s_nop 0
    v_cvt_pk_bf16_f32 v214, v232, v233
    v_cvt_pk_bf16_f32 v215, v234, v235
    v_exp_f32 v232, v168
    v_exp_f32 v233, v169
    v_exp_f32 v234, v170
    v_exp_f32 v235, v171
    s_nop 0
    v_cvt_pk_bf16_f32 v216, v232, v233
    v_cvt_pk_bf16_f32 v217, v234, v235
    v_exp_f32 v232, v184
    v_exp_f32 v233, v185
    v_exp_f32 v234, v186
    v_exp_f32 v235, v187
    s_nop 0
    v_cvt_pk_bf16_f32 v218, v232, v233
    v_cvt_pk_bf16_f32 v219, v234, v235
    v_exp_f32 v232, v172
    v_exp_f32 v233, v173
    v_exp_f32 v234, v174
    v_exp_f32 v235, v175
    s_nop 0
    v_cvt_pk_bf16_f32 v220, v232, v233
    v_cvt_pk_bf16_f32 v221, v234, v235
    v_exp_f32 v232, v188
    v_exp_f32 v233, v189
    v_exp_f32 v234, v190
    v_exp_f32 v235, v191
    s_nop 0
    v_cvt_pk_bf16_f32 v222, v232, v233
    v_cvt_pk_bf16_f32 v223, v234, v235
    s_nop 3
    s_setpc_b64 s[40:41]
k2_rare_164:
    s_nop 7
    v_max_f32 v53, v132, v133
    v_max3_f32 v53, v53, v134, v135
    v_max3_f32 v53, v53, v148, v149
    v_max3_f32 v53, v53, v150, v151
    v_max_f32 v54, v136, v137
    v_max3_f32 v54, v54, v138, v139
    v_max3_f32 v54, v54, v152, v153
    v_max3_f32 v54, v54, v154, v155
    v_max_f32 v55, v140, v141
    v_max3_f32 v55, v55, v142, v143
    v_max3_f32 v55, v55, v156, v157
    v_max3_f32 v55, v55, v158, v159
    v_mov_b32 v225, v53
    v_mov_b32 v226, v54
    v_mov_b32 v227, v55
    s_nop 1
    v_permlane16_swap_b32 v53, v225
    v_permlane16_swap_b32 v54, v226
    v_permlane16_swap_b32 v55, v227
    s_nop 1
    v_max_f32 v53, v53, v225
    v_max_f32 v54, v54, v226
    v_max_f32 v55, v55, v227
    v_mov_b32 v225, v53
    v_mov_b32 v226, v54
    v_mov_b32 v227, v55
    s_nop 1
    v_permlane32_swap_b32 v53, v225
    v_permlane32_swap_b32 v54, v226
    v_permlane32_swap_b32 v55, v227
    s_nop 1
    v_max_f32 v53, v53, v225
    v_max_f32 v54, v54, v226
    v_max_f32 v55, v55, v227
    v_add_f32 v53, 0x41400000, v53
    v_max_f32 v53, 0, v53
    v_add_f32 v54, 0x41400000, v54
    v_max_f32 v54, 0, v54
    v_add_f32 v55, 0x41400000, v55
    v_max_f32 v55, 0, v55
    v_sub_f32 v132, v132, v53
    v_sub_f32 v133, v133, v53
    v_sub_f32 v134, v134, v53
    v_sub_f32 v135, v135, v53
    v_sub_f32 v136, v136, v54
    v_sub_f32 v137, v137, v54
    v_sub_f32 v138, v138, v54
    v_sub_f32 v139, v139, v54
    v_sub_f32 v140, v140, v55
    v_sub_f32 v141, v141, v55
    v_sub_f32 v142, v142, v55
    v_sub_f32 v143, v143, v55
    v_sub_f32 v148, v148, v53
    v_sub_f32 v149, v149, v53
    v_sub_f32 v150, v150, v53
    v_sub_f32 v151, v151, v53
    v_sub_f32 v152, v152, v54
    v_sub_f32 v153, v153, v54
    v_sub_f32 v154, v154, v54
    v_sub_f32 v155, v155, v54
    v_sub_f32 v156, v156, v55
    v_sub_f32 v157, v157, v55
    v_sub_f32 v158, v158, v55
    v_sub_f32 v159, v159, v55
    v_sub_f32 v164, v164, v53
    v_sub_f32 v20, v20, v53
    v_sub_f32 v165, v165, v53
    v_sub_f32 v21, v21, v53
    v_sub_f32 v166, v166, v53
    v_sub_f32 v22, v22, v53
    v_sub_f32 v167, v167, v53
    v_sub_f32 v23, v23, v53
    v_sub_f32 v168, v168, v54
    v_sub_f32 v24, v24, v54
    v_sub_f32 v169, v169, v54
    v_sub_f32 v25, v25, v54
    v_sub_f32 v170, v170, v54
    v_sub_f32 v26, v26, v54
    v_sub_f32 v171, v171, v54
    v_sub_f32 v27, v27, v54
    v_sub_f32 v172, v172, v55
    v_sub_f32 v28, v28, v55
    v_sub_f32 v173, v173, v55
    v_sub_f32 v29, v29, v55
    v_sub_f32 v174, v174, v55
    v_sub_f32 v30, v30, v55
    v_sub_f32 v175, v175, v55
    v_sub_f32 v31, v31, v55
    v_sub_f32 v180, v180, v53
    v_sub_f32 v36, v36, v53
    v_sub_f32 v181, v181, v53
    v_sub_f32 v37, v37, v53
    v_sub_f32 v182, v182, v53
    v_sub_f32 v38, v38, v53
    v_sub_f32 v183, v183, v53
    v_sub_f32 v39, v39, v53
    v_sub_f32 v184, v184, v54
    v_sub_f32 v40, v40, v54
    v_sub_f32 v185, v185, v54
    v_sub_f32 v41, v41, v54
    v_sub_f32 v186, v186, v54
    v_sub_f32 v42, v42, v54
    v_sub_f32 v187, v187, v54
    v_sub_f32 v43, v43, v54
    v_sub_f32 v188, v188, v55
    v_sub_f32 v44, v44, v55
    v_sub_f32 v189, v189, v55
    v_sub_f32 v45, v45, v55
    v_sub_f32 v190, v190, v55
    v_sub_f32 v46, v46, v55
    v_sub_f32 v191, v191, v55
    v_sub_f32 v47, v47, v55
    v_sub_f32 v9, v9, v53
    v_exp_f32 v53, -v53
    v_sub_f32 v10, v10, v54
    v_exp_f32 v54, -v54
    v_sub_f32 v11, v11, v55
    v_exp_f32 v55, -v55
    s_nop 0
    v_mul_f32 v48, v48, v53
    v_mul_f32 v248, v248, v54
    v_mul_f32 v252, v252, v55
    v_accvgpr_read_b32 v224, a4
    v_accvgpr_read_b32 v225, a5
    v_accvgpr_read_b32 v226, a6
    v_accvgpr_read_b32 v227, a7
    v_mul_f32 v224, v224, v53
    v_mul_f32 v225, v225, v53
    v_mul_f32 v226, v226, v53
    v_mul_f32 v227, v227, v53
    v_accvgpr_write_b32 a4, v224
    v_accvgpr_write_b32 a5, v225
    v_accvgpr_write_b32 a6, v226
    v_accvgpr_write_b32 a7, v227
    v_accvgpr_read_b32 v224, a8
    v_accvgpr_read_b32 v225, a9
    v_accvgpr_read_b32 v226, a10
    v_accvgpr_read_b32 v227, a11
    v_mul_f32 v224, v224, v54
    v_mul_f32 v225, v225, v54
    v_mul_f32 v226, v226, v54
    v_mul_f32 v227, v227, v54
    v_accvgpr_write_b32 a8, v224
    v_accvgpr_write_b32 a9, v225
    v_accvgpr_write_b32 a10, v226
    v_accvgpr_write_b32 a11, v227
    v_accvgpr_read_b32 v224, a12
    v_accvgpr_read_b32 v225, a13
    v_accvgpr_read_b32 v226, a14
    v_accvgpr_read_b32 v227, a15
    v_mul_f32 v224, v224, v55
    v_mul_f32 v225, v225, v55
    v_mul_f32 v226, v226, v55
    v_mul_f32 v227, v227, v55
    v_accvgpr_write_b32 a12, v224
    v_accvgpr_write_b32 a13, v225
    v_accvgpr_write_b32 a14, v226
    v_accvgpr_write_b32 a15, v227
    v_accvgpr_read_b32 v224, a20
    v_accvgpr_read_b32 v225, a21
    v_accvgpr_read_b32 v226, a22
    v_accvgpr_read_b32 v227, a23
    v_mul_f32 v224, v224, v53
    v_mul_f32 v225, v225, v53
    v_mul_f32 v226, v226, v53
    v_mul_f32 v227, v227, v53
    v_accvgpr_write_b32 a20, v224
    v_accvgpr_write_b32 a21, v225
    v_accvgpr_write_b32 a22, v226
    v_accvgpr_write_b32 a23, v227
    v_accvgpr_read_b32 v224, a24
    v_accvgpr_read_b32 v225, a25
    v_accvgpr_read_b32 v226, a26
    v_accvgpr_read_b32 v227, a27
    v_mul_f32 v224, v224, v54
    v_mul_f32 v225, v225, v54
    v_mul_f32 v226, v226, v54
    v_mul_f32 v227, v227, v54
    v_accvgpr_write_b32 a24, v224
    v_accvgpr_write_b32 a25, v225
    v_accvgpr_write_b32 a26, v226
    v_accvgpr_write_b32 a27, v227
    v_accvgpr_read_b32 v224, a28
    v_accvgpr_read_b32 v225, a29
    v_accvgpr_read_b32 v226, a30
    v_accvgpr_read_b32 v227, a31
    v_mul_f32 v224, v224, v55
    v_mul_f32 v225, v225, v55
    v_mul_f32 v226, v226, v55
    v_mul_f32 v227, v227, v55
    v_accvgpr_write_b32 a28, v224
    v_accvgpr_write_b32 a29, v225
    v_accvgpr_write_b32 a30, v226
    v_accvgpr_write_b32 a31, v227
    v_accvgpr_read_b32 v224, a36
    v_accvgpr_read_b32 v225, a37
    v_accvgpr_read_b32 v226, a38
    v_accvgpr_read_b32 v227, a39
    v_mul_f32 v224, v224, v53
    v_mul_f32 v225, v225, v53
    v_mul_f32 v226, v226, v53
    v_mul_f32 v227, v227, v53
    v_accvgpr_write_b32 a36, v224
    v_accvgpr_write_b32 a37, v225
    v_accvgpr_write_b32 a38, v226
    v_accvgpr_write_b32 a39, v227
    v_accvgpr_read_b32 v224, a40
    v_accvgpr_read_b32 v225, a41
    v_accvgpr_read_b32 v226, a42
    v_accvgpr_read_b32 v227, a43
    v_mul_f32 v224, v224, v54
    v_mul_f32 v225, v225, v54
    v_mul_f32 v226, v226, v54
    v_mul_f32 v227, v227, v54
    v_accvgpr_write_b32 a40, v224
    v_accvgpr_write_b32 a41, v225
    v_accvgpr_write_b32 a42, v226
    v_accvgpr_write_b32 a43, v227
    v_accvgpr_read_b32 v224, a44
    v_accvgpr_read_b32 v225, a45
    v_accvgpr_read_b32 v226, a46
    v_accvgpr_read_b32 v227, a47
    v_mul_f32 v224, v224, v55
    v_mul_f32 v225, v225, v55
    v_mul_f32 v226, v226, v55
    v_mul_f32 v227, v227, v55
    v_accvgpr_write_b32 a44, v224
    v_accvgpr_write_b32 a45, v225
    v_accvgpr_write_b32 a46, v226
    v_accvgpr_write_b32 a47, v227
    v_accvgpr_read_b32 v224, a52
    v_accvgpr_read_b32 v225, a53
    v_accvgpr_read_b32 v226, a54
    v_accvgpr_read_b32 v227, a55
    v_mul_f32 v224, v224, v53
    v_mul_f32 v225, v225, v53
    v_mul_f32 v226, v226, v53
    v_mul_f32 v227, v227, v53
    v_accvgpr_write_b32 a52, v224
    v_accvgpr_write_b32 a53, v225
    v_accvgpr_write_b32 a54, v226
    v_accvgpr_write_b32 a55, v227
    v_accvgpr_read_b32 v224, a56
    v_accvgpr_read_b32 v225, a57
    v_accvgpr_read_b32 v226, a58
    v_accvgpr_read_b32 v227, a59
    v_mul_f32 v224, v224, v54
    v_mul_f32 v225, v225, v54
    v_mul_f32 v226, v226, v54
    v_mul_f32 v227, v227, v54
    v_accvgpr_write_b32 a56, v224
    v_accvgpr_write_b32 a57, v225
    v_accvgpr_write_b32 a58, v226
    v_accvgpr_write_b32 a59, v227
    v_accvgpr_read_b32 v224, a60
    v_accvgpr_read_b32 v225, a61
    v_accvgpr_read_b32 v226, a62
    v_accvgpr_read_b32 v227, a63
    v_mul_f32 v224, v224, v55
    v_mul_f32 v225, v225, v55
    v_mul_f32 v226, v226, v55
    v_mul_f32 v227, v227, v55
    v_accvgpr_write_b32 a60, v224
    v_accvgpr_write_b32 a61, v225
    v_accvgpr_write_b32 a62, v226
    v_accvgpr_write_b32 a63, v227
    v_accvgpr_read_b32 v224, a68
    v_accvgpr_read_b32 v225, a69
    v_accvgpr_read_b32 v226, a70
    v_accvgpr_read_b32 v227, a71
    v_mul_f32 v224, v224, v53
    v_mul_f32 v225, v225, v53
    v_mul_f32 v226, v226, v53
    v_mul_f32 v227, v227, v53
    v_accvgpr_write_b32 a68, v224
    v_accvgpr_write_b32 a69, v225
    v_accvgpr_write_b32 a70, v226
    v_accvgpr_write_b32 a71, v227
    v_accvgpr_read_b32 v224, a72
    v_accvgpr_read_b32 v225, a73
    v_accvgpr_read_b32 v226, a74
    v_accvgpr_read_b32 v227, a75
    v_mul_f32 v224, v224, v54
    v_mul_f32 v225, v225, v54
    v_mul_f32 v226, v226, v54
    v_mul_f32 v227, v227, v54
    v_accvgpr_write_b32 a72, v224
    v_accvgpr_write_b32 a73, v225
    v_accvgpr_write_b32 a74, v226
    v_accvgpr_write_b32 a75, v227
    v_accvgpr_read_b32 v224, a76
    v_accvgpr_read_b32 v225, a77
    v_accvgpr_read_b32 v226, a78
    v_accvgpr_read_b32 v227, a79
    v_mul_f32 v224, v224, v55
    v_mul_f32 v225, v225, v55
    v_mul_f32 v226, v226, v55
    v_mul_f32 v227, v227, v55
    v_accvgpr_write_b32 a76, v224
    v_accvgpr_write_b32 a77, v225
    v_accvgpr_write_b32 a78, v226
    v_accvgpr_write_b32 a79, v227
    v_accvgpr_read_b32 v224, a84
    v_accvgpr_read_b32 v225, a85
    v_accvgpr_read_b32 v226, a86
    v_accvgpr_read_b32 v227, a87
    v_mul_f32 v224, v224, v53
    v_mul_f32 v225, v225, v53
    v_mul_f32 v226, v226, v53
    v_mul_f32 v227, v227, v53
    v_accvgpr_write_b32 a84, v224
    v_accvgpr_write_b32 a85, v225
    v_accvgpr_write_b32 a86, v226
    v_accvgpr_write_b32 a87, v227
    v_accvgpr_read_b32 v224, a88
    v_accvgpr_read_b32 v225, a89
    v_accvgpr_read_b32 v226, a90
    v_accvgpr_read_b32 v227, a91
    v_mul_f32 v224, v224, v54
    v_mul_f32 v225, v225, v54
    v_mul_f32 v226, v226, v54
    v_mul_f32 v227, v227, v54
    v_accvgpr_write_b32 a88, v224
    v_accvgpr_write_b32 a89, v225
    v_accvgpr_write_b32 a90, v226
    v_accvgpr_write_b32 a91, v227
    v_accvgpr_read_b32 v224, a92
    v_accvgpr_read_b32 v225, a93
    v_accvgpr_read_b32 v226, a94
    v_accvgpr_read_b32 v227, a95
    v_mul_f32 v224, v224, v55
    v_mul_f32 v225, v225, v55
    v_mul_f32 v226, v226, v55
    v_mul_f32 v227, v227, v55
    v_accvgpr_write_b32 a92, v224
    v_accvgpr_write_b32 a93, v225
    v_accvgpr_write_b32 a94, v226
    v_accvgpr_write_b32 a95, v227
    v_accvgpr_read_b32 v224, a100
    v_accvgpr_read_b32 v225, a101
    v_accvgpr_read_b32 v226, a102
    v_accvgpr_read_b32 v227, a103
    v_mul_f32 v224, v224, v53
    v_mul_f32 v225, v225, v53
    v_mul_f32 v226, v226, v53
    v_mul_f32 v227, v227, v53
    v_accvgpr_write_b32 a100, v224
    v_accvgpr_write_b32 a101, v225
    v_accvgpr_write_b32 a102, v226
    v_accvgpr_write_b32 a103, v227
    v_accvgpr_read_b32 v224, a104
    v_accvgpr_read_b32 v225, a105
    v_accvgpr_read_b32 v226, a106
    v_accvgpr_read_b32 v227, a107
    v_mul_f32 v224, v224, v54
    v_mul_f32 v225, v225, v54
    v_mul_f32 v226, v226, v54
    v_mul_f32 v227, v227, v54
    v_accvgpr_write_b32 a104, v224
    v_accvgpr_write_b32 a105, v225
    v_accvgpr_write_b32 a106, v226
    v_accvgpr_write_b32 a107, v227
    v_accvgpr_read_b32 v224, a108
    v_accvgpr_read_b32 v225, a109
    v_accvgpr_read_b32 v226, a110
    v_accvgpr_read_b32 v227, a111
    v_mul_f32 v224, v224, v55
    v_mul_f32 v225, v225, v55
    v_mul_f32 v226, v226, v55
    v_mul_f32 v227, v227, v55
    v_accvgpr_write_b32 a108, v224
    v_accvgpr_write_b32 a109, v225
    v_accvgpr_write_b32 a110, v226
    v_accvgpr_write_b32 a111, v227
    v_accvgpr_read_b32 v224, a116
    v_accvgpr_read_b32 v225, a117
    v_accvgpr_read_b32 v226, a118
    v_accvgpr_read_b32 v227, a119
    v_mul_f32 v224, v224, v53
    v_mul_f32 v225, v225, v53
    v_mul_f32 v226, v226, v53
    v_mul_f32 v227, v227, v53
    v_accvgpr_write_b32 a116, v224
    v_accvgpr_write_b32 a117, v225
    v_accvgpr_write_b32 a118, v226
    v_accvgpr_write_b32 a119, v227
    v_accvgpr_read_b32 v224, a120
    v_accvgpr_read_b32 v225, a121
    v_accvgpr_read_b32 v226, a122
    v_accvgpr_read_b32 v227, a123
    v_mul_f32 v224, v224, v54
    v_mul_f32 v225, v225, v54
    v_mul_f32 v226, v226, v54
    v_mul_f32 v227, v227, v54
    v_accvgpr_write_b32 a120, v224
    v_accvgpr_write_b32 a121, v225
    v_accvgpr_write_b32 a122, v226
    v_accvgpr_write_b32 a123, v227
    v_accvgpr_read_b32 v224, a124
    v_accvgpr_read_b32 v225, a125
    v_accvgpr_read_b32 v226, a126
    v_accvgpr_read_b32 v227, a127
    v_mul_f32 v224, v224, v55
    v_mul_f32 v225, v225, v55
    v_mul_f32 v226, v226, v55
    v_mul_f32 v227, v227, v55
    v_accvgpr_write_b32 a124, v224
    v_accvgpr_write_b32 a125, v225
    v_accvgpr_write_b32 a126, v226
    v_accvgpr_write_b32 a127, v227
    v_exp_f32 v232, v132
    v_exp_f32 v233, v133
    v_exp_f32 v234, v134
    v_exp_f32 v235, v135
    s_nop 0
    v_cvt_pk_bf16_f32 v196, v232, v233
    v_cvt_pk_bf16_f32 v197, v234, v235
    v_exp_f32 v232, v148
    v_exp_f32 v233, v149
    v_exp_f32 v234, v150
    v_exp_f32 v235, v151
    s_nop 0
    v_cvt_pk_bf16_f32 v198, v232, v233
    v_cvt_pk_bf16_f32 v199, v234, v235
    v_exp_f32 v232, v136
    v_exp_f32 v233, v137
    v_exp_f32 v234, v138
    v_exp_f32 v235, v139
    s_nop 0
    v_cvt_pk_bf16_f32 v200, v232, v233
    v_cvt_pk_bf16_f32 v201, v234, v235
    v_exp_f32 v232, v152
    v_exp_f32 v233, v153
    v_exp_f32 v234, v154
    v_exp_f32 v235, v155
    s_nop 0
    v_cvt_pk_bf16_f32 v202, v232, v233
    v_cvt_pk_bf16_f32 v203, v234, v235
    v_exp_f32 v232, v140
    v_exp_f32 v233, v141
    v_exp_f32 v234, v142
    v_exp_f32 v235, v143
    s_nop 0
    v_cvt_pk_bf16_f32 v204, v232, v233
    v_cvt_pk_bf16_f32 v205, v234, v235
    v_exp_f32 v232, v156
    v_exp_f32 v233, v157
    v_exp_f32 v234, v158
    v_exp_f32 v235, v159
    s_nop 0
    v_cvt_pk_bf16_f32 v206, v232, v233
    v_cvt_pk_bf16_f32 v207, v234, v235
    s_nop 3
    s_setpc_b64 s[40:41]
k2_rare_165:
    s_nop 7
    v_max_f32 v53, v164, v165
    v_max3_f32 v53, v53, v166, v167
    v_max3_f32 v53, v53, v180, v181
    v_max3_f32 v53, v53, v182, v183
    v_max_f32 v54, v168, v169
    v_max3_f32 v54, v54, v170, v171
    v_max3_f32 v54, v54, v184, v185
    v_max3_f32 v54, v54, v186, v187
    v_max_f32 v55, v172, v173
    v_max3_f32 v55, v55, v174, v175
    v_max3_f32 v55, v55, v188, v189
    v_max3_f32 v55, v55, v190, v191
    v_mov_b32 v225, v53
    v_mov_b32 v226, v54
    v_mov_b32 v227, v55
    s_nop 1
    v_permlane16_swap_b32 v53, v225
    v_permlane16_swap_b32 v54, v226
    v_permlane16_swap_b32 v55, v227
    s_nop 1
    v_max_f32 v53, v53, v225
    v_max_f32 v54, v54, v226
    v_max_f32 v55, v55, v227
    v_mov_b32 v225, v53
    v_mov_b32 v226, v54
    v_mov_b32 v227, v55
    s_nop 1
    v_permlane32_swap_b32 v53, v225
    v_permlane32_swap_b32 v54, v226
    v_permlane32_swap_b32 v55, v227
    s_nop 1
    v_max_f32 v53, v53, v225
    v_max_f32 v54, v54, v226
    v_max_f32 v55, v55, v227
    v_add_f32 v53, 0x41400000, v53
    v_max_f32 v53, 0, v53
    v_add_f32 v54, 0x41400000, v54
    v_max_f32 v54, 0, v54
    v_add_f32 v55, 0x41400000, v55
    v_max_f32 v55, 0, v55
    v_sub_f32 v164, v164, v53
    v_sub_f32 v165, v165, v53
    v_sub_f32 v166, v166, v53
    v_sub_f32 v167, v167, v53
    v_sub_f32 v168, v168, v54
    v_sub_f32 v169, v169, v54
    v_sub_f32 v170, v170, v54
    v_sub_f32 v171, v171, v54
    v_sub_f32 v172, v172, v55
    v_sub_f32 v173, v173, v55
    v_sub_f32 v174, v174, v55
    v_sub_f32 v175, v175, v55
    v_sub_f32 v180, v180, v53
    v_sub_f32 v181, v181, v53
    v_sub_f32 v182, v182, v53
    v_sub_f32 v183, v183, v53
    v_sub_f32 v184, v184, v54
    v_sub_f32 v185, v185, v54
    v_sub_f32 v186, v186, v54
    v_sub_f32 v187, v187, v54
    v_sub_f32 v188, v188, v55
    v_sub_f32 v189, v189, v55
    v_sub_f32 v190, v190, v55
    v_sub_f32 v191, v191, v55
    v_sub_f32 v128, v128, v54
    v_sub_f32 v16, v16, v54
    v_sub_f32 v129, v129, v54
    v_sub_f32 v17, v17, v54
    v_sub_f32 v130, v130, v54
    v_sub_f32 v18, v18, v54
    v_sub_f32 v131, v131, v54
    v_sub_f32 v19, v19, v54
    v_sub_f32 v132, v132, v55
    v_sub_f32 v20, v20, v55
    v_sub_f32 v133, v133, v55
    v_sub_f32 v21, v21, v55
    v_sub_f32 v134, v134, v55
    v_sub_f32 v22, v22, v55
    v_sub_f32 v135, v135, v55
    v_sub_f32 v23, v23, v55
    v_sub_f32 v136, v136, v54
    v_sub_f32 v24, v24, v54
    v_sub_f32 v137, v137, v54
    v_sub_f32 v25, v25, v54
    v_sub_f32 v138, v138, v54
    v_sub_f32 v26, v26, v54
    v_sub_f32 v139, v139, v54
    v_sub_f32 v27, v27, v54
    v_sub_f32 v140, v140, v55
    v_sub_f32 v28, v28, v55
    v_sub_f32 v141, v141, v55
    v_sub_f32 v29, v29, v55
    v_sub_f32 v142, v142, v55
    v_sub_f32 v30, v30, v55
    v_sub_f32 v143, v143, v55
    v_sub_f32 v31, v31, v55
    v_sub_f32 v144, v144, v54
    v_sub_f32 v32, v32, v54
    v_sub_f32 v145, v145, v54
    v_sub_f32 v33, v33, v54
    v_sub_f32 v146, v146, v54
    v_sub_f32 v34, v34, v54
    v_sub_f32 v147, v147, v54
    v_sub_f32 v35, v35, v54
    v_sub_f32 v148, v148, v55
    v_sub_f32 v36, v36, v55
    v_sub_f32 v149, v149, v55
    v_sub_f32 v37, v37, v55
    v_sub_f32 v150, v150, v55
    v_sub_f32 v38, v38, v55
    v_sub_f32 v151, v151, v55
    v_sub_f32 v39, v39, v55
    v_sub_f32 v152, v152, v54
    v_sub_f32 v40, v40, v54
    v_sub_f32 v153, v153, v54
    v_sub_f32 v41, v41, v54
    v_sub_f32 v154, v154, v54
    v_sub_f32 v42, v42, v54
    v_sub_f32 v155, v155, v54
    v_sub_f32 v43, v43, v54
    v_sub_f32 v156, v156, v55
    v_sub_f32 v44, v44, v55
    v_sub_f32 v157, v157, v55
    v_sub_f32 v45, v45, v55
    v_sub_f32 v158, v158, v55
    v_sub_f32 v46, v46, v55
    v_sub_f32 v159, v159, v55
    v_sub_f32 v47, v47, v55
    v_sub_f32 v9, v9, v53
    v_exp_f32 v53, -v53
    v_sub_f32 v10, v10, v54
    v_exp_f32 v54, -v54
    v_sub_f32 v11, v11, v55
    v_exp_f32 v55, -v55
    s_nop 0
    v_mul_f32 v48, v48, v53
    v_mul_f32 v248, v248, v54
    v_mul_f32 v252, v252, v55
    v_accvgpr_read_b32 v224, a4
    v_accvgpr_read_b32 v225, a5
    v_accvgpr_read_b32 v226, a6
    v_accvgpr_read_b32 v227, a7
    v_mul_f32 v224, v224, v53
    v_mul_f32 v225, v225, v53
    v_mul_f32 v226, v226, v53
    v_mul_f32 v227, v227, v53
    v_accvgpr_write_b32 a4, v224
    v_accvgpr_write_b32 a5, v225
    v_accvgpr_write_b32 a6, v226
    v_accvgpr_write_b32 a7, v227
    v_accvgpr_read_b32 v224, a8
    v_accvgpr_read_b32 v225, a9
    v_accvgpr_read_b32 v226, a10
    v_accvgpr_read_b32 v227, a11
    v_mul_f32 v224, v224, v54
    v_mul_f32 v225, v225, v54
    v_mul_f32 v226, v226, v54
    v_mul_f32 v227, v227, v54
    v_accvgpr_write_b32 a8, v224
    v_accvgpr_write_b32 a9, v225
    v_accvgpr_write_b32 a10, v226
    v_accvgpr_write_b32 a11, v227
    v_accvgpr_read_b32 v224, a12
    v_accvgpr_read_b32 v225, a13
    v_accvgpr_read_b32 v226, a14
    v_accvgpr_read_b32 v227, a15
    v_mul_f32 v224, v224, v55
    v_mul_f32 v225, v225, v55
    v_mul_f32 v226, v226, v55
    v_mul_f32 v227, v227, v55
    v_accvgpr_write_b32 a12, v224
    v_accvgpr_write_b32 a13, v225
    v_accvgpr_write_b32 a14, v226
    v_accvgpr_write_b32 a15, v227
    v_accvgpr_read_b32 v224, a20
    v_accvgpr_read_b32 v225, a21
    v_accvgpr_read_b32 v226, a22
    v_accvgpr_read_b32 v227, a23
    v_mul_f32 v224, v224, v53
    v_mul_f32 v225, v225, v53
    v_mul_f32 v226, v226, v53
    v_mul_f32 v227, v227, v53
    v_accvgpr_write_b32 a20, v224
    v_accvgpr_write_b32 a21, v225
    v_accvgpr_write_b32 a22, v226
    v_accvgpr_write_b32 a23, v227
    v_accvgpr_read_b32 v224, a24
    v_accvgpr_read_b32 v225, a25
    v_accvgpr_read_b32 v226, a26
    v_accvgpr_read_b32 v227, a27
    v_mul_f32 v224, v224, v54
    v_mul_f32 v225, v225, v54
    v_mul_f32 v226, v226, v54
    v_mul_f32 v227, v227, v54
    v_accvgpr_write_b32 a24, v224
    v_accvgpr_write_b32 a25, v225
    v_accvgpr_write_b32 a26, v226
    v_accvgpr_write_b32 a27, v227
    v_accvgpr_read_b32 v224, a28
    v_accvgpr_read_b32 v225, a29
    v_accvgpr_read_b32 v226, a30
    v_accvgpr_read_b32 v227, a31
    v_mul_f32 v224, v224, v55
    v_mul_f32 v225, v225, v55
    v_mul_f32 v226, v226, v55
    v_mul_f32 v227, v227, v55
    v_accvgpr_write_b32 a28, v224
    v_accvgpr_write_b32 a29, v225
    v_accvgpr_write_b32 a30, v226
    v_accvgpr_write_b32 a31, v227
    v_accvgpr_read_b32 v224, a36
    v_accvgpr_read_b32 v225, a37
    v_accvgpr_read_b32 v226, a38
    v_accvgpr_read_b32 v227, a39
    v_mul_f32 v224, v224, v53
    v_mul_f32 v225, v225, v53
    v_mul_f32 v226, v226, v53
    v_mul_f32 v227, v227, v53
    v_accvgpr_write_b32 a36, v224
    v_accvgpr_write_b32 a37, v225
    v_accvgpr_write_b32 a38, v226
    v_accvgpr_write_b32 a39, v227
    v_accvgpr_read_b32 v224, a40
    v_accvgpr_read_b32 v225, a41
    v_accvgpr_read_b32 v226, a42
    v_accvgpr_read_b32 v227, a43
    v_mul_f32 v224, v224, v54
    v_mul_f32 v225, v225, v54
    v_mul_f32 v226, v226, v54
    v_mul_f32 v227, v227, v54
    v_accvgpr_write_b32 a40, v224
    v_accvgpr_write_b32 a41, v225
    v_accvgpr_write_b32 a42, v226
    v_accvgpr_write_b32 a43, v227
    v_accvgpr_read_b32 v224, a44
    v_accvgpr_read_b32 v225, a45
    v_accvgpr_read_b32 v226, a46
    v_accvgpr_read_b32 v227, a47
    v_mul_f32 v224, v224, v55
    v_mul_f32 v225, v225, v55
    v_mul_f32 v226, v226, v55
    v_mul_f32 v227, v227, v55
    v_accvgpr_write_b32 a44, v224
    v_accvgpr_write_b32 a45, v225
    v_accvgpr_write_b32 a46, v226
    v_accvgpr_write_b32 a47, v227
    v_accvgpr_read_b32 v224, a52
    v_accvgpr_read_b32 v225, a53
    v_accvgpr_read_b32 v226, a54
    v_accvgpr_read_b32 v227, a55
    v_mul_f32 v224, v224, v53
    v_mul_f32 v225, v225, v53
    v_mul_f32 v226, v226, v53
    v_mul_f32 v227, v227, v53
    v_accvgpr_write_b32 a52, v224
    v_accvgpr_write_b32 a53, v225
    v_accvgpr_write_b32 a54, v226
    v_accvgpr_write_b32 a55, v227
    v_accvgpr_read_b32 v224, a56
    v_accvgpr_read_b32 v225, a57
    v_accvgpr_read_b32 v226, a58
    v_accvgpr_read_b32 v227, a59
    v_mul_f32 v224, v224, v54
    v_mul_f32 v225, v225, v54
    v_mul_f32 v226, v226, v54
    v_mul_f32 v227, v227, v54
    v_accvgpr_write_b32 a56, v224
    v_accvgpr_write_b32 a57, v225
    v_accvgpr_write_b32 a58, v226
    v_accvgpr_write_b32 a59, v227
    v_accvgpr_read_b32 v224, a60
    v_accvgpr_read_b32 v225, a61
    v_accvgpr_read_b32 v226, a62
    v_accvgpr_read_b32 v227, a63
    v_mul_f32 v224, v224, v55
    v_mul_f32 v225, v225, v55
    v_mul_f32 v226, v226, v55
    v_mul_f32 v227, v227, v55
    v_accvgpr_write_b32 a60, v224
    v_accvgpr_write_b32 a61, v225
    v_accvgpr_write_b32 a62, v226
    v_accvgpr_write_b32 a63, v227
    v_accvgpr_read_b32 v224, a68
    v_accvgpr_read_b32 v225, a69
    v_accvgpr_read_b32 v226, a70
    v_accvgpr_read_b32 v227, a71
    v_mul_f32 v224, v224, v53
    v_mul_f32 v225, v225, v53
    v_mul_f32 v226, v226, v53
    v_mul_f32 v227, v227, v53
    v_accvgpr_write_b32 a68, v224
    v_accvgpr_write_b32 a69, v225
    v_accvgpr_write_b32 a70, v226
    v_accvgpr_write_b32 a71, v227
    v_accvgpr_read_b32 v224, a72
    v_accvgpr_read_b32 v225, a73
    v_accvgpr_read_b32 v226, a74
    v_accvgpr_read_b32 v227, a75
    v_mul_f32 v224, v224, v54
    v_mul_f32 v225, v225, v54
    v_mul_f32 v226, v226, v54
    v_mul_f32 v227, v227, v54
    v_accvgpr_write_b32 a72, v224
    v_accvgpr_write_b32 a73, v225
    v_accvgpr_write_b32 a74, v226
    v_accvgpr_write_b32 a75, v227
    v_accvgpr_read_b32 v224, a76
    v_accvgpr_read_b32 v225, a77
    v_accvgpr_read_b32 v226, a78
    v_accvgpr_read_b32 v227, a79
    v_mul_f32 v224, v224, v55
    v_mul_f32 v225, v225, v55
    v_mul_f32 v226, v226, v55
    v_mul_f32 v227, v227, v55
    v_accvgpr_write_b32 a76, v224
    v_accvgpr_write_b32 a77, v225
    v_accvgpr_write_b32 a78, v226
    v_accvgpr_write_b32 a79, v227
    v_accvgpr_read_b32 v224, a84
    v_accvgpr_read_b32 v225, a85
    v_accvgpr_read_b32 v226, a86
    v_accvgpr_read_b32 v227, a87
    v_mul_f32 v224, v224, v53
    v_mul_f32 v225, v225, v53
    v_mul_f32 v226, v226, v53
    v_mul_f32 v227, v227, v53
    v_accvgpr_write_b32 a84, v224
    v_accvgpr_write_b32 a85, v225
    v_accvgpr_write_b32 a86, v226
    v_accvgpr_write_b32 a87, v227
    v_accvgpr_read_b32 v224, a88
    v_accvgpr_read_b32 v225, a89
    v_accvgpr_read_b32 v226, a90
    v_accvgpr_read_b32 v227, a91
    v_mul_f32 v224, v224, v54
    v_mul_f32 v225, v225, v54
    v_mul_f32 v226, v226, v54
    v_mul_f32 v227, v227, v54
    v_accvgpr_write_b32 a88, v224
    v_accvgpr_write_b32 a89, v225
    v_accvgpr_write_b32 a90, v226
    v_accvgpr_write_b32 a91, v227
    v_accvgpr_read_b32 v224, a92
    v_accvgpr_read_b32 v225, a93
    v_accvgpr_read_b32 v226, a94
    v_accvgpr_read_b32 v227, a95
    v_mul_f32 v224, v224, v55
    v_mul_f32 v225, v225, v55
    v_mul_f32 v226, v226, v55
    v_mul_f32 v227, v227, v55
    v_accvgpr_write_b32 a92, v224
    v_accvgpr_write_b32 a93, v225
    v_accvgpr_write_b32 a94, v226
    v_accvgpr_write_b32 a95, v227
    v_accvgpr_read_b32 v224, a100
    v_accvgpr_read_b32 v225, a101
    v_accvgpr_read_b32 v226, a102
    v_accvgpr_read_b32 v227, a103
    v_mul_f32 v224, v224, v53
    v_mul_f32 v225, v225, v53
    v_mul_f32 v226, v226, v53
    v_mul_f32 v227, v227, v53
    v_accvgpr_write_b32 a100, v224
    v_accvgpr_write_b32 a101, v225
    v_accvgpr_write_b32 a102, v226
    v_accvgpr_write_b32 a103, v227
    v_accvgpr_read_b32 v224, a104
    v_accvgpr_read_b32 v225, a105
    v_accvgpr_read_b32 v226, a106
    v_accvgpr_read_b32 v227, a107
    v_mul_f32 v224, v224, v54
    v_mul_f32 v225, v225, v54
    v_mul_f32 v226, v226, v54
    v_mul_f32 v227, v227, v54
    v_accvgpr_write_b32 a104, v224
    v_accvgpr_write_b32 a105, v225
    v_accvgpr_write_b32 a106, v226
    v_accvgpr_write_b32 a107, v227
    v_accvgpr_read_b32 v224, a108
    v_accvgpr_read_b32 v225, a109
    v_accvgpr_read_b32 v226, a110
    v_accvgpr_read_b32 v227, a111
    v_mul_f32 v224, v224, v55
    v_mul_f32 v225, v225, v55
    v_mul_f32 v226, v226, v55
    v_mul_f32 v227, v227, v55
    v_accvgpr_write_b32 a108, v224
    v_accvgpr_write_b32 a109, v225
    v_accvgpr_write_b32 a110, v226
    v_accvgpr_write_b32 a111, v227
    v_accvgpr_read_b32 v224, a116
    v_accvgpr_read_b32 v225, a117
    v_accvgpr_read_b32 v226, a118
    v_accvgpr_read_b32 v227, a119
    v_mul_f32 v224, v224, v53
    v_mul_f32 v225, v225, v53
    v_mul_f32 v226, v226, v53
    v_mul_f32 v227, v227, v53
    v_accvgpr_write_b32 a116, v224
    v_accvgpr_write_b32 a117, v225
    v_accvgpr_write_b32 a118, v226
    v_accvgpr_write_b32 a119, v227
    v_accvgpr_read_b32 v224, a120
    v_accvgpr_read_b32 v225, a121
    v_accvgpr_read_b32 v226, a122
    v_accvgpr_read_b32 v227, a123
    v_mul_f32 v224, v224, v54
    v_mul_f32 v225, v225, v54
    v_mul_f32 v226, v226, v54
    v_mul_f32 v227, v227, v54
    v_accvgpr_write_b32 a120, v224
    v_accvgpr_write_b32 a121, v225
    v_accvgpr_write_b32 a122, v226
    v_accvgpr_write_b32 a123, v227
    v_accvgpr_read_b32 v224, a124
    v_accvgpr_read_b32 v225, a125
    v_accvgpr_read_b32 v226, a126
    v_accvgpr_read_b32 v227, a127
    v_mul_f32 v224, v224, v55
    v_mul_f32 v225, v225, v55
    v_mul_f32 v226, v226, v55
    v_mul_f32 v227, v227, v55
    v_accvgpr_write_b32 a124, v224
    v_accvgpr_write_b32 a125, v225
    v_accvgpr_write_b32 a126, v226
    v_accvgpr_write_b32 a127, v227
    v_exp_f32 v232, v164
    v_exp_f32 v233, v165
    v_exp_f32 v234, v166
    v_exp_f32 v235, v167
    s_nop 0
    v_cvt_pk_bf16_f32 v212, v232, v233
    v_cvt_pk_bf16_f32 v213, v234, v235
    v_exp_f32 v232, v180
    v_exp_f32 v233, v181
    v_exp_f32 v234, v182
    v_exp_f32 v235, v183
    s_nop 0
    v_cvt_pk_bf16_f32 v214, v232, v233
    v_cvt_pk_bf16_f32 v215, v234, v235
    v_exp_f32 v232, v168
    v_exp_f32 v233, v169
    v_exp_f32 v234, v170
    v_exp_f32 v235, v171
    s_nop 0
    v_cvt_pk_bf16_f32 v216, v232, v233
    v_cvt_pk_bf16_f32 v217, v234, v235
    v_exp_f32 v232, v184
    v_exp_f32 v233, v185
    v_exp_f32 v234, v186
    v_exp_f32 v235, v187
    s_nop 0
    v_cvt_pk_bf16_f32 v218, v232, v233
    v_cvt_pk_bf16_f32 v219, v234, v235
    v_exp_f32 v232, v172
    v_exp_f32 v233, v173
    v_exp_f32 v234, v174
    v_exp_f32 v235, v175
    s_nop 0
    v_cvt_pk_bf16_f32 v220, v232, v233
    v_cvt_pk_bf16_f32 v221, v234, v235
    v_exp_f32 v232, v188
    v_exp_f32 v233, v189
    v_exp_f32 v234, v190
    v_exp_f32 v235, v191
    s_nop 0
    v_cvt_pk_bf16_f32 v222, v232, v233
    v_cvt_pk_bf16_f32 v223, v234, v235
    s_nop 3
    s_setpc_b64 s[40:41]
k2_rare_166:
    s_nop 7
    v_max_f32 v54, v128, v129
    v_max3_f32 v54, v54, v130, v131
    v_max3_f32 v54, v54, v144, v145
    v_max3_f32 v54, v54, v146, v147
    v_max3_f32 v54, v54, v136, v137
    v_max3_f32 v54, v54, v138, v139
    v_max3_f32 v54, v54, v152, v153
    v_max3_f32 v54, v54, v154, v155
    v_max_f32 v55, v132, v133
    v_max3_f32 v55, v55, v134, v135
    v_max3_f32 v55, v55, v148, v149
    v_max3_f32 v55, v55, v150, v151
    v_max3_f32 v55, v55, v140, v141
    v_max3_f32 v55, v55, v142, v143
    v_max3_f32 v55, v55, v156, v157
    v_max3_f32 v55, v55, v158, v159
    v_mov_b32 v226, v54
    v_mov_b32 v227, v55
    s_nop 1
    v_permlane16_swap_b32 v54, v226
    v_permlane16_swap_b32 v55, v227
    s_nop 1
    v_max_f32 v54, v54, v226
    v_max_f32 v55, v55, v227
    v_mov_b32 v226, v54
    v_mov_b32 v227, v55
    s_nop 1
    v_permlane32_swap_b32 v54, v226
    v_permlane32_swap_b32 v55, v227
    s_nop 1
    v_max_f32 v54, v54, v226
    v_max_f32 v55, v55, v227
    v_add_f32 v54, 0x41400000, v54
    v_max_f32 v54, 0, v54
    v_add_f32 v55, 0x41400000, v55
    v_max_f32 v55, 0, v55
    v_sub_f32 v128, v128, v54
    v_sub_f32 v129, v129, v54
    v_sub_f32 v130, v130, v54
    v_sub_f32 v131, v131, v54
    v_sub_f32 v132, v132, v55
    v_sub_f32 v133, v133, v55
    v_sub_f32 v134, v134, v55
    v_sub_f32 v135, v135, v55
    v_sub_f32 v136, v136, v54
    v_sub_f32 v137, v137, v54
    v_sub_f32 v138, v138, v54
    v_sub_f32 v139, v139, v54
    v_sub_f32 v140, v140, v55
    v_sub_f32 v141, v141, v55
    v_sub_f32 v142, v142, v55
    v_sub_f32 v143, v143, v55
    v_sub_f32 v144, v144, v54
    v_sub_f32 v145, v145, v54
    v_sub_f32 v146, v146, v54
    v_sub_f32 v147, v147, v54
    v_sub_f32 v148, v148, v55
    v_sub_f32 v149, v149, v55
    v_sub_f32 v150, v150, v55
    v_sub_f32 v151, v151, v55
    v_sub_f32 v152, v152, v54
    v_sub_f32 v153, v153, v54
    v_sub_f32 v154, v154, v54
    v_sub_f32 v155, v155, v54
    v_sub_f32 v156, v156, v55
    v_sub_f32 v157, v157, v55
    v_sub_f32 v158, v158, v55
    v_sub_f32 v159, v159, v55
    v_sub_f32 v160, v160, v54
    v_sub_f32 v16, v16, v54
    v_sub_f32 v161, v161, v54
    v_sub_f32 v17, v17, v54
    v_sub_f32 v162, v162, v54
    v_sub_f32 v18, v18, v54
    v_sub_f32 v163, v163, v54
    v_sub_f32 v19, v19, v54
    v_sub_f32 v164, v164, v55
    v_sub_f32 v20, v20, v55
    v_sub_f32 v165, v165, v55
    v_sub_f32 v21, v21, v55
    v_sub_f32 v166, v166, v55
    v_sub_f32 v22, v22, v55
    v_sub_f32 v167, v167, v55
    v_sub_f32 v23, v23, v55
    v_sub_f32 v168, v168, v54
    v_sub_f32 v24, v24, v54
    v_sub_f32 v169, v169, v54
    v_sub_f32 v25, v25, v54
    v_sub_f32 v170, v170, v54
    v_sub_f32 v26, v26, v54
    v_sub_f32 v171, v171, v54
    v_sub_f32 v27, v27, v54
    v_sub_f32 v172, v172, v55
    v_sub_f32 v28, v28, v55
    v_sub_f32 v173, v173, v55
    v_sub_f32 v29, v29, v55
    v_sub_f32 v174, v174, v55
    v_sub_f32 v30, v30, v55
    v_sub_f32 v175, v175, v55
    v_sub_f32 v31, v31, v55
    v_sub_f32 v176, v176, v54
    v_sub_f32 v32, v32, v54
    v_sub_f32 v177, v177, v54
    v_sub_f32 v33, v33, v54
    v_sub_f32 v178, v178, v54
    v_sub_f32 v34, v34, v54
    v_sub_f32 v179, v179, v54
    v_sub_f32 v35, v35, v54
    v_sub_f32 v180, v180, v55
    v_sub_f32 v36, v36, v55
    v_sub_f32 v181, v181, v55
    v_sub_f32 v37, v37, v55
    v_sub_f32 v182, v182, v55
    v_sub_f32 v38, v38, v55
    v_sub_f32 v183, v183, v55
    v_sub_f32 v39, v39, v55
    v_sub_f32 v184, v184, v54
    v_sub_f32 v40, v40, v54
    v_sub_f32 v185, v185, v54
    v_sub_f32 v41, v41, v54
    v_sub_f32 v186, v186, v54
    v_sub_f32 v42, v42, v54
    v_sub_f32 v187, v187, v54
    v_sub_f32 v43, v43, v54
    v_sub_f32 v188, v188, v55
    v_sub_f32 v44, v44, v55
    v_sub_f32 v189, v189, v55
    v_sub_f32 v45, v45, v55
    v_sub_f32 v190, v190, v55
    v_sub_f32 v46, v46, v55
    v_sub_f32 v191, v191, v55
    v_sub_f32 v47, v47, v55
    v_sub_f32 v10, v10, v54
    v_exp_f32 v54, -v54
    v_sub_f32 v11, v11, v55
    v_exp_f32 v55, -v55
    s_nop 0
    v_mul_f32 v248, v248, v54
    v_mul_f32 v252, v252, v55
    v_accvgpr_read_b32 v224, a8
    v_accvgpr_read_b32 v225, a9
    v_accvgpr_read_b32 v226, a10
    v_accvgpr_read_b32 v227, a11
    v_mul_f32 v224, v224, v54
    v_mul_f32 v225, v225, v54
    v_mul_f32 v226, v226, v54
    v_mul_f32 v227, v227, v54
    v_accvgpr_write_b32 a8, v224
    v_accvgpr_write_b32 a9, v225
    v_accvgpr_write_b32 a10, v226
    v_accvgpr_write_b32 a11, v227
    v_accvgpr_read_b32 v224, a12
    v_accvgpr_read_b32 v225, a13
    v_accvgpr_read_b32 v226, a14
    v_accvgpr_read_b32 v227, a15
    v_mul_f32 v224, v224, v55
    v_mul_f32 v225, v225, v55
    v_mul_f32 v226, v226, v55
    v_mul_f32 v227, v227, v55
    v_accvgpr_write_b32 a12, v224
    v_accvgpr_write_b32 a13, v225
    v_accvgpr_write_b32 a14, v226
    v_accvgpr_write_b32 a15, v227
    v_accvgpr_read_b32 v224, a24
    v_accvgpr_read_b32 v225, a25
    v_accvgpr_read_b32 v226, a26
    v_accvgpr_read_b32 v227, a27
    v_mul_f32 v224, v224, v54
    v_mul_f32 v225, v225, v54
    v_mul_f32 v226, v226, v54
    v_mul_f32 v227, v227, v54
    v_accvgpr_write_b32 a24, v224
    v_accvgpr_write_b32 a25, v225
    v_accvgpr_write_b32 a26, v226
    v_accvgpr_write_b32 a27, v227
    v_accvgpr_read_b32 v224, a28
    v_accvgpr_read_b32 v225, a29
    v_accvgpr_read_b32 v226, a30
    v_accvgpr_read_b32 v227, a31
    v_mul_f32 v224, v224, v55
    v_mul_f32 v225, v225, v55
    v_mul_f32 v226, v226, v55
    v_mul_f32 v227, v227, v55
    v_accvgpr_write_b32 a28, v224
    v_accvgpr_write_b32 a29, v225
    v_accvgpr_write_b32 a30, v226
    v_accvgpr_write_b32 a31, v227
    v_accvgpr_read_b32 v224, a40
    v_accvgpr_read_b32 v225, a41
    v_accvgpr_read_b32 v226, a42
    v_accvgpr_read_b32 v227, a43
    v_mul_f32 v224, v224, v54
    v_mul_f32 v225, v225, v54
    v_mul_f32 v226, v226, v54
    v_mul_f32 v227, v227, v54
    v_accvgpr_write_b32 a40, v224
    v_accvgpr_write_b32 a41, v225
    v_accvgpr_write_b32 a42, v226
    v_accvgpr_write_b32 a43, v227
    v_accvgpr_read_b32 v224, a44
    v_accvgpr_read_b32 v225, a45
    v_accvgpr_read_b32 v226, a46
    v_accvgpr_read_b32 v227, a47
    v_mul_f32 v224, v224, v55
    v_mul_f32 v225, v225, v55
    v_mul_f32 v226, v226, v55
    v_mul_f32 v227, v227, v55
    v_accvgpr_write_b32 a44, v224
    v_accvgpr_write_b32 a45, v225
    v_accvgpr_write_b32 a46, v226
    v_accvgpr_write_b32 a47, v227
    v_accvgpr_read_b32 v224, a56
    v_accvgpr_read_b32 v225, a57
    v_accvgpr_read_b32 v226, a58
    v_accvgpr_read_b32 v227, a59
    v_mul_f32 v224, v224, v54
    v_mul_f32 v225, v225, v54
    v_mul_f32 v226, v226, v54
    v_mul_f32 v227, v227, v54
    v_accvgpr_write_b32 a56, v224
    v_accvgpr_write_b32 a57, v225
    v_accvgpr_write_b32 a58, v226
    v_accvgpr_write_b32 a59, v227
    v_accvgpr_read_b32 v224, a60
    v_accvgpr_read_b32 v225, a61
    v_accvgpr_read_b32 v226, a62
    v_accvgpr_read_b32 v227, a63
    v_mul_f32 v224, v224, v55
    v_mul_f32 v225, v225, v55
    v_mul_f32 v226, v226, v55
    v_mul_f32 v227, v227, v55
    v_accvgpr_write_b32 a60, v224
    v_accvgpr_write_b32 a61, v225
    v_accvgpr_write_b32 a62, v226
    v_accvgpr_write_b32 a63, v227
    v_accvgpr_read_b32 v224, a72
    v_accvgpr_read_b32 v225, a73
    v_accvgpr_read_b32 v226, a74
    v_accvgpr_read_b32 v227, a75
    v_mul_f32 v224, v224, v54
    v_mul_f32 v225, v225, v54
    v_mul_f32 v226, v226, v54
    v_mul_f32 v227, v227, v54
    v_accvgpr_write_b32 a72, v224
    v_accvgpr_write_b32 a73, v225
    v_accvgpr_write_b32 a74, v226
    v_accvgpr_write_b32 a75, v227
    v_accvgpr_read_b32 v224, a76
    v_accvgpr_read_b32 v225, a77
    v_accvgpr_read_b32 v226, a78
    v_accvgpr_read_b32 v227, a79
    v_mul_f32 v224, v224, v55
    v_mul_f32 v225, v225, v55
    v_mul_f32 v226, v226, v55
    v_mul_f32 v227, v227, v55
    v_accvgpr_write_b32 a76, v224
    v_accvgpr_write_b32 a77, v225
    v_accvgpr_write_b32 a78, v226
    v_accvgpr_write_b32 a79, v227
    v_accvgpr_read_b32 v224, a88
    v_accvgpr_read_b32 v225, a89
    v_accvgpr_read_b32 v226, a90
    v_accvgpr_read_b32 v227, a91
    v_mul_f32 v224, v224, v54
    v_mul_f32 v225, v225, v54
    v_mul_f32 v226, v226, v54
    v_mul_f32 v227, v227, v54
    v_accvgpr_write_b32 a88, v224
    v_accvgpr_write_b32 a89, v225
    v_accvgpr_write_b32 a90, v226
    v_accvgpr_write_b32 a91, v227
    v_accvgpr_read_b32 v224, a92
    v_accvgpr_read_b32 v225, a93
    v_accvgpr_read_b32 v226, a94
    v_accvgpr_read_b32 v227, a95
    v_mul_f32 v224, v224, v55
    v_mul_f32 v225, v225, v55
    v_mul_f32 v226, v226, v55
    v_mul_f32 v227, v227, v55
    v_accvgpr_write_b32 a92, v224
    v_accvgpr_write_b32 a93, v225
    v_accvgpr_write_b32 a94, v226
    v_accvgpr_write_b32 a95, v227
    v_accvgpr_read_b32 v224, a104
    v_accvgpr_read_b32 v225, a105
    v_accvgpr_read_b32 v226, a106
    v_accvgpr_read_b32 v227, a107
    v_mul_f32 v224, v224, v54
    v_mul_f32 v225, v225, v54
    v_mul_f32 v226, v226, v54
    v_mul_f32 v227, v227, v54
    v_accvgpr_write_b32 a104, v224
    v_accvgpr_write_b32 a105, v225
    v_accvgpr_write_b32 a106, v226
    v_accvgpr_write_b32 a107, v227
    v_accvgpr_read_b32 v224, a108
    v_accvgpr_read_b32 v225, a109
    v_accvgpr_read_b32 v226, a110
    v_accvgpr_read_b32 v227, a111
    v_mul_f32 v224, v224, v55
    v_mul_f32 v225, v225, v55
    v_mul_f32 v226, v226, v55
    v_mul_f32 v227, v227, v55
    v_accvgpr_write_b32 a108, v224
    v_accvgpr_write_b32 a109, v225
    v_accvgpr_write_b32 a110, v226
    v_accvgpr_write_b32 a111, v227
    v_accvgpr_read_b32 v224, a120
    v_accvgpr_read_b32 v225, a121
    v_accvgpr_read_b32 v226, a122
    v_accvgpr_read_b32 v227, a123
    v_mul_f32 v224, v224, v54
    v_mul_f32 v225, v225, v54
    v_mul_f32 v226, v226, v54
    v_mul_f32 v227, v227, v54
    v_accvgpr_write_b32 a120, v224
    v_accvgpr_write_b32 a121, v225
    v_accvgpr_write_b32 a122, v226
    v_accvgpr_write_b32 a123, v227
    v_accvgpr_read_b32 v224, a124
    v_accvgpr_read_b32 v225, a125
    v_accvgpr_read_b32 v226, a126
    v_accvgpr_read_b32 v227, a127
    v_mul_f32 v224, v224, v55
    v_mul_f32 v225, v225, v55
    v_mul_f32 v226, v226, v55
    v_mul_f32 v227, v227, v55
    v_accvgpr_write_b32 a124, v224
    v_accvgpr_write_b32 a125, v225
    v_accvgpr_write_b32 a126, v226
    v_accvgpr_write_b32 a127, v227
    v_exp_f32 v232, v128
    v_exp_f32 v233, v129
    v_exp_f32 v234, v130
    v_exp_f32 v235, v131
    s_nop 0
    v_cvt_pk_bf16_f32 v192, v232, v233
    v_cvt_pk_bf16_f32 v193, v234, v235
    v_exp_f32 v232, v144
    v_exp_f32 v233, v145
    v_exp_f32 v234, v146
    v_exp_f32 v235, v147
    s_nop 0
    v_cvt_pk_bf16_f32 v194, v232, v233
    v_cvt_pk_bf16_f32 v195, v234, v235
    v_exp_f32 v232, v132
    v_exp_f32 v233, v133
    v_exp_f32 v234, v134
    v_exp_f32 v235, v135
    s_nop 0
    v_cvt_pk_bf16_f32 v196, v232, v233
    v_cvt_pk_bf16_f32 v197, v234, v235
    v_exp_f32 v232, v148
    v_exp_f32 v233, v149
    v_exp_f32 v234, v150
    v_exp_f32 v235, v151
    s_nop 0
    v_cvt_pk_bf16_f32 v198, v232, v233
    v_cvt_pk_bf16_f32 v199, v234, v235
    v_exp_f32 v232, v136
    v_exp_f32 v233, v137
    v_exp_f32 v234, v138
    v_exp_f32 v235, v139
    s_nop 0
    v_cvt_pk_bf16_f32 v200, v232, v233
    v_cvt_pk_bf16_f32 v201, v234, v235
    v_exp_f32 v232, v152
    v_exp_f32 v233, v153
    v_exp_f32 v234, v154
    v_exp_f32 v235, v155
    s_nop 0
    v_cvt_pk_bf16_f32 v202, v232, v233
    v_cvt_pk_bf16_f32 v203, v234, v235
    v_exp_f32 v232, v140
    v_exp_f32 v233, v141
    v_exp_f32 v234, v142
    v_exp_f32 v235, v143
    s_nop 0
    v_cvt_pk_bf16_f32 v204, v232, v233
    v_cvt_pk_bf16_f32 v205, v234, v235
    v_exp_f32 v232, v156
    v_exp_f32 v233, v157
    v_exp_f32 v234, v158
    v_exp_f32 v235, v159
    s_nop 0
    v_cvt_pk_bf16_f32 v206, v232, v233
    v_cvt_pk_bf16_f32 v207, v234, v235
    s_nop 3
    s_setpc_b64 s[40:41]
k2_rare_167:
    s_nop 7
    v_max_f32 v54, v160, v161
    v_max3_f32 v54, v54, v162, v163
    v_max3_f32 v54, v54, v176, v177
    v_max3_f32 v54, v54, v178, v179
    v_max3_f32 v54, v54, v168, v169
    v_max3_f32 v54, v54, v170, v171
    v_max3_f32 v54, v54, v184, v185
    v_max3_f32 v54, v54, v186, v187
    v_max_f32 v55, v164, v165
    v_max3_f32 v55, v55, v166, v167
    v_max3_f32 v55, v55, v180, v181
    v_max3_f32 v55, v55, v182, v183
    v_max3_f32 v55, v55, v172, v173
    v_max3_f32 v55, v55, v174, v175
    v_max3_f32 v55, v55, v188, v189
    v_max3_f32 v55, v55, v190, v191
    v_mov_b32 v226, v54
    v_mov_b32 v227, v55
    s_nop 1
    v_permlane16_swap_b32 v54, v226
    v_permlane16_swap_b32 v55, v227
    s_nop 1
    v_max_f32 v54, v54, v226
    v_max_f32 v55, v55, v227
    v_mov_b32 v226, v54
    v_mov_b32 v227, v55
    s_nop 1
    v_permlane32_swap_b32 v54, v226
    v_permlane32_swap_b32 v55, v227
    s_nop 1
    v_max_f32 v54, v54, v226
    v_max_f32 v55, v55, v227
    v_add_f32 v54, 0x41400000, v54
    v_max_f32 v54, 0, v54
    v_add_f32 v55, 0x41400000, v55
    v_max_f32 v55, 0, v55
    v_sub_f32 v160, v160, v54
    v_sub_f32 v161, v161, v54
    v_sub_f32 v162, v162, v54
    v_sub_f32 v163, v163, v54
    v_sub_f32 v164, v164, v55
    v_sub_f32 v165, v165, v55
    v_sub_f32 v166, v166, v55
    v_sub_f32 v167, v167, v55
    v_sub_f32 v168, v168, v54
    v_sub_f32 v169, v169, v54
    v_sub_f32 v170, v170, v54
    v_sub_f32 v171, v171, v54
    v_sub_f32 v172, v172, v55
    v_sub_f32 v173, v173, v55
    v_sub_f32 v174, v174, v55
    v_sub_f32 v175, v175, v55
    v_sub_f32 v176, v176, v54
    v_sub_f32 v177, v177, v54
    v_sub_f32 v178, v178, v54
    v_sub_f32 v179, v179, v54
    v_sub_f32 v180, v180, v55
    v_sub_f32 v181, v181, v55
    v_sub_f32 v182, v182, v55
    v_sub_f32 v183, v183, v55
    v_sub_f32 v184, v184, v54
    v_sub_f32 v185, v185, v54
    v_sub_f32 v186, v186, v54
    v_sub_f32 v187, v187, v54
    v_sub_f32 v188, v188, v55
    v_sub_f32 v189, v189, v55
    v_sub_f32 v190, v190, v55
    v_sub_f32 v191, v191, v55
    v_sub_f32 v128, v128, v54
    v_sub_f32 v16, v16, v54
    v_sub_f32 v129, v129, v54
    v_sub_f32 v17, v17, v54
    v_sub_f32 v130, v130, v54
    v_sub_f32 v18, v18, v54
    v_sub_f32 v131, v131, v54
    v_sub_f32 v19, v19, v54
    v_sub_f32 v132, v132, v55
    v_sub_f32 v20, v20, v55
    v_sub_f32 v133, v133, v55
    v_sub_f32 v21, v21, v55
    v_sub_f32 v134, v134, v55
    v_sub_f32 v22, v22, v55
    v_sub_f32 v135, v135, v55
    v_sub_f32 v23, v23, v55
    v_sub_f32 v136, v136, v54
    v_sub_f32 v24, v24, v54
    v_sub_f32 v137, v137, v54
    v_sub_f32 v25, v25, v54
    v_sub_f32 v138, v138, v54
    v_sub_f32 v26, v26, v54
    v_sub_f32 v139, v139, v54
    v_sub_f32 v27, v27, v54
    v_sub_f32 v140, v140, v55
    v_sub_f32 v28, v28, v55
    v_sub_f32 v141, v141, v55
    v_sub_f32 v29, v29, v55
    v_sub_f32 v142, v142, v55
    v_sub_f32 v30, v30, v55
    v_sub_f32 v143, v143, v55
    v_sub_f32 v31, v31, v55
    v_sub_f32 v144, v144, v54
    v_sub_f32 v32, v32, v54
    v_sub_f32 v145, v145, v54
    v_sub_f32 v33, v33, v54
    v_sub_f32 v146, v146, v54
    v_sub_f32 v34, v34, v54
    v_sub_f32 v147, v147, v54
    v_sub_f32 v35, v35, v54
    v_sub_f32 v148, v148, v55
    v_sub_f32 v36, v36, v55
    v_sub_f32 v149, v149, v55
    v_sub_f32 v37, v37, v55
    v_sub_f32 v150, v150, v55
    v_sub_f32 v38, v38, v55
    v_sub_f32 v151, v151, v55
    v_sub_f32 v39, v39, v55
    v_sub_f32 v152, v152, v54
    v_sub_f32 v40, v40, v54
    v_sub_f32 v153, v153, v54
    v_sub_f32 v41, v41, v54
    v_sub_f32 v154, v154, v54
    v_sub_f32 v42, v42, v54
    v_sub_f32 v155, v155, v54
    v_sub_f32 v43, v43, v54
    v_sub_f32 v156, v156, v55
    v_sub_f32 v44, v44, v55
    v_sub_f32 v157, v157, v55
    v_sub_f32 v45, v45, v55
    v_sub_f32 v158, v158, v55
    v_sub_f32 v46, v46, v55
    v_sub_f32 v159, v159, v55
    v_sub_f32 v47, v47, v55
    v_sub_f32 v10, v10, v54
    v_exp_f32 v54, -v54
    v_sub_f32 v11, v11, v55
    v_exp_f32 v55, -v55
    s_nop 0
    v_mul_f32 v248, v248, v54
    v_mul_f32 v252, v252, v55
    v_accvgpr_read_b32 v224, a8
    v_accvgpr_read_b32 v225, a9
    v_accvgpr_read_b32 v226, a10
    v_accvgpr_read_b32 v227, a11
    v_mul_f32 v224, v224, v54
    v_mul_f32 v225, v225, v54
    v_mul_f32 v226, v226, v54
    v_mul_f32 v227, v227, v54
    v_accvgpr_write_b32 a8, v224
    v_accvgpr_write_b32 a9, v225
    v_accvgpr_write_b32 a10, v226
    v_accvgpr_write_b32 a11, v227
    v_accvgpr_read_b32 v224, a12
    v_accvgpr_read_b32 v225, a13
    v_accvgpr_read_b32 v226, a14
    v_accvgpr_read_b32 v227, a15
    v_mul_f32 v224, v224, v55
    v_mul_f32 v225, v225, v55
    v_mul_f32 v226, v226, v55
    v_mul_f32 v227, v227, v55
    v_accvgpr_write_b32 a12, v224
    v_accvgpr_write_b32 a13, v225
    v_accvgpr_write_b32 a14, v226
    v_accvgpr_write_b32 a15, v227
    v_accvgpr_read_b32 v224, a24
    v_accvgpr_read_b32 v225, a25
    v_accvgpr_read_b32 v226, a26
    v_accvgpr_read_b32 v227, a27
    v_mul_f32 v224, v224, v54
    v_mul_f32 v225, v225, v54
    v_mul_f32 v226, v226, v54
    v_mul_f32 v227, v227, v54
    v_accvgpr_write_b32 a24, v224
    v_accvgpr_write_b32 a25, v225
    v_accvgpr_write_b32 a26, v226
    v_accvgpr_write_b32 a27, v227
    v_accvgpr_read_b32 v224, a28
    v_accvgpr_read_b32 v225, a29
    v_accvgpr_read_b32 v226, a30
    v_accvgpr_read_b32 v227, a31
    v_mul_f32 v224, v224, v55
    v_mul_f32 v225, v225, v55
    v_mul_f32 v226, v226, v55
    v_mul_f32 v227, v227, v55
    v_accvgpr_write_b32 a28, v224
    v_accvgpr_write_b32 a29, v225
    v_accvgpr_write_b32 a30, v226
    v_accvgpr_write_b32 a31, v227
    v_accvgpr_read_b32 v224, a40
    v_accvgpr_read_b32 v225, a41
    v_accvgpr_read_b32 v226, a42
    v_accvgpr_read_b32 v227, a43
    v_mul_f32 v224, v224, v54
    v_mul_f32 v225, v225, v54
    v_mul_f32 v226, v226, v54
    v_mul_f32 v227, v227, v54
    v_accvgpr_write_b32 a40, v224
    v_accvgpr_write_b32 a41, v225
    v_accvgpr_write_b32 a42, v226
    v_accvgpr_write_b32 a43, v227
    v_accvgpr_read_b32 v224, a44
    v_accvgpr_read_b32 v225, a45
    v_accvgpr_read_b32 v226, a46
    v_accvgpr_read_b32 v227, a47
    v_mul_f32 v224, v224, v55
    v_mul_f32 v225, v225, v55
    v_mul_f32 v226, v226, v55
    v_mul_f32 v227, v227, v55
    v_accvgpr_write_b32 a44, v224
    v_accvgpr_write_b32 a45, v225
    v_accvgpr_write_b32 a46, v226
    v_accvgpr_write_b32 a47, v227
    v_accvgpr_read_b32 v224, a56
    v_accvgpr_read_b32 v225, a57
    v_accvgpr_read_b32 v226, a58
    v_accvgpr_read_b32 v227, a59
    v_mul_f32 v224, v224, v54
    v_mul_f32 v225, v225, v54
    v_mul_f32 v226, v226, v54
    v_mul_f32 v227, v227, v54
    v_accvgpr_write_b32 a56, v224
    v_accvgpr_write_b32 a57, v225
    v_accvgpr_write_b32 a58, v226
    v_accvgpr_write_b32 a59, v227
    v_accvgpr_read_b32 v224, a60
    v_accvgpr_read_b32 v225, a61
    v_accvgpr_read_b32 v226, a62
    v_accvgpr_read_b32 v227, a63
    v_mul_f32 v224, v224, v55
    v_mul_f32 v225, v225, v55
    v_mul_f32 v226, v226, v55
    v_mul_f32 v227, v227, v55
    v_accvgpr_write_b32 a60, v224
    v_accvgpr_write_b32 a61, v225
    v_accvgpr_write_b32 a62, v226
    v_accvgpr_write_b32 a63, v227
    v_accvgpr_read_b32 v224, a72
    v_accvgpr_read_b32 v225, a73
    v_accvgpr_read_b32 v226, a74
    v_accvgpr_read_b32 v227, a75
    v_mul_f32 v224, v224, v54
    v_mul_f32 v225, v225, v54
    v_mul_f32 v226, v226, v54
    v_mul_f32 v227, v227, v54
    v_accvgpr_write_b32 a72, v224
    v_accvgpr_write_b32 a73, v225
    v_accvgpr_write_b32 a74, v226
    v_accvgpr_write_b32 a75, v227
    v_accvgpr_read_b32 v224, a76
    v_accvgpr_read_b32 v225, a77
    v_accvgpr_read_b32 v226, a78
    v_accvgpr_read_b32 v227, a79
    v_mul_f32 v224, v224, v55
    v_mul_f32 v225, v225, v55
    v_mul_f32 v226, v226, v55
    v_mul_f32 v227, v227, v55
    v_accvgpr_write_b32 a76, v224
    v_accvgpr_write_b32 a77, v225
    v_accvgpr_write_b32 a78, v226
    v_accvgpr_write_b32 a79, v227
    v_accvgpr_read_b32 v224, a88
    v_accvgpr_read_b32 v225, a89
    v_accvgpr_read_b32 v226, a90
    v_accvgpr_read_b32 v227, a91
    v_mul_f32 v224, v224, v54
    v_mul_f32 v225, v225, v54
    v_mul_f32 v226, v226, v54
    v_mul_f32 v227, v227, v54
    v_accvgpr_write_b32 a88, v224
    v_accvgpr_write_b32 a89, v225
    v_accvgpr_write_b32 a90, v226
    v_accvgpr_write_b32 a91, v227
    v_accvgpr_read_b32 v224, a92
    v_accvgpr_read_b32 v225, a93
    v_accvgpr_read_b32 v226, a94
    v_accvgpr_read_b32 v227, a95
    v_mul_f32 v224, v224, v55
    v_mul_f32 v225, v225, v55
    v_mul_f32 v226, v226, v55
    v_mul_f32 v227, v227, v55
    v_accvgpr_write_b32 a92, v224
    v_accvgpr_write_b32 a93, v225
    v_accvgpr_write_b32 a94, v226
    v_accvgpr_write_b32 a95, v227
    v_accvgpr_read_b32 v224, a104
    v_accvgpr_read_b32 v225, a105
    v_accvgpr_read_b32 v226, a106
    v_accvgpr_read_b32 v227, a107
    v_mul_f32 v224, v224, v54
    v_mul_f32 v225, v225, v54
    v_mul_f32 v226, v226, v54
    v_mul_f32 v227, v227, v54
    v_accvgpr_write_b32 a104, v224
    v_accvgpr_write_b32 a105, v225
    v_accvgpr_write_b32 a106, v226
    v_accvgpr_write_b32 a107, v227
    v_accvgpr_read_b32 v224, a108
    v_accvgpr_read_b32 v225, a109
    v_accvgpr_read_b32 v226, a110
    v_accvgpr_read_b32 v227, a111
    v_mul_f32 v224, v224, v55
    v_mul_f32 v225, v225, v55
    v_mul_f32 v226, v226, v55
    v_mul_f32 v227, v227, v55
    v_accvgpr_write_b32 a108, v224
    v_accvgpr_write_b32 a109, v225
    v_accvgpr_write_b32 a110, v226
    v_accvgpr_write_b32 a111, v227
    v_accvgpr_read_b32 v224, a120
    v_accvgpr_read_b32 v225, a121
    v_accvgpr_read_b32 v226, a122
    v_accvgpr_read_b32 v227, a123
    v_mul_f32 v224, v224, v54
    v_mul_f32 v225, v225, v54
    v_mul_f32 v226, v226, v54
    v_mul_f32 v227, v227, v54
    v_accvgpr_write_b32 a120, v224
    v_accvgpr_write_b32 a121, v225
    v_accvgpr_write_b32 a122, v226
    v_accvgpr_write_b32 a123, v227
    v_accvgpr_read_b32 v224, a124
    v_accvgpr_read_b32 v225, a125
    v_accvgpr_read_b32 v226, a126
    v_accvgpr_read_b32 v227, a127
    v_mul_f32 v224, v224, v55
    v_mul_f32 v225, v225, v55
    v_mul_f32 v226, v226, v55
    v_mul_f32 v227, v227, v55
    v_accvgpr_write_b32 a124, v224
    v_accvgpr_write_b32 a125, v225
    v_accvgpr_write_b32 a126, v226
    v_accvgpr_write_b32 a127, v227
    v_exp_f32 v232, v160
    v_exp_f32 v233, v161
    v_exp_f32 v234, v162
    v_exp_f32 v235, v163
    s_nop 0
    v_cvt_pk_bf16_f32 v208, v232, v233
    v_cvt_pk_bf16_f32 v209, v234, v235
    v_exp_f32 v232, v176
    v_exp_f32 v233, v177
    v_exp_f32 v234, v178
    v_exp_f32 v235, v179
    s_nop 0
    v_cvt_pk_bf16_f32 v210, v232, v233
    v_cvt_pk_bf16_f32 v211, v234, v235
    v_exp_f32 v232, v164
    v_exp_f32 v233, v165
    v_exp_f32 v234, v166
    v_exp_f32 v235, v167
    s_nop 0
    v_cvt_pk_bf16_f32 v212, v232, v233
    v_cvt_pk_bf16_f32 v213, v234, v235
    v_exp_f32 v232, v180
    v_exp_f32 v233, v181
    v_exp_f32 v234, v182
    v_exp_f32 v235, v183
    s_nop 0
    v_cvt_pk_bf16_f32 v214, v232, v233
    v_cvt_pk_bf16_f32 v215, v234, v235
    v_exp_f32 v232, v168
    v_exp_f32 v233, v169
    v_exp_f32 v234, v170
    v_exp_f32 v235, v171
    s_nop 0
    v_cvt_pk_bf16_f32 v216, v232, v233
    v_cvt_pk_bf16_f32 v217, v234, v235
    v_exp_f32 v232, v184
    v_exp_f32 v233, v185
    v_exp_f32 v234, v186
    v_exp_f32 v235, v187
    s_nop 0
    v_cvt_pk_bf16_f32 v218, v232, v233
    v_cvt_pk_bf16_f32 v219, v234, v235
    v_exp_f32 v232, v172
    v_exp_f32 v233, v173
    v_exp_f32 v234, v174
    v_exp_f32 v235, v175
    s_nop 0
    v_cvt_pk_bf16_f32 v220, v232, v233
    v_cvt_pk_bf16_f32 v221, v234, v235
    v_exp_f32 v232, v188
    v_exp_f32 v233, v189
    v_exp_f32 v234, v190
    v_exp_f32 v235, v191
    s_nop 0
    v_cvt_pk_bf16_f32 v222, v232, v233
    v_cvt_pk_bf16_f32 v223, v234, v235
    s_nop 3
    s_setpc_b64 s[40:41]
k2_rare_171:
    s_nop 7
    v_max_f32 v55, v164, v165
    v_max3_f32 v55, v55, v166, v167
    v_max3_f32 v55, v55, v180, v181
    v_max3_f32 v55, v55, v182, v183
    v_max3_f32 v55, v55, v172, v173
    v_max3_f32 v55, v55, v174, v175
    v_max3_f32 v55, v55, v188, v189
    v_max3_f32 v55, v55, v190, v191
    v_mov_b32 v227, v55
    s_nop 1
    v_permlane16_swap_b32 v55, v227
    s_nop 1
    v_max_f32 v55, v55, v227
    v_mov_b32 v227, v55
    s_nop 1
    v_permlane32_swap_b32 v55, v227
    s_nop 1
    v_max_f32 v55, v55, v227
    v_add_f32 v55, 0x41400000, v55
    v_max_f32 v55, 0, v55
    v_sub_f32 v164, v164, v55
    v_sub_f32 v165, v165, v55
    v_sub_f32 v166, v166, v55
    v_sub_f32 v167, v167, v55
    v_sub_f32 v172, v172, v55
    v_sub_f32 v173, v173, v55
    v_sub_f32 v174, v174, v55
    v_sub_f32 v175, v175, v55
    v_sub_f32 v180, v180, v55
    v_sub_f32 v181, v181, v55
    v_sub_f32 v182, v182, v55
    v_sub_f32 v183, v183, v55
    v_sub_f32 v188, v188, v55
    v_sub_f32 v189, v189, v55
    v_sub_f32 v190, v190, v55
    v_sub_f32 v191, v191, v55
    v_sub_f32 v11, v11, v55
    v_exp_f32 v55, -v55
    s_nop 0
    v_mul_f32 v252, v252, v55
    v_accvgpr_read_b32 v224, a12
    v_accvgpr_read_b32 v225, a13
    v_accvgpr_read_b32 v226, a14
    v_accvgpr_read_b32 v227, a15
    v_mul_f32 v224, v224, v55
    v_mul_f32 v225, v225, v55
    v_mul_f32 v226, v226, v55
    v_mul_f32 v227, v227, v55
    v_accvgpr_write_b32 a12, v224
    v_accvgpr_write_b32 a13, v225
    v_accvgpr_write_b32 a14, v226
    v_accvgpr_write_b32 a15, v227
    v_accvgpr_read_b32 v224, a28
    v_accvgpr_read_b32 v225, a29
    v_accvgpr_read_b32 v226, a30
    v_accvgpr_read_b32 v227, a31
    v_mul_f32 v224, v224, v55
    v_mul_f32 v225, v225, v55
    v_mul_f32 v226, v226, v55
    v_mul_f32 v227, v227, v55
    v_accvgpr_write_b32 a28, v224
    v_accvgpr_write_b32 a29, v225
    v_accvgpr_write_b32 a30, v226
    v_accvgpr_write_b32 a31, v227
    v_accvgpr_read_b32 v224, a44
    v_accvgpr_read_b32 v225, a45
    v_accvgpr_read_b32 v226, a46
    v_accvgpr_read_b32 v227, a47
    v_mul_f32 v224, v224, v55
    v_mul_f32 v225, v225, v55
    v_mul_f32 v226, v226, v55
    v_mul_f32 v227, v227, v55
    v_accvgpr_write_b32 a44, v224
    v_accvgpr_write_b32 a45, v225
    v_accvgpr_write_b32 a46, v226
    v_accvgpr_write_b32 a47, v227
    v_accvgpr_read_b32 v224, a60
    v_accvgpr_read_b32 v225, a61
    v_accvgpr_read_b32 v226, a62
    v_accvgpr_read_b32 v227, a63
    v_mul_f32 v224, v224, v55
    v_mul_f32 v225, v225, v55
    v_mul_f32 v226, v226, v55
    v_mul_f32 v227, v227, v55
    v_accvgpr_write_b32 a60, v224
    v_accvgpr_write_b32 a61, v225
    v_accvgpr_write_b32 a62, v226
    v_accvgpr_write_b32 a63, v227
    v_accvgpr_read_b32 v224, a76
    v_accvgpr_read_b32 v225, a77
    v_accvgpr_read_b32 v226, a78
    v_accvgpr_read_b32 v227, a79
    v_mul_f32 v224, v224, v55
    v_mul_f32 v225, v225, v55
    v_mul_f32 v226, v226, v55
    v_mul_f32 v227, v227, v55
    v_accvgpr_write_b32 a76, v224
    v_accvgpr_write_b32 a77, v225
    v_accvgpr_write_b32 a78, v226
    v_accvgpr_write_b32 a79, v227
    v_accvgpr_read_b32 v224, a92
    v_accvgpr_read_b32 v225, a93
    v_accvgpr_read_b32 v226, a94
    v_accvgpr_read_b32 v227, a95
    v_mul_f32 v224, v224, v55
    v_mul_f32 v225, v225, v55
    v_mul_f32 v226, v226, v55
    v_mul_f32 v227, v227, v55
    v_accvgpr_write_b32 a92, v224
    v_accvgpr_write_b32 a93, v225
    v_accvgpr_write_b32 a94, v226
    v_accvgpr_write_b32 a95, v227
    v_accvgpr_read_b32 v224, a108
    v_accvgpr_read_b32 v225, a109
    v_accvgpr_read_b32 v226, a110
    v_accvgpr_read_b32 v227, a111
    v_mul_f32 v224, v224, v55
    v_mul_f32 v225, v225, v55
    v_mul_f32 v226, v226, v55
    v_mul_f32 v227, v227, v55
    v_accvgpr_write_b32 a108, v224
    v_accvgpr_write_b32 a109, v225
    v_accvgpr_write_b32 a110, v226
    v_accvgpr_write_b32 a111, v227
    v_accvgpr_read_b32 v224, a124
    v_accvgpr_read_b32 v225, a125
    v_accvgpr_read_b32 v226, a126
    v_accvgpr_read_b32 v227, a127
    v_mul_f32 v224, v224, v55
    v_mul_f32 v225, v225, v55
    v_mul_f32 v226, v226, v55
    v_mul_f32 v227, v227, v55
    v_accvgpr_write_b32 a124, v224
    v_accvgpr_write_b32 a125, v225
    v_accvgpr_write_b32 a126, v226
    v_accvgpr_write_b32 a127, v227
    v_exp_f32 v232, v164
    v_exp_f32 v233, v165
    v_exp_f32 v234, v166
    v_exp_f32 v235, v167
    s_nop 0
    v_cvt_pk_bf16_f32 v212, v232, v233
    v_cvt_pk_bf16_f32 v213, v234, v235
    v_exp_f32 v232, v180
    v_exp_f32 v233, v181
    v_exp_f32 v234, v182
    v_exp_f32 v235, v183
    s_nop 0
    v_cvt_pk_bf16_f32 v214, v232, v233
    v_cvt_pk_bf16_f32 v215, v234, v235
    v_exp_f32 v232, v172
    v_exp_f32 v233, v173
    v_exp_f32 v234, v174
    v_exp_f32 v235, v175
    s_nop 0
    v_cvt_pk_bf16_f32 v220, v232, v233
    v_cvt_pk_bf16_f32 v221, v234, v235
    v_exp_f32 v232, v188
    v_exp_f32 v233, v189
    v_exp_f32 v234, v190
    v_exp_f32 v235, v191
    s_nop 0
    v_cvt_pk_bf16_f32 v222, v232, v233
    v_cvt_pk_bf16_f32 v223, v234, v235
    s_nop 3
    s_setpc_b64 s[40:41]
code_end:
    s_endpgm
.section .rodata,"a"
.p2align 6
.amdhsa_kernel sequential_preLN__compressed_kv_cla__moe_arch_mod__prompt_kernel
  .amdhsa_next_free_vgpr 512
  .amdhsa_next_free_sgpr 102
  .amdhsa_accum_offset 256
  .amdhsa_group_segment_fixed_size 0
  .amdhsa_kernarg_size 112
  .amdhsa_user_sgpr_count 2
  .amdhsa_user_sgpr_kernarg_segment_ptr 1
  .amdhsa_system_sgpr_workgroup_id_x 1
.end_amdhsa_kernel
```

```asm
; @launch grid=(256,1,1) block=(256,1,1) lds=163840
.amdgcn_target "amdgcn-amd-amdhsa--gfx950"
.text
.globl sequential_preLN__compressed_kv_cla__moe_arch_mod__prompt_kernel
.p2align 8
.type sequential_preLN__compressed_kv_cla__moe_arch_mod__prompt_kernel,@function
sequential_preLN__compressed_kv_cla__moe_arch_mod__prompt_kernel:
    s_cmp_ge_u32 s2, 256
    s_cbranch_scc1 k12_end_1
    s_load_dwordx4 s[36:39], s[0:1], 0
    s_load_dwordx4 s[40:43], s[0:1], 24
    s_load_dwordx2 s[4:5], s[0:1], 16
    s_load_dwordx4 s[60:63], s[0:1], 96
    s_lshr_b32 s59, s2, 3
    s_lshl_b32 s58, s59, 4
    v_add_u32 v6, s58, v0
    v_cmp_gt_u32 vcc, 48, v0
    v_cmp_gt_u32 s[56:57], 64, v0
    s_nop 0
    v_cndmask_b32 v6, v6, v0, vcc
    s_getpc_b64 s[52:53]
pc_2:
    s_add_u32 s52, s52, k12_code0-pc_2
    s_addc_u32 s53, s53, 0
    v_lshlrev_b32 v58, 7, v6
    v_mov_b32 v59, s53
    v_add_co_u32 v58, vcc, s52, v58
    s_nop 1
    v_addc_co_u32 v59, vcc, 0, v59, vcc
k12_code0:
    s_mov_b64 exec, s[56:57]
    s_cbranch_execz k12_nocode_3
    global_load_dword v51, v[58:59], off
k12_nocode_3:
    s_mov_b64 exec, -1
    s_and_b32 s58, s2, 7
    s_lshr_b32 s59, s2, 3
    s_and_b32 s45, s59, 7
    s_lshr_b32 s57, s59, 3
    s_and_b32 s44, s57, 1
    s_lshl_b32 s52, s58, 1
    s_add_u32 s44, s44, s52
    s_lshr_b32 s57, s57, 1
    v_lshrrev_b32 v2, 6, v0
    v_and_b32 v3, 63, v0
    v_readfirstlane_b32 s30, v2
    v_lshlrev_b32 v1, 4, v3
    v_lshrrev_b32 v60, 5, v3
    v_lshl_add_u32 v60, v2, 1, v60
    v_and_b32 v61, 31, v3
    v_lshlrev_b32 v6, 11, v60
    v_lshl_add_u32 v62, v61, 4, v6
    s_lshl_b32 s52, s2, 14
    v_lshrrev_b32 v56, 3, v3
    v_and_b32 v57, 7, v3
    v_lshrrev_b32 v58, 1, v56
    v_xor_b32 v6, v57, v58
    v_xor_b32 v7, 4, v6
    v_lshl_add_u32 v58, v2, 6, v56
    v_lshlrev_b32 v58, 10, v58
    s_lshl_b32 s47, s45, 18
    v_add_u32 v58, s47, v58
    v_lshl_add_u32 v10, v6, 4, v58
    v_lshl_add_u32 v11, v7, 4, v58
    v_add_u32 v17, 54272, v11
    v_add_u32 v16, 47104, v10
    v_add_u32 v15, 39936, v11
    v_add_u32 v14, 32768, v10
    v_add_u32 v13, 21504, v11
    v_add_u32 v12, 14336, v10
    v_add_u32 v11, 7168, v11
    v_add_u32 v10, 0, v10
    s_lshl_b32 s48, s30, 13
    s_mov_b32 s49, 0
    s_mov_b32 s50, 0
    s_waitcnt lgkmcnt(0)
    s_mov_b32 s24, s36
    s_and_b32 s25, s37, 0xffff
    s_mov_b32 s26, 0x400000
    s_mov_b32 s27, 0x00020000
    s_mov_b32 s16, s38
    s_and_b32 s17, s39, 0xffff
    s_mov_b32 s18, 0x200000
    s_mov_b32 s19, 0x00020000
    s_cmp_eq_u32 s57, 0
    s_cselect_b32 s20, s40, s42
    s_cselect_b32 s21, s41, s43
    s_and_b32 s21, s21, 0xffff
    s_mov_b32 s22, 0x400000
    s_mov_b32 s23, 0x00020000
    v_lshlrev_b32 v6, 17, v1
    s_mov_b64 exec, 1
    buffer_load_dword v51, v62, s[24:27], s52 offen
    global_load_dword v51, v6, s[60:61]
    buffer_load_dword v51, v6, s[20:23], 0 offen
    global_load_dword v51, v6, s[62:63]
    global_load_dword v51, v6, s[4:5]
    s_mov_b64 exec, -1
    s_add_u32 m0, s48, 0
    s_nop 0
    buffer_load_dwordx4 v10, s[16:19], s49 offen offset:0 lds
    buffer_load_dwordx4 v11, s[16:19], s49 offen offset:1024 lds
    buffer_load_dwordx4 v12, s[16:19], s49 offen offset:2048 lds
    buffer_load_dwordx4 v13, s[16:19], s49 offen offset:3072 lds
    buffer_load_dwordx4 v[64:67], v62, s[24:27], s52 offen offset:0
    buffer_load_dwordx4 v[68:71], v62, s[24:27], s52 offen offset:512
    buffer_load_dwordx4 v[72:75], v62, s[24:27], s52 offen offset:1024
    buffer_load_dwordx4 v[76:79], v62, s[24:27], s52 offen offset:1536
    v_lshrrev_b32 v6, 5, v3
    v_bfe_u32 v7, v3, 1, 4
    v_and_b32 v59, 1, v3
    v_lshl_add_u32 v58, v2, 4, v6
    v_lshlrev_b32 v58, 13, v58
    v_lshl_add_u32 v58, v59, 4, v58
    s_lshl_b32 s47, s44, 9
    v_add_u32 v58, s47, v58
    v_xor_b32 v7, v7, v6
    v_xor_b32 v6, 0, v7
    v_lshl_add_u32 v6, v6, 5, v58
    v_add_u32 v18, 0, v6
    v_xor_b32 v6, 2, v7
    v_lshl_add_u32 v6, v6, 5, v58
    v_add_u32 v19, 15360, v6
    v_xor_b32 v6, 0, v7
    v_lshl_add_u32 v6, v6, 5, v58
    v_add_u32 v20, 30720, v6
    v_xor_b32 v6, 2, v7
    v_lshl_add_u32 v6, v6, 5, v58
    v_add_u32 v21, 46080, v6
    v_xor_b32 v6, 4, v7
    v_lshl_add_u32 v6, v6, 5, v58
    v_add_u32 v22, 65536, v6
    v_xor_b32 v6, 6, v7
    v_lshl_add_u32 v6, v6, 5, v58
    v_add_u32 v23, 80896, v6
    v_xor_b32 v6, 4, v7
    v_lshl_add_u32 v6, v6, 5, v58
    v_add_u32 v24, 96256, v6
    v_xor_b32 v6, 6, v7
    v_lshl_add_u32 v6, v6, 5, v58
    v_add_u32 v25, 111616, v6
    s_add_u32 m0, s48, 65536
    s_nop 0
    buffer_load_dwordx4 v18, s[20:23], s50 offen offset:0 lds
    buffer_load_dwordx4 v19, s[20:23], s50 offen offset:1024 lds
    buffer_load_dwordx4 v20, s[20:23], s50 offen offset:2048 lds
    buffer_load_dwordx4 v21, s[20:23], s50 offen offset:3072 lds
    s_mov_b64 s[6:7], s[62:63]
    s_add_u32 s8, s6, 0x0
    s_addc_u32 s9, s7, 0
    s_and_b32 s9, s9, 0xffff
    s_mov_b32 s10, 0x400000
    s_mov_b32 s11, 0x00020000
    s_mov_b32 s12, s4
    s_and_b32 s13, s5, 0xffff
    s_mov_b32 s14, 0x800000
    s_mov_b32 s15, 0x00020000
    s_add_u32 s32, s6, 0x1000000
    s_addc_u32 s33, s7, 0
    s_and_b32 s33, s33, 0xffff
    s_mov_b32 s34, 0x2000000
    s_mov_b32 s35, 0x00020000
    s_mov_b32 s24, s60
    s_and_b32 s25, s61, 0xffff
    s_mov_b32 s26, 0x100
    s_mov_b32 s27, 0x00020000
    s_lshl_b32 s28, s58, 2
    s_and_b32 s31, s59, 3
    s_add_u32 s28, s28, s31
    s_lshr_b32 s29, s59, 2
    s_lshl_b32 s42, s29, 7
    s_sub_u32 s43, 1920, s42
    s_lshl_b32 s31, s30, 4
    s_add_u32 s38, s42, s31
    s_add_u32 s39, s43, s31
    s_lshl_b32 s60, s30, 12
    s_mov_b32 s61, 0
    s_mov_b32 s62, 0
    s_lshl_b32 s47, s44, 1
    s_lshr_b32 s52, s30, 1
    s_add_u32 s47, s47, s52
    s_lshl_b32 s47, s47, 14
    s_lshl_b32 s52, s45, 1
    s_and_b32 s53, s30, 1
    s_add_u32 s52, s52, s53
    s_lshl_b32 s52, s52, 20
    s_add_u32 s47, s47, s52
    s_lshl_b32 s52, s57, 24
    s_add_u32 s47, s47, s52
    s_lshl_b32 s54, s44, 8
    s_lshr_b32 s55, s28, 1
    s_lshl_b32 s55, s55, 8
    s_and_b32 s53, s59, 3
    s_add_u32 s53, s53, 1
    s_cmp_eq_u32 s30, 0
    s_cselect_b32 s53, s53, -1
    s_cselect_b32 s46, 6, -1
    v_lshlrev_b32 v6, 13, v56
    v_lshl_add_u32 v50, v57, 7, v6
    s_lshl_b32 s56, s30, 5
    s_add_u32 s56, s56, s59
    s_lshl_b32 s56, s56, 16
    s_lshl_b32 s52, s58, 10
    s_add_u32 s56, s56, s52
    s_add_u32 s63, s30, 1
    v_mul_u32_u24 v6, 2064, v60
    v_lshl_add_u32 v6, v61, 4, v6
    v_add_u32 v54, 131072, v6
    v_mul_u32_u24 v7, 2064, v57
    v_lshl_add_u32 v7, v56, 4, v7
    v_lshl_add_u32 v7, v2, 9, v7
    v_add_u32 v55, 131072, v7
    v_lshrrev_b32 v7, 2, v56
    v_lshl_add_u32 v7, v2, 3, v7
    v_lshlrev_b32 v7, 17, v7
    v_and_b32 v6, 3, v56
    v_lshl_add_u32 v7, v6, 8, v7
    v_lshl_add_u32 v7, v57, 4, v7
    s_lshr_b32 s52, s2, 1
    s_lshl_b32 s52, s52, 10
    s_and_b32 s31, s2, 1
    s_lshl_b32 s31, s31, 7
    s_add_u32 s52, s52, s31
    v_add_u32 v53, s52, v7
    v_and_b32 v56, 15, v3
    v_lshrrev_b32 v57, 4, v3
    v_lshrrev_b32 v6, 1, v56
    v_xor_b32 v6, v6, v57
    v_and_b32 v7, 1, v2
    v_lshl_add_u32 v7, v7, 7, v56
    v_lshlrev_b32 v7, 7, v7
    v_lshl_add_u32 v26, v6, 4, v7
    v_xor_b32 v27, 64, v26
    v_lshrrev_b32 v6, 2, v56
    v_and_b32 v58, 1, v57
    v_lshl_add_u32 v58, v58, 2, v6
    v_lshl_add_u32 v59, v57, 3, v6
    v_and_b32 v63, 3, v3
    v_lshlrev_b32 v7, 9, v59
    v_lshrrev_b32 v6, 1, v2
    v_lshl_add_u32 v7, v6, 8, v7
    v_lshl_add_u32 v7, v63, 3, v7
    v_add_u32 v7, 65536, v7
    v_lshlrev_b32 v59, 8, v59
    v_lshl_add_u32 v59, v63, 3, v59
    v_add_u32 v59, 98304, v59
    v_xor_b32 v6, 0, v58
    v_lshl_add_u32 v28, v6, 5, v7
    v_lshl_add_u32 v42, v6, 5, v59
    v_xor_b32 v6, 1, v58
    v_lshl_add_u32 v29, v6, 5, v7
    v_lshl_add_u32 v43, v6, 5, v59
    v_xor_b32 v6, 2, v58
    v_lshl_add_u32 v30, v6, 5, v7
    v_lshl_add_u32 v44, v6, 5, v59
    v_xor_b32 v6, 3, v58
    v_lshl_add_u32 v31, v6, 5, v7
    v_lshl_add_u32 v45, v6, 5, v59
    v_xor_b32 v6, 4, v58
    v_lshl_add_u32 v32, v6, 5, v7
    v_lshl_add_u32 v46, v6, 5, v59
    v_xor_b32 v6, 5, v58
    v_lshl_add_u32 v33, v6, 5, v7
    v_lshl_add_u32 v47, v6, 5, v59
    v_xor_b32 v6, 6, v58
    v_lshl_add_u32 v34, v6, 5, v7
    v_lshl_add_u32 v48, v6, 5, v59
    v_xor_b32 v6, 7, v58
    v_lshl_add_u32 v35, v6, 5, v7
    v_lshl_add_u32 v49, v6, 5, v59
    s_lshl_b32 s31, s38, 6
    v_add_u32 v36, s31, v1
    s_lshl_b32 s31, s39, 6
    v_add_u32 v37, s31, v1
    v_bfe_u32 v6, v3, 1, 3
    v_and_b32 v7, 1, v3
    v_lshl_add_u32 v58, v2, 4, v57
    v_lshlrev_b32 v58, 13, v58
    v_lshl_add_u32 v58, v7, 4, v58
    s_lshl_b32 s31, s28, 8
    v_add_u32 v58, s31, v58
    v_xor_b32 v6, v6, v57
    v_xor_b32 v7, 0, v6
    v_lshl_add_u32 v7, v7, 5, v58
    v_add_u32 v38, 0, v7
    v_xor_b32 v7, 0, v6
    v_lshl_add_u32 v7, v7, 5, v58
    v_add_u32 v39, 31744, v7
    v_xor_b32 v7, 4, v6
    v_lshl_add_u32 v7, v7, 5, v58
    v_add_u32 v40, 63488, v7
    v_xor_b32 v7, 4, v6
    v_lshl_add_u32 v7, v7, 5, v58
    v_add_u32 v41, 95232, v7
    v_lshlrev_b32 v6, 2, v57
    v_sub_u32 v4, v56, v6
    v_mov_b32 v5, 0xff800000
    v_mov_b32 v8, 0
    v_mov_b32 v9, 1
    s_lshl_b32 s52, s59, 2
    s_add_u32 s52, s52, s30
    v_and_b32 v6, 1, v3
    v_lshl_add_u32 v6, s52, 1, v6
    s_getpc_b64 s[40:41]
pc_4:
    s_add_u32 s40, s40, k12_qcode-pc_4
    s_addc_u32 s41, s41, 0
    v_lshlrev_b32 v2, 7, v6
    v_mov_b32 v3, s41
    v_add_co_u32 v2, vcc, s40, v2
    s_nop 1
    v_addc_co_u32 v3, vcc, 0, v3, vcc
    v_mov_b32 v56, 0
    v_mov_b32 v57, 0
    v_mov_b32 v58, 0
    v_mov_b32 v59, 0
    s_nop 1
    v_mfma_f32_32x32x16_bf16 a[128:143], v[56:59], v[56:59], 0
    v_mfma_f32_32x32x16_bf16 a[144:159], v[56:59], v[56:59], 0
    v_mfma_f32_32x32x16_bf16 a[160:175], v[56:59], v[56:59], 0
    v_mfma_f32_32x32x16_bf16 a[176:191], v[56:59], v[56:59], 0
    v_mfma_f32_32x32x16_bf16 v[128:143], v[56:59], v[56:59], 0
    v_mfma_f32_32x32x16_bf16 v[144:159], v[56:59], v[56:59], 0
    v_mfma_f32_32x32x16_bf16 v[160:175], v[56:59], v[56:59], 0
    v_mfma_f32_32x32x16_bf16 v[176:191], v[56:59], v[56:59], 0
    v_mfma_f32_32x32x16_bf16 v[192:207], v[56:59], v[56:59], 0
    v_mfma_f32_32x32x16_bf16 v[208:223], v[56:59], v[56:59], 0
    v_mfma_f32_32x32x16_bf16 v[224:239], v[56:59], v[56:59], 0
    v_mfma_f32_32x32x16_bf16 v[240:255], v[56:59], v[56:59], 0
    s_add_u32 m0, s48, 4096
    s_nop 0
    buffer_load_dwordx4 v14, s[16:19], s49 offen offset:0 lds
    buffer_load_dwordx4 v15, s[16:19], s49 offen offset:1024 lds
    buffer_load_dwordx4 v16, s[16:19], s49 offen offset:2048 lds
    buffer_load_dwordx4 v17, s[16:19], s49 offen offset:3072 lds
    s_add_u32 s49, s49, 128
    s_add_u32 m0, s48, 69632
    s_nop 0
    buffer_load_dwordx4 v22, s[20:23], s50 offen offset:0 lds
    buffer_load_dwordx4 v23, s[20:23], s50 offen offset:1024 lds
    buffer_load_dwordx4 v24, s[20:23], s50 offen offset:2048 lds
    buffer_load_dwordx4 v25, s[20:23], s50 offen offset:3072 lds
    s_add_u32 s50, s50, 0x80000
    s_waitcnt vmcnt(12)
    v_lshlrev_b32 v80, 16, v64
    v_and_b32 v81, 0xffff0000, v64
    v_lshlrev_b32 v82, 16, v65
    v_and_b32 v83, 0xffff0000, v65
    v_lshlrev_b32 v84, 16, v66
    v_and_b32 v85, 0xffff0000, v66
    v_lshlrev_b32 v86, 16, v67
    v_and_b32 v87, 0xffff0000, v67
    v_lshlrev_b32 v88, 16, v68
    v_and_b32 v89, 0xffff0000, v68
    v_lshlrev_b32 v90, 16, v69
    v_and_b32 v91, 0xffff0000, v69
    v_lshlrev_b32 v92, 16, v70
    v_and_b32 v93, 0xffff0000, v70
    v_lshlrev_b32 v94, 16, v71
    v_and_b32 v95, 0xffff0000, v71
    v_lshlrev_b32 v96, 16, v72
    v_and_b32 v97, 0xffff0000, v72
    v_lshlrev_b32 v98, 16, v73
    v_and_b32 v99, 0xffff0000, v73
    v_lshlrev_b32 v100, 16, v74
    v_and_b32 v101, 0xffff0000, v74
    v_lshlrev_b32 v102, 16, v75
    v_and_b32 v103, 0xffff0000, v75
    v_lshlrev_b32 v104, 16, v76
    v_and_b32 v105, 0xffff0000, v76
    v_lshlrev_b32 v106, 16, v77
    v_and_b32 v107, 0xffff0000, v77
    v_lshlrev_b32 v108, 16, v78
    v_and_b32 v109, 0xffff0000, v78
    v_lshlrev_b32 v110, 16, v79
    v_and_b32 v111, 0xffff0000, v79
    v_pk_add_f32 v[112:113], v[80:81], v[82:83]
    v_pk_add_f32 v[114:115], v[84:85], v[86:87]
    v_pk_add_f32 v[112:113], v[112:113], v[88:89]
    v_pk_add_f32 v[114:115], v[114:115], v[90:91]
    v_pk_add_f32 v[112:113], v[112:113], v[92:93]
    v_pk_add_f32 v[114:115], v[114:115], v[94:95]
    v_pk_add_f32 v[112:113], v[112:113], v[96:97]
    v_pk_add_f32 v[114:115], v[114:115], v[98:99]
    v_pk_add_f32 v[112:113], v[112:113], v[100:101]
    v_pk_add_f32 v[114:115], v[114:115], v[102:103]
    v_pk_add_f32 v[112:113], v[112:113], v[104:105]
    v_pk_add_f32 v[114:115], v[114:115], v[106:107]
    s_add_u32 m0, s48, 32768
    s_nop 0
    buffer_load_dwordx4 v10, s[16:19], s49 offen offset:0 lds
    buffer_load_dwordx4 v11, s[16:19], s49 offen offset:1024 lds
    buffer_load_dwordx4 v12, s[16:19], s49 offen offset:2048 lds
    buffer_load_dwordx4 v13, s[16:19], s49 offen offset:3072 lds
    v_pk_add_f32 v[112:113], v[112:113], v[108:109]
    v_pk_add_f32 v[114:115], v[114:115], v[110:111]
    v_pk_add_f32 v[112:113], v[112:113], v[114:115]
    v_add_f32 v112, v112, v113
    s_nop 1
    v_add_f32_dpp v112, v112, v112 quad_perm:[1,0,3,2] row_mask:0xf bank_mask:0xf
    s_nop 1
    v_add_f32_dpp v112, v112, v112 quad_perm:[2,3,0,1] row_mask:0xf bank_mask:0xf
    s_nop 1
    v_add_f32_dpp v112, v112, v112 row_half_mirror row_mask:0xf bank_mask:0xf
    s_nop 1
    v_add_f32_dpp v112, v112, v112 row_mirror row_mask:0xf bank_mask:0xf
    v_mov_b32 v114, v112
    s_nop 1
    v_permlane16_swap_b32 v112, v114
    s_nop 1
    v_add_f32 v112, v112, v114
    v_mul_f32 v112, 0xba800000, v112
    v_mov_b32 v113, v112
    v_pk_add_f32 v[114:115], v[80:81], v[112:113]
    v_pk_add_f32 v[118:119], v[82:83], v[112:113]
    v_pk_mul_f32 v[116:117], v[114:115], v[114:115]
    v_pk_fma_f32 v[116:117], v[118:119], v[118:119], v[116:117]
    v_pk_add_f32 v[114:115], v[84:85], v[112:113]
    v_pk_add_f32 v[118:119], v[86:87], v[112:113]
    v_pk_fma_f32 v[116:117], v[114:115], v[114:115], v[116:117]
    v_pk_fma_f32 v[116:117], v[118:119], v[118:119], v[116:117]
    v_pk_add_f32 v[114:115], v[88:89], v[112:113]
    v_pk_add_f32 v[118:119], v[90:91], v[112:113]
    v_pk_fma_f32 v[116:117], v[114:115], v[114:115], v[116:117]
    v_pk_fma_f32 v[116:117], v[118:119], v[118:119], v[116:117]
    v_pk_add_f32 v[114:115], v[92:93], v[112:113]
    v_pk_add_f32 v[118:119], v[94:95], v[112:113]
    v_pk_fma_f32 v[116:117], v[114:115], v[114:115], v[116:117]
    v_pk_fma_f32 v[116:117], v[118:119], v[118:119], v[116:117]
    v_pk_add_f32 v[114:115], v[96:97], v[112:113]
    v_pk_add_f32 v[118:119], v[98:99], v[112:113]
    v_pk_fma_f32 v[116:117], v[114:115], v[114:115], v[116:117]
    v_pk_fma_f32 v[116:117], v[118:119], v[118:119], v[116:117]
    v_pk_add_f32 v[114:115], v[100:101], v[112:113]
    v_pk_add_f32 v[118:119], v[102:103], v[112:113]
    v_pk_fma_f32 v[116:117], v[114:115], v[114:115], v[116:117]
    v_pk_fma_f32 v[116:117], v[118:119], v[118:119], v[116:117]
    v_pk_add_f32 v[114:115], v[104:105], v[112:113]
    s_add_u32 m0, s48, 98304
    s_nop 0
    buffer_load_dwordx4 v18, s[20:23], s50 offen offset:0 lds
    buffer_load_dwordx4 v19, s[20:23], s50 offen offset:1024 lds
    buffer_load_dwordx4 v20, s[20:23], s50 offen offset:2048 lds
    buffer_load_dwordx4 v21, s[20:23], s50 offen offset:3072 lds
    v_pk_add_f32 v[118:119], v[106:107], v[112:113]
    v_pk_fma_f32 v[116:117], v[114:115], v[114:115], v[116:117]
    v_pk_fma_f32 v[116:117], v[118:119], v[118:119], v[116:117]
    v_pk_add_f32 v[114:115], v[108:109], v[112:113]
    v_pk_add_f32 v[118:119], v[110:111], v[112:113]
    v_pk_fma_f32 v[116:117], v[114:115], v[114:115], v[116:117]
    v_pk_fma_f32 v[116:117], v[118:119], v[118:119], v[116:117]
    v_add_f32 v116, v116, v117
    s_nop 1
    v_add_f32_dpp v116, v116, v116 quad_perm:[1,0,3,2] row_mask:0xf bank_mask:0xf
    s_nop 1
    v_add_f32_dpp v116, v116, v116 quad_perm:[2,3,0,1] row_mask:0xf bank_mask:0xf
    s_nop 1
    v_add_f32_dpp v116, v116, v116 row_half_mirror row_mask:0xf bank_mask:0xf
    s_nop 1
    v_add_f32_dpp v116, v116, v116 row_mirror row_mask:0xf bank_mask:0xf
    v_mov_b32 v114, v116
    s_nop 1
    v_permlane16_swap_b32 v116, v114
    s_nop 1
    v_add_f32 v116, v116, v114
    v_mul_f32 v116, 0x3a800000, v116
    v_cvt_pk_bf16_f32 v118, v112, v116
    v_and_b32 v116, 0xffff0000, v118
    v_lshlrev_b32 v118, 16, v118
    v_add_f32 v116, 0x3727c5ac, v116
    v_mov_b32 v119, v118
    v_cvt_pk_bf16_f32 v116, v116, v116
    v_and_b32 v116, 0xffff0000, v116
    v_sqrt_f32 v116, v116
    v_pk_add_f32 v[80:81], v[80:81], v[118:119]
    v_pk_add_f32 v[82:83], v[82:83], v[118:119]
    v_pk_add_f32 v[84:85], v[84:85], v[118:119]
    v_pk_add_f32 v[86:87], v[86:87], v[118:119]
    v_pk_add_f32 v[88:89], v[88:89], v[118:119]
    v_pk_add_f32 v[90:91], v[90:91], v[118:119]
    v_pk_add_f32 v[92:93], v[92:93], v[118:119]
    v_pk_add_f32 v[94:95], v[94:95], v[118:119]
    v_pk_add_f32 v[96:97], v[96:97], v[118:119]
    v_pk_add_f32 v[98:99], v[98:99], v[118:119]
    v_pk_add_f32 v[100:101], v[100:101], v[118:119]
    v_pk_add_f32 v[102:103], v[102:103], v[118:119]
    v_pk_add_f32 v[104:105], v[104:105], v[118:119]
    s_add_u32 m0, s48, 36864
    s_nop 0
    buffer_load_dwordx4 v14, s[16:19], s49 offen offset:0 lds
    buffer_load_dwordx4 v15, s[16:19], s49 offen offset:1024 lds
    buffer_load_dwordx4 v16, s[16:19], s49 offen offset:2048 lds
    buffer_load_dwordx4 v17, s[16:19], s49 offen offset:3072 lds
    s_add_u32 s49, s49, 128
    v_pk_add_f32 v[106:107], v[106:107], v[118:119]
    v_pk_add_f32 v[108:109], v[108:109], v[118:119]
    v_pk_add_f32 v[110:111], v[110:111], v[118:119]
    v_cvt_pk_bf16_f32 v116, v116, v116
    v_and_b32 v116, 0xffff0000, v116
    v_rcp_f32 v116, v116
    v_cvt_pk_bf16_f32 v64, v80, v81
    v_cvt_pk_bf16_f32 v65, v82, v83
    v_cvt_pk_bf16_f32 v66, v84, v85
    v_cvt_pk_bf16_f32 v67, v86, v87
    v_cvt_pk_bf16_f32 v68, v88, v89
    v_cvt_pk_bf16_f32 v69, v90, v91
    v_cvt_pk_bf16_f32 v70, v92, v93
    v_cvt_pk_bf16_f32 v71, v94, v95
    v_cvt_pk_bf16_f32 v72, v96, v97
    v_cvt_pk_bf16_f32 v73, v98, v99
    v_cvt_pk_bf16_f32 v74, v100, v101
    v_cvt_pk_bf16_f32 v75, v102, v103
    v_cvt_pk_bf16_f32 v76, v104, v105
    v_cvt_pk_bf16_f32 v77, v106, v107
    v_cvt_pk_bf16_f32 v78, v108, v109
    v_cvt_pk_bf16_f32 v79, v110, v111
    v_mov_b32 v117, v116
    v_lshlrev_b32 v80, 16, v64
    v_and_b32 v81, 0xffff0000, v64
    v_lshlrev_b32 v82, 16, v65
    v_and_b32 v83, 0xffff0000, v65
    v_lshlrev_b32 v84, 16, v66
    v_and_b32 v85, 0xffff0000, v66
    v_lshlrev_b32 v86, 16, v67
    v_and_b32 v87, 0xffff0000, v67
    v_lshlrev_b32 v88, 16, v68
    v_and_b32 v89, 0xffff0000, v68
    v_lshlrev_b32 v90, 16, v69
    v_and_b32 v91, 0xffff0000, v69
    v_lshlrev_b32 v92, 16, v70
    v_and_b32 v93, 0xffff0000, v70
    v_lshlrev_b32 v94, 16, v71
    v_and_b32 v95, 0xffff0000, v71
    v_lshlrev_b32 v96, 16, v72
    v_and_b32 v97, 0xffff0000, v72
    v_lshlrev_b32 v98, 16, v73
    v_and_b32 v99, 0xffff0000, v73
    v_lshlrev_b32 v100, 16, v74
    s_add_u32 m0, s48, 102400
    s_nop 0
    buffer_load_dwordx4 v22, s[20:23], s50 offen offset:0 lds
    buffer_load_dwordx4 v23, s[20:23], s50 offen offset:1024 lds
    buffer_load_dwordx4 v24, s[20:23], s50 offen offset:2048 lds
    buffer_load_dwordx4 v25, s[20:23], s50 offen offset:3072 lds
    s_add_u32 s50, s50, 0x80000
    v_and_b32 v101, 0xffff0000, v74
    v_lshlrev_b32 v102, 16, v75
    v_and_b32 v103, 0xffff0000, v75
    v_lshlrev_b32 v104, 16, v76
    v_and_b32 v105, 0xffff0000, v76
    v_lshlrev_b32 v106, 16, v77
    v_and_b32 v107, 0xffff0000, v77
    v_lshlrev_b32 v108, 16, v78
    v_and_b32 v109, 0xffff0000, v78
    v_lshlrev_b32 v110, 16, v79
    v_and_b32 v111, 0xffff0000, v79
    v_pk_mul_f32 v[80:81], v[80:81], v[116:117]
    v_pk_mul_f32 v[82:83], v[82:83], v[116:117]
    v_pk_mul_f32 v[84:85], v[84:85], v[116:117]
    v_pk_mul_f32 v[86:87], v[86:87], v[116:117]
    v_pk_mul_f32 v[88:89], v[88:89], v[116:117]
    v_pk_mul_f32 v[90:91], v[90:91], v[116:117]
    v_pk_mul_f32 v[92:93], v[92:93], v[116:117]
    v_pk_mul_f32 v[94:95], v[94:95], v[116:117]
    v_pk_mul_f32 v[96:97], v[96:97], v[116:117]
    v_pk_mul_f32 v[98:99], v[98:99], v[116:117]
    v_pk_mul_f32 v[100:101], v[100:101], v[116:117]
    v_pk_mul_f32 v[102:103], v[102:103], v[116:117]
    v_pk_mul_f32 v[104:105], v[104:105], v[116:117]
    v_pk_mul_f32 v[106:107], v[106:107], v[116:117]
    v_pk_mul_f32 v[108:109], v[108:109], v[116:117]
    v_pk_mul_f32 v[110:111], v[110:111], v[116:117]
    v_cvt_pk_bf16_f32 v64, v80, v81
    v_cvt_pk_bf16_f32 v65, v82, v83
    v_cvt_pk_bf16_f32 v66, v84, v85
    v_cvt_pk_bf16_f32 v67, v86, v87
    v_cvt_pk_bf16_f32 v68, v88, v89
    v_cvt_pk_bf16_f32 v69, v90, v91
    v_cvt_pk_bf16_f32 v70, v92, v93
    v_cvt_pk_bf16_f32 v71, v94, v95
    v_cvt_pk_bf16_f32 v72, v96, v97
    v_cvt_pk_bf16_f32 v73, v98, v99
    v_cvt_pk_bf16_f32 v74, v100, v101
    v_cvt_pk_bf16_f32 v75, v102, v103
    v_cvt_pk_bf16_f32 v76, v104, v105
    v_cvt_pk_bf16_f32 v77, v106, v107
    v_cvt_pk_bf16_f32 v78, v108, v109
    v_cvt_pk_bf16_f32 v79, v110, v111
    ds_write_b128 v54, v[64:67] offset:0
    ds_write_b128 v54, v[68:71] offset:512
    ds_write_b128 v54, v[72:75] offset:1024
    ds_write_b128 v54, v[76:79] offset:1536
    s_waitcnt vmcnt(16) lgkmcnt(0)
    s_barrier
    ds_read_b128 a[64:67], v55 offset:0
    ds_read_b128 a[68:71], v55 offset:128
    ds_read_b128 a[72:75], v55 offset:256
    ds_read_b128 a[76:79], v55 offset:384
    v_add_u32 v54, 4096, v36
    v_add_u32 v55, 4096, v37
    v_mfma_f32_32x32x16_bf16 v[64:79], v[56:59], v[56:59], 0
    v_mfma_f32_32x32x16_bf16 v[80:95], v[56:59], v[56:59], 0
    v_mfma_f32_32x32x16_bf16 v[96:111], v[56:59], v[56:59], 0
    v_mfma_f32_32x32x16_bf16 v[112:127], v[56:59], v[56:59], 0
    s_cmp_ge_u32 s2, 22
    s_cbranch_scc1 k12_nostat_5
    s_lshl_b32 s52, s2, 12
    s_add_u32 s52, s52, 0x3800000
    s_mov_b32 s34, -1
    v_lshlrev_b32 v6, 4, v0
    buffer_store_dwordx4 v[56:59], v6, s[32:35], s52 offen sc1
    s_mov_b32 s34, 0x2000000
k12_nostat_5:
    ds_read_b128 a[192:195], v26 offset:0
    ds_read_b64_tr_b16 a[0:1], v28 offset:0
    ds_read_b128 a[196:199], v27 offset:0
    ds_read_b64_tr_b16 a[2:3], v28 offset:2048
    ds_read_b128 a[200:203], v26 offset:2048
    ds_read_b64_tr_b16 a[4:5], v28 offset:16384
    ds_read_b128 a[204:207], v27 offset:2048
    ds_read_b64_tr_b16 a[6:7], v28 offset:18432
    ds_read_b128 a[208:211], v26 offset:4096
    ds_read_b64_tr_b16 a[8:9], v29 offset:0
    ds_read_b128 a[212:215], v27 offset:4096
    ds_read_b64_tr_b16 a[10:11], v29 offset:2048
    ds_read_b128 a[216:219], v26 offset:6144
    ds_read_b64_tr_b16 a[12:13], v29 offset:16384
    ds_read_b128 a[220:223], v27 offset:6144
    ds_read_b64_tr_b16 a[14:15], v29 offset:18432
    ds_read_b128 a[224:227], v26 offset:8192
    ds_read_b64_tr_b16 a[16:17], v30 offset:0
    ds_read_b128 a[228:231], v27 offset:8192
    ds_read_b64_tr_b16 a[18:19], v30 offset:2048
    ds_read_b128 a[232:235], v26 offset:10240
    ds_read_b64_tr_b16 a[20:21], v30 offset:16384
    ds_read_b128 a[236:239], v27 offset:10240
    ds_read_b64_tr_b16 a[22:23], v30 offset:18432
    ds_read_b128 a[240:243], v26 offset:12288
    ds_read_b64_tr_b16 a[24:25], v31 offset:0
    ds_read_b128 a[244:247], v27 offset:12288
    ds_read_b64_tr_b16 a[26:27], v31 offset:2048
    ds_read_b128 a[248:251], v26 offset:14336
    ds_read_b64_tr_b16 a[28:29], v31 offset:16384
    ds_read_b128 a[252:255], v27 offset:14336
    ds_read_b64_tr_b16 a[30:31], v31 offset:18432
    s_mov_b32 s51, 0
    s_waitcnt lgkmcnt(15)
    s_mov_b32 s52, 0
    buffer_store_dwordx4 a[64:67], v53, s[8:11], s52 offen sc1
    s_mov_b32 s52, 262144
    buffer_store_dwordx4 a[68:71], v53, s[8:11], s52 offen sc1
    s_mov_b32 s52, 524288
    buffer_store_dwordx4 a[72:75], v53, s[8:11], s52 offen sc1
    s_mov_b32 s52, 786432
    buffer_store_dwordx4 a[76:79], v53, s[8:11], s52 offen sc1
    s_waitcnt lgkmcnt(0)
    s_cmp_lg_u32 s57, 0
    s_cbranch_scc1 k12_v_6
k12_loop_8:
    v_mfma_f32_16x16x32_bf16 v[64:67], a[0:3], a[192:195], v[64:67]
    v_mfma_f32_16x16x32_bf16 v[64:67], a[4:7], a[196:199], v[64:67]
    ds_read_b64_tr_b16 a[32:33], v32 offset:0
    v_mfma_f32_16x16x32_bf16 v[80:83], a[4:7], a[204:207], v[80:83]
    v_mfma_f32_16x16x32_bf16 v[80:83], a[0:3], a[200:203], v[80:83]
    ds_read_b64_tr_b16 a[34:35], v32 offset:2048
    v_mfma_f32_16x16x32_bf16 v[96:99], a[0:3], a[208:211], v[96:99]
    s_cmp_eq_u32 s51, s46
    s_cbranch_scc1 k12_ool_10
k12_oolret_11:
    v_mfma_f32_16x16x32_bf16 v[96:99], a[4:7], a[212:215], v[96:99]
    v_mfma_f32_16x16x32_bf16 v[112:115], a[4:7], a[220:223], v[112:115]
    ds_read_b64_tr_b16 a[36:37], v32 offset:16384
    v_mfma_f32_16x16x32_bf16 v[112:115], a[0:3], a[216:219], v[112:115]
    v_mfma_f32_16x16x32_bf16 v[128:131], a[0:3], a[224:227], v[128:131]
    v_mfma_f32_16x16x32_bf16 v[128:131], a[4:7], a[228:231], v[128:131]
    ds_read_b64_tr_b16 a[38:39], v32 offset:18432
    v_mfma_f32_16x16x32_bf16 v[144:147], a[4:7], a[236:239], v[144:147]
    v_mfma_f32_16x16x32_bf16 v[144:147], a[0:3], a[232:235], v[144:147]
    v_mfma_f32_16x16x32_bf16 a[128:131], a[0:3], a[240:243], a[128:131]
    ds_read_b64_tr_b16 a[40:41], v33 offset:0
    v_mfma_f32_16x16x32_bf16 a[128:131], a[4:7], a[244:247], a[128:131]
    v_mfma_f32_16x16x32_bf16 a[160:163], a[4:7], a[252:255], a[160:163]
    v_mfma_f32_16x16x32_bf16 a[160:163], a[0:3], a[248:251], a[160:163]
    ds_read_b64_tr_b16 a[42:43], v33 offset:2048
    v_mfma_f32_16x16x32_bf16 a[164:167], a[8:11], a[248:251], a[164:167]
    v_mfma_f32_16x16x32_bf16 a[164:167], a[12:15], a[252:255], a[164:167]
    v_mfma_f32_16x16x32_bf16 a[132:135], a[12:15], a[244:247], a[132:135]
    ds_read_b64_tr_b16 a[44:45], v33 offset:16384
    v_mfma_f32_16x16x32_bf16 a[132:135], a[8:11], a[240:243], a[132:135]
    v_mfma_f32_16x16x32_bf16 v[240:243], a[8:11], a[232:235], v[240:243]
    v_mfma_f32_16x16x32_bf16 v[240:243], a[12:15], a[236:239], v[240:243]
    ds_read_b64_tr_b16 a[46:47], v33 offset:18432
    v_mfma_f32_16x16x32_bf16 v[224:227], a[12:15], a[228:231], v[224:227]
    v_mfma_f32_16x16x32_bf16 v[224:227], a[8:11], a[224:227], v[224:227]
    ds_read_b64_tr_b16 a[48:49], v34 offset:0
    v_mfma_f32_16x16x32_bf16 v[208:211], a[8:11], a[216:219], v[208:211]
    v_mfma_f32_16x16x32_bf16 v[208:211], a[12:15], a[220:223], v[208:211]
    v_mfma_f32_16x16x32_bf16 v[192:195], a[12:15], a[212:215], v[192:195]
    ds_read_b64_tr_b16 a[50:51], v34 offset:2048
    v_mfma_f32_16x16x32_bf16 v[192:195], a[8:11], a[208:211], v[192:195]
    v_mfma_f32_16x16x32_bf16 v[176:179], a[8:11], a[200:203], v[176:179]
    v_mfma_f32_16x16x32_bf16 v[176:179], a[12:15], a[204:207], v[176:179]
    ds_read_b64_tr_b16 a[52:53], v34 offset:16384
    v_mfma_f32_16x16x32_bf16 v[160:163], a[12:15], a[196:199], v[160:163]
    v_mfma_f32_16x16x32_bf16 v[160:163], a[8:11], a[192:195], v[160:163]
    v_mfma_f32_16x16x32_bf16 v[68:71], a[16:19], a[192:195], v[68:71]
    ds_read_b64_tr_b16 a[54:55], v34 offset:18432
    v_mfma_f32_16x16x32_bf16 v[68:71], a[20:23], a[196:199], v[68:71]
    v_mfma_f32_16x16x32_bf16 v[84:87], a[20:23], a[204:207], v[84:87]
    v_mfma_f32_16x16x32_bf16 v[84:87], a[16:19], a[200:203], v[84:87]
    ds_read_b64_tr_b16 a[56:57], v35 offset:0
    v_mfma_f32_16x16x32_bf16 v[100:103], a[16:19], a[208:211], v[100:103]
    v_mfma_f32_16x16x32_bf16 v[100:103], a[20:23], a[212:215], v[100:103]
    v_mfma_f32_16x16x32_bf16 v[116:119], a[20:23], a[220:223], v[116:119]
    ds_read_b64_tr_b16 a[58:59], v35 offset:2048
    v_mfma_f32_16x16x32_bf16 v[116:119], a[16:19], a[216:219], v[116:119]
    v_mfma_f32_16x16x32_bf16 v[132:135], a[16:19], a[224:227], v[132:135]
    v_mfma_f32_16x16x32_bf16 v[132:135], a[20:23], a[228:231], v[132:135]
    ds_read_b64_tr_b16 a[60:61], v35 offset:16384
    v_mfma_f32_16x16x32_bf16 v[148:151], a[20:23], a[236:239], v[148:151]
    v_mfma_f32_16x16x32_bf16 v[148:151], a[16:19], a[232:235], v[148:151]
    v_mfma_f32_16x16x32_bf16 a[136:139], a[16:19], a[240:243], a[136:139]
    ds_read_b64_tr_b16 a[62:63], v35 offset:18432
    v_mfma_f32_16x16x32_bf16 a[136:139], a[20:23], a[244:247], a[136:139]
    v_mfma_f32_16x16x32_bf16 a[168:171], a[20:23], a[252:255], a[168:171]
    v_mfma_f32_16x16x32_bf16 a[168:171], a[16:19], a[248:251], a[168:171]
    v_mfma_f32_16x16x32_bf16 a[172:175], a[24:27], a[248:251], a[172:175]
    v_mfma_f32_16x16x32_bf16 a[172:175], a[28:31], a[252:255], a[172:175]
    v_mfma_f32_16x16x32_bf16 a[140:143], a[28:31], a[244:247], a[140:143]
    v_mfma_f32_16x16x32_bf16 a[140:143], a[24:27], a[240:243], a[140:143]
    v_mfma_f32_16x16x32_bf16 v[244:247], a[24:27], a[232:235], v[244:247]
    v_mfma_f32_16x16x32_bf16 v[244:247], a[28:31], a[236:239], v[244:247]
    v_mfma_f32_16x16x32_bf16 v[228:231], a[28:31], a[228:231], v[228:231]
    v_mfma_f32_16x16x32_bf16 v[228:231], a[24:27], a[224:227], v[228:231]
    v_mfma_f32_16x16x32_bf16 v[212:215], a[24:27], a[216:219], v[212:215]
    v_mfma_f32_16x16x32_bf16 v[212:215], a[28:31], a[220:223], v[212:215]
    v_mfma_f32_16x16x32_bf16 v[196:199], a[28:31], a[212:215], v[196:199]
    v_mfma_f32_16x16x32_bf16 v[196:199], a[24:27], a[208:211], v[196:199]
    v_mfma_f32_16x16x32_bf16 v[180:183], a[24:27], a[200:203], v[180:183]
    v_mfma_f32_16x16x32_bf16 v[180:183], a[28:31], a[204:207], v[180:183]
    v_mfma_f32_16x16x32_bf16 v[164:167], a[28:31], a[196:199], v[164:167]
    v_mfma_f32_16x16x32_bf16 v[164:167], a[24:27], a[192:195], v[164:167]
    s_waitcnt vmcnt(0) lgkmcnt(0)
    s_cmp_eq_u32 s51, s46
    s_cbranch_scc1 k12_ool_14
k12_oolret_15:
    s_barrier
    v_mfma_f32_16x16x32_bf16 v[72:75], a[32:35], a[192:195], v[72:75]
    s_cmp_ge_u32 s49, 1024
    s_cselect_b32 s18, 0, s18
    s_cselect_b32 s22, 0, s22
    v_mfma_f32_16x16x32_bf16 v[72:75], a[36:39], a[196:199], v[72:75]
    s_add_u32 m0, s48, 0
    ds_read_b128 a[64:67], v26 offset:32768
    v_mfma_f32_16x16x32_bf16 v[88:91], a[36:39], a[204:207], v[88:91]
    buffer_load_dwordx4 v10, s[16:19], s49 offen offset:0 lds
    ds_read_b64_tr_b16 a[0:1], v28 offset:32768
    v_mfma_f32_16x16x32_bf16 v[88:91], a[32:35], a[200:203], v[88:91]
    ds_read_b128 a[68:71], v27 offset:32768
    v_mfma_f32_16x16x32_bf16 v[104:107], a[32:35], a[208:211], v[104:107]
    buffer_load_dwordx4 v11, s[16:19], s49 offen offset:1024 lds
    v_mfma_f32_16x16x32_bf16 v[104:107], a[36:39], a[212:215], v[104:107]
    ds_read_b64_tr_b16 a[2:3], v28 offset:34816
    v_mfma_f32_16x16x32_bf16 v[120:123], a[36:39], a[220:223], v[120:123]
    v_mfma_f32_16x16x32_bf16 v[120:123], a[32:35], a[216:219], v[120:123]
    ds_read_b128 a[72:75], v26 offset:34816
    v_mfma_f32_16x16x32_bf16 v[136:139], a[32:35], a[224:227], v[136:139]
    buffer_load_dwordx4 v12, s[16:19], s49 offen offset:2048 lds
    ds_read_b64_tr_b16 a[4:5], v28 offset:49152
    v_mfma_f32_16x16x32_bf16 v[136:139], a[36:39], a[228:231], v[136:139]
    v_mfma_f32_16x16x32_bf16 v[152:155], a[36:39], a[236:239], v[152:155]
    ds_read_b128 a[76:79], v27 offset:34816
    v_mfma_f32_16x16x32_bf16 v[152:155], a[32:35], a[232:235], v[152:155]
    buffer_load_dwordx4 v13, s[16:19], s49 offen offset:3072 lds
    v_mfma_f32_16x16x32_bf16 a[144:147], a[32:35], a[240:243], a[144:147]
    ds_read_b64_tr_b16 a[6:7], v28 offset:51200
    v_mfma_f32_16x16x32_bf16 a[144:147], a[36:39], a[244:247], a[144:147]
    s_add_u32 m0, s48, 4096
    ds_read_b128 a[80:83], v26 offset:36864
    v_mfma_f32_16x16x32_bf16 a[176:179], a[36:39], a[252:255], a[176:179]
    v_mfma_f32_16x16x32_bf16 a[176:179], a[32:35], a[248:251], a[176:179]
    buffer_load_dwordx4 v14, s[16:19], s49 offen offset:0 lds
    ds_read_b64_tr_b16 a[8:9], v29 offset:32768
    v_mfma_f32_16x16x32_bf16 a[180:183], a[40:43], a[248:251], a[180:183]
    v_mfma_f32_16x16x32_bf16 a[180:183], a[44:47], a[252:255], a[180:183]
    ds_read_b128 a[84:87], v27 offset:36864
    v_mfma_f32_16x16x32_bf16 a[148:151], a[44:47], a[244:247], a[148:151]
    buffer_load_dwordx4 v15, s[16:19], s49 offen offset:1024 lds
    ds_read_b64_tr_b16 a[10:11], v29 offset:34816
    v_mfma_f32_16x16x32_bf16 a[148:151], a[40:43], a[240:243], a[148:151]
    v_mfma_f32_16x16x32_bf16 v[248:251], a[40:43], a[232:235], v[248:251]
    ds_read_b128 a[88:91], v26 offset:38912
    v_mfma_f32_16x16x32_bf16 v[248:251], a[44:47], a[236:239], v[248:251]
    v_mfma_f32_16x16x32_bf16 v[232:235], a[44:47], a[228:231], v[232:235]
    buffer_load_dwordx4 v16, s[16:19], s49 offen offset:2048 lds
    ds_read_b64_tr_b16 a[12:13], v29 offset:49152
    v_mfma_f32_16x16x32_bf16 v[232:235], a[40:43], a[224:227], v[232:235]
    ds_read_b128 a[92:95], v27 offset:38912
    v_mfma_f32_16x16x32_bf16 v[216:219], a[40:43], a[216:219], v[216:219]
    v_mfma_f32_16x16x32_bf16 v[216:219], a[44:47], a[220:223], v[216:219]
    buffer_load_dwordx4 v17, s[16:19], s49 offen offset:3072 lds
    ds_read_b64_tr_b16 a[14:15], v29 offset:51200
    v_mfma_f32_16x16x32_bf16 v[200:203], a[44:47], a[212:215], v[200:203]
    ds_read_b128 a[96:99], v26 offset:40960
    v_mfma_f32_16x16x32_bf16 v[200:203], a[40:43], a[208:211], v[200:203]
    s_add_u32 s49, s49, 128
    v_mfma_f32_16x16x32_bf16 v[184:187], a[40:43], a[200:203], v[184:187]
    s_add_u32 m0, s48, 65536
    ds_read_b64_tr_b16 a[16:17], v30 offset:32768
    v_mfma_f32_16x16x32_bf16 v[184:187], a[44:47], a[204:207], v[184:187]
    buffer_load_dwordx4 v18, s[20:23], s50 offen offset:0 lds
    v_mfma_f32_16x16x32_bf16 v[168:171], a[44:47], a[196:199], v[168:171]
    ds_read_b128 a[100:103], v27 offset:40960
    v_mfma_f32_16x16x32_bf16 v[168:171], a[40:43], a[192:195], v[168:171]
    ds_read_b64_tr_b16 a[18:19], v30 offset:34816
    v_mfma_f32_16x16x32_bf16 v[76:79], a[48:51], a[192:195], v[76:79]
    buffer_load_dwordx4 v19, s[20:23], s50 offen offset:1024 lds
    v_mfma_f32_16x16x32_bf16 v[76:79], a[52:55], a[196:199], v[76:79]
    ds_read_b128 a[104:107], v26 offset:43008
    v_mfma_f32_16x16x32_bf16 v[92:95], a[52:55], a[204:207], v[92:95]
    v_mfma_f32_16x16x32_bf16 v[92:95], a[48:51], a[200:203], v[92:95]
    buffer_load_dwordx4 v20, s[20:23], s50 offen offset:2048 lds
    ds_read_b64_tr_b16 a[20:21], v30 offset:49152
    v_mfma_f32_16x16x32_bf16 v[108:111], a[48:51], a[208:211], v[108:111]
    ds_read_b128 a[108:111], v27 offset:43008
    v_mfma_f32_16x16x32_bf16 v[108:111], a[52:55], a[212:215], v[108:111]
    v_mfma_f32_16x16x32_bf16 v[124:127], a[52:55], a[220:223], v[124:127]
    ds_read_b64_tr_b16 a[22:23], v30 offset:51200
    v_mfma_f32_16x16x32_bf16 v[124:127], a[48:51], a[216:219], v[124:127]
    buffer_load_dwordx4 v21, s[20:23], s50 offen offset:3072 lds
    v_mfma_f32_16x16x32_bf16 v[140:143], a[48:51], a[224:227], v[140:143]
    s_add_u32 m0, s48, 69632
    ds_read_b128 a[112:115], v26 offset:45056
    v_mfma_f32_16x16x32_bf16 v[140:143], a[52:55], a[228:231], v[140:143]
    ds_read_b64_tr_b16 a[24:25], v31 offset:32768
    v_mfma_f32_16x16x32_bf16 v[156:159], a[52:55], a[236:239], v[156:159]
    buffer_load_dwordx4 v22, s[20:23], s50 offen offset:0 lds
    v_mfma_f32_16x16x32_bf16 v[156:159], a[48:51], a[232:235], v[156:159]
    ds_read_b128 a[116:119], v27 offset:45056
    v_mfma_f32_16x16x32_bf16 a[152:155], a[48:51], a[240:243], a[152:155]
    v_mfma_f32_16x16x32_bf16 a[152:155], a[52:55], a[244:247], a[152:155]
    ds_read_b64_tr_b16 a[26:27], v31 offset:34816
    v_mfma_f32_16x16x32_bf16 a[184:187], a[52:55], a[252:255], a[184:187]
    buffer_load_dwordx4 v23, s[20:23], s50 offen offset:1024 lds
    ds_read_b128 a[120:123], v26 offset:47104
    v_mfma_f32_16x16x32_bf16 a[184:187], a[48:51], a[248:251], a[184:187]
    v_mfma_f32_16x16x32_bf16 a[188:191], a[56:59], a[248:251], a[188:191]
    ds_read_b64_tr_b16 a[28:29], v31 offset:49152
    v_mfma_f32_16x16x32_bf16 a[188:191], a[60:63], a[252:255], a[188:191]
    buffer_load_dwordx4 v24, s[20:23], s50 offen offset:2048 lds
    v_mfma_f32_16x16x32_bf16 a[156:159], a[60:63], a[244:247], a[156:159]
    ds_read_b128 a[124:127], v27 offset:47104
    v_mfma_f32_16x16x32_bf16 a[156:159], a[56:59], a[240:243], a[156:159]
    ds_read_b64_tr_b16 a[30:31], v31 offset:51200
    v_mfma_f32_16x16x32_bf16 v[252:255], a[56:59], a[232:235], v[252:255]
    v_mfma_f32_16x16x32_bf16 v[252:255], a[60:63], a[236:239], v[252:255]
    buffer_load_dwordx4 v25, s[20:23], s50 offen offset:3072 lds
    v_mfma_f32_16x16x32_bf16 v[236:239], a[60:63], a[228:231], v[236:239]
    v_mfma_f32_16x16x32_bf16 v[236:239], a[56:59], a[224:227], v[236:239]
    s_add_u32 s50, s50, 0x80000
    v_mfma_f32_16x16x32_bf16 v[220:223], a[56:59], a[216:219], v[220:223]
    v_mfma_f32_16x16x32_bf16 v[220:223], a[60:63], a[220:223], v[220:223]
    s_cmp_eq_u32 s51, s53
    s_cbranch_scc1 k12_ool_16
k12_oolret_17:
    v_mfma_f32_16x16x32_bf16 v[204:207], a[60:63], a[212:215], v[204:207]
    s_cmp_eq_u32 s51, s63
    s_cbranch_scc1 k12_ool_18
k12_oolret_19:
    v_mfma_f32_16x16x32_bf16 v[204:207], a[56:59], a[208:211], v[204:207]
    s_cmp_eq_u32 s51, 6
    s_cbranch_scc1 k12_ool_20
k12_oolret_21:
    v_mfma_f32_16x16x32_bf16 v[188:191], a[56:59], a[200:203], v[188:191]
    v_mfma_f32_16x16x32_bf16 v[188:191], a[60:63], a[204:207], v[188:191]
    s_add_u32 s51, s51, 1
    v_mfma_f32_16x16x32_bf16 v[172:175], a[60:63], a[196:199], v[172:175]
    v_mfma_f32_16x16x32_bf16 v[172:175], a[56:59], a[192:195], v[172:175]
    s_waitcnt lgkmcnt(0)
    s_cmp_eq_u32 s51, 7
    s_cbranch_scc1 k12_last_9
    v_mfma_f32_16x16x32_bf16 v[64:67], a[0:3], a[64:67], v[64:67]
    v_mfma_f32_16x16x32_bf16 v[64:67], a[4:7], a[68:71], v[64:67]
    ds_read_b64_tr_b16 a[32:33], v32 offset:32768
    v_mfma_f32_16x16x32_bf16 v[80:83], a[4:7], a[76:79], v[80:83]
    v_mfma_f32_16x16x32_bf16 v[80:83], a[0:3], a[72:75], v[80:83]
    ds_read_b64_tr_b16 a[34:35], v32 offset:34816
    v_mfma_f32_16x16x32_bf16 v[96:99], a[0:3], a[80:83], v[96:99]
    v_mfma_f32_16x16x32_bf16 v[96:99], a[4:7], a[84:87], v[96:99]
    v_mfma_f32_16x16x32_bf16 v[112:115], a[4:7], a[92:95], v[112:115]
    ds_read_b64_tr_b16 a[36:37], v32 offset:49152
    v_mfma_f32_16x16x32_bf16 v[112:115], a[0:3], a[88:91], v[112:115]
    v_mfma_f32_16x16x32_bf16 v[128:131], a[0:3], a[96:99], v[128:131]
    v_mfma_f32_16x16x32_bf16 v[128:131], a[4:7], a[100:103], v[128:131]
    ds_read_b64_tr_b16 a[38:39], v32 offset:51200
    v_mfma_f32_16x16x32_bf16 v[144:147], a[4:7], a[108:111], v[144:147]
    v_mfma_f32_16x16x32_bf16 v[144:147], a[0:3], a[104:107], v[144:147]
    v_mfma_f32_16x16x32_bf16 a[128:131], a[0:3], a[112:115], a[128:131]
    ds_read_b64_tr_b16 a[40:41], v33 offset:32768
    v_mfma_f32_16x16x32_bf16 a[128:131], a[4:7], a[116:119], a[128:131]
    v_mfma_f32_16x16x32_bf16 a[160:163], a[4:7], a[124:127], a[160:163]
    v_mfma_f32_16x16x32_bf16 a[160:163], a[0:3], a[120:123], a[160:163]
    ds_read_b64_tr_b16 a[42:43], v33 offset:34816
    v_mfma_f32_16x16x32_bf16 a[164:167], a[8:11], a[120:123], a[164:167]
    v_mfma_f32_16x16x32_bf16 a[164:167], a[12:15], a[124:127], a[164:167]
    v_mfma_f32_16x16x32_bf16 a[132:135], a[12:15], a[116:119], a[132:135]
    ds_read_b64_tr_b16 a[44:45], v33 offset:49152
    v_mfma_f32_16x16x32_bf16 a[132:135], a[8:11], a[112:115], a[132:135]
    v_mfma_f32_16x16x32_bf16 v[240:243], a[8:11], a[104:107], v[240:243]
    v_mfma_f32_16x16x32_bf16 v[240:243], a[12:15], a[108:111], v[240:243]
    ds_read_b64_tr_b16 a[46:47], v33 offset:51200
    v_mfma_f32_16x16x32_bf16 v[224:227], a[12:15], a[100:103], v[224:227]
    v_mfma_f32_16x16x32_bf16 v[224:227], a[8:11], a[96:99], v[224:227]
    ds_read_b64_tr_b16 a[48:49], v34 offset:32768
    v_mfma_f32_16x16x32_bf16 v[208:211], a[8:11], a[88:91], v[208:211]
    v_mfma_f32_16x16x32_bf16 v[208:211], a[12:15], a[92:95], v[208:211]
    v_mfma_f32_16x16x32_bf16 v[192:195], a[12:15], a[84:87], v[192:195]
    ds_read_b64_tr_b16 a[50:51], v34 offset:34816
    v_mfma_f32_16x16x32_bf16 v[192:195], a[8:11], a[80:83], v[192:195]
    v_mfma_f32_16x16x32_bf16 v[176:179], a[8:11], a[72:75], v[176:179]
    v_mfma_f32_16x16x32_bf16 v[176:179], a[12:15], a[76:79], v[176:179]
    ds_read_b64_tr_b16 a[52:53], v34 offset:49152
    v_mfma_f32_16x16x32_bf16 v[160:163], a[12:15], a[68:71], v[160:163]
    v_mfma_f32_16x16x32_bf16 v[160:163], a[8:11], a[64:67], v[160:163]
    v_mfma_f32_16x16x32_bf16 v[68:71], a[16:19], a[64:67], v[68:71]
    ds_read_b64_tr_b16 a[54:55], v34 offset:51200
    v_mfma_f32_16x16x32_bf16 v[68:71], a[20:23], a[68:71], v[68:71]
    v_mfma_f32_16x16x32_bf16 v[84:87], a[20:23], a[76:79], v[84:87]
    v_mfma_f32_16x16x32_bf16 v[84:87], a[16:19], a[72:75], v[84:87]
    ds_read_b64_tr_b16 a[56:57], v35 offset:32768
    v_mfma_f32_16x16x32_bf16 v[100:103], a[16:19], a[80:83], v[100:103]
    v_mfma_f32_16x16x32_bf16 v[100:103], a[20:23], a[84:87], v[100:103]
    v_mfma_f32_16x16x32_bf16 v[116:119], a[20:23], a[92:95], v[116:119]
    ds_read_b64_tr_b16 a[58:59], v35 offset:34816
    v_mfma_f32_16x16x32_bf16 v[116:119], a[16:19], a[88:91], v[116:119]
    v_mfma_f32_16x16x32_bf16 v[132:135], a[16:19], a[96:99], v[132:135]
    v_mfma_f32_16x16x32_bf16 v[132:135], a[20:23], a[100:103], v[132:135]
    ds_read_b64_tr_b16 a[60:61], v35 offset:49152
    v_mfma_f32_16x16x32_bf16 v[148:151], a[20:23], a[108:111], v[148:151]
    v_mfma_f32_16x16x32_bf16 v[148:151], a[16:19], a[104:107], v[148:151]
    v_mfma_f32_16x16x32_bf16 a[136:139], a[16:19], a[112:115], a[136:139]
    ds_read_b64_tr_b16 a[62:63], v35 offset:51200
    v_mfma_f32_16x16x32_bf16 a[136:139], a[20:23], a[116:119], a[136:139]
    v_mfma_f32_16x16x32_bf16 a[168:171], a[20:23], a[124:127], a[168:171]
    v_mfma_f32_16x16x32_bf16 a[168:171], a[16:19], a[120:123], a[168:171]
    v_mfma_f32_16x16x32_bf16 a[172:175], a[24:27], a[120:123], a[172:175]
    v_mfma_f32_16x16x32_bf16 a[172:175], a[28:31], a[124:127], a[172:175]
    v_mfma_f32_16x16x32_bf16 a[140:143], a[28:31], a[116:119], a[140:143]
    v_mfma_f32_16x16x32_bf16 a[140:143], a[24:27], a[112:115], a[140:143]
    v_mfma_f32_16x16x32_bf16 v[244:247], a[24:27], a[104:107], v[244:247]
    v_mfma_f32_16x16x32_bf16 v[244:247], a[28:31], a[108:111], v[244:247]
    v_mfma_f32_16x16x32_bf16 v[228:231], a[28:31], a[100:103], v[228:231]
    v_mfma_f32_16x16x32_bf16 v[228:231], a[24:27], a[96:99], v[228:231]
    v_mfma_f32_16x16x32_bf16 v[212:215], a[24:27], a[88:91], v[212:215]
    v_mfma_f32_16x16x32_bf16 v[212:215], a[28:31], a[92:95], v[212:215]
    v_mfma_f32_16x16x32_bf16 v[196:199], a[28:31], a[84:87], v[196:199]
    v_mfma_f32_16x16x32_bf16 v[196:199], a[24:27], a[80:83], v[196:199]
    v_mfma_f32_16x16x32_bf16 v[180:183], a[24:27], a[72:75], v[180:183]
    v_mfma_f32_16x16x32_bf16 v[180:183], a[28:31], a[76:79], v[180:183]
    v_mfma_f32_16x16x32_bf16 v[164:167], a[28:31], a[68:71], v[164:167]
    v_mfma_f32_16x16x32_bf16 v[164:167], a[24:27], a[64:67], v[164:167]
    s_waitcnt vmcnt(0) lgkmcnt(0)
    s_barrier
    v_mfma_f32_16x16x32_bf16 v[72:75], a[32:35], a[64:67], v[72:75]
    v_mfma_f32_16x16x32_bf16 v[72:75], a[36:39], a[68:71], v[72:75]
    s_add_u32 m0, s48, 32768
    ds_read_b128 a[192:195], v26 offset:0
    v_mfma_f32_16x16x32_bf16 v[88:91], a[36:39], a[76:79], v[88:91]
    buffer_load_dwordx4 v10, s[16:19], s49 offen offset:0 lds
    ds_read_b64_tr_b16 a[0:1], v28 offset:0
    v_mfma_f32_16x16x32_bf16 v[88:91], a[32:35], a[72:75], v[88:91]
    ds_read_b128 a[196:199], v27 offset:0
    v_mfma_f32_16x16x32_bf16 v[104:107], a[32:35], a[80:83], v[104:107]
    buffer_load_dwordx4 v11, s[16:19], s49 offen offset:1024 lds
    v_mfma_f32_16x16x32_bf16 v[104:107], a[36:39], a[84:87], v[104:107]
    ds_read_b64_tr_b16 a[2:3], v28 offset:2048
    v_mfma_f32_16x16x32_bf16 v[120:123], a[36:39], a[92:95], v[120:123]
    v_mfma_f32_16x16x32_bf16 v[120:123], a[32:35], a[88:91], v[120:123]
    ds_read_b128 a[200:203], v26 offset:2048
    v_mfma_f32_16x16x32_bf16 v[136:139], a[32:35], a[96:99], v[136:139]
    buffer_load_dwordx4 v12, s[16:19], s49 offen offset:2048 lds
    ds_read_b64_tr_b16 a[4:5], v28 offset:16384
    v_mfma_f32_16x16x32_bf16 v[136:139], a[36:39], a[100:103], v[136:139]
    v_mfma_f32_16x16x32_bf16 v[152:155], a[36:39], a[108:111], v[152:155]
    ds_read_b128 a[204:207], v27 offset:2048
    v_mfma_f32_16x16x32_bf16 v[152:155], a[32:35], a[104:107], v[152:155]
    buffer_load_dwordx4 v13, s[16:19], s49 offen offset:3072 lds
    v_mfma_f32_16x16x32_bf16 a[144:147], a[32:35], a[112:115], a[144:147]
    ds_read_b64_tr_b16 a[6:7], v28 offset:18432
    v_mfma_f32_16x16x32_bf16 a[144:147], a[36:39], a[116:119], a[144:147]
    s_add_u32 m0, s48, 36864
    ds_read_b128 a[208:211], v26 offset:4096
    v_mfma_f32_16x16x32_bf16 a[176:179], a[36:39], a[124:127], a[176:179]
    v_mfma_f32_16x16x32_bf16 a[176:179], a[32:35], a[120:123], a[176:179]
    buffer_load_dwordx4 v14, s[16:19], s49 offen offset:0 lds
    ds_read_b64_tr_b16 a[8:9], v29 offset:0
    v_mfma_f32_16x16x32_bf16 a[180:183], a[40:43], a[120:123], a[180:183]
    v_mfma_f32_16x16x32_bf16 a[180:183], a[44:47], a[124:127], a[180:183]
    ds_read_b128 a[212:215], v27 offset:4096
    v_mfma_f32_16x16x32_bf16 a[148:151], a[44:47], a[116:119], a[148:151]
    buffer_load_dwordx4 v15, s[16:19], s49 offen offset:1024 lds
    ds_read_b64_tr_b16 a[10:11], v29 offset:2048
    v_mfma_f32_16x16x32_bf16 a[148:151], a[40:43], a[112:115], a[148:151]
    v_mfma_f32_16x16x32_bf16 v[248:251], a[40:43], a[104:107], v[248:251]
    ds_read_b128 a[216:219], v26 offset:6144
    v_mfma_f32_16x16x32_bf16 v[248:251], a[44:47], a[108:111], v[248:251]
    v_mfma_f32_16x16x32_bf16 v[232:235], a[44:47], a[100:103], v[232:235]
    buffer_load_dwordx4 v16, s[16:19], s49 offen offset:2048 lds
    ds_read_b64_tr_b16 a[12:13], v29 offset:16384
    v_mfma_f32_16x16x32_bf16 v[232:235], a[40:43], a[96:99], v[232:235]
    ds_read_b128 a[220:223], v27 offset:6144
    v_mfma_f32_16x16x32_bf16 v[216:219], a[40:43], a[88:91], v[216:219]
    v_mfma_f32_16x16x32_bf16 v[216:219], a[44:47], a[92:95], v[216:219]
    buffer_load_dwordx4 v17, s[16:19], s49 offen offset:3072 lds
    ds_read_b64_tr_b16 a[14:15], v29 offset:18432
    v_mfma_f32_16x16x32_bf16 v[200:203], a[44:47], a[84:87], v[200:203]
    ds_read_b128 a[224:227], v26 offset:8192
    v_mfma_f32_16x16x32_bf16 v[200:203], a[40:43], a[80:83], v[200:203]
    s_add_u32 s49, s49, 128
    v_mfma_f32_16x16x32_bf16 v[184:187], a[40:43], a[72:75], v[184:187]
    s_add_u32 m0, s48, 98304
    ds_read_b64_tr_b16 a[16:17], v30 offset:0
    v_mfma_f32_16x16x32_bf16 v[184:187], a[44:47], a[76:79], v[184:187]
    buffer_load_dwordx4 v18, s[20:23], s50 offen offset:0 lds
    v_mfma_f32_16x16x32_bf16 v[168:171], a[44:47], a[68:71], v[168:171]
    ds_read_b128 a[228:231], v27 offset:8192
    v_mfma_f32_16x16x32_bf16 v[168:171], a[40:43], a[64:67], v[168:171]
    ds_read_b64_tr_b16 a[18:19], v30 offset:2048
    v_mfma_f32_16x16x32_bf16 v[76:79], a[48:51], a[64:67], v[76:79]
    buffer_load_dwordx4 v19, s[20:23], s50 offen offset:1024 lds
    v_mfma_f32_16x16x32_bf16 v[76:79], a[52:55], a[68:71], v[76:79]
    ds_read_b128 a[232:235], v26 offset:10240
    v_mfma_f32_16x16x32_bf16 v[92:95], a[52:55], a[76:79], v[92:95]
    v_mfma_f32_16x16x32_bf16 v[92:95], a[48:51], a[72:75], v[92:95]
    buffer_load_dwordx4 v20, s[20:23], s50 offen offset:2048 lds
    ds_read_b64_tr_b16 a[20:21], v30 offset:16384
    v_mfma_f32_16x16x32_bf16 v[108:111], a[48:51], a[80:83], v[108:111]
    ds_read_b128 a[236:239], v27 offset:10240
    v_mfma_f32_16x16x32_bf16 v[108:111], a[52:55], a[84:87], v[108:111]
    v_mfma_f32_16x16x32_bf16 v[124:127], a[52:55], a[92:95], v[124:127]
    ds_read_b64_tr_b16 a[22:23], v30 offset:18432
    v_mfma_f32_16x16x32_bf16 v[124:127], a[48:51], a[88:91], v[124:127]
    buffer_load_dwordx4 v21, s[20:23], s50 offen offset:3072 lds
    v_mfma_f32_16x16x32_bf16 v[140:143], a[48:51], a[96:99], v[140:143]
    s_add_u32 m0, s48, 102400
    ds_read_b128 a[240:243], v26 offset:12288
    v_mfma_f32_16x16x32_bf16 v[140:143], a[52:55], a[100:103], v[140:143]
    ds_read_b64_tr_b16 a[24:25], v31 offset:0
    v_mfma_f32_16x16x32_bf16 v[156:159], a[52:55], a[108:111], v[156:159]
    buffer_load_dwordx4 v22, s[20:23], s50 offen offset:0 lds
    v_mfma_f32_16x16x32_bf16 v[156:159], a[48:51], a[104:107], v[156:159]
    ds_read_b128 a[244:247], v27 offset:12288
    v_mfma_f32_16x16x32_bf16 a[152:155], a[48:51], a[112:115], a[152:155]
    v_mfma_f32_16x16x32_bf16 a[152:155], a[52:55], a[116:119], a[152:155]
    ds_read_b64_tr_b16 a[26:27], v31 offset:2048
    v_mfma_f32_16x16x32_bf16 a[184:187], a[52:55], a[124:127], a[184:187]
    buffer_load_dwordx4 v23, s[20:23], s50 offen offset:1024 lds
    ds_read_b128 a[248:251], v26 offset:14336
    v_mfma_f32_16x16x32_bf16 a[184:187], a[48:51], a[120:123], a[184:187]
    v_mfma_f32_16x16x32_bf16 a[188:191], a[56:59], a[120:123], a[188:191]
    ds_read_b64_tr_b16 a[28:29], v31 offset:16384
    v_mfma_f32_16x16x32_bf16 a[188:191], a[60:63], a[124:127], a[188:191]
    buffer_load_dwordx4 v24, s[20:23], s50 offen offset:2048 lds
    v_mfma_f32_16x16x32_bf16 a[156:159], a[60:63], a[116:119], a[156:159]
    ds_read_b128 a[252:255], v27 offset:14336
    v_mfma_f32_16x16x32_bf16 a[156:159], a[56:59], a[112:115], a[156:159]
    ds_read_b64_tr_b16 a[30:31], v31 offset:18432
    v_mfma_f32_16x16x32_bf16 v[252:255], a[56:59], a[104:107], v[252:255]
    v_mfma_f32_16x16x32_bf16 v[252:255], a[60:63], a[108:111], v[252:255]
    buffer_load_dwordx4 v25, s[20:23], s50 offen offset:3072 lds
    v_mfma_f32_16x16x32_bf16 v[236:239], a[60:63], a[100:103], v[236:239]
    v_mfma_f32_16x16x32_bf16 v[236:239], a[56:59], a[96:99], v[236:239]
    s_add_u32 s50, s50, 0x80000
    v_mfma_f32_16x16x32_bf16 v[220:223], a[56:59], a[88:91], v[220:223]
    v_mfma_f32_16x16x32_bf16 v[220:223], a[60:63], a[92:95], v[220:223]
    s_cmp_eq_u32 s51, s53
    s_cbranch_scc1 k12_ool_22
k12_oolret_23:
    v_mfma_f32_16x16x32_bf16 v[204:207], a[60:63], a[84:87], v[204:207]
    s_cmp_eq_u32 s51, s63
    s_cbranch_scc1 k12_ool_24
k12_oolret_25:
    v_mfma_f32_16x16x32_bf16 v[204:207], a[56:59], a[80:83], v[204:207]
    s_cmp_eq_u32 s51, 5
    s_cbranch_scc1 k12_ool_26
k12_oolret_27:
    v_mfma_f32_16x16x32_bf16 v[188:191], a[56:59], a[72:75], v[188:191]
    v_mfma_f32_16x16x32_bf16 v[188:191], a[60:63], a[76:79], v[188:191]
    s_add_u32 s51, s51, 1
    v_mfma_f32_16x16x32_bf16 v[172:175], a[60:63], a[68:71], v[172:175]
    v_mfma_f32_16x16x32_bf16 v[172:175], a[56:59], a[64:67], v[172:175]
    s_waitcnt lgkmcnt(0)
    s_branch k12_loop_8
k12_last_9:
    v_mfma_f32_16x16x32_bf16 v[64:67], a[0:3], a[64:67], v[64:67]
    buffer_load_dwordx4 a[192:195], v36, s[8:11], s62 offen sc1
    v_mfma_f32_16x16x32_bf16 v[64:67], a[4:7], a[68:71], v[64:67]
    ds_read_b64_tr_b16 a[32:33], v32 offset:32768
    v_mfma_f32_16x16x32_bf16 v[160:163], a[12:15], a[68:71], v[160:163]
    buffer_load_dwordx4 a[196:199], v54, s[8:11], s62 offen sc1
    ds_read_b64_tr_b16 a[34:35], v32 offset:34816
    v_mfma_f32_16x16x32_bf16 v[160:163], a[8:11], a[64:67], v[160:163]
    v_mfma_f32_16x16x32_bf16 v[80:83], a[0:3], a[72:75], v[80:83]
    buffer_load_dwordx4 a[200:203], v37, s[8:11], s62 offen sc1
    v_mfma_f32_16x16x32_bf16 v[80:83], a[4:7], a[76:79], v[80:83]
    ds_read_b64_tr_b16 a[36:37], v32 offset:49152
    v_mfma_f32_16x16x32_bf16 v[176:179], a[12:15], a[76:79], v[176:179]
    buffer_load_dwordx4 a[204:207], v55, s[8:11], s62 offen sc1
    v_mfma_f32_16x16x32_bf16 v[176:179], a[8:11], a[72:75], v[176:179]
    s_add_u32 s62, s62, 0x20000
    buffer_load_dwordx4 a[208:211], v36, s[8:11], s62 offen sc1
    ds_read_b64_tr_b16 a[38:39], v32 offset:51200
    v_mfma_f32_16x16x32_bf16 v[96:99], a[0:3], a[80:83], v[96:99]
    v_mfma_f32_16x16x32_bf16 v[96:99], a[4:7], a[84:87], v[96:99]
    v_cvt_pk_bf16_f32 v64, v64, v65
    v_cvt_pk_bf16_f32 v65, v66, v67
    v_mfma_f32_16x16x32_bf16 v[192:195], a[12:15], a[84:87], v[192:195]
    v_cvt_pk_bf16_f32 v66, v160, v161
    v_cvt_pk_bf16_f32 v67, v162, v163
    v_mfma_f32_16x16x32_bf16 v[192:195], a[8:11], a[80:83], v[192:195]
    buffer_load_dwordx4 a[212:215], v54, s[8:11], s62 offen sc1
    ds_read_b64_tr_b16 a[40:41], v33 offset:32768
    v_mfma_f32_16x16x32_bf16 v[112:115], a[0:3], a[88:91], v[112:115]
    buffer_load_dwordx4 a[216:219], v37, s[8:11], s62 offen sc1
    ds_read_b64_tr_b16 a[42:43], v33 offset:34816
    v_mfma_f32_16x16x32_bf16 v[112:115], a[4:7], a[92:95], v[112:115]
    v_cvt_pk_bf16_f32 v80, v80, v81
    v_cvt_pk_bf16_f32 v81, v82, v83
    v_mfma_f32_16x16x32_bf16 v[208:211], a[12:15], a[92:95], v[208:211]
    v_cvt_pk_bf16_f32 v82, v176, v177
    v_cvt_pk_bf16_f32 v83, v178, v179
    v_mfma_f32_16x16x32_bf16 v[208:211], a[8:11], a[88:91], v[208:211]
    buffer_load_dwordx4 a[220:223], v55, s[8:11], s62 offen sc1
    ds_read_b64_tr_b16 a[44:45], v33 offset:49152
    v_mfma_f32_16x16x32_bf16 v[128:131], a[0:3], a[96:99], v[128:131]
    s_add_u32 s62, s62, 0x20000
    buffer_load_dwordx4 a[224:227], v36, s[8:11], s62 offen sc1
    v_mfma_f32_16x16x32_bf16 v[128:131], a[4:7], a[100:103], v[128:131]
    v_cvt_pk_bf16_f32 v96, v96, v97
    v_cvt_pk_bf16_f32 v97, v98, v99
    v_mfma_f32_16x16x32_bf16 v[224:227], a[12:15], a[100:103], v[224:227]
    buffer_load_dwordx4 a[228:231], v54, s[8:11], s62 offen sc1
    ds_read_b64_tr_b16 a[46:47], v33 offset:51200
    v_mfma_f32_16x16x32_bf16 v[224:227], a[8:11], a[96:99], v[224:227]
    v_cvt_pk_bf16_f32 v98, v192, v193
    v_cvt_pk_bf16_f32 v99, v194, v195
    v_mfma_f32_16x16x32_bf16 v[144:147], a[0:3], a[104:107], v[144:147]
    buffer_load_dwordx4 a[232:235], v37, s[8:11], s62 offen sc1
    ds_read_b64_tr_b16 a[48:49], v34 offset:32768
    v_mfma_f32_16x16x32_bf16 v[144:147], a[4:7], a[108:111], v[144:147]
    v_cvt_pk_bf16_f32 v112, v112, v113
    v_cvt_pk_bf16_f32 v113, v114, v115
    v_mfma_f32_16x16x32_bf16 v[240:243], a[12:15], a[108:111], v[240:243]
    buffer_load_dwordx4 a[236:239], v55, s[8:11], s62 offen sc1
    ds_read_b64_tr_b16 a[50:51], v34 offset:34816
    v_mfma_f32_16x16x32_bf16 v[240:243], a[8:11], a[104:107], v[240:243]
    s_add_u32 s62, s62, 0x20000
    v_cvt_pk_bf16_f32 v114, v208, v209
    v_cvt_pk_bf16_f32 v115, v210, v211
    v_mfma_f32_16x16x32_bf16 a[128:131], a[0:3], a[112:115], a[128:131]
    buffer_load_dwordx4 a[240:243], v36, s[8:11], s62 offen sc1
    ds_read_b64_tr_b16 a[52:53], v34 offset:49152
    v_mfma_f32_16x16x32_bf16 a[128:131], a[4:7], a[116:119], a[128:131]
    v_cvt_pk_bf16_f32 v128, v128, v129
    v_cvt_pk_bf16_f32 v129, v130, v131
    v_mfma_f32_16x16x32_bf16 a[132:135], a[12:15], a[116:119], a[132:135]
    buffer_load_dwordx4 a[244:247], v54, s[8:11], s62 offen sc1
    buffer_load_dwordx4 a[248:251], v37, s[8:11], s62 offen sc1
    v_mfma_f32_16x16x32_bf16 a[132:135], a[8:11], a[112:115], a[132:135]
    v_cvt_pk_bf16_f32 v130, v224, v225
    v_cvt_pk_bf16_f32 v131, v226, v227
    v_mfma_f32_16x16x32_bf16 a[160:163], a[0:3], a[120:123], a[160:163]
    buffer_load_dwordx4 a[252:255], v55, s[8:11], s62 offen sc1
    ds_read_b64_tr_b16 a[54:55], v34 offset:51200
    v_mfma_f32_16x16x32_bf16 a[160:163], a[4:7], a[124:127], a[160:163]
    s_add_u32 s62, s62, 0x20000
    v_cvt_pk_bf16_f32 v144, v144, v145
    v_cvt_pk_bf16_f32 v145, v146, v147
    v_mfma_f32_16x16x32_bf16 a[164:167], a[12:15], a[124:127], a[164:167]
    ds_read_b64_tr_b16 a[56:57], v35 offset:32768
    v_cvt_pk_bf16_f32 v146, v240, v241
    v_mfma_f32_16x16x32_bf16 a[164:167], a[8:11], a[120:123], a[164:167]
    v_cvt_pk_bf16_f32 v147, v242, v243
    v_mfma_f32_16x16x32_bf16 v[68:71], a[16:19], a[64:67], v[68:71]
    s_add_u32 s52, s47, 0
    ds_read_b64_tr_b16 a[58:59], v35 offset:34816
    v_mfma_f32_16x16x32_bf16 v[68:71], a[20:23], a[68:71], v[68:71]
    v_accvgpr_read_b32 v56, a128
    v_accvgpr_read_b32 v57, a129
    v_mfma_f32_16x16x32_bf16 v[164:167], a[28:31], a[68:71], v[164:167]
    v_accvgpr_read_b32 v58, a130
    v_accvgpr_read_b32 v59, a131
    v_mfma_f32_16x16x32_bf16 v[164:167], a[24:27], a[64:67], v[164:167]
    buffer_store_dwordx4 v[64:67], v1, s[32:35], s52 offen offset:0 sc1
    ds_read_b64_tr_b16 a[60:61], v35 offset:49152
    v_mfma_f32_16x16x32_bf16 v[84:87], a[16:19], a[72:75], v[84:87]
    v_accvgpr_read_b32 v60, a132
    v_accvgpr_read_b32 v61, a133
    v_mfma_f32_16x16x32_bf16 v[84:87], a[20:23], a[76:79], v[84:87]
    v_accvgpr_read_b32 v62, a134
    v_accvgpr_read_b32 v63, a135
    v_mfma_f32_16x16x32_bf16 v[180:183], a[28:31], a[76:79], v[180:183]
    v_cvt_pk_bf16_f32 v160, v56, v57
    v_cvt_pk_bf16_f32 v161, v58, v59
    v_mfma_f32_16x16x32_bf16 v[180:183], a[24:27], a[72:75], v[180:183]
    ds_read_b64_tr_b16 a[62:63], v35 offset:51200
    v_cvt_pk_bf16_f32 v162, v60, v61
    v_mfma_f32_16x16x32_bf16 v[100:103], a[16:19], a[80:83], v[100:103]
    v_cvt_pk_bf16_f32 v163, v62, v63
    v_accvgpr_read_b32 v56, a160
    v_mfma_f32_16x16x32_bf16 v[100:103], a[20:23], a[84:87], v[100:103]
    v_accvgpr_read_b32 v57, a161
    v_accvgpr_read_b32 v58, a162
    v_mfma_f32_16x16x32_bf16 v[196:199], a[28:31], a[84:87], v[196:199]
    v_accvgpr_read_b32 v59, a163
    v_accvgpr_read_b32 v60, a164
    v_mfma_f32_16x16x32_bf16 v[196:199], a[24:27], a[80:83], v[196:199]
    s_add_u32 s52, s47, 8192
    v_accvgpr_read_b32 v61, a165
    v_accvgpr_read_b32 v62, a166
    v_mfma_f32_16x16x32_bf16 v[116:119], a[16:19], a[88:91], v[116:119]
    v_accvgpr_read_b32 v63, a167
    v_cvt_pk_bf16_f32 v176, v56, v57
    v_mfma_f32_16x16x32_bf16 v[116:119], a[20:23], a[92:95], v[116:119]
    v_cvt_pk_bf16_f32 v177, v58, v59
    v_cvt_pk_bf16_f32 v68, v68, v69
    v_mfma_f32_16x16x32_bf16 v[212:215], a[28:31], a[92:95], v[212:215]
    v_cvt_pk_bf16_f32 v178, v60, v61
    v_cvt_pk_bf16_f32 v69, v70, v71
    v_mfma_f32_16x16x32_bf16 v[212:215], a[24:27], a[88:91], v[212:215]
    v_cvt_pk_bf16_f32 v179, v62, v63
    v_cvt_pk_bf16_f32 v70, v164, v165
    v_mfma_f32_16x16x32_bf16 v[132:135], a[16:19], a[96:99], v[132:135]
    v_cvt_pk_bf16_f32 v71, v166, v167
    v_cvt_pk_bf16_f32 v84, v84, v85
    v_mfma_f32_16x16x32_bf16 v[132:135], a[20:23], a[100:103], v[132:135]
    buffer_store_dwordx4 v[96:99], v1, s[32:35], s52 offen offset:0 sc1
    v_cvt_pk_bf16_f32 v85, v86, v87
    v_mfma_f32_16x16x32_bf16 v[228:231], a[28:31], a[100:103], v[228:231]
    v_cvt_pk_bf16_f32 v86, v180, v181
    v_cvt_pk_bf16_f32 v87, v182, v183
    v_mfma_f32_16x16x32_bf16 v[228:231], a[24:27], a[96:99], v[228:231]
    v_cvt_pk_bf16_f32 v100, v100, v101
    v_cvt_pk_bf16_f32 v101, v102, v103
    v_mfma_f32_16x16x32_bf16 v[148:151], a[16:19], a[104:107], v[148:151]
    v_cvt_pk_bf16_f32 v102, v196, v197
    v_cvt_pk_bf16_f32 v103, v198, v199
    v_mfma_f32_16x16x32_bf16 v[148:151], a[20:23], a[108:111], v[148:151]
    v_cvt_pk_bf16_f32 v116, v116, v117
    v_cvt_pk_bf16_f32 v117, v118, v119
    v_mfma_f32_16x16x32_bf16 v[244:247], a[28:31], a[108:111], v[244:247]
    v_cvt_pk_bf16_f32 v118, v212, v213
    v_cvt_pk_bf16_f32 v119, v214, v215
    v_mfma_f32_16x16x32_bf16 v[244:247], a[24:27], a[104:107], v[244:247]
    s_add_u32 s52, s47, 524288
    v_mfma_f32_16x16x32_bf16 a[136:139], a[16:19], a[112:115], a[136:139]
    buffer_store_dwordx4 v[128:131], v1, s[32:35], s52 offen offset:0 sc1
    v_mfma_f32_16x16x32_bf16 a[136:139], a[20:23], a[116:119], a[136:139]
    v_cvt_pk_bf16_f32 v132, v132, v133
    v_cvt_pk_bf16_f32 v133, v134, v135
    v_mfma_f32_16x16x32_bf16 a[140:143], a[28:31], a[116:119], a[140:143]
    v_cvt_pk_bf16_f32 v134, v228, v229
    v_cvt_pk_bf16_f32 v135, v230, v231
    v_mfma_f32_16x16x32_bf16 a[140:143], a[24:27], a[112:115], a[140:143]
    v_mfma_f32_16x16x32_bf16 a[168:171], a[16:19], a[120:123], a[168:171]
    s_waitcnt lgkmcnt(0)
    v_mfma_f32_16x16x32_bf16 a[168:171], a[20:23], a[124:127], a[168:171]
    v_cvt_pk_bf16_f32 v148, v148, v149
    v_cvt_pk_bf16_f32 v149, v150, v151
    v_mfma_f32_16x16x32_bf16 a[172:175], a[28:31], a[124:127], a[172:175]
    v_cvt_pk_bf16_f32 v150, v244, v245
    v_cvt_pk_bf16_f32 v151, v246, v247
    v_mfma_f32_16x16x32_bf16 a[172:175], a[24:27], a[120:123], a[172:175]
    v_mfma_f32_16x16x32_bf16 v[72:75], a[32:35], a[64:67], v[72:75]
    v_mfma_f32_16x16x32_bf16 v[72:75], a[36:39], a[68:71], v[72:75]
    v_accvgpr_read_b32 v56, a136
    v_accvgpr_read_b32 v57, a137
    v_mfma_f32_16x16x32_bf16 v[168:171], a[44:47], a[68:71], v[168:171]
    s_add_u32 s52, s47, 532480
    v_accvgpr_read_b32 v58, a138
    v_accvgpr_read_b32 v59, a139
    v_mfma_f32_16x16x32_bf16 v[168:171], a[40:43], a[64:67], v[168:171]
    v_accvgpr_read_b32 v60, a140
    v_accvgpr_read_b32 v61, a141
    v_mfma_f32_16x16x32_bf16 v[88:91], a[32:35], a[72:75], v[88:91]
    v_accvgpr_read_b32 v62, a142
    v_accvgpr_read_b32 v63, a143
    v_mfma_f32_16x16x32_bf16 v[88:91], a[36:39], a[76:79], v[88:91]
    v_cvt_pk_bf16_f32 v164, v56, v57
    v_cvt_pk_bf16_f32 v165, v58, v59
    v_mfma_f32_16x16x32_bf16 v[184:187], a[44:47], a[76:79], v[184:187]
    buffer_store_dwordx4 v[160:163], v1, s[32:35], s52 offen offset:0 sc1
    v_mfma_f32_16x16x32_bf16 v[184:187], a[40:43], a[72:75], v[184:187]
    v_cvt_pk_bf16_f32 v166, v60, v61
    v_cvt_pk_bf16_f32 v167, v62, v63
    v_mfma_f32_16x16x32_bf16 v[104:107], a[32:35], a[80:83], v[104:107]
    v_accvgpr_read_b32 v56, a168
    v_accvgpr_read_b32 v57, a169
    v_mfma_f32_16x16x32_bf16 v[104:107], a[36:39], a[84:87], v[104:107]
    v_accvgpr_read_b32 v58, a170
    v_accvgpr_read_b32 v59, a171
    v_mfma_f32_16x16x32_bf16 v[200:203], a[44:47], a[84:87], v[200:203]
    v_accvgpr_read_b32 v60, a172
    v_accvgpr_read_b32 v61, a173
    v_mfma_f32_16x16x32_bf16 v[200:203], a[40:43], a[80:83], v[200:203]
    v_accvgpr_read_b32 v62, a174
    v_accvgpr_read_b32 v63, a175
    v_mfma_f32_16x16x32_bf16 v[120:123], a[32:35], a[88:91], v[120:123]
    v_cvt_pk_bf16_f32 v180, v56, v57
    v_cvt_pk_bf16_f32 v181, v58, v59
    v_mfma_f32_16x16x32_bf16 v[120:123], a[36:39], a[92:95], v[120:123]
    v_cvt_pk_bf16_f32 v72, v72, v73
    v_cvt_pk_bf16_f32 v182, v60, v61
    v_mfma_f32_16x16x32_bf16 v[216:219], a[44:47], a[92:95], v[216:219]
    s_add_u32 s52, s47, 0
    v_cvt_pk_bf16_f32 v73, v74, v75
    v_cvt_pk_bf16_f32 v183, v62, v63
    v_mfma_f32_16x16x32_bf16 v[216:219], a[40:43], a[88:91], v[216:219]
    v_cvt_pk_bf16_f32 v74, v168, v169
    v_cvt_pk_bf16_f32 v75, v170, v171
    v_mfma_f32_16x16x32_bf16 v[136:139], a[32:35], a[96:99], v[136:139]
    v_cvt_pk_bf16_f32 v88, v88, v89
    v_cvt_pk_bf16_f32 v89, v90, v91
    v_mfma_f32_16x16x32_bf16 v[136:139], a[36:39], a[100:103], v[136:139]
    v_cvt_pk_bf16_f32 v90, v184, v185
    v_cvt_pk_bf16_f32 v91, v186, v187
    v_mfma_f32_16x16x32_bf16 v[232:235], a[44:47], a[100:103], v[232:235]
    buffer_store_dwordx4 v[68:71], v1, s[32:35], s52 offen offset:1024 sc1
    v_mfma_f32_16x16x32_bf16 v[232:235], a[40:43], a[96:99], v[232:235]
    v_cvt_pk_bf16_f32 v104, v104, v105
    v_cvt_pk_bf16_f32 v105, v106, v107
    v_mfma_f32_16x16x32_bf16 v[152:155], a[32:35], a[104:107], v[152:155]
    v_cvt_pk_bf16_f32 v106, v200, v201
    v_cvt_pk_bf16_f32 v107, v202, v203
    v_mfma_f32_16x16x32_bf16 v[152:155], a[36:39], a[108:111], v[152:155]
    v_cvt_pk_bf16_f32 v120, v120, v121
    v_cvt_pk_bf16_f32 v121, v122, v123
    v_mfma_f32_16x16x32_bf16 v[248:251], a[44:47], a[108:111], v[248:251]
    v_cvt_pk_bf16_f32 v122, v216, v217
    v_cvt_pk_bf16_f32 v123, v218, v219
    v_mfma_f32_16x16x32_bf16 v[248:251], a[40:43], a[104:107], v[248:251]
    v_mfma_f32_16x16x32_bf16 a[144:147], a[32:35], a[112:115], a[144:147]
    v_mfma_f32_16x16x32_bf16 a[144:147], a[36:39], a[116:119], a[144:147]
    s_add_u32 s52, s47, 8192
    v_cvt_pk_bf16_f32 v136, v136, v137
    v_cvt_pk_bf16_f32 v137, v138, v139
    v_mfma_f32_16x16x32_bf16 a[148:151], a[44:47], a[116:119], a[148:151]
    v_cvt_pk_bf16_f32 v138, v232, v233
    v_cvt_pk_bf16_f32 v139, v234, v235
    v_mfma_f32_16x16x32_bf16 a[148:151], a[40:43], a[112:115], a[148:151]
    buffer_store_dwordx4 v[100:103], v1, s[32:35], s52 offen offset:1024 sc1
    v_mfma_f32_16x16x32_bf16 a[176:179], a[32:35], a[120:123], a[176:179]
    v_mfma_f32_16x16x32_bf16 a[176:179], a[36:39], a[124:127], a[176:179]
    v_cvt_pk_bf16_f32 v152, v152, v153
    v_cvt_pk_bf16_f32 v153, v154, v155
    v_mfma_f32_16x16x32_bf16 a[180:183], a[44:47], a[124:127], a[180:183]
    v_cvt_pk_bf16_f32 v154, v248, v249
    v_cvt_pk_bf16_f32 v155, v250, v251
    v_mfma_f32_16x16x32_bf16 a[180:183], a[40:43], a[120:123], a[180:183]
    v_mfma_f32_16x16x32_bf16 v[76:79], a[48:51], a[64:67], v[76:79]
    s_waitcnt vmcnt(16)
    s_barrier
    v_mfma_f32_16x16x32_bf16 v[76:79], a[52:55], a[68:71], v[76:79]
    ds_read_b64_tr_b16 a[0:1], v42 offset:32768
    v_accvgpr_read_b32 v56, a144
    v_mfma_f32_16x16x32_bf16 v[172:175], a[60:63], a[68:71], v[172:175]
    v_accvgpr_read_b32 v57, a145
    v_accvgpr_read_b32 v58, a146
    v_mfma_f32_16x16x32_bf16 v[172:175], a[56:59], a[64:67], v[172:175]
    ds_read_b64_tr_b16 a[2:3], v42 offset:33792
    v_accvgpr_read_b32 v59, a147
    v_mfma_f32_16x16x32_bf16 v[92:95], a[48:51], a[72:75], v[92:95]
    v_accvgpr_read_b32 v60, a148
    v_accvgpr_read_b32 v61, a149
    v_mfma_f32_16x16x32_bf16 v[92:95], a[52:55], a[76:79], v[92:95]
    s_add_u32 s52, s47, 524288
    ds_read_b64_tr_b16 a[4:5], v42 offset:40960
    v_accvgpr_read_b32 v62, a150
    v_mfma_f32_16x16x32_bf16 v[188:191], a[60:63], a[76:79], v[188:191]
    v_accvgpr_read_b32 v63, a151
    v_cvt_pk_bf16_f32 v168, v56, v57
    v_mfma_f32_16x16x32_bf16 v[188:191], a[56:59], a[72:75], v[188:191]
    v_cvt_pk_bf16_f32 v169, v58, v59
    v_cvt_pk_bf16_f32 v170, v60, v61
    v_mfma_f32_16x16x32_bf16 v[108:111], a[48:51], a[80:83], v[108:111]
    ds_read_b64_tr_b16 a[6:7], v42 offset:41984
    v_cvt_pk_bf16_f32 v171, v62, v63
    v_mfma_f32_16x16x32_bf16 v[108:111], a[52:55], a[84:87], v[108:111]
    v_accvgpr_read_b32 v56, a176
    v_accvgpr_read_b32 v57, a177
    v_mfma_f32_16x16x32_bf16 v[204:207], a[60:63], a[84:87], v[204:207]
    v_accvgpr_read_b32 v58, a178
    v_accvgpr_read_b32 v59, a179
    v_mfma_f32_16x16x32_bf16 v[204:207], a[56:59], a[80:83], v[204:207]
    ds_read_b64_tr_b16 a[8:9], v43 offset:32768
    v_accvgpr_read_b32 v60, a180
    v_mfma_f32_16x16x32_bf16 v[124:127], a[48:51], a[88:91], v[124:127]
    buffer_store_dwordx4 v[132:135], v1, s[32:35], s52 offen offset:1024 sc1
    v_accvgpr_read_b32 v61, a181
    v_mfma_f32_16x16x32_bf16 v[124:127], a[52:55], a[92:95], v[124:127]
    v_accvgpr_read_b32 v62, a182
    v_accvgpr_read_b32 v63, a183
    v_mfma_f32_16x16x32_bf16 v[220:223], a[60:63], a[92:95], v[220:223]
    ds_read_b64_tr_b16 a[10:11], v43 offset:33792
    v_cvt_pk_bf16_f32 v184, v56, v57
    v_mfma_f32_16x16x32_bf16 v[220:223], a[56:59], a[88:91], v[220:223]
    v_cvt_pk_bf16_f32 v185, v58, v59
    v_cvt_pk_bf16_f32 v76, v76, v77
    v_mfma_f32_16x16x32_bf16 v[140:143], a[48:51], a[96:99], v[140:143]
    s_add_u32 s52, s47, 532480
    v_cvt_pk_bf16_f32 v186, v60, v61
    v_cvt_pk_bf16_f32 v77, v78, v79
    v_mfma_f32_16x16x32_bf16 v[140:143], a[52:55], a[100:103], v[140:143]
    ds_read_b64_tr_b16 a[12:13], v43 offset:40960
    v_cvt_pk_bf16_f32 v187, v62, v63
    v_mfma_f32_16x16x32_bf16 v[236:239], a[60:63], a[100:103], v[236:239]
    v_cvt_pk_bf16_f32 v78, v172, v173
    v_cvt_pk_bf16_f32 v79, v174, v175
    v_mfma_f32_16x16x32_bf16 v[236:239], a[56:59], a[96:99], v[236:239]
    ds_read_b64_tr_b16 a[14:15], v43 offset:41984
    ds_read_b64_tr_b16 a[16:17], v44 offset:32768
    v_mfma_f32_16x16x32_bf16 v[156:159], a[48:51], a[104:107], v[156:159]
    v_cvt_pk_bf16_f32 v92, v92, v93
    v_cvt_pk_bf16_f32 v93, v94, v95
    v_mfma_f32_16x16x32_bf16 v[156:159], a[52:55], a[108:111], v[156:159]
    ds_read_b64_tr_b16 a[18:19], v44 offset:33792
    v_cvt_pk_bf16_f32 v94, v188, v189
    v_mfma_f32_16x16x32_bf16 v[252:255], a[60:63], a[108:111], v[252:255]
    ds_read_b64_tr_b16 a[20:21], v44 offset:40960
    v_cvt_pk_bf16_f32 v95, v190, v191
    v_mfma_f32_16x16x32_bf16 v[252:255], a[56:59], a[104:107], v[252:255]
    ds_read_b64_tr_b16 a[22:23], v44 offset:41984
    v_cvt_pk_bf16_f32 v108, v108, v109
    v_mfma_f32_16x16x32_bf16 a[152:155], a[48:51], a[112:115], a[152:155]
    v_cvt_pk_bf16_f32 v109, v110, v111
    v_cvt_pk_bf16_f32 v110, v204, v205
    v_mfma_f32_16x16x32_bf16 a[152:155], a[52:55], a[116:119], a[152:155]
    ds_read_b64_tr_b16 a[24:25], v45 offset:32768
    v_cvt_pk_bf16_f32 v111, v206, v207
    v_mfma_f32_16x16x32_bf16 a[156:159], a[60:63], a[116:119], a[156:159]
    buffer_store_dwordx4 v[164:167], v1, s[32:35], s52 offen offset:1024 sc1
    ds_read_b64_tr_b16 a[26:27], v45 offset:33792
    v_mfma_f32_16x16x32_bf16 a[156:159], a[56:59], a[112:115], a[156:159]
    ds_read_b64_tr_b16 a[28:29], v45 offset:40960
    v_cvt_pk_bf16_f32 v124, v124, v125
    v_mfma_f32_16x16x32_bf16 a[184:187], a[48:51], a[120:123], a[184:187]
    v_cvt_pk_bf16_f32 v125, v126, v127
    v_cvt_pk_bf16_f32 v126, v220, v221
    v_mfma_f32_16x16x32_bf16 a[184:187], a[52:55], a[124:127], a[184:187]
    ds_read_b64_tr_b16 a[30:31], v45 offset:41984
    v_cvt_pk_bf16_f32 v127, v222, v223
    v_mfma_f32_16x16x32_bf16 a[188:191], a[60:63], a[124:127], a[188:191]
    v_cvt_pk_bf16_f32 v140, v140, v141
    v_cvt_pk_bf16_f32 v141, v142, v143
    v_mfma_f32_16x16x32_bf16 a[188:191], a[56:59], a[120:123], a[188:191]
    v_cvt_pk_bf16_f32 v142, v236, v237
    v_cvt_pk_bf16_f32 v143, v238, v239
    v_cvt_pk_bf16_f32 v156, v156, v157
    v_cvt_pk_bf16_f32 v157, v158, v159
    v_cvt_pk_bf16_f32 v158, v252, v253
    v_cvt_pk_bf16_f32 v159, v254, v255
    v_accvgpr_read_b32 v56, a152
    v_accvgpr_read_b32 v57, a153
    v_accvgpr_read_b32 v58, a154
    v_accvgpr_read_b32 v59, a155
    v_accvgpr_read_b32 v60, a156
    v_accvgpr_read_b32 v61, a157
    v_accvgpr_read_b32 v62, a158
    v_accvgpr_read_b32 v63, a159
    v_cvt_pk_bf16_f32 v172, v56, v57
    v_cvt_pk_bf16_f32 v173, v58, v59
    v_cvt_pk_bf16_f32 v174, v60, v61
    v_cvt_pk_bf16_f32 v175, v62, v63
    v_accvgpr_read_b32 v56, a184
    v_accvgpr_read_b32 v57, a185
    v_accvgpr_read_b32 v58, a186
    v_accvgpr_read_b32 v59, a187
    v_accvgpr_read_b32 v60, a188
    v_accvgpr_read_b32 v61, a189
    v_accvgpr_read_b32 v62, a190
    v_accvgpr_read_b32 v63, a191
    v_cvt_pk_bf16_f32 v188, v56, v57
    v_cvt_pk_bf16_f32 v189, v58, v59
    v_cvt_pk_bf16_f32 v190, v60, v61
    v_cvt_pk_bf16_f32 v191, v62, v63
    s_branch k12_join_7
k12_v_6:
k12_loop_28:
    v_mfma_f32_16x16x32_bf16 v[64:67], a[192:195], a[0:3], v[64:67]
    v_mfma_f32_16x16x32_bf16 v[64:67], a[196:199], a[4:7], v[64:67]
    ds_read_b64_tr_b16 a[32:33], v32 offset:0
    v_mfma_f32_16x16x32_bf16 v[160:163], a[204:207], a[4:7], v[160:163]
    v_mfma_f32_16x16x32_bf16 v[160:163], a[200:203], a[0:3], v[160:163]
    ds_read_b64_tr_b16 a[34:35], v32 offset:2048
    v_mfma_f32_16x16x32_bf16 v[96:99], a[208:211], a[0:3], v[96:99]
    s_cmp_eq_u32 s51, s46
    s_cbranch_scc1 k12_ool_30
k12_oolret_31:
    v_mfma_f32_16x16x32_bf16 v[96:99], a[212:215], a[4:7], v[96:99]
    v_mfma_f32_16x16x32_bf16 v[192:195], a[220:223], a[4:7], v[192:195]
    ds_read_b64_tr_b16 a[36:37], v32 offset:16384
    v_mfma_f32_16x16x32_bf16 v[192:195], a[216:219], a[0:3], v[192:195]
    v_mfma_f32_16x16x32_bf16 v[128:131], a[224:227], a[0:3], v[128:131]
    v_mfma_f32_16x16x32_bf16 v[128:131], a[228:231], a[4:7], v[128:131]
    ds_read_b64_tr_b16 a[38:39], v32 offset:18432
    v_mfma_f32_16x16x32_bf16 v[224:227], a[236:239], a[4:7], v[224:227]
    v_mfma_f32_16x16x32_bf16 v[224:227], a[232:235], a[0:3], v[224:227]
    v_mfma_f32_16x16x32_bf16 a[128:131], a[240:243], a[0:3], a[128:131]
    ds_read_b64_tr_b16 a[40:41], v33 offset:0
    v_mfma_f32_16x16x32_bf16 a[128:131], a[244:247], a[4:7], a[128:131]
    v_mfma_f32_16x16x32_bf16 a[132:135], a[252:255], a[4:7], a[132:135]
    v_mfma_f32_16x16x32_bf16 a[132:135], a[248:251], a[0:3], a[132:135]
    ds_read_b64_tr_b16 a[42:43], v33 offset:2048
    v_mfma_f32_16x16x32_bf16 a[140:143], a[248:251], a[8:11], a[140:143]
    v_mfma_f32_16x16x32_bf16 a[140:143], a[252:255], a[12:15], a[140:143]
    v_mfma_f32_16x16x32_bf16 a[136:139], a[244:247], a[12:15], a[136:139]
    ds_read_b64_tr_b16 a[44:45], v33 offset:16384
    v_mfma_f32_16x16x32_bf16 a[136:139], a[240:243], a[8:11], a[136:139]
    v_mfma_f32_16x16x32_bf16 v[228:231], a[232:235], a[8:11], v[228:231]
    v_mfma_f32_16x16x32_bf16 v[228:231], a[236:239], a[12:15], v[228:231]
    ds_read_b64_tr_b16 a[46:47], v33 offset:18432
    v_mfma_f32_16x16x32_bf16 v[132:135], a[228:231], a[12:15], v[132:135]
    v_mfma_f32_16x16x32_bf16 v[132:135], a[224:227], a[8:11], v[132:135]
    ds_read_b64_tr_b16 a[48:49], v34 offset:0
    v_mfma_f32_16x16x32_bf16 v[196:199], a[216:219], a[8:11], v[196:199]
    v_mfma_f32_16x16x32_bf16 v[196:199], a[220:223], a[12:15], v[196:199]
    v_mfma_f32_16x16x32_bf16 v[100:103], a[212:215], a[12:15], v[100:103]
    ds_read_b64_tr_b16 a[50:51], v34 offset:2048
    v_mfma_f32_16x16x32_bf16 v[100:103], a[208:211], a[8:11], v[100:103]
    v_mfma_f32_16x16x32_bf16 v[164:167], a[200:203], a[8:11], v[164:167]
    v_mfma_f32_16x16x32_bf16 v[164:167], a[204:207], a[12:15], v[164:167]
    ds_read_b64_tr_b16 a[52:53], v34 offset:16384
    v_mfma_f32_16x16x32_bf16 v[68:71], a[196:199], a[12:15], v[68:71]
    v_mfma_f32_16x16x32_bf16 v[68:71], a[192:195], a[8:11], v[68:71]
    v_mfma_f32_16x16x32_bf16 v[72:75], a[192:195], a[16:19], v[72:75]
    ds_read_b64_tr_b16 a[54:55], v34 offset:18432
    v_mfma_f32_16x16x32_bf16 v[72:75], a[196:199], a[20:23], v[72:75]
    v_mfma_f32_16x16x32_bf16 v[168:171], a[204:207], a[20:23], v[168:171]
    v_mfma_f32_16x16x32_bf16 v[168:171], a[200:203], a[16:19], v[168:171]
    ds_read_b64_tr_b16 a[56:57], v35 offset:0
    v_mfma_f32_16x16x32_bf16 v[104:107], a[208:211], a[16:19], v[104:107]
    v_mfma_f32_16x16x32_bf16 v[104:107], a[212:215], a[20:23], v[104:107]
    v_mfma_f32_16x16x32_bf16 v[200:203], a[220:223], a[20:23], v[200:203]
    ds_read_b64_tr_b16 a[58:59], v35 offset:2048
    v_mfma_f32_16x16x32_bf16 v[200:203], a[216:219], a[16:19], v[200:203]
    v_mfma_f32_16x16x32_bf16 v[136:139], a[224:227], a[16:19], v[136:139]
    v_mfma_f32_16x16x32_bf16 v[136:139], a[228:231], a[20:23], v[136:139]
    ds_read_b64_tr_b16 a[60:61], v35 offset:16384
    v_mfma_f32_16x16x32_bf16 v[232:235], a[236:239], a[20:23], v[232:235]
    v_mfma_f32_16x16x32_bf16 v[232:235], a[232:235], a[16:19], v[232:235]
    v_mfma_f32_16x16x32_bf16 a[144:147], a[240:243], a[16:19], a[144:147]
    ds_read_b64_tr_b16 a[62:63], v35 offset:18432
    v_mfma_f32_16x16x32_bf16 a[144:147], a[244:247], a[20:23], a[144:147]
    v_mfma_f32_16x16x32_bf16 a[148:151], a[252:255], a[20:23], a[148:151]
    v_mfma_f32_16x16x32_bf16 a[148:151], a[248:251], a[16:19], a[148:151]
    v_mfma_f32_16x16x32_bf16 a[156:159], a[248:251], a[24:27], a[156:159]
    v_mfma_f32_16x16x32_bf16 a[156:159], a[252:255], a[28:31], a[156:159]
    v_mfma_f32_16x16x32_bf16 a[152:155], a[244:247], a[28:31], a[152:155]
    v_mfma_f32_16x16x32_bf16 a[152:155], a[240:243], a[24:27], a[152:155]
    v_mfma_f32_16x16x32_bf16 v[236:239], a[232:235], a[24:27], v[236:239]
    v_mfma_f32_16x16x32_bf16 v[236:239], a[236:239], a[28:31], v[236:239]
    v_mfma_f32_16x16x32_bf16 v[140:143], a[228:231], a[28:31], v[140:143]
    v_mfma_f32_16x16x32_bf16 v[140:143], a[224:227], a[24:27], v[140:143]
    v_mfma_f32_16x16x32_bf16 v[204:207], a[216:219], a[24:27], v[204:207]
    v_mfma_f32_16x16x32_bf16 v[204:207], a[220:223], a[28:31], v[204:207]
    v_mfma_f32_16x16x32_bf16 v[108:111], a[212:215], a[28:31], v[108:111]
    v_mfma_f32_16x16x32_bf16 v[108:111], a[208:211], a[24:27], v[108:111]
    v_mfma_f32_16x16x32_bf16 v[172:175], a[200:203], a[24:27], v[172:175]
    v_mfma_f32_16x16x32_bf16 v[172:175], a[204:207], a[28:31], v[172:175]
    v_mfma_f32_16x16x32_bf16 v[76:79], a[196:199], a[28:31], v[76:79]
    v_mfma_f32_16x16x32_bf16 v[76:79], a[192:195], a[24:27], v[76:79]
    s_waitcnt vmcnt(0) lgkmcnt(0)
    s_cmp_eq_u32 s51, s46
    s_cbranch_scc1 k12_ool_34
k12_oolret_35:
    s_barrier
    v_mfma_f32_16x16x32_bf16 v[80:83], a[192:195], a[32:35], v[80:83]
    s_cmp_ge_u32 s49, 1024
    s_cselect_b32 s18, 0, s18
    s_cselect_b32 s22, 0, s22
    v_mfma_f32_16x16x32_bf16 v[80:83], a[196:199], a[36:39], v[80:83]
    s_add_u32 m0, s48, 0
    ds_read_b128 a[64:67], v26 offset:32768
    v_mfma_f32_16x16x32_bf16 v[176:179], a[204:207], a[36:39], v[176:179]
    buffer_load_dwordx4 v10, s[16:19], s49 offen offset:0 lds
    ds_read_b64_tr_b16 a[0:1], v28 offset:32768
    v_mfma_f32_16x16x32_bf16 v[176:179], a[200:203], a[32:35], v[176:179]
    ds_read_b128 a[68:71], v27 offset:32768
    v_mfma_f32_16x16x32_bf16 v[112:115], a[208:211], a[32:35], v[112:115]
    buffer_load_dwordx4 v11, s[16:19], s49 offen offset:1024 lds
    v_mfma_f32_16x16x32_bf16 v[112:115], a[212:215], a[36:39], v[112:115]
    ds_read_b64_tr_b16 a[2:3], v28 offset:34816
    v_mfma_f32_16x16x32_bf16 v[208:211], a[220:223], a[36:39], v[208:211]
    v_mfma_f32_16x16x32_bf16 v[208:211], a[216:219], a[32:35], v[208:211]
    ds_read_b128 a[72:75], v26 offset:34816
    v_mfma_f32_16x16x32_bf16 v[144:147], a[224:227], a[32:35], v[144:147]
    buffer_load_dwordx4 v12, s[16:19], s49 offen offset:2048 lds
    ds_read_b64_tr_b16 a[4:5], v28 offset:49152
    v_mfma_f32_16x16x32_bf16 v[144:147], a[228:231], a[36:39], v[144:147]
    v_mfma_f32_16x16x32_bf16 v[240:243], a[236:239], a[36:39], v[240:243]
    ds_read_b128 a[76:79], v27 offset:34816
    v_mfma_f32_16x16x32_bf16 v[240:243], a[232:235], a[32:35], v[240:243]
    buffer_load_dwordx4 v13, s[16:19], s49 offen offset:3072 lds
    v_mfma_f32_16x16x32_bf16 a[160:163], a[240:243], a[32:35], a[160:163]
    ds_read_b64_tr_b16 a[6:7], v28 offset:51200
    v_mfma_f32_16x16x32_bf16 a[160:163], a[244:247], a[36:39], a[160:163]
    s_add_u32 m0, s48, 4096
    ds_read_b128 a[80:83], v26 offset:36864
    v_mfma_f32_16x16x32_bf16 a[164:167], a[252:255], a[36:39], a[164:167]
    v_mfma_f32_16x16x32_bf16 a[164:167], a[248:251], a[32:35], a[164:167]
    buffer_load_dwordx4 v14, s[16:19], s49 offen offset:0 lds
    ds_read_b64_tr_b16 a[8:9], v29 offset:32768
    v_mfma_f32_16x16x32_bf16 a[172:175], a[248:251], a[40:43], a[172:175]
    v_mfma_f32_16x16x32_bf16 a[172:175], a[252:255], a[44:47], a[172:175]
    ds_read_b128 a[84:87], v27 offset:36864
    v_mfma_f32_16x16x32_bf16 a[168:171], a[244:247], a[44:47], a[168:171]
    buffer_load_dwordx4 v15, s[16:19], s49 offen offset:1024 lds
    ds_read_b64_tr_b16 a[10:11], v29 offset:34816
    v_mfma_f32_16x16x32_bf16 a[168:171], a[240:243], a[40:43], a[168:171]
    v_mfma_f32_16x16x32_bf16 v[244:247], a[232:235], a[40:43], v[244:247]
    ds_read_b128 a[88:91], v26 offset:38912
    v_mfma_f32_16x16x32_bf16 v[244:247], a[236:239], a[44:47], v[244:247]
    v_mfma_f32_16x16x32_bf16 v[148:151], a[228:231], a[44:47], v[148:151]
    buffer_load_dwordx4 v16, s[16:19], s49 offen offset:2048 lds
    ds_read_b64_tr_b16 a[12:13], v29 offset:49152
    v_mfma_f32_16x16x32_bf16 v[148:151], a[224:227], a[40:43], v[148:151]
    ds_read_b128 a[92:95], v27 offset:38912
    v_mfma_f32_16x16x32_bf16 v[212:215], a[216:219], a[40:43], v[212:215]
    v_mfma_f32_16x16x32_bf16 v[212:215], a[220:223], a[44:47], v[212:215]
    buffer_load_dwordx4 v17, s[16:19], s49 offen offset:3072 lds
    ds_read_b64_tr_b16 a[14:15], v29 offset:51200
    v_mfma_f32_16x16x32_bf16 v[116:119], a[212:215], a[44:47], v[116:119]
    ds_read_b128 a[96:99], v26 offset:40960
    v_mfma_f32_16x16x32_bf16 v[116:119], a[208:211], a[40:43], v[116:119]
    s_add_u32 s49, s49, 128
    v_mfma_f32_16x16x32_bf16 v[180:183], a[200:203], a[40:43], v[180:183]
    s_add_u32 m0, s48, 65536
    ds_read_b64_tr_b16 a[16:17], v30 offset:32768
    v_mfma_f32_16x16x32_bf16 v[180:183], a[204:207], a[44:47], v[180:183]
    buffer_load_dwordx4 v18, s[20:23], s50 offen offset:0 lds
    v_mfma_f32_16x16x32_bf16 v[84:87], a[196:199], a[44:47], v[84:87]
    ds_read_b128 a[100:103], v27 offset:40960
    v_mfma_f32_16x16x32_bf16 v[84:87], a[192:195], a[40:43], v[84:87]
    ds_read_b64_tr_b16 a[18:19], v30 offset:34816
    v_mfma_f32_16x16x32_bf16 v[88:91], a[192:195], a[48:51], v[88:91]
    buffer_load_dwordx4 v19, s[20:23], s50 offen offset:1024 lds
    v_mfma_f32_16x16x32_bf16 v[88:91], a[196:199], a[52:55], v[88:91]
    ds_read_b128 a[104:107], v26 offset:43008
    v_mfma_f32_16x16x32_bf16 v[184:187], a[204:207], a[52:55], v[184:187]
    v_mfma_f32_16x16x32_bf16 v[184:187], a[200:203], a[48:51], v[184:187]
    buffer_load_dwordx4 v20, s[20:23], s50 offen offset:2048 lds
    ds_read_b64_tr_b16 a[20:21], v30 offset:49152
    v_mfma_f32_16x16x32_bf16 v[120:123], a[208:211], a[48:51], v[120:123]
    ds_read_b128 a[108:111], v27 offset:43008
    v_mfma_f32_16x16x32_bf16 v[120:123], a[212:215], a[52:55], v[120:123]
    v_mfma_f32_16x16x32_bf16 v[216:219], a[220:223], a[52:55], v[216:219]
    ds_read_b64_tr_b16 a[22:23], v30 offset:51200
    v_mfma_f32_16x16x32_bf16 v[216:219], a[216:219], a[48:51], v[216:219]
    buffer_load_dwordx4 v21, s[20:23], s50 offen offset:3072 lds
    v_mfma_f32_16x16x32_bf16 v[152:155], a[224:227], a[48:51], v[152:155]
    s_add_u32 m0, s48, 69632
    ds_read_b128 a[112:115], v26 offset:45056
    v_mfma_f32_16x16x32_bf16 v[152:155], a[228:231], a[52:55], v[152:155]
    ds_read_b64_tr_b16 a[24:25], v31 offset:32768
    v_mfma_f32_16x16x32_bf16 v[248:251], a[236:239], a[52:55], v[248:251]
    buffer_load_dwordx4 v22, s[20:23], s50 offen offset:0 lds
    v_mfma_f32_16x16x32_bf16 v[248:251], a[232:235], a[48:51], v[248:251]
    ds_read_b128 a[116:119], v27 offset:45056
    v_mfma_f32_16x16x32_bf16 a[176:179], a[240:243], a[48:51], a[176:179]
    v_mfma_f32_16x16x32_bf16 a[176:179], a[244:247], a[52:55], a[176:179]
    ds_read_b64_tr_b16 a[26:27], v31 offset:34816
    v_mfma_f32_16x16x32_bf16 a[180:183], a[252:255], a[52:55], a[180:183]
    buffer_load_dwordx4 v23, s[20:23], s50 offen offset:1024 lds
    ds_read_b128 a[120:123], v26 offset:47104
    v_mfma_f32_16x16x32_bf16 a[180:183], a[248:251], a[48:51], a[180:183]
    v_mfma_f32_16x16x32_bf16 a[188:191], a[248:251], a[56:59], a[188:191]
    ds_read_b64_tr_b16 a[28:29], v31 offset:49152
    v_mfma_f32_16x16x32_bf16 a[188:191], a[252:255], a[60:63], a[188:191]
    buffer_load_dwordx4 v24, s[20:23], s50 offen offset:2048 lds
    v_mfma_f32_16x16x32_bf16 a[184:187], a[244:247], a[60:63], a[184:187]
    ds_read_b128 a[124:127], v27 offset:47104
    v_mfma_f32_16x16x32_bf16 a[184:187], a[240:243], a[56:59], a[184:187]
    ds_read_b64_tr_b16 a[30:31], v31 offset:51200
    v_mfma_f32_16x16x32_bf16 v[252:255], a[232:235], a[56:59], v[252:255]
    v_mfma_f32_16x16x32_bf16 v[252:255], a[236:239], a[60:63], v[252:255]
    buffer_load_dwordx4 v25, s[20:23], s50 offen offset:3072 lds
    v_mfma_f32_16x16x32_bf16 v[156:159], a[228:231], a[60:63], v[156:159]
    v_mfma_f32_16x16x32_bf16 v[156:159], a[224:227], a[56:59], v[156:159]
    s_add_u32 s50, s50, 0x80000
    v_mfma_f32_16x16x32_bf16 v[220:223], a[216:219], a[56:59], v[220:223]
    v_mfma_f32_16x16x32_bf16 v[220:223], a[220:223], a[60:63], v[220:223]
    s_cmp_eq_u32 s51, s53
    s_cbranch_scc1 k12_ool_36
k12_oolret_37:
    v_mfma_f32_16x16x32_bf16 v[124:127], a[212:215], a[60:63], v[124:127]
    s_cmp_eq_u32 s51, s63
    s_cbranch_scc1 k12_ool_38
k12_oolret_39:
    v_mfma_f32_16x16x32_bf16 v[124:127], a[208:211], a[56:59], v[124:127]
    s_cmp_eq_u32 s51, 6
    s_cbranch_scc1 k12_ool_40
k12_oolret_41:
    v_mfma_f32_16x16x32_bf16 v[188:191], a[200:203], a[56:59], v[188:191]
    v_mfma_f32_16x16x32_bf16 v[188:191], a[204:207], a[60:63], v[188:191]
    s_add_u32 s51, s51, 1
    v_mfma_f32_16x16x32_bf16 v[92:95], a[196:199], a[60:63], v[92:95]
    v_mfma_f32_16x16x32_bf16 v[92:95], a[192:195], a[56:59], v[92:95]
    s_waitcnt lgkmcnt(0)
    s_cmp_eq_u32 s51, 7
    s_cbranch_scc1 k12_last_29
    v_mfma_f32_16x16x32_bf16 v[64:67], a[64:67], a[0:3], v[64:67]
    v_mfma_f32_16x16x32_bf16 v[64:67], a[68:71], a[4:7], v[64:67]
    ds_read_b64_tr_b16 a[32:33], v32 offset:32768
    v_mfma_f32_16x16x32_bf16 v[160:163], a[76:79], a[4:7], v[160:163]
    v_mfma_f32_16x16x32_bf16 v[160:163], a[72:75], a[0:3], v[160:163]
    ds_read_b64_tr_b16 a[34:35], v32 offset:34816
    v_mfma_f32_16x16x32_bf16 v[96:99], a[80:83], a[0:3], v[96:99]
    v_mfma_f32_16x16x32_bf16 v[96:99], a[84:87], a[4:7], v[96:99]
    v_mfma_f32_16x16x32_bf16 v[192:195], a[92:95], a[4:7], v[192:195]
    ds_read_b64_tr_b16 a[36:37], v32 offset:49152
    v_mfma_f32_16x16x32_bf16 v[192:195], a[88:91], a[0:3], v[192:195]
    v_mfma_f32_16x16x32_bf16 v[128:131], a[96:99], a[0:3], v[128:131]
    v_mfma_f32_16x16x32_bf16 v[128:131], a[100:103], a[4:7], v[128:131]
    ds_read_b64_tr_b16 a[38:39], v32 offset:51200
    v_mfma_f32_16x16x32_bf16 v[224:227], a[108:111], a[4:7], v[224:227]
    v_mfma_f32_16x16x32_bf16 v[224:227], a[104:107], a[0:3], v[224:227]
    v_mfma_f32_16x16x32_bf16 a[128:131], a[112:115], a[0:3], a[128:131]
    ds_read_b64_tr_b16 a[40:41], v33 offset:32768
    v_mfma_f32_16x16x32_bf16 a[128:131], a[116:119], a[4:7], a[128:131]
    v_mfma_f32_16x16x32_bf16 a[132:135], a[124:127], a[4:7], a[132:135]
    v_mfma_f32_16x16x32_bf16 a[132:135], a[120:123], a[0:3], a[132:135]
    ds_read_b64_tr_b16 a[42:43], v33 offset:34816
    v_mfma_f32_16x16x32_bf16 a[140:143], a[120:123], a[8:11], a[140:143]
    v_mfma_f32_16x16x32_bf16 a[140:143], a[124:127], a[12:15], a[140:143]
    v_mfma_f32_16x16x32_bf16 a[136:139], a[116:119], a[12:15], a[136:139]
    ds_read_b64_tr_b16 a[44:45], v33 offset:49152
    v_mfma_f32_16x16x32_bf16 a[136:139], a[112:115], a[8:11], a[136:139]
    v_mfma_f32_16x16x32_bf16 v[228:231], a[104:107], a[8:11], v[228:231]
    v_mfma_f32_16x16x32_bf16 v[228:231], a[108:111], a[12:15], v[228:231]
    ds_read_b64_tr_b16 a[46:47], v33 offset:51200
    v_mfma_f32_16x16x32_bf16 v[132:135], a[100:103], a[12:15], v[132:135]
    v_mfma_f32_16x16x32_bf16 v[132:135], a[96:99], a[8:11], v[132:135]
    ds_read_b64_tr_b16 a[48:49], v34 offset:32768
    v_mfma_f32_16x16x32_bf16 v[196:199], a[88:91], a[8:11], v[196:199]
    v_mfma_f32_16x16x32_bf16 v[196:199], a[92:95], a[12:15], v[196:199]
    v_mfma_f32_16x16x32_bf16 v[100:103], a[84:87], a[12:15], v[100:103]
    ds_read_b64_tr_b16 a[50:51], v34 offset:34816
    v_mfma_f32_16x16x32_bf16 v[100:103], a[80:83], a[8:11], v[100:103]
    v_mfma_f32_16x16x32_bf16 v[164:167], a[72:75], a[8:11], v[164:167]
    v_mfma_f32_16x16x32_bf16 v[164:167], a[76:79], a[12:15], v[164:167]
    ds_read_b64_tr_b16 a[52:53], v34 offset:49152
    v_mfma_f32_16x16x32_bf16 v[68:71], a[68:71], a[12:15], v[68:71]
    v_mfma_f32_16x16x32_bf16 v[68:71], a[64:67], a[8:11], v[68:71]
    v_mfma_f32_16x16x32_bf16 v[72:75], a[64:67], a[16:19], v[72:75]
    ds_read_b64_tr_b16 a[54:55], v34 offset:51200
    v_mfma_f32_16x16x32_bf16 v[72:75], a[68:71], a[20:23], v[72:75]
    v_mfma_f32_16x16x32_bf16 v[168:171], a[76:79], a[20:23], v[168:171]
    v_mfma_f32_16x16x32_bf16 v[168:171], a[72:75], a[16:19], v[168:171]
    ds_read_b64_tr_b16 a[56:57], v35 offset:32768
    v_mfma_f32_16x16x32_bf16 v[104:107], a[80:83], a[16:19], v[104:107]
    v_mfma_f32_16x16x32_bf16 v[104:107], a[84:87], a[20:23], v[104:107]
    v_mfma_f32_16x16x32_bf16 v[200:203], a[92:95], a[20:23], v[200:203]
    ds_read_b64_tr_b16 a[58:59], v35 offset:34816
    v_mfma_f32_16x16x32_bf16 v[200:203], a[88:91], a[16:19], v[200:203]
    v_mfma_f32_16x16x32_bf16 v[136:139], a[96:99], a[16:19], v[136:139]
    v_mfma_f32_16x16x32_bf16 v[136:139], a[100:103], a[20:23], v[136:139]
    ds_read_b64_tr_b16 a[60:61], v35 offset:49152
    v_mfma_f32_16x16x32_bf16 v[232:235], a[108:111], a[20:23], v[232:235]
    v_mfma_f32_16x16x32_bf16 v[232:235], a[104:107], a[16:19], v[232:235]
    v_mfma_f32_16x16x32_bf16 a[144:147], a[112:115], a[16:19], a[144:147]
    ds_read_b64_tr_b16 a[62:63], v35 offset:51200
    v_mfma_f32_16x16x32_bf16 a[144:147], a[116:119], a[20:23], a[144:147]
    v_mfma_f32_16x16x32_bf16 a[148:151], a[124:127], a[20:23], a[148:151]
    v_mfma_f32_16x16x32_bf16 a[148:151], a[120:123], a[16:19], a[148:151]
    v_mfma_f32_16x16x32_bf16 a[156:159], a[120:123], a[24:27], a[156:159]
    v_mfma_f32_16x16x32_bf16 a[156:159], a[124:127], a[28:31], a[156:159]
    v_mfma_f32_16x16x32_bf16 a[152:155], a[116:119], a[28:31], a[152:155]
    v_mfma_f32_16x16x32_bf16 a[152:155], a[112:115], a[24:27], a[152:155]
    v_mfma_f32_16x16x32_bf16 v[236:239], a[104:107], a[24:27], v[236:239]
    v_mfma_f32_16x16x32_bf16 v[236:239], a[108:111], a[28:31], v[236:239]
    v_mfma_f32_16x16x32_bf16 v[140:143], a[100:103], a[28:31], v[140:143]
    v_mfma_f32_16x16x32_bf16 v[140:143], a[96:99], a[24:27], v[140:143]
    v_mfma_f32_16x16x32_bf16 v[204:207], a[88:91], a[24:27], v[204:207]
    v_mfma_f32_16x16x32_bf16 v[204:207], a[92:95], a[28:31], v[204:207]
    v_mfma_f32_16x16x32_bf16 v[108:111], a[84:87], a[28:31], v[108:111]
    v_mfma_f32_16x16x32_bf16 v[108:111], a[80:83], a[24:27], v[108:111]
    v_mfma_f32_16x16x32_bf16 v[172:175], a[72:75], a[24:27], v[172:175]
    v_mfma_f32_16x16x32_bf16 v[172:175], a[76:79], a[28:31], v[172:175]
    v_mfma_f32_16x16x32_bf16 v[76:79], a[68:71], a[28:31], v[76:79]
    v_mfma_f32_16x16x32_bf16 v[76:79], a[64:67], a[24:27], v[76:79]
    s_waitcnt vmcnt(0) lgkmcnt(0)
    s_barrier
    v_mfma_f32_16x16x32_bf16 v[80:83], a[64:67], a[32:35], v[80:83]
    v_mfma_f32_16x16x32_bf16 v[80:83], a[68:71], a[36:39], v[80:83]
    s_add_u32 m0, s48, 32768
    ds_read_b128 a[192:195], v26 offset:0
    v_mfma_f32_16x16x32_bf16 v[176:179], a[76:79], a[36:39], v[176:179]
    buffer_load_dwordx4 v10, s[16:19], s49 offen offset:0 lds
    ds_read_b64_tr_b16 a[0:1], v28 offset:0
    v_mfma_f32_16x16x32_bf16 v[176:179], a[72:75], a[32:35], v[176:179]
    ds_read_b128 a[196:199], v27 offset:0
    v_mfma_f32_16x16x32_bf16 v[112:115], a[80:83], a[32:35], v[112:115]
    buffer_load_dwordx4 v11, s[16:19], s49 offen offset:1024 lds
    v_mfma_f32_16x16x32_bf16 v[112:115], a[84:87], a[36:39], v[112:115]
    ds_read_b64_tr_b16 a[2:3], v28 offset:2048
    v_mfma_f32_16x16x32_bf16 v[208:211], a[92:95], a[36:39], v[208:211]
    v_mfma_f32_16x16x32_bf16 v[208:211], a[88:91], a[32:35], v[208:211]
    ds_read_b128 a[200:203], v26 offset:2048
    v_mfma_f32_16x16x32_bf16 v[144:147], a[96:99], a[32:35], v[144:147]
    buffer_load_dwordx4 v12, s[16:19], s49 offen offset:2048 lds
    ds_read_b64_tr_b16 a[4:5], v28 offset:16384
    v_mfma_f32_16x16x32_bf16 v[144:147], a[100:103], a[36:39], v[144:147]
    v_mfma_f32_16x16x32_bf16 v[240:243], a[108:111], a[36:39], v[240:243]
    ds_read_b128 a[204:207], v27 offset:2048
    v_mfma_f32_16x16x32_bf16 v[240:243], a[104:107], a[32:35], v[240:243]
    buffer_load_dwordx4 v13, s[16:19], s49 offen offset:3072 lds
    v_mfma_f32_16x16x32_bf16 a[160:163], a[112:115], a[32:35], a[160:163]
    ds_read_b64_tr_b16 a[6:7], v28 offset:18432
    v_mfma_f32_16x16x32_bf16 a[160:163], a[116:119], a[36:39], a[160:163]
    s_add_u32 m0, s48, 36864
    ds_read_b128 a[208:211], v26 offset:4096
    v_mfma_f32_16x16x32_bf16 a[164:167], a[124:127], a[36:39], a[164:167]
    v_mfma_f32_16x16x32_bf16 a[164:167], a[120:123], a[32:35], a[164:167]
    buffer_load_dwordx4 v14, s[16:19], s49 offen offset:0 lds
    ds_read_b64_tr_b16 a[8:9], v29 offset:0
    v_mfma_f32_16x16x32_bf16 a[172:175], a[120:123], a[40:43], a[172:175]
    v_mfma_f32_16x16x32_bf16 a[172:175], a[124:127], a[44:47], a[172:175]
    ds_read_b128 a[212:215], v27 offset:4096
    v_mfma_f32_16x16x32_bf16 a[168:171], a[116:119], a[44:47], a[168:171]
    buffer_load_dwordx4 v15, s[16:19], s49 offen offset:1024 lds
    ds_read_b64_tr_b16 a[10:11], v29 offset:2048
    v_mfma_f32_16x16x32_bf16 a[168:171], a[112:115], a[40:43], a[168:171]
    v_mfma_f32_16x16x32_bf16 v[244:247], a[104:107], a[40:43], v[244:247]
    ds_read_b128 a[216:219], v26 offset:6144
    v_mfma_f32_16x16x32_bf16 v[244:247], a[108:111], a[44:47], v[244:247]
    v_mfma_f32_16x16x32_bf16 v[148:151], a[100:103], a[44:47], v[148:151]
    buffer_load_dwordx4 v16, s[16:19], s49 offen offset:2048 lds
    ds_read_b64_tr_b16 a[12:13], v29 offset:16384
    v_mfma_f32_16x16x32_bf16 v[148:151], a[96:99], a[40:43], v[148:151]
    ds_read_b128 a[220:223], v27 offset:6144
    v_mfma_f32_16x16x32_bf16 v[212:215], a[88:91], a[40:43], v[212:215]
    v_mfma_f32_16x16x32_bf16 v[212:215], a[92:95], a[44:47], v[212:215]
    buffer_load_dwordx4 v17, s[16:19], s49 offen offset:3072 lds
    ds_read_b64_tr_b16 a[14:15], v29 offset:18432
    v_mfma_f32_16x16x32_bf16 v[116:119], a[84:87], a[44:47], v[116:119]
    ds_read_b128 a[224:227], v26 offset:8192
    v_mfma_f32_16x16x32_bf16 v[116:119], a[80:83], a[40:43], v[116:119]
    s_add_u32 s49, s49, 128
    v_mfma_f32_16x16x32_bf16 v[180:183], a[72:75], a[40:43], v[180:183]
    s_add_u32 m0, s48, 98304
    ds_read_b64_tr_b16 a[16:17], v30 offset:0
    v_mfma_f32_16x16x32_bf16 v[180:183], a[76:79], a[44:47], v[180:183]
    buffer_load_dwordx4 v18, s[20:23], s50 offen offset:0 lds
    v_mfma_f32_16x16x32_bf16 v[84:87], a[68:71], a[44:47], v[84:87]
    ds_read_b128 a[228:231], v27 offset:8192
    v_mfma_f32_16x16x32_bf16 v[84:87], a[64:67], a[40:43], v[84:87]
    ds_read_b64_tr_b16 a[18:19], v30 offset:2048
    v_mfma_f32_16x16x32_bf16 v[88:91], a[64:67], a[48:51], v[88:91]
    buffer_load_dwordx4 v19, s[20:23], s50 offen offset:1024 lds
    v_mfma_f32_16x16x32_bf16 v[88:91], a[68:71], a[52:55], v[88:91]
    ds_read_b128 a[232:235], v26 offset:10240
    v_mfma_f32_16x16x32_bf16 v[184:187], a[76:79], a[52:55], v[184:187]
    v_mfma_f32_16x16x32_bf16 v[184:187], a[72:75], a[48:51], v[184:187]
    buffer_load_dwordx4 v20, s[20:23], s50 offen offset:2048 lds
    ds_read_b64_tr_b16 a[20:21], v30 offset:16384
    v_mfma_f32_16x16x32_bf16 v[120:123], a[80:83], a[48:51], v[120:123]
    ds_read_b128 a[236:239], v27 offset:10240
    v_mfma_f32_16x16x32_bf16 v[120:123], a[84:87], a[52:55], v[120:123]
    v_mfma_f32_16x16x32_bf16 v[216:219], a[92:95], a[52:55], v[216:219]
    ds_read_b64_tr_b16 a[22:23], v30 offset:18432
    v_mfma_f32_16x16x32_bf16 v[216:219], a[88:91], a[48:51], v[216:219]
    buffer_load_dwordx4 v21, s[20:23], s50 offen offset:3072 lds
    v_mfma_f32_16x16x32_bf16 v[152:155], a[96:99], a[48:51], v[152:155]
    s_add_u32 m0, s48, 102400
    ds_read_b128 a[240:243], v26 offset:12288
    v_mfma_f32_16x16x32_bf16 v[152:155], a[100:103], a[52:55], v[152:155]
    ds_read_b64_tr_b16 a[24:25], v31 offset:0
    v_mfma_f32_16x16x32_bf16 v[248:251], a[108:111], a[52:55], v[248:251]
    buffer_load_dwordx4 v22, s[20:23], s50 offen offset:0 lds
    v_mfma_f32_16x16x32_bf16 v[248:251], a[104:107], a[48:51], v[248:251]
    ds_read_b128 a[244:247], v27 offset:12288
    v_mfma_f32_16x16x32_bf16 a[176:179], a[112:115], a[48:51], a[176:179]
    v_mfma_f32_16x16x32_bf16 a[176:179], a[116:119], a[52:55], a[176:179]
    ds_read_b64_tr_b16 a[26:27], v31 offset:2048
    v_mfma_f32_16x16x32_bf16 a[180:183], a[124:127], a[52:55], a[180:183]
    buffer_load_dwordx4 v23, s[20:23], s50 offen offset:1024 lds
    ds_read_b128 a[248:251], v26 offset:14336
    v_mfma_f32_16x16x32_bf16 a[180:183], a[120:123], a[48:51], a[180:183]
    v_mfma_f32_16x16x32_bf16 a[188:191], a[120:123], a[56:59], a[188:191]
    ds_read_b64_tr_b16 a[28:29], v31 offset:16384
    v_mfma_f32_16x16x32_bf16 a[188:191], a[124:127], a[60:63], a[188:191]
    buffer_load_dwordx4 v24, s[20:23], s50 offen offset:2048 lds
    v_mfma_f32_16x16x32_bf16 a[184:187], a[116:119], a[60:63], a[184:187]
    ds_read_b128 a[252:255], v27 offset:14336
    v_mfma_f32_16x16x32_bf16 a[184:187], a[112:115], a[56:59], a[184:187]
    ds_read_b64_tr_b16 a[30:31], v31 offset:18432
    v_mfma_f32_16x16x32_bf16 v[252:255], a[104:107], a[56:59], v[252:255]
    v_mfma_f32_16x16x32_bf16 v[252:255], a[108:111], a[60:63], v[252:255]
    buffer_load_dwordx4 v25, s[20:23], s50 offen offset:3072 lds
    v_mfma_f32_16x16x32_bf16 v[156:159], a[100:103], a[60:63], v[156:159]
    v_mfma_f32_16x16x32_bf16 v[156:159], a[96:99], a[56:59], v[156:159]
    s_add_u32 s50, s50, 0x80000
    v_mfma_f32_16x16x32_bf16 v[220:223], a[88:91], a[56:59], v[220:223]
    v_mfma_f32_16x16x32_bf16 v[220:223], a[92:95], a[60:63], v[220:223]
    s_cmp_eq_u32 s51, s53
    s_cbranch_scc1 k12_ool_42
k12_oolret_43:
    v_mfma_f32_16x16x32_bf16 v[124:127], a[84:87], a[60:63], v[124:127]
    s_cmp_eq_u32 s51, s63
    s_cbranch_scc1 k12_ool_44
k12_oolret_45:
    v_mfma_f32_16x16x32_bf16 v[124:127], a[80:83], a[56:59], v[124:127]
    s_cmp_eq_u32 s51, 5
    s_cbranch_scc1 k12_ool_46
k12_oolret_47:
    v_mfma_f32_16x16x32_bf16 v[188:191], a[72:75], a[56:59], v[188:191]
    v_mfma_f32_16x16x32_bf16 v[188:191], a[76:79], a[60:63], v[188:191]
    s_add_u32 s51, s51, 1
    v_mfma_f32_16x16x32_bf16 v[92:95], a[68:71], a[60:63], v[92:95]
    v_mfma_f32_16x16x32_bf16 v[92:95], a[64:67], a[56:59], v[92:95]
    s_waitcnt lgkmcnt(0)
    s_branch k12_loop_28
k12_last_29:
    v_mfma_f32_16x16x32_bf16 v[64:67], a[64:67], a[0:3], v[64:67]
    buffer_load_dwordx4 a[192:195], v36, s[8:11], s62 offen sc1
    v_mfma_f32_16x16x32_bf16 v[64:67], a[68:71], a[4:7], v[64:67]
    ds_read_b64_tr_b16 a[32:33], v32 offset:32768
    v_mfma_f32_16x16x32_bf16 v[160:163], a[76:79], a[4:7], v[160:163]
    buffer_load_dwordx4 a[196:199], v54, s[8:11], s62 offen sc1
    ds_read_b64_tr_b16 a[34:35], v32 offset:34816
    v_mfma_f32_16x16x32_bf16 v[160:163], a[72:75], a[0:3], v[160:163]
    v_mfma_f32_16x16x32_bf16 v[96:99], a[80:83], a[0:3], v[96:99]
    buffer_load_dwordx4 a[200:203], v37, s[8:11], s62 offen sc1
    v_mfma_f32_16x16x32_bf16 v[96:99], a[84:87], a[4:7], v[96:99]
    ds_read_b64_tr_b16 a[36:37], v32 offset:49152
    v_mfma_f32_16x16x32_bf16 v[192:195], a[92:95], a[4:7], v[192:195]
    buffer_load_dwordx4 a[204:207], v55, s[8:11], s62 offen sc1
    v_mfma_f32_16x16x32_bf16 v[192:195], a[88:91], a[0:3], v[192:195]
    s_add_u32 s62, s62, 0x20000
    buffer_load_dwordx4 a[208:211], v36, s[8:11], s62 offen sc1
    ds_read_b64_tr_b16 a[38:39], v32 offset:51200
    v_mfma_f32_16x16x32_bf16 v[128:131], a[96:99], a[0:3], v[128:131]
    v_mfma_f32_16x16x32_bf16 v[128:131], a[100:103], a[4:7], v[128:131]
    v_cvt_pk_bf16_f32 v64, v64, v65
    v_cvt_pk_bf16_f32 v65, v66, v67
    v_mfma_f32_16x16x32_bf16 v[224:227], a[108:111], a[4:7], v[224:227]
    v_cvt_pk_bf16_f32 v66, v160, v161
    v_cvt_pk_bf16_f32 v67, v162, v163
    v_mfma_f32_16x16x32_bf16 v[224:227], a[104:107], a[0:3], v[224:227]
    buffer_load_dwordx4 a[212:215], v54, s[8:11], s62 offen sc1
    ds_read_b64_tr_b16 a[40:41], v33 offset:32768
    v_mfma_f32_16x16x32_bf16 a[128:131], a[112:115], a[0:3], a[128:131]
    buffer_load_dwordx4 a[216:219], v37, s[8:11], s62 offen sc1
    ds_read_b64_tr_b16 a[42:43], v33 offset:34816
    v_mfma_f32_16x16x32_bf16 a[128:131], a[116:119], a[4:7], a[128:131]
    v_cvt_pk_bf16_f32 v96, v96, v97
    v_cvt_pk_bf16_f32 v97, v98, v99
    v_mfma_f32_16x16x32_bf16 a[132:135], a[124:127], a[4:7], a[132:135]
    v_cvt_pk_bf16_f32 v98, v192, v193
    v_cvt_pk_bf16_f32 v99, v194, v195
    v_mfma_f32_16x16x32_bf16 a[132:135], a[120:123], a[0:3], a[132:135]
    buffer_load_dwordx4 a[220:223], v55, s[8:11], s62 offen sc1
    ds_read_b64_tr_b16 a[44:45], v33 offset:49152
    v_mfma_f32_16x16x32_bf16 v[68:71], a[64:67], a[8:11], v[68:71]
    s_add_u32 s62, s62, 0x20000
    buffer_load_dwordx4 a[224:227], v36, s[8:11], s62 offen sc1
    v_mfma_f32_16x16x32_bf16 v[68:71], a[68:71], a[12:15], v[68:71]
    v_cvt_pk_bf16_f32 v128, v128, v129
    v_cvt_pk_bf16_f32 v129, v130, v131
    v_mfma_f32_16x16x32_bf16 v[164:167], a[76:79], a[12:15], v[164:167]
    buffer_load_dwordx4 a[228:231], v54, s[8:11], s62 offen sc1
    ds_read_b64_tr_b16 a[46:47], v33 offset:51200
    v_mfma_f32_16x16x32_bf16 v[164:167], a[72:75], a[8:11], v[164:167]
    v_cvt_pk_bf16_f32 v130, v224, v225
    v_cvt_pk_bf16_f32 v131, v226, v227
    v_mfma_f32_16x16x32_bf16 v[100:103], a[80:83], a[8:11], v[100:103]
    buffer_load_dwordx4 a[232:235], v37, s[8:11], s62 offen sc1
    ds_read_b64_tr_b16 a[48:49], v34 offset:32768
    v_mfma_f32_16x16x32_bf16 v[100:103], a[84:87], a[12:15], v[100:103]
    v_accvgpr_read_b32 v56, a128
    v_accvgpr_read_b32 v57, a129
    v_mfma_f32_16x16x32_bf16 v[196:199], a[92:95], a[12:15], v[196:199]
    buffer_load_dwordx4 a[236:239], v55, s[8:11], s62 offen sc1
    ds_read_b64_tr_b16 a[50:51], v34 offset:34816
    v_mfma_f32_16x16x32_bf16 v[196:199], a[88:91], a[8:11], v[196:199]
    s_add_u32 s62, s62, 0x20000
    v_accvgpr_read_b32 v58, a130
    v_accvgpr_read_b32 v59, a131
    v_mfma_f32_16x16x32_bf16 v[132:135], a[96:99], a[8:11], v[132:135]
    v_accvgpr_read_b32 v60, a132
    v_accvgpr_read_b32 v61, a133
    v_mfma_f32_16x16x32_bf16 v[132:135], a[100:103], a[12:15], v[132:135]
    v_accvgpr_read_b32 v62, a134
    v_accvgpr_read_b32 v63, a135
    v_mfma_f32_16x16x32_bf16 v[228:231], a[108:111], a[12:15], v[228:231]
    buffer_load_dwordx4 a[240:243], v36, s[8:11], s62 offen sc1
    ds_read_b64_tr_b16 a[52:53], v34 offset:49152
    v_mfma_f32_16x16x32_bf16 v[228:231], a[104:107], a[8:11], v[228:231]
    v_cvt_pk_bf16_f32 v160, v56, v57
    v_cvt_pk_bf16_f32 v161, v58, v59
    v_mfma_f32_16x16x32_bf16 a[136:139], a[112:115], a[8:11], a[136:139]
    v_cvt_pk_bf16_f32 v68, v68, v69
    v_cvt_pk_bf16_f32 v162, v60, v61
    v_mfma_f32_16x16x32_bf16 a[136:139], a[116:119], a[12:15], a[136:139]
    buffer_load_dwordx4 a[244:247], v54, s[8:11], s62 offen sc1
    v_cvt_pk_bf16_f32 v69, v70, v71
    v_mfma_f32_16x16x32_bf16 a[140:143], a[124:127], a[12:15], a[140:143]
    v_cvt_pk_bf16_f32 v163, v62, v63
    v_cvt_pk_bf16_f32 v70, v164, v165
    v_mfma_f32_16x16x32_bf16 a[140:143], a[120:123], a[8:11], a[140:143]
    buffer_load_dwordx4 a[248:251], v37, s[8:11], s62 offen sc1
    v_cvt_pk_bf16_f32 v71, v166, v167
    v_mfma_f32_16x16x32_bf16 v[72:75], a[64:67], a[16:19], v[72:75]
    ds_read_b64_tr_b16 a[54:55], v34 offset:51200
    v_cvt_pk_bf16_f32 v100, v100, v101
    v_mfma_f32_16x16x32_bf16 v[72:75], a[68:71], a[20:23], v[72:75]
    buffer_load_dwordx4 a[252:255], v55, s[8:11], s62 offen sc1
    v_cvt_pk_bf16_f32 v101, v102, v103
    v_mfma_f32_16x16x32_bf16 v[168:171], a[76:79], a[20:23], v[168:171]
    s_add_u32 s62, s62, 0x20000
    ds_read_b64_tr_b16 a[56:57], v35 offset:32768
    v_cvt_pk_bf16_f32 v102, v196, v197
    v_mfma_f32_16x16x32_bf16 v[168:171], a[72:75], a[16:19], v[168:171]
    s_add_u32 s52, s47, 0
    ds_read_b64_tr_b16 a[58:59], v35 offset:34816
    v_cvt_pk_bf16_f32 v103, v198, v199
    v_mfma_f32_16x16x32_bf16 v[104:107], a[80:83], a[16:19], v[104:107]
    v_cvt_pk_bf16_f32 v132, v132, v133
    v_cvt_pk_bf16_f32 v133, v134, v135
    v_mfma_f32_16x16x32_bf16 v[104:107], a[84:87], a[20:23], v[104:107]
    v_cvt_pk_bf16_f32 v134, v228, v229
    v_cvt_pk_bf16_f32 v135, v230, v231
    v_mfma_f32_16x16x32_bf16 v[200:203], a[92:95], a[20:23], v[200:203]
    buffer_store_dwordx4 v[64:67], v1, s[32:35], s52 offen offset:0 sc1
    ds_read_b64_tr_b16 a[60:61], v35 offset:49152
    v_mfma_f32_16x16x32_bf16 v[200:203], a[88:91], a[16:19], v[200:203]
    v_accvgpr_read_b32 v56, a136
    v_accvgpr_read_b32 v57, a137
    v_mfma_f32_16x16x32_bf16 v[136:139], a[96:99], a[16:19], v[136:139]
    ds_read_b64_tr_b16 a[62:63], v35 offset:51200
    v_accvgpr_read_b32 v58, a138
    v_mfma_f32_16x16x32_bf16 v[136:139], a[100:103], a[20:23], v[136:139]
    v_accvgpr_read_b32 v59, a139
    v_accvgpr_read_b32 v60, a140
    v_mfma_f32_16x16x32_bf16 v[232:235], a[108:111], a[20:23], v[232:235]
    v_accvgpr_read_b32 v61, a141
    v_accvgpr_read_b32 v62, a142
    v_mfma_f32_16x16x32_bf16 v[232:235], a[104:107], a[16:19], v[232:235]
    s_add_u32 s52, s47, 8192
    v_accvgpr_read_b32 v63, a143
    v_cvt_pk_bf16_f32 v164, v56, v57
    v_mfma_f32_16x16x32_bf16 a[144:147], a[112:115], a[16:19], a[144:147]
    v_cvt_pk_bf16_f32 v165, v58, v59
    v_cvt_pk_bf16_f32 v72, v72, v73
    v_mfma_f32_16x16x32_bf16 a[144:147], a[116:119], a[20:23], a[144:147]
    v_cvt_pk_bf16_f32 v166, v60, v61
    v_cvt_pk_bf16_f32 v73, v74, v75
    v_mfma_f32_16x16x32_bf16 a[148:151], a[124:127], a[20:23], a[148:151]
    v_cvt_pk_bf16_f32 v167, v62, v63
    v_cvt_pk_bf16_f32 v74, v168, v169
    v_mfma_f32_16x16x32_bf16 a[148:151], a[120:123], a[16:19], a[148:151]
    v_cvt_pk_bf16_f32 v75, v170, v171
    v_cvt_pk_bf16_f32 v104, v104, v105
    v_mfma_f32_16x16x32_bf16 v[76:79], a[64:67], a[24:27], v[76:79]
    v_cvt_pk_bf16_f32 v105, v106, v107
    v_cvt_pk_bf16_f32 v106, v200, v201
    v_mfma_f32_16x16x32_bf16 v[76:79], a[68:71], a[28:31], v[76:79]
    buffer_store_dwordx4 v[96:99], v1, s[32:35], s52 offen offset:0 sc1
    v_mfma_f32_16x16x32_bf16 v[172:175], a[76:79], a[28:31], v[172:175]
    v_cvt_pk_bf16_f32 v107, v202, v203
    v_cvt_pk_bf16_f32 v136, v136, v137
    v_mfma_f32_16x16x32_bf16 v[172:175], a[72:75], a[24:27], v[172:175]
    v_cvt_pk_bf16_f32 v137, v138, v139
    v_cvt_pk_bf16_f32 v138, v232, v233
    v_mfma_f32_16x16x32_bf16 v[108:111], a[80:83], a[24:27], v[108:111]
    v_cvt_pk_bf16_f32 v139, v234, v235
    v_mfma_f32_16x16x32_bf16 v[108:111], a[84:87], a[28:31], v[108:111]
    v_accvgpr_read_b32 v56, a144
    v_accvgpr_read_b32 v57, a145
    v_mfma_f32_16x16x32_bf16 v[204:207], a[92:95], a[28:31], v[204:207]
    v_accvgpr_read_b32 v58, a146
    v_accvgpr_read_b32 v59, a147
    v_mfma_f32_16x16x32_bf16 v[204:207], a[88:91], a[24:27], v[204:207]
    s_add_u32 s52, s47, 524288
    v_accvgpr_read_b32 v60, a148
    v_accvgpr_read_b32 v61, a149
    v_mfma_f32_16x16x32_bf16 v[140:143], a[96:99], a[24:27], v[140:143]
    v_accvgpr_read_b32 v62, a150
    v_accvgpr_read_b32 v63, a151
    v_mfma_f32_16x16x32_bf16 v[140:143], a[100:103], a[28:31], v[140:143]
    v_cvt_pk_bf16_f32 v168, v56, v57
    v_cvt_pk_bf16_f32 v169, v58, v59
    v_mfma_f32_16x16x32_bf16 v[236:239], a[108:111], a[28:31], v[236:239]
    v_cvt_pk_bf16_f32 v76, v76, v77
    v_cvt_pk_bf16_f32 v170, v60, v61
    v_mfma_f32_16x16x32_bf16 v[236:239], a[104:107], a[24:27], v[236:239]
    buffer_store_dwordx4 v[128:131], v1, s[32:35], s52 offen offset:0 sc1
    v_mfma_f32_16x16x32_bf16 a[152:155], a[112:115], a[24:27], a[152:155]
    s_waitcnt lgkmcnt(0)
    v_cvt_pk_bf16_f32 v77, v78, v79
    v_cvt_pk_bf16_f32 v171, v62, v63
    v_mfma_f32_16x16x32_bf16 a[152:155], a[116:119], a[28:31], a[152:155]
    v_cvt_pk_bf16_f32 v78, v172, v173
    v_cvt_pk_bf16_f32 v79, v174, v175
    v_mfma_f32_16x16x32_bf16 a[156:159], a[124:127], a[28:31], a[156:159]
    v_cvt_pk_bf16_f32 v108, v108, v109
    v_cvt_pk_bf16_f32 v109, v110, v111
    v_mfma_f32_16x16x32_bf16 a[156:159], a[120:123], a[24:27], a[156:159]
    v_cvt_pk_bf16_f32 v110, v204, v205
    v_cvt_pk_bf16_f32 v111, v206, v207
    v_mfma_f32_16x16x32_bf16 v[80:83], a[64:67], a[32:35], v[80:83]
    v_mfma_f32_16x16x32_bf16 v[80:83], a[68:71], a[36:39], v[80:83]
    v_cvt_pk_bf16_f32 v140, v140, v141
    v_cvt_pk_bf16_f32 v141, v142, v143
    v_mfma_f32_16x16x32_bf16 v[176:179], a[76:79], a[36:39], v[176:179]
    s_add_u32 s52, s47, 532480
    v_cvt_pk_bf16_f32 v142, v236, v237
    v_cvt_pk_bf16_f32 v143, v238, v239
    v_mfma_f32_16x16x32_bf16 v[176:179], a[72:75], a[32:35], v[176:179]
    buffer_store_dwordx4 v[160:163], v1, s[32:35], s52 offen offset:0 sc1
    v_mfma_f32_16x16x32_bf16 v[112:115], a[80:83], a[32:35], v[112:115]
    v_mfma_f32_16x16x32_bf16 v[112:115], a[84:87], a[36:39], v[112:115]
    v_accvgpr_read_b32 v56, a152
    v_accvgpr_read_b32 v57, a153
    v_mfma_f32_16x16x32_bf16 v[208:211], a[92:95], a[36:39], v[208:211]
    v_accvgpr_read_b32 v58, a154
    v_accvgpr_read_b32 v59, a155
    v_mfma_f32_16x16x32_bf16 v[208:211], a[88:91], a[32:35], v[208:211]
    v_accvgpr_read_b32 v60, a156
    v_accvgpr_read_b32 v61, a157
    v_mfma_f32_16x16x32_bf16 v[144:147], a[96:99], a[32:35], v[144:147]
    v_accvgpr_read_b32 v62, a158
    v_accvgpr_read_b32 v63, a159
    v_mfma_f32_16x16x32_bf16 v[144:147], a[100:103], a[36:39], v[144:147]
    v_cvt_pk_bf16_f32 v172, v56, v57
    v_cvt_pk_bf16_f32 v173, v58, v59
    v_mfma_f32_16x16x32_bf16 v[240:243], a[108:111], a[36:39], v[240:243]
    v_cvt_pk_bf16_f32 v80, v80, v81
    v_cvt_pk_bf16_f32 v174, v60, v61
    v_mfma_f32_16x16x32_bf16 v[240:243], a[104:107], a[32:35], v[240:243]
    v_cvt_pk_bf16_f32 v81, v82, v83
    v_cvt_pk_bf16_f32 v175, v62, v63
    v_mfma_f32_16x16x32_bf16 a[160:163], a[112:115], a[32:35], a[160:163]
    v_cvt_pk_bf16_f32 v82, v176, v177
    v_cvt_pk_bf16_f32 v83, v178, v179
    v_mfma_f32_16x16x32_bf16 a[160:163], a[116:119], a[36:39], a[160:163]
    v_cvt_pk_bf16_f32 v112, v112, v113
    v_cvt_pk_bf16_f32 v113, v114, v115
    v_mfma_f32_16x16x32_bf16 a[164:167], a[124:127], a[36:39], a[164:167]
    s_add_u32 s52, s47, 0
    v_cvt_pk_bf16_f32 v114, v208, v209
    v_cvt_pk_bf16_f32 v115, v210, v211
    v_mfma_f32_16x16x32_bf16 a[164:167], a[120:123], a[32:35], a[164:167]
    buffer_store_dwordx4 v[68:71], v1, s[32:35], s52 offen offset:1024 sc1
    v_mfma_f32_16x16x32_bf16 v[84:87], a[64:67], a[40:43], v[84:87]
    v_mfma_f32_16x16x32_bf16 v[84:87], a[68:71], a[44:47], v[84:87]
    v_cvt_pk_bf16_f32 v144, v144, v145
    v_cvt_pk_bf16_f32 v145, v146, v147
    v_mfma_f32_16x16x32_bf16 v[180:183], a[76:79], a[44:47], v[180:183]
    v_cvt_pk_bf16_f32 v146, v240, v241
    v_cvt_pk_bf16_f32 v147, v242, v243
    v_mfma_f32_16x16x32_bf16 v[180:183], a[72:75], a[40:43], v[180:183]
    v_mfma_f32_16x16x32_bf16 v[116:119], a[80:83], a[40:43], v[116:119]
    v_mfma_f32_16x16x32_bf16 v[116:119], a[84:87], a[44:47], v[116:119]
    v_accvgpr_read_b32 v56, a160
    v_accvgpr_read_b32 v57, a161
    v_mfma_f32_16x16x32_bf16 v[212:215], a[92:95], a[44:47], v[212:215]
    v_accvgpr_read_b32 v58, a162
    v_accvgpr_read_b32 v59, a163
    v_mfma_f32_16x16x32_bf16 v[212:215], a[88:91], a[40:43], v[212:215]
    v_accvgpr_read_b32 v60, a164
    v_accvgpr_read_b32 v61, a165
    v_mfma_f32_16x16x32_bf16 v[148:151], a[96:99], a[40:43], v[148:151]
    v_accvgpr_read_b32 v62, a166
    v_accvgpr_read_b32 v63, a167
    v_mfma_f32_16x16x32_bf16 v[148:151], a[100:103], a[44:47], v[148:151]
    s_add_u32 s52, s47, 8192
    v_cvt_pk_bf16_f32 v176, v56, v57
    v_cvt_pk_bf16_f32 v177, v58, v59
    v_mfma_f32_16x16x32_bf16 v[244:247], a[108:111], a[44:47], v[244:247]
    v_cvt_pk_bf16_f32 v84, v84, v85
    v_cvt_pk_bf16_f32 v178, v60, v61
    v_mfma_f32_16x16x32_bf16 v[244:247], a[104:107], a[40:43], v[244:247]
    v_cvt_pk_bf16_f32 v85, v86, v87
    v_cvt_pk_bf16_f32 v179, v62, v63
    v_mfma_f32_16x16x32_bf16 a[168:171], a[112:115], a[40:43], a[168:171]
    v_cvt_pk_bf16_f32 v86, v180, v181
    v_cvt_pk_bf16_f32 v87, v182, v183
    v_mfma_f32_16x16x32_bf16 a[168:171], a[116:119], a[44:47], a[168:171]
    buffer_store_dwordx4 v[100:103], v1, s[32:35], s52 offen offset:1024 sc1
    v_mfma_f32_16x16x32_bf16 a[172:175], a[124:127], a[44:47], a[172:175]
    v_cvt_pk_bf16_f32 v116, v116, v117
    v_cvt_pk_bf16_f32 v117, v118, v119
    v_mfma_f32_16x16x32_bf16 a[172:175], a[120:123], a[40:43], a[172:175]
    v_cvt_pk_bf16_f32 v118, v212, v213
    v_cvt_pk_bf16_f32 v119, v214, v215
    v_mfma_f32_16x16x32_bf16 v[88:91], a[64:67], a[48:51], v[88:91]
    s_waitcnt vmcnt(16)
    s_barrier
    v_mfma_f32_16x16x32_bf16 v[88:91], a[68:71], a[52:55], v[88:91]
    ds_read_b64_tr_b16 a[0:1], v42 offset:32768
    v_cvt_pk_bf16_f32 v148, v148, v149
    v_mfma_f32_16x16x32_bf16 v[184:187], a[76:79], a[52:55], v[184:187]
    v_cvt_pk_bf16_f32 v149, v150, v151
    v_cvt_pk_bf16_f32 v150, v244, v245
    v_mfma_f32_16x16x32_bf16 v[184:187], a[72:75], a[48:51], v[184:187]
    ds_read_b64_tr_b16 a[2:3], v42 offset:33792
    v_cvt_pk_bf16_f32 v151, v246, v247
    v_mfma_f32_16x16x32_bf16 v[120:123], a[80:83], a[48:51], v[120:123]
    ds_read_b64_tr_b16 a[4:5], v42 offset:40960
    ds_read_b64_tr_b16 a[6:7], v42 offset:41984
    v_mfma_f32_16x16x32_bf16 v[120:123], a[84:87], a[52:55], v[120:123]
    s_add_u32 s52, s47, 524288
    v_accvgpr_read_b32 v56, a168
    v_accvgpr_read_b32 v57, a169
    v_mfma_f32_16x16x32_bf16 v[216:219], a[92:95], a[52:55], v[216:219]
    v_accvgpr_read_b32 v58, a170
    v_accvgpr_read_b32 v59, a171
    v_mfma_f32_16x16x32_bf16 v[216:219], a[88:91], a[48:51], v[216:219]
    ds_read_b64_tr_b16 a[8:9], v43 offset:32768
    v_accvgpr_read_b32 v60, a172
    v_mfma_f32_16x16x32_bf16 v[152:155], a[96:99], a[48:51], v[152:155]
    buffer_store_dwordx4 v[132:135], v1, s[32:35], s52 offen offset:1024 sc1
    ds_read_b64_tr_b16 a[10:11], v43 offset:33792
    v_mfma_f32_16x16x32_bf16 v[152:155], a[100:103], a[52:55], v[152:155]
    v_accvgpr_read_b32 v61, a173
    v_accvgpr_read_b32 v62, a174
    v_mfma_f32_16x16x32_bf16 v[248:251], a[108:111], a[52:55], v[248:251]
    v_accvgpr_read_b32 v63, a175
    v_cvt_pk_bf16_f32 v180, v56, v57
    v_mfma_f32_16x16x32_bf16 v[248:251], a[104:107], a[48:51], v[248:251]
    v_cvt_pk_bf16_f32 v181, v58, v59
    v_cvt_pk_bf16_f32 v88, v88, v89
    v_mfma_f32_16x16x32_bf16 a[176:179], a[112:115], a[48:51], a[176:179]
    v_cvt_pk_bf16_f32 v182, v60, v61
    v_cvt_pk_bf16_f32 v89, v90, v91
    v_mfma_f32_16x16x32_bf16 a[176:179], a[116:119], a[52:55], a[176:179]
    ds_read_b64_tr_b16 a[12:13], v43 offset:40960
    v_cvt_pk_bf16_f32 v183, v62, v63
    v_mfma_f32_16x16x32_bf16 a[180:183], a[124:127], a[52:55], a[180:183]
    v_cvt_pk_bf16_f32 v90, v184, v185
    v_cvt_pk_bf16_f32 v91, v186, v187
    v_mfma_f32_16x16x32_bf16 a[180:183], a[120:123], a[48:51], a[180:183]
    ds_read_b64_tr_b16 a[14:15], v43 offset:41984
    ds_read_b64_tr_b16 a[16:17], v44 offset:32768
    v_mfma_f32_16x16x32_bf16 v[92:95], a[64:67], a[56:59], v[92:95]
    s_add_u32 s52, s47, 532480
    v_cvt_pk_bf16_f32 v120, v120, v121
    v_cvt_pk_bf16_f32 v121, v122, v123
    v_mfma_f32_16x16x32_bf16 v[92:95], a[68:71], a[60:63], v[92:95]
    ds_read_b64_tr_b16 a[18:19], v44 offset:33792
    v_cvt_pk_bf16_f32 v122, v216, v217
    v_mfma_f32_16x16x32_bf16 v[188:191], a[76:79], a[60:63], v[188:191]
    ds_read_b64_tr_b16 a[20:21], v44 offset:40960
    v_cvt_pk_bf16_f32 v123, v218, v219
    v_mfma_f32_16x16x32_bf16 v[188:191], a[72:75], a[56:59], v[188:191]
    ds_read_b64_tr_b16 a[22:23], v44 offset:41984
    v_cvt_pk_bf16_f32 v152, v152, v153
    v_mfma_f32_16x16x32_bf16 v[124:127], a[80:83], a[56:59], v[124:127]
    v_cvt_pk_bf16_f32 v153, v154, v155
    v_cvt_pk_bf16_f32 v154, v248, v249
    v_mfma_f32_16x16x32_bf16 v[124:127], a[84:87], a[60:63], v[124:127]
    ds_read_b64_tr_b16 a[24:25], v45 offset:32768
    v_cvt_pk_bf16_f32 v155, v250, v251
    v_mfma_f32_16x16x32_bf16 v[220:223], a[92:95], a[60:63], v[220:223]
    buffer_store_dwordx4 v[164:167], v1, s[32:35], s52 offen offset:1024 sc1
    ds_read_b64_tr_b16 a[26:27], v45 offset:33792
    v_mfma_f32_16x16x32_bf16 v[220:223], a[88:91], a[56:59], v[220:223]
    ds_read_b64_tr_b16 a[28:29], v45 offset:40960
    v_accvgpr_read_b32 v56, a176
    v_mfma_f32_16x16x32_bf16 v[156:159], a[96:99], a[56:59], v[156:159]
    v_accvgpr_read_b32 v57, a177
    v_accvgpr_read_b32 v58, a178
    v_mfma_f32_16x16x32_bf16 v[156:159], a[100:103], a[60:63], v[156:159]
    ds_read_b64_tr_b16 a[30:31], v45 offset:41984
    v_accvgpr_read_b32 v59, a179
    v_mfma_f32_16x16x32_bf16 v[252:255], a[108:111], a[60:63], v[252:255]
    v_accvgpr_read_b32 v60, a180
    v_accvgpr_read_b32 v61, a181
    v_mfma_f32_16x16x32_bf16 v[252:255], a[104:107], a[56:59], v[252:255]
    v_accvgpr_read_b32 v62, a182
    v_accvgpr_read_b32 v63, a183
    v_mfma_f32_16x16x32_bf16 a[184:187], a[112:115], a[56:59], a[184:187]
    v_cvt_pk_bf16_f32 v184, v56, v57
    v_cvt_pk_bf16_f32 v185, v58, v59
    v_mfma_f32_16x16x32_bf16 a[184:187], a[116:119], a[60:63], a[184:187]
    v_cvt_pk_bf16_f32 v92, v92, v93
    v_cvt_pk_bf16_f32 v186, v60, v61
    v_mfma_f32_16x16x32_bf16 a[188:191], a[124:127], a[60:63], a[188:191]
    v_cvt_pk_bf16_f32 v93, v94, v95
    v_cvt_pk_bf16_f32 v187, v62, v63
    v_mfma_f32_16x16x32_bf16 a[188:191], a[120:123], a[56:59], a[188:191]
    v_cvt_pk_bf16_f32 v94, v188, v189
    v_cvt_pk_bf16_f32 v95, v190, v191
    v_cvt_pk_bf16_f32 v124, v124, v125
    v_cvt_pk_bf16_f32 v125, v126, v127
    v_cvt_pk_bf16_f32 v126, v220, v221
    v_cvt_pk_bf16_f32 v127, v222, v223
    v_cvt_pk_bf16_f32 v156, v156, v157
    v_cvt_pk_bf16_f32 v157, v158, v159
    v_cvt_pk_bf16_f32 v158, v252, v253
    v_cvt_pk_bf16_f32 v159, v254, v255
    v_accvgpr_read_b32 v56, a184
    v_accvgpr_read_b32 v57, a185
    v_accvgpr_read_b32 v58, a186
    v_accvgpr_read_b32 v59, a187
    v_accvgpr_read_b32 v60, a188
    v_accvgpr_read_b32 v61, a189
    v_accvgpr_read_b32 v62, a190
    v_accvgpr_read_b32 v63, a191
    v_cvt_pk_bf16_f32 v188, v56, v57
    v_cvt_pk_bf16_f32 v189, v58, v59
    v_cvt_pk_bf16_f32 v190, v60, v61
    v_cvt_pk_bf16_f32 v191, v62, v63
k12_join_7:
k12_qcode:
    s_mov_b64 s[48:49], s[32:33]
    s_mov_b32 s51, 0x00020000
    s_cmp_eq_u32 s45, 0
    s_mov_b32 s50, s34
    s_cselect_b32 s56, s30, -1
    s_cselect_b32 s57, -1, s30
    s_waitcnt vmcnt(16) lgkmcnt(0)
    v_mfma_f32_16x16x32_bf16 v[192:195], a[0:3], a[192:195], 0
    v_mfma_f32_16x16x32_bf16 v[192:195], a[4:7], a[208:211], v[192:195]
    buffer_load_dwordx4 a[128:131], v36, s[8:11], s62 offen sc1
    ds_read_b64_tr_b16 a[32:33], v46 offset:32768
    v_mfma_f32_16x16x32_bf16 v[196:199], a[4:7], a[212:215], 0
    ds_read_b64_tr_b16 a[34:35], v46 offset:33792
    v_mfma_f32_16x16x32_bf16 v[196:199], a[0:3], a[196:199], v[196:199]
    ds_read_b64_tr_b16 a[36:37], v46 offset:40960
    v_mfma_f32_16x16x32_bf16 a[64:67], a[0:3], a[200:203], 0
    ds_read_b64_tr_b16 a[38:39], v46 offset:41984
    v_mfma_f32_16x16x32_bf16 a[64:67], a[4:7], a[216:219], a[64:67]
    ds_read_b64_tr_b16 a[40:41], v47 offset:32768
    v_mfma_f32_16x16x32_bf16 a[68:71], a[4:7], a[220:223], 0
    s_lshl_b32 s31, s28, 14
    v_mfma_f32_16x16x32_bf16 a[68:71], a[0:3], a[204:207], a[68:71]
    s_add_u32 s16, s6, s31
    s_addc_u32 s17, s7, 0
    buffer_load_dwordx4 a[132:135], v54, s[8:11], s62 offen sc1
    ds_read_b64_tr_b16 a[42:43], v47 offset:33792
    v_mfma_f32_16x16x32_bf16 a[76:79], a[8:11], a[204:207], 0
    ds_read_b64_tr_b16 a[44:45], v47 offset:40960
    v_mfma_f32_16x16x32_bf16 a[76:79], a[12:15], a[220:223], a[76:79]
    s_add_u32 s20, s16, 0x2000000
    s_addc_u32 s21, s17, 0
    ds_read_b64_tr_b16 a[46:47], v47 offset:41984
    v_mfma_f32_16x16x32_bf16 a[72:75], a[12:15], a[216:219], 0
    ds_read_b64_tr_b16 a[48:49], v48 offset:32768
    v_mfma_f32_16x16x32_bf16 a[72:75], a[8:11], a[200:203], a[72:75]
    s_add_u32 s16, s16, 0x1000000
    s_addc_u32 s17, s17, 0
    v_mfma_f32_16x16x32_bf16 v[204:207], a[8:11], a[196:199], 0
    ds_read_b64_tr_b16 a[50:51], v48 offset:33792
    v_mfma_f32_16x16x32_bf16 v[204:207], a[12:15], a[212:215], v[204:207]
    s_and_b32 s17, s17, 0xffff
    ds_read_b64_tr_b16 a[52:53], v48 offset:40960
    v_mfma_f32_16x16x32_bf16 v[200:203], a[12:15], a[208:211], 0
    buffer_load_dwordx4 a[136:139], v37, s[8:11], s62 offen sc1
    ds_read_b64_tr_b16 a[54:55], v48 offset:41984
    v_mfma_f32_16x16x32_bf16 v[200:203], a[8:11], a[192:195], v[200:203]
    s_and_b32 s21, s21, 0xffff
    v_mfma_f32_16x16x32_bf16 v[208:211], a[16:19], a[192:195], 0
    ds_read_b64_tr_b16 a[56:57], v49 offset:32768
    v_mfma_f32_16x16x32_bf16 v[208:211], a[20:23], a[208:211], v[208:211]
    s_lshl_b32 s31, s29, 20
    ds_read_b64_tr_b16 a[58:59], v49 offset:33792
    v_mfma_f32_16x16x32_bf16 v[212:215], a[20:23], a[212:215], 0
    ds_read_b64_tr_b16 a[60:61], v49 offset:40960
    v_mfma_f32_16x16x32_bf16 v[212:215], a[16:19], a[196:199], v[212:215]
    s_sub_u32 s18, 0xf84000, s31
    v_mfma_f32_16x16x32_bf16 a[80:83], a[16:19], a[200:203], 0
    buffer_load_dwordx4 a[140:143], v55, s[8:11], s62 offen sc1
    ds_read_b64_tr_b16 a[62:63], v49 offset:41984
    v_mfma_f32_16x16x32_bf16 a[80:83], a[20:23], a[216:219], a[80:83]
    s_mov_b32 s22, s18
    v_mfma_f32_16x16x32_bf16 a[84:87], a[20:23], a[220:223], 0
    v_mfma_f32_16x16x32_bf16 a[84:87], a[16:19], a[204:207], a[84:87]
    s_add_u32 s24, s6, 0x4806000
    s_addc_u32 s25, s7, 0
    v_mfma_f32_16x16x32_bf16 a[92:95], a[24:27], a[204:207], 0
    v_mfma_f32_16x16x32_bf16 a[92:95], a[28:31], a[220:223], a[92:95]
    s_and_b32 s25, s25, 0xffff
    v_mfma_f32_16x16x32_bf16 a[88:91], a[28:31], a[216:219], 0
    s_add_u32 s62, s62, 0x20000
    v_mfma_f32_16x16x32_bf16 a[88:91], a[24:27], a[200:203], a[88:91]
    s_mov_b32 s26, 4096
    v_mfma_f32_16x16x32_bf16 v[220:223], a[24:27], a[196:199], 0
    s_cmp_eq_u32 s45, 0
    s_cbranch_scc1 k12_ool_48
k12_oolret_49:
    v_mfma_f32_16x16x32_bf16 v[220:223], a[28:31], a[212:215], v[220:223]
    v_mfma_f32_16x16x32_bf16 v[216:219], a[28:31], a[208:211], 0
    v_mfma_f32_16x16x32_bf16 v[216:219], a[24:27], a[192:195], v[216:219]
    s_waitcnt vmcnt(28) lgkmcnt(0)
    s_barrier
    v_mfma_f32_16x16x32_bf16 v[224:227], a[32:35], a[192:195], 0
    v_mfma_f32_16x16x32_bf16 v[224:227], a[36:39], a[208:211], v[224:227]
    s_add_u32 m0, s60, 98304
    ds_read_b64_tr_b16 a[0:1], v42 offset:49152
    ds_read_b64_tr_b16 a[2:3], v42 offset:50176
    v_mfma_f32_16x16x32_bf16 v[228:231], a[36:39], a[212:215], 0
    buffer_load_dwordx4 v38, s[12:15], s61 offen offset:0 lds
    v_mfma_f32_16x16x32_bf16 v[228:231], a[32:35], a[196:199], v[228:231]
    ds_read_b64_tr_b16 a[4:5], v42 offset:57344
    v_mfma_f32_16x16x32_bf16 a[96:99], a[32:35], a[200:203], 0
    buffer_load_dwordx4 v39, s[12:15], s61 offen offset:1024 lds
    ds_read_b64_tr_b16 a[6:7], v42 offset:58368
    v_mfma_f32_16x16x32_bf16 a[96:99], a[36:39], a[216:219], a[96:99]
    ds_read_b64_tr_b16 a[8:9], v43 offset:49152
    v_mfma_f32_16x16x32_bf16 a[100:103], a[36:39], a[220:223], 0
    v_mfma_f32_16x16x32_bf16 a[100:103], a[32:35], a[204:207], a[100:103]
    buffer_load_dwordx4 v40, s[12:15], s61 offen offset:2048 lds
    ds_read_b64_tr_b16 a[10:11], v43 offset:50176
    v_mfma_f32_16x16x32_bf16 a[108:111], a[40:43], a[204:207], 0
    ds_read_b64_tr_b16 a[12:13], v43 offset:57344
    v_mfma_f32_16x16x32_bf16 a[108:111], a[44:47], a[220:223], a[108:111]
    ds_read_b64_tr_b16 a[14:15], v43 offset:58368
    v_mfma_f32_16x16x32_bf16 a[104:107], a[44:47], a[216:219], 0
    buffer_load_dwordx4 v41, s[12:15], s61 offen offset:3072 lds
    ds_read_b64_tr_b16 a[16:17], v44 offset:49152
    v_mfma_f32_16x16x32_bf16 a[104:107], a[40:43], a[200:203], a[104:107]
    v_mfma_f32_16x16x32_bf16 v[236:239], a[40:43], a[196:199], 0
    s_add_u32 s61, s61, 0x80000
    ds_read_b64_tr_b16 a[18:19], v44 offset:50176
    v_mfma_f32_16x16x32_bf16 v[236:239], a[44:47], a[212:215], v[236:239]
    buffer_load_dwordx4 a[144:147], v36, s[8:11], s62 offen sc1
    ds_read_b64_tr_b16 a[20:21], v44 offset:57344
    v_mfma_f32_16x16x32_bf16 v[232:235], a[44:47], a[208:211], 0
    ds_read_b64_tr_b16 a[22:23], v44 offset:58368
    v_mfma_f32_16x16x32_bf16 v[232:235], a[40:43], a[192:195], v[232:235]
    buffer_load_dwordx4 a[148:151], v54, s[8:11], s62 offen sc1
    v_mfma_f32_16x16x32_bf16 v[240:243], a[48:51], a[192:195], 0
    ds_read_b64_tr_b16 a[24:25], v45 offset:49152
    v_mfma_f32_16x16x32_bf16 v[240:243], a[52:55], a[208:211], v[240:243]
    ds_read_b64_tr_b16 a[26:27], v45 offset:50176
    v_mfma_f32_16x16x32_bf16 v[244:247], a[52:55], a[212:215], 0
    buffer_load_dwordx4 a[152:155], v37, s[8:11], s62 offen sc1
    ds_read_b64_tr_b16 a[28:29], v45 offset:57344
    v_mfma_f32_16x16x32_bf16 v[244:247], a[48:51], a[196:199], v[244:247]
    v_mfma_f32_16x16x32_bf16 a[112:115], a[48:51], a[200:203], 0
    ds_read_b64_tr_b16 a[30:31], v45 offset:58368
    v_mfma_f32_16x16x32_bf16 a[112:115], a[52:55], a[216:219], a[112:115]
    buffer_load_dwordx4 a[156:159], v55, s[8:11], s62 offen sc1
    v_mfma_f32_16x16x32_bf16 a[116:119], a[52:55], a[220:223], 0
    v_mfma_f32_16x16x32_bf16 a[116:119], a[48:51], a[204:207], a[116:119]
    s_add_u32 s62, s62, 0x20000
    v_mfma_f32_16x16x32_bf16 a[124:127], a[56:59], a[204:207], 0
    s_add_u32 s52, s47, 0
    v_mfma_f32_16x16x32_bf16 a[124:127], a[60:63], a[220:223], a[124:127]
    buffer_store_dwordx4 v[72:75], v1, s[48:51], s52 offen offset:2048 sc1
    v_mfma_f32_16x16x32_bf16 a[120:123], a[60:63], a[216:219], 0
    v_mfma_f32_16x16x32_bf16 a[120:123], a[56:59], a[200:203], a[120:123]
    v_mfma_f32_16x16x32_bf16 v[252:255], a[56:59], a[196:199], 0
    v_mfma_f32_16x16x32_bf16 v[252:255], a[60:63], a[212:215], v[252:255]
    v_mfma_f32_16x16x32_bf16 v[248:251], a[60:63], a[208:211], 0
    v_mfma_f32_16x16x32_bf16 v[248:251], a[56:59], a[192:195], v[248:251]
    s_waitcnt vmcnt(21) lgkmcnt(0)
    v_mfma_f32_16x16x32_bf16 v[192:195], a[0:3], a[224:227], v[192:195]
    v_mfma_f32_16x16x32_bf16 v[192:195], a[4:7], a[240:243], v[192:195]
    buffer_load_dwordx4 a[160:163], v36, s[8:11], s62 offen sc1
    ds_read_b64_tr_b16 a[32:33], v46 offset:49152
    v_mfma_f32_16x16x32_bf16 v[196:199], a[4:7], a[244:247], v[196:199]
    ds_read_b64_tr_b16 a[34:35], v46 offset:50176
    v_mfma_f32_16x16x32_bf16 v[196:199], a[0:3], a[228:231], v[196:199]
    ds_read_b64_tr_b16 a[36:37], v46 offset:57344
    v_mfma_f32_16x16x32_bf16 a[64:67], a[0:3], a[232:235], a[64:67]
    ds_read_b64_tr_b16 a[38:39], v46 offset:58368
    v_mfma_f32_16x16x32_bf16 a[64:67], a[4:7], a[248:251], a[64:67]
    ds_read_b64_tr_b16 a[40:41], v47 offset:49152
    v_mfma_f32_16x16x32_bf16 a[68:71], a[4:7], a[252:255], a[68:71]
    buffer_load_dwordx4 a[164:167], v54, s[8:11], s62 offen sc1
    v_mfma_f32_16x16x32_bf16 a[68:71], a[0:3], a[236:239], a[68:71]
    ds_read_b64_tr_b16 a[42:43], v47 offset:50176
    v_mfma_f32_16x16x32_bf16 a[76:79], a[8:11], a[236:239], a[76:79]
    ds_read_b64_tr_b16 a[44:45], v47 offset:57344
    v_mfma_f32_16x16x32_bf16 a[76:79], a[12:15], a[252:255], a[76:79]
    ds_read_b64_tr_b16 a[46:47], v47 offset:58368
    v_mfma_f32_16x16x32_bf16 a[72:75], a[12:15], a[248:251], a[72:75]
    ds_read_b64_tr_b16 a[48:49], v48 offset:49152
    v_mfma_f32_16x16x32_bf16 a[72:75], a[8:11], a[232:235], a[72:75]
    buffer_load_dwordx4 a[168:171], v37, s[8:11], s62 offen sc1
    v_mfma_f32_16x16x32_bf16 v[204:207], a[8:11], a[228:231], v[204:207]
    ds_read_b64_tr_b16 a[50:51], v48 offset:50176
    v_mfma_f32_16x16x32_bf16 v[204:207], a[12:15], a[244:247], v[204:207]
    ds_read_b64_tr_b16 a[52:53], v48 offset:57344
    v_mfma_f32_16x16x32_bf16 v[200:203], a[12:15], a[240:243], v[200:203]
    ds_read_b64_tr_b16 a[54:55], v48 offset:58368
    v_mfma_f32_16x16x32_bf16 v[200:203], a[8:11], a[224:227], v[200:203]
    v_mfma_f32_16x16x32_bf16 v[208:211], a[16:19], a[224:227], v[208:211]
    ds_read_b64_tr_b16 a[56:57], v49 offset:49152
    v_mfma_f32_16x16x32_bf16 v[208:211], a[20:23], a[240:243], v[208:211]
    buffer_load_dwordx4 a[172:175], v55, s[8:11], s62 offen sc1
    ds_read_b64_tr_b16 a[58:59], v49 offset:50176
    v_mfma_f32_16x16x32_bf16 v[212:215], a[20:23], a[244:247], v[212:215]
    ds_read_b64_tr_b16 a[60:61], v49 offset:57344
    v_mfma_f32_16x16x32_bf16 v[212:215], a[16:19], a[228:231], v[212:215]
    v_mfma_f32_16x16x32_bf16 a[80:83], a[16:19], a[232:235], a[80:83]
    ds_read_b64_tr_b16 a[62:63], v49 offset:58368
    v_mfma_f32_16x16x32_bf16 a[80:83], a[20:23], a[248:251], a[80:83]
    s_add_u32 s62, s62, 0x20000
    v_mfma_f32_16x16x32_bf16 a[84:87], a[20:23], a[252:255], a[84:87]
    s_add_u32 s52, s47, 0
    v_mfma_f32_16x16x32_bf16 a[84:87], a[16:19], a[236:239], a[84:87]
    buffer_store_dwordx4 v[76:79], v1, s[48:51], s52 offen offset:3072 sc1
    v_mfma_f32_16x16x32_bf16 a[92:95], a[24:27], a[236:239], a[92:95]
    v_mfma_f32_16x16x32_bf16 a[92:95], a[28:31], a[252:255], a[92:95]
    v_mfma_f32_16x16x32_bf16 a[88:91], a[28:31], a[248:251], a[88:91]
    v_mfma_f32_16x16x32_bf16 a[88:91], a[24:27], a[232:235], a[88:91]
    v_mfma_f32_16x16x32_bf16 v[220:223], a[24:27], a[228:231], v[220:223]
    s_cmp_eq_u32 s45, 0
    s_cbranch_scc1 k12_ool_50
k12_oolret_51:
    v_mfma_f32_16x16x32_bf16 v[220:223], a[28:31], a[244:247], v[220:223]
    v_mfma_f32_16x16x32_bf16 v[216:219], a[28:31], a[240:243], v[216:219]
    v_mfma_f32_16x16x32_bf16 v[216:219], a[24:27], a[224:227], v[216:219]
    s_waitcnt vmcnt(10) lgkmcnt(0)
    s_barrier
    v_mfma_f32_16x16x32_bf16 v[224:227], a[32:35], a[224:227], v[224:227]
    v_mfma_f32_16x16x32_bf16 v[224:227], a[36:39], a[240:243], v[224:227]
    s_add_u32 m0, s60, 114688
    ds_read_b64_tr_b16 a[0:1], v42 offset:0
    ds_read_b64_tr_b16 a[2:3], v42 offset:1024
    v_mfma_f32_16x16x32_bf16 v[228:231], a[36:39], a[244:247], v[228:231]
    buffer_load_dwordx4 v38, s[12:15], s61 offen offset:0 lds
    v_mfma_f32_16x16x32_bf16 v[228:231], a[32:35], a[228:231], v[228:231]
    ds_read_b64_tr_b16 a[4:5], v42 offset:8192
    v_mfma_f32_16x16x32_bf16 a[96:99], a[32:35], a[232:235], a[96:99]
    buffer_load_dwordx4 v39, s[12:15], s61 offen offset:1024 lds
    ds_read_b64_tr_b16 a[6:7], v42 offset:9216
    v_mfma_f32_16x16x32_bf16 a[96:99], a[36:39], a[248:251], a[96:99]
    ds_read_b64_tr_b16 a[8:9], v43 offset:0
    v_mfma_f32_16x16x32_bf16 a[100:103], a[36:39], a[252:255], a[100:103]
    v_mfma_f32_16x16x32_bf16 a[100:103], a[32:35], a[236:239], a[100:103]
    buffer_load_dwordx4 v40, s[12:15], s61 offen offset:2048 lds
    ds_read_b64_tr_b16 a[10:11], v43 offset:1024
    v_mfma_f32_16x16x32_bf16 a[108:111], a[40:43], a[236:239], a[108:111]
    ds_read_b64_tr_b16 a[12:13], v43 offset:8192
    v_mfma_f32_16x16x32_bf16 a[108:111], a[44:47], a[252:255], a[108:111]
    ds_read_b64_tr_b16 a[14:15], v43 offset:9216
    v_mfma_f32_16x16x32_bf16 a[104:107], a[44:47], a[248:251], a[104:107]
    buffer_load_dwordx4 v41, s[12:15], s61 offen offset:3072 lds
    ds_read_b64_tr_b16 a[16:17], v44 offset:0
    v_mfma_f32_16x16x32_bf16 a[104:107], a[40:43], a[232:235], a[104:107]
    v_mfma_f32_16x16x32_bf16 v[236:239], a[40:43], a[228:231], v[236:239]
    s_add_u32 s61, s61, 0x80000
    ds_read_b64_tr_b16 a[18:19], v44 offset:1024
    v_mfma_f32_16x16x32_bf16 v[236:239], a[44:47], a[244:247], v[236:239]
    buffer_load_dwordx4 a[176:179], v36, s[8:11], s62 offen sc1
    ds_read_b64_tr_b16 a[20:21], v44 offset:8192
    v_mfma_f32_16x16x32_bf16 v[232:235], a[44:47], a[240:243], v[232:235]
    ds_read_b64_tr_b16 a[22:23], v44 offset:9216
    v_mfma_f32_16x16x32_bf16 v[232:235], a[40:43], a[224:227], v[232:235]
    buffer_load_dwordx4 a[180:183], v54, s[8:11], s62 offen sc1
    v_mfma_f32_16x16x32_bf16 v[240:243], a[48:51], a[224:227], v[240:243]
    ds_read_b64_tr_b16 a[24:25], v45 offset:0
    v_mfma_f32_16x16x32_bf16 v[240:243], a[52:55], a[240:243], v[240:243]
    ds_read_b64_tr_b16 a[26:27], v45 offset:1024
    v_mfma_f32_16x16x32_bf16 v[244:247], a[52:55], a[244:247], v[244:247]
    buffer_load_dwordx4 a[184:187], v37, s[8:11], s62 offen sc1
    ds_read_b64_tr_b16 a[28:29], v45 offset:8192
    v_mfma_f32_16x16x32_bf16 v[244:247], a[48:51], a[228:231], v[244:247]
    v_mfma_f32_16x16x32_bf16 a[112:115], a[48:51], a[232:235], a[112:115]
    ds_read_b64_tr_b16 a[30:31], v45 offset:9216
    v_mfma_f32_16x16x32_bf16 a[112:115], a[52:55], a[248:251], a[112:115]
    buffer_load_dwordx4 a[188:191], v55, s[8:11], s62 offen sc1
    v_mfma_f32_16x16x32_bf16 a[116:119], a[52:55], a[252:255], a[116:119]
    v_mfma_f32_16x16x32_bf16 a[116:119], a[48:51], a[236:239], a[116:119]
    s_add_u32 s62, s62, 0x20000
    v_mfma_f32_16x16x32_bf16 a[124:127], a[56:59], a[236:239], a[124:127]
    s_add_u32 s52, s47, 4096
    v_mfma_f32_16x16x32_bf16 a[124:127], a[60:63], a[252:255], a[124:127]
    buffer_store_dwordx4 v[80:83], v1, s[48:51], s52 offen offset:0 sc1
    v_mfma_f32_16x16x32_bf16 a[120:123], a[60:63], a[248:251], a[120:123]
    v_mfma_f32_16x16x32_bf16 a[120:123], a[56:59], a[232:235], a[120:123]
    v_mfma_f32_16x16x32_bf16 v[252:255], a[56:59], a[228:231], v[252:255]
    v_mfma_f32_16x16x32_bf16 v[252:255], a[60:63], a[244:247], v[252:255]
    v_mfma_f32_16x16x32_bf16 v[248:251], a[60:63], a[240:243], v[248:251]
    v_mfma_f32_16x16x32_bf16 v[248:251], a[56:59], a[224:227], v[248:251]
    s_waitcnt vmcnt(15) lgkmcnt(0)
    v_mfma_f32_16x16x32_bf16 v[192:195], a[0:3], a[128:131], v[192:195]
    v_mfma_f32_16x16x32_bf16 v[192:195], a[4:7], a[144:147], v[192:195]
    buffer_load_dwordx4 a[192:195], v36, s[8:11], s62 offen sc1
    ds_read_b64_tr_b16 a[32:33], v46 offset:0
    v_mfma_f32_16x16x32_bf16 v[196:199], a[4:7], a[148:151], v[196:199]
    ds_read_b64_tr_b16 a[34:35], v46 offset:1024
    v_mfma_f32_16x16x32_bf16 v[196:199], a[0:3], a[132:135], v[196:199]
    ds_read_b64_tr_b16 a[36:37], v46 offset:8192
    v_mfma_f32_16x16x32_bf16 a[64:67], a[0:3], a[136:139], a[64:67]
    ds_read_b64_tr_b16 a[38:39], v46 offset:9216
    v_mfma_f32_16x16x32_bf16 a[64:67], a[4:7], a[152:155], a[64:67]
    ds_read_b64_tr_b16 a[40:41], v47 offset:0
    v_mfma_f32_16x16x32_bf16 a[68:71], a[4:7], a[156:159], a[68:71]
    buffer_load_dwordx4 a[196:199], v54, s[8:11], s62 offen sc1
    v_mfma_f32_16x16x32_bf16 a[68:71], a[0:3], a[140:143], a[68:71]
    ds_read_b64_tr_b16 a[42:43], v47 offset:1024
    v_mfma_f32_16x16x32_bf16 a[76:79], a[8:11], a[140:143], a[76:79]
    ds_read_b64_tr_b16 a[44:45], v47 offset:8192
    v_mfma_f32_16x16x32_bf16 a[76:79], a[12:15], a[156:159], a[76:79]
    ds_read_b64_tr_b16 a[46:47], v47 offset:9216
    v_mfma_f32_16x16x32_bf16 a[72:75], a[12:15], a[152:155], a[72:75]
    ds_read_b64_tr_b16 a[48:49], v48 offset:0
    v_mfma_f32_16x16x32_bf16 a[72:75], a[8:11], a[136:139], a[72:75]
    buffer_load_dwordx4 a[200:203], v37, s[8:11], s62 offen sc1
    v_mfma_f32_16x16x32_bf16 v[204:207], a[8:11], a[132:135], v[204:207]
    ds_read_b64_tr_b16 a[50:51], v48 offset:1024
    v_mfma_f32_16x16x32_bf16 v[204:207], a[12:15], a[148:151], v[204:207]
    ds_read_b64_tr_b16 a[52:53], v48 offset:8192
    v_mfma_f32_16x16x32_bf16 v[200:203], a[12:15], a[144:147], v[200:203]
    ds_read_b64_tr_b16 a[54:55], v48 offset:9216
    v_mfma_f32_16x16x32_bf16 v[200:203], a[8:11], a[128:131], v[200:203]
    v_mfma_f32_16x16x32_bf16 v[208:211], a[16:19], a[128:131], v[208:211]
    ds_read_b64_tr_b16 a[56:57], v49 offset:0
    v_mfma_f32_16x16x32_bf16 v[208:211], a[20:23], a[144:147], v[208:211]
    buffer_load_dwordx4 a[204:207], v55, s[8:11], s62 offen sc1
    ds_read_b64_tr_b16 a[58:59], v49 offset:1024
    v_mfma_f32_16x16x32_bf16 v[212:215], a[20:23], a[148:151], v[212:215]
    ds_read_b64_tr_b16 a[60:61], v49 offset:8192
    v_mfma_f32_16x16x32_bf16 v[212:215], a[16:19], a[132:135], v[212:215]
    v_mfma_f32_16x16x32_bf16 a[80:83], a[16:19], a[136:139], a[80:83]
    ds_read_b64_tr_b16 a[62:63], v49 offset:9216
    v_mfma_f32_16x16x32_bf16 a[80:83], a[20:23], a[152:155], a[80:83]
    s_add_u32 s62, s62, 0x20000
    v_mfma_f32_16x16x32_bf16 a[84:87], a[20:23], a[156:159], a[84:87]
    s_add_u32 s52, s47, 4096
    v_mfma_f32_16x16x32_bf16 a[84:87], a[16:19], a[140:143], a[84:87]
    buffer_store_dwordx4 v[84:87], v1, s[48:51], s52 offen offset:1024 sc1
    v_mfma_f32_16x16x32_bf16 a[92:95], a[24:27], a[140:143], a[92:95]
    v_mfma_f32_16x16x32_bf16 a[92:95], a[28:31], a[156:159], a[92:95]
    v_mfma_f32_16x16x32_bf16 a[88:91], a[28:31], a[152:155], a[88:91]
    v_mfma_f32_16x16x32_bf16 a[88:91], a[24:27], a[136:139], a[88:91]
    v_mfma_f32_16x16x32_bf16 v[220:223], a[24:27], a[132:135], v[220:223]
    v_mfma_f32_16x16x32_bf16 v[220:223], a[28:31], a[148:151], v[220:223]
    v_mfma_f32_16x16x32_bf16 v[216:219], a[28:31], a[144:147], v[216:219]
    v_mfma_f32_16x16x32_bf16 v[216:219], a[24:27], a[128:131], v[216:219]
    s_waitcnt vmcnt(10) lgkmcnt(0)
    s_barrier
    v_mfma_f32_16x16x32_bf16 v[224:227], a[32:35], a[128:131], v[224:227]
    v_mfma_f32_16x16x32_bf16 v[224:227], a[36:39], a[144:147], v[224:227]
    s_add_u32 m0, s60, 131072
    ds_read_b64_tr_b16 a[0:1], v42 offset:16384
    ds_read_b64_tr_b16 a[2:3], v42 offset:17408
    v_mfma_f32_16x16x32_bf16 v[228:231], a[36:39], a[148:151], v[228:231]
    buffer_load_dwordx4 v38, s[12:15], s61 offen offset:0 lds
    v_mfma_f32_16x16x32_bf16 v[228:231], a[32:35], a[132:135], v[228:231]
    ds_read_b64_tr_b16 a[4:5], v42 offset:24576
    v_mfma_f32_16x16x32_bf16 a[96:99], a[32:35], a[136:139], a[96:99]
    buffer_load_dwordx4 v39, s[12:15], s61 offen offset:1024 lds
    ds_read_b64_tr_b16 a[6:7], v42 offset:25600
    v_mfma_f32_16x16x32_bf16 a[96:99], a[36:39], a[152:155], a[96:99]
    ds_read_b64_tr_b16 a[8:9], v43 offset:16384
    v_mfma_f32_16x16x32_bf16 a[100:103], a[36:39], a[156:159], a[100:103]
    v_mfma_f32_16x16x32_bf16 a[100:103], a[32:35], a[140:143], a[100:103]
    buffer_load_dwordx4 v40, s[12:15], s61 offen offset:2048 lds
    ds_read_b64_tr_b16 a[10:11], v43 offset:17408
    v_mfma_f32_16x16x32_bf16 a[108:111], a[40:43], a[140:143], a[108:111]
    ds_read_b64_tr_b16 a[12:13], v43 offset:24576
    v_mfma_f32_16x16x32_bf16 a[108:111], a[44:47], a[156:159], a[108:111]
    ds_read_b64_tr_b16 a[14:15], v43 offset:25600
    v_mfma_f32_16x16x32_bf16 a[104:107], a[44:47], a[152:155], a[104:107]
    ds_read_b64_tr_b16 a[16:17], v44 offset:16384
    v_mfma_f32_16x16x32_bf16 a[104:107], a[40:43], a[136:139], a[104:107]
    buffer_load_dwordx4 v41, s[12:15], s61 offen offset:3072 lds
    v_mfma_f32_16x16x32_bf16 v[236:239], a[40:43], a[132:135], v[236:239]
    ds_read_b64_tr_b16 a[18:19], v44 offset:17408
    v_mfma_f32_16x16x32_bf16 v[236:239], a[44:47], a[148:151], v[236:239]
    s_add_u32 s61, s61, 0x80000
    ds_read_b64_tr_b16 a[20:21], v44 offset:24576
    v_mfma_f32_16x16x32_bf16 v[232:235], a[44:47], a[144:147], v[232:235]
    buffer_load_dwordx4 a[208:211], v36, s[8:11], s62 offen sc1
    ds_read_b64_tr_b16 a[22:23], v44 offset:25600
    v_mfma_f32_16x16x32_bf16 v[232:235], a[40:43], a[128:131], v[232:235]
    v_mfma_f32_16x16x32_bf16 v[240:243], a[48:51], a[128:131], v[240:243]
    ds_read_b64_tr_b16 a[24:25], v45 offset:16384
    v_mfma_f32_16x16x32_bf16 v[240:243], a[52:55], a[144:147], v[240:243]
    buffer_load_dwordx4 a[212:215], v54, s[8:11], s62 offen sc1
    ds_read_b64_tr_b16 a[26:27], v45 offset:17408
    v_mfma_f32_16x16x32_bf16 v[244:247], a[52:55], a[148:151], v[244:247]
    ds_read_b64_tr_b16 a[28:29], v45 offset:24576
    v_mfma_f32_16x16x32_bf16 v[244:247], a[48:51], a[132:135], v[244:247]
    v_mfma_f32_16x16x32_bf16 a[112:115], a[48:51], a[136:139], a[112:115]
    buffer_load_dwordx4 a[216:219], v37, s[8:11], s62 offen sc1
    ds_read_b64_tr_b16 a[30:31], v45 offset:25600
    v_mfma_f32_16x16x32_bf16 a[112:115], a[52:55], a[152:155], a[112:115]
    v_mfma_f32_16x16x32_bf16 a[116:119], a[52:55], a[156:159], a[116:119]
    v_mfma_f32_16x16x32_bf16 a[116:119], a[48:51], a[140:143], a[116:119]
    v_mfma_f32_16x16x32_bf16 a[124:127], a[56:59], a[140:143], a[124:127]
    buffer_load_dwordx4 a[220:223], v55, s[8:11], s62 offen sc1
    v_mfma_f32_16x16x32_bf16 a[124:127], a[60:63], a[156:159], a[124:127]
    v_mfma_f32_16x16x32_bf16 a[120:123], a[60:63], a[152:155], a[120:123]
    s_add_u32 s62, s62, 0x20000
    v_mfma_f32_16x16x32_bf16 a[120:123], a[56:59], a[136:139], a[120:123]
    v_mfma_f32_16x16x32_bf16 v[252:255], a[56:59], a[132:135], v[252:255]
    s_cmp_eq_u32 s45, 0
    s_cbranch_scc1 k12_ool_52
k12_oolret_53:
    v_mfma_f32_16x16x32_bf16 v[252:255], a[60:63], a[148:151], v[252:255]
    v_mfma_f32_16x16x32_bf16 v[248:251], a[60:63], a[144:147], v[248:251]
    v_mfma_f32_16x16x32_bf16 v[248:251], a[56:59], a[128:131], v[248:251]
    s_waitcnt vmcnt(14) lgkmcnt(0)
    v_mfma_f32_16x16x32_bf16 v[192:195], a[0:3], a[160:163], v[192:195]
    v_mfma_f32_16x16x32_bf16 v[192:195], a[4:7], a[176:179], v[192:195]
    buffer_load_dwordx4 a[224:227], v36, s[8:11], s62 offen sc1
    ds_read_b64_tr_b16 a[32:33], v46 offset:16384
    v_mfma_f32_16x16x32_bf16 v[196:199], a[4:7], a[180:183], v[196:199]
    ds_read_b64_tr_b16 a[34:35], v46 offset:17408
    v_mfma_f32_16x16x32_bf16 v[196:199], a[0:3], a[164:167], v[196:199]
    ds_read_b64_tr_b16 a[36:37], v46 offset:24576
    v_mfma_f32_16x16x32_bf16 a[64:67], a[0:3], a[168:171], a[64:67]
    ds_read_b64_tr_b16 a[38:39], v46 offset:25600
    v_mfma_f32_16x16x32_bf16 a[64:67], a[4:7], a[184:187], a[64:67]
    ds_read_b64_tr_b16 a[40:41], v47 offset:16384
    v_mfma_f32_16x16x32_bf16 a[68:71], a[4:7], a[188:191], a[68:71]
    buffer_load_dwordx4 a[228:231], v54, s[8:11], s62 offen sc1
    v_mfma_f32_16x16x32_bf16 a[68:71], a[0:3], a[172:175], a[68:71]
    ds_read_b64_tr_b16 a[42:43], v47 offset:17408
    v_mfma_f32_16x16x32_bf16 a[76:79], a[8:11], a[172:175], a[76:79]
    ds_read_b64_tr_b16 a[44:45], v47 offset:24576
    v_mfma_f32_16x16x32_bf16 a[76:79], a[12:15], a[188:191], a[76:79]
    ds_read_b64_tr_b16 a[46:47], v47 offset:25600
    v_mfma_f32_16x16x32_bf16 a[72:75], a[12:15], a[184:187], a[72:75]
    ds_read_b64_tr_b16 a[48:49], v48 offset:16384
    v_mfma_f32_16x16x32_bf16 a[72:75], a[8:11], a[168:171], a[72:75]
    buffer_load_dwordx4 a[232:235], v37, s[8:11], s62 offen sc1
    v_mfma_f32_16x16x32_bf16 v[204:207], a[8:11], a[164:167], v[204:207]
    ds_read_b64_tr_b16 a[50:51], v48 offset:17408
    v_mfma_f32_16x16x32_bf16 v[204:207], a[12:15], a[180:183], v[204:207]
    ds_read_b64_tr_b16 a[52:53], v48 offset:24576
    v_mfma_f32_16x16x32_bf16 v[200:203], a[12:15], a[176:179], v[200:203]
    ds_read_b64_tr_b16 a[54:55], v48 offset:25600
    v_mfma_f32_16x16x32_bf16 v[200:203], a[8:11], a[160:163], v[200:203]
    v_mfma_f32_16x16x32_bf16 v[208:211], a[16:19], a[160:163], v[208:211]
    ds_read_b64_tr_b16 a[56:57], v49 offset:16384
    v_mfma_f32_16x16x32_bf16 v[208:211], a[20:23], a[176:179], v[208:211]
    buffer_load_dwordx4 a[236:239], v55, s[8:11], s62 offen sc1
    ds_read_b64_tr_b16 a[58:59], v49 offset:17408
    v_mfma_f32_16x16x32_bf16 v[212:215], a[20:23], a[180:183], v[212:215]
    ds_read_b64_tr_b16 a[60:61], v49 offset:24576
    v_mfma_f32_16x16x32_bf16 v[212:215], a[16:19], a[164:167], v[212:215]
    v_mfma_f32_16x16x32_bf16 a[80:83], a[16:19], a[168:171], a[80:83]
    ds_read_b64_tr_b16 a[62:63], v49 offset:25600
    v_mfma_f32_16x16x32_bf16 a[80:83], a[20:23], a[184:187], a[80:83]
    s_add_u32 s62, s62, 0x20000
    v_mfma_f32_16x16x32_bf16 a[84:87], a[20:23], a[188:191], a[84:87]
    s_add_u32 s52, s47, 4096
    v_mfma_f32_16x16x32_bf16 a[84:87], a[16:19], a[172:175], a[84:87]
    buffer_store_dwordx4 v[88:91], v1, s[48:51], s52 offen offset:2048 sc1
    v_mfma_f32_16x16x32_bf16 a[92:95], a[24:27], a[172:175], a[92:95]
    v_mfma_f32_16x16x32_bf16 a[92:95], a[28:31], a[188:191], a[92:95]
    v_mfma_f32_16x16x32_bf16 a[88:91], a[28:31], a[184:187], a[88:91]
    v_mfma_f32_16x16x32_bf16 a[88:91], a[24:27], a[168:171], a[88:91]
    v_mfma_f32_16x16x32_bf16 v[220:223], a[24:27], a[164:167], v[220:223]
    v_mfma_f32_16x16x32_bf16 v[220:223], a[28:31], a[180:183], v[220:223]
    v_mfma_f32_16x16x32_bf16 v[216:219], a[28:31], a[176:179], v[216:219]
    v_mfma_f32_16x16x32_bf16 v[216:219], a[24:27], a[160:163], v[216:219]
    s_waitcnt vmcnt(9) lgkmcnt(0)
    s_barrier
    v_mfma_f32_16x16x32_bf16 v[224:227], a[32:35], a[160:163], v[224:227]
    v_mfma_f32_16x16x32_bf16 v[224:227], a[36:39], a[176:179], v[224:227]
    s_add_u32 m0, s60, 147456
    ds_read_b64_tr_b16 a[0:1], v42 offset:32768
    ds_read_b64_tr_b16 a[2:3], v42 offset:33792
    v_mfma_f32_16x16x32_bf16 v[228:231], a[36:39], a[180:183], v[228:231]
    buffer_load_dwordx4 v38, s[12:15], s61 offen offset:0 lds
    v_mfma_f32_16x16x32_bf16 v[228:231], a[32:35], a[164:167], v[228:231]
    ds_read_b64_tr_b16 a[4:5], v42 offset:40960
    v_mfma_f32_16x16x32_bf16 a[96:99], a[32:35], a[168:171], a[96:99]
    buffer_load_dwordx4 v39, s[12:15], s61 offen offset:1024 lds
    ds_read_b64_tr_b16 a[6:7], v42 offset:41984
    v_mfma_f32_16x16x32_bf16 a[96:99], a[36:39], a[184:187], a[96:99]
    ds_read_b64_tr_b16 a[8:9], v43 offset:32768
    v_mfma_f32_16x16x32_bf16 a[100:103], a[36:39], a[188:191], a[100:103]
    v_mfma_f32_16x16x32_bf16 a[100:103], a[32:35], a[172:175], a[100:103]
    buffer_load_dwordx4 v40, s[12:15], s61 offen offset:2048 lds
    ds_read_b64_tr_b16 a[10:11], v43 offset:33792
    v_mfma_f32_16x16x32_bf16 a[108:111], a[40:43], a[172:175], a[108:111]
    ds_read_b64_tr_b16 a[12:13], v43 offset:40960
    v_mfma_f32_16x16x32_bf16 a[108:111], a[44:47], a[188:191], a[108:111]
    ds_read_b64_tr_b16 a[14:15], v43 offset:41984
    v_mfma_f32_16x16x32_bf16 a[104:107], a[44:47], a[184:187], a[104:107]
    buffer_load_dwordx4 v41, s[12:15], s61 offen offset:3072 lds
    ds_read_b64_tr_b16 a[16:17], v44 offset:32768
    v_mfma_f32_16x16x32_bf16 a[104:107], a[40:43], a[168:171], a[104:107]
    v_mfma_f32_16x16x32_bf16 v[236:239], a[40:43], a[164:167], v[236:239]
    s_add_u32 s61, s61, 0x80000
    ds_read_b64_tr_b16 a[18:19], v44 offset:33792
    v_mfma_f32_16x16x32_bf16 v[236:239], a[44:47], a[180:183], v[236:239]
    buffer_load_dwordx4 a[240:243], v36, s[8:11], s62 offen sc1
    ds_read_b64_tr_b16 a[20:21], v44 offset:40960
    v_mfma_f32_16x16x32_bf16 v[232:235], a[44:47], a[176:179], v[232:235]
    ds_read_b64_tr_b16 a[22:23], v44 offset:41984
    v_mfma_f32_16x16x32_bf16 v[232:235], a[40:43], a[160:163], v[232:235]
    buffer_load_dwordx4 a[244:247], v54, s[8:11], s62 offen sc1
    v_mfma_f32_16x16x32_bf16 v[240:243], a[48:51], a[160:163], v[240:243]
    ds_read_b64_tr_b16 a[24:25], v45 offset:32768
    v_mfma_f32_16x16x32_bf16 v[240:243], a[52:55], a[176:179], v[240:243]
    ds_read_b64_tr_b16 a[26:27], v45 offset:33792
    v_mfma_f32_16x16x32_bf16 v[244:247], a[52:55], a[180:183], v[244:247]
    buffer_load_dwordx4 a[248:251], v37, s[8:11], s62 offen sc1
    ds_read_b64_tr_b16 a[28:29], v45 offset:40960
    v_mfma_f32_16x16x32_bf16 v[244:247], a[48:51], a[164:167], v[244:247]
    v_mfma_f32_16x16x32_bf16 a[112:115], a[48:51], a[168:171], a[112:115]
    ds_read_b64_tr_b16 a[30:31], v45 offset:41984
    v_mfma_f32_16x16x32_bf16 a[112:115], a[52:55], a[184:187], a[112:115]
    buffer_load_dwordx4 a[252:255], v55, s[8:11], s62 offen sc1
    v_mfma_f32_16x16x32_bf16 a[116:119], a[52:55], a[188:191], a[116:119]
    v_mfma_f32_16x16x32_bf16 a[116:119], a[48:51], a[172:175], a[116:119]
    s_add_u32 s62, s62, 0x20000
    v_mfma_f32_16x16x32_bf16 a[124:127], a[56:59], a[172:175], a[124:127]
    s_add_u32 s52, s47, 4096
    v_mfma_f32_16x16x32_bf16 a[124:127], a[60:63], a[188:191], a[124:127]
    buffer_store_dwordx4 v[92:95], v1, s[48:51], s52 offen offset:3072 sc1
    v_mfma_f32_16x16x32_bf16 a[120:123], a[60:63], a[184:187], a[120:123]
    v_mfma_f32_16x16x32_bf16 a[120:123], a[56:59], a[168:171], a[120:123]
    v_mfma_f32_16x16x32_bf16 v[252:255], a[56:59], a[164:167], v[252:255]
    s_cmp_eq_u32 s45, 0
    s_cbranch_scc1 k12_ool_54
k12_oolret_55:
    v_mfma_f32_16x16x32_bf16 v[252:255], a[60:63], a[180:183], v[252:255]
    v_mfma_f32_16x16x32_bf16 v[248:251], a[60:63], a[176:179], v[248:251]
    v_mfma_f32_16x16x32_bf16 v[248:251], a[56:59], a[160:163], v[248:251]
    s_waitcnt vmcnt(14) lgkmcnt(0)
    v_mfma_f32_16x16x32_bf16 v[192:195], a[0:3], a[192:195], v[192:195]
    v_mfma_f32_16x16x32_bf16 v[192:195], a[4:7], a[208:211], v[192:195]
    buffer_load_dwordx4 a[128:131], v36, s[8:11], s62 offen sc1
    ds_read_b64_tr_b16 a[32:33], v46 offset:32768
    v_mfma_f32_16x16x32_bf16 v[196:199], a[4:7], a[212:215], v[196:199]
    ds_read_b64_tr_b16 a[34:35], v46 offset:33792
    v_mfma_f32_16x16x32_bf16 v[196:199], a[0:3], a[196:199], v[196:199]
    ds_read_b64_tr_b16 a[36:37], v46 offset:40960
    v_mfma_f32_16x16x32_bf16 a[64:67], a[0:3], a[200:203], a[64:67]
    ds_read_b64_tr_b16 a[38:39], v46 offset:41984
    v_mfma_f32_16x16x32_bf16 a[64:67], a[4:7], a[216:219], a[64:67]
    ds_read_b64_tr_b16 a[40:41], v47 offset:32768
    v_mfma_f32_16x16x32_bf16 a[68:71], a[4:7], a[220:223], a[68:71]
    buffer_load_dwordx4 a[132:135], v54, s[8:11], s62 offen sc1
    v_mfma_f32_16x16x32_bf16 a[68:71], a[0:3], a[204:207], a[68:71]
    ds_read_b64_tr_b16 a[42:43], v47 offset:33792
    v_mfma_f32_16x16x32_bf16 a[76:79], a[8:11], a[204:207], a[76:79]
    ds_read_b64_tr_b16 a[44:45], v47 offset:40960
    v_mfma_f32_16x16x32_bf16 a[76:79], a[12:15], a[220:223], a[76:79]
    ds_read_b64_tr_b16 a[46:47], v47 offset:41984
    v_mfma_f32_16x16x32_bf16 a[72:75], a[12:15], a[216:219], a[72:75]
    ds_read_b64_tr_b16 a[48:49], v48 offset:32768
    v_mfma_f32_16x16x32_bf16 a[72:75], a[8:11], a[200:203], a[72:75]
    buffer_load_dwordx4 a[136:139], v37, s[8:11], s62 offen sc1
    v_mfma_f32_16x16x32_bf16 v[204:207], a[8:11], a[196:199], v[204:207]
    ds_read_b64_tr_b16 a[50:51], v48 offset:33792
    v_mfma_f32_16x16x32_bf16 v[204:207], a[12:15], a[212:215], v[204:207]
    ds_read_b64_tr_b16 a[52:53], v48 offset:40960
    v_mfma_f32_16x16x32_bf16 v[200:203], a[12:15], a[208:211], v[200:203]
    ds_read_b64_tr_b16 a[54:55], v48 offset:41984
    v_mfma_f32_16x16x32_bf16 v[200:203], a[8:11], a[192:195], v[200:203]
    v_mfma_f32_16x16x32_bf16 v[208:211], a[16:19], a[192:195], v[208:211]
    ds_read_b64_tr_b16 a[56:57], v49 offset:32768
    v_mfma_f32_16x16x32_bf16 v[208:211], a[20:23], a[208:211], v[208:211]
    buffer_load_dwordx4 a[140:143], v55, s[8:11], s62 offen sc1
    ds_read_b64_tr_b16 a[58:59], v49 offset:33792
    v_mfma_f32_16x16x32_bf16 v[212:215], a[20:23], a[212:215], v[212:215]
    ds_read_b64_tr_b16 a[60:61], v49 offset:40960
    v_mfma_f32_16x16x32_bf16 v[212:215], a[16:19], a[196:199], v[212:215]
    v_mfma_f32_16x16x32_bf16 a[80:83], a[16:19], a[200:203], a[80:83]
    ds_read_b64_tr_b16 a[62:63], v49 offset:41984
    v_mfma_f32_16x16x32_bf16 a[80:83], a[20:23], a[216:219], a[80:83]
    s_add_u32 s62, s62, 0x20000
    v_mfma_f32_16x16x32_bf16 a[84:87], a[20:23], a[220:223], a[84:87]
    s_add_u32 s52, s47, 8192
    v_mfma_f32_16x16x32_bf16 a[84:87], a[16:19], a[204:207], a[84:87]
    buffer_store_dwordx4 v[104:107], v1, s[48:51], s52 offen offset:2048 sc1
    v_mfma_f32_16x16x32_bf16 a[92:95], a[24:27], a[204:207], a[92:95]
    v_mfma_f32_16x16x32_bf16 a[92:95], a[28:31], a[220:223], a[92:95]
    v_mfma_f32_16x16x32_bf16 a[88:91], a[28:31], a[216:219], a[88:91]
    v_mfma_f32_16x16x32_bf16 a[88:91], a[24:27], a[200:203], a[88:91]
    v_mfma_f32_16x16x32_bf16 v[220:223], a[24:27], a[196:199], v[220:223]
    v_mfma_f32_16x16x32_bf16 v[220:223], a[28:31], a[212:215], v[220:223]
    v_mfma_f32_16x16x32_bf16 v[216:219], a[28:31], a[208:211], v[216:219]
    v_mfma_f32_16x16x32_bf16 v[216:219], a[24:27], a[192:195], v[216:219]
    s_waitcnt vmcnt(10) lgkmcnt(0)
    s_barrier
    v_mfma_f32_16x16x32_bf16 v[224:227], a[32:35], a[192:195], v[224:227]
    v_mfma_f32_16x16x32_bf16 v[224:227], a[36:39], a[208:211], v[224:227]
    s_add_u32 m0, s60, 98304
    ds_read_b64_tr_b16 a[0:1], v42 offset:49152
    ds_read_b64_tr_b16 a[2:3], v42 offset:50176
    v_mfma_f32_16x16x32_bf16 v[228:231], a[36:39], a[212:215], v[228:231]
    buffer_load_dwordx4 v38, s[12:15], s61 offen offset:0 lds
    v_mfma_f32_16x16x32_bf16 v[228:231], a[32:35], a[196:199], v[228:231]
    ds_read_b64_tr_b16 a[4:5], v42 offset:57344
    v_mfma_f32_16x16x32_bf16 a[96:99], a[32:35], a[200:203], a[96:99]
    buffer_load_dwordx4 v39, s[12:15], s61 offen offset:1024 lds
    ds_read_b64_tr_b16 a[6:7], v42 offset:58368
    v_mfma_f32_16x16x32_bf16 a[96:99], a[36:39], a[216:219], a[96:99]
    ds_read_b64_tr_b16 a[8:9], v43 offset:49152
    v_mfma_f32_16x16x32_bf16 a[100:103], a[36:39], a[220:223], a[100:103]
    v_mfma_f32_16x16x32_bf16 a[100:103], a[32:35], a[204:207], a[100:103]
    buffer_load_dwordx4 v40, s[12:15], s61 offen offset:2048 lds
    ds_read_b64_tr_b16 a[10:11], v43 offset:50176
    v_mfma_f32_16x16x32_bf16 a[108:111], a[40:43], a[204:207], a[108:111]
    ds_read_b64_tr_b16 a[12:13], v43 offset:57344
    v_mfma_f32_16x16x32_bf16 a[108:111], a[44:47], a[220:223], a[108:111]
    ds_read_b64_tr_b16 a[14:15], v43 offset:58368
    v_mfma_f32_16x16x32_bf16 a[104:107], a[44:47], a[216:219], a[104:107]
    buffer_load_dwordx4 v41, s[12:15], s61 offen offset:3072 lds
    ds_read_b64_tr_b16 a[16:17], v44 offset:49152
    v_mfma_f32_16x16x32_bf16 a[104:107], a[40:43], a[200:203], a[104:107]
    v_mfma_f32_16x16x32_bf16 v[236:239], a[40:43], a[196:199], v[236:239]
    s_add_u32 s61, s61, 0x80000
    ds_read_b64_tr_b16 a[18:19], v44 offset:50176
    v_mfma_f32_16x16x32_bf16 v[236:239], a[44:47], a[212:215], v[236:239]
    buffer_load_dwordx4 a[144:147], v36, s[8:11], s62 offen sc1
    ds_read_b64_tr_b16 a[20:21], v44 offset:57344
    v_mfma_f32_16x16x32_bf16 v[232:235], a[44:47], a[208:211], v[232:235]
    ds_read_b64_tr_b16 a[22:23], v44 offset:58368
    v_mfma_f32_16x16x32_bf16 v[232:235], a[40:43], a[192:195], v[232:235]
    buffer_load_dwordx4 a[148:151], v54, s[8:11], s62 offen sc1
    v_mfma_f32_16x16x32_bf16 v[240:243], a[48:51], a[192:195], v[240:243]
    ds_read_b64_tr_b16 a[24:25], v45 offset:49152
    v_mfma_f32_16x16x32_bf16 v[240:243], a[52:55], a[208:211], v[240:243]
    ds_read_b64_tr_b16 a[26:27], v45 offset:50176
    v_mfma_f32_16x16x32_bf16 v[244:247], a[52:55], a[212:215], v[244:247]
    buffer_load_dwordx4 a[152:155], v37, s[8:11], s62 offen sc1
    ds_read_b64_tr_b16 a[28:29], v45 offset:57344
    v_mfma_f32_16x16x32_bf16 v[244:247], a[48:51], a[196:199], v[244:247]
    v_mfma_f32_16x16x32_bf16 a[112:115], a[48:51], a[200:203], a[112:115]
    ds_read_b64_tr_b16 a[30:31], v45 offset:58368
    v_mfma_f32_16x16x32_bf16 a[112:115], a[52:55], a[216:219], a[112:115]
    buffer_load_dwordx4 a[156:159], v55, s[8:11], s62 offen sc1
    v_mfma_f32_16x16x32_bf16 a[116:119], a[52:55], a[220:223], a[116:119]
    v_mfma_f32_16x16x32_bf16 a[116:119], a[48:51], a[204:207], a[116:119]
    s_add_u32 s62, s62, 0x20000
    v_mfma_f32_16x16x32_bf16 a[124:127], a[56:59], a[204:207], a[124:127]
    s_add_u32 s52, s47, 8192
    v_mfma_f32_16x16x32_bf16 a[124:127], a[60:63], a[220:223], a[124:127]
    buffer_store_dwordx4 v[108:111], v1, s[48:51], s52 offen offset:3072 sc1
    v_mfma_f32_16x16x32_bf16 a[120:123], a[60:63], a[216:219], a[120:123]
    v_mfma_f32_16x16x32_bf16 a[120:123], a[56:59], a[200:203], a[120:123]
    v_mfma_f32_16x16x32_bf16 v[252:255], a[56:59], a[196:199], v[252:255]
    v_mfma_f32_16x16x32_bf16 v[252:255], a[60:63], a[212:215], v[252:255]
    v_mfma_f32_16x16x32_bf16 v[248:251], a[60:63], a[208:211], v[248:251]
    v_mfma_f32_16x16x32_bf16 v[248:251], a[56:59], a[192:195], v[248:251]
    s_waitcnt vmcnt(15) lgkmcnt(0)
    v_mfma_f32_16x16x32_bf16 v[192:195], a[0:3], a[224:227], v[192:195]
    v_mfma_f32_16x16x32_bf16 v[192:195], a[4:7], a[240:243], v[192:195]
    buffer_load_dwordx4 a[160:163], v36, s[8:11], s62 offen sc1
    ds_read_b64_tr_b16 a[32:33], v46 offset:49152
    v_mfma_f32_16x16x32_bf16 v[196:199], a[4:7], a[244:247], v[196:199]
    ds_read_b64_tr_b16 a[34:35], v46 offset:50176
    v_mfma_f32_16x16x32_bf16 v[196:199], a[0:3], a[228:231], v[196:199]
    ds_read_b64_tr_b16 a[36:37], v46 offset:57344
    v_mfma_f32_16x16x32_bf16 a[64:67], a[0:3], a[232:235], a[64:67]
    ds_read_b64_tr_b16 a[38:39], v46 offset:58368
    v_mfma_f32_16x16x32_bf16 a[64:67], a[4:7], a[248:251], a[64:67]
    ds_read_b64_tr_b16 a[40:41], v47 offset:49152
    v_mfma_f32_16x16x32_bf16 a[68:71], a[4:7], a[252:255], a[68:71]
    buffer_load_dwordx4 a[164:167], v54, s[8:11], s62 offen sc1
    v_mfma_f32_16x16x32_bf16 a[68:71], a[0:3], a[236:239], a[68:71]
    ds_read_b64_tr_b16 a[42:43], v47 offset:50176
    v_mfma_f32_16x16x32_bf16 a[76:79], a[8:11], a[236:239], a[76:79]
    ds_read_b64_tr_b16 a[44:45], v47 offset:57344
    v_mfma_f32_16x16x32_bf16 a[76:79], a[12:15], a[252:255], a[76:79]
    ds_read_b64_tr_b16 a[46:47], v47 offset:58368
    v_mfma_f32_16x16x32_bf16 a[72:75], a[12:15], a[248:251], a[72:75]
    ds_read_b64_tr_b16 a[48:49], v48 offset:49152
    v_mfma_f32_16x16x32_bf16 a[72:75], a[8:11], a[232:235], a[72:75]
    buffer_load_dwordx4 a[168:171], v37, s[8:11], s62 offen sc1
    v_mfma_f32_16x16x32_bf16 v[204:207], a[8:11], a[228:231], v[204:207]
    ds_read_b64_tr_b16 a[50:51], v48 offset:50176
    v_mfma_f32_16x16x32_bf16 v[204:207], a[12:15], a[244:247], v[204:207]
    ds_read_b64_tr_b16 a[52:53], v48 offset:57344
    v_mfma_f32_16x16x32_bf16 v[200:203], a[12:15], a[240:243], v[200:203]
    ds_read_b64_tr_b16 a[54:55], v48 offset:58368
    v_mfma_f32_16x16x32_bf16 v[200:203], a[8:11], a[224:227], v[200:203]
    v_mfma_f32_16x16x32_bf16 v[208:211], a[16:19], a[224:227], v[208:211]
    ds_read_b64_tr_b16 a[56:57], v49 offset:49152
    v_mfma_f32_16x16x32_bf16 v[208:211], a[20:23], a[240:243], v[208:211]
    buffer_load_dwordx4 a[172:175], v55, s[8:11], s62 offen sc1
    ds_read_b64_tr_b16 a[58:59], v49 offset:50176
    v_mfma_f32_16x16x32_bf16 v[212:215], a[20:23], a[244:247], v[212:215]
    ds_read_b64_tr_b16 a[60:61], v49 offset:57344
    v_mfma_f32_16x16x32_bf16 v[212:215], a[16:19], a[228:231], v[212:215]
    v_mfma_f32_16x16x32_bf16 a[80:83], a[16:19], a[232:235], a[80:83]
    ds_read_b64_tr_b16 a[62:63], v49 offset:58368
    v_mfma_f32_16x16x32_bf16 a[80:83], a[20:23], a[248:251], a[80:83]
    s_add_u32 s62, s62, 0x20000
    v_mfma_f32_16x16x32_bf16 a[84:87], a[20:23], a[252:255], a[84:87]
    s_add_u32 s52, s47, 12288
    v_mfma_f32_16x16x32_bf16 a[84:87], a[16:19], a[236:239], a[84:87]
    buffer_store_dwordx4 v[112:115], v1, s[48:51], s52 offen offset:0 sc1
    v_mfma_f32_16x16x32_bf16 a[92:95], a[24:27], a[236:239], a[92:95]
    v_mfma_f32_16x16x32_bf16 a[92:95], a[28:31], a[252:255], a[92:95]
    v_mfma_f32_16x16x32_bf16 a[88:91], a[28:31], a[248:251], a[88:91]
    v_mfma_f32_16x16x32_bf16 a[88:91], a[24:27], a[232:235], a[88:91]
    v_mfma_f32_16x16x32_bf16 v[220:223], a[24:27], a[228:231], v[220:223]
    s_cmp_eq_u32 s45, 0
    s_cbranch_scc1 k12_ool_56
k12_oolret_57:
    v_mfma_f32_16x16x32_bf16 v[220:223], a[28:31], a[244:247], v[220:223]
    v_mfma_f32_16x16x32_bf16 v[216:219], a[28:31], a[240:243], v[216:219]
    v_mfma_f32_16x16x32_bf16 v[216:219], a[24:27], a[224:227], v[216:219]
    s_waitcnt vmcnt(10) lgkmcnt(0)
    s_barrier
    v_mfma_f32_16x16x32_bf16 v[224:227], a[32:35], a[224:227], v[224:227]
    v_mfma_f32_16x16x32_bf16 v[224:227], a[36:39], a[240:243], v[224:227]
    s_add_u32 m0, s60, 114688
    ds_read_b64_tr_b16 a[0:1], v42 offset:0
    ds_read_b64_tr_b16 a[2:3], v42 offset:1024
    v_mfma_f32_16x16x32_bf16 v[228:231], a[36:39], a[244:247], v[228:231]
    buffer_load_dwordx4 v38, s[12:15], s61 offen offset:0 lds
    v_mfma_f32_16x16x32_bf16 v[228:231], a[32:35], a[228:231], v[228:231]
    ds_read_b64_tr_b16 a[4:5], v42 offset:8192
    v_mfma_f32_16x16x32_bf16 a[96:99], a[32:35], a[232:235], a[96:99]
    buffer_load_dwordx4 v39, s[12:15], s61 offen offset:1024 lds
    ds_read_b64_tr_b16 a[6:7], v42 offset:9216
    v_mfma_f32_16x16x32_bf16 a[96:99], a[36:39], a[248:251], a[96:99]
    ds_read_b64_tr_b16 a[8:9], v43 offset:0
    v_mfma_f32_16x16x32_bf16 a[100:103], a[36:39], a[252:255], a[100:103]
    v_mfma_f32_16x16x32_bf16 a[100:103], a[32:35], a[236:239], a[100:103]
    buffer_load_dwordx4 v40, s[12:15], s61 offen offset:2048 lds
    ds_read_b64_tr_b16 a[10:11], v43 offset:1024
    v_mfma_f32_16x16x32_bf16 a[108:111], a[40:43], a[236:239], a[108:111]
    ds_read_b64_tr_b16 a[12:13], v43 offset:8192
    v_mfma_f32_16x16x32_bf16 a[108:111], a[44:47], a[252:255], a[108:111]
    ds_read_b64_tr_b16 a[14:15], v43 offset:9216
    v_mfma_f32_16x16x32_bf16 a[104:107], a[44:47], a[248:251], a[104:107]
    ds_read_b64_tr_b16 a[16:17], v44 offset:0
    v_mfma_f32_16x16x32_bf16 a[104:107], a[40:43], a[232:235], a[104:107]
    buffer_load_dwordx4 v41, s[12:15], s61 offen offset:3072 lds
    v_mfma_f32_16x16x32_bf16 v[236:239], a[40:43], a[228:231], v[236:239]
    ds_read_b64_tr_b16 a[18:19], v44 offset:1024
    v_mfma_f32_16x16x32_bf16 v[236:239], a[44:47], a[244:247], v[236:239]
    s_add_u32 s61, s61, 0x80000
    ds_read_b64_tr_b16 a[20:21], v44 offset:8192
    v_mfma_f32_16x16x32_bf16 v[232:235], a[44:47], a[240:243], v[232:235]
    buffer_load_dwordx4 a[176:179], v36, s[8:11], s62 offen sc1
    ds_read_b64_tr_b16 a[22:23], v44 offset:9216
    v_mfma_f32_16x16x32_bf16 v[232:235], a[40:43], a[224:227], v[232:235]
    v_mfma_f32_16x16x32_bf16 v[240:243], a[48:51], a[224:227], v[240:243]
    ds_read_b64_tr_b16 a[24:25], v45 offset:0
    v_mfma_f32_16x16x32_bf16 v[240:243], a[52:55], a[240:243], v[240:243]
    buffer_load_dwordx4 a[180:183], v54, s[8:11], s62 offen sc1
    ds_read_b64_tr_b16 a[26:27], v45 offset:1024
    v_mfma_f32_16x16x32_bf16 v[244:247], a[52:55], a[244:247], v[244:247]
    ds_read_b64_tr_b16 a[28:29], v45 offset:8192
    v_mfma_f32_16x16x32_bf16 v[244:247], a[48:51], a[228:231], v[244:247]
    v_mfma_f32_16x16x32_bf16 a[112:115], a[48:51], a[232:235], a[112:115]
    buffer_load_dwordx4 a[184:187], v37, s[8:11], s62 offen sc1
    ds_read_b64_tr_b16 a[30:31], v45 offset:9216
    v_mfma_f32_16x16x32_bf16 a[112:115], a[52:55], a[248:251], a[112:115]
    v_mfma_f32_16x16x32_bf16 a[116:119], a[52:55], a[252:255], a[116:119]
    v_mfma_f32_16x16x32_bf16 a[116:119], a[48:51], a[236:239], a[116:119]
    v_mfma_f32_16x16x32_bf16 a[124:127], a[56:59], a[236:239], a[124:127]
    buffer_load_dwordx4 a[188:191], v55, s[8:11], s62 offen sc1
    v_mfma_f32_16x16x32_bf16 a[124:127], a[60:63], a[252:255], a[124:127]
    v_mfma_f32_16x16x32_bf16 a[120:123], a[60:63], a[248:251], a[120:123]
    s_add_u32 s62, s62, 0x20000
    v_mfma_f32_16x16x32_bf16 a[120:123], a[56:59], a[232:235], a[120:123]
    v_mfma_f32_16x16x32_bf16 v[252:255], a[56:59], a[228:231], v[252:255]
    v_mfma_f32_16x16x32_bf16 v[252:255], a[60:63], a[244:247], v[252:255]
    v_mfma_f32_16x16x32_bf16 v[248:251], a[60:63], a[240:243], v[248:251]
    v_mfma_f32_16x16x32_bf16 v[248:251], a[56:59], a[224:227], v[248:251]
    s_waitcnt vmcnt(14) lgkmcnt(0)
    v_mfma_f32_16x16x32_bf16 v[192:195], a[0:3], a[128:131], v[192:195]
    v_mfma_f32_16x16x32_bf16 v[192:195], a[4:7], a[144:147], v[192:195]
    buffer_load_dwordx4 a[192:195], v36, s[8:11], s62 offen sc1
    ds_read_b64_tr_b16 a[32:33], v46 offset:0
    v_mfma_f32_16x16x32_bf16 v[196:199], a[4:7], a[148:151], v[196:199]
    ds_read_b64_tr_b16 a[34:35], v46 offset:1024
    v_mfma_f32_16x16x32_bf16 v[196:199], a[0:3], a[132:135], v[196:199]
    ds_read_b64_tr_b16 a[36:37], v46 offset:8192
    v_mfma_f32_16x16x32_bf16 a[64:67], a[0:3], a[136:139], a[64:67]
    ds_read_b64_tr_b16 a[38:39], v46 offset:9216
    v_mfma_f32_16x16x32_bf16 a[64:67], a[4:7], a[152:155], a[64:67]
    ds_read_b64_tr_b16 a[40:41], v47 offset:0
    v_mfma_f32_16x16x32_bf16 a[68:71], a[4:7], a[156:159], a[68:71]
    buffer_load_dwordx4 a[196:199], v54, s[8:11], s62 offen sc1
    v_mfma_f32_16x16x32_bf16 a[68:71], a[0:3], a[140:143], a[68:71]
    ds_read_b64_tr_b16 a[42:43], v47 offset:1024
    v_mfma_f32_16x16x32_bf16 a[76:79], a[8:11], a[140:143], a[76:79]
    ds_read_b64_tr_b16 a[44:45], v47 offset:8192
    v_mfma_f32_16x16x32_bf16 a[76:79], a[12:15], a[156:159], a[76:79]
    ds_read_b64_tr_b16 a[46:47], v47 offset:9216
    v_mfma_f32_16x16x32_bf16 a[72:75], a[12:15], a[152:155], a[72:75]
    ds_read_b64_tr_b16 a[48:49], v48 offset:0
    v_mfma_f32_16x16x32_bf16 a[72:75], a[8:11], a[136:139], a[72:75]
    buffer_load_dwordx4 a[200:203], v37, s[8:11], s62 offen sc1
    v_mfma_f32_16x16x32_bf16 v[204:207], a[8:11], a[132:135], v[204:207]
    ds_read_b64_tr_b16 a[50:51], v48 offset:1024
    v_mfma_f32_16x16x32_bf16 v[204:207], a[12:15], a[148:151], v[204:207]
    ds_read_b64_tr_b16 a[52:53], v48 offset:8192
    v_mfma_f32_16x16x32_bf16 v[200:203], a[12:15], a[144:147], v[200:203]
    ds_read_b64_tr_b16 a[54:55], v48 offset:9216
    v_mfma_f32_16x16x32_bf16 v[200:203], a[8:11], a[128:131], v[200:203]
    v_mfma_f32_16x16x32_bf16 v[208:211], a[16:19], a[128:131], v[208:211]
    ds_read_b64_tr_b16 a[56:57], v49 offset:0
    v_mfma_f32_16x16x32_bf16 v[208:211], a[20:23], a[144:147], v[208:211]
    buffer_load_dwordx4 a[204:207], v55, s[8:11], s62 offen sc1
    ds_read_b64_tr_b16 a[58:59], v49 offset:1024
    v_mfma_f32_16x16x32_bf16 v[212:215], a[20:23], a[148:151], v[212:215]
    ds_read_b64_tr_b16 a[60:61], v49 offset:8192
    v_mfma_f32_16x16x32_bf16 v[212:215], a[16:19], a[132:135], v[212:215]
    v_mfma_f32_16x16x32_bf16 a[80:83], a[16:19], a[136:139], a[80:83]
    ds_read_b64_tr_b16 a[62:63], v49 offset:9216
    v_mfma_f32_16x16x32_bf16 a[80:83], a[20:23], a[152:155], a[80:83]
    s_add_u32 s62, s62, 0x20000
    v_mfma_f32_16x16x32_bf16 a[84:87], a[20:23], a[156:159], a[84:87]
    s_add_u32 s52, s47, 12288
    v_mfma_f32_16x16x32_bf16 a[84:87], a[16:19], a[140:143], a[84:87]
    buffer_store_dwordx4 v[116:119], v1, s[48:51], s52 offen offset:1024 sc1
    v_mfma_f32_16x16x32_bf16 a[92:95], a[24:27], a[140:143], a[92:95]
    v_mfma_f32_16x16x32_bf16 a[92:95], a[28:31], a[156:159], a[92:95]
    v_mfma_f32_16x16x32_bf16 a[88:91], a[28:31], a[152:155], a[88:91]
    v_mfma_f32_16x16x32_bf16 a[88:91], a[24:27], a[136:139], a[88:91]
    v_mfma_f32_16x16x32_bf16 v[220:223], a[24:27], a[132:135], v[220:223]
    s_cmp_eq_u32 s45, 0
    s_cbranch_scc1 k12_ool_58
k12_oolret_59:
    v_mfma_f32_16x16x32_bf16 v[220:223], a[28:31], a[148:151], v[220:223]
    v_mfma_f32_16x16x32_bf16 v[216:219], a[28:31], a[144:147], v[216:219]
    v_mfma_f32_16x16x32_bf16 v[216:219], a[24:27], a[128:131], v[216:219]
    s_waitcnt vmcnt(9) lgkmcnt(0)
    s_barrier
    v_mfma_f32_16x16x32_bf16 v[224:227], a[32:35], a[128:131], v[224:227]
    v_mfma_f32_16x16x32_bf16 v[224:227], a[36:39], a[144:147], v[224:227]
    s_add_u32 m0, s60, 131072
    ds_read_b64_tr_b16 a[0:1], v42 offset:16384
    ds_read_b64_tr_b16 a[2:3], v42 offset:17408
    v_mfma_f32_16x16x32_bf16 v[228:231], a[36:39], a[148:151], v[228:231]
    buffer_load_dwordx4 v38, s[12:15], s61 offen offset:0 lds
    v_mfma_f32_16x16x32_bf16 v[228:231], a[32:35], a[132:135], v[228:231]
    ds_read_b64_tr_b16 a[4:5], v42 offset:24576
    v_mfma_f32_16x16x32_bf16 a[96:99], a[32:35], a[136:139], a[96:99]
    buffer_load_dwordx4 v39, s[12:15], s61 offen offset:1024 lds
    ds_read_b64_tr_b16 a[6:7], v42 offset:25600
    v_mfma_f32_16x16x32_bf16 a[96:99], a[36:39], a[152:155], a[96:99]
    ds_read_b64_tr_b16 a[8:9], v43 offset:16384
    v_mfma_f32_16x16x32_bf16 a[100:103], a[36:39], a[156:159], a[100:103]
    v_mfma_f32_16x16x32_bf16 a[100:103], a[32:35], a[140:143], a[100:103]
    buffer_load_dwordx4 v40, s[12:15], s61 offen offset:2048 lds
    ds_read_b64_tr_b16 a[10:11], v43 offset:17408
    v_mfma_f32_16x16x32_bf16 a[108:111], a[40:43], a[140:143], a[108:111]
    ds_read_b64_tr_b16 a[12:13], v43 offset:24576
    v_mfma_f32_16x16x32_bf16 a[108:111], a[44:47], a[156:159], a[108:111]
    ds_read_b64_tr_b16 a[14:15], v43 offset:25600
    v_mfma_f32_16x16x32_bf16 a[104:107], a[44:47], a[152:155], a[104:107]
    buffer_load_dwordx4 v41, s[12:15], s61 offen offset:3072 lds
    ds_read_b64_tr_b16 a[16:17], v44 offset:16384
    v_mfma_f32_16x16x32_bf16 a[104:107], a[40:43], a[136:139], a[104:107]
    v_mfma_f32_16x16x32_bf16 v[236:239], a[40:43], a[132:135], v[236:239]
    s_add_u32 s61, s61, 0x80000
    ds_read_b64_tr_b16 a[18:19], v44 offset:17408
    v_mfma_f32_16x16x32_bf16 v[236:239], a[44:47], a[148:151], v[236:239]
    buffer_load_dwordx4 a[208:211], v36, s[8:11], s62 offen sc1
    ds_read_b64_tr_b16 a[20:21], v44 offset:24576
    v_mfma_f32_16x16x32_bf16 v[232:235], a[44:47], a[144:147], v[232:235]
    ds_read_b64_tr_b16 a[22:23], v44 offset:25600
    v_mfma_f32_16x16x32_bf16 v[232:235], a[40:43], a[128:131], v[232:235]
    buffer_load_dwordx4 a[212:215], v54, s[8:11], s62 offen sc1
    v_mfma_f32_16x16x32_bf16 v[240:243], a[48:51], a[128:131], v[240:243]
    ds_read_b64_tr_b16 a[24:25], v45 offset:16384
    v_mfma_f32_16x16x32_bf16 v[240:243], a[52:55], a[144:147], v[240:243]
    ds_read_b64_tr_b16 a[26:27], v45 offset:17408
    v_mfma_f32_16x16x32_bf16 v[244:247], a[52:55], a[148:151], v[244:247]
    buffer_load_dwordx4 a[216:219], v37, s[8:11], s62 offen sc1
    ds_read_b64_tr_b16 a[28:29], v45 offset:24576
    v_mfma_f32_16x16x32_bf16 v[244:247], a[48:51], a[132:135], v[244:247]
    v_mfma_f32_16x16x32_bf16 a[112:115], a[48:51], a[136:139], a[112:115]
    ds_read_b64_tr_b16 a[30:31], v45 offset:25600
    v_mfma_f32_16x16x32_bf16 a[112:115], a[52:55], a[152:155], a[112:115]
    buffer_load_dwordx4 a[220:223], v55, s[8:11], s62 offen sc1
    v_mfma_f32_16x16x32_bf16 a[116:119], a[52:55], a[156:159], a[116:119]
    v_mfma_f32_16x16x32_bf16 a[116:119], a[48:51], a[140:143], a[116:119]
    s_add_u32 s62, s62, 0x20000
    v_mfma_f32_16x16x32_bf16 a[124:127], a[56:59], a[140:143], a[124:127]
    s_add_u32 s52, s47, 12288
    v_mfma_f32_16x16x32_bf16 a[124:127], a[60:63], a[156:159], a[124:127]
    buffer_store_dwordx4 v[120:123], v1, s[48:51], s52 offen offset:2048 sc1
    v_mfma_f32_16x16x32_bf16 a[120:123], a[60:63], a[152:155], a[120:123]
    v_mfma_f32_16x16x32_bf16 a[120:123], a[56:59], a[136:139], a[120:123]
    v_mfma_f32_16x16x32_bf16 v[252:255], a[56:59], a[132:135], v[252:255]
    v_mfma_f32_16x16x32_bf16 v[252:255], a[60:63], a[148:151], v[252:255]
    v_mfma_f32_16x16x32_bf16 v[248:251], a[60:63], a[144:147], v[248:251]
    v_mfma_f32_16x16x32_bf16 v[248:251], a[56:59], a[128:131], v[248:251]
    s_waitcnt vmcnt(14) lgkmcnt(0)
    v_mfma_f32_16x16x32_bf16 v[192:195], a[0:3], a[160:163], v[192:195]
    v_mfma_f32_16x16x32_bf16 v[192:195], a[4:7], a[176:179], v[192:195]
    buffer_load_dwordx4 a[224:227], v36, s[8:11], s62 offen sc1
    ds_read_b64_tr_b16 a[32:33], v46 offset:16384
    v_mfma_f32_16x16x32_bf16 v[196:199], a[4:7], a[180:183], v[196:199]
    ds_read_b64_tr_b16 a[34:35], v46 offset:17408
    v_mfma_f32_16x16x32_bf16 v[196:199], a[0:3], a[164:167], v[196:199]
    ds_read_b64_tr_b16 a[36:37], v46 offset:24576
    v_mfma_f32_16x16x32_bf16 a[64:67], a[0:3], a[168:171], a[64:67]
    ds_read_b64_tr_b16 a[38:39], v46 offset:25600
    v_mfma_f32_16x16x32_bf16 a[64:67], a[4:7], a[184:187], a[64:67]
    ds_read_b64_tr_b16 a[40:41], v47 offset:16384
    v_mfma_f32_16x16x32_bf16 a[68:71], a[4:7], a[188:191], a[68:71]
    buffer_load_dwordx4 a[228:231], v54, s[8:11], s62 offen sc1
    v_mfma_f32_16x16x32_bf16 a[68:71], a[0:3], a[172:175], a[68:71]
    ds_read_b64_tr_b16 a[42:43], v47 offset:17408
    v_mfma_f32_16x16x32_bf16 a[76:79], a[8:11], a[172:175], a[76:79]
    ds_read_b64_tr_b16 a[44:45], v47 offset:24576
    v_mfma_f32_16x16x32_bf16 a[76:79], a[12:15], a[188:191], a[76:79]
    ds_read_b64_tr_b16 a[46:47], v47 offset:25600
    v_mfma_f32_16x16x32_bf16 a[72:75], a[12:15], a[184:187], a[72:75]
    ds_read_b64_tr_b16 a[48:49], v48 offset:16384
    v_mfma_f32_16x16x32_bf16 a[72:75], a[8:11], a[168:171], a[72:75]
    buffer_load_dwordx4 a[232:235], v37, s[8:11], s62 offen sc1
    v_mfma_f32_16x16x32_bf16 v[204:207], a[8:11], a[164:167], v[204:207]
    ds_read_b64_tr_b16 a[50:51], v48 offset:17408
    v_mfma_f32_16x16x32_bf16 v[204:207], a[12:15], a[180:183], v[204:207]
    ds_read_b64_tr_b16 a[52:53], v48 offset:24576
    v_mfma_f32_16x16x32_bf16 v[200:203], a[12:15], a[176:179], v[200:203]
    ds_read_b64_tr_b16 a[54:55], v48 offset:25600
    v_mfma_f32_16x16x32_bf16 v[200:203], a[8:11], a[160:163], v[200:203]
    v_mfma_f32_16x16x32_bf16 v[208:211], a[16:19], a[160:163], v[208:211]
    ds_read_b64_tr_b16 a[56:57], v49 offset:16384
    v_mfma_f32_16x16x32_bf16 v[208:211], a[20:23], a[176:179], v[208:211]
    buffer_load_dwordx4 a[236:239], v55, s[8:11], s62 offen sc1
    ds_read_b64_tr_b16 a[58:59], v49 offset:17408
    v_mfma_f32_16x16x32_bf16 v[212:215], a[20:23], a[180:183], v[212:215]
    ds_read_b64_tr_b16 a[60:61], v49 offset:24576
    v_mfma_f32_16x16x32_bf16 v[212:215], a[16:19], a[164:167], v[212:215]
    v_mfma_f32_16x16x32_bf16 a[80:83], a[16:19], a[168:171], a[80:83]
    ds_read_b64_tr_b16 a[62:63], v49 offset:25600
    v_mfma_f32_16x16x32_bf16 a[80:83], a[20:23], a[184:187], a[80:83]
    s_add_u32 s62, s62, 0x20000
    v_mfma_f32_16x16x32_bf16 a[84:87], a[20:23], a[188:191], a[84:87]
    s_add_u32 s52, s47, 12288
    v_mfma_f32_16x16x32_bf16 a[84:87], a[16:19], a[172:175], a[84:87]
    buffer_store_dwordx4 v[124:127], v1, s[48:51], s52 offen offset:3072 sc1
    v_mfma_f32_16x16x32_bf16 a[92:95], a[24:27], a[172:175], a[92:95]
    v_mfma_f32_16x16x32_bf16 a[92:95], a[28:31], a[188:191], a[92:95]
    v_mfma_f32_16x16x32_bf16 a[88:91], a[28:31], a[184:187], a[88:91]
    v_mfma_f32_16x16x32_bf16 a[88:91], a[24:27], a[168:171], a[88:91]
    v_mfma_f32_16x16x32_bf16 v[220:223], a[24:27], a[164:167], v[220:223]
    v_mfma_f32_16x16x32_bf16 v[220:223], a[28:31], a[180:183], v[220:223]
    v_mfma_f32_16x16x32_bf16 v[216:219], a[28:31], a[176:179], v[216:219]
    v_mfma_f32_16x16x32_bf16 v[216:219], a[24:27], a[160:163], v[216:219]
    s_waitcnt vmcnt(10) lgkmcnt(0)
    s_barrier
    v_mfma_f32_16x16x32_bf16 v[224:227], a[32:35], a[160:163], v[224:227]
    v_mfma_f32_16x16x32_bf16 v[224:227], a[36:39], a[176:179], v[224:227]
    s_add_u32 m0, s60, 147456
    ds_read_b64_tr_b16 a[0:1], v42 offset:32768
    ds_read_b64_tr_b16 a[2:3], v42 offset:33792
    v_mfma_f32_16x16x32_bf16 v[228:231], a[36:39], a[180:183], v[228:231]
    buffer_load_dwordx4 v38, s[12:15], s61 offen offset:0 lds
    v_mfma_f32_16x16x32_bf16 v[228:231], a[32:35], a[164:167], v[228:231]
    ds_read_b64_tr_b16 a[4:5], v42 offset:40960
    v_mfma_f32_16x16x32_bf16 a[96:99], a[32:35], a[168:171], a[96:99]
    buffer_load_dwordx4 v39, s[12:15], s61 offen offset:1024 lds
    ds_read_b64_tr_b16 a[6:7], v42 offset:41984
    v_mfma_f32_16x16x32_bf16 a[96:99], a[36:39], a[184:187], a[96:99]
    ds_read_b64_tr_b16 a[8:9], v43 offset:32768
    v_mfma_f32_16x16x32_bf16 a[100:103], a[36:39], a[188:191], a[100:103]
    v_mfma_f32_16x16x32_bf16 a[100:103], a[32:35], a[172:175], a[100:103]
    buffer_load_dwordx4 v40, s[12:15], s61 offen offset:2048 lds
    ds_read_b64_tr_b16 a[10:11], v43 offset:33792
    v_mfma_f32_16x16x32_bf16 a[108:111], a[40:43], a[172:175], a[108:111]
    ds_read_b64_tr_b16 a[12:13], v43 offset:40960
    v_mfma_f32_16x16x32_bf16 a[108:111], a[44:47], a[188:191], a[108:111]
    ds_read_b64_tr_b16 a[14:15], v43 offset:41984
    v_mfma_f32_16x16x32_bf16 a[104:107], a[44:47], a[184:187], a[104:107]
    buffer_load_dwordx4 v41, s[12:15], s61 offen offset:3072 lds
    ds_read_b64_tr_b16 a[16:17], v44 offset:32768
    v_mfma_f32_16x16x32_bf16 a[104:107], a[40:43], a[168:171], a[104:107]
    v_mfma_f32_16x16x32_bf16 v[236:239], a[40:43], a[164:167], v[236:239]
    s_add_u32 s61, s61, 0x80000
    ds_read_b64_tr_b16 a[18:19], v44 offset:33792
    v_mfma_f32_16x16x32_bf16 v[236:239], a[44:47], a[180:183], v[236:239]
    buffer_load_dwordx4 a[240:243], v36, s[8:11], s62 offen sc1
    ds_read_b64_tr_b16 a[20:21], v44 offset:40960
    v_mfma_f32_16x16x32_bf16 v[232:235], a[44:47], a[176:179], v[232:235]
    ds_read_b64_tr_b16 a[22:23], v44 offset:41984
    v_mfma_f32_16x16x32_bf16 v[232:235], a[40:43], a[160:163], v[232:235]
    buffer_load_dwordx4 a[244:247], v54, s[8:11], s62 offen sc1
    v_mfma_f32_16x16x32_bf16 v[240:243], a[48:51], a[160:163], v[240:243]
    ds_read_b64_tr_b16 a[24:25], v45 offset:32768
    v_mfma_f32_16x16x32_bf16 v[240:243], a[52:55], a[176:179], v[240:243]
    ds_read_b64_tr_b16 a[26:27], v45 offset:33792
    v_mfma_f32_16x16x32_bf16 v[244:247], a[52:55], a[180:183], v[244:247]
    buffer_load_dwordx4 a[248:251], v37, s[8:11], s62 offen sc1
    ds_read_b64_tr_b16 a[28:29], v45 offset:40960
    v_mfma_f32_16x16x32_bf16 v[244:247], a[48:51], a[164:167], v[244:247]
    v_mfma_f32_16x16x32_bf16 a[112:115], a[48:51], a[168:171], a[112:115]
    ds_read_b64_tr_b16 a[30:31], v45 offset:41984
    v_mfma_f32_16x16x32_bf16 a[112:115], a[52:55], a[184:187], a[112:115]
    buffer_load_dwordx4 a[252:255], v55, s[8:11], s62 offen sc1
    v_mfma_f32_16x16x32_bf16 a[116:119], a[52:55], a[188:191], a[116:119]
    v_mfma_f32_16x16x32_bf16 a[116:119], a[48:51], a[172:175], a[116:119]
    s_add_u32 s62, s62, 0x20000
    v_mfma_f32_16x16x32_bf16 a[124:127], a[56:59], a[172:175], a[124:127]
    s_add_u32 s52, s47, 524288
    v_mfma_f32_16x16x32_bf16 a[124:127], a[60:63], a[188:191], a[124:127]
    buffer_store_dwordx4 v[136:139], v1, s[48:51], s52 offen offset:2048 sc1
    v_mfma_f32_16x16x32_bf16 a[120:123], a[60:63], a[184:187], a[120:123]
    v_mfma_f32_16x16x32_bf16 a[120:123], a[56:59], a[168:171], a[120:123]
    v_mfma_f32_16x16x32_bf16 v[252:255], a[56:59], a[164:167], v[252:255]
    s_cmp_eq_u32 s45, 0
    s_cbranch_scc1 k12_ool_60
k12_oolret_61:
    v_mfma_f32_16x16x32_bf16 v[252:255], a[60:63], a[180:183], v[252:255]
    v_mfma_f32_16x16x32_bf16 v[248:251], a[60:63], a[176:179], v[248:251]
    v_mfma_f32_16x16x32_bf16 v[248:251], a[56:59], a[160:163], v[248:251]
    s_waitcnt vmcnt(15) lgkmcnt(0)
    v_mfma_f32_16x16x32_bf16 v[192:195], a[0:3], a[192:195], v[192:195]
    v_mfma_f32_16x16x32_bf16 v[192:195], a[4:7], a[208:211], v[192:195]
    buffer_load_dwordx4 a[128:131], v36, s[8:11], s62 offen sc1
    ds_read_b64_tr_b16 a[32:33], v46 offset:32768
    v_mfma_f32_16x16x32_bf16 v[196:199], a[4:7], a[212:215], v[196:199]
    ds_read_b64_tr_b16 a[34:35], v46 offset:33792
    v_mfma_f32_16x16x32_bf16 v[196:199], a[0:3], a[196:199], v[196:199]
    ds_read_b64_tr_b16 a[36:37], v46 offset:40960
    v_mfma_f32_16x16x32_bf16 a[64:67], a[0:3], a[200:203], a[64:67]
    ds_read_b64_tr_b16 a[38:39], v46 offset:41984
    v_mfma_f32_16x16x32_bf16 a[64:67], a[4:7], a[216:219], a[64:67]
    ds_read_b64_tr_b16 a[40:41], v47 offset:32768
    v_mfma_f32_16x16x32_bf16 a[68:71], a[4:7], a[220:223], a[68:71]
    buffer_load_dwordx4 a[132:135], v54, s[8:11], s62 offen sc1
    v_mfma_f32_16x16x32_bf16 a[68:71], a[0:3], a[204:207], a[68:71]
    ds_read_b64_tr_b16 a[42:43], v47 offset:33792
    v_mfma_f32_16x16x32_bf16 a[76:79], a[8:11], a[204:207], a[76:79]
    ds_read_b64_tr_b16 a[44:45], v47 offset:40960
    v_mfma_f32_16x16x32_bf16 a[76:79], a[12:15], a[220:223], a[76:79]
    ds_read_b64_tr_b16 a[46:47], v47 offset:41984
    v_mfma_f32_16x16x32_bf16 a[72:75], a[12:15], a[216:219], a[72:75]
    ds_read_b64_tr_b16 a[48:49], v48 offset:32768
    v_mfma_f32_16x16x32_bf16 a[72:75], a[8:11], a[200:203], a[72:75]
    buffer_load_dwordx4 a[136:139], v37, s[8:11], s62 offen sc1
    v_mfma_f32_16x16x32_bf16 v[204:207], a[8:11], a[196:199], v[204:207]
    ds_read_b64_tr_b16 a[50:51], v48 offset:33792
    v_mfma_f32_16x16x32_bf16 v[204:207], a[12:15], a[212:215], v[204:207]
    ds_read_b64_tr_b16 a[52:53], v48 offset:40960
    v_mfma_f32_16x16x32_bf16 v[200:203], a[12:15], a[208:211], v[200:203]
    ds_read_b64_tr_b16 a[54:55], v48 offset:41984
    v_mfma_f32_16x16x32_bf16 v[200:203], a[8:11], a[192:195], v[200:203]
    v_mfma_f32_16x16x32_bf16 v[208:211], a[16:19], a[192:195], v[208:211]
    ds_read_b64_tr_b16 a[56:57], v49 offset:32768
    v_mfma_f32_16x16x32_bf16 v[208:211], a[20:23], a[208:211], v[208:211]
    buffer_load_dwordx4 a[140:143], v55, s[8:11], s62 offen sc1
    ds_read_b64_tr_b16 a[58:59], v49 offset:33792
    v_mfma_f32_16x16x32_bf16 v[212:215], a[20:23], a[212:215], v[212:215]
    ds_read_b64_tr_b16 a[60:61], v49 offset:40960
    v_mfma_f32_16x16x32_bf16 v[212:215], a[16:19], a[196:199], v[212:215]
    v_mfma_f32_16x16x32_bf16 a[80:83], a[16:19], a[200:203], a[80:83]
    ds_read_b64_tr_b16 a[62:63], v49 offset:41984
    v_mfma_f32_16x16x32_bf16 a[80:83], a[20:23], a[216:219], a[80:83]
    s_add_u32 s62, s62, 0x20000
    v_mfma_f32_16x16x32_bf16 a[84:87], a[20:23], a[220:223], a[84:87]
    s_add_u32 s52, s47, 524288
    v_mfma_f32_16x16x32_bf16 a[84:87], a[16:19], a[204:207], a[84:87]
    buffer_store_dwordx4 v[140:143], v1, s[48:51], s52 offen offset:3072 sc1
    v_mfma_f32_16x16x32_bf16 a[92:95], a[24:27], a[204:207], a[92:95]
    v_mfma_f32_16x16x32_bf16 a[92:95], a[28:31], a[220:223], a[92:95]
    v_mfma_f32_16x16x32_bf16 a[88:91], a[28:31], a[216:219], a[88:91]
    v_mfma_f32_16x16x32_bf16 a[88:91], a[24:27], a[200:203], a[88:91]
    v_mfma_f32_16x16x32_bf16 v[220:223], a[24:27], a[196:199], v[220:223]
    v_mfma_f32_16x16x32_bf16 v[220:223], a[28:31], a[212:215], v[220:223]
    v_mfma_f32_16x16x32_bf16 v[216:219], a[28:31], a[208:211], v[216:219]
    v_mfma_f32_16x16x32_bf16 v[216:219], a[24:27], a[192:195], v[216:219]
    s_waitcnt vmcnt(10) lgkmcnt(0)
    s_barrier
    v_mfma_f32_16x16x32_bf16 v[224:227], a[32:35], a[192:195], v[224:227]
    v_mfma_f32_16x16x32_bf16 v[224:227], a[36:39], a[208:211], v[224:227]
    s_add_u32 m0, s60, 98304
    ds_read_b64_tr_b16 a[0:1], v42 offset:49152
    ds_read_b64_tr_b16 a[2:3], v42 offset:50176
    v_mfma_f32_16x16x32_bf16 v[228:231], a[36:39], a[212:215], v[228:231]
    buffer_load_dwordx4 v38, s[12:15], s61 offen offset:0 lds
    v_mfma_f32_16x16x32_bf16 v[228:231], a[32:35], a[196:199], v[228:231]
    ds_read_b64_tr_b16 a[4:5], v42 offset:57344
    v_mfma_f32_16x16x32_bf16 a[96:99], a[32:35], a[200:203], a[96:99]
    buffer_load_dwordx4 v39, s[12:15], s61 offen offset:1024 lds
    ds_read_b64_tr_b16 a[6:7], v42 offset:58368
    v_mfma_f32_16x16x32_bf16 a[96:99], a[36:39], a[216:219], a[96:99]
    ds_read_b64_tr_b16 a[8:9], v43 offset:49152
    v_mfma_f32_16x16x32_bf16 a[100:103], a[36:39], a[220:223], a[100:103]
    v_mfma_f32_16x16x32_bf16 a[100:103], a[32:35], a[204:207], a[100:103]
    buffer_load_dwordx4 v40, s[12:15], s61 offen offset:2048 lds
    ds_read_b64_tr_b16 a[10:11], v43 offset:50176
    v_mfma_f32_16x16x32_bf16 a[108:111], a[40:43], a[204:207], a[108:111]
    ds_read_b64_tr_b16 a[12:13], v43 offset:57344
    v_mfma_f32_16x16x32_bf16 a[108:111], a[44:47], a[220:223], a[108:111]
    ds_read_b64_tr_b16 a[14:15], v43 offset:58368
    v_mfma_f32_16x16x32_bf16 a[104:107], a[44:47], a[216:219], a[104:107]
    ds_read_b64_tr_b16 a[16:17], v44 offset:49152
    v_mfma_f32_16x16x32_bf16 a[104:107], a[40:43], a[200:203], a[104:107]
    buffer_load_dwordx4 v41, s[12:15], s61 offen offset:3072 lds
    v_mfma_f32_16x16x32_bf16 v[236:239], a[40:43], a[196:199], v[236:239]
    ds_read_b64_tr_b16 a[18:19], v44 offset:50176
    v_mfma_f32_16x16x32_bf16 v[236:239], a[44:47], a[212:215], v[236:239]
    s_add_u32 s61, s61, 0x80000
    ds_read_b64_tr_b16 a[20:21], v44 offset:57344
    v_mfma_f32_16x16x32_bf16 v[232:235], a[44:47], a[208:211], v[232:235]
    buffer_load_dwordx4 a[144:147], v36, s[8:11], s62 offen sc1
    ds_read_b64_tr_b16 a[22:23], v44 offset:58368
    v_mfma_f32_16x16x32_bf16 v[232:235], a[40:43], a[192:195], v[232:235]
    v_mfma_f32_16x16x32_bf16 v[240:243], a[48:51], a[192:195], v[240:243]
    ds_read_b64_tr_b16 a[24:25], v45 offset:49152
    v_mfma_f32_16x16x32_bf16 v[240:243], a[52:55], a[208:211], v[240:243]
    buffer_load_dwordx4 a[148:151], v54, s[8:11], s62 offen sc1
    ds_read_b64_tr_b16 a[26:27], v45 offset:50176
    v_mfma_f32_16x16x32_bf16 v[244:247], a[52:55], a[212:215], v[244:247]
    ds_read_b64_tr_b16 a[28:29], v45 offset:57344
    v_mfma_f32_16x16x32_bf16 v[244:247], a[48:51], a[196:199], v[244:247]
    v_mfma_f32_16x16x32_bf16 a[112:115], a[48:51], a[200:203], a[112:115]
    buffer_load_dwordx4 a[152:155], v37, s[8:11], s62 offen sc1
    ds_read_b64_tr_b16 a[30:31], v45 offset:58368
    v_mfma_f32_16x16x32_bf16 a[112:115], a[52:55], a[216:219], a[112:115]
    v_mfma_f32_16x16x32_bf16 a[116:119], a[52:55], a[220:223], a[116:119]
    v_mfma_f32_16x16x32_bf16 a[116:119], a[48:51], a[204:207], a[116:119]
    v_mfma_f32_16x16x32_bf16 a[124:127], a[56:59], a[204:207], a[124:127]
    buffer_load_dwordx4 a[156:159], v55, s[8:11], s62 offen sc1
    v_mfma_f32_16x16x32_bf16 a[124:127], a[60:63], a[220:223], a[124:127]
    v_mfma_f32_16x16x32_bf16 a[120:123], a[60:63], a[216:219], a[120:123]
    s_add_u32 s62, s62, 0x20000
    v_mfma_f32_16x16x32_bf16 a[120:123], a[56:59], a[200:203], a[120:123]
    v_mfma_f32_16x16x32_bf16 v[252:255], a[56:59], a[196:199], v[252:255]
    s_cmp_eq_u32 s45, 0
    s_cbranch_scc1 k12_ool_62
k12_oolret_63:
    v_mfma_f32_16x16x32_bf16 v[252:255], a[60:63], a[212:215], v[252:255]
    v_mfma_f32_16x16x32_bf16 v[248:251], a[60:63], a[208:211], v[248:251]
    v_mfma_f32_16x16x32_bf16 v[248:251], a[56:59], a[192:195], v[248:251]
    s_waitcnt vmcnt(14) lgkmcnt(0)
    v_mfma_f32_16x16x32_bf16 v[192:195], a[0:3], a[224:227], v[192:195]
    v_mfma_f32_16x16x32_bf16 v[192:195], a[4:7], a[240:243], v[192:195]
    buffer_load_dwordx4 a[160:163], v36, s[8:11], s62 offen sc1
    ds_read_b64_tr_b16 a[32:33], v46 offset:49152
    v_mfma_f32_16x16x32_bf16 v[196:199], a[4:7], a[244:247], v[196:199]
    ds_read_b64_tr_b16 a[34:35], v46 offset:50176
    v_mfma_f32_16x16x32_bf16 v[196:199], a[0:3], a[228:231], v[196:199]
    ds_read_b64_tr_b16 a[36:37], v46 offset:57344
    v_mfma_f32_16x16x32_bf16 a[64:67], a[0:3], a[232:235], a[64:67]
    ds_read_b64_tr_b16 a[38:39], v46 offset:58368
    v_mfma_f32_16x16x32_bf16 a[64:67], a[4:7], a[248:251], a[64:67]
    ds_read_b64_tr_b16 a[40:41], v47 offset:49152
    v_mfma_f32_16x16x32_bf16 a[68:71], a[4:7], a[252:255], a[68:71]
    buffer_load_dwordx4 a[164:167], v54, s[8:11], s62 offen sc1
    v_mfma_f32_16x16x32_bf16 a[68:71], a[0:3], a[236:239], a[68:71]
    ds_read_b64_tr_b16 a[42:43], v47 offset:50176
    v_mfma_f32_16x16x32_bf16 a[76:79], a[8:11], a[236:239], a[76:79]
    ds_read_b64_tr_b16 a[44:45], v47 offset:57344
    v_mfma_f32_16x16x32_bf16 a[76:79], a[12:15], a[252:255], a[76:79]
    ds_read_b64_tr_b16 a[46:47], v47 offset:58368
    v_mfma_f32_16x16x32_bf16 a[72:75], a[12:15], a[248:251], a[72:75]
    ds_read_b64_tr_b16 a[48:49], v48 offset:49152
    v_mfma_f32_16x16x32_bf16 a[72:75], a[8:11], a[232:235], a[72:75]
    buffer_load_dwordx4 a[168:171], v37, s[8:11], s62 offen sc1
    v_mfma_f32_16x16x32_bf16 v[204:207], a[8:11], a[228:231], v[204:207]
    ds_read_b64_tr_b16 a[50:51], v48 offset:50176
    v_mfma_f32_16x16x32_bf16 v[204:207], a[12:15], a[244:247], v[204:207]
    ds_read_b64_tr_b16 a[52:53], v48 offset:57344
    v_mfma_f32_16x16x32_bf16 v[200:203], a[12:15], a[240:243], v[200:203]
    ds_read_b64_tr_b16 a[54:55], v48 offset:58368
    v_mfma_f32_16x16x32_bf16 v[200:203], a[8:11], a[224:227], v[200:203]
    v_mfma_f32_16x16x32_bf16 v[208:211], a[16:19], a[224:227], v[208:211]
    ds_read_b64_tr_b16 a[56:57], v49 offset:49152
    v_mfma_f32_16x16x32_bf16 v[208:211], a[20:23], a[240:243], v[208:211]
    buffer_load_dwordx4 a[172:175], v55, s[8:11], s62 offen sc1
    ds_read_b64_tr_b16 a[58:59], v49 offset:50176
    v_mfma_f32_16x16x32_bf16 v[212:215], a[20:23], a[244:247], v[212:215]
    ds_read_b64_tr_b16 a[60:61], v49 offset:57344
    v_mfma_f32_16x16x32_bf16 v[212:215], a[16:19], a[228:231], v[212:215]
    v_mfma_f32_16x16x32_bf16 a[80:83], a[16:19], a[232:235], a[80:83]
    ds_read_b64_tr_b16 a[62:63], v49 offset:58368
    v_mfma_f32_16x16x32_bf16 a[80:83], a[20:23], a[248:251], a[80:83]
    s_add_u32 s62, s62, 0x20000
    v_mfma_f32_16x16x32_bf16 a[84:87], a[20:23], a[252:255], a[84:87]
    s_add_u32 s52, s47, 528384
    v_mfma_f32_16x16x32_bf16 a[84:87], a[16:19], a[236:239], a[84:87]
    buffer_store_dwordx4 v[144:147], v1, s[48:51], s52 offen offset:0 sc1
    v_mfma_f32_16x16x32_bf16 a[92:95], a[24:27], a[236:239], a[92:95]
    v_mfma_f32_16x16x32_bf16 a[92:95], a[28:31], a[252:255], a[92:95]
    v_mfma_f32_16x16x32_bf16 a[88:91], a[28:31], a[248:251], a[88:91]
    v_mfma_f32_16x16x32_bf16 a[88:91], a[24:27], a[232:235], a[88:91]
    v_mfma_f32_16x16x32_bf16 v[220:223], a[24:27], a[228:231], v[220:223]
    v_mfma_f32_16x16x32_bf16 v[220:223], a[28:31], a[244:247], v[220:223]
    v_mfma_f32_16x16x32_bf16 v[216:219], a[28:31], a[240:243], v[216:219]
    v_mfma_f32_16x16x32_bf16 v[216:219], a[24:27], a[224:227], v[216:219]
    s_waitcnt vmcnt(9) lgkmcnt(0)
    s_barrier
    v_mfma_f32_16x16x32_bf16 v[224:227], a[32:35], a[224:227], v[224:227]
    v_mfma_f32_16x16x32_bf16 v[224:227], a[36:39], a[240:243], v[224:227]
    s_add_u32 m0, s60, 114688
    ds_read_b64_tr_b16 a[0:1], v42 offset:0
    ds_read_b64_tr_b16 a[2:3], v42 offset:1024
    v_mfma_f32_16x16x32_bf16 v[228:231], a[36:39], a[244:247], v[228:231]
    buffer_load_dwordx4 v38, s[12:15], s61 offen offset:0 lds
    v_mfma_f32_16x16x32_bf16 v[228:231], a[32:35], a[228:231], v[228:231]
    ds_read_b64_tr_b16 a[4:5], v42 offset:8192
    v_mfma_f32_16x16x32_bf16 a[96:99], a[32:35], a[232:235], a[96:99]
    buffer_load_dwordx4 v39, s[12:15], s61 offen offset:1024 lds
    ds_read_b64_tr_b16 a[6:7], v42 offset:9216
    v_mfma_f32_16x16x32_bf16 a[96:99], a[36:39], a[248:251], a[96:99]
    ds_read_b64_tr_b16 a[8:9], v43 offset:0
    v_mfma_f32_16x16x32_bf16 a[100:103], a[36:39], a[252:255], a[100:103]
    v_mfma_f32_16x16x32_bf16 a[100:103], a[32:35], a[236:239], a[100:103]
    buffer_load_dwordx4 v40, s[12:15], s61 offen offset:2048 lds
    ds_read_b64_tr_b16 a[10:11], v43 offset:1024
    v_mfma_f32_16x16x32_bf16 a[108:111], a[40:43], a[236:239], a[108:111]
    ds_read_b64_tr_b16 a[12:13], v43 offset:8192
    v_mfma_f32_16x16x32_bf16 a[108:111], a[44:47], a[252:255], a[108:111]
    ds_read_b64_tr_b16 a[14:15], v43 offset:9216
    v_mfma_f32_16x16x32_bf16 a[104:107], a[44:47], a[248:251], a[104:107]
    buffer_load_dwordx4 v41, s[12:15], s61 offen offset:3072 lds
    ds_read_b64_tr_b16 a[16:17], v44 offset:0
    v_mfma_f32_16x16x32_bf16 a[104:107], a[40:43], a[232:235], a[104:107]
    v_mfma_f32_16x16x32_bf16 v[236:239], a[40:43], a[228:231], v[236:239]
    s_add_u32 s61, s61, 0x80000
    ds_read_b64_tr_b16 a[18:19], v44 offset:1024
    v_mfma_f32_16x16x32_bf16 v[236:239], a[44:47], a[244:247], v[236:239]
    buffer_load_dwordx4 a[176:179], v36, s[8:11], s62 offen sc1
    ds_read_b64_tr_b16 a[20:21], v44 offset:8192
    v_mfma_f32_16x16x32_bf16 v[232:235], a[44:47], a[240:243], v[232:235]
    ds_read_b64_tr_b16 a[22:23], v44 offset:9216
    v_mfma_f32_16x16x32_bf16 v[232:235], a[40:43], a[224:227], v[232:235]
    buffer_load_dwordx4 a[180:183], v54, s[8:11], s62 offen sc1
    v_mfma_f32_16x16x32_bf16 v[240:243], a[48:51], a[224:227], v[240:243]
    ds_read_b64_tr_b16 a[24:25], v45 offset:0
    v_mfma_f32_16x16x32_bf16 v[240:243], a[52:55], a[240:243], v[240:243]
    ds_read_b64_tr_b16 a[26:27], v45 offset:1024
    v_mfma_f32_16x16x32_bf16 v[244:247], a[52:55], a[244:247], v[244:247]
    buffer_load_dwordx4 a[184:187], v37, s[8:11], s62 offen sc1
    ds_read_b64_tr_b16 a[28:29], v45 offset:8192
    v_mfma_f32_16x16x32_bf16 v[244:247], a[48:51], a[228:231], v[244:247]
    v_mfma_f32_16x16x32_bf16 a[112:115], a[48:51], a[232:235], a[112:115]
    ds_read_b64_tr_b16 a[30:31], v45 offset:9216
    v_mfma_f32_16x16x32_bf16 a[112:115], a[52:55], a[248:251], a[112:115]
    buffer_load_dwordx4 a[188:191], v55, s[8:11], s62 offen sc1
    v_mfma_f32_16x16x32_bf16 a[116:119], a[52:55], a[252:255], a[116:119]
    v_mfma_f32_16x16x32_bf16 a[116:119], a[48:51], a[236:239], a[116:119]
    s_add_u32 s62, s62, 0x20000
    v_mfma_f32_16x16x32_bf16 a[124:127], a[56:59], a[236:239], a[124:127]
    s_add_u32 s52, s47, 528384
    v_mfma_f32_16x16x32_bf16 a[124:127], a[60:63], a[252:255], a[124:127]
    buffer_store_dwordx4 v[148:151], v1, s[48:51], s52 offen offset:1024 sc1
    v_mfma_f32_16x16x32_bf16 a[120:123], a[60:63], a[248:251], a[120:123]
    v_mfma_f32_16x16x32_bf16 a[120:123], a[56:59], a[232:235], a[120:123]
    v_mfma_f32_16x16x32_bf16 v[252:255], a[56:59], a[228:231], v[252:255]
    s_cmp_eq_u32 s45, 0
    s_cbranch_scc1 k12_ool_64
k12_oolret_65:
    v_mfma_f32_16x16x32_bf16 v[252:255], a[60:63], a[244:247], v[252:255]
    v_mfma_f32_16x16x32_bf16 v[248:251], a[60:63], a[240:243], v[248:251]
    v_mfma_f32_16x16x32_bf16 v[248:251], a[56:59], a[224:227], v[248:251]
    s_waitcnt vmcnt(14) lgkmcnt(0)
    v_mfma_f32_16x16x32_bf16 v[192:195], a[0:3], a[128:131], v[192:195]
    v_mfma_f32_16x16x32_bf16 v[192:195], a[4:7], a[144:147], v[192:195]
    buffer_load_dwordx4 a[192:195], v36, s[8:11], s62 offen sc1
    ds_read_b64_tr_b16 a[32:33], v46 offset:0
    v_mfma_f32_16x16x32_bf16 v[196:199], a[4:7], a[148:151], v[196:199]
    ds_read_b64_tr_b16 a[34:35], v46 offset:1024
    v_mfma_f32_16x16x32_bf16 v[196:199], a[0:3], a[132:135], v[196:199]
    ds_read_b64_tr_b16 a[36:37], v46 offset:8192
    v_mfma_f32_16x16x32_bf16 a[64:67], a[0:3], a[136:139], a[64:67]
    ds_read_b64_tr_b16 a[38:39], v46 offset:9216
    v_mfma_f32_16x16x32_bf16 a[64:67], a[4:7], a[152:155], a[64:67]
    ds_read_b64_tr_b16 a[40:41], v47 offset:0
    v_mfma_f32_16x16x32_bf16 a[68:71], a[4:7], a[156:159], a[68:71]
    buffer_load_dwordx4 a[196:199], v54, s[8:11], s62 offen sc1
    v_mfma_f32_16x16x32_bf16 a[68:71], a[0:3], a[140:143], a[68:71]
    ds_read_b64_tr_b16 a[42:43], v47 offset:1024
    v_mfma_f32_16x16x32_bf16 a[76:79], a[8:11], a[140:143], a[76:79]
    ds_read_b64_tr_b16 a[44:45], v47 offset:8192
    v_mfma_f32_16x16x32_bf16 a[76:79], a[12:15], a[156:159], a[76:79]
    ds_read_b64_tr_b16 a[46:47], v47 offset:9216
    v_mfma_f32_16x16x32_bf16 a[72:75], a[12:15], a[152:155], a[72:75]
    ds_read_b64_tr_b16 a[48:49], v48 offset:0
    v_mfma_f32_16x16x32_bf16 a[72:75], a[8:11], a[136:139], a[72:75]
    buffer_load_dwordx4 a[200:203], v37, s[8:11], s62 offen sc1
    v_mfma_f32_16x16x32_bf16 v[204:207], a[8:11], a[132:135], v[204:207]
    ds_read_b64_tr_b16 a[50:51], v48 offset:1024
    v_mfma_f32_16x16x32_bf16 v[204:207], a[12:15], a[148:151], v[204:207]
    ds_read_b64_tr_b16 a[52:53], v48 offset:8192
    v_mfma_f32_16x16x32_bf16 v[200:203], a[12:15], a[144:147], v[200:203]
    ds_read_b64_tr_b16 a[54:55], v48 offset:9216
    v_mfma_f32_16x16x32_bf16 v[200:203], a[8:11], a[128:131], v[200:203]
    v_mfma_f32_16x16x32_bf16 v[208:211], a[16:19], a[128:131], v[208:211]
    ds_read_b64_tr_b16 a[56:57], v49 offset:0
    v_mfma_f32_16x16x32_bf16 v[208:211], a[20:23], a[144:147], v[208:211]
    buffer_load_dwordx4 a[204:207], v55, s[8:11], s62 offen sc1
    ds_read_b64_tr_b16 a[58:59], v49 offset:1024
    v_mfma_f32_16x16x32_bf16 v[212:215], a[20:23], a[148:151], v[212:215]
    ds_read_b64_tr_b16 a[60:61], v49 offset:8192
    v_mfma_f32_16x16x32_bf16 v[212:215], a[16:19], a[132:135], v[212:215]
    v_mfma_f32_16x16x32_bf16 a[80:83], a[16:19], a[136:139], a[80:83]
    ds_read_b64_tr_b16 a[62:63], v49 offset:9216
    v_mfma_f32_16x16x32_bf16 a[80:83], a[20:23], a[152:155], a[80:83]
    s_add_u32 s62, s62, 0x20000
    v_mfma_f32_16x16x32_bf16 a[84:87], a[20:23], a[156:159], a[84:87]
    s_add_u32 s52, s47, 528384
    v_mfma_f32_16x16x32_bf16 a[84:87], a[16:19], a[140:143], a[84:87]
    buffer_store_dwordx4 v[152:155], v1, s[48:51], s52 offen offset:2048 sc1
    v_mfma_f32_16x16x32_bf16 a[92:95], a[24:27], a[140:143], a[92:95]
    v_mfma_f32_16x16x32_bf16 a[92:95], a[28:31], a[156:159], a[92:95]
    v_mfma_f32_16x16x32_bf16 a[88:91], a[28:31], a[152:155], a[88:91]
    v_mfma_f32_16x16x32_bf16 a[88:91], a[24:27], a[136:139], a[88:91]
    v_mfma_f32_16x16x32_bf16 v[220:223], a[24:27], a[132:135], v[220:223]
    v_mfma_f32_16x16x32_bf16 v[220:223], a[28:31], a[148:151], v[220:223]
    v_mfma_f32_16x16x32_bf16 v[216:219], a[28:31], a[144:147], v[216:219]
    v_mfma_f32_16x16x32_bf16 v[216:219], a[24:27], a[128:131], v[216:219]
    s_waitcnt vmcnt(10) lgkmcnt(0)
    s_barrier
    v_mfma_f32_16x16x32_bf16 v[224:227], a[32:35], a[128:131], v[224:227]
    v_mfma_f32_16x16x32_bf16 v[224:227], a[36:39], a[144:147], v[224:227]
    s_add_u32 m0, s60, 131072
    ds_read_b64_tr_b16 a[0:1], v42 offset:16384
    ds_read_b64_tr_b16 a[2:3], v42 offset:17408
    v_mfma_f32_16x16x32_bf16 v[228:231], a[36:39], a[148:151], v[228:231]
    buffer_load_dwordx4 v38, s[12:15], s61 offen offset:0 lds
    v_mfma_f32_16x16x32_bf16 v[228:231], a[32:35], a[132:135], v[228:231]
    ds_read_b64_tr_b16 a[4:5], v42 offset:24576
    v_mfma_f32_16x16x32_bf16 a[96:99], a[32:35], a[136:139], a[96:99]
    buffer_load_dwordx4 v39, s[12:15], s61 offen offset:1024 lds
    ds_read_b64_tr_b16 a[6:7], v42 offset:25600
    v_mfma_f32_16x16x32_bf16 a[96:99], a[36:39], a[152:155], a[96:99]
    ds_read_b64_tr_b16 a[8:9], v43 offset:16384
    v_mfma_f32_16x16x32_bf16 a[100:103], a[36:39], a[156:159], a[100:103]
    v_mfma_f32_16x16x32_bf16 a[100:103], a[32:35], a[140:143], a[100:103]
    buffer_load_dwordx4 v40, s[12:15], s61 offen offset:2048 lds
    ds_read_b64_tr_b16 a[10:11], v43 offset:17408
    v_mfma_f32_16x16x32_bf16 a[108:111], a[40:43], a[140:143], a[108:111]
    ds_read_b64_tr_b16 a[12:13], v43 offset:24576
    v_mfma_f32_16x16x32_bf16 a[108:111], a[44:47], a[156:159], a[108:111]
    ds_read_b64_tr_b16 a[14:15], v43 offset:25600
    v_mfma_f32_16x16x32_bf16 a[104:107], a[44:47], a[152:155], a[104:107]
    buffer_load_dwordx4 v41, s[12:15], s61 offen offset:3072 lds
    ds_read_b64_tr_b16 a[16:17], v44 offset:16384
    v_mfma_f32_16x16x32_bf16 a[104:107], a[40:43], a[136:139], a[104:107]
    v_mfma_f32_16x16x32_bf16 v[236:239], a[40:43], a[132:135], v[236:239]
    s_add_u32 s61, s61, 0x80000
    ds_read_b64_tr_b16 a[18:19], v44 offset:17408
    v_mfma_f32_16x16x32_bf16 v[236:239], a[44:47], a[148:151], v[236:239]
    buffer_load_dwordx4 a[208:211], v36, s[8:11], s62 offen sc1
    ds_read_b64_tr_b16 a[20:21], v44 offset:24576
    v_mfma_f32_16x16x32_bf16 v[232:235], a[44:47], a[144:147], v[232:235]
    ds_read_b64_tr_b16 a[22:23], v44 offset:25600
    v_mfma_f32_16x16x32_bf16 v[232:235], a[40:43], a[128:131], v[232:235]
    buffer_load_dwordx4 a[212:215], v54, s[8:11], s62 offen sc1
    v_mfma_f32_16x16x32_bf16 v[240:243], a[48:51], a[128:131], v[240:243]
    ds_read_b64_tr_b16 a[24:25], v45 offset:16384
    v_mfma_f32_16x16x32_bf16 v[240:243], a[52:55], a[144:147], v[240:243]
    ds_read_b64_tr_b16 a[26:27], v45 offset:17408
    v_mfma_f32_16x16x32_bf16 v[244:247], a[52:55], a[148:151], v[244:247]
    buffer_load_dwordx4 a[216:219], v37, s[8:11], s62 offen sc1
    ds_read_b64_tr_b16 a[28:29], v45 offset:24576
    v_mfma_f32_16x16x32_bf16 v[244:247], a[48:51], a[132:135], v[244:247]
    v_mfma_f32_16x16x32_bf16 a[112:115], a[48:51], a[136:139], a[112:115]
    ds_read_b64_tr_b16 a[30:31], v45 offset:25600
    v_mfma_f32_16x16x32_bf16 a[112:115], a[52:55], a[152:155], a[112:115]
    buffer_load_dwordx4 a[220:223], v55, s[8:11], s62 offen sc1
    v_mfma_f32_16x16x32_bf16 a[116:119], a[52:55], a[156:159], a[116:119]
    v_mfma_f32_16x16x32_bf16 a[116:119], a[48:51], a[140:143], a[116:119]
    s_add_u32 s62, s62, 0x20000
    v_mfma_f32_16x16x32_bf16 a[124:127], a[56:59], a[140:143], a[124:127]
    s_add_u32 s52, s47, 528384
    v_mfma_f32_16x16x32_bf16 a[124:127], a[60:63], a[156:159], a[124:127]
    buffer_store_dwordx4 v[156:159], v1, s[48:51], s52 offen offset:3072 sc1
    v_mfma_f32_16x16x32_bf16 a[120:123], a[60:63], a[152:155], a[120:123]
    v_mfma_f32_16x16x32_bf16 a[120:123], a[56:59], a[136:139], a[120:123]
    v_mfma_f32_16x16x32_bf16 v[252:255], a[56:59], a[132:135], v[252:255]
    v_mfma_f32_16x16x32_bf16 v[252:255], a[60:63], a[148:151], v[252:255]
    v_mfma_f32_16x16x32_bf16 v[248:251], a[60:63], a[144:147], v[248:251]
    v_mfma_f32_16x16x32_bf16 v[248:251], a[56:59], a[128:131], v[248:251]
    s_waitcnt vmcnt(15) lgkmcnt(0)
    v_mfma_f32_16x16x32_bf16 v[192:195], a[0:3], a[160:163], v[192:195]
    v_mfma_f32_16x16x32_bf16 v[192:195], a[4:7], a[176:179], v[192:195]
    buffer_load_dwordx4 a[224:227], v36, s[8:11], s62 offen sc1
    ds_read_b64_tr_b16 a[32:33], v46 offset:16384
    v_mfma_f32_16x16x32_bf16 v[196:199], a[4:7], a[180:183], v[196:199]
    ds_read_b64_tr_b16 a[34:35], v46 offset:17408
    v_mfma_f32_16x16x32_bf16 v[196:199], a[0:3], a[164:167], v[196:199]
    ds_read_b64_tr_b16 a[36:37], v46 offset:24576
    v_mfma_f32_16x16x32_bf16 a[64:67], a[0:3], a[168:171], a[64:67]
    ds_read_b64_tr_b16 a[38:39], v46 offset:25600
    v_mfma_f32_16x16x32_bf16 a[64:67], a[4:7], a[184:187], a[64:67]
    ds_read_b64_tr_b16 a[40:41], v47 offset:16384
    v_mfma_f32_16x16x32_bf16 a[68:71], a[4:7], a[188:191], a[68:71]
    buffer_load_dwordx4 a[228:231], v54, s[8:11], s62 offen sc1
    v_mfma_f32_16x16x32_bf16 a[68:71], a[0:3], a[172:175], a[68:71]
    ds_read_b64_tr_b16 a[42:43], v47 offset:17408
    v_mfma_f32_16x16x32_bf16 a[76:79], a[8:11], a[172:175], a[76:79]
    ds_read_b64_tr_b16 a[44:45], v47 offset:24576
    v_mfma_f32_16x16x32_bf16 a[76:79], a[12:15], a[188:191], a[76:79]
    ds_read_b64_tr_b16 a[46:47], v47 offset:25600
    v_mfma_f32_16x16x32_bf16 a[72:75], a[12:15], a[184:187], a[72:75]
    ds_read_b64_tr_b16 a[48:49], v48 offset:16384
    v_mfma_f32_16x16x32_bf16 a[72:75], a[8:11], a[168:171], a[72:75]
    buffer_load_dwordx4 a[232:235], v37, s[8:11], s62 offen sc1
    v_mfma_f32_16x16x32_bf16 v[204:207], a[8:11], a[164:167], v[204:207]
    ds_read_b64_tr_b16 a[50:51], v48 offset:17408
    v_mfma_f32_16x16x32_bf16 v[204:207], a[12:15], a[180:183], v[204:207]
    ds_read_b64_tr_b16 a[52:53], v48 offset:24576
    v_mfma_f32_16x16x32_bf16 v[200:203], a[12:15], a[176:179], v[200:203]
    ds_read_b64_tr_b16 a[54:55], v48 offset:25600
    v_mfma_f32_16x16x32_bf16 v[200:203], a[8:11], a[160:163], v[200:203]
    v_mfma_f32_16x16x32_bf16 v[208:211], a[16:19], a[160:163], v[208:211]
    ds_read_b64_tr_b16 a[56:57], v49 offset:16384
    v_mfma_f32_16x16x32_bf16 v[208:211], a[20:23], a[176:179], v[208:211]
    buffer_load_dwordx4 a[236:239], v55, s[8:11], s62 offen sc1
    ds_read_b64_tr_b16 a[58:59], v49 offset:17408
    v_mfma_f32_16x16x32_bf16 v[212:215], a[20:23], a[180:183], v[212:215]
    ds_read_b64_tr_b16 a[60:61], v49 offset:24576
    v_mfma_f32_16x16x32_bf16 v[212:215], a[16:19], a[164:167], v[212:215]
    v_mfma_f32_16x16x32_bf16 a[80:83], a[16:19], a[168:171], a[80:83]
    ds_read_b64_tr_b16 a[62:63], v49 offset:25600
    v_mfma_f32_16x16x32_bf16 a[80:83], a[20:23], a[184:187], a[80:83]
    s_add_u32 s62, s62, 0x20000
    v_mfma_f32_16x16x32_bf16 a[84:87], a[20:23], a[188:191], a[84:87]
    s_add_u32 s52, s47, 532480
    v_mfma_f32_16x16x32_bf16 a[84:87], a[16:19], a[172:175], a[84:87]
    buffer_store_dwordx4 v[168:171], v1, s[48:51], s52 offen offset:2048 sc1
    v_mfma_f32_16x16x32_bf16 a[92:95], a[24:27], a[172:175], a[92:95]
    v_mfma_f32_16x16x32_bf16 a[92:95], a[28:31], a[188:191], a[92:95]
    v_mfma_f32_16x16x32_bf16 a[88:91], a[28:31], a[184:187], a[88:91]
    v_mfma_f32_16x16x32_bf16 a[88:91], a[24:27], a[168:171], a[88:91]
    v_mfma_f32_16x16x32_bf16 v[220:223], a[24:27], a[164:167], v[220:223]
    v_mfma_f32_16x16x32_bf16 v[220:223], a[28:31], a[180:183], v[220:223]
    v_mfma_f32_16x16x32_bf16 v[216:219], a[28:31], a[176:179], v[216:219]
    v_mfma_f32_16x16x32_bf16 v[216:219], a[24:27], a[160:163], v[216:219]
    s_waitcnt vmcnt(10) lgkmcnt(0)
    s_barrier
    v_mfma_f32_16x16x32_bf16 v[224:227], a[32:35], a[160:163], v[224:227]
    s_cmp_eq_u32 s56, 0
    s_cbranch_scc1 k12_ool_66
k12_oolret_67:
    v_mfma_f32_16x16x32_bf16 v[224:227], a[36:39], a[176:179], v[224:227]
    s_add_u32 m0, s60, 147456
    ds_read_b64_tr_b16 a[0:1], v42 offset:32768
    ds_read_b64_tr_b16 a[2:3], v42 offset:33792
    v_mfma_f32_16x16x32_bf16 v[228:231], a[36:39], a[180:183], v[228:231]
    buffer_load_dwordx4 v38, s[12:15], s61 offen offset:0 lds
    v_mfma_f32_16x16x32_bf16 v[228:231], a[32:35], a[164:167], v[228:231]
    ds_read_b64_tr_b16 a[4:5], v42 offset:40960
    v_mfma_f32_16x16x32_bf16 a[96:99], a[32:35], a[168:171], a[96:99]
    buffer_load_dwordx4 v39, s[12:15], s61 offen offset:1024 lds
    ds_read_b64_tr_b16 a[6:7], v42 offset:41984
    v_mfma_f32_16x16x32_bf16 a[96:99], a[36:39], a[184:187], a[96:99]
    ds_read_b64_tr_b16 a[8:9], v43 offset:32768
    v_mfma_f32_16x16x32_bf16 a[100:103], a[36:39], a[188:191], a[100:103]
    v_mfma_f32_16x16x32_bf16 a[100:103], a[32:35], a[172:175], a[100:103]
    buffer_load_dwordx4 v40, s[12:15], s61 offen offset:2048 lds
    ds_read_b64_tr_b16 a[10:11], v43 offset:33792
    v_mfma_f32_16x16x32_bf16 a[108:111], a[40:43], a[172:175], a[108:111]
    s_mov_b32 s32, s60
    ds_read_b64_tr_b16 a[12:13], v43 offset:40960
    v_mfma_f32_16x16x32_bf16 a[108:111], a[44:47], a[188:191], a[108:111]
    ds_read_b64_tr_b16 a[14:15], v43 offset:41984
    v_mfma_f32_16x16x32_bf16 a[104:107], a[44:47], a[184:187], a[104:107]
    s_mov_b32 s34, s60
    ds_read_b64_tr_b16 a[16:17], v44 offset:32768
    v_mfma_f32_16x16x32_bf16 a[104:107], a[40:43], a[168:171], a[104:107]
    buffer_load_dwordx4 v41, s[12:15], s61 offen offset:3072 lds
    v_mfma_f32_16x16x32_bf16 v[236:239], a[40:43], a[164:167], v[236:239]
    ds_read_b64_tr_b16 a[18:19], v44 offset:33792
    v_mfma_f32_16x16x32_bf16 v[236:239], a[44:47], a[180:183], v[236:239]
    s_mov_b32 s33, s60
    ds_read_b64_tr_b16 a[20:21], v44 offset:40960
    v_mfma_f32_16x16x32_bf16 v[232:235], a[44:47], a[176:179], v[232:235]
    s_add_u32 s61, s61, 0x80000
    buffer_load_dwordx4 a[240:243], v36, s[8:11], s62 offen sc1
    ds_read_b64_tr_b16 a[22:23], v44 offset:41984
    v_mfma_f32_16x16x32_bf16 v[232:235], a[40:43], a[160:163], v[232:235]
    v_mfma_f32_16x16x32_bf16 v[240:243], a[48:51], a[160:163], v[240:243]
    s_add_u32 s35, s60, 0x10000
    ds_read_b64_tr_b16 a[24:25], v45 offset:32768
    v_mfma_f32_16x16x32_bf16 v[240:243], a[52:55], a[176:179], v[240:243]
    buffer_load_dwordx4 a[244:247], v54, s[8:11], s62 offen sc1
    ds_read_b64_tr_b16 a[26:27], v45 offset:33792
    v_mfma_f32_16x16x32_bf16 v[244:247], a[52:55], a[180:183], v[244:247]
    ds_read_b64_tr_b16 a[28:29], v45 offset:40960
    v_mfma_f32_16x16x32_bf16 v[244:247], a[48:51], a[164:167], v[244:247]
    v_mfma_f32_16x16x32_bf16 a[112:115], a[48:51], a[168:171], a[112:115]
    buffer_load_dwordx4 a[248:251], v37, s[8:11], s62 offen sc1
    ds_read_b64_tr_b16 a[30:31], v45 offset:41984
    v_mfma_f32_16x16x32_bf16 a[112:115], a[52:55], a[184:187], a[112:115]
    v_mfma_f32_16x16x32_bf16 a[116:119], a[52:55], a[188:191], a[116:119]
    v_mfma_f32_16x16x32_bf16 a[116:119], a[48:51], a[172:175], a[116:119]
    v_mfma_f32_16x16x32_bf16 a[124:127], a[56:59], a[172:175], a[124:127]
    buffer_load_dwordx4 a[252:255], v55, s[8:11], s62 offen sc1
    v_mfma_f32_16x16x32_bf16 a[124:127], a[60:63], a[188:191], a[124:127]
    v_mfma_f32_16x16x32_bf16 a[120:123], a[60:63], a[184:187], a[120:123]
    s_add_u32 s62, s62, 0x20000
    v_mfma_f32_16x16x32_bf16 a[120:123], a[56:59], a[168:171], a[120:123]
    v_mfma_f32_16x16x32_bf16 v[252:255], a[56:59], a[164:167], v[252:255]
    v_mfma_f32_16x16x32_bf16 v[252:255], a[60:63], a[180:183], v[252:255]
    v_mfma_f32_16x16x32_bf16 v[248:251], a[60:63], a[176:179], v[248:251]
    v_mfma_f32_16x16x32_bf16 v[248:251], a[56:59], a[160:163], v[248:251]
    s_waitcnt vmcnt(14) lgkmcnt(0)
    v_mfma_f32_16x16x32_bf16 v[192:195], a[0:3], a[192:195], v[192:195]
    v_mfma_f32_16x16x32_bf16 v[192:195], a[4:7], a[208:211], v[192:195]
    buffer_load_dwordx4 a[128:131], v36, s[8:11], s62 offen sc1
    ds_read_b64_tr_b16 a[32:33], v46 offset:32768
    v_mfma_f32_16x16x32_bf16 v[196:199], a[4:7], a[212:215], v[196:199]
    ds_read_b64_tr_b16 a[34:35], v46 offset:33792
    v_mfma_f32_16x16x32_bf16 v[196:199], a[0:3], a[196:199], v[196:199]
    ds_read_b64_tr_b16 a[36:37], v46 offset:40960
    v_mfma_f32_16x16x32_bf16 a[64:67], a[0:3], a[200:203], a[64:67]
    ds_read_b64_tr_b16 a[38:39], v46 offset:41984
    v_mfma_f32_16x16x32_bf16 a[64:67], a[4:7], a[216:219], a[64:67]
    ds_read_b64_tr_b16 a[40:41], v47 offset:32768
    v_mfma_f32_16x16x32_bf16 a[68:71], a[4:7], a[220:223], a[68:71]
    buffer_load_dwordx4 a[132:135], v54, s[8:11], s62 offen sc1
    v_mfma_f32_16x16x32_bf16 a[68:71], a[0:3], a[204:207], a[68:71]
    ds_read_b64_tr_b16 a[42:43], v47 offset:33792
    v_mfma_f32_16x16x32_bf16 a[76:79], a[8:11], a[204:207], a[76:79]
    ds_read_b64_tr_b16 a[44:45], v47 offset:40960
    v_mfma_f32_16x16x32_bf16 a[76:79], a[12:15], a[220:223], a[76:79]
    ds_read_b64_tr_b16 a[46:47], v47 offset:41984
    v_mfma_f32_16x16x32_bf16 a[72:75], a[12:15], a[216:219], a[72:75]
    ds_read_b64_tr_b16 a[48:49], v48 offset:32768
    v_mfma_f32_16x16x32_bf16 a[72:75], a[8:11], a[200:203], a[72:75]
    buffer_load_dwordx4 a[136:139], v37, s[8:11], s62 offen sc1
    v_mfma_f32_16x16x32_bf16 v[204:207], a[8:11], a[196:199], v[204:207]
    ds_read_b64_tr_b16 a[50:51], v48 offset:33792
    v_mfma_f32_16x16x32_bf16 v[204:207], a[12:15], a[212:215], v[204:207]
    ds_read_b64_tr_b16 a[52:53], v48 offset:40960
    v_mfma_f32_16x16x32_bf16 v[200:203], a[12:15], a[208:211], v[200:203]
    ds_read_b64_tr_b16 a[54:55], v48 offset:41984
    v_mfma_f32_16x16x32_bf16 v[200:203], a[8:11], a[192:195], v[200:203]
    v_mfma_f32_16x16x32_bf16 v[208:211], a[16:19], a[192:195], v[208:211]
    ds_read_b64_tr_b16 a[56:57], v49 offset:32768
    v_mfma_f32_16x16x32_bf16 v[208:211], a[20:23], a[208:211], v[208:211]
    buffer_load_dwordx4 a[140:143], v55, s[8:11], s62 offen sc1
    ds_read_b64_tr_b16 a[58:59], v49 offset:33792
    v_mfma_f32_16x16x32_bf16 v[212:215], a[20:23], a[212:215], v[212:215]
    ds_read_b64_tr_b16 a[60:61], v49 offset:40960
    v_mfma_f32_16x16x32_bf16 v[212:215], a[16:19], a[196:199], v[212:215]
    v_mfma_f32_16x16x32_bf16 a[80:83], a[16:19], a[200:203], a[80:83]
    ds_read_b64_tr_b16 a[62:63], v49 offset:41984
    v_mfma_f32_16x16x32_bf16 a[80:83], a[20:23], a[216:219], a[80:83]
    s_add_u32 s62, s62, 0x20000
    v_mfma_f32_16x16x32_bf16 a[84:87], a[20:23], a[220:223], a[84:87]
    s_add_u32 s52, s47, 532480
    v_mfma_f32_16x16x32_bf16 a[84:87], a[16:19], a[204:207], a[84:87]
    buffer_store_dwordx4 v[172:175], v1, s[48:51], s52 offen offset:3072 sc1
    v_mfma_f32_16x16x32_bf16 a[92:95], a[24:27], a[204:207], a[92:95]
    v_mfma_f32_16x16x32_bf16 a[92:95], a[28:31], a[220:223], a[92:95]
    v_mfma_f32_16x16x32_bf16 a[88:91], a[28:31], a[216:219], a[88:91]
    v_mfma_f32_16x16x32_bf16 a[88:91], a[24:27], a[200:203], a[88:91]
    v_mfma_f32_16x16x32_bf16 v[220:223], a[24:27], a[196:199], v[220:223]
    v_add_co_u32 v2, vcc, 0x4000, v2
    s_nop 1
    v_addc_co_u32 v3, vcc, 0, v3, vcc
    global_load_dword v51, v[2:3], off
    v_mfma_f32_16x16x32_bf16 v[220:223], a[28:31], a[212:215], v[220:223]
    v_mfma_f32_16x16x32_bf16 v[216:219], a[28:31], a[208:211], v[216:219]
    v_mfma_f32_16x16x32_bf16 v[216:219], a[24:27], a[192:195], v[216:219]
    s_waitcnt vmcnt(9) lgkmcnt(0)
    s_barrier
    v_mfma_f32_16x16x32_bf16 v[224:227], a[32:35], a[192:195], v[224:227]
    v_mfma_f32_16x16x32_bf16 v[224:227], a[36:39], a[208:211], v[224:227]
    s_add_u32 m0, s60, 98304
    ds_read_b64_tr_b16 a[0:1], v42 offset:49152
    ds_read_b64_tr_b16 a[2:3], v42 offset:50176
    v_mfma_f32_16x16x32_bf16 v[228:231], a[36:39], a[212:215], v[228:231]
    buffer_load_dwordx4 v38, s[12:15], s61 offen offset:0 lds
    v_mfma_f32_16x16x32_bf16 v[228:231], a[32:35], a[196:199], v[228:231]
    ds_read_b64_tr_b16 a[4:5], v42 offset:57344
    v_mfma_f32_16x16x32_bf16 a[96:99], a[32:35], a[200:203], a[96:99]
    buffer_load_dwordx4 v39, s[12:15], s61 offen offset:1024 lds
    ds_read_b64_tr_b16 a[6:7], v42 offset:58368
    v_mfma_f32_16x16x32_bf16 a[96:99], a[36:39], a[216:219], a[96:99]
    ds_read_b64_tr_b16 a[8:9], v43 offset:49152
    v_mfma_f32_16x16x32_bf16 a[100:103], a[36:39], a[220:223], a[100:103]
    v_mfma_f32_16x16x32_bf16 a[100:103], a[32:35], a[204:207], a[100:103]
    buffer_load_dwordx4 v40, s[12:15], s61 offen offset:2048 lds
    ds_read_b64_tr_b16 a[10:11], v43 offset:50176
    v_mfma_f32_16x16x32_bf16 a[108:111], a[40:43], a[204:207], a[108:111]
    ds_read_b64_tr_b16 a[12:13], v43 offset:57344
    v_mfma_f32_16x16x32_bf16 a[108:111], a[44:47], a[220:223], a[108:111]
    ds_read_b64_tr_b16 a[14:15], v43 offset:58368
    v_mfma_f32_16x16x32_bf16 a[104:107], a[44:47], a[216:219], a[104:107]
    buffer_load_dwordx4 v41, s[12:15], s61 offen offset:3072 lds
    ds_read_b64_tr_b16 a[16:17], v44 offset:49152
    v_mfma_f32_16x16x32_bf16 a[104:107], a[40:43], a[200:203], a[104:107]
    v_mfma_f32_16x16x32_bf16 v[236:239], a[40:43], a[196:199], v[236:239]
    s_add_u32 s61, s61, 0x80000
    ds_read_b64_tr_b16 a[18:19], v44 offset:50176
    v_mfma_f32_16x16x32_bf16 v[236:239], a[44:47], a[212:215], v[236:239]
    buffer_load_dwordx4 a[144:147], v36, s[8:11], s62 offen sc1
    ds_read_b64_tr_b16 a[20:21], v44 offset:57344
    v_mfma_f32_16x16x32_bf16 v[232:235], a[44:47], a[208:211], v[232:235]
    ds_read_b64_tr_b16 a[22:23], v44 offset:58368
    v_mfma_f32_16x16x32_bf16 v[232:235], a[40:43], a[192:195], v[232:235]
    buffer_load_dwordx4 a[148:151], v54, s[8:11], s62 offen sc1
    v_mfma_f32_16x16x32_bf16 v[240:243], a[48:51], a[192:195], v[240:243]
    ds_read_b64_tr_b16 a[24:25], v45 offset:49152
    v_mfma_f32_16x16x32_bf16 v[240:243], a[52:55], a[208:211], v[240:243]
    ds_read_b64_tr_b16 a[26:27], v45 offset:50176
    v_mfma_f32_16x16x32_bf16 v[244:247], a[52:55], a[212:215], v[244:247]
    buffer_load_dwordx4 a[152:155], v37, s[8:11], s62 offen sc1
    ds_read_b64_tr_b16 a[28:29], v45 offset:57344
    v_mfma_f32_16x16x32_bf16 v[244:247], a[48:51], a[196:199], v[244:247]
    v_mfma_f32_16x16x32_bf16 a[112:115], a[48:51], a[200:203], a[112:115]
    ds_read_b64_tr_b16 a[30:31], v45 offset:58368
    v_mfma_f32_16x16x32_bf16 a[112:115], a[52:55], a[216:219], a[112:115]
    buffer_load_dwordx4 a[156:159], v55, s[8:11], s62 offen sc1
    v_mfma_f32_16x16x32_bf16 a[116:119], a[52:55], a[220:223], a[116:119]
    v_mfma_f32_16x16x32_bf16 a[116:119], a[48:51], a[204:207], a[116:119]
    s_add_u32 s62, s62, 0x20000
    v_mfma_f32_16x16x32_bf16 a[124:127], a[56:59], a[204:207], a[124:127]
    s_add_u32 s52, s47, 536576
    v_mfma_f32_16x16x32_bf16 a[124:127], a[60:63], a[220:223], a[124:127]
    buffer_store_dwordx4 v[176:179], v1, s[48:51], s52 offen offset:0 sc1
    v_mfma_f32_16x16x32_bf16 a[120:123], a[60:63], a[216:219], a[120:123]
    v_mfma_f32_16x16x32_bf16 a[120:123], a[56:59], a[200:203], a[120:123]
    v_mfma_f32_16x16x32_bf16 v[252:255], a[56:59], a[196:199], v[252:255]
    v_mfma_f32_16x16x32_bf16 v[252:255], a[60:63], a[212:215], v[252:255]
    v_mfma_f32_16x16x32_bf16 v[248:251], a[60:63], a[208:211], v[248:251]
    v_mfma_f32_16x16x32_bf16 v[248:251], a[56:59], a[192:195], v[248:251]
    s_waitcnt vmcnt(14) lgkmcnt(0)
    v_mfma_f32_16x16x32_bf16 v[192:195], a[0:3], a[224:227], v[192:195]
    v_mfma_f32_16x16x32_bf16 v[192:195], a[4:7], a[240:243], v[192:195]
    buffer_load_dwordx4 a[160:163], v36, s[8:11], s62 offen sc1
    ds_read_b64_tr_b16 a[32:33], v46 offset:49152
    v_mfma_f32_16x16x32_bf16 v[196:199], a[4:7], a[244:247], v[196:199]
    ds_read_b64_tr_b16 a[34:35], v46 offset:50176
    v_mfma_f32_16x16x32_bf16 v[196:199], a[0:3], a[228:231], v[196:199]
    ds_read_b64_tr_b16 a[36:37], v46 offset:57344
    v_mfma_f32_16x16x32_bf16 a[64:67], a[0:3], a[232:235], a[64:67]
    ds_read_b64_tr_b16 a[38:39], v46 offset:58368
    v_mfma_f32_16x16x32_bf16 a[64:67], a[4:7], a[248:251], a[64:67]
    ds_read_b64_tr_b16 a[40:41], v47 offset:49152
    v_mfma_f32_16x16x32_bf16 a[68:71], a[4:7], a[252:255], a[68:71]
    buffer_load_dwordx4 a[164:167], v54, s[8:11], s62 offen sc1
    v_mfma_f32_16x16x32_bf16 a[68:71], a[0:3], a[236:239], a[68:71]
    ds_read_b64_tr_b16 a[42:43], v47 offset:50176
    v_mfma_f32_16x16x32_bf16 a[76:79], a[8:11], a[236:239], a[76:79]
    ds_read_b64_tr_b16 a[44:45], v47 offset:57344
    v_mfma_f32_16x16x32_bf16 a[76:79], a[12:15], a[252:255], a[76:79]
    ds_read_b64_tr_b16 a[46:47], v47 offset:58368
    v_mfma_f32_16x16x32_bf16 a[72:75], a[12:15], a[248:251], a[72:75]
    ds_read_b64_tr_b16 a[48:49], v48 offset:49152
    v_mfma_f32_16x16x32_bf16 a[72:75], a[8:11], a[232:235], a[72:75]
    buffer_load_dwordx4 a[168:171], v37, s[8:11], s62 offen sc1
    v_mfma_f32_16x16x32_bf16 v[204:207], a[8:11], a[228:231], v[204:207]
    ds_read_b64_tr_b16 a[50:51], v48 offset:50176
    v_mfma_f32_16x16x32_bf16 v[204:207], a[12:15], a[244:247], v[204:207]
    ds_read_b64_tr_b16 a[52:53], v48 offset:57344
    v_mfma_f32_16x16x32_bf16 v[200:203], a[12:15], a[240:243], v[200:203]
    ds_read_b64_tr_b16 a[54:55], v48 offset:58368
    v_mfma_f32_16x16x32_bf16 v[200:203], a[8:11], a[224:227], v[200:203]
    v_mfma_f32_16x16x32_bf16 v[208:211], a[16:19], a[224:227], v[208:211]
    ds_read_b64_tr_b16 a[56:57], v49 offset:49152
    v_mfma_f32_16x16x32_bf16 v[208:211], a[20:23], a[240:243], v[208:211]
    buffer_load_dwordx4 a[172:175], v55, s[8:11], s62 offen sc1
    ds_read_b64_tr_b16 a[58:59], v49 offset:50176
    v_mfma_f32_16x16x32_bf16 v[212:215], a[20:23], a[244:247], v[212:215]
    ds_read_b64_tr_b16 a[60:61], v49 offset:57344
    v_mfma_f32_16x16x32_bf16 v[212:215], a[16:19], a[228:231], v[212:215]
    v_mfma_f32_16x16x32_bf16 a[80:83], a[16:19], a[232:235], a[80:83]
    ds_read_b64_tr_b16 a[62:63], v49 offset:58368
    v_mfma_f32_16x16x32_bf16 a[80:83], a[20:23], a[248:251], a[80:83]
    s_add_u32 s62, s62, 0x20000
    v_mfma_f32_16x16x32_bf16 a[84:87], a[20:23], a[252:255], a[84:87]
    s_add_u32 s52, s47, 536576
    v_mfma_f32_16x16x32_bf16 a[84:87], a[16:19], a[236:239], a[84:87]
    buffer_store_dwordx4 v[180:183], v1, s[48:51], s52 offen offset:1024 sc1
    v_mfma_f32_16x16x32_bf16 a[92:95], a[24:27], a[236:239], a[92:95]
    v_mfma_f32_16x16x32_bf16 a[92:95], a[28:31], a[252:255], a[92:95]
    v_mfma_f32_16x16x32_bf16 a[88:91], a[28:31], a[248:251], a[88:91]
    v_mfma_f32_16x16x32_bf16 a[88:91], a[24:27], a[232:235], a[88:91]
    v_mfma_f32_16x16x32_bf16 v[220:223], a[24:27], a[228:231], v[220:223]
    v_mfma_f32_16x16x32_bf16 v[220:223], a[28:31], a[244:247], v[220:223]
    v_mfma_f32_16x16x32_bf16 v[216:219], a[28:31], a[240:243], v[216:219]
    v_mfma_f32_16x16x32_bf16 v[216:219], a[24:27], a[224:227], v[216:219]
    s_waitcnt vmcnt(10) lgkmcnt(0)
    s_barrier
    v_mfma_f32_16x16x32_bf16 v[224:227], a[32:35], a[224:227], v[224:227]
    s_cmp_eq_u32 s30, 0
    s_cbranch_scc1 k12_ool_68
k12_oolret_69:
    v_mfma_f32_16x16x32_bf16 v[224:227], a[36:39], a[240:243], v[224:227]
    s_add_u32 m0, s60, 114688
    ds_read_b64_tr_b16 a[0:1], v42 offset:0
    ds_read_b64_tr_b16 a[2:3], v42 offset:1024
    v_mfma_f32_16x16x32_bf16 v[228:231], a[36:39], a[244:247], v[228:231]
    buffer_load_dwordx4 v38, s[12:15], s61 offen offset:0 lds
    v_mfma_f32_16x16x32_bf16 v[228:231], a[32:35], a[228:231], v[228:231]
    ds_read_b64_tr_b16 a[4:5], v42 offset:8192
    v_mfma_f32_16x16x32_bf16 a[96:99], a[32:35], a[232:235], a[96:99]
    buffer_load_dwordx4 v39, s[12:15], s61 offen offset:1024 lds
    ds_read_b64_tr_b16 a[6:7], v42 offset:9216
    v_mfma_f32_16x16x32_bf16 a[96:99], a[36:39], a[248:251], a[96:99]
    ds_read_b64_tr_b16 a[8:9], v43 offset:0
    v_mfma_f32_16x16x32_bf16 a[100:103], a[36:39], a[252:255], a[100:103]
    v_mfma_f32_16x16x32_bf16 a[100:103], a[32:35], a[236:239], a[100:103]
    buffer_load_dwordx4 v40, s[12:15], s61 offen offset:2048 lds
    ds_read_b64_tr_b16 a[10:11], v43 offset:1024
    v_mfma_f32_16x16x32_bf16 a[108:111], a[40:43], a[236:239], a[108:111]
    ds_read_b64_tr_b16 a[12:13], v43 offset:8192
    v_mfma_f32_16x16x32_bf16 a[108:111], a[44:47], a[252:255], a[108:111]
    ds_read_b64_tr_b16 a[14:15], v43 offset:9216
    v_mfma_f32_16x16x32_bf16 a[104:107], a[44:47], a[248:251], a[104:107]
    buffer_load_dwordx4 v41, s[12:15], s61 offen offset:3072 lds
    ds_read_b64_tr_b16 a[16:17], v44 offset:0
    v_mfma_f32_16x16x32_bf16 a[104:107], a[40:43], a[232:235], a[104:107]
    v_mfma_f32_16x16x32_bf16 v[236:239], a[40:43], a[228:231], v[236:239]
    s_add_u32 s61, s61, 0x80000
    ds_read_b64_tr_b16 a[18:19], v44 offset:1024
    v_mfma_f32_16x16x32_bf16 v[236:239], a[44:47], a[244:247], v[236:239]
    buffer_load_dwordx4 a[176:179], v36, s[8:11], s62 offen sc1
    ds_read_b64_tr_b16 a[20:21], v44 offset:8192
    v_mfma_f32_16x16x32_bf16 v[232:235], a[44:47], a[240:243], v[232:235]
    ds_read_b64_tr_b16 a[22:23], v44 offset:9216
    v_mfma_f32_16x16x32_bf16 v[232:235], a[40:43], a[224:227], v[232:235]
    buffer_load_dwordx4 a[180:183], v54, s[8:11], s62 offen sc1
    v_mfma_f32_16x16x32_bf16 v[240:243], a[48:51], a[224:227], v[240:243]
    ds_read_b64_tr_b16 a[24:25], v45 offset:0
    v_mfma_f32_16x16x32_bf16 v[240:243], a[52:55], a[240:243], v[240:243]
    ds_read_b64_tr_b16 a[26:27], v45 offset:1024
    v_mfma_f32_16x16x32_bf16 v[244:247], a[52:55], a[244:247], v[244:247]
    buffer_load_dwordx4 a[184:187], v37, s[8:11], s62 offen sc1
    ds_read_b64_tr_b16 a[28:29], v45 offset:8192
    v_mfma_f32_16x16x32_bf16 v[244:247], a[48:51], a[228:231], v[244:247]
    v_mfma_f32_16x16x32_bf16 a[112:115], a[48:51], a[232:235], a[112:115]
    ds_read_b64_tr_b16 a[30:31], v45 offset:9216
    v_mfma_f32_16x16x32_bf16 a[112:115], a[52:55], a[248:251], a[112:115]
    buffer_load_dwordx4 a[188:191], v55, s[8:11], s62 offen sc1
    v_mfma_f32_16x16x32_bf16 a[116:119], a[52:55], a[252:255], a[116:119]
    v_mfma_f32_16x16x32_bf16 a[116:119], a[48:51], a[236:239], a[116:119]
    s_add_u32 s62, s62, 0x20000
    v_mfma_f32_16x16x32_bf16 a[124:127], a[56:59], a[236:239], a[124:127]
    s_add_u32 s52, s47, 536576
    v_mfma_f32_16x16x32_bf16 a[124:127], a[60:63], a[252:255], a[124:127]
    buffer_store_dwordx4 v[184:187], v1, s[48:51], s52 offen offset:2048 sc1
    v_mfma_f32_16x16x32_bf16 a[120:123], a[60:63], a[248:251], a[120:123]
    v_mfma_f32_16x16x32_bf16 a[120:123], a[56:59], a[232:235], a[120:123]
    v_mfma_f32_16x16x32_bf16 v[252:255], a[56:59], a[228:231], v[252:255]
    v_mfma_f32_16x16x32_bf16 v[252:255], a[60:63], a[244:247], v[252:255]
    v_mfma_f32_16x16x32_bf16 v[248:251], a[60:63], a[240:243], v[248:251]
    v_mfma_f32_16x16x32_bf16 v[248:251], a[56:59], a[224:227], v[248:251]
    s_waitcnt vmcnt(15) lgkmcnt(0)
    v_mfma_f32_16x16x32_bf16 v[192:195], a[0:3], a[128:131], v[192:195]
    v_mfma_f32_16x16x32_bf16 v[192:195], a[4:7], a[144:147], v[192:195]
    s_add_u32 s52, s47, 536576
    ds_read_b64_tr_b16 a[32:33], v46 offset:0
    ds_read_b64_tr_b16 a[34:35], v46 offset:1024
    v_mfma_f32_16x16x32_bf16 v[196:199], a[4:7], a[148:151], v[196:199]
    buffer_store_dwordx4 v[188:191], v1, s[48:51], s52 offen offset:3072 sc1
    v_mfma_f32_16x16x32_bf16 v[196:199], a[0:3], a[132:135], v[196:199]
    ds_read_b64_tr_b16 a[36:37], v46 offset:8192
    v_mfma_f32_16x16x32_bf16 a[64:67], a[0:3], a[136:139], a[64:67]
    ds_read_b64_tr_b16 a[38:39], v46 offset:9216
    v_mfma_f32_16x16x32_bf16 a[64:67], a[4:7], a[152:155], a[64:67]
    ds_read_b64_tr_b16 a[40:41], v47 offset:0
    v_mfma_f32_16x16x32_bf16 a[68:71], a[4:7], a[156:159], a[68:71]
    v_mfma_f32_16x16x32_bf16 a[68:71], a[0:3], a[140:143], a[68:71]
    ds_read_b64_tr_b16 a[42:43], v47 offset:1024
    v_mfma_f32_16x16x32_bf16 a[76:79], a[8:11], a[140:143], a[76:79]
    ds_read_b64_tr_b16 a[44:45], v47 offset:8192
    v_mfma_f32_16x16x32_bf16 a[76:79], a[12:15], a[156:159], a[76:79]
    ds_read_b64_tr_b16 a[46:47], v47 offset:9216
    v_mfma_f32_16x16x32_bf16 a[72:75], a[12:15], a[152:155], a[72:75]
    ds_read_b64_tr_b16 a[48:49], v48 offset:0
    v_mfma_f32_16x16x32_bf16 a[72:75], a[8:11], a[136:139], a[72:75]
    v_mfma_f32_16x16x32_bf16 v[204:207], a[8:11], a[132:135], v[204:207]
    ds_read_b64_tr_b16 a[50:51], v48 offset:1024
    v_mfma_f32_16x16x32_bf16 v[204:207], a[12:15], a[148:151], v[204:207]
    ds_read_b64_tr_b16 a[52:53], v48 offset:8192
    v_mfma_f32_16x16x32_bf16 v[200:203], a[12:15], a[144:147], v[200:203]
    ds_read_b64_tr_b16 a[54:55], v48 offset:9216
    v_mfma_f32_16x16x32_bf16 v[200:203], a[8:11], a[128:131], v[200:203]
    v_mfma_f32_16x16x32_bf16 v[208:211], a[16:19], a[128:131], v[208:211]
    ds_read_b64_tr_b16 a[56:57], v49 offset:0
    v_mfma_f32_16x16x32_bf16 v[208:211], a[20:23], a[144:147], v[208:211]
    ds_read_b64_tr_b16 a[58:59], v49 offset:1024
    v_mfma_f32_16x16x32_bf16 v[212:215], a[20:23], a[148:151], v[212:215]
    ds_read_b64_tr_b16 a[60:61], v49 offset:8192
    v_mfma_f32_16x16x32_bf16 v[212:215], a[16:19], a[132:135], v[212:215]
    v_mfma_f32_16x16x32_bf16 a[80:83], a[16:19], a[136:139], a[80:83]
    ds_read_b64_tr_b16 a[62:63], v49 offset:9216
    v_mfma_f32_16x16x32_bf16 a[80:83], a[20:23], a[152:155], a[80:83]
    v_mfma_f32_16x16x32_bf16 a[84:87], a[20:23], a[156:159], a[84:87]
    v_mfma_f32_16x16x32_bf16 a[84:87], a[16:19], a[140:143], a[84:87]
    v_mfma_f32_16x16x32_bf16 a[92:95], a[24:27], a[140:143], a[92:95]
    v_mfma_f32_16x16x32_bf16 a[92:95], a[28:31], a[156:159], a[92:95]
    v_mfma_f32_16x16x32_bf16 a[88:91], a[28:31], a[152:155], a[88:91]
    v_mfma_f32_16x16x32_bf16 a[88:91], a[24:27], a[136:139], a[88:91]
    v_mfma_f32_16x16x32_bf16 v[220:223], a[24:27], a[132:135], v[220:223]
    s_cmp_eq_u32 s30, 0
    s_cbranch_scc1 k12_ool_72
k12_oolret_73:
    v_mfma_f32_16x16x32_bf16 v[220:223], a[28:31], a[148:151], v[220:223]
    v_mfma_f32_16x16x32_bf16 v[216:219], a[28:31], a[144:147], v[216:219]
    v_mfma_f32_16x16x32_bf16 v[216:219], a[24:27], a[128:131], v[216:219]
    s_waitcnt vmcnt(6) lgkmcnt(0)
    s_barrier
    v_mfma_f32_16x16x32_bf16 v[224:227], a[32:35], a[128:131], v[224:227]
    v_mfma_f32_16x16x32_bf16 v[224:227], a[36:39], a[144:147], v[224:227]
    s_mov_b32 m0, s34
    ds_read_b64_tr_b16 a[0:1], v42 offset:16384
    ds_read_b64_tr_b16 a[2:3], v42 offset:17408
    v_mfma_f32_16x16x32_bf16 v[228:231], a[36:39], a[148:151], v[228:231]
    buffer_load_dwordx4 v1, s[16:19], s32 offen offset:0 sc1 lds
    v_mfma_f32_16x16x32_bf16 v[228:231], a[32:35], a[132:135], v[228:231]
    ds_read_b64_tr_b16 a[4:5], v42 offset:24576
    v_mfma_f32_16x16x32_bf16 a[96:99], a[32:35], a[136:139], a[96:99]
    buffer_load_dwordx4 v1, s[16:19], s32 offen offset:1024 sc1 lds
    ds_read_b64_tr_b16 a[6:7], v42 offset:25600
    v_mfma_f32_16x16x32_bf16 a[96:99], a[36:39], a[152:155], a[96:99]
    ds_read_b64_tr_b16 a[8:9], v43 offset:16384
    v_mfma_f32_16x16x32_bf16 a[100:103], a[36:39], a[156:159], a[100:103]
    v_mfma_f32_16x16x32_bf16 a[100:103], a[32:35], a[140:143], a[100:103]
    buffer_load_dwordx4 v1, s[16:19], s32 offen offset:2048 sc1 lds
    ds_read_b64_tr_b16 a[10:11], v43 offset:17408
    v_mfma_f32_16x16x32_bf16 a[108:111], a[40:43], a[140:143], a[108:111]
    ds_read_b64_tr_b16 a[12:13], v43 offset:24576
    v_mfma_f32_16x16x32_bf16 a[108:111], a[44:47], a[156:159], a[108:111]
    ds_read_b64_tr_b16 a[14:15], v43 offset:25600
    v_mfma_f32_16x16x32_bf16 a[104:107], a[44:47], a[152:155], a[104:107]
    ds_read_b64_tr_b16 a[16:17], v44 offset:16384
    v_mfma_f32_16x16x32_bf16 a[104:107], a[40:43], a[136:139], a[104:107]
    buffer_load_dwordx4 v1, s[16:19], s32 offen offset:3072 sc1 lds
    v_mfma_f32_16x16x32_bf16 v[236:239], a[40:43], a[132:135], v[236:239]
    ds_read_b64_tr_b16 a[18:19], v44 offset:17408
    v_mfma_f32_16x16x32_bf16 v[236:239], a[44:47], a[148:151], v[236:239]
    s_add_u32 s32, s32, 0x80000
    ds_read_b64_tr_b16 a[20:21], v44 offset:24576
    v_mfma_f32_16x16x32_bf16 v[232:235], a[44:47], a[144:147], v[232:235]
    s_add_u32 s34, s34, 0x4000
    ds_read_b64_tr_b16 a[22:23], v44 offset:25600
    s_mov_b32 m0, s34
    v_mfma_f32_16x16x32_bf16 v[232:235], a[40:43], a[128:131], v[232:235]
    buffer_load_dwordx4 v1, s[16:19], s32 offen offset:0 sc1 lds
    v_mfma_f32_16x16x32_bf16 v[240:243], a[48:51], a[128:131], v[240:243]
    ds_read_b64_tr_b16 a[24:25], v45 offset:16384
    v_mfma_f32_16x16x32_bf16 v[240:243], a[52:55], a[144:147], v[240:243]
    buffer_load_dwordx4 v1, s[16:19], s32 offen offset:1024 sc1 lds
    ds_read_b64_tr_b16 a[26:27], v45 offset:17408
    v_mfma_f32_16x16x32_bf16 v[244:247], a[52:55], a[148:151], v[244:247]
    ds_read_b64_tr_b16 a[28:29], v45 offset:24576
    v_mfma_f32_16x16x32_bf16 v[244:247], a[48:51], a[132:135], v[244:247]
    v_mfma_f32_16x16x32_bf16 a[112:115], a[48:51], a[136:139], a[112:115]
    buffer_load_dwordx4 v1, s[16:19], s32 offen offset:2048 sc1 lds
    ds_read_b64_tr_b16 a[30:31], v45 offset:25600
    v_mfma_f32_16x16x32_bf16 a[112:115], a[52:55], a[152:155], a[112:115]
    v_mfma_f32_16x16x32_bf16 a[116:119], a[52:55], a[156:159], a[116:119]
    v_mfma_f32_16x16x32_bf16 a[116:119], a[48:51], a[140:143], a[116:119]
    v_mfma_f32_16x16x32_bf16 a[124:127], a[56:59], a[140:143], a[124:127]
    buffer_load_dwordx4 v1, s[16:19], s32 offen offset:3072 sc1 lds
    v_mfma_f32_16x16x32_bf16 a[124:127], a[60:63], a[156:159], a[124:127]
    v_mfma_f32_16x16x32_bf16 a[120:123], a[60:63], a[152:155], a[120:123]
    s_add_u32 s32, s32, 0x80000
    v_mfma_f32_16x16x32_bf16 a[120:123], a[56:59], a[136:139], a[120:123]
    s_add_u32 s34, s34, 0x4000
    v_mfma_f32_16x16x32_bf16 v[252:255], a[56:59], a[132:135], v[252:255]
    v_mfma_f32_16x16x32_bf16 v[252:255], a[60:63], a[148:151], v[252:255]
    v_mfma_f32_16x16x32_bf16 v[248:251], a[60:63], a[144:147], v[248:251]
    v_mfma_f32_16x16x32_bf16 v[248:251], a[56:59], a[128:131], v[248:251]
    s_waitcnt vmcnt(10) lgkmcnt(0)
    v_mfma_f32_16x16x32_bf16 v[192:195], a[0:3], a[160:163], v[192:195]
    v_mfma_f32_16x16x32_bf16 v[192:195], a[4:7], a[176:179], v[192:195]
    s_mov_b32 m0, s35
    ds_read_b64_tr_b16 a[32:33], v46 offset:16384
    ds_read_b64_tr_b16 a[34:35], v46 offset:17408
    v_mfma_f32_16x16x32_bf16 v[196:199], a[4:7], a[180:183], v[196:199]
    buffer_load_dwordx4 v1, s[20:23], s33 offen offset:0 sc1 lds
    v_mfma_f32_16x16x32_bf16 v[196:199], a[0:3], a[164:167], v[196:199]
    ds_read_b64_tr_b16 a[36:37], v46 offset:24576
    v_mfma_f32_16x16x32_bf16 a[64:67], a[0:3], a[168:171], a[64:67]
    buffer_load_dwordx4 v1, s[20:23], s33 offen offset:1024 sc1 lds
    ds_read_b64_tr_b16 a[38:39], v46 offset:25600
    v_mfma_f32_16x16x32_bf16 a[64:67], a[4:7], a[184:187], a[64:67]
    ds_read_b64_tr_b16 a[40:41], v47 offset:16384
    v_mfma_f32_16x16x32_bf16 a[68:71], a[4:7], a[188:191], a[68:71]
    v_mfma_f32_16x16x32_bf16 a[68:71], a[0:3], a[172:175], a[68:71]
    buffer_load_dwordx4 v1, s[20:23], s33 offen offset:2048 sc1 lds
    ds_read_b64_tr_b16 a[42:43], v47 offset:17408
    v_mfma_f32_16x16x32_bf16 a[76:79], a[8:11], a[172:175], a[76:79]
    ds_read_b64_tr_b16 a[44:45], v47 offset:24576
    v_mfma_f32_16x16x32_bf16 a[76:79], a[12:15], a[188:191], a[76:79]
    ds_read_b64_tr_b16 a[46:47], v47 offset:25600
    v_mfma_f32_16x16x32_bf16 a[72:75], a[12:15], a[184:187], a[72:75]
    ds_read_b64_tr_b16 a[48:49], v48 offset:16384
    v_mfma_f32_16x16x32_bf16 a[72:75], a[8:11], a[168:171], a[72:75]
    buffer_load_dwordx4 v1, s[20:23], s33 offen offset:3072 sc1 lds
    v_mfma_f32_16x16x32_bf16 v[204:207], a[8:11], a[164:167], v[204:207]
    ds_read_b64_tr_b16 a[50:51], v48 offset:17408
    v_mfma_f32_16x16x32_bf16 v[204:207], a[12:15], a[180:183], v[204:207]
    s_add_u32 s33, s33, 0x80000
    ds_read_b64_tr_b16 a[52:53], v48 offset:24576
    v_mfma_f32_16x16x32_bf16 v[200:203], a[12:15], a[176:179], v[200:203]
    s_add_u32 s35, s35, 0x4000
    ds_read_b64_tr_b16 a[54:55], v48 offset:25600
    s_mov_b32 m0, s34
    v_mfma_f32_16x16x32_bf16 v[200:203], a[8:11], a[160:163], v[200:203]
    buffer_load_dwordx4 v1, s[16:19], s32 offen offset:0 sc1 lds
    v_mfma_f32_16x16x32_bf16 v[208:211], a[16:19], a[160:163], v[208:211]
    ds_read_b64_tr_b16 a[56:57], v49 offset:16384
    v_mfma_f32_16x16x32_bf16 v[208:211], a[20:23], a[176:179], v[208:211]
    buffer_load_dwordx4 v1, s[16:19], s32 offen offset:1024 sc1 lds
    ds_read_b64_tr_b16 a[58:59], v49 offset:17408
    v_mfma_f32_16x16x32_bf16 v[212:215], a[20:23], a[180:183], v[212:215]
    ds_read_b64_tr_b16 a[60:61], v49 offset:24576
    v_mfma_f32_16x16x32_bf16 v[212:215], a[16:19], a[164:167], v[212:215]
    v_mfma_f32_16x16x32_bf16 a[80:83], a[16:19], a[168:171], a[80:83]
    buffer_load_dwordx4 v1, s[16:19], s32 offen offset:2048 sc1 lds
    ds_read_b64_tr_b16 a[62:63], v49 offset:25600
    v_mfma_f32_16x16x32_bf16 a[80:83], a[20:23], a[184:187], a[80:83]
    v_mfma_f32_16x16x32_bf16 a[84:87], a[20:23], a[188:191], a[84:87]
    v_mfma_f32_16x16x32_bf16 a[84:87], a[16:19], a[172:175], a[84:87]
    v_mfma_f32_16x16x32_bf16 a[92:95], a[24:27], a[172:175], a[92:95]
    buffer_load_dwordx4 v1, s[16:19], s32 offen offset:3072 sc1 lds
    v_mfma_f32_16x16x32_bf16 a[92:95], a[28:31], a[188:191], a[92:95]
    v_mfma_f32_16x16x32_bf16 a[88:91], a[28:31], a[184:187], a[88:91]
    s_add_u32 s32, s32, 0x80000
    v_mfma_f32_16x16x32_bf16 a[88:91], a[24:27], a[168:171], a[88:91]
    s_add_u32 s34, s34, 0x4000
    v_mfma_f32_16x16x32_bf16 v[220:223], a[24:27], a[164:167], v[220:223]
    v_mfma_f32_16x16x32_bf16 v[220:223], a[28:31], a[180:183], v[220:223]
    v_mfma_f32_16x16x32_bf16 v[216:219], a[28:31], a[176:179], v[216:219]
    v_mfma_f32_16x16x32_bf16 v[216:219], a[24:27], a[160:163], v[216:219]
    s_waitcnt vmcnt(63) lgkmcnt(0)
    s_barrier
    v_mfma_f32_16x16x32_bf16 v[224:227], a[32:35], a[160:163], v[224:227]
    v_mfma_f32_16x16x32_bf16 v[224:227], a[36:39], a[176:179], v[224:227]
    s_mov_b32 m0, s35
    v_mfma_f32_16x16x32_bf16 v[228:231], a[36:39], a[180:183], v[228:231]
    buffer_load_dwordx4 v1, s[20:23], s33 offen offset:0 sc1 lds
    v_mfma_f32_16x16x32_bf16 v[228:231], a[32:35], a[164:167], v[228:231]
    v_mfma_f32_16x16x32_bf16 a[96:99], a[32:35], a[168:171], a[96:99]
    v_mfma_f32_16x16x32_bf16 a[96:99], a[36:39], a[184:187], a[96:99]
    v_mfma_f32_16x16x32_bf16 a[100:103], a[36:39], a[188:191], a[100:103]
    v_mfma_f32_16x16x32_bf16 a[100:103], a[32:35], a[172:175], a[100:103]
    buffer_load_dwordx4 v1, s[20:23], s33 offen offset:1024 sc1 lds
    v_mfma_f32_16x16x32_bf16 a[108:111], a[40:43], a[172:175], a[108:111]
    v_mfma_f32_16x16x32_bf16 a[108:111], a[44:47], a[188:191], a[108:111]
    v_mfma_f32_16x16x32_bf16 a[104:107], a[44:47], a[184:187], a[104:107]
    v_mfma_f32_16x16x32_bf16 a[104:107], a[40:43], a[168:171], a[104:107]
    v_mfma_f32_16x16x32_bf16 v[236:239], a[40:43], a[164:167], v[236:239]
    v_mfma_f32_16x16x32_bf16 v[236:239], a[44:47], a[180:183], v[236:239]
    v_mfma_f32_16x16x32_bf16 v[232:235], a[44:47], a[176:179], v[232:235]
    buffer_load_dwordx4 v1, s[20:23], s33 offen offset:2048 sc1 lds
    v_mfma_f32_16x16x32_bf16 v[232:235], a[40:43], a[160:163], v[232:235]
    v_mfma_f32_16x16x32_bf16 v[240:243], a[48:51], a[160:163], v[240:243]
    v_mfma_f32_16x16x32_bf16 v[240:243], a[52:55], a[176:179], v[240:243]
    v_mfma_f32_16x16x32_bf16 v[244:247], a[52:55], a[180:183], v[244:247]
    v_mfma_f32_16x16x32_bf16 v[244:247], a[48:51], a[164:167], v[244:247]
    v_mfma_f32_16x16x32_bf16 a[112:115], a[48:51], a[168:171], a[112:115]
    buffer_load_dwordx4 v1, s[20:23], s33 offen offset:3072 sc1 lds
    v_mfma_f32_16x16x32_bf16 a[112:115], a[52:55], a[184:187], a[112:115]
    v_mfma_f32_16x16x32_bf16 a[116:119], a[52:55], a[188:191], a[116:119]
    v_mfma_f32_16x16x32_bf16 a[116:119], a[48:51], a[172:175], a[116:119]
    v_mfma_f32_16x16x32_bf16 a[124:127], a[56:59], a[172:175], a[124:127]
    v_mfma_f32_16x16x32_bf16 a[124:127], a[60:63], a[188:191], a[124:127]
    v_mfma_f32_16x16x32_bf16 a[120:123], a[60:63], a[184:187], a[120:123]
    s_add_u32 s33, s33, 0x80000
    v_mfma_f32_16x16x32_bf16 a[120:123], a[56:59], a[168:171], a[120:123]
    s_add_u32 s35, s35, 0x4000
    v_mfma_f32_16x16x32_bf16 v[252:255], a[56:59], a[164:167], v[252:255]
    v_mfma_f32_16x16x32_bf16 v[252:255], a[60:63], a[180:183], v[252:255]
    v_mfma_f32_16x16x32_bf16 v[248:251], a[60:63], a[176:179], v[248:251]
    v_mfma_f32_16x16x32_bf16 v[248:251], a[56:59], a[160:163], v[248:251]
    s_add_u32 s3, s54, 64
    s_add_u32 s5, s55, 64
    s_mov_b32 s63, s57
    s_load_dwordx2 s[44:45], s[0:1], 40
    s_load_dwordx2 s[46:47], s[0:1], 64
    s_load_dwordx4 s[48:51], s[0:1], 72
    s_mov_b32 s40, 0x3e0293ee
    s_mov_b32 s41, 0x3e0293ee
    s_mov_b32 m0, s34
    s_nop 0
    buffer_load_dwordx4 v1, s[16:19], s32 offen offset:0 sc1 lds
    buffer_load_dwordx4 v1, s[16:19], s32 offen offset:1024 sc1 lds
    buffer_load_dwordx4 v1, s[16:19], s32 offen offset:2048 sc1 lds
    buffer_load_dwordx4 v1, s[16:19], s32 offen offset:3072 sc1 lds
    s_mov_b32 m0, s35
    s_nop 0
    buffer_load_dwordx4 v1, s[20:23], s33 offen offset:0 sc1 lds
    buffer_load_dwordx4 v1, s[20:23], s33 offen offset:1024 sc1 lds
    buffer_load_dwordx4 v1, s[20:23], s33 offen offset:2048 sc1 lds
    buffer_load_dwordx4 v1, s[20:23], s33 offen offset:3072 sc1 lds
    s_add_u32 s32, s32, 0x80000
    s_add_u32 s33, s33, 0x80000
    s_add_u32 s34, s34, 0x4000
    s_and_b32 s34, s34, 0xffff
    s_add_u32 s35, s35, 0x4000
    s_and_b32 s35, s35, 0xffff
    s_or_b32 s35, s35, 0x10000
    v_mov_b32 v2, v1
    v_or_b32 v3, 0x10000, v1
    v_mov_b32 v56, v3
    s_mov_b32 s52, 0x4000
    s_mov_b32 s53, 0
    s_lshl_b32 s62, s28, 6
    s_mul_i32 s31, s29, s29
    s_add_u32 s62, s62, s31
    s_lshr_b32 s31, s30, 1
    s_lshl_b32 s4, s31, 23
    s_add_u32 s4, s4, 0x6000000
    s_add_u32 s8, s6, s4
    s_addc_u32 s9, s7, 0
    s_and_b32 s9, s9, 0xffff
    s_mov_b32 s10, 0
    s_mov_b32 s58, 0
    s_mov_b32 s14, 0x700000
    s_mov_b32 s59, 0x700000
    s_lshl_b32 s54, s62, 12
    s_waitcnt vmcnt(16) lgkmcnt(0)
    s_barrier
    s_cmp_eq_u32 s63, 0
    s_cbranch_scc1 k12_ool_74
k12_oolret_75:
    v_mov_b32 v59, 0
    ds_read_b128 a[128:131], v2 offset:0
    ds_read_b128 a[132:135], v2 offset:1024
    ds_read_b128 a[136:139], v2 offset:2048
    ds_read_b128 a[140:143], v2 offset:3072
    ds_read_b128 a[144:147], v2 offset:4096
    ds_read_b128 a[148:151], v2 offset:5120
    ds_read_b128 a[152:155], v2 offset:6144
    ds_read_b128 a[156:159], v2 offset:7168
    ds_read_b128 a[160:163], v2 offset:8192
    ds_read_b128 a[164:167], v2 offset:9216
    ds_read_b128 a[168:171], v2 offset:10240
    ds_read_b128 a[172:175], v2 offset:11264
    ds_read_b128 a[176:179], v2 offset:12288
    ds_read_b128 a[180:183], v2 offset:13312
    ds_read_b128 a[184:187], v2 offset:14336
    ds_read_b128 a[188:191], v2 offset:15360
    s_cmp_lt_u32 s30, 2
    s_cselect_b64 s[12:13], s[46:47], s[48:49]
    s_cselect_b64 s[60:61], s[44:45], s[50:51]
    s_cselect_b32 s55, 0x800000, s14
    s_and_b32 s13, s13, 0xffff
    v_accvgpr_read_b32 v128, a64
    v_accvgpr_read_b32 v129, a65
    v_accvgpr_read_b32 v130, a66
    v_accvgpr_read_b32 v131, a67
    v_pk_mul_f32 v[128:129], v[128:129], s[40:41]
    v_pk_mul_f32 v[130:131], v[130:131], s[40:41]
    v_cvt_pk_bf16_f32 v96, v128, v129
    v_cvt_pk_bf16_f32 v97, v130, v131
    v_accvgpr_read_b32 v132, a72
    v_accvgpr_read_b32 v133, a73
    v_accvgpr_read_b32 v134, a74
    v_accvgpr_read_b32 v135, a75
    v_pk_mul_f32 v[132:133], v[132:133], s[40:41]
    v_pk_mul_f32 v[134:135], v[134:135], s[40:41]
    v_cvt_pk_bf16_f32 v98, v132, v133
    v_cvt_pk_bf16_f32 v99, v134, v135
    v_accvgpr_read_b32 v136, a80
    v_accvgpr_read_b32 v137, a81
    v_accvgpr_read_b32 v138, a82
    v_accvgpr_read_b32 v139, a83
    v_pk_mul_f32 v[136:137], v[136:137], s[40:41]
    v_pk_mul_f32 v[138:139], v[138:139], s[40:41]
    v_cvt_pk_bf16_f32 v100, v136, v137
    v_cvt_pk_bf16_f32 v101, v138, v139
    v_accvgpr_read_b32 v140, a88
    v_accvgpr_read_b32 v141, a89
    v_accvgpr_read_b32 v142, a90
    v_accvgpr_read_b32 v143, a91
    v_pk_mul_f32 v[140:141], v[140:141], s[40:41]
    v_pk_mul_f32 v[142:143], v[142:143], s[40:41]
    v_cvt_pk_bf16_f32 v102, v140, v141
    v_cvt_pk_bf16_f32 v103, v142, v143
    v_accvgpr_read_b32 v128, a96
    v_accvgpr_read_b32 v129, a97
    v_accvgpr_read_b32 v130, a98
    v_accvgpr_read_b32 v131, a99
    v_pk_mul_f32 v[128:129], v[128:129], s[40:41]
    v_pk_mul_f32 v[130:131], v[130:131], s[40:41]
    v_cvt_pk_bf16_f32 v104, v128, v129
    v_cvt_pk_bf16_f32 v105, v130, v131
    v_accvgpr_read_b32 v132, a104
    v_accvgpr_read_b32 v133, a105
    v_accvgpr_read_b32 v134, a106
    v_accvgpr_read_b32 v135, a107
    v_pk_mul_f32 v[132:133], v[132:133], s[40:41]
    v_pk_mul_f32 v[134:135], v[134:135], s[40:41]
    v_cvt_pk_bf16_f32 v106, v132, v133
    v_cvt_pk_bf16_f32 v107, v134, v135
    v_accvgpr_read_b32 v136, a112
    v_accvgpr_read_b32 v137, a113
    v_accvgpr_read_b32 v138, a114
    v_accvgpr_read_b32 v139, a115
    v_pk_mul_f32 v[136:137], v[136:137], s[40:41]
    v_pk_mul_f32 v[138:139], v[138:139], s[40:41]
    v_cvt_pk_bf16_f32 v108, v136, v137
    v_cvt_pk_bf16_f32 v109, v138, v139
    v_accvgpr_read_b32 v140, a120
    v_accvgpr_read_b32 v141, a121
    v_accvgpr_read_b32 v142, a122
    v_accvgpr_read_b32 v143, a123
    v_pk_mul_f32 v[140:141], v[140:141], s[40:41]
    v_pk_mul_f32 v[142:143], v[142:143], s[40:41]
    v_cvt_pk_bf16_f32 v110, v140, v141
    v_cvt_pk_bf16_f32 v111, v142, v143
    v_accvgpr_read_b32 v128, a68
    v_accvgpr_read_b32 v129, a69
    v_accvgpr_read_b32 v130, a70
    v_accvgpr_read_b32 v131, a71
    v_pk_mul_f32 v[128:129], v[128:129], s[40:41]
    v_pk_mul_f32 v[130:131], v[130:131], s[40:41]
    v_cvt_pk_bf16_f32 v112, v128, v129
    v_cvt_pk_bf16_f32 v113, v130, v131
    v_accvgpr_read_b32 v132, a76
    v_accvgpr_read_b32 v133, a77
    v_accvgpr_read_b32 v134, a78
    v_accvgpr_read_b32 v135, a79
    v_pk_mul_f32 v[132:133], v[132:133], s[40:41]
    v_pk_mul_f32 v[134:135], v[134:135], s[40:41]
    v_cvt_pk_bf16_f32 v114, v132, v133
    v_cvt_pk_bf16_f32 v115, v134, v135
    v_accvgpr_read_b32 v136, a84
    v_accvgpr_read_b32 v137, a85
    v_accvgpr_read_b32 v138, a86
    v_accvgpr_read_b32 v139, a87
    v_pk_mul_f32 v[136:137], v[136:137], s[40:41]
    v_pk_mul_f32 v[138:139], v[138:139], s[40:41]
    v_cvt_pk_bf16_f32 v116, v136, v137
    v_cvt_pk_bf16_f32 v117, v138, v139
    v_accvgpr_read_b32 v140, a92
    v_accvgpr_read_b32 v141, a93
    v_accvgpr_read_b32 v142, a94
    v_accvgpr_read_b32 v143, a95
    v_pk_mul_f32 v[140:141], v[140:141], s[40:41]
    v_pk_mul_f32 v[142:143], v[142:143], s[40:41]
    v_cvt_pk_bf16_f32 v118, v140, v141
    v_cvt_pk_bf16_f32 v119, v142, v143
    v_accvgpr_read_b32 v128, a100
    v_accvgpr_read_b32 v129, a101
    v_accvgpr_read_b32 v130, a102
    v_accvgpr_read_b32 v131, a103
    v_pk_mul_f32 v[128:129], v[128:129], s[40:41]
    v_pk_mul_f32 v[130:131], v[130:131], s[40:41]
    v_cvt_pk_bf16_f32 v120, v128, v129
    v_cvt_pk_bf16_f32 v121, v130, v131
    v_accvgpr_read_b32 v132, a108
    v_accvgpr_read_b32 v133, a109
    v_accvgpr_read_b32 v134, a110
    v_accvgpr_read_b32 v135, a111
    v_pk_mul_f32 v[132:133], v[132:133], s[40:41]
    v_pk_mul_f32 v[134:135], v[134:135], s[40:41]
    v_cvt_pk_bf16_f32 v122, v132, v133
    v_cvt_pk_bf16_f32 v123, v134, v135
    v_accvgpr_read_b32 v136, a116
    v_accvgpr_read_b32 v137, a117
    v_accvgpr_read_b32 v138, a118
    v_accvgpr_read_b32 v139, a119
    v_pk_mul_f32 v[136:137], v[136:137], s[40:41]
    v_pk_mul_f32 v[138:139], v[138:139], s[40:41]
    v_cvt_pk_bf16_f32 v124, v136, v137
    v_cvt_pk_bf16_f32 v125, v138, v139
    v_accvgpr_read_b32 v140, a124
    v_accvgpr_read_b32 v141, a125
    v_accvgpr_read_b32 v142, a126
    v_accvgpr_read_b32 v143, a127
    v_pk_mul_f32 v[140:141], v[140:141], s[40:41]
    v_pk_mul_f32 v[142:143], v[142:143], s[40:41]
    v_cvt_pk_bf16_f32 v126, v140, v141
    v_cvt_pk_bf16_f32 v127, v142, v143
    v_pk_mul_f32 v[192:193], v[192:193], s[40:41]
    v_pk_mul_f32 v[194:195], v[194:195], s[40:41]
    v_cvt_pk_bf16_f32 v64, v192, v193
    v_cvt_pk_bf16_f32 v65, v194, v195
    v_pk_mul_f32 v[200:201], v[200:201], s[40:41]
    v_pk_mul_f32 v[202:203], v[202:203], s[40:41]
    v_cvt_pk_bf16_f32 v66, v200, v201
    v_cvt_pk_bf16_f32 v67, v202, v203
    v_pk_mul_f32 v[208:209], v[208:209], s[40:41]
    v_pk_mul_f32 v[210:211], v[210:211], s[40:41]
    v_cvt_pk_bf16_f32 v68, v208, v209
    v_cvt_pk_bf16_f32 v69, v210, v211
    v_pk_mul_f32 v[216:217], v[216:217], s[40:41]
    v_pk_mul_f32 v[218:219], v[218:219], s[40:41]
    v_cvt_pk_bf16_f32 v70, v216, v217
    v_cvt_pk_bf16_f32 v71, v218, v219
    v_pk_mul_f32 v[224:225], v[224:225], s[40:41]
    v_pk_mul_f32 v[226:227], v[226:227], s[40:41]
    v_cvt_pk_bf16_f32 v72, v224, v225
    v_cvt_pk_bf16_f32 v73, v226, v227
    v_pk_mul_f32 v[232:233], v[232:233], s[40:41]
    v_pk_mul_f32 v[234:235], v[234:235], s[40:41]
    v_cvt_pk_bf16_f32 v74, v232, v233
    v_cvt_pk_bf16_f32 v75, v234, v235
    v_pk_mul_f32 v[240:241], v[240:241], s[40:41]
    v_pk_mul_f32 v[242:243], v[242:243], s[40:41]
    v_cvt_pk_bf16_f32 v76, v240, v241
    v_cvt_pk_bf16_f32 v77, v242, v243
    v_pk_mul_f32 v[248:249], v[248:249], s[40:41]
    v_pk_mul_f32 v[250:251], v[250:251], s[40:41]
    v_cvt_pk_bf16_f32 v78, v248, v249
    v_cvt_pk_bf16_f32 v79, v250, v251
    v_pk_mul_f32 v[196:197], v[196:197], s[40:41]
    v_pk_mul_f32 v[198:199], v[198:199], s[40:41]
    v_cvt_pk_bf16_f32 v80, v196, v197
    v_cvt_pk_bf16_f32 v81, v198, v199
    v_pk_mul_f32 v[204:205], v[204:205], s[40:41]
    v_pk_mul_f32 v[206:207], v[206:207], s[40:41]
    v_cvt_pk_bf16_f32 v82, v204, v205
    v_cvt_pk_bf16_f32 v83, v206, v207
    v_pk_mul_f32 v[212:213], v[212:213], s[40:41]
    v_pk_mul_f32 v[214:215], v[214:215], s[40:41]
    v_cvt_pk_bf16_f32 v84, v212, v213
    v_cvt_pk_bf16_f32 v85, v214, v215
    v_pk_mul_f32 v[220:221], v[220:221], s[40:41]
    v_pk_mul_f32 v[222:223], v[222:223], s[40:41]
    v_cvt_pk_bf16_f32 v86, v220, v221
    v_cvt_pk_bf16_f32 v87, v222, v223
    v_pk_mul_f32 v[228:229], v[228:229], s[40:41]
    v_pk_mul_f32 v[230:231], v[230:231], s[40:41]
    v_cvt_pk_bf16_f32 v88, v228, v229
    v_cvt_pk_bf16_f32 v89, v230, v231
    v_pk_mul_f32 v[236:237], v[236:237], s[40:41]
    v_pk_mul_f32 v[238:239], v[238:239], s[40:41]
    v_cvt_pk_bf16_f32 v90, v236, v237
    v_cvt_pk_bf16_f32 v91, v238, v239
    v_pk_mul_f32 v[244:245], v[244:245], s[40:41]
    v_pk_mul_f32 v[246:247], v[246:247], s[40:41]
    v_cvt_pk_bf16_f32 v92, v244, v245
    v_cvt_pk_bf16_f32 v93, v246, v247
    v_pk_mul_f32 v[252:253], v[252:253], s[40:41]
    v_pk_mul_f32 v[254:255], v[254:255], s[40:41]
    v_cvt_pk_bf16_f32 v94, v252, v253
    v_cvt_pk_bf16_f32 v95, v254, v255
    v_add_u32 v2, 0x4000, v1
    v_mov_b32 v8, 0
    v_mov_b32 v232, 0
    v_mov_b32 v9, 0
    v_mov_b32 v233, 0
    v_mov_b32 v10, 0
    v_mov_b32 v234, 0
    v_mov_b32 v11, 0
    v_mov_b32 v235, 0
    s_mov_b32 s36, 0
    s_mov_b32 s37, 0x40004000
    v_mfma_f32_32x32x16_bf16 v[16:31], v[232:235], v[232:235], 0
    v_mfma_f32_32x32x16_bf16 v[32:47], v[232:235], v[232:235], 0
    v_and_b32 v6, 0xf0, v1
    v_cmp_eq_u32 vcc, 0, v6
    v_mov_b32 v6, 0x3f803f80
    v_lshrrev_b32 v229, 7, v1
    s_and_b32 s4, s30, 1
    s_lshl_b32 s31, s4, 11
    v_lshl_add_u32 v230, v1, 1, s31
    v_lshl_add_u32 v229, s4, 4, v229
    v_mul_u32_u24 v228, 7168, v229
    v_and_b32 v7, 0x70, v1
    v_add_u32 v228, v228, v7
    v_lshlrev_b32 v229, 5, v229
    v_and_b32 v57, 0x10, v1
    v_add_u32 v229, v229, v57
    v_lshrrev_b32 v7, 5, v7
    v_lshl_add_u32 v229, v7, 15, v229
    v_cndmask_b32 v60, 0, v6, vcc
    v_cndmask_b32 v61, 0, v6, vcc
    v_cndmask_b32 v62, 0, v6, vcc
    v_cndmask_b32 v63, 0, v6, vcc
    v_mov_b32 v12, 0
    v_mov_b32 v13, 0
    v_mov_b32 v14, 0
    v_mov_b32 v15, 0
    v_mov_b32 v48, 0
    v_mov_b32 v49, 0
    v_mov_b32 v50, 0
    v_mov_b32 v51, 0
    v_mov_b32 v248, 0
    v_mov_b32 v249, 0
    v_mov_b32 v250, 0
    v_mov_b32 v251, 0
    v_mov_b32 v252, 0
    v_mov_b32 v253, 0
    v_mov_b32 v254, 0
    v_mov_b32 v255, 0
    s_waitcnt lgkmcnt(0)
    s_cmp_ge_u32 s36, s42
    s_cbranch_scc1 k2_prep_76
k2_prepret_77:
    v_mfma_f32_16x16x32_bf16 v[128:131], a[128:131], v[64:67], v[16:19]
    v_mfma_f32_16x16x32_bf16 v[128:131], a[132:135], v[68:71], v[128:131]
    v_mfma_f32_16x16x32_bf16 v[128:131], a[136:139], v[72:75], v[128:131]
    v_mfma_f32_16x16x32_bf16 v[128:131], a[140:143], v[76:79], v[128:131]
    s_add_u32 s36, s36, 32
    v_mfma_f32_16x16x32_bf16 v[132:135], a[140:143], v[92:95], v[20:23]
    v_mfma_f32_16x16x32_bf16 v[132:135], a[136:139], v[88:91], v[132:135]
    v_mfma_f32_16x16x32_bf16 v[132:135], a[132:135], v[84:87], v[132:135]
    v_mfma_f32_16x16x32_bf16 v[132:135], a[128:131], v[80:83], v[132:135]
    v_mfma_f32_16x16x32_bf16 v[136:139], a[128:131], v[96:99], v[24:27]
    v_mfma_f32_16x16x32_bf16 v[136:139], a[132:135], v[100:103], v[136:139]
    v_mfma_f32_16x16x32_bf16 v[136:139], a[136:139], v[104:107], v[136:139]
    v_mfma_f32_16x16x32_bf16 v[136:139], a[140:143], v[108:111], v[136:139]
    v_mfma_f32_16x16x32_bf16 v[140:143], a[140:143], v[124:127], v[28:31]
    v_mfma_f32_16x16x32_bf16 v[140:143], a[136:139], v[120:123], v[140:143]
    v_mfma_f32_16x16x32_bf16 v[140:143], a[132:135], v[116:119], v[140:143]
    v_mfma_f32_16x16x32_bf16 v[140:143], a[128:131], v[112:115], v[140:143]
    v_mfma_f32_16x16x32_bf16 v[156:159], a[144:147], v[112:115], v[44:47]
    v_mfma_f32_16x16x32_bf16 v[156:159], a[148:151], v[116:119], v[156:159]
    v_mfma_f32_16x16x32_bf16 v[156:159], a[152:155], v[120:123], v[156:159]
    v_mfma_f32_16x16x32_bf16 v[156:159], a[156:159], v[124:127], v[156:159]
    v_mfma_f32_16x16x32_bf16 v[152:155], a[156:159], v[108:111], v[40:43]
    v_mfma_f32_16x16x32_bf16 v[152:155], a[152:155], v[104:107], v[152:155]
    v_mfma_f32_16x16x32_bf16 v[152:155], a[148:151], v[100:103], v[152:155]
    v_mfma_f32_16x16x32_bf16 v[152:155], a[144:147], v[96:99], v[152:155]
    v_mfma_f32_16x16x32_bf16 v[148:151], a[144:147], v[80:83], v[36:39]
    v_mfma_f32_16x16x32_bf16 v[148:151], a[148:151], v[84:87], v[148:151]
    v_mfma_f32_16x16x32_bf16 v[148:151], a[152:155], v[88:91], v[148:151]
    v_mfma_f32_16x16x32_bf16 v[148:151], a[156:159], v[92:95], v[148:151]
    v_mfma_f32_16x16x32_bf16 v[144:147], a[156:159], v[76:79], v[32:35]
    v_mfma_f32_16x16x32_bf16 v[144:147], a[152:155], v[72:75], v[144:147]
    v_mfma_f32_16x16x32_bf16 v[144:147], a[148:151], v[68:71], v[144:147]
    v_mfma_f32_16x16x32_bf16 v[144:147], a[144:147], v[64:67], v[144:147]
    v_mfma_f32_32x32x16_bf16 a[0:15], v[232:235], v[232:235], 0
    v_mfma_f32_32x32x16_bf16 a[16:31], v[232:235], v[232:235], 0
    v_mfma_f32_32x32x16_bf16 a[32:47], v[232:235], v[232:235], 0
    v_mfma_f32_32x32x16_bf16 a[48:63], v[232:235], v[232:235], 0
    v_mfma_f32_32x32x16_bf16 a[64:79], v[232:235], v[232:235], 0
    v_mfma_f32_32x32x16_bf16 a[80:95], v[232:235], v[232:235], 0
    v_mfma_f32_32x32x16_bf16 a[96:111], v[232:235], v[232:235], 0
    v_mfma_f32_32x32x16_bf16 a[112:127], v[232:235], v[232:235], 0
    v_max_f32 v52, v128, v129
    v_max3_f32 v52, v52, v130, v131
    v_max3_f32 v52, v52, v144, v145
    v_max3_f32 v52, v52, v146, v147
    v_max_f32 v53, v132, v133
    v_max3_f32 v53, v53, v134, v135
    v_max3_f32 v53, v53, v148, v149
    v_max3_f32 v53, v53, v150, v151
    v_max_f32 v54, v136, v137
    v_max3_f32 v54, v54, v138, v139
    v_max3_f32 v54, v54, v152, v153
    v_max3_f32 v54, v54, v154, v155
    v_max_f32 v55, v140, v141
    v_max3_f32 v55, v55, v142, v143
    v_max3_f32 v55, v55, v156, v157
    v_max3_f32 v55, v55, v158, v159
    v_mov_b32 v224, v52
    v_mov_b32 v225, v53
    v_mov_b32 v226, v54
    v_mov_b32 v227, v55
    s_nop 1
    v_permlane16_swap_b32 v52, v224
    v_permlane16_swap_b32 v53, v225
    v_permlane16_swap_b32 v54, v226
    v_permlane16_swap_b32 v55, v227
    s_nop 1
    v_max_f32 v52, v52, v224
    v_max_f32 v53, v53, v225
    v_max_f32 v54, v54, v226
    v_max_f32 v55, v55, v227
    v_mov_b32 v224, v52
    v_mov_b32 v225, v53
    v_mov_b32 v226, v54
    v_mov_b32 v227, v55
    s_nop 1
    v_permlane32_swap_b32 v52, v224
    v_permlane32_swap_b32 v53, v225
    v_permlane32_swap_b32 v54, v226
    v_permlane32_swap_b32 v55, v227
    s_nop 1
    v_max_f32 v52, v52, v224
    v_max_f32 v53, v53, v225
    v_max_f32 v54, v54, v226
    v_max_f32 v55, v55, v227
    v_add_f32 v52, 0x41400000, v52
    v_add_f32 v53, 0x41400000, v53
    v_add_f32 v54, 0x41400000, v54
    v_add_f32 v55, 0x41400000, v55
    v_sub_f32 v16, 0, v52
    v_sub_f32 v17, 0, v52
    v_sub_f32 v18, 0, v52
    v_sub_f32 v19, 0, v52
    v_sub_f32 v20, 0, v53
    v_sub_f32 v21, 0, v53
    v_sub_f32 v22, 0, v53
    v_sub_f32 v23, 0, v53
    v_sub_f32 v24, 0, v54
    v_sub_f32 v25, 0, v54
    v_sub_f32 v26, 0, v54
    v_sub_f32 v27, 0, v54
    v_sub_f32 v28, 0, v55
    v_sub_f32 v29, 0, v55
    v_sub_f32 v30, 0, v55
    v_sub_f32 v31, 0, v55
    v_sub_f32 v32, 0, v52
    v_sub_f32 v33, 0, v52
    v_sub_f32 v34, 0, v52
    v_sub_f32 v35, 0, v52
    v_sub_f32 v36, 0, v53
    v_sub_f32 v37, 0, v53
    v_sub_f32 v38, 0, v53
    v_sub_f32 v39, 0, v53
    v_sub_f32 v40, 0, v54
    v_sub_f32 v41, 0, v54
    v_sub_f32 v42, 0, v54
    v_sub_f32 v43, 0, v54
    v_sub_f32 v44, 0, v55
    v_sub_f32 v45, 0, v55
    v_sub_f32 v46, 0, v55
    v_sub_f32 v47, 0, v55
    v_sub_f32 v8, 0, v52
    v_sub_f32 v9, 0, v53
    v_sub_f32 v10, 0, v54
    v_sub_f32 v11, 0, v55
    s_cmp_ge_u32 s36, s42
    s_cbranch_scc1 k2_prep_84
k2_prepret_85:
    v_mfma_f32_16x16x32_bf16 v[160:163], a[160:163], v[64:67], v[16:19]
    v_sub_f32 v128, v128, v52
    v_sub_f32 v129, v129, v52
    v_sub_f32 v130, v130, v52
    v_mfma_f32_16x16x32_bf16 v[160:163], a[164:167], v[68:71], v[160:163]
    v_exp_f32 v232, v128
    v_sub_f32 v131, v131, v52
    v_mfma_f32_16x16x32_bf16 v[160:163], a[168:171], v[72:75], v[160:163]
    v_exp_f32 v233, v129
    v_sub_f32 v144, v144, v52
    v_mfma_f32_16x16x32_bf16 v[160:163], a[172:175], v[76:79], v[160:163]
    s_add_u32 s36, s36, 32
    s_cmp_eq_u32 s30, 0
    s_cbranch_scc1 k12_ool_78
k12_oolret_79:
    v_sub_f32 v145, v145, v52
    v_mfma_f32_16x16x32_bf16 v[164:167], a[172:175], v[92:95], v[20:23]
    v_exp_f32 v234, v130
    v_cvt_pk_bf16_f32 v192, v232, v233
    v_mfma_f32_16x16x32_bf16 v[164:167], a[168:171], v[88:91], v[164:167]
    v_exp_f32 v235, v131
    v_sub_f32 v146, v146, v52
    v_mfma_f32_16x16x32_bf16 v[164:167], a[164:167], v[84:87], v[164:167]
    v_exp_f32 v236, v144
    v_sub_f32 v147, v147, v52
    v_mfma_f32_16x16x32_bf16 v[164:167], a[160:163], v[80:83], v[164:167]
    v_cvt_pk_bf16_f32 v193, v234, v235
    v_exp_f32 v237, v145
    v_mfma_f32_16x16x32_bf16 v[168:171], a[160:163], v[96:99], v[24:27]
    v_exp_f32 v238, v146
    v_sub_f32 v132, v132, v53
    v_mfma_f32_16x16x32_bf16 v[168:171], a[164:167], v[100:103], v[168:171]
    v_sub_f32 v133, v133, v53
    v_cvt_pk_bf16_f32 v194, v236, v237
    v_or3_b32 v57, v192, v193, v194
    v_mfma_f32_16x16x32_bf16 v[168:171], a[168:171], v[104:107], v[168:171]
    v_exp_f32 v239, v147
    v_sub_f32 v134, v134, v53
    v_mfma_f32_16x16x32_bf16 v[168:171], a[172:175], v[108:111], v[168:171]
    v_exp_f32 v240, v132
    v_sub_f32 v135, v135, v53
    v_mfma_f32_16x16x32_bf16 v[172:175], a[172:175], v[124:127], v[28:31]
    v_cvt_pk_bf16_f32 v195, v238, v239
    v_exp_f32 v241, v133
    v_mfma_f32_16x16x32_bf16 v[172:175], a[168:171], v[120:123], v[172:175]
    v_exp_f32 v242, v134
    v_sub_f32 v148, v148, v53
    v_mfma_f32_16x16x32_bf16 v[172:175], a[164:167], v[116:119], v[172:175]
    v_sub_f32 v149, v149, v53
    v_cvt_pk_bf16_f32 v196, v240, v241
    v_exp_f32 v243, v135
    v_mfma_f32_16x16x32_bf16 v[172:175], a[160:163], v[112:115], v[172:175]
    v_or3_b32 v57, v57, v195, v196
    v_exp_f32 v244, v148
    v_mfma_f32_16x16x32_bf16 v[188:191], a[176:179], v[112:115], v[44:47]
    v_sub_f32 v150, v150, v53
    v_sub_f32 v151, v151, v53
    v_cvt_pk_bf16_f32 v197, v242, v243
    v_mfma_f32_16x16x32_bf16 v[188:191], a[180:183], v[116:119], v[188:191]
    v_exp_f32 v245, v149
    v_exp_f32 v246, v150
    v_mfma_f32_16x16x32_bf16 v[188:191], a[184:187], v[120:123], v[188:191]
    v_sub_f32 v136, v136, v54
    v_sub_f32 v137, v137, v54
    v_cvt_pk_bf16_f32 v198, v244, v245
    v_mfma_f32_16x16x32_bf16 v[188:191], a[188:191], v[124:127], v[188:191]
    v_exp_f32 v247, v151
    v_or3_b32 v57, v57, v197, v198
    v_mfma_f32_16x16x32_bf16 v[184:187], a[188:191], v[108:111], v[40:43]
    v_exp_f32 v232, v136
    v_sub_f32 v138, v138, v54
    v_mfma_f32_16x16x32_bf16 v[184:187], a[184:187], v[104:107], v[184:187]
    ds_read_b128 a[192:195], v3 offset:0
    v_sub_f32 v139, v139, v54
    v_cvt_pk_bf16_f32 v199, v246, v247
    v_mfma_f32_16x16x32_bf16 v[184:187], a[180:183], v[100:103], v[184:187]
    v_exp_f32 v233, v137
    v_exp_f32 v234, v138
    v_mfma_f32_16x16x32_bf16 v[184:187], a[176:179], v[96:99], v[184:187]
    v_sub_f32 v152, v152, v54
    v_sub_f32 v153, v153, v54
    v_cvt_pk_bf16_f32 v200, v232, v233
    v_mfma_f32_16x16x32_bf16 v[180:183], a[176:179], v[80:83], v[36:39]
    v_exp_f32 v235, v139
    v_or3_b32 v57, v57, v199, v200
    v_mfma_f32_16x16x32_bf16 v[180:183], a[180:183], v[84:87], v[180:183]
    v_exp_f32 v236, v152
    v_sub_f32 v154, v154, v54
    v_mfma_f32_16x16x32_bf16 v[180:183], a[184:187], v[88:91], v[180:183]
    v_sub_f32 v155, v155, v54
    v_cvt_pk_bf16_f32 v201, v234, v235
    v_exp_f32 v237, v153
    v_mfma_f32_16x16x32_bf16 v[180:183], a[188:191], v[92:95], v[180:183]
    ds_read_b128 a[196:199], v3 offset:1024
    v_exp_f32 v238, v154
    v_mfma_f32_16x16x32_bf16 v[176:179], a[188:191], v[76:79], v[32:35]
    v_sub_f32 v140, v140, v55
    v_sub_f32 v141, v141, v55
    v_cvt_pk_bf16_f32 v202, v236, v237
    v_mfma_f32_16x16x32_bf16 v[176:179], a[184:187], v[72:75], v[176:179]
    v_exp_f32 v239, v155
    v_or3_b32 v57, v57, v201, v202
    v_mfma_f32_16x16x32_bf16 v[176:179], a[180:183], v[68:71], v[176:179]
    s_cmp_eq_u32 s30, 0
    s_cbranch_scc1 k12_ool_82
k12_oolret_83:
    v_exp_f32 v240, v140
    v_mfma_f32_16x16x32_bf16 v[176:179], a[176:179], v[64:67], v[176:179]
    s_waitcnt vmcnt(8)
    s_barrier
    v_sub_f32 v142, v142, v55
    v_sub_f32 v143, v143, v55
    v_cvt_pk_bf16_f32 v203, v238, v239
    v_exp_f32 v241, v141
    v_exp_f32 v242, v142
    v_sub_f32 v156, v156, v55
    v_sub_f32 v157, v157, v55
    ds_read_b128 a[200:203], v3 offset:2048
    v_cvt_pk_bf16_f32 v204, v240, v241
    v_exp_f32 v243, v143
    v_or3_b32 v57, v57, v203, v204
    v_exp_f32 v244, v156
    v_sub_f32 v158, v158, v55
    v_sub_f32 v159, v159, v55
    v_cvt_pk_bf16_f32 v205, v242, v243
    v_exp_f32 v245, v157
    v_exp_f32 v246, v158
    v_cvt_pk_bf16_f32 v206, v244, v245
    ds_read_b128 a[204:207], v3 offset:3072
    v_exp_f32 v247, v159
    v_or3_b32 v57, v57, v205, v206
    v_cvt_pk_bf16_f32 v207, v246, v247
    v_bitop3_b32 v57, v57, v207, s37 bitop3:0xa8
    v_cmp_ne_u32 vcc, 0, v57
    s_cbranch_vccnz k2_tramp_86
k2_ret_87:
    s_mov_b32 s24, s60
    s_and_b32 s25, s61, 0xffff
    s_mov_b32 s26, s55
    s_lshl_b32 s63, s29, 1
    s_sub_u32 s63, s63, 1
    s_cbranch_scc1 k2_dm3_89
k2_dloop_88:
    v_mfma_f32_16x16x32_bf16 v[12:15], v[60:63], v[192:195], v[12:15]
    v_exp_f32 v232, v160
    v_mfma_f32_16x16x32_bf16 v[48:51], v[60:63], v[196:199], v[48:51]
    s_mov_b32 m0, s34
    ds_read_b128 a[208:211], v3 offset:4096
    v_mfma_f32_16x16x32_bf16 v[248:251], v[60:63], v[200:203], v[248:251]
    s_add_u32 s53, s53, 8192
    buffer_load_dwordx4 v1, s[16:19], s32 offen offset:0 sc1 lds
    v_mfma_f32_16x16x32_bf16 v[252:255], v[60:63], v[204:207], v[252:255]
    s_waitcnt lgkmcnt(3)
    v_exp_f32 v233, v161
    v_mfma_f32_16x16x32_bf16 a[12:15], a[192:195], v[204:207], a[12:15]
    s_and_b32 s53, s53, 0xffff
    v_exp_f32 v234, v162
    v_mfma_f32_16x16x32_bf16 a[8:11], a[192:195], v[200:203], a[8:11]
    s_add_u32 s34, s34, 0x4000
    ds_read_b128 a[212:215], v3 offset:5120
    v_cvt_pk_bf16_f32 v208, v232, v233
    v_mfma_f32_16x16x32_bf16 a[4:7], a[192:195], v[196:199], a[4:7]
    v_exp_f32 v235, v163
    v_mfma_f32_16x16x32_bf16 a[0:3], a[192:195], v[192:195], a[0:3]
    buffer_load_dwordx4 v1, s[16:19], s32 offen offset:1024 sc1 lds
    v_mfma_f32_16x16x32_bf16 a[16:19], a[196:199], v[192:195], a[16:19]
    v_exp_f32 v236, v176
    v_mfma_f32_16x16x32_bf16 a[20:23], a[196:199], v[196:199], a[20:23]
    ds_read_b128 a[216:219], v3 offset:6144
    v_cvt_pk_bf16_f32 v209, v234, v235
    v_mfma_f32_16x16x32_bf16 a[24:27], a[196:199], v[200:203], a[24:27]
    v_exp_f32 v237, v177
    v_mfma_f32_16x16x32_bf16 a[28:31], a[196:199], v[204:207], a[28:31]
    s_waitcnt lgkmcnt(3)
    v_exp_f32 v238, v178
    v_mfma_f32_16x16x32_bf16 a[44:47], a[200:203], v[204:207], a[44:47]
    s_and_b32 s34, s34, 0xffff
    ds_read_b128 a[220:223], v3 offset:7168
    v_cvt_pk_bf16_f32 v210, v236, v237
    v_mfma_f32_16x16x32_bf16 a[40:43], a[200:203], v[200:203], a[40:43]
    s_and_b32 s60, s62, 31
    buffer_load_dwordx4 v1, s[16:19], s32 offen offset:2048 sc1 lds
    v_mfma_f32_16x16x32_bf16 a[36:39], a[200:203], v[196:199], a[36:39]
    v_exp_f32 v239, v179
    v_mfma_f32_16x16x32_bf16 a[32:35], a[200:203], v[192:195], a[32:35]
    s_lshr_b32 s61, s62, 5
    v_or3_b32 v57, v208, v209, v210
    v_add_u32 v3, s53, v56
    v_mfma_f32_16x16x32_bf16 a[48:51], a[204:207], v[192:195], a[48:51]
    v_exp_f32 v240, v164
    v_mfma_f32_16x16x32_bf16 a[52:55], a[204:207], v[196:199], a[52:55]
    ds_read_b128 a[128:131], v2 offset:0
    v_cvt_pk_bf16_f32 v211, v238, v239
    v_mfma_f32_16x16x32_bf16 a[56:59], a[204:207], v[200:203], a[56:59]
    s_mul_i32 s57, s60, 229376
    v_exp_f32 v241, v165
    v_mfma_f32_16x16x32_bf16 a[60:63], a[204:207], v[204:207], a[60:63]
    s_waitcnt lgkmcnt(3)
    buffer_load_dwordx4 v1, s[16:19], s32 offen offset:3072 sc1 lds
    v_mfma_f32_16x16x32_bf16 a[76:79], a[208:211], v[204:207], a[76:79]
    s_add_u32 s32, s32, 0x80000
    v_exp_f32 v242, v166
    v_mfma_f32_16x16x32_bf16 a[72:75], a[208:211], v[200:203], a[72:75]
    s_lshl_b32 s4, s61, 7
    ds_read_b128 a[132:135], v2 offset:1024
    v_cvt_pk_bf16_f32 v212, v240, v241
    v_mfma_f32_16x16x32_bf16 a[68:71], a[208:211], v[196:199], a[68:71]
    v_exp_f32 v243, v167
    v_mfma_f32_16x16x32_bf16 a[64:67], a[208:211], v[192:195], a[64:67]
    s_add_u32 s57, s57, s4
    v_or3_b32 v57, v57, v211, v212
    v_cvt_pk_bf16_f32 v213, v242, v243
    v_mfma_f32_16x16x32_bf16 a[80:83], a[212:215], v[192:195], a[80:83]
    s_waitcnt vmcnt(9)
    v_exp_f32 v244, v180
    v_mfma_f32_16x16x32_bf16 a[84:87], a[212:215], v[196:199], a[84:87]
    buffer_store_dwordx4 a[224:227], v229, s[8:11], s58 offen offset:0 sc1
    ds_read_b128 a[136:139], v2 offset:2048
    v_mfma_f32_16x16x32_bf16 a[88:91], a[212:215], v[200:203], a[88:91]
    s_add_u32 s56, s57, 57344
    v_exp_f32 v245, v181
    v_mfma_f32_16x16x32_bf16 a[92:95], a[212:215], v[204:207], a[92:95]
    s_waitcnt lgkmcnt(3)
    v_exp_f32 v246, v182
    v_mfma_f32_16x16x32_bf16 a[108:111], a[216:219], v[204:207], a[108:111]
    ds_read_b128 a[140:143], v2 offset:3072
    v_cvt_pk_bf16_f32 v214, v244, v245
    v_mfma_f32_16x16x32_bf16 a[104:107], a[216:219], v[200:203], a[104:107]
    s_add_u32 s62, s62, 1
    v_exp_f32 v247, v183
    v_mfma_f32_16x16x32_bf16 a[100:103], a[216:219], v[196:199], a[100:103]
    v_or3_b32 v57, v57, v213, v214
    v_mfma_f32_16x16x32_bf16 a[96:99], a[216:219], v[192:195], a[96:99]
    v_exp_f32 v232, v168
    v_mfma_f32_16x16x32_bf16 a[112:115], a[220:223], v[192:195], a[112:115]
    ds_read_b128 a[144:147], v2 offset:4096
    v_cvt_pk_bf16_f32 v215, v246, v247
    v_mfma_f32_16x16x32_bf16 a[116:119], a[220:223], v[196:199], a[116:119]
    buffer_store_dwordx4 a[228:231], v229, s[8:11], s58 offen offset:256 sc1
    v_mfma_f32_16x16x32_bf16 a[120:123], a[220:223], v[200:203], a[120:123]
    v_exp_f32 v233, v169
    v_mfma_f32_16x16x32_bf16 a[124:127], a[220:223], v[204:207], a[124:127]
    s_waitcnt lgkmcnt(3)
    v_exp_f32 v234, v170
    v_mfma_f32_16x16x32_bf16 v[128:131], a[128:131], v[64:67], v[16:19]
    ds_read_b128 a[148:151], v2 offset:5120
    v_cvt_pk_bf16_f32 v216, v232, v233
    v_mfma_f32_16x16x32_bf16 v[128:131], a[132:135], v[68:71], v[128:131]
    s_waitcnt lgkmcnt(2)
    v_exp_f32 v235, v171
    v_mfma_f32_16x16x32_bf16 v[128:131], a[136:139], v[72:75], v[128:131]
    v_or3_b32 v57, v57, v215, v216
    v_mfma_f32_16x16x32_bf16 v[128:131], a[140:143], v[76:79], v[128:131]
    s_add_u32 s36, s36, 32
    v_exp_f32 v236, v184
    v_mfma_f32_16x16x32_bf16 v[132:135], a[140:143], v[92:95], v[20:23]
    ds_read_b128 a[152:155], v2 offset:6144
    v_cvt_pk_bf16_f32 v217, v234, v235
    v_mfma_f32_16x16x32_bf16 v[132:135], a[136:139], v[88:91], v[132:135]
    s_lshl_b32 s58, s61, 17
    buffer_load_dwordx4 a[224:227], v228, s[12:15], s57 offen nt
    v_mfma_f32_16x16x32_bf16 v[132:135], a[132:135], v[84:87], v[132:135]
    s_add_u32 s52, s52, 8192
    v_exp_f32 v237, v185
    v_mfma_f32_16x16x32_bf16 v[132:135], a[128:131], v[80:83], v[132:135]
    v_exp_f32 v238, v186
    v_mfma_f32_16x16x32_bf16 v[136:139], a[128:131], v[96:99], v[24:27]
    s_lshl_b32 s60, s60, 10
    ds_read_b128 a[156:159], v2 offset:7168
    v_cvt_pk_bf16_f32 v218, v236, v237
    v_mfma_f32_16x16x32_bf16 v[136:139], a[132:135], v[100:103], v[136:139]
    s_and_b32 s52, s52, 0xffff
    v_exp_f32 v239, v187
    v_mfma_f32_16x16x32_bf16 v[136:139], a[136:139], v[104:107], v[136:139]
    v_or3_b32 v57, v57, v217, v218
    v_mfma_f32_16x16x32_bf16 v[136:139], a[140:143], v[108:111], v[136:139]
    v_add_u32 v2, s52, v1
    v_cvt_pk_bf16_f32 v219, v238, v239
    v_mfma_f32_16x16x32_bf16 v[140:143], a[140:143], v[124:127], v[28:31]
    s_add_u32 s58, s58, s60
    v_exp_f32 v240, v172
    v_mfma_f32_16x16x32_bf16 v[140:143], a[136:139], v[120:123], v[140:143]
    buffer_load_dwordx4 a[228:231], v228, s[12:15], s56 offen nt
    v_mfma_f32_16x16x32_bf16 v[140:143], a[132:135], v[116:119], v[140:143]
    v_exp_f32 v241, v173
    v_mfma_f32_16x16x32_bf16 v[140:143], a[128:131], v[112:115], v[140:143]
    s_waitcnt lgkmcnt(2)
    ds_read_b128 a[192:195], v3 offset:0
    v_cvt_pk_bf16_f32 v220, v240, v241
    v_mfma_f32_16x16x32_bf16 v[156:159], a[144:147], v[112:115], v[44:47]
    s_mov_b32 s10, s59
    v_exp_f32 v242, v174
    v_mfma_f32_16x16x32_bf16 v[156:159], a[148:151], v[116:119], v[156:159]
    s_waitcnt lgkmcnt(1)
    v_exp_f32 v243, v175
    v_mfma_f32_16x16x32_bf16 v[156:159], a[152:155], v[120:123], v[156:159]
    ds_read_b128 a[196:199], v3 offset:1024
    v_or3_b32 v57, v57, v219, v220
    v_mfma_f32_16x16x32_bf16 v[156:159], a[156:159], v[124:127], v[156:159]
    v_exp_f32 v244, v188
    v_mfma_f32_16x16x32_bf16 v[152:155], a[156:159], v[108:111], v[40:43]
    v_cvt_pk_bf16_f32 v221, v242, v243
    v_mfma_f32_16x16x32_bf16 v[152:155], a[152:155], v[104:107], v[152:155]
    buffer_load_dword v7, v230, s[24:27], s54 offen
    v_mfma_f32_16x16x32_bf16 v[152:155], a[148:151], v[100:103], v[152:155]
    v_exp_f32 v245, v189
    v_mfma_f32_16x16x32_bf16 v[152:155], a[144:147], v[96:99], v[152:155]
    ds_read_b128 a[200:203], v3 offset:2048
    v_cvt_pk_bf16_f32 v222, v244, v245
    v_mfma_f32_16x16x32_bf16 v[148:151], a[144:147], v[80:83], v[36:39]
    v_exp_f32 v246, v190
    v_mfma_f32_16x16x32_bf16 v[148:151], a[148:151], v[84:87], v[148:151]
    v_exp_f32 v247, v191
    v_mfma_f32_16x16x32_bf16 v[148:151], a[152:155], v[88:91], v[148:151]
    ds_read_b128 a[204:207], v3 offset:3072
    v_or3_b32 v57, v57, v221, v222
    v_mfma_f32_16x16x32_bf16 v[148:151], a[156:159], v[92:95], v[148:151]
    v_cvt_pk_bf16_f32 v223, v246, v247
    v_mfma_f32_16x16x32_bf16 v[144:147], a[156:159], v[76:79], v[32:35]
    s_add_u32 s54, s54, 4096
    v_mfma_f32_16x16x32_bf16 v[144:147], a[152:155], v[72:75], v[144:147]
    v_bitop3_b32 v57, v57, v223, s37 bitop3:0xa8
    v_cmp_ne_u32 vcc, 0, v57
    v_mfma_f32_16x16x32_bf16 v[144:147], a[148:151], v[68:71], v[144:147]
    v_mfma_f32_16x16x32_bf16 v[144:147], a[144:147], v[64:67], v[144:147]
    s_cbranch_vccnz k2_tramp_90
k2_ret_91:
    v_mfma_f32_16x16x32_bf16 v[12:15], v[60:63], v[208:211], v[12:15]
    v_exp_f32 v232, v128
    v_mfma_f32_16x16x32_bf16 v[48:51], v[60:63], v[212:215], v[48:51]
    s_mov_b32 m0, s35
    ds_read_b128 a[208:211], v3 offset:4096
    v_mfma_f32_16x16x32_bf16 v[248:251], v[60:63], v[216:219], v[248:251]
    s_add_u32 s53, s53, 8192
    buffer_load_dwordx4 v1, s[20:23], s33 offen offset:0 sc1 lds
    v_mfma_f32_16x16x32_bf16 v[252:255], v[60:63], v[220:223], v[252:255]
    s_waitcnt lgkmcnt(3)
    v_exp_f32 v233, v129
    v_mfma_f32_16x16x32_bf16 a[12:15], a[192:195], v[220:223], a[12:15]
    s_and_b32 s53, s53, 0xffff
    v_exp_f32 v234, v130
    v_mfma_f32_16x16x32_bf16 a[8:11], a[192:195], v[216:219], a[8:11]
    ds_read_b128 a[212:215], v3 offset:5120
    v_cvt_pk_bf16_f32 v192, v232, v233
    v_mfma_f32_16x16x32_bf16 a[4:7], a[192:195], v[212:215], a[4:7]
    v_exp_f32 v235, v131
    v_mfma_f32_16x16x32_bf16 a[0:3], a[192:195], v[208:211], a[0:3]
    v_exp_f32 v236, v144
    v_mfma_f32_16x16x32_bf16 a[16:19], a[196:199], v[208:211], a[16:19]
    ds_read_b128 a[216:219], v3 offset:6144
    v_cvt_pk_bf16_f32 v193, v234, v235
    v_mfma_f32_16x16x32_bf16 a[20:23], a[196:199], v[212:215], a[20:23]
    v_exp_f32 v237, v145
    v_mfma_f32_16x16x32_bf16 a[24:27], a[196:199], v[216:219], a[24:27]
    v_mfma_f32_16x16x32_bf16 a[28:31], a[196:199], v[220:223], a[28:31]
    s_waitcnt lgkmcnt(3)
    v_exp_f32 v238, v146
    v_mfma_f32_16x16x32_bf16 a[44:47], a[200:203], v[220:223], a[44:47]
    ds_read_b128 a[220:223], v3 offset:7168
    v_cvt_pk_bf16_f32 v194, v236, v237
    v_mfma_f32_16x16x32_bf16 a[40:43], a[200:203], v[216:219], a[40:43]
    v_exp_f32 v239, v147
    v_mfma_f32_16x16x32_bf16 a[36:39], a[200:203], v[212:215], a[36:39]
    v_or3_b32 v57, v192, v193, v194
    v_mfma_f32_16x16x32_bf16 a[32:35], a[200:203], v[208:211], a[32:35]
    s_add_u32 s35, s35, 0x4000
    v_add_u32 v3, s53, v56
    v_cvt_pk_bf16_f32 v195, v238, v239
    v_mfma_f32_16x16x32_bf16 a[48:51], a[204:207], v[208:211], a[48:51]
    v_exp_f32 v240, v132
    v_mfma_f32_16x16x32_bf16 a[52:55], a[204:207], v[212:215], a[52:55]
    buffer_load_dwordx4 v1, s[20:23], s33 offen offset:1024 sc1 lds
    ds_read_b128 a[128:131], v2 offset:0
    v_mfma_f32_16x16x32_bf16 a[56:59], a[204:207], v[216:219], a[56:59]
    v_exp_f32 v241, v133
    v_mfma_f32_16x16x32_bf16 a[60:63], a[204:207], v[220:223], a[60:63]
    s_waitcnt lgkmcnt(3)
    v_exp_f32 v242, v134
    v_mfma_f32_16x16x32_bf16 a[76:79], a[208:211], v[220:223], a[76:79]
    ds_read_b128 a[132:135], v2 offset:1024
    v_cvt_pk_bf16_f32 v196, v240, v241
    v_mfma_f32_16x16x32_bf16 a[72:75], a[208:211], v[216:219], a[72:75]
    v_exp_f32 v243, v135
    v_mfma_f32_16x16x32_bf16 a[68:71], a[208:211], v[212:215], a[68:71]
    v_or3_b32 v57, v57, v195, v196
    v_mfma_f32_16x16x32_bf16 a[64:67], a[208:211], v[208:211], a[64:67]
    v_exp_f32 v244, v148
    v_mfma_f32_16x16x32_bf16 a[80:83], a[212:215], v[208:211], a[80:83]
    ds_read_b128 a[136:139], v2 offset:2048
    v_cvt_pk_bf16_f32 v197, v242, v243
    v_mfma_f32_16x16x32_bf16 a[84:87], a[212:215], v[212:215], a[84:87]
    v_exp_f32 v245, v149
    v_mfma_f32_16x16x32_bf16 a[88:91], a[212:215], v[216:219], a[88:91]
    v_mfma_f32_16x16x32_bf16 a[92:95], a[212:215], v[220:223], a[92:95]
    s_waitcnt lgkmcnt(3)
    v_exp_f32 v246, v150
    v_mfma_f32_16x16x32_bf16 a[108:111], a[216:219], v[220:223], a[108:111]
    ds_read_b128 a[140:143], v2 offset:3072
    v_cvt_pk_bf16_f32 v198, v244, v245
    v_mfma_f32_16x16x32_bf16 a[104:107], a[216:219], v[216:219], a[104:107]
    v_exp_f32 v247, v151
    v_mfma_f32_16x16x32_bf16 a[100:103], a[216:219], v[212:215], a[100:103]
    v_or3_b32 v57, v57, v197, v198
    v_mfma_f32_16x16x32_bf16 a[96:99], a[216:219], v[208:211], a[96:99]
    s_and_b32 s35, s35, 0xffff
    v_exp_f32 v232, v136
    v_mfma_f32_16x16x32_bf16 a[112:115], a[220:223], v[208:211], a[112:115]
    ds_read_b128 a[144:147], v2 offset:4096
    v_cvt_pk_bf16_f32 v199, v246, v247
    v_mfma_f32_16x16x32_bf16 a[116:119], a[220:223], v[212:215], a[116:119]
    buffer_load_dwordx4 v1, s[20:23], s33 offen offset:2048 sc1 lds
    v_mfma_f32_16x16x32_bf16 a[120:123], a[220:223], v[216:219], a[120:123]
    v_exp_f32 v233, v137
    v_mfma_f32_16x16x32_bf16 a[124:127], a[220:223], v[220:223], a[124:127]
    s_waitcnt lgkmcnt(3)
    v_exp_f32 v234, v138
    v_mfma_f32_16x16x32_bf16 v[160:163], a[128:131], v[64:67], v[16:19]
    ds_read_b128 a[148:151], v2 offset:5120
    v_cvt_pk_bf16_f32 v200, v232, v233
    v_mfma_f32_16x16x32_bf16 v[160:163], a[132:135], v[68:71], v[160:163]
    s_waitcnt lgkmcnt(2)
    v_exp_f32 v235, v139
    v_mfma_f32_16x16x32_bf16 v[160:163], a[136:139], v[72:75], v[160:163]
    v_or3_b32 v57, v57, v199, v200
    v_mfma_f32_16x16x32_bf16 v[160:163], a[140:143], v[76:79], v[160:163]
    s_or_b32 s35, s35, 0x10000
    v_exp_f32 v236, v152
    v_mfma_f32_16x16x32_bf16 v[164:167], a[140:143], v[92:95], v[20:23]
    s_add_u32 s36, s36, 32
    ds_read_b128 a[152:155], v2 offset:6144
    v_cvt_pk_bf16_f32 v201, v234, v235
    v_mfma_f32_16x16x32_bf16 v[164:167], a[136:139], v[88:91], v[164:167]
    v_exp_f32 v237, v153
    v_mfma_f32_16x16x32_bf16 v[164:167], a[132:135], v[84:87], v[164:167]
    s_add_u32 s52, s52, 8192
    v_mfma_f32_16x16x32_bf16 v[164:167], a[128:131], v[80:83], v[164:167]
    v_exp_f32 v238, v154
    v_mfma_f32_16x16x32_bf16 v[168:171], a[128:131], v[96:99], v[24:27]
    s_and_b32 s52, s52, 0xffff
    ds_read_b128 a[156:159], v2 offset:7168
    v_cvt_pk_bf16_f32 v202, v236, v237
    v_mfma_f32_16x16x32_bf16 v[168:171], a[132:135], v[100:103], v[168:171]
    v_exp_f32 v239, v155
    v_mfma_f32_16x16x32_bf16 v[168:171], a[136:139], v[104:107], v[168:171]
    v_or3_b32 v57, v57, v201, v202
    v_mfma_f32_16x16x32_bf16 v[168:171], a[140:143], v[108:111], v[168:171]
    v_add_u32 v2, s52, v1
    v_cvt_pk_bf16_f32 v203, v238, v239
    v_mfma_f32_16x16x32_bf16 v[172:175], a[140:143], v[124:127], v[28:31]
    v_exp_f32 v240, v140
    v_mfma_f32_16x16x32_bf16 v[172:175], a[136:139], v[120:123], v[172:175]
    buffer_load_dwordx4 v1, s[20:23], s33 offen offset:3072 sc1 lds
    v_mfma_f32_16x16x32_bf16 v[172:175], a[132:135], v[116:119], v[172:175]
    s_add_u32 s33, s33, 0x80000
    v_exp_f32 v241, v141
    v_mfma_f32_16x16x32_bf16 v[172:175], a[128:131], v[112:115], v[172:175]
    s_waitcnt lgkmcnt(2)
    ds_read_b128 a[192:195], v3 offset:0
    v_cvt_pk_bf16_f32 v204, v240, v241
    v_mfma_f32_16x16x32_bf16 v[188:191], a[144:147], v[112:115], v[44:47]
    v_exp_f32 v242, v142
    v_mfma_f32_16x16x32_bf16 v[188:191], a[148:151], v[116:119], v[188:191]
    s_waitcnt lgkmcnt(1)
    v_exp_f32 v243, v143
    v_mfma_f32_16x16x32_bf16 v[188:191], a[152:155], v[120:123], v[188:191]
    ds_read_b128 a[196:199], v3 offset:1024
    v_or3_b32 v57, v57, v203, v204
    v_mfma_f32_16x16x32_bf16 v[188:191], a[156:159], v[124:127], v[188:191]
    v_exp_f32 v244, v156
    v_mfma_f32_16x16x32_bf16 v[184:187], a[156:159], v[108:111], v[40:43]
    v_cvt_pk_bf16_f32 v205, v242, v243
    v_mfma_f32_16x16x32_bf16 v[184:187], a[152:155], v[104:107], v[184:187]
    v_exp_f32 v245, v157
    v_mfma_f32_16x16x32_bf16 v[184:187], a[148:151], v[100:103], v[184:187]
    ds_read_b128 a[200:203], v3 offset:2048
    v_mfma_f32_16x16x32_bf16 v[184:187], a[144:147], v[96:99], v[184:187]
    s_sub_u32 s63, s63, 1
    v_exp_f32 v246, v158
    v_mfma_f32_16x16x32_bf16 v[180:183], a[144:147], v[80:83], v[36:39]
    v_cvt_pk_bf16_f32 v206, v244, v245
    v_mfma_f32_16x16x32_bf16 v[180:183], a[148:151], v[84:87], v[180:183]
    v_exp_f32 v247, v159
    v_mfma_f32_16x16x32_bf16 v[180:183], a[152:155], v[88:91], v[180:183]
    ds_read_b128 a[204:207], v3 offset:3072
    v_or3_b32 v57, v57, v205, v206
    v_mfma_f32_16x16x32_bf16 v[180:183], a[156:159], v[92:95], v[180:183]
    v_cvt_pk_bf16_f32 v207, v246, v247
    v_mfma_f32_16x16x32_bf16 v[176:179], a[156:159], v[76:79], v[32:35]
    v_mfma_f32_16x16x32_bf16 v[176:179], a[152:155], v[72:75], v[176:179]
    v_bitop3_b32 v57, v57, v207, s37 bitop3:0xa8
    v_cmp_ne_u32 vcc, 0, v57
    v_mfma_f32_16x16x32_bf16 v[176:179], a[148:151], v[68:71], v[176:179]
    v_mfma_f32_16x16x32_bf16 v[176:179], a[144:147], v[64:67], v[176:179]
    s_waitcnt vmcnt(13)
    s_barrier
    s_cbranch_vccnz k2_tramp_92
k2_ret_93:
    s_cmp_lg_u32 s63, 0
    s_cbranch_scc1 k2_dloop_88
    v_mfma_f32_16x16x32_bf16 v[12:15], v[60:63], v[192:195], v[12:15]
    v_exp_f32 v232, v160
    v_mfma_f32_16x16x32_bf16 v[48:51], v[60:63], v[196:199], v[48:51]
    s_mov_b32 m0, s34
    ds_read_b128 a[208:211], v3 offset:4096
    v_mfma_f32_16x16x32_bf16 v[248:251], v[60:63], v[200:203], v[248:251]
    s_add_u32 s53, s53, 8192
    buffer_load_dwordx4 v1, s[16:19], s32 offen offset:0 sc1 lds
    v_mfma_f32_16x16x32_bf16 v[252:255], v[60:63], v[204:207], v[252:255]
    s_waitcnt lgkmcnt(3)
    v_exp_f32 v233, v161
    v_mfma_f32_16x16x32_bf16 a[12:15], a[192:195], v[204:207], a[12:15]
    s_sub_u32 s40, s36, s38
    v_exp_f32 v234, v162
    v_mfma_f32_16x16x32_bf16 a[8:11], a[192:195], v[200:203], a[8:11]
    s_and_b32 s53, s53, 0xffff
    ds_read_b128 a[212:215], v3 offset:5120
    v_cvt_pk_bf16_f32 v208, v232, v233
    v_mfma_f32_16x16x32_bf16 a[4:7], a[192:195], v[196:199], a[4:7]
    s_add_u32 s34, s34, 0x4000
    v_subrev_u32 v6, s40, v4
    v_cmp_gt_i32 s[44:45], 0, v6
    v_mfma_f32_16x16x32_bf16 a[0:3], a[192:195], v[192:195], a[0:3]
    v_exp_f32 v235, v163
    v_mfma_f32_16x16x32_bf16 a[16:19], a[196:199], v[192:195], a[16:19]
    buffer_load_dwordx4 v1, s[16:19], s32 offen offset:1024 sc1 lds
    ds_read_b128 a[216:219], v3 offset:6144
    v_mfma_f32_16x16x32_bf16 a[20:23], a[196:199], v[196:199], a[20:23]
    v_exp_f32 v236, v176
    v_mfma_f32_16x16x32_bf16 a[24:27], a[196:199], v[200:203], a[24:27]
    v_cmp_gt_i32 s[46:47], 1, v6
    v_cvt_pk_bf16_f32 v209, v234, v235
    v_mfma_f32_16x16x32_bf16 a[28:31], a[196:199], v[204:207], a[28:31]
    s_waitcnt lgkmcnt(3)
    v_cmp_gt_i32 s[48:49], 2, v6
    v_cmp_gt_i32 s[50:51], 3, v6
    v_mfma_f32_16x16x32_bf16 a[44:47], a[200:203], v[204:207], a[44:47]
    s_and_b32 s34, s34, 0xffff
    v_exp_f32 v237, v177
    v_mfma_f32_16x16x32_bf16 a[40:43], a[200:203], v[200:203], a[40:43]
    s_and_b32 s60, s62, 31
    v_exp_f32 v238, v178
    v_mfma_f32_16x16x32_bf16 a[36:39], a[200:203], v[196:199], a[36:39]
    ds_read_b128 a[220:223], v3 offset:7168
    v_cvt_pk_bf16_f32 v210, v236, v237
    v_mfma_f32_16x16x32_bf16 a[32:35], a[200:203], v[192:195], a[32:35]
    s_lshr_b32 s61, s62, 5
    buffer_load_dwordx4 v1, s[16:19], s32 offen offset:2048 sc1 lds
    v_mfma_f32_16x16x32_bf16 a[48:51], a[204:207], v[192:195], a[48:51]
    v_cndmask_b32 v16, v8, v5, s[44:45]
    v_or3_b32 v57, v208, v209, v210
    v_mfma_f32_16x16x32_bf16 a[52:55], a[204:207], v[196:199], a[52:55]
    v_exp_f32 v239, v179
    v_mfma_f32_16x16x32_bf16 a[56:59], a[204:207], v[200:203], a[56:59]
    s_mul_i32 s57, s60, 229376
    v_cndmask_b32 v17, v8, v5, s[46:47]
    v_add_u32 v3, s53, v56
    v_mfma_f32_16x16x32_bf16 a[60:63], a[204:207], v[204:207], a[60:63]
    s_waitcnt lgkmcnt(2)
    v_exp_f32 v240, v164
    v_mfma_f32_16x16x32_bf16 a[76:79], a[208:211], v[204:207], a[76:79]
    v_cvt_pk_bf16_f32 v211, v238, v239
    v_cndmask_b32 v18, v8, v5, s[48:49]
    v_mfma_f32_16x16x32_bf16 a[72:75], a[208:211], v[200:203], a[72:75]
    s_lshl_b32 s4, s61, 7
    ds_read_b128 a[128:131], v2 offset:0
    v_cndmask_b32 v19, v8, v5, s[50:51]
    v_mfma_f32_16x16x32_bf16 a[68:71], a[208:211], v[196:199], a[68:71]
    v_exp_f32 v241, v165
    v_mfma_f32_16x16x32_bf16 a[64:67], a[208:211], v[192:195], a[64:67]
    s_add_u32 s57, s57, s4
    buffer_load_dwordx4 v1, s[16:19], s32 offen offset:3072 sc1 lds
    s_add_u32 s32, s32, 0x80000
    v_mfma_f32_16x16x32_bf16 a[80:83], a[212:215], v[192:195], a[80:83]
    s_waitcnt vmcnt(9)
    v_cmp_gt_i32 s[44:45], 16, v6
    v_exp_f32 v242, v166
    v_mfma_f32_16x16x32_bf16 a[84:87], a[212:215], v[196:199], a[84:87]
    ds_read_b128 a[132:135], v2 offset:1024
    v_cvt_pk_bf16_f32 v212, v240, v241
    v_mfma_f32_16x16x32_bf16 a[88:91], a[212:215], v[200:203], a[88:91]
    s_add_u32 s56, s57, 57344
    v_cmp_gt_i32 s[46:47], 17, v6
    v_exp_f32 v243, v167
    v_mfma_f32_16x16x32_bf16 a[92:95], a[212:215], v[204:207], a[92:95]
    s_waitcnt lgkmcnt(2)
    v_or3_b32 v57, v57, v211, v212
    v_cmp_gt_i32 s[48:49], 18, v6
    v_mfma_f32_16x16x32_bf16 a[108:111], a[216:219], v[204:207], a[108:111]
    v_exp_f32 v244, v180
    v_mfma_f32_16x16x32_bf16 a[104:107], a[216:219], v[200:203], a[104:107]
    s_add_u32 s62, s62, 1
    v_cvt_pk_bf16_f32 v213, v242, v243
    v_cmp_gt_i32 s[50:51], 19, v6
    v_mfma_f32_16x16x32_bf16 a[100:103], a[216:219], v[196:199], a[100:103]
    buffer_store_dwordx4 a[224:227], v229, s[8:11], s58 offen offset:0 sc1
    ds_read_b128 a[136:139], v2 offset:2048
    v_mfma_f32_16x16x32_bf16 a[96:99], a[216:219], v[192:195], a[96:99]
    v_exp_f32 v245, v181
    v_mfma_f32_16x16x32_bf16 a[112:115], a[220:223], v[192:195], a[112:115]
    v_cndmask_b32 v32, v8, v5, s[44:45]
    v_exp_f32 v246, v182
    v_mfma_f32_16x16x32_bf16 a[116:119], a[220:223], v[196:199], a[116:119]
    ds_read_b128 a[140:143], v2 offset:3072
    v_cndmask_b32 v33, v8, v5, s[46:47]
    v_cvt_pk_bf16_f32 v214, v244, v245
    v_cndmask_b32 v34, v8, v5, s[48:49]
    v_cndmask_b32 v35, v8, v5, s[50:51]
    v_mfma_f32_16x16x32_bf16 a[120:123], a[220:223], v[200:203], a[120:123]
    v_exp_f32 v247, v183
    v_mfma_f32_16x16x32_bf16 a[124:127], a[220:223], v[204:207], a[124:127]
    s_waitcnt lgkmcnt(2)
    v_or3_b32 v57, v57, v213, v214
    v_cvt_pk_bf16_f32 v215, v246, v247
    v_mfma_f32_16x16x32_bf16 v[128:131], a[128:131], v[64:67], v[16:19]
    v_exp_f32 v232, v168
    v_mfma_f32_16x16x32_bf16 v[128:131], a[132:135], v[68:71], v[128:131]
    s_waitcnt lgkmcnt(0)
    buffer_store_dwordx4 a[228:231], v229, s[8:11], s58 offen offset:256 sc1
    ds_read_b128 a[144:147], v2 offset:4096
    v_mfma_f32_16x16x32_bf16 v[128:131], a[136:139], v[72:75], v[128:131]
    v_exp_f32 v233, v169
    v_mfma_f32_16x16x32_bf16 v[128:131], a[140:143], v[76:79], v[128:131]
    s_add_u32 s36, s36, 32
    v_exp_f32 v234, v170
    v_mfma_f32_16x16x32_bf16 v[132:135], a[140:143], v[92:95], v[20:23]
    ds_read_b128 a[148:151], v2 offset:5120
    v_cvt_pk_bf16_f32 v216, v232, v233
    v_mfma_f32_16x16x32_bf16 v[132:135], a[136:139], v[88:91], v[132:135]
    s_lshl_b32 s58, s61, 17
    v_exp_f32 v235, v171
    v_mfma_f32_16x16x32_bf16 v[132:135], a[132:135], v[84:87], v[132:135]
    s_add_u32 s52, s52, 8192
    v_or3_b32 v57, v57, v215, v216
    v_cvt_pk_bf16_f32 v217, v234, v235
    v_mfma_f32_16x16x32_bf16 v[132:135], a[128:131], v[80:83], v[132:135]
    v_exp_f32 v236, v184
    v_mfma_f32_16x16x32_bf16 v[136:139], a[128:131], v[96:99], v[24:27]
    s_lshl_b32 s60, s60, 10
    buffer_load_dwordx4 a[224:227], v228, s[12:15], s57 offen nt
    ds_read_b128 a[152:155], v2 offset:6144
    v_mfma_f32_16x16x32_bf16 v[136:139], a[132:135], v[100:103], v[136:139]
    s_and_b32 s52, s52, 0xffff
    v_exp_f32 v237, v185
    v_mfma_f32_16x16x32_bf16 v[136:139], a[136:139], v[104:107], v[136:139]
    v_exp_f32 v238, v186
    v_mfma_f32_16x16x32_bf16 v[136:139], a[140:143], v[108:111], v[136:139]
    ds_read_b128 a[156:159], v2 offset:7168
    v_cvt_pk_bf16_f32 v218, v236, v237
    v_mfma_f32_16x16x32_bf16 v[140:143], a[140:143], v[124:127], v[28:31]
    s_add_u32 s58, s58, s60
    v_exp_f32 v239, v187
    v_mfma_f32_16x16x32_bf16 v[140:143], a[136:139], v[120:123], v[140:143]
    v_or3_b32 v57, v57, v217, v218
    v_add_u32 v2, s52, v1
    v_mfma_f32_16x16x32_bf16 v[140:143], a[132:135], v[116:119], v[140:143]
    v_exp_f32 v240, v172
    v_mfma_f32_16x16x32_bf16 v[140:143], a[128:131], v[112:115], v[140:143]
    s_waitcnt lgkmcnt(2)
    ds_read_b128 a[192:195], v3 offset:0
    v_cvt_pk_bf16_f32 v219, v238, v239
    v_mfma_f32_16x16x32_bf16 v[156:159], a[144:147], v[112:115], v[44:47]
    s_mov_b32 s10, s59
    buffer_load_dwordx4 a[228:231], v228, s[12:15], s56 offen nt
    v_mfma_f32_16x16x32_bf16 v[156:159], a[148:151], v[116:119], v[156:159]
    s_waitcnt lgkmcnt(1)
    v_exp_f32 v241, v173
    v_mfma_f32_16x16x32_bf16 v[156:159], a[152:155], v[120:123], v[156:159]
    v_exp_f32 v242, v174
    v_mfma_f32_16x16x32_bf16 v[156:159], a[156:159], v[124:127], v[156:159]
    v_cvt_pk_bf16_f32 v220, v240, v241
    v_or3_b32 v57, v57, v219, v220
    v_mfma_f32_16x16x32_bf16 v[152:155], a[156:159], v[108:111], v[40:43]
    v_exp_f32 v243, v175
    v_mfma_f32_16x16x32_bf16 v[152:155], a[152:155], v[104:107], v[152:155]
    ds_read_b128 a[196:199], v3 offset:1024
    v_cvt_pk_bf16_f32 v221, v242, v243
    v_mfma_f32_16x16x32_bf16 v[152:155], a[148:151], v[100:103], v[152:155]
    v_exp_f32 v244, v188
    v_mfma_f32_16x16x32_bf16 v[152:155], a[144:147], v[96:99], v[152:155]
    buffer_load_dword v7, v230, s[24:27], s54 offen
    ds_read_b128 a[200:203], v3 offset:2048
    v_mfma_f32_16x16x32_bf16 v[148:151], a[144:147], v[80:83], v[36:39]
    v_exp_f32 v245, v189
    v_mfma_f32_16x16x32_bf16 v[148:151], a[148:151], v[84:87], v[148:151]
    v_exp_f32 v246, v190
    v_mfma_f32_16x16x32_bf16 v[148:151], a[152:155], v[88:91], v[148:151]
    v_cvt_pk_bf16_f32 v222, v244, v245
    v_or3_b32 v57, v57, v221, v222
    v_mfma_f32_16x16x32_bf16 v[148:151], a[156:159], v[92:95], v[148:151]
    v_exp_f32 v247, v191
    v_mfma_f32_16x16x32_bf16 v[144:147], a[156:159], v[76:79], v[32:35]
    s_add_u32 s54, s54, 4096
    ds_read_b128 a[204:207], v3 offset:3072
    v_cvt_pk_bf16_f32 v223, v246, v247
    v_mfma_f32_16x16x32_bf16 v[144:147], a[152:155], v[72:75], v[144:147]
    v_bitop3_b32 v57, v57, v223, s37 bitop3:0xa8
    v_cmp_ne_u32 vcc, 0, v57
    v_mfma_f32_16x16x32_bf16 v[144:147], a[148:151], v[68:71], v[144:147]
    v_mfma_f32_16x16x32_bf16 v[144:147], a[144:147], v[64:67], v[144:147]
    s_cbranch_vccnz k2_tramp_94
k2_ret_95:
    v_mfma_f32_16x16x32_bf16 v[12:15], v[60:63], v[208:211], v[12:15]
    v_exp_f32 v232, v128
    v_mfma_f32_16x16x32_bf16 v[48:51], v[60:63], v[212:215], v[48:51]
    s_mov_b32 m0, s35
    ds_read_b128 a[208:211], v3 offset:4096
    v_mfma_f32_16x16x32_bf16 v[248:251], v[60:63], v[216:219], v[248:251]
    s_add_u32 s53, s53, 8192
    buffer_load_dwordx4 v1, s[20:23], s33 offen offset:0 sc1 lds
    v_mfma_f32_16x16x32_bf16 v[252:255], v[60:63], v[220:223], v[252:255]
    s_waitcnt lgkmcnt(3)
    v_exp_f32 v233, v129
    v_mfma_f32_16x16x32_bf16 a[12:15], a[192:195], v[220:223], a[12:15]
    s_sub_u32 s40, s36, s38
    v_exp_f32 v234, v130
    v_mfma_f32_16x16x32_bf16 a[8:11], a[192:195], v[216:219], a[8:11]
    s_and_b32 s53, s53, 0xffff
    ds_read_b128 a[212:215], v3 offset:5120
    v_cvt_pk_bf16_f32 v192, v232, v233
    v_mfma_f32_16x16x32_bf16 a[4:7], a[192:195], v[212:215], a[4:7]
    v_subrev_u32 v6, s40, v4
    v_cmp_gt_i32 s[44:45], 0, v6
    v_mfma_f32_16x16x32_bf16 a[0:3], a[192:195], v[208:211], a[0:3]
    v_exp_f32 v235, v131
    v_mfma_f32_16x16x32_bf16 a[16:19], a[196:199], v[208:211], a[16:19]
    v_exp_f32 v236, v144
    v_mfma_f32_16x16x32_bf16 a[20:23], a[196:199], v[212:215], a[20:23]
    v_cmp_gt_i32 s[46:47], 1, v6
    v_cvt_pk_bf16_f32 v193, v234, v235
    v_mfma_f32_16x16x32_bf16 a[24:27], a[196:199], v[216:219], a[24:27]
    ds_read_b128 a[216:219], v3 offset:6144
    v_cmp_gt_i32 s[48:49], 2, v6
    v_mfma_f32_16x16x32_bf16 a[28:31], a[196:199], v[220:223], a[28:31]
    s_waitcnt lgkmcnt(3)
    v_exp_f32 v237, v145
    v_mfma_f32_16x16x32_bf16 a[44:47], a[200:203], v[220:223], a[44:47]
    v_cmp_gt_i32 s[50:51], 3, v6
    v_cvt_pk_bf16_f32 v194, v236, v237
    v_mfma_f32_16x16x32_bf16 a[40:43], a[200:203], v[216:219], a[40:43]
    v_exp_f32 v238, v146
    v_mfma_f32_16x16x32_bf16 a[36:39], a[200:203], v[212:215], a[36:39]
    ds_read_b128 a[220:223], v3 offset:7168
    v_cndmask_b32 v16, v8, v5, s[44:45]
    v_mfma_f32_16x16x32_bf16 a[32:35], a[200:203], v[208:211], a[32:35]
    s_add_u32 s35, s35, 0x4000
    v_exp_f32 v239, v147
    v_mfma_f32_16x16x32_bf16 a[48:51], a[204:207], v[208:211], a[48:51]
    v_or3_b32 v57, v192, v193, v194
    v_cndmask_b32 v17, v8, v5, s[46:47]
    v_mfma_f32_16x16x32_bf16 a[52:55], a[204:207], v[212:215], a[52:55]
    v_add_u32 v3, s53, v56
    v_cvt_pk_bf16_f32 v195, v238, v239
    v_mfma_f32_16x16x32_bf16 a[56:59], a[204:207], v[216:219], a[56:59]
    v_exp_f32 v240, v132
    v_mfma_f32_16x16x32_bf16 a[60:63], a[204:207], v[220:223], a[60:63]
    s_waitcnt lgkmcnt(2)
    ds_read_b128 a[128:131], v2 offset:0
    v_cndmask_b32 v18, v8, v5, s[48:49]
    v_mfma_f32_16x16x32_bf16 a[76:79], a[208:211], v[220:223], a[76:79]
    buffer_load_dwordx4 v1, s[20:23], s33 offen offset:1024 sc1 lds
    ds_read_b128 a[132:135], v2 offset:1024
    v_mfma_f32_16x16x32_bf16 a[72:75], a[208:211], v[216:219], a[72:75]
    v_exp_f32 v241, v133
    v_mfma_f32_16x16x32_bf16 a[68:71], a[208:211], v[212:215], a[68:71]
    v_cndmask_b32 v19, v8, v5, s[50:51]
    v_cmp_gt_i32 s[44:45], 16, v6
    v_mfma_f32_16x16x32_bf16 a[64:67], a[208:211], v[208:211], a[64:67]
    v_exp_f32 v242, v134
    v_mfma_f32_16x16x32_bf16 a[80:83], a[212:215], v[208:211], a[80:83]
    v_cvt_pk_bf16_f32 v196, v240, v241
    v_cmp_gt_i32 s[46:47], 17, v6
    v_mfma_f32_16x16x32_bf16 a[84:87], a[212:215], v[212:215], a[84:87]
    v_exp_f32 v243, v135
    v_mfma_f32_16x16x32_bf16 a[88:91], a[212:215], v[216:219], a[88:91]
    v_or3_b32 v57, v57, v195, v196
    v_cmp_gt_i32 s[48:49], 18, v6
    v_mfma_f32_16x16x32_bf16 a[92:95], a[212:215], v[220:223], a[92:95]
    s_waitcnt lgkmcnt(2)
    v_exp_f32 v244, v148
    v_mfma_f32_16x16x32_bf16 a[108:111], a[216:219], v[220:223], a[108:111]
    v_cvt_pk_bf16_f32 v197, v242, v243
    v_cmp_gt_i32 s[50:51], 19, v6
    v_mfma_f32_16x16x32_bf16 a[104:107], a[216:219], v[216:219], a[104:107]
    ds_read_b128 a[136:139], v2 offset:2048
    v_cndmask_b32 v32, v8, v5, s[44:45]
    v_mfma_f32_16x16x32_bf16 a[100:103], a[216:219], v[212:215], a[100:103]
    v_exp_f32 v245, v149
    v_mfma_f32_16x16x32_bf16 a[96:99], a[216:219], v[208:211], a[96:99]
    s_and_b32 s35, s35, 0xffff
    v_exp_f32 v246, v150
    v_mfma_f32_16x16x32_bf16 a[112:115], a[220:223], v[208:211], a[112:115]
    v_cndmask_b32 v33, v8, v5, s[46:47]
    v_cvt_pk_bf16_f32 v198, v244, v245
    v_mfma_f32_16x16x32_bf16 a[116:119], a[220:223], v[212:215], a[116:119]
    ds_read_b128 a[140:143], v2 offset:3072
    v_cndmask_b32 v34, v8, v5, s[48:49]
    v_cndmask_b32 v35, v8, v5, s[50:51]
    v_mfma_f32_16x16x32_bf16 a[120:123], a[220:223], v[216:219], a[120:123]
    v_exp_f32 v247, v151
    v_mfma_f32_16x16x32_bf16 a[124:127], a[220:223], v[220:223], a[124:127]
    s_waitcnt lgkmcnt(2)
    v_or3_b32 v57, v57, v197, v198
    v_cvt_pk_bf16_f32 v199, v246, v247
    v_mfma_f32_16x16x32_bf16 v[160:163], a[128:131], v[64:67], v[16:19]
    v_exp_f32 v232, v136
    v_mfma_f32_16x16x32_bf16 v[160:163], a[132:135], v[68:71], v[160:163]
    s_waitcnt lgkmcnt(0)
    buffer_load_dwordx4 v1, s[20:23], s33 offen offset:2048 sc1 lds
    ds_read_b128 a[144:147], v2 offset:4096
    v_mfma_f32_16x16x32_bf16 v[160:163], a[136:139], v[72:75], v[160:163]
    v_exp_f32 v233, v137
    v_mfma_f32_16x16x32_bf16 v[160:163], a[140:143], v[76:79], v[160:163]
    s_or_b32 s35, s35, 0x10000
    v_exp_f32 v234, v138
    v_mfma_f32_16x16x32_bf16 v[164:167], a[140:143], v[92:95], v[20:23]
    s_add_u32 s36, s36, 32
    ds_read_b128 a[148:151], v2 offset:5120
    v_cvt_pk_bf16_f32 v200, v232, v233
    v_mfma_f32_16x16x32_bf16 v[164:167], a[136:139], v[88:91], v[164:167]
    v_exp_f32 v235, v139
    v_mfma_f32_16x16x32_bf16 v[164:167], a[132:135], v[84:87], v[164:167]
    s_add_u32 s52, s52, 8192
    v_or3_b32 v57, v57, v199, v200
    v_cvt_pk_bf16_f32 v201, v234, v235
    v_mfma_f32_16x16x32_bf16 v[164:167], a[128:131], v[80:83], v[164:167]
    v_exp_f32 v236, v152
    v_mfma_f32_16x16x32_bf16 v[168:171], a[128:131], v[96:99], v[24:27]
    s_and_b32 s52, s52, 0xffff
    ds_read_b128 a[152:155], v2 offset:6144
    ds_read_b128 a[156:159], v2 offset:7168
    v_mfma_f32_16x16x32_bf16 v[168:171], a[132:135], v[100:103], v[168:171]
    v_exp_f32 v237, v153
    v_mfma_f32_16x16x32_bf16 v[168:171], a[136:139], v[104:107], v[168:171]
    v_exp_f32 v238, v154
    v_mfma_f32_16x16x32_bf16 v[168:171], a[140:143], v[108:111], v[168:171]
    v_cvt_pk_bf16_f32 v202, v236, v237
    v_or3_b32 v57, v57, v201, v202
    v_mfma_f32_16x16x32_bf16 v[172:175], a[140:143], v[124:127], v[28:31]
    v_exp_f32 v239, v155
    v_mfma_f32_16x16x32_bf16 v[172:175], a[136:139], v[120:123], v[172:175]
    v_add_u32 v2, s52, v1
    v_cvt_pk_bf16_f32 v203, v238, v239
    v_mfma_f32_16x16x32_bf16 v[172:175], a[132:135], v[116:119], v[172:175]
    v_exp_f32 v240, v140
    v_mfma_f32_16x16x32_bf16 v[172:175], a[128:131], v[112:115], v[172:175]
    s_waitcnt lgkmcnt(2)
    buffer_load_dwordx4 v1, s[20:23], s33 offen offset:3072 sc1 lds
    s_add_u32 s33, s33, 0x80000
    v_mfma_f32_16x16x32_bf16 v[188:191], a[144:147], v[112:115], v[44:47]
    v_exp_f32 v241, v141
    v_mfma_f32_16x16x32_bf16 v[188:191], a[148:151], v[116:119], v[188:191]
    s_waitcnt lgkmcnt(0)
    ds_read_b128 a[192:195], v3 offset:0
    v_cvt_pk_bf16_f32 v204, v240, v241
    v_mfma_f32_16x16x32_bf16 v[188:191], a[152:155], v[120:123], v[188:191]
    v_exp_f32 v242, v142
    v_mfma_f32_16x16x32_bf16 v[188:191], a[156:159], v[124:127], v[188:191]
    v_exp_f32 v243, v143
    v_mfma_f32_16x16x32_bf16 v[184:187], a[156:159], v[108:111], v[40:43]
    ds_read_b128 a[196:199], v3 offset:1024
    v_or3_b32 v57, v57, v203, v204
    v_mfma_f32_16x16x32_bf16 v[184:187], a[152:155], v[104:107], v[184:187]
    v_exp_f32 v244, v156
    v_mfma_f32_16x16x32_bf16 v[184:187], a[148:151], v[100:103], v[184:187]
    ds_read_b128 a[200:203], v3 offset:2048
    v_cvt_pk_bf16_f32 v205, v242, v243
    v_mfma_f32_16x16x32_bf16 v[184:187], a[144:147], v[96:99], v[184:187]
    v_exp_f32 v245, v157
    v_mfma_f32_16x16x32_bf16 v[180:183], a[144:147], v[80:83], v[36:39]
    v_exp_f32 v246, v158
    v_mfma_f32_16x16x32_bf16 v[180:183], a[148:151], v[84:87], v[180:183]
    v_cvt_pk_bf16_f32 v206, v244, v245
    v_or3_b32 v57, v57, v205, v206
    v_mfma_f32_16x16x32_bf16 v[180:183], a[152:155], v[88:91], v[180:183]
    v_exp_f32 v247, v159
    v_mfma_f32_16x16x32_bf16 v[180:183], a[156:159], v[92:95], v[180:183]
    ds_read_b128 a[204:207], v3 offset:3072
    v_cvt_pk_bf16_f32 v207, v246, v247
    v_mfma_f32_16x16x32_bf16 v[176:179], a[156:159], v[76:79], v[32:35]
    v_mfma_f32_16x16x32_bf16 v[176:179], a[152:155], v[72:75], v[176:179]
    v_bitop3_b32 v57, v57, v207, s37 bitop3:0xa8
    v_cmp_ne_u32 vcc, 0, v57
    v_mfma_f32_16x16x32_bf16 v[176:179], a[148:151], v[68:71], v[176:179]
    v_mfma_f32_16x16x32_bf16 v[176:179], a[144:147], v[64:67], v[176:179]
    s_waitcnt vmcnt(13)
    s_barrier
    s_cbranch_vccnz k2_tramp_96
k2_ret_97:
k2_dm3_89:
    v_mfma_f32_16x16x32_bf16 v[12:15], v[60:63], v[192:195], v[12:15]
    v_exp_f32 v232, v160
    v_mfma_f32_16x16x32_bf16 v[48:51], v[60:63], v[196:199], v[48:51]
    s_mov_b32 m0, s34
    ds_read_b128 a[208:211], v3 offset:4096
    v_mfma_f32_16x16x32_bf16 v[248:251], v[60:63], v[200:203], v[248:251]
    s_add_u32 s53, s53, 8192
    v_exp_f32 v233, v161
    v_mfma_f32_16x16x32_bf16 v[252:255], v[60:63], v[204:207], v[252:255]
    s_waitcnt lgkmcnt(3)
    buffer_load_dwordx4 v1, s[16:19], s32 offen offset:0 sc1 lds
    v_mfma_f32_16x16x32_bf16 a[12:15], a[192:195], v[204:207], a[12:15]
    s_sub_u32 s40, s36, s38
    s_sub_u32 s40, s40, 64
    v_exp_f32 v234, v162
    v_cvt_pk_bf16_f32 v208, v232, v233
    v_mfma_f32_16x16x32_bf16 a[8:11], a[192:195], v[200:203], a[8:11]
    s_and_b32 s53, s53, 0xffff
    ds_read_b128 a[212:215], v3 offset:5120
    v_subrev_u32 v6, s40, v4
    v_mfma_f32_16x16x32_bf16 a[4:7], a[192:195], v[196:199], a[4:7]
    s_add_u32 s34, s34, 0x4000
    v_exp_f32 v235, v163
    v_cmp_gt_i32 s[44:45], 0, v6
    v_mfma_f32_16x16x32_bf16 a[0:3], a[192:195], v[192:195], a[0:3]
    v_exp_f32 v236, v176
    v_cvt_pk_bf16_f32 v209, v234, v235
    v_mfma_f32_16x16x32_bf16 a[16:19], a[196:199], v[192:195], a[16:19]
    buffer_load_dwordx4 v1, s[16:19], s32 offen offset:1024 sc1 lds
    ds_read_b128 a[216:219], v3 offset:6144
    v_mfma_f32_16x16x32_bf16 a[20:23], a[196:199], v[196:199], a[20:23]
    v_cmp_gt_i32 s[46:47], 1, v6
    v_exp_f32 v237, v177
    v_mfma_f32_16x16x32_bf16 a[24:27], a[196:199], v[200:203], a[24:27]
    v_cmp_gt_i32 s[48:49], 2, v6
    v_exp_f32 v238, v178
    v_mfma_f32_16x16x32_bf16 a[28:31], a[196:199], v[204:207], a[28:31]
    s_waitcnt lgkmcnt(3)
    v_cvt_pk_bf16_f32 v210, v236, v237
    v_cmp_gt_i32 s[50:51], 3, v6
    v_mfma_f32_16x16x32_bf16 a[44:47], a[200:203], v[204:207], a[44:47]
    s_and_b32 s34, s34, 0xffff
    v_exp_f32 v239, v179
    v_mfma_f32_16x16x32_bf16 a[40:43], a[200:203], v[200:203], a[40:43]
    s_and_b32 s60, s62, 31
    ds_read_b128 a[220:223], v3 offset:7168
    v_or3_b32 v57, v208, v209, v210
    v_cndmask_b32 v20, v9, v5, s[44:45]
    v_mfma_f32_16x16x32_bf16 a[36:39], a[200:203], v[196:199], a[36:39]
    buffer_load_dwordx4 v1, s[16:19], s32 offen offset:2048 sc1 lds
    v_mfma_f32_16x16x32_bf16 a[32:35], a[200:203], v[192:195], a[32:35]
    s_lshr_b32 s61, s62, 5
    v_exp_f32 v240, v164
    v_cvt_pk_bf16_f32 v211, v238, v239
    v_mfma_f32_16x16x32_bf16 a[48:51], a[204:207], v[192:195], a[48:51]
    v_cndmask_b32 v21, v9, v5, s[46:47]
    v_add_u32 v3, s53, v56
    v_mfma_f32_16x16x32_bf16 a[52:55], a[204:207], v[196:199], a[52:55]
    s_mul_i32 s57, s60, 229376
    v_exp_f32 v241, v165
    v_mfma_f32_16x16x32_bf16 a[56:59], a[204:207], v[200:203], a[56:59]
    ds_read_b128 a[128:131], v2 offset:0
    v_cndmask_b32 v22, v9, v5, s[48:49]
    v_cvt_pk_bf16_f32 v212, v240, v241
    v_mfma_f32_16x16x32_bf16 a[60:63], a[204:207], v[204:207], a[60:63]
    s_waitcnt lgkmcnt(3)
    v_exp_f32 v242, v166
    v_mfma_f32_16x16x32_bf16 a[76:79], a[208:211], v[204:207], a[76:79]
    s_lshl_b32 s4, s61, 7
    v_cndmask_b32 v23, v9, v5, s[50:51]
    v_or3_b32 v57, v57, v211, v212
    v_mfma_f32_16x16x32_bf16 a[72:75], a[208:211], v[200:203], a[72:75]
    buffer_load_dwordx4 v1, s[16:19], s32 offen offset:3072 sc1 lds
    ds_read_b128 a[132:135], v2 offset:1024
    s_add_u32 s32, s32, 0x80000
    v_mfma_f32_16x16x32_bf16 a[68:71], a[208:211], v[196:199], a[68:71]
    v_exp_f32 v243, v167
    v_mfma_f32_16x16x32_bf16 a[64:67], a[208:211], v[192:195], a[64:67]
    s_add_u32 s57, s57, s4
    v_cmp_gt_i32 s[44:45], 16, v6
    v_cvt_pk_bf16_f32 v213, v242, v243
    v_mfma_f32_16x16x32_bf16 a[80:83], a[212:215], v[192:195], a[80:83]
    s_waitcnt vmcnt(9)
    v_exp_f32 v244, v180
    v_mfma_f32_16x16x32_bf16 a[84:87], a[212:215], v[196:199], a[84:87]
    s_add_u32 s56, s57, 57344
    ds_read_b128 a[136:139], v2 offset:2048
    v_cmp_gt_i32 s[46:47], 17, v6
    v_mfma_f32_16x16x32_bf16 a[88:91], a[212:215], v[200:203], a[88:91]
    v_exp_f32 v245, v181
    v_cmp_gt_i32 s[48:49], 18, v6
    v_mfma_f32_16x16x32_bf16 a[92:95], a[212:215], v[204:207], a[92:95]
    s_waitcnt lgkmcnt(3)
    v_exp_f32 v246, v182
    v_mfma_f32_16x16x32_bf16 a[108:111], a[216:219], v[204:207], a[108:111]
    s_add_u32 s62, s62, 1
    v_cmp_gt_i32 s[50:51], 19, v6
    v_cvt_pk_bf16_f32 v214, v244, v245
    v_mfma_f32_16x16x32_bf16 a[104:107], a[216:219], v[200:203], a[104:107]
    buffer_store_dwordx4 a[224:227], v229, s[8:11], s58 offen offset:0 sc1
    ds_read_b128 a[140:143], v2 offset:3072
    ds_read_b128 a[144:147], v2 offset:4096
    v_mfma_f32_16x16x32_bf16 a[100:103], a[216:219], v[196:199], a[100:103]
    v_exp_f32 v247, v183
    v_mfma_f32_16x16x32_bf16 a[96:99], a[216:219], v[192:195], a[96:99]
    v_cndmask_b32 v36, v9, v5, s[44:45]
    v_or3_b32 v57, v57, v213, v214
    v_mfma_f32_16x16x32_bf16 a[112:115], a[220:223], v[192:195], a[112:115]
    v_exp_f32 v232, v168
    v_mfma_f32_16x16x32_bf16 a[116:119], a[220:223], v[196:199], a[116:119]
    v_cndmask_b32 v37, v9, v5, s[46:47]
    v_cvt_pk_bf16_f32 v215, v246, v247
    v_cndmask_b32 v38, v9, v5, s[48:49]
    v_cndmask_b32 v39, v9, v5, s[50:51]
    v_mfma_f32_16x16x32_bf16 a[120:123], a[220:223], v[200:203], a[120:123]
    v_exp_f32 v233, v169
    v_mfma_f32_16x16x32_bf16 a[124:127], a[220:223], v[204:207], a[124:127]
    s_waitcnt lgkmcnt(3)
    buffer_store_dwordx4 a[228:231], v229, s[8:11], s58 offen offset:256 sc1
    v_exp_f32 v234, v170
    v_mfma_f32_16x16x32_bf16 v[132:135], a[128:131], v[80:83], v[20:23]
    ds_read_b128 a[148:151], v2 offset:5120
    v_cvt_pk_bf16_f32 v216, v232, v233
    v_mfma_f32_16x16x32_bf16 v[132:135], a[132:135], v[84:87], v[132:135]
    s_waitcnt lgkmcnt(2)
    v_exp_f32 v235, v171
    v_mfma_f32_16x16x32_bf16 v[132:135], a[136:139], v[88:91], v[132:135]
    s_lshl_b32 s58, s61, 17
    ds_read_b128 a[152:155], v2 offset:6144
    v_or3_b32 v57, v57, v215, v216
    v_mfma_f32_16x16x32_bf16 v[132:135], a[140:143], v[92:95], v[132:135]
    s_add_u32 s36, s36, 32
    v_exp_f32 v236, v184
    v_mfma_f32_16x16x32_bf16 v[136:139], a[140:143], v[108:111], v[24:27]
    s_lshl_b32 s60, s60, 10
    v_cvt_pk_bf16_f32 v217, v234, v235
    v_exp_f32 v237, v185
    v_mfma_f32_16x16x32_bf16 v[136:139], a[136:139], v[104:107], v[136:139]
    buffer_load_dwordx4 a[224:227], v228, s[12:15], s57 offen nt
    ds_read_b128 a[156:159], v2 offset:7168
    v_mfma_f32_16x16x32_bf16 v[136:139], a[132:135], v[100:103], v[136:139]
    s_add_u32 s52, s52, 8192
    v_exp_f32 v238, v186
    v_mfma_f32_16x16x32_bf16 v[136:139], a[128:131], v[96:99], v[136:139]
    s_add_u32 s58, s58, s60
    v_cvt_pk_bf16_f32 v218, v236, v237
    v_or3_b32 v57, v57, v217, v218
    v_mfma_f32_16x16x32_bf16 v[140:143], a[128:131], v[112:115], v[28:31]
    s_and_b32 s52, s52, 0xffff
    v_exp_f32 v239, v187
    v_mfma_f32_16x16x32_bf16 v[140:143], a[132:135], v[116:119], v[140:143]
    v_add_u32 v2, s52, v1
    v_cvt_pk_bf16_f32 v219, v238, v239
    v_mfma_f32_16x16x32_bf16 v[140:143], a[136:139], v[120:123], v[140:143]
    s_mov_b32 s10, s59
    v_exp_f32 v240, v172
    v_mfma_f32_16x16x32_bf16 v[140:143], a[140:143], v[124:127], v[140:143]
    s_waitcnt lgkmcnt(2)
    ds_read_b128 a[192:195], v3 offset:0
    s_waitcnt lgkmcnt(1)
    v_mfma_f32_16x16x32_bf16 v[156:159], a[156:159], v[124:127], v[44:47]
    v_exp_f32 v241, v173
    v_mfma_f32_16x16x32_bf16 v[156:159], a[152:155], v[120:123], v[156:159]
    buffer_load_dwordx4 a[228:231], v228, s[12:15], s56 offen nt
    v_exp_f32 v242, v174
    v_mfma_f32_16x16x32_bf16 v[156:159], a[148:151], v[116:119], v[156:159]
    ds_read_b128 a[196:199], v3 offset:1024
    v_cvt_pk_bf16_f32 v220, v240, v241
    v_mfma_f32_16x16x32_bf16 v[156:159], a[144:147], v[112:115], v[156:159]
    v_exp_f32 v243, v175
    v_mfma_f32_16x16x32_bf16 v[152:155], a[144:147], v[96:99], v[40:43]
    v_or3_b32 v57, v57, v219, v220
    v_cvt_pk_bf16_f32 v221, v242, v243
    v_mfma_f32_16x16x32_bf16 v[152:155], a[148:151], v[100:103], v[152:155]
    ds_read_b128 a[200:203], v3 offset:2048
    v_exp_f32 v244, v188
    v_mfma_f32_16x16x32_bf16 v[152:155], a[152:155], v[104:107], v[152:155]
    buffer_load_dword v7, v230, s[24:27], s54 offen
    v_exp_f32 v245, v189
    v_mfma_f32_16x16x32_bf16 v[152:155], a[156:159], v[108:111], v[152:155]
    v_exp_f32 v246, v190
    v_mfma_f32_16x16x32_bf16 v[148:151], a[156:159], v[92:95], v[36:39]
    s_add_u32 s54, s54, 4096
    v_cvt_pk_bf16_f32 v222, v244, v245
    v_or3_b32 v57, v57, v221, v222
    v_mfma_f32_16x16x32_bf16 v[148:151], a[152:155], v[88:91], v[148:151]
    v_exp_f32 v247, v191
    v_mfma_f32_16x16x32_bf16 v[148:151], a[148:151], v[84:87], v[148:151]
    ds_read_b128 a[204:207], v3 offset:3072
    v_cvt_pk_bf16_f32 v223, v246, v247
    v_mfma_f32_16x16x32_bf16 v[148:151], a[144:147], v[80:83], v[148:151]
    v_bitop3_b32 v57, v57, v223, s37 bitop3:0xa8
    v_cmp_ne_u32 vcc, 0, v57
    s_cbranch_vccnz k2_tramp_98
k2_ret_99:
    v_mfma_f32_16x16x32_bf16 v[12:15], v[60:63], v[208:211], v[12:15]
    v_exp_f32 v232, v132
    v_mfma_f32_16x16x32_bf16 v[48:51], v[60:63], v[212:215], v[48:51]
    s_mov_b32 m0, s35
    ds_read_b128 a[208:211], v3 offset:4096
    v_mfma_f32_16x16x32_bf16 v[248:251], v[60:63], v[216:219], v[248:251]
    s_add_u32 s53, s53, 8192
    buffer_load_dwordx4 v1, s[20:23], s33 offen offset:0 sc1 lds
    v_mfma_f32_16x16x32_bf16 v[252:255], v[60:63], v[220:223], v[252:255]
    s_waitcnt lgkmcnt(3)
    v_exp_f32 v233, v133
    v_mfma_f32_16x16x32_bf16 a[12:15], a[192:195], v[220:223], a[12:15]
    s_sub_u32 s40, s36, s38
    s_sub_u32 s40, s40, 64
    v_exp_f32 v234, v134
    v_mfma_f32_16x16x32_bf16 a[8:11], a[192:195], v[216:219], a[8:11]
    s_and_b32 s53, s53, 0xffff
    ds_read_b128 a[212:215], v3 offset:5120
    v_subrev_u32 v6, s40, v4
    v_mfma_f32_16x16x32_bf16 a[4:7], a[192:195], v[212:215], a[4:7]
    v_cvt_pk_bf16_f32 v196, v232, v233
    v_cmp_gt_i32 s[44:45], 0, v6
    v_mfma_f32_16x16x32_bf16 a[0:3], a[192:195], v[208:211], a[0:3]
    v_exp_f32 v235, v135
    v_mfma_f32_16x16x32_bf16 a[16:19], a[196:199], v[208:211], a[16:19]
    ds_read_b128 a[216:219], v3 offset:6144
    v_cmp_gt_i32 s[46:47], 1, v6
    v_mfma_f32_16x16x32_bf16 a[20:23], a[196:199], v[212:215], a[20:23]
    v_exp_f32 v236, v148
    v_mfma_f32_16x16x32_bf16 a[24:27], a[196:199], v[216:219], a[24:27]
    v_cvt_pk_bf16_f32 v197, v234, v235
    v_cmp_gt_i32 s[48:49], 2, v6
    v_mfma_f32_16x16x32_bf16 a[28:31], a[196:199], v[220:223], a[28:31]
    s_waitcnt lgkmcnt(3)
    v_cmp_gt_i32 s[50:51], 3, v6
    v_mfma_f32_16x16x32_bf16 a[44:47], a[200:203], v[220:223], a[44:47]
    v_exp_f32 v237, v149
    v_mfma_f32_16x16x32_bf16 a[40:43], a[200:203], v[216:219], a[40:43]
    s_add_u32 s35, s35, 0x4000
    ds_read_b128 a[220:223], v3 offset:7168
    v_cndmask_b32 v20, v9, v5, s[44:45]
    v_mfma_f32_16x16x32_bf16 a[36:39], a[200:203], v[212:215], a[36:39]
    v_exp_f32 v238, v150
    v_mfma_f32_16x16x32_bf16 a[32:35], a[200:203], v[208:211], a[32:35]
    v_cvt_pk_bf16_f32 v198, v236, v237
    v_cndmask_b32 v21, v9, v5, s[46:47]
    v_mfma_f32_16x16x32_bf16 a[48:51], a[204:207], v[208:211], a[48:51]
    buffer_load_dwordx4 v1, s[20:23], s33 offen offset:1024 sc1 lds
    ds_read_b128 a[128:131], v2 offset:0
    v_mfma_f32_16x16x32_bf16 a[52:55], a[204:207], v[212:215], a[52:55]
    v_add_u32 v3, s53, v56
    v_cndmask_b32 v22, v9, v5, s[48:49]
    v_mfma_f32_16x16x32_bf16 a[56:59], a[204:207], v[216:219], a[56:59]
    v_exp_f32 v239, v151
    v_mfma_f32_16x16x32_bf16 a[60:63], a[204:207], v[220:223], a[60:63]
    s_waitcnt lgkmcnt(3)
    v_or3_b32 v57, v196, v197, v198
    v_cndmask_b32 v23, v9, v5, s[50:51]
    v_mfma_f32_16x16x32_bf16 a[76:79], a[208:211], v[220:223], a[76:79]
    v_exp_f32 v240, v136
    v_mfma_f32_16x16x32_bf16 a[72:75], a[208:211], v[216:219], a[72:75]
    v_cvt_pk_bf16_f32 v199, v238, v239
    v_cmp_gt_i32 s[44:45], 16, v6
    v_mfma_f32_16x16x32_bf16 a[68:71], a[208:211], v[212:215], a[68:71]
    ds_read_b128 a[132:135], v2 offset:1024
    v_cmp_gt_i32 s[46:47], 17, v6
    v_mfma_f32_16x16x32_bf16 a[64:67], a[208:211], v[208:211], a[64:67]
    v_exp_f32 v241, v137
    v_mfma_f32_16x16x32_bf16 a[80:83], a[212:215], v[208:211], a[80:83]
    ds_read_b128 a[136:139], v2 offset:2048
    v_cmp_gt_i32 s[48:49], 18, v6
    v_mfma_f32_16x16x32_bf16 a[84:87], a[212:215], v[212:215], a[84:87]
    v_exp_f32 v242, v138
    v_mfma_f32_16x16x32_bf16 a[88:91], a[212:215], v[216:219], a[88:91]
    v_cvt_pk_bf16_f32 v200, v240, v241
    v_cmp_gt_i32 s[50:51], 19, v6
    v_mfma_f32_16x16x32_bf16 a[92:95], a[212:215], v[220:223], a[92:95]
    s_waitcnt lgkmcnt(3)
    v_exp_f32 v243, v139
    v_mfma_f32_16x16x32_bf16 a[108:111], a[216:219], v[220:223], a[108:111]
    s_and_b32 s35, s35, 0xffff
    ds_read_b128 a[140:143], v2 offset:3072
    v_or3_b32 v57, v57, v199, v200
    v_mfma_f32_16x16x32_bf16 a[104:107], a[216:219], v[216:219], a[104:107]
    v_cndmask_b32 v36, v9, v5, s[44:45]
    v_cndmask_b32 v37, v9, v5, s[46:47]
    v_mfma_f32_16x16x32_bf16 a[100:103], a[216:219], v[212:215], a[100:103]
    v_exp_f32 v244, v152
    v_mfma_f32_16x16x32_bf16 a[96:99], a[216:219], v[208:211], a[96:99]
    ds_read_b128 a[144:147], v2 offset:4096
    v_cvt_pk_bf16_f32 v201, v242, v243
    v_mfma_f32_16x16x32_bf16 a[112:115], a[220:223], v[208:211], a[112:115]
    buffer_load_dwordx4 v1, s[20:23], s33 offen offset:2048 sc1 lds
    ds_read_b128 a[148:151], v2 offset:5120
    v_mfma_f32_16x16x32_bf16 a[116:119], a[220:223], v[212:215], a[116:119]
    v_cndmask_b32 v38, v9, v5, s[48:49]
    v_cndmask_b32 v39, v9, v5, s[50:51]
    v_mfma_f32_16x16x32_bf16 a[120:123], a[220:223], v[216:219], a[120:123]
    s_or_b32 s35, s35, 0x10000
    v_exp_f32 v245, v153
    v_mfma_f32_16x16x32_bf16 a[124:127], a[220:223], v[220:223], a[124:127]
    s_waitcnt lgkmcnt(4)
    v_exp_f32 v246, v154
    v_mfma_f32_16x16x32_bf16 v[164:167], a[128:131], v[80:83], v[20:23]
    ds_read_b128 a[152:155], v2 offset:6144
    v_cvt_pk_bf16_f32 v202, v244, v245
    v_mfma_f32_16x16x32_bf16 v[164:167], a[132:135], v[84:87], v[164:167]
    s_waitcnt lgkmcnt(3)
    v_exp_f32 v247, v155
    v_mfma_f32_16x16x32_bf16 v[164:167], a[136:139], v[88:91], v[164:167]
    v_or3_b32 v57, v57, v201, v202
    v_cvt_pk_bf16_f32 v203, v246, v247
    v_mfma_f32_16x16x32_bf16 v[164:167], a[140:143], v[92:95], v[164:167]
    s_add_u32 s36, s36, 32
    v_exp_f32 v232, v140
    v_mfma_f32_16x16x32_bf16 v[168:171], a[140:143], v[108:111], v[24:27]
    ds_read_b128 a[156:159], v2 offset:7168
    v_mfma_f32_16x16x32_bf16 v[168:171], a[136:139], v[104:107], v[168:171]
    v_exp_f32 v233, v141
    v_mfma_f32_16x16x32_bf16 v[168:171], a[132:135], v[100:103], v[168:171]
    s_add_u32 s52, s52, 8192
    v_exp_f32 v234, v142
    v_mfma_f32_16x16x32_bf16 v[168:171], a[128:131], v[96:99], v[168:171]
    ds_read_b128 a[192:195], v3 offset:0
    v_cvt_pk_bf16_f32 v204, v232, v233
    v_mfma_f32_16x16x32_bf16 v[172:175], a[128:131], v[112:115], v[28:31]
    s_and_b32 s52, s52, 0xffff
    v_add_u32 v2, s52, v1
    v_or3_b32 v57, v57, v203, v204
    v_mfma_f32_16x16x32_bf16 v[172:175], a[132:135], v[116:119], v[172:175]
    buffer_load_dwordx4 v1, s[20:23], s33 offen offset:3072 sc1 lds
    s_add_u32 s33, s33, 0x80000
    v_mfma_f32_16x16x32_bf16 v[172:175], a[136:139], v[120:123], v[172:175]
    v_exp_f32 v235, v143
    v_mfma_f32_16x16x32_bf16 v[172:175], a[140:143], v[124:127], v[172:175]
    s_waitcnt lgkmcnt(3)
    ds_read_b128 a[196:199], v3 offset:1024
    s_waitcnt lgkmcnt(2)
    v_mfma_f32_16x16x32_bf16 v[188:191], a[156:159], v[124:127], v[44:47]
    v_exp_f32 v236, v156
    v_mfma_f32_16x16x32_bf16 v[188:191], a[152:155], v[120:123], v[188:191]
    v_cvt_pk_bf16_f32 v205, v234, v235
    v_mfma_f32_16x16x32_bf16 v[188:191], a[148:151], v[116:119], v[188:191]
    v_exp_f32 v237, v157
    v_mfma_f32_16x16x32_bf16 v[188:191], a[144:147], v[112:115], v[188:191]
    ds_read_b128 a[200:203], v3 offset:2048
    v_cvt_pk_bf16_f32 v206, v236, v237
    v_mfma_f32_16x16x32_bf16 v[184:187], a[144:147], v[96:99], v[40:43]
    v_exp_f32 v238, v158
    v_mfma_f32_16x16x32_bf16 v[184:187], a[148:151], v[100:103], v[184:187]
    v_exp_f32 v239, v159
    v_mfma_f32_16x16x32_bf16 v[184:187], a[152:155], v[104:107], v[184:187]
    ds_read_b128 a[204:207], v3 offset:3072
    v_or3_b32 v57, v57, v205, v206
    v_mfma_f32_16x16x32_bf16 v[184:187], a[156:159], v[108:111], v[184:187]
    v_cvt_pk_bf16_f32 v207, v238, v239
    v_mfma_f32_16x16x32_bf16 v[180:183], a[156:159], v[92:95], v[36:39]
    v_mfma_f32_16x16x32_bf16 v[180:183], a[152:155], v[88:91], v[180:183]
    v_bitop3_b32 v57, v57, v207, s37 bitop3:0xa8
    v_cmp_ne_u32 vcc, 0, v57
    v_mfma_f32_16x16x32_bf16 v[180:183], a[148:151], v[84:87], v[180:183]
    v_mfma_f32_16x16x32_bf16 v[180:183], a[144:147], v[80:83], v[180:183]
    s_waitcnt vmcnt(13)
    s_barrier
    s_cbranch_vccnz k2_tramp_100
k2_ret_101:
    v_mfma_f32_16x16x32_bf16 v[48:51], v[60:63], v[196:199], v[48:51]
    ds_read_b128 a[208:211], v3 offset:4096
    ds_read_b128 a[212:215], v3 offset:5120
    v_mfma_f32_16x16x32_bf16 v[248:251], v[60:63], v[200:203], v[248:251]
    s_mov_b32 m0, s34
    v_exp_f32 v232, v164
    v_mfma_f32_16x16x32_bf16 v[252:255], v[60:63], v[204:207], v[252:255]
    s_waitcnt lgkmcnt(4)
    buffer_load_dwordx4 v1, s[16:19], s32 offen offset:0 sc1 lds
    ds_read_b128 a[216:219], v3 offset:6144
    v_mfma_f32_16x16x32_bf16 a[12:15], a[192:195], v[204:207], a[12:15]
    s_add_u32 s53, s53, 8192
    v_exp_f32 v233, v165
    v_mfma_f32_16x16x32_bf16 a[8:11], a[192:195], v[200:203], a[8:11]
    s_and_b32 s53, s53, 0xffff
    v_mov_b32 v16, v10
    v_mov_b32 v17, v10
    v_mfma_f32_16x16x32_bf16 a[4:7], a[192:195], v[196:199], a[4:7]
    s_add_u32 s34, s34, 0x4000
    v_exp_f32 v234, v166
    v_mfma_f32_16x16x32_bf16 a[20:23], a[196:199], v[196:199], a[20:23]
    ds_read_b128 a[220:223], v3 offset:7168
    v_cvt_pk_bf16_f32 v212, v232, v233
    v_mfma_f32_16x16x32_bf16 a[24:27], a[196:199], v[200:203], a[24:27]
    v_mov_b32 v18, v10
    v_mov_b32 v19, v10
    v_mfma_f32_16x16x32_bf16 a[28:31], a[196:199], v[204:207], a[28:31]
    s_waitcnt lgkmcnt(4)
    v_exp_f32 v235, v167
    v_mfma_f32_16x16x32_bf16 a[44:47], a[200:203], v[204:207], a[44:47]
    buffer_load_dwordx4 v1, s[16:19], s32 offen offset:1024 sc1 lds
    ds_read_b128 a[128:131], v2 offset:0
    v_mfma_f32_16x16x32_bf16 a[40:43], a[200:203], v[200:203], a[40:43]
    v_mov_b32 v20, v11
    v_add_u32 v3, s53, v56
    v_mfma_f32_16x16x32_bf16 a[36:39], a[200:203], v[196:199], a[36:39]
    s_and_b32 s34, s34, 0xffff
    v_mov_b32 v21, v11
    v_mov_b32 v22, v11
    v_mfma_f32_16x16x32_bf16 a[52:55], a[204:207], v[196:199], a[52:55]
    v_exp_f32 v236, v180
    v_mfma_f32_16x16x32_bf16 a[56:59], a[204:207], v[200:203], a[56:59]
    ds_read_b128 a[132:135], v2 offset:1024
    v_cvt_pk_bf16_f32 v213, v234, v235
    v_mfma_f32_16x16x32_bf16 a[60:63], a[204:207], v[204:207], a[60:63]
    s_waitcnt lgkmcnt(4)
    v_mov_b32 v23, v11
    v_mov_b32 v32, v10
    v_mfma_f32_16x16x32_bf16 a[76:79], a[208:211], v[204:207], a[76:79]
    v_exp_f32 v237, v181
    v_mfma_f32_16x16x32_bf16 a[72:75], a[208:211], v[200:203], a[72:75]
    ds_read_b128 a[136:139], v2 offset:2048
    v_mov_b32 v33, v10
    v_mfma_f32_16x16x32_bf16 a[68:71], a[208:211], v[196:199], a[68:71]
    buffer_load_dwordx4 v1, s[16:19], s32 offen offset:2048 sc1 lds
    v_mov_b32 v34, v10
    v_mfma_f32_16x16x32_bf16 a[84:87], a[212:215], v[196:199], a[84:87]
    v_exp_f32 v238, v182
    v_mfma_f32_16x16x32_bf16 a[88:91], a[212:215], v[200:203], a[88:91]
    ds_read_b128 a[140:143], v2 offset:3072
    v_cvt_pk_bf16_f32 v214, v236, v237
    v_mfma_f32_16x16x32_bf16 a[92:95], a[212:215], v[204:207], a[92:95]
    s_waitcnt lgkmcnt(4)
    v_mov_b32 v35, v10
    v_mov_b32 v36, v11
    v_mfma_f32_16x16x32_bf16 a[108:111], a[216:219], v[204:207], a[108:111]
    ds_read_b128 a[144:147], v2 offset:4096
    v_exp_f32 v239, v183
    v_mfma_f32_16x16x32_bf16 a[104:107], a[216:219], v[200:203], a[104:107]
    v_mov_b32 v37, v11
    v_or3_b32 v57, v212, v213, v214
    v_mov_b32 v38, v11
    v_mov_b32 v39, v11
    v_mfma_f32_16x16x32_bf16 a[100:103], a[216:219], v[196:199], a[100:103]
    buffer_load_dwordx4 v1, s[16:19], s32 offen offset:3072 sc1 lds
    ds_read_b128 a[148:151], v2 offset:5120
    v_mfma_f32_16x16x32_bf16 a[116:119], a[220:223], v[196:199], a[116:119]
    s_add_u32 s32, s32, 0x80000
    s_cmp_ge_u32 s36, s43
    s_cbranch_scc1 k2_prep_102
k2_prepret_103:
    v_mfma_f32_16x16x32_bf16 a[120:123], a[220:223], v[200:203], a[120:123]
    s_waitcnt vmcnt(9)
    v_exp_f32 v240, v168
    v_mfma_f32_16x16x32_bf16 a[124:127], a[220:223], v[204:207], a[124:127]
    s_waitcnt lgkmcnt(4)
    ds_read_b128 a[152:155], v2 offset:6144
    v_cvt_pk_bf16_f32 v215, v238, v239
    v_mfma_f32_16x16x32_bf16 v[128:131], a[128:131], v[96:99], v[16:19]
    v_exp_f32 v241, v169
    v_mfma_f32_16x16x32_bf16 v[128:131], a[132:135], v[100:103], v[128:131]
    s_waitcnt lgkmcnt(3)
    ds_read_b128 a[156:159], v2 offset:7168
    v_exp_f32 v242, v170
    v_mfma_f32_16x16x32_bf16 v[128:131], a[136:139], v[104:107], v[128:131]
    ds_read_b128 a[160:163], v2 offset:8192
    v_cvt_pk_bf16_f32 v216, v240, v241
    v_mfma_f32_16x16x32_bf16 v[128:131], a[140:143], v[108:111], v[128:131]
    s_add_u32 s36, s36, 64
    buffer_store_dwordx4 a[224:227], v229, s[8:11], s58 offen offset:0 sc1
    v_exp_f32 v243, v171
    v_mfma_f32_16x16x32_bf16 v[132:135], a[140:143], v[124:127], v[20:23]
    ds_read_b128 a[164:167], v2 offset:9216
    v_or3_b32 v57, v57, v215, v216
    v_mfma_f32_16x16x32_bf16 v[132:135], a[136:139], v[120:123], v[132:135]
    v_exp_f32 v244, v184
    v_mfma_f32_16x16x32_bf16 v[132:135], a[132:135], v[116:119], v[132:135]
    s_add_u32 s52, s52, 16384
    ds_read_b128 a[168:171], v2 offset:10240
    v_cvt_pk_bf16_f32 v217, v242, v243
    v_mfma_f32_16x16x32_bf16 v[132:135], a[128:131], v[112:115], v[132:135]
    s_waitcnt lgkmcnt(5)
    v_exp_f32 v245, v185
    v_mfma_f32_16x16x32_bf16 v[148:151], a[144:147], v[112:115], v[36:39]
    s_and_b32 s52, s52, 0xffff
    ds_read_b128 a[172:175], v2 offset:11264
    ds_read_b128 a[176:179], v2 offset:12288
    v_mfma_f32_16x16x32_bf16 v[148:151], a[148:151], v[116:119], v[148:151]
    s_waitcnt lgkmcnt(5)
    v_exp_f32 v246, v186
    v_mfma_f32_16x16x32_bf16 v[148:151], a[152:155], v[120:123], v[148:151]
    ds_read_b128 a[180:183], v2 offset:13312
    v_cvt_pk_bf16_f32 v218, v244, v245
    v_mfma_f32_16x16x32_bf16 v[148:151], a[156:159], v[124:127], v[148:151]
    v_exp_f32 v247, v187
    v_mfma_f32_16x16x32_bf16 v[144:147], a[156:159], v[108:111], v[32:35]
    ds_read_b128 a[184:187], v2 offset:14336
    v_or3_b32 v57, v57, v217, v218
    v_mfma_f32_16x16x32_bf16 v[144:147], a[152:155], v[104:107], v[144:147]
    v_exp_f32 v232, v172
    v_mfma_f32_16x16x32_bf16 v[144:147], a[148:151], v[100:103], v[144:147]
    ds_read_b128 a[188:191], v2 offset:15360
    v_cvt_pk_bf16_f32 v219, v246, v247
    v_mfma_f32_16x16x32_bf16 v[144:147], a[144:147], v[96:99], v[144:147]
    s_waitcnt lgkmcnt(6)
    v_exp_f32 v233, v173
    v_mfma_f32_16x16x32_bf16 v[136:139], a[160:163], v[96:99], v[24:27]
    buffer_store_dwordx4 a[228:231], v229, s[8:11], s58 offen offset:256 sc1
    ds_read_b128 a[192:195], v3 offset:0
    v_mfma_f32_16x16x32_bf16 v[136:139], a[164:167], v[100:103], v[136:139]
    s_waitcnt lgkmcnt(5)
    v_add_u32 v2, s52, v1
    v_cvt_pk_bf16_f32 v220, v232, v233
    v_mfma_f32_16x16x32_bf16 v[136:139], a[168:171], v[104:107], v[136:139]
    v_exp_f32 v234, v174
    v_mfma_f32_16x16x32_bf16 v[136:139], a[172:175], v[108:111], v[136:139]
    v_exp_f32 v235, v175
    v_mfma_f32_16x16x32_bf16 v[140:143], a[172:175], v[124:127], v[28:31]
    ds_read_b128 a[196:199], v3 offset:1024
    v_or3_b32 v57, v57, v219, v220
    v_mfma_f32_16x16x32_bf16 v[140:143], a[168:171], v[120:123], v[140:143]
    v_exp_f32 v236, v188
    v_mfma_f32_16x16x32_bf16 v[140:143], a[164:167], v[116:119], v[140:143]
    ds_read_b128 a[200:203], v3 offset:2048
    v_cvt_pk_bf16_f32 v221, v234, v235
    v_mfma_f32_16x16x32_bf16 v[140:143], a[160:163], v[112:115], v[140:143]
    s_waitcnt lgkmcnt(5)
    v_exp_f32 v237, v189
    v_mfma_f32_16x16x32_bf16 v[156:159], a[176:179], v[112:115], v[44:47]
    v_exp_f32 v238, v190
    v_mfma_f32_16x16x32_bf16 v[156:159], a[180:183], v[116:119], v[156:159]
    s_waitcnt lgkmcnt(3)
    v_cvt_pk_bf16_f32 v222, v236, v237
    v_or3_b32 v57, v57, v221, v222
    v_mfma_f32_16x16x32_bf16 v[156:159], a[184:187], v[120:123], v[156:159]
    v_exp_f32 v239, v191
    v_mfma_f32_16x16x32_bf16 v[156:159], a[188:191], v[124:127], v[156:159]
    ds_read_b128 a[204:207], v3 offset:3072
    v_cvt_pk_bf16_f32 v223, v238, v239
    v_mfma_f32_16x16x32_bf16 v[152:155], a[188:191], v[108:111], v[40:43]
    v_mfma_f32_16x16x32_bf16 v[152:155], a[184:187], v[104:107], v[152:155]
    v_bitop3_b32 v57, v57, v223, s37 bitop3:0xa8
    v_cmp_ne_u32 vcc, 0, v57
    v_mfma_f32_16x16x32_bf16 v[152:155], a[180:183], v[100:103], v[152:155]
    v_mfma_f32_16x16x32_bf16 v[152:155], a[176:179], v[96:99], v[152:155]
    s_cbranch_vccnz k2_tramp_104
k2_ret_105:
    v_mfma_f32_16x16x32_bf16 v[48:51], v[60:63], v[212:215], v[48:51]
    ds_read_b128 a[208:211], v3 offset:4096
    ds_read_b128 a[212:215], v3 offset:5120
    v_mfma_f32_16x16x32_bf16 v[248:251], v[60:63], v[216:219], v[248:251]
    s_mov_b32 m0, s35
    v_exp_f32 v232, v128
    v_mfma_f32_16x16x32_bf16 v[252:255], v[60:63], v[220:223], v[252:255]
    s_waitcnt lgkmcnt(4)
    ds_read_b128 a[216:219], v3 offset:6144
    v_exp_f32 v233, v129
    v_mfma_f32_16x16x32_bf16 a[12:15], a[192:195], v[220:223], a[12:15]
    s_add_u32 s53, s53, 8192
    buffer_load_dwordx4 v1, s[20:23], s33 offen offset:0 sc1 lds
    v_mfma_f32_16x16x32_bf16 a[8:11], a[192:195], v[216:219], a[8:11]
    s_and_b32 s53, s53, 0xffff
    v_exp_f32 v234, v130
    v_cvt_pk_bf16_f32 v192, v232, v233
    v_mfma_f32_16x16x32_bf16 a[4:7], a[192:195], v[212:215], a[4:7]
    ds_read_b128 a[220:223], v3 offset:7168
    v_mfma_f32_16x16x32_bf16 a[20:23], a[196:199], v[212:215], a[20:23]
    s_add_u32 s35, s35, 0x4000
    v_exp_f32 v235, v131
    v_mfma_f32_16x16x32_bf16 a[24:27], a[196:199], v[216:219], a[24:27]
    v_exp_f32 v236, v144
    v_cvt_pk_bf16_f32 v193, v234, v235
    v_mfma_f32_16x16x32_bf16 a[28:31], a[196:199], v[220:223], a[28:31]
    s_waitcnt lgkmcnt(4)
    buffer_load_dwordx4 v1, s[20:23], s33 offen offset:1024 sc1 lds
    ds_read_b128 a[128:131], v2 offset:0
    v_mfma_f32_16x16x32_bf16 a[44:47], a[200:203], v[220:223], a[44:47]
    v_add_u32 v3, s53, v56
    v_exp_f32 v237, v145
    v_mfma_f32_16x16x32_bf16 a[40:43], a[200:203], v[216:219], a[40:43]
    ds_read_b128 a[132:135], v2 offset:1024
    v_cvt_pk_bf16_f32 v194, v236, v237
    v_mfma_f32_16x16x32_bf16 a[36:39], a[200:203], v[212:215], a[36:39]
    ds_read_b128 a[136:139], v2 offset:2048
    v_exp_f32 v238, v146
    v_mfma_f32_16x16x32_bf16 a[52:55], a[204:207], v[212:215], a[52:55]
    s_and_b32 s35, s35, 0xffff
    v_exp_f32 v239, v147
    v_mfma_f32_16x16x32_bf16 a[56:59], a[204:207], v[216:219], a[56:59]
    ds_read_b128 a[140:143], v2 offset:3072
    v_or3_b32 v57, v192, v193, v194
    v_mfma_f32_16x16x32_bf16 a[60:63], a[204:207], v[220:223], a[60:63]
    s_waitcnt lgkmcnt(6)
    v_exp_f32 v240, v132
    v_mfma_f32_16x16x32_bf16 a[76:79], a[208:211], v[220:223], a[76:79]
    s_or_b32 s35, s35, 0x10000
    buffer_load_dwordx4 v1, s[20:23], s33 offen offset:2048 sc1 lds
    ds_read_b128 a[144:147], v2 offset:4096
    v_mfma_f32_16x16x32_bf16 a[72:75], a[208:211], v[216:219], a[72:75]
    v_cvt_pk_bf16_f32 v195, v238, v239
    v_exp_f32 v241, v133
    v_mfma_f32_16x16x32_bf16 a[68:71], a[208:211], v[212:215], a[68:71]
    v_exp_f32 v242, v134
    v_mfma_f32_16x16x32_bf16 a[84:87], a[212:215], v[212:215], a[84:87]
    ds_read_b128 a[148:151], v2 offset:5120
    v_cvt_pk_bf16_f32 v196, v240, v241
    v_mfma_f32_16x16x32_bf16 a[88:91], a[212:215], v[216:219], a[88:91]
    v_exp_f32 v243, v135
    v_mfma_f32_16x16x32_bf16 a[92:95], a[212:215], v[220:223], a[92:95]
    s_waitcnt lgkmcnt(6)
    ds_read_b128 a[152:155], v2 offset:6144
    v_or3_b32 v57, v57, v195, v196
    v_cvt_pk_bf16_f32 v197, v242, v243
    v_mfma_f32_16x16x32_bf16 a[108:111], a[216:219], v[220:223], a[108:111]
    buffer_load_dwordx4 v1, s[20:23], s33 offen offset:3072 sc1 lds
    ds_read_b128 a[156:159], v2 offset:7168
    v_mfma_f32_16x16x32_bf16 a[104:107], a[216:219], v[216:219], a[104:107]
    s_add_u32 s33, s33, 0x80000
    v_exp_f32 v244, v148
    v_mfma_f32_16x16x32_bf16 a[100:103], a[216:219], v[212:215], a[100:103]
    v_exp_f32 v245, v149
    v_mfma_f32_16x16x32_bf16 a[116:119], a[220:223], v[212:215], a[116:119]
    ds_read_b128 a[160:163], v2 offset:8192
    s_cmp_ge_u32 s36, s43
    s_cbranch_scc1 k2_prep_106
k2_prepret_107:
    v_mfma_f32_16x16x32_bf16 a[120:123], a[220:223], v[216:219], a[120:123]
    v_exp_f32 v246, v150
    v_mfma_f32_16x16x32_bf16 a[124:127], a[220:223], v[220:223], a[124:127]
    s_waitcnt lgkmcnt(7)
    ds_read_b128 a[164:167], v2 offset:9216
    v_cvt_pk_bf16_f32 v198, v244, v245
    v_mfma_f32_16x16x32_bf16 v[160:163], a[128:131], v[96:99], v[16:19]
    s_waitcnt vmcnt(12)
    s_barrier
    v_exp_f32 v247, v151
    v_mfma_f32_16x16x32_bf16 v[160:163], a[132:135], v[100:103], v[160:163]
    s_waitcnt lgkmcnt(6)
    v_or3_b32 v57, v57, v197, v198
    v_cvt_pk_bf16_f32 v199, v246, v247
    v_mfma_f32_16x16x32_bf16 v[160:163], a[136:139], v[104:107], v[160:163]
    s_mov_b32 m0, s34
    ds_read_b128 a[168:171], v2 offset:10240
    v_exp_f32 v232, v136
    v_mfma_f32_16x16x32_bf16 v[160:163], a[140:143], v[108:111], v[160:163]
    s_add_u32 s36, s36, 64
    buffer_load_dwordx4 v1, s[16:19], s32 offen offset:0 sc1 lds
    ds_read_b128 a[172:175], v2 offset:11264
    v_mfma_f32_16x16x32_bf16 v[164:167], a[140:143], v[124:127], v[20:23]
    v_exp_f32 v233, v137
    v_mfma_f32_16x16x32_bf16 v[164:167], a[136:139], v[120:123], v[164:167]
    v_exp_f32 v234, v138
    v_mfma_f32_16x16x32_bf16 v[164:167], a[132:135], v[116:119], v[164:167]
    s_add_u32 s52, s52, 16384
    ds_read_b128 a[176:179], v2 offset:12288
    v_cvt_pk_bf16_f32 v200, v232, v233
    v_mfma_f32_16x16x32_bf16 v[164:167], a[128:131], v[112:115], v[164:167]
    s_waitcnt lgkmcnt(7)
    v_exp_f32 v235, v139
    v_or3_b32 v57, v57, v199, v200
    v_mfma_f32_16x16x32_bf16 v[180:183], a[144:147], v[112:115], v[36:39]
    s_add_u32 s34, s34, 0x4000
    ds_read_b128 a[180:183], v2 offset:13312
    v_cvt_pk_bf16_f32 v201, v234, v235
    v_mfma_f32_16x16x32_bf16 v[180:183], a[148:151], v[116:119], v[180:183]
    s_waitcnt lgkmcnt(6)
    v_exp_f32 v236, v152
    v_mfma_f32_16x16x32_bf16 v[180:183], a[152:155], v[120:123], v[180:183]
    s_and_b32 s52, s52, 0xffff
    buffer_load_dwordx4 v1, s[16:19], s32 offen offset:1024 sc1 lds
    ds_read_b128 a[184:187], v2 offset:14336
    v_mfma_f32_16x16x32_bf16 v[180:183], a[156:159], v[124:127], v[180:183]
    ds_read_b128 a[188:191], v2 offset:15360
    v_exp_f32 v237, v153
    v_mfma_f32_16x16x32_bf16 v[176:179], a[156:159], v[108:111], v[32:35]
    v_exp_f32 v238, v154
    v_mfma_f32_16x16x32_bf16 v[176:179], a[152:155], v[104:107], v[176:179]
    v_cvt_pk_bf16_f32 v202, v236, v237
    v_or3_b32 v57, v57, v201, v202
    v_mfma_f32_16x16x32_bf16 v[176:179], a[148:151], v[100:103], v[176:179]
    s_and_b32 s34, s34, 0xffff
    v_exp_f32 v239, v155
    v_mfma_f32_16x16x32_bf16 v[176:179], a[144:147], v[96:99], v[176:179]
    s_waitcnt lgkmcnt(6)
    v_add_u32 v2, s52, v1
    v_cvt_pk_bf16_f32 v203, v238, v239
    v_mfma_f32_16x16x32_bf16 v[168:171], a[160:163], v[96:99], v[24:27]
    ds_read_b128 a[192:195], v3 offset:0
    v_exp_f32 v240, v140
    v_mfma_f32_16x16x32_bf16 v[168:171], a[164:167], v[100:103], v[168:171]
    s_waitcnt lgkmcnt(5)
    v_exp_f32 v241, v141
    v_mfma_f32_16x16x32_bf16 v[168:171], a[168:171], v[104:107], v[168:171]
    buffer_load_dwordx4 v1, s[16:19], s32 offen offset:2048 sc1 lds
    ds_read_b128 a[196:199], v3 offset:8192
    v_mfma_f32_16x16x32_bf16 v[168:171], a[172:175], v[108:111], v[168:171]
    v_exp_f32 v242, v142
    v_mfma_f32_16x16x32_bf16 v[172:175], a[172:175], v[124:127], v[28:31]
    ds_read_b128 a[200:203], v3 offset:1024
    v_cvt_pk_bf16_f32 v204, v240, v241
    v_or3_b32 v57, v57, v203, v204
    v_mfma_f32_16x16x32_bf16 v[172:175], a[168:171], v[120:123], v[172:175]
    v_exp_f32 v243, v143
    v_mfma_f32_16x16x32_bf16 v[172:175], a[164:167], v[116:119], v[172:175]
    ds_read_b128 a[204:207], v3 offset:9216
    v_cvt_pk_bf16_f32 v205, v242, v243
    v_mfma_f32_16x16x32_bf16 v[172:175], a[160:163], v[112:115], v[172:175]
    s_waitcnt lgkmcnt(6)
    v_exp_f32 v244, v156
    v_mfma_f32_16x16x32_bf16 v[188:191], a[176:179], v[112:115], v[44:47]
    v_exp_f32 v245, v157
    v_mfma_f32_16x16x32_bf16 v[188:191], a[180:183], v[116:119], v[188:191]
    s_waitcnt lgkmcnt(4)
    buffer_load_dwordx4 v1, s[16:19], s32 offen offset:3072 sc1 lds
    ds_read_b128 a[208:211], v3 offset:2048
    ds_read_b128 a[212:215], v3 offset:10240
    v_mfma_f32_16x16x32_bf16 v[188:191], a[184:187], v[120:123], v[188:191]
    s_add_u32 s32, s32, 0x80000
    v_exp_f32 v246, v158
    v_mfma_f32_16x16x32_bf16 v[188:191], a[188:191], v[124:127], v[188:191]
    v_cvt_pk_bf16_f32 v206, v244, v245
    v_or3_b32 v57, v57, v205, v206
    v_mfma_f32_16x16x32_bf16 v[184:187], a[188:191], v[108:111], v[40:43]
    v_exp_f32 v247, v159
    v_mfma_f32_16x16x32_bf16 v[184:187], a[184:187], v[104:107], v[184:187]
    ds_read_b128 a[216:219], v3 offset:3072
    ds_read_b128 a[220:223], v3 offset:11264
    v_cvt_pk_bf16_f32 v207, v246, v247
    v_mfma_f32_16x16x32_bf16 v[184:187], a[180:183], v[100:103], v[184:187]
    v_bitop3_b32 v57, v57, v207, s37 bitop3:0xa8
    v_cmp_ne_u32 vcc, 0, v57
    v_mfma_f32_16x16x32_bf16 v[184:187], a[176:179], v[96:99], v[184:187]
    s_cbranch_vccnz k2_tramp_108
k2_ret_109:
    s_load_dwordx2 s[4:5], s[0:1], 40
    s_add_u32 s24, s6, 0x3000000
    s_addc_u32 s25, s7, 0
    s_and_b32 s25, s25, 0xffff
    s_mov_b32 s26, 0x1000000
    s_mov_b32 s27, 0x00020000
    s_lshl_b32 s31, s28, 19
    s_lshl_b32 s44, s38, 6
    s_add_u32 s44, s44, s31
    s_add_u32 s45, s44, 131072
    s_add_u32 s46, s44, 262144
    s_add_u32 s47, s44, 393216
    s_add_u32 s48, s44, 4096
    s_add_u32 s49, s44, 135168
    s_add_u32 s50, s44, 266240
    s_add_u32 s51, s44, 397312
    v_mov_b32 v13, v12
    v_mov_b32 v49, v48
    s_nop 1
    v_permlane16_swap_b32 v12, v13
    v_permlane16_swap_b32 v48, v49
    s_nop 1
    v_add_f32 v12, v12, v13
    v_add_f32 v48, v48, v49
    v_mov_b32 v13, v12
    v_mov_b32 v49, v48
    s_nop 1
    v_permlane32_swap_b32 v12, v13
    v_permlane32_swap_b32 v48, v49
    s_nop 1
    v_add_f32 v12, v12, v13
    v_add_f32 v48, v48, v49
    v_rcp_f32 v13, v12
    v_rcp_f32 v49, v48
    v_rcp_f32 v12, v12
    v_rcp_f32 v48, v48
    s_nop 0
    v_accvgpr_read_b32 v68, a0
    v_accvgpr_read_b32 v69, a1
    v_accvgpr_read_b32 v70, a2
    v_accvgpr_read_b32 v71, a3
    v_accvgpr_read_b32 v72, a16
    v_accvgpr_read_b32 v73, a17
    v_accvgpr_read_b32 v74, a18
    v_accvgpr_read_b32 v75, a19
    v_pk_mul_f32 v[68:69], v[68:69], v[12:13]
    v_pk_mul_f32 v[70:71], v[70:71], v[12:13]
    v_pk_mul_f32 v[72:73], v[72:73], v[12:13]
    v_pk_mul_f32 v[74:75], v[74:75], v[12:13]
    v_cvt_pk_bf16_f32 v64, v68, v69
    v_cvt_pk_bf16_f32 v65, v70, v71
    v_cvt_pk_bf16_f32 v66, v72, v73
    v_cvt_pk_bf16_f32 v67, v74, v75
    buffer_store_dwordx4 v[64:67], v1, s[24:27], s44 offen sc1
    v_accvgpr_read_b32 v80, a32
    v_accvgpr_read_b32 v81, a33
    v_accvgpr_read_b32 v82, a34
    v_accvgpr_read_b32 v83, a35
    v_accvgpr_read_b32 v84, a48
    v_accvgpr_read_b32 v85, a49
    v_accvgpr_read_b32 v86, a50
    v_accvgpr_read_b32 v87, a51
    v_pk_mul_f32 v[80:81], v[80:81], v[12:13]
    v_pk_mul_f32 v[82:83], v[82:83], v[12:13]
    v_pk_mul_f32 v[84:85], v[84:85], v[12:13]
    v_pk_mul_f32 v[86:87], v[86:87], v[12:13]
    v_cvt_pk_bf16_f32 v76, v80, v81
    v_cvt_pk_bf16_f32 v77, v82, v83
    v_cvt_pk_bf16_f32 v78, v84, v85
    v_cvt_pk_bf16_f32 v79, v86, v87
    buffer_store_dwordx4 v[76:79], v1, s[24:27], s45 offen sc1
    v_accvgpr_read_b32 v68, a64
    v_accvgpr_read_b32 v69, a65
    v_accvgpr_read_b32 v70, a66
    v_accvgpr_read_b32 v71, a67
    v_accvgpr_read_b32 v72, a80
    v_accvgpr_read_b32 v73, a81
    v_accvgpr_read_b32 v74, a82
    v_accvgpr_read_b32 v75, a83
    v_pk_mul_f32 v[68:69], v[68:69], v[12:13]
    v_pk_mul_f32 v[70:71], v[70:71], v[12:13]
    v_pk_mul_f32 v[72:73], v[72:73], v[12:13]
    v_pk_mul_f32 v[74:75], v[74:75], v[12:13]
    v_cvt_pk_bf16_f32 v64, v68, v69
    v_cvt_pk_bf16_f32 v65, v70, v71
    v_cvt_pk_bf16_f32 v66, v72, v73
    v_cvt_pk_bf16_f32 v67, v74, v75
    buffer_store_dwordx4 v[64:67], v1, s[24:27], s46 offen sc1
    v_accvgpr_read_b32 v80, a96
    v_accvgpr_read_b32 v81, a97
    v_accvgpr_read_b32 v82, a98
    v_accvgpr_read_b32 v83, a99
    v_accvgpr_read_b32 v84, a112
    v_accvgpr_read_b32 v85, a113
    v_accvgpr_read_b32 v86, a114
    v_accvgpr_read_b32 v87, a115
    v_pk_mul_f32 v[80:81], v[80:81], v[12:13]
    v_pk_mul_f32 v[82:83], v[82:83], v[12:13]
    v_pk_mul_f32 v[84:85], v[84:85], v[12:13]
    v_pk_mul_f32 v[86:87], v[86:87], v[12:13]
    v_cvt_pk_bf16_f32 v76, v80, v81
    v_cvt_pk_bf16_f32 v77, v82, v83
    v_cvt_pk_bf16_f32 v78, v84, v85
    v_cvt_pk_bf16_f32 v79, v86, v87
    buffer_store_dwordx4 v[76:79], v1, s[24:27], s47 offen sc1
    v_accvgpr_read_b32 v68, a4
    v_accvgpr_read_b32 v69, a5
    v_accvgpr_read_b32 v70, a6
    v_accvgpr_read_b32 v71, a7
    v_accvgpr_read_b32 v72, a20
    v_accvgpr_read_b32 v73, a21
    v_accvgpr_read_b32 v74, a22
    v_accvgpr_read_b32 v75, a23
    v_pk_mul_f32 v[68:69], v[68:69], v[48:49]
    v_pk_mul_f32 v[70:71], v[70:71], v[48:49]
    v_pk_mul_f32 v[72:73], v[72:73], v[48:49]
    v_pk_mul_f32 v[74:75], v[74:75], v[48:49]
    v_cvt_pk_bf16_f32 v64, v68, v69
    v_cvt_pk_bf16_f32 v65, v70, v71
    v_cvt_pk_bf16_f32 v66, v72, v73
    v_cvt_pk_bf16_f32 v67, v74, v75
    buffer_store_dwordx4 v[64:67], v1, s[24:27], s48 offen sc1
    v_accvgpr_read_b32 v80, a36
    v_accvgpr_read_b32 v81, a37
    v_accvgpr_read_b32 v82, a38
    v_accvgpr_read_b32 v83, a39
    v_accvgpr_read_b32 v84, a52
    v_accvgpr_read_b32 v85, a53
    v_accvgpr_read_b32 v86, a54
    v_accvgpr_read_b32 v87, a55
    v_pk_mul_f32 v[80:81], v[80:81], v[48:49]
    v_pk_mul_f32 v[82:83], v[82:83], v[48:49]
    v_pk_mul_f32 v[84:85], v[84:85], v[48:49]
    v_pk_mul_f32 v[86:87], v[86:87], v[48:49]
    v_cvt_pk_bf16_f32 v76, v80, v81
    v_cvt_pk_bf16_f32 v77, v82, v83
    v_cvt_pk_bf16_f32 v78, v84, v85
    v_cvt_pk_bf16_f32 v79, v86, v87
    buffer_store_dwordx4 v[76:79], v1, s[24:27], s49 offen sc1
    v_accvgpr_read_b32 v68, a68
    v_accvgpr_read_b32 v69, a69
    v_accvgpr_read_b32 v70, a70
    v_accvgpr_read_b32 v71, a71
    v_accvgpr_read_b32 v72, a84
    v_accvgpr_read_b32 v73, a85
    v_accvgpr_read_b32 v74, a86
    v_accvgpr_read_b32 v75, a87
    v_pk_mul_f32 v[68:69], v[68:69], v[48:49]
    v_pk_mul_f32 v[70:71], v[70:71], v[48:49]
    v_pk_mul_f32 v[72:73], v[72:73], v[48:49]
    v_pk_mul_f32 v[74:75], v[74:75], v[48:49]
    v_cvt_pk_bf16_f32 v64, v68, v69
    v_cvt_pk_bf16_f32 v65, v70, v71
    v_cvt_pk_bf16_f32 v66, v72, v73
    v_cvt_pk_bf16_f32 v67, v74, v75
    buffer_store_dwordx4 v[64:67], v1, s[24:27], s50 offen sc1
    v_accvgpr_read_b32 v80, a100
    v_accvgpr_read_b32 v81, a101
    v_accvgpr_read_b32 v82, a102
    v_accvgpr_read_b32 v83, a103
    v_accvgpr_read_b32 v84, a116
    v_accvgpr_read_b32 v85, a117
    v_accvgpr_read_b32 v86, a118
    v_accvgpr_read_b32 v87, a119
    v_pk_mul_f32 v[80:81], v[80:81], v[48:49]
    v_pk_mul_f32 v[82:83], v[82:83], v[48:49]
    v_pk_mul_f32 v[84:85], v[84:85], v[48:49]
    v_pk_mul_f32 v[86:87], v[86:87], v[48:49]
    v_cvt_pk_bf16_f32 v76, v80, v81
    v_cvt_pk_bf16_f32 v77, v82, v83
    v_cvt_pk_bf16_f32 v78, v84, v85
    v_cvt_pk_bf16_f32 v79, v86, v87
    buffer_store_dwordx4 v[76:79], v1, s[24:27], s51 offen sc1
    s_nop 1
    s_lshr_b32 s31, s2, 3
    s_bfe_u32 s56, s2, 0x10002
    s_and_b32 s54, s2, 1
    s_and_b32 s55, s31, 7
    s_lshl_b32 s54, s54, 3
    s_add_u32 s54, s54, s55
    s_and_b32 s55, s2, 2
    s_lshl_b32 s55, s55, 1
    s_lshr_b32 s31, s31, 3
    s_add_u32 s55, s55, s31
    v_lshrrev_b32 v87, 4, v1
    v_lshrrev_b32 v72, 4, v87
    s_lshl_b32 s57, s54, 7
    s_lshl_b32 s31, s30, 5
    s_add_u32 s57, s57, s31
    s_lshl_b32 s31, s57, 6
    v_add_u32 v88, s31, v1
    v_add_u32 v89, 0x20000, v88
    v_bfe_u32 v84, v87, 1, 3
    v_xor_b32 v84, v84, v72
    v_and_b32 v85, 16, v1
    v_lshl_add_u32 v85, v72, 11, v85
    s_lshl_b32 s31, s30, 15
    s_lshl_b32 s58, s55, 8
    s_add_u32 s31, s31, s58
    v_add_u32 v85, s31, v85
    v_xor_b32 v86, 0, v84
    v_lshl_add_u32 v86, v86, 5, v85
    v_add_u32 v90, 0, v86
    v_xor_b32 v86, 4, v84
    v_lshl_add_u32 v86, v86, 5, v85
    v_add_u32 v91, 7168, v86
    v_xor_b32 v86, 0, v84
    v_lshl_add_u32 v86, v86, 5, v85
    v_add_u32 v92, 14336, v86
    v_xor_b32 v86, 4, v84
    v_lshl_add_u32 v86, v86, 5, v85
    v_add_u32 v93, 21504, v86
    v_and_b32 v84, 15, v87
    v_add_u32 v85, s57, v84
    v_lshlrev_b32 v77, 2, v85
    v_lshl_add_u32 v77, v72, 13, v77
    s_lshl_b32 s31, s56, 7
    s_add_u32 s58, s58, s31
    v_lshl_add_u32 v80, v72, 3, s58
    v_lshl_add_u32 v78, v85, 11, v80
    v_add_u32 v79, 0x8000, v78
    v_lshrrev_b32 v85, 2, v84
    v_lshl_add_u32 v85, v72, 2, v85
    v_and_b32 v84, 7, v85
    s_lshl_b32 s31, s56, 2
    v_xor_b32 v84, s31, v84
    v_lshlrev_b32 v85, 8, v85
    v_and_b32 v86, 3, v87
    v_lshl_add_u32 v85, v86, 3, v85
    s_add_u32 s31, s2, 1
    s_and_b32 s31, s31, 3
    v_add_u32 v73, s31, v86
    v_and_b32 v73, 3, v73
    v_lshlrev_b32 v73, 7, v73
    v_xor_b32 v86, 0, v84
    v_lshl_add_u32 v64, v86, 5, v85
    v_xor_b32 v86, 1, v84
    v_lshl_add_u32 v65, v86, 5, v85
    v_xor_b32 v86, 2, v84
    v_lshl_add_u32 v66, v86, 5, v85
    v_xor_b32 v86, 3, v84
    v_lshl_add_u32 v67, v86, 5, v85
    v_xor_b32 v86, 4, v84
    v_lshl_add_u32 v68, v86, 5, v85
    v_xor_b32 v86, 5, v84
    v_lshl_add_u32 v69, v86, 5, v85
    v_xor_b32 v86, 6, v84
    v_lshl_add_u32 v70, v86, 5, v85
    v_xor_b32 v86, 7, v84
    v_lshl_add_u32 v71, v86, 5, v85
    s_lshl_b32 s61, s31, 20
    s_lshl_b32 s62, s31, 21
    s_lshl_b32 s60, s30, 12
    s_lshl_b32 s59, s54, 10
    s_lshl_b32 s31, s56, 9
    s_add_u32 s59, s59, s31
    s_lshr_b32 s31, s28, 2
    s_lshl_b32 s31, s31, 7
    s_lshl_b32 s57, s29, 10
    s_sub_u32 s58, 0x3c00, s57
    s_add_u32 s57, s57, s31
    s_add_u32 s58, s58, s31
    v_mov_b32 v75, 0
    v_mov_b32 v76, 1
    s_lshl_b32 s31, s56, 23
    s_add_u32 s31, s31, 0x3000000
    s_add_u32 s8, s6, s31
    s_addc_u32 s9, s7, 0
    s_and_b32 s9, s9, 0xffff
    s_mov_b32 s10, 0x800000
    s_lshl_b32 s31, s56, 22
    s_waitcnt lgkmcnt(0)
    s_add_u32 s12, s4, s31
    s_addc_u32 s13, s5, 0
    s_and_b32 s13, s13, 0xffff
    s_mov_b32 s14, 0x400000
    s_load_dwordx2 s[4:5], s[0:1], 80
    v_mov_b32 v12, -1
    v_mov_b32 v13, -1
    v_mov_b32 v14, -1
    v_mov_b32 v15, -1
    s_waitcnt lgkmcnt(0)
    s_mov_b32 s26, -1
    s_lshl_b32 s31, s2, 14
    s_add_u32 s31, s31, s60
    s_add_u32 s40, s31, 0x2000000
    buffer_store_dwordx4 v[12:15], v1, s[24:27], s40 offen offset:0 sc1
    buffer_store_dwordx4 v[12:15], v1, s[24:27], s40 offen offset:1024 sc1
    buffer_store_dwordx4 v[12:15], v1, s[24:27], s40 offen offset:2048 sc1
    buffer_store_dwordx4 v[12:15], v1, s[24:27], s40 offen offset:3072 sc1
    s_lshr_b32 s31, s31, 2
    s_add_u32 s40, s31, 0x1900000
    buffer_store_dwordx4 v[12:15], v1, s[24:27], s40 offen sc1
    s_mov_b32 s26, 0x1000000
    s_and_b32 s31, s2, 7
    s_mul_i32 s31, s31, 28
    s_lshr_b32 s40, s2, 3
    s_add_u32 s31, s31, s40
    s_lshl_b32 s31, s31, 15
    s_lshl_b32 s40, s30, 13
    s_add_u32 s31, s31, s40
    s_mov_b32 s44, s4
    s_mov_b32 s47, 0x00020000
    s_and_b32 s45, s5, 0xffff
    s_cmp_ge_u32 s2, 224
    s_cselect_b32 s46, 0, 7340032
    s_add_u32 m0, s40, 131072
    s_nop 0
    buffer_load_dwordx4 v1, s[44:47], s31 offen offset:0 lds
    buffer_load_dwordx4 v1, s[44:47], s31 offen offset:1024 lds
    buffer_load_dwordx4 v1, s[44:47], s31 offen offset:2048 lds
    buffer_load_dwordx4 v1, s[44:47], s31 offen offset:3072 lds
    s_add_u32 s31, s31, 4096
    s_add_u32 m0, s40, 135168
    s_nop 0
    buffer_load_dwordx4 v1, s[44:47], s31 offen offset:0 lds
    buffer_load_dwordx4 v1, s[44:47], s31 offen offset:1024 lds
    buffer_load_dwordx4 v1, s[44:47], s31 offen offset:2048 lds
    buffer_load_dwordx4 v1, s[44:47], s31 offen offset:3072 lds
    s_add_u32 s31, s31, 4096
    s_lshl_b32 s63, s29, 1
    s_sub_u32 s63, 13, s63
    s_cbranch_scc1 k2_sdone_111
k2_sloop_110:
    v_mfma_f32_16x16x32_bf16 v[248:251], v[60:63], v[192:195], v[248:251]
    v_exp_f32 v232, v160
    v_mfma_f32_16x16x32_bf16 v[248:251], v[60:63], v[200:203], v[248:251]
    s_mov_b32 m0, s35
    ds_read_b128 a[224:227], v3 offset:4096
    v_mfma_f32_16x16x32_bf16 v[252:255], v[60:63], v[204:207], v[252:255]
    s_add_u32 s53, s53, 16384
    buffer_load_dwordx4 v1, s[20:23], s33 offen offset:0 sc1 lds
    ds_read_b128 a[228:231], v3 offset:12288
    v_mfma_f32_16x16x32_bf16 v[252:255], v[60:63], v[196:199], v[252:255]
    s_waitcnt lgkmcnt(8)
    v_exp_f32 v233, v161
    v_mfma_f32_16x16x32_bf16 a[12:15], a[192:195], v[196:199], a[12:15]
    s_and_b32 s53, s53, 0xffff
    v_exp_f32 v234, v162
    v_mfma_f32_16x16x32_bf16 a[12:15], a[196:199], v[204:207], a[12:15]
    ds_read_b128 a[232:235], v3 offset:5120
    v_cvt_pk_bf16_f32 v208, v232, v233
    v_mfma_f32_16x16x32_bf16 a[8:11], a[196:199], v[200:203], a[8:11]
    v_exp_f32 v235, v163
    v_mfma_f32_16x16x32_bf16 a[8:11], a[192:195], v[192:195], a[8:11]
    s_waitcnt lgkmcnt(7)
    ds_read_b128 a[236:239], v3 offset:13312
    v_cvt_pk_bf16_f32 v209, v234, v235
    v_mfma_f32_16x16x32_bf16 a[24:27], a[200:203], v[192:195], a[24:27]
    s_add_u32 s35, s35, 0x4000
    v_exp_f32 v236, v176
    v_mfma_f32_16x16x32_bf16 a[24:27], a[204:207], v[200:203], a[24:27]
    buffer_load_dwordx4 v1, s[20:23], s33 offen offset:1024 sc1 lds
    ds_read_b128 a[240:243], v3 offset:6144
    v_mfma_f32_16x16x32_bf16 a[28:31], a[204:207], v[204:207], a[28:31]
    v_exp_f32 v237, v177
    v_mfma_f32_16x16x32_bf16 a[28:31], a[200:203], v[196:199], a[28:31]
    s_waitcnt lgkmcnt(7)
    ds_read_b128 a[244:247], v3 offset:14336
    v_cvt_pk_bf16_f32 v210, v236, v237
    v_mfma_f32_16x16x32_bf16 a[44:47], a[208:211], v[196:199], a[44:47]
    v_exp_f32 v238, v178
    v_mfma_f32_16x16x32_bf16 a[44:47], a[212:215], v[204:207], a[44:47]
    ds_read_b128 a[248:251], v3 offset:7168
    v_or3_b32 v57, v208, v209, v210
    v_mfma_f32_16x16x32_bf16 a[40:43], a[212:215], v[200:203], a[40:43]
    v_exp_f32 v239, v179
    v_mfma_f32_16x16x32_bf16 a[40:43], a[208:211], v[192:195], a[40:43]
    s_waitcnt lgkmcnt(7)
    ds_read_b128 a[252:255], v3 offset:15360
    v_cvt_pk_bf16_f32 v211, v238, v239
    v_mfma_f32_16x16x32_bf16 a[56:59], a[216:219], v[192:195], a[56:59]
    s_and_b32 s35, s35, 0xffff
    v_exp_f32 v240, v164
    v_mfma_f32_16x16x32_bf16 a[56:59], a[220:223], v[200:203], a[56:59]
    ds_read_b128 a[128:131], v2 offset:0
    v_add_u32 v3, s53, v56
    v_mfma_f32_16x16x32_bf16 a[60:63], a[220:223], v[204:207], a[60:63]
    v_exp_f32 v241, v165
    v_mfma_f32_16x16x32_bf16 a[60:63], a[216:219], v[196:199], a[60:63]
    s_waitcnt lgkmcnt(7)
    buffer_load_dwordx4 v1, s[20:23], s33 offen offset:2048 sc1 lds
    ds_read_b128 a[132:135], v2 offset:1024
    v_mfma_f32_16x16x32_bf16 a[76:79], a[224:227], v[196:199], a[76:79]
    v_exp_f32 v242, v166
    v_mfma_f32_16x16x32_bf16 a[76:79], a[228:231], v[204:207], a[76:79]
    s_or_b32 s35, s35, 0x10000
    ds_read_b128 a[136:139], v2 offset:2048
    v_cvt_pk_bf16_f32 v212, v240, v241
    v_mfma_f32_16x16x32_bf16 a[72:75], a[228:231], v[200:203], a[72:75]
    v_exp_f32 v243, v167
    v_mfma_f32_16x16x32_bf16 a[72:75], a[224:227], v[192:195], a[72:75]
    s_waitcnt lgkmcnt(7)
    ds_read_b128 a[140:143], v2 offset:3072
    v_or3_b32 v57, v57, v211, v212
    v_mfma_f32_16x16x32_bf16 a[88:91], a[232:235], v[192:195], a[88:91]
    v_exp_f32 v244, v180
    v_mfma_f32_16x16x32_bf16 a[88:91], a[236:239], v[200:203], a[88:91]
    ds_read_b128 a[144:147], v2 offset:4096
    v_cvt_pk_bf16_f32 v213, v242, v243
    v_mfma_f32_16x16x32_bf16 a[92:95], a[236:239], v[204:207], a[92:95]
    v_exp_f32 v245, v181
    v_mfma_f32_16x16x32_bf16 a[92:95], a[232:235], v[196:199], a[92:95]
    s_waitcnt lgkmcnt(7)
    buffer_load_dwordx4 v1, s[20:23], s33 offen offset:3072 sc1 lds
    ds_read_b128 a[148:151], v2 offset:5120
    v_mfma_f32_16x16x32_bf16 a[108:111], a[240:243], v[196:199], a[108:111]
    s_add_u32 s33, s33, 0x80000
    v_exp_f32 v246, v182
    v_mfma_f32_16x16x32_bf16 a[108:111], a[244:247], v[204:207], a[108:111]
    ds_read_b128 a[152:155], v2 offset:6144
    v_cvt_pk_bf16_f32 v214, v244, v245
    v_mfma_f32_16x16x32_bf16 a[104:107], a[244:247], v[200:203], a[104:107]
    v_exp_f32 v247, v183
    v_mfma_f32_16x16x32_bf16 a[104:107], a[240:243], v[192:195], a[104:107]
    s_waitcnt lgkmcnt(7)
    ds_read_b128 a[156:159], v2 offset:7168
    v_or3_b32 v57, v57, v213, v214
    v_mfma_f32_16x16x32_bf16 a[120:123], a[248:251], v[192:195], a[120:123]
    v_exp_f32 v232, v168
    v_mfma_f32_16x16x32_bf16 a[120:123], a[252:255], v[200:203], a[120:123]
    ds_read_b128 a[160:163], v2 offset:8192
    v_cvt_pk_bf16_f32 v215, v246, v247
    v_mfma_f32_16x16x32_bf16 a[124:127], a[252:255], v[204:207], a[124:127]
    v_exp_f32 v233, v169
    v_mfma_f32_16x16x32_bf16 a[124:127], a[248:251], v[196:199], a[124:127]
    s_waitcnt lgkmcnt(7)
    ds_read_b128 a[164:167], v2 offset:9216
    v_cvt_pk_bf16_f32 v216, v232, v233
    v_mfma_f32_16x16x32_bf16 v[128:131], a[128:131], v[96:99], v[16:19]
    s_waitcnt vmcnt(12)
    s_barrier
    v_exp_f32 v234, v170
    v_mfma_f32_16x16x32_bf16 v[128:131], a[132:135], v[100:103], v[128:131]
    s_waitcnt lgkmcnt(6)
    ds_read_b128 a[168:171], v2 offset:10240
    v_or3_b32 v57, v57, v215, v216
    v_mfma_f32_16x16x32_bf16 v[128:131], a[136:139], v[104:107], v[128:131]
    s_mov_b32 m0, s34
    v_exp_f32 v235, v171
    v_mfma_f32_16x16x32_bf16 v[128:131], a[140:143], v[108:111], v[128:131]
    s_add_u32 s36, s36, 64
    buffer_load_dwordx4 v1, s[16:19], s32 offen offset:0 sc1 lds
    ds_read_b128 a[172:175], v2 offset:11264
    v_mfma_f32_16x16x32_bf16 v[132:135], a[140:143], v[124:127], v[20:23]
    v_exp_f32 v236, v184
    v_mfma_f32_16x16x32_bf16 v[132:135], a[136:139], v[120:123], v[132:135]
    ds_read_b128 a[176:179], v2 offset:12288
    v_cvt_pk_bf16_f32 v217, v234, v235
    v_mfma_f32_16x16x32_bf16 v[132:135], a[132:135], v[116:119], v[132:135]
    s_add_u32 s52, s52, 16384
    v_exp_f32 v237, v185
    v_mfma_f32_16x16x32_bf16 v[132:135], a[128:131], v[112:115], v[132:135]
    s_waitcnt lgkmcnt(7)
    ds_read_b128 a[180:183], v2 offset:13312
    v_cvt_pk_bf16_f32 v218, v236, v237
    v_mfma_f32_16x16x32_bf16 v[148:151], a[144:147], v[112:115], v[36:39]
    s_add_u32 s34, s34, 0x4000
    v_exp_f32 v238, v186
    v_mfma_f32_16x16x32_bf16 v[148:151], a[148:151], v[116:119], v[148:151]
    s_waitcnt lgkmcnt(6)
    buffer_load_dwordx4 v1, s[16:19], s32 offen offset:1024 sc1 lds
    ds_read_b128 a[184:187], v2 offset:14336
    v_mfma_f32_16x16x32_bf16 v[148:151], a[152:155], v[120:123], v[148:151]
    s_and_b32 s52, s52, 0xffff
    v_exp_f32 v239, v187
    v_mfma_f32_16x16x32_bf16 v[148:151], a[156:159], v[124:127], v[148:151]
    ds_read_b128 a[188:191], v2 offset:15360
    v_or3_b32 v57, v57, v217, v218
    v_mfma_f32_16x16x32_bf16 v[144:147], a[156:159], v[108:111], v[32:35]
    v_exp_f32 v240, v172
    v_mfma_f32_16x16x32_bf16 v[144:147], a[152:155], v[104:107], v[144:147]
    v_cvt_pk_bf16_f32 v219, v238, v239
    v_add_u32 v2, s52, v1
    v_mfma_f32_16x16x32_bf16 v[144:147], a[148:151], v[100:103], v[144:147]
    s_and_b32 s34, s34, 0xffff
    v_exp_f32 v241, v173
    v_mfma_f32_16x16x32_bf16 v[144:147], a[144:147], v[96:99], v[144:147]
    s_waitcnt lgkmcnt(6)
    ds_read_b128 a[192:195], v3 offset:0
    v_cvt_pk_bf16_f32 v220, v240, v241
    v_mfma_f32_16x16x32_bf16 v[136:139], a[160:163], v[96:99], v[24:27]
    v_exp_f32 v242, v174
    v_mfma_f32_16x16x32_bf16 v[136:139], a[164:167], v[100:103], v[136:139]
    s_waitcnt lgkmcnt(5)
    buffer_load_dwordx4 v1, s[16:19], s32 offen offset:2048 sc1 lds
    ds_read_b128 a[196:199], v3 offset:8192
    v_mfma_f32_16x16x32_bf16 v[136:139], a[168:171], v[104:107], v[136:139]
    v_exp_f32 v243, v175
    v_mfma_f32_16x16x32_bf16 v[136:139], a[172:175], v[108:111], v[136:139]
    ds_read_b128 a[200:203], v3 offset:1024
    v_or3_b32 v57, v57, v219, v220
    v_mfma_f32_16x16x32_bf16 v[140:143], a[172:175], v[124:127], v[28:31]
    v_exp_f32 v244, v188
    v_mfma_f32_16x16x32_bf16 v[140:143], a[168:171], v[120:123], v[140:143]
    ds_read_b128 a[204:207], v3 offset:9216
    v_cvt_pk_bf16_f32 v221, v242, v243
    v_mfma_f32_16x16x32_bf16 v[140:143], a[164:167], v[116:119], v[140:143]
    v_exp_f32 v245, v189
    v_mfma_f32_16x16x32_bf16 v[140:143], a[160:163], v[112:115], v[140:143]
    s_waitcnt lgkmcnt(6)
    buffer_load_dwordx4 v1, s[16:19], s32 offen offset:3072 sc1 lds
    ds_read_b128 a[208:211], v3 offset:2048
    v_mfma_f32_16x16x32_bf16 v[156:159], a[176:179], v[112:115], v[44:47]
    s_add_u32 s32, s32, 0x80000
    v_exp_f32 v246, v190
    v_mfma_f32_16x16x32_bf16 v[156:159], a[180:183], v[116:119], v[156:159]
    s_waitcnt lgkmcnt(5)
    ds_read_b128 a[212:215], v3 offset:10240
    v_cvt_pk_bf16_f32 v222, v244, v245
    v_mfma_f32_16x16x32_bf16 v[156:159], a[184:187], v[120:123], v[156:159]
    v_exp_f32 v247, v191
    v_mfma_f32_16x16x32_bf16 v[156:159], a[188:191], v[124:127], v[156:159]
    ds_read_b128 a[216:219], v3 offset:3072
    v_or3_b32 v57, v57, v221, v222
    v_mfma_f32_16x16x32_bf16 v[152:155], a[188:191], v[108:111], v[40:43]
    ds_read_b128 a[220:223], v3 offset:11264
    v_cvt_pk_bf16_f32 v223, v246, v247
    v_mfma_f32_16x16x32_bf16 v[152:155], a[184:187], v[104:107], v[152:155]
    v_bitop3_b32 v57, v57, v223, s37 bitop3:0xa8
    v_cmp_ne_u32 vcc, 0, v57
    v_mfma_f32_16x16x32_bf16 v[152:155], a[180:183], v[100:103], v[152:155]
    v_mfma_f32_16x16x32_bf16 v[152:155], a[176:179], v[96:99], v[152:155]
    s_cbranch_vccnz k2_tramp_112
k2_ret_113:
    v_mfma_f32_16x16x32_bf16 v[248:251], v[60:63], v[208:211], v[248:251]
    v_exp_f32 v232, v128
    v_mfma_f32_16x16x32_bf16 v[248:251], v[60:63], v[216:219], v[248:251]
    s_mov_b32 m0, s35
    ds_read_b128 a[224:227], v3 offset:4096
    v_mfma_f32_16x16x32_bf16 v[252:255], v[60:63], v[220:223], v[252:255]
    s_add_u32 s53, s53, 16384
    buffer_load_dwordx4 v1, s[20:23], s33 offen offset:0 sc1 lds
    ds_read_b128 a[228:231], v3 offset:12288
    v_mfma_f32_16x16x32_bf16 v[252:255], v[60:63], v[212:215], v[252:255]
    s_waitcnt lgkmcnt(8)
    v_exp_f32 v233, v129
    v_mfma_f32_16x16x32_bf16 a[12:15], a[192:195], v[212:215], a[12:15]
    s_and_b32 s53, s53, 0xffff
    v_exp_f32 v234, v130
    v_mfma_f32_16x16x32_bf16 a[12:15], a[196:199], v[220:223], a[12:15]
    ds_read_b128 a[232:235], v3 offset:5120
    v_cvt_pk_bf16_f32 v192, v232, v233
    v_mfma_f32_16x16x32_bf16 a[8:11], a[196:199], v[216:219], a[8:11]
    v_exp_f32 v235, v131
    v_mfma_f32_16x16x32_bf16 a[8:11], a[192:195], v[208:211], a[8:11]
    s_waitcnt lgkmcnt(7)
    ds_read_b128 a[236:239], v3 offset:13312
    v_cvt_pk_bf16_f32 v193, v234, v235
    v_mfma_f32_16x16x32_bf16 a[24:27], a[200:203], v[208:211], a[24:27]
    s_add_u32 s35, s35, 0x4000
    v_exp_f32 v236, v144
    v_mfma_f32_16x16x32_bf16 a[24:27], a[204:207], v[216:219], a[24:27]
    buffer_load_dwordx4 v1, s[20:23], s33 offen offset:1024 sc1 lds
    ds_read_b128 a[240:243], v3 offset:6144
    v_mfma_f32_16x16x32_bf16 a[28:31], a[204:207], v[220:223], a[28:31]
    v_exp_f32 v237, v145
    v_mfma_f32_16x16x32_bf16 a[28:31], a[200:203], v[212:215], a[28:31]
    s_waitcnt lgkmcnt(7)
    ds_read_b128 a[244:247], v3 offset:14336
    v_cvt_pk_bf16_f32 v194, v236, v237
    v_mfma_f32_16x16x32_bf16 a[44:47], a[208:211], v[212:215], a[44:47]
    v_exp_f32 v238, v146
    v_mfma_f32_16x16x32_bf16 a[44:47], a[212:215], v[220:223], a[44:47]
    ds_read_b128 a[248:251], v3 offset:7168
    v_or3_b32 v57, v192, v193, v194
    v_mfma_f32_16x16x32_bf16 a[40:43], a[212:215], v[216:219], a[40:43]
    v_exp_f32 v239, v147
    v_mfma_f32_16x16x32_bf16 a[40:43], a[208:211], v[208:211], a[40:43]
    s_waitcnt lgkmcnt(7)
    ds_read_b128 a[252:255], v3 offset:15360
    v_cvt_pk_bf16_f32 v195, v238, v239
    v_mfma_f32_16x16x32_bf16 a[56:59], a[216:219], v[208:211], a[56:59]
    s_and_b32 s35, s35, 0xffff
    v_exp_f32 v240, v132
    v_mfma_f32_16x16x32_bf16 a[56:59], a[220:223], v[216:219], a[56:59]
    ds_read_b128 a[128:131], v2 offset:0
    v_add_u32 v3, s53, v56
    v_mfma_f32_16x16x32_bf16 a[60:63], a[220:223], v[220:223], a[60:63]
    v_exp_f32 v241, v133
    v_mfma_f32_16x16x32_bf16 a[60:63], a[216:219], v[212:215], a[60:63]
    s_waitcnt lgkmcnt(7)
    buffer_load_dwordx4 v1, s[20:23], s33 offen offset:2048 sc1 lds
    ds_read_b128 a[132:135], v2 offset:1024
    v_mfma_f32_16x16x32_bf16 a[76:79], a[224:227], v[212:215], a[76:79]
    v_exp_f32 v242, v134
    v_mfma_f32_16x16x32_bf16 a[76:79], a[228:231], v[220:223], a[76:79]
    s_or_b32 s35, s35, 0x10000
    ds_read_b128 a[136:139], v2 offset:2048
    v_cvt_pk_bf16_f32 v196, v240, v241
    v_mfma_f32_16x16x32_bf16 a[72:75], a[228:231], v[216:219], a[72:75]
    v_exp_f32 v243, v135
    v_mfma_f32_16x16x32_bf16 a[72:75], a[224:227], v[208:211], a[72:75]
    s_waitcnt lgkmcnt(7)
    ds_read_b128 a[140:143], v2 offset:3072
    v_or3_b32 v57, v57, v195, v196
    v_mfma_f32_16x16x32_bf16 a[88:91], a[232:235], v[208:211], a[88:91]
    v_exp_f32 v244, v148
    v_mfma_f32_16x16x32_bf16 a[88:91], a[236:239], v[216:219], a[88:91]
    ds_read_b128 a[144:147], v2 offset:4096
    v_cvt_pk_bf16_f32 v197, v242, v243
    v_mfma_f32_16x16x32_bf16 a[92:95], a[236:239], v[220:223], a[92:95]
    v_exp_f32 v245, v149
    v_mfma_f32_16x16x32_bf16 a[92:95], a[232:235], v[212:215], a[92:95]
    s_waitcnt lgkmcnt(7)
    buffer_load_dwordx4 v1, s[20:23], s33 offen offset:3072 sc1 lds
    ds_read_b128 a[148:151], v2 offset:5120
    v_mfma_f32_16x16x32_bf16 a[108:111], a[240:243], v[212:215], a[108:111]
    s_add_u32 s33, s33, 0x80000
    v_exp_f32 v246, v150
    v_mfma_f32_16x16x32_bf16 a[108:111], a[244:247], v[220:223], a[108:111]
    ds_read_b128 a[152:155], v2 offset:6144
    v_cvt_pk_bf16_f32 v198, v244, v245
    v_mfma_f32_16x16x32_bf16 a[104:107], a[244:247], v[216:219], a[104:107]
    v_exp_f32 v247, v151
    v_mfma_f32_16x16x32_bf16 a[104:107], a[240:243], v[208:211], a[104:107]
    s_waitcnt lgkmcnt(7)
    ds_read_b128 a[156:159], v2 offset:7168
    v_or3_b32 v57, v57, v197, v198
    v_mfma_f32_16x16x32_bf16 a[120:123], a[248:251], v[208:211], a[120:123]
    v_exp_f32 v232, v136
    v_mfma_f32_16x16x32_bf16 a[120:123], a[252:255], v[216:219], a[120:123]
    ds_read_b128 a[160:163], v2 offset:8192
    v_cvt_pk_bf16_f32 v199, v246, v247
    v_mfma_f32_16x16x32_bf16 a[124:127], a[252:255], v[220:223], a[124:127]
    v_exp_f32 v233, v137
    v_mfma_f32_16x16x32_bf16 a[124:127], a[248:251], v[212:215], a[124:127]
    s_waitcnt lgkmcnt(7)
    ds_read_b128 a[164:167], v2 offset:9216
    v_cvt_pk_bf16_f32 v200, v232, v233
    v_mfma_f32_16x16x32_bf16 v[160:163], a[128:131], v[96:99], v[16:19]
    s_waitcnt vmcnt(12)
    s_barrier
    v_exp_f32 v234, v138
    v_mfma_f32_16x16x32_bf16 v[160:163], a[132:135], v[100:103], v[160:163]
    s_waitcnt lgkmcnt(6)
    ds_read_b128 a[168:171], v2 offset:10240
    v_or3_b32 v57, v57, v199, v200
    v_mfma_f32_16x16x32_bf16 v[160:163], a[136:139], v[104:107], v[160:163]
    s_mov_b32 m0, s34
    v_exp_f32 v235, v139
    v_mfma_f32_16x16x32_bf16 v[160:163], a[140:143], v[108:111], v[160:163]
    s_add_u32 s36, s36, 64
    buffer_load_dwordx4 v1, s[16:19], s32 offen offset:0 sc1 lds
    ds_read_b128 a[172:175], v2 offset:11264
    v_mfma_f32_16x16x32_bf16 v[164:167], a[140:143], v[124:127], v[20:23]
    v_exp_f32 v236, v152
    v_mfma_f32_16x16x32_bf16 v[164:167], a[136:139], v[120:123], v[164:167]
    ds_read_b128 a[176:179], v2 offset:12288
    v_cvt_pk_bf16_f32 v201, v234, v235
    v_mfma_f32_16x16x32_bf16 v[164:167], a[132:135], v[116:119], v[164:167]
    s_add_u32 s52, s52, 16384
    v_exp_f32 v237, v153
    v_mfma_f32_16x16x32_bf16 v[164:167], a[128:131], v[112:115], v[164:167]
    s_waitcnt lgkmcnt(7)
    ds_read_b128 a[180:183], v2 offset:13312
    v_cvt_pk_bf16_f32 v202, v236, v237
    v_mfma_f32_16x16x32_bf16 v[180:183], a[144:147], v[112:115], v[36:39]
    s_add_u32 s34, s34, 0x4000
    v_exp_f32 v238, v154
    v_mfma_f32_16x16x32_bf16 v[180:183], a[148:151], v[116:119], v[180:183]
    s_waitcnt lgkmcnt(6)
    buffer_load_dwordx4 v1, s[16:19], s32 offen offset:1024 sc1 lds
    ds_read_b128 a[184:187], v2 offset:14336
    v_mfma_f32_16x16x32_bf16 v[180:183], a[152:155], v[120:123], v[180:183]
    s_and_b32 s52, s52, 0xffff
    v_exp_f32 v239, v155
    v_mfma_f32_16x16x32_bf16 v[180:183], a[156:159], v[124:127], v[180:183]
    ds_read_b128 a[188:191], v2 offset:15360
    v_or3_b32 v57, v57, v201, v202
    v_mfma_f32_16x16x32_bf16 v[176:179], a[156:159], v[108:111], v[32:35]
    v_exp_f32 v240, v140
    v_mfma_f32_16x16x32_bf16 v[176:179], a[152:155], v[104:107], v[176:179]
    v_cvt_pk_bf16_f32 v203, v238, v239
    v_add_u32 v2, s52, v1
    v_mfma_f32_16x16x32_bf16 v[176:179], a[148:151], v[100:103], v[176:179]
    s_and_b32 s34, s34, 0xffff
    v_exp_f32 v241, v141
    v_mfma_f32_16x16x32_bf16 v[176:179], a[144:147], v[96:99], v[176:179]
    s_waitcnt lgkmcnt(6)
    ds_read_b128 a[192:195], v3 offset:0
    v_cvt_pk_bf16_f32 v204, v240, v241
    v_mfma_f32_16x16x32_bf16 v[168:171], a[160:163], v[96:99], v[24:27]
    v_exp_f32 v242, v142
    v_mfma_f32_16x16x32_bf16 v[168:171], a[164:167], v[100:103], v[168:171]
    s_waitcnt lgkmcnt(5)
    buffer_load_dwordx4 v1, s[16:19], s32 offen offset:2048 sc1 lds
    ds_read_b128 a[196:199], v3 offset:8192
    v_mfma_f32_16x16x32_bf16 v[168:171], a[168:171], v[104:107], v[168:171]
    v_exp_f32 v243, v143
    v_mfma_f32_16x16x32_bf16 v[168:171], a[172:175], v[108:111], v[168:171]
    ds_read_b128 a[200:203], v3 offset:1024
    v_or3_b32 v57, v57, v203, v204
    v_mfma_f32_16x16x32_bf16 v[172:175], a[172:175], v[124:127], v[28:31]
    v_exp_f32 v244, v156
    v_mfma_f32_16x16x32_bf16 v[172:175], a[168:171], v[120:123], v[172:175]
    ds_read_b128 a[204:207], v3 offset:9216
    v_cvt_pk_bf16_f32 v205, v242, v243
    v_mfma_f32_16x16x32_bf16 v[172:175], a[164:167], v[116:119], v[172:175]
    v_exp_f32 v245, v157
    v_mfma_f32_16x16x32_bf16 v[172:175], a[160:163], v[112:115], v[172:175]
    s_waitcnt lgkmcnt(6)
    buffer_load_dwordx4 v1, s[16:19], s32 offen offset:3072 sc1 lds
    ds_read_b128 a[208:211], v3 offset:2048
    v_mfma_f32_16x16x32_bf16 v[188:191], a[176:179], v[112:115], v[44:47]
    s_sub_u32 s63, s63, 1
    v_exp_f32 v246, v158
    v_mfma_f32_16x16x32_bf16 v[188:191], a[180:183], v[116:119], v[188:191]
    s_waitcnt lgkmcnt(5)
    ds_read_b128 a[212:215], v3 offset:10240
    v_cvt_pk_bf16_f32 v206, v244, v245
    v_mfma_f32_16x16x32_bf16 v[188:191], a[184:187], v[120:123], v[188:191]
    s_add_u32 s32, s32, 0x80000
    v_exp_f32 v247, v159
    v_mfma_f32_16x16x32_bf16 v[188:191], a[188:191], v[124:127], v[188:191]
    ds_read_b128 a[216:219], v3 offset:3072
    v_or3_b32 v57, v57, v205, v206
    v_mfma_f32_16x16x32_bf16 v[184:187], a[188:191], v[108:111], v[40:43]
    ds_read_b128 a[220:223], v3 offset:11264
    v_cvt_pk_bf16_f32 v207, v246, v247
    v_mfma_f32_16x16x32_bf16 v[184:187], a[184:187], v[104:107], v[184:187]
    v_bitop3_b32 v57, v57, v207, s37 bitop3:0xa8
    v_cmp_ne_u32 vcc, 0, v57
    v_mfma_f32_16x16x32_bf16 v[184:187], a[180:183], v[100:103], v[184:187]
    v_mfma_f32_16x16x32_bf16 v[184:187], a[176:179], v[96:99], v[184:187]
    s_cbranch_vccnz k2_tramp_114
k2_ret_115:
    s_cmp_lg_u32 s63, 0
    s_cbranch_scc1 k2_sloop_110
    v_mfma_f32_16x16x32_bf16 v[248:251], v[60:63], v[192:195], v[248:251]
    v_exp_f32 v232, v160
    v_mfma_f32_16x16x32_bf16 v[248:251], v[60:63], v[200:203], v[248:251]
    s_mov_b32 m0, s35
    ds_read_b128 a[224:227], v3 offset:4096
    v_exp_f32 v233, v161
    v_mfma_f32_16x16x32_bf16 v[252:255], v[60:63], v[204:207], v[252:255]
    s_add_u32 s53, s53, 16384
    buffer_load_dwordx4 v1, s[20:23], s33 offen offset:0 sc1 lds
    ds_read_b128 a[228:231], v3 offset:12288
    v_mfma_f32_16x16x32_bf16 v[252:255], v[60:63], v[196:199], v[252:255]
    s_waitcnt lgkmcnt(8)
    v_exp_f32 v234, v162
    v_cvt_pk_bf16_f32 v208, v232, v233
    v_mfma_f32_16x16x32_bf16 a[12:15], a[192:195], v[196:199], a[12:15]
    s_sub_u32 s40, s36, s39
    ds_read_b128 a[232:235], v3 offset:5120
    v_mfma_f32_16x16x32_bf16 a[12:15], a[196:199], v[204:207], a[12:15]
    s_and_b32 s53, s53, 0xffff
    v_subrev_u32 v6, s40, v4
    v_cmp_gt_i32 s[44:45], 0, v6
    v_mfma_f32_16x16x32_bf16 a[8:11], a[196:199], v[200:203], a[8:11]
    v_exp_f32 v235, v163
    v_cmp_gt_i32 s[46:47], 1, v6
    v_mfma_f32_16x16x32_bf16 a[8:11], a[192:195], v[192:195], a[8:11]
    s_waitcnt lgkmcnt(7)
    ds_read_b128 a[236:239], v3 offset:13312
    v_cmp_gt_i32 s[48:49], 2, v6
    v_cmp_gt_i32 s[50:51], 3, v6
    v_mfma_f32_16x16x32_bf16 a[24:27], a[200:203], v[192:195], a[24:27]
    s_add_u32 s35, s35, 0x4000
    v_exp_f32 v236, v176
    v_mfma_f32_16x16x32_bf16 a[24:27], a[204:207], v[200:203], a[24:27]
    ds_read_b128 a[240:243], v3 offset:6144
    v_cvt_pk_bf16_f32 v209, v234, v235
    v_cndmask_b32 v16, v10, v5, s[44:45]
    v_mfma_f32_16x16x32_bf16 a[28:31], a[204:207], v[204:207], a[28:31]
    v_exp_f32 v237, v177
    v_mfma_f32_16x16x32_bf16 a[28:31], a[200:203], v[196:199], a[28:31]
    s_waitcnt lgkmcnt(7)
    ds_read_b128 a[244:247], v3 offset:14336
    v_cndmask_b32 v17, v10, v5, s[46:47]
    v_cndmask_b32 v18, v10, v5, s[48:49]
    v_mfma_f32_16x16x32_bf16 a[44:47], a[208:211], v[196:199], a[44:47]
    buffer_load_dwordx4 v1, s[20:23], s33 offen offset:1024 sc1 lds
    ds_read_b128 a[248:251], v3 offset:7168
    v_mfma_f32_16x16x32_bf16 a[44:47], a[212:215], v[204:207], a[44:47]
    v_cndmask_b32 v19, v10, v5, s[50:51]
    v_cvt_pk_bf16_f32 v210, v236, v237
    v_mfma_f32_16x16x32_bf16 a[40:43], a[212:215], v[200:203], a[40:43]
    v_exp_f32 v238, v178
    v_cmp_gt_i32 s[44:45], 16, v6
    v_mfma_f32_16x16x32_bf16 a[40:43], a[208:211], v[192:195], a[40:43]
    s_waitcnt lgkmcnt(7)
    v_cmp_gt_i32 s[46:47], 17, v6
    v_cmp_gt_i32 s[48:49], 18, v6
    v_mfma_f32_16x16x32_bf16 a[56:59], a[216:219], v[192:195], a[56:59]
    s_and_b32 s35, s35, 0xffff
    v_exp_f32 v239, v179
    v_mfma_f32_16x16x32_bf16 a[56:59], a[220:223], v[200:203], a[56:59]
    ds_read_b128 a[252:255], v3 offset:15360
    v_or3_b32 v57, v208, v209, v210
    v_cmp_gt_i32 s[50:51], 19, v6
    v_mfma_f32_16x16x32_bf16 a[60:63], a[220:223], v[204:207], a[60:63]
    v_exp_f32 v240, v164
    v_mfma_f32_16x16x32_bf16 a[60:63], a[216:219], v[196:199], a[60:63]
    s_waitcnt lgkmcnt(6)
    v_cndmask_b32 v32, v10, v5, s[44:45]
    v_cvt_pk_bf16_f32 v211, v238, v239
    v_cndmask_b32 v33, v10, v5, s[46:47]
    v_mfma_f32_16x16x32_bf16 a[76:79], a[224:227], v[196:199], a[76:79]
    ds_read_b128 a[128:131], v2 offset:0
    v_cndmask_b32 v34, v10, v5, s[48:49]
    v_mfma_f32_16x16x32_bf16 a[76:79], a[228:231], v[204:207], a[76:79]
    s_or_b32 s35, s35, 0x10000
    v_add_u32 v3, s53, v56
    v_cndmask_b32 v35, v10, v5, s[50:51]
    v_mfma_f32_16x16x32_bf16 a[72:75], a[228:231], v[200:203], a[72:75]
    buffer_load_dwordx4 v1, s[20:23], s33 offen offset:2048 sc1 lds
    v_exp_f32 v241, v165
    v_mfma_f32_16x16x32_bf16 a[72:75], a[224:227], v[192:195], a[72:75]
    s_waitcnt lgkmcnt(5)
    ds_read_b128 a[132:135], v2 offset:1024
    v_cmp_gt_i32 s[44:45], 32, v6
    v_mfma_f32_16x16x32_bf16 a[88:91], a[232:235], v[192:195], a[88:91]
    v_exp_f32 v242, v166
    v_cmp_gt_i32 s[46:47], 33, v6
    v_mfma_f32_16x16x32_bf16 a[88:91], a[236:239], v[200:203], a[88:91]
    ds_read_b128 a[136:139], v2 offset:2048
    v_cvt_pk_bf16_f32 v212, v240, v241
    v_mfma_f32_16x16x32_bf16 a[92:95], a[236:239], v[204:207], a[92:95]
    v_cmp_gt_i32 s[48:49], 34, v6
    v_cmp_gt_i32 s[50:51], 35, v6
    v_mfma_f32_16x16x32_bf16 a[92:95], a[232:235], v[196:199], a[92:95]
    s_waitcnt lgkmcnt(5)
    v_exp_f32 v243, v167
    v_or3_b32 v57, v57, v211, v212
    v_mfma_f32_16x16x32_bf16 a[108:111], a[240:243], v[196:199], a[108:111]
    ds_read_b128 a[140:143], v2 offset:3072
    v_cndmask_b32 v24, v10, v5, s[44:45]
    v_mfma_f32_16x16x32_bf16 a[108:111], a[244:247], v[204:207], a[108:111]
    v_cndmask_b32 v25, v10, v5, s[46:47]
    v_exp_f32 v244, v180
    v_mfma_f32_16x16x32_bf16 a[104:107], a[244:247], v[200:203], a[104:107]
    v_cvt_pk_bf16_f32 v213, v242, v243
    v_cndmask_b32 v26, v10, v5, s[48:49]
    v_mfma_f32_16x16x32_bf16 a[104:107], a[240:243], v[192:195], a[104:107]
    s_waitcnt lgkmcnt(4)
    ds_read_b128 a[144:147], v2 offset:4096
    v_cndmask_b32 v27, v10, v5, s[50:51]
    v_mfma_f32_16x16x32_bf16 a[120:123], a[248:251], v[192:195], a[120:123]
    v_exp_f32 v245, v181
    v_cmp_gt_i32 s[44:45], 48, v6
    v_mfma_f32_16x16x32_bf16 a[120:123], a[252:255], v[200:203], a[120:123]
    buffer_load_dwordx4 v1, s[20:23], s33 offen offset:3072 sc1 lds
    ds_read_b128 a[148:151], v2 offset:5120
    ds_read_b128 a[152:155], v2 offset:6144
    v_cmp_gt_i32 s[46:47], 49, v6
    s_add_u32 s33, s33, 0x80000
    v_cmp_gt_i32 s[48:49], 50, v6
    v_exp_f32 v246, v182
    v_cvt_pk_bf16_f32 v214, v244, v245
    v_cmp_gt_i32 s[50:51], 51, v6
    v_cndmask_b32 v40, v10, v5, s[44:45]
    v_mfma_f32_16x16x32_bf16 a[124:127], a[252:255], v[204:207], a[124:127]
    v_exp_f32 v247, v183
    v_or3_b32 v57, v57, v213, v214
    v_cndmask_b32 v41, v10, v5, s[46:47]
    v_mfma_f32_16x16x32_bf16 a[124:127], a[248:251], v[196:199], a[124:127]
    s_waitcnt lgkmcnt(5)
    ds_read_b128 a[156:159], v2 offset:7168
    v_cndmask_b32 v42, v10, v5, s[48:49]
    v_cndmask_b32 v43, v10, v5, s[50:51]
    v_mfma_f32_16x16x32_bf16 v[128:131], a[128:131], v[96:99], v[16:19]
    s_waitcnt vmcnt(4)
    s_barrier
    v_exp_f32 v232, v168
    v_mfma_f32_16x16x32_bf16 v[128:131], a[132:135], v[100:103], v[128:131]
    s_waitcnt lgkmcnt(4)
    ds_read_b128 a[160:163], v2 offset:8192
    v_cvt_pk_bf16_f32 v215, v246, v247
    v_mfma_f32_16x16x32_bf16 v[128:131], a[136:139], v[104:107], v[128:131]
    v_exp_f32 v233, v169
    v_mfma_f32_16x16x32_bf16 v[128:131], a[140:143], v[108:111], v[128:131]
    s_add_u32 s36, s36, 64
    ds_read_b128 a[164:167], v2 offset:9216
    v_cvt_pk_bf16_f32 v216, v232, v233
    v_mfma_f32_16x16x32_bf16 v[132:135], a[140:143], v[124:127], v[20:23]
    v_exp_f32 v234, v170
    v_mfma_f32_16x16x32_bf16 v[132:135], a[136:139], v[120:123], v[132:135]
    ds_read_b128 a[168:171], v2 offset:10240
    v_or3_b32 v57, v57, v215, v216
    v_mfma_f32_16x16x32_bf16 v[132:135], a[132:135], v[116:119], v[132:135]
    s_add_u32 s52, s52, 16384
    v_exp_f32 v235, v171
    v_mfma_f32_16x16x32_bf16 v[132:135], a[128:131], v[112:115], v[132:135]
    s_waitcnt lgkmcnt(5)
    ds_read_b128 a[172:175], v2 offset:11264
    v_cvt_pk_bf16_f32 v217, v234, v235
    v_mfma_f32_16x16x32_bf16 v[148:151], a[144:147], v[112:115], v[36:39]
    s_and_b32 s52, s52, 0xffff
    v_exp_f32 v236, v184
    v_mfma_f32_16x16x32_bf16 v[148:151], a[148:151], v[116:119], v[148:151]
    s_waitcnt lgkmcnt(4)
    ds_read_b128 a[176:179], v2 offset:12288
    ds_read_b128 a[180:183], v2 offset:13312
    v_mfma_f32_16x16x32_bf16 v[148:151], a[152:155], v[120:123], v[148:151]
    v_exp_f32 v237, v185
    v_mfma_f32_16x16x32_bf16 v[148:151], a[156:159], v[124:127], v[148:151]
    v_exp_f32 v238, v186
    v_mfma_f32_16x16x32_bf16 v[144:147], a[156:159], v[108:111], v[32:35]
    ds_read_b128 a[184:187], v2 offset:14336
    v_cvt_pk_bf16_f32 v218, v236, v237
    v_mfma_f32_16x16x32_bf16 v[144:147], a[152:155], v[104:107], v[144:147]
    v_exp_f32 v239, v187
    v_mfma_f32_16x16x32_bf16 v[144:147], a[148:151], v[100:103], v[144:147]
    ds_read_b128 a[188:191], v2 offset:15360
    v_or3_b32 v57, v57, v217, v218
    v_mfma_f32_16x16x32_bf16 v[144:147], a[144:147], v[96:99], v[144:147]
    s_waitcnt lgkmcnt(6)
    v_exp_f32 v240, v172
    v_mfma_f32_16x16x32_bf16 v[136:139], a[160:163], v[96:99], v[24:27]
    v_cvt_pk_bf16_f32 v219, v238, v239
    v_add_u32 v2, s52, v1
    v_mfma_f32_16x16x32_bf16 v[136:139], a[164:167], v[100:103], v[136:139]
    s_waitcnt lgkmcnt(4)
    v_exp_f32 v241, v173
    v_mfma_f32_16x16x32_bf16 v[136:139], a[168:171], v[104:107], v[136:139]
    ds_read_b128 a[192:195], v3 offset:0
    v_cvt_pk_bf16_f32 v220, v240, v241
    v_mfma_f32_16x16x32_bf16 v[136:139], a[172:175], v[108:111], v[136:139]
    v_exp_f32 v242, v174
    v_mfma_f32_16x16x32_bf16 v[140:143], a[172:175], v[124:127], v[28:31]
    ds_read_b128 a[196:199], v3 offset:8192
    v_or3_b32 v57, v57, v219, v220
    v_mfma_f32_16x16x32_bf16 v[140:143], a[168:171], v[120:123], v[140:143]
    v_exp_f32 v243, v175
    v_mfma_f32_16x16x32_bf16 v[140:143], a[164:167], v[116:119], v[140:143]
    ds_read_b128 a[200:203], v3 offset:1024
    v_cvt_pk_bf16_f32 v221, v242, v243
    v_mfma_f32_16x16x32_bf16 v[140:143], a[160:163], v[112:115], v[140:143]
    s_waitcnt lgkmcnt(5)
    v_exp_f32 v244, v188
    v_mfma_f32_16x16x32_bf16 v[156:159], a[176:179], v[112:115], v[44:47]
    ds_read_b128 a[204:207], v3 offset:9216
    ds_read_b128 a[208:211], v3 offset:2048
    v_mfma_f32_16x16x32_bf16 v[156:159], a[180:183], v[116:119], v[156:159]
    s_waitcnt lgkmcnt(5)
    v_exp_f32 v245, v189
    v_mfma_f32_16x16x32_bf16 v[156:159], a[184:187], v[120:123], v[156:159]
    v_exp_f32 v246, v190
    v_mfma_f32_16x16x32_bf16 v[156:159], a[188:191], v[124:127], v[156:159]
    ds_read_b128 a[212:215], v3 offset:10240
    v_cvt_pk_bf16_f32 v222, v244, v245
    v_mfma_f32_16x16x32_bf16 v[152:155], a[188:191], v[108:111], v[40:43]
    v_exp_f32 v247, v191
    v_mfma_f32_16x16x32_bf16 v[152:155], a[184:187], v[104:107], v[152:155]
    ds_read_b128 a[216:219], v3 offset:3072
    v_or3_b32 v57, v57, v221, v222
    v_mfma_f32_16x16x32_bf16 v[152:155], a[180:183], v[100:103], v[152:155]
    ds_read_b128 a[220:223], v3 offset:11264
    v_cvt_pk_bf16_f32 v223, v246, v247
    v_bitop3_b32 v57, v57, v223, s37 bitop3:0xa8
    v_mfma_f32_16x16x32_bf16 v[152:155], a[176:179], v[96:99], v[152:155]
    v_cmp_ne_u32 vcc, 0, v57
    s_cbranch_vccnz k2_tramp_116
k2_ret_117:
    v_mfma_f32_16x16x32_bf16 v[248:251], v[60:63], v[208:211], v[248:251]
    ds_read_b128 a[224:227], v3 offset:4096
    v_exp_f32 v232, v128
    v_mfma_f32_16x16x32_bf16 v[248:251], v[60:63], v[216:219], v[248:251]
    v_exp_f32 v233, v129
    v_mfma_f32_16x16x32_bf16 v[252:255], v[60:63], v[220:223], v[252:255]
    s_add_u32 s53, s53, 16384
    ds_read_b128 a[228:231], v3 offset:12288
    v_exp_f32 v234, v130
    v_mfma_f32_16x16x32_bf16 v[252:255], v[60:63], v[212:215], v[252:255]
    s_waitcnt lgkmcnt(8)
    v_cvt_pk_bf16_f32 v192, v232, v233
    v_exp_f32 v235, v131
    v_mfma_f32_16x16x32_bf16 a[12:15], a[192:195], v[212:215], a[12:15]
    s_sub_u32 s40, s36, s39
    s_sub_u32 s40, s40, 64
    ds_read_b128 a[232:235], v3 offset:5120
    v_mfma_f32_16x16x32_bf16 a[12:15], a[196:199], v[220:223], a[12:15]
    s_and_b32 s53, s53, 0xffff
    v_subrev_u32 v6, s40, v4
    v_cmp_gt_i32 s[44:45], 0, v6
    v_cvt_pk_bf16_f32 v193, v234, v235
    v_mfma_f32_16x16x32_bf16 a[8:11], a[196:199], v[216:219], a[8:11]
    v_exp_f32 v236, v144
    v_cmp_gt_i32 s[46:47], 1, v6
    v_mfma_f32_16x16x32_bf16 a[8:11], a[192:195], v[208:211], a[8:11]
    s_waitcnt lgkmcnt(7)
    ds_read_b128 a[236:239], v3 offset:13312
    v_exp_f32 v237, v145
    v_mfma_f32_16x16x32_bf16 a[24:27], a[200:203], v[208:211], a[24:27]
    ds_read_b128 a[240:243], v3 offset:6144
    v_cmp_gt_i32 s[48:49], 2, v6
    v_cmp_gt_i32 s[50:51], 3, v6
    v_mfma_f32_16x16x32_bf16 a[24:27], a[204:207], v[216:219], a[24:27]
    v_exp_f32 v238, v146
    v_cndmask_b32 v20, v11, v5, s[44:45]
    v_mfma_f32_16x16x32_bf16 a[28:31], a[204:207], v[220:223], a[28:31]
    v_cvt_pk_bf16_f32 v194, v236, v237
    v_cndmask_b32 v21, v11, v5, s[46:47]
    v_or3_b32 v57, v192, v193, v194
    v_mfma_f32_16x16x32_bf16 a[28:31], a[200:203], v[212:215], a[28:31]
    s_waitcnt lgkmcnt(7)
    v_exp_f32 v239, v147
    v_cndmask_b32 v22, v11, v5, s[48:49]
    v_mfma_f32_16x16x32_bf16 a[44:47], a[208:211], v[212:215], a[44:47]
    ds_read_b128 a[244:247], v3 offset:14336
    v_cndmask_b32 v23, v11, v5, s[50:51]
    v_cvt_pk_bf16_f32 v195, v238, v239
    v_mfma_f32_16x16x32_bf16 a[44:47], a[212:215], v[220:223], a[44:47]
    v_exp_f32 v240, v132
    v_cmp_gt_i32 s[44:45], 16, v6
    v_mfma_f32_16x16x32_bf16 a[40:43], a[212:215], v[216:219], a[40:43]
    ds_read_b128 a[248:251], v3 offset:7168
    v_cmp_gt_i32 s[46:47], 17, v6
    v_cmp_gt_i32 s[48:49], 18, v6
    v_mfma_f32_16x16x32_bf16 a[40:43], a[208:211], v[208:211], a[40:43]
    s_waitcnt lgkmcnt(7)
    ds_read_b128 a[252:255], v3 offset:15360
    v_exp_f32 v241, v133
    v_mfma_f32_16x16x32_bf16 a[56:59], a[216:219], v[208:211], a[56:59]
    v_exp_f32 v242, v134
    v_cmp_gt_i32 s[50:51], 19, v6
    v_mfma_f32_16x16x32_bf16 a[56:59], a[220:223], v[216:219], a[56:59]
    v_cvt_pk_bf16_f32 v196, v240, v241
    v_cndmask_b32 v36, v11, v5, s[44:45]
    v_or3_b32 v57, v57, v195, v196
    v_mfma_f32_16x16x32_bf16 a[60:63], a[220:223], v[220:223], a[60:63]
    v_exp_f32 v243, v135
    v_cndmask_b32 v37, v11, v5, s[46:47]
    v_mfma_f32_16x16x32_bf16 a[60:63], a[216:219], v[212:215], a[60:63]
    s_waitcnt lgkmcnt(6)
    ds_read_b128 a[128:131], v2 offset:0
    v_cndmask_b32 v38, v11, v5, s[48:49]
    v_add_u32 v3, s53, v56
    v_mfma_f32_16x16x32_bf16 a[76:79], a[224:227], v[212:215], a[76:79]
    ds_read_b128 a[132:135], v2 offset:1024
    v_exp_f32 v244, v148
    v_mfma_f32_16x16x32_bf16 a[76:79], a[228:231], v[220:223], a[76:79]
    ds_read_b128 a[136:139], v2 offset:2048
    v_cvt_pk_bf16_f32 v197, v242, v243
    v_cndmask_b32 v39, v11, v5, s[50:51]
    v_mfma_f32_16x16x32_bf16 a[72:75], a[228:231], v[216:219], a[72:75]
    v_cmp_gt_i32 s[44:45], 32, v6
    v_exp_f32 v245, v149
    v_mfma_f32_16x16x32_bf16 a[72:75], a[224:227], v[208:211], a[72:75]
    s_waitcnt lgkmcnt(7)
    ds_read_b128 a[140:143], v2 offset:3072
    ds_read_b128 a[144:147], v2 offset:4096
    v_cmp_gt_i32 s[46:47], 33, v6
    v_mfma_f32_16x16x32_bf16 a[88:91], a[232:235], v[208:211], a[88:91]
    v_exp_f32 v246, v150
    v_cmp_gt_i32 s[48:49], 34, v6
    v_mfma_f32_16x16x32_bf16 a[88:91], a[236:239], v[216:219], a[88:91]
    ds_read_b128 a[148:151], v2 offset:5120
    v_cvt_pk_bf16_f32 v198, v244, v245
    v_cmp_gt_i32 s[50:51], 35, v6
    v_mfma_f32_16x16x32_bf16 a[92:95], a[236:239], v[220:223], a[92:95]
    v_exp_f32 v247, v151
    v_or3_b32 v57, v57, v197, v198
    v_mfma_f32_16x16x32_bf16 a[92:95], a[232:235], v[212:215], a[92:95]
    s_waitcnt lgkmcnt(8)
    ds_read_b128 a[152:155], v2 offset:6144
    v_cndmask_b32 v28, v11, v5, s[44:45]
    v_cndmask_b32 v29, v11, v5, s[46:47]
    v_mfma_f32_16x16x32_bf16 a[108:111], a[240:243], v[212:215], a[108:111]
    ds_read_b128 a[156:159], v2 offset:7168
    v_exp_f32 v232, v136
    v_mfma_f32_16x16x32_bf16 a[108:111], a[244:247], v[220:223], a[108:111]
    ds_read_b128 a[160:163], v2 offset:8192
    v_cvt_pk_bf16_f32 v199, v246, v247
    v_cndmask_b32 v30, v11, v5, s[48:49]
    v_mfma_f32_16x16x32_bf16 a[104:107], a[244:247], v[216:219], a[104:107]
    v_cndmask_b32 v31, v11, v5, s[50:51]
    v_exp_f32 v233, v137
    v_mfma_f32_16x16x32_bf16 a[104:107], a[240:243], v[208:211], a[104:107]
    s_waitcnt lgkmcnt(9)
    ds_read_b128 a[164:167], v2 offset:9216
    ds_read_b128 a[168:171], v2 offset:10240
    v_cmp_gt_i32 s[44:45], 48, v6
    v_mfma_f32_16x16x32_bf16 a[120:123], a[248:251], v[208:211], a[120:123]
    v_exp_f32 v234, v138
    v_cmp_gt_i32 s[46:47], 49, v6
    v_mfma_f32_16x16x32_bf16 a[120:123], a[252:255], v[216:219], a[120:123]
    ds_read_b128 a[172:175], v2 offset:11264
    ds_read_b128 a[176:179], v2 offset:12288
    v_cvt_pk_bf16_f32 v200, v232, v233
    v_cmp_gt_i32 s[48:49], 50, v6
    v_exp_f32 v235, v139
    v_cmp_gt_i32 s[50:51], 51, v6
    v_or3_b32 v57, v57, v199, v200
    v_cndmask_b32 v44, v11, v5, s[44:45]
    v_mfma_f32_16x16x32_bf16 a[124:127], a[252:255], v[220:223], a[124:127]
    ds_read_b128 a[180:183], v2 offset:13312
    v_exp_f32 v236, v152
    v_cvt_pk_bf16_f32 v201, v234, v235
    v_cndmask_b32 v45, v11, v5, s[46:47]
    v_mfma_f32_16x16x32_bf16 a[124:127], a[248:251], v[212:215], a[124:127]
    s_waitcnt lgkmcnt(12)
    ds_read_b128 a[184:187], v2 offset:14336
    v_cndmask_b32 v46, v11, v5, s[48:49]
    v_cndmask_b32 v47, v11, v5, s[50:51]
    v_mfma_f32_16x16x32_bf16 v[164:167], a[128:131], v[112:115], v[20:23]
    v_exp_f32 v237, v153
    v_mfma_f32_16x16x32_bf16 v[164:167], a[132:135], v[116:119], v[164:167]
    s_waitcnt lgkmcnt(11)
    ds_read_b128 a[188:191], v2 offset:15360
    v_exp_f32 v238, v154
    v_mfma_f32_16x16x32_bf16 v[164:167], a[136:139], v[120:123], v[164:167]
    v_cvt_pk_bf16_f32 v202, v236, v237
    v_exp_f32 v239, v155
    v_mfma_f32_16x16x32_bf16 v[164:167], a[140:143], v[124:127], v[164:167]
    s_waitcnt lgkmcnt(10)
    s_waitcnt lgkmcnt(8)
    v_or3_b32 v57, v57, v201, v202
    v_mfma_f32_16x16x32_bf16 v[180:183], a[156:159], v[124:127], v[36:39]
    s_add_u32 s36, s36, 64
    ds_read_b128 a[192:195], v3 offset:0
    v_exp_f32 v240, v140
    v_mfma_f32_16x16x32_bf16 v[180:183], a[152:155], v[120:123], v[180:183]
    ds_read_b128 a[196:199], v3 offset:8192
    v_cvt_pk_bf16_f32 v203, v238, v239
    v_mfma_f32_16x16x32_bf16 v[180:183], a[148:151], v[116:119], v[180:183]
    s_add_u32 s52, s52, 16384
    ds_read_b128 a[200:203], v3 offset:1024
    v_exp_f32 v241, v141
    v_mfma_f32_16x16x32_bf16 v[180:183], a[144:147], v[112:115], v[180:183]
    s_waitcnt lgkmcnt(9)
    v_exp_f32 v242, v142
    v_cvt_pk_bf16_f32 v204, v240, v241
    v_mfma_f32_16x16x32_bf16 v[172:175], a[160:163], v[112:115], v[28:31]
    s_and_b32 s52, s52, 0xffff
    v_add_u32 v2, s52, v1
    v_exp_f32 v243, v143
    v_mfma_f32_16x16x32_bf16 v[172:175], a[164:167], v[116:119], v[172:175]
    s_waitcnt lgkmcnt(7)
    ds_read_b128 a[204:207], v3 offset:9216
    v_or3_b32 v57, v57, v203, v204
    v_cvt_pk_bf16_f32 v205, v242, v243
    v_mfma_f32_16x16x32_bf16 v[172:175], a[168:171], v[120:123], v[172:175]
    ds_read_b128 a[208:211], v3 offset:2048
    v_exp_f32 v244, v156
    v_mfma_f32_16x16x32_bf16 v[172:175], a[172:175], v[124:127], v[172:175]
    s_waitcnt lgkmcnt(7)
    s_waitcnt lgkmcnt(5)
    v_exp_f32 v245, v157
    v_mfma_f32_16x16x32_bf16 v[188:191], a[188:191], v[124:127], v[44:47]
    ds_read_b128 a[212:215], v3 offset:10240
    v_exp_f32 v246, v158
    v_mfma_f32_16x16x32_bf16 v[188:191], a[184:187], v[120:123], v[188:191]
    v_cvt_pk_bf16_f32 v206, v244, v245
    v_exp_f32 v247, v159
    v_mfma_f32_16x16x32_bf16 v[188:191], a[180:183], v[116:119], v[188:191]
    ds_read_b128 a[216:219], v3 offset:3072
    v_or3_b32 v57, v57, v205, v206
    v_cvt_pk_bf16_f32 v207, v246, v247
    v_mfma_f32_16x16x32_bf16 v[188:191], a[176:179], v[112:115], v[188:191]
    ds_read_b128 a[220:223], v3 offset:11264
    v_bitop3_b32 v57, v57, v207, s37 bitop3:0xa8
    v_cmp_ne_u32 vcc, 0, v57
    s_cbranch_vccnz k2_tramp_118
k2_ret_119:
k2_sdone_111:
    s_add_u32 s16, s6, 0x4811000
    s_addc_u32 s17, s7, 0
    s_and_b32 s17, s17, 0xffff
    s_mov_b32 s18, 0x4000
    s_mov_b32 s19, 0x00020000
    v_mfma_f32_16x16x32_bf16 v[248:251], v[60:63], v[192:195], v[248:251]
    s_waitcnt vmcnt(0)
    s_barrier
    v_exp_f32 v232, v164
    v_mfma_f32_16x16x32_bf16 v[248:251], v[60:63], v[200:203], v[248:251]
    ds_read_b128 a[224:227], v3 offset:4096
    s_cmp_eq_u32 s30, 0
    s_cbranch_scc1 k12_ool_122
k12_oolret_123:
    v_mfma_f32_16x16x32_bf16 v[252:255], v[60:63], v[204:207], v[252:255]
    s_add_u32 m0, s60, 0
    v_exp_f32 v233, v165
    v_mfma_f32_16x16x32_bf16 v[252:255], v[60:63], v[196:199], v[252:255]
    s_waitcnt lgkmcnt(7)
    buffer_load_dwordx4 v90, s[12:15], s61 offen offset:0 lds
    ds_read_b128 a[228:231], v3 offset:12288
    v_mfma_f32_16x16x32_bf16 a[12:15], a[192:195], v[196:199], a[12:15]
    s_add_u32 s53, s53, 16384
    v_exp_f32 v234, v166
    v_cvt_pk_bf16_f32 v212, v232, v233
    v_mfma_f32_16x16x32_bf16 a[12:15], a[196:199], v[204:207], a[12:15]
    s_and_b32 s53, s53, 0xffff
    buffer_load_dwordx4 v91, s[12:15], s61 offen offset:1024 lds
    ds_read_b128 a[232:235], v3 offset:5120
    v_mfma_f32_16x16x32_bf16 a[8:11], a[196:199], v[200:203], a[8:11]
    ds_read_b128 a[236:239], v3 offset:13312
    v_exp_f32 v235, v167
    v_mfma_f32_16x16x32_bf16 a[8:11], a[192:195], v[192:195], a[8:11]
    s_waitcnt lgkmcnt(8)
    v_exp_f32 v236, v180
    v_mfma_f32_16x16x32_bf16 a[24:27], a[200:203], v[192:195], a[24:27]
    buffer_load_dwordx4 v92, s[12:15], s61 offen offset:2048 lds
    ds_read_b128 a[240:243], v3 offset:6144
    v_mfma_f32_16x16x32_bf16 a[24:27], a[204:207], v[200:203], a[24:27]
    v_cvt_pk_bf16_f32 v213, v234, v235
    v_exp_f32 v237, v181
    v_mfma_f32_16x16x32_bf16 a[28:31], a[204:207], v[204:207], a[28:31]
    buffer_load_dwordx4 v93, s[12:15], s61 offen offset:3072 lds
    ds_read_b128 a[244:247], v3 offset:14336
    v_mfma_f32_16x16x32_bf16 a[28:31], a[200:203], v[196:199], a[28:31]
    s_waitcnt lgkmcnt(8)
    v_exp_f32 v238, v182
    v_cvt_pk_bf16_f32 v214, v236, v237
    v_mfma_f32_16x16x32_bf16 a[44:47], a[208:211], v[196:199], a[44:47]
    s_add_u32 s61, s61, 0x20000
    s_and_b32 s61, s61, 0x3fffff
    ds_read_b128 a[248:251], v3 offset:7168
    v_mfma_f32_16x16x32_bf16 a[44:47], a[212:215], v[204:207], a[44:47]
    s_add_u32 m0, s60, 16384
    v_exp_f32 v239, v183
    v_or3_b32 v57, v212, v213, v214
    v_mfma_f32_16x16x32_bf16 a[40:43], a[212:215], v[200:203], a[40:43]
    buffer_load_dwordx4 v90, s[12:15], s61 offen offset:0 lds
    buffer_load_dwordx4 v91, s[12:15], s61 offen offset:1024 lds
    ds_read_b128 a[252:255], v3 offset:15360
    v_mfma_f32_16x16x32_bf16 a[40:43], a[208:211], v[192:195], a[40:43]
    s_waitcnt lgkmcnt(8)
    v_exp_f32 v240, v172
    v_cvt_pk_bf16_f32 v215, v238, v239
    v_mfma_f32_16x16x32_bf16 a[56:59], a[216:219], v[192:195], a[56:59]
    v_mfma_f32_16x16x32_bf16 a[56:59], a[220:223], v[200:203], a[56:59]
    v_add_u32 v3, s53, v56
    ds_read_b128 a[192:195], v3 offset:0
    v_mfma_f32_16x16x32_bf16 a[60:63], a[220:223], v[204:207], a[60:63]
    ds_read_b128 a[196:199], v3 offset:8192
    v_exp_f32 v241, v173
    v_mfma_f32_16x16x32_bf16 a[60:63], a[216:219], v[196:199], a[60:63]
    s_waitcnt lgkmcnt(8)
    buffer_load_dwordx4 v92, s[12:15], s61 offen offset:2048 lds
    buffer_load_dwordx4 v93, s[12:15], s61 offen offset:3072 lds
    ds_read_b128 a[200:203], v3 offset:1024
    v_mfma_f32_16x16x32_bf16 a[76:79], a[224:227], v[196:199], a[76:79]
    v_exp_f32 v242, v174
    v_cvt_pk_bf16_f32 v220, v240, v241
    v_mfma_f32_16x16x32_bf16 a[76:79], a[228:231], v[204:207], a[76:79]
    ds_read_b128 a[204:207], v3 offset:9216
    ds_read_b128 a[208:211], v3 offset:2048
    v_or3_b32 v57, v57, v215, v220
    v_mfma_f32_16x16x32_bf16 a[72:75], a[228:231], v[200:203], a[72:75]
    s_add_u32 s61, s61, 0x20000
    s_and_b32 s61, s61, 0x3fffff
    ds_read_b128 a[212:215], v3 offset:10240
    v_exp_f32 v243, v175
    v_mfma_f32_16x16x32_bf16 a[72:75], a[224:227], v[192:195], a[72:75]
    s_waitcnt lgkmcnt(10)
    ds_read_b128 a[216:219], v3 offset:3072
    s_add_u32 m0, s60, 32768
    v_mfma_f32_16x16x32_bf16 a[88:91], a[232:235], v[192:195], a[88:91]
    buffer_load_dwordx4 v90, s[12:15], s61 offen offset:0 lds
    ds_read_b128 a[220:223], v3 offset:11264
    v_mfma_f32_16x16x32_bf16 a[88:91], a[236:239], v[200:203], a[88:91]
    v_exp_f32 v244, v188
    v_cvt_pk_bf16_f32 v221, v242, v243
    v_mfma_f32_16x16x32_bf16 a[92:95], a[236:239], v[204:207], a[92:95]
    buffer_load_dwordx4 v91, s[12:15], s61 offen offset:1024 lds
    ds_read_b128 a[224:227], v3 offset:4096
    v_mfma_f32_16x16x32_bf16 a[92:95], a[232:235], v[196:199], a[92:95]
    s_waitcnt lgkmcnt(11)
    ds_read_b128 a[228:231], v3 offset:12288
    v_exp_f32 v245, v189
    v_mfma_f32_16x16x32_bf16 a[108:111], a[240:243], v[196:199], a[108:111]
    buffer_load_dwordx4 v92, s[12:15], s61 offen offset:2048 lds
    ds_read_b128 a[232:235], v3 offset:5120
    v_mfma_f32_16x16x32_bf16 a[108:111], a[244:247], v[204:207], a[108:111]
    v_exp_f32 v246, v190
    v_mfma_f32_16x16x32_bf16 a[104:107], a[244:247], v[200:203], a[104:107]
    ds_read_b128 a[236:239], v3 offset:13312
    v_cvt_pk_bf16_f32 v222, v244, v245
    v_or3_b32 v57, v57, v221, v222
    v_mfma_f32_16x16x32_bf16 a[104:107], a[240:243], v[192:195], a[104:107]
    s_waitcnt lgkmcnt(12)
    v_exp_f32 v247, v191
    v_mfma_f32_16x16x32_bf16 a[120:123], a[248:251], v[192:195], a[120:123]
    buffer_load_dwordx4 v93, s[12:15], s61 offen offset:3072 lds
    ds_read_b128 a[240:243], v3 offset:6144
    ds_read_b128 a[244:247], v3 offset:14336
    v_mfma_f32_16x16x32_bf16 a[120:123], a[252:255], v[200:203], a[120:123]
    s_add_u32 s61, s61, 0x20000
    s_and_b32 s61, s61, 0x3fffff
    v_cvt_pk_bf16_f32 v223, v246, v247
    v_bitop3_b32 v57, v57, v223, s37 bitop3:0xa8
    v_mfma_f32_16x16x32_bf16 a[124:127], a[252:255], v[204:207], a[124:127]
    v_cmp_ne_u32 vcc, 0, v57
    v_mfma_f32_16x16x32_bf16 a[124:127], a[248:251], v[196:199], a[124:127]
    buffer_load_dword v74, v73, s[16:19], s59 offen sc1
    ds_read_b128 a[248:251], v3 offset:7168
    ds_read_b128 a[252:255], v3 offset:15360
    s_cbranch_vccnz k2_tramp_120
k2_ret_121:
    v_lshrrev_b32 v6, 4, v1
    v_and_b32 v6, 31, v6
    s_getpc_b64 s[40:41]
pc_124:
    s_add_u32 s40, s40, op_head-pc_124
    s_addc_u32 s41, s41, 0
    v_lshlrev_b32 v224, 7, v6
    v_mov_b32 v225, s41
    v_add_co_u32 v224, vcc, s40, v224
    s_nop 1
    v_addc_co_u32 v225, vcc, 0, v225, vcc
    global_load_dword v7, v[224:225], off
    v_mfma_f32_16x16x32_bf16 v[252:255], v[60:63], v[212:215], v[252:255]
    s_lshl_b32 s31, s28, 19
    v_mov_b32 v249, v248
    s_nop 1
    v_permlane16_swap_b32 v248, v249
    v_mfma_f32_16x16x32_bf16 v[252:255], v[60:63], v[220:223], v[252:255]
    s_waitcnt lgkmcnt(0)
    s_nop 1
    v_add_f32 v248, v248, v249
    v_mov_b32 v249, v248
    v_mfma_f32_16x16x32_bf16 a[12:15], a[196:199], v[220:223], a[12:15]
    s_lshl_b32 s44, s39, 6
    s_nop 1
    v_permlane32_swap_b32 v248, v249
    s_nop 1
    v_mfma_f32_16x16x32_bf16 a[12:15], a[192:195], v[212:215], a[12:15]
    s_add_u32 s44, s44, s31
    s_add_u32 s45, s44, 131072
    v_add_f32 v248, v248, v249
    v_rcp_f32 v249, v248
    v_mfma_f32_16x16x32_bf16 a[28:31], a[200:203], v[212:215], a[28:31]
    s_add_u32 s46, s44, 262144
    v_rcp_f32 v248, v248
    s_nop 0
    s_add_u32 s47, s44, 393216
    v_mfma_f32_16x16x32_bf16 a[28:31], a[204:207], v[220:223], a[28:31]
    s_add_u32 s48, s44, 4096
    v_accvgpr_read_b32 v132, a8
    v_accvgpr_read_b32 v133, a9
    v_accvgpr_read_b32 v134, a10
    v_mfma_f32_16x16x32_bf16 a[44:47], a[212:215], v[220:223], a[44:47]
    s_add_u32 s49, s44, 135168
    v_accvgpr_read_b32 v135, a11
    v_accvgpr_read_b32 v136, a24
    v_accvgpr_read_b32 v137, a25
    v_mfma_f32_16x16x32_bf16 a[44:47], a[208:211], v[212:215], a[44:47]
    s_add_u32 s50, s44, 266240
    v_accvgpr_read_b32 v138, a26
    v_accvgpr_read_b32 v139, a27
    v_mul_f32 v132, v132, v248
    v_mfma_f32_16x16x32_bf16 a[60:63], a[216:219], v[212:215], a[60:63]
    s_add_u32 s51, s44, 397312
    v_mul_f32 v133, v133, v248
    v_mul_f32 v134, v134, v248
    v_mul_f32 v135, v135, v248
    v_mfma_f32_16x16x32_bf16 a[60:63], a[220:223], v[220:223], a[60:63]
    v_mul_f32 v136, v136, v248
    v_mul_f32 v137, v137, v248
    v_mul_f32 v138, v138, v248
    v_mfma_f32_16x16x32_bf16 a[76:79], a[228:231], v[220:223], a[76:79]
    v_mul_f32 v139, v139, v248
    v_cvt_pk_bf16_f32 v128, v132, v133
    v_cvt_pk_bf16_f32 v129, v134, v135
    v_mfma_f32_16x16x32_bf16 a[76:79], a[224:227], v[212:215], a[76:79]
    v_cvt_pk_bf16_f32 v130, v136, v137
    v_cvt_pk_bf16_f32 v131, v138, v139
    buffer_store_dwordx4 v[128:131], v1, s[24:27], s44 offen sc1
    v_mfma_f32_16x16x32_bf16 a[92:95], a[232:235], v[212:215], a[92:95]
    v_accvgpr_read_b32 v144, a40
    v_accvgpr_read_b32 v145, a41
    v_accvgpr_read_b32 v146, a42
    v_mfma_f32_16x16x32_bf16 a[92:95], a[236:239], v[220:223], a[92:95]
    v_accvgpr_read_b32 v147, a43
    v_accvgpr_read_b32 v148, a56
    v_mov_b32 v253, v252
    v_mfma_f32_16x16x32_bf16 a[108:111], a[244:247], v[220:223], a[108:111]
    v_accvgpr_read_b32 v149, a57
    v_accvgpr_read_b32 v150, a58
    s_nop 1
    v_mfma_f32_16x16x32_bf16 a[108:111], a[240:243], v[212:215], a[108:111]
    v_accvgpr_read_b32 v151, a59
    v_permlane16_swap_b32 v252, v253
    v_mul_f32 v144, v144, v248
    v_mfma_f32_16x16x32_bf16 a[124:127], a[248:251], v[212:215], a[124:127]
    s_nop 1
    v_mul_f32 v145, v145, v248
    v_add_f32 v252, v252, v253
    v_mfma_f32_16x16x32_bf16 a[124:127], a[252:255], v[220:223], a[124:127]
    v_mul_f32 v146, v146, v248
    v_mov_b32 v253, v252
    v_mul_f32 v147, v147, v248
    s_nop 1
    v_mul_f32 v148, v148, v248
    v_mul_f32 v149, v149, v248
    v_permlane32_swap_b32 v252, v253
    v_mul_f32 v150, v150, v248
    s_nop 1
    v_mul_f32 v151, v151, v248
    v_add_f32 v252, v252, v253
    v_cvt_pk_bf16_f32 v140, v144, v145
    v_rcp_f32 v253, v252
    v_cvt_pk_bf16_f32 v141, v146, v147
    v_rcp_f32 v252, v252
    v_cvt_pk_bf16_f32 v142, v148, v149
    s_nop 0
    v_cvt_pk_bf16_f32 v143, v150, v151
    buffer_store_dwordx4 v[140:143], v1, s[24:27], s45 offen sc1
    v_accvgpr_read_b32 v156, a72
    v_accvgpr_read_b32 v157, a73
    v_accvgpr_read_b32 v158, a74
    v_accvgpr_read_b32 v159, a75
    v_accvgpr_read_b32 v160, a88
    v_accvgpr_read_b32 v161, a89
    v_accvgpr_read_b32 v162, a90
    v_accvgpr_read_b32 v163, a91
    v_mul_f32 v156, v156, v248
    v_mul_f32 v157, v157, v248
    v_mul_f32 v158, v158, v248
    v_mul_f32 v159, v159, v248
    v_mul_f32 v160, v160, v248
    v_mul_f32 v161, v161, v248
    v_mul_f32 v162, v162, v248
    v_mul_f32 v163, v163, v248
    v_cvt_pk_bf16_f32 v152, v156, v157
    v_cvt_pk_bf16_f32 v153, v158, v159
    v_cvt_pk_bf16_f32 v154, v160, v161
    v_cvt_pk_bf16_f32 v155, v162, v163
    buffer_store_dwordx4 v[152:155], v1, s[24:27], s46 offen sc1
    v_accvgpr_read_b32 v168, a104
    v_accvgpr_read_b32 v169, a105
    v_accvgpr_read_b32 v170, a106
    v_accvgpr_read_b32 v171, a107
    v_accvgpr_read_b32 v172, a120
    v_accvgpr_read_b32 v173, a121
    v_accvgpr_read_b32 v174, a122
    v_accvgpr_read_b32 v175, a123
    v_mul_f32 v168, v168, v248
    v_mul_f32 v169, v169, v248
    v_mul_f32 v170, v170, v248
    v_mul_f32 v171, v171, v248
    v_mul_f32 v172, v172, v248
    v_mul_f32 v173, v173, v248
    v_mul_f32 v174, v174, v248
    v_mul_f32 v175, v175, v248
    v_cvt_pk_bf16_f32 v164, v168, v169
    v_cvt_pk_bf16_f32 v165, v170, v171
    v_cvt_pk_bf16_f32 v166, v172, v173
    v_cvt_pk_bf16_f32 v167, v174, v175
    buffer_store_dwordx4 v[164:167], v1, s[24:27], s47 offen sc1
    v_accvgpr_read_b32 v132, a12
    v_accvgpr_read_b32 v133, a13
    v_accvgpr_read_b32 v134, a14
    v_accvgpr_read_b32 v135, a15
    v_accvgpr_read_b32 v136, a28
    v_accvgpr_read_b32 v137, a29
    v_accvgpr_read_b32 v138, a30
    v_accvgpr_read_b32 v139, a31
    v_pk_mul_f32 v[132:133], v[132:133], v[252:253]
    v_pk_mul_f32 v[134:135], v[134:135], v[252:253]
    v_pk_mul_f32 v[136:137], v[136:137], v[252:253]
    v_pk_mul_f32 v[138:139], v[138:139], v[252:253]
    v_cvt_pk_bf16_f32 v128, v132, v133
    v_cvt_pk_bf16_f32 v129, v134, v135
    v_cvt_pk_bf16_f32 v130, v136, v137
    v_cvt_pk_bf16_f32 v131, v138, v139
    v_accvgpr_read_b32 v144, a44
    v_accvgpr_read_b32 v145, a45
    v_accvgpr_read_b32 v146, a46
    v_accvgpr_read_b32 v147, a47
    v_accvgpr_read_b32 v148, a60
    v_accvgpr_read_b32 v149, a61
    v_accvgpr_read_b32 v150, a62
    v_accvgpr_read_b32 v151, a63
    v_pk_mul_f32 v[144:145], v[144:145], v[252:253]
    v_pk_mul_f32 v[146:147], v[146:147], v[252:253]
    v_pk_mul_f32 v[148:149], v[148:149], v[252:253]
    v_pk_mul_f32 v[150:151], v[150:151], v[252:253]
    v_cvt_pk_bf16_f32 v140, v144, v145
    v_cvt_pk_bf16_f32 v141, v146, v147
    v_cvt_pk_bf16_f32 v142, v148, v149
    v_cvt_pk_bf16_f32 v143, v150, v151
    v_accvgpr_read_b32 v156, a76
    v_accvgpr_read_b32 v157, a77
    v_accvgpr_read_b32 v158, a78
    v_accvgpr_read_b32 v159, a79
    v_accvgpr_read_b32 v160, a92
    v_accvgpr_read_b32 v161, a93
    v_accvgpr_read_b32 v162, a94
    v_accvgpr_read_b32 v163, a95
    v_pk_mul_f32 v[156:157], v[156:157], v[252:253]
    v_pk_mul_f32 v[158:159], v[158:159], v[252:253]
    v_pk_mul_f32 v[160:161], v[160:161], v[252:253]
    v_pk_mul_f32 v[162:163], v[162:163], v[252:253]
    v_cvt_pk_bf16_f32 v152, v156, v157
    v_cvt_pk_bf16_f32 v153, v158, v159
    v_cvt_pk_bf16_f32 v154, v160, v161
    v_cvt_pk_bf16_f32 v155, v162, v163
    v_accvgpr_read_b32 v168, a108
    v_accvgpr_read_b32 v169, a109
    v_accvgpr_read_b32 v170, a110
    v_accvgpr_read_b32 v171, a111
    v_accvgpr_read_b32 v172, a124
    v_accvgpr_read_b32 v173, a125
    v_accvgpr_read_b32 v174, a126
    v_accvgpr_read_b32 v175, a127
    v_pk_mul_f32 v[168:169], v[168:169], v[252:253]
    v_pk_mul_f32 v[170:171], v[170:171], v[252:253]
    v_pk_mul_f32 v[172:173], v[172:173], v[252:253]
    v_pk_mul_f32 v[174:175], v[174:175], v[252:253]
    v_cvt_pk_bf16_f32 v164, v168, v169
    v_cvt_pk_bf16_f32 v165, v170, v171
    v_cvt_pk_bf16_f32 v166, v172, v173
    v_cvt_pk_bf16_f32 v167, v174, v175
    buffer_store_dwordx4 v[128:131], v1, s[24:27], s48 offen sc1
    buffer_store_dwordx4 v[140:143], v1, s[24:27], s49 offen sc1
    buffer_store_dwordx4 v[152:155], v1, s[24:27], s50 offen sc1
    buffer_store_dwordx4 v[164:167], v1, s[24:27], s51 offen sc1
op_head:
    s_load_dwordx2 s[28:29], s[0:1], 0
    s_load_dwordx2 s[42:43], s[0:1], 56
    s_waitcnt vmcnt(8)
    v_cmp_le_u32 vcc, 4, v74
    v_mov_b32 v56, 0
    v_mov_b32 v57, 0
    v_mov_b32 v58, 0
    v_mov_b32 v59, 0
    s_nop 1
    v_mfma_f32_32x32x16_bf16 v[128:143], v[56:59], v[56:59], 0
    v_mfma_f32_32x32x16_bf16 v[144:159], v[56:59], v[56:59], 0
    v_mfma_f32_32x32x16_bf16 v[160:175], v[56:59], v[56:59], 0
    v_mfma_f32_32x32x16_bf16 v[176:191], v[56:59], v[56:59], 0
    s_mov_b32 s33, vcc_lo
    s_bitcmp1_b32 s33, 0
    s_cbranch_scc0 op_late_125
    buffer_load_dwordx4 a[128:131], v88, s[8:11], s62 offen offset:0 sc1
    buffer_load_dwordx4 a[132:135], v88, s[8:11], s62 offen offset:1024 sc1
    buffer_load_dwordx4 a[136:139], v89, s[8:11], s62 offen offset:0 sc1
    buffer_load_dwordx4 a[140:143], v89, s[8:11], s62 offen offset:1024 sc1
    s_add_u32 s62, s62, 0x40000
    s_and_b32 s62, s62, 0x7fffff
    buffer_load_dwordx4 a[144:147], v88, s[8:11], s62 offen offset:0 sc1
    buffer_load_dwordx4 a[148:151], v88, s[8:11], s62 offen offset:1024 sc1
    buffer_load_dwordx4 a[152:155], v89, s[8:11], s62 offen offset:0 sc1
    buffer_load_dwordx4 a[156:159], v89, s[8:11], s62 offen offset:1024 sc1
    s_add_u32 s62, s62, 0x40000
    s_and_b32 s62, s62, 0x7fffff
    buffer_load_dwordx4 a[160:163], v88, s[8:11], s62 offen offset:0 sc1
    buffer_load_dwordx4 a[164:167], v88, s[8:11], s62 offen offset:1024 sc1
    buffer_load_dwordx4 a[168:171], v89, s[8:11], s62 offen offset:0 sc1
    buffer_load_dwordx4 a[172:175], v89, s[8:11], s62 offen offset:1024 sc1
    s_add_u32 s62, s62, 0x40000
    s_and_b32 s62, s62, 0x7fffff
    s_waitcnt vmcnt(12)
    s_branch op_join_126
op_late_125:
    s_waitcnt vmcnt(0)
op_join_126:
    s_barrier
    s_cmp_eq_u32 s30, 0
    s_cbranch_scc1 k12_ool_127
k12_oolret_128:
    s_bitcmp0_b32 s33, 0
    s_cbranch_scc1 k12_ool_131
k12_oolret_132:
    ds_read_b64_tr_b16 a[0:1], v64 offset:0
    ds_read_b64_tr_b16 a[2:3], v64 offset:4096
    ds_read_b64_tr_b16 a[4:5], v65 offset:0
    ds_read_b64_tr_b16 a[6:7], v65 offset:4096
    ds_read_b64_tr_b16 a[8:9], v66 offset:0
    ds_read_b64_tr_b16 a[10:11], v66 offset:4096
    ds_read_b64_tr_b16 a[12:13], v67 offset:0
    ds_read_b64_tr_b16 a[14:15], v67 offset:4096
    ds_read_b64_tr_b16 a[16:17], v68 offset:0
    ds_read_b64_tr_b16 a[18:19], v68 offset:4096
    ds_read_b64_tr_b16 a[20:21], v69 offset:0
    ds_read_b64_tr_b16 a[22:23], v69 offset:4096
    ds_read_b64_tr_b16 a[24:25], v70 offset:0
    ds_read_b64_tr_b16 a[26:27], v70 offset:4096
    ds_read_b64_tr_b16 a[28:29], v71 offset:0
    ds_read_b64_tr_b16 a[30:31], v71 offset:4096
    ds_read_b64_tr_b16 a[32:33], v64 offset:8192
    ds_read_b64_tr_b16 a[34:35], v64 offset:12288
    ds_read_b64_tr_b16 a[36:37], v65 offset:8192
    ds_read_b64_tr_b16 a[38:39], v65 offset:12288
    ds_read_b64_tr_b16 a[40:41], v66 offset:8192
    ds_read_b64_tr_b16 a[42:43], v66 offset:12288
    ds_read_b64_tr_b16 a[44:45], v67 offset:8192
    ds_read_b64_tr_b16 a[46:47], v67 offset:12288
    ds_read_b64_tr_b16 a[48:49], v68 offset:8192
    ds_read_b64_tr_b16 a[50:51], v68 offset:12288
    ds_read_b64_tr_b16 a[52:53], v69 offset:8192
    ds_read_b64_tr_b16 a[54:55], v69 offset:12288
    ds_read_b64_tr_b16 a[56:57], v70 offset:8192
    ds_read_b64_tr_b16 a[58:59], v70 offset:12288
    ds_read_b64_tr_b16 a[60:61], v71 offset:8192
    ds_read_b64_tr_b16 a[62:63], v71 offset:12288
    s_add_u32 s24, s6, 0x4000000
    s_addc_u32 s25, s7, 0
    s_and_b32 s25, s25, 0xffff
    s_mov_b32 s26, 0x400000
    s_mov_b32 s27, 0x00020000
    s_add_u32 s36, s6, 0x5000000
    s_addc_u32 s37, s7, 0
    s_and_b32 s37, s37, 0xffff
    s_mov_b32 s38, 0x800000
    s_mov_b32 s39, 0x00020000
    s_add_u32 s48, s6, 0x4807000
    s_addc_u32 s49, s7, 0
    s_and_b32 s49, s49, 0xffff
    s_mov_b32 s50, 0x8000
    s_mov_b32 s51, 0x00020000
    s_lshl_b32 s52, s2, 14
    s_add_u32 s52, s52, s60
    s_xor_b32 s53, s52, 0x10000
    s_lshl_b32 s57, s2, 7
    s_xor_b32 s58, s57, 0x200
    v_lshrrev_b32 v56, 4, v1
    s_lshl_b32 s31, s30, 6
    s_and_b32 s31, s31, 64
    v_add_u32 v56, s31, v56
    s_mov_b32 s31, (code_end-op_tail)/128
    v_min_u32 v56, s31, v56
    s_getpc_b64 s[40:41]
pc_133:
    s_add_u32 s40, s40, op_tail-pc_133
    s_addc_u32 s41, s41, 0
    v_lshlrev_b32 v82, 7, v56
    v_mov_b32 v83, s41
    v_add_co_u32 v82, vcc, s40, v82
    s_nop 1
    v_addc_co_u32 v83, vcc, 0, v83, vcc
    v_lshlrev_b32 v94, 3, v1
    s_and_b32 s35, s2, 7
    s_mul_i32 s35, s35, 28
    s_lshr_b32 s31, s2, 3
    s_add_u32 s55, s35, s31
    s_lshl_b32 s3, s55, 15
    s_lshl_b32 s31, s30, 13
    s_add_u32 s3, s3, s31
    s_add_u32 s35, s31, 65536
    s_mov_b32 s63, 0
    s_waitcnt vmcnt(8) lgkmcnt(0)
    s_mov_b32 s20, s28
    s_and_b32 s21, s29, 0xffff
    s_mov_b32 s22, 0x400000
    s_mov_b32 s23, 0x00020000
    s_mov_b32 s44, s42
    s_and_b32 s45, s43, 0xffff
    s_mov_b32 s46, 0x800
    s_mov_b32 s47, 0x00020000
op_loop_134:
    v_mfma_f32_16x16x32_bf16 v[160:163], a[16:19], a[128:131], v[160:163]
    s_add_u32 m0, s60, 49152
    ds_read_b64_tr_b16 a[64:65], v64 offset:16384
    ds_read_b64_tr_b16 a[66:67], v64 offset:20480
    v_mfma_f32_16x16x32_bf16 v[160:163], a[48:51], a[136:139], v[160:163]
    buffer_load_dwordx4 v90, s[12:15], s61 offen offset:0 lds
    ds_read_b64_tr_b16 a[68:69], v65 offset:16384
    v_mfma_f32_16x16x32_bf16 v[164:167], a[48:51], a[140:143], v[164:167]
    ds_read_b64_tr_b16 a[70:71], v65 offset:20480
    ds_read_b64_tr_b16 a[72:73], v66 offset:16384
    v_mfma_f32_16x16x32_bf16 v[164:167], a[16:19], a[132:135], v[164:167]
    buffer_load_dwordx4 v91, s[12:15], s61 offen offset:1024 lds
    ds_read_b64_tr_b16 a[74:75], v66 offset:20480
    v_mfma_f32_16x16x32_bf16 v[172:175], a[20:23], a[132:135], v[172:175]
    ds_read_b64_tr_b16 a[76:77], v67 offset:16384
    ds_read_b64_tr_b16 a[78:79], v67 offset:20480
    v_mfma_f32_16x16x32_bf16 v[172:175], a[52:55], a[140:143], v[172:175]
    ds_read_b64_tr_b16 a[80:81], v68 offset:16384
    v_mfma_f32_16x16x32_bf16 v[168:171], a[52:55], a[136:139], v[168:171]
    ds_read_b64_tr_b16 a[82:83], v68 offset:20480
    v_mfma_f32_16x16x32_bf16 v[168:171], a[20:23], a[128:131], v[168:171]
    buffer_load_dwordx4 v92, s[12:15], s61 offen offset:2048 lds
    ds_read_b64_tr_b16 a[84:85], v69 offset:16384
    v_mfma_f32_16x16x32_bf16 v[176:179], a[24:27], a[128:131], v[176:179]
    ds_read_b64_tr_b16 a[86:87], v69 offset:20480
    ds_read_b64_tr_b16 a[88:89], v70 offset:16384
    v_mfma_f32_16x16x32_bf16 v[176:179], a[56:59], a[136:139], v[176:179]
    ds_read_b64_tr_b16 a[90:91], v70 offset:20480
    v_mfma_f32_16x16x32_bf16 v[180:183], a[56:59], a[140:143], v[180:183]
    buffer_load_dwordx4 v93, s[12:15], s61 offen offset:3072 lds
    ds_read_b64_tr_b16 a[92:93], v71 offset:16384
    v_mfma_f32_16x16x32_bf16 v[180:183], a[24:27], a[132:135], v[180:183]
    ds_read_b64_tr_b16 a[94:95], v71 offset:20480
    ds_read_b64_tr_b16 a[96:97], v64 offset:24576
    v_mfma_f32_16x16x32_bf16 v[188:191], a[28:31], a[132:135], v[188:191]
    ds_read_b64_tr_b16 a[98:99], v64 offset:28672
    v_mfma_f32_16x16x32_bf16 v[188:191], a[60:63], a[140:143], v[188:191]
    ds_read_b64_tr_b16 a[100:101], v65 offset:24576
    v_mfma_f32_16x16x32_bf16 v[184:187], a[60:63], a[136:139], v[184:187]
    buffer_load_dwordx4 a[176:179], v88, s[8:11], s62 offen offset:0 sc1
    ds_read_b64_tr_b16 a[102:103], v65 offset:28672
    v_mfma_f32_16x16x32_bf16 v[184:187], a[28:31], a[128:131], v[184:187]
    s_add_u32 s61, s61, 0x20000
    s_and_b32 s61, s61, 0x3fffff
    ds_read_b64_tr_b16 a[104:105], v66 offset:24576
    ds_read_b64_tr_b16 a[106:107], v66 offset:28672
    v_mfma_f32_16x16x32_bf16 v[128:131], a[0:3], a[128:131], v[128:131]
    ds_read_b64_tr_b16 a[108:109], v67 offset:24576
    v_mfma_f32_16x16x32_bf16 v[128:131], a[32:35], a[136:139], v[128:131]
    buffer_load_dwordx4 a[180:183], v88, s[8:11], s62 offen offset:1024 sc1
    ds_read_b64_tr_b16 a[110:111], v67 offset:28672
    v_mfma_f32_16x16x32_bf16 v[132:135], a[32:35], a[140:143], v[132:135]
    ds_read_b64_tr_b16 a[112:113], v68 offset:24576
    v_mfma_f32_16x16x32_bf16 v[132:135], a[0:3], a[132:135], v[132:135]
    ds_read_b64_tr_b16 a[114:115], v68 offset:28672
    ds_read_b64_tr_b16 a[116:117], v69 offset:24576
    v_mfma_f32_16x16x32_bf16 v[140:143], a[4:7], a[132:135], v[140:143]
    ds_read_b64_tr_b16 a[118:119], v69 offset:28672
    v_mfma_f32_16x16x32_bf16 v[140:143], a[36:39], a[140:143], v[140:143]
    buffer_load_dwordx4 a[184:187], v89, s[8:11], s62 offen offset:0 sc1
    ds_read_b64_tr_b16 a[120:121], v70 offset:24576
    v_mfma_f32_16x16x32_bf16 v[136:139], a[36:39], a[136:139], v[136:139]
    ds_read_b64_tr_b16 a[122:123], v70 offset:28672
    ds_read_b64_tr_b16 a[124:125], v71 offset:24576
    v_mfma_f32_16x16x32_bf16 v[136:139], a[4:7], a[128:131], v[136:139]
    ds_read_b64_tr_b16 a[126:127], v71 offset:28672
    v_mfma_f32_16x16x32_bf16 v[144:147], a[8:11], a[128:131], v[144:147]
    buffer_load_dwordx4 a[188:191], v89, s[8:11], s62 offen offset:1024 sc1
    v_mfma_f32_16x16x32_bf16 v[144:147], a[40:43], a[136:139], v[144:147]
    v_mfma_f32_16x16x32_bf16 v[148:151], a[40:43], a[140:143], v[148:151]
    v_mfma_f32_16x16x32_bf16 v[148:151], a[8:11], a[132:135], v[148:151]
    v_mfma_f32_16x16x32_bf16 v[156:159], a[12:15], a[132:135], v[156:159]
    s_cmp_eq_u32 s63, 7
    s_cbranch_scc1 k12_ool_137
k12_oolret_138:
    v_mfma_f32_16x16x32_bf16 v[156:159], a[44:47], a[140:143], v[156:159]
    s_add_u32 s62, s62, 0x40000
    s_and_b32 s62, s62, 0x7fffff
    v_mfma_f32_16x16x32_bf16 v[152:155], a[44:47], a[136:139], v[152:155]
    v_mfma_f32_16x16x32_bf16 v[152:155], a[12:15], a[128:131], v[152:155]
    s_waitcnt vmcnt(12) lgkmcnt(0)
    s_barrier
    v_mfma_f32_16x16x32_bf16 v[160:163], a[80:83], a[144:147], v[160:163]
    s_add_u32 s32, s63, 1
    s_lshr_b32 s32, s32, 1
    ds_read_b64_tr_b16 a[0:1], v64 offset:32768
    v_cmp_le_u32 vcc, 4, v74
    v_mfma_f32_16x16x32_bf16 v[160:163], a[112:115], a[152:155], v[160:163]
    s_add_u32 m0, s60, 0
    ds_read_b64_tr_b16 a[2:3], v64 offset:36864
    ds_read_b64_tr_b16 a[4:5], v65 offset:32768
    v_mfma_f32_16x16x32_bf16 v[164:167], a[112:115], a[156:159], v[164:167]
    s_or_b32 s33, vcc_lo, 16
    buffer_load_dwordx4 v90, s[12:15], s61 offen offset:0 lds
    ds_read_b64_tr_b16 a[6:7], v65 offset:36864
    v_mfma_f32_16x16x32_bf16 v[164:167], a[80:83], a[148:151], v[164:167]
    ds_read_b64_tr_b16 a[8:9], v66 offset:32768
    ds_read_b64_tr_b16 a[10:11], v66 offset:36864
    v_mfma_f32_16x16x32_bf16 v[172:175], a[84:87], a[148:151], v[172:175]
    buffer_load_dwordx4 v91, s[12:15], s61 offen offset:1024 lds
    ds_read_b64_tr_b16 a[12:13], v67 offset:32768
    v_mfma_f32_16x16x32_bf16 v[172:175], a[116:119], a[156:159], v[172:175]
    ds_read_b64_tr_b16 a[14:15], v67 offset:36864
    ds_read_b64_tr_b16 a[16:17], v68 offset:32768
    v_mfma_f32_16x16x32_bf16 v[168:171], a[116:119], a[152:155], v[168:171]
    s_bitcmp0_b32 s33, s32
    s_cbranch_scc1 k12_ool_141
k12_oolret_142:
    v_mfma_f32_16x16x32_bf16 v[168:171], a[84:87], a[144:147], v[168:171]
    ds_read_b64_tr_b16 a[18:19], v68 offset:36864
    ds_read_b64_tr_b16 a[20:21], v69 offset:32768
    v_mfma_f32_16x16x32_bf16 v[176:179], a[88:91], a[144:147], v[176:179]
    buffer_load_dwordx4 v92, s[12:15], s61 offen offset:2048 lds
    ds_read_b64_tr_b16 a[22:23], v69 offset:36864
    v_mfma_f32_16x16x32_bf16 v[176:179], a[120:123], a[152:155], v[176:179]
    ds_read_b64_tr_b16 a[24:25], v70 offset:32768
    ds_read_b64_tr_b16 a[26:27], v70 offset:36864
    v_mfma_f32_16x16x32_bf16 v[180:183], a[120:123], a[156:159], v[180:183]
    buffer_load_dwordx4 v93, s[12:15], s61 offen offset:3072 lds
    ds_read_b64_tr_b16 a[28:29], v71 offset:32768
    v_mfma_f32_16x16x32_bf16 v[180:183], a[88:91], a[148:151], v[180:183]
    ds_read_b64_tr_b16 a[30:31], v71 offset:36864
    ds_read_b64_tr_b16 a[32:33], v64 offset:40960
    v_mfma_f32_16x16x32_bf16 v[188:191], a[92:95], a[148:151], v[188:191]
    ds_read_b64_tr_b16 a[34:35], v64 offset:45056
    v_mfma_f32_16x16x32_bf16 v[188:191], a[124:127], a[156:159], v[188:191]
    ds_read_b64_tr_b16 a[36:37], v65 offset:40960
    v_mfma_f32_16x16x32_bf16 v[184:187], a[124:127], a[152:155], v[184:187]
    buffer_load_dwordx4 a[128:131], v88, s[8:11], s62 offen offset:0 sc1
    ds_read_b64_tr_b16 a[38:39], v65 offset:45056
    v_mfma_f32_16x16x32_bf16 v[184:187], a[92:95], a[144:147], v[184:187]
    s_add_u32 s61, s61, 0x20000
    s_and_b32 s61, s61, 0x3fffff
    ds_read_b64_tr_b16 a[40:41], v66 offset:40960
    ds_read_b64_tr_b16 a[42:43], v66 offset:45056
    v_mfma_f32_16x16x32_bf16 v[128:131], a[64:67], a[144:147], v[128:131]
    ds_read_b64_tr_b16 a[44:45], v67 offset:40960
    v_mfma_f32_16x16x32_bf16 v[128:131], a[96:99], a[152:155], v[128:131]
    buffer_load_dwordx4 a[132:135], v88, s[8:11], s62 offen offset:1024 sc1
    ds_read_b64_tr_b16 a[46:47], v67 offset:45056
    v_mfma_f32_16x16x32_bf16 v[132:135], a[96:99], a[156:159], v[132:135]
    ds_read_b64_tr_b16 a[48:49], v68 offset:40960
    v_mfma_f32_16x16x32_bf16 v[132:135], a[64:67], a[148:151], v[132:135]
    ds_read_b64_tr_b16 a[50:51], v68 offset:45056
    ds_read_b64_tr_b16 a[52:53], v69 offset:40960
    v_mfma_f32_16x16x32_bf16 v[140:143], a[68:71], a[148:151], v[140:143]
    ds_read_b64_tr_b16 a[54:55], v69 offset:45056
    v_mfma_f32_16x16x32_bf16 v[140:143], a[100:103], a[156:159], v[140:143]
    buffer_load_dwordx4 a[136:139], v89, s[8:11], s62 offen offset:0 sc1
    ds_read_b64_tr_b16 a[56:57], v70 offset:40960
    v_mfma_f32_16x16x32_bf16 v[136:139], a[100:103], a[152:155], v[136:139]
    ds_read_b64_tr_b16 a[58:59], v70 offset:45056
    ds_read_b64_tr_b16 a[60:61], v71 offset:40960
    v_mfma_f32_16x16x32_bf16 v[136:139], a[68:71], a[144:147], v[136:139]
    ds_read_b64_tr_b16 a[62:63], v71 offset:45056
    v_mfma_f32_16x16x32_bf16 v[144:147], a[72:75], a[144:147], v[144:147]
    buffer_load_dwordx4 a[140:143], v89, s[8:11], s62 offen offset:1024 sc1
    v_mfma_f32_16x16x32_bf16 v[144:147], a[104:107], a[152:155], v[144:147]
    v_mfma_f32_16x16x32_bf16 v[148:151], a[104:107], a[156:159], v[148:151]
    s_cmp_eq_u32 s63, 6
    s_cbranch_scc1 k12_ool_143
k12_oolret_144:
    v_mfma_f32_16x16x32_bf16 v[148:151], a[72:75], a[148:151], v[148:151]
    v_mfma_f32_16x16x32_bf16 v[156:159], a[76:79], a[148:151], v[156:159]
    v_mfma_f32_16x16x32_bf16 v[156:159], a[108:111], a[156:159], v[156:159]
    s_add_u32 s62, s62, 0x40000
    s_and_b32 s62, s62, 0x7fffff
    v_mfma_f32_16x16x32_bf16 v[152:155], a[108:111], a[152:155], v[152:155]
    v_mfma_f32_16x16x32_bf16 v[152:155], a[76:79], a[144:147], v[152:155]
    s_waitcnt vmcnt(12) lgkmcnt(0)
    s_barrier
    v_mfma_f32_16x16x32_bf16 v[160:163], a[16:19], a[160:163], v[160:163]
    s_add_u32 m0, s60, 16384
    buffer_load_dword v74, v73, s[16:19], s59 offen sc1
    ds_read_b64_tr_b16 a[64:65], v64 offset:49152
    v_mfma_f32_16x16x32_bf16 v[160:163], a[48:51], a[168:171], v[160:163]
    buffer_load_dwordx4 v90, s[12:15], s61 offen offset:0 lds
    ds_read_b64_tr_b16 a[66:67], v64 offset:53248
    v_mfma_f32_16x16x32_bf16 v[164:167], a[48:51], a[172:175], v[164:167]
    ds_read_b64_tr_b16 a[68:69], v65 offset:49152
    ds_read_b64_tr_b16 a[70:71], v65 offset:53248
    v_mfma_f32_16x16x32_bf16 v[164:167], a[16:19], a[164:167], v[164:167]
    ds_read_b64_tr_b16 a[72:73], v66 offset:49152
    ds_read_b64_tr_b16 a[74:75], v66 offset:53248
    v_mfma_f32_16x16x32_bf16 v[172:175], a[20:23], a[164:167], v[172:175]
    buffer_load_dwordx4 v91, s[12:15], s61 offen offset:1024 lds
    ds_read_b64_tr_b16 a[76:77], v67 offset:49152
    v_mfma_f32_16x16x32_bf16 v[172:175], a[52:55], a[172:175], v[172:175]
    ds_read_b64_tr_b16 a[78:79], v67 offset:53248
    ds_read_b64_tr_b16 a[80:81], v68 offset:49152
    v_mfma_f32_16x16x32_bf16 v[168:171], a[52:55], a[168:171], v[168:171]
    ds_read_b64_tr_b16 a[82:83], v68 offset:53248
    v_mfma_f32_16x16x32_bf16 v[168:171], a[20:23], a[160:163], v[168:171]
    buffer_load_dwordx4 v92, s[12:15], s61 offen offset:2048 lds
    ds_read_b64_tr_b16 a[84:85], v69 offset:49152
    v_mfma_f32_16x16x32_bf16 v[176:179], a[24:27], a[160:163], v[176:179]
    ds_read_b64_tr_b16 a[86:87], v69 offset:53248
    ds_read_b64_tr_b16 a[88:89], v70 offset:49152
    v_mfma_f32_16x16x32_bf16 v[176:179], a[56:59], a[168:171], v[176:179]
    ds_read_b64_tr_b16 a[90:91], v70 offset:53248
    v_mfma_f32_16x16x32_bf16 v[180:183], a[56:59], a[172:175], v[180:183]
    buffer_load_dwordx4 v93, s[12:15], s61 offen offset:3072 lds
    ds_read_b64_tr_b16 a[92:93], v71 offset:49152
    v_mfma_f32_16x16x32_bf16 v[180:183], a[24:27], a[164:167], v[180:183]
    ds_read_b64_tr_b16 a[94:95], v71 offset:53248
    ds_read_b64_tr_b16 a[96:97], v64 offset:57344
    v_mfma_f32_16x16x32_bf16 v[188:191], a[28:31], a[164:167], v[188:191]
    ds_read_b64_tr_b16 a[98:99], v64 offset:61440
    v_mfma_f32_16x16x32_bf16 v[188:191], a[60:63], a[172:175], v[188:191]
    ds_read_b64_tr_b16 a[100:101], v65 offset:57344
    v_mfma_f32_16x16x32_bf16 v[184:187], a[60:63], a[168:171], v[184:187]
    buffer_load_dwordx4 a[144:147], v88, s[8:11], s62 offen offset:0 sc1
    ds_read_b64_tr_b16 a[102:103], v65 offset:61440
    v_mfma_f32_16x16x32_bf16 v[184:187], a[28:31], a[160:163], v[184:187]
    s_add_u32 s61, s61, 0x20000
    s_and_b32 s61, s61, 0x3fffff
    ds_read_b64_tr_b16 a[104:105], v66 offset:57344
    ds_read_b64_tr_b16 a[106:107], v66 offset:61440
    v_mfma_f32_16x16x32_bf16 v[128:131], a[0:3], a[160:163], v[128:131]
    ds_read_b64_tr_b16 a[108:109], v67 offset:57344
    v_mfma_f32_16x16x32_bf16 v[128:131], a[32:35], a[168:171], v[128:131]
    buffer_load_dwordx4 a[148:151], v88, s[8:11], s62 offen offset:1024 sc1
    ds_read_b64_tr_b16 a[110:111], v67 offset:61440
    v_mfma_f32_16x16x32_bf16 v[132:135], a[32:35], a[172:175], v[132:135]
    ds_read_b64_tr_b16 a[112:113], v68 offset:57344
    v_mfma_f32_16x16x32_bf16 v[132:135], a[0:3], a[164:167], v[132:135]
    ds_read_b64_tr_b16 a[114:115], v68 offset:61440
    ds_read_b64_tr_b16 a[116:117], v69 offset:57344
    v_mfma_f32_16x16x32_bf16 v[140:143], a[4:7], a[164:167], v[140:143]
    ds_read_b64_tr_b16 a[118:119], v69 offset:61440
    v_mfma_f32_16x16x32_bf16 v[140:143], a[36:39], a[172:175], v[140:143]
    buffer_load_dwordx4 a[152:155], v89, s[8:11], s62 offen offset:0 sc1
    ds_read_b64_tr_b16 a[120:121], v70 offset:57344
    v_mfma_f32_16x16x32_bf16 v[136:139], a[36:39], a[168:171], v[136:139]
    ds_read_b64_tr_b16 a[122:123], v70 offset:61440
    ds_read_b64_tr_b16 a[124:125], v71 offset:57344
    v_mfma_f32_16x16x32_bf16 v[136:139], a[4:7], a[160:163], v[136:139]
    ds_read_b64_tr_b16 a[126:127], v71 offset:61440
    v_mfma_f32_16x16x32_bf16 v[144:147], a[8:11], a[160:163], v[144:147]
    buffer_load_dwordx4 a[156:159], v89, s[8:11], s62 offen offset:1024 sc1
    v_mfma_f32_16x16x32_bf16 v[144:147], a[40:43], a[168:171], v[144:147]
    v_mfma_f32_16x16x32_bf16 v[148:151], a[40:43], a[172:175], v[148:151]
    v_mfma_f32_16x16x32_bf16 v[148:151], a[8:11], a[164:167], v[148:151]
    v_mfma_f32_16x16x32_bf16 v[156:159], a[12:15], a[164:167], v[156:159]
    v_mfma_f32_16x16x32_bf16 v[156:159], a[44:47], a[172:175], v[156:159]
    s_add_u32 s62, s62, 0x40000
    s_and_b32 s62, s62, 0x7fffff
    v_mfma_f32_16x16x32_bf16 v[152:155], a[44:47], a[168:171], v[152:155]
    v_mfma_f32_16x16x32_bf16 v[152:155], a[12:15], a[160:163], v[152:155]
    s_waitcnt vmcnt(12) lgkmcnt(0)
    s_barrier
    v_mfma_f32_16x16x32_bf16 v[160:163], a[80:83], a[176:179], v[160:163]
    s_add_u32 m0, s60, 32768
    ds_read_b64_tr_b16 a[0:1], v64 offset:0
    ds_read_b64_tr_b16 a[2:3], v64 offset:4096
    v_mfma_f32_16x16x32_bf16 v[160:163], a[112:115], a[184:187], v[160:163]
    buffer_load_dwordx4 v90, s[12:15], s61 offen offset:0 lds
    ds_read_b64_tr_b16 a[4:5], v65 offset:0
    v_mfma_f32_16x16x32_bf16 v[164:167], a[112:115], a[188:191], v[164:167]
    ds_read_b64_tr_b16 a[6:7], v65 offset:4096
    ds_read_b64_tr_b16 a[8:9], v66 offset:0
    v_mfma_f32_16x16x32_bf16 v[164:167], a[80:83], a[180:183], v[164:167]
    buffer_load_dwordx4 v91, s[12:15], s61 offen offset:1024 lds
    ds_read_b64_tr_b16 a[10:11], v66 offset:4096
    v_mfma_f32_16x16x32_bf16 v[172:175], a[84:87], a[180:183], v[172:175]
    ds_read_b64_tr_b16 a[12:13], v67 offset:0
    ds_read_b64_tr_b16 a[14:15], v67 offset:4096
    v_mfma_f32_16x16x32_bf16 v[172:175], a[116:119], a[188:191], v[172:175]
    ds_read_b64_tr_b16 a[16:17], v68 offset:0
    v_mfma_f32_16x16x32_bf16 v[168:171], a[116:119], a[184:187], v[168:171]
    ds_read_b64_tr_b16 a[18:19], v68 offset:4096
    v_mfma_f32_16x16x32_bf16 v[168:171], a[84:87], a[176:179], v[168:171]
    buffer_load_dwordx4 v92, s[12:15], s61 offen offset:2048 lds
    ds_read_b64_tr_b16 a[20:21], v69 offset:0
    v_mfma_f32_16x16x32_bf16 v[176:179], a[88:91], a[176:179], v[176:179]
    ds_read_b64_tr_b16 a[22:23], v69 offset:4096
    ds_read_b64_tr_b16 a[24:25], v70 offset:0
    v_mfma_f32_16x16x32_bf16 v[176:179], a[120:123], a[184:187], v[176:179]
    ds_read_b64_tr_b16 a[26:27], v70 offset:4096
    v_mfma_f32_16x16x32_bf16 v[180:183], a[120:123], a[188:191], v[180:183]
    buffer_load_dwordx4 v93, s[12:15], s61 offen offset:3072 lds
    ds_read_b64_tr_b16 a[28:29], v71 offset:0
    v_mfma_f32_16x16x32_bf16 v[180:183], a[88:91], a[180:183], v[180:183]
    ds_read_b64_tr_b16 a[30:31], v71 offset:4096
    ds_read_b64_tr_b16 a[32:33], v64 offset:8192
    v_mfma_f32_16x16x32_bf16 v[188:191], a[92:95], a[180:183], v[188:191]
    ds_read_b64_tr_b16 a[34:35], v64 offset:12288
    v_mfma_f32_16x16x32_bf16 v[188:191], a[124:127], a[188:191], v[188:191]
    ds_read_b64_tr_b16 a[36:37], v65 offset:8192
    v_mfma_f32_16x16x32_bf16 v[184:187], a[124:127], a[184:187], v[184:187]
    buffer_load_dwordx4 a[160:163], v88, s[8:11], s62 offen offset:0 sc1
    ds_read_b64_tr_b16 a[38:39], v65 offset:12288
    v_mfma_f32_16x16x32_bf16 v[184:187], a[92:95], a[176:179], v[184:187]
    s_add_u32 s61, s61, 0x20000
    s_and_b32 s61, s61, 0x3fffff
    ds_read_b64_tr_b16 a[40:41], v66 offset:8192
    ds_read_b64_tr_b16 a[42:43], v66 offset:12288
    v_mfma_f32_16x16x32_bf16 v[128:131], a[64:67], a[176:179], v[128:131]
    ds_read_b64_tr_b16 a[44:45], v67 offset:8192
    v_mfma_f32_16x16x32_bf16 v[128:131], a[96:99], a[184:187], v[128:131]
    buffer_load_dwordx4 a[164:167], v88, s[8:11], s62 offen offset:1024 sc1
    ds_read_b64_tr_b16 a[46:47], v67 offset:12288
    v_mfma_f32_16x16x32_bf16 v[132:135], a[96:99], a[188:191], v[132:135]
    ds_read_b64_tr_b16 a[48:49], v68 offset:8192
    v_mfma_f32_16x16x32_bf16 v[132:135], a[64:67], a[180:183], v[132:135]
    ds_read_b64_tr_b16 a[50:51], v68 offset:12288
    ds_read_b64_tr_b16 a[52:53], v69 offset:8192
    v_mfma_f32_16x16x32_bf16 v[140:143], a[68:71], a[180:183], v[140:143]
    ds_read_b64_tr_b16 a[54:55], v69 offset:12288
    v_mfma_f32_16x16x32_bf16 v[140:143], a[100:103], a[188:191], v[140:143]
    buffer_load_dwordx4 a[168:171], v89, s[8:11], s62 offen offset:0 sc1
    ds_read_b64_tr_b16 a[56:57], v70 offset:8192
    v_mfma_f32_16x16x32_bf16 v[136:139], a[100:103], a[184:187], v[136:139]
    ds_read_b64_tr_b16 a[58:59], v70 offset:12288
    ds_read_b64_tr_b16 a[60:61], v71 offset:8192
    v_mfma_f32_16x16x32_bf16 v[136:139], a[68:71], a[176:179], v[136:139]
    ds_read_b64_tr_b16 a[62:63], v71 offset:12288
    v_mfma_f32_16x16x32_bf16 v[144:147], a[72:75], a[176:179], v[144:147]
    buffer_load_dwordx4 a[172:175], v89, s[8:11], s62 offen offset:1024 sc1
    v_mfma_f32_16x16x32_bf16 v[144:147], a[104:107], a[184:187], v[144:147]
    v_mfma_f32_16x16x32_bf16 v[148:151], a[104:107], a[188:191], v[148:151]
    v_mfma_f32_16x16x32_bf16 v[148:151], a[72:75], a[180:183], v[148:151]
    v_mfma_f32_16x16x32_bf16 v[156:159], a[76:79], a[180:183], v[156:159]
    v_mfma_f32_16x16x32_bf16 v[156:159], a[108:111], a[188:191], v[156:159]
    s_add_u32 s62, s62, 0x40000
    s_and_b32 s62, s62, 0x7fffff
    v_mfma_f32_16x16x32_bf16 v[152:155], a[108:111], a[184:187], v[152:155]
    s_add_u32 s63, s63, 1
    v_mfma_f32_16x16x32_bf16 v[152:155], a[76:79], a[176:179], v[152:155]
    s_waitcnt vmcnt(12) lgkmcnt(0)
    s_barrier
    s_cmp_lt_u32 s63, 8
    s_cbranch_scc1 op_loop_134
op_tail:
    s_nop 1
    v_cvt_pk_bf16_f32 v160, v160, v161
    v_cvt_pk_bf16_f32 v161, v162, v163
    v_cvt_pk_bf16_f32 v162, v164, v165
    v_cvt_pk_bf16_f32 v163, v166, v167
    v_min_u32 v160, -2, v160
    v_min_u32 v161, -2, v161
    v_min_u32 v162, -2, v162
    v_min_u32 v163, -2, v163
    buffer_store_dwordx4 v[160:163], v1, s[36:39], s52 offen offset:0 sc1
    v_cvt_pk_bf16_f32 v168, v168, v169
    v_cvt_pk_bf16_f32 v169, v170, v171
    v_cvt_pk_bf16_f32 v170, v172, v173
    v_cvt_pk_bf16_f32 v171, v174, v175
    v_min_u32 v168, -2, v168
    v_min_u32 v169, -2, v169
    v_min_u32 v170, -2, v170
    v_min_u32 v171, -2, v171
    buffer_store_dwordx4 v[168:171], v1, s[36:39], s52 offen offset:1024 sc1
    v_cvt_pk_bf16_f32 v176, v176, v177
    v_cvt_pk_bf16_f32 v177, v178, v179
    v_cvt_pk_bf16_f32 v178, v180, v181
    v_cvt_pk_bf16_f32 v179, v182, v183
    v_min_u32 v176, -2, v176
    v_min_u32 v177, -2, v177
    v_min_u32 v178, -2, v178
    v_min_u32 v179, -2, v179
    buffer_store_dwordx4 v[176:179], v1, s[36:39], s52 offen offset:2048 sc1
    v_cvt_pk_bf16_f32 v184, v184, v185
    v_cvt_pk_bf16_f32 v185, v186, v187
    v_cvt_pk_bf16_f32 v186, v188, v189
    v_cvt_pk_bf16_f32 v187, v190, v191
    v_min_u32 v184, -2, v184
    v_min_u32 v185, -2, v185
    v_min_u32 v186, -2, v186
    v_min_u32 v187, -2, v187
    buffer_store_dwordx4 v[184:187], v1, s[36:39], s52 offen offset:3072 sc1
    s_add_u32 s32, s6, 0x4800000
    s_addc_u32 s33, s7, 0
    s_and_b32 s33, s33, 0xffff
    s_mov_b32 s34, 0x6000
    s_mov_b32 s35, 0x00020000
    s_waitcnt vmcnt(4) lgkmcnt(0)
    v_lshlrev_b32 v58, 16, v192
    v_and_b32 v59, 0xffff0000, v192
    v_pk_add_f32 v[128:129], v[128:129], v[58:59]
    v_lshlrev_b32 v58, 16, v193
    v_and_b32 v59, 0xffff0000, v193
    v_pk_add_f32 v[130:131], v[130:131], v[58:59]
    v_lshlrev_b32 v58, 16, v200
    v_and_b32 v59, 0xffff0000, v200
    v_pk_add_f32 v[132:133], v[132:133], v[58:59]
    v_lshlrev_b32 v58, 16, v201
    v_and_b32 v59, 0xffff0000, v201
    v_pk_add_f32 v[134:135], v[134:135], v[58:59]
    v_lshlrev_b32 v58, 16, v194
    v_and_b32 v59, 0xffff0000, v194
    v_pk_add_f32 v[136:137], v[136:137], v[58:59]
    v_lshlrev_b32 v58, 16, v195
    v_and_b32 v59, 0xffff0000, v195
    v_pk_add_f32 v[138:139], v[138:139], v[58:59]
    v_lshlrev_b32 v58, 16, v202
    v_and_b32 v59, 0xffff0000, v202
    v_pk_add_f32 v[140:141], v[140:141], v[58:59]
    v_lshlrev_b32 v58, 16, v203
    v_and_b32 v59, 0xffff0000, v203
    v_pk_add_f32 v[142:143], v[142:143], v[58:59]
    v_lshlrev_b32 v58, 16, v196
    v_and_b32 v59, 0xffff0000, v196
    v_pk_add_f32 v[144:145], v[144:145], v[58:59]
    v_lshlrev_b32 v58, 16, v197
    v_and_b32 v59, 0xffff0000, v197
    v_pk_add_f32 v[146:147], v[146:147], v[58:59]
    v_lshlrev_b32 v58, 16, v204
    v_and_b32 v59, 0xffff0000, v204
    v_pk_add_f32 v[148:149], v[148:149], v[58:59]
    v_lshlrev_b32 v58, 16, v205
    v_and_b32 v59, 0xffff0000, v205
    v_pk_add_f32 v[150:151], v[150:151], v[58:59]
    v_lshlrev_b32 v58, 16, v198
    v_and_b32 v59, 0xffff0000, v198
    v_pk_add_f32 v[152:153], v[152:153], v[58:59]
    v_lshlrev_b32 v58, 16, v199
    v_and_b32 v59, 0xffff0000, v199
    v_pk_add_f32 v[154:155], v[154:155], v[58:59]
    v_lshlrev_b32 v58, 16, v206
    v_and_b32 v59, 0xffff0000, v206
    v_pk_add_f32 v[156:157], v[156:157], v[58:59]
    v_lshlrev_b32 v58, 16, v207
    v_and_b32 v59, 0xffff0000, v207
    v_pk_add_f32 v[158:159], v[158:159], v[58:59]
    v_and_b32 v58, 1, v72
    v_lshrrev_b32 v59, 1, v72
    v_lshlrev_b32 v58, 5, v58
    v_lshl_add_u32 v58, v59, 4, v58
    v_lshlrev_b32 v59, 3, v72
    v_sub_u32 v58, v58, v59
    v_add_u32 v78, v78, v58
    v_add_u32 v79, v79, v58
    s_mov_b32 s42, 0x00003f80
    s_mov_b32 s43, 0x3f800000
    s_mov_b32 s41, 0x3f803f80
    s_or_b32 s31, s54, s30
    s_cbranch_scc1 op_nowr_145
    v_dot2_f32_bf16 v56, v208, s41, 0
    v_dot2_f32_bf16 v56, v209, s41, v56
    v_dot2_f32_bf16 v56, v210, s41, v56
    v_dot2_f32_bf16 v56, v211, s41, v56
    v_dot2_f32_bf16 v56, v212, s41, v56
    v_dot2_f32_bf16 v56, v213, s41, v56
    v_dot2_f32_bf16 v56, v214, s41, v56
    v_dot2_f32_bf16 v56, v215, s41, v56
    s_nop 2
    v_mov_b32 v57, v56
    s_nop 1
    v_permlane16_swap_b32 v56, v57
    s_nop 1
    v_add_f32 v56, v56, v57
    v_mov_b32 v57, v56
    s_nop 1
    v_permlane32_swap_b32 v56, v57
    s_nop 1
    v_add_f32 v56, v56, v57
    s_mov_b32 s31, 24704
    s_mov_b32 s34, 24708
    s_mov_b64 exec, 1
    buffer_atomic_add_f32 v56, v75, s[32:35], s31 offen
    s_mov_b64 exec, -1
    s_mov_b32 s34, 24576
op_nowr_145:
    s_mov_b32 s40, 1048576
op_xspin_146:
    buffer_load_dwordx4 v[224:227], v1, s[36:39], s53 offen offset:0 sc1
    buffer_load_dwordx4 v[228:231], v1, s[36:39], s53 offen offset:1024 sc1
    buffer_load_dwordx4 v[232:235], v1, s[36:39], s53 offen offset:2048 sc1
    buffer_load_dwordx4 v[236:239], v1, s[36:39], s53 offen offset:3072 sc1
    s_sub_u32 s40, s40, 1
    s_waitcnt vmcnt(0)
    s_cbranch_scc1 op_xok_147
    v_max3_u32 v56, v224, v225, v226
    v_max3_u32 v56, v56, v227, v228
    v_max3_u32 v56, v56, v229, v230
    v_max3_u32 v56, v56, v231, v232
    v_max3_u32 v56, v56, v233, v234
    v_max3_u32 v56, v56, v235, v236
    v_max3_u32 v56, v56, v237, v238
    v_max_u32 v56, v56, v239
    v_cmp_eq_u32 vcc, -1, v56
    s_cbranch_vccz op_xok_147
    s_sleep 2
    s_branch op_xspin_146
op_xok_147:
    v_dot2_f32_bf16 v128, v224, s42, v128
    v_dot2_f32_bf16 v129, v224, s43, v129
    v_dot2_f32_bf16 v130, v225, s42, v130
    v_dot2_f32_bf16 v131, v225, s43, v131
    v_dot2_f32_bf16 v132, v226, s42, v132
    v_dot2_f32_bf16 v133, v226, s43, v133
    v_dot2_f32_bf16 v134, v227, s42, v134
    v_dot2_f32_bf16 v135, v227, s43, v135
    s_nop 0
    v_cvt_pk_bf16_f32 v192, v128, v129
    v_cvt_pk_bf16_f32 v193, v130, v131
    v_cvt_pk_bf16_f32 v200, v132, v133
    v_cvt_pk_bf16_f32 v201, v134, v135
    v_dot2_f32_bf16 v48, v192, s41, 0
    v_dot2_f32_bf16 v49, v192, v192, 0
    v_dot2_f32_bf16 v50, v192, v208, 0
    v_dot2_f32_bf16 v48, v193, s41, v48
    v_dot2_f32_bf16 v49, v193, v193, v49
    v_dot2_f32_bf16 v50, v193, v209, v50
    v_dot2_f32_bf16 v52, v200, s41, 0
    v_dot2_f32_bf16 v53, v200, v200, 0
    v_dot2_f32_bf16 v54, v200, v208, 0
    v_dot2_f32_bf16 v52, v201, s41, v52
    v_dot2_f32_bf16 v53, v201, v201, v53
    v_dot2_f32_bf16 v54, v201, v209, v54
    v_dot2_f32_bf16 v136, v228, s42, v136
    v_dot2_f32_bf16 v137, v228, s43, v137
    v_dot2_f32_bf16 v138, v229, s42, v138
    v_dot2_f32_bf16 v139, v229, s43, v139
    v_dot2_f32_bf16 v140, v230, s42, v140
    v_dot2_f32_bf16 v141, v230, s43, v141
    v_dot2_f32_bf16 v142, v231, s42, v142
    v_dot2_f32_bf16 v143, v231, s43, v143
    s_nop 0
    v_cvt_pk_bf16_f32 v194, v136, v137
    v_cvt_pk_bf16_f32 v195, v138, v139
    v_cvt_pk_bf16_f32 v202, v140, v141
    v_cvt_pk_bf16_f32 v203, v142, v143
    v_dot2_f32_bf16 v48, v194, s41, v48
    v_dot2_f32_bf16 v49, v194, v194, v49
    v_dot2_f32_bf16 v50, v194, v210, v50
    v_dot2_f32_bf16 v48, v195, s41, v48
    v_dot2_f32_bf16 v49, v195, v195, v49
    v_dot2_f32_bf16 v50, v195, v211, v50
    v_permlane16_swap_b32 v192, v194
    v_permlane16_swap_b32 v193, v195
    buffer_store_dwordx4 v[192:195], v78, s[24:27], 0 offen offset:0 sc1
    v_dot2_f32_bf16 v52, v202, s41, v52
    v_dot2_f32_bf16 v53, v202, v202, v53
    v_dot2_f32_bf16 v54, v202, v210, v54
    v_dot2_f32_bf16 v52, v203, s41, v52
    v_dot2_f32_bf16 v53, v203, v203, v53
    v_dot2_f32_bf16 v54, v203, v211, v54
    v_permlane16_swap_b32 v200, v202
    v_permlane16_swap_b32 v201, v203
    buffer_store_dwordx4 v[200:203], v79, s[24:27], 0 offen offset:0 sc1
    v_dot2_f32_bf16 v144, v232, s42, v144
    v_dot2_f32_bf16 v145, v232, s43, v145
    v_dot2_f32_bf16 v146, v233, s42, v146
    v_dot2_f32_bf16 v147, v233, s43, v147
    v_dot2_f32_bf16 v148, v234, s42, v148
    v_dot2_f32_bf16 v149, v234, s43, v149
    v_dot2_f32_bf16 v150, v235, s42, v150
    v_dot2_f32_bf16 v151, v235, s43, v151
    s_nop 0
    v_cvt_pk_bf16_f32 v196, v144, v145
    v_cvt_pk_bf16_f32 v197, v146, v147
    v_cvt_pk_bf16_f32 v204, v148, v149
    v_cvt_pk_bf16_f32 v205, v150, v151
    v_dot2_f32_bf16 v48, v196, s41, v48
    v_dot2_f32_bf16 v49, v196, v196, v49
    v_dot2_f32_bf16 v50, v196, v212, v50
    v_dot2_f32_bf16 v48, v197, s41, v48
    v_dot2_f32_bf16 v49, v197, v197, v49
    v_dot2_f32_bf16 v50, v197, v213, v50
    v_dot2_f32_bf16 v52, v204, s41, v52
    v_dot2_f32_bf16 v53, v204, v204, v53
    v_dot2_f32_bf16 v54, v204, v212, v54
    v_dot2_f32_bf16 v52, v205, s41, v52
    v_dot2_f32_bf16 v53, v205, v205, v53
    v_dot2_f32_bf16 v54, v205, v213, v54
    v_dot2_f32_bf16 v152, v236, s42, v152
    v_dot2_f32_bf16 v153, v236, s43, v153
    v_dot2_f32_bf16 v154, v237, s42, v154
    v_dot2_f32_bf16 v155, v237, s43, v155
    v_dot2_f32_bf16 v156, v238, s42, v156
    v_dot2_f32_bf16 v157, v238, s43, v157
    v_dot2_f32_bf16 v158, v239, s42, v158
    v_dot2_f32_bf16 v159, v239, s43, v159
    s_nop 0
    v_cvt_pk_bf16_f32 v198, v152, v153
    v_cvt_pk_bf16_f32 v199, v154, v155
    v_cvt_pk_bf16_f32 v206, v156, v157
    v_cvt_pk_bf16_f32 v207, v158, v159
    v_dot2_f32_bf16 v48, v198, s41, v48
    v_dot2_f32_bf16 v49, v198, v198, v49
    v_dot2_f32_bf16 v50, v198, v214, v50
    v_dot2_f32_bf16 v48, v199, s41, v48
    v_dot2_f32_bf16 v49, v199, v199, v49
    v_dot2_f32_bf16 v50, v199, v215, v50
    v_permlane16_swap_b32 v196, v198
    v_permlane16_swap_b32 v197, v199
    buffer_store_dwordx4 v[196:199], v78, s[24:27], 0 offen offset:64 sc1
    v_dot2_f32_bf16 v52, v206, s41, v52
    v_dot2_f32_bf16 v53, v206, v206, v53
    v_dot2_f32_bf16 v54, v206, v214, v54
    v_dot2_f32_bf16 v52, v207, s41, v52
    v_dot2_f32_bf16 v53, v207, v207, v53
    v_dot2_f32_bf16 v54, v207, v215, v54
    v_permlane16_swap_b32 v204, v206
    v_permlane16_swap_b32 v205, v207
    buffer_store_dwordx4 v[204:207], v79, s[24:27], 0 offen offset:64 sc1
    s_nop 2
    v_mov_b32 v56, v48
    v_mov_b32 v57, v49
    v_mov_b32 v58, v50
    v_mov_b32 v59, v52
    v_mov_b32 v60, v53
    v_mov_b32 v61, v54
    s_nop 1
    v_permlane16_swap_b32 v48, v56
    v_permlane16_swap_b32 v49, v57
    v_permlane16_swap_b32 v50, v58
    v_permlane16_swap_b32 v52, v59
    v_permlane16_swap_b32 v53, v60
    v_permlane16_swap_b32 v54, v61
    s_nop 1
    v_add_f32 v48, v48, v56
    v_add_f32 v49, v49, v57
    v_add_f32 v50, v50, v58
    v_add_f32 v52, v52, v59
    v_add_f32 v53, v53, v60
    v_add_f32 v54, v54, v61
    v_mov_b32 v56, v48
    v_mov_b32 v57, v49
    v_mov_b32 v58, v50
    v_mov_b32 v59, v52
    v_mov_b32 v60, v53
    v_mov_b32 v61, v54
    s_nop 1
    v_permlane32_swap_b32 v48, v56
    v_permlane32_swap_b32 v49, v57
    v_permlane32_swap_b32 v50, v58
    v_permlane32_swap_b32 v52, v59
    v_permlane32_swap_b32 v53, v60
    v_permlane32_swap_b32 v54, v61
    s_nop 1
    v_add_f32 v48, v48, v56
    v_add_f32 v49, v49, v57
    v_add_f32 v50, v50, v58
    v_add_f32 v52, v52, v59
    v_add_f32 v53, v53, v60
    v_add_f32 v54, v54, v61
    v_cmp_eq_u32 s[40:41], 1, v72
    v_cmp_eq_u32 s[42:43], 2, v72
    s_nop 1
    v_cndmask_b32 v48, v48, v49, s[40:41]
    v_cndmask_b32 v48, v48, v50, s[42:43]
    buffer_atomic_add_f32 v48, v77, s[32:35], 0 offen offset:0
    v_cndmask_b32 v52, v52, v53, s[40:41]
    v_cndmask_b32 v52, v52, v54, s[42:43]
    buffer_atomic_add_f32 v52, v77, s[32:35], 0 offen offset:64
    s_load_dwordx2 s[42:43], s[0:1], 88
    s_load_dwordx2 s[56:57], s[0:1], 56
    s_add_u32 s16, s6, 0x4815000
    s_addc_u32 s17, s7, 0
    s_and_b32 s17, s17, 0xffff
    s_mov_b32 s18, 0x1000
    s_mov_b32 s19, 0x00020000
    v_lshrrev_b32 v3, 4, v1
    v_lshl_add_u32 v2, s30, 6, v3
    v_and_b32 v4, 31, v3
    v_lshrrev_b32 v5, 5, v3
    v_lshlrev_b32 v7, 4, v4
    v_and_b32 v8, 15, v3
    v_lshlrev_b32 v6, 7, v8
    s_bfe_u32 s31, s2, 0x20003
    s_lshl_b32 s31, s31, 7
    v_lshlrev_b32 v12, 9, v3
    v_and_b32 v14, 3, v3
    v_lshlrev_b32 v14, 7, v14
    s_and_b32 s59, s2, 7
    s_lshl_b32 s59, s59, 9
    s_setreg_imm32_b32 hwreg(HW_REG_MODE, 4, 2), 3
    s_waitcnt vmcnt(0) lgkmcnt(0)
    s_barrier
    s_cmp_lg_u32 s30, 0
    s_cbranch_scc1 ff_nosig_148
    s_mov_b64 exec, 0xff
    buffer_atomic_add v76, v12, s[16:19], s31 offen sc1
    s_mov_b64 exec, -1
ff_nosig_148:
    s_lshl_b32 s40, s30, 13
    s_add_u32 m0, s40, 65536
    s_add_u32 s41, s3, 0
    buffer_load_dwordx4 v1, s[44:47], s41 offen offset:0 sc1 lds
    buffer_load_dwordx4 v1, s[44:47], s41 offen offset:1024 sc1 lds
    buffer_load_dwordx4 v1, s[44:47], s41 offen offset:2048 sc1 lds
    buffer_load_dwordx4 v1, s[44:47], s41 offen offset:3072 sc1 lds
    s_lshl_b32 s41, s30, 9
    s_add_u32 s41, s41, 131072
    v_lshrrev_b32 v9, 1, v1
    v_add_u32 v9, s41, v9
    ds_read_b64 v[96:97], v9 offset:0
    ds_read_b64 v[98:99], v9 offset:2048
    ds_read_b64 v[100:101], v9 offset:4096
    ds_read_b64 v[102:103], v9 offset:6144
    ds_read_b64 v[104:105], v9 offset:8192
    ds_read_b64 v[106:107], v9 offset:10240
    ds_read_b64 v[108:109], v9 offset:12288
    ds_read_b64 v[110:111], v9 offset:14336
    ds_read_b64 v[112:113], v9 offset:16384
    ds_read_b64 v[114:115], v9 offset:18432
    ds_read_b64 v[116:117], v9 offset:20480
    ds_read_b64 v[118:119], v9 offset:22528
    ds_read_b64 v[120:121], v9 offset:24576
    ds_read_b64 v[122:123], v9 offset:26624
    ds_read_b64 v[124:125], v9 offset:28672
    ds_read_b64 v[126:127], v9 offset:30720
    s_mov_b32 s54, 0x05040100
    s_mov_b32 s53, 0x07060302
    s_waitcnt lgkmcnt(0)
    v_perm_b32 v144, v98, v96, s54
    v_perm_b32 v145, v98, v96, s53
    v_perm_b32 v146, v99, v97, s54
    v_perm_b32 v147, v99, v97, s53
    v_perm_b32 v148, v102, v100, s54
    v_perm_b32 v149, v102, v100, s53
    v_perm_b32 v150, v103, v101, s54
    v_perm_b32 v151, v103, v101, s53
    v_perm_b32 v152, v106, v104, s54
    v_perm_b32 v153, v106, v104, s53
    v_perm_b32 v154, v107, v105, s54
    v_perm_b32 v155, v107, v105, s53
    v_perm_b32 v156, v110, v108, s54
    v_perm_b32 v157, v110, v108, s53
    v_perm_b32 v158, v111, v109, s54
    v_perm_b32 v159, v111, v109, s53
    v_perm_b32 v160, v114, v112, s54
    v_perm_b32 v161, v114, v112, s53
    v_perm_b32 v162, v115, v113, s54
    v_perm_b32 v163, v115, v113, s53
    v_perm_b32 v164, v118, v116, s54
    v_perm_b32 v165, v118, v116, s53
    v_perm_b32 v166, v119, v117, s54
    v_perm_b32 v167, v119, v117, s53
    v_perm_b32 v168, v122, v120, s54
    v_perm_b32 v169, v122, v120, s53
    v_perm_b32 v170, v123, v121, s54
    v_perm_b32 v171, v123, v121, s53
    v_perm_b32 v172, v126, v124, s54
    v_perm_b32 v173, v126, v124, s53
    v_perm_b32 v174, v127, v125, s54
    v_perm_b32 v175, v127, v125, s53
    s_waitcnt vmcnt(0)
    s_lshl_b32 s40, s30, 13
    s_add_u32 m0, s40, 69632
    s_add_u32 s41, s3, 4096
    buffer_load_dwordx4 v1, s[44:47], s41 offen offset:0 sc1 lds
    buffer_load_dwordx4 v1, s[44:47], s41 offen offset:1024 sc1 lds
    buffer_load_dwordx4 v1, s[44:47], s41 offen offset:2048 sc1 lds
    buffer_load_dwordx4 v1, s[44:47], s41 offen offset:3072 sc1 lds
    s_waitcnt vmcnt(0)
    s_lshl_b32 s40, s30, 13
    s_add_u32 m0, s40, 98304
    s_add_u32 s41, s3, 8388608
    buffer_load_dwordx4 v1, s[44:47], s41 offen offset:0 sc1 lds
    buffer_load_dwordx4 v1, s[44:47], s41 offen offset:1024 sc1 lds
    buffer_load_dwordx4 v1, s[44:47], s41 offen offset:2048 sc1 lds
    buffer_load_dwordx4 v1, s[44:47], s41 offen offset:3072 sc1 lds
    s_waitcnt vmcnt(0)
    s_lshl_b32 s40, s30, 13
    s_add_u32 m0, s40, 102400
    s_add_u32 s41, s3, 8392704
    buffer_load_dwordx4 v1, s[44:47], s41 offen offset:0 sc1 lds
    buffer_load_dwordx4 v1, s[44:47], s41 offen offset:1024 sc1 lds
    buffer_load_dwordx4 v1, s[44:47], s41 offen offset:2048 sc1 lds
    buffer_load_dwordx4 v1, s[44:47], s41 offen offset:3072 sc1 lds
    s_mov_b32 s34, 24708
    s_mov_b32 s36, s42
    s_and_b32 s37, s43, 0xffff
    s_mov_b32 s38, 0x400000
    s_mov_b32 s39, 0x00020000
    s_add_u32 s48, s6, 0x4900000
    s_addc_u32 s49, s7, 0
    s_and_b32 s49, s49, 0xffff
    s_mov_b32 s50, 0xe0000
    s_mov_b32 s51, 0x00020000
    v_lshlrev_b32 v10, 5, v2
    v_lshl_add_u32 v11, s30, 1, v5
    s_lshl_b32 s31, s2, 3
    v_add_u32 v11, s31, v11
    v_lshl_add_u32 v0, v11, 11, v7
    s_cmp_lg_u32 s30, 0
    s_cbranch_scc1 ff_go_149
    s_mov_b32 s52, 1048576
ff_poll_150:
    buffer_load_dword v13, v14, s[16:19], s59 offen sc1
    s_sub_u32 s52, s52, 1
    s_cbranch_scc1 ff_go_149
    s_waitcnt vmcnt(0)
    v_cmp_gt_u32 vcc, 64, v13
    s_cbranch_vccz ff_go_149
    s_sleep 4
    s_branch ff_poll_150
ff_go_149:
    s_barrier
    s_mov_b32 s31, 0
    buffer_load_dwordx4 v[16:19], v10, s[32:35], s31 offen sc1
    buffer_load_dwordx4 v[20:23], v10, s[32:35], s31 offen offset:16 sc1
    s_mov_b32 s31, 8192
    buffer_load_dwordx4 v[24:27], v10, s[32:35], s31 offen sc1
    buffer_load_dwordx4 v[28:31], v10, s[32:35], s31 offen offset:16 sc1
    s_mov_b32 s31, 16384
    buffer_load_dwordx4 v[32:35], v10, s[32:35], s31 offen sc1
    buffer_load_dwordx4 v[36:39], v10, s[32:35], s31 offen offset:16 sc1
    s_mov_b32 s31, 24704
    buffer_load_dword v10, v75, s[32:35], s31 offen sc1
    s_mov_b32 s52, 0x3a800000
    s_mov_b32 s53, 0x3a800000
    s_mov_b32 s54, 0x7ff
    v_mov_b32 v14, 0x3727c5ac
    v_mov_b32 v15, v14
    v_mov_b32 v12, 0xff800000
    v_mov_b32 v13, v12
    s_waitcnt vmcnt(0)
    v_sub_f32 v56, 0, v10
    v_sub_f32 v57, 0, v10
    v_pk_mul_f32 v[16:17], v[16:17], s[52:53]
    v_pk_fma_f32 v[24:25], v[24:25], s[52:53], v[14:15]
    v_pk_fma_f32 v[32:33], v[16:17], v[56:57], v[32:33]
    v_pk_fma_f32 v[24:25], v[16:17], v[16:17], v[24:25] neg_lo:[1,0,0] neg_hi:[1,0,0]
    v_pk_mul_f32 v[18:19], v[18:19], s[52:53]
    v_pk_fma_f32 v[26:27], v[26:27], s[52:53], v[14:15]
    v_pk_fma_f32 v[34:35], v[18:19], v[56:57], v[34:35]
    v_pk_fma_f32 v[26:27], v[18:19], v[18:19], v[26:27] neg_lo:[1,0,0] neg_hi:[1,0,0]
    v_pk_mul_f32 v[20:21], v[20:21], s[52:53]
    v_pk_fma_f32 v[28:29], v[28:29], s[52:53], v[14:15]
    v_pk_fma_f32 v[36:37], v[20:21], v[56:57], v[36:37]
    v_pk_fma_f32 v[28:29], v[20:21], v[20:21], v[28:29] neg_lo:[1,0,0] neg_hi:[1,0,0]
    v_pk_mul_f32 v[22:23], v[22:23], s[52:53]
    v_pk_fma_f32 v[30:31], v[30:31], s[52:53], v[14:15]
    v_pk_fma_f32 v[38:39], v[22:23], v[56:57], v[38:39]
    v_pk_fma_f32 v[30:31], v[22:23], v[22:23], v[30:31] neg_lo:[1,0,0] neg_hi:[1,0,0]
    v_max_f32 v24, v14, v24
    v_max_f32 v25, v14, v25
    v_max_f32 v26, v14, v26
    v_max_f32 v27, v14, v27
    v_max_f32 v28, v14, v28
    v_max_f32 v29, v14, v29
    v_max_f32 v30, v14, v30
    v_max_f32 v31, v14, v31
    v_rsq_f32 v24, v24
    v_rsq_f32 v25, v25
    v_rsq_f32 v26, v26
    v_rsq_f32 v27, v27
    v_rsq_f32 v28, v28
    v_rsq_f32 v29, v29
    v_rsq_f32 v30, v30
    v_rsq_f32 v31, v31
    v_pk_mul_f32 v[32:33], v[32:33], v[24:25]
    v_pk_mul_f32 v[34:35], v[34:35], v[26:27]
    v_pk_mul_f32 v[36:37], v[36:37], v[28:29]
    v_pk_mul_f32 v[38:39], v[38:39], v[30:31]
    v_bfi_b32 v32, s54, 0, v32
    v_med3_f32 v13, v12, v13, v32
    v_max_f32 v12, v12, v32
    v_bfi_b32 v33, s54, 1, v33
    v_med3_f32 v13, v12, v13, v33
    v_max_f32 v12, v12, v33
    v_bfi_b32 v34, s54, 2, v34
    v_med3_f32 v13, v12, v13, v34
    v_max_f32 v12, v12, v34
    v_bfi_b32 v35, s54, 3, v35
    v_med3_f32 v13, v12, v13, v35
    v_max_f32 v12, v12, v35
    v_bfi_b32 v36, s54, 4, v36
    v_med3_f32 v13, v12, v13, v36
    v_max_f32 v12, v12, v36
    v_bfi_b32 v37, s54, 5, v37
    v_med3_f32 v13, v12, v13, v37
    v_max_f32 v12, v12, v37
    v_bfi_b32 v38, s54, 6, v38
    v_med3_f32 v13, v12, v13, v38
    v_max_f32 v12, v12, v38
    v_bfi_b32 v39, s54, 7, v39
    v_med3_f32 v13, v12, v13, v39
    v_max_f32 v12, v12, v39
    v_lshl_or_b32 v12, v2, 3, v12
    v_lshl_or_b32 v13, v2, 3, v13
    s_nop 1
    v_mov_b32_dpp v14, v12 quad_perm:[1,0,3,2] row_mask:0xf bank_mask:0xf
    v_mov_b32_dpp v15, v13 quad_perm:[1,0,3,2] row_mask:0xf bank_mask:0xf
    v_max_f32 v15, v15, v13
    v_med3_f32 v13, v12, v14, v15
    v_max_f32 v12, v12, v14
    s_nop 1
    v_mov_b32_dpp v14, v12 quad_perm:[2,3,0,1] row_mask:0xf bank_mask:0xf
    v_mov_b32_dpp v15, v13 quad_perm:[2,3,0,1] row_mask:0xf bank_mask:0xf
    v_max_f32 v15, v15, v13
    v_med3_f32 v13, v12, v14, v15
    v_max_f32 v12, v12, v14
    s_nop 1
    v_mov_b32_dpp v14, v12 row_half_mirror row_mask:0xf bank_mask:0xf
    v_mov_b32_dpp v15, v13 row_half_mirror row_mask:0xf bank_mask:0xf
    v_max_f32 v15, v15, v13
    v_med3_f32 v13, v12, v14, v15
    v_max_f32 v12, v12, v14
    s_nop 1
    v_mov_b32_dpp v14, v12 row_mirror row_mask:0xf bank_mask:0xf
    v_mov_b32_dpp v15, v13 row_mirror row_mask:0xf bank_mask:0xf
    v_max_f32 v15, v15, v13
    v_med3_f32 v13, v12, v14, v15
    v_max_f32 v12, v12, v14
    v_mov_b32 v14, v12
    v_mov_b32 v15, v13
    s_nop 1
    v_permlane16_swap_b32 v12, v14
    v_permlane16_swap_b32 v13, v15
    s_nop 1
    v_max_f32 v15, v15, v13
    v_med3_f32 v13, v12, v14, v15
    v_max_f32 v12, v12, v14
    v_mov_b32 v14, v12
    v_mov_b32 v15, v13
    s_nop 1
    v_permlane32_swap_b32 v12, v14
    v_permlane32_swap_b32 v13, v15
    s_nop 1
    v_max_f32 v15, v15, v13
    v_med3_f32 v13, v12, v14, v15
    v_max_f32 v12, v12, v14
    s_lshl_b32 s31, s30, 3
    s_add_u32 s31, s31, 8192
    v_mov_b32 v14, s31
    ds_write_b64 v14, v[12:13]
    v_mov_b32 v14, 8192
    s_waitcnt lgkmcnt(0)
    s_barrier
    ds_read_b128 v[16:19], v14
    ds_read_b128 v[20:23], v14 offset:16
    v_cmp_eq_u32 vcc, 0, v5
    s_waitcnt lgkmcnt(0)
    v_max_f32 v19, v19, v17
    v_med3_f32 v17, v16, v18, v19
    v_max_f32 v16, v16, v18
    v_max_f32 v23, v23, v21
    v_med3_f32 v21, v20, v22, v23
    v_max_f32 v20, v20, v22
    v_max_f32 v21, v21, v17
    v_med3_f32 v17, v16, v20, v21
    v_max_f32 v16, v16, v20
    v_and_b32 v16, 0x7ff, v16
    v_and_b32 v17, 0x7ff, v17
    v_cndmask_b32 v15, v17, v16, vcc
    v_lshl_add_u32 v12, v15, 11, v7
    buffer_load_dwordx4 v[40:43], v12, s[24:27], 0 offen offset:0 sc1
    buffer_load_dwordx4 v[44:47], v12, s[24:27], 0 offen offset:512 sc1
    buffer_load_dwordx4 v[48:51], v12, s[24:27], 0 offen offset:1024 sc1
    buffer_load_dwordx4 v[52:55], v12, s[24:27], 0 offen offset:1536 sc1
    buffer_load_dwordx4 v[128:131], v0, s[24:27], 0 offen offset:0 sc1
    buffer_load_dwordx4 v[132:135], v0, s[24:27], 0 offen offset:512 sc1
    buffer_load_dwordx4 v[136:139], v0, s[24:27], 0 offen offset:1024 sc1
    buffer_load_dwordx4 v[140:143], v0, s[24:27], 0 offen offset:1536 sc1
    v_cmp_eq_u32 vcc, v16, v11
    v_cmp_eq_u32 s[52:53], v17, v11
    v_mov_b32 v13, 0x7fffffff
    s_or_b64 vcc, vcc, s[52:53]
    v_cndmask_b32 v0, v0, v13, vcc
    v_lshl_add_u32 v12, v5, 11, v7
    v_add_u32 v12, 4096, v12
    s_mov_b32 s58, 0
    s_waitcnt vmcnt(8)
    v_lshlrev_b32 v14, 3, v3
    s_lshl_b32 s54, s30, 13
    s_add_u32 s54, s54, 65536
    v_add_u32 v14, s54, v14
    ds_read_b64_tr_b16 a[0:1], v14 offset:0
    ds_read_b64_tr_b16 a[2:3], v14 offset:512
    ds_read_b64_tr_b16 a[4:5], v14 offset:1024
    ds_read_b64_tr_b16 a[6:7], v14 offset:1536
    ds_read_b64_tr_b16 a[8:9], v14 offset:2048
    ds_read_b64_tr_b16 a[10:11], v14 offset:2560
    ds_read_b64_tr_b16 a[12:13], v14 offset:3072
    ds_read_b64_tr_b16 a[14:15], v14 offset:3584
    ds_read_b64_tr_b16 a[16:17], v14 offset:4096
    ds_read_b64_tr_b16 a[18:19], v14 offset:4608
    ds_read_b64_tr_b16 a[20:21], v14 offset:5120
    ds_read_b64_tr_b16 a[22:23], v14 offset:5632
    ds_read_b64_tr_b16 a[24:25], v14 offset:6144
    ds_read_b64_tr_b16 a[26:27], v14 offset:6656
    ds_read_b64_tr_b16 a[28:29], v14 offset:7168
    ds_read_b64_tr_b16 a[30:31], v14 offset:7680
    ds_read_b64_tr_b16 a[32:33], v14 offset:32768
    ds_read_b64_tr_b16 a[34:35], v14 offset:33280
    ds_read_b64_tr_b16 a[36:37], v14 offset:33792
    ds_read_b64_tr_b16 a[38:39], v14 offset:34304
    ds_read_b64_tr_b16 a[40:41], v14 offset:34816
    ds_read_b64_tr_b16 a[42:43], v14 offset:35328
    ds_read_b64_tr_b16 a[44:45], v14 offset:35840
    ds_read_b64_tr_b16 a[46:47], v14 offset:36352
    ds_read_b64_tr_b16 a[48:49], v14 offset:36864
    ds_read_b64_tr_b16 a[50:51], v14 offset:37376
    ds_read_b64_tr_b16 a[52:53], v14 offset:37888
    ds_read_b64_tr_b16 a[54:55], v14 offset:38400
    ds_read_b64_tr_b16 a[56:57], v14 offset:38912
    ds_read_b64_tr_b16 a[58:59], v14 offset:39424
    ds_read_b64_tr_b16 a[60:61], v14 offset:39936
    ds_read_b64_tr_b16 a[62:63], v14 offset:40448
    s_waitcnt vmcnt(4)
ff_ln_151:
    v_lshlrev_b32 v216, 16, v40
    v_and_b32 v217, 0xffff0000, v40
    v_lshlrev_b32 v218, 16, v41
    v_and_b32 v219, 0xffff0000, v41
    v_lshlrev_b32 v220, 16, v42
    v_and_b32 v221, 0xffff0000, v42
    v_lshlrev_b32 v222, 16, v43
    v_and_b32 v223, 0xffff0000, v43
    v_lshlrev_b32 v224, 16, v44
    v_and_b32 v225, 0xffff0000, v44
    v_lshlrev_b32 v226, 16, v45
    v_and_b32 v227, 0xffff0000, v45
    v_lshlrev_b32 v228, 16, v46
    v_and_b32 v229, 0xffff0000, v46
    v_lshlrev_b32 v230, 16, v47
    v_and_b32 v231, 0xffff0000, v47
    v_lshlrev_b32 v232, 16, v48
    v_and_b32 v233, 0xffff0000, v48
    v_lshlrev_b32 v234, 16, v49
    v_and_b32 v235, 0xffff0000, v49
    v_lshlrev_b32 v236, 16, v50
    v_and_b32 v237, 0xffff0000, v50
    v_lshlrev_b32 v238, 16, v51
    v_and_b32 v239, 0xffff0000, v51
    v_lshlrev_b32 v240, 16, v52
    v_and_b32 v241, 0xffff0000, v52
    v_lshlrev_b32 v242, 16, v53
    v_and_b32 v243, 0xffff0000, v53
    v_lshlrev_b32 v244, 16, v54
    v_and_b32 v245, 0xffff0000, v54
    v_lshlrev_b32 v246, 16, v55
    v_and_b32 v247, 0xffff0000, v55
    v_pk_add_f32 v[208:209], v[216:217], v[218:219]
    v_pk_add_f32 v[210:211], v[220:221], v[222:223]
    v_pk_add_f32 v[208:209], v[208:209], v[224:225]
    v_pk_add_f32 v[210:211], v[210:211], v[226:227]
    v_pk_add_f32 v[208:209], v[208:209], v[228:229]
    v_pk_add_f32 v[210:211], v[210:211], v[230:231]
    v_pk_add_f32 v[208:209], v[208:209], v[232:233]
    v_pk_add_f32 v[210:211], v[210:211], v[234:235]
    v_pk_add_f32 v[208:209], v[208:209], v[236:237]
    v_pk_add_f32 v[210:211], v[210:211], v[238:239]
    v_pk_add_f32 v[208:209], v[208:209], v[240:241]
    v_pk_add_f32 v[210:211], v[210:211], v[242:243]
    v_pk_add_f32 v[208:209], v[208:209], v[244:245]
    v_pk_add_f32 v[210:211], v[210:211], v[246:247]
    v_pk_add_f32 v[208:209], v[208:209], v[210:211]
    v_add_f32 v208, v208, v209
    s_nop 1
    v_add_f32_dpp v208, v208, v208 quad_perm:[1,0,3,2] row_mask:0xf bank_mask:0xf
    s_nop 1
    v_add_f32_dpp v208, v208, v208 quad_perm:[2,3,0,1] row_mask:0xf bank_mask:0xf
    s_nop 1
    v_add_f32_dpp v208, v208, v208 row_half_mirror row_mask:0xf bank_mask:0xf
    s_nop 1
    v_add_f32_dpp v208, v208, v208 row_mirror row_mask:0xf bank_mask:0xf
    v_mov_b32 v210, v208
    s_nop 1
    v_permlane16_swap_b32 v208, v210
    s_nop 1
    v_add_f32 v208, v208, v210
    v_mul_f32 v208, 0xba800000, v208
    v_mov_b32 v209, v208
    v_pk_add_f32 v[210:211], v[216:217], v[208:209]
    v_pk_add_f32 v[214:215], v[218:219], v[208:209]
    v_pk_mul_f32 v[212:213], v[210:211], v[210:211]
    v_pk_fma_f32 v[212:213], v[214:215], v[214:215], v[212:213]
    v_pk_add_f32 v[210:211], v[220:221], v[208:209]
    v_pk_add_f32 v[214:215], v[222:223], v[208:209]
    v_pk_fma_f32 v[212:213], v[210:211], v[210:211], v[212:213]
    v_pk_fma_f32 v[212:213], v[214:215], v[214:215], v[212:213]
    v_pk_add_f32 v[210:211], v[224:225], v[208:209]
    v_pk_add_f32 v[214:215], v[226:227], v[208:209]
    v_pk_fma_f32 v[212:213], v[210:211], v[210:211], v[212:213]
    v_pk_fma_f32 v[212:213], v[214:215], v[214:215], v[212:213]
    v_pk_add_f32 v[210:211], v[228:229], v[208:209]
    v_pk_add_f32 v[214:215], v[230:231], v[208:209]
    v_pk_fma_f32 v[212:213], v[210:211], v[210:211], v[212:213]
    v_pk_fma_f32 v[212:213], v[214:215], v[214:215], v[212:213]
    v_pk_add_f32 v[210:211], v[232:233], v[208:209]
    v_pk_add_f32 v[214:215], v[234:235], v[208:209]
    v_pk_fma_f32 v[212:213], v[210:211], v[210:211], v[212:213]
    v_pk_fma_f32 v[212:213], v[214:215], v[214:215], v[212:213]
    v_pk_add_f32 v[210:211], v[236:237], v[208:209]
    v_pk_add_f32 v[214:215], v[238:239], v[208:209]
    v_pk_fma_f32 v[212:213], v[210:211], v[210:211], v[212:213]
    v_pk_fma_f32 v[212:213], v[214:215], v[214:215], v[212:213]
    v_pk_add_f32 v[210:211], v[240:241], v[208:209]
    v_pk_add_f32 v[214:215], v[242:243], v[208:209]
    v_pk_fma_f32 v[212:213], v[210:211], v[210:211], v[212:213]
    v_pk_fma_f32 v[212:213], v[214:215], v[214:215], v[212:213]
    v_pk_add_f32 v[210:211], v[244:245], v[208:209]
    v_pk_add_f32 v[214:215], v[246:247], v[208:209]
    v_pk_fma_f32 v[212:213], v[210:211], v[210:211], v[212:213]
    v_pk_fma_f32 v[212:213], v[214:215], v[214:215], v[212:213]
    v_add_f32 v212, v212, v213
    s_nop 1
    v_add_f32_dpp v212, v212, v212 quad_perm:[1,0,3,2] row_mask:0xf bank_mask:0xf
    s_nop 1
    v_add_f32_dpp v212, v212, v212 quad_perm:[2,3,0,1] row_mask:0xf bank_mask:0xf
    s_nop 1
    v_add_f32_dpp v212, v212, v212 row_half_mirror row_mask:0xf bank_mask:0xf
    s_nop 1
    v_add_f32_dpp v212, v212, v212 row_mirror row_mask:0xf bank_mask:0xf
    v_mov_b32 v210, v212
    s_nop 1
    v_permlane16_swap_b32 v212, v210
    s_nop 1
    v_add_f32 v212, v212, v210
    v_mul_f32 v212, 0x3a800000, v212
    v_cvt_pk_bf16_f32 v214, v208, v212
    v_and_b32 v212, 0xffff0000, v214
    v_lshlrev_b32 v214, 16, v214
    v_add_f32 v212, 0x3727c5ac, v212
    v_mov_b32 v215, v214
    v_cvt_pk_bf16_f32 v212, v212, v212
    v_and_b32 v212, 0xffff0000, v212
    v_sqrt_f32 v212, v212
    v_pk_add_f32 v[176:177], v[216:217], v[214:215]
    v_pk_add_f32 v[178:179], v[218:219], v[214:215]
    v_pk_add_f32 v[180:181], v[220:221], v[214:215]
    v_pk_add_f32 v[182:183], v[222:223], v[214:215]
    v_pk_add_f32 v[184:185], v[224:225], v[214:215]
    v_pk_add_f32 v[186:187], v[226:227], v[214:215]
    v_pk_add_f32 v[188:189], v[228:229], v[214:215]
    v_pk_add_f32 v[190:191], v[230:231], v[214:215]
    v_pk_add_f32 v[192:193], v[232:233], v[214:215]
    v_pk_add_f32 v[194:195], v[234:235], v[214:215]
    v_pk_add_f32 v[196:197], v[236:237], v[214:215]
    v_pk_add_f32 v[198:199], v[238:239], v[214:215]
    v_pk_add_f32 v[200:201], v[240:241], v[214:215]
    v_pk_add_f32 v[202:203], v[242:243], v[214:215]
    v_pk_add_f32 v[204:205], v[244:245], v[214:215]
    v_pk_add_f32 v[206:207], v[246:247], v[214:215]
    v_cvt_pk_bf16_f32 v212, v212, v212
    v_and_b32 v212, 0xffff0000, v212
    v_rcp_f32 v212, v212
    v_cvt_pk_bf16_f32 v40, v176, v177
    v_cvt_pk_bf16_f32 v41, v178, v179
    v_cvt_pk_bf16_f32 v42, v180, v181
    v_cvt_pk_bf16_f32 v43, v182, v183
    v_cvt_pk_bf16_f32 v44, v184, v185
    v_cvt_pk_bf16_f32 v45, v186, v187
    v_cvt_pk_bf16_f32 v46, v188, v189
    v_cvt_pk_bf16_f32 v47, v190, v191
    v_cvt_pk_bf16_f32 v48, v192, v193
    v_cvt_pk_bf16_f32 v49, v194, v195
    v_cvt_pk_bf16_f32 v50, v196, v197
    v_cvt_pk_bf16_f32 v51, v198, v199
    v_cvt_pk_bf16_f32 v52, v200, v201
    v_cvt_pk_bf16_f32 v53, v202, v203
    v_cvt_pk_bf16_f32 v54, v204, v205
    v_cvt_pk_bf16_f32 v55, v206, v207
    v_mov_b32 v213, v212
    v_lshlrev_b32 v176, 16, v40
    v_and_b32 v177, 0xffff0000, v40
    v_lshlrev_b32 v178, 16, v41
    v_and_b32 v179, 0xffff0000, v41
    v_lshlrev_b32 v180, 16, v42
    v_and_b32 v181, 0xffff0000, v42
    v_lshlrev_b32 v182, 16, v43
    v_and_b32 v183, 0xffff0000, v43
    v_lshlrev_b32 v184, 16, v44
    v_and_b32 v185, 0xffff0000, v44
    v_lshlrev_b32 v186, 16, v45
    v_and_b32 v187, 0xffff0000, v45
    v_lshlrev_b32 v188, 16, v46
    v_and_b32 v189, 0xffff0000, v46
    v_lshlrev_b32 v190, 16, v47
    v_and_b32 v191, 0xffff0000, v47
    v_lshlrev_b32 v192, 16, v48
    v_and_b32 v193, 0xffff0000, v48
    v_lshlrev_b32 v194, 16, v49
    v_and_b32 v195, 0xffff0000, v49
    v_lshlrev_b32 v196, 16, v50
    v_and_b32 v197, 0xffff0000, v50
    v_lshlrev_b32 v198, 16, v51
    v_and_b32 v199, 0xffff0000, v51
    v_lshlrev_b32 v200, 16, v52
    v_and_b32 v201, 0xffff0000, v52
    v_lshlrev_b32 v202, 16, v53
    v_and_b32 v203, 0xffff0000, v53
    v_lshlrev_b32 v204, 16, v54
    v_and_b32 v205, 0xffff0000, v54
    v_lshlrev_b32 v206, 16, v55
    v_and_b32 v207, 0xffff0000, v55
    v_pk_mul_f32 v[176:177], v[176:177], v[212:213]
    v_pk_mul_f32 v[178:179], v[178:179], v[212:213]
    v_pk_mul_f32 v[180:181], v[180:181], v[212:213]
    v_pk_mul_f32 v[182:183], v[182:183], v[212:213]
    v_pk_mul_f32 v[184:185], v[184:185], v[212:213]
    v_pk_mul_f32 v[186:187], v[186:187], v[212:213]
    v_pk_mul_f32 v[188:189], v[188:189], v[212:213]
    v_pk_mul_f32 v[190:191], v[190:191], v[212:213]
    v_pk_mul_f32 v[192:193], v[192:193], v[212:213]
    v_pk_mul_f32 v[194:195], v[194:195], v[212:213]
    v_pk_mul_f32 v[196:197], v[196:197], v[212:213]
    v_pk_mul_f32 v[198:199], v[198:199], v[212:213]
    v_pk_mul_f32 v[200:201], v[200:201], v[212:213]
    v_pk_mul_f32 v[202:203], v[202:203], v[212:213]
    v_pk_mul_f32 v[204:205], v[204:205], v[212:213]
    v_pk_mul_f32 v[206:207], v[206:207], v[212:213]
    v_cvt_pk_bf16_f32 v40, v176, v177
    v_cvt_pk_bf16_f32 v41, v178, v179
    v_cvt_pk_bf16_f32 v42, v180, v181
    v_cvt_pk_bf16_f32 v43, v182, v183
    v_cvt_pk_bf16_f32 v44, v184, v185
    v_cvt_pk_bf16_f32 v45, v186, v187
    v_cvt_pk_bf16_f32 v46, v188, v189
    v_cvt_pk_bf16_f32 v47, v190, v191
    v_cvt_pk_bf16_f32 v48, v192, v193
    v_cvt_pk_bf16_f32 v49, v194, v195
    v_cvt_pk_bf16_f32 v50, v196, v197
    v_cvt_pk_bf16_f32 v51, v198, v199
    v_cvt_pk_bf16_f32 v52, v200, v201
    v_cvt_pk_bf16_f32 v53, v202, v203
    v_cvt_pk_bf16_f32 v54, v204, v205
    v_cvt_pk_bf16_f32 v55, v206, v207
    s_cmp_lg_u32 s58, 0
    s_cbranch_scc1 ff_own_152
    ds_write_b128 v12, v[40:43] offset:0
    ds_write_b128 v12, v[44:47] offset:512
    ds_write_b128 v12, v[48:51] offset:1024
    ds_write_b128 v12, v[52:55] offset:1536
    s_cmp_ge_u32 s2, 224
    s_cbranch_scc1 ff_red_153
    v_lshrrev_b32 v12, 4, v3
    v_and_b32 v13, 1, v3
    v_lshlrev_b32 v13, 11, v13
    v_lshl_add_u32 v13, v12, 3, v13
    s_lshl_b32 s54, s30, 9
    s_add_u32 s54, s54, 4096
    v_add_u32 v13, s54, v13
    ds_read_b64 a[64:65], v13 offset:0
    ds_read_b64 a[66:67], v13 offset:32
    ds_read_b64 a[68:69], v13 offset:64
    ds_read_b64 a[70:71], v13 offset:96
    ds_read_b64 a[72:73], v13 offset:128
    ds_read_b64 a[74:75], v13 offset:160
    ds_read_b64 a[76:77], v13 offset:192
    ds_read_b64 a[78:79], v13 offset:224
    ds_read_b64 a[80:81], v13 offset:256
    ds_read_b64 a[82:83], v13 offset:288
    ds_read_b64 a[84:85], v13 offset:320
    ds_read_b64 a[86:87], v13 offset:352
    ds_read_b64 a[88:89], v13 offset:384
    ds_read_b64 a[90:91], v13 offset:416
    ds_read_b64 a[92:93], v13 offset:448
    ds_read_b64 a[94:95], v13 offset:480
    v_lshlrev_b32 v13, 6, v8
    v_lshl_add_u32 v13, v12, 4, v13
    s_lshl_b32 s54, s30, 11
    s_add_u32 s54, s54, 8448
    v_add_u32 v13, s54, v13
    s_waitcnt lgkmcnt(0)
    v_mfma_f32_16x16x32_bf16 v[16:19], a[0:3], a[64:67], 0
    v_mfma_f32_16x16x32_bf16 v[20:23], a[32:35], a[64:67], 0
    v_mfma_f32_16x16x32_bf16 v[16:19], a[4:7], a[68:71], v[16:19]
    v_mfma_f32_16x16x32_bf16 v[20:23], a[36:39], a[68:71], v[20:23]
    v_mfma_f32_16x16x32_bf16 v[16:19], a[8:11], a[72:75], v[16:19]
    v_mfma_f32_16x16x32_bf16 v[20:23], a[40:43], a[72:75], v[20:23]
    v_mfma_f32_16x16x32_bf16 v[16:19], a[12:15], a[76:79], v[16:19]
    v_mfma_f32_16x16x32_bf16 v[20:23], a[44:47], a[76:79], v[20:23]
    v_mfma_f32_16x16x32_bf16 v[16:19], a[16:19], a[80:83], v[16:19]
    v_mfma_f32_16x16x32_bf16 v[20:23], a[48:51], a[80:83], v[20:23]
    v_mfma_f32_16x16x32_bf16 v[16:19], a[20:23], a[84:87], v[16:19]
    v_mfma_f32_16x16x32_bf16 v[20:23], a[52:55], a[84:87], v[20:23]
    v_mfma_f32_16x16x32_bf16 v[16:19], a[24:27], a[88:91], v[16:19]
    v_mfma_f32_16x16x32_bf16 v[20:23], a[56:59], a[88:91], v[20:23]
    v_mfma_f32_16x16x32_bf16 v[16:19], a[28:31], a[92:95], v[16:19]
    v_mfma_f32_16x16x32_bf16 v[20:23], a[60:63], a[92:95], v[20:23]
    s_nop 7
    ds_write_b128 v13, v[16:19]
    ds_write_b128 v13, v[20:23] offset:1024
    v_lshlrev_b32 v13, 2, v4
    v_add_u32 v13, 8448, v13
    s_waitcnt lgkmcnt(0)
    s_barrier
    ds_read2st64_b32 v[16:17], v13 offset0:0 offset1:4
    ds_read2st64_b32 v[18:19], v13 offset0:8 offset1:12
    ds_read2st64_b32 v[20:21], v13 offset0:16 offset1:20
    ds_read2st64_b32 v[22:23], v13 offset0:24 offset1:28
    s_waitcnt lgkmcnt(0)
    v_pk_add_f32 v[16:17], v[16:17], v[20:21]
    v_pk_add_f32 v[18:19], v[18:19], v[22:23]
    v_pk_add_f32 v[16:17], v[16:17], v[18:19]
    v_cvt_pk_bf16_f32 v16, v16, v17
    v_and_b32 v20, 0xffff0000, v16
    v_lshlrev_b32 v16, 16, v16
    v_mul_f32 v17, 0xbfb8aa3b, v16
    v_exp_f32 v17, v17
    s_lshl_b32 s54, s55, 12
    v_add_f32 v17, 1.0, v17
    v_rcp_f32 v17, v17
    s_add_u32 s53, s54, 4096
    v_mul_f32 v16, v16, v17
    v_cvt_pk_bf16_f32 v16, v16, v16
    v_and_b32 v16, 0xffff0000, v16
    v_mul_f32 v16, v16, v20
    s_nop 1
    v_mov_b32_dpp v17, v16 quad_perm:[1,0,3,2] row_mask:0xf bank_mask:0xf
    v_cvt_pk_bf16_f32 v16, v16, v17
    v_lshlrev_b32 v13, 4, v2
    v_readlane_b32 s8, v16, 0
    v_readlane_b32 s9, v16, 2
    v_readlane_b32 s10, v16, 4
    v_readlane_b32 s11, v16, 6
    v_readlane_b32 s12, v16, 8
    v_readlane_b32 s13, v16, 10
    v_readlane_b32 s14, v16, 12
    v_readlane_b32 s15, v16, 14
    v_readlane_b32 s16, v16, 16
    v_readlane_b32 s17, v16, 18
    v_readlane_b32 s18, v16, 20
    v_readlane_b32 s19, v16, 22
    v_readlane_b32 s20, v16, 24
    v_readlane_b32 s21, v16, 26
    v_readlane_b32 s22, v16, 28
    v_readlane_b32 s23, v16, 30
    v_dot2_f32_bf16 v24, v144, s8, 0
    v_dot2_f32_bf16 v25, v145, s8, 0
    v_dot2_f32_bf16 v26, v146, s8, 0
    v_dot2_f32_bf16 v27, v147, s8, 0
    v_dot2_f32_bf16 v24, v148, s9, v24
    v_dot2_f32_bf16 v25, v149, s9, v25
    v_dot2_f32_bf16 v26, v150, s9, v26
    v_dot2_f32_bf16 v27, v151, s9, v27
    v_dot2_f32_bf16 v24, v152, s10, v24
    v_dot2_f32_bf16 v25, v153, s10, v25
    v_dot2_f32_bf16 v26, v154, s10, v26
    v_dot2_f32_bf16 v27, v155, s10, v27
    v_dot2_f32_bf16 v24, v156, s11, v24
    v_dot2_f32_bf16 v25, v157, s11, v25
    v_dot2_f32_bf16 v26, v158, s11, v26
    v_dot2_f32_bf16 v27, v159, s11, v27
    v_dot2_f32_bf16 v24, v160, s12, v24
    v_dot2_f32_bf16 v25, v161, s12, v25
    v_dot2_f32_bf16 v26, v162, s12, v26
    v_dot2_f32_bf16 v27, v163, s12, v27
    v_dot2_f32_bf16 v24, v164, s13, v24
    v_dot2_f32_bf16 v25, v165, s13, v25
    v_dot2_f32_bf16 v26, v166, s13, v26
    v_dot2_f32_bf16 v27, v167, s13, v27
    v_dot2_f32_bf16 v24, v168, s14, v24
    v_dot2_f32_bf16 v25, v169, s14, v25
    v_dot2_f32_bf16 v26, v170, s14, v26
    v_dot2_f32_bf16 v27, v171, s14, v27
    v_dot2_f32_bf16 v24, v172, s15, v24
    v_dot2_f32_bf16 v25, v173, s15, v25
    v_dot2_f32_bf16 v26, v174, s15, v26
    v_dot2_f32_bf16 v27, v175, s15, v27
    v_dot2_f32_bf16 v28, v144, s16, 0
    v_dot2_f32_bf16 v29, v145, s16, 0
    v_dot2_f32_bf16 v30, v146, s16, 0
    v_dot2_f32_bf16 v31, v147, s16, 0
    v_dot2_f32_bf16 v28, v148, s17, v28
    v_dot2_f32_bf16 v29, v149, s17, v29
    v_dot2_f32_bf16 v30, v150, s17, v30
    v_dot2_f32_bf16 v31, v151, s17, v31
    v_dot2_f32_bf16 v28, v152, s18, v28
    v_dot2_f32_bf16 v29, v153, s18, v29
    v_dot2_f32_bf16 v30, v154, s18, v30
    v_dot2_f32_bf16 v31, v155, s18, v31
    v_dot2_f32_bf16 v28, v156, s19, v28
    v_dot2_f32_bf16 v29, v157, s19, v29
    v_dot2_f32_bf16 v30, v158, s19, v30
    v_dot2_f32_bf16 v31, v159, s19, v31
    v_dot2_f32_bf16 v28, v160, s20, v28
    v_dot2_f32_bf16 v29, v161, s20, v29
    v_dot2_f32_bf16 v30, v162, s20, v30
    v_dot2_f32_bf16 v31, v163, s20, v31
    v_dot2_f32_bf16 v28, v164, s21, v28
    v_dot2_f32_bf16 v29, v165, s21, v29
    v_dot2_f32_bf16 v30, v166, s21, v30
    v_dot2_f32_bf16 v31, v167, s21, v31
    v_dot2_f32_bf16 v28, v168, s22, v28
    v_dot2_f32_bf16 v29, v169, s22, v29
    v_dot2_f32_bf16 v30, v170, s22, v30
    v_dot2_f32_bf16 v31, v171, s22, v31
    v_dot2_f32_bf16 v28, v172, s23, v28
    v_dot2_f32_bf16 v29, v173, s23, v29
    v_dot2_f32_bf16 v30, v174, s23, v30
    v_dot2_f32_bf16 v31, v175, s23, v31
    s_nop 2
    v_cvt_pk_bf16_f32 v24, v24, v25
    v_cvt_pk_bf16_f32 v25, v26, v27
    v_cvt_pk_bf16_f32 v26, v28, v29
    v_cvt_pk_bf16_f32 v27, v30, v31
    v_min_u32 v24, -2, v24
    v_min_u32 v25, -2, v25
    v_min_u32 v26, -2, v26
    v_min_u32 v27, -2, v27
    buffer_store_dwordx4 v[24:27], v13, s[48:51], s54 offen sc1
    s_waitcnt vmcnt(1)
    v_mov_b32 v40, v128
    v_mov_b32 v41, v129
    v_mov_b32 v42, v130
    v_mov_b32 v43, v131
    v_mov_b32 v44, v132
    v_mov_b32 v45, v133
    v_mov_b32 v46, v134
    v_mov_b32 v47, v135
    v_mov_b32 v48, v136
    v_mov_b32 v49, v137
    v_mov_b32 v50, v138
    v_mov_b32 v51, v139
    v_mov_b32 v52, v140
    v_mov_b32 v53, v141
    v_mov_b32 v54, v142
    v_mov_b32 v55, v143
    s_mov_b32 s58, 1
    s_branch ff_ln_151
ff_own_152:
    v_lshlrev_b32 v176, 16, v40
    v_and_b32 v177, 0xffff0000, v40
    v_lshlrev_b32 v178, 16, v41
    v_and_b32 v179, 0xffff0000, v41
    v_lshlrev_b32 v180, 16, v42
    v_and_b32 v181, 0xffff0000, v42
    v_lshlrev_b32 v182, 16, v43
    v_and_b32 v183, 0xffff0000, v43
    v_lshlrev_b32 v184, 16, v44
    v_and_b32 v185, 0xffff0000, v44
    v_lshlrev_b32 v186, 16, v45
    v_and_b32 v187, 0xffff0000, v45
    v_lshlrev_b32 v188, 16, v46
    v_and_b32 v189, 0xffff0000, v46
    v_lshlrev_b32 v190, 16, v47
    v_and_b32 v191, 0xffff0000, v47
    v_lshlrev_b32 v192, 16, v48
    v_and_b32 v193, 0xffff0000, v48
    v_lshlrev_b32 v194, 16, v49
    v_and_b32 v195, 0xffff0000, v49
    v_lshlrev_b32 v196, 16, v50
    v_and_b32 v197, 0xffff0000, v50
    v_lshlrev_b32 v198, 16, v51
    v_and_b32 v199, 0xffff0000, v51
    v_lshlrev_b32 v200, 16, v52
    v_and_b32 v201, 0xffff0000, v52
    v_lshlrev_b32 v202, 16, v53
    v_and_b32 v203, 0xffff0000, v53
    v_lshlrev_b32 v204, 16, v54
    v_and_b32 v205, 0xffff0000, v54
    v_lshlrev_b32 v206, 16, v55
    v_and_b32 v207, 0xffff0000, v55
    v_pk_add_f32 v[176:177], v[176:177], v[216:217]
    v_pk_add_f32 v[178:179], v[178:179], v[218:219]
    v_pk_add_f32 v[180:181], v[180:181], v[220:221]
    v_pk_add_f32 v[182:183], v[182:183], v[222:223]
    v_pk_add_f32 v[184:185], v[184:185], v[224:225]
    v_pk_add_f32 v[186:187], v[186:187], v[226:227]
    v_pk_add_f32 v[188:189], v[188:189], v[228:229]
    v_pk_add_f32 v[190:191], v[190:191], v[230:231]
    v_pk_add_f32 v[192:193], v[192:193], v[232:233]
    v_pk_add_f32 v[194:195], v[194:195], v[234:235]
    v_pk_add_f32 v[196:197], v[196:197], v[236:237]
    v_pk_add_f32 v[198:199], v[198:199], v[238:239]
    v_pk_add_f32 v[200:201], v[200:201], v[240:241]
    v_pk_add_f32 v[202:203], v[202:203], v[242:243]
    v_pk_add_f32 v[204:205], v[204:205], v[244:245]
    v_pk_add_f32 v[206:207], v[206:207], v[246:247]
    v_cvt_pk_bf16_f32 v40, v176, v177
    v_cvt_pk_bf16_f32 v41, v178, v179
    v_cvt_pk_bf16_f32 v42, v180, v181
    v_cvt_pk_bf16_f32 v43, v182, v183
    v_cvt_pk_bf16_f32 v44, v184, v185
    v_cvt_pk_bf16_f32 v45, v186, v187
    v_cvt_pk_bf16_f32 v46, v188, v189
    v_cvt_pk_bf16_f32 v47, v190, v191
    v_cvt_pk_bf16_f32 v48, v192, v193
    v_cvt_pk_bf16_f32 v49, v194, v195
    v_cvt_pk_bf16_f32 v50, v196, v197
    v_cvt_pk_bf16_f32 v51, v198, v199
    v_cvt_pk_bf16_f32 v52, v200, v201
    v_cvt_pk_bf16_f32 v53, v202, v203
    v_cvt_pk_bf16_f32 v54, v204, v205
    v_cvt_pk_bf16_f32 v55, v206, v207
    buffer_store_dwordx4 v[40:43], v0, s[36:39], 0 offen offset:0 sc1
    buffer_store_dwordx4 v[44:47], v0, s[36:39], 0 offen offset:512 sc1
    buffer_store_dwordx4 v[48:51], v0, s[36:39], 0 offen offset:1024 sc1
    buffer_store_dwordx4 v[52:55], v0, s[36:39], 0 offen offset:1536 sc1
    s_cmp_ge_u32 s2, 224
    s_cbranch_scc1 ff_red2_154
    s_branch ff_fin_155
ff_red_153:
    s_sub_u32 s40, s2, 224
    s_mov_b32 s8, s56
    s_and_b32 s9, s57, 0xffff
    s_mov_b32 s10, 0x800
    s_mov_b32 s11, 0x00020000
    buffer_load_dwordx4 v[96:99], v7, s[8:11], 0 offen offset:0
    buffer_load_dwordx4 v[100:103], v7, s[8:11], 0 offen offset:512
    buffer_load_dwordx4 v[104:107], v7, s[8:11], 0 offen offset:1024
    buffer_load_dwordx4 v[108:111], v7, s[8:11], 0 offen offset:1536
    v_and_b32 v8, 7, v3
    s_lshl_b32 s47, s40, 6
    v_lshl_add_u32 v9, v8, 3, s47
    v_lshl_add_u32 v12, v5, 11, v9
    v_add_u32 v12, 4096, v12
    v_lshl_add_u32 v9, v15, 11, v9
    s_waitcnt lgkmcnt(0)
    ds_read_b64 v[32:33], v12
    buffer_load_dwordx2 v[34:35], v9, s[24:27], 0 offen sc1
    v_lshrrev_b32 v10, 3, v2
    v_lshlrev_b32 v10, 12, v10
    v_lshl_add_u32 v10, v8, 4, v10
    s_lshl_b32 s47, s40, 7
    s_waitcnt vmcnt(1)
    v_dot2_f32_bf16 v36, v40, v96, 0
    v_dot2_f32_bf16 v36, v41, v97, v36
    v_dot2_f32_bf16 v36, v42, v98, v36
    v_dot2_f32_bf16 v36, v43, v99, v36
    v_dot2_f32_bf16 v36, v44, v100, v36
    v_dot2_f32_bf16 v36, v45, v101, v36
    v_dot2_f32_bf16 v36, v46, v102, v36
    v_dot2_f32_bf16 v36, v47, v103, v36
    v_dot2_f32_bf16 v36, v48, v104, v36
    v_dot2_f32_bf16 v36, v49, v105, v36
    v_dot2_f32_bf16 v36, v50, v106, v36
    v_dot2_f32_bf16 v36, v51, v107, v36
    v_dot2_f32_bf16 v36, v52, v108, v36
    v_dot2_f32_bf16 v36, v53, v109, v36
    v_dot2_f32_bf16 v36, v54, v110, v36
    v_dot2_f32_bf16 v36, v55, v111, v36
    s_nop 2
    s_nop 1
    v_add_f32_dpp v36, v36, v36 quad_perm:[1,0,3,2] row_mask:0xf bank_mask:0xf
    s_nop 1
    v_add_f32_dpp v36, v36, v36 quad_perm:[2,3,0,1] row_mask:0xf bank_mask:0xf
    s_nop 1
    v_add_f32_dpp v36, v36, v36 row_half_mirror row_mask:0xf bank_mask:0xf
    s_nop 1
    v_add_f32_dpp v36, v36, v36 row_mirror row_mask:0xf bank_mask:0xf
    v_mov_b32 v13, v36
    s_nop 1
    v_permlane16_swap_b32 v36, v13
    s_nop 1
    v_add_f32 v36, v36, v13
    v_cvt_pk_bf16_f32 v36, v36, v36
    v_and_b32 v36, 0xffff0000, v36
    v_mul_f32 v36, 0xbfb8aa3b, v36
    v_exp_f32 v36, v36
    s_nop 0
    v_add_f32 v36, 1.0, v36
    v_rcp_f32 v36, v36
    s_nop 0
    v_cvt_pk_bf16_f32 v36, v36, v36
    v_and_b32 v36, 0xffff0000, v36
    v_mov_b32 v40, v128
    v_mov_b32 v41, v129
    v_mov_b32 v42, v130
    v_mov_b32 v43, v131
    v_mov_b32 v44, v132
    v_mov_b32 v45, v133
    v_mov_b32 v46, v134
    v_mov_b32 v47, v135
    v_mov_b32 v48, v136
    v_mov_b32 v49, v137
    v_mov_b32 v50, v138
    v_mov_b32 v51, v139
    v_mov_b32 v52, v140
    v_mov_b32 v53, v141
    v_mov_b32 v54, v142
    v_mov_b32 v55, v143
    s_mov_b32 s58, 1
    s_branch ff_ln_151
ff_red2_154:
    s_mov_b32 s52, 1048576
ff_rpoll_157:
    s_mov_b32 s53, s47
    buffer_load_dwordx4 v[96:99], v10, s[48:51], s53 offen sc1
    s_add_u32 s53, s53, 0x20000
    buffer_load_dwordx4 v[100:103], v10, s[48:51], s53 offen sc1
    s_add_u32 s53, s53, 0x20000
    buffer_load_dwordx4 v[104:107], v10, s[48:51], s53 offen sc1
    s_add_u32 s53, s53, 0x20000
    buffer_load_dwordx4 v[108:111], v10, s[48:51], s53 offen sc1
    s_add_u32 s53, s53, 0x20000
    buffer_load_dwordx4 v[112:115], v10, s[48:51], s53 offen sc1
    s_add_u32 s53, s53, 0x20000
    buffer_load_dwordx4 v[116:119], v10, s[48:51], s53 offen sc1
    s_add_u32 s53, s53, 0x20000
    buffer_load_dwordx4 v[120:123], v10, s[48:51], s53 offen sc1
    s_add_u32 s53, s53, 0x20000
    v_mov_b32 v13, 0
    s_waitcnt vmcnt(6)
    v_max3_u32 v13, v13, v96, v97
    v_max3_u32 v13, v13, v98, v99
    s_waitcnt vmcnt(5)
    v_max3_u32 v13, v13, v100, v101
    v_max3_u32 v13, v13, v102, v103
    s_waitcnt vmcnt(4)
    v_max3_u32 v13, v13, v104, v105
    v_max3_u32 v13, v13, v106, v107
    s_waitcnt vmcnt(3)
    v_max3_u32 v13, v13, v108, v109
    v_max3_u32 v13, v13, v110, v111
    s_waitcnt vmcnt(2)
    v_max3_u32 v13, v13, v112, v113
    v_max3_u32 v13, v13, v114, v115
    s_waitcnt vmcnt(1)
    v_max3_u32 v13, v13, v116, v117
    v_max3_u32 v13, v13, v118, v119
    s_waitcnt vmcnt(0)
    v_max3_u32 v13, v13, v120, v121
    v_max3_u32 v13, v13, v122, v123
    s_sub_u32 s52, s52, 1
    s_cbranch_scc1 ff_rgo_156
    v_cmp_eq_u32 vcc, -1, v13
    s_cbranch_vccnz ff_rpoll_157
ff_rgo_156:
    s_mov_b32 s52, 0x00003f80
    s_mov_b32 s53, 0x3f800000
    v_dot2_f32_bf16 v128, v96, s52, 0
    v_dot2_f32_bf16 v129, v96, s53, 0
    v_dot2_f32_bf16 v130, v97, s52, 0
    v_dot2_f32_bf16 v131, v97, s53, 0
    v_dot2_f32_bf16 v132, v98, s52, 0
    v_dot2_f32_bf16 v133, v98, s53, 0
    v_dot2_f32_bf16 v134, v99, s52, 0
    v_dot2_f32_bf16 v135, v99, s53, 0
    v_dot2_f32_bf16 v128, v100, s52, v128
    v_dot2_f32_bf16 v129, v100, s53, v129
    v_dot2_f32_bf16 v130, v101, s52, v130
    v_dot2_f32_bf16 v131, v101, s53, v131
    v_dot2_f32_bf16 v132, v102, s52, v132
    v_dot2_f32_bf16 v133, v102, s53, v133
    v_dot2_f32_bf16 v134, v103, s52, v134
    v_dot2_f32_bf16 v135, v103, s53, v135
    v_dot2_f32_bf16 v128, v104, s52, v128
    v_dot2_f32_bf16 v129, v104, s53, v129
    v_dot2_f32_bf16 v130, v105, s52, v130
    v_dot2_f32_bf16 v131, v105, s53, v131
    v_dot2_f32_bf16 v132, v106, s52, v132
    v_dot2_f32_bf16 v133, v106, s53, v133
    v_dot2_f32_bf16 v134, v107, s52, v134
    v_dot2_f32_bf16 v135, v107, s53, v135
    v_dot2_f32_bf16 v128, v108, s52, v128
    v_dot2_f32_bf16 v129, v108, s53, v129
    v_dot2_f32_bf16 v130, v109, s52, v130
    v_dot2_f32_bf16 v131, v109, s53, v131
    v_dot2_f32_bf16 v132, v110, s52, v132
    v_dot2_f32_bf16 v133, v110, s53, v133
    v_dot2_f32_bf16 v134, v111, s52, v134
    v_dot2_f32_bf16 v135, v111, s53, v135
    v_dot2_f32_bf16 v128, v112, s52, v128
    v_dot2_f32_bf16 v129, v112, s53, v129
    v_dot2_f32_bf16 v130, v113, s52, v130
    v_dot2_f32_bf16 v131, v113, s53, v131
    v_dot2_f32_bf16 v132, v114, s52, v132
    v_dot2_f32_bf16 v133, v114, s53, v133
    v_dot2_f32_bf16 v134, v115, s52, v134
    v_dot2_f32_bf16 v135, v115, s53, v135
    v_dot2_f32_bf16 v128, v116, s52, v128
    v_dot2_f32_bf16 v129, v116, s53, v129
    v_dot2_f32_bf16 v130, v117, s52, v130
    v_dot2_f32_bf16 v131, v117, s53, v131
    v_dot2_f32_bf16 v132, v118, s52, v132
    v_dot2_f32_bf16 v133, v118, s53, v133
    v_dot2_f32_bf16 v134, v119, s52, v134
    v_dot2_f32_bf16 v135, v119, s53, v135
    v_dot2_f32_bf16 v128, v120, s52, v128
    v_dot2_f32_bf16 v129, v120, s53, v129
    v_dot2_f32_bf16 v130, v121, s52, v130
    v_dot2_f32_bf16 v131, v121, s53, v131
    v_dot2_f32_bf16 v132, v122, s52, v132
    v_dot2_f32_bf16 v133, v122, s53, v133
    v_dot2_f32_bf16 v134, v123, s52, v134
    v_dot2_f32_bf16 v135, v123, s53, v135
    s_nop 2
    v_permlane32_swap_b32 v128, v132
    v_permlane32_swap_b32 v129, v133
    v_permlane32_swap_b32 v130, v134
    v_permlane32_swap_b32 v131, v135
    s_nop 1
    v_add_f32 v128, v128, v132
    v_add_f32 v129, v129, v133
    v_add_f32 v130, v130, v134
    v_add_f32 v131, v131, v135
    s_nop 1
    v_add_f32_dpp v128, v128, v128 row_ror:8 row_mask:0xf bank_mask:0xf
    v_add_f32_dpp v129, v129, v129 row_ror:8 row_mask:0xf bank_mask:0xf
    v_add_f32_dpp v130, v130, v130 row_ror:8 row_mask:0xf bank_mask:0xf
    v_add_f32_dpp v131, v131, v131 row_ror:8 row_mask:0xf bank_mask:0xf
    v_mov_b32 v132, v128
    v_mov_b32 v133, v129
    v_mov_b32 v134, v130
    v_mov_b32 v135, v131
    s_nop 1
    v_permlane16_swap_b32 v128, v132
    v_permlane16_swap_b32 v129, v133
    v_permlane16_swap_b32 v130, v134
    v_permlane16_swap_b32 v131, v135
    s_nop 1
    v_add_f32 v128, v128, v132
    v_add_f32 v129, v129, v133
    v_add_f32 v130, v130, v134
    v_add_f32 v131, v131, v135
    v_lshlrev_b32 v14, 4, v8
    v_lshl_add_u32 v14, v5, 7, v14
    s_lshl_b32 s31, s30, 8
    v_add_u32 v13, s31, v14
    ds_write_b128 v13, v[128:131]
    s_waitcnt lgkmcnt(0)
    s_barrier
    ds_read_b128 v[96:99], v14 offset:0
    ds_read_b128 v[100:103], v14 offset:256
    ds_read_b128 v[104:107], v14 offset:512
    ds_read_b128 v[108:111], v14 offset:768
    s_waitcnt lgkmcnt(0)
    v_pk_add_f32 v[96:97], v[96:97], v[100:101]
    v_pk_add_f32 v[98:99], v[98:99], v[102:103]
    v_pk_add_f32 v[96:97], v[96:97], v[104:105]
    v_pk_add_f32 v[98:99], v[98:99], v[106:107]
    v_pk_add_f32 v[96:97], v[96:97], v[108:109]
    v_pk_add_f32 v[98:99], v[98:99], v[110:111]
    v_cvt_pk_bf16_f32 v20, v96, v97
    v_lshlrev_b32 v21, 16, v20
    v_and_b32 v22, 0xffff0000, v20
    v_mul_f32 v21, v36, v21
    v_mul_f32 v22, v36, v22
    v_cvt_pk_bf16_f32 v20, v21, v22
    v_lshlrev_b32 v21, 16, v20
    v_and_b32 v22, 0xffff0000, v20
    v_lshlrev_b32 v23, 16, v32
    v_and_b32 v24, 0xffff0000, v32
    v_add_f32 v21, v21, v23
    v_add_f32 v22, v22, v24
    v_cvt_pk_bf16_f32 v20, v21, v22
    v_lshlrev_b32 v21, 16, v20
    v_and_b32 v22, 0xffff0000, v20
    v_lshlrev_b32 v23, 16, v34
    v_and_b32 v24, 0xffff0000, v34
    v_add_f32 v21, v21, v23
    v_add_f32 v22, v22, v24
    v_cvt_pk_bf16_f32 v26, v21, v22
    v_cvt_pk_bf16_f32 v20, v98, v99
    v_lshlrev_b32 v21, 16, v20
    v_and_b32 v22, 0xffff0000, v20
    v_mul_f32 v21, v36, v21
    v_mul_f32 v22, v36, v22
    v_cvt_pk_bf16_f32 v20, v21, v22
    v_lshlrev_b32 v21, 16, v20
    v_and_b32 v22, 0xffff0000, v20
    v_lshlrev_b32 v23, 16, v33
    v_and_b32 v24, 0xffff0000, v33
    v_add_f32 v21, v21, v23
    v_add_f32 v22, v22, v24
    v_cvt_pk_bf16_f32 v20, v21, v22
    v_lshlrev_b32 v21, 16, v20
    v_and_b32 v22, 0xffff0000, v20
    v_lshlrev_b32 v23, 16, v35
    v_and_b32 v24, 0xffff0000, v35
    v_add_f32 v21, v21, v23
    v_add_f32 v22, v22, v24
    v_cvt_pk_bf16_f32 v27, v21, v22
    s_cmp_lg_u32 s30, 0
    s_cbranch_scc1 ff_fin_155
    s_mov_b32 exec_lo, 0xff
    s_mov_b32 exec_hi, 0xff
    buffer_store_dwordx2 v[26:27], v9, s[36:39], 0 offen sc1
ff_fin_155:
    s_mov_b64 exec, -1
k12_end_1:
    s_endpgm
k2_prep_76:
    s_sub_u32 s40, s36, s38
    v_subrev_u32 v6, s40, v4
    v_cmp_gt_i32 s[44:45], 0, v6
    v_cmp_gt_i32 s[46:47], 1, v6
    v_cmp_gt_i32 s[48:49], 2, v6
    v_cmp_gt_i32 s[50:51], 3, v6
    v_cndmask_b32 v16, v8, v5, s[44:45]
    v_cndmask_b32 v17, v8, v5, s[46:47]
    v_cndmask_b32 v18, v8, v5, s[48:49]
    v_cndmask_b32 v19, v8, v5, s[50:51]
    v_cmp_gt_i32 s[44:45], 16, v6
    v_cmp_gt_i32 s[46:47], 17, v6
    v_cmp_gt_i32 s[48:49], 18, v6
    v_cmp_gt_i32 s[50:51], 19, v6
    v_cndmask_b32 v32, v8, v5, s[44:45]
    v_cndmask_b32 v33, v8, v5, s[46:47]
    v_cndmask_b32 v34, v8, v5, s[48:49]
    v_cndmask_b32 v35, v8, v5, s[50:51]
    s_nop 1
    s_branch k2_prepret_77
k2_prep_84:
    s_sub_u32 s40, s36, s38
    v_subrev_u32 v6, s40, v4
    v_cmp_gt_i32 s[44:45], 0, v6
    v_cmp_gt_i32 s[46:47], 1, v6
    v_cmp_gt_i32 s[48:49], 2, v6
    v_cmp_gt_i32 s[50:51], 3, v6
    v_cndmask_b32 v16, v8, v5, s[44:45]
    v_cndmask_b32 v17, v8, v5, s[46:47]
    v_cndmask_b32 v18, v8, v5, s[48:49]
    v_cndmask_b32 v19, v8, v5, s[50:51]
    v_cmp_gt_i32 s[44:45], 16, v6
    v_cmp_gt_i32 s[46:47], 17, v6
    v_cmp_gt_i32 s[48:49], 18, v6
    v_cmp_gt_i32 s[50:51], 19, v6
    v_cndmask_b32 v32, v8, v5, s[44:45]
    v_cndmask_b32 v33, v8, v5, s[46:47]
    v_cndmask_b32 v34, v8, v5, s[48:49]
    v_cndmask_b32 v35, v8, v5, s[50:51]
    s_nop 1
    s_branch k2_prepret_85
k2_prep_102:
    s_sub_u32 s40, s36, s39
    v_subrev_u32 v6, s40, v4
    v_cmp_gt_i32 s[44:45], 0, v6
    v_cmp_gt_i32 s[46:47], 1, v6
    v_cmp_gt_i32 s[48:49], 2, v6
    v_cmp_gt_i32 s[50:51], 3, v6
    v_cndmask_b32 v16, v10, v5, s[44:45]
    v_cndmask_b32 v17, v10, v5, s[46:47]
    v_cndmask_b32 v18, v10, v5, s[48:49]
    v_cndmask_b32 v19, v10, v5, s[50:51]
    v_cmp_gt_i32 s[44:45], 16, v6
    v_cmp_gt_i32 s[46:47], 17, v6
    v_cmp_gt_i32 s[48:49], 18, v6
    v_cmp_gt_i32 s[50:51], 19, v6
    v_cndmask_b32 v32, v10, v5, s[44:45]
    v_cndmask_b32 v33, v10, v5, s[46:47]
    v_cndmask_b32 v34, v10, v5, s[48:49]
    v_cndmask_b32 v35, v10, v5, s[50:51]
    v_cmp_gt_i32 s[44:45], 32, v6
    v_cmp_gt_i32 s[46:47], 33, v6
    v_cmp_gt_i32 s[48:49], 34, v6
    v_cmp_gt_i32 s[50:51], 35, v6
    v_cndmask_b32 v24, v10, v5, s[44:45]
    v_cndmask_b32 v25, v10, v5, s[46:47]
    v_cndmask_b32 v26, v10, v5, s[48:49]
    v_cndmask_b32 v27, v10, v5, s[50:51]
    v_cmp_gt_i32 s[44:45], 48, v6
    v_cmp_gt_i32 s[46:47], 49, v6
    v_cmp_gt_i32 s[48:49], 50, v6
    v_cmp_gt_i32 s[50:51], 51, v6
    v_cndmask_b32 v40, v10, v5, s[44:45]
    v_cndmask_b32 v41, v10, v5, s[46:47]
    v_cndmask_b32 v42, v10, v5, s[48:49]
    v_cndmask_b32 v43, v10, v5, s[50:51]
    s_nop 1
    s_branch k2_prepret_103
k2_prep_106:
    s_sub_u32 s40, s36, s39
    s_sub_u32 s40, s40, 64
    v_subrev_u32 v6, s40, v4
    v_cmp_gt_i32 s[44:45], 0, v6
    v_cmp_gt_i32 s[46:47], 1, v6
    v_cmp_gt_i32 s[48:49], 2, v6
    v_cmp_gt_i32 s[50:51], 3, v6
    v_cndmask_b32 v20, v11, v5, s[44:45]
    v_cndmask_b32 v21, v11, v5, s[46:47]
    v_cndmask_b32 v22, v11, v5, s[48:49]
    v_cndmask_b32 v23, v11, v5, s[50:51]
    v_cmp_gt_i32 s[44:45], 16, v6
    v_cmp_gt_i32 s[46:47], 17, v6
    v_cmp_gt_i32 s[48:49], 18, v6
    v_cmp_gt_i32 s[50:51], 19, v6
    v_cndmask_b32 v36, v11, v5, s[44:45]
    v_cndmask_b32 v37, v11, v5, s[46:47]
    v_cndmask_b32 v38, v11, v5, s[48:49]
    v_cndmask_b32 v39, v11, v5, s[50:51]
    v_cmp_gt_i32 s[44:45], 32, v6
    v_cmp_gt_i32 s[46:47], 33, v6
    v_cmp_gt_i32 s[48:49], 34, v6
    v_cmp_gt_i32 s[50:51], 35, v6
    v_cndmask_b32 v28, v11, v5, s[44:45]
    v_cndmask_b32 v29, v11, v5, s[46:47]
    v_cndmask_b32 v30, v11, v5, s[48:49]
    v_cndmask_b32 v31, v11, v5, s[50:51]
    v_cmp_gt_i32 s[44:45], 48, v6
    v_cmp_gt_i32 s[46:47], 49, v6
    v_cmp_gt_i32 s[48:49], 50, v6
    v_cmp_gt_i32 s[50:51], 51, v6
    v_cndmask_b32 v44, v11, v5, s[44:45]
    v_cndmask_b32 v45, v11, v5, s[46:47]
    v_cndmask_b32 v46, v11, v5, s[48:49]
    v_cndmask_b32 v47, v11, v5, s[50:51]
    s_nop 1
    s_branch k2_prepret_107
k12_ool_10:
    buffer_load_dword v52, v8, s[24:27], 0 offen sc1
    s_branch k12_oolret_11
k12_ool_14:
    v_readfirstlane_b32 s31, v52
    s_cmp_ge_u32 s31, 256
    s_cbranch_scc1 spin_ok_12
    s_mov_b32 s40, 1048576
spin_13:
    s_sleep 8
    buffer_load_dword v52, v8, s[24:27], 0 offen sc1
    s_waitcnt vmcnt(0)
    v_readfirstlane_b32 s31, v52
    s_sub_u32 s40, s40, 1
    s_cselect_b32 s31, -1, s31
    s_cmp_lt_u32 s31, 256
    s_cbranch_scc1 spin_13
spin_ok_12:
    s_branch k12_oolret_15
k12_ool_16:
    s_mov_b64 exec, 1
    buffer_atomic_add v9, v8, s[24:27], 0 offen sc1
    s_mov_b64 exec, -1
    s_branch k12_oolret_17
k12_ool_18:
    buffer_load_dword v51, v50, s[12:15], s56 offen
    s_branch k12_oolret_19
k12_ool_20:
    s_add_u32 m0, s60, 131072
    s_nop 0
    buffer_load_dwordx4 v38, s[12:15], s61 offen offset:0 lds
    buffer_load_dwordx4 v39, s[12:15], s61 offen offset:1024 lds
    buffer_load_dwordx4 v40, s[12:15], s61 offen offset:2048 lds
    buffer_load_dwordx4 v41, s[12:15], s61 offen offset:3072 lds
    s_add_u32 s61, s61, 0x80000
    s_add_u32 m0, s60, 147456
    s_nop 0
    buffer_load_dwordx4 v38, s[12:15], s61 offen offset:0 lds
    buffer_load_dwordx4 v39, s[12:15], s61 offen offset:1024 lds
    buffer_load_dwordx4 v40, s[12:15], s61 offen offset:2048 lds
    buffer_load_dwordx4 v41, s[12:15], s61 offen offset:3072 lds
    s_add_u32 s61, s61, 0x80000
    s_branch k12_oolret_21
k12_ool_22:
    s_mov_b64 exec, 1
    buffer_atomic_add v9, v8, s[24:27], 0 offen sc1
    s_mov_b64 exec, -1
    s_branch k12_oolret_23
k12_ool_24:
    buffer_load_dword v51, v50, s[12:15], s56 offen
    s_branch k12_oolret_25
k12_ool_26:
    global_load_dword v51, v[2:3], off
    s_branch k12_oolret_27
k12_ool_30:
    buffer_load_dword v52, v8, s[24:27], 0 offen sc1
    s_branch k12_oolret_31
k12_ool_34:
    v_readfirstlane_b32 s31, v52
    s_cmp_ge_u32 s31, 256
    s_cbranch_scc1 spin_ok_32
    s_mov_b32 s40, 1048576
spin_33:
    s_sleep 8
    buffer_load_dword v52, v8, s[24:27], 0 offen sc1
    s_waitcnt vmcnt(0)
    v_readfirstlane_b32 s31, v52
    s_sub_u32 s40, s40, 1
    s_cselect_b32 s31, -1, s31
    s_cmp_lt_u32 s31, 256
    s_cbranch_scc1 spin_33
spin_ok_32:
    s_branch k12_oolret_35
k12_ool_36:
    s_mov_b64 exec, 1
    buffer_atomic_add v9, v8, s[24:27], 0 offen sc1
    s_mov_b64 exec, -1
    s_branch k12_oolret_37
k12_ool_38:
    buffer_load_dword v51, v50, s[12:15], s56 offen
    s_branch k12_oolret_39
k12_ool_40:
    s_add_u32 m0, s60, 131072
    s_nop 0
    buffer_load_dwordx4 v38, s[12:15], s61 offen offset:0 lds
    buffer_load_dwordx4 v39, s[12:15], s61 offen offset:1024 lds
    buffer_load_dwordx4 v40, s[12:15], s61 offen offset:2048 lds
    buffer_load_dwordx4 v41, s[12:15], s61 offen offset:3072 lds
    s_add_u32 s61, s61, 0x80000
    s_add_u32 m0, s60, 147456
    s_nop 0
    buffer_load_dwordx4 v38, s[12:15], s61 offen offset:0 lds
    buffer_load_dwordx4 v39, s[12:15], s61 offen offset:1024 lds
    buffer_load_dwordx4 v40, s[12:15], s61 offen offset:2048 lds
    buffer_load_dwordx4 v41, s[12:15], s61 offen offset:3072 lds
    s_add_u32 s61, s61, 0x80000
    s_branch k12_oolret_41
k12_ool_42:
    s_mov_b64 exec, 1
    buffer_atomic_add v9, v8, s[24:27], 0 offen sc1
    s_mov_b64 exec, -1
    s_branch k12_oolret_43
k12_ool_44:
    buffer_load_dword v51, v50, s[12:15], s56 offen
    s_branch k12_oolret_45
k12_ool_46:
    global_load_dword v51, v[2:3], off
    s_branch k12_oolret_47
k12_ool_48:
    s_add_u32 s52, s47, 528384
    buffer_store_dwordx4 v[152:155], v1, s[48:51], s52 offen offset:2048 sc1
    s_branch k12_oolret_49
k12_ool_50:
    s_add_u32 s52, s47, 528384
    buffer_store_dwordx4 v[156:159], v1, s[48:51], s52 offen offset:3072 sc1
    s_branch k12_oolret_51
k12_ool_52:
    s_add_u32 s52, s47, 532480
    buffer_store_dwordx4 v[168:171], v1, s[48:51], s52 offen offset:2048 sc1
    s_branch k12_oolret_53
k12_ool_54:
    s_add_u32 s52, s47, 532480
    buffer_store_dwordx4 v[172:175], v1, s[48:51], s52 offen offset:3072 sc1
    s_branch k12_oolret_55
k12_ool_56:
    s_add_u32 s52, s47, 536576
    buffer_store_dwordx4 v[176:179], v1, s[48:51], s52 offen offset:0 sc1
    s_branch k12_oolret_57
k12_ool_58:
    s_add_u32 s52, s47, 536576
    buffer_store_dwordx4 v[180:183], v1, s[48:51], s52 offen offset:1024 sc1
    s_branch k12_oolret_59
k12_ool_60:
    s_add_u32 s52, s47, 536576
    buffer_store_dwordx4 v[184:187], v1, s[48:51], s52 offen offset:2048 sc1
    s_branch k12_oolret_61
k12_ool_62:
    s_add_u32 s52, s47, 536576
    buffer_store_dwordx4 v[188:191], v1, s[48:51], s52 offen offset:3072 sc1
    s_branch k12_oolret_63
k12_ool_64:
    s_mov_b32 s50, 0
    s_branch k12_oolret_65
k12_ool_66:
    s_mov_b64 exec, 1
    buffer_atomic_add v9, v8, s[24:27], s54 offen sc1
    s_mov_b64 exec, -1
    s_branch k12_oolret_67
k12_ool_68:
    buffer_load_dword v52, v8, s[24:27], s55 offen sc1
    s_branch k12_oolret_69
k12_ool_72:
    s_waitcnt vmcnt(10)
    v_readfirstlane_b32 s31, v52
    s_cmp_ge_u32 s31, 2
    s_cbranch_scc1 spin_ok_70
    s_mov_b32 s40, 1048576
spin_71:
    s_sleep 8
    buffer_load_dword v52, v8, s[24:27], s55 offen sc1
    s_waitcnt vmcnt(0)
    v_readfirstlane_b32 s31, v52
    s_sub_u32 s40, s40, 1
    s_cselect_b32 s31, -1, s31
    s_cmp_lt_u32 s31, 2
    s_cbranch_scc1 spin_71
spin_ok_70:
    s_branch k12_oolret_73
k12_ool_74:
    s_mov_b64 exec, 1
    buffer_atomic_add v9, v8, s[24:27], s3 offen sc1
    s_mov_b64 exec, -1
    s_branch k12_oolret_75
k12_ool_78:
    buffer_load_dword v58, v59, s[24:27], s5 offen sc1
    s_branch k12_oolret_79
k12_ool_82:
    s_waitcnt vmcnt(0)
    v_readfirstlane_b32 s31, v58
    s_cmp_ge_u32 s31, 14
    s_cbranch_scc1 spin_ok_80
    s_mov_b32 s40, 1048576
spin_81:
    s_sleep 8
    buffer_load_dword v58, v59, s[24:27], s5 offen sc1
    s_waitcnt vmcnt(0)
    v_readfirstlane_b32 s31, v58
    s_sub_u32 s40, s40, 1
    s_cselect_b32 s31, -1, s31
    s_cmp_lt_u32 s31, 14
    s_cbranch_scc1 spin_81
spin_ok_80:
    s_branch k12_oolret_83
k12_ool_122:
    s_mov_b64 exec, 1
    buffer_atomic_add v76, v75, s[16:19], s57 offen sc1
    s_mov_b64 exec, -1
    s_branch k12_oolret_123
k12_ool_127:
    s_mov_b64 exec, 1
    buffer_atomic_add v76, v75, s[16:19], s58 offen sc1
    s_mov_b64 exec, -1
    s_branch k12_oolret_128
k12_ool_131:
    s_mov_b32 s34, 1048576
op_spin_129:
    buffer_load_dword v74, v73, s[16:19], s59 offen sc1
    s_waitcnt vmcnt(0)
    v_cmp_le_u32 vcc, 4, v74
    s_sub_u32 s34, s34, 1
    s_cbranch_scc1 op_ok_130
    s_mov_b32 s33, vcc_lo
    s_bitcmp1_b32 s33, 0
    s_cbranch_scc1 op_ok_130
    s_sleep 4
    s_branch op_spin_129
op_ok_130:
    buffer_load_dwordx4 a[128:131], v88, s[8:11], s62 offen offset:0 sc1
    buffer_load_dwordx4 a[132:135], v88, s[8:11], s62 offen offset:1024 sc1
    buffer_load_dwordx4 a[136:139], v89, s[8:11], s62 offen offset:0 sc1
    buffer_load_dwordx4 a[140:143], v89, s[8:11], s62 offen offset:1024 sc1
    s_add_u32 s62, s62, 0x40000
    s_and_b32 s62, s62, 0x7fffff
    buffer_load_dwordx4 a[144:147], v88, s[8:11], s62 offen offset:0 sc1
    buffer_load_dwordx4 a[148:151], v88, s[8:11], s62 offen offset:1024 sc1
    buffer_load_dwordx4 a[152:155], v89, s[8:11], s62 offen offset:0 sc1
    buffer_load_dwordx4 a[156:159], v89, s[8:11], s62 offen offset:1024 sc1
    s_add_u32 s62, s62, 0x40000
    s_and_b32 s62, s62, 0x7fffff
    buffer_load_dwordx4 a[160:163], v88, s[8:11], s62 offen offset:0 sc1
    buffer_load_dwordx4 a[164:167], v88, s[8:11], s62 offen offset:1024 sc1
    buffer_load_dwordx4 a[168:171], v89, s[8:11], s62 offen offset:0 sc1
    buffer_load_dwordx4 a[172:175], v89, s[8:11], s62 offen offset:1024 sc1
    s_add_u32 s62, s62, 0x40000
    s_and_b32 s62, s62, 0x7fffff
    s_branch k12_oolret_132
k12_ool_137:
    buffer_load_dwordx2 v[192:193], v78, s[20:23], 0 offen offset:0
    buffer_load_dwordx2 v[194:195], v78, s[20:23], 0 offen offset:32
    buffer_load_dwordx2 v[196:197], v78, s[20:23], 0 offen offset:64
    buffer_load_dwordx2 v[198:199], v78, s[20:23], 0 offen offset:96
    buffer_load_dwordx2 v[200:201], v79, s[20:23], 0 offen offset:0
    buffer_load_dwordx2 v[202:203], v79, s[20:23], 0 offen offset:32
    buffer_load_dwordx2 v[204:205], v79, s[20:23], 0 offen offset:64
    buffer_load_dwordx2 v[206:207], v79, s[20:23], 0 offen offset:96
    buffer_load_dwordx2 v[208:209], v80, s[44:47], 0 offen offset:0
    buffer_load_dwordx2 v[210:211], v80, s[44:47], 0 offen offset:32
    buffer_load_dwordx2 v[212:213], v80, s[44:47], 0 offen offset:64
    buffer_load_dwordx2 v[214:215], v80, s[44:47], 0 offen offset:96
    global_load_dword v84, v[82:83], off
    s_mov_b32 s10, 0
    s_mov_b32 s14, 0
    s_mov_b32 s34, 1048576
ff_spin_135:
    v_cmp_gt_u32 vcc, 4, v95
    s_cbranch_vccz ff_ok_136
    s_sub_u32 s34, s34, 1
    s_cbranch_scc1 ff_ok_136
    s_sleep 4
    buffer_load_dword v95, v94, s[16:19], 0 offen sc1
    s_waitcnt vmcnt(0)
    s_branch ff_spin_135
ff_ok_136:
    s_add_u32 s44, s6, 0x6000000
    s_addc_u32 s45, s7, 0
    s_and_b32 s45, s45, 0xffff
    s_cmp_ge_u32 s2, 224
    s_cselect_b32 s46, 0, 0x1000000
    s_branch k12_oolret_138
k12_ool_141:
    s_mov_b32 s34, 1048576
op_spin_139:
    buffer_load_dword v74, v73, s[16:19], s59 offen sc1
    s_waitcnt vmcnt(0)
    v_cmp_le_u32 vcc, 4, v74
    s_sub_u32 s34, s34, 1
    s_cbranch_scc1 op_ok_140
    s_mov_b32 s33, vcc_lo
    s_bitcmp1_b32 s33, s32
    s_cbranch_scc1 op_ok_140
    s_sleep 4
    s_branch op_spin_139
op_ok_140:
    s_branch k12_oolret_142
k12_ool_143:
    buffer_load_dword v95, v94, s[16:19], 0 offen sc1
    s_branch k12_oolret_144
k2_tramp_86:
    s_call_b64 s[40:41], k2_rare_158
    s_branch k2_ret_87
k2_tramp_90:
    s_call_b64 s[40:41], k2_rare_159
    s_branch k2_ret_91
k2_tramp_92:
    s_call_b64 s[40:41], k2_rare_158
    s_branch k2_ret_93
k2_tramp_94:
    s_call_b64 s[40:41], k2_rare_159
    s_branch k2_ret_95
k2_tramp_96:
    s_call_b64 s[40:41], k2_rare_158
    s_branch k2_ret_97
k2_tramp_98:
    s_call_b64 s[40:41], k2_rare_159
    s_branch k2_ret_99
k2_tramp_100:
    s_call_b64 s[40:41], k2_rare_164
    s_branch k2_ret_101
k2_tramp_104:
    s_call_b64 s[40:41], k2_rare_165
    s_branch k2_ret_105
k2_tramp_108:
    s_call_b64 s[40:41], k2_rare_166
    s_branch k2_ret_109
k2_tramp_112:
    s_call_b64 s[40:41], k2_rare_167
    s_branch k2_ret_113
k2_tramp_114:
    s_call_b64 s[40:41], k2_rare_166
    s_branch k2_ret_115
k2_tramp_116:
    s_call_b64 s[40:41], k2_rare_167
    s_branch k2_ret_117
k2_tramp_118:
    s_call_b64 s[40:41], k2_rare_166
    s_branch k2_ret_119
k2_tramp_120:
    s_call_b64 s[40:41], k2_rare_171
    s_branch k2_ret_121
k2_rare_158:
    s_nop 7
    v_max_f32 v52, v128, v129
    v_max3_f32 v52, v52, v130, v131
    v_max3_f32 v52, v52, v144, v145
    v_max3_f32 v52, v52, v146, v147
    v_max_f32 v53, v132, v133
    v_max3_f32 v53, v53, v134, v135
    v_max3_f32 v53, v53, v148, v149
    v_max3_f32 v53, v53, v150, v151
    v_max_f32 v54, v136, v137
    v_max3_f32 v54, v54, v138, v139
    v_max3_f32 v54, v54, v152, v153
    v_max3_f32 v54, v54, v154, v155
    v_max_f32 v55, v140, v141
    v_max3_f32 v55, v55, v142, v143
    v_max3_f32 v55, v55, v156, v157
    v_max3_f32 v55, v55, v158, v159
    v_mov_b32 v224, v52
    v_mov_b32 v225, v53
    v_mov_b32 v226, v54
    v_mov_b32 v227, v55
    s_nop 1
    v_permlane16_swap_b32 v52, v224
    v_permlane16_swap_b32 v53, v225
    v_permlane16_swap_b32 v54, v226
    v_permlane16_swap_b32 v55, v227
    s_nop 1
    v_max_f32 v52, v52, v224
    v_max_f32 v53, v53, v225
    v_max_f32 v54, v54, v226
    v_max_f32 v55, v55, v227
    v_mov_b32 v224, v52
    v_mov_b32 v225, v53
    v_mov_b32 v226, v54
    v_mov_b32 v227, v55
    s_nop 1
    v_permlane32_swap_b32 v52, v224
    v_permlane32_swap_b32 v53, v225
    v_permlane32_swap_b32 v54, v226
    v_permlane32_swap_b32 v55, v227
    s_nop 1
    v_max_f32 v52, v52, v224
    v_max_f32 v53, v53, v225
    v_max_f32 v54, v54, v226
    v_max_f32 v55, v55, v227
    v_add_f32 v52, 0x41400000, v52
    v_max_f32 v52, 0, v52
    v_add_f32 v53, 0x41400000, v53
    v_max_f32 v53, 0, v53
    v_add_f32 v54, 0x41400000, v54
    v_max_f32 v54, 0, v54
    v_add_f32 v55, 0x41400000, v55
    v_max_f32 v55, 0, v55
    v_sub_f32 v128, v128, v52
    v_sub_f32 v129, v129, v52
    v_sub_f32 v130, v130, v52
    v_sub_f32 v131, v131, v52
    v_sub_f32 v132, v132, v53
    v_sub_f32 v133, v133, v53
    v_sub_f32 v134, v134, v53
    v_sub_f32 v135, v135, v53
    v_sub_f32 v136, v136, v54
    v_sub_f32 v137, v137, v54
    v_sub_f32 v138, v138, v54
    v_sub_f32 v139, v139, v54
    v_sub_f32 v140, v140, v55
    v_sub_f32 v141, v141, v55
    v_sub_f32 v142, v142, v55
    v_sub_f32 v143, v143, v55
    v_sub_f32 v144, v144, v52
    v_sub_f32 v145, v145, v52
    v_sub_f32 v146, v146, v52
    v_sub_f32 v147, v147, v52
    v_sub_f32 v148, v148, v53
    v_sub_f32 v149, v149, v53
    v_sub_f32 v150, v150, v53
    v_sub_f32 v151, v151, v53
    v_sub_f32 v152, v152, v54
    v_sub_f32 v153, v153, v54
    v_sub_f32 v154, v154, v54
    v_sub_f32 v155, v155, v54
    v_sub_f32 v156, v156, v55
    v_sub_f32 v157, v157, v55
    v_sub_f32 v158, v158, v55
    v_sub_f32 v159, v159, v55
    v_sub_f32 v160, v160, v52
    v_sub_f32 v16, v16, v52
    v_sub_f32 v161, v161, v52
    v_sub_f32 v17, v17, v52
    v_sub_f32 v162, v162, v52
    v_sub_f32 v18, v18, v52
    v_sub_f32 v163, v163, v52
    v_sub_f32 v19, v19, v52
    v_sub_f32 v164, v164, v53
    v_sub_f32 v20, v20, v53
    v_sub_f32 v165, v165, v53
    v_sub_f32 v21, v21, v53
    v_sub_f32 v166, v166, v53
    v_sub_f32 v22, v22, v53
    v_sub_f32 v167, v167, v53
    v_sub_f32 v23, v23, v53
    v_sub_f32 v168, v168, v54
    v_sub_f32 v24, v24, v54
    v_sub_f32 v169, v169, v54
    v_sub_f32 v25, v25, v54
    v_sub_f32 v170, v170, v54
    v_sub_f32 v26, v26, v54
    v_sub_f32 v171, v171, v54
    v_sub_f32 v27, v27, v54
    v_sub_f32 v172, v172, v55
    v_sub_f32 v28, v28, v55
    v_sub_f32 v173, v173, v55
    v_sub_f32 v29, v29, v55
    v_sub_f32 v174, v174, v55
    v_sub_f32 v30, v30, v55
    v_sub_f32 v175, v175, v55
    v_sub_f32 v31, v31, v55
    v_sub_f32 v176, v176, v52
    v_sub_f32 v32, v32, v52
    v_sub_f32 v177, v177, v52
    v_sub_f32 v33, v33, v52
    v_sub_f32 v178, v178, v52
    v_sub_f32 v34, v34, v52
    v_sub_f32 v179, v179, v52
    v_sub_f32 v35, v35, v52
    v_sub_f32 v180, v180, v53
    v_sub_f32 v36, v36, v53
    v_sub_f32 v181, v181, v53
    v_sub_f32 v37, v37, v53
    v_sub_f32 v182, v182, v53
    v_sub_f32 v38, v38, v53
    v_sub_f32 v183, v183, v53
    v_sub_f32 v39, v39, v53
    v_sub_f32 v184, v184, v54
    v_sub_f32 v40, v40, v54
    v_sub_f32 v185, v185, v54
    v_sub_f32 v41, v41, v54
    v_sub_f32 v186, v186, v54
    v_sub_f32 v42, v42, v54
    v_sub_f32 v187, v187, v54
    v_sub_f32 v43, v43, v54
    v_sub_f32 v188, v188, v55
    v_sub_f32 v44, v44, v55
    v_sub_f32 v189, v189, v55
    v_sub_f32 v45, v45, v55
    v_sub_f32 v190, v190, v55
    v_sub_f32 v46, v46, v55
    v_sub_f32 v191, v191, v55
    v_sub_f32 v47, v47, v55
    v_sub_f32 v8, v8, v52
    v_exp_f32 v52, -v52
    v_sub_f32 v9, v9, v53
    v_exp_f32 v53, -v53
    v_sub_f32 v10, v10, v54
    v_exp_f32 v54, -v54
    v_sub_f32 v11, v11, v55
    v_exp_f32 v55, -v55
    s_nop 0
    v_mul_f32 v12, v12, v52
    v_mul_f32 v48, v48, v53
    v_mul_f32 v248, v248, v54
    v_mul_f32 v252, v252, v55
    v_accvgpr_read_b32 v224, a0
    v_accvgpr_read_b32 v225, a1
    v_accvgpr_read_b32 v226, a2
    v_accvgpr_read_b32 v227, a3
    v_mul_f32 v224, v224, v52
    v_mul_f32 v225, v225, v52
    v_mul_f32 v226, v226, v52
    v_mul_f32 v227, v227, v52
    v_accvgpr_write_b32 a0, v224
    v_accvgpr_write_b32 a1, v225
    v_accvgpr_write_b32 a2, v226
    v_accvgpr_write_b32 a3, v227
    v_accvgpr_read_b32 v224, a4
    v_accvgpr_read_b32 v225, a5
    v_accvgpr_read_b32 v226, a6
    v_accvgpr_read_b32 v227, a7
    v_mul_f32 v224, v224, v53
    v_mul_f32 v225, v225, v53
    v_mul_f32 v226, v226, v53
    v_mul_f32 v227, v227, v53
    v_accvgpr_write_b32 a4, v224
    v_accvgpr_write_b32 a5, v225
    v_accvgpr_write_b32 a6, v226
    v_accvgpr_write_b32 a7, v227
    v_accvgpr_read_b32 v224, a8
    v_accvgpr_read_b32 v225, a9
    v_accvgpr_read_b32 v226, a10
    v_accvgpr_read_b32 v227, a11
    v_mul_f32 v224, v224, v54
    v_mul_f32 v225, v225, v54
    v_mul_f32 v226, v226, v54
    v_mul_f32 v227, v227, v54
    v_accvgpr_write_b32 a8, v224
    v_accvgpr_write_b32 a9, v225
    v_accvgpr_write_b32 a10, v226
    v_accvgpr_write_b32 a11, v227
    v_accvgpr_read_b32 v224, a12
    v_accvgpr_read_b32 v225, a13
    v_accvgpr_read_b32 v226, a14
    v_accvgpr_read_b32 v227, a15
    v_mul_f32 v224, v224, v55
    v_mul_f32 v225, v225, v55
    v_mul_f32 v226, v226, v55
    v_mul_f32 v227, v227, v55
    v_accvgpr_write_b32 a12, v224
    v_accvgpr_write_b32 a13, v225
    v_accvgpr_write_b32 a14, v226
    v_accvgpr_write_b32 a15, v227
    v_accvgpr_read_b32 v224, a16
    v_accvgpr_read_b32 v225, a17
    v_accvgpr_read_b32 v226, a18
    v_accvgpr_read_b32 v227, a19
    v_mul_f32 v224, v224, v52
    v_mul_f32 v225, v225, v52
    v_mul_f32 v226, v226, v52
    v_mul_f32 v227, v227, v52
    v_accvgpr_write_b32 a16, v224
    v_accvgpr_write_b32 a17, v225
    v_accvgpr_write_b32 a18, v226
    v_accvgpr_write_b32 a19, v227
    v_accvgpr_read_b32 v224, a20
    v_accvgpr_read_b32 v225, a21
    v_accvgpr_read_b32 v226, a22
    v_accvgpr_read_b32 v227, a23
    v_mul_f32 v224, v224, v53
    v_mul_f32 v225, v225, v53
    v_mul_f32 v226, v226, v53
    v_mul_f32 v227, v227, v53
    v_accvgpr_write_b32 a20, v224
    v_accvgpr_write_b32 a21, v225
    v_accvgpr_write_b32 a22, v226
    v_accvgpr_write_b32 a23, v227
    v_accvgpr_read_b32 v224, a24
    v_accvgpr_read_b32 v225, a25
    v_accvgpr_read_b32 v226, a26
    v_accvgpr_read_b32 v227, a27
    v_mul_f32 v224, v224, v54
    v_mul_f32 v225, v225, v54
    v_mul_f32 v226, v226, v54
    v_mul_f32 v227, v227, v54
    v_accvgpr_write_b32 a24, v224
    v_accvgpr_write_b32 a25, v225
    v_accvgpr_write_b32 a26, v226
    v_accvgpr_write_b32 a27, v227
    v_accvgpr_read_b32 v224, a28
    v_accvgpr_read_b32 v225, a29
    v_accvgpr_read_b32 v226, a30
    v_accvgpr_read_b32 v227, a31
    v_mul_f32 v224, v224, v55
    v_mul_f32 v225, v225, v55
    v_mul_f32 v226, v226, v55
    v_mul_f32 v227, v227, v55
    v_accvgpr_write_b32 a28, v224
    v_accvgpr_write_b32 a29, v225
    v_accvgpr_write_b32 a30, v226
    v_accvgpr_write_b32 a31, v227
    v_accvgpr_read_b32 v224, a32
    v_accvgpr_read_b32 v225, a33
    v_accvgpr_read_b32 v226, a34
    v_accvgpr_read_b32 v227, a35
    v_mul_f32 v224, v224, v52
    v_mul_f32 v225, v225, v52
    v_mul_f32 v226, v226, v52
    v_mul_f32 v227, v227, v52
    v_accvgpr_write_b32 a32, v224
    v_accvgpr_write_b32 a33, v225
    v_accvgpr_write_b32 a34, v226
    v_accvgpr_write_b32 a35, v227
    v_accvgpr_read_b32 v224, a36
    v_accvgpr_read_b32 v225, a37
    v_accvgpr_read_b32 v226, a38
    v_accvgpr_read_b32 v227, a39
    v_mul_f32 v224, v224, v53
    v_mul_f32 v225, v225, v53
    v_mul_f32 v226, v226, v53
    v_mul_f32 v227, v227, v53
    v_accvgpr_write_b32 a36, v224
    v_accvgpr_write_b32 a37, v225
    v_accvgpr_write_b32 a38, v226
    v_accvgpr_write_b32 a39, v227
    v_accvgpr_read_b32 v224, a40
    v_accvgpr_read_b32 v225, a41
    v_accvgpr_read_b32 v226, a42
    v_accvgpr_read_b32 v227, a43
    v_mul_f32 v224, v224, v54
    v_mul_f32 v225, v225, v54
    v_mul_f32 v226, v226, v54
    v_mul_f32 v227, v227, v54
    v_accvgpr_write_b32 a40, v224
    v_accvgpr_write_b32 a41, v225
    v_accvgpr_write_b32 a42, v226
    v_accvgpr_write_b32 a43, v227
    v_accvgpr_read_b32 v224, a44
    v_accvgpr_read_b32 v225, a45
    v_accvgpr_read_b32 v226, a46
    v_accvgpr_read_b32 v227, a47
    v_mul_f32 v224, v224, v55
    v_mul_f32 v225, v225, v55
    v_mul_f32 v226, v226, v55
    v_mul_f32 v227, v227, v55
    v_accvgpr_write_b32 a44, v224
    v_accvgpr_write_b32 a45, v225
    v_accvgpr_write_b32 a46, v226
    v_accvgpr_write_b32 a47, v227
    v_accvgpr_read_b32 v224, a48
    v_accvgpr_read_b32 v225, a49
    v_accvgpr_read_b32 v226, a50
    v_accvgpr_read_b32 v227, a51
    v_mul_f32 v224, v224, v52
    v_mul_f32 v225, v225, v52
    v_mul_f32 v226, v226, v52
    v_mul_f32 v227, v227, v52
    v_accvgpr_write_b32 a48, v224
    v_accvgpr_write_b32 a49, v225
    v_accvgpr_write_b32 a50, v226
    v_accvgpr_write_b32 a51, v227
    v_accvgpr_read_b32 v224, a52
    v_accvgpr_read_b32 v225, a53
    v_accvgpr_read_b32 v226, a54
    v_accvgpr_read_b32 v227, a55
    v_mul_f32 v224, v224, v53
    v_mul_f32 v225, v225, v53
    v_mul_f32 v226, v226, v53
    v_mul_f32 v227, v227, v53
    v_accvgpr_write_b32 a52, v224
    v_accvgpr_write_b32 a53, v225
    v_accvgpr_write_b32 a54, v226
    v_accvgpr_write_b32 a55, v227
    v_accvgpr_read_b32 v224, a56
    v_accvgpr_read_b32 v225, a57
    v_accvgpr_read_b32 v226, a58
    v_accvgpr_read_b32 v227, a59
    v_mul_f32 v224, v224, v54
    v_mul_f32 v225, v225, v54
    v_mul_f32 v226, v226, v54
    v_mul_f32 v227, v227, v54
    v_accvgpr_write_b32 a56, v224
    v_accvgpr_write_b32 a57, v225
    v_accvgpr_write_b32 a58, v226
    v_accvgpr_write_b32 a59, v227
    v_accvgpr_read_b32 v224, a60
    v_accvgpr_read_b32 v225, a61
    v_accvgpr_read_b32 v226, a62
    v_accvgpr_read_b32 v227, a63
    v_mul_f32 v224, v224, v55
    v_mul_f32 v225, v225, v55
    v_mul_f32 v226, v226, v55
    v_mul_f32 v227, v227, v55
    v_accvgpr_write_b32 a60, v224
    v_accvgpr_write_b32 a61, v225
    v_accvgpr_write_b32 a62, v226
    v_accvgpr_write_b32 a63, v227
    v_accvgpr_read_b32 v224, a64
    v_accvgpr_read_b32 v225, a65
    v_accvgpr_read_b32 v226, a66
    v_accvgpr_read_b32 v227, a67
    v_mul_f32 v224, v224, v52
    v_mul_f32 v225, v225, v52
    v_mul_f32 v226, v226, v52
    v_mul_f32 v227, v227, v52
    v_accvgpr_write_b32 a64, v224
    v_accvgpr_write_b32 a65, v225
    v_accvgpr_write_b32 a66, v226
    v_accvgpr_write_b32 a67, v227
    v_accvgpr_read_b32 v224, a68
    v_accvgpr_read_b32 v225, a69
    v_accvgpr_read_b32 v226, a70
    v_accvgpr_read_b32 v227, a71
    v_mul_f32 v224, v224, v53
    v_mul_f32 v225, v225, v53
    v_mul_f32 v226, v226, v53
    v_mul_f32 v227, v227, v53
    v_accvgpr_write_b32 a68, v224
    v_accvgpr_write_b32 a69, v225
    v_accvgpr_write_b32 a70, v226
    v_accvgpr_write_b32 a71, v227
    v_accvgpr_read_b32 v224, a72
    v_accvgpr_read_b32 v225, a73
    v_accvgpr_read_b32 v226, a74
    v_accvgpr_read_b32 v227, a75
    v_mul_f32 v224, v224, v54
    v_mul_f32 v225, v225, v54
    v_mul_f32 v226, v226, v54
    v_mul_f32 v227, v227, v54
    v_accvgpr_write_b32 a72, v224
    v_accvgpr_write_b32 a73, v225
    v_accvgpr_write_b32 a74, v226
    v_accvgpr_write_b32 a75, v227
    v_accvgpr_read_b32 v224, a76
    v_accvgpr_read_b32 v225, a77
    v_accvgpr_read_b32 v226, a78
    v_accvgpr_read_b32 v227, a79
    v_mul_f32 v224, v224, v55
    v_mul_f32 v225, v225, v55
    v_mul_f32 v226, v226, v55
    v_mul_f32 v227, v227, v55
    v_accvgpr_write_b32 a76, v224
    v_accvgpr_write_b32 a77, v225
    v_accvgpr_write_b32 a78, v226
    v_accvgpr_write_b32 a79, v227
    v_accvgpr_read_b32 v224, a80
    v_accvgpr_read_b32 v225, a81
    v_accvgpr_read_b32 v226, a82
    v_accvgpr_read_b32 v227, a83
    v_mul_f32 v224, v224, v52
    v_mul_f32 v225, v225, v52
    v_mul_f32 v226, v226, v52
    v_mul_f32 v227, v227, v52
    v_accvgpr_write_b32 a80, v224
    v_accvgpr_write_b32 a81, v225
    v_accvgpr_write_b32 a82, v226
    v_accvgpr_write_b32 a83, v227
    v_accvgpr_read_b32 v224, a84
    v_accvgpr_read_b32 v225, a85
    v_accvgpr_read_b32 v226, a86
    v_accvgpr_read_b32 v227, a87
    v_mul_f32 v224, v224, v53
    v_mul_f32 v225, v225, v53
    v_mul_f32 v226, v226, v53
    v_mul_f32 v227, v227, v53
    v_accvgpr_write_b32 a84, v224
    v_accvgpr_write_b32 a85, v225
    v_accvgpr_write_b32 a86, v226
    v_accvgpr_write_b32 a87, v227
    v_accvgpr_read_b32 v224, a88
    v_accvgpr_read_b32 v225, a89
    v_accvgpr_read_b32 v226, a90
    v_accvgpr_read_b32 v227, a91
    v_mul_f32 v224, v224, v54
    v_mul_f32 v225, v225, v54
    v_mul_f32 v226, v226, v54
    v_mul_f32 v227, v227, v54
    v_accvgpr_write_b32 a88, v224
    v_accvgpr_write_b32 a89, v225
    v_accvgpr_write_b32 a90, v226
    v_accvgpr_write_b32 a91, v227
    v_accvgpr_read_b32 v224, a92
    v_accvgpr_read_b32 v225, a93
    v_accvgpr_read_b32 v226, a94
    v_accvgpr_read_b32 v227, a95
    v_mul_f32 v224, v224, v55
    v_mul_f32 v225, v225, v55
    v_mul_f32 v226, v226, v55
    v_mul_f32 v227, v227, v55
    v_accvgpr_write_b32 a92, v224
    v_accvgpr_write_b32 a93, v225
    v_accvgpr_write_b32 a94, v226
    v_accvgpr_write_b32 a95, v227
    v_accvgpr_read_b32 v224, a96
    v_accvgpr_read_b32 v225, a97
    v_accvgpr_read_b32 v226, a98
    v_accvgpr_read_b32 v227, a99
    v_mul_f32 v224, v224, v52
    v_mul_f32 v225, v225, v52
    v_mul_f32 v226, v226, v52
    v_mul_f32 v227, v227, v52
    v_accvgpr_write_b32 a96, v224
    v_accvgpr_write_b32 a97, v225
    v_accvgpr_write_b32 a98, v226
    v_accvgpr_write_b32 a99, v227
    v_accvgpr_read_b32 v224, a100
    v_accvgpr_read_b32 v225, a101
    v_accvgpr_read_b32 v226, a102
    v_accvgpr_read_b32 v227, a103
    v_mul_f32 v224, v224, v53
    v_mul_f32 v225, v225, v53
    v_mul_f32 v226, v226, v53
    v_mul_f32 v227, v227, v53
    v_accvgpr_write_b32 a100, v224
    v_accvgpr_write_b32 a101, v225
    v_accvgpr_write_b32 a102, v226
    v_accvgpr_write_b32 a103, v227
    v_accvgpr_read_b32 v224, a104
    v_accvgpr_read_b32 v225, a105
    v_accvgpr_read_b32 v226, a106
    v_accvgpr_read_b32 v227, a107
    v_mul_f32 v224, v224, v54
    v_mul_f32 v225, v225, v54
    v_mul_f32 v226, v226, v54
    v_mul_f32 v227, v227, v54
    v_accvgpr_write_b32 a104, v224
    v_accvgpr_write_b32 a105, v225
    v_accvgpr_write_b32 a106, v226
    v_accvgpr_write_b32 a107, v227
    v_accvgpr_read_b32 v224, a108
    v_accvgpr_read_b32 v225, a109
    v_accvgpr_read_b32 v226, a110
    v_accvgpr_read_b32 v227, a111
    v_mul_f32 v224, v224, v55
    v_mul_f32 v225, v225, v55
    v_mul_f32 v226, v226, v55
    v_mul_f32 v227, v227, v55
    v_accvgpr_write_b32 a108, v224
    v_accvgpr_write_b32 a109, v225
    v_accvgpr_write_b32 a110, v226
    v_accvgpr_write_b32 a111, v227
    v_accvgpr_read_b32 v224, a112
    v_accvgpr_read_b32 v225, a113
    v_accvgpr_read_b32 v226, a114
    v_accvgpr_read_b32 v227, a115
    v_mul_f32 v224, v224, v52
    v_mul_f32 v225, v225, v52
    v_mul_f32 v226, v226, v52
    v_mul_f32 v227, v227, v52
    v_accvgpr_write_b32 a112, v224
    v_accvgpr_write_b32 a113, v225
    v_accvgpr_write_b32 a114, v226
    v_accvgpr_write_b32 a115, v227
    v_accvgpr_read_b32 v224, a116
    v_accvgpr_read_b32 v225, a117
    v_accvgpr_read_b32 v226, a118
    v_accvgpr_read_b32 v227, a119
    v_mul_f32 v224, v224, v53
    v_mul_f32 v225, v225, v53
    v_mul_f32 v226, v226, v53
    v_mul_f32 v227, v227, v53
    v_accvgpr_write_b32 a116, v224
    v_accvgpr_write_b32 a117, v225
    v_accvgpr_write_b32 a118, v226
    v_accvgpr_write_b32 a119, v227
    v_accvgpr_read_b32 v224, a120
    v_accvgpr_read_b32 v225, a121
    v_accvgpr_read_b32 v226, a122
    v_accvgpr_read_b32 v227, a123
    v_mul_f32 v224, v224, v54
    v_mul_f32 v225, v225, v54
    v_mul_f32 v226, v226, v54
    v_mul_f32 v227, v227, v54
    v_accvgpr_write_b32 a120, v224
    v_accvgpr_write_b32 a121, v225
    v_accvgpr_write_b32 a122, v226
    v_accvgpr_write_b32 a123, v227
    v_accvgpr_read_b32 v224, a124
    v_accvgpr_read_b32 v225, a125
    v_accvgpr_read_b32 v226, a126
    v_accvgpr_read_b32 v227, a127
    v_mul_f32 v224, v224, v55
    v_mul_f32 v225, v225, v55
    v_mul_f32 v226, v226, v55
    v_mul_f32 v227, v227, v55
    v_accvgpr_write_b32 a124, v224
    v_accvgpr_write_b32 a125, v225
    v_accvgpr_write_b32 a126, v226
    v_accvgpr_write_b32 a127, v227
    v_exp_f32 v232, v128
    v_exp_f32 v233, v129
    v_exp_f32 v234, v130
    v_exp_f32 v235, v131
    s_nop 0
    v_cvt_pk_bf16_f32 v192, v232, v233
    v_cvt_pk_bf16_f32 v193, v234, v235
    v_exp_f32 v232, v144
    v_exp_f32 v233, v145
    v_exp_f32 v234, v146
    v_exp_f32 v235, v147
    s_nop 0
    v_cvt_pk_bf16_f32 v194, v232, v233
    v_cvt_pk_bf16_f32 v195, v234, v235
    v_exp_f32 v232, v132
    v_exp_f32 v233, v133
    v_exp_f32 v234, v134
    v_exp_f32 v235, v135
    s_nop 0
    v_cvt_pk_bf16_f32 v196, v232, v233
    v_cvt_pk_bf16_f32 v197, v234, v235
    v_exp_f32 v232, v148
    v_exp_f32 v233, v149
    v_exp_f32 v234, v150
    v_exp_f32 v235, v151
    s_nop 0
    v_cvt_pk_bf16_f32 v198, v232, v233
    v_cvt_pk_bf16_f32 v199, v234, v235
    v_exp_f32 v232, v136
    v_exp_f32 v233, v137
    v_exp_f32 v234, v138
    v_exp_f32 v235, v139
    s_nop 0
    v_cvt_pk_bf16_f32 v200, v232, v233
    v_cvt_pk_bf16_f32 v201, v234, v235
    v_exp_f32 v232, v152
    v_exp_f32 v233, v153
    v_exp_f32 v234, v154
    v_exp_f32 v235, v155
    s_nop 0
    v_cvt_pk_bf16_f32 v202, v232, v233
    v_cvt_pk_bf16_f32 v203, v234, v235
    v_exp_f32 v232, v140
    v_exp_f32 v233, v141
    v_exp_f32 v234, v142
    v_exp_f32 v235, v143
    s_nop 0
    v_cvt_pk_bf16_f32 v204, v232, v233
    v_cvt_pk_bf16_f32 v205, v234, v235
    v_exp_f32 v232, v156
    v_exp_f32 v233, v157
    v_exp_f32 v234, v158
    v_exp_f32 v235, v159
    s_nop 0
    v_cvt_pk_bf16_f32 v206, v232, v233
    v_cvt_pk_bf16_f32 v207, v234, v235
    s_nop 3
    s_setpc_b64 s[40:41]
k2_rare_159:
    s_nop 7
    v_max_f32 v52, v160, v161
    v_max3_f32 v52, v52, v162, v163
    v_max3_f32 v52, v52, v176, v177
    v_max3_f32 v52, v52, v178, v179
    v_max_f32 v53, v164, v165
    v_max3_f32 v53, v53, v166, v167
    v_max3_f32 v53, v53, v180, v181
    v_max3_f32 v53, v53, v182, v183
    v_max_f32 v54, v168, v169
    v_max3_f32 v54, v54, v170, v171
    v_max3_f32 v54, v54, v184, v185
    v_max3_f32 v54, v54, v186, v187
    v_max_f32 v55, v172, v173
    v_max3_f32 v55, v55, v174, v175
    v_max3_f32 v55, v55, v188, v189
    v_max3_f32 v55, v55, v190, v191
    v_mov_b32 v224, v52
    v_mov_b32 v225, v53
    v_mov_b32 v226, v54
    v_mov_b32 v227, v55
    s_nop 1
    v_permlane16_swap_b32 v52, v224
    v_permlane16_swap_b32 v53, v225
    v_permlane16_swap_b32 v54, v226
    v_permlane16_swap_b32 v55, v227
    s_nop 1
    v_max_f32 v52, v52, v224
    v_max_f32 v53, v53, v225
    v_max_f32 v54, v54, v226
    v_max_f32 v55, v55, v227
    v_mov_b32 v224, v52
    v_mov_b32 v225, v53
    v_mov_b32 v226, v54
    v_mov_b32 v227, v55
    s_nop 1
    v_permlane32_swap_b32 v52, v224
    v_permlane32_swap_b32 v53, v225
    v_permlane32_swap_b32 v54, v226
    v_permlane32_swap_b32 v55, v227
    s_nop 1
    v_max_f32 v52, v52, v224
    v_max_f32 v53, v53, v225
    v_max_f32 v54, v54, v226
    v_max_f32 v55, v55, v227
    v_add_f32 v52, 0x41400000, v52
    v_max_f32 v52, 0, v52
    v_add_f32 v53, 0x41400000, v53
    v_max_f32 v53, 0, v53
    v_add_f32 v54, 0x41400000, v54
    v_max_f32 v54, 0, v54
    v_add_f32 v55, 0x41400000, v55
    v_max_f32 v55, 0, v55
    v_sub_f32 v160, v160, v52
    v_sub_f32 v161, v161, v52
    v_sub_f32 v162, v162, v52
    v_sub_f32 v163, v163, v52
    v_sub_f32 v164, v164, v53
    v_sub_f32 v165, v165, v53
    v_sub_f32 v166, v166, v53
    v_sub_f32 v167, v167, v53
    v_sub_f32 v168, v168, v54
    v_sub_f32 v169, v169, v54
    v_sub_f32 v170, v170, v54
    v_sub_f32 v171, v171, v54
    v_sub_f32 v172, v172, v55
    v_sub_f32 v173, v173, v55
    v_sub_f32 v174, v174, v55
    v_sub_f32 v175, v175, v55
    v_sub_f32 v176, v176, v52
    v_sub_f32 v177, v177, v52
    v_sub_f32 v178, v178, v52
    v_sub_f32 v179, v179, v52
    v_sub_f32 v180, v180, v53
    v_sub_f32 v181, v181, v53
    v_sub_f32 v182, v182, v53
    v_sub_f32 v183, v183, v53
    v_sub_f32 v184, v184, v54
    v_sub_f32 v185, v185, v54
    v_sub_f32 v186, v186, v54
    v_sub_f32 v187, v187, v54
    v_sub_f32 v188, v188, v55
    v_sub_f32 v189, v189, v55
    v_sub_f32 v190, v190, v55
    v_sub_f32 v191, v191, v55
    v_sub_f32 v128, v128, v52
    v_sub_f32 v16, v16, v52
    v_sub_f32 v129, v129, v52
    v_sub_f32 v17, v17, v52
    v_sub_f32 v130, v130, v52
    v_sub_f32 v18, v18, v52
    v_sub_f32 v131, v131, v52
    v_sub_f32 v19, v19, v52
    v_sub_f32 v132, v132, v53
    v_sub_f32 v20, v20, v53
    v_sub_f32 v133, v133, v53
    v_sub_f32 v21, v21, v53
    v_sub_f32 v134, v134, v53
    v_sub_f32 v22, v22, v53
    v_sub_f32 v135, v135, v53
    v_sub_f32 v23, v23, v53
    v_sub_f32 v136, v136, v54
    v_sub_f32 v24, v24, v54
    v_sub_f32 v137, v137, v54
    v_sub_f32 v25, v25, v54
    v_sub_f32 v138, v138, v54
    v_sub_f32 v26, v26, v54
    v_sub_f32 v139, v139, v54
    v_sub_f32 v27, v27, v54
    v_sub_f32 v140, v140, v55
    v_sub_f32 v28, v28, v55
    v_sub_f32 v141, v141, v55
    v_sub_f32 v29, v29, v55
    v_sub_f32 v142, v142, v55
    v_sub_f32 v30, v30, v55
    v_sub_f32 v143, v143, v55
    v_sub_f32 v31, v31, v55
    v_sub_f32 v144, v144, v52
    v_sub_f32 v32, v32, v52
    v_sub_f32 v145, v145, v52
    v_sub_f32 v33, v33, v52
    v_sub_f32 v146, v146, v52
    v_sub_f32 v34, v34, v52
    v_sub_f32 v147, v147, v52
    v_sub_f32 v35, v35, v52
    v_sub_f32 v148, v148, v53
    v_sub_f32 v36, v36, v53
    v_sub_f32 v149, v149, v53
    v_sub_f32 v37, v37, v53
    v_sub_f32 v150, v150, v53
    v_sub_f32 v38, v38, v53
    v_sub_f32 v151, v151, v53
    v_sub_f32 v39, v39, v53
    v_sub_f32 v152, v152, v54
    v_sub_f32 v40, v40, v54
    v_sub_f32 v153, v153, v54
    v_sub_f32 v41, v41, v54
    v_sub_f32 v154, v154, v54
    v_sub_f32 v42, v42, v54
    v_sub_f32 v155, v155, v54
    v_sub_f32 v43, v43, v54
    v_sub_f32 v156, v156, v55
    v_sub_f32 v44, v44, v55
    v_sub_f32 v157, v157, v55
    v_sub_f32 v45, v45, v55
    v_sub_f32 v158, v158, v55
    v_sub_f32 v46, v46, v55
    v_sub_f32 v159, v159, v55
    v_sub_f32 v47, v47, v55
    v_sub_f32 v8, v8, v52
    v_exp_f32 v52, -v52
    v_sub_f32 v9, v9, v53
    v_exp_f32 v53, -v53
    v_sub_f32 v10, v10, v54
    v_exp_f32 v54, -v54
    v_sub_f32 v11, v11, v55
    v_exp_f32 v55, -v55
    s_nop 0
    v_mul_f32 v12, v12, v52
    v_mul_f32 v48, v48, v53
    v_mul_f32 v248, v248, v54
    v_mul_f32 v252, v252, v55
    v_accvgpr_read_b32 v224, a0
    v_accvgpr_read_b32 v225, a1
    v_accvgpr_read_b32 v226, a2
    v_accvgpr_read_b32 v227, a3
    v_mul_f32 v224, v224, v52
    v_mul_f32 v225, v225, v52
    v_mul_f32 v226, v226, v52
    v_mul_f32 v227, v227, v52
    v_accvgpr_write_b32 a0, v224
    v_accvgpr_write_b32 a1, v225
    v_accvgpr_write_b32 a2, v226
    v_accvgpr_write_b32 a3, v227
    v_accvgpr_read_b32 v224, a4
    v_accvgpr_read_b32 v225, a5
    v_accvgpr_read_b32 v226, a6
    v_accvgpr_read_b32 v227, a7
    v_mul_f32 v224, v224, v53
    v_mul_f32 v225, v225, v53
    v_mul_f32 v226, v226, v53
    v_mul_f32 v227, v227, v53
    v_accvgpr_write_b32 a4, v224
    v_accvgpr_write_b32 a5, v225
    v_accvgpr_write_b32 a6, v226
    v_accvgpr_write_b32 a7, v227
    v_accvgpr_read_b32 v224, a8
    v_accvgpr_read_b32 v225, a9
    v_accvgpr_read_b32 v226, a10
    v_accvgpr_read_b32 v227, a11
    v_mul_f32 v224, v224, v54
    v_mul_f32 v225, v225, v54
    v_mul_f32 v226, v226, v54
    v_mul_f32 v227, v227, v54
    v_accvgpr_write_b32 a8, v224
    v_accvgpr_write_b32 a9, v225
    v_accvgpr_write_b32 a10, v226
    v_accvgpr_write_b32 a11, v227
    v_accvgpr_read_b32 v224, a12
    v_accvgpr_read_b32 v225, a13
    v_accvgpr_read_b32 v226, a14
    v_accvgpr_read_b32 v227, a15
    v_mul_f32 v224, v224, v55
    v_mul_f32 v225, v225, v55
    v_mul_f32 v226, v226, v55
    v_mul_f32 v227, v227, v55
    v_accvgpr_write_b32 a12, v224
    v_accvgpr_write_b32 a13, v225
    v_accvgpr_write_b32 a14, v226
    v_accvgpr_write_b32 a15, v227
    v_accvgpr_read_b32 v224, a16
    v_accvgpr_read_b32 v225, a17
    v_accvgpr_read_b32 v226, a18
    v_accvgpr_read_b32 v227, a19
    v_mul_f32 v224, v224, v52
    v_mul_f32 v225, v225, v52
    v_mul_f32 v226, v226, v52
    v_mul_f32 v227, v227, v52
    v_accvgpr_write_b32 a16, v224
    v_accvgpr_write_b32 a17, v225
    v_accvgpr_write_b32 a18, v226
    v_accvgpr_write_b32 a19, v227
    v_accvgpr_read_b32 v224, a20
    v_accvgpr_read_b32 v225, a21
    v_accvgpr_read_b32 v226, a22
    v_accvgpr_read_b32 v227, a23
    v_mul_f32 v224, v224, v53
    v_mul_f32 v225, v225, v53
    v_mul_f32 v226, v226, v53
    v_mul_f32 v227, v227, v53
    v_accvgpr_write_b32 a20, v224
    v_accvgpr_write_b32 a21, v225
    v_accvgpr_write_b32 a22, v226
    v_accvgpr_write_b32 a23, v227
    v_accvgpr_read_b32 v224, a24
    v_accvgpr_read_b32 v225, a25
    v_accvgpr_read_b32 v226, a26
    v_accvgpr_read_b32 v227, a27
    v_mul_f32 v224, v224, v54
    v_mul_f32 v225, v225, v54
    v_mul_f32 v226, v226, v54
    v_mul_f32 v227, v227, v54
    v_accvgpr_write_b32 a24, v224
    v_accvgpr_write_b32 a25, v225
    v_accvgpr_write_b32 a26, v226
    v_accvgpr_write_b32 a27, v227
    v_accvgpr_read_b32 v224, a28
    v_accvgpr_read_b32 v225, a29
    v_accvgpr_read_b32 v226, a30
    v_accvgpr_read_b32 v227, a31
    v_mul_f32 v224, v224, v55
    v_mul_f32 v225, v225, v55
    v_mul_f32 v226, v226, v55
    v_mul_f32 v227, v227, v55
    v_accvgpr_write_b32 a28, v224
    v_accvgpr_write_b32 a29, v225
    v_accvgpr_write_b32 a30, v226
    v_accvgpr_write_b32 a31, v227
    v_accvgpr_read_b32 v224, a32
    v_accvgpr_read_b32 v225, a33
    v_accvgpr_read_b32 v226, a34
    v_accvgpr_read_b32 v227, a35
    v_mul_f32 v224, v224, v52
    v_mul_f32 v225, v225, v52
    v_mul_f32 v226, v226, v52
    v_mul_f32 v227, v227, v52
    v_accvgpr_write_b32 a32, v224
    v_accvgpr_write_b32 a33, v225
    v_accvgpr_write_b32 a34, v226
    v_accvgpr_write_b32 a35, v227
    v_accvgpr_read_b32 v224, a36
    v_accvgpr_read_b32 v225, a37
    v_accvgpr_read_b32 v226, a38
    v_accvgpr_read_b32 v227, a39
    v_mul_f32 v224, v224, v53
    v_mul_f32 v225, v225, v53
    v_mul_f32 v226, v226, v53
    v_mul_f32 v227, v227, v53
    v_accvgpr_write_b32 a36, v224
    v_accvgpr_write_b32 a37, v225
    v_accvgpr_write_b32 a38, v226
    v_accvgpr_write_b32 a39, v227
    v_accvgpr_read_b32 v224, a40
    v_accvgpr_read_b32 v225, a41
    v_accvgpr_read_b32 v226, a42
    v_accvgpr_read_b32 v227, a43
    v_mul_f32 v224, v224, v54
    v_mul_f32 v225, v225, v54
    v_mul_f32 v226, v226, v54
    v_mul_f32 v227, v227, v54
    v_accvgpr_write_b32 a40, v224
    v_accvgpr_write_b32 a41, v225
    v_accvgpr_write_b32 a42, v226
    v_accvgpr_write_b32 a43, v227
    v_accvgpr_read_b32 v224, a44
    v_accvgpr_read_b32 v225, a45
    v_accvgpr_read_b32 v226, a46
    v_accvgpr_read_b32 v227, a47
    v_mul_f32 v224, v224, v55
    v_mul_f32 v225, v225, v55
    v_mul_f32 v226, v226, v55
    v_mul_f32 v227, v227, v55
    v_accvgpr_write_b32 a44, v224
    v_accvgpr_write_b32 a45, v225
    v_accvgpr_write_b32 a46, v226
    v_accvgpr_write_b32 a47, v227
    v_accvgpr_read_b32 v224, a48
    v_accvgpr_read_b32 v225, a49
    v_accvgpr_read_b32 v226, a50
    v_accvgpr_read_b32 v227, a51
    v_mul_f32 v224, v224, v52
    v_mul_f32 v225, v225, v52
    v_mul_f32 v226, v226, v52
    v_mul_f32 v227, v227, v52
    v_accvgpr_write_b32 a48, v224
    v_accvgpr_write_b32 a49, v225
    v_accvgpr_write_b32 a50, v226
    v_accvgpr_write_b32 a51, v227
    v_accvgpr_read_b32 v224, a52
    v_accvgpr_read_b32 v225, a53
    v_accvgpr_read_b32 v226, a54
    v_accvgpr_read_b32 v227, a55
    v_mul_f32 v224, v224, v53
    v_mul_f32 v225, v225, v53
    v_mul_f32 v226, v226, v53
    v_mul_f32 v227, v227, v53
    v_accvgpr_write_b32 a52, v224
    v_accvgpr_write_b32 a53, v225
    v_accvgpr_write_b32 a54, v226
    v_accvgpr_write_b32 a55, v227
    v_accvgpr_read_b32 v224, a56
    v_accvgpr_read_b32 v225, a57
    v_accvgpr_read_b32 v226, a58
    v_accvgpr_read_b32 v227, a59
    v_mul_f32 v224, v224, v54
    v_mul_f32 v225, v225, v54
    v_mul_f32 v226, v226, v54
    v_mul_f32 v227, v227, v54
    v_accvgpr_write_b32 a56, v224
    v_accvgpr_write_b32 a57, v225
    v_accvgpr_write_b32 a58, v226
    v_accvgpr_write_b32 a59, v227
    v_accvgpr_read_b32 v224, a60
    v_accvgpr_read_b32 v225, a61
    v_accvgpr_read_b32 v226, a62
    v_accvgpr_read_b32 v227, a63
    v_mul_f32 v224, v224, v55
    v_mul_f32 v225, v225, v55
    v_mul_f32 v226, v226, v55
    v_mul_f32 v227, v227, v55
    v_accvgpr_write_b32 a60, v224
    v_accvgpr_write_b32 a61, v225
    v_accvgpr_write_b32 a62, v226
    v_accvgpr_write_b32 a63, v227
    v_accvgpr_read_b32 v224, a64
    v_accvgpr_read_b32 v225, a65
    v_accvgpr_read_b32 v226, a66
    v_accvgpr_read_b32 v227, a67
    v_mul_f32 v224, v224, v52
    v_mul_f32 v225, v225, v52
    v_mul_f32 v226, v226, v52
    v_mul_f32 v227, v227, v52
    v_accvgpr_write_b32 a64, v224
    v_accvgpr_write_b32 a65, v225
    v_accvgpr_write_b32 a66, v226
    v_accvgpr_write_b32 a67, v227
    v_accvgpr_read_b32 v224, a68
    v_accvgpr_read_b32 v225, a69
    v_accvgpr_read_b32 v226, a70
    v_accvgpr_read_b32 v227, a71
    v_mul_f32 v224, v224, v53
    v_mul_f32 v225, v225, v53
    v_mul_f32 v226, v226, v53
    v_mul_f32 v227, v227, v53
    v_accvgpr_write_b32 a68, v224
    v_accvgpr_write_b32 a69, v225
    v_accvgpr_write_b32 a70, v226
    v_accvgpr_write_b32 a71, v227
    v_accvgpr_read_b32 v224, a72
    v_accvgpr_read_b32 v225, a73
    v_accvgpr_read_b32 v226, a74
    v_accvgpr_read_b32 v227, a75
    v_mul_f32 v224, v224, v54
    v_mul_f32 v225, v225, v54
    v_mul_f32 v226, v226, v54
    v_mul_f32 v227, v227, v54
    v_accvgpr_write_b32 a72, v224
    v_accvgpr_write_b32 a73, v225
    v_accvgpr_write_b32 a74, v226
    v_accvgpr_write_b32 a75, v227
    v_accvgpr_read_b32 v224, a76
    v_accvgpr_read_b32 v225, a77
    v_accvgpr_read_b32 v226, a78
    v_accvgpr_read_b32 v227, a79
    v_mul_f32 v224, v224, v55
    v_mul_f32 v225, v225, v55
    v_mul_f32 v226, v226, v55
    v_mul_f32 v227, v227, v55
    v_accvgpr_write_b32 a76, v224
    v_accvgpr_write_b32 a77, v225
    v_accvgpr_write_b32 a78, v226
    v_accvgpr_write_b32 a79, v227
    v_accvgpr_read_b32 v224, a80
    v_accvgpr_read_b32 v225, a81
    v_accvgpr_read_b32 v226, a82
    v_accvgpr_read_b32 v227, a83
    v_mul_f32 v224, v224, v52
    v_mul_f32 v225, v225, v52
    v_mul_f32 v226, v226, v52
    v_mul_f32 v227, v227, v52
    v_accvgpr_write_b32 a80, v224
    v_accvgpr_write_b32 a81, v225
    v_accvgpr_write_b32 a82, v226
    v_accvgpr_write_b32 a83, v227
    v_accvgpr_read_b32 v224, a84
    v_accvgpr_read_b32 v225, a85
    v_accvgpr_read_b32 v226, a86
    v_accvgpr_read_b32 v227, a87
    v_mul_f32 v224, v224, v53
    v_mul_f32 v225, v225, v53
    v_mul_f32 v226, v226, v53
    v_mul_f32 v227, v227, v53
    v_accvgpr_write_b32 a84, v224
    v_accvgpr_write_b32 a85, v225
    v_accvgpr_write_b32 a86, v226
    v_accvgpr_write_b32 a87, v227
    v_accvgpr_read_b32 v224, a88
    v_accvgpr_read_b32 v225, a89
    v_accvgpr_read_b32 v226, a90
    v_accvgpr_read_b32 v227, a91
    v_mul_f32 v224, v224, v54
    v_mul_f32 v225, v225, v54
    v_mul_f32 v226, v226, v54
    v_mul_f32 v227, v227, v54
    v_accvgpr_write_b32 a88, v224
    v_accvgpr_write_b32 a89, v225
    v_accvgpr_write_b32 a90, v226
    v_accvgpr_write_b32 a91, v227
    v_accvgpr_read_b32 v224, a92
    v_accvgpr_read_b32 v225, a93
    v_accvgpr_read_b32 v226, a94
    v_accvgpr_read_b32 v227, a95
    v_mul_f32 v224, v224, v55
    v_mul_f32 v225, v225, v55
    v_mul_f32 v226, v226, v55
    v_mul_f32 v227, v227, v55
    v_accvgpr_write_b32 a92, v224
    v_accvgpr_write_b32 a93, v225
    v_accvgpr_write_b32 a94, v226
    v_accvgpr_write_b32 a95, v227
    v_accvgpr_read_b32 v224, a96
    v_accvgpr_read_b32 v225, a97
    v_accvgpr_read_b32 v226, a98
    v_accvgpr_read_b32 v227, a99
    v_mul_f32 v224, v224, v52
    v_mul_f32 v225, v225, v52
    v_mul_f32 v226, v226, v52
    v_mul_f32 v227, v227, v52
    v_accvgpr_write_b32 a96, v224
    v_accvgpr_write_b32 a97, v225
    v_accvgpr_write_b32 a98, v226
    v_accvgpr_write_b32 a99, v227
    v_accvgpr_read_b32 v224, a100
    v_accvgpr_read_b32 v225, a101
    v_accvgpr_read_b32 v226, a102
    v_accvgpr_read_b32 v227, a103
    v_mul_f32 v224, v224, v53
    v_mul_f32 v225, v225, v53
    v_mul_f32 v226, v226, v53
    v_mul_f32 v227, v227, v53
    v_accvgpr_write_b32 a100, v224
    v_accvgpr_write_b32 a101, v225
    v_accvgpr_write_b32 a102, v226
    v_accvgpr_write_b32 a103, v227
    v_accvgpr_read_b32 v224, a104
    v_accvgpr_read_b32 v225, a105
    v_accvgpr_read_b32 v226, a106
    v_accvgpr_read_b32 v227, a107
    v_mul_f32 v224, v224, v54
    v_mul_f32 v225, v225, v54
    v_mul_f32 v226, v226, v54
    v_mul_f32 v227, v227, v54
    v_accvgpr_write_b32 a104, v224
    v_accvgpr_write_b32 a105, v225
    v_accvgpr_write_b32 a106, v226
    v_accvgpr_write_b32 a107, v227
    v_accvgpr_read_b32 v224, a108
    v_accvgpr_read_b32 v225, a109
    v_accvgpr_read_b32 v226, a110
    v_accvgpr_read_b32 v227, a111
    v_mul_f32 v224, v224, v55
    v_mul_f32 v225, v225, v55
    v_mul_f32 v226, v226, v55
    v_mul_f32 v227, v227, v55
    v_accvgpr_write_b32 a108, v224
    v_accvgpr_write_b32 a109, v225
    v_accvgpr_write_b32 a110, v226
    v_accvgpr_write_b32 a111, v227
    v_accvgpr_read_b32 v224, a112
    v_accvgpr_read_b32 v225, a113
    v_accvgpr_read_b32 v226, a114
    v_accvgpr_read_b32 v227, a115
    v_mul_f32 v224, v224, v52
    v_mul_f32 v225, v225, v52
    v_mul_f32 v226, v226, v52
    v_mul_f32 v227, v227, v52
    v_accvgpr_write_b32 a112, v224
    v_accvgpr_write_b32 a113, v225
    v_accvgpr_write_b32 a114, v226
    v_accvgpr_write_b32 a115, v227
    v_accvgpr_read_b32 v224, a116
    v_accvgpr_read_b32 v225, a117
    v_accvgpr_read_b32 v226, a118
    v_accvgpr_read_b32 v227, a119
    v_mul_f32 v224, v224, v53
    v_mul_f32 v225, v225, v53
    v_mul_f32 v226, v226, v53
    v_mul_f32 v227, v227, v53
    v_accvgpr_write_b32 a116, v224
    v_accvgpr_write_b32 a117, v225
    v_accvgpr_write_b32 a118, v226
    v_accvgpr_write_b32 a119, v227
    v_accvgpr_read_b32 v224, a120
    v_accvgpr_read_b32 v225, a121
    v_accvgpr_read_b32 v226, a122
    v_accvgpr_read_b32 v227, a123
    v_mul_f32 v224, v224, v54
    v_mul_f32 v225, v225, v54
    v_mul_f32 v226, v226, v54
    v_mul_f32 v227, v227, v54
    v_accvgpr_write_b32 a120, v224
    v_accvgpr_write_b32 a121, v225
    v_accvgpr_write_b32 a122, v226
    v_accvgpr_write_b32 a123, v227
    v_accvgpr_read_b32 v224, a124
    v_accvgpr_read_b32 v225, a125
    v_accvgpr_read_b32 v226, a126
    v_accvgpr_read_b32 v227, a127
    v_mul_f32 v224, v224, v55
    v_mul_f32 v225, v225, v55
    v_mul_f32 v226, v226, v55
    v_mul_f32 v227, v227, v55
    v_accvgpr_write_b32 a124, v224
    v_accvgpr_write_b32 a125, v225
    v_accvgpr_write_b32 a126, v226
    v_accvgpr_write_b32 a127, v227
    v_exp_f32 v232, v160
    v_exp_f32 v233, v161
    v_exp_f32 v234, v162
    v_exp_f32 v235, v163
    s_nop 0
    v_cvt_pk_bf16_f32 v208, v232, v233
    v_cvt_pk_bf16_f32 v209, v234, v235
    v_exp_f32 v232, v176
    v_exp_f32 v233, v177
    v_exp_f32 v234, v178
    v_exp_f32 v235, v179
    s_nop 0
    v_cvt_pk_bf16_f32 v210, v232, v233
    v_cvt_pk_bf16_f32 v211, v234, v235
    v_exp_f32 v232, v164
    v_exp_f32 v233, v165
    v_exp_f32 v234, v166
    v_exp_f32 v235, v167
    s_nop 0
    v_cvt_pk_bf16_f32 v212, v232, v233
    v_cvt_pk_bf16_f32 v213, v234, v235
    v_exp_f32 v232, v180
    v_exp_f32 v233, v181
    v_exp_f32 v234, v182
    v_exp_f32 v235, v183
    s_nop 0
    v_cvt_pk_bf16_f32 v214, v232, v233
    v_cvt_pk_bf16_f32 v215, v234, v235
    v_exp_f32 v232, v168
    v_exp_f32 v233, v169
    v_exp_f32 v234, v170
    v_exp_f32 v235, v171
    s_nop 0
    v_cvt_pk_bf16_f32 v216, v232, v233
    v_cvt_pk_bf16_f32 v217, v234, v235
    v_exp_f32 v232, v184
    v_exp_f32 v233, v185
    v_exp_f32 v234, v186
    v_exp_f32 v235, v187
    s_nop 0
    v_cvt_pk_bf16_f32 v218, v232, v233
    v_cvt_pk_bf16_f32 v219, v234, v235
    v_exp_f32 v232, v172
    v_exp_f32 v233, v173
    v_exp_f32 v234, v174
    v_exp_f32 v235, v175
    s_nop 0
    v_cvt_pk_bf16_f32 v220, v232, v233
    v_cvt_pk_bf16_f32 v221, v234, v235
    v_exp_f32 v232, v188
    v_exp_f32 v233, v189
    v_exp_f32 v234, v190
    v_exp_f32 v235, v191
    s_nop 0
    v_cvt_pk_bf16_f32 v222, v232, v233
    v_cvt_pk_bf16_f32 v223, v234, v235
    s_nop 3
    s_setpc_b64 s[40:41]
k2_rare_164:
    s_nop 7
    v_max_f32 v53, v132, v133
    v_max3_f32 v53, v53, v134, v135
    v_max3_f32 v53, v53, v148, v149
    v_max3_f32 v53, v53, v150, v151
    v_max_f32 v54, v136, v137
    v_max3_f32 v54, v54, v138, v139
    v_max3_f32 v54, v54, v152, v153
    v_max3_f32 v54, v54, v154, v155
    v_max_f32 v55, v140, v141
    v_max3_f32 v55, v55, v142, v143
    v_max3_f32 v55, v55, v156, v157
    v_max3_f32 v55, v55, v158, v159
    v_mov_b32 v225, v53
    v_mov_b32 v226, v54
    v_mov_b32 v227, v55
    s_nop 1
    v_permlane16_swap_b32 v53, v225
    v_permlane16_swap_b32 v54, v226
    v_permlane16_swap_b32 v55, v227
    s_nop 1
    v_max_f32 v53, v53, v225
    v_max_f32 v54, v54, v226
    v_max_f32 v55, v55, v227
    v_mov_b32 v225, v53
    v_mov_b32 v226, v54
    v_mov_b32 v227, v55
    s_nop 1
    v_permlane32_swap_b32 v53, v225
    v_permlane32_swap_b32 v54, v226
    v_permlane32_swap_b32 v55, v227
    s_nop 1
    v_max_f32 v53, v53, v225
    v_max_f32 v54, v54, v226
    v_max_f32 v55, v55, v227
    v_add_f32 v53, 0x41400000, v53
    v_max_f32 v53, 0, v53
    v_add_f32 v54, 0x41400000, v54
    v_max_f32 v54, 0, v54
    v_add_f32 v55, 0x41400000, v55
    v_max_f32 v55, 0, v55
    v_sub_f32 v132, v132, v53
    v_sub_f32 v133, v133, v53
    v_sub_f32 v134, v134, v53
    v_sub_f32 v135, v135, v53
    v_sub_f32 v136, v136, v54
    v_sub_f32 v137, v137, v54
    v_sub_f32 v138, v138, v54
    v_sub_f32 v139, v139, v54
    v_sub_f32 v140, v140, v55
    v_sub_f32 v141, v141, v55
    v_sub_f32 v142, v142, v55
    v_sub_f32 v143, v143, v55
    v_sub_f32 v148, v148, v53
    v_sub_f32 v149, v149, v53
    v_sub_f32 v150, v150, v53
    v_sub_f32 v151, v151, v53
    v_sub_f32 v152, v152, v54
    v_sub_f32 v153, v153, v54
    v_sub_f32 v154, v154, v54
    v_sub_f32 v155, v155, v54
    v_sub_f32 v156, v156, v55
    v_sub_f32 v157, v157, v55
    v_sub_f32 v158, v158, v55
    v_sub_f32 v159, v159, v55
    v_sub_f32 v164, v164, v53
    v_sub_f32 v20, v20, v53
    v_sub_f32 v165, v165, v53
    v_sub_f32 v21, v21, v53
    v_sub_f32 v166, v166, v53
    v_sub_f32 v22, v22, v53
    v_sub_f32 v167, v167, v53
    v_sub_f32 v23, v23, v53
    v_sub_f32 v168, v168, v54
    v_sub_f32 v24, v24, v54
    v_sub_f32 v169, v169, v54
    v_sub_f32 v25, v25, v54
    v_sub_f32 v170, v170, v54
    v_sub_f32 v26, v26, v54
    v_sub_f32 v171, v171, v54
    v_sub_f32 v27, v27, v54
    v_sub_f32 v172, v172, v55
    v_sub_f32 v28, v28, v55
    v_sub_f32 v173, v173, v55
    v_sub_f32 v29, v29, v55
    v_sub_f32 v174, v174, v55
    v_sub_f32 v30, v30, v55
    v_sub_f32 v175, v175, v55
    v_sub_f32 v31, v31, v55
    v_sub_f32 v180, v180, v53
    v_sub_f32 v36, v36, v53
    v_sub_f32 v181, v181, v53
    v_sub_f32 v37, v37, v53
    v_sub_f32 v182, v182, v53
    v_sub_f32 v38, v38, v53
    v_sub_f32 v183, v183, v53
    v_sub_f32 v39, v39, v53
    v_sub_f32 v184, v184, v54
    v_sub_f32 v40, v40, v54
    v_sub_f32 v185, v185, v54
    v_sub_f32 v41, v41, v54
    v_sub_f32 v186, v186, v54
    v_sub_f32 v42, v42, v54
    v_sub_f32 v187, v187, v54
    v_sub_f32 v43, v43, v54
    v_sub_f32 v188, v188, v55
    v_sub_f32 v44, v44, v55
    v_sub_f32 v189, v189, v55
    v_sub_f32 v45, v45, v55
    v_sub_f32 v190, v190, v55
    v_sub_f32 v46, v46, v55
    v_sub_f32 v191, v191, v55
    v_sub_f32 v47, v47, v55
    v_sub_f32 v9, v9, v53
    v_exp_f32 v53, -v53
    v_sub_f32 v10, v10, v54
    v_exp_f32 v54, -v54
    v_sub_f32 v11, v11, v55
    v_exp_f32 v55, -v55
    s_nop 0
    v_mul_f32 v48, v48, v53
    v_mul_f32 v248, v248, v54
    v_mul_f32 v252, v252, v55
    v_accvgpr_read_b32 v224, a4
    v_accvgpr_read_b32 v225, a5
    v_accvgpr_read_b32 v226, a6
    v_accvgpr_read_b32 v227, a7
    v_mul_f32 v224, v224, v53
    v_mul_f32 v225, v225, v53
    v_mul_f32 v226, v226, v53
    v_mul_f32 v227, v227, v53
    v_accvgpr_write_b32 a4, v224
    v_accvgpr_write_b32 a5, v225
    v_accvgpr_write_b32 a6, v226
    v_accvgpr_write_b32 a7, v227
    v_accvgpr_read_b32 v224, a8
    v_accvgpr_read_b32 v225, a9
    v_accvgpr_read_b32 v226, a10
    v_accvgpr_read_b32 v227, a11
    v_mul_f32 v224, v224, v54
    v_mul_f32 v225, v225, v54
    v_mul_f32 v226, v226, v54
    v_mul_f32 v227, v227, v54
    v_accvgpr_write_b32 a8, v224
    v_accvgpr_write_b32 a9, v225
    v_accvgpr_write_b32 a10, v226
    v_accvgpr_write_b32 a11, v227
    v_accvgpr_read_b32 v224, a12
    v_accvgpr_read_b32 v225, a13
    v_accvgpr_read_b32 v226, a14
    v_accvgpr_read_b32 v227, a15
    v_mul_f32 v224, v224, v55
    v_mul_f32 v225, v225, v55
    v_mul_f32 v226, v226, v55
    v_mul_f32 v227, v227, v55
    v_accvgpr_write_b32 a12, v224
    v_accvgpr_write_b32 a13, v225
    v_accvgpr_write_b32 a14, v226
    v_accvgpr_write_b32 a15, v227
    v_accvgpr_read_b32 v224, a20
    v_accvgpr_read_b32 v225, a21
    v_accvgpr_read_b32 v226, a22
    v_accvgpr_read_b32 v227, a23
    v_mul_f32 v224, v224, v53
    v_mul_f32 v225, v225, v53
    v_mul_f32 v226, v226, v53
    v_mul_f32 v227, v227, v53
    v_accvgpr_write_b32 a20, v224
    v_accvgpr_write_b32 a21, v225
    v_accvgpr_write_b32 a22, v226
    v_accvgpr_write_b32 a23, v227
    v_accvgpr_read_b32 v224, a24
    v_accvgpr_read_b32 v225, a25
    v_accvgpr_read_b32 v226, a26
    v_accvgpr_read_b32 v227, a27
    v_mul_f32 v224, v224, v54
    v_mul_f32 v225, v225, v54
    v_mul_f32 v226, v226, v54
    v_mul_f32 v227, v227, v54
    v_accvgpr_write_b32 a24, v224
    v_accvgpr_write_b32 a25, v225
    v_accvgpr_write_b32 a26, v226
    v_accvgpr_write_b32 a27, v227
    v_accvgpr_read_b32 v224, a28
    v_accvgpr_read_b32 v225, a29
    v_accvgpr_read_b32 v226, a30
    v_accvgpr_read_b32 v227, a31
    v_mul_f32 v224, v224, v55
    v_mul_f32 v225, v225, v55
    v_mul_f32 v226, v226, v55
    v_mul_f32 v227, v227, v55
    v_accvgpr_write_b32 a28, v224
    v_accvgpr_write_b32 a29, v225
    v_accvgpr_write_b32 a30, v226
    v_accvgpr_write_b32 a31, v227
    v_accvgpr_read_b32 v224, a36
    v_accvgpr_read_b32 v225, a37
    v_accvgpr_read_b32 v226, a38
    v_accvgpr_read_b32 v227, a39
    v_mul_f32 v224, v224, v53
    v_mul_f32 v225, v225, v53
    v_mul_f32 v226, v226, v53
    v_mul_f32 v227, v227, v53
    v_accvgpr_write_b32 a36, v224
    v_accvgpr_write_b32 a37, v225
    v_accvgpr_write_b32 a38, v226
    v_accvgpr_write_b32 a39, v227
    v_accvgpr_read_b32 v224, a40
    v_accvgpr_read_b32 v225, a41
    v_accvgpr_read_b32 v226, a42
    v_accvgpr_read_b32 v227, a43
    v_mul_f32 v224, v224, v54
    v_mul_f32 v225, v225, v54
    v_mul_f32 v226, v226, v54
    v_mul_f32 v227, v227, v54
    v_accvgpr_write_b32 a40, v224
    v_accvgpr_write_b32 a41, v225
    v_accvgpr_write_b32 a42, v226
    v_accvgpr_write_b32 a43, v227
    v_accvgpr_read_b32 v224, a44
    v_accvgpr_read_b32 v225, a45
    v_accvgpr_read_b32 v226, a46
    v_accvgpr_read_b32 v227, a47
    v_mul_f32 v224, v224, v55
    v_mul_f32 v225, v225, v55
    v_mul_f32 v226, v226, v55
    v_mul_f32 v227, v227, v55
    v_accvgpr_write_b32 a44, v224
    v_accvgpr_write_b32 a45, v225
    v_accvgpr_write_b32 a46, v226
    v_accvgpr_write_b32 a47, v227
    v_accvgpr_read_b32 v224, a52
    v_accvgpr_read_b32 v225, a53
    v_accvgpr_read_b32 v226, a54
    v_accvgpr_read_b32 v227, a55
    v_mul_f32 v224, v224, v53
    v_mul_f32 v225, v225, v53
    v_mul_f32 v226, v226, v53
    v_mul_f32 v227, v227, v53
    v_accvgpr_write_b32 a52, v224
    v_accvgpr_write_b32 a53, v225
    v_accvgpr_write_b32 a54, v226
    v_accvgpr_write_b32 a55, v227
    v_accvgpr_read_b32 v224, a56
    v_accvgpr_read_b32 v225, a57
    v_accvgpr_read_b32 v226, a58
    v_accvgpr_read_b32 v227, a59
    v_mul_f32 v224, v224, v54
    v_mul_f32 v225, v225, v54
    v_mul_f32 v226, v226, v54
    v_mul_f32 v227, v227, v54
    v_accvgpr_write_b32 a56, v224
    v_accvgpr_write_b32 a57, v225
    v_accvgpr_write_b32 a58, v226
    v_accvgpr_write_b32 a59, v227
    v_accvgpr_read_b32 v224, a60
    v_accvgpr_read_b32 v225, a61
    v_accvgpr_read_b32 v226, a62
    v_accvgpr_read_b32 v227, a63
    v_mul_f32 v224, v224, v55
    v_mul_f32 v225, v225, v55
    v_mul_f32 v226, v226, v55
    v_mul_f32 v227, v227, v55
    v_accvgpr_write_b32 a60, v224
    v_accvgpr_write_b32 a61, v225
    v_accvgpr_write_b32 a62, v226
    v_accvgpr_write_b32 a63, v227
    v_accvgpr_read_b32 v224, a68
    v_accvgpr_read_b32 v225, a69
    v_accvgpr_read_b32 v226, a70
    v_accvgpr_read_b32 v227, a71
    v_mul_f32 v224, v224, v53
    v_mul_f32 v225, v225, v53
    v_mul_f32 v226, v226, v53
    v_mul_f32 v227, v227, v53
    v_accvgpr_write_b32 a68, v224
    v_accvgpr_write_b32 a69, v225
    v_accvgpr_write_b32 a70, v226
    v_accvgpr_write_b32 a71, v227
    v_accvgpr_read_b32 v224, a72
    v_accvgpr_read_b32 v225, a73
    v_accvgpr_read_b32 v226, a74
    v_accvgpr_read_b32 v227, a75
    v_mul_f32 v224, v224, v54
    v_mul_f32 v225, v225, v54
    v_mul_f32 v226, v226, v54
    v_mul_f32 v227, v227, v54
    v_accvgpr_write_b32 a72, v224
    v_accvgpr_write_b32 a73, v225
    v_accvgpr_write_b32 a74, v226
    v_accvgpr_write_b32 a75, v227
    v_accvgpr_read_b32 v224, a76
    v_accvgpr_read_b32 v225, a77
    v_accvgpr_read_b32 v226, a78
    v_accvgpr_read_b32 v227, a79
    v_mul_f32 v224, v224, v55
    v_mul_f32 v225, v225, v55
    v_mul_f32 v226, v226, v55
    v_mul_f32 v227, v227, v55
    v_accvgpr_write_b32 a76, v224
    v_accvgpr_write_b32 a77, v225
    v_accvgpr_write_b32 a78, v226
    v_accvgpr_write_b32 a79, v227
    v_accvgpr_read_b32 v224, a84
    v_accvgpr_read_b32 v225, a85
    v_accvgpr_read_b32 v226, a86
    v_accvgpr_read_b32 v227, a87
    v_mul_f32 v224, v224, v53
    v_mul_f32 v225, v225, v53
    v_mul_f32 v226, v226, v53
    v_mul_f32 v227, v227, v53
    v_accvgpr_write_b32 a84, v224
    v_accvgpr_write_b32 a85, v225
    v_accvgpr_write_b32 a86, v226
    v_accvgpr_write_b32 a87, v227
    v_accvgpr_read_b32 v224, a88
    v_accvgpr_read_b32 v225, a89
    v_accvgpr_read_b32 v226, a90
    v_accvgpr_read_b32 v227, a91
    v_mul_f32 v224, v224, v54
    v_mul_f32 v225, v225, v54
    v_mul_f32 v226, v226, v54
    v_mul_f32 v227, v227, v54
    v_accvgpr_write_b32 a88, v224
    v_accvgpr_write_b32 a89, v225
    v_accvgpr_write_b32 a90, v226
    v_accvgpr_write_b32 a91, v227
    v_accvgpr_read_b32 v224, a92
    v_accvgpr_read_b32 v225, a93
    v_accvgpr_read_b32 v226, a94
    v_accvgpr_read_b32 v227, a95
    v_mul_f32 v224, v224, v55
    v_mul_f32 v225, v225, v55
    v_mul_f32 v226, v226, v55
    v_mul_f32 v227, v227, v55
    v_accvgpr_write_b32 a92, v224
    v_accvgpr_write_b32 a93, v225
    v_accvgpr_write_b32 a94, v226
    v_accvgpr_write_b32 a95, v227
    v_accvgpr_read_b32 v224, a100
    v_accvgpr_read_b32 v225, a101
    v_accvgpr_read_b32 v226, a102
    v_accvgpr_read_b32 v227, a103
    v_mul_f32 v224, v224, v53
    v_mul_f32 v225, v225, v53
    v_mul_f32 v226, v226, v53
    v_mul_f32 v227, v227, v53
    v_accvgpr_write_b32 a100, v224
    v_accvgpr_write_b32 a101, v225
    v_accvgpr_write_b32 a102, v226
    v_accvgpr_write_b32 a103, v227
    v_accvgpr_read_b32 v224, a104
    v_accvgpr_read_b32 v225, a105
    v_accvgpr_read_b32 v226, a106
    v_accvgpr_read_b32 v227, a107
    v_mul_f32 v224, v224, v54
    v_mul_f32 v225, v225, v54
    v_mul_f32 v226, v226, v54
    v_mul_f32 v227, v227, v54
    v_accvgpr_write_b32 a104, v224
    v_accvgpr_write_b32 a105, v225
    v_accvgpr_write_b32 a106, v226
    v_accvgpr_write_b32 a107, v227
    v_accvgpr_read_b32 v224, a108
    v_accvgpr_read_b32 v225, a109
    v_accvgpr_read_b32 v226, a110
    v_accvgpr_read_b32 v227, a111
    v_mul_f32 v224, v224, v55
    v_mul_f32 v225, v225, v55
    v_mul_f32 v226, v226, v55
    v_mul_f32 v227, v227, v55
    v_accvgpr_write_b32 a108, v224
    v_accvgpr_write_b32 a109, v225
    v_accvgpr_write_b32 a110, v226
    v_accvgpr_write_b32 a111, v227
    v_accvgpr_read_b32 v224, a116
    v_accvgpr_read_b32 v225, a117
    v_accvgpr_read_b32 v226, a118
    v_accvgpr_read_b32 v227, a119
    v_mul_f32 v224, v224, v53
    v_mul_f32 v225, v225, v53
    v_mul_f32 v226, v226, v53
    v_mul_f32 v227, v227, v53
    v_accvgpr_write_b32 a116, v224
    v_accvgpr_write_b32 a117, v225
    v_accvgpr_write_b32 a118, v226
    v_accvgpr_write_b32 a119, v227
    v_accvgpr_read_b32 v224, a120
    v_accvgpr_read_b32 v225, a121
    v_accvgpr_read_b32 v226, a122
    v_accvgpr_read_b32 v227, a123
    v_mul_f32 v224, v224, v54
    v_mul_f32 v225, v225, v54
    v_mul_f32 v226, v226, v54
    v_mul_f32 v227, v227, v54
    v_accvgpr_write_b32 a120, v224
    v_accvgpr_write_b32 a121, v225
    v_accvgpr_write_b32 a122, v226
    v_accvgpr_write_b32 a123, v227
    v_accvgpr_read_b32 v224, a124
    v_accvgpr_read_b32 v225, a125
    v_accvgpr_read_b32 v226, a126
    v_accvgpr_read_b32 v227, a127
    v_mul_f32 v224, v224, v55
    v_mul_f32 v225, v225, v55
    v_mul_f32 v226, v226, v55
    v_mul_f32 v227, v227, v55
    v_accvgpr_write_b32 a124, v224
    v_accvgpr_write_b32 a125, v225
    v_accvgpr_write_b32 a126, v226
    v_accvgpr_write_b32 a127, v227
    v_exp_f32 v232, v132
    v_exp_f32 v233, v133
    v_exp_f32 v234, v134
    v_exp_f32 v235, v135
    s_nop 0
    v_cvt_pk_bf16_f32 v196, v232, v233
    v_cvt_pk_bf16_f32 v197, v234, v235
    v_exp_f32 v232, v148
    v_exp_f32 v233, v149
    v_exp_f32 v234, v150
    v_exp_f32 v235, v151
    s_nop 0
    v_cvt_pk_bf16_f32 v198, v232, v233
    v_cvt_pk_bf16_f32 v199, v234, v235
    v_exp_f32 v232, v136
    v_exp_f32 v233, v137
    v_exp_f32 v234, v138
    v_exp_f32 v235, v139
    s_nop 0
    v_cvt_pk_bf16_f32 v200, v232, v233
    v_cvt_pk_bf16_f32 v201, v234, v235
    v_exp_f32 v232, v152
    v_exp_f32 v233, v153
    v_exp_f32 v234, v154
    v_exp_f32 v235, v155
    s_nop 0
    v_cvt_pk_bf16_f32 v202, v232, v233
    v_cvt_pk_bf16_f32 v203, v234, v235
    v_exp_f32 v232, v140
    v_exp_f32 v233, v141
    v_exp_f32 v234, v142
    v_exp_f32 v235, v143
    s_nop 0
    v_cvt_pk_bf16_f32 v204, v232, v233
    v_cvt_pk_bf16_f32 v205, v234, v235
    v_exp_f32 v232, v156
    v_exp_f32 v233, v157
    v_exp_f32 v234, v158
    v_exp_f32 v235, v159
    s_nop 0
    v_cvt_pk_bf16_f32 v206, v232, v233
    v_cvt_pk_bf16_f32 v207, v234, v235
    s_nop 3
    s_setpc_b64 s[40:41]
k2_rare_165:
    s_nop 7
    v_max_f32 v53, v164, v165
    v_max3_f32 v53, v53, v166, v167
    v_max3_f32 v53, v53, v180, v181
    v_max3_f32 v53, v53, v182, v183
    v_max_f32 v54, v168, v169
    v_max3_f32 v54, v54, v170, v171
    v_max3_f32 v54, v54, v184, v185
    v_max3_f32 v54, v54, v186, v187
    v_max_f32 v55, v172, v173
    v_max3_f32 v55, v55, v174, v175
    v_max3_f32 v55, v55, v188, v189
    v_max3_f32 v55, v55, v190, v191
    v_mov_b32 v225, v53
    v_mov_b32 v226, v54
    v_mov_b32 v227, v55
    s_nop 1
    v_permlane16_swap_b32 v53, v225
    v_permlane16_swap_b32 v54, v226
    v_permlane16_swap_b32 v55, v227
    s_nop 1
    v_max_f32 v53, v53, v225
    v_max_f32 v54, v54, v226
    v_max_f32 v55, v55, v227
    v_mov_b32 v225, v53
    v_mov_b32 v226, v54
    v_mov_b32 v227, v55
    s_nop 1
    v_permlane32_swap_b32 v53, v225
    v_permlane32_swap_b32 v54, v226
    v_permlane32_swap_b32 v55, v227
    s_nop 1
    v_max_f32 v53, v53, v225
    v_max_f32 v54, v54, v226
    v_max_f32 v55, v55, v227
    v_add_f32 v53, 0x41400000, v53
    v_max_f32 v53, 0, v53
    v_add_f32 v54, 0x41400000, v54
    v_max_f32 v54, 0, v54
    v_add_f32 v55, 0x41400000, v55
    v_max_f32 v55, 0, v55
    v_sub_f32 v164, v164, v53
    v_sub_f32 v165, v165, v53
    v_sub_f32 v166, v166, v53
    v_sub_f32 v167, v167, v53
    v_sub_f32 v168, v168, v54
    v_sub_f32 v169, v169, v54
    v_sub_f32 v170, v170, v54
    v_sub_f32 v171, v171, v54
    v_sub_f32 v172, v172, v55
    v_sub_f32 v173, v173, v55
    v_sub_f32 v174, v174, v55
    v_sub_f32 v175, v175, v55
    v_sub_f32 v180, v180, v53
    v_sub_f32 v181, v181, v53
    v_sub_f32 v182, v182, v53
    v_sub_f32 v183, v183, v53
    v_sub_f32 v184, v184, v54
    v_sub_f32 v185, v185, v54
    v_sub_f32 v186, v186, v54
    v_sub_f32 v187, v187, v54
    v_sub_f32 v188, v188, v55
    v_sub_f32 v189, v189, v55
    v_sub_f32 v190, v190, v55
    v_sub_f32 v191, v191, v55
    v_sub_f32 v128, v128, v54
    v_sub_f32 v16, v16, v54
    v_sub_f32 v129, v129, v54
    v_sub_f32 v17, v17, v54
    v_sub_f32 v130, v130, v54
    v_sub_f32 v18, v18, v54
    v_sub_f32 v131, v131, v54
    v_sub_f32 v19, v19, v54
    v_sub_f32 v132, v132, v55
    v_sub_f32 v20, v20, v55
    v_sub_f32 v133, v133, v55
    v_sub_f32 v21, v21, v55
    v_sub_f32 v134, v134, v55
    v_sub_f32 v22, v22, v55
    v_sub_f32 v135, v135, v55
    v_sub_f32 v23, v23, v55
    v_sub_f32 v136, v136, v54
    v_sub_f32 v24, v24, v54
    v_sub_f32 v137, v137, v54
    v_sub_f32 v25, v25, v54
    v_sub_f32 v138, v138, v54
    v_sub_f32 v26, v26, v54
    v_sub_f32 v139, v139, v54
    v_sub_f32 v27, v27, v54
    v_sub_f32 v140, v140, v55
    v_sub_f32 v28, v28, v55
    v_sub_f32 v141, v141, v55
    v_sub_f32 v29, v29, v55
    v_sub_f32 v142, v142, v55
    v_sub_f32 v30, v30, v55
    v_sub_f32 v143, v143, v55
    v_sub_f32 v31, v31, v55
    v_sub_f32 v144, v144, v54
    v_sub_f32 v32, v32, v54
    v_sub_f32 v145, v145, v54
    v_sub_f32 v33, v33, v54
    v_sub_f32 v146, v146, v54
    v_sub_f32 v34, v34, v54
    v_sub_f32 v147, v147, v54
    v_sub_f32 v35, v35, v54
    v_sub_f32 v148, v148, v55
    v_sub_f32 v36, v36, v55
    v_sub_f32 v149, v149, v55
    v_sub_f32 v37, v37, v55
    v_sub_f32 v150, v150, v55
    v_sub_f32 v38, v38, v55
    v_sub_f32 v151, v151, v55
    v_sub_f32 v39, v39, v55
    v_sub_f32 v152, v152, v54
    v_sub_f32 v40, v40, v54
    v_sub_f32 v153, v153, v54
    v_sub_f32 v41, v41, v54
    v_sub_f32 v154, v154, v54
    v_sub_f32 v42, v42, v54
    v_sub_f32 v155, v155, v54
    v_sub_f32 v43, v43, v54
    v_sub_f32 v156, v156, v55
    v_sub_f32 v44, v44, v55
    v_sub_f32 v157, v157, v55
    v_sub_f32 v45, v45, v55
    v_sub_f32 v158, v158, v55
    v_sub_f32 v46, v46, v55
    v_sub_f32 v159, v159, v55
    v_sub_f32 v47, v47, v55
    v_sub_f32 v9, v9, v53
    v_exp_f32 v53, -v53
    v_sub_f32 v10, v10, v54
    v_exp_f32 v54, -v54
    v_sub_f32 v11, v11, v55
    v_exp_f32 v55, -v55
    s_nop 0
    v_mul_f32 v48, v48, v53
    v_mul_f32 v248, v248, v54
    v_mul_f32 v252, v252, v55
    v_accvgpr_read_b32 v224, a4
    v_accvgpr_read_b32 v225, a5
    v_accvgpr_read_b32 v226, a6
    v_accvgpr_read_b32 v227, a7
    v_mul_f32 v224, v224, v53
    v_mul_f32 v225, v225, v53
    v_mul_f32 v226, v226, v53
    v_mul_f32 v227, v227, v53
    v_accvgpr_write_b32 a4, v224
    v_accvgpr_write_b32 a5, v225
    v_accvgpr_write_b32 a6, v226
    v_accvgpr_write_b32 a7, v227
    v_accvgpr_read_b32 v224, a8
    v_accvgpr_read_b32 v225, a9
    v_accvgpr_read_b32 v226, a10
    v_accvgpr_read_b32 v227, a11
    v_mul_f32 v224, v224, v54
    v_mul_f32 v225, v225, v54
    v_mul_f32 v226, v226, v54
    v_mul_f32 v227, v227, v54
    v_accvgpr_write_b32 a8, v224
    v_accvgpr_write_b32 a9, v225
    v_accvgpr_write_b32 a10, v226
    v_accvgpr_write_b32 a11, v227
    v_accvgpr_read_b32 v224, a12
    v_accvgpr_read_b32 v225, a13
    v_accvgpr_read_b32 v226, a14
    v_accvgpr_read_b32 v227, a15
    v_mul_f32 v224, v224, v55
    v_mul_f32 v225, v225, v55
    v_mul_f32 v226, v226, v55
    v_mul_f32 v227, v227, v55
    v_accvgpr_write_b32 a12, v224
    v_accvgpr_write_b32 a13, v225
    v_accvgpr_write_b32 a14, v226
    v_accvgpr_write_b32 a15, v227
    v_accvgpr_read_b32 v224, a20
    v_accvgpr_read_b32 v225, a21
    v_accvgpr_read_b32 v226, a22
    v_accvgpr_read_b32 v227, a23
    v_mul_f32 v224, v224, v53
    v_mul_f32 v225, v225, v53
    v_mul_f32 v226, v226, v53
    v_mul_f32 v227, v227, v53
    v_accvgpr_write_b32 a20, v224
    v_accvgpr_write_b32 a21, v225
    v_accvgpr_write_b32 a22, v226
    v_accvgpr_write_b32 a23, v227
    v_accvgpr_read_b32 v224, a24
    v_accvgpr_read_b32 v225, a25
    v_accvgpr_read_b32 v226, a26
    v_accvgpr_read_b32 v227, a27
    v_mul_f32 v224, v224, v54
    v_mul_f32 v225, v225, v54
    v_mul_f32 v226, v226, v54
    v_mul_f32 v227, v227, v54
    v_accvgpr_write_b32 a24, v224
    v_accvgpr_write_b32 a25, v225
    v_accvgpr_write_b32 a26, v226
    v_accvgpr_write_b32 a27, v227
    v_accvgpr_read_b32 v224, a28
    v_accvgpr_read_b32 v225, a29
    v_accvgpr_read_b32 v226, a30
    v_accvgpr_read_b32 v227, a31
    v_mul_f32 v224, v224, v55
    v_mul_f32 v225, v225, v55
    v_mul_f32 v226, v226, v55
    v_mul_f32 v227, v227, v55
    v_accvgpr_write_b32 a28, v224
    v_accvgpr_write_b32 a29, v225
    v_accvgpr_write_b32 a30, v226
    v_accvgpr_write_b32 a31, v227
    v_accvgpr_read_b32 v224, a36
    v_accvgpr_read_b32 v225, a37
    v_accvgpr_read_b32 v226, a38
    v_accvgpr_read_b32 v227, a39
    v_mul_f32 v224, v224, v53
    v_mul_f32 v225, v225, v53
    v_mul_f32 v226, v226, v53
    v_mul_f32 v227, v227, v53
    v_accvgpr_write_b32 a36, v224
    v_accvgpr_write_b32 a37, v225
    v_accvgpr_write_b32 a38, v226
    v_accvgpr_write_b32 a39, v227
    v_accvgpr_read_b32 v224, a40
    v_accvgpr_read_b32 v225, a41
    v_accvgpr_read_b32 v226, a42
    v_accvgpr_read_b32 v227, a43
    v_mul_f32 v224, v224, v54
    v_mul_f32 v225, v225, v54
    v_mul_f32 v226, v226, v54
    v_mul_f32 v227, v227, v54
    v_accvgpr_write_b32 a40, v224
    v_accvgpr_write_b32 a41, v225
    v_accvgpr_write_b32 a42, v226
    v_accvgpr_write_b32 a43, v227
    v_accvgpr_read_b32 v224, a44
    v_accvgpr_read_b32 v225, a45
    v_accvgpr_read_b32 v226, a46
    v_accvgpr_read_b32 v227, a47
    v_mul_f32 v224, v224, v55
    v_mul_f32 v225, v225, v55
    v_mul_f32 v226, v226, v55
    v_mul_f32 v227, v227, v55
    v_accvgpr_write_b32 a44, v224
    v_accvgpr_write_b32 a45, v225
    v_accvgpr_write_b32 a46, v226
    v_accvgpr_write_b32 a47, v227
    v_accvgpr_read_b32 v224, a52
    v_accvgpr_read_b32 v225, a53
    v_accvgpr_read_b32 v226, a54
    v_accvgpr_read_b32 v227, a55
    v_mul_f32 v224, v224, v53
    v_mul_f32 v225, v225, v53
    v_mul_f32 v226, v226, v53
    v_mul_f32 v227, v227, v53
    v_accvgpr_write_b32 a52, v224
    v_accvgpr_write_b32 a53, v225
    v_accvgpr_write_b32 a54, v226
    v_accvgpr_write_b32 a55, v227
    v_accvgpr_read_b32 v224, a56
    v_accvgpr_read_b32 v225, a57
    v_accvgpr_read_b32 v226, a58
    v_accvgpr_read_b32 v227, a59
    v_mul_f32 v224, v224, v54
    v_mul_f32 v225, v225, v54
    v_mul_f32 v226, v226, v54
    v_mul_f32 v227, v227, v54
    v_accvgpr_write_b32 a56, v224
    v_accvgpr_write_b32 a57, v225
    v_accvgpr_write_b32 a58, v226
    v_accvgpr_write_b32 a59, v227
    v_accvgpr_read_b32 v224, a60
    v_accvgpr_read_b32 v225, a61
    v_accvgpr_read_b32 v226, a62
    v_accvgpr_read_b32 v227, a63
    v_mul_f32 v224, v224, v55
    v_mul_f32 v225, v225, v55
    v_mul_f32 v226, v226, v55
    v_mul_f32 v227, v227, v55
    v_accvgpr_write_b32 a60, v224
    v_accvgpr_write_b32 a61, v225
    v_accvgpr_write_b32 a62, v226
    v_accvgpr_write_b32 a63, v227
    v_accvgpr_read_b32 v224, a68
    v_accvgpr_read_b32 v225, a69
    v_accvgpr_read_b32 v226, a70
    v_accvgpr_read_b32 v227, a71
    v_mul_f32 v224, v224, v53
    v_mul_f32 v225, v225, v53
    v_mul_f32 v226, v226, v53
    v_mul_f32 v227, v227, v53
    v_accvgpr_write_b32 a68, v224
    v_accvgpr_write_b32 a69, v225
    v_accvgpr_write_b32 a70, v226
    v_accvgpr_write_b32 a71, v227
    v_accvgpr_read_b32 v224, a72
    v_accvgpr_read_b32 v225, a73
    v_accvgpr_read_b32 v226, a74
    v_accvgpr_read_b32 v227, a75
    v_mul_f32 v224, v224, v54
    v_mul_f32 v225, v225, v54
    v_mul_f32 v226, v226, v54
    v_mul_f32 v227, v227, v54
    v_accvgpr_write_b32 a72, v224
    v_accvgpr_write_b32 a73, v225
    v_accvgpr_write_b32 a74, v226
    v_accvgpr_write_b32 a75, v227
    v_accvgpr_read_b32 v224, a76
    v_accvgpr_read_b32 v225, a77
    v_accvgpr_read_b32 v226, a78
    v_accvgpr_read_b32 v227, a79
    v_mul_f32 v224, v224, v55
    v_mul_f32 v225, v225, v55
    v_mul_f32 v226, v226, v55
    v_mul_f32 v227, v227, v55
    v_accvgpr_write_b32 a76, v224
    v_accvgpr_write_b32 a77, v225
    v_accvgpr_write_b32 a78, v226
    v_accvgpr_write_b32 a79, v227
    v_accvgpr_read_b32 v224, a84
    v_accvgpr_read_b32 v225, a85
    v_accvgpr_read_b32 v226, a86
    v_accvgpr_read_b32 v227, a87
    v_mul_f32 v224, v224, v53
    v_mul_f32 v225, v225, v53
    v_mul_f32 v226, v226, v53
    v_mul_f32 v227, v227, v53
    v_accvgpr_write_b32 a84, v224
    v_accvgpr_write_b32 a85, v225
    v_accvgpr_write_b32 a86, v226
    v_accvgpr_write_b32 a87, v227
    v_accvgpr_read_b32 v224, a88
    v_accvgpr_read_b32 v225, a89
    v_accvgpr_read_b32 v226, a90
    v_accvgpr_read_b32 v227, a91
    v_mul_f32 v224, v224, v54
    v_mul_f32 v225, v225, v54
    v_mul_f32 v226, v226, v54
    v_mul_f32 v227, v227, v54
    v_accvgpr_write_b32 a88, v224
    v_accvgpr_write_b32 a89, v225
    v_accvgpr_write_b32 a90, v226
    v_accvgpr_write_b32 a91, v227
    v_accvgpr_read_b32 v224, a92
    v_accvgpr_read_b32 v225, a93
    v_accvgpr_read_b32 v226, a94
    v_accvgpr_read_b32 v227, a95
    v_mul_f32 v224, v224, v55
    v_mul_f32 v225, v225, v55
    v_mul_f32 v226, v226, v55
    v_mul_f32 v227, v227, v55
    v_accvgpr_write_b32 a92, v224
    v_accvgpr_write_b32 a93, v225
    v_accvgpr_write_b32 a94, v226
    v_accvgpr_write_b32 a95, v227
    v_accvgpr_read_b32 v224, a100
    v_accvgpr_read_b32 v225, a101
    v_accvgpr_read_b32 v226, a102
    v_accvgpr_read_b32 v227, a103
    v_mul_f32 v224, v224, v53
    v_mul_f32 v225, v225, v53
    v_mul_f32 v226, v226, v53
    v_mul_f32 v227, v227, v53
    v_accvgpr_write_b32 a100, v224
    v_accvgpr_write_b32 a101, v225
    v_accvgpr_write_b32 a102, v226
    v_accvgpr_write_b32 a103, v227
    v_accvgpr_read_b32 v224, a104
    v_accvgpr_read_b32 v225, a105
    v_accvgpr_read_b32 v226, a106
    v_accvgpr_read_b32 v227, a107
    v_mul_f32 v224, v224, v54
    v_mul_f32 v225, v225, v54
    v_mul_f32 v226, v226, v54
    v_mul_f32 v227, v227, v54
    v_accvgpr_write_b32 a104, v224
    v_accvgpr_write_b32 a105, v225
    v_accvgpr_write_b32 a106, v226
    v_accvgpr_write_b32 a107, v227
    v_accvgpr_read_b32 v224, a108
    v_accvgpr_read_b32 v225, a109
    v_accvgpr_read_b32 v226, a110
    v_accvgpr_read_b32 v227, a111
    v_mul_f32 v224, v224, v55
    v_mul_f32 v225, v225, v55
    v_mul_f32 v226, v226, v55
    v_mul_f32 v227, v227, v55
    v_accvgpr_write_b32 a108, v224
    v_accvgpr_write_b32 a109, v225
    v_accvgpr_write_b32 a110, v226
    v_accvgpr_write_b32 a111, v227
    v_accvgpr_read_b32 v224, a116
    v_accvgpr_read_b32 v225, a117
    v_accvgpr_read_b32 v226, a118
    v_accvgpr_read_b32 v227, a119
    v_mul_f32 v224, v224, v53
    v_mul_f32 v225, v225, v53
    v_mul_f32 v226, v226, v53
    v_mul_f32 v227, v227, v53
    v_accvgpr_write_b32 a116, v224
    v_accvgpr_write_b32 a117, v225
    v_accvgpr_write_b32 a118, v226
    v_accvgpr_write_b32 a119, v227
    v_accvgpr_read_b32 v224, a120
    v_accvgpr_read_b32 v225, a121
    v_accvgpr_read_b32 v226, a122
    v_accvgpr_read_b32 v227, a123
    v_mul_f32 v224, v224, v54
    v_mul_f32 v225, v225, v54
    v_mul_f32 v226, v226, v54
    v_mul_f32 v227, v227, v54
    v_accvgpr_write_b32 a120, v224
    v_accvgpr_write_b32 a121, v225
    v_accvgpr_write_b32 a122, v226
    v_accvgpr_write_b32 a123, v227
    v_accvgpr_read_b32 v224, a124
    v_accvgpr_read_b32 v225, a125
    v_accvgpr_read_b32 v226, a126
    v_accvgpr_read_b32 v227, a127
    v_mul_f32 v224, v224, v55
    v_mul_f32 v225, v225, v55
    v_mul_f32 v226, v226, v55
    v_mul_f32 v227, v227, v55
    v_accvgpr_write_b32 a124, v224
    v_accvgpr_write_b32 a125, v225
    v_accvgpr_write_b32 a126, v226
    v_accvgpr_write_b32 a127, v227
    v_exp_f32 v232, v164
    v_exp_f32 v233, v165
    v_exp_f32 v234, v166
    v_exp_f32 v235, v167
    s_nop 0
    v_cvt_pk_bf16_f32 v212, v232, v233
    v_cvt_pk_bf16_f32 v213, v234, v235
    v_exp_f32 v232, v180
    v_exp_f32 v233, v181
    v_exp_f32 v234, v182
    v_exp_f32 v235, v183
    s_nop 0
    v_cvt_pk_bf16_f32 v214, v232, v233
    v_cvt_pk_bf16_f32 v215, v234, v235
    v_exp_f32 v232, v168
    v_exp_f32 v233, v169
    v_exp_f32 v234, v170
    v_exp_f32 v235, v171
    s_nop 0
    v_cvt_pk_bf16_f32 v216, v232, v233
    v_cvt_pk_bf16_f32 v217, v234, v235
    v_exp_f32 v232, v184
    v_exp_f32 v233, v185
    v_exp_f32 v234, v186
    v_exp_f32 v235, v187
    s_nop 0
    v_cvt_pk_bf16_f32 v218, v232, v233
    v_cvt_pk_bf16_f32 v219, v234, v235
    v_exp_f32 v232, v172
    v_exp_f32 v233, v173
    v_exp_f32 v234, v174
    v_exp_f32 v235, v175
    s_nop 0
    v_cvt_pk_bf16_f32 v220, v232, v233
    v_cvt_pk_bf16_f32 v221, v234, v235
    v_exp_f32 v232, v188
    v_exp_f32 v233, v189
    v_exp_f32 v234, v190
    v_exp_f32 v235, v191
    s_nop 0
    v_cvt_pk_bf16_f32 v222, v232, v233
    v_cvt_pk_bf16_f32 v223, v234, v235
    s_nop 3
    s_setpc_b64 s[40:41]
k2_rare_166:
    s_nop 7
    v_max_f32 v54, v128, v129
    v_max3_f32 v54, v54, v130, v131
    v_max3_f32 v54, v54, v144, v145
    v_max3_f32 v54, v54, v146, v147
    v_max3_f32 v54, v54, v136, v137
    v_max3_f32 v54, v54, v138, v139
    v_max3_f32 v54, v54, v152, v153
    v_max3_f32 v54, v54, v154, v155
    v_max_f32 v55, v132, v133
    v_max3_f32 v55, v55, v134, v135
    v_max3_f32 v55, v55, v148, v149
    v_max3_f32 v55, v55, v150, v151
    v_max3_f32 v55, v55, v140, v141
    v_max3_f32 v55, v55, v142, v143
    v_max3_f32 v55, v55, v156, v157
    v_max3_f32 v55, v55, v158, v159
    v_mov_b32 v226, v54
    v_mov_b32 v227, v55
    s_nop 1
    v_permlane16_swap_b32 v54, v226
    v_permlane16_swap_b32 v55, v227
    s_nop 1
    v_max_f32 v54, v54, v226
    v_max_f32 v55, v55, v227
    v_mov_b32 v226, v54
    v_mov_b32 v227, v55
    s_nop 1
    v_permlane32_swap_b32 v54, v226
    v_permlane32_swap_b32 v55, v227
    s_nop 1
    v_max_f32 v54, v54, v226
    v_max_f32 v55, v55, v227
    v_add_f32 v54, 0x41400000, v54
    v_max_f32 v54, 0, v54
    v_add_f32 v55, 0x41400000, v55
    v_max_f32 v55, 0, v55
    v_sub_f32 v128, v128, v54
    v_sub_f32 v129, v129, v54
    v_sub_f32 v130, v130, v54
    v_sub_f32 v131, v131, v54
    v_sub_f32 v132, v132, v55
    v_sub_f32 v133, v133, v55
    v_sub_f32 v134, v134, v55
    v_sub_f32 v135, v135, v55
    v_sub_f32 v136, v136, v54
    v_sub_f32 v137, v137, v54
    v_sub_f32 v138, v138, v54
    v_sub_f32 v139, v139, v54
    v_sub_f32 v140, v140, v55
    v_sub_f32 v141, v141, v55
    v_sub_f32 v142, v142, v55
    v_sub_f32 v143, v143, v55
    v_sub_f32 v144, v144, v54
    v_sub_f32 v145, v145, v54
    v_sub_f32 v146, v146, v54
    v_sub_f32 v147, v147, v54
    v_sub_f32 v148, v148, v55
    v_sub_f32 v149, v149, v55
    v_sub_f32 v150, v150, v55
    v_sub_f32 v151, v151, v55
    v_sub_f32 v152, v152, v54
    v_sub_f32 v153, v153, v54
    v_sub_f32 v154, v154, v54
    v_sub_f32 v155, v155, v54
    v_sub_f32 v156, v156, v55
    v_sub_f32 v157, v157, v55
    v_sub_f32 v158, v158, v55
    v_sub_f32 v159, v159, v55
    v_sub_f32 v160, v160, v54
    v_sub_f32 v16, v16, v54
    v_sub_f32 v161, v161, v54
    v_sub_f32 v17, v17, v54
    v_sub_f32 v162, v162, v54
    v_sub_f32 v18, v18, v54
    v_sub_f32 v163, v163, v54
    v_sub_f32 v19, v19, v54
    v_sub_f32 v164, v164, v55
    v_sub_f32 v20, v20, v55
    v_sub_f32 v165, v165, v55
    v_sub_f32 v21, v21, v55
    v_sub_f32 v166, v166, v55
    v_sub_f32 v22, v22, v55
    v_sub_f32 v167, v167, v55
    v_sub_f32 v23, v23, v55
    v_sub_f32 v168, v168, v54
    v_sub_f32 v24, v24, v54
    v_sub_f32 v169, v169, v54
    v_sub_f32 v25, v25, v54
    v_sub_f32 v170, v170, v54
    v_sub_f32 v26, v26, v54
    v_sub_f32 v171, v171, v54
    v_sub_f32 v27, v27, v54
    v_sub_f32 v172, v172, v55
    v_sub_f32 v28, v28, v55
    v_sub_f32 v173, v173, v55
    v_sub_f32 v29, v29, v55
    v_sub_f32 v174, v174, v55
    v_sub_f32 v30, v30, v55
    v_sub_f32 v175, v175, v55
    v_sub_f32 v31, v31, v55
    v_sub_f32 v176, v176, v54
    v_sub_f32 v32, v32, v54
    v_sub_f32 v177, v177, v54
    v_sub_f32 v33, v33, v54
    v_sub_f32 v178, v178, v54
    v_sub_f32 v34, v34, v54
    v_sub_f32 v179, v179, v54
    v_sub_f32 v35, v35, v54
    v_sub_f32 v180, v180, v55
    v_sub_f32 v36, v36, v55
    v_sub_f32 v181, v181, v55
    v_sub_f32 v37, v37, v55
    v_sub_f32 v182, v182, v55
    v_sub_f32 v38, v38, v55
    v_sub_f32 v183, v183, v55
    v_sub_f32 v39, v39, v55
    v_sub_f32 v184, v184, v54
    v_sub_f32 v40, v40, v54
    v_sub_f32 v185, v185, v54
    v_sub_f32 v41, v41, v54
    v_sub_f32 v186, v186, v54
    v_sub_f32 v42, v42, v54
    v_sub_f32 v187, v187, v54
    v_sub_f32 v43, v43, v54
    v_sub_f32 v188, v188, v55
    v_sub_f32 v44, v44, v55
    v_sub_f32 v189, v189, v55
    v_sub_f32 v45, v45, v55
    v_sub_f32 v190, v190, v55
    v_sub_f32 v46, v46, v55
    v_sub_f32 v191, v191, v55
    v_sub_f32 v47, v47, v55
    v_sub_f32 v10, v10, v54
    v_exp_f32 v54, -v54
    v_sub_f32 v11, v11, v55
    v_exp_f32 v55, -v55
    s_nop 0
    v_mul_f32 v248, v248, v54
    v_mul_f32 v252, v252, v55
    v_accvgpr_read_b32 v224, a8
    v_accvgpr_read_b32 v225, a9
    v_accvgpr_read_b32 v226, a10
    v_accvgpr_read_b32 v227, a11
    v_mul_f32 v224, v224, v54
    v_mul_f32 v225, v225, v54
    v_mul_f32 v226, v226, v54
    v_mul_f32 v227, v227, v54
    v_accvgpr_write_b32 a8, v224
    v_accvgpr_write_b32 a9, v225
    v_accvgpr_write_b32 a10, v226
    v_accvgpr_write_b32 a11, v227
    v_accvgpr_read_b32 v224, a12
    v_accvgpr_read_b32 v225, a13
    v_accvgpr_read_b32 v226, a14
    v_accvgpr_read_b32 v227, a15
    v_mul_f32 v224, v224, v55
    v_mul_f32 v225, v225, v55
    v_mul_f32 v226, v226, v55
    v_mul_f32 v227, v227, v55
    v_accvgpr_write_b32 a12, v224
    v_accvgpr_write_b32 a13, v225
    v_accvgpr_write_b32 a14, v226
    v_accvgpr_write_b32 a15, v227
    v_accvgpr_read_b32 v224, a24
    v_accvgpr_read_b32 v225, a25
    v_accvgpr_read_b32 v226, a26
    v_accvgpr_read_b32 v227, a27
    v_mul_f32 v224, v224, v54
    v_mul_f32 v225, v225, v54
    v_mul_f32 v226, v226, v54
    v_mul_f32 v227, v227, v54
    v_accvgpr_write_b32 a24, v224
    v_accvgpr_write_b32 a25, v225
    v_accvgpr_write_b32 a26, v226
    v_accvgpr_write_b32 a27, v227
    v_accvgpr_read_b32 v224, a28
    v_accvgpr_read_b32 v225, a29
    v_accvgpr_read_b32 v226, a30
    v_accvgpr_read_b32 v227, a31
    v_mul_f32 v224, v224, v55
    v_mul_f32 v225, v225, v55
    v_mul_f32 v226, v226, v55
    v_mul_f32 v227, v227, v55
    v_accvgpr_write_b32 a28, v224
    v_accvgpr_write_b32 a29, v225
    v_accvgpr_write_b32 a30, v226
    v_accvgpr_write_b32 a31, v227
    v_accvgpr_read_b32 v224, a40
    v_accvgpr_read_b32 v225, a41
    v_accvgpr_read_b32 v226, a42
    v_accvgpr_read_b32 v227, a43
    v_mul_f32 v224, v224, v54
    v_mul_f32 v225, v225, v54
    v_mul_f32 v226, v226, v54
    v_mul_f32 v227, v227, v54
    v_accvgpr_write_b32 a40, v224
    v_accvgpr_write_b32 a41, v225
    v_accvgpr_write_b32 a42, v226
    v_accvgpr_write_b32 a43, v227
    v_accvgpr_read_b32 v224, a44
    v_accvgpr_read_b32 v225, a45
    v_accvgpr_read_b32 v226, a46
    v_accvgpr_read_b32 v227, a47
    v_mul_f32 v224, v224, v55
    v_mul_f32 v225, v225, v55
    v_mul_f32 v226, v226, v55
    v_mul_f32 v227, v227, v55
    v_accvgpr_write_b32 a44, v224
    v_accvgpr_write_b32 a45, v225
    v_accvgpr_write_b32 a46, v226
    v_accvgpr_write_b32 a47, v227
    v_accvgpr_read_b32 v224, a56
    v_accvgpr_read_b32 v225, a57
    v_accvgpr_read_b32 v226, a58
    v_accvgpr_read_b32 v227, a59
    v_mul_f32 v224, v224, v54
    v_mul_f32 v225, v225, v54
    v_mul_f32 v226, v226, v54
    v_mul_f32 v227, v227, v54
    v_accvgpr_write_b32 a56, v224
    v_accvgpr_write_b32 a57, v225
    v_accvgpr_write_b32 a58, v226
    v_accvgpr_write_b32 a59, v227
    v_accvgpr_read_b32 v224, a60
    v_accvgpr_read_b32 v225, a61
    v_accvgpr_read_b32 v226, a62
    v_accvgpr_read_b32 v227, a63
    v_mul_f32 v224, v224, v55
    v_mul_f32 v225, v225, v55
    v_mul_f32 v226, v226, v55
    v_mul_f32 v227, v227, v55
    v_accvgpr_write_b32 a60, v224
    v_accvgpr_write_b32 a61, v225
    v_accvgpr_write_b32 a62, v226
    v_accvgpr_write_b32 a63, v227
    v_accvgpr_read_b32 v224, a72
    v_accvgpr_read_b32 v225, a73
    v_accvgpr_read_b32 v226, a74
    v_accvgpr_read_b32 v227, a75
    v_mul_f32 v224, v224, v54
    v_mul_f32 v225, v225, v54
    v_mul_f32 v226, v226, v54
    v_mul_f32 v227, v227, v54
    v_accvgpr_write_b32 a72, v224
    v_accvgpr_write_b32 a73, v225
    v_accvgpr_write_b32 a74, v226
    v_accvgpr_write_b32 a75, v227
    v_accvgpr_read_b32 v224, a76
    v_accvgpr_read_b32 v225, a77
    v_accvgpr_read_b32 v226, a78
    v_accvgpr_read_b32 v227, a79
    v_mul_f32 v224, v224, v55
    v_mul_f32 v225, v225, v55
    v_mul_f32 v226, v226, v55
    v_mul_f32 v227, v227, v55
    v_accvgpr_write_b32 a76, v224
    v_accvgpr_write_b32 a77, v225
    v_accvgpr_write_b32 a78, v226
    v_accvgpr_write_b32 a79, v227
    v_accvgpr_read_b32 v224, a88
    v_accvgpr_read_b32 v225, a89
    v_accvgpr_read_b32 v226, a90
    v_accvgpr_read_b32 v227, a91
    v_mul_f32 v224, v224, v54
    v_mul_f32 v225, v225, v54
    v_mul_f32 v226, v226, v54
    v_mul_f32 v227, v227, v54
    v_accvgpr_write_b32 a88, v224
    v_accvgpr_write_b32 a89, v225
    v_accvgpr_write_b32 a90, v226
    v_accvgpr_write_b32 a91, v227
    v_accvgpr_read_b32 v224, a92
    v_accvgpr_read_b32 v225, a93
    v_accvgpr_read_b32 v226, a94
    v_accvgpr_read_b32 v227, a95
    v_mul_f32 v224, v224, v55
    v_mul_f32 v225, v225, v55
    v_mul_f32 v226, v226, v55
    v_mul_f32 v227, v227, v55
    v_accvgpr_write_b32 a92, v224
    v_accvgpr_write_b32 a93, v225
    v_accvgpr_write_b32 a94, v226
    v_accvgpr_write_b32 a95, v227
    v_accvgpr_read_b32 v224, a104
    v_accvgpr_read_b32 v225, a105
    v_accvgpr_read_b32 v226, a106
    v_accvgpr_read_b32 v227, a107
    v_mul_f32 v224, v224, v54
    v_mul_f32 v225, v225, v54
    v_mul_f32 v226, v226, v54
    v_mul_f32 v227, v227, v54
    v_accvgpr_write_b32 a104, v224
    v_accvgpr_write_b32 a105, v225
    v_accvgpr_write_b32 a106, v226
    v_accvgpr_write_b32 a107, v227
    v_accvgpr_read_b32 v224, a108
    v_accvgpr_read_b32 v225, a109
    v_accvgpr_read_b32 v226, a110
    v_accvgpr_read_b32 v227, a111
    v_mul_f32 v224, v224, v55
    v_mul_f32 v225, v225, v55
    v_mul_f32 v226, v226, v55
    v_mul_f32 v227, v227, v55
    v_accvgpr_write_b32 a108, v224
    v_accvgpr_write_b32 a109, v225
    v_accvgpr_write_b32 a110, v226
    v_accvgpr_write_b32 a111, v227
    v_accvgpr_read_b32 v224, a120
    v_accvgpr_read_b32 v225, a121
    v_accvgpr_read_b32 v226, a122
    v_accvgpr_read_b32 v227, a123
    v_mul_f32 v224, v224, v54
    v_mul_f32 v225, v225, v54
    v_mul_f32 v226, v226, v54
    v_mul_f32 v227, v227, v54
    v_accvgpr_write_b32 a120, v224
    v_accvgpr_write_b32 a121, v225
    v_accvgpr_write_b32 a122, v226
    v_accvgpr_write_b32 a123, v227
    v_accvgpr_read_b32 v224, a124
    v_accvgpr_read_b32 v225, a125
    v_accvgpr_read_b32 v226, a126
    v_accvgpr_read_b32 v227, a127
    v_mul_f32 v224, v224, v55
    v_mul_f32 v225, v225, v55
    v_mul_f32 v226, v226, v55
    v_mul_f32 v227, v227, v55
    v_accvgpr_write_b32 a124, v224
    v_accvgpr_write_b32 a125, v225
    v_accvgpr_write_b32 a126, v226
    v_accvgpr_write_b32 a127, v227
    v_exp_f32 v232, v128
    v_exp_f32 v233, v129
    v_exp_f32 v234, v130
    v_exp_f32 v235, v131
    s_nop 0
    v_cvt_pk_bf16_f32 v192, v232, v233
    v_cvt_pk_bf16_f32 v193, v234, v235
    v_exp_f32 v232, v144
    v_exp_f32 v233, v145
    v_exp_f32 v234, v146
    v_exp_f32 v235, v147
    s_nop 0
    v_cvt_pk_bf16_f32 v194, v232, v233
    v_cvt_pk_bf16_f32 v195, v234, v235
    v_exp_f32 v232, v132
    v_exp_f32 v233, v133
    v_exp_f32 v234, v134
    v_exp_f32 v235, v135
    s_nop 0
    v_cvt_pk_bf16_f32 v196, v232, v233
    v_cvt_pk_bf16_f32 v197, v234, v235
    v_exp_f32 v232, v148
    v_exp_f32 v233, v149
    v_exp_f32 v234, v150
    v_exp_f32 v235, v151
    s_nop 0
    v_cvt_pk_bf16_f32 v198, v232, v233
    v_cvt_pk_bf16_f32 v199, v234, v235
    v_exp_f32 v232, v136
    v_exp_f32 v233, v137
    v_exp_f32 v234, v138
    v_exp_f32 v235, v139
    s_nop 0
    v_cvt_pk_bf16_f32 v200, v232, v233
    v_cvt_pk_bf16_f32 v201, v234, v235
    v_exp_f32 v232, v152
    v_exp_f32 v233, v153
    v_exp_f32 v234, v154
    v_exp_f32 v235, v155
    s_nop 0
    v_cvt_pk_bf16_f32 v202, v232, v233
    v_cvt_pk_bf16_f32 v203, v234, v235
    v_exp_f32 v232, v140
    v_exp_f32 v233, v141
    v_exp_f32 v234, v142
    v_exp_f32 v235, v143
    s_nop 0
    v_cvt_pk_bf16_f32 v204, v232, v233
    v_cvt_pk_bf16_f32 v205, v234, v235
    v_exp_f32 v232, v156
    v_exp_f32 v233, v157
    v_exp_f32 v234, v158
    v_exp_f32 v235, v159
    s_nop 0
    v_cvt_pk_bf16_f32 v206, v232, v233
    v_cvt_pk_bf16_f32 v207, v234, v235
    s_nop 3
    s_setpc_b64 s[40:41]
k2_rare_167:
    s_nop 7
    v_max_f32 v54, v160, v161
    v_max3_f32 v54, v54, v162, v163
    v_max3_f32 v54, v54, v176, v177
    v_max3_f32 v54, v54, v178, v179
    v_max3_f32 v54, v54, v168, v169
    v_max3_f32 v54, v54, v170, v171
    v_max3_f32 v54, v54, v184, v185
    v_max3_f32 v54, v54, v186, v187
    v_max_f32 v55, v164, v165
    v_max3_f32 v55, v55, v166, v167
    v_max3_f32 v55, v55, v180, v181
    v_max3_f32 v55, v55, v182, v183
    v_max3_f32 v55, v55, v172, v173
    v_max3_f32 v55, v55, v174, v175
    v_max3_f32 v55, v55, v188, v189
    v_max3_f32 v55, v55, v190, v191
    v_mov_b32 v226, v54
    v_mov_b32 v227, v55
    s_nop 1
    v_permlane16_swap_b32 v54, v226
    v_permlane16_swap_b32 v55, v227
    s_nop 1
    v_max_f32 v54, v54, v226
    v_max_f32 v55, v55, v227
    v_mov_b32 v226, v54
    v_mov_b32 v227, v55
    s_nop 1
    v_permlane32_swap_b32 v54, v226
    v_permlane32_swap_b32 v55, v227
    s_nop 1
    v_max_f32 v54, v54, v226
    v_max_f32 v55, v55, v227
    v_add_f32 v54, 0x41400000, v54
    v_max_f32 v54, 0, v54
    v_add_f32 v55, 0x41400000, v55
    v_max_f32 v55, 0, v55
    v_sub_f32 v160, v160, v54
    v_sub_f32 v161, v161, v54
    v_sub_f32 v162, v162, v54
    v_sub_f32 v163, v163, v54
    v_sub_f32 v164, v164, v55
    v_sub_f32 v165, v165, v55
    v_sub_f32 v166, v166, v55
    v_sub_f32 v167, v167, v55
    v_sub_f32 v168, v168, v54
    v_sub_f32 v169, v169, v54
    v_sub_f32 v170, v170, v54
    v_sub_f32 v171, v171, v54
    v_sub_f32 v172, v172, v55
    v_sub_f32 v173, v173, v55
    v_sub_f32 v174, v174, v55
    v_sub_f32 v175, v175, v55
    v_sub_f32 v176, v176, v54
    v_sub_f32 v177, v177, v54
    v_sub_f32 v178, v178, v54
    v_sub_f32 v179, v179, v54
    v_sub_f32 v180, v180, v55
    v_sub_f32 v181, v181, v55
    v_sub_f32 v182, v182, v55
    v_sub_f32 v183, v183, v55
    v_sub_f32 v184, v184, v54
    v_sub_f32 v185, v185, v54
    v_sub_f32 v186, v186, v54
    v_sub_f32 v187, v187, v54
    v_sub_f32 v188, v188, v55
    v_sub_f32 v189, v189, v55
    v_sub_f32 v190, v190, v55
    v_sub_f32 v191, v191, v55
    v_sub_f32 v128, v128, v54
    v_sub_f32 v16, v16, v54
    v_sub_f32 v129, v129, v54
    v_sub_f32 v17, v17, v54
    v_sub_f32 v130, v130, v54
    v_sub_f32 v18, v18, v54
    v_sub_f32 v131, v131, v54
    v_sub_f32 v19, v19, v54
    v_sub_f32 v132, v132, v55
    v_sub_f32 v20, v20, v55
    v_sub_f32 v133, v133, v55
    v_sub_f32 v21, v21, v55
    v_sub_f32 v134, v134, v55
    v_sub_f32 v22, v22, v55
    v_sub_f32 v135, v135, v55
    v_sub_f32 v23, v23, v55
    v_sub_f32 v136, v136, v54
    v_sub_f32 v24, v24, v54
    v_sub_f32 v137, v137, v54
    v_sub_f32 v25, v25, v54
    v_sub_f32 v138, v138, v54
    v_sub_f32 v26, v26, v54
    v_sub_f32 v139, v139, v54
    v_sub_f32 v27, v27, v54
    v_sub_f32 v140, v140, v55
    v_sub_f32 v28, v28, v55
    v_sub_f32 v141, v141, v55
    v_sub_f32 v29, v29, v55
    v_sub_f32 v142, v142, v55
    v_sub_f32 v30, v30, v55
    v_sub_f32 v143, v143, v55
    v_sub_f32 v31, v31, v55
    v_sub_f32 v144, v144, v54
    v_sub_f32 v32, v32, v54
    v_sub_f32 v145, v145, v54
    v_sub_f32 v33, v33, v54
    v_sub_f32 v146, v146, v54
    v_sub_f32 v34, v34, v54
    v_sub_f32 v147, v147, v54
    v_sub_f32 v35, v35, v54
    v_sub_f32 v148, v148, v55
    v_sub_f32 v36, v36, v55
    v_sub_f32 v149, v149, v55
    v_sub_f32 v37, v37, v55
    v_sub_f32 v150, v150, v55
    v_sub_f32 v38, v38, v55
    v_sub_f32 v151, v151, v55
    v_sub_f32 v39, v39, v55
    v_sub_f32 v152, v152, v54
    v_sub_f32 v40, v40, v54
    v_sub_f32 v153, v153, v54
    v_sub_f32 v41, v41, v54
    v_sub_f32 v154, v154, v54
    v_sub_f32 v42, v42, v54
    v_sub_f32 v155, v155, v54
    v_sub_f32 v43, v43, v54
    v_sub_f32 v156, v156, v55
    v_sub_f32 v44, v44, v55
    v_sub_f32 v157, v157, v55
    v_sub_f32 v45, v45, v55
    v_sub_f32 v158, v158, v55
    v_sub_f32 v46, v46, v55
    v_sub_f32 v159, v159, v55
    v_sub_f32 v47, v47, v55
    v_sub_f32 v10, v10, v54
    v_exp_f32 v54, -v54
    v_sub_f32 v11, v11, v55
    v_exp_f32 v55, -v55
    s_nop 0
    v_mul_f32 v248, v248, v54
    v_mul_f32 v252, v252, v55
    v_accvgpr_read_b32 v224, a8
    v_accvgpr_read_b32 v225, a9
    v_accvgpr_read_b32 v226, a10
    v_accvgpr_read_b32 v227, a11
    v_mul_f32 v224, v224, v54
    v_mul_f32 v225, v225, v54
    v_mul_f32 v226, v226, v54
    v_mul_f32 v227, v227, v54
    v_accvgpr_write_b32 a8, v224
    v_accvgpr_write_b32 a9, v225
    v_accvgpr_write_b32 a10, v226
    v_accvgpr_write_b32 a11, v227
    v_accvgpr_read_b32 v224, a12
    v_accvgpr_read_b32 v225, a13
    v_accvgpr_read_b32 v226, a14
    v_accvgpr_read_b32 v227, a15
    v_mul_f32 v224, v224, v55
    v_mul_f32 v225, v225, v55
    v_mul_f32 v226, v226, v55
    v_mul_f32 v227, v227, v55
    v_accvgpr_write_b32 a12, v224
    v_accvgpr_write_b32 a13, v225
    v_accvgpr_write_b32 a14, v226
    v_accvgpr_write_b32 a15, v227
    v_accvgpr_read_b32 v224, a24
    v_accvgpr_read_b32 v225, a25
    v_accvgpr_read_b32 v226, a26
    v_accvgpr_read_b32 v227, a27
    v_mul_f32 v224, v224, v54
    v_mul_f32 v225, v225, v54
    v_mul_f32 v226, v226, v54
    v_mul_f32 v227, v227, v54
    v_accvgpr_write_b32 a24, v224
    v_accvgpr_write_b32 a25, v225
    v_accvgpr_write_b32 a26, v226
    v_accvgpr_write_b32 a27, v227
    v_accvgpr_read_b32 v224, a28
    v_accvgpr_read_b32 v225, a29
    v_accvgpr_read_b32 v226, a30
    v_accvgpr_read_b32 v227, a31
    v_mul_f32 v224, v224, v55
    v_mul_f32 v225, v225, v55
    v_mul_f32 v226, v226, v55
    v_mul_f32 v227, v227, v55
    v_accvgpr_write_b32 a28, v224
    v_accvgpr_write_b32 a29, v225
    v_accvgpr_write_b32 a30, v226
    v_accvgpr_write_b32 a31, v227
    v_accvgpr_read_b32 v224, a40
    v_accvgpr_read_b32 v225, a41
    v_accvgpr_read_b32 v226, a42
    v_accvgpr_read_b32 v227, a43
    v_mul_f32 v224, v224, v54
    v_mul_f32 v225, v225, v54
    v_mul_f32 v226, v226, v54
    v_mul_f32 v227, v227, v54
    v_accvgpr_write_b32 a40, v224
    v_accvgpr_write_b32 a41, v225
    v_accvgpr_write_b32 a42, v226
    v_accvgpr_write_b32 a43, v227
    v_accvgpr_read_b32 v224, a44
    v_accvgpr_read_b32 v225, a45
    v_accvgpr_read_b32 v226, a46
    v_accvgpr_read_b32 v227, a47
    v_mul_f32 v224, v224, v55
    v_mul_f32 v225, v225, v55
    v_mul_f32 v226, v226, v55
    v_mul_f32 v227, v227, v55
    v_accvgpr_write_b32 a44, v224
    v_accvgpr_write_b32 a45, v225
    v_accvgpr_write_b32 a46, v226
    v_accvgpr_write_b32 a47, v227
    v_accvgpr_read_b32 v224, a56
    v_accvgpr_read_b32 v225, a57
    v_accvgpr_read_b32 v226, a58
    v_accvgpr_read_b32 v227, a59
    v_mul_f32 v224, v224, v54
    v_mul_f32 v225, v225, v54
    v_mul_f32 v226, v226, v54
    v_mul_f32 v227, v227, v54
    v_accvgpr_write_b32 a56, v224
    v_accvgpr_write_b32 a57, v225
    v_accvgpr_write_b32 a58, v226
    v_accvgpr_write_b32 a59, v227
    v_accvgpr_read_b32 v224, a60
    v_accvgpr_read_b32 v225, a61
    v_accvgpr_read_b32 v226, a62
    v_accvgpr_read_b32 v227, a63
    v_mul_f32 v224, v224, v55
    v_mul_f32 v225, v225, v55
    v_mul_f32 v226, v226, v55
    v_mul_f32 v227, v227, v55
    v_accvgpr_write_b32 a60, v224
    v_accvgpr_write_b32 a61, v225
    v_accvgpr_write_b32 a62, v226
    v_accvgpr_write_b32 a63, v227
    v_accvgpr_read_b32 v224, a72
    v_accvgpr_read_b32 v225, a73
    v_accvgpr_read_b32 v226, a74
    v_accvgpr_read_b32 v227, a75
    v_mul_f32 v224, v224, v54
    v_mul_f32 v225, v225, v54
    v_mul_f32 v226, v226, v54
    v_mul_f32 v227, v227, v54
    v_accvgpr_write_b32 a72, v224
    v_accvgpr_write_b32 a73, v225
    v_accvgpr_write_b32 a74, v226
    v_accvgpr_write_b32 a75, v227
    v_accvgpr_read_b32 v224, a76
    v_accvgpr_read_b32 v225, a77
    v_accvgpr_read_b32 v226, a78
    v_accvgpr_read_b32 v227, a79
    v_mul_f32 v224, v224, v55
    v_mul_f32 v225, v225, v55
    v_mul_f32 v226, v226, v55
    v_mul_f32 v227, v227, v55
    v_accvgpr_write_b32 a76, v224
    v_accvgpr_write_b32 a77, v225
    v_accvgpr_write_b32 a78, v226
    v_accvgpr_write_b32 a79, v227
    v_accvgpr_read_b32 v224, a88
    v_accvgpr_read_b32 v225, a89
    v_accvgpr_read_b32 v226, a90
    v_accvgpr_read_b32 v227, a91
    v_mul_f32 v224, v224, v54
    v_mul_f32 v225, v225, v54
    v_mul_f32 v226, v226, v54
    v_mul_f32 v227, v227, v54
    v_accvgpr_write_b32 a88, v224
    v_accvgpr_write_b32 a89, v225
    v_accvgpr_write_b32 a90, v226
    v_accvgpr_write_b32 a91, v227
    v_accvgpr_read_b32 v224, a92
    v_accvgpr_read_b32 v225, a93
    v_accvgpr_read_b32 v226, a94
    v_accvgpr_read_b32 v227, a95
    v_mul_f32 v224, v224, v55
    v_mul_f32 v225, v225, v55
    v_mul_f32 v226, v226, v55
    v_mul_f32 v227, v227, v55
    v_accvgpr_write_b32 a92, v224
    v_accvgpr_write_b32 a93, v225
    v_accvgpr_write_b32 a94, v226
    v_accvgpr_write_b32 a95, v227
    v_accvgpr_read_b32 v224, a104
    v_accvgpr_read_b32 v225, a105
    v_accvgpr_read_b32 v226, a106
    v_accvgpr_read_b32 v227, a107
    v_mul_f32 v224, v224, v54
    v_mul_f32 v225, v225, v54
    v_mul_f32 v226, v226, v54
    v_mul_f32 v227, v227, v54
    v_accvgpr_write_b32 a104, v224
    v_accvgpr_write_b32 a105, v225
    v_accvgpr_write_b32 a106, v226
    v_accvgpr_write_b32 a107, v227
    v_accvgpr_read_b32 v224, a108
    v_accvgpr_read_b32 v225, a109
    v_accvgpr_read_b32 v226, a110
    v_accvgpr_read_b32 v227, a111
    v_mul_f32 v224, v224, v55
    v_mul_f32 v225, v225, v55
    v_mul_f32 v226, v226, v55
    v_mul_f32 v227, v227, v55
    v_accvgpr_write_b32 a108, v224
    v_accvgpr_write_b32 a109, v225
    v_accvgpr_write_b32 a110, v226
    v_accvgpr_write_b32 a111, v227
    v_accvgpr_read_b32 v224, a120
    v_accvgpr_read_b32 v225, a121
    v_accvgpr_read_b32 v226, a122
    v_accvgpr_read_b32 v227, a123
    v_mul_f32 v224, v224, v54
    v_mul_f32 v225, v225, v54
    v_mul_f32 v226, v226, v54
    v_mul_f32 v227, v227, v54
    v_accvgpr_write_b32 a120, v224
    v_accvgpr_write_b32 a121, v225
    v_accvgpr_write_b32 a122, v226
    v_accvgpr_write_b32 a123, v227
    v_accvgpr_read_b32 v224, a124
    v_accvgpr_read_b32 v225, a125
    v_accvgpr_read_b32 v226, a126
    v_accvgpr_read_b32 v227, a127
    v_mul_f32 v224, v224, v55
    v_mul_f32 v225, v225, v55
    v_mul_f32 v226, v226, v55
    v_mul_f32 v227, v227, v55
    v_accvgpr_write_b32 a124, v224
    v_accvgpr_write_b32 a125, v225
    v_accvgpr_write_b32 a126, v226
    v_accvgpr_write_b32 a127, v227
    v_exp_f32 v232, v160
    v_exp_f32 v233, v161
    v_exp_f32 v234, v162
    v_exp_f32 v235, v163
    s_nop 0
    v_cvt_pk_bf16_f32 v208, v232, v233
    v_cvt_pk_bf16_f32 v209, v234, v235
    v_exp_f32 v232, v176
    v_exp_f32 v233, v177
    v_exp_f32 v234, v178
    v_exp_f32 v235, v179
    s_nop 0
    v_cvt_pk_bf16_f32 v210, v232, v233
    v_cvt_pk_bf16_f32 v211, v234, v235
    v_exp_f32 v232, v164
    v_exp_f32 v233, v165
    v_exp_f32 v234, v166
    v_exp_f32 v235, v167
    s_nop 0
    v_cvt_pk_bf16_f32 v212, v232, v233
    v_cvt_pk_bf16_f32 v213, v234, v235
    v_exp_f32 v232, v180
    v_exp_f32 v233, v181
    v_exp_f32 v234, v182
    v_exp_f32 v235, v183
    s_nop 0
    v_cvt_pk_bf16_f32 v214, v232, v233
    v_cvt_pk_bf16_f32 v215, v234, v235
    v_exp_f32 v232, v168
    v_exp_f32 v233, v169
    v_exp_f32 v234, v170
    v_exp_f32 v235, v171
    s_nop 0
    v_cvt_pk_bf16_f32 v216, v232, v233
    v_cvt_pk_bf16_f32 v217, v234, v235
    v_exp_f32 v232, v184
    v_exp_f32 v233, v185
    v_exp_f32 v234, v186
    v_exp_f32 v235, v187
    s_nop 0
    v_cvt_pk_bf16_f32 v218, v232, v233
    v_cvt_pk_bf16_f32 v219, v234, v235
    v_exp_f32 v232, v172
    v_exp_f32 v233, v173
    v_exp_f32 v234, v174
    v_exp_f32 v235, v175
    s_nop 0
    v_cvt_pk_bf16_f32 v220, v232, v233
    v_cvt_pk_bf16_f32 v221, v234, v235
    v_exp_f32 v232, v188
    v_exp_f32 v233, v189
    v_exp_f32 v234, v190
    v_exp_f32 v235, v191
    s_nop 0
    v_cvt_pk_bf16_f32 v222, v232, v233
    v_cvt_pk_bf16_f32 v223, v234, v235
    s_nop 3
    s_setpc_b64 s[40:41]
k2_rare_171:
    s_nop 7
    v_max_f32 v55, v164, v165
    v_max3_f32 v55, v55, v166, v167
    v_max3_f32 v55, v55, v180, v181
    v_max3_f32 v55, v55, v182, v183
    v_max3_f32 v55, v55, v172, v173
    v_max3_f32 v55, v55, v174, v175
    v_max3_f32 v55, v55, v188, v189
    v_max3_f32 v55, v55, v190, v191
    v_mov_b32 v227, v55
    s_nop 1
    v_permlane16_swap_b32 v55, v227
    s_nop 1
    v_max_f32 v55, v55, v227
    v_mov_b32 v227, v55
    s_nop 1
    v_permlane32_swap_b32 v55, v227
    s_nop 1
    v_max_f32 v55, v55, v227
    v_add_f32 v55, 0x41400000, v55
    v_max_f32 v55, 0, v55
    v_sub_f32 v164, v164, v55
    v_sub_f32 v165, v165, v55
    v_sub_f32 v166, v166, v55
    v_sub_f32 v167, v167, v55
    v_sub_f32 v172, v172, v55
    v_sub_f32 v173, v173, v55
    v_sub_f32 v174, v174, v55
    v_sub_f32 v175, v175, v55
    v_sub_f32 v180, v180, v55
    v_sub_f32 v181, v181, v55
    v_sub_f32 v182, v182, v55
    v_sub_f32 v183, v183, v55
    v_sub_f32 v188, v188, v55
    v_sub_f32 v189, v189, v55
    v_sub_f32 v190, v190, v55
    v_sub_f32 v191, v191, v55
    v_sub_f32 v11, v11, v55
    v_exp_f32 v55, -v55
    s_nop 0
    v_mul_f32 v252, v252, v55
    v_accvgpr_read_b32 v224, a12
    v_accvgpr_read_b32 v225, a13
    v_accvgpr_read_b32 v226, a14
    v_accvgpr_read_b32 v227, a15
    v_mul_f32 v224, v224, v55
    v_mul_f32 v225, v225, v55
    v_mul_f32 v226, v226, v55
    v_mul_f32 v227, v227, v55
    v_accvgpr_write_b32 a12, v224
    v_accvgpr_write_b32 a13, v225
    v_accvgpr_write_b32 a14, v226
    v_accvgpr_write_b32 a15, v227
    v_accvgpr_read_b32 v224, a28
    v_accvgpr_read_b32 v225, a29
    v_accvgpr_read_b32 v226, a30
    v_accvgpr_read_b32 v227, a31
    v_mul_f32 v224, v224, v55
    v_mul_f32 v225, v225, v55
    v_mul_f32 v226, v226, v55
    v_mul_f32 v227, v227, v55
    v_accvgpr_write_b32 a28, v224
    v_accvgpr_write_b32 a29, v225
    v_accvgpr_write_b32 a30, v226
    v_accvgpr_write_b32 a31, v227
    v_accvgpr_read_b32 v224, a44
    v_accvgpr_read_b32 v225, a45
    v_accvgpr_read_b32 v226, a46
    v_accvgpr_read_b32 v227, a47
    v_mul_f32 v224, v224, v55
    v_mul_f32 v225, v225, v55
    v_mul_f32 v226, v226, v55
    v_mul_f32 v227, v227, v55
    v_accvgpr_write_b32 a44, v224
    v_accvgpr_write_b32 a45, v225
    v_accvgpr_write_b32 a46, v226
    v_accvgpr_write_b32 a47, v227
    v_accvgpr_read_b32 v224, a60
    v_accvgpr_read_b32 v225, a61
    v_accvgpr_read_b32 v226, a62
    v_accvgpr_read_b32 v227, a63
    v_mul_f32 v224, v224, v55
    v_mul_f32 v225, v225, v55
    v_mul_f32 v226, v226, v55
    v_mul_f32 v227, v227, v55
    v_accvgpr_write_b32 a60, v224
    v_accvgpr_write_b32 a61, v225
    v_accvgpr_write_b32 a62, v226
    v_accvgpr_write_b32 a63, v227
    v_accvgpr_read_b32 v224, a76
    v_accvgpr_read_b32 v225, a77
    v_accvgpr_read_b32 v226, a78
    v_accvgpr_read_b32 v227, a79
    v_mul_f32 v224, v224, v55
    v_mul_f32 v225, v225, v55
    v_mul_f32 v226, v226, v55
    v_mul_f32 v227, v227, v55
    v_accvgpr_write_b32 a76, v224
    v_accvgpr_write_b32 a77, v225
    v_accvgpr_write_b32 a78, v226
    v_accvgpr_write_b32 a79, v227
    v_accvgpr_read_b32 v224, a92
    v_accvgpr_read_b32 v225, a93
    v_accvgpr_read_b32 v226, a94
    v_accvgpr_read_b32 v227, a95
    v_mul_f32 v224, v224, v55
    v_mul_f32 v225, v225, v55
    v_mul_f32 v226, v226, v55
    v_mul_f32 v227, v227, v55
    v_accvgpr_write_b32 a92, v224
    v_accvgpr_write_b32 a93, v225
    v_accvgpr_write_b32 a94, v226
    v_accvgpr_write_b32 a95, v227
    v_accvgpr_read_b32 v224, a108
    v_accvgpr_read_b32 v225, a109
    v_accvgpr_read_b32 v226, a110
    v_accvgpr_read_b32 v227, a111
    v_mul_f32 v224, v224, v55
    v_mul_f32 v225, v225, v55
    v_mul_f32 v226, v226, v55
    v_mul_f32 v227, v227, v55
    v_accvgpr_write_b32 a108, v224
    v_accvgpr_write_b32 a109, v225
    v_accvgpr_write_b32 a110, v226
    v_accvgpr_write_b32 a111, v227
    v_accvgpr_read_b32 v224, a124
    v_accvgpr_read_b32 v225, a125
    v_accvgpr_read_b32 v226, a126
    v_accvgpr_read_b32 v227, a127
    v_mul_f32 v224, v224, v55
    v_mul_f32 v225, v225, v55
    v_mul_f32 v226, v226, v55
    v_mul_f32 v227, v227, v55
    v_accvgpr_write_b32 a124, v224
    v_accvgpr_write_b32 a125, v225
    v_accvgpr_write_b32 a126, v226
    v_accvgpr_write_b32 a127, v227
    v_exp_f32 v232, v164
    v_exp_f32 v233, v165
    v_exp_f32 v234, v166
    v_exp_f32 v235, v167
    s_nop 0
    v_cvt_pk_bf16_f32 v212, v232, v233
    v_cvt_pk_bf16_f32 v213, v234, v235
    v_exp_f32 v232, v180
    v_exp_f32 v233, v181
    v_exp_f32 v234, v182
    v_exp_f32 v235, v183
    s_nop 0
    v_cvt_pk_bf16_f32 v214, v232, v233
    v_cvt_pk_bf16_f32 v215, v234, v235
    v_exp_f32 v232, v172
    v_exp_f32 v233, v173
    v_exp_f32 v234, v174
    v_exp_f32 v235, v175
    s_nop 0
    v_cvt_pk_bf16_f32 v220, v232, v233
    v_cvt_pk_bf16_f32 v221, v234, v235
    v_exp_f32 v232, v188
    v_exp_f32 v233, v189
    v_exp_f32 v234, v190
    v_exp_f32 v235, v191
    s_nop 0
    v_cvt_pk_bf16_f32 v222, v232, v233
    v_cvt_pk_bf16_f32 v223, v234, v235
    s_nop 3
    s_setpc_b64 s[40:41]
code_end:
    s_endpgm
.section .rodata,"a"
.p2align 6
.amdhsa_kernel sequential_preLN__compressed_kv_cla__moe_arch_mod__prompt_kernel
  .amdhsa_next_free_vgpr 512
  .amdhsa_next_free_sgpr 102
  .amdhsa_accum_offset 256
  .amdhsa_group_segment_fixed_size 0
  .amdhsa_kernarg_size 112
  .amdhsa_user_sgpr_count 2
  .amdhsa_user_sgpr_kernarg_segment_ptr 1
  .amdhsa_system_sgpr_workgroup_id_x 1
.end_amdhsa_kernel
```

```asm
; @launch grid=(256,1,1) block=(256,1,1) lds=163840
.amdgcn_target "amdgcn-amd-amdhsa--gfx950"
.text
.globl sequential_preLN__compressed_kv_cla__moe_arch_mod__prompt_kernel
.p2align 8
.type sequential_preLN__compressed_kv_cla__moe_arch_mod__prompt_kernel,@function
sequential_preLN__compressed_kv_cla__moe_arch_mod__prompt_kernel:
    s_cmp_ge_u32 s2, 256
    s_cbranch_scc1 k12_end_1
    s_load_dwordx4 s[36:39], s[0:1], 0
    s_load_dwordx4 s[40:43], s[0:1], 24
    s_load_dwordx2 s[4:5], s[0:1], 16
    s_load_dwordx4 s[60:63], s[0:1], 96
    s_lshr_b32 s59, s2, 3
    s_lshl_b32 s58, s59, 4
    v_add_u32 v6, s58, v0
    v_cmp_gt_u32 vcc, 48, v0
    v_cmp_gt_u32 s[56:57], 64, v0
    s_nop 0
    v_cndmask_b32 v6, v6, v0, vcc
    s_getpc_b64 s[52:53]
pc_2:
    s_add_u32 s52, s52, k12_code0-pc_2
    s_addc_u32 s53, s53, 0
    v_lshlrev_b32 v58, 7, v6
    v_mov_b32 v59, s53
    v_add_co_u32 v58, vcc, s52, v58
    s_nop 1
    v_addc_co_u32 v59, vcc, 0, v59, vcc
k12_code0:
    s_mov_b64 exec, s[56:57]
    s_cbranch_execz k12_nocode_3
    global_load_dword v51, v[58:59], off
k12_nocode_3:
    s_mov_b64 exec, -1
    s_and_b32 s58, s2, 7
    s_lshr_b32 s59, s2, 3
    s_and_b32 s45, s59, 7
    s_lshr_b32 s57, s59, 3
    s_and_b32 s44, s57, 1
    s_lshl_b32 s52, s58, 1
    s_add_u32 s44, s44, s52
    s_lshr_b32 s57, s57, 1
    v_lshrrev_b32 v2, 6, v0
    v_and_b32 v3, 63, v0
    v_readfirstlane_b32 s30, v2
    v_lshlrev_b32 v1, 4, v3
    v_lshrrev_b32 v60, 5, v3
    v_lshl_add_u32 v60, v2, 1, v60
    v_and_b32 v61, 31, v3
    v_lshlrev_b32 v6, 11, v60
    v_lshl_add_u32 v62, v61, 4, v6
    s_lshl_b32 s52, s2, 14
    v_lshrrev_b32 v56, 3, v3
    v_and_b32 v57, 7, v3
    v_lshrrev_b32 v58, 1, v56
    v_xor_b32 v6, v57, v58
    v_xor_b32 v7, 4, v6
    v_lshl_add_u32 v58, v2, 6, v56
    v_lshlrev_b32 v58, 10, v58
    s_lshl_b32 s47, s45, 18
    v_add_u32 v58, s47, v58
    v_lshl_add_u32 v10, v6, 4, v58
    v_lshl_add_u32 v11, v7, 4, v58
    v_add_u32 v17, 54272, v11
    v_add_u32 v16, 47104, v10
    v_add_u32 v15, 39936, v11
    v_add_u32 v14, 32768, v10
    v_add_u32 v13, 21504, v11
    v_add_u32 v12, 14336, v10
    v_add_u32 v11, 7168, v11
    v_add_u32 v10, 0, v10
    s_lshl_b32 s48, s30, 13
    s_mov_b32 s49, 0
    s_mov_b32 s50, 0
    s_waitcnt lgkmcnt(0)
    s_mov_b32 s24, s36
    s_and_b32 s25, s37, 0xffff
    s_mov_b32 s26, 0x400000
    s_mov_b32 s27, 0x00020000
    s_mov_b32 s16, s38
    s_and_b32 s17, s39, 0xffff
    s_mov_b32 s18, 0x200000
    s_mov_b32 s19, 0x00020000
    s_cmp_eq_u32 s57, 0
    s_cselect_b32 s20, s40, s42
    s_cselect_b32 s21, s41, s43
    s_and_b32 s21, s21, 0xffff
    s_mov_b32 s22, 0x400000
    s_mov_b32 s23, 0x00020000
    v_lshlrev_b32 v6, 17, v1
    s_mov_b64 exec, 1
    buffer_load_dword v51, v62, s[24:27], s52 offen
    global_load_dword v51, v6, s[60:61]
    buffer_load_dword v51, v6, s[20:23], 0 offen
    global_load_dword v51, v6, s[62:63]
    global_load_dword v51, v6, s[4:5]
    s_mov_b64 exec, -1
    s_add_u32 m0, s48, 0
    s_nop 0
    buffer_load_dwordx4 v10, s[16:19], s49 offen offset:0 lds
    buffer_load_dwordx4 v11, s[16:19], s49 offen offset:1024 lds
    buffer_load_dwordx4 v12, s[16:19], s49 offen offset:2048 lds
    buffer_load_dwordx4 v13, s[16:19], s49 offen offset:3072 lds
    buffer_load_dwordx4 v[64:67], v62, s[24:27], s52 offen offset:0
    buffer_load_dwordx4 v[68:71], v62, s[24:27], s52 offen offset:512
    buffer_load_dwordx4 v[72:75], v62, s[24:27], s52 offen offset:1024
    buffer_load_dwordx4 v[76:79], v62, s[24:27], s52 offen offset:1536
    v_lshrrev_b32 v6, 5, v3
    v_bfe_u32 v7, v3, 1, 4
    v_and_b32 v59, 1, v3
    v_lshl_add_u32 v58, v2, 4, v6
    v_lshlrev_b32 v58, 13, v58
    v_lshl_add_u32 v58, v59, 4, v58
    s_lshl_b32 s47, s44, 9
    v_add_u32 v58, s47, v58
    v_xor_b32 v7, v7, v6
    v_xor_b32 v6, 0, v7
    v_lshl_add_u32 v6, v6, 5, v58
    v_add_u32 v18, 0, v6
    v_xor_b32 v6, 2, v7
    v_lshl_add_u32 v6, v6, 5, v58
    v_add_u32 v19, 15360, v6
    v_xor_b32 v6, 0, v7
    v_lshl_add_u32 v6, v6, 5, v58
    v_add_u32 v20, 30720, v6
    v_xor_b32 v6, 2, v7
    v_lshl_add_u32 v6, v6, 5, v58
    v_add_u32 v21, 46080, v6
    v_xor_b32 v6, 4, v7
    v_lshl_add_u32 v6, v6, 5, v58
    v_add_u32 v22, 65536, v6
    v_xor_b32 v6, 6, v7
    v_lshl_add_u32 v6, v6, 5, v58
    v_add_u32 v23, 80896, v6
    v_xor_b32 v6, 4, v7
    v_lshl_add_u32 v6, v6, 5, v58
    v_add_u32 v24, 96256, v6
    v_xor_b32 v6, 6, v7
    v_lshl_add_u32 v6, v6, 5, v58
    v_add_u32 v25, 111616, v6
    s_add_u32 m0, s48, 65536
    s_nop 0
    buffer_load_dwordx4 v18, s[20:23], s50 offen offset:0 lds
    buffer_load_dwordx4 v19, s[20:23], s50 offen offset:1024 lds
    buffer_load_dwordx4 v20, s[20:23], s50 offen offset:2048 lds
    buffer_load_dwordx4 v21, s[20:23], s50 offen offset:3072 lds
    s_mov_b64 s[6:7], s[62:63]
    s_add_u32 s8, s6, 0x0
    s_addc_u32 s9, s7, 0
    s_and_b32 s9, s9, 0xffff
    s_mov_b32 s10, 0x400000
    s_mov_b32 s11, 0x00020000
    s_mov_b32 s12, s4
    s_and_b32 s13, s5, 0xffff
    s_mov_b32 s14, 0x800000
    s_mov_b32 s15, 0x00020000
    s_add_u32 s32, s6, 0x1000000
    s_addc_u32 s33, s7, 0
    s_and_b32 s33, s33, 0xffff
    s_mov_b32 s34, 0x2000000
    s_mov_b32 s35, 0x00020000
    s_mov_b32 s24, s60
    s_and_b32 s25, s61, 0xffff
    s_mov_b32 s26, 0x100
    s_mov_b32 s27, 0x00020000
    s_lshl_b32 s28, s58, 2
    s_and_b32 s31, s59, 3
    s_add_u32 s28, s28, s31
    s_lshr_b32 s29, s59, 2
    s_lshl_b32 s42, s29, 7
    s_sub_u32 s43, 1920, s42
    s_lshl_b32 s31, s30, 4
    s_add_u32 s38, s42, s31
    s_add_u32 s39, s43, s31
    s_lshl_b32 s60, s30, 12
    s_mov_b32 s61, 0
    s_mov_b32 s62, 0
    s_lshl_b32 s47, s44, 1
    s_lshr_b32 s52, s30, 1
    s_add_u32 s47, s47, s52
    s_lshl_b32 s47, s47, 14
    s_lshl_b32 s52, s45, 1
    s_and_b32 s53, s30, 1
    s_add_u32 s52, s52, s53
    s_lshl_b32 s52, s52, 20
    s_add_u32 s47, s47, s52
    s_lshl_b32 s52, s57, 24
    s_add_u32 s47, s47, s52
    s_lshl_b32 s54, s44, 8
    s_lshr_b32 s55, s28, 1
    s_lshl_b32 s55, s55, 8
    s_and_b32 s53, s59, 3
    s_add_u32 s53, s53, 1
    s_cmp_eq_u32 s30, 0
    s_cselect_b32 s53, s53, -1
    s_cselect_b32 s46, 6, -1
    v_lshlrev_b32 v6, 13, v56
    v_lshl_add_u32 v50, v57, 7, v6
    s_lshl_b32 s56, s30, 5
    s_add_u32 s56, s56, s59
    s_lshl_b32 s56, s56, 16
    s_lshl_b32 s52, s58, 10
    s_add_u32 s56, s56, s52
    s_add_u32 s63, s30, 1
    v_mul_u32_u24 v6, 2064, v60
    v_lshl_add_u32 v6, v61, 4, v6
    v_add_u32 v54, 131072, v6
    v_mul_u32_u24 v7, 2064, v57
    v_lshl_add_u32 v7, v56, 4, v7
    v_lshl_add_u32 v7, v2, 9, v7
    v_add_u32 v55, 131072, v7
    v_lshrrev_b32 v7, 2, v56
    v_lshl_add_u32 v7, v2, 3, v7
    v_lshlrev_b32 v7, 17, v7
    v_and_b32 v6, 3, v56
    v_lshl_add_u32 v7, v6, 8, v7
    v_lshl_add_u32 v7, v57, 4, v7
    s_lshr_b32 s52, s2, 1
    s_lshl_b32 s52, s52, 10
    s_and_b32 s31, s2, 1
    s_lshl_b32 s31, s31, 7
    s_add_u32 s52, s52, s31
    v_add_u32 v53, s52, v7
    v_and_b32 v56, 15, v3
    v_lshrrev_b32 v57, 4, v3
    v_lshrrev_b32 v6, 1, v56
    v_xor_b32 v6, v6, v57
    v_and_b32 v7, 1, v2
    v_lshl_add_u32 v7, v7, 7, v56
    v_lshlrev_b32 v7, 7, v7
    v_lshl_add_u32 v26, v6, 4, v7
    v_xor_b32 v27, 64, v26
    v_lshrrev_b32 v6, 2, v56
    v_and_b32 v58, 1, v57
    v_lshl_add_u32 v58, v58, 2, v6
    v_lshl_add_u32 v59, v57, 3, v6
    v_and_b32 v63, 3, v3
    v_lshlrev_b32 v7, 9, v59
    v_lshrrev_b32 v6, 1, v2
    v_lshl_add_u32 v7, v6, 8, v7
    v_lshl_add_u32 v7, v63, 3, v7
    v_add_u32 v7, 65536, v7
    v_lshlrev_b32 v59, 8, v59
    v_lshl_add_u32 v59, v63, 3, v59
    v_add_u32 v59, 98304, v59
    v_xor_b32 v6, 0, v58
    v_lshl_add_u32 v28, v6, 5, v7
    v_lshl_add_u32 v42, v6, 5, v59
    v_xor_b32 v6, 1, v58
    v_lshl_add_u32 v29, v6, 5, v7
    v_lshl_add_u32 v43, v6, 5, v59
    v_xor_b32 v6, 2, v58
    v_lshl_add_u32 v30, v6, 5, v7
    v_lshl_add_u32 v44, v6, 5, v59
    v_xor_b32 v6, 3, v58
    v_lshl_add_u32 v31, v6, 5, v7
    v_lshl_add_u32 v45, v6, 5, v59
    v_xor_b32 v6, 4, v58
    v_lshl_add_u32 v32, v6, 5, v7
    v_lshl_add_u32 v46, v6, 5, v59
    v_xor_b32 v6, 5, v58
    v_lshl_add_u32 v33, v6, 5, v7
    v_lshl_add_u32 v47, v6, 5, v59
    v_xor_b32 v6, 6, v58
    v_lshl_add_u32 v34, v6, 5, v7
    v_lshl_add_u32 v48, v6, 5, v59
    v_xor_b32 v6, 7, v58
    v_lshl_add_u32 v35, v6, 5, v7
    v_lshl_add_u32 v49, v6, 5, v59
    s_lshl_b32 s31, s38, 6
    v_add_u32 v36, s31, v1
    s_lshl_b32 s31, s39, 6
    v_add_u32 v37, s31, v1
    v_bfe_u32 v6, v3, 1, 3
    v_and_b32 v7, 1, v3
    v_lshl_add_u32 v58, v2, 4, v57
    v_lshlrev_b32 v58, 13, v58
    v_lshl_add_u32 v58, v7, 4, v58
    s_lshl_b32 s31, s28, 8
    v_add_u32 v58, s31, v58
    v_xor_b32 v6, v6, v57
    v_xor_b32 v7, 0, v6
    v_lshl_add_u32 v7, v7, 5, v58
    v_add_u32 v38, 0, v7
    v_xor_b32 v7, 0, v6
    v_lshl_add_u32 v7, v7, 5, v58
    v_add_u32 v39, 31744, v7
    v_xor_b32 v7, 4, v6
    v_lshl_add_u32 v7, v7, 5, v58
    v_add_u32 v40, 63488, v7
    v_xor_b32 v7, 4, v6
    v_lshl_add_u32 v7, v7, 5, v58
    v_add_u32 v41, 95232, v7
    v_lshlrev_b32 v6, 2, v57
    v_sub_u32 v4, v56, v6
    v_mov_b32 v5, 0xff800000
    v_mov_b32 v8, 0
    v_mov_b32 v9, 1
    s_lshl_b32 s52, s59, 2
    s_add_u32 s52, s52, s30
    v_and_b32 v6, 1, v3
    v_lshl_add_u32 v6, s52, 1, v6
    s_getpc_b64 s[40:41]
pc_4:
    s_add_u32 s40, s40, k12_qcode-pc_4
    s_addc_u32 s41, s41, 0
    v_lshlrev_b32 v2, 7, v6
    v_mov_b32 v3, s41
    v_add_co_u32 v2, vcc, s40, v2
    s_nop 1
    v_addc_co_u32 v3, vcc, 0, v3, vcc
    v_mov_b32 v56, 0
    v_mov_b32 v57, 0
    v_mov_b32 v58, 0
    v_mov_b32 v59, 0
    s_nop 1
    v_mfma_f32_32x32x16_bf16 a[128:143], v[56:59], v[56:59], 0
    v_mfma_f32_32x32x16_bf16 a[144:159], v[56:59], v[56:59], 0
    v_mfma_f32_32x32x16_bf16 a[160:175], v[56:59], v[56:59], 0
    v_mfma_f32_32x32x16_bf16 a[176:191], v[56:59], v[56:59], 0
    v_mfma_f32_32x32x16_bf16 v[128:143], v[56:59], v[56:59], 0
    v_mfma_f32_32x32x16_bf16 v[144:159], v[56:59], v[56:59], 0
    v_mfma_f32_32x32x16_bf16 v[160:175], v[56:59], v[56:59], 0
    v_mfma_f32_32x32x16_bf16 v[176:191], v[56:59], v[56:59], 0
    v_mfma_f32_32x32x16_bf16 v[192:207], v[56:59], v[56:59], 0
    v_mfma_f32_32x32x16_bf16 v[208:223], v[56:59], v[56:59], 0
    v_mfma_f32_32x32x16_bf16 v[224:239], v[56:59], v[56:59], 0
    v_mfma_f32_32x32x16_bf16 v[240:255], v[56:59], v[56:59], 0
    s_add_u32 m0, s48, 4096
    s_nop 0
    buffer_load_dwordx4 v14, s[16:19], s49 offen offset:0 lds
    buffer_load_dwordx4 v15, s[16:19], s49 offen offset:1024 lds
    buffer_load_dwordx4 v16, s[16:19], s49 offen offset:2048 lds
    buffer_load_dwordx4 v17, s[16:19], s49 offen offset:3072 lds
    s_add_u32 s49, s49, 128
    s_add_u32 m0, s48, 69632
    s_nop 0
    buffer_load_dwordx4 v22, s[20:23], s50 offen offset:0 lds
    buffer_load_dwordx4 v23, s[20:23], s50 offen offset:1024 lds
    buffer_load_dwordx4 v24, s[20:23], s50 offen offset:2048 lds
    buffer_load_dwordx4 v25, s[20:23], s50 offen offset:3072 lds
    s_add_u32 s50, s50, 0x80000
    s_waitcnt vmcnt(12)
    v_lshlrev_b32 v80, 16, v64
    v_and_b32 v81, 0xffff0000, v64
    v_lshlrev_b32 v82, 16, v65
    v_and_b32 v83, 0xffff0000, v65
    v_lshlrev_b32 v84, 16, v66
    v_and_b32 v85, 0xffff0000, v66
    v_lshlrev_b32 v86, 16, v67
    v_and_b32 v87, 0xffff0000, v67
    v_lshlrev_b32 v88, 16, v68
    v_and_b32 v89, 0xffff0000, v68
    v_lshlrev_b32 v90, 16, v69
    v_and_b32 v91, 0xffff0000, v69
    v_lshlrev_b32 v92, 16, v70
    v_and_b32 v93, 0xffff0000, v70
    v_lshlrev_b32 v94, 16, v71
    v_and_b32 v95, 0xffff0000, v71
    v_lshlrev_b32 v96, 16, v72
    v_and_b32 v97, 0xffff0000, v72
    v_lshlrev_b32 v98, 16, v73
    v_and_b32 v99, 0xffff0000, v73
    v_lshlrev_b32 v100, 16, v74
    v_and_b32 v101, 0xffff0000, v74
    v_lshlrev_b32 v102, 16, v75
    v_and_b32 v103, 0xffff0000, v75
    v_lshlrev_b32 v104, 16, v76
    v_and_b32 v105, 0xffff0000, v76
    v_lshlrev_b32 v106, 16, v77
    v_and_b32 v107, 0xffff0000, v77
    v_lshlrev_b32 v108, 16, v78
    v_and_b32 v109, 0xffff0000, v78
    v_lshlrev_b32 v110, 16, v79
    v_and_b32 v111, 0xffff0000, v79
    v_pk_add_f32 v[112:113], v[80:81], v[82:83]
    v_pk_add_f32 v[114:115], v[84:85], v[86:87]
    v_pk_add_f32 v[112:113], v[112:113], v[88:89]
    v_pk_add_f32 v[114:115], v[114:115], v[90:91]
    v_pk_add_f32 v[112:113], v[112:113], v[92:93]
    v_pk_add_f32 v[114:115], v[114:115], v[94:95]
    v_pk_add_f32 v[112:113], v[112:113], v[96:97]
    v_pk_add_f32 v[114:115], v[114:115], v[98:99]
    v_pk_add_f32 v[112:113], v[112:113], v[100:101]
    v_pk_add_f32 v[114:115], v[114:115], v[102:103]
    v_pk_add_f32 v[112:113], v[112:113], v[104:105]
    v_pk_add_f32 v[114:115], v[114:115], v[106:107]
    s_add_u32 m0, s48, 32768
    s_nop 0
    buffer_load_dwordx4 v10, s[16:19], s49 offen offset:0 lds
    buffer_load_dwordx4 v11, s[16:19], s49 offen offset:1024 lds
    buffer_load_dwordx4 v12, s[16:19], s49 offen offset:2048 lds
    buffer_load_dwordx4 v13, s[16:19], s49 offen offset:3072 lds
    v_pk_add_f32 v[112:113], v[112:113], v[108:109]
    v_pk_add_f32 v[114:115], v[114:115], v[110:111]
    v_pk_add_f32 v[112:113], v[112:113], v[114:115]
    v_add_f32 v112, v112, v113
    s_nop 1
    v_add_f32_dpp v112, v112, v112 quad_perm:[1,0,3,2] row_mask:0xf bank_mask:0xf
    s_nop 1
    v_add_f32_dpp v112, v112, v112 quad_perm:[2,3,0,1] row_mask:0xf bank_mask:0xf
    s_nop 1
    v_add_f32_dpp v112, v112, v112 row_half_mirror row_mask:0xf bank_mask:0xf
    s_nop 1
    v_add_f32_dpp v112, v112, v112 row_mirror row_mask:0xf bank_mask:0xf
    v_mov_b32 v114, v112
    s_nop 1
    v_permlane16_swap_b32 v112, v114
    s_nop 1
    v_add_f32 v112, v112, v114
    v_mul_f32 v112, 0xba800000, v112
    v_mov_b32 v113, v112
    v_pk_add_f32 v[114:115], v[80:81], v[112:113]
    v_pk_add_f32 v[118:119], v[82:83], v[112:113]
    v_pk_mul_f32 v[116:117], v[114:115], v[114:115]
    v_pk_fma_f32 v[116:117], v[118:119], v[118:119], v[116:117]
    v_pk_add_f32 v[114:115], v[84:85], v[112:113]
    v_pk_add_f32 v[118:119], v[86:87], v[112:113]
    v_pk_fma_f32 v[116:117], v[114:115], v[114:115], v[116:117]
    v_pk_fma_f32 v[116:117], v[118:119], v[118:119], v[116:117]
    v_pk_add_f32 v[114:115], v[88:89], v[112:113]
    v_pk_add_f32 v[118:119], v[90:91], v[112:113]
    v_pk_fma_f32 v[116:117], v[114:115], v[114:115], v[116:117]
    v_pk_fma_f32 v[116:117], v[118:119], v[118:119], v[116:117]
    v_pk_add_f32 v[114:115], v[92:93], v[112:113]
    v_pk_add_f32 v[118:119], v[94:95], v[112:113]
    v_pk_fma_f32 v[116:117], v[114:115], v[114:115], v[116:117]
    v_pk_fma_f32 v[116:117], v[118:119], v[118:119], v[116:117]
    v_pk_add_f32 v[114:115], v[96:97], v[112:113]
    v_pk_add_f32 v[118:119], v[98:99], v[112:113]
    v_pk_fma_f32 v[116:117], v[114:115], v[114:115], v[116:117]
    v_pk_fma_f32 v[116:117], v[118:119], v[118:119], v[116:117]
    v_pk_add_f32 v[114:115], v[100:101], v[112:113]
    v_pk_add_f32 v[118:119], v[102:103], v[112:113]
    v_pk_fma_f32 v[116:117], v[114:115], v[114:115], v[116:117]
    v_pk_fma_f32 v[116:117], v[118:119], v[118:119], v[116:117]
    v_pk_add_f32 v[114:115], v[104:105], v[112:113]
    s_add_u32 m0, s48, 98304
    s_nop 0
    buffer_load_dwordx4 v18, s[20:23], s50 offen offset:0 lds
    buffer_load_dwordx4 v19, s[20:23], s50 offen offset:1024 lds
    buffer_load_dwordx4 v20, s[20:23], s50 offen offset:2048 lds
    buffer_load_dwordx4 v21, s[20:23], s50 offen offset:3072 lds
    v_pk_add_f32 v[118:119], v[106:107], v[112:113]
    v_pk_fma_f32 v[116:117], v[114:115], v[114:115], v[116:117]
    v_pk_fma_f32 v[116:117], v[118:119], v[118:119], v[116:117]
    v_pk_add_f32 v[114:115], v[108:109], v[112:113]
    v_pk_add_f32 v[118:119], v[110:111], v[112:113]
    v_pk_fma_f32 v[116:117], v[114:115], v[114:115], v[116:117]
    v_pk_fma_f32 v[116:117], v[118:119], v[118:119], v[116:117]
    v_add_f32 v116, v116, v117
    s_nop 1
    v_add_f32_dpp v116, v116, v116 quad_perm:[1,0,3,2] row_mask:0xf bank_mask:0xf
    s_nop 1
    v_add_f32_dpp v116, v116, v116 quad_perm:[2,3,0,1] row_mask:0xf bank_mask:0xf
    s_nop 1
    v_add_f32_dpp v116, v116, v116 row_half_mirror row_mask:0xf bank_mask:0xf
    s_nop 1
    v_add_f32_dpp v116, v116, v116 row_mirror row_mask:0xf bank_mask:0xf
    v_mov_b32 v114, v116
    s_nop 1
    v_permlane16_swap_b32 v116, v114
    s_nop 1
    v_add_f32 v116, v116, v114
    v_mul_f32 v116, 0x3a800000, v116
    v_cvt_pk_bf16_f32 v118, v112, v116
    v_and_b32 v116, 0xffff0000, v118
    v_lshlrev_b32 v118, 16, v118
    v_add_f32 v116, 0x3727c5ac, v116
    v_mov_b32 v119, v118
    v_cvt_pk_bf16_f32 v116, v116, v116
    v_and_b32 v116, 0xffff0000, v116
    v_sqrt_f32 v116, v116
    v_pk_add_f32 v[80:81], v[80:81], v[118:119]
    v_pk_add_f32 v[82:83], v[82:83], v[118:119]
    v_pk_add_f32 v[84:85], v[84:85], v[118:119]
    v_pk_add_f32 v[86:87], v[86:87], v[118:119]
    v_pk_add_f32 v[88:89], v[88:89], v[118:119]
    v_pk_add_f32 v[90:91], v[90:91], v[118:119]
    v_pk_add_f32 v[92:93], v[92:93], v[118:119]
    v_pk_add_f32 v[94:95], v[94:95], v[118:119]
    v_pk_add_f32 v[96:97], v[96:97], v[118:119]
    v_pk_add_f32 v[98:99], v[98:99], v[118:119]
    v_pk_add_f32 v[100:101], v[100:101], v[118:119]
    v_pk_add_f32 v[102:103], v[102:103], v[118:119]
    v_pk_add_f32 v[104:105], v[104:105], v[118:119]
    s_add_u32 m0, s48, 36864
    s_nop 0
    buffer_load_dwordx4 v14, s[16:19], s49 offen offset:0 lds
    buffer_load_dwordx4 v15, s[16:19], s49 offen offset:1024 lds
    buffer_load_dwordx4 v16, s[16:19], s49 offen offset:2048 lds
    buffer_load_dwordx4 v17, s[16:19], s49 offen offset:3072 lds
    s_add_u32 s49, s49, 128
    v_pk_add_f32 v[106:107], v[106:107], v[118:119]
    v_pk_add_f32 v[108:109], v[108:109], v[118:119]
    v_pk_add_f32 v[110:111], v[110:111], v[118:119]
    v_cvt_pk_bf16_f32 v116, v116, v116
    v_and_b32 v116, 0xffff0000, v116
    v_rcp_f32 v116, v116
    v_cvt_pk_bf16_f32 v64, v80, v81
    v_cvt_pk_bf16_f32 v65, v82, v83
    v_cvt_pk_bf16_f32 v66, v84, v85
    v_cvt_pk_bf16_f32 v67, v86, v87
    v_cvt_pk_bf16_f32 v68, v88, v89
    v_cvt_pk_bf16_f32 v69, v90, v91
    v_cvt_pk_bf16_f32 v70, v92, v93
    v_cvt_pk_bf16_f32 v71, v94, v95
    v_cvt_pk_bf16_f32 v72, v96, v97
    v_cvt_pk_bf16_f32 v73, v98, v99
    v_cvt_pk_bf16_f32 v74, v100, v101
    v_cvt_pk_bf16_f32 v75, v102, v103
    v_cvt_pk_bf16_f32 v76, v104, v105
    v_cvt_pk_bf16_f32 v77, v106, v107
    v_cvt_pk_bf16_f32 v78, v108, v109
    v_cvt_pk_bf16_f32 v79, v110, v111
    v_mov_b32 v117, v116
    v_lshlrev_b32 v80, 16, v64
    v_and_b32 v81, 0xffff0000, v64
    v_lshlrev_b32 v82, 16, v65
    v_and_b32 v83, 0xffff0000, v65
    v_lshlrev_b32 v84, 16, v66
    v_and_b32 v85, 0xffff0000, v66
    v_lshlrev_b32 v86, 16, v67
    v_and_b32 v87, 0xffff0000, v67
    v_lshlrev_b32 v88, 16, v68
    v_and_b32 v89, 0xffff0000, v68
    v_lshlrev_b32 v90, 16, v69
    v_and_b32 v91, 0xffff0000, v69
    v_lshlrev_b32 v92, 16, v70
    v_and_b32 v93, 0xffff0000, v70
    v_lshlrev_b32 v94, 16, v71
    v_and_b32 v95, 0xffff0000, v71
    v_lshlrev_b32 v96, 16, v72
    v_and_b32 v97, 0xffff0000, v72
    v_lshlrev_b32 v98, 16, v73
    v_and_b32 v99, 0xffff0000, v73
    v_lshlrev_b32 v100, 16, v74
    s_add_u32 m0, s48, 102400
    s_nop 0
    buffer_load_dwordx4 v22, s[20:23], s50 offen offset:0 lds
    buffer_load_dwordx4 v23, s[20:23], s50 offen offset:1024 lds
    buffer_load_dwordx4 v24, s[20:23], s50 offen offset:2048 lds
    buffer_load_dwordx4 v25, s[20:23], s50 offen offset:3072 lds
    s_add_u32 s50, s50, 0x80000
    v_and_b32 v101, 0xffff0000, v74
    v_lshlrev_b32 v102, 16, v75
    v_and_b32 v103, 0xffff0000, v75
    v_lshlrev_b32 v104, 16, v76
    v_and_b32 v105, 0xffff0000, v76
    v_lshlrev_b32 v106, 16, v77
    v_and_b32 v107, 0xffff0000, v77
    v_lshlrev_b32 v108, 16, v78
    v_and_b32 v109, 0xffff0000, v78
    v_lshlrev_b32 v110, 16, v79
    v_and_b32 v111, 0xffff0000, v79
    v_pk_mul_f32 v[80:81], v[80:81], v[116:117]
    v_pk_mul_f32 v[82:83], v[82:83], v[116:117]
    v_pk_mul_f32 v[84:85], v[84:85], v[116:117]
    v_pk_mul_f32 v[86:87], v[86:87], v[116:117]
    v_pk_mul_f32 v[88:89], v[88:89], v[116:117]
    v_pk_mul_f32 v[90:91], v[90:91], v[116:117]
    v_pk_mul_f32 v[92:93], v[92:93], v[116:117]
    v_pk_mul_f32 v[94:95], v[94:95], v[116:117]
    v_pk_mul_f32 v[96:97], v[96:97], v[116:117]
    v_pk_mul_f32 v[98:99], v[98:99], v[116:117]
    v_pk_mul_f32 v[100:101], v[100:101], v[116:117]
    v_pk_mul_f32 v[102:103], v[102:103], v[116:117]
    v_pk_mul_f32 v[104:105], v[104:105], v[116:117]
    v_pk_mul_f32 v[106:107], v[106:107], v[116:117]
    v_pk_mul_f32 v[108:109], v[108:109], v[116:117]
    v_pk_mul_f32 v[110:111], v[110:111], v[116:117]
    v_cvt_pk_bf16_f32 v64, v80, v81
    v_cvt_pk_bf16_f32 v65, v82, v83
    v_cvt_pk_bf16_f32 v66, v84, v85
    v_cvt_pk_bf16_f32 v67, v86, v87
    v_cvt_pk_bf16_f32 v68, v88, v89
    v_cvt_pk_bf16_f32 v69, v90, v91
    v_cvt_pk_bf16_f32 v70, v92, v93
    v_cvt_pk_bf16_f32 v71, v94, v95
    v_cvt_pk_bf16_f32 v72, v96, v97
    v_cvt_pk_bf16_f32 v73, v98, v99
    v_cvt_pk_bf16_f32 v74, v100, v101
    v_cvt_pk_bf16_f32 v75, v102, v103
    v_cvt_pk_bf16_f32 v76, v104, v105
    v_cvt_pk_bf16_f32 v77, v106, v107
    v_cvt_pk_bf16_f32 v78, v108, v109
    v_cvt_pk_bf16_f32 v79, v110, v111
    ds_write_b128 v54, v[64:67] offset:0
    ds_write_b128 v54, v[68:71] offset:512
    ds_write_b128 v54, v[72:75] offset:1024
    ds_write_b128 v54, v[76:79] offset:1536
    s_waitcnt vmcnt(16) lgkmcnt(0)
    s_barrier
    ds_read_b128 a[64:67], v55 offset:0
    ds_read_b128 a[68:71], v55 offset:128
    ds_read_b128 a[72:75], v55 offset:256
    ds_read_b128 a[76:79], v55 offset:384
    v_add_u32 v54, 4096, v36
    v_add_u32 v55, 4096, v37
    v_mfma_f32_32x32x16_bf16 v[64:79], v[56:59], v[56:59], 0
    v_mfma_f32_32x32x16_bf16 v[80:95], v[56:59], v[56:59], 0
    v_mfma_f32_32x32x16_bf16 v[96:111], v[56:59], v[56:59], 0
    v_mfma_f32_32x32x16_bf16 v[112:127], v[56:59], v[56:59], 0
    s_cmp_ge_u32 s2, 22
    s_cbranch_scc1 k12_nostat_5
    s_lshl_b32 s52, s2, 12
    s_add_u32 s52, s52, 0x3800000
    s_mov_b32 s34, -1
    v_lshlrev_b32 v6, 4, v0
    buffer_store_dwordx4 v[56:59], v6, s[32:35], s52 offen sc1
    s_mov_b32 s34, 0x2000000
k12_nostat_5:
    ds_read_b128 a[192:195], v26 offset:0
    ds_read_b64_tr_b16 a[0:1], v28 offset:0
    ds_read_b128 a[196:199], v27 offset:0
    ds_read_b64_tr_b16 a[2:3], v28 offset:2048
    ds_read_b128 a[200:203], v26 offset:2048
    ds_read_b64_tr_b16 a[4:5], v28 offset:16384
    ds_read_b128 a[204:207], v27 offset:2048
    ds_read_b64_tr_b16 a[6:7], v28 offset:18432
    ds_read_b128 a[208:211], v26 offset:4096
    ds_read_b64_tr_b16 a[8:9], v29 offset:0
    ds_read_b128 a[212:215], v27 offset:4096
    ds_read_b64_tr_b16 a[10:11], v29 offset:2048
    ds_read_b128 a[216:219], v26 offset:6144
    ds_read_b64_tr_b16 a[12:13], v29 offset:16384
    ds_read_b128 a[220:223], v27 offset:6144
    ds_read_b64_tr_b16 a[14:15], v29 offset:18432
    ds_read_b128 a[224:227], v26 offset:8192
    ds_read_b64_tr_b16 a[16:17], v30 offset:0
    ds_read_b128 a[228:231], v27 offset:8192
    ds_read_b64_tr_b16 a[18:19], v30 offset:2048
    ds_read_b128 a[232:235], v26 offset:10240
    ds_read_b64_tr_b16 a[20:21], v30 offset:16384
    ds_read_b128 a[236:239], v27 offset:10240
    ds_read_b64_tr_b16 a[22:23], v30 offset:18432
    ds_read_b128 a[240:243], v26 offset:12288
    ds_read_b64_tr_b16 a[24:25], v31 offset:0
    ds_read_b128 a[244:247], v27 offset:12288
    ds_read_b64_tr_b16 a[26:27], v31 offset:2048
    ds_read_b128 a[248:251], v26 offset:14336
    ds_read_b64_tr_b16 a[28:29], v31 offset:16384
    ds_read_b128 a[252:255], v27 offset:14336
    ds_read_b64_tr_b16 a[30:31], v31 offset:18432
    s_mov_b32 s51, 0
    s_waitcnt lgkmcnt(15)
    s_mov_b32 s52, 0
    buffer_store_dwordx4 a[64:67], v53, s[8:11], s52 offen sc1
    s_mov_b32 s52, 262144
    buffer_store_dwordx4 a[68:71], v53, s[8:11], s52 offen sc1
    s_mov_b32 s52, 524288
    buffer_store_dwordx4 a[72:75], v53, s[8:11], s52 offen sc1
    s_mov_b32 s52, 786432
    buffer_store_dwordx4 a[76:79], v53, s[8:11], s52 offen sc1
    s_waitcnt lgkmcnt(0)
    s_cmp_lg_u32 s57, 0
    s_cbranch_scc1 k12_v_6
k12_loop_8:
    v_mfma_f32_16x16x32_bf16 v[64:67], a[0:3], a[192:195], v[64:67]
    v_mfma_f32_16x16x32_bf16 v[64:67], a[4:7], a[196:199], v[64:67]
    ds_read_b64_tr_b16 a[32:33], v32 offset:0
    v_mfma_f32_16x16x32_bf16 v[80:83], a[4:7], a[204:207], v[80:83]
    v_mfma_f32_16x16x32_bf16 v[80:83], a[0:3], a[200:203], v[80:83]
    ds_read_b64_tr_b16 a[34:35], v32 offset:2048
    v_mfma_f32_16x16x32_bf16 v[96:99], a[0:3], a[208:211], v[96:99]
    s_cmp_eq_u32 s51, s46
    s_cbranch_scc1 k12_ool_10
k12_oolret_11:
    v_mfma_f32_16x16x32_bf16 v[96:99], a[4:7], a[212:215], v[96:99]
    v_mfma_f32_16x16x32_bf16 v[112:115], a[4:7], a[220:223], v[112:115]
    ds_read_b64_tr_b16 a[36:37], v32 offset:16384
    v_mfma_f32_16x16x32_bf16 v[112:115], a[0:3], a[216:219], v[112:115]
    v_mfma_f32_16x16x32_bf16 v[128:131], a[0:3], a[224:227], v[128:131]
    v_mfma_f32_16x16x32_bf16 v[128:131], a[4:7], a[228:231], v[128:131]
    ds_read_b64_tr_b16 a[38:39], v32 offset:18432
    v_mfma_f32_16x16x32_bf16 v[144:147], a[4:7], a[236:239], v[144:147]
    v_mfma_f32_16x16x32_bf16 v[144:147], a[0:3], a[232:235], v[144:147]
    v_mfma_f32_16x16x32_bf16 a[128:131], a[0:3], a[240:243], a[128:131]
    ds_read_b64_tr_b16 a[40:41], v33 offset:0
    v_mfma_f32_16x16x32_bf16 a[128:131], a[4:7], a[244:247], a[128:131]
    v_mfma_f32_16x16x32_bf16 a[160:163], a[4:7], a[252:255], a[160:163]
    v_mfma_f32_16x16x32_bf16 a[160:163], a[0:3], a[248:251], a[160:163]
    ds_read_b64_tr_b16 a[42:43], v33 offset:2048
    v_mfma_f32_16x16x32_bf16 a[164:167], a[8:11], a[248:251], a[164:167]
    v_mfma_f32_16x16x32_bf16 a[164:167], a[12:15], a[252:255], a[164:167]
    v_mfma_f32_16x16x32_bf16 a[132:135], a[12:15], a[244:247], a[132:135]
    ds_read_b64_tr_b16 a[44:45], v33 offset:16384
    v_mfma_f32_16x16x32_bf16 a[132:135], a[8:11], a[240:243], a[132:135]
    v_mfma_f32_16x16x32_bf16 v[240:243], a[8:11], a[232:235], v[240:243]
    v_mfma_f32_16x16x32_bf16 v[240:243], a[12:15], a[236:239], v[240:243]
    ds_read_b64_tr_b16 a[46:47], v33 offset:18432
    v_mfma_f32_16x16x32_bf16 v[224:227], a[12:15], a[228:231], v[224:227]
    v_mfma_f32_16x16x32_bf16 v[224:227], a[8:11], a[224:227], v[224:227]
    ds_read_b64_tr_b16 a[48:49], v34 offset:0
    v_mfma_f32_16x16x32_bf16 v[208:211], a[8:11], a[216:219], v[208:211]
    v_mfma_f32_16x16x32_bf16 v[208:211], a[12:15], a[220:223], v[208:211]
    v_mfma_f32_16x16x32_bf16 v[192:195], a[12:15], a[212:215], v[192:195]
    ds_read_b64_tr_b16 a[50:51], v34 offset:2048
    v_mfma_f32_16x16x32_bf16 v[192:195], a[8:11], a[208:211], v[192:195]
    v_mfma_f32_16x16x32_bf16 v[176:179], a[8:11], a[200:203], v[176:179]
    v_mfma_f32_16x16x32_bf16 v[176:179], a[12:15], a[204:207], v[176:179]
    ds_read_b64_tr_b16 a[52:53], v34 offset:16384
    v_mfma_f32_16x16x32_bf16 v[160:163], a[12:15], a[196:199], v[160:163]
    v_mfma_f32_16x16x32_bf16 v[160:163], a[8:11], a[192:195], v[160:163]
    v_mfma_f32_16x16x32_bf16 v[68:71], a[16:19], a[192:195], v[68:71]
    ds_read_b64_tr_b16 a[54:55], v34 offset:18432
    v_mfma_f32_16x16x32_bf16 v[68:71], a[20:23], a[196:199], v[68:71]
    v_mfma_f32_16x16x32_bf16 v[84:87], a[20:23], a[204:207], v[84:87]
    v_mfma_f32_16x16x32_bf16 v[84:87], a[16:19], a[200:203], v[84:87]
    ds_read_b64_tr_b16 a[56:57], v35 offset:0
    v_mfma_f32_16x16x32_bf16 v[100:103], a[16:19], a[208:211], v[100:103]
    v_mfma_f32_16x16x32_bf16 v[100:103], a[20:23], a[212:215], v[100:103]
    v_mfma_f32_16x16x32_bf16 v[116:119], a[20:23], a[220:223], v[116:119]
    ds_read_b64_tr_b16 a[58:59], v35 offset:2048
    v_mfma_f32_16x16x32_bf16 v[116:119], a[16:19], a[216:219], v[116:119]
    v_mfma_f32_16x16x32_bf16 v[132:135], a[16:19], a[224:227], v[132:135]
    v_mfma_f32_16x16x32_bf16 v[132:135], a[20:23], a[228:231], v[132:135]
    ds_read_b64_tr_b16 a[60:61], v35 offset:16384
    v_mfma_f32_16x16x32_bf16 v[148:151], a[20:23], a[236:239], v[148:151]
    v_mfma_f32_16x16x32_bf16 v[148:151], a[16:19], a[232:235], v[148:151]
    v_mfma_f32_16x16x32_bf16 a[136:139], a[16:19], a[240:243], a[136:139]
    ds_read_b64_tr_b16 a[62:63], v35 offset:18432
    v_mfma_f32_16x16x32_bf16 a[136:139], a[20:23], a[244:247], a[136:139]
    v_mfma_f32_16x16x32_bf16 a[168:171], a[20:23], a[252:255], a[168:171]
    v_mfma_f32_16x16x32_bf16 a[168:171], a[16:19], a[248:251], a[168:171]
    v_mfma_f32_16x16x32_bf16 a[172:175], a[24:27], a[248:251], a[172:175]
    v_mfma_f32_16x16x32_bf16 a[172:175], a[28:31], a[252:255], a[172:175]
    v_mfma_f32_16x16x32_bf16 a[140:143], a[28:31], a[244:247], a[140:143]
    v_mfma_f32_16x16x32_bf16 a[140:143], a[24:27], a[240:243], a[140:143]
    v_mfma_f32_16x16x32_bf16 v[244:247], a[24:27], a[232:235], v[244:247]
    v_mfma_f32_16x16x32_bf16 v[244:247], a[28:31], a[236:239], v[244:247]
    v_mfma_f32_16x16x32_bf16 v[228:231], a[28:31], a[228:231], v[228:231]
    v_mfma_f32_16x16x32_bf16 v[228:231], a[24:27], a[224:227], v[228:231]
    v_mfma_f32_16x16x32_bf16 v[212:215], a[24:27], a[216:219], v[212:215]
    v_mfma_f32_16x16x32_bf16 v[212:215], a[28:31], a[220:223], v[212:215]
    v_mfma_f32_16x16x32_bf16 v[196:199], a[28:31], a[212:215], v[196:199]
    v_mfma_f32_16x16x32_bf16 v[196:199], a[24:27], a[208:211], v[196:199]
    v_mfma_f32_16x16x32_bf16 v[180:183], a[24:27], a[200:203], v[180:183]
    v_mfma_f32_16x16x32_bf16 v[180:183], a[28:31], a[204:207], v[180:183]
    v_mfma_f32_16x16x32_bf16 v[164:167], a[28:31], a[196:199], v[164:167]
    v_mfma_f32_16x16x32_bf16 v[164:167], a[24:27], a[192:195], v[164:167]
    s_waitcnt vmcnt(0) lgkmcnt(0)
    s_cmp_eq_u32 s51, s46
    s_cbranch_scc1 k12_ool_14
k12_oolret_15:
    s_barrier
    v_mfma_f32_16x16x32_bf16 v[72:75], a[32:35], a[192:195], v[72:75]
    s_cmp_ge_u32 s49, 1024
    s_cselect_b32 s18, 0, s18
    s_cselect_b32 s22, 0, s22
    v_mfma_f32_16x16x32_bf16 v[72:75], a[36:39], a[196:199], v[72:75]
    s_add_u32 m0, s48, 0
    ds_read_b128 a[64:67], v26 offset:32768
    v_mfma_f32_16x16x32_bf16 v[88:91], a[36:39], a[204:207], v[88:91]
    buffer_load_dwordx4 v10, s[16:19], s49 offen offset:0 lds
    ds_read_b64_tr_b16 a[0:1], v28 offset:32768
    v_mfma_f32_16x16x32_bf16 v[88:91], a[32:35], a[200:203], v[88:91]
    ds_read_b128 a[68:71], v27 offset:32768
    v_mfma_f32_16x16x32_bf16 v[104:107], a[32:35], a[208:211], v[104:107]
    buffer_load_dwordx4 v11, s[16:19], s49 offen offset:1024 lds
    v_mfma_f32_16x16x32_bf16 v[104:107], a[36:39], a[212:215], v[104:107]
    ds_read_b64_tr_b16 a[2:3], v28 offset:34816
    v_mfma_f32_16x16x32_bf16 v[120:123], a[36:39], a[220:223], v[120:123]
    v_mfma_f32_16x16x32_bf16 v[120:123], a[32:35], a[216:219], v[120:123]
    ds_read_b128 a[72:75], v26 offset:34816
    v_mfma_f32_16x16x32_bf16 v[136:139], a[32:35], a[224:227], v[136:139]
    buffer_load_dwordx4 v12, s[16:19], s49 offen offset:2048 lds
    ds_read_b64_tr_b16 a[4:5], v28 offset:49152
    v_mfma_f32_16x16x32_bf16 v[136:139], a[36:39], a[228:231], v[136:139]
    v_mfma_f32_16x16x32_bf16 v[152:155], a[36:39], a[236:239], v[152:155]
    ds_read_b128 a[76:79], v27 offset:34816
    v_mfma_f32_16x16x32_bf16 v[152:155], a[32:35], a[232:235], v[152:155]
    buffer_load_dwordx4 v13, s[16:19], s49 offen offset:3072 lds
    v_mfma_f32_16x16x32_bf16 a[144:147], a[32:35], a[240:243], a[144:147]
    ds_read_b64_tr_b16 a[6:7], v28 offset:51200
    v_mfma_f32_16x16x32_bf16 a[144:147], a[36:39], a[244:247], a[144:147]
    s_add_u32 m0, s48, 4096
    ds_read_b128 a[80:83], v26 offset:36864
    v_mfma_f32_16x16x32_bf16 a[176:179], a[36:39], a[252:255], a[176:179]
    v_mfma_f32_16x16x32_bf16 a[176:179], a[32:35], a[248:251], a[176:179]
    buffer_load_dwordx4 v14, s[16:19], s49 offen offset:0 lds
    ds_read_b64_tr_b16 a[8:9], v29 offset:32768
    v_mfma_f32_16x16x32_bf16 a[180:183], a[40:43], a[248:251], a[180:183]
    v_mfma_f32_16x16x32_bf16 a[180:183], a[44:47], a[252:255], a[180:183]
    ds_read_b128 a[84:87], v27 offset:36864
    v_mfma_f32_16x16x32_bf16 a[148:151], a[44:47], a[244:247], a[148:151]
    buffer_load_dwordx4 v15, s[16:19], s49 offen offset:1024 lds
    ds_read_b64_tr_b16 a[10:11], v29 offset:34816
    v_mfma_f32_16x16x32_bf16 a[148:151], a[40:43], a[240:243], a[148:151]
    v_mfma_f32_16x16x32_bf16 v[248:251], a[40:43], a[232:235], v[248:251]
    ds_read_b128 a[88:91], v26 offset:38912
    v_mfma_f32_16x16x32_bf16 v[248:251], a[44:47], a[236:239], v[248:251]
    v_mfma_f32_16x16x32_bf16 v[232:235], a[44:47], a[228:231], v[232:235]
    buffer_load_dwordx4 v16, s[16:19], s49 offen offset:2048 lds
    ds_read_b64_tr_b16 a[12:13], v29 offset:49152
    v_mfma_f32_16x16x32_bf16 v[232:235], a[40:43], a[224:227], v[232:235]
    ds_read_b128 a[92:95], v27 offset:38912
    v_mfma_f32_16x16x32_bf16 v[216:219], a[40:43], a[216:219], v[216:219]
    v_mfma_f32_16x16x32_bf16 v[216:219], a[44:47], a[220:223], v[216:219]
    buffer_load_dwordx4 v17, s[16:19], s49 offen offset:3072 lds
    ds_read_b64_tr_b16 a[14:15], v29 offset:51200
    v_mfma_f32_16x16x32_bf16 v[200:203], a[44:47], a[212:215], v[200:203]
    ds_read_b128 a[96:99], v26 offset:40960
    v_mfma_f32_16x16x32_bf16 v[200:203], a[40:43], a[208:211], v[200:203]
    s_add_u32 s49, s49, 128
    v_mfma_f32_16x16x32_bf16 v[184:187], a[40:43], a[200:203], v[184:187]
    s_add_u32 m0, s48, 65536
    ds_read_b64_tr_b16 a[16:17], v30 offset:32768
    v_mfma_f32_16x16x32_bf16 v[184:187], a[44:47], a[204:207], v[184:187]
    buffer_load_dwordx4 v18, s[20:23], s50 offen offset:0 lds
    v_mfma_f32_16x16x32_bf16 v[168:171], a[44:47], a[196:199], v[168:171]
    ds_read_b128 a[100:103], v27 offset:40960
    v_mfma_f32_16x16x32_bf16 v[168:171], a[40:43], a[192:195], v[168:171]
    ds_read_b64_tr_b16 a[18:19], v30 offset:34816
    v_mfma_f32_16x16x32_bf16 v[76:79], a[48:51], a[192:195], v[76:79]
    buffer_load_dwordx4 v19, s[20:23], s50 offen offset:1024 lds
    v_mfma_f32_16x16x32_bf16 v[76:79], a[52:55], a[196:199], v[76:79]
    ds_read_b128 a[104:107], v26 offset:43008
    v_mfma_f32_16x16x32_bf16 v[92:95], a[52:55], a[204:207], v[92:95]
    v_mfma_f32_16x16x32_bf16 v[92:95], a[48:51], a[200:203], v[92:95]
    buffer_load_dwordx4 v20, s[20:23], s50 offen offset:2048 lds
    ds_read_b64_tr_b16 a[20:21], v30 offset:49152
    v_mfma_f32_16x16x32_bf16 v[108:111], a[48:51], a[208:211], v[108:111]
    ds_read_b128 a[108:111], v27 offset:43008
    v_mfma_f32_16x16x32_bf16 v[108:111], a[52:55], a[212:215], v[108:111]
    v_mfma_f32_16x16x32_bf16 v[124:127], a[52:55], a[220:223], v[124:127]
    ds_read_b64_tr_b16 a[22:23], v30 offset:51200
    v_mfma_f32_16x16x32_bf16 v[124:127], a[48:51], a[216:219], v[124:127]
    buffer_load_dwordx4 v21, s[20:23], s50 offen offset:3072 lds
    v_mfma_f32_16x16x32_bf16 v[140:143], a[48:51], a[224:227], v[140:143]
    s_add_u32 m0, s48, 69632
    ds_read_b128 a[112:115], v26 offset:45056
    v_mfma_f32_16x16x32_bf16 v[140:143], a[52:55], a[228:231], v[140:143]
    ds_read_b64_tr_b16 a[24:25], v31 offset:32768
    v_mfma_f32_16x16x32_bf16 v[156:159], a[52:55], a[236:239], v[156:159]
    buffer_load_dwordx4 v22, s[20:23], s50 offen offset:0 lds
    v_mfma_f32_16x16x32_bf16 v[156:159], a[48:51], a[232:235], v[156:159]
    ds_read_b128 a[116:119], v27 offset:45056
    v_mfma_f32_16x16x32_bf16 a[152:155], a[48:51], a[240:243], a[152:155]
    v_mfma_f32_16x16x32_bf16 a[152:155], a[52:55], a[244:247], a[152:155]
    ds_read_b64_tr_b16 a[26:27], v31 offset:34816
    v_mfma_f32_16x16x32_bf16 a[184:187], a[52:55], a[252:255], a[184:187]
    buffer_load_dwordx4 v23, s[20:23], s50 offen offset:1024 lds
    ds_read_b128 a[120:123], v26 offset:47104
    v_mfma_f32_16x16x32_bf16 a[184:187], a[48:51], a[248:251], a[184:187]
    v_mfma_f32_16x16x32_bf16 a[188:191], a[56:59], a[248:251], a[188:191]
    ds_read_b64_tr_b16 a[28:29], v31 offset:49152
    v_mfma_f32_16x16x32_bf16 a[188:191], a[60:63], a[252:255], a[188:191]
    buffer_load_dwordx4 v24, s[20:23], s50 offen offset:2048 lds
    v_mfma_f32_16x16x32_bf16 a[156:159], a[60:63], a[244:247], a[156:159]
    ds_read_b128 a[124:127], v27 offset:47104
    v_mfma_f32_16x16x32_bf16 a[156:159], a[56:59], a[240:243], a[156:159]
    ds_read_b64_tr_b16 a[30:31], v31 offset:51200
    v_mfma_f32_16x16x32_bf16 v[252:255], a[56:59], a[232:235], v[252:255]
    v_mfma_f32_16x16x32_bf16 v[252:255], a[60:63], a[236:239], v[252:255]
    buffer_load_dwordx4 v25, s[20:23], s50 offen offset:3072 lds
    v_mfma_f32_16x16x32_bf16 v[236:239], a[60:63], a[228:231], v[236:239]
    v_mfma_f32_16x16x32_bf16 v[236:239], a[56:59], a[224:227], v[236:239]
    s_add_u32 s50, s50, 0x80000
    v_mfma_f32_16x16x32_bf16 v[220:223], a[56:59], a[216:219], v[220:223]
    v_mfma_f32_16x16x32_bf16 v[220:223], a[60:63], a[220:223], v[220:223]
    s_cmp_eq_u32 s51, s53
    s_cbranch_scc1 k12_ool_16
k12_oolret_17:
    v_mfma_f32_16x16x32_bf16 v[204:207], a[60:63], a[212:215], v[204:207]
    s_cmp_eq_u32 s51, s63
    s_cbranch_scc1 k12_ool_18
k12_oolret_19:
    v_mfma_f32_16x16x32_bf16 v[204:207], a[56:59], a[208:211], v[204:207]
    s_cmp_eq_u32 s51, 6
    s_cbranch_scc1 k12_ool_20
k12_oolret_21:
    v_mfma_f32_16x16x32_bf16 v[188:191], a[56:59], a[200:203], v[188:191]
    v_mfma_f32_16x16x32_bf16 v[188:191], a[60:63], a[204:207], v[188:191]
    s_add_u32 s51, s51, 1
    v_mfma_f32_16x16x32_bf16 v[172:175], a[60:63], a[196:199], v[172:175]
    v_mfma_f32_16x16x32_bf16 v[172:175], a[56:59], a[192:195], v[172:175]
    s_waitcnt lgkmcnt(0)
    s_cmp_eq_u32 s51, 7
    s_cbranch_scc1 k12_last_9
    v_mfma_f32_16x16x32_bf16 v[64:67], a[0:3], a[64:67], v[64:67]
    v_mfma_f32_16x16x32_bf16 v[64:67], a[4:7], a[68:71], v[64:67]
    ds_read_b64_tr_b16 a[32:33], v32 offset:32768
    v_mfma_f32_16x16x32_bf16 v[80:83], a[4:7], a[76:79], v[80:83]
    v_mfma_f32_16x16x32_bf16 v[80:83], a[0:3], a[72:75], v[80:83]
    ds_read_b64_tr_b16 a[34:35], v32 offset:34816
    v_mfma_f32_16x16x32_bf16 v[96:99], a[0:3], a[80:83], v[96:99]
    v_mfma_f32_16x16x32_bf16 v[96:99], a[4:7], a[84:87], v[96:99]
    v_mfma_f32_16x16x32_bf16 v[112:115], a[4:7], a[92:95], v[112:115]
    ds_read_b64_tr_b16 a[36:37], v32 offset:49152
    v_mfma_f32_16x16x32_bf16 v[112:115], a[0:3], a[88:91], v[112:115]
    v_mfma_f32_16x16x32_bf16 v[128:131], a[0:3], a[96:99], v[128:131]
    v_mfma_f32_16x16x32_bf16 v[128:131], a[4:7], a[100:103], v[128:131]
    ds_read_b64_tr_b16 a[38:39], v32 offset:51200
    v_mfma_f32_16x16x32_bf16 v[144:147], a[4:7], a[108:111], v[144:147]
    v_mfma_f32_16x16x32_bf16 v[144:147], a[0:3], a[104:107], v[144:147]
    v_mfma_f32_16x16x32_bf16 a[128:131], a[0:3], a[112:115], a[128:131]
    ds_read_b64_tr_b16 a[40:41], v33 offset:32768
    v_mfma_f32_16x16x32_bf16 a[128:131], a[4:7], a[116:119], a[128:131]
    v_mfma_f32_16x16x32_bf16 a[160:163], a[4:7], a[124:127], a[160:163]
    v_mfma_f32_16x16x32_bf16 a[160:163], a[0:3], a[120:123], a[160:163]
    ds_read_b64_tr_b16 a[42:43], v33 offset:34816
    v_mfma_f32_16x16x32_bf16 a[164:167], a[8:11], a[120:123], a[164:167]
    v_mfma_f32_16x16x32_bf16 a[164:167], a[12:15], a[124:127], a[164:167]
    v_mfma_f32_16x16x32_bf16 a[132:135], a[12:15], a[116:119], a[132:135]
    ds_read_b64_tr_b16 a[44:45], v33 offset:49152
    v_mfma_f32_16x16x32_bf16 a[132:135], a[8:11], a[112:115], a[132:135]
    v_mfma_f32_16x16x32_bf16 v[240:243], a[8:11], a[104:107], v[240:243]
    v_mfma_f32_16x16x32_bf16 v[240:243], a[12:15], a[108:111], v[240:243]
    ds_read_b64_tr_b16 a[46:47], v33 offset:51200
    v_mfma_f32_16x16x32_bf16 v[224:227], a[12:15], a[100:103], v[224:227]
    v_mfma_f32_16x16x32_bf16 v[224:227], a[8:11], a[96:99], v[224:227]
    ds_read_b64_tr_b16 a[48:49], v34 offset:32768
    v_mfma_f32_16x16x32_bf16 v[208:211], a[8:11], a[88:91], v[208:211]
    v_mfma_f32_16x16x32_bf16 v[208:211], a[12:15], a[92:95], v[208:211]
    v_mfma_f32_16x16x32_bf16 v[192:195], a[12:15], a[84:87], v[192:195]
    ds_read_b64_tr_b16 a[50:51], v34 offset:34816
    v_mfma_f32_16x16x32_bf16 v[192:195], a[8:11], a[80:83], v[192:195]
    v_mfma_f32_16x16x32_bf16 v[176:179], a[8:11], a[72:75], v[176:179]
    v_mfma_f32_16x16x32_bf16 v[176:179], a[12:15], a[76:79], v[176:179]
    ds_read_b64_tr_b16 a[52:53], v34 offset:49152
    v_mfma_f32_16x16x32_bf16 v[160:163], a[12:15], a[68:71], v[160:163]
    v_mfma_f32_16x16x32_bf16 v[160:163], a[8:11], a[64:67], v[160:163]
    v_mfma_f32_16x16x32_bf16 v[68:71], a[16:19], a[64:67], v[68:71]
    ds_read_b64_tr_b16 a[54:55], v34 offset:51200
    v_mfma_f32_16x16x32_bf16 v[68:71], a[20:23], a[68:71], v[68:71]
    v_mfma_f32_16x16x32_bf16 v[84:87], a[20:23], a[76:79], v[84:87]
    v_mfma_f32_16x16x32_bf16 v[84:87], a[16:19], a[72:75], v[84:87]
    ds_read_b64_tr_b16 a[56:57], v35 offset:32768
    v_mfma_f32_16x16x32_bf16 v[100:103], a[16:19], a[80:83], v[100:103]
    v_mfma_f32_16x16x32_bf16 v[100:103], a[20:23], a[84:87], v[100:103]
    v_mfma_f32_16x16x32_bf16 v[116:119], a[20:23], a[92:95], v[116:119]
    ds_read_b64_tr_b16 a[58:59], v35 offset:34816
    v_mfma_f32_16x16x32_bf16 v[116:119], a[16:19], a[88:91], v[116:119]
    v_mfma_f32_16x16x32_bf16 v[132:135], a[16:19], a[96:99], v[132:135]
    v_mfma_f32_16x16x32_bf16 v[132:135], a[20:23], a[100:103], v[132:135]
    ds_read_b64_tr_b16 a[60:61], v35 offset:49152
    v_mfma_f32_16x16x32_bf16 v[148:151], a[20:23], a[108:111], v[148:151]
    v_mfma_f32_16x16x32_bf16 v[148:151], a[16:19], a[104:107], v[148:151]
    v_mfma_f32_16x16x32_bf16 a[136:139], a[16:19], a[112:115], a[136:139]
    ds_read_b64_tr_b16 a[62:63], v35 offset:51200
    v_mfma_f32_16x16x32_bf16 a[136:139], a[20:23], a[116:119], a[136:139]
    v_mfma_f32_16x16x32_bf16 a[168:171], a[20:23], a[124:127], a[168:171]
    v_mfma_f32_16x16x32_bf16 a[168:171], a[16:19], a[120:123], a[168:171]
    v_mfma_f32_16x16x32_bf16 a[172:175], a[24:27], a[120:123], a[172:175]
    v_mfma_f32_16x16x32_bf16 a[172:175], a[28:31], a[124:127], a[172:175]
    v_mfma_f32_16x16x32_bf16 a[140:143], a[28:31], a[116:119], a[140:143]
    v_mfma_f32_16x16x32_bf16 a[140:143], a[24:27], a[112:115], a[140:143]
    v_mfma_f32_16x16x32_bf16 v[244:247], a[24:27], a[104:107], v[244:247]
    v_mfma_f32_16x16x32_bf16 v[244:247], a[28:31], a[108:111], v[244:247]
    v_mfma_f32_16x16x32_bf16 v[228:231], a[28:31], a[100:103], v[228:231]
    v_mfma_f32_16x16x32_bf16 v[228:231], a[24:27], a[96:99], v[228:231]
    v_mfma_f32_16x16x32_bf16 v[212:215], a[24:27], a[88:91], v[212:215]
    v_mfma_f32_16x16x32_bf16 v[212:215], a[28:31], a[92:95], v[212:215]
    v_mfma_f32_16x16x32_bf16 v[196:199], a[28:31], a[84:87], v[196:199]
    v_mfma_f32_16x16x32_bf16 v[196:199], a[24:27], a[80:83], v[196:199]
    v_mfma_f32_16x16x32_bf16 v[180:183], a[24:27], a[72:75], v[180:183]
    v_mfma_f32_16x16x32_bf16 v[180:183], a[28:31], a[76:79], v[180:183]
    v_mfma_f32_16x16x32_bf16 v[164:167], a[28:31], a[68:71], v[164:167]
    v_mfma_f32_16x16x32_bf16 v[164:167], a[24:27], a[64:67], v[164:167]
    s_waitcnt vmcnt(0) lgkmcnt(0)
    s_barrier
    v_mfma_f32_16x16x32_bf16 v[72:75], a[32:35], a[64:67], v[72:75]
    v_mfma_f32_16x16x32_bf16 v[72:75], a[36:39], a[68:71], v[72:75]
    s_add_u32 m0, s48, 32768
    ds_read_b128 a[192:195], v26 offset:0
    v_mfma_f32_16x16x32_bf16 v[88:91], a[36:39], a[76:79], v[88:91]
    buffer_load_dwordx4 v10, s[16:19], s49 offen offset:0 lds
    ds_read_b64_tr_b16 a[0:1], v28 offset:0
    v_mfma_f32_16x16x32_bf16 v[88:91], a[32:35], a[72:75], v[88:91]
    ds_read_b128 a[196:199], v27 offset:0
    v_mfma_f32_16x16x32_bf16 v[104:107], a[32:35], a[80:83], v[104:107]
    buffer_load_dwordx4 v11, s[16:19], s49 offen offset:1024 lds
    v_mfma_f32_16x16x32_bf16 v[104:107], a[36:39], a[84:87], v[104:107]
    ds_read_b64_tr_b16 a[2:3], v28 offset:2048
    v_mfma_f32_16x16x32_bf16 v[120:123], a[36:39], a[92:95], v[120:123]
    v_mfma_f32_16x16x32_bf16 v[120:123], a[32:35], a[88:91], v[120:123]
    ds_read_b128 a[200:203], v26 offset:2048
    v_mfma_f32_16x16x32_bf16 v[136:139], a[32:35], a[96:99], v[136:139]
    buffer_load_dwordx4 v12, s[16:19], s49 offen offset:2048 lds
    ds_read_b64_tr_b16 a[4:5], v28 offset:16384
    v_mfma_f32_16x16x32_bf16 v[136:139], a[36:39], a[100:103], v[136:139]
    v_mfma_f32_16x16x32_bf16 v[152:155], a[36:39], a[108:111], v[152:155]
    ds_read_b128 a[204:207], v27 offset:2048
    v_mfma_f32_16x16x32_bf16 v[152:155], a[32:35], a[104:107], v[152:155]
    buffer_load_dwordx4 v13, s[16:19], s49 offen offset:3072 lds
    v_mfma_f32_16x16x32_bf16 a[144:147], a[32:35], a[112:115], a[144:147]
    ds_read_b64_tr_b16 a[6:7], v28 offset:18432
    v_mfma_f32_16x16x32_bf16 a[144:147], a[36:39], a[116:119], a[144:147]
    s_add_u32 m0, s48, 36864
    ds_read_b128 a[208:211], v26 offset:4096
    v_mfma_f32_16x16x32_bf16 a[176:179], a[36:39], a[124:127], a[176:179]
    v_mfma_f32_16x16x32_bf16 a[176:179], a[32:35], a[120:123], a[176:179]
    buffer_load_dwordx4 v14, s[16:19], s49 offen offset:0 lds
    ds_read_b64_tr_b16 a[8:9], v29 offset:0
    v_mfma_f32_16x16x32_bf16 a[180:183], a[40:43], a[120:123], a[180:183]
    v_mfma_f32_16x16x32_bf16 a[180:183], a[44:47], a[124:127], a[180:183]
    ds_read_b128 a[212:215], v27 offset:4096
    v_mfma_f32_16x16x32_bf16 a[148:151], a[44:47], a[116:119], a[148:151]
    buffer_load_dwordx4 v15, s[16:19], s49 offen offset:1024 lds
    ds_read_b64_tr_b16 a[10:11], v29 offset:2048
    v_mfma_f32_16x16x32_bf16 a[148:151], a[40:43], a[112:115], a[148:151]
    v_mfma_f32_16x16x32_bf16 v[248:251], a[40:43], a[104:107], v[248:251]
    ds_read_b128 a[216:219], v26 offset:6144
    v_mfma_f32_16x16x32_bf16 v[248:251], a[44:47], a[108:111], v[248:251]
    v_mfma_f32_16x16x32_bf16 v[232:235], a[44:47], a[100:103], v[232:235]
    buffer_load_dwordx4 v16, s[16:19], s49 offen offset:2048 lds
    ds_read_b64_tr_b16 a[12:13], v29 offset:16384
    v_mfma_f32_16x16x32_bf16 v[232:235], a[40:43], a[96:99], v[232:235]
    ds_read_b128 a[220:223], v27 offset:6144
    v_mfma_f32_16x16x32_bf16 v[216:219], a[40:43], a[88:91], v[216:219]
    v_mfma_f32_16x16x32_bf16 v[216:219], a[44:47], a[92:95], v[216:219]
    buffer_load_dwordx4 v17, s[16:19], s49 offen offset:3072 lds
    ds_read_b64_tr_b16 a[14:15], v29 offset:18432
    v_mfma_f32_16x16x32_bf16 v[200:203], a[44:47], a[84:87], v[200:203]
    ds_read_b128 a[224:227], v26 offset:8192
    v_mfma_f32_16x16x32_bf16 v[200:203], a[40:43], a[80:83], v[200:203]
    s_add_u32 s49, s49, 128
    v_mfma_f32_16x16x32_bf16 v[184:187], a[40:43], a[72:75], v[184:187]
    s_add_u32 m0, s48, 98304
    ds_read_b64_tr_b16 a[16:17], v30 offset:0
    v_mfma_f32_16x16x32_bf16 v[184:187], a[44:47], a[76:79], v[184:187]
    buffer_load_dwordx4 v18, s[20:23], s50 offen offset:0 lds
    v_mfma_f32_16x16x32_bf16 v[168:171], a[44:47], a[68:71], v[168:171]
    ds_read_b128 a[228:231], v27 offset:8192
    v_mfma_f32_16x16x32_bf16 v[168:171], a[40:43], a[64:67], v[168:171]
    ds_read_b64_tr_b16 a[18:19], v30 offset:2048
    v_mfma_f32_16x16x32_bf16 v[76:79], a[48:51], a[64:67], v[76:79]
    buffer_load_dwordx4 v19, s[20:23], s50 offen offset:1024 lds
    v_mfma_f32_16x16x32_bf16 v[76:79], a[52:55], a[68:71], v[76:79]
    ds_read_b128 a[232:235], v26 offset:10240
    v_mfma_f32_16x16x32_bf16 v[92:95], a[52:55], a[76:79], v[92:95]
    v_mfma_f32_16x16x32_bf16 v[92:95], a[48:51], a[72:75], v[92:95]
    buffer_load_dwordx4 v20, s[20:23], s50 offen offset:2048 lds
    ds_read_b64_tr_b16 a[20:21], v30 offset:16384
    v_mfma_f32_16x16x32_bf16 v[108:111], a[48:51], a[80:83], v[108:111]
    ds_read_b128 a[236:239], v27 offset:10240
    v_mfma_f32_16x16x32_bf16 v[108:111], a[52:55], a[84:87], v[108:111]
    v_mfma_f32_16x16x32_bf16 v[124:127], a[52:55], a[92:95], v[124:127]
    ds_read_b64_tr_b16 a[22:23], v30 offset:18432
    v_mfma_f32_16x16x32_bf16 v[124:127], a[48:51], a[88:91], v[124:127]
    buffer_load_dwordx4 v21, s[20:23], s50 offen offset:3072 lds
    v_mfma_f32_16x16x32_bf16 v[140:143], a[48:51], a[96:99], v[140:143]
    s_add_u32 m0, s48, 102400
    ds_read_b128 a[240:243], v26 offset:12288
    v_mfma_f32_16x16x32_bf16 v[140:143], a[52:55], a[100:103], v[140:143]
    ds_read_b64_tr_b16 a[24:25], v31 offset:0
    v_mfma_f32_16x16x32_bf16 v[156:159], a[52:55], a[108:111], v[156:159]
    buffer_load_dwordx4 v22, s[20:23], s50 offen offset:0 lds
    v_mfma_f32_16x16x32_bf16 v[156:159], a[48:51], a[104:107], v[156:159]
    ds_read_b128 a[244:247], v27 offset:12288
    v_mfma_f32_16x16x32_bf16 a[152:155], a[48:51], a[112:115], a[152:155]
    v_mfma_f32_16x16x32_bf16 a[152:155], a[52:55], a[116:119], a[152:155]
    ds_read_b64_tr_b16 a[26:27], v31 offset:2048
    v_mfma_f32_16x16x32_bf16 a[184:187], a[52:55], a[124:127], a[184:187]
    buffer_load_dwordx4 v23, s[20:23], s50 offen offset:1024 lds
    ds_read_b128 a[248:251], v26 offset:14336
    v_mfma_f32_16x16x32_bf16 a[184:187], a[48:51], a[120:123], a[184:187]
    v_mfma_f32_16x16x32_bf16 a[188:191], a[56:59], a[120:123], a[188:191]
    ds_read_b64_tr_b16 a[28:29], v31 offset:16384
    v_mfma_f32_16x16x32_bf16 a[188:191], a[60:63], a[124:127], a[188:191]
    buffer_load_dwordx4 v24, s[20:23], s50 offen offset:2048 lds
    v_mfma_f32_16x16x32_bf16 a[156:159], a[60:63], a[116:119], a[156:159]
    ds_read_b128 a[252:255], v27 offset:14336
    v_mfma_f32_16x16x32_bf16 a[156:159], a[56:59], a[112:115], a[156:159]
    ds_read_b64_tr_b16 a[30:31], v31 offset:18432
    v_mfma_f32_16x16x32_bf16 v[252:255], a[56:59], a[104:107], v[252:255]
    v_mfma_f32_16x16x32_bf16 v[252:255], a[60:63], a[108:111], v[252:255]
    buffer_load_dwordx4 v25, s[20:23], s50 offen offset:3072 lds
    v_mfma_f32_16x16x32_bf16 v[236:239], a[60:63], a[100:103], v[236:239]
    v_mfma_f32_16x16x32_bf16 v[236:239], a[56:59], a[96:99], v[236:239]
    s_add_u32 s50, s50, 0x80000
    v_mfma_f32_16x16x32_bf16 v[220:223], a[56:59], a[88:91], v[220:223]
    v_mfma_f32_16x16x32_bf16 v[220:223], a[60:63], a[92:95], v[220:223]
    s_cmp_eq_u32 s51, s53
    s_cbranch_scc1 k12_ool_22
k12_oolret_23:
    v_mfma_f32_16x16x32_bf16 v[204:207], a[60:63], a[84:87], v[204:207]
    s_cmp_eq_u32 s51, s63
    s_cbranch_scc1 k12_ool_24
k12_oolret_25:
    v_mfma_f32_16x16x32_bf16 v[204:207], a[56:59], a[80:83], v[204:207]
    s_cmp_eq_u32 s51, 5
    s_cbranch_scc1 k12_ool_26
k12_oolret_27:
    v_mfma_f32_16x16x32_bf16 v[188:191], a[56:59], a[72:75], v[188:191]
    v_mfma_f32_16x16x32_bf16 v[188:191], a[60:63], a[76:79], v[188:191]
    s_add_u32 s51, s51, 1
    v_mfma_f32_16x16x32_bf16 v[172:175], a[60:63], a[68:71], v[172:175]
    v_mfma_f32_16x16x32_bf16 v[172:175], a[56:59], a[64:67], v[172:175]
    s_waitcnt lgkmcnt(0)
    s_branch k12_loop_8
k12_last_9:
    v_mfma_f32_16x16x32_bf16 v[64:67], a[0:3], a[64:67], v[64:67]
    buffer_load_dwordx4 a[192:195], v36, s[8:11], s62 offen sc1
    v_mfma_f32_16x16x32_bf16 v[64:67], a[4:7], a[68:71], v[64:67]
    ds_read_b64_tr_b16 a[32:33], v32 offset:32768
    v_mfma_f32_16x16x32_bf16 v[160:163], a[12:15], a[68:71], v[160:163]
    buffer_load_dwordx4 a[196:199], v54, s[8:11], s62 offen sc1
    ds_read_b64_tr_b16 a[34:35], v32 offset:34816
    v_mfma_f32_16x16x32_bf16 v[160:163], a[8:11], a[64:67], v[160:163]
    v_mfma_f32_16x16x32_bf16 v[80:83], a[0:3], a[72:75], v[80:83]
    buffer_load_dwordx4 a[200:203], v37, s[8:11], s62 offen sc1
    v_mfma_f32_16x16x32_bf16 v[80:83], a[4:7], a[76:79], v[80:83]
    ds_read_b64_tr_b16 a[36:37], v32 offset:49152
    v_mfma_f32_16x16x32_bf16 v[176:179], a[12:15], a[76:79], v[176:179]
    buffer_load_dwordx4 a[204:207], v55, s[8:11], s62 offen sc1
    v_mfma_f32_16x16x32_bf16 v[176:179], a[8:11], a[72:75], v[176:179]
    s_add_u32 s62, s62, 0x20000
    buffer_load_dwordx4 a[208:211], v36, s[8:11], s62 offen sc1
    ds_read_b64_tr_b16 a[38:39], v32 offset:51200
    v_mfma_f32_16x16x32_bf16 v[96:99], a[0:3], a[80:83], v[96:99]
    v_mfma_f32_16x16x32_bf16 v[96:99], a[4:7], a[84:87], v[96:99]
    v_cvt_pk_bf16_f32 v64, v64, v65
    v_cvt_pk_bf16_f32 v65, v66, v67
    v_mfma_f32_16x16x32_bf16 v[192:195], a[12:15], a[84:87], v[192:195]
    v_cvt_pk_bf16_f32 v66, v160, v161
    v_cvt_pk_bf16_f32 v67, v162, v163
    v_mfma_f32_16x16x32_bf16 v[192:195], a[8:11], a[80:83], v[192:195]
    buffer_load_dwordx4 a[212:215], v54, s[8:11], s62 offen sc1
    ds_read_b64_tr_b16 a[40:41], v33 offset:32768
    v_mfma_f32_16x16x32_bf16 v[112:115], a[0:3], a[88:91], v[112:115]
    buffer_load_dwordx4 a[216:219], v37, s[8:11], s62 offen sc1
    ds_read_b64_tr_b16 a[42:43], v33 offset:34816
    v_mfma_f32_16x16x32_bf16 v[112:115], a[4:7], a[92:95], v[112:115]
    v_cvt_pk_bf16_f32 v80, v80, v81
    v_cvt_pk_bf16_f32 v81, v82, v83
    v_mfma_f32_16x16x32_bf16 v[208:211], a[12:15], a[92:95], v[208:211]
    v_cvt_pk_bf16_f32 v82, v176, v177
    v_cvt_pk_bf16_f32 v83, v178, v179
    v_mfma_f32_16x16x32_bf16 v[208:211], a[8:11], a[88:91], v[208:211]
    buffer_load_dwordx4 a[220:223], v55, s[8:11], s62 offen sc1
    ds_read_b64_tr_b16 a[44:45], v33 offset:49152
    v_mfma_f32_16x16x32_bf16 v[128:131], a[0:3], a[96:99], v[128:131]
    s_add_u32 s62, s62, 0x20000
    buffer_load_dwordx4 a[224:227], v36, s[8:11], s62 offen sc1
    v_mfma_f32_16x16x32_bf16 v[128:131], a[4:7], a[100:103], v[128:131]
    v_cvt_pk_bf16_f32 v96, v96, v97
    v_cvt_pk_bf16_f32 v97, v98, v99
    v_mfma_f32_16x16x32_bf16 v[224:227], a[12:15], a[100:103], v[224:227]
    buffer_load_dwordx4 a[228:231], v54, s[8:11], s62 offen sc1
    ds_read_b64_tr_b16 a[46:47], v33 offset:51200
    v_mfma_f32_16x16x32_bf16 v[224:227], a[8:11], a[96:99], v[224:227]
    v_cvt_pk_bf16_f32 v98, v192, v193
    v_cvt_pk_bf16_f32 v99, v194, v195
    v_mfma_f32_16x16x32_bf16 v[144:147], a[0:3], a[104:107], v[144:147]
    buffer_load_dwordx4 a[232:235], v37, s[8:11], s62 offen sc1
    ds_read_b64_tr_b16 a[48:49], v34 offset:32768
    v_mfma_f32_16x16x32_bf16 v[144:147], a[4:7], a[108:111], v[144:147]
    v_cvt_pk_bf16_f32 v112, v112, v113
    v_cvt_pk_bf16_f32 v113, v114, v115
    v_mfma_f32_16x16x32_bf16 v[240:243], a[12:15], a[108:111], v[240:243]
    buffer_load_dwordx4 a[236:239], v55, s[8:11], s62 offen sc1
    ds_read_b64_tr_b16 a[50:51], v34 offset:34816
    v_mfma_f32_16x16x32_bf16 v[240:243], a[8:11], a[104:107], v[240:243]
    s_add_u32 s62, s62, 0x20000
    v_cvt_pk_bf16_f32 v114, v208, v209
    v_cvt_pk_bf16_f32 v115, v210, v211
    v_mfma_f32_16x16x32_bf16 a[128:131], a[0:3], a[112:115], a[128:131]
    buffer_load_dwordx4 a[240:243], v36, s[8:11], s62 offen sc1
    ds_read_b64_tr_b16 a[52:53], v34 offset:49152
    v_mfma_f32_16x16x32_bf16 a[128:131], a[4:7], a[116:119], a[128:131]
    v_cvt_pk_bf16_f32 v128, v128, v129
    v_cvt_pk_bf16_f32 v129, v130, v131
    v_mfma_f32_16x16x32_bf16 a[132:135], a[12:15], a[116:119], a[132:135]
    buffer_load_dwordx4 a[244:247], v54, s[8:11], s62 offen sc1
    buffer_load_dwordx4 a[248:251], v37, s[8:11], s62 offen sc1
    v_mfma_f32_16x16x32_bf16 a[132:135], a[8:11], a[112:115], a[132:135]
    v_cvt_pk_bf16_f32 v130, v224, v225
    v_cvt_pk_bf16_f32 v131, v226, v227
    v_mfma_f32_16x16x32_bf16 a[160:163], a[0:3], a[120:123], a[160:163]
    buffer_load_dwordx4 a[252:255], v55, s[8:11], s62 offen sc1
    ds_read_b64_tr_b16 a[54:55], v34 offset:51200
    v_mfma_f32_16x16x32_bf16 a[160:163], a[4:7], a[124:127], a[160:163]
    s_add_u32 s62, s62, 0x20000
    v_cvt_pk_bf16_f32 v144, v144, v145
    v_cvt_pk_bf16_f32 v145, v146, v147
    v_mfma_f32_16x16x32_bf16 a[164:167], a[12:15], a[124:127], a[164:167]
    ds_read_b64_tr_b16 a[56:57], v35 offset:32768
    v_cvt_pk_bf16_f32 v146, v240, v241
    v_mfma_f32_16x16x32_bf16 a[164:167], a[8:11], a[120:123], a[164:167]
    v_cvt_pk_bf16_f32 v147, v242, v243
    v_mfma_f32_16x16x32_bf16 v[68:71], a[16:19], a[64:67], v[68:71]
    s_add_u32 s52, s47, 0
    ds_read_b64_tr_b16 a[58:59], v35 offset:34816
    v_mfma_f32_16x16x32_bf16 v[68:71], a[20:23], a[68:71], v[68:71]
    v_accvgpr_read_b32 v56, a128
    v_accvgpr_read_b32 v57, a129
    v_mfma_f32_16x16x32_bf16 v[164:167], a[28:31], a[68:71], v[164:167]
    v_accvgpr_read_b32 v58, a130
    v_accvgpr_read_b32 v59, a131
    v_mfma_f32_16x16x32_bf16 v[164:167], a[24:27], a[64:67], v[164:167]
    buffer_store_dwordx4 v[64:67], v1, s[32:35], s52 offen offset:0 sc1
    ds_read_b64_tr_b16 a[60:61], v35 offset:49152
    v_mfma_f32_16x16x32_bf16 v[84:87], a[16:19], a[72:75], v[84:87]
    v_accvgpr_read_b32 v60, a132
    v_accvgpr_read_b32 v61, a133
    v_mfma_f32_16x16x32_bf16 v[84:87], a[20:23], a[76:79], v[84:87]
    v_accvgpr_read_b32 v62, a134
    v_accvgpr_read_b32 v63, a135
    v_mfma_f32_16x16x32_bf16 v[180:183], a[28:31], a[76:79], v[180:183]
    v_cvt_pk_bf16_f32 v160, v56, v57
    v_cvt_pk_bf16_f32 v161, v58, v59
    v_mfma_f32_16x16x32_bf16 v[180:183], a[24:27], a[72:75], v[180:183]
    ds_read_b64_tr_b16 a[62:63], v35 offset:51200
    v_cvt_pk_bf16_f32 v162, v60, v61
    v_mfma_f32_16x16x32_bf16 v[100:103], a[16:19], a[80:83], v[100:103]
    v_cvt_pk_bf16_f32 v163, v62, v63
    v_accvgpr_read_b32 v56, a160
    v_mfma_f32_16x16x32_bf16 v[100:103], a[20:23], a[84:87], v[100:103]
    v_accvgpr_read_b32 v57, a161
    v_accvgpr_read_b32 v58, a162
    v_mfma_f32_16x16x32_bf16 v[196:199], a[28:31], a[84:87], v[196:199]
    v_accvgpr_read_b32 v59, a163
    v_accvgpr_read_b32 v60, a164
    v_mfma_f32_16x16x32_bf16 v[196:199], a[24:27], a[80:83], v[196:199]
    s_add_u32 s52, s47, 8192
    v_accvgpr_read_b32 v61, a165
    v_accvgpr_read_b32 v62, a166
    v_mfma_f32_16x16x32_bf16 v[116:119], a[16:19], a[88:91], v[116:119]
    v_accvgpr_read_b32 v63, a167
    v_cvt_pk_bf16_f32 v176, v56, v57
    v_mfma_f32_16x16x32_bf16 v[116:119], a[20:23], a[92:95], v[116:119]
    v_cvt_pk_bf16_f32 v177, v58, v59
    v_cvt_pk_bf16_f32 v68, v68, v69
    v_mfma_f32_16x16x32_bf16 v[212:215], a[28:31], a[92:95], v[212:215]
    v_cvt_pk_bf16_f32 v178, v60, v61
    v_cvt_pk_bf16_f32 v69, v70, v71
    v_mfma_f32_16x16x32_bf16 v[212:215], a[24:27], a[88:91], v[212:215]
    v_cvt_pk_bf16_f32 v179, v62, v63
    v_cvt_pk_bf16_f32 v70, v164, v165
    v_mfma_f32_16x16x32_bf16 v[132:135], a[16:19], a[96:99], v[132:135]
    v_cvt_pk_bf16_f32 v71, v166, v167
    v_cvt_pk_bf16_f32 v84, v84, v85
    v_mfma_f32_16x16x32_bf16 v[132:135], a[20:23], a[100:103], v[132:135]
    buffer_store_dwordx4 v[96:99], v1, s[32:35], s52 offen offset:0 sc1
    v_cvt_pk_bf16_f32 v85, v86, v87
    v_mfma_f32_16x16x32_bf16 v[228:231], a[28:31], a[100:103], v[228:231]
    v_cvt_pk_bf16_f32 v86, v180, v181
    v_cvt_pk_bf16_f32 v87, v182, v183
    v_mfma_f32_16x16x32_bf16 v[228:231], a[24:27], a[96:99], v[228:231]
    v_cvt_pk_bf16_f32 v100, v100, v101
    v_cvt_pk_bf16_f32 v101, v102, v103
    v_mfma_f32_16x16x32_bf16 v[148:151], a[16:19], a[104:107], v[148:151]
    v_cvt_pk_bf16_f32 v102, v196, v197
    v_cvt_pk_bf16_f32 v103, v198, v199
    v_mfma_f32_16x16x32_bf16 v[148:151], a[20:23], a[108:111], v[148:151]
    v_cvt_pk_bf16_f32 v116, v116, v117
    v_cvt_pk_bf16_f32 v117, v118, v119
    v_mfma_f32_16x16x32_bf16 v[244:247], a[28:31], a[108:111], v[244:247]
    v_cvt_pk_bf16_f32 v118, v212, v213
    v_cvt_pk_bf16_f32 v119, v214, v215
    v_mfma_f32_16x16x32_bf16 v[244:247], a[24:27], a[104:107], v[244:247]
    s_add_u32 s52, s47, 524288
    v_mfma_f32_16x16x32_bf16 a[136:139], a[16:19], a[112:115], a[136:139]
    buffer_store_dwordx4 v[128:131], v1, s[32:35], s52 offen offset:0 sc1
    v_mfma_f32_16x16x32_bf16 a[136:139], a[20:23], a[116:119], a[136:139]
    v_cvt_pk_bf16_f32 v132, v132, v133
    v_cvt_pk_bf16_f32 v133, v134, v135
    v_mfma_f32_16x16x32_bf16 a[140:143], a[28:31], a[116:119], a[140:143]
    v_cvt_pk_bf16_f32 v134, v228, v229
    v_cvt_pk_bf16_f32 v135, v230, v231
    v_mfma_f32_16x16x32_bf16 a[140:143], a[24:27], a[112:115], a[140:143]
    v_mfma_f32_16x16x32_bf16 a[168:171], a[16:19], a[120:123], a[168:171]
    s_waitcnt lgkmcnt(0)
    v_mfma_f32_16x16x32_bf16 a[168:171], a[20:23], a[124:127], a[168:171]
    v_cvt_pk_bf16_f32 v148, v148, v149
    v_cvt_pk_bf16_f32 v149, v150, v151
    v_mfma_f32_16x16x32_bf16 a[172:175], a[28:31], a[124:127], a[172:175]
    v_cvt_pk_bf16_f32 v150, v244, v245
    v_cvt_pk_bf16_f32 v151, v246, v247
    v_mfma_f32_16x16x32_bf16 a[172:175], a[24:27], a[120:123], a[172:175]
    v_mfma_f32_16x16x32_bf16 v[72:75], a[32:35], a[64:67], v[72:75]
    v_mfma_f32_16x16x32_bf16 v[72:75], a[36:39], a[68:71], v[72:75]
    v_accvgpr_read_b32 v56, a136
    v_accvgpr_read_b32 v57, a137
    v_mfma_f32_16x16x32_bf16 v[168:171], a[44:47], a[68:71], v[168:171]
    s_add_u32 s52, s47, 532480
    v_accvgpr_read_b32 v58, a138
    v_accvgpr_read_b32 v59, a139
    v_mfma_f32_16x16x32_bf16 v[168:171], a[40:43], a[64:67], v[168:171]
    v_accvgpr_read_b32 v60, a140
    v_accvgpr_read_b32 v61, a141
    v_mfma_f32_16x16x32_bf16 v[88:91], a[32:35], a[72:75], v[88:91]
    v_accvgpr_read_b32 v62, a142
    v_accvgpr_read_b32 v63, a143
    v_mfma_f32_16x16x32_bf16 v[88:91], a[36:39], a[76:79], v[88:91]
    v_cvt_pk_bf16_f32 v164, v56, v57
    v_cvt_pk_bf16_f32 v165, v58, v59
    v_mfma_f32_16x16x32_bf16 v[184:187], a[44:47], a[76:79], v[184:187]
    buffer_store_dwordx4 v[160:163], v1, s[32:35], s52 offen offset:0 sc1
    v_mfma_f32_16x16x32_bf16 v[184:187], a[40:43], a[72:75], v[184:187]
    v_cvt_pk_bf16_f32 v166, v60, v61
    v_cvt_pk_bf16_f32 v167, v62, v63
    v_mfma_f32_16x16x32_bf16 v[104:107], a[32:35], a[80:83], v[104:107]
    v_accvgpr_read_b32 v56, a168
    v_accvgpr_read_b32 v57, a169
    v_mfma_f32_16x16x32_bf16 v[104:107], a[36:39], a[84:87], v[104:107]
    v_accvgpr_read_b32 v58, a170
    v_accvgpr_read_b32 v59, a171
    v_mfma_f32_16x16x32_bf16 v[200:203], a[44:47], a[84:87], v[200:203]
    v_accvgpr_read_b32 v60, a172
    v_accvgpr_read_b32 v61, a173
    v_mfma_f32_16x16x32_bf16 v[200:203], a[40:43], a[80:83], v[200:203]
    v_accvgpr_read_b32 v62, a174
    v_accvgpr_read_b32 v63, a175
    v_mfma_f32_16x16x32_bf16 v[120:123], a[32:35], a[88:91], v[120:123]
    v_cvt_pk_bf16_f32 v180, v56, v57
    v_cvt_pk_bf16_f32 v181, v58, v59
    v_mfma_f32_16x16x32_bf16 v[120:123], a[36:39], a[92:95], v[120:123]
    v_cvt_pk_bf16_f32 v72, v72, v73
    v_cvt_pk_bf16_f32 v182, v60, v61
    v_mfma_f32_16x16x32_bf16 v[216:219], a[44:47], a[92:95], v[216:219]
    s_add_u32 s52, s47, 0
    v_cvt_pk_bf16_f32 v73, v74, v75
    v_cvt_pk_bf16_f32 v183, v62, v63
    v_mfma_f32_16x16x32_bf16 v[216:219], a[40:43], a[88:91], v[216:219]
    v_cvt_pk_bf16_f32 v74, v168, v169
    v_cvt_pk_bf16_f32 v75, v170, v171
    v_mfma_f32_16x16x32_bf16 v[136:139], a[32:35], a[96:99], v[136:139]
    v_cvt_pk_bf16_f32 v88, v88, v89
    v_cvt_pk_bf16_f32 v89, v90, v91
    v_mfma_f32_16x16x32_bf16 v[136:139], a[36:39], a[100:103], v[136:139]
    v_cvt_pk_bf16_f32 v90, v184, v185
    v_cvt_pk_bf16_f32 v91, v186, v187
    v_mfma_f32_16x16x32_bf16 v[232:235], a[44:47], a[100:103], v[232:235]
    buffer_store_dwordx4 v[68:71], v1, s[32:35], s52 offen offset:1024 sc1
    v_mfma_f32_16x16x32_bf16 v[232:235], a[40:43], a[96:99], v[232:235]
    v_cvt_pk_bf16_f32 v104, v104, v105
    v_cvt_pk_bf16_f32 v105, v106, v107
    v_mfma_f32_16x16x32_bf16 v[152:155], a[32:35], a[104:107], v[152:155]
    v_cvt_pk_bf16_f32 v106, v200, v201
    v_cvt_pk_bf16_f32 v107, v202, v203
    v_mfma_f32_16x16x32_bf16 v[152:155], a[36:39], a[108:111], v[152:155]
    v_cvt_pk_bf16_f32 v120, v120, v121
    v_cvt_pk_bf16_f32 v121, v122, v123
    v_mfma_f32_16x16x32_bf16 v[248:251], a[44:47], a[108:111], v[248:251]
    v_cvt_pk_bf16_f32 v122, v216, v217
    v_cvt_pk_bf16_f32 v123, v218, v219
    v_mfma_f32_16x16x32_bf16 v[248:251], a[40:43], a[104:107], v[248:251]
    v_mfma_f32_16x16x32_bf16 a[144:147], a[32:35], a[112:115], a[144:147]
    v_mfma_f32_16x16x32_bf16 a[144:147], a[36:39], a[116:119], a[144:147]
    s_add_u32 s52, s47, 8192
    v_cvt_pk_bf16_f32 v136, v136, v137
    v_cvt_pk_bf16_f32 v137, v138, v139
    v_mfma_f32_16x16x32_bf16 a[148:151], a[44:47], a[116:119], a[148:151]
    v_cvt_pk_bf16_f32 v138, v232, v233
    v_cvt_pk_bf16_f32 v139, v234, v235
    v_mfma_f32_16x16x32_bf16 a[148:151], a[40:43], a[112:115], a[148:151]
    buffer_store_dwordx4 v[100:103], v1, s[32:35], s52 offen offset:1024 sc1
    v_mfma_f32_16x16x32_bf16 a[176:179], a[32:35], a[120:123], a[176:179]
    v_mfma_f32_16x16x32_bf16 a[176:179], a[36:39], a[124:127], a[176:179]
    v_cvt_pk_bf16_f32 v152, v152, v153
    v_cvt_pk_bf16_f32 v153, v154, v155
    v_mfma_f32_16x16x32_bf16 a[180:183], a[44:47], a[124:127], a[180:183]
    v_cvt_pk_bf16_f32 v154, v248, v249
    v_cvt_pk_bf16_f32 v155, v250, v251
    v_mfma_f32_16x16x32_bf16 a[180:183], a[40:43], a[120:123], a[180:183]
    v_mfma_f32_16x16x32_bf16 v[76:79], a[48:51], a[64:67], v[76:79]
    s_waitcnt vmcnt(16)
    s_barrier
    v_mfma_f32_16x16x32_bf16 v[76:79], a[52:55], a[68:71], v[76:79]
    ds_read_b64_tr_b16 a[0:1], v42 offset:32768
    v_accvgpr_read_b32 v56, a144
    v_mfma_f32_16x16x32_bf16 v[172:175], a[60:63], a[68:71], v[172:175]
    v_accvgpr_read_b32 v57, a145
    v_accvgpr_read_b32 v58, a146
    v_mfma_f32_16x16x32_bf16 v[172:175], a[56:59], a[64:67], v[172:175]
    ds_read_b64_tr_b16 a[2:3], v42 offset:33792
    v_accvgpr_read_b32 v59, a147
    v_mfma_f32_16x16x32_bf16 v[92:95], a[48:51], a[72:75], v[92:95]
    v_accvgpr_read_b32 v60, a148
    v_accvgpr_read_b32 v61, a149
    v_mfma_f32_16x16x32_bf16 v[92:95], a[52:55], a[76:79], v[92:95]
    s_add_u32 s52, s47, 524288
    ds_read_b64_tr_b16 a[4:5], v42 offset:40960
    v_accvgpr_read_b32 v62, a150
    v_mfma_f32_16x16x32_bf16 v[188:191], a[60:63], a[76:79], v[188:191]
    v_accvgpr_read_b32 v63, a151
    v_cvt_pk_bf16_f32 v168, v56, v57
    v_mfma_f32_16x16x32_bf16 v[188:191], a[56:59], a[72:75], v[188:191]
    v_cvt_pk_bf16_f32 v169, v58, v59
    v_cvt_pk_bf16_f32 v170, v60, v61
    v_mfma_f32_16x16x32_bf16 v[108:111], a[48:51], a[80:83], v[108:111]
    ds_read_b64_tr_b16 a[6:7], v42 offset:41984
    v_cvt_pk_bf16_f32 v171, v62, v63
    v_mfma_f32_16x16x32_bf16 v[108:111], a[52:55], a[84:87], v[108:111]
    v_accvgpr_read_b32 v56, a176
    v_accvgpr_read_b32 v57, a177
    v_mfma_f32_16x16x32_bf16 v[204:207], a[60:63], a[84:87], v[204:207]
    v_accvgpr_read_b32 v58, a178
    v_accvgpr_read_b32 v59, a179
    v_mfma_f32_16x16x32_bf16 v[204:207], a[56:59], a[80:83], v[204:207]
    ds_read_b64_tr_b16 a[8:9], v43 offset:32768
    v_accvgpr_read_b32 v60, a180
    v_mfma_f32_16x16x32_bf16 v[124:127], a[48:51], a[88:91], v[124:127]
    buffer_store_dwordx4 v[132:135], v1, s[32:35], s52 offen offset:1024 sc1
    v_accvgpr_read_b32 v61, a181
    v_mfma_f32_16x16x32_bf16 v[124:127], a[52:55], a[92:95], v[124:127]
    v_accvgpr_read_b32 v62, a182
    v_accvgpr_read_b32 v63, a183
    v_mfma_f32_16x16x32_bf16 v[220:223], a[60:63], a[92:95], v[220:223]
    ds_read_b64_tr_b16 a[10:11], v43 offset:33792
    v_cvt_pk_bf16_f32 v184, v56, v57
    v_mfma_f32_16x16x32_bf16 v[220:223], a[56:59], a[88:91], v[220:223]
    v_cvt_pk_bf16_f32 v185, v58, v59
    v_cvt_pk_bf16_f32 v76, v76, v77
    v_mfma_f32_16x16x32_bf16 v[140:143], a[48:51], a[96:99], v[140:143]
    s_add_u32 s52, s47, 532480
    v_cvt_pk_bf16_f32 v186, v60, v61
    v_cvt_pk_bf16_f32 v77, v78, v79
    v_mfma_f32_16x16x32_bf16 v[140:143], a[52:55], a[100:103], v[140:143]
    ds_read_b64_tr_b16 a[12:13], v43 offset:40960
    v_cvt_pk_bf16_f32 v187, v62, v63
    v_mfma_f32_16x16x32_bf16 v[236:239], a[60:63], a[100:103], v[236:239]
    v_cvt_pk_bf16_f32 v78, v172, v173
    v_cvt_pk_bf16_f32 v79, v174, v175
    v_mfma_f32_16x16x32_bf16 v[236:239], a[56:59], a[96:99], v[236:239]
    ds_read_b64_tr_b16 a[14:15], v43 offset:41984
    ds_read_b64_tr_b16 a[16:17], v44 offset:32768
    v_mfma_f32_16x16x32_bf16 v[156:159], a[48:51], a[104:107], v[156:159]
    v_cvt_pk_bf16_f32 v92, v92, v93
    v_cvt_pk_bf16_f32 v93, v94, v95
    v_mfma_f32_16x16x32_bf16 v[156:159], a[52:55], a[108:111], v[156:159]
    ds_read_b64_tr_b16 a[18:19], v44 offset:33792
    v_cvt_pk_bf16_f32 v94, v188, v189
    v_mfma_f32_16x16x32_bf16 v[252:255], a[60:63], a[108:111], v[252:255]
    ds_read_b64_tr_b16 a[20:21], v44 offset:40960
    v_cvt_pk_bf16_f32 v95, v190, v191
    v_mfma_f32_16x16x32_bf16 v[252:255], a[56:59], a[104:107], v[252:255]
    ds_read_b64_tr_b16 a[22:23], v44 offset:41984
    v_cvt_pk_bf16_f32 v108, v108, v109
    v_mfma_f32_16x16x32_bf16 a[152:155], a[48:51], a[112:115], a[152:155]
    v_cvt_pk_bf16_f32 v109, v110, v111
    v_cvt_pk_bf16_f32 v110, v204, v205
    v_mfma_f32_16x16x32_bf16 a[152:155], a[52:55], a[116:119], a[152:155]
    ds_read_b64_tr_b16 a[24:25], v45 offset:32768
    v_cvt_pk_bf16_f32 v111, v206, v207
    v_mfma_f32_16x16x32_bf16 a[156:159], a[60:63], a[116:119], a[156:159]
    buffer_store_dwordx4 v[164:167], v1, s[32:35], s52 offen offset:1024 sc1
    ds_read_b64_tr_b16 a[26:27], v45 offset:33792
    v_mfma_f32_16x16x32_bf16 a[156:159], a[56:59], a[112:115], a[156:159]
    ds_read_b64_tr_b16 a[28:29], v45 offset:40960
    v_cvt_pk_bf16_f32 v124, v124, v125
    v_mfma_f32_16x16x32_bf16 a[184:187], a[48:51], a[120:123], a[184:187]
    v_cvt_pk_bf16_f32 v125, v126, v127
    v_cvt_pk_bf16_f32 v126, v220, v221
    v_mfma_f32_16x16x32_bf16 a[184:187], a[52:55], a[124:127], a[184:187]
    ds_read_b64_tr_b16 a[30:31], v45 offset:41984
    v_cvt_pk_bf16_f32 v127, v222, v223
    v_mfma_f32_16x16x32_bf16 a[188:191], a[60:63], a[124:127], a[188:191]
    v_cvt_pk_bf16_f32 v140, v140, v141
    v_cvt_pk_bf16_f32 v141, v142, v143
    v_mfma_f32_16x16x32_bf16 a[188:191], a[56:59], a[120:123], a[188:191]
    v_cvt_pk_bf16_f32 v142, v236, v237
    v_cvt_pk_bf16_f32 v143, v238, v239
    v_cvt_pk_bf16_f32 v156, v156, v157
    v_cvt_pk_bf16_f32 v157, v158, v159
    v_cvt_pk_bf16_f32 v158, v252, v253
    v_cvt_pk_bf16_f32 v159, v254, v255
    v_accvgpr_read_b32 v56, a152
    v_accvgpr_read_b32 v57, a153
    v_accvgpr_read_b32 v58, a154
    v_accvgpr_read_b32 v59, a155
    v_accvgpr_read_b32 v60, a156
    v_accvgpr_read_b32 v61, a157
    v_accvgpr_read_b32 v62, a158
    v_accvgpr_read_b32 v63, a159
    v_cvt_pk_bf16_f32 v172, v56, v57
    v_cvt_pk_bf16_f32 v173, v58, v59
    v_cvt_pk_bf16_f32 v174, v60, v61
    v_cvt_pk_bf16_f32 v175, v62, v63
    v_accvgpr_read_b32 v56, a184
    v_accvgpr_read_b32 v57, a185
    v_accvgpr_read_b32 v58, a186
    v_accvgpr_read_b32 v59, a187
    v_accvgpr_read_b32 v60, a188
    v_accvgpr_read_b32 v61, a189
    v_accvgpr_read_b32 v62, a190
    v_accvgpr_read_b32 v63, a191
    v_cvt_pk_bf16_f32 v188, v56, v57
    v_cvt_pk_bf16_f32 v189, v58, v59
    v_cvt_pk_bf16_f32 v190, v60, v61
    v_cvt_pk_bf16_f32 v191, v62, v63
    s_branch k12_join_7
k12_v_6:
k12_loop_28:
    v_mfma_f32_16x16x32_bf16 v[64:67], a[192:195], a[0:3], v[64:67]
    v_mfma_f32_16x16x32_bf16 v[64:67], a[196:199], a[4:7], v[64:67]
    ds_read_b64_tr_b16 a[32:33], v32 offset:0
    v_mfma_f32_16x16x32_bf16 v[160:163], a[204:207], a[4:7], v[160:163]
    v_mfma_f32_16x16x32_bf16 v[160:163], a[200:203], a[0:3], v[160:163]
    ds_read_b64_tr_b16 a[34:35], v32 offset:2048
    v_mfma_f32_16x16x32_bf16 v[96:99], a[208:211], a[0:3], v[96:99]
    s_cmp_eq_u32 s51, s46
    s_cbranch_scc1 k12_ool_30
k12_oolret_31:
    v_mfma_f32_16x16x32_bf16 v[96:99], a[212:215], a[4:7], v[96:99]
    v_mfma_f32_16x16x32_bf16 v[192:195], a[220:223], a[4:7], v[192:195]
    ds_read_b64_tr_b16 a[36:37], v32 offset:16384
    v_mfma_f32_16x16x32_bf16 v[192:195], a[216:219], a[0:3], v[192:195]
    v_mfma_f32_16x16x32_bf16 v[128:131], a[224:227], a[0:3], v[128:131]
    v_mfma_f32_16x16x32_bf16 v[128:131], a[228:231], a[4:7], v[128:131]
    ds_read_b64_tr_b16 a[38:39], v32 offset:18432
    v_mfma_f32_16x16x32_bf16 v[224:227], a[236:239], a[4:7], v[224:227]
    v_mfma_f32_16x16x32_bf16 v[224:227], a[232:235], a[0:3], v[224:227]
    v_mfma_f32_16x16x32_bf16 a[128:131], a[240:243], a[0:3], a[128:131]
    ds_read_b64_tr_b16 a[40:41], v33 offset:0
    v_mfma_f32_16x16x32_bf16 a[128:131], a[244:247], a[4:7], a[128:131]
    v_mfma_f32_16x16x32_bf16 a[132:135], a[252:255], a[4:7], a[132:135]
    v_mfma_f32_16x16x32_bf16 a[132:135], a[248:251], a[0:3], a[132:135]
    ds_read_b64_tr_b16 a[42:43], v33 offset:2048
    v_mfma_f32_16x16x32_bf16 a[140:143], a[248:251], a[8:11], a[140:143]
    v_mfma_f32_16x16x32_bf16 a[140:143], a[252:255], a[12:15], a[140:143]
    v_mfma_f32_16x16x32_bf16 a[136:139], a[244:247], a[12:15], a[136:139]
    ds_read_b64_tr_b16 a[44:45], v33 offset:16384
    v_mfma_f32_16x16x32_bf16 a[136:139], a[240:243], a[8:11], a[136:139]
    v_mfma_f32_16x16x32_bf16 v[228:231], a[232:235], a[8:11], v[228:231]
    v_mfma_f32_16x16x32_bf16 v[228:231], a[236:239], a[12:15], v[228:231]
    ds_read_b64_tr_b16 a[46:47], v33 offset:18432
    v_mfma_f32_16x16x32_bf16 v[132:135], a[228:231], a[12:15], v[132:135]
    v_mfma_f32_16x16x32_bf16 v[132:135], a[224:227], a[8:11], v[132:135]
    ds_read_b64_tr_b16 a[48:49], v34 offset:0
    v_mfma_f32_16x16x32_bf16 v[196:199], a[216:219], a[8:11], v[196:199]
    v_mfma_f32_16x16x32_bf16 v[196:199], a[220:223], a[12:15], v[196:199]
    v_mfma_f32_16x16x32_bf16 v[100:103], a[212:215], a[12:15], v[100:103]
    ds_read_b64_tr_b16 a[50:51], v34 offset:2048
    v_mfma_f32_16x16x32_bf16 v[100:103], a[208:211], a[8:11], v[100:103]
    v_mfma_f32_16x16x32_bf16 v[164:167], a[200:203], a[8:11], v[164:167]
    v_mfma_f32_16x16x32_bf16 v[164:167], a[204:207], a[12:15], v[164:167]
    ds_read_b64_tr_b16 a[52:53], v34 offset:16384
    v_mfma_f32_16x16x32_bf16 v[68:71], a[196:199], a[12:15], v[68:71]
    v_mfma_f32_16x16x32_bf16 v[68:71], a[192:195], a[8:11], v[68:71]
    v_mfma_f32_16x16x32_bf16 v[72:75], a[192:195], a[16:19], v[72:75]
    ds_read_b64_tr_b16 a[54:55], v34 offset:18432
    v_mfma_f32_16x16x32_bf16 v[72:75], a[196:199], a[20:23], v[72:75]
    v_mfma_f32_16x16x32_bf16 v[168:171], a[204:207], a[20:23], v[168:171]
    v_mfma_f32_16x16x32_bf16 v[168:171], a[200:203], a[16:19], v[168:171]
    ds_read_b64_tr_b16 a[56:57], v35 offset:0
    v_mfma_f32_16x16x32_bf16 v[104:107], a[208:211], a[16:19], v[104:107]
    v_mfma_f32_16x16x32_bf16 v[104:107], a[212:215], a[20:23], v[104:107]
    v_mfma_f32_16x16x32_bf16 v[200:203], a[220:223], a[20:23], v[200:203]
    ds_read_b64_tr_b16 a[58:59], v35 offset:2048
    v_mfma_f32_16x16x32_bf16 v[200:203], a[216:219], a[16:19], v[200:203]
    v_mfma_f32_16x16x32_bf16 v[136:139], a[224:227], a[16:19], v[136:139]
    v_mfma_f32_16x16x32_bf16 v[136:139], a[228:231], a[20:23], v[136:139]
    ds_read_b64_tr_b16 a[60:61], v35 offset:16384
    v_mfma_f32_16x16x32_bf16 v[232:235], a[236:239], a[20:23], v[232:235]
    v_mfma_f32_16x16x32_bf16 v[232:235], a[232:235], a[16:19], v[232:235]
    v_mfma_f32_16x16x32_bf16 a[144:147], a[240:243], a[16:19], a[144:147]
    ds_read_b64_tr_b16 a[62:63], v35 offset:18432
    v_mfma_f32_16x16x32_bf16 a[144:147], a[244:247], a[20:23], a[144:147]
    v_mfma_f32_16x16x32_bf16 a[148:151], a[252:255], a[20:23], a[148:151]
    v_mfma_f32_16x16x32_bf16 a[148:151], a[248:251], a[16:19], a[148:151]
    v_mfma_f32_16x16x32_bf16 a[156:159], a[248:251], a[24:27], a[156:159]
    v_mfma_f32_16x16x32_bf16 a[156:159], a[252:255], a[28:31], a[156:159]
    v_mfma_f32_16x16x32_bf16 a[152:155], a[244:247], a[28:31], a[152:155]
    v_mfma_f32_16x16x32_bf16 a[152:155], a[240:243], a[24:27], a[152:155]
    v_mfma_f32_16x16x32_bf16 v[236:239], a[232:235], a[24:27], v[236:239]
    v_mfma_f32_16x16x32_bf16 v[236:239], a[236:239], a[28:31], v[236:239]
    v_mfma_f32_16x16x32_bf16 v[140:143], a[228:231], a[28:31], v[140:143]
    v_mfma_f32_16x16x32_bf16 v[140:143], a[224:227], a[24:27], v[140:143]
    v_mfma_f32_16x16x32_bf16 v[204:207], a[216:219], a[24:27], v[204:207]
    v_mfma_f32_16x16x32_bf16 v[204:207], a[220:223], a[28:31], v[204:207]
    v_mfma_f32_16x16x32_bf16 v[108:111], a[212:215], a[28:31], v[108:111]
    v_mfma_f32_16x16x32_bf16 v[108:111], a[208:211], a[24:27], v[108:111]
    v_mfma_f32_16x16x32_bf16 v[172:175], a[200:203], a[24:27], v[172:175]
    v_mfma_f32_16x16x32_bf16 v[172:175], a[204:207], a[28:31], v[172:175]
    v_mfma_f32_16x16x32_bf16 v[76:79], a[196:199], a[28:31], v[76:79]
    v_mfma_f32_16x16x32_bf16 v[76:79], a[192:195], a[24:27], v[76:79]
    s_waitcnt vmcnt(0) lgkmcnt(0)
    s_cmp_eq_u32 s51, s46
    s_cbranch_scc1 k12_ool_34
k12_oolret_35:
    s_barrier
    v_mfma_f32_16x16x32_bf16 v[80:83], a[192:195], a[32:35], v[80:83]
    s_cmp_ge_u32 s49, 1024
    s_cselect_b32 s18, 0, s18
    s_cselect_b32 s22, 0, s22
    v_mfma_f32_16x16x32_bf16 v[80:83], a[196:199], a[36:39], v[80:83]
    s_add_u32 m0, s48, 0
    ds_read_b128 a[64:67], v26 offset:32768
    v_mfma_f32_16x16x32_bf16 v[176:179], a[204:207], a[36:39], v[176:179]
    buffer_load_dwordx4 v10, s[16:19], s49 offen offset:0 lds
    ds_read_b64_tr_b16 a[0:1], v28 offset:32768
    v_mfma_f32_16x16x32_bf16 v[176:179], a[200:203], a[32:35], v[176:179]
    ds_read_b128 a[68:71], v27 offset:32768
    v_mfma_f32_16x16x32_bf16 v[112:115], a[208:211], a[32:35], v[112:115]
    buffer_load_dwordx4 v11, s[16:19], s49 offen offset:1024 lds
    v_mfma_f32_16x16x32_bf16 v[112:115], a[212:215], a[36:39], v[112:115]
    ds_read_b64_tr_b16 a[2:3], v28 offset:34816
    v_mfma_f32_16x16x32_bf16 v[208:211], a[220:223], a[36:39], v[208:211]
    v_mfma_f32_16x16x32_bf16 v[208:211], a[216:219], a[32:35], v[208:211]
    ds_read_b128 a[72:75], v26 offset:34816
    v_mfma_f32_16x16x32_bf16 v[144:147], a[224:227], a[32:35], v[144:147]
    buffer_load_dwordx4 v12, s[16:19], s49 offen offset:2048 lds
    ds_read_b64_tr_b16 a[4:5], v28 offset:49152
    v_mfma_f32_16x16x32_bf16 v[144:147], a[228:231], a[36:39], v[144:147]
    v_mfma_f32_16x16x32_bf16 v[240:243], a[236:239], a[36:39], v[240:243]
    ds_read_b128 a[76:79], v27 offset:34816
    v_mfma_f32_16x16x32_bf16 v[240:243], a[232:235], a[32:35], v[240:243]
    buffer_load_dwordx4 v13, s[16:19], s49 offen offset:3072 lds
    v_mfma_f32_16x16x32_bf16 a[160:163], a[240:243], a[32:35], a[160:163]
    ds_read_b64_tr_b16 a[6:7], v28 offset:51200
    v_mfma_f32_16x16x32_bf16 a[160:163], a[244:247], a[36:39], a[160:163]
    s_add_u32 m0, s48, 4096
    ds_read_b128 a[80:83], v26 offset:36864
    v_mfma_f32_16x16x32_bf16 a[164:167], a[252:255], a[36:39], a[164:167]
    v_mfma_f32_16x16x32_bf16 a[164:167], a[248:251], a[32:35], a[164:167]
    buffer_load_dwordx4 v14, s[16:19], s49 offen offset:0 lds
    ds_read_b64_tr_b16 a[8:9], v29 offset:32768
    v_mfma_f32_16x16x32_bf16 a[172:175], a[248:251], a[40:43], a[172:175]
    v_mfma_f32_16x16x32_bf16 a[172:175], a[252:255], a[44:47], a[172:175]
    ds_read_b128 a[84:87], v27 offset:36864
    v_mfma_f32_16x16x32_bf16 a[168:171], a[244:247], a[44:47], a[168:171]
    buffer_load_dwordx4 v15, s[16:19], s49 offen offset:1024 lds
    ds_read_b64_tr_b16 a[10:11], v29 offset:34816
    v_mfma_f32_16x16x32_bf16 a[168:171], a[240:243], a[40:43], a[168:171]
    v_mfma_f32_16x16x32_bf16 v[244:247], a[232:235], a[40:43], v[244:247]
    ds_read_b128 a[88:91], v26 offset:38912
    v_mfma_f32_16x16x32_bf16 v[244:247], a[236:239], a[44:47], v[244:247]
    v_mfma_f32_16x16x32_bf16 v[148:151], a[228:231], a[44:47], v[148:151]
    buffer_load_dwordx4 v16, s[16:19], s49 offen offset:2048 lds
    ds_read_b64_tr_b16 a[12:13], v29 offset:49152
    v_mfma_f32_16x16x32_bf16 v[148:151], a[224:227], a[40:43], v[148:151]
    ds_read_b128 a[92:95], v27 offset:38912
    v_mfma_f32_16x16x32_bf16 v[212:215], a[216:219], a[40:43], v[212:215]
    v_mfma_f32_16x16x32_bf16 v[212:215], a[220:223], a[44:47], v[212:215]
    buffer_load_dwordx4 v17, s[16:19], s49 offen offset:3072 lds
    ds_read_b64_tr_b16 a[14:15], v29 offset:51200
    v_mfma_f32_16x16x32_bf16 v[116:119], a[212:215], a[44:47], v[116:119]
    ds_read_b128 a[96:99], v26 offset:40960
    v_mfma_f32_16x16x32_bf16 v[116:119], a[208:211], a[40:43], v[116:119]
    s_add_u32 s49, s49, 128
    v_mfma_f32_16x16x32_bf16 v[180:183], a[200:203], a[40:43], v[180:183]
    s_add_u32 m0, s48, 65536
    ds_read_b64_tr_b16 a[16:17], v30 offset:32768
    v_mfma_f32_16x16x32_bf16 v[180:183], a[204:207], a[44:47], v[180:183]
    buffer_load_dwordx4 v18, s[20:23], s50 offen offset:0 lds
    v_mfma_f32_16x16x32_bf16 v[84:87], a[196:199], a[44:47], v[84:87]
    ds_read_b128 a[100:103], v27 offset:40960
    v_mfma_f32_16x16x32_bf16 v[84:87], a[192:195], a[40:43], v[84:87]
    ds_read_b64_tr_b16 a[18:19], v30 offset:34816
    v_mfma_f32_16x16x32_bf16 v[88:91], a[192:195], a[48:51], v[88:91]
    buffer_load_dwordx4 v19, s[20:23], s50 offen offset:1024 lds
    v_mfma_f32_16x16x32_bf16 v[88:91], a[196:199], a[52:55], v[88:91]
    ds_read_b128 a[104:107], v26 offset:43008
    v_mfma_f32_16x16x32_bf16 v[184:187], a[204:207], a[52:55], v[184:187]
    v_mfma_f32_16x16x32_bf16 v[184:187], a[200:203], a[48:51], v[184:187]
    buffer_load_dwordx4 v20, s[20:23], s50 offen offset:2048 lds
    ds_read_b64_tr_b16 a[20:21], v30 offset:49152
    v_mfma_f32_16x16x32_bf16 v[120:123], a[208:211], a[48:51], v[120:123]
    ds_read_b128 a[108:111], v27 offset:43008
    v_mfma_f32_16x16x32_bf16 v[120:123], a[212:215], a[52:55], v[120:123]
    v_mfma_f32_16x16x32_bf16 v[216:219], a[220:223], a[52:55], v[216:219]
    ds_read_b64_tr_b16 a[22:23], v30 offset:51200
    v_mfma_f32_16x16x32_bf16 v[216:219], a[216:219], a[48:51], v[216:219]
    buffer_load_dwordx4 v21, s[20:23], s50 offen offset:3072 lds
    v_mfma_f32_16x16x32_bf16 v[152:155], a[224:227], a[48:51], v[152:155]
    s_add_u32 m0, s48, 69632
    ds_read_b128 a[112:115], v26 offset:45056
    v_mfma_f32_16x16x32_bf16 v[152:155], a[228:231], a[52:55], v[152:155]
    ds_read_b64_tr_b16 a[24:25], v31 offset:32768
    v_mfma_f32_16x16x32_bf16 v[248:251], a[236:239], a[52:55], v[248:251]
    buffer_load_dwordx4 v22, s[20:23], s50 offen offset:0 lds
    v_mfma_f32_16x16x32_bf16 v[248:251], a[232:235], a[48:51], v[248:251]
    ds_read_b128 a[116:119], v27 offset:45056
    v_mfma_f32_16x16x32_bf16 a[176:179], a[240:243], a[48:51], a[176:179]
    v_mfma_f32_16x16x32_bf16 a[176:179], a[244:247], a[52:55], a[176:179]
    ds_read_b64_tr_b16 a[26:27], v31 offset:34816
    v_mfma_f32_16x16x32_bf16 a[180:183], a[252:255], a[52:55], a[180:183]
    buffer_load_dwordx4 v23, s[20:23], s50 offen offset:1024 lds
    ds_read_b128 a[120:123], v26 offset:47104
    v_mfma_f32_16x16x32_bf16 a[180:183], a[248:251], a[48:51], a[180:183]
    v_mfma_f32_16x16x32_bf16 a[188:191], a[248:251], a[56:59], a[188:191]
    ds_read_b64_tr_b16 a[28:29], v31 offset:49152
    v_mfma_f32_16x16x32_bf16 a[188:191], a[252:255], a[60:63], a[188:191]
    buffer_load_dwordx4 v24, s[20:23], s50 offen offset:2048 lds
    v_mfma_f32_16x16x32_bf16 a[184:187], a[244:247], a[60:63], a[184:187]
    ds_read_b128 a[124:127], v27 offset:47104
    v_mfma_f32_16x16x32_bf16 a[184:187], a[240:243], a[56:59], a[184:187]
    ds_read_b64_tr_b16 a[30:31], v31 offset:51200
    v_mfma_f32_16x16x32_bf16 v[252:255], a[232:235], a[56:59], v[252:255]
    v_mfma_f32_16x16x32_bf16 v[252:255], a[236:239], a[60:63], v[252:255]
    buffer_load_dwordx4 v25, s[20:23], s50 offen offset:3072 lds
    v_mfma_f32_16x16x32_bf16 v[156:159], a[228:231], a[60:63], v[156:159]
    v_mfma_f32_16x16x32_bf16 v[156:159], a[224:227], a[56:59], v[156:159]
    s_add_u32 s50, s50, 0x80000
    v_mfma_f32_16x16x32_bf16 v[220:223], a[216:219], a[56:59], v[220:223]
    v_mfma_f32_16x16x32_bf16 v[220:223], a[220:223], a[60:63], v[220:223]
    s_cmp_eq_u32 s51, s53
    s_cbranch_scc1 k12_ool_36
k12_oolret_37:
    v_mfma_f32_16x16x32_bf16 v[124:127], a[212:215], a[60:63], v[124:127]
    s_cmp_eq_u32 s51, s63
    s_cbranch_scc1 k12_ool_38
k12_oolret_39:
    v_mfma_f32_16x16x32_bf16 v[124:127], a[208:211], a[56:59], v[124:127]
    s_cmp_eq_u32 s51, 6
    s_cbranch_scc1 k12_ool_40
k12_oolret_41:
    v_mfma_f32_16x16x32_bf16 v[188:191], a[200:203], a[56:59], v[188:191]
    v_mfma_f32_16x16x32_bf16 v[188:191], a[204:207], a[60:63], v[188:191]
    s_add_u32 s51, s51, 1
    v_mfma_f32_16x16x32_bf16 v[92:95], a[196:199], a[60:63], v[92:95]
    v_mfma_f32_16x16x32_bf16 v[92:95], a[192:195], a[56:59], v[92:95]
    s_waitcnt lgkmcnt(0)
    s_cmp_eq_u32 s51, 7
    s_cbranch_scc1 k12_last_29
    v_mfma_f32_16x16x32_bf16 v[64:67], a[64:67], a[0:3], v[64:67]
    v_mfma_f32_16x16x32_bf16 v[64:67], a[68:71], a[4:7], v[64:67]
    ds_read_b64_tr_b16 a[32:33], v32 offset:32768
    v_mfma_f32_16x16x32_bf16 v[160:163], a[76:79], a[4:7], v[160:163]
    v_mfma_f32_16x16x32_bf16 v[160:163], a[72:75], a[0:3], v[160:163]
    ds_read_b64_tr_b16 a[34:35], v32 offset:34816
    v_mfma_f32_16x16x32_bf16 v[96:99], a[80:83], a[0:3], v[96:99]
    v_mfma_f32_16x16x32_bf16 v[96:99], a[84:87], a[4:7], v[96:99]
    v_mfma_f32_16x16x32_bf16 v[192:195], a[92:95], a[4:7], v[192:195]
    ds_read_b64_tr_b16 a[36:37], v32 offset:49152
    v_mfma_f32_16x16x32_bf16 v[192:195], a[88:91], a[0:3], v[192:195]
    v_mfma_f32_16x16x32_bf16 v[128:131], a[96:99], a[0:3], v[128:131]
    v_mfma_f32_16x16x32_bf16 v[128:131], a[100:103], a[4:7], v[128:131]
    ds_read_b64_tr_b16 a[38:39], v32 offset:51200
    v_mfma_f32_16x16x32_bf16 v[224:227], a[108:111], a[4:7], v[224:227]
    v_mfma_f32_16x16x32_bf16 v[224:227], a[104:107], a[0:3], v[224:227]
    v_mfma_f32_16x16x32_bf16 a[128:131], a[112:115], a[0:3], a[128:131]
    ds_read_b64_tr_b16 a[40:41], v33 offset:32768
    v_mfma_f32_16x16x32_bf16 a[128:131], a[116:119], a[4:7], a[128:131]
    v_mfma_f32_16x16x32_bf16 a[132:135], a[124:127], a[4:7], a[132:135]
    v_mfma_f32_16x16x32_bf16 a[132:135], a[120:123], a[0:3], a[132:135]
    ds_read_b64_tr_b16 a[42:43], v33 offset:34816
    v_mfma_f32_16x16x32_bf16 a[140:143], a[120:123], a[8:11], a[140:143]
    v_mfma_f32_16x16x32_bf16 a[140:143], a[124:127], a[12:15], a[140:143]
    v_mfma_f32_16x16x32_bf16 a[136:139], a[116:119], a[12:15], a[136:139]
    ds_read_b64_tr_b16 a[44:45], v33 offset:49152
    v_mfma_f32_16x16x32_bf16 a[136:139], a[112:115], a[8:11], a[136:139]
    v_mfma_f32_16x16x32_bf16 v[228:231], a[104:107], a[8:11], v[228:231]
    v_mfma_f32_16x16x32_bf16 v[228:231], a[108:111], a[12:15], v[228:231]
    ds_read_b64_tr_b16 a[46:47], v33 offset:51200
    v_mfma_f32_16x16x32_bf16 v[132:135], a[100:103], a[12:15], v[132:135]
    v_mfma_f32_16x16x32_bf16 v[132:135], a[96:99], a[8:11], v[132:135]
    ds_read_b64_tr_b16 a[48:49], v34 offset:32768
    v_mfma_f32_16x16x32_bf16 v[196:199], a[88:91], a[8:11], v[196:199]
    v_mfma_f32_16x16x32_bf16 v[196:199], a[92:95], a[12:15], v[196:199]
    v_mfma_f32_16x16x32_bf16 v[100:103], a[84:87], a[12:15], v[100:103]
    ds_read_b64_tr_b16 a[50:51], v34 offset:34816
    v_mfma_f32_16x16x32_bf16 v[100:103], a[80:83], a[8:11], v[100:103]
    v_mfma_f32_16x16x32_bf16 v[164:167], a[72:75], a[8:11], v[164:167]
    v_mfma_f32_16x16x32_bf16 v[164:167], a[76:79], a[12:15], v[164:167]
    ds_read_b64_tr_b16 a[52:53], v34 offset:49152
    v_mfma_f32_16x16x32_bf16 v[68:71], a[68:71], a[12:15], v[68:71]
    v_mfma_f32_16x16x32_bf16 v[68:71], a[64:67], a[8:11], v[68:71]
    v_mfma_f32_16x16x32_bf16 v[72:75], a[64:67], a[16:19], v[72:75]
    ds_read_b64_tr_b16 a[54:55], v34 offset:51200
    v_mfma_f32_16x16x32_bf16 v[72:75], a[68:71], a[20:23], v[72:75]
    v_mfma_f32_16x16x32_bf16 v[168:171], a[76:79], a[20:23], v[168:171]
    v_mfma_f32_16x16x32_bf16 v[168:171], a[72:75], a[16:19], v[168:171]
    ds_read_b64_tr_b16 a[56:57], v35 offset:32768
    v_mfma_f32_16x16x32_bf16 v[104:107], a[80:83], a[16:19], v[104:107]
    v_mfma_f32_16x16x32_bf16 v[104:107], a[84:87], a[20:23], v[104:107]
    v_mfma_f32_16x16x32_bf16 v[200:203], a[92:95], a[20:23], v[200:203]
    ds_read_b64_tr_b16 a[58:59], v35 offset:34816
    v_mfma_f32_16x16x32_bf16 v[200:203], a[88:91], a[16:19], v[200:203]
    v_mfma_f32_16x16x32_bf16 v[136:139], a[96:99], a[16:19], v[136:139]
    v_mfma_f32_16x16x32_bf16 v[136:139], a[100:103], a[20:23], v[136:139]
    ds_read_b64_tr_b16 a[60:61], v35 offset:49152
    v_mfma_f32_16x16x32_bf16 v[232:235], a[108:111], a[20:23], v[232:235]
    v_mfma_f32_16x16x32_bf16 v[232:235], a[104:107], a[16:19], v[232:235]
    v_mfma_f32_16x16x32_bf16 a[144:147], a[112:115], a[16:19], a[144:147]
    ds_read_b64_tr_b16 a[62:63], v35 offset:51200
    v_mfma_f32_16x16x32_bf16 a[144:147], a[116:119], a[20:23], a[144:147]
    v_mfma_f32_16x16x32_bf16 a[148:151], a[124:127], a[20:23], a[148:151]
    v_mfma_f32_16x16x32_bf16 a[148:151], a[120:123], a[16:19], a[148:151]
    v_mfma_f32_16x16x32_bf16 a[156:159], a[120:123], a[24:27], a[156:159]
    v_mfma_f32_16x16x32_bf16 a[156:159], a[124:127], a[28:31], a[156:159]
    v_mfma_f32_16x16x32_bf16 a[152:155], a[116:119], a[28:31], a[152:155]
    v_mfma_f32_16x16x32_bf16 a[152:155], a[112:115], a[24:27], a[152:155]
    v_mfma_f32_16x16x32_bf16 v[236:239], a[104:107], a[24:27], v[236:239]
    v_mfma_f32_16x16x32_bf16 v[236:239], a[108:111], a[28:31], v[236:239]
    v_mfma_f32_16x16x32_bf16 v[140:143], a[100:103], a[28:31], v[140:143]
    v_mfma_f32_16x16x32_bf16 v[140:143], a[96:99], a[24:27], v[140:143]
    v_mfma_f32_16x16x32_bf16 v[204:207], a[88:91], a[24:27], v[204:207]
    v_mfma_f32_16x16x32_bf16 v[204:207], a[92:95], a[28:31], v[204:207]
    v_mfma_f32_16x16x32_bf16 v[108:111], a[84:87], a[28:31], v[108:111]
    v_mfma_f32_16x16x32_bf16 v[108:111], a[80:83], a[24:27], v[108:111]
    v_mfma_f32_16x16x32_bf16 v[172:175], a[72:75], a[24:27], v[172:175]
    v_mfma_f32_16x16x32_bf16 v[172:175], a[76:79], a[28:31], v[172:175]
    v_mfma_f32_16x16x32_bf16 v[76:79], a[68:71], a[28:31], v[76:79]
    v_mfma_f32_16x16x32_bf16 v[76:79], a[64:67], a[24:27], v[76:79]
    s_waitcnt vmcnt(0) lgkmcnt(0)
    s_barrier
    v_mfma_f32_16x16x32_bf16 v[80:83], a[64:67], a[32:35], v[80:83]
    v_mfma_f32_16x16x32_bf16 v[80:83], a[68:71], a[36:39], v[80:83]
    s_add_u32 m0, s48, 32768
    ds_read_b128 a[192:195], v26 offset:0
    v_mfma_f32_16x16x32_bf16 v[176:179], a[76:79], a[36:39], v[176:179]
    buffer_load_dwordx4 v10, s[16:19], s49 offen offset:0 lds
    ds_read_b64_tr_b16 a[0:1], v28 offset:0
    v_mfma_f32_16x16x32_bf16 v[176:179], a[72:75], a[32:35], v[176:179]
    ds_read_b128 a[196:199], v27 offset:0
    v_mfma_f32_16x16x32_bf16 v[112:115], a[80:83], a[32:35], v[112:115]
    buffer_load_dwordx4 v11, s[16:19], s49 offen offset:1024 lds
    v_mfma_f32_16x16x32_bf16 v[112:115], a[84:87], a[36:39], v[112:115]
    ds_read_b64_tr_b16 a[2:3], v28 offset:2048
    v_mfma_f32_16x16x32_bf16 v[208:211], a[92:95], a[36:39], v[208:211]
    v_mfma_f32_16x16x32_bf16 v[208:211], a[88:91], a[32:35], v[208:211]
    ds_read_b128 a[200:203], v26 offset:2048
    v_mfma_f32_16x16x32_bf16 v[144:147], a[96:99], a[32:35], v[144:147]
    buffer_load_dwordx4 v12, s[16:19], s49 offen offset:2048 lds
    ds_read_b64_tr_b16 a[4:5], v28 offset:16384
    v_mfma_f32_16x16x32_bf16 v[144:147], a[100:103], a[36:39], v[144:147]
    v_mfma_f32_16x16x32_bf16 v[240:243], a[108:111], a[36:39], v[240:243]
    ds_read_b128 a[204:207], v27 offset:2048
    v_mfma_f32_16x16x32_bf16 v[240:243], a[104:107], a[32:35], v[240:243]
    buffer_load_dwordx4 v13, s[16:19], s49 offen offset:3072 lds
    v_mfma_f32_16x16x32_bf16 a[160:163], a[112:115], a[32:35], a[160:163]
    ds_read_b64_tr_b16 a[6:7], v28 offset:18432
    v_mfma_f32_16x16x32_bf16 a[160:163], a[116:119], a[36:39], a[160:163]
    s_add_u32 m0, s48, 36864
    ds_read_b128 a[208:211], v26 offset:4096
    v_mfma_f32_16x16x32_bf16 a[164:167], a[124:127], a[36:39], a[164:167]
    v_mfma_f32_16x16x32_bf16 a[164:167], a[120:123], a[32:35], a[164:167]
    buffer_load_dwordx4 v14, s[16:19], s49 offen offset:0 lds
    ds_read_b64_tr_b16 a[8:9], v29 offset:0
    v_mfma_f32_16x16x32_bf16 a[172:175], a[120:123], a[40:43], a[172:175]
    v_mfma_f32_16x16x32_bf16 a[172:175], a[124:127], a[44:47], a[172:175]
    ds_read_b128 a[212:215], v27 offset:4096
    v_mfma_f32_16x16x32_bf16 a[168:171], a[116:119], a[44:47], a[168:171]
    buffer_load_dwordx4 v15, s[16:19], s49 offen offset:1024 lds
    ds_read_b64_tr_b16 a[10:11], v29 offset:2048
    v_mfma_f32_16x16x32_bf16 a[168:171], a[112:115], a[40:43], a[168:171]
    v_mfma_f32_16x16x32_bf16 v[244:247], a[104:107], a[40:43], v[244:247]
    ds_read_b128 a[216:219], v26 offset:6144
    v_mfma_f32_16x16x32_bf16 v[244:247], a[108:111], a[44:47], v[244:247]
    v_mfma_f32_16x16x32_bf16 v[148:151], a[100:103], a[44:47], v[148:151]
    buffer_load_dwordx4 v16, s[16:19], s49 offen offset:2048 lds
    ds_read_b64_tr_b16 a[12:13], v29 offset:16384
    v_mfma_f32_16x16x32_bf16 v[148:151], a[96:99], a[40:43], v[148:151]
    ds_read_b128 a[220:223], v27 offset:6144
    v_mfma_f32_16x16x32_bf16 v[212:215], a[88:91], a[40:43], v[212:215]
    v_mfma_f32_16x16x32_bf16 v[212:215], a[92:95], a[44:47], v[212:215]
    buffer_load_dwordx4 v17, s[16:19], s49 offen offset:3072 lds
    ds_read_b64_tr_b16 a[14:15], v29 offset:18432
    v_mfma_f32_16x16x32_bf16 v[116:119], a[84:87], a[44:47], v[116:119]
    ds_read_b128 a[224:227], v26 offset:8192
    v_mfma_f32_16x16x32_bf16 v[116:119], a[80:83], a[40:43], v[116:119]
    s_add_u32 s49, s49, 128
    v_mfma_f32_16x16x32_bf16 v[180:183], a[72:75], a[40:43], v[180:183]
    s_add_u32 m0, s48, 98304
    ds_read_b64_tr_b16 a[16:17], v30 offset:0
    v_mfma_f32_16x16x32_bf16 v[180:183], a[76:79], a[44:47], v[180:183]
    buffer_load_dwordx4 v18, s[20:23], s50 offen offset:0 lds
    v_mfma_f32_16x16x32_bf16 v[84:87], a[68:71], a[44:47], v[84:87]
    ds_read_b128 a[228:231], v27 offset:8192
    v_mfma_f32_16x16x32_bf16 v[84:87], a[64:67], a[40:43], v[84:87]
    ds_read_b64_tr_b16 a[18:19], v30 offset:2048
    v_mfma_f32_16x16x32_bf16 v[88:91], a[64:67], a[48:51], v[88:91]
    buffer_load_dwordx4 v19, s[20:23], s50 offen offset:1024 lds
    v_mfma_f32_16x16x32_bf16 v[88:91], a[68:71], a[52:55], v[88:91]
    ds_read_b128 a[232:235], v26 offset:10240
    v_mfma_f32_16x16x32_bf16 v[184:187], a[76:79], a[52:55], v[184:187]
    v_mfma_f32_16x16x32_bf16 v[184:187], a[72:75], a[48:51], v[184:187]
    buffer_load_dwordx4 v20, s[20:23], s50 offen offset:2048 lds
    ds_read_b64_tr_b16 a[20:21], v30 offset:16384
    v_mfma_f32_16x16x32_bf16 v[120:123], a[80:83], a[48:51], v[120:123]
    ds_read_b128 a[236:239], v27 offset:10240
    v_mfma_f32_16x16x32_bf16 v[120:123], a[84:87], a[52:55], v[120:123]
    v_mfma_f32_16x16x32_bf16 v[216:219], a[92:95], a[52:55], v[216:219]
    ds_read_b64_tr_b16 a[22:23], v30 offset:18432
    v_mfma_f32_16x16x32_bf16 v[216:219], a[88:91], a[48:51], v[216:219]
    buffer_load_dwordx4 v21, s[20:23], s50 offen offset:3072 lds
    v_mfma_f32_16x16x32_bf16 v[152:155], a[96:99], a[48:51], v[152:155]
    s_add_u32 m0, s48, 102400
    ds_read_b128 a[240:243], v26 offset:12288
    v_mfma_f32_16x16x32_bf16 v[152:155], a[100:103], a[52:55], v[152:155]
    ds_read_b64_tr_b16 a[24:25], v31 offset:0
    v_mfma_f32_16x16x32_bf16 v[248:251], a[108:111], a[52:55], v[248:251]
    buffer_load_dwordx4 v22, s[20:23], s50 offen offset:0 lds
    v_mfma_f32_16x16x32_bf16 v[248:251], a[104:107], a[48:51], v[248:251]
    ds_read_b128 a[244:247], v27 offset:12288
    v_mfma_f32_16x16x32_bf16 a[176:179], a[112:115], a[48:51], a[176:179]
    v_mfma_f32_16x16x32_bf16 a[176:179], a[116:119], a[52:55], a[176:179]
    ds_read_b64_tr_b16 a[26:27], v31 offset:2048
    v_mfma_f32_16x16x32_bf16 a[180:183], a[124:127], a[52:55], a[180:183]
    buffer_load_dwordx4 v23, s[20:23], s50 offen offset:1024 lds
    ds_read_b128 a[248:251], v26 offset:14336
    v_mfma_f32_16x16x32_bf16 a[180:183], a[120:123], a[48:51], a[180:183]
    v_mfma_f32_16x16x32_bf16 a[188:191], a[120:123], a[56:59], a[188:191]
    ds_read_b64_tr_b16 a[28:29], v31 offset:16384
    v_mfma_f32_16x16x32_bf16 a[188:191], a[124:127], a[60:63], a[188:191]
    buffer_load_dwordx4 v24, s[20:23], s50 offen offset:2048 lds
    v_mfma_f32_16x16x32_bf16 a[184:187], a[116:119], a[60:63], a[184:187]
    ds_read_b128 a[252:255], v27 offset:14336
    v_mfma_f32_16x16x32_bf16 a[184:187], a[112:115], a[56:59], a[184:187]
    ds_read_b64_tr_b16 a[30:31], v31 offset:18432
    v_mfma_f32_16x16x32_bf16 v[252:255], a[104:107], a[56:59], v[252:255]
    v_mfma_f32_16x16x32_bf16 v[252:255], a[108:111], a[60:63], v[252:255]
    buffer_load_dwordx4 v25, s[20:23], s50 offen offset:3072 lds
    v_mfma_f32_16x16x32_bf16 v[156:159], a[100:103], a[60:63], v[156:159]
    v_mfma_f32_16x16x32_bf16 v[156:159], a[96:99], a[56:59], v[156:159]
    s_add_u32 s50, s50, 0x80000
    v_mfma_f32_16x16x32_bf16 v[220:223], a[88:91], a[56:59], v[220:223]
    v_mfma_f32_16x16x32_bf16 v[220:223], a[92:95], a[60:63], v[220:223]
    s_cmp_eq_u32 s51, s53
    s_cbranch_scc1 k12_ool_42
k12_oolret_43:
    v_mfma_f32_16x16x32_bf16 v[124:127], a[84:87], a[60:63], v[124:127]
    s_cmp_eq_u32 s51, s63
    s_cbranch_scc1 k12_ool_44
k12_oolret_45:
    v_mfma_f32_16x16x32_bf16 v[124:127], a[80:83], a[56:59], v[124:127]
    s_cmp_eq_u32 s51, 5
    s_cbranch_scc1 k12_ool_46
k12_oolret_47:
    v_mfma_f32_16x16x32_bf16 v[188:191], a[72:75], a[56:59], v[188:191]
    v_mfma_f32_16x16x32_bf16 v[188:191], a[76:79], a[60:63], v[188:191]
    s_add_u32 s51, s51, 1
    v_mfma_f32_16x16x32_bf16 v[92:95], a[68:71], a[60:63], v[92:95]
    v_mfma_f32_16x16x32_bf16 v[92:95], a[64:67], a[56:59], v[92:95]
    s_waitcnt lgkmcnt(0)
    s_branch k12_loop_28
k12_last_29:
    v_mfma_f32_16x16x32_bf16 v[64:67], a[64:67], a[0:3], v[64:67]
    buffer_load_dwordx4 a[192:195], v36, s[8:11], s62 offen sc1
    v_mfma_f32_16x16x32_bf16 v[64:67], a[68:71], a[4:7], v[64:67]
    ds_read_b64_tr_b16 a[32:33], v32 offset:32768
    v_mfma_f32_16x16x32_bf16 v[160:163], a[76:79], a[4:7], v[160:163]
    buffer_load_dwordx4 a[196:199], v54, s[8:11], s62 offen sc1
    ds_read_b64_tr_b16 a[34:35], v32 offset:34816
    v_mfma_f32_16x16x32_bf16 v[160:163], a[72:75], a[0:3], v[160:163]
    v_mfma_f32_16x16x32_bf16 v[96:99], a[80:83], a[0:3], v[96:99]
    buffer_load_dwordx4 a[200:203], v37, s[8:11], s62 offen sc1
    v_mfma_f32_16x16x32_bf16 v[96:99], a[84:87], a[4:7], v[96:99]
    ds_read_b64_tr_b16 a[36:37], v32 offset:49152
    v_mfma_f32_16x16x32_bf16 v[192:195], a[92:95], a[4:7], v[192:195]
    buffer_load_dwordx4 a[204:207], v55, s[8:11], s62 offen sc1
    v_mfma_f32_16x16x32_bf16 v[192:195], a[88:91], a[0:3], v[192:195]
    s_add_u32 s62, s62, 0x20000
    buffer_load_dwordx4 a[208:211], v36, s[8:11], s62 offen sc1
    ds_read_b64_tr_b16 a[38:39], v32 offset:51200
    v_mfma_f32_16x16x32_bf16 v[128:131], a[96:99], a[0:3], v[128:131]
    v_mfma_f32_16x16x32_bf16 v[128:131], a[100:103], a[4:7], v[128:131]
    v_cvt_pk_bf16_f32 v64, v64, v65
    v_cvt_pk_bf16_f32 v65, v66, v67
    v_mfma_f32_16x16x32_bf16 v[224:227], a[108:111], a[4:7], v[224:227]
    v_cvt_pk_bf16_f32 v66, v160, v161
    v_cvt_pk_bf16_f32 v67, v162, v163
    v_mfma_f32_16x16x32_bf16 v[224:227], a[104:107], a[0:3], v[224:227]
    buffer_load_dwordx4 a[212:215], v54, s[8:11], s62 offen sc1
    ds_read_b64_tr_b16 a[40:41], v33 offset:32768
    v_mfma_f32_16x16x32_bf16 a[128:131], a[112:115], a[0:3], a[128:131]
    buffer_load_dwordx4 a[216:219], v37, s[8:11], s62 offen sc1
    ds_read_b64_tr_b16 a[42:43], v33 offset:34816
    v_mfma_f32_16x16x32_bf16 a[128:131], a[116:119], a[4:7], a[128:131]
    v_cvt_pk_bf16_f32 v96, v96, v97
    v_cvt_pk_bf16_f32 v97, v98, v99
    v_mfma_f32_16x16x32_bf16 a[132:135], a[124:127], a[4:7], a[132:135]
    v_cvt_pk_bf16_f32 v98, v192, v193
    v_cvt_pk_bf16_f32 v99, v194, v195
    v_mfma_f32_16x16x32_bf16 a[132:135], a[120:123], a[0:3], a[132:135]
    buffer_load_dwordx4 a[220:223], v55, s[8:11], s62 offen sc1
    ds_read_b64_tr_b16 a[44:45], v33 offset:49152
    v_mfma_f32_16x16x32_bf16 v[68:71], a[64:67], a[8:11], v[68:71]
    s_add_u32 s62, s62, 0x20000
    buffer_load_dwordx4 a[224:227], v36, s[8:11], s62 offen sc1
    v_mfma_f32_16x16x32_bf16 v[68:71], a[68:71], a[12:15], v[68:71]
    v_cvt_pk_bf16_f32 v128, v128, v129
    v_cvt_pk_bf16_f32 v129, v130, v131
    v_mfma_f32_16x16x32_bf16 v[164:167], a[76:79], a[12:15], v[164:167]
    buffer_load_dwordx4 a[228:231], v54, s[8:11], s62 offen sc1
    ds_read_b64_tr_b16 a[46:47], v33 offset:51200
    v_mfma_f32_16x16x32_bf16 v[164:167], a[72:75], a[8:11], v[164:167]
    v_cvt_pk_bf16_f32 v130, v224, v225
    v_cvt_pk_bf16_f32 v131, v226, v227
    v_mfma_f32_16x16x32_bf16 v[100:103], a[80:83], a[8:11], v[100:103]
    buffer_load_dwordx4 a[232:235], v37, s[8:11], s62 offen sc1
    ds_read_b64_tr_b16 a[48:49], v34 offset:32768
    v_mfma_f32_16x16x32_bf16 v[100:103], a[84:87], a[12:15], v[100:103]
    v_accvgpr_read_b32 v56, a128
    v_accvgpr_read_b32 v57, a129
    v_mfma_f32_16x16x32_bf16 v[196:199], a[92:95], a[12:15], v[196:199]
    buffer_load_dwordx4 a[236:239], v55, s[8:11], s62 offen sc1
    ds_read_b64_tr_b16 a[50:51], v34 offset:34816
    v_mfma_f32_16x16x32_bf16 v[196:199], a[88:91], a[8:11], v[196:199]
    s_add_u32 s62, s62, 0x20000
    v_accvgpr_read_b32 v58, a130
    v_accvgpr_read_b32 v59, a131
    v_mfma_f32_16x16x32_bf16 v[132:135], a[96:99], a[8:11], v[132:135]
    v_accvgpr_read_b32 v60, a132
    v_accvgpr_read_b32 v61, a133
    v_mfma_f32_16x16x32_bf16 v[132:135], a[100:103], a[12:15], v[132:135]
    v_accvgpr_read_b32 v62, a134
    v_accvgpr_read_b32 v63, a135
    v_mfma_f32_16x16x32_bf16 v[228:231], a[108:111], a[12:15], v[228:231]
    buffer_load_dwordx4 a[240:243], v36, s[8:11], s62 offen sc1
    ds_read_b64_tr_b16 a[52:53], v34 offset:49152
    v_mfma_f32_16x16x32_bf16 v[228:231], a[104:107], a[8:11], v[228:231]
    v_cvt_pk_bf16_f32 v160, v56, v57
    v_cvt_pk_bf16_f32 v161, v58, v59
    v_mfma_f32_16x16x32_bf16 a[136:139], a[112:115], a[8:11], a[136:139]
    v_cvt_pk_bf16_f32 v68, v68, v69
    v_cvt_pk_bf16_f32 v162, v60, v61
    v_mfma_f32_16x16x32_bf16 a[136:139], a[116:119], a[12:15], a[136:139]
    buffer_load_dwordx4 a[244:247], v54, s[8:11], s62 offen sc1
    v_cvt_pk_bf16_f32 v69, v70, v71
    v_mfma_f32_16x16x32_bf16 a[140:143], a[124:127], a[12:15], a[140:143]
    v_cvt_pk_bf16_f32 v163, v62, v63
    v_cvt_pk_bf16_f32 v70, v164, v165
    v_mfma_f32_16x16x32_bf16 a[140:143], a[120:123], a[8:11], a[140:143]
    buffer_load_dwordx4 a[248:251], v37, s[8:11], s62 offen sc1
    v_cvt_pk_bf16_f32 v71, v166, v167
    v_mfma_f32_16x16x32_bf16 v[72:75], a[64:67], a[16:19], v[72:75]
    ds_read_b64_tr_b16 a[54:55], v34 offset:51200
    v_cvt_pk_bf16_f32 v100, v100, v101
    v_mfma_f32_16x16x32_bf16 v[72:75], a[68:71], a[20:23], v[72:75]
    buffer_load_dwordx4 a[252:255], v55, s[8:11], s62 offen sc1
    v_cvt_pk_bf16_f32 v101, v102, v103
    v_mfma_f32_16x16x32_bf16 v[168:171], a[76:79], a[20:23], v[168:171]
    s_add_u32 s62, s62, 0x20000
    ds_read_b64_tr_b16 a[56:57], v35 offset:32768
    v_cvt_pk_bf16_f32 v102, v196, v197
    v_mfma_f32_16x16x32_bf16 v[168:171], a[72:75], a[16:19], v[168:171]
    s_add_u32 s52, s47, 0
    ds_read_b64_tr_b16 a[58:59], v35 offset:34816
    v_cvt_pk_bf16_f32 v103, v198, v199
    v_mfma_f32_16x16x32_bf16 v[104:107], a[80:83], a[16:19], v[104:107]
    v_cvt_pk_bf16_f32 v132, v132, v133
    v_cvt_pk_bf16_f32 v133, v134, v135
    v_mfma_f32_16x16x32_bf16 v[104:107], a[84:87], a[20:23], v[104:107]
    v_cvt_pk_bf16_f32 v134, v228, v229
    v_cvt_pk_bf16_f32 v135, v230, v231
    v_mfma_f32_16x16x32_bf16 v[200:203], a[92:95], a[20:23], v[200:203]
    buffer_store_dwordx4 v[64:67], v1, s[32:35], s52 offen offset:0 sc1
    ds_read_b64_tr_b16 a[60:61], v35 offset:49152
    v_mfma_f32_16x16x32_bf16 v[200:203], a[88:91], a[16:19], v[200:203]
    v_accvgpr_read_b32 v56, a136
    v_accvgpr_read_b32 v57, a137
    v_mfma_f32_16x16x32_bf16 v[136:139], a[96:99], a[16:19], v[136:139]
    ds_read_b64_tr_b16 a[62:63], v35 offset:51200
    v_accvgpr_read_b32 v58, a138
    v_mfma_f32_16x16x32_bf16 v[136:139], a[100:103], a[20:23], v[136:139]
    v_accvgpr_read_b32 v59, a139
    v_accvgpr_read_b32 v60, a140
    v_mfma_f32_16x16x32_bf16 v[232:235], a[108:111], a[20:23], v[232:235]
    v_accvgpr_read_b32 v61, a141
    v_accvgpr_read_b32 v62, a142
    v_mfma_f32_16x16x32_bf16 v[232:235], a[104:107], a[16:19], v[232:235]
    s_add_u32 s52, s47, 8192
    v_accvgpr_read_b32 v63, a143
    v_cvt_pk_bf16_f32 v164, v56, v57
    v_mfma_f32_16x16x32_bf16 a[144:147], a[112:115], a[16:19], a[144:147]
    v_cvt_pk_bf16_f32 v165, v58, v59
    v_cvt_pk_bf16_f32 v72, v72, v73
    v_mfma_f32_16x16x32_bf16 a[144:147], a[116:119], a[20:23], a[144:147]
    v_cvt_pk_bf16_f32 v166, v60, v61
    v_cvt_pk_bf16_f32 v73, v74, v75
    v_mfma_f32_16x16x32_bf16 a[148:151], a[124:127], a[20:23], a[148:151]
    v_cvt_pk_bf16_f32 v167, v62, v63
    v_cvt_pk_bf16_f32 v74, v168, v169
    v_mfma_f32_16x16x32_bf16 a[148:151], a[120:123], a[16:19], a[148:151]
    v_cvt_pk_bf16_f32 v75, v170, v171
    v_cvt_pk_bf16_f32 v104, v104, v105
    v_mfma_f32_16x16x32_bf16 v[76:79], a[64:67], a[24:27], v[76:79]
    v_cvt_pk_bf16_f32 v105, v106, v107
    v_cvt_pk_bf16_f32 v106, v200, v201
    v_mfma_f32_16x16x32_bf16 v[76:79], a[68:71], a[28:31], v[76:79]
    buffer_store_dwordx4 v[96:99], v1, s[32:35], s52 offen offset:0 sc1
    v_mfma_f32_16x16x32_bf16 v[172:175], a[76:79], a[28:31], v[172:175]
    v_cvt_pk_bf16_f32 v107, v202, v203
    v_cvt_pk_bf16_f32 v136, v136, v137
    v_mfma_f32_16x16x32_bf16 v[172:175], a[72:75], a[24:27], v[172:175]
    v_cvt_pk_bf16_f32 v137, v138, v139
    v_cvt_pk_bf16_f32 v138, v232, v233
    v_mfma_f32_16x16x32_bf16 v[108:111], a[80:83], a[24:27], v[108:111]
    v_cvt_pk_bf16_f32 v139, v234, v235
    v_mfma_f32_16x16x32_bf16 v[108:111], a[84:87], a[28:31], v[108:111]
    v_accvgpr_read_b32 v56, a144
    v_accvgpr_read_b32 v57, a145
    v_mfma_f32_16x16x32_bf16 v[204:207], a[92:95], a[28:31], v[204:207]
    v_accvgpr_read_b32 v58, a146
    v_accvgpr_read_b32 v59, a147
    v_mfma_f32_16x16x32_bf16 v[204:207], a[88:91], a[24:27], v[204:207]
    s_add_u32 s52, s47, 524288
    v_accvgpr_read_b32 v60, a148
    v_accvgpr_read_b32 v61, a149
    v_mfma_f32_16x16x32_bf16 v[140:143], a[96:99], a[24:27], v[140:143]
    v_accvgpr_read_b32 v62, a150
    v_accvgpr_read_b32 v63, a151
    v_mfma_f32_16x16x32_bf16 v[140:143], a[100:103], a[28:31], v[140:143]
    v_cvt_pk_bf16_f32 v168, v56, v57
    v_cvt_pk_bf16_f32 v169, v58, v59
    v_mfma_f32_16x16x32_bf16 v[236:239], a[108:111], a[28:31], v[236:239]
    v_cvt_pk_bf16_f32 v76, v76, v77
    v_cvt_pk_bf16_f32 v170, v60, v61
    v_mfma_f32_16x16x32_bf16 v[236:239], a[104:107], a[24:27], v[236:239]
    buffer_store_dwordx4 v[128:131], v1, s[32:35], s52 offen offset:0 sc1
    v_mfma_f32_16x16x32_bf16 a[152:155], a[112:115], a[24:27], a[152:155]
    s_waitcnt lgkmcnt(0)
    v_cvt_pk_bf16_f32 v77, v78, v79
    v_cvt_pk_bf16_f32 v171, v62, v63
    v_mfma_f32_16x16x32_bf16 a[152:155], a[116:119], a[28:31], a[152:155]
    v_cvt_pk_bf16_f32 v78, v172, v173
    v_cvt_pk_bf16_f32 v79, v174, v175
    v_mfma_f32_16x16x32_bf16 a[156:159], a[124:127], a[28:31], a[156:159]
    v_cvt_pk_bf16_f32 v108, v108, v109
    v_cvt_pk_bf16_f32 v109, v110, v111
    v_mfma_f32_16x16x32_bf16 a[156:159], a[120:123], a[24:27], a[156:159]
    v_cvt_pk_bf16_f32 v110, v204, v205
    v_cvt_pk_bf16_f32 v111, v206, v207
    v_mfma_f32_16x16x32_bf16 v[80:83], a[64:67], a[32:35], v[80:83]
    v_mfma_f32_16x16x32_bf16 v[80:83], a[68:71], a[36:39], v[80:83]
    v_cvt_pk_bf16_f32 v140, v140, v141
    v_cvt_pk_bf16_f32 v141, v142, v143
    v_mfma_f32_16x16x32_bf16 v[176:179], a[76:79], a[36:39], v[176:179]
    s_add_u32 s52, s47, 532480
    v_cvt_pk_bf16_f32 v142, v236, v237
    v_cvt_pk_bf16_f32 v143, v238, v239
    v_mfma_f32_16x16x32_bf16 v[176:179], a[72:75], a[32:35], v[176:179]
    buffer_store_dwordx4 v[160:163], v1, s[32:35], s52 offen offset:0 sc1
    v_mfma_f32_16x16x32_bf16 v[112:115], a[80:83], a[32:35], v[112:115]
    v_mfma_f32_16x16x32_bf16 v[112:115], a[84:87], a[36:39], v[112:115]
    v_accvgpr_read_b32 v56, a152
    v_accvgpr_read_b32 v57, a153
    v_mfma_f32_16x16x32_bf16 v[208:211], a[92:95], a[36:39], v[208:211]
    v_accvgpr_read_b32 v58, a154
    v_accvgpr_read_b32 v59, a155
    v_mfma_f32_16x16x32_bf16 v[208:211], a[88:91], a[32:35], v[208:211]
    v_accvgpr_read_b32 v60, a156
    v_accvgpr_read_b32 v61, a157
    v_mfma_f32_16x16x32_bf16 v[144:147], a[96:99], a[32:35], v[144:147]
    v_accvgpr_read_b32 v62, a158
    v_accvgpr_read_b32 v63, a159
    v_mfma_f32_16x16x32_bf16 v[144:147], a[100:103], a[36:39], v[144:147]
    v_cvt_pk_bf16_f32 v172, v56, v57
    v_cvt_pk_bf16_f32 v173, v58, v59
    v_mfma_f32_16x16x32_bf16 v[240:243], a[108:111], a[36:39], v[240:243]
    v_cvt_pk_bf16_f32 v80, v80, v81
    v_cvt_pk_bf16_f32 v174, v60, v61
    v_mfma_f32_16x16x32_bf16 v[240:243], a[104:107], a[32:35], v[240:243]
    v_cvt_pk_bf16_f32 v81, v82, v83
    v_cvt_pk_bf16_f32 v175, v62, v63
    v_mfma_f32_16x16x32_bf16 a[160:163], a[112:115], a[32:35], a[160:163]
    v_cvt_pk_bf16_f32 v82, v176, v177
    v_cvt_pk_bf16_f32 v83, v178, v179
    v_mfma_f32_16x16x32_bf16 a[160:163], a[116:119], a[36:39], a[160:163]
    v_cvt_pk_bf16_f32 v112, v112, v113
    v_cvt_pk_bf16_f32 v113, v114, v115
    v_mfma_f32_16x16x32_bf16 a[164:167], a[124:127], a[36:39], a[164:167]
    s_add_u32 s52, s47, 0
    v_cvt_pk_bf16_f32 v114, v208, v209
    v_cvt_pk_bf16_f32 v115, v210, v211
    v_mfma_f32_16x16x32_bf16 a[164:167], a[120:123], a[32:35], a[164:167]
    buffer_store_dwordx4 v[68:71], v1, s[32:35], s52 offen offset:1024 sc1
    v_mfma_f32_16x16x32_bf16 v[84:87], a[64:67], a[40:43], v[84:87]
    v_mfma_f32_16x16x32_bf16 v[84:87], a[68:71], a[44:47], v[84:87]
    v_cvt_pk_bf16_f32 v144, v144, v145
    v_cvt_pk_bf16_f32 v145, v146, v147
    v_mfma_f32_16x16x32_bf16 v[180:183], a[76:79], a[44:47], v[180:183]
    v_cvt_pk_bf16_f32 v146, v240, v241
    v_cvt_pk_bf16_f32 v147, v242, v243
    v_mfma_f32_16x16x32_bf16 v[180:183], a[72:75], a[40:43], v[180:183]
    v_mfma_f32_16x16x32_bf16 v[116:119], a[80:83], a[40:43], v[116:119]
    v_mfma_f32_16x16x32_bf16 v[116:119], a[84:87], a[44:47], v[116:119]
    v_accvgpr_read_b32 v56, a160
    v_accvgpr_read_b32 v57, a161
    v_mfma_f32_16x16x32_bf16 v[212:215], a[92:95], a[44:47], v[212:215]
    v_accvgpr_read_b32 v58, a162
    v_accvgpr_read_b32 v59, a163
    v_mfma_f32_16x16x32_bf16 v[212:215], a[88:91], a[40:43], v[212:215]
    v_accvgpr_read_b32 v60, a164
    v_accvgpr_read_b32 v61, a165
    v_mfma_f32_16x16x32_bf16 v[148:151], a[96:99], a[40:43], v[148:151]
    v_accvgpr_read_b32 v62, a166
    v_accvgpr_read_b32 v63, a167
    v_mfma_f32_16x16x32_bf16 v[148:151], a[100:103], a[44:47], v[148:151]
    s_add_u32 s52, s47, 8192
    v_cvt_pk_bf16_f32 v176, v56, v57
    v_cvt_pk_bf16_f32 v177, v58, v59
    v_mfma_f32_16x16x32_bf16 v[244:247], a[108:111], a[44:47], v[244:247]
    v_cvt_pk_bf16_f32 v84, v84, v85
    v_cvt_pk_bf16_f32 v178, v60, v61
    v_mfma_f32_16x16x32_bf16 v[244:247], a[104:107], a[40:43], v[244:247]
    v_cvt_pk_bf16_f32 v85, v86, v87
    v_cvt_pk_bf16_f32 v179, v62, v63
    v_mfma_f32_16x16x32_bf16 a[168:171], a[112:115], a[40:43], a[168:171]
    v_cvt_pk_bf16_f32 v86, v180, v181
    v_cvt_pk_bf16_f32 v87, v182, v183
    v_mfma_f32_16x16x32_bf16 a[168:171], a[116:119], a[44:47], a[168:171]
    buffer_store_dwordx4 v[100:103], v1, s[32:35], s52 offen offset:1024 sc1
    v_mfma_f32_16x16x32_bf16 a[172:175], a[124:127], a[44:47], a[172:175]
    v_cvt_pk_bf16_f32 v116, v116, v117
    v_cvt_pk_bf16_f32 v117, v118, v119
    v_mfma_f32_16x16x32_bf16 a[172:175], a[120:123], a[40:43], a[172:175]
    v_cvt_pk_bf16_f32 v118, v212, v213
    v_cvt_pk_bf16_f32 v119, v214, v215
    v_mfma_f32_16x16x32_bf16 v[88:91], a[64:67], a[48:51], v[88:91]
    s_waitcnt vmcnt(16)
    s_barrier
    v_mfma_f32_16x16x32_bf16 v[88:91], a[68:71], a[52:55], v[88:91]
    ds_read_b64_tr_b16 a[0:1], v42 offset:32768
    v_cvt_pk_bf16_f32 v148, v148, v149
    v_mfma_f32_16x16x32_bf16 v[184:187], a[76:79], a[52:55], v[184:187]
    v_cvt_pk_bf16_f32 v149, v150, v151
    v_cvt_pk_bf16_f32 v150, v244, v245
    v_mfma_f32_16x16x32_bf16 v[184:187], a[72:75], a[48:51], v[184:187]
    ds_read_b64_tr_b16 a[2:3], v42 offset:33792
    v_cvt_pk_bf16_f32 v151, v246, v247
    v_mfma_f32_16x16x32_bf16 v[120:123], a[80:83], a[48:51], v[120:123]
    ds_read_b64_tr_b16 a[4:5], v42 offset:40960
    ds_read_b64_tr_b16 a[6:7], v42 offset:41984
    v_mfma_f32_16x16x32_bf16 v[120:123], a[84:87], a[52:55], v[120:123]
    s_add_u32 s52, s47, 524288
    v_accvgpr_read_b32 v56, a168
    v_accvgpr_read_b32 v57, a169
    v_mfma_f32_16x16x32_bf16 v[216:219], a[92:95], a[52:55], v[216:219]
    v_accvgpr_read_b32 v58, a170
    v_accvgpr_read_b32 v59, a171
    v_mfma_f32_16x16x32_bf16 v[216:219], a[88:91], a[48:51], v[216:219]
    ds_read_b64_tr_b16 a[8:9], v43 offset:32768
    v_accvgpr_read_b32 v60, a172
    v_mfma_f32_16x16x32_bf16 v[152:155], a[96:99], a[48:51], v[152:155]
    buffer_store_dwordx4 v[132:135], v1, s[32:35], s52 offen offset:1024 sc1
    ds_read_b64_tr_b16 a[10:11], v43 offset:33792
    v_mfma_f32_16x16x32_bf16 v[152:155], a[100:103], a[52:55], v[152:155]
    v_accvgpr_read_b32 v61, a173
    v_accvgpr_read_b32 v62, a174
    v_mfma_f32_16x16x32_bf16 v[248:251], a[108:111], a[52:55], v[248:251]
    v_accvgpr_read_b32 v63, a175
    v_cvt_pk_bf16_f32 v180, v56, v57
    v_mfma_f32_16x16x32_bf16 v[248:251], a[104:107], a[48:51], v[248:251]
    v_cvt_pk_bf16_f32 v181, v58, v59
    v_cvt_pk_bf16_f32 v88, v88, v89
    v_mfma_f32_16x16x32_bf16 a[176:179], a[112:115], a[48:51], a[176:179]
    v_cvt_pk_bf16_f32 v182, v60, v61
    v_cvt_pk_bf16_f32 v89, v90, v91
    v_mfma_f32_16x16x32_bf16 a[176:179], a[116:119], a[52:55], a[176:179]
    ds_read_b64_tr_b16 a[12:13], v43 offset:40960
    v_cvt_pk_bf16_f32 v183, v62, v63
    v_mfma_f32_16x16x32_bf16 a[180:183], a[124:127], a[52:55], a[180:183]
    v_cvt_pk_bf16_f32 v90, v184, v185
    v_cvt_pk_bf16_f32 v91, v186, v187
    v_mfma_f32_16x16x32_bf16 a[180:183], a[120:123], a[48:51], a[180:183]
    ds_read_b64_tr_b16 a[14:15], v43 offset:41984
    ds_read_b64_tr_b16 a[16:17], v44 offset:32768
    v_mfma_f32_16x16x32_bf16 v[92:95], a[64:67], a[56:59], v[92:95]
    s_add_u32 s52, s47, 532480
    v_cvt_pk_bf16_f32 v120, v120, v121
    v_cvt_pk_bf16_f32 v121, v122, v123
    v_mfma_f32_16x16x32_bf16 v[92:95], a[68:71], a[60:63], v[92:95]
    ds_read_b64_tr_b16 a[18:19], v44 offset:33792
    v_cvt_pk_bf16_f32 v122, v216, v217
    v_mfma_f32_16x16x32_bf16 v[188:191], a[76:79], a[60:63], v[188:191]
    ds_read_b64_tr_b16 a[20:21], v44 offset:40960
    v_cvt_pk_bf16_f32 v123, v218, v219
    v_mfma_f32_16x16x32_bf16 v[188:191], a[72:75], a[56:59], v[188:191]
    ds_read_b64_tr_b16 a[22:23], v44 offset:41984
    v_cvt_pk_bf16_f32 v152, v152, v153
    v_mfma_f32_16x16x32_bf16 v[124:127], a[80:83], a[56:59], v[124:127]
    v_cvt_pk_bf16_f32 v153, v154, v155
    v_cvt_pk_bf16_f32 v154, v248, v249
    v_mfma_f32_16x16x32_bf16 v[124:127], a[84:87], a[60:63], v[124:127]
    ds_read_b64_tr_b16 a[24:25], v45 offset:32768
    v_cvt_pk_bf16_f32 v155, v250, v251
    v_mfma_f32_16x16x32_bf16 v[220:223], a[92:95], a[60:63], v[220:223]
    buffer_store_dwordx4 v[164:167], v1, s[32:35], s52 offen offset:1024 sc1
    ds_read_b64_tr_b16 a[26:27], v45 offset:33792
    v_mfma_f32_16x16x32_bf16 v[220:223], a[88:91], a[56:59], v[220:223]
    ds_read_b64_tr_b16 a[28:29], v45 offset:40960
    v_accvgpr_read_b32 v56, a176
    v_mfma_f32_16x16x32_bf16 v[156:159], a[96:99], a[56:59], v[156:159]
    v_accvgpr_read_b32 v57, a177
    v_accvgpr_read_b32 v58, a178
    v_mfma_f32_16x16x32_bf16 v[156:159], a[100:103], a[60:63], v[156:159]
    ds_read_b64_tr_b16 a[30:31], v45 offset:41984
    v_accvgpr_read_b32 v59, a179
    v_mfma_f32_16x16x32_bf16 v[252:255], a[108:111], a[60:63], v[252:255]
    v_accvgpr_read_b32 v60, a180
    v_accvgpr_read_b32 v61, a181
    v_mfma_f32_16x16x32_bf16 v[252:255], a[104:107], a[56:59], v[252:255]
    v_accvgpr_read_b32 v62, a182
    v_accvgpr_read_b32 v63, a183
    v_mfma_f32_16x16x32_bf16 a[184:187], a[112:115], a[56:59], a[184:187]
    v_cvt_pk_bf16_f32 v184, v56, v57
    v_cvt_pk_bf16_f32 v185, v58, v59
    v_mfma_f32_16x16x32_bf16 a[184:187], a[116:119], a[60:63], a[184:187]
    v_cvt_pk_bf16_f32 v92, v92, v93
    v_cvt_pk_bf16_f32 v186, v60, v61
    v_mfma_f32_16x16x32_bf16 a[188:191], a[124:127], a[60:63], a[188:191]
    v_cvt_pk_bf16_f32 v93, v94, v95
    v_cvt_pk_bf16_f32 v187, v62, v63
    v_mfma_f32_16x16x32_bf16 a[188:191], a[120:123], a[56:59], a[188:191]
    v_cvt_pk_bf16_f32 v94, v188, v189
    v_cvt_pk_bf16_f32 v95, v190, v191
    v_cvt_pk_bf16_f32 v124, v124, v125
    v_cvt_pk_bf16_f32 v125, v126, v127
    v_cvt_pk_bf16_f32 v126, v220, v221
    v_cvt_pk_bf16_f32 v127, v222, v223
    v_cvt_pk_bf16_f32 v156, v156, v157
    v_cvt_pk_bf16_f32 v157, v158, v159
    v_cvt_pk_bf16_f32 v158, v252, v253
    v_cvt_pk_bf16_f32 v159, v254, v255
    v_accvgpr_read_b32 v56, a184
    v_accvgpr_read_b32 v57, a185
    v_accvgpr_read_b32 v58, a186
    v_accvgpr_read_b32 v59, a187
    v_accvgpr_read_b32 v60, a188
    v_accvgpr_read_b32 v61, a189
    v_accvgpr_read_b32 v62, a190
    v_accvgpr_read_b32 v63, a191
    v_cvt_pk_bf16_f32 v188, v56, v57
    v_cvt_pk_bf16_f32 v189, v58, v59
    v_cvt_pk_bf16_f32 v190, v60, v61
    v_cvt_pk_bf16_f32 v191, v62, v63
k12_join_7:
k12_qcode:
    s_mov_b64 s[48:49], s[32:33]
    s_mov_b32 s51, 0x00020000
    s_cmp_eq_u32 s45, 0
    s_mov_b32 s50, s34
    s_cselect_b32 s56, s30, -1
    s_cselect_b32 s57, -1, s30
    s_waitcnt vmcnt(16) lgkmcnt(0)
    v_mfma_f32_16x16x32_bf16 v[192:195], a[0:3], a[192:195], 0
    v_mfma_f32_16x16x32_bf16 v[192:195], a[4:7], a[208:211], v[192:195]
    buffer_load_dwordx4 a[128:131], v36, s[8:11], s62 offen sc1
    ds_read_b64_tr_b16 a[32:33], v46 offset:32768
    v_mfma_f32_16x16x32_bf16 v[196:199], a[4:7], a[212:215], 0
    ds_read_b64_tr_b16 a[34:35], v46 offset:33792
    v_mfma_f32_16x16x32_bf16 v[196:199], a[0:3], a[196:199], v[196:199]
    ds_read_b64_tr_b16 a[36:37], v46 offset:40960
    v_mfma_f32_16x16x32_bf16 a[64:67], a[0:3], a[200:203], 0
    ds_read_b64_tr_b16 a[38:39], v46 offset:41984
    v_mfma_f32_16x16x32_bf16 a[64:67], a[4:7], a[216:219], a[64:67]
    ds_read_b64_tr_b16 a[40:41], v47 offset:32768
    v_mfma_f32_16x16x32_bf16 a[68:71], a[4:7], a[220:223], 0
    s_lshl_b32 s31, s28, 14
    v_mfma_f32_16x16x32_bf16 a[68:71], a[0:3], a[204:207], a[68:71]
    s_add_u32 s16, s6, s31
    s_addc_u32 s17, s7, 0
    buffer_load_dwordx4 a[132:135], v54, s[8:11], s62 offen sc1
    ds_read_b64_tr_b16 a[42:43], v47 offset:33792
    v_mfma_f32_16x16x32_bf16 a[76:79], a[8:11], a[204:207], 0
    ds_read_b64_tr_b16 a[44:45], v47 offset:40960
    v_mfma_f32_16x16x32_bf16 a[76:79], a[12:15], a[220:223], a[76:79]
    s_add_u32 s20, s16, 0x2000000
    s_addc_u32 s21, s17, 0
    ds_read_b64_tr_b16 a[46:47], v47 offset:41984
    v_mfma_f32_16x16x32_bf16 a[72:75], a[12:15], a[216:219], 0
    ds_read_b64_tr_b16 a[48:49], v48 offset:32768
    v_mfma_f32_16x16x32_bf16 a[72:75], a[8:11], a[200:203], a[72:75]
    s_add_u32 s16, s16, 0x1000000
    s_addc_u32 s17, s17, 0
    v_mfma_f32_16x16x32_bf16 v[204:207], a[8:11], a[196:199], 0
    ds_read_b64_tr_b16 a[50:51], v48 offset:33792
    v_mfma_f32_16x16x32_bf16 v[204:207], a[12:15], a[212:215], v[204:207]
    s_and_b32 s17, s17, 0xffff
    ds_read_b64_tr_b16 a[52:53], v48 offset:40960
    v_mfma_f32_16x16x32_bf16 v[200:203], a[12:15], a[208:211], 0
    buffer_load_dwordx4 a[136:139], v37, s[8:11], s62 offen sc1
    ds_read_b64_tr_b16 a[54:55], v48 offset:41984
    v_mfma_f32_16x16x32_bf16 v[200:203], a[8:11], a[192:195], v[200:203]
    s_and_b32 s21, s21, 0xffff
    v_mfma_f32_16x16x32_bf16 v[208:211], a[16:19], a[192:195], 0
    ds_read_b64_tr_b16 a[56:57], v49 offset:32768
    v_mfma_f32_16x16x32_bf16 v[208:211], a[20:23], a[208:211], v[208:211]
    s_lshl_b32 s31, s29, 20
    ds_read_b64_tr_b16 a[58:59], v49 offset:33792
    v_mfma_f32_16x16x32_bf16 v[212:215], a[20:23], a[212:215], 0
    ds_read_b64_tr_b16 a[60:61], v49 offset:40960
    v_mfma_f32_16x16x32_bf16 v[212:215], a[16:19], a[196:199], v[212:215]
    s_sub_u32 s18, 0xf84000, s31
    v_mfma_f32_16x16x32_bf16 a[80:83], a[16:19], a[200:203], 0
    buffer_load_dwordx4 a[140:143], v55, s[8:11], s62 offen sc1
    ds_read_b64_tr_b16 a[62:63], v49 offset:41984
    v_mfma_f32_16x16x32_bf16 a[80:83], a[20:23], a[216:219], a[80:83]
    s_mov_b32 s22, s18
    v_mfma_f32_16x16x32_bf16 a[84:87], a[20:23], a[220:223], 0
    v_mfma_f32_16x16x32_bf16 a[84:87], a[16:19], a[204:207], a[84:87]
    s_add_u32 s24, s6, 0x4806000
    s_addc_u32 s25, s7, 0
    v_mfma_f32_16x16x32_bf16 a[92:95], a[24:27], a[204:207], 0
    v_mfma_f32_16x16x32_bf16 a[92:95], a[28:31], a[220:223], a[92:95]
    s_and_b32 s25, s25, 0xffff
    v_mfma_f32_16x16x32_bf16 a[88:91], a[28:31], a[216:219], 0
    s_add_u32 s62, s62, 0x20000
    v_mfma_f32_16x16x32_bf16 a[88:91], a[24:27], a[200:203], a[88:91]
    s_mov_b32 s26, 4096
    v_mfma_f32_16x16x32_bf16 v[220:223], a[24:27], a[196:199], 0
    s_cmp_eq_u32 s45, 0
    s_cbranch_scc1 k12_ool_48
k12_oolret_49:
    v_mfma_f32_16x16x32_bf16 v[220:223], a[28:31], a[212:215], v[220:223]
    v_mfma_f32_16x16x32_bf16 v[216:219], a[28:31], a[208:211], 0
    v_mfma_f32_16x16x32_bf16 v[216:219], a[24:27], a[192:195], v[216:219]
    s_waitcnt vmcnt(28) lgkmcnt(0)
    s_barrier
    v_mfma_f32_16x16x32_bf16 v[224:227], a[32:35], a[192:195], 0
    v_mfma_f32_16x16x32_bf16 v[224:227], a[36:39], a[208:211], v[224:227]
    s_add_u32 m0, s60, 98304
    ds_read_b64_tr_b16 a[0:1], v42 offset:49152
    ds_read_b64_tr_b16 a[2:3], v42 offset:50176
    v_mfma_f32_16x16x32_bf16 v[228:231], a[36:39], a[212:215], 0
    buffer_load_dwordx4 v38, s[12:15], s61 offen offset:0 lds
    v_mfma_f32_16x16x32_bf16 v[228:231], a[32:35], a[196:199], v[228:231]
    ds_read_b64_tr_b16 a[4:5], v42 offset:57344
    v_mfma_f32_16x16x32_bf16 a[96:99], a[32:35], a[200:203], 0
    buffer_load_dwordx4 v39, s[12:15], s61 offen offset:1024 lds
    ds_read_b64_tr_b16 a[6:7], v42 offset:58368
    v_mfma_f32_16x16x32_bf16 a[96:99], a[36:39], a[216:219], a[96:99]
    ds_read_b64_tr_b16 a[8:9], v43 offset:49152
    v_mfma_f32_16x16x32_bf16 a[100:103], a[36:39], a[220:223], 0
    v_mfma_f32_16x16x32_bf16 a[100:103], a[32:35], a[204:207], a[100:103]
    buffer_load_dwordx4 v40, s[12:15], s61 offen offset:2048 lds
    ds_read_b64_tr_b16 a[10:11], v43 offset:50176
    v_mfma_f32_16x16x32_bf16 a[108:111], a[40:43], a[204:207], 0
    ds_read_b64_tr_b16 a[12:13], v43 offset:57344
    v_mfma_f32_16x16x32_bf16 a[108:111], a[44:47], a[220:223], a[108:111]
    ds_read_b64_tr_b16 a[14:15], v43 offset:58368
    v_mfma_f32_16x16x32_bf16 a[104:107], a[44:47], a[216:219], 0
    buffer_load_dwordx4 v41, s[12:15], s61 offen offset:3072 lds
    ds_read_b64_tr_b16 a[16:17], v44 offset:49152
    v_mfma_f32_16x16x32_bf16 a[104:107], a[40:43], a[200:203], a[104:107]
    v_mfma_f32_16x16x32_bf16 v[236:239], a[40:43], a[196:199], 0
    s_add_u32 s61, s61, 0x80000
    ds_read_b64_tr_b16 a[18:19], v44 offset:50176
    v_mfma_f32_16x16x32_bf16 v[236:239], a[44:47], a[212:215], v[236:239]
    buffer_load_dwordx4 a[144:147], v36, s[8:11], s62 offen sc1
    ds_read_b64_tr_b16 a[20:21], v44 offset:57344
    v_mfma_f32_16x16x32_bf16 v[232:235], a[44:47], a[208:211], 0
    ds_read_b64_tr_b16 a[22:23], v44 offset:58368
    v_mfma_f32_16x16x32_bf16 v[232:235], a[40:43], a[192:195], v[232:235]
    buffer_load_dwordx4 a[148:151], v54, s[8:11], s62 offen sc1
    v_mfma_f32_16x16x32_bf16 v[240:243], a[48:51], a[192:195], 0
    ds_read_b64_tr_b16 a[24:25], v45 offset:49152
    v_mfma_f32_16x16x32_bf16 v[240:243], a[52:55], a[208:211], v[240:243]
    ds_read_b64_tr_b16 a[26:27], v45 offset:50176
    v_mfma_f32_16x16x32_bf16 v[244:247], a[52:55], a[212:215], 0
    buffer_load_dwordx4 a[152:155], v37, s[8:11], s62 offen sc1
    ds_read_b64_tr_b16 a[28:29], v45 offset:57344
    v_mfma_f32_16x16x32_bf16 v[244:247], a[48:51], a[196:199], v[244:247]
    v_mfma_f32_16x16x32_bf16 a[112:115], a[48:51], a[200:203], 0
    ds_read_b64_tr_b16 a[30:31], v45 offset:58368
    v_mfma_f32_16x16x32_bf16 a[112:115], a[52:55], a[216:219], a[112:115]
    buffer_load_dwordx4 a[156:159], v55, s[8:11], s62 offen sc1
    v_mfma_f32_16x16x32_bf16 a[116:119], a[52:55], a[220:223], 0
    v_mfma_f32_16x16x32_bf16 a[116:119], a[48:51], a[204:207], a[116:119]
    s_add_u32 s62, s62, 0x20000
    v_mfma_f32_16x16x32_bf16 a[124:127], a[56:59], a[204:207], 0
    s_add_u32 s52, s47, 0
    v_mfma_f32_16x16x32_bf16 a[124:127], a[60:63], a[220:223], a[124:127]
    buffer_store_dwordx4 v[72:75], v1, s[48:51], s52 offen offset:2048 sc1
    v_mfma_f32_16x16x32_bf16 a[120:123], a[60:63], a[216:219], 0
    v_mfma_f32_16x16x32_bf16 a[120:123], a[56:59], a[200:203], a[120:123]
    v_mfma_f32_16x16x32_bf16 v[252:255], a[56:59], a[196:199], 0
    v_mfma_f32_16x16x32_bf16 v[252:255], a[60:63], a[212:215], v[252:255]
    v_mfma_f32_16x16x32_bf16 v[248:251], a[60:63], a[208:211], 0
    v_mfma_f32_16x16x32_bf16 v[248:251], a[56:59], a[192:195], v[248:251]
    s_waitcnt vmcnt(21) lgkmcnt(0)
    v_mfma_f32_16x16x32_bf16 v[192:195], a[0:3], a[224:227], v[192:195]
    v_mfma_f32_16x16x32_bf16 v[192:195], a[4:7], a[240:243], v[192:195]
    buffer_load_dwordx4 a[160:163], v36, s[8:11], s62 offen sc1
    ds_read_b64_tr_b16 a[32:33], v46 offset:49152
    v_mfma_f32_16x16x32_bf16 v[196:199], a[4:7], a[244:247], v[196:199]
    ds_read_b64_tr_b16 a[34:35], v46 offset:50176
    v_mfma_f32_16x16x32_bf16 v[196:199], a[0:3], a[228:231], v[196:199]
    ds_read_b64_tr_b16 a[36:37], v46 offset:57344
    v_mfma_f32_16x16x32_bf16 a[64:67], a[0:3], a[232:235], a[64:67]
    ds_read_b64_tr_b16 a[38:39], v46 offset:58368
    v_mfma_f32_16x16x32_bf16 a[64:67], a[4:7], a[248:251], a[64:67]
    ds_read_b64_tr_b16 a[40:41], v47 offset:49152
    v_mfma_f32_16x16x32_bf16 a[68:71], a[4:7], a[252:255], a[68:71]
    buffer_load_dwordx4 a[164:167], v54, s[8:11], s62 offen sc1
    v_mfma_f32_16x16x32_bf16 a[68:71], a[0:3], a[236:239], a[68:71]
    ds_read_b64_tr_b16 a[42:43], v47 offset:50176
    v_mfma_f32_16x16x32_bf16 a[76:79], a[8:11], a[236:239], a[76:79]
    ds_read_b64_tr_b16 a[44:45], v47 offset:57344
    v_mfma_f32_16x16x32_bf16 a[76:79], a[12:15], a[252:255], a[76:79]
    ds_read_b64_tr_b16 a[46:47], v47 offset:58368
    v_mfma_f32_16x16x32_bf16 a[72:75], a[12:15], a[248:251], a[72:75]
    ds_read_b64_tr_b16 a[48:49], v48 offset:49152
    v_mfma_f32_16x16x32_bf16 a[72:75], a[8:11], a[232:235], a[72:75]
    buffer_load_dwordx4 a[168:171], v37, s[8:11], s62 offen sc1
    v_mfma_f32_16x16x32_bf16 v[204:207], a[8:11], a[228:231], v[204:207]
    ds_read_b64_tr_b16 a[50:51], v48 offset:50176
    v_mfma_f32_16x16x32_bf16 v[204:207], a[12:15], a[244:247], v[204:207]
    ds_read_b64_tr_b16 a[52:53], v48 offset:57344
    v_mfma_f32_16x16x32_bf16 v[200:203], a[12:15], a[240:243], v[200:203]
    ds_read_b64_tr_b16 a[54:55], v48 offset:58368
    v_mfma_f32_16x16x32_bf16 v[200:203], a[8:11], a[224:227], v[200:203]
    v_mfma_f32_16x16x32_bf16 v[208:211], a[16:19], a[224:227], v[208:211]
    ds_read_b64_tr_b16 a[56:57], v49 offset:49152
    v_mfma_f32_16x16x32_bf16 v[208:211], a[20:23], a[240:243], v[208:211]
    buffer_load_dwordx4 a[172:175], v55, s[8:11], s62 offen sc1
    ds_read_b64_tr_b16 a[58:59], v49 offset:50176
    v_mfma_f32_16x16x32_bf16 v[212:215], a[20:23], a[244:247], v[212:215]
    ds_read_b64_tr_b16 a[60:61], v49 offset:57344
    v_mfma_f32_16x16x32_bf16 v[212:215], a[16:19], a[228:231], v[212:215]
    v_mfma_f32_16x16x32_bf16 a[80:83], a[16:19], a[232:235], a[80:83]
    ds_read_b64_tr_b16 a[62:63], v49 offset:58368
    v_mfma_f32_16x16x32_bf16 a[80:83], a[20:23], a[248:251], a[80:83]
    s_add_u32 s62, s62, 0x20000
    v_mfma_f32_16x16x32_bf16 a[84:87], a[20:23], a[252:255], a[84:87]
    s_add_u32 s52, s47, 0
    v_mfma_f32_16x16x32_bf16 a[84:87], a[16:19], a[236:239], a[84:87]
    buffer_store_dwordx4 v[76:79], v1, s[48:51], s52 offen offset:3072 sc1
    v_mfma_f32_16x16x32_bf16 a[92:95], a[24:27], a[236:239], a[92:95]
    v_mfma_f32_16x16x32_bf16 a[92:95], a[28:31], a[252:255], a[92:95]
    v_mfma_f32_16x16x32_bf16 a[88:91], a[28:31], a[248:251], a[88:91]
    v_mfma_f32_16x16x32_bf16 a[88:91], a[24:27], a[232:235], a[88:91]
    v_mfma_f32_16x16x32_bf16 v[220:223], a[24:27], a[228:231], v[220:223]
    s_cmp_eq_u32 s45, 0
    s_cbranch_scc1 k12_ool_50
k12_oolret_51:
    v_mfma_f32_16x16x32_bf16 v[220:223], a[28:31], a[244:247], v[220:223]
    v_mfma_f32_16x16x32_bf16 v[216:219], a[28:31], a[240:243], v[216:219]
    v_mfma_f32_16x16x32_bf16 v[216:219], a[24:27], a[224:227], v[216:219]
    s_waitcnt vmcnt(10) lgkmcnt(0)
    s_barrier
    v_mfma_f32_16x16x32_bf16 v[224:227], a[32:35], a[224:227], v[224:227]
    v_mfma_f32_16x16x32_bf16 v[224:227], a[36:39], a[240:243], v[224:227]
    s_add_u32 m0, s60, 114688
    ds_read_b64_tr_b16 a[0:1], v42 offset:0
    ds_read_b64_tr_b16 a[2:3], v42 offset:1024
    v_mfma_f32_16x16x32_bf16 v[228:231], a[36:39], a[244:247], v[228:231]
    buffer_load_dwordx4 v38, s[12:15], s61 offen offset:0 lds
    v_mfma_f32_16x16x32_bf16 v[228:231], a[32:35], a[228:231], v[228:231]
    ds_read_b64_tr_b16 a[4:5], v42 offset:8192
    v_mfma_f32_16x16x32_bf16 a[96:99], a[32:35], a[232:235], a[96:99]
    buffer_load_dwordx4 v39, s[12:15], s61 offen offset:1024 lds
    ds_read_b64_tr_b16 a[6:7], v42 offset:9216
    v_mfma_f32_16x16x32_bf16 a[96:99], a[36:39], a[248:251], a[96:99]
    ds_read_b64_tr_b16 a[8:9], v43 offset:0
    v_mfma_f32_16x16x32_bf16 a[100:103], a[36:39], a[252:255], a[100:103]
    v_mfma_f32_16x16x32_bf16 a[100:103], a[32:35], a[236:239], a[100:103]
    buffer_load_dwordx4 v40, s[12:15], s61 offen offset:2048 lds
    ds_read_b64_tr_b16 a[10:11], v43 offset:1024
    v_mfma_f32_16x16x32_bf16 a[108:111], a[40:43], a[236:239], a[108:111]
    ds_read_b64_tr_b16 a[12:13], v43 offset:8192
    v_mfma_f32_16x16x32_bf16 a[108:111], a[44:47], a[252:255], a[108:111]
    ds_read_b64_tr_b16 a[14:15], v43 offset:9216
    v_mfma_f32_16x16x32_bf16 a[104:107], a[44:47], a[248:251], a[104:107]
    buffer_load_dwordx4 v41, s[12:15], s61 offen offset:3072 lds
    ds_read_b64_tr_b16 a[16:17], v44 offset:0
    v_mfma_f32_16x16x32_bf16 a[104:107], a[40:43], a[232:235], a[104:107]
    v_mfma_f32_16x16x32_bf16 v[236:239], a[40:43], a[228:231], v[236:239]
    s_add_u32 s61, s61, 0x80000
    ds_read_b64_tr_b16 a[18:19], v44 offset:1024
    v_mfma_f32_16x16x32_bf16 v[236:239], a[44:47], a[244:247], v[236:239]
    buffer_load_dwordx4 a[176:179], v36, s[8:11], s62 offen sc1
    ds_read_b64_tr_b16 a[20:21], v44 offset:8192
    v_mfma_f32_16x16x32_bf16 v[232:235], a[44:47], a[240:243], v[232:235]
    ds_read_b64_tr_b16 a[22:23], v44 offset:9216
    v_mfma_f32_16x16x32_bf16 v[232:235], a[40:43], a[224:227], v[232:235]
    buffer_load_dwordx4 a[180:183], v54, s[8:11], s62 offen sc1
    v_mfma_f32_16x16x32_bf16 v[240:243], a[48:51], a[224:227], v[240:243]
    ds_read_b64_tr_b16 a[24:25], v45 offset:0
    v_mfma_f32_16x16x32_bf16 v[240:243], a[52:55], a[240:243], v[240:243]
    ds_read_b64_tr_b16 a[26:27], v45 offset:1024
    v_mfma_f32_16x16x32_bf16 v[244:247], a[52:55], a[244:247], v[244:247]
    buffer_load_dwordx4 a[184:187], v37, s[8:11], s62 offen sc1
    ds_read_b64_tr_b16 a[28:29], v45 offset:8192
    v_mfma_f32_16x16x32_bf16 v[244:247], a[48:51], a[228:231], v[244:247]
    v_mfma_f32_16x16x32_bf16 a[112:115], a[48:51], a[232:235], a[112:115]
    ds_read_b64_tr_b16 a[30:31], v45 offset:9216
    v_mfma_f32_16x16x32_bf16 a[112:115], a[52:55], a[248:251], a[112:115]
    buffer_load_dwordx4 a[188:191], v55, s[8:11], s62 offen sc1
    v_mfma_f32_16x16x32_bf16 a[116:119], a[52:55], a[252:255], a[116:119]
    v_mfma_f32_16x16x32_bf16 a[116:119], a[48:51], a[236:239], a[116:119]
    s_add_u32 s62, s62, 0x20000
    v_mfma_f32_16x16x32_bf16 a[124:127], a[56:59], a[236:239], a[124:127]
    s_add_u32 s52, s47, 4096
    v_mfma_f32_16x16x32_bf16 a[124:127], a[60:63], a[252:255], a[124:127]
    buffer_store_dwordx4 v[80:83], v1, s[48:51], s52 offen offset:0 sc1
    v_mfma_f32_16x16x32_bf16 a[120:123], a[60:63], a[248:251], a[120:123]
    v_mfma_f32_16x16x32_bf16 a[120:123], a[56:59], a[232:235], a[120:123]
    v_mfma_f32_16x16x32_bf16 v[252:255], a[56:59], a[228:231], v[252:255]
    v_mfma_f32_16x16x32_bf16 v[252:255], a[60:63], a[244:247], v[252:255]
    v_mfma_f32_16x16x32_bf16 v[248:251], a[60:63], a[240:243], v[248:251]
    v_mfma_f32_16x16x32_bf16 v[248:251], a[56:59], a[224:227], v[248:251]
    s_waitcnt vmcnt(15) lgkmcnt(0)
    v_mfma_f32_16x16x32_bf16 v[192:195], a[0:3], a[128:131], v[192:195]
    v_mfma_f32_16x16x32_bf16 v[192:195], a[4:7], a[144:147], v[192:195]
    buffer_load_dwordx4 a[192:195], v36, s[8:11], s62 offen sc1
    ds_read_b64_tr_b16 a[32:33], v46 offset:0
    v_mfma_f32_16x16x32_bf16 v[196:199], a[4:7], a[148:151], v[196:199]
    ds_read_b64_tr_b16 a[34:35], v46 offset:1024
    v_mfma_f32_16x16x32_bf16 v[196:199], a[0:3], a[132:135], v[196:199]
    ds_read_b64_tr_b16 a[36:37], v46 offset:8192
    v_mfma_f32_16x16x32_bf16 a[64:67], a[0:3], a[136:139], a[64:67]
    ds_read_b64_tr_b16 a[38:39], v46 offset:9216
    v_mfma_f32_16x16x32_bf16 a[64:67], a[4:7], a[152:155], a[64:67]
    ds_read_b64_tr_b16 a[40:41], v47 offset:0
    v_mfma_f32_16x16x32_bf16 a[68:71], a[4:7], a[156:159], a[68:71]
    buffer_load_dwordx4 a[196:199], v54, s[8:11], s62 offen sc1
    v_mfma_f32_16x16x32_bf16 a[68:71], a[0:3], a[140:143], a[68:71]
    ds_read_b64_tr_b16 a[42:43], v47 offset:1024
    v_mfma_f32_16x16x32_bf16 a[76:79], a[8:11], a[140:143], a[76:79]
    ds_read_b64_tr_b16 a[44:45], v47 offset:8192
    v_mfma_f32_16x16x32_bf16 a[76:79], a[12:15], a[156:159], a[76:79]
    ds_read_b64_tr_b16 a[46:47], v47 offset:9216
    v_mfma_f32_16x16x32_bf16 a[72:75], a[12:15], a[152:155], a[72:75]
    ds_read_b64_tr_b16 a[48:49], v48 offset:0
    v_mfma_f32_16x16x32_bf16 a[72:75], a[8:11], a[136:139], a[72:75]
    buffer_load_dwordx4 a[200:203], v37, s[8:11], s62 offen sc1
    v_mfma_f32_16x16x32_bf16 v[204:207], a[8:11], a[132:135], v[204:207]
    ds_read_b64_tr_b16 a[50:51], v48 offset:1024
    v_mfma_f32_16x16x32_bf16 v[204:207], a[12:15], a[148:151], v[204:207]
    ds_read_b64_tr_b16 a[52:53], v48 offset:8192
    v_mfma_f32_16x16x32_bf16 v[200:203], a[12:15], a[144:147], v[200:203]
    ds_read_b64_tr_b16 a[54:55], v48 offset:9216
    v_mfma_f32_16x16x32_bf16 v[200:203], a[8:11], a[128:131], v[200:203]
    v_mfma_f32_16x16x32_bf16 v[208:211], a[16:19], a[128:131], v[208:211]
    ds_read_b64_tr_b16 a[56:57], v49 offset:0
    v_mfma_f32_16x16x32_bf16 v[208:211], a[20:23], a[144:147], v[208:211]
    buffer_load_dwordx4 a[204:207], v55, s[8:11], s62 offen sc1
    ds_read_b64_tr_b16 a[58:59], v49 offset:1024
    v_mfma_f32_16x16x32_bf16 v[212:215], a[20:23], a[148:151], v[212:215]
    ds_read_b64_tr_b16 a[60:61], v49 offset:8192
    v_mfma_f32_16x16x32_bf16 v[212:215], a[16:19], a[132:135], v[212:215]
    v_mfma_f32_16x16x32_bf16 a[80:83], a[16:19], a[136:139], a[80:83]
    ds_read_b64_tr_b16 a[62:63], v49 offset:9216
    v_mfma_f32_16x16x32_bf16 a[80:83], a[20:23], a[152:155], a[80:83]
    s_add_u32 s62, s62, 0x20000
    v_mfma_f32_16x16x32_bf16 a[84:87], a[20:23], a[156:159], a[84:87]
    s_add_u32 s52, s47, 4096
    v_mfma_f32_16x16x32_bf16 a[84:87], a[16:19], a[140:143], a[84:87]
    buffer_store_dwordx4 v[84:87], v1, s[48:51], s52 offen offset:1024 sc1
    v_mfma_f32_16x16x32_bf16 a[92:95], a[24:27], a[140:143], a[92:95]
    v_mfma_f32_16x16x32_bf16 a[92:95], a[28:31], a[156:159], a[92:95]
    v_mfma_f32_16x16x32_bf16 a[88:91], a[28:31], a[152:155], a[88:91]
    v_mfma_f32_16x16x32_bf16 a[88:91], a[24:27], a[136:139], a[88:91]
    v_mfma_f32_16x16x32_bf16 v[220:223], a[24:27], a[132:135], v[220:223]
    v_mfma_f32_16x16x32_bf16 v[220:223], a[28:31], a[148:151], v[220:223]
    v_mfma_f32_16x16x32_bf16 v[216:219], a[28:31], a[144:147], v[216:219]
    v_mfma_f32_16x16x32_bf16 v[216:219], a[24:27], a[128:131], v[216:219]
    s_waitcnt vmcnt(10) lgkmcnt(0)
    s_barrier
    v_mfma_f32_16x16x32_bf16 v[224:227], a[32:35], a[128:131], v[224:227]
    v_mfma_f32_16x16x32_bf16 v[224:227], a[36:39], a[144:147], v[224:227]
    s_add_u32 m0, s60, 131072
    ds_read_b64_tr_b16 a[0:1], v42 offset:16384
    ds_read_b64_tr_b16 a[2:3], v42 offset:17408
    v_mfma_f32_16x16x32_bf16 v[228:231], a[36:39], a[148:151], v[228:231]
    buffer_load_dwordx4 v38, s[12:15], s61 offen offset:0 lds
    v_mfma_f32_16x16x32_bf16 v[228:231], a[32:35], a[132:135], v[228:231]
    ds_read_b64_tr_b16 a[4:5], v42 offset:24576
    v_mfma_f32_16x16x32_bf16 a[96:99], a[32:35], a[136:139], a[96:99]
    buffer_load_dwordx4 v39, s[12:15], s61 offen offset:1024 lds
    ds_read_b64_tr_b16 a[6:7], v42 offset:25600
    v_mfma_f32_16x16x32_bf16 a[96:99], a[36:39], a[152:155], a[96:99]
    ds_read_b64_tr_b16 a[8:9], v43 offset:16384
    v_mfma_f32_16x16x32_bf16 a[100:103], a[36:39], a[156:159], a[100:103]
    v_mfma_f32_16x16x32_bf16 a[100:103], a[32:35], a[140:143], a[100:103]
    buffer_load_dwordx4 v40, s[12:15], s61 offen offset:2048 lds
    ds_read_b64_tr_b16 a[10:11], v43 offset:17408
    v_mfma_f32_16x16x32_bf16 a[108:111], a[40:43], a[140:143], a[108:111]
    ds_read_b64_tr_b16 a[12:13], v43 offset:24576
    v_mfma_f32_16x16x32_bf16 a[108:111], a[44:47], a[156:159], a[108:111]
    ds_read_b64_tr_b16 a[14:15], v43 offset:25600
    v_mfma_f32_16x16x32_bf16 a[104:107], a[44:47], a[152:155], a[104:107]
    ds_read_b64_tr_b16 a[16:17], v44 offset:16384
    v_mfma_f32_16x16x32_bf16 a[104:107], a[40:43], a[136:139], a[104:107]
    buffer_load_dwordx4 v41, s[12:15], s61 offen offset:3072 lds
    v_mfma_f32_16x16x32_bf16 v[236:239], a[40:43], a[132:135], v[236:239]
    ds_read_b64_tr_b16 a[18:19], v44 offset:17408
    v_mfma_f32_16x16x32_bf16 v[236:239], a[44:47], a[148:151], v[236:239]
    s_add_u32 s61, s61, 0x80000
    ds_read_b64_tr_b16 a[20:21], v44 offset:24576
    v_mfma_f32_16x16x32_bf16 v[232:235], a[44:47], a[144:147], v[232:235]
    buffer_load_dwordx4 a[208:211], v36, s[8:11], s62 offen sc1
    ds_read_b64_tr_b16 a[22:23], v44 offset:25600
    v_mfma_f32_16x16x32_bf16 v[232:235], a[40:43], a[128:131], v[232:235]
    v_mfma_f32_16x16x32_bf16 v[240:243], a[48:51], a[128:131], v[240:243]
    ds_read_b64_tr_b16 a[24:25], v45 offset:16384
    v_mfma_f32_16x16x32_bf16 v[240:243], a[52:55], a[144:147], v[240:243]
    buffer_load_dwordx4 a[212:215], v54, s[8:11], s62 offen sc1
    ds_read_b64_tr_b16 a[26:27], v45 offset:17408
    v_mfma_f32_16x16x32_bf16 v[244:247], a[52:55], a[148:151], v[244:247]
    ds_read_b64_tr_b16 a[28:29], v45 offset:24576
    v_mfma_f32_16x16x32_bf16 v[244:247], a[48:51], a[132:135], v[244:247]
    v_mfma_f32_16x16x32_bf16 a[112:115], a[48:51], a[136:139], a[112:115]
    buffer_load_dwordx4 a[216:219], v37, s[8:11], s62 offen sc1
    ds_read_b64_tr_b16 a[30:31], v45 offset:25600
    v_mfma_f32_16x16x32_bf16 a[112:115], a[52:55], a[152:155], a[112:115]
    v_mfma_f32_16x16x32_bf16 a[116:119], a[52:55], a[156:159], a[116:119]
    v_mfma_f32_16x16x32_bf16 a[116:119], a[48:51], a[140:143], a[116:119]
    v_mfma_f32_16x16x32_bf16 a[124:127], a[56:59], a[140:143], a[124:127]
    buffer_load_dwordx4 a[220:223], v55, s[8:11], s62 offen sc1
    v_mfma_f32_16x16x32_bf16 a[124:127], a[60:63], a[156:159], a[124:127]
    v_mfma_f32_16x16x32_bf16 a[120:123], a[60:63], a[152:155], a[120:123]
    s_add_u32 s62, s62, 0x20000
    v_mfma_f32_16x16x32_bf16 a[120:123], a[56:59], a[136:139], a[120:123]
    v_mfma_f32_16x16x32_bf16 v[252:255], a[56:59], a[132:135], v[252:255]
    s_cmp_eq_u32 s45, 0
    s_cbranch_scc1 k12_ool_52
k12_oolret_53:
    v_mfma_f32_16x16x32_bf16 v[252:255], a[60:63], a[148:151], v[252:255]
    v_mfma_f32_16x16x32_bf16 v[248:251], a[60:63], a[144:147], v[248:251]
    v_mfma_f32_16x16x32_bf16 v[248:251], a[56:59], a[128:131], v[248:251]
    s_waitcnt vmcnt(14) lgkmcnt(0)
    v_mfma_f32_16x16x32_bf16 v[192:195], a[0:3], a[160:163], v[192:195]
    v_mfma_f32_16x16x32_bf16 v[192:195], a[4:7], a[176:179], v[192:195]
    buffer_load_dwordx4 a[224:227], v36, s[8:11], s62 offen sc1
    ds_read_b64_tr_b16 a[32:33], v46 offset:16384
    v_mfma_f32_16x16x32_bf16 v[196:199], a[4:7], a[180:183], v[196:199]
    ds_read_b64_tr_b16 a[34:35], v46 offset:17408
    v_mfma_f32_16x16x32_bf16 v[196:199], a[0:3], a[164:167], v[196:199]
    ds_read_b64_tr_b16 a[36:37], v46 offset:24576
    v_mfma_f32_16x16x32_bf16 a[64:67], a[0:3], a[168:171], a[64:67]
    ds_read_b64_tr_b16 a[38:39], v46 offset:25600
    v_mfma_f32_16x16x32_bf16 a[64:67], a[4:7], a[184:187], a[64:67]
    ds_read_b64_tr_b16 a[40:41], v47 offset:16384
    v_mfma_f32_16x16x32_bf16 a[68:71], a[4:7], a[188:191], a[68:71]
    buffer_load_dwordx4 a[228:231], v54, s[8:11], s62 offen sc1
    v_mfma_f32_16x16x32_bf16 a[68:71], a[0:3], a[172:175], a[68:71]
    ds_read_b64_tr_b16 a[42:43], v47 offset:17408
    v_mfma_f32_16x16x32_bf16 a[76:79], a[8:11], a[172:175], a[76:79]
    ds_read_b64_tr_b16 a[44:45], v47 offset:24576
    v_mfma_f32_16x16x32_bf16 a[76:79], a[12:15], a[188:191], a[76:79]
    ds_read_b64_tr_b16 a[46:47], v47 offset:25600
    v_mfma_f32_16x16x32_bf16 a[72:75], a[12:15], a[184:187], a[72:75]
    ds_read_b64_tr_b16 a[48:49], v48 offset:16384
    v_mfma_f32_16x16x32_bf16 a[72:75], a[8:11], a[168:171], a[72:75]
    buffer_load_dwordx4 a[232:235], v37, s[8:11], s62 offen sc1
    v_mfma_f32_16x16x32_bf16 v[204:207], a[8:11], a[164:167], v[204:207]
    ds_read_b64_tr_b16 a[50:51], v48 offset:17408
    v_mfma_f32_16x16x32_bf16 v[204:207], a[12:15], a[180:183], v[204:207]
    ds_read_b64_tr_b16 a[52:53], v48 offset:24576
    v_mfma_f32_16x16x32_bf16 v[200:203], a[12:15], a[176:179], v[200:203]
    ds_read_b64_tr_b16 a[54:55], v48 offset:25600
    v_mfma_f32_16x16x32_bf16 v[200:203], a[8:11], a[160:163], v[200:203]
    v_mfma_f32_16x16x32_bf16 v[208:211], a[16:19], a[160:163], v[208:211]
    ds_read_b64_tr_b16 a[56:57], v49 offset:16384
    v_mfma_f32_16x16x32_bf16 v[208:211], a[20:23], a[176:179], v[208:211]
    buffer_load_dwordx4 a[236:239], v55, s[8:11], s62 offen sc1
    ds_read_b64_tr_b16 a[58:59], v49 offset:17408
    v_mfma_f32_16x16x32_bf16 v[212:215], a[20:23], a[180:183], v[212:215]
    ds_read_b64_tr_b16 a[60:61], v49 offset:24576
    v_mfma_f32_16x16x32_bf16 v[212:215], a[16:19], a[164:167], v[212:215]
    v_mfma_f32_16x16x32_bf16 a[80:83], a[16:19], a[168:171], a[80:83]
    ds_read_b64_tr_b16 a[62:63], v49 offset:25600
    v_mfma_f32_16x16x32_bf16 a[80:83], a[20:23], a[184:187], a[80:83]
    s_add_u32 s62, s62, 0x20000
    v_mfma_f32_16x16x32_bf16 a[84:87], a[20:23], a[188:191], a[84:87]
    s_add_u32 s52, s47, 4096
    v_mfma_f32_16x16x32_bf16 a[84:87], a[16:19], a[172:175], a[84:87]
    buffer_store_dwordx4 v[88:91], v1, s[48:51], s52 offen offset:2048 sc1
    v_mfma_f32_16x16x32_bf16 a[92:95], a[24:27], a[172:175], a[92:95]
    v_mfma_f32_16x16x32_bf16 a[92:95], a[28:31], a[188:191], a[92:95]
    v_mfma_f32_16x16x32_bf16 a[88:91], a[28:31], a[184:187], a[88:91]
    v_mfma_f32_16x16x32_bf16 a[88:91], a[24:27], a[168:171], a[88:91]
    v_mfma_f32_16x16x32_bf16 v[220:223], a[24:27], a[164:167], v[220:223]
    v_mfma_f32_16x16x32_bf16 v[220:223], a[28:31], a[180:183], v[220:223]
    v_mfma_f32_16x16x32_bf16 v[216:219], a[28:31], a[176:179], v[216:219]
    v_mfma_f32_16x16x32_bf16 v[216:219], a[24:27], a[160:163], v[216:219]
    s_waitcnt vmcnt(9) lgkmcnt(0)
    s_barrier
    v_mfma_f32_16x16x32_bf16 v[224:227], a[32:35], a[160:163], v[224:227]
    v_mfma_f32_16x16x32_bf16 v[224:227], a[36:39], a[176:179], v[224:227]
    s_add_u32 m0, s60, 147456
    ds_read_b64_tr_b16 a[0:1], v42 offset:32768
    ds_read_b64_tr_b16 a[2:3], v42 offset:33792
    v_mfma_f32_16x16x32_bf16 v[228:231], a[36:39], a[180:183], v[228:231]
    buffer_load_dwordx4 v38, s[12:15], s61 offen offset:0 lds
    v_mfma_f32_16x16x32_bf16 v[228:231], a[32:35], a[164:167], v[228:231]
    ds_read_b64_tr_b16 a[4:5], v42 offset:40960
    v_mfma_f32_16x16x32_bf16 a[96:99], a[32:35], a[168:171], a[96:99]
    buffer_load_dwordx4 v39, s[12:15], s61 offen offset:1024 lds
    ds_read_b64_tr_b16 a[6:7], v42 offset:41984
    v_mfma_f32_16x16x32_bf16 a[96:99], a[36:39], a[184:187], a[96:99]
    ds_read_b64_tr_b16 a[8:9], v43 offset:32768
    v_mfma_f32_16x16x32_bf16 a[100:103], a[36:39], a[188:191], a[100:103]
    v_mfma_f32_16x16x32_bf16 a[100:103], a[32:35], a[172:175], a[100:103]
    buffer_load_dwordx4 v40, s[12:15], s61 offen offset:2048 lds
    ds_read_b64_tr_b16 a[10:11], v43 offset:33792
    v_mfma_f32_16x16x32_bf16 a[108:111], a[40:43], a[172:175], a[108:111]
    ds_read_b64_tr_b16 a[12:13], v43 offset:40960
    v_mfma_f32_16x16x32_bf16 a[108:111], a[44:47], a[188:191], a[108:111]
    ds_read_b64_tr_b16 a[14:15], v43 offset:41984
    v_mfma_f32_16x16x32_bf16 a[104:107], a[44:47], a[184:187], a[104:107]
    buffer_load_dwordx4 v41, s[12:15], s61 offen offset:3072 lds
    ds_read_b64_tr_b16 a[16:17], v44 offset:32768
    v_mfma_f32_16x16x32_bf16 a[104:107], a[40:43], a[168:171], a[104:107]
    v_mfma_f32_16x16x32_bf16 v[236:239], a[40:43], a[164:167], v[236:239]
    s_add_u32 s61, s61, 0x80000
    ds_read_b64_tr_b16 a[18:19], v44 offset:33792
    v_mfma_f32_16x16x32_bf16 v[236:239], a[44:47], a[180:183], v[236:239]
    buffer_load_dwordx4 a[240:243], v36, s[8:11], s62 offen sc1
    ds_read_b64_tr_b16 a[20:21], v44 offset:40960
    v_mfma_f32_16x16x32_bf16 v[232:235], a[44:47], a[176:179], v[232:235]
    ds_read_b64_tr_b16 a[22:23], v44 offset:41984
    v_mfma_f32_16x16x32_bf16 v[232:235], a[40:43], a[160:163], v[232:235]
    buffer_load_dwordx4 a[244:247], v54, s[8:11], s62 offen sc1
    v_mfma_f32_16x16x32_bf16 v[240:243], a[48:51], a[160:163], v[240:243]
    ds_read_b64_tr_b16 a[24:25], v45 offset:32768
    v_mfma_f32_16x16x32_bf16 v[240:243], a[52:55], a[176:179], v[240:243]
    ds_read_b64_tr_b16 a[26:27], v45 offset:33792
    v_mfma_f32_16x16x32_bf16 v[244:247], a[52:55], a[180:183], v[244:247]
    buffer_load_dwordx4 a[248:251], v37, s[8:11], s62 offen sc1
    ds_read_b64_tr_b16 a[28:29], v45 offset:40960
    v_mfma_f32_16x16x32_bf16 v[244:247], a[48:51], a[164:167], v[244:247]
    v_mfma_f32_16x16x32_bf16 a[112:115], a[48:51], a[168:171], a[112:115]
    ds_read_b64_tr_b16 a[30:31], v45 offset:41984
    v_mfma_f32_16x16x32_bf16 a[112:115], a[52:55], a[184:187], a[112:115]
    buffer_load_dwordx4 a[252:255], v55, s[8:11], s62 offen sc1
    v_mfma_f32_16x16x32_bf16 a[116:119], a[52:55], a[188:191], a[116:119]
    v_mfma_f32_16x16x32_bf16 a[116:119], a[48:51], a[172:175], a[116:119]
    s_add_u32 s62, s62, 0x20000
    v_mfma_f32_16x16x32_bf16 a[124:127], a[56:59], a[172:175], a[124:127]
    s_add_u32 s52, s47, 4096
    v_mfma_f32_16x16x32_bf16 a[124:127], a[60:63], a[188:191], a[124:127]
    buffer_store_dwordx4 v[92:95], v1, s[48:51], s52 offen offset:3072 sc1
    v_mfma_f32_16x16x32_bf16 a[120:123], a[60:63], a[184:187], a[120:123]
    v_mfma_f32_16x16x32_bf16 a[120:123], a[56:59], a[168:171], a[120:123]
    v_mfma_f32_16x16x32_bf16 v[252:255], a[56:59], a[164:167], v[252:255]
    s_cmp_eq_u32 s45, 0
    s_cbranch_scc1 k12_ool_54
k12_oolret_55:
    v_mfma_f32_16x16x32_bf16 v[252:255], a[60:63], a[180:183], v[252:255]
    v_mfma_f32_16x16x32_bf16 v[248:251], a[60:63], a[176:179], v[248:251]
    v_mfma_f32_16x16x32_bf16 v[248:251], a[56:59], a[160:163], v[248:251]
    s_waitcnt vmcnt(14) lgkmcnt(0)
    v_mfma_f32_16x16x32_bf16 v[192:195], a[0:3], a[192:195], v[192:195]
    v_mfma_f32_16x16x32_bf16 v[192:195], a[4:7], a[208:211], v[192:195]
    buffer_load_dwordx4 a[128:131], v36, s[8:11], s62 offen sc1
    ds_read_b64_tr_b16 a[32:33], v46 offset:32768
    v_mfma_f32_16x16x32_bf16 v[196:199], a[4:7], a[212:215], v[196:199]
    ds_read_b64_tr_b16 a[34:35], v46 offset:33792
    v_mfma_f32_16x16x32_bf16 v[196:199], a[0:3], a[196:199], v[196:199]
    ds_read_b64_tr_b16 a[36:37], v46 offset:40960
    v_mfma_f32_16x16x32_bf16 a[64:67], a[0:3], a[200:203], a[64:67]
    ds_read_b64_tr_b16 a[38:39], v46 offset:41984
    v_mfma_f32_16x16x32_bf16 a[64:67], a[4:7], a[216:219], a[64:67]
    ds_read_b64_tr_b16 a[40:41], v47 offset:32768
    v_mfma_f32_16x16x32_bf16 a[68:71], a[4:7], a[220:223], a[68:71]
    buffer_load_dwordx4 a[132:135], v54, s[8:11], s62 offen sc1
    v_mfma_f32_16x16x32_bf16 a[68:71], a[0:3], a[204:207], a[68:71]
    ds_read_b64_tr_b16 a[42:43], v47 offset:33792
    v_mfma_f32_16x16x32_bf16 a[76:79], a[8:11], a[204:207], a[76:79]
    ds_read_b64_tr_b16 a[44:45], v47 offset:40960
    v_mfma_f32_16x16x32_bf16 a[76:79], a[12:15], a[220:223], a[76:79]
    ds_read_b64_tr_b16 a[46:47], v47 offset:41984
    v_mfma_f32_16x16x32_bf16 a[72:75], a[12:15], a[216:219], a[72:75]
    ds_read_b64_tr_b16 a[48:49], v48 offset:32768
    v_mfma_f32_16x16x32_bf16 a[72:75], a[8:11], a[200:203], a[72:75]
    buffer_load_dwordx4 a[136:139], v37, s[8:11], s62 offen sc1
    v_mfma_f32_16x16x32_bf16 v[204:207], a[8:11], a[196:199], v[204:207]
    ds_read_b64_tr_b16 a[50:51], v48 offset:33792
    v_mfma_f32_16x16x32_bf16 v[204:207], a[12:15], a[212:215], v[204:207]
    ds_read_b64_tr_b16 a[52:53], v48 offset:40960
    v_mfma_f32_16x16x32_bf16 v[200:203], a[12:15], a[208:211], v[200:203]
    ds_read_b64_tr_b16 a[54:55], v48 offset:41984
    v_mfma_f32_16x16x32_bf16 v[200:203], a[8:11], a[192:195], v[200:203]
    v_mfma_f32_16x16x32_bf16 v[208:211], a[16:19], a[192:195], v[208:211]
    ds_read_b64_tr_b16 a[56:57], v49 offset:32768
    v_mfma_f32_16x16x32_bf16 v[208:211], a[20:23], a[208:211], v[208:211]
    buffer_load_dwordx4 a[140:143], v55, s[8:11], s62 offen sc1
    ds_read_b64_tr_b16 a[58:59], v49 offset:33792
    v_mfma_f32_16x16x32_bf16 v[212:215], a[20:23], a[212:215], v[212:215]
    ds_read_b64_tr_b16 a[60:61], v49 offset:40960
    v_mfma_f32_16x16x32_bf16 v[212:215], a[16:19], a[196:199], v[212:215]
    v_mfma_f32_16x16x32_bf16 a[80:83], a[16:19], a[200:203], a[80:83]
    ds_read_b64_tr_b16 a[62:63], v49 offset:41984
    v_mfma_f32_16x16x32_bf16 a[80:83], a[20:23], a[216:219], a[80:83]
    s_add_u32 s62, s62, 0x20000
    v_mfma_f32_16x16x32_bf16 a[84:87], a[20:23], a[220:223], a[84:87]
    s_add_u32 s52, s47, 8192
    v_mfma_f32_16x16x32_bf16 a[84:87], a[16:19], a[204:207], a[84:87]
    buffer_store_dwordx4 v[104:107], v1, s[48:51], s52 offen offset:2048 sc1
    v_mfma_f32_16x16x32_bf16 a[92:95], a[24:27], a[204:207], a[92:95]
    v_mfma_f32_16x16x32_bf16 a[92:95], a[28:31], a[220:223], a[92:95]
    v_mfma_f32_16x16x32_bf16 a[88:91], a[28:31], a[216:219], a[88:91]
    v_mfma_f32_16x16x32_bf16 a[88:91], a[24:27], a[200:203], a[88:91]
    v_mfma_f32_16x16x32_bf16 v[220:223], a[24:27], a[196:199], v[220:223]
    v_mfma_f32_16x16x32_bf16 v[220:223], a[28:31], a[212:215], v[220:223]
    v_mfma_f32_16x16x32_bf16 v[216:219], a[28:31], a[208:211], v[216:219]
    v_mfma_f32_16x16x32_bf16 v[216:219], a[24:27], a[192:195], v[216:219]
    s_waitcnt vmcnt(10) lgkmcnt(0)
    s_barrier
    v_mfma_f32_16x16x32_bf16 v[224:227], a[32:35], a[192:195], v[224:227]
    v_mfma_f32_16x16x32_bf16 v[224:227], a[36:39], a[208:211], v[224:227]
    s_add_u32 m0, s60, 98304
    ds_read_b64_tr_b16 a[0:1], v42 offset:49152
    ds_read_b64_tr_b16 a[2:3], v42 offset:50176
    v_mfma_f32_16x16x32_bf16 v[228:231], a[36:39], a[212:215], v[228:231]
    buffer_load_dwordx4 v38, s[12:15], s61 offen offset:0 lds
    v_mfma_f32_16x16x32_bf16 v[228:231], a[32:35], a[196:199], v[228:231]
    ds_read_b64_tr_b16 a[4:5], v42 offset:57344
    v_mfma_f32_16x16x32_bf16 a[96:99], a[32:35], a[200:203], a[96:99]
    buffer_load_dwordx4 v39, s[12:15], s61 offen offset:1024 lds
    ds_read_b64_tr_b16 a[6:7], v42 offset:58368
    v_mfma_f32_16x16x32_bf16 a[96:99], a[36:39], a[216:219], a[96:99]
    ds_read_b64_tr_b16 a[8:9], v43 offset:49152
    v_mfma_f32_16x16x32_bf16 a[100:103], a[36:39], a[220:223], a[100:103]
    v_mfma_f32_16x16x32_bf16 a[100:103], a[32:35], a[204:207], a[100:103]
    buffer_load_dwordx4 v40, s[12:15], s61 offen offset:2048 lds
    ds_read_b64_tr_b16 a[10:11], v43 offset:50176
    v_mfma_f32_16x16x32_bf16 a[108:111], a[40:43], a[204:207], a[108:111]
    ds_read_b64_tr_b16 a[12:13], v43 offset:57344
    v_mfma_f32_16x16x32_bf16 a[108:111], a[44:47], a[220:223], a[108:111]
    ds_read_b64_tr_b16 a[14:15], v43 offset:58368
    v_mfma_f32_16x16x32_bf16 a[104:107], a[44:47], a[216:219], a[104:107]
    buffer_load_dwordx4 v41, s[12:15], s61 offen offset:3072 lds
    ds_read_b64_tr_b16 a[16:17], v44 offset:49152
    v_mfma_f32_16x16x32_bf16 a[104:107], a[40:43], a[200:203], a[104:107]
    v_mfma_f32_16x16x32_bf16 v[236:239], a[40:43], a[196:199], v[236:239]
    s_add_u32 s61, s61, 0x80000
    ds_read_b64_tr_b16 a[18:19], v44 offset:50176
    v_mfma_f32_16x16x32_bf16 v[236:239], a[44:47], a[212:215], v[236:239]
    buffer_load_dwordx4 a[144:147], v36, s[8:11], s62 offen sc1
    ds_read_b64_tr_b16 a[20:21], v44 offset:57344
    v_mfma_f32_16x16x32_bf16 v[232:235], a[44:47], a[208:211], v[232:235]
    ds_read_b64_tr_b16 a[22:23], v44 offset:58368
    v_mfma_f32_16x16x32_bf16 v[232:235], a[40:43], a[192:195], v[232:235]
    buffer_load_dwordx4 a[148:151], v54, s[8:11], s62 offen sc1
    v_mfma_f32_16x16x32_bf16 v[240:243], a[48:51], a[192:195], v[240:243]
    ds_read_b64_tr_b16 a[24:25], v45 offset:49152
    v_mfma_f32_16x16x32_bf16 v[240:243], a[52:55], a[208:211], v[240:243]
    ds_read_b64_tr_b16 a[26:27], v45 offset:50176
    v_mfma_f32_16x16x32_bf16 v[244:247], a[52:55], a[212:215], v[244:247]
    buffer_load_dwordx4 a[152:155], v37, s[8:11], s62 offen sc1
    ds_read_b64_tr_b16 a[28:29], v45 offset:57344
    v_mfma_f32_16x16x32_bf16 v[244:247], a[48:51], a[196:199], v[244:247]
    v_mfma_f32_16x16x32_bf16 a[112:115], a[48:51], a[200:203], a[112:115]
    ds_read_b64_tr_b16 a[30:31], v45 offset:58368
    v_mfma_f32_16x16x32_bf16 a[112:115], a[52:55], a[216:219], a[112:115]
    buffer_load_dwordx4 a[156:159], v55, s[8:11], s62 offen sc1
    v_mfma_f32_16x16x32_bf16 a[116:119], a[52:55], a[220:223], a[116:119]
    v_mfma_f32_16x16x32_bf16 a[116:119], a[48:51], a[204:207], a[116:119]
    s_add_u32 s62, s62, 0x20000
    v_mfma_f32_16x16x32_bf16 a[124:127], a[56:59], a[204:207], a[124:127]
    s_add_u32 s52, s47, 8192
    v_mfma_f32_16x16x32_bf16 a[124:127], a[60:63], a[220:223], a[124:127]
    buffer_store_dwordx4 v[108:111], v1, s[48:51], s52 offen offset:3072 sc1
    v_mfma_f32_16x16x32_bf16 a[120:123], a[60:63], a[216:219], a[120:123]
    v_mfma_f32_16x16x32_bf16 a[120:123], a[56:59], a[200:203], a[120:123]
    v_mfma_f32_16x16x32_bf16 v[252:255], a[56:59], a[196:199], v[252:255]
    v_mfma_f32_16x16x32_bf16 v[252:255], a[60:63], a[212:215], v[252:255]
    v_mfma_f32_16x16x32_bf16 v[248:251], a[60:63], a[208:211], v[248:251]
    v_mfma_f32_16x16x32_bf16 v[248:251], a[56:59], a[192:195], v[248:251]
    s_waitcnt vmcnt(15) lgkmcnt(0)
    v_mfma_f32_16x16x32_bf16 v[192:195], a[0:3], a[224:227], v[192:195]
    v_mfma_f32_16x16x32_bf16 v[192:195], a[4:7], a[240:243], v[192:195]
    buffer_load_dwordx4 a[160:163], v36, s[8:11], s62 offen sc1
    ds_read_b64_tr_b16 a[32:33], v46 offset:49152
    v_mfma_f32_16x16x32_bf16 v[196:199], a[4:7], a[244:247], v[196:199]
    ds_read_b64_tr_b16 a[34:35], v46 offset:50176
    v_mfma_f32_16x16x32_bf16 v[196:199], a[0:3], a[228:231], v[196:199]
    ds_read_b64_tr_b16 a[36:37], v46 offset:57344
    v_mfma_f32_16x16x32_bf16 a[64:67], a[0:3], a[232:235], a[64:67]
    ds_read_b64_tr_b16 a[38:39], v46 offset:58368
    v_mfma_f32_16x16x32_bf16 a[64:67], a[4:7], a[248:251], a[64:67]
    ds_read_b64_tr_b16 a[40:41], v47 offset:49152
    v_mfma_f32_16x16x32_bf16 a[68:71], a[4:7], a[252:255], a[68:71]
    buffer_load_dwordx4 a[164:167], v54, s[8:11], s62 offen sc1
    v_mfma_f32_16x16x32_bf16 a[68:71], a[0:3], a[236:239], a[68:71]
    ds_read_b64_tr_b16 a[42:43], v47 offset:50176
    v_mfma_f32_16x16x32_bf16 a[76:79], a[8:11], a[236:239], a[76:79]
    ds_read_b64_tr_b16 a[44:45], v47 offset:57344
    v_mfma_f32_16x16x32_bf16 a[76:79], a[12:15], a[252:255], a[76:79]
    ds_read_b64_tr_b16 a[46:47], v47 offset:58368
    v_mfma_f32_16x16x32_bf16 a[72:75], a[12:15], a[248:251], a[72:75]
    ds_read_b64_tr_b16 a[48:49], v48 offset:49152
    v_mfma_f32_16x16x32_bf16 a[72:75], a[8:11], a[232:235], a[72:75]
    buffer_load_dwordx4 a[168:171], v37, s[8:11], s62 offen sc1
    v_mfma_f32_16x16x32_bf16 v[204:207], a[8:11], a[228:231], v[204:207]
    ds_read_b64_tr_b16 a[50:51], v48 offset:50176
    v_mfma_f32_16x16x32_bf16 v[204:207], a[12:15], a[244:247], v[204:207]
    ds_read_b64_tr_b16 a[52:53], v48 offset:57344
    v_mfma_f32_16x16x32_bf16 v[200:203], a[12:15], a[240:243], v[200:203]
    ds_read_b64_tr_b16 a[54:55], v48 offset:58368
    v_mfma_f32_16x16x32_bf16 v[200:203], a[8:11], a[224:227], v[200:203]
    v_mfma_f32_16x16x32_bf16 v[208:211], a[16:19], a[224:227], v[208:211]
    ds_read_b64_tr_b16 a[56:57], v49 offset:49152
    v_mfma_f32_16x16x32_bf16 v[208:211], a[20:23], a[240:243], v[208:211]
    buffer_load_dwordx4 a[172:175], v55, s[8:11], s62 offen sc1
    ds_read_b64_tr_b16 a[58:59], v49 offset:50176
    v_mfma_f32_16x16x32_bf16 v[212:215], a[20:23], a[244:247], v[212:215]
    ds_read_b64_tr_b16 a[60:61], v49 offset:57344
    v_mfma_f32_16x16x32_bf16 v[212:215], a[16:19], a[228:231], v[212:215]
    v_mfma_f32_16x16x32_bf16 a[80:83], a[16:19], a[232:235], a[80:83]
    ds_read_b64_tr_b16 a[62:63], v49 offset:58368
    v_mfma_f32_16x16x32_bf16 a[80:83], a[20:23], a[248:251], a[80:83]
    s_add_u32 s62, s62, 0x20000
    v_mfma_f32_16x16x32_bf16 a[84:87], a[20:23], a[252:255], a[84:87]
    s_add_u32 s52, s47, 12288
    v_mfma_f32_16x16x32_bf16 a[84:87], a[16:19], a[236:239], a[84:87]
    buffer_store_dwordx4 v[112:115], v1, s[48:51], s52 offen offset:0 sc1
    v_mfma_f32_16x16x32_bf16 a[92:95], a[24:27], a[236:239], a[92:95]
    v_mfma_f32_16x16x32_bf16 a[92:95], a[28:31], a[252:255], a[92:95]
    v_mfma_f32_16x16x32_bf16 a[88:91], a[28:31], a[248:251], a[88:91]
    v_mfma_f32_16x16x32_bf16 a[88:91], a[24:27], a[232:235], a[88:91]
    v_mfma_f32_16x16x32_bf16 v[220:223], a[24:27], a[228:231], v[220:223]
    s_cmp_eq_u32 s45, 0
    s_cbranch_scc1 k12_ool_56
k12_oolret_57:
    v_mfma_f32_16x16x32_bf16 v[220:223], a[28:31], a[244:247], v[220:223]
    v_mfma_f32_16x16x32_bf16 v[216:219], a[28:31], a[240:243], v[216:219]
    v_mfma_f32_16x16x32_bf16 v[216:219], a[24:27], a[224:227], v[216:219]
    s_waitcnt vmcnt(10) lgkmcnt(0)
    s_barrier
    v_mfma_f32_16x16x32_bf16 v[224:227], a[32:35], a[224:227], v[224:227]
    v_mfma_f32_16x16x32_bf16 v[224:227], a[36:39], a[240:243], v[224:227]
    s_add_u32 m0, s60, 114688
    ds_read_b64_tr_b16 a[0:1], v42 offset:0
    ds_read_b64_tr_b16 a[2:3], v42 offset:1024
    v_mfma_f32_16x16x32_bf16 v[228:231], a[36:39], a[244:247], v[228:231]
    buffer_load_dwordx4 v38, s[12:15], s61 offen offset:0 lds
    v_mfma_f32_16x16x32_bf16 v[228:231], a[32:35], a[228:231], v[228:231]
    ds_read_b64_tr_b16 a[4:5], v42 offset:8192
    v_mfma_f32_16x16x32_bf16 a[96:99], a[32:35], a[232:235], a[96:99]
    buffer_load_dwordx4 v39, s[12:15], s61 offen offset:1024 lds
    ds_read_b64_tr_b16 a[6:7], v42 offset:9216
    v_mfma_f32_16x16x32_bf16 a[96:99], a[36:39], a[248:251], a[96:99]
    ds_read_b64_tr_b16 a[8:9], v43 offset:0
    v_mfma_f32_16x16x32_bf16 a[100:103], a[36:39], a[252:255], a[100:103]
    v_mfma_f32_16x16x32_bf16 a[100:103], a[32:35], a[236:239], a[100:103]
    buffer_load_dwordx4 v40, s[12:15], s61 offen offset:2048 lds
    ds_read_b64_tr_b16 a[10:11], v43 offset:1024
    v_mfma_f32_16x16x32_bf16 a[108:111], a[40:43], a[236:239], a[108:111]
    ds_read_b64_tr_b16 a[12:13], v43 offset:8192
    v_mfma_f32_16x16x32_bf16 a[108:111], a[44:47], a[252:255], a[108:111]
    ds_read_b64_tr_b16 a[14:15], v43 offset:9216
    v_mfma_f32_16x16x32_bf16 a[104:107], a[44:47], a[248:251], a[104:107]
    ds_read_b64_tr_b16 a[16:17], v44 offset:0
    v_mfma_f32_16x16x32_bf16 a[104:107], a[40:43], a[232:235], a[104:107]
    buffer_load_dwordx4 v41, s[12:15], s61 offen offset:3072 lds
    v_mfma_f32_16x16x32_bf16 v[236:239], a[40:43], a[228:231], v[236:239]
    ds_read_b64_tr_b16 a[18:19], v44 offset:1024
    v_mfma_f32_16x16x32_bf16 v[236:239], a[44:47], a[244:247], v[236:239]
    s_add_u32 s61, s61, 0x80000
    ds_read_b64_tr_b16 a[20:21], v44 offset:8192
    v_mfma_f32_16x16x32_bf16 v[232:235], a[44:47], a[240:243], v[232:235]
    buffer_load_dwordx4 a[176:179], v36, s[8:11], s62 offen sc1
    ds_read_b64_tr_b16 a[22:23], v44 offset:9216
    v_mfma_f32_16x16x32_bf16 v[232:235], a[40:43], a[224:227], v[232:235]
    v_mfma_f32_16x16x32_bf16 v[240:243], a[48:51], a[224:227], v[240:243]
    ds_read_b64_tr_b16 a[24:25], v45 offset:0
    v_mfma_f32_16x16x32_bf16 v[240:243], a[52:55], a[240:243], v[240:243]
    buffer_load_dwordx4 a[180:183], v54, s[8:11], s62 offen sc1
    ds_read_b64_tr_b16 a[26:27], v45 offset:1024
    v_mfma_f32_16x16x32_bf16 v[244:247], a[52:55], a[244:247], v[244:247]
    ds_read_b64_tr_b16 a[28:29], v45 offset:8192
    v_mfma_f32_16x16x32_bf16 v[244:247], a[48:51], a[228:231], v[244:247]
    v_mfma_f32_16x16x32_bf16 a[112:115], a[48:51], a[232:235], a[112:115]
    buffer_load_dwordx4 a[184:187], v37, s[8:11], s62 offen sc1
    ds_read_b64_tr_b16 a[30:31], v45 offset:9216
    v_mfma_f32_16x16x32_bf16 a[112:115], a[52:55], a[248:251], a[112:115]
    v_mfma_f32_16x16x32_bf16 a[116:119], a[52:55], a[252:255], a[116:119]
    v_mfma_f32_16x16x32_bf16 a[116:119], a[48:51], a[236:239], a[116:119]
    v_mfma_f32_16x16x32_bf16 a[124:127], a[56:59], a[236:239], a[124:127]
    buffer_load_dwordx4 a[188:191], v55, s[8:11], s62 offen sc1
    v_mfma_f32_16x16x32_bf16 a[124:127], a[60:63], a[252:255], a[124:127]
    v_mfma_f32_16x16x32_bf16 a[120:123], a[60:63], a[248:251], a[120:123]
    s_add_u32 s62, s62, 0x20000
    v_mfma_f32_16x16x32_bf16 a[120:123], a[56:59], a[232:235], a[120:123]
    v_mfma_f32_16x16x32_bf16 v[252:255], a[56:59], a[228:231], v[252:255]
    v_mfma_f32_16x16x32_bf16 v[252:255], a[60:63], a[244:247], v[252:255]
    v_mfma_f32_16x16x32_bf16 v[248:251], a[60:63], a[240:243], v[248:251]
    v_mfma_f32_16x16x32_bf16 v[248:251], a[56:59], a[224:227], v[248:251]
    s_waitcnt vmcnt(14) lgkmcnt(0)
    v_mfma_f32_16x16x32_bf16 v[192:195], a[0:3], a[128:131], v[192:195]
    v_mfma_f32_16x16x32_bf16 v[192:195], a[4:7], a[144:147], v[192:195]
    buffer_load_dwordx4 a[192:195], v36, s[8:11], s62 offen sc1
    ds_read_b64_tr_b16 a[32:33], v46 offset:0
    v_mfma_f32_16x16x32_bf16 v[196:199], a[4:7], a[148:151], v[196:199]
    ds_read_b64_tr_b16 a[34:35], v46 offset:1024
    v_mfma_f32_16x16x32_bf16 v[196:199], a[0:3], a[132:135], v[196:199]
    ds_read_b64_tr_b16 a[36:37], v46 offset:8192
    v_mfma_f32_16x16x32_bf16 a[64:67], a[0:3], a[136:139], a[64:67]
    ds_read_b64_tr_b16 a[38:39], v46 offset:9216
    v_mfma_f32_16x16x32_bf16 a[64:67], a[4:7], a[152:155], a[64:67]
    ds_read_b64_tr_b16 a[40:41], v47 offset:0
    v_mfma_f32_16x16x32_bf16 a[68:71], a[4:7], a[156:159], a[68:71]
    buffer_load_dwordx4 a[196:199], v54, s[8:11], s62 offen sc1
    v_mfma_f32_16x16x32_bf16 a[68:71], a[0:3], a[140:143], a[68:71]
    ds_read_b64_tr_b16 a[42:43], v47 offset:1024
    v_mfma_f32_16x16x32_bf16 a[76:79], a[8:11], a[140:143], a[76:79]
    ds_read_b64_tr_b16 a[44:45], v47 offset:8192
    v_mfma_f32_16x16x32_bf16 a[76:79], a[12:15], a[156:159], a[76:79]
    ds_read_b64_tr_b16 a[46:47], v47 offset:9216
    v_mfma_f32_16x16x32_bf16 a[72:75], a[12:15], a[152:155], a[72:75]
    ds_read_b64_tr_b16 a[48:49], v48 offset:0
    v_mfma_f32_16x16x32_bf16 a[72:75], a[8:11], a[136:139], a[72:75]
    buffer_load_dwordx4 a[200:203], v37, s[8:11], s62 offen sc1
    v_mfma_f32_16x16x32_bf16 v[204:207], a[8:11], a[132:135], v[204:207]
    ds_read_b64_tr_b16 a[50:51], v48 offset:1024
    v_mfma_f32_16x16x32_bf16 v[204:207], a[12:15], a[148:151], v[204:207]
    ds_read_b64_tr_b16 a[52:53], v48 offset:8192
    v_mfma_f32_16x16x32_bf16 v[200:203], a[12:15], a[144:147], v[200:203]
    ds_read_b64_tr_b16 a[54:55], v48 offset:9216
    v_mfma_f32_16x16x32_bf16 v[200:203], a[8:11], a[128:131], v[200:203]
    v_mfma_f32_16x16x32_bf16 v[208:211], a[16:19], a[128:131], v[208:211]
    ds_read_b64_tr_b16 a[56:57], v49 offset:0
    v_mfma_f32_16x16x32_bf16 v[208:211], a[20:23], a[144:147], v[208:211]
    buffer_load_dwordx4 a[204:207], v55, s[8:11], s62 offen sc1
    ds_read_b64_tr_b16 a[58:59], v49 offset:1024
    v_mfma_f32_16x16x32_bf16 v[212:215], a[20:23], a[148:151], v[212:215]
    ds_read_b64_tr_b16 a[60:61], v49 offset:8192
    v_mfma_f32_16x16x32_bf16 v[212:215], a[16:19], a[132:135], v[212:215]
    v_mfma_f32_16x16x32_bf16 a[80:83], a[16:19], a[136:139], a[80:83]
    ds_read_b64_tr_b16 a[62:63], v49 offset:9216
    v_mfma_f32_16x16x32_bf16 a[80:83], a[20:23], a[152:155], a[80:83]
    s_add_u32 s62, s62, 0x20000
    v_mfma_f32_16x16x32_bf16 a[84:87], a[20:23], a[156:159], a[84:87]
    s_add_u32 s52, s47, 12288
    v_mfma_f32_16x16x32_bf16 a[84:87], a[16:19], a[140:143], a[84:87]
    buffer_store_dwordx4 v[116:119], v1, s[48:51], s52 offen offset:1024 sc1
    v_mfma_f32_16x16x32_bf16 a[92:95], a[24:27], a[140:143], a[92:95]
    v_mfma_f32_16x16x32_bf16 a[92:95], a[28:31], a[156:159], a[92:95]
    v_mfma_f32_16x16x32_bf16 a[88:91], a[28:31], a[152:155], a[88:91]
    v_mfma_f32_16x16x32_bf16 a[88:91], a[24:27], a[136:139], a[88:91]
    v_mfma_f32_16x16x32_bf16 v[220:223], a[24:27], a[132:135], v[220:223]
    s_cmp_eq_u32 s45, 0
    s_cbranch_scc1 k12_ool_58
k12_oolret_59:
    v_mfma_f32_16x16x32_bf16 v[220:223], a[28:31], a[148:151], v[220:223]
    v_mfma_f32_16x16x32_bf16 v[216:219], a[28:31], a[144:147], v[216:219]
    v_mfma_f32_16x16x32_bf16 v[216:219], a[24:27], a[128:131], v[216:219]
    s_waitcnt vmcnt(9) lgkmcnt(0)
    s_barrier
    v_mfma_f32_16x16x32_bf16 v[224:227], a[32:35], a[128:131], v[224:227]
    v_mfma_f32_16x16x32_bf16 v[224:227], a[36:39], a[144:147], v[224:227]
    s_add_u32 m0, s60, 131072
    ds_read_b64_tr_b16 a[0:1], v42 offset:16384
    ds_read_b64_tr_b16 a[2:3], v42 offset:17408
    v_mfma_f32_16x16x32_bf16 v[228:231], a[36:39], a[148:151], v[228:231]
    buffer_load_dwordx4 v38, s[12:15], s61 offen offset:0 lds
    v_mfma_f32_16x16x32_bf16 v[228:231], a[32:35], a[132:135], v[228:231]
    ds_read_b64_tr_b16 a[4:5], v42 offset:24576
    v_mfma_f32_16x16x32_bf16 a[96:99], a[32:35], a[136:139], a[96:99]
    buffer_load_dwordx4 v39, s[12:15], s61 offen offset:1024 lds
    ds_read_b64_tr_b16 a[6:7], v42 offset:25600
    v_mfma_f32_16x16x32_bf16 a[96:99], a[36:39], a[152:155], a[96:99]
    ds_read_b64_tr_b16 a[8:9], v43 offset:16384
    v_mfma_f32_16x16x32_bf16 a[100:103], a[36:39], a[156:159], a[100:103]
    v_mfma_f32_16x16x32_bf16 a[100:103], a[32:35], a[140:143], a[100:103]
    buffer_load_dwordx4 v40, s[12:15], s61 offen offset:2048 lds
    ds_read_b64_tr_b16 a[10:11], v43 offset:17408
    v_mfma_f32_16x16x32_bf16 a[108:111], a[40:43], a[140:143], a[108:111]
    ds_read_b64_tr_b16 a[12:13], v43 offset:24576
    v_mfma_f32_16x16x32_bf16 a[108:111], a[44:47], a[156:159], a[108:111]
    ds_read_b64_tr_b16 a[14:15], v43 offset:25600
    v_mfma_f32_16x16x32_bf16 a[104:107], a[44:47], a[152:155], a[104:107]
    buffer_load_dwordx4 v41, s[12:15], s61 offen offset:3072 lds
    ds_read_b64_tr_b16 a[16:17], v44 offset:16384
    v_mfma_f32_16x16x32_bf16 a[104:107], a[40:43], a[136:139], a[104:107]
    v_mfma_f32_16x16x32_bf16 v[236:239], a[40:43], a[132:135], v[236:239]
    s_add_u32 s61, s61, 0x80000
    ds_read_b64_tr_b16 a[18:19], v44 offset:17408
    v_mfma_f32_16x16x32_bf16 v[236:239], a[44:47], a[148:151], v[236:239]
    buffer_load_dwordx4 a[208:211], v36, s[8:11], s62 offen sc1
    ds_read_b64_tr_b16 a[20:21], v44 offset:24576
    v_mfma_f32_16x16x32_bf16 v[232:235], a[44:47], a[144:147], v[232:235]
    ds_read_b64_tr_b16 a[22:23], v44 offset:25600
    v_mfma_f32_16x16x32_bf16 v[232:235], a[40:43], a[128:131], v[232:235]
    buffer_load_dwordx4 a[212:215], v54, s[8:11], s62 offen sc1
    v_mfma_f32_16x16x32_bf16 v[240:243], a[48:51], a[128:131], v[240:243]
    ds_read_b64_tr_b16 a[24:25], v45 offset:16384
    v_mfma_f32_16x16x32_bf16 v[240:243], a[52:55], a[144:147], v[240:243]
    ds_read_b64_tr_b16 a[26:27], v45 offset:17408
    v_mfma_f32_16x16x32_bf16 v[244:247], a[52:55], a[148:151], v[244:247]
    buffer_load_dwordx4 a[216:219], v37, s[8:11], s62 offen sc1
    ds_read_b64_tr_b16 a[28:29], v45 offset:24576
    v_mfma_f32_16x16x32_bf16 v[244:247], a[48:51], a[132:135], v[244:247]
    v_mfma_f32_16x16x32_bf16 a[112:115], a[48:51], a[136:139], a[112:115]
    ds_read_b64_tr_b16 a[30:31], v45 offset:25600
    v_mfma_f32_16x16x32_bf16 a[112:115], a[52:55], a[152:155], a[112:115]
    buffer_load_dwordx4 a[220:223], v55, s[8:11], s62 offen sc1
    v_mfma_f32_16x16x32_bf16 a[116:119], a[52:55], a[156:159], a[116:119]
    v_mfma_f32_16x16x32_bf16 a[116:119], a[48:51], a[140:143], a[116:119]
    s_add_u32 s62, s62, 0x20000
    v_mfma_f32_16x16x32_bf16 a[124:127], a[56:59], a[140:143], a[124:127]
    s_add_u32 s52, s47, 12288
    v_mfma_f32_16x16x32_bf16 a[124:127], a[60:63], a[156:159], a[124:127]
    buffer_store_dwordx4 v[120:123], v1, s[48:51], s52 offen offset:2048 sc1
    v_mfma_f32_16x16x32_bf16 a[120:123], a[60:63], a[152:155], a[120:123]
    v_mfma_f32_16x16x32_bf16 a[120:123], a[56:59], a[136:139], a[120:123]
    v_mfma_f32_16x16x32_bf16 v[252:255], a[56:59], a[132:135], v[252:255]
    v_mfma_f32_16x16x32_bf16 v[252:255], a[60:63], a[148:151], v[252:255]
    v_mfma_f32_16x16x32_bf16 v[248:251], a[60:63], a[144:147], v[248:251]
    v_mfma_f32_16x16x32_bf16 v[248:251], a[56:59], a[128:131], v[248:251]
    s_waitcnt vmcnt(14) lgkmcnt(0)
    v_mfma_f32_16x16x32_bf16 v[192:195], a[0:3], a[160:163], v[192:195]
    v_mfma_f32_16x16x32_bf16 v[192:195], a[4:7], a[176:179], v[192:195]
    buffer_load_dwordx4 a[224:227], v36, s[8:11], s62 offen sc1
    ds_read_b64_tr_b16 a[32:33], v46 offset:16384
    v_mfma_f32_16x16x32_bf16 v[196:199], a[4:7], a[180:183], v[196:199]
    ds_read_b64_tr_b16 a[34:35], v46 offset:17408
    v_mfma_f32_16x16x32_bf16 v[196:199], a[0:3], a[164:167], v[196:199]
    ds_read_b64_tr_b16 a[36:37], v46 offset:24576
    v_mfma_f32_16x16x32_bf16 a[64:67], a[0:3], a[168:171], a[64:67]
    ds_read_b64_tr_b16 a[38:39], v46 offset:25600
    v_mfma_f32_16x16x32_bf16 a[64:67], a[4:7], a[184:187], a[64:67]
    ds_read_b64_tr_b16 a[40:41], v47 offset:16384
    v_mfma_f32_16x16x32_bf16 a[68:71], a[4:7], a[188:191], a[68:71]
    buffer_load_dwordx4 a[228:231], v54, s[8:11], s62 offen sc1
    v_mfma_f32_16x16x32_bf16 a[68:71], a[0:3], a[172:175], a[68:71]
    ds_read_b64_tr_b16 a[42:43], v47 offset:17408
    v_mfma_f32_16x16x32_bf16 a[76:79], a[8:11], a[172:175], a[76:79]
    ds_read_b64_tr_b16 a[44:45], v47 offset:24576
    v_mfma_f32_16x16x32_bf16 a[76:79], a[12:15], a[188:191], a[76:79]
    ds_read_b64_tr_b16 a[46:47], v47 offset:25600
    v_mfma_f32_16x16x32_bf16 a[72:75], a[12:15], a[184:187], a[72:75]
    ds_read_b64_tr_b16 a[48:49], v48 offset:16384
    v_mfma_f32_16x16x32_bf16 a[72:75], a[8:11], a[168:171], a[72:75]
    buffer_load_dwordx4 a[232:235], v37, s[8:11], s62 offen sc1
    v_mfma_f32_16x16x32_bf16 v[204:207], a[8:11], a[164:167], v[204:207]
    ds_read_b64_tr_b16 a[50:51], v48 offset:17408
    v_mfma_f32_16x16x32_bf16 v[204:207], a[12:15], a[180:183], v[204:207]
    ds_read_b64_tr_b16 a[52:53], v48 offset:24576
    v_mfma_f32_16x16x32_bf16 v[200:203], a[12:15], a[176:179], v[200:203]
    ds_read_b64_tr_b16 a[54:55], v48 offset:25600
    v_mfma_f32_16x16x32_bf16 v[200:203], a[8:11], a[160:163], v[200:203]
    v_mfma_f32_16x16x32_bf16 v[208:211], a[16:19], a[160:163], v[208:211]
    ds_read_b64_tr_b16 a[56:57], v49 offset:16384
    v_mfma_f32_16x16x32_bf16 v[208:211], a[20:23], a[176:179], v[208:211]
    buffer_load_dwordx4 a[236:239], v55, s[8:11], s62 offen sc1
    ds_read_b64_tr_b16 a[58:59], v49 offset:17408
    v_mfma_f32_16x16x32_bf16 v[212:215], a[20:23], a[180:183], v[212:215]
    ds_read_b64_tr_b16 a[60:61], v49 offset:24576
    v_mfma_f32_16x16x32_bf16 v[212:215], a[16:19], a[164:167], v[212:215]
    v_mfma_f32_16x16x32_bf16 a[80:83], a[16:19], a[168:171], a[80:83]
    ds_read_b64_tr_b16 a[62:63], v49 offset:25600
    v_mfma_f32_16x16x32_bf16 a[80:83], a[20:23], a[184:187], a[80:83]
    s_add_u32 s62, s62, 0x20000
    v_mfma_f32_16x16x32_bf16 a[84:87], a[20:23], a[188:191], a[84:87]
    s_add_u32 s52, s47, 12288
    v_mfma_f32_16x16x32_bf16 a[84:87], a[16:19], a[172:175], a[84:87]
    buffer_store_dwordx4 v[124:127], v1, s[48:51], s52 offen offset:3072 sc1
    v_mfma_f32_16x16x32_bf16 a[92:95], a[24:27], a[172:175], a[92:95]
    v_mfma_f32_16x16x32_bf16 a[92:95], a[28:31], a[188:191], a[92:95]
    v_mfma_f32_16x16x32_bf16 a[88:91], a[28:31], a[184:187], a[88:91]
    v_mfma_f32_16x16x32_bf16 a[88:91], a[24:27], a[168:171], a[88:91]
    v_mfma_f32_16x16x32_bf16 v[220:223], a[24:27], a[164:167], v[220:223]
    v_mfma_f32_16x16x32_bf16 v[220:223], a[28:31], a[180:183], v[220:223]
    v_mfma_f32_16x16x32_bf16 v[216:219], a[28:31], a[176:179], v[216:219]
    v_mfma_f32_16x16x32_bf16 v[216:219], a[24:27], a[160:163], v[216:219]
    s_waitcnt vmcnt(10) lgkmcnt(0)
    s_barrier
    v_mfma_f32_16x16x32_bf16 v[224:227], a[32:35], a[160:163], v[224:227]
    v_mfma_f32_16x16x32_bf16 v[224:227], a[36:39], a[176:179], v[224:227]
    s_add_u32 m0, s60, 147456
    ds_read_b64_tr_b16 a[0:1], v42 offset:32768
    ds_read_b64_tr_b16 a[2:3], v42 offset:33792
    v_mfma_f32_16x16x32_bf16 v[228:231], a[36:39], a[180:183], v[228:231]
    buffer_load_dwordx4 v38, s[12:15], s61 offen offset:0 lds
    v_mfma_f32_16x16x32_bf16 v[228:231], a[32:35], a[164:167], v[228:231]
    ds_read_b64_tr_b16 a[4:5], v42 offset:40960
    v_mfma_f32_16x16x32_bf16 a[96:99], a[32:35], a[168:171], a[96:99]
    buffer_load_dwordx4 v39, s[12:15], s61 offen offset:1024 lds
    ds_read_b64_tr_b16 a[6:7], v42 offset:41984
    v_mfma_f32_16x16x32_bf16 a[96:99], a[36:39], a[184:187], a[96:99]
    ds_read_b64_tr_b16 a[8:9], v43 offset:32768
    v_mfma_f32_16x16x32_bf16 a[100:103], a[36:39], a[188:191], a[100:103]
    v_mfma_f32_16x16x32_bf16 a[100:103], a[32:35], a[172:175], a[100:103]
    buffer_load_dwordx4 v40, s[12:15], s61 offen offset:2048 lds
    ds_read_b64_tr_b16 a[10:11], v43 offset:33792
    v_mfma_f32_16x16x32_bf16 a[108:111], a[40:43], a[172:175], a[108:111]
    ds_read_b64_tr_b16 a[12:13], v43 offset:40960
    v_mfma_f32_16x16x32_bf16 a[108:111], a[44:47], a[188:191], a[108:111]
    ds_read_b64_tr_b16 a[14:15], v43 offset:41984
    v_mfma_f32_16x16x32_bf16 a[104:107], a[44:47], a[184:187], a[104:107]
    buffer_load_dwordx4 v41, s[12:15], s61 offen offset:3072 lds
    ds_read_b64_tr_b16 a[16:17], v44 offset:32768
    v_mfma_f32_16x16x32_bf16 a[104:107], a[40:43], a[168:171], a[104:107]
    v_mfma_f32_16x16x32_bf16 v[236:239], a[40:43], a[164:167], v[236:239]
    s_add_u32 s61, s61, 0x80000
    ds_read_b64_tr_b16 a[18:19], v44 offset:33792
    v_mfma_f32_16x16x32_bf16 v[236:239], a[44:47], a[180:183], v[236:239]
    buffer_load_dwordx4 a[240:243], v36, s[8:11], s62 offen sc1
    ds_read_b64_tr_b16 a[20:21], v44 offset:40960
    v_mfma_f32_16x16x32_bf16 v[232:235], a[44:47], a[176:179], v[232:235]
    ds_read_b64_tr_b16 a[22:23], v44 offset:41984
    v_mfma_f32_16x16x32_bf16 v[232:235], a[40:43], a[160:163], v[232:235]
    buffer_load_dwordx4 a[244:247], v54, s[8:11], s62 offen sc1
    v_mfma_f32_16x16x32_bf16 v[240:243], a[48:51], a[160:163], v[240:243]
    ds_read_b64_tr_b16 a[24:25], v45 offset:32768
    v_mfma_f32_16x16x32_bf16 v[240:243], a[52:55], a[176:179], v[240:243]
    ds_read_b64_tr_b16 a[26:27], v45 offset:33792
    v_mfma_f32_16x16x32_bf16 v[244:247], a[52:55], a[180:183], v[244:247]
    buffer_load_dwordx4 a[248:251], v37, s[8:11], s62 offen sc1
    ds_read_b64_tr_b16 a[28:29], v45 offset:40960
    v_mfma_f32_16x16x32_bf16 v[244:247], a[48:51], a[164:167], v[244:247]
    v_mfma_f32_16x16x32_bf16 a[112:115], a[48:51], a[168:171], a[112:115]
    ds_read_b64_tr_b16 a[30:31], v45 offset:41984
    v_mfma_f32_16x16x32_bf16 a[112:115], a[52:55], a[184:187], a[112:115]
    buffer_load_dwordx4 a[252:255], v55, s[8:11], s62 offen sc1
    v_mfma_f32_16x16x32_bf16 a[116:119], a[52:55], a[188:191], a[116:119]
    v_mfma_f32_16x16x32_bf16 a[116:119], a[48:51], a[172:175], a[116:119]
    s_add_u32 s62, s62, 0x20000
    v_mfma_f32_16x16x32_bf16 a[124:127], a[56:59], a[172:175], a[124:127]
    s_add_u32 s52, s47, 524288
    v_mfma_f32_16x16x32_bf16 a[124:127], a[60:63], a[188:191], a[124:127]
    buffer_store_dwordx4 v[136:139], v1, s[48:51], s52 offen offset:2048 sc1
    v_mfma_f32_16x16x32_bf16 a[120:123], a[60:63], a[184:187], a[120:123]
    v_mfma_f32_16x16x32_bf16 a[120:123], a[56:59], a[168:171], a[120:123]
    v_mfma_f32_16x16x32_bf16 v[252:255], a[56:59], a[164:167], v[252:255]
    s_cmp_eq_u32 s45, 0
    s_cbranch_scc1 k12_ool_60
k12_oolret_61:
    v_mfma_f32_16x16x32_bf16 v[252:255], a[60:63], a[180:183], v[252:255]
    v_mfma_f32_16x16x32_bf16 v[248:251], a[60:63], a[176:179], v[248:251]
    v_mfma_f32_16x16x32_bf16 v[248:251], a[56:59], a[160:163], v[248:251]
    s_waitcnt vmcnt(15) lgkmcnt(0)
    v_mfma_f32_16x16x32_bf16 v[192:195], a[0:3], a[192:195], v[192:195]
    v_mfma_f32_16x16x32_bf16 v[192:195], a[4:7], a[208:211], v[192:195]
    buffer_load_dwordx4 a[128:131], v36, s[8:11], s62 offen sc1
    ds_read_b64_tr_b16 a[32:33], v46 offset:32768
    v_mfma_f32_16x16x32_bf16 v[196:199], a[4:7], a[212:215], v[196:199]
    ds_read_b64_tr_b16 a[34:35], v46 offset:33792
    v_mfma_f32_16x16x32_bf16 v[196:199], a[0:3], a[196:199], v[196:199]
    ds_read_b64_tr_b16 a[36:37], v46 offset:40960
    v_mfma_f32_16x16x32_bf16 a[64:67], a[0:3], a[200:203], a[64:67]
    ds_read_b64_tr_b16 a[38:39], v46 offset:41984
    v_mfma_f32_16x16x32_bf16 a[64:67], a[4:7], a[216:219], a[64:67]
    ds_read_b64_tr_b16 a[40:41], v47 offset:32768
    v_mfma_f32_16x16x32_bf16 a[68:71], a[4:7], a[220:223], a[68:71]
    buffer_load_dwordx4 a[132:135], v54, s[8:11], s62 offen sc1
    v_mfma_f32_16x16x32_bf16 a[68:71], a[0:3], a[204:207], a[68:71]
    ds_read_b64_tr_b16 a[42:43], v47 offset:33792
    v_mfma_f32_16x16x32_bf16 a[76:79], a[8:11], a[204:207], a[76:79]
    ds_read_b64_tr_b16 a[44:45], v47 offset:40960
    v_mfma_f32_16x16x32_bf16 a[76:79], a[12:15], a[220:223], a[76:79]
    ds_read_b64_tr_b16 a[46:47], v47 offset:41984
    v_mfma_f32_16x16x32_bf16 a[72:75], a[12:15], a[216:219], a[72:75]
    ds_read_b64_tr_b16 a[48:49], v48 offset:32768
    v_mfma_f32_16x16x32_bf16 a[72:75], a[8:11], a[200:203], a[72:75]
    buffer_load_dwordx4 a[136:139], v37, s[8:11], s62 offen sc1
    v_mfma_f32_16x16x32_bf16 v[204:207], a[8:11], a[196:199], v[204:207]
    ds_read_b64_tr_b16 a[50:51], v48 offset:33792
    v_mfma_f32_16x16x32_bf16 v[204:207], a[12:15], a[212:215], v[204:207]
    ds_read_b64_tr_b16 a[52:53], v48 offset:40960
    v_mfma_f32_16x16x32_bf16 v[200:203], a[12:15], a[208:211], v[200:203]
    ds_read_b64_tr_b16 a[54:55], v48 offset:41984
    v_mfma_f32_16x16x32_bf16 v[200:203], a[8:11], a[192:195], v[200:203]
    v_mfma_f32_16x16x32_bf16 v[208:211], a[16:19], a[192:195], v[208:211]
    ds_read_b64_tr_b16 a[56:57], v49 offset:32768
    v_mfma_f32_16x16x32_bf16 v[208:211], a[20:23], a[208:211], v[208:211]
    buffer_load_dwordx4 a[140:143], v55, s[8:11], s62 offen sc1
    ds_read_b64_tr_b16 a[58:59], v49 offset:33792
    v_mfma_f32_16x16x32_bf16 v[212:215], a[20:23], a[212:215], v[212:215]
    ds_read_b64_tr_b16 a[60:61], v49 offset:40960
    v_mfma_f32_16x16x32_bf16 v[212:215], a[16:19], a[196:199], v[212:215]
    v_mfma_f32_16x16x32_bf16 a[80:83], a[16:19], a[200:203], a[80:83]
    ds_read_b64_tr_b16 a[62:63], v49 offset:41984
    v_mfma_f32_16x16x32_bf16 a[80:83], a[20:23], a[216:219], a[80:83]
    s_add_u32 s62, s62, 0x20000
    v_mfma_f32_16x16x32_bf16 a[84:87], a[20:23], a[220:223], a[84:87]
    s_add_u32 s52, s47, 524288
    v_mfma_f32_16x16x32_bf16 a[84:87], a[16:19], a[204:207], a[84:87]
    buffer_store_dwordx4 v[140:143], v1, s[48:51], s52 offen offset:3072 sc1
    v_mfma_f32_16x16x32_bf16 a[92:95], a[24:27], a[204:207], a[92:95]
    v_mfma_f32_16x16x32_bf16 a[92:95], a[28:31], a[220:223], a[92:95]
    v_mfma_f32_16x16x32_bf16 a[88:91], a[28:31], a[216:219], a[88:91]
    v_mfma_f32_16x16x32_bf16 a[88:91], a[24:27], a[200:203], a[88:91]
    v_mfma_f32_16x16x32_bf16 v[220:223], a[24:27], a[196:199], v[220:223]
    v_mfma_f32_16x16x32_bf16 v[220:223], a[28:31], a[212:215], v[220:223]
    v_mfma_f32_16x16x32_bf16 v[216:219], a[28:31], a[208:211], v[216:219]
    v_mfma_f32_16x16x32_bf16 v[216:219], a[24:27], a[192:195], v[216:219]
    s_waitcnt vmcnt(10) lgkmcnt(0)
    s_barrier
    v_mfma_f32_16x16x32_bf16 v[224:227], a[32:35], a[192:195], v[224:227]
    v_mfma_f32_16x16x32_bf16 v[224:227], a[36:39], a[208:211], v[224:227]
    s_add_u32 m0, s60, 98304
    ds_read_b64_tr_b16 a[0:1], v42 offset:49152
    ds_read_b64_tr_b16 a[2:3], v42 offset:50176
    v_mfma_f32_16x16x32_bf16 v[228:231], a[36:39], a[212:215], v[228:231]
    buffer_load_dwordx4 v38, s[12:15], s61 offen offset:0 lds
    v_mfma_f32_16x16x32_bf16 v[228:231], a[32:35], a[196:199], v[228:231]
    ds_read_b64_tr_b16 a[4:5], v42 offset:57344
    v_mfma_f32_16x16x32_bf16 a[96:99], a[32:35], a[200:203], a[96:99]
    buffer_load_dwordx4 v39, s[12:15], s61 offen offset:1024 lds
    ds_read_b64_tr_b16 a[6:7], v42 offset:58368
    v_mfma_f32_16x16x32_bf16 a[96:99], a[36:39], a[216:219], a[96:99]
    ds_read_b64_tr_b16 a[8:9], v43 offset:49152
    v_mfma_f32_16x16x32_bf16 a[100:103], a[36:39], a[220:223], a[100:103]
    v_mfma_f32_16x16x32_bf16 a[100:103], a[32:35], a[204:207], a[100:103]
    buffer_load_dwordx4 v40, s[12:15], s61 offen offset:2048 lds
    ds_read_b64_tr_b16 a[10:11], v43 offset:50176
    v_mfma_f32_16x16x32_bf16 a[108:111], a[40:43], a[204:207], a[108:111]
    ds_read_b64_tr_b16 a[12:13], v43 offset:57344
    v_mfma_f32_16x16x32_bf16 a[108:111], a[44:47], a[220:223], a[108:111]
    ds_read_b64_tr_b16 a[14:15], v43 offset:58368
    v_mfma_f32_16x16x32_bf16 a[104:107], a[44:47], a[216:219], a[104:107]
    ds_read_b64_tr_b16 a[16:17], v44 offset:49152
    v_mfma_f32_16x16x32_bf16 a[104:107], a[40:43], a[200:203], a[104:107]
    buffer_load_dwordx4 v41, s[12:15], s61 offen offset:3072 lds
    v_mfma_f32_16x16x32_bf16 v[236:239], a[40:43], a[196:199], v[236:239]
    ds_read_b64_tr_b16 a[18:19], v44 offset:50176
    v_mfma_f32_16x16x32_bf16 v[236:239], a[44:47], a[212:215], v[236:239]
    s_add_u32 s61, s61, 0x80000
    ds_read_b64_tr_b16 a[20:21], v44 offset:57344
    v_mfma_f32_16x16x32_bf16 v[232:235], a[44:47], a[208:211], v[232:235]
    buffer_load_dwordx4 a[144:147], v36, s[8:11], s62 offen sc1
    ds_read_b64_tr_b16 a[22:23], v44 offset:58368
    v_mfma_f32_16x16x32_bf16 v[232:235], a[40:43], a[192:195], v[232:235]
    v_mfma_f32_16x16x32_bf16 v[240:243], a[48:51], a[192:195], v[240:243]
    ds_read_b64_tr_b16 a[24:25], v45 offset:49152
    v_mfma_f32_16x16x32_bf16 v[240:243], a[52:55], a[208:211], v[240:243]
    buffer_load_dwordx4 a[148:151], v54, s[8:11], s62 offen sc1
    ds_read_b64_tr_b16 a[26:27], v45 offset:50176
    v_mfma_f32_16x16x32_bf16 v[244:247], a[52:55], a[212:215], v[244:247]
    ds_read_b64_tr_b16 a[28:29], v45 offset:57344
    v_mfma_f32_16x16x32_bf16 v[244:247], a[48:51], a[196:199], v[244:247]
    v_mfma_f32_16x16x32_bf16 a[112:115], a[48:51], a[200:203], a[112:115]
    buffer_load_dwordx4 a[152:155], v37, s[8:11], s62 offen sc1
    ds_read_b64_tr_b16 a[30:31], v45 offset:58368
    v_mfma_f32_16x16x32_bf16 a[112:115], a[52:55], a[216:219], a[112:115]
    v_mfma_f32_16x16x32_bf16 a[116:119], a[52:55], a[220:223], a[116:119]
    v_mfma_f32_16x16x32_bf16 a[116:119], a[48:51], a[204:207], a[116:119]
    v_mfma_f32_16x16x32_bf16 a[124:127], a[56:59], a[204:207], a[124:127]
    buffer_load_dwordx4 a[156:159], v55, s[8:11], s62 offen sc1
    v_mfma_f32_16x16x32_bf16 a[124:127], a[60:63], a[220:223], a[124:127]
    v_mfma_f32_16x16x32_bf16 a[120:123], a[60:63], a[216:219], a[120:123]
    s_add_u32 s62, s62, 0x20000
    v_mfma_f32_16x16x32_bf16 a[120:123], a[56:59], a[200:203], a[120:123]
    v_mfma_f32_16x16x32_bf16 v[252:255], a[56:59], a[196:199], v[252:255]
    s_cmp_eq_u32 s45, 0
    s_cbranch_scc1 k12_ool_62
k12_oolret_63:
    v_mfma_f32_16x16x32_bf16 v[252:255], a[60:63], a[212:215], v[252:255]
    v_mfma_f32_16x16x32_bf16 v[248:251], a[60:63], a[208:211], v[248:251]
    v_mfma_f32_16x16x32_bf16 v[248:251], a[56:59], a[192:195], v[248:251]
    s_waitcnt vmcnt(14) lgkmcnt(0)
    v_mfma_f32_16x16x32_bf16 v[192:195], a[0:3], a[224:227], v[192:195]
    v_mfma_f32_16x16x32_bf16 v[192:195], a[4:7], a[240:243], v[192:195]
    buffer_load_dwordx4 a[160:163], v36, s[8:11], s62 offen sc1
    ds_read_b64_tr_b16 a[32:33], v46 offset:49152
    v_mfma_f32_16x16x32_bf16 v[196:199], a[4:7], a[244:247], v[196:199]
    ds_read_b64_tr_b16 a[34:35], v46 offset:50176
    v_mfma_f32_16x16x32_bf16 v[196:199], a[0:3], a[228:231], v[196:199]
    ds_read_b64_tr_b16 a[36:37], v46 offset:57344
    v_mfma_f32_16x16x32_bf16 a[64:67], a[0:3], a[232:235], a[64:67]
    ds_read_b64_tr_b16 a[38:39], v46 offset:58368
    v_mfma_f32_16x16x32_bf16 a[64:67], a[4:7], a[248:251], a[64:67]
    ds_read_b64_tr_b16 a[40:41], v47 offset:49152
    v_mfma_f32_16x16x32_bf16 a[68:71], a[4:7], a[252:255], a[68:71]
    buffer_load_dwordx4 a[164:167], v54, s[8:11], s62 offen sc1
    v_mfma_f32_16x16x32_bf16 a[68:71], a[0:3], a[236:239], a[68:71]
    ds_read_b64_tr_b16 a[42:43], v47 offset:50176
    v_mfma_f32_16x16x32_bf16 a[76:79], a[8:11], a[236:239], a[76:79]
    ds_read_b64_tr_b16 a[44:45], v47 offset:57344
    v_mfma_f32_16x16x32_bf16 a[76:79], a[12:15], a[252:255], a[76:79]
    ds_read_b64_tr_b16 a[46:47], v47 offset:58368
    v_mfma_f32_16x16x32_bf16 a[72:75], a[12:15], a[248:251], a[72:75]
    ds_read_b64_tr_b16 a[48:49], v48 offset:49152
    v_mfma_f32_16x16x32_bf16 a[72:75], a[8:11], a[232:235], a[72:75]
    buffer_load_dwordx4 a[168:171], v37, s[8:11], s62 offen sc1
    v_mfma_f32_16x16x32_bf16 v[204:207], a[8:11], a[228:231], v[204:207]
    ds_read_b64_tr_b16 a[50:51], v48 offset:50176
    v_mfma_f32_16x16x32_bf16 v[204:207], a[12:15], a[244:247], v[204:207]
    ds_read_b64_tr_b16 a[52:53], v48 offset:57344
    v_mfma_f32_16x16x32_bf16 v[200:203], a[12:15], a[240:243], v[200:203]
    ds_read_b64_tr_b16 a[54:55], v48 offset:58368
    v_mfma_f32_16x16x32_bf16 v[200:203], a[8:11], a[224:227], v[200:203]
    v_mfma_f32_16x16x32_bf16 v[208:211], a[16:19], a[224:227], v[208:211]
    ds_read_b64_tr_b16 a[56:57], v49 offset:49152
    v_mfma_f32_16x16x32_bf16 v[208:211], a[20:23], a[240:243], v[208:211]
    buffer_load_dwordx4 a[172:175], v55, s[8:11], s62 offen sc1
    ds_read_b64_tr_b16 a[58:59], v49 offset:50176
    v_mfma_f32_16x16x32_bf16 v[212:215], a[20:23], a[244:247], v[212:215]
    ds_read_b64_tr_b16 a[60:61], v49 offset:57344
    v_mfma_f32_16x16x32_bf16 v[212:215], a[16:19], a[228:231], v[212:215]
    v_mfma_f32_16x16x32_bf16 a[80:83], a[16:19], a[232:235], a[80:83]
    ds_read_b64_tr_b16 a[62:63], v49 offset:58368
    v_mfma_f32_16x16x32_bf16 a[80:83], a[20:23], a[248:251], a[80:83]
    s_add_u32 s62, s62, 0x20000
    v_mfma_f32_16x16x32_bf16 a[84:87], a[20:23], a[252:255], a[84:87]
    s_add_u32 s52, s47, 528384
    v_mfma_f32_16x16x32_bf16 a[84:87], a[16:19], a[236:239], a[84:87]
    buffer_store_dwordx4 v[144:147], v1, s[48:51], s52 offen offset:0 sc1
    v_mfma_f32_16x16x32_bf16 a[92:95], a[24:27], a[236:239], a[92:95]
    v_mfma_f32_16x16x32_bf16 a[92:95], a[28:31], a[252:255], a[92:95]
    v_mfma_f32_16x16x32_bf16 a[88:91], a[28:31], a[248:251], a[88:91]
    v_mfma_f32_16x16x32_bf16 a[88:91], a[24:27], a[232:235], a[88:91]
    v_mfma_f32_16x16x32_bf16 v[220:223], a[24:27], a[228:231], v[220:223]
    v_mfma_f32_16x16x32_bf16 v[220:223], a[28:31], a[244:247], v[220:223]
    v_mfma_f32_16x16x32_bf16 v[216:219], a[28:31], a[240:243], v[216:219]
    v_mfma_f32_16x16x32_bf16 v[216:219], a[24:27], a[224:227], v[216:219]
    s_waitcnt vmcnt(9) lgkmcnt(0)
    s_barrier
    v_mfma_f32_16x16x32_bf16 v[224:227], a[32:35], a[224:227], v[224:227]
    v_mfma_f32_16x16x32_bf16 v[224:227], a[36:39], a[240:243], v[224:227]
    s_add_u32 m0, s60, 114688
    ds_read_b64_tr_b16 a[0:1], v42 offset:0
    ds_read_b64_tr_b16 a[2:3], v42 offset:1024
    v_mfma_f32_16x16x32_bf16 v[228:231], a[36:39], a[244:247], v[228:231]
    buffer_load_dwordx4 v38, s[12:15], s61 offen offset:0 lds
    v_mfma_f32_16x16x32_bf16 v[228:231], a[32:35], a[228:231], v[228:231]
    ds_read_b64_tr_b16 a[4:5], v42 offset:8192
    v_mfma_f32_16x16x32_bf16 a[96:99], a[32:35], a[232:235], a[96:99]
    buffer_load_dwordx4 v39, s[12:15], s61 offen offset:1024 lds
    ds_read_b64_tr_b16 a[6:7], v42 offset:9216
    v_mfma_f32_16x16x32_bf16 a[96:99], a[36:39], a[248:251], a[96:99]
    ds_read_b64_tr_b16 a[8:9], v43 offset:0
    v_mfma_f32_16x16x32_bf16 a[100:103], a[36:39], a[252:255], a[100:103]
    v_mfma_f32_16x16x32_bf16 a[100:103], a[32:35], a[236:239], a[100:103]
    buffer_load_dwordx4 v40, s[12:15], s61 offen offset:2048 lds
    ds_read_b64_tr_b16 a[10:11], v43 offset:1024
    v_mfma_f32_16x16x32_bf16 a[108:111], a[40:43], a[236:239], a[108:111]
    ds_read_b64_tr_b16 a[12:13], v43 offset:8192
    v_mfma_f32_16x16x32_bf16 a[108:111], a[44:47], a[252:255], a[108:111]
    ds_read_b64_tr_b16 a[14:15], v43 offset:9216
    v_mfma_f32_16x16x32_bf16 a[104:107], a[44:47], a[248:251], a[104:107]
    buffer_load_dwordx4 v41, s[12:15], s61 offen offset:3072 lds
    ds_read_b64_tr_b16 a[16:17], v44 offset:0
    v_mfma_f32_16x16x32_bf16 a[104:107], a[40:43], a[232:235], a[104:107]
    v_mfma_f32_16x16x32_bf16 v[236:239], a[40:43], a[228:231], v[236:239]
    s_add_u32 s61, s61, 0x80000
    ds_read_b64_tr_b16 a[18:19], v44 offset:1024
    v_mfma_f32_16x16x32_bf16 v[236:239], a[44:47], a[244:247], v[236:239]
    buffer_load_dwordx4 a[176:179], v36, s[8:11], s62 offen sc1
    ds_read_b64_tr_b16 a[20:21], v44 offset:8192
    v_mfma_f32_16x16x32_bf16 v[232:235], a[44:47], a[240:243], v[232:235]
    ds_read_b64_tr_b16 a[22:23], v44 offset:9216
    v_mfma_f32_16x16x32_bf16 v[232:235], a[40:43], a[224:227], v[232:235]
    buffer_load_dwordx4 a[180:183], v54, s[8:11], s62 offen sc1
    v_mfma_f32_16x16x32_bf16 v[240:243], a[48:51], a[224:227], v[240:243]
    ds_read_b64_tr_b16 a[24:25], v45 offset:0
    v_mfma_f32_16x16x32_bf16 v[240:243], a[52:55], a[240:243], v[240:243]
    ds_read_b64_tr_b16 a[26:27], v45 offset:1024
    v_mfma_f32_16x16x32_bf16 v[244:247], a[52:55], a[244:247], v[244:247]
    buffer_load_dwordx4 a[184:187], v37, s[8:11], s62 offen sc1
    ds_read_b64_tr_b16 a[28:29], v45 offset:8192
    v_mfma_f32_16x16x32_bf16 v[244:247], a[48:51], a[228:231], v[244:247]
    v_mfma_f32_16x16x32_bf16 a[112:115], a[48:51], a[232:235], a[112:115]
    ds_read_b64_tr_b16 a[30:31], v45 offset:9216
    v_mfma_f32_16x16x32_bf16 a[112:115], a[52:55], a[248:251], a[112:115]
    buffer_load_dwordx4 a[188:191], v55, s[8:11], s62 offen sc1
    v_mfma_f32_16x16x32_bf16 a[116:119], a[52:55], a[252:255], a[116:119]
    v_mfma_f32_16x16x32_bf16 a[116:119], a[48:51], a[236:239], a[116:119]
    s_add_u32 s62, s62, 0x20000
    v_mfma_f32_16x16x32_bf16 a[124:127], a[56:59], a[236:239], a[124:127]
    s_add_u32 s52, s47, 528384
    v_mfma_f32_16x16x32_bf16 a[124:127], a[60:63], a[252:255], a[124:127]
    buffer_store_dwordx4 v[148:151], v1, s[48:51], s52 offen offset:1024 sc1
    v_mfma_f32_16x16x32_bf16 a[120:123], a[60:63], a[248:251], a[120:123]
    v_mfma_f32_16x16x32_bf16 a[120:123], a[56:59], a[232:235], a[120:123]
    v_mfma_f32_16x16x32_bf16 v[252:255], a[56:59], a[228:231], v[252:255]
    s_cmp_eq_u32 s45, 0
    s_cbranch_scc1 k12_ool_64
k12_oolret_65:
    v_mfma_f32_16x16x32_bf16 v[252:255], a[60:63], a[244:247], v[252:255]
    v_mfma_f32_16x16x32_bf16 v[248:251], a[60:63], a[240:243], v[248:251]
    v_mfma_f32_16x16x32_bf16 v[248:251], a[56:59], a[224:227], v[248:251]
    s_waitcnt vmcnt(14) lgkmcnt(0)
    v_mfma_f32_16x16x32_bf16 v[192:195], a[0:3], a[128:131], v[192:195]
    v_mfma_f32_16x16x32_bf16 v[192:195], a[4:7], a[144:147], v[192:195]
    buffer_load_dwordx4 a[192:195], v36, s[8:11], s62 offen sc1
    ds_read_b64_tr_b16 a[32:33], v46 offset:0
    v_mfma_f32_16x16x32_bf16 v[196:199], a[4:7], a[148:151], v[196:199]
    ds_read_b64_tr_b16 a[34:35], v46 offset:1024
    v_mfma_f32_16x16x32_bf16 v[196:199], a[0:3], a[132:135], v[196:199]
    ds_read_b64_tr_b16 a[36:37], v46 offset:8192
    v_mfma_f32_16x16x32_bf16 a[64:67], a[0:3], a[136:139], a[64:67]
    ds_read_b64_tr_b16 a[38:39], v46 offset:9216
    v_mfma_f32_16x16x32_bf16 a[64:67], a[4:7], a[152:155], a[64:67]
    ds_read_b64_tr_b16 a[40:41], v47 offset:0
    v_mfma_f32_16x16x32_bf16 a[68:71], a[4:7], a[156:159], a[68:71]
    buffer_load_dwordx4 a[196:199], v54, s[8:11], s62 offen sc1
    v_mfma_f32_16x16x32_bf16 a[68:71], a[0:3], a[140:143], a[68:71]
    ds_read_b64_tr_b16 a[42:43], v47 offset:1024
    v_mfma_f32_16x16x32_bf16 a[76:79], a[8:11], a[140:143], a[76:79]
    ds_read_b64_tr_b16 a[44:45], v47 offset:8192
    v_mfma_f32_16x16x32_bf16 a[76:79], a[12:15], a[156:159], a[76:79]
    ds_read_b64_tr_b16 a[46:47], v47 offset:9216
    v_mfma_f32_16x16x32_bf16 a[72:75], a[12:15], a[152:155], a[72:75]
    ds_read_b64_tr_b16 a[48:49], v48 offset:0
    v_mfma_f32_16x16x32_bf16 a[72:75], a[8:11], a[136:139], a[72:75]
    buffer_load_dwordx4 a[200:203], v37, s[8:11], s62 offen sc1
    v_mfma_f32_16x16x32_bf16 v[204:207], a[8:11], a[132:135], v[204:207]
    ds_read_b64_tr_b16 a[50:51], v48 offset:1024
    v_mfma_f32_16x16x32_bf16 v[204:207], a[12:15], a[148:151], v[204:207]
    ds_read_b64_tr_b16 a[52:53], v48 offset:8192
    v_mfma_f32_16x16x32_bf16 v[200:203], a[12:15], a[144:147], v[200:203]
    ds_read_b64_tr_b16 a[54:55], v48 offset:9216
    v_mfma_f32_16x16x32_bf16 v[200:203], a[8:11], a[128:131], v[200:203]
    v_mfma_f32_16x16x32_bf16 v[208:211], a[16:19], a[128:131], v[208:211]
    ds_read_b64_tr_b16 a[56:57], v49 offset:0
    v_mfma_f32_16x16x32_bf16 v[208:211], a[20:23], a[144:147], v[208:211]
    buffer_load_dwordx4 a[204:207], v55, s[8:11], s62 offen sc1
    ds_read_b64_tr_b16 a[58:59], v49 offset:1024
    v_mfma_f32_16x16x32_bf16 v[212:215], a[20:23], a[148:151], v[212:215]
    ds_read_b64_tr_b16 a[60:61], v49 offset:8192
    v_mfma_f32_16x16x32_bf16 v[212:215], a[16:19], a[132:135], v[212:215]
    v_mfma_f32_16x16x32_bf16 a[80:83], a[16:19], a[136:139], a[80:83]
    ds_read_b64_tr_b16 a[62:63], v49 offset:9216
    v_mfma_f32_16x16x32_bf16 a[80:83], a[20:23], a[152:155], a[80:83]
    s_add_u32 s62, s62, 0x20000
    v_mfma_f32_16x16x32_bf16 a[84:87], a[20:23], a[156:159], a[84:87]
    s_add_u32 s52, s47, 528384
    v_mfma_f32_16x16x32_bf16 a[84:87], a[16:19], a[140:143], a[84:87]
    buffer_store_dwordx4 v[152:155], v1, s[48:51], s52 offen offset:2048 sc1
    v_mfma_f32_16x16x32_bf16 a[92:95], a[24:27], a[140:143], a[92:95]
    v_mfma_f32_16x16x32_bf16 a[92:95], a[28:31], a[156:159], a[92:95]
    v_mfma_f32_16x16x32_bf16 a[88:91], a[28:31], a[152:155], a[88:91]
    v_mfma_f32_16x16x32_bf16 a[88:91], a[24:27], a[136:139], a[88:91]
    v_mfma_f32_16x16x32_bf16 v[220:223], a[24:27], a[132:135], v[220:223]
    v_mfma_f32_16x16x32_bf16 v[220:223], a[28:31], a[148:151], v[220:223]
    v_mfma_f32_16x16x32_bf16 v[216:219], a[28:31], a[144:147], v[216:219]
    v_mfma_f32_16x16x32_bf16 v[216:219], a[24:27], a[128:131], v[216:219]
    s_waitcnt vmcnt(10) lgkmcnt(0)
    s_barrier
    v_mfma_f32_16x16x32_bf16 v[224:227], a[32:35], a[128:131], v[224:227]
    v_mfma_f32_16x16x32_bf16 v[224:227], a[36:39], a[144:147], v[224:227]
    s_add_u32 m0, s60, 131072
    ds_read_b64_tr_b16 a[0:1], v42 offset:16384
    ds_read_b64_tr_b16 a[2:3], v42 offset:17408
    v_mfma_f32_16x16x32_bf16 v[228:231], a[36:39], a[148:151], v[228:231]
    buffer_load_dwordx4 v38, s[12:15], s61 offen offset:0 lds
    v_mfma_f32_16x16x32_bf16 v[228:231], a[32:35], a[132:135], v[228:231]
    ds_read_b64_tr_b16 a[4:5], v42 offset:24576
    v_mfma_f32_16x16x32_bf16 a[96:99], a[32:35], a[136:139], a[96:99]
    buffer_load_dwordx4 v39, s[12:15], s61 offen offset:1024 lds
    ds_read_b64_tr_b16 a[6:7], v42 offset:25600
    v_mfma_f32_16x16x32_bf16 a[96:99], a[36:39], a[152:155], a[96:99]
    ds_read_b64_tr_b16 a[8:9], v43 offset:16384
    v_mfma_f32_16x16x32_bf16 a[100:103], a[36:39], a[156:159], a[100:103]
    v_mfma_f32_16x16x32_bf16 a[100:103], a[32:35], a[140:143], a[100:103]
    buffer_load_dwordx4 v40, s[12:15], s61 offen offset:2048 lds
    ds_read_b64_tr_b16 a[10:11], v43 offset:17408
    v_mfma_f32_16x16x32_bf16 a[108:111], a[40:43], a[140:143], a[108:111]
    ds_read_b64_tr_b16 a[12:13], v43 offset:24576
    v_mfma_f32_16x16x32_bf16 a[108:111], a[44:47], a[156:159], a[108:111]
    ds_read_b64_tr_b16 a[14:15], v43 offset:25600
    v_mfma_f32_16x16x32_bf16 a[104:107], a[44:47], a[152:155], a[104:107]
    buffer_load_dwordx4 v41, s[12:15], s61 offen offset:3072 lds
    ds_read_b64_tr_b16 a[16:17], v44 offset:16384
    v_mfma_f32_16x16x32_bf16 a[104:107], a[40:43], a[136:139], a[104:107]
    v_mfma_f32_16x16x32_bf16 v[236:239], a[40:43], a[132:135], v[236:239]
    s_add_u32 s61, s61, 0x80000
    ds_read_b64_tr_b16 a[18:19], v44 offset:17408
    v_mfma_f32_16x16x32_bf16 v[236:239], a[44:47], a[148:151], v[236:239]
    buffer_load_dwordx4 a[208:211], v36, s[8:11], s62 offen sc1
    ds_read_b64_tr_b16 a[20:21], v44 offset:24576
    v_mfma_f32_16x16x32_bf16 v[232:235], a[44:47], a[144:147], v[232:235]
    ds_read_b64_tr_b16 a[22:23], v44 offset:25600
    v_mfma_f32_16x16x32_bf16 v[232:235], a[40:43], a[128:131], v[232:235]
    buffer_load_dwordx4 a[212:215], v54, s[8:11], s62 offen sc1
    v_mfma_f32_16x16x32_bf16 v[240:243], a[48:51], a[128:131], v[240:243]
    ds_read_b64_tr_b16 a[24:25], v45 offset:16384
    v_mfma_f32_16x16x32_bf16 v[240:243], a[52:55], a[144:147], v[240:243]
    ds_read_b64_tr_b16 a[26:27], v45 offset:17408
    v_mfma_f32_16x16x32_bf16 v[244:247], a[52:55], a[148:151], v[244:247]
    buffer_load_dwordx4 a[216:219], v37, s[8:11], s62 offen sc1
    ds_read_b64_tr_b16 a[28:29], v45 offset:24576
    v_mfma_f32_16x16x32_bf16 v[244:247], a[48:51], a[132:135], v[244:247]
    v_mfma_f32_16x16x32_bf16 a[112:115], a[48:51], a[136:139], a[112:115]
    ds_read_b64_tr_b16 a[30:31], v45 offset:25600
    v_mfma_f32_16x16x32_bf16 a[112:115], a[52:55], a[152:155], a[112:115]
    buffer_load_dwordx4 a[220:223], v55, s[8:11], s62 offen sc1
    v_mfma_f32_16x16x32_bf16 a[116:119], a[52:55], a[156:159], a[116:119]
    v_mfma_f32_16x16x32_bf16 a[116:119], a[48:51], a[140:143], a[116:119]
    s_add_u32 s62, s62, 0x20000
    v_mfma_f32_16x16x32_bf16 a[124:127], a[56:59], a[140:143], a[124:127]
    s_add_u32 s52, s47, 528384
    v_mfma_f32_16x16x32_bf16 a[124:127], a[60:63], a[156:159], a[124:127]
    buffer_store_dwordx4 v[156:159], v1, s[48:51], s52 offen offset:3072 sc1
    v_mfma_f32_16x16x32_bf16 a[120:123], a[60:63], a[152:155], a[120:123]
    v_mfma_f32_16x16x32_bf16 a[120:123], a[56:59], a[136:139], a[120:123]
    v_mfma_f32_16x16x32_bf16 v[252:255], a[56:59], a[132:135], v[252:255]
    v_mfma_f32_16x16x32_bf16 v[252:255], a[60:63], a[148:151], v[252:255]
    v_mfma_f32_16x16x32_bf16 v[248:251], a[60:63], a[144:147], v[248:251]
    v_mfma_f32_16x16x32_bf16 v[248:251], a[56:59], a[128:131], v[248:251]
    s_waitcnt vmcnt(15) lgkmcnt(0)
    v_mfma_f32_16x16x32_bf16 v[192:195], a[0:3], a[160:163], v[192:195]
    v_mfma_f32_16x16x32_bf16 v[192:195], a[4:7], a[176:179], v[192:195]
    buffer_load_dwordx4 a[224:227], v36, s[8:11], s62 offen sc1
    ds_read_b64_tr_b16 a[32:33], v46 offset:16384
    v_mfma_f32_16x16x32_bf16 v[196:199], a[4:7], a[180:183], v[196:199]
    ds_read_b64_tr_b16 a[34:35], v46 offset:17408
    v_mfma_f32_16x16x32_bf16 v[196:199], a[0:3], a[164:167], v[196:199]
    ds_read_b64_tr_b16 a[36:37], v46 offset:24576
    v_mfma_f32_16x16x32_bf16 a[64:67], a[0:3], a[168:171], a[64:67]
    ds_read_b64_tr_b16 a[38:39], v46 offset:25600
    v_mfma_f32_16x16x32_bf16 a[64:67], a[4:7], a[184:187], a[64:67]
    ds_read_b64_tr_b16 a[40:41], v47 offset:16384
    v_mfma_f32_16x16x32_bf16 a[68:71], a[4:7], a[188:191], a[68:71]
    buffer_load_dwordx4 a[228:231], v54, s[8:11], s62 offen sc1
    v_mfma_f32_16x16x32_bf16 a[68:71], a[0:3], a[172:175], a[68:71]
    ds_read_b64_tr_b16 a[42:43], v47 offset:17408
    v_mfma_f32_16x16x32_bf16 a[76:79], a[8:11], a[172:175], a[76:79]
    ds_read_b64_tr_b16 a[44:45], v47 offset:24576
    v_mfma_f32_16x16x32_bf16 a[76:79], a[12:15], a[188:191], a[76:79]
    ds_read_b64_tr_b16 a[46:47], v47 offset:25600
    v_mfma_f32_16x16x32_bf16 a[72:75], a[12:15], a[184:187], a[72:75]
    ds_read_b64_tr_b16 a[48:49], v48 offset:16384
    v_mfma_f32_16x16x32_bf16 a[72:75], a[8:11], a[168:171], a[72:75]
    buffer_load_dwordx4 a[232:235], v37, s[8:11], s62 offen sc1
    v_mfma_f32_16x16x32_bf16 v[204:207], a[8:11], a[164:167], v[204:207]
    ds_read_b64_tr_b16 a[50:51], v48 offset:17408
    v_mfma_f32_16x16x32_bf16 v[204:207], a[12:15], a[180:183], v[204:207]
    ds_read_b64_tr_b16 a[52:53], v48 offset:24576
    v_mfma_f32_16x16x32_bf16 v[200:203], a[12:15], a[176:179], v[200:203]
    ds_read_b64_tr_b16 a[54:55], v48 offset:25600
    v_mfma_f32_16x16x32_bf16 v[200:203], a[8:11], a[160:163], v[200:203]
    v_mfma_f32_16x16x32_bf16 v[208:211], a[16:19], a[160:163], v[208:211]
    ds_read_b64_tr_b16 a[56:57], v49 offset:16384
    v_mfma_f32_16x16x32_bf16 v[208:211], a[20:23], a[176:179], v[208:211]
    buffer_load_dwordx4 a[236:239], v55, s[8:11], s62 offen sc1
    ds_read_b64_tr_b16 a[58:59], v49 offset:17408
    v_mfma_f32_16x16x32_bf16 v[212:215], a[20:23], a[180:183], v[212:215]
    ds_read_b64_tr_b16 a[60:61], v49 offset:24576
    v_mfma_f32_16x16x32_bf16 v[212:215], a[16:19], a[164:167], v[212:215]
    v_mfma_f32_16x16x32_bf16 a[80:83], a[16:19], a[168:171], a[80:83]
    ds_read_b64_tr_b16 a[62:63], v49 offset:25600
    v_mfma_f32_16x16x32_bf16 a[80:83], a[20:23], a[184:187], a[80:83]
    s_add_u32 s62, s62, 0x20000
    v_mfma_f32_16x16x32_bf16 a[84:87], a[20:23], a[188:191], a[84:87]
    s_add_u32 s52, s47, 532480
    v_mfma_f32_16x16x32_bf16 a[84:87], a[16:19], a[172:175], a[84:87]
    buffer_store_dwordx4 v[168:171], v1, s[48:51], s52 offen offset:2048 sc1
    v_mfma_f32_16x16x32_bf16 a[92:95], a[24:27], a[172:175], a[92:95]
    v_mfma_f32_16x16x32_bf16 a[92:95], a[28:31], a[188:191], a[92:95]
    v_mfma_f32_16x16x32_bf16 a[88:91], a[28:31], a[184:187], a[88:91]
    v_mfma_f32_16x16x32_bf16 a[88:91], a[24:27], a[168:171], a[88:91]
    v_mfma_f32_16x16x32_bf16 v[220:223], a[24:27], a[164:167], v[220:223]
    v_mfma_f32_16x16x32_bf16 v[220:223], a[28:31], a[180:183], v[220:223]
    v_mfma_f32_16x16x32_bf16 v[216:219], a[28:31], a[176:179], v[216:219]
    v_mfma_f32_16x16x32_bf16 v[216:219], a[24:27], a[160:163], v[216:219]
    s_waitcnt vmcnt(10) lgkmcnt(0)
    s_barrier
    v_mfma_f32_16x16x32_bf16 v[224:227], a[32:35], a[160:163], v[224:227]
    s_cmp_eq_u32 s56, 0
    s_cbranch_scc1 k12_ool_66
k12_oolret_67:
    v_mfma_f32_16x16x32_bf16 v[224:227], a[36:39], a[176:179], v[224:227]
    s_add_u32 m0, s60, 147456
    ds_read_b64_tr_b16 a[0:1], v42 offset:32768
    ds_read_b64_tr_b16 a[2:3], v42 offset:33792
    v_mfma_f32_16x16x32_bf16 v[228:231], a[36:39], a[180:183], v[228:231]
    buffer_load_dwordx4 v38, s[12:15], s61 offen offset:0 lds
    v_mfma_f32_16x16x32_bf16 v[228:231], a[32:35], a[164:167], v[228:231]
    ds_read_b64_tr_b16 a[4:5], v42 offset:40960
    v_mfma_f32_16x16x32_bf16 a[96:99], a[32:35], a[168:171], a[96:99]
    buffer_load_dwordx4 v39, s[12:15], s61 offen offset:1024 lds
    ds_read_b64_tr_b16 a[6:7], v42 offset:41984
    v_mfma_f32_16x16x32_bf16 a[96:99], a[36:39], a[184:187], a[96:99]
    ds_read_b64_tr_b16 a[8:9], v43 offset:32768
    v_mfma_f32_16x16x32_bf16 a[100:103], a[36:39], a[188:191], a[100:103]
    v_mfma_f32_16x16x32_bf16 a[100:103], a[32:35], a[172:175], a[100:103]
    buffer_load_dwordx4 v40, s[12:15], s61 offen offset:2048 lds
    ds_read_b64_tr_b16 a[10:11], v43 offset:33792
    v_mfma_f32_16x16x32_bf16 a[108:111], a[40:43], a[172:175], a[108:111]
    s_mov_b32 s32, s60
    ds_read_b64_tr_b16 a[12:13], v43 offset:40960
    v_mfma_f32_16x16x32_bf16 a[108:111], a[44:47], a[188:191], a[108:111]
    ds_read_b64_tr_b16 a[14:15], v43 offset:41984
    v_mfma_f32_16x16x32_bf16 a[104:107], a[44:47], a[184:187], a[104:107]
    s_mov_b32 s34, s60
    ds_read_b64_tr_b16 a[16:17], v44 offset:32768
    v_mfma_f32_16x16x32_bf16 a[104:107], a[40:43], a[168:171], a[104:107]
    buffer_load_dwordx4 v41, s[12:15], s61 offen offset:3072 lds
    v_mfma_f32_16x16x32_bf16 v[236:239], a[40:43], a[164:167], v[236:239]
    ds_read_b64_tr_b16 a[18:19], v44 offset:33792
    v_mfma_f32_16x16x32_bf16 v[236:239], a[44:47], a[180:183], v[236:239]
    s_mov_b32 s33, s60
    ds_read_b64_tr_b16 a[20:21], v44 offset:40960
    v_mfma_f32_16x16x32_bf16 v[232:235], a[44:47], a[176:179], v[232:235]
    s_add_u32 s61, s61, 0x80000
    buffer_load_dwordx4 a[240:243], v36, s[8:11], s62 offen sc1
    ds_read_b64_tr_b16 a[22:23], v44 offset:41984
    v_mfma_f32_16x16x32_bf16 v[232:235], a[40:43], a[160:163], v[232:235]
    v_mfma_f32_16x16x32_bf16 v[240:243], a[48:51], a[160:163], v[240:243]
    s_add_u32 s35, s60, 0x10000
    ds_read_b64_tr_b16 a[24:25], v45 offset:32768
    v_mfma_f32_16x16x32_bf16 v[240:243], a[52:55], a[176:179], v[240:243]
    buffer_load_dwordx4 a[244:247], v54, s[8:11], s62 offen sc1
    ds_read_b64_tr_b16 a[26:27], v45 offset:33792
    v_mfma_f32_16x16x32_bf16 v[244:247], a[52:55], a[180:183], v[244:247]
    ds_read_b64_tr_b16 a[28:29], v45 offset:40960
    v_mfma_f32_16x16x32_bf16 v[244:247], a[48:51], a[164:167], v[244:247]
    v_mfma_f32_16x16x32_bf16 a[112:115], a[48:51], a[168:171], a[112:115]
    buffer_load_dwordx4 a[248:251], v37, s[8:11], s62 offen sc1
    ds_read_b64_tr_b16 a[30:31], v45 offset:41984
    v_mfma_f32_16x16x32_bf16 a[112:115], a[52:55], a[184:187], a[112:115]
    v_mfma_f32_16x16x32_bf16 a[116:119], a[52:55], a[188:191], a[116:119]
    v_mfma_f32_16x16x32_bf16 a[116:119], a[48:51], a[172:175], a[116:119]
    v_mfma_f32_16x16x32_bf16 a[124:127], a[56:59], a[172:175], a[124:127]
    buffer_load_dwordx4 a[252:255], v55, s[8:11], s62 offen sc1
    v_mfma_f32_16x16x32_bf16 a[124:127], a[60:63], a[188:191], a[124:127]
    v_mfma_f32_16x16x32_bf16 a[120:123], a[60:63], a[184:187], a[120:123]
    s_add_u32 s62, s62, 0x20000
    v_mfma_f32_16x16x32_bf16 a[120:123], a[56:59], a[168:171], a[120:123]
    v_mfma_f32_16x16x32_bf16 v[252:255], a[56:59], a[164:167], v[252:255]
    v_mfma_f32_16x16x32_bf16 v[252:255], a[60:63], a[180:183], v[252:255]
    v_mfma_f32_16x16x32_bf16 v[248:251], a[60:63], a[176:179], v[248:251]
    v_mfma_f32_16x16x32_bf16 v[248:251], a[56:59], a[160:163], v[248:251]
    s_waitcnt vmcnt(14) lgkmcnt(0)
    v_mfma_f32_16x16x32_bf16 v[192:195], a[0:3], a[192:195], v[192:195]
    v_mfma_f32_16x16x32_bf16 v[192:195], a[4:7], a[208:211], v[192:195]
    buffer_load_dwordx4 a[128:131], v36, s[8:11], s62 offen sc1
    ds_read_b64_tr_b16 a[32:33], v46 offset:32768
    v_mfma_f32_16x16x32_bf16 v[196:199], a[4:7], a[212:215], v[196:199]
    ds_read_b64_tr_b16 a[34:35], v46 offset:33792
    v_mfma_f32_16x16x32_bf16 v[196:199], a[0:3], a[196:199], v[196:199]
    ds_read_b64_tr_b16 a[36:37], v46 offset:40960
    v_mfma_f32_16x16x32_bf16 a[64:67], a[0:3], a[200:203], a[64:67]
    ds_read_b64_tr_b16 a[38:39], v46 offset:41984
    v_mfma_f32_16x16x32_bf16 a[64:67], a[4:7], a[216:219], a[64:67]
    ds_read_b64_tr_b16 a[40:41], v47 offset:32768
    v_mfma_f32_16x16x32_bf16 a[68:71], a[4:7], a[220:223], a[68:71]
    buffer_load_dwordx4 a[132:135], v54, s[8:11], s62 offen sc1
    v_mfma_f32_16x16x32_bf16 a[68:71], a[0:3], a[204:207], a[68:71]
    ds_read_b64_tr_b16 a[42:43], v47 offset:33792
    v_mfma_f32_16x16x32_bf16 a[76:79], a[8:11], a[204:207], a[76:79]
    ds_read_b64_tr_b16 a[44:45], v47 offset:40960
    v_mfma_f32_16x16x32_bf16 a[76:79], a[12:15], a[220:223], a[76:79]
    ds_read_b64_tr_b16 a[46:47], v47 offset:41984
    v_mfma_f32_16x16x32_bf16 a[72:75], a[12:15], a[216:219], a[72:75]
    ds_read_b64_tr_b16 a[48:49], v48 offset:32768
    v_mfma_f32_16x16x32_bf16 a[72:75], a[8:11], a[200:203], a[72:75]
    buffer_load_dwordx4 a[136:139], v37, s[8:11], s62 offen sc1
    v_mfma_f32_16x16x32_bf16 v[204:207], a[8:11], a[196:199], v[204:207]
    ds_read_b64_tr_b16 a[50:51], v48 offset:33792
    v_mfma_f32_16x16x32_bf16 v[204:207], a[12:15], a[212:215], v[204:207]
    ds_read_b64_tr_b16 a[52:53], v48 offset:40960
    v_mfma_f32_16x16x32_bf16 v[200:203], a[12:15], a[208:211], v[200:203]
    ds_read_b64_tr_b16 a[54:55], v48 offset:41984
    v_mfma_f32_16x16x32_bf16 v[200:203], a[8:11], a[192:195], v[200:203]
    v_mfma_f32_16x16x32_bf16 v[208:211], a[16:19], a[192:195], v[208:211]
    ds_read_b64_tr_b16 a[56:57], v49 offset:32768
    v_mfma_f32_16x16x32_bf16 v[208:211], a[20:23], a[208:211], v[208:211]
    buffer_load_dwordx4 a[140:143], v55, s[8:11], s62 offen sc1
    ds_read_b64_tr_b16 a[58:59], v49 offset:33792
    v_mfma_f32_16x16x32_bf16 v[212:215], a[20:23], a[212:215], v[212:215]
    ds_read_b64_tr_b16 a[60:61], v49 offset:40960
    v_mfma_f32_16x16x32_bf16 v[212:215], a[16:19], a[196:199], v[212:215]
    v_mfma_f32_16x16x32_bf16 a[80:83], a[16:19], a[200:203], a[80:83]
    ds_read_b64_tr_b16 a[62:63], v49 offset:41984
    v_mfma_f32_16x16x32_bf16 a[80:83], a[20:23], a[216:219], a[80:83]
    s_add_u32 s62, s62, 0x20000
    v_mfma_f32_16x16x32_bf16 a[84:87], a[20:23], a[220:223], a[84:87]
    s_add_u32 s52, s47, 532480
    v_mfma_f32_16x16x32_bf16 a[84:87], a[16:19], a[204:207], a[84:87]
    buffer_store_dwordx4 v[172:175], v1, s[48:51], s52 offen offset:3072 sc1
    v_mfma_f32_16x16x32_bf16 a[92:95], a[24:27], a[204:207], a[92:95]
    v_mfma_f32_16x16x32_bf16 a[92:95], a[28:31], a[220:223], a[92:95]
    v_mfma_f32_16x16x32_bf16 a[88:91], a[28:31], a[216:219], a[88:91]
    v_mfma_f32_16x16x32_bf16 a[88:91], a[24:27], a[200:203], a[88:91]
    v_mfma_f32_16x16x32_bf16 v[220:223], a[24:27], a[196:199], v[220:223]
    v_add_co_u32 v2, vcc, 0x4000, v2
    s_nop 1
    v_addc_co_u32 v3, vcc, 0, v3, vcc
    global_load_dword v51, v[2:3], off
    v_mfma_f32_16x16x32_bf16 v[220:223], a[28:31], a[212:215], v[220:223]
    v_mfma_f32_16x16x32_bf16 v[216:219], a[28:31], a[208:211], v[216:219]
    v_mfma_f32_16x16x32_bf16 v[216:219], a[24:27], a[192:195], v[216:219]
    s_waitcnt vmcnt(9) lgkmcnt(0)
    s_barrier
    v_mfma_f32_16x16x32_bf16 v[224:227], a[32:35], a[192:195], v[224:227]
    v_mfma_f32_16x16x32_bf16 v[224:227], a[36:39], a[208:211], v[224:227]
    s_add_u32 m0, s60, 98304
    ds_read_b64_tr_b16 a[0:1], v42 offset:49152
    ds_read_b64_tr_b16 a[2:3], v42 offset:50176
    v_mfma_f32_16x16x32_bf16 v[228:231], a[36:39], a[212:215], v[228:231]
    buffer_load_dwordx4 v38, s[12:15], s61 offen offset:0 lds
    v_mfma_f32_16x16x32_bf16 v[228:231], a[32:35], a[196:199], v[228:231]
    ds_read_b64_tr_b16 a[4:5], v42 offset:57344
    v_mfma_f32_16x16x32_bf16 a[96:99], a[32:35], a[200:203], a[96:99]
    buffer_load_dwordx4 v39, s[12:15], s61 offen offset:1024 lds
    ds_read_b64_tr_b16 a[6:7], v42 offset:58368
    v_mfma_f32_16x16x32_bf16 a[96:99], a[36:39], a[216:219], a[96:99]
    ds_read_b64_tr_b16 a[8:9], v43 offset:49152
    v_mfma_f32_16x16x32_bf16 a[100:103], a[36:39], a[220:223], a[100:103]
    v_mfma_f32_16x16x32_bf16 a[100:103], a[32:35], a[204:207], a[100:103]
    buffer_load_dwordx4 v40, s[12:15], s61 offen offset:2048 lds
    ds_read_b64_tr_b16 a[10:11], v43 offset:50176
    v_mfma_f32_16x16x32_bf16 a[108:111], a[40:43], a[204:207], a[108:111]
    ds_read_b64_tr_b16 a[12:13], v43 offset:57344
    v_mfma_f32_16x16x32_bf16 a[108:111], a[44:47], a[220:223], a[108:111]
    ds_read_b64_tr_b16 a[14:15], v43 offset:58368
    v_mfma_f32_16x16x32_bf16 a[104:107], a[44:47], a[216:219], a[104:107]
    buffer_load_dwordx4 v41, s[12:15], s61 offen offset:3072 lds
    ds_read_b64_tr_b16 a[16:17], v44 offset:49152
    v_mfma_f32_16x16x32_bf16 a[104:107], a[40:43], a[200:203], a[104:107]
    v_mfma_f32_16x16x32_bf16 v[236:239], a[40:43], a[196:199], v[236:239]
    s_add_u32 s61, s61, 0x80000
    ds_read_b64_tr_b16 a[18:19], v44 offset:50176
    v_mfma_f32_16x16x32_bf16 v[236:239], a[44:47], a[212:215], v[236:239]
    buffer_load_dwordx4 a[144:147], v36, s[8:11], s62 offen sc1
    ds_read_b64_tr_b16 a[20:21], v44 offset:57344
    v_mfma_f32_16x16x32_bf16 v[232:235], a[44:47], a[208:211], v[232:235]
    ds_read_b64_tr_b16 a[22:23], v44 offset:58368
    v_mfma_f32_16x16x32_bf16 v[232:235], a[40:43], a[192:195], v[232:235]
    buffer_load_dwordx4 a[148:151], v54, s[8:11], s62 offen sc1
    v_mfma_f32_16x16x32_bf16 v[240:243], a[48:51], a[192:195], v[240:243]
    ds_read_b64_tr_b16 a[24:25], v45 offset:49152
    v_mfma_f32_16x16x32_bf16 v[240:243], a[52:55], a[208:211], v[240:243]
    ds_read_b64_tr_b16 a[26:27], v45 offset:50176
    v_mfma_f32_16x16x32_bf16 v[244:247], a[52:55], a[212:215], v[244:247]
    buffer_load_dwordx4 a[152:155], v37, s[8:11], s62 offen sc1
    ds_read_b64_tr_b16 a[28:29], v45 offset:57344
    v_mfma_f32_16x16x32_bf16 v[244:247], a[48:51], a[196:199], v[244:247]
    v_mfma_f32_16x16x32_bf16 a[112:115], a[48:51], a[200:203], a[112:115]
    ds_read_b64_tr_b16 a[30:31], v45 offset:58368
    v_mfma_f32_16x16x32_bf16 a[112:115], a[52:55], a[216:219], a[112:115]
    buffer_load_dwordx4 a[156:159], v55, s[8:11], s62 offen sc1
    v_mfma_f32_16x16x32_bf16 a[116:119], a[52:55], a[220:223], a[116:119]
    v_mfma_f32_16x16x32_bf16 a[116:119], a[48:51], a[204:207], a[116:119]
    s_add_u32 s62, s62, 0x20000
    v_mfma_f32_16x16x32_bf16 a[124:127], a[56:59], a[204:207], a[124:127]
    s_add_u32 s52, s47, 536576
    v_mfma_f32_16x16x32_bf16 a[124:127], a[60:63], a[220:223], a[124:127]
    buffer_store_dwordx4 v[176:179], v1, s[48:51], s52 offen offset:0 sc1
    v_mfma_f32_16x16x32_bf16 a[120:123], a[60:63], a[216:219], a[120:123]
    v_mfma_f32_16x16x32_bf16 a[120:123], a[56:59], a[200:203], a[120:123]
    v_mfma_f32_16x16x32_bf16 v[252:255], a[56:59], a[196:199], v[252:255]
    v_mfma_f32_16x16x32_bf16 v[252:255], a[60:63], a[212:215], v[252:255]
    v_mfma_f32_16x16x32_bf16 v[248:251], a[60:63], a[208:211], v[248:251]
    v_mfma_f32_16x16x32_bf16 v[248:251], a[56:59], a[192:195], v[248:251]
    s_waitcnt vmcnt(14) lgkmcnt(0)
    v_mfma_f32_16x16x32_bf16 v[192:195], a[0:3], a[224:227], v[192:195]
    v_mfma_f32_16x16x32_bf16 v[192:195], a[4:7], a[240:243], v[192:195]
    buffer_load_dwordx4 a[160:163], v36, s[8:11], s62 offen sc1
    ds_read_b64_tr_b16 a[32:33], v46 offset:49152
    v_mfma_f32_16x16x32_bf16 v[196:199], a[4:7], a[244:247], v[196:199]
    ds_read_b64_tr_b16 a[34:35], v46 offset:50176
    v_mfma_f32_16x16x32_bf16 v[196:199], a[0:3], a[228:231], v[196:199]
    ds_read_b64_tr_b16 a[36:37], v46 offset:57344
    v_mfma_f32_16x16x32_bf16 a[64:67], a[0:3], a[232:235], a[64:67]
    ds_read_b64_tr_b16 a[38:39], v46 offset:58368
    v_mfma_f32_16x16x32_bf16 a[64:67], a[4:7], a[248:251], a[64:67]
    ds_read_b64_tr_b16 a[40:41], v47 offset:49152
    v_mfma_f32_16x16x32_bf16 a[68:71], a[4:7], a[252:255], a[68:71]
    buffer_load_dwordx4 a[164:167], v54, s[8:11], s62 offen sc1
    v_mfma_f32_16x16x32_bf16 a[68:71], a[0:3], a[236:239], a[68:71]
    ds_read_b64_tr_b16 a[42:43], v47 offset:50176
    v_mfma_f32_16x16x32_bf16 a[76:79], a[8:11], a[236:239], a[76:79]
    ds_read_b64_tr_b16 a[44:45], v47 offset:57344
    v_mfma_f32_16x16x32_bf16 a[76:79], a[12:15], a[252:255], a[76:79]
    ds_read_b64_tr_b16 a[46:47], v47 offset:58368
    v_mfma_f32_16x16x32_bf16 a[72:75], a[12:15], a[248:251], a[72:75]
    ds_read_b64_tr_b16 a[48:49], v48 offset:49152
    v_mfma_f32_16x16x32_bf16 a[72:75], a[8:11], a[232:235], a[72:75]
    buffer_load_dwordx4 a[168:171], v37, s[8:11], s62 offen sc1
    v_mfma_f32_16x16x32_bf16 v[204:207], a[8:11], a[228:231], v[204:207]
    ds_read_b64_tr_b16 a[50:51], v48 offset:50176
    v_mfma_f32_16x16x32_bf16 v[204:207], a[12:15], a[244:247], v[204:207]
    ds_read_b64_tr_b16 a[52:53], v48 offset:57344
    v_mfma_f32_16x16x32_bf16 v[200:203], a[12:15], a[240:243], v[200:203]
    ds_read_b64_tr_b16 a[54:55], v48 offset:58368
    v_mfma_f32_16x16x32_bf16 v[200:203], a[8:11], a[224:227], v[200:203]
    v_mfma_f32_16x16x32_bf16 v[208:211], a[16:19], a[224:227], v[208:211]
    ds_read_b64_tr_b16 a[56:57], v49 offset:49152
    v_mfma_f32_16x16x32_bf16 v[208:211], a[20:23], a[240:243], v[208:211]
    buffer_load_dwordx4 a[172:175], v55, s[8:11], s62 offen sc1
    ds_read_b64_tr_b16 a[58:59], v49 offset:50176
    v_mfma_f32_16x16x32_bf16 v[212:215], a[20:23], a[244:247], v[212:215]
    ds_read_b64_tr_b16 a[60:61], v49 offset:57344
    v_mfma_f32_16x16x32_bf16 v[212:215], a[16:19], a[228:231], v[212:215]
    v_mfma_f32_16x16x32_bf16 a[80:83], a[16:19], a[232:235], a[80:83]
    ds_read_b64_tr_b16 a[62:63], v49 offset:58368
    v_mfma_f32_16x16x32_bf16 a[80:83], a[20:23], a[248:251], a[80:83]
    s_add_u32 s62, s62, 0x20000
    v_mfma_f32_16x16x32_bf16 a[84:87], a[20:23], a[252:255], a[84:87]
    s_add_u32 s52, s47, 536576
    v_mfma_f32_16x16x32_bf16 a[84:87], a[16:19], a[236:239], a[84:87]
    buffer_store_dwordx4 v[180:183], v1, s[48:51], s52 offen offset:1024 sc1
    v_mfma_f32_16x16x32_bf16 a[92:95], a[24:27], a[236:239], a[92:95]
    v_mfma_f32_16x16x32_bf16 a[92:95], a[28:31], a[252:255], a[92:95]
    v_mfma_f32_16x16x32_bf16 a[88:91], a[28:31], a[248:251], a[88:91]
    v_mfma_f32_16x16x32_bf16 a[88:91], a[24:27], a[232:235], a[88:91]
    v_mfma_f32_16x16x32_bf16 v[220:223], a[24:27], a[228:231], v[220:223]
    v_mfma_f32_16x16x32_bf16 v[220:223], a[28:31], a[244:247], v[220:223]
    v_mfma_f32_16x16x32_bf16 v[216:219], a[28:31], a[240:243], v[216:219]
    v_mfma_f32_16x16x32_bf16 v[216:219], a[24:27], a[224:227], v[216:219]
    s_waitcnt vmcnt(10) lgkmcnt(0)
    s_barrier
    v_mfma_f32_16x16x32_bf16 v[224:227], a[32:35], a[224:227], v[224:227]
    s_cmp_eq_u32 s30, 0
    s_cbranch_scc1 k12_ool_68
k12_oolret_69:
    v_mfma_f32_16x16x32_bf16 v[224:227], a[36:39], a[240:243], v[224:227]
    s_add_u32 m0, s60, 114688
    ds_read_b64_tr_b16 a[0:1], v42 offset:0
    ds_read_b64_tr_b16 a[2:3], v42 offset:1024
    v_mfma_f32_16x16x32_bf16 v[228:231], a[36:39], a[244:247], v[228:231]
    buffer_load_dwordx4 v38, s[12:15], s61 offen offset:0 lds
    v_mfma_f32_16x16x32_bf16 v[228:231], a[32:35], a[228:231], v[228:231]
    ds_read_b64_tr_b16 a[4:5], v42 offset:8192
    v_mfma_f32_16x16x32_bf16 a[96:99], a[32:35], a[232:235], a[96:99]
    buffer_load_dwordx4 v39, s[12:15], s61 offen offset:1024 lds
    ds_read_b64_tr_b16 a[6:7], v42 offset:9216
    v_mfma_f32_16x16x32_bf16 a[96:99], a[36:39], a[248:251], a[96:99]
    ds_read_b64_tr_b16 a[8:9], v43 offset:0
    v_mfma_f32_16x16x32_bf16 a[100:103], a[36:39], a[252:255], a[100:103]
    v_mfma_f32_16x16x32_bf16 a[100:103], a[32:35], a[236:239], a[100:103]
    buffer_load_dwordx4 v40, s[12:15], s61 offen offset:2048 lds
    ds_read_b64_tr_b16 a[10:11], v43 offset:1024
    v_mfma_f32_16x16x32_bf16 a[108:111], a[40:43], a[236:239], a[108:111]
    ds_read_b64_tr_b16 a[12:13], v43 offset:8192
    v_mfma_f32_16x16x32_bf16 a[108:111], a[44:47], a[252:255], a[108:111]
    ds_read_b64_tr_b16 a[14:15], v43 offset:9216
    v_mfma_f32_16x16x32_bf16 a[104:107], a[44:47], a[248:251], a[104:107]
    buffer_load_dwordx4 v41, s[12:15], s61 offen offset:3072 lds
    ds_read_b64_tr_b16 a[16:17], v44 offset:0
    v_mfma_f32_16x16x32_bf16 a[104:107], a[40:43], a[232:235], a[104:107]
    v_mfma_f32_16x16x32_bf16 v[236:239], a[40:43], a[228:231], v[236:239]
    s_add_u32 s61, s61, 0x80000
    ds_read_b64_tr_b16 a[18:19], v44 offset:1024
    v_mfma_f32_16x16x32_bf16 v[236:239], a[44:47], a[244:247], v[236:239]
    buffer_load_dwordx4 a[176:179], v36, s[8:11], s62 offen sc1
    ds_read_b64_tr_b16 a[20:21], v44 offset:8192
    v_mfma_f32_16x16x32_bf16 v[232:235], a[44:47], a[240:243], v[232:235]
    ds_read_b64_tr_b16 a[22:23], v44 offset:9216
    v_mfma_f32_16x16x32_bf16 v[232:235], a[40:43], a[224:227], v[232:235]
    buffer_load_dwordx4 a[180:183], v54, s[8:11], s62 offen sc1
    v_mfma_f32_16x16x32_bf16 v[240:243], a[48:51], a[224:227], v[240:243]
    ds_read_b64_tr_b16 a[24:25], v45 offset:0
    v_mfma_f32_16x16x32_bf16 v[240:243], a[52:55], a[240:243], v[240:243]
    ds_read_b64_tr_b16 a[26:27], v45 offset:1024
    v_mfma_f32_16x16x32_bf16 v[244:247], a[52:55], a[244:247], v[244:247]
    buffer_load_dwordx4 a[184:187], v37, s[8:11], s62 offen sc1
    ds_read_b64_tr_b16 a[28:29], v45 offset:8192
    v_mfma_f32_16x16x32_bf16 v[244:247], a[48:51], a[228:231], v[244:247]
    v_mfma_f32_16x16x32_bf16 a[112:115], a[48:51], a[232:235], a[112:115]
    ds_read_b64_tr_b16 a[30:31], v45 offset:9216
    v_mfma_f32_16x16x32_bf16 a[112:115], a[52:55], a[248:251], a[112:115]
    buffer_load_dwordx4 a[188:191], v55, s[8:11], s62 offen sc1
    v_mfma_f32_16x16x32_bf16 a[116:119], a[52:55], a[252:255], a[116:119]
    v_mfma_f32_16x16x32_bf16 a[116:119], a[48:51], a[236:239], a[116:119]
    s_add_u32 s62, s62, 0x20000
    v_mfma_f32_16x16x32_bf16 a[124:127], a[56:59], a[236:239], a[124:127]
    s_add_u32 s52, s47, 536576
    v_mfma_f32_16x16x32_bf16 a[124:127], a[60:63], a[252:255], a[124:127]
    buffer_store_dwordx4 v[184:187], v1, s[48:51], s52 offen offset:2048 sc1
    v_mfma_f32_16x16x32_bf16 a[120:123], a[60:63], a[248:251], a[120:123]
    v_mfma_f32_16x16x32_bf16 a[120:123], a[56:59], a[232:235], a[120:123]
    v_mfma_f32_16x16x32_bf16 v[252:255], a[56:59], a[228:231], v[252:255]
    v_mfma_f32_16x16x32_bf16 v[252:255], a[60:63], a[244:247], v[252:255]
    v_mfma_f32_16x16x32_bf16 v[248:251], a[60:63], a[240:243], v[248:251]
    v_mfma_f32_16x16x32_bf16 v[248:251], a[56:59], a[224:227], v[248:251]
    s_waitcnt vmcnt(15) lgkmcnt(0)
    v_mfma_f32_16x16x32_bf16 v[192:195], a[0:3], a[128:131], v[192:195]
    v_mfma_f32_16x16x32_bf16 v[192:195], a[4:7], a[144:147], v[192:195]
    s_add_u32 s52, s47, 536576
    ds_read_b64_tr_b16 a[32:33], v46 offset:0
    ds_read_b64_tr_b16 a[34:35], v46 offset:1024
    v_mfma_f32_16x16x32_bf16 v[196:199], a[4:7], a[148:151], v[196:199]
    buffer_store_dwordx4 v[188:191], v1, s[48:51], s52 offen offset:3072 sc1
    v_mfma_f32_16x16x32_bf16 v[196:199], a[0:3], a[132:135], v[196:199]
    ds_read_b64_tr_b16 a[36:37], v46 offset:8192
    v_mfma_f32_16x16x32_bf16 a[64:67], a[0:3], a[136:139], a[64:67]
    ds_read_b64_tr_b16 a[38:39], v46 offset:9216
    v_mfma_f32_16x16x32_bf16 a[64:67], a[4:7], a[152:155], a[64:67]
    ds_read_b64_tr_b16 a[40:41], v47 offset:0
    v_mfma_f32_16x16x32_bf16 a[68:71], a[4:7], a[156:159], a[68:71]
    v_mfma_f32_16x16x32_bf16 a[68:71], a[0:3], a[140:143], a[68:71]
    ds_read_b64_tr_b16 a[42:43], v47 offset:1024
    v_mfma_f32_16x16x32_bf16 a[76:79], a[8:11], a[140:143], a[76:79]
    ds_read_b64_tr_b16 a[44:45], v47 offset:8192
    v_mfma_f32_16x16x32_bf16 a[76:79], a[12:15], a[156:159], a[76:79]
    ds_read_b64_tr_b16 a[46:47], v47 offset:9216
    v_mfma_f32_16x16x32_bf16 a[72:75], a[12:15], a[152:155], a[72:75]
    ds_read_b64_tr_b16 a[48:49], v48 offset:0
    v_mfma_f32_16x16x32_bf16 a[72:75], a[8:11], a[136:139], a[72:75]
    v_mfma_f32_16x16x32_bf16 v[204:207], a[8:11], a[132:135], v[204:207]
    ds_read_b64_tr_b16 a[50:51], v48 offset:1024
    v_mfma_f32_16x16x32_bf16 v[204:207], a[12:15], a[148:151], v[204:207]
    ds_read_b64_tr_b16 a[52:53], v48 offset:8192
    v_mfma_f32_16x16x32_bf16 v[200:203], a[12:15], a[144:147], v[200:203]
    ds_read_b64_tr_b16 a[54:55], v48 offset:9216
    v_mfma_f32_16x16x32_bf16 v[200:203], a[8:11], a[128:131], v[200:203]
    v_mfma_f32_16x16x32_bf16 v[208:211], a[16:19], a[128:131], v[208:211]
    ds_read_b64_tr_b16 a[56:57], v49 offset:0
    v_mfma_f32_16x16x32_bf16 v[208:211], a[20:23], a[144:147], v[208:211]
    ds_read_b64_tr_b16 a[58:59], v49 offset:1024
    v_mfma_f32_16x16x32_bf16 v[212:215], a[20:23], a[148:151], v[212:215]
    ds_read_b64_tr_b16 a[60:61], v49 offset:8192
    v_mfma_f32_16x16x32_bf16 v[212:215], a[16:19], a[132:135], v[212:215]
    v_mfma_f32_16x16x32_bf16 a[80:83], a[16:19], a[136:139], a[80:83]
    ds_read_b64_tr_b16 a[62:63], v49 offset:9216
    v_mfma_f32_16x16x32_bf16 a[80:83], a[20:23], a[152:155], a[80:83]
    v_mfma_f32_16x16x32_bf16 a[84:87], a[20:23], a[156:159], a[84:87]
    v_mfma_f32_16x16x32_bf16 a[84:87], a[16:19], a[140:143], a[84:87]
    v_mfma_f32_16x16x32_bf16 a[92:95], a[24:27], a[140:143], a[92:95]
    v_mfma_f32_16x16x32_bf16 a[92:95], a[28:31], a[156:159], a[92:95]
    v_mfma_f32_16x16x32_bf16 a[88:91], a[28:31], a[152:155], a[88:91]
    v_mfma_f32_16x16x32_bf16 a[88:91], a[24:27], a[136:139], a[88:91]
    v_mfma_f32_16x16x32_bf16 v[220:223], a[24:27], a[132:135], v[220:223]
    s_cmp_eq_u32 s30, 0
    s_cbranch_scc1 k12_ool_72
k12_oolret_73:
    v_mfma_f32_16x16x32_bf16 v[220:223], a[28:31], a[148:151], v[220:223]
    v_mfma_f32_16x16x32_bf16 v[216:219], a[28:31], a[144:147], v[216:219]
    v_mfma_f32_16x16x32_bf16 v[216:219], a[24:27], a[128:131], v[216:219]
    s_waitcnt vmcnt(6) lgkmcnt(0)
    s_barrier
    v_mfma_f32_16x16x32_bf16 v[224:227], a[32:35], a[128:131], v[224:227]
    v_mfma_f32_16x16x32_bf16 v[224:227], a[36:39], a[144:147], v[224:227]
    s_mov_b32 m0, s34
    ds_read_b64_tr_b16 a[0:1], v42 offset:16384
    ds_read_b64_tr_b16 a[2:3], v42 offset:17408
    v_mfma_f32_16x16x32_bf16 v[228:231], a[36:39], a[148:151], v[228:231]
    buffer_load_dwordx4 v1, s[16:19], s32 offen offset:0 sc1 lds
    v_mfma_f32_16x16x32_bf16 v[228:231], a[32:35], a[132:135], v[228:231]
    ds_read_b64_tr_b16 a[4:5], v42 offset:24576
    v_mfma_f32_16x16x32_bf16 a[96:99], a[32:35], a[136:139], a[96:99]
    buffer_load_dwordx4 v1, s[16:19], s32 offen offset:1024 sc1 lds
    ds_read_b64_tr_b16 a[6:7], v42 offset:25600
    v_mfma_f32_16x16x32_bf16 a[96:99], a[36:39], a[152:155], a[96:99]
    ds_read_b64_tr_b16 a[8:9], v43 offset:16384
    v_mfma_f32_16x16x32_bf16 a[100:103], a[36:39], a[156:159], a[100:103]
    v_mfma_f32_16x16x32_bf16 a[100:103], a[32:35], a[140:143], a[100:103]
    buffer_load_dwordx4 v1, s[16:19], s32 offen offset:2048 sc1 lds
    ds_read_b64_tr_b16 a[10:11], v43 offset:17408
    v_mfma_f32_16x16x32_bf16 a[108:111], a[40:43], a[140:143], a[108:111]
    ds_read_b64_tr_b16 a[12:13], v43 offset:24576
    v_mfma_f32_16x16x32_bf16 a[108:111], a[44:47], a[156:159], a[108:111]
    ds_read_b64_tr_b16 a[14:15], v43 offset:25600
    v_mfma_f32_16x16x32_bf16 a[104:107], a[44:47], a[152:155], a[104:107]
    ds_read_b64_tr_b16 a[16:17], v44 offset:16384
    v_mfma_f32_16x16x32_bf16 a[104:107], a[40:43], a[136:139], a[104:107]
    buffer_load_dwordx4 v1, s[16:19], s32 offen offset:3072 sc1 lds
    v_mfma_f32_16x16x32_bf16 v[236:239], a[40:43], a[132:135], v[236:239]
    ds_read_b64_tr_b16 a[18:19], v44 offset:17408
    v_mfma_f32_16x16x32_bf16 v[236:239], a[44:47], a[148:151], v[236:239]
    s_add_u32 s32, s32, 0x80000
    ds_read_b64_tr_b16 a[20:21], v44 offset:24576
    v_mfma_f32_16x16x32_bf16 v[232:235], a[44:47], a[144:147], v[232:235]
    s_add_u32 s34, s34, 0x4000
    ds_read_b64_tr_b16 a[22:23], v44 offset:25600
    s_mov_b32 m0, s34
    v_mfma_f32_16x16x32_bf16 v[232:235], a[40:43], a[128:131], v[232:235]
    buffer_load_dwordx4 v1, s[16:19], s32 offen offset:0 sc1 lds
    v_mfma_f32_16x16x32_bf16 v[240:243], a[48:51], a[128:131], v[240:243]
    ds_read_b64_tr_b16 a[24:25], v45 offset:16384
    v_mfma_f32_16x16x32_bf16 v[240:243], a[52:55], a[144:147], v[240:243]
    buffer_load_dwordx4 v1, s[16:19], s32 offen offset:1024 sc1 lds
    ds_read_b64_tr_b16 a[26:27], v45 offset:17408
    v_mfma_f32_16x16x32_bf16 v[244:247], a[52:55], a[148:151], v[244:247]
    ds_read_b64_tr_b16 a[28:29], v45 offset:24576
    v_mfma_f32_16x16x32_bf16 v[244:247], a[48:51], a[132:135], v[244:247]
    v_mfma_f32_16x16x32_bf16 a[112:115], a[48:51], a[136:139], a[112:115]
    buffer_load_dwordx4 v1, s[16:19], s32 offen offset:2048 sc1 lds
    ds_read_b64_tr_b16 a[30:31], v45 offset:25600
    v_mfma_f32_16x16x32_bf16 a[112:115], a[52:55], a[152:155], a[112:115]
    v_mfma_f32_16x16x32_bf16 a[116:119], a[52:55], a[156:159], a[116:119]
    v_mfma_f32_16x16x32_bf16 a[116:119], a[48:51], a[140:143], a[116:119]
    v_mfma_f32_16x16x32_bf16 a[124:127], a[56:59], a[140:143], a[124:127]
    buffer_load_dwordx4 v1, s[16:19], s32 offen offset:3072 sc1 lds
    v_mfma_f32_16x16x32_bf16 a[124:127], a[60:63], a[156:159], a[124:127]
    v_mfma_f32_16x16x32_bf16 a[120:123], a[60:63], a[152:155], a[120:123]
    s_add_u32 s32, s32, 0x80000
    v_mfma_f32_16x16x32_bf16 a[120:123], a[56:59], a[136:139], a[120:123]
    s_add_u32 s34, s34, 0x4000
    v_mfma_f32_16x16x32_bf16 v[252:255], a[56:59], a[132:135], v[252:255]
    v_mfma_f32_16x16x32_bf16 v[252:255], a[60:63], a[148:151], v[252:255]
    v_mfma_f32_16x16x32_bf16 v[248:251], a[60:63], a[144:147], v[248:251]
    v_mfma_f32_16x16x32_bf16 v[248:251], a[56:59], a[128:131], v[248:251]
    s_waitcnt vmcnt(10) lgkmcnt(0)
    v_mfma_f32_16x16x32_bf16 v[192:195], a[0:3], a[160:163], v[192:195]
    v_mfma_f32_16x16x32_bf16 v[192:195], a[4:7], a[176:179], v[192:195]
    s_mov_b32 m0, s35
    ds_read_b64_tr_b16 a[32:33], v46 offset:16384
    ds_read_b64_tr_b16 a[34:35], v46 offset:17408
    v_mfma_f32_16x16x32_bf16 v[196:199], a[4:7], a[180:183], v[196:199]
    s_mov_b32 s41, 0x3e0293ee
    buffer_load_dwordx4 v1, s[20:23], s33 offen offset:0 sc1 lds
    v_mfma_f32_16x16x32_bf16 v[196:199], a[0:3], a[164:167], v[196:199]
    ds_read_b64_tr_b16 a[36:37], v46 offset:24576
    v_mfma_f32_16x16x32_bf16 a[64:67], a[0:3], a[168:171], a[64:67]
    buffer_load_dwordx4 v1, s[20:23], s33 offen offset:1024 sc1 lds
    ds_read_b64_tr_b16 a[38:39], v46 offset:25600
    v_mfma_f32_16x16x32_bf16 a[64:67], a[4:7], a[184:187], a[64:67]
    ds_read_b64_tr_b16 a[40:41], v47 offset:16384
    v_mfma_f32_16x16x32_bf16 a[68:71], a[4:7], a[188:191], a[68:71]
    v_mfma_f32_16x16x32_bf16 a[68:71], a[0:3], a[172:175], a[68:71]
    buffer_load_dwordx4 v1, s[20:23], s33 offen offset:2048 sc1 lds
    ds_read_b64_tr_b16 a[42:43], v47 offset:17408
    v_mfma_f32_16x16x32_bf16 a[76:79], a[8:11], a[172:175], a[76:79]
    ds_read_b64_tr_b16 a[44:45], v47 offset:24576
    v_mfma_f32_16x16x32_bf16 a[76:79], a[12:15], a[188:191], a[76:79]
    ds_read_b64_tr_b16 a[46:47], v47 offset:25600
    v_mfma_f32_16x16x32_bf16 a[72:75], a[12:15], a[184:187], a[72:75]
    ds_read_b64_tr_b16 a[48:49], v48 offset:16384
    v_mfma_f32_16x16x32_bf16 a[72:75], a[8:11], a[168:171], a[72:75]
    buffer_load_dwordx4 v1, s[20:23], s33 offen offset:3072 sc1 lds
    v_mfma_f32_16x16x32_bf16 v[204:207], a[8:11], a[164:167], v[204:207]
    ds_read_b64_tr_b16 a[50:51], v48 offset:17408
    v_mfma_f32_16x16x32_bf16 v[204:207], a[12:15], a[180:183], v[204:207]
    s_add_u32 s33, s33, 0x80000
    ds_read_b64_tr_b16 a[52:53], v48 offset:24576
    v_mfma_f32_16x16x32_bf16 v[200:203], a[12:15], a[176:179], v[200:203]
    s_add_u32 s35, s35, 0x4000
    ds_read_b64_tr_b16 a[54:55], v48 offset:25600
    s_mov_b32 m0, s34
    v_mfma_f32_16x16x32_bf16 v[200:203], a[8:11], a[160:163], v[200:203]
    buffer_load_dwordx4 v1, s[16:19], s32 offen offset:0 sc1 lds
    v_mfma_f32_16x16x32_bf16 v[208:211], a[16:19], a[160:163], v[208:211]
    ds_read_b64_tr_b16 a[56:57], v49 offset:16384
    v_mfma_f32_16x16x32_bf16 v[208:211], a[20:23], a[176:179], v[208:211]
    buffer_load_dwordx4 v1, s[16:19], s32 offen offset:1024 sc1 lds
    ds_read_b64_tr_b16 a[58:59], v49 offset:17408
    v_mfma_f32_16x16x32_bf16 v[212:215], a[20:23], a[180:183], v[212:215]
    ds_read_b64_tr_b16 a[60:61], v49 offset:24576
    v_mfma_f32_16x16x32_bf16 v[212:215], a[16:19], a[164:167], v[212:215]
    v_mfma_f32_16x16x32_bf16 a[80:83], a[16:19], a[168:171], a[80:83]
    buffer_load_dwordx4 v1, s[16:19], s32 offen offset:2048 sc1 lds
    ds_read_b64_tr_b16 a[62:63], v49 offset:25600
    v_mfma_f32_16x16x32_bf16 a[80:83], a[20:23], a[184:187], a[80:83]
    v_accvgpr_read_b32 v128, a64
    v_accvgpr_read_b32 v129, a65
    v_mfma_f32_16x16x32_bf16 a[84:87], a[20:23], a[188:191], a[84:87]
    v_accvgpr_read_b32 v130, a66
    v_accvgpr_read_b32 v131, a67
    v_mfma_f32_16x16x32_bf16 a[84:87], a[16:19], a[172:175], a[84:87]
    v_mul_f32 v128, s41, v128
    v_mul_f32 v129, s41, v129
    v_mfma_f32_16x16x32_bf16 a[92:95], a[24:27], a[172:175], a[92:95]
    v_mul_f32 v130, s41, v130
    v_mul_f32 v131, s41, v131
    v_mfma_f32_16x16x32_bf16 a[92:95], a[28:31], a[188:191], a[92:95]
    buffer_load_dwordx4 v1, s[16:19], s32 offen offset:3072 sc1 lds
    v_mfma_f32_16x16x32_bf16 a[88:91], a[28:31], a[184:187], a[88:91]
    s_add_u32 s32, s32, 0x80000
    v_cvt_pk_bf16_f32 v96, v128, v129
    v_cvt_pk_bf16_f32 v97, v130, v131
    v_mfma_f32_16x16x32_bf16 a[88:91], a[24:27], a[168:171], a[88:91]
    s_add_u32 s34, s34, 0x4000
    v_accvgpr_read_b32 v132, a72
    v_accvgpr_read_b32 v133, a73
    v_mfma_f32_16x16x32_bf16 v[220:223], a[24:27], a[164:167], v[220:223]
    v_accvgpr_read_b32 v134, a74
    v_accvgpr_read_b32 v135, a75
    v_mfma_f32_16x16x32_bf16 v[220:223], a[28:31], a[180:183], v[220:223]
    v_mul_f32 v132, s41, v132
    v_mul_f32 v133, s41, v133
    v_mfma_f32_16x16x32_bf16 v[216:219], a[28:31], a[176:179], v[216:219]
    v_mul_f32 v134, s41, v134
    v_mul_f32 v135, s41, v135
    v_mfma_f32_16x16x32_bf16 v[216:219], a[24:27], a[160:163], v[216:219]
    s_waitcnt vmcnt(63) lgkmcnt(0)
    s_barrier
    v_cvt_pk_bf16_f32 v98, v132, v133
    v_cvt_pk_bf16_f32 v99, v134, v135
    v_mfma_f32_16x16x32_bf16 v[224:227], a[32:35], a[160:163], v[224:227]
    v_accvgpr_read_b32 v136, a68
    v_accvgpr_read_b32 v137, a69
    v_mfma_f32_16x16x32_bf16 v[224:227], a[36:39], a[176:179], v[224:227]
    s_mov_b32 m0, s35
    v_accvgpr_read_b32 v138, a70
    v_accvgpr_read_b32 v139, a71
    v_mfma_f32_16x16x32_bf16 v[228:231], a[36:39], a[180:183], v[228:231]
    buffer_load_dwordx4 v1, s[20:23], s33 offen offset:0 sc1 lds
    v_mfma_f32_16x16x32_bf16 v[228:231], a[32:35], a[164:167], v[228:231]
    v_mul_f32 v136, s41, v136
    v_mul_f32 v137, s41, v137
    v_mfma_f32_16x16x32_bf16 a[96:99], a[32:35], a[168:171], a[96:99]
    v_mul_f32 v138, s41, v138
    v_mul_f32 v139, s41, v139
    v_mfma_f32_16x16x32_bf16 a[96:99], a[36:39], a[184:187], a[96:99]
    v_cvt_pk_bf16_f32 v112, v136, v137
    v_cvt_pk_bf16_f32 v113, v138, v139
    v_mfma_f32_16x16x32_bf16 a[100:103], a[36:39], a[188:191], a[100:103]
    v_accvgpr_read_b32 v140, a76
    v_accvgpr_read_b32 v141, a77
    v_mfma_f32_16x16x32_bf16 a[100:103], a[32:35], a[172:175], a[100:103]
    v_accvgpr_read_b32 v142, a78
    v_accvgpr_read_b32 v143, a79
    v_mfma_f32_16x16x32_bf16 a[108:111], a[40:43], a[172:175], a[108:111]
    v_mul_f32 v140, s41, v140
    v_mul_f32 v141, s41, v141
    v_mfma_f32_16x16x32_bf16 a[108:111], a[44:47], a[188:191], a[108:111]
    buffer_load_dwordx4 v1, s[20:23], s33 offen offset:1024 sc1 lds
    v_mfma_f32_16x16x32_bf16 a[104:107], a[44:47], a[184:187], a[104:107]
    v_mul_f32 v142, s41, v142
    v_mul_f32 v143, s41, v143
    v_mfma_f32_16x16x32_bf16 a[104:107], a[40:43], a[168:171], a[104:107]
    v_cvt_pk_bf16_f32 v114, v140, v141
    v_cvt_pk_bf16_f32 v115, v142, v143
    v_mfma_f32_16x16x32_bf16 v[236:239], a[40:43], a[164:167], v[236:239]
    v_mul_f32 v192, s41, v192
    v_mul_f32 v193, s41, v193
    v_mfma_f32_16x16x32_bf16 v[236:239], a[44:47], a[180:183], v[236:239]
    v_mul_f32 v194, s41, v194
    v_mul_f32 v195, s41, v195
    v_mfma_f32_16x16x32_bf16 v[232:235], a[44:47], a[176:179], v[232:235]
    v_cvt_pk_bf16_f32 v64, v192, v193
    v_cvt_pk_bf16_f32 v65, v194, v195
    v_mfma_f32_16x16x32_bf16 v[232:235], a[40:43], a[160:163], v[232:235]
    v_mul_f32 v200, s41, v200
    v_mul_f32 v201, s41, v201
    v_mfma_f32_16x16x32_bf16 v[240:243], a[48:51], a[160:163], v[240:243]
    buffer_load_dwordx4 v1, s[20:23], s33 offen offset:2048 sc1 lds
    v_mfma_f32_16x16x32_bf16 v[240:243], a[52:55], a[176:179], v[240:243]
    v_mul_f32 v202, s41, v202
    v_mul_f32 v203, s41, v203
    v_mfma_f32_16x16x32_bf16 v[244:247], a[52:55], a[180:183], v[244:247]
    v_cvt_pk_bf16_f32 v66, v200, v201
    v_cvt_pk_bf16_f32 v67, v202, v203
    v_mfma_f32_16x16x32_bf16 v[244:247], a[48:51], a[164:167], v[244:247]
    v_mul_f32 v196, s41, v196
    v_mul_f32 v197, s41, v197
    v_mfma_f32_16x16x32_bf16 a[112:115], a[48:51], a[168:171], a[112:115]
    v_mul_f32 v198, s41, v198
    v_mul_f32 v199, s41, v199
    v_mfma_f32_16x16x32_bf16 a[112:115], a[52:55], a[184:187], a[112:115]
    v_cvt_pk_bf16_f32 v80, v196, v197
    v_cvt_pk_bf16_f32 v81, v198, v199
    v_mfma_f32_16x16x32_bf16 a[116:119], a[52:55], a[188:191], a[116:119]
    v_mul_f32 v204, s41, v204
    v_mul_f32 v205, s41, v205
    v_mfma_f32_16x16x32_bf16 a[116:119], a[48:51], a[172:175], a[116:119]
    buffer_load_dwordx4 v1, s[20:23], s33 offen offset:3072 sc1 lds
    v_mfma_f32_16x16x32_bf16 a[124:127], a[56:59], a[172:175], a[124:127]
    v_mul_f32 v206, s41, v206
    v_mul_f32 v207, s41, v207
    v_mfma_f32_16x16x32_bf16 a[124:127], a[60:63], a[188:191], a[124:127]
    v_cvt_pk_bf16_f32 v82, v204, v205
    v_cvt_pk_bf16_f32 v83, v206, v207
    v_mfma_f32_16x16x32_bf16 a[120:123], a[60:63], a[184:187], a[120:123]
    s_add_u32 s33, s33, 0x80000
    v_mul_f32 v208, s41, v208
    v_mul_f32 v209, s41, v209
    v_mfma_f32_16x16x32_bf16 a[120:123], a[56:59], a[168:171], a[120:123]
    s_add_u32 s35, s35, 0x4000
    v_mul_f32 v210, s41, v210
    v_mul_f32 v211, s41, v211
    v_mfma_f32_16x16x32_bf16 v[252:255], a[56:59], a[164:167], v[252:255]
    v_cvt_pk_bf16_f32 v68, v208, v209
    v_cvt_pk_bf16_f32 v69, v210, v211
    v_mfma_f32_16x16x32_bf16 v[252:255], a[60:63], a[180:183], v[252:255]
    v_mul_f32 v216, s41, v216
    v_mul_f32 v217, s41, v217
    v_mfma_f32_16x16x32_bf16 v[248:251], a[60:63], a[176:179], v[248:251]
    v_mul_f32 v218, s41, v218
    v_mul_f32 v219, s41, v219
    v_mfma_f32_16x16x32_bf16 v[248:251], a[56:59], a[160:163], v[248:251]
    v_cvt_pk_bf16_f32 v70, v216, v217
    v_cvt_pk_bf16_f32 v71, v218, v219
    s_add_u32 s3, s54, 64
    s_add_u32 s5, s55, 64
    s_mov_b32 s63, s57
    s_load_dwordx2 s[44:45], s[0:1], 40
    s_load_dwordx2 s[46:47], s[0:1], 64
    s_load_dwordx4 s[48:51], s[0:1], 72
    s_mov_b32 s40, 0x3e0293ee
    s_mov_b32 s41, 0x3e0293ee
    v_mov_b32 v2, v1
    s_mov_b32 s52, 0x4000
    s_mov_b32 s53, 0
    s_lshl_b32 s62, s28, 6
    s_mul_i32 s31, s29, s29
    s_add_u32 s62, s62, s31
    s_lshr_b32 s31, s30, 1
    s_lshl_b32 s4, s31, 23
    s_add_u32 s4, s4, 0x6000000
    s_add_u32 s8, s6, s4
    s_addc_u32 s9, s7, 0
    s_and_b32 s9, s9, 0xffff
    s_mov_b32 s10, 0
    s_mov_b32 s58, 0
    s_mov_b32 s14, 0x700000
    s_mov_b32 s59, 0x700000
    s_lshl_b32 s54, s62, 12
    s_waitcnt vmcnt(8) lgkmcnt(0)
    s_barrier
    s_cmp_eq_u32 s63, 0
    s_cbranch_scc1 k12_ool_74
k12_oolret_75:
    ds_read_b128 a[128:131], v2 offset:0
    ds_read_b128 a[132:135], v2 offset:1024
    ds_read_b128 a[136:139], v2 offset:2048
    ds_read_b128 a[140:143], v2 offset:3072
    ds_read_b128 a[144:147], v2 offset:4096
    ds_read_b128 a[148:151], v2 offset:5120
    ds_read_b128 a[152:155], v2 offset:6144
    ds_read_b128 a[156:159], v2 offset:7168
    ds_read_b128 a[160:163], v2 offset:8192
    ds_read_b128 a[164:167], v2 offset:9216
    ds_read_b128 a[168:171], v2 offset:10240
    ds_read_b128 a[172:175], v2 offset:11264
    ds_read_b128 a[176:179], v2 offset:12288
    ds_read_b128 a[180:183], v2 offset:13312
    ds_read_b128 a[184:187], v2 offset:14336
    ds_read_b128 a[188:191], v2 offset:15360
    s_cmp_lt_u32 s30, 2
    s_cselect_b64 s[12:13], s[46:47], s[48:49]
    s_cselect_b64 s[60:61], s[44:45], s[50:51]
    s_cselect_b32 s55, 0x800000, s14
    s_and_b32 s13, s13, 0xffff
    v_mov_b32 v8, 0
    v_mov_b32 v9, 0
    v_mov_b32 v10, 0
    v_mov_b32 v11, 0
    s_mov_b32 s36, 0
    s_mov_b32 s37, 0x40004000
    v_mfma_f32_32x32x16_bf16 v[16:31], v[8:11], v[8:11], 0
    v_mfma_f32_32x32x16_bf16 v[32:47], v[8:11], v[8:11], 0
    v_accvgpr_read_b32 v136, a80
    v_accvgpr_read_b32 v137, a81
    v_accvgpr_read_b32 v138, a82
    v_accvgpr_read_b32 v139, a83
    v_pk_mul_f32 v[136:137], v[136:137], s[40:41]
    v_pk_mul_f32 v[138:139], v[138:139], s[40:41]
    v_cvt_pk_bf16_f32 v100, v136, v137
    v_cvt_pk_bf16_f32 v101, v138, v139
    v_accvgpr_read_b32 v140, a88
    v_accvgpr_read_b32 v141, a89
    v_accvgpr_read_b32 v142, a90
    v_accvgpr_read_b32 v143, a91
    v_pk_mul_f32 v[140:141], v[140:141], s[40:41]
    v_pk_mul_f32 v[142:143], v[142:143], s[40:41]
    v_cvt_pk_bf16_f32 v102, v140, v141
    v_cvt_pk_bf16_f32 v103, v142, v143
    v_accvgpr_read_b32 v128, a84
    v_accvgpr_read_b32 v129, a85
    v_accvgpr_read_b32 v130, a86
    v_accvgpr_read_b32 v131, a87
    v_pk_mul_f32 v[128:129], v[128:129], s[40:41]
    v_pk_mul_f32 v[130:131], v[130:131], s[40:41]
    v_cvt_pk_bf16_f32 v116, v128, v129
    v_cvt_pk_bf16_f32 v117, v130, v131
    v_accvgpr_read_b32 v132, a92
    v_accvgpr_read_b32 v133, a93
    v_accvgpr_read_b32 v134, a94
    v_accvgpr_read_b32 v135, a95
    v_pk_mul_f32 v[132:133], v[132:133], s[40:41]
    v_pk_mul_f32 v[134:135], v[134:135], s[40:41]
    v_cvt_pk_bf16_f32 v118, v132, v133
    v_cvt_pk_bf16_f32 v119, v134, v135
    v_pk_mul_f32 v[212:213], v[212:213], s[40:41]
    v_pk_mul_f32 v[214:215], v[214:215], s[40:41]
    v_cvt_pk_bf16_f32 v84, v212, v213
    v_cvt_pk_bf16_f32 v85, v214, v215
    v_pk_mul_f32 v[220:221], v[220:221], s[40:41]
    v_pk_mul_f32 v[222:223], v[222:223], s[40:41]
    v_cvt_pk_bf16_f32 v86, v220, v221
    v_cvt_pk_bf16_f32 v87, v222, v223
    v_accvgpr_read_b32 v128, a96
    v_accvgpr_read_b32 v129, a97
    v_accvgpr_read_b32 v130, a98
    v_accvgpr_read_b32 v131, a99
    v_pk_mul_f32 v[128:129], v[128:129], s[40:41]
    v_pk_mul_f32 v[130:131], v[130:131], s[40:41]
    v_cvt_pk_bf16_f32 v104, v128, v129
    v_cvt_pk_bf16_f32 v105, v130, v131
    v_accvgpr_read_b32 v132, a104
    v_accvgpr_read_b32 v133, a105
    v_accvgpr_read_b32 v134, a106
    v_accvgpr_read_b32 v135, a107
    v_pk_mul_f32 v[132:133], v[132:133], s[40:41]
    v_pk_mul_f32 v[134:135], v[134:135], s[40:41]
    v_cvt_pk_bf16_f32 v106, v132, v133
    v_cvt_pk_bf16_f32 v107, v134, v135
    v_accvgpr_read_b32 v136, a100
    v_accvgpr_read_b32 v137, a101
    v_accvgpr_read_b32 v138, a102
    v_accvgpr_read_b32 v139, a103
    v_pk_mul_f32 v[136:137], v[136:137], s[40:41]
    v_pk_mul_f32 v[138:139], v[138:139], s[40:41]
    v_cvt_pk_bf16_f32 v120, v136, v137
    v_cvt_pk_bf16_f32 v121, v138, v139
    v_accvgpr_read_b32 v140, a108
    v_accvgpr_read_b32 v141, a109
    v_accvgpr_read_b32 v142, a110
    v_accvgpr_read_b32 v143, a111
    v_pk_mul_f32 v[140:141], v[140:141], s[40:41]
    v_pk_mul_f32 v[142:143], v[142:143], s[40:41]
    v_cvt_pk_bf16_f32 v122, v140, v141
    v_cvt_pk_bf16_f32 v123, v142, v143
    v_pk_mul_f32 v[224:225], v[224:225], s[40:41]
    v_pk_mul_f32 v[226:227], v[226:227], s[40:41]
    v_cvt_pk_bf16_f32 v72, v224, v225
    v_cvt_pk_bf16_f32 v73, v226, v227
    v_pk_mul_f32 v[232:233], v[232:233], s[40:41]
    v_pk_mul_f32 v[234:235], v[234:235], s[40:41]
    v_cvt_pk_bf16_f32 v74, v232, v233
    v_cvt_pk_bf16_f32 v75, v234, v235
    v_pk_mul_f32 v[228:229], v[228:229], s[40:41]
    v_pk_mul_f32 v[230:231], v[230:231], s[40:41]
    v_cvt_pk_bf16_f32 v88, v228, v229
    v_cvt_pk_bf16_f32 v89, v230, v231
    v_pk_mul_f32 v[236:237], v[236:237], s[40:41]
    v_pk_mul_f32 v[238:239], v[238:239], s[40:41]
    v_cvt_pk_bf16_f32 v90, v236, v237
    v_cvt_pk_bf16_f32 v91, v238, v239
    v_accvgpr_read_b32 v136, a112
    v_accvgpr_read_b32 v137, a113
    v_accvgpr_read_b32 v138, a114
    v_accvgpr_read_b32 v139, a115
    v_pk_mul_f32 v[136:137], v[136:137], s[40:41]
    v_pk_mul_f32 v[138:139], v[138:139], s[40:41]
    v_cvt_pk_bf16_f32 v108, v136, v137
    v_cvt_pk_bf16_f32 v109, v138, v139
    v_accvgpr_read_b32 v140, a120
    v_accvgpr_read_b32 v141, a121
    v_accvgpr_read_b32 v142, a122
    v_accvgpr_read_b32 v143, a123
    v_pk_mul_f32 v[140:141], v[140:141], s[40:41]
    v_pk_mul_f32 v[142:143], v[142:143], s[40:41]
    v_cvt_pk_bf16_f32 v110, v140, v141
    v_cvt_pk_bf16_f32 v111, v142, v143
    v_accvgpr_read_b32 v128, a116
    v_accvgpr_read_b32 v129, a117
    v_accvgpr_read_b32 v130, a118
    v_accvgpr_read_b32 v131, a119
    v_pk_mul_f32 v[128:129], v[128:129], s[40:41]
    v_pk_mul_f32 v[130:131], v[130:131], s[40:41]
    v_cvt_pk_bf16_f32 v124, v128, v129
    v_cvt_pk_bf16_f32 v125, v130, v131
    v_accvgpr_read_b32 v132, a124
    v_accvgpr_read_b32 v133, a125
    v_accvgpr_read_b32 v134, a126
    v_accvgpr_read_b32 v135, a127
    v_pk_mul_f32 v[132:133], v[132:133], s[40:41]
    v_pk_mul_f32 v[134:135], v[134:135], s[40:41]
    v_cvt_pk_bf16_f32 v126, v132, v133
    v_cvt_pk_bf16_f32 v127, v134, v135
    v_pk_mul_f32 v[240:241], v[240:241], s[40:41]
    v_pk_mul_f32 v[242:243], v[242:243], s[40:41]
    v_cvt_pk_bf16_f32 v76, v240, v241
    v_cvt_pk_bf16_f32 v77, v242, v243
    v_pk_mul_f32 v[248:249], v[248:249], s[40:41]
    v_pk_mul_f32 v[250:251], v[250:251], s[40:41]
    v_cvt_pk_bf16_f32 v78, v248, v249
    v_cvt_pk_bf16_f32 v79, v250, v251
    v_pk_mul_f32 v[244:245], v[244:245], s[40:41]
    v_pk_mul_f32 v[246:247], v[246:247], s[40:41]
    v_cvt_pk_bf16_f32 v92, v244, v245
    v_cvt_pk_bf16_f32 v93, v246, v247
    v_pk_mul_f32 v[252:253], v[252:253], s[40:41]
    v_pk_mul_f32 v[254:255], v[254:255], s[40:41]
    v_cvt_pk_bf16_f32 v94, v252, v253
    v_cvt_pk_bf16_f32 v95, v254, v255
    s_and_b32 s4, s30, 1
    s_lshl_b32 s31, s4, 11
    s_waitcnt lgkmcnt(0)
    s_cmp_ge_u32 s36, s42
    s_cbranch_scc1 k2_prep_76
k2_prepret_77:
    v_mfma_f32_16x16x32_bf16 v[128:131], a[128:131], v[64:67], v[16:19]
    s_mov_b32 m0, s34
    v_add_u32 v2, 0x4000, v1
    v_or_b32 v3, 0x10000, v1
    v_mfma_f32_16x16x32_bf16 v[128:131], a[132:135], v[68:71], v[128:131]
    buffer_load_dwordx4 v1, s[16:19], s32 offen offset:0 sc1 lds
    v_mfma_f32_16x16x32_bf16 v[128:131], a[136:139], v[72:75], v[128:131]
    s_add_u32 s34, s34, 0x4000
    v_mov_b32 v56, v3
    v_mov_b32 v59, 0
    v_mfma_f32_16x16x32_bf16 v[128:131], a[140:143], v[76:79], v[128:131]
    s_add_u32 s36, s36, 32
    v_and_b32 v6, 0xf0, v1
    v_cmp_eq_u32 vcc, 0, v6
    v_mfma_f32_16x16x32_bf16 v[132:135], a[140:143], v[92:95], v[20:23]
    buffer_load_dwordx4 v1, s[16:19], s32 offen offset:1024 sc1 lds
    v_mfma_f32_16x16x32_bf16 v[132:135], a[136:139], v[88:91], v[132:135]
    v_mov_b32 v6, 0x3f803f80
    v_lshrrev_b32 v229, 7, v1
    v_mfma_f32_16x16x32_bf16 v[132:135], a[132:135], v[84:87], v[132:135]
    s_and_b32 s34, s34, 0xffff
    v_lshl_add_u32 v230, v1, 1, s31
    v_lshl_add_u32 v229, s4, 4, v229
    v_mfma_f32_16x16x32_bf16 v[132:135], a[128:131], v[80:83], v[132:135]
    v_mul_u32_u24 v228, 7168, v229
    v_mfma_f32_16x16x32_bf16 v[136:139], a[128:131], v[96:99], v[24:27]
    buffer_load_dwordx4 v1, s[16:19], s32 offen offset:2048 sc1 lds
    v_mfma_f32_16x16x32_bf16 v[136:139], a[132:135], v[100:103], v[136:139]
    v_and_b32 v7, 0x70, v1
    v_add_u32 v228, v228, v7
    v_mfma_f32_16x16x32_bf16 v[136:139], a[136:139], v[104:107], v[136:139]
    v_lshlrev_b32 v229, 5, v229
    v_and_b32 v57, 0x10, v1
    v_mfma_f32_16x16x32_bf16 v[136:139], a[140:143], v[108:111], v[136:139]
    buffer_load_dwordx4 v1, s[16:19], s32 offen offset:3072 sc1 lds
    v_mfma_f32_16x16x32_bf16 v[140:143], a[140:143], v[124:127], v[28:31]
    s_add_u32 s32, s32, 0x80000
    v_add_u32 v229, v229, v57
    v_lshrrev_b32 v7, 5, v7
    v_mfma_f32_16x16x32_bf16 v[140:143], a[136:139], v[120:123], v[140:143]
    v_lshl_add_u32 v229, v7, 15, v229
    v_cndmask_b32 v60, 0, v6, vcc
    v_mfma_f32_16x16x32_bf16 v[140:143], a[132:135], v[116:119], v[140:143]
    v_cndmask_b32 v61, 0, v6, vcc
    v_mfma_f32_16x16x32_bf16 v[140:143], a[128:131], v[112:115], v[140:143]
    v_cndmask_b32 v62, 0, v6, vcc
    v_mfma_f32_16x16x32_bf16 v[156:159], a[144:147], v[112:115], v[44:47]
    s_mov_b32 m0, s35
    v_cndmask_b32 v63, 0, v6, vcc
    v_mov_b32 v12, 0
    v_mfma_f32_16x16x32_bf16 v[156:159], a[148:151], v[116:119], v[156:159]
    buffer_load_dwordx4 v1, s[20:23], s33 offen offset:0 sc1 lds
    v_mfma_f32_16x16x32_bf16 v[156:159], a[152:155], v[120:123], v[156:159]
    s_add_u32 s35, s35, 0x4000
    v_mov_b32 v13, 0
    v_mov_b32 v14, 0
    v_mfma_f32_16x16x32_bf16 v[156:159], a[156:159], v[124:127], v[156:159]
    v_mov_b32 v15, 0
    v_mfma_f32_16x16x32_bf16 v[152:155], a[156:159], v[108:111], v[40:43]
    buffer_load_dwordx4 v1, s[20:23], s33 offen offset:1024 sc1 lds
    v_mfma_f32_16x16x32_bf16 v[152:155], a[152:155], v[104:107], v[152:155]
    v_mov_b32 v48, 0
    v_mov_b32 v49, 0
    v_mfma_f32_16x16x32_bf16 v[152:155], a[148:151], v[100:103], v[152:155]
    s_and_b32 s35, s35, 0xffff
    v_mov_b32 v50, 0
    v_mov_b32 v51, 0
    v_mfma_f32_16x16x32_bf16 v[152:155], a[144:147], v[96:99], v[152:155]
    v_mov_b32 v248, 0
    v_mov_b32 v249, 0
    v_mfma_f32_16x16x32_bf16 v[148:151], a[144:147], v[80:83], v[36:39]
    s_or_b32 s35, s35, 0x10000
    buffer_load_dwordx4 v1, s[20:23], s33 offen offset:2048 sc1 lds
    v_mfma_f32_16x16x32_bf16 v[148:151], a[148:151], v[84:87], v[148:151]
    v_mov_b32 v250, 0
    v_mov_b32 v251, 0
    v_mfma_f32_16x16x32_bf16 v[148:151], a[152:155], v[88:91], v[148:151]
    v_mov_b32 v252, 0
    v_mfma_f32_16x16x32_bf16 v[148:151], a[156:159], v[92:95], v[148:151]
    buffer_load_dwordx4 v1, s[20:23], s33 offen offset:3072 sc1 lds
    v_mfma_f32_16x16x32_bf16 v[144:147], a[156:159], v[76:79], v[32:35]
    s_add_u32 s33, s33, 0x80000
    v_mov_b32 v253, 0
    v_mov_b32 v254, 0
    v_mfma_f32_16x16x32_bf16 v[144:147], a[152:155], v[72:75], v[144:147]
    v_mov_b32 v255, 0
    v_mfma_f32_16x16x32_bf16 v[144:147], a[148:151], v[68:71], v[144:147]
    v_mfma_f32_16x16x32_bf16 v[144:147], a[144:147], v[64:67], v[144:147]
    v_mfma_f32_32x32x16_bf16 a[0:15], v[8:11], v[8:11], 0
    v_max_f32 v55, v140, v141
    v_max3_f32 v55, v55, v142, v143
    v_max3_f32 v55, v55, v156, v157
    v_max3_f32 v55, v55, v158, v159
    v_max_f32 v54, v136, v137
    v_max3_f32 v54, v54, v138, v139
    v_max3_f32 v54, v54, v152, v153
    v_mfma_f32_32x32x16_bf16 a[16:31], v[8:11], v[8:11], 0
    v_max3_f32 v54, v54, v154, v155
    v_max_f32 v53, v132, v133
    v_max3_f32 v53, v53, v134, v135
    v_max3_f32 v53, v53, v148, v149
    v_max3_f32 v53, v53, v150, v151
    v_max_f32 v52, v128, v129
    v_max3_f32 v52, v52, v130, v131
    v_mfma_f32_32x32x16_bf16 a[32:47], v[8:11], v[8:11], 0
    v_max3_f32 v52, v52, v144, v145
    v_max3_f32 v52, v52, v146, v147
    v_mov_b32 v227, v55
    v_mov_b32 v226, v54
    v_mov_b32 v225, v53
    v_mov_b32 v224, v52
    s_nop 1
    v_mfma_f32_32x32x16_bf16 a[48:63], v[8:11], v[8:11], 0
    v_permlane16_swap_b32 v55, v227
    v_permlane16_swap_b32 v54, v226
    v_permlane16_swap_b32 v53, v225
    v_permlane16_swap_b32 v52, v224
    s_nop 1
    v_max_f32 v55, v55, v227
    v_max_f32 v54, v54, v226
    v_mfma_f32_32x32x16_bf16 a[64:79], v[8:11], v[8:11], 0
    v_max_f32 v53, v53, v225
    v_max_f32 v52, v52, v224
    v_mov_b32 v227, v55
    v_mov_b32 v226, v54
    v_mov_b32 v225, v53
    v_mov_b32 v224, v52
    s_nop 1
    v_mfma_f32_32x32x16_bf16 a[80:95], v[8:11], v[8:11], 0
    v_permlane32_swap_b32 v55, v227
    v_permlane32_swap_b32 v54, v226
    v_permlane32_swap_b32 v53, v225
    v_permlane32_swap_b32 v52, v224
    s_nop 1
    v_max_f32 v55, v55, v227
    v_max_f32 v54, v54, v226
    v_mfma_f32_32x32x16_bf16 a[96:111], v[8:11], v[8:11], 0
    v_max_f32 v53, v53, v225
    v_max_f32 v52, v52, v224
    v_add_f32 v55, 0x41400000, v55
    v_add_f32 v54, 0x41400000, v54
    v_add_f32 v53, 0x41400000, v53
    v_add_f32 v52, 0x41400000, v52
    v_sub_f32 v16, 0, v52
    v_mfma_f32_32x32x16_bf16 a[112:127], v[8:11], v[8:11], 0
    v_sub_f32 v17, 0, v52
    v_sub_f32 v18, 0, v52
    v_sub_f32 v19, 0, v52
    v_sub_f32 v20, 0, v53
    v_sub_f32 v21, 0, v53
    v_sub_f32 v22, 0, v53
    v_sub_f32 v23, 0, v53
    v_sub_f32 v24, 0, v54
    v_sub_f32 v25, 0, v54
    v_sub_f32 v26, 0, v54
    v_sub_f32 v27, 0, v54
    v_sub_f32 v28, 0, v55
    v_sub_f32 v29, 0, v55
    v_sub_f32 v30, 0, v55
    v_sub_f32 v31, 0, v55
    v_sub_f32 v32, 0, v52
    v_sub_f32 v33, 0, v52
    v_sub_f32 v34, 0, v52
    v_sub_f32 v35, 0, v52
    v_sub_f32 v36, 0, v53
    v_sub_f32 v37, 0, v53
    v_sub_f32 v38, 0, v53
    v_sub_f32 v39, 0, v53
    v_sub_f32 v40, 0, v54
    v_sub_f32 v41, 0, v54
    v_sub_f32 v42, 0, v54
    v_sub_f32 v43, 0, v54
    v_sub_f32 v44, 0, v55
    v_sub_f32 v45, 0, v55
    v_sub_f32 v46, 0, v55
    v_sub_f32 v47, 0, v55
    v_sub_f32 v8, 0, v52
    v_sub_f32 v9, 0, v53
    v_sub_f32 v10, 0, v54
    v_sub_f32 v11, 0, v55
    s_cmp_ge_u32 s36, s42
    s_cbranch_scc1 k2_prep_84
k2_prepret_85:
    v_mfma_f32_16x16x32_bf16 v[160:163], a[160:163], v[64:67], v[16:19]
    v_sub_f32 v128, v128, v52
    v_sub_f32 v129, v129, v52
    v_sub_f32 v130, v130, v52
    v_mfma_f32_16x16x32_bf16 v[160:163], a[164:167], v[68:71], v[160:163]
    v_exp_f32 v232, v128
    v_sub_f32 v131, v131, v52
    v_mfma_f32_16x16x32_bf16 v[160:163], a[168:171], v[72:75], v[160:163]
    v_exp_f32 v233, v129
    v_sub_f32 v144, v144, v52
    v_mfma_f32_16x16x32_bf16 v[160:163], a[172:175], v[76:79], v[160:163]
    s_add_u32 s36, s36, 32
    s_cmp_eq_u32 s30, 0
    s_cbranch_scc1 k12_ool_78
k12_oolret_79:
    v_sub_f32 v145, v145, v52
    v_mfma_f32_16x16x32_bf16 v[164:167], a[172:175], v[92:95], v[20:23]
    v_exp_f32 v234, v130
    v_cvt_pk_bf16_f32 v192, v232, v233
    v_mfma_f32_16x16x32_bf16 v[164:167], a[168:171], v[88:91], v[164:167]
    v_exp_f32 v235, v131
    v_sub_f32 v146, v146, v52
    v_mfma_f32_16x16x32_bf16 v[164:167], a[164:167], v[84:87], v[164:167]
    v_exp_f32 v236, v144
    v_sub_f32 v147, v147, v52
    v_mfma_f32_16x16x32_bf16 v[164:167], a[160:163], v[80:83], v[164:167]
    v_cvt_pk_bf16_f32 v193, v234, v235
    v_exp_f32 v237, v145
    v_mfma_f32_16x16x32_bf16 v[168:171], a[160:163], v[96:99], v[24:27]
    v_exp_f32 v238, v146
    v_sub_f32 v132, v132, v53
    v_mfma_f32_16x16x32_bf16 v[168:171], a[164:167], v[100:103], v[168:171]
    v_sub_f32 v133, v133, v53
    v_cvt_pk_bf16_f32 v194, v236, v237
    v_or3_b32 v57, v192, v193, v194
    v_mfma_f32_16x16x32_bf16 v[168:171], a[168:171], v[104:107], v[168:171]
    v_exp_f32 v239, v147
    v_sub_f32 v134, v134, v53
    v_mfma_f32_16x16x32_bf16 v[168:171], a[172:175], v[108:111], v[168:171]
    v_exp_f32 v240, v132
    v_sub_f32 v135, v135, v53
    v_mfma_f32_16x16x32_bf16 v[172:175], a[172:175], v[124:127], v[28:31]
    v_cvt_pk_bf16_f32 v195, v238, v239
    v_exp_f32 v241, v133
    v_mfma_f32_16x16x32_bf16 v[172:175], a[168:171], v[120:123], v[172:175]
    v_exp_f32 v242, v134
    v_sub_f32 v148, v148, v53
    v_mfma_f32_16x16x32_bf16 v[172:175], a[164:167], v[116:119], v[172:175]
    v_sub_f32 v149, v149, v53
    v_cvt_pk_bf16_f32 v196, v240, v241
    v_exp_f32 v243, v135
    v_mfma_f32_16x16x32_bf16 v[172:175], a[160:163], v[112:115], v[172:175]
    v_or3_b32 v57, v57, v195, v196
    v_exp_f32 v244, v148
    v_mfma_f32_16x16x32_bf16 v[188:191], a[176:179], v[112:115], v[44:47]
    v_sub_f32 v150, v150, v53
    v_sub_f32 v151, v151, v53
    v_cvt_pk_bf16_f32 v197, v242, v243
    v_mfma_f32_16x16x32_bf16 v[188:191], a[180:183], v[116:119], v[188:191]
    v_exp_f32 v245, v149
    v_exp_f32 v246, v150
    v_mfma_f32_16x16x32_bf16 v[188:191], a[184:187], v[120:123], v[188:191]
    v_sub_f32 v136, v136, v54
    v_sub_f32 v137, v137, v54
    v_cvt_pk_bf16_f32 v198, v244, v245
    v_mfma_f32_16x16x32_bf16 v[188:191], a[188:191], v[124:127], v[188:191]
    v_exp_f32 v247, v151
    v_or3_b32 v57, v57, v197, v198
    v_mfma_f32_16x16x32_bf16 v[184:187], a[188:191], v[108:111], v[40:43]
    v_exp_f32 v232, v136
    v_sub_f32 v138, v138, v54
    v_mfma_f32_16x16x32_bf16 v[184:187], a[184:187], v[104:107], v[184:187]
    ds_read_b128 a[192:195], v3 offset:0
    v_sub_f32 v139, v139, v54
    v_cvt_pk_bf16_f32 v199, v246, v247
    v_mfma_f32_16x16x32_bf16 v[184:187], a[180:183], v[100:103], v[184:187]
    v_exp_f32 v233, v137
    v_exp_f32 v234, v138
    v_mfma_f32_16x16x32_bf16 v[184:187], a[176:179], v[96:99], v[184:187]
    v_sub_f32 v152, v152, v54
    v_sub_f32 v153, v153, v54
    v_cvt_pk_bf16_f32 v200, v232, v233
    v_mfma_f32_16x16x32_bf16 v[180:183], a[176:179], v[80:83], v[36:39]
    v_exp_f32 v235, v139
    v_or3_b32 v57, v57, v199, v200
    v_mfma_f32_16x16x32_bf16 v[180:183], a[180:183], v[84:87], v[180:183]
    v_exp_f32 v236, v152
    v_sub_f32 v154, v154, v54
    v_mfma_f32_16x16x32_bf16 v[180:183], a[184:187], v[88:91], v[180:183]
    v_sub_f32 v155, v155, v54
    v_cvt_pk_bf16_f32 v201, v234, v235
    v_exp_f32 v237, v153
    v_mfma_f32_16x16x32_bf16 v[180:183], a[188:191], v[92:95], v[180:183]
    ds_read_b128 a[196:199], v3 offset:1024
    v_exp_f32 v238, v154
    v_mfma_f32_16x16x32_bf16 v[176:179], a[188:191], v[76:79], v[32:35]
    v_sub_f32 v140, v140, v55
    v_sub_f32 v141, v141, v55
    v_cvt_pk_bf16_f32 v202, v236, v237
    v_mfma_f32_16x16x32_bf16 v[176:179], a[184:187], v[72:75], v[176:179]
    v_exp_f32 v239, v155
    v_or3_b32 v57, v57, v201, v202
    v_mfma_f32_16x16x32_bf16 v[176:179], a[180:183], v[68:71], v[176:179]
    s_cmp_eq_u32 s30, 0
    s_cbranch_scc1 k12_ool_82
k12_oolret_83:
    v_exp_f32 v240, v140
    v_mfma_f32_16x16x32_bf16 v[176:179], a[176:179], v[64:67], v[176:179]
    s_waitcnt vmcnt(8)
    s_barrier
    v_sub_f32 v142, v142, v55
    v_sub_f32 v143, v143, v55
    v_cvt_pk_bf16_f32 v203, v238, v239
    v_exp_f32 v241, v141
    v_exp_f32 v242, v142
    v_sub_f32 v156, v156, v55
    v_sub_f32 v157, v157, v55
    ds_read_b128 a[200:203], v3 offset:2048
    v_cvt_pk_bf16_f32 v204, v240, v241
    v_exp_f32 v243, v143
    v_or3_b32 v57, v57, v203, v204
    v_exp_f32 v244, v156
    v_sub_f32 v158, v158, v55
    v_sub_f32 v159, v159, v55
    v_cvt_pk_bf16_f32 v205, v242, v243
    v_exp_f32 v245, v157
    v_exp_f32 v246, v158
    v_cvt_pk_bf16_f32 v206, v244, v245
    ds_read_b128 a[204:207], v3 offset:3072
    v_exp_f32 v247, v159
    v_or3_b32 v57, v57, v205, v206
    v_cvt_pk_bf16_f32 v207, v246, v247
    v_bitop3_b32 v57, v57, v207, s37 bitop3:0xa8
    v_cmp_ne_u32 vcc, 0, v57
    s_cbranch_vccnz k2_tramp_86
k2_ret_87:
    s_mov_b32 s24, s60
    s_and_b32 s25, s61, 0xffff
    s_mov_b32 s26, s55
    s_lshl_b32 s63, s29, 1
    s_sub_u32 s63, s63, 1
    s_cbranch_scc1 k2_dm3_89
k2_dloop_88:
    v_mfma_f32_16x16x32_bf16 v[12:15], v[60:63], v[192:195], v[12:15]
    v_exp_f32 v232, v160
    v_mfma_f32_16x16x32_bf16 v[48:51], v[60:63], v[196:199], v[48:51]
    s_mov_b32 m0, s34
    ds_read_b128 a[208:211], v3 offset:4096
    v_mfma_f32_16x16x32_bf16 v[248:251], v[60:63], v[200:203], v[248:251]
    s_add_u32 s53, s53, 8192
    buffer_load_dwordx4 v1, s[16:19], s32 offen offset:0 sc1 lds
    v_mfma_f32_16x16x32_bf16 v[252:255], v[60:63], v[204:207], v[252:255]
    s_waitcnt lgkmcnt(3)
    v_exp_f32 v233, v161
    v_mfma_f32_16x16x32_bf16 a[12:15], a[192:195], v[204:207], a[12:15]
    s_and_b32 s53, s53, 0xffff
    v_exp_f32 v234, v162
    v_mfma_f32_16x16x32_bf16 a[8:11], a[192:195], v[200:203], a[8:11]
    s_add_u32 s34, s34, 0x4000
    ds_read_b128 a[212:215], v3 offset:5120
    v_cvt_pk_bf16_f32 v208, v232, v233
    v_mfma_f32_16x16x32_bf16 a[4:7], a[192:195], v[196:199], a[4:7]
    v_exp_f32 v235, v163
    v_mfma_f32_16x16x32_bf16 a[0:3], a[192:195], v[192:195], a[0:3]
    buffer_load_dwordx4 v1, s[16:19], s32 offen offset:1024 sc1 lds
    v_mfma_f32_16x16x32_bf16 a[16:19], a[196:199], v[192:195], a[16:19]
    v_exp_f32 v236, v176
    v_mfma_f32_16x16x32_bf16 a[20:23], a[196:199], v[196:199], a[20:23]
    ds_read_b128 a[216:219], v3 offset:6144
    v_cvt_pk_bf16_f32 v209, v234, v235
    v_mfma_f32_16x16x32_bf16 a[24:27], a[196:199], v[200:203], a[24:27]
    v_exp_f32 v237, v177
    v_mfma_f32_16x16x32_bf16 a[28:31], a[196:199], v[204:207], a[28:31]
    s_waitcnt lgkmcnt(3)
    v_exp_f32 v238, v178
    v_mfma_f32_16x16x32_bf16 a[44:47], a[200:203], v[204:207], a[44:47]
    s_and_b32 s34, s34, 0xffff
    ds_read_b128 a[220:223], v3 offset:7168
    v_cvt_pk_bf16_f32 v210, v236, v237
    v_mfma_f32_16x16x32_bf16 a[40:43], a[200:203], v[200:203], a[40:43]
    s_and_b32 s60, s62, 31
    buffer_load_dwordx4 v1, s[16:19], s32 offen offset:2048 sc1 lds
    v_mfma_f32_16x16x32_bf16 a[36:39], a[200:203], v[196:199], a[36:39]
    v_exp_f32 v239, v179
    v_mfma_f32_16x16x32_bf16 a[32:35], a[200:203], v[192:195], a[32:35]
    s_lshr_b32 s61, s62, 5
    v_or3_b32 v57, v208, v209, v210
    v_add_u32 v3, s53, v56
    v_mfma_f32_16x16x32_bf16 a[48:51], a[204:207], v[192:195], a[48:51]
    v_exp_f32 v240, v164
    v_mfma_f32_16x16x32_bf16 a[52:55], a[204:207], v[196:199], a[52:55]
    ds_read_b128 a[128:131], v2 offset:0
    v_cvt_pk_bf16_f32 v211, v238, v239
    v_mfma_f32_16x16x32_bf16 a[56:59], a[204:207], v[200:203], a[56:59]
    s_mul_i32 s57, s60, 229376
    v_exp_f32 v241, v165
    v_mfma_f32_16x16x32_bf16 a[60:63], a[204:207], v[204:207], a[60:63]
    s_waitcnt lgkmcnt(3)
    buffer_load_dwordx4 v1, s[16:19], s32 offen offset:3072 sc1 lds
    v_mfma_f32_16x16x32_bf16 a[76:79], a[208:211], v[204:207], a[76:79]
    s_add_u32 s32, s32, 0x80000
    v_exp_f32 v242, v166
    v_mfma_f32_16x16x32_bf16 a[72:75], a[208:211], v[200:203], a[72:75]
    s_lshl_b32 s4, s61, 7
    ds_read_b128 a[132:135], v2 offset:1024
    v_cvt_pk_bf16_f32 v212, v240, v241
    v_mfma_f32_16x16x32_bf16 a[68:71], a[208:211], v[196:199], a[68:71]
    v_exp_f32 v243, v167
    v_mfma_f32_16x16x32_bf16 a[64:67], a[208:211], v[192:195], a[64:67]
    s_add_u32 s57, s57, s4
    v_or3_b32 v57, v57, v211, v212
    v_cvt_pk_bf16_f32 v213, v242, v243
    v_mfma_f32_16x16x32_bf16 a[80:83], a[212:215], v[192:195], a[80:83]
    s_waitcnt vmcnt(9)
    v_exp_f32 v244, v180
    v_mfma_f32_16x16x32_bf16 a[84:87], a[212:215], v[196:199], a[84:87]
    buffer_store_dwordx4 a[224:227], v229, s[8:11], s58 offen offset:0 sc1
    ds_read_b128 a[136:139], v2 offset:2048
    v_mfma_f32_16x16x32_bf16 a[88:91], a[212:215], v[200:203], a[88:91]
    s_add_u32 s56, s57, 57344
    v_exp_f32 v245, v181
    v_mfma_f32_16x16x32_bf16 a[92:95], a[212:215], v[204:207], a[92:95]
    s_waitcnt lgkmcnt(3)
    v_exp_f32 v246, v182
    v_mfma_f32_16x16x32_bf16 a[108:111], a[216:219], v[204:207], a[108:111]
    ds_read_b128 a[140:143], v2 offset:3072
    v_cvt_pk_bf16_f32 v214, v244, v245
    v_mfma_f32_16x16x32_bf16 a[104:107], a[216:219], v[200:203], a[104:107]
    s_add_u32 s62, s62, 1
    v_exp_f32 v247, v183
    v_mfma_f32_16x16x32_bf16 a[100:103], a[216:219], v[196:199], a[100:103]
    v_or3_b32 v57, v57, v213, v214
    v_mfma_f32_16x16x32_bf16 a[96:99], a[216:219], v[192:195], a[96:99]
    v_exp_f32 v232, v168
    v_mfma_f32_16x16x32_bf16 a[112:115], a[220:223], v[192:195], a[112:115]
    ds_read_b128 a[144:147], v2 offset:4096
    v_cvt_pk_bf16_f32 v215, v246, v247
    v_mfma_f32_16x16x32_bf16 a[116:119], a[220:223], v[196:199], a[116:119]
    buffer_store_dwordx4 a[228:231], v229, s[8:11], s58 offen offset:256 sc1
    v_mfma_f32_16x16x32_bf16 a[120:123], a[220:223], v[200:203], a[120:123]
    v_exp_f32 v233, v169
    v_mfma_f32_16x16x32_bf16 a[124:127], a[220:223], v[204:207], a[124:127]
    s_waitcnt lgkmcnt(3)
    v_exp_f32 v234, v170
    v_mfma_f32_16x16x32_bf16 v[128:131], a[128:131], v[64:67], v[16:19]
    ds_read_b128 a[148:151], v2 offset:5120
    v_cvt_pk_bf16_f32 v216, v232, v233
    v_mfma_f32_16x16x32_bf16 v[128:131], a[132:135], v[68:71], v[128:131]
    s_waitcnt lgkmcnt(2)
    v_exp_f32 v235, v171
    v_mfma_f32_16x16x32_bf16 v[128:131], a[136:139], v[72:75], v[128:131]
    v_or3_b32 v57, v57, v215, v216
    v_mfma_f32_16x16x32_bf16 v[128:131], a[140:143], v[76:79], v[128:131]
    s_add_u32 s36, s36, 32
    v_exp_f32 v236, v184
    v_mfma_f32_16x16x32_bf16 v[132:135], a[140:143], v[92:95], v[20:23]
    ds_read_b128 a[152:155], v2 offset:6144
    v_cvt_pk_bf16_f32 v217, v234, v235
    v_mfma_f32_16x16x32_bf16 v[132:135], a[136:139], v[88:91], v[132:135]
    s_lshl_b32 s58, s61, 17
    buffer_load_dwordx4 a[224:227], v228, s[12:15], s57 offen nt
    v_mfma_f32_16x16x32_bf16 v[132:135], a[132:135], v[84:87], v[132:135]
    s_add_u32 s52, s52, 8192
    v_exp_f32 v237, v185
    v_mfma_f32_16x16x32_bf16 v[132:135], a[128:131], v[80:83], v[132:135]
    v_exp_f32 v238, v186
    v_mfma_f32_16x16x32_bf16 v[136:139], a[128:131], v[96:99], v[24:27]
    s_lshl_b32 s60, s60, 10
    ds_read_b128 a[156:159], v2 offset:7168
    v_cvt_pk_bf16_f32 v218, v236, v237
    v_mfma_f32_16x16x32_bf16 v[136:139], a[132:135], v[100:103], v[136:139]
    s_and_b32 s52, s52, 0xffff
    v_exp_f32 v239, v187
    v_mfma_f32_16x16x32_bf16 v[136:139], a[136:139], v[104:107], v[136:139]
    v_or3_b32 v57, v57, v217, v218
    v_mfma_f32_16x16x32_bf16 v[136:139], a[140:143], v[108:111], v[136:139]
    v_add_u32 v2, s52, v1
    v_cvt_pk_bf16_f32 v219, v238, v239
    v_mfma_f32_16x16x32_bf16 v[140:143], a[140:143], v[124:127], v[28:31]
    s_add_u32 s58, s58, s60
    v_exp_f32 v240, v172
    v_mfma_f32_16x16x32_bf16 v[140:143], a[136:139], v[120:123], v[140:143]
    buffer_load_dwordx4 a[228:231], v228, s[12:15], s56 offen nt
    v_mfma_f32_16x16x32_bf16 v[140:143], a[132:135], v[116:119], v[140:143]
    v_exp_f32 v241, v173
    v_mfma_f32_16x16x32_bf16 v[140:143], a[128:131], v[112:115], v[140:143]
    s_waitcnt lgkmcnt(2)
    ds_read_b128 a[192:195], v3 offset:0
    v_cvt_pk_bf16_f32 v220, v240, v241
    v_mfma_f32_16x16x32_bf16 v[156:159], a[144:147], v[112:115], v[44:47]
    s_mov_b32 s10, s59
    v_exp_f32 v242, v174
    v_mfma_f32_16x16x32_bf16 v[156:159], a[148:151], v[116:119], v[156:159]
    s_waitcnt lgkmcnt(1)
    v_exp_f32 v243, v175
    v_mfma_f32_16x16x32_bf16 v[156:159], a[152:155], v[120:123], v[156:159]
    ds_read_b128 a[196:199], v3 offset:1024
    v_or3_b32 v57, v57, v219, v220
    v_mfma_f32_16x16x32_bf16 v[156:159], a[156:159], v[124:127], v[156:159]
    v_exp_f32 v244, v188
    v_mfma_f32_16x16x32_bf16 v[152:155], a[156:159], v[108:111], v[40:43]
    v_cvt_pk_bf16_f32 v221, v242, v243
    v_mfma_f32_16x16x32_bf16 v[152:155], a[152:155], v[104:107], v[152:155]
    buffer_load_dword v7, v230, s[24:27], s54 offen
    v_mfma_f32_16x16x32_bf16 v[152:155], a[148:151], v[100:103], v[152:155]
    v_exp_f32 v245, v189
    v_mfma_f32_16x16x32_bf16 v[152:155], a[144:147], v[96:99], v[152:155]
    ds_read_b128 a[200:203], v3 offset:2048
    v_cvt_pk_bf16_f32 v222, v244, v245
    v_mfma_f32_16x16x32_bf16 v[148:151], a[144:147], v[80:83], v[36:39]
    v_exp_f32 v246, v190
    v_mfma_f32_16x16x32_bf16 v[148:151], a[148:151], v[84:87], v[148:151]
    v_exp_f32 v247, v191
    v_mfma_f32_16x16x32_bf16 v[148:151], a[152:155], v[88:91], v[148:151]
    ds_read_b128 a[204:207], v3 offset:3072
    v_or3_b32 v57, v57, v221, v222
    v_mfma_f32_16x16x32_bf16 v[148:151], a[156:159], v[92:95], v[148:151]
    v_cvt_pk_bf16_f32 v223, v246, v247
    v_mfma_f32_16x16x32_bf16 v[144:147], a[156:159], v[76:79], v[32:35]
    s_add_u32 s54, s54, 4096
    v_mfma_f32_16x16x32_bf16 v[144:147], a[152:155], v[72:75], v[144:147]
    v_bitop3_b32 v57, v57, v223, s37 bitop3:0xa8
    v_cmp_ne_u32 vcc, 0, v57
    v_mfma_f32_16x16x32_bf16 v[144:147], a[148:151], v[68:71], v[144:147]
    v_mfma_f32_16x16x32_bf16 v[144:147], a[144:147], v[64:67], v[144:147]
    s_cbranch_vccnz k2_tramp_90
k2_ret_91:
    v_mfma_f32_16x16x32_bf16 v[12:15], v[60:63], v[208:211], v[12:15]
    v_exp_f32 v232, v128
    v_mfma_f32_16x16x32_bf16 v[48:51], v[60:63], v[212:215], v[48:51]
    s_mov_b32 m0, s35
    ds_read_b128 a[208:211], v3 offset:4096
    v_mfma_f32_16x16x32_bf16 v[248:251], v[60:63], v[216:219], v[248:251]
    s_add_u32 s53, s53, 8192
    buffer_load_dwordx4 v1, s[20:23], s33 offen offset:0 sc1 lds
    v_mfma_f32_16x16x32_bf16 v[252:255], v[60:63], v[220:223], v[252:255]
    s_waitcnt lgkmcnt(3)
    v_exp_f32 v233, v129
    v_mfma_f32_16x16x32_bf16 a[12:15], a[192:195], v[220:223], a[12:15]
    s_and_b32 s53, s53, 0xffff
    v_exp_f32 v234, v130
    v_mfma_f32_16x16x32_bf16 a[8:11], a[192:195], v[216:219], a[8:11]
    ds_read_b128 a[212:215], v3 offset:5120
    v_cvt_pk_bf16_f32 v192, v232, v233
    v_mfma_f32_16x16x32_bf16 a[4:7], a[192:195], v[212:215], a[4:7]
    v_exp_f32 v235, v131
    v_mfma_f32_16x16x32_bf16 a[0:3], a[192:195], v[208:211], a[0:3]
    v_exp_f32 v236, v144
    v_mfma_f32_16x16x32_bf16 a[16:19], a[196:199], v[208:211], a[16:19]
    ds_read_b128 a[216:219], v3 offset:6144
    v_cvt_pk_bf16_f32 v193, v234, v235
    v_mfma_f32_16x16x32_bf16 a[20:23], a[196:199], v[212:215], a[20:23]
    v_exp_f32 v237, v145
    v_mfma_f32_16x16x32_bf16 a[24:27], a[196:199], v[216:219], a[24:27]
    v_mfma_f32_16x16x32_bf16 a[28:31], a[196:199], v[220:223], a[28:31]
    s_waitcnt lgkmcnt(3)
    v_exp_f32 v238, v146
    v_mfma_f32_16x16x32_bf16 a[44:47], a[200:203], v[220:223], a[44:47]
    ds_read_b128 a[220:223], v3 offset:7168
    v_cvt_pk_bf16_f32 v194, v236, v237
    v_mfma_f32_16x16x32_bf16 a[40:43], a[200:203], v[216:219], a[40:43]
    v_exp_f32 v239, v147
    v_mfma_f32_16x16x32_bf16 a[36:39], a[200:203], v[212:215], a[36:39]
    v_or3_b32 v57, v192, v193, v194
    v_mfma_f32_16x16x32_bf16 a[32:35], a[200:203], v[208:211], a[32:35]
    s_add_u32 s35, s35, 0x4000
    v_add_u32 v3, s53, v56
    v_cvt_pk_bf16_f32 v195, v238, v239
    v_mfma_f32_16x16x32_bf16 a[48:51], a[204:207], v[208:211], a[48:51]
    v_exp_f32 v240, v132
    v_mfma_f32_16x16x32_bf16 a[52:55], a[204:207], v[212:215], a[52:55]
    buffer_load_dwordx4 v1, s[20:23], s33 offen offset:1024 sc1 lds
    ds_read_b128 a[128:131], v2 offset:0
    v_mfma_f32_16x16x32_bf16 a[56:59], a[204:207], v[216:219], a[56:59]
    v_exp_f32 v241, v133
    v_mfma_f32_16x16x32_bf16 a[60:63], a[204:207], v[220:223], a[60:63]
    s_waitcnt lgkmcnt(3)
    v_exp_f32 v242, v134
    v_mfma_f32_16x16x32_bf16 a[76:79], a[208:211], v[220:223], a[76:79]
    ds_read_b128 a[132:135], v2 offset:1024
    v_cvt_pk_bf16_f32 v196, v240, v241
    v_mfma_f32_16x16x32_bf16 a[72:75], a[208:211], v[216:219], a[72:75]
    v_exp_f32 v243, v135
    v_mfma_f32_16x16x32_bf16 a[68:71], a[208:211], v[212:215], a[68:71]
    v_or3_b32 v57, v57, v195, v196
    v_mfma_f32_16x16x32_bf16 a[64:67], a[208:211], v[208:211], a[64:67]
    v_exp_f32 v244, v148
    v_mfma_f32_16x16x32_bf16 a[80:83], a[212:215], v[208:211], a[80:83]
    ds_read_b128 a[136:139], v2 offset:2048
    v_cvt_pk_bf16_f32 v197, v242, v243
    v_mfma_f32_16x16x32_bf16 a[84:87], a[212:215], v[212:215], a[84:87]
    v_exp_f32 v245, v149
    v_mfma_f32_16x16x32_bf16 a[88:91], a[212:215], v[216:219], a[88:91]
    v_mfma_f32_16x16x32_bf16 a[92:95], a[212:215], v[220:223], a[92:95]
    s_waitcnt lgkmcnt(3)
    v_exp_f32 v246, v150
    v_mfma_f32_16x16x32_bf16 a[108:111], a[216:219], v[220:223], a[108:111]
    ds_read_b128 a[140:143], v2 offset:3072
    v_cvt_pk_bf16_f32 v198, v244, v245
    v_mfma_f32_16x16x32_bf16 a[104:107], a[216:219], v[216:219], a[104:107]
    v_exp_f32 v247, v151
    v_mfma_f32_16x16x32_bf16 a[100:103], a[216:219], v[212:215], a[100:103]
    v_or3_b32 v57, v57, v197, v198
    v_mfma_f32_16x16x32_bf16 a[96:99], a[216:219], v[208:211], a[96:99]
    s_and_b32 s35, s35, 0xffff
    v_exp_f32 v232, v136
    v_mfma_f32_16x16x32_bf16 a[112:115], a[220:223], v[208:211], a[112:115]
    ds_read_b128 a[144:147], v2 offset:4096
    v_cvt_pk_bf16_f32 v199, v246, v247
    v_mfma_f32_16x16x32_bf16 a[116:119], a[220:223], v[212:215], a[116:119]
    buffer_load_dwordx4 v1, s[20:23], s33 offen offset:2048 sc1 lds
    v_mfma_f32_16x16x32_bf16 a[120:123], a[220:223], v[216:219], a[120:123]
    v_exp_f32 v233, v137
    v_mfma_f32_16x16x32_bf16 a[124:127], a[220:223], v[220:223], a[124:127]
    s_waitcnt lgkmcnt(3)
    v_exp_f32 v234, v138
    v_mfma_f32_16x16x32_bf16 v[160:163], a[128:131], v[64:67], v[16:19]
    ds_read_b128 a[148:151], v2 offset:5120
    v_cvt_pk_bf16_f32 v200, v232, v233
    v_mfma_f32_16x16x32_bf16 v[160:163], a[132:135], v[68:71], v[160:163]
    s_waitcnt lgkmcnt(2)
    v_exp_f32 v235, v139
    v_mfma_f32_16x16x32_bf16 v[160:163], a[136:139], v[72:75], v[160:163]
    v_or3_b32 v57, v57, v199, v200
    v_mfma_f32_16x16x32_bf16 v[160:163], a[140:143], v[76:79], v[160:163]
    s_or_b32 s35, s35, 0x10000
    v_exp_f32 v236, v152
    v_mfma_f32_16x16x32_bf16 v[164:167], a[140:143], v[92:95], v[20:23]
    s_add_u32 s36, s36, 32
    ds_read_b128 a[152:155], v2 offset:6144
    v_cvt_pk_bf16_f32 v201, v234, v235
    v_mfma_f32_16x16x32_bf16 v[164:167], a[136:139], v[88:91], v[164:167]
    v_exp_f32 v237, v153
    v_mfma_f32_16x16x32_bf16 v[164:167], a[132:135], v[84:87], v[164:167]
    s_add_u32 s52, s52, 8192
    v_mfma_f32_16x16x32_bf16 v[164:167], a[128:131], v[80:83], v[164:167]
    v_exp_f32 v238, v154
    v_mfma_f32_16x16x32_bf16 v[168:171], a[128:131], v[96:99], v[24:27]
    s_and_b32 s52, s52, 0xffff
    ds_read_b128 a[156:159], v2 offset:7168
    v_cvt_pk_bf16_f32 v202, v236, v237
    v_mfma_f32_16x16x32_bf16 v[168:171], a[132:135], v[100:103], v[168:171]
    v_exp_f32 v239, v155
    v_mfma_f32_16x16x32_bf16 v[168:171], a[136:139], v[104:107], v[168:171]
    v_or3_b32 v57, v57, v201, v202
    v_mfma_f32_16x16x32_bf16 v[168:171], a[140:143], v[108:111], v[168:171]
    v_add_u32 v2, s52, v1
    v_cvt_pk_bf16_f32 v203, v238, v239
    v_mfma_f32_16x16x32_bf16 v[172:175], a[140:143], v[124:127], v[28:31]
    v_exp_f32 v240, v140
    v_mfma_f32_16x16x32_bf16 v[172:175], a[136:139], v[120:123], v[172:175]
    buffer_load_dwordx4 v1, s[20:23], s33 offen offset:3072 sc1 lds
    v_mfma_f32_16x16x32_bf16 v[172:175], a[132:135], v[116:119], v[172:175]
    s_add_u32 s33, s33, 0x80000
    v_exp_f32 v241, v141
    v_mfma_f32_16x16x32_bf16 v[172:175], a[128:131], v[112:115], v[172:175]
    s_waitcnt lgkmcnt(2)
    ds_read_b128 a[192:195], v3 offset:0
    v_cvt_pk_bf16_f32 v204, v240, v241
    v_mfma_f32_16x16x32_bf16 v[188:191], a[144:147], v[112:115], v[44:47]
    v_exp_f32 v242, v142
    v_mfma_f32_16x16x32_bf16 v[188:191], a[148:151], v[116:119], v[188:191]
    s_waitcnt lgkmcnt(1)
    v_exp_f32 v243, v143
    v_mfma_f32_16x16x32_bf16 v[188:191], a[152:155], v[120:123], v[188:191]
    ds_read_b128 a[196:199], v3 offset:1024
    v_or3_b32 v57, v57, v203, v204
    v_mfma_f32_16x16x32_bf16 v[188:191], a[156:159], v[124:127], v[188:191]
    v_exp_f32 v244, v156
    v_mfma_f32_16x16x32_bf16 v[184:187], a[156:159], v[108:111], v[40:43]
    v_cvt_pk_bf16_f32 v205, v242, v243
    v_mfma_f32_16x16x32_bf16 v[184:187], a[152:155], v[104:107], v[184:187]
    v_exp_f32 v245, v157
    v_mfma_f32_16x16x32_bf16 v[184:187], a[148:151], v[100:103], v[184:187]
    ds_read_b128 a[200:203], v3 offset:2048
    v_mfma_f32_16x16x32_bf16 v[184:187], a[144:147], v[96:99], v[184:187]
    s_sub_u32 s63, s63, 1
    v_exp_f32 v246, v158
    v_mfma_f32_16x16x32_bf16 v[180:183], a[144:147], v[80:83], v[36:39]
    v_cvt_pk_bf16_f32 v206, v244, v245
    v_mfma_f32_16x16x32_bf16 v[180:183], a[148:151], v[84:87], v[180:183]
    v_exp_f32 v247, v159
    v_mfma_f32_16x16x32_bf16 v[180:183], a[152:155], v[88:91], v[180:183]
    ds_read_b128 a[204:207], v3 offset:3072
    v_or3_b32 v57, v57, v205, v206
    v_mfma_f32_16x16x32_bf16 v[180:183], a[156:159], v[92:95], v[180:183]
    v_cvt_pk_bf16_f32 v207, v246, v247
    v_mfma_f32_16x16x32_bf16 v[176:179], a[156:159], v[76:79], v[32:35]
    v_mfma_f32_16x16x32_bf16 v[176:179], a[152:155], v[72:75], v[176:179]
    v_bitop3_b32 v57, v57, v207, s37 bitop3:0xa8
    v_cmp_ne_u32 vcc, 0, v57
    v_mfma_f32_16x16x32_bf16 v[176:179], a[148:151], v[68:71], v[176:179]
    v_mfma_f32_16x16x32_bf16 v[176:179], a[144:147], v[64:67], v[176:179]
    s_waitcnt vmcnt(13)
    s_barrier
    s_cbranch_vccnz k2_tramp_92
k2_ret_93:
    s_cmp_lg_u32 s63, 0
    s_cbranch_scc1 k2_dloop_88
    v_mfma_f32_16x16x32_bf16 v[12:15], v[60:63], v[192:195], v[12:15]
    v_exp_f32 v232, v160
    v_mfma_f32_16x16x32_bf16 v[48:51], v[60:63], v[196:199], v[48:51]
    s_mov_b32 m0, s34
    ds_read_b128 a[208:211], v3 offset:4096
    v_mfma_f32_16x16x32_bf16 v[248:251], v[60:63], v[200:203], v[248:251]
    s_add_u32 s53, s53, 8192
    buffer_load_dwordx4 v1, s[16:19], s32 offen offset:0 sc1 lds
    v_mfma_f32_16x16x32_bf16 v[252:255], v[60:63], v[204:207], v[252:255]
    s_waitcnt lgkmcnt(3)
    v_exp_f32 v233, v161
    v_mfma_f32_16x16x32_bf16 a[12:15], a[192:195], v[204:207], a[12:15]
    s_sub_u32 s40, s36, s38
    v_exp_f32 v234, v162
    v_mfma_f32_16x16x32_bf16 a[8:11], a[192:195], v[200:203], a[8:11]
    s_and_b32 s53, s53, 0xffff
    ds_read_b128 a[212:215], v3 offset:5120
    v_cvt_pk_bf16_f32 v208, v232, v233
    v_mfma_f32_16x16x32_bf16 a[4:7], a[192:195], v[196:199], a[4:7]
    s_add_u32 s34, s34, 0x4000
    v_subrev_u32 v6, s40, v4
    v_cmp_gt_i32 s[44:45], 0, v6
    v_mfma_f32_16x16x32_bf16 a[0:3], a[192:195], v[192:195], a[0:3]
    v_exp_f32 v235, v163
    v_mfma_f32_16x16x32_bf16 a[16:19], a[196:199], v[192:195], a[16:19]
    buffer_load_dwordx4 v1, s[16:19], s32 offen offset:1024 sc1 lds
    ds_read_b128 a[216:219], v3 offset:6144
    v_mfma_f32_16x16x32_bf16 a[20:23], a[196:199], v[196:199], a[20:23]
    v_exp_f32 v236, v176
    v_mfma_f32_16x16x32_bf16 a[24:27], a[196:199], v[200:203], a[24:27]
    v_cmp_gt_i32 s[46:47], 1, v6
    v_cvt_pk_bf16_f32 v209, v234, v235
    v_mfma_f32_16x16x32_bf16 a[28:31], a[196:199], v[204:207], a[28:31]
    s_waitcnt lgkmcnt(3)
    v_cmp_gt_i32 s[48:49], 2, v6
    v_cmp_gt_i32 s[50:51], 3, v6
    v_mfma_f32_16x16x32_bf16 a[44:47], a[200:203], v[204:207], a[44:47]
    s_and_b32 s34, s34, 0xffff
    v_exp_f32 v237, v177
    v_mfma_f32_16x16x32_bf16 a[40:43], a[200:203], v[200:203], a[40:43]
    s_and_b32 s60, s62, 31
    v_exp_f32 v238, v178
    v_mfma_f32_16x16x32_bf16 a[36:39], a[200:203], v[196:199], a[36:39]
    ds_read_b128 a[220:223], v3 offset:7168
    v_cvt_pk_bf16_f32 v210, v236, v237
    v_mfma_f32_16x16x32_bf16 a[32:35], a[200:203], v[192:195], a[32:35]
    s_lshr_b32 s61, s62, 5
    buffer_load_dwordx4 v1, s[16:19], s32 offen offset:2048 sc1 lds
    v_mfma_f32_16x16x32_bf16 a[48:51], a[204:207], v[192:195], a[48:51]
    v_cndmask_b32 v16, v8, v5, s[44:45]
    v_or3_b32 v57, v208, v209, v210
    v_mfma_f32_16x16x32_bf16 a[52:55], a[204:207], v[196:199], a[52:55]
    v_exp_f32 v239, v179
    v_mfma_f32_16x16x32_bf16 a[56:59], a[204:207], v[200:203], a[56:59]
    s_mul_i32 s57, s60, 229376
    v_cndmask_b32 v17, v8, v5, s[46:47]
    v_add_u32 v3, s53, v56
    v_mfma_f32_16x16x32_bf16 a[60:63], a[204:207], v[204:207], a[60:63]
    s_waitcnt lgkmcnt(2)
    v_exp_f32 v240, v164
    v_mfma_f32_16x16x32_bf16 a[76:79], a[208:211], v[204:207], a[76:79]
    v_cvt_pk_bf16_f32 v211, v238, v239
    v_cndmask_b32 v18, v8, v5, s[48:49]
    v_mfma_f32_16x16x32_bf16 a[72:75], a[208:211], v[200:203], a[72:75]
    s_lshl_b32 s4, s61, 7
    ds_read_b128 a[128:131], v2 offset:0
    v_cndmask_b32 v19, v8, v5, s[50:51]
    v_mfma_f32_16x16x32_bf16 a[68:71], a[208:211], v[196:199], a[68:71]
    v_exp_f32 v241, v165
    v_mfma_f32_16x16x32_bf16 a[64:67], a[208:211], v[192:195], a[64:67]
    s_add_u32 s57, s57, s4
    buffer_load_dwordx4 v1, s[16:19], s32 offen offset:3072 sc1 lds
    s_add_u32 s32, s32, 0x80000
    v_mfma_f32_16x16x32_bf16 a[80:83], a[212:215], v[192:195], a[80:83]
    s_waitcnt vmcnt(9)
    v_cmp_gt_i32 s[44:45], 16, v6
    v_exp_f32 v242, v166
    v_mfma_f32_16x16x32_bf16 a[84:87], a[212:215], v[196:199], a[84:87]
    ds_read_b128 a[132:135], v2 offset:1024
    v_cvt_pk_bf16_f32 v212, v240, v241
    v_mfma_f32_16x16x32_bf16 a[88:91], a[212:215], v[200:203], a[88:91]
    s_add_u32 s56, s57, 57344
    v_cmp_gt_i32 s[46:47], 17, v6
    v_exp_f32 v243, v167
    v_mfma_f32_16x16x32_bf16 a[92:95], a[212:215], v[204:207], a[92:95]
    s_waitcnt lgkmcnt(2)
    v_or3_b32 v57, v57, v211, v212
    v_cmp_gt_i32 s[48:49], 18, v6
    v_mfma_f32_16x16x32_bf16 a[108:111], a[216:219], v[204:207], a[108:111]
    v_exp_f32 v244, v180
    v_mfma_f32_16x16x32_bf16 a[104:107], a[216:219], v[200:203], a[104:107]
    s_add_u32 s62, s62, 1
    v_cvt_pk_bf16_f32 v213, v242, v243
    v_cmp_gt_i32 s[50:51], 19, v6
    v_mfma_f32_16x16x32_bf16 a[100:103], a[216:219], v[196:199], a[100:103]
    buffer_store_dwordx4 a[224:227], v229, s[8:11], s58 offen offset:0 sc1
    ds_read_b128 a[136:139], v2 offset:2048
    v_mfma_f32_16x16x32_bf16 a[96:99], a[216:219], v[192:195], a[96:99]
    v_exp_f32 v245, v181
    v_mfma_f32_16x16x32_bf16 a[112:115], a[220:223], v[192:195], a[112:115]
    v_cndmask_b32 v32, v8, v5, s[44:45]
    v_exp_f32 v246, v182
    v_mfma_f32_16x16x32_bf16 a[116:119], a[220:223], v[196:199], a[116:119]
    ds_read_b128 a[140:143], v2 offset:3072
    v_cndmask_b32 v33, v8, v5, s[46:47]
    v_cvt_pk_bf16_f32 v214, v244, v245
    v_cndmask_b32 v34, v8, v5, s[48:49]
    v_cndmask_b32 v35, v8, v5, s[50:51]
    v_mfma_f32_16x16x32_bf16 a[120:123], a[220:223], v[200:203], a[120:123]
    v_exp_f32 v247, v183
    v_mfma_f32_16x16x32_bf16 a[124:127], a[220:223], v[204:207], a[124:127]
    s_waitcnt lgkmcnt(2)
    v_or3_b32 v57, v57, v213, v214
    v_cvt_pk_bf16_f32 v215, v246, v247
    v_mfma_f32_16x16x32_bf16 v[128:131], a[128:131], v[64:67], v[16:19]
    v_exp_f32 v232, v168
    v_mfma_f32_16x16x32_bf16 v[128:131], a[132:135], v[68:71], v[128:131]
    s_waitcnt lgkmcnt(0)
    buffer_store_dwordx4 a[228:231], v229, s[8:11], s58 offen offset:256 sc1
    ds_read_b128 a[144:147], v2 offset:4096
    v_mfma_f32_16x16x32_bf16 v[128:131], a[136:139], v[72:75], v[128:131]
    v_exp_f32 v233, v169
    v_mfma_f32_16x16x32_bf16 v[128:131], a[140:143], v[76:79], v[128:131]
    s_add_u32 s36, s36, 32
    v_exp_f32 v234, v170
    v_mfma_f32_16x16x32_bf16 v[132:135], a[140:143], v[92:95], v[20:23]
    ds_read_b128 a[148:151], v2 offset:5120
    v_cvt_pk_bf16_f32 v216, v232, v233
    v_mfma_f32_16x16x32_bf16 v[132:135], a[136:139], v[88:91], v[132:135]
    s_lshl_b32 s58, s61, 17
    v_exp_f32 v235, v171
    v_mfma_f32_16x16x32_bf16 v[132:135], a[132:135], v[84:87], v[132:135]
    s_add_u32 s52, s52, 8192
    v_or3_b32 v57, v57, v215, v216
    v_cvt_pk_bf16_f32 v217, v234, v235
    v_mfma_f32_16x16x32_bf16 v[132:135], a[128:131], v[80:83], v[132:135]
    v_exp_f32 v236, v184
    v_mfma_f32_16x16x32_bf16 v[136:139], a[128:131], v[96:99], v[24:27]
    s_lshl_b32 s60, s60, 10
    buffer_load_dwordx4 a[224:227], v228, s[12:15], s57 offen nt
    ds_read_b128 a[152:155], v2 offset:6144
    v_mfma_f32_16x16x32_bf16 v[136:139], a[132:135], v[100:103], v[136:139]
    s_and_b32 s52, s52, 0xffff
    v_exp_f32 v237, v185
    v_mfma_f32_16x16x32_bf16 v[136:139], a[136:139], v[104:107], v[136:139]
    v_exp_f32 v238, v186
    v_mfma_f32_16x16x32_bf16 v[136:139], a[140:143], v[108:111], v[136:139]
    ds_read_b128 a[156:159], v2 offset:7168
    v_cvt_pk_bf16_f32 v218, v236, v237
    v_mfma_f32_16x16x32_bf16 v[140:143], a[140:143], v[124:127], v[28:31]
    s_add_u32 s58, s58, s60
    v_exp_f32 v239, v187
    v_mfma_f32_16x16x32_bf16 v[140:143], a[136:139], v[120:123], v[140:143]
    v_or3_b32 v57, v57, v217, v218
    v_add_u32 v2, s52, v1
    v_mfma_f32_16x16x32_bf16 v[140:143], a[132:135], v[116:119], v[140:143]
    v_exp_f32 v240, v172
    v_mfma_f32_16x16x32_bf16 v[140:143], a[128:131], v[112:115], v[140:143]
    s_waitcnt lgkmcnt(2)
    ds_read_b128 a[192:195], v3 offset:0
    v_cvt_pk_bf16_f32 v219, v238, v239
    v_mfma_f32_16x16x32_bf16 v[156:159], a[144:147], v[112:115], v[44:47]
    s_mov_b32 s10, s59
    buffer_load_dwordx4 a[228:231], v228, s[12:15], s56 offen nt
    v_mfma_f32_16x16x32_bf16 v[156:159], a[148:151], v[116:119], v[156:159]
    s_waitcnt lgkmcnt(1)
    v_exp_f32 v241, v173
    v_mfma_f32_16x16x32_bf16 v[156:159], a[152:155], v[120:123], v[156:159]
    v_exp_f32 v242, v174
    v_mfma_f32_16x16x32_bf16 v[156:159], a[156:159], v[124:127], v[156:159]
    v_cvt_pk_bf16_f32 v220, v240, v241
    v_or3_b32 v57, v57, v219, v220
    v_mfma_f32_16x16x32_bf16 v[152:155], a[156:159], v[108:111], v[40:43]
    v_exp_f32 v243, v175
    v_mfma_f32_16x16x32_bf16 v[152:155], a[152:155], v[104:107], v[152:155]
    ds_read_b128 a[196:199], v3 offset:1024
    v_cvt_pk_bf16_f32 v221, v242, v243
    v_mfma_f32_16x16x32_bf16 v[152:155], a[148:151], v[100:103], v[152:155]
    v_exp_f32 v244, v188
    v_mfma_f32_16x16x32_bf16 v[152:155], a[144:147], v[96:99], v[152:155]
    buffer_load_dword v7, v230, s[24:27], s54 offen
    ds_read_b128 a[200:203], v3 offset:2048
    v_mfma_f32_16x16x32_bf16 v[148:151], a[144:147], v[80:83], v[36:39]
    v_exp_f32 v245, v189
    v_mfma_f32_16x16x32_bf16 v[148:151], a[148:151], v[84:87], v[148:151]
    v_exp_f32 v246, v190
    v_mfma_f32_16x16x32_bf16 v[148:151], a[152:155], v[88:91], v[148:151]
    v_cvt_pk_bf16_f32 v222, v244, v245
    v_or3_b32 v57, v57, v221, v222
    v_mfma_f32_16x16x32_bf16 v[148:151], a[156:159], v[92:95], v[148:151]
    v_exp_f32 v247, v191
    v_mfma_f32_16x16x32_bf16 v[144:147], a[156:159], v[76:79], v[32:35]
    s_add_u32 s54, s54, 4096
    ds_read_b128 a[204:207], v3 offset:3072
    v_cvt_pk_bf16_f32 v223, v246, v247
    v_mfma_f32_16x16x32_bf16 v[144:147], a[152:155], v[72:75], v[144:147]
    v_bitop3_b32 v57, v57, v223, s37 bitop3:0xa8
    v_cmp_ne_u32 vcc, 0, v57
    v_mfma_f32_16x16x32_bf16 v[144:147], a[148:151], v[68:71], v[144:147]
    v_mfma_f32_16x16x32_bf16 v[144:147], a[144:147], v[64:67], v[144:147]
    s_cbranch_vccnz k2_tramp_94
k2_ret_95:
    v_mfma_f32_16x16x32_bf16 v[12:15], v[60:63], v[208:211], v[12:15]
    v_exp_f32 v232, v128
    v_mfma_f32_16x16x32_bf16 v[48:51], v[60:63], v[212:215], v[48:51]
    s_mov_b32 m0, s35
    ds_read_b128 a[208:211], v3 offset:4096
    v_mfma_f32_16x16x32_bf16 v[248:251], v[60:63], v[216:219], v[248:251]
    s_add_u32 s53, s53, 8192
    buffer_load_dwordx4 v1, s[20:23], s33 offen offset:0 sc1 lds
    v_mfma_f32_16x16x32_bf16 v[252:255], v[60:63], v[220:223], v[252:255]
    s_waitcnt lgkmcnt(3)
    v_exp_f32 v233, v129
    v_mfma_f32_16x16x32_bf16 a[12:15], a[192:195], v[220:223], a[12:15]
    s_sub_u32 s40, s36, s38
    v_exp_f32 v234, v130
    v_mfma_f32_16x16x32_bf16 a[8:11], a[192:195], v[216:219], a[8:11]
    s_and_b32 s53, s53, 0xffff
    ds_read_b128 a[212:215], v3 offset:5120
    v_cvt_pk_bf16_f32 v192, v232, v233
    v_mfma_f32_16x16x32_bf16 a[4:7], a[192:195], v[212:215], a[4:7]
    v_subrev_u32 v6, s40, v4
    v_cmp_gt_i32 s[44:45], 0, v6
    v_mfma_f32_16x16x32_bf16 a[0:3], a[192:195], v[208:211], a[0:3]
    v_exp_f32 v235, v131
    v_mfma_f32_16x16x32_bf16 a[16:19], a[196:199], v[208:211], a[16:19]
    v_exp_f32 v236, v144
    v_mfma_f32_16x16x32_bf16 a[20:23], a[196:199], v[212:215], a[20:23]
    v_cmp_gt_i32 s[46:47], 1, v6
    v_cvt_pk_bf16_f32 v193, v234, v235
    v_mfma_f32_16x16x32_bf16 a[24:27], a[196:199], v[216:219], a[24:27]
    ds_read_b128 a[216:219], v3 offset:6144
    v_cmp_gt_i32 s[48:49], 2, v6
    v_mfma_f32_16x16x32_bf16 a[28:31], a[196:199], v[220:223], a[28:31]
    s_waitcnt lgkmcnt(3)
    v_exp_f32 v237, v145
    v_mfma_f32_16x16x32_bf16 a[44:47], a[200:203], v[220:223], a[44:47]
    v_cmp_gt_i32 s[50:51], 3, v6
    v_cvt_pk_bf16_f32 v194, v236, v237
    v_mfma_f32_16x16x32_bf16 a[40:43], a[200:203], v[216:219], a[40:43]
    v_exp_f32 v238, v146
    v_mfma_f32_16x16x32_bf16 a[36:39], a[200:203], v[212:215], a[36:39]
    ds_read_b128 a[220:223], v3 offset:7168
    v_cndmask_b32 v16, v8, v5, s[44:45]
    v_mfma_f32_16x16x32_bf16 a[32:35], a[200:203], v[208:211], a[32:35]
    s_add_u32 s35, s35, 0x4000
    v_exp_f32 v239, v147
    v_mfma_f32_16x16x32_bf16 a[48:51], a[204:207], v[208:211], a[48:51]
    v_or3_b32 v57, v192, v193, v194
    v_cndmask_b32 v17, v8, v5, s[46:47]
    v_mfma_f32_16x16x32_bf16 a[52:55], a[204:207], v[212:215], a[52:55]
    v_add_u32 v3, s53, v56
    v_cvt_pk_bf16_f32 v195, v238, v239
    v_mfma_f32_16x16x32_bf16 a[56:59], a[204:207], v[216:219], a[56:59]
    v_exp_f32 v240, v132
    v_mfma_f32_16x16x32_bf16 a[60:63], a[204:207], v[220:223], a[60:63]
    s_waitcnt lgkmcnt(2)
    ds_read_b128 a[128:131], v2 offset:0
    v_cndmask_b32 v18, v8, v5, s[48:49]
    v_mfma_f32_16x16x32_bf16 a[76:79], a[208:211], v[220:223], a[76:79]
    buffer_load_dwordx4 v1, s[20:23], s33 offen offset:1024 sc1 lds
    ds_read_b128 a[132:135], v2 offset:1024
    v_mfma_f32_16x16x32_bf16 a[72:75], a[208:211], v[216:219], a[72:75]
    v_exp_f32 v241, v133
    v_mfma_f32_16x16x32_bf16 a[68:71], a[208:211], v[212:215], a[68:71]
    v_cndmask_b32 v19, v8, v5, s[50:51]
    v_cmp_gt_i32 s[44:45], 16, v6
    v_mfma_f32_16x16x32_bf16 a[64:67], a[208:211], v[208:211], a[64:67]
    v_exp_f32 v242, v134
    v_mfma_f32_16x16x32_bf16 a[80:83], a[212:215], v[208:211], a[80:83]
    v_cvt_pk_bf16_f32 v196, v240, v241
    v_cmp_gt_i32 s[46:47], 17, v6
    v_mfma_f32_16x16x32_bf16 a[84:87], a[212:215], v[212:215], a[84:87]
    v_exp_f32 v243, v135
    v_mfma_f32_16x16x32_bf16 a[88:91], a[212:215], v[216:219], a[88:91]
    v_or3_b32 v57, v57, v195, v196
    v_cmp_gt_i32 s[48:49], 18, v6
    v_mfma_f32_16x16x32_bf16 a[92:95], a[212:215], v[220:223], a[92:95]
    s_waitcnt lgkmcnt(2)
    v_exp_f32 v244, v148
    v_mfma_f32_16x16x32_bf16 a[108:111], a[216:219], v[220:223], a[108:111]
    v_cvt_pk_bf16_f32 v197, v242, v243
    v_cmp_gt_i32 s[50:51], 19, v6
    v_mfma_f32_16x16x32_bf16 a[104:107], a[216:219], v[216:219], a[104:107]
    ds_read_b128 a[136:139], v2 offset:2048
    v_cndmask_b32 v32, v8, v5, s[44:45]
    v_mfma_f32_16x16x32_bf16 a[100:103], a[216:219], v[212:215], a[100:103]
    v_exp_f32 v245, v149
    v_mfma_f32_16x16x32_bf16 a[96:99], a[216:219], v[208:211], a[96:99]
    s_and_b32 s35, s35, 0xffff
    v_exp_f32 v246, v150
    v_mfma_f32_16x16x32_bf16 a[112:115], a[220:223], v[208:211], a[112:115]
    v_cndmask_b32 v33, v8, v5, s[46:47]
    v_cvt_pk_bf16_f32 v198, v244, v245
    v_mfma_f32_16x16x32_bf16 a[116:119], a[220:223], v[212:215], a[116:119]
    ds_read_b128 a[140:143], v2 offset:3072
    v_cndmask_b32 v34, v8, v5, s[48:49]
    v_cndmask_b32 v35, v8, v5, s[50:51]
    v_mfma_f32_16x16x32_bf16 a[120:123], a[220:223], v[216:219], a[120:123]
    v_exp_f32 v247, v151
    v_mfma_f32_16x16x32_bf16 a[124:127], a[220:223], v[220:223], a[124:127]
    s_waitcnt lgkmcnt(2)
    v_or3_b32 v57, v57, v197, v198
    v_cvt_pk_bf16_f32 v199, v246, v247
    v_mfma_f32_16x16x32_bf16 v[160:163], a[128:131], v[64:67], v[16:19]
    v_exp_f32 v232, v136
    v_mfma_f32_16x16x32_bf16 v[160:163], a[132:135], v[68:71], v[160:163]
    s_waitcnt lgkmcnt(0)
    buffer_load_dwordx4 v1, s[20:23], s33 offen offset:2048 sc1 lds
    ds_read_b128 a[144:147], v2 offset:4096
    v_mfma_f32_16x16x32_bf16 v[160:163], a[136:139], v[72:75], v[160:163]
    v_exp_f32 v233, v137
    v_mfma_f32_16x16x32_bf16 v[160:163], a[140:143], v[76:79], v[160:163]
    s_or_b32 s35, s35, 0x10000
    v_exp_f32 v234, v138
    v_mfma_f32_16x16x32_bf16 v[164:167], a[140:143], v[92:95], v[20:23]
    s_add_u32 s36, s36, 32
    ds_read_b128 a[148:151], v2 offset:5120
    v_cvt_pk_bf16_f32 v200, v232, v233
    v_mfma_f32_16x16x32_bf16 v[164:167], a[136:139], v[88:91], v[164:167]
    v_exp_f32 v235, v139
    v_mfma_f32_16x16x32_bf16 v[164:167], a[132:135], v[84:87], v[164:167]
    s_add_u32 s52, s52, 8192
    v_or3_b32 v57, v57, v199, v200
    v_cvt_pk_bf16_f32 v201, v234, v235
    v_mfma_f32_16x16x32_bf16 v[164:167], a[128:131], v[80:83], v[164:167]
    v_exp_f32 v236, v152
    v_mfma_f32_16x16x32_bf16 v[168:171], a[128:131], v[96:99], v[24:27]
    s_and_b32 s52, s52, 0xffff
    ds_read_b128 a[152:155], v2 offset:6144
    ds_read_b128 a[156:159], v2 offset:7168
    v_mfma_f32_16x16x32_bf16 v[168:171], a[132:135], v[100:103], v[168:171]
    v_exp_f32 v237, v153
    v_mfma_f32_16x16x32_bf16 v[168:171], a[136:139], v[104:107], v[168:171]
    v_exp_f32 v238, v154
    v_mfma_f32_16x16x32_bf16 v[168:171], a[140:143], v[108:111], v[168:171]
    v_cvt_pk_bf16_f32 v202, v236, v237
    v_or3_b32 v57, v57, v201, v202
    v_mfma_f32_16x16x32_bf16 v[172:175], a[140:143], v[124:127], v[28:31]
    v_exp_f32 v239, v155
    v_mfma_f32_16x16x32_bf16 v[172:175], a[136:139], v[120:123], v[172:175]
    v_add_u32 v2, s52, v1
    v_cvt_pk_bf16_f32 v203, v238, v239
    v_mfma_f32_16x16x32_bf16 v[172:175], a[132:135], v[116:119], v[172:175]
    v_exp_f32 v240, v140
    v_mfma_f32_16x16x32_bf16 v[172:175], a[128:131], v[112:115], v[172:175]
    s_waitcnt lgkmcnt(2)
    buffer_load_dwordx4 v1, s[20:23], s33 offen offset:3072 sc1 lds
    s_add_u32 s33, s33, 0x80000
    v_mfma_f32_16x16x32_bf16 v[188:191], a[144:147], v[112:115], v[44:47]
    v_exp_f32 v241, v141
    v_mfma_f32_16x16x32_bf16 v[188:191], a[148:151], v[116:119], v[188:191]
    s_waitcnt lgkmcnt(0)
    ds_read_b128 a[192:195], v3 offset:0
    v_cvt_pk_bf16_f32 v204, v240, v241
    v_mfma_f32_16x16x32_bf16 v[188:191], a[152:155], v[120:123], v[188:191]
    v_exp_f32 v242, v142
    v_mfma_f32_16x16x32_bf16 v[188:191], a[156:159], v[124:127], v[188:191]
    v_exp_f32 v243, v143
    v_mfma_f32_16x16x32_bf16 v[184:187], a[156:159], v[108:111], v[40:43]
    ds_read_b128 a[196:199], v3 offset:1024
    v_or3_b32 v57, v57, v203, v204
    v_mfma_f32_16x16x32_bf16 v[184:187], a[152:155], v[104:107], v[184:187]
    v_exp_f32 v244, v156
    v_mfma_f32_16x16x32_bf16 v[184:187], a[148:151], v[100:103], v[184:187]
    ds_read_b128 a[200:203], v3 offset:2048
    v_cvt_pk_bf16_f32 v205, v242, v243
    v_mfma_f32_16x16x32_bf16 v[184:187], a[144:147], v[96:99], v[184:187]
    v_exp_f32 v245, v157
    v_mfma_f32_16x16x32_bf16 v[180:183], a[144:147], v[80:83], v[36:39]
    v_exp_f32 v246, v158
    v_mfma_f32_16x16x32_bf16 v[180:183], a[148:151], v[84:87], v[180:183]
    v_cvt_pk_bf16_f32 v206, v244, v245
    v_or3_b32 v57, v57, v205, v206
    v_mfma_f32_16x16x32_bf16 v[180:183], a[152:155], v[88:91], v[180:183]
    v_exp_f32 v247, v159
    v_mfma_f32_16x16x32_bf16 v[180:183], a[156:159], v[92:95], v[180:183]
    ds_read_b128 a[204:207], v3 offset:3072
    v_cvt_pk_bf16_f32 v207, v246, v247
    v_mfma_f32_16x16x32_bf16 v[176:179], a[156:159], v[76:79], v[32:35]
    v_mfma_f32_16x16x32_bf16 v[176:179], a[152:155], v[72:75], v[176:179]
    v_bitop3_b32 v57, v57, v207, s37 bitop3:0xa8
    v_cmp_ne_u32 vcc, 0, v57
    v_mfma_f32_16x16x32_bf16 v[176:179], a[148:151], v[68:71], v[176:179]
    v_mfma_f32_16x16x32_bf16 v[176:179], a[144:147], v[64:67], v[176:179]
    s_waitcnt vmcnt(13)
    s_barrier
    s_cbranch_vccnz k2_tramp_96
k2_ret_97:
k2_dm3_89:
    v_mfma_f32_16x16x32_bf16 v[12:15], v[60:63], v[192:195], v[12:15]
    v_exp_f32 v232, v160
    v_mfma_f32_16x16x32_bf16 v[48:51], v[60:63], v[196:199], v[48:51]
    s_mov_b32 m0, s34
    ds_read_b128 a[208:211], v3 offset:4096
    v_mfma_f32_16x16x32_bf16 v[248:251], v[60:63], v[200:203], v[248:251]
    s_add_u32 s53, s53, 8192
    v_exp_f32 v233, v161
    v_mfma_f32_16x16x32_bf16 v[252:255], v[60:63], v[204:207], v[252:255]
    s_waitcnt lgkmcnt(3)
    buffer_load_dwordx4 v1, s[16:19], s32 offen offset:0 sc1 lds
    v_mfma_f32_16x16x32_bf16 a[12:15], a[192:195], v[204:207], a[12:15]
    s_sub_u32 s40, s36, s38
    s_sub_u32 s40, s40, 64
    v_exp_f32 v234, v162
    v_cvt_pk_bf16_f32 v208, v232, v233
    v_mfma_f32_16x16x32_bf16 a[8:11], a[192:195], v[200:203], a[8:11]
    s_and_b32 s53, s53, 0xffff
    ds_read_b128 a[212:215], v3 offset:5120
    v_subrev_u32 v6, s40, v4
    v_mfma_f32_16x16x32_bf16 a[4:7], a[192:195], v[196:199], a[4:7]
    s_add_u32 s34, s34, 0x4000
    v_exp_f32 v235, v163
    v_cmp_gt_i32 s[44:45], 0, v6
    v_mfma_f32_16x16x32_bf16 a[0:3], a[192:195], v[192:195], a[0:3]
    v_exp_f32 v236, v176
    v_cvt_pk_bf16_f32 v209, v234, v235
    v_mfma_f32_16x16x32_bf16 a[16:19], a[196:199], v[192:195], a[16:19]
    buffer_load_dwordx4 v1, s[16:19], s32 offen offset:1024 sc1 lds
    ds_read_b128 a[216:219], v3 offset:6144
    v_mfma_f32_16x16x32_bf16 a[20:23], a[196:199], v[196:199], a[20:23]
    v_cmp_gt_i32 s[46:47], 1, v6
    v_exp_f32 v237, v177
    v_mfma_f32_16x16x32_bf16 a[24:27], a[196:199], v[200:203], a[24:27]
    v_cmp_gt_i32 s[48:49], 2, v6
    v_exp_f32 v238, v178
    v_mfma_f32_16x16x32_bf16 a[28:31], a[196:199], v[204:207], a[28:31]
    s_waitcnt lgkmcnt(3)
    v_cvt_pk_bf16_f32 v210, v236, v237
    v_cmp_gt_i32 s[50:51], 3, v6
    v_mfma_f32_16x16x32_bf16 a[44:47], a[200:203], v[204:207], a[44:47]
    s_and_b32 s34, s34, 0xffff
    v_exp_f32 v239, v179
    v_mfma_f32_16x16x32_bf16 a[40:43], a[200:203], v[200:203], a[40:43]
    s_and_b32 s60, s62, 31
    ds_read_b128 a[220:223], v3 offset:7168
    v_or3_b32 v57, v208, v209, v210
    v_cndmask_b32 v20, v9, v5, s[44:45]
    v_mfma_f32_16x16x32_bf16 a[36:39], a[200:203], v[196:199], a[36:39]
    buffer_load_dwordx4 v1, s[16:19], s32 offen offset:2048 sc1 lds
    v_mfma_f32_16x16x32_bf16 a[32:35], a[200:203], v[192:195], a[32:35]
    s_lshr_b32 s61, s62, 5
    v_exp_f32 v240, v164
    v_cvt_pk_bf16_f32 v211, v238, v239
    v_mfma_f32_16x16x32_bf16 a[48:51], a[204:207], v[192:195], a[48:51]
    v_cndmask_b32 v21, v9, v5, s[46:47]
    v_add_u32 v3, s53, v56
    v_mfma_f32_16x16x32_bf16 a[52:55], a[204:207], v[196:199], a[52:55]
    s_mul_i32 s57, s60, 229376
    v_exp_f32 v241, v165
    v_mfma_f32_16x16x32_bf16 a[56:59], a[204:207], v[200:203], a[56:59]
    ds_read_b128 a[128:131], v2 offset:0
    v_cndmask_b32 v22, v9, v5, s[48:49]
    v_cvt_pk_bf16_f32 v212, v240, v241
    v_mfma_f32_16x16x32_bf16 a[60:63], a[204:207], v[204:207], a[60:63]
    s_waitcnt lgkmcnt(3)
    v_exp_f32 v242, v166
    v_mfma_f32_16x16x32_bf16 a[76:79], a[208:211], v[204:207], a[76:79]
    s_lshl_b32 s4, s61, 7
    v_cndmask_b32 v23, v9, v5, s[50:51]
    v_or3_b32 v57, v57, v211, v212
    v_mfma_f32_16x16x32_bf16 a[72:75], a[208:211], v[200:203], a[72:75]
    buffer_load_dwordx4 v1, s[16:19], s32 offen offset:3072 sc1 lds
    ds_read_b128 a[132:135], v2 offset:1024
    s_add_u32 s32, s32, 0x80000
    v_mfma_f32_16x16x32_bf16 a[68:71], a[208:211], v[196:199], a[68:71]
    v_exp_f32 v243, v167
    v_mfma_f32_16x16x32_bf16 a[64:67], a[208:211], v[192:195], a[64:67]
    s_add_u32 s57, s57, s4
    v_cmp_gt_i32 s[44:45], 16, v6
    v_cvt_pk_bf16_f32 v213, v242, v243
    v_mfma_f32_16x16x32_bf16 a[80:83], a[212:215], v[192:195], a[80:83]
    s_waitcnt vmcnt(9)
    v_exp_f32 v244, v180
    v_mfma_f32_16x16x32_bf16 a[84:87], a[212:215], v[196:199], a[84:87]
    s_add_u32 s56, s57, 57344
    ds_read_b128 a[136:139], v2 offset:2048
    v_cmp_gt_i32 s[46:47], 17, v6
    v_mfma_f32_16x16x32_bf16 a[88:91], a[212:215], v[200:203], a[88:91]
    v_exp_f32 v245, v181
    v_cmp_gt_i32 s[48:49], 18, v6
    v_mfma_f32_16x16x32_bf16 a[92:95], a[212:215], v[204:207], a[92:95]
    s_waitcnt lgkmcnt(3)
    v_exp_f32 v246, v182
    v_mfma_f32_16x16x32_bf16 a[108:111], a[216:219], v[204:207], a[108:111]
    s_add_u32 s62, s62, 1
    v_cmp_gt_i32 s[50:51], 19, v6
    v_cvt_pk_bf16_f32 v214, v244, v245
    v_mfma_f32_16x16x32_bf16 a[104:107], a[216:219], v[200:203], a[104:107]
    buffer_store_dwordx4 a[224:227], v229, s[8:11], s58 offen offset:0 sc1
    ds_read_b128 a[140:143], v2 offset:3072
    ds_read_b128 a[144:147], v2 offset:4096
    v_mfma_f32_16x16x32_bf16 a[100:103], a[216:219], v[196:199], a[100:103]
    v_exp_f32 v247, v183
    v_mfma_f32_16x16x32_bf16 a[96:99], a[216:219], v[192:195], a[96:99]
    v_cndmask_b32 v36, v9, v5, s[44:45]
    v_or3_b32 v57, v57, v213, v214
    v_mfma_f32_16x16x32_bf16 a[112:115], a[220:223], v[192:195], a[112:115]
    v_exp_f32 v232, v168
    v_mfma_f32_16x16x32_bf16 a[116:119], a[220:223], v[196:199], a[116:119]
    v_cndmask_b32 v37, v9, v5, s[46:47]
    v_cvt_pk_bf16_f32 v215, v246, v247
    v_cndmask_b32 v38, v9, v5, s[48:49]
    v_cndmask_b32 v39, v9, v5, s[50:51]
    v_mfma_f32_16x16x32_bf16 a[120:123], a[220:223], v[200:203], a[120:123]
    v_exp_f32 v233, v169
    v_mfma_f32_16x16x32_bf16 a[124:127], a[220:223], v[204:207], a[124:127]
    s_waitcnt lgkmcnt(3)
    buffer_store_dwordx4 a[228:231], v229, s[8:11], s58 offen offset:256 sc1
    v_exp_f32 v234, v170
    v_mfma_f32_16x16x32_bf16 v[132:135], a[128:131], v[80:83], v[20:23]
    ds_read_b128 a[148:151], v2 offset:5120
    v_cvt_pk_bf16_f32 v216, v232, v233
    v_mfma_f32_16x16x32_bf16 v[132:135], a[132:135], v[84:87], v[132:135]
    s_waitcnt lgkmcnt(2)
    v_exp_f32 v235, v171
    v_mfma_f32_16x16x32_bf16 v[132:135], a[136:139], v[88:91], v[132:135]
    s_lshl_b32 s58, s61, 17
    ds_read_b128 a[152:155], v2 offset:6144
    v_or3_b32 v57, v57, v215, v216
    v_mfma_f32_16x16x32_bf16 v[132:135], a[140:143], v[92:95], v[132:135]
    s_add_u32 s36, s36, 32
    v_exp_f32 v236, v184
    v_mfma_f32_16x16x32_bf16 v[136:139], a[140:143], v[108:111], v[24:27]
    s_lshl_b32 s60, s60, 10
    v_cvt_pk_bf16_f32 v217, v234, v235
    v_exp_f32 v237, v185
    v_mfma_f32_16x16x32_bf16 v[136:139], a[136:139], v[104:107], v[136:139]
    buffer_load_dwordx4 a[224:227], v228, s[12:15], s57 offen nt
    ds_read_b128 a[156:159], v2 offset:7168
    v_mfma_f32_16x16x32_bf16 v[136:139], a[132:135], v[100:103], v[136:139]
    s_add_u32 s52, s52, 8192
    v_exp_f32 v238, v186
    v_mfma_f32_16x16x32_bf16 v[136:139], a[128:131], v[96:99], v[136:139]
    s_add_u32 s58, s58, s60
    v_cvt_pk_bf16_f32 v218, v236, v237
    v_or3_b32 v57, v57, v217, v218
    v_mfma_f32_16x16x32_bf16 v[140:143], a[128:131], v[112:115], v[28:31]
    s_and_b32 s52, s52, 0xffff
    v_exp_f32 v239, v187
    v_mfma_f32_16x16x32_bf16 v[140:143], a[132:135], v[116:119], v[140:143]
    v_add_u32 v2, s52, v1
    v_cvt_pk_bf16_f32 v219, v238, v239
    v_mfma_f32_16x16x32_bf16 v[140:143], a[136:139], v[120:123], v[140:143]
    s_mov_b32 s10, s59
    v_exp_f32 v240, v172
    v_mfma_f32_16x16x32_bf16 v[140:143], a[140:143], v[124:127], v[140:143]
    s_waitcnt lgkmcnt(2)
    ds_read_b128 a[192:195], v3 offset:0
    s_waitcnt lgkmcnt(1)
    v_mfma_f32_16x16x32_bf16 v[156:159], a[156:159], v[124:127], v[44:47]
    v_exp_f32 v241, v173
    v_mfma_f32_16x16x32_bf16 v[156:159], a[152:155], v[120:123], v[156:159]
    buffer_load_dwordx4 a[228:231], v228, s[12:15], s56 offen nt
    v_exp_f32 v242, v174
    v_mfma_f32_16x16x32_bf16 v[156:159], a[148:151], v[116:119], v[156:159]
    ds_read_b128 a[196:199], v3 offset:1024
    v_cvt_pk_bf16_f32 v220, v240, v241
    v_mfma_f32_16x16x32_bf16 v[156:159], a[144:147], v[112:115], v[156:159]
    v_exp_f32 v243, v175
    v_mfma_f32_16x16x32_bf16 v[152:155], a[144:147], v[96:99], v[40:43]
    v_or3_b32 v57, v57, v219, v220
    v_cvt_pk_bf16_f32 v221, v242, v243
    v_mfma_f32_16x16x32_bf16 v[152:155], a[148:151], v[100:103], v[152:155]
    ds_read_b128 a[200:203], v3 offset:2048
    v_exp_f32 v244, v188
    v_mfma_f32_16x16x32_bf16 v[152:155], a[152:155], v[104:107], v[152:155]
    buffer_load_dword v7, v230, s[24:27], s54 offen
    v_exp_f32 v245, v189
    v_mfma_f32_16x16x32_bf16 v[152:155], a[156:159], v[108:111], v[152:155]
    v_exp_f32 v246, v190
    v_mfma_f32_16x16x32_bf16 v[148:151], a[156:159], v[92:95], v[36:39]
    s_add_u32 s54, s54, 4096
    v_cvt_pk_bf16_f32 v222, v244, v245
    v_or3_b32 v57, v57, v221, v222
    v_mfma_f32_16x16x32_bf16 v[148:151], a[152:155], v[88:91], v[148:151]
    v_exp_f32 v247, v191
    v_mfma_f32_16x16x32_bf16 v[148:151], a[148:151], v[84:87], v[148:151]
    ds_read_b128 a[204:207], v3 offset:3072
    v_cvt_pk_bf16_f32 v223, v246, v247
    v_mfma_f32_16x16x32_bf16 v[148:151], a[144:147], v[80:83], v[148:151]
    v_bitop3_b32 v57, v57, v223, s37 bitop3:0xa8
    v_cmp_ne_u32 vcc, 0, v57
    s_cbranch_vccnz k2_tramp_98
k2_ret_99:
    v_mfma_f32_16x16x32_bf16 v[12:15], v[60:63], v[208:211], v[12:15]
    v_exp_f32 v232, v132
    v_mfma_f32_16x16x32_bf16 v[48:51], v[60:63], v[212:215], v[48:51]
    s_mov_b32 m0, s35
    ds_read_b128 a[208:211], v3 offset:4096
    v_mfma_f32_16x16x32_bf16 v[248:251], v[60:63], v[216:219], v[248:251]
    s_add_u32 s53, s53, 8192
    buffer_load_dwordx4 v1, s[20:23], s33 offen offset:0 sc1 lds
    v_mfma_f32_16x16x32_bf16 v[252:255], v[60:63], v[220:223], v[252:255]
    s_waitcnt lgkmcnt(3)
    v_exp_f32 v233, v133
    v_mfma_f32_16x16x32_bf16 a[12:15], a[192:195], v[220:223], a[12:15]
    s_sub_u32 s40, s36, s38
    s_sub_u32 s40, s40, 64
    v_exp_f32 v234, v134
    v_mfma_f32_16x16x32_bf16 a[8:11], a[192:195], v[216:219], a[8:11]
    s_and_b32 s53, s53, 0xffff
    ds_read_b128 a[212:215], v3 offset:5120
    v_subrev_u32 v6, s40, v4
    v_mfma_f32_16x16x32_bf16 a[4:7], a[192:195], v[212:215], a[4:7]
    v_cvt_pk_bf16_f32 v196, v232, v233
    v_cmp_gt_i32 s[44:45], 0, v6
    v_mfma_f32_16x16x32_bf16 a[0:3], a[192:195], v[208:211], a[0:3]
    v_exp_f32 v235, v135
    v_mfma_f32_16x16x32_bf16 a[16:19], a[196:199], v[208:211], a[16:19]
    ds_read_b128 a[216:219], v3 offset:6144
    v_cmp_gt_i32 s[46:47], 1, v6
    v_mfma_f32_16x16x32_bf16 a[20:23], a[196:199], v[212:215], a[20:23]
    v_exp_f32 v236, v148
    v_mfma_f32_16x16x32_bf16 a[24:27], a[196:199], v[216:219], a[24:27]
    v_cvt_pk_bf16_f32 v197, v234, v235
    v_cmp_gt_i32 s[48:49], 2, v6
    v_mfma_f32_16x16x32_bf16 a[28:31], a[196:199], v[220:223], a[28:31]
    s_waitcnt lgkmcnt(3)
    v_cmp_gt_i32 s[50:51], 3, v6
    v_mfma_f32_16x16x32_bf16 a[44:47], a[200:203], v[220:223], a[44:47]
    v_exp_f32 v237, v149
    v_mfma_f32_16x16x32_bf16 a[40:43], a[200:203], v[216:219], a[40:43]
    s_add_u32 s35, s35, 0x4000
    ds_read_b128 a[220:223], v3 offset:7168
    v_cndmask_b32 v20, v9, v5, s[44:45]
    v_mfma_f32_16x16x32_bf16 a[36:39], a[200:203], v[212:215], a[36:39]
    v_exp_f32 v238, v150
    v_mfma_f32_16x16x32_bf16 a[32:35], a[200:203], v[208:211], a[32:35]
    v_cvt_pk_bf16_f32 v198, v236, v237
    v_cndmask_b32 v21, v9, v5, s[46:47]
    v_mfma_f32_16x16x32_bf16 a[48:51], a[204:207], v[208:211], a[48:51]
    buffer_load_dwordx4 v1, s[20:23], s33 offen offset:1024 sc1 lds
    ds_read_b128 a[128:131], v2 offset:0
    v_mfma_f32_16x16x32_bf16 a[52:55], a[204:207], v[212:215], a[52:55]
    v_add_u32 v3, s53, v56
    v_cndmask_b32 v22, v9, v5, s[48:49]
    v_mfma_f32_16x16x32_bf16 a[56:59], a[204:207], v[216:219], a[56:59]
    v_exp_f32 v239, v151
    v_mfma_f32_16x16x32_bf16 a[60:63], a[204:207], v[220:223], a[60:63]
    s_waitcnt lgkmcnt(3)
    v_or3_b32 v57, v196, v197, v198
    v_cndmask_b32 v23, v9, v5, s[50:51]
    v_mfma_f32_16x16x32_bf16 a[76:79], a[208:211], v[220:223], a[76:79]
    v_exp_f32 v240, v136
    v_mfma_f32_16x16x32_bf16 a[72:75], a[208:211], v[216:219], a[72:75]
    v_cvt_pk_bf16_f32 v199, v238, v239
    v_cmp_gt_i32 s[44:45], 16, v6
    v_mfma_f32_16x16x32_bf16 a[68:71], a[208:211], v[212:215], a[68:71]
    ds_read_b128 a[132:135], v2 offset:1024
    v_cmp_gt_i32 s[46:47], 17, v6
    v_mfma_f32_16x16x32_bf16 a[64:67], a[208:211], v[208:211], a[64:67]
    v_exp_f32 v241, v137
    v_mfma_f32_16x16x32_bf16 a[80:83], a[212:215], v[208:211], a[80:83]
    ds_read_b128 a[136:139], v2 offset:2048
    v_cmp_gt_i32 s[48:49], 18, v6
    v_mfma_f32_16x16x32_bf16 a[84:87], a[212:215], v[212:215], a[84:87]
    v_exp_f32 v242, v138
    v_mfma_f32_16x16x32_bf16 a[88:91], a[212:215], v[216:219], a[88:91]
    v_cvt_pk_bf16_f32 v200, v240, v241
    v_cmp_gt_i32 s[50:51], 19, v6
    v_mfma_f32_16x16x32_bf16 a[92:95], a[212:215], v[220:223], a[92:95]
    s_waitcnt lgkmcnt(3)
    v_exp_f32 v243, v139
    v_mfma_f32_16x16x32_bf16 a[108:111], a[216:219], v[220:223], a[108:111]
    s_and_b32 s35, s35, 0xffff
    ds_read_b128 a[140:143], v2 offset:3072
    v_or3_b32 v57, v57, v199, v200
    v_mfma_f32_16x16x32_bf16 a[104:107], a[216:219], v[216:219], a[104:107]
    v_cndmask_b32 v36, v9, v5, s[44:45]
    v_cndmask_b32 v37, v9, v5, s[46:47]
    v_mfma_f32_16x16x32_bf16 a[100:103], a[216:219], v[212:215], a[100:103]
    v_exp_f32 v244, v152
    v_mfma_f32_16x16x32_bf16 a[96:99], a[216:219], v[208:211], a[96:99]
    ds_read_b128 a[144:147], v2 offset:4096
    v_cvt_pk_bf16_f32 v201, v242, v243
    v_mfma_f32_16x16x32_bf16 a[112:115], a[220:223], v[208:211], a[112:115]
    buffer_load_dwordx4 v1, s[20:23], s33 offen offset:2048 sc1 lds
    ds_read_b128 a[148:151], v2 offset:5120
    v_mfma_f32_16x16x32_bf16 a[116:119], a[220:223], v[212:215], a[116:119]
    v_cndmask_b32 v38, v9, v5, s[48:49]
    v_cndmask_b32 v39, v9, v5, s[50:51]
    v_mfma_f32_16x16x32_bf16 a[120:123], a[220:223], v[216:219], a[120:123]
    s_or_b32 s35, s35, 0x10000
    v_exp_f32 v245, v153
    v_mfma_f32_16x16x32_bf16 a[124:127], a[220:223], v[220:223], a[124:127]
    s_waitcnt lgkmcnt(4)
    v_exp_f32 v246, v154
    v_mfma_f32_16x16x32_bf16 v[164:167], a[128:131], v[80:83], v[20:23]
    ds_read_b128 a[152:155], v2 offset:6144
    v_cvt_pk_bf16_f32 v202, v244, v245
    v_mfma_f32_16x16x32_bf16 v[164:167], a[132:135], v[84:87], v[164:167]
    s_waitcnt lgkmcnt(3)
    v_exp_f32 v247, v155
    v_mfma_f32_16x16x32_bf16 v[164:167], a[136:139], v[88:91], v[164:167]
    v_or3_b32 v57, v57, v201, v202
    v_cvt_pk_bf16_f32 v203, v246, v247
    v_mfma_f32_16x16x32_bf16 v[164:167], a[140:143], v[92:95], v[164:167]
    s_add_u32 s36, s36, 32
    v_exp_f32 v232, v140
    v_mfma_f32_16x16x32_bf16 v[168:171], a[140:143], v[108:111], v[24:27]
    ds_read_b128 a[156:159], v2 offset:7168
    v_mfma_f32_16x16x32_bf16 v[168:171], a[136:139], v[104:107], v[168:171]
    v_exp_f32 v233, v141
    v_mfma_f32_16x16x32_bf16 v[168:171], a[132:135], v[100:103], v[168:171]
    s_add_u32 s52, s52, 8192
    v_exp_f32 v234, v142
    v_mfma_f32_16x16x32_bf16 v[168:171], a[128:131], v[96:99], v[168:171]
    ds_read_b128 a[192:195], v3 offset:0
    v_cvt_pk_bf16_f32 v204, v232, v233
    v_mfma_f32_16x16x32_bf16 v[172:175], a[128:131], v[112:115], v[28:31]
    s_and_b32 s52, s52, 0xffff
    v_add_u32 v2, s52, v1
    v_or3_b32 v57, v57, v203, v204
    v_mfma_f32_16x16x32_bf16 v[172:175], a[132:135], v[116:119], v[172:175]
    buffer_load_dwordx4 v1, s[20:23], s33 offen offset:3072 sc1 lds
    s_add_u32 s33, s33, 0x80000
    v_mfma_f32_16x16x32_bf16 v[172:175], a[136:139], v[120:123], v[172:175]
    v_exp_f32 v235, v143
    v_mfma_f32_16x16x32_bf16 v[172:175], a[140:143], v[124:127], v[172:175]
    s_waitcnt lgkmcnt(3)
    ds_read_b128 a[196:199], v3 offset:1024
    s_waitcnt lgkmcnt(2)
    v_mfma_f32_16x16x32_bf16 v[188:191], a[156:159], v[124:127], v[44:47]
    v_exp_f32 v236, v156
    v_mfma_f32_16x16x32_bf16 v[188:191], a[152:155], v[120:123], v[188:191]
    v_cvt_pk_bf16_f32 v205, v234, v235
    v_mfma_f32_16x16x32_bf16 v[188:191], a[148:151], v[116:119], v[188:191]
    v_exp_f32 v237, v157
    v_mfma_f32_16x16x32_bf16 v[188:191], a[144:147], v[112:115], v[188:191]
    ds_read_b128 a[200:203], v3 offset:2048
    v_cvt_pk_bf16_f32 v206, v236, v237
    v_mfma_f32_16x16x32_bf16 v[184:187], a[144:147], v[96:99], v[40:43]
    v_exp_f32 v238, v158
    v_mfma_f32_16x16x32_bf16 v[184:187], a[148:151], v[100:103], v[184:187]
    v_exp_f32 v239, v159
    v_mfma_f32_16x16x32_bf16 v[184:187], a[152:155], v[104:107], v[184:187]
    ds_read_b128 a[204:207], v3 offset:3072
    v_or3_b32 v57, v57, v205, v206
    v_mfma_f32_16x16x32_bf16 v[184:187], a[156:159], v[108:111], v[184:187]
    v_cvt_pk_bf16_f32 v207, v238, v239
    v_mfma_f32_16x16x32_bf16 v[180:183], a[156:159], v[92:95], v[36:39]
    v_mfma_f32_16x16x32_bf16 v[180:183], a[152:155], v[88:91], v[180:183]
    v_bitop3_b32 v57, v57, v207, s37 bitop3:0xa8
    v_cmp_ne_u32 vcc, 0, v57
    v_mfma_f32_16x16x32_bf16 v[180:183], a[148:151], v[84:87], v[180:183]
    v_mfma_f32_16x16x32_bf16 v[180:183], a[144:147], v[80:83], v[180:183]
    s_waitcnt vmcnt(13)
    s_barrier
    s_cbranch_vccnz k2_tramp_100
k2_ret_101:
    v_mfma_f32_16x16x32_bf16 v[48:51], v[60:63], v[196:199], v[48:51]
    ds_read_b128 a[208:211], v3 offset:4096
    ds_read_b128 a[212:215], v3 offset:5120
    v_mfma_f32_16x16x32_bf16 v[248:251], v[60:63], v[200:203], v[248:251]
    s_mov_b32 m0, s34
    v_exp_f32 v232, v164
    v_mfma_f32_16x16x32_bf16 v[252:255], v[60:63], v[204:207], v[252:255]
    s_waitcnt lgkmcnt(4)
    buffer_load_dwordx4 v1, s[16:19], s32 offen offset:0 sc1 lds
    ds_read_b128 a[216:219], v3 offset:6144
    v_mfma_f32_16x16x32_bf16 a[12:15], a[192:195], v[204:207], a[12:15]
    s_add_u32 s53, s53, 8192
    v_exp_f32 v233, v165
    v_mfma_f32_16x16x32_bf16 a[8:11], a[192:195], v[200:203], a[8:11]
    s_and_b32 s53, s53, 0xffff
    v_mov_b32 v16, v10
    v_mov_b32 v17, v10
    v_mfma_f32_16x16x32_bf16 a[4:7], a[192:195], v[196:199], a[4:7]
    s_add_u32 s34, s34, 0x4000
    v_exp_f32 v234, v166
    v_mfma_f32_16x16x32_bf16 a[20:23], a[196:199], v[196:199], a[20:23]
    ds_read_b128 a[220:223], v3 offset:7168
    v_cvt_pk_bf16_f32 v212, v232, v233
    v_mfma_f32_16x16x32_bf16 a[24:27], a[196:199], v[200:203], a[24:27]
    v_mov_b32 v18, v10
    v_mov_b32 v19, v10
    v_mfma_f32_16x16x32_bf16 a[28:31], a[196:199], v[204:207], a[28:31]
    s_waitcnt lgkmcnt(4)
    v_exp_f32 v235, v167
    v_mfma_f32_16x16x32_bf16 a[44:47], a[200:203], v[204:207], a[44:47]
    buffer_load_dwordx4 v1, s[16:19], s32 offen offset:1024 sc1 lds
    ds_read_b128 a[128:131], v2 offset:0
    v_mfma_f32_16x16x32_bf16 a[40:43], a[200:203], v[200:203], a[40:43]
    v_mov_b32 v20, v11
    v_add_u32 v3, s53, v56
    v_mfma_f32_16x16x32_bf16 a[36:39], a[200:203], v[196:199], a[36:39]
    s_and_b32 s34, s34, 0xffff
    v_mov_b32 v21, v11
    v_mov_b32 v22, v11
    v_mfma_f32_16x16x32_bf16 a[52:55], a[204:207], v[196:199], a[52:55]
    v_exp_f32 v236, v180
    v_mfma_f32_16x16x32_bf16 a[56:59], a[204:207], v[200:203], a[56:59]
    ds_read_b128 a[132:135], v2 offset:1024
    v_cvt_pk_bf16_f32 v213, v234, v235
    v_mfma_f32_16x16x32_bf16 a[60:63], a[204:207], v[204:207], a[60:63]
    s_waitcnt lgkmcnt(4)
    v_mov_b32 v23, v11
    v_mov_b32 v32, v10
    v_mfma_f32_16x16x32_bf16 a[76:79], a[208:211], v[204:207], a[76:79]
    v_exp_f32 v237, v181
    v_mfma_f32_16x16x32_bf16 a[72:75], a[208:211], v[200:203], a[72:75]
    ds_read_b128 a[136:139], v2 offset:2048
    v_mov_b32 v33, v10
    v_mfma_f32_16x16x32_bf16 a[68:71], a[208:211], v[196:199], a[68:71]
    buffer_load_dwordx4 v1, s[16:19], s32 offen offset:2048 sc1 lds
    v_mov_b32 v34, v10
    v_mfma_f32_16x16x32_bf16 a[84:87], a[212:215], v[196:199], a[84:87]
    v_exp_f32 v238, v182
    v_mfma_f32_16x16x32_bf16 a[88:91], a[212:215], v[200:203], a[88:91]
    ds_read_b128 a[140:143], v2 offset:3072
    v_cvt_pk_bf16_f32 v214, v236, v237
    v_mfma_f32_16x16x32_bf16 a[92:95], a[212:215], v[204:207], a[92:95]
    s_waitcnt lgkmcnt(4)
    v_mov_b32 v35, v10
    v_mov_b32 v36, v11
    v_mfma_f32_16x16x32_bf16 a[108:111], a[216:219], v[204:207], a[108:111]
    ds_read_b128 a[144:147], v2 offset:4096
    v_exp_f32 v239, v183
    v_mfma_f32_16x16x32_bf16 a[104:107], a[216:219], v[200:203], a[104:107]
    v_mov_b32 v37, v11
    v_or3_b32 v57, v212, v213, v214
    v_mov_b32 v38, v11
    v_mov_b32 v39, v11
    v_mfma_f32_16x16x32_bf16 a[100:103], a[216:219], v[196:199], a[100:103]
    buffer_load_dwordx4 v1, s[16:19], s32 offen offset:3072 sc1 lds
    ds_read_b128 a[148:151], v2 offset:5120
    v_mfma_f32_16x16x32_bf16 a[116:119], a[220:223], v[196:199], a[116:119]
    s_add_u32 s32, s32, 0x80000
    s_cmp_ge_u32 s36, s43
    s_cbranch_scc1 k2_prep_102
k2_prepret_103:
    v_mfma_f32_16x16x32_bf16 a[120:123], a[220:223], v[200:203], a[120:123]
    s_waitcnt vmcnt(9)
    v_exp_f32 v240, v168
    v_mfma_f32_16x16x32_bf16 a[124:127], a[220:223], v[204:207], a[124:127]
    s_waitcnt lgkmcnt(4)
    ds_read_b128 a[152:155], v2 offset:6144
    v_cvt_pk_bf16_f32 v215, v238, v239
    v_mfma_f32_16x16x32_bf16 v[128:131], a[128:131], v[96:99], v[16:19]
    v_exp_f32 v241, v169
    v_mfma_f32_16x16x32_bf16 v[128:131], a[132:135], v[100:103], v[128:131]
    s_waitcnt lgkmcnt(3)
    ds_read_b128 a[156:159], v2 offset:7168
    v_exp_f32 v242, v170
    v_mfma_f32_16x16x32_bf16 v[128:131], a[136:139], v[104:107], v[128:131]
    ds_read_b128 a[160:163], v2 offset:8192
    v_cvt_pk_bf16_f32 v216, v240, v241
    v_mfma_f32_16x16x32_bf16 v[128:131], a[140:143], v[108:111], v[128:131]
    s_add_u32 s36, s36, 64
    buffer_store_dwordx4 a[224:227], v229, s[8:11], s58 offen offset:0 sc1
    v_exp_f32 v243, v171
    v_mfma_f32_16x16x32_bf16 v[132:135], a[140:143], v[124:127], v[20:23]
    ds_read_b128 a[164:167], v2 offset:9216
    v_or3_b32 v57, v57, v215, v216
    v_mfma_f32_16x16x32_bf16 v[132:135], a[136:139], v[120:123], v[132:135]
    v_exp_f32 v244, v184
    v_mfma_f32_16x16x32_bf16 v[132:135], a[132:135], v[116:119], v[132:135]
    s_add_u32 s52, s52, 16384
    ds_read_b128 a[168:171], v2 offset:10240
    v_cvt_pk_bf16_f32 v217, v242, v243
    v_mfma_f32_16x16x32_bf16 v[132:135], a[128:131], v[112:115], v[132:135]
    s_waitcnt lgkmcnt(5)
    v_exp_f32 v245, v185
    v_mfma_f32_16x16x32_bf16 v[148:151], a[144:147], v[112:115], v[36:39]
    s_and_b32 s52, s52, 0xffff
    ds_read_b128 a[172:175], v2 offset:11264
    ds_read_b128 a[176:179], v2 offset:12288
    v_mfma_f32_16x16x32_bf16 v[148:151], a[148:151], v[116:119], v[148:151]
    s_waitcnt lgkmcnt(5)
    v_exp_f32 v246, v186
    v_mfma_f32_16x16x32_bf16 v[148:151], a[152:155], v[120:123], v[148:151]
    ds_read_b128 a[180:183], v2 offset:13312
    v_cvt_pk_bf16_f32 v218, v244, v245
    v_mfma_f32_16x16x32_bf16 v[148:151], a[156:159], v[124:127], v[148:151]
    v_exp_f32 v247, v187
    v_mfma_f32_16x16x32_bf16 v[144:147], a[156:159], v[108:111], v[32:35]
    ds_read_b128 a[184:187], v2 offset:14336
    v_or3_b32 v57, v57, v217, v218
    v_mfma_f32_16x16x32_bf16 v[144:147], a[152:155], v[104:107], v[144:147]
    v_exp_f32 v232, v172
    v_mfma_f32_16x16x32_bf16 v[144:147], a[148:151], v[100:103], v[144:147]
    ds_read_b128 a[188:191], v2 offset:15360
    v_cvt_pk_bf16_f32 v219, v246, v247
    v_mfma_f32_16x16x32_bf16 v[144:147], a[144:147], v[96:99], v[144:147]
    s_waitcnt lgkmcnt(6)
    v_exp_f32 v233, v173
    v_mfma_f32_16x16x32_bf16 v[136:139], a[160:163], v[96:99], v[24:27]
    buffer_store_dwordx4 a[228:231], v229, s[8:11], s58 offen offset:256 sc1
    ds_read_b128 a[192:195], v3 offset:0
    v_mfma_f32_16x16x32_bf16 v[136:139], a[164:167], v[100:103], v[136:139]
    s_waitcnt lgkmcnt(5)
    v_add_u32 v2, s52, v1
    v_cvt_pk_bf16_f32 v220, v232, v233
    v_mfma_f32_16x16x32_bf16 v[136:139], a[168:171], v[104:107], v[136:139]
    v_exp_f32 v234, v174
    v_mfma_f32_16x16x32_bf16 v[136:139], a[172:175], v[108:111], v[136:139]
    v_exp_f32 v235, v175
    v_mfma_f32_16x16x32_bf16 v[140:143], a[172:175], v[124:127], v[28:31]
    ds_read_b128 a[196:199], v3 offset:1024
    v_or3_b32 v57, v57, v219, v220
    v_mfma_f32_16x16x32_bf16 v[140:143], a[168:171], v[120:123], v[140:143]
    v_exp_f32 v236, v188
    v_mfma_f32_16x16x32_bf16 v[140:143], a[164:167], v[116:119], v[140:143]
    ds_read_b128 a[200:203], v3 offset:2048
    v_cvt_pk_bf16_f32 v221, v234, v235
    v_mfma_f32_16x16x32_bf16 v[140:143], a[160:163], v[112:115], v[140:143]
    s_waitcnt lgkmcnt(5)
    v_exp_f32 v237, v189
    v_mfma_f32_16x16x32_bf16 v[156:159], a[176:179], v[112:115], v[44:47]
    v_exp_f32 v238, v190
    v_mfma_f32_16x16x32_bf16 v[156:159], a[180:183], v[116:119], v[156:159]
    s_waitcnt lgkmcnt(3)
    v_cvt_pk_bf16_f32 v222, v236, v237
    v_or3_b32 v57, v57, v221, v222
    v_mfma_f32_16x16x32_bf16 v[156:159], a[184:187], v[120:123], v[156:159]
    v_exp_f32 v239, v191
    v_mfma_f32_16x16x32_bf16 v[156:159], a[188:191], v[124:127], v[156:159]
    ds_read_b128 a[204:207], v3 offset:3072
    v_cvt_pk_bf16_f32 v223, v238, v239
    v_mfma_f32_16x16x32_bf16 v[152:155], a[188:191], v[108:111], v[40:43]
    v_mfma_f32_16x16x32_bf16 v[152:155], a[184:187], v[104:107], v[152:155]
    v_bitop3_b32 v57, v57, v223, s37 bitop3:0xa8
    v_cmp_ne_u32 vcc, 0, v57
    v_mfma_f32_16x16x32_bf16 v[152:155], a[180:183], v[100:103], v[152:155]
    v_mfma_f32_16x16x32_bf16 v[152:155], a[176:179], v[96:99], v[152:155]
    s_cbranch_vccnz k2_tramp_104
k2_ret_105:
    v_mfma_f32_16x16x32_bf16 v[48:51], v[60:63], v[212:215], v[48:51]
    ds_read_b128 a[208:211], v3 offset:4096
    ds_read_b128 a[212:215], v3 offset:5120
    v_mfma_f32_16x16x32_bf16 v[248:251], v[60:63], v[216:219], v[248:251]
    s_mov_b32 m0, s35
    v_exp_f32 v232, v128
    v_mfma_f32_16x16x32_bf16 v[252:255], v[60:63], v[220:223], v[252:255]
    s_waitcnt lgkmcnt(4)
    ds_read_b128 a[216:219], v3 offset:6144
    v_exp_f32 v233, v129
    v_mfma_f32_16x16x32_bf16 a[12:15], a[192:195], v[220:223], a[12:15]
    s_add_u32 s53, s53, 8192
    buffer_load_dwordx4 v1, s[20:23], s33 offen offset:0 sc1 lds
    v_mfma_f32_16x16x32_bf16 a[8:11], a[192:195], v[216:219], a[8:11]
    s_and_b32 s53, s53, 0xffff
    v_exp_f32 v234, v130
    v_cvt_pk_bf16_f32 v192, v232, v233
    v_mfma_f32_16x16x32_bf16 a[4:7], a[192:195], v[212:215], a[4:7]
    ds_read_b128 a[220:223], v3 offset:7168
    v_mfma_f32_16x16x32_bf16 a[20:23], a[196:199], v[212:215], a[20:23]
    s_add_u32 s35, s35, 0x4000
    v_exp_f32 v235, v131
    v_mfma_f32_16x16x32_bf16 a[24:27], a[196:199], v[216:219], a[24:27]
    v_exp_f32 v236, v144
    v_cvt_pk_bf16_f32 v193, v234, v235
    v_mfma_f32_16x16x32_bf16 a[28:31], a[196:199], v[220:223], a[28:31]
    s_waitcnt lgkmcnt(4)
    buffer_load_dwordx4 v1, s[20:23], s33 offen offset:1024 sc1 lds
    ds_read_b128 a[128:131], v2 offset:0
    v_mfma_f32_16x16x32_bf16 a[44:47], a[200:203], v[220:223], a[44:47]
    v_add_u32 v3, s53, v56
    v_exp_f32 v237, v145
    v_mfma_f32_16x16x32_bf16 a[40:43], a[200:203], v[216:219], a[40:43]
    ds_read_b128 a[132:135], v2 offset:1024
    v_cvt_pk_bf16_f32 v194, v236, v237
    v_mfma_f32_16x16x32_bf16 a[36:39], a[200:203], v[212:215], a[36:39]
    ds_read_b128 a[136:139], v2 offset:2048
    v_exp_f32 v238, v146
    v_mfma_f32_16x16x32_bf16 a[52:55], a[204:207], v[212:215], a[52:55]
    s_and_b32 s35, s35, 0xffff
    v_exp_f32 v239, v147
    v_mfma_f32_16x16x32_bf16 a[56:59], a[204:207], v[216:219], a[56:59]
    ds_read_b128 a[140:143], v2 offset:3072
    v_or3_b32 v57, v192, v193, v194
    v_mfma_f32_16x16x32_bf16 a[60:63], a[204:207], v[220:223], a[60:63]
    s_waitcnt lgkmcnt(6)
    v_exp_f32 v240, v132
    v_mfma_f32_16x16x32_bf16 a[76:79], a[208:211], v[220:223], a[76:79]
    s_or_b32 s35, s35, 0x10000
    buffer_load_dwordx4 v1, s[20:23], s33 offen offset:2048 sc1 lds
    ds_read_b128 a[144:147], v2 offset:4096
    v_mfma_f32_16x16x32_bf16 a[72:75], a[208:211], v[216:219], a[72:75]
    v_cvt_pk_bf16_f32 v195, v238, v239
    v_exp_f32 v241, v133
    v_mfma_f32_16x16x32_bf16 a[68:71], a[208:211], v[212:215], a[68:71]
    v_exp_f32 v242, v134
    v_mfma_f32_16x16x32_bf16 a[84:87], a[212:215], v[212:215], a[84:87]
    ds_read_b128 a[148:151], v2 offset:5120
    v_cvt_pk_bf16_f32 v196, v240, v241
    v_mfma_f32_16x16x32_bf16 a[88:91], a[212:215], v[216:219], a[88:91]
    v_exp_f32 v243, v135
    v_mfma_f32_16x16x32_bf16 a[92:95], a[212:215], v[220:223], a[92:95]
    s_waitcnt lgkmcnt(6)
    ds_read_b128 a[152:155], v2 offset:6144
    v_or3_b32 v57, v57, v195, v196
    v_cvt_pk_bf16_f32 v197, v242, v243
    v_mfma_f32_16x16x32_bf16 a[108:111], a[216:219], v[220:223], a[108:111]
    buffer_load_dwordx4 v1, s[20:23], s33 offen offset:3072 sc1 lds
    ds_read_b128 a[156:159], v2 offset:7168
    v_mfma_f32_16x16x32_bf16 a[104:107], a[216:219], v[216:219], a[104:107]
    s_add_u32 s33, s33, 0x80000
    v_exp_f32 v244, v148
    v_mfma_f32_16x16x32_bf16 a[100:103], a[216:219], v[212:215], a[100:103]
    v_exp_f32 v245, v149
    v_mfma_f32_16x16x32_bf16 a[116:119], a[220:223], v[212:215], a[116:119]
    ds_read_b128 a[160:163], v2 offset:8192
    s_cmp_ge_u32 s36, s43
    s_cbranch_scc1 k2_prep_106
k2_prepret_107:
    v_mfma_f32_16x16x32_bf16 a[120:123], a[220:223], v[216:219], a[120:123]
    v_exp_f32 v246, v150
    v_mfma_f32_16x16x32_bf16 a[124:127], a[220:223], v[220:223], a[124:127]
    s_waitcnt lgkmcnt(7)
    ds_read_b128 a[164:167], v2 offset:9216
    v_cvt_pk_bf16_f32 v198, v244, v245
    v_mfma_f32_16x16x32_bf16 v[160:163], a[128:131], v[96:99], v[16:19]
    s_waitcnt vmcnt(12)
    s_barrier
    v_exp_f32 v247, v151
    v_mfma_f32_16x16x32_bf16 v[160:163], a[132:135], v[100:103], v[160:163]
    s_waitcnt lgkmcnt(6)
    v_or3_b32 v57, v57, v197, v198
    v_cvt_pk_bf16_f32 v199, v246, v247
    v_mfma_f32_16x16x32_bf16 v[160:163], a[136:139], v[104:107], v[160:163]
    s_mov_b32 m0, s34
    ds_read_b128 a[168:171], v2 offset:10240
    v_exp_f32 v232, v136
    v_mfma_f32_16x16x32_bf16 v[160:163], a[140:143], v[108:111], v[160:163]
    s_add_u32 s36, s36, 64
    buffer_load_dwordx4 v1, s[16:19], s32 offen offset:0 sc1 lds
    ds_read_b128 a[172:175], v2 offset:11264
    v_mfma_f32_16x16x32_bf16 v[164:167], a[140:143], v[124:127], v[20:23]
    v_exp_f32 v233, v137
    v_mfma_f32_16x16x32_bf16 v[164:167], a[136:139], v[120:123], v[164:167]
    v_exp_f32 v234, v138
    v_mfma_f32_16x16x32_bf16 v[164:167], a[132:135], v[116:119], v[164:167]
    s_add_u32 s52, s52, 16384
    ds_read_b128 a[176:179], v2 offset:12288
    v_cvt_pk_bf16_f32 v200, v232, v233
    v_mfma_f32_16x16x32_bf16 v[164:167], a[128:131], v[112:115], v[164:167]
    s_waitcnt lgkmcnt(7)
    v_exp_f32 v235, v139
    v_or3_b32 v57, v57, v199, v200
    v_mfma_f32_16x16x32_bf16 v[180:183], a[144:147], v[112:115], v[36:39]
    s_add_u32 s34, s34, 0x4000
    ds_read_b128 a[180:183], v2 offset:13312
    v_cvt_pk_bf16_f32 v201, v234, v235
    v_mfma_f32_16x16x32_bf16 v[180:183], a[148:151], v[116:119], v[180:183]
    s_waitcnt lgkmcnt(6)
    v_exp_f32 v236, v152
    v_mfma_f32_16x16x32_bf16 v[180:183], a[152:155], v[120:123], v[180:183]
    s_and_b32 s52, s52, 0xffff
    buffer_load_dwordx4 v1, s[16:19], s32 offen offset:1024 sc1 lds
    ds_read_b128 a[184:187], v2 offset:14336
    v_mfma_f32_16x16x32_bf16 v[180:183], a[156:159], v[124:127], v[180:183]
    ds_read_b128 a[188:191], v2 offset:15360
    v_exp_f32 v237, v153
    v_mfma_f32_16x16x32_bf16 v[176:179], a[156:159], v[108:111], v[32:35]
    v_exp_f32 v238, v154
    v_mfma_f32_16x16x32_bf16 v[176:179], a[152:155], v[104:107], v[176:179]
    v_cvt_pk_bf16_f32 v202, v236, v237
    v_or3_b32 v57, v57, v201, v202
    v_mfma_f32_16x16x32_bf16 v[176:179], a[148:151], v[100:103], v[176:179]
    s_and_b32 s34, s34, 0xffff
    v_exp_f32 v239, v155
    v_mfma_f32_16x16x32_bf16 v[176:179], a[144:147], v[96:99], v[176:179]
    s_waitcnt lgkmcnt(6)
    v_add_u32 v2, s52, v1
    v_cvt_pk_bf16_f32 v203, v238, v239
    v_mfma_f32_16x16x32_bf16 v[168:171], a[160:163], v[96:99], v[24:27]
    ds_read_b128 a[192:195], v3 offset:0
    v_exp_f32 v240, v140
    v_mfma_f32_16x16x32_bf16 v[168:171], a[164:167], v[100:103], v[168:171]
    s_waitcnt lgkmcnt(5)
    v_exp_f32 v241, v141
    v_mfma_f32_16x16x32_bf16 v[168:171], a[168:171], v[104:107], v[168:171]
    buffer_load_dwordx4 v1, s[16:19], s32 offen offset:2048 sc1 lds
    ds_read_b128 a[196:199], v3 offset:8192
    v_mfma_f32_16x16x32_bf16 v[168:171], a[172:175], v[108:111], v[168:171]
    v_exp_f32 v242, v142
    v_mfma_f32_16x16x32_bf16 v[172:175], a[172:175], v[124:127], v[28:31]
    ds_read_b128 a[200:203], v3 offset:1024
    v_cvt_pk_bf16_f32 v204, v240, v241
    v_or3_b32 v57, v57, v203, v204
    v_mfma_f32_16x16x32_bf16 v[172:175], a[168:171], v[120:123], v[172:175]
    v_exp_f32 v243, v143
    v_mfma_f32_16x16x32_bf16 v[172:175], a[164:167], v[116:119], v[172:175]
    ds_read_b128 a[204:207], v3 offset:9216
    v_cvt_pk_bf16_f32 v205, v242, v243
    v_mfma_f32_16x16x32_bf16 v[172:175], a[160:163], v[112:115], v[172:175]
    s_waitcnt lgkmcnt(6)
    v_exp_f32 v244, v156
    v_mfma_f32_16x16x32_bf16 v[188:191], a[176:179], v[112:115], v[44:47]
    v_exp_f32 v245, v157
    v_mfma_f32_16x16x32_bf16 v[188:191], a[180:183], v[116:119], v[188:191]
    s_waitcnt lgkmcnt(4)
    buffer_load_dwordx4 v1, s[16:19], s32 offen offset:3072 sc1 lds
    ds_read_b128 a[208:211], v3 offset:2048
    ds_read_b128 a[212:215], v3 offset:10240
    v_mfma_f32_16x16x32_bf16 v[188:191], a[184:187], v[120:123], v[188:191]
    s_add_u32 s32, s32, 0x80000
    v_exp_f32 v246, v158
    v_mfma_f32_16x16x32_bf16 v[188:191], a[188:191], v[124:127], v[188:191]
    v_cvt_pk_bf16_f32 v206, v244, v245
    v_or3_b32 v57, v57, v205, v206
    v_mfma_f32_16x16x32_bf16 v[184:187], a[188:191], v[108:111], v[40:43]
    v_exp_f32 v247, v159
    v_mfma_f32_16x16x32_bf16 v[184:187], a[184:187], v[104:107], v[184:187]
    ds_read_b128 a[216:219], v3 offset:3072
    ds_read_b128 a[220:223], v3 offset:11264
    v_cvt_pk_bf16_f32 v207, v246, v247
    v_mfma_f32_16x16x32_bf16 v[184:187], a[180:183], v[100:103], v[184:187]
    v_bitop3_b32 v57, v57, v207, s37 bitop3:0xa8
    v_cmp_ne_u32 vcc, 0, v57
    v_mfma_f32_16x16x32_bf16 v[184:187], a[176:179], v[96:99], v[184:187]
    s_cbranch_vccnz k2_tramp_108
k2_ret_109:
    s_load_dwordx2 s[4:5], s[0:1], 40
    s_add_u32 s24, s6, 0x3000000
    s_addc_u32 s25, s7, 0
    s_and_b32 s25, s25, 0xffff
    s_mov_b32 s26, 0x1000000
    s_mov_b32 s27, 0x00020000
    s_lshl_b32 s31, s28, 19
    s_lshl_b32 s44, s38, 6
    s_add_u32 s44, s44, s31
    s_add_u32 s45, s44, 131072
    s_add_u32 s46, s44, 262144
    s_add_u32 s47, s44, 393216
    s_add_u32 s48, s44, 4096
    s_add_u32 s49, s44, 135168
    s_add_u32 s50, s44, 266240
    s_add_u32 s51, s44, 397312
    v_mov_b32 v13, v12
    v_mov_b32 v49, v48
    s_nop 1
    v_permlane16_swap_b32 v12, v13
    v_permlane16_swap_b32 v48, v49
    s_nop 1
    v_add_f32 v12, v12, v13
    v_add_f32 v48, v48, v49
    v_mov_b32 v13, v12
    v_mov_b32 v49, v48
    s_nop 1
    v_permlane32_swap_b32 v12, v13
    v_permlane32_swap_b32 v48, v49
    s_nop 1
    v_add_f32 v12, v12, v13
    v_add_f32 v48, v48, v49
    v_rcp_f32 v13, v12
    v_rcp_f32 v49, v48
    v_rcp_f32 v12, v12
    v_rcp_f32 v48, v48
    s_nop 0
    v_accvgpr_read_b32 v68, a0
    v_accvgpr_read_b32 v69, a1
    v_accvgpr_read_b32 v70, a2
    v_accvgpr_read_b32 v71, a3
    v_accvgpr_read_b32 v72, a16
    v_accvgpr_read_b32 v73, a17
    v_accvgpr_read_b32 v74, a18
    v_accvgpr_read_b32 v75, a19
    v_pk_mul_f32 v[68:69], v[68:69], v[12:13]
    v_pk_mul_f32 v[70:71], v[70:71], v[12:13]
    v_pk_mul_f32 v[72:73], v[72:73], v[12:13]
    v_pk_mul_f32 v[74:75], v[74:75], v[12:13]
    v_cvt_pk_bf16_f32 v64, v68, v69
    v_cvt_pk_bf16_f32 v65, v70, v71
    v_cvt_pk_bf16_f32 v66, v72, v73
    v_cvt_pk_bf16_f32 v67, v74, v75
    buffer_store_dwordx4 v[64:67], v1, s[24:27], s44 offen sc1
    v_accvgpr_read_b32 v80, a32
    v_accvgpr_read_b32 v81, a33
    v_accvgpr_read_b32 v82, a34
    v_accvgpr_read_b32 v83, a35
    v_accvgpr_read_b32 v84, a48
    v_accvgpr_read_b32 v85, a49
    v_accvgpr_read_b32 v86, a50
    v_accvgpr_read_b32 v87, a51
    v_pk_mul_f32 v[80:81], v[80:81], v[12:13]
    v_pk_mul_f32 v[82:83], v[82:83], v[12:13]
    v_pk_mul_f32 v[84:85], v[84:85], v[12:13]
    v_pk_mul_f32 v[86:87], v[86:87], v[12:13]
    v_cvt_pk_bf16_f32 v76, v80, v81
    v_cvt_pk_bf16_f32 v77, v82, v83
    v_cvt_pk_bf16_f32 v78, v84, v85
    v_cvt_pk_bf16_f32 v79, v86, v87
    buffer_store_dwordx4 v[76:79], v1, s[24:27], s45 offen sc1
    v_accvgpr_read_b32 v68, a64
    v_accvgpr_read_b32 v69, a65
    v_accvgpr_read_b32 v70, a66
    v_accvgpr_read_b32 v71, a67
    v_accvgpr_read_b32 v72, a80
    v_accvgpr_read_b32 v73, a81
    v_accvgpr_read_b32 v74, a82
    v_accvgpr_read_b32 v75, a83
    v_pk_mul_f32 v[68:69], v[68:69], v[12:13]
    v_pk_mul_f32 v[70:71], v[70:71], v[12:13]
    v_pk_mul_f32 v[72:73], v[72:73], v[12:13]
    v_pk_mul_f32 v[74:75], v[74:75], v[12:13]
    v_cvt_pk_bf16_f32 v64, v68, v69
    v_cvt_pk_bf16_f32 v65, v70, v71
    v_cvt_pk_bf16_f32 v66, v72, v73
    v_cvt_pk_bf16_f32 v67, v74, v75
    buffer_store_dwordx4 v[64:67], v1, s[24:27], s46 offen sc1
    v_accvgpr_read_b32 v80, a96
    v_accvgpr_read_b32 v81, a97
    v_accvgpr_read_b32 v82, a98
    v_accvgpr_read_b32 v83, a99
    v_accvgpr_read_b32 v84, a112
    v_accvgpr_read_b32 v85, a113
    v_accvgpr_read_b32 v86, a114
    v_accvgpr_read_b32 v87, a115
    v_pk_mul_f32 v[80:81], v[80:81], v[12:13]
    v_pk_mul_f32 v[82:83], v[82:83], v[12:13]
    v_pk_mul_f32 v[84:85], v[84:85], v[12:13]
    v_pk_mul_f32 v[86:87], v[86:87], v[12:13]
    v_cvt_pk_bf16_f32 v76, v80, v81
    v_cvt_pk_bf16_f32 v77, v82, v83
    v_cvt_pk_bf16_f32 v78, v84, v85
    v_cvt_pk_bf16_f32 v79, v86, v87
    buffer_store_dwordx4 v[76:79], v1, s[24:27], s47 offen sc1
    v_accvgpr_read_b32 v68, a4
    v_accvgpr_read_b32 v69, a5
    v_accvgpr_read_b32 v70, a6
    v_accvgpr_read_b32 v71, a7
    v_accvgpr_read_b32 v72, a20
    v_accvgpr_read_b32 v73, a21
    v_accvgpr_read_b32 v74, a22
    v_accvgpr_read_b32 v75, a23
    v_pk_mul_f32 v[68:69], v[68:69], v[48:49]
    v_pk_mul_f32 v[70:71], v[70:71], v[48:49]
    v_pk_mul_f32 v[72:73], v[72:73], v[48:49]
    v_pk_mul_f32 v[74:75], v[74:75], v[48:49]
    v_cvt_pk_bf16_f32 v64, v68, v69
    v_cvt_pk_bf16_f32 v65, v70, v71
    v_cvt_pk_bf16_f32 v66, v72, v73
    v_cvt_pk_bf16_f32 v67, v74, v75
    buffer_store_dwordx4 v[64:67], v1, s[24:27], s48 offen sc1
    v_accvgpr_read_b32 v80, a36
    v_accvgpr_read_b32 v81, a37
    v_accvgpr_read_b32 v82, a38
    v_accvgpr_read_b32 v83, a39
    v_accvgpr_read_b32 v84, a52
    v_accvgpr_read_b32 v85, a53
    v_accvgpr_read_b32 v86, a54
    v_accvgpr_read_b32 v87, a55
    v_pk_mul_f32 v[80:81], v[80:81], v[48:49]
    v_pk_mul_f32 v[82:83], v[82:83], v[48:49]
    v_pk_mul_f32 v[84:85], v[84:85], v[48:49]
    v_pk_mul_f32 v[86:87], v[86:87], v[48:49]
    v_cvt_pk_bf16_f32 v76, v80, v81
    v_cvt_pk_bf16_f32 v77, v82, v83
    v_cvt_pk_bf16_f32 v78, v84, v85
    v_cvt_pk_bf16_f32 v79, v86, v87
    buffer_store_dwordx4 v[76:79], v1, s[24:27], s49 offen sc1
    v_accvgpr_read_b32 v68, a68
    v_accvgpr_read_b32 v69, a69
    v_accvgpr_read_b32 v70, a70
    v_accvgpr_read_b32 v71, a71
    v_accvgpr_read_b32 v72, a84
    v_accvgpr_read_b32 v73, a85
    v_accvgpr_read_b32 v74, a86
    v_accvgpr_read_b32 v75, a87
    v_pk_mul_f32 v[68:69], v[68:69], v[48:49]
    v_pk_mul_f32 v[70:71], v[70:71], v[48:49]
    v_pk_mul_f32 v[72:73], v[72:73], v[48:49]
    v_pk_mul_f32 v[74:75], v[74:75], v[48:49]
    v_cvt_pk_bf16_f32 v64, v68, v69
    v_cvt_pk_bf16_f32 v65, v70, v71
    v_cvt_pk_bf16_f32 v66, v72, v73
    v_cvt_pk_bf16_f32 v67, v74, v75
    buffer_store_dwordx4 v[64:67], v1, s[24:27], s50 offen sc1
    v_accvgpr_read_b32 v80, a100
    v_accvgpr_read_b32 v81, a101
    v_accvgpr_read_b32 v82, a102
    v_accvgpr_read_b32 v83, a103
    v_accvgpr_read_b32 v84, a116
    v_accvgpr_read_b32 v85, a117
    v_accvgpr_read_b32 v86, a118
    v_accvgpr_read_b32 v87, a119
    v_pk_mul_f32 v[80:81], v[80:81], v[48:49]
    v_pk_mul_f32 v[82:83], v[82:83], v[48:49]
    v_pk_mul_f32 v[84:85], v[84:85], v[48:49]
    v_pk_mul_f32 v[86:87], v[86:87], v[48:49]
    v_cvt_pk_bf16_f32 v76, v80, v81
    v_cvt_pk_bf16_f32 v77, v82, v83
    v_cvt_pk_bf16_f32 v78, v84, v85
    v_cvt_pk_bf16_f32 v79, v86, v87
    buffer_store_dwordx4 v[76:79], v1, s[24:27], s51 offen sc1
    s_nop 1
    s_lshr_b32 s31, s2, 3
    s_bfe_u32 s56, s2, 0x10002
    s_and_b32 s54, s2, 1
    s_and_b32 s55, s31, 7
    s_lshl_b32 s54, s54, 3
    s_add_u32 s54, s54, s55
    s_and_b32 s55, s2, 2
    s_lshl_b32 s55, s55, 1
    s_lshr_b32 s31, s31, 3
    s_add_u32 s55, s55, s31
    v_lshrrev_b32 v87, 4, v1
    v_lshrrev_b32 v72, 4, v87
    s_lshl_b32 s57, s54, 7
    s_lshl_b32 s31, s30, 5
    s_add_u32 s57, s57, s31
    s_lshl_b32 s31, s57, 6
    v_add_u32 v88, s31, v1
    v_add_u32 v89, 0x20000, v88
    v_bfe_u32 v84, v87, 1, 3
    v_xor_b32 v84, v84, v72
    v_and_b32 v85, 16, v1
    v_lshl_add_u32 v85, v72, 11, v85
    s_lshl_b32 s31, s30, 15
    s_lshl_b32 s58, s55, 8
    s_add_u32 s31, s31, s58
    v_add_u32 v85, s31, v85
    v_xor_b32 v86, 0, v84
    v_lshl_add_u32 v86, v86, 5, v85
    v_add_u32 v90, 0, v86
    v_xor_b32 v86, 4, v84
    v_lshl_add_u32 v86, v86, 5, v85
    v_add_u32 v91, 7168, v86
    v_xor_b32 v86, 0, v84
    v_lshl_add_u32 v86, v86, 5, v85
    v_add_u32 v92, 14336, v86
    v_xor_b32 v86, 4, v84
    v_lshl_add_u32 v86, v86, 5, v85
    v_add_u32 v93, 21504, v86
    v_and_b32 v84, 15, v87
    v_add_u32 v85, s57, v84
    v_lshlrev_b32 v77, 2, v85
    v_lshl_add_u32 v77, v72, 13, v77
    s_lshl_b32 s31, s56, 7
    s_add_u32 s58, s58, s31
    v_lshl_add_u32 v80, v72, 3, s58
    v_lshl_add_u32 v78, v85, 11, v80
    v_add_u32 v79, 0x8000, v78
    v_lshrrev_b32 v85, 2, v84
    v_lshl_add_u32 v85, v72, 2, v85
    v_and_b32 v84, 7, v85
    s_lshl_b32 s31, s56, 2
    v_xor_b32 v84, s31, v84
    v_lshlrev_b32 v85, 8, v85
    v_and_b32 v86, 3, v87
    v_lshl_add_u32 v85, v86, 3, v85
    s_add_u32 s31, s2, 1
    s_and_b32 s31, s31, 3
    v_add_u32 v73, s31, v86
    v_and_b32 v73, 3, v73
    v_lshlrev_b32 v73, 7, v73
    v_xor_b32 v86, 0, v84
    v_lshl_add_u32 v64, v86, 5, v85
    v_xor_b32 v86, 1, v84
    v_lshl_add_u32 v65, v86, 5, v85
    v_xor_b32 v86, 2, v84
    v_lshl_add_u32 v66, v86, 5, v85
    v_xor_b32 v86, 3, v84
    v_lshl_add_u32 v67, v86, 5, v85
    v_xor_b32 v86, 4, v84
    v_lshl_add_u32 v68, v86, 5, v85
    v_xor_b32 v86, 5, v84
    v_lshl_add_u32 v69, v86, 5, v85
    v_xor_b32 v86, 6, v84
    v_lshl_add_u32 v70, v86, 5, v85
    v_xor_b32 v86, 7, v84
    v_lshl_add_u32 v71, v86, 5, v85
    s_lshl_b32 s61, s31, 20
    s_lshl_b32 s62, s31, 21
    s_lshl_b32 s60, s30, 12
    s_lshl_b32 s59, s54, 10
    s_lshl_b32 s31, s56, 9
    s_add_u32 s59, s59, s31
    s_lshr_b32 s31, s28, 2
    s_lshl_b32 s31, s31, 7
    s_lshl_b32 s57, s29, 10
    s_sub_u32 s58, 0x3c00, s57
    s_add_u32 s57, s57, s31
    s_add_u32 s58, s58, s31
    v_mov_b32 v75, 0
    v_mov_b32 v76, 1
    s_lshl_b32 s31, s56, 23
    s_add_u32 s31, s31, 0x3000000
    s_add_u32 s8, s6, s31
    s_addc_u32 s9, s7, 0
    s_and_b32 s9, s9, 0xffff
    s_mov_b32 s10, 0x800000
    s_lshl_b32 s31, s56, 22
    s_waitcnt lgkmcnt(0)
    s_add_u32 s12, s4, s31
    s_addc_u32 s13, s5, 0
    s_and_b32 s13, s13, 0xffff
    s_mov_b32 s14, 0x400000
    s_load_dwordx2 s[4:5], s[0:1], 80
    v_mov_b32 v12, -1
    v_mov_b32 v13, -1
    v_mov_b32 v14, -1
    v_mov_b32 v15, -1
    s_waitcnt lgkmcnt(0)
    s_mov_b32 s26, -1
    s_lshl_b32 s31, s2, 14
    s_add_u32 s31, s31, s60
    s_add_u32 s40, s31, 0x2000000
    buffer_store_dwordx4 v[12:15], v1, s[24:27], s40 offen offset:0 sc1
    buffer_store_dwordx4 v[12:15], v1, s[24:27], s40 offen offset:1024 sc1
    buffer_store_dwordx4 v[12:15], v1, s[24:27], s40 offen offset:2048 sc1
    buffer_store_dwordx4 v[12:15], v1, s[24:27], s40 offen offset:3072 sc1
    s_lshr_b32 s31, s31, 2
    s_add_u32 s40, s31, 0x1900000
    buffer_store_dwordx4 v[12:15], v1, s[24:27], s40 offen sc1
    s_mov_b32 s26, 0x1000000
    s_and_b32 s31, s2, 7
    s_mul_i32 s31, s31, 28
    s_lshr_b32 s40, s2, 3
    s_add_u32 s31, s31, s40
    s_lshl_b32 s31, s31, 15
    s_lshl_b32 s40, s30, 13
    s_add_u32 s31, s31, s40
    s_mov_b32 s44, s4
    s_mov_b32 s47, 0x00020000
    s_and_b32 s45, s5, 0xffff
    s_cmp_ge_u32 s2, 224
    s_cselect_b32 s46, 0, 7340032
    s_add_u32 m0, s40, 131072
    s_nop 0
    buffer_load_dwordx4 v1, s[44:47], s31 offen offset:0 lds
    buffer_load_dwordx4 v1, s[44:47], s31 offen offset:1024 lds
    buffer_load_dwordx4 v1, s[44:47], s31 offen offset:2048 lds
    buffer_load_dwordx4 v1, s[44:47], s31 offen offset:3072 lds
    s_add_u32 s31, s31, 4096
    s_add_u32 m0, s40, 135168
    s_nop 0
    buffer_load_dwordx4 v1, s[44:47], s31 offen offset:0 lds
    buffer_load_dwordx4 v1, s[44:47], s31 offen offset:1024 lds
    buffer_load_dwordx4 v1, s[44:47], s31 offen offset:2048 lds
    buffer_load_dwordx4 v1, s[44:47], s31 offen offset:3072 lds
    s_add_u32 s31, s31, 4096
    s_lshl_b32 s63, s29, 1
    s_sub_u32 s63, 13, s63
    s_cbranch_scc1 k2_sdone_111
k2_sloop_110:
    v_mfma_f32_16x16x32_bf16 v[248:251], v[60:63], v[192:195], v[248:251]
    v_exp_f32 v232, v160
    v_mfma_f32_16x16x32_bf16 v[248:251], v[60:63], v[200:203], v[248:251]
    s_mov_b32 m0, s35
    ds_read_b128 a[224:227], v3 offset:4096
    v_mfma_f32_16x16x32_bf16 v[252:255], v[60:63], v[204:207], v[252:255]
    s_add_u32 s53, s53, 16384
    buffer_load_dwordx4 v1, s[20:23], s33 offen offset:0 sc1 lds
    ds_read_b128 a[228:231], v3 offset:12288
    v_mfma_f32_16x16x32_bf16 v[252:255], v[60:63], v[196:199], v[252:255]
    s_waitcnt lgkmcnt(8)
    v_exp_f32 v233, v161
    v_mfma_f32_16x16x32_bf16 a[12:15], a[192:195], v[196:199], a[12:15]
    s_and_b32 s53, s53, 0xffff
    v_exp_f32 v234, v162
    v_mfma_f32_16x16x32_bf16 a[12:15], a[196:199], v[204:207], a[12:15]
    ds_read_b128 a[232:235], v3 offset:5120
    v_cvt_pk_bf16_f32 v208, v232, v233
    v_mfma_f32_16x16x32_bf16 a[8:11], a[196:199], v[200:203], a[8:11]
    v_exp_f32 v235, v163
    v_mfma_f32_16x16x32_bf16 a[8:11], a[192:195], v[192:195], a[8:11]
    s_waitcnt lgkmcnt(7)
    ds_read_b128 a[236:239], v3 offset:13312
    v_cvt_pk_bf16_f32 v209, v234, v235
    v_mfma_f32_16x16x32_bf16 a[24:27], a[200:203], v[192:195], a[24:27]
    s_add_u32 s35, s35, 0x4000
    v_exp_f32 v236, v176
    v_mfma_f32_16x16x32_bf16 a[24:27], a[204:207], v[200:203], a[24:27]
    buffer_load_dwordx4 v1, s[20:23], s33 offen offset:1024 sc1 lds
    ds_read_b128 a[240:243], v3 offset:6144
    v_mfma_f32_16x16x32_bf16 a[28:31], a[204:207], v[204:207], a[28:31]
    v_exp_f32 v237, v177
    v_mfma_f32_16x16x32_bf16 a[28:31], a[200:203], v[196:199], a[28:31]
    s_waitcnt lgkmcnt(7)
    ds_read_b128 a[244:247], v3 offset:14336
    v_cvt_pk_bf16_f32 v210, v236, v237
    v_mfma_f32_16x16x32_bf16 a[44:47], a[208:211], v[196:199], a[44:47]
    v_exp_f32 v238, v178
    v_mfma_f32_16x16x32_bf16 a[44:47], a[212:215], v[204:207], a[44:47]
    ds_read_b128 a[248:251], v3 offset:7168
    v_or3_b32 v57, v208, v209, v210
    v_mfma_f32_16x16x32_bf16 a[40:43], a[212:215], v[200:203], a[40:43]
    v_exp_f32 v239, v179
    v_mfma_f32_16x16x32_bf16 a[40:43], a[208:211], v[192:195], a[40:43]
    s_waitcnt lgkmcnt(7)
    ds_read_b128 a[252:255], v3 offset:15360
    v_cvt_pk_bf16_f32 v211, v238, v239
    v_mfma_f32_16x16x32_bf16 a[56:59], a[216:219], v[192:195], a[56:59]
    s_and_b32 s35, s35, 0xffff
    v_exp_f32 v240, v164
    v_mfma_f32_16x16x32_bf16 a[56:59], a[220:223], v[200:203], a[56:59]
    ds_read_b128 a[128:131], v2 offset:0
    v_add_u32 v3, s53, v56
    v_mfma_f32_16x16x32_bf16 a[60:63], a[220:223], v[204:207], a[60:63]
    v_exp_f32 v241, v165
    v_mfma_f32_16x16x32_bf16 a[60:63], a[216:219], v[196:199], a[60:63]
    s_waitcnt lgkmcnt(7)
    buffer_load_dwordx4 v1, s[20:23], s33 offen offset:2048 sc1 lds
    ds_read_b128 a[132:135], v2 offset:1024
    v_mfma_f32_16x16x32_bf16 a[76:79], a[224:227], v[196:199], a[76:79]
    v_exp_f32 v242, v166
    v_mfma_f32_16x16x32_bf16 a[76:79], a[228:231], v[204:207], a[76:79]
    s_or_b32 s35, s35, 0x10000
    ds_read_b128 a[136:139], v2 offset:2048
    v_cvt_pk_bf16_f32 v212, v240, v241
    v_mfma_f32_16x16x32_bf16 a[72:75], a[228:231], v[200:203], a[72:75]
    v_exp_f32 v243, v167
    v_mfma_f32_16x16x32_bf16 a[72:75], a[224:227], v[192:195], a[72:75]
    s_waitcnt lgkmcnt(7)
    ds_read_b128 a[140:143], v2 offset:3072
    v_or3_b32 v57, v57, v211, v212
    v_mfma_f32_16x16x32_bf16 a[88:91], a[232:235], v[192:195], a[88:91]
    v_exp_f32 v244, v180
    v_mfma_f32_16x16x32_bf16 a[88:91], a[236:239], v[200:203], a[88:91]
    ds_read_b128 a[144:147], v2 offset:4096
    v_cvt_pk_bf16_f32 v213, v242, v243
    v_mfma_f32_16x16x32_bf16 a[92:95], a[236:239], v[204:207], a[92:95]
    v_exp_f32 v245, v181
    v_mfma_f32_16x16x32_bf16 a[92:95], a[232:235], v[196:199], a[92:95]
    s_waitcnt lgkmcnt(7)
    buffer_load_dwordx4 v1, s[20:23], s33 offen offset:3072 sc1 lds
    ds_read_b128 a[148:151], v2 offset:5120
    v_mfma_f32_16x16x32_bf16 a[108:111], a[240:243], v[196:199], a[108:111]
    s_add_u32 s33, s33, 0x80000
    v_exp_f32 v246, v182
    v_mfma_f32_16x16x32_bf16 a[108:111], a[244:247], v[204:207], a[108:111]
    ds_read_b128 a[152:155], v2 offset:6144
    v_cvt_pk_bf16_f32 v214, v244, v245
    v_mfma_f32_16x16x32_bf16 a[104:107], a[244:247], v[200:203], a[104:107]
    v_exp_f32 v247, v183
    v_mfma_f32_16x16x32_bf16 a[104:107], a[240:243], v[192:195], a[104:107]
    s_waitcnt lgkmcnt(7)
    ds_read_b128 a[156:159], v2 offset:7168
    v_or3_b32 v57, v57, v213, v214
    v_mfma_f32_16x16x32_bf16 a[120:123], a[248:251], v[192:195], a[120:123]
    v_exp_f32 v232, v168
    v_mfma_f32_16x16x32_bf16 a[120:123], a[252:255], v[200:203], a[120:123]
    ds_read_b128 a[160:163], v2 offset:8192
    v_cvt_pk_bf16_f32 v215, v246, v247
    v_mfma_f32_16x16x32_bf16 a[124:127], a[252:255], v[204:207], a[124:127]
    v_exp_f32 v233, v169
    v_mfma_f32_16x16x32_bf16 a[124:127], a[248:251], v[196:199], a[124:127]
    s_waitcnt lgkmcnt(7)
    ds_read_b128 a[164:167], v2 offset:9216
    v_cvt_pk_bf16_f32 v216, v232, v233
    v_mfma_f32_16x16x32_bf16 v[128:131], a[128:131], v[96:99], v[16:19]
    s_waitcnt vmcnt(12)
    s_barrier
    v_exp_f32 v234, v170
    v_mfma_f32_16x16x32_bf16 v[128:131], a[132:135], v[100:103], v[128:131]
    s_waitcnt lgkmcnt(6)
    ds_read_b128 a[168:171], v2 offset:10240
    v_or3_b32 v57, v57, v215, v216
    v_mfma_f32_16x16x32_bf16 v[128:131], a[136:139], v[104:107], v[128:131]
    s_mov_b32 m0, s34
    v_exp_f32 v235, v171
    v_mfma_f32_16x16x32_bf16 v[128:131], a[140:143], v[108:111], v[128:131]
    s_add_u32 s36, s36, 64
    buffer_load_dwordx4 v1, s[16:19], s32 offen offset:0 sc1 lds
    ds_read_b128 a[172:175], v2 offset:11264
    v_mfma_f32_16x16x32_bf16 v[132:135], a[140:143], v[124:127], v[20:23]
    v_exp_f32 v236, v184
    v_mfma_f32_16x16x32_bf16 v[132:135], a[136:139], v[120:123], v[132:135]
    ds_read_b128 a[176:179], v2 offset:12288
    v_cvt_pk_bf16_f32 v217, v234, v235
    v_mfma_f32_16x16x32_bf16 v[132:135], a[132:135], v[116:119], v[132:135]
    s_add_u32 s52, s52, 16384
    v_exp_f32 v237, v185
    v_mfma_f32_16x16x32_bf16 v[132:135], a[128:131], v[112:115], v[132:135]
    s_waitcnt lgkmcnt(7)
    ds_read_b128 a[180:183], v2 offset:13312
    v_cvt_pk_bf16_f32 v218, v236, v237
    v_mfma_f32_16x16x32_bf16 v[148:151], a[144:147], v[112:115], v[36:39]
    s_add_u32 s34, s34, 0x4000
    v_exp_f32 v238, v186
    v_mfma_f32_16x16x32_bf16 v[148:151], a[148:151], v[116:119], v[148:151]
    s_waitcnt lgkmcnt(6)
    buffer_load_dwordx4 v1, s[16:19], s32 offen offset:1024 sc1 lds
    ds_read_b128 a[184:187], v2 offset:14336
    v_mfma_f32_16x16x32_bf16 v[148:151], a[152:155], v[120:123], v[148:151]
    s_and_b32 s52, s52, 0xffff
    v_exp_f32 v239, v187
    v_mfma_f32_16x16x32_bf16 v[148:151], a[156:159], v[124:127], v[148:151]
    ds_read_b128 a[188:191], v2 offset:15360
    v_or3_b32 v57, v57, v217, v218
    v_mfma_f32_16x16x32_bf16 v[144:147], a[156:159], v[108:111], v[32:35]
    v_exp_f32 v240, v172
    v_mfma_f32_16x16x32_bf16 v[144:147], a[152:155], v[104:107], v[144:147]
    v_cvt_pk_bf16_f32 v219, v238, v239
    v_add_u32 v2, s52, v1
    v_mfma_f32_16x16x32_bf16 v[144:147], a[148:151], v[100:103], v[144:147]
    s_and_b32 s34, s34, 0xffff
    v_exp_f32 v241, v173
    v_mfma_f32_16x16x32_bf16 v[144:147], a[144:147], v[96:99], v[144:147]
    s_waitcnt lgkmcnt(6)
    ds_read_b128 a[192:195], v3 offset:0
    v_cvt_pk_bf16_f32 v220, v240, v241
    v_mfma_f32_16x16x32_bf16 v[136:139], a[160:163], v[96:99], v[24:27]
    v_exp_f32 v242, v174
    v_mfma_f32_16x16x32_bf16 v[136:139], a[164:167], v[100:103], v[136:139]
    s_waitcnt lgkmcnt(5)
    buffer_load_dwordx4 v1, s[16:19], s32 offen offset:2048 sc1 lds
    ds_read_b128 a[196:199], v3 offset:8192
    v_mfma_f32_16x16x32_bf16 v[136:139], a[168:171], v[104:107], v[136:139]
    v_exp_f32 v243, v175
    v_mfma_f32_16x16x32_bf16 v[136:139], a[172:175], v[108:111], v[136:139]
    ds_read_b128 a[200:203], v3 offset:1024
    v_or3_b32 v57, v57, v219, v220
    v_mfma_f32_16x16x32_bf16 v[140:143], a[172:175], v[124:127], v[28:31]
    v_exp_f32 v244, v188
    v_mfma_f32_16x16x32_bf16 v[140:143], a[168:171], v[120:123], v[140:143]
    ds_read_b128 a[204:207], v3 offset:9216
    v_cvt_pk_bf16_f32 v221, v242, v243
    v_mfma_f32_16x16x32_bf16 v[140:143], a[164:167], v[116:119], v[140:143]
    v_exp_f32 v245, v189
    v_mfma_f32_16x16x32_bf16 v[140:143], a[160:163], v[112:115], v[140:143]
    s_waitcnt lgkmcnt(6)
    buffer_load_dwordx4 v1, s[16:19], s32 offen offset:3072 sc1 lds
    ds_read_b128 a[208:211], v3 offset:2048
    v_mfma_f32_16x16x32_bf16 v[156:159], a[176:179], v[112:115], v[44:47]
    s_add_u32 s32, s32, 0x80000
    v_exp_f32 v246, v190
    v_mfma_f32_16x16x32_bf16 v[156:159], a[180:183], v[116:119], v[156:159]
    s_waitcnt lgkmcnt(5)
    ds_read_b128 a[212:215], v3 offset:10240
    v_cvt_pk_bf16_f32 v222, v244, v245
    v_mfma_f32_16x16x32_bf16 v[156:159], a[184:187], v[120:123], v[156:159]
    v_exp_f32 v247, v191
    v_mfma_f32_16x16x32_bf16 v[156:159], a[188:191], v[124:127], v[156:159]
    ds_read_b128 a[216:219], v3 offset:3072
    v_or3_b32 v57, v57, v221, v222
    v_mfma_f32_16x16x32_bf16 v[152:155], a[188:191], v[108:111], v[40:43]
    ds_read_b128 a[220:223], v3 offset:11264
    v_cvt_pk_bf16_f32 v223, v246, v247
    v_mfma_f32_16x16x32_bf16 v[152:155], a[184:187], v[104:107], v[152:155]
    v_bitop3_b32 v57, v57, v223, s37 bitop3:0xa8
    v_cmp_ne_u32 vcc, 0, v57
    v_mfma_f32_16x16x32_bf16 v[152:155], a[180:183], v[100:103], v[152:155]
    v_mfma_f32_16x16x32_bf16 v[152:155], a[176:179], v[96:99], v[152:155]
    s_cbranch_vccnz k2_tramp_112
k2_ret_113:
    v_mfma_f32_16x16x32_bf16 v[248:251], v[60:63], v[208:211], v[248:251]
    v_exp_f32 v232, v128
    v_mfma_f32_16x16x32_bf16 v[248:251], v[60:63], v[216:219], v[248:251]
    s_mov_b32 m0, s35
    ds_read_b128 a[224:227], v3 offset:4096
    v_mfma_f32_16x16x32_bf16 v[252:255], v[60:63], v[220:223], v[252:255]
    s_add_u32 s53, s53, 16384
    buffer_load_dwordx4 v1, s[20:23], s33 offen offset:0 sc1 lds
    ds_read_b128 a[228:231], v3 offset:12288
    v_mfma_f32_16x16x32_bf16 v[252:255], v[60:63], v[212:215], v[252:255]
    s_waitcnt lgkmcnt(8)
    v_exp_f32 v233, v129
    v_mfma_f32_16x16x32_bf16 a[12:15], a[192:195], v[212:215], a[12:15]
    s_and_b32 s53, s53, 0xffff
    v_exp_f32 v234, v130
    v_mfma_f32_16x16x32_bf16 a[12:15], a[196:199], v[220:223], a[12:15]
    ds_read_b128 a[232:235], v3 offset:5120
    v_cvt_pk_bf16_f32 v192, v232, v233
    v_mfma_f32_16x16x32_bf16 a[8:11], a[196:199], v[216:219], a[8:11]
    v_exp_f32 v235, v131
    v_mfma_f32_16x16x32_bf16 a[8:11], a[192:195], v[208:211], a[8:11]
    s_waitcnt lgkmcnt(7)
    ds_read_b128 a[236:239], v3 offset:13312
    v_cvt_pk_bf16_f32 v193, v234, v235
    v_mfma_f32_16x16x32_bf16 a[24:27], a[200:203], v[208:211], a[24:27]
    s_add_u32 s35, s35, 0x4000
    v_exp_f32 v236, v144
    v_mfma_f32_16x16x32_bf16 a[24:27], a[204:207], v[216:219], a[24:27]
    buffer_load_dwordx4 v1, s[20:23], s33 offen offset:1024 sc1 lds
    ds_read_b128 a[240:243], v3 offset:6144
    v_mfma_f32_16x16x32_bf16 a[28:31], a[204:207], v[220:223], a[28:31]
    v_exp_f32 v237, v145
    v_mfma_f32_16x16x32_bf16 a[28:31], a[200:203], v[212:215], a[28:31]
    s_waitcnt lgkmcnt(7)
    ds_read_b128 a[244:247], v3 offset:14336
    v_cvt_pk_bf16_f32 v194, v236, v237
    v_mfma_f32_16x16x32_bf16 a[44:47], a[208:211], v[212:215], a[44:47]
    v_exp_f32 v238, v146
    v_mfma_f32_16x16x32_bf16 a[44:47], a[212:215], v[220:223], a[44:47]
    ds_read_b128 a[248:251], v3 offset:7168
    v_or3_b32 v57, v192, v193, v194
    v_mfma_f32_16x16x32_bf16 a[40:43], a[212:215], v[216:219], a[40:43]
    v_exp_f32 v239, v147
    v_mfma_f32_16x16x32_bf16 a[40:43], a[208:211], v[208:211], a[40:43]
    s_waitcnt lgkmcnt(7)
    ds_read_b128 a[252:255], v3 offset:15360
    v_cvt_pk_bf16_f32 v195, v238, v239
    v_mfma_f32_16x16x32_bf16 a[56:59], a[216:219], v[208:211], a[56:59]
    s_and_b32 s35, s35, 0xffff
    v_exp_f32 v240, v132
    v_mfma_f32_16x16x32_bf16 a[56:59], a[220:223], v[216:219], a[56:59]
    ds_read_b128 a[128:131], v2 offset:0
    v_add_u32 v3, s53, v56
    v_mfma_f32_16x16x32_bf16 a[60:63], a[220:223], v[220:223], a[60:63]
    v_exp_f32 v241, v133
    v_mfma_f32_16x16x32_bf16 a[60:63], a[216:219], v[212:215], a[60:63]
    s_waitcnt lgkmcnt(7)
    buffer_load_dwordx4 v1, s[20:23], s33 offen offset:2048 sc1 lds
    ds_read_b128 a[132:135], v2 offset:1024
    v_mfma_f32_16x16x32_bf16 a[76:79], a[224:227], v[212:215], a[76:79]
    v_exp_f32 v242, v134
    v_mfma_f32_16x16x32_bf16 a[76:79], a[228:231], v[220:223], a[76:79]
    s_or_b32 s35, s35, 0x10000
    ds_read_b128 a[136:139], v2 offset:2048
    v_cvt_pk_bf16_f32 v196, v240, v241
    v_mfma_f32_16x16x32_bf16 a[72:75], a[228:231], v[216:219], a[72:75]
    v_exp_f32 v243, v135
    v_mfma_f32_16x16x32_bf16 a[72:75], a[224:227], v[208:211], a[72:75]
    s_waitcnt lgkmcnt(7)
    ds_read_b128 a[140:143], v2 offset:3072
    v_or3_b32 v57, v57, v195, v196
    v_mfma_f32_16x16x32_bf16 a[88:91], a[232:235], v[208:211], a[88:91]
    v_exp_f32 v244, v148
    v_mfma_f32_16x16x32_bf16 a[88:91], a[236:239], v[216:219], a[88:91]
    ds_read_b128 a[144:147], v2 offset:4096
    v_cvt_pk_bf16_f32 v197, v242, v243
    v_mfma_f32_16x16x32_bf16 a[92:95], a[236:239], v[220:223], a[92:95]
    v_exp_f32 v245, v149
    v_mfma_f32_16x16x32_bf16 a[92:95], a[232:235], v[212:215], a[92:95]
    s_waitcnt lgkmcnt(7)
    buffer_load_dwordx4 v1, s[20:23], s33 offen offset:3072 sc1 lds
    ds_read_b128 a[148:151], v2 offset:5120
    v_mfma_f32_16x16x32_bf16 a[108:111], a[240:243], v[212:215], a[108:111]
    s_add_u32 s33, s33, 0x80000
    v_exp_f32 v246, v150
    v_mfma_f32_16x16x32_bf16 a[108:111], a[244:247], v[220:223], a[108:111]
    ds_read_b128 a[152:155], v2 offset:6144
    v_cvt_pk_bf16_f32 v198, v244, v245
    v_mfma_f32_16x16x32_bf16 a[104:107], a[244:247], v[216:219], a[104:107]
    v_exp_f32 v247, v151
    v_mfma_f32_16x16x32_bf16 a[104:107], a[240:243], v[208:211], a[104:107]
    s_waitcnt lgkmcnt(7)
    ds_read_b128 a[156:159], v2 offset:7168
    v_or3_b32 v57, v57, v197, v198
    v_mfma_f32_16x16x32_bf16 a[120:123], a[248:251], v[208:211], a[120:123]
    v_exp_f32 v232, v136
    v_mfma_f32_16x16x32_bf16 a[120:123], a[252:255], v[216:219], a[120:123]
    ds_read_b128 a[160:163], v2 offset:8192
    v_cvt_pk_bf16_f32 v199, v246, v247
    v_mfma_f32_16x16x32_bf16 a[124:127], a[252:255], v[220:223], a[124:127]
    v_exp_f32 v233, v137
    v_mfma_f32_16x16x32_bf16 a[124:127], a[248:251], v[212:215], a[124:127]
    s_waitcnt lgkmcnt(7)
    ds_read_b128 a[164:167], v2 offset:9216
    v_cvt_pk_bf16_f32 v200, v232, v233
    v_mfma_f32_16x16x32_bf16 v[160:163], a[128:131], v[96:99], v[16:19]
    s_waitcnt vmcnt(12)
    s_barrier
    v_exp_f32 v234, v138
    v_mfma_f32_16x16x32_bf16 v[160:163], a[132:135], v[100:103], v[160:163]
    s_waitcnt lgkmcnt(6)
    ds_read_b128 a[168:171], v2 offset:10240
    v_or3_b32 v57, v57, v199, v200
    v_mfma_f32_16x16x32_bf16 v[160:163], a[136:139], v[104:107], v[160:163]
    s_mov_b32 m0, s34
    v_exp_f32 v235, v139
    v_mfma_f32_16x16x32_bf16 v[160:163], a[140:143], v[108:111], v[160:163]
    s_add_u32 s36, s36, 64
    buffer_load_dwordx4 v1, s[16:19], s32 offen offset:0 sc1 lds
    ds_read_b128 a[172:175], v2 offset:11264
    v_mfma_f32_16x16x32_bf16 v[164:167], a[140:143], v[124:127], v[20:23]
    v_exp_f32 v236, v152
    v_mfma_f32_16x16x32_bf16 v[164:167], a[136:139], v[120:123], v[164:167]
    ds_read_b128 a[176:179], v2 offset:12288
    v_cvt_pk_bf16_f32 v201, v234, v235
    v_mfma_f32_16x16x32_bf16 v[164:167], a[132:135], v[116:119], v[164:167]
    s_add_u32 s52, s52, 16384
    v_exp_f32 v237, v153
    v_mfma_f32_16x16x32_bf16 v[164:167], a[128:131], v[112:115], v[164:167]
    s_waitcnt lgkmcnt(7)
    ds_read_b128 a[180:183], v2 offset:13312
    v_cvt_pk_bf16_f32 v202, v236, v237
    v_mfma_f32_16x16x32_bf16 v[180:183], a[144:147], v[112:115], v[36:39]
    s_add_u32 s34, s34, 0x4000
    v_exp_f32 v238, v154
    v_mfma_f32_16x16x32_bf16 v[180:183], a[148:151], v[116:119], v[180:183]
    s_waitcnt lgkmcnt(6)
    buffer_load_dwordx4 v1, s[16:19], s32 offen offset:1024 sc1 lds
    ds_read_b128 a[184:187], v2 offset:14336
    v_mfma_f32_16x16x32_bf16 v[180:183], a[152:155], v[120:123], v[180:183]
    s_and_b32 s52, s52, 0xffff
    v_exp_f32 v239, v155
    v_mfma_f32_16x16x32_bf16 v[180:183], a[156:159], v[124:127], v[180:183]
    ds_read_b128 a[188:191], v2 offset:15360
    v_or3_b32 v57, v57, v201, v202
    v_mfma_f32_16x16x32_bf16 v[176:179], a[156:159], v[108:111], v[32:35]
    v_exp_f32 v240, v140
    v_mfma_f32_16x16x32_bf16 v[176:179], a[152:155], v[104:107], v[176:179]
    v_cvt_pk_bf16_f32 v203, v238, v239
    v_add_u32 v2, s52, v1
    v_mfma_f32_16x16x32_bf16 v[176:179], a[148:151], v[100:103], v[176:179]
    s_and_b32 s34, s34, 0xffff
    v_exp_f32 v241, v141
    v_mfma_f32_16x16x32_bf16 v[176:179], a[144:147], v[96:99], v[176:179]
    s_waitcnt lgkmcnt(6)
    ds_read_b128 a[192:195], v3 offset:0
    v_cvt_pk_bf16_f32 v204, v240, v241
    v_mfma_f32_16x16x32_bf16 v[168:171], a[160:163], v[96:99], v[24:27]
    v_exp_f32 v242, v142
    v_mfma_f32_16x16x32_bf16 v[168:171], a[164:167], v[100:103], v[168:171]
    s_waitcnt lgkmcnt(5)
    buffer_load_dwordx4 v1, s[16:19], s32 offen offset:2048 sc1 lds
    ds_read_b128 a[196:199], v3 offset:8192
    v_mfma_f32_16x16x32_bf16 v[168:171], a[168:171], v[104:107], v[168:171]
    v_exp_f32 v243, v143
    v_mfma_f32_16x16x32_bf16 v[168:171], a[172:175], v[108:111], v[168:171]
    ds_read_b128 a[200:203], v3 offset:1024
    v_or3_b32 v57, v57, v203, v204
    v_mfma_f32_16x16x32_bf16 v[172:175], a[172:175], v[124:127], v[28:31]
    v_exp_f32 v244, v156
    v_mfma_f32_16x16x32_bf16 v[172:175], a[168:171], v[120:123], v[172:175]
    ds_read_b128 a[204:207], v3 offset:9216
    v_cvt_pk_bf16_f32 v205, v242, v243
    v_mfma_f32_16x16x32_bf16 v[172:175], a[164:167], v[116:119], v[172:175]
    v_exp_f32 v245, v157
    v_mfma_f32_16x16x32_bf16 v[172:175], a[160:163], v[112:115], v[172:175]
    s_waitcnt lgkmcnt(6)
    buffer_load_dwordx4 v1, s[16:19], s32 offen offset:3072 sc1 lds
    ds_read_b128 a[208:211], v3 offset:2048
    v_mfma_f32_16x16x32_bf16 v[188:191], a[176:179], v[112:115], v[44:47]
    s_sub_u32 s63, s63, 1
    v_exp_f32 v246, v158
    v_mfma_f32_16x16x32_bf16 v[188:191], a[180:183], v[116:119], v[188:191]
    s_waitcnt lgkmcnt(5)
    ds_read_b128 a[212:215], v3 offset:10240
    v_cvt_pk_bf16_f32 v206, v244, v245
    v_mfma_f32_16x16x32_bf16 v[188:191], a[184:187], v[120:123], v[188:191]
    s_add_u32 s32, s32, 0x80000
    v_exp_f32 v247, v159
    v_mfma_f32_16x16x32_bf16 v[188:191], a[188:191], v[124:127], v[188:191]
    ds_read_b128 a[216:219], v3 offset:3072
    v_or3_b32 v57, v57, v205, v206
    v_mfma_f32_16x16x32_bf16 v[184:187], a[188:191], v[108:111], v[40:43]
    ds_read_b128 a[220:223], v3 offset:11264
    v_cvt_pk_bf16_f32 v207, v246, v247
    v_mfma_f32_16x16x32_bf16 v[184:187], a[184:187], v[104:107], v[184:187]
    v_bitop3_b32 v57, v57, v207, s37 bitop3:0xa8
    v_cmp_ne_u32 vcc, 0, v57
    v_mfma_f32_16x16x32_bf16 v[184:187], a[180:183], v[100:103], v[184:187]
    v_mfma_f32_16x16x32_bf16 v[184:187], a[176:179], v[96:99], v[184:187]
    s_cbranch_vccnz k2_tramp_114
k2_ret_115:
    s_cmp_lg_u32 s63, 0
    s_cbranch_scc1 k2_sloop_110
    v_mfma_f32_16x16x32_bf16 v[248:251], v[60:63], v[192:195], v[248:251]
    v_exp_f32 v232, v160
    v_mfma_f32_16x16x32_bf16 v[248:251], v[60:63], v[200:203], v[248:251]
    s_mov_b32 m0, s35
    ds_read_b128 a[224:227], v3 offset:4096
    v_exp_f32 v233, v161
    v_mfma_f32_16x16x32_bf16 v[252:255], v[60:63], v[204:207], v[252:255]
    s_add_u32 s53, s53, 16384
    buffer_load_dwordx4 v1, s[20:23], s33 offen offset:0 sc1 lds
    ds_read_b128 a[228:231], v3 offset:12288
    v_mfma_f32_16x16x32_bf16 v[252:255], v[60:63], v[196:199], v[252:255]
    s_waitcnt lgkmcnt(8)
    v_exp_f32 v234, v162
    v_cvt_pk_bf16_f32 v208, v232, v233
    v_mfma_f32_16x16x32_bf16 a[12:15], a[192:195], v[196:199], a[12:15]
    s_sub_u32 s40, s36, s39
    ds_read_b128 a[232:235], v3 offset:5120
    v_mfma_f32_16x16x32_bf16 a[12:15], a[196:199], v[204:207], a[12:15]
    s_and_b32 s53, s53, 0xffff
    v_subrev_u32 v6, s40, v4
    v_cmp_gt_i32 s[44:45], 0, v6
    v_mfma_f32_16x16x32_bf16 a[8:11], a[196:199], v[200:203], a[8:11]
    v_exp_f32 v235, v163
    v_cmp_gt_i32 s[46:47], 1, v6
    v_mfma_f32_16x16x32_bf16 a[8:11], a[192:195], v[192:195], a[8:11]
    s_waitcnt lgkmcnt(7)
    ds_read_b128 a[236:239], v3 offset:13312
    v_cmp_gt_i32 s[48:49], 2, v6
    v_cmp_gt_i32 s[50:51], 3, v6
    v_mfma_f32_16x16x32_bf16 a[24:27], a[200:203], v[192:195], a[24:27]
    s_add_u32 s35, s35, 0x4000
    v_exp_f32 v236, v176
    v_mfma_f32_16x16x32_bf16 a[24:27], a[204:207], v[200:203], a[24:27]
    ds_read_b128 a[240:243], v3 offset:6144
    v_cvt_pk_bf16_f32 v209, v234, v235
    v_cndmask_b32 v16, v10, v5, s[44:45]
    v_mfma_f32_16x16x32_bf16 a[28:31], a[204:207], v[204:207], a[28:31]
    v_exp_f32 v237, v177
    v_mfma_f32_16x16x32_bf16 a[28:31], a[200:203], v[196:199], a[28:31]
    s_waitcnt lgkmcnt(7)
    ds_read_b128 a[244:247], v3 offset:14336
    v_cndmask_b32 v17, v10, v5, s[46:47]
    v_cndmask_b32 v18, v10, v5, s[48:49]
    v_mfma_f32_16x16x32_bf16 a[44:47], a[208:211], v[196:199], a[44:47]
    buffer_load_dwordx4 v1, s[20:23], s33 offen offset:1024 sc1 lds
    ds_read_b128 a[248:251], v3 offset:7168
    v_mfma_f32_16x16x32_bf16 a[44:47], a[212:215], v[204:207], a[44:47]
    v_cndmask_b32 v19, v10, v5, s[50:51]
    v_cvt_pk_bf16_f32 v210, v236, v237
    v_mfma_f32_16x16x32_bf16 a[40:43], a[212:215], v[200:203], a[40:43]
    v_exp_f32 v238, v178
    v_cmp_gt_i32 s[44:45], 16, v6
    v_mfma_f32_16x16x32_bf16 a[40:43], a[208:211], v[192:195], a[40:43]
    s_waitcnt lgkmcnt(7)
    v_cmp_gt_i32 s[46:47], 17, v6
    v_cmp_gt_i32 s[48:49], 18, v6
    v_mfma_f32_16x16x32_bf16 a[56:59], a[216:219], v[192:195], a[56:59]
    s_and_b32 s35, s35, 0xffff
    v_exp_f32 v239, v179
    v_mfma_f32_16x16x32_bf16 a[56:59], a[220:223], v[200:203], a[56:59]
    ds_read_b128 a[252:255], v3 offset:15360
    v_or3_b32 v57, v208, v209, v210
    v_cmp_gt_i32 s[50:51], 19, v6
    v_mfma_f32_16x16x32_bf16 a[60:63], a[220:223], v[204:207], a[60:63]
    v_exp_f32 v240, v164
    v_mfma_f32_16x16x32_bf16 a[60:63], a[216:219], v[196:199], a[60:63]
    s_waitcnt lgkmcnt(6)
    v_cndmask_b32 v32, v10, v5, s[44:45]
    v_cvt_pk_bf16_f32 v211, v238, v239
    v_cndmask_b32 v33, v10, v5, s[46:47]
    v_mfma_f32_16x16x32_bf16 a[76:79], a[224:227], v[196:199], a[76:79]
    ds_read_b128 a[128:131], v2 offset:0
    v_cndmask_b32 v34, v10, v5, s[48:49]
    v_mfma_f32_16x16x32_bf16 a[76:79], a[228:231], v[204:207], a[76:79]
    s_or_b32 s35, s35, 0x10000
    v_add_u32 v3, s53, v56
    v_cndmask_b32 v35, v10, v5, s[50:51]
    v_mfma_f32_16x16x32_bf16 a[72:75], a[228:231], v[200:203], a[72:75]
    buffer_load_dwordx4 v1, s[20:23], s33 offen offset:2048 sc1 lds
    v_exp_f32 v241, v165
    v_mfma_f32_16x16x32_bf16 a[72:75], a[224:227], v[192:195], a[72:75]
    s_waitcnt lgkmcnt(5)
    ds_read_b128 a[132:135], v2 offset:1024
    v_cmp_gt_i32 s[44:45], 32, v6
    v_mfma_f32_16x16x32_bf16 a[88:91], a[232:235], v[192:195], a[88:91]
    v_exp_f32 v242, v166
    v_cmp_gt_i32 s[46:47], 33, v6
    v_mfma_f32_16x16x32_bf16 a[88:91], a[236:239], v[200:203], a[88:91]
    ds_read_b128 a[136:139], v2 offset:2048
    v_cvt_pk_bf16_f32 v212, v240, v241
    v_mfma_f32_16x16x32_bf16 a[92:95], a[236:239], v[204:207], a[92:95]
    v_cmp_gt_i32 s[48:49], 34, v6
    v_cmp_gt_i32 s[50:51], 35, v6
    v_mfma_f32_16x16x32_bf16 a[92:95], a[232:235], v[196:199], a[92:95]
    s_waitcnt lgkmcnt(5)
    v_exp_f32 v243, v167
    v_or3_b32 v57, v57, v211, v212
    v_mfma_f32_16x16x32_bf16 a[108:111], a[240:243], v[196:199], a[108:111]
    ds_read_b128 a[140:143], v2 offset:3072
    v_cndmask_b32 v24, v10, v5, s[44:45]
    v_mfma_f32_16x16x32_bf16 a[108:111], a[244:247], v[204:207], a[108:111]
    v_cndmask_b32 v25, v10, v5, s[46:47]
    v_exp_f32 v244, v180
    v_mfma_f32_16x16x32_bf16 a[104:107], a[244:247], v[200:203], a[104:107]
    v_cvt_pk_bf16_f32 v213, v242, v243
    v_cndmask_b32 v26, v10, v5, s[48:49]
    v_mfma_f32_16x16x32_bf16 a[104:107], a[240:243], v[192:195], a[104:107]
    s_waitcnt lgkmcnt(4)
    ds_read_b128 a[144:147], v2 offset:4096
    v_cndmask_b32 v27, v10, v5, s[50:51]
    v_mfma_f32_16x16x32_bf16 a[120:123], a[248:251], v[192:195], a[120:123]
    v_exp_f32 v245, v181
    v_cmp_gt_i32 s[44:45], 48, v6
    v_mfma_f32_16x16x32_bf16 a[120:123], a[252:255], v[200:203], a[120:123]
    buffer_load_dwordx4 v1, s[20:23], s33 offen offset:3072 sc1 lds
    ds_read_b128 a[148:151], v2 offset:5120
    ds_read_b128 a[152:155], v2 offset:6144
    v_cmp_gt_i32 s[46:47], 49, v6
    s_add_u32 s33, s33, 0x80000
    v_cmp_gt_i32 s[48:49], 50, v6
    v_exp_f32 v246, v182
    v_cvt_pk_bf16_f32 v214, v244, v245
    v_cmp_gt_i32 s[50:51], 51, v6
    v_cndmask_b32 v40, v10, v5, s[44:45]
    v_mfma_f32_16x16x32_bf16 a[124:127], a[252:255], v[204:207], a[124:127]
    v_exp_f32 v247, v183
    v_or3_b32 v57, v57, v213, v214
    v_cndmask_b32 v41, v10, v5, s[46:47]
    v_mfma_f32_16x16x32_bf16 a[124:127], a[248:251], v[196:199], a[124:127]
    s_waitcnt lgkmcnt(5)
    ds_read_b128 a[156:159], v2 offset:7168
    v_cndmask_b32 v42, v10, v5, s[48:49]
    v_cndmask_b32 v43, v10, v5, s[50:51]
    v_mfma_f32_16x16x32_bf16 v[128:131], a[128:131], v[96:99], v[16:19]
    s_waitcnt vmcnt(4)
    s_barrier
    v_exp_f32 v232, v168
    v_mfma_f32_16x16x32_bf16 v[128:131], a[132:135], v[100:103], v[128:131]
    s_waitcnt lgkmcnt(4)
    ds_read_b128 a[160:163], v2 offset:8192
    v_cvt_pk_bf16_f32 v215, v246, v247
    v_mfma_f32_16x16x32_bf16 v[128:131], a[136:139], v[104:107], v[128:131]
    v_exp_f32 v233, v169
    v_mfma_f32_16x16x32_bf16 v[128:131], a[140:143], v[108:111], v[128:131]
    s_add_u32 s36, s36, 64
    ds_read_b128 a[164:167], v2 offset:9216
    v_cvt_pk_bf16_f32 v216, v232, v233
    v_mfma_f32_16x16x32_bf16 v[132:135], a[140:143], v[124:127], v[20:23]
    v_exp_f32 v234, v170
    v_mfma_f32_16x16x32_bf16 v[132:135], a[136:139], v[120:123], v[132:135]
    ds_read_b128 a[168:171], v2 offset:10240
    v_or3_b32 v57, v57, v215, v216
    v_mfma_f32_16x16x32_bf16 v[132:135], a[132:135], v[116:119], v[132:135]
    s_add_u32 s52, s52, 16384
    v_exp_f32 v235, v171
    v_mfma_f32_16x16x32_bf16 v[132:135], a[128:131], v[112:115], v[132:135]
    s_waitcnt lgkmcnt(5)
    ds_read_b128 a[172:175], v2 offset:11264
    v_cvt_pk_bf16_f32 v217, v234, v235
    v_mfma_f32_16x16x32_bf16 v[148:151], a[144:147], v[112:115], v[36:39]
    s_and_b32 s52, s52, 0xffff
    v_exp_f32 v236, v184
    v_mfma_f32_16x16x32_bf16 v[148:151], a[148:151], v[116:119], v[148:151]
    s_waitcnt lgkmcnt(4)
    ds_read_b128 a[176:179], v2 offset:12288
    ds_read_b128 a[180:183], v2 offset:13312
    v_mfma_f32_16x16x32_bf16 v[148:151], a[152:155], v[120:123], v[148:151]
    v_exp_f32 v237, v185
    v_mfma_f32_16x16x32_bf16 v[148:151], a[156:159], v[124:127], v[148:151]
    v_exp_f32 v238, v186
    v_mfma_f32_16x16x32_bf16 v[144:147], a[156:159], v[108:111], v[32:35]
    ds_read_b128 a[184:187], v2 offset:14336
    v_cvt_pk_bf16_f32 v218, v236, v237
    v_mfma_f32_16x16x32_bf16 v[144:147], a[152:155], v[104:107], v[144:147]
    v_exp_f32 v239, v187
    v_mfma_f32_16x16x32_bf16 v[144:147], a[148:151], v[100:103], v[144:147]
    ds_read_b128 a[188:191], v2 offset:15360
    v_or3_b32 v57, v57, v217, v218
    v_mfma_f32_16x16x32_bf16 v[144:147], a[144:147], v[96:99], v[144:147]
    s_waitcnt lgkmcnt(6)
    v_exp_f32 v240, v172
    v_mfma_f32_16x16x32_bf16 v[136:139], a[160:163], v[96:99], v[24:27]
    v_cvt_pk_bf16_f32 v219, v238, v239
    v_add_u32 v2, s52, v1
    v_mfma_f32_16x16x32_bf16 v[136:139], a[164:167], v[100:103], v[136:139]
    s_waitcnt lgkmcnt(4)
    v_exp_f32 v241, v173
    v_mfma_f32_16x16x32_bf16 v[136:139], a[168:171], v[104:107], v[136:139]
    ds_read_b128 a[192:195], v3 offset:0
    v_cvt_pk_bf16_f32 v220, v240, v241
    v_mfma_f32_16x16x32_bf16 v[136:139], a[172:175], v[108:111], v[136:139]
    v_exp_f32 v242, v174
    v_mfma_f32_16x16x32_bf16 v[140:143], a[172:175], v[124:127], v[28:31]
    ds_read_b128 a[196:199], v3 offset:8192
    v_or3_b32 v57, v57, v219, v220
    v_mfma_f32_16x16x32_bf16 v[140:143], a[168:171], v[120:123], v[140:143]
    v_exp_f32 v243, v175
    v_mfma_f32_16x16x32_bf16 v[140:143], a[164:167], v[116:119], v[140:143]
    ds_read_b128 a[200:203], v3 offset:1024
    v_cvt_pk_bf16_f32 v221, v242, v243
    v_mfma_f32_16x16x32_bf16 v[140:143], a[160:163], v[112:115], v[140:143]
    s_waitcnt lgkmcnt(5)
    v_exp_f32 v244, v188
    v_mfma_f32_16x16x32_bf16 v[156:159], a[176:179], v[112:115], v[44:47]
    ds_read_b128 a[204:207], v3 offset:9216
    ds_read_b128 a[208:211], v3 offset:2048
    v_mfma_f32_16x16x32_bf16 v[156:159], a[180:183], v[116:119], v[156:159]
    s_waitcnt lgkmcnt(5)
    v_exp_f32 v245, v189
    v_mfma_f32_16x16x32_bf16 v[156:159], a[184:187], v[120:123], v[156:159]
    v_exp_f32 v246, v190
    v_mfma_f32_16x16x32_bf16 v[156:159], a[188:191], v[124:127], v[156:159]
    ds_read_b128 a[212:215], v3 offset:10240
    v_cvt_pk_bf16_f32 v222, v244, v245
    v_mfma_f32_16x16x32_bf16 v[152:155], a[188:191], v[108:111], v[40:43]
    v_exp_f32 v247, v191
    v_mfma_f32_16x16x32_bf16 v[152:155], a[184:187], v[104:107], v[152:155]
    ds_read_b128 a[216:219], v3 offset:3072
    v_or3_b32 v57, v57, v221, v222
    v_mfma_f32_16x16x32_bf16 v[152:155], a[180:183], v[100:103], v[152:155]
    ds_read_b128 a[220:223], v3 offset:11264
    v_cvt_pk_bf16_f32 v223, v246, v247
    v_bitop3_b32 v57, v57, v223, s37 bitop3:0xa8
    v_mfma_f32_16x16x32_bf16 v[152:155], a[176:179], v[96:99], v[152:155]
    v_cmp_ne_u32 vcc, 0, v57
    s_cbranch_vccnz k2_tramp_116
k2_ret_117:
    v_mfma_f32_16x16x32_bf16 v[248:251], v[60:63], v[208:211], v[248:251]
    ds_read_b128 a[224:227], v3 offset:4096
    v_exp_f32 v232, v128
    v_mfma_f32_16x16x32_bf16 v[248:251], v[60:63], v[216:219], v[248:251]
    v_exp_f32 v233, v129
    v_mfma_f32_16x16x32_bf16 v[252:255], v[60:63], v[220:223], v[252:255]
    s_add_u32 s53, s53, 16384
    ds_read_b128 a[228:231], v3 offset:12288
    v_exp_f32 v234, v130
    v_mfma_f32_16x16x32_bf16 v[252:255], v[60:63], v[212:215], v[252:255]
    s_waitcnt lgkmcnt(8)
    v_cvt_pk_bf16_f32 v192, v232, v233
    v_exp_f32 v235, v131
    v_mfma_f32_16x16x32_bf16 a[12:15], a[192:195], v[212:215], a[12:15]
    s_sub_u32 s40, s36, s39
    s_sub_u32 s40, s40, 64
    ds_read_b128 a[232:235], v3 offset:5120
    v_mfma_f32_16x16x32_bf16 a[12:15], a[196:199], v[220:223], a[12:15]
    s_and_b32 s53, s53, 0xffff
    v_subrev_u32 v6, s40, v4
    v_cmp_gt_i32 s[44:45], 0, v6
    v_cvt_pk_bf16_f32 v193, v234, v235
    v_mfma_f32_16x16x32_bf16 a[8:11], a[196:199], v[216:219], a[8:11]
    v_exp_f32 v236, v144
    v_cmp_gt_i32 s[46:47], 1, v6
    v_mfma_f32_16x16x32_bf16 a[8:11], a[192:195], v[208:211], a[8:11]
    s_waitcnt lgkmcnt(7)
    ds_read_b128 a[236:239], v3 offset:13312
    v_exp_f32 v237, v145
    v_mfma_f32_16x16x32_bf16 a[24:27], a[200:203], v[208:211], a[24:27]
    ds_read_b128 a[240:243], v3 offset:6144
    v_cmp_gt_i32 s[48:49], 2, v6
    v_cmp_gt_i32 s[50:51], 3, v6
    v_mfma_f32_16x16x32_bf16 a[24:27], a[204:207], v[216:219], a[24:27]
    v_exp_f32 v238, v146
    v_cndmask_b32 v20, v11, v5, s[44:45]
    v_mfma_f32_16x16x32_bf16 a[28:31], a[204:207], v[220:223], a[28:31]
    v_cvt_pk_bf16_f32 v194, v236, v237
    v_cndmask_b32 v21, v11, v5, s[46:47]
    v_or3_b32 v57, v192, v193, v194
    v_mfma_f32_16x16x32_bf16 a[28:31], a[200:203], v[212:215], a[28:31]
    s_waitcnt lgkmcnt(7)
    v_exp_f32 v239, v147
    v_cndmask_b32 v22, v11, v5, s[48:49]
    v_mfma_f32_16x16x32_bf16 a[44:47], a[208:211], v[212:215], a[44:47]
    ds_read_b128 a[244:247], v3 offset:14336
    v_cndmask_b32 v23, v11, v5, s[50:51]
    v_cvt_pk_bf16_f32 v195, v238, v239
    v_mfma_f32_16x16x32_bf16 a[44:47], a[212:215], v[220:223], a[44:47]
    v_exp_f32 v240, v132
    v_cmp_gt_i32 s[44:45], 16, v6
    v_mfma_f32_16x16x32_bf16 a[40:43], a[212:215], v[216:219], a[40:43]
    ds_read_b128 a[248:251], v3 offset:7168
    v_cmp_gt_i32 s[46:47], 17, v6
    v_cmp_gt_i32 s[48:49], 18, v6
    v_mfma_f32_16x16x32_bf16 a[40:43], a[208:211], v[208:211], a[40:43]
    s_waitcnt lgkmcnt(7)
    ds_read_b128 a[252:255], v3 offset:15360
    v_exp_f32 v241, v133
    v_mfma_f32_16x16x32_bf16 a[56:59], a[216:219], v[208:211], a[56:59]
    v_exp_f32 v242, v134
    v_cmp_gt_i32 s[50:51], 19, v6
    v_mfma_f32_16x16x32_bf16 a[56:59], a[220:223], v[216:219], a[56:59]
    v_cvt_pk_bf16_f32 v196, v240, v241
    v_cndmask_b32 v36, v11, v5, s[44:45]
    v_or3_b32 v57, v57, v195, v196
    v_mfma_f32_16x16x32_bf16 a[60:63], a[220:223], v[220:223], a[60:63]
    v_exp_f32 v243, v135
    v_cndmask_b32 v37, v11, v5, s[46:47]
    v_mfma_f32_16x16x32_bf16 a[60:63], a[216:219], v[212:215], a[60:63]
    s_waitcnt lgkmcnt(6)
    ds_read_b128 a[128:131], v2 offset:0
    v_cndmask_b32 v38, v11, v5, s[48:49]
    v_add_u32 v3, s53, v56
    v_mfma_f32_16x16x32_bf16 a[76:79], a[224:227], v[212:215], a[76:79]
    ds_read_b128 a[132:135], v2 offset:1024
    v_exp_f32 v244, v148
    v_mfma_f32_16x16x32_bf16 a[76:79], a[228:231], v[220:223], a[76:79]
    ds_read_b128 a[136:139], v2 offset:2048
    v_cvt_pk_bf16_f32 v197, v242, v243
    v_cndmask_b32 v39, v11, v5, s[50:51]
    v_mfma_f32_16x16x32_bf16 a[72:75], a[228:231], v[216:219], a[72:75]
    v_cmp_gt_i32 s[44:45], 32, v6
    v_exp_f32 v245, v149
    v_mfma_f32_16x16x32_bf16 a[72:75], a[224:227], v[208:211], a[72:75]
    s_waitcnt lgkmcnt(7)
    ds_read_b128 a[140:143], v2 offset:3072
    ds_read_b128 a[144:147], v2 offset:4096
    v_cmp_gt_i32 s[46:47], 33, v6
    v_mfma_f32_16x16x32_bf16 a[88:91], a[232:235], v[208:211], a[88:91]
    v_exp_f32 v246, v150
    v_cmp_gt_i32 s[48:49], 34, v6
    v_mfma_f32_16x16x32_bf16 a[88:91], a[236:239], v[216:219], a[88:91]
    ds_read_b128 a[148:151], v2 offset:5120
    v_cvt_pk_bf16_f32 v198, v244, v245
    v_cmp_gt_i32 s[50:51], 35, v6
    v_mfma_f32_16x16x32_bf16 a[92:95], a[236:239], v[220:223], a[92:95]
    v_exp_f32 v247, v151
    v_or3_b32 v57, v57, v197, v198
    v_mfma_f32_16x16x32_bf16 a[92:95], a[232:235], v[212:215], a[92:95]
    s_waitcnt lgkmcnt(8)
    ds_read_b128 a[152:155], v2 offset:6144
    v_cndmask_b32 v28, v11, v5, s[44:45]
    v_cndmask_b32 v29, v11, v5, s[46:47]
    v_mfma_f32_16x16x32_bf16 a[108:111], a[240:243], v[212:215], a[108:111]
    ds_read_b128 a[156:159], v2 offset:7168
    v_exp_f32 v232, v136
    v_mfma_f32_16x16x32_bf16 a[108:111], a[244:247], v[220:223], a[108:111]
    ds_read_b128 a[160:163], v2 offset:8192
    v_cvt_pk_bf16_f32 v199, v246, v247
    v_cndmask_b32 v30, v11, v5, s[48:49]
    v_mfma_f32_16x16x32_bf16 a[104:107], a[244:247], v[216:219], a[104:107]
    v_cndmask_b32 v31, v11, v5, s[50:51]
    v_exp_f32 v233, v137
    v_mfma_f32_16x16x32_bf16 a[104:107], a[240:243], v[208:211], a[104:107]
    s_waitcnt lgkmcnt(9)
    ds_read_b128 a[164:167], v2 offset:9216
    ds_read_b128 a[168:171], v2 offset:10240
    v_cmp_gt_i32 s[44:45], 48, v6
    v_mfma_f32_16x16x32_bf16 a[120:123], a[248:251], v[208:211], a[120:123]
    v_exp_f32 v234, v138
    v_cmp_gt_i32 s[46:47], 49, v6
    v_mfma_f32_16x16x32_bf16 a[120:123], a[252:255], v[216:219], a[120:123]
    ds_read_b128 a[172:175], v2 offset:11264
    ds_read_b128 a[176:179], v2 offset:12288
    v_cvt_pk_bf16_f32 v200, v232, v233
    v_cmp_gt_i32 s[48:49], 50, v6
    v_exp_f32 v235, v139
    v_cmp_gt_i32 s[50:51], 51, v6
    v_or3_b32 v57, v57, v199, v200
    v_cndmask_b32 v44, v11, v5, s[44:45]
    v_mfma_f32_16x16x32_bf16 a[124:127], a[252:255], v[220:223], a[124:127]
    ds_read_b128 a[180:183], v2 offset:13312
    v_exp_f32 v236, v152
    v_cvt_pk_bf16_f32 v201, v234, v235
    v_cndmask_b32 v45, v11, v5, s[46:47]
    v_mfma_f32_16x16x32_bf16 a[124:127], a[248:251], v[212:215], a[124:127]
    s_waitcnt lgkmcnt(12)
    ds_read_b128 a[184:187], v2 offset:14336
    v_cndmask_b32 v46, v11, v5, s[48:49]
    v_cndmask_b32 v47, v11, v5, s[50:51]
    v_mfma_f32_16x16x32_bf16 v[164:167], a[128:131], v[112:115], v[20:23]
    v_exp_f32 v237, v153
    v_mfma_f32_16x16x32_bf16 v[164:167], a[132:135], v[116:119], v[164:167]
    s_waitcnt lgkmcnt(11)
    ds_read_b128 a[188:191], v2 offset:15360
    v_exp_f32 v238, v154
    v_mfma_f32_16x16x32_bf16 v[164:167], a[136:139], v[120:123], v[164:167]
    v_cvt_pk_bf16_f32 v202, v236, v237
    v_exp_f32 v239, v155
    v_mfma_f32_16x16x32_bf16 v[164:167], a[140:143], v[124:127], v[164:167]
    s_waitcnt lgkmcnt(10)
    s_waitcnt lgkmcnt(8)
    v_or3_b32 v57, v57, v201, v202
    v_mfma_f32_16x16x32_bf16 v[180:183], a[156:159], v[124:127], v[36:39]
    s_add_u32 s36, s36, 64
    ds_read_b128 a[192:195], v3 offset:0
    v_exp_f32 v240, v140
    v_mfma_f32_16x16x32_bf16 v[180:183], a[152:155], v[120:123], v[180:183]
    ds_read_b128 a[196:199], v3 offset:8192
    v_cvt_pk_bf16_f32 v203, v238, v239
    v_mfma_f32_16x16x32_bf16 v[180:183], a[148:151], v[116:119], v[180:183]
    s_add_u32 s52, s52, 16384
    ds_read_b128 a[200:203], v3 offset:1024
    v_exp_f32 v241, v141
    v_mfma_f32_16x16x32_bf16 v[180:183], a[144:147], v[112:115], v[180:183]
    s_waitcnt lgkmcnt(9)
    v_exp_f32 v242, v142
    v_cvt_pk_bf16_f32 v204, v240, v241
    v_mfma_f32_16x16x32_bf16 v[172:175], a[160:163], v[112:115], v[28:31]
    s_and_b32 s52, s52, 0xffff
    v_add_u32 v2, s52, v1
    v_exp_f32 v243, v143
    v_mfma_f32_16x16x32_bf16 v[172:175], a[164:167], v[116:119], v[172:175]
    s_waitcnt lgkmcnt(7)
    ds_read_b128 a[204:207], v3 offset:9216
    v_or3_b32 v57, v57, v203, v204
    v_cvt_pk_bf16_f32 v205, v242, v243
    v_mfma_f32_16x16x32_bf16 v[172:175], a[168:171], v[120:123], v[172:175]
    ds_read_b128 a[208:211], v3 offset:2048
    v_exp_f32 v244, v156
    v_mfma_f32_16x16x32_bf16 v[172:175], a[172:175], v[124:127], v[172:175]
    s_waitcnt lgkmcnt(7)
    s_waitcnt lgkmcnt(5)
    v_exp_f32 v245, v157
    v_mfma_f32_16x16x32_bf16 v[188:191], a[188:191], v[124:127], v[44:47]
    ds_read_b128 a[212:215], v3 offset:10240
    v_exp_f32 v246, v158
    v_mfma_f32_16x16x32_bf16 v[188:191], a[184:187], v[120:123], v[188:191]
    v_cvt_pk_bf16_f32 v206, v244, v245
    v_exp_f32 v247, v159
    v_mfma_f32_16x16x32_bf16 v[188:191], a[180:183], v[116:119], v[188:191]
    ds_read_b128 a[216:219], v3 offset:3072
    v_or3_b32 v57, v57, v205, v206
    v_cvt_pk_bf16_f32 v207, v246, v247
    v_mfma_f32_16x16x32_bf16 v[188:191], a[176:179], v[112:115], v[188:191]
    ds_read_b128 a[220:223], v3 offset:11264
    v_bitop3_b32 v57, v57, v207, s37 bitop3:0xa8
    v_cmp_ne_u32 vcc, 0, v57
    s_cbranch_vccnz k2_tramp_118
k2_ret_119:
k2_sdone_111:
    s_add_u32 s16, s6, 0x4811000
    s_addc_u32 s17, s7, 0
    s_and_b32 s17, s17, 0xffff
    s_mov_b32 s18, 0x4000
    s_mov_b32 s19, 0x00020000
    v_mfma_f32_16x16x32_bf16 v[248:251], v[60:63], v[192:195], v[248:251]
    s_waitcnt vmcnt(0)
    s_barrier
    v_exp_f32 v232, v164
    v_mfma_f32_16x16x32_bf16 v[248:251], v[60:63], v[200:203], v[248:251]
    ds_read_b128 a[224:227], v3 offset:4096
    s_cmp_eq_u32 s30, 0
    s_cbranch_scc1 k12_ool_122
k12_oolret_123:
    v_mfma_f32_16x16x32_bf16 v[252:255], v[60:63], v[204:207], v[252:255]
    s_add_u32 m0, s60, 0
    v_exp_f32 v233, v165
    v_mfma_f32_16x16x32_bf16 v[252:255], v[60:63], v[196:199], v[252:255]
    s_waitcnt lgkmcnt(7)
    buffer_load_dwordx4 v90, s[12:15], s61 offen offset:0 lds
    ds_read_b128 a[228:231], v3 offset:12288
    v_mfma_f32_16x16x32_bf16 a[12:15], a[192:195], v[196:199], a[12:15]
    s_add_u32 s53, s53, 16384
    v_exp_f32 v234, v166
    v_cvt_pk_bf16_f32 v212, v232, v233
    v_mfma_f32_16x16x32_bf16 a[12:15], a[196:199], v[204:207], a[12:15]
    s_and_b32 s53, s53, 0xffff
    buffer_load_dwordx4 v91, s[12:15], s61 offen offset:1024 lds
    ds_read_b128 a[232:235], v3 offset:5120
    v_mfma_f32_16x16x32_bf16 a[8:11], a[196:199], v[200:203], a[8:11]
    ds_read_b128 a[236:239], v3 offset:13312
    v_exp_f32 v235, v167
    v_mfma_f32_16x16x32_bf16 a[8:11], a[192:195], v[192:195], a[8:11]
    s_waitcnt lgkmcnt(8)
    v_exp_f32 v236, v180
    v_mfma_f32_16x16x32_bf16 a[24:27], a[200:203], v[192:195], a[24:27]
    buffer_load_dwordx4 v92, s[12:15], s61 offen offset:2048 lds
    ds_read_b128 a[240:243], v3 offset:6144
    v_mfma_f32_16x16x32_bf16 a[24:27], a[204:207], v[200:203], a[24:27]
    v_cvt_pk_bf16_f32 v213, v234, v235
    v_exp_f32 v237, v181
    v_mfma_f32_16x16x32_bf16 a[28:31], a[204:207], v[204:207], a[28:31]
    buffer_load_dwordx4 v93, s[12:15], s61 offen offset:3072 lds
    ds_read_b128 a[244:247], v3 offset:14336
    v_mfma_f32_16x16x32_bf16 a[28:31], a[200:203], v[196:199], a[28:31]
    s_waitcnt lgkmcnt(8)
    v_exp_f32 v238, v182
    v_cvt_pk_bf16_f32 v214, v236, v237
    v_mfma_f32_16x16x32_bf16 a[44:47], a[208:211], v[196:199], a[44:47]
    s_add_u32 s61, s61, 0x20000
    s_and_b32 s61, s61, 0x3fffff
    ds_read_b128 a[248:251], v3 offset:7168
    v_mfma_f32_16x16x32_bf16 a[44:47], a[212:215], v[204:207], a[44:47]
    s_add_u32 m0, s60, 16384
    v_exp_f32 v239, v183
    v_or3_b32 v57, v212, v213, v214
    v_mfma_f32_16x16x32_bf16 a[40:43], a[212:215], v[200:203], a[40:43]
    buffer_load_dwordx4 v90, s[12:15], s61 offen offset:0 lds
    buffer_load_dwordx4 v91, s[12:15], s61 offen offset:1024 lds
    ds_read_b128 a[252:255], v3 offset:15360
    v_mfma_f32_16x16x32_bf16 a[40:43], a[208:211], v[192:195], a[40:43]
    s_waitcnt lgkmcnt(8)
    v_exp_f32 v240, v172
    v_cvt_pk_bf16_f32 v215, v238, v239
    v_mfma_f32_16x16x32_bf16 a[56:59], a[216:219], v[192:195], a[56:59]
    v_mfma_f32_16x16x32_bf16 a[56:59], a[220:223], v[200:203], a[56:59]
    v_add_u32 v3, s53, v56
    ds_read_b128 a[192:195], v3 offset:0
    v_mfma_f32_16x16x32_bf16 a[60:63], a[220:223], v[204:207], a[60:63]
    ds_read_b128 a[196:199], v3 offset:8192
    v_exp_f32 v241, v173
    v_mfma_f32_16x16x32_bf16 a[60:63], a[216:219], v[196:199], a[60:63]
    s_waitcnt lgkmcnt(8)
    buffer_load_dwordx4 v92, s[12:15], s61 offen offset:2048 lds
    buffer_load_dwordx4 v93, s[12:15], s61 offen offset:3072 lds
    ds_read_b128 a[200:203], v3 offset:1024
    v_mfma_f32_16x16x32_bf16 a[76:79], a[224:227], v[196:199], a[76:79]
    v_exp_f32 v242, v174
    v_cvt_pk_bf16_f32 v220, v240, v241
    v_mfma_f32_16x16x32_bf16 a[76:79], a[228:231], v[204:207], a[76:79]
    ds_read_b128 a[204:207], v3 offset:9216
    ds_read_b128 a[208:211], v3 offset:2048
    v_or3_b32 v57, v57, v215, v220
    v_mfma_f32_16x16x32_bf16 a[72:75], a[228:231], v[200:203], a[72:75]
    s_add_u32 s61, s61, 0x20000
    s_and_b32 s61, s61, 0x3fffff
    ds_read_b128 a[212:215], v3 offset:10240
    v_exp_f32 v243, v175
    v_mfma_f32_16x16x32_bf16 a[72:75], a[224:227], v[192:195], a[72:75]
    s_waitcnt lgkmcnt(10)
    ds_read_b128 a[216:219], v3 offset:3072
    s_add_u32 m0, s60, 32768
    v_mfma_f32_16x16x32_bf16 a[88:91], a[232:235], v[192:195], a[88:91]
    buffer_load_dwordx4 v90, s[12:15], s61 offen offset:0 lds
    ds_read_b128 a[220:223], v3 offset:11264
    v_mfma_f32_16x16x32_bf16 a[88:91], a[236:239], v[200:203], a[88:91]
    v_exp_f32 v244, v188
    v_cvt_pk_bf16_f32 v221, v242, v243
    v_mfma_f32_16x16x32_bf16 a[92:95], a[236:239], v[204:207], a[92:95]
    buffer_load_dwordx4 v91, s[12:15], s61 offen offset:1024 lds
    ds_read_b128 a[224:227], v3 offset:4096
    v_mfma_f32_16x16x32_bf16 a[92:95], a[232:235], v[196:199], a[92:95]
    s_waitcnt lgkmcnt(11)
    ds_read_b128 a[228:231], v3 offset:12288
    v_exp_f32 v245, v189
    v_mfma_f32_16x16x32_bf16 a[108:111], a[240:243], v[196:199], a[108:111]
    buffer_load_dwordx4 v92, s[12:15], s61 offen offset:2048 lds
    ds_read_b128 a[232:235], v3 offset:5120
    v_mfma_f32_16x16x32_bf16 a[108:111], a[244:247], v[204:207], a[108:111]
    v_exp_f32 v246, v190
    v_mfma_f32_16x16x32_bf16 a[104:107], a[244:247], v[200:203], a[104:107]
    ds_read_b128 a[236:239], v3 offset:13312
    v_cvt_pk_bf16_f32 v222, v244, v245
    v_or3_b32 v57, v57, v221, v222
    v_mfma_f32_16x16x32_bf16 a[104:107], a[240:243], v[192:195], a[104:107]
    s_waitcnt lgkmcnt(12)
    v_exp_f32 v247, v191
    v_mfma_f32_16x16x32_bf16 a[120:123], a[248:251], v[192:195], a[120:123]
    buffer_load_dwordx4 v93, s[12:15], s61 offen offset:3072 lds
    ds_read_b128 a[240:243], v3 offset:6144
    ds_read_b128 a[244:247], v3 offset:14336
    v_mfma_f32_16x16x32_bf16 a[120:123], a[252:255], v[200:203], a[120:123]
    s_add_u32 s61, s61, 0x20000
    s_and_b32 s61, s61, 0x3fffff
    v_cvt_pk_bf16_f32 v223, v246, v247
    v_bitop3_b32 v57, v57, v223, s37 bitop3:0xa8
    v_mfma_f32_16x16x32_bf16 a[124:127], a[252:255], v[204:207], a[124:127]
    v_cmp_ne_u32 vcc, 0, v57
    v_mfma_f32_16x16x32_bf16 a[124:127], a[248:251], v[196:199], a[124:127]
    buffer_load_dword v74, v73, s[16:19], s59 offen sc1
    ds_read_b128 a[248:251], v3 offset:7168
    ds_read_b128 a[252:255], v3 offset:15360
    s_cbranch_vccnz k2_tramp_120
k2_ret_121:
    v_lshrrev_b32 v6, 4, v1
    v_and_b32 v6, 31, v6
    s_getpc_b64 s[40:41]
pc_124:
    s_add_u32 s40, s40, op_head-pc_124
    s_addc_u32 s41, s41, 0
    v_lshlrev_b32 v224, 7, v6
    v_mov_b32 v225, s41
    v_add_co_u32 v224, vcc, s40, v224
    s_nop 1
    v_addc_co_u32 v225, vcc, 0, v225, vcc
    global_load_dword v7, v[224:225], off
    v_mfma_f32_16x16x32_bf16 v[252:255], v[60:63], v[212:215], v[252:255]
    s_lshl_b32 s31, s28, 19
    v_mov_b32 v249, v248
    s_nop 1
    v_permlane16_swap_b32 v248, v249
    v_mfma_f32_16x16x32_bf16 v[252:255], v[60:63], v[220:223], v[252:255]
    s_waitcnt lgkmcnt(0)
    s_nop 1
    v_add_f32 v248, v248, v249
    v_mov_b32 v249, v248
    v_mfma_f32_16x16x32_bf16 a[12:15], a[196:199], v[220:223], a[12:15]
    s_lshl_b32 s44, s39, 6
    s_nop 1
    v_permlane32_swap_b32 v248, v249
    s_nop 1
    v_mfma_f32_16x16x32_bf16 a[12:15], a[192:195], v[212:215], a[12:15]
    s_add_u32 s44, s44, s31
    s_add_u32 s45, s44, 131072
    v_add_f32 v248, v248, v249
    v_rcp_f32 v249, v248
    v_mfma_f32_16x16x32_bf16 a[28:31], a[200:203], v[212:215], a[28:31]
    s_add_u32 s46, s44, 262144
    v_rcp_f32 v248, v248
    s_nop 0
    s_add_u32 s47, s44, 393216
    v_mfma_f32_16x16x32_bf16 a[28:31], a[204:207], v[220:223], a[28:31]
    s_add_u32 s48, s44, 4096
    v_accvgpr_read_b32 v132, a8
    v_accvgpr_read_b32 v133, a9
    v_accvgpr_read_b32 v134, a10
    v_mfma_f32_16x16x32_bf16 a[44:47], a[212:215], v[220:223], a[44:47]
    s_add_u32 s49, s44, 135168
    v_accvgpr_read_b32 v135, a11
    v_accvgpr_read_b32 v136, a24
    v_accvgpr_read_b32 v137, a25
    v_mfma_f32_16x16x32_bf16 a[44:47], a[208:211], v[212:215], a[44:47]
    s_add_u32 s50, s44, 266240
    v_accvgpr_read_b32 v138, a26
    v_accvgpr_read_b32 v139, a27
    v_mul_f32 v132, v132, v248
    v_mfma_f32_16x16x32_bf16 a[60:63], a[216:219], v[212:215], a[60:63]
    s_add_u32 s51, s44, 397312
    v_mul_f32 v133, v133, v248
    v_mul_f32 v134, v134, v248
    v_mul_f32 v135, v135, v248
    v_mfma_f32_16x16x32_bf16 a[60:63], a[220:223], v[220:223], a[60:63]
    v_mul_f32 v136, v136, v248
    v_mul_f32 v137, v137, v248
    v_mul_f32 v138, v138, v248
    v_mfma_f32_16x16x32_bf16 a[76:79], a[228:231], v[220:223], a[76:79]
    v_mul_f32 v139, v139, v248
    v_cvt_pk_bf16_f32 v128, v132, v133
    v_cvt_pk_bf16_f32 v129, v134, v135
    v_mfma_f32_16x16x32_bf16 a[76:79], a[224:227], v[212:215], a[76:79]
    v_cvt_pk_bf16_f32 v130, v136, v137
    v_cvt_pk_bf16_f32 v131, v138, v139
    buffer_store_dwordx4 v[128:131], v1, s[24:27], s44 offen sc1
    v_mfma_f32_16x16x32_bf16 a[92:95], a[232:235], v[212:215], a[92:95]
    v_accvgpr_read_b32 v144, a40
    v_accvgpr_read_b32 v145, a41
    v_accvgpr_read_b32 v146, a42
    v_mfma_f32_16x16x32_bf16 a[92:95], a[236:239], v[220:223], a[92:95]
    v_accvgpr_read_b32 v147, a43
    v_accvgpr_read_b32 v148, a56
    v_mov_b32 v253, v252
    v_mfma_f32_16x16x32_bf16 a[108:111], a[244:247], v[220:223], a[108:111]
    v_accvgpr_read_b32 v149, a57
    v_accvgpr_read_b32 v150, a58
    s_nop 1
    v_mfma_f32_16x16x32_bf16 a[108:111], a[240:243], v[212:215], a[108:111]
    v_accvgpr_read_b32 v151, a59
    v_permlane16_swap_b32 v252, v253
    v_mul_f32 v144, v144, v248
    v_mfma_f32_16x16x32_bf16 a[124:127], a[248:251], v[212:215], a[124:127]
    s_nop 1
    v_mul_f32 v145, v145, v248
    v_add_f32 v252, v252, v253
    v_mfma_f32_16x16x32_bf16 a[124:127], a[252:255], v[220:223], a[124:127]
    v_mul_f32 v146, v146, v248
    v_mov_b32 v253, v252
    v_mul_f32 v147, v147, v248
    s_nop 1
    v_mul_f32 v148, v148, v248
    v_mul_f32 v149, v149, v248
    v_permlane32_swap_b32 v252, v253
    v_mul_f32 v150, v150, v248
    s_nop 1
    v_mul_f32 v151, v151, v248
    v_add_f32 v252, v252, v253
    v_cvt_pk_bf16_f32 v140, v144, v145
    v_rcp_f32 v253, v252
    v_cvt_pk_bf16_f32 v141, v146, v147
    v_rcp_f32 v252, v252
    v_cvt_pk_bf16_f32 v142, v148, v149
    s_nop 0
    v_cvt_pk_bf16_f32 v143, v150, v151
    buffer_store_dwordx4 v[140:143], v1, s[24:27], s45 offen sc1
    v_accvgpr_read_b32 v156, a72
    v_accvgpr_read_b32 v157, a73
    v_accvgpr_read_b32 v158, a74
    v_accvgpr_read_b32 v159, a75
    v_accvgpr_read_b32 v160, a88
    v_accvgpr_read_b32 v161, a89
    v_accvgpr_read_b32 v162, a90
    v_accvgpr_read_b32 v163, a91
    v_mul_f32 v156, v156, v248
    v_mul_f32 v157, v157, v248
    v_mul_f32 v158, v158, v248
    v_mul_f32 v159, v159, v248
    v_mul_f32 v160, v160, v248
    v_mul_f32 v161, v161, v248
    v_mul_f32 v162, v162, v248
    v_mul_f32 v163, v163, v248
    v_cvt_pk_bf16_f32 v152, v156, v157
    v_cvt_pk_bf16_f32 v153, v158, v159
    v_cvt_pk_bf16_f32 v154, v160, v161
    v_cvt_pk_bf16_f32 v155, v162, v163
    buffer_store_dwordx4 v[152:155], v1, s[24:27], s46 offen sc1
    v_accvgpr_read_b32 v168, a104
    v_accvgpr_read_b32 v169, a105
    v_accvgpr_read_b32 v170, a106
    v_accvgpr_read_b32 v171, a107
    v_accvgpr_read_b32 v172, a120
    v_accvgpr_read_b32 v173, a121
    v_accvgpr_read_b32 v174, a122
    v_accvgpr_read_b32 v175, a123
    v_mul_f32 v168, v168, v248
    v_mul_f32 v169, v169, v248
    v_mul_f32 v170, v170, v248
    v_mul_f32 v171, v171, v248
    v_mul_f32 v172, v172, v248
    v_mul_f32 v173, v173, v248
    v_mul_f32 v174, v174, v248
    v_mul_f32 v175, v175, v248
    v_cvt_pk_bf16_f32 v164, v168, v169
    v_cvt_pk_bf16_f32 v165, v170, v171
    v_cvt_pk_bf16_f32 v166, v172, v173
    v_cvt_pk_bf16_f32 v167, v174, v175
    buffer_store_dwordx4 v[164:167], v1, s[24:27], s47 offen sc1
    v_accvgpr_read_b32 v132, a12
    v_accvgpr_read_b32 v133, a13
    v_accvgpr_read_b32 v134, a14
    v_accvgpr_read_b32 v135, a15
    v_accvgpr_read_b32 v136, a28
    v_accvgpr_read_b32 v137, a29
    v_accvgpr_read_b32 v138, a30
    v_accvgpr_read_b32 v139, a31
    v_pk_mul_f32 v[132:133], v[132:133], v[252:253]
    v_pk_mul_f32 v[134:135], v[134:135], v[252:253]
    v_pk_mul_f32 v[136:137], v[136:137], v[252:253]
    v_pk_mul_f32 v[138:139], v[138:139], v[252:253]
    v_cvt_pk_bf16_f32 v128, v132, v133
    v_cvt_pk_bf16_f32 v129, v134, v135
    v_cvt_pk_bf16_f32 v130, v136, v137
    v_cvt_pk_bf16_f32 v131, v138, v139
    v_accvgpr_read_b32 v144, a44
    v_accvgpr_read_b32 v145, a45
    v_accvgpr_read_b32 v146, a46
    v_accvgpr_read_b32 v147, a47
    v_accvgpr_read_b32 v148, a60
    v_accvgpr_read_b32 v149, a61
    v_accvgpr_read_b32 v150, a62
    v_accvgpr_read_b32 v151, a63
    v_pk_mul_f32 v[144:145], v[144:145], v[252:253]
    v_pk_mul_f32 v[146:147], v[146:147], v[252:253]
    v_pk_mul_f32 v[148:149], v[148:149], v[252:253]
    v_pk_mul_f32 v[150:151], v[150:151], v[252:253]
    v_cvt_pk_bf16_f32 v140, v144, v145
    v_cvt_pk_bf16_f32 v141, v146, v147
    v_cvt_pk_bf16_f32 v142, v148, v149
    v_cvt_pk_bf16_f32 v143, v150, v151
    v_accvgpr_read_b32 v156, a76
    v_accvgpr_read_b32 v157, a77
    v_accvgpr_read_b32 v158, a78
    v_accvgpr_read_b32 v159, a79
    v_accvgpr_read_b32 v160, a92
    v_accvgpr_read_b32 v161, a93
    v_accvgpr_read_b32 v162, a94
    v_accvgpr_read_b32 v163, a95
    v_pk_mul_f32 v[156:157], v[156:157], v[252:253]
    v_pk_mul_f32 v[158:159], v[158:159], v[252:253]
    v_pk_mul_f32 v[160:161], v[160:161], v[252:253]
    v_pk_mul_f32 v[162:163], v[162:163], v[252:253]
    v_cvt_pk_bf16_f32 v152, v156, v157
    v_cvt_pk_bf16_f32 v153, v158, v159
    v_cvt_pk_bf16_f32 v154, v160, v161
    v_cvt_pk_bf16_f32 v155, v162, v163
    v_accvgpr_read_b32 v168, a108
    v_accvgpr_read_b32 v169, a109
    v_accvgpr_read_b32 v170, a110
    v_accvgpr_read_b32 v171, a111
    v_accvgpr_read_b32 v172, a124
    v_accvgpr_read_b32 v173, a125
    v_accvgpr_read_b32 v174, a126
    v_accvgpr_read_b32 v175, a127
    v_pk_mul_f32 v[168:169], v[168:169], v[252:253]
    v_pk_mul_f32 v[170:171], v[170:171], v[252:253]
    v_pk_mul_f32 v[172:173], v[172:173], v[252:253]
    v_pk_mul_f32 v[174:175], v[174:175], v[252:253]
    v_cvt_pk_bf16_f32 v164, v168, v169
    v_cvt_pk_bf16_f32 v165, v170, v171
    v_cvt_pk_bf16_f32 v166, v172, v173
    v_cvt_pk_bf16_f32 v167, v174, v175
    buffer_store_dwordx4 v[128:131], v1, s[24:27], s48 offen sc1
    buffer_store_dwordx4 v[140:143], v1, s[24:27], s49 offen sc1
    buffer_store_dwordx4 v[152:155], v1, s[24:27], s50 offen sc1
    buffer_store_dwordx4 v[164:167], v1, s[24:27], s51 offen sc1
op_head:
    s_load_dwordx2 s[28:29], s[0:1], 0
    s_load_dwordx2 s[42:43], s[0:1], 56
    s_waitcnt vmcnt(8)
    v_cmp_le_u32 vcc, 4, v74
    v_mov_b32 v56, 0
    v_mov_b32 v57, 0
    v_mov_b32 v58, 0
    v_mov_b32 v59, 0
    s_nop 1
    v_mfma_f32_32x32x16_bf16 v[128:143], v[56:59], v[56:59], 0
    v_mfma_f32_32x32x16_bf16 v[144:159], v[56:59], v[56:59], 0
    v_mfma_f32_32x32x16_bf16 v[160:175], v[56:59], v[56:59], 0
    v_mfma_f32_32x32x16_bf16 v[176:191], v[56:59], v[56:59], 0
    s_mov_b32 s33, vcc_lo
    s_bitcmp1_b32 s33, 0
    s_cbranch_scc0 op_late_125
    buffer_load_dwordx4 a[128:131], v88, s[8:11], s62 offen offset:0 sc1
    buffer_load_dwordx4 a[132:135], v88, s[8:11], s62 offen offset:1024 sc1
    buffer_load_dwordx4 a[136:139], v89, s[8:11], s62 offen offset:0 sc1
    buffer_load_dwordx4 a[140:143], v89, s[8:11], s62 offen offset:1024 sc1
    s_add_u32 s62, s62, 0x40000
    s_and_b32 s62, s62, 0x7fffff
    buffer_load_dwordx4 a[144:147], v88, s[8:11], s62 offen offset:0 sc1
    buffer_load_dwordx4 a[148:151], v88, s[8:11], s62 offen offset:1024 sc1
    buffer_load_dwordx4 a[152:155], v89, s[8:11], s62 offen offset:0 sc1
    buffer_load_dwordx4 a[156:159], v89, s[8:11], s62 offen offset:1024 sc1
    s_add_u32 s62, s62, 0x40000
    s_and_b32 s62, s62, 0x7fffff
    buffer_load_dwordx4 a[160:163], v88, s[8:11], s62 offen offset:0 sc1
    buffer_load_dwordx4 a[164:167], v88, s[8:11], s62 offen offset:1024 sc1
    buffer_load_dwordx4 a[168:171], v89, s[8:11], s62 offen offset:0 sc1
    buffer_load_dwordx4 a[172:175], v89, s[8:11], s62 offen offset:1024 sc1
    s_add_u32 s62, s62, 0x40000
    s_and_b32 s62, s62, 0x7fffff
    s_waitcnt vmcnt(12)
    s_branch op_join_126
op_late_125:
    s_waitcnt vmcnt(0)
op_join_126:
    s_barrier
    s_cmp_eq_u32 s30, 0
    s_cbranch_scc1 k12_ool_127
k12_oolret_128:
    s_bitcmp0_b32 s33, 0
    s_cbranch_scc1 k12_ool_131
k12_oolret_132:
    ds_read_b64_tr_b16 a[0:1], v64 offset:0
    ds_read_b64_tr_b16 a[2:3], v64 offset:4096
    ds_read_b64_tr_b16 a[4:5], v65 offset:0
    ds_read_b64_tr_b16 a[6:7], v65 offset:4096
    ds_read_b64_tr_b16 a[8:9], v66 offset:0
    ds_read_b64_tr_b16 a[10:11], v66 offset:4096
    ds_read_b64_tr_b16 a[12:13], v67 offset:0
    ds_read_b64_tr_b16 a[14:15], v67 offset:4096
    ds_read_b64_tr_b16 a[16:17], v68 offset:0
    ds_read_b64_tr_b16 a[18:19], v68 offset:4096
    ds_read_b64_tr_b16 a[20:21], v69 offset:0
    ds_read_b64_tr_b16 a[22:23], v69 offset:4096
    ds_read_b64_tr_b16 a[24:25], v70 offset:0
    ds_read_b64_tr_b16 a[26:27], v70 offset:4096
    ds_read_b64_tr_b16 a[28:29], v71 offset:0
    ds_read_b64_tr_b16 a[30:31], v71 offset:4096
    ds_read_b64_tr_b16 a[32:33], v64 offset:8192
    ds_read_b64_tr_b16 a[34:35], v64 offset:12288
    ds_read_b64_tr_b16 a[36:37], v65 offset:8192
    ds_read_b64_tr_b16 a[38:39], v65 offset:12288
    ds_read_b64_tr_b16 a[40:41], v66 offset:8192
    ds_read_b64_tr_b16 a[42:43], v66 offset:12288
    ds_read_b64_tr_b16 a[44:45], v67 offset:8192
    ds_read_b64_tr_b16 a[46:47], v67 offset:12288
    ds_read_b64_tr_b16 a[48:49], v68 offset:8192
    ds_read_b64_tr_b16 a[50:51], v68 offset:12288
    ds_read_b64_tr_b16 a[52:53], v69 offset:8192
    ds_read_b64_tr_b16 a[54:55], v69 offset:12288
    ds_read_b64_tr_b16 a[56:57], v70 offset:8192
    ds_read_b64_tr_b16 a[58:59], v70 offset:12288
    ds_read_b64_tr_b16 a[60:61], v71 offset:8192
    ds_read_b64_tr_b16 a[62:63], v71 offset:12288
    s_add_u32 s24, s6, 0x4000000
    s_addc_u32 s25, s7, 0
    s_and_b32 s25, s25, 0xffff
    s_mov_b32 s26, 0x400000
    s_mov_b32 s27, 0x00020000
    s_add_u32 s36, s6, 0x5000000
    s_addc_u32 s37, s7, 0
    s_and_b32 s37, s37, 0xffff
    s_mov_b32 s38, 0x800000
    s_mov_b32 s39, 0x00020000
    s_add_u32 s48, s6, 0x4807000
    s_addc_u32 s49, s7, 0
    s_and_b32 s49, s49, 0xffff
    s_mov_b32 s50, 0x8000
    s_mov_b32 s51, 0x00020000
    s_lshl_b32 s52, s2, 14
    s_add_u32 s52, s52, s60
    s_xor_b32 s53, s52, 0x10000
    s_lshl_b32 s57, s2, 7
    s_xor_b32 s58, s57, 0x200
    v_lshrrev_b32 v56, 4, v1
    s_lshl_b32 s31, s30, 6
    s_and_b32 s31, s31, 64
    v_add_u32 v56, s31, v56
    s_mov_b32 s31, (code_end-op_tail)/128
    v_min_u32 v56, s31, v56
    s_getpc_b64 s[40:41]
pc_133:
    s_add_u32 s40, s40, op_tail-pc_133
    s_addc_u32 s41, s41, 0
    v_lshlrev_b32 v82, 7, v56
    v_mov_b32 v83, s41
    v_add_co_u32 v82, vcc, s40, v82
    s_nop 1
    v_addc_co_u32 v83, vcc, 0, v83, vcc
    v_lshlrev_b32 v94, 3, v1
    s_and_b32 s35, s2, 7
    s_mul_i32 s35, s35, 28
    s_lshr_b32 s31, s2, 3
    s_add_u32 s55, s35, s31
    s_lshl_b32 s3, s55, 15
    s_lshl_b32 s31, s30, 13
    s_add_u32 s3, s3, s31
    s_add_u32 s35, s31, 65536
    s_mov_b32 s63, 0
    s_waitcnt vmcnt(8) lgkmcnt(0)
    s_mov_b32 s20, s28
    s_and_b32 s21, s29, 0xffff
    s_mov_b32 s22, 0x400000
    s_mov_b32 s23, 0x00020000
    s_mov_b32 s44, s42
    s_and_b32 s45, s43, 0xffff
    s_mov_b32 s46, 0x800
    s_mov_b32 s47, 0x00020000
op_loop_134:
    v_mfma_f32_16x16x32_bf16 v[160:163], a[16:19], a[128:131], v[160:163]
    s_add_u32 m0, s60, 49152
    ds_read_b64_tr_b16 a[64:65], v64 offset:16384
    ds_read_b64_tr_b16 a[66:67], v64 offset:20480
    v_mfma_f32_16x16x32_bf16 v[160:163], a[48:51], a[136:139], v[160:163]
    buffer_load_dwordx4 v90, s[12:15], s61 offen offset:0 lds
    ds_read_b64_tr_b16 a[68:69], v65 offset:16384
    v_mfma_f32_16x16x32_bf16 v[164:167], a[48:51], a[140:143], v[164:167]
    ds_read_b64_tr_b16 a[70:71], v65 offset:20480
    ds_read_b64_tr_b16 a[72:73], v66 offset:16384
    v_mfma_f32_16x16x32_bf16 v[164:167], a[16:19], a[132:135], v[164:167]
    buffer_load_dwordx4 v91, s[12:15], s61 offen offset:1024 lds
    ds_read_b64_tr_b16 a[74:75], v66 offset:20480
    v_mfma_f32_16x16x32_bf16 v[172:175], a[20:23], a[132:135], v[172:175]
    ds_read_b64_tr_b16 a[76:77], v67 offset:16384
    ds_read_b64_tr_b16 a[78:79], v67 offset:20480
    v_mfma_f32_16x16x32_bf16 v[172:175], a[52:55], a[140:143], v[172:175]
    ds_read_b64_tr_b16 a[80:81], v68 offset:16384
    v_mfma_f32_16x16x32_bf16 v[168:171], a[52:55], a[136:139], v[168:171]
    ds_read_b64_tr_b16 a[82:83], v68 offset:20480
    v_mfma_f32_16x16x32_bf16 v[168:171], a[20:23], a[128:131], v[168:171]
    buffer_load_dwordx4 v92, s[12:15], s61 offen offset:2048 lds
    ds_read_b64_tr_b16 a[84:85], v69 offset:16384
    v_mfma_f32_16x16x32_bf16 v[176:179], a[24:27], a[128:131], v[176:179]
    ds_read_b64_tr_b16 a[86:87], v69 offset:20480
    ds_read_b64_tr_b16 a[88:89], v70 offset:16384
    v_mfma_f32_16x16x32_bf16 v[176:179], a[56:59], a[136:139], v[176:179]
    ds_read_b64_tr_b16 a[90:91], v70 offset:20480
    v_mfma_f32_16x16x32_bf16 v[180:183], a[56:59], a[140:143], v[180:183]
    buffer_load_dwordx4 v93, s[12:15], s61 offen offset:3072 lds
    ds_read_b64_tr_b16 a[92:93], v71 offset:16384
    v_mfma_f32_16x16x32_bf16 v[180:183], a[24:27], a[132:135], v[180:183]
    ds_read_b64_tr_b16 a[94:95], v71 offset:20480
    ds_read_b64_tr_b16 a[96:97], v64 offset:24576
    v_mfma_f32_16x16x32_bf16 v[188:191], a[28:31], a[132:135], v[188:191]
    ds_read_b64_tr_b16 a[98:99], v64 offset:28672
    v_mfma_f32_16x16x32_bf16 v[188:191], a[60:63], a[140:143], v[188:191]
    ds_read_b64_tr_b16 a[100:101], v65 offset:24576
    v_mfma_f32_16x16x32_bf16 v[184:187], a[60:63], a[136:139], v[184:187]
    buffer_load_dwordx4 a[176:179], v88, s[8:11], s62 offen offset:0 sc1
    ds_read_b64_tr_b16 a[102:103], v65 offset:28672
    v_mfma_f32_16x16x32_bf16 v[184:187], a[28:31], a[128:131], v[184:187]
    s_add_u32 s61, s61, 0x20000
    s_and_b32 s61, s61, 0x3fffff
    ds_read_b64_tr_b16 a[104:105], v66 offset:24576
    ds_read_b64_tr_b16 a[106:107], v66 offset:28672
    v_mfma_f32_16x16x32_bf16 v[128:131], a[0:3], a[128:131], v[128:131]
    ds_read_b64_tr_b16 a[108:109], v67 offset:24576
    v_mfma_f32_16x16x32_bf16 v[128:131], a[32:35], a[136:139], v[128:131]
    buffer_load_dwordx4 a[180:183], v88, s[8:11], s62 offen offset:1024 sc1
    ds_read_b64_tr_b16 a[110:111], v67 offset:28672
    v_mfma_f32_16x16x32_bf16 v[132:135], a[32:35], a[140:143], v[132:135]
    ds_read_b64_tr_b16 a[112:113], v68 offset:24576
    v_mfma_f32_16x16x32_bf16 v[132:135], a[0:3], a[132:135], v[132:135]
    ds_read_b64_tr_b16 a[114:115], v68 offset:28672
    ds_read_b64_tr_b16 a[116:117], v69 offset:24576
    v_mfma_f32_16x16x32_bf16 v[140:143], a[4:7], a[132:135], v[140:143]
    ds_read_b64_tr_b16 a[118:119], v69 offset:28672
    v_mfma_f32_16x16x32_bf16 v[140:143], a[36:39], a[140:143], v[140:143]
    buffer_load_dwordx4 a[184:187], v89, s[8:11], s62 offen offset:0 sc1
    ds_read_b64_tr_b16 a[120:121], v70 offset:24576
    v_mfma_f32_16x16x32_bf16 v[136:139], a[36:39], a[136:139], v[136:139]
    ds_read_b64_tr_b16 a[122:123], v70 offset:28672
    ds_read_b64_tr_b16 a[124:125], v71 offset:24576
    v_mfma_f32_16x16x32_bf16 v[136:139], a[4:7], a[128:131], v[136:139]
    ds_read_b64_tr_b16 a[126:127], v71 offset:28672
    v_mfma_f32_16x16x32_bf16 v[144:147], a[8:11], a[128:131], v[144:147]
    buffer_load_dwordx4 a[188:191], v89, s[8:11], s62 offen offset:1024 sc1
    v_mfma_f32_16x16x32_bf16 v[144:147], a[40:43], a[136:139], v[144:147]
    v_mfma_f32_16x16x32_bf16 v[148:151], a[40:43], a[140:143], v[148:151]
    v_mfma_f32_16x16x32_bf16 v[148:151], a[8:11], a[132:135], v[148:151]
    v_mfma_f32_16x16x32_bf16 v[156:159], a[12:15], a[132:135], v[156:159]
    s_cmp_eq_u32 s63, 7
    s_cbranch_scc1 k12_ool_137
k12_oolret_138:
    v_mfma_f32_16x16x32_bf16 v[156:159], a[44:47], a[140:143], v[156:159]
    s_add_u32 s62, s62, 0x40000
    s_and_b32 s62, s62, 0x7fffff
    v_mfma_f32_16x16x32_bf16 v[152:155], a[44:47], a[136:139], v[152:155]
    v_mfma_f32_16x16x32_bf16 v[152:155], a[12:15], a[128:131], v[152:155]
    s_waitcnt vmcnt(12) lgkmcnt(0)
    s_barrier
    v_mfma_f32_16x16x32_bf16 v[160:163], a[80:83], a[144:147], v[160:163]
    s_add_u32 s32, s63, 1
    s_lshr_b32 s32, s32, 1
    ds_read_b64_tr_b16 a[0:1], v64 offset:32768
    v_cmp_le_u32 vcc, 4, v74
    v_mfma_f32_16x16x32_bf16 v[160:163], a[112:115], a[152:155], v[160:163]
    s_add_u32 m0, s60, 0
    ds_read_b64_tr_b16 a[2:3], v64 offset:36864
    ds_read_b64_tr_b16 a[4:5], v65 offset:32768
    v_mfma_f32_16x16x32_bf16 v[164:167], a[112:115], a[156:159], v[164:167]
    s_or_b32 s33, vcc_lo, 16
    buffer_load_dwordx4 v90, s[12:15], s61 offen offset:0 lds
    ds_read_b64_tr_b16 a[6:7], v65 offset:36864
    v_mfma_f32_16x16x32_bf16 v[164:167], a[80:83], a[148:151], v[164:167]
    ds_read_b64_tr_b16 a[8:9], v66 offset:32768
    ds_read_b64_tr_b16 a[10:11], v66 offset:36864
    v_mfma_f32_16x16x32_bf16 v[172:175], a[84:87], a[148:151], v[172:175]
    buffer_load_dwordx4 v91, s[12:15], s61 offen offset:1024 lds
    ds_read_b64_tr_b16 a[12:13], v67 offset:32768
    v_mfma_f32_16x16x32_bf16 v[172:175], a[116:119], a[156:159], v[172:175]
    ds_read_b64_tr_b16 a[14:15], v67 offset:36864
    ds_read_b64_tr_b16 a[16:17], v68 offset:32768
    v_mfma_f32_16x16x32_bf16 v[168:171], a[116:119], a[152:155], v[168:171]
    s_bitcmp0_b32 s33, s32
    s_cbranch_scc1 k12_ool_141
k12_oolret_142:
    v_mfma_f32_16x16x32_bf16 v[168:171], a[84:87], a[144:147], v[168:171]
    ds_read_b64_tr_b16 a[18:19], v68 offset:36864
    ds_read_b64_tr_b16 a[20:21], v69 offset:32768
    v_mfma_f32_16x16x32_bf16 v[176:179], a[88:91], a[144:147], v[176:179]
    buffer_load_dwordx4 v92, s[12:15], s61 offen offset:2048 lds
    ds_read_b64_tr_b16 a[22:23], v69 offset:36864
    v_mfma_f32_16x16x32_bf16 v[176:179], a[120:123], a[152:155], v[176:179]
    ds_read_b64_tr_b16 a[24:25], v70 offset:32768
    ds_read_b64_tr_b16 a[26:27], v70 offset:36864
    v_mfma_f32_16x16x32_bf16 v[180:183], a[120:123], a[156:159], v[180:183]
    buffer_load_dwordx4 v93, s[12:15], s61 offen offset:3072 lds
    ds_read_b64_tr_b16 a[28:29], v71 offset:32768
    v_mfma_f32_16x16x32_bf16 v[180:183], a[88:91], a[148:151], v[180:183]
    ds_read_b64_tr_b16 a[30:31], v71 offset:36864
    ds_read_b64_tr_b16 a[32:33], v64 offset:40960
    v_mfma_f32_16x16x32_bf16 v[188:191], a[92:95], a[148:151], v[188:191]
    ds_read_b64_tr_b16 a[34:35], v64 offset:45056
    v_mfma_f32_16x16x32_bf16 v[188:191], a[124:127], a[156:159], v[188:191]
    ds_read_b64_tr_b16 a[36:37], v65 offset:40960
    v_mfma_f32_16x16x32_bf16 v[184:187], a[124:127], a[152:155], v[184:187]
    buffer_load_dwordx4 a[128:131], v88, s[8:11], s62 offen offset:0 sc1
    ds_read_b64_tr_b16 a[38:39], v65 offset:45056
    v_mfma_f32_16x16x32_bf16 v[184:187], a[92:95], a[144:147], v[184:187]
    s_add_u32 s61, s61, 0x20000
    s_and_b32 s61, s61, 0x3fffff
    ds_read_b64_tr_b16 a[40:41], v66 offset:40960
    ds_read_b64_tr_b16 a[42:43], v66 offset:45056
    v_mfma_f32_16x16x32_bf16 v[128:131], a[64:67], a[144:147], v[128:131]
    ds_read_b64_tr_b16 a[44:45], v67 offset:40960
    v_mfma_f32_16x16x32_bf16 v[128:131], a[96:99], a[152:155], v[128:131]
    buffer_load_dwordx4 a[132:135], v88, s[8:11], s62 offen offset:1024 sc1
    ds_read_b64_tr_b16 a[46:47], v67 offset:45056
    v_mfma_f32_16x16x32_bf16 v[132:135], a[96:99], a[156:159], v[132:135]
    ds_read_b64_tr_b16 a[48:49], v68 offset:40960
    v_mfma_f32_16x16x32_bf16 v[132:135], a[64:67], a[148:151], v[132:135]
    ds_read_b64_tr_b16 a[50:51], v68 offset:45056
    ds_read_b64_tr_b16 a[52:53], v69 offset:40960
    v_mfma_f32_16x16x32_bf16 v[140:143], a[68:71], a[148:151], v[140:143]
    ds_read_b64_tr_b16 a[54:55], v69 offset:45056
    v_mfma_f32_16x16x32_bf16 v[140:143], a[100:103], a[156:159], v[140:143]
    buffer_load_dwordx4 a[136:139], v89, s[8:11], s62 offen offset:0 sc1
    ds_read_b64_tr_b16 a[56:57], v70 offset:40960
    v_mfma_f32_16x16x32_bf16 v[136:139], a[100:103], a[152:155], v[136:139]
    ds_read_b64_tr_b16 a[58:59], v70 offset:45056
    ds_read_b64_tr_b16 a[60:61], v71 offset:40960
    v_mfma_f32_16x16x32_bf16 v[136:139], a[68:71], a[144:147], v[136:139]
    ds_read_b64_tr_b16 a[62:63], v71 offset:45056
    v_mfma_f32_16x16x32_bf16 v[144:147], a[72:75], a[144:147], v[144:147]
    buffer_load_dwordx4 a[140:143], v89, s[8:11], s62 offen offset:1024 sc1
    v_mfma_f32_16x16x32_bf16 v[144:147], a[104:107], a[152:155], v[144:147]
    v_mfma_f32_16x16x32_bf16 v[148:151], a[104:107], a[156:159], v[148:151]
    s_cmp_eq_u32 s63, 6
    s_cbranch_scc1 k12_ool_143
k12_oolret_144:
    v_mfma_f32_16x16x32_bf16 v[148:151], a[72:75], a[148:151], v[148:151]
    v_mfma_f32_16x16x32_bf16 v[156:159], a[76:79], a[148:151], v[156:159]
    v_mfma_f32_16x16x32_bf16 v[156:159], a[108:111], a[156:159], v[156:159]
    s_add_u32 s62, s62, 0x40000
    s_and_b32 s62, s62, 0x7fffff
    v_mfma_f32_16x16x32_bf16 v[152:155], a[108:111], a[152:155], v[152:155]
    v_mfma_f32_16x16x32_bf16 v[152:155], a[76:79], a[144:147], v[152:155]
    s_waitcnt vmcnt(12) lgkmcnt(0)
    s_barrier
    v_mfma_f32_16x16x32_bf16 v[160:163], a[16:19], a[160:163], v[160:163]
    s_add_u32 m0, s60, 16384
    buffer_load_dword v74, v73, s[16:19], s59 offen sc1
    ds_read_b64_tr_b16 a[64:65], v64 offset:49152
    v_mfma_f32_16x16x32_bf16 v[160:163], a[48:51], a[168:171], v[160:163]
    buffer_load_dwordx4 v90, s[12:15], s61 offen offset:0 lds
    ds_read_b64_tr_b16 a[66:67], v64 offset:53248
    v_mfma_f32_16x16x32_bf16 v[164:167], a[48:51], a[172:175], v[164:167]
    ds_read_b64_tr_b16 a[68:69], v65 offset:49152
    ds_read_b64_tr_b16 a[70:71], v65 offset:53248
    v_mfma_f32_16x16x32_bf16 v[164:167], a[16:19], a[164:167], v[164:167]
    ds_read_b64_tr_b16 a[72:73], v66 offset:49152
    ds_read_b64_tr_b16 a[74:75], v66 offset:53248
    v_mfma_f32_16x16x32_bf16 v[172:175], a[20:23], a[164:167], v[172:175]
    buffer_load_dwordx4 v91, s[12:15], s61 offen offset:1024 lds
    ds_read_b64_tr_b16 a[76:77], v67 offset:49152
    v_mfma_f32_16x16x32_bf16 v[172:175], a[52:55], a[172:175], v[172:175]
    ds_read_b64_tr_b16 a[78:79], v67 offset:53248
    ds_read_b64_tr_b16 a[80:81], v68 offset:49152
    v_mfma_f32_16x16x32_bf16 v[168:171], a[52:55], a[168:171], v[168:171]
    ds_read_b64_tr_b16 a[82:83], v68 offset:53248
    v_mfma_f32_16x16x32_bf16 v[168:171], a[20:23], a[160:163], v[168:171]
    buffer_load_dwordx4 v92, s[12:15], s61 offen offset:2048 lds
    ds_read_b64_tr_b16 a[84:85], v69 offset:49152
    v_mfma_f32_16x16x32_bf16 v[176:179], a[24:27], a[160:163], v[176:179]
    ds_read_b64_tr_b16 a[86:87], v69 offset:53248
    ds_read_b64_tr_b16 a[88:89], v70 offset:49152
    v_mfma_f32_16x16x32_bf16 v[176:179], a[56:59], a[168:171], v[176:179]
    ds_read_b64_tr_b16 a[90:91], v70 offset:53248
    v_mfma_f32_16x16x32_bf16 v[180:183], a[56:59], a[172:175], v[180:183]
    buffer_load_dwordx4 v93, s[12:15], s61 offen offset:3072 lds
    ds_read_b64_tr_b16 a[92:93], v71 offset:49152
    v_mfma_f32_16x16x32_bf16 v[180:183], a[24:27], a[164:167], v[180:183]
    ds_read_b64_tr_b16 a[94:95], v71 offset:53248
    ds_read_b64_tr_b16 a[96:97], v64 offset:57344
    v_mfma_f32_16x16x32_bf16 v[188:191], a[28:31], a[164:167], v[188:191]
    ds_read_b64_tr_b16 a[98:99], v64 offset:61440
    v_mfma_f32_16x16x32_bf16 v[188:191], a[60:63], a[172:175], v[188:191]
    ds_read_b64_tr_b16 a[100:101], v65 offset:57344
    v_mfma_f32_16x16x32_bf16 v[184:187], a[60:63], a[168:171], v[184:187]
    buffer_load_dwordx4 a[144:147], v88, s[8:11], s62 offen offset:0 sc1
    ds_read_b64_tr_b16 a[102:103], v65 offset:61440
    v_mfma_f32_16x16x32_bf16 v[184:187], a[28:31], a[160:163], v[184:187]
    s_add_u32 s61, s61, 0x20000
    s_and_b32 s61, s61, 0x3fffff
    ds_read_b64_tr_b16 a[104:105], v66 offset:57344
    ds_read_b64_tr_b16 a[106:107], v66 offset:61440
    v_mfma_f32_16x16x32_bf16 v[128:131], a[0:3], a[160:163], v[128:131]
    ds_read_b64_tr_b16 a[108:109], v67 offset:57344
    v_mfma_f32_16x16x32_bf16 v[128:131], a[32:35], a[168:171], v[128:131]
    buffer_load_dwordx4 a[148:151], v88, s[8:11], s62 offen offset:1024 sc1
    ds_read_b64_tr_b16 a[110:111], v67 offset:61440
    v_mfma_f32_16x16x32_bf16 v[132:135], a[32:35], a[172:175], v[132:135]
    ds_read_b64_tr_b16 a[112:113], v68 offset:57344
    v_mfma_f32_16x16x32_bf16 v[132:135], a[0:3], a[164:167], v[132:135]
    ds_read_b64_tr_b16 a[114:115], v68 offset:61440
    ds_read_b64_tr_b16 a[116:117], v69 offset:57344
    v_mfma_f32_16x16x32_bf16 v[140:143], a[4:7], a[164:167], v[140:143]
    ds_read_b64_tr_b16 a[118:119], v69 offset:61440
    v_mfma_f32_16x16x32_bf16 v[140:143], a[36:39], a[172:175], v[140:143]
    buffer_load_dwordx4 a[152:155], v89, s[8:11], s62 offen offset:0 sc1
    ds_read_b64_tr_b16 a[120:121], v70 offset:57344
    v_mfma_f32_16x16x32_bf16 v[136:139], a[36:39], a[168:171], v[136:139]
    ds_read_b64_tr_b16 a[122:123], v70 offset:61440
    ds_read_b64_tr_b16 a[124:125], v71 offset:57344
    v_mfma_f32_16x16x32_bf16 v[136:139], a[4:7], a[160:163], v[136:139]
    ds_read_b64_tr_b16 a[126:127], v71 offset:61440
    v_mfma_f32_16x16x32_bf16 v[144:147], a[8:11], a[160:163], v[144:147]
    buffer_load_dwordx4 a[156:159], v89, s[8:11], s62 offen offset:1024 sc1
    v_mfma_f32_16x16x32_bf16 v[144:147], a[40:43], a[168:171], v[144:147]
    v_mfma_f32_16x16x32_bf16 v[148:151], a[40:43], a[172:175], v[148:151]
    v_mfma_f32_16x16x32_bf16 v[148:151], a[8:11], a[164:167], v[148:151]
    v_mfma_f32_16x16x32_bf16 v[156:159], a[12:15], a[164:167], v[156:159]
    v_mfma_f32_16x16x32_bf16 v[156:159], a[44:47], a[172:175], v[156:159]
    s_add_u32 s62, s62, 0x40000
    s_and_b32 s62, s62, 0x7fffff
    v_mfma_f32_16x16x32_bf16 v[152:155], a[44:47], a[168:171], v[152:155]
    v_mfma_f32_16x16x32_bf16 v[152:155], a[12:15], a[160:163], v[152:155]
    s_waitcnt vmcnt(12) lgkmcnt(0)
    s_barrier
    v_mfma_f32_16x16x32_bf16 v[160:163], a[80:83], a[176:179], v[160:163]
    s_add_u32 m0, s60, 32768
    ds_read_b64_tr_b16 a[0:1], v64 offset:0
    ds_read_b64_tr_b16 a[2:3], v64 offset:4096
    v_mfma_f32_16x16x32_bf16 v[160:163], a[112:115], a[184:187], v[160:163]
    buffer_load_dwordx4 v90, s[12:15], s61 offen offset:0 lds
    ds_read_b64_tr_b16 a[4:5], v65 offset:0
    v_mfma_f32_16x16x32_bf16 v[164:167], a[112:115], a[188:191], v[164:167]
    ds_read_b64_tr_b16 a[6:7], v65 offset:4096
    ds_read_b64_tr_b16 a[8:9], v66 offset:0
    v_mfma_f32_16x16x32_bf16 v[164:167], a[80:83], a[180:183], v[164:167]
    buffer_load_dwordx4 v91, s[12:15], s61 offen offset:1024 lds
    ds_read_b64_tr_b16 a[10:11], v66 offset:4096
    v_mfma_f32_16x16x32_bf16 v[172:175], a[84:87], a[180:183], v[172:175]
    ds_read_b64_tr_b16 a[12:13], v67 offset:0
    ds_read_b64_tr_b16 a[14:15], v67 offset:4096
    v_mfma_f32_16x16x32_bf16 v[172:175], a[116:119], a[188:191], v[172:175]
    ds_read_b64_tr_b16 a[16:17], v68 offset:0
    v_mfma_f32_16x16x32_bf16 v[168:171], a[116:119], a[184:187], v[168:171]
    ds_read_b64_tr_b16 a[18:19], v68 offset:4096
    v_mfma_f32_16x16x32_bf16 v[168:171], a[84:87], a[176:179], v[168:171]
    buffer_load_dwordx4 v92, s[12:15], s61 offen offset:2048 lds
    ds_read_b64_tr_b16 a[20:21], v69 offset:0
    v_mfma_f32_16x16x32_bf16 v[176:179], a[88:91], a[176:179], v[176:179]
    ds_read_b64_tr_b16 a[22:23], v69 offset:4096
    ds_read_b64_tr_b16 a[24:25], v70 offset:0
    v_mfma_f32_16x16x32_bf16 v[176:179], a[120:123], a[184:187], v[176:179]
    ds_read_b64_tr_b16 a[26:27], v70 offset:4096
    v_mfma_f32_16x16x32_bf16 v[180:183], a[120:123], a[188:191], v[180:183]
    buffer_load_dwordx4 v93, s[12:15], s61 offen offset:3072 lds
    ds_read_b64_tr_b16 a[28:29], v71 offset:0
    v_mfma_f32_16x16x32_bf16 v[180:183], a[88:91], a[180:183], v[180:183]
    ds_read_b64_tr_b16 a[30:31], v71 offset:4096
    ds_read_b64_tr_b16 a[32:33], v64 offset:8192
    v_mfma_f32_16x16x32_bf16 v[188:191], a[92:95], a[180:183], v[188:191]
    ds_read_b64_tr_b16 a[34:35], v64 offset:12288
    v_mfma_f32_16x16x32_bf16 v[188:191], a[124:127], a[188:191], v[188:191]
    ds_read_b64_tr_b16 a[36:37], v65 offset:8192
    v_mfma_f32_16x16x32_bf16 v[184:187], a[124:127], a[184:187], v[184:187]
    buffer_load_dwordx4 a[160:163], v88, s[8:11], s62 offen offset:0 sc1
    ds_read_b64_tr_b16 a[38:39], v65 offset:12288
    v_mfma_f32_16x16x32_bf16 v[184:187], a[92:95], a[176:179], v[184:187]
    s_add_u32 s61, s61, 0x20000
    s_and_b32 s61, s61, 0x3fffff
    ds_read_b64_tr_b16 a[40:41], v66 offset:8192
    ds_read_b64_tr_b16 a[42:43], v66 offset:12288
    v_mfma_f32_16x16x32_bf16 v[128:131], a[64:67], a[176:179], v[128:131]
    ds_read_b64_tr_b16 a[44:45], v67 offset:8192
    v_mfma_f32_16x16x32_bf16 v[128:131], a[96:99], a[184:187], v[128:131]
    buffer_load_dwordx4 a[164:167], v88, s[8:11], s62 offen offset:1024 sc1
    ds_read_b64_tr_b16 a[46:47], v67 offset:12288
    v_mfma_f32_16x16x32_bf16 v[132:135], a[96:99], a[188:191], v[132:135]
    ds_read_b64_tr_b16 a[48:49], v68 offset:8192
    v_mfma_f32_16x16x32_bf16 v[132:135], a[64:67], a[180:183], v[132:135]
    ds_read_b64_tr_b16 a[50:51], v68 offset:12288
    ds_read_b64_tr_b16 a[52:53], v69 offset:8192
    v_mfma_f32_16x16x32_bf16 v[140:143], a[68:71], a[180:183], v[140:143]
    ds_read_b64_tr_b16 a[54:55], v69 offset:12288
    v_mfma_f32_16x16x32_bf16 v[140:143], a[100:103], a[188:191], v[140:143]
    buffer_load_dwordx4 a[168:171], v89, s[8:11], s62 offen offset:0 sc1
    ds_read_b64_tr_b16 a[56:57], v70 offset:8192
    v_mfma_f32_16x16x32_bf16 v[136:139], a[100:103], a[184:187], v[136:139]
    ds_read_b64_tr_b16 a[58:59], v70 offset:12288
    ds_read_b64_tr_b16 a[60:61], v71 offset:8192
    v_mfma_f32_16x16x32_bf16 v[136:139], a[68:71], a[176:179], v[136:139]
    ds_read_b64_tr_b16 a[62:63], v71 offset:12288
    v_mfma_f32_16x16x32_bf16 v[144:147], a[72:75], a[176:179], v[144:147]
    buffer_load_dwordx4 a[172:175], v89, s[8:11], s62 offen offset:1024 sc1
    v_mfma_f32_16x16x32_bf16 v[144:147], a[104:107], a[184:187], v[144:147]
    v_mfma_f32_16x16x32_bf16 v[148:151], a[104:107], a[188:191], v[148:151]
    v_mfma_f32_16x16x32_bf16 v[148:151], a[72:75], a[180:183], v[148:151]
    v_mfma_f32_16x16x32_bf16 v[156:159], a[76:79], a[180:183], v[156:159]
    v_mfma_f32_16x16x32_bf16 v[156:159], a[108:111], a[188:191], v[156:159]
    s_add_u32 s62, s62, 0x40000
    s_and_b32 s62, s62, 0x7fffff
    v_mfma_f32_16x16x32_bf16 v[152:155], a[108:111], a[184:187], v[152:155]
    s_add_u32 s63, s63, 1
    v_mfma_f32_16x16x32_bf16 v[152:155], a[76:79], a[176:179], v[152:155]
    s_waitcnt vmcnt(12) lgkmcnt(0)
    s_barrier
    s_cmp_lt_u32 s63, 8
    s_cbranch_scc1 op_loop_134
op_tail:
    s_nop 1
    v_cvt_pk_bf16_f32 v160, v160, v161
    v_cvt_pk_bf16_f32 v161, v162, v163
    v_cvt_pk_bf16_f32 v162, v164, v165
    v_cvt_pk_bf16_f32 v163, v166, v167
    v_min_u32 v160, -2, v160
    v_min_u32 v161, -2, v161
    v_min_u32 v162, -2, v162
    v_min_u32 v163, -2, v163
    buffer_store_dwordx4 v[160:163], v1, s[36:39], s52 offen offset:0 sc1
    v_cvt_pk_bf16_f32 v168, v168, v169
    v_cvt_pk_bf16_f32 v169, v170, v171
    v_cvt_pk_bf16_f32 v170, v172, v173
    v_cvt_pk_bf16_f32 v171, v174, v175
    v_min_u32 v168, -2, v168
    v_min_u32 v169, -2, v169
    v_min_u32 v170, -2, v170
    v_min_u32 v171, -2, v171
    buffer_store_dwordx4 v[168:171], v1, s[36:39], s52 offen offset:1024 sc1
    v_cvt_pk_bf16_f32 v176, v176, v177
    v_cvt_pk_bf16_f32 v177, v178, v179
    v_cvt_pk_bf16_f32 v178, v180, v181
    v_cvt_pk_bf16_f32 v179, v182, v183
    v_min_u32 v176, -2, v176
    v_min_u32 v177, -2, v177
    v_min_u32 v178, -2, v178
    v_min_u32 v179, -2, v179
    buffer_store_dwordx4 v[176:179], v1, s[36:39], s52 offen offset:2048 sc1
    v_cvt_pk_bf16_f32 v184, v184, v185
    v_cvt_pk_bf16_f32 v185, v186, v187
    v_cvt_pk_bf16_f32 v186, v188, v189
    v_cvt_pk_bf16_f32 v187, v190, v191
    v_min_u32 v184, -2, v184
    v_min_u32 v185, -2, v185
    v_min_u32 v186, -2, v186
    v_min_u32 v187, -2, v187
    buffer_store_dwordx4 v[184:187], v1, s[36:39], s52 offen offset:3072 sc1
    s_add_u32 s32, s6, 0x4800000
    s_addc_u32 s33, s7, 0
    s_and_b32 s33, s33, 0xffff
    s_mov_b32 s34, 0x6000
    s_mov_b32 s35, 0x00020000
    s_waitcnt vmcnt(4) lgkmcnt(0)
    v_lshlrev_b32 v58, 16, v192
    v_and_b32 v59, 0xffff0000, v192
    v_pk_add_f32 v[128:129], v[128:129], v[58:59]
    v_lshlrev_b32 v58, 16, v193
    v_and_b32 v59, 0xffff0000, v193
    v_pk_add_f32 v[130:131], v[130:131], v[58:59]
    v_lshlrev_b32 v58, 16, v200
    v_and_b32 v59, 0xffff0000, v200
    v_pk_add_f32 v[132:133], v[132:133], v[58:59]
    v_lshlrev_b32 v58, 16, v201
    v_and_b32 v59, 0xffff0000, v201
    v_pk_add_f32 v[134:135], v[134:135], v[58:59]
    v_lshlrev_b32 v58, 16, v194
    v_and_b32 v59, 0xffff0000, v194
    v_pk_add_f32 v[136:137], v[136:137], v[58:59]
    v_lshlrev_b32 v58, 16, v195
    v_and_b32 v59, 0xffff0000, v195
    v_pk_add_f32 v[138:139], v[138:139], v[58:59]
    v_lshlrev_b32 v58, 16, v202
    v_and_b32 v59, 0xffff0000, v202
    v_pk_add_f32 v[140:141], v[140:141], v[58:59]
    v_lshlrev_b32 v58, 16, v203
    v_and_b32 v59, 0xffff0000, v203
    v_pk_add_f32 v[142:143], v[142:143], v[58:59]
    v_lshlrev_b32 v58, 16, v196
    v_and_b32 v59, 0xffff0000, v196
    v_pk_add_f32 v[144:145], v[144:145], v[58:59]
    v_lshlrev_b32 v58, 16, v197
    v_and_b32 v59, 0xffff0000, v197
    v_pk_add_f32 v[146:147], v[146:147], v[58:59]
    v_lshlrev_b32 v58, 16, v204
    v_and_b32 v59, 0xffff0000, v204
    v_pk_add_f32 v[148:149], v[148:149], v[58:59]
    v_lshlrev_b32 v58, 16, v205
    v_and_b32 v59, 0xffff0000, v205
    v_pk_add_f32 v[150:151], v[150:151], v[58:59]
    v_lshlrev_b32 v58, 16, v198
    v_and_b32 v59, 0xffff0000, v198
    v_pk_add_f32 v[152:153], v[152:153], v[58:59]
    v_lshlrev_b32 v58, 16, v199
    v_and_b32 v59, 0xffff0000, v199
    v_pk_add_f32 v[154:155], v[154:155], v[58:59]
    v_lshlrev_b32 v58, 16, v206
    v_and_b32 v59, 0xffff0000, v206
    v_pk_add_f32 v[156:157], v[156:157], v[58:59]
    v_lshlrev_b32 v58, 16, v207
    v_and_b32 v59, 0xffff0000, v207
    v_pk_add_f32 v[158:159], v[158:159], v[58:59]
    v_and_b32 v58, 1, v72
    v_lshrrev_b32 v59, 1, v72
    v_lshlrev_b32 v58, 5, v58
    v_lshl_add_u32 v58, v59, 4, v58
    v_lshlrev_b32 v59, 3, v72
    v_sub_u32 v58, v58, v59
    v_add_u32 v78, v78, v58
    v_add_u32 v79, v79, v58
    s_mov_b32 s42, 0x00003f80
    s_mov_b32 s43, 0x3f800000
    s_mov_b32 s41, 0x3f803f80
    s_or_b32 s31, s54, s30
    s_cbranch_scc1 op_nowr_145
    v_dot2_f32_bf16 v56, v208, s41, 0
    v_dot2_f32_bf16 v56, v209, s41, v56
    v_dot2_f32_bf16 v56, v210, s41, v56
    v_dot2_f32_bf16 v56, v211, s41, v56
    v_dot2_f32_bf16 v56, v212, s41, v56
    v_dot2_f32_bf16 v56, v213, s41, v56
    v_dot2_f32_bf16 v56, v214, s41, v56
    v_dot2_f32_bf16 v56, v215, s41, v56
    s_nop 2
    v_mov_b32 v57, v56
    s_nop 1
    v_permlane16_swap_b32 v56, v57
    s_nop 1
    v_add_f32 v56, v56, v57
    v_mov_b32 v57, v56
    s_nop 1
    v_permlane32_swap_b32 v56, v57
    s_nop 1
    v_add_f32 v56, v56, v57
    s_mov_b32 s31, 24704
    s_mov_b32 s34, 24708
    s_mov_b64 exec, 1
    buffer_atomic_add_f32 v56, v75, s[32:35], s31 offen
    s_mov_b64 exec, -1
    s_mov_b32 s34, 24576
op_nowr_145:
    s_mov_b32 s40, 1048576
op_xspin_146:
    buffer_load_dwordx4 v[224:227], v1, s[36:39], s53 offen offset:0 sc1
    buffer_load_dwordx4 v[228:231], v1, s[36:39], s53 offen offset:1024 sc1
    buffer_load_dwordx4 v[232:235], v1, s[36:39], s53 offen offset:2048 sc1
    buffer_load_dwordx4 v[236:239], v1, s[36:39], s53 offen offset:3072 sc1
    s_sub_u32 s40, s40, 1
    s_waitcnt vmcnt(0)
    s_cbranch_scc1 op_xok_147
    v_max3_u32 v56, v224, v225, v226
    v_max3_u32 v56, v56, v227, v228
    v_max3_u32 v56, v56, v229, v230
    v_max3_u32 v56, v56, v231, v232
    v_max3_u32 v56, v56, v233, v234
    v_max3_u32 v56, v56, v235, v236
    v_max3_u32 v56, v56, v237, v238
    v_max_u32 v56, v56, v239
    v_cmp_eq_u32 vcc, -1, v56
    s_cbranch_vccz op_xok_147
    s_sleep 2
    s_branch op_xspin_146
op_xok_147:
    v_dot2_f32_bf16 v128, v224, s42, v128
    v_dot2_f32_bf16 v129, v224, s43, v129
    v_dot2_f32_bf16 v130, v225, s42, v130
    v_dot2_f32_bf16 v131, v225, s43, v131
    v_dot2_f32_bf16 v132, v226, s42, v132
    v_dot2_f32_bf16 v133, v226, s43, v133
    v_dot2_f32_bf16 v134, v227, s42, v134
    v_dot2_f32_bf16 v135, v227, s43, v135
    s_nop 0
    v_cvt_pk_bf16_f32 v192, v128, v129
    v_cvt_pk_bf16_f32 v193, v130, v131
    v_cvt_pk_bf16_f32 v200, v132, v133
    v_cvt_pk_bf16_f32 v201, v134, v135
    v_dot2_f32_bf16 v48, v192, s41, 0
    v_dot2_f32_bf16 v49, v192, v192, 0
    v_dot2_f32_bf16 v50, v192, v208, 0
    v_dot2_f32_bf16 v48, v193, s41, v48
    v_dot2_f32_bf16 v49, v193, v193, v49
    v_dot2_f32_bf16 v50, v193, v209, v50
    v_dot2_f32_bf16 v52, v200, s41, 0
    v_dot2_f32_bf16 v53, v200, v200, 0
    v_dot2_f32_bf16 v54, v200, v208, 0
    v_dot2_f32_bf16 v52, v201, s41, v52
    v_dot2_f32_bf16 v53, v201, v201, v53
    v_dot2_f32_bf16 v54, v201, v209, v54
    v_dot2_f32_bf16 v136, v228, s42, v136
    v_dot2_f32_bf16 v137, v228, s43, v137
    v_dot2_f32_bf16 v138, v229, s42, v138
    v_dot2_f32_bf16 v139, v229, s43, v139
    v_dot2_f32_bf16 v140, v230, s42, v140
    v_dot2_f32_bf16 v141, v230, s43, v141
    v_dot2_f32_bf16 v142, v231, s42, v142
    v_dot2_f32_bf16 v143, v231, s43, v143
    s_nop 0
    v_cvt_pk_bf16_f32 v194, v136, v137
    v_cvt_pk_bf16_f32 v195, v138, v139
    v_cvt_pk_bf16_f32 v202, v140, v141
    v_cvt_pk_bf16_f32 v203, v142, v143
    v_dot2_f32_bf16 v48, v194, s41, v48
    v_dot2_f32_bf16 v49, v194, v194, v49
    v_dot2_f32_bf16 v50, v194, v210, v50
    v_dot2_f32_bf16 v48, v195, s41, v48
    v_dot2_f32_bf16 v49, v195, v195, v49
    v_dot2_f32_bf16 v50, v195, v211, v50
    v_permlane16_swap_b32 v192, v194
    v_permlane16_swap_b32 v193, v195
    buffer_store_dwordx4 v[192:195], v78, s[24:27], 0 offen offset:0 sc1
    v_dot2_f32_bf16 v52, v202, s41, v52
    v_dot2_f32_bf16 v53, v202, v202, v53
    v_dot2_f32_bf16 v54, v202, v210, v54
    v_dot2_f32_bf16 v52, v203, s41, v52
    v_dot2_f32_bf16 v53, v203, v203, v53
    v_dot2_f32_bf16 v54, v203, v211, v54
    v_permlane16_swap_b32 v200, v202
    v_permlane16_swap_b32 v201, v203
    buffer_store_dwordx4 v[200:203], v79, s[24:27], 0 offen offset:0 sc1
    v_dot2_f32_bf16 v144, v232, s42, v144
    v_dot2_f32_bf16 v145, v232, s43, v145
    v_dot2_f32_bf16 v146, v233, s42, v146
    v_dot2_f32_bf16 v147, v233, s43, v147
    v_dot2_f32_bf16 v148, v234, s42, v148
    v_dot2_f32_bf16 v149, v234, s43, v149
    v_dot2_f32_bf16 v150, v235, s42, v150
    v_dot2_f32_bf16 v151, v235, s43, v151
    s_nop 0
    v_cvt_pk_bf16_f32 v196, v144, v145
    v_cvt_pk_bf16_f32 v197, v146, v147
    v_cvt_pk_bf16_f32 v204, v148, v149
    v_cvt_pk_bf16_f32 v205, v150, v151
    v_dot2_f32_bf16 v48, v196, s41, v48
    v_dot2_f32_bf16 v49, v196, v196, v49
    v_dot2_f32_bf16 v50, v196, v212, v50
    v_dot2_f32_bf16 v48, v197, s41, v48
    v_dot2_f32_bf16 v49, v197, v197, v49
    v_dot2_f32_bf16 v50, v197, v213, v50
    v_dot2_f32_bf16 v52, v204, s41, v52
    v_dot2_f32_bf16 v53, v204, v204, v53
    v_dot2_f32_bf16 v54, v204, v212, v54
    v_dot2_f32_bf16 v52, v205, s41, v52
    v_dot2_f32_bf16 v53, v205, v205, v53
    v_dot2_f32_bf16 v54, v205, v213, v54
    v_dot2_f32_bf16 v152, v236, s42, v152
    v_dot2_f32_bf16 v153, v236, s43, v153
    v_dot2_f32_bf16 v154, v237, s42, v154
    v_dot2_f32_bf16 v155, v237, s43, v155
    v_dot2_f32_bf16 v156, v238, s42, v156
    v_dot2_f32_bf16 v157, v238, s43, v157
    v_dot2_f32_bf16 v158, v239, s42, v158
    v_dot2_f32_bf16 v159, v239, s43, v159
    s_nop 0
    v_cvt_pk_bf16_f32 v198, v152, v153
    v_cvt_pk_bf16_f32 v199, v154, v155
    v_cvt_pk_bf16_f32 v206, v156, v157
    v_cvt_pk_bf16_f32 v207, v158, v159
    v_dot2_f32_bf16 v48, v198, s41, v48
    v_dot2_f32_bf16 v49, v198, v198, v49
    v_dot2_f32_bf16 v50, v198, v214, v50
    v_dot2_f32_bf16 v48, v199, s41, v48
    v_dot2_f32_bf16 v49, v199, v199, v49
    v_dot2_f32_bf16 v50, v199, v215, v50
    v_permlane16_swap_b32 v196, v198
    v_permlane16_swap_b32 v197, v199
    buffer_store_dwordx4 v[196:199], v78, s[24:27], 0 offen offset:64 sc1
    v_dot2_f32_bf16 v52, v206, s41, v52
    v_dot2_f32_bf16 v53, v206, v206, v53
    v_dot2_f32_bf16 v54, v206, v214, v54
    v_dot2_f32_bf16 v52, v207, s41, v52
    v_dot2_f32_bf16 v53, v207, v207, v53
    v_dot2_f32_bf16 v54, v207, v215, v54
    v_permlane16_swap_b32 v204, v206
    v_permlane16_swap_b32 v205, v207
    buffer_store_dwordx4 v[204:207], v79, s[24:27], 0 offen offset:64 sc1
    s_nop 2
    v_mov_b32 v56, v48
    v_mov_b32 v57, v49
    v_mov_b32 v58, v50
    v_mov_b32 v59, v52
    v_mov_b32 v60, v53
    v_mov_b32 v61, v54
    s_nop 1
    v_permlane16_swap_b32 v48, v56
    v_permlane16_swap_b32 v49, v57
    v_permlane16_swap_b32 v50, v58
    v_permlane16_swap_b32 v52, v59
    v_permlane16_swap_b32 v53, v60
    v_permlane16_swap_b32 v54, v61
    s_nop 1
    v_add_f32 v48, v48, v56
    v_add_f32 v49, v49, v57
    v_add_f32 v50, v50, v58
    v_add_f32 v52, v52, v59
    v_add_f32 v53, v53, v60
    v_add_f32 v54, v54, v61
    v_mov_b32 v56, v48
    v_mov_b32 v57, v49
    v_mov_b32 v58, v50
    v_mov_b32 v59, v52
    v_mov_b32 v60, v53
    v_mov_b32 v61, v54
    s_nop 1
    v_permlane32_swap_b32 v48, v56
    v_permlane32_swap_b32 v49, v57
    v_permlane32_swap_b32 v50, v58
    v_permlane32_swap_b32 v52, v59
    v_permlane32_swap_b32 v53, v60
    v_permlane32_swap_b32 v54, v61
    s_nop 1
    v_add_f32 v48, v48, v56
    v_add_f32 v49, v49, v57
    v_add_f32 v50, v50, v58
    v_add_f32 v52, v52, v59
    v_add_f32 v53, v53, v60
    v_add_f32 v54, v54, v61
    v_cmp_eq_u32 s[40:41], 1, v72
    v_cmp_eq_u32 s[42:43], 2, v72
    s_nop 1
    v_cndmask_b32 v48, v48, v49, s[40:41]
    v_cndmask_b32 v48, v48, v50, s[42:43]
    buffer_atomic_add_f32 v48, v77, s[32:35], 0 offen offset:0
    v_cndmask_b32 v52, v52, v53, s[40:41]
    v_cndmask_b32 v52, v52, v54, s[42:43]
    buffer_atomic_add_f32 v52, v77, s[32:35], 0 offen offset:64
    s_load_dwordx2 s[42:43], s[0:1], 88
    s_load_dwordx2 s[56:57], s[0:1], 56
    s_add_u32 s16, s6, 0x4815000
    s_addc_u32 s17, s7, 0
    s_and_b32 s17, s17, 0xffff
    s_mov_b32 s18, 0x1000
    s_mov_b32 s19, 0x00020000
    v_lshrrev_b32 v3, 4, v1
    v_lshl_add_u32 v2, s30, 6, v3
    v_and_b32 v4, 31, v3
    v_lshrrev_b32 v5, 5, v3
    v_lshlrev_b32 v7, 4, v4
    v_and_b32 v8, 15, v3
    v_lshlrev_b32 v6, 7, v8
    s_bfe_u32 s31, s2, 0x20003
    s_lshl_b32 s31, s31, 7
    v_lshlrev_b32 v12, 9, v3
    v_and_b32 v14, 3, v3
    v_lshlrev_b32 v14, 7, v14
    s_and_b32 s59, s2, 7
    s_lshl_b32 s59, s59, 9
    s_setreg_imm32_b32 hwreg(HW_REG_MODE, 4, 2), 3
    s_waitcnt vmcnt(0) lgkmcnt(0)
    s_barrier
    s_cmp_lg_u32 s30, 0
    s_cbranch_scc1 ff_nosig_148
    s_mov_b64 exec, 0xff
    buffer_atomic_add v76, v12, s[16:19], s31 offen sc1
    s_mov_b64 exec, -1
ff_nosig_148:
    s_lshl_b32 s40, s30, 13
    s_add_u32 m0, s40, 65536
    s_add_u32 s41, s3, 0
    buffer_load_dwordx4 v1, s[44:47], s41 offen offset:0 sc1 lds
    buffer_load_dwordx4 v1, s[44:47], s41 offen offset:1024 sc1 lds
    buffer_load_dwordx4 v1, s[44:47], s41 offen offset:2048 sc1 lds
    buffer_load_dwordx4 v1, s[44:47], s41 offen offset:3072 sc1 lds
    s_lshl_b32 s41, s30, 9
    s_add_u32 s41, s41, 131072
    v_lshrrev_b32 v9, 1, v1
    v_add_u32 v9, s41, v9
    ds_read_b64 v[96:97], v9 offset:0
    ds_read_b64 v[98:99], v9 offset:2048
    ds_read_b64 v[100:101], v9 offset:4096
    ds_read_b64 v[102:103], v9 offset:6144
    ds_read_b64 v[104:105], v9 offset:8192
    ds_read_b64 v[106:107], v9 offset:10240
    ds_read_b64 v[108:109], v9 offset:12288
    ds_read_b64 v[110:111], v9 offset:14336
    ds_read_b64 v[112:113], v9 offset:16384
    ds_read_b64 v[114:115], v9 offset:18432
    ds_read_b64 v[116:117], v9 offset:20480
    ds_read_b64 v[118:119], v9 offset:22528
    ds_read_b64 v[120:121], v9 offset:24576
    ds_read_b64 v[122:123], v9 offset:26624
    ds_read_b64 v[124:125], v9 offset:28672
    ds_read_b64 v[126:127], v9 offset:30720
    s_mov_b32 s54, 0x05040100
    s_mov_b32 s53, 0x07060302
    s_waitcnt lgkmcnt(0)
    v_perm_b32 v144, v98, v96, s54
    v_perm_b32 v145, v98, v96, s53
    v_perm_b32 v146, v99, v97, s54
    v_perm_b32 v147, v99, v97, s53
    v_perm_b32 v148, v102, v100, s54
    v_perm_b32 v149, v102, v100, s53
    v_perm_b32 v150, v103, v101, s54
    v_perm_b32 v151, v103, v101, s53
    v_perm_b32 v152, v106, v104, s54
    v_perm_b32 v153, v106, v104, s53
    v_perm_b32 v154, v107, v105, s54
    v_perm_b32 v155, v107, v105, s53
    v_perm_b32 v156, v110, v108, s54
    v_perm_b32 v157, v110, v108, s53
    v_perm_b32 v158, v111, v109, s54
    v_perm_b32 v159, v111, v109, s53
    v_perm_b32 v160, v114, v112, s54
    v_perm_b32 v161, v114, v112, s53
    v_perm_b32 v162, v115, v113, s54
    v_perm_b32 v163, v115, v113, s53
    v_perm_b32 v164, v118, v116, s54
    v_perm_b32 v165, v118, v116, s53
    v_perm_b32 v166, v119, v117, s54
    v_perm_b32 v167, v119, v117, s53
    v_perm_b32 v168, v122, v120, s54
    v_perm_b32 v169, v122, v120, s53
    v_perm_b32 v170, v123, v121, s54
    v_perm_b32 v171, v123, v121, s53
    v_perm_b32 v172, v126, v124, s54
    v_perm_b32 v173, v126, v124, s53
    v_perm_b32 v174, v127, v125, s54
    v_perm_b32 v175, v127, v125, s53
    s_waitcnt vmcnt(0)
    s_lshl_b32 s40, s30, 13
    s_add_u32 m0, s40, 69632
    s_add_u32 s41, s3, 4096
    buffer_load_dwordx4 v1, s[44:47], s41 offen offset:0 sc1 lds
    buffer_load_dwordx4 v1, s[44:47], s41 offen offset:1024 sc1 lds
    buffer_load_dwordx4 v1, s[44:47], s41 offen offset:2048 sc1 lds
    buffer_load_dwordx4 v1, s[44:47], s41 offen offset:3072 sc1 lds
    s_waitcnt vmcnt(0)
    s_lshl_b32 s40, s30, 13
    s_add_u32 m0, s40, 98304
    s_add_u32 s41, s3, 8388608
    buffer_load_dwordx4 v1, s[44:47], s41 offen offset:0 sc1 lds
    buffer_load_dwordx4 v1, s[44:47], s41 offen offset:1024 sc1 lds
    buffer_load_dwordx4 v1, s[44:47], s41 offen offset:2048 sc1 lds
    buffer_load_dwordx4 v1, s[44:47], s41 offen offset:3072 sc1 lds
    s_waitcnt vmcnt(0)
    s_lshl_b32 s40, s30, 13
    s_add_u32 m0, s40, 102400
    s_add_u32 s41, s3, 8392704
    buffer_load_dwordx4 v1, s[44:47], s41 offen offset:0 sc1 lds
    buffer_load_dwordx4 v1, s[44:47], s41 offen offset:1024 sc1 lds
    buffer_load_dwordx4 v1, s[44:47], s41 offen offset:2048 sc1 lds
    buffer_load_dwordx4 v1, s[44:47], s41 offen offset:3072 sc1 lds
    s_mov_b32 s34, 24708
    s_mov_b32 s36, s42
    s_and_b32 s37, s43, 0xffff
    s_mov_b32 s38, 0x400000
    s_mov_b32 s39, 0x00020000
    s_add_u32 s48, s6, 0x4900000
    s_addc_u32 s49, s7, 0
    s_and_b32 s49, s49, 0xffff
    s_mov_b32 s50, 0xe0000
    s_mov_b32 s51, 0x00020000
    v_lshlrev_b32 v10, 5, v2
    v_lshl_add_u32 v11, s30, 1, v5
    s_lshl_b32 s31, s2, 3
    v_add_u32 v11, s31, v11
    v_lshl_add_u32 v0, v11, 11, v7
    s_cmp_lg_u32 s30, 0
    s_cbranch_scc1 ff_go_149
    s_mov_b32 s52, 1048576
ff_poll_150:
    buffer_load_dword v13, v14, s[16:19], s59 offen sc1
    s_sub_u32 s52, s52, 1
    s_cbranch_scc1 ff_go_149
    s_waitcnt vmcnt(0)
    v_cmp_gt_u32 vcc, 64, v13
    s_cbranch_vccz ff_go_149
    s_sleep 4
    s_branch ff_poll_150
ff_go_149:
    s_barrier
    s_mov_b32 s31, 0
    buffer_load_dwordx4 v[16:19], v10, s[32:35], s31 offen sc1
    buffer_load_dwordx4 v[20:23], v10, s[32:35], s31 offen offset:16 sc1
    s_mov_b32 s31, 8192
    buffer_load_dwordx4 v[24:27], v10, s[32:35], s31 offen sc1
    buffer_load_dwordx4 v[28:31], v10, s[32:35], s31 offen offset:16 sc1
    s_mov_b32 s31, 16384
    buffer_load_dwordx4 v[32:35], v10, s[32:35], s31 offen sc1
    buffer_load_dwordx4 v[36:39], v10, s[32:35], s31 offen offset:16 sc1
    s_mov_b32 s31, 24704
    buffer_load_dword v10, v75, s[32:35], s31 offen sc1
    s_mov_b32 s52, 0x3a800000
    s_mov_b32 s53, 0x3a800000
    s_mov_b32 s54, 0x7ff
    v_mov_b32 v14, 0x3727c5ac
    v_mov_b32 v15, v14
    v_mov_b32 v12, 0xff800000
    v_mov_b32 v13, v12
    s_waitcnt vmcnt(0)
    v_sub_f32 v56, 0, v10
    v_sub_f32 v57, 0, v10
    v_pk_mul_f32 v[16:17], v[16:17], s[52:53]
    v_pk_fma_f32 v[24:25], v[24:25], s[52:53], v[14:15]
    v_pk_fma_f32 v[32:33], v[16:17], v[56:57], v[32:33]
    v_pk_fma_f32 v[24:25], v[16:17], v[16:17], v[24:25] neg_lo:[1,0,0] neg_hi:[1,0,0]
    v_pk_mul_f32 v[18:19], v[18:19], s[52:53]
    v_pk_fma_f32 v[26:27], v[26:27], s[52:53], v[14:15]
    v_pk_fma_f32 v[34:35], v[18:19], v[56:57], v[34:35]
    v_pk_fma_f32 v[26:27], v[18:19], v[18:19], v[26:27] neg_lo:[1,0,0] neg_hi:[1,0,0]
    v_pk_mul_f32 v[20:21], v[20:21], s[52:53]
    v_pk_fma_f32 v[28:29], v[28:29], s[52:53], v[14:15]
    v_pk_fma_f32 v[36:37], v[20:21], v[56:57], v[36:37]
    v_pk_fma_f32 v[28:29], v[20:21], v[20:21], v[28:29] neg_lo:[1,0,0] neg_hi:[1,0,0]
    v_pk_mul_f32 v[22:23], v[22:23], s[52:53]
    v_pk_fma_f32 v[30:31], v[30:31], s[52:53], v[14:15]
    v_pk_fma_f32 v[38:39], v[22:23], v[56:57], v[38:39]
    v_pk_fma_f32 v[30:31], v[22:23], v[22:23], v[30:31] neg_lo:[1,0,0] neg_hi:[1,0,0]
    v_max_f32 v24, v14, v24
    v_max_f32 v25, v14, v25
    v_max_f32 v26, v14, v26
    v_max_f32 v27, v14, v27
    v_max_f32 v28, v14, v28
    v_max_f32 v29, v14, v29
    v_max_f32 v30, v14, v30
    v_max_f32 v31, v14, v31
    v_rsq_f32 v24, v24
    v_rsq_f32 v25, v25
    v_rsq_f32 v26, v26
    v_rsq_f32 v27, v27
    v_rsq_f32 v28, v28
    v_rsq_f32 v29, v29
    v_rsq_f32 v30, v30
    v_rsq_f32 v31, v31
    v_pk_mul_f32 v[32:33], v[32:33], v[24:25]
    v_pk_mul_f32 v[34:35], v[34:35], v[26:27]
    v_pk_mul_f32 v[36:37], v[36:37], v[28:29]
    v_pk_mul_f32 v[38:39], v[38:39], v[30:31]
    v_bfi_b32 v32, s54, 0, v32
    v_med3_f32 v13, v12, v13, v32
    v_max_f32 v12, v12, v32
    v_bfi_b32 v33, s54, 1, v33
    v_med3_f32 v13, v12, v13, v33
    v_max_f32 v12, v12, v33
    v_bfi_b32 v34, s54, 2, v34
    v_med3_f32 v13, v12, v13, v34
    v_max_f32 v12, v12, v34
    v_bfi_b32 v35, s54, 3, v35
    v_med3_f32 v13, v12, v13, v35
    v_max_f32 v12, v12, v35
    v_bfi_b32 v36, s54, 4, v36
    v_med3_f32 v13, v12, v13, v36
    v_max_f32 v12, v12, v36
    v_bfi_b32 v37, s54, 5, v37
    v_med3_f32 v13, v12, v13, v37
    v_max_f32 v12, v12, v37
    v_bfi_b32 v38, s54, 6, v38
    v_med3_f32 v13, v12, v13, v38
    v_max_f32 v12, v12, v38
    v_bfi_b32 v39, s54, 7, v39
    v_med3_f32 v13, v12, v13, v39
    v_max_f32 v12, v12, v39
    v_lshl_or_b32 v12, v2, 3, v12
    v_lshl_or_b32 v13, v2, 3, v13
    s_nop 1
    v_mov_b32_dpp v14, v12 quad_perm:[1,0,3,2] row_mask:0xf bank_mask:0xf
    v_mov_b32_dpp v15, v13 quad_perm:[1,0,3,2] row_mask:0xf bank_mask:0xf
    v_max_f32 v15, v15, v13
    v_med3_f32 v13, v12, v14, v15
    v_max_f32 v12, v12, v14
    s_nop 1
    v_mov_b32_dpp v14, v12 quad_perm:[2,3,0,1] row_mask:0xf bank_mask:0xf
    v_mov_b32_dpp v15, v13 quad_perm:[2,3,0,1] row_mask:0xf bank_mask:0xf
    v_max_f32 v15, v15, v13
    v_med3_f32 v13, v12, v14, v15
    v_max_f32 v12, v12, v14
    s_nop 1
    v_mov_b32_dpp v14, v12 row_half_mirror row_mask:0xf bank_mask:0xf
    v_mov_b32_dpp v15, v13 row_half_mirror row_mask:0xf bank_mask:0xf
    v_max_f32 v15, v15, v13
    v_med3_f32 v13, v12, v14, v15
    v_max_f32 v12, v12, v14
    s_nop 1
    v_mov_b32_dpp v14, v12 row_mirror row_mask:0xf bank_mask:0xf
    v_mov_b32_dpp v15, v13 row_mirror row_mask:0xf bank_mask:0xf
    v_max_f32 v15, v15, v13
    v_med3_f32 v13, v12, v14, v15
    v_max_f32 v12, v12, v14
    v_mov_b32 v14, v12
    v_mov_b32 v15, v13
    s_nop 1
    v_permlane16_swap_b32 v12, v14
    v_permlane16_swap_b32 v13, v15
    s_nop 1
    v_max_f32 v15, v15, v13
    v_med3_f32 v13, v12, v14, v15
    v_max_f32 v12, v12, v14
    v_mov_b32 v14, v12
    v_mov_b32 v15, v13
    s_nop 1
    v_permlane32_swap_b32 v12, v14
    v_permlane32_swap_b32 v13, v15
    s_nop 1
    v_max_f32 v15, v15, v13
    v_med3_f32 v13, v12, v14, v15
    v_max_f32 v12, v12, v14
    s_lshl_b32 s31, s30, 3
    s_add_u32 s31, s31, 8192
    v_mov_b32 v14, s31
    ds_write_b64 v14, v[12:13]
    v_mov_b32 v14, 8192
    s_waitcnt lgkmcnt(0)
    s_barrier
    ds_read_b128 v[16:19], v14
    ds_read_b128 v[20:23], v14 offset:16
    v_cmp_eq_u32 vcc, 0, v5
    s_waitcnt lgkmcnt(0)
    v_max_f32 v19, v19, v17
    v_med3_f32 v17, v16, v18, v19
    v_max_f32 v16, v16, v18
    v_max_f32 v23, v23, v21
    v_med3_f32 v21, v20, v22, v23
    v_max_f32 v20, v20, v22
    v_max_f32 v21, v21, v17
    v_med3_f32 v17, v16, v20, v21
    v_max_f32 v16, v16, v20
    v_and_b32 v16, 0x7ff, v16
    v_and_b32 v17, 0x7ff, v17
    v_cndmask_b32 v15, v17, v16, vcc
    v_lshl_add_u32 v12, v15, 11, v7
    buffer_load_dwordx4 v[40:43], v12, s[24:27], 0 offen offset:0 sc1
    buffer_load_dwordx4 v[44:47], v12, s[24:27], 0 offen offset:512 sc1
    buffer_load_dwordx4 v[48:51], v12, s[24:27], 0 offen offset:1024 sc1
    buffer_load_dwordx4 v[52:55], v12, s[24:27], 0 offen offset:1536 sc1
    buffer_load_dwordx4 v[128:131], v0, s[24:27], 0 offen offset:0 sc1
    buffer_load_dwordx4 v[132:135], v0, s[24:27], 0 offen offset:512 sc1
    buffer_load_dwordx4 v[136:139], v0, s[24:27], 0 offen offset:1024 sc1
    buffer_load_dwordx4 v[140:143], v0, s[24:27], 0 offen offset:1536 sc1
    v_cmp_eq_u32 vcc, v16, v11
    v_cmp_eq_u32 s[52:53], v17, v11
    v_mov_b32 v13, 0x7fffffff
    s_or_b64 vcc, vcc, s[52:53]
    v_cndmask_b32 v0, v0, v13, vcc
    v_lshl_add_u32 v12, v5, 11, v7
    v_add_u32 v12, 4096, v12
    s_mov_b32 s58, 0
    s_waitcnt vmcnt(8)
    v_lshlrev_b32 v14, 3, v3
    s_lshl_b32 s54, s30, 13
    s_add_u32 s54, s54, 65536
    v_add_u32 v14, s54, v14
    ds_read_b64_tr_b16 a[0:1], v14 offset:0
    ds_read_b64_tr_b16 a[2:3], v14 offset:512
    ds_read_b64_tr_b16 a[4:5], v14 offset:1024
    ds_read_b64_tr_b16 a[6:7], v14 offset:1536
    ds_read_b64_tr_b16 a[8:9], v14 offset:2048
    ds_read_b64_tr_b16 a[10:11], v14 offset:2560
    ds_read_b64_tr_b16 a[12:13], v14 offset:3072
    ds_read_b64_tr_b16 a[14:15], v14 offset:3584
    ds_read_b64_tr_b16 a[16:17], v14 offset:4096
    ds_read_b64_tr_b16 a[18:19], v14 offset:4608
    ds_read_b64_tr_b16 a[20:21], v14 offset:5120
    ds_read_b64_tr_b16 a[22:23], v14 offset:5632
    ds_read_b64_tr_b16 a[24:25], v14 offset:6144
    ds_read_b64_tr_b16 a[26:27], v14 offset:6656
    ds_read_b64_tr_b16 a[28:29], v14 offset:7168
    ds_read_b64_tr_b16 a[30:31], v14 offset:7680
    ds_read_b64_tr_b16 a[32:33], v14 offset:32768
    ds_read_b64_tr_b16 a[34:35], v14 offset:33280
    ds_read_b64_tr_b16 a[36:37], v14 offset:33792
    ds_read_b64_tr_b16 a[38:39], v14 offset:34304
    ds_read_b64_tr_b16 a[40:41], v14 offset:34816
    ds_read_b64_tr_b16 a[42:43], v14 offset:35328
    ds_read_b64_tr_b16 a[44:45], v14 offset:35840
    ds_read_b64_tr_b16 a[46:47], v14 offset:36352
    ds_read_b64_tr_b16 a[48:49], v14 offset:36864
    ds_read_b64_tr_b16 a[50:51], v14 offset:37376
    ds_read_b64_tr_b16 a[52:53], v14 offset:37888
    ds_read_b64_tr_b16 a[54:55], v14 offset:38400
    ds_read_b64_tr_b16 a[56:57], v14 offset:38912
    ds_read_b64_tr_b16 a[58:59], v14 offset:39424
    ds_read_b64_tr_b16 a[60:61], v14 offset:39936
    ds_read_b64_tr_b16 a[62:63], v14 offset:40448
    s_waitcnt vmcnt(4)
ff_ln_151:
    v_lshlrev_b32 v216, 16, v40
    v_and_b32 v217, 0xffff0000, v40
    v_lshlrev_b32 v218, 16, v41
    v_and_b32 v219, 0xffff0000, v41
    v_lshlrev_b32 v220, 16, v42
    v_and_b32 v221, 0xffff0000, v42
    v_lshlrev_b32 v222, 16, v43
    v_and_b32 v223, 0xffff0000, v43
    v_lshlrev_b32 v224, 16, v44
    v_and_b32 v225, 0xffff0000, v44
    v_lshlrev_b32 v226, 16, v45
    v_and_b32 v227, 0xffff0000, v45
    v_lshlrev_b32 v228, 16, v46
    v_and_b32 v229, 0xffff0000, v46
    v_lshlrev_b32 v230, 16, v47
    v_and_b32 v231, 0xffff0000, v47
    v_lshlrev_b32 v232, 16, v48
    v_and_b32 v233, 0xffff0000, v48
    v_lshlrev_b32 v234, 16, v49
    v_and_b32 v235, 0xffff0000, v49
    v_lshlrev_b32 v236, 16, v50
    v_and_b32 v237, 0xffff0000, v50
    v_lshlrev_b32 v238, 16, v51
    v_and_b32 v239, 0xffff0000, v51
    v_lshlrev_b32 v240, 16, v52
    v_and_b32 v241, 0xffff0000, v52
    v_lshlrev_b32 v242, 16, v53
    v_and_b32 v243, 0xffff0000, v53
    v_lshlrev_b32 v244, 16, v54
    v_and_b32 v245, 0xffff0000, v54
    v_lshlrev_b32 v246, 16, v55
    v_and_b32 v247, 0xffff0000, v55
    v_pk_add_f32 v[208:209], v[216:217], v[218:219]
    v_pk_add_f32 v[210:211], v[220:221], v[222:223]
    v_pk_add_f32 v[208:209], v[208:209], v[224:225]
    v_pk_add_f32 v[210:211], v[210:211], v[226:227]
    v_pk_add_f32 v[208:209], v[208:209], v[228:229]
    v_pk_add_f32 v[210:211], v[210:211], v[230:231]
    v_pk_add_f32 v[208:209], v[208:209], v[232:233]
    v_pk_add_f32 v[210:211], v[210:211], v[234:235]
    v_pk_add_f32 v[208:209], v[208:209], v[236:237]
    v_pk_add_f32 v[210:211], v[210:211], v[238:239]
    v_pk_add_f32 v[208:209], v[208:209], v[240:241]
    v_pk_add_f32 v[210:211], v[210:211], v[242:243]
    v_pk_add_f32 v[208:209], v[208:209], v[244:245]
    v_pk_add_f32 v[210:211], v[210:211], v[246:247]
    v_pk_add_f32 v[208:209], v[208:209], v[210:211]
    v_add_f32 v208, v208, v209
    s_nop 1
    v_add_f32_dpp v208, v208, v208 quad_perm:[1,0,3,2] row_mask:0xf bank_mask:0xf
    s_nop 1
    v_add_f32_dpp v208, v208, v208 quad_perm:[2,3,0,1] row_mask:0xf bank_mask:0xf
    s_nop 1
    v_add_f32_dpp v208, v208, v208 row_half_mirror row_mask:0xf bank_mask:0xf
    s_nop 1
    v_add_f32_dpp v208, v208, v208 row_mirror row_mask:0xf bank_mask:0xf
    v_mov_b32 v210, v208
    s_nop 1
    v_permlane16_swap_b32 v208, v210
    s_nop 1
    v_add_f32 v208, v208, v210
    v_mul_f32 v208, 0xba800000, v208
    v_mov_b32 v209, v208
    v_pk_add_f32 v[210:211], v[216:217], v[208:209]
    v_pk_add_f32 v[214:215], v[218:219], v[208:209]
    v_pk_mul_f32 v[212:213], v[210:211], v[210:211]
    v_pk_fma_f32 v[212:213], v[214:215], v[214:215], v[212:213]
    v_pk_add_f32 v[210:211], v[220:221], v[208:209]
    v_pk_add_f32 v[214:215], v[222:223], v[208:209]
    v_pk_fma_f32 v[212:213], v[210:211], v[210:211], v[212:213]
    v_pk_fma_f32 v[212:213], v[214:215], v[214:215], v[212:213]
    v_pk_add_f32 v[210:211], v[224:225], v[208:209]
    v_pk_add_f32 v[214:215], v[226:227], v[208:209]
    v_pk_fma_f32 v[212:213], v[210:211], v[210:211], v[212:213]
    v_pk_fma_f32 v[212:213], v[214:215], v[214:215], v[212:213]
    v_pk_add_f32 v[210:211], v[228:229], v[208:209]
    v_pk_add_f32 v[214:215], v[230:231], v[208:209]
    v_pk_fma_f32 v[212:213], v[210:211], v[210:211], v[212:213]
    v_pk_fma_f32 v[212:213], v[214:215], v[214:215], v[212:213]
    v_pk_add_f32 v[210:211], v[232:233], v[208:209]
    v_pk_add_f32 v[214:215], v[234:235], v[208:209]
    v_pk_fma_f32 v[212:213], v[210:211], v[210:211], v[212:213]
    v_pk_fma_f32 v[212:213], v[214:215], v[214:215], v[212:213]
    v_pk_add_f32 v[210:211], v[236:237], v[208:209]
    v_pk_add_f32 v[214:215], v[238:239], v[208:209]
    v_pk_fma_f32 v[212:213], v[210:211], v[210:211], v[212:213]
    v_pk_fma_f32 v[212:213], v[214:215], v[214:215], v[212:213]
    v_pk_add_f32 v[210:211], v[240:241], v[208:209]
    v_pk_add_f32 v[214:215], v[242:243], v[208:209]
    v_pk_fma_f32 v[212:213], v[210:211], v[210:211], v[212:213]
    v_pk_fma_f32 v[212:213], v[214:215], v[214:215], v[212:213]
    v_pk_add_f32 v[210:211], v[244:245], v[208:209]
    v_pk_add_f32 v[214:215], v[246:247], v[208:209]
    v_pk_fma_f32 v[212:213], v[210:211], v[210:211], v[212:213]
    v_pk_fma_f32 v[212:213], v[214:215], v[214:215], v[212:213]
    v_add_f32 v212, v212, v213
    s_nop 1
    v_add_f32_dpp v212, v212, v212 quad_perm:[1,0,3,2] row_mask:0xf bank_mask:0xf
    s_nop 1
    v_add_f32_dpp v212, v212, v212 quad_perm:[2,3,0,1] row_mask:0xf bank_mask:0xf
    s_nop 1
    v_add_f32_dpp v212, v212, v212 row_half_mirror row_mask:0xf bank_mask:0xf
    s_nop 1
    v_add_f32_dpp v212, v212, v212 row_mirror row_mask:0xf bank_mask:0xf
    v_mov_b32 v210, v212
    s_nop 1
    v_permlane16_swap_b32 v212, v210
    s_nop 1
    v_add_f32 v212, v212, v210
    v_mul_f32 v212, 0x3a800000, v212
    v_cvt_pk_bf16_f32 v214, v208, v212
    v_and_b32 v212, 0xffff0000, v214
    v_lshlrev_b32 v214, 16, v214
    v_add_f32 v212, 0x3727c5ac, v212
    v_mov_b32 v215, v214
    v_cvt_pk_bf16_f32 v212, v212, v212
    v_and_b32 v212, 0xffff0000, v212
    v_sqrt_f32 v212, v212
    v_pk_add_f32 v[176:177], v[216:217], v[214:215]
    v_pk_add_f32 v[178:179], v[218:219], v[214:215]
    v_pk_add_f32 v[180:181], v[220:221], v[214:215]
    v_pk_add_f32 v[182:183], v[222:223], v[214:215]
    v_pk_add_f32 v[184:185], v[224:225], v[214:215]
    v_pk_add_f32 v[186:187], v[226:227], v[214:215]
    v_pk_add_f32 v[188:189], v[228:229], v[214:215]
    v_pk_add_f32 v[190:191], v[230:231], v[214:215]
    v_pk_add_f32 v[192:193], v[232:233], v[214:215]
    v_pk_add_f32 v[194:195], v[234:235], v[214:215]
    v_pk_add_f32 v[196:197], v[236:237], v[214:215]
    v_pk_add_f32 v[198:199], v[238:239], v[214:215]
    v_pk_add_f32 v[200:201], v[240:241], v[214:215]
    v_pk_add_f32 v[202:203], v[242:243], v[214:215]
    v_pk_add_f32 v[204:205], v[244:245], v[214:215]
    v_pk_add_f32 v[206:207], v[246:247], v[214:215]
    v_cvt_pk_bf16_f32 v212, v212, v212
    v_and_b32 v212, 0xffff0000, v212
    v_rcp_f32 v212, v212
    v_cvt_pk_bf16_f32 v40, v176, v177
    v_cvt_pk_bf16_f32 v41, v178, v179
    v_cvt_pk_bf16_f32 v42, v180, v181
    v_cvt_pk_bf16_f32 v43, v182, v183
    v_cvt_pk_bf16_f32 v44, v184, v185
    v_cvt_pk_bf16_f32 v45, v186, v187
    v_cvt_pk_bf16_f32 v46, v188, v189
    v_cvt_pk_bf16_f32 v47, v190, v191
    v_cvt_pk_bf16_f32 v48, v192, v193
    v_cvt_pk_bf16_f32 v49, v194, v195
    v_cvt_pk_bf16_f32 v50, v196, v197
    v_cvt_pk_bf16_f32 v51, v198, v199
    v_cvt_pk_bf16_f32 v52, v200, v201
    v_cvt_pk_bf16_f32 v53, v202, v203
    v_cvt_pk_bf16_f32 v54, v204, v205
    v_cvt_pk_bf16_f32 v55, v206, v207
    v_mov_b32 v213, v212
    v_lshlrev_b32 v176, 16, v40
    v_and_b32 v177, 0xffff0000, v40
    v_lshlrev_b32 v178, 16, v41
    v_and_b32 v179, 0xffff0000, v41
    v_lshlrev_b32 v180, 16, v42
    v_and_b32 v181, 0xffff0000, v42
    v_lshlrev_b32 v182, 16, v43
    v_and_b32 v183, 0xffff0000, v43
    v_lshlrev_b32 v184, 16, v44
    v_and_b32 v185, 0xffff0000, v44
    v_lshlrev_b32 v186, 16, v45
    v_and_b32 v187, 0xffff0000, v45
    v_lshlrev_b32 v188, 16, v46
    v_and_b32 v189, 0xffff0000, v46
    v_lshlrev_b32 v190, 16, v47
    v_and_b32 v191, 0xffff0000, v47
    v_lshlrev_b32 v192, 16, v48
    v_and_b32 v193, 0xffff0000, v48
    v_lshlrev_b32 v194, 16, v49
    v_and_b32 v195, 0xffff0000, v49
    v_lshlrev_b32 v196, 16, v50
    v_and_b32 v197, 0xffff0000, v50
    v_lshlrev_b32 v198, 16, v51
    v_and_b32 v199, 0xffff0000, v51
    v_lshlrev_b32 v200, 16, v52
    v_and_b32 v201, 0xffff0000, v52
    v_lshlrev_b32 v202, 16, v53
    v_and_b32 v203, 0xffff0000, v53
    v_lshlrev_b32 v204, 16, v54
    v_and_b32 v205, 0xffff0000, v54
    v_lshlrev_b32 v206, 16, v55
    v_and_b32 v207, 0xffff0000, v55
    v_pk_mul_f32 v[176:177], v[176:177], v[212:213]
    v_pk_mul_f32 v[178:179], v[178:179], v[212:213]
    v_pk_mul_f32 v[180:181], v[180:181], v[212:213]
    v_pk_mul_f32 v[182:183], v[182:183], v[212:213]
    v_pk_mul_f32 v[184:185], v[184:185], v[212:213]
    v_pk_mul_f32 v[186:187], v[186:187], v[212:213]
    v_pk_mul_f32 v[188:189], v[188:189], v[212:213]
    v_pk_mul_f32 v[190:191], v[190:191], v[212:213]
    v_pk_mul_f32 v[192:193], v[192:193], v[212:213]
    v_pk_mul_f32 v[194:195], v[194:195], v[212:213]
    v_pk_mul_f32 v[196:197], v[196:197], v[212:213]
    v_pk_mul_f32 v[198:199], v[198:199], v[212:213]
    v_pk_mul_f32 v[200:201], v[200:201], v[212:213]
    v_pk_mul_f32 v[202:203], v[202:203], v[212:213]
    v_pk_mul_f32 v[204:205], v[204:205], v[212:213]
    v_pk_mul_f32 v[206:207], v[206:207], v[212:213]
    v_cvt_pk_bf16_f32 v40, v176, v177
    v_cvt_pk_bf16_f32 v41, v178, v179
    v_cvt_pk_bf16_f32 v42, v180, v181
    v_cvt_pk_bf16_f32 v43, v182, v183
    v_cvt_pk_bf16_f32 v44, v184, v185
    v_cvt_pk_bf16_f32 v45, v186, v187
    v_cvt_pk_bf16_f32 v46, v188, v189
    v_cvt_pk_bf16_f32 v47, v190, v191
    v_cvt_pk_bf16_f32 v48, v192, v193
    v_cvt_pk_bf16_f32 v49, v194, v195
    v_cvt_pk_bf16_f32 v50, v196, v197
    v_cvt_pk_bf16_f32 v51, v198, v199
    v_cvt_pk_bf16_f32 v52, v200, v201
    v_cvt_pk_bf16_f32 v53, v202, v203
    v_cvt_pk_bf16_f32 v54, v204, v205
    v_cvt_pk_bf16_f32 v55, v206, v207
    s_cmp_lg_u32 s58, 0
    s_cbranch_scc1 ff_own_152
    ds_write_b128 v12, v[40:43] offset:0
    ds_write_b128 v12, v[44:47] offset:512
    ds_write_b128 v12, v[48:51] offset:1024
    ds_write_b128 v12, v[52:55] offset:1536
    s_cmp_ge_u32 s2, 224
    s_cbranch_scc1 ff_red_153
    v_lshrrev_b32 v12, 4, v3
    v_and_b32 v13, 1, v3
    v_lshlrev_b32 v13, 11, v13
    v_lshl_add_u32 v13, v12, 3, v13
    s_lshl_b32 s54, s30, 9
    s_add_u32 s54, s54, 4096
    v_add_u32 v13, s54, v13
    ds_read_b64 a[64:65], v13 offset:0
    ds_read_b64 a[66:67], v13 offset:32
    ds_read_b64 a[68:69], v13 offset:64
    ds_read_b64 a[70:71], v13 offset:96
    ds_read_b64 a[72:73], v13 offset:128
    ds_read_b64 a[74:75], v13 offset:160
    ds_read_b64 a[76:77], v13 offset:192
    ds_read_b64 a[78:79], v13 offset:224
    ds_read_b64 a[80:81], v13 offset:256
    ds_read_b64 a[82:83], v13 offset:288
    ds_read_b64 a[84:85], v13 offset:320
    ds_read_b64 a[86:87], v13 offset:352
    ds_read_b64 a[88:89], v13 offset:384
    ds_read_b64 a[90:91], v13 offset:416
    ds_read_b64 a[92:93], v13 offset:448
    ds_read_b64 a[94:95], v13 offset:480
    v_lshlrev_b32 v13, 6, v8
    v_lshl_add_u32 v13, v12, 4, v13
    s_lshl_b32 s54, s30, 11
    s_add_u32 s54, s54, 8448
    v_add_u32 v13, s54, v13
    s_waitcnt lgkmcnt(0)
    v_mfma_f32_16x16x32_bf16 v[16:19], a[0:3], a[64:67], 0
    v_mfma_f32_16x16x32_bf16 v[20:23], a[32:35], a[64:67], 0
    v_mfma_f32_16x16x32_bf16 v[16:19], a[4:7], a[68:71], v[16:19]
    v_mfma_f32_16x16x32_bf16 v[20:23], a[36:39], a[68:71], v[20:23]
    v_mfma_f32_16x16x32_bf16 v[16:19], a[8:11], a[72:75], v[16:19]
    v_mfma_f32_16x16x32_bf16 v[20:23], a[40:43], a[72:75], v[20:23]
    v_mfma_f32_16x16x32_bf16 v[16:19], a[12:15], a[76:79], v[16:19]
    v_mfma_f32_16x16x32_bf16 v[20:23], a[44:47], a[76:79], v[20:23]
    v_mfma_f32_16x16x32_bf16 v[16:19], a[16:19], a[80:83], v[16:19]
    v_mfma_f32_16x16x32_bf16 v[20:23], a[48:51], a[80:83], v[20:23]
    v_mfma_f32_16x16x32_bf16 v[16:19], a[20:23], a[84:87], v[16:19]
    v_mfma_f32_16x16x32_bf16 v[20:23], a[52:55], a[84:87], v[20:23]
    v_mfma_f32_16x16x32_bf16 v[16:19], a[24:27], a[88:91], v[16:19]
    v_mfma_f32_16x16x32_bf16 v[20:23], a[56:59], a[88:91], v[20:23]
    v_mfma_f32_16x16x32_bf16 v[16:19], a[28:31], a[92:95], v[16:19]
    v_mfma_f32_16x16x32_bf16 v[20:23], a[60:63], a[92:95], v[20:23]
    s_nop 7
    ds_write_b128 v13, v[16:19]
    ds_write_b128 v13, v[20:23] offset:1024
    v_lshlrev_b32 v13, 2, v4
    v_add_u32 v13, 8448, v13
    s_waitcnt lgkmcnt(0)
    s_barrier
    ds_read2st64_b32 v[16:17], v13 offset0:0 offset1:4
    ds_read2st64_b32 v[18:19], v13 offset0:8 offset1:12
    ds_read2st64_b32 v[20:21], v13 offset0:16 offset1:20
    ds_read2st64_b32 v[22:23], v13 offset0:24 offset1:28
    s_waitcnt lgkmcnt(0)
    v_pk_add_f32 v[16:17], v[16:17], v[20:21]
    v_pk_add_f32 v[18:19], v[18:19], v[22:23]
    v_pk_add_f32 v[16:17], v[16:17], v[18:19]
    v_cvt_pk_bf16_f32 v16, v16, v17
    v_and_b32 v20, 0xffff0000, v16
    v_lshlrev_b32 v16, 16, v16
    v_mul_f32 v17, 0xbfb8aa3b, v16
    v_exp_f32 v17, v17
    s_lshl_b32 s54, s55, 12
    v_add_f32 v17, 1.0, v17
    v_rcp_f32 v17, v17
    s_add_u32 s53, s54, 4096
    v_mul_f32 v16, v16, v17
    v_cvt_pk_bf16_f32 v16, v16, v16
    v_and_b32 v16, 0xffff0000, v16
    v_mul_f32 v16, v16, v20
    s_nop 1
    v_mov_b32_dpp v17, v16 quad_perm:[1,0,3,2] row_mask:0xf bank_mask:0xf
    v_cvt_pk_bf16_f32 v16, v16, v17
    v_lshlrev_b32 v13, 4, v2
    v_readlane_b32 s8, v16, 0
    v_readlane_b32 s9, v16, 2
    v_readlane_b32 s10, v16, 4
    v_readlane_b32 s11, v16, 6
    v_readlane_b32 s12, v16, 8
    v_readlane_b32 s13, v16, 10
    v_readlane_b32 s14, v16, 12
    v_readlane_b32 s15, v16, 14
    v_readlane_b32 s16, v16, 16
    v_readlane_b32 s17, v16, 18
    v_readlane_b32 s18, v16, 20
    v_readlane_b32 s19, v16, 22
    v_readlane_b32 s20, v16, 24
    v_readlane_b32 s21, v16, 26
    v_readlane_b32 s22, v16, 28
    v_readlane_b32 s23, v16, 30
    v_dot2_f32_bf16 v24, v144, s8, 0
    v_dot2_f32_bf16 v25, v145, s8, 0
    v_dot2_f32_bf16 v26, v146, s8, 0
    v_dot2_f32_bf16 v27, v147, s8, 0
    v_dot2_f32_bf16 v24, v148, s9, v24
    v_dot2_f32_bf16 v25, v149, s9, v25
    v_dot2_f32_bf16 v26, v150, s9, v26
    v_dot2_f32_bf16 v27, v151, s9, v27
    v_dot2_f32_bf16 v24, v152, s10, v24
    v_dot2_f32_bf16 v25, v153, s10, v25
    v_dot2_f32_bf16 v26, v154, s10, v26
    v_dot2_f32_bf16 v27, v155, s10, v27
    v_dot2_f32_bf16 v24, v156, s11, v24
    v_dot2_f32_bf16 v25, v157, s11, v25
    v_dot2_f32_bf16 v26, v158, s11, v26
    v_dot2_f32_bf16 v27, v159, s11, v27
    v_dot2_f32_bf16 v24, v160, s12, v24
    v_dot2_f32_bf16 v25, v161, s12, v25
    v_dot2_f32_bf16 v26, v162, s12, v26
    v_dot2_f32_bf16 v27, v163, s12, v27
    v_dot2_f32_bf16 v24, v164, s13, v24
    v_dot2_f32_bf16 v25, v165, s13, v25
    v_dot2_f32_bf16 v26, v166, s13, v26
    v_dot2_f32_bf16 v27, v167, s13, v27
    v_dot2_f32_bf16 v24, v168, s14, v24
    v_dot2_f32_bf16 v25, v169, s14, v25
    v_dot2_f32_bf16 v26, v170, s14, v26
    v_dot2_f32_bf16 v27, v171, s14, v27
    v_dot2_f32_bf16 v24, v172, s15, v24
    v_dot2_f32_bf16 v25, v173, s15, v25
    v_dot2_f32_bf16 v26, v174, s15, v26
    v_dot2_f32_bf16 v27, v175, s15, v27
    v_dot2_f32_bf16 v28, v144, s16, 0
    v_dot2_f32_bf16 v29, v145, s16, 0
    v_dot2_f32_bf16 v30, v146, s16, 0
    v_dot2_f32_bf16 v31, v147, s16, 0
    v_dot2_f32_bf16 v28, v148, s17, v28
    v_dot2_f32_bf16 v29, v149, s17, v29
    v_dot2_f32_bf16 v30, v150, s17, v30
    v_dot2_f32_bf16 v31, v151, s17, v31
    v_dot2_f32_bf16 v28, v152, s18, v28
    v_dot2_f32_bf16 v29, v153, s18, v29
    v_dot2_f32_bf16 v30, v154, s18, v30
    v_dot2_f32_bf16 v31, v155, s18, v31
    v_dot2_f32_bf16 v28, v156, s19, v28
    v_dot2_f32_bf16 v29, v157, s19, v29
    v_dot2_f32_bf16 v30, v158, s19, v30
    v_dot2_f32_bf16 v31, v159, s19, v31
    v_dot2_f32_bf16 v28, v160, s20, v28
    v_dot2_f32_bf16 v29, v161, s20, v29
    v_dot2_f32_bf16 v30, v162, s20, v30
    v_dot2_f32_bf16 v31, v163, s20, v31
    v_dot2_f32_bf16 v28, v164, s21, v28
    v_dot2_f32_bf16 v29, v165, s21, v29
    v_dot2_f32_bf16 v30, v166, s21, v30
    v_dot2_f32_bf16 v31, v167, s21, v31
    v_dot2_f32_bf16 v28, v168, s22, v28
    v_dot2_f32_bf16 v29, v169, s22, v29
    v_dot2_f32_bf16 v30, v170, s22, v30
    v_dot2_f32_bf16 v31, v171, s22, v31
    v_dot2_f32_bf16 v28, v172, s23, v28
    v_dot2_f32_bf16 v29, v173, s23, v29
    v_dot2_f32_bf16 v30, v174, s23, v30
    v_dot2_f32_bf16 v31, v175, s23, v31
    s_nop 2
    v_cvt_pk_bf16_f32 v24, v24, v25
    v_cvt_pk_bf16_f32 v25, v26, v27
    v_cvt_pk_bf16_f32 v26, v28, v29
    v_cvt_pk_bf16_f32 v27, v30, v31
    v_min_u32 v24, -2, v24
    v_min_u32 v25, -2, v25
    v_min_u32 v26, -2, v26
    v_min_u32 v27, -2, v27
    buffer_store_dwordx4 v[24:27], v13, s[48:51], s54 offen sc1
    s_waitcnt vmcnt(1)
    v_mov_b32 v40, v128
    v_mov_b32 v41, v129
    v_mov_b32 v42, v130
    v_mov_b32 v43, v131
    v_mov_b32 v44, v132
    v_mov_b32 v45, v133
    v_mov_b32 v46, v134
    v_mov_b32 v47, v135
    v_mov_b32 v48, v136
    v_mov_b32 v49, v137
    v_mov_b32 v50, v138
    v_mov_b32 v51, v139
    v_mov_b32 v52, v140
    v_mov_b32 v53, v141
    v_mov_b32 v54, v142
    v_mov_b32 v55, v143
    s_mov_b32 s58, 1
    s_branch ff_ln_151
ff_own_152:
    v_lshlrev_b32 v176, 16, v40
    v_and_b32 v177, 0xffff0000, v40
    v_lshlrev_b32 v178, 16, v41
    v_and_b32 v179, 0xffff0000, v41
    v_lshlrev_b32 v180, 16, v42
    v_and_b32 v181, 0xffff0000, v42
    v_lshlrev_b32 v182, 16, v43
    v_and_b32 v183, 0xffff0000, v43
    v_lshlrev_b32 v184, 16, v44
    v_and_b32 v185, 0xffff0000, v44
    v_lshlrev_b32 v186, 16, v45
    v_and_b32 v187, 0xffff0000, v45
    v_lshlrev_b32 v188, 16, v46
    v_and_b32 v189, 0xffff0000, v46
    v_lshlrev_b32 v190, 16, v47
    v_and_b32 v191, 0xffff0000, v47
    v_lshlrev_b32 v192, 16, v48
    v_and_b32 v193, 0xffff0000, v48
    v_lshlrev_b32 v194, 16, v49
    v_and_b32 v195, 0xffff0000, v49
    v_lshlrev_b32 v196, 16, v50
    v_and_b32 v197, 0xffff0000, v50
    v_lshlrev_b32 v198, 16, v51
    v_and_b32 v199, 0xffff0000, v51
    v_lshlrev_b32 v200, 16, v52
    v_and_b32 v201, 0xffff0000, v52
    v_lshlrev_b32 v202, 16, v53
    v_and_b32 v203, 0xffff0000, v53
    v_lshlrev_b32 v204, 16, v54
    v_and_b32 v205, 0xffff0000, v54
    v_lshlrev_b32 v206, 16, v55
    v_and_b32 v207, 0xffff0000, v55
    v_pk_add_f32 v[176:177], v[176:177], v[216:217]
    v_pk_add_f32 v[178:179], v[178:179], v[218:219]
    v_pk_add_f32 v[180:181], v[180:181], v[220:221]
    v_pk_add_f32 v[182:183], v[182:183], v[222:223]
    v_pk_add_f32 v[184:185], v[184:185], v[224:225]
    v_pk_add_f32 v[186:187], v[186:187], v[226:227]
    v_pk_add_f32 v[188:189], v[188:189], v[228:229]
    v_pk_add_f32 v[190:191], v[190:191], v[230:231]
    v_pk_add_f32 v[192:193], v[192:193], v[232:233]
    v_pk_add_f32 v[194:195], v[194:195], v[234:235]
    v_pk_add_f32 v[196:197], v[196:197], v[236:237]
    v_pk_add_f32 v[198:199], v[198:199], v[238:239]
    v_pk_add_f32 v[200:201], v[200:201], v[240:241]
    v_pk_add_f32 v[202:203], v[202:203], v[242:243]
    v_pk_add_f32 v[204:205], v[204:205], v[244:245]
    v_pk_add_f32 v[206:207], v[206:207], v[246:247]
    v_cvt_pk_bf16_f32 v40, v176, v177
    v_cvt_pk_bf16_f32 v41, v178, v179
    v_cvt_pk_bf16_f32 v42, v180, v181
    v_cvt_pk_bf16_f32 v43, v182, v183
    v_cvt_pk_bf16_f32 v44, v184, v185
    v_cvt_pk_bf16_f32 v45, v186, v187
    v_cvt_pk_bf16_f32 v46, v188, v189
    v_cvt_pk_bf16_f32 v47, v190, v191
    v_cvt_pk_bf16_f32 v48, v192, v193
    v_cvt_pk_bf16_f32 v49, v194, v195
    v_cvt_pk_bf16_f32 v50, v196, v197
    v_cvt_pk_bf16_f32 v51, v198, v199
    v_cvt_pk_bf16_f32 v52, v200, v201
    v_cvt_pk_bf16_f32 v53, v202, v203
    v_cvt_pk_bf16_f32 v54, v204, v205
    v_cvt_pk_bf16_f32 v55, v206, v207
    buffer_store_dwordx4 v[40:43], v0, s[36:39], 0 offen offset:0 sc1
    buffer_store_dwordx4 v[44:47], v0, s[36:39], 0 offen offset:512 sc1
    buffer_store_dwordx4 v[48:51], v0, s[36:39], 0 offen offset:1024 sc1
    buffer_store_dwordx4 v[52:55], v0, s[36:39], 0 offen offset:1536 sc1
    s_cmp_ge_u32 s2, 224
    s_cbranch_scc1 ff_red2_154
    s_branch ff_fin_155
ff_red_153:
    s_sub_u32 s40, s2, 224
    s_mov_b32 s8, s56
    s_and_b32 s9, s57, 0xffff
    s_mov_b32 s10, 0x800
    s_mov_b32 s11, 0x00020000
    buffer_load_dwordx4 v[96:99], v7, s[8:11], 0 offen offset:0
    buffer_load_dwordx4 v[100:103], v7, s[8:11], 0 offen offset:512
    buffer_load_dwordx4 v[104:107], v7, s[8:11], 0 offen offset:1024
    buffer_load_dwordx4 v[108:111], v7, s[8:11], 0 offen offset:1536
    v_and_b32 v8, 7, v3
    s_lshl_b32 s47, s40, 6
    v_lshl_add_u32 v9, v8, 3, s47
    v_lshl_add_u32 v12, v5, 11, v9
    v_add_u32 v12, 4096, v12
    v_lshl_add_u32 v9, v15, 11, v9
    s_waitcnt lgkmcnt(0)
    ds_read_b64 v[32:33], v12
    buffer_load_dwordx2 v[34:35], v9, s[24:27], 0 offen sc1
    v_lshrrev_b32 v10, 3, v2
    v_lshlrev_b32 v10, 12, v10
    v_lshl_add_u32 v10, v8, 4, v10
    s_lshl_b32 s47, s40, 7
    s_waitcnt vmcnt(1)
    v_dot2_f32_bf16 v36, v40, v96, 0
    v_dot2_f32_bf16 v36, v41, v97, v36
    v_dot2_f32_bf16 v36, v42, v98, v36
    v_dot2_f32_bf16 v36, v43, v99, v36
    v_dot2_f32_bf16 v36, v44, v100, v36
    v_dot2_f32_bf16 v36, v45, v101, v36
    v_dot2_f32_bf16 v36, v46, v102, v36
    v_dot2_f32_bf16 v36, v47, v103, v36
    v_dot2_f32_bf16 v36, v48, v104, v36
    v_dot2_f32_bf16 v36, v49, v105, v36
    v_dot2_f32_bf16 v36, v50, v106, v36
    v_dot2_f32_bf16 v36, v51, v107, v36
    v_dot2_f32_bf16 v36, v52, v108, v36
    v_dot2_f32_bf16 v36, v53, v109, v36
    v_dot2_f32_bf16 v36, v54, v110, v36
    v_dot2_f32_bf16 v36, v55, v111, v36
    s_nop 2
    s_nop 1
    v_add_f32_dpp v36, v36, v36 quad_perm:[1,0,3,2] row_mask:0xf bank_mask:0xf
    s_nop 1
    v_add_f32_dpp v36, v36, v36 quad_perm:[2,3,0,1] row_mask:0xf bank_mask:0xf
    s_nop 1
    v_add_f32_dpp v36, v36, v36 row_half_mirror row_mask:0xf bank_mask:0xf
    s_nop 1
    v_add_f32_dpp v36, v36, v36 row_mirror row_mask:0xf bank_mask:0xf
    v_mov_b32 v13, v36
    s_nop 1
    v_permlane16_swap_b32 v36, v13
    s_nop 1
    v_add_f32 v36, v36, v13
    v_cvt_pk_bf16_f32 v36, v36, v36
    v_and_b32 v36, 0xffff0000, v36
    v_mul_f32 v36, 0xbfb8aa3b, v36
    v_exp_f32 v36, v36
    s_nop 0
    v_add_f32 v36, 1.0, v36
    v_rcp_f32 v36, v36
    s_nop 0
    v_cvt_pk_bf16_f32 v36, v36, v36
    v_and_b32 v36, 0xffff0000, v36
    v_mov_b32 v40, v128
    v_mov_b32 v41, v129
    v_mov_b32 v42, v130
    v_mov_b32 v43, v131
    v_mov_b32 v44, v132
    v_mov_b32 v45, v133
    v_mov_b32 v46, v134
    v_mov_b32 v47, v135
    v_mov_b32 v48, v136
    v_mov_b32 v49, v137
    v_mov_b32 v50, v138
    v_mov_b32 v51, v139
    v_mov_b32 v52, v140
    v_mov_b32 v53, v141
    v_mov_b32 v54, v142
    v_mov_b32 v55, v143
    s_mov_b32 s58, 1
    s_branch ff_ln_151
ff_red2_154:
    s_mov_b32 s52, 1048576
ff_rpoll_157:
    s_mov_b32 s53, s47
    buffer_load_dwordx4 v[96:99], v10, s[48:51], s53 offen sc1
    s_add_u32 s53, s53, 0x20000
    buffer_load_dwordx4 v[100:103], v10, s[48:51], s53 offen sc1
    s_add_u32 s53, s53, 0x20000
    buffer_load_dwordx4 v[104:107], v10, s[48:51], s53 offen sc1
    s_add_u32 s53, s53, 0x20000
    buffer_load_dwordx4 v[108:111], v10, s[48:51], s53 offen sc1
    s_add_u32 s53, s53, 0x20000
    buffer_load_dwordx4 v[112:115], v10, s[48:51], s53 offen sc1
    s_add_u32 s53, s53, 0x20000
    buffer_load_dwordx4 v[116:119], v10, s[48:51], s53 offen sc1
    s_add_u32 s53, s53, 0x20000
    buffer_load_dwordx4 v[120:123], v10, s[48:51], s53 offen sc1
    s_add_u32 s53, s53, 0x20000
    v_mov_b32 v13, 0
    s_waitcnt vmcnt(6)
    v_max3_u32 v13, v13, v96, v97
    v_max3_u32 v13, v13, v98, v99
    s_waitcnt vmcnt(5)
    v_max3_u32 v13, v13, v100, v101
    v_max3_u32 v13, v13, v102, v103
    s_waitcnt vmcnt(4)
    v_max3_u32 v13, v13, v104, v105
    v_max3_u32 v13, v13, v106, v107
    s_waitcnt vmcnt(3)
    v_max3_u32 v13, v13, v108, v109
    v_max3_u32 v13, v13, v110, v111
    s_waitcnt vmcnt(2)
    v_max3_u32 v13, v13, v112, v113
    v_max3_u32 v13, v13, v114, v115
    s_waitcnt vmcnt(1)
    v_max3_u32 v13, v13, v116, v117
    v_max3_u32 v13, v13, v118, v119
    s_waitcnt vmcnt(0)
    v_max3_u32 v13, v13, v120, v121
    v_max3_u32 v13, v13, v122, v123
    s_sub_u32 s52, s52, 1
    s_cbranch_scc1 ff_rgo_156
    v_cmp_eq_u32 vcc, -1, v13
    s_cbranch_vccnz ff_rpoll_157
ff_rgo_156:
    s_mov_b32 s52, 0x00003f80
    s_mov_b32 s53, 0x3f800000
    v_dot2_f32_bf16 v128, v96, s52, 0
    v_dot2_f32_bf16 v129, v96, s53, 0
    v_dot2_f32_bf16 v130, v97, s52, 0
    v_dot2_f32_bf16 v131, v97, s53, 0
    v_dot2_f32_bf16 v132, v98, s52, 0
    v_dot2_f32_bf16 v133, v98, s53, 0
    v_dot2_f32_bf16 v134, v99, s52, 0
    v_dot2_f32_bf16 v135, v99, s53, 0
    v_dot2_f32_bf16 v128, v100, s52, v128
    v_dot2_f32_bf16 v129, v100, s53, v129
    v_dot2_f32_bf16 v130, v101, s52, v130
    v_dot2_f32_bf16 v131, v101, s53, v131
    v_dot2_f32_bf16 v132, v102, s52, v132
    v_dot2_f32_bf16 v133, v102, s53, v133
    v_dot2_f32_bf16 v134, v103, s52, v134
    v_dot2_f32_bf16 v135, v103, s53, v135
    v_dot2_f32_bf16 v128, v104, s52, v128
    v_dot2_f32_bf16 v129, v104, s53, v129
    v_dot2_f32_bf16 v130, v105, s52, v130
    v_dot2_f32_bf16 v131, v105, s53, v131
    v_dot2_f32_bf16 v132, v106, s52, v132
    v_dot2_f32_bf16 v133, v106, s53, v133
    v_dot2_f32_bf16 v134, v107, s52, v134
    v_dot2_f32_bf16 v135, v107, s53, v135
    v_dot2_f32_bf16 v128, v108, s52, v128
    v_dot2_f32_bf16 v129, v108, s53, v129
    v_dot2_f32_bf16 v130, v109, s52, v130
    v_dot2_f32_bf16 v131, v109, s53, v131
    v_dot2_f32_bf16 v132, v110, s52, v132
    v_dot2_f32_bf16 v133, v110, s53, v133
    v_dot2_f32_bf16 v134, v111, s52, v134
    v_dot2_f32_bf16 v135, v111, s53, v135
    v_dot2_f32_bf16 v128, v112, s52, v128
    v_dot2_f32_bf16 v129, v112, s53, v129
    v_dot2_f32_bf16 v130, v113, s52, v130
    v_dot2_f32_bf16 v131, v113, s53, v131
    v_dot2_f32_bf16 v132, v114, s52, v132
    v_dot2_f32_bf16 v133, v114, s53, v133
    v_dot2_f32_bf16 v134, v115, s52, v134
    v_dot2_f32_bf16 v135, v115, s53, v135
    v_dot2_f32_bf16 v128, v116, s52, v128
    v_dot2_f32_bf16 v129, v116, s53, v129
    v_dot2_f32_bf16 v130, v117, s52, v130
    v_dot2_f32_bf16 v131, v117, s53, v131
    v_dot2_f32_bf16 v132, v118, s52, v132
    v_dot2_f32_bf16 v133, v118, s53, v133
    v_dot2_f32_bf16 v134, v119, s52, v134
    v_dot2_f32_bf16 v135, v119, s53, v135
    v_dot2_f32_bf16 v128, v120, s52, v128
    v_dot2_f32_bf16 v129, v120, s53, v129
    v_dot2_f32_bf16 v130, v121, s52, v130
    v_dot2_f32_bf16 v131, v121, s53, v131
    v_dot2_f32_bf16 v132, v122, s52, v132
    v_dot2_f32_bf16 v133, v122, s53, v133
    v_dot2_f32_bf16 v134, v123, s52, v134
    v_dot2_f32_bf16 v135, v123, s53, v135
    s_nop 2
    v_permlane32_swap_b32 v128, v132
    v_permlane32_swap_b32 v129, v133
    v_permlane32_swap_b32 v130, v134
    v_permlane32_swap_b32 v131, v135
    s_nop 1
    v_add_f32 v128, v128, v132
    v_add_f32 v129, v129, v133
    v_add_f32 v130, v130, v134
    v_add_f32 v131, v131, v135
    s_nop 1
    v_add_f32_dpp v128, v128, v128 row_ror:8 row_mask:0xf bank_mask:0xf
    v_add_f32_dpp v129, v129, v129 row_ror:8 row_mask:0xf bank_mask:0xf
    v_add_f32_dpp v130, v130, v130 row_ror:8 row_mask:0xf bank_mask:0xf
    v_add_f32_dpp v131, v131, v131 row_ror:8 row_mask:0xf bank_mask:0xf
    v_mov_b32 v132, v128
    v_mov_b32 v133, v129
    v_mov_b32 v134, v130
    v_mov_b32 v135, v131
    s_nop 1
    v_permlane16_swap_b32 v128, v132
    v_permlane16_swap_b32 v129, v133
    v_permlane16_swap_b32 v130, v134
    v_permlane16_swap_b32 v131, v135
    s_nop 1
    v_add_f32 v128, v128, v132
    v_add_f32 v129, v129, v133
    v_add_f32 v130, v130, v134
    v_add_f32 v131, v131, v135
    v_lshlrev_b32 v14, 4, v8
    v_lshl_add_u32 v14, v5, 7, v14
    s_lshl_b32 s31, s30, 8
    v_add_u32 v13, s31, v14
    ds_write_b128 v13, v[128:131]
    s_waitcnt lgkmcnt(0)
    s_barrier
    ds_read_b128 v[96:99], v14 offset:0
    ds_read_b128 v[100:103], v14 offset:256
    ds_read_b128 v[104:107], v14 offset:512
    ds_read_b128 v[108:111], v14 offset:768
    s_waitcnt lgkmcnt(0)
    v_pk_add_f32 v[96:97], v[96:97], v[100:101]
    v_pk_add_f32 v[98:99], v[98:99], v[102:103]
    v_pk_add_f32 v[96:97], v[96:97], v[104:105]
    v_pk_add_f32 v[98:99], v[98:99], v[106:107]
    v_pk_add_f32 v[96:97], v[96:97], v[108:109]
    v_pk_add_f32 v[98:99], v[98:99], v[110:111]
    v_cvt_pk_bf16_f32 v20, v96, v97
    v_lshlrev_b32 v21, 16, v20
    v_and_b32 v22, 0xffff0000, v20
    v_mul_f32 v21, v36, v21
    v_mul_f32 v22, v36, v22
    v_cvt_pk_bf16_f32 v20, v21, v22
    v_lshlrev_b32 v21, 16, v20
    v_and_b32 v22, 0xffff0000, v20
    v_lshlrev_b32 v23, 16, v32
    v_and_b32 v24, 0xffff0000, v32
    v_add_f32 v21, v21, v23
    v_add_f32 v22, v22, v24
    v_cvt_pk_bf16_f32 v20, v21, v22
    v_lshlrev_b32 v21, 16, v20
    v_and_b32 v22, 0xffff0000, v20
    v_lshlrev_b32 v23, 16, v34
    v_and_b32 v24, 0xffff0000, v34
    v_add_f32 v21, v21, v23
    v_add_f32 v22, v22, v24
    v_cvt_pk_bf16_f32 v26, v21, v22
    v_cvt_pk_bf16_f32 v20, v98, v99
    v_lshlrev_b32 v21, 16, v20
    v_and_b32 v22, 0xffff0000, v20
    v_mul_f32 v21, v36, v21
    v_mul_f32 v22, v36, v22
    v_cvt_pk_bf16_f32 v20, v21, v22
    v_lshlrev_b32 v21, 16, v20
    v_and_b32 v22, 0xffff0000, v20
    v_lshlrev_b32 v23, 16, v33
    v_and_b32 v24, 0xffff0000, v33
    v_add_f32 v21, v21, v23
    v_add_f32 v22, v22, v24
    v_cvt_pk_bf16_f32 v20, v21, v22
    v_lshlrev_b32 v21, 16, v20
    v_and_b32 v22, 0xffff0000, v20
    v_lshlrev_b32 v23, 16, v35
    v_and_b32 v24, 0xffff0000, v35
    v_add_f32 v21, v21, v23
    v_add_f32 v22, v22, v24
    v_cvt_pk_bf16_f32 v27, v21, v22
    s_cmp_lg_u32 s30, 0
    s_cbranch_scc1 ff_fin_155
    s_mov_b32 exec_lo, 0xff
    s_mov_b32 exec_hi, 0xff
    buffer_store_dwordx2 v[26:27], v9, s[36:39], 0 offen sc1
ff_fin_155:
    s_mov_b64 exec, -1
k12_end_1:
    s_endpgm
k2_prep_76:
    s_sub_u32 s40, s36, s38
    v_subrev_u32 v6, s40, v4
    v_cmp_gt_i32 s[44:45], 0, v6
    v_cmp_gt_i32 s[46:47], 1, v6
    v_cmp_gt_i32 s[48:49], 2, v6
    v_cmp_gt_i32 s[50:51], 3, v6
    v_cndmask_b32 v16, v8, v5, s[44:45]
    v_cndmask_b32 v17, v8, v5, s[46:47]
    v_cndmask_b32 v18, v8, v5, s[48:49]
    v_cndmask_b32 v19, v8, v5, s[50:51]
    v_cmp_gt_i32 s[44:45], 16, v6
    v_cmp_gt_i32 s[46:47], 17, v6
    v_cmp_gt_i32 s[48:49], 18, v6
    v_cmp_gt_i32 s[50:51], 19, v6
    v_cndmask_b32 v32, v8, v5, s[44:45]
    v_cndmask_b32 v33, v8, v5, s[46:47]
    v_cndmask_b32 v34, v8, v5, s[48:49]
    v_cndmask_b32 v35, v8, v5, s[50:51]
    s_nop 1
    s_branch k2_prepret_77
k2_prep_84:
    s_sub_u32 s40, s36, s38
    v_subrev_u32 v6, s40, v4
    v_cmp_gt_i32 s[44:45], 0, v6
    v_cmp_gt_i32 s[46:47], 1, v6
    v_cmp_gt_i32 s[48:49], 2, v6
    v_cmp_gt_i32 s[50:51], 3, v6
    v_cndmask_b32 v16, v8, v5, s[44:45]
    v_cndmask_b32 v17, v8, v5, s[46:47]
    v_cndmask_b32 v18, v8, v5, s[48:49]
    v_cndmask_b32 v19, v8, v5, s[50:51]
    v_cmp_gt_i32 s[44:45], 16, v6
    v_cmp_gt_i32 s[46:47], 17, v6
    v_cmp_gt_i32 s[48:49], 18, v6
    v_cmp_gt_i32 s[50:51], 19, v6
    v_cndmask_b32 v32, v8, v5, s[44:45]
    v_cndmask_b32 v33, v8, v5, s[46:47]
    v_cndmask_b32 v34, v8, v5, s[48:49]
    v_cndmask_b32 v35, v8, v5, s[50:51]
    s_nop 1
    s_branch k2_prepret_85
k2_prep_102:
    s_sub_u32 s40, s36, s39
    v_subrev_u32 v6, s40, v4
    v_cmp_gt_i32 s[44:45], 0, v6
    v_cmp_gt_i32 s[46:47], 1, v6
    v_cmp_gt_i32 s[48:49], 2, v6
    v_cmp_gt_i32 s[50:51], 3, v6
    v_cndmask_b32 v16, v10, v5, s[44:45]
    v_cndmask_b32 v17, v10, v5, s[46:47]
    v_cndmask_b32 v18, v10, v5, s[48:49]
    v_cndmask_b32 v19, v10, v5, s[50:51]
    v_cmp_gt_i32 s[44:45], 16, v6
    v_cmp_gt_i32 s[46:47], 17, v6
    v_cmp_gt_i32 s[48:49], 18, v6
    v_cmp_gt_i32 s[50:51], 19, v6
    v_cndmask_b32 v32, v10, v5, s[44:45]
    v_cndmask_b32 v33, v10, v5, s[46:47]
    v_cndmask_b32 v34, v10, v5, s[48:49]
    v_cndmask_b32 v35, v10, v5, s[50:51]
    v_cmp_gt_i32 s[44:45], 32, v6
    v_cmp_gt_i32 s[46:47], 33, v6
    v_cmp_gt_i32 s[48:49], 34, v6
    v_cmp_gt_i32 s[50:51], 35, v6
    v_cndmask_b32 v24, v10, v5, s[44:45]
    v_cndmask_b32 v25, v10, v5, s[46:47]
    v_cndmask_b32 v26, v10, v5, s[48:49]
    v_cndmask_b32 v27, v10, v5, s[50:51]
    v_cmp_gt_i32 s[44:45], 48, v6
    v_cmp_gt_i32 s[46:47], 49, v6
    v_cmp_gt_i32 s[48:49], 50, v6
    v_cmp_gt_i32 s[50:51], 51, v6
    v_cndmask_b32 v40, v10, v5, s[44:45]
    v_cndmask_b32 v41, v10, v5, s[46:47]
    v_cndmask_b32 v42, v10, v5, s[48:49]
    v_cndmask_b32 v43, v10, v5, s[50:51]
    s_nop 1
    s_branch k2_prepret_103
k2_prep_106:
    s_sub_u32 s40, s36, s39
    s_sub_u32 s40, s40, 64
    v_subrev_u32 v6, s40, v4
    v_cmp_gt_i32 s[44:45], 0, v6
    v_cmp_gt_i32 s[46:47], 1, v6
    v_cmp_gt_i32 s[48:49], 2, v6
    v_cmp_gt_i32 s[50:51], 3, v6
    v_cndmask_b32 v20, v11, v5, s[44:45]
    v_cndmask_b32 v21, v11, v5, s[46:47]
    v_cndmask_b32 v22, v11, v5, s[48:49]
    v_cndmask_b32 v23, v11, v5, s[50:51]
    v_cmp_gt_i32 s[44:45], 16, v6
    v_cmp_gt_i32 s[46:47], 17, v6
    v_cmp_gt_i32 s[48:49], 18, v6
    v_cmp_gt_i32 s[50:51], 19, v6
    v_cndmask_b32 v36, v11, v5, s[44:45]
    v_cndmask_b32 v37, v11, v5, s[46:47]
    v_cndmask_b32 v38, v11, v5, s[48:49]
    v_cndmask_b32 v39, v11, v5, s[50:51]
    v_cmp_gt_i32 s[44:45], 32, v6
    v_cmp_gt_i32 s[46:47], 33, v6
    v_cmp_gt_i32 s[48:49], 34, v6
    v_cmp_gt_i32 s[50:51], 35, v6
    v_cndmask_b32 v28, v11, v5, s[44:45]
    v_cndmask_b32 v29, v11, v5, s[46:47]
    v_cndmask_b32 v30, v11, v5, s[48:49]
    v_cndmask_b32 v31, v11, v5, s[50:51]
    v_cmp_gt_i32 s[44:45], 48, v6
    v_cmp_gt_i32 s[46:47], 49, v6
    v_cmp_gt_i32 s[48:49], 50, v6
    v_cmp_gt_i32 s[50:51], 51, v6
    v_cndmask_b32 v44, v11, v5, s[44:45]
    v_cndmask_b32 v45, v11, v5, s[46:47]
    v_cndmask_b32 v46, v11, v5, s[48:49]
    v_cndmask_b32 v47, v11, v5, s[50:51]
    s_nop 1
    s_branch k2_prepret_107
k12_ool_10:
    buffer_load_dword v52, v8, s[24:27], 0 offen sc1
    s_branch k12_oolret_11
k12_ool_14:
    v_readfirstlane_b32 s31, v52
    s_cmp_ge_u32 s31, 256
    s_cbranch_scc1 spin_ok_12
    s_mov_b32 s40, 1048576
spin_13:
    s_sleep 8
    buffer_load_dword v52, v8, s[24:27], 0 offen sc1
    s_waitcnt vmcnt(0)
    v_readfirstlane_b32 s31, v52
    s_sub_u32 s40, s40, 1
    s_cselect_b32 s31, -1, s31
    s_cmp_lt_u32 s31, 256
    s_cbranch_scc1 spin_13
spin_ok_12:
    s_branch k12_oolret_15
k12_ool_16:
    s_mov_b64 exec, 1
    buffer_atomic_add v9, v8, s[24:27], 0 offen sc1
    s_mov_b64 exec, -1
    s_branch k12_oolret_17
k12_ool_18:
    buffer_load_dword v51, v50, s[12:15], s56 offen
    s_branch k12_oolret_19
k12_ool_20:
    s_add_u32 m0, s60, 131072
    s_nop 0
    buffer_load_dwordx4 v38, s[12:15], s61 offen offset:0 lds
    buffer_load_dwordx4 v39, s[12:15], s61 offen offset:1024 lds
    buffer_load_dwordx4 v40, s[12:15], s61 offen offset:2048 lds
    buffer_load_dwordx4 v41, s[12:15], s61 offen offset:3072 lds
    s_add_u32 s61, s61, 0x80000
    s_add_u32 m0, s60, 147456
    s_nop 0
    buffer_load_dwordx4 v38, s[12:15], s61 offen offset:0 lds
    buffer_load_dwordx4 v39, s[12:15], s61 offen offset:1024 lds
    buffer_load_dwordx4 v40, s[12:15], s61 offen offset:2048 lds
    buffer_load_dwordx4 v41, s[12:15], s61 offen offset:3072 lds
    s_add_u32 s61, s61, 0x80000
    s_branch k12_oolret_21
k12_ool_22:
    s_mov_b64 exec, 1
    buffer_atomic_add v9, v8, s[24:27], 0 offen sc1
    s_mov_b64 exec, -1
    s_branch k12_oolret_23
k12_ool_24:
    buffer_load_dword v51, v50, s[12:15], s56 offen
    s_branch k12_oolret_25
k12_ool_26:
    global_load_dword v51, v[2:3], off
    s_branch k12_oolret_27
k12_ool_30:
    buffer_load_dword v52, v8, s[24:27], 0 offen sc1
    s_branch k12_oolret_31
k12_ool_34:
    v_readfirstlane_b32 s31, v52
    s_cmp_ge_u32 s31, 256
    s_cbranch_scc1 spin_ok_32
    s_mov_b32 s40, 1048576
spin_33:
    s_sleep 8
    buffer_load_dword v52, v8, s[24:27], 0 offen sc1
    s_waitcnt vmcnt(0)
    v_readfirstlane_b32 s31, v52
    s_sub_u32 s40, s40, 1
    s_cselect_b32 s31, -1, s31
    s_cmp_lt_u32 s31, 256
    s_cbranch_scc1 spin_33
spin_ok_32:
    s_branch k12_oolret_35
k12_ool_36:
    s_mov_b64 exec, 1
    buffer_atomic_add v9, v8, s[24:27], 0 offen sc1
    s_mov_b64 exec, -1
    s_branch k12_oolret_37
k12_ool_38:
    buffer_load_dword v51, v50, s[12:15], s56 offen
    s_branch k12_oolret_39
k12_ool_40:
    s_add_u32 m0, s60, 131072
    s_nop 0
    buffer_load_dwordx4 v38, s[12:15], s61 offen offset:0 lds
    buffer_load_dwordx4 v39, s[12:15], s61 offen offset:1024 lds
    buffer_load_dwordx4 v40, s[12:15], s61 offen offset:2048 lds
    buffer_load_dwordx4 v41, s[12:15], s61 offen offset:3072 lds
    s_add_u32 s61, s61, 0x80000
    s_add_u32 m0, s60, 147456
    s_nop 0
    buffer_load_dwordx4 v38, s[12:15], s61 offen offset:0 lds
    buffer_load_dwordx4 v39, s[12:15], s61 offen offset:1024 lds
    buffer_load_dwordx4 v40, s[12:15], s61 offen offset:2048 lds
    buffer_load_dwordx4 v41, s[12:15], s61 offen offset:3072 lds
    s_add_u32 s61, s61, 0x80000
    s_branch k12_oolret_41
k12_ool_42:
    s_mov_b64 exec, 1
    buffer_atomic_add v9, v8, s[24:27], 0 offen sc1
    s_mov_b64 exec, -1
    s_branch k12_oolret_43
k12_ool_44:
    buffer_load_dword v51, v50, s[12:15], s56 offen
    s_branch k12_oolret_45
k12_ool_46:
    global_load_dword v51, v[2:3], off
    s_branch k12_oolret_47
k12_ool_48:
    s_add_u32 s52, s47, 528384
    buffer_store_dwordx4 v[152:155], v1, s[48:51], s52 offen offset:2048 sc1
    s_branch k12_oolret_49
k12_ool_50:
    s_add_u32 s52, s47, 528384
    buffer_store_dwordx4 v[156:159], v1, s[48:51], s52 offen offset:3072 sc1
    s_branch k12_oolret_51
k12_ool_52:
    s_add_u32 s52, s47, 532480
    buffer_store_dwordx4 v[168:171], v1, s[48:51], s52 offen offset:2048 sc1
    s_branch k12_oolret_53
k12_ool_54:
    s_add_u32 s52, s47, 532480
    buffer_store_dwordx4 v[172:175], v1, s[48:51], s52 offen offset:3072 sc1
    s_branch k12_oolret_55
k12_ool_56:
    s_add_u32 s52, s47, 536576
    buffer_store_dwordx4 v[176:179], v1, s[48:51], s52 offen offset:0 sc1
    s_branch k12_oolret_57
k12_ool_58:
    s_add_u32 s52, s47, 536576
    buffer_store_dwordx4 v[180:183], v1, s[48:51], s52 offen offset:1024 sc1
    s_branch k12_oolret_59
k12_ool_60:
    s_add_u32 s52, s47, 536576
    buffer_store_dwordx4 v[184:187], v1, s[48:51], s52 offen offset:2048 sc1
    s_branch k12_oolret_61
k12_ool_62:
    s_add_u32 s52, s47, 536576
    buffer_store_dwordx4 v[188:191], v1, s[48:51], s52 offen offset:3072 sc1
    s_branch k12_oolret_63
k12_ool_64:
    s_mov_b32 s50, 0
    s_branch k12_oolret_65
k12_ool_66:
    s_mov_b64 exec, 1
    buffer_atomic_add v9, v8, s[24:27], s54 offen sc1
    s_mov_b64 exec, -1
    s_branch k12_oolret_67
k12_ool_68:
    buffer_load_dword v52, v8, s[24:27], s55 offen sc1
    s_branch k12_oolret_69
k12_ool_72:
    s_waitcnt vmcnt(10)
    v_readfirstlane_b32 s31, v52
    s_cmp_ge_u32 s31, 2
    s_cbranch_scc1 spin_ok_70
    s_mov_b32 s40, 1048576
spin_71:
    s_sleep 8
    buffer_load_dword v52, v8, s[24:27], s55 offen sc1
    s_waitcnt vmcnt(0)
    v_readfirstlane_b32 s31, v52
    s_sub_u32 s40, s40, 1
    s_cselect_b32 s31, -1, s31
    s_cmp_lt_u32 s31, 2
    s_cbranch_scc1 spin_71
spin_ok_70:
    s_branch k12_oolret_73
k12_ool_74:
    s_mov_b64 exec, 1
    buffer_atomic_add v9, v8, s[24:27], s3 offen sc1
    s_mov_b64 exec, -1
    s_branch k12_oolret_75
k12_ool_78:
    buffer_load_dword v58, v59, s[24:27], s5 offen sc1
    s_branch k12_oolret_79
k12_ool_82:
    s_waitcnt vmcnt(0)
    v_readfirstlane_b32 s31, v58
    s_cmp_ge_u32 s31, 14
    s_cbranch_scc1 spin_ok_80
    s_mov_b32 s40, 1048576
spin_81:
    s_sleep 8
    buffer_load_dword v58, v59, s[24:27], s5 offen sc1
    s_waitcnt vmcnt(0)
    v_readfirstlane_b32 s31, v58
    s_sub_u32 s40, s40, 1
    s_cselect_b32 s31, -1, s31
    s_cmp_lt_u32 s31, 14
    s_cbranch_scc1 spin_81
spin_ok_80:
    s_branch k12_oolret_83
k12_ool_122:
    s_mov_b64 exec, 1
    buffer_atomic_add v76, v75, s[16:19], s57 offen sc1
    s_mov_b64 exec, -1
    s_branch k12_oolret_123
k12_ool_127:
    s_mov_b64 exec, 1
    buffer_atomic_add v76, v75, s[16:19], s58 offen sc1
    s_mov_b64 exec, -1
    s_branch k12_oolret_128
k12_ool_131:
    s_mov_b32 s34, 1048576
op_spin_129:
    buffer_load_dword v74, v73, s[16:19], s59 offen sc1
    s_waitcnt vmcnt(0)
    v_cmp_le_u32 vcc, 4, v74
    s_sub_u32 s34, s34, 1
    s_cbranch_scc1 op_ok_130
    s_mov_b32 s33, vcc_lo
    s_bitcmp1_b32 s33, 0
    s_cbranch_scc1 op_ok_130
    s_sleep 4
    s_branch op_spin_129
op_ok_130:
    buffer_load_dwordx4 a[128:131], v88, s[8:11], s62 offen offset:0 sc1
    buffer_load_dwordx4 a[132:135], v88, s[8:11], s62 offen offset:1024 sc1
    buffer_load_dwordx4 a[136:139], v89, s[8:11], s62 offen offset:0 sc1
    buffer_load_dwordx4 a[140:143], v89, s[8:11], s62 offen offset:1024 sc1
    s_add_u32 s62, s62, 0x40000
    s_and_b32 s62, s62, 0x7fffff
    buffer_load_dwordx4 a[144:147], v88, s[8:11], s62 offen offset:0 sc1
    buffer_load_dwordx4 a[148:151], v88, s[8:11], s62 offen offset:1024 sc1
    buffer_load_dwordx4 a[152:155], v89, s[8:11], s62 offen offset:0 sc1
    buffer_load_dwordx4 a[156:159], v89, s[8:11], s62 offen offset:1024 sc1
    s_add_u32 s62, s62, 0x40000
    s_and_b32 s62, s62, 0x7fffff
    buffer_load_dwordx4 a[160:163], v88, s[8:11], s62 offen offset:0 sc1
    buffer_load_dwordx4 a[164:167], v88, s[8:11], s62 offen offset:1024 sc1
    buffer_load_dwordx4 a[168:171], v89, s[8:11], s62 offen offset:0 sc1
    buffer_load_dwordx4 a[172:175], v89, s[8:11], s62 offen offset:1024 sc1
    s_add_u32 s62, s62, 0x40000
    s_and_b32 s62, s62, 0x7fffff
    s_branch k12_oolret_132
k12_ool_137:
    buffer_load_dwordx2 v[192:193], v78, s[20:23], 0 offen offset:0
    buffer_load_dwordx2 v[194:195], v78, s[20:23], 0 offen offset:32
    buffer_load_dwordx2 v[196:197], v78, s[20:23], 0 offen offset:64
    buffer_load_dwordx2 v[198:199], v78, s[20:23], 0 offen offset:96
    buffer_load_dwordx2 v[200:201], v79, s[20:23], 0 offen offset:0
    buffer_load_dwordx2 v[202:203], v79, s[20:23], 0 offen offset:32
    buffer_load_dwordx2 v[204:205], v79, s[20:23], 0 offen offset:64
    buffer_load_dwordx2 v[206:207], v79, s[20:23], 0 offen offset:96
    buffer_load_dwordx2 v[208:209], v80, s[44:47], 0 offen offset:0
    buffer_load_dwordx2 v[210:211], v80, s[44:47], 0 offen offset:32
    buffer_load_dwordx2 v[212:213], v80, s[44:47], 0 offen offset:64
    buffer_load_dwordx2 v[214:215], v80, s[44:47], 0 offen offset:96
    global_load_dword v84, v[82:83], off
    s_mov_b32 s10, 0
    s_mov_b32 s14, 0
    s_mov_b32 s34, 1048576
ff_spin_135:
    v_cmp_gt_u32 vcc, 4, v95
    s_cbranch_vccz ff_ok_136
    s_sub_u32 s34, s34, 1
    s_cbranch_scc1 ff_ok_136
    s_sleep 4
    buffer_load_dword v95, v94, s[16:19], 0 offen sc1
    s_waitcnt vmcnt(0)
    s_branch ff_spin_135
ff_ok_136:
    s_add_u32 s44, s6, 0x6000000
    s_addc_u32 s45, s7, 0
    s_and_b32 s45, s45, 0xffff
    s_cmp_ge_u32 s2, 224
    s_cselect_b32 s46, 0, 0x1000000
    s_branch k12_oolret_138
k12_ool_141:
    s_mov_b32 s34, 1048576
op_spin_139:
    buffer_load_dword v74, v73, s[16:19], s59 offen sc1
    s_waitcnt vmcnt(0)
    v_cmp_le_u32 vcc, 4, v74
    s_sub_u32 s34, s34, 1
    s_cbranch_scc1 op_ok_140
    s_mov_b32 s33, vcc_lo
    s_bitcmp1_b32 s33, s32
    s_cbranch_scc1 op_ok_140
    s_sleep 4
    s_branch op_spin_139
op_ok_140:
    s_branch k12_oolret_142
k12_ool_143:
    buffer_load_dword v95, v94, s[16:19], 0 offen sc1
    s_branch k12_oolret_144
k2_tramp_86:
    s_call_b64 s[40:41], k2_rare_158
    s_branch k2_ret_87
k2_tramp_90:
    s_call_b64 s[40:41], k2_rare_159
    s_branch k2_ret_91
k2_tramp_92:
    s_call_b64 s[40:41], k2_rare_158
    s_branch k2_ret_93
k2_tramp_94:
    s_call_b64 s[40:41], k2_rare_159
    s_branch k2_ret_95
k2_tramp_96:
    s_call_b64 s[40:41], k2_rare_158
    s_branch k2_ret_97
k2_tramp_98:
    s_call_b64 s[40:41], k2_rare_159
    s_branch k2_ret_99
k2_tramp_100:
    s_call_b64 s[40:41], k2_rare_164
    s_branch k2_ret_101
k2_tramp_104:
    s_call_b64 s[40:41], k2_rare_165
    s_branch k2_ret_105
k2_tramp_108:
    s_call_b64 s[40:41], k2_rare_166
    s_branch k2_ret_109
k2_tramp_112:
    s_call_b64 s[40:41], k2_rare_167
    s_branch k2_ret_113
k2_tramp_114:
    s_call_b64 s[40:41], k2_rare_166
    s_branch k2_ret_115
k2_tramp_116:
    s_call_b64 s[40:41], k2_rare_167
    s_branch k2_ret_117
k2_tramp_118:
    s_call_b64 s[40:41], k2_rare_166
    s_branch k2_ret_119
k2_tramp_120:
    s_call_b64 s[40:41], k2_rare_171
    s_branch k2_ret_121
k2_rare_158:
    s_nop 7
    v_max_f32 v52, v128, v129
    v_max3_f32 v52, v52, v130, v131
    v_max3_f32 v52, v52, v144, v145
    v_max3_f32 v52, v52, v146, v147
    v_max_f32 v53, v132, v133
    v_max3_f32 v53, v53, v134, v135
    v_max3_f32 v53, v53, v148, v149
    v_max3_f32 v53, v53, v150, v151
    v_max_f32 v54, v136, v137
    v_max3_f32 v54, v54, v138, v139
    v_max3_f32 v54, v54, v152, v153
    v_max3_f32 v54, v54, v154, v155
    v_max_f32 v55, v140, v141
    v_max3_f32 v55, v55, v142, v143
    v_max3_f32 v55, v55, v156, v157
    v_max3_f32 v55, v55, v158, v159
    v_mov_b32 v224, v52
    v_mov_b32 v225, v53
    v_mov_b32 v226, v54
    v_mov_b32 v227, v55
    s_nop 1
    v_permlane16_swap_b32 v52, v224
    v_permlane16_swap_b32 v53, v225
    v_permlane16_swap_b32 v54, v226
    v_permlane16_swap_b32 v55, v227
    s_nop 1
    v_max_f32 v52, v52, v224
    v_max_f32 v53, v53, v225
    v_max_f32 v54, v54, v226
    v_max_f32 v55, v55, v227
    v_mov_b32 v224, v52
    v_mov_b32 v225, v53
    v_mov_b32 v226, v54
    v_mov_b32 v227, v55
    s_nop 1
    v_permlane32_swap_b32 v52, v224
    v_permlane32_swap_b32 v53, v225
    v_permlane32_swap_b32 v54, v226
    v_permlane32_swap_b32 v55, v227
    s_nop 1
    v_max_f32 v52, v52, v224
    v_max_f32 v53, v53, v225
    v_max_f32 v54, v54, v226
    v_max_f32 v55, v55, v227
    v_add_f32 v52, 0x41400000, v52
    v_max_f32 v52, 0, v52
    v_add_f32 v53, 0x41400000, v53
    v_max_f32 v53, 0, v53
    v_add_f32 v54, 0x41400000, v54
    v_max_f32 v54, 0, v54
    v_add_f32 v55, 0x41400000, v55
    v_max_f32 v55, 0, v55
    v_sub_f32 v128, v128, v52
    v_sub_f32 v129, v129, v52
    v_sub_f32 v130, v130, v52
    v_sub_f32 v131, v131, v52
    v_sub_f32 v132, v132, v53
    v_sub_f32 v133, v133, v53
    v_sub_f32 v134, v134, v53
    v_sub_f32 v135, v135, v53
    v_sub_f32 v136, v136, v54
    v_sub_f32 v137, v137, v54
    v_sub_f32 v138, v138, v54
    v_sub_f32 v139, v139, v54
    v_sub_f32 v140, v140, v55
    v_sub_f32 v141, v141, v55
    v_sub_f32 v142, v142, v55
    v_sub_f32 v143, v143, v55
    v_sub_f32 v144, v144, v52
    v_sub_f32 v145, v145, v52
    v_sub_f32 v146, v146, v52
    v_sub_f32 v147, v147, v52
    v_sub_f32 v148, v148, v53
    v_sub_f32 v149, v149, v53
    v_sub_f32 v150, v150, v53
    v_sub_f32 v151, v151, v53
    v_sub_f32 v152, v152, v54
    v_sub_f32 v153, v153, v54
    v_sub_f32 v154, v154, v54
    v_sub_f32 v155, v155, v54
    v_sub_f32 v156, v156, v55
    v_sub_f32 v157, v157, v55
    v_sub_f32 v158, v158, v55
    v_sub_f32 v159, v159, v55
    v_sub_f32 v160, v160, v52
    v_sub_f32 v16, v16, v52
    v_sub_f32 v161, v161, v52
    v_sub_f32 v17, v17, v52
    v_sub_f32 v162, v162, v52
    v_sub_f32 v18, v18, v52
    v_sub_f32 v163, v163, v52
    v_sub_f32 v19, v19, v52
    v_sub_f32 v164, v164, v53
    v_sub_f32 v20, v20, v53
    v_sub_f32 v165, v165, v53
    v_sub_f32 v21, v21, v53
    v_sub_f32 v166, v166, v53
    v_sub_f32 v22, v22, v53
    v_sub_f32 v167, v167, v53
    v_sub_f32 v23, v23, v53
    v_sub_f32 v168, v168, v54
    v_sub_f32 v24, v24, v54
    v_sub_f32 v169, v169, v54
    v_sub_f32 v25, v25, v54
    v_sub_f32 v170, v170, v54
    v_sub_f32 v26, v26, v54
    v_sub_f32 v171, v171, v54
    v_sub_f32 v27, v27, v54
    v_sub_f32 v172, v172, v55
    v_sub_f32 v28, v28, v55
    v_sub_f32 v173, v173, v55
    v_sub_f32 v29, v29, v55
    v_sub_f32 v174, v174, v55
    v_sub_f32 v30, v30, v55
    v_sub_f32 v175, v175, v55
    v_sub_f32 v31, v31, v55
    v_sub_f32 v176, v176, v52
    v_sub_f32 v32, v32, v52
    v_sub_f32 v177, v177, v52
    v_sub_f32 v33, v33, v52
    v_sub_f32 v178, v178, v52
    v_sub_f32 v34, v34, v52
    v_sub_f32 v179, v179, v52
    v_sub_f32 v35, v35, v52
    v_sub_f32 v180, v180, v53
    v_sub_f32 v36, v36, v53
    v_sub_f32 v181, v181, v53
    v_sub_f32 v37, v37, v53
    v_sub_f32 v182, v182, v53
    v_sub_f32 v38, v38, v53
    v_sub_f32 v183, v183, v53
    v_sub_f32 v39, v39, v53
    v_sub_f32 v184, v184, v54
    v_sub_f32 v40, v40, v54
    v_sub_f32 v185, v185, v54
    v_sub_f32 v41, v41, v54
    v_sub_f32 v186, v186, v54
    v_sub_f32 v42, v42, v54
    v_sub_f32 v187, v187, v54
    v_sub_f32 v43, v43, v54
    v_sub_f32 v188, v188, v55
    v_sub_f32 v44, v44, v55
    v_sub_f32 v189, v189, v55
    v_sub_f32 v45, v45, v55
    v_sub_f32 v190, v190, v55
    v_sub_f32 v46, v46, v55
    v_sub_f32 v191, v191, v55
    v_sub_f32 v47, v47, v55
    v_sub_f32 v8, v8, v52
    v_exp_f32 v52, -v52
    v_sub_f32 v9, v9, v53
    v_exp_f32 v53, -v53
    v_sub_f32 v10, v10, v54
    v_exp_f32 v54, -v54
    v_sub_f32 v11, v11, v55
    v_exp_f32 v55, -v55
    s_nop 0
    v_mul_f32 v12, v12, v52
    v_mul_f32 v48, v48, v53
    v_mul_f32 v248, v248, v54
    v_mul_f32 v252, v252, v55
    v_accvgpr_read_b32 v224, a0
    v_accvgpr_read_b32 v225, a1
    v_accvgpr_read_b32 v226, a2
    v_accvgpr_read_b32 v227, a3
    v_mul_f32 v224, v224, v52
    v_mul_f32 v225, v225, v52
    v_mul_f32 v226, v226, v52
    v_mul_f32 v227, v227, v52
    v_accvgpr_write_b32 a0, v224
    v_accvgpr_write_b32 a1, v225
    v_accvgpr_write_b32 a2, v226
    v_accvgpr_write_b32 a3, v227
    v_accvgpr_read_b32 v224, a4
    v_accvgpr_read_b32 v225, a5
    v_accvgpr_read_b32 v226, a6
    v_accvgpr_read_b32 v227, a7
    v_mul_f32 v224, v224, v53
    v_mul_f32 v225, v225, v53
    v_mul_f32 v226, v226, v53
    v_mul_f32 v227, v227, v53
    v_accvgpr_write_b32 a4, v224
    v_accvgpr_write_b32 a5, v225
    v_accvgpr_write_b32 a6, v226
    v_accvgpr_write_b32 a7, v227
    v_accvgpr_read_b32 v224, a8
    v_accvgpr_read_b32 v225, a9
    v_accvgpr_read_b32 v226, a10
    v_accvgpr_read_b32 v227, a11
    v_mul_f32 v224, v224, v54
    v_mul_f32 v225, v225, v54
    v_mul_f32 v226, v226, v54
    v_mul_f32 v227, v227, v54
    v_accvgpr_write_b32 a8, v224
    v_accvgpr_write_b32 a9, v225
    v_accvgpr_write_b32 a10, v226
    v_accvgpr_write_b32 a11, v227
    v_accvgpr_read_b32 v224, a12
    v_accvgpr_read_b32 v225, a13
    v_accvgpr_read_b32 v226, a14
    v_accvgpr_read_b32 v227, a15
    v_mul_f32 v224, v224, v55
    v_mul_f32 v225, v225, v55
    v_mul_f32 v226, v226, v55
    v_mul_f32 v227, v227, v55
    v_accvgpr_write_b32 a12, v224
    v_accvgpr_write_b32 a13, v225
    v_accvgpr_write_b32 a14, v226
    v_accvgpr_write_b32 a15, v227
    v_accvgpr_read_b32 v224, a16
    v_accvgpr_read_b32 v225, a17
    v_accvgpr_read_b32 v226, a18
    v_accvgpr_read_b32 v227, a19
    v_mul_f32 v224, v224, v52
    v_mul_f32 v225, v225, v52
    v_mul_f32 v226, v226, v52
    v_mul_f32 v227, v227, v52
    v_accvgpr_write_b32 a16, v224
    v_accvgpr_write_b32 a17, v225
    v_accvgpr_write_b32 a18, v226
    v_accvgpr_write_b32 a19, v227
    v_accvgpr_read_b32 v224, a20
    v_accvgpr_read_b32 v225, a21
    v_accvgpr_read_b32 v226, a22
    v_accvgpr_read_b32 v227, a23
    v_mul_f32 v224, v224, v53
    v_mul_f32 v225, v225, v53
    v_mul_f32 v226, v226, v53
    v_mul_f32 v227, v227, v53
    v_accvgpr_write_b32 a20, v224
    v_accvgpr_write_b32 a21, v225
    v_accvgpr_write_b32 a22, v226
    v_accvgpr_write_b32 a23, v227
    v_accvgpr_read_b32 v224, a24
    v_accvgpr_read_b32 v225, a25
    v_accvgpr_read_b32 v226, a26
    v_accvgpr_read_b32 v227, a27
    v_mul_f32 v224, v224, v54
    v_mul_f32 v225, v225, v54
    v_mul_f32 v226, v226, v54
    v_mul_f32 v227, v227, v54
    v_accvgpr_write_b32 a24, v224
    v_accvgpr_write_b32 a25, v225
    v_accvgpr_write_b32 a26, v226
    v_accvgpr_write_b32 a27, v227
    v_accvgpr_read_b32 v224, a28
    v_accvgpr_read_b32 v225, a29
    v_accvgpr_read_b32 v226, a30
    v_accvgpr_read_b32 v227, a31
    v_mul_f32 v224, v224, v55
    v_mul_f32 v225, v225, v55
    v_mul_f32 v226, v226, v55
    v_mul_f32 v227, v227, v55
    v_accvgpr_write_b32 a28, v224
    v_accvgpr_write_b32 a29, v225
    v_accvgpr_write_b32 a30, v226
    v_accvgpr_write_b32 a31, v227
    v_accvgpr_read_b32 v224, a32
    v_accvgpr_read_b32 v225, a33
    v_accvgpr_read_b32 v226, a34
    v_accvgpr_read_b32 v227, a35
    v_mul_f32 v224, v224, v52
    v_mul_f32 v225, v225, v52
    v_mul_f32 v226, v226, v52
    v_mul_f32 v227, v227, v52
    v_accvgpr_write_b32 a32, v224
    v_accvgpr_write_b32 a33, v225
    v_accvgpr_write_b32 a34, v226
    v_accvgpr_write_b32 a35, v227
    v_accvgpr_read_b32 v224, a36
    v_accvgpr_read_b32 v225, a37
    v_accvgpr_read_b32 v226, a38
    v_accvgpr_read_b32 v227, a39
    v_mul_f32 v224, v224, v53
    v_mul_f32 v225, v225, v53
    v_mul_f32 v226, v226, v53
    v_mul_f32 v227, v227, v53
    v_accvgpr_write_b32 a36, v224
    v_accvgpr_write_b32 a37, v225
    v_accvgpr_write_b32 a38, v226
    v_accvgpr_write_b32 a39, v227
    v_accvgpr_read_b32 v224, a40
    v_accvgpr_read_b32 v225, a41
    v_accvgpr_read_b32 v226, a42
    v_accvgpr_read_b32 v227, a43
    v_mul_f32 v224, v224, v54
    v_mul_f32 v225, v225, v54
    v_mul_f32 v226, v226, v54
    v_mul_f32 v227, v227, v54
    v_accvgpr_write_b32 a40, v224
    v_accvgpr_write_b32 a41, v225
    v_accvgpr_write_b32 a42, v226
    v_accvgpr_write_b32 a43, v227
    v_accvgpr_read_b32 v224, a44
    v_accvgpr_read_b32 v225, a45
    v_accvgpr_read_b32 v226, a46
    v_accvgpr_read_b32 v227, a47
    v_mul_f32 v224, v224, v55
    v_mul_f32 v225, v225, v55
    v_mul_f32 v226, v226, v55
    v_mul_f32 v227, v227, v55
    v_accvgpr_write_b32 a44, v224
    v_accvgpr_write_b32 a45, v225
    v_accvgpr_write_b32 a46, v226
    v_accvgpr_write_b32 a47, v227
    v_accvgpr_read_b32 v224, a48
    v_accvgpr_read_b32 v225, a49
    v_accvgpr_read_b32 v226, a50
    v_accvgpr_read_b32 v227, a51
    v_mul_f32 v224, v224, v52
    v_mul_f32 v225, v225, v52
    v_mul_f32 v226, v226, v52
    v_mul_f32 v227, v227, v52
    v_accvgpr_write_b32 a48, v224
    v_accvgpr_write_b32 a49, v225
    v_accvgpr_write_b32 a50, v226
    v_accvgpr_write_b32 a51, v227
    v_accvgpr_read_b32 v224, a52
    v_accvgpr_read_b32 v225, a53
    v_accvgpr_read_b32 v226, a54
    v_accvgpr_read_b32 v227, a55
    v_mul_f32 v224, v224, v53
    v_mul_f32 v225, v225, v53
    v_mul_f32 v226, v226, v53
    v_mul_f32 v227, v227, v53
    v_accvgpr_write_b32 a52, v224
    v_accvgpr_write_b32 a53, v225
    v_accvgpr_write_b32 a54, v226
    v_accvgpr_write_b32 a55, v227
    v_accvgpr_read_b32 v224, a56
    v_accvgpr_read_b32 v225, a57
    v_accvgpr_read_b32 v226, a58
    v_accvgpr_read_b32 v227, a59
    v_mul_f32 v224, v224, v54
    v_mul_f32 v225, v225, v54
    v_mul_f32 v226, v226, v54
    v_mul_f32 v227, v227, v54
    v_accvgpr_write_b32 a56, v224
    v_accvgpr_write_b32 a57, v225
    v_accvgpr_write_b32 a58, v226
    v_accvgpr_write_b32 a59, v227
    v_accvgpr_read_b32 v224, a60
    v_accvgpr_read_b32 v225, a61
    v_accvgpr_read_b32 v226, a62
    v_accvgpr_read_b32 v227, a63
    v_mul_f32 v224, v224, v55
    v_mul_f32 v225, v225, v55
    v_mul_f32 v226, v226, v55
    v_mul_f32 v227, v227, v55
    v_accvgpr_write_b32 a60, v224
    v_accvgpr_write_b32 a61, v225
    v_accvgpr_write_b32 a62, v226
    v_accvgpr_write_b32 a63, v227
    v_accvgpr_read_b32 v224, a64
    v_accvgpr_read_b32 v225, a65
    v_accvgpr_read_b32 v226, a66
    v_accvgpr_read_b32 v227, a67
    v_mul_f32 v224, v224, v52
    v_mul_f32 v225, v225, v52
    v_mul_f32 v226, v226, v52
    v_mul_f32 v227, v227, v52
    v_accvgpr_write_b32 a64, v224
    v_accvgpr_write_b32 a65, v225
    v_accvgpr_write_b32 a66, v226
    v_accvgpr_write_b32 a67, v227
    v_accvgpr_read_b32 v224, a68
    v_accvgpr_read_b32 v225, a69
    v_accvgpr_read_b32 v226, a70
    v_accvgpr_read_b32 v227, a71
    v_mul_f32 v224, v224, v53
    v_mul_f32 v225, v225, v53
    v_mul_f32 v226, v226, v53
    v_mul_f32 v227, v227, v53
    v_accvgpr_write_b32 a68, v224
    v_accvgpr_write_b32 a69, v225
    v_accvgpr_write_b32 a70, v226
    v_accvgpr_write_b32 a71, v227
    v_accvgpr_read_b32 v224, a72
    v_accvgpr_read_b32 v225, a73
    v_accvgpr_read_b32 v226, a74
    v_accvgpr_read_b32 v227, a75
    v_mul_f32 v224, v224, v54
    v_mul_f32 v225, v225, v54
    v_mul_f32 v226, v226, v54
    v_mul_f32 v227, v227, v54
    v_accvgpr_write_b32 a72, v224
    v_accvgpr_write_b32 a73, v225
    v_accvgpr_write_b32 a74, v226
    v_accvgpr_write_b32 a75, v227
    v_accvgpr_read_b32 v224, a76
    v_accvgpr_read_b32 v225, a77
    v_accvgpr_read_b32 v226, a78
    v_accvgpr_read_b32 v227, a79
    v_mul_f32 v224, v224, v55
    v_mul_f32 v225, v225, v55
    v_mul_f32 v226, v226, v55
    v_mul_f32 v227, v227, v55
    v_accvgpr_write_b32 a76, v224
    v_accvgpr_write_b32 a77, v225
    v_accvgpr_write_b32 a78, v226
    v_accvgpr_write_b32 a79, v227
    v_accvgpr_read_b32 v224, a80
    v_accvgpr_read_b32 v225, a81
    v_accvgpr_read_b32 v226, a82
    v_accvgpr_read_b32 v227, a83
    v_mul_f32 v224, v224, v52
    v_mul_f32 v225, v225, v52
    v_mul_f32 v226, v226, v52
    v_mul_f32 v227, v227, v52
    v_accvgpr_write_b32 a80, v224
    v_accvgpr_write_b32 a81, v225
    v_accvgpr_write_b32 a82, v226
    v_accvgpr_write_b32 a83, v227
    v_accvgpr_read_b32 v224, a84
    v_accvgpr_read_b32 v225, a85
    v_accvgpr_read_b32 v226, a86
    v_accvgpr_read_b32 v227, a87
    v_mul_f32 v224, v224, v53
    v_mul_f32 v225, v225, v53
    v_mul_f32 v226, v226, v53
    v_mul_f32 v227, v227, v53
    v_accvgpr_write_b32 a84, v224
    v_accvgpr_write_b32 a85, v225
    v_accvgpr_write_b32 a86, v226
    v_accvgpr_write_b32 a87, v227
    v_accvgpr_read_b32 v224, a88
    v_accvgpr_read_b32 v225, a89
    v_accvgpr_read_b32 v226, a90
    v_accvgpr_read_b32 v227, a91
    v_mul_f32 v224, v224, v54
    v_mul_f32 v225, v225, v54
    v_mul_f32 v226, v226, v54
    v_mul_f32 v227, v227, v54
    v_accvgpr_write_b32 a88, v224
    v_accvgpr_write_b32 a89, v225
    v_accvgpr_write_b32 a90, v226
    v_accvgpr_write_b32 a91, v227
    v_accvgpr_read_b32 v224, a92
    v_accvgpr_read_b32 v225, a93
    v_accvgpr_read_b32 v226, a94
    v_accvgpr_read_b32 v227, a95
    v_mul_f32 v224, v224, v55
    v_mul_f32 v225, v225, v55
    v_mul_f32 v226, v226, v55
    v_mul_f32 v227, v227, v55
    v_accvgpr_write_b32 a92, v224
    v_accvgpr_write_b32 a93, v225
    v_accvgpr_write_b32 a94, v226
    v_accvgpr_write_b32 a95, v227
    v_accvgpr_read_b32 v224, a96
    v_accvgpr_read_b32 v225, a97
    v_accvgpr_read_b32 v226, a98
    v_accvgpr_read_b32 v227, a99
    v_mul_f32 v224, v224, v52
    v_mul_f32 v225, v225, v52
    v_mul_f32 v226, v226, v52
    v_mul_f32 v227, v227, v52
    v_accvgpr_write_b32 a96, v224
    v_accvgpr_write_b32 a97, v225
    v_accvgpr_write_b32 a98, v226
    v_accvgpr_write_b32 a99, v227
    v_accvgpr_read_b32 v224, a100
    v_accvgpr_read_b32 v225, a101
    v_accvgpr_read_b32 v226, a102
    v_accvgpr_read_b32 v227, a103
    v_mul_f32 v224, v224, v53
    v_mul_f32 v225, v225, v53
    v_mul_f32 v226, v226, v53
    v_mul_f32 v227, v227, v53
    v_accvgpr_write_b32 a100, v224
    v_accvgpr_write_b32 a101, v225
    v_accvgpr_write_b32 a102, v226
    v_accvgpr_write_b32 a103, v227
    v_accvgpr_read_b32 v224, a104
    v_accvgpr_read_b32 v225, a105
    v_accvgpr_read_b32 v226, a106
    v_accvgpr_read_b32 v227, a107
    v_mul_f32 v224, v224, v54
    v_mul_f32 v225, v225, v54
    v_mul_f32 v226, v226, v54
    v_mul_f32 v227, v227, v54
    v_accvgpr_write_b32 a104, v224
    v_accvgpr_write_b32 a105, v225
    v_accvgpr_write_b32 a106, v226
    v_accvgpr_write_b32 a107, v227
    v_accvgpr_read_b32 v224, a108
    v_accvgpr_read_b32 v225, a109
    v_accvgpr_read_b32 v226, a110
    v_accvgpr_read_b32 v227, a111
    v_mul_f32 v224, v224, v55
    v_mul_f32 v225, v225, v55
    v_mul_f32 v226, v226, v55
    v_mul_f32 v227, v227, v55
    v_accvgpr_write_b32 a108, v224
    v_accvgpr_write_b32 a109, v225
    v_accvgpr_write_b32 a110, v226
    v_accvgpr_write_b32 a111, v227
    v_accvgpr_read_b32 v224, a112
    v_accvgpr_read_b32 v225, a113
    v_accvgpr_read_b32 v226, a114
    v_accvgpr_read_b32 v227, a115
    v_mul_f32 v224, v224, v52
    v_mul_f32 v225, v225, v52
    v_mul_f32 v226, v226, v52
    v_mul_f32 v227, v227, v52
    v_accvgpr_write_b32 a112, v224
    v_accvgpr_write_b32 a113, v225
    v_accvgpr_write_b32 a114, v226
    v_accvgpr_write_b32 a115, v227
    v_accvgpr_read_b32 v224, a116
    v_accvgpr_read_b32 v225, a117
    v_accvgpr_read_b32 v226, a118
    v_accvgpr_read_b32 v227, a119
    v_mul_f32 v224, v224, v53
    v_mul_f32 v225, v225, v53
    v_mul_f32 v226, v226, v53
    v_mul_f32 v227, v227, v53
    v_accvgpr_write_b32 a116, v224
    v_accvgpr_write_b32 a117, v225
    v_accvgpr_write_b32 a118, v226
    v_accvgpr_write_b32 a119, v227
    v_accvgpr_read_b32 v224, a120
    v_accvgpr_read_b32 v225, a121
    v_accvgpr_read_b32 v226, a122
    v_accvgpr_read_b32 v227, a123
    v_mul_f32 v224, v224, v54
    v_mul_f32 v225, v225, v54
    v_mul_f32 v226, v226, v54
    v_mul_f32 v227, v227, v54
    v_accvgpr_write_b32 a120, v224
    v_accvgpr_write_b32 a121, v225
    v_accvgpr_write_b32 a122, v226
    v_accvgpr_write_b32 a123, v227
    v_accvgpr_read_b32 v224, a124
    v_accvgpr_read_b32 v225, a125
    v_accvgpr_read_b32 v226, a126
    v_accvgpr_read_b32 v227, a127
    v_mul_f32 v224, v224, v55
    v_mul_f32 v225, v225, v55
    v_mul_f32 v226, v226, v55
    v_mul_f32 v227, v227, v55
    v_accvgpr_write_b32 a124, v224
    v_accvgpr_write_b32 a125, v225
    v_accvgpr_write_b32 a126, v226
    v_accvgpr_write_b32 a127, v227
    v_exp_f32 v232, v128
    v_exp_f32 v233, v129
    v_exp_f32 v234, v130
    v_exp_f32 v235, v131
    s_nop 0
    v_cvt_pk_bf16_f32 v192, v232, v233
    v_cvt_pk_bf16_f32 v193, v234, v235
    v_exp_f32 v232, v144
    v_exp_f32 v233, v145
    v_exp_f32 v234, v146
    v_exp_f32 v235, v147
    s_nop 0
    v_cvt_pk_bf16_f32 v194, v232, v233
    v_cvt_pk_bf16_f32 v195, v234, v235
    v_exp_f32 v232, v132
    v_exp_f32 v233, v133
    v_exp_f32 v234, v134
    v_exp_f32 v235, v135
    s_nop 0
    v_cvt_pk_bf16_f32 v196, v232, v233
    v_cvt_pk_bf16_f32 v197, v234, v235
    v_exp_f32 v232, v148
    v_exp_f32 v233, v149
    v_exp_f32 v234, v150
    v_exp_f32 v235, v151
    s_nop 0
    v_cvt_pk_bf16_f32 v198, v232, v233
    v_cvt_pk_bf16_f32 v199, v234, v235
    v_exp_f32 v232, v136
    v_exp_f32 v233, v137
    v_exp_f32 v234, v138
    v_exp_f32 v235, v139
    s_nop 0
    v_cvt_pk_bf16_f32 v200, v232, v233
    v_cvt_pk_bf16_f32 v201, v234, v235
    v_exp_f32 v232, v152
    v_exp_f32 v233, v153
    v_exp_f32 v234, v154
    v_exp_f32 v235, v155
    s_nop 0
    v_cvt_pk_bf16_f32 v202, v232, v233
    v_cvt_pk_bf16_f32 v203, v234, v235
    v_exp_f32 v232, v140
    v_exp_f32 v233, v141
    v_exp_f32 v234, v142
    v_exp_f32 v235, v143
    s_nop 0
    v_cvt_pk_bf16_f32 v204, v232, v233
    v_cvt_pk_bf16_f32 v205, v234, v235
    v_exp_f32 v232, v156
    v_exp_f32 v233, v157
    v_exp_f32 v234, v158
    v_exp_f32 v235, v159
    s_nop 0
    v_cvt_pk_bf16_f32 v206, v232, v233
    v_cvt_pk_bf16_f32 v207, v234, v235
    s_nop 3
    s_setpc_b64 s[40:41]
k2_rare_159:
    s_nop 7
    v_max_f32 v52, v160, v161
    v_max3_f32 v52, v52, v162, v163
    v_max3_f32 v52, v52, v176, v177
    v_max3_f32 v52, v52, v178, v179
    v_max_f32 v53, v164, v165
    v_max3_f32 v53, v53, v166, v167
    v_max3_f32 v53, v53, v180, v181
    v_max3_f32 v53, v53, v182, v183
    v_max_f32 v54, v168, v169
    v_max3_f32 v54, v54, v170, v171
    v_max3_f32 v54, v54, v184, v185
    v_max3_f32 v54, v54, v186, v187
    v_max_f32 v55, v172, v173
    v_max3_f32 v55, v55, v174, v175
    v_max3_f32 v55, v55, v188, v189
    v_max3_f32 v55, v55, v190, v191
    v_mov_b32 v224, v52
    v_mov_b32 v225, v53
    v_mov_b32 v226, v54
    v_mov_b32 v227, v55
    s_nop 1
    v_permlane16_swap_b32 v52, v224
    v_permlane16_swap_b32 v53, v225
    v_permlane16_swap_b32 v54, v226
    v_permlane16_swap_b32 v55, v227
    s_nop 1
    v_max_f32 v52, v52, v224
    v_max_f32 v53, v53, v225
    v_max_f32 v54, v54, v226
    v_max_f32 v55, v55, v227
    v_mov_b32 v224, v52
    v_mov_b32 v225, v53
    v_mov_b32 v226, v54
    v_mov_b32 v227, v55
    s_nop 1
    v_permlane32_swap_b32 v52, v224
    v_permlane32_swap_b32 v53, v225
    v_permlane32_swap_b32 v54, v226
    v_permlane32_swap_b32 v55, v227
    s_nop 1
    v_max_f32 v52, v52, v224
    v_max_f32 v53, v53, v225
    v_max_f32 v54, v54, v226
    v_max_f32 v55, v55, v227
    v_add_f32 v52, 0x41400000, v52
    v_max_f32 v52, 0, v52
    v_add_f32 v53, 0x41400000, v53
    v_max_f32 v53, 0, v53
    v_add_f32 v54, 0x41400000, v54
    v_max_f32 v54, 0, v54
    v_add_f32 v55, 0x41400000, v55
    v_max_f32 v55, 0, v55
    v_sub_f32 v160, v160, v52
    v_sub_f32 v161, v161, v52
    v_sub_f32 v162, v162, v52
    v_sub_f32 v163, v163, v52
    v_sub_f32 v164, v164, v53
    v_sub_f32 v165, v165, v53
    v_sub_f32 v166, v166, v53
    v_sub_f32 v167, v167, v53
    v_sub_f32 v168, v168, v54
    v_sub_f32 v169, v169, v54
    v_sub_f32 v170, v170, v54
    v_sub_f32 v171, v171, v54
    v_sub_f32 v172, v172, v55
    v_sub_f32 v173, v173, v55
    v_sub_f32 v174, v174, v55
    v_sub_f32 v175, v175, v55
    v_sub_f32 v176, v176, v52
    v_sub_f32 v177, v177, v52
    v_sub_f32 v178, v178, v52
    v_sub_f32 v179, v179, v52
    v_sub_f32 v180, v180, v53
    v_sub_f32 v181, v181, v53
    v_sub_f32 v182, v182, v53
    v_sub_f32 v183, v183, v53
    v_sub_f32 v184, v184, v54
    v_sub_f32 v185, v185, v54
    v_sub_f32 v186, v186, v54
    v_sub_f32 v187, v187, v54
    v_sub_f32 v188, v188, v55
    v_sub_f32 v189, v189, v55
    v_sub_f32 v190, v190, v55
    v_sub_f32 v191, v191, v55
    v_sub_f32 v128, v128, v52
    v_sub_f32 v16, v16, v52
    v_sub_f32 v129, v129, v52
    v_sub_f32 v17, v17, v52
    v_sub_f32 v130, v130, v52
    v_sub_f32 v18, v18, v52
    v_sub_f32 v131, v131, v52
    v_sub_f32 v19, v19, v52
    v_sub_f32 v132, v132, v53
    v_sub_f32 v20, v20, v53
    v_sub_f32 v133, v133, v53
    v_sub_f32 v21, v21, v53
    v_sub_f32 v134, v134, v53
    v_sub_f32 v22, v22, v53
    v_sub_f32 v135, v135, v53
    v_sub_f32 v23, v23, v53
    v_sub_f32 v136, v136, v54
    v_sub_f32 v24, v24, v54
    v_sub_f32 v137, v137, v54
    v_sub_f32 v25, v25, v54
    v_sub_f32 v138, v138, v54
    v_sub_f32 v26, v26, v54
    v_sub_f32 v139, v139, v54
    v_sub_f32 v27, v27, v54
    v_sub_f32 v140, v140, v55
    v_sub_f32 v28, v28, v55
    v_sub_f32 v141, v141, v55
    v_sub_f32 v29, v29, v55
    v_sub_f32 v142, v142, v55
    v_sub_f32 v30, v30, v55
    v_sub_f32 v143, v143, v55
    v_sub_f32 v31, v31, v55
    v_sub_f32 v144, v144, v52
    v_sub_f32 v32, v32, v52
    v_sub_f32 v145, v145, v52
    v_sub_f32 v33, v33, v52
    v_sub_f32 v146, v146, v52
    v_sub_f32 v34, v34, v52
    v_sub_f32 v147, v147, v52
    v_sub_f32 v35, v35, v52
    v_sub_f32 v148, v148, v53
    v_sub_f32 v36, v36, v53
    v_sub_f32 v149, v149, v53
    v_sub_f32 v37, v37, v53
    v_sub_f32 v150, v150, v53
    v_sub_f32 v38, v38, v53
    v_sub_f32 v151, v151, v53
    v_sub_f32 v39, v39, v53
    v_sub_f32 v152, v152, v54
    v_sub_f32 v40, v40, v54
    v_sub_f32 v153, v153, v54
    v_sub_f32 v41, v41, v54
    v_sub_f32 v154, v154, v54
    v_sub_f32 v42, v42, v54
    v_sub_f32 v155, v155, v54
    v_sub_f32 v43, v43, v54
    v_sub_f32 v156, v156, v55
    v_sub_f32 v44, v44, v55
    v_sub_f32 v157, v157, v55
    v_sub_f32 v45, v45, v55
    v_sub_f32 v158, v158, v55
    v_sub_f32 v46, v46, v55
    v_sub_f32 v159, v159, v55
    v_sub_f32 v47, v47, v55
    v_sub_f32 v8, v8, v52
    v_exp_f32 v52, -v52
    v_sub_f32 v9, v9, v53
    v_exp_f32 v53, -v53
    v_sub_f32 v10, v10, v54
    v_exp_f32 v54, -v54
    v_sub_f32 v11, v11, v55
    v_exp_f32 v55, -v55
    s_nop 0
    v_mul_f32 v12, v12, v52
    v_mul_f32 v48, v48, v53
    v_mul_f32 v248, v248, v54
    v_mul_f32 v252, v252, v55
    v_accvgpr_read_b32 v224, a0
    v_accvgpr_read_b32 v225, a1
    v_accvgpr_read_b32 v226, a2
    v_accvgpr_read_b32 v227, a3
    v_mul_f32 v224, v224, v52
    v_mul_f32 v225, v225, v52
    v_mul_f32 v226, v226, v52
    v_mul_f32 v227, v227, v52
    v_accvgpr_write_b32 a0, v224
    v_accvgpr_write_b32 a1, v225
    v_accvgpr_write_b32 a2, v226
    v_accvgpr_write_b32 a3, v227
    v_accvgpr_read_b32 v224, a4
    v_accvgpr_read_b32 v225, a5
    v_accvgpr_read_b32 v226, a6
    v_accvgpr_read_b32 v227, a7
    v_mul_f32 v224, v224, v53
    v_mul_f32 v225, v225, v53
    v_mul_f32 v226, v226, v53
    v_mul_f32 v227, v227, v53
    v_accvgpr_write_b32 a4, v224
    v_accvgpr_write_b32 a5, v225
    v_accvgpr_write_b32 a6, v226
    v_accvgpr_write_b32 a7, v227
    v_accvgpr_read_b32 v224, a8
    v_accvgpr_read_b32 v225, a9
    v_accvgpr_read_b32 v226, a10
    v_accvgpr_read_b32 v227, a11
    v_mul_f32 v224, v224, v54
    v_mul_f32 v225, v225, v54
    v_mul_f32 v226, v226, v54
    v_mul_f32 v227, v227, v54
    v_accvgpr_write_b32 a8, v224
    v_accvgpr_write_b32 a9, v225
    v_accvgpr_write_b32 a10, v226
    v_accvgpr_write_b32 a11, v227
    v_accvgpr_read_b32 v224, a12
    v_accvgpr_read_b32 v225, a13
    v_accvgpr_read_b32 v226, a14
    v_accvgpr_read_b32 v227, a15
    v_mul_f32 v224, v224, v55
    v_mul_f32 v225, v225, v55
    v_mul_f32 v226, v226, v55
    v_mul_f32 v227, v227, v55
    v_accvgpr_write_b32 a12, v224
    v_accvgpr_write_b32 a13, v225
    v_accvgpr_write_b32 a14, v226
    v_accvgpr_write_b32 a15, v227
    v_accvgpr_read_b32 v224, a16
    v_accvgpr_read_b32 v225, a17
    v_accvgpr_read_b32 v226, a18
    v_accvgpr_read_b32 v227, a19
    v_mul_f32 v224, v224, v52
    v_mul_f32 v225, v225, v52
    v_mul_f32 v226, v226, v52
    v_mul_f32 v227, v227, v52
    v_accvgpr_write_b32 a16, v224
    v_accvgpr_write_b32 a17, v225
    v_accvgpr_write_b32 a18, v226
    v_accvgpr_write_b32 a19, v227
    v_accvgpr_read_b32 v224, a20
    v_accvgpr_read_b32 v225, a21
    v_accvgpr_read_b32 v226, a22
    v_accvgpr_read_b32 v227, a23
    v_mul_f32 v224, v224, v53
    v_mul_f32 v225, v225, v53
    v_mul_f32 v226, v226, v53
    v_mul_f32 v227, v227, v53
    v_accvgpr_write_b32 a20, v224
    v_accvgpr_write_b32 a21, v225
    v_accvgpr_write_b32 a22, v226
    v_accvgpr_write_b32 a23, v227
    v_accvgpr_read_b32 v224, a24
    v_accvgpr_read_b32 v225, a25
    v_accvgpr_read_b32 v226, a26
    v_accvgpr_read_b32 v227, a27
    v_mul_f32 v224, v224, v54
    v_mul_f32 v225, v225, v54
    v_mul_f32 v226, v226, v54
    v_mul_f32 v227, v227, v54
    v_accvgpr_write_b32 a24, v224
    v_accvgpr_write_b32 a25, v225
    v_accvgpr_write_b32 a26, v226
    v_accvgpr_write_b32 a27, v227
    v_accvgpr_read_b32 v224, a28
    v_accvgpr_read_b32 v225, a29
    v_accvgpr_read_b32 v226, a30
    v_accvgpr_read_b32 v227, a31
    v_mul_f32 v224, v224, v55
    v_mul_f32 v225, v225, v55
    v_mul_f32 v226, v226, v55
    v_mul_f32 v227, v227, v55
    v_accvgpr_write_b32 a28, v224
    v_accvgpr_write_b32 a29, v225
    v_accvgpr_write_b32 a30, v226
    v_accvgpr_write_b32 a31, v227
    v_accvgpr_read_b32 v224, a32
    v_accvgpr_read_b32 v225, a33
    v_accvgpr_read_b32 v226, a34
    v_accvgpr_read_b32 v227, a35
    v_mul_f32 v224, v224, v52
    v_mul_f32 v225, v225, v52
    v_mul_f32 v226, v226, v52
    v_mul_f32 v227, v227, v52
    v_accvgpr_write_b32 a32, v224
    v_accvgpr_write_b32 a33, v225
    v_accvgpr_write_b32 a34, v226
    v_accvgpr_write_b32 a35, v227
    v_accvgpr_read_b32 v224, a36
    v_accvgpr_read_b32 v225, a37
    v_accvgpr_read_b32 v226, a38
    v_accvgpr_read_b32 v227, a39
    v_mul_f32 v224, v224, v53
    v_mul_f32 v225, v225, v53
    v_mul_f32 v226, v226, v53
    v_mul_f32 v227, v227, v53
    v_accvgpr_write_b32 a36, v224
    v_accvgpr_write_b32 a37, v225
    v_accvgpr_write_b32 a38, v226
    v_accvgpr_write_b32 a39, v227
    v_accvgpr_read_b32 v224, a40
    v_accvgpr_read_b32 v225, a41
    v_accvgpr_read_b32 v226, a42
    v_accvgpr_read_b32 v227, a43
    v_mul_f32 v224, v224, v54
    v_mul_f32 v225, v225, v54
    v_mul_f32 v226, v226, v54
    v_mul_f32 v227, v227, v54
    v_accvgpr_write_b32 a40, v224
    v_accvgpr_write_b32 a41, v225
    v_accvgpr_write_b32 a42, v226
    v_accvgpr_write_b32 a43, v227
    v_accvgpr_read_b32 v224, a44
    v_accvgpr_read_b32 v225, a45
    v_accvgpr_read_b32 v226, a46
    v_accvgpr_read_b32 v227, a47
    v_mul_f32 v224, v224, v55
    v_mul_f32 v225, v225, v55
    v_mul_f32 v226, v226, v55
    v_mul_f32 v227, v227, v55
    v_accvgpr_write_b32 a44, v224
    v_accvgpr_write_b32 a45, v225
    v_accvgpr_write_b32 a46, v226
    v_accvgpr_write_b32 a47, v227
    v_accvgpr_read_b32 v224, a48
    v_accvgpr_read_b32 v225, a49
    v_accvgpr_read_b32 v226, a50
    v_accvgpr_read_b32 v227, a51
    v_mul_f32 v224, v224, v52
    v_mul_f32 v225, v225, v52
    v_mul_f32 v226, v226, v52
    v_mul_f32 v227, v227, v52
    v_accvgpr_write_b32 a48, v224
    v_accvgpr_write_b32 a49, v225
    v_accvgpr_write_b32 a50, v226
    v_accvgpr_write_b32 a51, v227
    v_accvgpr_read_b32 v224, a52
    v_accvgpr_read_b32 v225, a53
    v_accvgpr_read_b32 v226, a54
    v_accvgpr_read_b32 v227, a55
    v_mul_f32 v224, v224, v53
    v_mul_f32 v225, v225, v53
    v_mul_f32 v226, v226, v53
    v_mul_f32 v227, v227, v53
    v_accvgpr_write_b32 a52, v224
    v_accvgpr_write_b32 a53, v225
    v_accvgpr_write_b32 a54, v226
    v_accvgpr_write_b32 a55, v227
    v_accvgpr_read_b32 v224, a56
    v_accvgpr_read_b32 v225, a57
    v_accvgpr_read_b32 v226, a58
    v_accvgpr_read_b32 v227, a59
    v_mul_f32 v224, v224, v54
    v_mul_f32 v225, v225, v54
    v_mul_f32 v226, v226, v54
    v_mul_f32 v227, v227, v54
    v_accvgpr_write_b32 a56, v224
    v_accvgpr_write_b32 a57, v225
    v_accvgpr_write_b32 a58, v226
    v_accvgpr_write_b32 a59, v227
    v_accvgpr_read_b32 v224, a60
    v_accvgpr_read_b32 v225, a61
    v_accvgpr_read_b32 v226, a62
    v_accvgpr_read_b32 v227, a63
    v_mul_f32 v224, v224, v55
    v_mul_f32 v225, v225, v55
    v_mul_f32 v226, v226, v55
    v_mul_f32 v227, v227, v55
    v_accvgpr_write_b32 a60, v224
    v_accvgpr_write_b32 a61, v225
    v_accvgpr_write_b32 a62, v226
    v_accvgpr_write_b32 a63, v227
    v_accvgpr_read_b32 v224, a64
    v_accvgpr_read_b32 v225, a65
    v_accvgpr_read_b32 v226, a66
    v_accvgpr_read_b32 v227, a67
    v_mul_f32 v224, v224, v52
    v_mul_f32 v225, v225, v52
    v_mul_f32 v226, v226, v52
    v_mul_f32 v227, v227, v52
    v_accvgpr_write_b32 a64, v224
    v_accvgpr_write_b32 a65, v225
    v_accvgpr_write_b32 a66, v226
    v_accvgpr_write_b32 a67, v227
    v_accvgpr_read_b32 v224, a68
    v_accvgpr_read_b32 v225, a69
    v_accvgpr_read_b32 v226, a70
    v_accvgpr_read_b32 v227, a71
    v_mul_f32 v224, v224, v53
    v_mul_f32 v225, v225, v53
    v_mul_f32 v226, v226, v53
    v_mul_f32 v227, v227, v53
    v_accvgpr_write_b32 a68, v224
    v_accvgpr_write_b32 a69, v225
    v_accvgpr_write_b32 a70, v226
    v_accvgpr_write_b32 a71, v227
    v_accvgpr_read_b32 v224, a72
    v_accvgpr_read_b32 v225, a73
    v_accvgpr_read_b32 v226, a74
    v_accvgpr_read_b32 v227, a75
    v_mul_f32 v224, v224, v54
    v_mul_f32 v225, v225, v54
    v_mul_f32 v226, v226, v54
    v_mul_f32 v227, v227, v54
    v_accvgpr_write_b32 a72, v224
    v_accvgpr_write_b32 a73, v225
    v_accvgpr_write_b32 a74, v226
    v_accvgpr_write_b32 a75, v227
    v_accvgpr_read_b32 v224, a76
    v_accvgpr_read_b32 v225, a77
    v_accvgpr_read_b32 v226, a78
    v_accvgpr_read_b32 v227, a79
    v_mul_f32 v224, v224, v55
    v_mul_f32 v225, v225, v55
    v_mul_f32 v226, v226, v55
    v_mul_f32 v227, v227, v55
    v_accvgpr_write_b32 a76, v224
    v_accvgpr_write_b32 a77, v225
    v_accvgpr_write_b32 a78, v226
    v_accvgpr_write_b32 a79, v227
    v_accvgpr_read_b32 v224, a80
    v_accvgpr_read_b32 v225, a81
    v_accvgpr_read_b32 v226, a82
    v_accvgpr_read_b32 v227, a83
    v_mul_f32 v224, v224, v52
    v_mul_f32 v225, v225, v52
    v_mul_f32 v226, v226, v52
    v_mul_f32 v227, v227, v52
    v_accvgpr_write_b32 a80, v224
    v_accvgpr_write_b32 a81, v225
    v_accvgpr_write_b32 a82, v226
    v_accvgpr_write_b32 a83, v227
    v_accvgpr_read_b32 v224, a84
    v_accvgpr_read_b32 v225, a85
    v_accvgpr_read_b32 v226, a86
    v_accvgpr_read_b32 v227, a87
    v_mul_f32 v224, v224, v53
    v_mul_f32 v225, v225, v53
    v_mul_f32 v226, v226, v53
    v_mul_f32 v227, v227, v53
    v_accvgpr_write_b32 a84, v224
    v_accvgpr_write_b32 a85, v225
    v_accvgpr_write_b32 a86, v226
    v_accvgpr_write_b32 a87, v227
    v_accvgpr_read_b32 v224, a88
    v_accvgpr_read_b32 v225, a89
    v_accvgpr_read_b32 v226, a90
    v_accvgpr_read_b32 v227, a91
    v_mul_f32 v224, v224, v54
    v_mul_f32 v225, v225, v54
    v_mul_f32 v226, v226, v54
    v_mul_f32 v227, v227, v54
    v_accvgpr_write_b32 a88, v224
    v_accvgpr_write_b32 a89, v225
    v_accvgpr_write_b32 a90, v226
    v_accvgpr_write_b32 a91, v227
    v_accvgpr_read_b32 v224, a92
    v_accvgpr_read_b32 v225, a93
    v_accvgpr_read_b32 v226, a94
    v_accvgpr_read_b32 v227, a95
    v_mul_f32 v224, v224, v55
    v_mul_f32 v225, v225, v55
    v_mul_f32 v226, v226, v55
    v_mul_f32 v227, v227, v55
    v_accvgpr_write_b32 a92, v224
    v_accvgpr_write_b32 a93, v225
    v_accvgpr_write_b32 a94, v226
    v_accvgpr_write_b32 a95, v227
    v_accvgpr_read_b32 v224, a96
    v_accvgpr_read_b32 v225, a97
    v_accvgpr_read_b32 v226, a98
    v_accvgpr_read_b32 v227, a99
    v_mul_f32 v224, v224, v52
    v_mul_f32 v225, v225, v52
    v_mul_f32 v226, v226, v52
    v_mul_f32 v227, v227, v52
    v_accvgpr_write_b32 a96, v224
    v_accvgpr_write_b32 a97, v225
    v_accvgpr_write_b32 a98, v226
    v_accvgpr_write_b32 a99, v227
    v_accvgpr_read_b32 v224, a100
    v_accvgpr_read_b32 v225, a101
    v_accvgpr_read_b32 v226, a102
    v_accvgpr_read_b32 v227, a103
    v_mul_f32 v224, v224, v53
    v_mul_f32 v225, v225, v53
    v_mul_f32 v226, v226, v53
    v_mul_f32 v227, v227, v53
    v_accvgpr_write_b32 a100, v224
    v_accvgpr_write_b32 a101, v225
    v_accvgpr_write_b32 a102, v226
    v_accvgpr_write_b32 a103, v227
    v_accvgpr_read_b32 v224, a104
    v_accvgpr_read_b32 v225, a105
    v_accvgpr_read_b32 v226, a106
    v_accvgpr_read_b32 v227, a107
    v_mul_f32 v224, v224, v54
    v_mul_f32 v225, v225, v54
    v_mul_f32 v226, v226, v54
    v_mul_f32 v227, v227, v54
    v_accvgpr_write_b32 a104, v224
    v_accvgpr_write_b32 a105, v225
    v_accvgpr_write_b32 a106, v226
    v_accvgpr_write_b32 a107, v227
    v_accvgpr_read_b32 v224, a108
    v_accvgpr_read_b32 v225, a109
    v_accvgpr_read_b32 v226, a110
    v_accvgpr_read_b32 v227, a111
    v_mul_f32 v224, v224, v55
    v_mul_f32 v225, v225, v55
    v_mul_f32 v226, v226, v55
    v_mul_f32 v227, v227, v55
    v_accvgpr_write_b32 a108, v224
    v_accvgpr_write_b32 a109, v225
    v_accvgpr_write_b32 a110, v226
    v_accvgpr_write_b32 a111, v227
    v_accvgpr_read_b32 v224, a112
    v_accvgpr_read_b32 v225, a113
    v_accvgpr_read_b32 v226, a114
    v_accvgpr_read_b32 v227, a115
    v_mul_f32 v224, v224, v52
    v_mul_f32 v225, v225, v52
    v_mul_f32 v226, v226, v52
    v_mul_f32 v227, v227, v52
    v_accvgpr_write_b32 a112, v224
    v_accvgpr_write_b32 a113, v225
    v_accvgpr_write_b32 a114, v226
    v_accvgpr_write_b32 a115, v227
    v_accvgpr_read_b32 v224, a116
    v_accvgpr_read_b32 v225, a117
    v_accvgpr_read_b32 v226, a118
    v_accvgpr_read_b32 v227, a119
    v_mul_f32 v224, v224, v53
    v_mul_f32 v225, v225, v53
    v_mul_f32 v226, v226, v53
    v_mul_f32 v227, v227, v53
    v_accvgpr_write_b32 a116, v224
    v_accvgpr_write_b32 a117, v225
    v_accvgpr_write_b32 a118, v226
    v_accvgpr_write_b32 a119, v227
    v_accvgpr_read_b32 v224, a120
    v_accvgpr_read_b32 v225, a121
    v_accvgpr_read_b32 v226, a122
    v_accvgpr_read_b32 v227, a123
    v_mul_f32 v224, v224, v54
    v_mul_f32 v225, v225, v54
    v_mul_f32 v226, v226, v54
    v_mul_f32 v227, v227, v54
    v_accvgpr_write_b32 a120, v224
    v_accvgpr_write_b32 a121, v225
    v_accvgpr_write_b32 a122, v226
    v_accvgpr_write_b32 a123, v227
    v_accvgpr_read_b32 v224, a124
    v_accvgpr_read_b32 v225, a125
    v_accvgpr_read_b32 v226, a126
    v_accvgpr_read_b32 v227, a127
    v_mul_f32 v224, v224, v55
    v_mul_f32 v225, v225, v55
    v_mul_f32 v226, v226, v55
    v_mul_f32 v227, v227, v55
    v_accvgpr_write_b32 a124, v224
    v_accvgpr_write_b32 a125, v225
    v_accvgpr_write_b32 a126, v226
    v_accvgpr_write_b32 a127, v227
    v_exp_f32 v232, v160
    v_exp_f32 v233, v161
    v_exp_f32 v234, v162
    v_exp_f32 v235, v163
    s_nop 0
    v_cvt_pk_bf16_f32 v208, v232, v233
    v_cvt_pk_bf16_f32 v209, v234, v235
    v_exp_f32 v232, v176
    v_exp_f32 v233, v177
    v_exp_f32 v234, v178
    v_exp_f32 v235, v179
    s_nop 0
    v_cvt_pk_bf16_f32 v210, v232, v233
    v_cvt_pk_bf16_f32 v211, v234, v235
    v_exp_f32 v232, v164
    v_exp_f32 v233, v165
    v_exp_f32 v234, v166
    v_exp_f32 v235, v167
    s_nop 0
    v_cvt_pk_bf16_f32 v212, v232, v233
    v_cvt_pk_bf16_f32 v213, v234, v235
    v_exp_f32 v232, v180
    v_exp_f32 v233, v181
    v_exp_f32 v234, v182
    v_exp_f32 v235, v183
    s_nop 0
    v_cvt_pk_bf16_f32 v214, v232, v233
    v_cvt_pk_bf16_f32 v215, v234, v235
    v_exp_f32 v232, v168
    v_exp_f32 v233, v169
    v_exp_f32 v234, v170
    v_exp_f32 v235, v171
    s_nop 0
    v_cvt_pk_bf16_f32 v216, v232, v233
    v_cvt_pk_bf16_f32 v217, v234, v235
    v_exp_f32 v232, v184
    v_exp_f32 v233, v185
    v_exp_f32 v234, v186
    v_exp_f32 v235, v187
    s_nop 0
    v_cvt_pk_bf16_f32 v218, v232, v233
    v_cvt_pk_bf16_f32 v219, v234, v235
    v_exp_f32 v232, v172
    v_exp_f32 v233, v173
    v_exp_f32 v234, v174
    v_exp_f32 v235, v175
    s_nop 0
    v_cvt_pk_bf16_f32 v220, v232, v233
    v_cvt_pk_bf16_f32 v221, v234, v235
    v_exp_f32 v232, v188
    v_exp_f32 v233, v189
    v_exp_f32 v234, v190
    v_exp_f32 v235, v191
    s_nop 0
    v_cvt_pk_bf16_f32 v222, v232, v233
    v_cvt_pk_bf16_f32 v223, v234, v235
    s_nop 3
    s_setpc_b64 s[40:41]
k2_rare_164:
    s_nop 7
    v_max_f32 v53, v132, v133
    v_max3_f32 v53, v53, v134, v135
    v_max3_f32 v53, v53, v148, v149
    v_max3_f32 v53, v53, v150, v151
    v_max_f32 v54, v136, v137
    v_max3_f32 v54, v54, v138, v139
    v_max3_f32 v54, v54, v152, v153
    v_max3_f32 v54, v54, v154, v155
    v_max_f32 v55, v140, v141
    v_max3_f32 v55, v55, v142, v143
    v_max3_f32 v55, v55, v156, v157
    v_max3_f32 v55, v55, v158, v159
    v_mov_b32 v225, v53
    v_mov_b32 v226, v54
    v_mov_b32 v227, v55
    s_nop 1
    v_permlane16_swap_b32 v53, v225
    v_permlane16_swap_b32 v54, v226
    v_permlane16_swap_b32 v55, v227
    s_nop 1
    v_max_f32 v53, v53, v225
    v_max_f32 v54, v54, v226
    v_max_f32 v55, v55, v227
    v_mov_b32 v225, v53
    v_mov_b32 v226, v54
    v_mov_b32 v227, v55
    s_nop 1
    v_permlane32_swap_b32 v53, v225
    v_permlane32_swap_b32 v54, v226
    v_permlane32_swap_b32 v55, v227
    s_nop 1
    v_max_f32 v53, v53, v225
    v_max_f32 v54, v54, v226
    v_max_f32 v55, v55, v227
    v_add_f32 v53, 0x41400000, v53
    v_max_f32 v53, 0, v53
    v_add_f32 v54, 0x41400000, v54
    v_max_f32 v54, 0, v54
    v_add_f32 v55, 0x41400000, v55
    v_max_f32 v55, 0, v55
    v_sub_f32 v132, v132, v53
    v_sub_f32 v133, v133, v53
    v_sub_f32 v134, v134, v53
    v_sub_f32 v135, v135, v53
    v_sub_f32 v136, v136, v54
    v_sub_f32 v137, v137, v54
    v_sub_f32 v138, v138, v54
    v_sub_f32 v139, v139, v54
    v_sub_f32 v140, v140, v55
    v_sub_f32 v141, v141, v55
    v_sub_f32 v142, v142, v55
    v_sub_f32 v143, v143, v55
    v_sub_f32 v148, v148, v53
    v_sub_f32 v149, v149, v53
    v_sub_f32 v150, v150, v53
    v_sub_f32 v151, v151, v53
    v_sub_f32 v152, v152, v54
    v_sub_f32 v153, v153, v54
    v_sub_f32 v154, v154, v54
    v_sub_f32 v155, v155, v54
    v_sub_f32 v156, v156, v55
    v_sub_f32 v157, v157, v55
    v_sub_f32 v158, v158, v55
    v_sub_f32 v159, v159, v55
    v_sub_f32 v164, v164, v53
    v_sub_f32 v20, v20, v53
    v_sub_f32 v165, v165, v53
    v_sub_f32 v21, v21, v53
    v_sub_f32 v166, v166, v53
    v_sub_f32 v22, v22, v53
    v_sub_f32 v167, v167, v53
    v_sub_f32 v23, v23, v53
    v_sub_f32 v168, v168, v54
    v_sub_f32 v24, v24, v54
    v_sub_f32 v169, v169, v54
    v_sub_f32 v25, v25, v54
    v_sub_f32 v170, v170, v54
    v_sub_f32 v26, v26, v54
    v_sub_f32 v171, v171, v54
    v_sub_f32 v27, v27, v54
    v_sub_f32 v172, v172, v55
    v_sub_f32 v28, v28, v55
    v_sub_f32 v173, v173, v55
    v_sub_f32 v29, v29, v55
    v_sub_f32 v174, v174, v55
    v_sub_f32 v30, v30, v55
    v_sub_f32 v175, v175, v55
    v_sub_f32 v31, v31, v55
    v_sub_f32 v180, v180, v53
    v_sub_f32 v36, v36, v53
    v_sub_f32 v181, v181, v53
    v_sub_f32 v37, v37, v53
    v_sub_f32 v182, v182, v53
    v_sub_f32 v38, v38, v53
    v_sub_f32 v183, v183, v53
    v_sub_f32 v39, v39, v53
    v_sub_f32 v184, v184, v54
    v_sub_f32 v40, v40, v54
    v_sub_f32 v185, v185, v54
    v_sub_f32 v41, v41, v54
    v_sub_f32 v186, v186, v54
    v_sub_f32 v42, v42, v54
    v_sub_f32 v187, v187, v54
    v_sub_f32 v43, v43, v54
    v_sub_f32 v188, v188, v55
    v_sub_f32 v44, v44, v55
    v_sub_f32 v189, v189, v55
    v_sub_f32 v45, v45, v55
    v_sub_f32 v190, v190, v55
    v_sub_f32 v46, v46, v55
    v_sub_f32 v191, v191, v55
    v_sub_f32 v47, v47, v55
    v_sub_f32 v9, v9, v53
    v_exp_f32 v53, -v53
    v_sub_f32 v10, v10, v54
    v_exp_f32 v54, -v54
    v_sub_f32 v11, v11, v55
    v_exp_f32 v55, -v55
    s_nop 0
    v_mul_f32 v48, v48, v53
    v_mul_f32 v248, v248, v54
    v_mul_f32 v252, v252, v55
    v_accvgpr_read_b32 v224, a4
    v_accvgpr_read_b32 v225, a5
    v_accvgpr_read_b32 v226, a6
    v_accvgpr_read_b32 v227, a7
    v_mul_f32 v224, v224, v53
    v_mul_f32 v225, v225, v53
    v_mul_f32 v226, v226, v53
    v_mul_f32 v227, v227, v53
    v_accvgpr_write_b32 a4, v224
    v_accvgpr_write_b32 a5, v225
    v_accvgpr_write_b32 a6, v226
    v_accvgpr_write_b32 a7, v227
    v_accvgpr_read_b32 v224, a8
    v_accvgpr_read_b32 v225, a9
    v_accvgpr_read_b32 v226, a10
    v_accvgpr_read_b32 v227, a11
    v_mul_f32 v224, v224, v54
    v_mul_f32 v225, v225, v54
    v_mul_f32 v226, v226, v54
    v_mul_f32 v227, v227, v54
    v_accvgpr_write_b32 a8, v224
    v_accvgpr_write_b32 a9, v225
    v_accvgpr_write_b32 a10, v226
    v_accvgpr_write_b32 a11, v227
    v_accvgpr_read_b32 v224, a12
    v_accvgpr_read_b32 v225, a13
    v_accvgpr_read_b32 v226, a14
    v_accvgpr_read_b32 v227, a15
    v_mul_f32 v224, v224, v55
    v_mul_f32 v225, v225, v55
    v_mul_f32 v226, v226, v55
    v_mul_f32 v227, v227, v55
    v_accvgpr_write_b32 a12, v224
    v_accvgpr_write_b32 a13, v225
    v_accvgpr_write_b32 a14, v226
    v_accvgpr_write_b32 a15, v227
    v_accvgpr_read_b32 v224, a20
    v_accvgpr_read_b32 v225, a21
    v_accvgpr_read_b32 v226, a22
    v_accvgpr_read_b32 v227, a23
    v_mul_f32 v224, v224, v53
    v_mul_f32 v225, v225, v53
    v_mul_f32 v226, v226, v53
    v_mul_f32 v227, v227, v53
    v_accvgpr_write_b32 a20, v224
    v_accvgpr_write_b32 a21, v225
    v_accvgpr_write_b32 a22, v226
    v_accvgpr_write_b32 a23, v227
    v_accvgpr_read_b32 v224, a24
    v_accvgpr_read_b32 v225, a25
    v_accvgpr_read_b32 v226, a26
    v_accvgpr_read_b32 v227, a27
    v_mul_f32 v224, v224, v54
    v_mul_f32 v225, v225, v54
    v_mul_f32 v226, v226, v54
    v_mul_f32 v227, v227, v54
    v_accvgpr_write_b32 a24, v224
    v_accvgpr_write_b32 a25, v225
    v_accvgpr_write_b32 a26, v226
    v_accvgpr_write_b32 a27, v227
    v_accvgpr_read_b32 v224, a28
    v_accvgpr_read_b32 v225, a29
    v_accvgpr_read_b32 v226, a30
    v_accvgpr_read_b32 v227, a31
    v_mul_f32 v224, v224, v55
    v_mul_f32 v225, v225, v55
    v_mul_f32 v226, v226, v55
    v_mul_f32 v227, v227, v55
    v_accvgpr_write_b32 a28, v224
    v_accvgpr_write_b32 a29, v225
    v_accvgpr_write_b32 a30, v226
    v_accvgpr_write_b32 a31, v227
    v_accvgpr_read_b32 v224, a36
    v_accvgpr_read_b32 v225, a37
    v_accvgpr_read_b32 v226, a38
    v_accvgpr_read_b32 v227, a39
    v_mul_f32 v224, v224, v53
    v_mul_f32 v225, v225, v53
    v_mul_f32 v226, v226, v53
    v_mul_f32 v227, v227, v53
    v_accvgpr_write_b32 a36, v224
    v_accvgpr_write_b32 a37, v225
    v_accvgpr_write_b32 a38, v226
    v_accvgpr_write_b32 a39, v227
    v_accvgpr_read_b32 v224, a40
    v_accvgpr_read_b32 v225, a41
    v_accvgpr_read_b32 v226, a42
    v_accvgpr_read_b32 v227, a43
    v_mul_f32 v224, v224, v54
    v_mul_f32 v225, v225, v54
    v_mul_f32 v226, v226, v54
    v_mul_f32 v227, v227, v54
    v_accvgpr_write_b32 a40, v224
    v_accvgpr_write_b32 a41, v225
    v_accvgpr_write_b32 a42, v226
    v_accvgpr_write_b32 a43, v227
    v_accvgpr_read_b32 v224, a44
    v_accvgpr_read_b32 v225, a45
    v_accvgpr_read_b32 v226, a46
    v_accvgpr_read_b32 v227, a47
    v_mul_f32 v224, v224, v55
    v_mul_f32 v225, v225, v55
    v_mul_f32 v226, v226, v55
    v_mul_f32 v227, v227, v55
    v_accvgpr_write_b32 a44, v224
    v_accvgpr_write_b32 a45, v225
    v_accvgpr_write_b32 a46, v226
    v_accvgpr_write_b32 a47, v227
    v_accvgpr_read_b32 v224, a52
    v_accvgpr_read_b32 v225, a53
    v_accvgpr_read_b32 v226, a54
    v_accvgpr_read_b32 v227, a55
    v_mul_f32 v224, v224, v53
    v_mul_f32 v225, v225, v53
    v_mul_f32 v226, v226, v53
    v_mul_f32 v227, v227, v53
    v_accvgpr_write_b32 a52, v224
    v_accvgpr_write_b32 a53, v225
    v_accvgpr_write_b32 a54, v226
    v_accvgpr_write_b32 a55, v227
    v_accvgpr_read_b32 v224, a56
    v_accvgpr_read_b32 v225, a57
    v_accvgpr_read_b32 v226, a58
    v_accvgpr_read_b32 v227, a59
    v_mul_f32 v224, v224, v54
    v_mul_f32 v225, v225, v54
    v_mul_f32 v226, v226, v54
    v_mul_f32 v227, v227, v54
    v_accvgpr_write_b32 a56, v224
    v_accvgpr_write_b32 a57, v225
    v_accvgpr_write_b32 a58, v226
    v_accvgpr_write_b32 a59, v227
    v_accvgpr_read_b32 v224, a60
    v_accvgpr_read_b32 v225, a61
    v_accvgpr_read_b32 v226, a62
    v_accvgpr_read_b32 v227, a63
    v_mul_f32 v224, v224, v55
    v_mul_f32 v225, v225, v55
    v_mul_f32 v226, v226, v55
    v_mul_f32 v227, v227, v55
    v_accvgpr_write_b32 a60, v224
    v_accvgpr_write_b32 a61, v225
    v_accvgpr_write_b32 a62, v226
    v_accvgpr_write_b32 a63, v227
    v_accvgpr_read_b32 v224, a68
    v_accvgpr_read_b32 v225, a69
    v_accvgpr_read_b32 v226, a70
    v_accvgpr_read_b32 v227, a71
    v_mul_f32 v224, v224, v53
    v_mul_f32 v225, v225, v53
    v_mul_f32 v226, v226, v53
    v_mul_f32 v227, v227, v53
    v_accvgpr_write_b32 a68, v224
    v_accvgpr_write_b32 a69, v225
    v_accvgpr_write_b32 a70, v226
    v_accvgpr_write_b32 a71, v227
    v_accvgpr_read_b32 v224, a72
    v_accvgpr_read_b32 v225, a73
    v_accvgpr_read_b32 v226, a74
    v_accvgpr_read_b32 v227, a75
    v_mul_f32 v224, v224, v54
    v_mul_f32 v225, v225, v54
    v_mul_f32 v226, v226, v54
    v_mul_f32 v227, v227, v54
    v_accvgpr_write_b32 a72, v224
    v_accvgpr_write_b32 a73, v225
    v_accvgpr_write_b32 a74, v226
    v_accvgpr_write_b32 a75, v227
    v_accvgpr_read_b32 v224, a76
    v_accvgpr_read_b32 v225, a77
    v_accvgpr_read_b32 v226, a78
    v_accvgpr_read_b32 v227, a79
    v_mul_f32 v224, v224, v55
    v_mul_f32 v225, v225, v55
    v_mul_f32 v226, v226, v55
    v_mul_f32 v227, v227, v55
    v_accvgpr_write_b32 a76, v224
    v_accvgpr_write_b32 a77, v225
    v_accvgpr_write_b32 a78, v226
    v_accvgpr_write_b32 a79, v227
    v_accvgpr_read_b32 v224, a84
    v_accvgpr_read_b32 v225, a85
    v_accvgpr_read_b32 v226, a86
    v_accvgpr_read_b32 v227, a87
    v_mul_f32 v224, v224, v53
    v_mul_f32 v225, v225, v53
    v_mul_f32 v226, v226, v53
    v_mul_f32 v227, v227, v53
    v_accvgpr_write_b32 a84, v224
    v_accvgpr_write_b32 a85, v225
    v_accvgpr_write_b32 a86, v226
    v_accvgpr_write_b32 a87, v227
    v_accvgpr_read_b32 v224, a88
    v_accvgpr_read_b32 v225, a89
    v_accvgpr_read_b32 v226, a90
    v_accvgpr_read_b32 v227, a91
    v_mul_f32 v224, v224, v54
    v_mul_f32 v225, v225, v54
    v_mul_f32 v226, v226, v54
    v_mul_f32 v227, v227, v54
    v_accvgpr_write_b32 a88, v224
    v_accvgpr_write_b32 a89, v225
    v_accvgpr_write_b32 a90, v226
    v_accvgpr_write_b32 a91, v227
    v_accvgpr_read_b32 v224, a92
    v_accvgpr_read_b32 v225, a93
    v_accvgpr_read_b32 v226, a94
    v_accvgpr_read_b32 v227, a95
    v_mul_f32 v224, v224, v55
    v_mul_f32 v225, v225, v55
    v_mul_f32 v226, v226, v55
    v_mul_f32 v227, v227, v55
    v_accvgpr_write_b32 a92, v224
    v_accvgpr_write_b32 a93, v225
    v_accvgpr_write_b32 a94, v226
    v_accvgpr_write_b32 a95, v227
    v_accvgpr_read_b32 v224, a100
    v_accvgpr_read_b32 v225, a101
    v_accvgpr_read_b32 v226, a102
    v_accvgpr_read_b32 v227, a103
    v_mul_f32 v224, v224, v53
    v_mul_f32 v225, v225, v53
    v_mul_f32 v226, v226, v53
    v_mul_f32 v227, v227, v53
    v_accvgpr_write_b32 a100, v224
    v_accvgpr_write_b32 a101, v225
    v_accvgpr_write_b32 a102, v226
    v_accvgpr_write_b32 a103, v227
    v_accvgpr_read_b32 v224, a104
    v_accvgpr_read_b32 v225, a105
    v_accvgpr_read_b32 v226, a106
    v_accvgpr_read_b32 v227, a107
    v_mul_f32 v224, v224, v54
    v_mul_f32 v225, v225, v54
    v_mul_f32 v226, v226, v54
    v_mul_f32 v227, v227, v54
    v_accvgpr_write_b32 a104, v224
    v_accvgpr_write_b32 a105, v225
    v_accvgpr_write_b32 a106, v226
    v_accvgpr_write_b32 a107, v227
    v_accvgpr_read_b32 v224, a108
    v_accvgpr_read_b32 v225, a109
    v_accvgpr_read_b32 v226, a110
    v_accvgpr_read_b32 v227, a111
    v_mul_f32 v224, v224, v55
    v_mul_f32 v225, v225, v55
    v_mul_f32 v226, v226, v55
    v_mul_f32 v227, v227, v55
    v_accvgpr_write_b32 a108, v224
    v_accvgpr_write_b32 a109, v225
    v_accvgpr_write_b32 a110, v226
    v_accvgpr_write_b32 a111, v227
    v_accvgpr_read_b32 v224, a116
    v_accvgpr_read_b32 v225, a117
    v_accvgpr_read_b32 v226, a118
    v_accvgpr_read_b32 v227, a119
    v_mul_f32 v224, v224, v53
    v_mul_f32 v225, v225, v53
    v_mul_f32 v226, v226, v53
    v_mul_f32 v227, v227, v53
    v_accvgpr_write_b32 a116, v224
    v_accvgpr_write_b32 a117, v225
    v_accvgpr_write_b32 a118, v226
    v_accvgpr_write_b32 a119, v227
    v_accvgpr_read_b32 v224, a120
    v_accvgpr_read_b32 v225, a121
    v_accvgpr_read_b32 v226, a122
    v_accvgpr_read_b32 v227, a123
    v_mul_f32 v224, v224, v54
    v_mul_f32 v225, v225, v54
    v_mul_f32 v226, v226, v54
    v_mul_f32 v227, v227, v54
    v_accvgpr_write_b32 a120, v224
    v_accvgpr_write_b32 a121, v225
    v_accvgpr_write_b32 a122, v226
    v_accvgpr_write_b32 a123, v227
    v_accvgpr_read_b32 v224, a124
    v_accvgpr_read_b32 v225, a125
    v_accvgpr_read_b32 v226, a126
    v_accvgpr_read_b32 v227, a127
    v_mul_f32 v224, v224, v55
    v_mul_f32 v225, v225, v55
    v_mul_f32 v226, v226, v55
    v_mul_f32 v227, v227, v55
    v_accvgpr_write_b32 a124, v224
    v_accvgpr_write_b32 a125, v225
    v_accvgpr_write_b32 a126, v226
    v_accvgpr_write_b32 a127, v227
    v_exp_f32 v232, v132
    v_exp_f32 v233, v133
    v_exp_f32 v234, v134
    v_exp_f32 v235, v135
    s_nop 0
    v_cvt_pk_bf16_f32 v196, v232, v233
    v_cvt_pk_bf16_f32 v197, v234, v235
    v_exp_f32 v232, v148
    v_exp_f32 v233, v149
    v_exp_f32 v234, v150
    v_exp_f32 v235, v151
    s_nop 0
    v_cvt_pk_bf16_f32 v198, v232, v233
    v_cvt_pk_bf16_f32 v199, v234, v235
    v_exp_f32 v232, v136
    v_exp_f32 v233, v137
    v_exp_f32 v234, v138
    v_exp_f32 v235, v139
    s_nop 0
    v_cvt_pk_bf16_f32 v200, v232, v233
    v_cvt_pk_bf16_f32 v201, v234, v235
    v_exp_f32 v232, v152
    v_exp_f32 v233, v153
    v_exp_f32 v234, v154
    v_exp_f32 v235, v155
    s_nop 0
    v_cvt_pk_bf16_f32 v202, v232, v233
    v_cvt_pk_bf16_f32 v203, v234, v235
    v_exp_f32 v232, v140
    v_exp_f32 v233, v141
    v_exp_f32 v234, v142
    v_exp_f32 v235, v143
    s_nop 0
    v_cvt_pk_bf16_f32 v204, v232, v233
    v_cvt_pk_bf16_f32 v205, v234, v235
    v_exp_f32 v232, v156
    v_exp_f32 v233, v157
    v_exp_f32 v234, v158
    v_exp_f32 v235, v159
    s_nop 0
    v_cvt_pk_bf16_f32 v206, v232, v233
    v_cvt_pk_bf16_f32 v207, v234, v235
    s_nop 3
    s_setpc_b64 s[40:41]
k2_rare_165:
    s_nop 7
    v_max_f32 v53, v164, v165
    v_max3_f32 v53, v53, v166, v167
    v_max3_f32 v53, v53, v180, v181
    v_max3_f32 v53, v53, v182, v183
    v_max_f32 v54, v168, v169
    v_max3_f32 v54, v54, v170, v171
    v_max3_f32 v54, v54, v184, v185
    v_max3_f32 v54, v54, v186, v187
    v_max_f32 v55, v172, v173
    v_max3_f32 v55, v55, v174, v175
    v_max3_f32 v55, v55, v188, v189
    v_max3_f32 v55, v55, v190, v191
    v_mov_b32 v225, v53
    v_mov_b32 v226, v54
    v_mov_b32 v227, v55
    s_nop 1
    v_permlane16_swap_b32 v53, v225
    v_permlane16_swap_b32 v54, v226
    v_permlane16_swap_b32 v55, v227
    s_nop 1
    v_max_f32 v53, v53, v225
    v_max_f32 v54, v54, v226
    v_max_f32 v55, v55, v227
    v_mov_b32 v225, v53
    v_mov_b32 v226, v54
    v_mov_b32 v227, v55
    s_nop 1
    v_permlane32_swap_b32 v53, v225
    v_permlane32_swap_b32 v54, v226
    v_permlane32_swap_b32 v55, v227
    s_nop 1
    v_max_f32 v53, v53, v225
    v_max_f32 v54, v54, v226
    v_max_f32 v55, v55, v227
    v_add_f32 v53, 0x41400000, v53
    v_max_f32 v53, 0, v53
    v_add_f32 v54, 0x41400000, v54
    v_max_f32 v54, 0, v54
    v_add_f32 v55, 0x41400000, v55
    v_max_f32 v55, 0, v55
    v_sub_f32 v164, v164, v53
    v_sub_f32 v165, v165, v53
    v_sub_f32 v166, v166, v53
    v_sub_f32 v167, v167, v53
    v_sub_f32 v168, v168, v54
    v_sub_f32 v169, v169, v54
    v_sub_f32 v170, v170, v54
    v_sub_f32 v171, v171, v54
    v_sub_f32 v172, v172, v55
    v_sub_f32 v173, v173, v55
    v_sub_f32 v174, v174, v55
    v_sub_f32 v175, v175, v55
    v_sub_f32 v180, v180, v53
    v_sub_f32 v181, v181, v53
    v_sub_f32 v182, v182, v53
    v_sub_f32 v183, v183, v53
    v_sub_f32 v184, v184, v54
    v_sub_f32 v185, v185, v54
    v_sub_f32 v186, v186, v54
    v_sub_f32 v187, v187, v54
    v_sub_f32 v188, v188, v55
    v_sub_f32 v189, v189, v55
    v_sub_f32 v190, v190, v55
    v_sub_f32 v191, v191, v55
    v_sub_f32 v128, v128, v54
    v_sub_f32 v16, v16, v54
    v_sub_f32 v129, v129, v54
    v_sub_f32 v17, v17, v54
    v_sub_f32 v130, v130, v54
    v_sub_f32 v18, v18, v54
    v_sub_f32 v131, v131, v54
    v_sub_f32 v19, v19, v54
    v_sub_f32 v132, v132, v55
    v_sub_f32 v20, v20, v55
    v_sub_f32 v133, v133, v55
    v_sub_f32 v21, v21, v55
    v_sub_f32 v134, v134, v55
    v_sub_f32 v22, v22, v55
    v_sub_f32 v135, v135, v55
    v_sub_f32 v23, v23, v55
    v_sub_f32 v136, v136, v54
    v_sub_f32 v24, v24, v54
    v_sub_f32 v137, v137, v54
    v_sub_f32 v25, v25, v54
    v_sub_f32 v138, v138, v54
    v_sub_f32 v26, v26, v54
    v_sub_f32 v139, v139, v54
    v_sub_f32 v27, v27, v54
    v_sub_f32 v140, v140, v55
    v_sub_f32 v28, v28, v55
    v_sub_f32 v141, v141, v55
    v_sub_f32 v29, v29, v55
    v_sub_f32 v142, v142, v55
    v_sub_f32 v30, v30, v55
    v_sub_f32 v143, v143, v55
    v_sub_f32 v31, v31, v55
    v_sub_f32 v144, v144, v54
    v_sub_f32 v32, v32, v54
    v_sub_f32 v145, v145, v54
    v_sub_f32 v33, v33, v54
    v_sub_f32 v146, v146, v54
    v_sub_f32 v34, v34, v54
    v_sub_f32 v147, v147, v54
    v_sub_f32 v35, v35, v54
    v_sub_f32 v148, v148, v55
    v_sub_f32 v36, v36, v55
    v_sub_f32 v149, v149, v55
    v_sub_f32 v37, v37, v55
    v_sub_f32 v150, v150, v55
    v_sub_f32 v38, v38, v55
    v_sub_f32 v151, v151, v55
    v_sub_f32 v39, v39, v55
    v_sub_f32 v152, v152, v54
    v_sub_f32 v40, v40, v54
    v_sub_f32 v153, v153, v54
    v_sub_f32 v41, v41, v54
    v_sub_f32 v154, v154, v54
    v_sub_f32 v42, v42, v54
    v_sub_f32 v155, v155, v54
    v_sub_f32 v43, v43, v54
    v_sub_f32 v156, v156, v55
    v_sub_f32 v44, v44, v55
    v_sub_f32 v157, v157, v55
    v_sub_f32 v45, v45, v55
    v_sub_f32 v158, v158, v55
    v_sub_f32 v46, v46, v55
    v_sub_f32 v159, v159, v55
    v_sub_f32 v47, v47, v55
    v_sub_f32 v9, v9, v53
    v_exp_f32 v53, -v53
    v_sub_f32 v10, v10, v54
    v_exp_f32 v54, -v54
    v_sub_f32 v11, v11, v55
    v_exp_f32 v55, -v55
    s_nop 0
    v_mul_f32 v48, v48, v53
    v_mul_f32 v248, v248, v54
    v_mul_f32 v252, v252, v55
    v_accvgpr_read_b32 v224, a4
    v_accvgpr_read_b32 v225, a5
    v_accvgpr_read_b32 v226, a6
    v_accvgpr_read_b32 v227, a7
    v_mul_f32 v224, v224, v53
    v_mul_f32 v225, v225, v53
    v_mul_f32 v226, v226, v53
    v_mul_f32 v227, v227, v53
    v_accvgpr_write_b32 a4, v224
    v_accvgpr_write_b32 a5, v225
    v_accvgpr_write_b32 a6, v226
    v_accvgpr_write_b32 a7, v227
    v_accvgpr_read_b32 v224, a8
    v_accvgpr_read_b32 v225, a9
    v_accvgpr_read_b32 v226, a10
    v_accvgpr_read_b32 v227, a11
    v_mul_f32 v224, v224, v54
    v_mul_f32 v225, v225, v54
    v_mul_f32 v226, v226, v54
    v_mul_f32 v227, v227, v54
    v_accvgpr_write_b32 a8, v224
    v_accvgpr_write_b32 a9, v225
    v_accvgpr_write_b32 a10, v226
    v_accvgpr_write_b32 a11, v227
    v_accvgpr_read_b32 v224, a12
    v_accvgpr_read_b32 v225, a13
    v_accvgpr_read_b32 v226, a14
    v_accvgpr_read_b32 v227, a15
    v_mul_f32 v224, v224, v55
    v_mul_f32 v225, v225, v55
    v_mul_f32 v226, v226, v55
    v_mul_f32 v227, v227, v55
    v_accvgpr_write_b32 a12, v224
    v_accvgpr_write_b32 a13, v225
    v_accvgpr_write_b32 a14, v226
    v_accvgpr_write_b32 a15, v227
    v_accvgpr_read_b32 v224, a20
    v_accvgpr_read_b32 v225, a21
    v_accvgpr_read_b32 v226, a22
    v_accvgpr_read_b32 v227, a23
    v_mul_f32 v224, v224, v53
    v_mul_f32 v225, v225, v53
    v_mul_f32 v226, v226, v53
    v_mul_f32 v227, v227, v53
    v_accvgpr_write_b32 a20, v224
    v_accvgpr_write_b32 a21, v225
    v_accvgpr_write_b32 a22, v226
    v_accvgpr_write_b32 a23, v227
    v_accvgpr_read_b32 v224, a24
    v_accvgpr_read_b32 v225, a25
    v_accvgpr_read_b32 v226, a26
    v_accvgpr_read_b32 v227, a27
    v_mul_f32 v224, v224, v54
    v_mul_f32 v225, v225, v54
    v_mul_f32 v226, v226, v54
    v_mul_f32 v227, v227, v54
    v_accvgpr_write_b32 a24, v224
    v_accvgpr_write_b32 a25, v225
    v_accvgpr_write_b32 a26, v226
    v_accvgpr_write_b32 a27, v227
    v_accvgpr_read_b32 v224, a28
    v_accvgpr_read_b32 v225, a29
    v_accvgpr_read_b32 v226, a30
    v_accvgpr_read_b32 v227, a31
    v_mul_f32 v224, v224, v55
    v_mul_f32 v225, v225, v55
    v_mul_f32 v226, v226, v55
    v_mul_f32 v227, v227, v55
    v_accvgpr_write_b32 a28, v224
    v_accvgpr_write_b32 a29, v225
    v_accvgpr_write_b32 a30, v226
    v_accvgpr_write_b32 a31, v227
    v_accvgpr_read_b32 v224, a36
    v_accvgpr_read_b32 v225, a37
    v_accvgpr_read_b32 v226, a38
    v_accvgpr_read_b32 v227, a39
    v_mul_f32 v224, v224, v53
    v_mul_f32 v225, v225, v53
    v_mul_f32 v226, v226, v53
    v_mul_f32 v227, v227, v53
    v_accvgpr_write_b32 a36, v224
    v_accvgpr_write_b32 a37, v225
    v_accvgpr_write_b32 a38, v226
    v_accvgpr_write_b32 a39, v227
    v_accvgpr_read_b32 v224, a40
    v_accvgpr_read_b32 v225, a41
    v_accvgpr_read_b32 v226, a42
    v_accvgpr_read_b32 v227, a43
    v_mul_f32 v224, v224, v54
    v_mul_f32 v225, v225, v54
    v_mul_f32 v226, v226, v54
    v_mul_f32 v227, v227, v54
    v_accvgpr_write_b32 a40, v224
    v_accvgpr_write_b32 a41, v225
    v_accvgpr_write_b32 a42, v226
    v_accvgpr_write_b32 a43, v227
    v_accvgpr_read_b32 v224, a44
    v_accvgpr_read_b32 v225, a45
    v_accvgpr_read_b32 v226, a46
    v_accvgpr_read_b32 v227, a47
    v_mul_f32 v224, v224, v55
    v_mul_f32 v225, v225, v55
    v_mul_f32 v226, v226, v55
    v_mul_f32 v227, v227, v55
    v_accvgpr_write_b32 a44, v224
    v_accvgpr_write_b32 a45, v225
    v_accvgpr_write_b32 a46, v226
    v_accvgpr_write_b32 a47, v227
    v_accvgpr_read_b32 v224, a52
    v_accvgpr_read_b32 v225, a53
    v_accvgpr_read_b32 v226, a54
    v_accvgpr_read_b32 v227, a55
    v_mul_f32 v224, v224, v53
    v_mul_f32 v225, v225, v53
    v_mul_f32 v226, v226, v53
    v_mul_f32 v227, v227, v53
    v_accvgpr_write_b32 a52, v224
    v_accvgpr_write_b32 a53, v225
    v_accvgpr_write_b32 a54, v226
    v_accvgpr_write_b32 a55, v227
    v_accvgpr_read_b32 v224, a56
    v_accvgpr_read_b32 v225, a57
    v_accvgpr_read_b32 v226, a58
    v_accvgpr_read_b32 v227, a59
    v_mul_f32 v224, v224, v54
    v_mul_f32 v225, v225, v54
    v_mul_f32 v226, v226, v54
    v_mul_f32 v227, v227, v54
    v_accvgpr_write_b32 a56, v224
    v_accvgpr_write_b32 a57, v225
    v_accvgpr_write_b32 a58, v226
    v_accvgpr_write_b32 a59, v227
    v_accvgpr_read_b32 v224, a60
    v_accvgpr_read_b32 v225, a61
    v_accvgpr_read_b32 v226, a62
    v_accvgpr_read_b32 v227, a63
    v_mul_f32 v224, v224, v55
    v_mul_f32 v225, v225, v55
    v_mul_f32 v226, v226, v55
    v_mul_f32 v227, v227, v55
    v_accvgpr_write_b32 a60, v224
    v_accvgpr_write_b32 a61, v225
    v_accvgpr_write_b32 a62, v226
    v_accvgpr_write_b32 a63, v227
    v_accvgpr_read_b32 v224, a68
    v_accvgpr_read_b32 v225, a69
    v_accvgpr_read_b32 v226, a70
    v_accvgpr_read_b32 v227, a71
    v_mul_f32 v224, v224, v53
    v_mul_f32 v225, v225, v53
    v_mul_f32 v226, v226, v53
    v_mul_f32 v227, v227, v53
    v_accvgpr_write_b32 a68, v224
    v_accvgpr_write_b32 a69, v225
    v_accvgpr_write_b32 a70, v226
    v_accvgpr_write_b32 a71, v227
    v_accvgpr_read_b32 v224, a72
    v_accvgpr_read_b32 v225, a73
    v_accvgpr_read_b32 v226, a74
    v_accvgpr_read_b32 v227, a75
    v_mul_f32 v224, v224, v54
    v_mul_f32 v225, v225, v54
    v_mul_f32 v226, v226, v54
    v_mul_f32 v227, v227, v54
    v_accvgpr_write_b32 a72, v224
    v_accvgpr_write_b32 a73, v225
    v_accvgpr_write_b32 a74, v226
    v_accvgpr_write_b32 a75, v227
    v_accvgpr_read_b32 v224, a76
    v_accvgpr_read_b32 v225, a77
    v_accvgpr_read_b32 v226, a78
    v_accvgpr_read_b32 v227, a79
    v_mul_f32 v224, v224, v55
    v_mul_f32 v225, v225, v55
    v_mul_f32 v226, v226, v55
    v_mul_f32 v227, v227, v55
    v_accvgpr_write_b32 a76, v224
    v_accvgpr_write_b32 a77, v225
    v_accvgpr_write_b32 a78, v226
    v_accvgpr_write_b32 a79, v227
    v_accvgpr_read_b32 v224, a84
    v_accvgpr_read_b32 v225, a85
    v_accvgpr_read_b32 v226, a86
    v_accvgpr_read_b32 v227, a87
    v_mul_f32 v224, v224, v53
    v_mul_f32 v225, v225, v53
    v_mul_f32 v226, v226, v53
    v_mul_f32 v227, v227, v53
    v_accvgpr_write_b32 a84, v224
    v_accvgpr_write_b32 a85, v225
    v_accvgpr_write_b32 a86, v226
    v_accvgpr_write_b32 a87, v227
    v_accvgpr_read_b32 v224, a88
    v_accvgpr_read_b32 v225, a89
    v_accvgpr_read_b32 v226, a90
    v_accvgpr_read_b32 v227, a91
    v_mul_f32 v224, v224, v54
    v_mul_f32 v225, v225, v54
    v_mul_f32 v226, v226, v54
    v_mul_f32 v227, v227, v54
    v_accvgpr_write_b32 a88, v224
    v_accvgpr_write_b32 a89, v225
    v_accvgpr_write_b32 a90, v226
    v_accvgpr_write_b32 a91, v227
    v_accvgpr_read_b32 v224, a92
    v_accvgpr_read_b32 v225, a93
    v_accvgpr_read_b32 v226, a94
    v_accvgpr_read_b32 v227, a95
    v_mul_f32 v224, v224, v55
    v_mul_f32 v225, v225, v55
    v_mul_f32 v226, v226, v55
    v_mul_f32 v227, v227, v55
    v_accvgpr_write_b32 a92, v224
    v_accvgpr_write_b32 a93, v225
    v_accvgpr_write_b32 a94, v226
    v_accvgpr_write_b32 a95, v227
    v_accvgpr_read_b32 v224, a100
    v_accvgpr_read_b32 v225, a101
    v_accvgpr_read_b32 v226, a102
    v_accvgpr_read_b32 v227, a103
    v_mul_f32 v224, v224, v53
    v_mul_f32 v225, v225, v53
    v_mul_f32 v226, v226, v53
    v_mul_f32 v227, v227, v53
    v_accvgpr_write_b32 a100, v224
    v_accvgpr_write_b32 a101, v225
    v_accvgpr_write_b32 a102, v226
    v_accvgpr_write_b32 a103, v227
    v_accvgpr_read_b32 v224, a104
    v_accvgpr_read_b32 v225, a105
    v_accvgpr_read_b32 v226, a106
    v_accvgpr_read_b32 v227, a107
    v_mul_f32 v224, v224, v54
    v_mul_f32 v225, v225, v54
    v_mul_f32 v226, v226, v54
    v_mul_f32 v227, v227, v54
    v_accvgpr_write_b32 a104, v224
    v_accvgpr_write_b32 a105, v225
    v_accvgpr_write_b32 a106, v226
    v_accvgpr_write_b32 a107, v227
    v_accvgpr_read_b32 v224, a108
    v_accvgpr_read_b32 v225, a109
    v_accvgpr_read_b32 v226, a110
    v_accvgpr_read_b32 v227, a111
    v_mul_f32 v224, v224, v55
    v_mul_f32 v225, v225, v55
    v_mul_f32 v226, v226, v55
    v_mul_f32 v227, v227, v55
    v_accvgpr_write_b32 a108, v224
    v_accvgpr_write_b32 a109, v225
    v_accvgpr_write_b32 a110, v226
    v_accvgpr_write_b32 a111, v227
    v_accvgpr_read_b32 v224, a116
    v_accvgpr_read_b32 v225, a117
    v_accvgpr_read_b32 v226, a118
    v_accvgpr_read_b32 v227, a119
    v_mul_f32 v224, v224, v53
    v_mul_f32 v225, v225, v53
    v_mul_f32 v226, v226, v53
    v_mul_f32 v227, v227, v53
    v_accvgpr_write_b32 a116, v224
    v_accvgpr_write_b32 a117, v225
    v_accvgpr_write_b32 a118, v226
    v_accvgpr_write_b32 a119, v227
    v_accvgpr_read_b32 v224, a120
    v_accvgpr_read_b32 v225, a121
    v_accvgpr_read_b32 v226, a122
    v_accvgpr_read_b32 v227, a123
    v_mul_f32 v224, v224, v54
    v_mul_f32 v225, v225, v54
    v_mul_f32 v226, v226, v54
    v_mul_f32 v227, v227, v54
    v_accvgpr_write_b32 a120, v224
    v_accvgpr_write_b32 a121, v225
    v_accvgpr_write_b32 a122, v226
    v_accvgpr_write_b32 a123, v227
    v_accvgpr_read_b32 v224, a124
    v_accvgpr_read_b32 v225, a125
    v_accvgpr_read_b32 v226, a126
    v_accvgpr_read_b32 v227, a127
    v_mul_f32 v224, v224, v55
    v_mul_f32 v225, v225, v55
    v_mul_f32 v226, v226, v55
    v_mul_f32 v227, v227, v55
    v_accvgpr_write_b32 a124, v224
    v_accvgpr_write_b32 a125, v225
    v_accvgpr_write_b32 a126, v226
    v_accvgpr_write_b32 a127, v227
    v_exp_f32 v232, v164
    v_exp_f32 v233, v165
    v_exp_f32 v234, v166
    v_exp_f32 v235, v167
    s_nop 0
    v_cvt_pk_bf16_f32 v212, v232, v233
    v_cvt_pk_bf16_f32 v213, v234, v235
    v_exp_f32 v232, v180
    v_exp_f32 v233, v181
    v_exp_f32 v234, v182
    v_exp_f32 v235, v183
    s_nop 0
    v_cvt_pk_bf16_f32 v214, v232, v233
    v_cvt_pk_bf16_f32 v215, v234, v235
    v_exp_f32 v232, v168
    v_exp_f32 v233, v169
    v_exp_f32 v234, v170
    v_exp_f32 v235, v171
    s_nop 0
    v_cvt_pk_bf16_f32 v216, v232, v233
    v_cvt_pk_bf16_f32 v217, v234, v235
    v_exp_f32 v232, v184
    v_exp_f32 v233, v185
    v_exp_f32 v234, v186
    v_exp_f32 v235, v187
    s_nop 0
    v_cvt_pk_bf16_f32 v218, v232, v233
    v_cvt_pk_bf16_f32 v219, v234, v235
    v_exp_f32 v232, v172
    v_exp_f32 v233, v173
    v_exp_f32 v234, v174
    v_exp_f32 v235, v175
    s_nop 0
    v_cvt_pk_bf16_f32 v220, v232, v233
    v_cvt_pk_bf16_f32 v221, v234, v235
    v_exp_f32 v232, v188
    v_exp_f32 v233, v189
    v_exp_f32 v234, v190
    v_exp_f32 v235, v191
    s_nop 0
    v_cvt_pk_bf16_f32 v222, v232, v233
    v_cvt_pk_bf16_f32 v223, v234, v235
    s_nop 3
    s_setpc_b64 s[40:41]
k2_rare_166:
    s_nop 7
    v_max_f32 v54, v128, v129
    v_max3_f32 v54, v54, v130, v131
    v_max3_f32 v54, v54, v144, v145
    v_max3_f32 v54, v54, v146, v147
    v_max3_f32 v54, v54, v136, v137
    v_max3_f32 v54, v54, v138, v139
    v_max3_f32 v54, v54, v152, v153
    v_max3_f32 v54, v54, v154, v155
    v_max_f32 v55, v132, v133
    v_max3_f32 v55, v55, v134, v135
    v_max3_f32 v55, v55, v148, v149
    v_max3_f32 v55, v55, v150, v151
    v_max3_f32 v55, v55, v140, v141
    v_max3_f32 v55, v55, v142, v143
    v_max3_f32 v55, v55, v156, v157
    v_max3_f32 v55, v55, v158, v159
    v_mov_b32 v226, v54
    v_mov_b32 v227, v55
    s_nop 1
    v_permlane16_swap_b32 v54, v226
    v_permlane16_swap_b32 v55, v227
    s_nop 1
    v_max_f32 v54, v54, v226
    v_max_f32 v55, v55, v227
    v_mov_b32 v226, v54
    v_mov_b32 v227, v55
    s_nop 1
    v_permlane32_swap_b32 v54, v226
    v_permlane32_swap_b32 v55, v227
    s_nop 1
    v_max_f32 v54, v54, v226
    v_max_f32 v55, v55, v227
    v_add_f32 v54, 0x41400000, v54
    v_max_f32 v54, 0, v54
    v_add_f32 v55, 0x41400000, v55
    v_max_f32 v55, 0, v55
    v_sub_f32 v128, v128, v54
    v_sub_f32 v129, v129, v54
    v_sub_f32 v130, v130, v54
    v_sub_f32 v131, v131, v54
    v_sub_f32 v132, v132, v55
    v_sub_f32 v133, v133, v55
    v_sub_f32 v134, v134, v55
    v_sub_f32 v135, v135, v55
    v_sub_f32 v136, v136, v54
    v_sub_f32 v137, v137, v54
    v_sub_f32 v138, v138, v54
    v_sub_f32 v139, v139, v54
    v_sub_f32 v140, v140, v55
    v_sub_f32 v141, v141, v55
    v_sub_f32 v142, v142, v55
    v_sub_f32 v143, v143, v55
    v_sub_f32 v144, v144, v54
    v_sub_f32 v145, v145, v54
    v_sub_f32 v146, v146, v54
    v_sub_f32 v147, v147, v54
    v_sub_f32 v148, v148, v55
    v_sub_f32 v149, v149, v55
    v_sub_f32 v150, v150, v55
    v_sub_f32 v151, v151, v55
    v_sub_f32 v152, v152, v54
    v_sub_f32 v153, v153, v54
    v_sub_f32 v154, v154, v54
    v_sub_f32 v155, v155, v54
    v_sub_f32 v156, v156, v55
    v_sub_f32 v157, v157, v55
    v_sub_f32 v158, v158, v55
    v_sub_f32 v159, v159, v55
    v_sub_f32 v160, v160, v54
    v_sub_f32 v16, v16, v54
    v_sub_f32 v161, v161, v54
    v_sub_f32 v17, v17, v54
    v_sub_f32 v162, v162, v54
    v_sub_f32 v18, v18, v54
    v_sub_f32 v163, v163, v54
    v_sub_f32 v19, v19, v54
    v_sub_f32 v164, v164, v55
    v_sub_f32 v20, v20, v55
    v_sub_f32 v165, v165, v55
    v_sub_f32 v21, v21, v55
    v_sub_f32 v166, v166, v55
    v_sub_f32 v22, v22, v55
    v_sub_f32 v167, v167, v55
    v_sub_f32 v23, v23, v55
    v_sub_f32 v168, v168, v54
    v_sub_f32 v24, v24, v54
    v_sub_f32 v169, v169, v54
    v_sub_f32 v25, v25, v54
    v_sub_f32 v170, v170, v54
    v_sub_f32 v26, v26, v54
    v_sub_f32 v171, v171, v54
    v_sub_f32 v27, v27, v54
    v_sub_f32 v172, v172, v55
    v_sub_f32 v28, v28, v55
    v_sub_f32 v173, v173, v55
    v_sub_f32 v29, v29, v55
    v_sub_f32 v174, v174, v55
    v_sub_f32 v30, v30, v55
    v_sub_f32 v175, v175, v55
    v_sub_f32 v31, v31, v55
    v_sub_f32 v176, v176, v54
    v_sub_f32 v32, v32, v54
    v_sub_f32 v177, v177, v54
    v_sub_f32 v33, v33, v54
    v_sub_f32 v178, v178, v54
    v_sub_f32 v34, v34, v54
    v_sub_f32 v179, v179, v54
    v_sub_f32 v35, v35, v54
    v_sub_f32 v180, v180, v55
    v_sub_f32 v36, v36, v55
    v_sub_f32 v181, v181, v55
    v_sub_f32 v37, v37, v55
    v_sub_f32 v182, v182, v55
    v_sub_f32 v38, v38, v55
    v_sub_f32 v183, v183, v55
    v_sub_f32 v39, v39, v55
    v_sub_f32 v184, v184, v54
    v_sub_f32 v40, v40, v54
    v_sub_f32 v185, v185, v54
    v_sub_f32 v41, v41, v54
    v_sub_f32 v186, v186, v54
    v_sub_f32 v42, v42, v54
    v_sub_f32 v187, v187, v54
    v_sub_f32 v43, v43, v54
    v_sub_f32 v188, v188, v55
    v_sub_f32 v44, v44, v55
    v_sub_f32 v189, v189, v55
    v_sub_f32 v45, v45, v55
    v_sub_f32 v190, v190, v55
    v_sub_f32 v46, v46, v55
    v_sub_f32 v191, v191, v55
    v_sub_f32 v47, v47, v55
    v_sub_f32 v10, v10, v54
    v_exp_f32 v54, -v54
    v_sub_f32 v11, v11, v55
    v_exp_f32 v55, -v55
    s_nop 0
    v_mul_f32 v248, v248, v54
    v_mul_f32 v252, v252, v55
    v_accvgpr_read_b32 v224, a8
    v_accvgpr_read_b32 v225, a9
    v_accvgpr_read_b32 v226, a10
    v_accvgpr_read_b32 v227, a11
    v_mul_f32 v224, v224, v54
    v_mul_f32 v225, v225, v54
    v_mul_f32 v226, v226, v54
    v_mul_f32 v227, v227, v54
    v_accvgpr_write_b32 a8, v224
    v_accvgpr_write_b32 a9, v225
    v_accvgpr_write_b32 a10, v226
    v_accvgpr_write_b32 a11, v227
    v_accvgpr_read_b32 v224, a12
    v_accvgpr_read_b32 v225, a13
    v_accvgpr_read_b32 v226, a14
    v_accvgpr_read_b32 v227, a15
    v_mul_f32 v224, v224, v55
    v_mul_f32 v225, v225, v55
    v_mul_f32 v226, v226, v55
    v_mul_f32 v227, v227, v55
    v_accvgpr_write_b32 a12, v224
    v_accvgpr_write_b32 a13, v225
    v_accvgpr_write_b32 a14, v226
    v_accvgpr_write_b32 a15, v227
    v_accvgpr_read_b32 v224, a24
    v_accvgpr_read_b32 v225, a25
    v_accvgpr_read_b32 v226, a26
    v_accvgpr_read_b32 v227, a27
    v_mul_f32 v224, v224, v54
    v_mul_f32 v225, v225, v54
    v_mul_f32 v226, v226, v54
    v_mul_f32 v227, v227, v54
    v_accvgpr_write_b32 a24, v224
    v_accvgpr_write_b32 a25, v225
    v_accvgpr_write_b32 a26, v226
    v_accvgpr_write_b32 a27, v227
    v_accvgpr_read_b32 v224, a28
    v_accvgpr_read_b32 v225, a29
    v_accvgpr_read_b32 v226, a30
    v_accvgpr_read_b32 v227, a31
    v_mul_f32 v224, v224, v55
    v_mul_f32 v225, v225, v55
    v_mul_f32 v226, v226, v55
    v_mul_f32 v227, v227, v55
    v_accvgpr_write_b32 a28, v224
    v_accvgpr_write_b32 a29, v225
    v_accvgpr_write_b32 a30, v226
    v_accvgpr_write_b32 a31, v227
    v_accvgpr_read_b32 v224, a40
    v_accvgpr_read_b32 v225, a41
    v_accvgpr_read_b32 v226, a42
    v_accvgpr_read_b32 v227, a43
    v_mul_f32 v224, v224, v54
    v_mul_f32 v225, v225, v54
    v_mul_f32 v226, v226, v54
    v_mul_f32 v227, v227, v54
    v_accvgpr_write_b32 a40, v224
    v_accvgpr_write_b32 a41, v225
    v_accvgpr_write_b32 a42, v226
    v_accvgpr_write_b32 a43, v227
    v_accvgpr_read_b32 v224, a44
    v_accvgpr_read_b32 v225, a45
    v_accvgpr_read_b32 v226, a46
    v_accvgpr_read_b32 v227, a47
    v_mul_f32 v224, v224, v55
    v_mul_f32 v225, v225, v55
    v_mul_f32 v226, v226, v55
    v_mul_f32 v227, v227, v55
    v_accvgpr_write_b32 a44, v224
    v_accvgpr_write_b32 a45, v225
    v_accvgpr_write_b32 a46, v226
    v_accvgpr_write_b32 a47, v227
    v_accvgpr_read_b32 v224, a56
    v_accvgpr_read_b32 v225, a57
    v_accvgpr_read_b32 v226, a58
    v_accvgpr_read_b32 v227, a59
    v_mul_f32 v224, v224, v54
    v_mul_f32 v225, v225, v54
    v_mul_f32 v226, v226, v54
    v_mul_f32 v227, v227, v54
    v_accvgpr_write_b32 a56, v224
    v_accvgpr_write_b32 a57, v225
    v_accvgpr_write_b32 a58, v226
    v_accvgpr_write_b32 a59, v227
    v_accvgpr_read_b32 v224, a60
    v_accvgpr_read_b32 v225, a61
    v_accvgpr_read_b32 v226, a62
    v_accvgpr_read_b32 v227, a63
    v_mul_f32 v224, v224, v55
    v_mul_f32 v225, v225, v55
    v_mul_f32 v226, v226, v55
    v_mul_f32 v227, v227, v55
    v_accvgpr_write_b32 a60, v224
    v_accvgpr_write_b32 a61, v225
    v_accvgpr_write_b32 a62, v226
    v_accvgpr_write_b32 a63, v227
    v_accvgpr_read_b32 v224, a72
    v_accvgpr_read_b32 v225, a73
    v_accvgpr_read_b32 v226, a74
    v_accvgpr_read_b32 v227, a75
    v_mul_f32 v224, v224, v54
    v_mul_f32 v225, v225, v54
    v_mul_f32 v226, v226, v54
    v_mul_f32 v227, v227, v54
    v_accvgpr_write_b32 a72, v224
    v_accvgpr_write_b32 a73, v225
    v_accvgpr_write_b32 a74, v226
    v_accvgpr_write_b32 a75, v227
    v_accvgpr_read_b32 v224, a76
    v_accvgpr_read_b32 v225, a77
    v_accvgpr_read_b32 v226, a78
    v_accvgpr_read_b32 v227, a79
    v_mul_f32 v224, v224, v55
    v_mul_f32 v225, v225, v55
    v_mul_f32 v226, v226, v55
    v_mul_f32 v227, v227, v55
    v_accvgpr_write_b32 a76, v224
    v_accvgpr_write_b32 a77, v225
    v_accvgpr_write_b32 a78, v226
    v_accvgpr_write_b32 a79, v227
    v_accvgpr_read_b32 v224, a88
    v_accvgpr_read_b32 v225, a89
    v_accvgpr_read_b32 v226, a90
    v_accvgpr_read_b32 v227, a91
    v_mul_f32 v224, v224, v54
    v_mul_f32 v225, v225, v54
    v_mul_f32 v226, v226, v54
    v_mul_f32 v227, v227, v54
    v_accvgpr_write_b32 a88, v224
    v_accvgpr_write_b32 a89, v225
    v_accvgpr_write_b32 a90, v226
    v_accvgpr_write_b32 a91, v227
    v_accvgpr_read_b32 v224, a92
    v_accvgpr_read_b32 v225, a93
    v_accvgpr_read_b32 v226, a94
    v_accvgpr_read_b32 v227, a95
    v_mul_f32 v224, v224, v55
    v_mul_f32 v225, v225, v55
    v_mul_f32 v226, v226, v55
    v_mul_f32 v227, v227, v55
    v_accvgpr_write_b32 a92, v224
    v_accvgpr_write_b32 a93, v225
    v_accvgpr_write_b32 a94, v226
    v_accvgpr_write_b32 a95, v227
    v_accvgpr_read_b32 v224, a104
    v_accvgpr_read_b32 v225, a105
    v_accvgpr_read_b32 v226, a106
    v_accvgpr_read_b32 v227, a107
    v_mul_f32 v224, v224, v54
    v_mul_f32 v225, v225, v54
    v_mul_f32 v226, v226, v54
    v_mul_f32 v227, v227, v54
    v_accvgpr_write_b32 a104, v224
    v_accvgpr_write_b32 a105, v225
    v_accvgpr_write_b32 a106, v226
    v_accvgpr_write_b32 a107, v227
    v_accvgpr_read_b32 v224, a108
    v_accvgpr_read_b32 v225, a109
    v_accvgpr_read_b32 v226, a110
    v_accvgpr_read_b32 v227, a111
    v_mul_f32 v224, v224, v55
    v_mul_f32 v225, v225, v55
    v_mul_f32 v226, v226, v55
    v_mul_f32 v227, v227, v55
    v_accvgpr_write_b32 a108, v224
    v_accvgpr_write_b32 a109, v225
    v_accvgpr_write_b32 a110, v226
    v_accvgpr_write_b32 a111, v227
    v_accvgpr_read_b32 v224, a120
    v_accvgpr_read_b32 v225, a121
    v_accvgpr_read_b32 v226, a122
    v_accvgpr_read_b32 v227, a123
    v_mul_f32 v224, v224, v54
    v_mul_f32 v225, v225, v54
    v_mul_f32 v226, v226, v54
    v_mul_f32 v227, v227, v54
    v_accvgpr_write_b32 a120, v224
    v_accvgpr_write_b32 a121, v225
    v_accvgpr_write_b32 a122, v226
    v_accvgpr_write_b32 a123, v227
    v_accvgpr_read_b32 v224, a124
    v_accvgpr_read_b32 v225, a125
    v_accvgpr_read_b32 v226, a126
    v_accvgpr_read_b32 v227, a127
    v_mul_f32 v224, v224, v55
    v_mul_f32 v225, v225, v55
    v_mul_f32 v226, v226, v55
    v_mul_f32 v227, v227, v55
    v_accvgpr_write_b32 a124, v224
    v_accvgpr_write_b32 a125, v225
    v_accvgpr_write_b32 a126, v226
    v_accvgpr_write_b32 a127, v227
    v_exp_f32 v232, v128
    v_exp_f32 v233, v129
    v_exp_f32 v234, v130
    v_exp_f32 v235, v131
    s_nop 0
    v_cvt_pk_bf16_f32 v192, v232, v233
    v_cvt_pk_bf16_f32 v193, v234, v235
    v_exp_f32 v232, v144
    v_exp_f32 v233, v145
    v_exp_f32 v234, v146
    v_exp_f32 v235, v147
    s_nop 0
    v_cvt_pk_bf16_f32 v194, v232, v233
    v_cvt_pk_bf16_f32 v195, v234, v235
    v_exp_f32 v232, v132
    v_exp_f32 v233, v133
    v_exp_f32 v234, v134
    v_exp_f32 v235, v135
    s_nop 0
    v_cvt_pk_bf16_f32 v196, v232, v233
    v_cvt_pk_bf16_f32 v197, v234, v235
    v_exp_f32 v232, v148
    v_exp_f32 v233, v149
    v_exp_f32 v234, v150
    v_exp_f32 v235, v151
    s_nop 0
    v_cvt_pk_bf16_f32 v198, v232, v233
    v_cvt_pk_bf16_f32 v199, v234, v235
    v_exp_f32 v232, v136
    v_exp_f32 v233, v137
    v_exp_f32 v234, v138
    v_exp_f32 v235, v139
    s_nop 0
    v_cvt_pk_bf16_f32 v200, v232, v233
    v_cvt_pk_bf16_f32 v201, v234, v235
    v_exp_f32 v232, v152
    v_exp_f32 v233, v153
    v_exp_f32 v234, v154
    v_exp_f32 v235, v155
    s_nop 0
    v_cvt_pk_bf16_f32 v202, v232, v233
    v_cvt_pk_bf16_f32 v203, v234, v235
    v_exp_f32 v232, v140
    v_exp_f32 v233, v141
    v_exp_f32 v234, v142
    v_exp_f32 v235, v143
    s_nop 0
    v_cvt_pk_bf16_f32 v204, v232, v233
    v_cvt_pk_bf16_f32 v205, v234, v235
    v_exp_f32 v232, v156
    v_exp_f32 v233, v157
    v_exp_f32 v234, v158
    v_exp_f32 v235, v159
    s_nop 0
    v_cvt_pk_bf16_f32 v206, v232, v233
    v_cvt_pk_bf16_f32 v207, v234, v235
    s_nop 3
    s_setpc_b64 s[40:41]
k2_rare_167:
    s_nop 7
    v_max_f32 v54, v160, v161
    v_max3_f32 v54, v54, v162, v163
    v_max3_f32 v54, v54, v176, v177
    v_max3_f32 v54, v54, v178, v179
    v_max3_f32 v54, v54, v168, v169
    v_max3_f32 v54, v54, v170, v171
    v_max3_f32 v54, v54, v184, v185
    v_max3_f32 v54, v54, v186, v187
    v_max_f32 v55, v164, v165
    v_max3_f32 v55, v55, v166, v167
    v_max3_f32 v55, v55, v180, v181
    v_max3_f32 v55, v55, v182, v183
    v_max3_f32 v55, v55, v172, v173
    v_max3_f32 v55, v55, v174, v175
    v_max3_f32 v55, v55, v188, v189
    v_max3_f32 v55, v55, v190, v191
    v_mov_b32 v226, v54
    v_mov_b32 v227, v55
    s_nop 1
    v_permlane16_swap_b32 v54, v226
    v_permlane16_swap_b32 v55, v227
    s_nop 1
    v_max_f32 v54, v54, v226
    v_max_f32 v55, v55, v227
    v_mov_b32 v226, v54
    v_mov_b32 v227, v55
    s_nop 1
    v_permlane32_swap_b32 v54, v226
    v_permlane32_swap_b32 v55, v227
    s_nop 1
    v_max_f32 v54, v54, v226
    v_max_f32 v55, v55, v227
    v_add_f32 v54, 0x41400000, v54
    v_max_f32 v54, 0, v54
    v_add_f32 v55, 0x41400000, v55
    v_max_f32 v55, 0, v55
    v_sub_f32 v160, v160, v54
    v_sub_f32 v161, v161, v54
    v_sub_f32 v162, v162, v54
    v_sub_f32 v163, v163, v54
    v_sub_f32 v164, v164, v55
    v_sub_f32 v165, v165, v55
    v_sub_f32 v166, v166, v55
    v_sub_f32 v167, v167, v55
    v_sub_f32 v168, v168, v54
    v_sub_f32 v169, v169, v54
    v_sub_f32 v170, v170, v54
    v_sub_f32 v171, v171, v54
    v_sub_f32 v172, v172, v55
    v_sub_f32 v173, v173, v55
    v_sub_f32 v174, v174, v55
    v_sub_f32 v175, v175, v55
    v_sub_f32 v176, v176, v54
    v_sub_f32 v177, v177, v54
    v_sub_f32 v178, v178, v54
    v_sub_f32 v179, v179, v54
    v_sub_f32 v180, v180, v55
    v_sub_f32 v181, v181, v55
    v_sub_f32 v182, v182, v55
    v_sub_f32 v183, v183, v55
    v_sub_f32 v184, v184, v54
    v_sub_f32 v185, v185, v54
    v_sub_f32 v186, v186, v54
    v_sub_f32 v187, v187, v54
    v_sub_f32 v188, v188, v55
    v_sub_f32 v189, v189, v55
    v_sub_f32 v190, v190, v55
    v_sub_f32 v191, v191, v55
    v_sub_f32 v128, v128, v54
    v_sub_f32 v16, v16, v54
    v_sub_f32 v129, v129, v54
    v_sub_f32 v17, v17, v54
    v_sub_f32 v130, v130, v54
    v_sub_f32 v18, v18, v54
    v_sub_f32 v131, v131, v54
    v_sub_f32 v19, v19, v54
    v_sub_f32 v132, v132, v55
    v_sub_f32 v20, v20, v55
    v_sub_f32 v133, v133, v55
    v_sub_f32 v21, v21, v55
    v_sub_f32 v134, v134, v55
    v_sub_f32 v22, v22, v55
    v_sub_f32 v135, v135, v55
    v_sub_f32 v23, v23, v55
    v_sub_f32 v136, v136, v54
    v_sub_f32 v24, v24, v54
    v_sub_f32 v137, v137, v54
    v_sub_f32 v25, v25, v54
    v_sub_f32 v138, v138, v54
    v_sub_f32 v26, v26, v54
    v_sub_f32 v139, v139, v54
    v_sub_f32 v27, v27, v54
    v_sub_f32 v140, v140, v55
    v_sub_f32 v28, v28, v55
    v_sub_f32 v141, v141, v55
    v_sub_f32 v29, v29, v55
    v_sub_f32 v142, v142, v55
    v_sub_f32 v30, v30, v55
    v_sub_f32 v143, v143, v55
    v_sub_f32 v31, v31, v55
    v_sub_f32 v144, v144, v54
    v_sub_f32 v32, v32, v54
    v_sub_f32 v145, v145, v54
    v_sub_f32 v33, v33, v54
    v_sub_f32 v146, v146, v54
    v_sub_f32 v34, v34, v54
    v_sub_f32 v147, v147, v54
    v_sub_f32 v35, v35, v54
    v_sub_f32 v148, v148, v55
    v_sub_f32 v36, v36, v55
    v_sub_f32 v149, v149, v55
    v_sub_f32 v37, v37, v55
    v_sub_f32 v150, v150, v55
    v_sub_f32 v38, v38, v55
    v_sub_f32 v151, v151, v55
    v_sub_f32 v39, v39, v55
    v_sub_f32 v152, v152, v54
    v_sub_f32 v40, v40, v54
    v_sub_f32 v153, v153, v54
    v_sub_f32 v41, v41, v54
    v_sub_f32 v154, v154, v54
    v_sub_f32 v42, v42, v54
    v_sub_f32 v155, v155, v54
    v_sub_f32 v43, v43, v54
    v_sub_f32 v156, v156, v55
    v_sub_f32 v44, v44, v55
    v_sub_f32 v157, v157, v55
    v_sub_f32 v45, v45, v55
    v_sub_f32 v158, v158, v55
    v_sub_f32 v46, v46, v55
    v_sub_f32 v159, v159, v55
    v_sub_f32 v47, v47, v55
    v_sub_f32 v10, v10, v54
    v_exp_f32 v54, -v54
    v_sub_f32 v11, v11, v55
    v_exp_f32 v55, -v55
    s_nop 0
    v_mul_f32 v248, v248, v54
    v_mul_f32 v252, v252, v55
    v_accvgpr_read_b32 v224, a8
    v_accvgpr_read_b32 v225, a9
    v_accvgpr_read_b32 v226, a10
    v_accvgpr_read_b32 v227, a11
    v_mul_f32 v224, v224, v54
    v_mul_f32 v225, v225, v54
    v_mul_f32 v226, v226, v54
    v_mul_f32 v227, v227, v54
    v_accvgpr_write_b32 a8, v224
    v_accvgpr_write_b32 a9, v225
    v_accvgpr_write_b32 a10, v226
    v_accvgpr_write_b32 a11, v227
    v_accvgpr_read_b32 v224, a12
    v_accvgpr_read_b32 v225, a13
    v_accvgpr_read_b32 v226, a14
    v_accvgpr_read_b32 v227, a15
    v_mul_f32 v224, v224, v55
    v_mul_f32 v225, v225, v55
    v_mul_f32 v226, v226, v55
    v_mul_f32 v227, v227, v55
    v_accvgpr_write_b32 a12, v224
    v_accvgpr_write_b32 a13, v225
    v_accvgpr_write_b32 a14, v226
    v_accvgpr_write_b32 a15, v227
    v_accvgpr_read_b32 v224, a24
    v_accvgpr_read_b32 v225, a25
    v_accvgpr_read_b32 v226, a26
    v_accvgpr_read_b32 v227, a27
    v_mul_f32 v224, v224, v54
    v_mul_f32 v225, v225, v54
    v_mul_f32 v226, v226, v54
    v_mul_f32 v227, v227, v54
    v_accvgpr_write_b32 a24, v224
    v_accvgpr_write_b32 a25, v225
    v_accvgpr_write_b32 a26, v226
    v_accvgpr_write_b32 a27, v227
    v_accvgpr_read_b32 v224, a28
    v_accvgpr_read_b32 v225, a29
    v_accvgpr_read_b32 v226, a30
    v_accvgpr_read_b32 v227, a31
    v_mul_f32 v224, v224, v55
    v_mul_f32 v225, v225, v55
    v_mul_f32 v226, v226, v55
    v_mul_f32 v227, v227, v55
    v_accvgpr_write_b32 a28, v224
    v_accvgpr_write_b32 a29, v225
    v_accvgpr_write_b32 a30, v226
    v_accvgpr_write_b32 a31, v227
    v_accvgpr_read_b32 v224, a40
    v_accvgpr_read_b32 v225, a41
    v_accvgpr_read_b32 v226, a42
    v_accvgpr_read_b32 v227, a43
    v_mul_f32 v224, v224, v54
    v_mul_f32 v225, v225, v54
    v_mul_f32 v226, v226, v54
    v_mul_f32 v227, v227, v54
    v_accvgpr_write_b32 a40, v224
    v_accvgpr_write_b32 a41, v225
    v_accvgpr_write_b32 a42, v226
    v_accvgpr_write_b32 a43, v227
    v_accvgpr_read_b32 v224, a44
    v_accvgpr_read_b32 v225, a45
    v_accvgpr_read_b32 v226, a46
    v_accvgpr_read_b32 v227, a47
    v_mul_f32 v224, v224, v55
    v_mul_f32 v225, v225, v55
    v_mul_f32 v226, v226, v55
    v_mul_f32 v227, v227, v55
    v_accvgpr_write_b32 a44, v224
    v_accvgpr_write_b32 a45, v225
    v_accvgpr_write_b32 a46, v226
    v_accvgpr_write_b32 a47, v227
    v_accvgpr_read_b32 v224, a56
    v_accvgpr_read_b32 v225, a57
    v_accvgpr_read_b32 v226, a58
    v_accvgpr_read_b32 v227, a59
    v_mul_f32 v224, v224, v54
    v_mul_f32 v225, v225, v54
    v_mul_f32 v226, v226, v54
    v_mul_f32 v227, v227, v54
    v_accvgpr_write_b32 a56, v224
    v_accvgpr_write_b32 a57, v225
    v_accvgpr_write_b32 a58, v226
    v_accvgpr_write_b32 a59, v227
    v_accvgpr_read_b32 v224, a60
    v_accvgpr_read_b32 v225, a61
    v_accvgpr_read_b32 v226, a62
    v_accvgpr_read_b32 v227, a63
    v_mul_f32 v224, v224, v55
    v_mul_f32 v225, v225, v55
    v_mul_f32 v226, v226, v55
    v_mul_f32 v227, v227, v55
    v_accvgpr_write_b32 a60, v224
    v_accvgpr_write_b32 a61, v225
    v_accvgpr_write_b32 a62, v226
    v_accvgpr_write_b32 a63, v227
    v_accvgpr_read_b32 v224, a72
    v_accvgpr_read_b32 v225, a73
    v_accvgpr_read_b32 v226, a74
    v_accvgpr_read_b32 v227, a75
    v_mul_f32 v224, v224, v54
    v_mul_f32 v225, v225, v54
    v_mul_f32 v226, v226, v54
    v_mul_f32 v227, v227, v54
    v_accvgpr_write_b32 a72, v224
    v_accvgpr_write_b32 a73, v225
    v_accvgpr_write_b32 a74, v226
    v_accvgpr_write_b32 a75, v227
    v_accvgpr_read_b32 v224, a76
    v_accvgpr_read_b32 v225, a77
    v_accvgpr_read_b32 v226, a78
    v_accvgpr_read_b32 v227, a79
    v_mul_f32 v224, v224, v55
    v_mul_f32 v225, v225, v55
    v_mul_f32 v226, v226, v55
    v_mul_f32 v227, v227, v55
    v_accvgpr_write_b32 a76, v224
    v_accvgpr_write_b32 a77, v225
    v_accvgpr_write_b32 a78, v226
    v_accvgpr_write_b32 a79, v227
    v_accvgpr_read_b32 v224, a88
    v_accvgpr_read_b32 v225, a89
    v_accvgpr_read_b32 v226, a90
    v_accvgpr_read_b32 v227, a91
    v_mul_f32 v224, v224, v54
    v_mul_f32 v225, v225, v54
    v_mul_f32 v226, v226, v54
    v_mul_f32 v227, v227, v54
    v_accvgpr_write_b32 a88, v224
    v_accvgpr_write_b32 a89, v225
    v_accvgpr_write_b32 a90, v226
    v_accvgpr_write_b32 a91, v227
    v_accvgpr_read_b32 v224, a92
    v_accvgpr_read_b32 v225, a93
    v_accvgpr_read_b32 v226, a94
    v_accvgpr_read_b32 v227, a95
    v_mul_f32 v224, v224, v55
    v_mul_f32 v225, v225, v55
    v_mul_f32 v226, v226, v55
    v_mul_f32 v227, v227, v55
    v_accvgpr_write_b32 a92, v224
    v_accvgpr_write_b32 a93, v225
    v_accvgpr_write_b32 a94, v226
    v_accvgpr_write_b32 a95, v227
    v_accvgpr_read_b32 v224, a104
    v_accvgpr_read_b32 v225, a105
    v_accvgpr_read_b32 v226, a106
    v_accvgpr_read_b32 v227, a107
    v_mul_f32 v224, v224, v54
    v_mul_f32 v225, v225, v54
    v_mul_f32 v226, v226, v54
    v_mul_f32 v227, v227, v54
    v_accvgpr_write_b32 a104, v224
    v_accvgpr_write_b32 a105, v225
    v_accvgpr_write_b32 a106, v226
    v_accvgpr_write_b32 a107, v227
    v_accvgpr_read_b32 v224, a108
    v_accvgpr_read_b32 v225, a109
    v_accvgpr_read_b32 v226, a110
    v_accvgpr_read_b32 v227, a111
    v_mul_f32 v224, v224, v55
    v_mul_f32 v225, v225, v55
    v_mul_f32 v226, v226, v55
    v_mul_f32 v227, v227, v55
    v_accvgpr_write_b32 a108, v224
    v_accvgpr_write_b32 a109, v225
    v_accvgpr_write_b32 a110, v226
    v_accvgpr_write_b32 a111, v227
    v_accvgpr_read_b32 v224, a120
    v_accvgpr_read_b32 v225, a121
    v_accvgpr_read_b32 v226, a122
    v_accvgpr_read_b32 v227, a123
    v_mul_f32 v224, v224, v54
    v_mul_f32 v225, v225, v54
    v_mul_f32 v226, v226, v54
    v_mul_f32 v227, v227, v54
    v_accvgpr_write_b32 a120, v224
    v_accvgpr_write_b32 a121, v225
    v_accvgpr_write_b32 a122, v226
    v_accvgpr_write_b32 a123, v227
    v_accvgpr_read_b32 v224, a124
    v_accvgpr_read_b32 v225, a125
    v_accvgpr_read_b32 v226, a126
    v_accvgpr_read_b32 v227, a127
    v_mul_f32 v224, v224, v55
    v_mul_f32 v225, v225, v55
    v_mul_f32 v226, v226, v55
    v_mul_f32 v227, v227, v55
    v_accvgpr_write_b32 a124, v224
    v_accvgpr_write_b32 a125, v225
    v_accvgpr_write_b32 a126, v226
    v_accvgpr_write_b32 a127, v227
    v_exp_f32 v232, v160
    v_exp_f32 v233, v161
    v_exp_f32 v234, v162
    v_exp_f32 v235, v163
    s_nop 0
    v_cvt_pk_bf16_f32 v208, v232, v233
    v_cvt_pk_bf16_f32 v209, v234, v235
    v_exp_f32 v232, v176
    v_exp_f32 v233, v177
    v_exp_f32 v234, v178
    v_exp_f32 v235, v179
    s_nop 0
    v_cvt_pk_bf16_f32 v210, v232, v233
    v_cvt_pk_bf16_f32 v211, v234, v235
    v_exp_f32 v232, v164
    v_exp_f32 v233, v165
    v_exp_f32 v234, v166
    v_exp_f32 v235, v167
    s_nop 0
    v_cvt_pk_bf16_f32 v212, v232, v233
    v_cvt_pk_bf16_f32 v213, v234, v235
    v_exp_f32 v232, v180
    v_exp_f32 v233, v181
    v_exp_f32 v234, v182
    v_exp_f32 v235, v183
    s_nop 0
    v_cvt_pk_bf16_f32 v214, v232, v233
    v_cvt_pk_bf16_f32 v215, v234, v235
    v_exp_f32 v232, v168
    v_exp_f32 v233, v169
    v_exp_f32 v234, v170
    v_exp_f32 v235, v171
    s_nop 0
    v_cvt_pk_bf16_f32 v216, v232, v233
    v_cvt_pk_bf16_f32 v217, v234, v235
    v_exp_f32 v232, v184
    v_exp_f32 v233, v185
    v_exp_f32 v234, v186
    v_exp_f32 v235, v187
    s_nop 0
    v_cvt_pk_bf16_f32 v218, v232, v233
    v_cvt_pk_bf16_f32 v219, v234, v235
    v_exp_f32 v232, v172
    v_exp_f32 v233, v173
    v_exp_f32 v234, v174
    v_exp_f32 v235, v175
    s_nop 0
    v_cvt_pk_bf16_f32 v220, v232, v233
    v_cvt_pk_bf16_f32 v221, v234, v235
    v_exp_f32 v232, v188
    v_exp_f32 v233, v189
    v_exp_f32 v234, v190
    v_exp_f32 v235, v191
    s_nop 0
    v_cvt_pk_bf16_f32 v222, v232, v233
    v_cvt_pk_bf16_f32 v223, v234, v235
    s_nop 3
    s_setpc_b64 s[40:41]
k2_rare_171:
    s_nop 7
    v_max_f32 v55, v164, v165
    v_max3_f32 v55, v55, v166, v167
    v_max3_f32 v55, v55, v180, v181
    v_max3_f32 v55, v55, v182, v183
    v_max3_f32 v55, v55, v172, v173
    v_max3_f32 v55, v55, v174, v175
    v_max3_f32 v55, v55, v188, v189
    v_max3_f32 v55, v55, v190, v191
    v_mov_b32 v227, v55
    s_nop 1
    v_permlane16_swap_b32 v55, v227
    s_nop 1
    v_max_f32 v55, v55, v227
    v_mov_b32 v227, v55
    s_nop 1
    v_permlane32_swap_b32 v55, v227
    s_nop 1
    v_max_f32 v55, v55, v227
    v_add_f32 v55, 0x41400000, v55
    v_max_f32 v55, 0, v55
    v_sub_f32 v164, v164, v55
    v_sub_f32 v165, v165, v55
    v_sub_f32 v166, v166, v55
    v_sub_f32 v167, v167, v55
    v_sub_f32 v172, v172, v55
    v_sub_f32 v173, v173, v55
    v_sub_f32 v174, v174, v55
    v_sub_f32 v175, v175, v55
    v_sub_f32 v180, v180, v55
    v_sub_f32 v181, v181, v55
    v_sub_f32 v182, v182, v55
    v_sub_f32 v183, v183, v55
    v_sub_f32 v188, v188, v55
    v_sub_f32 v189, v189, v55
    v_sub_f32 v190, v190, v55
    v_sub_f32 v191, v191, v55
    v_sub_f32 v11, v11, v55
    v_exp_f32 v55, -v55
    s_nop 0
    v_mul_f32 v252, v252, v55
    v_accvgpr_read_b32 v224, a12
    v_accvgpr_read_b32 v225, a13
    v_accvgpr_read_b32 v226, a14
    v_accvgpr_read_b32 v227, a15
    v_mul_f32 v224, v224, v55
    v_mul_f32 v225, v225, v55
    v_mul_f32 v226, v226, v55
    v_mul_f32 v227, v227, v55
    v_accvgpr_write_b32 a12, v224
    v_accvgpr_write_b32 a13, v225
    v_accvgpr_write_b32 a14, v226
    v_accvgpr_write_b32 a15, v227
    v_accvgpr_read_b32 v224, a28
    v_accvgpr_read_b32 v225, a29
    v_accvgpr_read_b32 v226, a30
    v_accvgpr_read_b32 v227, a31
    v_mul_f32 v224, v224, v55
    v_mul_f32 v225, v225, v55
    v_mul_f32 v226, v226, v55
    v_mul_f32 v227, v227, v55
    v_accvgpr_write_b32 a28, v224
    v_accvgpr_write_b32 a29, v225
    v_accvgpr_write_b32 a30, v226
    v_accvgpr_write_b32 a31, v227
    v_accvgpr_read_b32 v224, a44
    v_accvgpr_read_b32 v225, a45
    v_accvgpr_read_b32 v226, a46
    v_accvgpr_read_b32 v227, a47
    v_mul_f32 v224, v224, v55
    v_mul_f32 v225, v225, v55
    v_mul_f32 v226, v226, v55
    v_mul_f32 v227, v227, v55
    v_accvgpr_write_b32 a44, v224
    v_accvgpr_write_b32 a45, v225
    v_accvgpr_write_b32 a46, v226
    v_accvgpr_write_b32 a47, v227
    v_accvgpr_read_b32 v224, a60
    v_accvgpr_read_b32 v225, a61
    v_accvgpr_read_b32 v226, a62
    v_accvgpr_read_b32 v227, a63
    v_mul_f32 v224, v224, v55
    v_mul_f32 v225, v225, v55
    v_mul_f32 v226, v226, v55
    v_mul_f32 v227, v227, v55
    v_accvgpr_write_b32 a60, v224
    v_accvgpr_write_b32 a61, v225
    v_accvgpr_write_b32 a62, v226
    v_accvgpr_write_b32 a63, v227
    v_accvgpr_read_b32 v224, a76
    v_accvgpr_read_b32 v225, a77
    v_accvgpr_read_b32 v226, a78
    v_accvgpr_read_b32 v227, a79
    v_mul_f32 v224, v224, v55
    v_mul_f32 v225, v225, v55
    v_mul_f32 v226, v226, v55
    v_mul_f32 v227, v227, v55
    v_accvgpr_write_b32 a76, v224
    v_accvgpr_write_b32 a77, v225
    v_accvgpr_write_b32 a78, v226
    v_accvgpr_write_b32 a79, v227
    v_accvgpr_read_b32 v224, a92
    v_accvgpr_read_b32 v225, a93
    v_accvgpr_read_b32 v226, a94
    v_accvgpr_read_b32 v227, a95
    v_mul_f32 v224, v224, v55
    v_mul_f32 v225, v225, v55
    v_mul_f32 v226, v226, v55
    v_mul_f32 v227, v227, v55
    v_accvgpr_write_b32 a92, v224
    v_accvgpr_write_b32 a93, v225
    v_accvgpr_write_b32 a94, v226
    v_accvgpr_write_b32 a95, v227
    v_accvgpr_read_b32 v224, a108
    v_accvgpr_read_b32 v225, a109
    v_accvgpr_read_b32 v226, a110
    v_accvgpr_read_b32 v227, a111
    v_mul_f32 v224, v224, v55
    v_mul_f32 v225, v225, v55
    v_mul_f32 v226, v226, v55
    v_mul_f32 v227, v227, v55
    v_accvgpr_write_b32 a108, v224
    v_accvgpr_write_b32 a109, v225
    v_accvgpr_write_b32 a110, v226
    v_accvgpr_write_b32 a111, v227
    v_accvgpr_read_b32 v224, a124
    v_accvgpr_read_b32 v225, a125
    v_accvgpr_read_b32 v226, a126
    v_accvgpr_read_b32 v227, a127
    v_mul_f32 v224, v224, v55
    v_mul_f32 v225, v225, v55
    v_mul_f32 v226, v226, v55
    v_mul_f32 v227, v227, v55
    v_accvgpr_write_b32 a124, v224
    v_accvgpr_write_b32 a125, v225
    v_accvgpr_write_b32 a126, v226
    v_accvgpr_write_b32 a127, v227
    v_exp_f32 v232, v164
    v_exp_f32 v233, v165
    v_exp_f32 v234, v166
    v_exp_f32 v235, v167
    s_nop 0
    v_cvt_pk_bf16_f32 v212, v232, v233
    v_cvt_pk_bf16_f32 v213, v234, v235
    v_exp_f32 v232, v180
    v_exp_f32 v233, v181
    v_exp_f32 v234, v182
    v_exp_f32 v235, v183
    s_nop 0
    v_cvt_pk_bf16_f32 v214, v232, v233
    v_cvt_pk_bf16_f32 v215, v234, v235
    v_exp_f32 v232, v172
    v_exp_f32 v233, v173
    v_exp_f32 v234, v174
    v_exp_f32 v235, v175
    s_nop 0
    v_cvt_pk_bf16_f32 v220, v232, v233
    v_cvt_pk_bf16_f32 v221, v234, v235
    v_exp_f32 v232, v188
    v_exp_f32 v233, v189
    v_exp_f32 v234, v190
    v_exp_f32 v235, v191
    s_nop 0
    v_cvt_pk_bf16_f32 v222, v232, v233
    v_cvt_pk_bf16_f32 v223, v234, v235
    s_nop 3
    s_setpc_b64 s[40:41]
code_end:
    s_endpgm
.section .rodata,"a"
.p2align 6
.amdhsa_kernel sequential_preLN__compressed_kv_cla__moe_arch_mod__prompt_kernel
  .amdhsa_next_free_vgpr 512
  .amdhsa_next_free_sgpr 102
  .amdhsa_accum_offset 256
  .amdhsa_group_segment_fixed_size 0
  .amdhsa_kernarg_size 112
  .amdhsa_user_sgpr_count 2
  .amdhsa_user_sgpr_kernarg_segment_ptr 1
  .amdhsa_system_sgpr_workgroup_id_x 1
.end_amdhsa_kernel
```
